```python
import torch

def _softmax(x, axis=-1):
    return torch.softmax(x, dim=axis)

def _gelu(x):
    return torch.nn.functional.gelu(x, approximate='tanh')

def _silu(x):
    return torch.nn.functional.silu(x)

def _sigmoid(x):
    return torch.sigmoid(x)

def _layernorm(x, axis=-1, eps=1e-05):
    m = x.mean(dim=axis, keepdim=True)
    v = x.var(dim=axis, keepdim=True, unbiased=False)
    return (x - m) / torch.sqrt(v + eps)

def _scatter_add(tgt, idx, src, axis=0):
    return tgt.clone().index_add_(axis, idx, src)

def _segment_sum(src, seg, n):
    out = torch.zeros((n,) + src.shape[1:], dtype=src.dtype)
    return out.index_add_(0, seg, src)

def _pad(x, pw):
    flat = tuple((v for pair in reversed(pw) for v in pair))
    return torch.nn.functional.pad(x, flat)
kernel_name = 'adaLN_cond__sliding_block_cached__moe_arch_mod__prompt'

def setup_inputs():

    _w = lambda a: (lambda t: t.to(torch.bfloat16) if t.is_floating_point() else t)(torch.as_tensor(a))

    def _A_setup():
        B, Sq, D = (1, 2048, 1024)
        Hq, Hkv, Sk, Dh = (32, 4, 2048, 128)
        assert Hq % Hkv == 0, (Hq, Hkv)
        return {'x': _w((lambda *s: torch.randn(*s, dtype=torch.bfloat16) * 0.05)(B, Sq, D)), 'k_cache': _w((lambda *s: torch.randn(*s, dtype=torch.bfloat16) * 3.2)(B, Hkv, Sk, Dh)), 'v_cache': _w((lambda *s: torch.randn(*s, dtype=torch.bfloat16) * 0.4)(B, Hkv, Sk, Dh)), 'wq': _w((lambda *s: torch.randn(*s, dtype=torch.bfloat16) * 3.2)(D, Hq * Dh) * D ** (-0.5)), 'wo': _w((lambda *s: torch.randn(*s, dtype=torch.bfloat16) * 0.4)(Hq * Dh, D) * (Hq * Dh) ** (-0.5))}
    _A_in = _A_setup()

    def _B_setup():
        B, S, D, F, C = (1, 2048, 1024, 3584, 1)
        return {'x': _w((lambda *s: torch.randn(*s, dtype=torch.bfloat16) * 0.05)(B, S, D)), 'w_r': _w((lambda *s: torch.randn(*s, dtype=torch.bfloat16) * 0.05)(D)), 'w_gate': _w((lambda *s: torch.randn(*s, dtype=torch.bfloat16) * 0.05)(D, F)), 'w_up': _w((lambda *s: torch.randn(*s, dtype=torch.bfloat16) * 0.05)(D, F)), 'w_down': _w((lambda *s: torch.randn(*s, dtype=torch.bfloat16) * 0.05)(F, D))}
    _B_in = _B_setup()
    return {'A_x': _A_in['x'], 'A_k_cache': _A_in['k_cache'], 'A_v_cache': _A_in['v_cache'], 'A_wq': _A_in['wq'], 'A_wo': _A_in['wo'], 'B_x': _B_in['x'], 'B_w_r': _B_in['w_r'], 'B_w_gate': _B_in['w_gate'], 'B_w_up': _B_in['w_up'], 'B_w_down': _B_in['w_down'], 'c': _w((lambda *s: torch.randn(*s, dtype=torch.bfloat16) * 0.1)(1, 1024) * 8.0), 'w_mod': _w((lambda *s: torch.randn(*s, dtype=torch.bfloat16) * 0.1)(1024, 6 * 1024) * 1024 ** (-0.5) * 8.0)}

def reference(A_x, A_k_cache, A_v_cache, A_wq, A_wo, B_x, B_w_r, B_w_gate, B_w_up, B_w_down, c, w_mod):

    def _A_ref(x, k_cache, v_cache, wq, wo):
        B, Sq, D = x.shape
        Hq, Dh = (32, 128)
        Hkv, Sk = (k_cache.shape[1], k_cache.shape[2])
        W = min(4096, max(256, Sk // 4))
        rep = Hq // Hkv
        q = (lambda x, *d: x.permute(*d))((x @ wq).reshape(B, Sq, Hq, Dh), 0, 2, 1, 3)
        k = (lambda x, n, axis: torch.repeat_interleave(x, n, dim=axis))(k_cache[:, :, Sk - W:, :], rep, axis=1)
        v = (lambda x, n, axis: torch.repeat_interleave(x, n, dim=axis))(v_cache[:, :, Sk - W:, :], rep, axis=1)
        scores = torch.einsum('bhqd,bhkd->bhqk', q, k) * Dh ** (-0.5)
        p = _softmax(scores, axis=-1)
        o = torch.einsum('bhqk,bhkd->bhqd', p, v)
        return (lambda x, *d: x.permute(*d))(o, 0, 2, 1, 3).reshape(B, Sq, Hq * Dh) @ wo

    def _B_ref(x, w_r, w_gate, w_up, w_down):
        B, S, D = x.shape
        C = 1
        r = x @ w_r
        idx = torch.argsort(-r, axis=-1)[:, :C]
        idx_e = (lambda x, n, axis: torch.repeat_interleave(x, n, dim=axis))(idx.reshape(B, C, 1), D, axis=2)
        x_sel = (lambda x, i, axis: torch.take_along_dim(x, i, dim=axis))(x, idx_e, axis=1)
        g = _silu(x_sel @ w_gate)
        u = x_sel @ w_up
        y = g * u @ w_down
        r_sel = _sigmoid((lambda x, i, axis: torch.take_along_dim(x, i, dim=axis))(r, idx, axis=1))
        y = y * r_sel.reshape(B, C, 1)
        b_off = (torch.arange(B) * S).reshape(B, 1)
        flat_idx = (idx + b_off).reshape(B * C)
        zero = (x * 0.0).reshape(B * S, D)
        upd = _scatter_add(zero, flat_idx, y.reshape(B * C, D), axis=0)
        return x + upd.reshape(B, S, D)
    x = A_x
    mod = (_silu(c) @ w_mod).reshape(c.shape[0], 6, 1, -1)
    sa, ca, ga, sb, cb, gb = (mod[:, 0].clone(), mod[:, 1].clone(), mod[:, 2].clone(), mod[:, 3].clone(), mod[:, 4].clone(), mod[:, 5].clone())
    h = _layernorm(x, axis=-1) * (1 + ca) + sa
    x = x + ga * _A_ref(h, A_k_cache, A_v_cache, A_wq, A_wo)
    h = _layernorm(x, axis=-1) * (1 + cb) + sb
    x = x + gb * _B_ref(h, B_w_r, B_w_gate, B_w_up, B_w_down)
    return x
```

```asm
; @launch grid=(256,1,1) block=(512,1,1) lds=163840
.amdgcn_target "amdgcn-amd-amdhsa--gfx950"
.text
.globl adaLN_cond__sliding_block_cached__moe_arch_mod__prompt_kernel
.p2align 8
.type adaLN_cond__sliding_block_cached__moe_arch_mod__prompt_kernel,@function
adaLN_cond__sliding_block_cached__moe_arch_mod__prompt_kernel:
    s_cmp_ge_u32 s2, 256
    s_cbranch_scc1 adaLN_cond__sliding_block_cached__moe_arch_mod__prompt_kernel_end
    s_load_dwordx4 s[56:59], s[0:1], 96
    s_load_dwordx2 s[60:61], s[0:1], 112
    s_load_dwordx8 s[48:55], s[0:1], 64
    s_load_dwordx16 s[32:47], s[0:1], 0
    s_memrealtime s[62:63]
    v_lshrrev_b32 v16, 6, v0
    v_and_b32 v1, 63, v0
    v_readfirstlane_b32 s3, v16
    v_lshlrev_b32 v2, 4, v1
    s_and_b32 s12, s2, 3
    s_lshl_b32 s12, s12, 3
    s_bfe_u32 s13, s2, 0x30003
    s_add_u32 s12, s12, s13
    s_bfe_u32 s13, s2, 0x10002
    s_lshl_b32 s13, s13, 2
    s_lshr_b32 s14, s2, 6
    s_add_u32 s13, s13, s14
    v_bfe_u32 v16, v1, 2, 2
    v_lshrrev_b32 v17, 4, v1
    v_and_b32 v18, 3, v1
    v_lshlrev_b32 v19, 6, v17
    v_lshl_add_u32 v19, v18, 4, v19
    v_lshl_add_u32 v3, v16, 13, v19
    s_and_b32 s14, s3, 1
    s_lshl_b32 s14, s14, 5
    v_xor_b32 v3, s14, v3
    v_lshlrev_b32 v4, 11, v17
    v_lshl_add_u32 v4, v16, 6, v4
    v_lshl_add_u32 v4, v18, 3, v4
    v_and_b32 v20, 1, v17
    v_lshlrev_b32 v20, 5, v20
    v_sub_u32 v5, v4, v20
    v_add_u32 v4, v4, v20
    s_lshl_b32 s14, s13, 3
    s_add_u32 s14, s14, s3
    s_lshl_b32 s14, s14, 16
    v_add_u32 v7, s14, v2
    s_cmp_ge_u32 s3, 4
    s_cbranch_scc1 adaLN_cond__sliding_block_cached__moe_arch_mod__prompt_kernel_roleB
    v_mov_b32 v132, 0
    v_mov_b32 v133, 0
    v_lshrrev_b32 v16, 3, v0
    v_and_b32 v17, 7, v0
    v_mul_u32_u24 v135, 24576, v16
    v_lshl_add_u32 v135, v17, 4, v135
    v_lshlrev_b32 v136, 2, v16
    s_and_b32 s14, s2, 31
    s_lshr_b32 s15, s2, 5
    s_mul_i32 s26, s15, 1572864
    s_lshl_b32 s16, s14, 7
    s_add_u32 s26, s26, s16
    s_lshl_b32 s29, s15, 8
    v_lshlrev_b32 v137, 3, v0
    s_lshl_b32 s18, s2, 3
    s_add_u32 s18, s18, s3
    s_lshl_b32 s18, s18, 11
    v_and_b32 v18, 15, v1
    v_lshrrev_b32 v19, 4, v1
    v_lshlrev_b32 v138, 11, v18
    v_lshl_add_u32 v138, v19, 4, v138
    s_lshr_b32 s30, s2, 4
    s_and_b32 s31, s2, 15
    s_lshl_b32 s19, s30, 3
    s_add_u32 s19, s19, s3
    s_lshl_b32 s22, s19, 15
    s_lshl_b32 s23, s31, 7
    s_add_u32 s22, s22, s23
    s_lshl_b32 s23, s2, 12
    s_add_u32 s23, s23, 0x600000
    s_or_b32 s25, s2, s3
    s_cmp_eq_u32 s25, 0
    s_cselect_b32 s25, 0, 0x7ffffff0
    s_waitcnt lgkmcnt(0)
    s_mov_b64 s[64:65], s[58:59]
    s_mov_b32 s66, 0x100
    s_mov_b32 s67, 0x20000
    s_or_b32 s28, s62, 1
    v_mov_b32 v134, s28
    s_mov_b64 exec, 1
    buffer_store_dword v134, v132, s[64:67], s25 offen sc1
    s_mov_b64 exec, -1
    s_mov_b64 s[68:69], s[52:53]
    s_mov_b32 s70, 0x800
    s_mov_b32 s71, 0x20000
    s_mov_b64 s[72:73], s[54:55]
    s_mov_b32 s74, 0xc00000
    s_mov_b32 s75, 0x20000
    s_mov_b64 s[76:77], s[32:33]
    s_mov_b32 s78, 0x400000
    s_mov_b32 s79, 0x20000
    s_mov_b64 s[8:9], s[60:61]
    s_mov_b32 s10, 0x3400000
    s_mov_b32 s11, 0x20000
    buffer_load_dword v72, v136, s[68:71], s29 offen
    buffer_load_dwordx4 v[24:27], v135, s[72:75], s26 offen
    s_add_u32 s26, s26, 12288
    buffer_load_dwordx4 v[28:31], v135, s[72:75], s26 offen
    buffer_load_dwordx4 v[32:35], v2, s[76:79], s18 offen offset:0
    buffer_load_dwordx4 v[36:39], v2, s[76:79], s18 offen offset:1024
    s_cmp_eq_u32 s3, 0
    s_cselect_b32 s25, 0, 0x7ffffff0
    buffer_load_dword v134, v132, s[64:67], s25 offen sc1
    buffer_store_dwordx2 v[132:133], v137, s[8:11], s23 offen sc1
    s_barrier
    buffer_load_dwordx4 v[40:43], v138, s[76:79], s22 offen offset:0
    buffer_load_dwordx4 v[44:47], v138, s[76:79], s22 offen offset:64
    s_mov_b32 s29, s19
    s_waitcnt vmcnt(8)
    v_and_b32 v73, 0xffff0000, v72
    v_lshlrev_b32 v72, 16, v72
    v_mul_f32 v16, 0xbfb8aa3b, v72
    v_exp_f32 v16, v16
    s_nop 0
    v_add_f32 v16, 1.0, v16
    v_rcp_f32 v16, v16
    s_nop 0
    v_mul_f32 v72, v72, v16
    v_mul_f32 v17, 0xbfb8aa3b, v73
    v_exp_f32 v17, v17
    s_nop 0
    v_add_f32 v17, 1.0, v17
    v_rcp_f32 v17, v17
    s_nop 0
    v_mul_f32 v73, v73, v17
    v_cvt_pk_bf16_f32 v16, v72, v73
    v_lshlrev_b32 v72, 16, v16
    v_and_b32 v73, 0xffff0000, v16
    v_lshrrev_b32 v74, 16, v72
    v_lshrrev_b32 v75, 16, v73
    s_waitcnt vmcnt(7)
    v_dot2_f32_bf16 v49, v24, v72, 0
    v_dot2_f32_bf16 v48, v24, v74, 0
    v_dot2_f32_bf16 v51, v25, v72, 0
    v_dot2_f32_bf16 v50, v25, v74, 0
    v_dot2_f32_bf16 v53, v26, v72, 0
    v_dot2_f32_bf16 v52, v26, v74, 0
    v_dot2_f32_bf16 v55, v27, v72, 0
    v_dot2_f32_bf16 v54, v27, v74, 0
    s_waitcnt vmcnt(6)
    v_dot2c_f32_bf16 v49, v28, v73
    v_dot2c_f32_bf16 v48, v28, v75
    v_dot2c_f32_bf16 v51, v29, v73
    v_dot2c_f32_bf16 v50, v29, v75
    v_dot2c_f32_bf16 v53, v30, v73
    v_dot2c_f32_bf16 v52, v30, v75
    v_dot2c_f32_bf16 v55, v31, v73
    v_dot2c_f32_bf16 v54, v31, v75
    s_nop 0
    v_permlane32_swap_b32 v48, v52
    v_permlane32_swap_b32 v49, v53
    v_permlane32_swap_b32 v50, v54
    v_permlane32_swap_b32 v51, v55
    v_add_f32 v48, v48, v52
    v_add_f32 v49, v49, v53
    v_add_f32 v50, v50, v54
    v_add_f32 v51, v51, v55
    s_nop 0
    v_permlane16_swap_b32 v48, v50
    v_permlane16_swap_b32 v49, v51
    v_add_f32 v48, v48, v50
    v_add_f32 v49, v49, v51
    s_nop 0
    v_add_f32_dpp v48, v48, v48 row_ror:8 row_mask:0xf bank_mask:0xf
    v_add_f32_dpp v49, v49, v49 row_ror:8 row_mask:0xf bank_mask:0xf
    v_and_b32 v16, 7, v1
    v_lshlrev_b32 v16, 5, v16
    v_lshrrev_b32 v17, 4, v1
    v_lshl_add_u32 v16, v17, 3, v16
    s_lshl_b32 s16, s3, 8
    s_add_u32 s16, s16, 65536
    v_add_u32 v16, s16, v16
    ds_write_b64 v16, v[48:49]
    s_waitcnt vmcnt(5)
    v_lshlrev_b32 v56, 16, v32
    v_and_b32 v57, 0xffff0000, v32
    v_lshlrev_b32 v58, 16, v33
    v_and_b32 v59, 0xffff0000, v33
    v_lshlrev_b32 v60, 16, v34
    v_and_b32 v61, 0xffff0000, v34
    v_lshlrev_b32 v62, 16, v35
    v_and_b32 v63, 0xffff0000, v35
    s_waitcnt vmcnt(4)
    v_lshlrev_b32 v64, 16, v36
    v_and_b32 v65, 0xffff0000, v36
    v_lshlrev_b32 v66, 16, v37
    v_and_b32 v67, 0xffff0000, v37
    v_lshlrev_b32 v68, 16, v38
    v_and_b32 v69, 0xffff0000, v38
    v_lshlrev_b32 v70, 16, v39
    v_and_b32 v71, 0xffff0000, v39
    v_add_f32 v20, v56, v57
    v_add_f32 v21, v58, v59
    v_add_f32 v20, v20, v60
    v_add_f32 v21, v21, v61
    v_add_f32 v20, v20, v62
    v_add_f32 v21, v21, v63
    v_add_f32 v20, v20, v64
    v_add_f32 v21, v21, v65
    v_add_f32 v20, v20, v66
    v_add_f32 v21, v21, v67
    v_add_f32 v20, v20, v68
    v_add_f32 v21, v21, v69
    v_add_f32 v20, v20, v70
    v_add_f32 v21, v21, v71
    v_add_f32 v128, v20, v21
    s_nop 1
    v_add_f32_dpp v128, v128, v128 row_ror:1 row_mask:0xf bank_mask:0xf
    s_nop 1
    v_add_f32_dpp v128, v128, v128 row_ror:2 row_mask:0xf bank_mask:0xf
    s_nop 1
    v_add_f32_dpp v128, v128, v128 row_ror:4 row_mask:0xf bank_mask:0xf
    s_nop 1
    v_add_f32_dpp v128, v128, v128 row_ror:8 row_mask:0xf bank_mask:0xf
    v_mov_b32 v20, v128
    s_nop 1
    v_permlane16_swap_b32 v128, v20
    v_add_f32 v128, v128, v20
    v_mov_b32 v20, v128
    s_nop 1
    v_permlane32_swap_b32 v128, v20
    v_add_f32 v128, v128, v20
    v_mul_f32 v128, 0x3a800000, v128
    v_sub_f32 v18, v56, v128
    v_mul_f32 v20, v18, v18
    v_sub_f32 v19, v57, v128
    v_mul_f32 v21, v19, v19
    v_sub_f32 v18, v58, v128
    v_sub_f32 v19, v59, v128
    v_fmac_f32 v20, v18, v18
    v_fmac_f32 v21, v19, v19
    v_sub_f32 v18, v60, v128
    v_sub_f32 v19, v61, v128
    v_fmac_f32 v20, v18, v18
    v_fmac_f32 v21, v19, v19
    v_sub_f32 v18, v62, v128
    v_sub_f32 v19, v63, v128
    v_fmac_f32 v20, v18, v18
    v_fmac_f32 v21, v19, v19
    v_sub_f32 v18, v64, v128
    v_sub_f32 v19, v65, v128
    v_fmac_f32 v20, v18, v18
    v_fmac_f32 v21, v19, v19
    v_sub_f32 v18, v66, v128
    v_sub_f32 v19, v67, v128
    v_fmac_f32 v20, v18, v18
    v_fmac_f32 v21, v19, v19
    v_sub_f32 v18, v68, v128
    v_sub_f32 v19, v69, v128
    v_fmac_f32 v20, v18, v18
    v_fmac_f32 v21, v19, v19
    v_sub_f32 v18, v70, v128
    v_sub_f32 v19, v71, v128
    v_fmac_f32 v20, v18, v18
    v_fmac_f32 v21, v19, v19
    v_add_f32 v17, v20, v21
    s_nop 1
    v_add_f32_dpp v17, v17, v17 row_ror:1 row_mask:0xf bank_mask:0xf
    s_nop 1
    v_add_f32_dpp v17, v17, v17 row_ror:2 row_mask:0xf bank_mask:0xf
    s_nop 1
    v_add_f32_dpp v17, v17, v17 row_ror:4 row_mask:0xf bank_mask:0xf
    s_nop 1
    v_add_f32_dpp v17, v17, v17 row_ror:8 row_mask:0xf bank_mask:0xf
    v_mov_b32 v20, v17
    s_nop 1
    v_permlane16_swap_b32 v17, v20
    v_add_f32 v17, v17, v20
    v_mov_b32 v20, v17
    s_nop 1
    v_permlane32_swap_b32 v17, v20
    v_add_f32 v17, v17, v20
    v_mul_f32 v17, 0x3a800000, v17
    v_cvt_pk_bf16_f32 v128, v128, v128
    v_lshlrev_b32 v128, 16, v128
    v_cvt_pk_bf16_f32 v17, v17, v17
    v_lshlrev_b32 v17, 16, v17
    v_add_f32 v17, 0x3727c5ac, v17
    v_cvt_pk_bf16_f32 v17, v17, v17
    v_lshlrev_b32 v17, 16, v17
    v_sqrt_f32 v129, v17
    s_nop 0
    v_cvt_pk_bf16_f32 v129, v129, v129
    v_lshlrev_b32 v129, 16, v129
    v_rcp_f32 v130, v129
    s_lshl_b32 s16, s3, 4
    s_add_u32 s16, s16, 67600
    v_mov_b32 v19, s16
    ds_write_b128 v19, v[128:131]
    s_waitcnt vmcnt(3)
    v_cmp_eq_u32 vcc, 0, v134
    s_cmp_eq_u32 s3, 0
    s_cselect_b64 s[62:63], -1, 0
    s_and_b64 vcc, vcc, s[62:63]
    s_cbranch_vccnz adaLN_cond__sliding_block_cached__moe_arch_mod__prompt_kernel_n1r
adaLN_cond__sliding_block_cached__moe_arch_mod__prompt_kernel_n1b:
    v_mov_b32 v19, 67584
    s_cmp_eq_u32 s3, 0
    s_cselect_b64 exec, 1, 0
    ds_write_b32 v19, v134
    s_mov_b64 exec, -1
    v_mov_b32 v19, 67584
    v_and_b32 v17, 31, v1
    v_lshlrev_b32 v18, 3, v17
    v_add_u32 v18, 65536, v18
    v_lshlrev_b32 v17, 4, v17
    s_waitcnt lgkmcnt(0)
    s_barrier
    ds_read_b32 v134, v19
    ds_read_b64 v[96:97], v18 offset:0
    ds_read_b64 v[100:101], v18 offset:256
    ds_read_b64 v[104:105], v18 offset:512
    ds_read_b64 v[108:109], v18 offset:768
    ds_read_b64 v[112:113], v18 offset:1024
    ds_read_b64 v[116:117], v18 offset:1280
    ds_read_b64 v[120:121], v18 offset:1536
    ds_read_b64 v[124:125], v18 offset:1792
    s_waitcnt lgkmcnt(8)
    v_readfirstlane_b32 s28, v134
    v_and_b32 v20, 7, v1
    v_lshlrev_b32 v20, 4, v20
    v_add_u32 v21, 67600, v20
    ds_read_b128 v[128:131], v21
    s_waitcnt lgkmcnt(0)
    v_mov_b32 v131, s28
    s_lshl_b32 s16, s2, 7
    s_add_u32 s16, s16, 0x520000
    s_cmp_eq_u32 s3, 0
    s_cselect_b32 s16, s16, 0x7ffffff0
    s_mov_b64 exec, 0xff
    buffer_store_dwordx4 v[128:131], v20, s[8:11], s16 offen sc1
    s_mov_b64 exec, -1
    v_pk_add_f32 v[96:97], v[96:97], v[112:113]
    v_pk_add_f32 v[100:101], v[100:101], v[116:117]
    v_pk_add_f32 v[104:105], v[104:105], v[120:121]
    v_pk_add_f32 v[108:109], v[108:109], v[124:125]
    v_pk_add_f32 v[96:97], v[96:97], v[104:105]
    v_pk_add_f32 v[100:101], v[100:101], v[108:109]
    v_pk_add_f32 v[96:97], v[96:97], v[100:101]
    v_mov_b32 v98, s28
    v_mov_b32 v99, s28
    s_lshl_b32 s16, s14, 3
    s_add_u32 s16, s16, s15
    s_lshl_b32 s16, s16, 9
    s_add_u32 s16, s16, 0x500000
    s_cmp_eq_u32 s3, 0
    s_cselect_b32 s16, s16, 0x7ffffff0
    s_mov_b64 exec, 0xffffffff
    buffer_store_dwordx4 v[96:99], v17, s[8:11], s16 offen sc1
    s_mov_b64 exec, -1
    s_lshr_b32 s16, s3, 2
    s_lshl_b32 s16, s16, 4
    s_add_u32 s16, s16, s31
    s_lshl_b32 s16, s16, 12
    s_and_b32 s17, s3, 3
    s_lshl_b32 s17, s17, 7
    s_add_u32 s16, s16, s17
    s_add_u32 s16, s16, 0x500000
    v_lshrrev_b32 v139, 3, v1
    v_lshlrev_b32 v139, 9, v139
    v_and_b32 v16, 7, v1
    v_lshl_add_u32 v139, v16, 4, v139
    v_and_b32 v140, 15, v1
    v_lshlrev_b32 v140, 4, v140
    s_lshl_b32 s17, s29, 8
    s_add_u32 s17, s17, 0x520000
    s_waitcnt vmcnt(3)
    v_lshlrev_b32 v56, 16, v40
    v_and_b32 v57, 0xffff0000, v40
    v_lshlrev_b32 v58, 16, v41
    v_and_b32 v59, 0xffff0000, v41
    v_lshlrev_b32 v60, 16, v42
    v_and_b32 v61, 0xffff0000, v42
    v_lshlrev_b32 v62, 16, v43
    v_and_b32 v63, 0xffff0000, v43
    s_waitcnt vmcnt(2)
    v_lshlrev_b32 v64, 16, v44
    v_and_b32 v65, 0xffff0000, v44
    v_lshlrev_b32 v66, 16, v45
    v_and_b32 v67, 0xffff0000, v45
    v_lshlrev_b32 v68, 16, v46
    v_and_b32 v69, 0xffff0000, v46
    v_lshlrev_b32 v70, 16, v47
    v_and_b32 v71, 0xffff0000, v47
    s_mov_b32 s27, 0
adaLN_cond__sliding_block_cached__moe_arch_mod__prompt_kernel_g2p:
    buffer_load_dwordx4 v[76:79], v139, s[8:11], s16 offen sc1
    buffer_load_dwordx4 v[80:83], v140, s[8:11], s17 offen sc1
    s_waitcnt vmcnt(1)
    v_cmp_ne_u32 vcc, s28, v78
    v_cmp_ne_u32 s[62:63], s28, v79
    s_or_b64 vcc, vcc, s[62:63]
    s_waitcnt vmcnt(0)
    v_cmp_ne_u32 s[62:63], s28, v83
    s_or_b64 vcc, vcc, s[62:63]
    s_add_u32 s27, s27, 1
    s_cmp_ge_u32 s27, 262144
    s_cbranch_scc1 adaLN_cond__sliding_block_cached__moe_arch_mod__prompt_kernel_g2g
    s_cbranch_vccnz adaLN_cond__sliding_block_cached__moe_arch_mod__prompt_kernel_g2p
adaLN_cond__sliding_block_cached__moe_arch_mod__prompt_kernel_g2g:
    v_add_f32_dpp v76, v76, v76 row_ror:8 row_mask:0xf bank_mask:0xf
    v_add_f32_dpp v77, v77, v77 row_ror:8 row_mask:0xf bank_mask:0xf
    v_mov_b32 v17, v76
    s_nop 1
    v_permlane16_swap_b32 v76, v17
    v_add_f32 v76, v76, v17
    v_mov_b32 v18, v77
    s_nop 1
    v_permlane16_swap_b32 v77, v18
    v_add_f32 v77, v77, v18
    v_mov_b32 v17, v76
    s_nop 1
    v_permlane32_swap_b32 v76, v17
    v_add_f32 v76, v76, v17
    v_mov_b32 v18, v77
    s_nop 1
    v_permlane32_swap_b32 v77, v18
    v_add_f32 v77, v77, v18
    v_cvt_pk_bf16_f32 v17, v76, v77
    v_lshlrev_b32 v76, 16, v17
    v_and_b32 v77, 0xffff0000, v17
    v_add_f32 v76, 0, v76
    v_add_f32 v77, 0, v77
    s_lshl_b32 s16, s3, 6
    s_add_u32 s16, s16, 69632
    v_lshl_add_u32 v16, v16, 3, s16
    ds_write_b64 v16, v[76:77]
    v_lshrrev_b32 v17, 4, v1
    v_lshlrev_b32 v17, 5, v17
    v_add_u32 v17, 69632, v17
    v_sub_f32 v56, v56, v80
    v_sub_f32 v57, v57, v80
    v_sub_f32 v58, v58, v80
    v_sub_f32 v59, v59, v80
    v_sub_f32 v60, v60, v80
    v_sub_f32 v61, v61, v80
    v_sub_f32 v62, v62, v80
    v_sub_f32 v63, v63, v80
    v_sub_f32 v64, v64, v80
    v_sub_f32 v65, v65, v80
    v_sub_f32 v66, v66, v80
    v_sub_f32 v67, v67, v80
    v_sub_f32 v68, v68, v80
    v_sub_f32 v69, v69, v80
    v_sub_f32 v70, v70, v80
    v_sub_f32 v71, v71, v80
    v_cvt_pk_bf16_f32 v18, v56, v57
    v_lshlrev_b32 v56, 16, v18
    v_and_b32 v57, 0xffff0000, v18
    v_cvt_pk_bf16_f32 v19, v58, v59
    v_lshlrev_b32 v58, 16, v19
    v_and_b32 v59, 0xffff0000, v19
    v_cvt_pk_bf16_f32 v18, v60, v61
    v_lshlrev_b32 v60, 16, v18
    v_and_b32 v61, 0xffff0000, v18
    v_cvt_pk_bf16_f32 v19, v62, v63
    v_lshlrev_b32 v62, 16, v19
    v_and_b32 v63, 0xffff0000, v19
    v_cvt_pk_bf16_f32 v18, v64, v65
    v_lshlrev_b32 v64, 16, v18
    v_and_b32 v65, 0xffff0000, v18
    v_cvt_pk_bf16_f32 v19, v66, v67
    v_lshlrev_b32 v66, 16, v19
    v_and_b32 v67, 0xffff0000, v19
    v_cvt_pk_bf16_f32 v18, v68, v69
    v_lshlrev_b32 v68, 16, v18
    v_and_b32 v69, 0xffff0000, v18
    v_cvt_pk_bf16_f32 v19, v70, v71
    v_lshlrev_b32 v70, 16, v19
    v_and_b32 v71, 0xffff0000, v19
    v_mul_f32 v56, v56, v82
    v_mul_f32 v57, v57, v82
    v_mul_f32 v58, v58, v82
    v_mul_f32 v59, v59, v82
    v_mul_f32 v60, v60, v82
    v_mul_f32 v61, v61, v82
    v_mul_f32 v62, v62, v82
    v_mul_f32 v63, v63, v82
    v_mul_f32 v64, v64, v82
    v_mul_f32 v65, v65, v82
    v_mul_f32 v66, v66, v82
    v_mul_f32 v67, v67, v82
    v_mul_f32 v68, v68, v82
    v_mul_f32 v69, v69, v82
    v_mul_f32 v70, v70, v82
    v_mul_f32 v71, v71, v82
    v_cvt_pk_bf16_f32 v18, v56, v57
    v_lshlrev_b32 v56, 16, v18
    v_and_b32 v57, 0xffff0000, v18
    v_cvt_pk_bf16_f32 v19, v58, v59
    v_lshlrev_b32 v58, 16, v19
    v_and_b32 v59, 0xffff0000, v19
    v_cvt_pk_bf16_f32 v18, v60, v61
    v_lshlrev_b32 v60, 16, v18
    v_and_b32 v61, 0xffff0000, v18
    v_cvt_pk_bf16_f32 v19, v62, v63
    v_lshlrev_b32 v62, 16, v19
    v_and_b32 v63, 0xffff0000, v19
    v_cvt_pk_bf16_f32 v18, v64, v65
    v_lshlrev_b32 v64, 16, v18
    v_and_b32 v65, 0xffff0000, v18
    v_cvt_pk_bf16_f32 v19, v66, v67
    v_lshlrev_b32 v66, 16, v19
    v_and_b32 v67, 0xffff0000, v19
    v_cvt_pk_bf16_f32 v18, v68, v69
    v_lshlrev_b32 v68, 16, v18
    v_and_b32 v69, 0xffff0000, v18
    v_cvt_pk_bf16_f32 v19, v70, v71
    v_lshlrev_b32 v70, 16, v19
    v_and_b32 v71, 0xffff0000, v19
    s_lshl_b32 s16, s29, 15
    s_lshl_b32 s17, s31, 11
    s_add_u32 s16, s16, s17
    s_waitcnt lgkmcnt(0)
    s_barrier
    ds_read_b128 v[96:99], v17 offset:256
    ds_read_b128 v[104:107], v17 offset:0
    ds_read_b128 v[100:103], v17 offset:272
    ds_read_b128 v[108:111], v17 offset:16
    ds_read_b128 v[112:115], v17 offset:384
    ds_read_b128 v[120:123], v17 offset:128
    ds_read_b128 v[116:119], v17 offset:400
    ds_read_b128 v[124:127], v17 offset:144
    s_waitcnt lgkmcnt(7)
    v_pk_mul_f32 v[56:57], v[56:57], v[96:97]
    v_pk_mul_f32 v[58:59], v[58:59], v[98:99]
    s_waitcnt lgkmcnt(5)
    v_pk_mul_f32 v[60:61], v[60:61], v[100:101]
    v_pk_mul_f32 v[62:63], v[62:63], v[102:103]
    v_cvt_pk_bf16_f32 v18, v56, v57
    v_lshlrev_b32 v56, 16, v18
    v_and_b32 v57, 0xffff0000, v18
    v_cvt_pk_bf16_f32 v19, v58, v59
    v_lshlrev_b32 v58, 16, v19
    v_and_b32 v59, 0xffff0000, v19
    v_cvt_pk_bf16_f32 v18, v60, v61
    v_lshlrev_b32 v60, 16, v18
    v_and_b32 v61, 0xffff0000, v18
    v_cvt_pk_bf16_f32 v19, v62, v63
    v_lshlrev_b32 v62, 16, v19
    v_and_b32 v63, 0xffff0000, v19
    v_pk_add_f32 v[56:57], v[56:57], v[104:105]
    v_pk_add_f32 v[58:59], v[58:59], v[106:107]
    s_waitcnt lgkmcnt(4)
    v_pk_add_f32 v[60:61], v[60:61], v[108:109]
    v_pk_add_f32 v[62:63], v[62:63], v[110:111]
    v_cvt_pk_bf16_f32 v32, v56, v57
    v_cvt_pk_bf16_f32 v33, v58, v59
    v_cvt_pk_bf16_f32 v34, v60, v61
    v_cvt_pk_bf16_f32 v35, v62, v63
    buffer_store_dwordx4 v[32:35], v2, s[8:11], s16 offen offset:0 sc1
    s_waitcnt lgkmcnt(3)
    v_pk_mul_f32 v[64:65], v[64:65], v[112:113]
    v_pk_mul_f32 v[66:67], v[66:67], v[114:115]
    s_waitcnt lgkmcnt(1)
    v_pk_mul_f32 v[68:69], v[68:69], v[116:117]
    v_pk_mul_f32 v[70:71], v[70:71], v[118:119]
    v_cvt_pk_bf16_f32 v18, v64, v65
    v_lshlrev_b32 v64, 16, v18
    v_and_b32 v65, 0xffff0000, v18
    v_cvt_pk_bf16_f32 v19, v66, v67
    v_lshlrev_b32 v66, 16, v19
    v_and_b32 v67, 0xffff0000, v19
    v_cvt_pk_bf16_f32 v18, v68, v69
    v_lshlrev_b32 v68, 16, v18
    v_and_b32 v69, 0xffff0000, v18
    v_cvt_pk_bf16_f32 v19, v70, v71
    v_lshlrev_b32 v70, 16, v19
    v_and_b32 v71, 0xffff0000, v19
    v_pk_add_f32 v[64:65], v[64:65], v[120:121]
    v_pk_add_f32 v[66:67], v[66:67], v[122:123]
    s_waitcnt lgkmcnt(0)
    v_pk_add_f32 v[68:69], v[68:69], v[124:125]
    v_pk_add_f32 v[70:71], v[70:71], v[126:127]
    v_cvt_pk_bf16_f32 v36, v64, v65
    v_cvt_pk_bf16_f32 v37, v66, v67
    v_cvt_pk_bf16_f32 v38, v68, v69
    v_cvt_pk_bf16_f32 v39, v70, v71
    buffer_store_dwordx4 v[36:39], v2, s[8:11], s16 offen offset:1024 sc1
    s_lshl_b32 s19, s3, 16
    s_lshl_b32 s20, s3, 11
    s_lshl_b32 s16, s12, 8
    s_add_u32 s4, s38, s16
    s_addc_u32 s5, s39, 0
    s_sub_u32 s6, 0x800000, s16
    s_mov_b32 s7, 0x20000
    s_add_u32 s22, s19, 0x0
    s_add_u32 m0, s20, 0x0
    s_nop 0
    buffer_load_dwordx4 v3, s[4:7], s22 offen lds
    s_add_u32 s22, s19, 0x8000
    s_add_u32 m0, s20, 0x400
    s_nop 0
    buffer_load_dwordx4 v3, s[4:7], s22 offen lds
    s_add_u32 s22, s19, 0x80000
    s_add_u32 m0, s20, 0x4000
    s_nop 0
    buffer_load_dwordx4 v3, s[4:7], s22 offen lds
    s_add_u32 s22, s19, 0x88000
    s_add_u32 m0, s20, 0x4400
    s_nop 0
    buffer_load_dwordx4 v3, s[4:7], s22 offen lds
    s_add_u32 s22, s19, 0x100000
    s_add_u32 m0, s20, 0x8000
    s_nop 0
    buffer_load_dwordx4 v3, s[4:7], s22 offen lds
    s_add_u32 s22, s19, 0x108000
    s_add_u32 m0, s20, 0x8400
    s_nop 0
    buffer_load_dwordx4 v3, s[4:7], s22 offen lds
    v_mov_b32 v134, s28
    s_lshl_b32 s16, s29, 4
    s_add_u32 s16, s16, s31
    s_lshl_b32 s16, s16, 2
    s_add_u32 s16, s16, 0x528000
    v_and_b32 v16, 31, v1
    v_lshlrev_b32 v16, 2, v16
    s_lshl_b32 s17, s13, 3
    s_add_u32 s17, s17, s3
    s_lshl_b32 s17, s17, 7
    s_add_u32 s17, s17, 0x528000
    s_waitcnt vmcnt(6)
    s_mov_b64 exec, 1
    buffer_store_dword v134, v132, s[8:11], s16 offen sc1
    s_mov_b64 exec, -1
    s_sleep 48
    s_mov_b32 s27, 0
adaLN_cond__sliding_block_cached__moe_arch_mod__prompt_kernel_h3p:
    buffer_load_dword v17, v16, s[8:11], s17 offen sc1
    s_waitcnt vmcnt(0)
    v_cmp_ne_u32 vcc, s28, v17
    s_add_u32 s27, s27, 1
    s_cmp_ge_u32 s27, 262144
    s_cbranch_scc1 adaLN_cond__sliding_block_cached__moe_arch_mod__prompt_kernel_h3g
    s_cbranch_vccnz adaLN_cond__sliding_block_cached__moe_arch_mod__prompt_kernel_h3p
adaLN_cond__sliding_block_cached__moe_arch_mod__prompt_kernel_h3g:
    s_mov_b32 s23, 0x0
    buffer_load_dwordx4 v[88:91], v7, s[8:11], s23 offen offset:0 sc1
    s_mov_b32 s23, 0x8000
    buffer_load_dwordx4 v[92:95], v7, s[8:11], s23 offen offset:0 sc1
    s_mov_b32 s23, 0x0
    buffer_load_dwordx4 v[96:99], v7, s[8:11], s23 offen offset:1024 sc1
    s_mov_b32 s23, 0x8000
    buffer_load_dwordx4 v[100:103], v7, s[8:11], s23 offen offset:1024 sc1
    s_mov_b32 s23, 0x800
    buffer_load_dwordx4 v[104:107], v7, s[8:11], s23 offen offset:0 sc1
    s_mov_b32 s23, 0x8800
    buffer_load_dwordx4 v[108:111], v7, s[8:11], s23 offen offset:0 sc1
    s_mov_b32 s23, 0x800
    buffer_load_dwordx4 v[112:115], v7, s[8:11], s23 offen offset:1024 sc1
    s_mov_b32 s23, 0x8800
    buffer_load_dwordx4 v[116:119], v7, s[8:11], s23 offen offset:1024 sc1
    s_lshr_b32 s21, s12, 3
    s_lshl_b32 s21, s21, 17
    s_add_u32 s21, s21, s20
    s_add_u32 s21, s21, 0x400000
    s_barrier
    ds_read_b64_tr_b16 v[224:225], v4 offset:0
    ds_read_b64_tr_b16 v[226:227], v4 offset:1024
    ds_read_b64_tr_b16 v[228:229], v5 offset:32
    ds_read_b64_tr_b16 v[230:231], v5 offset:1056
    ds_read_b64_tr_b16 v[232:233], v4 offset:256
    ds_read_b64_tr_b16 v[234:235], v4 offset:1280
    ds_read_b64_tr_b16 v[236:237], v5 offset:288
    ds_read_b64_tr_b16 v[238:239], v5 offset:1312
    s_waitcnt vmcnt(7) lgkmcnt(6)
    v_mfma_f32_16x16x32_bf16 v[24:27], v[224:227], v[88:91], 0
    ds_read_b64_tr_b16 v[240:241], v4 offset:512
    s_waitcnt vmcnt(6)
    v_mfma_f32_16x16x32_bf16 v[28:31], v[224:227], v[92:95], 0
    ds_read_b64_tr_b16 v[242:243], v4 offset:1536
    s_waitcnt lgkmcnt(6)
    v_mfma_f32_16x16x32_bf16 v[32:35], v[228:231], v[88:91], 0
    ds_read_b64_tr_b16 v[244:245], v5 offset:544
    v_mfma_f32_16x16x32_bf16 v[36:39], v[228:231], v[92:95], 0
    ds_read_b64_tr_b16 v[246:247], v5 offset:1568
    s_mov_b32 s23, 0x1000
    buffer_load_dwordx4 v[120:123], v7, s[8:11], s23 offen offset:0 sc1
    s_waitcnt lgkmcnt(6)
    v_mfma_f32_16x16x32_bf16 v[40:43], v[232:235], v[88:91], 0
    ds_read_b64_tr_b16 v[224:225], v4 offset:768
    v_mfma_f32_16x16x32_bf16 v[44:47], v[232:235], v[92:95], 0
    ds_read_b64_tr_b16 v[226:227], v4 offset:1792
    s_waitcnt lgkmcnt(6)
    v_mfma_f32_16x16x32_bf16 v[48:51], v[236:239], v[88:91], 0
    ds_read_b64_tr_b16 v[228:229], v5 offset:800
    v_mfma_f32_16x16x32_bf16 v[52:55], v[236:239], v[92:95], 0
    ds_read_b64_tr_b16 v[230:231], v5 offset:1824
    s_waitcnt lgkmcnt(6)
    v_mfma_f32_16x16x32_bf16 v[56:59], v[240:243], v[88:91], 0
    ds_read_b64_tr_b16 v[232:233], v4 offset:8192
    v_mfma_f32_16x16x32_bf16 v[60:63], v[240:243], v[92:95], 0
    ds_read_b64_tr_b16 v[234:235], v4 offset:9216
    s_waitcnt lgkmcnt(6)
    v_mfma_f32_16x16x32_bf16 v[64:67], v[244:247], v[88:91], 0
    ds_read_b64_tr_b16 v[236:237], v5 offset:8224
    v_mfma_f32_16x16x32_bf16 v[68:71], v[244:247], v[92:95], 0
    ds_read_b64_tr_b16 v[238:239], v5 offset:9248
    s_mov_b32 s23, 0x9000
    buffer_load_dwordx4 v[124:127], v7, s[8:11], s23 offen offset:0 sc1
    s_waitcnt lgkmcnt(6)
    v_mfma_f32_16x16x32_bf16 v[72:75], v[224:227], v[88:91], 0
    ds_read_b64_tr_b16 v[240:241], v4 offset:8448
    v_mfma_f32_16x16x32_bf16 v[76:79], v[224:227], v[92:95], 0
    ds_read_b64_tr_b16 v[242:243], v4 offset:9472
    s_waitcnt lgkmcnt(6)
    v_mfma_f32_16x16x32_bf16 v[80:83], v[228:231], v[88:91], 0
    ds_read_b64_tr_b16 v[244:245], v5 offset:8480
    v_mfma_f32_16x16x32_bf16 v[84:87], v[228:231], v[92:95], 0
    ds_read_b64_tr_b16 v[246:247], v5 offset:9504
    s_waitcnt vmcnt(7) lgkmcnt(6)
    v_mfma_f32_16x16x32_bf16 v[24:27], v[232:235], v[96:99], v[24:27]
    ds_read_b64_tr_b16 v[224:225], v4 offset:8704
    s_waitcnt vmcnt(6)
    v_mfma_f32_16x16x32_bf16 v[28:31], v[232:235], v[100:103], v[28:31]
    ds_read_b64_tr_b16 v[226:227], v4 offset:9728
    s_waitcnt lgkmcnt(6)
    v_mfma_f32_16x16x32_bf16 v[32:35], v[236:239], v[96:99], v[32:35]
    ds_read_b64_tr_b16 v[228:229], v5 offset:8736
    v_mfma_f32_16x16x32_bf16 v[36:39], v[236:239], v[100:103], v[36:39]
    ds_read_b64_tr_b16 v[230:231], v5 offset:9760
    s_mov_b32 s23, 0x1000
    buffer_load_dwordx4 v[128:131], v7, s[8:11], s23 offen offset:1024 sc1
    s_waitcnt lgkmcnt(6)
    v_mfma_f32_16x16x32_bf16 v[40:43], v[240:243], v[96:99], v[40:43]
    ds_read_b64_tr_b16 v[232:233], v4 offset:8960
    v_mfma_f32_16x16x32_bf16 v[44:47], v[240:243], v[100:103], v[44:47]
    ds_read_b64_tr_b16 v[234:235], v4 offset:9984
    s_waitcnt lgkmcnt(6)
    v_mfma_f32_16x16x32_bf16 v[48:51], v[244:247], v[96:99], v[48:51]
    ds_read_b64_tr_b16 v[236:237], v5 offset:8992
    v_mfma_f32_16x16x32_bf16 v[52:55], v[244:247], v[100:103], v[52:55]
    ds_read_b64_tr_b16 v[238:239], v5 offset:10016
    s_waitcnt lgkmcnt(6)
    v_mfma_f32_16x16x32_bf16 v[56:59], v[224:227], v[96:99], v[56:59]
    v_mfma_f32_16x16x32_bf16 v[60:63], v[224:227], v[100:103], v[60:63]
    s_barrier
    ds_read_b64_tr_b16 v[240:241], v4 offset:16384
    ds_read_b64_tr_b16 v[242:243], v4 offset:17408
    s_waitcnt lgkmcnt(6)
    v_mfma_f32_16x16x32_bf16 v[64:67], v[228:231], v[96:99], v[64:67]
    ds_read_b64_tr_b16 v[244:245], v5 offset:16416
    v_mfma_f32_16x16x32_bf16 v[68:71], v[228:231], v[100:103], v[68:71]
    s_add_u32 s22, s19, 0x180000
    s_add_u32 m0, s20, 0xc000
    s_nop 0
    buffer_load_dwordx4 v3, s[4:7], s22 offen lds
    ds_read_b64_tr_b16 v[246:247], v5 offset:17440
    s_mov_b32 s23, 0x9000
    buffer_load_dwordx4 v[132:135], v7, s[8:11], s23 offen offset:1024 sc1
    s_waitcnt lgkmcnt(6)
    v_mfma_f32_16x16x32_bf16 v[72:75], v[232:235], v[96:99], v[72:75]
    ds_read_b64_tr_b16 v[224:225], v4 offset:16640
    v_mfma_f32_16x16x32_bf16 v[76:79], v[232:235], v[100:103], v[76:79]
    ds_read_b64_tr_b16 v[226:227], v4 offset:17664
    s_waitcnt lgkmcnt(6)
    v_mfma_f32_16x16x32_bf16 v[80:83], v[236:239], v[96:99], v[80:83]
    ds_read_b64_tr_b16 v[228:229], v5 offset:16672
    v_mfma_f32_16x16x32_bf16 v[84:87], v[236:239], v[100:103], v[84:87]
    ds_read_b64_tr_b16 v[230:231], v5 offset:17696
    s_waitcnt vmcnt(8) lgkmcnt(6)
    v_mfma_f32_16x16x32_bf16 v[24:27], v[240:243], v[104:107], v[24:27]
    ds_read_b64_tr_b16 v[232:233], v4 offset:16896
    s_waitcnt vmcnt(7)
    v_mfma_f32_16x16x32_bf16 v[28:31], v[240:243], v[108:111], v[28:31]
    ds_read_b64_tr_b16 v[234:235], v4 offset:17920
    s_waitcnt lgkmcnt(6)
    v_mfma_f32_16x16x32_bf16 v[32:35], v[244:247], v[104:107], v[32:35]
    ds_read_b64_tr_b16 v[236:237], v5 offset:16928
    v_mfma_f32_16x16x32_bf16 v[36:39], v[244:247], v[108:111], v[36:39]
    s_add_u32 s22, s19, 0x188000
    s_add_u32 m0, s20, 0xc400
    s_nop 0
    buffer_load_dwordx4 v3, s[4:7], s22 offen lds
    ds_read_b64_tr_b16 v[238:239], v5 offset:17952
    s_mov_b32 s23, 0x1800
    buffer_load_dwordx4 v[88:91], v7, s[8:11], s23 offen offset:0 sc1
    s_waitcnt lgkmcnt(6)
    v_mfma_f32_16x16x32_bf16 v[40:43], v[224:227], v[104:107], v[40:43]
    ds_read_b64_tr_b16 v[240:241], v4 offset:17152
    v_mfma_f32_16x16x32_bf16 v[44:47], v[224:227], v[108:111], v[44:47]
    ds_read_b64_tr_b16 v[242:243], v4 offset:18176
    s_waitcnt lgkmcnt(6)
    v_mfma_f32_16x16x32_bf16 v[48:51], v[228:231], v[104:107], v[48:51]
    ds_read_b64_tr_b16 v[244:245], v5 offset:17184
    v_mfma_f32_16x16x32_bf16 v[52:55], v[228:231], v[108:111], v[52:55]
    ds_read_b64_tr_b16 v[246:247], v5 offset:18208
    s_waitcnt lgkmcnt(6)
    v_mfma_f32_16x16x32_bf16 v[56:59], v[232:235], v[104:107], v[56:59]
    ds_read_b64_tr_b16 v[224:225], v4 offset:24576
    v_mfma_f32_16x16x32_bf16 v[60:63], v[232:235], v[108:111], v[60:63]
    ds_read_b64_tr_b16 v[226:227], v4 offset:25600
    s_waitcnt lgkmcnt(6)
    v_mfma_f32_16x16x32_bf16 v[64:67], v[236:239], v[104:107], v[64:67]
    ds_read_b64_tr_b16 v[228:229], v5 offset:24608
    v_mfma_f32_16x16x32_bf16 v[68:71], v[236:239], v[108:111], v[68:71]
    ds_read_b64_tr_b16 v[230:231], v5 offset:25632
    s_mov_b32 s23, 0x9800
    buffer_load_dwordx4 v[92:95], v7, s[8:11], s23 offen offset:0 sc1
    s_waitcnt lgkmcnt(6)
    v_mfma_f32_16x16x32_bf16 v[72:75], v[240:243], v[104:107], v[72:75]
    ds_read_b64_tr_b16 v[232:233], v4 offset:24832
    v_mfma_f32_16x16x32_bf16 v[76:79], v[240:243], v[108:111], v[76:79]
    ds_read_b64_tr_b16 v[234:235], v4 offset:25856
    s_waitcnt lgkmcnt(6)
    v_mfma_f32_16x16x32_bf16 v[80:83], v[244:247], v[104:107], v[80:83]
    ds_read_b64_tr_b16 v[236:237], v5 offset:24864
    v_mfma_f32_16x16x32_bf16 v[84:87], v[244:247], v[108:111], v[84:87]
    ds_read_b64_tr_b16 v[238:239], v5 offset:25888
    s_waitcnt vmcnt(9) lgkmcnt(6)
    v_mfma_f32_16x16x32_bf16 v[24:27], v[224:227], v[112:115], v[24:27]
    ds_read_b64_tr_b16 v[240:241], v4 offset:25088
    s_waitcnt vmcnt(8)
    v_mfma_f32_16x16x32_bf16 v[28:31], v[224:227], v[116:119], v[28:31]
    ds_read_b64_tr_b16 v[242:243], v4 offset:26112
    s_waitcnt lgkmcnt(6)
    v_mfma_f32_16x16x32_bf16 v[32:35], v[228:231], v[112:115], v[32:35]
    ds_read_b64_tr_b16 v[244:245], v5 offset:25120
    v_mfma_f32_16x16x32_bf16 v[36:39], v[228:231], v[116:119], v[36:39]
    ds_read_b64_tr_b16 v[246:247], v5 offset:26144
    s_mov_b32 s23, 0x1800
    buffer_load_dwordx4 v[96:99], v7, s[8:11], s23 offen offset:1024 sc1
    s_waitcnt lgkmcnt(6)
    v_mfma_f32_16x16x32_bf16 v[40:43], v[232:235], v[112:115], v[40:43]
    ds_read_b64_tr_b16 v[224:225], v4 offset:25344
    v_mfma_f32_16x16x32_bf16 v[44:47], v[232:235], v[116:119], v[44:47]
    ds_read_b64_tr_b16 v[226:227], v4 offset:26368
    s_waitcnt lgkmcnt(6)
    v_mfma_f32_16x16x32_bf16 v[48:51], v[236:239], v[112:115], v[48:51]
    ds_read_b64_tr_b16 v[228:229], v5 offset:25376
    v_mfma_f32_16x16x32_bf16 v[52:55], v[236:239], v[116:119], v[52:55]
    ds_read_b64_tr_b16 v[230:231], v5 offset:26400
    s_waitcnt lgkmcnt(6)
    v_mfma_f32_16x16x32_bf16 v[56:59], v[240:243], v[112:115], v[56:59]
    v_mfma_f32_16x16x32_bf16 v[60:63], v[240:243], v[116:119], v[60:63]
    s_barrier
    ds_read_b64_tr_b16 v[232:233], v4 offset:32768
    ds_read_b64_tr_b16 v[234:235], v4 offset:33792
    s_waitcnt lgkmcnt(6)
    v_mfma_f32_16x16x32_bf16 v[64:67], v[244:247], v[112:115], v[64:67]
    ds_read_b64_tr_b16 v[236:237], v5 offset:32800
    v_mfma_f32_16x16x32_bf16 v[68:71], v[244:247], v[116:119], v[68:71]
    s_add_u32 s22, s19, 0x200000
    s_add_u32 m0, s20, 0x0
    s_nop 0
    buffer_load_dwordx4 v3, s[4:7], s22 offen lds
    ds_read_b64_tr_b16 v[238:239], v5 offset:33824
    s_mov_b32 s23, 0x9800
    buffer_load_dwordx4 v[100:103], v7, s[8:11], s23 offen offset:1024 sc1
    s_waitcnt lgkmcnt(6)
    v_mfma_f32_16x16x32_bf16 v[72:75], v[224:227], v[112:115], v[72:75]
    ds_read_b64_tr_b16 v[240:241], v4 offset:33024
    v_mfma_f32_16x16x32_bf16 v[76:79], v[224:227], v[116:119], v[76:79]
    ds_read_b64_tr_b16 v[242:243], v4 offset:34048
    s_waitcnt lgkmcnt(6)
    v_mfma_f32_16x16x32_bf16 v[80:83], v[228:231], v[112:115], v[80:83]
    ds_read_b64_tr_b16 v[244:245], v5 offset:33056
    v_mfma_f32_16x16x32_bf16 v[84:87], v[228:231], v[116:119], v[84:87]
    ds_read_b64_tr_b16 v[246:247], v5 offset:34080
    s_waitcnt vmcnt(10) lgkmcnt(6)
    v_mfma_f32_16x16x32_bf16 v[24:27], v[232:235], v[120:123], v[24:27]
    ds_read_b64_tr_b16 v[224:225], v4 offset:33280
    s_waitcnt vmcnt(9)
    v_mfma_f32_16x16x32_bf16 v[28:31], v[232:235], v[124:127], v[28:31]
    ds_read_b64_tr_b16 v[226:227], v4 offset:34304
    s_waitcnt lgkmcnt(6)
    v_mfma_f32_16x16x32_bf16 v[32:35], v[236:239], v[120:123], v[32:35]
    ds_read_b64_tr_b16 v[228:229], v5 offset:33312
    v_mfma_f32_16x16x32_bf16 v[36:39], v[236:239], v[124:127], v[36:39]
    s_add_u32 s22, s19, 0x208000
    s_add_u32 m0, s20, 0x400
    s_nop 0
    buffer_load_dwordx4 v3, s[4:7], s22 offen lds
    ds_read_b64_tr_b16 v[230:231], v5 offset:34336
    s_mov_b32 s23, 0x2000
    buffer_load_dwordx4 v[104:107], v7, s[8:11], s23 offen offset:0 sc1
    s_waitcnt lgkmcnt(6)
    v_mfma_f32_16x16x32_bf16 v[40:43], v[240:243], v[120:123], v[40:43]
    ds_read_b64_tr_b16 v[232:233], v4 offset:33536
    v_mfma_f32_16x16x32_bf16 v[44:47], v[240:243], v[124:127], v[44:47]
    ds_read_b64_tr_b16 v[234:235], v4 offset:34560
    s_waitcnt lgkmcnt(6)
    v_mfma_f32_16x16x32_bf16 v[48:51], v[244:247], v[120:123], v[48:51]
    ds_read_b64_tr_b16 v[236:237], v5 offset:33568
    v_mfma_f32_16x16x32_bf16 v[52:55], v[244:247], v[124:127], v[52:55]
    ds_read_b64_tr_b16 v[238:239], v5 offset:34592
    s_waitcnt lgkmcnt(6)
    v_mfma_f32_16x16x32_bf16 v[56:59], v[224:227], v[120:123], v[56:59]
    ds_read_b64_tr_b16 v[240:241], v4 offset:40960
    v_mfma_f32_16x16x32_bf16 v[60:63], v[224:227], v[124:127], v[60:63]
    ds_read_b64_tr_b16 v[242:243], v4 offset:41984
    s_waitcnt lgkmcnt(6)
    v_mfma_f32_16x16x32_bf16 v[64:67], v[228:231], v[120:123], v[64:67]
    ds_read_b64_tr_b16 v[244:245], v5 offset:40992
    v_mfma_f32_16x16x32_bf16 v[68:71], v[228:231], v[124:127], v[68:71]
    ds_read_b64_tr_b16 v[246:247], v5 offset:42016
    s_mov_b32 s23, 0xa000
    buffer_load_dwordx4 v[108:111], v7, s[8:11], s23 offen offset:0 sc1
    s_waitcnt lgkmcnt(6)
    v_mfma_f32_16x16x32_bf16 v[72:75], v[232:235], v[120:123], v[72:75]
    ds_read_b64_tr_b16 v[224:225], v4 offset:41216
    v_mfma_f32_16x16x32_bf16 v[76:79], v[232:235], v[124:127], v[76:79]
    ds_read_b64_tr_b16 v[226:227], v4 offset:42240
    s_waitcnt lgkmcnt(6)
    v_mfma_f32_16x16x32_bf16 v[80:83], v[236:239], v[120:123], v[80:83]
    ds_read_b64_tr_b16 v[228:229], v5 offset:41248
    v_mfma_f32_16x16x32_bf16 v[84:87], v[236:239], v[124:127], v[84:87]
    ds_read_b64_tr_b16 v[230:231], v5 offset:42272
    s_waitcnt vmcnt(11) lgkmcnt(6)
    v_mfma_f32_16x16x32_bf16 v[24:27], v[240:243], v[128:131], v[24:27]
    ds_read_b64_tr_b16 v[232:233], v4 offset:41472
    s_waitcnt vmcnt(9)
    v_mfma_f32_16x16x32_bf16 v[28:31], v[240:243], v[132:135], v[28:31]
    ds_read_b64_tr_b16 v[234:235], v4 offset:42496
    s_waitcnt lgkmcnt(6)
    v_mfma_f32_16x16x32_bf16 v[32:35], v[244:247], v[128:131], v[32:35]
    ds_read_b64_tr_b16 v[236:237], v5 offset:41504
    v_mfma_f32_16x16x32_bf16 v[36:39], v[244:247], v[132:135], v[36:39]
    ds_read_b64_tr_b16 v[238:239], v5 offset:42528
    s_mov_b32 s23, 0x2000
    buffer_load_dwordx4 v[112:115], v7, s[8:11], s23 offen offset:1024 sc1
    s_waitcnt lgkmcnt(6)
    v_mfma_f32_16x16x32_bf16 v[40:43], v[224:227], v[128:131], v[40:43]
    ds_read_b64_tr_b16 v[240:241], v4 offset:41728
    v_mfma_f32_16x16x32_bf16 v[44:47], v[224:227], v[132:135], v[44:47]
    ds_read_b64_tr_b16 v[242:243], v4 offset:42752
    s_waitcnt lgkmcnt(6)
    v_mfma_f32_16x16x32_bf16 v[48:51], v[228:231], v[128:131], v[48:51]
    ds_read_b64_tr_b16 v[244:245], v5 offset:41760
    v_mfma_f32_16x16x32_bf16 v[52:55], v[228:231], v[132:135], v[52:55]
    ds_read_b64_tr_b16 v[246:247], v5 offset:42784
    s_waitcnt lgkmcnt(6)
    v_mfma_f32_16x16x32_bf16 v[56:59], v[232:235], v[128:131], v[56:59]
    v_mfma_f32_16x16x32_bf16 v[60:63], v[232:235], v[132:135], v[60:63]
    s_waitcnt vmcnt(9)
    s_barrier
    ds_read_b64_tr_b16 v[224:225], v4 offset:49152
    ds_read_b64_tr_b16 v[226:227], v4 offset:50176
    s_waitcnt lgkmcnt(6)
    v_mfma_f32_16x16x32_bf16 v[64:67], v[236:239], v[128:131], v[64:67]
    ds_read_b64_tr_b16 v[228:229], v5 offset:49184
    v_mfma_f32_16x16x32_bf16 v[68:71], v[236:239], v[132:135], v[68:71]
    s_add_u32 s22, s19, 0x280000
    s_add_u32 m0, s20, 0x4000
    s_nop 0
    buffer_load_dwordx4 v3, s[4:7], s22 offen lds
    ds_read_b64_tr_b16 v[230:231], v5 offset:50208
    s_mov_b32 s23, 0xa000
    buffer_load_dwordx4 v[116:119], v7, s[8:11], s23 offen offset:1024 sc1
    s_waitcnt lgkmcnt(6)
    v_mfma_f32_16x16x32_bf16 v[72:75], v[240:243], v[128:131], v[72:75]
    ds_read_b64_tr_b16 v[232:233], v4 offset:49408
    v_mfma_f32_16x16x32_bf16 v[76:79], v[240:243], v[132:135], v[76:79]
    ds_read_b64_tr_b16 v[234:235], v4 offset:50432
    s_waitcnt lgkmcnt(6)
    v_mfma_f32_16x16x32_bf16 v[80:83], v[244:247], v[128:131], v[80:83]
    ds_read_b64_tr_b16 v[236:237], v5 offset:49440
    v_mfma_f32_16x16x32_bf16 v[84:87], v[244:247], v[132:135], v[84:87]
    ds_read_b64_tr_b16 v[238:239], v5 offset:50464
    s_waitcnt vmcnt(10) lgkmcnt(6)
    v_mfma_f32_16x16x32_bf16 v[24:27], v[224:227], v[88:91], v[24:27]
    ds_read_b64_tr_b16 v[240:241], v4 offset:49664
    s_waitcnt vmcnt(9)
    v_mfma_f32_16x16x32_bf16 v[28:31], v[224:227], v[92:95], v[28:31]
    ds_read_b64_tr_b16 v[242:243], v4 offset:50688
    s_waitcnt lgkmcnt(6)
    v_mfma_f32_16x16x32_bf16 v[32:35], v[228:231], v[88:91], v[32:35]
    ds_read_b64_tr_b16 v[244:245], v5 offset:49696
    v_mfma_f32_16x16x32_bf16 v[36:39], v[228:231], v[92:95], v[36:39]
    s_add_u32 s22, s19, 0x288000
    s_add_u32 m0, s20, 0x4400
    s_nop 0
    buffer_load_dwordx4 v3, s[4:7], s22 offen lds
    ds_read_b64_tr_b16 v[246:247], v5 offset:50720
    s_mov_b32 s23, 0x2800
    buffer_load_dwordx4 v[120:123], v7, s[8:11], s23 offen offset:0 sc1
    s_waitcnt lgkmcnt(6)
    v_mfma_f32_16x16x32_bf16 v[40:43], v[232:235], v[88:91], v[40:43]
    ds_read_b64_tr_b16 v[224:225], v4 offset:49920
    v_mfma_f32_16x16x32_bf16 v[44:47], v[232:235], v[92:95], v[44:47]
    ds_read_b64_tr_b16 v[226:227], v4 offset:50944
    s_waitcnt lgkmcnt(6)
    v_mfma_f32_16x16x32_bf16 v[48:51], v[236:239], v[88:91], v[48:51]
    ds_read_b64_tr_b16 v[228:229], v5 offset:49952
    v_mfma_f32_16x16x32_bf16 v[52:55], v[236:239], v[92:95], v[52:55]
    ds_read_b64_tr_b16 v[230:231], v5 offset:50976
    s_waitcnt lgkmcnt(6)
    v_mfma_f32_16x16x32_bf16 v[56:59], v[240:243], v[88:91], v[56:59]
    ds_read_b64_tr_b16 v[232:233], v4 offset:57344
    v_mfma_f32_16x16x32_bf16 v[60:63], v[240:243], v[92:95], v[60:63]
    ds_read_b64_tr_b16 v[234:235], v4 offset:58368
    s_waitcnt lgkmcnt(6)
    v_mfma_f32_16x16x32_bf16 v[64:67], v[244:247], v[88:91], v[64:67]
    ds_read_b64_tr_b16 v[236:237], v5 offset:57376
    v_mfma_f32_16x16x32_bf16 v[68:71], v[244:247], v[92:95], v[68:71]
    ds_read_b64_tr_b16 v[238:239], v5 offset:58400
    s_mov_b32 s23, 0xa800
    buffer_load_dwordx4 v[124:127], v7, s[8:11], s23 offen offset:0 sc1
    s_waitcnt lgkmcnt(6)
    v_mfma_f32_16x16x32_bf16 v[72:75], v[224:227], v[88:91], v[72:75]
    ds_read_b64_tr_b16 v[240:241], v4 offset:57600
    v_mfma_f32_16x16x32_bf16 v[76:79], v[224:227], v[92:95], v[76:79]
    ds_read_b64_tr_b16 v[242:243], v4 offset:58624
    s_waitcnt lgkmcnt(6)
    v_mfma_f32_16x16x32_bf16 v[80:83], v[228:231], v[88:91], v[80:83]
    ds_read_b64_tr_b16 v[244:245], v5 offset:57632
    v_mfma_f32_16x16x32_bf16 v[84:87], v[228:231], v[92:95], v[84:87]
    ds_read_b64_tr_b16 v[246:247], v5 offset:58656
    s_waitcnt vmcnt(11) lgkmcnt(6)
    v_mfma_f32_16x16x32_bf16 v[24:27], v[232:235], v[96:99], v[24:27]
    ds_read_b64_tr_b16 v[224:225], v4 offset:57856
    s_waitcnt vmcnt(9)
    v_mfma_f32_16x16x32_bf16 v[28:31], v[232:235], v[100:103], v[28:31]
    ds_read_b64_tr_b16 v[226:227], v4 offset:58880
    s_waitcnt lgkmcnt(6)
    v_mfma_f32_16x16x32_bf16 v[32:35], v[236:239], v[96:99], v[32:35]
    ds_read_b64_tr_b16 v[228:229], v5 offset:57888
    v_mfma_f32_16x16x32_bf16 v[36:39], v[236:239], v[100:103], v[36:39]
    ds_read_b64_tr_b16 v[230:231], v5 offset:58912
    s_mov_b32 s23, 0x2800
    buffer_load_dwordx4 v[128:131], v7, s[8:11], s23 offen offset:1024 sc1
    s_waitcnt lgkmcnt(6)
    v_mfma_f32_16x16x32_bf16 v[40:43], v[240:243], v[96:99], v[40:43]
    ds_read_b64_tr_b16 v[232:233], v4 offset:58112
    v_mfma_f32_16x16x32_bf16 v[44:47], v[240:243], v[100:103], v[44:47]
    ds_read_b64_tr_b16 v[234:235], v4 offset:59136
    s_waitcnt lgkmcnt(6)
    v_mfma_f32_16x16x32_bf16 v[48:51], v[244:247], v[96:99], v[48:51]
    ds_read_b64_tr_b16 v[236:237], v5 offset:58144
    v_mfma_f32_16x16x32_bf16 v[52:55], v[244:247], v[100:103], v[52:55]
    ds_read_b64_tr_b16 v[238:239], v5 offset:59168
    s_waitcnt lgkmcnt(6)
    v_mfma_f32_16x16x32_bf16 v[56:59], v[224:227], v[96:99], v[56:59]
    v_mfma_f32_16x16x32_bf16 v[60:63], v[224:227], v[100:103], v[60:63]
    s_waitcnt vmcnt(9)
    s_barrier
    ds_read_b64_tr_b16 v[240:241], v4 offset:0
    ds_read_b64_tr_b16 v[242:243], v4 offset:1024
    s_waitcnt lgkmcnt(6)
    v_mfma_f32_16x16x32_bf16 v[64:67], v[228:231], v[96:99], v[64:67]
    ds_read_b64_tr_b16 v[244:245], v5 offset:32
    v_mfma_f32_16x16x32_bf16 v[68:71], v[228:231], v[100:103], v[68:71]
    s_add_u32 s22, s19, 0x300000
    s_add_u32 m0, s20, 0x8000
    s_nop 0
    buffer_load_dwordx4 v3, s[4:7], s22 offen lds
    ds_read_b64_tr_b16 v[246:247], v5 offset:1056
    s_mov_b32 s23, 0xa800
    buffer_load_dwordx4 v[132:135], v7, s[8:11], s23 offen offset:1024 sc1
    s_waitcnt lgkmcnt(6)
    v_mfma_f32_16x16x32_bf16 v[72:75], v[232:235], v[96:99], v[72:75]
    ds_read_b64_tr_b16 v[224:225], v4 offset:256
    v_mfma_f32_16x16x32_bf16 v[76:79], v[232:235], v[100:103], v[76:79]
    ds_read_b64_tr_b16 v[226:227], v4 offset:1280
    s_waitcnt lgkmcnt(6)
    v_mfma_f32_16x16x32_bf16 v[80:83], v[236:239], v[96:99], v[80:83]
    ds_read_b64_tr_b16 v[228:229], v5 offset:288
    v_mfma_f32_16x16x32_bf16 v[84:87], v[236:239], v[100:103], v[84:87]
    ds_read_b64_tr_b16 v[230:231], v5 offset:1312
    s_waitcnt vmcnt(10) lgkmcnt(6)
    v_mfma_f32_16x16x32_bf16 v[24:27], v[240:243], v[104:107], v[24:27]
    ds_read_b64_tr_b16 v[232:233], v4 offset:512
    s_waitcnt vmcnt(9)
    v_mfma_f32_16x16x32_bf16 v[28:31], v[240:243], v[108:111], v[28:31]
    ds_read_b64_tr_b16 v[234:235], v4 offset:1536
    s_waitcnt lgkmcnt(6)
    v_mfma_f32_16x16x32_bf16 v[32:35], v[244:247], v[104:107], v[32:35]
    ds_read_b64_tr_b16 v[236:237], v5 offset:544
    v_mfma_f32_16x16x32_bf16 v[36:39], v[244:247], v[108:111], v[36:39]
    s_add_u32 s22, s19, 0x308000
    s_add_u32 m0, s20, 0x8400
    s_nop 0
    buffer_load_dwordx4 v3, s[4:7], s22 offen lds
    ds_read_b64_tr_b16 v[238:239], v5 offset:1568
    s_mov_b32 s23, 0x3000
    buffer_load_dwordx4 v[88:91], v7, s[8:11], s23 offen offset:0 sc1
    s_waitcnt lgkmcnt(6)
    v_mfma_f32_16x16x32_bf16 v[40:43], v[224:227], v[104:107], v[40:43]
    ds_read_b64_tr_b16 v[240:241], v4 offset:768
    v_mfma_f32_16x16x32_bf16 v[44:47], v[224:227], v[108:111], v[44:47]
    ds_read_b64_tr_b16 v[242:243], v4 offset:1792
    s_waitcnt lgkmcnt(6)
    v_mfma_f32_16x16x32_bf16 v[48:51], v[228:231], v[104:107], v[48:51]
    ds_read_b64_tr_b16 v[244:245], v5 offset:800
    v_mfma_f32_16x16x32_bf16 v[52:55], v[228:231], v[108:111], v[52:55]
    ds_read_b64_tr_b16 v[246:247], v5 offset:1824
    s_waitcnt lgkmcnt(6)
    v_mfma_f32_16x16x32_bf16 v[56:59], v[232:235], v[104:107], v[56:59]
    ds_read_b64_tr_b16 v[224:225], v4 offset:8192
    v_mfma_f32_16x16x32_bf16 v[60:63], v[232:235], v[108:111], v[60:63]
    ds_read_b64_tr_b16 v[226:227], v4 offset:9216
    s_waitcnt lgkmcnt(6)
    v_mfma_f32_16x16x32_bf16 v[64:67], v[236:239], v[104:107], v[64:67]
    ds_read_b64_tr_b16 v[228:229], v5 offset:8224
    v_mfma_f32_16x16x32_bf16 v[68:71], v[236:239], v[108:111], v[68:71]
    ds_read_b64_tr_b16 v[230:231], v5 offset:9248
    s_mov_b32 s23, 0xb000
    buffer_load_dwordx4 v[92:95], v7, s[8:11], s23 offen offset:0 sc1
    s_waitcnt lgkmcnt(6)
    v_mfma_f32_16x16x32_bf16 v[72:75], v[240:243], v[104:107], v[72:75]
    ds_read_b64_tr_b16 v[232:233], v4 offset:8448
    v_mfma_f32_16x16x32_bf16 v[76:79], v[240:243], v[108:111], v[76:79]
    ds_read_b64_tr_b16 v[234:235], v4 offset:9472
    s_waitcnt lgkmcnt(6)
    v_mfma_f32_16x16x32_bf16 v[80:83], v[244:247], v[104:107], v[80:83]
    ds_read_b64_tr_b16 v[236:237], v5 offset:8480
    v_mfma_f32_16x16x32_bf16 v[84:87], v[244:247], v[108:111], v[84:87]
    ds_read_b64_tr_b16 v[238:239], v5 offset:9504
    s_waitcnt vmcnt(11) lgkmcnt(6)
    v_mfma_f32_16x16x32_bf16 v[24:27], v[224:227], v[112:115], v[24:27]
    ds_read_b64_tr_b16 v[240:241], v4 offset:8704
    s_waitcnt vmcnt(9)
    v_mfma_f32_16x16x32_bf16 v[28:31], v[224:227], v[116:119], v[28:31]
    ds_read_b64_tr_b16 v[242:243], v4 offset:9728
    s_waitcnt lgkmcnt(6)
    v_mfma_f32_16x16x32_bf16 v[32:35], v[228:231], v[112:115], v[32:35]
    ds_read_b64_tr_b16 v[244:245], v5 offset:8736
    v_mfma_f32_16x16x32_bf16 v[36:39], v[228:231], v[116:119], v[36:39]
    ds_read_b64_tr_b16 v[246:247], v5 offset:9760
    s_mov_b32 s23, 0x3000
    buffer_load_dwordx4 v[96:99], v7, s[8:11], s23 offen offset:1024 sc1
    s_waitcnt lgkmcnt(6)
    v_mfma_f32_16x16x32_bf16 v[40:43], v[232:235], v[112:115], v[40:43]
    ds_read_b64_tr_b16 v[224:225], v4 offset:8960
    v_mfma_f32_16x16x32_bf16 v[44:47], v[232:235], v[116:119], v[44:47]
    ds_read_b64_tr_b16 v[226:227], v4 offset:9984
    s_waitcnt lgkmcnt(6)
    v_mfma_f32_16x16x32_bf16 v[48:51], v[236:239], v[112:115], v[48:51]
    ds_read_b64_tr_b16 v[228:229], v5 offset:8992
    v_mfma_f32_16x16x32_bf16 v[52:55], v[236:239], v[116:119], v[52:55]
    ds_read_b64_tr_b16 v[230:231], v5 offset:10016
    s_waitcnt lgkmcnt(6)
    v_mfma_f32_16x16x32_bf16 v[56:59], v[240:243], v[112:115], v[56:59]
    v_mfma_f32_16x16x32_bf16 v[60:63], v[240:243], v[116:119], v[60:63]
    s_waitcnt vmcnt(9)
    s_barrier
    ds_read_b64_tr_b16 v[232:233], v4 offset:16384
    ds_read_b64_tr_b16 v[234:235], v4 offset:17408
    s_waitcnt lgkmcnt(6)
    v_mfma_f32_16x16x32_bf16 v[64:67], v[244:247], v[112:115], v[64:67]
    ds_read_b64_tr_b16 v[236:237], v5 offset:16416
    v_mfma_f32_16x16x32_bf16 v[68:71], v[244:247], v[116:119], v[68:71]
    s_add_u32 s22, s19, 0x380000
    s_add_u32 m0, s20, 0xc000
    s_nop 0
    buffer_load_dwordx4 v3, s[4:7], s22 offen lds
    ds_read_b64_tr_b16 v[238:239], v5 offset:17440
    s_mov_b32 s23, 0xb000
    buffer_load_dwordx4 v[100:103], v7, s[8:11], s23 offen offset:1024 sc1
    s_waitcnt lgkmcnt(6)
    v_mfma_f32_16x16x32_bf16 v[72:75], v[224:227], v[112:115], v[72:75]
    ds_read_b64_tr_b16 v[240:241], v4 offset:16640
    v_mfma_f32_16x16x32_bf16 v[76:79], v[224:227], v[116:119], v[76:79]
    ds_read_b64_tr_b16 v[242:243], v4 offset:17664
    s_waitcnt lgkmcnt(6)
    v_mfma_f32_16x16x32_bf16 v[80:83], v[228:231], v[112:115], v[80:83]
    ds_read_b64_tr_b16 v[244:245], v5 offset:16672
    v_mfma_f32_16x16x32_bf16 v[84:87], v[228:231], v[116:119], v[84:87]
    ds_read_b64_tr_b16 v[246:247], v5 offset:17696
    s_waitcnt vmcnt(10) lgkmcnt(6)
    v_mfma_f32_16x16x32_bf16 v[24:27], v[232:235], v[120:123], v[24:27]
    ds_read_b64_tr_b16 v[224:225], v4 offset:16896
    s_waitcnt vmcnt(9)
    v_mfma_f32_16x16x32_bf16 v[28:31], v[232:235], v[124:127], v[28:31]
    ds_read_b64_tr_b16 v[226:227], v4 offset:17920
    s_waitcnt lgkmcnt(6)
    v_mfma_f32_16x16x32_bf16 v[32:35], v[236:239], v[120:123], v[32:35]
    ds_read_b64_tr_b16 v[228:229], v5 offset:16928
    v_mfma_f32_16x16x32_bf16 v[36:39], v[236:239], v[124:127], v[36:39]
    s_add_u32 s22, s19, 0x388000
    s_add_u32 m0, s20, 0xc400
    s_nop 0
    buffer_load_dwordx4 v3, s[4:7], s22 offen lds
    ds_read_b64_tr_b16 v[230:231], v5 offset:17952
    s_mov_b32 s23, 0x3800
    buffer_load_dwordx4 v[104:107], v7, s[8:11], s23 offen offset:0 sc1
    s_waitcnt lgkmcnt(6)
    v_mfma_f32_16x16x32_bf16 v[40:43], v[240:243], v[120:123], v[40:43]
    ds_read_b64_tr_b16 v[232:233], v4 offset:17152
    v_mfma_f32_16x16x32_bf16 v[44:47], v[240:243], v[124:127], v[44:47]
    ds_read_b64_tr_b16 v[234:235], v4 offset:18176
    s_waitcnt lgkmcnt(6)
    v_mfma_f32_16x16x32_bf16 v[48:51], v[244:247], v[120:123], v[48:51]
    ds_read_b64_tr_b16 v[236:237], v5 offset:17184
    v_mfma_f32_16x16x32_bf16 v[52:55], v[244:247], v[124:127], v[52:55]
    ds_read_b64_tr_b16 v[238:239], v5 offset:18208
    s_waitcnt lgkmcnt(6)
    v_mfma_f32_16x16x32_bf16 v[56:59], v[224:227], v[120:123], v[56:59]
    ds_read_b64_tr_b16 v[240:241], v4 offset:24576
    v_mfma_f32_16x16x32_bf16 v[60:63], v[224:227], v[124:127], v[60:63]
    ds_read_b64_tr_b16 v[242:243], v4 offset:25600
    s_waitcnt lgkmcnt(6)
    v_mfma_f32_16x16x32_bf16 v[64:67], v[228:231], v[120:123], v[64:67]
    ds_read_b64_tr_b16 v[244:245], v5 offset:24608
    v_mfma_f32_16x16x32_bf16 v[68:71], v[228:231], v[124:127], v[68:71]
    ds_read_b64_tr_b16 v[246:247], v5 offset:25632
    s_mov_b32 s23, 0xb800
    buffer_load_dwordx4 v[108:111], v7, s[8:11], s23 offen offset:0 sc1
    s_waitcnt lgkmcnt(6)
    v_mfma_f32_16x16x32_bf16 v[72:75], v[232:235], v[120:123], v[72:75]
    ds_read_b64_tr_b16 v[224:225], v4 offset:24832
    v_mfma_f32_16x16x32_bf16 v[76:79], v[232:235], v[124:127], v[76:79]
    ds_read_b64_tr_b16 v[226:227], v4 offset:25856
    s_waitcnt lgkmcnt(6)
    v_mfma_f32_16x16x32_bf16 v[80:83], v[236:239], v[120:123], v[80:83]
    ds_read_b64_tr_b16 v[228:229], v5 offset:24864
    v_mfma_f32_16x16x32_bf16 v[84:87], v[236:239], v[124:127], v[84:87]
    ds_read_b64_tr_b16 v[230:231], v5 offset:25888
    s_waitcnt vmcnt(11) lgkmcnt(6)
    v_mfma_f32_16x16x32_bf16 v[24:27], v[240:243], v[128:131], v[24:27]
    ds_read_b64_tr_b16 v[232:233], v4 offset:25088
    s_waitcnt vmcnt(9)
    v_mfma_f32_16x16x32_bf16 v[28:31], v[240:243], v[132:135], v[28:31]
    ds_read_b64_tr_b16 v[234:235], v4 offset:26112
    s_waitcnt lgkmcnt(6)
    v_mfma_f32_16x16x32_bf16 v[32:35], v[244:247], v[128:131], v[32:35]
    ds_read_b64_tr_b16 v[236:237], v5 offset:25120
    v_mfma_f32_16x16x32_bf16 v[36:39], v[244:247], v[132:135], v[36:39]
    ds_read_b64_tr_b16 v[238:239], v5 offset:26144
    s_mov_b32 s23, 0x3800
    buffer_load_dwordx4 v[112:115], v7, s[8:11], s23 offen offset:1024 sc1
    s_waitcnt lgkmcnt(6)
    v_mfma_f32_16x16x32_bf16 v[40:43], v[224:227], v[128:131], v[40:43]
    ds_read_b64_tr_b16 v[240:241], v4 offset:25344
    v_mfma_f32_16x16x32_bf16 v[44:47], v[224:227], v[132:135], v[44:47]
    ds_read_b64_tr_b16 v[242:243], v4 offset:26368
    s_waitcnt lgkmcnt(6)
    v_mfma_f32_16x16x32_bf16 v[48:51], v[228:231], v[128:131], v[48:51]
    ds_read_b64_tr_b16 v[244:245], v5 offset:25376
    v_mfma_f32_16x16x32_bf16 v[52:55], v[228:231], v[132:135], v[52:55]
    ds_read_b64_tr_b16 v[246:247], v5 offset:26400
    s_waitcnt lgkmcnt(6)
    v_mfma_f32_16x16x32_bf16 v[56:59], v[232:235], v[128:131], v[56:59]
    v_mfma_f32_16x16x32_bf16 v[60:63], v[232:235], v[132:135], v[60:63]
    s_waitcnt vmcnt(9)
    s_barrier
    ds_read_b64_tr_b16 v[224:225], v4 offset:32768
    ds_read_b64_tr_b16 v[226:227], v4 offset:33792
    s_waitcnt lgkmcnt(6)
    v_mfma_f32_16x16x32_bf16 v[64:67], v[236:239], v[128:131], v[64:67]
    ds_read_b64_tr_b16 v[228:229], v5 offset:32800
    v_mfma_f32_16x16x32_bf16 v[68:71], v[236:239], v[132:135], v[68:71]
    s_add_u32 s22, s19, 0x400000
    s_add_u32 m0, s20, 0x0
    s_nop 0
    buffer_load_dwordx4 v3, s[4:7], s22 offen lds
    ds_read_b64_tr_b16 v[230:231], v5 offset:33824
    s_mov_b32 s23, 0xb800
    buffer_load_dwordx4 v[116:119], v7, s[8:11], s23 offen offset:1024 sc1
    s_waitcnt lgkmcnt(6)
    v_mfma_f32_16x16x32_bf16 v[72:75], v[240:243], v[128:131], v[72:75]
    ds_read_b64_tr_b16 v[232:233], v4 offset:33024
    v_mfma_f32_16x16x32_bf16 v[76:79], v[240:243], v[132:135], v[76:79]
    ds_read_b64_tr_b16 v[234:235], v4 offset:34048
    s_waitcnt lgkmcnt(6)
    v_mfma_f32_16x16x32_bf16 v[80:83], v[244:247], v[128:131], v[80:83]
    ds_read_b64_tr_b16 v[236:237], v5 offset:33056
    v_mfma_f32_16x16x32_bf16 v[84:87], v[244:247], v[132:135], v[84:87]
    ds_read_b64_tr_b16 v[238:239], v5 offset:34080
    s_waitcnt vmcnt(10) lgkmcnt(6)
    v_mfma_f32_16x16x32_bf16 v[24:27], v[224:227], v[88:91], v[24:27]
    ds_read_b64_tr_b16 v[240:241], v4 offset:33280
    s_waitcnt vmcnt(9)
    v_mfma_f32_16x16x32_bf16 v[28:31], v[224:227], v[92:95], v[28:31]
    ds_read_b64_tr_b16 v[242:243], v4 offset:34304
    s_waitcnt lgkmcnt(6)
    v_mfma_f32_16x16x32_bf16 v[32:35], v[228:231], v[88:91], v[32:35]
    ds_read_b64_tr_b16 v[244:245], v5 offset:33312
    v_mfma_f32_16x16x32_bf16 v[36:39], v[228:231], v[92:95], v[36:39]
    s_add_u32 s22, s19, 0x408000
    s_add_u32 m0, s20, 0x400
    s_nop 0
    buffer_load_dwordx4 v3, s[4:7], s22 offen lds
    ds_read_b64_tr_b16 v[246:247], v5 offset:34336
    s_mov_b32 s23, 0x4000
    buffer_load_dwordx4 v[120:123], v7, s[8:11], s23 offen offset:0 sc1
    s_waitcnt lgkmcnt(6)
    v_mfma_f32_16x16x32_bf16 v[40:43], v[232:235], v[88:91], v[40:43]
    ds_read_b64_tr_b16 v[224:225], v4 offset:33536
    v_mfma_f32_16x16x32_bf16 v[44:47], v[232:235], v[92:95], v[44:47]
    ds_read_b64_tr_b16 v[226:227], v4 offset:34560
    s_waitcnt lgkmcnt(6)
    v_mfma_f32_16x16x32_bf16 v[48:51], v[236:239], v[88:91], v[48:51]
    ds_read_b64_tr_b16 v[228:229], v5 offset:33568
    v_mfma_f32_16x16x32_bf16 v[52:55], v[236:239], v[92:95], v[52:55]
    ds_read_b64_tr_b16 v[230:231], v5 offset:34592
    s_waitcnt lgkmcnt(6)
    v_mfma_f32_16x16x32_bf16 v[56:59], v[240:243], v[88:91], v[56:59]
    ds_read_b64_tr_b16 v[232:233], v4 offset:40960
    v_mfma_f32_16x16x32_bf16 v[60:63], v[240:243], v[92:95], v[60:63]
    ds_read_b64_tr_b16 v[234:235], v4 offset:41984
    s_waitcnt lgkmcnt(6)
    v_mfma_f32_16x16x32_bf16 v[64:67], v[244:247], v[88:91], v[64:67]
    ds_read_b64_tr_b16 v[236:237], v5 offset:40992
    v_mfma_f32_16x16x32_bf16 v[68:71], v[244:247], v[92:95], v[68:71]
    ds_read_b64_tr_b16 v[238:239], v5 offset:42016
    s_mov_b32 s23, 0xc000
    buffer_load_dwordx4 v[124:127], v7, s[8:11], s23 offen offset:0 sc1
    s_waitcnt lgkmcnt(6)
    v_mfma_f32_16x16x32_bf16 v[72:75], v[224:227], v[88:91], v[72:75]
    ds_read_b64_tr_b16 v[240:241], v4 offset:41216
    v_lshrrev_b32 v21, 4, v1
    v_lshlrev_b32 v21, 9, v21
    v_and_b32 v20, 15, v1
    v_lshl_add_u32 v21, v20, 4, v21
    s_lshr_b32 s18, s12, 3
    s_lshl_b32 s18, s18, 11
    s_add_u32 s18, s18, 0x528100
    buffer_load_dwordx4 v[12:15], v21, s[8:11], s18 offen sc1
    v_mfma_f32_16x16x32_bf16 v[76:79], v[224:227], v[92:95], v[76:79]
    ds_read_b64_tr_b16 v[242:243], v4 offset:42240
    s_waitcnt lgkmcnt(6)
    v_mfma_f32_16x16x32_bf16 v[80:83], v[228:231], v[88:91], v[80:83]
    ds_read_b64_tr_b16 v[244:245], v5 offset:41248
    v_mfma_f32_16x16x32_bf16 v[84:87], v[228:231], v[92:95], v[84:87]
    ds_read_b64_tr_b16 v[246:247], v5 offset:42272
    s_waitcnt vmcnt(12) lgkmcnt(6)
    v_mfma_f32_16x16x32_bf16 v[24:27], v[232:235], v[96:99], v[24:27]
    ds_read_b64_tr_b16 v[224:225], v4 offset:41472
    s_waitcnt vmcnt(10)
    v_mfma_f32_16x16x32_bf16 v[28:31], v[232:235], v[100:103], v[28:31]
    ds_read_b64_tr_b16 v[226:227], v4 offset:42496
    s_waitcnt lgkmcnt(6)
    v_mfma_f32_16x16x32_bf16 v[32:35], v[236:239], v[96:99], v[32:35]
    ds_read_b64_tr_b16 v[228:229], v5 offset:41504
    v_mfma_f32_16x16x32_bf16 v[36:39], v[236:239], v[100:103], v[36:39]
    ds_read_b64_tr_b16 v[230:231], v5 offset:42528
    s_mov_b32 s23, 0x4000
    buffer_load_dwordx4 v[128:131], v7, s[8:11], s23 offen offset:1024 sc1
    s_waitcnt lgkmcnt(6)
    v_mfma_f32_16x16x32_bf16 v[40:43], v[240:243], v[96:99], v[40:43]
    ds_read_b64_tr_b16 v[232:233], v4 offset:41728
    v_mfma_f32_16x16x32_bf16 v[44:47], v[240:243], v[100:103], v[44:47]
    ds_read_b64_tr_b16 v[234:235], v4 offset:42752
    s_waitcnt lgkmcnt(6)
    v_mfma_f32_16x16x32_bf16 v[48:51], v[244:247], v[96:99], v[48:51]
    ds_read_b64_tr_b16 v[236:237], v5 offset:41760
    v_mfma_f32_16x16x32_bf16 v[52:55], v[244:247], v[100:103], v[52:55]
    ds_read_b64_tr_b16 v[238:239], v5 offset:42784
    s_waitcnt lgkmcnt(6)
    v_mfma_f32_16x16x32_bf16 v[56:59], v[224:227], v[96:99], v[56:59]
    v_mfma_f32_16x16x32_bf16 v[60:63], v[224:227], v[100:103], v[60:63]
    s_waitcnt vmcnt(10)
    s_barrier
    ds_read_b64_tr_b16 v[240:241], v4 offset:49152
    ds_read_b64_tr_b16 v[242:243], v4 offset:50176
    s_waitcnt lgkmcnt(6)
    v_mfma_f32_16x16x32_bf16 v[64:67], v[228:231], v[96:99], v[64:67]
    ds_read_b64_tr_b16 v[244:245], v5 offset:49184
    v_mfma_f32_16x16x32_bf16 v[68:71], v[228:231], v[100:103], v[68:71]
    s_add_u32 s22, s19, 0x480000
    s_add_u32 m0, s20, 0x4000
    s_nop 0
    buffer_load_dwordx4 v3, s[4:7], s22 offen lds
    ds_read_b64_tr_b16 v[246:247], v5 offset:50208
    s_mov_b32 s23, 0xc000
    buffer_load_dwordx4 v[132:135], v7, s[8:11], s23 offen offset:1024 sc1
    s_waitcnt lgkmcnt(6)
    v_mfma_f32_16x16x32_bf16 v[72:75], v[232:235], v[96:99], v[72:75]
    ds_read_b64_tr_b16 v[224:225], v4 offset:49408
    v_mfma_f32_16x16x32_bf16 v[76:79], v[232:235], v[100:103], v[76:79]
    ds_read_b64_tr_b16 v[226:227], v4 offset:50432
    s_waitcnt lgkmcnt(6)
    v_mfma_f32_16x16x32_bf16 v[80:83], v[236:239], v[96:99], v[80:83]
    ds_read_b64_tr_b16 v[228:229], v5 offset:49440
    v_mfma_f32_16x16x32_bf16 v[84:87], v[236:239], v[100:103], v[84:87]
    ds_read_b64_tr_b16 v[230:231], v5 offset:50464
    s_waitcnt vmcnt(11) lgkmcnt(6)
    v_mfma_f32_16x16x32_bf16 v[24:27], v[240:243], v[104:107], v[24:27]
    ds_read_b64_tr_b16 v[232:233], v4 offset:49664
    s_waitcnt vmcnt(10)
    v_mfma_f32_16x16x32_bf16 v[28:31], v[240:243], v[108:111], v[28:31]
    ds_read_b64_tr_b16 v[234:235], v4 offset:50688
    s_waitcnt lgkmcnt(6)
    v_mfma_f32_16x16x32_bf16 v[32:35], v[244:247], v[104:107], v[32:35]
    ds_read_b64_tr_b16 v[236:237], v5 offset:49696
    v_mfma_f32_16x16x32_bf16 v[36:39], v[244:247], v[108:111], v[36:39]
    s_add_u32 s22, s19, 0x488000
    s_add_u32 m0, s20, 0x4400
    s_nop 0
    buffer_load_dwordx4 v3, s[4:7], s22 offen lds
    ds_read_b64_tr_b16 v[238:239], v5 offset:50720
    s_mov_b32 s23, 0x4800
    buffer_load_dwordx4 v[88:91], v7, s[8:11], s23 offen offset:0 sc1
    s_waitcnt lgkmcnt(6)
    v_mfma_f32_16x16x32_bf16 v[40:43], v[224:227], v[104:107], v[40:43]
    ds_read_b64_tr_b16 v[240:241], v4 offset:49920
    v_mfma_f32_16x16x32_bf16 v[44:47], v[224:227], v[108:111], v[44:47]
    ds_read_b64_tr_b16 v[242:243], v4 offset:50944
    s_waitcnt lgkmcnt(6)
    v_mfma_f32_16x16x32_bf16 v[48:51], v[228:231], v[104:107], v[48:51]
    ds_read_b64_tr_b16 v[244:245], v5 offset:49952
    v_mfma_f32_16x16x32_bf16 v[52:55], v[228:231], v[108:111], v[52:55]
    ds_read_b64_tr_b16 v[246:247], v5 offset:50976
    s_waitcnt lgkmcnt(6)
    v_mfma_f32_16x16x32_bf16 v[56:59], v[232:235], v[104:107], v[56:59]
    ds_read_b64_tr_b16 v[224:225], v4 offset:57344
    v_mfma_f32_16x16x32_bf16 v[60:63], v[232:235], v[108:111], v[60:63]
    ds_read_b64_tr_b16 v[226:227], v4 offset:58368
    s_waitcnt lgkmcnt(6)
    v_mfma_f32_16x16x32_bf16 v[64:67], v[236:239], v[104:107], v[64:67]
    ds_read_b64_tr_b16 v[228:229], v5 offset:57376
    v_mfma_f32_16x16x32_bf16 v[68:71], v[236:239], v[108:111], v[68:71]
    ds_read_b64_tr_b16 v[230:231], v5 offset:58400
    s_mov_b32 s23, 0xc800
    buffer_load_dwordx4 v[92:95], v7, s[8:11], s23 offen offset:0 sc1
    s_waitcnt lgkmcnt(6)
    v_mfma_f32_16x16x32_bf16 v[72:75], v[240:243], v[104:107], v[72:75]
    ds_read_b64_tr_b16 v[232:233], v4 offset:57600
    v_mfma_f32_16x16x32_bf16 v[76:79], v[240:243], v[108:111], v[76:79]
    ds_read_b64_tr_b16 v[234:235], v4 offset:58624
    s_waitcnt lgkmcnt(6)
    v_mfma_f32_16x16x32_bf16 v[80:83], v[244:247], v[104:107], v[80:83]
    ds_read_b64_tr_b16 v[236:237], v5 offset:57632
    v_mfma_f32_16x16x32_bf16 v[84:87], v[244:247], v[108:111], v[84:87]
    ds_read_b64_tr_b16 v[238:239], v5 offset:58656
    s_waitcnt vmcnt(12) lgkmcnt(6)
    v_mfma_f32_16x16x32_bf16 v[24:27], v[224:227], v[112:115], v[24:27]
    ds_read_b64_tr_b16 v[240:241], v4 offset:57856
    s_waitcnt vmcnt(10)
    v_mfma_f32_16x16x32_bf16 v[28:31], v[224:227], v[116:119], v[28:31]
    ds_read_b64_tr_b16 v[242:243], v4 offset:58880
    s_waitcnt lgkmcnt(6)
    v_mfma_f32_16x16x32_bf16 v[32:35], v[228:231], v[112:115], v[32:35]
    ds_read_b64_tr_b16 v[244:245], v5 offset:57888
    v_mfma_f32_16x16x32_bf16 v[36:39], v[228:231], v[116:119], v[36:39]
    ds_read_b64_tr_b16 v[246:247], v5 offset:58912
    s_mov_b32 s23, 0x4800
    buffer_load_dwordx4 v[96:99], v7, s[8:11], s23 offen offset:1024 sc1
    s_waitcnt lgkmcnt(6)
    v_mfma_f32_16x16x32_bf16 v[40:43], v[232:235], v[112:115], v[40:43]
    ds_read_b64_tr_b16 v[224:225], v4 offset:58112
    v_mfma_f32_16x16x32_bf16 v[44:47], v[232:235], v[116:119], v[44:47]
    ds_read_b64_tr_b16 v[226:227], v4 offset:59136
    s_waitcnt lgkmcnt(6)
    v_mfma_f32_16x16x32_bf16 v[48:51], v[236:239], v[112:115], v[48:51]
    ds_read_b64_tr_b16 v[228:229], v5 offset:58144
    v_mfma_f32_16x16x32_bf16 v[52:55], v[236:239], v[116:119], v[52:55]
    ds_read_b64_tr_b16 v[230:231], v5 offset:59168
    s_waitcnt lgkmcnt(6)
    v_mfma_f32_16x16x32_bf16 v[56:59], v[240:243], v[112:115], v[56:59]
    v_mfma_f32_16x16x32_bf16 v[60:63], v[240:243], v[116:119], v[60:63]
    s_waitcnt vmcnt(10)
    s_barrier
    ds_read_b64_tr_b16 v[232:233], v4 offset:0
    ds_read_b64_tr_b16 v[234:235], v4 offset:1024
    s_waitcnt lgkmcnt(6)
    v_mfma_f32_16x16x32_bf16 v[64:67], v[244:247], v[112:115], v[64:67]
    ds_read_b64_tr_b16 v[236:237], v5 offset:32
    v_mfma_f32_16x16x32_bf16 v[68:71], v[244:247], v[116:119], v[68:71]
    s_add_u32 s22, s19, 0x500000
    s_add_u32 m0, s20, 0x8000
    s_nop 0
    buffer_load_dwordx4 v3, s[4:7], s22 offen lds
    ds_read_b64_tr_b16 v[238:239], v5 offset:1056
    s_mov_b32 s23, 0xc800
    buffer_load_dwordx4 v[100:103], v7, s[8:11], s23 offen offset:1024 sc1
    s_waitcnt lgkmcnt(6)
    v_mfma_f32_16x16x32_bf16 v[72:75], v[224:227], v[112:115], v[72:75]
    ds_read_b64_tr_b16 v[240:241], v4 offset:256
    v_mfma_f32_16x16x32_bf16 v[76:79], v[224:227], v[116:119], v[76:79]
    ds_read_b64_tr_b16 v[242:243], v4 offset:1280
    s_waitcnt lgkmcnt(6)
    v_mfma_f32_16x16x32_bf16 v[80:83], v[228:231], v[112:115], v[80:83]
    ds_read_b64_tr_b16 v[244:245], v5 offset:288
    v_mfma_f32_16x16x32_bf16 v[84:87], v[228:231], v[116:119], v[84:87]
    ds_read_b64_tr_b16 v[246:247], v5 offset:1312
    s_waitcnt vmcnt(11) lgkmcnt(6)
    v_mfma_f32_16x16x32_bf16 v[24:27], v[232:235], v[120:123], v[24:27]
    ds_read_b64_tr_b16 v[224:225], v4 offset:512
    s_waitcnt vmcnt(10)
    v_mfma_f32_16x16x32_bf16 v[28:31], v[232:235], v[124:127], v[28:31]
    ds_read_b64_tr_b16 v[226:227], v4 offset:1536
    s_waitcnt lgkmcnt(6)
    v_mfma_f32_16x16x32_bf16 v[32:35], v[236:239], v[120:123], v[32:35]
    ds_read_b64_tr_b16 v[228:229], v5 offset:544
    v_mfma_f32_16x16x32_bf16 v[36:39], v[236:239], v[124:127], v[36:39]
    s_add_u32 s22, s19, 0x508000
    s_add_u32 m0, s20, 0x8400
    s_nop 0
    buffer_load_dwordx4 v3, s[4:7], s22 offen lds
    ds_read_b64_tr_b16 v[230:231], v5 offset:1568
    s_mov_b32 s23, 0x5000
    buffer_load_dwordx4 v[104:107], v7, s[8:11], s23 offen offset:0 sc1
    s_waitcnt lgkmcnt(6)
    v_mfma_f32_16x16x32_bf16 v[40:43], v[240:243], v[120:123], v[40:43]
    ds_read_b64_tr_b16 v[232:233], v4 offset:768
    v_mfma_f32_16x16x32_bf16 v[44:47], v[240:243], v[124:127], v[44:47]
    ds_read_b64_tr_b16 v[234:235], v4 offset:1792
    s_waitcnt lgkmcnt(6)
    v_mfma_f32_16x16x32_bf16 v[48:51], v[244:247], v[120:123], v[48:51]
    ds_read_b64_tr_b16 v[236:237], v5 offset:800
    v_mfma_f32_16x16x32_bf16 v[52:55], v[244:247], v[124:127], v[52:55]
    ds_read_b64_tr_b16 v[238:239], v5 offset:1824
    s_waitcnt lgkmcnt(6)
    v_mfma_f32_16x16x32_bf16 v[56:59], v[224:227], v[120:123], v[56:59]
    ds_read_b64_tr_b16 v[240:241], v4 offset:8192
    v_mfma_f32_16x16x32_bf16 v[60:63], v[224:227], v[124:127], v[60:63]
    ds_read_b64_tr_b16 v[242:243], v4 offset:9216
    s_waitcnt lgkmcnt(6)
    v_mfma_f32_16x16x32_bf16 v[64:67], v[228:231], v[120:123], v[64:67]
    ds_read_b64_tr_b16 v[244:245], v5 offset:8224
    v_mfma_f32_16x16x32_bf16 v[68:71], v[228:231], v[124:127], v[68:71]
    ds_read_b64_tr_b16 v[246:247], v5 offset:9248
    s_mov_b32 s23, 0xd000
    buffer_load_dwordx4 v[108:111], v7, s[8:11], s23 offen offset:0 sc1
    s_waitcnt lgkmcnt(6)
    v_mfma_f32_16x16x32_bf16 v[72:75], v[232:235], v[120:123], v[72:75]
    ds_read_b64_tr_b16 v[224:225], v4 offset:8448
    v_mfma_f32_16x16x32_bf16 v[76:79], v[232:235], v[124:127], v[76:79]
    ds_read_b64_tr_b16 v[226:227], v4 offset:9472
    s_waitcnt lgkmcnt(6)
    v_mfma_f32_16x16x32_bf16 v[80:83], v[236:239], v[120:123], v[80:83]
    ds_read_b64_tr_b16 v[228:229], v5 offset:8480
    v_mfma_f32_16x16x32_bf16 v[84:87], v[236:239], v[124:127], v[84:87]
    ds_read_b64_tr_b16 v[230:231], v5 offset:9504
    s_waitcnt vmcnt(11) lgkmcnt(6)
    v_mfma_f32_16x16x32_bf16 v[24:27], v[240:243], v[128:131], v[24:27]
    ds_read_b64_tr_b16 v[232:233], v4 offset:8704
    s_waitcnt vmcnt(9)
    v_mfma_f32_16x16x32_bf16 v[28:31], v[240:243], v[132:135], v[28:31]
    ds_read_b64_tr_b16 v[234:235], v4 offset:9728
    s_waitcnt lgkmcnt(6)
    v_mfma_f32_16x16x32_bf16 v[32:35], v[244:247], v[128:131], v[32:35]
    ds_read_b64_tr_b16 v[236:237], v5 offset:8736
    v_mfma_f32_16x16x32_bf16 v[36:39], v[244:247], v[132:135], v[36:39]
    ds_read_b64_tr_b16 v[238:239], v5 offset:9760
    s_mov_b32 s23, 0x5000
    buffer_load_dwordx4 v[112:115], v7, s[8:11], s23 offen offset:1024 sc1
    s_waitcnt lgkmcnt(6)
    v_mfma_f32_16x16x32_bf16 v[40:43], v[224:227], v[128:131], v[40:43]
    ds_read_b64_tr_b16 v[240:241], v4 offset:8960
    v_mfma_f32_16x16x32_bf16 v[44:47], v[224:227], v[132:135], v[44:47]
    ds_read_b64_tr_b16 v[242:243], v4 offset:9984
    s_waitcnt lgkmcnt(6)
    v_mfma_f32_16x16x32_bf16 v[48:51], v[228:231], v[128:131], v[48:51]
    ds_read_b64_tr_b16 v[244:245], v5 offset:8992
    v_mfma_f32_16x16x32_bf16 v[52:55], v[228:231], v[132:135], v[52:55]
    ds_read_b64_tr_b16 v[246:247], v5 offset:10016
    s_waitcnt lgkmcnt(6)
    v_mfma_f32_16x16x32_bf16 v[56:59], v[232:235], v[128:131], v[56:59]
    v_mfma_f32_16x16x32_bf16 v[60:63], v[232:235], v[132:135], v[60:63]
    s_waitcnt vmcnt(9)
    s_barrier
    ds_read_b64_tr_b16 v[224:225], v4 offset:16384
    ds_read_b64_tr_b16 v[226:227], v4 offset:17408
    s_waitcnt lgkmcnt(6)
    v_mfma_f32_16x16x32_bf16 v[64:67], v[236:239], v[128:131], v[64:67]
    ds_read_b64_tr_b16 v[228:229], v5 offset:16416
    v_mfma_f32_16x16x32_bf16 v[68:71], v[236:239], v[132:135], v[68:71]
    s_add_u32 s22, s19, 0x580000
    s_add_u32 m0, s20, 0xc000
    s_nop 0
    buffer_load_dwordx4 v3, s[4:7], s22 offen lds
    ds_read_b64_tr_b16 v[230:231], v5 offset:17440
    s_mov_b32 s23, 0xd000
    buffer_load_dwordx4 v[116:119], v7, s[8:11], s23 offen offset:1024 sc1
    s_waitcnt lgkmcnt(6)
    v_mfma_f32_16x16x32_bf16 v[72:75], v[240:243], v[128:131], v[72:75]
    ds_read_b64_tr_b16 v[232:233], v4 offset:16640
    v_mfma_f32_16x16x32_bf16 v[76:79], v[240:243], v[132:135], v[76:79]
    ds_read_b64_tr_b16 v[234:235], v4 offset:17664
    s_waitcnt lgkmcnt(6)
    v_mfma_f32_16x16x32_bf16 v[80:83], v[244:247], v[128:131], v[80:83]
    ds_read_b64_tr_b16 v[236:237], v5 offset:16672
    v_mfma_f32_16x16x32_bf16 v[84:87], v[244:247], v[132:135], v[84:87]
    ds_read_b64_tr_b16 v[238:239], v5 offset:17696
    s_waitcnt vmcnt(10) lgkmcnt(6)
    v_mfma_f32_16x16x32_bf16 v[24:27], v[224:227], v[88:91], v[24:27]
    ds_read_b64_tr_b16 v[240:241], v4 offset:16896
    s_waitcnt vmcnt(9)
    v_mfma_f32_16x16x32_bf16 v[28:31], v[224:227], v[92:95], v[28:31]
    ds_read_b64_tr_b16 v[242:243], v4 offset:17920
    s_waitcnt lgkmcnt(6)
    v_mfma_f32_16x16x32_bf16 v[32:35], v[228:231], v[88:91], v[32:35]
    ds_read_b64_tr_b16 v[244:245], v5 offset:16928
    v_mfma_f32_16x16x32_bf16 v[36:39], v[228:231], v[92:95], v[36:39]
    s_add_u32 s22, s19, 0x588000
    s_add_u32 m0, s20, 0xc400
    s_nop 0
    buffer_load_dwordx4 v3, s[4:7], s22 offen lds
    ds_read_b64_tr_b16 v[246:247], v5 offset:17952
    s_mov_b32 s23, 0x5800
    buffer_load_dwordx4 v[120:123], v7, s[8:11], s23 offen offset:0 sc1
    s_waitcnt lgkmcnt(6)
    v_mfma_f32_16x16x32_bf16 v[40:43], v[232:235], v[88:91], v[40:43]
    ds_read_b64_tr_b16 v[224:225], v4 offset:17152
    v_mfma_f32_16x16x32_bf16 v[44:47], v[232:235], v[92:95], v[44:47]
    ds_read_b64_tr_b16 v[226:227], v4 offset:18176
    s_waitcnt lgkmcnt(6)
    v_mfma_f32_16x16x32_bf16 v[48:51], v[236:239], v[88:91], v[48:51]
    ds_read_b64_tr_b16 v[228:229], v5 offset:17184
    v_mfma_f32_16x16x32_bf16 v[52:55], v[236:239], v[92:95], v[52:55]
    ds_read_b64_tr_b16 v[230:231], v5 offset:18208
    s_waitcnt lgkmcnt(6)
    v_mfma_f32_16x16x32_bf16 v[56:59], v[240:243], v[88:91], v[56:59]
    ds_read_b64_tr_b16 v[232:233], v4 offset:24576
    v_mfma_f32_16x16x32_bf16 v[60:63], v[240:243], v[92:95], v[60:63]
    ds_read_b64_tr_b16 v[234:235], v4 offset:25600
    s_waitcnt lgkmcnt(6)
    v_mfma_f32_16x16x32_bf16 v[64:67], v[244:247], v[88:91], v[64:67]
    ds_read_b64_tr_b16 v[236:237], v5 offset:24608
    v_mfma_f32_16x16x32_bf16 v[68:71], v[244:247], v[92:95], v[68:71]
    ds_read_b64_tr_b16 v[238:239], v5 offset:25632
    s_mov_b32 s23, 0xd800
    buffer_load_dwordx4 v[124:127], v7, s[8:11], s23 offen offset:0 sc1
    s_waitcnt lgkmcnt(6)
    v_mfma_f32_16x16x32_bf16 v[72:75], v[224:227], v[88:91], v[72:75]
    ds_read_b64_tr_b16 v[240:241], v4 offset:24832
    v_xor_b32 v8, s28, v12
    v_xor_b32 v20, s28, v13
    v_or_b32 v8, v8, v20
    v_xor_b32 v20, s28, v14
    v_or_b32 v8, v8, v20
    v_xor_b32 v20, s28, v15
    v_or_b32 v8, v8, v20
    v_cmp_ne_u32 vcc, 0, v8
    s_cbranch_vccnz adaLN_cond__sliding_block_cached__moe_arch_mod__prompt_kernel_kv4r
adaLN_cond__sliding_block_cached__moe_arch_mod__prompt_kernel_kv4b:
    v_mfma_f32_16x16x32_bf16 v[76:79], v[224:227], v[92:95], v[76:79]
    ds_read_b64_tr_b16 v[242:243], v4 offset:25856
    s_waitcnt lgkmcnt(6)
    v_mfma_f32_16x16x32_bf16 v[80:83], v[228:231], v[88:91], v[80:83]
    ds_read_b64_tr_b16 v[244:245], v5 offset:24864
    v_mfma_f32_16x16x32_bf16 v[84:87], v[228:231], v[92:95], v[84:87]
    ds_read_b64_tr_b16 v[246:247], v5 offset:25888
    s_waitcnt vmcnt(11) lgkmcnt(6)
    v_mfma_f32_16x16x32_bf16 v[24:27], v[232:235], v[96:99], v[24:27]
    ds_read_b64_tr_b16 v[224:225], v4 offset:25088
    s_waitcnt vmcnt(9)
    v_mfma_f32_16x16x32_bf16 v[28:31], v[232:235], v[100:103], v[28:31]
    ds_read_b64_tr_b16 v[226:227], v4 offset:26112
    s_waitcnt lgkmcnt(6)
    v_mfma_f32_16x16x32_bf16 v[32:35], v[236:239], v[96:99], v[32:35]
    ds_read_b64_tr_b16 v[228:229], v5 offset:25120
    v_mfma_f32_16x16x32_bf16 v[36:39], v[236:239], v[100:103], v[36:39]
    ds_read_b64_tr_b16 v[230:231], v5 offset:26144
    s_mov_b32 s23, 0x5800
    buffer_load_dwordx4 v[128:131], v7, s[8:11], s23 offen offset:1024 sc1
    s_waitcnt lgkmcnt(6)
    v_mfma_f32_16x16x32_bf16 v[40:43], v[240:243], v[96:99], v[40:43]
    ds_read_b64_tr_b16 v[232:233], v4 offset:25344
    v_mfma_f32_16x16x32_bf16 v[44:47], v[240:243], v[100:103], v[44:47]
    ds_read_b64_tr_b16 v[234:235], v4 offset:26368
    s_waitcnt lgkmcnt(6)
    v_mfma_f32_16x16x32_bf16 v[48:51], v[244:247], v[96:99], v[48:51]
    ds_read_b64_tr_b16 v[236:237], v5 offset:25376
    v_mfma_f32_16x16x32_bf16 v[52:55], v[244:247], v[100:103], v[52:55]
    ds_read_b64_tr_b16 v[238:239], v5 offset:26400
    s_waitcnt lgkmcnt(6)
    v_mfma_f32_16x16x32_bf16 v[56:59], v[224:227], v[96:99], v[56:59]
    v_mfma_f32_16x16x32_bf16 v[60:63], v[224:227], v[100:103], v[60:63]
    s_waitcnt vmcnt(9)
    s_barrier
    ds_read_b64_tr_b16 v[240:241], v4 offset:32768
    ds_read_b64_tr_b16 v[242:243], v4 offset:33792
    s_waitcnt lgkmcnt(6)
    v_mfma_f32_16x16x32_bf16 v[64:67], v[228:231], v[96:99], v[64:67]
    ds_read_b64_tr_b16 v[244:245], v5 offset:32800
    v_mfma_f32_16x16x32_bf16 v[68:71], v[228:231], v[100:103], v[68:71]
    s_add_u32 s22, s19, 0x600000
    s_add_u32 m0, s20, 0x0
    s_nop 0
    buffer_load_dwordx4 v3, s[4:7], s22 offen lds
    ds_read_b64_tr_b16 v[246:247], v5 offset:33824
    s_mov_b32 s23, 0xd800
    buffer_load_dwordx4 v[132:135], v7, s[8:11], s23 offen offset:1024 sc1
    s_waitcnt lgkmcnt(6)
    v_mfma_f32_16x16x32_bf16 v[72:75], v[232:235], v[96:99], v[72:75]
    ds_read_b64_tr_b16 v[224:225], v4 offset:33024
    v_mfma_f32_16x16x32_bf16 v[76:79], v[232:235], v[100:103], v[76:79]
    ds_read_b64_tr_b16 v[226:227], v4 offset:34048
    s_waitcnt lgkmcnt(6)
    v_mfma_f32_16x16x32_bf16 v[80:83], v[236:239], v[96:99], v[80:83]
    ds_read_b64_tr_b16 v[228:229], v5 offset:33056
    v_mfma_f32_16x16x32_bf16 v[84:87], v[236:239], v[100:103], v[84:87]
    ds_read_b64_tr_b16 v[230:231], v5 offset:34080
    s_waitcnt vmcnt(10) lgkmcnt(6)
    v_mfma_f32_16x16x32_bf16 v[24:27], v[240:243], v[104:107], v[24:27]
    ds_read_b64_tr_b16 v[232:233], v4 offset:33280
    s_waitcnt vmcnt(9)
    v_mfma_f32_16x16x32_bf16 v[28:31], v[240:243], v[108:111], v[28:31]
    ds_read_b64_tr_b16 v[234:235], v4 offset:34304
    s_waitcnt lgkmcnt(6)
    v_mfma_f32_16x16x32_bf16 v[32:35], v[244:247], v[104:107], v[32:35]
    ds_read_b64_tr_b16 v[236:237], v5 offset:33312
    v_mfma_f32_16x16x32_bf16 v[36:39], v[244:247], v[108:111], v[36:39]
    s_add_u32 s22, s19, 0x608000
    s_add_u32 m0, s20, 0x400
    s_nop 0
    buffer_load_dwordx4 v3, s[4:7], s22 offen lds
    ds_read_b64_tr_b16 v[238:239], v5 offset:34336
    s_mov_b32 s23, 0x6000
    buffer_load_dwordx4 v[88:91], v7, s[8:11], s23 offen offset:0 sc1
    s_waitcnt lgkmcnt(6)
    v_mfma_f32_16x16x32_bf16 v[40:43], v[224:227], v[104:107], v[40:43]
    ds_read_b64_tr_b16 v[240:241], v4 offset:33536
    v_mfma_f32_16x16x32_bf16 v[44:47], v[224:227], v[108:111], v[44:47]
    ds_read_b64_tr_b16 v[242:243], v4 offset:34560
    s_waitcnt lgkmcnt(6)
    v_mfma_f32_16x16x32_bf16 v[48:51], v[228:231], v[104:107], v[48:51]
    ds_read_b64_tr_b16 v[244:245], v5 offset:33568
    v_mfma_f32_16x16x32_bf16 v[52:55], v[228:231], v[108:111], v[52:55]
    ds_read_b64_tr_b16 v[246:247], v5 offset:34592
    s_waitcnt lgkmcnt(6)
    v_mfma_f32_16x16x32_bf16 v[56:59], v[232:235], v[104:107], v[56:59]
    ds_read_b64_tr_b16 v[224:225], v4 offset:40960
    v_mfma_f32_16x16x32_bf16 v[60:63], v[232:235], v[108:111], v[60:63]
    ds_read_b64_tr_b16 v[226:227], v4 offset:41984
    s_waitcnt lgkmcnt(6)
    v_mfma_f32_16x16x32_bf16 v[64:67], v[236:239], v[104:107], v[64:67]
    ds_read_b64_tr_b16 v[228:229], v5 offset:40992
    v_mfma_f32_16x16x32_bf16 v[68:71], v[236:239], v[108:111], v[68:71]
    ds_read_b64_tr_b16 v[230:231], v5 offset:42016
    s_mov_b32 s23, 0xe000
    buffer_load_dwordx4 v[92:95], v7, s[8:11], s23 offen offset:0 sc1
    s_waitcnt lgkmcnt(6)
    v_mfma_f32_16x16x32_bf16 v[72:75], v[240:243], v[104:107], v[72:75]
    ds_read_b64_tr_b16 v[232:233], v4 offset:41216
    v_mfma_f32_16x16x32_bf16 v[76:79], v[240:243], v[108:111], v[76:79]
    ds_read_b64_tr_b16 v[234:235], v4 offset:42240
    s_waitcnt lgkmcnt(6)
    v_mfma_f32_16x16x32_bf16 v[80:83], v[244:247], v[104:107], v[80:83]
    ds_read_b64_tr_b16 v[236:237], v5 offset:41248
    v_mfma_f32_16x16x32_bf16 v[84:87], v[244:247], v[108:111], v[84:87]
    ds_read_b64_tr_b16 v[238:239], v5 offset:42272
    s_waitcnt vmcnt(11) lgkmcnt(6)
    v_mfma_f32_16x16x32_bf16 v[24:27], v[224:227], v[112:115], v[24:27]
    ds_read_b64_tr_b16 v[240:241], v4 offset:41472
    s_add_u32 s22, s21, 0x0
    s_add_u32 m0, s20, 0x10000
    s_nop 0
    buffer_load_dwordx4 v2, s[8:11], s22 offen sc1 lds
    s_waitcnt vmcnt(10)
    v_mfma_f32_16x16x32_bf16 v[28:31], v[224:227], v[116:119], v[28:31]
    ds_read_b64_tr_b16 v[242:243], v4 offset:42496
    s_waitcnt lgkmcnt(6)
    v_mfma_f32_16x16x32_bf16 v[32:35], v[228:231], v[112:115], v[32:35]
    ds_read_b64_tr_b16 v[244:245], v5 offset:41504
    v_mfma_f32_16x16x32_bf16 v[36:39], v[228:231], v[116:119], v[36:39]
    ds_read_b64_tr_b16 v[246:247], v5 offset:42528
    s_mov_b32 s23, 0x6000
    buffer_load_dwordx4 v[96:99], v7, s[8:11], s23 offen offset:1024 sc1
    s_waitcnt lgkmcnt(6)
    v_mfma_f32_16x16x32_bf16 v[40:43], v[232:235], v[112:115], v[40:43]
    ds_read_b64_tr_b16 v[224:225], v4 offset:41728
    s_add_u32 s22, s21, 0x400
    s_add_u32 m0, s20, 0x10400
    s_nop 0
    buffer_load_dwordx4 v2, s[8:11], s22 offen sc1 lds
    v_mfma_f32_16x16x32_bf16 v[44:47], v[232:235], v[116:119], v[44:47]
    ds_read_b64_tr_b16 v[226:227], v4 offset:42752
    s_waitcnt lgkmcnt(6)
    v_mfma_f32_16x16x32_bf16 v[48:51], v[236:239], v[112:115], v[48:51]
    ds_read_b64_tr_b16 v[228:229], v5 offset:41760
    v_mfma_f32_16x16x32_bf16 v[52:55], v[236:239], v[116:119], v[52:55]
    ds_read_b64_tr_b16 v[230:231], v5 offset:42784
    s_waitcnt lgkmcnt(6)
    v_mfma_f32_16x16x32_bf16 v[56:59], v[240:243], v[112:115], v[56:59]
    v_mfma_f32_16x16x32_bf16 v[60:63], v[240:243], v[116:119], v[60:63]
    s_waitcnt vmcnt(11)
    s_barrier
    ds_read_b64_tr_b16 v[232:233], v4 offset:49152
    ds_read_b64_tr_b16 v[234:235], v4 offset:50176
    s_waitcnt lgkmcnt(6)
    v_mfma_f32_16x16x32_bf16 v[64:67], v[244:247], v[112:115], v[64:67]
    ds_read_b64_tr_b16 v[236:237], v5 offset:49184
    v_mfma_f32_16x16x32_bf16 v[68:71], v[244:247], v[116:119], v[68:71]
    s_add_u32 s22, s19, 0x680000
    s_add_u32 m0, s20, 0x4000
    s_nop 0
    buffer_load_dwordx4 v3, s[4:7], s22 offen lds
    ds_read_b64_tr_b16 v[238:239], v5 offset:50208
    s_mov_b32 s23, 0xe000
    buffer_load_dwordx4 v[100:103], v7, s[8:11], s23 offen offset:1024 sc1
    s_waitcnt lgkmcnt(6)
    v_mfma_f32_16x16x32_bf16 v[72:75], v[224:227], v[112:115], v[72:75]
    ds_read_b64_tr_b16 v[240:241], v4 offset:49408
    v_mfma_f32_16x16x32_bf16 v[76:79], v[224:227], v[116:119], v[76:79]
    ds_read_b64_tr_b16 v[242:243], v4 offset:50432
    s_waitcnt lgkmcnt(6)
    v_mfma_f32_16x16x32_bf16 v[80:83], v[228:231], v[112:115], v[80:83]
    ds_read_b64_tr_b16 v[244:245], v5 offset:49440
    v_mfma_f32_16x16x32_bf16 v[84:87], v[228:231], v[116:119], v[84:87]
    ds_read_b64_tr_b16 v[246:247], v5 offset:50464
    s_waitcnt vmcnt(12) lgkmcnt(6)
    v_mfma_f32_16x16x32_bf16 v[24:27], v[232:235], v[120:123], v[24:27]
    ds_read_b64_tr_b16 v[224:225], v4 offset:49664
    s_waitcnt vmcnt(11)
    v_mfma_f32_16x16x32_bf16 v[28:31], v[232:235], v[124:127], v[28:31]
    ds_read_b64_tr_b16 v[226:227], v4 offset:50688
    s_waitcnt lgkmcnt(6)
    v_mfma_f32_16x16x32_bf16 v[32:35], v[236:239], v[120:123], v[32:35]
    ds_read_b64_tr_b16 v[228:229], v5 offset:49696
    v_mfma_f32_16x16x32_bf16 v[36:39], v[236:239], v[124:127], v[36:39]
    s_add_u32 s22, s19, 0x688000
    s_add_u32 m0, s20, 0x4400
    s_nop 0
    buffer_load_dwordx4 v3, s[4:7], s22 offen lds
    ds_read_b64_tr_b16 v[230:231], v5 offset:50720
    s_mov_b32 s23, 0x6800
    buffer_load_dwordx4 v[104:107], v7, s[8:11], s23 offen offset:0 sc1
    s_waitcnt lgkmcnt(6)
    v_mfma_f32_16x16x32_bf16 v[40:43], v[240:243], v[120:123], v[40:43]
    ds_read_b64_tr_b16 v[232:233], v4 offset:49920
    v_mfma_f32_16x16x32_bf16 v[44:47], v[240:243], v[124:127], v[44:47]
    ds_read_b64_tr_b16 v[234:235], v4 offset:50944
    s_waitcnt lgkmcnt(6)
    v_mfma_f32_16x16x32_bf16 v[48:51], v[244:247], v[120:123], v[48:51]
    ds_read_b64_tr_b16 v[236:237], v5 offset:49952
    v_mfma_f32_16x16x32_bf16 v[52:55], v[244:247], v[124:127], v[52:55]
    ds_read_b64_tr_b16 v[238:239], v5 offset:50976
    s_waitcnt lgkmcnt(6)
    v_mfma_f32_16x16x32_bf16 v[56:59], v[224:227], v[120:123], v[56:59]
    ds_read_b64_tr_b16 v[240:241], v4 offset:57344
    v_mfma_f32_16x16x32_bf16 v[60:63], v[224:227], v[124:127], v[60:63]
    ds_read_b64_tr_b16 v[242:243], v4 offset:58368
    s_waitcnt lgkmcnt(6)
    v_mfma_f32_16x16x32_bf16 v[64:67], v[228:231], v[120:123], v[64:67]
    ds_read_b64_tr_b16 v[244:245], v5 offset:57376
    v_mfma_f32_16x16x32_bf16 v[68:71], v[228:231], v[124:127], v[68:71]
    ds_read_b64_tr_b16 v[246:247], v5 offset:58400
    s_mov_b32 s23, 0xe800
    buffer_load_dwordx4 v[108:111], v7, s[8:11], s23 offen offset:0 sc1
    s_waitcnt lgkmcnt(6)
    v_mfma_f32_16x16x32_bf16 v[72:75], v[232:235], v[120:123], v[72:75]
    ds_read_b64_tr_b16 v[224:225], v4 offset:57600
    v_mfma_f32_16x16x32_bf16 v[76:79], v[232:235], v[124:127], v[76:79]
    ds_read_b64_tr_b16 v[226:227], v4 offset:58624
    s_waitcnt lgkmcnt(6)
    v_mfma_f32_16x16x32_bf16 v[80:83], v[236:239], v[120:123], v[80:83]
    ds_read_b64_tr_b16 v[228:229], v5 offset:57632
    v_mfma_f32_16x16x32_bf16 v[84:87], v[236:239], v[124:127], v[84:87]
    ds_read_b64_tr_b16 v[230:231], v5 offset:58656
    s_waitcnt vmcnt(13) lgkmcnt(6)
    v_mfma_f32_16x16x32_bf16 v[24:27], v[240:243], v[128:131], v[24:27]
    ds_read_b64_tr_b16 v[232:233], v4 offset:57856
    s_add_u32 s22, s21, 0x4000
    s_add_u32 m0, s20, 0x14000
    s_nop 0
    buffer_load_dwordx4 v2, s[8:11], s22 offen sc1 lds
    s_waitcnt vmcnt(12)
    v_mfma_f32_16x16x32_bf16 v[28:31], v[240:243], v[132:135], v[28:31]
    ds_read_b64_tr_b16 v[234:235], v4 offset:58880
    s_waitcnt lgkmcnt(6)
    v_mfma_f32_16x16x32_bf16 v[32:35], v[244:247], v[128:131], v[32:35]
    ds_read_b64_tr_b16 v[236:237], v5 offset:57888
    v_mfma_f32_16x16x32_bf16 v[36:39], v[244:247], v[132:135], v[36:39]
    ds_read_b64_tr_b16 v[238:239], v5 offset:58912
    s_mov_b32 s23, 0x6800
    buffer_load_dwordx4 v[112:115], v7, s[8:11], s23 offen offset:1024 sc1
    s_waitcnt lgkmcnt(6)
    v_mfma_f32_16x16x32_bf16 v[40:43], v[224:227], v[128:131], v[40:43]
    ds_read_b64_tr_b16 v[240:241], v4 offset:58112
    s_add_u32 s22, s21, 0x4400
    s_add_u32 m0, s20, 0x14400
    s_nop 0
    buffer_load_dwordx4 v2, s[8:11], s22 offen sc1 lds
    v_mfma_f32_16x16x32_bf16 v[44:47], v[224:227], v[132:135], v[44:47]
    ds_read_b64_tr_b16 v[242:243], v4 offset:59136
    s_waitcnt lgkmcnt(6)
    v_mfma_f32_16x16x32_bf16 v[48:51], v[228:231], v[128:131], v[48:51]
    ds_read_b64_tr_b16 v[244:245], v5 offset:58144
    v_mfma_f32_16x16x32_bf16 v[52:55], v[228:231], v[132:135], v[52:55]
    ds_read_b64_tr_b16 v[246:247], v5 offset:59168
    s_waitcnt lgkmcnt(6)
    v_mfma_f32_16x16x32_bf16 v[56:59], v[232:235], v[128:131], v[56:59]
    v_mfma_f32_16x16x32_bf16 v[60:63], v[232:235], v[132:135], v[60:63]
    s_waitcnt vmcnt(13)
    s_barrier
    ds_read_b64_tr_b16 v[224:225], v4 offset:0
    ds_read_b64_tr_b16 v[226:227], v4 offset:1024
    s_waitcnt lgkmcnt(6)
    v_mfma_f32_16x16x32_bf16 v[64:67], v[236:239], v[128:131], v[64:67]
    ds_read_b64_tr_b16 v[228:229], v5 offset:32
    v_mfma_f32_16x16x32_bf16 v[68:71], v[236:239], v[132:135], v[68:71]
    s_add_u32 s22, s19, 0x700000
    s_add_u32 m0, s20, 0x8000
    s_nop 0
    buffer_load_dwordx4 v3, s[4:7], s22 offen lds
    ds_read_b64_tr_b16 v[230:231], v5 offset:1056
    s_mov_b32 s23, 0xe800
    buffer_load_dwordx4 v[116:119], v7, s[8:11], s23 offen offset:1024 sc1
    s_waitcnt lgkmcnt(6)
    v_mfma_f32_16x16x32_bf16 v[72:75], v[240:243], v[128:131], v[72:75]
    ds_read_b64_tr_b16 v[232:233], v4 offset:256
    v_mfma_f32_16x16x32_bf16 v[76:79], v[240:243], v[132:135], v[76:79]
    ds_read_b64_tr_b16 v[234:235], v4 offset:1280
    s_waitcnt lgkmcnt(6)
    v_mfma_f32_16x16x32_bf16 v[80:83], v[244:247], v[128:131], v[80:83]
    ds_read_b64_tr_b16 v[236:237], v5 offset:288
    v_mfma_f32_16x16x32_bf16 v[84:87], v[244:247], v[132:135], v[84:87]
    ds_read_b64_tr_b16 v[238:239], v5 offset:1312
    s_waitcnt vmcnt(14) lgkmcnt(6)
    v_mfma_f32_16x16x32_bf16 v[24:27], v[224:227], v[88:91], v[24:27]
    ds_read_b64_tr_b16 v[240:241], v4 offset:512
    s_waitcnt vmcnt(13)
    v_mfma_f32_16x16x32_bf16 v[28:31], v[224:227], v[92:95], v[28:31]
    ds_read_b64_tr_b16 v[242:243], v4 offset:1536
    s_waitcnt lgkmcnt(6)
    v_mfma_f32_16x16x32_bf16 v[32:35], v[228:231], v[88:91], v[32:35]
    ds_read_b64_tr_b16 v[244:245], v5 offset:544
    v_mfma_f32_16x16x32_bf16 v[36:39], v[228:231], v[92:95], v[36:39]
    s_add_u32 s22, s19, 0x708000
    s_add_u32 m0, s20, 0x8400
    s_nop 0
    buffer_load_dwordx4 v3, s[4:7], s22 offen lds
    ds_read_b64_tr_b16 v[246:247], v5 offset:1568
    s_mov_b32 s23, 0x7000
    buffer_load_dwordx4 v[120:123], v7, s[8:11], s23 offen offset:0 sc1
    s_waitcnt lgkmcnt(6)
    v_mfma_f32_16x16x32_bf16 v[40:43], v[232:235], v[88:91], v[40:43]
    ds_read_b64_tr_b16 v[224:225], v4 offset:768
    v_mfma_f32_16x16x32_bf16 v[44:47], v[232:235], v[92:95], v[44:47]
    ds_read_b64_tr_b16 v[226:227], v4 offset:1792
    s_waitcnt lgkmcnt(6)
    v_mfma_f32_16x16x32_bf16 v[48:51], v[236:239], v[88:91], v[48:51]
    ds_read_b64_tr_b16 v[228:229], v5 offset:800
    v_mfma_f32_16x16x32_bf16 v[52:55], v[236:239], v[92:95], v[52:55]
    ds_read_b64_tr_b16 v[230:231], v5 offset:1824
    s_waitcnt lgkmcnt(6)
    v_mfma_f32_16x16x32_bf16 v[56:59], v[240:243], v[88:91], v[56:59]
    ds_read_b64_tr_b16 v[232:233], v4 offset:8192
    v_mfma_f32_16x16x32_bf16 v[60:63], v[240:243], v[92:95], v[60:63]
    ds_read_b64_tr_b16 v[234:235], v4 offset:9216
    s_waitcnt lgkmcnt(6)
    v_mfma_f32_16x16x32_bf16 v[64:67], v[244:247], v[88:91], v[64:67]
    ds_read_b64_tr_b16 v[236:237], v5 offset:8224
    v_mfma_f32_16x16x32_bf16 v[68:71], v[244:247], v[92:95], v[68:71]
    ds_read_b64_tr_b16 v[238:239], v5 offset:9248
    s_mov_b32 s23, 0xf000
    buffer_load_dwordx4 v[124:127], v7, s[8:11], s23 offen offset:0 sc1
    s_waitcnt lgkmcnt(6)
    v_mfma_f32_16x16x32_bf16 v[72:75], v[224:227], v[88:91], v[72:75]
    ds_read_b64_tr_b16 v[240:241], v4 offset:8448
    v_mfma_f32_16x16x32_bf16 v[76:79], v[224:227], v[92:95], v[76:79]
    ds_read_b64_tr_b16 v[242:243], v4 offset:9472
    s_waitcnt lgkmcnt(6)
    v_mfma_f32_16x16x32_bf16 v[80:83], v[228:231], v[88:91], v[80:83]
    ds_read_b64_tr_b16 v[244:245], v5 offset:8480
    v_mfma_f32_16x16x32_bf16 v[84:87], v[228:231], v[92:95], v[84:87]
    ds_read_b64_tr_b16 v[246:247], v5 offset:9504
    s_waitcnt vmcnt(14) lgkmcnt(6)
    v_mfma_f32_16x16x32_bf16 v[24:27], v[232:235], v[96:99], v[24:27]
    ds_read_b64_tr_b16 v[224:225], v4 offset:8704
    s_add_u32 s22, s21, 0x8000
    s_add_u32 m0, s20, 0x18000
    s_nop 0
    buffer_load_dwordx4 v2, s[8:11], s22 offen sc1 lds
    s_waitcnt vmcnt(12)
    v_mfma_f32_16x16x32_bf16 v[28:31], v[232:235], v[100:103], v[28:31]
    ds_read_b64_tr_b16 v[226:227], v4 offset:9728
    s_waitcnt lgkmcnt(6)
    v_mfma_f32_16x16x32_bf16 v[32:35], v[236:239], v[96:99], v[32:35]
    ds_read_b64_tr_b16 v[228:229], v5 offset:8736
    v_mfma_f32_16x16x32_bf16 v[36:39], v[236:239], v[100:103], v[36:39]
    ds_read_b64_tr_b16 v[230:231], v5 offset:9760
    s_mov_b32 s23, 0x7000
    buffer_load_dwordx4 v[128:131], v7, s[8:11], s23 offen offset:1024 sc1
    s_waitcnt lgkmcnt(6)
    v_mfma_f32_16x16x32_bf16 v[40:43], v[240:243], v[96:99], v[40:43]
    ds_read_b64_tr_b16 v[232:233], v4 offset:8960
    s_add_u32 s22, s21, 0x8400
    s_add_u32 m0, s20, 0x18400
    s_nop 0
    buffer_load_dwordx4 v2, s[8:11], s22 offen sc1 lds
    v_mfma_f32_16x16x32_bf16 v[44:47], v[240:243], v[100:103], v[44:47]
    ds_read_b64_tr_b16 v[234:235], v4 offset:9984
    s_waitcnt lgkmcnt(6)
    v_mfma_f32_16x16x32_bf16 v[48:51], v[244:247], v[96:99], v[48:51]
    ds_read_b64_tr_b16 v[236:237], v5 offset:8992
    v_mfma_f32_16x16x32_bf16 v[52:55], v[244:247], v[100:103], v[52:55]
    ds_read_b64_tr_b16 v[238:239], v5 offset:10016
    s_waitcnt lgkmcnt(6)
    v_mfma_f32_16x16x32_bf16 v[56:59], v[224:227], v[96:99], v[56:59]
    v_mfma_f32_16x16x32_bf16 v[60:63], v[224:227], v[100:103], v[60:63]
    s_waitcnt vmcnt(13)
    s_barrier
    ds_read_b64_tr_b16 v[240:241], v4 offset:16384
    ds_read_b64_tr_b16 v[242:243], v4 offset:17408
    s_waitcnt lgkmcnt(6)
    v_mfma_f32_16x16x32_bf16 v[64:67], v[228:231], v[96:99], v[64:67]
    ds_read_b64_tr_b16 v[244:245], v5 offset:16416
    v_mfma_f32_16x16x32_bf16 v[68:71], v[228:231], v[100:103], v[68:71]
    s_add_u32 s22, s19, 0x780000
    s_add_u32 m0, s20, 0xc000
    s_nop 0
    buffer_load_dwordx4 v3, s[4:7], s22 offen lds
    ds_read_b64_tr_b16 v[246:247], v5 offset:17440
    s_mov_b32 s23, 0xf000
    buffer_load_dwordx4 v[132:135], v7, s[8:11], s23 offen offset:1024 sc1
    s_waitcnt lgkmcnt(6)
    v_mfma_f32_16x16x32_bf16 v[72:75], v[232:235], v[96:99], v[72:75]
    ds_read_b64_tr_b16 v[224:225], v4 offset:16640
    v_mfma_f32_16x16x32_bf16 v[76:79], v[232:235], v[100:103], v[76:79]
    ds_read_b64_tr_b16 v[226:227], v4 offset:17664
    s_waitcnt lgkmcnt(6)
    v_mfma_f32_16x16x32_bf16 v[80:83], v[236:239], v[96:99], v[80:83]
    ds_read_b64_tr_b16 v[228:229], v5 offset:16672
    v_mfma_f32_16x16x32_bf16 v[84:87], v[236:239], v[100:103], v[84:87]
    ds_read_b64_tr_b16 v[230:231], v5 offset:17696
    s_waitcnt vmcnt(14) lgkmcnt(6)
    v_mfma_f32_16x16x32_bf16 v[24:27], v[240:243], v[104:107], v[24:27]
    ds_read_b64_tr_b16 v[232:233], v4 offset:16896
    s_waitcnt vmcnt(13)
    v_mfma_f32_16x16x32_bf16 v[28:31], v[240:243], v[108:111], v[28:31]
    ds_read_b64_tr_b16 v[234:235], v4 offset:17920
    s_waitcnt lgkmcnt(6)
    v_mfma_f32_16x16x32_bf16 v[32:35], v[244:247], v[104:107], v[32:35]
    ds_read_b64_tr_b16 v[236:237], v5 offset:16928
    v_mfma_f32_16x16x32_bf16 v[36:39], v[244:247], v[108:111], v[36:39]
    s_add_u32 s22, s19, 0x788000
    s_add_u32 m0, s20, 0xc400
    s_nop 0
    buffer_load_dwordx4 v3, s[4:7], s22 offen lds
    ds_read_b64_tr_b16 v[238:239], v5 offset:17952
    s_mov_b32 s23, 0x7800
    buffer_load_dwordx4 v[88:91], v7, s[8:11], s23 offen offset:0 sc1
    s_waitcnt lgkmcnt(6)
    v_mfma_f32_16x16x32_bf16 v[40:43], v[224:227], v[104:107], v[40:43]
    ds_read_b64_tr_b16 v[240:241], v4 offset:17152
    v_mfma_f32_16x16x32_bf16 v[44:47], v[224:227], v[108:111], v[44:47]
    ds_read_b64_tr_b16 v[242:243], v4 offset:18176
    s_waitcnt lgkmcnt(6)
    v_mfma_f32_16x16x32_bf16 v[48:51], v[228:231], v[104:107], v[48:51]
    ds_read_b64_tr_b16 v[244:245], v5 offset:17184
    v_mfma_f32_16x16x32_bf16 v[52:55], v[228:231], v[108:111], v[52:55]
    ds_read_b64_tr_b16 v[246:247], v5 offset:18208
    s_waitcnt lgkmcnt(6)
    v_mfma_f32_16x16x32_bf16 v[56:59], v[232:235], v[104:107], v[56:59]
    ds_read_b64_tr_b16 v[224:225], v4 offset:24576
    v_mfma_f32_16x16x32_bf16 v[60:63], v[232:235], v[108:111], v[60:63]
    ds_read_b64_tr_b16 v[226:227], v4 offset:25600
    s_waitcnt lgkmcnt(6)
    v_mfma_f32_16x16x32_bf16 v[64:67], v[236:239], v[104:107], v[64:67]
    ds_read_b64_tr_b16 v[228:229], v5 offset:24608
    v_mfma_f32_16x16x32_bf16 v[68:71], v[236:239], v[108:111], v[68:71]
    ds_read_b64_tr_b16 v[230:231], v5 offset:25632
    s_mov_b32 s23, 0xf800
    buffer_load_dwordx4 v[92:95], v7, s[8:11], s23 offen offset:0 sc1
    s_waitcnt lgkmcnt(6)
    v_mfma_f32_16x16x32_bf16 v[72:75], v[240:243], v[104:107], v[72:75]
    ds_read_b64_tr_b16 v[232:233], v4 offset:24832
    v_mfma_f32_16x16x32_bf16 v[76:79], v[240:243], v[108:111], v[76:79]
    ds_read_b64_tr_b16 v[234:235], v4 offset:25856
    s_waitcnt lgkmcnt(6)
    v_mfma_f32_16x16x32_bf16 v[80:83], v[244:247], v[104:107], v[80:83]
    ds_read_b64_tr_b16 v[236:237], v5 offset:24864
    v_mfma_f32_16x16x32_bf16 v[84:87], v[244:247], v[108:111], v[84:87]
    ds_read_b64_tr_b16 v[238:239], v5 offset:25888
    s_waitcnt vmcnt(14) lgkmcnt(6)
    v_mfma_f32_16x16x32_bf16 v[24:27], v[224:227], v[112:115], v[24:27]
    ds_read_b64_tr_b16 v[240:241], v4 offset:25088
    s_add_u32 s22, s21, 0xc000
    s_add_u32 m0, s20, 0x1c000
    s_nop 0
    buffer_load_dwordx4 v2, s[8:11], s22 offen sc1 lds
    s_waitcnt vmcnt(12)
    v_mfma_f32_16x16x32_bf16 v[28:31], v[224:227], v[116:119], v[28:31]
    ds_read_b64_tr_b16 v[242:243], v4 offset:26112
    s_waitcnt lgkmcnt(6)
    v_mfma_f32_16x16x32_bf16 v[32:35], v[228:231], v[112:115], v[32:35]
    ds_read_b64_tr_b16 v[244:245], v5 offset:25120
    v_mfma_f32_16x16x32_bf16 v[36:39], v[228:231], v[116:119], v[36:39]
    ds_read_b64_tr_b16 v[246:247], v5 offset:26144
    s_mov_b32 s23, 0x7800
    buffer_load_dwordx4 v[96:99], v7, s[8:11], s23 offen offset:1024 sc1
    s_waitcnt lgkmcnt(6)
    v_mfma_f32_16x16x32_bf16 v[40:43], v[232:235], v[112:115], v[40:43]
    ds_read_b64_tr_b16 v[224:225], v4 offset:25344
    s_add_u32 s22, s21, 0xc400
    s_add_u32 m0, s20, 0x1c400
    s_nop 0
    buffer_load_dwordx4 v2, s[8:11], s22 offen sc1 lds
    v_mfma_f32_16x16x32_bf16 v[44:47], v[232:235], v[116:119], v[44:47]
    ds_read_b64_tr_b16 v[226:227], v4 offset:26368
    s_waitcnt lgkmcnt(6)
    v_mfma_f32_16x16x32_bf16 v[48:51], v[236:239], v[112:115], v[48:51]
    ds_read_b64_tr_b16 v[228:229], v5 offset:25376
    v_mfma_f32_16x16x32_bf16 v[52:55], v[236:239], v[116:119], v[52:55]
    ds_read_b64_tr_b16 v[230:231], v5 offset:26400
    s_waitcnt lgkmcnt(6)
    v_mfma_f32_16x16x32_bf16 v[56:59], v[240:243], v[112:115], v[56:59]
    v_mfma_f32_16x16x32_bf16 v[60:63], v[240:243], v[116:119], v[60:63]
    s_waitcnt vmcnt(13)
    s_barrier
    ds_read_b64_tr_b16 v[232:233], v4 offset:32768
    ds_read_b64_tr_b16 v[234:235], v4 offset:33792
    s_waitcnt lgkmcnt(6)
    v_mfma_f32_16x16x32_bf16 v[64:67], v[244:247], v[112:115], v[64:67]
    ds_read_b64_tr_b16 v[236:237], v5 offset:32800
    v_mfma_f32_16x16x32_bf16 v[68:71], v[244:247], v[116:119], v[68:71]
    ds_read_b64_tr_b16 v[238:239], v5 offset:33824
    s_mov_b32 s23, 0xf800
    buffer_load_dwordx4 v[100:103], v7, s[8:11], s23 offen offset:1024 sc1
    s_waitcnt lgkmcnt(6)
    v_mfma_f32_16x16x32_bf16 v[72:75], v[224:227], v[112:115], v[72:75]
    ds_read_b64_tr_b16 v[240:241], v4 offset:33024
    v_mfma_f32_16x16x32_bf16 v[76:79], v[224:227], v[116:119], v[76:79]
    ds_read_b64_tr_b16 v[242:243], v4 offset:34048
    s_waitcnt lgkmcnt(6)
    v_mfma_f32_16x16x32_bf16 v[80:83], v[228:231], v[112:115], v[80:83]
    ds_read_b64_tr_b16 v[244:245], v5 offset:33056
    v_mfma_f32_16x16x32_bf16 v[84:87], v[228:231], v[116:119], v[84:87]
    ds_read_b64_tr_b16 v[246:247], v5 offset:34080
    s_waitcnt vmcnt(13) lgkmcnt(6)
    v_mfma_f32_16x16x32_bf16 v[24:27], v[232:235], v[120:123], v[24:27]
    ds_read_b64_tr_b16 v[224:225], v4 offset:33280
    s_waitcnt vmcnt(12)
    v_mfma_f32_16x16x32_bf16 v[28:31], v[232:235], v[124:127], v[28:31]
    ds_read_b64_tr_b16 v[226:227], v4 offset:34304
    s_waitcnt lgkmcnt(6)
    v_mfma_f32_16x16x32_bf16 v[32:35], v[236:239], v[120:123], v[32:35]
    ds_read_b64_tr_b16 v[228:229], v5 offset:33312
    v_mfma_f32_16x16x32_bf16 v[36:39], v[236:239], v[124:127], v[36:39]
    ds_read_b64_tr_b16 v[230:231], v5 offset:34336
    s_waitcnt lgkmcnt(6)
    v_mfma_f32_16x16x32_bf16 v[40:43], v[240:243], v[120:123], v[40:43]
    ds_read_b64_tr_b16 v[232:233], v4 offset:33536
    v_mfma_f32_16x16x32_bf16 v[44:47], v[240:243], v[124:127], v[44:47]
    ds_read_b64_tr_b16 v[234:235], v4 offset:34560
    s_waitcnt lgkmcnt(6)
    v_mfma_f32_16x16x32_bf16 v[48:51], v[244:247], v[120:123], v[48:51]
    ds_read_b64_tr_b16 v[236:237], v5 offset:33568
    v_mfma_f32_16x16x32_bf16 v[52:55], v[244:247], v[124:127], v[52:55]
    ds_read_b64_tr_b16 v[238:239], v5 offset:34592
    s_waitcnt lgkmcnt(6)
    v_mfma_f32_16x16x32_bf16 v[56:59], v[224:227], v[120:123], v[56:59]
    ds_read_b64_tr_b16 v[240:241], v4 offset:40960
    v_mfma_f32_16x16x32_bf16 v[60:63], v[224:227], v[124:127], v[60:63]
    ds_read_b64_tr_b16 v[242:243], v4 offset:41984
    s_waitcnt lgkmcnt(6)
    v_mfma_f32_16x16x32_bf16 v[64:67], v[228:231], v[120:123], v[64:67]
    ds_read_b64_tr_b16 v[244:245], v5 offset:40992
    v_mfma_f32_16x16x32_bf16 v[68:71], v[228:231], v[124:127], v[68:71]
    ds_read_b64_tr_b16 v[246:247], v5 offset:42016
    s_waitcnt lgkmcnt(6)
    v_mfma_f32_16x16x32_bf16 v[72:75], v[232:235], v[120:123], v[72:75]
    ds_read_b64_tr_b16 v[224:225], v4 offset:41216
    v_mfma_f32_16x16x32_bf16 v[76:79], v[232:235], v[124:127], v[76:79]
    ds_read_b64_tr_b16 v[226:227], v4 offset:42240
    s_waitcnt lgkmcnt(6)
    v_mfma_f32_16x16x32_bf16 v[80:83], v[236:239], v[120:123], v[80:83]
    ds_read_b64_tr_b16 v[228:229], v5 offset:41248
    v_mfma_f32_16x16x32_bf16 v[84:87], v[236:239], v[124:127], v[84:87]
    ds_read_b64_tr_b16 v[230:231], v5 offset:42272
    s_waitcnt vmcnt(10) lgkmcnt(6)
    v_mfma_f32_16x16x32_bf16 v[24:27], v[240:243], v[128:131], v[24:27]
    ds_read_b64_tr_b16 v[232:233], v4 offset:41472
    s_waitcnt vmcnt(7)
    v_mfma_f32_16x16x32_bf16 v[28:31], v[240:243], v[132:135], v[28:31]
    ds_read_b64_tr_b16 v[234:235], v4 offset:42496
    s_waitcnt lgkmcnt(6)
    v_mfma_f32_16x16x32_bf16 v[32:35], v[244:247], v[128:131], v[32:35]
    ds_read_b64_tr_b16 v[236:237], v5 offset:41504
    v_mfma_f32_16x16x32_bf16 v[36:39], v[244:247], v[132:135], v[36:39]
    ds_read_b64_tr_b16 v[238:239], v5 offset:42528
    s_waitcnt lgkmcnt(6)
    v_mfma_f32_16x16x32_bf16 v[40:43], v[224:227], v[128:131], v[40:43]
    ds_read_b64_tr_b16 v[240:241], v4 offset:41728
    v_mfma_f32_16x16x32_bf16 v[44:47], v[224:227], v[132:135], v[44:47]
    ds_read_b64_tr_b16 v[242:243], v4 offset:42752
    s_waitcnt lgkmcnt(6)
    v_mfma_f32_16x16x32_bf16 v[48:51], v[228:231], v[128:131], v[48:51]
    ds_read_b64_tr_b16 v[244:245], v5 offset:41760
    v_mfma_f32_16x16x32_bf16 v[52:55], v[228:231], v[132:135], v[52:55]
    ds_read_b64_tr_b16 v[246:247], v5 offset:42784
    s_waitcnt lgkmcnt(6)
    v_mfma_f32_16x16x32_bf16 v[56:59], v[232:235], v[128:131], v[56:59]
    v_mfma_f32_16x16x32_bf16 v[60:63], v[232:235], v[132:135], v[60:63]
    s_waitcnt vmcnt(6)
    s_barrier
    ds_read_b64_tr_b16 v[224:225], v4 offset:49152
    ds_read_b64_tr_b16 v[226:227], v4 offset:50176
    s_waitcnt lgkmcnt(6)
    v_mfma_f32_16x16x32_bf16 v[64:67], v[236:239], v[128:131], v[64:67]
    ds_read_b64_tr_b16 v[228:229], v5 offset:49184
    v_mfma_f32_16x16x32_bf16 v[68:71], v[236:239], v[132:135], v[68:71]
    ds_read_b64_tr_b16 v[230:231], v5 offset:50208
    s_waitcnt lgkmcnt(6)
    v_mfma_f32_16x16x32_bf16 v[72:75], v[240:243], v[128:131], v[72:75]
    ds_read_b64_tr_b16 v[232:233], v4 offset:49408
    v_mfma_f32_16x16x32_bf16 v[76:79], v[240:243], v[132:135], v[76:79]
    ds_read_b64_tr_b16 v[234:235], v4 offset:50432
    s_waitcnt lgkmcnt(6)
    v_mfma_f32_16x16x32_bf16 v[80:83], v[244:247], v[128:131], v[80:83]
    ds_read_b64_tr_b16 v[236:237], v5 offset:49440
    v_mfma_f32_16x16x32_bf16 v[84:87], v[244:247], v[132:135], v[84:87]
    ds_read_b64_tr_b16 v[238:239], v5 offset:50464
    s_waitcnt vmcnt(5) lgkmcnt(6)
    v_mfma_f32_16x16x32_bf16 v[24:27], v[224:227], v[88:91], v[24:27]
    ds_read_b64_tr_b16 v[240:241], v4 offset:49664
    s_waitcnt vmcnt(4)
    v_mfma_f32_16x16x32_bf16 v[28:31], v[224:227], v[92:95], v[28:31]
    ds_read_b64_tr_b16 v[242:243], v4 offset:50688
    s_waitcnt lgkmcnt(6)
    v_mfma_f32_16x16x32_bf16 v[32:35], v[228:231], v[88:91], v[32:35]
    ds_read_b64_tr_b16 v[244:245], v5 offset:49696
    v_mfma_f32_16x16x32_bf16 v[36:39], v[228:231], v[92:95], v[36:39]
    ds_read_b64_tr_b16 v[246:247], v5 offset:50720
    s_waitcnt lgkmcnt(6)
    v_mfma_f32_16x16x32_bf16 v[40:43], v[232:235], v[88:91], v[40:43]
    ds_read_b64_tr_b16 v[224:225], v4 offset:49920
    v_mfma_f32_16x16x32_bf16 v[44:47], v[232:235], v[92:95], v[44:47]
    ds_read_b64_tr_b16 v[226:227], v4 offset:50944
    s_waitcnt lgkmcnt(6)
    v_mfma_f32_16x16x32_bf16 v[48:51], v[236:239], v[88:91], v[48:51]
    ds_read_b64_tr_b16 v[228:229], v5 offset:49952
    v_mfma_f32_16x16x32_bf16 v[52:55], v[236:239], v[92:95], v[52:55]
    ds_read_b64_tr_b16 v[230:231], v5 offset:50976
    s_waitcnt lgkmcnt(6)
    v_mfma_f32_16x16x32_bf16 v[56:59], v[240:243], v[88:91], v[56:59]
    ds_read_b64_tr_b16 v[232:233], v4 offset:57344
    v_mfma_f32_16x16x32_bf16 v[60:63], v[240:243], v[92:95], v[60:63]
    ds_read_b64_tr_b16 v[234:235], v4 offset:58368
    s_waitcnt lgkmcnt(6)
    v_mfma_f32_16x16x32_bf16 v[64:67], v[244:247], v[88:91], v[64:67]
    ds_read_b64_tr_b16 v[236:237], v5 offset:57376
    v_mfma_f32_16x16x32_bf16 v[68:71], v[244:247], v[92:95], v[68:71]
    ds_read_b64_tr_b16 v[238:239], v5 offset:58400
    s_waitcnt lgkmcnt(6)
    v_mfma_f32_16x16x32_bf16 v[72:75], v[224:227], v[88:91], v[72:75]
    ds_read_b64_tr_b16 v[240:241], v4 offset:57600
    v_mfma_f32_16x16x32_bf16 v[76:79], v[224:227], v[92:95], v[76:79]
    ds_read_b64_tr_b16 v[242:243], v4 offset:58624
    s_waitcnt lgkmcnt(6)
    v_mfma_f32_16x16x32_bf16 v[80:83], v[228:231], v[88:91], v[80:83]
    ds_read_b64_tr_b16 v[244:245], v5 offset:57632
    v_mfma_f32_16x16x32_bf16 v[84:87], v[228:231], v[92:95], v[84:87]
    ds_read_b64_tr_b16 v[246:247], v5 offset:58656
    s_waitcnt vmcnt(2) lgkmcnt(6)
    v_mfma_f32_16x16x32_bf16 v[24:27], v[232:235], v[96:99], v[24:27]
    ds_read_b64_tr_b16 v[224:225], v4 offset:57856
    s_waitcnt vmcnt(0)
    v_mfma_f32_16x16x32_bf16 v[28:31], v[232:235], v[100:103], v[28:31]
    ds_read_b64_tr_b16 v[226:227], v4 offset:58880
    s_waitcnt lgkmcnt(6)
    v_mfma_f32_16x16x32_bf16 v[32:35], v[236:239], v[96:99], v[32:35]
    ds_read_b64_tr_b16 v[228:229], v5 offset:57888
    v_mfma_f32_16x16x32_bf16 v[36:39], v[236:239], v[100:103], v[36:39]
    ds_read_b64_tr_b16 v[230:231], v5 offset:58912
    s_waitcnt lgkmcnt(6)
    v_mfma_f32_16x16x32_bf16 v[40:43], v[240:243], v[96:99], v[40:43]
    ds_read_b64_tr_b16 v[232:233], v4 offset:58112
    v_mfma_f32_16x16x32_bf16 v[44:47], v[240:243], v[100:103], v[44:47]
    ds_read_b64_tr_b16 v[234:235], v4 offset:59136
    s_waitcnt lgkmcnt(6)
    v_mfma_f32_16x16x32_bf16 v[48:51], v[244:247], v[96:99], v[48:51]
    ds_read_b64_tr_b16 v[236:237], v5 offset:58144
    v_mfma_f32_16x16x32_bf16 v[52:55], v[244:247], v[100:103], v[52:55]
    ds_read_b64_tr_b16 v[238:239], v5 offset:59168
    s_waitcnt lgkmcnt(6)
    v_mfma_f32_16x16x32_bf16 v[56:59], v[224:227], v[96:99], v[56:59]
    v_mfma_f32_16x16x32_bf16 v[60:63], v[224:227], v[100:103], v[60:63]
    s_waitcnt lgkmcnt(4)
    v_mfma_f32_16x16x32_bf16 v[64:67], v[228:231], v[96:99], v[64:67]
    v_mfma_f32_16x16x32_bf16 v[68:71], v[228:231], v[100:103], v[68:71]
    s_waitcnt lgkmcnt(2)
    v_mfma_f32_16x16x32_bf16 v[72:75], v[232:235], v[96:99], v[72:75]
    v_mfma_f32_16x16x32_bf16 v[76:79], v[232:235], v[100:103], v[76:79]
    s_waitcnt lgkmcnt(0)
    v_mfma_f32_16x16x32_bf16 v[80:83], v[236:239], v[96:99], v[80:83]
    v_mfma_f32_16x16x32_bf16 v[84:87], v[236:239], v[100:103], v[84:87]
    s_mov_b32 s23, 0x3e0293ee
    v_mul_f32 v16, s23, v24
    v_mul_f32 v17, s23, v25
    v_cvt_pk_bf16_f32 v152, v16, v17
    v_mul_f32 v18, s23, v26
    v_mul_f32 v19, s23, v27
    v_cvt_pk_bf16_f32 v153, v18, v19
    v_mul_f32 v16, s23, v28
    v_mul_f32 v17, s23, v29
    v_cvt_pk_bf16_f32 v168, v16, v17
    v_mul_f32 v18, s23, v30
    v_mul_f32 v19, s23, v31
    v_cvt_pk_bf16_f32 v169, v18, v19
    v_mul_f32 v16, s23, v32
    v_mul_f32 v17, s23, v33
    v_cvt_pk_bf16_f32 v154, v16, v17
    v_mul_f32 v18, s23, v34
    v_mul_f32 v19, s23, v35
    v_cvt_pk_bf16_f32 v155, v18, v19
    v_mul_f32 v16, s23, v36
    v_mul_f32 v17, s23, v37
    v_cvt_pk_bf16_f32 v170, v16, v17
    v_mul_f32 v18, s23, v38
    v_mul_f32 v19, s23, v39
    v_cvt_pk_bf16_f32 v171, v18, v19
    v_mul_f32 v16, s23, v40
    v_mul_f32 v17, s23, v41
    v_cvt_pk_bf16_f32 v156, v16, v17
    v_mul_f32 v18, s23, v42
    v_mul_f32 v19, s23, v43
    v_cvt_pk_bf16_f32 v157, v18, v19
    v_mul_f32 v16, s23, v44
    v_mul_f32 v17, s23, v45
    v_cvt_pk_bf16_f32 v172, v16, v17
    v_mul_f32 v18, s23, v46
    v_mul_f32 v19, s23, v47
    v_cvt_pk_bf16_f32 v173, v18, v19
    v_mul_f32 v16, s23, v48
    v_mul_f32 v17, s23, v49
    v_cvt_pk_bf16_f32 v158, v16, v17
    v_mul_f32 v18, s23, v50
    v_mul_f32 v19, s23, v51
    v_cvt_pk_bf16_f32 v159, v18, v19
    v_mul_f32 v16, s23, v52
    v_mul_f32 v17, s23, v53
    v_cvt_pk_bf16_f32 v174, v16, v17
    v_mul_f32 v18, s23, v54
    v_mul_f32 v19, s23, v55
    v_cvt_pk_bf16_f32 v175, v18, v19
    v_mul_f32 v16, s23, v56
    v_mul_f32 v17, s23, v57
    v_cvt_pk_bf16_f32 v160, v16, v17
    v_mul_f32 v18, s23, v58
    v_mul_f32 v19, s23, v59
    v_cvt_pk_bf16_f32 v161, v18, v19
    v_mul_f32 v16, s23, v60
    v_mul_f32 v17, s23, v61
    v_cvt_pk_bf16_f32 v176, v16, v17
    v_mul_f32 v18, s23, v62
    v_mul_f32 v19, s23, v63
    v_cvt_pk_bf16_f32 v177, v18, v19
    v_mul_f32 v16, s23, v64
    v_mul_f32 v17, s23, v65
    v_cvt_pk_bf16_f32 v162, v16, v17
    v_mul_f32 v18, s23, v66
    v_mul_f32 v19, s23, v67
    v_cvt_pk_bf16_f32 v163, v18, v19
    v_mul_f32 v16, s23, v68
    v_mul_f32 v17, s23, v69
    v_cvt_pk_bf16_f32 v178, v16, v17
    v_mul_f32 v18, s23, v70
    v_mul_f32 v19, s23, v71
    v_cvt_pk_bf16_f32 v179, v18, v19
    v_mul_f32 v16, s23, v72
    v_mul_f32 v17, s23, v73
    v_cvt_pk_bf16_f32 v164, v16, v17
    v_mul_f32 v18, s23, v74
    v_mul_f32 v19, s23, v75
    v_cvt_pk_bf16_f32 v165, v18, v19
    v_mul_f32 v16, s23, v76
    v_mul_f32 v17, s23, v77
    v_cvt_pk_bf16_f32 v180, v16, v17
    v_mul_f32 v18, s23, v78
    v_mul_f32 v19, s23, v79
    v_cvt_pk_bf16_f32 v181, v18, v19
    v_mul_f32 v16, s23, v80
    v_mul_f32 v17, s23, v81
    v_cvt_pk_bf16_f32 v166, v16, v17
    v_mul_f32 v18, s23, v82
    v_mul_f32 v19, s23, v83
    v_cvt_pk_bf16_f32 v167, v18, v19
    v_mul_f32 v16, s23, v84
    v_mul_f32 v17, s23, v85
    v_cvt_pk_bf16_f32 v182, v16, v17
    v_mul_f32 v18, s23, v86
    v_mul_f32 v19, s23, v87
    v_cvt_pk_bf16_f32 v183, v18, v19
    v_add_u32 v4, 0x10000, v2
    v_add_u32 v5, 0x20000, v2
    s_barrier
    ds_read_b128 v[224:227], v4 offset:0
    ds_read_b128 v[228:231], v4 offset:1024
    ds_read_b128 v[232:235], v4 offset:2048
    ds_read_b128 v[236:239], v4 offset:3072
    s_waitcnt lgkmcnt(3)
    v_mfma_f32_16x16x32_bf16 v[184:187], v[224:227], v[152:155], 0
    v_mfma_f32_16x16x32_bf16 v[188:191], v[224:227], v[168:171], 0
    ds_read_b128 v[240:243], v4 offset:4096
    s_and_b32 s29, s2, 7
    s_mul_i32 s29, s29, 28
    s_lshr_b32 s16, s2, 3
    s_add_u32 s29, s29, s16
    s_waitcnt lgkmcnt(3)
    v_mfma_f32_16x16x32_bf16 v[192:195], v[228:231], v[152:155], 0
    s_add_u32 s22, s21, 0x10000
    s_add_u32 m0, s20, 0x20000
    s_nop 0
    buffer_load_dwordx4 v2, s[8:11], s22 offen sc1 lds
    v_mfma_f32_16x16x32_bf16 v[196:199], v[228:231], v[168:171], 0
    ds_read_b128 v[244:247], v4 offset:5120
    s_waitcnt lgkmcnt(3)
    v_mfma_f32_16x16x32_bf16 v[184:187], v[232:235], v[156:159], v[184:187]
    v_mfma_f32_16x16x32_bf16 v[188:191], v[232:235], v[172:175], v[188:191]
    ds_read_b128 v[224:227], v4 offset:6144
    s_waitcnt lgkmcnt(3)
    v_mfma_f32_16x16x32_bf16 v[192:195], v[236:239], v[156:159], v[192:195]
    v_mfma_f32_16x16x32_bf16 v[196:199], v[236:239], v[172:175], v[196:199]
    ds_read_b128 v[228:231], v4 offset:7168
    s_waitcnt lgkmcnt(3)
    v_mfma_f32_16x16x32_bf16 v[184:187], v[240:243], v[160:163], v[184:187]
    v_mfma_f32_16x16x32_bf16 v[188:191], v[240:243], v[176:179], v[188:191]
    ds_read_b128 v[232:235], v4 offset:8192
    s_waitcnt lgkmcnt(3)
    v_mfma_f32_16x16x32_bf16 v[192:195], v[244:247], v[160:163], v[192:195]
    s_add_u32 s22, s21, 0x10400
    s_add_u32 m0, s20, 0x20400
    s_nop 0
    buffer_load_dwordx4 v2, s[8:11], s22 offen sc1 lds
    v_mfma_f32_16x16x32_bf16 v[196:199], v[244:247], v[176:179], v[196:199]
    ds_read_b128 v[236:239], v4 offset:9216
    s_waitcnt lgkmcnt(3)
    v_mfma_f32_16x16x32_bf16 v[184:187], v[224:227], v[164:167], v[184:187]
    v_mfma_f32_16x16x32_bf16 v[188:191], v[224:227], v[180:183], v[188:191]
    ds_read_b128 v[240:243], v4 offset:10240
    s_waitcnt lgkmcnt(3)
    v_mfma_f32_16x16x32_bf16 v[192:195], v[228:231], v[164:167], v[192:195]
    v_mfma_f32_16x16x32_bf16 v[196:199], v[228:231], v[180:183], v[196:199]
    ds_read_b128 v[244:247], v4 offset:11264
    s_waitcnt lgkmcnt(3)
    v_mfma_f32_16x16x32_bf16 v[200:203], v[232:235], v[152:155], 0
    v_mfma_f32_16x16x32_bf16 v[204:207], v[232:235], v[168:171], 0
    ds_read_b128 v[224:227], v4 offset:12288
    s_waitcnt lgkmcnt(3)
    v_mfma_f32_16x16x32_bf16 v[208:211], v[236:239], v[152:155], 0
    v_mfma_f32_16x16x32_bf16 v[212:215], v[236:239], v[168:171], 0
    ds_read_b128 v[228:231], v4 offset:13312
    s_waitcnt lgkmcnt(3)
    v_mfma_f32_16x16x32_bf16 v[200:203], v[240:243], v[156:159], v[200:203]
    v_mfma_f32_16x16x32_bf16 v[204:207], v[240:243], v[172:175], v[204:207]
    ds_read_b128 v[232:235], v4 offset:14336
    s_waitcnt lgkmcnt(3)
    v_mfma_f32_16x16x32_bf16 v[208:211], v[244:247], v[156:159], v[208:211]
    v_max3_f32 v16, v184, v185, v186
    v_mfma_f32_16x16x32_bf16 v[212:215], v[244:247], v[172:175], v[212:215]
    ds_read_b128 v[236:239], v4 offset:15360
    v_max3_f32 v16, v16, v187, v192
    s_waitcnt lgkmcnt(3)
    v_mfma_f32_16x16x32_bf16 v[200:203], v[224:227], v[160:163], v[200:203]
    v_max3_f32 v16, v16, v193, v194
    v_mfma_f32_16x16x32_bf16 v[204:207], v[224:227], v[176:179], v[204:207]
    s_barrier
    ds_read_b128 v[240:243], v4 offset:16384
    v_max_f32 v16, v16, v195
    s_waitcnt lgkmcnt(3)
    v_mfma_f32_16x16x32_bf16 v[208:211], v[228:231], v[160:163], v[208:211]
    v_max3_f32 v17, v188, v189, v190
    v_mfma_f32_16x16x32_bf16 v[212:215], v[228:231], v[176:179], v[212:215]
    s_add_u32 s22, s21, 0x14000
    s_add_u32 m0, s20, 0x24000
    s_nop 0
    buffer_load_dwordx4 v2, s[8:11], s22 offen sc1 lds
    ds_read_b128 v[244:247], v4 offset:17408
    v_max3_f32 v17, v17, v191, v196
    s_waitcnt lgkmcnt(3)
    v_mfma_f32_16x16x32_bf16 v[200:203], v[232:235], v[164:167], v[200:203]
    v_max3_f32 v17, v17, v197, v198
    v_mfma_f32_16x16x32_bf16 v[204:207], v[232:235], v[180:183], v[204:207]
    ds_read_b128 v[224:227], v4 offset:18432
    v_max_f32 v17, v17, v199
    s_waitcnt lgkmcnt(3)
    v_mfma_f32_16x16x32_bf16 v[208:211], v[236:239], v[164:167], v[208:211]
    v_mfma_f32_16x16x32_bf16 v[212:215], v[236:239], v[180:183], v[212:215]
    ds_read_b128 v[228:231], v4 offset:19456
    v_max3_f32 v16, v16, v200, v201
    v_max3_f32 v16, v16, v202, v203
    s_nop 3
    v_max3_f32 v16, v16, v208, v209
    v_max3_f32 v16, v16, v210, v211
    v_max3_f32 v17, v17, v204, v205
    v_max3_f32 v17, v17, v206, v207
    v_max3_f32 v17, v17, v212, v213
    v_max3_f32 v17, v17, v214, v215
    v_mov_b32 v18, v16
    v_mov_b32 v19, v17
    s_nop 0
    v_permlane16_swap_b32 v16, v18
    v_permlane16_swap_b32 v17, v19
    v_max_f32 v16, v16, v18
    v_max_f32 v17, v17, v19
    v_mov_b32 v18, v16
    v_mov_b32 v19, v17
    s_nop 0
    v_permlane32_swap_b32 v16, v18
    v_permlane32_swap_b32 v17, v19
    v_max_f32 v16, v16, v18
    v_max_f32 v17, v17, v19
    v_sub_f32 v216, 0, v16
    v_sub_f32 v217, 0, v16
    v_sub_f32 v218, 0, v16
    v_sub_f32 v219, 0, v16
    v_sub_f32 v220, 0, v17
    v_sub_f32 v221, 0, v17
    v_sub_f32 v222, 0, v17
    v_sub_f32 v223, 0, v17
    v_add_f32 v184, v184, v216
    v_add_f32 v185, v185, v216
    v_exp_f32 v184, v184
    v_exp_f32 v185, v185
    s_nop 0
    v_add_f32 v9, v184, v185
    v_cvt_pk_bf16_f32 v24, v184, v185
    v_add_f32 v186, v186, v216
    v_add_f32 v187, v187, v216
    v_exp_f32 v186, v186
    v_exp_f32 v187, v187
    v_add_f32 v9, v9, v186
    v_add_f32 v9, v9, v187
    v_cvt_pk_bf16_f32 v25, v186, v187
    v_add_f32 v188, v188, v220
    v_add_f32 v189, v189, v220
    v_exp_f32 v188, v188
    v_exp_f32 v189, v189
    s_nop 0
    v_add_f32 v10, v188, v189
    v_cvt_pk_bf16_f32 v28, v188, v189
    v_add_f32 v190, v190, v220
    v_add_f32 v191, v191, v220
    v_exp_f32 v190, v190
    v_exp_f32 v191, v191
    v_add_f32 v10, v10, v190
    v_add_f32 v10, v10, v191
    v_cvt_pk_bf16_f32 v29, v190, v191
    v_add_f32 v192, v192, v216
    v_add_f32 v193, v193, v216
    v_exp_f32 v192, v192
    v_exp_f32 v193, v193
    v_add_f32 v9, v9, v192
    v_add_f32 v9, v9, v193
    v_cvt_pk_bf16_f32 v26, v192, v193
    v_add_f32 v194, v194, v216
    v_add_f32 v195, v195, v216
    v_exp_f32 v194, v194
    v_exp_f32 v195, v195
    v_add_f32 v9, v9, v194
    v_add_f32 v9, v9, v195
    v_cvt_pk_bf16_f32 v27, v194, v195
    v_add_f32 v196, v196, v220
    v_add_f32 v197, v197, v220
    v_exp_f32 v196, v196
    v_exp_f32 v197, v197
    v_add_f32 v10, v10, v196
    v_add_f32 v10, v10, v197
    v_cvt_pk_bf16_f32 v30, v196, v197
    v_add_f32 v198, v198, v220
    v_add_f32 v199, v199, v220
    v_exp_f32 v198, v198
    v_exp_f32 v199, v199
    v_add_f32 v10, v10, v198
    v_add_f32 v10, v10, v199
    v_cvt_pk_bf16_f32 v31, v198, v199
    s_waitcnt lgkmcnt(3)
    v_mfma_f32_16x16x32_bf16 v[184:187], v[240:243], v[152:155], v[216:219]
    v_mfma_f32_16x16x32_bf16 v[188:191], v[240:243], v[168:171], v[220:223]
    ds_read_b128 v[232:235], v4 offset:20480
    v_add_f32 v200, v200, v216
    v_add_f32 v201, v201, v216
    v_exp_f32 v200, v200
    v_exp_f32 v201, v201
    s_waitcnt lgkmcnt(3)
    v_mfma_f32_16x16x32_bf16 v[192:195], v[244:247], v[152:155], v[216:219]
    v_add_f32 v9, v9, v200
    v_add_f32 v9, v9, v201
    v_cvt_pk_bf16_f32 v32, v200, v201
    v_add_f32 v202, v202, v216
    v_mfma_f32_16x16x32_bf16 v[196:199], v[244:247], v[168:171], v[220:223]
    s_add_u32 s22, s21, 0x14400
    s_add_u32 m0, s20, 0x24400
    s_nop 0
    buffer_load_dwordx4 v2, s[8:11], s22 offen sc1 lds
    ds_read_b128 v[236:239], v4 offset:21504
    v_add_f32 v203, v203, v216
    v_exp_f32 v202, v202
    v_exp_f32 v203, v203
    v_add_f32 v9, v9, v202
    s_waitcnt lgkmcnt(3)
    v_mfma_f32_16x16x32_bf16 v[184:187], v[224:227], v[156:159], v[184:187]
    v_add_f32 v9, v9, v203
    v_cvt_pk_bf16_f32 v33, v202, v203
    v_add_f32 v204, v204, v220
    v_mfma_f32_16x16x32_bf16 v[188:191], v[224:227], v[172:175], v[188:191]
    ds_read_b128 v[240:243], v4 offset:22528
    v_add_f32 v205, v205, v220
    v_exp_f32 v204, v204
    v_exp_f32 v205, v205
    v_add_f32 v10, v10, v204
    s_mov_b64 s[4:5], s[40:41]
    s_mov_b32 s6, 0x800000
    s_mov_b32 s7, 0x20000
    v_bfe_u32 v20, v1, 2, 2
    v_lshlrev_b32 v21, 13, v20
    v_sub_u32 v3, v3, v21
    v_lshl_add_u32 v3, v20, 11, v3
    s_and_b32 s16, s2, 1
    s_lshl_b32 s24, s16, 22
    s_lshr_b32 s16, s2, 5
    s_lshl_b32 s16, s16, 8
    s_add_u32 s24, s24, s16
    s_lshl_b32 s16, s3, 14
    s_add_u32 s24, s24, s16
    s_waitcnt lgkmcnt(3)
    v_mfma_f32_16x16x32_bf16 v[192:195], v[228:231], v[156:159], v[192:195]
    v_add_f32 v10, v10, v205
    v_cvt_pk_bf16_f32 v36, v204, v205
    v_add_f32 v206, v206, v220
    v_add_f32 v207, v207, v220
    v_mfma_f32_16x16x32_bf16 v[196:199], v[228:231], v[172:175], v[196:199]
    ds_read_b128 v[244:247], v4 offset:23552
    v_exp_f32 v206, v206
    v_exp_f32 v207, v207
    v_add_f32 v10, v10, v206
    v_add_f32 v10, v10, v207
    s_waitcnt lgkmcnt(3)
    v_mfma_f32_16x16x32_bf16 v[184:187], v[232:235], v[160:163], v[184:187]
    v_cvt_pk_bf16_f32 v37, v206, v207
    v_add_f32 v208, v208, v216
    v_add_f32 v209, v209, v216
    v_mfma_f32_16x16x32_bf16 v[188:191], v[232:235], v[176:179], v[188:191]
    ds_read_b128 v[224:227], v4 offset:24576
    v_exp_f32 v208, v208
    v_exp_f32 v209, v209
    v_add_f32 v9, v9, v208
    v_add_f32 v9, v9, v209
    s_waitcnt lgkmcnt(3)
    v_mfma_f32_16x16x32_bf16 v[192:195], v[236:239], v[160:163], v[192:195]
    v_cvt_pk_bf16_f32 v34, v208, v209
    v_add_f32 v210, v210, v216
    v_add_f32 v211, v211, v216
    v_exp_f32 v210, v210
    v_mfma_f32_16x16x32_bf16 v[196:199], v[236:239], v[176:179], v[196:199]
    ds_read_b128 v[228:231], v4 offset:25600
    v_exp_f32 v211, v211
    v_add_f32 v9, v9, v210
    v_add_f32 v9, v9, v211
    v_cvt_pk_bf16_f32 v35, v210, v211
    s_waitcnt lgkmcnt(3)
    v_mfma_f32_16x16x32_bf16 v[184:187], v[240:243], v[164:167], v[184:187]
    v_add_f32 v212, v212, v220
    v_add_f32 v213, v213, v220
    v_exp_f32 v212, v212
    v_mfma_f32_16x16x32_bf16 v[188:191], v[240:243], v[180:183], v[188:191]
    ds_read_b128 v[232:235], v4 offset:26624
    v_exp_f32 v213, v213
    v_add_f32 v10, v10, v212
    v_add_f32 v10, v10, v213
    v_cvt_pk_bf16_f32 v38, v212, v213
    s_waitcnt lgkmcnt(3)
    v_mfma_f32_16x16x32_bf16 v[192:195], v[244:247], v[164:167], v[192:195]
    v_add_f32 v214, v214, v220
    v_add_f32 v215, v215, v220
    v_exp_f32 v214, v214
    v_exp_f32 v215, v215
    v_mfma_f32_16x16x32_bf16 v[196:199], v[244:247], v[180:183], v[196:199]
    ds_read_b128 v[236:239], v4 offset:27648
    v_add_f32 v10, v10, v214
    v_add_f32 v10, v10, v215
    v_cvt_pk_bf16_f32 v39, v214, v215
    s_waitcnt lgkmcnt(3)
    v_mfma_f32_16x16x32_bf16 v[200:203], v[224:227], v[152:155], v[216:219]
    v_mfma_f32_16x16x32_bf16 v[204:207], v[224:227], v[168:171], v[220:223]
    ds_read_b128 v[240:243], v4 offset:28672
    v_exp_f32 v184, v184
    v_exp_f32 v185, v185
    v_add_f32 v9, v9, v184
    s_waitcnt lgkmcnt(3)
    v_mfma_f32_16x16x32_bf16 v[208:211], v[228:231], v[152:155], v[216:219]
    v_add_f32 v9, v9, v185
    v_cvt_pk_bf16_f32 v40, v184, v185
    v_exp_f32 v186, v186
    v_mfma_f32_16x16x32_bf16 v[212:215], v[228:231], v[168:171], v[220:223]
    ds_read_b128 v[244:247], v4 offset:29696
    v_exp_f32 v187, v187
    v_add_f32 v9, v9, v186
    s_waitcnt lgkmcnt(3)
    v_mfma_f32_16x16x32_bf16 v[200:203], v[232:235], v[156:159], v[200:203]
    v_add_f32 v9, v9, v187
    v_cvt_pk_bf16_f32 v41, v186, v187
    v_exp_f32 v188, v188
    v_mfma_f32_16x16x32_bf16 v[204:207], v[232:235], v[172:175], v[204:207]
    ds_read_b128 v[224:227], v4 offset:30720
    v_exp_f32 v189, v189
    v_add_f32 v10, v10, v188
    v_add_f32 v10, v10, v189
    s_waitcnt lgkmcnt(3)
    v_mfma_f32_16x16x32_bf16 v[208:211], v[236:239], v[156:159], v[208:211]
    v_cvt_pk_bf16_f32 v44, v188, v189
    v_exp_f32 v190, v190
    v_mfma_f32_16x16x32_bf16 v[212:215], v[236:239], v[172:175], v[212:215]
    ds_read_b128 v[228:231], v4 offset:31744
    v_exp_f32 v191, v191
    v_add_f32 v10, v10, v190
    v_add_f32 v10, v10, v191
    s_waitcnt lgkmcnt(3)
    v_mfma_f32_16x16x32_bf16 v[200:203], v[240:243], v[160:163], v[200:203]
    v_cvt_pk_bf16_f32 v45, v190, v191
    v_exp_f32 v192, v192
    v_exp_f32 v193, v193
    v_mfma_f32_16x16x32_bf16 v[204:207], v[240:243], v[176:179], v[204:207]
    s_barrier
    ds_read_b128 v[232:235], v4 offset:32768
    v_add_f32 v9, v9, v192
    v_add_f32 v9, v9, v193
    s_waitcnt lgkmcnt(3)
    v_mfma_f32_16x16x32_bf16 v[208:211], v[244:247], v[160:163], v[208:211]
    v_cvt_pk_bf16_f32 v42, v192, v193
    v_exp_f32 v194, v194
    v_exp_f32 v195, v195
    v_mfma_f32_16x16x32_bf16 v[212:215], v[244:247], v[176:179], v[212:215]
    s_add_u32 s22, s21, 0x18000
    s_add_u32 m0, s20, 0x10000
    s_nop 0
    buffer_load_dwordx4 v2, s[8:11], s22 offen sc1 lds
    ds_read_b128 v[236:239], v4 offset:33792
    v_add_f32 v9, v9, v194
    v_add_f32 v9, v9, v195
    v_cvt_pk_bf16_f32 v43, v194, v195
    s_waitcnt lgkmcnt(3)
    v_mfma_f32_16x16x32_bf16 v[200:203], v[224:227], v[164:167], v[200:203]
    v_exp_f32 v196, v196
    v_exp_f32 v197, v197
    v_mfma_f32_16x16x32_bf16 v[204:207], v[224:227], v[180:183], v[204:207]
    ds_read_b128 v[240:243], v4 offset:34816
    v_add_f32 v10, v10, v196
    v_add_f32 v10, v10, v197
    v_cvt_pk_bf16_f32 v46, v196, v197
    s_waitcnt lgkmcnt(3)
    v_mfma_f32_16x16x32_bf16 v[208:211], v[228:231], v[164:167], v[208:211]
    v_exp_f32 v198, v198
    v_exp_f32 v199, v199
    v_add_f32 v10, v10, v198
    v_mfma_f32_16x16x32_bf16 v[212:215], v[228:231], v[180:183], v[212:215]
    ds_read_b128 v[244:247], v4 offset:35840
    v_add_f32 v10, v10, v199
    v_cvt_pk_bf16_f32 v47, v198, v199
    s_waitcnt lgkmcnt(3)
    v_mfma_f32_16x16x32_bf16 v[184:187], v[232:235], v[152:155], v[216:219]
    v_mfma_f32_16x16x32_bf16 v[188:191], v[232:235], v[168:171], v[220:223]
    ds_read_b128 v[224:227], v4 offset:36864
    v_exp_f32 v200, v200
    v_exp_f32 v201, v201
    v_add_f32 v9, v9, v200
    s_waitcnt lgkmcnt(3)
    v_mfma_f32_16x16x32_bf16 v[192:195], v[236:239], v[152:155], v[216:219]
    v_add_f32 v9, v9, v201
    v_cvt_pk_bf16_f32 v48, v200, v201
    v_exp_f32 v202, v202
    v_mfma_f32_16x16x32_bf16 v[196:199], v[236:239], v[168:171], v[220:223]
    s_add_u32 s22, s21, 0x18400
    s_add_u32 m0, s20, 0x10400
    s_nop 0
    buffer_load_dwordx4 v2, s[8:11], s22 offen sc1 lds
    ds_read_b128 v[228:231], v4 offset:37888
    v_exp_f32 v203, v203
    v_add_f32 v9, v9, v202
    s_waitcnt lgkmcnt(3)
    v_mfma_f32_16x16x32_bf16 v[184:187], v[240:243], v[156:159], v[184:187]
    v_add_f32 v9, v9, v203
    v_cvt_pk_bf16_f32 v49, v202, v203
    v_exp_f32 v204, v204
    v_mfma_f32_16x16x32_bf16 v[188:191], v[240:243], v[172:175], v[188:191]
    ds_read_b128 v[232:235], v4 offset:38912
    v_exp_f32 v205, v205
    v_add_f32 v10, v10, v204
    v_add_f32 v10, v10, v205
    s_waitcnt lgkmcnt(3)
    v_mfma_f32_16x16x32_bf16 v[192:195], v[244:247], v[156:159], v[192:195]
    v_cvt_pk_bf16_f32 v52, v204, v205
    v_exp_f32 v206, v206
    v_mfma_f32_16x16x32_bf16 v[196:199], v[244:247], v[172:175], v[196:199]
    ds_read_b128 v[236:239], v4 offset:39936
    v_exp_f32 v207, v207
    v_add_f32 v10, v10, v206
    v_add_f32 v10, v10, v207
    s_waitcnt lgkmcnt(3)
    v_mfma_f32_16x16x32_bf16 v[184:187], v[224:227], v[160:163], v[184:187]
    v_cvt_pk_bf16_f32 v53, v206, v207
    v_exp_f32 v208, v208
    v_exp_f32 v209, v209
    v_mfma_f32_16x16x32_bf16 v[188:191], v[224:227], v[176:179], v[188:191]
    ds_read_b128 v[240:243], v4 offset:40960
    v_add_f32 v9, v9, v208
    v_add_f32 v9, v9, v209
    s_waitcnt lgkmcnt(3)
    v_mfma_f32_16x16x32_bf16 v[192:195], v[228:231], v[160:163], v[192:195]
    v_cvt_pk_bf16_f32 v50, v208, v209
    v_exp_f32 v210, v210
    v_exp_f32 v211, v211
    v_mfma_f32_16x16x32_bf16 v[196:199], v[228:231], v[176:179], v[196:199]
    ds_read_b128 v[244:247], v4 offset:41984
    v_add_f32 v9, v9, v210
    v_add_f32 v9, v9, v211
    v_cvt_pk_bf16_f32 v51, v210, v211
    s_waitcnt lgkmcnt(3)
    v_mfma_f32_16x16x32_bf16 v[184:187], v[232:235], v[164:167], v[184:187]
    v_exp_f32 v212, v212
    v_exp_f32 v213, v213
    v_mfma_f32_16x16x32_bf16 v[188:191], v[232:235], v[180:183], v[188:191]
    ds_read_b128 v[224:227], v4 offset:43008
    v_add_f32 v10, v10, v212
    v_add_f32 v10, v10, v213
    v_cvt_pk_bf16_f32 v54, v212, v213
    s_waitcnt lgkmcnt(3)
    v_mfma_f32_16x16x32_bf16 v[192:195], v[236:239], v[164:167], v[192:195]
    v_exp_f32 v214, v214
    v_exp_f32 v215, v215
    v_add_f32 v10, v10, v214
    v_mfma_f32_16x16x32_bf16 v[196:199], v[236:239], v[180:183], v[196:199]
    ds_read_b128 v[228:231], v4 offset:44032
    v_add_f32 v10, v10, v215
    v_cvt_pk_bf16_f32 v55, v214, v215
    s_waitcnt lgkmcnt(3)
    v_mfma_f32_16x16x32_bf16 v[200:203], v[240:243], v[152:155], v[216:219]
    v_mfma_f32_16x16x32_bf16 v[204:207], v[240:243], v[168:171], v[220:223]
    ds_read_b128 v[232:235], v4 offset:45056
    v_exp_f32 v184, v184
    v_exp_f32 v185, v185
    v_add_f32 v9, v9, v184
    s_waitcnt lgkmcnt(3)
    v_mfma_f32_16x16x32_bf16 v[208:211], v[244:247], v[152:155], v[216:219]
    v_add_f32 v9, v9, v185
    v_cvt_pk_bf16_f32 v56, v184, v185
    v_exp_f32 v186, v186
    v_mfma_f32_16x16x32_bf16 v[212:215], v[244:247], v[168:171], v[220:223]
    ds_read_b128 v[236:239], v4 offset:46080
    v_exp_f32 v187, v187
    v_add_f32 v9, v9, v186
    s_waitcnt lgkmcnt(3)
    v_mfma_f32_16x16x32_bf16 v[200:203], v[224:227], v[156:159], v[200:203]
    v_add_f32 v9, v9, v187
    v_cvt_pk_bf16_f32 v57, v186, v187
    v_exp_f32 v188, v188
    v_mfma_f32_16x16x32_bf16 v[204:207], v[224:227], v[172:175], v[204:207]
    ds_read_b128 v[240:243], v4 offset:47104
    v_exp_f32 v189, v189
    v_add_f32 v10, v10, v188
    v_add_f32 v10, v10, v189
    s_waitcnt lgkmcnt(3)
    v_mfma_f32_16x16x32_bf16 v[208:211], v[228:231], v[156:159], v[208:211]
    v_cvt_pk_bf16_f32 v60, v188, v189
    v_exp_f32 v190, v190
    v_mfma_f32_16x16x32_bf16 v[212:215], v[228:231], v[172:175], v[212:215]
    ds_read_b128 v[244:247], v4 offset:48128
    v_exp_f32 v191, v191
    v_add_f32 v10, v10, v190
    v_add_f32 v10, v10, v191
    s_waitcnt lgkmcnt(3)
    v_mfma_f32_16x16x32_bf16 v[200:203], v[232:235], v[160:163], v[200:203]
    v_cvt_pk_bf16_f32 v61, v190, v191
    v_exp_f32 v192, v192
    v_exp_f32 v193, v193
    v_mfma_f32_16x16x32_bf16 v[204:207], v[232:235], v[176:179], v[204:207]
    s_barrier
    ds_read_b128 v[224:227], v4 offset:49152
    v_add_f32 v9, v9, v192
    v_add_f32 v9, v9, v193
    s_waitcnt lgkmcnt(3)
    v_mfma_f32_16x16x32_bf16 v[208:211], v[236:239], v[160:163], v[208:211]
    v_cvt_pk_bf16_f32 v58, v192, v193
    v_exp_f32 v194, v194
    v_exp_f32 v195, v195
    v_mfma_f32_16x16x32_bf16 v[212:215], v[236:239], v[176:179], v[212:215]
    s_add_u32 s22, s21, 0x1c000
    s_add_u32 m0, s20, 0x14000
    s_nop 0
    buffer_load_dwordx4 v2, s[8:11], s22 offen sc1 lds
    ds_read_b128 v[228:231], v4 offset:50176
    v_add_f32 v9, v9, v194
    v_add_f32 v9, v9, v195
    v_cvt_pk_bf16_f32 v59, v194, v195
    s_waitcnt lgkmcnt(3)
    v_mfma_f32_16x16x32_bf16 v[200:203], v[240:243], v[164:167], v[200:203]
    v_exp_f32 v196, v196
    v_exp_f32 v197, v197
    v_mfma_f32_16x16x32_bf16 v[204:207], v[240:243], v[180:183], v[204:207]
    ds_read_b128 v[232:235], v4 offset:51200
    v_add_f32 v10, v10, v196
    v_add_f32 v10, v10, v197
    v_cvt_pk_bf16_f32 v62, v196, v197
    s_waitcnt lgkmcnt(3)
    v_mfma_f32_16x16x32_bf16 v[208:211], v[244:247], v[164:167], v[208:211]
    v_exp_f32 v198, v198
    v_exp_f32 v199, v199
    v_add_f32 v10, v10, v198
    v_mfma_f32_16x16x32_bf16 v[212:215], v[244:247], v[180:183], v[212:215]
    ds_read_b128 v[236:239], v4 offset:52224
    v_add_f32 v10, v10, v199
    v_cvt_pk_bf16_f32 v63, v198, v199
    s_waitcnt lgkmcnt(3)
    v_mfma_f32_16x16x32_bf16 v[184:187], v[224:227], v[152:155], v[216:219]
    v_mfma_f32_16x16x32_bf16 v[188:191], v[224:227], v[168:171], v[220:223]
    ds_read_b128 v[240:243], v4 offset:53248
    v_exp_f32 v200, v200
    v_exp_f32 v201, v201
    v_add_f32 v9, v9, v200
    s_waitcnt lgkmcnt(3)
    v_mfma_f32_16x16x32_bf16 v[192:195], v[228:231], v[152:155], v[216:219]
    v_add_f32 v9, v9, v201
    v_cvt_pk_bf16_f32 v64, v200, v201
    v_exp_f32 v202, v202
    v_mfma_f32_16x16x32_bf16 v[196:199], v[228:231], v[168:171], v[220:223]
    s_add_u32 s22, s21, 0x1c400
    s_add_u32 m0, s20, 0x14400
    s_nop 0
    buffer_load_dwordx4 v2, s[8:11], s22 offen sc1 lds
    ds_read_b128 v[244:247], v4 offset:54272
    v_exp_f32 v203, v203
    v_add_f32 v9, v9, v202
    s_waitcnt lgkmcnt(3)
    v_mfma_f32_16x16x32_bf16 v[184:187], v[232:235], v[156:159], v[184:187]
    v_add_f32 v9, v9, v203
    v_cvt_pk_bf16_f32 v65, v202, v203
    v_exp_f32 v204, v204
    v_mfma_f32_16x16x32_bf16 v[188:191], v[232:235], v[172:175], v[188:191]
    ds_read_b128 v[224:227], v4 offset:55296
    v_exp_f32 v205, v205
    v_add_f32 v10, v10, v204
    v_add_f32 v10, v10, v205
    s_waitcnt lgkmcnt(3)
    v_mfma_f32_16x16x32_bf16 v[192:195], v[236:239], v[156:159], v[192:195]
    v_cvt_pk_bf16_f32 v68, v204, v205
    v_exp_f32 v206, v206
    v_mfma_f32_16x16x32_bf16 v[196:199], v[236:239], v[172:175], v[196:199]
    ds_read_b128 v[228:231], v4 offset:56320
    v_exp_f32 v207, v207
    v_add_f32 v10, v10, v206
    v_add_f32 v10, v10, v207
    s_waitcnt lgkmcnt(3)
    v_mfma_f32_16x16x32_bf16 v[184:187], v[240:243], v[160:163], v[184:187]
    v_cvt_pk_bf16_f32 v69, v206, v207
    v_exp_f32 v208, v208
    v_exp_f32 v209, v209
    v_mfma_f32_16x16x32_bf16 v[188:191], v[240:243], v[176:179], v[188:191]
    ds_read_b128 v[232:235], v4 offset:57344
    v_add_f32 v9, v9, v208
    v_add_f32 v9, v9, v209
    s_waitcnt lgkmcnt(3)
    v_mfma_f32_16x16x32_bf16 v[192:195], v[244:247], v[160:163], v[192:195]
    v_cvt_pk_bf16_f32 v66, v208, v209
    v_exp_f32 v210, v210
    v_exp_f32 v211, v211
    v_mfma_f32_16x16x32_bf16 v[196:199], v[244:247], v[176:179], v[196:199]
    ds_read_b128 v[236:239], v4 offset:58368
    v_add_f32 v9, v9, v210
    v_add_f32 v9, v9, v211
    v_cvt_pk_bf16_f32 v67, v210, v211
    s_waitcnt lgkmcnt(3)
    v_mfma_f32_16x16x32_bf16 v[184:187], v[224:227], v[164:167], v[184:187]
    v_exp_f32 v212, v212
    v_exp_f32 v213, v213
    v_mfma_f32_16x16x32_bf16 v[188:191], v[224:227], v[180:183], v[188:191]
    ds_read_b128 v[240:243], v4 offset:59392
    v_add_f32 v10, v10, v212
    v_add_f32 v10, v10, v213
    v_cvt_pk_bf16_f32 v70, v212, v213
    s_waitcnt lgkmcnt(3)
    v_mfma_f32_16x16x32_bf16 v[192:195], v[228:231], v[164:167], v[192:195]
    v_exp_f32 v214, v214
    v_exp_f32 v215, v215
    v_add_f32 v10, v10, v214
    v_mfma_f32_16x16x32_bf16 v[196:199], v[228:231], v[180:183], v[196:199]
    ds_read_b128 v[244:247], v4 offset:60416
    v_add_f32 v10, v10, v215
    v_cvt_pk_bf16_f32 v71, v214, v215
    s_waitcnt lgkmcnt(3)
    v_mfma_f32_16x16x32_bf16 v[200:203], v[232:235], v[152:155], v[216:219]
    v_mfma_f32_16x16x32_bf16 v[204:207], v[232:235], v[168:171], v[220:223]
    ds_read_b128 v[224:227], v4 offset:61440
    v_exp_f32 v184, v184
    v_exp_f32 v185, v185
    v_add_f32 v9, v9, v184
    s_waitcnt lgkmcnt(3)
    v_mfma_f32_16x16x32_bf16 v[208:211], v[236:239], v[152:155], v[216:219]
    v_add_f32 v9, v9, v185
    v_cvt_pk_bf16_f32 v72, v184, v185
    v_exp_f32 v186, v186
    v_mfma_f32_16x16x32_bf16 v[212:215], v[236:239], v[168:171], v[220:223]
    ds_read_b128 v[228:231], v4 offset:62464
    v_exp_f32 v187, v187
    v_add_f32 v9, v9, v186
    s_waitcnt lgkmcnt(3)
    v_mfma_f32_16x16x32_bf16 v[200:203], v[240:243], v[156:159], v[200:203]
    v_add_f32 v9, v9, v187
    v_cvt_pk_bf16_f32 v73, v186, v187
    v_exp_f32 v188, v188
    v_mfma_f32_16x16x32_bf16 v[204:207], v[240:243], v[172:175], v[204:207]
    ds_read_b128 v[232:235], v4 offset:63488
    v_exp_f32 v189, v189
    v_add_f32 v10, v10, v188
    v_add_f32 v10, v10, v189
    s_waitcnt lgkmcnt(3)
    v_mfma_f32_16x16x32_bf16 v[208:211], v[244:247], v[156:159], v[208:211]
    v_cvt_pk_bf16_f32 v76, v188, v189
    v_exp_f32 v190, v190
    v_mfma_f32_16x16x32_bf16 v[212:215], v[244:247], v[172:175], v[212:215]
    ds_read_b128 v[236:239], v4 offset:64512
    v_exp_f32 v191, v191
    v_add_f32 v10, v10, v190
    v_add_f32 v10, v10, v191
    s_waitcnt lgkmcnt(3)
    v_mfma_f32_16x16x32_bf16 v[200:203], v[224:227], v[160:163], v[200:203]
    v_cvt_pk_bf16_f32 v77, v190, v191
    v_exp_f32 v192, v192
    v_exp_f32 v193, v193
    v_mfma_f32_16x16x32_bf16 v[204:207], v[224:227], v[176:179], v[204:207]
    s_waitcnt vmcnt(6)
    s_barrier
    ds_read_b128 v[240:243], v5 offset:0
    v_add_f32 v9, v9, v192
    v_add_f32 v9, v9, v193
    s_waitcnt lgkmcnt(3)
    v_mfma_f32_16x16x32_bf16 v[208:211], v[228:231], v[160:163], v[208:211]
    v_cvt_pk_bf16_f32 v74, v192, v193
    v_exp_f32 v194, v194
    v_exp_f32 v195, v195
    v_mfma_f32_16x16x32_bf16 v[212:215], v[228:231], v[176:179], v[212:215]
    s_add_u32 s22, s21, 0x80000
    s_add_u32 m0, s20, 0x18000
    s_nop 0
    buffer_load_dwordx4 v2, s[8:11], s22 offen sc1 lds
    ds_read_b128 v[244:247], v5 offset:1024
    v_add_f32 v9, v9, v194
    v_add_f32 v9, v9, v195
    v_cvt_pk_bf16_f32 v75, v194, v195
    s_waitcnt lgkmcnt(3)
    v_mfma_f32_16x16x32_bf16 v[200:203], v[232:235], v[164:167], v[200:203]
    v_exp_f32 v196, v196
    v_exp_f32 v197, v197
    v_mfma_f32_16x16x32_bf16 v[204:207], v[232:235], v[180:183], v[204:207]
    ds_read_b128 v[224:227], v5 offset:2048
    v_add_f32 v10, v10, v196
    v_add_f32 v10, v10, v197
    v_cvt_pk_bf16_f32 v78, v196, v197
    s_waitcnt lgkmcnt(3)
    v_mfma_f32_16x16x32_bf16 v[208:211], v[236:239], v[164:167], v[208:211]
    v_exp_f32 v198, v198
    v_exp_f32 v199, v199
    v_add_f32 v10, v10, v198
    v_mfma_f32_16x16x32_bf16 v[212:215], v[236:239], v[180:183], v[212:215]
    ds_read_b128 v[228:231], v5 offset:3072
    v_add_f32 v10, v10, v199
    v_cvt_pk_bf16_f32 v79, v198, v199
    s_waitcnt lgkmcnt(3)
    v_mfma_f32_16x16x32_bf16 v[184:187], v[240:243], v[152:155], v[216:219]
    v_mfma_f32_16x16x32_bf16 v[188:191], v[240:243], v[168:171], v[220:223]
    ds_read_b128 v[232:235], v5 offset:4096
    v_exp_f32 v200, v200
    v_exp_f32 v201, v201
    v_add_f32 v9, v9, v200
    s_waitcnt lgkmcnt(3)
    v_mfma_f32_16x16x32_bf16 v[192:195], v[244:247], v[152:155], v[216:219]
    v_add_f32 v9, v9, v201
    v_cvt_pk_bf16_f32 v80, v200, v201
    v_exp_f32 v202, v202
    v_mfma_f32_16x16x32_bf16 v[196:199], v[244:247], v[168:171], v[220:223]
    s_add_u32 s22, s21, 0x80400
    s_add_u32 m0, s20, 0x18400
    s_nop 0
    buffer_load_dwordx4 v2, s[8:11], s22 offen sc1 lds
    ds_read_b128 v[236:239], v5 offset:5120
    v_exp_f32 v203, v203
    v_add_f32 v9, v9, v202
    s_waitcnt lgkmcnt(3)
    v_mfma_f32_16x16x32_bf16 v[184:187], v[224:227], v[156:159], v[184:187]
    v_add_f32 v9, v9, v203
    v_cvt_pk_bf16_f32 v81, v202, v203
    v_exp_f32 v204, v204
    v_mfma_f32_16x16x32_bf16 v[188:191], v[224:227], v[172:175], v[188:191]
    ds_read_b128 v[240:243], v5 offset:6144
    v_exp_f32 v205, v205
    v_add_f32 v10, v10, v204
    v_add_f32 v10, v10, v205
    s_waitcnt lgkmcnt(3)
    v_mfma_f32_16x16x32_bf16 v[192:195], v[228:231], v[156:159], v[192:195]
    v_cvt_pk_bf16_f32 v84, v204, v205
    v_exp_f32 v206, v206
    v_mfma_f32_16x16x32_bf16 v[196:199], v[228:231], v[172:175], v[196:199]
    ds_read_b128 v[244:247], v5 offset:7168
    v_exp_f32 v207, v207
    v_add_f32 v10, v10, v206
    v_add_f32 v10, v10, v207
    s_waitcnt lgkmcnt(3)
    v_mfma_f32_16x16x32_bf16 v[184:187], v[232:235], v[160:163], v[184:187]
    v_cvt_pk_bf16_f32 v85, v206, v207
    v_exp_f32 v208, v208
    v_exp_f32 v209, v209
    v_mfma_f32_16x16x32_bf16 v[188:191], v[232:235], v[176:179], v[188:191]
    ds_read_b128 v[224:227], v5 offset:8192
    v_add_f32 v9, v9, v208
    v_add_f32 v9, v9, v209
    s_waitcnt lgkmcnt(3)
    v_mfma_f32_16x16x32_bf16 v[192:195], v[236:239], v[160:163], v[192:195]
    v_cvt_pk_bf16_f32 v82, v208, v209
    v_exp_f32 v210, v210
    v_exp_f32 v211, v211
    v_mfma_f32_16x16x32_bf16 v[196:199], v[236:239], v[176:179], v[196:199]
    ds_read_b128 v[228:231], v5 offset:9216
    v_add_f32 v9, v9, v210
    v_add_f32 v9, v9, v211
    v_cvt_pk_bf16_f32 v83, v210, v211
    s_waitcnt lgkmcnt(3)
    v_mfma_f32_16x16x32_bf16 v[184:187], v[240:243], v[164:167], v[184:187]
    v_exp_f32 v212, v212
    v_exp_f32 v213, v213
    v_mfma_f32_16x16x32_bf16 v[188:191], v[240:243], v[180:183], v[188:191]
    ds_read_b128 v[232:235], v5 offset:10240
    v_add_f32 v10, v10, v212
    v_add_f32 v10, v10, v213
    v_cvt_pk_bf16_f32 v86, v212, v213
    s_waitcnt lgkmcnt(3)
    v_mfma_f32_16x16x32_bf16 v[192:195], v[244:247], v[164:167], v[192:195]
    v_exp_f32 v214, v214
    v_exp_f32 v215, v215
    v_add_f32 v10, v10, v214
    v_mfma_f32_16x16x32_bf16 v[196:199], v[244:247], v[180:183], v[196:199]
    ds_read_b128 v[236:239], v5 offset:11264
    v_add_f32 v10, v10, v215
    v_cvt_pk_bf16_f32 v87, v214, v215
    s_waitcnt lgkmcnt(3)
    v_mfma_f32_16x16x32_bf16 v[200:203], v[224:227], v[152:155], v[216:219]
    v_mfma_f32_16x16x32_bf16 v[204:207], v[224:227], v[168:171], v[220:223]
    ds_read_b128 v[240:243], v5 offset:12288
    v_exp_f32 v184, v184
    v_exp_f32 v185, v185
    v_add_f32 v9, v9, v184
    s_waitcnt lgkmcnt(3)
    v_mfma_f32_16x16x32_bf16 v[208:211], v[228:231], v[152:155], v[216:219]
    v_add_f32 v9, v9, v185
    v_cvt_pk_bf16_f32 v88, v184, v185
    v_exp_f32 v186, v186
    v_mfma_f32_16x16x32_bf16 v[212:215], v[228:231], v[168:171], v[220:223]
    ds_read_b128 v[244:247], v5 offset:13312
    v_exp_f32 v187, v187
    v_add_f32 v9, v9, v186
    s_waitcnt lgkmcnt(3)
    v_mfma_f32_16x16x32_bf16 v[200:203], v[232:235], v[156:159], v[200:203]
    v_add_f32 v9, v9, v187
    v_cvt_pk_bf16_f32 v89, v186, v187
    v_exp_f32 v188, v188
    v_mfma_f32_16x16x32_bf16 v[204:207], v[232:235], v[172:175], v[204:207]
    ds_read_b128 v[224:227], v5 offset:14336
    v_exp_f32 v189, v189
    v_add_f32 v10, v10, v188
    v_add_f32 v10, v10, v189
    s_waitcnt lgkmcnt(3)
    v_mfma_f32_16x16x32_bf16 v[208:211], v[236:239], v[156:159], v[208:211]
    v_cvt_pk_bf16_f32 v92, v188, v189
    v_exp_f32 v190, v190
    v_mfma_f32_16x16x32_bf16 v[212:215], v[236:239], v[172:175], v[212:215]
    ds_read_b128 v[228:231], v5 offset:15360
    v_exp_f32 v191, v191
    v_add_f32 v10, v10, v190
    v_add_f32 v10, v10, v191
    s_waitcnt lgkmcnt(3)
    v_mfma_f32_16x16x32_bf16 v[200:203], v[240:243], v[160:163], v[200:203]
    v_cvt_pk_bf16_f32 v93, v190, v191
    v_exp_f32 v192, v192
    v_exp_f32 v193, v193
    v_mfma_f32_16x16x32_bf16 v[204:207], v[240:243], v[176:179], v[204:207]
    s_waitcnt vmcnt(6)
    s_barrier
    ds_read_b128 v[232:235], v5 offset:16384
    v_add_f32 v9, v9, v192
    v_add_f32 v9, v9, v193
    s_waitcnt lgkmcnt(3)
    v_mfma_f32_16x16x32_bf16 v[208:211], v[244:247], v[160:163], v[208:211]
    v_cvt_pk_bf16_f32 v90, v192, v193
    v_exp_f32 v194, v194
    v_exp_f32 v195, v195
    v_mfma_f32_16x16x32_bf16 v[212:215], v[244:247], v[176:179], v[212:215]
    s_add_u32 s22, s21, 0x84000
    s_add_u32 m0, s20, 0x1c000
    s_nop 0
    buffer_load_dwordx4 v2, s[8:11], s22 offen sc1 lds
    ds_read_b128 v[236:239], v5 offset:17408
    v_add_f32 v9, v9, v194
    v_add_f32 v9, v9, v195
    v_cvt_pk_bf16_f32 v91, v194, v195
    s_waitcnt lgkmcnt(3)
    v_mfma_f32_16x16x32_bf16 v[200:203], v[224:227], v[164:167], v[200:203]
    v_exp_f32 v196, v196
    v_exp_f32 v197, v197
    v_mfma_f32_16x16x32_bf16 v[204:207], v[224:227], v[180:183], v[204:207]
    ds_read_b128 v[240:243], v5 offset:18432
    v_add_f32 v10, v10, v196
    v_add_f32 v10, v10, v197
    v_cvt_pk_bf16_f32 v94, v196, v197
    s_waitcnt lgkmcnt(3)
    v_mfma_f32_16x16x32_bf16 v[208:211], v[228:231], v[164:167], v[208:211]
    v_exp_f32 v198, v198
    v_exp_f32 v199, v199
    v_add_f32 v10, v10, v198
    v_mfma_f32_16x16x32_bf16 v[212:215], v[228:231], v[180:183], v[212:215]
    ds_read_b128 v[244:247], v5 offset:19456
    v_add_f32 v10, v10, v199
    v_cvt_pk_bf16_f32 v95, v198, v199
    s_waitcnt lgkmcnt(3)
    v_mfma_f32_16x16x32_bf16 v[184:187], v[232:235], v[152:155], v[216:219]
    v_mfma_f32_16x16x32_bf16 v[188:191], v[232:235], v[168:171], v[220:223]
    ds_read_b128 v[224:227], v5 offset:20480
    v_exp_f32 v200, v200
    v_exp_f32 v201, v201
    v_add_f32 v9, v9, v200
    s_waitcnt lgkmcnt(3)
    v_mfma_f32_16x16x32_bf16 v[192:195], v[236:239], v[152:155], v[216:219]
    v_add_f32 v9, v9, v201
    v_cvt_pk_bf16_f32 v96, v200, v201
    v_exp_f32 v202, v202
    v_mfma_f32_16x16x32_bf16 v[196:199], v[236:239], v[168:171], v[220:223]
    s_add_u32 s22, s21, 0x84400
    s_add_u32 m0, s20, 0x1c400
    s_nop 0
    buffer_load_dwordx4 v2, s[8:11], s22 offen sc1 lds
    ds_read_b128 v[228:231], v5 offset:21504
    v_exp_f32 v203, v203
    v_add_f32 v9, v9, v202
    s_waitcnt lgkmcnt(3)
    v_mfma_f32_16x16x32_bf16 v[184:187], v[240:243], v[156:159], v[184:187]
    v_add_f32 v9, v9, v203
    v_cvt_pk_bf16_f32 v97, v202, v203
    v_exp_f32 v204, v204
    v_mfma_f32_16x16x32_bf16 v[188:191], v[240:243], v[172:175], v[188:191]
    ds_read_b128 v[232:235], v5 offset:22528
    v_exp_f32 v205, v205
    v_add_f32 v10, v10, v204
    v_add_f32 v10, v10, v205
    s_waitcnt lgkmcnt(3)
    v_mfma_f32_16x16x32_bf16 v[192:195], v[244:247], v[156:159], v[192:195]
    v_cvt_pk_bf16_f32 v100, v204, v205
    v_exp_f32 v206, v206
    v_mfma_f32_16x16x32_bf16 v[196:199], v[244:247], v[172:175], v[196:199]
    ds_read_b128 v[236:239], v5 offset:23552
    v_exp_f32 v207, v207
    v_add_f32 v10, v10, v206
    v_add_f32 v10, v10, v207
    s_waitcnt lgkmcnt(3)
    v_mfma_f32_16x16x32_bf16 v[184:187], v[224:227], v[160:163], v[184:187]
    v_cvt_pk_bf16_f32 v101, v206, v207
    v_exp_f32 v208, v208
    v_exp_f32 v209, v209
    v_mfma_f32_16x16x32_bf16 v[188:191], v[224:227], v[176:179], v[188:191]
    ds_read_b128 v[240:243], v5 offset:24576
    v_add_f32 v9, v9, v208
    v_add_f32 v9, v9, v209
    s_waitcnt lgkmcnt(3)
    v_mfma_f32_16x16x32_bf16 v[192:195], v[228:231], v[160:163], v[192:195]
    v_cvt_pk_bf16_f32 v98, v208, v209
    v_exp_f32 v210, v210
    v_exp_f32 v211, v211
    v_mfma_f32_16x16x32_bf16 v[196:199], v[228:231], v[176:179], v[196:199]
    ds_read_b128 v[244:247], v5 offset:25600
    v_add_f32 v9, v9, v210
    v_add_f32 v9, v9, v211
    v_cvt_pk_bf16_f32 v99, v210, v211
    s_waitcnt lgkmcnt(3)
    v_mfma_f32_16x16x32_bf16 v[184:187], v[232:235], v[164:167], v[184:187]
    v_exp_f32 v212, v212
    v_exp_f32 v213, v213
    v_mfma_f32_16x16x32_bf16 v[188:191], v[232:235], v[180:183], v[188:191]
    ds_read_b128 v[224:227], v5 offset:26624
    v_add_f32 v10, v10, v212
    v_add_f32 v10, v10, v213
    v_cvt_pk_bf16_f32 v102, v212, v213
    s_waitcnt lgkmcnt(3)
    v_mfma_f32_16x16x32_bf16 v[192:195], v[236:239], v[164:167], v[192:195]
    v_exp_f32 v214, v214
    v_exp_f32 v215, v215
    v_add_f32 v10, v10, v214
    v_mfma_f32_16x16x32_bf16 v[196:199], v[236:239], v[180:183], v[196:199]
    ds_read_b128 v[228:231], v5 offset:27648
    v_add_f32 v10, v10, v215
    v_cvt_pk_bf16_f32 v103, v214, v215
    s_waitcnt lgkmcnt(3)
    v_mfma_f32_16x16x32_bf16 v[200:203], v[240:243], v[152:155], v[216:219]
    v_mfma_f32_16x16x32_bf16 v[204:207], v[240:243], v[168:171], v[220:223]
    ds_read_b128 v[232:235], v5 offset:28672
    v_exp_f32 v184, v184
    v_exp_f32 v185, v185
    v_add_f32 v9, v9, v184
    s_waitcnt lgkmcnt(3)
    v_mfma_f32_16x16x32_bf16 v[208:211], v[244:247], v[152:155], v[216:219]
    v_add_f32 v9, v9, v185
    v_cvt_pk_bf16_f32 v104, v184, v185
    v_exp_f32 v186, v186
    v_mfma_f32_16x16x32_bf16 v[212:215], v[244:247], v[168:171], v[220:223]
    ds_read_b128 v[236:239], v5 offset:29696
    v_exp_f32 v187, v187
    v_add_f32 v9, v9, v186
    s_waitcnt lgkmcnt(3)
    v_mfma_f32_16x16x32_bf16 v[200:203], v[224:227], v[156:159], v[200:203]
    v_add_f32 v9, v9, v187
    v_cvt_pk_bf16_f32 v105, v186, v187
    v_exp_f32 v188, v188
    v_mfma_f32_16x16x32_bf16 v[204:207], v[224:227], v[172:175], v[204:207]
    ds_read_b128 v[240:243], v5 offset:30720
    v_exp_f32 v189, v189
    v_add_f32 v10, v10, v188
    v_add_f32 v10, v10, v189
    s_waitcnt lgkmcnt(3)
    v_mfma_f32_16x16x32_bf16 v[208:211], v[228:231], v[156:159], v[208:211]
    v_cvt_pk_bf16_f32 v108, v188, v189
    v_exp_f32 v190, v190
    v_mfma_f32_16x16x32_bf16 v[212:215], v[228:231], v[172:175], v[212:215]
    ds_read_b128 v[244:247], v5 offset:31744
    v_exp_f32 v191, v191
    v_add_f32 v10, v10, v190
    v_add_f32 v10, v10, v191
    s_waitcnt lgkmcnt(3)
    v_mfma_f32_16x16x32_bf16 v[200:203], v[232:235], v[160:163], v[200:203]
    v_cvt_pk_bf16_f32 v109, v190, v191
    v_exp_f32 v192, v192
    v_exp_f32 v193, v193
    v_mfma_f32_16x16x32_bf16 v[204:207], v[232:235], v[176:179], v[204:207]
    s_waitcnt vmcnt(6)
    s_barrier
    ds_read_b128 v[224:227], v4 offset:0
    v_add_f32 v9, v9, v192
    v_add_f32 v9, v9, v193
    s_waitcnt lgkmcnt(3)
    v_mfma_f32_16x16x32_bf16 v[208:211], v[236:239], v[160:163], v[208:211]
    v_cvt_pk_bf16_f32 v106, v192, v193
    v_exp_f32 v194, v194
    v_exp_f32 v195, v195
    v_mfma_f32_16x16x32_bf16 v[212:215], v[236:239], v[176:179], v[212:215]
    s_add_u32 s22, s21, 0x88000
    s_add_u32 m0, s20, 0x20000
    s_nop 0
    buffer_load_dwordx4 v2, s[8:11], s22 offen sc1 lds
    ds_read_b128 v[228:231], v4 offset:1024
    v_add_f32 v9, v9, v194
    v_add_f32 v9, v9, v195
    v_cvt_pk_bf16_f32 v107, v194, v195
    s_waitcnt lgkmcnt(3)
    v_mfma_f32_16x16x32_bf16 v[200:203], v[240:243], v[164:167], v[200:203]
    v_exp_f32 v196, v196
    v_exp_f32 v197, v197
    v_mfma_f32_16x16x32_bf16 v[204:207], v[240:243], v[180:183], v[204:207]
    ds_read_b128 v[232:235], v4 offset:2048
    v_add_f32 v10, v10, v196
    v_add_f32 v10, v10, v197
    v_cvt_pk_bf16_f32 v110, v196, v197
    s_waitcnt lgkmcnt(3)
    v_mfma_f32_16x16x32_bf16 v[208:211], v[244:247], v[164:167], v[208:211]
    v_exp_f32 v198, v198
    v_exp_f32 v199, v199
    v_add_f32 v10, v10, v198
    v_mfma_f32_16x16x32_bf16 v[212:215], v[244:247], v[180:183], v[212:215]
    ds_read_b128 v[236:239], v4 offset:3072
    v_add_f32 v10, v10, v199
    v_cvt_pk_bf16_f32 v111, v198, v199
    s_waitcnt lgkmcnt(3)
    v_mfma_f32_16x16x32_bf16 v[184:187], v[224:227], v[152:155], v[216:219]
    v_mfma_f32_16x16x32_bf16 v[188:191], v[224:227], v[168:171], v[220:223]
    ds_read_b128 v[240:243], v4 offset:4096
    v_exp_f32 v200, v200
    v_exp_f32 v201, v201
    v_add_f32 v9, v9, v200
    s_waitcnt lgkmcnt(3)
    v_mfma_f32_16x16x32_bf16 v[192:195], v[228:231], v[152:155], v[216:219]
    v_add_f32 v9, v9, v201
    v_cvt_pk_bf16_f32 v112, v200, v201
    v_exp_f32 v202, v202
    v_mfma_f32_16x16x32_bf16 v[196:199], v[228:231], v[168:171], v[220:223]
    s_add_u32 s22, s21, 0x88400
    s_add_u32 m0, s20, 0x20400
    s_nop 0
    buffer_load_dwordx4 v2, s[8:11], s22 offen sc1 lds
    ds_read_b128 v[244:247], v4 offset:5120
    v_exp_f32 v203, v203
    v_add_f32 v9, v9, v202
    s_waitcnt lgkmcnt(3)
    v_mfma_f32_16x16x32_bf16 v[184:187], v[232:235], v[156:159], v[184:187]
    v_add_f32 v9, v9, v203
    v_cvt_pk_bf16_f32 v113, v202, v203
    v_exp_f32 v204, v204
    v_mfma_f32_16x16x32_bf16 v[188:191], v[232:235], v[172:175], v[188:191]
    ds_read_b128 v[224:227], v4 offset:6144
    v_exp_f32 v205, v205
    v_add_f32 v10, v10, v204
    v_add_f32 v10, v10, v205
    s_waitcnt lgkmcnt(3)
    v_mfma_f32_16x16x32_bf16 v[192:195], v[236:239], v[156:159], v[192:195]
    v_cvt_pk_bf16_f32 v116, v204, v205
    v_exp_f32 v206, v206
    v_mfma_f32_16x16x32_bf16 v[196:199], v[236:239], v[172:175], v[196:199]
    ds_read_b128 v[228:231], v4 offset:7168
    v_exp_f32 v207, v207
    v_add_f32 v10, v10, v206
    v_add_f32 v10, v10, v207
    s_waitcnt lgkmcnt(3)
    v_mfma_f32_16x16x32_bf16 v[184:187], v[240:243], v[160:163], v[184:187]
    v_cvt_pk_bf16_f32 v117, v206, v207
    v_exp_f32 v208, v208
    v_exp_f32 v209, v209
    v_mfma_f32_16x16x32_bf16 v[188:191], v[240:243], v[176:179], v[188:191]
    ds_read_b128 v[232:235], v4 offset:8192
    v_add_f32 v9, v9, v208
    v_add_f32 v9, v9, v209
    s_waitcnt lgkmcnt(3)
    v_mfma_f32_16x16x32_bf16 v[192:195], v[244:247], v[160:163], v[192:195]
    v_cvt_pk_bf16_f32 v114, v208, v209
    v_exp_f32 v210, v210
    v_exp_f32 v211, v211
    v_mfma_f32_16x16x32_bf16 v[196:199], v[244:247], v[176:179], v[196:199]
    ds_read_b128 v[236:239], v4 offset:9216
    v_add_f32 v9, v9, v210
    v_add_f32 v9, v9, v211
    v_cvt_pk_bf16_f32 v115, v210, v211
    s_waitcnt lgkmcnt(3)
    v_mfma_f32_16x16x32_bf16 v[184:187], v[224:227], v[164:167], v[184:187]
    v_exp_f32 v212, v212
    v_exp_f32 v213, v213
    v_mfma_f32_16x16x32_bf16 v[188:191], v[224:227], v[180:183], v[188:191]
    ds_read_b128 v[240:243], v4 offset:10240
    v_add_f32 v10, v10, v212
    v_add_f32 v10, v10, v213
    v_cvt_pk_bf16_f32 v118, v212, v213
    s_waitcnt lgkmcnt(3)
    v_mfma_f32_16x16x32_bf16 v[192:195], v[228:231], v[164:167], v[192:195]
    v_exp_f32 v214, v214
    v_exp_f32 v215, v215
    v_add_f32 v10, v10, v214
    v_mfma_f32_16x16x32_bf16 v[196:199], v[228:231], v[180:183], v[196:199]
    ds_read_b128 v[244:247], v4 offset:11264
    v_add_f32 v10, v10, v215
    v_cvt_pk_bf16_f32 v119, v214, v215
    s_waitcnt lgkmcnt(3)
    v_mfma_f32_16x16x32_bf16 v[200:203], v[232:235], v[152:155], v[216:219]
    v_mfma_f32_16x16x32_bf16 v[204:207], v[232:235], v[168:171], v[220:223]
    ds_read_b128 v[224:227], v4 offset:12288
    v_exp_f32 v184, v184
    v_exp_f32 v185, v185
    v_add_f32 v9, v9, v184
    s_waitcnt lgkmcnt(3)
    v_mfma_f32_16x16x32_bf16 v[208:211], v[236:239], v[152:155], v[216:219]
    v_add_f32 v9, v9, v185
    v_cvt_pk_bf16_f32 v120, v184, v185
    v_exp_f32 v186, v186
    v_mfma_f32_16x16x32_bf16 v[212:215], v[236:239], v[168:171], v[220:223]
    ds_read_b128 v[228:231], v4 offset:13312
    v_exp_f32 v187, v187
    v_add_f32 v9, v9, v186
    s_waitcnt lgkmcnt(3)
    v_mfma_f32_16x16x32_bf16 v[200:203], v[240:243], v[156:159], v[200:203]
    v_add_f32 v9, v9, v187
    v_cvt_pk_bf16_f32 v121, v186, v187
    v_exp_f32 v188, v188
    v_mfma_f32_16x16x32_bf16 v[204:207], v[240:243], v[172:175], v[204:207]
    ds_read_b128 v[232:235], v4 offset:14336
    v_exp_f32 v189, v189
    v_add_f32 v10, v10, v188
    v_add_f32 v10, v10, v189
    s_waitcnt lgkmcnt(3)
    v_mfma_f32_16x16x32_bf16 v[208:211], v[244:247], v[156:159], v[208:211]
    v_cvt_pk_bf16_f32 v124, v188, v189
    v_exp_f32 v190, v190
    v_mfma_f32_16x16x32_bf16 v[212:215], v[244:247], v[172:175], v[212:215]
    ds_read_b128 v[236:239], v4 offset:15360
    v_exp_f32 v191, v191
    v_add_f32 v10, v10, v190
    v_add_f32 v10, v10, v191
    s_waitcnt lgkmcnt(3)
    v_mfma_f32_16x16x32_bf16 v[200:203], v[224:227], v[160:163], v[200:203]
    v_cvt_pk_bf16_f32 v125, v190, v191
    v_exp_f32 v192, v192
    v_exp_f32 v193, v193
    v_mfma_f32_16x16x32_bf16 v[204:207], v[224:227], v[176:179], v[204:207]
    s_waitcnt vmcnt(6)
    s_barrier
    ds_read_b128 v[240:243], v4 offset:16384
    v_add_f32 v9, v9, v192
    v_add_f32 v9, v9, v193
    s_waitcnt lgkmcnt(3)
    v_mfma_f32_16x16x32_bf16 v[208:211], v[228:231], v[160:163], v[208:211]
    v_cvt_pk_bf16_f32 v122, v192, v193
    v_exp_f32 v194, v194
    v_exp_f32 v195, v195
    v_mfma_f32_16x16x32_bf16 v[212:215], v[228:231], v[176:179], v[212:215]
    s_add_u32 s22, s21, 0x8c000
    s_add_u32 m0, s20, 0x24000
    s_nop 0
    buffer_load_dwordx4 v2, s[8:11], s22 offen sc1 lds
    ds_read_b128 v[244:247], v4 offset:17408
    v_add_f32 v9, v9, v194
    v_add_f32 v9, v9, v195
    v_cvt_pk_bf16_f32 v123, v194, v195
    s_waitcnt lgkmcnt(3)
    v_mfma_f32_16x16x32_bf16 v[200:203], v[232:235], v[164:167], v[200:203]
    v_exp_f32 v196, v196
    v_exp_f32 v197, v197
    v_mfma_f32_16x16x32_bf16 v[204:207], v[232:235], v[180:183], v[204:207]
    ds_read_b128 v[224:227], v4 offset:18432
    v_add_f32 v10, v10, v196
    v_add_f32 v10, v10, v197
    v_cvt_pk_bf16_f32 v126, v196, v197
    s_waitcnt lgkmcnt(3)
    v_mfma_f32_16x16x32_bf16 v[208:211], v[236:239], v[164:167], v[208:211]
    v_exp_f32 v198, v198
    v_exp_f32 v199, v199
    v_add_f32 v10, v10, v198
    v_mfma_f32_16x16x32_bf16 v[212:215], v[236:239], v[180:183], v[212:215]
    ds_read_b128 v[228:231], v4 offset:19456
    v_add_f32 v10, v10, v199
    v_cvt_pk_bf16_f32 v127, v198, v199
    s_waitcnt lgkmcnt(3)
    v_mfma_f32_16x16x32_bf16 v[184:187], v[240:243], v[152:155], v[216:219]
    v_mfma_f32_16x16x32_bf16 v[188:191], v[240:243], v[168:171], v[220:223]
    ds_read_b128 v[232:235], v4 offset:20480
    v_exp_f32 v200, v200
    v_exp_f32 v201, v201
    v_add_f32 v9, v9, v200
    s_waitcnt lgkmcnt(3)
    v_mfma_f32_16x16x32_bf16 v[192:195], v[244:247], v[152:155], v[216:219]
    v_add_f32 v9, v9, v201
    v_cvt_pk_bf16_f32 v128, v200, v201
    v_exp_f32 v202, v202
    v_mfma_f32_16x16x32_bf16 v[196:199], v[244:247], v[168:171], v[220:223]
    s_add_u32 s22, s21, 0x8c400
    s_add_u32 m0, s20, 0x24400
    s_nop 0
    buffer_load_dwordx4 v2, s[8:11], s22 offen sc1 lds
    ds_read_b128 v[236:239], v4 offset:21504
    v_exp_f32 v203, v203
    v_add_f32 v9, v9, v202
    s_waitcnt lgkmcnt(3)
    v_mfma_f32_16x16x32_bf16 v[184:187], v[224:227], v[156:159], v[184:187]
    v_add_f32 v9, v9, v203
    v_cvt_pk_bf16_f32 v129, v202, v203
    v_exp_f32 v204, v204
    v_mfma_f32_16x16x32_bf16 v[188:191], v[224:227], v[172:175], v[188:191]
    ds_read_b128 v[240:243], v4 offset:22528
    v_exp_f32 v205, v205
    v_add_f32 v10, v10, v204
    v_add_f32 v10, v10, v205
    s_waitcnt lgkmcnt(3)
    v_mfma_f32_16x16x32_bf16 v[192:195], v[228:231], v[156:159], v[192:195]
    v_cvt_pk_bf16_f32 v132, v204, v205
    v_exp_f32 v206, v206
    v_mfma_f32_16x16x32_bf16 v[196:199], v[228:231], v[172:175], v[196:199]
    ds_read_b128 v[244:247], v4 offset:23552
    v_exp_f32 v207, v207
    v_add_f32 v10, v10, v206
    v_add_f32 v10, v10, v207
    s_waitcnt lgkmcnt(3)
    v_mfma_f32_16x16x32_bf16 v[184:187], v[232:235], v[160:163], v[184:187]
    v_cvt_pk_bf16_f32 v133, v206, v207
    v_exp_f32 v208, v208
    v_exp_f32 v209, v209
    v_mfma_f32_16x16x32_bf16 v[188:191], v[232:235], v[176:179], v[188:191]
    ds_read_b128 v[224:227], v4 offset:24576
    v_add_f32 v9, v9, v208
    v_add_f32 v9, v9, v209
    s_waitcnt lgkmcnt(3)
    v_mfma_f32_16x16x32_bf16 v[192:195], v[236:239], v[160:163], v[192:195]
    v_cvt_pk_bf16_f32 v130, v208, v209
    v_exp_f32 v210, v210
    v_exp_f32 v211, v211
    v_mfma_f32_16x16x32_bf16 v[196:199], v[236:239], v[176:179], v[196:199]
    ds_read_b128 v[228:231], v4 offset:25600
    v_add_f32 v9, v9, v210
    v_add_f32 v9, v9, v211
    v_cvt_pk_bf16_f32 v131, v210, v211
    s_waitcnt lgkmcnt(3)
    v_mfma_f32_16x16x32_bf16 v[184:187], v[240:243], v[164:167], v[184:187]
    v_exp_f32 v212, v212
    v_exp_f32 v213, v213
    v_mfma_f32_16x16x32_bf16 v[188:191], v[240:243], v[180:183], v[188:191]
    ds_read_b128 v[232:235], v4 offset:26624
    v_add_f32 v10, v10, v212
    v_add_f32 v10, v10, v213
    v_cvt_pk_bf16_f32 v134, v212, v213
    s_waitcnt lgkmcnt(3)
    v_mfma_f32_16x16x32_bf16 v[192:195], v[244:247], v[164:167], v[192:195]
    v_exp_f32 v214, v214
    v_exp_f32 v215, v215
    v_add_f32 v10, v10, v214
    v_mfma_f32_16x16x32_bf16 v[196:199], v[244:247], v[180:183], v[196:199]
    ds_read_b128 v[236:239], v4 offset:27648
    v_add_f32 v10, v10, v215
    v_cvt_pk_bf16_f32 v135, v214, v215
    s_waitcnt lgkmcnt(3)
    v_mfma_f32_16x16x32_bf16 v[200:203], v[224:227], v[152:155], v[216:219]
    v_mfma_f32_16x16x32_bf16 v[204:207], v[224:227], v[168:171], v[220:223]
    ds_read_b128 v[240:243], v4 offset:28672
    v_exp_f32 v184, v184
    v_exp_f32 v185, v185
    v_add_f32 v9, v9, v184
    s_waitcnt lgkmcnt(3)
    v_mfma_f32_16x16x32_bf16 v[208:211], v[228:231], v[152:155], v[216:219]
    v_add_f32 v9, v9, v185
    v_cvt_pk_bf16_f32 v136, v184, v185
    v_exp_f32 v186, v186
    v_mfma_f32_16x16x32_bf16 v[212:215], v[228:231], v[168:171], v[220:223]
    ds_read_b128 v[244:247], v4 offset:29696
    v_exp_f32 v187, v187
    v_add_f32 v9, v9, v186
    s_waitcnt lgkmcnt(3)
    v_mfma_f32_16x16x32_bf16 v[200:203], v[232:235], v[156:159], v[200:203]
    v_add_f32 v9, v9, v187
    v_cvt_pk_bf16_f32 v137, v186, v187
    v_exp_f32 v188, v188
    v_mfma_f32_16x16x32_bf16 v[204:207], v[232:235], v[172:175], v[204:207]
    ds_read_b128 v[224:227], v4 offset:30720
    v_exp_f32 v189, v189
    v_add_f32 v10, v10, v188
    v_add_f32 v10, v10, v189
    s_waitcnt lgkmcnt(3)
    v_mfma_f32_16x16x32_bf16 v[208:211], v[236:239], v[156:159], v[208:211]
    v_cvt_pk_bf16_f32 v140, v188, v189
    v_exp_f32 v190, v190
    v_mfma_f32_16x16x32_bf16 v[212:215], v[236:239], v[172:175], v[212:215]
    ds_read_b128 v[228:231], v4 offset:31744
    v_exp_f32 v191, v191
    v_add_f32 v10, v10, v190
    v_add_f32 v10, v10, v191
    s_waitcnt lgkmcnt(3)
    v_mfma_f32_16x16x32_bf16 v[200:203], v[240:243], v[160:163], v[200:203]
    v_cvt_pk_bf16_f32 v141, v190, v191
    v_exp_f32 v192, v192
    v_exp_f32 v193, v193
    v_mfma_f32_16x16x32_bf16 v[204:207], v[240:243], v[176:179], v[204:207]
    v_add_f32 v9, v9, v192
    v_add_f32 v9, v9, v193
    s_waitcnt lgkmcnt(2)
    v_mfma_f32_16x16x32_bf16 v[208:211], v[244:247], v[160:163], v[208:211]
    v_cvt_pk_bf16_f32 v138, v192, v193
    v_exp_f32 v194, v194
    v_exp_f32 v195, v195
    v_mfma_f32_16x16x32_bf16 v[212:215], v[244:247], v[176:179], v[212:215]
    v_add_f32 v9, v9, v194
    v_add_f32 v9, v9, v195
    v_cvt_pk_bf16_f32 v139, v194, v195
    s_waitcnt lgkmcnt(1)
    v_mfma_f32_16x16x32_bf16 v[200:203], v[224:227], v[164:167], v[200:203]
    v_exp_f32 v196, v196
    v_exp_f32 v197, v197
    v_mfma_f32_16x16x32_bf16 v[204:207], v[224:227], v[180:183], v[204:207]
    v_add_f32 v10, v10, v196
    v_add_f32 v10, v10, v197
    v_cvt_pk_bf16_f32 v142, v196, v197
    s_waitcnt lgkmcnt(0)
    v_mfma_f32_16x16x32_bf16 v[208:211], v[228:231], v[164:167], v[208:211]
    v_exp_f32 v198, v198
    v_exp_f32 v199, v199
    v_add_f32 v10, v10, v198
    v_mfma_f32_16x16x32_bf16 v[212:215], v[228:231], v[180:183], v[212:215]
    v_add_f32 v10, v10, v199
    v_cvt_pk_bf16_f32 v143, v198, v199
    s_waitcnt vmcnt(6)
    s_barrier
    ds_read_b128 v[232:235], v4 offset:32768
    ds_read_b128 v[236:239], v4 offset:33792
    ds_read_b128 v[240:243], v4 offset:34816
    ds_read_b128 v[244:247], v4 offset:35840
    v_exp_f32 v200, v200
    v_exp_f32 v201, v201
    v_add_f32 v9, v9, v200
    v_add_f32 v9, v9, v201
    v_cvt_pk_bf16_f32 v144, v200, v201
    v_exp_f32 v202, v202
    v_exp_f32 v203, v203
    v_add_f32 v9, v9, v202
    v_add_f32 v9, v9, v203
    v_cvt_pk_bf16_f32 v145, v202, v203
    v_exp_f32 v204, v204
    v_exp_f32 v205, v205
    v_add_f32 v10, v10, v204
    v_add_f32 v10, v10, v205
    v_cvt_pk_bf16_f32 v148, v204, v205
    v_exp_f32 v206, v206
    v_exp_f32 v207, v207
    v_add_f32 v10, v10, v206
    v_add_f32 v10, v10, v207
    v_cvt_pk_bf16_f32 v149, v206, v207
    v_exp_f32 v208, v208
    v_exp_f32 v209, v209
    v_add_f32 v9, v9, v208
    v_add_f32 v9, v9, v209
    v_cvt_pk_bf16_f32 v146, v208, v209
    v_exp_f32 v210, v210
    v_exp_f32 v211, v211
    v_add_f32 v9, v9, v210
    v_add_f32 v9, v9, v211
    v_cvt_pk_bf16_f32 v147, v210, v211
    v_exp_f32 v212, v212
    v_exp_f32 v213, v213
    v_add_f32 v10, v10, v212
    v_add_f32 v10, v10, v213
    v_cvt_pk_bf16_f32 v150, v212, v213
    v_exp_f32 v214, v214
    v_exp_f32 v215, v215
    v_add_f32 v10, v10, v214
    v_add_f32 v10, v10, v215
    v_cvt_pk_bf16_f32 v151, v214, v215
    v_mov_b32 v16, v9
    v_mov_b32 v18, v10
    s_nop 0
    v_permlane16_swap_b32 v9, v16
    v_permlane16_swap_b32 v10, v18
    v_add_f32 v9, v9, v16
    v_add_f32 v10, v10, v18
    v_mov_b32 v16, v9
    v_mov_b32 v18, v10
    s_nop 0
    v_permlane32_swap_b32 v9, v16
    v_permlane32_swap_b32 v10, v18
    v_add_f32 v9, v9, v16
    v_add_f32 v10, v10, v18
    v_max_f32 v17, v9, v10
    s_mov_b32 s16, 0x71800000
    v_cmp_ngt_f32 vcc, s16, v17
    v_cmp_u_f32 s[62:63], v9, v10
    s_or_b64 vcc, vcc, s[62:63]
    s_cbranch_vccnz adaLN_cond__sliding_block_cached__moe_arch_mod__prompt_kernel_fixA
adaLN_cond__sliding_block_cached__moe_arch_mod__prompt_kernel_fixAb:
    v_rcp_f32 v9, v9
    v_rcp_f32 v10, v10
    s_lshl_b32 s25, s13, 3
    s_add_u32 s25, s25, s3
    s_lshl_b32 s25, s25, 18
    s_lshl_b32 s26, s12, 12
    s_add_u32 s25, s25, s26
    s_add_u32 s25, s25, 0x1000000
    s_add_u32 s26, s25, 131072
    s_lshl_b32 s63, s13, 3
    s_add_u32 s63, s63, s3
    s_lshl_b32 s63, s63, 5
    s_add_u32 s63, s63, s12
    s_lshl_b32 s63, s63, 2
    s_waitcnt lgkmcnt(3)
    v_mfma_f32_16x16x32_bf16 v[184:187], v[232:235], v[24:27], 0
    v_mfma_f32_16x16x32_bf16 v[188:191], v[232:235], v[28:31], 0
    ds_read_b128 v[224:227], v4 offset:36864
    s_waitcnt lgkmcnt(3)
    v_mfma_f32_16x16x32_bf16 v[192:195], v[236:239], v[24:27], 0
    s_add_u32 s22, s21, 0x90000
    s_add_u32 m0, s20, 0x10000
    s_nop 0
    buffer_load_dwordx4 v2, s[8:11], s22 offen sc1 lds
    v_mfma_f32_16x16x32_bf16 v[196:199], v[236:239], v[28:31], 0
    ds_read_b128 v[228:231], v4 offset:37888
    s_waitcnt lgkmcnt(3)
    v_mfma_f32_16x16x32_bf16 v[184:187], v[240:243], v[32:35], v[184:187]
    s_mov_b64 s[72:73], s[54:55]
    s_mov_b32 s74, 0xc00000
    s_mov_b32 s75, 0x20000
    s_mov_b64 s[76:77], s[52:53]
    s_mov_b32 s78, 0x800
    s_mov_b32 s79, 0x20000
    v_lshrrev_b32 v16, 3, v1
    v_lshlrev_b32 v16, 3, v16
    s_lshl_b32 s17, s3, 6
    v_add_u32 v16, s17, v16
    s_lshr_b32 s15, s2, 6
    s_and_b32 s14, s2, 63
    v_lshlrev_b32 v8, 1, v16
    s_lshl_b32 s17, s15, 9
    buffer_load_dwordx4 v[12:15], v8, s[76:79], s17 offen
    s_mov_b32 s17, 12288
    v_mul_lo_u32 v7, s17, v16
    v_and_b32 v16, 7, v1
    v_lshl_add_u32 v7, v16, 4, v7
    s_mul_i32 s17, s15, 3145728
    s_lshl_b32 s16, s14, 7
    s_add_u32 s17, s17, s16
    s_add_u32 s17, s17, 4096
    s_add_u32 s22, s17, 0
    buffer_load_dwordx4 v[152:155], v7, s[72:75], s22 offen
    s_add_u32 s22, s17, 12288
    buffer_load_dwordx4 v[156:159], v7, s[72:75], s22 offen
    s_add_u32 s22, s17, 24576
    buffer_load_dwordx4 v[160:163], v7, s[72:75], s22 offen
    s_add_u32 s22, s17, 36864
    buffer_load_dwordx4 v[164:167], v7, s[72:75], s22 offen
    s_add_u32 s22, s17, 49152
    buffer_load_dwordx4 v[168:171], v7, s[72:75], s22 offen
    s_add_u32 s22, s17, 61440
    buffer_load_dwordx4 v[172:175], v7, s[72:75], s22 offen
    s_add_u32 s22, s17, 73728
    buffer_load_dwordx4 v[176:179], v7, s[72:75], s22 offen
    s_add_u32 s22, s17, 86016
    buffer_load_dwordx4 v[180:183], v7, s[72:75], s22 offen
    v_mfma_f32_16x16x32_bf16 v[188:191], v[240:243], v[36:39], v[188:191]
    ds_read_b128 v[232:235], v4 offset:38912
    s_waitcnt lgkmcnt(3)
    v_mfma_f32_16x16x32_bf16 v[192:195], v[244:247], v[32:35], v[192:195]
    v_mfma_f32_16x16x32_bf16 v[196:199], v[244:247], v[36:39], v[196:199]
    ds_read_b128 v[236:239], v4 offset:39936
    s_waitcnt lgkmcnt(3)
    v_mfma_f32_16x16x32_bf16 v[184:187], v[224:227], v[40:43], v[184:187]
    v_mfma_f32_16x16x32_bf16 v[188:191], v[224:227], v[44:47], v[188:191]
    ds_read_b128 v[240:243], v4 offset:40960
    s_waitcnt lgkmcnt(3)
    v_mfma_f32_16x16x32_bf16 v[192:195], v[228:231], v[40:43], v[192:195]
    s_add_u32 s22, s21, 0x90400
    s_add_u32 m0, s20, 0x10400
    s_nop 0
    buffer_load_dwordx4 v2, s[8:11], s22 offen sc1 lds
    v_mfma_f32_16x16x32_bf16 v[196:199], v[228:231], v[44:47], v[196:199]
    ds_read_b128 v[244:247], v4 offset:41984
    s_waitcnt lgkmcnt(3)
    v_mfma_f32_16x16x32_bf16 v[184:187], v[232:235], v[48:51], v[184:187]
    v_mfma_f32_16x16x32_bf16 v[188:191], v[232:235], v[52:55], v[188:191]
    ds_read_b128 v[224:227], v4 offset:43008
    s_waitcnt lgkmcnt(3)
    v_mfma_f32_16x16x32_bf16 v[192:195], v[236:239], v[48:51], v[192:195]
    v_mfma_f32_16x16x32_bf16 v[196:199], v[236:239], v[52:55], v[196:199]
    ds_read_b128 v[228:231], v4 offset:44032
    s_waitcnt lgkmcnt(3)
    v_mfma_f32_16x16x32_bf16 v[184:187], v[240:243], v[56:59], v[184:187]
    v_mfma_f32_16x16x32_bf16 v[188:191], v[240:243], v[60:63], v[188:191]
    ds_read_b128 v[232:235], v4 offset:45056
    s_waitcnt lgkmcnt(3)
    v_mfma_f32_16x16x32_bf16 v[192:195], v[244:247], v[56:59], v[192:195]
    v_mfma_f32_16x16x32_bf16 v[196:199], v[244:247], v[60:63], v[196:199]
    ds_read_b128 v[236:239], v4 offset:46080
    s_waitcnt lgkmcnt(3)
    v_mfma_f32_16x16x32_bf16 v[184:187], v[224:227], v[64:67], v[184:187]
    v_mfma_f32_16x16x32_bf16 v[188:191], v[224:227], v[68:71], v[188:191]
    ds_read_b128 v[240:243], v4 offset:47104
    s_waitcnt lgkmcnt(3)
    v_mfma_f32_16x16x32_bf16 v[192:195], v[228:231], v[64:67], v[192:195]
    v_mfma_f32_16x16x32_bf16 v[196:199], v[228:231], v[68:71], v[196:199]
    ds_read_b128 v[244:247], v4 offset:48128
    s_waitcnt lgkmcnt(3)
    v_mfma_f32_16x16x32_bf16 v[184:187], v[232:235], v[72:75], v[184:187]
    v_mfma_f32_16x16x32_bf16 v[188:191], v[232:235], v[76:79], v[188:191]
    s_waitcnt vmcnt(15)
    s_barrier
    ds_read_b128 v[224:227], v4 offset:49152
    s_waitcnt lgkmcnt(3)
    v_mfma_f32_16x16x32_bf16 v[192:195], v[236:239], v[72:75], v[192:195]
    v_mfma_f32_16x16x32_bf16 v[196:199], v[236:239], v[76:79], v[196:199]
    s_add_u32 s22, s21, 0x94000
    s_add_u32 m0, s20, 0x14000
    s_nop 0
    buffer_load_dwordx4 v2, s[8:11], s22 offen sc1 lds
    ds_read_b128 v[228:231], v4 offset:50176
    s_waitcnt lgkmcnt(3)
    v_mfma_f32_16x16x32_bf16 v[184:187], v[240:243], v[80:83], v[184:187]
    v_mfma_f32_16x16x32_bf16 v[188:191], v[240:243], v[84:87], v[188:191]
    ds_read_b128 v[232:235], v4 offset:51200
    s_waitcnt lgkmcnt(3)
    v_mfma_f32_16x16x32_bf16 v[192:195], v[244:247], v[80:83], v[192:195]
    v_mfma_f32_16x16x32_bf16 v[196:199], v[244:247], v[84:87], v[196:199]
    ds_read_b128 v[236:239], v4 offset:52224
    s_waitcnt lgkmcnt(3)
    v_mfma_f32_16x16x32_bf16 v[184:187], v[224:227], v[88:91], v[184:187]
    v_mfma_f32_16x16x32_bf16 v[188:191], v[224:227], v[92:95], v[188:191]
    ds_read_b128 v[240:243], v4 offset:53248
    s_waitcnt lgkmcnt(3)
    v_mfma_f32_16x16x32_bf16 v[192:195], v[228:231], v[88:91], v[192:195]
    v_mfma_f32_16x16x32_bf16 v[196:199], v[228:231], v[92:95], v[196:199]
    s_add_u32 s22, s21, 0x94400
    s_add_u32 m0, s20, 0x14400
    s_nop 0
    buffer_load_dwordx4 v2, s[8:11], s22 offen sc1 lds
    ds_read_b128 v[244:247], v4 offset:54272
    s_waitcnt lgkmcnt(3)
    v_mfma_f32_16x16x32_bf16 v[184:187], v[232:235], v[96:99], v[184:187]
    v_mfma_f32_16x16x32_bf16 v[188:191], v[232:235], v[100:103], v[188:191]
    ds_read_b128 v[224:227], v4 offset:55296
    s_waitcnt lgkmcnt(3)
    v_mfma_f32_16x16x32_bf16 v[192:195], v[236:239], v[96:99], v[192:195]
    v_mfma_f32_16x16x32_bf16 v[196:199], v[236:239], v[100:103], v[196:199]
    ds_read_b128 v[228:231], v4 offset:56320
    s_waitcnt lgkmcnt(3)
    v_mfma_f32_16x16x32_bf16 v[184:187], v[240:243], v[104:107], v[184:187]
    v_mfma_f32_16x16x32_bf16 v[188:191], v[240:243], v[108:111], v[188:191]
    ds_read_b128 v[232:235], v4 offset:57344
    s_waitcnt lgkmcnt(3)
    v_mfma_f32_16x16x32_bf16 v[192:195], v[244:247], v[104:107], v[192:195]
    v_mfma_f32_16x16x32_bf16 v[196:199], v[244:247], v[108:111], v[196:199]
    ds_read_b128 v[236:239], v4 offset:58368
    s_waitcnt lgkmcnt(3)
    v_mfma_f32_16x16x32_bf16 v[184:187], v[224:227], v[112:115], v[184:187]
    v_mfma_f32_16x16x32_bf16 v[188:191], v[224:227], v[116:119], v[188:191]
    ds_read_b128 v[240:243], v4 offset:59392
    s_waitcnt lgkmcnt(3)
    v_mfma_f32_16x16x32_bf16 v[192:195], v[228:231], v[112:115], v[192:195]
    v_mfma_f32_16x16x32_bf16 v[196:199], v[228:231], v[116:119], v[196:199]
    ds_read_b128 v[244:247], v4 offset:60416
    s_waitcnt lgkmcnt(3)
    v_mfma_f32_16x16x32_bf16 v[184:187], v[232:235], v[120:123], v[184:187]
    v_mfma_f32_16x16x32_bf16 v[188:191], v[232:235], v[124:127], v[188:191]
    ds_read_b128 v[224:227], v4 offset:61440
    s_waitcnt lgkmcnt(3)
    v_mfma_f32_16x16x32_bf16 v[192:195], v[236:239], v[120:123], v[192:195]
    v_mfma_f32_16x16x32_bf16 v[196:199], v[236:239], v[124:127], v[196:199]
    ds_read_b128 v[228:231], v4 offset:62464
    s_waitcnt lgkmcnt(3)
    v_mfma_f32_16x16x32_bf16 v[184:187], v[240:243], v[128:131], v[184:187]
    v_mfma_f32_16x16x32_bf16 v[188:191], v[240:243], v[132:135], v[188:191]
    ds_read_b128 v[232:235], v4 offset:63488
    s_waitcnt lgkmcnt(3)
    v_mfma_f32_16x16x32_bf16 v[192:195], v[244:247], v[128:131], v[192:195]
    v_mfma_f32_16x16x32_bf16 v[196:199], v[244:247], v[132:135], v[196:199]
    ds_read_b128 v[236:239], v4 offset:64512
    s_waitcnt lgkmcnt(3)
    v_mfma_f32_16x16x32_bf16 v[184:187], v[224:227], v[136:139], v[184:187]
    v_mfma_f32_16x16x32_bf16 v[188:191], v[224:227], v[140:143], v[188:191]
    s_waitcnt vmcnt(15)
    s_barrier
    ds_read_b128 v[240:243], v5 offset:0
    s_waitcnt lgkmcnt(3)
    v_mfma_f32_16x16x32_bf16 v[192:195], v[228:231], v[136:139], v[192:195]
    v_mfma_f32_16x16x32_bf16 v[196:199], v[228:231], v[140:143], v[196:199]
    s_add_u32 s22, s21, 0x98000
    s_add_u32 m0, s20, 0x18000
    s_nop 0
    buffer_load_dwordx4 v2, s[8:11], s22 offen sc1 lds
    ds_read_b128 v[244:247], v5 offset:1024
    s_waitcnt lgkmcnt(3)
    v_mfma_f32_16x16x32_bf16 v[184:187], v[232:235], v[144:147], v[184:187]
    v_mfma_f32_16x16x32_bf16 v[188:191], v[232:235], v[148:151], v[188:191]
    ds_read_b128 v[224:227], v5 offset:2048
    s_waitcnt lgkmcnt(3)
    v_mfma_f32_16x16x32_bf16 v[192:195], v[236:239], v[144:147], v[192:195]
    v_mfma_f32_16x16x32_bf16 v[196:199], v[236:239], v[148:151], v[196:199]
    ds_read_b128 v[228:231], v5 offset:3072
    s_waitcnt lgkmcnt(3)
    v_mfma_f32_16x16x32_bf16 v[200:203], v[240:243], v[24:27], 0
    v_mfma_f32_16x16x32_bf16 v[204:207], v[240:243], v[28:31], 0
    ds_read_b128 v[232:235], v5 offset:4096
    s_waitcnt lgkmcnt(3)
    v_mfma_f32_16x16x32_bf16 v[208:211], v[244:247], v[24:27], 0
    v_mfma_f32_16x16x32_bf16 v[212:215], v[244:247], v[28:31], 0
    s_add_u32 s22, s21, 0x98400
    s_add_u32 m0, s20, 0x18400
    s_nop 0
    buffer_load_dwordx4 v2, s[8:11], s22 offen sc1 lds
    ds_read_b128 v[236:239], v5 offset:5120
    v_mul_f32 v184, v184, v9
    s_waitcnt lgkmcnt(3)
    v_mfma_f32_16x16x32_bf16 v[200:203], v[224:227], v[32:35], v[200:203]
    v_mfma_f32_16x16x32_bf16 v[204:207], v[224:227], v[36:39], v[204:207]
    ds_read_b128 v[240:243], v5 offset:6144
    v_mul_f32 v185, v185, v9
    s_waitcnt lgkmcnt(3)
    v_mfma_f32_16x16x32_bf16 v[208:211], v[228:231], v[32:35], v[208:211]
    v_mfma_f32_16x16x32_bf16 v[212:215], v[228:231], v[36:39], v[212:215]
    ds_read_b128 v[244:247], v5 offset:7168
    v_mul_f32 v186, v186, v9
    s_waitcnt lgkmcnt(3)
    v_mfma_f32_16x16x32_bf16 v[200:203], v[232:235], v[40:43], v[200:203]
    v_mfma_f32_16x16x32_bf16 v[204:207], v[232:235], v[44:47], v[204:207]
    ds_read_b128 v[224:227], v5 offset:8192
    v_mul_f32 v187, v187, v9
    s_waitcnt lgkmcnt(3)
    v_mfma_f32_16x16x32_bf16 v[208:211], v[236:239], v[40:43], v[208:211]
    v_mfma_f32_16x16x32_bf16 v[212:215], v[236:239], v[44:47], v[212:215]
    ds_read_b128 v[228:231], v5 offset:9216
    v_mul_f32 v192, v192, v9
    s_waitcnt lgkmcnt(3)
    v_mfma_f32_16x16x32_bf16 v[200:203], v[240:243], v[48:51], v[200:203]
    v_mfma_f32_16x16x32_bf16 v[204:207], v[240:243], v[52:55], v[204:207]
    ds_read_b128 v[232:235], v5 offset:10240
    v_mul_f32 v193, v193, v9
    s_waitcnt lgkmcnt(3)
    v_mfma_f32_16x16x32_bf16 v[208:211], v[244:247], v[48:51], v[208:211]
    v_mfma_f32_16x16x32_bf16 v[212:215], v[244:247], v[52:55], v[212:215]
    ds_read_b128 v[236:239], v5 offset:11264
    v_mul_f32 v194, v194, v9
    s_waitcnt lgkmcnt(3)
    v_mfma_f32_16x16x32_bf16 v[200:203], v[224:227], v[56:59], v[200:203]
    v_mfma_f32_16x16x32_bf16 v[204:207], v[224:227], v[60:63], v[204:207]
    ds_read_b128 v[240:243], v5 offset:12288
    v_mul_f32 v195, v195, v9
    s_waitcnt lgkmcnt(3)
    v_mfma_f32_16x16x32_bf16 v[208:211], v[228:231], v[56:59], v[208:211]
    v_mfma_f32_16x16x32_bf16 v[212:215], v[228:231], v[60:63], v[212:215]
    ds_read_b128 v[244:247], v5 offset:13312
    v_cvt_pk_bf16_f32 v216, v184, v185
    s_waitcnt lgkmcnt(3)
    v_mfma_f32_16x16x32_bf16 v[200:203], v[232:235], v[64:67], v[200:203]
    v_mfma_f32_16x16x32_bf16 v[204:207], v[232:235], v[68:71], v[204:207]
    ds_read_b128 v[224:227], v5 offset:14336
    v_cvt_pk_bf16_f32 v217, v186, v187
    s_waitcnt lgkmcnt(3)
    v_mfma_f32_16x16x32_bf16 v[208:211], v[236:239], v[64:67], v[208:211]
    v_mfma_f32_16x16x32_bf16 v[212:215], v[236:239], v[68:71], v[212:215]
    ds_read_b128 v[228:231], v5 offset:15360
    v_cvt_pk_bf16_f32 v218, v192, v193
    s_waitcnt lgkmcnt(3)
    v_mfma_f32_16x16x32_bf16 v[200:203], v[240:243], v[72:75], v[200:203]
    v_mfma_f32_16x16x32_bf16 v[204:207], v[240:243], v[76:79], v[204:207]
    s_waitcnt vmcnt(15)
    s_barrier
    ds_read_b128 v[232:235], v5 offset:16384
    v_cvt_pk_bf16_f32 v219, v194, v195
    s_waitcnt lgkmcnt(3)
    v_mfma_f32_16x16x32_bf16 v[208:211], v[244:247], v[72:75], v[208:211]
    s_waitcnt vmcnt(13)
    v_lshlrev_b32 v16, 16, v12
    v_mul_f32 v17, 0xbfb8aa3b, v16
    v_mfma_f32_16x16x32_bf16 v[212:215], v[244:247], v[76:79], v[212:215]
    s_add_u32 s22, s21, 0x9c000
    s_add_u32 m0, s20, 0x1c000
    s_nop 0
    buffer_load_dwordx4 v2, s[8:11], s22 offen sc1 lds
    ds_read_b128 v[236:239], v5 offset:17408
    buffer_store_dwordx4 v[216:219], v2, s[8:11], s25 offen offset:0 sc1
    v_exp_f32 v17, v17
    s_nop 0
    v_add_f32 v17, 1.0, v17
    s_waitcnt lgkmcnt(3)
    v_mfma_f32_16x16x32_bf16 v[200:203], v[224:227], v[80:83], v[200:203]
    v_rcp_f32 v17, v17
    s_nop 0
    v_mul_f32 v16, v16, v17
    v_mfma_f32_16x16x32_bf16 v[204:207], v[224:227], v[84:87], v[204:207]
    ds_read_b128 v[240:243], v5 offset:18432
    v_mul_f32 v188, v188, v10
    v_cvt_pk_bf16_f32 v16, v16, v16
    v_lshlrev_b32 v16, 16, v16
    s_waitcnt lgkmcnt(3)
    v_mfma_f32_16x16x32_bf16 v[208:211], v[228:231], v[80:83], v[208:211]
    v_lshrrev_b32 v17, 16, v16
    v_mfma_f32_16x16x32_bf16 v[212:215], v[228:231], v[84:87], v[212:215]
    ds_read_b128 v[244:247], v5 offset:19456
    v_mul_f32 v189, v189, v10
    s_waitcnt vmcnt(14)
    v_dot2_f32_bf16 v249, v152, v16, 0
    v_dot2_f32_bf16 v248, v152, v17, 0
    s_waitcnt lgkmcnt(3)
    v_mfma_f32_16x16x32_bf16 v[200:203], v[232:235], v[88:91], v[200:203]
    v_dot2_f32_bf16 v251, v153, v16, 0
    v_dot2_f32_bf16 v250, v153, v17, 0
    v_mfma_f32_16x16x32_bf16 v[204:207], v[232:235], v[92:95], v[204:207]
    ds_read_b128 v[224:227], v5 offset:20480
    v_mul_f32 v190, v190, v10
    v_dot2_f32_bf16 v253, v154, v16, 0
    v_dot2_f32_bf16 v252, v154, v17, 0
    s_waitcnt lgkmcnt(3)
    v_mfma_f32_16x16x32_bf16 v[208:211], v[236:239], v[88:91], v[208:211]
    v_dot2_f32_bf16 v255, v155, v16, 0
    v_dot2_f32_bf16 v254, v155, v17, 0
    v_mfma_f32_16x16x32_bf16 v[212:215], v[236:239], v[92:95], v[212:215]
    s_add_u32 s22, s21, 0x9c400
    s_add_u32 m0, s20, 0x1c400
    s_nop 0
    buffer_load_dwordx4 v2, s[8:11], s22 offen sc1 lds
    ds_read_b128 v[228:231], v5 offset:21504
    v_mul_f32 v191, v191, v10
    v_and_b32 v18, 0xffff0000, v12
    s_waitcnt lgkmcnt(3)
    v_mfma_f32_16x16x32_bf16 v[200:203], v[240:243], v[96:99], v[200:203]
    v_mul_f32 v19, 0xbfb8aa3b, v18
    v_exp_f32 v19, v19
    v_mfma_f32_16x16x32_bf16 v[204:207], v[240:243], v[100:103], v[204:207]
    ds_read_b128 v[232:235], v5 offset:22528
    v_mul_f32 v196, v196, v10
    v_add_f32 v19, 1.0, v19
    v_rcp_f32 v19, v19
    s_waitcnt lgkmcnt(3)
    v_mfma_f32_16x16x32_bf16 v[208:211], v[244:247], v[96:99], v[208:211]
    v_mul_f32 v18, v18, v19
    v_cvt_pk_bf16_f32 v18, v18, v18
    v_mfma_f32_16x16x32_bf16 v[212:215], v[244:247], v[100:103], v[212:215]
    ds_read_b128 v[236:239], v5 offset:23552
    v_mul_f32 v197, v197, v10
    v_lshlrev_b32 v18, 16, v18
    v_lshrrev_b32 v19, 16, v18
    s_waitcnt lgkmcnt(3)
    v_mfma_f32_16x16x32_bf16 v[200:203], v[224:227], v[104:107], v[200:203]
    s_waitcnt vmcnt(14)
    v_dot2c_f32_bf16 v249, v156, v18
    v_mfma_f32_16x16x32_bf16 v[204:207], v[224:227], v[108:111], v[204:207]
    ds_read_b128 v[240:243], v5 offset:24576
    v_mul_f32 v198, v198, v10
    v_dot2c_f32_bf16 v248, v156, v19
    v_dot2c_f32_bf16 v251, v157, v18
    s_waitcnt lgkmcnt(3)
    v_mfma_f32_16x16x32_bf16 v[208:211], v[228:231], v[104:107], v[208:211]
    v_dot2c_f32_bf16 v250, v157, v19
    v_dot2c_f32_bf16 v253, v158, v18
    v_mfma_f32_16x16x32_bf16 v[212:215], v[228:231], v[108:111], v[212:215]
    ds_read_b128 v[244:247], v5 offset:25600
    v_mul_f32 v199, v199, v10
    v_dot2c_f32_bf16 v252, v158, v19
    v_dot2c_f32_bf16 v255, v159, v18
    s_waitcnt lgkmcnt(3)
    v_mfma_f32_16x16x32_bf16 v[200:203], v[232:235], v[112:115], v[200:203]
    v_dot2c_f32_bf16 v254, v159, v19
    v_lshlrev_b32 v16, 16, v13
    v_mfma_f32_16x16x32_bf16 v[204:207], v[232:235], v[116:119], v[204:207]
    ds_read_b128 v[224:227], v5 offset:26624
    v_cvt_pk_bf16_f32 v220, v188, v189
    v_mul_f32 v17, 0xbfb8aa3b, v16
    s_waitcnt lgkmcnt(3)
    v_mfma_f32_16x16x32_bf16 v[208:211], v[236:239], v[112:115], v[208:211]
    v_exp_f32 v17, v17
    s_nop 0
    v_add_f32 v17, 1.0, v17
    v_mfma_f32_16x16x32_bf16 v[212:215], v[236:239], v[116:119], v[212:215]
    ds_read_b128 v[228:231], v5 offset:27648
    v_cvt_pk_bf16_f32 v221, v190, v191
    v_rcp_f32 v17, v17
    s_nop 0
    v_mul_f32 v16, v16, v17
    s_waitcnt lgkmcnt(3)
    v_mfma_f32_16x16x32_bf16 v[200:203], v[240:243], v[120:123], v[200:203]
    v_cvt_pk_bf16_f32 v16, v16, v16
    v_lshlrev_b32 v16, 16, v16
    v_mfma_f32_16x16x32_bf16 v[204:207], v[240:243], v[124:127], v[204:207]
    ds_read_b128 v[232:235], v5 offset:28672
    v_cvt_pk_bf16_f32 v222, v196, v197
    v_lshrrev_b32 v17, 16, v16
    s_waitcnt vmcnt(13)
    v_dot2c_f32_bf16 v249, v160, v16
    s_waitcnt lgkmcnt(3)
    v_mfma_f32_16x16x32_bf16 v[208:211], v[244:247], v[120:123], v[208:211]
    v_dot2c_f32_bf16 v248, v160, v17
    v_mfma_f32_16x16x32_bf16 v[212:215], v[244:247], v[124:127], v[212:215]
    ds_read_b128 v[236:239], v5 offset:29696
    v_cvt_pk_bf16_f32 v223, v198, v199
    v_dot2c_f32_bf16 v251, v161, v16
    v_dot2c_f32_bf16 v250, v161, v17
    s_waitcnt lgkmcnt(3)
    v_mfma_f32_16x16x32_bf16 v[200:203], v[224:227], v[128:131], v[200:203]
    v_dot2c_f32_bf16 v253, v162, v16
    v_dot2c_f32_bf16 v252, v162, v17
    v_mfma_f32_16x16x32_bf16 v[204:207], v[224:227], v[132:135], v[204:207]
    ds_read_b128 v[240:243], v5 offset:30720
    buffer_store_dwordx4 v[220:223], v2, s[8:11], s26 offen offset:0 sc1
    v_dot2c_f32_bf16 v255, v163, v16
    v_dot2c_f32_bf16 v254, v163, v17
    s_waitcnt lgkmcnt(3)
    v_mfma_f32_16x16x32_bf16 v[208:211], v[228:231], v[128:131], v[208:211]
    v_and_b32 v18, 0xffff0000, v13
    v_mul_f32 v19, 0xbfb8aa3b, v18
    v_mfma_f32_16x16x32_bf16 v[212:215], v[228:231], v[132:135], v[212:215]
    ds_read_b128 v[244:247], v5 offset:31744
    v_exp_f32 v19, v19
    s_waitcnt lgkmcnt(3)
    v_mfma_f32_16x16x32_bf16 v[200:203], v[232:235], v[136:139], v[200:203]
    v_add_f32 v19, 1.0, v19
    v_rcp_f32 v19, v19
    v_mfma_f32_16x16x32_bf16 v[204:207], v[232:235], v[140:143], v[204:207]
    s_waitcnt vmcnt(8)
    s_barrier
    ds_read_b128 v[224:227], v4 offset:0
    v_mul_f32 v18, v18, v19
    v_cvt_pk_bf16_f32 v18, v18, v18
    s_waitcnt lgkmcnt(3)
    v_mfma_f32_16x16x32_bf16 v[208:211], v[236:239], v[136:139], v[208:211]
    v_lshlrev_b32 v18, 16, v18
    v_lshrrev_b32 v19, 16, v18
    v_mfma_f32_16x16x32_bf16 v[212:215], v[236:239], v[140:143], v[212:215]
    s_add_u32 s22, s24, 0x0
    s_add_u32 m0, s20, 0x20000
    s_nop 0
    buffer_load_dwordx4 v3, s[4:7], s22 offen lds
    ds_read_b128 v[228:231], v4 offset:1024
    v_dot2c_f32_bf16 v249, v164, v18
    v_dot2c_f32_bf16 v248, v164, v19
    s_waitcnt lgkmcnt(3)
    v_mfma_f32_16x16x32_bf16 v[200:203], v[240:243], v[144:147], v[200:203]
    v_dot2c_f32_bf16 v251, v165, v18
    v_mfma_f32_16x16x32_bf16 v[204:207], v[240:243], v[148:151], v[204:207]
    ds_read_b128 v[232:235], v4 offset:2048
    v_dot2c_f32_bf16 v250, v165, v19
    v_dot2c_f32_bf16 v253, v166, v18
    s_waitcnt lgkmcnt(3)
    v_mfma_f32_16x16x32_bf16 v[208:211], v[244:247], v[144:147], v[208:211]
    v_dot2c_f32_bf16 v252, v166, v19
    v_dot2c_f32_bf16 v255, v167, v18
    v_mfma_f32_16x16x32_bf16 v[212:215], v[244:247], v[148:151], v[212:215]
    ds_read_b128 v[236:239], v4 offset:3072
    v_dot2c_f32_bf16 v254, v167, v19
    v_lshlrev_b32 v16, 16, v14
    s_waitcnt lgkmcnt(3)
    v_mfma_f32_16x16x32_bf16 v[184:187], v[224:227], v[24:27], 0
    v_mul_f32 v17, 0xbfb8aa3b, v16
    v_exp_f32 v17, v17
    v_mfma_f32_16x16x32_bf16 v[188:191], v[224:227], v[28:31], 0
    ds_read_b128 v[240:243], v4 offset:4096
    v_add_f32 v17, 1.0, v17
    s_waitcnt lgkmcnt(3)
    v_mfma_f32_16x16x32_bf16 v[192:195], v[228:231], v[24:27], 0
    v_rcp_f32 v17, v17
    s_nop 0
    v_mul_f32 v16, v16, v17
    v_mfma_f32_16x16x32_bf16 v[196:199], v[228:231], v[28:31], 0
    s_add_u32 s22, s24, 0x2000
    s_add_u32 m0, s20, 0x20400
    s_nop 0
    buffer_load_dwordx4 v3, s[4:7], s22 offen lds
    ds_read_b128 v[244:247], v4 offset:5120
    v_mul_f32 v200, v200, v9
    v_cvt_pk_bf16_f32 v16, v16, v16
    v_lshlrev_b32 v16, 16, v16
    s_waitcnt lgkmcnt(3)
    v_mfma_f32_16x16x32_bf16 v[184:187], v[232:235], v[32:35], v[184:187]
    v_lshrrev_b32 v17, 16, v16
    v_dot2c_f32_bf16 v249, v168, v16
    v_mfma_f32_16x16x32_bf16 v[188:191], v[232:235], v[36:39], v[188:191]
    ds_read_b128 v[224:227], v4 offset:6144
    v_mul_f32 v201, v201, v9
    v_dot2c_f32_bf16 v248, v168, v17
    s_waitcnt lgkmcnt(3)
    v_mfma_f32_16x16x32_bf16 v[192:195], v[236:239], v[32:35], v[192:195]
    v_dot2c_f32_bf16 v251, v169, v16
    v_dot2c_f32_bf16 v250, v169, v17
    v_mfma_f32_16x16x32_bf16 v[196:199], v[236:239], v[36:39], v[196:199]
    ds_read_b128 v[228:231], v4 offset:7168
    v_mul_f32 v202, v202, v9
    v_dot2c_f32_bf16 v253, v170, v16
    v_dot2c_f32_bf16 v252, v170, v17
    s_waitcnt lgkmcnt(3)
    v_mfma_f32_16x16x32_bf16 v[184:187], v[240:243], v[40:43], v[184:187]
    v_dot2c_f32_bf16 v255, v171, v16
    v_dot2c_f32_bf16 v254, v171, v17
    v_mfma_f32_16x16x32_bf16 v[188:191], v[240:243], v[44:47], v[188:191]
    ds_read_b128 v[232:235], v4 offset:8192
    v_mul_f32 v203, v203, v9
    v_and_b32 v18, 0xffff0000, v14
    v_mul_f32 v19, 0xbfb8aa3b, v18
    s_waitcnt lgkmcnt(3)
    v_mfma_f32_16x16x32_bf16 v[192:195], v[244:247], v[40:43], v[192:195]
    v_exp_f32 v19, v19
    v_mfma_f32_16x16x32_bf16 v[196:199], v[244:247], v[44:47], v[196:199]
    ds_read_b128 v[236:239], v4 offset:9216
    v_mul_f32 v208, v208, v9
    v_add_f32 v19, 1.0, v19
    v_rcp_f32 v19, v19
    s_waitcnt lgkmcnt(3)
    v_mfma_f32_16x16x32_bf16 v[184:187], v[224:227], v[48:51], v[184:187]
    v_mul_f32 v18, v18, v19
    v_cvt_pk_bf16_f32 v18, v18, v18
    v_mfma_f32_16x16x32_bf16 v[188:191], v[224:227], v[52:55], v[188:191]
    ds_read_b128 v[240:243], v4 offset:10240
    v_mul_f32 v209, v209, v9
    v_lshlrev_b32 v18, 16, v18
    v_lshrrev_b32 v19, 16, v18
    s_waitcnt lgkmcnt(3)
    v_mfma_f32_16x16x32_bf16 v[192:195], v[228:231], v[48:51], v[192:195]
    v_dot2c_f32_bf16 v249, v172, v18
    v_dot2c_f32_bf16 v248, v172, v19
    v_mfma_f32_16x16x32_bf16 v[196:199], v[228:231], v[52:55], v[196:199]
    ds_read_b128 v[244:247], v4 offset:11264
    v_mul_f32 v210, v210, v9
    v_dot2c_f32_bf16 v251, v173, v18
    s_waitcnt lgkmcnt(3)
    v_mfma_f32_16x16x32_bf16 v[184:187], v[232:235], v[56:59], v[184:187]
    v_dot2c_f32_bf16 v250, v173, v19
    v_dot2c_f32_bf16 v253, v174, v18
    v_mfma_f32_16x16x32_bf16 v[188:191], v[232:235], v[60:63], v[188:191]
    ds_read_b128 v[224:227], v4 offset:12288
    v_mul_f32 v211, v211, v9
    v_dot2c_f32_bf16 v252, v174, v19
    v_dot2c_f32_bf16 v255, v175, v18
    s_waitcnt lgkmcnt(3)
    v_mfma_f32_16x16x32_bf16 v[192:195], v[236:239], v[56:59], v[192:195]
    v_dot2c_f32_bf16 v254, v175, v19
    v_lshlrev_b32 v16, 16, v15
    v_mfma_f32_16x16x32_bf16 v[196:199], v[236:239], v[60:63], v[196:199]
    ds_read_b128 v[228:231], v4 offset:13312
    v_cvt_pk_bf16_f32 v216, v200, v201
    v_mul_f32 v17, 0xbfb8aa3b, v16
    v_exp_f32 v17, v17
    s_waitcnt lgkmcnt(3)
    v_mfma_f32_16x16x32_bf16 v[184:187], v[240:243], v[64:67], v[184:187]
    v_add_f32 v17, 1.0, v17
    v_mfma_f32_16x16x32_bf16 v[188:191], v[240:243], v[68:71], v[188:191]
    ds_read_b128 v[232:235], v4 offset:14336
    v_cvt_pk_bf16_f32 v217, v202, v203
    v_rcp_f32 v17, v17
    s_nop 0
    v_mul_f32 v16, v16, v17
    s_waitcnt lgkmcnt(3)
    v_mfma_f32_16x16x32_bf16 v[192:195], v[244:247], v[64:67], v[192:195]
    v_cvt_pk_bf16_f32 v16, v16, v16
    v_lshlrev_b32 v16, 16, v16
    v_mfma_f32_16x16x32_bf16 v[196:199], v[244:247], v[68:71], v[196:199]
    ds_read_b128 v[236:239], v4 offset:15360
    v_cvt_pk_bf16_f32 v218, v208, v209
    v_lshrrev_b32 v17, 16, v16
    v_dot2c_f32_bf16 v249, v176, v16
    s_waitcnt lgkmcnt(3)
    v_mfma_f32_16x16x32_bf16 v[184:187], v[224:227], v[72:75], v[184:187]
    v_dot2c_f32_bf16 v248, v176, v17
    v_dot2c_f32_bf16 v251, v177, v16
    v_mfma_f32_16x16x32_bf16 v[188:191], v[224:227], v[76:79], v[188:191]
    s_waitcnt vmcnt(8)
    s_barrier
    ds_read_b128 v[240:243], v4 offset:16384
    v_cvt_pk_bf16_f32 v219, v210, v211
    v_dot2c_f32_bf16 v250, v177, v17
    s_waitcnt lgkmcnt(3)
    v_mfma_f32_16x16x32_bf16 v[192:195], v[228:231], v[72:75], v[192:195]
    v_dot2c_f32_bf16 v253, v178, v16
    v_dot2c_f32_bf16 v252, v178, v17
    v_mfma_f32_16x16x32_bf16 v[196:199], v[228:231], v[76:79], v[196:199]
    s_add_u32 s22, s24, 0x80000
    s_add_u32 m0, s20, 0x24000
    s_nop 0
    buffer_load_dwordx4 v3, s[4:7], s22 offen lds
    ds_read_b128 v[244:247], v4 offset:17408
    buffer_store_dwordx4 v[216:219], v2, s[8:11], s25 offen offset:1024 sc1
    v_dot2c_f32_bf16 v255, v179, v16
    v_dot2c_f32_bf16 v254, v179, v17
    s_waitcnt lgkmcnt(3)
    v_mfma_f32_16x16x32_bf16 v[184:187], v[232:235], v[80:83], v[184:187]
    v_and_b32 v18, 0xffff0000, v15
    v_mul_f32 v19, 0xbfb8aa3b, v18
    v_mfma_f32_16x16x32_bf16 v[188:191], v[232:235], v[84:87], v[188:191]
    ds_read_b128 v[224:227], v4 offset:18432
    v_mul_f32 v204, v204, v10
    v_exp_f32 v19, v19
    s_nop 0
    v_add_f32 v19, 1.0, v19
    s_waitcnt lgkmcnt(3)
    v_mfma_f32_16x16x32_bf16 v[192:195], v[236:239], v[80:83], v[192:195]
    v_rcp_f32 v19, v19
    v_mfma_f32_16x16x32_bf16 v[196:199], v[236:239], v[84:87], v[196:199]
    ds_read_b128 v[228:231], v4 offset:19456
    v_mul_f32 v205, v205, v10
    v_mul_f32 v18, v18, v19
    v_cvt_pk_bf16_f32 v18, v18, v18
    s_waitcnt lgkmcnt(3)
    v_mfma_f32_16x16x32_bf16 v[184:187], v[240:243], v[88:91], v[184:187]
    v_lshlrev_b32 v18, 16, v18
    v_lshrrev_b32 v19, 16, v18
    v_mfma_f32_16x16x32_bf16 v[188:191], v[240:243], v[92:95], v[188:191]
    ds_read_b128 v[232:235], v4 offset:20480
    v_mul_f32 v206, v206, v10
    v_dot2c_f32_bf16 v249, v180, v18
    v_dot2c_f32_bf16 v248, v180, v19
    s_waitcnt lgkmcnt(3)
    v_mfma_f32_16x16x32_bf16 v[192:195], v[244:247], v[88:91], v[192:195]
    v_dot2c_f32_bf16 v251, v181, v18
    v_dot2c_f32_bf16 v250, v181, v19
    v_mfma_f32_16x16x32_bf16 v[196:199], v[244:247], v[92:95], v[196:199]
    s_add_u32 s22, s24, 0x82000
    s_add_u32 m0, s20, 0x24400
    s_nop 0
    buffer_load_dwordx4 v3, s[4:7], s22 offen lds
    ds_read_b128 v[236:239], v4 offset:21504
    v_mul_f32 v207, v207, v10
    v_dot2c_f32_bf16 v253, v182, v18
    s_waitcnt lgkmcnt(3)
    v_mfma_f32_16x16x32_bf16 v[184:187], v[224:227], v[96:99], v[184:187]
    v_dot2c_f32_bf16 v252, v182, v19
    v_dot2c_f32_bf16 v255, v183, v18
    v_mfma_f32_16x16x32_bf16 v[188:191], v[224:227], v[100:103], v[188:191]
    ds_read_b128 v[240:243], v4 offset:22528
    v_mul_f32 v212, v212, v10
    v_dot2c_f32_bf16 v254, v183, v19
    v_permlane32_swap_b32 v248, v252
    s_waitcnt lgkmcnt(3)
    v_mfma_f32_16x16x32_bf16 v[192:195], v[228:231], v[96:99], v[192:195]
    v_permlane32_swap_b32 v249, v253
    v_permlane32_swap_b32 v250, v254
    v_mfma_f32_16x16x32_bf16 v[196:199], v[228:231], v[100:103], v[196:199]
    ds_read_b128 v[244:247], v4 offset:23552
    v_mul_f32 v213, v213, v10
    v_permlane32_swap_b32 v251, v255
    v_add_f32 v248, v248, v252
    s_waitcnt lgkmcnt(3)
    v_mfma_f32_16x16x32_bf16 v[184:187], v[232:235], v[104:107], v[184:187]
    v_add_f32 v249, v249, v253
    v_mfma_f32_16x16x32_bf16 v[188:191], v[232:235], v[108:111], v[188:191]
    ds_read_b128 v[224:227], v4 offset:24576
    v_mul_f32 v214, v214, v10
    v_add_f32 v250, v250, v254
    v_add_f32 v251, v251, v255
    s_waitcnt lgkmcnt(3)
    v_mfma_f32_16x16x32_bf16 v[192:195], v[236:239], v[104:107], v[192:195]
    v_permlane16_swap_b32 v248, v250
    v_permlane16_swap_b32 v249, v251
    v_mfma_f32_16x16x32_bf16 v[196:199], v[236:239], v[108:111], v[196:199]
    ds_read_b128 v[228:231], v4 offset:25600
    v_mul_f32 v215, v215, v10
    v_add_f32 v248, v248, v250
    v_add_f32 v249, v249, v251
    s_waitcnt lgkmcnt(3)
    v_mfma_f32_16x16x32_bf16 v[184:187], v[240:243], v[112:115], v[184:187]
    v_add_f32_dpp v248, v248, v248 row_ror:8 row_mask:0xf bank_mask:0xf
    v_add_f32_dpp v249, v249, v249 row_ror:8 row_mask:0xf bank_mask:0xf
    v_mfma_f32_16x16x32_bf16 v[188:191], v[240:243], v[116:119], v[188:191]
    ds_read_b128 v[232:235], v4 offset:26624
    v_cvt_pk_bf16_f32 v220, v204, v205
    v_and_b32 v16, 7, v1
    s_waitcnt lgkmcnt(3)
    v_mfma_f32_16x16x32_bf16 v[192:195], v[244:247], v[112:115], v[192:195]
    v_lshlrev_b32 v16, 5, v16
    v_lshrrev_b32 v17, 4, v1
    v_mfma_f32_16x16x32_bf16 v[196:199], v[244:247], v[116:119], v[196:199]
    ds_read_b128 v[236:239], v4 offset:27648
    v_cvt_pk_bf16_f32 v221, v206, v207
    v_lshl_add_u32 v16, v17, 3, v16
    s_lshl_b32 s16, s3, 8
    s_waitcnt lgkmcnt(3)
    v_mfma_f32_16x16x32_bf16 v[184:187], v[224:227], v[120:123], v[184:187]
    s_add_u32 s16, s16, 64512
    v_add_u32 v16, s16, v16
    v_mfma_f32_16x16x32_bf16 v[188:191], v[224:227], v[124:127], v[188:191]
    ds_read_b128 v[240:243], v4 offset:28672
    v_cvt_pk_bf16_f32 v222, v212, v213
    ds_write_b64 v16, v[248:249]
    s_waitcnt lgkmcnt(4)
    v_mfma_f32_16x16x32_bf16 v[192:195], v[228:231], v[120:123], v[192:195]
    v_mfma_f32_16x16x32_bf16 v[196:199], v[228:231], v[124:127], v[196:199]
    ds_read_b128 v[244:247], v4 offset:29696
    v_cvt_pk_bf16_f32 v223, v214, v215
    s_waitcnt lgkmcnt(0)
    v_mfma_f32_16x16x32_bf16 v[184:187], v[232:235], v[128:131], v[184:187]
    v_mfma_f32_16x16x32_bf16 v[188:191], v[232:235], v[132:135], v[188:191]
    ds_read_b128 v[224:227], v4 offset:30720
    buffer_store_dwordx4 v[220:223], v2, s[8:11], s26 offen offset:1024 sc1
    v_mfma_f32_16x16x32_bf16 v[192:195], v[236:239], v[128:131], v[192:195]
    v_mfma_f32_16x16x32_bf16 v[196:199], v[236:239], v[132:135], v[196:199]
    ds_read_b128 v[228:231], v4 offset:31744
    v_mfma_f32_16x16x32_bf16 v[184:187], v[240:243], v[136:139], v[184:187]
    v_mfma_f32_16x16x32_bf16 v[188:191], v[240:243], v[140:143], v[188:191]
    s_waitcnt vmcnt(10)
    s_barrier
    ds_read_b128 v[232:235], v4 offset:32768
    v_mfma_f32_16x16x32_bf16 v[192:195], v[244:247], v[136:139], v[192:195]
    v_mfma_f32_16x16x32_bf16 v[196:199], v[244:247], v[140:143], v[196:199]
    s_add_u32 s22, s24, 0x100000
    s_add_u32 m0, s20, 0x10000
    s_nop 0
    buffer_load_dwordx4 v3, s[4:7], s22 offen lds
    ds_read_b128 v[236:239], v4 offset:33792
    s_waitcnt lgkmcnt(3)
    v_mfma_f32_16x16x32_bf16 v[184:187], v[224:227], v[144:147], v[184:187]
    v_lshlrev_b32 v16, 2, v1
    v_add_u32 v17, 64512, v16
    ds_read_b32 v248, v17 offset:0
    ds_read_b32 v249, v17 offset:256
    ds_read_b32 v250, v17 offset:512
    ds_read_b32 v251, v17 offset:768
    v_mfma_f32_16x16x32_bf16 v[188:191], v[224:227], v[148:151], v[188:191]
    ds_read_b128 v[240:243], v4 offset:34816
    s_waitcnt lgkmcnt(7)
    v_mfma_f32_16x16x32_bf16 v[192:195], v[228:231], v[144:147], v[192:195]
    v_mfma_f32_16x16x32_bf16 v[196:199], v[228:231], v[148:151], v[196:199]
    ds_read_b128 v[244:247], v4 offset:35840
    s_waitcnt lgkmcnt(7)
    v_mfma_f32_16x16x32_bf16 v[200:203], v[232:235], v[24:27], 0
    s_waitcnt lgkmcnt(4)
    v_add_f32 v248, v248, v249
    s_waitcnt lgkmcnt(2)
    v_add_f32 v250, v250, v251
    v_add_f32 v248, v248, v250
    s_lshl_b32 s16, s15, 14
    s_lshl_b32 s17, s14, 8
    s_add_u32 s16, s16, s17
    s_add_u32 s16, s16, 0x550000
    s_cmp_eq_u32 s3, 0
    s_cselect_b32 s16, s16, 0x7ffffff0
    buffer_store_dword v248, v16, s[8:11], s16 offen sc1
    v_mfma_f32_16x16x32_bf16 v[204:207], v[232:235], v[28:31], 0
    ds_read_b128 v[224:227], v4 offset:36864
    v_mfma_f32_16x16x32_bf16 v[208:211], v[236:239], v[24:27], 0
    v_mfma_f32_16x16x32_bf16 v[212:215], v[236:239], v[28:31], 0
    s_add_u32 s22, s24, 0x102000
    s_add_u32 m0, s20, 0x10400
    s_nop 0
    buffer_load_dwordx4 v3, s[4:7], s22 offen lds
    ds_read_b128 v[228:231], v4 offset:37888
    v_mul_f32 v184, v184, v9
    s_waitcnt lgkmcnt(3)
    v_mfma_f32_16x16x32_bf16 v[200:203], v[240:243], v[32:35], v[200:203]
    v_mfma_f32_16x16x32_bf16 v[204:207], v[240:243], v[36:39], v[204:207]
    ds_read_b128 v[232:235], v4 offset:38912
    v_mul_f32 v185, v185, v9
    s_waitcnt lgkmcnt(3)
    v_mfma_f32_16x16x32_bf16 v[208:211], v[244:247], v[32:35], v[208:211]
    v_mfma_f32_16x16x32_bf16 v[212:215], v[244:247], v[36:39], v[212:215]
    ds_read_b128 v[236:239], v4 offset:39936
    v_mul_f32 v186, v186, v9
    s_waitcnt lgkmcnt(3)
    v_mfma_f32_16x16x32_bf16 v[200:203], v[224:227], v[40:43], v[200:203]
    s_waitcnt vmcnt(9)
    s_add_u32 s16, s63, 0x570000
    v_mov_b32 v20, s28
    v_mov_b32 v21, 0
    s_mov_b64 exec, 1
    buffer_store_dword v20, v21, s[8:11], s16 offen sc1
    s_mov_b64 exec, -1
    v_mfma_f32_16x16x32_bf16 v[204:207], v[224:227], v[44:47], v[204:207]
    ds_read_b128 v[240:243], v4 offset:40960
    v_mul_f32 v187, v187, v9
    s_waitcnt lgkmcnt(3)
    v_mfma_f32_16x16x32_bf16 v[208:211], v[228:231], v[40:43], v[208:211]
    v_mfma_f32_16x16x32_bf16 v[212:215], v[228:231], v[44:47], v[212:215]
    ds_read_b128 v[244:247], v4 offset:41984
    v_mul_f32 v192, v192, v9
    s_waitcnt lgkmcnt(3)
    v_mfma_f32_16x16x32_bf16 v[200:203], v[232:235], v[48:51], v[200:203]
    v_mfma_f32_16x16x32_bf16 v[204:207], v[232:235], v[52:55], v[204:207]
    ds_read_b128 v[224:227], v4 offset:43008
    v_mul_f32 v193, v193, v9
    s_waitcnt lgkmcnt(3)
    v_mfma_f32_16x16x32_bf16 v[208:211], v[236:239], v[48:51], v[208:211]
    v_mfma_f32_16x16x32_bf16 v[212:215], v[236:239], v[52:55], v[212:215]
    ds_read_b128 v[228:231], v4 offset:44032
    v_mul_f32 v194, v194, v9
    s_waitcnt lgkmcnt(3)
    v_mfma_f32_16x16x32_bf16 v[200:203], v[240:243], v[56:59], v[200:203]
    v_mfma_f32_16x16x32_bf16 v[204:207], v[240:243], v[60:63], v[204:207]
    ds_read_b128 v[232:235], v4 offset:45056
    v_mul_f32 v195, v195, v9
    s_waitcnt lgkmcnt(3)
    v_mfma_f32_16x16x32_bf16 v[208:211], v[244:247], v[56:59], v[208:211]
    v_mfma_f32_16x16x32_bf16 v[212:215], v[244:247], v[60:63], v[212:215]
    ds_read_b128 v[236:239], v4 offset:46080
    v_cvt_pk_bf16_f32 v216, v184, v185
    s_waitcnt lgkmcnt(3)
    v_mfma_f32_16x16x32_bf16 v[200:203], v[224:227], v[64:67], v[200:203]
    v_mfma_f32_16x16x32_bf16 v[204:207], v[224:227], v[68:71], v[204:207]
    ds_read_b128 v[240:243], v4 offset:47104
    v_cvt_pk_bf16_f32 v217, v186, v187
    s_waitcnt lgkmcnt(3)
    v_mfma_f32_16x16x32_bf16 v[208:211], v[228:231], v[64:67], v[208:211]
    v_mfma_f32_16x16x32_bf16 v[212:215], v[228:231], v[68:71], v[212:215]
    ds_read_b128 v[244:247], v4 offset:48128
    v_cvt_pk_bf16_f32 v218, v192, v193
    s_waitcnt lgkmcnt(3)
    v_mfma_f32_16x16x32_bf16 v[200:203], v[232:235], v[72:75], v[200:203]
    v_mfma_f32_16x16x32_bf16 v[204:207], v[232:235], v[76:79], v[204:207]
    s_barrier
    ds_read_b128 v[224:227], v4 offset:49152
    v_cvt_pk_bf16_f32 v219, v194, v195
    s_waitcnt lgkmcnt(3)
    v_mfma_f32_16x16x32_bf16 v[208:211], v[236:239], v[72:75], v[208:211]
    v_mfma_f32_16x16x32_bf16 v[212:215], v[236:239], v[76:79], v[212:215]
    s_add_u32 s22, s24, 0x180000
    s_add_u32 m0, s20, 0x14000
    s_nop 0
    buffer_load_dwordx4 v3, s[4:7], s22 offen lds
    ds_read_b128 v[228:231], v4 offset:50176
    buffer_store_dwordx4 v[216:219], v2, s[8:11], s25 offen offset:2048 sc1
    s_waitcnt lgkmcnt(3)
    v_mfma_f32_16x16x32_bf16 v[200:203], v[240:243], v[80:83], v[200:203]
    v_mfma_f32_16x16x32_bf16 v[204:207], v[240:243], v[84:87], v[204:207]
    ds_read_b128 v[232:235], v4 offset:51200
    v_mul_f32 v188, v188, v10
    s_waitcnt lgkmcnt(3)
    v_mfma_f32_16x16x32_bf16 v[208:211], v[244:247], v[80:83], v[208:211]
    v_mfma_f32_16x16x32_bf16 v[212:215], v[244:247], v[84:87], v[212:215]
    ds_read_b128 v[236:239], v4 offset:52224
    v_mul_f32 v189, v189, v10
    s_waitcnt lgkmcnt(3)
    v_mfma_f32_16x16x32_bf16 v[200:203], v[224:227], v[88:91], v[200:203]
    v_mfma_f32_16x16x32_bf16 v[204:207], v[224:227], v[92:95], v[204:207]
    ds_read_b128 v[240:243], v4 offset:53248
    v_mul_f32 v190, v190, v10
    s_waitcnt lgkmcnt(3)
    v_mfma_f32_16x16x32_bf16 v[208:211], v[228:231], v[88:91], v[208:211]
    v_mfma_f32_16x16x32_bf16 v[212:215], v[228:231], v[92:95], v[212:215]
    s_add_u32 s22, s24, 0x182000
    s_add_u32 m0, s20, 0x14400
    s_nop 0
    buffer_load_dwordx4 v3, s[4:7], s22 offen lds
    ds_read_b128 v[244:247], v4 offset:54272
    v_mul_f32 v191, v191, v10
    s_waitcnt lgkmcnt(3)
    v_mfma_f32_16x16x32_bf16 v[200:203], v[232:235], v[96:99], v[200:203]
    v_mfma_f32_16x16x32_bf16 v[204:207], v[232:235], v[100:103], v[204:207]
    ds_read_b128 v[224:227], v4 offset:55296
    v_mul_f32 v196, v196, v10
    s_waitcnt lgkmcnt(3)
    v_mfma_f32_16x16x32_bf16 v[208:211], v[236:239], v[96:99], v[208:211]
    v_mfma_f32_16x16x32_bf16 v[212:215], v[236:239], v[100:103], v[212:215]
    ds_read_b128 v[228:231], v4 offset:56320
    v_mul_f32 v197, v197, v10
    s_waitcnt lgkmcnt(3)
    v_mfma_f32_16x16x32_bf16 v[200:203], v[240:243], v[104:107], v[200:203]
    v_mfma_f32_16x16x32_bf16 v[204:207], v[240:243], v[108:111], v[204:207]
    ds_read_b128 v[232:235], v4 offset:57344
    v_mul_f32 v198, v198, v10
    s_waitcnt lgkmcnt(3)
    v_mfma_f32_16x16x32_bf16 v[208:211], v[244:247], v[104:107], v[208:211]
    v_mfma_f32_16x16x32_bf16 v[212:215], v[244:247], v[108:111], v[212:215]
    ds_read_b128 v[236:239], v4 offset:58368
    v_mul_f32 v199, v199, v10
    s_waitcnt lgkmcnt(3)
    v_mfma_f32_16x16x32_bf16 v[200:203], v[224:227], v[112:115], v[200:203]
    v_mfma_f32_16x16x32_bf16 v[204:207], v[224:227], v[116:119], v[204:207]
    ds_read_b128 v[240:243], v4 offset:59392
    v_cvt_pk_bf16_f32 v220, v188, v189
    s_waitcnt lgkmcnt(3)
    v_mfma_f32_16x16x32_bf16 v[208:211], v[228:231], v[112:115], v[208:211]
    v_mfma_f32_16x16x32_bf16 v[212:215], v[228:231], v[116:119], v[212:215]
    ds_read_b128 v[244:247], v4 offset:60416
    v_cvt_pk_bf16_f32 v221, v190, v191
    s_waitcnt lgkmcnt(3)
    v_mfma_f32_16x16x32_bf16 v[200:203], v[232:235], v[120:123], v[200:203]
    v_mfma_f32_16x16x32_bf16 v[204:207], v[232:235], v[124:127], v[204:207]
    ds_read_b128 v[224:227], v4 offset:61440
    v_cvt_pk_bf16_f32 v222, v196, v197
    s_waitcnt lgkmcnt(3)
    v_mfma_f32_16x16x32_bf16 v[208:211], v[236:239], v[120:123], v[208:211]
    v_mfma_f32_16x16x32_bf16 v[212:215], v[236:239], v[124:127], v[212:215]
    ds_read_b128 v[228:231], v4 offset:62464
    v_cvt_pk_bf16_f32 v223, v198, v199
    s_waitcnt lgkmcnt(3)
    v_mfma_f32_16x16x32_bf16 v[200:203], v[240:243], v[128:131], v[200:203]
    v_mfma_f32_16x16x32_bf16 v[204:207], v[240:243], v[132:135], v[204:207]
    ds_read_b128 v[232:235], v4 offset:63488
    buffer_store_dwordx4 v[220:223], v2, s[8:11], s26 offen offset:2048 sc1
    s_waitcnt lgkmcnt(3)
    v_mfma_f32_16x16x32_bf16 v[208:211], v[244:247], v[128:131], v[208:211]
    v_mfma_f32_16x16x32_bf16 v[212:215], v[244:247], v[132:135], v[212:215]
    ds_read_b128 v[236:239], v4 offset:64512
    s_waitcnt lgkmcnt(3)
    v_mfma_f32_16x16x32_bf16 v[200:203], v[224:227], v[136:139], v[200:203]
    v_mfma_f32_16x16x32_bf16 v[204:207], v[224:227], v[140:143], v[204:207]
    s_waitcnt lgkmcnt(2)
    v_mfma_f32_16x16x32_bf16 v[208:211], v[228:231], v[136:139], v[208:211]
    v_mfma_f32_16x16x32_bf16 v[212:215], v[228:231], v[140:143], v[212:215]
    s_waitcnt lgkmcnt(1)
    v_mfma_f32_16x16x32_bf16 v[200:203], v[232:235], v[144:147], v[200:203]
    v_mfma_f32_16x16x32_bf16 v[204:207], v[232:235], v[148:151], v[204:207]
    s_waitcnt lgkmcnt(0)
    v_mfma_f32_16x16x32_bf16 v[208:211], v[236:239], v[144:147], v[208:211]
    v_mfma_f32_16x16x32_bf16 v[212:215], v[236:239], v[148:151], v[212:215]
    s_waitcnt vmcnt(8)
    s_add_u32 s16, s63, 0x572000
    v_mov_b32 v20, s28
    v_mov_b32 v21, 0
    s_mov_b64 exec, 1
    buffer_store_dword v20, v21, s[8:11], s16 offen sc1
    s_mov_b64 exec, -1
    v_mul_f32 v200, v200, v9
    v_mul_f32 v201, v201, v9
    v_mul_f32 v202, v202, v9
    v_mul_f32 v203, v203, v9
    v_mul_f32 v208, v208, v9
    v_mul_f32 v209, v209, v9
    v_mul_f32 v210, v210, v9
    v_mul_f32 v211, v211, v9
    v_cvt_pk_bf16_f32 v216, v200, v201
    v_cvt_pk_bf16_f32 v217, v202, v203
    v_cvt_pk_bf16_f32 v218, v208, v209
    v_cvt_pk_bf16_f32 v219, v210, v211
    buffer_store_dwordx4 v[216:219], v2, s[8:11], s25 offen offset:3072 sc1
    v_mul_f32 v204, v204, v10
    v_mul_f32 v205, v205, v10
    v_mul_f32 v206, v206, v10
    v_mul_f32 v207, v207, v10
    v_mul_f32 v212, v212, v10
    v_mul_f32 v213, v213, v10
    v_mul_f32 v214, v214, v10
    v_mul_f32 v215, v215, v10
    v_cvt_pk_bf16_f32 v220, v204, v205
    v_cvt_pk_bf16_f32 v221, v206, v207
    v_cvt_pk_bf16_f32 v222, v212, v213
    v_cvt_pk_bf16_f32 v223, v214, v215
    buffer_store_dwordx4 v[220:223], v2, s[8:11], s26 offen offset:3072 sc1
    s_bfe_u32 s30, s2, 0x20001
    s_lshl_b32 s30, s30, 2
    s_bfe_u32 s17, s2, 0x20003
    s_add_u32 s30, s30, s17
    s_lshr_b32 s31, s2, 5
    s_and_b32 s15, s2, 1
    v_bfe_u32 v18, v1, 2, 2
    v_lshrrev_b32 v19, 4, v1
    v_and_b32 v20, 3, v1
    v_lshlrev_b32 v4, 11, v19
    v_lshl_add_u32 v4, v18, 6, v4
    v_lshl_add_u32 v4, v20, 3, v4
    v_add_u32 v4, 0x10000, v4
    v_and_b32 v21, 1, v19
    v_lshlrev_b32 v21, 5, v21
    v_sub_u32 v5, v4, v21
    v_add_u32 v4, v4, v21
    v_add_u32 v7, 0x10000, v4
    v_add_u32 v8, 0x10000, v5
    s_and_b32 s17, s3, 3
    s_lshl_b32 s18, s30, 2
    s_add_u32 s18, s18, s17
    s_lshl_b32 s19, s18, 18
    s_lshl_b32 s23, s15, 16
    s_add_u32 s19, s19, s23
    s_add_u32 s19, s19, 0x1000000
    v_add_u32 v11, s19, v2
    s_lshl_b32 s18, s18, 7
    s_lshl_b32 s23, s15, 6
    s_add_u32 s18, s18, s23
    s_add_u32 s18, s18, 0x570000
    v_and_b32 v18, 15, v1
    v_lshlrev_b32 v18, 2, v18
    s_mov_b32 s27, 0
adaLN_cond__sliding_block_cached__moe_arch_mod__prompt_kernel_o5p:
    buffer_load_dword v19, v18, s[8:11], s18 offen sc1
    s_waitcnt vmcnt(0)
    v_cmp_ne_u32 vcc, s28, v19
    s_add_u32 s27, s27, 1
    s_cmp_ge_u32 s27, 262144
    s_cbranch_scc1 adaLN_cond__sliding_block_cached__moe_arch_mod__prompt_kernel_o5g
    s_cbranch_vccnz adaLN_cond__sliding_block_cached__moe_arch_mod__prompt_kernel_o5p
adaLN_cond__sliding_block_cached__moe_arch_mod__prompt_kernel_o5g:
    s_mov_b32 s23, 0x0
    buffer_load_dwordx4 v[88:91], v11, s[8:11], s23 offen offset:0 sc1
    s_mov_b32 s23, 0x20000
    buffer_load_dwordx4 v[92:95], v11, s[8:11], s23 offen offset:0 sc1
    s_mov_b32 s23, 0x2000
    buffer_load_dwordx4 v[96:99], v11, s[8:11], s23 offen offset:0 sc1
    s_mov_b32 s23, 0x22000
    buffer_load_dwordx4 v[100:103], v11, s[8:11], s23 offen offset:0 sc1
    s_mov_b32 s23, 0x4000
    buffer_load_dwordx4 v[104:107], v11, s[8:11], s23 offen offset:0 sc1
    s_mov_b32 s23, 0x24000
    buffer_load_dwordx4 v[108:111], v11, s[8:11], s23 offen offset:0 sc1
    s_mov_b32 s23, 0x6000
    buffer_load_dwordx4 v[112:115], v11, s[8:11], s23 offen offset:0 sc1
    s_mov_b32 s23, 0x26000
    buffer_load_dwordx4 v[116:119], v11, s[8:11], s23 offen offset:0 sc1
    v_mov_b32 v13, v18
    s_barrier
    ds_read_b64_tr_b16 v[224:225], v7 offset:0
    ds_read_b64_tr_b16 v[226:227], v7 offset:1024
    ds_read_b64_tr_b16 v[228:229], v8 offset:32
    ds_read_b64_tr_b16 v[230:231], v8 offset:1056
    ds_read_b64_tr_b16 v[232:233], v7 offset:256
    ds_read_b64_tr_b16 v[234:235], v7 offset:1280
    ds_read_b64_tr_b16 v[236:237], v8 offset:288
    ds_read_b64_tr_b16 v[238:239], v8 offset:1312
    s_waitcnt vmcnt(7) lgkmcnt(6)
    v_mfma_f32_16x16x32_bf16 v[24:27], v[224:227], v[88:91], 0
    ds_read_b64_tr_b16 v[240:241], v7 offset:512
    s_waitcnt vmcnt(6)
    v_mfma_f32_16x16x32_bf16 v[28:31], v[224:227], v[92:95], 0
    s_add_u32 s22, s24, 0x200000
    s_add_u32 m0, s20, 0x18000
    s_nop 0
    buffer_load_dwordx4 v3, s[4:7], s22 offen lds
    ds_read_b64_tr_b16 v[242:243], v7 offset:1536
    s_waitcnt lgkmcnt(6)
    v_mfma_f32_16x16x32_bf16 v[32:35], v[228:231], v[88:91], 0
    ds_read_b64_tr_b16 v[244:245], v8 offset:544
    s_mov_b32 s23, 0x8000
    buffer_load_dwordx4 v[120:123], v11, s[8:11], s23 offen offset:0 sc1
    v_mfma_f32_16x16x32_bf16 v[36:39], v[228:231], v[92:95], 0
    ds_read_b64_tr_b16 v[246:247], v8 offset:1568
    s_waitcnt lgkmcnt(6)
    v_mfma_f32_16x16x32_bf16 v[40:43], v[232:235], v[88:91], 0
    ds_read_b64_tr_b16 v[224:225], v7 offset:768
    v_mfma_f32_16x16x32_bf16 v[44:47], v[232:235], v[92:95], 0
    ds_read_b64_tr_b16 v[226:227], v7 offset:1792
    s_waitcnt lgkmcnt(6)
    v_mfma_f32_16x16x32_bf16 v[48:51], v[236:239], v[88:91], 0
    ds_read_b64_tr_b16 v[228:229], v8 offset:800
    v_mfma_f32_16x16x32_bf16 v[52:55], v[236:239], v[92:95], 0
    ds_read_b64_tr_b16 v[230:231], v8 offset:1824
    s_waitcnt lgkmcnt(6)
    v_mfma_f32_16x16x32_bf16 v[56:59], v[240:243], v[88:91], 0
    s_add_u32 s22, s24, 0x202000
    s_add_u32 m0, s20, 0x18400
    s_nop 0
    buffer_load_dwordx4 v3, s[4:7], s22 offen lds
    s_mov_b32 s23, 0x28000
    buffer_load_dwordx4 v[124:127], v11, s[8:11], s23 offen offset:0 sc1
    v_mfma_f32_16x16x32_bf16 v[60:63], v[240:243], v[92:95], 0
    s_barrier
    ds_read_b64_tr_b16 v[232:233], v7 offset:16384
    ds_read_b64_tr_b16 v[234:235], v7 offset:17408
    s_waitcnt lgkmcnt(6)
    v_mfma_f32_16x16x32_bf16 v[64:67], v[244:247], v[88:91], 0
    s_add_u32 s22, s24, 0x280000
    s_add_u32 m0, s20, 0x1c000
    s_nop 0
    buffer_load_dwordx4 v3, s[4:7], s22 offen lds
    ds_read_b64_tr_b16 v[236:237], v8 offset:16416
    v_mfma_f32_16x16x32_bf16 v[68:71], v[244:247], v[92:95], 0
    ds_read_b64_tr_b16 v[238:239], v8 offset:17440
    s_waitcnt lgkmcnt(6)
    v_mfma_f32_16x16x32_bf16 v[72:75], v[224:227], v[88:91], 0
    ds_read_b64_tr_b16 v[240:241], v7 offset:16640
    v_mfma_f32_16x16x32_bf16 v[76:79], v[224:227], v[92:95], 0
    ds_read_b64_tr_b16 v[242:243], v7 offset:17664
    s_waitcnt lgkmcnt(6)
    v_mfma_f32_16x16x32_bf16 v[80:83], v[228:231], v[88:91], 0
    ds_read_b64_tr_b16 v[244:245], v8 offset:16672
    v_mfma_f32_16x16x32_bf16 v[84:87], v[228:231], v[92:95], 0
    ds_read_b64_tr_b16 v[246:247], v8 offset:17696
    s_waitcnt vmcnt(10) lgkmcnt(6)
    v_mfma_f32_16x16x32_bf16 v[24:27], v[232:235], v[96:99], v[24:27]
    ds_read_b64_tr_b16 v[224:225], v7 offset:16896
    s_waitcnt vmcnt(9)
    v_mfma_f32_16x16x32_bf16 v[28:31], v[232:235], v[100:103], v[28:31]
    s_add_u32 s22, s24, 0x282000
    s_add_u32 m0, s20, 0x1c400
    s_nop 0
    buffer_load_dwordx4 v3, s[4:7], s22 offen lds
    ds_read_b64_tr_b16 v[226:227], v7 offset:17920
    s_waitcnt lgkmcnt(6)
    v_mfma_f32_16x16x32_bf16 v[32:35], v[236:239], v[96:99], v[32:35]
    ds_read_b64_tr_b16 v[228:229], v8 offset:16928
    s_mov_b32 s23, 0xa000
    buffer_load_dwordx4 v[88:91], v11, s[8:11], s23 offen offset:0 sc1
    v_mfma_f32_16x16x32_bf16 v[36:39], v[236:239], v[100:103], v[36:39]
    ds_read_b64_tr_b16 v[230:231], v8 offset:17952
    s_waitcnt lgkmcnt(6)
    v_mfma_f32_16x16x32_bf16 v[40:43], v[240:243], v[96:99], v[40:43]
    s_add_u32 s16, s63, 0x574000
    v_mov_b32 v20, s28
    v_mov_b32 v21, 0
    s_mov_b64 exec, 1
    buffer_store_dword v20, v21, s[8:11], s16 offen sc1
    s_mov_b64 exec, -1
    ds_read_b64_tr_b16 v[232:233], v7 offset:17152
    v_mfma_f32_16x16x32_bf16 v[44:47], v[240:243], v[100:103], v[44:47]
    ds_read_b64_tr_b16 v[234:235], v7 offset:18176
    s_waitcnt lgkmcnt(6)
    v_mfma_f32_16x16x32_bf16 v[48:51], v[244:247], v[96:99], v[48:51]
    ds_read_b64_tr_b16 v[236:237], v8 offset:17184
    v_mfma_f32_16x16x32_bf16 v[52:55], v[244:247], v[100:103], v[52:55]
    ds_read_b64_tr_b16 v[238:239], v8 offset:18208
    s_waitcnt lgkmcnt(6)
    v_mfma_f32_16x16x32_bf16 v[56:59], v[224:227], v[96:99], v[56:59]
    v_mov_b32 v251, s28
    v_mov_b32 v252, 0
    s_lshl_b32 s16, s2, 2
    s_add_u32 s16, s16, 0x560000
    s_cmp_eq_u32 s3, 0
    s_cselect_b32 s16, s16, 0x7ffffff0
    s_mov_b64 exec, 1
    buffer_store_dword v251, v252, s[8:11], s16 offen sc1
    s_mov_b64 exec, -1
    s_mov_b32 s23, 0x2a000
    buffer_load_dwordx4 v[92:95], v11, s[8:11], s23 offen offset:0 sc1
    v_mfma_f32_16x16x32_bf16 v[60:63], v[224:227], v[100:103], v[60:63]
    s_barrier
    ds_read_b64_tr_b16 v[240:241], v4 offset:0
    ds_read_b64_tr_b16 v[242:243], v4 offset:1024
    s_waitcnt lgkmcnt(6)
    v_mfma_f32_16x16x32_bf16 v[64:67], v[228:231], v[96:99], v[64:67]
    s_add_u32 s22, s24, 0x300000
    s_add_u32 m0, s20, 0x20000
    s_nop 0
    buffer_load_dwordx4 v3, s[4:7], s22 offen lds
    ds_read_b64_tr_b16 v[244:245], v5 offset:32
    v_mfma_f32_16x16x32_bf16 v[68:71], v[228:231], v[100:103], v[68:71]
    ds_read_b64_tr_b16 v[246:247], v5 offset:1056
    s_waitcnt lgkmcnt(6)
    v_mfma_f32_16x16x32_bf16 v[72:75], v[232:235], v[96:99], v[72:75]
    ds_read_b64_tr_b16 v[224:225], v4 offset:256
    v_mfma_f32_16x16x32_bf16 v[76:79], v[232:235], v[100:103], v[76:79]
    ds_read_b64_tr_b16 v[226:227], v4 offset:1280
    s_waitcnt lgkmcnt(6)
    v_mfma_f32_16x16x32_bf16 v[80:83], v[236:239], v[96:99], v[80:83]
    ds_read_b64_tr_b16 v[228:229], v5 offset:288
    v_mfma_f32_16x16x32_bf16 v[84:87], v[236:239], v[100:103], v[84:87]
    ds_read_b64_tr_b16 v[230:231], v5 offset:1312
    s_waitcnt vmcnt(14) lgkmcnt(6)
    v_mfma_f32_16x16x32_bf16 v[24:27], v[240:243], v[104:107], v[24:27]
    ds_read_b64_tr_b16 v[232:233], v4 offset:512
    s_waitcnt vmcnt(13)
    v_mfma_f32_16x16x32_bf16 v[28:31], v[240:243], v[108:111], v[28:31]
    s_add_u32 s22, s24, 0x302000
    s_add_u32 m0, s20, 0x20400
    s_nop 0
    buffer_load_dwordx4 v3, s[4:7], s22 offen lds
    ds_read_b64_tr_b16 v[234:235], v4 offset:1536
    s_waitcnt lgkmcnt(6)
    v_mfma_f32_16x16x32_bf16 v[32:35], v[244:247], v[104:107], v[32:35]
    ds_read_b64_tr_b16 v[236:237], v5 offset:544
    s_mov_b32 s23, 0xc000
    buffer_load_dwordx4 v[96:99], v11, s[8:11], s23 offen offset:0 sc1
    v_mfma_f32_16x16x32_bf16 v[36:39], v[244:247], v[108:111], v[36:39]
    ds_read_b64_tr_b16 v[238:239], v5 offset:1568
    s_waitcnt lgkmcnt(6)
    v_mfma_f32_16x16x32_bf16 v[40:43], v[224:227], v[104:107], v[40:43]
    ds_read_b64_tr_b16 v[240:241], v4 offset:768
    v_mfma_f32_16x16x32_bf16 v[44:47], v[224:227], v[108:111], v[44:47]
    ds_read_b64_tr_b16 v[242:243], v4 offset:1792
    s_waitcnt lgkmcnt(6)
    v_mfma_f32_16x16x32_bf16 v[48:51], v[228:231], v[104:107], v[48:51]
    ds_read_b64_tr_b16 v[244:245], v5 offset:800
    v_mfma_f32_16x16x32_bf16 v[52:55], v[228:231], v[108:111], v[52:55]
    ds_read_b64_tr_b16 v[246:247], v5 offset:1824
    s_waitcnt lgkmcnt(6)
    v_mfma_f32_16x16x32_bf16 v[56:59], v[232:235], v[104:107], v[56:59]
    s_mov_b32 s23, 0x2c000
    buffer_load_dwordx4 v[100:103], v11, s[8:11], s23 offen offset:0 sc1
    v_mfma_f32_16x16x32_bf16 v[60:63], v[232:235], v[108:111], v[60:63]
    s_barrier
    ds_read_b64_tr_b16 v[224:225], v4 offset:16384
    ds_read_b64_tr_b16 v[226:227], v4 offset:17408
    s_add_u32 s17, s18, 8192
    buffer_load_dword v12, v13, s[8:11], s17 offen sc1
    s_waitcnt lgkmcnt(6)
    v_mfma_f32_16x16x32_bf16 v[64:67], v[236:239], v[104:107], v[64:67]
    s_add_u32 s22, s24, 0x380000
    s_add_u32 m0, s20, 0x24000
    s_nop 0
    buffer_load_dwordx4 v3, s[4:7], s22 offen lds
    ds_read_b64_tr_b16 v[228:229], v5 offset:16416
    v_mfma_f32_16x16x32_bf16 v[68:71], v[236:239], v[108:111], v[68:71]
    ds_read_b64_tr_b16 v[230:231], v5 offset:17440
    s_waitcnt lgkmcnt(6)
    v_mfma_f32_16x16x32_bf16 v[72:75], v[240:243], v[104:107], v[72:75]
    ds_read_b64_tr_b16 v[232:233], v4 offset:16640
    v_mfma_f32_16x16x32_bf16 v[76:79], v[240:243], v[108:111], v[76:79]
    ds_read_b64_tr_b16 v[234:235], v4 offset:17664
    s_waitcnt lgkmcnt(6)
    v_mfma_f32_16x16x32_bf16 v[80:83], v[244:247], v[104:107], v[80:83]
    ds_read_b64_tr_b16 v[236:237], v5 offset:16672
    v_mfma_f32_16x16x32_bf16 v[84:87], v[244:247], v[108:111], v[84:87]
    ds_read_b64_tr_b16 v[238:239], v5 offset:17696
    s_waitcnt vmcnt(17) lgkmcnt(6)
    v_mfma_f32_16x16x32_bf16 v[24:27], v[224:227], v[112:115], v[24:27]
    ds_read_b64_tr_b16 v[240:241], v4 offset:16896
    s_waitcnt vmcnt(16)
    v_mfma_f32_16x16x32_bf16 v[28:31], v[224:227], v[116:119], v[28:31]
    s_add_u32 s22, s24, 0x382000
    s_add_u32 m0, s20, 0x24400
    s_nop 0
    buffer_load_dwordx4 v3, s[4:7], s22 offen lds
    ds_read_b64_tr_b16 v[242:243], v4 offset:17920
    s_waitcnt lgkmcnt(6)
    v_mfma_f32_16x16x32_bf16 v[32:35], v[228:231], v[112:115], v[32:35]
    ds_read_b64_tr_b16 v[244:245], v5 offset:16928
    s_mov_b32 s23, 0xe000
    buffer_load_dwordx4 v[104:107], v11, s[8:11], s23 offen offset:0 sc1
    v_mfma_f32_16x16x32_bf16 v[36:39], v[228:231], v[116:119], v[36:39]
    ds_read_b64_tr_b16 v[246:247], v5 offset:17952
    s_waitcnt lgkmcnt(6)
    v_mfma_f32_16x16x32_bf16 v[40:43], v[232:235], v[112:115], v[40:43]
    ds_read_b64_tr_b16 v[224:225], v4 offset:17152
    v_mfma_f32_16x16x32_bf16 v[44:47], v[232:235], v[116:119], v[44:47]
    ds_read_b64_tr_b16 v[226:227], v4 offset:18176
    s_waitcnt lgkmcnt(6)
    v_mfma_f32_16x16x32_bf16 v[48:51], v[236:239], v[112:115], v[48:51]
    ds_read_b64_tr_b16 v[228:229], v5 offset:17184
    v_mfma_f32_16x16x32_bf16 v[52:55], v[236:239], v[116:119], v[52:55]
    ds_read_b64_tr_b16 v[230:231], v5 offset:18208
    s_waitcnt lgkmcnt(6)
    v_mfma_f32_16x16x32_bf16 v[56:59], v[240:243], v[112:115], v[56:59]
    s_mov_b32 s23, 0x2e000
    buffer_load_dwordx4 v[108:111], v11, s[8:11], s23 offen offset:0 sc1
    v_mfma_f32_16x16x32_bf16 v[60:63], v[240:243], v[116:119], v[60:63]
    s_waitcnt vmcnt(16)
    s_barrier
    ds_read_b64_tr_b16 v[232:233], v4 offset:32768
    ds_read_b64_tr_b16 v[234:235], v4 offset:33792
    s_waitcnt lgkmcnt(6)
    v_mfma_f32_16x16x32_bf16 v[64:67], v[244:247], v[112:115], v[64:67]
    s_add_u32 s22, s24, 0x10000
    s_add_u32 m0, s20, 0x10000
    s_nop 0
    buffer_load_dwordx4 v3, s[4:7], s22 offen lds
    ds_read_b64_tr_b16 v[236:237], v5 offset:32800
    v_mfma_f32_16x16x32_bf16 v[68:71], v[244:247], v[116:119], v[68:71]
    ds_read_b64_tr_b16 v[238:239], v5 offset:33824
    s_waitcnt lgkmcnt(6)
    v_mfma_f32_16x16x32_bf16 v[72:75], v[224:227], v[112:115], v[72:75]
    v_and_b32 v250, 3, v1
    v_lshlrev_b32 v250, 8, v250
    s_lshr_b32 s14, s2, 2
    s_lshl_b32 s14, s14, 2
    s_add_u32 s14, s14, 0x560000
    buffer_load_dword v248, v250, s[8:11], s14 offen sc1
    ds_read_b64_tr_b16 v[240:241], v4 offset:33024
    v_mfma_f32_16x16x32_bf16 v[76:79], v[224:227], v[116:119], v[76:79]
    ds_read_b64_tr_b16 v[242:243], v4 offset:34048
    s_waitcnt lgkmcnt(6)
    v_mfma_f32_16x16x32_bf16 v[80:83], v[228:231], v[112:115], v[80:83]
    ds_read_b64_tr_b16 v[244:245], v5 offset:33056
    v_mfma_f32_16x16x32_bf16 v[84:87], v[228:231], v[116:119], v[84:87]
    ds_read_b64_tr_b16 v[246:247], v5 offset:34080
    s_waitcnt vmcnt(6)
    v_cmp_ne_u32 vcc, s28, v12
    s_cbranch_vccnz adaLN_cond__sliding_block_cached__moe_arch_mod__prompt_kernel_o26r
adaLN_cond__sliding_block_cached__moe_arch_mod__prompt_kernel_o26b:
    s_waitcnt lgkmcnt(6)
    v_mfma_f32_16x16x32_bf16 v[24:27], v[232:235], v[120:123], v[24:27]
    ds_read_b64_tr_b16 v[224:225], v4 offset:33280
    v_mfma_f32_16x16x32_bf16 v[28:31], v[232:235], v[124:127], v[28:31]
    s_add_u32 s22, s24, 0x12000
    s_add_u32 m0, s20, 0x10400
    s_nop 0
    buffer_load_dwordx4 v3, s[4:7], s22 offen lds
    ds_read_b64_tr_b16 v[226:227], v4 offset:34304
    s_waitcnt lgkmcnt(6)
    v_mfma_f32_16x16x32_bf16 v[32:35], v[236:239], v[120:123], v[32:35]
    ds_read_b64_tr_b16 v[228:229], v5 offset:33312
    s_mov_b32 s23, 0x0
    buffer_load_dwordx4 v[112:115], v11, s[8:11], s23 offen offset:1024 sc1
    v_mfma_f32_16x16x32_bf16 v[36:39], v[236:239], v[124:127], v[36:39]
    ds_read_b64_tr_b16 v[230:231], v5 offset:34336
    s_waitcnt lgkmcnt(6)
    v_mfma_f32_16x16x32_bf16 v[40:43], v[240:243], v[120:123], v[40:43]
    ds_read_b64_tr_b16 v[232:233], v4 offset:33536
    v_mfma_f32_16x16x32_bf16 v[44:47], v[240:243], v[124:127], v[44:47]
    ds_read_b64_tr_b16 v[234:235], v4 offset:34560
    s_waitcnt lgkmcnt(6)
    v_mfma_f32_16x16x32_bf16 v[48:51], v[244:247], v[120:123], v[48:51]
    s_add_u32 s16, s63, 0x576000
    v_mov_b32 v20, s28
    v_mov_b32 v21, 0
    s_mov_b64 exec, 1
    buffer_store_dword v20, v21, s[8:11], s16 offen sc1
    s_mov_b64 exec, -1
    ds_read_b64_tr_b16 v[236:237], v5 offset:33568
    v_mfma_f32_16x16x32_bf16 v[52:55], v[244:247], v[124:127], v[52:55]
    ds_read_b64_tr_b16 v[238:239], v5 offset:34592
    s_waitcnt lgkmcnt(6)
    v_mfma_f32_16x16x32_bf16 v[56:59], v[224:227], v[120:123], v[56:59]
    s_mov_b32 s23, 0x20000
    buffer_load_dwordx4 v[116:119], v11, s[8:11], s23 offen offset:1024 sc1
    v_mfma_f32_16x16x32_bf16 v[60:63], v[224:227], v[124:127], v[60:63]
    s_barrier
    ds_read_b64_tr_b16 v[240:241], v4 offset:49152
    ds_read_b64_tr_b16 v[242:243], v4 offset:50176
    s_waitcnt lgkmcnt(6)
    v_mfma_f32_16x16x32_bf16 v[64:67], v[228:231], v[120:123], v[64:67]
    s_add_u32 s22, s24, 0x90000
    s_add_u32 m0, s20, 0x14000
    s_nop 0
    buffer_load_dwordx4 v3, s[4:7], s22 offen lds
    ds_read_b64_tr_b16 v[244:245], v5 offset:49184
    v_mfma_f32_16x16x32_bf16 v[68:71], v[228:231], v[124:127], v[68:71]
    ds_read_b64_tr_b16 v[246:247], v5 offset:50208
    s_waitcnt lgkmcnt(6)
    v_mfma_f32_16x16x32_bf16 v[72:75], v[232:235], v[120:123], v[72:75]
    ds_read_b64_tr_b16 v[224:225], v4 offset:49408
    v_mfma_f32_16x16x32_bf16 v[76:79], v[232:235], v[124:127], v[76:79]
    ds_read_b64_tr_b16 v[226:227], v4 offset:50432
    s_waitcnt lgkmcnt(6)
    v_mfma_f32_16x16x32_bf16 v[80:83], v[236:239], v[120:123], v[80:83]
    ds_read_b64_tr_b16 v[228:229], v5 offset:49440
    v_mfma_f32_16x16x32_bf16 v[84:87], v[236:239], v[124:127], v[84:87]
    ds_read_b64_tr_b16 v[230:231], v5 offset:50464
    s_waitcnt lgkmcnt(6)
    v_mfma_f32_16x16x32_bf16 v[24:27], v[240:243], v[88:91], v[24:27]
    ds_read_b64_tr_b16 v[232:233], v4 offset:49664
    v_mfma_f32_16x16x32_bf16 v[28:31], v[240:243], v[92:95], v[28:31]
    s_add_u32 s22, s24, 0x92000
    s_add_u32 m0, s20, 0x14400
    s_nop 0
    buffer_load_dwordx4 v3, s[4:7], s22 offen lds
    ds_read_b64_tr_b16 v[234:235], v4 offset:50688
    s_waitcnt lgkmcnt(6)
    v_mfma_f32_16x16x32_bf16 v[32:35], v[244:247], v[88:91], v[32:35]
    ds_read_b64_tr_b16 v[236:237], v5 offset:49696
    s_mov_b32 s23, 0x2000
    buffer_load_dwordx4 v[120:123], v11, s[8:11], s23 offen offset:1024 sc1
    v_mfma_f32_16x16x32_bf16 v[36:39], v[244:247], v[92:95], v[36:39]
    ds_read_b64_tr_b16 v[238:239], v5 offset:50720
    s_waitcnt lgkmcnt(6)
    v_mfma_f32_16x16x32_bf16 v[40:43], v[224:227], v[88:91], v[40:43]
    ds_read_b64_tr_b16 v[240:241], v4 offset:49920
    v_mfma_f32_16x16x32_bf16 v[44:47], v[224:227], v[92:95], v[44:47]
    ds_read_b64_tr_b16 v[242:243], v4 offset:50944
    s_waitcnt lgkmcnt(6)
    v_mfma_f32_16x16x32_bf16 v[48:51], v[228:231], v[88:91], v[48:51]
    ds_read_b64_tr_b16 v[244:245], v5 offset:49952
    v_mfma_f32_16x16x32_bf16 v[52:55], v[228:231], v[92:95], v[52:55]
    ds_read_b64_tr_b16 v[246:247], v5 offset:50976
    s_waitcnt lgkmcnt(6)
    v_mfma_f32_16x16x32_bf16 v[56:59], v[232:235], v[88:91], v[56:59]
    s_mov_b32 s23, 0x22000
    buffer_load_dwordx4 v[124:127], v11, s[8:11], s23 offen offset:1024 sc1
    v_mfma_f32_16x16x32_bf16 v[60:63], v[232:235], v[92:95], v[60:63]
    s_barrier
    ds_read_b64_tr_b16 v[224:225], v7 offset:0
    ds_read_b64_tr_b16 v[226:227], v7 offset:1024
    s_waitcnt lgkmcnt(6)
    v_mfma_f32_16x16x32_bf16 v[64:67], v[236:239], v[88:91], v[64:67]
    s_add_u32 s22, s24, 0x110000
    s_add_u32 m0, s20, 0x18000
    s_nop 0
    buffer_load_dwordx4 v3, s[4:7], s22 offen lds
    ds_read_b64_tr_b16 v[228:229], v8 offset:32
    v_mfma_f32_16x16x32_bf16 v[68:71], v[236:239], v[92:95], v[68:71]
    ds_read_b64_tr_b16 v[230:231], v8 offset:1056
    s_waitcnt lgkmcnt(6)
    v_mfma_f32_16x16x32_bf16 v[72:75], v[240:243], v[88:91], v[72:75]
    ds_read_b64_tr_b16 v[232:233], v7 offset:256
    v_mfma_f32_16x16x32_bf16 v[76:79], v[240:243], v[92:95], v[76:79]
    ds_read_b64_tr_b16 v[234:235], v7 offset:1280
    s_waitcnt lgkmcnt(6)
    v_mfma_f32_16x16x32_bf16 v[80:83], v[244:247], v[88:91], v[80:83]
    ds_read_b64_tr_b16 v[236:237], v8 offset:288
    v_mfma_f32_16x16x32_bf16 v[84:87], v[244:247], v[92:95], v[84:87]
    ds_read_b64_tr_b16 v[238:239], v8 offset:1312
    s_waitcnt lgkmcnt(6)
    v_mfma_f32_16x16x32_bf16 v[24:27], v[224:227], v[96:99], v[24:27]
    ds_read_b64_tr_b16 v[240:241], v7 offset:512
    v_mfma_f32_16x16x32_bf16 v[28:31], v[224:227], v[100:103], v[28:31]
    s_add_u32 s22, s24, 0x112000
    s_add_u32 m0, s20, 0x18400
    s_nop 0
    buffer_load_dwordx4 v3, s[4:7], s22 offen lds
    ds_read_b64_tr_b16 v[242:243], v7 offset:1536
    s_waitcnt lgkmcnt(6)
    v_mfma_f32_16x16x32_bf16 v[32:35], v[228:231], v[96:99], v[32:35]
    ds_read_b64_tr_b16 v[244:245], v8 offset:544
    s_mov_b32 s23, 0x4000
    buffer_load_dwordx4 v[88:91], v11, s[8:11], s23 offen offset:1024 sc1
    v_mfma_f32_16x16x32_bf16 v[36:39], v[228:231], v[100:103], v[36:39]
    ds_read_b64_tr_b16 v[246:247], v8 offset:1568
    s_waitcnt lgkmcnt(6)
    v_mfma_f32_16x16x32_bf16 v[40:43], v[232:235], v[96:99], v[40:43]
    ds_read_b64_tr_b16 v[224:225], v7 offset:768
    v_mfma_f32_16x16x32_bf16 v[44:47], v[232:235], v[100:103], v[44:47]
    ds_read_b64_tr_b16 v[226:227], v7 offset:1792
    s_waitcnt lgkmcnt(6)
    v_mfma_f32_16x16x32_bf16 v[48:51], v[236:239], v[96:99], v[48:51]
    ds_read_b64_tr_b16 v[228:229], v8 offset:800
    v_mfma_f32_16x16x32_bf16 v[52:55], v[236:239], v[100:103], v[52:55]
    ds_read_b64_tr_b16 v[230:231], v8 offset:1824
    s_waitcnt lgkmcnt(6)
    v_mfma_f32_16x16x32_bf16 v[56:59], v[240:243], v[96:99], v[56:59]
    s_mov_b32 s23, 0x24000
    buffer_load_dwordx4 v[92:95], v11, s[8:11], s23 offen offset:1024 sc1
    v_mfma_f32_16x16x32_bf16 v[60:63], v[240:243], v[100:103], v[60:63]
    s_waitcnt vmcnt(16)
    s_barrier
    ds_read_b64_tr_b16 v[232:233], v7 offset:16384
    ds_read_b64_tr_b16 v[234:235], v7 offset:17408
    s_waitcnt lgkmcnt(6)
    v_mfma_f32_16x16x32_bf16 v[64:67], v[244:247], v[96:99], v[64:67]
    s_add_u32 s22, s24, 0x190000
    s_add_u32 m0, s20, 0x1c000
    s_nop 0
    buffer_load_dwordx4 v3, s[4:7], s22 offen lds
    ds_read_b64_tr_b16 v[236:237], v8 offset:16416
    v_mfma_f32_16x16x32_bf16 v[68:71], v[244:247], v[100:103], v[68:71]
    ds_read_b64_tr_b16 v[238:239], v8 offset:17440
    s_waitcnt lgkmcnt(6)
    v_mfma_f32_16x16x32_bf16 v[72:75], v[224:227], v[96:99], v[72:75]
    ds_read_b64_tr_b16 v[240:241], v7 offset:16640
    v_mfma_f32_16x16x32_bf16 v[76:79], v[224:227], v[100:103], v[76:79]
    ds_read_b64_tr_b16 v[242:243], v7 offset:17664
    s_waitcnt lgkmcnt(6)
    v_mfma_f32_16x16x32_bf16 v[80:83], v[228:231], v[96:99], v[80:83]
    s_waitcnt vmcnt(13)
    v_cmp_ne_u32 vcc, s28, v248
    s_cbranch_vccnz adaLN_cond__sliding_block_cached__moe_arch_mod__prompt_kernel_mp7r
adaLN_cond__sliding_block_cached__moe_arch_mod__prompt_kernel_mp7b:
    ds_read_b64_tr_b16 v[244:245], v8 offset:16672
    v_mfma_f32_16x16x32_bf16 v[84:87], v[228:231], v[100:103], v[84:87]
    v_lshrrev_b32 v250, 4, v1
    v_lshlrev_b32 v250, 14, v250
    v_and_b32 v253, 15, v1
    v_lshl_add_u32 v250, v253, 2, v250
    s_lshl_b32 s14, s2, 6
    s_add_u32 s14, s14, 0x550000
    buffer_load_dword v249, v250, s[8:11], s14 offen sc1
    ds_read_b64_tr_b16 v[246:247], v8 offset:17696
    s_waitcnt lgkmcnt(6)
    v_mfma_f32_16x16x32_bf16 v[24:27], v[232:235], v[104:107], v[24:27]
    ds_read_b64_tr_b16 v[224:225], v7 offset:16896
    v_mfma_f32_16x16x32_bf16 v[28:31], v[232:235], v[108:111], v[28:31]
    s_add_u32 s22, s24, 0x192000
    s_add_u32 m0, s20, 0x1c400
    s_nop 0
    buffer_load_dwordx4 v3, s[4:7], s22 offen lds
    ds_read_b64_tr_b16 v[226:227], v7 offset:17920
    s_waitcnt lgkmcnt(6)
    v_mfma_f32_16x16x32_bf16 v[32:35], v[236:239], v[104:107], v[32:35]
    ds_read_b64_tr_b16 v[228:229], v8 offset:16928
    s_mov_b32 s23, 0x6000
    buffer_load_dwordx4 v[96:99], v11, s[8:11], s23 offen offset:1024 sc1
    v_mfma_f32_16x16x32_bf16 v[36:39], v[236:239], v[108:111], v[36:39]
    ds_read_b64_tr_b16 v[230:231], v8 offset:17952
    s_waitcnt lgkmcnt(6)
    v_mfma_f32_16x16x32_bf16 v[40:43], v[240:243], v[104:107], v[40:43]
    ds_read_b64_tr_b16 v[232:233], v7 offset:17152
    v_mfma_f32_16x16x32_bf16 v[44:47], v[240:243], v[108:111], v[44:47]
    ds_read_b64_tr_b16 v[234:235], v7 offset:18176
    s_waitcnt lgkmcnt(6)
    v_mfma_f32_16x16x32_bf16 v[48:51], v[244:247], v[104:107], v[48:51]
    ds_read_b64_tr_b16 v[236:237], v8 offset:17184
    v_mfma_f32_16x16x32_bf16 v[52:55], v[244:247], v[108:111], v[52:55]
    ds_read_b64_tr_b16 v[238:239], v8 offset:18208
    s_waitcnt lgkmcnt(6)
    v_mfma_f32_16x16x32_bf16 v[56:59], v[224:227], v[104:107], v[56:59]
    s_mov_b32 s23, 0x26000
    buffer_load_dwordx4 v[100:103], v11, s[8:11], s23 offen offset:1024 sc1
    v_mfma_f32_16x16x32_bf16 v[60:63], v[224:227], v[108:111], v[60:63]
    s_waitcnt vmcnt(16)
    s_barrier
    ds_read_b64_tr_b16 v[240:241], v4 offset:0
    ds_read_b64_tr_b16 v[242:243], v4 offset:1024
    s_waitcnt lgkmcnt(6)
    v_mfma_f32_16x16x32_bf16 v[64:67], v[228:231], v[104:107], v[64:67]
    s_add_u32 s22, s24, 0x210000
    s_add_u32 m0, s20, 0x20000
    s_nop 0
    buffer_load_dwordx4 v3, s[4:7], s22 offen lds
    ds_read_b64_tr_b16 v[244:245], v5 offset:32
    v_mfma_f32_16x16x32_bf16 v[68:71], v[228:231], v[108:111], v[68:71]
    ds_read_b64_tr_b16 v[246:247], v5 offset:1056
    s_waitcnt lgkmcnt(6)
    v_mfma_f32_16x16x32_bf16 v[72:75], v[232:235], v[104:107], v[72:75]
    ds_read_b64_tr_b16 v[224:225], v4 offset:256
    v_mfma_f32_16x16x32_bf16 v[76:79], v[232:235], v[108:111], v[76:79]
    ds_read_b64_tr_b16 v[226:227], v4 offset:1280
    s_waitcnt lgkmcnt(6)
    v_mfma_f32_16x16x32_bf16 v[80:83], v[236:239], v[104:107], v[80:83]
    ds_read_b64_tr_b16 v[228:229], v5 offset:288
    v_mfma_f32_16x16x32_bf16 v[84:87], v[236:239], v[108:111], v[84:87]
    ds_read_b64_tr_b16 v[230:231], v5 offset:1312
    s_waitcnt vmcnt(16) lgkmcnt(6)
    v_mfma_f32_16x16x32_bf16 v[24:27], v[240:243], v[112:115], v[24:27]
    ds_read_b64_tr_b16 v[232:233], v4 offset:512
    s_waitcnt vmcnt(14)
    v_mfma_f32_16x16x32_bf16 v[28:31], v[240:243], v[116:119], v[28:31]
    s_add_u32 s22, s24, 0x212000
    s_add_u32 m0, s20, 0x20400
    s_nop 0
    buffer_load_dwordx4 v3, s[4:7], s22 offen lds
    ds_read_b64_tr_b16 v[234:235], v4 offset:1536
    s_waitcnt lgkmcnt(6)
    v_mfma_f32_16x16x32_bf16 v[32:35], v[244:247], v[112:115], v[32:35]
    ds_read_b64_tr_b16 v[236:237], v5 offset:544
    s_mov_b32 s23, 0x8000
    buffer_load_dwordx4 v[104:107], v11, s[8:11], s23 offen offset:1024 sc1
    v_mfma_f32_16x16x32_bf16 v[36:39], v[244:247], v[116:119], v[36:39]
    ds_read_b64_tr_b16 v[238:239], v5 offset:1568
    s_waitcnt lgkmcnt(6)
    v_mfma_f32_16x16x32_bf16 v[40:43], v[224:227], v[112:115], v[40:43]
    ds_read_b64_tr_b16 v[240:241], v4 offset:768
    v_mfma_f32_16x16x32_bf16 v[44:47], v[224:227], v[116:119], v[44:47]
    ds_read_b64_tr_b16 v[242:243], v4 offset:1792
    s_waitcnt lgkmcnt(6)
    v_mfma_f32_16x16x32_bf16 v[48:51], v[228:231], v[112:115], v[48:51]
    s_waitcnt vmcnt(6)
    v_mov_b32 v250, v249
    s_nop 1
    v_permlane16_swap_b32 v249, v250
    v_add_f32 v249, v249, v250
    v_mov_b32 v250, v249
    s_nop 1
    v_permlane32_swap_b32 v249, v250
    v_add_f32 v249, v249, v250
    v_cvt_pk_bf16_f32 v249, v249, v249
    v_lshlrev_b32 v249, 16, v249
    s_lshr_b32 s14, s2, 6
    s_cmp_eq_u32 s14, 2
    s_cselect_b32 s14, 1.0, 0
    v_add_f32 v249, s14, v249
    v_cvt_pk_bf16_f32 v249, v249, v249
    v_lshlrev_b32 v253, 1, v253
    s_lshl_b32 s14, s2, 5
    s_add_u32 s14, s14, 0x540000
    s_cmp_eq_u32 s3, 0
    s_cselect_b32 s14, s14, 0x7ffffff0
    s_mov_b64 exec, 0xffff
    buffer_store_short v249, v253, s[8:11], s14 offen sc1
    s_mov_b64 exec, -1
    ds_read_b64_tr_b16 v[244:245], v5 offset:800
    v_mfma_f32_16x16x32_bf16 v[52:55], v[228:231], v[116:119], v[52:55]
    ds_read_b64_tr_b16 v[246:247], v5 offset:1824
    s_waitcnt lgkmcnt(6)
    v_mfma_f32_16x16x32_bf16 v[56:59], v[232:235], v[112:115], v[56:59]
    s_mov_b32 s23, 0x28000
    buffer_load_dwordx4 v[108:111], v11, s[8:11], s23 offen offset:1024 sc1
    v_mfma_f32_16x16x32_bf16 v[60:63], v[232:235], v[116:119], v[60:63]
    s_barrier
    ds_read_b64_tr_b16 v[224:225], v4 offset:16384
    ds_read_b64_tr_b16 v[226:227], v4 offset:17408
    s_waitcnt lgkmcnt(6)
    v_mfma_f32_16x16x32_bf16 v[64:67], v[236:239], v[112:115], v[64:67]
    s_add_u32 s22, s24, 0x290000
    s_add_u32 m0, s20, 0x24000
    s_nop 0
    buffer_load_dwordx4 v3, s[4:7], s22 offen lds
    ds_read_b64_tr_b16 v[228:229], v5 offset:16416
    v_mfma_f32_16x16x32_bf16 v[68:71], v[236:239], v[116:119], v[68:71]
    ds_read_b64_tr_b16 v[230:231], v5 offset:17440
    s_waitcnt lgkmcnt(6)
    v_mfma_f32_16x16x32_bf16 v[72:75], v[240:243], v[112:115], v[72:75]
    ds_read_b64_tr_b16 v[232:233], v4 offset:16640
    v_mfma_f32_16x16x32_bf16 v[76:79], v[240:243], v[116:119], v[76:79]
    ds_read_b64_tr_b16 v[234:235], v4 offset:17664
    s_waitcnt lgkmcnt(6)
    v_mfma_f32_16x16x32_bf16 v[80:83], v[244:247], v[112:115], v[80:83]
    ds_read_b64_tr_b16 v[236:237], v5 offset:16672
    v_mfma_f32_16x16x32_bf16 v[84:87], v[244:247], v[116:119], v[84:87]
    ds_read_b64_tr_b16 v[238:239], v5 offset:17696
    s_waitcnt lgkmcnt(6)
    v_mfma_f32_16x16x32_bf16 v[24:27], v[224:227], v[120:123], v[24:27]
    ds_read_b64_tr_b16 v[240:241], v4 offset:16896
    v_mfma_f32_16x16x32_bf16 v[28:31], v[224:227], v[124:127], v[28:31]
    s_add_u32 s22, s24, 0x292000
    s_add_u32 m0, s20, 0x24400
    s_nop 0
    buffer_load_dwordx4 v3, s[4:7], s22 offen lds
    ds_read_b64_tr_b16 v[242:243], v4 offset:17920
    s_waitcnt lgkmcnt(6)
    v_mfma_f32_16x16x32_bf16 v[32:35], v[228:231], v[120:123], v[32:35]
    ds_read_b64_tr_b16 v[244:245], v5 offset:16928
    s_mov_b32 s23, 0xa000
    buffer_load_dwordx4 v[112:115], v11, s[8:11], s23 offen offset:1024 sc1
    v_mfma_f32_16x16x32_bf16 v[36:39], v[228:231], v[124:127], v[36:39]
    ds_read_b64_tr_b16 v[246:247], v5 offset:17952
    s_waitcnt lgkmcnt(6)
    v_mfma_f32_16x16x32_bf16 v[40:43], v[232:235], v[120:123], v[40:43]
    ds_read_b64_tr_b16 v[224:225], v4 offset:17152
    v_mfma_f32_16x16x32_bf16 v[44:47], v[232:235], v[124:127], v[44:47]
    ds_read_b64_tr_b16 v[226:227], v4 offset:18176
    s_waitcnt lgkmcnt(6)
    v_mfma_f32_16x16x32_bf16 v[48:51], v[236:239], v[120:123], v[48:51]
    ds_read_b64_tr_b16 v[228:229], v5 offset:17184
    v_mfma_f32_16x16x32_bf16 v[52:55], v[236:239], v[124:127], v[52:55]
    ds_read_b64_tr_b16 v[230:231], v5 offset:18208
    s_waitcnt lgkmcnt(6)
    v_mfma_f32_16x16x32_bf16 v[56:59], v[240:243], v[120:123], v[56:59]
    s_mov_b32 s23, 0x2a000
    buffer_load_dwordx4 v[116:119], v11, s[8:11], s23 offen offset:1024 sc1
    v_mfma_f32_16x16x32_bf16 v[60:63], v[240:243], v[124:127], v[60:63]
    s_barrier
    ds_read_b64_tr_b16 v[232:233], v4 offset:32768
    ds_read_b64_tr_b16 v[234:235], v4 offset:33792
    s_waitcnt lgkmcnt(6)
    v_mfma_f32_16x16x32_bf16 v[64:67], v[244:247], v[120:123], v[64:67]
    s_add_u32 s22, s24, 0x310000
    s_add_u32 m0, s20, 0x10000
    s_nop 0
    buffer_load_dwordx4 v3, s[4:7], s22 offen lds
    ds_read_b64_tr_b16 v[236:237], v5 offset:32800
    v_mfma_f32_16x16x32_bf16 v[68:71], v[244:247], v[124:127], v[68:71]
    ds_read_b64_tr_b16 v[238:239], v5 offset:33824
    s_waitcnt lgkmcnt(6)
    v_mfma_f32_16x16x32_bf16 v[72:75], v[224:227], v[120:123], v[72:75]
    ds_read_b64_tr_b16 v[240:241], v4 offset:33024
    v_mfma_f32_16x16x32_bf16 v[76:79], v[224:227], v[124:127], v[76:79]
    ds_read_b64_tr_b16 v[242:243], v4 offset:34048
    s_waitcnt lgkmcnt(6)
    v_mfma_f32_16x16x32_bf16 v[80:83], v[228:231], v[120:123], v[80:83]
    ds_read_b64_tr_b16 v[244:245], v5 offset:33056
    v_mfma_f32_16x16x32_bf16 v[84:87], v[228:231], v[124:127], v[84:87]
    ds_read_b64_tr_b16 v[246:247], v5 offset:34080
    s_waitcnt lgkmcnt(6)
    v_mfma_f32_16x16x32_bf16 v[24:27], v[232:235], v[88:91], v[24:27]
    ds_read_b64_tr_b16 v[224:225], v4 offset:33280
    v_mfma_f32_16x16x32_bf16 v[28:31], v[232:235], v[92:95], v[28:31]
    s_add_u32 s22, s24, 0x312000
    s_add_u32 m0, s20, 0x10400
    s_nop 0
    buffer_load_dwordx4 v3, s[4:7], s22 offen lds
    ds_read_b64_tr_b16 v[226:227], v4 offset:34304
    s_waitcnt lgkmcnt(6)
    v_mfma_f32_16x16x32_bf16 v[32:35], v[236:239], v[88:91], v[32:35]
    ds_read_b64_tr_b16 v[228:229], v5 offset:33312
    s_mov_b32 s23, 0xc000
    buffer_load_dwordx4 v[120:123], v11, s[8:11], s23 offen offset:1024 sc1
    v_mfma_f32_16x16x32_bf16 v[36:39], v[236:239], v[92:95], v[36:39]
    ds_read_b64_tr_b16 v[230:231], v5 offset:34336
    s_waitcnt lgkmcnt(6)
    v_mfma_f32_16x16x32_bf16 v[40:43], v[240:243], v[88:91], v[40:43]
    ds_read_b64_tr_b16 v[232:233], v4 offset:33536
    v_mfma_f32_16x16x32_bf16 v[44:47], v[240:243], v[92:95], v[44:47]
    ds_read_b64_tr_b16 v[234:235], v4 offset:34560
    s_waitcnt lgkmcnt(6)
    v_mfma_f32_16x16x32_bf16 v[48:51], v[244:247], v[88:91], v[48:51]
    ds_read_b64_tr_b16 v[236:237], v5 offset:33568
    v_mfma_f32_16x16x32_bf16 v[52:55], v[244:247], v[92:95], v[52:55]
    ds_read_b64_tr_b16 v[238:239], v5 offset:34592
    s_waitcnt lgkmcnt(6)
    v_mfma_f32_16x16x32_bf16 v[56:59], v[224:227], v[88:91], v[56:59]
    s_mov_b32 s23, 0x2c000
    buffer_load_dwordx4 v[124:127], v11, s[8:11], s23 offen offset:1024 sc1
    v_mfma_f32_16x16x32_bf16 v[60:63], v[224:227], v[92:95], v[60:63]
    s_waitcnt vmcnt(15)
    s_barrier
    ds_read_b64_tr_b16 v[240:241], v4 offset:49152
    ds_read_b64_tr_b16 v[242:243], v4 offset:50176
    s_add_u32 s17, s18, 16384
    buffer_load_dword v12, v13, s[8:11], s17 offen sc1
    s_waitcnt lgkmcnt(6)
    v_mfma_f32_16x16x32_bf16 v[64:67], v[228:231], v[88:91], v[64:67]
    s_add_u32 s22, s24, 0x390000
    s_add_u32 m0, s20, 0x14000
    s_nop 0
    buffer_load_dwordx4 v3, s[4:7], s22 offen lds
    ds_read_b64_tr_b16 v[244:245], v5 offset:49184
    v_mfma_f32_16x16x32_bf16 v[68:71], v[228:231], v[92:95], v[68:71]
    ds_read_b64_tr_b16 v[246:247], v5 offset:50208
    s_waitcnt lgkmcnt(6)
    v_mfma_f32_16x16x32_bf16 v[72:75], v[232:235], v[88:91], v[72:75]
    ds_read_b64_tr_b16 v[224:225], v4 offset:49408
    v_mfma_f32_16x16x32_bf16 v[76:79], v[232:235], v[92:95], v[76:79]
    ds_read_b64_tr_b16 v[226:227], v4 offset:50432
    s_waitcnt lgkmcnt(6)
    v_mfma_f32_16x16x32_bf16 v[80:83], v[236:239], v[88:91], v[80:83]
    s_waitcnt vmcnt(11)
    v_mov_b32 v248, s28
    v_mov_b32 v249, 0
    s_lshl_b32 s14, s2, 2
    s_add_u32 s14, s14, 0x544000
    s_cmp_eq_u32 s3, 0
    s_cselect_b32 s14, s14, 0x7ffffff0
    s_mov_b64 exec, 1
    buffer_store_dword v248, v249, s[8:11], s14 offen sc1
    s_mov_b64 exec, -1
    ds_read_b64_tr_b16 v[228:229], v5 offset:49440
    v_mfma_f32_16x16x32_bf16 v[84:87], v[236:239], v[92:95], v[84:87]
    ds_read_b64_tr_b16 v[230:231], v5 offset:50464
    s_waitcnt lgkmcnt(6)
    v_mfma_f32_16x16x32_bf16 v[24:27], v[240:243], v[96:99], v[24:27]
    ds_read_b64_tr_b16 v[232:233], v4 offset:49664
    v_mfma_f32_16x16x32_bf16 v[28:31], v[240:243], v[100:103], v[28:31]
    s_add_u32 s22, s24, 0x392000
    s_add_u32 m0, s20, 0x14400
    s_nop 0
    buffer_load_dwordx4 v3, s[4:7], s22 offen lds
    ds_read_b64_tr_b16 v[234:235], v4 offset:50688
    s_waitcnt lgkmcnt(6)
    v_mfma_f32_16x16x32_bf16 v[32:35], v[244:247], v[96:99], v[32:35]
    ds_read_b64_tr_b16 v[236:237], v5 offset:49696
    s_mov_b32 s23, 0xe000
    buffer_load_dwordx4 v[88:91], v11, s[8:11], s23 offen offset:1024 sc1
    v_mfma_f32_16x16x32_bf16 v[36:39], v[244:247], v[100:103], v[36:39]
    ds_read_b64_tr_b16 v[238:239], v5 offset:50720
    s_waitcnt lgkmcnt(6)
    v_mfma_f32_16x16x32_bf16 v[40:43], v[224:227], v[96:99], v[40:43]
    ds_read_b64_tr_b16 v[240:241], v4 offset:49920
    v_mfma_f32_16x16x32_bf16 v[44:47], v[224:227], v[100:103], v[44:47]
    ds_read_b64_tr_b16 v[242:243], v4 offset:50944
    s_waitcnt lgkmcnt(6)
    v_mfma_f32_16x16x32_bf16 v[48:51], v[228:231], v[96:99], v[48:51]
    ds_read_b64_tr_b16 v[244:245], v5 offset:49952
    v_mfma_f32_16x16x32_bf16 v[52:55], v[228:231], v[100:103], v[52:55]
    ds_read_b64_tr_b16 v[246:247], v5 offset:50976
    s_waitcnt lgkmcnt(6)
    v_mfma_f32_16x16x32_bf16 v[56:59], v[232:235], v[96:99], v[56:59]
    s_mov_b32 s23, 0x2e000
    buffer_load_dwordx4 v[92:95], v11, s[8:11], s23 offen offset:1024 sc1
    v_mfma_f32_16x16x32_bf16 v[60:63], v[232:235], v[100:103], v[60:63]
    s_barrier
    ds_read_b64_tr_b16 v[224:225], v7 offset:0
    ds_read_b64_tr_b16 v[226:227], v7 offset:1024
    s_waitcnt lgkmcnt(6)
    v_mfma_f32_16x16x32_bf16 v[64:67], v[236:239], v[96:99], v[64:67]
    s_add_u32 s22, s24, 0x20000
    s_add_u32 m0, s20, 0x18000
    s_nop 0
    buffer_load_dwordx4 v3, s[4:7], s22 offen lds
    ds_read_b64_tr_b16 v[228:229], v8 offset:32
    v_mfma_f32_16x16x32_bf16 v[68:71], v[236:239], v[100:103], v[68:71]
    ds_read_b64_tr_b16 v[230:231], v8 offset:1056
    s_waitcnt lgkmcnt(6)
    v_mfma_f32_16x16x32_bf16 v[72:75], v[240:243], v[96:99], v[72:75]
    ds_read_b64_tr_b16 v[232:233], v7 offset:256
    v_mfma_f32_16x16x32_bf16 v[76:79], v[240:243], v[100:103], v[76:79]
    ds_read_b64_tr_b16 v[234:235], v7 offset:1280
    s_waitcnt lgkmcnt(6)
    v_mfma_f32_16x16x32_bf16 v[80:83], v[244:247], v[96:99], v[80:83]
    ds_read_b64_tr_b16 v[236:237], v8 offset:288
    v_mfma_f32_16x16x32_bf16 v[84:87], v[244:247], v[100:103], v[84:87]
    ds_read_b64_tr_b16 v[238:239], v8 offset:1312
    s_waitcnt vmcnt(6)
    v_cmp_ne_u32 vcc, s28, v12
    s_cbranch_vccnz adaLN_cond__sliding_block_cached__moe_arch_mod__prompt_kernel_o28r
adaLN_cond__sliding_block_cached__moe_arch_mod__prompt_kernel_o28b:
    s_waitcnt lgkmcnt(6)
    v_mfma_f32_16x16x32_bf16 v[24:27], v[224:227], v[104:107], v[24:27]
    ds_read_b64_tr_b16 v[240:241], v7 offset:512
    v_mfma_f32_16x16x32_bf16 v[28:31], v[224:227], v[108:111], v[28:31]
    s_add_u32 s22, s24, 0x22000
    s_add_u32 m0, s20, 0x18400
    s_nop 0
    buffer_load_dwordx4 v3, s[4:7], s22 offen lds
    ds_read_b64_tr_b16 v[242:243], v7 offset:1536
    s_waitcnt lgkmcnt(6)
    v_mfma_f32_16x16x32_bf16 v[32:35], v[228:231], v[104:107], v[32:35]
    ds_read_b64_tr_b16 v[244:245], v8 offset:544
    s_mov_b32 s23, 0x0
    buffer_load_dwordx4 v[96:99], v11, s[8:11], s23 offen offset:2048 sc1
    v_mfma_f32_16x16x32_bf16 v[36:39], v[228:231], v[108:111], v[36:39]
    ds_read_b64_tr_b16 v[246:247], v8 offset:1568
    s_waitcnt lgkmcnt(6)
    v_mfma_f32_16x16x32_bf16 v[40:43], v[232:235], v[104:107], v[40:43]
    ds_read_b64_tr_b16 v[224:225], v7 offset:768
    v_mfma_f32_16x16x32_bf16 v[44:47], v[232:235], v[108:111], v[44:47]
    ds_read_b64_tr_b16 v[226:227], v7 offset:1792
    s_waitcnt lgkmcnt(6)
    v_mfma_f32_16x16x32_bf16 v[48:51], v[236:239], v[104:107], v[48:51]
    ds_read_b64_tr_b16 v[228:229], v8 offset:800
    v_mfma_f32_16x16x32_bf16 v[52:55], v[236:239], v[108:111], v[52:55]
    ds_read_b64_tr_b16 v[230:231], v8 offset:1824
    s_waitcnt lgkmcnt(6)
    v_mfma_f32_16x16x32_bf16 v[56:59], v[240:243], v[104:107], v[56:59]
    s_mov_b32 s23, 0x20000
    buffer_load_dwordx4 v[100:103], v11, s[8:11], s23 offen offset:2048 sc1
    v_mfma_f32_16x16x32_bf16 v[60:63], v[240:243], v[108:111], v[60:63]
    s_barrier
    ds_read_b64_tr_b16 v[232:233], v7 offset:16384
    ds_read_b64_tr_b16 v[234:235], v7 offset:17408
    s_waitcnt lgkmcnt(6)
    v_mfma_f32_16x16x32_bf16 v[64:67], v[244:247], v[104:107], v[64:67]
    s_add_u32 s22, s24, 0xa0000
    s_add_u32 m0, s20, 0x1c000
    s_nop 0
    buffer_load_dwordx4 v3, s[4:7], s22 offen lds
    ds_read_b64_tr_b16 v[236:237], v8 offset:16416
    v_mfma_f32_16x16x32_bf16 v[68:71], v[244:247], v[108:111], v[68:71]
    ds_read_b64_tr_b16 v[238:239], v8 offset:17440
    s_waitcnt lgkmcnt(6)
    v_mfma_f32_16x16x32_bf16 v[72:75], v[224:227], v[104:107], v[72:75]
    ds_read_b64_tr_b16 v[240:241], v7 offset:16640
    v_mfma_f32_16x16x32_bf16 v[76:79], v[224:227], v[108:111], v[76:79]
    ds_read_b64_tr_b16 v[242:243], v7 offset:17664
    s_waitcnt lgkmcnt(6)
    v_mfma_f32_16x16x32_bf16 v[80:83], v[228:231], v[104:107], v[80:83]
    ds_read_b64_tr_b16 v[244:245], v8 offset:16672
    v_mfma_f32_16x16x32_bf16 v[84:87], v[228:231], v[108:111], v[84:87]
    ds_read_b64_tr_b16 v[246:247], v8 offset:17696
    s_waitcnt lgkmcnt(6)
    v_mfma_f32_16x16x32_bf16 v[24:27], v[232:235], v[112:115], v[24:27]
    ds_read_b64_tr_b16 v[224:225], v7 offset:16896
    v_mfma_f32_16x16x32_bf16 v[28:31], v[232:235], v[116:119], v[28:31]
    s_add_u32 s22, s24, 0xa2000
    s_add_u32 m0, s20, 0x1c400
    s_nop 0
    buffer_load_dwordx4 v3, s[4:7], s22 offen lds
    ds_read_b64_tr_b16 v[226:227], v7 offset:17920
    s_waitcnt lgkmcnt(6)
    v_mfma_f32_16x16x32_bf16 v[32:35], v[236:239], v[112:115], v[32:35]
    ds_read_b64_tr_b16 v[228:229], v8 offset:16928
    s_mov_b32 s23, 0x2000
    buffer_load_dwordx4 v[104:107], v11, s[8:11], s23 offen offset:2048 sc1
    v_mfma_f32_16x16x32_bf16 v[36:39], v[236:239], v[116:119], v[36:39]
    ds_read_b64_tr_b16 v[230:231], v8 offset:17952
    s_waitcnt lgkmcnt(6)
    v_mfma_f32_16x16x32_bf16 v[40:43], v[240:243], v[112:115], v[40:43]
    ds_read_b64_tr_b16 v[232:233], v7 offset:17152
    v_mfma_f32_16x16x32_bf16 v[44:47], v[240:243], v[116:119], v[44:47]
    ds_read_b64_tr_b16 v[234:235], v7 offset:18176
    s_waitcnt lgkmcnt(6)
    v_mfma_f32_16x16x32_bf16 v[48:51], v[244:247], v[112:115], v[48:51]
    ds_read_b64_tr_b16 v[236:237], v8 offset:17184
    v_mfma_f32_16x16x32_bf16 v[52:55], v[244:247], v[116:119], v[52:55]
    ds_read_b64_tr_b16 v[238:239], v8 offset:18208
    s_waitcnt lgkmcnt(6)
    v_mfma_f32_16x16x32_bf16 v[56:59], v[224:227], v[112:115], v[56:59]
    s_mov_b32 s23, 0x22000
    buffer_load_dwordx4 v[108:111], v11, s[8:11], s23 offen offset:2048 sc1
    v_mfma_f32_16x16x32_bf16 v[60:63], v[224:227], v[116:119], v[60:63]
    s_barrier
    ds_read_b64_tr_b16 v[240:241], v4 offset:0
    ds_read_b64_tr_b16 v[242:243], v4 offset:1024
    s_waitcnt lgkmcnt(6)
    v_mfma_f32_16x16x32_bf16 v[64:67], v[228:231], v[112:115], v[64:67]
    s_add_u32 s22, s24, 0x120000
    s_add_u32 m0, s20, 0x20000
    s_nop 0
    buffer_load_dwordx4 v3, s[4:7], s22 offen lds
    ds_read_b64_tr_b16 v[244:245], v5 offset:32
    v_mfma_f32_16x16x32_bf16 v[68:71], v[228:231], v[116:119], v[68:71]
    ds_read_b64_tr_b16 v[246:247], v5 offset:1056
    s_waitcnt lgkmcnt(6)
    v_mfma_f32_16x16x32_bf16 v[72:75], v[232:235], v[112:115], v[72:75]
    ds_read_b64_tr_b16 v[224:225], v4 offset:256
    v_mfma_f32_16x16x32_bf16 v[76:79], v[232:235], v[116:119], v[76:79]
    ds_read_b64_tr_b16 v[226:227], v4 offset:1280
    s_waitcnt lgkmcnt(6)
    v_mfma_f32_16x16x32_bf16 v[80:83], v[236:239], v[112:115], v[80:83]
    ds_read_b64_tr_b16 v[228:229], v5 offset:288
    v_mfma_f32_16x16x32_bf16 v[84:87], v[236:239], v[116:119], v[84:87]
    ds_read_b64_tr_b16 v[230:231], v5 offset:1312
    s_waitcnt lgkmcnt(6)
    v_mfma_f32_16x16x32_bf16 v[24:27], v[240:243], v[120:123], v[24:27]
    ds_read_b64_tr_b16 v[232:233], v4 offset:512
    v_mfma_f32_16x16x32_bf16 v[28:31], v[240:243], v[124:127], v[28:31]
    s_add_u32 s22, s24, 0x122000
    s_add_u32 m0, s20, 0x20400
    s_nop 0
    buffer_load_dwordx4 v3, s[4:7], s22 offen lds
    ds_read_b64_tr_b16 v[234:235], v4 offset:1536
    s_waitcnt lgkmcnt(6)
    v_mfma_f32_16x16x32_bf16 v[32:35], v[244:247], v[120:123], v[32:35]
    ds_read_b64_tr_b16 v[236:237], v5 offset:544
    s_mov_b32 s23, 0x4000
    buffer_load_dwordx4 v[112:115], v11, s[8:11], s23 offen offset:2048 sc1
    v_mfma_f32_16x16x32_bf16 v[36:39], v[244:247], v[124:127], v[36:39]
    ds_read_b64_tr_b16 v[238:239], v5 offset:1568
    s_waitcnt lgkmcnt(6)
    v_mfma_f32_16x16x32_bf16 v[40:43], v[224:227], v[120:123], v[40:43]
    ds_read_b64_tr_b16 v[240:241], v4 offset:768
    v_mfma_f32_16x16x32_bf16 v[44:47], v[224:227], v[124:127], v[44:47]
    ds_read_b64_tr_b16 v[242:243], v4 offset:1792
    s_waitcnt lgkmcnt(6)
    v_mfma_f32_16x16x32_bf16 v[48:51], v[228:231], v[120:123], v[48:51]
    ds_read_b64_tr_b16 v[244:245], v5 offset:800
    v_mfma_f32_16x16x32_bf16 v[52:55], v[228:231], v[124:127], v[52:55]
    ds_read_b64_tr_b16 v[246:247], v5 offset:1824
    s_waitcnt lgkmcnt(6)
    v_mfma_f32_16x16x32_bf16 v[56:59], v[232:235], v[120:123], v[56:59]
    s_mov_b32 s23, 0x24000
    buffer_load_dwordx4 v[116:119], v11, s[8:11], s23 offen offset:2048 sc1
    v_mfma_f32_16x16x32_bf16 v[60:63], v[232:235], v[124:127], v[60:63]
    s_waitcnt vmcnt(14)
    s_barrier
    ds_read_b64_tr_b16 v[224:225], v4 offset:16384
    ds_read_b64_tr_b16 v[226:227], v4 offset:17408
    s_waitcnt lgkmcnt(6)
    v_mfma_f32_16x16x32_bf16 v[64:67], v[236:239], v[120:123], v[64:67]
    s_add_u32 s22, s24, 0x1a0000
    s_add_u32 m0, s20, 0x24000
    s_nop 0
    buffer_load_dwordx4 v3, s[4:7], s22 offen lds
    ds_read_b64_tr_b16 v[228:229], v5 offset:16416
    v_mfma_f32_16x16x32_bf16 v[68:71], v[236:239], v[124:127], v[68:71]
    ds_read_b64_tr_b16 v[230:231], v5 offset:17440
    s_waitcnt lgkmcnt(6)
    v_mfma_f32_16x16x32_bf16 v[72:75], v[240:243], v[120:123], v[72:75]
    ds_read_b64_tr_b16 v[232:233], v4 offset:16640
    v_mfma_f32_16x16x32_bf16 v[76:79], v[240:243], v[124:127], v[76:79]
    ds_read_b64_tr_b16 v[234:235], v4 offset:17664
    s_waitcnt lgkmcnt(6)
    v_mfma_f32_16x16x32_bf16 v[80:83], v[244:247], v[120:123], v[80:83]
    ds_read_b64_tr_b16 v[236:237], v5 offset:16672
    v_mfma_f32_16x16x32_bf16 v[84:87], v[244:247], v[124:127], v[84:87]
    ds_read_b64_tr_b16 v[238:239], v5 offset:17696
    s_waitcnt vmcnt(14) lgkmcnt(6)
    v_mfma_f32_16x16x32_bf16 v[24:27], v[224:227], v[88:91], v[24:27]
    ds_read_b64_tr_b16 v[240:241], v4 offset:16896
    s_waitcnt vmcnt(13)
    v_mfma_f32_16x16x32_bf16 v[28:31], v[224:227], v[92:95], v[28:31]
    s_add_u32 s22, s24, 0x1a2000
    s_add_u32 m0, s20, 0x24400
    s_nop 0
    buffer_load_dwordx4 v3, s[4:7], s22 offen lds
    ds_read_b64_tr_b16 v[242:243], v4 offset:17920
    s_waitcnt lgkmcnt(6)
    v_mfma_f32_16x16x32_bf16 v[32:35], v[228:231], v[88:91], v[32:35]
    ds_read_b64_tr_b16 v[244:245], v5 offset:16928
    s_mov_b32 s23, 0x6000
    buffer_load_dwordx4 v[120:123], v11, s[8:11], s23 offen offset:2048 sc1
    v_mfma_f32_16x16x32_bf16 v[36:39], v[228:231], v[92:95], v[36:39]
    ds_read_b64_tr_b16 v[246:247], v5 offset:17952
    s_waitcnt lgkmcnt(6)
    v_mfma_f32_16x16x32_bf16 v[40:43], v[232:235], v[88:91], v[40:43]
    ds_read_b64_tr_b16 v[224:225], v4 offset:17152
    v_mfma_f32_16x16x32_bf16 v[44:47], v[232:235], v[92:95], v[44:47]
    ds_read_b64_tr_b16 v[226:227], v4 offset:18176
    s_waitcnt lgkmcnt(6)
    v_mfma_f32_16x16x32_bf16 v[48:51], v[236:239], v[88:91], v[48:51]
    ds_read_b64_tr_b16 v[228:229], v5 offset:17184
    v_mfma_f32_16x16x32_bf16 v[52:55], v[236:239], v[92:95], v[52:55]
    ds_read_b64_tr_b16 v[230:231], v5 offset:18208
    s_waitcnt lgkmcnt(6)
    v_mfma_f32_16x16x32_bf16 v[56:59], v[240:243], v[88:91], v[56:59]
    s_mov_b32 s23, 0x26000
    buffer_load_dwordx4 v[124:127], v11, s[8:11], s23 offen offset:2048 sc1
    v_mfma_f32_16x16x32_bf16 v[60:63], v[240:243], v[92:95], v[60:63]
    s_waitcnt vmcnt(14)
    s_barrier
    ds_read_b64_tr_b16 v[232:233], v4 offset:32768
    ds_read_b64_tr_b16 v[234:235], v4 offset:33792
    s_waitcnt lgkmcnt(6)
    v_mfma_f32_16x16x32_bf16 v[64:67], v[244:247], v[88:91], v[64:67]
    s_add_u32 s22, s24, 0x220000
    s_add_u32 m0, s20, 0x10000
    s_nop 0
    buffer_load_dwordx4 v3, s[4:7], s22 offen lds
    ds_read_b64_tr_b16 v[236:237], v5 offset:32800
    v_mfma_f32_16x16x32_bf16 v[68:71], v[244:247], v[92:95], v[68:71]
    ds_read_b64_tr_b16 v[238:239], v5 offset:33824
    s_waitcnt lgkmcnt(6)
    v_mfma_f32_16x16x32_bf16 v[72:75], v[224:227], v[88:91], v[72:75]
    ds_read_b64_tr_b16 v[240:241], v4 offset:33024
    v_mfma_f32_16x16x32_bf16 v[76:79], v[224:227], v[92:95], v[76:79]
    ds_read_b64_tr_b16 v[242:243], v4 offset:34048
    s_waitcnt lgkmcnt(6)
    v_mfma_f32_16x16x32_bf16 v[80:83], v[228:231], v[88:91], v[80:83]
    ds_read_b64_tr_b16 v[244:245], v5 offset:33056
    v_mfma_f32_16x16x32_bf16 v[84:87], v[228:231], v[92:95], v[84:87]
    ds_read_b64_tr_b16 v[246:247], v5 offset:34080
    s_waitcnt vmcnt(14) lgkmcnt(6)
    v_mfma_f32_16x16x32_bf16 v[24:27], v[232:235], v[96:99], v[24:27]
    ds_read_b64_tr_b16 v[224:225], v4 offset:33280
    s_waitcnt vmcnt(13)
    v_mfma_f32_16x16x32_bf16 v[28:31], v[232:235], v[100:103], v[28:31]
    s_add_u32 s22, s24, 0x222000
    s_add_u32 m0, s20, 0x10400
    s_nop 0
    buffer_load_dwordx4 v3, s[4:7], s22 offen lds
    ds_read_b64_tr_b16 v[226:227], v4 offset:34304
    s_waitcnt lgkmcnt(6)
    v_mfma_f32_16x16x32_bf16 v[32:35], v[236:239], v[96:99], v[32:35]
    ds_read_b64_tr_b16 v[228:229], v5 offset:33312
    s_mov_b32 s23, 0x8000
    buffer_load_dwordx4 v[88:91], v11, s[8:11], s23 offen offset:2048 sc1
    v_mfma_f32_16x16x32_bf16 v[36:39], v[236:239], v[100:103], v[36:39]
    ds_read_b64_tr_b16 v[230:231], v5 offset:34336
    s_waitcnt lgkmcnt(6)
    v_mfma_f32_16x16x32_bf16 v[40:43], v[240:243], v[96:99], v[40:43]
    ds_read_b64_tr_b16 v[232:233], v4 offset:33536
    v_mfma_f32_16x16x32_bf16 v[44:47], v[240:243], v[100:103], v[44:47]
    ds_read_b64_tr_b16 v[234:235], v4 offset:34560
    s_waitcnt lgkmcnt(6)
    v_mfma_f32_16x16x32_bf16 v[48:51], v[244:247], v[96:99], v[48:51]
    ds_read_b64_tr_b16 v[236:237], v5 offset:33568
    v_mfma_f32_16x16x32_bf16 v[52:55], v[244:247], v[100:103], v[52:55]
    ds_read_b64_tr_b16 v[238:239], v5 offset:34592
    s_waitcnt lgkmcnt(6)
    v_mfma_f32_16x16x32_bf16 v[56:59], v[224:227], v[96:99], v[56:59]
    s_mov_b32 s23, 0x28000
    buffer_load_dwordx4 v[92:95], v11, s[8:11], s23 offen offset:2048 sc1
    v_mfma_f32_16x16x32_bf16 v[60:63], v[224:227], v[100:103], v[60:63]
    s_waitcnt vmcnt(14)
    s_barrier
    ds_read_b64_tr_b16 v[240:241], v4 offset:49152
    ds_read_b64_tr_b16 v[242:243], v4 offset:50176
    s_waitcnt lgkmcnt(6)
    v_mfma_f32_16x16x32_bf16 v[64:67], v[228:231], v[96:99], v[64:67]
    s_add_u32 s22, s24, 0x2a0000
    s_add_u32 m0, s20, 0x14000
    s_nop 0
    buffer_load_dwordx4 v3, s[4:7], s22 offen lds
    ds_read_b64_tr_b16 v[244:245], v5 offset:49184
    v_mfma_f32_16x16x32_bf16 v[68:71], v[228:231], v[100:103], v[68:71]
    ds_read_b64_tr_b16 v[246:247], v5 offset:50208
    s_waitcnt lgkmcnt(6)
    v_mfma_f32_16x16x32_bf16 v[72:75], v[232:235], v[96:99], v[72:75]
    ds_read_b64_tr_b16 v[224:225], v4 offset:49408
    v_mfma_f32_16x16x32_bf16 v[76:79], v[232:235], v[100:103], v[76:79]
    ds_read_b64_tr_b16 v[226:227], v4 offset:50432
    s_waitcnt lgkmcnt(6)
    v_mfma_f32_16x16x32_bf16 v[80:83], v[236:239], v[96:99], v[80:83]
    ds_read_b64_tr_b16 v[228:229], v5 offset:49440
    v_mfma_f32_16x16x32_bf16 v[84:87], v[236:239], v[100:103], v[84:87]
    ds_read_b64_tr_b16 v[230:231], v5 offset:50464
    s_waitcnt vmcnt(14) lgkmcnt(6)
    v_mfma_f32_16x16x32_bf16 v[24:27], v[240:243], v[104:107], v[24:27]
    ds_read_b64_tr_b16 v[232:233], v4 offset:49664
    s_waitcnt vmcnt(13)
    v_mfma_f32_16x16x32_bf16 v[28:31], v[240:243], v[108:111], v[28:31]
    s_add_u32 s22, s24, 0x2a2000
    s_add_u32 m0, s20, 0x14400
    s_nop 0
    buffer_load_dwordx4 v3, s[4:7], s22 offen lds
    ds_read_b64_tr_b16 v[234:235], v4 offset:50688
    s_waitcnt lgkmcnt(6)
    v_mfma_f32_16x16x32_bf16 v[32:35], v[244:247], v[104:107], v[32:35]
    ds_read_b64_tr_b16 v[236:237], v5 offset:49696
    s_mov_b32 s23, 0xa000
    buffer_load_dwordx4 v[96:99], v11, s[8:11], s23 offen offset:2048 sc1
    v_mfma_f32_16x16x32_bf16 v[36:39], v[244:247], v[108:111], v[36:39]
    ds_read_b64_tr_b16 v[238:239], v5 offset:50720
    s_waitcnt lgkmcnt(6)
    v_mfma_f32_16x16x32_bf16 v[40:43], v[224:227], v[104:107], v[40:43]
    ds_read_b64_tr_b16 v[240:241], v4 offset:49920
    v_mfma_f32_16x16x32_bf16 v[44:47], v[224:227], v[108:111], v[44:47]
    ds_read_b64_tr_b16 v[242:243], v4 offset:50944
    s_waitcnt lgkmcnt(6)
    v_mfma_f32_16x16x32_bf16 v[48:51], v[228:231], v[104:107], v[48:51]
    ds_read_b64_tr_b16 v[244:245], v5 offset:49952
    v_mfma_f32_16x16x32_bf16 v[52:55], v[228:231], v[108:111], v[52:55]
    ds_read_b64_tr_b16 v[246:247], v5 offset:50976
    s_waitcnt lgkmcnt(6)
    v_mfma_f32_16x16x32_bf16 v[56:59], v[232:235], v[104:107], v[56:59]
    s_mov_b32 s23, 0x2a000
    buffer_load_dwordx4 v[100:103], v11, s[8:11], s23 offen offset:2048 sc1
    v_mfma_f32_16x16x32_bf16 v[60:63], v[232:235], v[108:111], v[60:63]
    s_waitcnt vmcnt(14)
    s_barrier
    ds_read_b64_tr_b16 v[224:225], v7 offset:0
    ds_read_b64_tr_b16 v[226:227], v7 offset:1024
    s_waitcnt lgkmcnt(6)
    v_mfma_f32_16x16x32_bf16 v[64:67], v[236:239], v[104:107], v[64:67]
    s_add_u32 s22, s24, 0x320000
    s_add_u32 m0, s20, 0x18000
    s_nop 0
    buffer_load_dwordx4 v3, s[4:7], s22 offen lds
    ds_read_b64_tr_b16 v[228:229], v8 offset:32
    v_mfma_f32_16x16x32_bf16 v[68:71], v[236:239], v[108:111], v[68:71]
    ds_read_b64_tr_b16 v[230:231], v8 offset:1056
    s_waitcnt lgkmcnt(6)
    v_mfma_f32_16x16x32_bf16 v[72:75], v[240:243], v[104:107], v[72:75]
    ds_read_b64_tr_b16 v[232:233], v7 offset:256
    v_mfma_f32_16x16x32_bf16 v[76:79], v[240:243], v[108:111], v[76:79]
    ds_read_b64_tr_b16 v[234:235], v7 offset:1280
    s_waitcnt lgkmcnt(6)
    v_mfma_f32_16x16x32_bf16 v[80:83], v[244:247], v[104:107], v[80:83]
    ds_read_b64_tr_b16 v[236:237], v8 offset:288
    v_mfma_f32_16x16x32_bf16 v[84:87], v[244:247], v[108:111], v[84:87]
    ds_read_b64_tr_b16 v[238:239], v8 offset:1312
    s_waitcnt vmcnt(14) lgkmcnt(6)
    v_mfma_f32_16x16x32_bf16 v[24:27], v[224:227], v[112:115], v[24:27]
    ds_read_b64_tr_b16 v[240:241], v7 offset:512
    s_waitcnt vmcnt(13)
    v_mfma_f32_16x16x32_bf16 v[28:31], v[224:227], v[116:119], v[28:31]
    s_add_u32 s22, s24, 0x322000
    s_add_u32 m0, s20, 0x18400
    s_nop 0
    buffer_load_dwordx4 v3, s[4:7], s22 offen lds
    ds_read_b64_tr_b16 v[242:243], v7 offset:1536
    s_waitcnt lgkmcnt(6)
    v_mfma_f32_16x16x32_bf16 v[32:35], v[228:231], v[112:115], v[32:35]
    ds_read_b64_tr_b16 v[244:245], v8 offset:544
    s_mov_b32 s23, 0xc000
    buffer_load_dwordx4 v[104:107], v11, s[8:11], s23 offen offset:2048 sc1
    v_mfma_f32_16x16x32_bf16 v[36:39], v[228:231], v[116:119], v[36:39]
    ds_read_b64_tr_b16 v[246:247], v8 offset:1568
    s_waitcnt lgkmcnt(6)
    v_mfma_f32_16x16x32_bf16 v[40:43], v[232:235], v[112:115], v[40:43]
    ds_read_b64_tr_b16 v[224:225], v7 offset:768
    v_mfma_f32_16x16x32_bf16 v[44:47], v[232:235], v[116:119], v[44:47]
    ds_read_b64_tr_b16 v[226:227], v7 offset:1792
    s_waitcnt lgkmcnt(6)
    v_mfma_f32_16x16x32_bf16 v[48:51], v[236:239], v[112:115], v[48:51]
    ds_read_b64_tr_b16 v[228:229], v8 offset:800
    v_mfma_f32_16x16x32_bf16 v[52:55], v[236:239], v[116:119], v[52:55]
    ds_read_b64_tr_b16 v[230:231], v8 offset:1824
    s_waitcnt lgkmcnt(6)
    v_mfma_f32_16x16x32_bf16 v[56:59], v[240:243], v[112:115], v[56:59]
    s_mov_b32 s23, 0x2c000
    buffer_load_dwordx4 v[108:111], v11, s[8:11], s23 offen offset:2048 sc1
    v_mfma_f32_16x16x32_bf16 v[60:63], v[240:243], v[116:119], v[60:63]
    s_waitcnt vmcnt(14)
    s_barrier
    ds_read_b64_tr_b16 v[232:233], v7 offset:16384
    ds_read_b64_tr_b16 v[234:235], v7 offset:17408
    s_add_u32 s17, s18, 24576
    buffer_load_dword v12, v13, s[8:11], s17 offen sc1
    s_waitcnt lgkmcnt(6)
    v_mfma_f32_16x16x32_bf16 v[64:67], v[244:247], v[112:115], v[64:67]
    s_add_u32 s22, s24, 0x3a0000
    s_add_u32 m0, s20, 0x1c000
    s_nop 0
    buffer_load_dwordx4 v3, s[4:7], s22 offen lds
    ds_read_b64_tr_b16 v[236:237], v8 offset:16416
    v_mfma_f32_16x16x32_bf16 v[68:71], v[244:247], v[116:119], v[68:71]
    ds_read_b64_tr_b16 v[238:239], v8 offset:17440
    s_waitcnt lgkmcnt(6)
    v_mfma_f32_16x16x32_bf16 v[72:75], v[224:227], v[112:115], v[72:75]
    ds_read_b64_tr_b16 v[240:241], v7 offset:16640
    v_mfma_f32_16x16x32_bf16 v[76:79], v[224:227], v[116:119], v[76:79]
    ds_read_b64_tr_b16 v[242:243], v7 offset:17664
    s_waitcnt lgkmcnt(6)
    v_mfma_f32_16x16x32_bf16 v[80:83], v[228:231], v[112:115], v[80:83]
    ds_read_b64_tr_b16 v[244:245], v8 offset:16672
    v_mfma_f32_16x16x32_bf16 v[84:87], v[228:231], v[116:119], v[84:87]
    ds_read_b64_tr_b16 v[246:247], v8 offset:17696
    s_waitcnt vmcnt(15) lgkmcnt(6)
    v_mfma_f32_16x16x32_bf16 v[24:27], v[232:235], v[120:123], v[24:27]
    ds_read_b64_tr_b16 v[224:225], v7 offset:16896
    s_waitcnt vmcnt(14)
    v_mfma_f32_16x16x32_bf16 v[28:31], v[232:235], v[124:127], v[28:31]
    s_add_u32 s22, s24, 0x3a2000
    s_add_u32 m0, s20, 0x1c400
    s_nop 0
    buffer_load_dwordx4 v3, s[4:7], s22 offen lds
    ds_read_b64_tr_b16 v[226:227], v7 offset:17920
    s_waitcnt lgkmcnt(6)
    v_mfma_f32_16x16x32_bf16 v[32:35], v[236:239], v[120:123], v[32:35]
    ds_read_b64_tr_b16 v[228:229], v8 offset:16928
    s_mov_b32 s23, 0xe000
    buffer_load_dwordx4 v[112:115], v11, s[8:11], s23 offen offset:2048 sc1
    v_mfma_f32_16x16x32_bf16 v[36:39], v[236:239], v[124:127], v[36:39]
    ds_read_b64_tr_b16 v[230:231], v8 offset:17952
    s_waitcnt lgkmcnt(6)
    v_mfma_f32_16x16x32_bf16 v[40:43], v[240:243], v[120:123], v[40:43]
    ds_read_b64_tr_b16 v[232:233], v7 offset:17152
    v_mfma_f32_16x16x32_bf16 v[44:47], v[240:243], v[124:127], v[44:47]
    ds_read_b64_tr_b16 v[234:235], v7 offset:18176
    s_waitcnt lgkmcnt(6)
    v_mfma_f32_16x16x32_bf16 v[48:51], v[244:247], v[120:123], v[48:51]
    ds_read_b64_tr_b16 v[236:237], v8 offset:17184
    v_mfma_f32_16x16x32_bf16 v[52:55], v[244:247], v[124:127], v[52:55]
    ds_read_b64_tr_b16 v[238:239], v8 offset:18208
    s_waitcnt lgkmcnt(6)
    v_mfma_f32_16x16x32_bf16 v[56:59], v[224:227], v[120:123], v[56:59]
    s_mov_b32 s23, 0x2e000
    buffer_load_dwordx4 v[116:119], v11, s[8:11], s23 offen offset:2048 sc1
    v_mfma_f32_16x16x32_bf16 v[60:63], v[224:227], v[124:127], v[60:63]
    s_waitcnt vmcnt(15)
    s_barrier
    ds_read_b64_tr_b16 v[240:241], v4 offset:0
    ds_read_b64_tr_b16 v[242:243], v4 offset:1024
    s_waitcnt lgkmcnt(6)
    v_mfma_f32_16x16x32_bf16 v[64:67], v[228:231], v[120:123], v[64:67]
    s_add_u32 s22, s24, 0x30000
    s_add_u32 m0, s20, 0x20000
    s_nop 0
    buffer_load_dwordx4 v3, s[4:7], s22 offen lds
    ds_read_b64_tr_b16 v[244:245], v5 offset:32
    v_mfma_f32_16x16x32_bf16 v[68:71], v[228:231], v[124:127], v[68:71]
    ds_read_b64_tr_b16 v[246:247], v5 offset:1056
    s_waitcnt lgkmcnt(6)
    v_mfma_f32_16x16x32_bf16 v[72:75], v[232:235], v[120:123], v[72:75]
    ds_read_b64_tr_b16 v[224:225], v4 offset:256
    v_mfma_f32_16x16x32_bf16 v[76:79], v[232:235], v[124:127], v[76:79]
    ds_read_b64_tr_b16 v[226:227], v4 offset:1280
    s_waitcnt lgkmcnt(6)
    v_mfma_f32_16x16x32_bf16 v[80:83], v[236:239], v[120:123], v[80:83]
    ds_read_b64_tr_b16 v[228:229], v5 offset:288
    v_mfma_f32_16x16x32_bf16 v[84:87], v[236:239], v[124:127], v[84:87]
    ds_read_b64_tr_b16 v[230:231], v5 offset:1312
    s_waitcnt vmcnt(5)
    v_cmp_ne_u32 vcc, s28, v12
    s_cbranch_vccnz adaLN_cond__sliding_block_cached__moe_arch_mod__prompt_kernel_o29r
adaLN_cond__sliding_block_cached__moe_arch_mod__prompt_kernel_o29b:
    s_waitcnt lgkmcnt(6)
    v_mfma_f32_16x16x32_bf16 v[24:27], v[240:243], v[88:91], v[24:27]
    ds_read_b64_tr_b16 v[232:233], v4 offset:512
    v_mfma_f32_16x16x32_bf16 v[28:31], v[240:243], v[92:95], v[28:31]
    s_add_u32 s22, s24, 0x32000
    s_add_u32 m0, s20, 0x20400
    s_nop 0
    buffer_load_dwordx4 v3, s[4:7], s22 offen lds
    ds_read_b64_tr_b16 v[234:235], v4 offset:1536
    s_waitcnt lgkmcnt(6)
    v_mfma_f32_16x16x32_bf16 v[32:35], v[244:247], v[88:91], v[32:35]
    ds_read_b64_tr_b16 v[236:237], v5 offset:544
    s_mov_b32 s23, 0x0
    buffer_load_dwordx4 v[120:123], v11, s[8:11], s23 offen offset:3072 sc1
    v_mfma_f32_16x16x32_bf16 v[36:39], v[244:247], v[92:95], v[36:39]
    ds_read_b64_tr_b16 v[238:239], v5 offset:1568
    s_waitcnt lgkmcnt(6)
    v_mfma_f32_16x16x32_bf16 v[40:43], v[224:227], v[88:91], v[40:43]
    ds_read_b64_tr_b16 v[240:241], v4 offset:768
    v_mfma_f32_16x16x32_bf16 v[44:47], v[224:227], v[92:95], v[44:47]
    ds_read_b64_tr_b16 v[242:243], v4 offset:1792
    s_waitcnt lgkmcnt(6)
    v_mfma_f32_16x16x32_bf16 v[48:51], v[228:231], v[88:91], v[48:51]
    ds_read_b64_tr_b16 v[244:245], v5 offset:800
    v_mfma_f32_16x16x32_bf16 v[52:55], v[228:231], v[92:95], v[52:55]
    ds_read_b64_tr_b16 v[246:247], v5 offset:1824
    s_waitcnt lgkmcnt(6)
    v_mfma_f32_16x16x32_bf16 v[56:59], v[232:235], v[88:91], v[56:59]
    s_mov_b32 s23, 0x20000
    buffer_load_dwordx4 v[124:127], v11, s[8:11], s23 offen offset:3072 sc1
    v_mfma_f32_16x16x32_bf16 v[60:63], v[232:235], v[92:95], v[60:63]
    s_barrier
    ds_read_b64_tr_b16 v[224:225], v4 offset:16384
    ds_read_b64_tr_b16 v[226:227], v4 offset:17408
    s_waitcnt lgkmcnt(6)
    v_mfma_f32_16x16x32_bf16 v[64:67], v[236:239], v[88:91], v[64:67]
    s_add_u32 s22, s24, 0xb0000
    s_add_u32 m0, s20, 0x24000
    s_nop 0
    buffer_load_dwordx4 v3, s[4:7], s22 offen lds
    ds_read_b64_tr_b16 v[228:229], v5 offset:16416
    v_mfma_f32_16x16x32_bf16 v[68:71], v[236:239], v[92:95], v[68:71]
    ds_read_b64_tr_b16 v[230:231], v5 offset:17440
    s_waitcnt lgkmcnt(6)
    v_mfma_f32_16x16x32_bf16 v[72:75], v[240:243], v[88:91], v[72:75]
    ds_read_b64_tr_b16 v[232:233], v4 offset:16640
    v_mfma_f32_16x16x32_bf16 v[76:79], v[240:243], v[92:95], v[76:79]
    ds_read_b64_tr_b16 v[234:235], v4 offset:17664
    s_waitcnt lgkmcnt(6)
    v_mfma_f32_16x16x32_bf16 v[80:83], v[244:247], v[88:91], v[80:83]
    ds_read_b64_tr_b16 v[236:237], v5 offset:16672
    v_mfma_f32_16x16x32_bf16 v[84:87], v[244:247], v[92:95], v[84:87]
    ds_read_b64_tr_b16 v[238:239], v5 offset:17696
    s_waitcnt lgkmcnt(6)
    v_mfma_f32_16x16x32_bf16 v[24:27], v[224:227], v[96:99], v[24:27]
    ds_read_b64_tr_b16 v[240:241], v4 offset:16896
    v_mfma_f32_16x16x32_bf16 v[28:31], v[224:227], v[100:103], v[28:31]
    s_add_u32 s22, s24, 0xb2000
    s_add_u32 m0, s20, 0x24400
    s_nop 0
    buffer_load_dwordx4 v3, s[4:7], s22 offen lds
    ds_read_b64_tr_b16 v[242:243], v4 offset:17920
    s_waitcnt lgkmcnt(6)
    v_mfma_f32_16x16x32_bf16 v[32:35], v[228:231], v[96:99], v[32:35]
    ds_read_b64_tr_b16 v[244:245], v5 offset:16928
    s_mov_b32 s23, 0x2000
    buffer_load_dwordx4 v[88:91], v11, s[8:11], s23 offen offset:3072 sc1
    v_mfma_f32_16x16x32_bf16 v[36:39], v[228:231], v[100:103], v[36:39]
    ds_read_b64_tr_b16 v[246:247], v5 offset:17952
    s_waitcnt lgkmcnt(6)
    v_mfma_f32_16x16x32_bf16 v[40:43], v[232:235], v[96:99], v[40:43]
    ds_read_b64_tr_b16 v[224:225], v4 offset:17152
    v_mfma_f32_16x16x32_bf16 v[44:47], v[232:235], v[100:103], v[44:47]
    ds_read_b64_tr_b16 v[226:227], v4 offset:18176
    s_waitcnt lgkmcnt(6)
    v_mfma_f32_16x16x32_bf16 v[48:51], v[236:239], v[96:99], v[48:51]
    ds_read_b64_tr_b16 v[228:229], v5 offset:17184
    v_mfma_f32_16x16x32_bf16 v[52:55], v[236:239], v[100:103], v[52:55]
    ds_read_b64_tr_b16 v[230:231], v5 offset:18208
    s_waitcnt lgkmcnt(6)
    v_mfma_f32_16x16x32_bf16 v[56:59], v[240:243], v[96:99], v[56:59]
    s_mov_b32 s23, 0x22000
    buffer_load_dwordx4 v[92:95], v11, s[8:11], s23 offen offset:3072 sc1
    v_mfma_f32_16x16x32_bf16 v[60:63], v[240:243], v[100:103], v[60:63]
    s_barrier
    ds_read_b64_tr_b16 v[232:233], v4 offset:32768
    ds_read_b64_tr_b16 v[234:235], v4 offset:33792
    s_waitcnt lgkmcnt(6)
    v_mfma_f32_16x16x32_bf16 v[64:67], v[244:247], v[96:99], v[64:67]
    s_add_u32 s22, s24, 0x130000
    s_add_u32 m0, s20, 0x10000
    s_nop 0
    buffer_load_dwordx4 v3, s[4:7], s22 offen lds
    ds_read_b64_tr_b16 v[236:237], v5 offset:32800
    v_mfma_f32_16x16x32_bf16 v[68:71], v[244:247], v[100:103], v[68:71]
    ds_read_b64_tr_b16 v[238:239], v5 offset:33824
    s_waitcnt lgkmcnt(6)
    v_mfma_f32_16x16x32_bf16 v[72:75], v[224:227], v[96:99], v[72:75]
    ds_read_b64_tr_b16 v[240:241], v4 offset:33024
    v_mfma_f32_16x16x32_bf16 v[76:79], v[224:227], v[100:103], v[76:79]
    ds_read_b64_tr_b16 v[242:243], v4 offset:34048
    s_waitcnt lgkmcnt(6)
    v_mfma_f32_16x16x32_bf16 v[80:83], v[228:231], v[96:99], v[80:83]
    ds_read_b64_tr_b16 v[244:245], v5 offset:33056
    v_mfma_f32_16x16x32_bf16 v[84:87], v[228:231], v[100:103], v[84:87]
    ds_read_b64_tr_b16 v[246:247], v5 offset:34080
    s_waitcnt lgkmcnt(6)
    v_mfma_f32_16x16x32_bf16 v[24:27], v[232:235], v[104:107], v[24:27]
    ds_read_b64_tr_b16 v[224:225], v4 offset:33280
    v_mfma_f32_16x16x32_bf16 v[28:31], v[232:235], v[108:111], v[28:31]
    s_add_u32 s22, s24, 0x132000
    s_add_u32 m0, s20, 0x10400
    s_nop 0
    buffer_load_dwordx4 v3, s[4:7], s22 offen lds
    ds_read_b64_tr_b16 v[226:227], v4 offset:34304
    s_waitcnt lgkmcnt(6)
    v_mfma_f32_16x16x32_bf16 v[32:35], v[236:239], v[104:107], v[32:35]
    ds_read_b64_tr_b16 v[228:229], v5 offset:33312
    s_mov_b32 s23, 0x4000
    buffer_load_dwordx4 v[96:99], v11, s[8:11], s23 offen offset:3072 sc1
    v_mfma_f32_16x16x32_bf16 v[36:39], v[236:239], v[108:111], v[36:39]
    ds_read_b64_tr_b16 v[230:231], v5 offset:34336
    s_waitcnt lgkmcnt(6)
    v_mfma_f32_16x16x32_bf16 v[40:43], v[240:243], v[104:107], v[40:43]
    ds_read_b64_tr_b16 v[232:233], v4 offset:33536
    v_mfma_f32_16x16x32_bf16 v[44:47], v[240:243], v[108:111], v[44:47]
    ds_read_b64_tr_b16 v[234:235], v4 offset:34560
    s_mov_b32 s16, 0x544000
    buffer_load_dwordx4 v[184:187], v2, s[8:11], s16 offen sc1
    s_waitcnt lgkmcnt(6)
    v_mfma_f32_16x16x32_bf16 v[48:51], v[244:247], v[104:107], v[48:51]
    ds_read_b64_tr_b16 v[236:237], v5 offset:33568
    v_mfma_f32_16x16x32_bf16 v[52:55], v[244:247], v[108:111], v[52:55]
    ds_read_b64_tr_b16 v[238:239], v5 offset:34592
    s_waitcnt lgkmcnt(6)
    v_mfma_f32_16x16x32_bf16 v[56:59], v[224:227], v[104:107], v[56:59]
    s_mov_b32 s23, 0x24000
    buffer_load_dwordx4 v[100:103], v11, s[8:11], s23 offen offset:3072 sc1
    v_mfma_f32_16x16x32_bf16 v[60:63], v[224:227], v[108:111], v[60:63]
    s_waitcnt vmcnt(15)
    s_barrier
    ds_read_b64_tr_b16 v[240:241], v4 offset:49152
    ds_read_b64_tr_b16 v[242:243], v4 offset:50176
    s_waitcnt lgkmcnt(6)
    v_mfma_f32_16x16x32_bf16 v[64:67], v[228:231], v[104:107], v[64:67]
    s_add_u32 s22, s24, 0x1b0000
    s_add_u32 m0, s20, 0x14000
    s_nop 0
    buffer_load_dwordx4 v3, s[4:7], s22 offen lds
    ds_read_b64_tr_b16 v[244:245], v5 offset:49184
    v_mfma_f32_16x16x32_bf16 v[68:71], v[228:231], v[108:111], v[68:71]
    ds_read_b64_tr_b16 v[246:247], v5 offset:50208
    s_waitcnt lgkmcnt(6)
    v_mfma_f32_16x16x32_bf16 v[72:75], v[232:235], v[104:107], v[72:75]
    ds_read_b64_tr_b16 v[224:225], v4 offset:49408
    v_mfma_f32_16x16x32_bf16 v[76:79], v[232:235], v[108:111], v[76:79]
    ds_read_b64_tr_b16 v[226:227], v4 offset:50432
    s_waitcnt lgkmcnt(6)
    v_mfma_f32_16x16x32_bf16 v[80:83], v[236:239], v[104:107], v[80:83]
    ds_read_b64_tr_b16 v[228:229], v5 offset:49440
    v_mfma_f32_16x16x32_bf16 v[84:87], v[236:239], v[108:111], v[84:87]
    ds_read_b64_tr_b16 v[230:231], v5 offset:50464
    s_waitcnt vmcnt(15) lgkmcnt(6)
    v_mfma_f32_16x16x32_bf16 v[24:27], v[240:243], v[112:115], v[24:27]
    ds_read_b64_tr_b16 v[232:233], v4 offset:49664
    s_waitcnt vmcnt(14)
    v_mfma_f32_16x16x32_bf16 v[28:31], v[240:243], v[116:119], v[28:31]
    s_add_u32 s22, s24, 0x1b2000
    s_add_u32 m0, s20, 0x14400
    s_nop 0
    buffer_load_dwordx4 v3, s[4:7], s22 offen lds
    ds_read_b64_tr_b16 v[234:235], v4 offset:50688
    s_waitcnt lgkmcnt(6)
    v_mfma_f32_16x16x32_bf16 v[32:35], v[244:247], v[112:115], v[32:35]
    ds_read_b64_tr_b16 v[236:237], v5 offset:49696
    s_mov_b32 s23, 0x6000
    buffer_load_dwordx4 v[104:107], v11, s[8:11], s23 offen offset:3072 sc1
    v_mfma_f32_16x16x32_bf16 v[36:39], v[244:247], v[116:119], v[36:39]
    ds_read_b64_tr_b16 v[238:239], v5 offset:50720
    s_waitcnt lgkmcnt(6)
    v_mfma_f32_16x16x32_bf16 v[40:43], v[224:227], v[112:115], v[40:43]
    ds_read_b64_tr_b16 v[240:241], v4 offset:49920
    v_mfma_f32_16x16x32_bf16 v[44:47], v[224:227], v[116:119], v[44:47]
    ds_read_b64_tr_b16 v[242:243], v4 offset:50944
    s_waitcnt lgkmcnt(6)
    v_mfma_f32_16x16x32_bf16 v[48:51], v[228:231], v[112:115], v[48:51]
    ds_read_b64_tr_b16 v[244:245], v5 offset:49952
    v_mfma_f32_16x16x32_bf16 v[52:55], v[228:231], v[116:119], v[52:55]
    ds_read_b64_tr_b16 v[246:247], v5 offset:50976
    s_waitcnt lgkmcnt(6)
    v_mfma_f32_16x16x32_bf16 v[56:59], v[232:235], v[112:115], v[56:59]
    s_mov_b32 s23, 0x26000
    buffer_load_dwordx4 v[108:111], v11, s[8:11], s23 offen offset:3072 sc1
    v_mfma_f32_16x16x32_bf16 v[60:63], v[232:235], v[116:119], v[60:63]
    s_waitcnt vmcnt(15)
    s_barrier
    ds_read_b64_tr_b16 v[224:225], v7 offset:0
    ds_read_b64_tr_b16 v[226:227], v7 offset:1024
    s_waitcnt lgkmcnt(6)
    v_mfma_f32_16x16x32_bf16 v[64:67], v[236:239], v[112:115], v[64:67]
    s_add_u32 s22, s24, 0x230000
    s_add_u32 m0, s20, 0x18000
    s_nop 0
    buffer_load_dwordx4 v3, s[4:7], s22 offen lds
    ds_read_b64_tr_b16 v[228:229], v8 offset:32
    v_mfma_f32_16x16x32_bf16 v[68:71], v[236:239], v[116:119], v[68:71]
    ds_read_b64_tr_b16 v[230:231], v8 offset:1056
    s_waitcnt lgkmcnt(6)
    v_mfma_f32_16x16x32_bf16 v[72:75], v[240:243], v[112:115], v[72:75]
    ds_read_b64_tr_b16 v[232:233], v7 offset:256
    v_mfma_f32_16x16x32_bf16 v[76:79], v[240:243], v[116:119], v[76:79]
    ds_read_b64_tr_b16 v[234:235], v7 offset:1280
    s_waitcnt lgkmcnt(6)
    v_mfma_f32_16x16x32_bf16 v[80:83], v[244:247], v[112:115], v[80:83]
    ds_read_b64_tr_b16 v[236:237], v8 offset:288
    v_mfma_f32_16x16x32_bf16 v[84:87], v[244:247], v[116:119], v[84:87]
    ds_read_b64_tr_b16 v[238:239], v8 offset:1312
    s_waitcnt vmcnt(15) lgkmcnt(6)
    v_mfma_f32_16x16x32_bf16 v[24:27], v[224:227], v[120:123], v[24:27]
    ds_read_b64_tr_b16 v[240:241], v7 offset:512
    s_waitcnt vmcnt(14)
    v_mfma_f32_16x16x32_bf16 v[28:31], v[224:227], v[124:127], v[28:31]
    s_add_u32 s22, s24, 0x232000
    s_add_u32 m0, s20, 0x18400
    s_nop 0
    buffer_load_dwordx4 v3, s[4:7], s22 offen lds
    ds_read_b64_tr_b16 v[242:243], v7 offset:1536
    s_waitcnt lgkmcnt(6)
    v_mfma_f32_16x16x32_bf16 v[32:35], v[228:231], v[120:123], v[32:35]
    ds_read_b64_tr_b16 v[244:245], v8 offset:544
    s_mov_b32 s23, 0x8000
    buffer_load_dwordx4 v[112:115], v11, s[8:11], s23 offen offset:3072 sc1
    v_mfma_f32_16x16x32_bf16 v[36:39], v[228:231], v[124:127], v[36:39]
    ds_read_b64_tr_b16 v[246:247], v8 offset:1568
    s_waitcnt lgkmcnt(6)
    v_mfma_f32_16x16x32_bf16 v[40:43], v[232:235], v[120:123], v[40:43]
    ds_read_b64_tr_b16 v[224:225], v7 offset:768
    v_mfma_f32_16x16x32_bf16 v[44:47], v[232:235], v[124:127], v[44:47]
    ds_read_b64_tr_b16 v[226:227], v7 offset:1792
    s_waitcnt lgkmcnt(6)
    v_mfma_f32_16x16x32_bf16 v[48:51], v[236:239], v[120:123], v[48:51]
    ds_read_b64_tr_b16 v[228:229], v8 offset:800
    v_mfma_f32_16x16x32_bf16 v[52:55], v[236:239], v[124:127], v[52:55]
    ds_read_b64_tr_b16 v[230:231], v8 offset:1824
    s_waitcnt lgkmcnt(6)
    v_mfma_f32_16x16x32_bf16 v[56:59], v[240:243], v[120:123], v[56:59]
    s_mov_b32 s23, 0x28000
    buffer_load_dwordx4 v[116:119], v11, s[8:11], s23 offen offset:3072 sc1
    v_mfma_f32_16x16x32_bf16 v[60:63], v[240:243], v[124:127], v[60:63]
    s_waitcnt vmcnt(15)
    s_barrier
    ds_read_b64_tr_b16 v[232:233], v7 offset:16384
    ds_read_b64_tr_b16 v[234:235], v7 offset:17408
    s_waitcnt lgkmcnt(6)
    v_mfma_f32_16x16x32_bf16 v[64:67], v[244:247], v[120:123], v[64:67]
    s_add_u32 s22, s24, 0x2b0000
    s_add_u32 m0, s20, 0x1c000
    s_nop 0
    buffer_load_dwordx4 v3, s[4:7], s22 offen lds
    ds_read_b64_tr_b16 v[236:237], v8 offset:16416
    v_mfma_f32_16x16x32_bf16 v[68:71], v[244:247], v[124:127], v[68:71]
    ds_read_b64_tr_b16 v[238:239], v8 offset:17440
    s_waitcnt lgkmcnt(6)
    v_mfma_f32_16x16x32_bf16 v[72:75], v[224:227], v[120:123], v[72:75]
    ds_read_b64_tr_b16 v[240:241], v7 offset:16640
    v_mfma_f32_16x16x32_bf16 v[76:79], v[224:227], v[124:127], v[76:79]
    ds_read_b64_tr_b16 v[242:243], v7 offset:17664
    s_waitcnt lgkmcnt(6)
    v_mfma_f32_16x16x32_bf16 v[80:83], v[228:231], v[120:123], v[80:83]
    ds_read_b64_tr_b16 v[244:245], v8 offset:16672
    v_mfma_f32_16x16x32_bf16 v[84:87], v[228:231], v[124:127], v[84:87]
    ds_read_b64_tr_b16 v[246:247], v8 offset:17696
    s_waitcnt vmcnt(15) lgkmcnt(6)
    v_mfma_f32_16x16x32_bf16 v[24:27], v[232:235], v[88:91], v[24:27]
    ds_read_b64_tr_b16 v[224:225], v7 offset:16896
    s_waitcnt vmcnt(14)
    v_mfma_f32_16x16x32_bf16 v[28:31], v[232:235], v[92:95], v[28:31]
    s_add_u32 s22, s24, 0x2b2000
    s_add_u32 m0, s20, 0x1c400
    s_nop 0
    buffer_load_dwordx4 v3, s[4:7], s22 offen lds
    ds_read_b64_tr_b16 v[226:227], v7 offset:17920
    s_waitcnt lgkmcnt(6)
    v_mfma_f32_16x16x32_bf16 v[32:35], v[236:239], v[88:91], v[32:35]
    ds_read_b64_tr_b16 v[228:229], v8 offset:16928
    s_mov_b32 s23, 0xa000
    buffer_load_dwordx4 v[120:123], v11, s[8:11], s23 offen offset:3072 sc1
    v_mfma_f32_16x16x32_bf16 v[36:39], v[236:239], v[92:95], v[36:39]
    ds_read_b64_tr_b16 v[230:231], v8 offset:17952
    s_waitcnt lgkmcnt(6)
    v_mfma_f32_16x16x32_bf16 v[40:43], v[240:243], v[88:91], v[40:43]
    ds_read_b64_tr_b16 v[232:233], v7 offset:17152
    v_mfma_f32_16x16x32_bf16 v[44:47], v[240:243], v[92:95], v[44:47]
    ds_read_b64_tr_b16 v[234:235], v7 offset:18176
    s_waitcnt lgkmcnt(6)
    v_mfma_f32_16x16x32_bf16 v[48:51], v[244:247], v[88:91], v[48:51]
    ds_read_b64_tr_b16 v[236:237], v8 offset:17184
    v_mfma_f32_16x16x32_bf16 v[52:55], v[244:247], v[92:95], v[52:55]
    ds_read_b64_tr_b16 v[238:239], v8 offset:18208
    s_waitcnt lgkmcnt(6)
    v_mfma_f32_16x16x32_bf16 v[56:59], v[224:227], v[88:91], v[56:59]
    s_mov_b32 s23, 0x2a000
    buffer_load_dwordx4 v[124:127], v11, s[8:11], s23 offen offset:3072 sc1
    v_mfma_f32_16x16x32_bf16 v[60:63], v[224:227], v[92:95], v[60:63]
    s_waitcnt vmcnt(15)
    s_barrier
    ds_read_b64_tr_b16 v[240:241], v4 offset:0
    ds_read_b64_tr_b16 v[242:243], v4 offset:1024
    s_waitcnt lgkmcnt(6)
    v_mfma_f32_16x16x32_bf16 v[64:67], v[228:231], v[88:91], v[64:67]
    s_add_u32 s22, s24, 0x330000
    s_add_u32 m0, s20, 0x20000
    s_nop 0
    buffer_load_dwordx4 v3, s[4:7], s22 offen lds
    ds_read_b64_tr_b16 v[244:245], v5 offset:32
    v_mfma_f32_16x16x32_bf16 v[68:71], v[228:231], v[92:95], v[68:71]
    ds_read_b64_tr_b16 v[246:247], v5 offset:1056
    s_waitcnt lgkmcnt(6)
    v_mfma_f32_16x16x32_bf16 v[72:75], v[232:235], v[88:91], v[72:75]
    ds_read_b64_tr_b16 v[224:225], v4 offset:256
    v_mfma_f32_16x16x32_bf16 v[76:79], v[232:235], v[92:95], v[76:79]
    ds_read_b64_tr_b16 v[226:227], v4 offset:1280
    s_waitcnt lgkmcnt(6)
    v_mfma_f32_16x16x32_bf16 v[80:83], v[236:239], v[88:91], v[80:83]
    ds_read_b64_tr_b16 v[228:229], v5 offset:288
    v_mfma_f32_16x16x32_bf16 v[84:87], v[236:239], v[92:95], v[84:87]
    ds_read_b64_tr_b16 v[230:231], v5 offset:1312
    s_waitcnt vmcnt(15) lgkmcnt(6)
    v_mfma_f32_16x16x32_bf16 v[24:27], v[240:243], v[96:99], v[24:27]
    ds_read_b64_tr_b16 v[232:233], v4 offset:512
    s_waitcnt vmcnt(13)
    v_mfma_f32_16x16x32_bf16 v[28:31], v[240:243], v[100:103], v[28:31]
    s_add_u32 s22, s24, 0x332000
    s_add_u32 m0, s20, 0x20400
    s_nop 0
    buffer_load_dwordx4 v3, s[4:7], s22 offen lds
    ds_read_b64_tr_b16 v[234:235], v4 offset:1536
    s_waitcnt lgkmcnt(6)
    v_mfma_f32_16x16x32_bf16 v[32:35], v[244:247], v[96:99], v[32:35]
    ds_read_b64_tr_b16 v[236:237], v5 offset:544
    s_mov_b32 s23, 0xc000
    buffer_load_dwordx4 v[88:91], v11, s[8:11], s23 offen offset:3072 sc1
    v_mfma_f32_16x16x32_bf16 v[36:39], v[244:247], v[100:103], v[36:39]
    ds_read_b64_tr_b16 v[238:239], v5 offset:1568
    s_waitcnt lgkmcnt(6)
    v_mfma_f32_16x16x32_bf16 v[40:43], v[224:227], v[96:99], v[40:43]
    ds_read_b64_tr_b16 v[240:241], v4 offset:768
    v_mfma_f32_16x16x32_bf16 v[44:47], v[224:227], v[100:103], v[44:47]
    ds_read_b64_tr_b16 v[242:243], v4 offset:1792
    v_xor_b32 v16, s28, v184
    v_xor_b32 v17, s28, v185
    v_xor_b32 v18, s28, v186
    v_xor_b32 v19, s28, v187
    v_or3_b32 v16, v16, v17, v18
    v_or_b32 v16, v16, v19
    v_cmp_ne_u32 vcc, 0, v16
    s_cbranch_vccnz adaLN_cond__sliding_block_cached__moe_arch_mod__prompt_kernel_mf10r
adaLN_cond__sliding_block_cached__moe_arch_mod__prompt_kernel_mf10b:
    s_waitcnt lgkmcnt(6)
    v_mfma_f32_16x16x32_bf16 v[48:51], v[228:231], v[96:99], v[48:51]
    ds_read_b64_tr_b16 v[244:245], v5 offset:800
    v_mfma_f32_16x16x32_bf16 v[52:55], v[228:231], v[100:103], v[52:55]
    ds_read_b64_tr_b16 v[246:247], v5 offset:1824
    s_waitcnt lgkmcnt(6)
    v_mfma_f32_16x16x32_bf16 v[56:59], v[232:235], v[96:99], v[56:59]
    s_mov_b32 s23, 0x2c000
    buffer_load_dwordx4 v[92:95], v11, s[8:11], s23 offen offset:3072 sc1
    v_mfma_f32_16x16x32_bf16 v[60:63], v[232:235], v[100:103], v[60:63]
    s_waitcnt vmcnt(14)
    s_barrier
    ds_read_b64_tr_b16 v[224:225], v4 offset:16384
    ds_read_b64_tr_b16 v[226:227], v4 offset:17408
    s_waitcnt lgkmcnt(6)
    v_mfma_f32_16x16x32_bf16 v[64:67], v[236:239], v[96:99], v[64:67]
    s_add_u32 s22, s24, 0x3b0000
    s_add_u32 m0, s20, 0x24000
    s_nop 0
    buffer_load_dwordx4 v3, s[4:7], s22 offen lds
    ds_read_b64_tr_b16 v[228:229], v5 offset:16416
    v_mfma_f32_16x16x32_bf16 v[68:71], v[236:239], v[100:103], v[68:71]
    ds_read_b64_tr_b16 v[230:231], v5 offset:17440
    s_waitcnt lgkmcnt(6)
    v_mfma_f32_16x16x32_bf16 v[72:75], v[240:243], v[96:99], v[72:75]
    ds_read_b64_tr_b16 v[232:233], v4 offset:16640
    v_mfma_f32_16x16x32_bf16 v[76:79], v[240:243], v[100:103], v[76:79]
    ds_read_b64_tr_b16 v[234:235], v4 offset:17664
    s_waitcnt lgkmcnt(6)
    v_mfma_f32_16x16x32_bf16 v[80:83], v[244:247], v[96:99], v[80:83]
    ds_read_b64_tr_b16 v[236:237], v5 offset:16672
    v_mfma_f32_16x16x32_bf16 v[84:87], v[244:247], v[100:103], v[84:87]
    ds_read_b64_tr_b16 v[238:239], v5 offset:17696
    s_waitcnt vmcnt(14) lgkmcnt(6)
    v_mfma_f32_16x16x32_bf16 v[24:27], v[224:227], v[104:107], v[24:27]
    ds_read_b64_tr_b16 v[240:241], v4 offset:16896
    s_waitcnt vmcnt(13)
    v_mfma_f32_16x16x32_bf16 v[28:31], v[224:227], v[108:111], v[28:31]
    s_add_u32 s22, s24, 0x3b2000
    s_add_u32 m0, s20, 0x24400
    s_nop 0
    buffer_load_dwordx4 v3, s[4:7], s22 offen lds
    ds_read_b64_tr_b16 v[242:243], v4 offset:17920
    s_waitcnt lgkmcnt(6)
    v_mfma_f32_16x16x32_bf16 v[32:35], v[228:231], v[104:107], v[32:35]
    ds_read_b64_tr_b16 v[244:245], v5 offset:16928
    s_mov_b32 s23, 0xe000
    buffer_load_dwordx4 v[96:99], v11, s[8:11], s23 offen offset:3072 sc1
    v_mfma_f32_16x16x32_bf16 v[36:39], v[228:231], v[108:111], v[36:39]
    ds_read_b64_tr_b16 v[246:247], v5 offset:17952
    s_waitcnt lgkmcnt(6)
    v_mfma_f32_16x16x32_bf16 v[40:43], v[232:235], v[104:107], v[40:43]
    ds_read_b64_tr_b16 v[224:225], v4 offset:17152
    v_mfma_f32_16x16x32_bf16 v[44:47], v[232:235], v[108:111], v[44:47]
    ds_read_b64_tr_b16 v[226:227], v4 offset:18176
    v_lshrrev_b32 v16, 4, v1
    v_lshlrev_b32 v16, 3, v16
    s_lshl_b32 s16, s31, 8
    s_add_u32 s16, s16, 0x540000
    buffer_load_dwordx2 v[248:249], v16, s[8:11], s16 offen offset:0 sc1
    buffer_load_dwordx2 v[250:251], v16, s[8:11], s16 offen offset:32 sc1
    buffer_load_dwordx2 v[252:253], v16, s[8:11], s16 offen offset:64 sc1
    buffer_load_dwordx2 v[254:255], v16, s[8:11], s16 offen offset:96 sc1
    s_waitcnt lgkmcnt(6)
    v_mfma_f32_16x16x32_bf16 v[48:51], v[236:239], v[104:107], v[48:51]
    ds_read_b64_tr_b16 v[228:229], v5 offset:17184
    v_mfma_f32_16x16x32_bf16 v[52:55], v[236:239], v[108:111], v[52:55]
    ds_read_b64_tr_b16 v[230:231], v5 offset:18208
    s_waitcnt lgkmcnt(6)
    v_mfma_f32_16x16x32_bf16 v[56:59], v[240:243], v[104:107], v[56:59]
    s_mov_b32 s23, 0x2e000
    buffer_load_dwordx4 v[100:103], v11, s[8:11], s23 offen offset:3072 sc1
    v_mfma_f32_16x16x32_bf16 v[60:63], v[240:243], v[108:111], v[60:63]
    s_waitcnt vmcnt(18)
    s_barrier
    ds_read_b64_tr_b16 v[232:233], v4 offset:32768
    ds_read_b64_tr_b16 v[234:235], v4 offset:33792
    s_waitcnt lgkmcnt(6)
    v_mfma_f32_16x16x32_bf16 v[64:67], v[244:247], v[104:107], v[64:67]
    ds_read_b64_tr_b16 v[236:237], v5 offset:32800
    v_mfma_f32_16x16x32_bf16 v[68:71], v[244:247], v[108:111], v[68:71]
    ds_read_b64_tr_b16 v[238:239], v5 offset:33824
    s_waitcnt lgkmcnt(6)
    v_mfma_f32_16x16x32_bf16 v[72:75], v[224:227], v[104:107], v[72:75]
    ds_read_b64_tr_b16 v[240:241], v4 offset:33024
    v_mfma_f32_16x16x32_bf16 v[76:79], v[224:227], v[108:111], v[76:79]
    ds_read_b64_tr_b16 v[242:243], v4 offset:34048
    s_waitcnt lgkmcnt(6)
    v_mfma_f32_16x16x32_bf16 v[80:83], v[228:231], v[104:107], v[80:83]
    ds_read_b64_tr_b16 v[244:245], v5 offset:33056
    v_mfma_f32_16x16x32_bf16 v[84:87], v[228:231], v[108:111], v[84:87]
    ds_read_b64_tr_b16 v[246:247], v5 offset:34080
    s_waitcnt vmcnt(17) lgkmcnt(6)
    v_mfma_f32_16x16x32_bf16 v[24:27], v[232:235], v[112:115], v[24:27]
    ds_read_b64_tr_b16 v[224:225], v4 offset:33280
    s_waitcnt vmcnt(16)
    v_mfma_f32_16x16x32_bf16 v[28:31], v[232:235], v[116:119], v[28:31]
    ds_read_b64_tr_b16 v[226:227], v4 offset:34304
    s_waitcnt lgkmcnt(6)
    v_mfma_f32_16x16x32_bf16 v[32:35], v[236:239], v[112:115], v[32:35]
    ds_read_b64_tr_b16 v[228:229], v5 offset:33312
    v_mfma_f32_16x16x32_bf16 v[36:39], v[236:239], v[116:119], v[36:39]
    ds_read_b64_tr_b16 v[230:231], v5 offset:34336
    s_waitcnt lgkmcnt(6)
    v_mfma_f32_16x16x32_bf16 v[40:43], v[240:243], v[112:115], v[40:43]
    ds_read_b64_tr_b16 v[232:233], v4 offset:33536
    v_mfma_f32_16x16x32_bf16 v[44:47], v[240:243], v[116:119], v[44:47]
    ds_read_b64_tr_b16 v[234:235], v4 offset:34560
    s_mov_b64 s[64:65], s[44:45]
    s_mov_b32 s66, 0x800
    s_mov_b32 s67, 0x20000
    s_mov_b64 s[76:77], s[32:33]
    s_mov_b32 s78, 0x400000
    s_mov_b32 s79, 0x20000
    s_mov_b64 s[68:69], s[56:57]
    s_mov_b32 s70, 0x400000
    s_mov_b32 s71, 0x20000
    s_lshl_b32 s14, s31, 1
    s_add_u32 s14, s14, s15
    s_lshl_b32 s14, s14, 3
    s_add_u32 s14, s14, s3
    s_lshl_b32 s16, s30, 7
    s_add_u32 s14, s14, s16
    s_lshl_b32 s16, s14, 11
    buffer_load_dwordx4 v[216:219], v2, s[76:79], s16 offen offset:0
    buffer_load_dwordx4 v[220:223], v2, s[76:79], s16 offen offset:1024
    s_mov_b32 s16, 0x540800
    buffer_load_dwordx4 v[184:187], v2, s[8:11], s16 offen offset:0 sc1
    buffer_load_dwordx4 v[188:191], v2, s[8:11], s16 offen offset:1024 sc1
    s_mov_b32 s16, 0x541000
    buffer_load_dwordx4 v[192:195], v2, s[8:11], s16 offen offset:0 sc1
    buffer_load_dwordx4 v[196:199], v2, s[8:11], s16 offen offset:1024 sc1
    s_mov_b32 s16, 0x541800
    buffer_load_dwordx4 v[200:203], v2, s[8:11], s16 offen offset:0 sc1
    buffer_load_dwordx4 v[204:207], v2, s[8:11], s16 offen offset:1024 sc1
    buffer_load_dwordx4 v[208:211], v2, s[64:67], 0 offen offset:0
    buffer_load_dwordx4 v[212:215], v2, s[64:67], 0 offen offset:1024
    s_waitcnt lgkmcnt(6)
    v_mfma_f32_16x16x32_bf16 v[48:51], v[244:247], v[112:115], v[48:51]
    ds_read_b64_tr_b16 v[236:237], v5 offset:33568
    v_mfma_f32_16x16x32_bf16 v[52:55], v[244:247], v[116:119], v[52:55]
    ds_read_b64_tr_b16 v[238:239], v5 offset:34592
    s_waitcnt lgkmcnt(6)
    v_mfma_f32_16x16x32_bf16 v[56:59], v[224:227], v[112:115], v[56:59]
    v_mfma_f32_16x16x32_bf16 v[60:63], v[224:227], v[116:119], v[60:63]
    s_waitcnt vmcnt(24)
    s_barrier
    ds_read_b64_tr_b16 v[240:241], v4 offset:49152
    ds_read_b64_tr_b16 v[242:243], v4 offset:50176
    s_waitcnt lgkmcnt(6)
    v_mfma_f32_16x16x32_bf16 v[64:67], v[228:231], v[112:115], v[64:67]
    ds_read_b64_tr_b16 v[244:245], v5 offset:49184
    v_mfma_f32_16x16x32_bf16 v[68:71], v[228:231], v[116:119], v[68:71]
    ds_read_b64_tr_b16 v[246:247], v5 offset:50208
    s_waitcnt lgkmcnt(6)
    v_mfma_f32_16x16x32_bf16 v[72:75], v[232:235], v[112:115], v[72:75]
    ds_read_b64_tr_b16 v[224:225], v4 offset:49408
    v_mfma_f32_16x16x32_bf16 v[76:79], v[232:235], v[116:119], v[76:79]
    ds_read_b64_tr_b16 v[226:227], v4 offset:50432
    s_waitcnt lgkmcnt(6)
    v_mfma_f32_16x16x32_bf16 v[80:83], v[236:239], v[112:115], v[80:83]
    ds_read_b64_tr_b16 v[228:229], v5 offset:49440
    v_mfma_f32_16x16x32_bf16 v[84:87], v[236:239], v[116:119], v[84:87]
    ds_read_b64_tr_b16 v[230:231], v5 offset:50464
    s_waitcnt vmcnt(23) lgkmcnt(6)
    v_mfma_f32_16x16x32_bf16 v[24:27], v[240:243], v[120:123], v[24:27]
    ds_read_b64_tr_b16 v[232:233], v4 offset:49664
    s_waitcnt vmcnt(22)
    v_mfma_f32_16x16x32_bf16 v[28:31], v[240:243], v[124:127], v[28:31]
    ds_read_b64_tr_b16 v[234:235], v4 offset:50688
    s_waitcnt lgkmcnt(6)
    v_mfma_f32_16x16x32_bf16 v[32:35], v[244:247], v[120:123], v[32:35]
    ds_read_b64_tr_b16 v[236:237], v5 offset:49696
    v_mfma_f32_16x16x32_bf16 v[36:39], v[244:247], v[124:127], v[36:39]
    ds_read_b64_tr_b16 v[238:239], v5 offset:50720
    s_waitcnt lgkmcnt(6)
    v_mfma_f32_16x16x32_bf16 v[40:43], v[224:227], v[120:123], v[40:43]
    ds_read_b64_tr_b16 v[240:241], v4 offset:49920
    v_mfma_f32_16x16x32_bf16 v[44:47], v[224:227], v[124:127], v[44:47]
    ds_read_b64_tr_b16 v[242:243], v4 offset:50944
    s_waitcnt lgkmcnt(6)
    v_mfma_f32_16x16x32_bf16 v[48:51], v[228:231], v[120:123], v[48:51]
    ds_read_b64_tr_b16 v[244:245], v5 offset:49952
    v_mfma_f32_16x16x32_bf16 v[52:55], v[228:231], v[124:127], v[52:55]
    ds_read_b64_tr_b16 v[246:247], v5 offset:50976
    s_waitcnt lgkmcnt(6)
    v_mfma_f32_16x16x32_bf16 v[56:59], v[232:235], v[120:123], v[56:59]
    v_mfma_f32_16x16x32_bf16 v[60:63], v[232:235], v[124:127], v[60:63]
    s_waitcnt vmcnt(20)
    s_barrier
    ds_read_b64_tr_b16 v[224:225], v7 offset:0
    ds_read_b64_tr_b16 v[226:227], v7 offset:1024
    s_waitcnt lgkmcnt(6)
    v_mfma_f32_16x16x32_bf16 v[64:67], v[236:239], v[120:123], v[64:67]
    ds_read_b64_tr_b16 v[228:229], v8 offset:32
    v_mfma_f32_16x16x32_bf16 v[68:71], v[236:239], v[124:127], v[68:71]
    ds_read_b64_tr_b16 v[230:231], v8 offset:1056
    s_waitcnt lgkmcnt(6)
    v_mfma_f32_16x16x32_bf16 v[72:75], v[240:243], v[120:123], v[72:75]
    ds_read_b64_tr_b16 v[232:233], v7 offset:256
    v_mfma_f32_16x16x32_bf16 v[76:79], v[240:243], v[124:127], v[76:79]
    ds_read_b64_tr_b16 v[234:235], v7 offset:1280
    s_waitcnt lgkmcnt(6)
    v_mfma_f32_16x16x32_bf16 v[80:83], v[244:247], v[120:123], v[80:83]
    ds_read_b64_tr_b16 v[236:237], v8 offset:288
    v_mfma_f32_16x16x32_bf16 v[84:87], v[244:247], v[124:127], v[84:87]
    ds_read_b64_tr_b16 v[238:239], v8 offset:1312
    s_waitcnt vmcnt(19) lgkmcnt(6)
    v_mfma_f32_16x16x32_bf16 v[24:27], v[224:227], v[88:91], v[24:27]
    ds_read_b64_tr_b16 v[240:241], v7 offset:512
    s_waitcnt vmcnt(18)
    v_mfma_f32_16x16x32_bf16 v[28:31], v[224:227], v[92:95], v[28:31]
    ds_read_b64_tr_b16 v[242:243], v7 offset:1536
    s_waitcnt lgkmcnt(6)
    v_mfma_f32_16x16x32_bf16 v[32:35], v[228:231], v[88:91], v[32:35]
    ds_read_b64_tr_b16 v[244:245], v8 offset:544
    v_mfma_f32_16x16x32_bf16 v[36:39], v[228:231], v[92:95], v[36:39]
    ds_read_b64_tr_b16 v[246:247], v8 offset:1568
    s_waitcnt lgkmcnt(6)
    v_mfma_f32_16x16x32_bf16 v[40:43], v[232:235], v[88:91], v[40:43]
    ds_read_b64_tr_b16 v[224:225], v7 offset:768
    v_mfma_f32_16x16x32_bf16 v[44:47], v[232:235], v[92:95], v[44:47]
    ds_read_b64_tr_b16 v[226:227], v7 offset:1792
    s_waitcnt lgkmcnt(6)
    v_mfma_f32_16x16x32_bf16 v[48:51], v[236:239], v[88:91], v[48:51]
    ds_read_b64_tr_b16 v[228:229], v8 offset:800
    v_mfma_f32_16x16x32_bf16 v[52:55], v[236:239], v[92:95], v[52:55]
    ds_read_b64_tr_b16 v[230:231], v8 offset:1824
    s_waitcnt lgkmcnt(6)
    v_mfma_f32_16x16x32_bf16 v[56:59], v[240:243], v[88:91], v[56:59]
    v_mfma_f32_16x16x32_bf16 v[60:63], v[240:243], v[92:95], v[60:63]
    s_waitcnt vmcnt(16)
    s_barrier
    ds_read_b64_tr_b16 v[232:233], v7 offset:16384
    ds_read_b64_tr_b16 v[234:235], v7 offset:17408
    s_waitcnt lgkmcnt(6)
    v_mfma_f32_16x16x32_bf16 v[64:67], v[244:247], v[88:91], v[64:67]
    ds_read_b64_tr_b16 v[236:237], v8 offset:16416
    v_mfma_f32_16x16x32_bf16 v[68:71], v[244:247], v[92:95], v[68:71]
    ds_read_b64_tr_b16 v[238:239], v8 offset:17440
    s_waitcnt lgkmcnt(6)
    v_mfma_f32_16x16x32_bf16 v[72:75], v[224:227], v[88:91], v[72:75]
    ds_read_b64_tr_b16 v[240:241], v7 offset:16640
    v_mfma_f32_16x16x32_bf16 v[76:79], v[224:227], v[92:95], v[76:79]
    ds_read_b64_tr_b16 v[242:243], v7 offset:17664
    s_waitcnt lgkmcnt(6)
    v_mfma_f32_16x16x32_bf16 v[80:83], v[228:231], v[88:91], v[80:83]
    ds_read_b64_tr_b16 v[244:245], v8 offset:16672
    v_mfma_f32_16x16x32_bf16 v[84:87], v[228:231], v[92:95], v[84:87]
    ds_read_b64_tr_b16 v[246:247], v8 offset:17696
    s_waitcnt vmcnt(15) lgkmcnt(6)
    v_mfma_f32_16x16x32_bf16 v[24:27], v[232:235], v[96:99], v[24:27]
    ds_read_b64_tr_b16 v[224:225], v7 offset:16896
    s_waitcnt vmcnt(10)
    v_mfma_f32_16x16x32_bf16 v[28:31], v[232:235], v[100:103], v[28:31]
    ds_read_b64_tr_b16 v[226:227], v7 offset:17920
    s_waitcnt lgkmcnt(6)
    v_mfma_f32_16x16x32_bf16 v[32:35], v[236:239], v[96:99], v[32:35]
    ds_read_b64_tr_b16 v[228:229], v8 offset:16928
    v_mfma_f32_16x16x32_bf16 v[36:39], v[236:239], v[100:103], v[36:39]
    ds_read_b64_tr_b16 v[230:231], v8 offset:17952
    s_waitcnt lgkmcnt(6)
    v_mfma_f32_16x16x32_bf16 v[40:43], v[240:243], v[96:99], v[40:43]
    ds_read_b64_tr_b16 v[232:233], v7 offset:17152
    v_mfma_f32_16x16x32_bf16 v[44:47], v[240:243], v[100:103], v[44:47]
    ds_read_b64_tr_b16 v[234:235], v7 offset:18176
    s_waitcnt lgkmcnt(6)
    v_mfma_f32_16x16x32_bf16 v[48:51], v[244:247], v[96:99], v[48:51]
    ds_read_b64_tr_b16 v[236:237], v8 offset:17184
    v_mfma_f32_16x16x32_bf16 v[52:55], v[244:247], v[100:103], v[52:55]
    ds_read_b64_tr_b16 v[238:239], v8 offset:18208
    s_waitcnt lgkmcnt(6)
    v_mfma_f32_16x16x32_bf16 v[56:59], v[224:227], v[96:99], v[56:59]
    v_mfma_f32_16x16x32_bf16 v[60:63], v[224:227], v[100:103], v[60:63]
    s_waitcnt lgkmcnt(4)
    v_mfma_f32_16x16x32_bf16 v[64:67], v[228:231], v[96:99], v[64:67]
    v_mfma_f32_16x16x32_bf16 v[68:71], v[228:231], v[100:103], v[68:71]
    s_waitcnt lgkmcnt(2)
    v_mfma_f32_16x16x32_bf16 v[72:75], v[232:235], v[96:99], v[72:75]
    v_mfma_f32_16x16x32_bf16 v[76:79], v[232:235], v[100:103], v[76:79]
    s_waitcnt lgkmcnt(0)
    v_mfma_f32_16x16x32_bf16 v[80:83], v[236:239], v[96:99], v[80:83]
    v_mfma_f32_16x16x32_bf16 v[84:87], v[236:239], v[100:103], v[84:87]
    s_lshl_b32 s16, s3, 13
    s_add_u32 s16, s16, 0x10000
    v_add_u32 v16, s16, v2
    s_xor_b32 s16, s16, 0x8000
    v_add_u32 v17, s16, v2
    ds_write_b128 v16, v[56:59] offset:0
    ds_write_b128 v16, v[60:63] offset:1024
    ds_write_b128 v16, v[64:67] offset:2048
    ds_write_b128 v16, v[68:71] offset:3072
    ds_write_b128 v16, v[72:75] offset:4096
    ds_write_b128 v16, v[76:79] offset:5120
    ds_write_b128 v16, v[80:83] offset:6144
    ds_write_b128 v16, v[84:87] offset:7168
    v_lshlrev_b32 v88, 16, v248
    v_and_b32 v89, 0xffff0000, v248
    v_lshlrev_b32 v90, 16, v249
    v_and_b32 v91, 0xffff0000, v249
    v_lshlrev_b32 v92, 16, v250
    v_and_b32 v93, 0xffff0000, v250
    v_lshlrev_b32 v94, 16, v251
    v_and_b32 v95, 0xffff0000, v251
    v_lshlrev_b32 v96, 16, v252
    v_and_b32 v97, 0xffff0000, v252
    v_lshlrev_b32 v98, 16, v253
    v_and_b32 v99, 0xffff0000, v253
    v_lshlrev_b32 v100, 16, v254
    v_and_b32 v101, 0xffff0000, v254
    v_lshlrev_b32 v102, 16, v255
    v_and_b32 v103, 0xffff0000, v255
    v_and_b32 v18, 15, v1
    v_lshlrev_b32 v18, 6, v18
    v_lshrrev_b32 v19, 4, v1
    v_and_b32 v20, 1, v19
    v_lshl_add_u32 v18, v20, 5, v18
    v_lshrrev_b32 v19, 1, v19
    v_lshl_add_u32 v18, v19, 4, v18
    s_and_b32 s17, s3, 3
    s_lshl_b32 s18, s30, 2
    s_add_u32 s18, s18, s17
    s_lshl_b32 s18, s18, 16
    s_lshl_b32 s19, s15, 22
    s_add_u32 s18, s18, s19
    s_lshl_b32 s19, s31, 12
    s_add_u32 s18, s18, s19
    s_add_u32 s18, s18, 0x2c00000
    s_add_u32 s19, s18, 32768
    s_waitcnt lgkmcnt(0)
    s_barrier
    ds_read_b128 v[104:107], v17 offset:0
    ds_read_b128 v[108:111], v17 offset:1024
    ds_read_b128 v[112:115], v17 offset:2048
    ds_read_b128 v[116:119], v17 offset:3072
    ds_read_b128 v[120:123], v17 offset:4096
    ds_read_b128 v[124:127], v17 offset:5120
    ds_read_b128 v[128:131], v17 offset:6144
    ds_read_b128 v[132:135], v17 offset:7168
    s_waitcnt lgkmcnt(7)
    v_pk_add_f32 v[24:25], v[24:25], v[104:105]
    v_pk_add_f32 v[26:27], v[26:27], v[106:107]
    v_pk_mul_f32 v[24:25], v[24:25], v[88:89]
    v_pk_mul_f32 v[26:27], v[26:27], v[90:91]
    v_cvt_pk_bf16_f32 v136, v24, v25
    v_cvt_pk_bf16_f32 v137, v26, v27
    s_waitcnt lgkmcnt(5)
    v_pk_add_f32 v[32:33], v[32:33], v[112:113]
    v_pk_add_f32 v[34:35], v[34:35], v[114:115]
    v_pk_mul_f32 v[32:33], v[32:33], v[92:93]
    v_pk_mul_f32 v[34:35], v[34:35], v[94:95]
    v_cvt_pk_bf16_f32 v138, v32, v33
    v_cvt_pk_bf16_f32 v139, v34, v35
    s_nop 0
    v_permlane16_swap_b32 v136, v138
    v_permlane16_swap_b32 v137, v139
    buffer_store_dwordx4 v[136:139], v18, s[8:11], s18 offen offset:0 sc1
    v_pk_add_f32 v[28:29], v[28:29], v[108:109]
    v_pk_add_f32 v[30:31], v[30:31], v[110:111]
    v_pk_mul_f32 v[28:29], v[28:29], v[88:89]
    v_pk_mul_f32 v[30:31], v[30:31], v[90:91]
    v_cvt_pk_bf16_f32 v140, v28, v29
    v_cvt_pk_bf16_f32 v141, v30, v31
    s_waitcnt lgkmcnt(4)
    v_pk_add_f32 v[36:37], v[36:37], v[116:117]
    v_pk_add_f32 v[38:39], v[38:39], v[118:119]
    v_pk_mul_f32 v[36:37], v[36:37], v[92:93]
    v_pk_mul_f32 v[38:39], v[38:39], v[94:95]
    v_cvt_pk_bf16_f32 v142, v36, v37
    v_cvt_pk_bf16_f32 v143, v38, v39
    s_nop 0
    v_permlane16_swap_b32 v140, v142
    v_permlane16_swap_b32 v141, v143
    buffer_store_dwordx4 v[140:143], v18, s[8:11], s19 offen offset:0 sc1
    s_waitcnt lgkmcnt(3)
    v_pk_add_f32 v[40:41], v[40:41], v[120:121]
    v_pk_add_f32 v[42:43], v[42:43], v[122:123]
    v_pk_mul_f32 v[40:41], v[40:41], v[96:97]
    v_pk_mul_f32 v[42:43], v[42:43], v[98:99]
    v_cvt_pk_bf16_f32 v144, v40, v41
    v_cvt_pk_bf16_f32 v145, v42, v43
    s_waitcnt lgkmcnt(1)
    v_pk_add_f32 v[48:49], v[48:49], v[128:129]
    v_pk_add_f32 v[50:51], v[50:51], v[130:131]
    v_pk_mul_f32 v[48:49], v[48:49], v[100:101]
    v_pk_mul_f32 v[50:51], v[50:51], v[102:103]
    v_cvt_pk_bf16_f32 v146, v48, v49
    v_cvt_pk_bf16_f32 v147, v50, v51
    s_nop 0
    v_permlane16_swap_b32 v144, v146
    v_permlane16_swap_b32 v145, v147
    buffer_store_dwordx4 v[144:147], v18, s[8:11], s18 offen offset:1024 sc1
    v_pk_add_f32 v[44:45], v[44:45], v[124:125]
    v_pk_add_f32 v[46:47], v[46:47], v[126:127]
    v_pk_mul_f32 v[44:45], v[44:45], v[96:97]
    v_pk_mul_f32 v[46:47], v[46:47], v[98:99]
    v_cvt_pk_bf16_f32 v148, v44, v45
    v_cvt_pk_bf16_f32 v149, v46, v47
    s_waitcnt lgkmcnt(0)
    v_pk_add_f32 v[52:53], v[52:53], v[132:133]
    v_pk_add_f32 v[54:55], v[54:55], v[134:135]
    v_pk_mul_f32 v[52:53], v[52:53], v[100:101]
    v_pk_mul_f32 v[54:55], v[54:55], v[102:103]
    v_cvt_pk_bf16_f32 v150, v52, v53
    v_cvt_pk_bf16_f32 v151, v54, v55
    s_nop 0
    v_permlane16_swap_b32 v148, v150
    v_permlane16_swap_b32 v149, v151
    buffer_store_dwordx4 v[148:151], v18, s[8:11], s19 offen offset:1024 sc1
    v_mov_b32 v94, 0
    s_waitcnt vmcnt(9)
    v_lshlrev_b32 v76, 16, v192
    v_and_b32 v77, 0xffff0000, v192
    s_waitcnt vmcnt(5)
    v_lshlrev_b32 v78, 16, v208
    v_and_b32 v79, 0xffff0000, v208
    v_pk_mul_f32 v[60:61], v[76:77], v[78:79]
    v_lshlrev_b32 v76, 16, v184
    v_and_b32 v77, 0xffff0000, v184
    v_fmac_f32 v94, v76, v78
    v_fmac_f32 v94, v77, v79
    v_lshlrev_b32 v76, 16, v193
    v_and_b32 v77, 0xffff0000, v193
    v_lshlrev_b32 v78, 16, v209
    v_and_b32 v79, 0xffff0000, v209
    v_pk_mul_f32 v[62:63], v[76:77], v[78:79]
    v_lshlrev_b32 v76, 16, v185
    v_and_b32 v77, 0xffff0000, v185
    v_fmac_f32 v94, v76, v78
    v_fmac_f32 v94, v77, v79
    v_lshlrev_b32 v76, 16, v194
    v_and_b32 v77, 0xffff0000, v194
    v_lshlrev_b32 v78, 16, v210
    v_and_b32 v79, 0xffff0000, v210
    v_pk_mul_f32 v[64:65], v[76:77], v[78:79]
    v_lshlrev_b32 v76, 16, v186
    v_and_b32 v77, 0xffff0000, v186
    v_fmac_f32 v94, v76, v78
    v_fmac_f32 v94, v77, v79
    v_lshlrev_b32 v76, 16, v195
    v_and_b32 v77, 0xffff0000, v195
    v_lshlrev_b32 v78, 16, v211
    v_and_b32 v79, 0xffff0000, v211
    v_pk_mul_f32 v[66:67], v[76:77], v[78:79]
    v_lshlrev_b32 v76, 16, v187
    v_and_b32 v77, 0xffff0000, v187
    v_fmac_f32 v94, v76, v78
    v_fmac_f32 v94, v77, v79
    v_lshlrev_b32 v76, 16, v196
    v_and_b32 v77, 0xffff0000, v196
    s_waitcnt vmcnt(4)
    v_lshlrev_b32 v78, 16, v212
    v_and_b32 v79, 0xffff0000, v212
    v_pk_mul_f32 v[68:69], v[76:77], v[78:79]
    v_lshlrev_b32 v76, 16, v188
    v_and_b32 v77, 0xffff0000, v188
    v_fmac_f32 v94, v76, v78
    v_fmac_f32 v94, v77, v79
    v_lshlrev_b32 v76, 16, v197
    v_and_b32 v77, 0xffff0000, v197
    v_lshlrev_b32 v78, 16, v213
    v_and_b32 v79, 0xffff0000, v213
    v_pk_mul_f32 v[70:71], v[76:77], v[78:79]
    v_lshlrev_b32 v76, 16, v189
    v_and_b32 v77, 0xffff0000, v189
    v_fmac_f32 v94, v76, v78
    v_fmac_f32 v94, v77, v79
    v_lshlrev_b32 v76, 16, v198
    v_and_b32 v77, 0xffff0000, v198
    v_lshlrev_b32 v78, 16, v214
    v_and_b32 v79, 0xffff0000, v214
    v_pk_mul_f32 v[72:73], v[76:77], v[78:79]
    v_lshlrev_b32 v76, 16, v190
    v_and_b32 v77, 0xffff0000, v190
    v_fmac_f32 v94, v76, v78
    v_fmac_f32 v94, v77, v79
    v_lshlrev_b32 v76, 16, v199
    v_and_b32 v77, 0xffff0000, v199
    v_lshlrev_b32 v78, 16, v215
    v_and_b32 v79, 0xffff0000, v215
    v_pk_mul_f32 v[74:75], v[76:77], v[78:79]
    v_lshlrev_b32 v76, 16, v191
    v_and_b32 v77, 0xffff0000, v191
    v_fmac_f32 v94, v76, v78
    v_fmac_f32 v94, v77, v79
    s_nop 1
    v_add_f32_dpp v94, v94, v94 row_ror:1 row_mask:0xf bank_mask:0xf
    s_nop 1
    v_add_f32_dpp v94, v94, v94 row_ror:2 row_mask:0xf bank_mask:0xf
    s_nop 1
    v_add_f32_dpp v94, v94, v94 row_ror:4 row_mask:0xf bank_mask:0xf
    s_nop 1
    v_add_f32_dpp v94, v94, v94 row_ror:8 row_mask:0xf bank_mask:0xf
    v_mov_b32 v76, v94
    s_nop 1
    v_permlane16_swap_b32 v94, v76
    v_add_f32 v94, v94, v76
    v_mov_b32 v76, v94
    s_nop 1
    v_permlane32_swap_b32 v94, v76
    v_add_f32 v94, v94, v76
    v_lshlrev_b32 v28, 16, v216
    v_and_b32 v29, 0xffff0000, v216
    v_lshlrev_b32 v30, 16, v217
    v_and_b32 v31, 0xffff0000, v217
    v_lshlrev_b32 v32, 16, v218
    v_and_b32 v33, 0xffff0000, v218
    v_lshlrev_b32 v34, 16, v219
    v_and_b32 v35, 0xffff0000, v219
    v_lshlrev_b32 v36, 16, v220
    v_and_b32 v37, 0xffff0000, v220
    v_lshlrev_b32 v38, 16, v221
    v_and_b32 v39, 0xffff0000, v221
    v_lshlrev_b32 v40, 16, v222
    v_and_b32 v41, 0xffff0000, v222
    v_lshlrev_b32 v42, 16, v223
    v_and_b32 v43, 0xffff0000, v223
    s_and_b32 s17, s3, 3
    s_lshl_b32 s16, s30, 2
    s_add_u32 s16, s16, s17
    s_lshl_b32 s16, s16, 5
    s_lshl_b32 s17, s31, 2
    s_add_u32 s16, s16, s17
    s_lshl_b32 s17, s15, 1
    s_add_u32 s16, s16, s17
    s_add_u32 s16, s16, 0
    s_lshl_b32 s16, s16, 2
    s_add_u32 s16, s16, 0x530000
    v_mov_b32 v16, s28
    v_mov_b32 v17, 0
    s_lshr_b32 s18, s14, 4
    s_lshl_b32 s18, s18, 15
    s_and_b32 s19, s14, 15
    s_lshl_b32 s19, s19, 6
    s_add_u32 s18, s18, s19
    s_add_u32 s18, s18, 0x2c00000
    s_add_u32 s19, s18, 16384
    v_lshrrev_b32 v18, 2, v1
    v_lshlrev_b32 v18, 10, v18
    v_and_b32 v19, 3, v1
    v_lshl_add_u32 v18, v19, 4, v18
    v_add_u32 v19, 0x400000, v18
    s_lshr_b32 s25, s14, 5
    s_lshl_b32 s25, s25, 7
    s_add_u32 s25, s25, 0x530000
    v_and_b32 v20, 31, v1
    v_lshlrev_b32 v20, 2, v20
    s_waitcnt vmcnt(0)
    s_mov_b64 exec, 1
    buffer_store_dword v16, v17, s[8:11], s16 offen sc1
    s_mov_b64 exec, -1
    s_sleep 32
    s_mov_b32 s27, 0
adaLN_cond__sliding_block_cached__moe_arch_mod__prompt_kernel_a11p:
    buffer_load_dword v76, v20, s[8:11], s25 offen sc1
    s_waitcnt vmcnt(0)
    v_cmp_ne_u32 vcc, s28, v76
    s_add_u32 s27, s27, 1
    s_cmp_ge_u32 s27, 262144
    s_cbranch_scc1 adaLN_cond__sliding_block_cached__moe_arch_mod__prompt_kernel_a11g
    s_cbranch_vccnz adaLN_cond__sliding_block_cached__moe_arch_mod__prompt_kernel_a11p
adaLN_cond__sliding_block_cached__moe_arch_mod__prompt_kernel_a11g:
    buffer_load_dwordx4 v[44:47], v18, s[8:11], s18 offen sc1
    buffer_load_dwordx4 v[52:55], v19, s[8:11], s18 offen sc1
    buffer_load_dwordx4 v[48:51], v18, s[8:11], s19 offen sc1
    buffer_load_dwordx4 v[56:59], v19, s[8:11], s19 offen sc1
    v_lshlrev_b32 v21, 2, v0
    s_mov_b32 s16, 0x540800
    buffer_load_dword v106, v21, s[8:11], s16 offen sc1
    buffer_load_dword v104, v21, s[8:11], s16 offen offset:2048 sc1
    s_waitcnt vmcnt(5)
    v_lshlrev_b32 v76, 16, v44
    v_and_b32 v77, 0xffff0000, v44
    s_waitcnt vmcnt(4)
    v_lshlrev_b32 v78, 16, v52
    v_and_b32 v79, 0xffff0000, v52
    v_pk_add_f32 v[76:77], v[76:77], v[78:79]
    v_pk_add_f32 v[28:29], v[28:29], v[76:77]
    v_cvt_pk_bf16_f32 v16, v28, v29
    v_lshlrev_b32 v28, 16, v16
    v_and_b32 v29, 0xffff0000, v16
    v_lshlrev_b32 v80, 16, v45
    v_and_b32 v81, 0xffff0000, v45
    v_lshlrev_b32 v82, 16, v53
    v_and_b32 v83, 0xffff0000, v53
    v_pk_add_f32 v[80:81], v[80:81], v[82:83]
    v_pk_add_f32 v[30:31], v[30:31], v[80:81]
    v_cvt_pk_bf16_f32 v17, v30, v31
    v_lshlrev_b32 v30, 16, v17
    v_and_b32 v31, 0xffff0000, v17
    v_lshlrev_b32 v76, 16, v46
    v_and_b32 v77, 0xffff0000, v46
    v_lshlrev_b32 v78, 16, v54
    v_and_b32 v79, 0xffff0000, v54
    v_pk_add_f32 v[76:77], v[76:77], v[78:79]
    v_pk_add_f32 v[32:33], v[32:33], v[76:77]
    v_cvt_pk_bf16_f32 v16, v32, v33
    v_lshlrev_b32 v32, 16, v16
    v_and_b32 v33, 0xffff0000, v16
    v_lshlrev_b32 v80, 16, v47
    v_and_b32 v81, 0xffff0000, v47
    v_lshlrev_b32 v82, 16, v55
    v_and_b32 v83, 0xffff0000, v55
    v_pk_add_f32 v[80:81], v[80:81], v[82:83]
    v_pk_add_f32 v[34:35], v[34:35], v[80:81]
    v_cvt_pk_bf16_f32 v17, v34, v35
    v_lshlrev_b32 v34, 16, v17
    v_and_b32 v35, 0xffff0000, v17
    s_waitcnt vmcnt(3)
    v_lshlrev_b32 v76, 16, v48
    v_and_b32 v77, 0xffff0000, v48
    s_waitcnt vmcnt(2)
    v_lshlrev_b32 v78, 16, v56
    v_and_b32 v79, 0xffff0000, v56
    v_pk_add_f32 v[76:77], v[76:77], v[78:79]
    v_pk_add_f32 v[36:37], v[36:37], v[76:77]
    v_cvt_pk_bf16_f32 v16, v36, v37
    v_lshlrev_b32 v36, 16, v16
    v_and_b32 v37, 0xffff0000, v16
    v_lshlrev_b32 v80, 16, v49
    v_and_b32 v81, 0xffff0000, v49
    v_lshlrev_b32 v82, 16, v57
    v_and_b32 v83, 0xffff0000, v57
    v_pk_add_f32 v[80:81], v[80:81], v[82:83]
    v_pk_add_f32 v[38:39], v[38:39], v[80:81]
    v_cvt_pk_bf16_f32 v17, v38, v39
    v_lshlrev_b32 v38, 16, v17
    v_and_b32 v39, 0xffff0000, v17
    v_lshlrev_b32 v76, 16, v50
    v_and_b32 v77, 0xffff0000, v50
    v_lshlrev_b32 v78, 16, v58
    v_and_b32 v79, 0xffff0000, v58
    v_pk_add_f32 v[76:77], v[76:77], v[78:79]
    v_pk_add_f32 v[40:41], v[40:41], v[76:77]
    v_cvt_pk_bf16_f32 v16, v40, v41
    v_lshlrev_b32 v40, 16, v16
    v_and_b32 v41, 0xffff0000, v16
    v_lshlrev_b32 v80, 16, v51
    v_and_b32 v81, 0xffff0000, v51
    v_lshlrev_b32 v82, 16, v59
    v_and_b32 v83, 0xffff0000, v59
    v_pk_add_f32 v[80:81], v[80:81], v[82:83]
    v_pk_add_f32 v[42:43], v[42:43], v[80:81]
    v_cvt_pk_bf16_f32 v17, v42, v43
    v_lshlrev_b32 v42, 16, v17
    v_and_b32 v43, 0xffff0000, v17
    v_pk_add_f32 v[76:77], v[28:29], v[30:31]
    v_pk_add_f32 v[78:79], v[32:33], v[34:35]
    v_pk_add_f32 v[76:77], v[76:77], v[36:37]
    v_pk_add_f32 v[78:79], v[78:79], v[38:39]
    v_pk_add_f32 v[76:77], v[76:77], v[40:41]
    v_pk_add_f32 v[78:79], v[78:79], v[42:43]
    v_pk_add_f32 v[76:77], v[76:77], v[78:79]
    v_add_f32 v96, v76, v77
    s_nop 1
    v_add_f32_dpp v96, v96, v96 row_ror:1 row_mask:0xf bank_mask:0xf
    s_nop 1
    v_add_f32_dpp v96, v96, v96 row_ror:2 row_mask:0xf bank_mask:0xf
    s_nop 1
    v_add_f32_dpp v96, v96, v96 row_ror:4 row_mask:0xf bank_mask:0xf
    s_nop 1
    v_add_f32_dpp v96, v96, v96 row_ror:8 row_mask:0xf bank_mask:0xf
    v_mov_b32 v76, v96
    s_nop 1
    v_permlane16_swap_b32 v96, v76
    v_add_f32 v96, v96, v76
    v_mov_b32 v76, v96
    s_nop 1
    v_permlane32_swap_b32 v96, v76
    v_add_f32 v96, v96, v76
    v_mul_f32 v96, 0x3a800000, v96
    v_sub_f32 v44, v28, v96
    v_sub_f32 v45, v29, v96
    v_sub_f32 v46, v30, v96
    v_sub_f32 v47, v31, v96
    v_sub_f32 v48, v32, v96
    v_sub_f32 v49, v33, v96
    v_sub_f32 v50, v34, v96
    v_sub_f32 v51, v35, v96
    v_sub_f32 v52, v36, v96
    v_sub_f32 v53, v37, v96
    v_sub_f32 v54, v38, v96
    v_sub_f32 v55, v39, v96
    v_sub_f32 v56, v40, v96
    v_sub_f32 v57, v41, v96
    v_sub_f32 v58, v42, v96
    v_sub_f32 v59, v43, v96
    v_pk_mul_f32 v[76:77], v[44:45], v[44:45]
    v_pk_mul_f32 v[78:79], v[44:45], v[60:61]
    v_pk_fma_f32 v[76:77], v[46:47], v[46:47], v[76:77]
    v_pk_fma_f32 v[78:79], v[46:47], v[62:63], v[78:79]
    v_pk_fma_f32 v[76:77], v[48:49], v[48:49], v[76:77]
    v_pk_fma_f32 v[78:79], v[48:49], v[64:65], v[78:79]
    v_pk_fma_f32 v[76:77], v[50:51], v[50:51], v[76:77]
    v_pk_fma_f32 v[78:79], v[50:51], v[66:67], v[78:79]
    v_pk_fma_f32 v[76:77], v[52:53], v[52:53], v[76:77]
    v_pk_fma_f32 v[78:79], v[52:53], v[68:69], v[78:79]
    v_pk_fma_f32 v[76:77], v[54:55], v[54:55], v[76:77]
    v_pk_fma_f32 v[78:79], v[54:55], v[70:71], v[78:79]
    v_pk_fma_f32 v[76:77], v[56:57], v[56:57], v[76:77]
    v_pk_fma_f32 v[78:79], v[56:57], v[72:73], v[78:79]
    v_pk_fma_f32 v[76:77], v[58:59], v[58:59], v[76:77]
    v_pk_fma_f32 v[78:79], v[58:59], v[74:75], v[78:79]
    v_add_f32 v97, v76, v77
    v_add_f32 v98, v78, v79
    s_nop 0
    v_add_f32_dpp v97, v97, v97 row_ror:1 row_mask:0xf bank_mask:0xf
    v_add_f32_dpp v98, v98, v98 row_ror:1 row_mask:0xf bank_mask:0xf
    s_nop 0
    v_add_f32_dpp v97, v97, v97 row_ror:2 row_mask:0xf bank_mask:0xf
    v_add_f32_dpp v98, v98, v98 row_ror:2 row_mask:0xf bank_mask:0xf
    s_nop 0
    v_add_f32_dpp v97, v97, v97 row_ror:4 row_mask:0xf bank_mask:0xf
    v_add_f32_dpp v98, v98, v98 row_ror:4 row_mask:0xf bank_mask:0xf
    s_nop 0
    v_add_f32_dpp v97, v97, v97 row_ror:8 row_mask:0xf bank_mask:0xf
    v_add_f32_dpp v98, v98, v98 row_ror:8 row_mask:0xf bank_mask:0xf
    v_mov_b32 v76, v97
    s_nop 1
    v_permlane16_swap_b32 v97, v76
    v_add_f32 v97, v97, v76
    v_mov_b32 v77, v98
    s_nop 1
    v_permlane16_swap_b32 v98, v77
    v_add_f32 v98, v98, v77
    v_mov_b32 v76, v97
    s_nop 1
    v_permlane32_swap_b32 v97, v76
    v_add_f32 v97, v97, v76
    v_mov_b32 v77, v98
    s_nop 1
    v_permlane32_swap_b32 v98, v77
    v_add_f32 v98, v98, v77
    v_mul_f32 v97, 0x3a800000, v97
    v_add_f32 v76, 0x3727c5ac, v97
    v_rsq_f32 v76, v76
    s_nop 0
    v_fma_f32 v27, v98, v76, v94
    v_cvt_pk_bf16_f32 v96, v96, v96
    v_lshlrev_b32 v96, 16, v96
    v_cvt_pk_bf16_f32 v97, v97, v97
    v_lshlrev_b32 v97, 16, v97
    v_add_f32 v97, 0x3727c5ac, v97
    v_cvt_pk_bf16_f32 v97, v97, v97
    v_lshlrev_b32 v97, 16, v97
    v_sqrt_f32 v98, v97
    s_nop 0
    v_cvt_pk_bf16_f32 v98, v98, v98
    v_lshlrev_b32 v98, 16, v98
    v_rcp_f32 v99, v98
    v_mov_b32 v25, v96
    v_mov_b32 v26, v98
    v_ashrrev_i32 v16, 31, v27
    v_or_b32 v16, 0x80000000, v16
    v_xor_b32 v24, v27, v16
    v_and_b32 v24, 0xfffff800, v24
    v_max_u32 v24, 0x800, v24
    s_sub_u32 s16, 2047, s14
    v_or_b32 v24, s16, v24
    s_lshl_b32 s16, s3, 4
    s_add_u32 s16, s16, 65536
    v_mov_b32 v16, s16
    ds_write_b128 v16, v[24:27]
    s_waitcnt lgkmcnt(0)
    s_barrier
    v_and_b32 v16, 7, v1
    v_lshlrev_b32 v16, 4, v16
    v_add_u32 v16, 65536, v16
    ds_read_b32 v76, v16
    s_waitcnt lgkmcnt(0)
    v_mov_b32 v77, v76
    s_nop 1
    v_max_u32_dpp v77, v77, v77 row_ror:1 row_mask:0xf bank_mask:0xf
    s_nop 1
    v_max_u32_dpp v77, v77, v77 row_ror:2 row_mask:0xf bank_mask:0xf
    s_nop 1
    v_max_u32_dpp v77, v77, v77 row_ror:4 row_mask:0xf bank_mask:0xf
    v_cmp_eq_u32 vcc, v76, v77
    s_ff1_i32_b64 s16, vcc
    s_lshl_b32 s16, s16, 4
    s_add_u32 s16, s16, 65536
    v_mov_b32 v16, s16
    ds_read_b128 v[24:27], v16
    s_lshl_b32 s16, s2, 4
    s_add_u32 s16, s16, 0x6e0000
    s_cmp_eq_u32 s3, 0
    s_cselect_b32 s16, s16, 0x7ffffff0
    v_mov_b32 v17, 0
    s_mov_b64 exec, 1
    s_waitcnt lgkmcnt(0)
    buffer_store_dwordx4 v[24:27], v17, s[8:11], s16 offen sc1
    s_mov_b64 exec, -1
    v_sub_f32 v44, v28, v96
    v_sub_f32 v45, v29, v96
    v_sub_f32 v46, v30, v96
    v_sub_f32 v47, v31, v96
    v_sub_f32 v48, v32, v96
    v_sub_f32 v49, v33, v96
    v_sub_f32 v50, v34, v96
    v_sub_f32 v51, v35, v96
    v_cvt_pk_bf16_f32 v16, v44, v45
    v_lshlrev_b32 v44, 16, v16
    v_and_b32 v45, 0xffff0000, v16
    v_cvt_pk_bf16_f32 v16, v46, v47
    v_lshlrev_b32 v46, 16, v16
    v_and_b32 v47, 0xffff0000, v16
    v_cvt_pk_bf16_f32 v16, v48, v49
    v_lshlrev_b32 v48, 16, v16
    v_and_b32 v49, 0xffff0000, v16
    v_cvt_pk_bf16_f32 v16, v50, v51
    v_lshlrev_b32 v50, 16, v16
    v_and_b32 v51, 0xffff0000, v16
    v_mul_f32 v52, v44, v99
    v_mul_f32 v53, v45, v99
    v_mul_f32 v54, v46, v99
    v_mul_f32 v55, v47, v99
    v_mul_f32 v56, v48, v99
    v_mul_f32 v57, v49, v99
    v_mul_f32 v58, v50, v99
    v_mul_f32 v59, v51, v99
    v_fma_f32 v44, -v52, v98, v44
    v_fma_f32 v45, -v53, v98, v45
    v_fma_f32 v46, -v54, v98, v46
    v_fma_f32 v47, -v55, v98, v47
    v_fma_f32 v48, -v56, v98, v48
    v_fma_f32 v49, -v57, v98, v49
    v_fma_f32 v50, -v58, v98, v50
    v_fma_f32 v51, -v59, v98, v51
    v_fma_f32 v44, v44, v99, v52
    v_fma_f32 v45, v45, v99, v53
    v_fma_f32 v46, v46, v99, v54
    v_fma_f32 v47, v47, v99, v55
    v_fma_f32 v48, v48, v99, v56
    v_fma_f32 v49, v49, v99, v57
    v_fma_f32 v50, v50, v99, v58
    v_fma_f32 v51, v51, v99, v59
    v_cvt_pk_bf16_f32 v16, v44, v45
    v_lshlrev_b32 v44, 16, v16
    v_and_b32 v45, 0xffff0000, v16
    v_cvt_pk_bf16_f32 v16, v46, v47
    v_lshlrev_b32 v46, 16, v16
    v_and_b32 v47, 0xffff0000, v16
    v_cvt_pk_bf16_f32 v16, v48, v49
    v_lshlrev_b32 v48, 16, v16
    v_and_b32 v49, 0xffff0000, v16
    v_cvt_pk_bf16_f32 v16, v50, v51
    v_lshlrev_b32 v50, 16, v16
    v_and_b32 v51, 0xffff0000, v16
    v_lshlrev_b32 v52, 16, v192
    v_and_b32 v53, 0xffff0000, v192
    v_lshlrev_b32 v54, 16, v193
    v_and_b32 v55, 0xffff0000, v193
    v_lshlrev_b32 v56, 16, v194
    v_and_b32 v57, 0xffff0000, v194
    v_lshlrev_b32 v58, 16, v195
    v_and_b32 v59, 0xffff0000, v195
    v_pk_mul_f32 v[44:45], v[44:45], v[52:53]
    v_pk_mul_f32 v[46:47], v[46:47], v[54:55]
    v_pk_mul_f32 v[48:49], v[48:49], v[56:57]
    v_pk_mul_f32 v[50:51], v[50:51], v[58:59]
    v_cvt_pk_bf16_f32 v16, v44, v45
    v_lshlrev_b32 v44, 16, v16
    v_and_b32 v45, 0xffff0000, v16
    v_cvt_pk_bf16_f32 v16, v46, v47
    v_lshlrev_b32 v46, 16, v16
    v_and_b32 v47, 0xffff0000, v16
    v_cvt_pk_bf16_f32 v16, v48, v49
    v_lshlrev_b32 v48, 16, v16
    v_and_b32 v49, 0xffff0000, v16
    v_cvt_pk_bf16_f32 v16, v50, v51
    v_lshlrev_b32 v50, 16, v16
    v_and_b32 v51, 0xffff0000, v16
    v_lshlrev_b32 v52, 16, v184
    v_and_b32 v53, 0xffff0000, v184
    v_lshlrev_b32 v54, 16, v185
    v_and_b32 v55, 0xffff0000, v185
    v_lshlrev_b32 v56, 16, v186
    v_and_b32 v57, 0xffff0000, v186
    v_lshlrev_b32 v58, 16, v187
    v_and_b32 v59, 0xffff0000, v187
    v_pk_add_f32 v[44:45], v[44:45], v[52:53]
    v_pk_add_f32 v[46:47], v[46:47], v[54:55]
    v_pk_add_f32 v[48:49], v[48:49], v[56:57]
    v_pk_add_f32 v[50:51], v[50:51], v[58:59]
    v_cvt_pk_bf16_f32 v16, v44, v45
    v_lshlrev_b32 v44, 16, v16
    v_and_b32 v45, 0xffff0000, v16
    v_cvt_pk_bf16_f32 v16, v46, v47
    v_lshlrev_b32 v46, 16, v16
    v_and_b32 v47, 0xffff0000, v16
    v_cvt_pk_bf16_f32 v16, v48, v49
    v_lshlrev_b32 v48, 16, v16
    v_and_b32 v49, 0xffff0000, v16
    v_cvt_pk_bf16_f32 v16, v50, v51
    v_lshlrev_b32 v50, 16, v16
    v_and_b32 v51, 0xffff0000, v16
    v_lshlrev_b32 v52, 16, v200
    v_and_b32 v53, 0xffff0000, v200
    v_lshlrev_b32 v54, 16, v201
    v_and_b32 v55, 0xffff0000, v201
    v_lshlrev_b32 v56, 16, v202
    v_and_b32 v57, 0xffff0000, v202
    v_lshlrev_b32 v58, 16, v203
    v_and_b32 v59, 0xffff0000, v203
    v_pk_mul_f32 v[44:45], v[44:45], v[52:53]
    v_pk_mul_f32 v[46:47], v[46:47], v[54:55]
    v_pk_mul_f32 v[48:49], v[48:49], v[56:57]
    v_pk_mul_f32 v[50:51], v[50:51], v[58:59]
    v_cvt_pk_bf16_f32 v16, v44, v45
    v_lshlrev_b32 v44, 16, v16
    v_and_b32 v45, 0xffff0000, v16
    v_cvt_pk_bf16_f32 v16, v46, v47
    v_lshlrev_b32 v46, 16, v16
    v_and_b32 v47, 0xffff0000, v16
    v_cvt_pk_bf16_f32 v16, v48, v49
    v_lshlrev_b32 v48, 16, v16
    v_and_b32 v49, 0xffff0000, v16
    v_cvt_pk_bf16_f32 v16, v50, v51
    v_lshlrev_b32 v50, 16, v16
    v_and_b32 v51, 0xffff0000, v16
    v_pk_add_f32 v[44:45], v[44:45], v[28:29]
    v_pk_add_f32 v[46:47], v[46:47], v[30:31]
    v_pk_add_f32 v[48:49], v[48:49], v[32:33]
    v_pk_add_f32 v[50:51], v[50:51], v[34:35]
    v_cvt_pk_bf16_f32 v28, v44, v45
    v_cvt_pk_bf16_f32 v29, v46, v47
    v_cvt_pk_bf16_f32 v30, v48, v49
    v_cvt_pk_bf16_f32 v31, v50, v51
    v_sub_f32 v44, v36, v96
    v_sub_f32 v45, v37, v96
    v_sub_f32 v46, v38, v96
    v_sub_f32 v47, v39, v96
    v_sub_f32 v48, v40, v96
    v_sub_f32 v49, v41, v96
    v_sub_f32 v50, v42, v96
    v_sub_f32 v51, v43, v96
    v_cvt_pk_bf16_f32 v16, v44, v45
    v_lshlrev_b32 v44, 16, v16
    v_and_b32 v45, 0xffff0000, v16
    v_cvt_pk_bf16_f32 v16, v46, v47
    v_lshlrev_b32 v46, 16, v16
    v_and_b32 v47, 0xffff0000, v16
    v_cvt_pk_bf16_f32 v16, v48, v49
    v_lshlrev_b32 v48, 16, v16
    v_and_b32 v49, 0xffff0000, v16
    v_cvt_pk_bf16_f32 v16, v50, v51
    v_lshlrev_b32 v50, 16, v16
    v_and_b32 v51, 0xffff0000, v16
    v_mul_f32 v52, v44, v99
    v_mul_f32 v53, v45, v99
    v_mul_f32 v54, v46, v99
    v_mul_f32 v55, v47, v99
    v_mul_f32 v56, v48, v99
    v_mul_f32 v57, v49, v99
    v_mul_f32 v58, v50, v99
    v_mul_f32 v59, v51, v99
    v_fma_f32 v44, -v52, v98, v44
    v_fma_f32 v45, -v53, v98, v45
    v_fma_f32 v46, -v54, v98, v46
    v_fma_f32 v47, -v55, v98, v47
    v_fma_f32 v48, -v56, v98, v48
    v_fma_f32 v49, -v57, v98, v49
    v_fma_f32 v50, -v58, v98, v50
    v_fma_f32 v51, -v59, v98, v51
    v_fma_f32 v44, v44, v99, v52
    v_fma_f32 v45, v45, v99, v53
    v_fma_f32 v46, v46, v99, v54
    v_fma_f32 v47, v47, v99, v55
    v_fma_f32 v48, v48, v99, v56
    v_fma_f32 v49, v49, v99, v57
    v_fma_f32 v50, v50, v99, v58
    v_fma_f32 v51, v51, v99, v59
    v_cvt_pk_bf16_f32 v16, v44, v45
    v_lshlrev_b32 v44, 16, v16
    v_and_b32 v45, 0xffff0000, v16
    v_cvt_pk_bf16_f32 v16, v46, v47
    v_lshlrev_b32 v46, 16, v16
    v_and_b32 v47, 0xffff0000, v16
    v_cvt_pk_bf16_f32 v16, v48, v49
    v_lshlrev_b32 v48, 16, v16
    v_and_b32 v49, 0xffff0000, v16
    v_cvt_pk_bf16_f32 v16, v50, v51
    v_lshlrev_b32 v50, 16, v16
    v_and_b32 v51, 0xffff0000, v16
    v_lshlrev_b32 v52, 16, v196
    v_and_b32 v53, 0xffff0000, v196
    v_lshlrev_b32 v54, 16, v197
    v_and_b32 v55, 0xffff0000, v197
    v_lshlrev_b32 v56, 16, v198
    v_and_b32 v57, 0xffff0000, v198
    v_lshlrev_b32 v58, 16, v199
    v_and_b32 v59, 0xffff0000, v199
    v_pk_mul_f32 v[44:45], v[44:45], v[52:53]
    v_pk_mul_f32 v[46:47], v[46:47], v[54:55]
    v_pk_mul_f32 v[48:49], v[48:49], v[56:57]
    v_pk_mul_f32 v[50:51], v[50:51], v[58:59]
    v_cvt_pk_bf16_f32 v16, v44, v45
    v_lshlrev_b32 v44, 16, v16
    v_and_b32 v45, 0xffff0000, v16
    v_cvt_pk_bf16_f32 v16, v46, v47
    v_lshlrev_b32 v46, 16, v16
    v_and_b32 v47, 0xffff0000, v16
    v_cvt_pk_bf16_f32 v16, v48, v49
    v_lshlrev_b32 v48, 16, v16
    v_and_b32 v49, 0xffff0000, v16
    v_cvt_pk_bf16_f32 v16, v50, v51
    v_lshlrev_b32 v50, 16, v16
    v_and_b32 v51, 0xffff0000, v16
    v_lshlrev_b32 v52, 16, v188
    v_and_b32 v53, 0xffff0000, v188
    v_lshlrev_b32 v54, 16, v189
    v_and_b32 v55, 0xffff0000, v189
    v_lshlrev_b32 v56, 16, v190
    v_and_b32 v57, 0xffff0000, v190
    v_lshlrev_b32 v58, 16, v191
    v_and_b32 v59, 0xffff0000, v191
    v_pk_add_f32 v[44:45], v[44:45], v[52:53]
    v_pk_add_f32 v[46:47], v[46:47], v[54:55]
    v_pk_add_f32 v[48:49], v[48:49], v[56:57]
    v_pk_add_f32 v[50:51], v[50:51], v[58:59]
    v_cvt_pk_bf16_f32 v16, v44, v45
    v_lshlrev_b32 v44, 16, v16
    v_and_b32 v45, 0xffff0000, v16
    v_cvt_pk_bf16_f32 v16, v46, v47
    v_lshlrev_b32 v46, 16, v16
    v_and_b32 v47, 0xffff0000, v16
    v_cvt_pk_bf16_f32 v16, v48, v49
    v_lshlrev_b32 v48, 16, v16
    v_and_b32 v49, 0xffff0000, v16
    v_cvt_pk_bf16_f32 v16, v50, v51
    v_lshlrev_b32 v50, 16, v16
    v_and_b32 v51, 0xffff0000, v16
    v_lshlrev_b32 v52, 16, v204
    v_and_b32 v53, 0xffff0000, v204
    v_lshlrev_b32 v54, 16, v205
    v_and_b32 v55, 0xffff0000, v205
    v_lshlrev_b32 v56, 16, v206
    v_and_b32 v57, 0xffff0000, v206
    v_lshlrev_b32 v58, 16, v207
    v_and_b32 v59, 0xffff0000, v207
    v_pk_mul_f32 v[44:45], v[44:45], v[52:53]
    v_pk_mul_f32 v[46:47], v[46:47], v[54:55]
    v_pk_mul_f32 v[48:49], v[48:49], v[56:57]
    v_pk_mul_f32 v[50:51], v[50:51], v[58:59]
    v_cvt_pk_bf16_f32 v16, v44, v45
    v_lshlrev_b32 v44, 16, v16
    v_and_b32 v45, 0xffff0000, v16
    v_cvt_pk_bf16_f32 v16, v46, v47
    v_lshlrev_b32 v46, 16, v16
    v_and_b32 v47, 0xffff0000, v16
    v_cvt_pk_bf16_f32 v16, v48, v49
    v_lshlrev_b32 v48, 16, v16
    v_and_b32 v49, 0xffff0000, v16
    v_cvt_pk_bf16_f32 v16, v50, v51
    v_lshlrev_b32 v50, 16, v16
    v_and_b32 v51, 0xffff0000, v16
    v_pk_add_f32 v[44:45], v[44:45], v[36:37]
    v_pk_add_f32 v[46:47], v[46:47], v[38:39]
    v_pk_add_f32 v[48:49], v[48:49], v[40:41]
    v_pk_add_f32 v[50:51], v[50:51], v[42:43]
    v_cvt_pk_bf16_f32 v36, v44, v45
    v_cvt_pk_bf16_f32 v37, v46, v47
    v_cvt_pk_bf16_f32 v38, v48, v49
    v_cvt_pk_bf16_f32 v39, v50, v51
    v_lshlrev_b32 v18, 4, v0
    s_mov_b32 s16, 0x6e0000
    s_mov_b32 s27, 0
adaLN_cond__sliding_block_cached__moe_arch_mod__prompt_kernel_w12p:
    buffer_load_dwordx4 v[24:27], v18, s[8:11], s16 offen sc1
    s_waitcnt vmcnt(0)
    v_cmp_eq_u32 vcc, 0, v24
    s_add_u32 s27, s27, 1
    s_cmp_ge_u32 s27, 262144
    s_cbranch_scc1 adaLN_cond__sliding_block_cached__moe_arch_mod__prompt_kernel_w12g
    s_cbranch_vccnz adaLN_cond__sliding_block_cached__moe_arch_mod__prompt_kernel_w12p
adaLN_cond__sliding_block_cached__moe_arch_mod__prompt_kernel_w12g:
    v_mov_b32 v76, v24
    s_nop 1
    v_max_u32_dpp v76, v76, v76 row_ror:1 row_mask:0xf bank_mask:0xf
    s_nop 1
    v_max_u32_dpp v76, v76, v76 row_ror:2 row_mask:0xf bank_mask:0xf
    s_nop 1
    v_max_u32_dpp v76, v76, v76 row_ror:4 row_mask:0xf bank_mask:0xf
    s_nop 1
    v_max_u32_dpp v76, v76, v76 row_ror:8 row_mask:0xf bank_mask:0xf
    v_mov_b32 v77, v76
    s_nop 1
    v_permlane16_swap_b32 v76, v77
    v_max_u32 v76, v76, v77
    v_mov_b32 v77, v76
    s_nop 1
    v_permlane32_swap_b32 v76, v77
    v_max_u32 v76, v76, v77
    v_cmp_eq_u32 vcc, v76, v24
    s_lshl_b32 s16, s3, 4
    s_add_u32 s16, s16, 65792
    v_mov_b32 v16, s16
    s_and_saveexec_b64 s[62:63], vcc
    ds_write_b128 v16, v[24:27]
    s_mov_b64 exec, s[62:63]
    s_waitcnt lgkmcnt(0)
    s_barrier
    v_and_b32 v16, 3, v1
    v_lshlrev_b32 v16, 4, v16
    v_add_u32 v16, 65792, v16
    ds_read_b32 v76, v16
    s_waitcnt lgkmcnt(0)
    v_mov_b32 v77, v76
    s_nop 1
    v_max_u32_dpp v77, v77, v77 row_ror:1 row_mask:0xf bank_mask:0xf
    s_nop 1
    v_max_u32_dpp v77, v77, v77 row_ror:2 row_mask:0xf bank_mask:0xf
    v_cmp_eq_u32 vcc, v76, v77
    s_ff1_i32_b64 s16, vcc
    s_lshl_b32 s16, s16, 4
    s_add_u32 s16, s16, 65792
    v_mov_b32 v16, s16
    ds_read_b128 v[24:27], v16
    s_waitcnt lgkmcnt(0)
    v_and_b32 v76, 0x7ff, v24
    v_sub_u32 v76, 2047, v76
    s_nop 0
    v_readfirstlane_b32 s12, v76
    v_rcp_f32 v103, v26
    s_lshr_b32 s18, s12, 4
    s_lshl_b32 s18, s18, 15
    s_and_b32 s19, s12, 15
    s_lshl_b32 s19, s19, 6
    s_add_u32 s18, s18, s19
    s_add_u32 s18, s18, 0x2c00000
    s_add_u32 s19, s18, 0x400000
    v_lshrrev_b32 v18, 4, v0
    v_lshlrev_b32 v18, 10, v18
    v_and_b32 v19, 15, v0
    v_lshl_add_u32 v18, v19, 2, v18
    s_lshl_b32 s13, s12, 11
    buffer_load_dword v100, v18, s[8:11], s18 offen sc1
    buffer_load_dword v101, v18, s[8:11], s19 offen sc1
    buffer_load_dword v102, v21, s[76:79], s13 offen
    s_lshl_b32 s16, s14, 11
    s_cmp_lg_u32 s12, s14
    s_cselect_b32 s16, s16, 0x7ffffff0
    buffer_store_dwordx4 v[28:31], v2, s[68:71], s16 offen offset:0 sc1
    buffer_store_dwordx4 v[36:39], v2, s[68:71], s16 offen offset:1024 sc1
    s_lshl_b32 s16, s3, 13
    v_add_u32 v20, s16, v2
    s_waitcnt vmcnt(4)
    v_lshlrev_b32 v76, 16, v100
    v_and_b32 v77, 0xffff0000, v100
    s_waitcnt vmcnt(3)
    v_lshlrev_b32 v78, 16, v101
    v_and_b32 v79, 0xffff0000, v101
    v_pk_add_f32 v[76:77], v[76:77], v[78:79]
    s_waitcnt vmcnt(2)
    v_lshlrev_b32 v78, 16, v102
    v_and_b32 v79, 0xffff0000, v102
    v_pk_add_f32 v[92:93], v[78:79], v[76:77]
    v_cvt_pk_bf16_f32 v76, v92, v93
    v_lshlrev_b32 v92, 16, v76
    v_and_b32 v93, 0xffff0000, v76
    v_cvt_pk_bf16_f32 v100, v92, v93
    v_and_b32 v105, 0xffff0000, v104
    v_lshlrev_b32 v104, 16, v104
    v_and_b32 v107, 0xffff0000, v106
    v_lshlrev_b32 v106, 16, v106
    v_sub_f32 v92, v92, v25
    v_sub_f32 v93, v93, v25
    v_cvt_pk_bf16_f32 v76, v92, v93
    v_lshlrev_b32 v92, 16, v76
    v_and_b32 v93, 0xffff0000, v76
    v_mul_f32 v77, v92, v103
    v_fma_f32 v92, -v77, v26, v92
    v_fma_f32 v92, v92, v103, v77
    v_mul_f32 v77, v93, v103
    v_fma_f32 v93, -v77, v26, v93
    v_fma_f32 v93, v93, v103, v77
    v_cvt_pk_bf16_f32 v76, v92, v93
    v_lshlrev_b32 v92, 16, v76
    v_and_b32 v93, 0xffff0000, v76
    v_mul_f32 v92, v92, v104
    v_mul_f32 v93, v93, v105
    v_cvt_pk_bf16_f32 v76, v92, v93
    v_lshlrev_b32 v92, 16, v76
    v_and_b32 v93, 0xffff0000, v76
    v_add_f32 v92, v92, v106
    v_add_f32 v93, v93, v107
    v_cvt_pk_bf16_f32 v101, v92, v93
    v_add_u32 v16, 66560, v21
    ds_write_b32 v16, v101
    ds_write_b32 v16, v100 offset:2048
    s_waitcnt lgkmcnt(0)
    s_barrier
    ds_read_b128 v[60:63], v20 offset:0
    ds_read_b128 v[64:67], v20 offset:1024
    ds_read_b128 v[68:71], v20 offset:2048
    ds_read_b128 v[72:75], v20 offset:3072
    ds_read_b128 v[108:111], v20 offset:4096
    ds_read_b128 v[112:115], v20 offset:5120
    ds_read_b128 v[116:119], v20 offset:6144
    ds_read_b128 v[120:123], v20 offset:7168
    s_and_b32 s16, s3, 3
    s_lshl_b32 s16, s16, 7
    s_and_b32 s17, s29, 3
    s_lshl_b32 s17, s17, 9
    s_add_u32 s16, s16, s17
    s_add_u32 s16, s16, 66560
    v_lshrrev_b32 v16, 3, v1
    v_lshlrev_b32 v16, 4, v16
    v_add_u32 v16, s16, v16
    ds_read_b128 v[104:107], v16
    s_waitcnt lgkmcnt(0)
    v_lshlrev_b32 v76, 16, v104
    v_and_b32 v77, 0xffff, v104
    v_dot2_f32_bf16 v85, v60, v76, 0
    v_dot2_f32_bf16 v84, v60, v77, 0
    v_dot2_f32_bf16 v87, v61, v76, 0
    v_dot2_f32_bf16 v86, v61, v77, 0
    v_dot2_f32_bf16 v89, v62, v76, 0
    v_dot2_f32_bf16 v88, v62, v77, 0
    v_dot2_f32_bf16 v91, v63, v76, 0
    v_dot2_f32_bf16 v90, v63, v77, 0
    v_and_b32 v78, 0xffff0000, v104
    v_lshrrev_b32 v79, 16, v104
    v_dot2c_f32_bf16 v85, v64, v78
    v_dot2c_f32_bf16 v84, v64, v79
    v_dot2c_f32_bf16 v87, v65, v78
    v_dot2c_f32_bf16 v86, v65, v79
    v_dot2c_f32_bf16 v89, v66, v78
    v_dot2c_f32_bf16 v88, v66, v79
    v_dot2c_f32_bf16 v91, v67, v78
    v_dot2c_f32_bf16 v90, v67, v79
    v_lshlrev_b32 v80, 16, v105
    v_and_b32 v81, 0xffff, v105
    v_dot2c_f32_bf16 v85, v68, v80
    v_dot2c_f32_bf16 v84, v68, v81
    v_dot2c_f32_bf16 v87, v69, v80
    v_dot2c_f32_bf16 v86, v69, v81
    v_dot2c_f32_bf16 v89, v70, v80
    v_dot2c_f32_bf16 v88, v70, v81
    v_dot2c_f32_bf16 v91, v71, v80
    v_dot2c_f32_bf16 v90, v71, v81
    v_and_b32 v82, 0xffff0000, v105
    v_lshrrev_b32 v83, 16, v105
    v_dot2c_f32_bf16 v85, v72, v82
    v_dot2c_f32_bf16 v84, v72, v83
    v_dot2c_f32_bf16 v87, v73, v82
    v_dot2c_f32_bf16 v86, v73, v83
    v_dot2c_f32_bf16 v89, v74, v82
    v_dot2c_f32_bf16 v88, v74, v83
    v_dot2c_f32_bf16 v91, v75, v82
    v_dot2c_f32_bf16 v90, v75, v83
    v_lshlrev_b32 v76, 16, v106
    v_and_b32 v77, 0xffff, v106
    v_dot2c_f32_bf16 v85, v108, v76
    v_dot2c_f32_bf16 v84, v108, v77
    v_dot2c_f32_bf16 v87, v109, v76
    v_dot2c_f32_bf16 v86, v109, v77
    v_dot2c_f32_bf16 v89, v110, v76
    v_dot2c_f32_bf16 v88, v110, v77
    v_dot2c_f32_bf16 v91, v111, v76
    v_dot2c_f32_bf16 v90, v111, v77
    v_and_b32 v78, 0xffff0000, v106
    v_lshrrev_b32 v79, 16, v106
    v_dot2c_f32_bf16 v85, v112, v78
    v_dot2c_f32_bf16 v84, v112, v79
    v_dot2c_f32_bf16 v87, v113, v78
    v_dot2c_f32_bf16 v86, v113, v79
    v_dot2c_f32_bf16 v89, v114, v78
    v_dot2c_f32_bf16 v88, v114, v79
    v_dot2c_f32_bf16 v91, v115, v78
    v_dot2c_f32_bf16 v90, v115, v79
    v_lshlrev_b32 v80, 16, v107
    v_and_b32 v81, 0xffff, v107
    v_dot2c_f32_bf16 v85, v116, v80
    v_dot2c_f32_bf16 v84, v116, v81
    v_dot2c_f32_bf16 v87, v117, v80
    v_dot2c_f32_bf16 v86, v117, v81
    v_dot2c_f32_bf16 v89, v118, v80
    v_dot2c_f32_bf16 v88, v118, v81
    v_dot2c_f32_bf16 v91, v119, v80
    v_dot2c_f32_bf16 v90, v119, v81
    v_and_b32 v82, 0xffff0000, v107
    v_lshrrev_b32 v83, 16, v107
    v_dot2c_f32_bf16 v85, v120, v82
    v_dot2c_f32_bf16 v84, v120, v83
    v_dot2c_f32_bf16 v87, v121, v82
    v_dot2c_f32_bf16 v86, v121, v83
    v_dot2c_f32_bf16 v89, v122, v82
    v_dot2c_f32_bf16 v88, v122, v83
    v_dot2c_f32_bf16 v91, v123, v82
    v_dot2c_f32_bf16 v90, v123, v83
    s_nop 0
    v_permlane32_swap_b32 v84, v88
    v_permlane32_swap_b32 v85, v89
    v_permlane32_swap_b32 v86, v90
    v_permlane32_swap_b32 v87, v91
    v_add_f32 v84, v84, v88
    v_add_f32 v85, v85, v89
    v_add_f32 v86, v86, v90
    v_add_f32 v87, v87, v91
    s_nop 0
    v_permlane16_swap_b32 v84, v86
    v_permlane16_swap_b32 v85, v87
    v_add_f32 v84, v84, v86
    v_add_f32 v85, v85, v87
    s_nop 0
    v_add_f32_dpp v84, v84, v84 row_ror:8 row_mask:0xf bank_mask:0xf
    v_add_f32_dpp v85, v85, v85 row_ror:8 row_mask:0xf bank_mask:0xf
    v_and_b32 v16, 7, v1
    v_lshlrev_b32 v16, 5, v16
    v_lshrrev_b32 v17, 4, v1
    v_lshl_add_u32 v16, v17, 3, v16
    s_lshl_b32 s16, s3, 8
    s_add_u32 s16, s16, 70656
    v_add_u32 v16, s16, v16
    ds_write_b64 v16, v[84:85]
    s_lshr_b32 s16, s3, 2
    s_lshl_b32 s17, s16, 10
    s_add_u32 s17, s17, 70656
    v_lshlrev_b32 v17, 2, v1
    v_add_u32 v16, s17, v17
    s_and_b32 s17, s29, 3
    s_lshl_b32 s17, s17, 1
    s_add_u32 s17, s17, s16
    s_mul_i32 s17, s17, 14336
    s_lshr_b32 s16, s29, 2
    s_lshl_b32 s16, s16, 8
    s_add_u32 s17, s17, s16
    s_add_u32 s17, s17, 0x6e1000
    s_and_b32 s16, s3, 3
    s_cmp_eq_u32 s16, 0
    s_cselect_b32 s17, s17, 0x7ffffff0
    s_cmp_lt_u32 s2, 224
    s_cselect_b32 s17, s17, 0x7ffffff0
    s_waitcnt lgkmcnt(0)
    s_barrier
    ds_read_b32 v84, v16 offset:0
    ds_read_b32 v85, v16 offset:256
    ds_read_b32 v86, v16 offset:512
    ds_read_b32 v87, v16 offset:768
    s_waitcnt lgkmcnt(2)
    v_add_f32 v84, v84, v85
    s_waitcnt lgkmcnt(0)
    v_add_f32 v86, v86, v87
    v_add_f32 v84, v84, v86
    v_or_b32 v84, 1, v84
    buffer_store_dword v84, v17, s[8:11], s17 offen sc1
    s_barrier
    v_lshlrev_b32 v16, 3, v0
    v_add_u32 v17, 73728, v16
    ds_read_b64 v[84:85], v17 offset:0
    ds_read_b64 v[86:87], v17 offset:4096
    ds_read_b64 v[88:89], v17 offset:8192
    ds_read_b64 v[90:91], v17 offset:12288
    s_waitcnt lgkmcnt(2)
    v_pk_add_f32 v[84:85], v[84:85], v[86:87]
    s_waitcnt lgkmcnt(0)
    v_pk_add_f32 v[88:89], v[88:89], v[90:91]
    v_pk_add_f32 v[84:85], v[84:85], v[88:89]
    v_or_b32 v84, 1, v84
    v_or_b32 v85, 1, v85
    s_lshl_b32 s16, s29, 12
    s_add_u32 s16, s16, 0x600000
    s_cmp_lt_u32 s2, 224
    s_cselect_b32 s16, s16, 0x7ffffff0
    buffer_store_dwordx2 v[84:85], v16, s[8:11], s16 offen sc1
    s_cmp_lt_u32 s2, 224
    s_cbranch_scc1 adaLN_cond__sliding_block_cached__moe_arch_mod__prompt_kernel_end
    s_sub_u32 s16, s2, 224
    s_lshl_b32 s17, s16, 7
    s_add_u32 s17, s17, 0x600000
    v_lshrrev_b32 v16, 3, v0
    v_lshlrev_b32 v16, 12, v16
    v_and_b32 v17, 7, v0
    v_lshl_add_u32 v16, v17, 4, v16
    v_cmp_gt_u32 vcc, 256, v0
    v_bfrev_b32 v17, -2
    s_nop 0
    v_cndmask_b32 v17, v17, v16, vcc
    v_mov_b32 v19, 0
    v_cndmask_b32 v18, 1, v19, vcc
    s_lshl_b32 s18, s16, 6
    v_and_b32 v19, 31, v1
    v_lshlrev_b32 v19, 1, v19
    v_add_u32 v19, s18, v19
    s_mov_b32 s19, 0x541800
    buffer_load_ushort v95, v19, s[8:11], s19 offen sc1
    v_add_u32 v20, 66560, v19
    ds_read_u16 v96, v20
    ds_read_u16 v97, v20 offset:2048
    v_mov_b32 v94, v27
    v_cvt_pk_bf16_f32 v94, v94, v94
    v_lshlrev_b32 v94, 16, v94
    v_mul_f32 v94, 0xbfb8aa3b, v94
    v_exp_f32 v94, v94
    s_nop 0
    v_add_f32 v94, 1.0, v94
    v_rcp_f32 v94, v94
    s_nop 0
    v_cvt_pk_bf16_f32 v94, v94, v94
    v_lshlrev_b32 v94, 16, v94
    s_waitcnt vmcnt(0)
    v_lshlrev_b32 v95, 16, v95
    s_waitcnt lgkmcnt(1)
    v_lshlrev_b32 v96, 16, v96
    s_waitcnt lgkmcnt(0)
    v_lshlrev_b32 v97, 16, v97
    s_mov_b32 s27, 0
adaLN_cond__sliding_block_cached__moe_arch_mod__prompt_kernel_y13p:
    s_add_u32 s19, s17, 0x0
    buffer_load_dwordx4 v[44:47], v16, s[8:11], s19 offen sc1
    s_add_u32 s19, s17, 0x40000
    buffer_load_dwordx4 v[48:51], v16, s[8:11], s19 offen sc1
    s_add_u32 s19, s17, 0x80000
    buffer_load_dwordx4 v[52:55], v16, s[8:11], s19 offen sc1
    s_add_u32 s19, s17, 0xc0000
    buffer_load_dwordx4 v[56:59], v17, s[8:11], s19 offen sc1
    s_waitcnt vmcnt(0)
    v_min3_u32 v98, v56, v57, v58
    v_min_u32 v98, v98, v59
    v_or_b32 v98, v98, v18
    v_min3_u32 v98, v98, v44, v45
    v_min3_u32 v98, v98, v46, v47
    v_min3_u32 v98, v98, v48, v49
    v_min3_u32 v98, v98, v50, v51
    v_min3_u32 v98, v98, v52, v53
    v_min3_u32 v98, v98, v54, v55
    v_cmp_eq_u32 vcc, 0, v98
    s_add_u32 s27, s27, 1
    s_cmp_ge_u32 s27, 262144
    s_cbranch_scc1 adaLN_cond__sliding_block_cached__moe_arch_mod__prompt_kernel_y13g
    s_cbranch_vccnz adaLN_cond__sliding_block_cached__moe_arch_mod__prompt_kernel_y13p
adaLN_cond__sliding_block_cached__moe_arch_mod__prompt_kernel_y13g:
    v_pk_add_f32 v[44:45], v[44:45], v[52:53]
    v_pk_add_f32 v[46:47], v[46:47], v[54:55]
    v_pk_add_f32 v[48:49], v[48:49], v[56:57]
    v_pk_add_f32 v[50:51], v[50:51], v[58:59]
    v_pk_add_f32 v[44:45], v[44:45], v[48:49]
    v_pk_add_f32 v[46:47], v[46:47], v[50:51]
    s_nop 0
    v_add_f32_dpp v44, v44, v44 row_ror:8 row_mask:0xf bank_mask:0xf
    v_add_f32_dpp v45, v45, v45 row_ror:8 row_mask:0xf bank_mask:0xf
    v_add_f32_dpp v46, v46, v46 row_ror:8 row_mask:0xf bank_mask:0xf
    v_add_f32_dpp v47, v47, v47 row_ror:8 row_mask:0xf bank_mask:0xf
    s_nop 0
    v_permlane32_swap_b32 v44, v46
    v_permlane32_swap_b32 v45, v47
    v_add_f32 v44, v44, v46
    v_add_f32 v45, v45, v47
    s_nop 1
    v_permlane16_swap_b32 v44, v45
    v_add_f32 v44, v44, v45
    v_and_b32 v16, 7, v1
    v_lshlrev_b32 v16, 4, v16
    v_lshrrev_b32 v17, 4, v1
    v_lshl_add_u32 v16, v17, 2, v16
    s_lshl_b32 s19, s3, 7
    s_add_u32 s19, s19, 91136
    v_add_u32 v16, s19, v16
    ds_write_b32 v16, v44
    v_and_b32 v16, 31, v1
    v_lshlrev_b32 v16, 2, v16
    v_add_u32 v16, 91136, v16
    s_waitcnt lgkmcnt(0)
    s_barrier
    s_cmp_lg_u32 s3, 0
    s_cbranch_scc1 adaLN_cond__sliding_block_cached__moe_arch_mod__prompt_kernel_end
    ds_read_b32 v44, v16 offset:0
    ds_read_b32 v45, v16 offset:128
    ds_read_b32 v46, v16 offset:256
    ds_read_b32 v47, v16 offset:384
    ds_read_b32 v48, v16 offset:512
    ds_read_b32 v49, v16 offset:640
    ds_read_b32 v50, v16 offset:768
    ds_read_b32 v51, v16 offset:896
    s_waitcnt lgkmcnt(3)
    v_add_f32 v44, v44, v48
    s_waitcnt lgkmcnt(2)
    v_add_f32 v45, v45, v49
    s_waitcnt lgkmcnt(1)
    v_add_f32 v46, v46, v50
    s_waitcnt lgkmcnt(0)
    v_add_f32 v47, v47, v51
    v_add_f32 v44, v44, v46
    v_add_f32 v45, v45, v47
    v_add_f32 v44, v44, v45
    v_cvt_pk_bf16_f32 v44, v44, v44
    v_lshlrev_b32 v44, 16, v44
    v_mul_f32 v44, v44, v94
    v_cvt_pk_bf16_f32 v44, v44, v44
    v_lshlrev_b32 v44, 16, v44
    v_add_f32 v44, v44, v96
    v_cvt_pk_bf16_f32 v44, v44, v44
    v_lshlrev_b32 v44, 16, v44
    v_mul_f32 v44, v44, v95
    v_cvt_pk_bf16_f32 v44, v44, v44
    v_lshlrev_b32 v44, 16, v44
    v_add_f32 v44, v44, v97
    v_cvt_pk_bf16_f32 v44, v44, v44
    s_mov_b64 exec, 0xffffffff
    buffer_store_short v44, v19, s[68:71], s13 offen sc1
    s_branch adaLN_cond__sliding_block_cached__moe_arch_mod__prompt_kernel_end
adaLN_cond__sliding_block_cached__moe_arch_mod__prompt_kernel_roleB:
    v_mov_b32 v132, 0
    v_mov_b32 v133, 0
    v_lshrrev_b32 v16, 3, v0
    v_and_b32 v17, 7, v0
    v_mul_u32_u24 v135, 24576, v16
    v_lshl_add_u32 v135, v17, 4, v135
    v_lshlrev_b32 v136, 2, v16
    s_and_b32 s14, s2, 31
    s_lshr_b32 s15, s2, 5
    s_mul_i32 s26, s15, 1572864
    s_lshl_b32 s16, s14, 7
    s_add_u32 s26, s26, s16
    s_lshl_b32 s29, s15, 8
    v_lshlrev_b32 v137, 3, v0
    s_lshl_b32 s18, s2, 3
    s_add_u32 s18, s18, s3
    s_lshl_b32 s18, s18, 11
    v_and_b32 v18, 15, v1
    v_lshrrev_b32 v19, 4, v1
    v_lshlrev_b32 v138, 11, v18
    v_lshl_add_u32 v138, v19, 4, v138
    s_lshr_b32 s30, s2, 4
    s_and_b32 s31, s2, 15
    s_lshl_b32 s19, s30, 3
    s_add_u32 s19, s19, s3
    s_lshl_b32 s22, s19, 15
    s_lshl_b32 s23, s31, 7
    s_add_u32 s22, s22, s23
    s_lshl_b32 s23, s2, 12
    s_add_u32 s23, s23, 0x600000
    s_or_b32 s25, s2, s3
    s_cmp_eq_u32 s25, 0
    s_cselect_b32 s25, 0, 0x7ffffff0
    s_waitcnt lgkmcnt(0)
    s_mov_b64 s[64:65], s[58:59]
    s_mov_b32 s66, 0x100
    s_mov_b32 s67, 0x20000
    s_or_b32 s28, s62, 1
    v_mov_b32 v134, s28
    s_mov_b64 exec, 1
    buffer_store_dword v134, v132, s[64:67], s25 offen sc1
    s_mov_b64 exec, -1
    s_mov_b64 s[68:69], s[52:53]
    s_mov_b32 s70, 0x800
    s_mov_b32 s71, 0x20000
    s_mov_b64 s[72:73], s[54:55]
    s_mov_b32 s74, 0xc00000
    s_mov_b32 s75, 0x20000
    s_mov_b64 s[76:77], s[32:33]
    s_mov_b32 s78, 0x400000
    s_mov_b32 s79, 0x20000
    s_mov_b64 s[8:9], s[60:61]
    s_mov_b32 s10, 0x3400000
    s_mov_b32 s11, 0x20000
    buffer_load_dword v72, v136, s[68:71], s29 offen
    buffer_load_dwordx4 v[24:27], v135, s[72:75], s26 offen
    s_add_u32 s26, s26, 12288
    buffer_load_dwordx4 v[28:31], v135, s[72:75], s26 offen
    buffer_load_dwordx4 v[32:35], v2, s[76:79], s18 offen offset:0
    buffer_load_dwordx4 v[36:39], v2, s[76:79], s18 offen offset:1024
    buffer_store_dwordx2 v[132:133], v137, s[8:11], s23 offen sc1
    s_barrier
    buffer_load_dwordx4 v[40:43], v138, s[76:79], s22 offen offset:0
    buffer_load_dwordx4 v[44:47], v138, s[76:79], s22 offen offset:64
    s_mov_b32 s29, s19
    s_mov_b64 s[64:65], s[34:35]
    s_mov_b32 s66, 0x200000
    s_mov_b32 s67, 0x20000
    s_mov_b64 s[68:69], s[36:37]
    s_mov_b32 s70, 0x200000
    s_mov_b32 s71, 0x20000
    s_lshl_b32 s20, s2, 2
    s_add_u32 s20, s20, s3
    s_sub_u32 s20, s20, 4
    s_lshr_b32 s22, s20, 8
    s_bfe_u32 s23, s20, 0x40004
    s_and_b32 s24, s20, 15
    s_lshl_b32 s25, s22, 19
    s_lshl_b32 s26, s23, 13
    s_add_u32 s25, s25, s26
    s_add_u32 s25, s25, 393216
    v_and_b32 v16, 15, v1
    v_lshrrev_b32 v17, 4, v1
    s_lshl_b32 s21, s22, 17
    s_cmp_ge_u32 s24, 8
    s_cbranch_scc1 adaLN_cond__sliding_block_cached__moe_arch_mod__prompt_kernel_kvV
    v_lshlrev_b32 v18, 8, v16
    v_lshl_add_u32 v18, v17, 3, v18
    s_and_b32 s26, s24, 1
    s_lshl_b32 s26, s26, 12
    s_add_u32 s25, s25, s26
    s_lshr_b32 s26, s24, 1
    s_lshl_b32 s26, s26, 6
    s_add_u32 s25, s25, s26
    buffer_load_dwordx2 v[84:85], v18, s[64:67], s25 offen
    buffer_load_dwordx2 v[86:87], v18, s[64:67], s25 offen offset:32
    s_lshl_b32 s26, s23, 13
    s_add_u32 s21, s21, s26
    s_lshl_b32 s26, s24, 10
    s_add_u32 s21, s21, s26
    s_add_u32 s21, s21, 0x400000
    s_branch adaLN_cond__sliding_block_cached__moe_arch_mod__prompt_kernel_kvJ
adaLN_cond__sliding_block_cached__moe_arch_mod__prompt_kernel_kvV:
    s_bfe_u32 s26, s24, 0x20001
    s_lshl_b32 s26, s26, 6
    s_add_u32 s25, s25, s26
    s_and_b32 s26, s24, 1
    s_lshl_b32 s26, s26, 3
    s_add_u32 s25, s25, s26
    s_add_u32 s26, s25, 4096
    v_lshrrev_b32 v18, 2, v16
    v_lshlrev_b32 v18, 4, v18
    v_and_b32 v19, 3, v16
    v_lshl_add_u32 v18, v19, 1, v18
    v_lshl_add_u32 v18, v17, 10, v18
    buffer_load_ushort v88, v18, s[68:71], s25 offen offset:0
    buffer_load_ushort v89, v18, s[68:71], s25 offen offset:256
    buffer_load_ushort v90, v18, s[68:71], s25 offen offset:512
    buffer_load_ushort v91, v18, s[68:71], s25 offen offset:768
    buffer_load_ushort v92, v18, s[68:71], s26 offen offset:0
    buffer_load_ushort v93, v18, s[68:71], s26 offen offset:256
    buffer_load_ushort v94, v18, s[68:71], s26 offen offset:512
    buffer_load_ushort v95, v18, s[68:71], s26 offen offset:768
    s_bfe_u32 s26, s24, 0x20001
    s_lshl_b32 s26, s26, 15
    s_add_u32 s21, s21, s26
    s_lshl_b32 s26, s23, 11
    s_add_u32 s21, s21, s26
    s_and_b32 s26, s24, 1
    s_lshl_b32 s26, s26, 10
    s_add_u32 s21, s21, s26
    s_add_u32 s21, s21, 0x480000
adaLN_cond__sliding_block_cached__moe_arch_mod__prompt_kernel_kvJ:
    s_waitcnt vmcnt(9)
    v_and_b32 v73, 0xffff0000, v72
    v_lshlrev_b32 v72, 16, v72
    v_mul_f32 v16, 0xbfb8aa3b, v72
    v_exp_f32 v16, v16
    s_nop 0
    v_add_f32 v16, 1.0, v16
    v_rcp_f32 v16, v16
    s_nop 0
    v_mul_f32 v72, v72, v16
    v_mul_f32 v17, 0xbfb8aa3b, v73
    v_exp_f32 v17, v17
    s_nop 0
    v_add_f32 v17, 1.0, v17
    v_rcp_f32 v17, v17
    s_nop 0
    v_mul_f32 v73, v73, v17
    v_cvt_pk_bf16_f32 v16, v72, v73
    v_lshlrev_b32 v72, 16, v16
    v_and_b32 v73, 0xffff0000, v16
    v_lshrrev_b32 v74, 16, v72
    v_lshrrev_b32 v75, 16, v73
    s_waitcnt vmcnt(8)
    v_dot2_f32_bf16 v49, v24, v72, 0
    v_dot2_f32_bf16 v48, v24, v74, 0
    v_dot2_f32_bf16 v51, v25, v72, 0
    v_dot2_f32_bf16 v50, v25, v74, 0
    v_dot2_f32_bf16 v53, v26, v72, 0
    v_dot2_f32_bf16 v52, v26, v74, 0
    v_dot2_f32_bf16 v55, v27, v72, 0
    v_dot2_f32_bf16 v54, v27, v74, 0
    s_waitcnt vmcnt(7)
    v_dot2c_f32_bf16 v49, v28, v73
    v_dot2c_f32_bf16 v48, v28, v75
    v_dot2c_f32_bf16 v51, v29, v73
    v_dot2c_f32_bf16 v50, v29, v75
    v_dot2c_f32_bf16 v53, v30, v73
    v_dot2c_f32_bf16 v52, v30, v75
    v_dot2c_f32_bf16 v55, v31, v73
    v_dot2c_f32_bf16 v54, v31, v75
    s_nop 0
    v_permlane32_swap_b32 v48, v52
    v_permlane32_swap_b32 v49, v53
    v_permlane32_swap_b32 v50, v54
    v_permlane32_swap_b32 v51, v55
    v_add_f32 v48, v48, v52
    v_add_f32 v49, v49, v53
    v_add_f32 v50, v50, v54
    v_add_f32 v51, v51, v55
    s_nop 0
    v_permlane16_swap_b32 v48, v50
    v_permlane16_swap_b32 v49, v51
    v_add_f32 v48, v48, v50
    v_add_f32 v49, v49, v51
    s_nop 0
    v_add_f32_dpp v48, v48, v48 row_ror:8 row_mask:0xf bank_mask:0xf
    v_add_f32_dpp v49, v49, v49 row_ror:8 row_mask:0xf bank_mask:0xf
    v_and_b32 v16, 7, v1
    v_lshlrev_b32 v16, 5, v16
    v_lshrrev_b32 v17, 4, v1
    v_lshl_add_u32 v16, v17, 3, v16
    s_lshl_b32 s16, s3, 8
    s_add_u32 s16, s16, 65536
    v_add_u32 v16, s16, v16
    ds_write_b64 v16, v[48:49]
    s_waitcnt vmcnt(6)
    v_lshlrev_b32 v56, 16, v32
    v_and_b32 v57, 0xffff0000, v32
    v_lshlrev_b32 v58, 16, v33
    v_and_b32 v59, 0xffff0000, v33
    v_lshlrev_b32 v60, 16, v34
    v_and_b32 v61, 0xffff0000, v34
    v_lshlrev_b32 v62, 16, v35
    v_and_b32 v63, 0xffff0000, v35
    s_waitcnt vmcnt(5)
    v_lshlrev_b32 v64, 16, v36
    v_and_b32 v65, 0xffff0000, v36
    v_lshlrev_b32 v66, 16, v37
    v_and_b32 v67, 0xffff0000, v37
    v_lshlrev_b32 v68, 16, v38
    v_and_b32 v69, 0xffff0000, v38
    v_lshlrev_b32 v70, 16, v39
    v_and_b32 v71, 0xffff0000, v39
    v_add_f32 v20, v56, v57
    v_add_f32 v21, v58, v59
    v_add_f32 v20, v20, v60
    v_add_f32 v21, v21, v61
    v_add_f32 v20, v20, v62
    v_add_f32 v21, v21, v63
    v_add_f32 v20, v20, v64
    v_add_f32 v21, v21, v65
    v_add_f32 v20, v20, v66
    v_add_f32 v21, v21, v67
    v_add_f32 v20, v20, v68
    v_add_f32 v21, v21, v69
    v_add_f32 v20, v20, v70
    v_add_f32 v21, v21, v71
    v_add_f32 v128, v20, v21
    s_nop 1
    v_add_f32_dpp v128, v128, v128 row_ror:1 row_mask:0xf bank_mask:0xf
    s_nop 1
    v_add_f32_dpp v128, v128, v128 row_ror:2 row_mask:0xf bank_mask:0xf
    s_nop 1
    v_add_f32_dpp v128, v128, v128 row_ror:4 row_mask:0xf bank_mask:0xf
    s_nop 1
    v_add_f32_dpp v128, v128, v128 row_ror:8 row_mask:0xf bank_mask:0xf
    v_mov_b32 v20, v128
    s_nop 1
    v_permlane16_swap_b32 v128, v20
    v_add_f32 v128, v128, v20
    v_mov_b32 v20, v128
    s_nop 1
    v_permlane32_swap_b32 v128, v20
    v_add_f32 v128, v128, v20
    v_mul_f32 v128, 0x3a800000, v128
    v_sub_f32 v18, v56, v128
    v_mul_f32 v20, v18, v18
    v_sub_f32 v19, v57, v128
    v_mul_f32 v21, v19, v19
    v_sub_f32 v18, v58, v128
    v_sub_f32 v19, v59, v128
    v_fmac_f32 v20, v18, v18
    v_fmac_f32 v21, v19, v19
    v_sub_f32 v18, v60, v128
    v_sub_f32 v19, v61, v128
    v_fmac_f32 v20, v18, v18
    v_fmac_f32 v21, v19, v19
    v_sub_f32 v18, v62, v128
    v_sub_f32 v19, v63, v128
    v_fmac_f32 v20, v18, v18
    v_fmac_f32 v21, v19, v19
    v_sub_f32 v18, v64, v128
    v_sub_f32 v19, v65, v128
    v_fmac_f32 v20, v18, v18
    v_fmac_f32 v21, v19, v19
    v_sub_f32 v18, v66, v128
    v_sub_f32 v19, v67, v128
    v_fmac_f32 v20, v18, v18
    v_fmac_f32 v21, v19, v19
    v_sub_f32 v18, v68, v128
    v_sub_f32 v19, v69, v128
    v_fmac_f32 v20, v18, v18
    v_fmac_f32 v21, v19, v19
    v_sub_f32 v18, v70, v128
    v_sub_f32 v19, v71, v128
    v_fmac_f32 v20, v18, v18
    v_fmac_f32 v21, v19, v19
    v_add_f32 v17, v20, v21
    s_nop 1
    v_add_f32_dpp v17, v17, v17 row_ror:1 row_mask:0xf bank_mask:0xf
    s_nop 1
    v_add_f32_dpp v17, v17, v17 row_ror:2 row_mask:0xf bank_mask:0xf
    s_nop 1
    v_add_f32_dpp v17, v17, v17 row_ror:4 row_mask:0xf bank_mask:0xf
    s_nop 1
    v_add_f32_dpp v17, v17, v17 row_ror:8 row_mask:0xf bank_mask:0xf
    v_mov_b32 v20, v17
    s_nop 1
    v_permlane16_swap_b32 v17, v20
    v_add_f32 v17, v17, v20
    v_mov_b32 v20, v17
    s_nop 1
    v_permlane32_swap_b32 v17, v20
    v_add_f32 v17, v17, v20
    v_mul_f32 v17, 0x3a800000, v17
    v_cvt_pk_bf16_f32 v128, v128, v128
    v_lshlrev_b32 v128, 16, v128
    v_cvt_pk_bf16_f32 v17, v17, v17
    v_lshlrev_b32 v17, 16, v17
    v_add_f32 v17, 0x3727c5ac, v17
    v_cvt_pk_bf16_f32 v17, v17, v17
    v_lshlrev_b32 v17, 16, v17
    v_sqrt_f32 v129, v17
    s_nop 0
    v_cvt_pk_bf16_f32 v129, v129, v129
    v_lshlrev_b32 v129, 16, v129
    v_rcp_f32 v130, v129
    s_lshl_b32 s16, s3, 4
    s_add_u32 s16, s16, 67600
    v_mov_b32 v19, s16
    ds_write_b128 v19, v[128:131]
    v_mov_b32 v19, 67584
    v_and_b32 v17, 31, v1
    v_lshlrev_b32 v18, 3, v17
    v_add_u32 v18, 65536, v18
    v_lshlrev_b32 v17, 4, v17
    s_waitcnt lgkmcnt(0)
    s_barrier
    ds_read_b32 v134, v19
    ds_read_b64 v[96:97], v18 offset:0
    ds_read_b64 v[100:101], v18 offset:256
    ds_read_b64 v[104:105], v18 offset:512
    ds_read_b64 v[108:109], v18 offset:768
    ds_read_b64 v[112:113], v18 offset:1024
    ds_read_b64 v[116:117], v18 offset:1280
    ds_read_b64 v[120:121], v18 offset:1536
    ds_read_b64 v[124:125], v18 offset:1792
    s_waitcnt lgkmcnt(8)
    v_readfirstlane_b32 s28, v134
    v_and_b32 v20, 7, v1
    v_lshlrev_b32 v20, 4, v20
    v_add_u32 v21, 67600, v20
    ds_read_b128 v[128:131], v21
    s_waitcnt lgkmcnt(0)
    v_mov_b32 v131, s28
    s_lshl_b32 s16, s2, 7
    s_add_u32 s16, s16, 0x520000
    s_cmp_eq_u32 s3, 0
    s_cselect_b32 s16, s16, 0x7ffffff0
    s_mov_b64 exec, 0xff
    buffer_store_dwordx4 v[128:131], v20, s[8:11], s16 offen sc1
    s_mov_b64 exec, -1
    v_pk_add_f32 v[96:97], v[96:97], v[112:113]
    v_pk_add_f32 v[100:101], v[100:101], v[116:117]
    v_pk_add_f32 v[104:105], v[104:105], v[120:121]
    v_pk_add_f32 v[108:109], v[108:109], v[124:125]
    v_pk_add_f32 v[96:97], v[96:97], v[104:105]
    v_pk_add_f32 v[100:101], v[100:101], v[108:109]
    v_pk_add_f32 v[96:97], v[96:97], v[100:101]
    v_mov_b32 v98, s28
    v_mov_b32 v99, s28
    s_lshl_b32 s16, s14, 3
    s_add_u32 s16, s16, s15
    s_lshl_b32 s16, s16, 9
    s_add_u32 s16, s16, 0x500000
    s_cmp_eq_u32 s3, 0
    s_cselect_b32 s16, s16, 0x7ffffff0
    s_mov_b64 exec, 0xffffffff
    buffer_store_dwordx4 v[96:99], v17, s[8:11], s16 offen sc1
    s_mov_b64 exec, -1
    s_cmp_lt_u32 s24, 8
    s_cbranch_scc1 adaLN_cond__sliding_block_cached__moe_arch_mod__prompt_kernel_kvS
    s_waitcnt vmcnt(3)
    v_lshl_or_b32 v84, v89, 16, v88
    v_lshl_or_b32 v85, v91, 16, v90
    s_waitcnt vmcnt(2)
    v_lshl_or_b32 v86, v93, 16, v92
    v_lshl_or_b32 v87, v95, 16, v94
adaLN_cond__sliding_block_cached__moe_arch_mod__prompt_kernel_kvS:
    s_waitcnt vmcnt(2)
    buffer_store_dwordx4 v[84:87], v2, s[8:11], s21 offen sc1
    s_lshr_b32 s16, s3, 2
    s_lshl_b32 s16, s16, 4
    s_add_u32 s16, s16, s31
    s_lshl_b32 s16, s16, 12
    s_and_b32 s17, s3, 3
    s_lshl_b32 s17, s17, 7
    s_add_u32 s16, s16, s17
    s_add_u32 s16, s16, 0x500000
    v_lshrrev_b32 v139, 3, v1
    v_lshlrev_b32 v139, 9, v139
    v_and_b32 v16, 7, v1
    v_lshl_add_u32 v139, v16, 4, v139
    v_and_b32 v140, 15, v1
    v_lshlrev_b32 v140, 4, v140
    s_lshl_b32 s17, s29, 8
    s_add_u32 s17, s17, 0x520000
    v_lshlrev_b32 v56, 16, v40
    v_and_b32 v57, 0xffff0000, v40
    v_lshlrev_b32 v58, 16, v41
    v_and_b32 v59, 0xffff0000, v41
    v_lshlrev_b32 v60, 16, v42
    v_and_b32 v61, 0xffff0000, v42
    v_lshlrev_b32 v62, 16, v43
    v_and_b32 v63, 0xffff0000, v43
    v_lshlrev_b32 v64, 16, v44
    v_and_b32 v65, 0xffff0000, v44
    v_lshlrev_b32 v66, 16, v45
    v_and_b32 v67, 0xffff0000, v45
    v_lshlrev_b32 v68, 16, v46
    v_and_b32 v69, 0xffff0000, v46
    v_lshlrev_b32 v70, 16, v47
    v_and_b32 v71, 0xffff0000, v47
    s_mov_b32 s27, 0
adaLN_cond__sliding_block_cached__moe_arch_mod__prompt_kernel_g14p:
    buffer_load_dwordx4 v[76:79], v139, s[8:11], s16 offen sc1
    buffer_load_dwordx4 v[80:83], v140, s[8:11], s17 offen sc1
    s_waitcnt vmcnt(1)
    v_cmp_ne_u32 vcc, s28, v78
    v_cmp_ne_u32 s[62:63], s28, v79
    s_or_b64 vcc, vcc, s[62:63]
    s_waitcnt vmcnt(0)
    v_cmp_ne_u32 s[62:63], s28, v83
    s_or_b64 vcc, vcc, s[62:63]
    s_add_u32 s27, s27, 1
    s_cmp_ge_u32 s27, 262144
    s_cbranch_scc1 adaLN_cond__sliding_block_cached__moe_arch_mod__prompt_kernel_g14g
    s_cbranch_vccnz adaLN_cond__sliding_block_cached__moe_arch_mod__prompt_kernel_g14p
adaLN_cond__sliding_block_cached__moe_arch_mod__prompt_kernel_g14g:
    v_add_f32_dpp v76, v76, v76 row_ror:8 row_mask:0xf bank_mask:0xf
    v_add_f32_dpp v77, v77, v77 row_ror:8 row_mask:0xf bank_mask:0xf
    v_mov_b32 v17, v76
    s_nop 1
    v_permlane16_swap_b32 v76, v17
    v_add_f32 v76, v76, v17
    v_mov_b32 v18, v77
    s_nop 1
    v_permlane16_swap_b32 v77, v18
    v_add_f32 v77, v77, v18
    v_mov_b32 v17, v76
    s_nop 1
    v_permlane32_swap_b32 v76, v17
    v_add_f32 v76, v76, v17
    v_mov_b32 v18, v77
    s_nop 1
    v_permlane32_swap_b32 v77, v18
    v_add_f32 v77, v77, v18
    v_cvt_pk_bf16_f32 v17, v76, v77
    v_lshlrev_b32 v76, 16, v17
    v_and_b32 v77, 0xffff0000, v17
    v_add_f32 v76, 1.0, v76
    v_add_f32 v77, 1.0, v77
    v_cvt_pk_bf16_f32 v17, v76, v77
    v_lshlrev_b32 v76, 16, v17
    v_and_b32 v77, 0xffff0000, v17
    s_lshl_b32 s16, s3, 6
    s_add_u32 s16, s16, 69632
    v_lshl_add_u32 v16, v16, 3, s16
    ds_write_b64 v16, v[76:77]
    v_lshrrev_b32 v17, 4, v1
    v_lshlrev_b32 v17, 5, v17
    v_add_u32 v17, 69632, v17
    v_sub_f32 v56, v56, v80
    v_sub_f32 v57, v57, v80
    v_sub_f32 v58, v58, v80
    v_sub_f32 v59, v59, v80
    v_sub_f32 v60, v60, v80
    v_sub_f32 v61, v61, v80
    v_sub_f32 v62, v62, v80
    v_sub_f32 v63, v63, v80
    v_sub_f32 v64, v64, v80
    v_sub_f32 v65, v65, v80
    v_sub_f32 v66, v66, v80
    v_sub_f32 v67, v67, v80
    v_sub_f32 v68, v68, v80
    v_sub_f32 v69, v69, v80
    v_sub_f32 v70, v70, v80
    v_sub_f32 v71, v71, v80
    v_cvt_pk_bf16_f32 v18, v56, v57
    v_lshlrev_b32 v56, 16, v18
    v_and_b32 v57, 0xffff0000, v18
    v_cvt_pk_bf16_f32 v19, v58, v59
    v_lshlrev_b32 v58, 16, v19
    v_and_b32 v59, 0xffff0000, v19
    v_cvt_pk_bf16_f32 v18, v60, v61
    v_lshlrev_b32 v60, 16, v18
    v_and_b32 v61, 0xffff0000, v18
    v_cvt_pk_bf16_f32 v19, v62, v63
    v_lshlrev_b32 v62, 16, v19
    v_and_b32 v63, 0xffff0000, v19
    v_cvt_pk_bf16_f32 v18, v64, v65
    v_lshlrev_b32 v64, 16, v18
    v_and_b32 v65, 0xffff0000, v18
    v_cvt_pk_bf16_f32 v19, v66, v67
    v_lshlrev_b32 v66, 16, v19
    v_and_b32 v67, 0xffff0000, v19
    v_cvt_pk_bf16_f32 v18, v68, v69
    v_lshlrev_b32 v68, 16, v18
    v_and_b32 v69, 0xffff0000, v18
    v_cvt_pk_bf16_f32 v19, v70, v71
    v_lshlrev_b32 v70, 16, v19
    v_and_b32 v71, 0xffff0000, v19
    v_mul_f32 v56, v56, v82
    v_mul_f32 v57, v57, v82
    v_mul_f32 v58, v58, v82
    v_mul_f32 v59, v59, v82
    v_mul_f32 v60, v60, v82
    v_mul_f32 v61, v61, v82
    v_mul_f32 v62, v62, v82
    v_mul_f32 v63, v63, v82
    v_mul_f32 v64, v64, v82
    v_mul_f32 v65, v65, v82
    v_mul_f32 v66, v66, v82
    v_mul_f32 v67, v67, v82
    v_mul_f32 v68, v68, v82
    v_mul_f32 v69, v69, v82
    v_mul_f32 v70, v70, v82
    v_mul_f32 v71, v71, v82
    v_cvt_pk_bf16_f32 v18, v56, v57
    v_lshlrev_b32 v56, 16, v18
    v_and_b32 v57, 0xffff0000, v18
    v_cvt_pk_bf16_f32 v19, v58, v59
    v_lshlrev_b32 v58, 16, v19
    v_and_b32 v59, 0xffff0000, v19
    v_cvt_pk_bf16_f32 v18, v60, v61
    v_lshlrev_b32 v60, 16, v18
    v_and_b32 v61, 0xffff0000, v18
    v_cvt_pk_bf16_f32 v19, v62, v63
    v_lshlrev_b32 v62, 16, v19
    v_and_b32 v63, 0xffff0000, v19
    v_cvt_pk_bf16_f32 v18, v64, v65
    v_lshlrev_b32 v64, 16, v18
    v_and_b32 v65, 0xffff0000, v18
    v_cvt_pk_bf16_f32 v19, v66, v67
    v_lshlrev_b32 v66, 16, v19
    v_and_b32 v67, 0xffff0000, v19
    v_cvt_pk_bf16_f32 v18, v68, v69
    v_lshlrev_b32 v68, 16, v18
    v_and_b32 v69, 0xffff0000, v18
    v_cvt_pk_bf16_f32 v19, v70, v71
    v_lshlrev_b32 v70, 16, v19
    v_and_b32 v71, 0xffff0000, v19
    s_lshl_b32 s16, s29, 15
    s_lshl_b32 s17, s31, 11
    s_add_u32 s16, s16, s17
    s_waitcnt lgkmcnt(0)
    s_barrier
    ds_read_b128 v[96:99], v17 offset:256
    ds_read_b128 v[104:107], v17 offset:0
    ds_read_b128 v[100:103], v17 offset:272
    ds_read_b128 v[108:111], v17 offset:16
    ds_read_b128 v[112:115], v17 offset:384
    ds_read_b128 v[120:123], v17 offset:128
    ds_read_b128 v[116:119], v17 offset:400
    ds_read_b128 v[124:127], v17 offset:144
    s_waitcnt lgkmcnt(7)
    v_pk_mul_f32 v[56:57], v[56:57], v[96:97]
    v_pk_mul_f32 v[58:59], v[58:59], v[98:99]
    s_waitcnt lgkmcnt(5)
    v_pk_mul_f32 v[60:61], v[60:61], v[100:101]
    v_pk_mul_f32 v[62:63], v[62:63], v[102:103]
    v_cvt_pk_bf16_f32 v18, v56, v57
    v_lshlrev_b32 v56, 16, v18
    v_and_b32 v57, 0xffff0000, v18
    v_cvt_pk_bf16_f32 v19, v58, v59
    v_lshlrev_b32 v58, 16, v19
    v_and_b32 v59, 0xffff0000, v19
    v_cvt_pk_bf16_f32 v18, v60, v61
    v_lshlrev_b32 v60, 16, v18
    v_and_b32 v61, 0xffff0000, v18
    v_cvt_pk_bf16_f32 v19, v62, v63
    v_lshlrev_b32 v62, 16, v19
    v_and_b32 v63, 0xffff0000, v19
    v_pk_add_f32 v[56:57], v[56:57], v[104:105]
    v_pk_add_f32 v[58:59], v[58:59], v[106:107]
    s_waitcnt lgkmcnt(4)
    v_pk_add_f32 v[60:61], v[60:61], v[108:109]
    v_pk_add_f32 v[62:63], v[62:63], v[110:111]
    v_cvt_pk_bf16_f32 v32, v56, v57
    v_cvt_pk_bf16_f32 v33, v58, v59
    v_cvt_pk_bf16_f32 v34, v60, v61
    v_cvt_pk_bf16_f32 v35, v62, v63
    buffer_store_dwordx4 v[32:35], v2, s[8:11], s16 offen offset:0 sc1
    s_waitcnt lgkmcnt(3)
    v_pk_mul_f32 v[64:65], v[64:65], v[112:113]
    v_pk_mul_f32 v[66:67], v[66:67], v[114:115]
    s_waitcnt lgkmcnt(1)
    v_pk_mul_f32 v[68:69], v[68:69], v[116:117]
    v_pk_mul_f32 v[70:71], v[70:71], v[118:119]
    v_cvt_pk_bf16_f32 v18, v64, v65
    v_lshlrev_b32 v64, 16, v18
    v_and_b32 v65, 0xffff0000, v18
    v_cvt_pk_bf16_f32 v19, v66, v67
    v_lshlrev_b32 v66, 16, v19
    v_and_b32 v67, 0xffff0000, v19
    v_cvt_pk_bf16_f32 v18, v68, v69
    v_lshlrev_b32 v68, 16, v18
    v_and_b32 v69, 0xffff0000, v18
    v_cvt_pk_bf16_f32 v19, v70, v71
    v_lshlrev_b32 v70, 16, v19
    v_and_b32 v71, 0xffff0000, v19
    v_pk_add_f32 v[64:65], v[64:65], v[120:121]
    v_pk_add_f32 v[66:67], v[66:67], v[122:123]
    s_waitcnt lgkmcnt(0)
    v_pk_add_f32 v[68:69], v[68:69], v[124:125]
    v_pk_add_f32 v[70:71], v[70:71], v[126:127]
    v_cvt_pk_bf16_f32 v36, v64, v65
    v_cvt_pk_bf16_f32 v37, v66, v67
    v_cvt_pk_bf16_f32 v38, v68, v69
    v_cvt_pk_bf16_f32 v39, v70, v71
    buffer_store_dwordx4 v[36:39], v2, s[8:11], s16 offen offset:1024 sc1
    s_lshl_b32 s19, s3, 16
    s_lshl_b32 s20, s3, 11
    s_lshl_b32 s16, s12, 8
    s_add_u32 s4, s38, s16
    s_addc_u32 s5, s39, 0
    s_sub_u32 s6, 0x800000, s16
    s_mov_b32 s7, 0x20000
    s_add_u32 s22, s19, 0x0
    s_add_u32 m0, s20, 0x0
    s_nop 0
    buffer_load_dwordx4 v3, s[4:7], s22 offen lds
    s_add_u32 s22, s19, 0x8000
    s_add_u32 m0, s20, 0x400
    s_nop 0
    buffer_load_dwordx4 v3, s[4:7], s22 offen lds
    s_add_u32 s22, s19, 0x80000
    s_add_u32 m0, s20, 0x4000
    s_nop 0
    buffer_load_dwordx4 v3, s[4:7], s22 offen lds
    s_add_u32 s22, s19, 0x88000
    s_add_u32 m0, s20, 0x4400
    s_nop 0
    buffer_load_dwordx4 v3, s[4:7], s22 offen lds
    s_add_u32 s22, s19, 0x100000
    s_add_u32 m0, s20, 0x8000
    s_nop 0
    buffer_load_dwordx4 v3, s[4:7], s22 offen lds
    s_add_u32 s22, s19, 0x108000
    s_add_u32 m0, s20, 0x8400
    s_nop 0
    buffer_load_dwordx4 v3, s[4:7], s22 offen lds
    v_mov_b32 v134, s28
    s_lshl_b32 s16, s29, 4
    s_add_u32 s16, s16, s31
    s_lshl_b32 s16, s16, 2
    s_add_u32 s16, s16, 0x528000
    v_and_b32 v16, 31, v1
    v_lshlrev_b32 v16, 2, v16
    s_lshl_b32 s17, s13, 3
    s_add_u32 s17, s17, s3
    s_lshl_b32 s17, s17, 7
    s_add_u32 s17, s17, 0x528000
    s_waitcnt vmcnt(6)
    s_mov_b64 exec, 1
    buffer_store_dword v134, v132, s[8:11], s16 offen sc1
    s_mov_b64 exec, -1
    s_sleep 48
    s_mov_b32 s27, 0
adaLN_cond__sliding_block_cached__moe_arch_mod__prompt_kernel_h15p:
    buffer_load_dword v17, v16, s[8:11], s17 offen sc1
    s_waitcnt vmcnt(0)
    v_cmp_ne_u32 vcc, s28, v17
    s_add_u32 s27, s27, 1
    s_cmp_ge_u32 s27, 262144
    s_cbranch_scc1 adaLN_cond__sliding_block_cached__moe_arch_mod__prompt_kernel_h15g
    s_cbranch_vccnz adaLN_cond__sliding_block_cached__moe_arch_mod__prompt_kernel_h15p
adaLN_cond__sliding_block_cached__moe_arch_mod__prompt_kernel_h15g:
    s_mov_b32 s23, 0x0
    buffer_load_dwordx4 v[88:91], v7, s[8:11], s23 offen offset:0 sc1
    s_mov_b32 s23, 0x8000
    buffer_load_dwordx4 v[92:95], v7, s[8:11], s23 offen offset:0 sc1
    s_mov_b32 s23, 0x0
    buffer_load_dwordx4 v[96:99], v7, s[8:11], s23 offen offset:1024 sc1
    s_mov_b32 s23, 0x8000
    buffer_load_dwordx4 v[100:103], v7, s[8:11], s23 offen offset:1024 sc1
    s_mov_b32 s23, 0x800
    buffer_load_dwordx4 v[104:107], v7, s[8:11], s23 offen offset:0 sc1
    s_mov_b32 s23, 0x8800
    buffer_load_dwordx4 v[108:111], v7, s[8:11], s23 offen offset:0 sc1
    s_mov_b32 s23, 0x800
    buffer_load_dwordx4 v[112:115], v7, s[8:11], s23 offen offset:1024 sc1
    s_mov_b32 s23, 0x8800
    buffer_load_dwordx4 v[116:119], v7, s[8:11], s23 offen offset:1024 sc1
    s_lshr_b32 s21, s12, 3
    s_lshl_b32 s21, s21, 17
    s_add_u32 s21, s21, s20
    s_add_u32 s21, s21, 0x400000
    s_barrier
    ds_read_b64_tr_b16 v[224:225], v4 offset:0
    ds_read_b64_tr_b16 v[226:227], v4 offset:1024
    ds_read_b64_tr_b16 v[228:229], v5 offset:32
    ds_read_b64_tr_b16 v[230:231], v5 offset:1056
    ds_read_b64_tr_b16 v[232:233], v4 offset:256
    ds_read_b64_tr_b16 v[234:235], v4 offset:1280
    ds_read_b64_tr_b16 v[236:237], v5 offset:288
    ds_read_b64_tr_b16 v[238:239], v5 offset:1312
    s_waitcnt vmcnt(7) lgkmcnt(6)
    v_mfma_f32_16x16x32_bf16 v[24:27], v[224:227], v[88:91], 0
    ds_read_b64_tr_b16 v[240:241], v4 offset:512
    s_waitcnt vmcnt(6)
    v_mfma_f32_16x16x32_bf16 v[28:31], v[224:227], v[92:95], 0
    ds_read_b64_tr_b16 v[242:243], v4 offset:1536
    s_waitcnt lgkmcnt(6)
    v_mfma_f32_16x16x32_bf16 v[32:35], v[228:231], v[88:91], 0
    ds_read_b64_tr_b16 v[244:245], v5 offset:544
    v_mfma_f32_16x16x32_bf16 v[36:39], v[228:231], v[92:95], 0
    ds_read_b64_tr_b16 v[246:247], v5 offset:1568
    s_mov_b32 s23, 0x1000
    buffer_load_dwordx4 v[120:123], v7, s[8:11], s23 offen offset:0 sc1
    s_waitcnt lgkmcnt(6)
    v_mfma_f32_16x16x32_bf16 v[40:43], v[232:235], v[88:91], 0
    ds_read_b64_tr_b16 v[224:225], v4 offset:768
    v_mfma_f32_16x16x32_bf16 v[44:47], v[232:235], v[92:95], 0
    ds_read_b64_tr_b16 v[226:227], v4 offset:1792
    s_waitcnt lgkmcnt(6)
    v_mfma_f32_16x16x32_bf16 v[48:51], v[236:239], v[88:91], 0
    ds_read_b64_tr_b16 v[228:229], v5 offset:800
    v_mfma_f32_16x16x32_bf16 v[52:55], v[236:239], v[92:95], 0
    ds_read_b64_tr_b16 v[230:231], v5 offset:1824
    s_waitcnt lgkmcnt(6)
    v_mfma_f32_16x16x32_bf16 v[56:59], v[240:243], v[88:91], 0
    ds_read_b64_tr_b16 v[232:233], v4 offset:8192
    v_mfma_f32_16x16x32_bf16 v[60:63], v[240:243], v[92:95], 0
    ds_read_b64_tr_b16 v[234:235], v4 offset:9216
    s_waitcnt lgkmcnt(6)
    v_mfma_f32_16x16x32_bf16 v[64:67], v[244:247], v[88:91], 0
    ds_read_b64_tr_b16 v[236:237], v5 offset:8224
    v_mfma_f32_16x16x32_bf16 v[68:71], v[244:247], v[92:95], 0
    ds_read_b64_tr_b16 v[238:239], v5 offset:9248
    s_mov_b32 s23, 0x9000
    buffer_load_dwordx4 v[124:127], v7, s[8:11], s23 offen offset:0 sc1
    s_waitcnt lgkmcnt(6)
    v_mfma_f32_16x16x32_bf16 v[72:75], v[224:227], v[88:91], 0
    ds_read_b64_tr_b16 v[240:241], v4 offset:8448
    v_mfma_f32_16x16x32_bf16 v[76:79], v[224:227], v[92:95], 0
    ds_read_b64_tr_b16 v[242:243], v4 offset:9472
    s_waitcnt lgkmcnt(6)
    v_mfma_f32_16x16x32_bf16 v[80:83], v[228:231], v[88:91], 0
    ds_read_b64_tr_b16 v[244:245], v5 offset:8480
    v_mfma_f32_16x16x32_bf16 v[84:87], v[228:231], v[92:95], 0
    ds_read_b64_tr_b16 v[246:247], v5 offset:9504
    s_waitcnt vmcnt(7) lgkmcnt(6)
    v_mfma_f32_16x16x32_bf16 v[24:27], v[232:235], v[96:99], v[24:27]
    ds_read_b64_tr_b16 v[224:225], v4 offset:8704
    s_waitcnt vmcnt(6)
    v_mfma_f32_16x16x32_bf16 v[28:31], v[232:235], v[100:103], v[28:31]
    ds_read_b64_tr_b16 v[226:227], v4 offset:9728
    s_waitcnt lgkmcnt(6)
    v_mfma_f32_16x16x32_bf16 v[32:35], v[236:239], v[96:99], v[32:35]
    ds_read_b64_tr_b16 v[228:229], v5 offset:8736
    v_mfma_f32_16x16x32_bf16 v[36:39], v[236:239], v[100:103], v[36:39]
    ds_read_b64_tr_b16 v[230:231], v5 offset:9760
    s_mov_b32 s23, 0x1000
    buffer_load_dwordx4 v[128:131], v7, s[8:11], s23 offen offset:1024 sc1
    s_waitcnt lgkmcnt(6)
    v_mfma_f32_16x16x32_bf16 v[40:43], v[240:243], v[96:99], v[40:43]
    ds_read_b64_tr_b16 v[232:233], v4 offset:8960
    v_mfma_f32_16x16x32_bf16 v[44:47], v[240:243], v[100:103], v[44:47]
    ds_read_b64_tr_b16 v[234:235], v4 offset:9984
    s_waitcnt lgkmcnt(6)
    v_mfma_f32_16x16x32_bf16 v[48:51], v[244:247], v[96:99], v[48:51]
    ds_read_b64_tr_b16 v[236:237], v5 offset:8992
    v_mfma_f32_16x16x32_bf16 v[52:55], v[244:247], v[100:103], v[52:55]
    ds_read_b64_tr_b16 v[238:239], v5 offset:10016
    s_waitcnt lgkmcnt(6)
    v_mfma_f32_16x16x32_bf16 v[56:59], v[224:227], v[96:99], v[56:59]
    v_mfma_f32_16x16x32_bf16 v[60:63], v[224:227], v[100:103], v[60:63]
    s_barrier
    ds_read_b64_tr_b16 v[240:241], v4 offset:16384
    ds_read_b64_tr_b16 v[242:243], v4 offset:17408
    s_waitcnt lgkmcnt(6)
    v_mfma_f32_16x16x32_bf16 v[64:67], v[228:231], v[96:99], v[64:67]
    ds_read_b64_tr_b16 v[244:245], v5 offset:16416
    v_mfma_f32_16x16x32_bf16 v[68:71], v[228:231], v[100:103], v[68:71]
    s_add_u32 s22, s19, 0x180000
    s_add_u32 m0, s20, 0xc000
    s_nop 0
    buffer_load_dwordx4 v3, s[4:7], s22 offen lds
    ds_read_b64_tr_b16 v[246:247], v5 offset:17440
    s_mov_b32 s23, 0x9000
    buffer_load_dwordx4 v[132:135], v7, s[8:11], s23 offen offset:1024 sc1
    s_waitcnt lgkmcnt(6)
    v_mfma_f32_16x16x32_bf16 v[72:75], v[232:235], v[96:99], v[72:75]
    ds_read_b64_tr_b16 v[224:225], v4 offset:16640
    v_mfma_f32_16x16x32_bf16 v[76:79], v[232:235], v[100:103], v[76:79]
    ds_read_b64_tr_b16 v[226:227], v4 offset:17664
    s_waitcnt lgkmcnt(6)
    v_mfma_f32_16x16x32_bf16 v[80:83], v[236:239], v[96:99], v[80:83]
    ds_read_b64_tr_b16 v[228:229], v5 offset:16672
    v_mfma_f32_16x16x32_bf16 v[84:87], v[236:239], v[100:103], v[84:87]
    ds_read_b64_tr_b16 v[230:231], v5 offset:17696
    s_waitcnt vmcnt(8) lgkmcnt(6)
    v_mfma_f32_16x16x32_bf16 v[24:27], v[240:243], v[104:107], v[24:27]
    ds_read_b64_tr_b16 v[232:233], v4 offset:16896
    s_waitcnt vmcnt(7)
    v_mfma_f32_16x16x32_bf16 v[28:31], v[240:243], v[108:111], v[28:31]
    ds_read_b64_tr_b16 v[234:235], v4 offset:17920
    s_waitcnt lgkmcnt(6)
    v_mfma_f32_16x16x32_bf16 v[32:35], v[244:247], v[104:107], v[32:35]
    ds_read_b64_tr_b16 v[236:237], v5 offset:16928
    v_mfma_f32_16x16x32_bf16 v[36:39], v[244:247], v[108:111], v[36:39]
    s_add_u32 s22, s19, 0x188000
    s_add_u32 m0, s20, 0xc400
    s_nop 0
    buffer_load_dwordx4 v3, s[4:7], s22 offen lds
    ds_read_b64_tr_b16 v[238:239], v5 offset:17952
    s_mov_b32 s23, 0x1800
    buffer_load_dwordx4 v[88:91], v7, s[8:11], s23 offen offset:0 sc1
    s_waitcnt lgkmcnt(6)
    v_mfma_f32_16x16x32_bf16 v[40:43], v[224:227], v[104:107], v[40:43]
    ds_read_b64_tr_b16 v[240:241], v4 offset:17152
    v_mfma_f32_16x16x32_bf16 v[44:47], v[224:227], v[108:111], v[44:47]
    ds_read_b64_tr_b16 v[242:243], v4 offset:18176
    s_waitcnt lgkmcnt(6)
    v_mfma_f32_16x16x32_bf16 v[48:51], v[228:231], v[104:107], v[48:51]
    ds_read_b64_tr_b16 v[244:245], v5 offset:17184
    v_mfma_f32_16x16x32_bf16 v[52:55], v[228:231], v[108:111], v[52:55]
    ds_read_b64_tr_b16 v[246:247], v5 offset:18208
    s_waitcnt lgkmcnt(6)
    v_mfma_f32_16x16x32_bf16 v[56:59], v[232:235], v[104:107], v[56:59]
    ds_read_b64_tr_b16 v[224:225], v4 offset:24576
    v_mfma_f32_16x16x32_bf16 v[60:63], v[232:235], v[108:111], v[60:63]
    ds_read_b64_tr_b16 v[226:227], v4 offset:25600
    s_waitcnt lgkmcnt(6)
    v_mfma_f32_16x16x32_bf16 v[64:67], v[236:239], v[104:107], v[64:67]
    ds_read_b64_tr_b16 v[228:229], v5 offset:24608
    v_mfma_f32_16x16x32_bf16 v[68:71], v[236:239], v[108:111], v[68:71]
    ds_read_b64_tr_b16 v[230:231], v5 offset:25632
    s_mov_b32 s23, 0x9800
    buffer_load_dwordx4 v[92:95], v7, s[8:11], s23 offen offset:0 sc1
    s_waitcnt lgkmcnt(6)
    v_mfma_f32_16x16x32_bf16 v[72:75], v[240:243], v[104:107], v[72:75]
    ds_read_b64_tr_b16 v[232:233], v4 offset:24832
    v_mfma_f32_16x16x32_bf16 v[76:79], v[240:243], v[108:111], v[76:79]
    ds_read_b64_tr_b16 v[234:235], v4 offset:25856
    s_waitcnt lgkmcnt(6)
    v_mfma_f32_16x16x32_bf16 v[80:83], v[244:247], v[104:107], v[80:83]
    ds_read_b64_tr_b16 v[236:237], v5 offset:24864
    v_mfma_f32_16x16x32_bf16 v[84:87], v[244:247], v[108:111], v[84:87]
    ds_read_b64_tr_b16 v[238:239], v5 offset:25888
    s_waitcnt vmcnt(9) lgkmcnt(6)
    v_mfma_f32_16x16x32_bf16 v[24:27], v[224:227], v[112:115], v[24:27]
    ds_read_b64_tr_b16 v[240:241], v4 offset:25088
    s_waitcnt vmcnt(8)
    v_mfma_f32_16x16x32_bf16 v[28:31], v[224:227], v[116:119], v[28:31]
    ds_read_b64_tr_b16 v[242:243], v4 offset:26112
    s_waitcnt lgkmcnt(6)
    v_mfma_f32_16x16x32_bf16 v[32:35], v[228:231], v[112:115], v[32:35]
    ds_read_b64_tr_b16 v[244:245], v5 offset:25120
    v_mfma_f32_16x16x32_bf16 v[36:39], v[228:231], v[116:119], v[36:39]
    ds_read_b64_tr_b16 v[246:247], v5 offset:26144
    s_mov_b32 s23, 0x1800
    buffer_load_dwordx4 v[96:99], v7, s[8:11], s23 offen offset:1024 sc1
    s_waitcnt lgkmcnt(6)
    v_mfma_f32_16x16x32_bf16 v[40:43], v[232:235], v[112:115], v[40:43]
    ds_read_b64_tr_b16 v[224:225], v4 offset:25344
    v_mfma_f32_16x16x32_bf16 v[44:47], v[232:235], v[116:119], v[44:47]
    ds_read_b64_tr_b16 v[226:227], v4 offset:26368
    s_waitcnt lgkmcnt(6)
    v_mfma_f32_16x16x32_bf16 v[48:51], v[236:239], v[112:115], v[48:51]
    ds_read_b64_tr_b16 v[228:229], v5 offset:25376
    v_mfma_f32_16x16x32_bf16 v[52:55], v[236:239], v[116:119], v[52:55]
    ds_read_b64_tr_b16 v[230:231], v5 offset:26400
    s_waitcnt lgkmcnt(6)
    v_mfma_f32_16x16x32_bf16 v[56:59], v[240:243], v[112:115], v[56:59]
    v_mfma_f32_16x16x32_bf16 v[60:63], v[240:243], v[116:119], v[60:63]
    s_barrier
    ds_read_b64_tr_b16 v[232:233], v4 offset:32768
    ds_read_b64_tr_b16 v[234:235], v4 offset:33792
    s_waitcnt lgkmcnt(6)
    v_mfma_f32_16x16x32_bf16 v[64:67], v[244:247], v[112:115], v[64:67]
    ds_read_b64_tr_b16 v[236:237], v5 offset:32800
    v_mfma_f32_16x16x32_bf16 v[68:71], v[244:247], v[116:119], v[68:71]
    s_add_u32 s22, s19, 0x200000
    s_add_u32 m0, s20, 0x0
    s_nop 0
    buffer_load_dwordx4 v3, s[4:7], s22 offen lds
    ds_read_b64_tr_b16 v[238:239], v5 offset:33824
    s_mov_b32 s23, 0x9800
    buffer_load_dwordx4 v[100:103], v7, s[8:11], s23 offen offset:1024 sc1
    s_waitcnt lgkmcnt(6)
    v_mfma_f32_16x16x32_bf16 v[72:75], v[224:227], v[112:115], v[72:75]
    ds_read_b64_tr_b16 v[240:241], v4 offset:33024
    v_mfma_f32_16x16x32_bf16 v[76:79], v[224:227], v[116:119], v[76:79]
    ds_read_b64_tr_b16 v[242:243], v4 offset:34048
    s_waitcnt lgkmcnt(6)
    v_mfma_f32_16x16x32_bf16 v[80:83], v[228:231], v[112:115], v[80:83]
    ds_read_b64_tr_b16 v[244:245], v5 offset:33056
    v_mfma_f32_16x16x32_bf16 v[84:87], v[228:231], v[116:119], v[84:87]
    ds_read_b64_tr_b16 v[246:247], v5 offset:34080
    s_waitcnt vmcnt(10) lgkmcnt(6)
    v_mfma_f32_16x16x32_bf16 v[24:27], v[232:235], v[120:123], v[24:27]
    ds_read_b64_tr_b16 v[224:225], v4 offset:33280
    s_waitcnt vmcnt(9)
    v_mfma_f32_16x16x32_bf16 v[28:31], v[232:235], v[124:127], v[28:31]
    ds_read_b64_tr_b16 v[226:227], v4 offset:34304
    s_waitcnt lgkmcnt(6)
    v_mfma_f32_16x16x32_bf16 v[32:35], v[236:239], v[120:123], v[32:35]
    ds_read_b64_tr_b16 v[228:229], v5 offset:33312
    v_mfma_f32_16x16x32_bf16 v[36:39], v[236:239], v[124:127], v[36:39]
    s_add_u32 s22, s19, 0x208000
    s_add_u32 m0, s20, 0x400
    s_nop 0
    buffer_load_dwordx4 v3, s[4:7], s22 offen lds
    ds_read_b64_tr_b16 v[230:231], v5 offset:34336
    s_mov_b32 s23, 0x2000
    buffer_load_dwordx4 v[104:107], v7, s[8:11], s23 offen offset:0 sc1
    s_waitcnt lgkmcnt(6)
    v_mfma_f32_16x16x32_bf16 v[40:43], v[240:243], v[120:123], v[40:43]
    ds_read_b64_tr_b16 v[232:233], v4 offset:33536
    v_mfma_f32_16x16x32_bf16 v[44:47], v[240:243], v[124:127], v[44:47]
    ds_read_b64_tr_b16 v[234:235], v4 offset:34560
    s_waitcnt lgkmcnt(6)
    v_mfma_f32_16x16x32_bf16 v[48:51], v[244:247], v[120:123], v[48:51]
    ds_read_b64_tr_b16 v[236:237], v5 offset:33568
    v_mfma_f32_16x16x32_bf16 v[52:55], v[244:247], v[124:127], v[52:55]
    ds_read_b64_tr_b16 v[238:239], v5 offset:34592
    s_waitcnt lgkmcnt(6)
    v_mfma_f32_16x16x32_bf16 v[56:59], v[224:227], v[120:123], v[56:59]
    ds_read_b64_tr_b16 v[240:241], v4 offset:40960
    v_mfma_f32_16x16x32_bf16 v[60:63], v[224:227], v[124:127], v[60:63]
    ds_read_b64_tr_b16 v[242:243], v4 offset:41984
    s_waitcnt lgkmcnt(6)
    v_mfma_f32_16x16x32_bf16 v[64:67], v[228:231], v[120:123], v[64:67]
    ds_read_b64_tr_b16 v[244:245], v5 offset:40992
    v_mfma_f32_16x16x32_bf16 v[68:71], v[228:231], v[124:127], v[68:71]
    ds_read_b64_tr_b16 v[246:247], v5 offset:42016
    s_mov_b32 s23, 0xa000
    buffer_load_dwordx4 v[108:111], v7, s[8:11], s23 offen offset:0 sc1
    s_waitcnt lgkmcnt(6)
    v_mfma_f32_16x16x32_bf16 v[72:75], v[232:235], v[120:123], v[72:75]
    ds_read_b64_tr_b16 v[224:225], v4 offset:41216
    v_mfma_f32_16x16x32_bf16 v[76:79], v[232:235], v[124:127], v[76:79]
    ds_read_b64_tr_b16 v[226:227], v4 offset:42240
    s_waitcnt lgkmcnt(6)
    v_mfma_f32_16x16x32_bf16 v[80:83], v[236:239], v[120:123], v[80:83]
    ds_read_b64_tr_b16 v[228:229], v5 offset:41248
    v_mfma_f32_16x16x32_bf16 v[84:87], v[236:239], v[124:127], v[84:87]
    ds_read_b64_tr_b16 v[230:231], v5 offset:42272
    s_waitcnt vmcnt(11) lgkmcnt(6)
    v_mfma_f32_16x16x32_bf16 v[24:27], v[240:243], v[128:131], v[24:27]
    ds_read_b64_tr_b16 v[232:233], v4 offset:41472
    s_waitcnt vmcnt(9)
    v_mfma_f32_16x16x32_bf16 v[28:31], v[240:243], v[132:135], v[28:31]
    ds_read_b64_tr_b16 v[234:235], v4 offset:42496
    s_waitcnt lgkmcnt(6)
    v_mfma_f32_16x16x32_bf16 v[32:35], v[244:247], v[128:131], v[32:35]
    ds_read_b64_tr_b16 v[236:237], v5 offset:41504
    v_mfma_f32_16x16x32_bf16 v[36:39], v[244:247], v[132:135], v[36:39]
    ds_read_b64_tr_b16 v[238:239], v5 offset:42528
    s_mov_b32 s23, 0x2000
    buffer_load_dwordx4 v[112:115], v7, s[8:11], s23 offen offset:1024 sc1
    s_waitcnt lgkmcnt(6)
    v_mfma_f32_16x16x32_bf16 v[40:43], v[224:227], v[128:131], v[40:43]
    ds_read_b64_tr_b16 v[240:241], v4 offset:41728
    v_mfma_f32_16x16x32_bf16 v[44:47], v[224:227], v[132:135], v[44:47]
    ds_read_b64_tr_b16 v[242:243], v4 offset:42752
    s_waitcnt lgkmcnt(6)
    v_mfma_f32_16x16x32_bf16 v[48:51], v[228:231], v[128:131], v[48:51]
    ds_read_b64_tr_b16 v[244:245], v5 offset:41760
    v_mfma_f32_16x16x32_bf16 v[52:55], v[228:231], v[132:135], v[52:55]
    ds_read_b64_tr_b16 v[246:247], v5 offset:42784
    s_waitcnt lgkmcnt(6)
    v_mfma_f32_16x16x32_bf16 v[56:59], v[232:235], v[128:131], v[56:59]
    v_mfma_f32_16x16x32_bf16 v[60:63], v[232:235], v[132:135], v[60:63]
    s_waitcnt vmcnt(9)
    s_barrier
    ds_read_b64_tr_b16 v[224:225], v4 offset:49152
    ds_read_b64_tr_b16 v[226:227], v4 offset:50176
    s_waitcnt lgkmcnt(6)
    v_mfma_f32_16x16x32_bf16 v[64:67], v[236:239], v[128:131], v[64:67]
    ds_read_b64_tr_b16 v[228:229], v5 offset:49184
    v_mfma_f32_16x16x32_bf16 v[68:71], v[236:239], v[132:135], v[68:71]
    s_add_u32 s22, s19, 0x280000
    s_add_u32 m0, s20, 0x4000
    s_nop 0
    buffer_load_dwordx4 v3, s[4:7], s22 offen lds
    ds_read_b64_tr_b16 v[230:231], v5 offset:50208
    s_mov_b32 s23, 0xa000
    buffer_load_dwordx4 v[116:119], v7, s[8:11], s23 offen offset:1024 sc1
    s_waitcnt lgkmcnt(6)
    v_mfma_f32_16x16x32_bf16 v[72:75], v[240:243], v[128:131], v[72:75]
    ds_read_b64_tr_b16 v[232:233], v4 offset:49408
    v_mfma_f32_16x16x32_bf16 v[76:79], v[240:243], v[132:135], v[76:79]
    ds_read_b64_tr_b16 v[234:235], v4 offset:50432
    s_waitcnt lgkmcnt(6)
    v_mfma_f32_16x16x32_bf16 v[80:83], v[244:247], v[128:131], v[80:83]
    ds_read_b64_tr_b16 v[236:237], v5 offset:49440
    v_mfma_f32_16x16x32_bf16 v[84:87], v[244:247], v[132:135], v[84:87]
    ds_read_b64_tr_b16 v[238:239], v5 offset:50464
    s_waitcnt vmcnt(10) lgkmcnt(6)
    v_mfma_f32_16x16x32_bf16 v[24:27], v[224:227], v[88:91], v[24:27]
    ds_read_b64_tr_b16 v[240:241], v4 offset:49664
    s_waitcnt vmcnt(9)
    v_mfma_f32_16x16x32_bf16 v[28:31], v[224:227], v[92:95], v[28:31]
    ds_read_b64_tr_b16 v[242:243], v4 offset:50688
    s_waitcnt lgkmcnt(6)
    v_mfma_f32_16x16x32_bf16 v[32:35], v[228:231], v[88:91], v[32:35]
    ds_read_b64_tr_b16 v[244:245], v5 offset:49696
    v_mfma_f32_16x16x32_bf16 v[36:39], v[228:231], v[92:95], v[36:39]
    s_add_u32 s22, s19, 0x288000
    s_add_u32 m0, s20, 0x4400
    s_nop 0
    buffer_load_dwordx4 v3, s[4:7], s22 offen lds
    ds_read_b64_tr_b16 v[246:247], v5 offset:50720
    s_mov_b32 s23, 0x2800
    buffer_load_dwordx4 v[120:123], v7, s[8:11], s23 offen offset:0 sc1
    s_waitcnt lgkmcnt(6)
    v_mfma_f32_16x16x32_bf16 v[40:43], v[232:235], v[88:91], v[40:43]
    ds_read_b64_tr_b16 v[224:225], v4 offset:49920
    v_mfma_f32_16x16x32_bf16 v[44:47], v[232:235], v[92:95], v[44:47]
    ds_read_b64_tr_b16 v[226:227], v4 offset:50944
    s_waitcnt lgkmcnt(6)
    v_mfma_f32_16x16x32_bf16 v[48:51], v[236:239], v[88:91], v[48:51]
    ds_read_b64_tr_b16 v[228:229], v5 offset:49952
    v_mfma_f32_16x16x32_bf16 v[52:55], v[236:239], v[92:95], v[52:55]
    ds_read_b64_tr_b16 v[230:231], v5 offset:50976
    s_waitcnt lgkmcnt(6)
    v_mfma_f32_16x16x32_bf16 v[56:59], v[240:243], v[88:91], v[56:59]
    ds_read_b64_tr_b16 v[232:233], v4 offset:57344
    v_mfma_f32_16x16x32_bf16 v[60:63], v[240:243], v[92:95], v[60:63]
    ds_read_b64_tr_b16 v[234:235], v4 offset:58368
    s_waitcnt lgkmcnt(6)
    v_mfma_f32_16x16x32_bf16 v[64:67], v[244:247], v[88:91], v[64:67]
    ds_read_b64_tr_b16 v[236:237], v5 offset:57376
    v_mfma_f32_16x16x32_bf16 v[68:71], v[244:247], v[92:95], v[68:71]
    ds_read_b64_tr_b16 v[238:239], v5 offset:58400
    s_mov_b32 s23, 0xa800
    buffer_load_dwordx4 v[124:127], v7, s[8:11], s23 offen offset:0 sc1
    s_waitcnt lgkmcnt(6)
    v_mfma_f32_16x16x32_bf16 v[72:75], v[224:227], v[88:91], v[72:75]
    ds_read_b64_tr_b16 v[240:241], v4 offset:57600
    v_mfma_f32_16x16x32_bf16 v[76:79], v[224:227], v[92:95], v[76:79]
    ds_read_b64_tr_b16 v[242:243], v4 offset:58624
    s_waitcnt lgkmcnt(6)
    v_mfma_f32_16x16x32_bf16 v[80:83], v[228:231], v[88:91], v[80:83]
    ds_read_b64_tr_b16 v[244:245], v5 offset:57632
    v_mfma_f32_16x16x32_bf16 v[84:87], v[228:231], v[92:95], v[84:87]
    ds_read_b64_tr_b16 v[246:247], v5 offset:58656
    s_waitcnt vmcnt(11) lgkmcnt(6)
    v_mfma_f32_16x16x32_bf16 v[24:27], v[232:235], v[96:99], v[24:27]
    ds_read_b64_tr_b16 v[224:225], v4 offset:57856
    s_waitcnt vmcnt(9)
    v_mfma_f32_16x16x32_bf16 v[28:31], v[232:235], v[100:103], v[28:31]
    ds_read_b64_tr_b16 v[226:227], v4 offset:58880
    s_waitcnt lgkmcnt(6)
    v_mfma_f32_16x16x32_bf16 v[32:35], v[236:239], v[96:99], v[32:35]
    ds_read_b64_tr_b16 v[228:229], v5 offset:57888
    v_mfma_f32_16x16x32_bf16 v[36:39], v[236:239], v[100:103], v[36:39]
    ds_read_b64_tr_b16 v[230:231], v5 offset:58912
    s_mov_b32 s23, 0x2800
    buffer_load_dwordx4 v[128:131], v7, s[8:11], s23 offen offset:1024 sc1
    s_waitcnt lgkmcnt(6)
    v_mfma_f32_16x16x32_bf16 v[40:43], v[240:243], v[96:99], v[40:43]
    ds_read_b64_tr_b16 v[232:233], v4 offset:58112
    v_mfma_f32_16x16x32_bf16 v[44:47], v[240:243], v[100:103], v[44:47]
    ds_read_b64_tr_b16 v[234:235], v4 offset:59136
    s_waitcnt lgkmcnt(6)
    v_mfma_f32_16x16x32_bf16 v[48:51], v[244:247], v[96:99], v[48:51]
    ds_read_b64_tr_b16 v[236:237], v5 offset:58144
    v_mfma_f32_16x16x32_bf16 v[52:55], v[244:247], v[100:103], v[52:55]
    ds_read_b64_tr_b16 v[238:239], v5 offset:59168
    s_waitcnt lgkmcnt(6)
    v_mfma_f32_16x16x32_bf16 v[56:59], v[224:227], v[96:99], v[56:59]
    v_mfma_f32_16x16x32_bf16 v[60:63], v[224:227], v[100:103], v[60:63]
    s_waitcnt vmcnt(9)
    s_barrier
    ds_read_b64_tr_b16 v[240:241], v4 offset:0
    ds_read_b64_tr_b16 v[242:243], v4 offset:1024
    s_waitcnt lgkmcnt(6)
    v_mfma_f32_16x16x32_bf16 v[64:67], v[228:231], v[96:99], v[64:67]
    ds_read_b64_tr_b16 v[244:245], v5 offset:32
    v_mfma_f32_16x16x32_bf16 v[68:71], v[228:231], v[100:103], v[68:71]
    s_add_u32 s22, s19, 0x300000
    s_add_u32 m0, s20, 0x8000
    s_nop 0
    buffer_load_dwordx4 v3, s[4:7], s22 offen lds
    ds_read_b64_tr_b16 v[246:247], v5 offset:1056
    s_mov_b32 s23, 0xa800
    buffer_load_dwordx4 v[132:135], v7, s[8:11], s23 offen offset:1024 sc1
    s_waitcnt lgkmcnt(6)
    v_mfma_f32_16x16x32_bf16 v[72:75], v[232:235], v[96:99], v[72:75]
    ds_read_b64_tr_b16 v[224:225], v4 offset:256
    v_mfma_f32_16x16x32_bf16 v[76:79], v[232:235], v[100:103], v[76:79]
    ds_read_b64_tr_b16 v[226:227], v4 offset:1280
    s_waitcnt lgkmcnt(6)
    v_mfma_f32_16x16x32_bf16 v[80:83], v[236:239], v[96:99], v[80:83]
    ds_read_b64_tr_b16 v[228:229], v5 offset:288
    v_mfma_f32_16x16x32_bf16 v[84:87], v[236:239], v[100:103], v[84:87]
    ds_read_b64_tr_b16 v[230:231], v5 offset:1312
    s_waitcnt vmcnt(10) lgkmcnt(6)
    v_mfma_f32_16x16x32_bf16 v[24:27], v[240:243], v[104:107], v[24:27]
    ds_read_b64_tr_b16 v[232:233], v4 offset:512
    s_waitcnt vmcnt(9)
    v_mfma_f32_16x16x32_bf16 v[28:31], v[240:243], v[108:111], v[28:31]
    ds_read_b64_tr_b16 v[234:235], v4 offset:1536
    s_waitcnt lgkmcnt(6)
    v_mfma_f32_16x16x32_bf16 v[32:35], v[244:247], v[104:107], v[32:35]
    ds_read_b64_tr_b16 v[236:237], v5 offset:544
    v_mfma_f32_16x16x32_bf16 v[36:39], v[244:247], v[108:111], v[36:39]
    s_add_u32 s22, s19, 0x308000
    s_add_u32 m0, s20, 0x8400
    s_nop 0
    buffer_load_dwordx4 v3, s[4:7], s22 offen lds
    ds_read_b64_tr_b16 v[238:239], v5 offset:1568
    s_mov_b32 s23, 0x3000
    buffer_load_dwordx4 v[88:91], v7, s[8:11], s23 offen offset:0 sc1
    s_waitcnt lgkmcnt(6)
    v_mfma_f32_16x16x32_bf16 v[40:43], v[224:227], v[104:107], v[40:43]
    ds_read_b64_tr_b16 v[240:241], v4 offset:768
    v_mfma_f32_16x16x32_bf16 v[44:47], v[224:227], v[108:111], v[44:47]
    ds_read_b64_tr_b16 v[242:243], v4 offset:1792
    s_waitcnt lgkmcnt(6)
    v_mfma_f32_16x16x32_bf16 v[48:51], v[228:231], v[104:107], v[48:51]
    ds_read_b64_tr_b16 v[244:245], v5 offset:800
    v_mfma_f32_16x16x32_bf16 v[52:55], v[228:231], v[108:111], v[52:55]
    ds_read_b64_tr_b16 v[246:247], v5 offset:1824
    s_waitcnt lgkmcnt(6)
    v_mfma_f32_16x16x32_bf16 v[56:59], v[232:235], v[104:107], v[56:59]
    ds_read_b64_tr_b16 v[224:225], v4 offset:8192
    v_mfma_f32_16x16x32_bf16 v[60:63], v[232:235], v[108:111], v[60:63]
    ds_read_b64_tr_b16 v[226:227], v4 offset:9216
    s_waitcnt lgkmcnt(6)
    v_mfma_f32_16x16x32_bf16 v[64:67], v[236:239], v[104:107], v[64:67]
    ds_read_b64_tr_b16 v[228:229], v5 offset:8224
    v_mfma_f32_16x16x32_bf16 v[68:71], v[236:239], v[108:111], v[68:71]
    ds_read_b64_tr_b16 v[230:231], v5 offset:9248
    s_mov_b32 s23, 0xb000
    buffer_load_dwordx4 v[92:95], v7, s[8:11], s23 offen offset:0 sc1
    s_waitcnt lgkmcnt(6)
    v_mfma_f32_16x16x32_bf16 v[72:75], v[240:243], v[104:107], v[72:75]
    ds_read_b64_tr_b16 v[232:233], v4 offset:8448
    v_mfma_f32_16x16x32_bf16 v[76:79], v[240:243], v[108:111], v[76:79]
    ds_read_b64_tr_b16 v[234:235], v4 offset:9472
    s_waitcnt lgkmcnt(6)
    v_mfma_f32_16x16x32_bf16 v[80:83], v[244:247], v[104:107], v[80:83]
    ds_read_b64_tr_b16 v[236:237], v5 offset:8480
    v_mfma_f32_16x16x32_bf16 v[84:87], v[244:247], v[108:111], v[84:87]
    ds_read_b64_tr_b16 v[238:239], v5 offset:9504
    s_waitcnt vmcnt(11) lgkmcnt(6)
    v_mfma_f32_16x16x32_bf16 v[24:27], v[224:227], v[112:115], v[24:27]
    ds_read_b64_tr_b16 v[240:241], v4 offset:8704
    s_waitcnt vmcnt(9)
    v_mfma_f32_16x16x32_bf16 v[28:31], v[224:227], v[116:119], v[28:31]
    ds_read_b64_tr_b16 v[242:243], v4 offset:9728
    s_waitcnt lgkmcnt(6)
    v_mfma_f32_16x16x32_bf16 v[32:35], v[228:231], v[112:115], v[32:35]
    ds_read_b64_tr_b16 v[244:245], v5 offset:8736
    v_mfma_f32_16x16x32_bf16 v[36:39], v[228:231], v[116:119], v[36:39]
    ds_read_b64_tr_b16 v[246:247], v5 offset:9760
    s_mov_b32 s23, 0x3000
    buffer_load_dwordx4 v[96:99], v7, s[8:11], s23 offen offset:1024 sc1
    s_waitcnt lgkmcnt(6)
    v_mfma_f32_16x16x32_bf16 v[40:43], v[232:235], v[112:115], v[40:43]
    ds_read_b64_tr_b16 v[224:225], v4 offset:8960
    v_mfma_f32_16x16x32_bf16 v[44:47], v[232:235], v[116:119], v[44:47]
    ds_read_b64_tr_b16 v[226:227], v4 offset:9984
    s_waitcnt lgkmcnt(6)
    v_mfma_f32_16x16x32_bf16 v[48:51], v[236:239], v[112:115], v[48:51]
    ds_read_b64_tr_b16 v[228:229], v5 offset:8992
    v_mfma_f32_16x16x32_bf16 v[52:55], v[236:239], v[116:119], v[52:55]
    ds_read_b64_tr_b16 v[230:231], v5 offset:10016
    s_waitcnt lgkmcnt(6)
    v_mfma_f32_16x16x32_bf16 v[56:59], v[240:243], v[112:115], v[56:59]
    v_mfma_f32_16x16x32_bf16 v[60:63], v[240:243], v[116:119], v[60:63]
    s_waitcnt vmcnt(9)
    s_barrier
    ds_read_b64_tr_b16 v[232:233], v4 offset:16384
    ds_read_b64_tr_b16 v[234:235], v4 offset:17408
    s_waitcnt lgkmcnt(6)
    v_mfma_f32_16x16x32_bf16 v[64:67], v[244:247], v[112:115], v[64:67]
    ds_read_b64_tr_b16 v[236:237], v5 offset:16416
    v_mfma_f32_16x16x32_bf16 v[68:71], v[244:247], v[116:119], v[68:71]
    s_add_u32 s22, s19, 0x380000
    s_add_u32 m0, s20, 0xc000
    s_nop 0
    buffer_load_dwordx4 v3, s[4:7], s22 offen lds
    ds_read_b64_tr_b16 v[238:239], v5 offset:17440
    s_mov_b32 s23, 0xb000
    buffer_load_dwordx4 v[100:103], v7, s[8:11], s23 offen offset:1024 sc1
    s_waitcnt lgkmcnt(6)
    v_mfma_f32_16x16x32_bf16 v[72:75], v[224:227], v[112:115], v[72:75]
    ds_read_b64_tr_b16 v[240:241], v4 offset:16640
    v_mfma_f32_16x16x32_bf16 v[76:79], v[224:227], v[116:119], v[76:79]
    ds_read_b64_tr_b16 v[242:243], v4 offset:17664
    s_waitcnt lgkmcnt(6)
    v_mfma_f32_16x16x32_bf16 v[80:83], v[228:231], v[112:115], v[80:83]
    ds_read_b64_tr_b16 v[244:245], v5 offset:16672
    v_mfma_f32_16x16x32_bf16 v[84:87], v[228:231], v[116:119], v[84:87]
    ds_read_b64_tr_b16 v[246:247], v5 offset:17696
    s_waitcnt vmcnt(10) lgkmcnt(6)
    v_mfma_f32_16x16x32_bf16 v[24:27], v[232:235], v[120:123], v[24:27]
    ds_read_b64_tr_b16 v[224:225], v4 offset:16896
    s_waitcnt vmcnt(9)
    v_mfma_f32_16x16x32_bf16 v[28:31], v[232:235], v[124:127], v[28:31]
    ds_read_b64_tr_b16 v[226:227], v4 offset:17920
    s_waitcnt lgkmcnt(6)
    v_mfma_f32_16x16x32_bf16 v[32:35], v[236:239], v[120:123], v[32:35]
    ds_read_b64_tr_b16 v[228:229], v5 offset:16928
    v_mfma_f32_16x16x32_bf16 v[36:39], v[236:239], v[124:127], v[36:39]
    s_add_u32 s22, s19, 0x388000
    s_add_u32 m0, s20, 0xc400
    s_nop 0
    buffer_load_dwordx4 v3, s[4:7], s22 offen lds
    ds_read_b64_tr_b16 v[230:231], v5 offset:17952
    s_mov_b32 s23, 0x3800
    buffer_load_dwordx4 v[104:107], v7, s[8:11], s23 offen offset:0 sc1
    s_waitcnt lgkmcnt(6)
    v_mfma_f32_16x16x32_bf16 v[40:43], v[240:243], v[120:123], v[40:43]
    ds_read_b64_tr_b16 v[232:233], v4 offset:17152
    v_mfma_f32_16x16x32_bf16 v[44:47], v[240:243], v[124:127], v[44:47]
    ds_read_b64_tr_b16 v[234:235], v4 offset:18176
    s_waitcnt lgkmcnt(6)
    v_mfma_f32_16x16x32_bf16 v[48:51], v[244:247], v[120:123], v[48:51]
    ds_read_b64_tr_b16 v[236:237], v5 offset:17184
    v_mfma_f32_16x16x32_bf16 v[52:55], v[244:247], v[124:127], v[52:55]
    ds_read_b64_tr_b16 v[238:239], v5 offset:18208
    s_waitcnt lgkmcnt(6)
    v_mfma_f32_16x16x32_bf16 v[56:59], v[224:227], v[120:123], v[56:59]
    ds_read_b64_tr_b16 v[240:241], v4 offset:24576
    v_mfma_f32_16x16x32_bf16 v[60:63], v[224:227], v[124:127], v[60:63]
    ds_read_b64_tr_b16 v[242:243], v4 offset:25600
    s_waitcnt lgkmcnt(6)
    v_mfma_f32_16x16x32_bf16 v[64:67], v[228:231], v[120:123], v[64:67]
    ds_read_b64_tr_b16 v[244:245], v5 offset:24608
    v_mfma_f32_16x16x32_bf16 v[68:71], v[228:231], v[124:127], v[68:71]
    ds_read_b64_tr_b16 v[246:247], v5 offset:25632
    s_mov_b32 s23, 0xb800
    buffer_load_dwordx4 v[108:111], v7, s[8:11], s23 offen offset:0 sc1
    s_waitcnt lgkmcnt(6)
    v_mfma_f32_16x16x32_bf16 v[72:75], v[232:235], v[120:123], v[72:75]
    ds_read_b64_tr_b16 v[224:225], v4 offset:24832
    v_mfma_f32_16x16x32_bf16 v[76:79], v[232:235], v[124:127], v[76:79]
    ds_read_b64_tr_b16 v[226:227], v4 offset:25856
    s_waitcnt lgkmcnt(6)
    v_mfma_f32_16x16x32_bf16 v[80:83], v[236:239], v[120:123], v[80:83]
    ds_read_b64_tr_b16 v[228:229], v5 offset:24864
    v_mfma_f32_16x16x32_bf16 v[84:87], v[236:239], v[124:127], v[84:87]
    ds_read_b64_tr_b16 v[230:231], v5 offset:25888
    s_waitcnt vmcnt(11) lgkmcnt(6)
    v_mfma_f32_16x16x32_bf16 v[24:27], v[240:243], v[128:131], v[24:27]
    ds_read_b64_tr_b16 v[232:233], v4 offset:25088
    s_waitcnt vmcnt(9)
    v_mfma_f32_16x16x32_bf16 v[28:31], v[240:243], v[132:135], v[28:31]
    ds_read_b64_tr_b16 v[234:235], v4 offset:26112
    s_waitcnt lgkmcnt(6)
    v_mfma_f32_16x16x32_bf16 v[32:35], v[244:247], v[128:131], v[32:35]
    ds_read_b64_tr_b16 v[236:237], v5 offset:25120
    v_mfma_f32_16x16x32_bf16 v[36:39], v[244:247], v[132:135], v[36:39]
    ds_read_b64_tr_b16 v[238:239], v5 offset:26144
    s_mov_b32 s23, 0x3800
    buffer_load_dwordx4 v[112:115], v7, s[8:11], s23 offen offset:1024 sc1
    s_waitcnt lgkmcnt(6)
    v_mfma_f32_16x16x32_bf16 v[40:43], v[224:227], v[128:131], v[40:43]
    ds_read_b64_tr_b16 v[240:241], v4 offset:25344
    v_mfma_f32_16x16x32_bf16 v[44:47], v[224:227], v[132:135], v[44:47]
    ds_read_b64_tr_b16 v[242:243], v4 offset:26368
    s_waitcnt lgkmcnt(6)
    v_mfma_f32_16x16x32_bf16 v[48:51], v[228:231], v[128:131], v[48:51]
    ds_read_b64_tr_b16 v[244:245], v5 offset:25376
    v_mfma_f32_16x16x32_bf16 v[52:55], v[228:231], v[132:135], v[52:55]
    ds_read_b64_tr_b16 v[246:247], v5 offset:26400
    s_waitcnt lgkmcnt(6)
    v_mfma_f32_16x16x32_bf16 v[56:59], v[232:235], v[128:131], v[56:59]
    v_mfma_f32_16x16x32_bf16 v[60:63], v[232:235], v[132:135], v[60:63]
    s_waitcnt vmcnt(9)
    s_barrier
    ds_read_b64_tr_b16 v[224:225], v4 offset:32768
    ds_read_b64_tr_b16 v[226:227], v4 offset:33792
    s_waitcnt lgkmcnt(6)
    v_mfma_f32_16x16x32_bf16 v[64:67], v[236:239], v[128:131], v[64:67]
    ds_read_b64_tr_b16 v[228:229], v5 offset:32800
    v_mfma_f32_16x16x32_bf16 v[68:71], v[236:239], v[132:135], v[68:71]
    s_add_u32 s22, s19, 0x400000
    s_add_u32 m0, s20, 0x0
    s_nop 0
    buffer_load_dwordx4 v3, s[4:7], s22 offen lds
    ds_read_b64_tr_b16 v[230:231], v5 offset:33824
    s_mov_b32 s23, 0xb800
    buffer_load_dwordx4 v[116:119], v7, s[8:11], s23 offen offset:1024 sc1
    s_waitcnt lgkmcnt(6)
    v_mfma_f32_16x16x32_bf16 v[72:75], v[240:243], v[128:131], v[72:75]
    ds_read_b64_tr_b16 v[232:233], v4 offset:33024
    v_mfma_f32_16x16x32_bf16 v[76:79], v[240:243], v[132:135], v[76:79]
    ds_read_b64_tr_b16 v[234:235], v4 offset:34048
    s_waitcnt lgkmcnt(6)
    v_mfma_f32_16x16x32_bf16 v[80:83], v[244:247], v[128:131], v[80:83]
    ds_read_b64_tr_b16 v[236:237], v5 offset:33056
    v_mfma_f32_16x16x32_bf16 v[84:87], v[244:247], v[132:135], v[84:87]
    ds_read_b64_tr_b16 v[238:239], v5 offset:34080
    s_waitcnt vmcnt(10) lgkmcnt(6)
    v_mfma_f32_16x16x32_bf16 v[24:27], v[224:227], v[88:91], v[24:27]
    ds_read_b64_tr_b16 v[240:241], v4 offset:33280
    s_waitcnt vmcnt(9)
    v_mfma_f32_16x16x32_bf16 v[28:31], v[224:227], v[92:95], v[28:31]
    ds_read_b64_tr_b16 v[242:243], v4 offset:34304
    s_waitcnt lgkmcnt(6)
    v_mfma_f32_16x16x32_bf16 v[32:35], v[228:231], v[88:91], v[32:35]
    ds_read_b64_tr_b16 v[244:245], v5 offset:33312
    v_mfma_f32_16x16x32_bf16 v[36:39], v[228:231], v[92:95], v[36:39]
    s_add_u32 s22, s19, 0x408000
    s_add_u32 m0, s20, 0x400
    s_nop 0
    buffer_load_dwordx4 v3, s[4:7], s22 offen lds
    ds_read_b64_tr_b16 v[246:247], v5 offset:34336
    s_mov_b32 s23, 0x4000
    buffer_load_dwordx4 v[120:123], v7, s[8:11], s23 offen offset:0 sc1
    s_waitcnt lgkmcnt(6)
    v_mfma_f32_16x16x32_bf16 v[40:43], v[232:235], v[88:91], v[40:43]
    ds_read_b64_tr_b16 v[224:225], v4 offset:33536
    v_mfma_f32_16x16x32_bf16 v[44:47], v[232:235], v[92:95], v[44:47]
    ds_read_b64_tr_b16 v[226:227], v4 offset:34560
    s_waitcnt lgkmcnt(6)
    v_mfma_f32_16x16x32_bf16 v[48:51], v[236:239], v[88:91], v[48:51]
    ds_read_b64_tr_b16 v[228:229], v5 offset:33568
    v_mfma_f32_16x16x32_bf16 v[52:55], v[236:239], v[92:95], v[52:55]
    ds_read_b64_tr_b16 v[230:231], v5 offset:34592
    s_waitcnt lgkmcnt(6)
    v_mfma_f32_16x16x32_bf16 v[56:59], v[240:243], v[88:91], v[56:59]
    ds_read_b64_tr_b16 v[232:233], v4 offset:40960
    v_mfma_f32_16x16x32_bf16 v[60:63], v[240:243], v[92:95], v[60:63]
    ds_read_b64_tr_b16 v[234:235], v4 offset:41984
    s_waitcnt lgkmcnt(6)
    v_mfma_f32_16x16x32_bf16 v[64:67], v[244:247], v[88:91], v[64:67]
    ds_read_b64_tr_b16 v[236:237], v5 offset:40992
    v_mfma_f32_16x16x32_bf16 v[68:71], v[244:247], v[92:95], v[68:71]
    ds_read_b64_tr_b16 v[238:239], v5 offset:42016
    s_mov_b32 s23, 0xc000
    buffer_load_dwordx4 v[124:127], v7, s[8:11], s23 offen offset:0 sc1
    s_waitcnt lgkmcnt(6)
    v_mfma_f32_16x16x32_bf16 v[72:75], v[224:227], v[88:91], v[72:75]
    ds_read_b64_tr_b16 v[240:241], v4 offset:41216
    v_lshrrev_b32 v21, 4, v1
    v_lshlrev_b32 v21, 9, v21
    v_and_b32 v20, 15, v1
    v_lshl_add_u32 v21, v20, 4, v21
    s_lshr_b32 s18, s12, 3
    s_lshl_b32 s18, s18, 11
    s_add_u32 s18, s18, 0x528100
    buffer_load_dwordx4 v[12:15], v21, s[8:11], s18 offen sc1
    v_mfma_f32_16x16x32_bf16 v[76:79], v[224:227], v[92:95], v[76:79]
    ds_read_b64_tr_b16 v[242:243], v4 offset:42240
    s_waitcnt lgkmcnt(6)
    v_mfma_f32_16x16x32_bf16 v[80:83], v[228:231], v[88:91], v[80:83]
    ds_read_b64_tr_b16 v[244:245], v5 offset:41248
    v_mfma_f32_16x16x32_bf16 v[84:87], v[228:231], v[92:95], v[84:87]
    ds_read_b64_tr_b16 v[246:247], v5 offset:42272
    s_waitcnt vmcnt(12) lgkmcnt(6)
    v_mfma_f32_16x16x32_bf16 v[24:27], v[232:235], v[96:99], v[24:27]
    ds_read_b64_tr_b16 v[224:225], v4 offset:41472
    s_waitcnt vmcnt(10)
    v_mfma_f32_16x16x32_bf16 v[28:31], v[232:235], v[100:103], v[28:31]
    ds_read_b64_tr_b16 v[226:227], v4 offset:42496
    s_waitcnt lgkmcnt(6)
    v_mfma_f32_16x16x32_bf16 v[32:35], v[236:239], v[96:99], v[32:35]
    ds_read_b64_tr_b16 v[228:229], v5 offset:41504
    v_mfma_f32_16x16x32_bf16 v[36:39], v[236:239], v[100:103], v[36:39]
    ds_read_b64_tr_b16 v[230:231], v5 offset:42528
    s_mov_b32 s23, 0x4000
    buffer_load_dwordx4 v[128:131], v7, s[8:11], s23 offen offset:1024 sc1
    s_waitcnt lgkmcnt(6)
    v_mfma_f32_16x16x32_bf16 v[40:43], v[240:243], v[96:99], v[40:43]
    ds_read_b64_tr_b16 v[232:233], v4 offset:41728
    v_mfma_f32_16x16x32_bf16 v[44:47], v[240:243], v[100:103], v[44:47]
    ds_read_b64_tr_b16 v[234:235], v4 offset:42752
    s_waitcnt lgkmcnt(6)
    v_mfma_f32_16x16x32_bf16 v[48:51], v[244:247], v[96:99], v[48:51]
    ds_read_b64_tr_b16 v[236:237], v5 offset:41760
    v_mfma_f32_16x16x32_bf16 v[52:55], v[244:247], v[100:103], v[52:55]
    ds_read_b64_tr_b16 v[238:239], v5 offset:42784
    s_waitcnt lgkmcnt(6)
    v_mfma_f32_16x16x32_bf16 v[56:59], v[224:227], v[96:99], v[56:59]
    v_mfma_f32_16x16x32_bf16 v[60:63], v[224:227], v[100:103], v[60:63]
    s_waitcnt vmcnt(10)
    s_barrier
    ds_read_b64_tr_b16 v[240:241], v4 offset:49152
    ds_read_b64_tr_b16 v[242:243], v4 offset:50176
    s_waitcnt lgkmcnt(6)
    v_mfma_f32_16x16x32_bf16 v[64:67], v[228:231], v[96:99], v[64:67]
    ds_read_b64_tr_b16 v[244:245], v5 offset:49184
    v_mfma_f32_16x16x32_bf16 v[68:71], v[228:231], v[100:103], v[68:71]
    s_add_u32 s22, s19, 0x480000
    s_add_u32 m0, s20, 0x4000
    s_nop 0
    buffer_load_dwordx4 v3, s[4:7], s22 offen lds
    ds_read_b64_tr_b16 v[246:247], v5 offset:50208
    s_mov_b32 s23, 0xc000
    buffer_load_dwordx4 v[132:135], v7, s[8:11], s23 offen offset:1024 sc1
    s_waitcnt lgkmcnt(6)
    v_mfma_f32_16x16x32_bf16 v[72:75], v[232:235], v[96:99], v[72:75]
    ds_read_b64_tr_b16 v[224:225], v4 offset:49408
    v_mfma_f32_16x16x32_bf16 v[76:79], v[232:235], v[100:103], v[76:79]
    ds_read_b64_tr_b16 v[226:227], v4 offset:50432
    s_waitcnt lgkmcnt(6)
    v_mfma_f32_16x16x32_bf16 v[80:83], v[236:239], v[96:99], v[80:83]
    ds_read_b64_tr_b16 v[228:229], v5 offset:49440
    v_mfma_f32_16x16x32_bf16 v[84:87], v[236:239], v[100:103], v[84:87]
    ds_read_b64_tr_b16 v[230:231], v5 offset:50464
    s_waitcnt vmcnt(11) lgkmcnt(6)
    v_mfma_f32_16x16x32_bf16 v[24:27], v[240:243], v[104:107], v[24:27]
    ds_read_b64_tr_b16 v[232:233], v4 offset:49664
    s_waitcnt vmcnt(10)
    v_mfma_f32_16x16x32_bf16 v[28:31], v[240:243], v[108:111], v[28:31]
    ds_read_b64_tr_b16 v[234:235], v4 offset:50688
    s_waitcnt lgkmcnt(6)
    v_mfma_f32_16x16x32_bf16 v[32:35], v[244:247], v[104:107], v[32:35]
    ds_read_b64_tr_b16 v[236:237], v5 offset:49696
    v_mfma_f32_16x16x32_bf16 v[36:39], v[244:247], v[108:111], v[36:39]
    s_add_u32 s22, s19, 0x488000
    s_add_u32 m0, s20, 0x4400
    s_nop 0
    buffer_load_dwordx4 v3, s[4:7], s22 offen lds
    ds_read_b64_tr_b16 v[238:239], v5 offset:50720
    s_mov_b32 s23, 0x4800
    buffer_load_dwordx4 v[88:91], v7, s[8:11], s23 offen offset:0 sc1
    s_waitcnt lgkmcnt(6)
    v_mfma_f32_16x16x32_bf16 v[40:43], v[224:227], v[104:107], v[40:43]
    ds_read_b64_tr_b16 v[240:241], v4 offset:49920
    v_mfma_f32_16x16x32_bf16 v[44:47], v[224:227], v[108:111], v[44:47]
    ds_read_b64_tr_b16 v[242:243], v4 offset:50944
    s_waitcnt lgkmcnt(6)
    v_mfma_f32_16x16x32_bf16 v[48:51], v[228:231], v[104:107], v[48:51]
    ds_read_b64_tr_b16 v[244:245], v5 offset:49952
    v_mfma_f32_16x16x32_bf16 v[52:55], v[228:231], v[108:111], v[52:55]
    ds_read_b64_tr_b16 v[246:247], v5 offset:50976
    s_waitcnt lgkmcnt(6)
    v_mfma_f32_16x16x32_bf16 v[56:59], v[232:235], v[104:107], v[56:59]
    ds_read_b64_tr_b16 v[224:225], v4 offset:57344
    v_mfma_f32_16x16x32_bf16 v[60:63], v[232:235], v[108:111], v[60:63]
    ds_read_b64_tr_b16 v[226:227], v4 offset:58368
    s_waitcnt lgkmcnt(6)
    v_mfma_f32_16x16x32_bf16 v[64:67], v[236:239], v[104:107], v[64:67]
    ds_read_b64_tr_b16 v[228:229], v5 offset:57376
    v_mfma_f32_16x16x32_bf16 v[68:71], v[236:239], v[108:111], v[68:71]
    ds_read_b64_tr_b16 v[230:231], v5 offset:58400
    s_mov_b32 s23, 0xc800
    buffer_load_dwordx4 v[92:95], v7, s[8:11], s23 offen offset:0 sc1
    s_waitcnt lgkmcnt(6)
    v_mfma_f32_16x16x32_bf16 v[72:75], v[240:243], v[104:107], v[72:75]
    ds_read_b64_tr_b16 v[232:233], v4 offset:57600
    v_mfma_f32_16x16x32_bf16 v[76:79], v[240:243], v[108:111], v[76:79]
    ds_read_b64_tr_b16 v[234:235], v4 offset:58624
    s_waitcnt lgkmcnt(6)
    v_mfma_f32_16x16x32_bf16 v[80:83], v[244:247], v[104:107], v[80:83]
    ds_read_b64_tr_b16 v[236:237], v5 offset:57632
    v_mfma_f32_16x16x32_bf16 v[84:87], v[244:247], v[108:111], v[84:87]
    ds_read_b64_tr_b16 v[238:239], v5 offset:58656
    s_waitcnt vmcnt(12) lgkmcnt(6)
    v_mfma_f32_16x16x32_bf16 v[24:27], v[224:227], v[112:115], v[24:27]
    ds_read_b64_tr_b16 v[240:241], v4 offset:57856
    s_waitcnt vmcnt(10)
    v_mfma_f32_16x16x32_bf16 v[28:31], v[224:227], v[116:119], v[28:31]
    ds_read_b64_tr_b16 v[242:243], v4 offset:58880
    s_waitcnt lgkmcnt(6)
    v_mfma_f32_16x16x32_bf16 v[32:35], v[228:231], v[112:115], v[32:35]
    ds_read_b64_tr_b16 v[244:245], v5 offset:57888
    v_mfma_f32_16x16x32_bf16 v[36:39], v[228:231], v[116:119], v[36:39]
    ds_read_b64_tr_b16 v[246:247], v5 offset:58912
    s_mov_b32 s23, 0x4800
    buffer_load_dwordx4 v[96:99], v7, s[8:11], s23 offen offset:1024 sc1
    s_waitcnt lgkmcnt(6)
    v_mfma_f32_16x16x32_bf16 v[40:43], v[232:235], v[112:115], v[40:43]
    ds_read_b64_tr_b16 v[224:225], v4 offset:58112
    v_mfma_f32_16x16x32_bf16 v[44:47], v[232:235], v[116:119], v[44:47]
    ds_read_b64_tr_b16 v[226:227], v4 offset:59136
    s_waitcnt lgkmcnt(6)
    v_mfma_f32_16x16x32_bf16 v[48:51], v[236:239], v[112:115], v[48:51]
    ds_read_b64_tr_b16 v[228:229], v5 offset:58144
    v_mfma_f32_16x16x32_bf16 v[52:55], v[236:239], v[116:119], v[52:55]
    ds_read_b64_tr_b16 v[230:231], v5 offset:59168
    s_waitcnt lgkmcnt(6)
    v_mfma_f32_16x16x32_bf16 v[56:59], v[240:243], v[112:115], v[56:59]
    v_mfma_f32_16x16x32_bf16 v[60:63], v[240:243], v[116:119], v[60:63]
    s_waitcnt vmcnt(10)
    s_barrier
    ds_read_b64_tr_b16 v[232:233], v4 offset:0
    ds_read_b64_tr_b16 v[234:235], v4 offset:1024
    s_waitcnt lgkmcnt(6)
    v_mfma_f32_16x16x32_bf16 v[64:67], v[244:247], v[112:115], v[64:67]
    ds_read_b64_tr_b16 v[236:237], v5 offset:32
    v_mfma_f32_16x16x32_bf16 v[68:71], v[244:247], v[116:119], v[68:71]
    s_add_u32 s22, s19, 0x500000
    s_add_u32 m0, s20, 0x8000
    s_nop 0
    buffer_load_dwordx4 v3, s[4:7], s22 offen lds
    ds_read_b64_tr_b16 v[238:239], v5 offset:1056
    s_mov_b32 s23, 0xc800
    buffer_load_dwordx4 v[100:103], v7, s[8:11], s23 offen offset:1024 sc1
    s_waitcnt lgkmcnt(6)
    v_mfma_f32_16x16x32_bf16 v[72:75], v[224:227], v[112:115], v[72:75]
    ds_read_b64_tr_b16 v[240:241], v4 offset:256
    v_mfma_f32_16x16x32_bf16 v[76:79], v[224:227], v[116:119], v[76:79]
    ds_read_b64_tr_b16 v[242:243], v4 offset:1280
    s_waitcnt lgkmcnt(6)
    v_mfma_f32_16x16x32_bf16 v[80:83], v[228:231], v[112:115], v[80:83]
    ds_read_b64_tr_b16 v[244:245], v5 offset:288
    v_mfma_f32_16x16x32_bf16 v[84:87], v[228:231], v[116:119], v[84:87]
    ds_read_b64_tr_b16 v[246:247], v5 offset:1312
    s_waitcnt vmcnt(11) lgkmcnt(6)
    v_mfma_f32_16x16x32_bf16 v[24:27], v[232:235], v[120:123], v[24:27]
    ds_read_b64_tr_b16 v[224:225], v4 offset:512
    s_waitcnt vmcnt(10)
    v_mfma_f32_16x16x32_bf16 v[28:31], v[232:235], v[124:127], v[28:31]
    ds_read_b64_tr_b16 v[226:227], v4 offset:1536
    s_waitcnt lgkmcnt(6)
    v_mfma_f32_16x16x32_bf16 v[32:35], v[236:239], v[120:123], v[32:35]
    ds_read_b64_tr_b16 v[228:229], v5 offset:544
    v_mfma_f32_16x16x32_bf16 v[36:39], v[236:239], v[124:127], v[36:39]
    s_add_u32 s22, s19, 0x508000
    s_add_u32 m0, s20, 0x8400
    s_nop 0
    buffer_load_dwordx4 v3, s[4:7], s22 offen lds
    ds_read_b64_tr_b16 v[230:231], v5 offset:1568
    s_mov_b32 s23, 0x5000
    buffer_load_dwordx4 v[104:107], v7, s[8:11], s23 offen offset:0 sc1
    s_waitcnt lgkmcnt(6)
    v_mfma_f32_16x16x32_bf16 v[40:43], v[240:243], v[120:123], v[40:43]
    ds_read_b64_tr_b16 v[232:233], v4 offset:768
    v_mfma_f32_16x16x32_bf16 v[44:47], v[240:243], v[124:127], v[44:47]
    ds_read_b64_tr_b16 v[234:235], v4 offset:1792
    s_waitcnt lgkmcnt(6)
    v_mfma_f32_16x16x32_bf16 v[48:51], v[244:247], v[120:123], v[48:51]
    ds_read_b64_tr_b16 v[236:237], v5 offset:800
    v_mfma_f32_16x16x32_bf16 v[52:55], v[244:247], v[124:127], v[52:55]
    ds_read_b64_tr_b16 v[238:239], v5 offset:1824
    s_waitcnt lgkmcnt(6)
    v_mfma_f32_16x16x32_bf16 v[56:59], v[224:227], v[120:123], v[56:59]
    ds_read_b64_tr_b16 v[240:241], v4 offset:8192
    v_mfma_f32_16x16x32_bf16 v[60:63], v[224:227], v[124:127], v[60:63]
    ds_read_b64_tr_b16 v[242:243], v4 offset:9216
    s_waitcnt lgkmcnt(6)
    v_mfma_f32_16x16x32_bf16 v[64:67], v[228:231], v[120:123], v[64:67]
    ds_read_b64_tr_b16 v[244:245], v5 offset:8224
    v_mfma_f32_16x16x32_bf16 v[68:71], v[228:231], v[124:127], v[68:71]
    ds_read_b64_tr_b16 v[246:247], v5 offset:9248
    s_mov_b32 s23, 0xd000
    buffer_load_dwordx4 v[108:111], v7, s[8:11], s23 offen offset:0 sc1
    s_waitcnt lgkmcnt(6)
    v_mfma_f32_16x16x32_bf16 v[72:75], v[232:235], v[120:123], v[72:75]
    ds_read_b64_tr_b16 v[224:225], v4 offset:8448
    v_mfma_f32_16x16x32_bf16 v[76:79], v[232:235], v[124:127], v[76:79]
    ds_read_b64_tr_b16 v[226:227], v4 offset:9472
    s_waitcnt lgkmcnt(6)
    v_mfma_f32_16x16x32_bf16 v[80:83], v[236:239], v[120:123], v[80:83]
    ds_read_b64_tr_b16 v[228:229], v5 offset:8480
    v_mfma_f32_16x16x32_bf16 v[84:87], v[236:239], v[124:127], v[84:87]
    ds_read_b64_tr_b16 v[230:231], v5 offset:9504
    s_waitcnt vmcnt(11) lgkmcnt(6)
    v_mfma_f32_16x16x32_bf16 v[24:27], v[240:243], v[128:131], v[24:27]
    ds_read_b64_tr_b16 v[232:233], v4 offset:8704
    s_waitcnt vmcnt(9)
    v_mfma_f32_16x16x32_bf16 v[28:31], v[240:243], v[132:135], v[28:31]
    ds_read_b64_tr_b16 v[234:235], v4 offset:9728
    s_waitcnt lgkmcnt(6)
    v_mfma_f32_16x16x32_bf16 v[32:35], v[244:247], v[128:131], v[32:35]
    ds_read_b64_tr_b16 v[236:237], v5 offset:8736
    v_mfma_f32_16x16x32_bf16 v[36:39], v[244:247], v[132:135], v[36:39]
    ds_read_b64_tr_b16 v[238:239], v5 offset:9760
    s_mov_b32 s23, 0x5000
    buffer_load_dwordx4 v[112:115], v7, s[8:11], s23 offen offset:1024 sc1
    s_waitcnt lgkmcnt(6)
    v_mfma_f32_16x16x32_bf16 v[40:43], v[224:227], v[128:131], v[40:43]
    ds_read_b64_tr_b16 v[240:241], v4 offset:8960
    v_mfma_f32_16x16x32_bf16 v[44:47], v[224:227], v[132:135], v[44:47]
    ds_read_b64_tr_b16 v[242:243], v4 offset:9984
    s_waitcnt lgkmcnt(6)
    v_mfma_f32_16x16x32_bf16 v[48:51], v[228:231], v[128:131], v[48:51]
    ds_read_b64_tr_b16 v[244:245], v5 offset:8992
    v_mfma_f32_16x16x32_bf16 v[52:55], v[228:231], v[132:135], v[52:55]
    ds_read_b64_tr_b16 v[246:247], v5 offset:10016
    s_waitcnt lgkmcnt(6)
    v_mfma_f32_16x16x32_bf16 v[56:59], v[232:235], v[128:131], v[56:59]
    v_mfma_f32_16x16x32_bf16 v[60:63], v[232:235], v[132:135], v[60:63]
    s_waitcnt vmcnt(9)
    s_barrier
    ds_read_b64_tr_b16 v[224:225], v4 offset:16384
    ds_read_b64_tr_b16 v[226:227], v4 offset:17408
    s_waitcnt lgkmcnt(6)
    v_mfma_f32_16x16x32_bf16 v[64:67], v[236:239], v[128:131], v[64:67]
    ds_read_b64_tr_b16 v[228:229], v5 offset:16416
    v_mfma_f32_16x16x32_bf16 v[68:71], v[236:239], v[132:135], v[68:71]
    s_add_u32 s22, s19, 0x580000
    s_add_u32 m0, s20, 0xc000
    s_nop 0
    buffer_load_dwordx4 v3, s[4:7], s22 offen lds
    ds_read_b64_tr_b16 v[230:231], v5 offset:17440
    s_mov_b32 s23, 0xd000
    buffer_load_dwordx4 v[116:119], v7, s[8:11], s23 offen offset:1024 sc1
    s_waitcnt lgkmcnt(6)
    v_mfma_f32_16x16x32_bf16 v[72:75], v[240:243], v[128:131], v[72:75]
    ds_read_b64_tr_b16 v[232:233], v4 offset:16640
    v_mfma_f32_16x16x32_bf16 v[76:79], v[240:243], v[132:135], v[76:79]
    ds_read_b64_tr_b16 v[234:235], v4 offset:17664
    s_waitcnt lgkmcnt(6)
    v_mfma_f32_16x16x32_bf16 v[80:83], v[244:247], v[128:131], v[80:83]
    ds_read_b64_tr_b16 v[236:237], v5 offset:16672
    v_mfma_f32_16x16x32_bf16 v[84:87], v[244:247], v[132:135], v[84:87]
    ds_read_b64_tr_b16 v[238:239], v5 offset:17696
    s_waitcnt vmcnt(10) lgkmcnt(6)
    v_mfma_f32_16x16x32_bf16 v[24:27], v[224:227], v[88:91], v[24:27]
    ds_read_b64_tr_b16 v[240:241], v4 offset:16896
    s_waitcnt vmcnt(9)
    v_mfma_f32_16x16x32_bf16 v[28:31], v[224:227], v[92:95], v[28:31]
    ds_read_b64_tr_b16 v[242:243], v4 offset:17920
    s_waitcnt lgkmcnt(6)
    v_mfma_f32_16x16x32_bf16 v[32:35], v[228:231], v[88:91], v[32:35]
    ds_read_b64_tr_b16 v[244:245], v5 offset:16928
    v_mfma_f32_16x16x32_bf16 v[36:39], v[228:231], v[92:95], v[36:39]
    s_add_u32 s22, s19, 0x588000
    s_add_u32 m0, s20, 0xc400
    s_nop 0
    buffer_load_dwordx4 v3, s[4:7], s22 offen lds
    ds_read_b64_tr_b16 v[246:247], v5 offset:17952
    s_mov_b32 s23, 0x5800
    buffer_load_dwordx4 v[120:123], v7, s[8:11], s23 offen offset:0 sc1
    s_waitcnt lgkmcnt(6)
    v_mfma_f32_16x16x32_bf16 v[40:43], v[232:235], v[88:91], v[40:43]
    ds_read_b64_tr_b16 v[224:225], v4 offset:17152
    v_mfma_f32_16x16x32_bf16 v[44:47], v[232:235], v[92:95], v[44:47]
    ds_read_b64_tr_b16 v[226:227], v4 offset:18176
    s_waitcnt lgkmcnt(6)
    v_mfma_f32_16x16x32_bf16 v[48:51], v[236:239], v[88:91], v[48:51]
    ds_read_b64_tr_b16 v[228:229], v5 offset:17184
    v_mfma_f32_16x16x32_bf16 v[52:55], v[236:239], v[92:95], v[52:55]
    ds_read_b64_tr_b16 v[230:231], v5 offset:18208
    s_waitcnt lgkmcnt(6)
    v_mfma_f32_16x16x32_bf16 v[56:59], v[240:243], v[88:91], v[56:59]
    ds_read_b64_tr_b16 v[232:233], v4 offset:24576
    v_mfma_f32_16x16x32_bf16 v[60:63], v[240:243], v[92:95], v[60:63]
    ds_read_b64_tr_b16 v[234:235], v4 offset:25600
    s_waitcnt lgkmcnt(6)
    v_mfma_f32_16x16x32_bf16 v[64:67], v[244:247], v[88:91], v[64:67]
    ds_read_b64_tr_b16 v[236:237], v5 offset:24608
    v_mfma_f32_16x16x32_bf16 v[68:71], v[244:247], v[92:95], v[68:71]
    ds_read_b64_tr_b16 v[238:239], v5 offset:25632
    s_mov_b32 s23, 0xd800
    buffer_load_dwordx4 v[124:127], v7, s[8:11], s23 offen offset:0 sc1
    s_waitcnt lgkmcnt(6)
    v_mfma_f32_16x16x32_bf16 v[72:75], v[224:227], v[88:91], v[72:75]
    ds_read_b64_tr_b16 v[240:241], v4 offset:24832
    v_xor_b32 v8, s28, v12
    v_xor_b32 v20, s28, v13
    v_or_b32 v8, v8, v20
    v_xor_b32 v20, s28, v14
    v_or_b32 v8, v8, v20
    v_xor_b32 v20, s28, v15
    v_or_b32 v8, v8, v20
    v_cmp_ne_u32 vcc, 0, v8
    s_cbranch_vccnz adaLN_cond__sliding_block_cached__moe_arch_mod__prompt_kernel_kv16r
adaLN_cond__sliding_block_cached__moe_arch_mod__prompt_kernel_kv16b:
    v_mfma_f32_16x16x32_bf16 v[76:79], v[224:227], v[92:95], v[76:79]
    ds_read_b64_tr_b16 v[242:243], v4 offset:25856
    s_waitcnt lgkmcnt(6)
    v_mfma_f32_16x16x32_bf16 v[80:83], v[228:231], v[88:91], v[80:83]
    ds_read_b64_tr_b16 v[244:245], v5 offset:24864
    v_mfma_f32_16x16x32_bf16 v[84:87], v[228:231], v[92:95], v[84:87]
    ds_read_b64_tr_b16 v[246:247], v5 offset:25888
    s_waitcnt vmcnt(11) lgkmcnt(6)
    v_mfma_f32_16x16x32_bf16 v[24:27], v[232:235], v[96:99], v[24:27]
    ds_read_b64_tr_b16 v[224:225], v4 offset:25088
    s_waitcnt vmcnt(9)
    v_mfma_f32_16x16x32_bf16 v[28:31], v[232:235], v[100:103], v[28:31]
    ds_read_b64_tr_b16 v[226:227], v4 offset:26112
    s_waitcnt lgkmcnt(6)
    v_mfma_f32_16x16x32_bf16 v[32:35], v[236:239], v[96:99], v[32:35]
    ds_read_b64_tr_b16 v[228:229], v5 offset:25120
    v_mfma_f32_16x16x32_bf16 v[36:39], v[236:239], v[100:103], v[36:39]
    ds_read_b64_tr_b16 v[230:231], v5 offset:26144
    s_mov_b32 s23, 0x5800
    buffer_load_dwordx4 v[128:131], v7, s[8:11], s23 offen offset:1024 sc1
    s_waitcnt lgkmcnt(6)
    v_mfma_f32_16x16x32_bf16 v[40:43], v[240:243], v[96:99], v[40:43]
    ds_read_b64_tr_b16 v[232:233], v4 offset:25344
    v_mfma_f32_16x16x32_bf16 v[44:47], v[240:243], v[100:103], v[44:47]
    ds_read_b64_tr_b16 v[234:235], v4 offset:26368
    s_waitcnt lgkmcnt(6)
    v_mfma_f32_16x16x32_bf16 v[48:51], v[244:247], v[96:99], v[48:51]
    ds_read_b64_tr_b16 v[236:237], v5 offset:25376
    v_mfma_f32_16x16x32_bf16 v[52:55], v[244:247], v[100:103], v[52:55]
    ds_read_b64_tr_b16 v[238:239], v5 offset:26400
    s_waitcnt lgkmcnt(6)
    v_mfma_f32_16x16x32_bf16 v[56:59], v[224:227], v[96:99], v[56:59]
    v_mfma_f32_16x16x32_bf16 v[60:63], v[224:227], v[100:103], v[60:63]
    s_waitcnt vmcnt(9)
    s_barrier
    ds_read_b64_tr_b16 v[240:241], v4 offset:32768
    ds_read_b64_tr_b16 v[242:243], v4 offset:33792
    s_waitcnt lgkmcnt(6)
    v_mfma_f32_16x16x32_bf16 v[64:67], v[228:231], v[96:99], v[64:67]
    ds_read_b64_tr_b16 v[244:245], v5 offset:32800
    v_mfma_f32_16x16x32_bf16 v[68:71], v[228:231], v[100:103], v[68:71]
    s_add_u32 s22, s19, 0x600000
    s_add_u32 m0, s20, 0x0
    s_nop 0
    buffer_load_dwordx4 v3, s[4:7], s22 offen lds
    ds_read_b64_tr_b16 v[246:247], v5 offset:33824
    s_mov_b32 s23, 0xd800
    buffer_load_dwordx4 v[132:135], v7, s[8:11], s23 offen offset:1024 sc1
    s_waitcnt lgkmcnt(6)
    v_mfma_f32_16x16x32_bf16 v[72:75], v[232:235], v[96:99], v[72:75]
    ds_read_b64_tr_b16 v[224:225], v4 offset:33024
    v_mfma_f32_16x16x32_bf16 v[76:79], v[232:235], v[100:103], v[76:79]
    ds_read_b64_tr_b16 v[226:227], v4 offset:34048
    s_waitcnt lgkmcnt(6)
    v_mfma_f32_16x16x32_bf16 v[80:83], v[236:239], v[96:99], v[80:83]
    ds_read_b64_tr_b16 v[228:229], v5 offset:33056
    v_mfma_f32_16x16x32_bf16 v[84:87], v[236:239], v[100:103], v[84:87]
    ds_read_b64_tr_b16 v[230:231], v5 offset:34080
    s_waitcnt vmcnt(10) lgkmcnt(6)
    v_mfma_f32_16x16x32_bf16 v[24:27], v[240:243], v[104:107], v[24:27]
    ds_read_b64_tr_b16 v[232:233], v4 offset:33280
    s_waitcnt vmcnt(9)
    v_mfma_f32_16x16x32_bf16 v[28:31], v[240:243], v[108:111], v[28:31]
    ds_read_b64_tr_b16 v[234:235], v4 offset:34304
    s_waitcnt lgkmcnt(6)
    v_mfma_f32_16x16x32_bf16 v[32:35], v[244:247], v[104:107], v[32:35]
    ds_read_b64_tr_b16 v[236:237], v5 offset:33312
    v_mfma_f32_16x16x32_bf16 v[36:39], v[244:247], v[108:111], v[36:39]
    s_add_u32 s22, s19, 0x608000
    s_add_u32 m0, s20, 0x400
    s_nop 0
    buffer_load_dwordx4 v3, s[4:7], s22 offen lds
    ds_read_b64_tr_b16 v[238:239], v5 offset:34336
    s_mov_b32 s23, 0x6000
    buffer_load_dwordx4 v[88:91], v7, s[8:11], s23 offen offset:0 sc1
    s_waitcnt lgkmcnt(6)
    v_mfma_f32_16x16x32_bf16 v[40:43], v[224:227], v[104:107], v[40:43]
    ds_read_b64_tr_b16 v[240:241], v4 offset:33536
    v_mfma_f32_16x16x32_bf16 v[44:47], v[224:227], v[108:111], v[44:47]
    ds_read_b64_tr_b16 v[242:243], v4 offset:34560
    s_waitcnt lgkmcnt(6)
    v_mfma_f32_16x16x32_bf16 v[48:51], v[228:231], v[104:107], v[48:51]
    ds_read_b64_tr_b16 v[244:245], v5 offset:33568
    v_mfma_f32_16x16x32_bf16 v[52:55], v[228:231], v[108:111], v[52:55]
    ds_read_b64_tr_b16 v[246:247], v5 offset:34592
    s_waitcnt lgkmcnt(6)
    v_mfma_f32_16x16x32_bf16 v[56:59], v[232:235], v[104:107], v[56:59]
    ds_read_b64_tr_b16 v[224:225], v4 offset:40960
    v_mfma_f32_16x16x32_bf16 v[60:63], v[232:235], v[108:111], v[60:63]
    ds_read_b64_tr_b16 v[226:227], v4 offset:41984
    s_waitcnt lgkmcnt(6)
    v_mfma_f32_16x16x32_bf16 v[64:67], v[236:239], v[104:107], v[64:67]
    ds_read_b64_tr_b16 v[228:229], v5 offset:40992
    v_mfma_f32_16x16x32_bf16 v[68:71], v[236:239], v[108:111], v[68:71]
    ds_read_b64_tr_b16 v[230:231], v5 offset:42016
    s_mov_b32 s23, 0xe000
    buffer_load_dwordx4 v[92:95], v7, s[8:11], s23 offen offset:0 sc1
    s_waitcnt lgkmcnt(6)
    v_mfma_f32_16x16x32_bf16 v[72:75], v[240:243], v[104:107], v[72:75]
    ds_read_b64_tr_b16 v[232:233], v4 offset:41216
    v_mfma_f32_16x16x32_bf16 v[76:79], v[240:243], v[108:111], v[76:79]
    ds_read_b64_tr_b16 v[234:235], v4 offset:42240
    s_waitcnt lgkmcnt(6)
    v_mfma_f32_16x16x32_bf16 v[80:83], v[244:247], v[104:107], v[80:83]
    ds_read_b64_tr_b16 v[236:237], v5 offset:41248
    v_mfma_f32_16x16x32_bf16 v[84:87], v[244:247], v[108:111], v[84:87]
    ds_read_b64_tr_b16 v[238:239], v5 offset:42272
    s_waitcnt vmcnt(11) lgkmcnt(6)
    v_mfma_f32_16x16x32_bf16 v[24:27], v[224:227], v[112:115], v[24:27]
    ds_read_b64_tr_b16 v[240:241], v4 offset:41472
    s_add_u32 s22, s21, 0x0
    s_add_u32 m0, s20, 0x10000
    s_nop 0
    buffer_load_dwordx4 v2, s[8:11], s22 offen sc1 lds
    s_waitcnt vmcnt(10)
    v_mfma_f32_16x16x32_bf16 v[28:31], v[224:227], v[116:119], v[28:31]
    ds_read_b64_tr_b16 v[242:243], v4 offset:42496
    s_waitcnt lgkmcnt(6)
    v_mfma_f32_16x16x32_bf16 v[32:35], v[228:231], v[112:115], v[32:35]
    ds_read_b64_tr_b16 v[244:245], v5 offset:41504
    v_mfma_f32_16x16x32_bf16 v[36:39], v[228:231], v[116:119], v[36:39]
    ds_read_b64_tr_b16 v[246:247], v5 offset:42528
    s_mov_b32 s23, 0x6000
    buffer_load_dwordx4 v[96:99], v7, s[8:11], s23 offen offset:1024 sc1
    s_waitcnt lgkmcnt(6)
    v_mfma_f32_16x16x32_bf16 v[40:43], v[232:235], v[112:115], v[40:43]
    ds_read_b64_tr_b16 v[224:225], v4 offset:41728
    s_add_u32 s22, s21, 0x400
    s_add_u32 m0, s20, 0x10400
    s_nop 0
    buffer_load_dwordx4 v2, s[8:11], s22 offen sc1 lds
    v_mfma_f32_16x16x32_bf16 v[44:47], v[232:235], v[116:119], v[44:47]
    ds_read_b64_tr_b16 v[226:227], v4 offset:42752
    s_waitcnt lgkmcnt(6)
    v_mfma_f32_16x16x32_bf16 v[48:51], v[236:239], v[112:115], v[48:51]
    ds_read_b64_tr_b16 v[228:229], v5 offset:41760
    v_mfma_f32_16x16x32_bf16 v[52:55], v[236:239], v[116:119], v[52:55]
    ds_read_b64_tr_b16 v[230:231], v5 offset:42784
    s_waitcnt lgkmcnt(6)
    v_mfma_f32_16x16x32_bf16 v[56:59], v[240:243], v[112:115], v[56:59]
    v_mfma_f32_16x16x32_bf16 v[60:63], v[240:243], v[116:119], v[60:63]
    s_waitcnt vmcnt(11)
    s_barrier
    ds_read_b64_tr_b16 v[232:233], v4 offset:49152
    ds_read_b64_tr_b16 v[234:235], v4 offset:50176
    s_waitcnt lgkmcnt(6)
    v_mfma_f32_16x16x32_bf16 v[64:67], v[244:247], v[112:115], v[64:67]
    ds_read_b64_tr_b16 v[236:237], v5 offset:49184
    v_mfma_f32_16x16x32_bf16 v[68:71], v[244:247], v[116:119], v[68:71]
    s_add_u32 s22, s19, 0x680000
    s_add_u32 m0, s20, 0x4000
    s_nop 0
    buffer_load_dwordx4 v3, s[4:7], s22 offen lds
    ds_read_b64_tr_b16 v[238:239], v5 offset:50208
    s_mov_b32 s23, 0xe000
    buffer_load_dwordx4 v[100:103], v7, s[8:11], s23 offen offset:1024 sc1
    s_waitcnt lgkmcnt(6)
    v_mfma_f32_16x16x32_bf16 v[72:75], v[224:227], v[112:115], v[72:75]
    ds_read_b64_tr_b16 v[240:241], v4 offset:49408
    v_mfma_f32_16x16x32_bf16 v[76:79], v[224:227], v[116:119], v[76:79]
    ds_read_b64_tr_b16 v[242:243], v4 offset:50432
    s_waitcnt lgkmcnt(6)
    v_mfma_f32_16x16x32_bf16 v[80:83], v[228:231], v[112:115], v[80:83]
    ds_read_b64_tr_b16 v[244:245], v5 offset:49440
    v_mfma_f32_16x16x32_bf16 v[84:87], v[228:231], v[116:119], v[84:87]
    ds_read_b64_tr_b16 v[246:247], v5 offset:50464
    s_waitcnt vmcnt(12) lgkmcnt(6)
    v_mfma_f32_16x16x32_bf16 v[24:27], v[232:235], v[120:123], v[24:27]
    ds_read_b64_tr_b16 v[224:225], v4 offset:49664
    s_waitcnt vmcnt(11)
    v_mfma_f32_16x16x32_bf16 v[28:31], v[232:235], v[124:127], v[28:31]
    ds_read_b64_tr_b16 v[226:227], v4 offset:50688
    s_waitcnt lgkmcnt(6)
    v_mfma_f32_16x16x32_bf16 v[32:35], v[236:239], v[120:123], v[32:35]
    ds_read_b64_tr_b16 v[228:229], v5 offset:49696
    v_mfma_f32_16x16x32_bf16 v[36:39], v[236:239], v[124:127], v[36:39]
    s_add_u32 s22, s19, 0x688000
    s_add_u32 m0, s20, 0x4400
    s_nop 0
    buffer_load_dwordx4 v3, s[4:7], s22 offen lds
    ds_read_b64_tr_b16 v[230:231], v5 offset:50720
    s_mov_b32 s23, 0x6800
    buffer_load_dwordx4 v[104:107], v7, s[8:11], s23 offen offset:0 sc1
    s_waitcnt lgkmcnt(6)
    v_mfma_f32_16x16x32_bf16 v[40:43], v[240:243], v[120:123], v[40:43]
    ds_read_b64_tr_b16 v[232:233], v4 offset:49920
    v_mfma_f32_16x16x32_bf16 v[44:47], v[240:243], v[124:127], v[44:47]
    ds_read_b64_tr_b16 v[234:235], v4 offset:50944
    s_waitcnt lgkmcnt(6)
    v_mfma_f32_16x16x32_bf16 v[48:51], v[244:247], v[120:123], v[48:51]
    ds_read_b64_tr_b16 v[236:237], v5 offset:49952
    v_mfma_f32_16x16x32_bf16 v[52:55], v[244:247], v[124:127], v[52:55]
    ds_read_b64_tr_b16 v[238:239], v5 offset:50976
    s_waitcnt lgkmcnt(6)
    v_mfma_f32_16x16x32_bf16 v[56:59], v[224:227], v[120:123], v[56:59]
    ds_read_b64_tr_b16 v[240:241], v4 offset:57344
    v_mfma_f32_16x16x32_bf16 v[60:63], v[224:227], v[124:127], v[60:63]
    ds_read_b64_tr_b16 v[242:243], v4 offset:58368
    s_waitcnt lgkmcnt(6)
    v_mfma_f32_16x16x32_bf16 v[64:67], v[228:231], v[120:123], v[64:67]
    ds_read_b64_tr_b16 v[244:245], v5 offset:57376
    v_mfma_f32_16x16x32_bf16 v[68:71], v[228:231], v[124:127], v[68:71]
    ds_read_b64_tr_b16 v[246:247], v5 offset:58400
    s_mov_b32 s23, 0xe800
    buffer_load_dwordx4 v[108:111], v7, s[8:11], s23 offen offset:0 sc1
    s_waitcnt lgkmcnt(6)
    v_mfma_f32_16x16x32_bf16 v[72:75], v[232:235], v[120:123], v[72:75]
    ds_read_b64_tr_b16 v[224:225], v4 offset:57600
    v_mfma_f32_16x16x32_bf16 v[76:79], v[232:235], v[124:127], v[76:79]
    ds_read_b64_tr_b16 v[226:227], v4 offset:58624
    s_waitcnt lgkmcnt(6)
    v_mfma_f32_16x16x32_bf16 v[80:83], v[236:239], v[120:123], v[80:83]
    ds_read_b64_tr_b16 v[228:229], v5 offset:57632
    v_mfma_f32_16x16x32_bf16 v[84:87], v[236:239], v[124:127], v[84:87]
    ds_read_b64_tr_b16 v[230:231], v5 offset:58656
    s_waitcnt vmcnt(13) lgkmcnt(6)
    v_mfma_f32_16x16x32_bf16 v[24:27], v[240:243], v[128:131], v[24:27]
    ds_read_b64_tr_b16 v[232:233], v4 offset:57856
    s_add_u32 s22, s21, 0x4000
    s_add_u32 m0, s20, 0x14000
    s_nop 0
    buffer_load_dwordx4 v2, s[8:11], s22 offen sc1 lds
    s_waitcnt vmcnt(12)
    v_mfma_f32_16x16x32_bf16 v[28:31], v[240:243], v[132:135], v[28:31]
    ds_read_b64_tr_b16 v[234:235], v4 offset:58880
    s_waitcnt lgkmcnt(6)
    v_mfma_f32_16x16x32_bf16 v[32:35], v[244:247], v[128:131], v[32:35]
    ds_read_b64_tr_b16 v[236:237], v5 offset:57888
    v_mfma_f32_16x16x32_bf16 v[36:39], v[244:247], v[132:135], v[36:39]
    ds_read_b64_tr_b16 v[238:239], v5 offset:58912
    s_mov_b32 s23, 0x6800
    buffer_load_dwordx4 v[112:115], v7, s[8:11], s23 offen offset:1024 sc1
    s_waitcnt lgkmcnt(6)
    v_mfma_f32_16x16x32_bf16 v[40:43], v[224:227], v[128:131], v[40:43]
    ds_read_b64_tr_b16 v[240:241], v4 offset:58112
    s_add_u32 s22, s21, 0x4400
    s_add_u32 m0, s20, 0x14400
    s_nop 0
    buffer_load_dwordx4 v2, s[8:11], s22 offen sc1 lds
    v_mfma_f32_16x16x32_bf16 v[44:47], v[224:227], v[132:135], v[44:47]
    ds_read_b64_tr_b16 v[242:243], v4 offset:59136
    s_waitcnt lgkmcnt(6)
    v_mfma_f32_16x16x32_bf16 v[48:51], v[228:231], v[128:131], v[48:51]
    ds_read_b64_tr_b16 v[244:245], v5 offset:58144
    v_mfma_f32_16x16x32_bf16 v[52:55], v[228:231], v[132:135], v[52:55]
    ds_read_b64_tr_b16 v[246:247], v5 offset:59168
    s_waitcnt lgkmcnt(6)
    v_mfma_f32_16x16x32_bf16 v[56:59], v[232:235], v[128:131], v[56:59]
    v_mfma_f32_16x16x32_bf16 v[60:63], v[232:235], v[132:135], v[60:63]
    s_waitcnt vmcnt(13)
    s_barrier
    ds_read_b64_tr_b16 v[224:225], v4 offset:0
    ds_read_b64_tr_b16 v[226:227], v4 offset:1024
    s_waitcnt lgkmcnt(6)
    v_mfma_f32_16x16x32_bf16 v[64:67], v[236:239], v[128:131], v[64:67]
    ds_read_b64_tr_b16 v[228:229], v5 offset:32
    v_mfma_f32_16x16x32_bf16 v[68:71], v[236:239], v[132:135], v[68:71]
    s_add_u32 s22, s19, 0x700000
    s_add_u32 m0, s20, 0x8000
    s_nop 0
    buffer_load_dwordx4 v3, s[4:7], s22 offen lds
    ds_read_b64_tr_b16 v[230:231], v5 offset:1056
    s_mov_b32 s23, 0xe800
    buffer_load_dwordx4 v[116:119], v7, s[8:11], s23 offen offset:1024 sc1
    s_waitcnt lgkmcnt(6)
    v_mfma_f32_16x16x32_bf16 v[72:75], v[240:243], v[128:131], v[72:75]
    ds_read_b64_tr_b16 v[232:233], v4 offset:256
    v_mfma_f32_16x16x32_bf16 v[76:79], v[240:243], v[132:135], v[76:79]
    ds_read_b64_tr_b16 v[234:235], v4 offset:1280
    s_waitcnt lgkmcnt(6)
    v_mfma_f32_16x16x32_bf16 v[80:83], v[244:247], v[128:131], v[80:83]
    ds_read_b64_tr_b16 v[236:237], v5 offset:288
    v_mfma_f32_16x16x32_bf16 v[84:87], v[244:247], v[132:135], v[84:87]
    ds_read_b64_tr_b16 v[238:239], v5 offset:1312
    s_waitcnt vmcnt(14) lgkmcnt(6)
    v_mfma_f32_16x16x32_bf16 v[24:27], v[224:227], v[88:91], v[24:27]
    ds_read_b64_tr_b16 v[240:241], v4 offset:512
    s_waitcnt vmcnt(13)
    v_mfma_f32_16x16x32_bf16 v[28:31], v[224:227], v[92:95], v[28:31]
    ds_read_b64_tr_b16 v[242:243], v4 offset:1536
    s_waitcnt lgkmcnt(6)
    v_mfma_f32_16x16x32_bf16 v[32:35], v[228:231], v[88:91], v[32:35]
    ds_read_b64_tr_b16 v[244:245], v5 offset:544
    v_mfma_f32_16x16x32_bf16 v[36:39], v[228:231], v[92:95], v[36:39]
    s_add_u32 s22, s19, 0x708000
    s_add_u32 m0, s20, 0x8400
    s_nop 0
    buffer_load_dwordx4 v3, s[4:7], s22 offen lds
    ds_read_b64_tr_b16 v[246:247], v5 offset:1568
    s_mov_b32 s23, 0x7000
    buffer_load_dwordx4 v[120:123], v7, s[8:11], s23 offen offset:0 sc1
    s_waitcnt lgkmcnt(6)
    v_mfma_f32_16x16x32_bf16 v[40:43], v[232:235], v[88:91], v[40:43]
    ds_read_b64_tr_b16 v[224:225], v4 offset:768
    v_mfma_f32_16x16x32_bf16 v[44:47], v[232:235], v[92:95], v[44:47]
    ds_read_b64_tr_b16 v[226:227], v4 offset:1792
    s_waitcnt lgkmcnt(6)
    v_mfma_f32_16x16x32_bf16 v[48:51], v[236:239], v[88:91], v[48:51]
    ds_read_b64_tr_b16 v[228:229], v5 offset:800
    v_mfma_f32_16x16x32_bf16 v[52:55], v[236:239], v[92:95], v[52:55]
    ds_read_b64_tr_b16 v[230:231], v5 offset:1824
    s_waitcnt lgkmcnt(6)
    v_mfma_f32_16x16x32_bf16 v[56:59], v[240:243], v[88:91], v[56:59]
    ds_read_b64_tr_b16 v[232:233], v4 offset:8192
    v_mfma_f32_16x16x32_bf16 v[60:63], v[240:243], v[92:95], v[60:63]
    ds_read_b64_tr_b16 v[234:235], v4 offset:9216
    s_waitcnt lgkmcnt(6)
    v_mfma_f32_16x16x32_bf16 v[64:67], v[244:247], v[88:91], v[64:67]
    ds_read_b64_tr_b16 v[236:237], v5 offset:8224
    v_mfma_f32_16x16x32_bf16 v[68:71], v[244:247], v[92:95], v[68:71]
    ds_read_b64_tr_b16 v[238:239], v5 offset:9248
    s_mov_b32 s23, 0xf000
    buffer_load_dwordx4 v[124:127], v7, s[8:11], s23 offen offset:0 sc1
    s_waitcnt lgkmcnt(6)
    v_mfma_f32_16x16x32_bf16 v[72:75], v[224:227], v[88:91], v[72:75]
    ds_read_b64_tr_b16 v[240:241], v4 offset:8448
    v_mfma_f32_16x16x32_bf16 v[76:79], v[224:227], v[92:95], v[76:79]
    ds_read_b64_tr_b16 v[242:243], v4 offset:9472
    s_waitcnt lgkmcnt(6)
    v_mfma_f32_16x16x32_bf16 v[80:83], v[228:231], v[88:91], v[80:83]
    ds_read_b64_tr_b16 v[244:245], v5 offset:8480
    v_mfma_f32_16x16x32_bf16 v[84:87], v[228:231], v[92:95], v[84:87]
    ds_read_b64_tr_b16 v[246:247], v5 offset:9504
    s_waitcnt vmcnt(14) lgkmcnt(6)
    v_mfma_f32_16x16x32_bf16 v[24:27], v[232:235], v[96:99], v[24:27]
    ds_read_b64_tr_b16 v[224:225], v4 offset:8704
    s_add_u32 s22, s21, 0x8000
    s_add_u32 m0, s20, 0x18000
    s_nop 0
    buffer_load_dwordx4 v2, s[8:11], s22 offen sc1 lds
    s_waitcnt vmcnt(12)
    v_mfma_f32_16x16x32_bf16 v[28:31], v[232:235], v[100:103], v[28:31]
    ds_read_b64_tr_b16 v[226:227], v4 offset:9728
    s_waitcnt lgkmcnt(6)
    v_mfma_f32_16x16x32_bf16 v[32:35], v[236:239], v[96:99], v[32:35]
    ds_read_b64_tr_b16 v[228:229], v5 offset:8736
    v_mfma_f32_16x16x32_bf16 v[36:39], v[236:239], v[100:103], v[36:39]
    ds_read_b64_tr_b16 v[230:231], v5 offset:9760
    s_mov_b32 s23, 0x7000
    buffer_load_dwordx4 v[128:131], v7, s[8:11], s23 offen offset:1024 sc1
    s_waitcnt lgkmcnt(6)
    v_mfma_f32_16x16x32_bf16 v[40:43], v[240:243], v[96:99], v[40:43]
    ds_read_b64_tr_b16 v[232:233], v4 offset:8960
    s_add_u32 s22, s21, 0x8400
    s_add_u32 m0, s20, 0x18400
    s_nop 0
    buffer_load_dwordx4 v2, s[8:11], s22 offen sc1 lds
    v_mfma_f32_16x16x32_bf16 v[44:47], v[240:243], v[100:103], v[44:47]
    ds_read_b64_tr_b16 v[234:235], v4 offset:9984
    s_waitcnt lgkmcnt(6)
    v_mfma_f32_16x16x32_bf16 v[48:51], v[244:247], v[96:99], v[48:51]
    ds_read_b64_tr_b16 v[236:237], v5 offset:8992
    v_mfma_f32_16x16x32_bf16 v[52:55], v[244:247], v[100:103], v[52:55]
    ds_read_b64_tr_b16 v[238:239], v5 offset:10016
    s_waitcnt lgkmcnt(6)
    v_mfma_f32_16x16x32_bf16 v[56:59], v[224:227], v[96:99], v[56:59]
    v_mfma_f32_16x16x32_bf16 v[60:63], v[224:227], v[100:103], v[60:63]
    s_waitcnt vmcnt(13)
    s_barrier
    ds_read_b64_tr_b16 v[240:241], v4 offset:16384
    ds_read_b64_tr_b16 v[242:243], v4 offset:17408
    s_waitcnt lgkmcnt(6)
    v_mfma_f32_16x16x32_bf16 v[64:67], v[228:231], v[96:99], v[64:67]
    ds_read_b64_tr_b16 v[244:245], v5 offset:16416
    v_mfma_f32_16x16x32_bf16 v[68:71], v[228:231], v[100:103], v[68:71]
    s_add_u32 s22, s19, 0x780000
    s_add_u32 m0, s20, 0xc000
    s_nop 0
    buffer_load_dwordx4 v3, s[4:7], s22 offen lds
    ds_read_b64_tr_b16 v[246:247], v5 offset:17440
    s_mov_b32 s23, 0xf000
    buffer_load_dwordx4 v[132:135], v7, s[8:11], s23 offen offset:1024 sc1
    s_waitcnt lgkmcnt(6)
    v_mfma_f32_16x16x32_bf16 v[72:75], v[232:235], v[96:99], v[72:75]
    ds_read_b64_tr_b16 v[224:225], v4 offset:16640
    v_mfma_f32_16x16x32_bf16 v[76:79], v[232:235], v[100:103], v[76:79]
    ds_read_b64_tr_b16 v[226:227], v4 offset:17664
    s_waitcnt lgkmcnt(6)
    v_mfma_f32_16x16x32_bf16 v[80:83], v[236:239], v[96:99], v[80:83]
    ds_read_b64_tr_b16 v[228:229], v5 offset:16672
    v_mfma_f32_16x16x32_bf16 v[84:87], v[236:239], v[100:103], v[84:87]
    ds_read_b64_tr_b16 v[230:231], v5 offset:17696
    s_waitcnt vmcnt(14) lgkmcnt(6)
    v_mfma_f32_16x16x32_bf16 v[24:27], v[240:243], v[104:107], v[24:27]
    ds_read_b64_tr_b16 v[232:233], v4 offset:16896
    s_waitcnt vmcnt(13)
    v_mfma_f32_16x16x32_bf16 v[28:31], v[240:243], v[108:111], v[28:31]
    ds_read_b64_tr_b16 v[234:235], v4 offset:17920
    s_waitcnt lgkmcnt(6)
    v_mfma_f32_16x16x32_bf16 v[32:35], v[244:247], v[104:107], v[32:35]
    ds_read_b64_tr_b16 v[236:237], v5 offset:16928
    v_mfma_f32_16x16x32_bf16 v[36:39], v[244:247], v[108:111], v[36:39]
    s_add_u32 s22, s19, 0x788000
    s_add_u32 m0, s20, 0xc400
    s_nop 0
    buffer_load_dwordx4 v3, s[4:7], s22 offen lds
    ds_read_b64_tr_b16 v[238:239], v5 offset:17952
    s_mov_b32 s23, 0x7800
    buffer_load_dwordx4 v[88:91], v7, s[8:11], s23 offen offset:0 sc1
    s_waitcnt lgkmcnt(6)
    v_mfma_f32_16x16x32_bf16 v[40:43], v[224:227], v[104:107], v[40:43]
    ds_read_b64_tr_b16 v[240:241], v4 offset:17152
    v_mfma_f32_16x16x32_bf16 v[44:47], v[224:227], v[108:111], v[44:47]
    ds_read_b64_tr_b16 v[242:243], v4 offset:18176
    s_waitcnt lgkmcnt(6)
    v_mfma_f32_16x16x32_bf16 v[48:51], v[228:231], v[104:107], v[48:51]
    ds_read_b64_tr_b16 v[244:245], v5 offset:17184
    v_mfma_f32_16x16x32_bf16 v[52:55], v[228:231], v[108:111], v[52:55]
    ds_read_b64_tr_b16 v[246:247], v5 offset:18208
    s_waitcnt lgkmcnt(6)
    v_mfma_f32_16x16x32_bf16 v[56:59], v[232:235], v[104:107], v[56:59]
    ds_read_b64_tr_b16 v[224:225], v4 offset:24576
    v_mfma_f32_16x16x32_bf16 v[60:63], v[232:235], v[108:111], v[60:63]
    ds_read_b64_tr_b16 v[226:227], v4 offset:25600
    s_waitcnt lgkmcnt(6)
    v_mfma_f32_16x16x32_bf16 v[64:67], v[236:239], v[104:107], v[64:67]
    ds_read_b64_tr_b16 v[228:229], v5 offset:24608
    v_mfma_f32_16x16x32_bf16 v[68:71], v[236:239], v[108:111], v[68:71]
    ds_read_b64_tr_b16 v[230:231], v5 offset:25632
    s_mov_b32 s23, 0xf800
    buffer_load_dwordx4 v[92:95], v7, s[8:11], s23 offen offset:0 sc1
    s_waitcnt lgkmcnt(6)
    v_mfma_f32_16x16x32_bf16 v[72:75], v[240:243], v[104:107], v[72:75]
    ds_read_b64_tr_b16 v[232:233], v4 offset:24832
    v_mfma_f32_16x16x32_bf16 v[76:79], v[240:243], v[108:111], v[76:79]
    ds_read_b64_tr_b16 v[234:235], v4 offset:25856
    s_waitcnt lgkmcnt(6)
    v_mfma_f32_16x16x32_bf16 v[80:83], v[244:247], v[104:107], v[80:83]
    ds_read_b64_tr_b16 v[236:237], v5 offset:24864
    v_mfma_f32_16x16x32_bf16 v[84:87], v[244:247], v[108:111], v[84:87]
    ds_read_b64_tr_b16 v[238:239], v5 offset:25888
    s_waitcnt vmcnt(14) lgkmcnt(6)
    v_mfma_f32_16x16x32_bf16 v[24:27], v[224:227], v[112:115], v[24:27]
    ds_read_b64_tr_b16 v[240:241], v4 offset:25088
    s_add_u32 s22, s21, 0xc000
    s_add_u32 m0, s20, 0x1c000
    s_nop 0
    buffer_load_dwordx4 v2, s[8:11], s22 offen sc1 lds
    s_waitcnt vmcnt(12)
    v_mfma_f32_16x16x32_bf16 v[28:31], v[224:227], v[116:119], v[28:31]
    ds_read_b64_tr_b16 v[242:243], v4 offset:26112
    s_waitcnt lgkmcnt(6)
    v_mfma_f32_16x16x32_bf16 v[32:35], v[228:231], v[112:115], v[32:35]
    ds_read_b64_tr_b16 v[244:245], v5 offset:25120
    v_mfma_f32_16x16x32_bf16 v[36:39], v[228:231], v[116:119], v[36:39]
    ds_read_b64_tr_b16 v[246:247], v5 offset:26144
    s_mov_b32 s23, 0x7800
    buffer_load_dwordx4 v[96:99], v7, s[8:11], s23 offen offset:1024 sc1
    s_waitcnt lgkmcnt(6)
    v_mfma_f32_16x16x32_bf16 v[40:43], v[232:235], v[112:115], v[40:43]
    ds_read_b64_tr_b16 v[224:225], v4 offset:25344
    s_add_u32 s22, s21, 0xc400
    s_add_u32 m0, s20, 0x1c400
    s_nop 0
    buffer_load_dwordx4 v2, s[8:11], s22 offen sc1 lds
    v_mfma_f32_16x16x32_bf16 v[44:47], v[232:235], v[116:119], v[44:47]
    ds_read_b64_tr_b16 v[226:227], v4 offset:26368
    s_waitcnt lgkmcnt(6)
    v_mfma_f32_16x16x32_bf16 v[48:51], v[236:239], v[112:115], v[48:51]
    ds_read_b64_tr_b16 v[228:229], v5 offset:25376
    v_mfma_f32_16x16x32_bf16 v[52:55], v[236:239], v[116:119], v[52:55]
    ds_read_b64_tr_b16 v[230:231], v5 offset:26400
    s_waitcnt lgkmcnt(6)
    v_mfma_f32_16x16x32_bf16 v[56:59], v[240:243], v[112:115], v[56:59]
    v_mfma_f32_16x16x32_bf16 v[60:63], v[240:243], v[116:119], v[60:63]
    s_waitcnt vmcnt(13)
    s_barrier
    ds_read_b64_tr_b16 v[232:233], v4 offset:32768
    ds_read_b64_tr_b16 v[234:235], v4 offset:33792
    s_waitcnt lgkmcnt(6)
    v_mfma_f32_16x16x32_bf16 v[64:67], v[244:247], v[112:115], v[64:67]
    ds_read_b64_tr_b16 v[236:237], v5 offset:32800
    v_mfma_f32_16x16x32_bf16 v[68:71], v[244:247], v[116:119], v[68:71]
    ds_read_b64_tr_b16 v[238:239], v5 offset:33824
    s_mov_b32 s23, 0xf800
    buffer_load_dwordx4 v[100:103], v7, s[8:11], s23 offen offset:1024 sc1
    s_waitcnt lgkmcnt(6)
    v_mfma_f32_16x16x32_bf16 v[72:75], v[224:227], v[112:115], v[72:75]
    ds_read_b64_tr_b16 v[240:241], v4 offset:33024
    v_mfma_f32_16x16x32_bf16 v[76:79], v[224:227], v[116:119], v[76:79]
    ds_read_b64_tr_b16 v[242:243], v4 offset:34048
    s_waitcnt lgkmcnt(6)
    v_mfma_f32_16x16x32_bf16 v[80:83], v[228:231], v[112:115], v[80:83]
    ds_read_b64_tr_b16 v[244:245], v5 offset:33056
    v_mfma_f32_16x16x32_bf16 v[84:87], v[228:231], v[116:119], v[84:87]
    ds_read_b64_tr_b16 v[246:247], v5 offset:34080
    s_waitcnt vmcnt(13) lgkmcnt(6)
    v_mfma_f32_16x16x32_bf16 v[24:27], v[232:235], v[120:123], v[24:27]
    ds_read_b64_tr_b16 v[224:225], v4 offset:33280
    s_waitcnt vmcnt(12)
    v_mfma_f32_16x16x32_bf16 v[28:31], v[232:235], v[124:127], v[28:31]
    ds_read_b64_tr_b16 v[226:227], v4 offset:34304
    s_waitcnt lgkmcnt(6)
    v_mfma_f32_16x16x32_bf16 v[32:35], v[236:239], v[120:123], v[32:35]
    ds_read_b64_tr_b16 v[228:229], v5 offset:33312
    v_mfma_f32_16x16x32_bf16 v[36:39], v[236:239], v[124:127], v[36:39]
    ds_read_b64_tr_b16 v[230:231], v5 offset:34336
    s_waitcnt lgkmcnt(6)
    v_mfma_f32_16x16x32_bf16 v[40:43], v[240:243], v[120:123], v[40:43]
    ds_read_b64_tr_b16 v[232:233], v4 offset:33536
    v_mfma_f32_16x16x32_bf16 v[44:47], v[240:243], v[124:127], v[44:47]
    ds_read_b64_tr_b16 v[234:235], v4 offset:34560
    s_waitcnt lgkmcnt(6)
    v_mfma_f32_16x16x32_bf16 v[48:51], v[244:247], v[120:123], v[48:51]
    ds_read_b64_tr_b16 v[236:237], v5 offset:33568
    v_mfma_f32_16x16x32_bf16 v[52:55], v[244:247], v[124:127], v[52:55]
    ds_read_b64_tr_b16 v[238:239], v5 offset:34592
    s_waitcnt lgkmcnt(6)
    v_mfma_f32_16x16x32_bf16 v[56:59], v[224:227], v[120:123], v[56:59]
    ds_read_b64_tr_b16 v[240:241], v4 offset:40960
    v_mfma_f32_16x16x32_bf16 v[60:63], v[224:227], v[124:127], v[60:63]
    ds_read_b64_tr_b16 v[242:243], v4 offset:41984
    s_waitcnt lgkmcnt(6)
    v_mfma_f32_16x16x32_bf16 v[64:67], v[228:231], v[120:123], v[64:67]
    ds_read_b64_tr_b16 v[244:245], v5 offset:40992
    v_mfma_f32_16x16x32_bf16 v[68:71], v[228:231], v[124:127], v[68:71]
    ds_read_b64_tr_b16 v[246:247], v5 offset:42016
    s_waitcnt lgkmcnt(6)
    v_mfma_f32_16x16x32_bf16 v[72:75], v[232:235], v[120:123], v[72:75]
    ds_read_b64_tr_b16 v[224:225], v4 offset:41216
    v_mfma_f32_16x16x32_bf16 v[76:79], v[232:235], v[124:127], v[76:79]
    ds_read_b64_tr_b16 v[226:227], v4 offset:42240
    s_waitcnt lgkmcnt(6)
    v_mfma_f32_16x16x32_bf16 v[80:83], v[236:239], v[120:123], v[80:83]
    ds_read_b64_tr_b16 v[228:229], v5 offset:41248
    v_mfma_f32_16x16x32_bf16 v[84:87], v[236:239], v[124:127], v[84:87]
    ds_read_b64_tr_b16 v[230:231], v5 offset:42272
    s_waitcnt vmcnt(10) lgkmcnt(6)
    v_mfma_f32_16x16x32_bf16 v[24:27], v[240:243], v[128:131], v[24:27]
    ds_read_b64_tr_b16 v[232:233], v4 offset:41472
    s_waitcnt vmcnt(7)
    v_mfma_f32_16x16x32_bf16 v[28:31], v[240:243], v[132:135], v[28:31]
    ds_read_b64_tr_b16 v[234:235], v4 offset:42496
    s_waitcnt lgkmcnt(6)
    v_mfma_f32_16x16x32_bf16 v[32:35], v[244:247], v[128:131], v[32:35]
    ds_read_b64_tr_b16 v[236:237], v5 offset:41504
    v_mfma_f32_16x16x32_bf16 v[36:39], v[244:247], v[132:135], v[36:39]
    ds_read_b64_tr_b16 v[238:239], v5 offset:42528
    s_waitcnt lgkmcnt(6)
    v_mfma_f32_16x16x32_bf16 v[40:43], v[224:227], v[128:131], v[40:43]
    ds_read_b64_tr_b16 v[240:241], v4 offset:41728
    v_mfma_f32_16x16x32_bf16 v[44:47], v[224:227], v[132:135], v[44:47]
    ds_read_b64_tr_b16 v[242:243], v4 offset:42752
    s_waitcnt lgkmcnt(6)
    v_mfma_f32_16x16x32_bf16 v[48:51], v[228:231], v[128:131], v[48:51]
    ds_read_b64_tr_b16 v[244:245], v5 offset:41760
    v_mfma_f32_16x16x32_bf16 v[52:55], v[228:231], v[132:135], v[52:55]
    ds_read_b64_tr_b16 v[246:247], v5 offset:42784
    s_waitcnt lgkmcnt(6)
    v_mfma_f32_16x16x32_bf16 v[56:59], v[232:235], v[128:131], v[56:59]
    v_mfma_f32_16x16x32_bf16 v[60:63], v[232:235], v[132:135], v[60:63]
    s_waitcnt vmcnt(6)
    s_barrier
    ds_read_b64_tr_b16 v[224:225], v4 offset:49152
    ds_read_b64_tr_b16 v[226:227], v4 offset:50176
    s_waitcnt lgkmcnt(6)
    v_mfma_f32_16x16x32_bf16 v[64:67], v[236:239], v[128:131], v[64:67]
    ds_read_b64_tr_b16 v[228:229], v5 offset:49184
    v_mfma_f32_16x16x32_bf16 v[68:71], v[236:239], v[132:135], v[68:71]
    ds_read_b64_tr_b16 v[230:231], v5 offset:50208
    s_waitcnt lgkmcnt(6)
    v_mfma_f32_16x16x32_bf16 v[72:75], v[240:243], v[128:131], v[72:75]
    ds_read_b64_tr_b16 v[232:233], v4 offset:49408
    v_mfma_f32_16x16x32_bf16 v[76:79], v[240:243], v[132:135], v[76:79]
    ds_read_b64_tr_b16 v[234:235], v4 offset:50432
    s_waitcnt lgkmcnt(6)
    v_mfma_f32_16x16x32_bf16 v[80:83], v[244:247], v[128:131], v[80:83]
    ds_read_b64_tr_b16 v[236:237], v5 offset:49440
    v_mfma_f32_16x16x32_bf16 v[84:87], v[244:247], v[132:135], v[84:87]
    ds_read_b64_tr_b16 v[238:239], v5 offset:50464
    s_waitcnt vmcnt(5) lgkmcnt(6)
    v_mfma_f32_16x16x32_bf16 v[24:27], v[224:227], v[88:91], v[24:27]
    ds_read_b64_tr_b16 v[240:241], v4 offset:49664
    s_waitcnt vmcnt(4)
    v_mfma_f32_16x16x32_bf16 v[28:31], v[224:227], v[92:95], v[28:31]
    ds_read_b64_tr_b16 v[242:243], v4 offset:50688
    s_waitcnt lgkmcnt(6)
    v_mfma_f32_16x16x32_bf16 v[32:35], v[228:231], v[88:91], v[32:35]
    ds_read_b64_tr_b16 v[244:245], v5 offset:49696
    v_mfma_f32_16x16x32_bf16 v[36:39], v[228:231], v[92:95], v[36:39]
    ds_read_b64_tr_b16 v[246:247], v5 offset:50720
    s_waitcnt lgkmcnt(6)
    v_mfma_f32_16x16x32_bf16 v[40:43], v[232:235], v[88:91], v[40:43]
    ds_read_b64_tr_b16 v[224:225], v4 offset:49920
    v_mfma_f32_16x16x32_bf16 v[44:47], v[232:235], v[92:95], v[44:47]
    ds_read_b64_tr_b16 v[226:227], v4 offset:50944
    s_waitcnt lgkmcnt(6)
    v_mfma_f32_16x16x32_bf16 v[48:51], v[236:239], v[88:91], v[48:51]
    ds_read_b64_tr_b16 v[228:229], v5 offset:49952
    v_mfma_f32_16x16x32_bf16 v[52:55], v[236:239], v[92:95], v[52:55]
    ds_read_b64_tr_b16 v[230:231], v5 offset:50976
    s_waitcnt lgkmcnt(6)
    v_mfma_f32_16x16x32_bf16 v[56:59], v[240:243], v[88:91], v[56:59]
    ds_read_b64_tr_b16 v[232:233], v4 offset:57344
    v_mfma_f32_16x16x32_bf16 v[60:63], v[240:243], v[92:95], v[60:63]
    ds_read_b64_tr_b16 v[234:235], v4 offset:58368
    s_waitcnt lgkmcnt(6)
    v_mfma_f32_16x16x32_bf16 v[64:67], v[244:247], v[88:91], v[64:67]
    ds_read_b64_tr_b16 v[236:237], v5 offset:57376
    v_mfma_f32_16x16x32_bf16 v[68:71], v[244:247], v[92:95], v[68:71]
    ds_read_b64_tr_b16 v[238:239], v5 offset:58400
    s_waitcnt lgkmcnt(6)
    v_mfma_f32_16x16x32_bf16 v[72:75], v[224:227], v[88:91], v[72:75]
    ds_read_b64_tr_b16 v[240:241], v4 offset:57600
    v_mfma_f32_16x16x32_bf16 v[76:79], v[224:227], v[92:95], v[76:79]
    ds_read_b64_tr_b16 v[242:243], v4 offset:58624
    s_waitcnt lgkmcnt(6)
    v_mfma_f32_16x16x32_bf16 v[80:83], v[228:231], v[88:91], v[80:83]
    ds_read_b64_tr_b16 v[244:245], v5 offset:57632
    v_mfma_f32_16x16x32_bf16 v[84:87], v[228:231], v[92:95], v[84:87]
    ds_read_b64_tr_b16 v[246:247], v5 offset:58656
    s_waitcnt vmcnt(2) lgkmcnt(6)
    v_mfma_f32_16x16x32_bf16 v[24:27], v[232:235], v[96:99], v[24:27]
    ds_read_b64_tr_b16 v[224:225], v4 offset:57856
    s_waitcnt vmcnt(0)
    v_mfma_f32_16x16x32_bf16 v[28:31], v[232:235], v[100:103], v[28:31]
    ds_read_b64_tr_b16 v[226:227], v4 offset:58880
    s_waitcnt lgkmcnt(6)
    v_mfma_f32_16x16x32_bf16 v[32:35], v[236:239], v[96:99], v[32:35]
    ds_read_b64_tr_b16 v[228:229], v5 offset:57888
    v_mfma_f32_16x16x32_bf16 v[36:39], v[236:239], v[100:103], v[36:39]
    ds_read_b64_tr_b16 v[230:231], v5 offset:58912
    s_waitcnt lgkmcnt(6)
    v_mfma_f32_16x16x32_bf16 v[40:43], v[240:243], v[96:99], v[40:43]
    ds_read_b64_tr_b16 v[232:233], v4 offset:58112
    v_mfma_f32_16x16x32_bf16 v[44:47], v[240:243], v[100:103], v[44:47]
    ds_read_b64_tr_b16 v[234:235], v4 offset:59136
    s_waitcnt lgkmcnt(6)
    v_mfma_f32_16x16x32_bf16 v[48:51], v[244:247], v[96:99], v[48:51]
    ds_read_b64_tr_b16 v[236:237], v5 offset:58144
    v_mfma_f32_16x16x32_bf16 v[52:55], v[244:247], v[100:103], v[52:55]
    ds_read_b64_tr_b16 v[238:239], v5 offset:59168
    s_waitcnt lgkmcnt(6)
    v_mfma_f32_16x16x32_bf16 v[56:59], v[224:227], v[96:99], v[56:59]
    v_mfma_f32_16x16x32_bf16 v[60:63], v[224:227], v[100:103], v[60:63]
    s_waitcnt lgkmcnt(4)
    v_mfma_f32_16x16x32_bf16 v[64:67], v[228:231], v[96:99], v[64:67]
    v_mfma_f32_16x16x32_bf16 v[68:71], v[228:231], v[100:103], v[68:71]
    s_waitcnt lgkmcnt(2)
    v_mfma_f32_16x16x32_bf16 v[72:75], v[232:235], v[96:99], v[72:75]
    v_mfma_f32_16x16x32_bf16 v[76:79], v[232:235], v[100:103], v[76:79]
    s_waitcnt lgkmcnt(0)
    v_mfma_f32_16x16x32_bf16 v[80:83], v[236:239], v[96:99], v[80:83]
    v_mfma_f32_16x16x32_bf16 v[84:87], v[236:239], v[100:103], v[84:87]
    s_mov_b32 s23, 0x3e0293ee
    v_mul_f32 v16, s23, v24
    v_mul_f32 v17, s23, v25
    v_cvt_pk_bf16_f32 v152, v16, v17
    v_mul_f32 v18, s23, v26
    v_mul_f32 v19, s23, v27
    v_cvt_pk_bf16_f32 v153, v18, v19
    v_mul_f32 v16, s23, v28
    v_mul_f32 v17, s23, v29
    v_cvt_pk_bf16_f32 v168, v16, v17
    v_mul_f32 v18, s23, v30
    v_mul_f32 v19, s23, v31
    v_cvt_pk_bf16_f32 v169, v18, v19
    v_mul_f32 v16, s23, v32
    v_mul_f32 v17, s23, v33
    v_cvt_pk_bf16_f32 v154, v16, v17
    v_mul_f32 v18, s23, v34
    v_mul_f32 v19, s23, v35
    v_cvt_pk_bf16_f32 v155, v18, v19
    v_mul_f32 v16, s23, v36
    v_mul_f32 v17, s23, v37
    v_cvt_pk_bf16_f32 v170, v16, v17
    v_mul_f32 v18, s23, v38
    v_mul_f32 v19, s23, v39
    v_cvt_pk_bf16_f32 v171, v18, v19
    v_mul_f32 v16, s23, v40
    v_mul_f32 v17, s23, v41
    v_cvt_pk_bf16_f32 v156, v16, v17
    v_mul_f32 v18, s23, v42
    v_mul_f32 v19, s23, v43
    v_cvt_pk_bf16_f32 v157, v18, v19
    v_mul_f32 v16, s23, v44
    v_mul_f32 v17, s23, v45
    v_cvt_pk_bf16_f32 v172, v16, v17
    v_mul_f32 v18, s23, v46
    v_mul_f32 v19, s23, v47
    v_cvt_pk_bf16_f32 v173, v18, v19
    v_mul_f32 v16, s23, v48
    v_mul_f32 v17, s23, v49
    v_cvt_pk_bf16_f32 v158, v16, v17
    v_mul_f32 v18, s23, v50
    v_mul_f32 v19, s23, v51
    v_cvt_pk_bf16_f32 v159, v18, v19
    v_mul_f32 v16, s23, v52
    v_mul_f32 v17, s23, v53
    v_cvt_pk_bf16_f32 v174, v16, v17
    v_mul_f32 v18, s23, v54
    v_mul_f32 v19, s23, v55
    v_cvt_pk_bf16_f32 v175, v18, v19
    v_mul_f32 v16, s23, v56
    v_mul_f32 v17, s23, v57
    v_cvt_pk_bf16_f32 v160, v16, v17
    v_mul_f32 v18, s23, v58
    v_mul_f32 v19, s23, v59
    v_cvt_pk_bf16_f32 v161, v18, v19
    v_mul_f32 v16, s23, v60
    v_mul_f32 v17, s23, v61
    v_cvt_pk_bf16_f32 v176, v16, v17
    v_mul_f32 v18, s23, v62
    v_mul_f32 v19, s23, v63
    v_cvt_pk_bf16_f32 v177, v18, v19
    v_mul_f32 v16, s23, v64
    v_mul_f32 v17, s23, v65
    v_cvt_pk_bf16_f32 v162, v16, v17
    v_mul_f32 v18, s23, v66
    v_mul_f32 v19, s23, v67
    v_cvt_pk_bf16_f32 v163, v18, v19
    v_mul_f32 v16, s23, v68
    v_mul_f32 v17, s23, v69
    v_cvt_pk_bf16_f32 v178, v16, v17
    v_mul_f32 v18, s23, v70
    v_mul_f32 v19, s23, v71
    v_cvt_pk_bf16_f32 v179, v18, v19
    v_mul_f32 v16, s23, v72
    v_mul_f32 v17, s23, v73
    v_cvt_pk_bf16_f32 v164, v16, v17
    v_mul_f32 v18, s23, v74
    v_mul_f32 v19, s23, v75
    v_cvt_pk_bf16_f32 v165, v18, v19
    v_mul_f32 v16, s23, v76
    v_mul_f32 v17, s23, v77
    v_cvt_pk_bf16_f32 v180, v16, v17
    v_mul_f32 v18, s23, v78
    v_mul_f32 v19, s23, v79
    v_cvt_pk_bf16_f32 v181, v18, v19
    v_mul_f32 v16, s23, v80
    v_mul_f32 v17, s23, v81
    v_cvt_pk_bf16_f32 v166, v16, v17
    v_mul_f32 v18, s23, v82
    v_mul_f32 v19, s23, v83
    v_cvt_pk_bf16_f32 v167, v18, v19
    v_mul_f32 v16, s23, v84
    v_mul_f32 v17, s23, v85
    v_cvt_pk_bf16_f32 v182, v16, v17
    v_mul_f32 v18, s23, v86
    v_mul_f32 v19, s23, v87
    v_cvt_pk_bf16_f32 v183, v18, v19
    v_add_u32 v4, 0x10000, v2
    v_add_u32 v5, 0x20000, v2
    s_barrier
    ds_read_b128 v[224:227], v4 offset:0
    ds_read_b128 v[228:231], v4 offset:1024
    ds_read_b128 v[232:235], v4 offset:2048
    ds_read_b128 v[236:239], v4 offset:3072
    s_waitcnt lgkmcnt(3)
    v_mfma_f32_16x16x32_bf16 v[184:187], v[224:227], v[152:155], 0
    v_mfma_f32_16x16x32_bf16 v[188:191], v[224:227], v[168:171], 0
    ds_read_b128 v[240:243], v4 offset:4096
    s_mov_b64 s[64:65], s[46:47]
    s_mov_b32 s66, 0x700000
    s_mov_b32 s67, 0x20000
    s_mov_b64 s[68:69], s[48:49]
    s_mov_b32 s70, 0x700000
    s_mov_b32 s71, 0x20000
    s_cmp_lt_u32 s2, 224
    s_cselect_b32 s66, 7340032, 0
    s_cselect_b32 s70, 7340032, 0
    s_and_b32 s29, s2, 7
    s_mul_i32 s29, s29, 28
    s_lshr_b32 s16, s2, 3
    s_add_u32 s29, s29, s16
    s_sub_u32 s16, s3, 4
    v_lshrrev_b32 v20, 3, v1
    v_lshlrev_b32 v20, 3, v20
    s_lshl_b32 s17, s16, 6
    v_add_u32 v20, s17, v20
    s_mov_b32 s17, 7168
    v_mul_lo_u32 v11, s17, v20
    v_and_b32 v20, 7, v1
    v_lshl_add_u32 v11, v20, 4, v11
    s_and_b32 s17, s29, 3
    s_mul_i32 s18, s17, 1835008
    s_lshr_b32 s17, s29, 2
    s_lshl_b32 s17, s17, 7
    s_add_u32 s18, s18, s17
    s_lshl_b32 s15, s16, 13
    s_waitcnt lgkmcnt(3)
    v_mfma_f32_16x16x32_bf16 v[192:195], v[228:231], v[152:155], 0
    s_add_u32 s22, s21, 0x10000
    s_add_u32 m0, s20, 0x20000
    s_nop 0
    buffer_load_dwordx4 v2, s[8:11], s22 offen sc1 lds
    v_mfma_f32_16x16x32_bf16 v[196:199], v[228:231], v[168:171], 0
    ds_read_b128 v[244:247], v4 offset:5120
    s_waitcnt lgkmcnt(3)
    v_mfma_f32_16x16x32_bf16 v[184:187], v[232:235], v[156:159], v[184:187]
    v_mfma_f32_16x16x32_bf16 v[188:191], v[232:235], v[172:175], v[188:191]
    ds_read_b128 v[224:227], v4 offset:6144
    s_waitcnt lgkmcnt(3)
    v_mfma_f32_16x16x32_bf16 v[192:195], v[236:239], v[156:159], v[192:195]
    v_mfma_f32_16x16x32_bf16 v[196:199], v[236:239], v[172:175], v[196:199]
    ds_read_b128 v[228:231], v4 offset:7168
    s_waitcnt lgkmcnt(3)
    v_mfma_f32_16x16x32_bf16 v[184:187], v[240:243], v[160:163], v[184:187]
    v_mfma_f32_16x16x32_bf16 v[188:191], v[240:243], v[176:179], v[188:191]
    ds_read_b128 v[232:235], v4 offset:8192
    s_waitcnt lgkmcnt(3)
    v_mfma_f32_16x16x32_bf16 v[192:195], v[244:247], v[160:163], v[192:195]
    s_add_u32 s22, s21, 0x10400
    s_add_u32 m0, s20, 0x20400
    s_nop 0
    buffer_load_dwordx4 v2, s[8:11], s22 offen sc1 lds
    v_mfma_f32_16x16x32_bf16 v[196:199], v[244:247], v[176:179], v[196:199]
    ds_read_b128 v[236:239], v4 offset:9216
    s_waitcnt lgkmcnt(3)
    v_mfma_f32_16x16x32_bf16 v[184:187], v[224:227], v[164:167], v[184:187]
    v_mfma_f32_16x16x32_bf16 v[188:191], v[224:227], v[180:183], v[188:191]
    ds_read_b128 v[240:243], v4 offset:10240
    s_waitcnt lgkmcnt(3)
    v_mfma_f32_16x16x32_bf16 v[192:195], v[228:231], v[164:167], v[192:195]
    v_mfma_f32_16x16x32_bf16 v[196:199], v[228:231], v[180:183], v[196:199]
    ds_read_b128 v[244:247], v4 offset:11264
    s_waitcnt lgkmcnt(3)
    v_mfma_f32_16x16x32_bf16 v[200:203], v[232:235], v[152:155], 0
    v_mfma_f32_16x16x32_bf16 v[204:207], v[232:235], v[168:171], 0
    ds_read_b128 v[224:227], v4 offset:12288
    s_waitcnt lgkmcnt(3)
    v_mfma_f32_16x16x32_bf16 v[208:211], v[236:239], v[152:155], 0
    v_mfma_f32_16x16x32_bf16 v[212:215], v[236:239], v[168:171], 0
    ds_read_b128 v[228:231], v4 offset:13312
    s_waitcnt lgkmcnt(3)
    v_mfma_f32_16x16x32_bf16 v[200:203], v[240:243], v[156:159], v[200:203]
    v_mfma_f32_16x16x32_bf16 v[204:207], v[240:243], v[172:175], v[204:207]
    ds_read_b128 v[232:235], v4 offset:14336
    s_waitcnt lgkmcnt(3)
    v_mfma_f32_16x16x32_bf16 v[208:211], v[244:247], v[156:159], v[208:211]
    v_max3_f32 v16, v184, v185, v186
    v_mfma_f32_16x16x32_bf16 v[212:215], v[244:247], v[172:175], v[212:215]
    ds_read_b128 v[236:239], v4 offset:15360
    v_max3_f32 v16, v16, v187, v192
    s_waitcnt lgkmcnt(3)
    v_mfma_f32_16x16x32_bf16 v[200:203], v[224:227], v[160:163], v[200:203]
    v_max3_f32 v16, v16, v193, v194
    v_mfma_f32_16x16x32_bf16 v[204:207], v[224:227], v[176:179], v[204:207]
    s_barrier
    ds_read_b128 v[240:243], v4 offset:16384
    v_max_f32 v16, v16, v195
    s_waitcnt lgkmcnt(3)
    v_mfma_f32_16x16x32_bf16 v[208:211], v[228:231], v[160:163], v[208:211]
    v_max3_f32 v17, v188, v189, v190
    v_mfma_f32_16x16x32_bf16 v[212:215], v[228:231], v[176:179], v[212:215]
    s_add_u32 s22, s21, 0x14000
    s_add_u32 m0, s20, 0x24000
    s_nop 0
    buffer_load_dwordx4 v2, s[8:11], s22 offen sc1 lds
    ds_read_b128 v[244:247], v4 offset:17408
    v_max3_f32 v17, v17, v191, v196
    s_waitcnt lgkmcnt(3)
    v_mfma_f32_16x16x32_bf16 v[200:203], v[232:235], v[164:167], v[200:203]
    v_max3_f32 v17, v17, v197, v198
    v_mfma_f32_16x16x32_bf16 v[204:207], v[232:235], v[180:183], v[204:207]
    ds_read_b128 v[224:227], v4 offset:18432
    v_max_f32 v17, v17, v199
    s_waitcnt lgkmcnt(3)
    v_mfma_f32_16x16x32_bf16 v[208:211], v[236:239], v[164:167], v[208:211]
    v_mfma_f32_16x16x32_bf16 v[212:215], v[236:239], v[180:183], v[212:215]
    ds_read_b128 v[228:231], v4 offset:19456
    v_max3_f32 v16, v16, v200, v201
    v_max3_f32 v16, v16, v202, v203
    s_nop 3
    v_max3_f32 v16, v16, v208, v209
    v_max3_f32 v16, v16, v210, v211
    v_max3_f32 v17, v17, v204, v205
    v_max3_f32 v17, v17, v206, v207
    v_max3_f32 v17, v17, v212, v213
    v_max3_f32 v17, v17, v214, v215
    v_mov_b32 v18, v16
    v_mov_b32 v19, v17
    s_nop 0
    v_permlane16_swap_b32 v16, v18
    v_permlane16_swap_b32 v17, v19
    v_max_f32 v16, v16, v18
    v_max_f32 v17, v17, v19
    v_mov_b32 v18, v16
    v_mov_b32 v19, v17
    s_nop 0
    v_permlane32_swap_b32 v16, v18
    v_permlane32_swap_b32 v17, v19
    v_max_f32 v16, v16, v18
    v_max_f32 v17, v17, v19
    v_sub_f32 v216, 0, v16
    v_sub_f32 v217, 0, v16
    v_sub_f32 v218, 0, v16
    v_sub_f32 v219, 0, v16
    v_sub_f32 v220, 0, v17
    v_sub_f32 v221, 0, v17
    v_sub_f32 v222, 0, v17
    v_sub_f32 v223, 0, v17
    v_add_f32 v184, v184, v216
    v_add_f32 v185, v185, v216
    v_exp_f32 v184, v184
    v_exp_f32 v185, v185
    s_nop 0
    v_add_f32 v9, v184, v185
    v_cvt_pk_bf16_f32 v24, v184, v185
    v_add_f32 v186, v186, v216
    v_add_f32 v187, v187, v216
    v_exp_f32 v186, v186
    v_exp_f32 v187, v187
    v_add_f32 v9, v9, v186
    v_add_f32 v9, v9, v187
    v_cvt_pk_bf16_f32 v25, v186, v187
    v_add_f32 v188, v188, v220
    v_add_f32 v189, v189, v220
    v_exp_f32 v188, v188
    v_exp_f32 v189, v189
    s_nop 0
    v_add_f32 v10, v188, v189
    v_cvt_pk_bf16_f32 v28, v188, v189
    v_add_f32 v190, v190, v220
    v_add_f32 v191, v191, v220
    v_exp_f32 v190, v190
    v_exp_f32 v191, v191
    v_add_f32 v10, v10, v190
    v_add_f32 v10, v10, v191
    v_cvt_pk_bf16_f32 v29, v190, v191
    v_add_f32 v192, v192, v216
    v_add_f32 v193, v193, v216
    v_exp_f32 v192, v192
    v_exp_f32 v193, v193
    v_add_f32 v9, v9, v192
    v_add_f32 v9, v9, v193
    v_cvt_pk_bf16_f32 v26, v192, v193
    v_add_f32 v194, v194, v216
    v_add_f32 v195, v195, v216
    v_exp_f32 v194, v194
    v_exp_f32 v195, v195
    v_add_f32 v9, v9, v194
    v_add_f32 v9, v9, v195
    v_cvt_pk_bf16_f32 v27, v194, v195
    v_add_f32 v196, v196, v220
    v_add_f32 v197, v197, v220
    v_exp_f32 v196, v196
    v_exp_f32 v197, v197
    v_add_f32 v10, v10, v196
    v_add_f32 v10, v10, v197
    v_cvt_pk_bf16_f32 v30, v196, v197
    v_add_f32 v198, v198, v220
    v_add_f32 v199, v199, v220
    v_exp_f32 v198, v198
    v_exp_f32 v199, v199
    v_add_f32 v10, v10, v198
    v_add_f32 v10, v10, v199
    v_cvt_pk_bf16_f32 v31, v198, v199
    s_waitcnt lgkmcnt(3)
    v_mfma_f32_16x16x32_bf16 v[184:187], v[240:243], v[152:155], v[216:219]
    v_mfma_f32_16x16x32_bf16 v[188:191], v[240:243], v[168:171], v[220:223]
    ds_read_b128 v[232:235], v4 offset:20480
    v_add_f32 v200, v200, v216
    v_add_f32 v201, v201, v216
    v_exp_f32 v200, v200
    v_exp_f32 v201, v201
    s_waitcnt lgkmcnt(3)
    v_mfma_f32_16x16x32_bf16 v[192:195], v[244:247], v[152:155], v[216:219]
    v_add_f32 v9, v9, v200
    v_add_f32 v9, v9, v201
    v_cvt_pk_bf16_f32 v32, v200, v201
    v_add_f32 v202, v202, v216
    v_mfma_f32_16x16x32_bf16 v[196:199], v[244:247], v[168:171], v[220:223]
    s_add_u32 s22, s21, 0x14400
    s_add_u32 m0, s20, 0x24400
    s_nop 0
    buffer_load_dwordx4 v2, s[8:11], s22 offen sc1 lds
    ds_read_b128 v[236:239], v4 offset:21504
    v_add_f32 v203, v203, v216
    v_exp_f32 v202, v202
    v_exp_f32 v203, v203
    v_add_f32 v9, v9, v202
    s_waitcnt lgkmcnt(3)
    v_mfma_f32_16x16x32_bf16 v[184:187], v[224:227], v[156:159], v[184:187]
    v_add_f32 v9, v9, v203
    v_cvt_pk_bf16_f32 v33, v202, v203
    v_add_f32 v204, v204, v220
    s_add_u32 s22, s18, 0
    s_add_u32 m0, s15, 0
    s_nop 0
    buffer_load_dwordx4 v11, s[64:67], s22 offen lds
    v_mfma_f32_16x16x32_bf16 v[188:191], v[224:227], v[172:175], v[188:191]
    ds_read_b128 v[240:243], v4 offset:22528
    v_add_f32 v205, v205, v220
    v_exp_f32 v204, v204
    v_exp_f32 v205, v205
    v_add_f32 v10, v10, v204
    s_mov_b64 s[4:5], s[40:41]
    s_mov_b32 s6, 0x800000
    s_mov_b32 s7, 0x20000
    v_bfe_u32 v20, v1, 2, 2
    v_lshlrev_b32 v21, 13, v20
    v_sub_u32 v3, v3, v21
    v_lshl_add_u32 v3, v20, 11, v3
    s_and_b32 s16, s2, 1
    s_lshl_b32 s24, s16, 22
    s_lshr_b32 s16, s2, 5
    s_lshl_b32 s16, s16, 8
    s_add_u32 s24, s24, s16
    s_lshl_b32 s16, s3, 14
    s_add_u32 s24, s24, s16
    s_add_u32 s24, s24, 196608
    s_waitcnt lgkmcnt(3)
    v_mfma_f32_16x16x32_bf16 v[192:195], v[228:231], v[156:159], v[192:195]
    v_add_f32 v10, v10, v205
    v_cvt_pk_bf16_f32 v36, v204, v205
    v_add_f32 v206, v206, v220
    v_add_f32 v207, v207, v220
    v_mfma_f32_16x16x32_bf16 v[196:199], v[228:231], v[172:175], v[196:199]
    ds_read_b128 v[244:247], v4 offset:23552
    v_exp_f32 v206, v206
    v_exp_f32 v207, v207
    v_add_f32 v10, v10, v206
    v_add_f32 v10, v10, v207
    s_waitcnt lgkmcnt(3)
    v_mfma_f32_16x16x32_bf16 v[184:187], v[232:235], v[160:163], v[184:187]
    v_cvt_pk_bf16_f32 v37, v206, v207
    v_add_f32 v208, v208, v216
    v_add_f32 v209, v209, v216
    s_mov_b64 s[72:73], s[40:41]
    s_mov_b32 s74, 0x800000
    s_mov_b32 s75, 0x20000
    v_lshlrev_b32 v21, 7, v1
    s_lshl_b32 s16, s2, 2
    s_add_u32 s16, s16, s3
    s_sub_u32 s16, s16, 4
    s_lshl_b32 s16, s16, 13
    buffer_load_dword v15, v21, s[72:75], s16 offen
    v_mfma_f32_16x16x32_bf16 v[188:191], v[232:235], v[176:179], v[188:191]
    ds_read_b128 v[224:227], v4 offset:24576
    v_exp_f32 v208, v208
    v_exp_f32 v209, v209
    v_add_f32 v9, v9, v208
    v_add_f32 v9, v9, v209
    s_waitcnt lgkmcnt(3)
    v_mfma_f32_16x16x32_bf16 v[192:195], v[236:239], v[160:163], v[192:195]
    v_cvt_pk_bf16_f32 v34, v208, v209
    v_add_f32 v210, v210, v216
    v_add_f32 v211, v211, v216
    v_exp_f32 v210, v210
    v_mfma_f32_16x16x32_bf16 v[196:199], v[236:239], v[176:179], v[196:199]
    ds_read_b128 v[228:231], v4 offset:25600
    v_exp_f32 v211, v211
    v_add_f32 v9, v9, v210
    v_add_f32 v9, v9, v211
    v_cvt_pk_bf16_f32 v35, v210, v211
    s_waitcnt lgkmcnt(3)
    v_mfma_f32_16x16x32_bf16 v[184:187], v[240:243], v[164:167], v[184:187]
    v_add_f32 v212, v212, v220
    v_add_f32 v213, v213, v220
    v_exp_f32 v212, v212
    v_mfma_f32_16x16x32_bf16 v[188:191], v[240:243], v[180:183], v[188:191]
    ds_read_b128 v[232:235], v4 offset:26624
    v_exp_f32 v213, v213
    v_add_f32 v10, v10, v212
    v_add_f32 v10, v10, v213
    v_cvt_pk_bf16_f32 v38, v212, v213
    s_waitcnt lgkmcnt(3)
    v_mfma_f32_16x16x32_bf16 v[192:195], v[244:247], v[164:167], v[192:195]
    v_add_f32 v214, v214, v220
    v_add_f32 v215, v215, v220
    v_exp_f32 v214, v214
    v_exp_f32 v215, v215
    v_mfma_f32_16x16x32_bf16 v[196:199], v[244:247], v[180:183], v[196:199]
    ds_read_b128 v[236:239], v4 offset:27648
    v_add_f32 v10, v10, v214
    v_add_f32 v10, v10, v215
    v_cvt_pk_bf16_f32 v39, v214, v215
    s_waitcnt lgkmcnt(3)
    v_mfma_f32_16x16x32_bf16 v[200:203], v[224:227], v[152:155], v[216:219]
    s_add_u32 s22, s18, 0
    s_add_u32 m0, s15, 32768
    s_nop 0
    buffer_load_dwordx4 v11, s[68:71], s22 offen lds
    v_mfma_f32_16x16x32_bf16 v[204:207], v[224:227], v[168:171], v[220:223]
    ds_read_b128 v[240:243], v4 offset:28672
    v_exp_f32 v184, v184
    v_exp_f32 v185, v185
    v_add_f32 v9, v9, v184
    s_waitcnt lgkmcnt(3)
    v_mfma_f32_16x16x32_bf16 v[208:211], v[228:231], v[152:155], v[216:219]
    v_add_f32 v9, v9, v185
    v_cvt_pk_bf16_f32 v40, v184, v185
    v_exp_f32 v186, v186
    v_mfma_f32_16x16x32_bf16 v[212:215], v[228:231], v[168:171], v[220:223]
    ds_read_b128 v[244:247], v4 offset:29696
    v_exp_f32 v187, v187
    v_add_f32 v9, v9, v186
    s_waitcnt lgkmcnt(3)
    v_mfma_f32_16x16x32_bf16 v[200:203], v[232:235], v[156:159], v[200:203]
    v_add_f32 v9, v9, v187
    v_cvt_pk_bf16_f32 v41, v186, v187
    v_exp_f32 v188, v188
    v_mfma_f32_16x16x32_bf16 v[204:207], v[232:235], v[172:175], v[204:207]
    ds_read_b128 v[224:227], v4 offset:30720
    v_exp_f32 v189, v189
    v_add_f32 v10, v10, v188
    v_add_f32 v10, v10, v189
    s_waitcnt lgkmcnt(3)
    v_mfma_f32_16x16x32_bf16 v[208:211], v[236:239], v[156:159], v[208:211]
    v_cvt_pk_bf16_f32 v44, v188, v189
    v_exp_f32 v190, v190
    v_mfma_f32_16x16x32_bf16 v[212:215], v[236:239], v[172:175], v[212:215]
    ds_read_b128 v[228:231], v4 offset:31744
    v_exp_f32 v191, v191
    v_add_f32 v10, v10, v190
    v_add_f32 v10, v10, v191
    s_waitcnt lgkmcnt(3)
    v_mfma_f32_16x16x32_bf16 v[200:203], v[240:243], v[160:163], v[200:203]
    v_cvt_pk_bf16_f32 v45, v190, v191
    v_exp_f32 v192, v192
    v_exp_f32 v193, v193
    v_mfma_f32_16x16x32_bf16 v[204:207], v[240:243], v[176:179], v[204:207]
    s_barrier
    ds_read_b128 v[232:235], v4 offset:32768
    v_add_f32 v9, v9, v192
    v_add_f32 v9, v9, v193
    s_waitcnt lgkmcnt(3)
    v_mfma_f32_16x16x32_bf16 v[208:211], v[244:247], v[160:163], v[208:211]
    v_cvt_pk_bf16_f32 v42, v192, v193
    v_exp_f32 v194, v194
    v_exp_f32 v195, v195
    v_mfma_f32_16x16x32_bf16 v[212:215], v[244:247], v[176:179], v[212:215]
    s_add_u32 s22, s21, 0x18000
    s_add_u32 m0, s20, 0x10000
    s_nop 0
    buffer_load_dwordx4 v2, s[8:11], s22 offen sc1 lds
    ds_read_b128 v[236:239], v4 offset:33792
    v_add_f32 v9, v9, v194
    v_add_f32 v9, v9, v195
    v_cvt_pk_bf16_f32 v43, v194, v195
    s_waitcnt lgkmcnt(3)
    v_mfma_f32_16x16x32_bf16 v[200:203], v[224:227], v[164:167], v[200:203]
    v_exp_f32 v196, v196
    v_exp_f32 v197, v197
    v_mfma_f32_16x16x32_bf16 v[204:207], v[224:227], v[180:183], v[204:207]
    ds_read_b128 v[240:243], v4 offset:34816
    v_add_f32 v10, v10, v196
    v_add_f32 v10, v10, v197
    v_cvt_pk_bf16_f32 v46, v196, v197
    s_add_u32 s22, s18, 7168
    s_add_u32 m0, s15, 1024
    s_nop 0
    buffer_load_dwordx4 v11, s[64:67], s22 offen lds
    s_waitcnt lgkmcnt(3)
    v_mfma_f32_16x16x32_bf16 v[208:211], v[228:231], v[164:167], v[208:211]
    v_exp_f32 v198, v198
    v_exp_f32 v199, v199
    v_add_f32 v10, v10, v198
    v_mfma_f32_16x16x32_bf16 v[212:215], v[228:231], v[180:183], v[212:215]
    ds_read_b128 v[244:247], v4 offset:35840
    v_add_f32 v10, v10, v199
    v_cvt_pk_bf16_f32 v47, v198, v199
    s_waitcnt lgkmcnt(3)
    v_mfma_f32_16x16x32_bf16 v[184:187], v[232:235], v[152:155], v[216:219]
    v_mfma_f32_16x16x32_bf16 v[188:191], v[232:235], v[168:171], v[220:223]
    ds_read_b128 v[224:227], v4 offset:36864
    v_exp_f32 v200, v200
    v_exp_f32 v201, v201
    v_add_f32 v9, v9, v200
    s_waitcnt lgkmcnt(3)
    v_mfma_f32_16x16x32_bf16 v[192:195], v[236:239], v[152:155], v[216:219]
    v_add_f32 v9, v9, v201
    v_cvt_pk_bf16_f32 v48, v200, v201
    v_exp_f32 v202, v202
    v_mfma_f32_16x16x32_bf16 v[196:199], v[236:239], v[168:171], v[220:223]
    s_add_u32 s22, s21, 0x18400
    s_add_u32 m0, s20, 0x10400
    s_nop 0
    buffer_load_dwordx4 v2, s[8:11], s22 offen sc1 lds
    ds_read_b128 v[228:231], v4 offset:37888
    v_exp_f32 v203, v203
    v_add_f32 v9, v9, v202
    s_waitcnt lgkmcnt(3)
    v_mfma_f32_16x16x32_bf16 v[184:187], v[240:243], v[156:159], v[184:187]
    v_add_f32 v9, v9, v203
    v_cvt_pk_bf16_f32 v49, v202, v203
    v_exp_f32 v204, v204
    v_mfma_f32_16x16x32_bf16 v[188:191], v[240:243], v[172:175], v[188:191]
    ds_read_b128 v[232:235], v4 offset:38912
    v_exp_f32 v205, v205
    v_add_f32 v10, v10, v204
    v_add_f32 v10, v10, v205
    s_waitcnt lgkmcnt(3)
    v_mfma_f32_16x16x32_bf16 v[192:195], v[244:247], v[156:159], v[192:195]
    v_cvt_pk_bf16_f32 v52, v204, v205
    v_exp_f32 v206, v206
    v_mfma_f32_16x16x32_bf16 v[196:199], v[244:247], v[172:175], v[196:199]
    ds_read_b128 v[236:239], v4 offset:39936
    v_exp_f32 v207, v207
    v_add_f32 v10, v10, v206
    v_add_f32 v10, v10, v207
    s_waitcnt lgkmcnt(3)
    v_mfma_f32_16x16x32_bf16 v[184:187], v[224:227], v[160:163], v[184:187]
    v_cvt_pk_bf16_f32 v53, v206, v207
    v_exp_f32 v208, v208
    v_exp_f32 v209, v209
    v_mfma_f32_16x16x32_bf16 v[188:191], v[224:227], v[176:179], v[188:191]
    ds_read_b128 v[240:243], v4 offset:40960
    v_add_f32 v9, v9, v208
    v_add_f32 v9, v9, v209
    s_add_u32 s22, s18, 7168
    s_add_u32 m0, s15, 33792
    s_nop 0
    buffer_load_dwordx4 v11, s[68:71], s22 offen lds
    s_waitcnt lgkmcnt(3)
    v_mfma_f32_16x16x32_bf16 v[192:195], v[228:231], v[160:163], v[192:195]
    v_cvt_pk_bf16_f32 v50, v208, v209
    v_exp_f32 v210, v210
    v_exp_f32 v211, v211
    v_mfma_f32_16x16x32_bf16 v[196:199], v[228:231], v[176:179], v[196:199]
    ds_read_b128 v[244:247], v4 offset:41984
    v_add_f32 v9, v9, v210
    v_add_f32 v9, v9, v211
    v_cvt_pk_bf16_f32 v51, v210, v211
    s_waitcnt lgkmcnt(3)
    v_mfma_f32_16x16x32_bf16 v[184:187], v[232:235], v[164:167], v[184:187]
    v_exp_f32 v212, v212
    v_exp_f32 v213, v213
    v_mfma_f32_16x16x32_bf16 v[188:191], v[232:235], v[180:183], v[188:191]
    ds_read_b128 v[224:227], v4 offset:43008
    v_add_f32 v10, v10, v212
    v_add_f32 v10, v10, v213
    v_cvt_pk_bf16_f32 v54, v212, v213
    s_waitcnt lgkmcnt(3)
    v_mfma_f32_16x16x32_bf16 v[192:195], v[236:239], v[164:167], v[192:195]
    v_exp_f32 v214, v214
    v_exp_f32 v215, v215
    v_add_f32 v10, v10, v214
    v_mfma_f32_16x16x32_bf16 v[196:199], v[236:239], v[180:183], v[196:199]
    ds_read_b128 v[228:231], v4 offset:44032
    v_add_f32 v10, v10, v215
    v_cvt_pk_bf16_f32 v55, v214, v215
    s_waitcnt lgkmcnt(3)
    v_mfma_f32_16x16x32_bf16 v[200:203], v[240:243], v[152:155], v[216:219]
    v_mfma_f32_16x16x32_bf16 v[204:207], v[240:243], v[168:171], v[220:223]
    ds_read_b128 v[232:235], v4 offset:45056
    v_exp_f32 v184, v184
    v_exp_f32 v185, v185
    v_add_f32 v9, v9, v184
    s_waitcnt lgkmcnt(3)
    v_mfma_f32_16x16x32_bf16 v[208:211], v[244:247], v[152:155], v[216:219]
    v_add_f32 v9, v9, v185
    v_cvt_pk_bf16_f32 v56, v184, v185
    v_exp_f32 v186, v186
    v_mfma_f32_16x16x32_bf16 v[212:215], v[244:247], v[168:171], v[220:223]
    ds_read_b128 v[236:239], v4 offset:46080
    v_exp_f32 v187, v187
    v_add_f32 v9, v9, v186
    s_waitcnt lgkmcnt(3)
    v_mfma_f32_16x16x32_bf16 v[200:203], v[224:227], v[156:159], v[200:203]
    v_add_f32 v9, v9, v187
    v_cvt_pk_bf16_f32 v57, v186, v187
    v_exp_f32 v188, v188
    v_mfma_f32_16x16x32_bf16 v[204:207], v[224:227], v[172:175], v[204:207]
    ds_read_b128 v[240:243], v4 offset:47104
    v_exp_f32 v189, v189
    v_add_f32 v10, v10, v188
    v_add_f32 v10, v10, v189
    s_waitcnt lgkmcnt(3)
    v_mfma_f32_16x16x32_bf16 v[208:211], v[228:231], v[156:159], v[208:211]
    v_cvt_pk_bf16_f32 v60, v188, v189
    v_exp_f32 v190, v190
    s_add_u32 s22, s18, 14336
    s_add_u32 m0, s15, 2048
    s_nop 0
    buffer_load_dwordx4 v11, s[64:67], s22 offen lds
    v_mfma_f32_16x16x32_bf16 v[212:215], v[228:231], v[172:175], v[212:215]
    ds_read_b128 v[244:247], v4 offset:48128
    v_exp_f32 v191, v191
    v_add_f32 v10, v10, v190
    v_add_f32 v10, v10, v191
    s_waitcnt lgkmcnt(3)
    v_mfma_f32_16x16x32_bf16 v[200:203], v[232:235], v[160:163], v[200:203]
    v_cvt_pk_bf16_f32 v61, v190, v191
    v_exp_f32 v192, v192
    v_exp_f32 v193, v193
    v_mfma_f32_16x16x32_bf16 v[204:207], v[232:235], v[176:179], v[204:207]
    s_barrier
    ds_read_b128 v[224:227], v4 offset:49152
    v_add_f32 v9, v9, v192
    v_add_f32 v9, v9, v193
    s_waitcnt lgkmcnt(3)
    v_mfma_f32_16x16x32_bf16 v[208:211], v[236:239], v[160:163], v[208:211]
    v_cvt_pk_bf16_f32 v58, v192, v193
    v_exp_f32 v194, v194
    v_exp_f32 v195, v195
    v_mfma_f32_16x16x32_bf16 v[212:215], v[236:239], v[176:179], v[212:215]
    s_add_u32 s22, s21, 0x1c000
    s_add_u32 m0, s20, 0x14000
    s_nop 0
    buffer_load_dwordx4 v2, s[8:11], s22 offen sc1 lds
    ds_read_b128 v[228:231], v4 offset:50176
    v_add_f32 v9, v9, v194
    v_add_f32 v9, v9, v195
    v_cvt_pk_bf16_f32 v59, v194, v195
    s_waitcnt lgkmcnt(3)
    v_mfma_f32_16x16x32_bf16 v[200:203], v[240:243], v[164:167], v[200:203]
    v_exp_f32 v196, v196
    v_exp_f32 v197, v197
    v_mfma_f32_16x16x32_bf16 v[204:207], v[240:243], v[180:183], v[204:207]
    ds_read_b128 v[232:235], v4 offset:51200
    v_add_f32 v10, v10, v196
    v_add_f32 v10, v10, v197
    v_cvt_pk_bf16_f32 v62, v196, v197
    s_waitcnt lgkmcnt(3)
    v_mfma_f32_16x16x32_bf16 v[208:211], v[244:247], v[164:167], v[208:211]
    v_exp_f32 v198, v198
    v_exp_f32 v199, v199
    v_add_f32 v10, v10, v198
    v_mfma_f32_16x16x32_bf16 v[212:215], v[244:247], v[180:183], v[212:215]
    ds_read_b128 v[236:239], v4 offset:52224
    v_add_f32 v10, v10, v199
    v_cvt_pk_bf16_f32 v63, v198, v199
    s_waitcnt lgkmcnt(3)
    v_mfma_f32_16x16x32_bf16 v[184:187], v[224:227], v[152:155], v[216:219]
    v_mfma_f32_16x16x32_bf16 v[188:191], v[224:227], v[168:171], v[220:223]
    ds_read_b128 v[240:243], v4 offset:53248
    v_exp_f32 v200, v200
    v_exp_f32 v201, v201
    v_add_f32 v9, v9, v200
    s_waitcnt lgkmcnt(3)
    v_mfma_f32_16x16x32_bf16 v[192:195], v[228:231], v[152:155], v[216:219]
    v_add_f32 v9, v9, v201
    v_cvt_pk_bf16_f32 v64, v200, v201
    v_exp_f32 v202, v202
    s_add_u32 s22, s18, 14336
    s_add_u32 m0, s15, 34816
    s_nop 0
    buffer_load_dwordx4 v11, s[68:71], s22 offen lds
    v_mfma_f32_16x16x32_bf16 v[196:199], v[228:231], v[168:171], v[220:223]
    s_add_u32 s22, s21, 0x1c400
    s_add_u32 m0, s20, 0x14400
    s_nop 0
    buffer_load_dwordx4 v2, s[8:11], s22 offen sc1 lds
    ds_read_b128 v[244:247], v4 offset:54272
    v_exp_f32 v203, v203
    v_add_f32 v9, v9, v202
    s_waitcnt lgkmcnt(3)
    v_mfma_f32_16x16x32_bf16 v[184:187], v[232:235], v[156:159], v[184:187]
    v_add_f32 v9, v9, v203
    v_cvt_pk_bf16_f32 v65, v202, v203
    v_exp_f32 v204, v204
    v_mfma_f32_16x16x32_bf16 v[188:191], v[232:235], v[172:175], v[188:191]
    ds_read_b128 v[224:227], v4 offset:55296
    v_exp_f32 v205, v205
    v_add_f32 v10, v10, v204
    v_add_f32 v10, v10, v205
    s_waitcnt lgkmcnt(3)
    v_mfma_f32_16x16x32_bf16 v[192:195], v[236:239], v[156:159], v[192:195]
    v_cvt_pk_bf16_f32 v68, v204, v205
    v_exp_f32 v206, v206
    v_mfma_f32_16x16x32_bf16 v[196:199], v[236:239], v[172:175], v[196:199]
    ds_read_b128 v[228:231], v4 offset:56320
    v_exp_f32 v207, v207
    v_add_f32 v10, v10, v206
    v_add_f32 v10, v10, v207
    s_waitcnt lgkmcnt(3)
    v_mfma_f32_16x16x32_bf16 v[184:187], v[240:243], v[160:163], v[184:187]
    v_cvt_pk_bf16_f32 v69, v206, v207
    v_exp_f32 v208, v208
    v_exp_f32 v209, v209
    v_mfma_f32_16x16x32_bf16 v[188:191], v[240:243], v[176:179], v[188:191]
    ds_read_b128 v[232:235], v4 offset:57344
    v_add_f32 v9, v9, v208
    v_add_f32 v9, v9, v209
    s_waitcnt lgkmcnt(3)
    v_mfma_f32_16x16x32_bf16 v[192:195], v[244:247], v[160:163], v[192:195]
    v_cvt_pk_bf16_f32 v66, v208, v209
    v_exp_f32 v210, v210
    v_exp_f32 v211, v211
    v_mfma_f32_16x16x32_bf16 v[196:199], v[244:247], v[176:179], v[196:199]
    ds_read_b128 v[236:239], v4 offset:58368
    v_add_f32 v9, v9, v210
    v_add_f32 v9, v9, v211
    v_cvt_pk_bf16_f32 v67, v210, v211
    s_waitcnt lgkmcnt(3)
    v_mfma_f32_16x16x32_bf16 v[184:187], v[224:227], v[164:167], v[184:187]
    v_exp_f32 v212, v212
    v_exp_f32 v213, v213
    v_mfma_f32_16x16x32_bf16 v[188:191], v[224:227], v[180:183], v[188:191]
    ds_read_b128 v[240:243], v4 offset:59392
    v_add_f32 v10, v10, v212
    v_add_f32 v10, v10, v213
    v_cvt_pk_bf16_f32 v70, v212, v213
    s_waitcnt lgkmcnt(3)
    v_mfma_f32_16x16x32_bf16 v[192:195], v[228:231], v[164:167], v[192:195]
    v_exp_f32 v214, v214
    v_exp_f32 v215, v215
    v_add_f32 v10, v10, v214
    v_mfma_f32_16x16x32_bf16 v[196:199], v[228:231], v[180:183], v[196:199]
    ds_read_b128 v[244:247], v4 offset:60416
    v_add_f32 v10, v10, v215
    v_cvt_pk_bf16_f32 v71, v214, v215
    s_add_u32 s22, s18, 21504
    s_add_u32 m0, s15, 3072
    s_nop 0
    buffer_load_dwordx4 v11, s[64:67], s22 offen lds
    s_waitcnt lgkmcnt(3)
    v_mfma_f32_16x16x32_bf16 v[200:203], v[232:235], v[152:155], v[216:219]
    v_mfma_f32_16x16x32_bf16 v[204:207], v[232:235], v[168:171], v[220:223]
    ds_read_b128 v[224:227], v4 offset:61440
    v_exp_f32 v184, v184
    v_exp_f32 v185, v185
    v_add_f32 v9, v9, v184
    s_waitcnt lgkmcnt(3)
    v_mfma_f32_16x16x32_bf16 v[208:211], v[236:239], v[152:155], v[216:219]
    v_add_f32 v9, v9, v185
    v_cvt_pk_bf16_f32 v72, v184, v185
    v_exp_f32 v186, v186
    v_mfma_f32_16x16x32_bf16 v[212:215], v[236:239], v[168:171], v[220:223]
    ds_read_b128 v[228:231], v4 offset:62464
    v_exp_f32 v187, v187
    v_add_f32 v9, v9, v186
    s_waitcnt lgkmcnt(3)
    v_mfma_f32_16x16x32_bf16 v[200:203], v[240:243], v[156:159], v[200:203]
    v_add_f32 v9, v9, v187
    v_cvt_pk_bf16_f32 v73, v186, v187
    v_exp_f32 v188, v188
    v_mfma_f32_16x16x32_bf16 v[204:207], v[240:243], v[172:175], v[204:207]
    ds_read_b128 v[232:235], v4 offset:63488
    v_exp_f32 v189, v189
    v_add_f32 v10, v10, v188
    v_add_f32 v10, v10, v189
    s_waitcnt lgkmcnt(3)
    v_mfma_f32_16x16x32_bf16 v[208:211], v[244:247], v[156:159], v[208:211]
    v_cvt_pk_bf16_f32 v76, v188, v189
    v_exp_f32 v190, v190
    v_mfma_f32_16x16x32_bf16 v[212:215], v[244:247], v[172:175], v[212:215]
    ds_read_b128 v[236:239], v4 offset:64512
    v_exp_f32 v191, v191
    v_add_f32 v10, v10, v190
    v_add_f32 v10, v10, v191
    s_waitcnt lgkmcnt(3)
    v_mfma_f32_16x16x32_bf16 v[200:203], v[224:227], v[160:163], v[200:203]
    v_cvt_pk_bf16_f32 v77, v190, v191
    v_exp_f32 v192, v192
    v_exp_f32 v193, v193
    v_mfma_f32_16x16x32_bf16 v[204:207], v[224:227], v[176:179], v[204:207]
    s_waitcnt vmcnt(14)
    s_barrier
    ds_read_b128 v[240:243], v5 offset:0
    v_add_f32 v9, v9, v192
    v_add_f32 v9, v9, v193
    s_waitcnt lgkmcnt(3)
    v_mfma_f32_16x16x32_bf16 v[208:211], v[228:231], v[160:163], v[208:211]
    v_cvt_pk_bf16_f32 v74, v192, v193
    v_exp_f32 v194, v194
    v_exp_f32 v195, v195
    v_mfma_f32_16x16x32_bf16 v[212:215], v[228:231], v[176:179], v[212:215]
    s_add_u32 s22, s21, 0x80000
    s_add_u32 m0, s20, 0x18000
    s_nop 0
    buffer_load_dwordx4 v2, s[8:11], s22 offen sc1 lds
    ds_read_b128 v[244:247], v5 offset:1024
    v_add_f32 v9, v9, v194
    v_add_f32 v9, v9, v195
    v_cvt_pk_bf16_f32 v75, v194, v195
    s_add_u32 s22, s18, 21504
    s_add_u32 m0, s15, 35840
    s_nop 0
    buffer_load_dwordx4 v11, s[68:71], s22 offen lds
    s_waitcnt lgkmcnt(3)
    v_mfma_f32_16x16x32_bf16 v[200:203], v[232:235], v[164:167], v[200:203]
    v_exp_f32 v196, v196
    v_exp_f32 v197, v197
    v_mfma_f32_16x16x32_bf16 v[204:207], v[232:235], v[180:183], v[204:207]
    ds_read_b128 v[224:227], v5 offset:2048
    v_add_f32 v10, v10, v196
    v_add_f32 v10, v10, v197
    v_cvt_pk_bf16_f32 v78, v196, v197
    s_waitcnt lgkmcnt(3)
    v_mfma_f32_16x16x32_bf16 v[208:211], v[236:239], v[164:167], v[208:211]
    v_exp_f32 v198, v198
    v_exp_f32 v199, v199
    v_add_f32 v10, v10, v198
    v_mfma_f32_16x16x32_bf16 v[212:215], v[236:239], v[180:183], v[212:215]
    ds_read_b128 v[228:231], v5 offset:3072
    v_add_f32 v10, v10, v199
    v_cvt_pk_bf16_f32 v79, v198, v199
    s_waitcnt lgkmcnt(3)
    v_mfma_f32_16x16x32_bf16 v[184:187], v[240:243], v[152:155], v[216:219]
    v_mfma_f32_16x16x32_bf16 v[188:191], v[240:243], v[168:171], v[220:223]
    ds_read_b128 v[232:235], v5 offset:4096
    v_exp_f32 v200, v200
    v_exp_f32 v201, v201
    v_add_f32 v9, v9, v200
    s_waitcnt lgkmcnt(3)
    v_mfma_f32_16x16x32_bf16 v[192:195], v[244:247], v[152:155], v[216:219]
    v_add_f32 v9, v9, v201
    v_cvt_pk_bf16_f32 v80, v200, v201
    v_exp_f32 v202, v202
    v_mfma_f32_16x16x32_bf16 v[196:199], v[244:247], v[168:171], v[220:223]
    s_add_u32 s22, s21, 0x80400
    s_add_u32 m0, s20, 0x18400
    s_nop 0
    buffer_load_dwordx4 v2, s[8:11], s22 offen sc1 lds
    ds_read_b128 v[236:239], v5 offset:5120
    v_exp_f32 v203, v203
    v_add_f32 v9, v9, v202
    s_waitcnt lgkmcnt(3)
    v_mfma_f32_16x16x32_bf16 v[184:187], v[224:227], v[156:159], v[184:187]
    v_add_f32 v9, v9, v203
    v_cvt_pk_bf16_f32 v81, v202, v203
    v_exp_f32 v204, v204
    v_mfma_f32_16x16x32_bf16 v[188:191], v[224:227], v[172:175], v[188:191]
    ds_read_b128 v[240:243], v5 offset:6144
    v_exp_f32 v205, v205
    v_add_f32 v10, v10, v204
    v_add_f32 v10, v10, v205
    s_waitcnt lgkmcnt(3)
    v_mfma_f32_16x16x32_bf16 v[192:195], v[228:231], v[156:159], v[192:195]
    v_cvt_pk_bf16_f32 v84, v204, v205
    v_exp_f32 v206, v206
    v_mfma_f32_16x16x32_bf16 v[196:199], v[228:231], v[172:175], v[196:199]
    ds_read_b128 v[244:247], v5 offset:7168
    v_exp_f32 v207, v207
    v_add_f32 v10, v10, v206
    v_add_f32 v10, v10, v207
    s_waitcnt lgkmcnt(3)
    v_mfma_f32_16x16x32_bf16 v[184:187], v[232:235], v[160:163], v[184:187]
    v_cvt_pk_bf16_f32 v85, v206, v207
    v_exp_f32 v208, v208
    v_exp_f32 v209, v209
    s_add_u32 s22, s18, 28672
    s_add_u32 m0, s15, 4096
    s_nop 0
    buffer_load_dwordx4 v11, s[64:67], s22 offen lds
    v_mfma_f32_16x16x32_bf16 v[188:191], v[232:235], v[176:179], v[188:191]
    ds_read_b128 v[224:227], v5 offset:8192
    v_add_f32 v9, v9, v208
    v_add_f32 v9, v9, v209
    s_waitcnt lgkmcnt(3)
    v_mfma_f32_16x16x32_bf16 v[192:195], v[236:239], v[160:163], v[192:195]
    v_cvt_pk_bf16_f32 v82, v208, v209
    v_exp_f32 v210, v210
    v_exp_f32 v211, v211
    v_mfma_f32_16x16x32_bf16 v[196:199], v[236:239], v[176:179], v[196:199]
    ds_read_b128 v[228:231], v5 offset:9216
    v_add_f32 v9, v9, v210
    v_add_f32 v9, v9, v211
    v_cvt_pk_bf16_f32 v83, v210, v211
    s_waitcnt lgkmcnt(3)
    v_mfma_f32_16x16x32_bf16 v[184:187], v[240:243], v[164:167], v[184:187]
    v_exp_f32 v212, v212
    v_exp_f32 v213, v213
    v_mfma_f32_16x16x32_bf16 v[188:191], v[240:243], v[180:183], v[188:191]
    ds_read_b128 v[232:235], v5 offset:10240
    v_add_f32 v10, v10, v212
    v_add_f32 v10, v10, v213
    v_cvt_pk_bf16_f32 v86, v212, v213
    s_waitcnt lgkmcnt(3)
    v_mfma_f32_16x16x32_bf16 v[192:195], v[244:247], v[164:167], v[192:195]
    v_exp_f32 v214, v214
    v_exp_f32 v215, v215
    v_add_f32 v10, v10, v214
    v_mfma_f32_16x16x32_bf16 v[196:199], v[244:247], v[180:183], v[196:199]
    ds_read_b128 v[236:239], v5 offset:11264
    v_add_f32 v10, v10, v215
    v_cvt_pk_bf16_f32 v87, v214, v215
    s_waitcnt lgkmcnt(3)
    v_mfma_f32_16x16x32_bf16 v[200:203], v[224:227], v[152:155], v[216:219]
    v_mfma_f32_16x16x32_bf16 v[204:207], v[224:227], v[168:171], v[220:223]
    ds_read_b128 v[240:243], v5 offset:12288
    v_exp_f32 v184, v184
    v_exp_f32 v185, v185
    v_add_f32 v9, v9, v184
    s_waitcnt lgkmcnt(3)
    v_mfma_f32_16x16x32_bf16 v[208:211], v[228:231], v[152:155], v[216:219]
    v_add_f32 v9, v9, v185
    v_cvt_pk_bf16_f32 v88, v184, v185
    v_exp_f32 v186, v186
    v_mfma_f32_16x16x32_bf16 v[212:215], v[228:231], v[168:171], v[220:223]
    ds_read_b128 v[244:247], v5 offset:13312
    v_exp_f32 v187, v187
    v_add_f32 v9, v9, v186
    s_waitcnt lgkmcnt(3)
    v_mfma_f32_16x16x32_bf16 v[200:203], v[232:235], v[156:159], v[200:203]
    v_add_f32 v9, v9, v187
    v_cvt_pk_bf16_f32 v89, v186, v187
    v_exp_f32 v188, v188
    s_add_u32 s22, s18, 28672
    s_add_u32 m0, s15, 36864
    s_nop 0
    buffer_load_dwordx4 v11, s[68:71], s22 offen lds
    v_mfma_f32_16x16x32_bf16 v[204:207], v[232:235], v[172:175], v[204:207]
    ds_read_b128 v[224:227], v5 offset:14336
    v_exp_f32 v189, v189
    v_add_f32 v10, v10, v188
    v_add_f32 v10, v10, v189
    s_waitcnt lgkmcnt(3)
    v_mfma_f32_16x16x32_bf16 v[208:211], v[236:239], v[156:159], v[208:211]
    v_cvt_pk_bf16_f32 v92, v188, v189
    v_exp_f32 v190, v190
    v_mfma_f32_16x16x32_bf16 v[212:215], v[236:239], v[172:175], v[212:215]
    ds_read_b128 v[228:231], v5 offset:15360
    v_exp_f32 v191, v191
    v_add_f32 v10, v10, v190
    v_add_f32 v10, v10, v191
    s_waitcnt lgkmcnt(3)
    v_mfma_f32_16x16x32_bf16 v[200:203], v[240:243], v[160:163], v[200:203]
    v_cvt_pk_bf16_f32 v93, v190, v191
    v_exp_f32 v192, v192
    v_exp_f32 v193, v193
    v_mfma_f32_16x16x32_bf16 v[204:207], v[240:243], v[176:179], v[204:207]
    s_waitcnt vmcnt(17)
    s_barrier
    ds_read_b128 v[232:235], v5 offset:16384
    v_add_f32 v9, v9, v192
    v_add_f32 v9, v9, v193
    s_waitcnt lgkmcnt(3)
    v_mfma_f32_16x16x32_bf16 v[208:211], v[244:247], v[160:163], v[208:211]
    v_cvt_pk_bf16_f32 v90, v192, v193
    v_exp_f32 v194, v194
    v_exp_f32 v195, v195
    v_mfma_f32_16x16x32_bf16 v[212:215], v[244:247], v[176:179], v[212:215]
    s_add_u32 s22, s21, 0x84000
    s_add_u32 m0, s20, 0x1c000
    s_nop 0
    buffer_load_dwordx4 v2, s[8:11], s22 offen sc1 lds
    ds_read_b128 v[236:239], v5 offset:17408
    v_add_f32 v9, v9, v194
    v_add_f32 v9, v9, v195
    v_cvt_pk_bf16_f32 v91, v194, v195
    s_waitcnt lgkmcnt(3)
    v_mfma_f32_16x16x32_bf16 v[200:203], v[224:227], v[164:167], v[200:203]
    v_exp_f32 v196, v196
    v_exp_f32 v197, v197
    v_mfma_f32_16x16x32_bf16 v[204:207], v[224:227], v[180:183], v[204:207]
    ds_read_b128 v[240:243], v5 offset:18432
    v_add_f32 v10, v10, v196
    v_add_f32 v10, v10, v197
    v_cvt_pk_bf16_f32 v94, v196, v197
    s_waitcnt lgkmcnt(3)
    v_mfma_f32_16x16x32_bf16 v[208:211], v[228:231], v[164:167], v[208:211]
    v_exp_f32 v198, v198
    v_exp_f32 v199, v199
    v_add_f32 v10, v10, v198
    v_mfma_f32_16x16x32_bf16 v[212:215], v[228:231], v[180:183], v[212:215]
    ds_read_b128 v[244:247], v5 offset:19456
    v_add_f32 v10, v10, v199
    v_cvt_pk_bf16_f32 v95, v198, v199
    s_waitcnt lgkmcnt(3)
    v_mfma_f32_16x16x32_bf16 v[184:187], v[232:235], v[152:155], v[216:219]
    v_mfma_f32_16x16x32_bf16 v[188:191], v[232:235], v[168:171], v[220:223]
    ds_read_b128 v[224:227], v5 offset:20480
    v_exp_f32 v200, v200
    v_exp_f32 v201, v201
    v_add_f32 v9, v9, v200
    s_add_u32 s22, s18, 35840
    s_add_u32 m0, s15, 5120
    s_nop 0
    buffer_load_dwordx4 v11, s[64:67], s22 offen lds
    s_waitcnt lgkmcnt(3)
    v_mfma_f32_16x16x32_bf16 v[192:195], v[236:239], v[152:155], v[216:219]
    v_add_f32 v9, v9, v201
    v_cvt_pk_bf16_f32 v96, v200, v201
    v_exp_f32 v202, v202
    v_mfma_f32_16x16x32_bf16 v[196:199], v[236:239], v[168:171], v[220:223]
    s_add_u32 s22, s21, 0x84400
    s_add_u32 m0, s20, 0x1c400
    s_nop 0
    buffer_load_dwordx4 v2, s[8:11], s22 offen sc1 lds
    ds_read_b128 v[228:231], v5 offset:21504
    v_exp_f32 v203, v203
    v_add_f32 v9, v9, v202
    s_waitcnt lgkmcnt(3)
    v_mfma_f32_16x16x32_bf16 v[184:187], v[240:243], v[156:159], v[184:187]
    v_add_f32 v9, v9, v203
    v_cvt_pk_bf16_f32 v97, v202, v203
    v_exp_f32 v204, v204
    v_mfma_f32_16x16x32_bf16 v[188:191], v[240:243], v[172:175], v[188:191]
    ds_read_b128 v[232:235], v5 offset:22528
    v_exp_f32 v205, v205
    v_add_f32 v10, v10, v204
    v_add_f32 v10, v10, v205
    s_waitcnt lgkmcnt(3)
    v_mfma_f32_16x16x32_bf16 v[192:195], v[244:247], v[156:159], v[192:195]
    v_cvt_pk_bf16_f32 v100, v204, v205
    v_exp_f32 v206, v206
    v_mfma_f32_16x16x32_bf16 v[196:199], v[244:247], v[172:175], v[196:199]
    ds_read_b128 v[236:239], v5 offset:23552
    v_exp_f32 v207, v207
    v_add_f32 v10, v10, v206
    v_add_f32 v10, v10, v207
    s_waitcnt lgkmcnt(3)
    v_mfma_f32_16x16x32_bf16 v[184:187], v[224:227], v[160:163], v[184:187]
    v_cvt_pk_bf16_f32 v101, v206, v207
    v_exp_f32 v208, v208
    v_exp_f32 v209, v209
    v_mfma_f32_16x16x32_bf16 v[188:191], v[224:227], v[176:179], v[188:191]
    ds_read_b128 v[240:243], v5 offset:24576
    v_add_f32 v9, v9, v208
    v_add_f32 v9, v9, v209
    s_waitcnt lgkmcnt(3)
    v_mfma_f32_16x16x32_bf16 v[192:195], v[228:231], v[160:163], v[192:195]
    v_cvt_pk_bf16_f32 v98, v208, v209
    v_exp_f32 v210, v210
    v_exp_f32 v211, v211
    v_mfma_f32_16x16x32_bf16 v[196:199], v[228:231], v[176:179], v[196:199]
    ds_read_b128 v[244:247], v5 offset:25600
    v_add_f32 v9, v9, v210
    v_add_f32 v9, v9, v211
    v_cvt_pk_bf16_f32 v99, v210, v211
    s_waitcnt lgkmcnt(3)
    v_mfma_f32_16x16x32_bf16 v[184:187], v[232:235], v[164:167], v[184:187]
    v_exp_f32 v212, v212
    v_exp_f32 v213, v213
    v_mfma_f32_16x16x32_bf16 v[188:191], v[232:235], v[180:183], v[188:191]
    ds_read_b128 v[224:227], v5 offset:26624
    v_add_f32 v10, v10, v212
    v_add_f32 v10, v10, v213
    v_cvt_pk_bf16_f32 v102, v212, v213
    s_add_u32 s22, s18, 35840
    s_add_u32 m0, s15, 37888
    s_nop 0
    buffer_load_dwordx4 v11, s[68:71], s22 offen lds
    s_waitcnt lgkmcnt(3)
    v_mfma_f32_16x16x32_bf16 v[192:195], v[236:239], v[164:167], v[192:195]
    v_exp_f32 v214, v214
    v_exp_f32 v215, v215
    v_add_f32 v10, v10, v214
    v_mfma_f32_16x16x32_bf16 v[196:199], v[236:239], v[180:183], v[196:199]
    ds_read_b128 v[228:231], v5 offset:27648
    v_add_f32 v10, v10, v215
    v_cvt_pk_bf16_f32 v103, v214, v215
    s_waitcnt lgkmcnt(3)
    v_mfma_f32_16x16x32_bf16 v[200:203], v[240:243], v[152:155], v[216:219]
    v_mfma_f32_16x16x32_bf16 v[204:207], v[240:243], v[168:171], v[220:223]
    ds_read_b128 v[232:235], v5 offset:28672
    v_exp_f32 v184, v184
    v_exp_f32 v185, v185
    v_add_f32 v9, v9, v184
    s_waitcnt lgkmcnt(3)
    v_mfma_f32_16x16x32_bf16 v[208:211], v[244:247], v[152:155], v[216:219]
    v_add_f32 v9, v9, v185
    v_cvt_pk_bf16_f32 v104, v184, v185
    v_exp_f32 v186, v186
    v_mfma_f32_16x16x32_bf16 v[212:215], v[244:247], v[168:171], v[220:223]
    ds_read_b128 v[236:239], v5 offset:29696
    v_exp_f32 v187, v187
    v_add_f32 v9, v9, v186
    s_waitcnt lgkmcnt(3)
    v_mfma_f32_16x16x32_bf16 v[200:203], v[224:227], v[156:159], v[200:203]
    v_add_f32 v9, v9, v187
    v_cvt_pk_bf16_f32 v105, v186, v187
    v_exp_f32 v188, v188
    v_mfma_f32_16x16x32_bf16 v[204:207], v[224:227], v[172:175], v[204:207]
    ds_read_b128 v[240:243], v5 offset:30720
    v_exp_f32 v189, v189
    v_add_f32 v10, v10, v188
    v_add_f32 v10, v10, v189
    s_waitcnt lgkmcnt(3)
    v_mfma_f32_16x16x32_bf16 v[208:211], v[228:231], v[156:159], v[208:211]
    v_cvt_pk_bf16_f32 v108, v188, v189
    v_exp_f32 v190, v190
    v_mfma_f32_16x16x32_bf16 v[212:215], v[228:231], v[172:175], v[212:215]
    ds_read_b128 v[244:247], v5 offset:31744
    v_exp_f32 v191, v191
    v_add_f32 v10, v10, v190
    v_add_f32 v10, v10, v191
    s_waitcnt lgkmcnt(3)
    v_mfma_f32_16x16x32_bf16 v[200:203], v[232:235], v[160:163], v[200:203]
    v_cvt_pk_bf16_f32 v109, v190, v191
    v_exp_f32 v192, v192
    v_exp_f32 v193, v193
    v_mfma_f32_16x16x32_bf16 v[204:207], v[232:235], v[176:179], v[204:207]
    s_waitcnt vmcnt(15)
    s_barrier
    ds_read_b128 v[224:227], v4 offset:0
    v_add_f32 v9, v9, v192
    v_add_f32 v9, v9, v193
    s_waitcnt lgkmcnt(3)
    v_mfma_f32_16x16x32_bf16 v[208:211], v[236:239], v[160:163], v[208:211]
    v_cvt_pk_bf16_f32 v106, v192, v193
    v_exp_f32 v194, v194
    v_exp_f32 v195, v195
    s_add_u32 s22, s18, 43008
    s_add_u32 m0, s15, 6144
    s_nop 0
    buffer_load_dwordx4 v11, s[64:67], s22 offen lds
    v_mfma_f32_16x16x32_bf16 v[212:215], v[236:239], v[176:179], v[212:215]
    s_add_u32 s22, s21, 0x88000
    s_add_u32 m0, s20, 0x20000
    s_nop 0
    buffer_load_dwordx4 v2, s[8:11], s22 offen sc1 lds
    ds_read_b128 v[228:231], v4 offset:1024
    v_add_f32 v9, v9, v194
    v_add_f32 v9, v9, v195
    v_cvt_pk_bf16_f32 v107, v194, v195
    s_waitcnt lgkmcnt(3)
    v_mfma_f32_16x16x32_bf16 v[200:203], v[240:243], v[164:167], v[200:203]
    v_exp_f32 v196, v196
    v_exp_f32 v197, v197
    v_mfma_f32_16x16x32_bf16 v[204:207], v[240:243], v[180:183], v[204:207]
    ds_read_b128 v[232:235], v4 offset:2048
    v_add_f32 v10, v10, v196
    v_add_f32 v10, v10, v197
    v_cvt_pk_bf16_f32 v110, v196, v197
    s_waitcnt lgkmcnt(3)
    v_mfma_f32_16x16x32_bf16 v[208:211], v[244:247], v[164:167], v[208:211]
    v_exp_f32 v198, v198
    v_exp_f32 v199, v199
    v_add_f32 v10, v10, v198
    v_mfma_f32_16x16x32_bf16 v[212:215], v[244:247], v[180:183], v[212:215]
    ds_read_b128 v[236:239], v4 offset:3072
    v_add_f32 v10, v10, v199
    v_cvt_pk_bf16_f32 v111, v198, v199
    s_waitcnt lgkmcnt(3)
    v_mfma_f32_16x16x32_bf16 v[184:187], v[224:227], v[152:155], v[216:219]
    v_mfma_f32_16x16x32_bf16 v[188:191], v[224:227], v[168:171], v[220:223]
    ds_read_b128 v[240:243], v4 offset:4096
    v_exp_f32 v200, v200
    v_exp_f32 v201, v201
    v_add_f32 v9, v9, v200
    s_waitcnt lgkmcnt(3)
    v_mfma_f32_16x16x32_bf16 v[192:195], v[228:231], v[152:155], v[216:219]
    v_add_f32 v9, v9, v201
    v_cvt_pk_bf16_f32 v112, v200, v201
    v_exp_f32 v202, v202
    v_mfma_f32_16x16x32_bf16 v[196:199], v[228:231], v[168:171], v[220:223]
    s_add_u32 s22, s21, 0x88400
    s_add_u32 m0, s20, 0x20400
    s_nop 0
    buffer_load_dwordx4 v2, s[8:11], s22 offen sc1 lds
    ds_read_b128 v[244:247], v4 offset:5120
    v_exp_f32 v203, v203
    v_add_f32 v9, v9, v202
    s_waitcnt lgkmcnt(3)
    v_mfma_f32_16x16x32_bf16 v[184:187], v[232:235], v[156:159], v[184:187]
    v_add_f32 v9, v9, v203
    v_cvt_pk_bf16_f32 v113, v202, v203
    v_exp_f32 v204, v204
    v_mfma_f32_16x16x32_bf16 v[188:191], v[232:235], v[172:175], v[188:191]
    ds_read_b128 v[224:227], v4 offset:6144
    v_exp_f32 v205, v205
    v_add_f32 v10, v10, v204
    v_add_f32 v10, v10, v205
    s_waitcnt lgkmcnt(3)
    v_mfma_f32_16x16x32_bf16 v[192:195], v[236:239], v[156:159], v[192:195]
    v_cvt_pk_bf16_f32 v116, v204, v205
    v_exp_f32 v206, v206
    s_add_u32 s22, s18, 43008
    s_add_u32 m0, s15, 38912
    s_nop 0
    buffer_load_dwordx4 v11, s[68:71], s22 offen lds
    v_mfma_f32_16x16x32_bf16 v[196:199], v[236:239], v[172:175], v[196:199]
    ds_read_b128 v[228:231], v4 offset:7168
    v_exp_f32 v207, v207
    v_add_f32 v10, v10, v206
    v_add_f32 v10, v10, v207
    s_waitcnt lgkmcnt(3)
    v_mfma_f32_16x16x32_bf16 v[184:187], v[240:243], v[160:163], v[184:187]
    v_cvt_pk_bf16_f32 v117, v206, v207
    v_exp_f32 v208, v208
    v_exp_f32 v209, v209
    v_mfma_f32_16x16x32_bf16 v[188:191], v[240:243], v[176:179], v[188:191]
    ds_read_b128 v[232:235], v4 offset:8192
    v_add_f32 v9, v9, v208
    v_add_f32 v9, v9, v209
    s_waitcnt lgkmcnt(3)
    v_mfma_f32_16x16x32_bf16 v[192:195], v[244:247], v[160:163], v[192:195]
    v_cvt_pk_bf16_f32 v114, v208, v209
    v_exp_f32 v210, v210
    v_exp_f32 v211, v211
    v_mfma_f32_16x16x32_bf16 v[196:199], v[244:247], v[176:179], v[196:199]
    ds_read_b128 v[236:239], v4 offset:9216
    v_add_f32 v9, v9, v210
    v_add_f32 v9, v9, v211
    v_cvt_pk_bf16_f32 v115, v210, v211
    s_waitcnt lgkmcnt(3)
    v_mfma_f32_16x16x32_bf16 v[184:187], v[224:227], v[164:167], v[184:187]
    v_exp_f32 v212, v212
    v_exp_f32 v213, v213
    v_mfma_f32_16x16x32_bf16 v[188:191], v[224:227], v[180:183], v[188:191]
    ds_read_b128 v[240:243], v4 offset:10240
    v_add_f32 v10, v10, v212
    v_add_f32 v10, v10, v213
    v_cvt_pk_bf16_f32 v118, v212, v213
    s_waitcnt lgkmcnt(3)
    v_mfma_f32_16x16x32_bf16 v[192:195], v[228:231], v[164:167], v[192:195]
    v_exp_f32 v214, v214
    v_exp_f32 v215, v215
    v_add_f32 v10, v10, v214
    v_mfma_f32_16x16x32_bf16 v[196:199], v[228:231], v[180:183], v[196:199]
    ds_read_b128 v[244:247], v4 offset:11264
    v_add_f32 v10, v10, v215
    v_cvt_pk_bf16_f32 v119, v214, v215
    s_waitcnt lgkmcnt(3)
    v_mfma_f32_16x16x32_bf16 v[200:203], v[232:235], v[152:155], v[216:219]
    v_mfma_f32_16x16x32_bf16 v[204:207], v[232:235], v[168:171], v[220:223]
    ds_read_b128 v[224:227], v4 offset:12288
    v_exp_f32 v184, v184
    v_exp_f32 v185, v185
    v_add_f32 v9, v9, v184
    s_waitcnt lgkmcnt(3)
    v_mfma_f32_16x16x32_bf16 v[208:211], v[236:239], v[152:155], v[216:219]
    v_add_f32 v9, v9, v185
    v_cvt_pk_bf16_f32 v120, v184, v185
    v_exp_f32 v186, v186
    v_mfma_f32_16x16x32_bf16 v[212:215], v[236:239], v[168:171], v[220:223]
    ds_read_b128 v[228:231], v4 offset:13312
    v_exp_f32 v187, v187
    v_add_f32 v9, v9, v186
    s_add_u32 s22, s18, 50176
    s_add_u32 m0, s15, 7168
    s_nop 0
    buffer_load_dwordx4 v11, s[64:67], s22 offen lds
    s_waitcnt lgkmcnt(3)
    v_mfma_f32_16x16x32_bf16 v[200:203], v[240:243], v[156:159], v[200:203]
    v_add_f32 v9, v9, v187
    v_cvt_pk_bf16_f32 v121, v186, v187
    v_exp_f32 v188, v188
    v_mfma_f32_16x16x32_bf16 v[204:207], v[240:243], v[172:175], v[204:207]
    ds_read_b128 v[232:235], v4 offset:14336
    v_exp_f32 v189, v189
    v_add_f32 v10, v10, v188
    v_add_f32 v10, v10, v189
    s_waitcnt lgkmcnt(3)
    v_mfma_f32_16x16x32_bf16 v[208:211], v[244:247], v[156:159], v[208:211]
    v_cvt_pk_bf16_f32 v124, v188, v189
    v_exp_f32 v190, v190
    v_mfma_f32_16x16x32_bf16 v[212:215], v[244:247], v[172:175], v[212:215]
    ds_read_b128 v[236:239], v4 offset:15360
    v_exp_f32 v191, v191
    v_add_f32 v10, v10, v190
    v_add_f32 v10, v10, v191
    s_waitcnt lgkmcnt(3)
    v_mfma_f32_16x16x32_bf16 v[200:203], v[224:227], v[160:163], v[200:203]
    v_cvt_pk_bf16_f32 v125, v190, v191
    v_exp_f32 v192, v192
    v_exp_f32 v193, v193
    v_mfma_f32_16x16x32_bf16 v[204:207], v[224:227], v[176:179], v[204:207]
    s_waitcnt vmcnt(15)
    s_barrier
    ds_read_b128 v[240:243], v4 offset:16384
    v_add_f32 v9, v9, v192
    v_add_f32 v9, v9, v193
    s_waitcnt lgkmcnt(3)
    v_mfma_f32_16x16x32_bf16 v[208:211], v[228:231], v[160:163], v[208:211]
    v_cvt_pk_bf16_f32 v122, v192, v193
    v_exp_f32 v194, v194
    v_exp_f32 v195, v195
    v_mfma_f32_16x16x32_bf16 v[212:215], v[228:231], v[176:179], v[212:215]
    s_add_u32 s22, s21, 0x8c000
    s_add_u32 m0, s20, 0x24000
    s_nop 0
    buffer_load_dwordx4 v2, s[8:11], s22 offen sc1 lds
    ds_read_b128 v[244:247], v4 offset:17408
    v_add_f32 v9, v9, v194
    v_add_f32 v9, v9, v195
    v_cvt_pk_bf16_f32 v123, v194, v195
    s_waitcnt lgkmcnt(3)
    v_mfma_f32_16x16x32_bf16 v[200:203], v[232:235], v[164:167], v[200:203]
    v_exp_f32 v196, v196
    v_exp_f32 v197, v197
    v_mfma_f32_16x16x32_bf16 v[204:207], v[232:235], v[180:183], v[204:207]
    ds_read_b128 v[224:227], v4 offset:18432
    v_add_f32 v10, v10, v196
    v_add_f32 v10, v10, v197
    v_cvt_pk_bf16_f32 v126, v196, v197
    s_waitcnt lgkmcnt(3)
    v_mfma_f32_16x16x32_bf16 v[208:211], v[236:239], v[164:167], v[208:211]
    v_exp_f32 v198, v198
    v_exp_f32 v199, v199
    v_add_f32 v10, v10, v198
    v_mfma_f32_16x16x32_bf16 v[212:215], v[236:239], v[180:183], v[212:215]
    ds_read_b128 v[228:231], v4 offset:19456
    v_add_f32 v10, v10, v199
    v_cvt_pk_bf16_f32 v127, v198, v199
    s_waitcnt lgkmcnt(3)
    v_mfma_f32_16x16x32_bf16 v[184:187], v[240:243], v[152:155], v[216:219]
    v_mfma_f32_16x16x32_bf16 v[188:191], v[240:243], v[168:171], v[220:223]
    ds_read_b128 v[232:235], v4 offset:20480
    v_exp_f32 v200, v200
    v_exp_f32 v201, v201
    v_add_f32 v9, v9, v200
    s_waitcnt lgkmcnt(3)
    v_mfma_f32_16x16x32_bf16 v[192:195], v[244:247], v[152:155], v[216:219]
    v_add_f32 v9, v9, v201
    v_cvt_pk_bf16_f32 v128, v200, v201
    v_exp_f32 v202, v202
    v_mfma_f32_16x16x32_bf16 v[196:199], v[244:247], v[168:171], v[220:223]
    s_add_u32 s22, s21, 0x8c400
    s_add_u32 m0, s20, 0x24400
    s_nop 0
    buffer_load_dwordx4 v2, s[8:11], s22 offen sc1 lds
    ds_read_b128 v[236:239], v4 offset:21504
    v_exp_f32 v203, v203
    v_add_f32 v9, v9, v202
    s_waitcnt lgkmcnt(3)
    v_mfma_f32_16x16x32_bf16 v[184:187], v[224:227], v[156:159], v[184:187]
    v_add_f32 v9, v9, v203
    v_cvt_pk_bf16_f32 v129, v202, v203
    v_exp_f32 v204, v204
    v_mfma_f32_16x16x32_bf16 v[188:191], v[224:227], v[172:175], v[188:191]
    ds_read_b128 v[240:243], v4 offset:22528
    v_exp_f32 v205, v205
    v_add_f32 v10, v10, v204
    v_add_f32 v10, v10, v205
    s_waitcnt lgkmcnt(3)
    v_mfma_f32_16x16x32_bf16 v[192:195], v[228:231], v[156:159], v[192:195]
    v_cvt_pk_bf16_f32 v132, v204, v205
    v_exp_f32 v206, v206
    v_mfma_f32_16x16x32_bf16 v[196:199], v[228:231], v[172:175], v[196:199]
    ds_read_b128 v[244:247], v4 offset:23552
    v_exp_f32 v207, v207
    v_add_f32 v10, v10, v206
    v_add_f32 v10, v10, v207
    s_waitcnt lgkmcnt(3)
    v_mfma_f32_16x16x32_bf16 v[184:187], v[232:235], v[160:163], v[184:187]
    v_cvt_pk_bf16_f32 v133, v206, v207
    v_exp_f32 v208, v208
    v_exp_f32 v209, v209
    v_mfma_f32_16x16x32_bf16 v[188:191], v[232:235], v[176:179], v[188:191]
    ds_read_b128 v[224:227], v4 offset:24576
    v_add_f32 v9, v9, v208
    v_add_f32 v9, v9, v209
    s_waitcnt lgkmcnt(3)
    v_mfma_f32_16x16x32_bf16 v[192:195], v[236:239], v[160:163], v[192:195]
    v_cvt_pk_bf16_f32 v130, v208, v209
    v_exp_f32 v210, v210
    v_exp_f32 v211, v211
    v_mfma_f32_16x16x32_bf16 v[196:199], v[236:239], v[176:179], v[196:199]
    ds_read_b128 v[228:231], v4 offset:25600
    v_add_f32 v9, v9, v210
    v_add_f32 v9, v9, v211
    v_cvt_pk_bf16_f32 v131, v210, v211
    s_waitcnt lgkmcnt(3)
    v_mfma_f32_16x16x32_bf16 v[184:187], v[240:243], v[164:167], v[184:187]
    v_exp_f32 v212, v212
    v_exp_f32 v213, v213
    v_mfma_f32_16x16x32_bf16 v[188:191], v[240:243], v[180:183], v[188:191]
    ds_read_b128 v[232:235], v4 offset:26624
    v_add_f32 v10, v10, v212
    v_add_f32 v10, v10, v213
    v_cvt_pk_bf16_f32 v134, v212, v213
    s_waitcnt lgkmcnt(3)
    v_mfma_f32_16x16x32_bf16 v[192:195], v[244:247], v[164:167], v[192:195]
    v_exp_f32 v214, v214
    v_exp_f32 v215, v215
    v_add_f32 v10, v10, v214
    v_mfma_f32_16x16x32_bf16 v[196:199], v[244:247], v[180:183], v[196:199]
    ds_read_b128 v[236:239], v4 offset:27648
    v_add_f32 v10, v10, v215
    v_cvt_pk_bf16_f32 v135, v214, v215
    s_waitcnt lgkmcnt(3)
    v_mfma_f32_16x16x32_bf16 v[200:203], v[224:227], v[152:155], v[216:219]
    v_mfma_f32_16x16x32_bf16 v[204:207], v[224:227], v[168:171], v[220:223]
    ds_read_b128 v[240:243], v4 offset:28672
    v_exp_f32 v184, v184
    v_exp_f32 v185, v185
    v_add_f32 v9, v9, v184
    s_waitcnt lgkmcnt(3)
    v_mfma_f32_16x16x32_bf16 v[208:211], v[228:231], v[152:155], v[216:219]
    v_add_f32 v9, v9, v185
    v_cvt_pk_bf16_f32 v136, v184, v185
    v_exp_f32 v186, v186
    v_mfma_f32_16x16x32_bf16 v[212:215], v[228:231], v[168:171], v[220:223]
    ds_read_b128 v[244:247], v4 offset:29696
    v_exp_f32 v187, v187
    v_add_f32 v9, v9, v186
    s_waitcnt lgkmcnt(3)
    v_mfma_f32_16x16x32_bf16 v[200:203], v[232:235], v[156:159], v[200:203]
    v_add_f32 v9, v9, v187
    v_cvt_pk_bf16_f32 v137, v186, v187
    v_exp_f32 v188, v188
    v_mfma_f32_16x16x32_bf16 v[204:207], v[232:235], v[172:175], v[204:207]
    ds_read_b128 v[224:227], v4 offset:30720
    v_exp_f32 v189, v189
    v_add_f32 v10, v10, v188
    v_add_f32 v10, v10, v189
    s_waitcnt lgkmcnt(3)
    v_mfma_f32_16x16x32_bf16 v[208:211], v[236:239], v[156:159], v[208:211]
    v_cvt_pk_bf16_f32 v140, v188, v189
    v_exp_f32 v190, v190
    v_mfma_f32_16x16x32_bf16 v[212:215], v[236:239], v[172:175], v[212:215]
    ds_read_b128 v[228:231], v4 offset:31744
    v_exp_f32 v191, v191
    v_add_f32 v10, v10, v190
    v_add_f32 v10, v10, v191
    s_waitcnt lgkmcnt(3)
    v_mfma_f32_16x16x32_bf16 v[200:203], v[240:243], v[160:163], v[200:203]
    v_cvt_pk_bf16_f32 v141, v190, v191
    v_exp_f32 v192, v192
    v_exp_f32 v193, v193
    v_mfma_f32_16x16x32_bf16 v[204:207], v[240:243], v[176:179], v[204:207]
    v_add_f32 v9, v9, v192
    v_add_f32 v9, v9, v193
    s_waitcnt lgkmcnt(2)
    v_mfma_f32_16x16x32_bf16 v[208:211], v[244:247], v[160:163], v[208:211]
    v_cvt_pk_bf16_f32 v138, v192, v193
    v_exp_f32 v194, v194
    v_exp_f32 v195, v195
    v_mfma_f32_16x16x32_bf16 v[212:215], v[244:247], v[176:179], v[212:215]
    v_add_f32 v9, v9, v194
    v_add_f32 v9, v9, v195
    v_cvt_pk_bf16_f32 v139, v194, v195
    s_waitcnt lgkmcnt(1)
    v_mfma_f32_16x16x32_bf16 v[200:203], v[224:227], v[164:167], v[200:203]
    v_exp_f32 v196, v196
    v_exp_f32 v197, v197
    v_mfma_f32_16x16x32_bf16 v[204:207], v[224:227], v[180:183], v[204:207]
    v_add_f32 v10, v10, v196
    v_add_f32 v10, v10, v197
    v_cvt_pk_bf16_f32 v142, v196, v197
    s_waitcnt lgkmcnt(0)
    v_mfma_f32_16x16x32_bf16 v[208:211], v[228:231], v[164:167], v[208:211]
    v_exp_f32 v198, v198
    v_exp_f32 v199, v199
    v_add_f32 v10, v10, v198
    v_mfma_f32_16x16x32_bf16 v[212:215], v[228:231], v[180:183], v[212:215]
    v_add_f32 v10, v10, v199
    v_cvt_pk_bf16_f32 v143, v198, v199
    s_waitcnt vmcnt(13)
    s_barrier
    ds_read_b128 v[232:235], v4 offset:32768
    ds_read_b128 v[236:239], v4 offset:33792
    ds_read_b128 v[240:243], v4 offset:34816
    ds_read_b128 v[244:247], v4 offset:35840
    v_exp_f32 v200, v200
    v_exp_f32 v201, v201
    v_add_f32 v9, v9, v200
    v_add_f32 v9, v9, v201
    v_cvt_pk_bf16_f32 v144, v200, v201
    v_exp_f32 v202, v202
    v_exp_f32 v203, v203
    v_add_f32 v9, v9, v202
    v_add_f32 v9, v9, v203
    v_cvt_pk_bf16_f32 v145, v202, v203
    v_exp_f32 v204, v204
    v_exp_f32 v205, v205
    v_add_f32 v10, v10, v204
    v_add_f32 v10, v10, v205
    v_cvt_pk_bf16_f32 v148, v204, v205
    v_exp_f32 v206, v206
    v_exp_f32 v207, v207
    v_add_f32 v10, v10, v206
    v_add_f32 v10, v10, v207
    v_cvt_pk_bf16_f32 v149, v206, v207
    v_exp_f32 v208, v208
    v_exp_f32 v209, v209
    v_add_f32 v9, v9, v208
    v_add_f32 v9, v9, v209
    v_cvt_pk_bf16_f32 v146, v208, v209
    v_exp_f32 v210, v210
    v_exp_f32 v211, v211
    v_add_f32 v9, v9, v210
    v_add_f32 v9, v9, v211
    v_cvt_pk_bf16_f32 v147, v210, v211
    v_exp_f32 v212, v212
    v_exp_f32 v213, v213
    v_add_f32 v10, v10, v212
    v_add_f32 v10, v10, v213
    v_cvt_pk_bf16_f32 v150, v212, v213
    v_exp_f32 v214, v214
    v_exp_f32 v215, v215
    v_add_f32 v10, v10, v214
    v_add_f32 v10, v10, v215
    v_cvt_pk_bf16_f32 v151, v214, v215
    v_mov_b32 v16, v9
    v_mov_b32 v18, v10
    s_nop 0
    v_permlane16_swap_b32 v9, v16
    v_permlane16_swap_b32 v10, v18
    v_add_f32 v9, v9, v16
    v_add_f32 v10, v10, v18
    v_mov_b32 v16, v9
    v_mov_b32 v18, v10
    s_nop 0
    v_permlane32_swap_b32 v9, v16
    v_permlane32_swap_b32 v10, v18
    v_add_f32 v9, v9, v16
    v_add_f32 v10, v10, v18
    v_max_f32 v17, v9, v10
    s_mov_b32 s16, 0x71800000
    v_cmp_ngt_f32 vcc, s16, v17
    v_cmp_u_f32 s[62:63], v9, v10
    s_or_b64 vcc, vcc, s[62:63]
    s_cbranch_vccnz adaLN_cond__sliding_block_cached__moe_arch_mod__prompt_kernel_fixB
adaLN_cond__sliding_block_cached__moe_arch_mod__prompt_kernel_fixBb:
    v_rcp_f32 v9, v9
    v_rcp_f32 v10, v10
    s_lshl_b32 s25, s13, 3
    s_add_u32 s25, s25, s3
    s_lshl_b32 s25, s25, 18
    s_lshl_b32 s26, s12, 12
    s_add_u32 s25, s25, s26
    s_add_u32 s25, s25, 0x1000000
    s_add_u32 s26, s25, 131072
    s_lshl_b32 s63, s13, 3
    s_add_u32 s63, s63, s3
    s_lshl_b32 s63, s63, 5
    s_add_u32 s63, s63, s12
    s_lshl_b32 s63, s63, 2
    s_waitcnt lgkmcnt(3)
    v_mfma_f32_16x16x32_bf16 v[184:187], v[232:235], v[24:27], 0
    v_mfma_f32_16x16x32_bf16 v[188:191], v[232:235], v[28:31], 0
    ds_read_b128 v[224:227], v4 offset:36864
    s_waitcnt lgkmcnt(3)
    v_mfma_f32_16x16x32_bf16 v[192:195], v[236:239], v[24:27], 0
    s_add_u32 s22, s21, 0x90000
    s_add_u32 m0, s20, 0x10000
    s_nop 0
    buffer_load_dwordx4 v2, s[8:11], s22 offen sc1 lds
    v_mfma_f32_16x16x32_bf16 v[196:199], v[236:239], v[28:31], 0
    ds_read_b128 v[228:231], v4 offset:37888
    s_waitcnt lgkmcnt(3)
    v_mfma_f32_16x16x32_bf16 v[184:187], v[240:243], v[32:35], v[184:187]
    v_mfma_f32_16x16x32_bf16 v[188:191], v[240:243], v[36:39], v[188:191]
    ds_read_b128 v[232:235], v4 offset:38912
    s_waitcnt lgkmcnt(3)
    v_mfma_f32_16x16x32_bf16 v[192:195], v[244:247], v[32:35], v[192:195]
    v_mfma_f32_16x16x32_bf16 v[196:199], v[244:247], v[36:39], v[196:199]
    ds_read_b128 v[236:239], v4 offset:39936
    s_waitcnt lgkmcnt(3)
    v_mfma_f32_16x16x32_bf16 v[184:187], v[224:227], v[40:43], v[184:187]
    v_mfma_f32_16x16x32_bf16 v[188:191], v[224:227], v[44:47], v[188:191]
    ds_read_b128 v[240:243], v4 offset:40960
    s_waitcnt lgkmcnt(3)
    v_mfma_f32_16x16x32_bf16 v[192:195], v[228:231], v[40:43], v[192:195]
    s_add_u32 s22, s21, 0x90400
    s_add_u32 m0, s20, 0x10400
    s_nop 0
    buffer_load_dwordx4 v2, s[8:11], s22 offen sc1 lds
    v_mfma_f32_16x16x32_bf16 v[196:199], v[228:231], v[44:47], v[196:199]
    ds_read_b128 v[244:247], v4 offset:41984
    s_waitcnt lgkmcnt(3)
    v_mfma_f32_16x16x32_bf16 v[184:187], v[232:235], v[48:51], v[184:187]
    v_mfma_f32_16x16x32_bf16 v[188:191], v[232:235], v[52:55], v[188:191]
    ds_read_b128 v[224:227], v4 offset:43008
    s_waitcnt lgkmcnt(3)
    v_mfma_f32_16x16x32_bf16 v[192:195], v[236:239], v[48:51], v[192:195]
    v_mfma_f32_16x16x32_bf16 v[196:199], v[236:239], v[52:55], v[196:199]
    ds_read_b128 v[228:231], v4 offset:44032
    s_waitcnt lgkmcnt(3)
    v_mfma_f32_16x16x32_bf16 v[184:187], v[240:243], v[56:59], v[184:187]
    v_mfma_f32_16x16x32_bf16 v[188:191], v[240:243], v[60:63], v[188:191]
    ds_read_b128 v[232:235], v4 offset:45056
    s_waitcnt lgkmcnt(3)
    v_mfma_f32_16x16x32_bf16 v[192:195], v[244:247], v[56:59], v[192:195]
    v_mfma_f32_16x16x32_bf16 v[196:199], v[244:247], v[60:63], v[196:199]
    ds_read_b128 v[236:239], v4 offset:46080
    s_waitcnt lgkmcnt(3)
    v_mfma_f32_16x16x32_bf16 v[184:187], v[224:227], v[64:67], v[184:187]
    v_mfma_f32_16x16x32_bf16 v[188:191], v[224:227], v[68:71], v[188:191]
    ds_read_b128 v[240:243], v4 offset:47104
    s_waitcnt lgkmcnt(3)
    v_mfma_f32_16x16x32_bf16 v[192:195], v[228:231], v[64:67], v[192:195]
    v_mfma_f32_16x16x32_bf16 v[196:199], v[228:231], v[68:71], v[196:199]
    ds_read_b128 v[244:247], v4 offset:48128
    s_waitcnt lgkmcnt(3)
    v_mfma_f32_16x16x32_bf16 v[184:187], v[232:235], v[72:75], v[184:187]
    v_mfma_f32_16x16x32_bf16 v[188:191], v[232:235], v[76:79], v[188:191]
    s_waitcnt vmcnt(10)
    s_barrier
    ds_read_b128 v[224:227], v4 offset:49152
    s_waitcnt lgkmcnt(3)
    v_mfma_f32_16x16x32_bf16 v[192:195], v[236:239], v[72:75], v[192:195]
    v_mfma_f32_16x16x32_bf16 v[196:199], v[236:239], v[76:79], v[196:199]
    s_add_u32 s22, s21, 0x94000
    s_add_u32 m0, s20, 0x14000
    s_nop 0
    buffer_load_dwordx4 v2, s[8:11], s22 offen sc1 lds
    ds_read_b128 v[228:231], v4 offset:50176
    s_waitcnt lgkmcnt(3)
    v_mfma_f32_16x16x32_bf16 v[184:187], v[240:243], v[80:83], v[184:187]
    v_mfma_f32_16x16x32_bf16 v[188:191], v[240:243], v[84:87], v[188:191]
    ds_read_b128 v[232:235], v4 offset:51200
    s_waitcnt lgkmcnt(3)
    v_mfma_f32_16x16x32_bf16 v[192:195], v[244:247], v[80:83], v[192:195]
    v_mfma_f32_16x16x32_bf16 v[196:199], v[244:247], v[84:87], v[196:199]
    ds_read_b128 v[236:239], v4 offset:52224
    s_waitcnt lgkmcnt(3)
    v_mfma_f32_16x16x32_bf16 v[184:187], v[224:227], v[88:91], v[184:187]
    v_mfma_f32_16x16x32_bf16 v[188:191], v[224:227], v[92:95], v[188:191]
    ds_read_b128 v[240:243], v4 offset:53248
    s_waitcnt lgkmcnt(3)
    v_mfma_f32_16x16x32_bf16 v[192:195], v[228:231], v[88:91], v[192:195]
    v_mfma_f32_16x16x32_bf16 v[196:199], v[228:231], v[92:95], v[196:199]
    s_add_u32 s22, s21, 0x94400
    s_add_u32 m0, s20, 0x14400
    s_nop 0
    buffer_load_dwordx4 v2, s[8:11], s22 offen sc1 lds
    ds_read_b128 v[244:247], v4 offset:54272
    s_waitcnt lgkmcnt(3)
    v_mfma_f32_16x16x32_bf16 v[184:187], v[232:235], v[96:99], v[184:187]
    v_mfma_f32_16x16x32_bf16 v[188:191], v[232:235], v[100:103], v[188:191]
    ds_read_b128 v[224:227], v4 offset:55296
    s_waitcnt lgkmcnt(3)
    v_mfma_f32_16x16x32_bf16 v[192:195], v[236:239], v[96:99], v[192:195]
    v_mfma_f32_16x16x32_bf16 v[196:199], v[236:239], v[100:103], v[196:199]
    ds_read_b128 v[228:231], v4 offset:56320
    s_waitcnt lgkmcnt(3)
    v_mfma_f32_16x16x32_bf16 v[184:187], v[240:243], v[104:107], v[184:187]
    v_mfma_f32_16x16x32_bf16 v[188:191], v[240:243], v[108:111], v[188:191]
    ds_read_b128 v[232:235], v4 offset:57344
    s_waitcnt lgkmcnt(3)
    v_mfma_f32_16x16x32_bf16 v[192:195], v[244:247], v[104:107], v[192:195]
    v_mfma_f32_16x16x32_bf16 v[196:199], v[244:247], v[108:111], v[196:199]
    ds_read_b128 v[236:239], v4 offset:58368
    s_waitcnt lgkmcnt(3)
    v_mfma_f32_16x16x32_bf16 v[184:187], v[224:227], v[112:115], v[184:187]
    v_mfma_f32_16x16x32_bf16 v[188:191], v[224:227], v[116:119], v[188:191]
    ds_read_b128 v[240:243], v4 offset:59392
    s_waitcnt lgkmcnt(3)
    v_mfma_f32_16x16x32_bf16 v[192:195], v[228:231], v[112:115], v[192:195]
    v_mfma_f32_16x16x32_bf16 v[196:199], v[228:231], v[116:119], v[196:199]
    ds_read_b128 v[244:247], v4 offset:60416
    s_waitcnt lgkmcnt(3)
    v_mfma_f32_16x16x32_bf16 v[184:187], v[232:235], v[120:123], v[184:187]
    v_mfma_f32_16x16x32_bf16 v[188:191], v[232:235], v[124:127], v[188:191]
    ds_read_b128 v[224:227], v4 offset:61440
    s_waitcnt lgkmcnt(3)
    v_mfma_f32_16x16x32_bf16 v[192:195], v[236:239], v[120:123], v[192:195]
    v_mfma_f32_16x16x32_bf16 v[196:199], v[236:239], v[124:127], v[196:199]
    ds_read_b128 v[228:231], v4 offset:62464
    s_waitcnt lgkmcnt(3)
    v_mfma_f32_16x16x32_bf16 v[184:187], v[240:243], v[128:131], v[184:187]
    v_mfma_f32_16x16x32_bf16 v[188:191], v[240:243], v[132:135], v[188:191]
    ds_read_b128 v[232:235], v4 offset:63488
    s_waitcnt lgkmcnt(3)
    v_mfma_f32_16x16x32_bf16 v[192:195], v[244:247], v[128:131], v[192:195]
    v_mfma_f32_16x16x32_bf16 v[196:199], v[244:247], v[132:135], v[196:199]
    ds_read_b128 v[236:239], v4 offset:64512
    s_waitcnt lgkmcnt(3)
    v_mfma_f32_16x16x32_bf16 v[184:187], v[224:227], v[136:139], v[184:187]
    v_mfma_f32_16x16x32_bf16 v[188:191], v[224:227], v[140:143], v[188:191]
    s_waitcnt vmcnt(8)
    s_barrier
    ds_read_b128 v[240:243], v5 offset:0
    s_waitcnt lgkmcnt(3)
    v_mfma_f32_16x16x32_bf16 v[192:195], v[228:231], v[136:139], v[192:195]
    v_mfma_f32_16x16x32_bf16 v[196:199], v[228:231], v[140:143], v[196:199]
    s_add_u32 s22, s21, 0x98000
    s_add_u32 m0, s20, 0x18000
    s_nop 0
    buffer_load_dwordx4 v2, s[8:11], s22 offen sc1 lds
    ds_read_b128 v[244:247], v5 offset:1024
    s_waitcnt lgkmcnt(3)
    v_mfma_f32_16x16x32_bf16 v[184:187], v[232:235], v[144:147], v[184:187]
    v_mfma_f32_16x16x32_bf16 v[188:191], v[232:235], v[148:151], v[188:191]
    ds_read_b128 v[224:227], v5 offset:2048
    s_waitcnt lgkmcnt(3)
    v_mfma_f32_16x16x32_bf16 v[192:195], v[236:239], v[144:147], v[192:195]
    v_mfma_f32_16x16x32_bf16 v[196:199], v[236:239], v[148:151], v[196:199]
    ds_read_b128 v[228:231], v5 offset:3072
    s_waitcnt lgkmcnt(3)
    v_mfma_f32_16x16x32_bf16 v[200:203], v[240:243], v[24:27], 0
    v_mfma_f32_16x16x32_bf16 v[204:207], v[240:243], v[28:31], 0
    ds_read_b128 v[232:235], v5 offset:4096
    s_waitcnt lgkmcnt(3)
    v_mfma_f32_16x16x32_bf16 v[208:211], v[244:247], v[24:27], 0
    v_mfma_f32_16x16x32_bf16 v[212:215], v[244:247], v[28:31], 0
    s_add_u32 s22, s21, 0x98400
    s_add_u32 m0, s20, 0x18400
    s_nop 0
    buffer_load_dwordx4 v2, s[8:11], s22 offen sc1 lds
    ds_read_b128 v[236:239], v5 offset:5120
    v_mul_f32 v184, v184, v9
    s_waitcnt lgkmcnt(3)
    v_mfma_f32_16x16x32_bf16 v[200:203], v[224:227], v[32:35], v[200:203]
    v_mfma_f32_16x16x32_bf16 v[204:207], v[224:227], v[36:39], v[204:207]
    ds_read_b128 v[240:243], v5 offset:6144
    v_mul_f32 v185, v185, v9
    s_waitcnt lgkmcnt(3)
    v_mfma_f32_16x16x32_bf16 v[208:211], v[228:231], v[32:35], v[208:211]
    v_mfma_f32_16x16x32_bf16 v[212:215], v[228:231], v[36:39], v[212:215]
    ds_read_b128 v[244:247], v5 offset:7168
    v_mul_f32 v186, v186, v9
    s_waitcnt lgkmcnt(3)
    v_mfma_f32_16x16x32_bf16 v[200:203], v[232:235], v[40:43], v[200:203]
    v_mfma_f32_16x16x32_bf16 v[204:207], v[232:235], v[44:47], v[204:207]
    ds_read_b128 v[224:227], v5 offset:8192
    v_mul_f32 v187, v187, v9
    s_waitcnt lgkmcnt(3)
    v_mfma_f32_16x16x32_bf16 v[208:211], v[236:239], v[40:43], v[208:211]
    v_mfma_f32_16x16x32_bf16 v[212:215], v[236:239], v[44:47], v[212:215]
    ds_read_b128 v[228:231], v5 offset:9216
    v_mul_f32 v192, v192, v9
    s_waitcnt lgkmcnt(3)
    v_mfma_f32_16x16x32_bf16 v[200:203], v[240:243], v[48:51], v[200:203]
    v_mfma_f32_16x16x32_bf16 v[204:207], v[240:243], v[52:55], v[204:207]
    ds_read_b128 v[232:235], v5 offset:10240
    v_mul_f32 v193, v193, v9
    s_waitcnt lgkmcnt(3)
    v_mfma_f32_16x16x32_bf16 v[208:211], v[244:247], v[48:51], v[208:211]
    v_mfma_f32_16x16x32_bf16 v[212:215], v[244:247], v[52:55], v[212:215]
    ds_read_b128 v[236:239], v5 offset:11264
    v_mul_f32 v194, v194, v9
    s_waitcnt lgkmcnt(3)
    v_mfma_f32_16x16x32_bf16 v[200:203], v[224:227], v[56:59], v[200:203]
    v_mfma_f32_16x16x32_bf16 v[204:207], v[224:227], v[60:63], v[204:207]
    ds_read_b128 v[240:243], v5 offset:12288
    v_mul_f32 v195, v195, v9
    s_waitcnt lgkmcnt(3)
    v_mfma_f32_16x16x32_bf16 v[208:211], v[228:231], v[56:59], v[208:211]
    v_mfma_f32_16x16x32_bf16 v[212:215], v[228:231], v[60:63], v[212:215]
    ds_read_b128 v[244:247], v5 offset:13312
    v_cvt_pk_bf16_f32 v216, v184, v185
    s_waitcnt lgkmcnt(3)
    v_mfma_f32_16x16x32_bf16 v[200:203], v[232:235], v[64:67], v[200:203]
    v_mfma_f32_16x16x32_bf16 v[204:207], v[232:235], v[68:71], v[204:207]
    ds_read_b128 v[224:227], v5 offset:14336
    v_cvt_pk_bf16_f32 v217, v186, v187
    s_waitcnt lgkmcnt(3)
    v_mfma_f32_16x16x32_bf16 v[208:211], v[236:239], v[64:67], v[208:211]
    v_mfma_f32_16x16x32_bf16 v[212:215], v[236:239], v[68:71], v[212:215]
    ds_read_b128 v[228:231], v5 offset:15360
    v_cvt_pk_bf16_f32 v218, v192, v193
    s_waitcnt lgkmcnt(3)
    v_mfma_f32_16x16x32_bf16 v[200:203], v[240:243], v[72:75], v[200:203]
    v_mfma_f32_16x16x32_bf16 v[204:207], v[240:243], v[76:79], v[204:207]
    s_waitcnt vmcnt(6)
    s_barrier
    ds_read_b128 v[232:235], v5 offset:16384
    v_cvt_pk_bf16_f32 v219, v194, v195
    s_waitcnt lgkmcnt(3)
    v_mfma_f32_16x16x32_bf16 v[208:211], v[244:247], v[72:75], v[208:211]
    v_mfma_f32_16x16x32_bf16 v[212:215], v[244:247], v[76:79], v[212:215]
    s_add_u32 s22, s21, 0x9c000
    s_add_u32 m0, s20, 0x1c000
    s_nop 0
    buffer_load_dwordx4 v2, s[8:11], s22 offen sc1 lds
    ds_read_b128 v[236:239], v5 offset:17408
    buffer_store_dwordx4 v[216:219], v2, s[8:11], s25 offen offset:0 sc1
    s_waitcnt lgkmcnt(3)
    v_mfma_f32_16x16x32_bf16 v[200:203], v[224:227], v[80:83], v[200:203]
    v_mfma_f32_16x16x32_bf16 v[204:207], v[224:227], v[84:87], v[204:207]
    ds_read_b128 v[240:243], v5 offset:18432
    v_mul_f32 v188, v188, v10
    s_waitcnt lgkmcnt(3)
    v_mfma_f32_16x16x32_bf16 v[208:211], v[228:231], v[80:83], v[208:211]
    v_mfma_f32_16x16x32_bf16 v[212:215], v[228:231], v[84:87], v[212:215]
    ds_read_b128 v[244:247], v5 offset:19456
    v_mul_f32 v189, v189, v10
    s_waitcnt lgkmcnt(3)
    v_mfma_f32_16x16x32_bf16 v[200:203], v[232:235], v[88:91], v[200:203]
    v_mfma_f32_16x16x32_bf16 v[204:207], v[232:235], v[92:95], v[204:207]
    ds_read_b128 v[224:227], v5 offset:20480
    v_mul_f32 v190, v190, v10
    s_waitcnt lgkmcnt(3)
    v_mfma_f32_16x16x32_bf16 v[208:211], v[236:239], v[88:91], v[208:211]
    v_mfma_f32_16x16x32_bf16 v[212:215], v[236:239], v[92:95], v[212:215]
    s_add_u32 s22, s21, 0x9c400
    s_add_u32 m0, s20, 0x1c400
    s_nop 0
    buffer_load_dwordx4 v2, s[8:11], s22 offen sc1 lds
    ds_read_b128 v[228:231], v5 offset:21504
    v_mul_f32 v191, v191, v10
    s_waitcnt lgkmcnt(3)
    v_mfma_f32_16x16x32_bf16 v[200:203], v[240:243], v[96:99], v[200:203]
    v_mfma_f32_16x16x32_bf16 v[204:207], v[240:243], v[100:103], v[204:207]
    ds_read_b128 v[232:235], v5 offset:22528
    v_mul_f32 v196, v196, v10
    s_waitcnt lgkmcnt(3)
    v_mfma_f32_16x16x32_bf16 v[208:211], v[244:247], v[96:99], v[208:211]
    v_mfma_f32_16x16x32_bf16 v[212:215], v[244:247], v[100:103], v[212:215]
    ds_read_b128 v[236:239], v5 offset:23552
    v_mul_f32 v197, v197, v10
    s_waitcnt lgkmcnt(3)
    v_mfma_f32_16x16x32_bf16 v[200:203], v[224:227], v[104:107], v[200:203]
    v_mfma_f32_16x16x32_bf16 v[204:207], v[224:227], v[108:111], v[204:207]
    ds_read_b128 v[240:243], v5 offset:24576
    v_mul_f32 v198, v198, v10
    s_waitcnt lgkmcnt(3)
    v_mfma_f32_16x16x32_bf16 v[208:211], v[228:231], v[104:107], v[208:211]
    v_mfma_f32_16x16x32_bf16 v[212:215], v[228:231], v[108:111], v[212:215]
    ds_read_b128 v[244:247], v5 offset:25600
    v_mul_f32 v199, v199, v10
    s_waitcnt lgkmcnt(3)
    v_mfma_f32_16x16x32_bf16 v[200:203], v[232:235], v[112:115], v[200:203]
    v_mfma_f32_16x16x32_bf16 v[204:207], v[232:235], v[116:119], v[204:207]
    ds_read_b128 v[224:227], v5 offset:26624
    v_cvt_pk_bf16_f32 v220, v188, v189
    s_waitcnt lgkmcnt(3)
    v_mfma_f32_16x16x32_bf16 v[208:211], v[236:239], v[112:115], v[208:211]
    v_mfma_f32_16x16x32_bf16 v[212:215], v[236:239], v[116:119], v[212:215]
    ds_read_b128 v[228:231], v5 offset:27648
    v_cvt_pk_bf16_f32 v221, v190, v191
    s_waitcnt lgkmcnt(3)
    v_mfma_f32_16x16x32_bf16 v[200:203], v[240:243], v[120:123], v[200:203]
    v_mfma_f32_16x16x32_bf16 v[204:207], v[240:243], v[124:127], v[204:207]
    ds_read_b128 v[232:235], v5 offset:28672
    v_cvt_pk_bf16_f32 v222, v196, v197
    s_waitcnt lgkmcnt(3)
    v_mfma_f32_16x16x32_bf16 v[208:211], v[244:247], v[120:123], v[208:211]
    v_mfma_f32_16x16x32_bf16 v[212:215], v[244:247], v[124:127], v[212:215]
    ds_read_b128 v[236:239], v5 offset:29696
    v_cvt_pk_bf16_f32 v223, v198, v199
    s_waitcnt lgkmcnt(3)
    v_mfma_f32_16x16x32_bf16 v[200:203], v[224:227], v[128:131], v[200:203]
    v_mfma_f32_16x16x32_bf16 v[204:207], v[224:227], v[132:135], v[204:207]
    ds_read_b128 v[240:243], v5 offset:30720
    buffer_store_dwordx4 v[220:223], v2, s[8:11], s26 offen offset:0 sc1
    s_waitcnt lgkmcnt(3)
    v_mfma_f32_16x16x32_bf16 v[208:211], v[228:231], v[128:131], v[208:211]
    v_mfma_f32_16x16x32_bf16 v[212:215], v[228:231], v[132:135], v[212:215]
    ds_read_b128 v[244:247], v5 offset:31744
    s_waitcnt lgkmcnt(3)
    v_mfma_f32_16x16x32_bf16 v[200:203], v[232:235], v[136:139], v[200:203]
    v_mfma_f32_16x16x32_bf16 v[204:207], v[232:235], v[140:143], v[204:207]
    s_waitcnt vmcnt(8)
    s_barrier
    ds_read_b128 v[224:227], v4 offset:0
    s_waitcnt lgkmcnt(3)
    v_mfma_f32_16x16x32_bf16 v[208:211], v[236:239], v[136:139], v[208:211]
    v_mfma_f32_16x16x32_bf16 v[212:215], v[236:239], v[140:143], v[212:215]
    s_add_u32 s22, s24, 0x0
    s_add_u32 m0, s20, 0x20000
    s_nop 0
    buffer_load_dwordx4 v3, s[4:7], s22 offen lds
    ds_read_b128 v[228:231], v4 offset:1024
    s_waitcnt lgkmcnt(3)
    v_mfma_f32_16x16x32_bf16 v[200:203], v[240:243], v[144:147], v[200:203]
    v_mfma_f32_16x16x32_bf16 v[204:207], v[240:243], v[148:151], v[204:207]
    ds_read_b128 v[232:235], v4 offset:2048
    s_waitcnt lgkmcnt(3)
    v_mfma_f32_16x16x32_bf16 v[208:211], v[244:247], v[144:147], v[208:211]
    v_mfma_f32_16x16x32_bf16 v[212:215], v[244:247], v[148:151], v[212:215]
    ds_read_b128 v[236:239], v4 offset:3072
    s_waitcnt lgkmcnt(3)
    v_mfma_f32_16x16x32_bf16 v[184:187], v[224:227], v[24:27], 0
    v_mfma_f32_16x16x32_bf16 v[188:191], v[224:227], v[28:31], 0
    ds_read_b128 v[240:243], v4 offset:4096
    s_waitcnt lgkmcnt(3)
    v_mfma_f32_16x16x32_bf16 v[192:195], v[228:231], v[24:27], 0
    s_mov_b64 s[72:73], s[50:51]
    s_mov_b32 s74, 0x700000
    s_mov_b32 s75, 0x20000
    s_cmp_lt_u32 s2, 224
    s_cselect_b32 s74, 7340032, 0
    s_lshl_b32 s17, s29, 4
    s_sub_u32 s16, s3, 4
    s_lshl_b32 s16, s16, 2
    s_add_u32 s16, s16, s17
    s_lshl_b32 s16, s16, 11
    s_add_u32 s17, s16, 0
    buffer_load_dwordx4 v[152:155], v2, s[72:75], s17 offen offset:0
    buffer_load_dwordx4 v[156:159], v2, s[72:75], s17 offen offset:1024
    s_add_u32 s17, s16, 2048
    buffer_load_dwordx4 v[160:163], v2, s[72:75], s17 offen offset:0
    buffer_load_dwordx4 v[164:167], v2, s[72:75], s17 offen offset:1024
    s_add_u32 s17, s16, 4096
    buffer_load_dwordx4 v[168:171], v2, s[72:75], s17 offen offset:0
    buffer_load_dwordx4 v[172:175], v2, s[72:75], s17 offen offset:1024
    s_add_u32 s17, s16, 6144
    buffer_load_dwordx4 v[176:179], v2, s[72:75], s17 offen offset:0
    buffer_load_dwordx4 v[180:183], v2, s[72:75], s17 offen offset:1024
    v_mfma_f32_16x16x32_bf16 v[196:199], v[228:231], v[28:31], 0
    s_add_u32 s22, s24, 0x2000
    s_add_u32 m0, s20, 0x20400
    s_nop 0
    buffer_load_dwordx4 v3, s[4:7], s22 offen lds
    ds_read_b128 v[244:247], v4 offset:5120
    v_mul_f32 v200, v200, v9
    s_waitcnt lgkmcnt(3)
    v_mfma_f32_16x16x32_bf16 v[184:187], v[232:235], v[32:35], v[184:187]
    v_mfma_f32_16x16x32_bf16 v[188:191], v[232:235], v[36:39], v[188:191]
    ds_read_b128 v[224:227], v4 offset:6144
    v_mul_f32 v201, v201, v9
    s_waitcnt lgkmcnt(3)
    v_mfma_f32_16x16x32_bf16 v[192:195], v[236:239], v[32:35], v[192:195]
    v_mfma_f32_16x16x32_bf16 v[196:199], v[236:239], v[36:39], v[196:199]
    ds_read_b128 v[228:231], v4 offset:7168
    v_mul_f32 v202, v202, v9
    s_waitcnt lgkmcnt(3)
    v_mfma_f32_16x16x32_bf16 v[184:187], v[240:243], v[40:43], v[184:187]
    v_mfma_f32_16x16x32_bf16 v[188:191], v[240:243], v[44:47], v[188:191]
    ds_read_b128 v[232:235], v4 offset:8192
    v_mul_f32 v203, v203, v9
    s_waitcnt lgkmcnt(3)
    v_mfma_f32_16x16x32_bf16 v[192:195], v[244:247], v[40:43], v[192:195]
    v_mfma_f32_16x16x32_bf16 v[196:199], v[244:247], v[44:47], v[196:199]
    ds_read_b128 v[236:239], v4 offset:9216
    v_mul_f32 v208, v208, v9
    s_waitcnt lgkmcnt(3)
    v_mfma_f32_16x16x32_bf16 v[184:187], v[224:227], v[48:51], v[184:187]
    v_mfma_f32_16x16x32_bf16 v[188:191], v[224:227], v[52:55], v[188:191]
    ds_read_b128 v[240:243], v4 offset:10240
    v_mul_f32 v209, v209, v9
    s_waitcnt lgkmcnt(3)
    v_mfma_f32_16x16x32_bf16 v[192:195], v[228:231], v[48:51], v[192:195]
    v_mfma_f32_16x16x32_bf16 v[196:199], v[228:231], v[52:55], v[196:199]
    ds_read_b128 v[244:247], v4 offset:11264
    v_mul_f32 v210, v210, v9
    s_waitcnt lgkmcnt(3)
    v_mfma_f32_16x16x32_bf16 v[184:187], v[232:235], v[56:59], v[184:187]
    v_mfma_f32_16x16x32_bf16 v[188:191], v[232:235], v[60:63], v[188:191]
    ds_read_b128 v[224:227], v4 offset:12288
    v_mul_f32 v211, v211, v9
    s_waitcnt lgkmcnt(3)
    v_mfma_f32_16x16x32_bf16 v[192:195], v[236:239], v[56:59], v[192:195]
    v_mfma_f32_16x16x32_bf16 v[196:199], v[236:239], v[60:63], v[196:199]
    ds_read_b128 v[228:231], v4 offset:13312
    v_cvt_pk_bf16_f32 v216, v200, v201
    s_waitcnt lgkmcnt(3)
    v_mfma_f32_16x16x32_bf16 v[184:187], v[240:243], v[64:67], v[184:187]
    v_mfma_f32_16x16x32_bf16 v[188:191], v[240:243], v[68:71], v[188:191]
    ds_read_b128 v[232:235], v4 offset:14336
    v_cvt_pk_bf16_f32 v217, v202, v203
    s_waitcnt lgkmcnt(3)
    v_mfma_f32_16x16x32_bf16 v[192:195], v[244:247], v[64:67], v[192:195]
    v_mfma_f32_16x16x32_bf16 v[196:199], v[244:247], v[68:71], v[196:199]
    ds_read_b128 v[236:239], v4 offset:15360
    v_cvt_pk_bf16_f32 v218, v208, v209
    s_waitcnt lgkmcnt(3)
    v_mfma_f32_16x16x32_bf16 v[184:187], v[224:227], v[72:75], v[184:187]
    v_mfma_f32_16x16x32_bf16 v[188:191], v[224:227], v[76:79], v[188:191]
    s_waitcnt vmcnt(16)
    s_barrier
    ds_read_b128 v[240:243], v4 offset:16384
    v_cvt_pk_bf16_f32 v219, v210, v211
    s_waitcnt lgkmcnt(3)
    v_mfma_f32_16x16x32_bf16 v[192:195], v[228:231], v[72:75], v[192:195]
    v_mfma_f32_16x16x32_bf16 v[196:199], v[228:231], v[76:79], v[196:199]
    s_add_u32 s22, s24, 0x80000
    s_add_u32 m0, s20, 0x24000
    s_nop 0
    buffer_load_dwordx4 v3, s[4:7], s22 offen lds
    ds_read_b128 v[244:247], v4 offset:17408
    buffer_store_dwordx4 v[216:219], v2, s[8:11], s25 offen offset:1024 sc1
    s_waitcnt lgkmcnt(3)
    v_mfma_f32_16x16x32_bf16 v[184:187], v[232:235], v[80:83], v[184:187]
    v_mfma_f32_16x16x32_bf16 v[188:191], v[232:235], v[84:87], v[188:191]
    ds_read_b128 v[224:227], v4 offset:18432
    v_mul_f32 v204, v204, v10
    s_waitcnt lgkmcnt(3)
    v_mfma_f32_16x16x32_bf16 v[192:195], v[236:239], v[80:83], v[192:195]
    v_mfma_f32_16x16x32_bf16 v[196:199], v[236:239], v[84:87], v[196:199]
    ds_read_b128 v[228:231], v4 offset:19456
    v_mul_f32 v205, v205, v10
    s_waitcnt lgkmcnt(3)
    v_mfma_f32_16x16x32_bf16 v[184:187], v[240:243], v[88:91], v[184:187]
    v_mfma_f32_16x16x32_bf16 v[188:191], v[240:243], v[92:95], v[188:191]
    ds_read_b128 v[232:235], v4 offset:20480
    v_mul_f32 v206, v206, v10
    s_waitcnt lgkmcnt(3)
    v_mfma_f32_16x16x32_bf16 v[192:195], v[244:247], v[88:91], v[192:195]
    v_mfma_f32_16x16x32_bf16 v[196:199], v[244:247], v[92:95], v[196:199]
    s_add_u32 s22, s24, 0x82000
    s_add_u32 m0, s20, 0x24400
    s_nop 0
    buffer_load_dwordx4 v3, s[4:7], s22 offen lds
    ds_read_b128 v[236:239], v4 offset:21504
    v_mul_f32 v207, v207, v10
    s_waitcnt lgkmcnt(3)
    v_mfma_f32_16x16x32_bf16 v[184:187], v[224:227], v[96:99], v[184:187]
    v_mfma_f32_16x16x32_bf16 v[188:191], v[224:227], v[100:103], v[188:191]
    ds_read_b128 v[240:243], v4 offset:22528
    v_mul_f32 v212, v212, v10
    s_waitcnt lgkmcnt(3)
    v_mfma_f32_16x16x32_bf16 v[192:195], v[228:231], v[96:99], v[192:195]
    v_mfma_f32_16x16x32_bf16 v[196:199], v[228:231], v[100:103], v[196:199]
    ds_read_b128 v[244:247], v4 offset:23552
    v_mul_f32 v213, v213, v10
    s_waitcnt lgkmcnt(3)
    v_mfma_f32_16x16x32_bf16 v[184:187], v[232:235], v[104:107], v[184:187]
    v_mfma_f32_16x16x32_bf16 v[188:191], v[232:235], v[108:111], v[188:191]
    ds_read_b128 v[224:227], v4 offset:24576
    v_mul_f32 v214, v214, v10
    s_waitcnt lgkmcnt(3)
    v_mfma_f32_16x16x32_bf16 v[192:195], v[236:239], v[104:107], v[192:195]
    v_mfma_f32_16x16x32_bf16 v[196:199], v[236:239], v[108:111], v[196:199]
    ds_read_b128 v[228:231], v4 offset:25600
    v_mul_f32 v215, v215, v10
    s_waitcnt lgkmcnt(3)
    v_mfma_f32_16x16x32_bf16 v[184:187], v[240:243], v[112:115], v[184:187]
    v_mfma_f32_16x16x32_bf16 v[188:191], v[240:243], v[116:119], v[188:191]
    ds_read_b128 v[232:235], v4 offset:26624
    v_cvt_pk_bf16_f32 v220, v204, v205
    s_waitcnt lgkmcnt(3)
    v_mfma_f32_16x16x32_bf16 v[192:195], v[244:247], v[112:115], v[192:195]
    v_mfma_f32_16x16x32_bf16 v[196:199], v[244:247], v[116:119], v[196:199]
    ds_read_b128 v[236:239], v4 offset:27648
    v_cvt_pk_bf16_f32 v221, v206, v207
    s_waitcnt lgkmcnt(3)
    v_mfma_f32_16x16x32_bf16 v[184:187], v[224:227], v[120:123], v[184:187]
    v_mfma_f32_16x16x32_bf16 v[188:191], v[224:227], v[124:127], v[188:191]
    ds_read_b128 v[240:243], v4 offset:28672
    v_cvt_pk_bf16_f32 v222, v212, v213
    s_waitcnt lgkmcnt(3)
    v_mfma_f32_16x16x32_bf16 v[192:195], v[228:231], v[120:123], v[192:195]
    v_mfma_f32_16x16x32_bf16 v[196:199], v[228:231], v[124:127], v[196:199]
    ds_read_b128 v[244:247], v4 offset:29696
    v_cvt_pk_bf16_f32 v223, v214, v215
    s_waitcnt lgkmcnt(3)
    v_mfma_f32_16x16x32_bf16 v[184:187], v[232:235], v[128:131], v[184:187]
    v_mfma_f32_16x16x32_bf16 v[188:191], v[232:235], v[132:135], v[188:191]
    ds_read_b128 v[224:227], v4 offset:30720
    buffer_store_dwordx4 v[220:223], v2, s[8:11], s26 offen offset:1024 sc1
    s_waitcnt lgkmcnt(3)
    v_mfma_f32_16x16x32_bf16 v[192:195], v[236:239], v[128:131], v[192:195]
    v_mfma_f32_16x16x32_bf16 v[196:199], v[236:239], v[132:135], v[196:199]
    ds_read_b128 v[228:231], v4 offset:31744
    s_waitcnt lgkmcnt(3)
    v_mfma_f32_16x16x32_bf16 v[184:187], v[240:243], v[136:139], v[184:187]
    v_mfma_f32_16x16x32_bf16 v[188:191], v[240:243], v[140:143], v[188:191]
    s_waitcnt vmcnt(18)
    s_barrier
    ds_read_b128 v[232:235], v4 offset:32768
    s_waitcnt lgkmcnt(3)
    v_mfma_f32_16x16x32_bf16 v[192:195], v[244:247], v[136:139], v[192:195]
    v_mfma_f32_16x16x32_bf16 v[196:199], v[244:247], v[140:143], v[196:199]
    s_add_u32 s22, s24, 0x100000
    s_add_u32 m0, s20, 0x10000
    s_nop 0
    buffer_load_dwordx4 v3, s[4:7], s22 offen lds
    ds_read_b128 v[236:239], v4 offset:33792
    s_waitcnt lgkmcnt(3)
    v_mfma_f32_16x16x32_bf16 v[184:187], v[224:227], v[144:147], v[184:187]
    v_mfma_f32_16x16x32_bf16 v[188:191], v[224:227], v[148:151], v[188:191]
    ds_read_b128 v[240:243], v4 offset:34816
    s_waitcnt lgkmcnt(3)
    v_mfma_f32_16x16x32_bf16 v[192:195], v[228:231], v[144:147], v[192:195]
    v_mfma_f32_16x16x32_bf16 v[196:199], v[228:231], v[148:151], v[196:199]
    ds_read_b128 v[244:247], v4 offset:35840
    s_waitcnt lgkmcnt(3)
    v_mfma_f32_16x16x32_bf16 v[200:203], v[232:235], v[24:27], 0
    v_mfma_f32_16x16x32_bf16 v[204:207], v[232:235], v[28:31], 0
    ds_read_b128 v[224:227], v4 offset:36864
    s_waitcnt lgkmcnt(3)
    v_mfma_f32_16x16x32_bf16 v[208:211], v[236:239], v[24:27], 0
    v_mfma_f32_16x16x32_bf16 v[212:215], v[236:239], v[28:31], 0
    s_add_u32 s22, s24, 0x102000
    s_add_u32 m0, s20, 0x10400
    s_nop 0
    buffer_load_dwordx4 v3, s[4:7], s22 offen lds
    ds_read_b128 v[228:231], v4 offset:37888
    v_mul_f32 v184, v184, v9
    s_waitcnt lgkmcnt(3)
    v_mfma_f32_16x16x32_bf16 v[200:203], v[240:243], v[32:35], v[200:203]
    v_mfma_f32_16x16x32_bf16 v[204:207], v[240:243], v[36:39], v[204:207]
    ds_read_b128 v[232:235], v4 offset:38912
    v_mul_f32 v185, v185, v9
    s_waitcnt lgkmcnt(3)
    v_mfma_f32_16x16x32_bf16 v[208:211], v[244:247], v[32:35], v[208:211]
    v_mfma_f32_16x16x32_bf16 v[212:215], v[244:247], v[36:39], v[212:215]
    ds_read_b128 v[236:239], v4 offset:39936
    v_mul_f32 v186, v186, v9
    s_waitcnt lgkmcnt(3)
    v_mfma_f32_16x16x32_bf16 v[200:203], v[224:227], v[40:43], v[200:203]
    s_waitcnt vmcnt(16)
    s_add_u32 s16, s63, 0x570000
    v_mov_b32 v20, s28
    v_mov_b32 v21, 0
    s_mov_b64 exec, 1
    buffer_store_dword v20, v21, s[8:11], s16 offen sc1
    s_mov_b64 exec, -1
    v_mfma_f32_16x16x32_bf16 v[204:207], v[224:227], v[44:47], v[204:207]
    ds_read_b128 v[240:243], v4 offset:40960
    v_mul_f32 v187, v187, v9
    s_waitcnt lgkmcnt(3)
    v_mfma_f32_16x16x32_bf16 v[208:211], v[228:231], v[40:43], v[208:211]
    v_mfma_f32_16x16x32_bf16 v[212:215], v[228:231], v[44:47], v[212:215]
    ds_read_b128 v[244:247], v4 offset:41984
    v_mul_f32 v192, v192, v9
    s_waitcnt lgkmcnt(3)
    v_mfma_f32_16x16x32_bf16 v[200:203], v[232:235], v[48:51], v[200:203]
    v_mfma_f32_16x16x32_bf16 v[204:207], v[232:235], v[52:55], v[204:207]
    ds_read_b128 v[224:227], v4 offset:43008
    v_mul_f32 v193, v193, v9
    s_waitcnt lgkmcnt(3)
    v_mfma_f32_16x16x32_bf16 v[208:211], v[236:239], v[48:51], v[208:211]
    v_mfma_f32_16x16x32_bf16 v[212:215], v[236:239], v[52:55], v[212:215]
    ds_read_b128 v[228:231], v4 offset:44032
    v_mul_f32 v194, v194, v9
    s_waitcnt lgkmcnt(3)
    v_mfma_f32_16x16x32_bf16 v[200:203], v[240:243], v[56:59], v[200:203]
    v_mfma_f32_16x16x32_bf16 v[204:207], v[240:243], v[60:63], v[204:207]
    ds_read_b128 v[232:235], v4 offset:45056
    v_mul_f32 v195, v195, v9
    s_waitcnt lgkmcnt(3)
    v_mfma_f32_16x16x32_bf16 v[208:211], v[244:247], v[56:59], v[208:211]
    v_mfma_f32_16x16x32_bf16 v[212:215], v[244:247], v[60:63], v[212:215]
    ds_read_b128 v[236:239], v4 offset:46080
    v_cvt_pk_bf16_f32 v216, v184, v185
    s_waitcnt lgkmcnt(3)
    v_mfma_f32_16x16x32_bf16 v[200:203], v[224:227], v[64:67], v[200:203]
    v_mfma_f32_16x16x32_bf16 v[204:207], v[224:227], v[68:71], v[204:207]
    ds_read_b128 v[240:243], v4 offset:47104
    v_cvt_pk_bf16_f32 v217, v186, v187
    s_waitcnt lgkmcnt(3)
    v_mfma_f32_16x16x32_bf16 v[208:211], v[228:231], v[64:67], v[208:211]
    v_mfma_f32_16x16x32_bf16 v[212:215], v[228:231], v[68:71], v[212:215]
    ds_read_b128 v[244:247], v4 offset:48128
    v_cvt_pk_bf16_f32 v218, v192, v193
    s_waitcnt lgkmcnt(3)
    v_mfma_f32_16x16x32_bf16 v[200:203], v[232:235], v[72:75], v[200:203]
    v_mfma_f32_16x16x32_bf16 v[204:207], v[232:235], v[76:79], v[204:207]
    s_barrier
    ds_read_b128 v[224:227], v4 offset:49152
    v_cvt_pk_bf16_f32 v219, v194, v195
    s_waitcnt lgkmcnt(3)
    v_mfma_f32_16x16x32_bf16 v[208:211], v[236:239], v[72:75], v[208:211]
    v_mfma_f32_16x16x32_bf16 v[212:215], v[236:239], v[76:79], v[212:215]
    s_add_u32 s22, s24, 0x180000
    s_add_u32 m0, s20, 0x14000
    s_nop 0
    buffer_load_dwordx4 v3, s[4:7], s22 offen lds
    ds_read_b128 v[228:231], v4 offset:50176
    buffer_store_dwordx4 v[216:219], v2, s[8:11], s25 offen offset:2048 sc1
    s_waitcnt lgkmcnt(3)
    v_mfma_f32_16x16x32_bf16 v[200:203], v[240:243], v[80:83], v[200:203]
    s_add_u32 s22, s18, 50176
    s_add_u32 m0, s15, 39936
    s_nop 0
    buffer_load_dwordx4 v11, s[68:71], s22 offen lds
    v_mfma_f32_16x16x32_bf16 v[204:207], v[240:243], v[84:87], v[204:207]
    ds_read_b128 v[232:235], v4 offset:51200
    v_mul_f32 v188, v188, v10
    s_waitcnt lgkmcnt(3)
    v_mfma_f32_16x16x32_bf16 v[208:211], v[244:247], v[80:83], v[208:211]
    v_mfma_f32_16x16x32_bf16 v[212:215], v[244:247], v[84:87], v[212:215]
    ds_read_b128 v[236:239], v4 offset:52224
    v_mul_f32 v189, v189, v10
    s_waitcnt lgkmcnt(3)
    v_mfma_f32_16x16x32_bf16 v[200:203], v[224:227], v[88:91], v[200:203]
    v_mfma_f32_16x16x32_bf16 v[204:207], v[224:227], v[92:95], v[204:207]
    ds_read_b128 v[240:243], v4 offset:53248
    v_mul_f32 v190, v190, v10
    s_waitcnt lgkmcnt(3)
    v_mfma_f32_16x16x32_bf16 v[208:211], v[228:231], v[88:91], v[208:211]
    v_mfma_f32_16x16x32_bf16 v[212:215], v[228:231], v[92:95], v[212:215]
    s_add_u32 s22, s24, 0x182000
    s_add_u32 m0, s20, 0x14400
    s_nop 0
    buffer_load_dwordx4 v3, s[4:7], s22 offen lds
    ds_read_b128 v[244:247], v4 offset:54272
    v_mul_f32 v191, v191, v10
    s_waitcnt lgkmcnt(3)
    v_mfma_f32_16x16x32_bf16 v[200:203], v[232:235], v[96:99], v[200:203]
    v_mfma_f32_16x16x32_bf16 v[204:207], v[232:235], v[100:103], v[204:207]
    ds_read_b128 v[224:227], v4 offset:55296
    v_mul_f32 v196, v196, v10
    s_waitcnt lgkmcnt(3)
    v_mfma_f32_16x16x32_bf16 v[208:211], v[236:239], v[96:99], v[208:211]
    v_mfma_f32_16x16x32_bf16 v[212:215], v[236:239], v[100:103], v[212:215]
    ds_read_b128 v[228:231], v4 offset:56320
    v_mul_f32 v197, v197, v10
    s_waitcnt lgkmcnt(3)
    v_mfma_f32_16x16x32_bf16 v[200:203], v[240:243], v[104:107], v[200:203]
    v_mfma_f32_16x16x32_bf16 v[204:207], v[240:243], v[108:111], v[204:207]
    ds_read_b128 v[232:235], v4 offset:57344
    v_mul_f32 v198, v198, v10
    s_waitcnt lgkmcnt(3)
    v_mfma_f32_16x16x32_bf16 v[208:211], v[244:247], v[104:107], v[208:211]
    v_mfma_f32_16x16x32_bf16 v[212:215], v[244:247], v[108:111], v[212:215]
    ds_read_b128 v[236:239], v4 offset:58368
    v_mul_f32 v199, v199, v10
    s_waitcnt lgkmcnt(3)
    v_mfma_f32_16x16x32_bf16 v[200:203], v[224:227], v[112:115], v[200:203]
    v_mfma_f32_16x16x32_bf16 v[204:207], v[224:227], v[116:119], v[204:207]
    ds_read_b128 v[240:243], v4 offset:59392
    v_cvt_pk_bf16_f32 v220, v188, v189
    s_waitcnt lgkmcnt(3)
    v_mfma_f32_16x16x32_bf16 v[208:211], v[228:231], v[112:115], v[208:211]
    v_mfma_f32_16x16x32_bf16 v[212:215], v[228:231], v[116:119], v[212:215]
    ds_read_b128 v[244:247], v4 offset:60416
    v_cvt_pk_bf16_f32 v221, v190, v191
    s_waitcnt lgkmcnt(3)
    v_mfma_f32_16x16x32_bf16 v[200:203], v[232:235], v[120:123], v[200:203]
    v_mfma_f32_16x16x32_bf16 v[204:207], v[232:235], v[124:127], v[204:207]
    ds_read_b128 v[224:227], v4 offset:61440
    v_cvt_pk_bf16_f32 v222, v196, v197
    s_waitcnt lgkmcnt(3)
    v_mfma_f32_16x16x32_bf16 v[208:211], v[236:239], v[120:123], v[208:211]
    v_mfma_f32_16x16x32_bf16 v[212:215], v[236:239], v[124:127], v[212:215]
    ds_read_b128 v[228:231], v4 offset:62464
    v_cvt_pk_bf16_f32 v223, v198, v199
    s_waitcnt lgkmcnt(3)
    v_mfma_f32_16x16x32_bf16 v[200:203], v[240:243], v[128:131], v[200:203]
    v_mfma_f32_16x16x32_bf16 v[204:207], v[240:243], v[132:135], v[204:207]
    ds_read_b128 v[232:235], v4 offset:63488
    buffer_store_dwordx4 v[220:223], v2, s[8:11], s26 offen offset:2048 sc1
    s_waitcnt lgkmcnt(3)
    v_mfma_f32_16x16x32_bf16 v[208:211], v[244:247], v[128:131], v[208:211]
    v_mfma_f32_16x16x32_bf16 v[212:215], v[244:247], v[132:135], v[212:215]
    ds_read_b128 v[236:239], v4 offset:64512
    s_waitcnt lgkmcnt(3)
    v_mfma_f32_16x16x32_bf16 v[200:203], v[224:227], v[136:139], v[200:203]
    v_mfma_f32_16x16x32_bf16 v[204:207], v[224:227], v[140:143], v[204:207]
    s_waitcnt lgkmcnt(2)
    v_mfma_f32_16x16x32_bf16 v[208:211], v[228:231], v[136:139], v[208:211]
    v_mfma_f32_16x16x32_bf16 v[212:215], v[228:231], v[140:143], v[212:215]
    s_waitcnt lgkmcnt(1)
    v_mfma_f32_16x16x32_bf16 v[200:203], v[232:235], v[144:147], v[200:203]
    v_mfma_f32_16x16x32_bf16 v[204:207], v[232:235], v[148:151], v[204:207]
    s_waitcnt lgkmcnt(0)
    v_mfma_f32_16x16x32_bf16 v[208:211], v[236:239], v[144:147], v[208:211]
    v_mfma_f32_16x16x32_bf16 v[212:215], v[236:239], v[148:151], v[212:215]
    s_waitcnt vmcnt(8)
    s_add_u32 s16, s63, 0x572000
    v_mov_b32 v20, s28
    v_mov_b32 v21, 0
    s_mov_b64 exec, 1
    buffer_store_dword v20, v21, s[8:11], s16 offen sc1
    s_mov_b64 exec, -1
    v_mul_f32 v200, v200, v9
    v_mul_f32 v201, v201, v9
    v_mul_f32 v202, v202, v9
    v_mul_f32 v203, v203, v9
    v_mul_f32 v208, v208, v9
    v_mul_f32 v209, v209, v9
    v_mul_f32 v210, v210, v9
    v_mul_f32 v211, v211, v9
    v_cvt_pk_bf16_f32 v216, v200, v201
    v_cvt_pk_bf16_f32 v217, v202, v203
    v_cvt_pk_bf16_f32 v218, v208, v209
    v_cvt_pk_bf16_f32 v219, v210, v211
    buffer_store_dwordx4 v[216:219], v2, s[8:11], s25 offen offset:3072 sc1
    v_mul_f32 v204, v204, v10
    v_mul_f32 v205, v205, v10
    v_mul_f32 v206, v206, v10
    v_mul_f32 v207, v207, v10
    v_mul_f32 v212, v212, v10
    v_mul_f32 v213, v213, v10
    v_mul_f32 v214, v214, v10
    v_mul_f32 v215, v215, v10
    v_cvt_pk_bf16_f32 v220, v204, v205
    v_cvt_pk_bf16_f32 v221, v206, v207
    v_cvt_pk_bf16_f32 v222, v212, v213
    v_cvt_pk_bf16_f32 v223, v214, v215
    buffer_store_dwordx4 v[220:223], v2, s[8:11], s26 offen offset:3072 sc1
    s_bfe_u32 s30, s2, 0x20001
    s_lshl_b32 s30, s30, 2
    s_bfe_u32 s17, s2, 0x20003
    s_add_u32 s30, s30, s17
    s_lshr_b32 s31, s2, 5
    s_and_b32 s15, s2, 1
    v_bfe_u32 v18, v1, 2, 2
    v_lshrrev_b32 v19, 4, v1
    v_and_b32 v20, 3, v1
    v_lshlrev_b32 v4, 11, v19
    v_lshl_add_u32 v4, v18, 6, v4
    v_lshl_add_u32 v4, v20, 3, v4
    v_add_u32 v4, 0x12000, v4
    v_and_b32 v21, 1, v19
    v_lshlrev_b32 v21, 5, v21
    v_sub_u32 v5, v4, v21
    v_add_u32 v4, v4, v21
    v_add_u32 v7, 0x10000, v4
    v_add_u32 v8, 0x10000, v5
    s_and_b32 s17, s3, 3
    s_lshl_b32 s18, s30, 2
    s_add_u32 s18, s18, s17
    s_lshl_b32 s19, s18, 18
    s_lshl_b32 s23, s15, 16
    s_add_u32 s19, s19, s23
    s_add_u32 s19, s19, 0x1001000
    v_add_u32 v11, s19, v2
    s_lshl_b32 s18, s18, 7
    s_lshl_b32 s23, s15, 6
    s_add_u32 s18, s18, s23
    s_add_u32 s18, s18, 0x570000
    v_and_b32 v18, 15, v1
    v_lshlrev_b32 v18, 2, v18
    s_mov_b32 s27, 0
adaLN_cond__sliding_block_cached__moe_arch_mod__prompt_kernel_o17p:
    buffer_load_dword v19, v18, s[8:11], s18 offen sc1
    s_waitcnt vmcnt(0)
    v_cmp_ne_u32 vcc, s28, v19
    s_add_u32 s27, s27, 1
    s_cmp_ge_u32 s27, 262144
    s_cbranch_scc1 adaLN_cond__sliding_block_cached__moe_arch_mod__prompt_kernel_o17g
    s_cbranch_vccnz adaLN_cond__sliding_block_cached__moe_arch_mod__prompt_kernel_o17p
adaLN_cond__sliding_block_cached__moe_arch_mod__prompt_kernel_o17g:
    s_mov_b32 s23, 0x0
    buffer_load_dwordx4 v[88:91], v11, s[8:11], s23 offen offset:0 sc1
    s_mov_b32 s23, 0x20000
    buffer_load_dwordx4 v[92:95], v11, s[8:11], s23 offen offset:0 sc1
    s_mov_b32 s23, 0x2000
    buffer_load_dwordx4 v[96:99], v11, s[8:11], s23 offen offset:0 sc1
    s_mov_b32 s23, 0x22000
    buffer_load_dwordx4 v[100:103], v11, s[8:11], s23 offen offset:0 sc1
    s_mov_b32 s23, 0x4000
    buffer_load_dwordx4 v[104:107], v11, s[8:11], s23 offen offset:0 sc1
    s_mov_b32 s23, 0x24000
    buffer_load_dwordx4 v[108:111], v11, s[8:11], s23 offen offset:0 sc1
    s_mov_b32 s23, 0x6000
    buffer_load_dwordx4 v[112:115], v11, s[8:11], s23 offen offset:0 sc1
    s_mov_b32 s23, 0x26000
    buffer_load_dwordx4 v[116:119], v11, s[8:11], s23 offen offset:0 sc1
    v_mov_b32 v13, v18
    s_barrier
    ds_read_b64_tr_b16 v[224:225], v7 offset:0
    ds_read_b64_tr_b16 v[226:227], v7 offset:1024
    ds_read_b64_tr_b16 v[228:229], v8 offset:32
    ds_read_b64_tr_b16 v[230:231], v8 offset:1056
    ds_read_b64_tr_b16 v[232:233], v7 offset:256
    ds_read_b64_tr_b16 v[234:235], v7 offset:1280
    ds_read_b64_tr_b16 v[236:237], v8 offset:288
    ds_read_b64_tr_b16 v[238:239], v8 offset:1312
    s_waitcnt vmcnt(7) lgkmcnt(6)
    v_mfma_f32_16x16x32_bf16 v[24:27], v[224:227], v[88:91], 0
    ds_read_b64_tr_b16 v[240:241], v7 offset:512
    s_waitcnt vmcnt(6)
    v_mfma_f32_16x16x32_bf16 v[28:31], v[224:227], v[92:95], 0
    s_add_u32 s22, s24, 0x200000
    s_add_u32 m0, s20, 0x18000
    s_nop 0
    buffer_load_dwordx4 v3, s[4:7], s22 offen lds
    ds_read_b64_tr_b16 v[242:243], v7 offset:1536
    s_waitcnt lgkmcnt(6)
    v_mfma_f32_16x16x32_bf16 v[32:35], v[228:231], v[88:91], 0
    ds_read_b64_tr_b16 v[244:245], v8 offset:544
    s_mov_b32 s23, 0x8000
    buffer_load_dwordx4 v[120:123], v11, s[8:11], s23 offen offset:0 sc1
    v_mfma_f32_16x16x32_bf16 v[36:39], v[228:231], v[92:95], 0
    ds_read_b64_tr_b16 v[246:247], v8 offset:1568
    s_waitcnt lgkmcnt(6)
    v_mfma_f32_16x16x32_bf16 v[40:43], v[232:235], v[88:91], 0
    ds_read_b64_tr_b16 v[224:225], v7 offset:768
    v_mfma_f32_16x16x32_bf16 v[44:47], v[232:235], v[92:95], 0
    ds_read_b64_tr_b16 v[226:227], v7 offset:1792
    s_waitcnt lgkmcnt(6)
    v_mfma_f32_16x16x32_bf16 v[48:51], v[236:239], v[88:91], 0
    ds_read_b64_tr_b16 v[228:229], v8 offset:800
    v_mfma_f32_16x16x32_bf16 v[52:55], v[236:239], v[92:95], 0
    ds_read_b64_tr_b16 v[230:231], v8 offset:1824
    s_waitcnt lgkmcnt(6)
    v_mfma_f32_16x16x32_bf16 v[56:59], v[240:243], v[88:91], 0
    s_add_u32 s22, s24, 0x202000
    s_add_u32 m0, s20, 0x18400
    s_nop 0
    buffer_load_dwordx4 v3, s[4:7], s22 offen lds
    s_mov_b32 s23, 0x28000
    buffer_load_dwordx4 v[124:127], v11, s[8:11], s23 offen offset:0 sc1
    v_mfma_f32_16x16x32_bf16 v[60:63], v[240:243], v[92:95], 0
    s_barrier
    ds_read_b64_tr_b16 v[232:233], v7 offset:16384
    ds_read_b64_tr_b16 v[234:235], v7 offset:17408
    s_waitcnt lgkmcnt(6)
    v_mfma_f32_16x16x32_bf16 v[64:67], v[244:247], v[88:91], 0
    s_add_u32 s22, s24, 0x280000
    s_add_u32 m0, s20, 0x1c000
    s_nop 0
    buffer_load_dwordx4 v3, s[4:7], s22 offen lds
    ds_read_b64_tr_b16 v[236:237], v8 offset:16416
    v_mfma_f32_16x16x32_bf16 v[68:71], v[244:247], v[92:95], 0
    ds_read_b64_tr_b16 v[238:239], v8 offset:17440
    s_waitcnt lgkmcnt(6)
    v_mfma_f32_16x16x32_bf16 v[72:75], v[224:227], v[88:91], 0
    ds_read_b64_tr_b16 v[240:241], v7 offset:16640
    v_mfma_f32_16x16x32_bf16 v[76:79], v[224:227], v[92:95], 0
    ds_read_b64_tr_b16 v[242:243], v7 offset:17664
    s_waitcnt lgkmcnt(6)
    v_mfma_f32_16x16x32_bf16 v[80:83], v[228:231], v[88:91], 0
    ds_read_b64_tr_b16 v[244:245], v8 offset:16672
    v_mfma_f32_16x16x32_bf16 v[84:87], v[228:231], v[92:95], 0
    ds_read_b64_tr_b16 v[246:247], v8 offset:17696
    s_waitcnt vmcnt(10) lgkmcnt(6)
    v_mfma_f32_16x16x32_bf16 v[24:27], v[232:235], v[96:99], v[24:27]
    ds_read_b64_tr_b16 v[224:225], v7 offset:16896
    s_waitcnt vmcnt(9)
    v_mfma_f32_16x16x32_bf16 v[28:31], v[232:235], v[100:103], v[28:31]
    s_add_u32 s22, s24, 0x282000
    s_add_u32 m0, s20, 0x1c400
    s_nop 0
    buffer_load_dwordx4 v3, s[4:7], s22 offen lds
    ds_read_b64_tr_b16 v[226:227], v7 offset:17920
    s_waitcnt lgkmcnt(6)
    v_mfma_f32_16x16x32_bf16 v[32:35], v[236:239], v[96:99], v[32:35]
    ds_read_b64_tr_b16 v[228:229], v8 offset:16928
    s_mov_b32 s23, 0xa000
    buffer_load_dwordx4 v[88:91], v11, s[8:11], s23 offen offset:0 sc1
    v_mfma_f32_16x16x32_bf16 v[36:39], v[236:239], v[100:103], v[36:39]
    ds_read_b64_tr_b16 v[230:231], v8 offset:17952
    s_waitcnt lgkmcnt(6)
    v_mfma_f32_16x16x32_bf16 v[40:43], v[240:243], v[96:99], v[40:43]
    s_add_u32 s16, s63, 0x574000
    v_mov_b32 v20, s28
    v_mov_b32 v21, 0
    s_mov_b64 exec, 1
    buffer_store_dword v20, v21, s[8:11], s16 offen sc1
    s_mov_b64 exec, -1
    ds_read_b64_tr_b16 v[232:233], v7 offset:17152
    v_mfma_f32_16x16x32_bf16 v[44:47], v[240:243], v[100:103], v[44:47]
    ds_read_b64_tr_b16 v[234:235], v7 offset:18176
    s_waitcnt lgkmcnt(6)
    v_mfma_f32_16x16x32_bf16 v[48:51], v[244:247], v[96:99], v[48:51]
    ds_read_b64_tr_b16 v[236:237], v8 offset:17184
    v_mfma_f32_16x16x32_bf16 v[52:55], v[244:247], v[100:103], v[52:55]
    ds_read_b64_tr_b16 v[238:239], v8 offset:18208
    s_waitcnt lgkmcnt(6)
    v_mfma_f32_16x16x32_bf16 v[56:59], v[224:227], v[96:99], v[56:59]
    s_mov_b32 s23, 0x2a000
    buffer_load_dwordx4 v[92:95], v11, s[8:11], s23 offen offset:0 sc1
    v_mfma_f32_16x16x32_bf16 v[60:63], v[224:227], v[100:103], v[60:63]
    s_barrier
    ds_read_b64_tr_b16 v[240:241], v4 offset:0
    ds_read_b64_tr_b16 v[242:243], v4 offset:1024
    s_waitcnt lgkmcnt(6)
    v_mfma_f32_16x16x32_bf16 v[64:67], v[228:231], v[96:99], v[64:67]
    s_add_u32 s22, s24, 0x300000
    s_add_u32 m0, s20, 0x20000
    s_nop 0
    buffer_load_dwordx4 v3, s[4:7], s22 offen lds
    ds_read_b64_tr_b16 v[244:245], v5 offset:32
    v_mfma_f32_16x16x32_bf16 v[68:71], v[228:231], v[100:103], v[68:71]
    ds_read_b64_tr_b16 v[246:247], v5 offset:1056
    s_waitcnt lgkmcnt(6)
    v_mfma_f32_16x16x32_bf16 v[72:75], v[232:235], v[96:99], v[72:75]
    ds_read_b64_tr_b16 v[224:225], v4 offset:256
    v_mfma_f32_16x16x32_bf16 v[76:79], v[232:235], v[100:103], v[76:79]
    ds_read_b64_tr_b16 v[226:227], v4 offset:1280
    s_waitcnt lgkmcnt(6)
    v_mfma_f32_16x16x32_bf16 v[80:83], v[236:239], v[96:99], v[80:83]
    ds_read_b64_tr_b16 v[228:229], v5 offset:288
    v_mfma_f32_16x16x32_bf16 v[84:87], v[236:239], v[100:103], v[84:87]
    ds_read_b64_tr_b16 v[230:231], v5 offset:1312
    s_waitcnt vmcnt(13) lgkmcnt(6)
    v_mfma_f32_16x16x32_bf16 v[24:27], v[240:243], v[104:107], v[24:27]
    ds_read_b64_tr_b16 v[232:233], v4 offset:512
    s_waitcnt vmcnt(12)
    v_mfma_f32_16x16x32_bf16 v[28:31], v[240:243], v[108:111], v[28:31]
    s_add_u32 s22, s24, 0x302000
    s_add_u32 m0, s20, 0x20400
    s_nop 0
    buffer_load_dwordx4 v3, s[4:7], s22 offen lds
    ds_read_b64_tr_b16 v[234:235], v4 offset:1536
    s_waitcnt lgkmcnt(6)
    v_mfma_f32_16x16x32_bf16 v[32:35], v[244:247], v[104:107], v[32:35]
    ds_read_b64_tr_b16 v[236:237], v5 offset:544
    s_mov_b32 s23, 0xc000
    buffer_load_dwordx4 v[96:99], v11, s[8:11], s23 offen offset:0 sc1
    v_mfma_f32_16x16x32_bf16 v[36:39], v[244:247], v[108:111], v[36:39]
    ds_read_b64_tr_b16 v[238:239], v5 offset:1568
    s_waitcnt lgkmcnt(6)
    v_mfma_f32_16x16x32_bf16 v[40:43], v[224:227], v[104:107], v[40:43]
    ds_read_b64_tr_b16 v[240:241], v4 offset:768
    v_mfma_f32_16x16x32_bf16 v[44:47], v[224:227], v[108:111], v[44:47]
    ds_read_b64_tr_b16 v[242:243], v4 offset:1792
    s_waitcnt lgkmcnt(6)
    v_mfma_f32_16x16x32_bf16 v[48:51], v[228:231], v[104:107], v[48:51]
    ds_read_b64_tr_b16 v[244:245], v5 offset:800
    v_mfma_f32_16x16x32_bf16 v[52:55], v[228:231], v[108:111], v[52:55]
    ds_read_b64_tr_b16 v[246:247], v5 offset:1824
    s_waitcnt lgkmcnt(6)
    v_mfma_f32_16x16x32_bf16 v[56:59], v[232:235], v[104:107], v[56:59]
    s_mov_b32 s23, 0x2c000
    buffer_load_dwordx4 v[100:103], v11, s[8:11], s23 offen offset:0 sc1
    v_mfma_f32_16x16x32_bf16 v[60:63], v[232:235], v[108:111], v[60:63]
    s_barrier
    ds_read_b64_tr_b16 v[224:225], v4 offset:16384
    ds_read_b64_tr_b16 v[226:227], v4 offset:17408
    s_add_u32 s17, s18, 8192
    buffer_load_dword v12, v13, s[8:11], s17 offen sc1
    s_waitcnt lgkmcnt(6)
    v_mfma_f32_16x16x32_bf16 v[64:67], v[236:239], v[104:107], v[64:67]
    s_add_u32 s22, s24, 0x380000
    s_add_u32 m0, s20, 0x24000
    s_nop 0
    buffer_load_dwordx4 v3, s[4:7], s22 offen lds
    ds_read_b64_tr_b16 v[228:229], v5 offset:16416
    v_mfma_f32_16x16x32_bf16 v[68:71], v[236:239], v[108:111], v[68:71]
    ds_read_b64_tr_b16 v[230:231], v5 offset:17440
    s_waitcnt lgkmcnt(6)
    v_mfma_f32_16x16x32_bf16 v[72:75], v[240:243], v[104:107], v[72:75]
    ds_read_b64_tr_b16 v[232:233], v4 offset:16640
    v_mfma_f32_16x16x32_bf16 v[76:79], v[240:243], v[108:111], v[76:79]
    ds_read_b64_tr_b16 v[234:235], v4 offset:17664
    s_waitcnt lgkmcnt(6)
    v_mfma_f32_16x16x32_bf16 v[80:83], v[244:247], v[104:107], v[80:83]
    ds_read_b64_tr_b16 v[236:237], v5 offset:16672
    v_mfma_f32_16x16x32_bf16 v[84:87], v[244:247], v[108:111], v[84:87]
    ds_read_b64_tr_b16 v[238:239], v5 offset:17696
    s_waitcnt vmcnt(16) lgkmcnt(6)
    v_mfma_f32_16x16x32_bf16 v[24:27], v[224:227], v[112:115], v[24:27]
    ds_read_b64_tr_b16 v[240:241], v4 offset:16896
    s_waitcnt vmcnt(15)
    v_mfma_f32_16x16x32_bf16 v[28:31], v[224:227], v[116:119], v[28:31]
    s_add_u32 s22, s24, 0x382000
    s_add_u32 m0, s20, 0x24400
    s_nop 0
    buffer_load_dwordx4 v3, s[4:7], s22 offen lds
    ds_read_b64_tr_b16 v[242:243], v4 offset:17920
    s_waitcnt lgkmcnt(6)
    v_mfma_f32_16x16x32_bf16 v[32:35], v[228:231], v[112:115], v[32:35]
    ds_read_b64_tr_b16 v[244:245], v5 offset:16928
    s_mov_b32 s23, 0xe000
    buffer_load_dwordx4 v[104:107], v11, s[8:11], s23 offen offset:0 sc1
    v_mfma_f32_16x16x32_bf16 v[36:39], v[228:231], v[116:119], v[36:39]
    ds_read_b64_tr_b16 v[246:247], v5 offset:17952
    s_waitcnt lgkmcnt(6)
    v_mfma_f32_16x16x32_bf16 v[40:43], v[232:235], v[112:115], v[40:43]
    ds_read_b64_tr_b16 v[224:225], v4 offset:17152
    v_mfma_f32_16x16x32_bf16 v[44:47], v[232:235], v[116:119], v[44:47]
    ds_read_b64_tr_b16 v[226:227], v4 offset:18176
    s_waitcnt lgkmcnt(6)
    v_mfma_f32_16x16x32_bf16 v[48:51], v[236:239], v[112:115], v[48:51]
    ds_read_b64_tr_b16 v[228:229], v5 offset:17184
    v_mfma_f32_16x16x32_bf16 v[52:55], v[236:239], v[116:119], v[52:55]
    ds_read_b64_tr_b16 v[230:231], v5 offset:18208
    s_waitcnt lgkmcnt(6)
    v_mfma_f32_16x16x32_bf16 v[56:59], v[240:243], v[112:115], v[56:59]
    s_mov_b32 s23, 0x2e000
    buffer_load_dwordx4 v[108:111], v11, s[8:11], s23 offen offset:0 sc1
    v_mfma_f32_16x16x32_bf16 v[60:63], v[240:243], v[116:119], v[60:63]
    s_waitcnt vmcnt(15)
    s_barrier
    ds_read_b64_tr_b16 v[232:233], v4 offset:32768
    ds_read_b64_tr_b16 v[234:235], v4 offset:33792
    s_waitcnt lgkmcnt(6)
    v_mfma_f32_16x16x32_bf16 v[64:67], v[244:247], v[112:115], v[64:67]
    s_add_u32 s22, s24, 0x10000
    s_add_u32 m0, s20, 0x10000
    s_nop 0
    buffer_load_dwordx4 v3, s[4:7], s22 offen lds
    ds_read_b64_tr_b16 v[236:237], v5 offset:32800
    v_mfma_f32_16x16x32_bf16 v[68:71], v[244:247], v[116:119], v[68:71]
    ds_read_b64_tr_b16 v[238:239], v5 offset:33824
    s_waitcnt lgkmcnt(6)
    v_mfma_f32_16x16x32_bf16 v[72:75], v[224:227], v[112:115], v[72:75]
    ds_read_b64_tr_b16 v[240:241], v4 offset:33024
    v_mfma_f32_16x16x32_bf16 v[76:79], v[224:227], v[116:119], v[76:79]
    ds_read_b64_tr_b16 v[242:243], v4 offset:34048
    s_waitcnt lgkmcnt(6)
    v_mfma_f32_16x16x32_bf16 v[80:83], v[228:231], v[112:115], v[80:83]
    ds_read_b64_tr_b16 v[244:245], v5 offset:33056
    v_mfma_f32_16x16x32_bf16 v[84:87], v[228:231], v[116:119], v[84:87]
    ds_read_b64_tr_b16 v[246:247], v5 offset:34080
    s_waitcnt vmcnt(5)
    v_cmp_ne_u32 vcc, s28, v12
    s_cbranch_vccnz adaLN_cond__sliding_block_cached__moe_arch_mod__prompt_kernel_o218r
adaLN_cond__sliding_block_cached__moe_arch_mod__prompt_kernel_o218b:
    s_waitcnt lgkmcnt(6)
    v_mfma_f32_16x16x32_bf16 v[24:27], v[232:235], v[120:123], v[24:27]
    ds_read_b64_tr_b16 v[224:225], v4 offset:33280
    v_mfma_f32_16x16x32_bf16 v[28:31], v[232:235], v[124:127], v[28:31]
    s_add_u32 s22, s24, 0x12000
    s_add_u32 m0, s20, 0x10400
    s_nop 0
    buffer_load_dwordx4 v3, s[4:7], s22 offen lds
    ds_read_b64_tr_b16 v[226:227], v4 offset:34304
    s_waitcnt lgkmcnt(6)
    v_mfma_f32_16x16x32_bf16 v[32:35], v[236:239], v[120:123], v[32:35]
    ds_read_b64_tr_b16 v[228:229], v5 offset:33312
    s_mov_b32 s23, 0x0
    buffer_load_dwordx4 v[112:115], v11, s[8:11], s23 offen offset:1024 sc1
    v_mfma_f32_16x16x32_bf16 v[36:39], v[236:239], v[124:127], v[36:39]
    ds_read_b64_tr_b16 v[230:231], v5 offset:34336
    s_waitcnt lgkmcnt(6)
    v_mfma_f32_16x16x32_bf16 v[40:43], v[240:243], v[120:123], v[40:43]
    ds_read_b64_tr_b16 v[232:233], v4 offset:33536
    v_mfma_f32_16x16x32_bf16 v[44:47], v[240:243], v[124:127], v[44:47]
    ds_read_b64_tr_b16 v[234:235], v4 offset:34560
    s_waitcnt lgkmcnt(6)
    v_mfma_f32_16x16x32_bf16 v[48:51], v[244:247], v[120:123], v[48:51]
    s_add_u32 s16, s63, 0x576000
    v_mov_b32 v20, s28
    v_mov_b32 v21, 0
    s_mov_b64 exec, 1
    buffer_store_dword v20, v21, s[8:11], s16 offen sc1
    s_mov_b64 exec, -1
    ds_read_b64_tr_b16 v[236:237], v5 offset:33568
    v_mfma_f32_16x16x32_bf16 v[52:55], v[244:247], v[124:127], v[52:55]
    ds_read_b64_tr_b16 v[238:239], v5 offset:34592
    s_waitcnt lgkmcnt(6)
    v_mfma_f32_16x16x32_bf16 v[56:59], v[224:227], v[120:123], v[56:59]
    s_mov_b32 s23, 0x20000
    buffer_load_dwordx4 v[116:119], v11, s[8:11], s23 offen offset:1024 sc1
    v_mfma_f32_16x16x32_bf16 v[60:63], v[224:227], v[124:127], v[60:63]
    s_barrier
    ds_read_b64_tr_b16 v[240:241], v4 offset:49152
    ds_read_b64_tr_b16 v[242:243], v4 offset:50176
    s_waitcnt lgkmcnt(6)
    v_mfma_f32_16x16x32_bf16 v[64:67], v[228:231], v[120:123], v[64:67]
    s_add_u32 s22, s24, 0x90000
    s_add_u32 m0, s20, 0x14000
    s_nop 0
    buffer_load_dwordx4 v3, s[4:7], s22 offen lds
    ds_read_b64_tr_b16 v[244:245], v5 offset:49184
    v_mfma_f32_16x16x32_bf16 v[68:71], v[228:231], v[124:127], v[68:71]
    ds_read_b64_tr_b16 v[246:247], v5 offset:50208
    s_waitcnt lgkmcnt(6)
    v_mfma_f32_16x16x32_bf16 v[72:75], v[232:235], v[120:123], v[72:75]
    ds_read_b64_tr_b16 v[224:225], v4 offset:49408
    v_mfma_f32_16x16x32_bf16 v[76:79], v[232:235], v[124:127], v[76:79]
    ds_read_b64_tr_b16 v[226:227], v4 offset:50432
    s_waitcnt lgkmcnt(6)
    v_mfma_f32_16x16x32_bf16 v[80:83], v[236:239], v[120:123], v[80:83]
    ds_read_b64_tr_b16 v[228:229], v5 offset:49440
    v_mfma_f32_16x16x32_bf16 v[84:87], v[236:239], v[124:127], v[84:87]
    ds_read_b64_tr_b16 v[230:231], v5 offset:50464
    s_waitcnt lgkmcnt(6)
    v_mfma_f32_16x16x32_bf16 v[24:27], v[240:243], v[88:91], v[24:27]
    ds_read_b64_tr_b16 v[232:233], v4 offset:49664
    v_mfma_f32_16x16x32_bf16 v[28:31], v[240:243], v[92:95], v[28:31]
    s_add_u32 s22, s24, 0x92000
    s_add_u32 m0, s20, 0x14400
    s_nop 0
    buffer_load_dwordx4 v3, s[4:7], s22 offen lds
    ds_read_b64_tr_b16 v[234:235], v4 offset:50688
    s_waitcnt lgkmcnt(6)
    v_mfma_f32_16x16x32_bf16 v[32:35], v[244:247], v[88:91], v[32:35]
    ds_read_b64_tr_b16 v[236:237], v5 offset:49696
    s_mov_b32 s23, 0x2000
    buffer_load_dwordx4 v[120:123], v11, s[8:11], s23 offen offset:1024 sc1
    v_mfma_f32_16x16x32_bf16 v[36:39], v[244:247], v[92:95], v[36:39]
    ds_read_b64_tr_b16 v[238:239], v5 offset:50720
    s_waitcnt lgkmcnt(6)
    v_mfma_f32_16x16x32_bf16 v[40:43], v[224:227], v[88:91], v[40:43]
    ds_read_b64_tr_b16 v[240:241], v4 offset:49920
    v_mfma_f32_16x16x32_bf16 v[44:47], v[224:227], v[92:95], v[44:47]
    ds_read_b64_tr_b16 v[242:243], v4 offset:50944
    s_waitcnt lgkmcnt(6)
    v_mfma_f32_16x16x32_bf16 v[48:51], v[228:231], v[88:91], v[48:51]
    ds_read_b64_tr_b16 v[244:245], v5 offset:49952
    v_mfma_f32_16x16x32_bf16 v[52:55], v[228:231], v[92:95], v[52:55]
    ds_read_b64_tr_b16 v[246:247], v5 offset:50976
    s_waitcnt lgkmcnt(6)
    v_mfma_f32_16x16x32_bf16 v[56:59], v[232:235], v[88:91], v[56:59]
    s_mov_b32 s23, 0x22000
    buffer_load_dwordx4 v[124:127], v11, s[8:11], s23 offen offset:1024 sc1
    v_mfma_f32_16x16x32_bf16 v[60:63], v[232:235], v[92:95], v[60:63]
    s_barrier
    ds_read_b64_tr_b16 v[224:225], v7 offset:0
    ds_read_b64_tr_b16 v[226:227], v7 offset:1024
    s_waitcnt lgkmcnt(6)
    v_mfma_f32_16x16x32_bf16 v[64:67], v[236:239], v[88:91], v[64:67]
    s_add_u32 s22, s24, 0x110000
    s_add_u32 m0, s20, 0x18000
    s_nop 0
    buffer_load_dwordx4 v3, s[4:7], s22 offen lds
    ds_read_b64_tr_b16 v[228:229], v8 offset:32
    v_mfma_f32_16x16x32_bf16 v[68:71], v[236:239], v[92:95], v[68:71]
    ds_read_b64_tr_b16 v[230:231], v8 offset:1056
    s_waitcnt lgkmcnt(6)
    v_mfma_f32_16x16x32_bf16 v[72:75], v[240:243], v[88:91], v[72:75]
    ds_read_b64_tr_b16 v[232:233], v7 offset:256
    v_mfma_f32_16x16x32_bf16 v[76:79], v[240:243], v[92:95], v[76:79]
    ds_read_b64_tr_b16 v[234:235], v7 offset:1280
    s_waitcnt lgkmcnt(6)
    v_mfma_f32_16x16x32_bf16 v[80:83], v[244:247], v[88:91], v[80:83]
    ds_read_b64_tr_b16 v[236:237], v8 offset:288
    v_mfma_f32_16x16x32_bf16 v[84:87], v[244:247], v[92:95], v[84:87]
    ds_read_b64_tr_b16 v[238:239], v8 offset:1312
    s_waitcnt lgkmcnt(6)
    v_mfma_f32_16x16x32_bf16 v[24:27], v[224:227], v[96:99], v[24:27]
    ds_read_b64_tr_b16 v[240:241], v7 offset:512
    v_mfma_f32_16x16x32_bf16 v[28:31], v[224:227], v[100:103], v[28:31]
    s_add_u32 s22, s24, 0x112000
    s_add_u32 m0, s20, 0x18400
    s_nop 0
    buffer_load_dwordx4 v3, s[4:7], s22 offen lds
    ds_read_b64_tr_b16 v[242:243], v7 offset:1536
    s_waitcnt lgkmcnt(6)
    v_mfma_f32_16x16x32_bf16 v[32:35], v[228:231], v[96:99], v[32:35]
    ds_read_b64_tr_b16 v[244:245], v8 offset:544
    s_mov_b32 s23, 0x4000
    buffer_load_dwordx4 v[88:91], v11, s[8:11], s23 offen offset:1024 sc1
    v_mfma_f32_16x16x32_bf16 v[36:39], v[228:231], v[100:103], v[36:39]
    ds_read_b64_tr_b16 v[246:247], v8 offset:1568
    s_waitcnt lgkmcnt(6)
    v_mfma_f32_16x16x32_bf16 v[40:43], v[232:235], v[96:99], v[40:43]
    ds_read_b64_tr_b16 v[224:225], v7 offset:768
    v_mfma_f32_16x16x32_bf16 v[44:47], v[232:235], v[100:103], v[44:47]
    ds_read_b64_tr_b16 v[226:227], v7 offset:1792
    s_waitcnt lgkmcnt(6)
    v_mfma_f32_16x16x32_bf16 v[48:51], v[236:239], v[96:99], v[48:51]
    ds_read_b64_tr_b16 v[228:229], v8 offset:800
    v_mfma_f32_16x16x32_bf16 v[52:55], v[236:239], v[100:103], v[52:55]
    ds_read_b64_tr_b16 v[230:231], v8 offset:1824
    s_waitcnt lgkmcnt(6)
    v_mfma_f32_16x16x32_bf16 v[56:59], v[240:243], v[96:99], v[56:59]
    s_mov_b32 s23, 0x24000
    buffer_load_dwordx4 v[92:95], v11, s[8:11], s23 offen offset:1024 sc1
    v_mfma_f32_16x16x32_bf16 v[60:63], v[240:243], v[100:103], v[60:63]
    s_waitcnt vmcnt(15)
    s_barrier
    ds_read_b64_tr_b16 v[232:233], v7 offset:16384
    ds_read_b64_tr_b16 v[234:235], v7 offset:17408
    s_waitcnt lgkmcnt(6)
    v_mfma_f32_16x16x32_bf16 v[64:67], v[244:247], v[96:99], v[64:67]
    s_add_u32 s22, s24, 0x190000
    s_add_u32 m0, s20, 0x1c000
    s_nop 0
    buffer_load_dwordx4 v3, s[4:7], s22 offen lds
    ds_read_b64_tr_b16 v[236:237], v8 offset:16416
    v_mfma_f32_16x16x32_bf16 v[68:71], v[244:247], v[100:103], v[68:71]
    ds_read_b64_tr_b16 v[238:239], v8 offset:17440
    s_waitcnt lgkmcnt(6)
    v_mfma_f32_16x16x32_bf16 v[72:75], v[224:227], v[96:99], v[72:75]
    ds_read_b64_tr_b16 v[240:241], v7 offset:16640
    v_mfma_f32_16x16x32_bf16 v[76:79], v[224:227], v[100:103], v[76:79]
    ds_read_b64_tr_b16 v[242:243], v7 offset:17664
    s_waitcnt lgkmcnt(6)
    v_mfma_f32_16x16x32_bf16 v[80:83], v[228:231], v[96:99], v[80:83]
    ds_read_b64_tr_b16 v[244:245], v8 offset:16672
    v_mfma_f32_16x16x32_bf16 v[84:87], v[228:231], v[100:103], v[84:87]
    ds_read_b64_tr_b16 v[246:247], v8 offset:17696
    s_waitcnt vmcnt(15) lgkmcnt(6)
    v_mfma_f32_16x16x32_bf16 v[24:27], v[232:235], v[104:107], v[24:27]
    ds_read_b64_tr_b16 v[224:225], v7 offset:16896
    s_waitcnt vmcnt(14)
    v_mfma_f32_16x16x32_bf16 v[28:31], v[232:235], v[108:111], v[28:31]
    s_add_u32 s22, s24, 0x192000
    s_add_u32 m0, s20, 0x1c400
    s_nop 0
    buffer_load_dwordx4 v3, s[4:7], s22 offen lds
    ds_read_b64_tr_b16 v[226:227], v7 offset:17920
    s_waitcnt lgkmcnt(6)
    v_mfma_f32_16x16x32_bf16 v[32:35], v[236:239], v[104:107], v[32:35]
    ds_read_b64_tr_b16 v[228:229], v8 offset:16928
    s_mov_b32 s23, 0x6000
    buffer_load_dwordx4 v[96:99], v11, s[8:11], s23 offen offset:1024 sc1
    v_mfma_f32_16x16x32_bf16 v[36:39], v[236:239], v[108:111], v[36:39]
    ds_read_b64_tr_b16 v[230:231], v8 offset:17952
    s_waitcnt lgkmcnt(6)
    v_mfma_f32_16x16x32_bf16 v[40:43], v[240:243], v[104:107], v[40:43]
    ds_read_b64_tr_b16 v[232:233], v7 offset:17152
    v_mfma_f32_16x16x32_bf16 v[44:47], v[240:243], v[108:111], v[44:47]
    ds_read_b64_tr_b16 v[234:235], v7 offset:18176
    s_waitcnt lgkmcnt(6)
    v_mfma_f32_16x16x32_bf16 v[48:51], v[244:247], v[104:107], v[48:51]
    ds_read_b64_tr_b16 v[236:237], v8 offset:17184
    v_mfma_f32_16x16x32_bf16 v[52:55], v[244:247], v[108:111], v[52:55]
    ds_read_b64_tr_b16 v[238:239], v8 offset:18208
    s_waitcnt lgkmcnt(6)
    v_mfma_f32_16x16x32_bf16 v[56:59], v[224:227], v[104:107], v[56:59]
    s_mov_b32 s23, 0x26000
    buffer_load_dwordx4 v[100:103], v11, s[8:11], s23 offen offset:1024 sc1
    v_mfma_f32_16x16x32_bf16 v[60:63], v[224:227], v[108:111], v[60:63]
    s_waitcnt vmcnt(15)
    s_barrier
    ds_read_b64_tr_b16 v[240:241], v4 offset:0
    ds_read_b64_tr_b16 v[242:243], v4 offset:1024
    s_waitcnt lgkmcnt(6)
    v_mfma_f32_16x16x32_bf16 v[64:67], v[228:231], v[104:107], v[64:67]
    s_add_u32 s22, s24, 0x210000
    s_add_u32 m0, s20, 0x20000
    s_nop 0
    buffer_load_dwordx4 v3, s[4:7], s22 offen lds
    ds_read_b64_tr_b16 v[244:245], v5 offset:32
    v_mfma_f32_16x16x32_bf16 v[68:71], v[228:231], v[108:111], v[68:71]
    ds_read_b64_tr_b16 v[246:247], v5 offset:1056
    s_waitcnt lgkmcnt(6)
    v_mfma_f32_16x16x32_bf16 v[72:75], v[232:235], v[104:107], v[72:75]
    ds_read_b64_tr_b16 v[224:225], v4 offset:256
    v_mfma_f32_16x16x32_bf16 v[76:79], v[232:235], v[108:111], v[76:79]
    ds_read_b64_tr_b16 v[226:227], v4 offset:1280
    s_waitcnt lgkmcnt(6)
    v_mfma_f32_16x16x32_bf16 v[80:83], v[236:239], v[104:107], v[80:83]
    ds_read_b64_tr_b16 v[228:229], v5 offset:288
    v_mfma_f32_16x16x32_bf16 v[84:87], v[236:239], v[108:111], v[84:87]
    ds_read_b64_tr_b16 v[230:231], v5 offset:1312
    s_waitcnt vmcnt(15) lgkmcnt(6)
    v_mfma_f32_16x16x32_bf16 v[24:27], v[240:243], v[112:115], v[24:27]
    ds_read_b64_tr_b16 v[232:233], v4 offset:512
    s_waitcnt vmcnt(13)
    v_mfma_f32_16x16x32_bf16 v[28:31], v[240:243], v[116:119], v[28:31]
    s_add_u32 s22, s24, 0x212000
    s_add_u32 m0, s20, 0x20400
    s_nop 0
    buffer_load_dwordx4 v3, s[4:7], s22 offen lds
    ds_read_b64_tr_b16 v[234:235], v4 offset:1536
    s_waitcnt lgkmcnt(6)
    v_mfma_f32_16x16x32_bf16 v[32:35], v[244:247], v[112:115], v[32:35]
    ds_read_b64_tr_b16 v[236:237], v5 offset:544
    s_mov_b32 s23, 0x8000
    buffer_load_dwordx4 v[104:107], v11, s[8:11], s23 offen offset:1024 sc1
    v_mfma_f32_16x16x32_bf16 v[36:39], v[244:247], v[116:119], v[36:39]
    ds_read_b64_tr_b16 v[238:239], v5 offset:1568
    s_waitcnt lgkmcnt(6)
    v_mfma_f32_16x16x32_bf16 v[40:43], v[224:227], v[112:115], v[40:43]
    ds_read_b64_tr_b16 v[240:241], v4 offset:768
    v_mfma_f32_16x16x32_bf16 v[44:47], v[224:227], v[116:119], v[44:47]
    ds_read_b64_tr_b16 v[242:243], v4 offset:1792
    s_waitcnt lgkmcnt(6)
    v_mfma_f32_16x16x32_bf16 v[48:51], v[228:231], v[112:115], v[48:51]
    ds_read_b64_tr_b16 v[244:245], v5 offset:800
    v_mfma_f32_16x16x32_bf16 v[52:55], v[228:231], v[116:119], v[52:55]
    ds_read_b64_tr_b16 v[246:247], v5 offset:1824
    s_waitcnt lgkmcnt(6)
    v_mfma_f32_16x16x32_bf16 v[56:59], v[232:235], v[112:115], v[56:59]
    s_mov_b32 s23, 0x28000
    buffer_load_dwordx4 v[108:111], v11, s[8:11], s23 offen offset:1024 sc1
    v_mfma_f32_16x16x32_bf16 v[60:63], v[232:235], v[116:119], v[60:63]
    s_waitcnt vmcnt(14)
    s_barrier
    ds_read_b64_tr_b16 v[224:225], v4 offset:16384
    ds_read_b64_tr_b16 v[226:227], v4 offset:17408
    s_waitcnt lgkmcnt(6)
    v_mfma_f32_16x16x32_bf16 v[64:67], v[236:239], v[112:115], v[64:67]
    s_add_u32 s22, s24, 0x290000
    s_add_u32 m0, s20, 0x24000
    s_nop 0
    buffer_load_dwordx4 v3, s[4:7], s22 offen lds
    ds_read_b64_tr_b16 v[228:229], v5 offset:16416
    v_mfma_f32_16x16x32_bf16 v[68:71], v[236:239], v[116:119], v[68:71]
    ds_read_b64_tr_b16 v[230:231], v5 offset:17440
    s_waitcnt lgkmcnt(6)
    v_mfma_f32_16x16x32_bf16 v[72:75], v[240:243], v[112:115], v[72:75]
    ds_read_b64_tr_b16 v[232:233], v4 offset:16640
    v_mfma_f32_16x16x32_bf16 v[76:79], v[240:243], v[116:119], v[76:79]
    ds_read_b64_tr_b16 v[234:235], v4 offset:17664
    s_waitcnt lgkmcnt(6)
    v_mfma_f32_16x16x32_bf16 v[80:83], v[244:247], v[112:115], v[80:83]
    ds_read_b64_tr_b16 v[236:237], v5 offset:16672
    v_mfma_f32_16x16x32_bf16 v[84:87], v[244:247], v[116:119], v[84:87]
    ds_read_b64_tr_b16 v[238:239], v5 offset:17696
    s_waitcnt vmcnt(14) lgkmcnt(6)
    v_mfma_f32_16x16x32_bf16 v[24:27], v[224:227], v[120:123], v[24:27]
    ds_read_b64_tr_b16 v[240:241], v4 offset:16896
    s_waitcnt vmcnt(13)
    v_mfma_f32_16x16x32_bf16 v[28:31], v[224:227], v[124:127], v[28:31]
    s_add_u32 s22, s24, 0x292000
    s_add_u32 m0, s20, 0x24400
    s_nop 0
    buffer_load_dwordx4 v3, s[4:7], s22 offen lds
    ds_read_b64_tr_b16 v[242:243], v4 offset:17920
    s_waitcnt lgkmcnt(6)
    v_mfma_f32_16x16x32_bf16 v[32:35], v[228:231], v[120:123], v[32:35]
    ds_read_b64_tr_b16 v[244:245], v5 offset:16928
    s_mov_b32 s23, 0xa000
    buffer_load_dwordx4 v[112:115], v11, s[8:11], s23 offen offset:1024 sc1
    v_mfma_f32_16x16x32_bf16 v[36:39], v[228:231], v[124:127], v[36:39]
    ds_read_b64_tr_b16 v[246:247], v5 offset:17952
    s_waitcnt lgkmcnt(6)
    v_mfma_f32_16x16x32_bf16 v[40:43], v[232:235], v[120:123], v[40:43]
    ds_read_b64_tr_b16 v[224:225], v4 offset:17152
    v_mfma_f32_16x16x32_bf16 v[44:47], v[232:235], v[124:127], v[44:47]
    ds_read_b64_tr_b16 v[226:227], v4 offset:18176
    s_waitcnt lgkmcnt(6)
    v_mfma_f32_16x16x32_bf16 v[48:51], v[236:239], v[120:123], v[48:51]
    ds_read_b64_tr_b16 v[228:229], v5 offset:17184
    v_mfma_f32_16x16x32_bf16 v[52:55], v[236:239], v[124:127], v[52:55]
    ds_read_b64_tr_b16 v[230:231], v5 offset:18208
    s_waitcnt lgkmcnt(6)
    v_mfma_f32_16x16x32_bf16 v[56:59], v[240:243], v[120:123], v[56:59]
    s_mov_b32 s23, 0x2a000
    buffer_load_dwordx4 v[116:119], v11, s[8:11], s23 offen offset:1024 sc1
    v_mfma_f32_16x16x32_bf16 v[60:63], v[240:243], v[124:127], v[60:63]
    s_waitcnt vmcnt(14)
    s_barrier
    ds_read_b64_tr_b16 v[232:233], v4 offset:32768
    ds_read_b64_tr_b16 v[234:235], v4 offset:33792
    s_waitcnt lgkmcnt(6)
    v_mfma_f32_16x16x32_bf16 v[64:67], v[244:247], v[120:123], v[64:67]
    s_add_u32 s22, s24, 0x310000
    s_add_u32 m0, s20, 0x10000
    s_nop 0
    buffer_load_dwordx4 v3, s[4:7], s22 offen lds
    ds_read_b64_tr_b16 v[236:237], v5 offset:32800
    v_mfma_f32_16x16x32_bf16 v[68:71], v[244:247], v[124:127], v[68:71]
    ds_read_b64_tr_b16 v[238:239], v5 offset:33824
    s_waitcnt lgkmcnt(6)
    v_mfma_f32_16x16x32_bf16 v[72:75], v[224:227], v[120:123], v[72:75]
    ds_read_b64_tr_b16 v[240:241], v4 offset:33024
    v_mfma_f32_16x16x32_bf16 v[76:79], v[224:227], v[124:127], v[76:79]
    ds_read_b64_tr_b16 v[242:243], v4 offset:34048
    s_waitcnt lgkmcnt(6)
    v_mfma_f32_16x16x32_bf16 v[80:83], v[228:231], v[120:123], v[80:83]
    ds_read_b64_tr_b16 v[244:245], v5 offset:33056
    v_mfma_f32_16x16x32_bf16 v[84:87], v[228:231], v[124:127], v[84:87]
    ds_read_b64_tr_b16 v[246:247], v5 offset:34080
    s_waitcnt vmcnt(14) lgkmcnt(6)
    v_mfma_f32_16x16x32_bf16 v[24:27], v[232:235], v[88:91], v[24:27]
    ds_read_b64_tr_b16 v[224:225], v4 offset:33280
    s_waitcnt vmcnt(13)
    v_mfma_f32_16x16x32_bf16 v[28:31], v[232:235], v[92:95], v[28:31]
    s_add_u32 s22, s24, 0x312000
    s_add_u32 m0, s20, 0x10400
    s_nop 0
    buffer_load_dwordx4 v3, s[4:7], s22 offen lds
    ds_read_b64_tr_b16 v[226:227], v4 offset:34304
    s_waitcnt lgkmcnt(6)
    v_mfma_f32_16x16x32_bf16 v[32:35], v[236:239], v[88:91], v[32:35]
    ds_read_b64_tr_b16 v[228:229], v5 offset:33312
    s_mov_b32 s23, 0xc000
    buffer_load_dwordx4 v[120:123], v11, s[8:11], s23 offen offset:1024 sc1
    v_mfma_f32_16x16x32_bf16 v[36:39], v[236:239], v[92:95], v[36:39]
    ds_read_b64_tr_b16 v[230:231], v5 offset:34336
    s_waitcnt lgkmcnt(6)
    v_mfma_f32_16x16x32_bf16 v[40:43], v[240:243], v[88:91], v[40:43]
    ds_read_b64_tr_b16 v[232:233], v4 offset:33536
    v_mfma_f32_16x16x32_bf16 v[44:47], v[240:243], v[92:95], v[44:47]
    ds_read_b64_tr_b16 v[234:235], v4 offset:34560
    s_waitcnt lgkmcnt(6)
    v_mfma_f32_16x16x32_bf16 v[48:51], v[244:247], v[88:91], v[48:51]
    ds_read_b64_tr_b16 v[236:237], v5 offset:33568
    v_mfma_f32_16x16x32_bf16 v[52:55], v[244:247], v[92:95], v[52:55]
    ds_read_b64_tr_b16 v[238:239], v5 offset:34592
    s_waitcnt lgkmcnt(6)
    v_mfma_f32_16x16x32_bf16 v[56:59], v[224:227], v[88:91], v[56:59]
    s_mov_b32 s23, 0x2c000
    buffer_load_dwordx4 v[124:127], v11, s[8:11], s23 offen offset:1024 sc1
    v_mfma_f32_16x16x32_bf16 v[60:63], v[224:227], v[92:95], v[60:63]
    s_waitcnt vmcnt(14)
    s_barrier
    ds_read_b64_tr_b16 v[240:241], v4 offset:49152
    ds_read_b64_tr_b16 v[242:243], v4 offset:50176
    s_add_u32 s17, s18, 16384
    buffer_load_dword v12, v13, s[8:11], s17 offen sc1
    s_waitcnt lgkmcnt(6)
    v_mfma_f32_16x16x32_bf16 v[64:67], v[228:231], v[88:91], v[64:67]
    s_add_u32 s22, s24, 0x390000
    s_add_u32 m0, s20, 0x14000
    s_nop 0
    buffer_load_dwordx4 v3, s[4:7], s22 offen lds
    ds_read_b64_tr_b16 v[244:245], v5 offset:49184
    v_mfma_f32_16x16x32_bf16 v[68:71], v[228:231], v[92:95], v[68:71]
    ds_read_b64_tr_b16 v[246:247], v5 offset:50208
    s_waitcnt lgkmcnt(6)
    v_mfma_f32_16x16x32_bf16 v[72:75], v[232:235], v[88:91], v[72:75]
    ds_read_b64_tr_b16 v[224:225], v4 offset:49408
    v_mfma_f32_16x16x32_bf16 v[76:79], v[232:235], v[92:95], v[76:79]
    ds_read_b64_tr_b16 v[226:227], v4 offset:50432
    s_waitcnt lgkmcnt(6)
    v_mfma_f32_16x16x32_bf16 v[80:83], v[236:239], v[88:91], v[80:83]
    ds_read_b64_tr_b16 v[228:229], v5 offset:49440
    v_mfma_f32_16x16x32_bf16 v[84:87], v[236:239], v[92:95], v[84:87]
    ds_read_b64_tr_b16 v[230:231], v5 offset:50464
    s_waitcnt vmcnt(15) lgkmcnt(6)
    v_mfma_f32_16x16x32_bf16 v[24:27], v[240:243], v[96:99], v[24:27]
    ds_read_b64_tr_b16 v[232:233], v4 offset:49664
    s_waitcnt vmcnt(14)
    v_mfma_f32_16x16x32_bf16 v[28:31], v[240:243], v[100:103], v[28:31]
    s_add_u32 s22, s24, 0x392000
    s_add_u32 m0, s20, 0x14400
    s_nop 0
    buffer_load_dwordx4 v3, s[4:7], s22 offen lds
    ds_read_b64_tr_b16 v[234:235], v4 offset:50688
    s_waitcnt lgkmcnt(6)
    v_mfma_f32_16x16x32_bf16 v[32:35], v[244:247], v[96:99], v[32:35]
    ds_read_b64_tr_b16 v[236:237], v5 offset:49696
    s_mov_b32 s23, 0xe000
    buffer_load_dwordx4 v[88:91], v11, s[8:11], s23 offen offset:1024 sc1
    v_mfma_f32_16x16x32_bf16 v[36:39], v[244:247], v[100:103], v[36:39]
    ds_read_b64_tr_b16 v[238:239], v5 offset:50720
    s_waitcnt lgkmcnt(6)
    v_mfma_f32_16x16x32_bf16 v[40:43], v[224:227], v[96:99], v[40:43]
    ds_read_b64_tr_b16 v[240:241], v4 offset:49920
    v_mfma_f32_16x16x32_bf16 v[44:47], v[224:227], v[100:103], v[44:47]
    ds_read_b64_tr_b16 v[242:243], v4 offset:50944
    s_waitcnt lgkmcnt(6)
    v_mfma_f32_16x16x32_bf16 v[48:51], v[228:231], v[96:99], v[48:51]
    ds_read_b64_tr_b16 v[244:245], v5 offset:49952
    v_mfma_f32_16x16x32_bf16 v[52:55], v[228:231], v[100:103], v[52:55]
    ds_read_b64_tr_b16 v[246:247], v5 offset:50976
    s_waitcnt lgkmcnt(6)
    v_mfma_f32_16x16x32_bf16 v[56:59], v[232:235], v[96:99], v[56:59]
    s_mov_b32 s23, 0x2e000
    buffer_load_dwordx4 v[92:95], v11, s[8:11], s23 offen offset:1024 sc1
    v_mfma_f32_16x16x32_bf16 v[60:63], v[232:235], v[100:103], v[60:63]
    s_waitcnt vmcnt(15)
    s_barrier
    ds_read_b64_tr_b16 v[224:225], v7 offset:0
    ds_read_b64_tr_b16 v[226:227], v7 offset:1024
    s_waitcnt lgkmcnt(6)
    v_mfma_f32_16x16x32_bf16 v[64:67], v[236:239], v[96:99], v[64:67]
    s_add_u32 s22, s24, 0x20000
    s_add_u32 m0, s20, 0x18000
    s_nop 0
    buffer_load_dwordx4 v3, s[4:7], s22 offen lds
    ds_read_b64_tr_b16 v[228:229], v8 offset:32
    v_mfma_f32_16x16x32_bf16 v[68:71], v[236:239], v[100:103], v[68:71]
    ds_read_b64_tr_b16 v[230:231], v8 offset:1056
    s_waitcnt lgkmcnt(6)
    v_mfma_f32_16x16x32_bf16 v[72:75], v[240:243], v[96:99], v[72:75]
    ds_read_b64_tr_b16 v[232:233], v7 offset:256
    v_mfma_f32_16x16x32_bf16 v[76:79], v[240:243], v[100:103], v[76:79]
    ds_read_b64_tr_b16 v[234:235], v7 offset:1280
    s_waitcnt lgkmcnt(6)
    v_mfma_f32_16x16x32_bf16 v[80:83], v[244:247], v[96:99], v[80:83]
    ds_read_b64_tr_b16 v[236:237], v8 offset:288
    v_mfma_f32_16x16x32_bf16 v[84:87], v[244:247], v[100:103], v[84:87]
    ds_read_b64_tr_b16 v[238:239], v8 offset:1312
    s_waitcnt vmcnt(5)
    v_cmp_ne_u32 vcc, s28, v12
    s_cbranch_vccnz adaLN_cond__sliding_block_cached__moe_arch_mod__prompt_kernel_o219r
adaLN_cond__sliding_block_cached__moe_arch_mod__prompt_kernel_o219b:
    s_waitcnt lgkmcnt(6)
    v_mfma_f32_16x16x32_bf16 v[24:27], v[224:227], v[104:107], v[24:27]
    ds_read_b64_tr_b16 v[240:241], v7 offset:512
    v_mfma_f32_16x16x32_bf16 v[28:31], v[224:227], v[108:111], v[28:31]
    s_add_u32 s22, s24, 0x22000
    s_add_u32 m0, s20, 0x18400
    s_nop 0
    buffer_load_dwordx4 v3, s[4:7], s22 offen lds
    ds_read_b64_tr_b16 v[242:243], v7 offset:1536
    s_waitcnt lgkmcnt(6)
    v_mfma_f32_16x16x32_bf16 v[32:35], v[228:231], v[104:107], v[32:35]
    ds_read_b64_tr_b16 v[244:245], v8 offset:544
    s_mov_b32 s23, 0x0
    buffer_load_dwordx4 v[96:99], v11, s[8:11], s23 offen offset:2048 sc1
    v_mfma_f32_16x16x32_bf16 v[36:39], v[228:231], v[108:111], v[36:39]
    ds_read_b64_tr_b16 v[246:247], v8 offset:1568
    s_waitcnt lgkmcnt(6)
    v_mfma_f32_16x16x32_bf16 v[40:43], v[232:235], v[104:107], v[40:43]
    ds_read_b64_tr_b16 v[224:225], v7 offset:768
    v_mfma_f32_16x16x32_bf16 v[44:47], v[232:235], v[108:111], v[44:47]
    ds_read_b64_tr_b16 v[226:227], v7 offset:1792
    s_waitcnt lgkmcnt(6)
    v_mfma_f32_16x16x32_bf16 v[48:51], v[236:239], v[104:107], v[48:51]
    ds_read_b64_tr_b16 v[228:229], v8 offset:800
    v_mfma_f32_16x16x32_bf16 v[52:55], v[236:239], v[108:111], v[52:55]
    ds_read_b64_tr_b16 v[230:231], v8 offset:1824
    s_waitcnt lgkmcnt(6)
    v_mfma_f32_16x16x32_bf16 v[56:59], v[240:243], v[104:107], v[56:59]
    s_mov_b32 s23, 0x20000
    buffer_load_dwordx4 v[100:103], v11, s[8:11], s23 offen offset:2048 sc1
    v_mfma_f32_16x16x32_bf16 v[60:63], v[240:243], v[108:111], v[60:63]
    s_barrier
    ds_read_b64_tr_b16 v[232:233], v7 offset:16384
    ds_read_b64_tr_b16 v[234:235], v7 offset:17408
    s_waitcnt lgkmcnt(6)
    v_mfma_f32_16x16x32_bf16 v[64:67], v[244:247], v[104:107], v[64:67]
    s_add_u32 s22, s24, 0xa0000
    s_add_u32 m0, s20, 0x1c000
    s_nop 0
    buffer_load_dwordx4 v3, s[4:7], s22 offen lds
    ds_read_b64_tr_b16 v[236:237], v8 offset:16416
    v_mfma_f32_16x16x32_bf16 v[68:71], v[244:247], v[108:111], v[68:71]
    ds_read_b64_tr_b16 v[238:239], v8 offset:17440
    s_waitcnt lgkmcnt(6)
    v_mfma_f32_16x16x32_bf16 v[72:75], v[224:227], v[104:107], v[72:75]
    ds_read_b64_tr_b16 v[240:241], v7 offset:16640
    v_mfma_f32_16x16x32_bf16 v[76:79], v[224:227], v[108:111], v[76:79]
    ds_read_b64_tr_b16 v[242:243], v7 offset:17664
    s_waitcnt lgkmcnt(6)
    v_mfma_f32_16x16x32_bf16 v[80:83], v[228:231], v[104:107], v[80:83]
    ds_read_b64_tr_b16 v[244:245], v8 offset:16672
    v_mfma_f32_16x16x32_bf16 v[84:87], v[228:231], v[108:111], v[84:87]
    ds_read_b64_tr_b16 v[246:247], v8 offset:17696
    s_waitcnt lgkmcnt(6)
    v_mfma_f32_16x16x32_bf16 v[24:27], v[232:235], v[112:115], v[24:27]
    ds_read_b64_tr_b16 v[224:225], v7 offset:16896
    v_mfma_f32_16x16x32_bf16 v[28:31], v[232:235], v[116:119], v[28:31]
    s_add_u32 s22, s24, 0xa2000
    s_add_u32 m0, s20, 0x1c400
    s_nop 0
    buffer_load_dwordx4 v3, s[4:7], s22 offen lds
    ds_read_b64_tr_b16 v[226:227], v7 offset:17920
    s_waitcnt lgkmcnt(6)
    v_mfma_f32_16x16x32_bf16 v[32:35], v[236:239], v[112:115], v[32:35]
    ds_read_b64_tr_b16 v[228:229], v8 offset:16928
    s_mov_b32 s23, 0x2000
    buffer_load_dwordx4 v[104:107], v11, s[8:11], s23 offen offset:2048 sc1
    v_mfma_f32_16x16x32_bf16 v[36:39], v[236:239], v[116:119], v[36:39]
    ds_read_b64_tr_b16 v[230:231], v8 offset:17952
    s_waitcnt lgkmcnt(6)
    v_mfma_f32_16x16x32_bf16 v[40:43], v[240:243], v[112:115], v[40:43]
    ds_read_b64_tr_b16 v[232:233], v7 offset:17152
    v_mfma_f32_16x16x32_bf16 v[44:47], v[240:243], v[116:119], v[44:47]
    ds_read_b64_tr_b16 v[234:235], v7 offset:18176
    s_waitcnt lgkmcnt(6)
    v_mfma_f32_16x16x32_bf16 v[48:51], v[244:247], v[112:115], v[48:51]
    ds_read_b64_tr_b16 v[236:237], v8 offset:17184
    v_mfma_f32_16x16x32_bf16 v[52:55], v[244:247], v[116:119], v[52:55]
    ds_read_b64_tr_b16 v[238:239], v8 offset:18208
    s_waitcnt lgkmcnt(6)
    v_mfma_f32_16x16x32_bf16 v[56:59], v[224:227], v[112:115], v[56:59]
    s_mov_b32 s23, 0x22000
    buffer_load_dwordx4 v[108:111], v11, s[8:11], s23 offen offset:2048 sc1
    v_mfma_f32_16x16x32_bf16 v[60:63], v[224:227], v[116:119], v[60:63]
    s_barrier
    ds_read_b64_tr_b16 v[240:241], v4 offset:0
    ds_read_b64_tr_b16 v[242:243], v4 offset:1024
    s_waitcnt lgkmcnt(6)
    v_mfma_f32_16x16x32_bf16 v[64:67], v[228:231], v[112:115], v[64:67]
    s_add_u32 s22, s24, 0x120000
    s_add_u32 m0, s20, 0x20000
    s_nop 0
    buffer_load_dwordx4 v3, s[4:7], s22 offen lds
    ds_read_b64_tr_b16 v[244:245], v5 offset:32
    v_mfma_f32_16x16x32_bf16 v[68:71], v[228:231], v[116:119], v[68:71]
    ds_read_b64_tr_b16 v[246:247], v5 offset:1056
    s_waitcnt lgkmcnt(6)
    v_mfma_f32_16x16x32_bf16 v[72:75], v[232:235], v[112:115], v[72:75]
    ds_read_b64_tr_b16 v[224:225], v4 offset:256
    v_mfma_f32_16x16x32_bf16 v[76:79], v[232:235], v[116:119], v[76:79]
    ds_read_b64_tr_b16 v[226:227], v4 offset:1280
    s_waitcnt lgkmcnt(6)
    v_mfma_f32_16x16x32_bf16 v[80:83], v[236:239], v[112:115], v[80:83]
    ds_read_b64_tr_b16 v[228:229], v5 offset:288
    v_mfma_f32_16x16x32_bf16 v[84:87], v[236:239], v[116:119], v[84:87]
    ds_read_b64_tr_b16 v[230:231], v5 offset:1312
    s_waitcnt lgkmcnt(6)
    v_mfma_f32_16x16x32_bf16 v[24:27], v[240:243], v[120:123], v[24:27]
    ds_read_b64_tr_b16 v[232:233], v4 offset:512
    v_mfma_f32_16x16x32_bf16 v[28:31], v[240:243], v[124:127], v[28:31]
    s_add_u32 s22, s24, 0x122000
    s_add_u32 m0, s20, 0x20400
    s_nop 0
    buffer_load_dwordx4 v3, s[4:7], s22 offen lds
    ds_read_b64_tr_b16 v[234:235], v4 offset:1536
    s_waitcnt lgkmcnt(6)
    v_mfma_f32_16x16x32_bf16 v[32:35], v[244:247], v[120:123], v[32:35]
    ds_read_b64_tr_b16 v[236:237], v5 offset:544
    s_mov_b32 s23, 0x4000
    buffer_load_dwordx4 v[112:115], v11, s[8:11], s23 offen offset:2048 sc1
    v_mfma_f32_16x16x32_bf16 v[36:39], v[244:247], v[124:127], v[36:39]
    ds_read_b64_tr_b16 v[238:239], v5 offset:1568
    s_waitcnt lgkmcnt(6)
    v_mfma_f32_16x16x32_bf16 v[40:43], v[224:227], v[120:123], v[40:43]
    ds_read_b64_tr_b16 v[240:241], v4 offset:768
    v_mfma_f32_16x16x32_bf16 v[44:47], v[224:227], v[124:127], v[44:47]
    ds_read_b64_tr_b16 v[242:243], v4 offset:1792
    s_waitcnt lgkmcnt(6)
    v_mfma_f32_16x16x32_bf16 v[48:51], v[228:231], v[120:123], v[48:51]
    ds_read_b64_tr_b16 v[244:245], v5 offset:800
    v_mfma_f32_16x16x32_bf16 v[52:55], v[228:231], v[124:127], v[52:55]
    ds_read_b64_tr_b16 v[246:247], v5 offset:1824
    s_waitcnt lgkmcnt(6)
    v_mfma_f32_16x16x32_bf16 v[56:59], v[232:235], v[120:123], v[56:59]
    s_mov_b32 s23, 0x24000
    buffer_load_dwordx4 v[116:119], v11, s[8:11], s23 offen offset:2048 sc1
    v_mfma_f32_16x16x32_bf16 v[60:63], v[232:235], v[124:127], v[60:63]
    s_waitcnt vmcnt(14)
    s_barrier
    ds_read_b64_tr_b16 v[224:225], v4 offset:16384
    ds_read_b64_tr_b16 v[226:227], v4 offset:17408
    s_waitcnt lgkmcnt(6)
    v_mfma_f32_16x16x32_bf16 v[64:67], v[236:239], v[120:123], v[64:67]
    s_add_u32 s22, s24, 0x1a0000
    s_add_u32 m0, s20, 0x24000
    s_nop 0
    buffer_load_dwordx4 v3, s[4:7], s22 offen lds
    ds_read_b64_tr_b16 v[228:229], v5 offset:16416
    v_mfma_f32_16x16x32_bf16 v[68:71], v[236:239], v[124:127], v[68:71]
    ds_read_b64_tr_b16 v[230:231], v5 offset:17440
    s_waitcnt lgkmcnt(6)
    v_mfma_f32_16x16x32_bf16 v[72:75], v[240:243], v[120:123], v[72:75]
    ds_read_b64_tr_b16 v[232:233], v4 offset:16640
    v_mfma_f32_16x16x32_bf16 v[76:79], v[240:243], v[124:127], v[76:79]
    ds_read_b64_tr_b16 v[234:235], v4 offset:17664
    s_waitcnt lgkmcnt(6)
    v_mfma_f32_16x16x32_bf16 v[80:83], v[244:247], v[120:123], v[80:83]
    ds_read_b64_tr_b16 v[236:237], v5 offset:16672
    v_mfma_f32_16x16x32_bf16 v[84:87], v[244:247], v[124:127], v[84:87]
    ds_read_b64_tr_b16 v[238:239], v5 offset:17696
    s_waitcnt vmcnt(14) lgkmcnt(6)
    v_mfma_f32_16x16x32_bf16 v[24:27], v[224:227], v[88:91], v[24:27]
    ds_read_b64_tr_b16 v[240:241], v4 offset:16896
    s_waitcnt vmcnt(13)
    v_mfma_f32_16x16x32_bf16 v[28:31], v[224:227], v[92:95], v[28:31]
    s_add_u32 s22, s24, 0x1a2000
    s_add_u32 m0, s20, 0x24400
    s_nop 0
    buffer_load_dwordx4 v3, s[4:7], s22 offen lds
    ds_read_b64_tr_b16 v[242:243], v4 offset:17920
    s_waitcnt lgkmcnt(6)
    v_mfma_f32_16x16x32_bf16 v[32:35], v[228:231], v[88:91], v[32:35]
    ds_read_b64_tr_b16 v[244:245], v5 offset:16928
    s_mov_b32 s23, 0x6000
    buffer_load_dwordx4 v[120:123], v11, s[8:11], s23 offen offset:2048 sc1
    v_mfma_f32_16x16x32_bf16 v[36:39], v[228:231], v[92:95], v[36:39]
    ds_read_b64_tr_b16 v[246:247], v5 offset:17952
    s_waitcnt lgkmcnt(6)
    v_mfma_f32_16x16x32_bf16 v[40:43], v[232:235], v[88:91], v[40:43]
    ds_read_b64_tr_b16 v[224:225], v4 offset:17152
    v_mfma_f32_16x16x32_bf16 v[44:47], v[232:235], v[92:95], v[44:47]
    ds_read_b64_tr_b16 v[226:227], v4 offset:18176
    s_waitcnt lgkmcnt(6)
    v_mfma_f32_16x16x32_bf16 v[48:51], v[236:239], v[88:91], v[48:51]
    ds_read_b64_tr_b16 v[228:229], v5 offset:17184
    v_mfma_f32_16x16x32_bf16 v[52:55], v[236:239], v[92:95], v[52:55]
    ds_read_b64_tr_b16 v[230:231], v5 offset:18208
    s_waitcnt lgkmcnt(6)
    v_mfma_f32_16x16x32_bf16 v[56:59], v[240:243], v[88:91], v[56:59]
    s_mov_b32 s23, 0x26000
    buffer_load_dwordx4 v[124:127], v11, s[8:11], s23 offen offset:2048 sc1
    v_mfma_f32_16x16x32_bf16 v[60:63], v[240:243], v[92:95], v[60:63]
    s_waitcnt vmcnt(14)
    s_barrier
    ds_read_b64_tr_b16 v[232:233], v4 offset:32768
    ds_read_b64_tr_b16 v[234:235], v4 offset:33792
    s_waitcnt lgkmcnt(6)
    v_mfma_f32_16x16x32_bf16 v[64:67], v[244:247], v[88:91], v[64:67]
    s_add_u32 s22, s24, 0x220000
    s_add_u32 m0, s20, 0x10000
    s_nop 0
    buffer_load_dwordx4 v3, s[4:7], s22 offen lds
    ds_read_b64_tr_b16 v[236:237], v5 offset:32800
    v_mfma_f32_16x16x32_bf16 v[68:71], v[244:247], v[92:95], v[68:71]
    ds_read_b64_tr_b16 v[238:239], v5 offset:33824
    s_waitcnt lgkmcnt(6)
    v_mfma_f32_16x16x32_bf16 v[72:75], v[224:227], v[88:91], v[72:75]
    ds_read_b64_tr_b16 v[240:241], v4 offset:33024
    v_mfma_f32_16x16x32_bf16 v[76:79], v[224:227], v[92:95], v[76:79]
    ds_read_b64_tr_b16 v[242:243], v4 offset:34048
    s_waitcnt lgkmcnt(6)
    v_mfma_f32_16x16x32_bf16 v[80:83], v[228:231], v[88:91], v[80:83]
    ds_read_b64_tr_b16 v[244:245], v5 offset:33056
    v_mfma_f32_16x16x32_bf16 v[84:87], v[228:231], v[92:95], v[84:87]
    ds_read_b64_tr_b16 v[246:247], v5 offset:34080
    s_waitcnt vmcnt(14) lgkmcnt(6)
    v_mfma_f32_16x16x32_bf16 v[24:27], v[232:235], v[96:99], v[24:27]
    ds_read_b64_tr_b16 v[224:225], v4 offset:33280
    s_waitcnt vmcnt(13)
    v_mfma_f32_16x16x32_bf16 v[28:31], v[232:235], v[100:103], v[28:31]
    s_add_u32 s22, s24, 0x222000
    s_add_u32 m0, s20, 0x10400
    s_nop 0
    buffer_load_dwordx4 v3, s[4:7], s22 offen lds
    ds_read_b64_tr_b16 v[226:227], v4 offset:34304
    s_waitcnt lgkmcnt(6)
    v_mfma_f32_16x16x32_bf16 v[32:35], v[236:239], v[96:99], v[32:35]
    ds_read_b64_tr_b16 v[228:229], v5 offset:33312
    s_mov_b32 s23, 0x8000
    buffer_load_dwordx4 v[88:91], v11, s[8:11], s23 offen offset:2048 sc1
    v_mfma_f32_16x16x32_bf16 v[36:39], v[236:239], v[100:103], v[36:39]
    ds_read_b64_tr_b16 v[230:231], v5 offset:34336
    s_waitcnt lgkmcnt(6)
    v_mfma_f32_16x16x32_bf16 v[40:43], v[240:243], v[96:99], v[40:43]
    ds_read_b64_tr_b16 v[232:233], v4 offset:33536
    v_mfma_f32_16x16x32_bf16 v[44:47], v[240:243], v[100:103], v[44:47]
    ds_read_b64_tr_b16 v[234:235], v4 offset:34560
    s_waitcnt lgkmcnt(6)
    v_mfma_f32_16x16x32_bf16 v[48:51], v[244:247], v[96:99], v[48:51]
    ds_read_b64_tr_b16 v[236:237], v5 offset:33568
    v_mfma_f32_16x16x32_bf16 v[52:55], v[244:247], v[100:103], v[52:55]
    ds_read_b64_tr_b16 v[238:239], v5 offset:34592
    s_waitcnt lgkmcnt(6)
    v_mfma_f32_16x16x32_bf16 v[56:59], v[224:227], v[96:99], v[56:59]
    s_mov_b32 s23, 0x28000
    buffer_load_dwordx4 v[92:95], v11, s[8:11], s23 offen offset:2048 sc1
    v_mfma_f32_16x16x32_bf16 v[60:63], v[224:227], v[100:103], v[60:63]
    s_waitcnt vmcnt(14)
    s_barrier
    ds_read_b64_tr_b16 v[240:241], v4 offset:49152
    ds_read_b64_tr_b16 v[242:243], v4 offset:50176
    s_waitcnt lgkmcnt(6)
    v_mfma_f32_16x16x32_bf16 v[64:67], v[228:231], v[96:99], v[64:67]
    s_add_u32 s22, s24, 0x2a0000
    s_add_u32 m0, s20, 0x14000
    s_nop 0
    buffer_load_dwordx4 v3, s[4:7], s22 offen lds
    ds_read_b64_tr_b16 v[244:245], v5 offset:49184
    v_mfma_f32_16x16x32_bf16 v[68:71], v[228:231], v[100:103], v[68:71]
    ds_read_b64_tr_b16 v[246:247], v5 offset:50208
    s_waitcnt lgkmcnt(6)
    v_mfma_f32_16x16x32_bf16 v[72:75], v[232:235], v[96:99], v[72:75]
    ds_read_b64_tr_b16 v[224:225], v4 offset:49408
    v_mfma_f32_16x16x32_bf16 v[76:79], v[232:235], v[100:103], v[76:79]
    ds_read_b64_tr_b16 v[226:227], v4 offset:50432
    s_waitcnt lgkmcnt(6)
    v_mfma_f32_16x16x32_bf16 v[80:83], v[236:239], v[96:99], v[80:83]
    ds_read_b64_tr_b16 v[228:229], v5 offset:49440
    v_mfma_f32_16x16x32_bf16 v[84:87], v[236:239], v[100:103], v[84:87]
    ds_read_b64_tr_b16 v[230:231], v5 offset:50464
    s_waitcnt vmcnt(14) lgkmcnt(6)
    v_mfma_f32_16x16x32_bf16 v[24:27], v[240:243], v[104:107], v[24:27]
    ds_read_b64_tr_b16 v[232:233], v4 offset:49664
    s_waitcnt vmcnt(13)
    v_mfma_f32_16x16x32_bf16 v[28:31], v[240:243], v[108:111], v[28:31]
    s_add_u32 s22, s24, 0x2a2000
    s_add_u32 m0, s20, 0x14400
    s_nop 0
    buffer_load_dwordx4 v3, s[4:7], s22 offen lds
    ds_read_b64_tr_b16 v[234:235], v4 offset:50688
    s_waitcnt lgkmcnt(6)
    v_mfma_f32_16x16x32_bf16 v[32:35], v[244:247], v[104:107], v[32:35]
    ds_read_b64_tr_b16 v[236:237], v5 offset:49696
    s_mov_b32 s23, 0xa000
    buffer_load_dwordx4 v[96:99], v11, s[8:11], s23 offen offset:2048 sc1
    v_mfma_f32_16x16x32_bf16 v[36:39], v[244:247], v[108:111], v[36:39]
    ds_read_b64_tr_b16 v[238:239], v5 offset:50720
    s_waitcnt lgkmcnt(6)
    v_mfma_f32_16x16x32_bf16 v[40:43], v[224:227], v[104:107], v[40:43]
    ds_read_b64_tr_b16 v[240:241], v4 offset:49920
    v_mfma_f32_16x16x32_bf16 v[44:47], v[224:227], v[108:111], v[44:47]
    ds_read_b64_tr_b16 v[242:243], v4 offset:50944
    s_waitcnt lgkmcnt(6)
    v_mfma_f32_16x16x32_bf16 v[48:51], v[228:231], v[104:107], v[48:51]
    ds_read_b64_tr_b16 v[244:245], v5 offset:49952
    v_mfma_f32_16x16x32_bf16 v[52:55], v[228:231], v[108:111], v[52:55]
    ds_read_b64_tr_b16 v[246:247], v5 offset:50976
    s_waitcnt lgkmcnt(6)
    v_mfma_f32_16x16x32_bf16 v[56:59], v[232:235], v[104:107], v[56:59]
    s_mov_b32 s23, 0x2a000
    buffer_load_dwordx4 v[100:103], v11, s[8:11], s23 offen offset:2048 sc1
    v_mfma_f32_16x16x32_bf16 v[60:63], v[232:235], v[108:111], v[60:63]
    s_waitcnt vmcnt(14)
    s_barrier
    ds_read_b64_tr_b16 v[224:225], v7 offset:0
    ds_read_b64_tr_b16 v[226:227], v7 offset:1024
    s_waitcnt lgkmcnt(6)
    v_mfma_f32_16x16x32_bf16 v[64:67], v[236:239], v[104:107], v[64:67]
    s_add_u32 s22, s24, 0x320000
    s_add_u32 m0, s20, 0x18000
    s_nop 0
    buffer_load_dwordx4 v3, s[4:7], s22 offen lds
    ds_read_b64_tr_b16 v[228:229], v8 offset:32
    v_mfma_f32_16x16x32_bf16 v[68:71], v[236:239], v[108:111], v[68:71]
    ds_read_b64_tr_b16 v[230:231], v8 offset:1056
    s_waitcnt lgkmcnt(6)
    v_mfma_f32_16x16x32_bf16 v[72:75], v[240:243], v[104:107], v[72:75]
    ds_read_b64_tr_b16 v[232:233], v7 offset:256
    v_mfma_f32_16x16x32_bf16 v[76:79], v[240:243], v[108:111], v[76:79]
    ds_read_b64_tr_b16 v[234:235], v7 offset:1280
    s_waitcnt lgkmcnt(6)
    v_mfma_f32_16x16x32_bf16 v[80:83], v[244:247], v[104:107], v[80:83]
    ds_read_b64_tr_b16 v[236:237], v8 offset:288
    v_mfma_f32_16x16x32_bf16 v[84:87], v[244:247], v[108:111], v[84:87]
    ds_read_b64_tr_b16 v[238:239], v8 offset:1312
    s_waitcnt vmcnt(14) lgkmcnt(6)
    v_mfma_f32_16x16x32_bf16 v[24:27], v[224:227], v[112:115], v[24:27]
    ds_read_b64_tr_b16 v[240:241], v7 offset:512
    s_waitcnt vmcnt(13)
    v_mfma_f32_16x16x32_bf16 v[28:31], v[224:227], v[116:119], v[28:31]
    s_add_u32 s22, s24, 0x322000
    s_add_u32 m0, s20, 0x18400
    s_nop 0
    buffer_load_dwordx4 v3, s[4:7], s22 offen lds
    ds_read_b64_tr_b16 v[242:243], v7 offset:1536
    s_waitcnt lgkmcnt(6)
    v_mfma_f32_16x16x32_bf16 v[32:35], v[228:231], v[112:115], v[32:35]
    ds_read_b64_tr_b16 v[244:245], v8 offset:544
    s_mov_b32 s23, 0xc000
    buffer_load_dwordx4 v[104:107], v11, s[8:11], s23 offen offset:2048 sc1
    v_mfma_f32_16x16x32_bf16 v[36:39], v[228:231], v[116:119], v[36:39]
    ds_read_b64_tr_b16 v[246:247], v8 offset:1568
    s_waitcnt lgkmcnt(6)
    v_mfma_f32_16x16x32_bf16 v[40:43], v[232:235], v[112:115], v[40:43]
    ds_read_b64_tr_b16 v[224:225], v7 offset:768
    v_mfma_f32_16x16x32_bf16 v[44:47], v[232:235], v[116:119], v[44:47]
    ds_read_b64_tr_b16 v[226:227], v7 offset:1792
    s_waitcnt lgkmcnt(6)
    v_mfma_f32_16x16x32_bf16 v[48:51], v[236:239], v[112:115], v[48:51]
    ds_read_b64_tr_b16 v[228:229], v8 offset:800
    v_mfma_f32_16x16x32_bf16 v[52:55], v[236:239], v[116:119], v[52:55]
    ds_read_b64_tr_b16 v[230:231], v8 offset:1824
    s_waitcnt lgkmcnt(6)
    v_mfma_f32_16x16x32_bf16 v[56:59], v[240:243], v[112:115], v[56:59]
    s_mov_b32 s23, 0x2c000
    buffer_load_dwordx4 v[108:111], v11, s[8:11], s23 offen offset:2048 sc1
    v_mfma_f32_16x16x32_bf16 v[60:63], v[240:243], v[116:119], v[60:63]
    s_waitcnt vmcnt(14)
    s_barrier
    ds_read_b64_tr_b16 v[232:233], v7 offset:16384
    ds_read_b64_tr_b16 v[234:235], v7 offset:17408
    s_add_u32 s17, s18, 24576
    buffer_load_dword v12, v13, s[8:11], s17 offen sc1
    s_waitcnt lgkmcnt(6)
    v_mfma_f32_16x16x32_bf16 v[64:67], v[244:247], v[112:115], v[64:67]
    s_add_u32 s22, s24, 0x3a0000
    s_add_u32 m0, s20, 0x1c000
    s_nop 0
    buffer_load_dwordx4 v3, s[4:7], s22 offen lds
    ds_read_b64_tr_b16 v[236:237], v8 offset:16416
    v_mfma_f32_16x16x32_bf16 v[68:71], v[244:247], v[116:119], v[68:71]
    ds_read_b64_tr_b16 v[238:239], v8 offset:17440
    s_waitcnt lgkmcnt(6)
    v_mfma_f32_16x16x32_bf16 v[72:75], v[224:227], v[112:115], v[72:75]
    ds_read_b64_tr_b16 v[240:241], v7 offset:16640
    v_mfma_f32_16x16x32_bf16 v[76:79], v[224:227], v[116:119], v[76:79]
    ds_read_b64_tr_b16 v[242:243], v7 offset:17664
    s_waitcnt lgkmcnt(6)
    v_mfma_f32_16x16x32_bf16 v[80:83], v[228:231], v[112:115], v[80:83]
    ds_read_b64_tr_b16 v[244:245], v8 offset:16672
    v_mfma_f32_16x16x32_bf16 v[84:87], v[228:231], v[116:119], v[84:87]
    ds_read_b64_tr_b16 v[246:247], v8 offset:17696
    s_waitcnt vmcnt(15) lgkmcnt(6)
    v_mfma_f32_16x16x32_bf16 v[24:27], v[232:235], v[120:123], v[24:27]
    ds_read_b64_tr_b16 v[224:225], v7 offset:16896
    s_waitcnt vmcnt(14)
    v_mfma_f32_16x16x32_bf16 v[28:31], v[232:235], v[124:127], v[28:31]
    s_add_u32 s22, s24, 0x3a2000
    s_add_u32 m0, s20, 0x1c400
    s_nop 0
    buffer_load_dwordx4 v3, s[4:7], s22 offen lds
    ds_read_b64_tr_b16 v[226:227], v7 offset:17920
    s_waitcnt lgkmcnt(6)
    v_mfma_f32_16x16x32_bf16 v[32:35], v[236:239], v[120:123], v[32:35]
    ds_read_b64_tr_b16 v[228:229], v8 offset:16928
    s_mov_b32 s23, 0xe000
    buffer_load_dwordx4 v[112:115], v11, s[8:11], s23 offen offset:2048 sc1
    v_mfma_f32_16x16x32_bf16 v[36:39], v[236:239], v[124:127], v[36:39]
    ds_read_b64_tr_b16 v[230:231], v8 offset:17952
    s_waitcnt lgkmcnt(6)
    v_mfma_f32_16x16x32_bf16 v[40:43], v[240:243], v[120:123], v[40:43]
    ds_read_b64_tr_b16 v[232:233], v7 offset:17152
    v_mfma_f32_16x16x32_bf16 v[44:47], v[240:243], v[124:127], v[44:47]
    ds_read_b64_tr_b16 v[234:235], v7 offset:18176
    s_waitcnt lgkmcnt(6)
    v_mfma_f32_16x16x32_bf16 v[48:51], v[244:247], v[120:123], v[48:51]
    ds_read_b64_tr_b16 v[236:237], v8 offset:17184
    v_mfma_f32_16x16x32_bf16 v[52:55], v[244:247], v[124:127], v[52:55]
    ds_read_b64_tr_b16 v[238:239], v8 offset:18208
    s_waitcnt lgkmcnt(6)
    v_mfma_f32_16x16x32_bf16 v[56:59], v[224:227], v[120:123], v[56:59]
    s_mov_b32 s23, 0x2e000
    buffer_load_dwordx4 v[116:119], v11, s[8:11], s23 offen offset:2048 sc1
    v_mfma_f32_16x16x32_bf16 v[60:63], v[224:227], v[124:127], v[60:63]
    s_waitcnt vmcnt(15)
    s_barrier
    ds_read_b64_tr_b16 v[240:241], v4 offset:0
    ds_read_b64_tr_b16 v[242:243], v4 offset:1024
    s_waitcnt lgkmcnt(6)
    v_mfma_f32_16x16x32_bf16 v[64:67], v[228:231], v[120:123], v[64:67]
    s_add_u32 s22, s24, 0x30000
    s_add_u32 m0, s20, 0x20000
    s_nop 0
    buffer_load_dwordx4 v3, s[4:7], s22 offen lds
    ds_read_b64_tr_b16 v[244:245], v5 offset:32
    v_mfma_f32_16x16x32_bf16 v[68:71], v[228:231], v[124:127], v[68:71]
    ds_read_b64_tr_b16 v[246:247], v5 offset:1056
    s_waitcnt lgkmcnt(6)
    v_mfma_f32_16x16x32_bf16 v[72:75], v[232:235], v[120:123], v[72:75]
    ds_read_b64_tr_b16 v[224:225], v4 offset:256
    v_mfma_f32_16x16x32_bf16 v[76:79], v[232:235], v[124:127], v[76:79]
    ds_read_b64_tr_b16 v[226:227], v4 offset:1280
    s_waitcnt lgkmcnt(6)
    v_mfma_f32_16x16x32_bf16 v[80:83], v[236:239], v[120:123], v[80:83]
    ds_read_b64_tr_b16 v[228:229], v5 offset:288
    v_mfma_f32_16x16x32_bf16 v[84:87], v[236:239], v[124:127], v[84:87]
    ds_read_b64_tr_b16 v[230:231], v5 offset:1312
    s_waitcnt vmcnt(5)
    v_cmp_ne_u32 vcc, s28, v12
    s_cbranch_vccnz adaLN_cond__sliding_block_cached__moe_arch_mod__prompt_kernel_o220r
adaLN_cond__sliding_block_cached__moe_arch_mod__prompt_kernel_o220b:
    s_waitcnt lgkmcnt(6)
    v_mfma_f32_16x16x32_bf16 v[24:27], v[240:243], v[88:91], v[24:27]
    ds_read_b64_tr_b16 v[232:233], v4 offset:512
    v_mfma_f32_16x16x32_bf16 v[28:31], v[240:243], v[92:95], v[28:31]
    s_add_u32 s22, s24, 0x32000
    s_add_u32 m0, s20, 0x20400
    s_nop 0
    buffer_load_dwordx4 v3, s[4:7], s22 offen lds
    ds_read_b64_tr_b16 v[234:235], v4 offset:1536
    s_waitcnt lgkmcnt(6)
    v_mfma_f32_16x16x32_bf16 v[32:35], v[244:247], v[88:91], v[32:35]
    ds_read_b64_tr_b16 v[236:237], v5 offset:544
    s_mov_b32 s23, 0x0
    buffer_load_dwordx4 v[120:123], v11, s[8:11], s23 offen offset:3072 sc1
    v_mfma_f32_16x16x32_bf16 v[36:39], v[244:247], v[92:95], v[36:39]
    ds_read_b64_tr_b16 v[238:239], v5 offset:1568
    s_waitcnt lgkmcnt(6)
    v_mfma_f32_16x16x32_bf16 v[40:43], v[224:227], v[88:91], v[40:43]
    ds_read_b64_tr_b16 v[240:241], v4 offset:768
    v_mfma_f32_16x16x32_bf16 v[44:47], v[224:227], v[92:95], v[44:47]
    ds_read_b64_tr_b16 v[242:243], v4 offset:1792
    s_waitcnt lgkmcnt(6)
    v_mfma_f32_16x16x32_bf16 v[48:51], v[228:231], v[88:91], v[48:51]
    ds_read_b64_tr_b16 v[244:245], v5 offset:800
    v_mfma_f32_16x16x32_bf16 v[52:55], v[228:231], v[92:95], v[52:55]
    ds_read_b64_tr_b16 v[246:247], v5 offset:1824
    s_waitcnt lgkmcnt(6)
    v_mfma_f32_16x16x32_bf16 v[56:59], v[232:235], v[88:91], v[56:59]
    s_mov_b32 s23, 0x20000
    buffer_load_dwordx4 v[124:127], v11, s[8:11], s23 offen offset:3072 sc1
    v_mfma_f32_16x16x32_bf16 v[60:63], v[232:235], v[92:95], v[60:63]
    s_barrier
    ds_read_b64_tr_b16 v[224:225], v4 offset:16384
    ds_read_b64_tr_b16 v[226:227], v4 offset:17408
    s_waitcnt lgkmcnt(6)
    v_mfma_f32_16x16x32_bf16 v[64:67], v[236:239], v[88:91], v[64:67]
    s_add_u32 s22, s24, 0xb0000
    s_add_u32 m0, s20, 0x24000
    s_nop 0
    buffer_load_dwordx4 v3, s[4:7], s22 offen lds
    ds_read_b64_tr_b16 v[228:229], v5 offset:16416
    v_mfma_f32_16x16x32_bf16 v[68:71], v[236:239], v[92:95], v[68:71]
    ds_read_b64_tr_b16 v[230:231], v5 offset:17440
    s_waitcnt lgkmcnt(6)
    v_mfma_f32_16x16x32_bf16 v[72:75], v[240:243], v[88:91], v[72:75]
    ds_read_b64_tr_b16 v[232:233], v4 offset:16640
    v_mfma_f32_16x16x32_bf16 v[76:79], v[240:243], v[92:95], v[76:79]
    ds_read_b64_tr_b16 v[234:235], v4 offset:17664
    s_waitcnt lgkmcnt(6)
    v_mfma_f32_16x16x32_bf16 v[80:83], v[244:247], v[88:91], v[80:83]
    ds_read_b64_tr_b16 v[236:237], v5 offset:16672
    v_mfma_f32_16x16x32_bf16 v[84:87], v[244:247], v[92:95], v[84:87]
    ds_read_b64_tr_b16 v[238:239], v5 offset:17696
    s_waitcnt lgkmcnt(6)
    v_mfma_f32_16x16x32_bf16 v[24:27], v[224:227], v[96:99], v[24:27]
    ds_read_b64_tr_b16 v[240:241], v4 offset:16896
    v_mfma_f32_16x16x32_bf16 v[28:31], v[224:227], v[100:103], v[28:31]
    s_add_u32 s22, s24, 0xb2000
    s_add_u32 m0, s20, 0x24400
    s_nop 0
    buffer_load_dwordx4 v3, s[4:7], s22 offen lds
    ds_read_b64_tr_b16 v[242:243], v4 offset:17920
    s_waitcnt lgkmcnt(6)
    v_mfma_f32_16x16x32_bf16 v[32:35], v[228:231], v[96:99], v[32:35]
    ds_read_b64_tr_b16 v[244:245], v5 offset:16928
    s_mov_b32 s23, 0x2000
    buffer_load_dwordx4 v[88:91], v11, s[8:11], s23 offen offset:3072 sc1
    v_mfma_f32_16x16x32_bf16 v[36:39], v[228:231], v[100:103], v[36:39]
    ds_read_b64_tr_b16 v[246:247], v5 offset:17952
    s_waitcnt lgkmcnt(6)
    v_mfma_f32_16x16x32_bf16 v[40:43], v[232:235], v[96:99], v[40:43]
    ds_read_b64_tr_b16 v[224:225], v4 offset:17152
    v_mfma_f32_16x16x32_bf16 v[44:47], v[232:235], v[100:103], v[44:47]
    ds_read_b64_tr_b16 v[226:227], v4 offset:18176
    s_waitcnt lgkmcnt(6)
    v_mfma_f32_16x16x32_bf16 v[48:51], v[236:239], v[96:99], v[48:51]
    ds_read_b64_tr_b16 v[228:229], v5 offset:17184
    v_mfma_f32_16x16x32_bf16 v[52:55], v[236:239], v[100:103], v[52:55]
    ds_read_b64_tr_b16 v[230:231], v5 offset:18208
    s_waitcnt lgkmcnt(6)
    v_mfma_f32_16x16x32_bf16 v[56:59], v[240:243], v[96:99], v[56:59]
    s_mov_b32 s23, 0x22000
    buffer_load_dwordx4 v[92:95], v11, s[8:11], s23 offen offset:3072 sc1
    v_mfma_f32_16x16x32_bf16 v[60:63], v[240:243], v[100:103], v[60:63]
    s_barrier
    ds_read_b64_tr_b16 v[232:233], v4 offset:32768
    ds_read_b64_tr_b16 v[234:235], v4 offset:33792
    s_waitcnt lgkmcnt(6)
    v_mfma_f32_16x16x32_bf16 v[64:67], v[244:247], v[96:99], v[64:67]
    s_add_u32 s22, s24, 0x130000
    s_add_u32 m0, s20, 0x10000
    s_nop 0
    buffer_load_dwordx4 v3, s[4:7], s22 offen lds
    ds_read_b64_tr_b16 v[236:237], v5 offset:32800
    v_mfma_f32_16x16x32_bf16 v[68:71], v[244:247], v[100:103], v[68:71]
    ds_read_b64_tr_b16 v[238:239], v5 offset:33824
    s_waitcnt lgkmcnt(6)
    v_mfma_f32_16x16x32_bf16 v[72:75], v[224:227], v[96:99], v[72:75]
    ds_read_b64_tr_b16 v[240:241], v4 offset:33024
    v_mfma_f32_16x16x32_bf16 v[76:79], v[224:227], v[100:103], v[76:79]
    ds_read_b64_tr_b16 v[242:243], v4 offset:34048
    s_waitcnt lgkmcnt(6)
    v_mfma_f32_16x16x32_bf16 v[80:83], v[228:231], v[96:99], v[80:83]
    ds_read_b64_tr_b16 v[244:245], v5 offset:33056
    v_mfma_f32_16x16x32_bf16 v[84:87], v[228:231], v[100:103], v[84:87]
    ds_read_b64_tr_b16 v[246:247], v5 offset:34080
    s_waitcnt lgkmcnt(6)
    v_mfma_f32_16x16x32_bf16 v[24:27], v[232:235], v[104:107], v[24:27]
    ds_read_b64_tr_b16 v[224:225], v4 offset:33280
    v_mfma_f32_16x16x32_bf16 v[28:31], v[232:235], v[108:111], v[28:31]
    s_add_u32 s22, s24, 0x132000
    s_add_u32 m0, s20, 0x10400
    s_nop 0
    buffer_load_dwordx4 v3, s[4:7], s22 offen lds
    ds_read_b64_tr_b16 v[226:227], v4 offset:34304
    s_waitcnt lgkmcnt(6)
    v_mfma_f32_16x16x32_bf16 v[32:35], v[236:239], v[104:107], v[32:35]
    ds_read_b64_tr_b16 v[228:229], v5 offset:33312
    s_mov_b32 s23, 0x4000
    buffer_load_dwordx4 v[96:99], v11, s[8:11], s23 offen offset:3072 sc1
    v_mfma_f32_16x16x32_bf16 v[36:39], v[236:239], v[108:111], v[36:39]
    ds_read_b64_tr_b16 v[230:231], v5 offset:34336
    s_waitcnt lgkmcnt(6)
    v_mfma_f32_16x16x32_bf16 v[40:43], v[240:243], v[104:107], v[40:43]
    ds_read_b64_tr_b16 v[232:233], v4 offset:33536
    v_mfma_f32_16x16x32_bf16 v[44:47], v[240:243], v[108:111], v[44:47]
    ds_read_b64_tr_b16 v[234:235], v4 offset:34560
    s_mov_b32 s16, 0x544000
    buffer_load_dwordx4 v[184:187], v2, s[8:11], s16 offen sc1
    s_waitcnt lgkmcnt(6)
    v_mfma_f32_16x16x32_bf16 v[48:51], v[244:247], v[104:107], v[48:51]
    ds_read_b64_tr_b16 v[236:237], v5 offset:33568
    v_mfma_f32_16x16x32_bf16 v[52:55], v[244:247], v[108:111], v[52:55]
    ds_read_b64_tr_b16 v[238:239], v5 offset:34592
    s_waitcnt lgkmcnt(6)
    v_mfma_f32_16x16x32_bf16 v[56:59], v[224:227], v[104:107], v[56:59]
    s_mov_b32 s23, 0x24000
    buffer_load_dwordx4 v[100:103], v11, s[8:11], s23 offen offset:3072 sc1
    v_mfma_f32_16x16x32_bf16 v[60:63], v[224:227], v[108:111], v[60:63]
    s_waitcnt vmcnt(15)
    s_barrier
    ds_read_b64_tr_b16 v[240:241], v4 offset:49152
    ds_read_b64_tr_b16 v[242:243], v4 offset:50176
    s_waitcnt lgkmcnt(6)
    v_mfma_f32_16x16x32_bf16 v[64:67], v[228:231], v[104:107], v[64:67]
    s_add_u32 s22, s24, 0x1b0000
    s_add_u32 m0, s20, 0x14000
    s_nop 0
    buffer_load_dwordx4 v3, s[4:7], s22 offen lds
    ds_read_b64_tr_b16 v[244:245], v5 offset:49184
    v_mfma_f32_16x16x32_bf16 v[68:71], v[228:231], v[108:111], v[68:71]
    ds_read_b64_tr_b16 v[246:247], v5 offset:50208
    s_waitcnt lgkmcnt(6)
    v_mfma_f32_16x16x32_bf16 v[72:75], v[232:235], v[104:107], v[72:75]
    ds_read_b64_tr_b16 v[224:225], v4 offset:49408
    v_mfma_f32_16x16x32_bf16 v[76:79], v[232:235], v[108:111], v[76:79]
    ds_read_b64_tr_b16 v[226:227], v4 offset:50432
    s_waitcnt lgkmcnt(6)
    v_mfma_f32_16x16x32_bf16 v[80:83], v[236:239], v[104:107], v[80:83]
    ds_read_b64_tr_b16 v[228:229], v5 offset:49440
    v_mfma_f32_16x16x32_bf16 v[84:87], v[236:239], v[108:111], v[84:87]
    ds_read_b64_tr_b16 v[230:231], v5 offset:50464
    s_waitcnt vmcnt(15) lgkmcnt(6)
    v_mfma_f32_16x16x32_bf16 v[24:27], v[240:243], v[112:115], v[24:27]
    ds_read_b64_tr_b16 v[232:233], v4 offset:49664
    s_waitcnt vmcnt(14)
    v_mfma_f32_16x16x32_bf16 v[28:31], v[240:243], v[116:119], v[28:31]
    s_add_u32 s22, s24, 0x1b2000
    s_add_u32 m0, s20, 0x14400
    s_nop 0
    buffer_load_dwordx4 v3, s[4:7], s22 offen lds
    ds_read_b64_tr_b16 v[234:235], v4 offset:50688
    s_waitcnt lgkmcnt(6)
    v_mfma_f32_16x16x32_bf16 v[32:35], v[244:247], v[112:115], v[32:35]
    ds_read_b64_tr_b16 v[236:237], v5 offset:49696
    s_mov_b32 s23, 0x6000
    buffer_load_dwordx4 v[104:107], v11, s[8:11], s23 offen offset:3072 sc1
    v_mfma_f32_16x16x32_bf16 v[36:39], v[244:247], v[116:119], v[36:39]
    ds_read_b64_tr_b16 v[238:239], v5 offset:50720
    s_waitcnt lgkmcnt(6)
    v_mfma_f32_16x16x32_bf16 v[40:43], v[224:227], v[112:115], v[40:43]
    ds_read_b64_tr_b16 v[240:241], v4 offset:49920
    v_mfma_f32_16x16x32_bf16 v[44:47], v[224:227], v[116:119], v[44:47]
    ds_read_b64_tr_b16 v[242:243], v4 offset:50944
    s_waitcnt lgkmcnt(6)
    v_mfma_f32_16x16x32_bf16 v[48:51], v[228:231], v[112:115], v[48:51]
    ds_read_b64_tr_b16 v[244:245], v5 offset:49952
    v_mfma_f32_16x16x32_bf16 v[52:55], v[228:231], v[116:119], v[52:55]
    ds_read_b64_tr_b16 v[246:247], v5 offset:50976
    s_waitcnt lgkmcnt(6)
    v_mfma_f32_16x16x32_bf16 v[56:59], v[232:235], v[112:115], v[56:59]
    s_mov_b32 s23, 0x26000
    buffer_load_dwordx4 v[108:111], v11, s[8:11], s23 offen offset:3072 sc1
    v_mfma_f32_16x16x32_bf16 v[60:63], v[232:235], v[116:119], v[60:63]
    s_waitcnt vmcnt(15)
    s_barrier
    ds_read_b64_tr_b16 v[224:225], v7 offset:0
    ds_read_b64_tr_b16 v[226:227], v7 offset:1024
    s_waitcnt lgkmcnt(6)
    v_mfma_f32_16x16x32_bf16 v[64:67], v[236:239], v[112:115], v[64:67]
    s_add_u32 s22, s24, 0x230000
    s_add_u32 m0, s20, 0x18000
    s_nop 0
    buffer_load_dwordx4 v3, s[4:7], s22 offen lds
    ds_read_b64_tr_b16 v[228:229], v8 offset:32
    v_mfma_f32_16x16x32_bf16 v[68:71], v[236:239], v[116:119], v[68:71]
    ds_read_b64_tr_b16 v[230:231], v8 offset:1056
    s_waitcnt lgkmcnt(6)
    v_mfma_f32_16x16x32_bf16 v[72:75], v[240:243], v[112:115], v[72:75]
    ds_read_b64_tr_b16 v[232:233], v7 offset:256
    v_mfma_f32_16x16x32_bf16 v[76:79], v[240:243], v[116:119], v[76:79]
    ds_read_b64_tr_b16 v[234:235], v7 offset:1280
    s_waitcnt lgkmcnt(6)
    v_mfma_f32_16x16x32_bf16 v[80:83], v[244:247], v[112:115], v[80:83]
    ds_read_b64_tr_b16 v[236:237], v8 offset:288
    v_mfma_f32_16x16x32_bf16 v[84:87], v[244:247], v[116:119], v[84:87]
    ds_read_b64_tr_b16 v[238:239], v8 offset:1312
    s_waitcnt vmcnt(15) lgkmcnt(6)
    v_mfma_f32_16x16x32_bf16 v[24:27], v[224:227], v[120:123], v[24:27]
    ds_read_b64_tr_b16 v[240:241], v7 offset:512
    s_waitcnt vmcnt(14)
    v_mfma_f32_16x16x32_bf16 v[28:31], v[224:227], v[124:127], v[28:31]
    s_add_u32 s22, s24, 0x232000
    s_add_u32 m0, s20, 0x18400
    s_nop 0
    buffer_load_dwordx4 v3, s[4:7], s22 offen lds
    ds_read_b64_tr_b16 v[242:243], v7 offset:1536
    s_waitcnt lgkmcnt(6)
    v_mfma_f32_16x16x32_bf16 v[32:35], v[228:231], v[120:123], v[32:35]
    ds_read_b64_tr_b16 v[244:245], v8 offset:544
    s_mov_b32 s23, 0x8000
    buffer_load_dwordx4 v[112:115], v11, s[8:11], s23 offen offset:3072 sc1
    v_mfma_f32_16x16x32_bf16 v[36:39], v[228:231], v[124:127], v[36:39]
    ds_read_b64_tr_b16 v[246:247], v8 offset:1568
    s_waitcnt lgkmcnt(6)
    v_mfma_f32_16x16x32_bf16 v[40:43], v[232:235], v[120:123], v[40:43]
    ds_read_b64_tr_b16 v[224:225], v7 offset:768
    v_mfma_f32_16x16x32_bf16 v[44:47], v[232:235], v[124:127], v[44:47]
    ds_read_b64_tr_b16 v[226:227], v7 offset:1792
    s_waitcnt lgkmcnt(6)
    v_mfma_f32_16x16x32_bf16 v[48:51], v[236:239], v[120:123], v[48:51]
    ds_read_b64_tr_b16 v[228:229], v8 offset:800
    v_mfma_f32_16x16x32_bf16 v[52:55], v[236:239], v[124:127], v[52:55]
    ds_read_b64_tr_b16 v[230:231], v8 offset:1824
    s_waitcnt lgkmcnt(6)
    v_mfma_f32_16x16x32_bf16 v[56:59], v[240:243], v[120:123], v[56:59]
    s_mov_b32 s23, 0x28000
    buffer_load_dwordx4 v[116:119], v11, s[8:11], s23 offen offset:3072 sc1
    v_mfma_f32_16x16x32_bf16 v[60:63], v[240:243], v[124:127], v[60:63]
    s_waitcnt vmcnt(15)
    s_barrier
    ds_read_b64_tr_b16 v[232:233], v7 offset:16384
    ds_read_b64_tr_b16 v[234:235], v7 offset:17408
    s_waitcnt lgkmcnt(6)
    v_mfma_f32_16x16x32_bf16 v[64:67], v[244:247], v[120:123], v[64:67]
    s_add_u32 s22, s24, 0x2b0000
    s_add_u32 m0, s20, 0x1c000
    s_nop 0
    buffer_load_dwordx4 v3, s[4:7], s22 offen lds
    ds_read_b64_tr_b16 v[236:237], v8 offset:16416
    v_mfma_f32_16x16x32_bf16 v[68:71], v[244:247], v[124:127], v[68:71]
    ds_read_b64_tr_b16 v[238:239], v8 offset:17440
    s_waitcnt lgkmcnt(6)
    v_mfma_f32_16x16x32_bf16 v[72:75], v[224:227], v[120:123], v[72:75]
    ds_read_b64_tr_b16 v[240:241], v7 offset:16640
    v_mfma_f32_16x16x32_bf16 v[76:79], v[224:227], v[124:127], v[76:79]
    ds_read_b64_tr_b16 v[242:243], v7 offset:17664
    s_waitcnt lgkmcnt(6)
    v_mfma_f32_16x16x32_bf16 v[80:83], v[228:231], v[120:123], v[80:83]
    ds_read_b64_tr_b16 v[244:245], v8 offset:16672
    v_mfma_f32_16x16x32_bf16 v[84:87], v[228:231], v[124:127], v[84:87]
    ds_read_b64_tr_b16 v[246:247], v8 offset:17696
    s_waitcnt vmcnt(15) lgkmcnt(6)
    v_mfma_f32_16x16x32_bf16 v[24:27], v[232:235], v[88:91], v[24:27]
    ds_read_b64_tr_b16 v[224:225], v7 offset:16896
    s_waitcnt vmcnt(14)
    v_mfma_f32_16x16x32_bf16 v[28:31], v[232:235], v[92:95], v[28:31]
    s_add_u32 s22, s24, 0x2b2000
    s_add_u32 m0, s20, 0x1c400
    s_nop 0
    buffer_load_dwordx4 v3, s[4:7], s22 offen lds
    ds_read_b64_tr_b16 v[226:227], v7 offset:17920
    s_waitcnt lgkmcnt(6)
    v_mfma_f32_16x16x32_bf16 v[32:35], v[236:239], v[88:91], v[32:35]
    ds_read_b64_tr_b16 v[228:229], v8 offset:16928
    s_mov_b32 s23, 0xa000
    buffer_load_dwordx4 v[120:123], v11, s[8:11], s23 offen offset:3072 sc1
    v_mfma_f32_16x16x32_bf16 v[36:39], v[236:239], v[92:95], v[36:39]
    ds_read_b64_tr_b16 v[230:231], v8 offset:17952
    s_waitcnt lgkmcnt(6)
    v_mfma_f32_16x16x32_bf16 v[40:43], v[240:243], v[88:91], v[40:43]
    ds_read_b64_tr_b16 v[232:233], v7 offset:17152
    v_mfma_f32_16x16x32_bf16 v[44:47], v[240:243], v[92:95], v[44:47]
    ds_read_b64_tr_b16 v[234:235], v7 offset:18176
    s_waitcnt lgkmcnt(6)
    v_mfma_f32_16x16x32_bf16 v[48:51], v[244:247], v[88:91], v[48:51]
    ds_read_b64_tr_b16 v[236:237], v8 offset:17184
    v_mfma_f32_16x16x32_bf16 v[52:55], v[244:247], v[92:95], v[52:55]
    ds_read_b64_tr_b16 v[238:239], v8 offset:18208
    s_waitcnt lgkmcnt(6)
    v_mfma_f32_16x16x32_bf16 v[56:59], v[224:227], v[88:91], v[56:59]
    s_mov_b32 s23, 0x2a000
    buffer_load_dwordx4 v[124:127], v11, s[8:11], s23 offen offset:3072 sc1
    v_mfma_f32_16x16x32_bf16 v[60:63], v[224:227], v[92:95], v[60:63]
    s_waitcnt vmcnt(15)
    s_barrier
    ds_read_b64_tr_b16 v[240:241], v4 offset:0
    ds_read_b64_tr_b16 v[242:243], v4 offset:1024
    s_waitcnt lgkmcnt(6)
    v_mfma_f32_16x16x32_bf16 v[64:67], v[228:231], v[88:91], v[64:67]
    s_add_u32 s22, s24, 0x330000
    s_add_u32 m0, s20, 0x20000
    s_nop 0
    buffer_load_dwordx4 v3, s[4:7], s22 offen lds
    ds_read_b64_tr_b16 v[244:245], v5 offset:32
    v_mfma_f32_16x16x32_bf16 v[68:71], v[228:231], v[92:95], v[68:71]
    ds_read_b64_tr_b16 v[246:247], v5 offset:1056
    s_waitcnt lgkmcnt(6)
    v_mfma_f32_16x16x32_bf16 v[72:75], v[232:235], v[88:91], v[72:75]
    ds_read_b64_tr_b16 v[224:225], v4 offset:256
    v_mfma_f32_16x16x32_bf16 v[76:79], v[232:235], v[92:95], v[76:79]
    ds_read_b64_tr_b16 v[226:227], v4 offset:1280
    s_waitcnt lgkmcnt(6)
    v_mfma_f32_16x16x32_bf16 v[80:83], v[236:239], v[88:91], v[80:83]
    ds_read_b64_tr_b16 v[228:229], v5 offset:288
    v_mfma_f32_16x16x32_bf16 v[84:87], v[236:239], v[92:95], v[84:87]
    ds_read_b64_tr_b16 v[230:231], v5 offset:1312
    s_waitcnt vmcnt(15) lgkmcnt(6)
    v_mfma_f32_16x16x32_bf16 v[24:27], v[240:243], v[96:99], v[24:27]
    ds_read_b64_tr_b16 v[232:233], v4 offset:512
    s_waitcnt vmcnt(13)
    v_mfma_f32_16x16x32_bf16 v[28:31], v[240:243], v[100:103], v[28:31]
    s_add_u32 s22, s24, 0x332000
    s_add_u32 m0, s20, 0x20400
    s_nop 0
    buffer_load_dwordx4 v3, s[4:7], s22 offen lds
    ds_read_b64_tr_b16 v[234:235], v4 offset:1536
    s_waitcnt lgkmcnt(6)
    v_mfma_f32_16x16x32_bf16 v[32:35], v[244:247], v[96:99], v[32:35]
    ds_read_b64_tr_b16 v[236:237], v5 offset:544
    s_mov_b32 s23, 0xc000
    buffer_load_dwordx4 v[88:91], v11, s[8:11], s23 offen offset:3072 sc1
    v_mfma_f32_16x16x32_bf16 v[36:39], v[244:247], v[100:103], v[36:39]
    ds_read_b64_tr_b16 v[238:239], v5 offset:1568
    s_waitcnt lgkmcnt(6)
    v_mfma_f32_16x16x32_bf16 v[40:43], v[224:227], v[96:99], v[40:43]
    ds_read_b64_tr_b16 v[240:241], v4 offset:768
    v_mfma_f32_16x16x32_bf16 v[44:47], v[224:227], v[100:103], v[44:47]
    ds_read_b64_tr_b16 v[242:243], v4 offset:1792
    v_xor_b32 v16, s28, v184
    v_xor_b32 v17, s28, v185
    v_xor_b32 v18, s28, v186
    v_xor_b32 v19, s28, v187
    v_or3_b32 v16, v16, v17, v18
    v_or_b32 v16, v16, v19
    v_cmp_ne_u32 vcc, 0, v16
    s_cbranch_vccnz adaLN_cond__sliding_block_cached__moe_arch_mod__prompt_kernel_mf21r
adaLN_cond__sliding_block_cached__moe_arch_mod__prompt_kernel_mf21b:
    s_waitcnt lgkmcnt(6)
    v_mfma_f32_16x16x32_bf16 v[48:51], v[228:231], v[96:99], v[48:51]
    ds_read_b64_tr_b16 v[244:245], v5 offset:800
    v_mfma_f32_16x16x32_bf16 v[52:55], v[228:231], v[100:103], v[52:55]
    ds_read_b64_tr_b16 v[246:247], v5 offset:1824
    s_waitcnt lgkmcnt(6)
    v_mfma_f32_16x16x32_bf16 v[56:59], v[232:235], v[96:99], v[56:59]
    s_mov_b32 s23, 0x2c000
    buffer_load_dwordx4 v[92:95], v11, s[8:11], s23 offen offset:3072 sc1
    v_mfma_f32_16x16x32_bf16 v[60:63], v[232:235], v[100:103], v[60:63]
    s_waitcnt vmcnt(14)
    s_barrier
    ds_read_b64_tr_b16 v[224:225], v4 offset:16384
    ds_read_b64_tr_b16 v[226:227], v4 offset:17408
    s_waitcnt lgkmcnt(6)
    v_mfma_f32_16x16x32_bf16 v[64:67], v[236:239], v[96:99], v[64:67]
    s_add_u32 s22, s24, 0x3b0000
    s_add_u32 m0, s20, 0x24000
    s_nop 0
    buffer_load_dwordx4 v3, s[4:7], s22 offen lds
    ds_read_b64_tr_b16 v[228:229], v5 offset:16416
    v_mfma_f32_16x16x32_bf16 v[68:71], v[236:239], v[100:103], v[68:71]
    ds_read_b64_tr_b16 v[230:231], v5 offset:17440
    s_waitcnt lgkmcnt(6)
    v_mfma_f32_16x16x32_bf16 v[72:75], v[240:243], v[96:99], v[72:75]
    ds_read_b64_tr_b16 v[232:233], v4 offset:16640
    v_mfma_f32_16x16x32_bf16 v[76:79], v[240:243], v[100:103], v[76:79]
    ds_read_b64_tr_b16 v[234:235], v4 offset:17664
    s_waitcnt lgkmcnt(6)
    v_mfma_f32_16x16x32_bf16 v[80:83], v[244:247], v[96:99], v[80:83]
    ds_read_b64_tr_b16 v[236:237], v5 offset:16672
    v_mfma_f32_16x16x32_bf16 v[84:87], v[244:247], v[100:103], v[84:87]
    ds_read_b64_tr_b16 v[238:239], v5 offset:17696
    s_waitcnt vmcnt(14) lgkmcnt(6)
    v_mfma_f32_16x16x32_bf16 v[24:27], v[224:227], v[104:107], v[24:27]
    ds_read_b64_tr_b16 v[240:241], v4 offset:16896
    s_waitcnt vmcnt(13)
    v_mfma_f32_16x16x32_bf16 v[28:31], v[224:227], v[108:111], v[28:31]
    s_add_u32 s22, s24, 0x3b2000
    s_add_u32 m0, s20, 0x24400
    s_nop 0
    buffer_load_dwordx4 v3, s[4:7], s22 offen lds
    ds_read_b64_tr_b16 v[242:243], v4 offset:17920
    s_waitcnt lgkmcnt(6)
    v_mfma_f32_16x16x32_bf16 v[32:35], v[228:231], v[104:107], v[32:35]
    ds_read_b64_tr_b16 v[244:245], v5 offset:16928
    s_mov_b32 s23, 0xe000
    buffer_load_dwordx4 v[96:99], v11, s[8:11], s23 offen offset:3072 sc1
    v_mfma_f32_16x16x32_bf16 v[36:39], v[228:231], v[108:111], v[36:39]
    ds_read_b64_tr_b16 v[246:247], v5 offset:17952
    s_waitcnt lgkmcnt(6)
    v_mfma_f32_16x16x32_bf16 v[40:43], v[232:235], v[104:107], v[40:43]
    ds_read_b64_tr_b16 v[224:225], v4 offset:17152
    v_mfma_f32_16x16x32_bf16 v[44:47], v[232:235], v[108:111], v[44:47]
    ds_read_b64_tr_b16 v[226:227], v4 offset:18176
    v_lshrrev_b32 v16, 4, v1
    v_lshlrev_b32 v16, 3, v16
    s_lshl_b32 s16, s31, 8
    s_add_u32 s16, s16, 0x540080
    buffer_load_dwordx2 v[248:249], v16, s[8:11], s16 offen offset:0 sc1
    buffer_load_dwordx2 v[250:251], v16, s[8:11], s16 offen offset:32 sc1
    buffer_load_dwordx2 v[252:253], v16, s[8:11], s16 offen offset:64 sc1
    buffer_load_dwordx2 v[254:255], v16, s[8:11], s16 offen offset:96 sc1
    s_waitcnt lgkmcnt(6)
    v_mfma_f32_16x16x32_bf16 v[48:51], v[236:239], v[104:107], v[48:51]
    ds_read_b64_tr_b16 v[228:229], v5 offset:17184
    v_mfma_f32_16x16x32_bf16 v[52:55], v[236:239], v[108:111], v[52:55]
    ds_read_b64_tr_b16 v[230:231], v5 offset:18208
    s_waitcnt lgkmcnt(6)
    v_mfma_f32_16x16x32_bf16 v[56:59], v[240:243], v[104:107], v[56:59]
    s_mov_b32 s23, 0x2e000
    buffer_load_dwordx4 v[100:103], v11, s[8:11], s23 offen offset:3072 sc1
    v_mfma_f32_16x16x32_bf16 v[60:63], v[240:243], v[108:111], v[60:63]
    s_waitcnt vmcnt(18)
    s_barrier
    ds_read_b64_tr_b16 v[232:233], v4 offset:32768
    ds_read_b64_tr_b16 v[234:235], v4 offset:33792
    s_waitcnt lgkmcnt(6)
    v_mfma_f32_16x16x32_bf16 v[64:67], v[244:247], v[104:107], v[64:67]
    ds_read_b64_tr_b16 v[236:237], v5 offset:32800
    v_mfma_f32_16x16x32_bf16 v[68:71], v[244:247], v[108:111], v[68:71]
    ds_read_b64_tr_b16 v[238:239], v5 offset:33824
    s_waitcnt lgkmcnt(6)
    v_mfma_f32_16x16x32_bf16 v[72:75], v[224:227], v[104:107], v[72:75]
    ds_read_b64_tr_b16 v[240:241], v4 offset:33024
    v_mfma_f32_16x16x32_bf16 v[76:79], v[224:227], v[108:111], v[76:79]
    ds_read_b64_tr_b16 v[242:243], v4 offset:34048
    s_waitcnt lgkmcnt(6)
    v_mfma_f32_16x16x32_bf16 v[80:83], v[228:231], v[104:107], v[80:83]
    ds_read_b64_tr_b16 v[244:245], v5 offset:33056
    v_mfma_f32_16x16x32_bf16 v[84:87], v[228:231], v[108:111], v[84:87]
    ds_read_b64_tr_b16 v[246:247], v5 offset:34080
    s_waitcnt vmcnt(17) lgkmcnt(6)
    v_mfma_f32_16x16x32_bf16 v[24:27], v[232:235], v[112:115], v[24:27]
    ds_read_b64_tr_b16 v[224:225], v4 offset:33280
    s_waitcnt vmcnt(16)
    v_mfma_f32_16x16x32_bf16 v[28:31], v[232:235], v[116:119], v[28:31]
    ds_read_b64_tr_b16 v[226:227], v4 offset:34304
    s_waitcnt lgkmcnt(6)
    v_mfma_f32_16x16x32_bf16 v[32:35], v[236:239], v[112:115], v[32:35]
    ds_read_b64_tr_b16 v[228:229], v5 offset:33312
    v_mfma_f32_16x16x32_bf16 v[36:39], v[236:239], v[116:119], v[36:39]
    ds_read_b64_tr_b16 v[230:231], v5 offset:34336
    s_waitcnt lgkmcnt(6)
    v_mfma_f32_16x16x32_bf16 v[40:43], v[240:243], v[112:115], v[40:43]
    ds_read_b64_tr_b16 v[232:233], v4 offset:33536
    v_mfma_f32_16x16x32_bf16 v[44:47], v[240:243], v[116:119], v[44:47]
    ds_read_b64_tr_b16 v[234:235], v4 offset:34560
    s_mov_b64 s[64:65], s[44:45]
    s_mov_b32 s66, 0x800
    s_mov_b32 s67, 0x20000
    s_mov_b64 s[76:77], s[32:33]
    s_mov_b32 s78, 0x400000
    s_mov_b32 s79, 0x20000
    s_mov_b64 s[68:69], s[56:57]
    s_mov_b32 s70, 0x400000
    s_mov_b32 s71, 0x20000
    s_lshl_b32 s14, s31, 1
    s_add_u32 s14, s14, s15
    s_lshl_b32 s14, s14, 3
    s_add_u32 s14, s14, s3
    s_lshl_b32 s16, s30, 7
    s_add_u32 s14, s14, s16
    s_lshl_b32 s16, s14, 11
    buffer_load_dwordx4 v[216:219], v2, s[76:79], s16 offen offset:0
    buffer_load_dwordx4 v[220:223], v2, s[76:79], s16 offen offset:1024
    s_mov_b32 s16, 0x540800
    buffer_load_dwordx4 v[184:187], v2, s[8:11], s16 offen offset:0 sc1
    buffer_load_dwordx4 v[188:191], v2, s[8:11], s16 offen offset:1024 sc1
    s_mov_b32 s16, 0x541000
    buffer_load_dwordx4 v[192:195], v2, s[8:11], s16 offen offset:0 sc1
    buffer_load_dwordx4 v[196:199], v2, s[8:11], s16 offen offset:1024 sc1
    s_mov_b32 s16, 0x541800
    buffer_load_dwordx4 v[200:203], v2, s[8:11], s16 offen offset:0 sc1
    buffer_load_dwordx4 v[204:207], v2, s[8:11], s16 offen offset:1024 sc1
    buffer_load_dwordx4 v[208:211], v2, s[64:67], 0 offen offset:0
    buffer_load_dwordx4 v[212:215], v2, s[64:67], 0 offen offset:1024
    s_waitcnt lgkmcnt(6)
    v_mfma_f32_16x16x32_bf16 v[48:51], v[244:247], v[112:115], v[48:51]
    ds_read_b64_tr_b16 v[236:237], v5 offset:33568
    v_mfma_f32_16x16x32_bf16 v[52:55], v[244:247], v[116:119], v[52:55]
    ds_read_b64_tr_b16 v[238:239], v5 offset:34592
    s_waitcnt lgkmcnt(6)
    v_mfma_f32_16x16x32_bf16 v[56:59], v[224:227], v[112:115], v[56:59]
    v_mfma_f32_16x16x32_bf16 v[60:63], v[224:227], v[116:119], v[60:63]
    s_waitcnt vmcnt(24)
    s_barrier
    ds_read_b64_tr_b16 v[240:241], v4 offset:49152
    ds_read_b64_tr_b16 v[242:243], v4 offset:50176
    s_waitcnt lgkmcnt(6)
    v_mfma_f32_16x16x32_bf16 v[64:67], v[228:231], v[112:115], v[64:67]
    ds_read_b64_tr_b16 v[244:245], v5 offset:49184
    v_mfma_f32_16x16x32_bf16 v[68:71], v[228:231], v[116:119], v[68:71]
    ds_read_b64_tr_b16 v[246:247], v5 offset:50208
    s_waitcnt lgkmcnt(6)
    v_mfma_f32_16x16x32_bf16 v[72:75], v[232:235], v[112:115], v[72:75]
    ds_read_b64_tr_b16 v[224:225], v4 offset:49408
    v_mfma_f32_16x16x32_bf16 v[76:79], v[232:235], v[116:119], v[76:79]
    ds_read_b64_tr_b16 v[226:227], v4 offset:50432
    s_waitcnt lgkmcnt(6)
    v_mfma_f32_16x16x32_bf16 v[80:83], v[236:239], v[112:115], v[80:83]
    ds_read_b64_tr_b16 v[228:229], v5 offset:49440
    v_mfma_f32_16x16x32_bf16 v[84:87], v[236:239], v[116:119], v[84:87]
    ds_read_b64_tr_b16 v[230:231], v5 offset:50464
    s_waitcnt vmcnt(23) lgkmcnt(6)
    v_mfma_f32_16x16x32_bf16 v[24:27], v[240:243], v[120:123], v[24:27]
    ds_read_b64_tr_b16 v[232:233], v4 offset:49664
    s_waitcnt vmcnt(22)
    v_mfma_f32_16x16x32_bf16 v[28:31], v[240:243], v[124:127], v[28:31]
    ds_read_b64_tr_b16 v[234:235], v4 offset:50688
    s_waitcnt lgkmcnt(6)
    v_mfma_f32_16x16x32_bf16 v[32:35], v[244:247], v[120:123], v[32:35]
    ds_read_b64_tr_b16 v[236:237], v5 offset:49696
    v_mfma_f32_16x16x32_bf16 v[36:39], v[244:247], v[124:127], v[36:39]
    ds_read_b64_tr_b16 v[238:239], v5 offset:50720
    s_waitcnt lgkmcnt(6)
    v_mfma_f32_16x16x32_bf16 v[40:43], v[224:227], v[120:123], v[40:43]
    ds_read_b64_tr_b16 v[240:241], v4 offset:49920
    v_mfma_f32_16x16x32_bf16 v[44:47], v[224:227], v[124:127], v[44:47]
    ds_read_b64_tr_b16 v[242:243], v4 offset:50944
    s_waitcnt lgkmcnt(6)
    v_mfma_f32_16x16x32_bf16 v[48:51], v[228:231], v[120:123], v[48:51]
    ds_read_b64_tr_b16 v[244:245], v5 offset:49952
    v_mfma_f32_16x16x32_bf16 v[52:55], v[228:231], v[124:127], v[52:55]
    ds_read_b64_tr_b16 v[246:247], v5 offset:50976
    s_waitcnt lgkmcnt(6)
    v_mfma_f32_16x16x32_bf16 v[56:59], v[232:235], v[120:123], v[56:59]
    v_mfma_f32_16x16x32_bf16 v[60:63], v[232:235], v[124:127], v[60:63]
    s_waitcnt vmcnt(20)
    s_barrier
    ds_read_b64_tr_b16 v[224:225], v7 offset:0
    ds_read_b64_tr_b16 v[226:227], v7 offset:1024
    s_waitcnt lgkmcnt(6)
    v_mfma_f32_16x16x32_bf16 v[64:67], v[236:239], v[120:123], v[64:67]
    ds_read_b64_tr_b16 v[228:229], v8 offset:32
    v_mfma_f32_16x16x32_bf16 v[68:71], v[236:239], v[124:127], v[68:71]
    ds_read_b64_tr_b16 v[230:231], v8 offset:1056
    s_waitcnt lgkmcnt(6)
    v_mfma_f32_16x16x32_bf16 v[72:75], v[240:243], v[120:123], v[72:75]
    ds_read_b64_tr_b16 v[232:233], v7 offset:256
    v_mfma_f32_16x16x32_bf16 v[76:79], v[240:243], v[124:127], v[76:79]
    ds_read_b64_tr_b16 v[234:235], v7 offset:1280
    s_waitcnt lgkmcnt(6)
    v_mfma_f32_16x16x32_bf16 v[80:83], v[244:247], v[120:123], v[80:83]
    ds_read_b64_tr_b16 v[236:237], v8 offset:288
    v_mfma_f32_16x16x32_bf16 v[84:87], v[244:247], v[124:127], v[84:87]
    ds_read_b64_tr_b16 v[238:239], v8 offset:1312
    s_waitcnt vmcnt(19) lgkmcnt(6)
    v_mfma_f32_16x16x32_bf16 v[24:27], v[224:227], v[88:91], v[24:27]
    ds_read_b64_tr_b16 v[240:241], v7 offset:512
    s_waitcnt vmcnt(18)
    v_mfma_f32_16x16x32_bf16 v[28:31], v[224:227], v[92:95], v[28:31]
    ds_read_b64_tr_b16 v[242:243], v7 offset:1536
    s_waitcnt lgkmcnt(6)
    v_mfma_f32_16x16x32_bf16 v[32:35], v[228:231], v[88:91], v[32:35]
    ds_read_b64_tr_b16 v[244:245], v8 offset:544
    v_mfma_f32_16x16x32_bf16 v[36:39], v[228:231], v[92:95], v[36:39]
    ds_read_b64_tr_b16 v[246:247], v8 offset:1568
    s_waitcnt lgkmcnt(6)
    v_mfma_f32_16x16x32_bf16 v[40:43], v[232:235], v[88:91], v[40:43]
    ds_read_b64_tr_b16 v[224:225], v7 offset:768
    v_mfma_f32_16x16x32_bf16 v[44:47], v[232:235], v[92:95], v[44:47]
    ds_read_b64_tr_b16 v[226:227], v7 offset:1792
    s_waitcnt lgkmcnt(6)
    v_mfma_f32_16x16x32_bf16 v[48:51], v[236:239], v[88:91], v[48:51]
    ds_read_b64_tr_b16 v[228:229], v8 offset:800
    v_mfma_f32_16x16x32_bf16 v[52:55], v[236:239], v[92:95], v[52:55]
    ds_read_b64_tr_b16 v[230:231], v8 offset:1824
    s_waitcnt lgkmcnt(6)
    v_mfma_f32_16x16x32_bf16 v[56:59], v[240:243], v[88:91], v[56:59]
    v_mfma_f32_16x16x32_bf16 v[60:63], v[240:243], v[92:95], v[60:63]
    s_waitcnt vmcnt(16)
    s_barrier
    ds_read_b64_tr_b16 v[232:233], v7 offset:16384
    ds_read_b64_tr_b16 v[234:235], v7 offset:17408
    s_waitcnt lgkmcnt(6)
    v_mfma_f32_16x16x32_bf16 v[64:67], v[244:247], v[88:91], v[64:67]
    ds_read_b64_tr_b16 v[236:237], v8 offset:16416
    v_mfma_f32_16x16x32_bf16 v[68:71], v[244:247], v[92:95], v[68:71]
    ds_read_b64_tr_b16 v[238:239], v8 offset:17440
    s_waitcnt lgkmcnt(6)
    v_mfma_f32_16x16x32_bf16 v[72:75], v[224:227], v[88:91], v[72:75]
    ds_read_b64_tr_b16 v[240:241], v7 offset:16640
    v_mfma_f32_16x16x32_bf16 v[76:79], v[224:227], v[92:95], v[76:79]
    ds_read_b64_tr_b16 v[242:243], v7 offset:17664
    s_waitcnt lgkmcnt(6)
    v_mfma_f32_16x16x32_bf16 v[80:83], v[228:231], v[88:91], v[80:83]
    ds_read_b64_tr_b16 v[244:245], v8 offset:16672
    v_mfma_f32_16x16x32_bf16 v[84:87], v[228:231], v[92:95], v[84:87]
    ds_read_b64_tr_b16 v[246:247], v8 offset:17696
    s_waitcnt vmcnt(15) lgkmcnt(6)
    v_mfma_f32_16x16x32_bf16 v[24:27], v[232:235], v[96:99], v[24:27]
    ds_read_b64_tr_b16 v[224:225], v7 offset:16896
    s_waitcnt vmcnt(10)
    v_mfma_f32_16x16x32_bf16 v[28:31], v[232:235], v[100:103], v[28:31]
    ds_read_b64_tr_b16 v[226:227], v7 offset:17920
    s_waitcnt lgkmcnt(6)
    v_mfma_f32_16x16x32_bf16 v[32:35], v[236:239], v[96:99], v[32:35]
    ds_read_b64_tr_b16 v[228:229], v8 offset:16928
    v_mfma_f32_16x16x32_bf16 v[36:39], v[236:239], v[100:103], v[36:39]
    ds_read_b64_tr_b16 v[230:231], v8 offset:17952
    s_waitcnt lgkmcnt(6)
    v_mfma_f32_16x16x32_bf16 v[40:43], v[240:243], v[96:99], v[40:43]
    ds_read_b64_tr_b16 v[232:233], v7 offset:17152
    v_mfma_f32_16x16x32_bf16 v[44:47], v[240:243], v[100:103], v[44:47]
    ds_read_b64_tr_b16 v[234:235], v7 offset:18176
    s_waitcnt lgkmcnt(6)
    v_mfma_f32_16x16x32_bf16 v[48:51], v[244:247], v[96:99], v[48:51]
    ds_read_b64_tr_b16 v[236:237], v8 offset:17184
    v_mfma_f32_16x16x32_bf16 v[52:55], v[244:247], v[100:103], v[52:55]
    ds_read_b64_tr_b16 v[238:239], v8 offset:18208
    s_waitcnt lgkmcnt(6)
    v_mfma_f32_16x16x32_bf16 v[56:59], v[224:227], v[96:99], v[56:59]
    v_mfma_f32_16x16x32_bf16 v[60:63], v[224:227], v[100:103], v[60:63]
    s_waitcnt lgkmcnt(4)
    v_mfma_f32_16x16x32_bf16 v[64:67], v[228:231], v[96:99], v[64:67]
    v_mfma_f32_16x16x32_bf16 v[68:71], v[228:231], v[100:103], v[68:71]
    s_waitcnt lgkmcnt(2)
    v_mfma_f32_16x16x32_bf16 v[72:75], v[232:235], v[96:99], v[72:75]
    v_mfma_f32_16x16x32_bf16 v[76:79], v[232:235], v[100:103], v[76:79]
    s_waitcnt lgkmcnt(0)
    v_mfma_f32_16x16x32_bf16 v[80:83], v[236:239], v[96:99], v[80:83]
    v_mfma_f32_16x16x32_bf16 v[84:87], v[236:239], v[100:103], v[84:87]
    s_lshl_b32 s16, s3, 13
    s_add_u32 s16, s16, 0x10000
    v_add_u32 v16, s16, v2
    s_xor_b32 s16, s16, 0x8000
    v_add_u32 v17, s16, v2
    ds_write_b128 v16, v[24:27] offset:0
    ds_write_b128 v16, v[28:31] offset:1024
    ds_write_b128 v16, v[32:35] offset:2048
    ds_write_b128 v16, v[36:39] offset:3072
    ds_write_b128 v16, v[40:43] offset:4096
    ds_write_b128 v16, v[44:47] offset:5120
    ds_write_b128 v16, v[48:51] offset:6144
    ds_write_b128 v16, v[52:55] offset:7168
    v_lshlrev_b32 v88, 16, v248
    v_and_b32 v89, 0xffff0000, v248
    v_lshlrev_b32 v90, 16, v249
    v_and_b32 v91, 0xffff0000, v249
    v_lshlrev_b32 v92, 16, v250
    v_and_b32 v93, 0xffff0000, v250
    v_lshlrev_b32 v94, 16, v251
    v_and_b32 v95, 0xffff0000, v251
    v_lshlrev_b32 v96, 16, v252
    v_and_b32 v97, 0xffff0000, v252
    v_lshlrev_b32 v98, 16, v253
    v_and_b32 v99, 0xffff0000, v253
    v_lshlrev_b32 v100, 16, v254
    v_and_b32 v101, 0xffff0000, v254
    v_lshlrev_b32 v102, 16, v255
    v_and_b32 v103, 0xffff0000, v255
    v_and_b32 v18, 15, v1
    v_lshlrev_b32 v18, 6, v18
    v_lshrrev_b32 v19, 4, v1
    v_and_b32 v20, 1, v19
    v_lshl_add_u32 v18, v20, 5, v18
    v_lshrrev_b32 v19, 1, v19
    v_lshl_add_u32 v18, v19, 4, v18
    s_and_b32 s17, s3, 3
    s_lshl_b32 s18, s30, 2
    s_add_u32 s18, s18, s17
    s_lshl_b32 s18, s18, 16
    s_lshl_b32 s19, s15, 22
    s_add_u32 s18, s18, s19
    s_lshl_b32 s19, s31, 12
    s_add_u32 s18, s18, s19
    s_add_u32 s18, s18, 0x2c00800
    s_add_u32 s19, s18, 32768
    s_waitcnt lgkmcnt(0)
    s_barrier
    ds_read_b128 v[104:107], v17 offset:0
    ds_read_b128 v[108:111], v17 offset:1024
    ds_read_b128 v[112:115], v17 offset:2048
    ds_read_b128 v[116:119], v17 offset:3072
    ds_read_b128 v[120:123], v17 offset:4096
    ds_read_b128 v[124:127], v17 offset:5120
    ds_read_b128 v[128:131], v17 offset:6144
    ds_read_b128 v[132:135], v17 offset:7168
    s_waitcnt lgkmcnt(7)
    v_pk_add_f32 v[56:57], v[56:57], v[104:105]
    v_pk_add_f32 v[58:59], v[58:59], v[106:107]
    v_pk_mul_f32 v[56:57], v[56:57], v[88:89]
    v_pk_mul_f32 v[58:59], v[58:59], v[90:91]
    v_cvt_pk_bf16_f32 v136, v56, v57
    v_cvt_pk_bf16_f32 v137, v58, v59
    s_waitcnt lgkmcnt(5)
    v_pk_add_f32 v[64:65], v[64:65], v[112:113]
    v_pk_add_f32 v[66:67], v[66:67], v[114:115]
    v_pk_mul_f32 v[64:65], v[64:65], v[92:93]
    v_pk_mul_f32 v[66:67], v[66:67], v[94:95]
    v_cvt_pk_bf16_f32 v138, v64, v65
    v_cvt_pk_bf16_f32 v139, v66, v67
    s_nop 0
    v_permlane16_swap_b32 v136, v138
    v_permlane16_swap_b32 v137, v139
    buffer_store_dwordx4 v[136:139], v18, s[8:11], s18 offen offset:0 sc1
    v_pk_add_f32 v[60:61], v[60:61], v[108:109]
    v_pk_add_f32 v[62:63], v[62:63], v[110:111]
    v_pk_mul_f32 v[60:61], v[60:61], v[88:89]
    v_pk_mul_f32 v[62:63], v[62:63], v[90:91]
    v_cvt_pk_bf16_f32 v140, v60, v61
    v_cvt_pk_bf16_f32 v141, v62, v63
    s_waitcnt lgkmcnt(4)
    v_pk_add_f32 v[68:69], v[68:69], v[116:117]
    v_pk_add_f32 v[70:71], v[70:71], v[118:119]
    v_pk_mul_f32 v[68:69], v[68:69], v[92:93]
    v_pk_mul_f32 v[70:71], v[70:71], v[94:95]
    v_cvt_pk_bf16_f32 v142, v68, v69
    v_cvt_pk_bf16_f32 v143, v70, v71
    s_nop 0
    v_permlane16_swap_b32 v140, v142
    v_permlane16_swap_b32 v141, v143
    buffer_store_dwordx4 v[140:143], v18, s[8:11], s19 offen offset:0 sc1
    s_waitcnt lgkmcnt(3)
    v_pk_add_f32 v[72:73], v[72:73], v[120:121]
    v_pk_add_f32 v[74:75], v[74:75], v[122:123]
    v_pk_mul_f32 v[72:73], v[72:73], v[96:97]
    v_pk_mul_f32 v[74:75], v[74:75], v[98:99]
    v_cvt_pk_bf16_f32 v144, v72, v73
    v_cvt_pk_bf16_f32 v145, v74, v75
    s_waitcnt lgkmcnt(1)
    v_pk_add_f32 v[80:81], v[80:81], v[128:129]
    v_pk_add_f32 v[82:83], v[82:83], v[130:131]
    v_pk_mul_f32 v[80:81], v[80:81], v[100:101]
    v_pk_mul_f32 v[82:83], v[82:83], v[102:103]
    v_cvt_pk_bf16_f32 v146, v80, v81
    v_cvt_pk_bf16_f32 v147, v82, v83
    s_nop 0
    v_permlane16_swap_b32 v144, v146
    v_permlane16_swap_b32 v145, v147
    buffer_store_dwordx4 v[144:147], v18, s[8:11], s18 offen offset:1024 sc1
    v_pk_add_f32 v[76:77], v[76:77], v[124:125]
    v_pk_add_f32 v[78:79], v[78:79], v[126:127]
    v_pk_mul_f32 v[76:77], v[76:77], v[96:97]
    v_pk_mul_f32 v[78:79], v[78:79], v[98:99]
    v_cvt_pk_bf16_f32 v148, v76, v77
    v_cvt_pk_bf16_f32 v149, v78, v79
    s_waitcnt lgkmcnt(0)
    v_pk_add_f32 v[84:85], v[84:85], v[132:133]
    v_pk_add_f32 v[86:87], v[86:87], v[134:135]
    v_pk_mul_f32 v[84:85], v[84:85], v[100:101]
    v_pk_mul_f32 v[86:87], v[86:87], v[102:103]
    v_cvt_pk_bf16_f32 v150, v84, v85
    v_cvt_pk_bf16_f32 v151, v86, v87
    s_nop 0
    v_permlane16_swap_b32 v148, v150
    v_permlane16_swap_b32 v149, v151
    buffer_store_dwordx4 v[148:151], v18, s[8:11], s19 offen offset:1024 sc1
    v_mov_b32 v94, 0
    s_waitcnt vmcnt(9)
    v_lshlrev_b32 v76, 16, v192
    v_and_b32 v77, 0xffff0000, v192
    s_waitcnt vmcnt(5)
    v_lshlrev_b32 v78, 16, v208
    v_and_b32 v79, 0xffff0000, v208
    v_pk_mul_f32 v[60:61], v[76:77], v[78:79]
    v_lshlrev_b32 v76, 16, v184
    v_and_b32 v77, 0xffff0000, v184
    v_fmac_f32 v94, v76, v78
    v_fmac_f32 v94, v77, v79
    v_lshlrev_b32 v76, 16, v193
    v_and_b32 v77, 0xffff0000, v193
    v_lshlrev_b32 v78, 16, v209
    v_and_b32 v79, 0xffff0000, v209
    v_pk_mul_f32 v[62:63], v[76:77], v[78:79]
    v_lshlrev_b32 v76, 16, v185
    v_and_b32 v77, 0xffff0000, v185
    v_fmac_f32 v94, v76, v78
    v_fmac_f32 v94, v77, v79
    v_lshlrev_b32 v76, 16, v194
    v_and_b32 v77, 0xffff0000, v194
    v_lshlrev_b32 v78, 16, v210
    v_and_b32 v79, 0xffff0000, v210
    v_pk_mul_f32 v[64:65], v[76:77], v[78:79]
    v_lshlrev_b32 v76, 16, v186
    v_and_b32 v77, 0xffff0000, v186
    v_fmac_f32 v94, v76, v78
    v_fmac_f32 v94, v77, v79
    v_lshlrev_b32 v76, 16, v195
    v_and_b32 v77, 0xffff0000, v195
    v_lshlrev_b32 v78, 16, v211
    v_and_b32 v79, 0xffff0000, v211
    v_pk_mul_f32 v[66:67], v[76:77], v[78:79]
    v_lshlrev_b32 v76, 16, v187
    v_and_b32 v77, 0xffff0000, v187
    v_fmac_f32 v94, v76, v78
    v_fmac_f32 v94, v77, v79
    v_lshlrev_b32 v76, 16, v196
    v_and_b32 v77, 0xffff0000, v196
    s_waitcnt vmcnt(4)
    v_lshlrev_b32 v78, 16, v212
    v_and_b32 v79, 0xffff0000, v212
    v_pk_mul_f32 v[68:69], v[76:77], v[78:79]
    v_lshlrev_b32 v76, 16, v188
    v_and_b32 v77, 0xffff0000, v188
    v_fmac_f32 v94, v76, v78
    v_fmac_f32 v94, v77, v79
    v_lshlrev_b32 v76, 16, v197
    v_and_b32 v77, 0xffff0000, v197
    v_lshlrev_b32 v78, 16, v213
    v_and_b32 v79, 0xffff0000, v213
    v_pk_mul_f32 v[70:71], v[76:77], v[78:79]
    v_lshlrev_b32 v76, 16, v189
    v_and_b32 v77, 0xffff0000, v189
    v_fmac_f32 v94, v76, v78
    v_fmac_f32 v94, v77, v79
    v_lshlrev_b32 v76, 16, v198
    v_and_b32 v77, 0xffff0000, v198
    v_lshlrev_b32 v78, 16, v214
    v_and_b32 v79, 0xffff0000, v214
    v_pk_mul_f32 v[72:73], v[76:77], v[78:79]
    v_lshlrev_b32 v76, 16, v190
    v_and_b32 v77, 0xffff0000, v190
    v_fmac_f32 v94, v76, v78
    v_fmac_f32 v94, v77, v79
    v_lshlrev_b32 v76, 16, v199
    v_and_b32 v77, 0xffff0000, v199
    v_lshlrev_b32 v78, 16, v215
    v_and_b32 v79, 0xffff0000, v215
    v_pk_mul_f32 v[74:75], v[76:77], v[78:79]
    v_lshlrev_b32 v76, 16, v191
    v_and_b32 v77, 0xffff0000, v191
    v_fmac_f32 v94, v76, v78
    v_fmac_f32 v94, v77, v79
    s_nop 1
    v_add_f32_dpp v94, v94, v94 row_ror:1 row_mask:0xf bank_mask:0xf
    s_nop 1
    v_add_f32_dpp v94, v94, v94 row_ror:2 row_mask:0xf bank_mask:0xf
    s_nop 1
    v_add_f32_dpp v94, v94, v94 row_ror:4 row_mask:0xf bank_mask:0xf
    s_nop 1
    v_add_f32_dpp v94, v94, v94 row_ror:8 row_mask:0xf bank_mask:0xf
    v_mov_b32 v76, v94
    s_nop 1
    v_permlane16_swap_b32 v94, v76
    v_add_f32 v94, v94, v76
    v_mov_b32 v76, v94
    s_nop 1
    v_permlane32_swap_b32 v94, v76
    v_add_f32 v94, v94, v76
    v_lshlrev_b32 v28, 16, v216
    v_and_b32 v29, 0xffff0000, v216
    v_lshlrev_b32 v30, 16, v217
    v_and_b32 v31, 0xffff0000, v217
    v_lshlrev_b32 v32, 16, v218
    v_and_b32 v33, 0xffff0000, v218
    v_lshlrev_b32 v34, 16, v219
    v_and_b32 v35, 0xffff0000, v219
    v_lshlrev_b32 v36, 16, v220
    v_and_b32 v37, 0xffff0000, v220
    v_lshlrev_b32 v38, 16, v221
    v_and_b32 v39, 0xffff0000, v221
    v_lshlrev_b32 v40, 16, v222
    v_and_b32 v41, 0xffff0000, v222
    v_lshlrev_b32 v42, 16, v223
    v_and_b32 v43, 0xffff0000, v223
    s_and_b32 s17, s3, 3
    s_lshl_b32 s16, s30, 2
    s_add_u32 s16, s16, s17
    s_lshl_b32 s16, s16, 5
    s_lshl_b32 s17, s31, 2
    s_add_u32 s16, s16, s17
    s_lshl_b32 s17, s15, 1
    s_add_u32 s16, s16, s17
    s_add_u32 s16, s16, 1
    s_lshl_b32 s16, s16, 2
    s_add_u32 s16, s16, 0x530000
    v_mov_b32 v16, s28
    v_mov_b32 v17, 0
    s_lshr_b32 s18, s14, 4
    s_lshl_b32 s18, s18, 15
    s_and_b32 s19, s14, 15
    s_lshl_b32 s19, s19, 6
    s_add_u32 s18, s18, s19
    s_add_u32 s18, s18, 0x2c00000
    s_add_u32 s19, s18, 16384
    v_lshrrev_b32 v18, 2, v1
    v_lshlrev_b32 v18, 10, v18
    v_and_b32 v19, 3, v1
    v_lshl_add_u32 v18, v19, 4, v18
    v_add_u32 v19, 0x400000, v18
    s_lshr_b32 s25, s14, 5
    s_lshl_b32 s25, s25, 7
    s_add_u32 s25, s25, 0x530000
    v_and_b32 v20, 31, v1
    v_lshlrev_b32 v20, 2, v20
    s_waitcnt vmcnt(0)
    s_mov_b64 exec, 1
    buffer_store_dword v16, v17, s[8:11], s16 offen sc1
    s_mov_b64 exec, -1
    s_sleep 32
    s_mov_b32 s27, 0
adaLN_cond__sliding_block_cached__moe_arch_mod__prompt_kernel_a22p:
    buffer_load_dword v76, v20, s[8:11], s25 offen sc1
    s_waitcnt vmcnt(0)
    v_cmp_ne_u32 vcc, s28, v76
    s_add_u32 s27, s27, 1
    s_cmp_ge_u32 s27, 262144
    s_cbranch_scc1 adaLN_cond__sliding_block_cached__moe_arch_mod__prompt_kernel_a22g
    s_cbranch_vccnz adaLN_cond__sliding_block_cached__moe_arch_mod__prompt_kernel_a22p
adaLN_cond__sliding_block_cached__moe_arch_mod__prompt_kernel_a22g:
    buffer_load_dwordx4 v[44:47], v18, s[8:11], s18 offen sc1
    buffer_load_dwordx4 v[52:55], v19, s[8:11], s18 offen sc1
    buffer_load_dwordx4 v[48:51], v18, s[8:11], s19 offen sc1
    buffer_load_dwordx4 v[56:59], v19, s[8:11], s19 offen sc1
    v_lshlrev_b32 v21, 2, v0
    s_mov_b32 s16, 0x540800
    buffer_load_dword v106, v21, s[8:11], s16 offen sc1
    buffer_load_dword v104, v21, s[8:11], s16 offen offset:2048 sc1
    s_waitcnt vmcnt(5)
    v_lshlrev_b32 v76, 16, v44
    v_and_b32 v77, 0xffff0000, v44
    s_waitcnt vmcnt(4)
    v_lshlrev_b32 v78, 16, v52
    v_and_b32 v79, 0xffff0000, v52
    v_pk_add_f32 v[76:77], v[76:77], v[78:79]
    v_pk_add_f32 v[28:29], v[28:29], v[76:77]
    v_cvt_pk_bf16_f32 v16, v28, v29
    v_lshlrev_b32 v28, 16, v16
    v_and_b32 v29, 0xffff0000, v16
    v_lshlrev_b32 v80, 16, v45
    v_and_b32 v81, 0xffff0000, v45
    v_lshlrev_b32 v82, 16, v53
    v_and_b32 v83, 0xffff0000, v53
    v_pk_add_f32 v[80:81], v[80:81], v[82:83]
    v_pk_add_f32 v[30:31], v[30:31], v[80:81]
    v_cvt_pk_bf16_f32 v17, v30, v31
    v_lshlrev_b32 v30, 16, v17
    v_and_b32 v31, 0xffff0000, v17
    v_lshlrev_b32 v76, 16, v46
    v_and_b32 v77, 0xffff0000, v46
    v_lshlrev_b32 v78, 16, v54
    v_and_b32 v79, 0xffff0000, v54
    v_pk_add_f32 v[76:77], v[76:77], v[78:79]
    v_pk_add_f32 v[32:33], v[32:33], v[76:77]
    v_cvt_pk_bf16_f32 v16, v32, v33
    v_lshlrev_b32 v32, 16, v16
    v_and_b32 v33, 0xffff0000, v16
    v_lshlrev_b32 v80, 16, v47
    v_and_b32 v81, 0xffff0000, v47
    v_lshlrev_b32 v82, 16, v55
    v_and_b32 v83, 0xffff0000, v55
    v_pk_add_f32 v[80:81], v[80:81], v[82:83]
    v_pk_add_f32 v[34:35], v[34:35], v[80:81]
    v_cvt_pk_bf16_f32 v17, v34, v35
    v_lshlrev_b32 v34, 16, v17
    v_and_b32 v35, 0xffff0000, v17
    s_waitcnt vmcnt(3)
    v_lshlrev_b32 v76, 16, v48
    v_and_b32 v77, 0xffff0000, v48
    s_waitcnt vmcnt(2)
    v_lshlrev_b32 v78, 16, v56
    v_and_b32 v79, 0xffff0000, v56
    v_pk_add_f32 v[76:77], v[76:77], v[78:79]
    v_pk_add_f32 v[36:37], v[36:37], v[76:77]
    v_cvt_pk_bf16_f32 v16, v36, v37
    v_lshlrev_b32 v36, 16, v16
    v_and_b32 v37, 0xffff0000, v16
    v_lshlrev_b32 v80, 16, v49
    v_and_b32 v81, 0xffff0000, v49
    v_lshlrev_b32 v82, 16, v57
    v_and_b32 v83, 0xffff0000, v57
    v_pk_add_f32 v[80:81], v[80:81], v[82:83]
    v_pk_add_f32 v[38:39], v[38:39], v[80:81]
    v_cvt_pk_bf16_f32 v17, v38, v39
    v_lshlrev_b32 v38, 16, v17
    v_and_b32 v39, 0xffff0000, v17
    v_lshlrev_b32 v76, 16, v50
    v_and_b32 v77, 0xffff0000, v50
    v_lshlrev_b32 v78, 16, v58
    v_and_b32 v79, 0xffff0000, v58
    v_pk_add_f32 v[76:77], v[76:77], v[78:79]
    v_pk_add_f32 v[40:41], v[40:41], v[76:77]
    v_cvt_pk_bf16_f32 v16, v40, v41
    v_lshlrev_b32 v40, 16, v16
    v_and_b32 v41, 0xffff0000, v16
    v_lshlrev_b32 v80, 16, v51
    v_and_b32 v81, 0xffff0000, v51
    v_lshlrev_b32 v82, 16, v59
    v_and_b32 v83, 0xffff0000, v59
    v_pk_add_f32 v[80:81], v[80:81], v[82:83]
    v_pk_add_f32 v[42:43], v[42:43], v[80:81]
    v_cvt_pk_bf16_f32 v17, v42, v43
    v_lshlrev_b32 v42, 16, v17
    v_and_b32 v43, 0xffff0000, v17
    v_pk_add_f32 v[76:77], v[28:29], v[30:31]
    v_pk_add_f32 v[78:79], v[32:33], v[34:35]
    v_pk_add_f32 v[76:77], v[76:77], v[36:37]
    v_pk_add_f32 v[78:79], v[78:79], v[38:39]
    v_pk_add_f32 v[76:77], v[76:77], v[40:41]
    v_pk_add_f32 v[78:79], v[78:79], v[42:43]
    v_pk_add_f32 v[76:77], v[76:77], v[78:79]
    v_add_f32 v96, v76, v77
    s_nop 1
    v_add_f32_dpp v96, v96, v96 row_ror:1 row_mask:0xf bank_mask:0xf
    s_nop 1
    v_add_f32_dpp v96, v96, v96 row_ror:2 row_mask:0xf bank_mask:0xf
    s_nop 1
    v_add_f32_dpp v96, v96, v96 row_ror:4 row_mask:0xf bank_mask:0xf
    s_nop 1
    v_add_f32_dpp v96, v96, v96 row_ror:8 row_mask:0xf bank_mask:0xf
    v_mov_b32 v76, v96
    s_nop 1
    v_permlane16_swap_b32 v96, v76
    v_add_f32 v96, v96, v76
    v_mov_b32 v76, v96
    s_nop 1
    v_permlane32_swap_b32 v96, v76
    v_add_f32 v96, v96, v76
    v_mul_f32 v96, 0x3a800000, v96
    v_sub_f32 v44, v28, v96
    v_sub_f32 v45, v29, v96
    v_sub_f32 v46, v30, v96
    v_sub_f32 v47, v31, v96
    v_sub_f32 v48, v32, v96
    v_sub_f32 v49, v33, v96
    v_sub_f32 v50, v34, v96
    v_sub_f32 v51, v35, v96
    v_sub_f32 v52, v36, v96
    v_sub_f32 v53, v37, v96
    v_sub_f32 v54, v38, v96
    v_sub_f32 v55, v39, v96
    v_sub_f32 v56, v40, v96
    v_sub_f32 v57, v41, v96
    v_sub_f32 v58, v42, v96
    v_sub_f32 v59, v43, v96
    v_pk_mul_f32 v[76:77], v[44:45], v[44:45]
    v_pk_mul_f32 v[78:79], v[44:45], v[60:61]
    v_pk_fma_f32 v[76:77], v[46:47], v[46:47], v[76:77]
    v_pk_fma_f32 v[78:79], v[46:47], v[62:63], v[78:79]
    v_pk_fma_f32 v[76:77], v[48:49], v[48:49], v[76:77]
    v_pk_fma_f32 v[78:79], v[48:49], v[64:65], v[78:79]
    v_pk_fma_f32 v[76:77], v[50:51], v[50:51], v[76:77]
    v_pk_fma_f32 v[78:79], v[50:51], v[66:67], v[78:79]
    v_pk_fma_f32 v[76:77], v[52:53], v[52:53], v[76:77]
    v_pk_fma_f32 v[78:79], v[52:53], v[68:69], v[78:79]
    v_pk_fma_f32 v[76:77], v[54:55], v[54:55], v[76:77]
    v_pk_fma_f32 v[78:79], v[54:55], v[70:71], v[78:79]
    v_pk_fma_f32 v[76:77], v[56:57], v[56:57], v[76:77]
    v_pk_fma_f32 v[78:79], v[56:57], v[72:73], v[78:79]
    v_pk_fma_f32 v[76:77], v[58:59], v[58:59], v[76:77]
    v_pk_fma_f32 v[78:79], v[58:59], v[74:75], v[78:79]
    v_add_f32 v97, v76, v77
    v_add_f32 v98, v78, v79
    s_nop 0
    v_add_f32_dpp v97, v97, v97 row_ror:1 row_mask:0xf bank_mask:0xf
    v_add_f32_dpp v98, v98, v98 row_ror:1 row_mask:0xf bank_mask:0xf
    s_nop 0
    v_add_f32_dpp v97, v97, v97 row_ror:2 row_mask:0xf bank_mask:0xf
    v_add_f32_dpp v98, v98, v98 row_ror:2 row_mask:0xf bank_mask:0xf
    s_nop 0
    v_add_f32_dpp v97, v97, v97 row_ror:4 row_mask:0xf bank_mask:0xf
    v_add_f32_dpp v98, v98, v98 row_ror:4 row_mask:0xf bank_mask:0xf
    s_nop 0
    v_add_f32_dpp v97, v97, v97 row_ror:8 row_mask:0xf bank_mask:0xf
    v_add_f32_dpp v98, v98, v98 row_ror:8 row_mask:0xf bank_mask:0xf
    v_mov_b32 v76, v97
    s_nop 1
    v_permlane16_swap_b32 v97, v76
    v_add_f32 v97, v97, v76
    v_mov_b32 v77, v98
    s_nop 1
    v_permlane16_swap_b32 v98, v77
    v_add_f32 v98, v98, v77
    v_mov_b32 v76, v97
    s_nop 1
    v_permlane32_swap_b32 v97, v76
    v_add_f32 v97, v97, v76
    v_mov_b32 v77, v98
    s_nop 1
    v_permlane32_swap_b32 v98, v77
    v_add_f32 v98, v98, v77
    v_mul_f32 v97, 0x3a800000, v97
    v_add_f32 v76, 0x3727c5ac, v97
    v_rsq_f32 v76, v76
    s_nop 0
    v_fma_f32 v27, v98, v76, v94
    v_cvt_pk_bf16_f32 v96, v96, v96
    v_lshlrev_b32 v96, 16, v96
    v_cvt_pk_bf16_f32 v97, v97, v97
    v_lshlrev_b32 v97, 16, v97
    v_add_f32 v97, 0x3727c5ac, v97
    v_cvt_pk_bf16_f32 v97, v97, v97
    v_lshlrev_b32 v97, 16, v97
    v_sqrt_f32 v98, v97
    s_nop 0
    v_cvt_pk_bf16_f32 v98, v98, v98
    v_lshlrev_b32 v98, 16, v98
    v_rcp_f32 v99, v98
    v_mov_b32 v25, v96
    v_mov_b32 v26, v98
    v_ashrrev_i32 v16, 31, v27
    v_or_b32 v16, 0x80000000, v16
    v_xor_b32 v24, v27, v16
    v_and_b32 v24, 0xfffff800, v24
    v_max_u32 v24, 0x800, v24
    s_sub_u32 s16, 2047, s14
    v_or_b32 v24, s16, v24
    s_lshl_b32 s16, s3, 4
    s_add_u32 s16, s16, 65536
    v_mov_b32 v16, s16
    ds_write_b128 v16, v[24:27]
    s_waitcnt lgkmcnt(0)
    s_barrier
    v_and_b32 v16, 7, v1
    v_lshlrev_b32 v16, 4, v16
    v_add_u32 v16, 65536, v16
    ds_read_b32 v76, v16
    s_waitcnt lgkmcnt(0)
    v_mov_b32 v77, v76
    s_nop 1
    v_max_u32_dpp v77, v77, v77 row_ror:1 row_mask:0xf bank_mask:0xf
    s_nop 1
    v_max_u32_dpp v77, v77, v77 row_ror:2 row_mask:0xf bank_mask:0xf
    s_nop 1
    v_max_u32_dpp v77, v77, v77 row_ror:4 row_mask:0xf bank_mask:0xf
    v_cmp_eq_u32 vcc, v76, v77
    s_ff1_i32_b64 s16, vcc
    s_lshl_b32 s16, s16, 4
    s_add_u32 s16, s16, 65536
    v_mov_b32 v16, s16
    ds_read_b128 v[24:27], v16
    s_lshl_b32 s16, s2, 4
    s_add_u32 s16, s16, 0x6e0000
    s_cmp_eq_u32 s3, 0
    s_cselect_b32 s16, s16, 0x7ffffff0
    v_mov_b32 v17, 0
    s_mov_b64 exec, 1
    s_waitcnt lgkmcnt(0)
    buffer_store_dwordx4 v[24:27], v17, s[8:11], s16 offen sc1
    s_mov_b64 exec, -1
    v_sub_f32 v44, v28, v96
    v_sub_f32 v45, v29, v96
    v_sub_f32 v46, v30, v96
    v_sub_f32 v47, v31, v96
    v_sub_f32 v48, v32, v96
    v_sub_f32 v49, v33, v96
    v_sub_f32 v50, v34, v96
    v_sub_f32 v51, v35, v96
    v_cvt_pk_bf16_f32 v16, v44, v45
    v_lshlrev_b32 v44, 16, v16
    v_and_b32 v45, 0xffff0000, v16
    v_cvt_pk_bf16_f32 v16, v46, v47
    v_lshlrev_b32 v46, 16, v16
    v_and_b32 v47, 0xffff0000, v16
    v_cvt_pk_bf16_f32 v16, v48, v49
    v_lshlrev_b32 v48, 16, v16
    v_and_b32 v49, 0xffff0000, v16
    v_cvt_pk_bf16_f32 v16, v50, v51
    v_lshlrev_b32 v50, 16, v16
    v_and_b32 v51, 0xffff0000, v16
    v_mul_f32 v52, v44, v99
    v_mul_f32 v53, v45, v99
    v_mul_f32 v54, v46, v99
    v_mul_f32 v55, v47, v99
    v_mul_f32 v56, v48, v99
    v_mul_f32 v57, v49, v99
    v_mul_f32 v58, v50, v99
    v_mul_f32 v59, v51, v99
    v_fma_f32 v44, -v52, v98, v44
    v_fma_f32 v45, -v53, v98, v45
    v_fma_f32 v46, -v54, v98, v46
    v_fma_f32 v47, -v55, v98, v47
    v_fma_f32 v48, -v56, v98, v48
    v_fma_f32 v49, -v57, v98, v49
    v_fma_f32 v50, -v58, v98, v50
    v_fma_f32 v51, -v59, v98, v51
    v_fma_f32 v44, v44, v99, v52
    v_fma_f32 v45, v45, v99, v53
    v_fma_f32 v46, v46, v99, v54
    v_fma_f32 v47, v47, v99, v55
    v_fma_f32 v48, v48, v99, v56
    v_fma_f32 v49, v49, v99, v57
    v_fma_f32 v50, v50, v99, v58
    v_fma_f32 v51, v51, v99, v59
    v_cvt_pk_bf16_f32 v16, v44, v45
    v_lshlrev_b32 v44, 16, v16
    v_and_b32 v45, 0xffff0000, v16
    v_cvt_pk_bf16_f32 v16, v46, v47
    v_lshlrev_b32 v46, 16, v16
    v_and_b32 v47, 0xffff0000, v16
    v_cvt_pk_bf16_f32 v16, v48, v49
    v_lshlrev_b32 v48, 16, v16
    v_and_b32 v49, 0xffff0000, v16
    v_cvt_pk_bf16_f32 v16, v50, v51
    v_lshlrev_b32 v50, 16, v16
    v_and_b32 v51, 0xffff0000, v16
    v_lshlrev_b32 v52, 16, v192
    v_and_b32 v53, 0xffff0000, v192
    v_lshlrev_b32 v54, 16, v193
    v_and_b32 v55, 0xffff0000, v193
    v_lshlrev_b32 v56, 16, v194
    v_and_b32 v57, 0xffff0000, v194
    v_lshlrev_b32 v58, 16, v195
    v_and_b32 v59, 0xffff0000, v195
    v_pk_mul_f32 v[44:45], v[44:45], v[52:53]
    v_pk_mul_f32 v[46:47], v[46:47], v[54:55]
    v_pk_mul_f32 v[48:49], v[48:49], v[56:57]
    v_pk_mul_f32 v[50:51], v[50:51], v[58:59]
    v_cvt_pk_bf16_f32 v16, v44, v45
    v_lshlrev_b32 v44, 16, v16
    v_and_b32 v45, 0xffff0000, v16
    v_cvt_pk_bf16_f32 v16, v46, v47
    v_lshlrev_b32 v46, 16, v16
    v_and_b32 v47, 0xffff0000, v16
    v_cvt_pk_bf16_f32 v16, v48, v49
    v_lshlrev_b32 v48, 16, v16
    v_and_b32 v49, 0xffff0000, v16
    v_cvt_pk_bf16_f32 v16, v50, v51
    v_lshlrev_b32 v50, 16, v16
    v_and_b32 v51, 0xffff0000, v16
    v_lshlrev_b32 v52, 16, v184
    v_and_b32 v53, 0xffff0000, v184
    v_lshlrev_b32 v54, 16, v185
    v_and_b32 v55, 0xffff0000, v185
    v_lshlrev_b32 v56, 16, v186
    v_and_b32 v57, 0xffff0000, v186
    v_lshlrev_b32 v58, 16, v187
    v_and_b32 v59, 0xffff0000, v187
    v_pk_add_f32 v[44:45], v[44:45], v[52:53]
    v_pk_add_f32 v[46:47], v[46:47], v[54:55]
    v_pk_add_f32 v[48:49], v[48:49], v[56:57]
    v_pk_add_f32 v[50:51], v[50:51], v[58:59]
    v_cvt_pk_bf16_f32 v16, v44, v45
    v_lshlrev_b32 v44, 16, v16
    v_and_b32 v45, 0xffff0000, v16
    v_cvt_pk_bf16_f32 v16, v46, v47
    v_lshlrev_b32 v46, 16, v16
    v_and_b32 v47, 0xffff0000, v16
    v_cvt_pk_bf16_f32 v16, v48, v49
    v_lshlrev_b32 v48, 16, v16
    v_and_b32 v49, 0xffff0000, v16
    v_cvt_pk_bf16_f32 v16, v50, v51
    v_lshlrev_b32 v50, 16, v16
    v_and_b32 v51, 0xffff0000, v16
    v_lshlrev_b32 v52, 16, v200
    v_and_b32 v53, 0xffff0000, v200
    v_lshlrev_b32 v54, 16, v201
    v_and_b32 v55, 0xffff0000, v201
    v_lshlrev_b32 v56, 16, v202
    v_and_b32 v57, 0xffff0000, v202
    v_lshlrev_b32 v58, 16, v203
    v_and_b32 v59, 0xffff0000, v203
    v_pk_mul_f32 v[44:45], v[44:45], v[52:53]
    v_pk_mul_f32 v[46:47], v[46:47], v[54:55]
    v_pk_mul_f32 v[48:49], v[48:49], v[56:57]
    v_pk_mul_f32 v[50:51], v[50:51], v[58:59]
    v_cvt_pk_bf16_f32 v16, v44, v45
    v_lshlrev_b32 v44, 16, v16
    v_and_b32 v45, 0xffff0000, v16
    v_cvt_pk_bf16_f32 v16, v46, v47
    v_lshlrev_b32 v46, 16, v16
    v_and_b32 v47, 0xffff0000, v16
    v_cvt_pk_bf16_f32 v16, v48, v49
    v_lshlrev_b32 v48, 16, v16
    v_and_b32 v49, 0xffff0000, v16
    v_cvt_pk_bf16_f32 v16, v50, v51
    v_lshlrev_b32 v50, 16, v16
    v_and_b32 v51, 0xffff0000, v16
    v_pk_add_f32 v[44:45], v[44:45], v[28:29]
    v_pk_add_f32 v[46:47], v[46:47], v[30:31]
    v_pk_add_f32 v[48:49], v[48:49], v[32:33]
    v_pk_add_f32 v[50:51], v[50:51], v[34:35]
    v_cvt_pk_bf16_f32 v28, v44, v45
    v_cvt_pk_bf16_f32 v29, v46, v47
    v_cvt_pk_bf16_f32 v30, v48, v49
    v_cvt_pk_bf16_f32 v31, v50, v51
    v_sub_f32 v44, v36, v96
    v_sub_f32 v45, v37, v96
    v_sub_f32 v46, v38, v96
    v_sub_f32 v47, v39, v96
    v_sub_f32 v48, v40, v96
    v_sub_f32 v49, v41, v96
    v_sub_f32 v50, v42, v96
    v_sub_f32 v51, v43, v96
    v_cvt_pk_bf16_f32 v16, v44, v45
    v_lshlrev_b32 v44, 16, v16
    v_and_b32 v45, 0xffff0000, v16
    v_cvt_pk_bf16_f32 v16, v46, v47
    v_lshlrev_b32 v46, 16, v16
    v_and_b32 v47, 0xffff0000, v16
    v_cvt_pk_bf16_f32 v16, v48, v49
    v_lshlrev_b32 v48, 16, v16
    v_and_b32 v49, 0xffff0000, v16
    v_cvt_pk_bf16_f32 v16, v50, v51
    v_lshlrev_b32 v50, 16, v16
    v_and_b32 v51, 0xffff0000, v16
    v_mul_f32 v52, v44, v99
    v_mul_f32 v53, v45, v99
    v_mul_f32 v54, v46, v99
    v_mul_f32 v55, v47, v99
    v_mul_f32 v56, v48, v99
    v_mul_f32 v57, v49, v99
    v_mul_f32 v58, v50, v99
    v_mul_f32 v59, v51, v99
    v_fma_f32 v44, -v52, v98, v44
    v_fma_f32 v45, -v53, v98, v45
    v_fma_f32 v46, -v54, v98, v46
    v_fma_f32 v47, -v55, v98, v47
    v_fma_f32 v48, -v56, v98, v48
    v_fma_f32 v49, -v57, v98, v49
    v_fma_f32 v50, -v58, v98, v50
    v_fma_f32 v51, -v59, v98, v51
    v_fma_f32 v44, v44, v99, v52
    v_fma_f32 v45, v45, v99, v53
    v_fma_f32 v46, v46, v99, v54
    v_fma_f32 v47, v47, v99, v55
    v_fma_f32 v48, v48, v99, v56
    v_fma_f32 v49, v49, v99, v57
    v_fma_f32 v50, v50, v99, v58
    v_fma_f32 v51, v51, v99, v59
    v_cvt_pk_bf16_f32 v16, v44, v45
    v_lshlrev_b32 v44, 16, v16
    v_and_b32 v45, 0xffff0000, v16
    v_cvt_pk_bf16_f32 v16, v46, v47
    v_lshlrev_b32 v46, 16, v16
    v_and_b32 v47, 0xffff0000, v16
    v_cvt_pk_bf16_f32 v16, v48, v49
    v_lshlrev_b32 v48, 16, v16
    v_and_b32 v49, 0xffff0000, v16
    v_cvt_pk_bf16_f32 v16, v50, v51
    v_lshlrev_b32 v50, 16, v16
    v_and_b32 v51, 0xffff0000, v16
    v_lshlrev_b32 v52, 16, v196
    v_and_b32 v53, 0xffff0000, v196
    v_lshlrev_b32 v54, 16, v197
    v_and_b32 v55, 0xffff0000, v197
    v_lshlrev_b32 v56, 16, v198
    v_and_b32 v57, 0xffff0000, v198
    v_lshlrev_b32 v58, 16, v199
    v_and_b32 v59, 0xffff0000, v199
    v_pk_mul_f32 v[44:45], v[44:45], v[52:53]
    v_pk_mul_f32 v[46:47], v[46:47], v[54:55]
    v_pk_mul_f32 v[48:49], v[48:49], v[56:57]
    v_pk_mul_f32 v[50:51], v[50:51], v[58:59]
    v_cvt_pk_bf16_f32 v16, v44, v45
    v_lshlrev_b32 v44, 16, v16
    v_and_b32 v45, 0xffff0000, v16
    v_cvt_pk_bf16_f32 v16, v46, v47
    v_lshlrev_b32 v46, 16, v16
    v_and_b32 v47, 0xffff0000, v16
    v_cvt_pk_bf16_f32 v16, v48, v49
    v_lshlrev_b32 v48, 16, v16
    v_and_b32 v49, 0xffff0000, v16
    v_cvt_pk_bf16_f32 v16, v50, v51
    v_lshlrev_b32 v50, 16, v16
    v_and_b32 v51, 0xffff0000, v16
    v_lshlrev_b32 v52, 16, v188
    v_and_b32 v53, 0xffff0000, v188
    v_lshlrev_b32 v54, 16, v189
    v_and_b32 v55, 0xffff0000, v189
    v_lshlrev_b32 v56, 16, v190
    v_and_b32 v57, 0xffff0000, v190
    v_lshlrev_b32 v58, 16, v191
    v_and_b32 v59, 0xffff0000, v191
    v_pk_add_f32 v[44:45], v[44:45], v[52:53]
    v_pk_add_f32 v[46:47], v[46:47], v[54:55]
    v_pk_add_f32 v[48:49], v[48:49], v[56:57]
    v_pk_add_f32 v[50:51], v[50:51], v[58:59]
    v_cvt_pk_bf16_f32 v16, v44, v45
    v_lshlrev_b32 v44, 16, v16
    v_and_b32 v45, 0xffff0000, v16
    v_cvt_pk_bf16_f32 v16, v46, v47
    v_lshlrev_b32 v46, 16, v16
    v_and_b32 v47, 0xffff0000, v16
    v_cvt_pk_bf16_f32 v16, v48, v49
    v_lshlrev_b32 v48, 16, v16
    v_and_b32 v49, 0xffff0000, v16
    v_cvt_pk_bf16_f32 v16, v50, v51
    v_lshlrev_b32 v50, 16, v16
    v_and_b32 v51, 0xffff0000, v16
    v_lshlrev_b32 v52, 16, v204
    v_and_b32 v53, 0xffff0000, v204
    v_lshlrev_b32 v54, 16, v205
    v_and_b32 v55, 0xffff0000, v205
    v_lshlrev_b32 v56, 16, v206
    v_and_b32 v57, 0xffff0000, v206
    v_lshlrev_b32 v58, 16, v207
    v_and_b32 v59, 0xffff0000, v207
    v_pk_mul_f32 v[44:45], v[44:45], v[52:53]
    v_pk_mul_f32 v[46:47], v[46:47], v[54:55]
    v_pk_mul_f32 v[48:49], v[48:49], v[56:57]
    v_pk_mul_f32 v[50:51], v[50:51], v[58:59]
    v_cvt_pk_bf16_f32 v16, v44, v45
    v_lshlrev_b32 v44, 16, v16
    v_and_b32 v45, 0xffff0000, v16
    v_cvt_pk_bf16_f32 v16, v46, v47
    v_lshlrev_b32 v46, 16, v16
    v_and_b32 v47, 0xffff0000, v16
    v_cvt_pk_bf16_f32 v16, v48, v49
    v_lshlrev_b32 v48, 16, v16
    v_and_b32 v49, 0xffff0000, v16
    v_cvt_pk_bf16_f32 v16, v50, v51
    v_lshlrev_b32 v50, 16, v16
    v_and_b32 v51, 0xffff0000, v16
    v_pk_add_f32 v[44:45], v[44:45], v[36:37]
    v_pk_add_f32 v[46:47], v[46:47], v[38:39]
    v_pk_add_f32 v[48:49], v[48:49], v[40:41]
    v_pk_add_f32 v[50:51], v[50:51], v[42:43]
    v_cvt_pk_bf16_f32 v36, v44, v45
    v_cvt_pk_bf16_f32 v37, v46, v47
    v_cvt_pk_bf16_f32 v38, v48, v49
    v_cvt_pk_bf16_f32 v39, v50, v51
    s_barrier
    v_and_b32 v16, 3, v1
    v_lshlrev_b32 v16, 4, v16
    v_add_u32 v16, 65792, v16
    ds_read_b32 v76, v16
    s_waitcnt lgkmcnt(0)
    v_mov_b32 v77, v76
    s_nop 1
    v_max_u32_dpp v77, v77, v77 row_ror:1 row_mask:0xf bank_mask:0xf
    s_nop 1
    v_max_u32_dpp v77, v77, v77 row_ror:2 row_mask:0xf bank_mask:0xf
    v_cmp_eq_u32 vcc, v76, v77
    s_ff1_i32_b64 s16, vcc
    s_lshl_b32 s16, s16, 4
    s_add_u32 s16, s16, 65792
    v_mov_b32 v16, s16
    ds_read_b128 v[24:27], v16
    s_waitcnt lgkmcnt(0)
    v_and_b32 v76, 0x7ff, v24
    v_sub_u32 v76, 2047, v76
    s_nop 0
    v_readfirstlane_b32 s12, v76
    v_rcp_f32 v103, v26
    s_lshr_b32 s18, s12, 4
    s_lshl_b32 s18, s18, 15
    s_and_b32 s19, s12, 15
    s_lshl_b32 s19, s19, 6
    s_add_u32 s18, s18, s19
    s_add_u32 s18, s18, 0x2c00000
    s_add_u32 s19, s18, 0x400000
    v_lshrrev_b32 v18, 4, v0
    v_lshlrev_b32 v18, 10, v18
    v_and_b32 v19, 15, v0
    v_lshl_add_u32 v18, v19, 2, v18
    s_lshl_b32 s13, s12, 11
    buffer_load_dword v100, v18, s[8:11], s18 offen sc1
    buffer_load_dword v101, v18, s[8:11], s19 offen sc1
    buffer_load_dword v102, v21, s[76:79], s13 offen
    s_lshl_b32 s16, s14, 11
    s_cmp_lg_u32 s12, s14
    s_cselect_b32 s16, s16, 0x7ffffff0
    buffer_store_dwordx4 v[28:31], v2, s[68:71], s16 offen offset:0 sc1
    buffer_store_dwordx4 v[36:39], v2, s[68:71], s16 offen offset:1024 sc1
    s_lshl_b32 s16, s3, 13
    v_add_u32 v20, s16, v2
    s_waitcnt vmcnt(4)
    v_lshlrev_b32 v76, 16, v100
    v_and_b32 v77, 0xffff0000, v100
    s_waitcnt vmcnt(3)
    v_lshlrev_b32 v78, 16, v101
    v_and_b32 v79, 0xffff0000, v101
    v_pk_add_f32 v[76:77], v[76:77], v[78:79]
    s_waitcnt vmcnt(2)
    v_lshlrev_b32 v78, 16, v102
    v_and_b32 v79, 0xffff0000, v102
    v_pk_add_f32 v[92:93], v[78:79], v[76:77]
    v_cvt_pk_bf16_f32 v76, v92, v93
    v_lshlrev_b32 v92, 16, v76
    v_and_b32 v93, 0xffff0000, v76
    v_cvt_pk_bf16_f32 v100, v92, v93
    v_and_b32 v105, 0xffff0000, v104
    v_lshlrev_b32 v104, 16, v104
    v_and_b32 v107, 0xffff0000, v106
    v_lshlrev_b32 v106, 16, v106
    v_sub_f32 v92, v92, v25
    v_sub_f32 v93, v93, v25
    v_cvt_pk_bf16_f32 v76, v92, v93
    v_lshlrev_b32 v92, 16, v76
    v_and_b32 v93, 0xffff0000, v76
    v_mul_f32 v77, v92, v103
    v_fma_f32 v92, -v77, v26, v92
    v_fma_f32 v92, v92, v103, v77
    v_mul_f32 v77, v93, v103
    v_fma_f32 v93, -v77, v26, v93
    v_fma_f32 v93, v93, v103, v77
    v_cvt_pk_bf16_f32 v76, v92, v93
    v_lshlrev_b32 v92, 16, v76
    v_and_b32 v93, 0xffff0000, v76
    v_mul_f32 v92, v92, v104
    v_mul_f32 v93, v93, v105
    v_cvt_pk_bf16_f32 v76, v92, v93
    v_lshlrev_b32 v92, 16, v76
    v_and_b32 v93, 0xffff0000, v76
    v_add_f32 v92, v92, v106
    v_add_f32 v93, v93, v107
    v_cvt_pk_bf16_f32 v101, v92, v93
    v_add_u32 v16, 66560, v21
    ds_write_b32 v16, v101
    ds_write_b32 v16, v100 offset:2048
    s_waitcnt lgkmcnt(0)
    s_barrier
    ds_read_b128 v[60:63], v20 offset:0
    ds_read_b128 v[64:67], v20 offset:1024
    ds_read_b128 v[68:71], v20 offset:2048
    ds_read_b128 v[72:75], v20 offset:3072
    ds_read_b128 v[108:111], v20 offset:4096
    ds_read_b128 v[112:115], v20 offset:5120
    ds_read_b128 v[116:119], v20 offset:6144
    ds_read_b128 v[120:123], v20 offset:7168
    s_and_b32 s16, s3, 3
    s_lshl_b32 s16, s16, 7
    s_and_b32 s17, s29, 3
    s_lshl_b32 s17, s17, 9
    s_add_u32 s16, s16, s17
    s_add_u32 s16, s16, 66560
    v_lshrrev_b32 v16, 3, v1
    v_lshlrev_b32 v16, 4, v16
    v_add_u32 v16, s16, v16
    ds_read_b128 v[104:107], v16
    s_waitcnt lgkmcnt(0)
    v_lshlrev_b32 v76, 16, v104
    v_and_b32 v77, 0xffff, v104
    v_dot2_f32_bf16 v85, v60, v76, 0
    v_dot2_f32_bf16 v84, v60, v77, 0
    v_dot2_f32_bf16 v87, v61, v76, 0
    v_dot2_f32_bf16 v86, v61, v77, 0
    v_dot2_f32_bf16 v89, v62, v76, 0
    v_dot2_f32_bf16 v88, v62, v77, 0
    v_dot2_f32_bf16 v91, v63, v76, 0
    v_dot2_f32_bf16 v90, v63, v77, 0
    v_and_b32 v78, 0xffff0000, v104
    v_lshrrev_b32 v79, 16, v104
    v_dot2c_f32_bf16 v85, v64, v78
    v_dot2c_f32_bf16 v84, v64, v79
    v_dot2c_f32_bf16 v87, v65, v78
    v_dot2c_f32_bf16 v86, v65, v79
    v_dot2c_f32_bf16 v89, v66, v78
    v_dot2c_f32_bf16 v88, v66, v79
    v_dot2c_f32_bf16 v91, v67, v78
    v_dot2c_f32_bf16 v90, v67, v79
    v_lshlrev_b32 v80, 16, v105
    v_and_b32 v81, 0xffff, v105
    v_dot2c_f32_bf16 v85, v68, v80
    v_dot2c_f32_bf16 v84, v68, v81
    v_dot2c_f32_bf16 v87, v69, v80
    v_dot2c_f32_bf16 v86, v69, v81
    v_dot2c_f32_bf16 v89, v70, v80
    v_dot2c_f32_bf16 v88, v70, v81
    v_dot2c_f32_bf16 v91, v71, v80
    v_dot2c_f32_bf16 v90, v71, v81
    v_and_b32 v82, 0xffff0000, v105
    v_lshrrev_b32 v83, 16, v105
    v_dot2c_f32_bf16 v85, v72, v82
    v_dot2c_f32_bf16 v84, v72, v83
    v_dot2c_f32_bf16 v87, v73, v82
    v_dot2c_f32_bf16 v86, v73, v83
    v_dot2c_f32_bf16 v89, v74, v82
    v_dot2c_f32_bf16 v88, v74, v83
    v_dot2c_f32_bf16 v91, v75, v82
    v_dot2c_f32_bf16 v90, v75, v83
    v_lshlrev_b32 v76, 16, v106
    v_and_b32 v77, 0xffff, v106
    v_dot2c_f32_bf16 v85, v108, v76
    v_dot2c_f32_bf16 v84, v108, v77
    v_dot2c_f32_bf16 v87, v109, v76
    v_dot2c_f32_bf16 v86, v109, v77
    v_dot2c_f32_bf16 v89, v110, v76
    v_dot2c_f32_bf16 v88, v110, v77
    v_dot2c_f32_bf16 v91, v111, v76
    v_dot2c_f32_bf16 v90, v111, v77
    v_and_b32 v78, 0xffff0000, v106
    v_lshrrev_b32 v79, 16, v106
    v_dot2c_f32_bf16 v85, v112, v78
    v_dot2c_f32_bf16 v84, v112, v79
    v_dot2c_f32_bf16 v87, v113, v78
    v_dot2c_f32_bf16 v86, v113, v79
    v_dot2c_f32_bf16 v89, v114, v78
    v_dot2c_f32_bf16 v88, v114, v79
    v_dot2c_f32_bf16 v91, v115, v78
    v_dot2c_f32_bf16 v90, v115, v79
    v_lshlrev_b32 v80, 16, v107
    v_and_b32 v81, 0xffff, v107
    v_dot2c_f32_bf16 v85, v116, v80
    v_dot2c_f32_bf16 v84, v116, v81
    v_dot2c_f32_bf16 v87, v117, v80
    v_dot2c_f32_bf16 v86, v117, v81
    v_dot2c_f32_bf16 v89, v118, v80
    v_dot2c_f32_bf16 v88, v118, v81
    v_dot2c_f32_bf16 v91, v119, v80
    v_dot2c_f32_bf16 v90, v119, v81
    v_and_b32 v82, 0xffff0000, v107
    v_lshrrev_b32 v83, 16, v107
    v_dot2c_f32_bf16 v85, v120, v82
    v_dot2c_f32_bf16 v84, v120, v83
    v_dot2c_f32_bf16 v87, v121, v82
    v_dot2c_f32_bf16 v86, v121, v83
    v_dot2c_f32_bf16 v89, v122, v82
    v_dot2c_f32_bf16 v88, v122, v83
    v_dot2c_f32_bf16 v91, v123, v82
    v_dot2c_f32_bf16 v90, v123, v83
    s_nop 0
    v_permlane32_swap_b32 v84, v88
    v_permlane32_swap_b32 v85, v89
    v_permlane32_swap_b32 v86, v90
    v_permlane32_swap_b32 v87, v91
    v_add_f32 v84, v84, v88
    v_add_f32 v85, v85, v89
    v_add_f32 v86, v86, v90
    v_add_f32 v87, v87, v91
    s_nop 0
    v_permlane16_swap_b32 v84, v86
    v_permlane16_swap_b32 v85, v87
    v_add_f32 v84, v84, v86
    v_add_f32 v85, v85, v87
    s_nop 0
    v_add_f32_dpp v84, v84, v84 row_ror:8 row_mask:0xf bank_mask:0xf
    v_add_f32_dpp v85, v85, v85 row_ror:8 row_mask:0xf bank_mask:0xf
    v_and_b32 v16, 7, v1
    v_lshlrev_b32 v16, 5, v16
    v_lshrrev_b32 v17, 4, v1
    v_lshl_add_u32 v16, v17, 3, v16
    s_lshl_b32 s16, s3, 8
    s_add_u32 s16, s16, 70656
    v_add_u32 v16, s16, v16
    ds_write_b64 v16, v[84:85]
    s_lshr_b32 s16, s3, 2
    s_lshl_b32 s17, s16, 10
    s_add_u32 s17, s17, 70656
    v_lshlrev_b32 v17, 2, v1
    v_add_u32 v16, s17, v17
    s_and_b32 s17, s29, 3
    s_lshl_b32 s17, s17, 1
    s_add_u32 s17, s17, s16
    s_mul_i32 s17, s17, 14336
    s_lshr_b32 s16, s29, 2
    s_lshl_b32 s16, s16, 8
    s_add_u32 s17, s17, s16
    s_add_u32 s17, s17, 0x6e1000
    s_and_b32 s16, s3, 3
    s_cmp_eq_u32 s16, 0
    s_cselect_b32 s17, s17, 0x7ffffff0
    s_cmp_lt_u32 s2, 224
    s_cselect_b32 s17, s17, 0x7ffffff0
    s_waitcnt lgkmcnt(0)
    s_barrier
    ds_read_b32 v84, v16 offset:0
    ds_read_b32 v85, v16 offset:256
    ds_read_b32 v86, v16 offset:512
    ds_read_b32 v87, v16 offset:768
    s_waitcnt lgkmcnt(2)
    v_add_f32 v84, v84, v85
    s_waitcnt lgkmcnt(0)
    v_add_f32 v86, v86, v87
    v_add_f32 v84, v84, v86
    v_or_b32 v84, 1, v84
    buffer_store_dword v84, v17, s[8:11], s17 offen sc1
    v_lshrrev_b32 v16, 4, v1
    v_mul_u32_u24 v16, 28672, v16
    v_and_b32 v17, 15, v1
    v_lshl_add_u32 v16, v17, 2, v16
    s_lshl_b32 s16, s29, 6
    s_add_u32 s16, s16, 0x6e1000
    s_add_u32 s17, s16, 14336
    s_mov_b32 s27, 0
adaLN_cond__sliding_block_cached__moe_arch_mod__prompt_kernel_gu23p:
    buffer_load_dword v84, v16, s[8:11], s16 offen sc1
    buffer_load_dword v85, v16, s[8:11], s17 offen sc1
    s_waitcnt vmcnt(0)
    v_min_u32 v86, v84, v85
    v_cmp_eq_u32 vcc, 0, v86
    s_cmp_lt_u32 s2, 224
    s_cselect_b64 s[62:63], -1, 0
    s_and_b64 vcc, vcc, s[62:63]
    s_add_u32 s27, s27, 1
    s_cmp_ge_u32 s27, 262144
    s_cbranch_scc1 adaLN_cond__sliding_block_cached__moe_arch_mod__prompt_kernel_gu23g
    s_cbranch_vccnz adaLN_cond__sliding_block_cached__moe_arch_mod__prompt_kernel_gu23p
adaLN_cond__sliding_block_cached__moe_arch_mod__prompt_kernel_gu23g:
    v_mov_b32 v86, v84
    s_nop 1
    v_permlane16_swap_b32 v84, v86
    v_add_f32 v84, v84, v86
    v_mov_b32 v87, v85
    s_nop 1
    v_permlane16_swap_b32 v85, v87
    v_add_f32 v85, v85, v87
    v_mov_b32 v86, v84
    s_nop 1
    v_permlane32_swap_b32 v84, v86
    v_add_f32 v84, v84, v86
    v_mov_b32 v87, v85
    s_nop 1
    v_permlane32_swap_b32 v85, v87
    v_add_f32 v85, v85, v87
    v_cvt_pk_bf16_f32 v86, v84, v85
    v_lshlrev_b32 v84, 16, v86
    v_and_b32 v85, 0xffff0000, v86
    v_mul_f32 v86, 0xbfb8aa3b, v84
    v_exp_f32 v86, v86
    s_nop 0
    v_add_f32 v86, 1.0, v86
    v_rcp_f32 v86, v86
    s_nop 0
    v_mul_f32 v84, v84, v86
    v_cvt_pk_bf16_f32 v84, v84, v84
    v_lshlrev_b32 v84, 16, v84
    v_mul_f32 v84, v84, v85
    v_cvt_pk_bf16_f32 v84, v84, v84
    v_lshlrev_b32 v84, 16, v84
    s_sub_u32 s16, s3, 4
    s_lshl_b32 s16, s16, 2
    s_add_u32 s17, s16, 0
    v_readlane_b32 s20, v84, s17
    s_lshr_b32 s4, s20, 16
    s_add_u32 s17, s16, 1
    v_readlane_b32 s21, v84, s17
    s_lshr_b32 s5, s21, 16
    s_add_u32 s17, s16, 2
    v_readlane_b32 s22, v84, s17
    s_lshr_b32 s6, s22, 16
    s_add_u32 s17, s16, 3
    v_readlane_b32 s23, v84, s17
    s_lshr_b32 s7, s23, 16
    v_dot2_f32_bf16 v45, v152, s20, 0
    v_dot2_f32_bf16 v44, v152, s4, 0
    v_dot2_f32_bf16 v47, v153, s20, 0
    v_dot2_f32_bf16 v46, v153, s4, 0
    v_dot2_f32_bf16 v49, v154, s20, 0
    v_dot2_f32_bf16 v48, v154, s4, 0
    v_dot2_f32_bf16 v51, v155, s20, 0
    v_dot2_f32_bf16 v50, v155, s4, 0
    v_dot2_f32_bf16 v53, v156, s20, 0
    v_dot2_f32_bf16 v52, v156, s4, 0
    v_dot2_f32_bf16 v55, v157, s20, 0
    v_dot2_f32_bf16 v54, v157, s4, 0
    v_dot2_f32_bf16 v57, v158, s20, 0
    v_dot2_f32_bf16 v56, v158, s4, 0
    v_dot2_f32_bf16 v59, v159, s20, 0
    v_dot2_f32_bf16 v58, v159, s4, 0
    v_dot2c_f32_bf16 v45, s21, v160
    v_dot2c_f32_bf16 v44, s5, v160
    v_dot2c_f32_bf16 v47, s21, v161
    v_dot2c_f32_bf16 v46, s5, v161
    v_dot2c_f32_bf16 v49, s21, v162
    v_dot2c_f32_bf16 v48, s5, v162
    v_dot2c_f32_bf16 v51, s21, v163
    v_dot2c_f32_bf16 v50, s5, v163
    v_dot2c_f32_bf16 v53, s21, v164
    v_dot2c_f32_bf16 v52, s5, v164
    v_dot2c_f32_bf16 v55, s21, v165
    v_dot2c_f32_bf16 v54, s5, v165
    v_dot2c_f32_bf16 v57, s21, v166
    v_dot2c_f32_bf16 v56, s5, v166
    v_dot2c_f32_bf16 v59, s21, v167
    v_dot2c_f32_bf16 v58, s5, v167
    v_dot2c_f32_bf16 v45, s22, v168
    v_dot2c_f32_bf16 v44, s6, v168
    v_dot2c_f32_bf16 v47, s22, v169
    v_dot2c_f32_bf16 v46, s6, v169
    v_dot2c_f32_bf16 v49, s22, v170
    v_dot2c_f32_bf16 v48, s6, v170
    v_dot2c_f32_bf16 v51, s22, v171
    v_dot2c_f32_bf16 v50, s6, v171
    v_dot2c_f32_bf16 v53, s22, v172
    v_dot2c_f32_bf16 v52, s6, v172
    v_dot2c_f32_bf16 v55, s22, v173
    v_dot2c_f32_bf16 v54, s6, v173
    v_dot2c_f32_bf16 v57, s22, v174
    v_dot2c_f32_bf16 v56, s6, v174
    v_dot2c_f32_bf16 v59, s22, v175
    v_dot2c_f32_bf16 v58, s6, v175
    v_dot2c_f32_bf16 v45, s23, v176
    v_dot2c_f32_bf16 v44, s7, v176
    v_dot2c_f32_bf16 v47, s23, v177
    v_dot2c_f32_bf16 v46, s7, v177
    v_dot2c_f32_bf16 v49, s23, v178
    v_dot2c_f32_bf16 v48, s7, v178
    v_dot2c_f32_bf16 v51, s23, v179
    v_dot2c_f32_bf16 v50, s7, v179
    v_dot2c_f32_bf16 v53, s23, v180
    v_dot2c_f32_bf16 v52, s7, v180
    v_dot2c_f32_bf16 v55, s23, v181
    v_dot2c_f32_bf16 v54, s7, v181
    v_dot2c_f32_bf16 v57, s23, v182
    v_dot2c_f32_bf16 v56, s7, v182
    v_dot2c_f32_bf16 v59, s23, v183
    v_dot2c_f32_bf16 v58, s7, v183
    s_sub_u32 s16, s3, 4
    s_lshl_b32 s16, s16, 12
    s_add_u32 s16, s16, 73728
    v_lshlrev_b32 v16, 5, v1
    v_add_u32 v16, s16, v16
    ds_write_b128 v16, v[44:47] offset:0
    ds_write_b128 v16, v[48:51] offset:16
    ds_write_b128 v16, v[52:55] offset:2048
    ds_write_b128 v16, v[56:59] offset:2064
    s_waitcnt lgkmcnt(0)
    s_barrier
    v_lshlrev_b32 v16, 3, v0
    v_add_u32 v17, 73728, v16
    ds_read_b64 v[84:85], v17 offset:0
    ds_read_b64 v[86:87], v17 offset:4096
    ds_read_b64 v[88:89], v17 offset:8192
    ds_read_b64 v[90:91], v17 offset:12288
    s_waitcnt lgkmcnt(2)
    v_pk_add_f32 v[84:85], v[84:85], v[86:87]
    s_waitcnt lgkmcnt(0)
    v_pk_add_f32 v[88:89], v[88:89], v[90:91]
    v_pk_add_f32 v[84:85], v[84:85], v[88:89]
    v_or_b32 v84, 1, v84
    v_or_b32 v85, 1, v85
    s_lshl_b32 s16, s29, 12
    s_add_u32 s16, s16, 0x600000
    s_cmp_lt_u32 s2, 224
    s_cselect_b32 s16, s16, 0x7ffffff0
    buffer_store_dwordx2 v[84:85], v16, s[8:11], s16 offen sc1
    s_cmp_lt_u32 s2, 224
    s_cbranch_scc1 adaLN_cond__sliding_block_cached__moe_arch_mod__prompt_kernel_end
    s_sub_u32 s16, s2, 224
    s_lshl_b32 s17, s16, 7
    s_add_u32 s17, s17, 0x600000
    v_lshrrev_b32 v16, 3, v0
    v_lshlrev_b32 v16, 12, v16
    v_and_b32 v17, 7, v0
    v_lshl_add_u32 v16, v17, 4, v16
    v_cmp_gt_u32 vcc, 256, v0
    v_bfrev_b32 v17, -2
    s_nop 0
    v_cndmask_b32 v17, v17, v16, vcc
    v_mov_b32 v19, 0
    v_cndmask_b32 v18, 1, v19, vcc
    s_lshl_b32 s18, s16, 6
    v_and_b32 v19, 31, v1
    v_lshlrev_b32 v19, 1, v19
    v_add_u32 v19, s18, v19
    s_mov_b32 s19, 0x541800
    buffer_load_ushort v95, v19, s[8:11], s19 offen sc1
    v_add_u32 v20, 66560, v19
    ds_read_u16 v96, v20
    ds_read_u16 v97, v20 offset:2048
    v_mov_b32 v94, v27
    v_cvt_pk_bf16_f32 v94, v94, v94
    v_lshlrev_b32 v94, 16, v94
    v_mul_f32 v94, 0xbfb8aa3b, v94
    v_exp_f32 v94, v94
    s_nop 0
    v_add_f32 v94, 1.0, v94
    v_rcp_f32 v94, v94
    s_nop 0
    v_cvt_pk_bf16_f32 v94, v94, v94
    v_lshlrev_b32 v94, 16, v94
    s_waitcnt vmcnt(0)
    v_lshlrev_b32 v95, 16, v95
    s_waitcnt lgkmcnt(1)
    v_lshlrev_b32 v96, 16, v96
    s_waitcnt lgkmcnt(0)
    v_lshlrev_b32 v97, 16, v97
    s_mov_b32 s27, 0
adaLN_cond__sliding_block_cached__moe_arch_mod__prompt_kernel_y24p:
    s_add_u32 s19, s17, 0x0
    buffer_load_dwordx4 v[44:47], v16, s[8:11], s19 offen sc1
    s_add_u32 s19, s17, 0x40000
    buffer_load_dwordx4 v[48:51], v16, s[8:11], s19 offen sc1
    s_add_u32 s19, s17, 0x80000
    buffer_load_dwordx4 v[52:55], v16, s[8:11], s19 offen sc1
    s_add_u32 s19, s17, 0xc0000
    buffer_load_dwordx4 v[56:59], v17, s[8:11], s19 offen sc1
    s_waitcnt vmcnt(0)
    v_min3_u32 v98, v56, v57, v58
    v_min_u32 v98, v98, v59
    v_or_b32 v98, v98, v18
    v_min3_u32 v98, v98, v44, v45
    v_min3_u32 v98, v98, v46, v47
    v_min3_u32 v98, v98, v48, v49
    v_min3_u32 v98, v98, v50, v51
    v_min3_u32 v98, v98, v52, v53
    v_min3_u32 v98, v98, v54, v55
    v_cmp_eq_u32 vcc, 0, v98
    s_add_u32 s27, s27, 1
    s_cmp_ge_u32 s27, 262144
    s_cbranch_scc1 adaLN_cond__sliding_block_cached__moe_arch_mod__prompt_kernel_y24g
    s_cbranch_vccnz adaLN_cond__sliding_block_cached__moe_arch_mod__prompt_kernel_y24p
adaLN_cond__sliding_block_cached__moe_arch_mod__prompt_kernel_y24g:
    v_pk_add_f32 v[44:45], v[44:45], v[52:53]
    v_pk_add_f32 v[46:47], v[46:47], v[54:55]
    v_pk_add_f32 v[48:49], v[48:49], v[56:57]
    v_pk_add_f32 v[50:51], v[50:51], v[58:59]
    v_pk_add_f32 v[44:45], v[44:45], v[48:49]
    v_pk_add_f32 v[46:47], v[46:47], v[50:51]
    s_nop 0
    v_add_f32_dpp v44, v44, v44 row_ror:8 row_mask:0xf bank_mask:0xf
    v_add_f32_dpp v45, v45, v45 row_ror:8 row_mask:0xf bank_mask:0xf
    v_add_f32_dpp v46, v46, v46 row_ror:8 row_mask:0xf bank_mask:0xf
    v_add_f32_dpp v47, v47, v47 row_ror:8 row_mask:0xf bank_mask:0xf
    s_nop 0
    v_permlane32_swap_b32 v44, v46
    v_permlane32_swap_b32 v45, v47
    v_add_f32 v44, v44, v46
    v_add_f32 v45, v45, v47
    s_nop 1
    v_permlane16_swap_b32 v44, v45
    v_add_f32 v44, v44, v45
    v_and_b32 v16, 7, v1
    v_lshlrev_b32 v16, 4, v16
    v_lshrrev_b32 v17, 4, v1
    v_lshl_add_u32 v16, v17, 2, v16
    s_lshl_b32 s19, s3, 7
    s_add_u32 s19, s19, 91136
    v_add_u32 v16, s19, v16
    ds_write_b32 v16, v44
    v_and_b32 v16, 31, v1
    v_lshlrev_b32 v16, 2, v16
    v_add_u32 v16, 91136, v16
    s_waitcnt lgkmcnt(0)
    s_barrier
    s_cmp_lg_u32 s3, 0
    s_cbranch_scc1 adaLN_cond__sliding_block_cached__moe_arch_mod__prompt_kernel_end
    ds_read_b32 v44, v16 offset:0
    ds_read_b32 v45, v16 offset:128
    ds_read_b32 v46, v16 offset:256
    ds_read_b32 v47, v16 offset:384
    ds_read_b32 v48, v16 offset:512
    ds_read_b32 v49, v16 offset:640
    ds_read_b32 v50, v16 offset:768
    ds_read_b32 v51, v16 offset:896
    s_waitcnt lgkmcnt(3)
    v_add_f32 v44, v44, v48
    s_waitcnt lgkmcnt(2)
    v_add_f32 v45, v45, v49
    s_waitcnt lgkmcnt(1)
    v_add_f32 v46, v46, v50
    s_waitcnt lgkmcnt(0)
    v_add_f32 v47, v47, v51
    v_add_f32 v44, v44, v46
    v_add_f32 v45, v45, v47
    v_add_f32 v44, v44, v45
    v_cvt_pk_bf16_f32 v44, v44, v44
    v_lshlrev_b32 v44, 16, v44
    v_mul_f32 v44, v44, v94
    v_cvt_pk_bf16_f32 v44, v44, v44
    v_lshlrev_b32 v44, 16, v44
    v_add_f32 v44, v44, v96
    v_cvt_pk_bf16_f32 v44, v44, v44
    v_lshlrev_b32 v44, 16, v44
    v_mul_f32 v44, v44, v95
    v_cvt_pk_bf16_f32 v44, v44, v44
    v_lshlrev_b32 v44, 16, v44
    v_add_f32 v44, v44, v97
    v_cvt_pk_bf16_f32 v44, v44, v44
    s_mov_b64 exec, 0xffffffff
    buffer_store_short v44, v19, s[68:71], s13 offen sc1
adaLN_cond__sliding_block_cached__moe_arch_mod__prompt_kernel_end:
    s_endpgm
adaLN_cond__sliding_block_cached__moe_arch_mod__prompt_kernel_n1r:
    s_mov_b32 s27, 0
adaLN_cond__sliding_block_cached__moe_arch_mod__prompt_kernel_n1p:
    buffer_load_dword v134, v132, s[64:67], 0 offen sc1
    s_waitcnt vmcnt(0)
    v_cmp_eq_u32 vcc, 0, v134
    s_cmp_eq_u32 s3, 0
    s_cselect_b64 s[62:63], -1, 0
    s_and_b64 vcc, vcc, s[62:63]
    s_add_u32 s27, s27, 1
    s_cmp_ge_u32 s27, 262144
    s_cbranch_scc1 adaLN_cond__sliding_block_cached__moe_arch_mod__prompt_kernel_n1g
    s_cbranch_vccnz adaLN_cond__sliding_block_cached__moe_arch_mod__prompt_kernel_n1p
adaLN_cond__sliding_block_cached__moe_arch_mod__prompt_kernel_n1g:
    s_waitcnt vmcnt(0) lgkmcnt(0)
    s_nop 15
    s_nop 3
    s_branch adaLN_cond__sliding_block_cached__moe_arch_mod__prompt_kernel_n1b
adaLN_cond__sliding_block_cached__moe_arch_mod__prompt_kernel_kv4r:
    s_waitcnt vmcnt(0) lgkmcnt(0)
    s_nop 15
    s_nop 3
    s_mov_b32 s27, 0
adaLN_cond__sliding_block_cached__moe_arch_mod__prompt_kernel_kv4p:
    buffer_load_dwordx4 v[12:15], v21, s[8:11], s18 offen sc1
    s_waitcnt vmcnt(0)
    v_xor_b32 v8, s28, v12
    v_xor_b32 v20, s28, v13
    v_or_b32 v8, v8, v20
    v_xor_b32 v20, s28, v14
    v_or_b32 v8, v8, v20
    v_xor_b32 v20, s28, v15
    v_or_b32 v8, v8, v20
    v_cmp_ne_u32 vcc, 0, v8
    s_add_u32 s27, s27, 1
    s_cmp_ge_u32 s27, 262144
    s_cbranch_scc1 adaLN_cond__sliding_block_cached__moe_arch_mod__prompt_kernel_kv4g
    s_cbranch_vccnz adaLN_cond__sliding_block_cached__moe_arch_mod__prompt_kernel_kv4p
adaLN_cond__sliding_block_cached__moe_arch_mod__prompt_kernel_kv4g:
    s_waitcnt vmcnt(0) lgkmcnt(0)
    s_nop 15
    s_nop 3
    s_branch adaLN_cond__sliding_block_cached__moe_arch_mod__prompt_kernel_kv4b
adaLN_cond__sliding_block_cached__moe_arch_mod__prompt_kernel_fixA:
    s_waitcnt vmcnt(0) lgkmcnt(0)
    s_nop 15
    s_nop 3
    s_lshr_b32 s16, s12, 3
    s_lshl_b32 s16, s16, 17
    s_add_u32 s16, s16, 0x400000
    v_add_u32 v8, s16, v2
    v_mov_b32 v16, 0xff7fffff
    v_mov_b32 v17, 0xff7fffff
    s_mov_b32 s16, 0
adaLN_cond__sliding_block_cached__moe_arch_mod__prompt_kernel_fixAm:
    s_add_u32 s17, s16, 0
    buffer_load_dwordx4 v[200:203], v8, s[8:11], s17 offen offset:0
    buffer_load_dwordx4 v[204:207], v8, s[8:11], s17 offen offset:1024
    buffer_load_dwordx4 v[208:211], v8, s[8:11], s17 offen offset:2048
    buffer_load_dwordx4 v[212:215], v8, s[8:11], s17 offen offset:3072
    s_waitcnt vmcnt(3)
    v_mfma_f32_16x16x32_bf16 v[184:187], v[200:203], v[152:155], 0
    v_mfma_f32_16x16x32_bf16 v[188:191], v[200:203], v[168:171], 0
    s_waitcnt vmcnt(2)
    v_mfma_f32_16x16x32_bf16 v[192:195], v[204:207], v[152:155], 0
    v_mfma_f32_16x16x32_bf16 v[196:199], v[204:207], v[168:171], 0
    s_waitcnt vmcnt(1)
    v_mfma_f32_16x16x32_bf16 v[184:187], v[208:211], v[156:159], v[184:187]
    v_mfma_f32_16x16x32_bf16 v[188:191], v[208:211], v[172:175], v[188:191]
    s_waitcnt vmcnt(0)
    v_mfma_f32_16x16x32_bf16 v[192:195], v[212:215], v[156:159], v[192:195]
    v_mfma_f32_16x16x32_bf16 v[196:199], v[212:215], v[172:175], v[196:199]
    s_add_u32 s17, s16, 4096
    buffer_load_dwordx4 v[200:203], v8, s[8:11], s17 offen offset:0
    buffer_load_dwordx4 v[204:207], v8, s[8:11], s17 offen offset:1024
    buffer_load_dwordx4 v[208:211], v8, s[8:11], s17 offen offset:2048
    buffer_load_dwordx4 v[212:215], v8, s[8:11], s17 offen offset:3072
    s_waitcnt vmcnt(3)
    v_mfma_f32_16x16x32_bf16 v[184:187], v[200:203], v[160:163], v[184:187]
    v_mfma_f32_16x16x32_bf16 v[188:191], v[200:203], v[176:179], v[188:191]
    s_waitcnt vmcnt(2)
    v_mfma_f32_16x16x32_bf16 v[192:195], v[204:207], v[160:163], v[192:195]
    v_mfma_f32_16x16x32_bf16 v[196:199], v[204:207], v[176:179], v[196:199]
    s_waitcnt vmcnt(1)
    v_mfma_f32_16x16x32_bf16 v[184:187], v[208:211], v[164:167], v[184:187]
    v_mfma_f32_16x16x32_bf16 v[188:191], v[208:211], v[180:183], v[188:191]
    s_waitcnt vmcnt(0)
    v_mfma_f32_16x16x32_bf16 v[192:195], v[212:215], v[164:167], v[192:195]
    v_mfma_f32_16x16x32_bf16 v[196:199], v[212:215], v[180:183], v[196:199]
    s_nop 3
    v_max3_f32 v16, v16, v184, v185
    v_max3_f32 v16, v16, v186, v187
    v_max3_f32 v17, v17, v188, v189
    v_max3_f32 v17, v17, v190, v191
    v_max3_f32 v16, v16, v192, v193
    v_max3_f32 v16, v16, v194, v195
    v_max3_f32 v17, v17, v196, v197
    v_max3_f32 v17, v17, v198, v199
    s_add_u32 s16, s16, 8192
    s_cmp_lt_u32 s16, 0x20000
    s_cbranch_scc1 adaLN_cond__sliding_block_cached__moe_arch_mod__prompt_kernel_fixAm
    v_mov_b32 v18, v16
    v_mov_b32 v19, v17
    s_nop 0
    v_permlane16_swap_b32 v16, v18
    v_permlane16_swap_b32 v17, v19
    v_max_f32 v16, v16, v18
    v_max_f32 v17, v17, v19
    v_mov_b32 v18, v16
    v_mov_b32 v19, v17
    s_nop 0
    v_permlane32_swap_b32 v16, v18
    v_permlane32_swap_b32 v17, v19
    v_max_f32 v16, v16, v18
    v_max_f32 v17, v17, v19
    v_sub_f32 v216, 0, v16
    v_sub_f32 v217, 0, v16
    v_sub_f32 v218, 0, v16
    v_sub_f32 v219, 0, v16
    v_sub_f32 v220, 0, v17
    v_sub_f32 v221, 0, v17
    v_sub_f32 v222, 0, v17
    v_sub_f32 v223, 0, v17
    s_mov_b32 s17, 0x0
    buffer_load_dwordx4 v[200:203], v8, s[8:11], s17 offen offset:0
    buffer_load_dwordx4 v[204:207], v8, s[8:11], s17 offen offset:1024
    buffer_load_dwordx4 v[208:211], v8, s[8:11], s17 offen offset:2048
    buffer_load_dwordx4 v[212:215], v8, s[8:11], s17 offen offset:3072
    s_waitcnt vmcnt(3)
    v_mfma_f32_16x16x32_bf16 v[184:187], v[200:203], v[152:155], v[216:219]
    v_mfma_f32_16x16x32_bf16 v[188:191], v[200:203], v[168:171], v[220:223]
    s_waitcnt vmcnt(2)
    v_mfma_f32_16x16x32_bf16 v[192:195], v[204:207], v[152:155], v[216:219]
    v_mfma_f32_16x16x32_bf16 v[196:199], v[204:207], v[168:171], v[220:223]
    s_waitcnt vmcnt(1)
    v_mfma_f32_16x16x32_bf16 v[184:187], v[208:211], v[156:159], v[184:187]
    v_mfma_f32_16x16x32_bf16 v[188:191], v[208:211], v[172:175], v[188:191]
    s_waitcnt vmcnt(0)
    v_mfma_f32_16x16x32_bf16 v[192:195], v[212:215], v[156:159], v[192:195]
    v_mfma_f32_16x16x32_bf16 v[196:199], v[212:215], v[172:175], v[196:199]
    s_mov_b32 s17, 0x1000
    buffer_load_dwordx4 v[200:203], v8, s[8:11], s17 offen offset:0
    buffer_load_dwordx4 v[204:207], v8, s[8:11], s17 offen offset:1024
    buffer_load_dwordx4 v[208:211], v8, s[8:11], s17 offen offset:2048
    buffer_load_dwordx4 v[212:215], v8, s[8:11], s17 offen offset:3072
    s_waitcnt vmcnt(3)
    v_mfma_f32_16x16x32_bf16 v[184:187], v[200:203], v[160:163], v[184:187]
    v_mfma_f32_16x16x32_bf16 v[188:191], v[200:203], v[176:179], v[188:191]
    s_waitcnt vmcnt(2)
    v_mfma_f32_16x16x32_bf16 v[192:195], v[204:207], v[160:163], v[192:195]
    v_mfma_f32_16x16x32_bf16 v[196:199], v[204:207], v[176:179], v[196:199]
    s_waitcnt vmcnt(1)
    v_mfma_f32_16x16x32_bf16 v[184:187], v[208:211], v[164:167], v[184:187]
    v_mfma_f32_16x16x32_bf16 v[188:191], v[208:211], v[180:183], v[188:191]
    s_waitcnt vmcnt(0)
    v_mfma_f32_16x16x32_bf16 v[192:195], v[212:215], v[164:167], v[192:195]
    v_mfma_f32_16x16x32_bf16 v[196:199], v[212:215], v[180:183], v[196:199]
    s_nop 3
    v_exp_f32 v184, v184
    v_exp_f32 v185, v185
    s_nop 0
    v_add_f32 v9, v184, v185
    v_cvt_pk_bf16_f32 v24, v184, v185
    v_exp_f32 v186, v186
    v_exp_f32 v187, v187
    v_add_f32 v9, v9, v186
    v_add_f32 v9, v9, v187
    v_cvt_pk_bf16_f32 v25, v186, v187
    v_exp_f32 v188, v188
    v_exp_f32 v189, v189
    s_nop 0
    v_add_f32 v10, v188, v189
    v_cvt_pk_bf16_f32 v28, v188, v189
    v_exp_f32 v190, v190
    v_exp_f32 v191, v191
    v_add_f32 v10, v10, v190
    v_add_f32 v10, v10, v191
    v_cvt_pk_bf16_f32 v29, v190, v191
    v_exp_f32 v192, v192
    v_exp_f32 v193, v193
    v_add_f32 v9, v9, v192
    v_add_f32 v9, v9, v193
    v_cvt_pk_bf16_f32 v26, v192, v193
    v_exp_f32 v194, v194
    v_exp_f32 v195, v195
    v_add_f32 v9, v9, v194
    v_add_f32 v9, v9, v195
    v_cvt_pk_bf16_f32 v27, v194, v195
    v_exp_f32 v196, v196
    v_exp_f32 v197, v197
    v_add_f32 v10, v10, v196
    v_add_f32 v10, v10, v197
    v_cvt_pk_bf16_f32 v30, v196, v197
    v_exp_f32 v198, v198
    v_exp_f32 v199, v199
    v_add_f32 v10, v10, v198
    v_add_f32 v10, v10, v199
    v_cvt_pk_bf16_f32 v31, v198, v199
    s_mov_b32 s17, 0x2000
    buffer_load_dwordx4 v[200:203], v8, s[8:11], s17 offen offset:0
    buffer_load_dwordx4 v[204:207], v8, s[8:11], s17 offen offset:1024
    buffer_load_dwordx4 v[208:211], v8, s[8:11], s17 offen offset:2048
    buffer_load_dwordx4 v[212:215], v8, s[8:11], s17 offen offset:3072
    s_waitcnt vmcnt(3)
    v_mfma_f32_16x16x32_bf16 v[184:187], v[200:203], v[152:155], v[216:219]
    v_mfma_f32_16x16x32_bf16 v[188:191], v[200:203], v[168:171], v[220:223]
    s_waitcnt vmcnt(2)
    v_mfma_f32_16x16x32_bf16 v[192:195], v[204:207], v[152:155], v[216:219]
    v_mfma_f32_16x16x32_bf16 v[196:199], v[204:207], v[168:171], v[220:223]
    s_waitcnt vmcnt(1)
    v_mfma_f32_16x16x32_bf16 v[184:187], v[208:211], v[156:159], v[184:187]
    v_mfma_f32_16x16x32_bf16 v[188:191], v[208:211], v[172:175], v[188:191]
    s_waitcnt vmcnt(0)
    v_mfma_f32_16x16x32_bf16 v[192:195], v[212:215], v[156:159], v[192:195]
    v_mfma_f32_16x16x32_bf16 v[196:199], v[212:215], v[172:175], v[196:199]
    s_mov_b32 s17, 0x3000
    buffer_load_dwordx4 v[200:203], v8, s[8:11], s17 offen offset:0
    buffer_load_dwordx4 v[204:207], v8, s[8:11], s17 offen offset:1024
    buffer_load_dwordx4 v[208:211], v8, s[8:11], s17 offen offset:2048
    buffer_load_dwordx4 v[212:215], v8, s[8:11], s17 offen offset:3072
    s_waitcnt vmcnt(3)
    v_mfma_f32_16x16x32_bf16 v[184:187], v[200:203], v[160:163], v[184:187]
    v_mfma_f32_16x16x32_bf16 v[188:191], v[200:203], v[176:179], v[188:191]
    s_waitcnt vmcnt(2)
    v_mfma_f32_16x16x32_bf16 v[192:195], v[204:207], v[160:163], v[192:195]
    v_mfma_f32_16x16x32_bf16 v[196:199], v[204:207], v[176:179], v[196:199]
    s_waitcnt vmcnt(1)
    v_mfma_f32_16x16x32_bf16 v[184:187], v[208:211], v[164:167], v[184:187]
    v_mfma_f32_16x16x32_bf16 v[188:191], v[208:211], v[180:183], v[188:191]
    s_waitcnt vmcnt(0)
    v_mfma_f32_16x16x32_bf16 v[192:195], v[212:215], v[164:167], v[192:195]
    v_mfma_f32_16x16x32_bf16 v[196:199], v[212:215], v[180:183], v[196:199]
    s_nop 3
    v_exp_f32 v184, v184
    v_exp_f32 v185, v185
    v_add_f32 v9, v9, v184
    v_add_f32 v9, v9, v185
    v_cvt_pk_bf16_f32 v32, v184, v185
    v_exp_f32 v186, v186
    v_exp_f32 v187, v187
    v_add_f32 v9, v9, v186
    v_add_f32 v9, v9, v187
    v_cvt_pk_bf16_f32 v33, v186, v187
    v_exp_f32 v188, v188
    v_exp_f32 v189, v189
    v_add_f32 v10, v10, v188
    v_add_f32 v10, v10, v189
    v_cvt_pk_bf16_f32 v36, v188, v189
    v_exp_f32 v190, v190
    v_exp_f32 v191, v191
    v_add_f32 v10, v10, v190
    v_add_f32 v10, v10, v191
    v_cvt_pk_bf16_f32 v37, v190, v191
    v_exp_f32 v192, v192
    v_exp_f32 v193, v193
    v_add_f32 v9, v9, v192
    v_add_f32 v9, v9, v193
    v_cvt_pk_bf16_f32 v34, v192, v193
    v_exp_f32 v194, v194
    v_exp_f32 v195, v195
    v_add_f32 v9, v9, v194
    v_add_f32 v9, v9, v195
    v_cvt_pk_bf16_f32 v35, v194, v195
    v_exp_f32 v196, v196
    v_exp_f32 v197, v197
    v_add_f32 v10, v10, v196
    v_add_f32 v10, v10, v197
    v_cvt_pk_bf16_f32 v38, v196, v197
    v_exp_f32 v198, v198
    v_exp_f32 v199, v199
    v_add_f32 v10, v10, v198
    v_add_f32 v10, v10, v199
    v_cvt_pk_bf16_f32 v39, v198, v199
    s_mov_b32 s17, 0x4000
    buffer_load_dwordx4 v[200:203], v8, s[8:11], s17 offen offset:0
    buffer_load_dwordx4 v[204:207], v8, s[8:11], s17 offen offset:1024
    buffer_load_dwordx4 v[208:211], v8, s[8:11], s17 offen offset:2048
    buffer_load_dwordx4 v[212:215], v8, s[8:11], s17 offen offset:3072
    s_waitcnt vmcnt(3)
    v_mfma_f32_16x16x32_bf16 v[184:187], v[200:203], v[152:155], v[216:219]
    v_mfma_f32_16x16x32_bf16 v[188:191], v[200:203], v[168:171], v[220:223]
    s_waitcnt vmcnt(2)
    v_mfma_f32_16x16x32_bf16 v[192:195], v[204:207], v[152:155], v[216:219]
    v_mfma_f32_16x16x32_bf16 v[196:199], v[204:207], v[168:171], v[220:223]
    s_waitcnt vmcnt(1)
    v_mfma_f32_16x16x32_bf16 v[184:187], v[208:211], v[156:159], v[184:187]
    v_mfma_f32_16x16x32_bf16 v[188:191], v[208:211], v[172:175], v[188:191]
    s_waitcnt vmcnt(0)
    v_mfma_f32_16x16x32_bf16 v[192:195], v[212:215], v[156:159], v[192:195]
    v_mfma_f32_16x16x32_bf16 v[196:199], v[212:215], v[172:175], v[196:199]
    s_mov_b32 s17, 0x5000
    buffer_load_dwordx4 v[200:203], v8, s[8:11], s17 offen offset:0
    buffer_load_dwordx4 v[204:207], v8, s[8:11], s17 offen offset:1024
    buffer_load_dwordx4 v[208:211], v8, s[8:11], s17 offen offset:2048
    buffer_load_dwordx4 v[212:215], v8, s[8:11], s17 offen offset:3072
    s_waitcnt vmcnt(3)
    v_mfma_f32_16x16x32_bf16 v[184:187], v[200:203], v[160:163], v[184:187]
    v_mfma_f32_16x16x32_bf16 v[188:191], v[200:203], v[176:179], v[188:191]
    s_waitcnt vmcnt(2)
    v_mfma_f32_16x16x32_bf16 v[192:195], v[204:207], v[160:163], v[192:195]
    v_mfma_f32_16x16x32_bf16 v[196:199], v[204:207], v[176:179], v[196:199]
    s_waitcnt vmcnt(1)
    v_mfma_f32_16x16x32_bf16 v[184:187], v[208:211], v[164:167], v[184:187]
    v_mfma_f32_16x16x32_bf16 v[188:191], v[208:211], v[180:183], v[188:191]
    s_waitcnt vmcnt(0)
    v_mfma_f32_16x16x32_bf16 v[192:195], v[212:215], v[164:167], v[192:195]
    v_mfma_f32_16x16x32_bf16 v[196:199], v[212:215], v[180:183], v[196:199]
    s_nop 3
    v_exp_f32 v184, v184
    v_exp_f32 v185, v185
    v_add_f32 v9, v9, v184
    v_add_f32 v9, v9, v185
    v_cvt_pk_bf16_f32 v40, v184, v185
    v_exp_f32 v186, v186
    v_exp_f32 v187, v187
    v_add_f32 v9, v9, v186
    v_add_f32 v9, v9, v187
    v_cvt_pk_bf16_f32 v41, v186, v187
    v_exp_f32 v188, v188
    v_exp_f32 v189, v189
    v_add_f32 v10, v10, v188
    v_add_f32 v10, v10, v189
    v_cvt_pk_bf16_f32 v44, v188, v189
    v_exp_f32 v190, v190
    v_exp_f32 v191, v191
    v_add_f32 v10, v10, v190
    v_add_f32 v10, v10, v191
    v_cvt_pk_bf16_f32 v45, v190, v191
    v_exp_f32 v192, v192
    v_exp_f32 v193, v193
    v_add_f32 v9, v9, v192
    v_add_f32 v9, v9, v193
    v_cvt_pk_bf16_f32 v42, v192, v193
    v_exp_f32 v194, v194
    v_exp_f32 v195, v195
    v_add_f32 v9, v9, v194
    v_add_f32 v9, v9, v195
    v_cvt_pk_bf16_f32 v43, v194, v195
    v_exp_f32 v196, v196
    v_exp_f32 v197, v197
    v_add_f32 v10, v10, v196
    v_add_f32 v10, v10, v197
    v_cvt_pk_bf16_f32 v46, v196, v197
    v_exp_f32 v198, v198
    v_exp_f32 v199, v199
    v_add_f32 v10, v10, v198
    v_add_f32 v10, v10, v199
    v_cvt_pk_bf16_f32 v47, v198, v199
    s_mov_b32 s17, 0x6000
    buffer_load_dwordx4 v[200:203], v8, s[8:11], s17 offen offset:0
    buffer_load_dwordx4 v[204:207], v8, s[8:11], s17 offen offset:1024
    buffer_load_dwordx4 v[208:211], v8, s[8:11], s17 offen offset:2048
    buffer_load_dwordx4 v[212:215], v8, s[8:11], s17 offen offset:3072
    s_waitcnt vmcnt(3)
    v_mfma_f32_16x16x32_bf16 v[184:187], v[200:203], v[152:155], v[216:219]
    v_mfma_f32_16x16x32_bf16 v[188:191], v[200:203], v[168:171], v[220:223]
    s_waitcnt vmcnt(2)
    v_mfma_f32_16x16x32_bf16 v[192:195], v[204:207], v[152:155], v[216:219]
    v_mfma_f32_16x16x32_bf16 v[196:199], v[204:207], v[168:171], v[220:223]
    s_waitcnt vmcnt(1)
    v_mfma_f32_16x16x32_bf16 v[184:187], v[208:211], v[156:159], v[184:187]
    v_mfma_f32_16x16x32_bf16 v[188:191], v[208:211], v[172:175], v[188:191]
    s_waitcnt vmcnt(0)
    v_mfma_f32_16x16x32_bf16 v[192:195], v[212:215], v[156:159], v[192:195]
    v_mfma_f32_16x16x32_bf16 v[196:199], v[212:215], v[172:175], v[196:199]
    s_mov_b32 s17, 0x7000
    buffer_load_dwordx4 v[200:203], v8, s[8:11], s17 offen offset:0
    buffer_load_dwordx4 v[204:207], v8, s[8:11], s17 offen offset:1024
    buffer_load_dwordx4 v[208:211], v8, s[8:11], s17 offen offset:2048
    buffer_load_dwordx4 v[212:215], v8, s[8:11], s17 offen offset:3072
    s_waitcnt vmcnt(3)
    v_mfma_f32_16x16x32_bf16 v[184:187], v[200:203], v[160:163], v[184:187]
    v_mfma_f32_16x16x32_bf16 v[188:191], v[200:203], v[176:179], v[188:191]
    s_waitcnt vmcnt(2)
    v_mfma_f32_16x16x32_bf16 v[192:195], v[204:207], v[160:163], v[192:195]
    v_mfma_f32_16x16x32_bf16 v[196:199], v[204:207], v[176:179], v[196:199]
    s_waitcnt vmcnt(1)
    v_mfma_f32_16x16x32_bf16 v[184:187], v[208:211], v[164:167], v[184:187]
    v_mfma_f32_16x16x32_bf16 v[188:191], v[208:211], v[180:183], v[188:191]
    s_waitcnt vmcnt(0)
    v_mfma_f32_16x16x32_bf16 v[192:195], v[212:215], v[164:167], v[192:195]
    v_mfma_f32_16x16x32_bf16 v[196:199], v[212:215], v[180:183], v[196:199]
    s_nop 3
    v_exp_f32 v184, v184
    v_exp_f32 v185, v185
    v_add_f32 v9, v9, v184
    v_add_f32 v9, v9, v185
    v_cvt_pk_bf16_f32 v48, v184, v185
    v_exp_f32 v186, v186
    v_exp_f32 v187, v187
    v_add_f32 v9, v9, v186
    v_add_f32 v9, v9, v187
    v_cvt_pk_bf16_f32 v49, v186, v187
    v_exp_f32 v188, v188
    v_exp_f32 v189, v189
    v_add_f32 v10, v10, v188
    v_add_f32 v10, v10, v189
    v_cvt_pk_bf16_f32 v52, v188, v189
    v_exp_f32 v190, v190
    v_exp_f32 v191, v191
    v_add_f32 v10, v10, v190
    v_add_f32 v10, v10, v191
    v_cvt_pk_bf16_f32 v53, v190, v191
    v_exp_f32 v192, v192
    v_exp_f32 v193, v193
    v_add_f32 v9, v9, v192
    v_add_f32 v9, v9, v193
    v_cvt_pk_bf16_f32 v50, v192, v193
    v_exp_f32 v194, v194
    v_exp_f32 v195, v195
    v_add_f32 v9, v9, v194
    v_add_f32 v9, v9, v195
    v_cvt_pk_bf16_f32 v51, v194, v195
    v_exp_f32 v196, v196
    v_exp_f32 v197, v197
    v_add_f32 v10, v10, v196
    v_add_f32 v10, v10, v197
    v_cvt_pk_bf16_f32 v54, v196, v197
    v_exp_f32 v198, v198
    v_exp_f32 v199, v199
    v_add_f32 v10, v10, v198
    v_add_f32 v10, v10, v199
    v_cvt_pk_bf16_f32 v55, v198, v199
    s_mov_b32 s17, 0x8000
    buffer_load_dwordx4 v[200:203], v8, s[8:11], s17 offen offset:0
    buffer_load_dwordx4 v[204:207], v8, s[8:11], s17 offen offset:1024
    buffer_load_dwordx4 v[208:211], v8, s[8:11], s17 offen offset:2048
    buffer_load_dwordx4 v[212:215], v8, s[8:11], s17 offen offset:3072
    s_waitcnt vmcnt(3)
    v_mfma_f32_16x16x32_bf16 v[184:187], v[200:203], v[152:155], v[216:219]
    v_mfma_f32_16x16x32_bf16 v[188:191], v[200:203], v[168:171], v[220:223]
    s_waitcnt vmcnt(2)
    v_mfma_f32_16x16x32_bf16 v[192:195], v[204:207], v[152:155], v[216:219]
    v_mfma_f32_16x16x32_bf16 v[196:199], v[204:207], v[168:171], v[220:223]
    s_waitcnt vmcnt(1)
    v_mfma_f32_16x16x32_bf16 v[184:187], v[208:211], v[156:159], v[184:187]
    v_mfma_f32_16x16x32_bf16 v[188:191], v[208:211], v[172:175], v[188:191]
    s_waitcnt vmcnt(0)
    v_mfma_f32_16x16x32_bf16 v[192:195], v[212:215], v[156:159], v[192:195]
    v_mfma_f32_16x16x32_bf16 v[196:199], v[212:215], v[172:175], v[196:199]
    s_mov_b32 s17, 0x9000
    buffer_load_dwordx4 v[200:203], v8, s[8:11], s17 offen offset:0
    buffer_load_dwordx4 v[204:207], v8, s[8:11], s17 offen offset:1024
    buffer_load_dwordx4 v[208:211], v8, s[8:11], s17 offen offset:2048
    buffer_load_dwordx4 v[212:215], v8, s[8:11], s17 offen offset:3072
    s_waitcnt vmcnt(3)
    v_mfma_f32_16x16x32_bf16 v[184:187], v[200:203], v[160:163], v[184:187]
    v_mfma_f32_16x16x32_bf16 v[188:191], v[200:203], v[176:179], v[188:191]
    s_waitcnt vmcnt(2)
    v_mfma_f32_16x16x32_bf16 v[192:195], v[204:207], v[160:163], v[192:195]
    v_mfma_f32_16x16x32_bf16 v[196:199], v[204:207], v[176:179], v[196:199]
    s_waitcnt vmcnt(1)
    v_mfma_f32_16x16x32_bf16 v[184:187], v[208:211], v[164:167], v[184:187]
    v_mfma_f32_16x16x32_bf16 v[188:191], v[208:211], v[180:183], v[188:191]
    s_waitcnt vmcnt(0)
    v_mfma_f32_16x16x32_bf16 v[192:195], v[212:215], v[164:167], v[192:195]
    v_mfma_f32_16x16x32_bf16 v[196:199], v[212:215], v[180:183], v[196:199]
    s_nop 3
    v_exp_f32 v184, v184
    v_exp_f32 v185, v185
    v_add_f32 v9, v9, v184
    v_add_f32 v9, v9, v185
    v_cvt_pk_bf16_f32 v56, v184, v185
    v_exp_f32 v186, v186
    v_exp_f32 v187, v187
    v_add_f32 v9, v9, v186
    v_add_f32 v9, v9, v187
    v_cvt_pk_bf16_f32 v57, v186, v187
    v_exp_f32 v188, v188
    v_exp_f32 v189, v189
    v_add_f32 v10, v10, v188
    v_add_f32 v10, v10, v189
    v_cvt_pk_bf16_f32 v60, v188, v189
    v_exp_f32 v190, v190
    v_exp_f32 v191, v191
    v_add_f32 v10, v10, v190
    v_add_f32 v10, v10, v191
    v_cvt_pk_bf16_f32 v61, v190, v191
    v_exp_f32 v192, v192
    v_exp_f32 v193, v193
    v_add_f32 v9, v9, v192
    v_add_f32 v9, v9, v193
    v_cvt_pk_bf16_f32 v58, v192, v193
    v_exp_f32 v194, v194
    v_exp_f32 v195, v195
    v_add_f32 v9, v9, v194
    v_add_f32 v9, v9, v195
    v_cvt_pk_bf16_f32 v59, v194, v195
    v_exp_f32 v196, v196
    v_exp_f32 v197, v197
    v_add_f32 v10, v10, v196
    v_add_f32 v10, v10, v197
    v_cvt_pk_bf16_f32 v62, v196, v197
    v_exp_f32 v198, v198
    v_exp_f32 v199, v199
    v_add_f32 v10, v10, v198
    v_add_f32 v10, v10, v199
    v_cvt_pk_bf16_f32 v63, v198, v199
    s_mov_b32 s17, 0xa000
    buffer_load_dwordx4 v[200:203], v8, s[8:11], s17 offen offset:0
    buffer_load_dwordx4 v[204:207], v8, s[8:11], s17 offen offset:1024
    buffer_load_dwordx4 v[208:211], v8, s[8:11], s17 offen offset:2048
    buffer_load_dwordx4 v[212:215], v8, s[8:11], s17 offen offset:3072
    s_waitcnt vmcnt(3)
    v_mfma_f32_16x16x32_bf16 v[184:187], v[200:203], v[152:155], v[216:219]
    v_mfma_f32_16x16x32_bf16 v[188:191], v[200:203], v[168:171], v[220:223]
    s_waitcnt vmcnt(2)
    v_mfma_f32_16x16x32_bf16 v[192:195], v[204:207], v[152:155], v[216:219]
    v_mfma_f32_16x16x32_bf16 v[196:199], v[204:207], v[168:171], v[220:223]
    s_waitcnt vmcnt(1)
    v_mfma_f32_16x16x32_bf16 v[184:187], v[208:211], v[156:159], v[184:187]
    v_mfma_f32_16x16x32_bf16 v[188:191], v[208:211], v[172:175], v[188:191]
    s_waitcnt vmcnt(0)
    v_mfma_f32_16x16x32_bf16 v[192:195], v[212:215], v[156:159], v[192:195]
    v_mfma_f32_16x16x32_bf16 v[196:199], v[212:215], v[172:175], v[196:199]
    s_mov_b32 s17, 0xb000
    buffer_load_dwordx4 v[200:203], v8, s[8:11], s17 offen offset:0
    buffer_load_dwordx4 v[204:207], v8, s[8:11], s17 offen offset:1024
    buffer_load_dwordx4 v[208:211], v8, s[8:11], s17 offen offset:2048
    buffer_load_dwordx4 v[212:215], v8, s[8:11], s17 offen offset:3072
    s_waitcnt vmcnt(3)
    v_mfma_f32_16x16x32_bf16 v[184:187], v[200:203], v[160:163], v[184:187]
    v_mfma_f32_16x16x32_bf16 v[188:191], v[200:203], v[176:179], v[188:191]
    s_waitcnt vmcnt(2)
    v_mfma_f32_16x16x32_bf16 v[192:195], v[204:207], v[160:163], v[192:195]
    v_mfma_f32_16x16x32_bf16 v[196:199], v[204:207], v[176:179], v[196:199]
    s_waitcnt vmcnt(1)
    v_mfma_f32_16x16x32_bf16 v[184:187], v[208:211], v[164:167], v[184:187]
    v_mfma_f32_16x16x32_bf16 v[188:191], v[208:211], v[180:183], v[188:191]
    s_waitcnt vmcnt(0)
    v_mfma_f32_16x16x32_bf16 v[192:195], v[212:215], v[164:167], v[192:195]
    v_mfma_f32_16x16x32_bf16 v[196:199], v[212:215], v[180:183], v[196:199]
    s_nop 3
    v_exp_f32 v184, v184
    v_exp_f32 v185, v185
    v_add_f32 v9, v9, v184
    v_add_f32 v9, v9, v185
    v_cvt_pk_bf16_f32 v64, v184, v185
    v_exp_f32 v186, v186
    v_exp_f32 v187, v187
    v_add_f32 v9, v9, v186
    v_add_f32 v9, v9, v187
    v_cvt_pk_bf16_f32 v65, v186, v187
    v_exp_f32 v188, v188
    v_exp_f32 v189, v189
    v_add_f32 v10, v10, v188
    v_add_f32 v10, v10, v189
    v_cvt_pk_bf16_f32 v68, v188, v189
    v_exp_f32 v190, v190
    v_exp_f32 v191, v191
    v_add_f32 v10, v10, v190
    v_add_f32 v10, v10, v191
    v_cvt_pk_bf16_f32 v69, v190, v191
    v_exp_f32 v192, v192
    v_exp_f32 v193, v193
    v_add_f32 v9, v9, v192
    v_add_f32 v9, v9, v193
    v_cvt_pk_bf16_f32 v66, v192, v193
    v_exp_f32 v194, v194
    v_exp_f32 v195, v195
    v_add_f32 v9, v9, v194
    v_add_f32 v9, v9, v195
    v_cvt_pk_bf16_f32 v67, v194, v195
    v_exp_f32 v196, v196
    v_exp_f32 v197, v197
    v_add_f32 v10, v10, v196
    v_add_f32 v10, v10, v197
    v_cvt_pk_bf16_f32 v70, v196, v197
    v_exp_f32 v198, v198
    v_exp_f32 v199, v199
    v_add_f32 v10, v10, v198
    v_add_f32 v10, v10, v199
    v_cvt_pk_bf16_f32 v71, v198, v199
    s_mov_b32 s17, 0xc000
    buffer_load_dwordx4 v[200:203], v8, s[8:11], s17 offen offset:0
    buffer_load_dwordx4 v[204:207], v8, s[8:11], s17 offen offset:1024
    buffer_load_dwordx4 v[208:211], v8, s[8:11], s17 offen offset:2048
    buffer_load_dwordx4 v[212:215], v8, s[8:11], s17 offen offset:3072
    s_waitcnt vmcnt(3)
    v_mfma_f32_16x16x32_bf16 v[184:187], v[200:203], v[152:155], v[216:219]
    v_mfma_f32_16x16x32_bf16 v[188:191], v[200:203], v[168:171], v[220:223]
    s_waitcnt vmcnt(2)
    v_mfma_f32_16x16x32_bf16 v[192:195], v[204:207], v[152:155], v[216:219]
    v_mfma_f32_16x16x32_bf16 v[196:199], v[204:207], v[168:171], v[220:223]
    s_waitcnt vmcnt(1)
    v_mfma_f32_16x16x32_bf16 v[184:187], v[208:211], v[156:159], v[184:187]
    v_mfma_f32_16x16x32_bf16 v[188:191], v[208:211], v[172:175], v[188:191]
    s_waitcnt vmcnt(0)
    v_mfma_f32_16x16x32_bf16 v[192:195], v[212:215], v[156:159], v[192:195]
    v_mfma_f32_16x16x32_bf16 v[196:199], v[212:215], v[172:175], v[196:199]
    s_mov_b32 s17, 0xd000
    buffer_load_dwordx4 v[200:203], v8, s[8:11], s17 offen offset:0
    buffer_load_dwordx4 v[204:207], v8, s[8:11], s17 offen offset:1024
    buffer_load_dwordx4 v[208:211], v8, s[8:11], s17 offen offset:2048
    buffer_load_dwordx4 v[212:215], v8, s[8:11], s17 offen offset:3072
    s_waitcnt vmcnt(3)
    v_mfma_f32_16x16x32_bf16 v[184:187], v[200:203], v[160:163], v[184:187]
    v_mfma_f32_16x16x32_bf16 v[188:191], v[200:203], v[176:179], v[188:191]
    s_waitcnt vmcnt(2)
    v_mfma_f32_16x16x32_bf16 v[192:195], v[204:207], v[160:163], v[192:195]
    v_mfma_f32_16x16x32_bf16 v[196:199], v[204:207], v[176:179], v[196:199]
    s_waitcnt vmcnt(1)
    v_mfma_f32_16x16x32_bf16 v[184:187], v[208:211], v[164:167], v[184:187]
    v_mfma_f32_16x16x32_bf16 v[188:191], v[208:211], v[180:183], v[188:191]
    s_waitcnt vmcnt(0)
    v_mfma_f32_16x16x32_bf16 v[192:195], v[212:215], v[164:167], v[192:195]
    v_mfma_f32_16x16x32_bf16 v[196:199], v[212:215], v[180:183], v[196:199]
    s_nop 3
    v_exp_f32 v184, v184
    v_exp_f32 v185, v185
    v_add_f32 v9, v9, v184
    v_add_f32 v9, v9, v185
    v_cvt_pk_bf16_f32 v72, v184, v185
    v_exp_f32 v186, v186
    v_exp_f32 v187, v187
    v_add_f32 v9, v9, v186
    v_add_f32 v9, v9, v187
    v_cvt_pk_bf16_f32 v73, v186, v187
    v_exp_f32 v188, v188
    v_exp_f32 v189, v189
    v_add_f32 v10, v10, v188
    v_add_f32 v10, v10, v189
    v_cvt_pk_bf16_f32 v76, v188, v189
    v_exp_f32 v190, v190
    v_exp_f32 v191, v191
    v_add_f32 v10, v10, v190
    v_add_f32 v10, v10, v191
    v_cvt_pk_bf16_f32 v77, v190, v191
    v_exp_f32 v192, v192
    v_exp_f32 v193, v193
    v_add_f32 v9, v9, v192
    v_add_f32 v9, v9, v193
    v_cvt_pk_bf16_f32 v74, v192, v193
    v_exp_f32 v194, v194
    v_exp_f32 v195, v195
    v_add_f32 v9, v9, v194
    v_add_f32 v9, v9, v195
    v_cvt_pk_bf16_f32 v75, v194, v195
    v_exp_f32 v196, v196
    v_exp_f32 v197, v197
    v_add_f32 v10, v10, v196
    v_add_f32 v10, v10, v197
    v_cvt_pk_bf16_f32 v78, v196, v197
    v_exp_f32 v198, v198
    v_exp_f32 v199, v199
    v_add_f32 v10, v10, v198
    v_add_f32 v10, v10, v199
    v_cvt_pk_bf16_f32 v79, v198, v199
    s_mov_b32 s17, 0xe000
    buffer_load_dwordx4 v[200:203], v8, s[8:11], s17 offen offset:0
    buffer_load_dwordx4 v[204:207], v8, s[8:11], s17 offen offset:1024
    buffer_load_dwordx4 v[208:211], v8, s[8:11], s17 offen offset:2048
    buffer_load_dwordx4 v[212:215], v8, s[8:11], s17 offen offset:3072
    s_waitcnt vmcnt(3)
    v_mfma_f32_16x16x32_bf16 v[184:187], v[200:203], v[152:155], v[216:219]
    v_mfma_f32_16x16x32_bf16 v[188:191], v[200:203], v[168:171], v[220:223]
    s_waitcnt vmcnt(2)
    v_mfma_f32_16x16x32_bf16 v[192:195], v[204:207], v[152:155], v[216:219]
    v_mfma_f32_16x16x32_bf16 v[196:199], v[204:207], v[168:171], v[220:223]
    s_waitcnt vmcnt(1)
    v_mfma_f32_16x16x32_bf16 v[184:187], v[208:211], v[156:159], v[184:187]
    v_mfma_f32_16x16x32_bf16 v[188:191], v[208:211], v[172:175], v[188:191]
    s_waitcnt vmcnt(0)
    v_mfma_f32_16x16x32_bf16 v[192:195], v[212:215], v[156:159], v[192:195]
    v_mfma_f32_16x16x32_bf16 v[196:199], v[212:215], v[172:175], v[196:199]
    s_mov_b32 s17, 0xf000
    buffer_load_dwordx4 v[200:203], v8, s[8:11], s17 offen offset:0
    buffer_load_dwordx4 v[204:207], v8, s[8:11], s17 offen offset:1024
    buffer_load_dwordx4 v[208:211], v8, s[8:11], s17 offen offset:2048
    buffer_load_dwordx4 v[212:215], v8, s[8:11], s17 offen offset:3072
    s_waitcnt vmcnt(3)
    v_mfma_f32_16x16x32_bf16 v[184:187], v[200:203], v[160:163], v[184:187]
    v_mfma_f32_16x16x32_bf16 v[188:191], v[200:203], v[176:179], v[188:191]
    s_waitcnt vmcnt(2)
    v_mfma_f32_16x16x32_bf16 v[192:195], v[204:207], v[160:163], v[192:195]
    v_mfma_f32_16x16x32_bf16 v[196:199], v[204:207], v[176:179], v[196:199]
    s_waitcnt vmcnt(1)
    v_mfma_f32_16x16x32_bf16 v[184:187], v[208:211], v[164:167], v[184:187]
    v_mfma_f32_16x16x32_bf16 v[188:191], v[208:211], v[180:183], v[188:191]
    s_waitcnt vmcnt(0)
    v_mfma_f32_16x16x32_bf16 v[192:195], v[212:215], v[164:167], v[192:195]
    v_mfma_f32_16x16x32_bf16 v[196:199], v[212:215], v[180:183], v[196:199]
    s_nop 3
    v_exp_f32 v184, v184
    v_exp_f32 v185, v185
    v_add_f32 v9, v9, v184
    v_add_f32 v9, v9, v185
    v_cvt_pk_bf16_f32 v80, v184, v185
    v_exp_f32 v186, v186
    v_exp_f32 v187, v187
    v_add_f32 v9, v9, v186
    v_add_f32 v9, v9, v187
    v_cvt_pk_bf16_f32 v81, v186, v187
    v_exp_f32 v188, v188
    v_exp_f32 v189, v189
    v_add_f32 v10, v10, v188
    v_add_f32 v10, v10, v189
    v_cvt_pk_bf16_f32 v84, v188, v189
    v_exp_f32 v190, v190
    v_exp_f32 v191, v191
    v_add_f32 v10, v10, v190
    v_add_f32 v10, v10, v191
    v_cvt_pk_bf16_f32 v85, v190, v191
    v_exp_f32 v192, v192
    v_exp_f32 v193, v193
    v_add_f32 v9, v9, v192
    v_add_f32 v9, v9, v193
    v_cvt_pk_bf16_f32 v82, v192, v193
    v_exp_f32 v194, v194
    v_exp_f32 v195, v195
    v_add_f32 v9, v9, v194
    v_add_f32 v9, v9, v195
    v_cvt_pk_bf16_f32 v83, v194, v195
    v_exp_f32 v196, v196
    v_exp_f32 v197, v197
    v_add_f32 v10, v10, v196
    v_add_f32 v10, v10, v197
    v_cvt_pk_bf16_f32 v86, v196, v197
    v_exp_f32 v198, v198
    v_exp_f32 v199, v199
    v_add_f32 v10, v10, v198
    v_add_f32 v10, v10, v199
    v_cvt_pk_bf16_f32 v87, v198, v199
    s_mov_b32 s17, 0x10000
    buffer_load_dwordx4 v[200:203], v8, s[8:11], s17 offen offset:0
    buffer_load_dwordx4 v[204:207], v8, s[8:11], s17 offen offset:1024
    buffer_load_dwordx4 v[208:211], v8, s[8:11], s17 offen offset:2048
    buffer_load_dwordx4 v[212:215], v8, s[8:11], s17 offen offset:3072
    s_waitcnt vmcnt(3)
    v_mfma_f32_16x16x32_bf16 v[184:187], v[200:203], v[152:155], v[216:219]
    v_mfma_f32_16x16x32_bf16 v[188:191], v[200:203], v[168:171], v[220:223]
    s_waitcnt vmcnt(2)
    v_mfma_f32_16x16x32_bf16 v[192:195], v[204:207], v[152:155], v[216:219]
    v_mfma_f32_16x16x32_bf16 v[196:199], v[204:207], v[168:171], v[220:223]
    s_waitcnt vmcnt(1)
    v_mfma_f32_16x16x32_bf16 v[184:187], v[208:211], v[156:159], v[184:187]
    v_mfma_f32_16x16x32_bf16 v[188:191], v[208:211], v[172:175], v[188:191]
    s_waitcnt vmcnt(0)
    v_mfma_f32_16x16x32_bf16 v[192:195], v[212:215], v[156:159], v[192:195]
    v_mfma_f32_16x16x32_bf16 v[196:199], v[212:215], v[172:175], v[196:199]
    s_mov_b32 s17, 0x11000
    buffer_load_dwordx4 v[200:203], v8, s[8:11], s17 offen offset:0
    buffer_load_dwordx4 v[204:207], v8, s[8:11], s17 offen offset:1024
    buffer_load_dwordx4 v[208:211], v8, s[8:11], s17 offen offset:2048
    buffer_load_dwordx4 v[212:215], v8, s[8:11], s17 offen offset:3072
    s_waitcnt vmcnt(3)
    v_mfma_f32_16x16x32_bf16 v[184:187], v[200:203], v[160:163], v[184:187]
    v_mfma_f32_16x16x32_bf16 v[188:191], v[200:203], v[176:179], v[188:191]
    s_waitcnt vmcnt(2)
    v_mfma_f32_16x16x32_bf16 v[192:195], v[204:207], v[160:163], v[192:195]
    v_mfma_f32_16x16x32_bf16 v[196:199], v[204:207], v[176:179], v[196:199]
    s_waitcnt vmcnt(1)
    v_mfma_f32_16x16x32_bf16 v[184:187], v[208:211], v[164:167], v[184:187]
    v_mfma_f32_16x16x32_bf16 v[188:191], v[208:211], v[180:183], v[188:191]
    s_waitcnt vmcnt(0)
    v_mfma_f32_16x16x32_bf16 v[192:195], v[212:215], v[164:167], v[192:195]
    v_mfma_f32_16x16x32_bf16 v[196:199], v[212:215], v[180:183], v[196:199]
    s_nop 3
    v_exp_f32 v184, v184
    v_exp_f32 v185, v185
    v_add_f32 v9, v9, v184
    v_add_f32 v9, v9, v185
    v_cvt_pk_bf16_f32 v88, v184, v185
    v_exp_f32 v186, v186
    v_exp_f32 v187, v187
    v_add_f32 v9, v9, v186
    v_add_f32 v9, v9, v187
    v_cvt_pk_bf16_f32 v89, v186, v187
    v_exp_f32 v188, v188
    v_exp_f32 v189, v189
    v_add_f32 v10, v10, v188
    v_add_f32 v10, v10, v189
    v_cvt_pk_bf16_f32 v92, v188, v189
    v_exp_f32 v190, v190
    v_exp_f32 v191, v191
    v_add_f32 v10, v10, v190
    v_add_f32 v10, v10, v191
    v_cvt_pk_bf16_f32 v93, v190, v191
    v_exp_f32 v192, v192
    v_exp_f32 v193, v193
    v_add_f32 v9, v9, v192
    v_add_f32 v9, v9, v193
    v_cvt_pk_bf16_f32 v90, v192, v193
    v_exp_f32 v194, v194
    v_exp_f32 v195, v195
    v_add_f32 v9, v9, v194
    v_add_f32 v9, v9, v195
    v_cvt_pk_bf16_f32 v91, v194, v195
    v_exp_f32 v196, v196
    v_exp_f32 v197, v197
    v_add_f32 v10, v10, v196
    v_add_f32 v10, v10, v197
    v_cvt_pk_bf16_f32 v94, v196, v197
    v_exp_f32 v198, v198
    v_exp_f32 v199, v199
    v_add_f32 v10, v10, v198
    v_add_f32 v10, v10, v199
    v_cvt_pk_bf16_f32 v95, v198, v199
    s_mov_b32 s17, 0x12000
    buffer_load_dwordx4 v[200:203], v8, s[8:11], s17 offen offset:0
    buffer_load_dwordx4 v[204:207], v8, s[8:11], s17 offen offset:1024
    buffer_load_dwordx4 v[208:211], v8, s[8:11], s17 offen offset:2048
    buffer_load_dwordx4 v[212:215], v8, s[8:11], s17 offen offset:3072
    s_waitcnt vmcnt(3)
    v_mfma_f32_16x16x32_bf16 v[184:187], v[200:203], v[152:155], v[216:219]
    v_mfma_f32_16x16x32_bf16 v[188:191], v[200:203], v[168:171], v[220:223]
    s_waitcnt vmcnt(2)
    v_mfma_f32_16x16x32_bf16 v[192:195], v[204:207], v[152:155], v[216:219]
    v_mfma_f32_16x16x32_bf16 v[196:199], v[204:207], v[168:171], v[220:223]
    s_waitcnt vmcnt(1)
    v_mfma_f32_16x16x32_bf16 v[184:187], v[208:211], v[156:159], v[184:187]
    v_mfma_f32_16x16x32_bf16 v[188:191], v[208:211], v[172:175], v[188:191]
    s_waitcnt vmcnt(0)
    v_mfma_f32_16x16x32_bf16 v[192:195], v[212:215], v[156:159], v[192:195]
    v_mfma_f32_16x16x32_bf16 v[196:199], v[212:215], v[172:175], v[196:199]
    s_mov_b32 s17, 0x13000
    buffer_load_dwordx4 v[200:203], v8, s[8:11], s17 offen offset:0
    buffer_load_dwordx4 v[204:207], v8, s[8:11], s17 offen offset:1024
    buffer_load_dwordx4 v[208:211], v8, s[8:11], s17 offen offset:2048
    buffer_load_dwordx4 v[212:215], v8, s[8:11], s17 offen offset:3072
    s_waitcnt vmcnt(3)
    v_mfma_f32_16x16x32_bf16 v[184:187], v[200:203], v[160:163], v[184:187]
    v_mfma_f32_16x16x32_bf16 v[188:191], v[200:203], v[176:179], v[188:191]
    s_waitcnt vmcnt(2)
    v_mfma_f32_16x16x32_bf16 v[192:195], v[204:207], v[160:163], v[192:195]
    v_mfma_f32_16x16x32_bf16 v[196:199], v[204:207], v[176:179], v[196:199]
    s_waitcnt vmcnt(1)
    v_mfma_f32_16x16x32_bf16 v[184:187], v[208:211], v[164:167], v[184:187]
    v_mfma_f32_16x16x32_bf16 v[188:191], v[208:211], v[180:183], v[188:191]
    s_waitcnt vmcnt(0)
    v_mfma_f32_16x16x32_bf16 v[192:195], v[212:215], v[164:167], v[192:195]
    v_mfma_f32_16x16x32_bf16 v[196:199], v[212:215], v[180:183], v[196:199]
    s_nop 3
    v_exp_f32 v184, v184
    v_exp_f32 v185, v185
    v_add_f32 v9, v9, v184
    v_add_f32 v9, v9, v185
    v_cvt_pk_bf16_f32 v96, v184, v185
    v_exp_f32 v186, v186
    v_exp_f32 v187, v187
    v_add_f32 v9, v9, v186
    v_add_f32 v9, v9, v187
    v_cvt_pk_bf16_f32 v97, v186, v187
    v_exp_f32 v188, v188
    v_exp_f32 v189, v189
    v_add_f32 v10, v10, v188
    v_add_f32 v10, v10, v189
    v_cvt_pk_bf16_f32 v100, v188, v189
    v_exp_f32 v190, v190
    v_exp_f32 v191, v191
    v_add_f32 v10, v10, v190
    v_add_f32 v10, v10, v191
    v_cvt_pk_bf16_f32 v101, v190, v191
    v_exp_f32 v192, v192
    v_exp_f32 v193, v193
    v_add_f32 v9, v9, v192
    v_add_f32 v9, v9, v193
    v_cvt_pk_bf16_f32 v98, v192, v193
    v_exp_f32 v194, v194
    v_exp_f32 v195, v195
    v_add_f32 v9, v9, v194
    v_add_f32 v9, v9, v195
    v_cvt_pk_bf16_f32 v99, v194, v195
    v_exp_f32 v196, v196
    v_exp_f32 v197, v197
    v_add_f32 v10, v10, v196
    v_add_f32 v10, v10, v197
    v_cvt_pk_bf16_f32 v102, v196, v197
    v_exp_f32 v198, v198
    v_exp_f32 v199, v199
    v_add_f32 v10, v10, v198
    v_add_f32 v10, v10, v199
    v_cvt_pk_bf16_f32 v103, v198, v199
    s_mov_b32 s17, 0x14000
    buffer_load_dwordx4 v[200:203], v8, s[8:11], s17 offen offset:0
    buffer_load_dwordx4 v[204:207], v8, s[8:11], s17 offen offset:1024
    buffer_load_dwordx4 v[208:211], v8, s[8:11], s17 offen offset:2048
    buffer_load_dwordx4 v[212:215], v8, s[8:11], s17 offen offset:3072
    s_waitcnt vmcnt(3)
    v_mfma_f32_16x16x32_bf16 v[184:187], v[200:203], v[152:155], v[216:219]
    v_mfma_f32_16x16x32_bf16 v[188:191], v[200:203], v[168:171], v[220:223]
    s_waitcnt vmcnt(2)
    v_mfma_f32_16x16x32_bf16 v[192:195], v[204:207], v[152:155], v[216:219]
    v_mfma_f32_16x16x32_bf16 v[196:199], v[204:207], v[168:171], v[220:223]
    s_waitcnt vmcnt(1)
    v_mfma_f32_16x16x32_bf16 v[184:187], v[208:211], v[156:159], v[184:187]
    v_mfma_f32_16x16x32_bf16 v[188:191], v[208:211], v[172:175], v[188:191]
    s_waitcnt vmcnt(0)
    v_mfma_f32_16x16x32_bf16 v[192:195], v[212:215], v[156:159], v[192:195]
    v_mfma_f32_16x16x32_bf16 v[196:199], v[212:215], v[172:175], v[196:199]
    s_mov_b32 s17, 0x15000
    buffer_load_dwordx4 v[200:203], v8, s[8:11], s17 offen offset:0
    buffer_load_dwordx4 v[204:207], v8, s[8:11], s17 offen offset:1024
    buffer_load_dwordx4 v[208:211], v8, s[8:11], s17 offen offset:2048
    buffer_load_dwordx4 v[212:215], v8, s[8:11], s17 offen offset:3072
    s_waitcnt vmcnt(3)
    v_mfma_f32_16x16x32_bf16 v[184:187], v[200:203], v[160:163], v[184:187]
    v_mfma_f32_16x16x32_bf16 v[188:191], v[200:203], v[176:179], v[188:191]
    s_waitcnt vmcnt(2)
    v_mfma_f32_16x16x32_bf16 v[192:195], v[204:207], v[160:163], v[192:195]
    v_mfma_f32_16x16x32_bf16 v[196:199], v[204:207], v[176:179], v[196:199]
    s_waitcnt vmcnt(1)
    v_mfma_f32_16x16x32_bf16 v[184:187], v[208:211], v[164:167], v[184:187]
    v_mfma_f32_16x16x32_bf16 v[188:191], v[208:211], v[180:183], v[188:191]
    s_waitcnt vmcnt(0)
    v_mfma_f32_16x16x32_bf16 v[192:195], v[212:215], v[164:167], v[192:195]
    v_mfma_f32_16x16x32_bf16 v[196:199], v[212:215], v[180:183], v[196:199]
    s_nop 3
    v_exp_f32 v184, v184
    v_exp_f32 v185, v185
    v_add_f32 v9, v9, v184
    v_add_f32 v9, v9, v185
    v_cvt_pk_bf16_f32 v104, v184, v185
    v_exp_f32 v186, v186
    v_exp_f32 v187, v187
    v_add_f32 v9, v9, v186
    v_add_f32 v9, v9, v187
    v_cvt_pk_bf16_f32 v105, v186, v187
    v_exp_f32 v188, v188
    v_exp_f32 v189, v189
    v_add_f32 v10, v10, v188
    v_add_f32 v10, v10, v189
    v_cvt_pk_bf16_f32 v108, v188, v189
    v_exp_f32 v190, v190
    v_exp_f32 v191, v191
    v_add_f32 v10, v10, v190
    v_add_f32 v10, v10, v191
    v_cvt_pk_bf16_f32 v109, v190, v191
    v_exp_f32 v192, v192
    v_exp_f32 v193, v193
    v_add_f32 v9, v9, v192
    v_add_f32 v9, v9, v193
    v_cvt_pk_bf16_f32 v106, v192, v193
    v_exp_f32 v194, v194
    v_exp_f32 v195, v195
    v_add_f32 v9, v9, v194
    v_add_f32 v9, v9, v195
    v_cvt_pk_bf16_f32 v107, v194, v195
    v_exp_f32 v196, v196
    v_exp_f32 v197, v197
    v_add_f32 v10, v10, v196
    v_add_f32 v10, v10, v197
    v_cvt_pk_bf16_f32 v110, v196, v197
    v_exp_f32 v198, v198
    v_exp_f32 v199, v199
    v_add_f32 v10, v10, v198
    v_add_f32 v10, v10, v199
    v_cvt_pk_bf16_f32 v111, v198, v199
    s_mov_b32 s17, 0x16000
    buffer_load_dwordx4 v[200:203], v8, s[8:11], s17 offen offset:0
    buffer_load_dwordx4 v[204:207], v8, s[8:11], s17 offen offset:1024
    buffer_load_dwordx4 v[208:211], v8, s[8:11], s17 offen offset:2048
    buffer_load_dwordx4 v[212:215], v8, s[8:11], s17 offen offset:3072
    s_waitcnt vmcnt(3)
    v_mfma_f32_16x16x32_bf16 v[184:187], v[200:203], v[152:155], v[216:219]
    v_mfma_f32_16x16x32_bf16 v[188:191], v[200:203], v[168:171], v[220:223]
    s_waitcnt vmcnt(2)
    v_mfma_f32_16x16x32_bf16 v[192:195], v[204:207], v[152:155], v[216:219]
    v_mfma_f32_16x16x32_bf16 v[196:199], v[204:207], v[168:171], v[220:223]
    s_waitcnt vmcnt(1)
    v_mfma_f32_16x16x32_bf16 v[184:187], v[208:211], v[156:159], v[184:187]
    v_mfma_f32_16x16x32_bf16 v[188:191], v[208:211], v[172:175], v[188:191]
    s_waitcnt vmcnt(0)
    v_mfma_f32_16x16x32_bf16 v[192:195], v[212:215], v[156:159], v[192:195]
    v_mfma_f32_16x16x32_bf16 v[196:199], v[212:215], v[172:175], v[196:199]
    s_mov_b32 s17, 0x17000
    buffer_load_dwordx4 v[200:203], v8, s[8:11], s17 offen offset:0
    buffer_load_dwordx4 v[204:207], v8, s[8:11], s17 offen offset:1024
    buffer_load_dwordx4 v[208:211], v8, s[8:11], s17 offen offset:2048
    buffer_load_dwordx4 v[212:215], v8, s[8:11], s17 offen offset:3072
    s_waitcnt vmcnt(3)
    v_mfma_f32_16x16x32_bf16 v[184:187], v[200:203], v[160:163], v[184:187]
    v_mfma_f32_16x16x32_bf16 v[188:191], v[200:203], v[176:179], v[188:191]
    s_waitcnt vmcnt(2)
    v_mfma_f32_16x16x32_bf16 v[192:195], v[204:207], v[160:163], v[192:195]
    v_mfma_f32_16x16x32_bf16 v[196:199], v[204:207], v[176:179], v[196:199]
    s_waitcnt vmcnt(1)
    v_mfma_f32_16x16x32_bf16 v[184:187], v[208:211], v[164:167], v[184:187]
    v_mfma_f32_16x16x32_bf16 v[188:191], v[208:211], v[180:183], v[188:191]
    s_waitcnt vmcnt(0)
    v_mfma_f32_16x16x32_bf16 v[192:195], v[212:215], v[164:167], v[192:195]
    v_mfma_f32_16x16x32_bf16 v[196:199], v[212:215], v[180:183], v[196:199]
    s_nop 3
    v_exp_f32 v184, v184
    v_exp_f32 v185, v185
    v_add_f32 v9, v9, v184
    v_add_f32 v9, v9, v185
    v_cvt_pk_bf16_f32 v112, v184, v185
    v_exp_f32 v186, v186
    v_exp_f32 v187, v187
    v_add_f32 v9, v9, v186
    v_add_f32 v9, v9, v187
    v_cvt_pk_bf16_f32 v113, v186, v187
    v_exp_f32 v188, v188
    v_exp_f32 v189, v189
    v_add_f32 v10, v10, v188
    v_add_f32 v10, v10, v189
    v_cvt_pk_bf16_f32 v116, v188, v189
    v_exp_f32 v190, v190
    v_exp_f32 v191, v191
    v_add_f32 v10, v10, v190
    v_add_f32 v10, v10, v191
    v_cvt_pk_bf16_f32 v117, v190, v191
    v_exp_f32 v192, v192
    v_exp_f32 v193, v193
    v_add_f32 v9, v9, v192
    v_add_f32 v9, v9, v193
    v_cvt_pk_bf16_f32 v114, v192, v193
    v_exp_f32 v194, v194
    v_exp_f32 v195, v195
    v_add_f32 v9, v9, v194
    v_add_f32 v9, v9, v195
    v_cvt_pk_bf16_f32 v115, v194, v195
    v_exp_f32 v196, v196
    v_exp_f32 v197, v197
    v_add_f32 v10, v10, v196
    v_add_f32 v10, v10, v197
    v_cvt_pk_bf16_f32 v118, v196, v197
    v_exp_f32 v198, v198
    v_exp_f32 v199, v199
    v_add_f32 v10, v10, v198
    v_add_f32 v10, v10, v199
    v_cvt_pk_bf16_f32 v119, v198, v199
    s_mov_b32 s17, 0x18000
    buffer_load_dwordx4 v[200:203], v8, s[8:11], s17 offen offset:0
    buffer_load_dwordx4 v[204:207], v8, s[8:11], s17 offen offset:1024
    buffer_load_dwordx4 v[208:211], v8, s[8:11], s17 offen offset:2048
    buffer_load_dwordx4 v[212:215], v8, s[8:11], s17 offen offset:3072
    s_waitcnt vmcnt(3)
    v_mfma_f32_16x16x32_bf16 v[184:187], v[200:203], v[152:155], v[216:219]
    v_mfma_f32_16x16x32_bf16 v[188:191], v[200:203], v[168:171], v[220:223]
    s_waitcnt vmcnt(2)
    v_mfma_f32_16x16x32_bf16 v[192:195], v[204:207], v[152:155], v[216:219]
    v_mfma_f32_16x16x32_bf16 v[196:199], v[204:207], v[168:171], v[220:223]
    s_waitcnt vmcnt(1)
    v_mfma_f32_16x16x32_bf16 v[184:187], v[208:211], v[156:159], v[184:187]
    v_mfma_f32_16x16x32_bf16 v[188:191], v[208:211], v[172:175], v[188:191]
    s_waitcnt vmcnt(0)
    v_mfma_f32_16x16x32_bf16 v[192:195], v[212:215], v[156:159], v[192:195]
    v_mfma_f32_16x16x32_bf16 v[196:199], v[212:215], v[172:175], v[196:199]
    s_mov_b32 s17, 0x19000
    buffer_load_dwordx4 v[200:203], v8, s[8:11], s17 offen offset:0
    buffer_load_dwordx4 v[204:207], v8, s[8:11], s17 offen offset:1024
    buffer_load_dwordx4 v[208:211], v8, s[8:11], s17 offen offset:2048
    buffer_load_dwordx4 v[212:215], v8, s[8:11], s17 offen offset:3072
    s_waitcnt vmcnt(3)
    v_mfma_f32_16x16x32_bf16 v[184:187], v[200:203], v[160:163], v[184:187]
    v_mfma_f32_16x16x32_bf16 v[188:191], v[200:203], v[176:179], v[188:191]
    s_waitcnt vmcnt(2)
    v_mfma_f32_16x16x32_bf16 v[192:195], v[204:207], v[160:163], v[192:195]
    v_mfma_f32_16x16x32_bf16 v[196:199], v[204:207], v[176:179], v[196:199]
    s_waitcnt vmcnt(1)
    v_mfma_f32_16x16x32_bf16 v[184:187], v[208:211], v[164:167], v[184:187]
    v_mfma_f32_16x16x32_bf16 v[188:191], v[208:211], v[180:183], v[188:191]
    s_waitcnt vmcnt(0)
    v_mfma_f32_16x16x32_bf16 v[192:195], v[212:215], v[164:167], v[192:195]
    v_mfma_f32_16x16x32_bf16 v[196:199], v[212:215], v[180:183], v[196:199]
    s_nop 3
    v_exp_f32 v184, v184
    v_exp_f32 v185, v185
    v_add_f32 v9, v9, v184
    v_add_f32 v9, v9, v185
    v_cvt_pk_bf16_f32 v120, v184, v185
    v_exp_f32 v186, v186
    v_exp_f32 v187, v187
    v_add_f32 v9, v9, v186
    v_add_f32 v9, v9, v187
    v_cvt_pk_bf16_f32 v121, v186, v187
    v_exp_f32 v188, v188
    v_exp_f32 v189, v189
    v_add_f32 v10, v10, v188
    v_add_f32 v10, v10, v189
    v_cvt_pk_bf16_f32 v124, v188, v189
    v_exp_f32 v190, v190
    v_exp_f32 v191, v191
    v_add_f32 v10, v10, v190
    v_add_f32 v10, v10, v191
    v_cvt_pk_bf16_f32 v125, v190, v191
    v_exp_f32 v192, v192
    v_exp_f32 v193, v193
    v_add_f32 v9, v9, v192
    v_add_f32 v9, v9, v193
    v_cvt_pk_bf16_f32 v122, v192, v193
    v_exp_f32 v194, v194
    v_exp_f32 v195, v195
    v_add_f32 v9, v9, v194
    v_add_f32 v9, v9, v195
    v_cvt_pk_bf16_f32 v123, v194, v195
    v_exp_f32 v196, v196
    v_exp_f32 v197, v197
    v_add_f32 v10, v10, v196
    v_add_f32 v10, v10, v197
    v_cvt_pk_bf16_f32 v126, v196, v197
    v_exp_f32 v198, v198
    v_exp_f32 v199, v199
    v_add_f32 v10, v10, v198
    v_add_f32 v10, v10, v199
    v_cvt_pk_bf16_f32 v127, v198, v199
    s_mov_b32 s17, 0x1a000
    buffer_load_dwordx4 v[200:203], v8, s[8:11], s17 offen offset:0
    buffer_load_dwordx4 v[204:207], v8, s[8:11], s17 offen offset:1024
    buffer_load_dwordx4 v[208:211], v8, s[8:11], s17 offen offset:2048
    buffer_load_dwordx4 v[212:215], v8, s[8:11], s17 offen offset:3072
    s_waitcnt vmcnt(3)
    v_mfma_f32_16x16x32_bf16 v[184:187], v[200:203], v[152:155], v[216:219]
    v_mfma_f32_16x16x32_bf16 v[188:191], v[200:203], v[168:171], v[220:223]
    s_waitcnt vmcnt(2)
    v_mfma_f32_16x16x32_bf16 v[192:195], v[204:207], v[152:155], v[216:219]
    v_mfma_f32_16x16x32_bf16 v[196:199], v[204:207], v[168:171], v[220:223]
    s_waitcnt vmcnt(1)
    v_mfma_f32_16x16x32_bf16 v[184:187], v[208:211], v[156:159], v[184:187]
    v_mfma_f32_16x16x32_bf16 v[188:191], v[208:211], v[172:175], v[188:191]
    s_waitcnt vmcnt(0)
    v_mfma_f32_16x16x32_bf16 v[192:195], v[212:215], v[156:159], v[192:195]
    v_mfma_f32_16x16x32_bf16 v[196:199], v[212:215], v[172:175], v[196:199]
    s_mov_b32 s17, 0x1b000
    buffer_load_dwordx4 v[200:203], v8, s[8:11], s17 offen offset:0
    buffer_load_dwordx4 v[204:207], v8, s[8:11], s17 offen offset:1024
    buffer_load_dwordx4 v[208:211], v8, s[8:11], s17 offen offset:2048
    buffer_load_dwordx4 v[212:215], v8, s[8:11], s17 offen offset:3072
    s_waitcnt vmcnt(3)
    v_mfma_f32_16x16x32_bf16 v[184:187], v[200:203], v[160:163], v[184:187]
    v_mfma_f32_16x16x32_bf16 v[188:191], v[200:203], v[176:179], v[188:191]
    s_waitcnt vmcnt(2)
    v_mfma_f32_16x16x32_bf16 v[192:195], v[204:207], v[160:163], v[192:195]
    v_mfma_f32_16x16x32_bf16 v[196:199], v[204:207], v[176:179], v[196:199]
    s_waitcnt vmcnt(1)
    v_mfma_f32_16x16x32_bf16 v[184:187], v[208:211], v[164:167], v[184:187]
    v_mfma_f32_16x16x32_bf16 v[188:191], v[208:211], v[180:183], v[188:191]
    s_waitcnt vmcnt(0)
    v_mfma_f32_16x16x32_bf16 v[192:195], v[212:215], v[164:167], v[192:195]
    v_mfma_f32_16x16x32_bf16 v[196:199], v[212:215], v[180:183], v[196:199]
    s_nop 3
    v_exp_f32 v184, v184
    v_exp_f32 v185, v185
    v_add_f32 v9, v9, v184
    v_add_f32 v9, v9, v185
    v_cvt_pk_bf16_f32 v128, v184, v185
    v_exp_f32 v186, v186
    v_exp_f32 v187, v187
    v_add_f32 v9, v9, v186
    v_add_f32 v9, v9, v187
    v_cvt_pk_bf16_f32 v129, v186, v187
    v_exp_f32 v188, v188
    v_exp_f32 v189, v189
    v_add_f32 v10, v10, v188
    v_add_f32 v10, v10, v189
    v_cvt_pk_bf16_f32 v132, v188, v189
    v_exp_f32 v190, v190
    v_exp_f32 v191, v191
    v_add_f32 v10, v10, v190
    v_add_f32 v10, v10, v191
    v_cvt_pk_bf16_f32 v133, v190, v191
    v_exp_f32 v192, v192
    v_exp_f32 v193, v193
    v_add_f32 v9, v9, v192
    v_add_f32 v9, v9, v193
    v_cvt_pk_bf16_f32 v130, v192, v193
    v_exp_f32 v194, v194
    v_exp_f32 v195, v195
    v_add_f32 v9, v9, v194
    v_add_f32 v9, v9, v195
    v_cvt_pk_bf16_f32 v131, v194, v195
    v_exp_f32 v196, v196
    v_exp_f32 v197, v197
    v_add_f32 v10, v10, v196
    v_add_f32 v10, v10, v197
    v_cvt_pk_bf16_f32 v134, v196, v197
    v_exp_f32 v198, v198
    v_exp_f32 v199, v199
    v_add_f32 v10, v10, v198
    v_add_f32 v10, v10, v199
    v_cvt_pk_bf16_f32 v135, v198, v199
    s_mov_b32 s17, 0x1c000
    buffer_load_dwordx4 v[200:203], v8, s[8:11], s17 offen offset:0
    buffer_load_dwordx4 v[204:207], v8, s[8:11], s17 offen offset:1024
    buffer_load_dwordx4 v[208:211], v8, s[8:11], s17 offen offset:2048
    buffer_load_dwordx4 v[212:215], v8, s[8:11], s17 offen offset:3072
    s_waitcnt vmcnt(3)
    v_mfma_f32_16x16x32_bf16 v[184:187], v[200:203], v[152:155], v[216:219]
    v_mfma_f32_16x16x32_bf16 v[188:191], v[200:203], v[168:171], v[220:223]
    s_waitcnt vmcnt(2)
    v_mfma_f32_16x16x32_bf16 v[192:195], v[204:207], v[152:155], v[216:219]
    v_mfma_f32_16x16x32_bf16 v[196:199], v[204:207], v[168:171], v[220:223]
    s_waitcnt vmcnt(1)
    v_mfma_f32_16x16x32_bf16 v[184:187], v[208:211], v[156:159], v[184:187]
    v_mfma_f32_16x16x32_bf16 v[188:191], v[208:211], v[172:175], v[188:191]
    s_waitcnt vmcnt(0)
    v_mfma_f32_16x16x32_bf16 v[192:195], v[212:215], v[156:159], v[192:195]
    v_mfma_f32_16x16x32_bf16 v[196:199], v[212:215], v[172:175], v[196:199]
    s_mov_b32 s17, 0x1d000
    buffer_load_dwordx4 v[200:203], v8, s[8:11], s17 offen offset:0
    buffer_load_dwordx4 v[204:207], v8, s[8:11], s17 offen offset:1024
    buffer_load_dwordx4 v[208:211], v8, s[8:11], s17 offen offset:2048
    buffer_load_dwordx4 v[212:215], v8, s[8:11], s17 offen offset:3072
    s_waitcnt vmcnt(3)
    v_mfma_f32_16x16x32_bf16 v[184:187], v[200:203], v[160:163], v[184:187]
    v_mfma_f32_16x16x32_bf16 v[188:191], v[200:203], v[176:179], v[188:191]
    s_waitcnt vmcnt(2)
    v_mfma_f32_16x16x32_bf16 v[192:195], v[204:207], v[160:163], v[192:195]
    v_mfma_f32_16x16x32_bf16 v[196:199], v[204:207], v[176:179], v[196:199]
    s_waitcnt vmcnt(1)
    v_mfma_f32_16x16x32_bf16 v[184:187], v[208:211], v[164:167], v[184:187]
    v_mfma_f32_16x16x32_bf16 v[188:191], v[208:211], v[180:183], v[188:191]
    s_waitcnt vmcnt(0)
    v_mfma_f32_16x16x32_bf16 v[192:195], v[212:215], v[164:167], v[192:195]
    v_mfma_f32_16x16x32_bf16 v[196:199], v[212:215], v[180:183], v[196:199]
    s_nop 3
    v_exp_f32 v184, v184
    v_exp_f32 v185, v185
    v_add_f32 v9, v9, v184
    v_add_f32 v9, v9, v185
    v_cvt_pk_bf16_f32 v136, v184, v185
    v_exp_f32 v186, v186
    v_exp_f32 v187, v187
    v_add_f32 v9, v9, v186
    v_add_f32 v9, v9, v187
    v_cvt_pk_bf16_f32 v137, v186, v187
    v_exp_f32 v188, v188
    v_exp_f32 v189, v189
    v_add_f32 v10, v10, v188
    v_add_f32 v10, v10, v189
    v_cvt_pk_bf16_f32 v140, v188, v189
    v_exp_f32 v190, v190
    v_exp_f32 v191, v191
    v_add_f32 v10, v10, v190
    v_add_f32 v10, v10, v191
    v_cvt_pk_bf16_f32 v141, v190, v191
    v_exp_f32 v192, v192
    v_exp_f32 v193, v193
    v_add_f32 v9, v9, v192
    v_add_f32 v9, v9, v193
    v_cvt_pk_bf16_f32 v138, v192, v193
    v_exp_f32 v194, v194
    v_exp_f32 v195, v195
    v_add_f32 v9, v9, v194
    v_add_f32 v9, v9, v195
    v_cvt_pk_bf16_f32 v139, v194, v195
    v_exp_f32 v196, v196
    v_exp_f32 v197, v197
    v_add_f32 v10, v10, v196
    v_add_f32 v10, v10, v197
    v_cvt_pk_bf16_f32 v142, v196, v197
    v_exp_f32 v198, v198
    v_exp_f32 v199, v199
    v_add_f32 v10, v10, v198
    v_add_f32 v10, v10, v199
    v_cvt_pk_bf16_f32 v143, v198, v199
    s_mov_b32 s17, 0x1e000
    buffer_load_dwordx4 v[200:203], v8, s[8:11], s17 offen offset:0
    buffer_load_dwordx4 v[204:207], v8, s[8:11], s17 offen offset:1024
    buffer_load_dwordx4 v[208:211], v8, s[8:11], s17 offen offset:2048
    buffer_load_dwordx4 v[212:215], v8, s[8:11], s17 offen offset:3072
    s_waitcnt vmcnt(3)
    v_mfma_f32_16x16x32_bf16 v[184:187], v[200:203], v[152:155], v[216:219]
    v_mfma_f32_16x16x32_bf16 v[188:191], v[200:203], v[168:171], v[220:223]
    s_waitcnt vmcnt(2)
    v_mfma_f32_16x16x32_bf16 v[192:195], v[204:207], v[152:155], v[216:219]
    v_mfma_f32_16x16x32_bf16 v[196:199], v[204:207], v[168:171], v[220:223]
    s_waitcnt vmcnt(1)
    v_mfma_f32_16x16x32_bf16 v[184:187], v[208:211], v[156:159], v[184:187]
    v_mfma_f32_16x16x32_bf16 v[188:191], v[208:211], v[172:175], v[188:191]
    s_waitcnt vmcnt(0)
    v_mfma_f32_16x16x32_bf16 v[192:195], v[212:215], v[156:159], v[192:195]
    v_mfma_f32_16x16x32_bf16 v[196:199], v[212:215], v[172:175], v[196:199]
    s_mov_b32 s17, 0x1f000
    buffer_load_dwordx4 v[200:203], v8, s[8:11], s17 offen offset:0
    buffer_load_dwordx4 v[204:207], v8, s[8:11], s17 offen offset:1024
    buffer_load_dwordx4 v[208:211], v8, s[8:11], s17 offen offset:2048
    buffer_load_dwordx4 v[212:215], v8, s[8:11], s17 offen offset:3072
    s_waitcnt vmcnt(3)
    v_mfma_f32_16x16x32_bf16 v[184:187], v[200:203], v[160:163], v[184:187]
    v_mfma_f32_16x16x32_bf16 v[188:191], v[200:203], v[176:179], v[188:191]
    s_waitcnt vmcnt(2)
    v_mfma_f32_16x16x32_bf16 v[192:195], v[204:207], v[160:163], v[192:195]
    v_mfma_f32_16x16x32_bf16 v[196:199], v[204:207], v[176:179], v[196:199]
    s_waitcnt vmcnt(1)
    v_mfma_f32_16x16x32_bf16 v[184:187], v[208:211], v[164:167], v[184:187]
    v_mfma_f32_16x16x32_bf16 v[188:191], v[208:211], v[180:183], v[188:191]
    s_waitcnt vmcnt(0)
    v_mfma_f32_16x16x32_bf16 v[192:195], v[212:215], v[164:167], v[192:195]
    v_mfma_f32_16x16x32_bf16 v[196:199], v[212:215], v[180:183], v[196:199]
    s_nop 3
    v_exp_f32 v184, v184
    v_exp_f32 v185, v185
    v_add_f32 v9, v9, v184
    v_add_f32 v9, v9, v185
    v_cvt_pk_bf16_f32 v144, v184, v185
    v_exp_f32 v186, v186
    v_exp_f32 v187, v187
    v_add_f32 v9, v9, v186
    v_add_f32 v9, v9, v187
    v_cvt_pk_bf16_f32 v145, v186, v187
    v_exp_f32 v188, v188
    v_exp_f32 v189, v189
    v_add_f32 v10, v10, v188
    v_add_f32 v10, v10, v189
    v_cvt_pk_bf16_f32 v148, v188, v189
    v_exp_f32 v190, v190
    v_exp_f32 v191, v191
    v_add_f32 v10, v10, v190
    v_add_f32 v10, v10, v191
    v_cvt_pk_bf16_f32 v149, v190, v191
    v_exp_f32 v192, v192
    v_exp_f32 v193, v193
    v_add_f32 v9, v9, v192
    v_add_f32 v9, v9, v193
    v_cvt_pk_bf16_f32 v146, v192, v193
    v_exp_f32 v194, v194
    v_exp_f32 v195, v195
    v_add_f32 v9, v9, v194
    v_add_f32 v9, v9, v195
    v_cvt_pk_bf16_f32 v147, v194, v195
    v_exp_f32 v196, v196
    v_exp_f32 v197, v197
    v_add_f32 v10, v10, v196
    v_add_f32 v10, v10, v197
    v_cvt_pk_bf16_f32 v150, v196, v197
    v_exp_f32 v198, v198
    v_exp_f32 v199, v199
    v_add_f32 v10, v10, v198
    v_add_f32 v10, v10, v199
    v_cvt_pk_bf16_f32 v151, v198, v199
    v_mov_b32 v16, v9
    v_mov_b32 v18, v10
    s_nop 0
    v_permlane16_swap_b32 v9, v16
    v_permlane16_swap_b32 v10, v18
    v_add_f32 v9, v9, v16
    v_add_f32 v10, v10, v18
    v_mov_b32 v16, v9
    v_mov_b32 v18, v10
    s_nop 0
    v_permlane32_swap_b32 v9, v16
    v_permlane32_swap_b32 v10, v18
    v_add_f32 v9, v9, v16
    v_add_f32 v10, v10, v18
    s_waitcnt vmcnt(0) lgkmcnt(0)
    s_nop 15
    s_nop 3
    s_branch adaLN_cond__sliding_block_cached__moe_arch_mod__prompt_kernel_fixAb
adaLN_cond__sliding_block_cached__moe_arch_mod__prompt_kernel_o26r:
    s_waitcnt vmcnt(0) lgkmcnt(0)
    s_nop 15
    s_nop 3
    s_mov_b32 s27, 0
adaLN_cond__sliding_block_cached__moe_arch_mod__prompt_kernel_o26p:
    buffer_load_dword v12, v13, s[8:11], s17 offen sc1
    s_waitcnt vmcnt(0)
    v_cmp_ne_u32 vcc, s28, v12
    s_add_u32 s27, s27, 1
    s_cmp_ge_u32 s27, 262144
    s_cbranch_scc1 adaLN_cond__sliding_block_cached__moe_arch_mod__prompt_kernel_o26g
    s_cbranch_vccnz adaLN_cond__sliding_block_cached__moe_arch_mod__prompt_kernel_o26p
adaLN_cond__sliding_block_cached__moe_arch_mod__prompt_kernel_o26g:
    s_waitcnt vmcnt(0) lgkmcnt(0)
    s_nop 15
    s_nop 3
    s_branch adaLN_cond__sliding_block_cached__moe_arch_mod__prompt_kernel_o26b
adaLN_cond__sliding_block_cached__moe_arch_mod__prompt_kernel_mp7r:
    s_waitcnt vmcnt(0) lgkmcnt(0)
    s_nop 15
    s_nop 3
    s_mov_b32 s27, 0
adaLN_cond__sliding_block_cached__moe_arch_mod__prompt_kernel_mp7p:
    buffer_load_dword v248, v250, s[8:11], s14 offen sc1
    s_waitcnt vmcnt(0)
    v_cmp_ne_u32 vcc, s28, v248
    s_add_u32 s27, s27, 1
    s_cmp_ge_u32 s27, 262144
    s_cbranch_scc1 adaLN_cond__sliding_block_cached__moe_arch_mod__prompt_kernel_mp7g
    s_cbranch_vccnz adaLN_cond__sliding_block_cached__moe_arch_mod__prompt_kernel_mp7p
adaLN_cond__sliding_block_cached__moe_arch_mod__prompt_kernel_mp7g:
    s_waitcnt vmcnt(0) lgkmcnt(0)
    s_nop 15
    s_nop 3
    s_branch adaLN_cond__sliding_block_cached__moe_arch_mod__prompt_kernel_mp7b
adaLN_cond__sliding_block_cached__moe_arch_mod__prompt_kernel_o28r:
    s_waitcnt vmcnt(0) lgkmcnt(0)
    s_nop 15
    s_nop 3
    s_mov_b32 s27, 0
adaLN_cond__sliding_block_cached__moe_arch_mod__prompt_kernel_o28p:
    buffer_load_dword v12, v13, s[8:11], s17 offen sc1
    s_waitcnt vmcnt(0)
    v_cmp_ne_u32 vcc, s28, v12
    s_add_u32 s27, s27, 1
    s_cmp_ge_u32 s27, 262144
    s_cbranch_scc1 adaLN_cond__sliding_block_cached__moe_arch_mod__prompt_kernel_o28g
    s_cbranch_vccnz adaLN_cond__sliding_block_cached__moe_arch_mod__prompt_kernel_o28p
adaLN_cond__sliding_block_cached__moe_arch_mod__prompt_kernel_o28g:
    s_waitcnt vmcnt(0) lgkmcnt(0)
    s_nop 15
    s_nop 3
    s_branch adaLN_cond__sliding_block_cached__moe_arch_mod__prompt_kernel_o28b
adaLN_cond__sliding_block_cached__moe_arch_mod__prompt_kernel_o29r:
    s_waitcnt vmcnt(0) lgkmcnt(0)
    s_nop 15
    s_nop 3
    s_mov_b32 s27, 0
adaLN_cond__sliding_block_cached__moe_arch_mod__prompt_kernel_o29p:
    buffer_load_dword v12, v13, s[8:11], s17 offen sc1
    s_waitcnt vmcnt(0)
    v_cmp_ne_u32 vcc, s28, v12
    s_add_u32 s27, s27, 1
    s_cmp_ge_u32 s27, 262144
    s_cbranch_scc1 adaLN_cond__sliding_block_cached__moe_arch_mod__prompt_kernel_o29g
    s_cbranch_vccnz adaLN_cond__sliding_block_cached__moe_arch_mod__prompt_kernel_o29p
adaLN_cond__sliding_block_cached__moe_arch_mod__prompt_kernel_o29g:
    s_waitcnt vmcnt(0) lgkmcnt(0)
    s_nop 15
    s_nop 3
    s_branch adaLN_cond__sliding_block_cached__moe_arch_mod__prompt_kernel_o29b
adaLN_cond__sliding_block_cached__moe_arch_mod__prompt_kernel_mf10r:
    s_waitcnt vmcnt(0) lgkmcnt(0)
    s_nop 15
    s_nop 3
    s_mov_b32 s27, 0
adaLN_cond__sliding_block_cached__moe_arch_mod__prompt_kernel_mf10p:
    s_mov_b32 s16, 0x544000
    buffer_load_dwordx4 v[184:187], v2, s[8:11], s16 offen sc1
    s_waitcnt vmcnt(0)
    v_xor_b32 v16, s28, v184
    v_xor_b32 v17, s28, v185
    v_xor_b32 v18, s28, v186
    v_xor_b32 v19, s28, v187
    v_or3_b32 v16, v16, v17, v18
    v_or_b32 v16, v16, v19
    v_cmp_ne_u32 vcc, 0, v16
    s_add_u32 s27, s27, 1
    s_cmp_ge_u32 s27, 262144
    s_cbranch_scc1 adaLN_cond__sliding_block_cached__moe_arch_mod__prompt_kernel_mf10g
    s_cbranch_vccnz adaLN_cond__sliding_block_cached__moe_arch_mod__prompt_kernel_mf10p
adaLN_cond__sliding_block_cached__moe_arch_mod__prompt_kernel_mf10g:
    s_waitcnt vmcnt(0) lgkmcnt(0)
    s_nop 15
    s_nop 3
    s_branch adaLN_cond__sliding_block_cached__moe_arch_mod__prompt_kernel_mf10b
adaLN_cond__sliding_block_cached__moe_arch_mod__prompt_kernel_kv16r:
    s_waitcnt vmcnt(0) lgkmcnt(0)
    s_nop 15
    s_nop 3
    s_mov_b32 s27, 0
adaLN_cond__sliding_block_cached__moe_arch_mod__prompt_kernel_kv16p:
    buffer_load_dwordx4 v[12:15], v21, s[8:11], s18 offen sc1
    s_waitcnt vmcnt(0)
    v_xor_b32 v8, s28, v12
    v_xor_b32 v20, s28, v13
    v_or_b32 v8, v8, v20
    v_xor_b32 v20, s28, v14
    v_or_b32 v8, v8, v20
    v_xor_b32 v20, s28, v15
    v_or_b32 v8, v8, v20
    v_cmp_ne_u32 vcc, 0, v8
    s_add_u32 s27, s27, 1
    s_cmp_ge_u32 s27, 262144
    s_cbranch_scc1 adaLN_cond__sliding_block_cached__moe_arch_mod__prompt_kernel_kv16g
    s_cbranch_vccnz adaLN_cond__sliding_block_cached__moe_arch_mod__prompt_kernel_kv16p
adaLN_cond__sliding_block_cached__moe_arch_mod__prompt_kernel_kv16g:
    s_waitcnt vmcnt(0) lgkmcnt(0)
    s_nop 15
    s_nop 3
    s_branch adaLN_cond__sliding_block_cached__moe_arch_mod__prompt_kernel_kv16b
adaLN_cond__sliding_block_cached__moe_arch_mod__prompt_kernel_fixB:
    s_waitcnt vmcnt(0) lgkmcnt(0)
    s_nop 15
    s_nop 3
    s_lshr_b32 s16, s12, 3
    s_lshl_b32 s16, s16, 17
    s_add_u32 s16, s16, 0x400000
    v_add_u32 v8, s16, v2
    v_mov_b32 v16, 0xff7fffff
    v_mov_b32 v17, 0xff7fffff
    s_mov_b32 s16, 0
adaLN_cond__sliding_block_cached__moe_arch_mod__prompt_kernel_fixBm:
    s_add_u32 s17, s16, 0
    buffer_load_dwordx4 v[200:203], v8, s[8:11], s17 offen offset:0
    buffer_load_dwordx4 v[204:207], v8, s[8:11], s17 offen offset:1024
    buffer_load_dwordx4 v[208:211], v8, s[8:11], s17 offen offset:2048
    buffer_load_dwordx4 v[212:215], v8, s[8:11], s17 offen offset:3072
    s_waitcnt vmcnt(3)
    v_mfma_f32_16x16x32_bf16 v[184:187], v[200:203], v[152:155], 0
    v_mfma_f32_16x16x32_bf16 v[188:191], v[200:203], v[168:171], 0
    s_waitcnt vmcnt(2)
    v_mfma_f32_16x16x32_bf16 v[192:195], v[204:207], v[152:155], 0
    v_mfma_f32_16x16x32_bf16 v[196:199], v[204:207], v[168:171], 0
    s_waitcnt vmcnt(1)
    v_mfma_f32_16x16x32_bf16 v[184:187], v[208:211], v[156:159], v[184:187]
    v_mfma_f32_16x16x32_bf16 v[188:191], v[208:211], v[172:175], v[188:191]
    s_waitcnt vmcnt(0)
    v_mfma_f32_16x16x32_bf16 v[192:195], v[212:215], v[156:159], v[192:195]
    v_mfma_f32_16x16x32_bf16 v[196:199], v[212:215], v[172:175], v[196:199]
    s_add_u32 s17, s16, 4096
    buffer_load_dwordx4 v[200:203], v8, s[8:11], s17 offen offset:0
    buffer_load_dwordx4 v[204:207], v8, s[8:11], s17 offen offset:1024
    buffer_load_dwordx4 v[208:211], v8, s[8:11], s17 offen offset:2048
    buffer_load_dwordx4 v[212:215], v8, s[8:11], s17 offen offset:3072
    s_waitcnt vmcnt(3)
    v_mfma_f32_16x16x32_bf16 v[184:187], v[200:203], v[160:163], v[184:187]
    v_mfma_f32_16x16x32_bf16 v[188:191], v[200:203], v[176:179], v[188:191]
    s_waitcnt vmcnt(2)
    v_mfma_f32_16x16x32_bf16 v[192:195], v[204:207], v[160:163], v[192:195]
    v_mfma_f32_16x16x32_bf16 v[196:199], v[204:207], v[176:179], v[196:199]
    s_waitcnt vmcnt(1)
    v_mfma_f32_16x16x32_bf16 v[184:187], v[208:211], v[164:167], v[184:187]
    v_mfma_f32_16x16x32_bf16 v[188:191], v[208:211], v[180:183], v[188:191]
    s_waitcnt vmcnt(0)
    v_mfma_f32_16x16x32_bf16 v[192:195], v[212:215], v[164:167], v[192:195]
    v_mfma_f32_16x16x32_bf16 v[196:199], v[212:215], v[180:183], v[196:199]
    s_nop 3
    v_max3_f32 v16, v16, v184, v185
    v_max3_f32 v16, v16, v186, v187
    v_max3_f32 v17, v17, v188, v189
    v_max3_f32 v17, v17, v190, v191
    v_max3_f32 v16, v16, v192, v193
    v_max3_f32 v16, v16, v194, v195
    v_max3_f32 v17, v17, v196, v197
    v_max3_f32 v17, v17, v198, v199
    s_add_u32 s16, s16, 8192
    s_cmp_lt_u32 s16, 0x20000
    s_cbranch_scc1 adaLN_cond__sliding_block_cached__moe_arch_mod__prompt_kernel_fixBm
    v_mov_b32 v18, v16
    v_mov_b32 v19, v17
    s_nop 0
    v_permlane16_swap_b32 v16, v18
    v_permlane16_swap_b32 v17, v19
    v_max_f32 v16, v16, v18
    v_max_f32 v17, v17, v19
    v_mov_b32 v18, v16
    v_mov_b32 v19, v17
    s_nop 0
    v_permlane32_swap_b32 v16, v18
    v_permlane32_swap_b32 v17, v19
    v_max_f32 v16, v16, v18
    v_max_f32 v17, v17, v19
    v_sub_f32 v216, 0, v16
    v_sub_f32 v217, 0, v16
    v_sub_f32 v218, 0, v16
    v_sub_f32 v219, 0, v16
    v_sub_f32 v220, 0, v17
    v_sub_f32 v221, 0, v17
    v_sub_f32 v222, 0, v17
    v_sub_f32 v223, 0, v17
    s_mov_b32 s17, 0x0
    buffer_load_dwordx4 v[200:203], v8, s[8:11], s17 offen offset:0
    buffer_load_dwordx4 v[204:207], v8, s[8:11], s17 offen offset:1024
    buffer_load_dwordx4 v[208:211], v8, s[8:11], s17 offen offset:2048
    buffer_load_dwordx4 v[212:215], v8, s[8:11], s17 offen offset:3072
    s_waitcnt vmcnt(3)
    v_mfma_f32_16x16x32_bf16 v[184:187], v[200:203], v[152:155], v[216:219]
    v_mfma_f32_16x16x32_bf16 v[188:191], v[200:203], v[168:171], v[220:223]
    s_waitcnt vmcnt(2)
    v_mfma_f32_16x16x32_bf16 v[192:195], v[204:207], v[152:155], v[216:219]
    v_mfma_f32_16x16x32_bf16 v[196:199], v[204:207], v[168:171], v[220:223]
    s_waitcnt vmcnt(1)
    v_mfma_f32_16x16x32_bf16 v[184:187], v[208:211], v[156:159], v[184:187]
    v_mfma_f32_16x16x32_bf16 v[188:191], v[208:211], v[172:175], v[188:191]
    s_waitcnt vmcnt(0)
    v_mfma_f32_16x16x32_bf16 v[192:195], v[212:215], v[156:159], v[192:195]
    v_mfma_f32_16x16x32_bf16 v[196:199], v[212:215], v[172:175], v[196:199]
    s_mov_b32 s17, 0x1000
    buffer_load_dwordx4 v[200:203], v8, s[8:11], s17 offen offset:0
    buffer_load_dwordx4 v[204:207], v8, s[8:11], s17 offen offset:1024
    buffer_load_dwordx4 v[208:211], v8, s[8:11], s17 offen offset:2048
    buffer_load_dwordx4 v[212:215], v8, s[8:11], s17 offen offset:3072
    s_waitcnt vmcnt(3)
    v_mfma_f32_16x16x32_bf16 v[184:187], v[200:203], v[160:163], v[184:187]
    v_mfma_f32_16x16x32_bf16 v[188:191], v[200:203], v[176:179], v[188:191]
    s_waitcnt vmcnt(2)
    v_mfma_f32_16x16x32_bf16 v[192:195], v[204:207], v[160:163], v[192:195]
    v_mfma_f32_16x16x32_bf16 v[196:199], v[204:207], v[176:179], v[196:199]
    s_waitcnt vmcnt(1)
    v_mfma_f32_16x16x32_bf16 v[184:187], v[208:211], v[164:167], v[184:187]
    v_mfma_f32_16x16x32_bf16 v[188:191], v[208:211], v[180:183], v[188:191]
    s_waitcnt vmcnt(0)
    v_mfma_f32_16x16x32_bf16 v[192:195], v[212:215], v[164:167], v[192:195]
    v_mfma_f32_16x16x32_bf16 v[196:199], v[212:215], v[180:183], v[196:199]
    s_nop 3
    v_exp_f32 v184, v184
    v_exp_f32 v185, v185
    s_nop 0
    v_add_f32 v9, v184, v185
    v_cvt_pk_bf16_f32 v24, v184, v185
    v_exp_f32 v186, v186
    v_exp_f32 v187, v187
    v_add_f32 v9, v9, v186
    v_add_f32 v9, v9, v187
    v_cvt_pk_bf16_f32 v25, v186, v187
    v_exp_f32 v188, v188
    v_exp_f32 v189, v189
    s_nop 0
    v_add_f32 v10, v188, v189
    v_cvt_pk_bf16_f32 v28, v188, v189
    v_exp_f32 v190, v190
    v_exp_f32 v191, v191
    v_add_f32 v10, v10, v190
    v_add_f32 v10, v10, v191
    v_cvt_pk_bf16_f32 v29, v190, v191
    v_exp_f32 v192, v192
    v_exp_f32 v193, v193
    v_add_f32 v9, v9, v192
    v_add_f32 v9, v9, v193
    v_cvt_pk_bf16_f32 v26, v192, v193
    v_exp_f32 v194, v194
    v_exp_f32 v195, v195
    v_add_f32 v9, v9, v194
    v_add_f32 v9, v9, v195
    v_cvt_pk_bf16_f32 v27, v194, v195
    v_exp_f32 v196, v196
    v_exp_f32 v197, v197
    v_add_f32 v10, v10, v196
    v_add_f32 v10, v10, v197
    v_cvt_pk_bf16_f32 v30, v196, v197
    v_exp_f32 v198, v198
    v_exp_f32 v199, v199
    v_add_f32 v10, v10, v198
    v_add_f32 v10, v10, v199
    v_cvt_pk_bf16_f32 v31, v198, v199
    s_mov_b32 s17, 0x2000
    buffer_load_dwordx4 v[200:203], v8, s[8:11], s17 offen offset:0
    buffer_load_dwordx4 v[204:207], v8, s[8:11], s17 offen offset:1024
    buffer_load_dwordx4 v[208:211], v8, s[8:11], s17 offen offset:2048
    buffer_load_dwordx4 v[212:215], v8, s[8:11], s17 offen offset:3072
    s_waitcnt vmcnt(3)
    v_mfma_f32_16x16x32_bf16 v[184:187], v[200:203], v[152:155], v[216:219]
    v_mfma_f32_16x16x32_bf16 v[188:191], v[200:203], v[168:171], v[220:223]
    s_waitcnt vmcnt(2)
    v_mfma_f32_16x16x32_bf16 v[192:195], v[204:207], v[152:155], v[216:219]
    v_mfma_f32_16x16x32_bf16 v[196:199], v[204:207], v[168:171], v[220:223]
    s_waitcnt vmcnt(1)
    v_mfma_f32_16x16x32_bf16 v[184:187], v[208:211], v[156:159], v[184:187]
    v_mfma_f32_16x16x32_bf16 v[188:191], v[208:211], v[172:175], v[188:191]
    s_waitcnt vmcnt(0)
    v_mfma_f32_16x16x32_bf16 v[192:195], v[212:215], v[156:159], v[192:195]
    v_mfma_f32_16x16x32_bf16 v[196:199], v[212:215], v[172:175], v[196:199]
    s_mov_b32 s17, 0x3000
    buffer_load_dwordx4 v[200:203], v8, s[8:11], s17 offen offset:0
    buffer_load_dwordx4 v[204:207], v8, s[8:11], s17 offen offset:1024
    buffer_load_dwordx4 v[208:211], v8, s[8:11], s17 offen offset:2048
    buffer_load_dwordx4 v[212:215], v8, s[8:11], s17 offen offset:3072
    s_waitcnt vmcnt(3)
    v_mfma_f32_16x16x32_bf16 v[184:187], v[200:203], v[160:163], v[184:187]
    v_mfma_f32_16x16x32_bf16 v[188:191], v[200:203], v[176:179], v[188:191]
    s_waitcnt vmcnt(2)
    v_mfma_f32_16x16x32_bf16 v[192:195], v[204:207], v[160:163], v[192:195]
    v_mfma_f32_16x16x32_bf16 v[196:199], v[204:207], v[176:179], v[196:199]
    s_waitcnt vmcnt(1)
    v_mfma_f32_16x16x32_bf16 v[184:187], v[208:211], v[164:167], v[184:187]
    v_mfma_f32_16x16x32_bf16 v[188:191], v[208:211], v[180:183], v[188:191]
    s_waitcnt vmcnt(0)
    v_mfma_f32_16x16x32_bf16 v[192:195], v[212:215], v[164:167], v[192:195]
    v_mfma_f32_16x16x32_bf16 v[196:199], v[212:215], v[180:183], v[196:199]
    s_nop 3
    v_exp_f32 v184, v184
    v_exp_f32 v185, v185
    v_add_f32 v9, v9, v184
    v_add_f32 v9, v9, v185
    v_cvt_pk_bf16_f32 v32, v184, v185
    v_exp_f32 v186, v186
    v_exp_f32 v187, v187
    v_add_f32 v9, v9, v186
    v_add_f32 v9, v9, v187
    v_cvt_pk_bf16_f32 v33, v186, v187
    v_exp_f32 v188, v188
    v_exp_f32 v189, v189
    v_add_f32 v10, v10, v188
    v_add_f32 v10, v10, v189
    v_cvt_pk_bf16_f32 v36, v188, v189
    v_exp_f32 v190, v190
    v_exp_f32 v191, v191
    v_add_f32 v10, v10, v190
    v_add_f32 v10, v10, v191
    v_cvt_pk_bf16_f32 v37, v190, v191
    v_exp_f32 v192, v192
    v_exp_f32 v193, v193
    v_add_f32 v9, v9, v192
    v_add_f32 v9, v9, v193
    v_cvt_pk_bf16_f32 v34, v192, v193
    v_exp_f32 v194, v194
    v_exp_f32 v195, v195
    v_add_f32 v9, v9, v194
    v_add_f32 v9, v9, v195
    v_cvt_pk_bf16_f32 v35, v194, v195
    v_exp_f32 v196, v196
    v_exp_f32 v197, v197
    v_add_f32 v10, v10, v196
    v_add_f32 v10, v10, v197
    v_cvt_pk_bf16_f32 v38, v196, v197
    v_exp_f32 v198, v198
    v_exp_f32 v199, v199
    v_add_f32 v10, v10, v198
    v_add_f32 v10, v10, v199
    v_cvt_pk_bf16_f32 v39, v198, v199
    s_mov_b32 s17, 0x4000
    buffer_load_dwordx4 v[200:203], v8, s[8:11], s17 offen offset:0
    buffer_load_dwordx4 v[204:207], v8, s[8:11], s17 offen offset:1024
    buffer_load_dwordx4 v[208:211], v8, s[8:11], s17 offen offset:2048
    buffer_load_dwordx4 v[212:215], v8, s[8:11], s17 offen offset:3072
    s_waitcnt vmcnt(3)
    v_mfma_f32_16x16x32_bf16 v[184:187], v[200:203], v[152:155], v[216:219]
    v_mfma_f32_16x16x32_bf16 v[188:191], v[200:203], v[168:171], v[220:223]
    s_waitcnt vmcnt(2)
    v_mfma_f32_16x16x32_bf16 v[192:195], v[204:207], v[152:155], v[216:219]
    v_mfma_f32_16x16x32_bf16 v[196:199], v[204:207], v[168:171], v[220:223]
    s_waitcnt vmcnt(1)
    v_mfma_f32_16x16x32_bf16 v[184:187], v[208:211], v[156:159], v[184:187]
    v_mfma_f32_16x16x32_bf16 v[188:191], v[208:211], v[172:175], v[188:191]
    s_waitcnt vmcnt(0)
    v_mfma_f32_16x16x32_bf16 v[192:195], v[212:215], v[156:159], v[192:195]
    v_mfma_f32_16x16x32_bf16 v[196:199], v[212:215], v[172:175], v[196:199]
    s_mov_b32 s17, 0x5000
    buffer_load_dwordx4 v[200:203], v8, s[8:11], s17 offen offset:0
    buffer_load_dwordx4 v[204:207], v8, s[8:11], s17 offen offset:1024
    buffer_load_dwordx4 v[208:211], v8, s[8:11], s17 offen offset:2048
    buffer_load_dwordx4 v[212:215], v8, s[8:11], s17 offen offset:3072
    s_waitcnt vmcnt(3)
    v_mfma_f32_16x16x32_bf16 v[184:187], v[200:203], v[160:163], v[184:187]
    v_mfma_f32_16x16x32_bf16 v[188:191], v[200:203], v[176:179], v[188:191]
    s_waitcnt vmcnt(2)
    v_mfma_f32_16x16x32_bf16 v[192:195], v[204:207], v[160:163], v[192:195]
    v_mfma_f32_16x16x32_bf16 v[196:199], v[204:207], v[176:179], v[196:199]
    s_waitcnt vmcnt(1)
    v_mfma_f32_16x16x32_bf16 v[184:187], v[208:211], v[164:167], v[184:187]
    v_mfma_f32_16x16x32_bf16 v[188:191], v[208:211], v[180:183], v[188:191]
    s_waitcnt vmcnt(0)
    v_mfma_f32_16x16x32_bf16 v[192:195], v[212:215], v[164:167], v[192:195]
    v_mfma_f32_16x16x32_bf16 v[196:199], v[212:215], v[180:183], v[196:199]
    s_nop 3
    v_exp_f32 v184, v184
    v_exp_f32 v185, v185
    v_add_f32 v9, v9, v184
    v_add_f32 v9, v9, v185
    v_cvt_pk_bf16_f32 v40, v184, v185
    v_exp_f32 v186, v186
    v_exp_f32 v187, v187
    v_add_f32 v9, v9, v186
    v_add_f32 v9, v9, v187
    v_cvt_pk_bf16_f32 v41, v186, v187
    v_exp_f32 v188, v188
    v_exp_f32 v189, v189
    v_add_f32 v10, v10, v188
    v_add_f32 v10, v10, v189
    v_cvt_pk_bf16_f32 v44, v188, v189
    v_exp_f32 v190, v190
    v_exp_f32 v191, v191
    v_add_f32 v10, v10, v190
    v_add_f32 v10, v10, v191
    v_cvt_pk_bf16_f32 v45, v190, v191
    v_exp_f32 v192, v192
    v_exp_f32 v193, v193
    v_add_f32 v9, v9, v192
    v_add_f32 v9, v9, v193
    v_cvt_pk_bf16_f32 v42, v192, v193
    v_exp_f32 v194, v194
    v_exp_f32 v195, v195
    v_add_f32 v9, v9, v194
    v_add_f32 v9, v9, v195
    v_cvt_pk_bf16_f32 v43, v194, v195
    v_exp_f32 v196, v196
    v_exp_f32 v197, v197
    v_add_f32 v10, v10, v196
    v_add_f32 v10, v10, v197
    v_cvt_pk_bf16_f32 v46, v196, v197
    v_exp_f32 v198, v198
    v_exp_f32 v199, v199
    v_add_f32 v10, v10, v198
    v_add_f32 v10, v10, v199
    v_cvt_pk_bf16_f32 v47, v198, v199
    s_mov_b32 s17, 0x6000
    buffer_load_dwordx4 v[200:203], v8, s[8:11], s17 offen offset:0
    buffer_load_dwordx4 v[204:207], v8, s[8:11], s17 offen offset:1024
    buffer_load_dwordx4 v[208:211], v8, s[8:11], s17 offen offset:2048
    buffer_load_dwordx4 v[212:215], v8, s[8:11], s17 offen offset:3072
    s_waitcnt vmcnt(3)
    v_mfma_f32_16x16x32_bf16 v[184:187], v[200:203], v[152:155], v[216:219]
    v_mfma_f32_16x16x32_bf16 v[188:191], v[200:203], v[168:171], v[220:223]
    s_waitcnt vmcnt(2)
    v_mfma_f32_16x16x32_bf16 v[192:195], v[204:207], v[152:155], v[216:219]
    v_mfma_f32_16x16x32_bf16 v[196:199], v[204:207], v[168:171], v[220:223]
    s_waitcnt vmcnt(1)
    v_mfma_f32_16x16x32_bf16 v[184:187], v[208:211], v[156:159], v[184:187]
    v_mfma_f32_16x16x32_bf16 v[188:191], v[208:211], v[172:175], v[188:191]
    s_waitcnt vmcnt(0)
    v_mfma_f32_16x16x32_bf16 v[192:195], v[212:215], v[156:159], v[192:195]
    v_mfma_f32_16x16x32_bf16 v[196:199], v[212:215], v[172:175], v[196:199]
    s_mov_b32 s17, 0x7000
    buffer_load_dwordx4 v[200:203], v8, s[8:11], s17 offen offset:0
    buffer_load_dwordx4 v[204:207], v8, s[8:11], s17 offen offset:1024
    buffer_load_dwordx4 v[208:211], v8, s[8:11], s17 offen offset:2048
    buffer_load_dwordx4 v[212:215], v8, s[8:11], s17 offen offset:3072
    s_waitcnt vmcnt(3)
    v_mfma_f32_16x16x32_bf16 v[184:187], v[200:203], v[160:163], v[184:187]
    v_mfma_f32_16x16x32_bf16 v[188:191], v[200:203], v[176:179], v[188:191]
    s_waitcnt vmcnt(2)
    v_mfma_f32_16x16x32_bf16 v[192:195], v[204:207], v[160:163], v[192:195]
    v_mfma_f32_16x16x32_bf16 v[196:199], v[204:207], v[176:179], v[196:199]
    s_waitcnt vmcnt(1)
    v_mfma_f32_16x16x32_bf16 v[184:187], v[208:211], v[164:167], v[184:187]
    v_mfma_f32_16x16x32_bf16 v[188:191], v[208:211], v[180:183], v[188:191]
    s_waitcnt vmcnt(0)
    v_mfma_f32_16x16x32_bf16 v[192:195], v[212:215], v[164:167], v[192:195]
    v_mfma_f32_16x16x32_bf16 v[196:199], v[212:215], v[180:183], v[196:199]
    s_nop 3
    v_exp_f32 v184, v184
    v_exp_f32 v185, v185
    v_add_f32 v9, v9, v184
    v_add_f32 v9, v9, v185
    v_cvt_pk_bf16_f32 v48, v184, v185
    v_exp_f32 v186, v186
    v_exp_f32 v187, v187
    v_add_f32 v9, v9, v186
    v_add_f32 v9, v9, v187
    v_cvt_pk_bf16_f32 v49, v186, v187
    v_exp_f32 v188, v188
    v_exp_f32 v189, v189
    v_add_f32 v10, v10, v188
    v_add_f32 v10, v10, v189
    v_cvt_pk_bf16_f32 v52, v188, v189
    v_exp_f32 v190, v190
    v_exp_f32 v191, v191
    v_add_f32 v10, v10, v190
    v_add_f32 v10, v10, v191
    v_cvt_pk_bf16_f32 v53, v190, v191
    v_exp_f32 v192, v192
    v_exp_f32 v193, v193
    v_add_f32 v9, v9, v192
    v_add_f32 v9, v9, v193
    v_cvt_pk_bf16_f32 v50, v192, v193
    v_exp_f32 v194, v194
    v_exp_f32 v195, v195
    v_add_f32 v9, v9, v194
    v_add_f32 v9, v9, v195
    v_cvt_pk_bf16_f32 v51, v194, v195
    v_exp_f32 v196, v196
    v_exp_f32 v197, v197
    v_add_f32 v10, v10, v196
    v_add_f32 v10, v10, v197
    v_cvt_pk_bf16_f32 v54, v196, v197
    v_exp_f32 v198, v198
    v_exp_f32 v199, v199
    v_add_f32 v10, v10, v198
    v_add_f32 v10, v10, v199
    v_cvt_pk_bf16_f32 v55, v198, v199
    s_mov_b32 s17, 0x8000
    buffer_load_dwordx4 v[200:203], v8, s[8:11], s17 offen offset:0
    buffer_load_dwordx4 v[204:207], v8, s[8:11], s17 offen offset:1024
    buffer_load_dwordx4 v[208:211], v8, s[8:11], s17 offen offset:2048
    buffer_load_dwordx4 v[212:215], v8, s[8:11], s17 offen offset:3072
    s_waitcnt vmcnt(3)
    v_mfma_f32_16x16x32_bf16 v[184:187], v[200:203], v[152:155], v[216:219]
    v_mfma_f32_16x16x32_bf16 v[188:191], v[200:203], v[168:171], v[220:223]
    s_waitcnt vmcnt(2)
    v_mfma_f32_16x16x32_bf16 v[192:195], v[204:207], v[152:155], v[216:219]
    v_mfma_f32_16x16x32_bf16 v[196:199], v[204:207], v[168:171], v[220:223]
    s_waitcnt vmcnt(1)
    v_mfma_f32_16x16x32_bf16 v[184:187], v[208:211], v[156:159], v[184:187]
    v_mfma_f32_16x16x32_bf16 v[188:191], v[208:211], v[172:175], v[188:191]
    s_waitcnt vmcnt(0)
    v_mfma_f32_16x16x32_bf16 v[192:195], v[212:215], v[156:159], v[192:195]
    v_mfma_f32_16x16x32_bf16 v[196:199], v[212:215], v[172:175], v[196:199]
    s_mov_b32 s17, 0x9000
    buffer_load_dwordx4 v[200:203], v8, s[8:11], s17 offen offset:0
    buffer_load_dwordx4 v[204:207], v8, s[8:11], s17 offen offset:1024
    buffer_load_dwordx4 v[208:211], v8, s[8:11], s17 offen offset:2048
    buffer_load_dwordx4 v[212:215], v8, s[8:11], s17 offen offset:3072
    s_waitcnt vmcnt(3)
    v_mfma_f32_16x16x32_bf16 v[184:187], v[200:203], v[160:163], v[184:187]
    v_mfma_f32_16x16x32_bf16 v[188:191], v[200:203], v[176:179], v[188:191]
    s_waitcnt vmcnt(2)
    v_mfma_f32_16x16x32_bf16 v[192:195], v[204:207], v[160:163], v[192:195]
    v_mfma_f32_16x16x32_bf16 v[196:199], v[204:207], v[176:179], v[196:199]
    s_waitcnt vmcnt(1)
    v_mfma_f32_16x16x32_bf16 v[184:187], v[208:211], v[164:167], v[184:187]
    v_mfma_f32_16x16x32_bf16 v[188:191], v[208:211], v[180:183], v[188:191]
    s_waitcnt vmcnt(0)
    v_mfma_f32_16x16x32_bf16 v[192:195], v[212:215], v[164:167], v[192:195]
    v_mfma_f32_16x16x32_bf16 v[196:199], v[212:215], v[180:183], v[196:199]
    s_nop 3
    v_exp_f32 v184, v184
    v_exp_f32 v185, v185
    v_add_f32 v9, v9, v184
    v_add_f32 v9, v9, v185
    v_cvt_pk_bf16_f32 v56, v184, v185
    v_exp_f32 v186, v186
    v_exp_f32 v187, v187
    v_add_f32 v9, v9, v186
    v_add_f32 v9, v9, v187
    v_cvt_pk_bf16_f32 v57, v186, v187
    v_exp_f32 v188, v188
    v_exp_f32 v189, v189
    v_add_f32 v10, v10, v188
    v_add_f32 v10, v10, v189
    v_cvt_pk_bf16_f32 v60, v188, v189
    v_exp_f32 v190, v190
    v_exp_f32 v191, v191
    v_add_f32 v10, v10, v190
    v_add_f32 v10, v10, v191
    v_cvt_pk_bf16_f32 v61, v190, v191
    v_exp_f32 v192, v192
    v_exp_f32 v193, v193
    v_add_f32 v9, v9, v192
    v_add_f32 v9, v9, v193
    v_cvt_pk_bf16_f32 v58, v192, v193
    v_exp_f32 v194, v194
    v_exp_f32 v195, v195
    v_add_f32 v9, v9, v194
    v_add_f32 v9, v9, v195
    v_cvt_pk_bf16_f32 v59, v194, v195
    v_exp_f32 v196, v196
    v_exp_f32 v197, v197
    v_add_f32 v10, v10, v196
    v_add_f32 v10, v10, v197
    v_cvt_pk_bf16_f32 v62, v196, v197
    v_exp_f32 v198, v198
    v_exp_f32 v199, v199
    v_add_f32 v10, v10, v198
    v_add_f32 v10, v10, v199
    v_cvt_pk_bf16_f32 v63, v198, v199
    s_mov_b32 s17, 0xa000
    buffer_load_dwordx4 v[200:203], v8, s[8:11], s17 offen offset:0
    buffer_load_dwordx4 v[204:207], v8, s[8:11], s17 offen offset:1024
    buffer_load_dwordx4 v[208:211], v8, s[8:11], s17 offen offset:2048
    buffer_load_dwordx4 v[212:215], v8, s[8:11], s17 offen offset:3072
    s_waitcnt vmcnt(3)
    v_mfma_f32_16x16x32_bf16 v[184:187], v[200:203], v[152:155], v[216:219]
    v_mfma_f32_16x16x32_bf16 v[188:191], v[200:203], v[168:171], v[220:223]
    s_waitcnt vmcnt(2)
    v_mfma_f32_16x16x32_bf16 v[192:195], v[204:207], v[152:155], v[216:219]
    v_mfma_f32_16x16x32_bf16 v[196:199], v[204:207], v[168:171], v[220:223]
    s_waitcnt vmcnt(1)
    v_mfma_f32_16x16x32_bf16 v[184:187], v[208:211], v[156:159], v[184:187]
    v_mfma_f32_16x16x32_bf16 v[188:191], v[208:211], v[172:175], v[188:191]
    s_waitcnt vmcnt(0)
    v_mfma_f32_16x16x32_bf16 v[192:195], v[212:215], v[156:159], v[192:195]
    v_mfma_f32_16x16x32_bf16 v[196:199], v[212:215], v[172:175], v[196:199]
    s_mov_b32 s17, 0xb000
    buffer_load_dwordx4 v[200:203], v8, s[8:11], s17 offen offset:0
    buffer_load_dwordx4 v[204:207], v8, s[8:11], s17 offen offset:1024
    buffer_load_dwordx4 v[208:211], v8, s[8:11], s17 offen offset:2048
    buffer_load_dwordx4 v[212:215], v8, s[8:11], s17 offen offset:3072
    s_waitcnt vmcnt(3)
    v_mfma_f32_16x16x32_bf16 v[184:187], v[200:203], v[160:163], v[184:187]
    v_mfma_f32_16x16x32_bf16 v[188:191], v[200:203], v[176:179], v[188:191]
    s_waitcnt vmcnt(2)
    v_mfma_f32_16x16x32_bf16 v[192:195], v[204:207], v[160:163], v[192:195]
    v_mfma_f32_16x16x32_bf16 v[196:199], v[204:207], v[176:179], v[196:199]
    s_waitcnt vmcnt(1)
    v_mfma_f32_16x16x32_bf16 v[184:187], v[208:211], v[164:167], v[184:187]
    v_mfma_f32_16x16x32_bf16 v[188:191], v[208:211], v[180:183], v[188:191]
    s_waitcnt vmcnt(0)
    v_mfma_f32_16x16x32_bf16 v[192:195], v[212:215], v[164:167], v[192:195]
    v_mfma_f32_16x16x32_bf16 v[196:199], v[212:215], v[180:183], v[196:199]
    s_nop 3
    v_exp_f32 v184, v184
    v_exp_f32 v185, v185
    v_add_f32 v9, v9, v184
    v_add_f32 v9, v9, v185
    v_cvt_pk_bf16_f32 v64, v184, v185
    v_exp_f32 v186, v186
    v_exp_f32 v187, v187
    v_add_f32 v9, v9, v186
    v_add_f32 v9, v9, v187
    v_cvt_pk_bf16_f32 v65, v186, v187
    v_exp_f32 v188, v188
    v_exp_f32 v189, v189
    v_add_f32 v10, v10, v188
    v_add_f32 v10, v10, v189
    v_cvt_pk_bf16_f32 v68, v188, v189
    v_exp_f32 v190, v190
    v_exp_f32 v191, v191
    v_add_f32 v10, v10, v190
    v_add_f32 v10, v10, v191
    v_cvt_pk_bf16_f32 v69, v190, v191
    v_exp_f32 v192, v192
    v_exp_f32 v193, v193
    v_add_f32 v9, v9, v192
    v_add_f32 v9, v9, v193
    v_cvt_pk_bf16_f32 v66, v192, v193
    v_exp_f32 v194, v194
    v_exp_f32 v195, v195
    v_add_f32 v9, v9, v194
    v_add_f32 v9, v9, v195
    v_cvt_pk_bf16_f32 v67, v194, v195
    v_exp_f32 v196, v196
    v_exp_f32 v197, v197
    v_add_f32 v10, v10, v196
    v_add_f32 v10, v10, v197
    v_cvt_pk_bf16_f32 v70, v196, v197
    v_exp_f32 v198, v198
    v_exp_f32 v199, v199
    v_add_f32 v10, v10, v198
    v_add_f32 v10, v10, v199
    v_cvt_pk_bf16_f32 v71, v198, v199
    s_mov_b32 s17, 0xc000
    buffer_load_dwordx4 v[200:203], v8, s[8:11], s17 offen offset:0
    buffer_load_dwordx4 v[204:207], v8, s[8:11], s17 offen offset:1024
    buffer_load_dwordx4 v[208:211], v8, s[8:11], s17 offen offset:2048
    buffer_load_dwordx4 v[212:215], v8, s[8:11], s17 offen offset:3072
    s_waitcnt vmcnt(3)
    v_mfma_f32_16x16x32_bf16 v[184:187], v[200:203], v[152:155], v[216:219]
    v_mfma_f32_16x16x32_bf16 v[188:191], v[200:203], v[168:171], v[220:223]
    s_waitcnt vmcnt(2)
    v_mfma_f32_16x16x32_bf16 v[192:195], v[204:207], v[152:155], v[216:219]
    v_mfma_f32_16x16x32_bf16 v[196:199], v[204:207], v[168:171], v[220:223]
    s_waitcnt vmcnt(1)
    v_mfma_f32_16x16x32_bf16 v[184:187], v[208:211], v[156:159], v[184:187]
    v_mfma_f32_16x16x32_bf16 v[188:191], v[208:211], v[172:175], v[188:191]
    s_waitcnt vmcnt(0)
    v_mfma_f32_16x16x32_bf16 v[192:195], v[212:215], v[156:159], v[192:195]
    v_mfma_f32_16x16x32_bf16 v[196:199], v[212:215], v[172:175], v[196:199]
    s_mov_b32 s17, 0xd000
    buffer_load_dwordx4 v[200:203], v8, s[8:11], s17 offen offset:0
    buffer_load_dwordx4 v[204:207], v8, s[8:11], s17 offen offset:1024
    buffer_load_dwordx4 v[208:211], v8, s[8:11], s17 offen offset:2048
    buffer_load_dwordx4 v[212:215], v8, s[8:11], s17 offen offset:3072
    s_waitcnt vmcnt(3)
    v_mfma_f32_16x16x32_bf16 v[184:187], v[200:203], v[160:163], v[184:187]
    v_mfma_f32_16x16x32_bf16 v[188:191], v[200:203], v[176:179], v[188:191]
    s_waitcnt vmcnt(2)
    v_mfma_f32_16x16x32_bf16 v[192:195], v[204:207], v[160:163], v[192:195]
    v_mfma_f32_16x16x32_bf16 v[196:199], v[204:207], v[176:179], v[196:199]
    s_waitcnt vmcnt(1)
    v_mfma_f32_16x16x32_bf16 v[184:187], v[208:211], v[164:167], v[184:187]
    v_mfma_f32_16x16x32_bf16 v[188:191], v[208:211], v[180:183], v[188:191]
    s_waitcnt vmcnt(0)
    v_mfma_f32_16x16x32_bf16 v[192:195], v[212:215], v[164:167], v[192:195]
    v_mfma_f32_16x16x32_bf16 v[196:199], v[212:215], v[180:183], v[196:199]
    s_nop 3
    v_exp_f32 v184, v184
    v_exp_f32 v185, v185
    v_add_f32 v9, v9, v184
    v_add_f32 v9, v9, v185
    v_cvt_pk_bf16_f32 v72, v184, v185
    v_exp_f32 v186, v186
    v_exp_f32 v187, v187
    v_add_f32 v9, v9, v186
    v_add_f32 v9, v9, v187
    v_cvt_pk_bf16_f32 v73, v186, v187
    v_exp_f32 v188, v188
    v_exp_f32 v189, v189
    v_add_f32 v10, v10, v188
    v_add_f32 v10, v10, v189
    v_cvt_pk_bf16_f32 v76, v188, v189
    v_exp_f32 v190, v190
    v_exp_f32 v191, v191
    v_add_f32 v10, v10, v190
    v_add_f32 v10, v10, v191
    v_cvt_pk_bf16_f32 v77, v190, v191
    v_exp_f32 v192, v192
    v_exp_f32 v193, v193
    v_add_f32 v9, v9, v192
    v_add_f32 v9, v9, v193
    v_cvt_pk_bf16_f32 v74, v192, v193
    v_exp_f32 v194, v194
    v_exp_f32 v195, v195
    v_add_f32 v9, v9, v194
    v_add_f32 v9, v9, v195
    v_cvt_pk_bf16_f32 v75, v194, v195
    v_exp_f32 v196, v196
    v_exp_f32 v197, v197
    v_add_f32 v10, v10, v196
    v_add_f32 v10, v10, v197
    v_cvt_pk_bf16_f32 v78, v196, v197
    v_exp_f32 v198, v198
    v_exp_f32 v199, v199
    v_add_f32 v10, v10, v198
    v_add_f32 v10, v10, v199
    v_cvt_pk_bf16_f32 v79, v198, v199
    s_mov_b32 s17, 0xe000
    buffer_load_dwordx4 v[200:203], v8, s[8:11], s17 offen offset:0
    buffer_load_dwordx4 v[204:207], v8, s[8:11], s17 offen offset:1024
    buffer_load_dwordx4 v[208:211], v8, s[8:11], s17 offen offset:2048
    buffer_load_dwordx4 v[212:215], v8, s[8:11], s17 offen offset:3072
    s_waitcnt vmcnt(3)
    v_mfma_f32_16x16x32_bf16 v[184:187], v[200:203], v[152:155], v[216:219]
    v_mfma_f32_16x16x32_bf16 v[188:191], v[200:203], v[168:171], v[220:223]
    s_waitcnt vmcnt(2)
    v_mfma_f32_16x16x32_bf16 v[192:195], v[204:207], v[152:155], v[216:219]
    v_mfma_f32_16x16x32_bf16 v[196:199], v[204:207], v[168:171], v[220:223]
    s_waitcnt vmcnt(1)
    v_mfma_f32_16x16x32_bf16 v[184:187], v[208:211], v[156:159], v[184:187]
    v_mfma_f32_16x16x32_bf16 v[188:191], v[208:211], v[172:175], v[188:191]
    s_waitcnt vmcnt(0)
    v_mfma_f32_16x16x32_bf16 v[192:195], v[212:215], v[156:159], v[192:195]
    v_mfma_f32_16x16x32_bf16 v[196:199], v[212:215], v[172:175], v[196:199]
    s_mov_b32 s17, 0xf000
    buffer_load_dwordx4 v[200:203], v8, s[8:11], s17 offen offset:0
    buffer_load_dwordx4 v[204:207], v8, s[8:11], s17 offen offset:1024
    buffer_load_dwordx4 v[208:211], v8, s[8:11], s17 offen offset:2048
    buffer_load_dwordx4 v[212:215], v8, s[8:11], s17 offen offset:3072
    s_waitcnt vmcnt(3)
    v_mfma_f32_16x16x32_bf16 v[184:187], v[200:203], v[160:163], v[184:187]
    v_mfma_f32_16x16x32_bf16 v[188:191], v[200:203], v[176:179], v[188:191]
    s_waitcnt vmcnt(2)
    v_mfma_f32_16x16x32_bf16 v[192:195], v[204:207], v[160:163], v[192:195]
    v_mfma_f32_16x16x32_bf16 v[196:199], v[204:207], v[176:179], v[196:199]
    s_waitcnt vmcnt(1)
    v_mfma_f32_16x16x32_bf16 v[184:187], v[208:211], v[164:167], v[184:187]
    v_mfma_f32_16x16x32_bf16 v[188:191], v[208:211], v[180:183], v[188:191]
    s_waitcnt vmcnt(0)
    v_mfma_f32_16x16x32_bf16 v[192:195], v[212:215], v[164:167], v[192:195]
    v_mfma_f32_16x16x32_bf16 v[196:199], v[212:215], v[180:183], v[196:199]
    s_nop 3
    v_exp_f32 v184, v184
    v_exp_f32 v185, v185
    v_add_f32 v9, v9, v184
    v_add_f32 v9, v9, v185
    v_cvt_pk_bf16_f32 v80, v184, v185
    v_exp_f32 v186, v186
    v_exp_f32 v187, v187
    v_add_f32 v9, v9, v186
    v_add_f32 v9, v9, v187
    v_cvt_pk_bf16_f32 v81, v186, v187
    v_exp_f32 v188, v188
    v_exp_f32 v189, v189
    v_add_f32 v10, v10, v188
    v_add_f32 v10, v10, v189
    v_cvt_pk_bf16_f32 v84, v188, v189
    v_exp_f32 v190, v190
    v_exp_f32 v191, v191
    v_add_f32 v10, v10, v190
    v_add_f32 v10, v10, v191
    v_cvt_pk_bf16_f32 v85, v190, v191
    v_exp_f32 v192, v192
    v_exp_f32 v193, v193
    v_add_f32 v9, v9, v192
    v_add_f32 v9, v9, v193
    v_cvt_pk_bf16_f32 v82, v192, v193
    v_exp_f32 v194, v194
    v_exp_f32 v195, v195
    v_add_f32 v9, v9, v194
    v_add_f32 v9, v9, v195
    v_cvt_pk_bf16_f32 v83, v194, v195
    v_exp_f32 v196, v196
    v_exp_f32 v197, v197
    v_add_f32 v10, v10, v196
    v_add_f32 v10, v10, v197
    v_cvt_pk_bf16_f32 v86, v196, v197
    v_exp_f32 v198, v198
    v_exp_f32 v199, v199
    v_add_f32 v10, v10, v198
    v_add_f32 v10, v10, v199
    v_cvt_pk_bf16_f32 v87, v198, v199
    s_mov_b32 s17, 0x10000
    buffer_load_dwordx4 v[200:203], v8, s[8:11], s17 offen offset:0
    buffer_load_dwordx4 v[204:207], v8, s[8:11], s17 offen offset:1024
    buffer_load_dwordx4 v[208:211], v8, s[8:11], s17 offen offset:2048
    buffer_load_dwordx4 v[212:215], v8, s[8:11], s17 offen offset:3072
    s_waitcnt vmcnt(3)
    v_mfma_f32_16x16x32_bf16 v[184:187], v[200:203], v[152:155], v[216:219]
    v_mfma_f32_16x16x32_bf16 v[188:191], v[200:203], v[168:171], v[220:223]
    s_waitcnt vmcnt(2)
    v_mfma_f32_16x16x32_bf16 v[192:195], v[204:207], v[152:155], v[216:219]
    v_mfma_f32_16x16x32_bf16 v[196:199], v[204:207], v[168:171], v[220:223]
    s_waitcnt vmcnt(1)
    v_mfma_f32_16x16x32_bf16 v[184:187], v[208:211], v[156:159], v[184:187]
    v_mfma_f32_16x16x32_bf16 v[188:191], v[208:211], v[172:175], v[188:191]
    s_waitcnt vmcnt(0)
    v_mfma_f32_16x16x32_bf16 v[192:195], v[212:215], v[156:159], v[192:195]
    v_mfma_f32_16x16x32_bf16 v[196:199], v[212:215], v[172:175], v[196:199]
    s_mov_b32 s17, 0x11000
    buffer_load_dwordx4 v[200:203], v8, s[8:11], s17 offen offset:0
    buffer_load_dwordx4 v[204:207], v8, s[8:11], s17 offen offset:1024
    buffer_load_dwordx4 v[208:211], v8, s[8:11], s17 offen offset:2048
    buffer_load_dwordx4 v[212:215], v8, s[8:11], s17 offen offset:3072
    s_waitcnt vmcnt(3)
    v_mfma_f32_16x16x32_bf16 v[184:187], v[200:203], v[160:163], v[184:187]
    v_mfma_f32_16x16x32_bf16 v[188:191], v[200:203], v[176:179], v[188:191]
    s_waitcnt vmcnt(2)
    v_mfma_f32_16x16x32_bf16 v[192:195], v[204:207], v[160:163], v[192:195]
    v_mfma_f32_16x16x32_bf16 v[196:199], v[204:207], v[176:179], v[196:199]
    s_waitcnt vmcnt(1)
    v_mfma_f32_16x16x32_bf16 v[184:187], v[208:211], v[164:167], v[184:187]
    v_mfma_f32_16x16x32_bf16 v[188:191], v[208:211], v[180:183], v[188:191]
    s_waitcnt vmcnt(0)
    v_mfma_f32_16x16x32_bf16 v[192:195], v[212:215], v[164:167], v[192:195]
    v_mfma_f32_16x16x32_bf16 v[196:199], v[212:215], v[180:183], v[196:199]
    s_nop 3
    v_exp_f32 v184, v184
    v_exp_f32 v185, v185
    v_add_f32 v9, v9, v184
    v_add_f32 v9, v9, v185
    v_cvt_pk_bf16_f32 v88, v184, v185
    v_exp_f32 v186, v186
    v_exp_f32 v187, v187
    v_add_f32 v9, v9, v186
    v_add_f32 v9, v9, v187
    v_cvt_pk_bf16_f32 v89, v186, v187
    v_exp_f32 v188, v188
    v_exp_f32 v189, v189
    v_add_f32 v10, v10, v188
    v_add_f32 v10, v10, v189
    v_cvt_pk_bf16_f32 v92, v188, v189
    v_exp_f32 v190, v190
    v_exp_f32 v191, v191
    v_add_f32 v10, v10, v190
    v_add_f32 v10, v10, v191
    v_cvt_pk_bf16_f32 v93, v190, v191
    v_exp_f32 v192, v192
    v_exp_f32 v193, v193
    v_add_f32 v9, v9, v192
    v_add_f32 v9, v9, v193
    v_cvt_pk_bf16_f32 v90, v192, v193
    v_exp_f32 v194, v194
    v_exp_f32 v195, v195
    v_add_f32 v9, v9, v194
    v_add_f32 v9, v9, v195
    v_cvt_pk_bf16_f32 v91, v194, v195
    v_exp_f32 v196, v196
    v_exp_f32 v197, v197
    v_add_f32 v10, v10, v196
    v_add_f32 v10, v10, v197
    v_cvt_pk_bf16_f32 v94, v196, v197
    v_exp_f32 v198, v198
    v_exp_f32 v199, v199
    v_add_f32 v10, v10, v198
    v_add_f32 v10, v10, v199
    v_cvt_pk_bf16_f32 v95, v198, v199
    s_mov_b32 s17, 0x12000
    buffer_load_dwordx4 v[200:203], v8, s[8:11], s17 offen offset:0
    buffer_load_dwordx4 v[204:207], v8, s[8:11], s17 offen offset:1024
    buffer_load_dwordx4 v[208:211], v8, s[8:11], s17 offen offset:2048
    buffer_load_dwordx4 v[212:215], v8, s[8:11], s17 offen offset:3072
    s_waitcnt vmcnt(3)
    v_mfma_f32_16x16x32_bf16 v[184:187], v[200:203], v[152:155], v[216:219]
    v_mfma_f32_16x16x32_bf16 v[188:191], v[200:203], v[168:171], v[220:223]
    s_waitcnt vmcnt(2)
    v_mfma_f32_16x16x32_bf16 v[192:195], v[204:207], v[152:155], v[216:219]
    v_mfma_f32_16x16x32_bf16 v[196:199], v[204:207], v[168:171], v[220:223]
    s_waitcnt vmcnt(1)
    v_mfma_f32_16x16x32_bf16 v[184:187], v[208:211], v[156:159], v[184:187]
    v_mfma_f32_16x16x32_bf16 v[188:191], v[208:211], v[172:175], v[188:191]
    s_waitcnt vmcnt(0)
    v_mfma_f32_16x16x32_bf16 v[192:195], v[212:215], v[156:159], v[192:195]
    v_mfma_f32_16x16x32_bf16 v[196:199], v[212:215], v[172:175], v[196:199]
    s_mov_b32 s17, 0x13000
    buffer_load_dwordx4 v[200:203], v8, s[8:11], s17 offen offset:0
    buffer_load_dwordx4 v[204:207], v8, s[8:11], s17 offen offset:1024
    buffer_load_dwordx4 v[208:211], v8, s[8:11], s17 offen offset:2048
    buffer_load_dwordx4 v[212:215], v8, s[8:11], s17 offen offset:3072
    s_waitcnt vmcnt(3)
    v_mfma_f32_16x16x32_bf16 v[184:187], v[200:203], v[160:163], v[184:187]
    v_mfma_f32_16x16x32_bf16 v[188:191], v[200:203], v[176:179], v[188:191]
    s_waitcnt vmcnt(2)
    v_mfma_f32_16x16x32_bf16 v[192:195], v[204:207], v[160:163], v[192:195]
    v_mfma_f32_16x16x32_bf16 v[196:199], v[204:207], v[176:179], v[196:199]
    s_waitcnt vmcnt(1)
    v_mfma_f32_16x16x32_bf16 v[184:187], v[208:211], v[164:167], v[184:187]
    v_mfma_f32_16x16x32_bf16 v[188:191], v[208:211], v[180:183], v[188:191]
    s_waitcnt vmcnt(0)
    v_mfma_f32_16x16x32_bf16 v[192:195], v[212:215], v[164:167], v[192:195]
    v_mfma_f32_16x16x32_bf16 v[196:199], v[212:215], v[180:183], v[196:199]
    s_nop 3
    v_exp_f32 v184, v184
    v_exp_f32 v185, v185
    v_add_f32 v9, v9, v184
    v_add_f32 v9, v9, v185
    v_cvt_pk_bf16_f32 v96, v184, v185
    v_exp_f32 v186, v186
    v_exp_f32 v187, v187
    v_add_f32 v9, v9, v186
    v_add_f32 v9, v9, v187
    v_cvt_pk_bf16_f32 v97, v186, v187
    v_exp_f32 v188, v188
    v_exp_f32 v189, v189
    v_add_f32 v10, v10, v188
    v_add_f32 v10, v10, v189
    v_cvt_pk_bf16_f32 v100, v188, v189
    v_exp_f32 v190, v190
    v_exp_f32 v191, v191
    v_add_f32 v10, v10, v190
    v_add_f32 v10, v10, v191
    v_cvt_pk_bf16_f32 v101, v190, v191
    v_exp_f32 v192, v192
    v_exp_f32 v193, v193
    v_add_f32 v9, v9, v192
    v_add_f32 v9, v9, v193
    v_cvt_pk_bf16_f32 v98, v192, v193
    v_exp_f32 v194, v194
    v_exp_f32 v195, v195
    v_add_f32 v9, v9, v194
    v_add_f32 v9, v9, v195
    v_cvt_pk_bf16_f32 v99, v194, v195
    v_exp_f32 v196, v196
    v_exp_f32 v197, v197
    v_add_f32 v10, v10, v196
    v_add_f32 v10, v10, v197
    v_cvt_pk_bf16_f32 v102, v196, v197
    v_exp_f32 v198, v198
    v_exp_f32 v199, v199
    v_add_f32 v10, v10, v198
    v_add_f32 v10, v10, v199
    v_cvt_pk_bf16_f32 v103, v198, v199
    s_mov_b32 s17, 0x14000
    buffer_load_dwordx4 v[200:203], v8, s[8:11], s17 offen offset:0
    buffer_load_dwordx4 v[204:207], v8, s[8:11], s17 offen offset:1024
    buffer_load_dwordx4 v[208:211], v8, s[8:11], s17 offen offset:2048
    buffer_load_dwordx4 v[212:215], v8, s[8:11], s17 offen offset:3072
    s_waitcnt vmcnt(3)
    v_mfma_f32_16x16x32_bf16 v[184:187], v[200:203], v[152:155], v[216:219]
    v_mfma_f32_16x16x32_bf16 v[188:191], v[200:203], v[168:171], v[220:223]
    s_waitcnt vmcnt(2)
    v_mfma_f32_16x16x32_bf16 v[192:195], v[204:207], v[152:155], v[216:219]
    v_mfma_f32_16x16x32_bf16 v[196:199], v[204:207], v[168:171], v[220:223]
    s_waitcnt vmcnt(1)
    v_mfma_f32_16x16x32_bf16 v[184:187], v[208:211], v[156:159], v[184:187]
    v_mfma_f32_16x16x32_bf16 v[188:191], v[208:211], v[172:175], v[188:191]
    s_waitcnt vmcnt(0)
    v_mfma_f32_16x16x32_bf16 v[192:195], v[212:215], v[156:159], v[192:195]
    v_mfma_f32_16x16x32_bf16 v[196:199], v[212:215], v[172:175], v[196:199]
    s_mov_b32 s17, 0x15000
    buffer_load_dwordx4 v[200:203], v8, s[8:11], s17 offen offset:0
    buffer_load_dwordx4 v[204:207], v8, s[8:11], s17 offen offset:1024
    buffer_load_dwordx4 v[208:211], v8, s[8:11], s17 offen offset:2048
    buffer_load_dwordx4 v[212:215], v8, s[8:11], s17 offen offset:3072
    s_waitcnt vmcnt(3)
    v_mfma_f32_16x16x32_bf16 v[184:187], v[200:203], v[160:163], v[184:187]
    v_mfma_f32_16x16x32_bf16 v[188:191], v[200:203], v[176:179], v[188:191]
    s_waitcnt vmcnt(2)
    v_mfma_f32_16x16x32_bf16 v[192:195], v[204:207], v[160:163], v[192:195]
    v_mfma_f32_16x16x32_bf16 v[196:199], v[204:207], v[176:179], v[196:199]
    s_waitcnt vmcnt(1)
    v_mfma_f32_16x16x32_bf16 v[184:187], v[208:211], v[164:167], v[184:187]
    v_mfma_f32_16x16x32_bf16 v[188:191], v[208:211], v[180:183], v[188:191]
    s_waitcnt vmcnt(0)
    v_mfma_f32_16x16x32_bf16 v[192:195], v[212:215], v[164:167], v[192:195]
    v_mfma_f32_16x16x32_bf16 v[196:199], v[212:215], v[180:183], v[196:199]
    s_nop 3
    v_exp_f32 v184, v184
    v_exp_f32 v185, v185
    v_add_f32 v9, v9, v184
    v_add_f32 v9, v9, v185
    v_cvt_pk_bf16_f32 v104, v184, v185
    v_exp_f32 v186, v186
    v_exp_f32 v187, v187
    v_add_f32 v9, v9, v186
    v_add_f32 v9, v9, v187
    v_cvt_pk_bf16_f32 v105, v186, v187
    v_exp_f32 v188, v188
    v_exp_f32 v189, v189
    v_add_f32 v10, v10, v188
    v_add_f32 v10, v10, v189
    v_cvt_pk_bf16_f32 v108, v188, v189
    v_exp_f32 v190, v190
    v_exp_f32 v191, v191
    v_add_f32 v10, v10, v190
    v_add_f32 v10, v10, v191
    v_cvt_pk_bf16_f32 v109, v190, v191
    v_exp_f32 v192, v192
    v_exp_f32 v193, v193
    v_add_f32 v9, v9, v192
    v_add_f32 v9, v9, v193
    v_cvt_pk_bf16_f32 v106, v192, v193
    v_exp_f32 v194, v194
    v_exp_f32 v195, v195
    v_add_f32 v9, v9, v194
    v_add_f32 v9, v9, v195
    v_cvt_pk_bf16_f32 v107, v194, v195
    v_exp_f32 v196, v196
    v_exp_f32 v197, v197
    v_add_f32 v10, v10, v196
    v_add_f32 v10, v10, v197
    v_cvt_pk_bf16_f32 v110, v196, v197
    v_exp_f32 v198, v198
    v_exp_f32 v199, v199
    v_add_f32 v10, v10, v198
    v_add_f32 v10, v10, v199
    v_cvt_pk_bf16_f32 v111, v198, v199
    s_mov_b32 s17, 0x16000
    buffer_load_dwordx4 v[200:203], v8, s[8:11], s17 offen offset:0
    buffer_load_dwordx4 v[204:207], v8, s[8:11], s17 offen offset:1024
    buffer_load_dwordx4 v[208:211], v8, s[8:11], s17 offen offset:2048
    buffer_load_dwordx4 v[212:215], v8, s[8:11], s17 offen offset:3072
    s_waitcnt vmcnt(3)
    v_mfma_f32_16x16x32_bf16 v[184:187], v[200:203], v[152:155], v[216:219]
    v_mfma_f32_16x16x32_bf16 v[188:191], v[200:203], v[168:171], v[220:223]
    s_waitcnt vmcnt(2)
    v_mfma_f32_16x16x32_bf16 v[192:195], v[204:207], v[152:155], v[216:219]
    v_mfma_f32_16x16x32_bf16 v[196:199], v[204:207], v[168:171], v[220:223]
    s_waitcnt vmcnt(1)
    v_mfma_f32_16x16x32_bf16 v[184:187], v[208:211], v[156:159], v[184:187]
    v_mfma_f32_16x16x32_bf16 v[188:191], v[208:211], v[172:175], v[188:191]
    s_waitcnt vmcnt(0)
    v_mfma_f32_16x16x32_bf16 v[192:195], v[212:215], v[156:159], v[192:195]
    v_mfma_f32_16x16x32_bf16 v[196:199], v[212:215], v[172:175], v[196:199]
    s_mov_b32 s17, 0x17000
    buffer_load_dwordx4 v[200:203], v8, s[8:11], s17 offen offset:0
    buffer_load_dwordx4 v[204:207], v8, s[8:11], s17 offen offset:1024
    buffer_load_dwordx4 v[208:211], v8, s[8:11], s17 offen offset:2048
    buffer_load_dwordx4 v[212:215], v8, s[8:11], s17 offen offset:3072
    s_waitcnt vmcnt(3)
    v_mfma_f32_16x16x32_bf16 v[184:187], v[200:203], v[160:163], v[184:187]
    v_mfma_f32_16x16x32_bf16 v[188:191], v[200:203], v[176:179], v[188:191]
    s_waitcnt vmcnt(2)
    v_mfma_f32_16x16x32_bf16 v[192:195], v[204:207], v[160:163], v[192:195]
    v_mfma_f32_16x16x32_bf16 v[196:199], v[204:207], v[176:179], v[196:199]
    s_waitcnt vmcnt(1)
    v_mfma_f32_16x16x32_bf16 v[184:187], v[208:211], v[164:167], v[184:187]
    v_mfma_f32_16x16x32_bf16 v[188:191], v[208:211], v[180:183], v[188:191]
    s_waitcnt vmcnt(0)
    v_mfma_f32_16x16x32_bf16 v[192:195], v[212:215], v[164:167], v[192:195]
    v_mfma_f32_16x16x32_bf16 v[196:199], v[212:215], v[180:183], v[196:199]
    s_nop 3
    v_exp_f32 v184, v184
    v_exp_f32 v185, v185
    v_add_f32 v9, v9, v184
    v_add_f32 v9, v9, v185
    v_cvt_pk_bf16_f32 v112, v184, v185
    v_exp_f32 v186, v186
    v_exp_f32 v187, v187
    v_add_f32 v9, v9, v186
    v_add_f32 v9, v9, v187
    v_cvt_pk_bf16_f32 v113, v186, v187
    v_exp_f32 v188, v188
    v_exp_f32 v189, v189
    v_add_f32 v10, v10, v188
    v_add_f32 v10, v10, v189
    v_cvt_pk_bf16_f32 v116, v188, v189
    v_exp_f32 v190, v190
    v_exp_f32 v191, v191
    v_add_f32 v10, v10, v190
    v_add_f32 v10, v10, v191
    v_cvt_pk_bf16_f32 v117, v190, v191
    v_exp_f32 v192, v192
    v_exp_f32 v193, v193
    v_add_f32 v9, v9, v192
    v_add_f32 v9, v9, v193
    v_cvt_pk_bf16_f32 v114, v192, v193
    v_exp_f32 v194, v194
    v_exp_f32 v195, v195
    v_add_f32 v9, v9, v194
    v_add_f32 v9, v9, v195
    v_cvt_pk_bf16_f32 v115, v194, v195
    v_exp_f32 v196, v196
    v_exp_f32 v197, v197
    v_add_f32 v10, v10, v196
    v_add_f32 v10, v10, v197
    v_cvt_pk_bf16_f32 v118, v196, v197
    v_exp_f32 v198, v198
    v_exp_f32 v199, v199
    v_add_f32 v10, v10, v198
    v_add_f32 v10, v10, v199
    v_cvt_pk_bf16_f32 v119, v198, v199
    s_mov_b32 s17, 0x18000
    buffer_load_dwordx4 v[200:203], v8, s[8:11], s17 offen offset:0
    buffer_load_dwordx4 v[204:207], v8, s[8:11], s17 offen offset:1024
    buffer_load_dwordx4 v[208:211], v8, s[8:11], s17 offen offset:2048
    buffer_load_dwordx4 v[212:215], v8, s[8:11], s17 offen offset:3072
    s_waitcnt vmcnt(3)
    v_mfma_f32_16x16x32_bf16 v[184:187], v[200:203], v[152:155], v[216:219]
    v_mfma_f32_16x16x32_bf16 v[188:191], v[200:203], v[168:171], v[220:223]
    s_waitcnt vmcnt(2)
    v_mfma_f32_16x16x32_bf16 v[192:195], v[204:207], v[152:155], v[216:219]
    v_mfma_f32_16x16x32_bf16 v[196:199], v[204:207], v[168:171], v[220:223]
    s_waitcnt vmcnt(1)
    v_mfma_f32_16x16x32_bf16 v[184:187], v[208:211], v[156:159], v[184:187]
    v_mfma_f32_16x16x32_bf16 v[188:191], v[208:211], v[172:175], v[188:191]
    s_waitcnt vmcnt(0)
    v_mfma_f32_16x16x32_bf16 v[192:195], v[212:215], v[156:159], v[192:195]
    v_mfma_f32_16x16x32_bf16 v[196:199], v[212:215], v[172:175], v[196:199]
    s_mov_b32 s17, 0x19000
    buffer_load_dwordx4 v[200:203], v8, s[8:11], s17 offen offset:0
    buffer_load_dwordx4 v[204:207], v8, s[8:11], s17 offen offset:1024
    buffer_load_dwordx4 v[208:211], v8, s[8:11], s17 offen offset:2048
    buffer_load_dwordx4 v[212:215], v8, s[8:11], s17 offen offset:3072
    s_waitcnt vmcnt(3)
    v_mfma_f32_16x16x32_bf16 v[184:187], v[200:203], v[160:163], v[184:187]
    v_mfma_f32_16x16x32_bf16 v[188:191], v[200:203], v[176:179], v[188:191]
    s_waitcnt vmcnt(2)
    v_mfma_f32_16x16x32_bf16 v[192:195], v[204:207], v[160:163], v[192:195]
    v_mfma_f32_16x16x32_bf16 v[196:199], v[204:207], v[176:179], v[196:199]
    s_waitcnt vmcnt(1)
    v_mfma_f32_16x16x32_bf16 v[184:187], v[208:211], v[164:167], v[184:187]
    v_mfma_f32_16x16x32_bf16 v[188:191], v[208:211], v[180:183], v[188:191]
    s_waitcnt vmcnt(0)
    v_mfma_f32_16x16x32_bf16 v[192:195], v[212:215], v[164:167], v[192:195]
    v_mfma_f32_16x16x32_bf16 v[196:199], v[212:215], v[180:183], v[196:199]
    s_nop 3
    v_exp_f32 v184, v184
    v_exp_f32 v185, v185
    v_add_f32 v9, v9, v184
    v_add_f32 v9, v9, v185
    v_cvt_pk_bf16_f32 v120, v184, v185
    v_exp_f32 v186, v186
    v_exp_f32 v187, v187
    v_add_f32 v9, v9, v186
    v_add_f32 v9, v9, v187
    v_cvt_pk_bf16_f32 v121, v186, v187
    v_exp_f32 v188, v188
    v_exp_f32 v189, v189
    v_add_f32 v10, v10, v188
    v_add_f32 v10, v10, v189
    v_cvt_pk_bf16_f32 v124, v188, v189
    v_exp_f32 v190, v190
    v_exp_f32 v191, v191
    v_add_f32 v10, v10, v190
    v_add_f32 v10, v10, v191
    v_cvt_pk_bf16_f32 v125, v190, v191
    v_exp_f32 v192, v192
    v_exp_f32 v193, v193
    v_add_f32 v9, v9, v192
    v_add_f32 v9, v9, v193
    v_cvt_pk_bf16_f32 v122, v192, v193
    v_exp_f32 v194, v194
    v_exp_f32 v195, v195
    v_add_f32 v9, v9, v194
    v_add_f32 v9, v9, v195
    v_cvt_pk_bf16_f32 v123, v194, v195
    v_exp_f32 v196, v196
    v_exp_f32 v197, v197
    v_add_f32 v10, v10, v196
    v_add_f32 v10, v10, v197
    v_cvt_pk_bf16_f32 v126, v196, v197
    v_exp_f32 v198, v198
    v_exp_f32 v199, v199
    v_add_f32 v10, v10, v198
    v_add_f32 v10, v10, v199
    v_cvt_pk_bf16_f32 v127, v198, v199
    s_mov_b32 s17, 0x1a000
    buffer_load_dwordx4 v[200:203], v8, s[8:11], s17 offen offset:0
    buffer_load_dwordx4 v[204:207], v8, s[8:11], s17 offen offset:1024
    buffer_load_dwordx4 v[208:211], v8, s[8:11], s17 offen offset:2048
    buffer_load_dwordx4 v[212:215], v8, s[8:11], s17 offen offset:3072
    s_waitcnt vmcnt(3)
    v_mfma_f32_16x16x32_bf16 v[184:187], v[200:203], v[152:155], v[216:219]
    v_mfma_f32_16x16x32_bf16 v[188:191], v[200:203], v[168:171], v[220:223]
    s_waitcnt vmcnt(2)
    v_mfma_f32_16x16x32_bf16 v[192:195], v[204:207], v[152:155], v[216:219]
    v_mfma_f32_16x16x32_bf16 v[196:199], v[204:207], v[168:171], v[220:223]
    s_waitcnt vmcnt(1)
    v_mfma_f32_16x16x32_bf16 v[184:187], v[208:211], v[156:159], v[184:187]
    v_mfma_f32_16x16x32_bf16 v[188:191], v[208:211], v[172:175], v[188:191]
    s_waitcnt vmcnt(0)
    v_mfma_f32_16x16x32_bf16 v[192:195], v[212:215], v[156:159], v[192:195]
    v_mfma_f32_16x16x32_bf16 v[196:199], v[212:215], v[172:175], v[196:199]
    s_mov_b32 s17, 0x1b000
    buffer_load_dwordx4 v[200:203], v8, s[8:11], s17 offen offset:0
    buffer_load_dwordx4 v[204:207], v8, s[8:11], s17 offen offset:1024
    buffer_load_dwordx4 v[208:211], v8, s[8:11], s17 offen offset:2048
    buffer_load_dwordx4 v[212:215], v8, s[8:11], s17 offen offset:3072
    s_waitcnt vmcnt(3)
    v_mfma_f32_16x16x32_bf16 v[184:187], v[200:203], v[160:163], v[184:187]
    v_mfma_f32_16x16x32_bf16 v[188:191], v[200:203], v[176:179], v[188:191]
    s_waitcnt vmcnt(2)
    v_mfma_f32_16x16x32_bf16 v[192:195], v[204:207], v[160:163], v[192:195]
    v_mfma_f32_16x16x32_bf16 v[196:199], v[204:207], v[176:179], v[196:199]
    s_waitcnt vmcnt(1)
    v_mfma_f32_16x16x32_bf16 v[184:187], v[208:211], v[164:167], v[184:187]
    v_mfma_f32_16x16x32_bf16 v[188:191], v[208:211], v[180:183], v[188:191]
    s_waitcnt vmcnt(0)
    v_mfma_f32_16x16x32_bf16 v[192:195], v[212:215], v[164:167], v[192:195]
    v_mfma_f32_16x16x32_bf16 v[196:199], v[212:215], v[180:183], v[196:199]
    s_nop 3
    v_exp_f32 v184, v184
    v_exp_f32 v185, v185
    v_add_f32 v9, v9, v184
    v_add_f32 v9, v9, v185
    v_cvt_pk_bf16_f32 v128, v184, v185
    v_exp_f32 v186, v186
    v_exp_f32 v187, v187
    v_add_f32 v9, v9, v186
    v_add_f32 v9, v9, v187
    v_cvt_pk_bf16_f32 v129, v186, v187
    v_exp_f32 v188, v188
    v_exp_f32 v189, v189
    v_add_f32 v10, v10, v188
    v_add_f32 v10, v10, v189
    v_cvt_pk_bf16_f32 v132, v188, v189
    v_exp_f32 v190, v190
    v_exp_f32 v191, v191
    v_add_f32 v10, v10, v190
    v_add_f32 v10, v10, v191
    v_cvt_pk_bf16_f32 v133, v190, v191
    v_exp_f32 v192, v192
    v_exp_f32 v193, v193
    v_add_f32 v9, v9, v192
    v_add_f32 v9, v9, v193
    v_cvt_pk_bf16_f32 v130, v192, v193
    v_exp_f32 v194, v194
    v_exp_f32 v195, v195
    v_add_f32 v9, v9, v194
    v_add_f32 v9, v9, v195
    v_cvt_pk_bf16_f32 v131, v194, v195
    v_exp_f32 v196, v196
    v_exp_f32 v197, v197
    v_add_f32 v10, v10, v196
    v_add_f32 v10, v10, v197
    v_cvt_pk_bf16_f32 v134, v196, v197
    v_exp_f32 v198, v198
    v_exp_f32 v199, v199
    v_add_f32 v10, v10, v198
    v_add_f32 v10, v10, v199
    v_cvt_pk_bf16_f32 v135, v198, v199
    s_mov_b32 s17, 0x1c000
    buffer_load_dwordx4 v[200:203], v8, s[8:11], s17 offen offset:0
    buffer_load_dwordx4 v[204:207], v8, s[8:11], s17 offen offset:1024
    buffer_load_dwordx4 v[208:211], v8, s[8:11], s17 offen offset:2048
    buffer_load_dwordx4 v[212:215], v8, s[8:11], s17 offen offset:3072
    s_waitcnt vmcnt(3)
    v_mfma_f32_16x16x32_bf16 v[184:187], v[200:203], v[152:155], v[216:219]
    v_mfma_f32_16x16x32_bf16 v[188:191], v[200:203], v[168:171], v[220:223]
    s_waitcnt vmcnt(2)
    v_mfma_f32_16x16x32_bf16 v[192:195], v[204:207], v[152:155], v[216:219]
    v_mfma_f32_16x16x32_bf16 v[196:199], v[204:207], v[168:171], v[220:223]
    s_waitcnt vmcnt(1)
    v_mfma_f32_16x16x32_bf16 v[184:187], v[208:211], v[156:159], v[184:187]
    v_mfma_f32_16x16x32_bf16 v[188:191], v[208:211], v[172:175], v[188:191]
    s_waitcnt vmcnt(0)
    v_mfma_f32_16x16x32_bf16 v[192:195], v[212:215], v[156:159], v[192:195]
    v_mfma_f32_16x16x32_bf16 v[196:199], v[212:215], v[172:175], v[196:199]
    s_mov_b32 s17, 0x1d000
    buffer_load_dwordx4 v[200:203], v8, s[8:11], s17 offen offset:0
    buffer_load_dwordx4 v[204:207], v8, s[8:11], s17 offen offset:1024
    buffer_load_dwordx4 v[208:211], v8, s[8:11], s17 offen offset:2048
    buffer_load_dwordx4 v[212:215], v8, s[8:11], s17 offen offset:3072
    s_waitcnt vmcnt(3)
    v_mfma_f32_16x16x32_bf16 v[184:187], v[200:203], v[160:163], v[184:187]
    v_mfma_f32_16x16x32_bf16 v[188:191], v[200:203], v[176:179], v[188:191]
    s_waitcnt vmcnt(2)
    v_mfma_f32_16x16x32_bf16 v[192:195], v[204:207], v[160:163], v[192:195]
    v_mfma_f32_16x16x32_bf16 v[196:199], v[204:207], v[176:179], v[196:199]
    s_waitcnt vmcnt(1)
    v_mfma_f32_16x16x32_bf16 v[184:187], v[208:211], v[164:167], v[184:187]
    v_mfma_f32_16x16x32_bf16 v[188:191], v[208:211], v[180:183], v[188:191]
    s_waitcnt vmcnt(0)
    v_mfma_f32_16x16x32_bf16 v[192:195], v[212:215], v[164:167], v[192:195]
    v_mfma_f32_16x16x32_bf16 v[196:199], v[212:215], v[180:183], v[196:199]
    s_nop 3
    v_exp_f32 v184, v184
    v_exp_f32 v185, v185
    v_add_f32 v9, v9, v184
    v_add_f32 v9, v9, v185
    v_cvt_pk_bf16_f32 v136, v184, v185
    v_exp_f32 v186, v186
    v_exp_f32 v187, v187
    v_add_f32 v9, v9, v186
    v_add_f32 v9, v9, v187
    v_cvt_pk_bf16_f32 v137, v186, v187
    v_exp_f32 v188, v188
    v_exp_f32 v189, v189
    v_add_f32 v10, v10, v188
    v_add_f32 v10, v10, v189
    v_cvt_pk_bf16_f32 v140, v188, v189
    v_exp_f32 v190, v190
    v_exp_f32 v191, v191
    v_add_f32 v10, v10, v190
    v_add_f32 v10, v10, v191
    v_cvt_pk_bf16_f32 v141, v190, v191
    v_exp_f32 v192, v192
    v_exp_f32 v193, v193
    v_add_f32 v9, v9, v192
    v_add_f32 v9, v9, v193
    v_cvt_pk_bf16_f32 v138, v192, v193
    v_exp_f32 v194, v194
    v_exp_f32 v195, v195
    v_add_f32 v9, v9, v194
    v_add_f32 v9, v9, v195
    v_cvt_pk_bf16_f32 v139, v194, v195
    v_exp_f32 v196, v196
    v_exp_f32 v197, v197
    v_add_f32 v10, v10, v196
    v_add_f32 v10, v10, v197
    v_cvt_pk_bf16_f32 v142, v196, v197
    v_exp_f32 v198, v198
    v_exp_f32 v199, v199
    v_add_f32 v10, v10, v198
    v_add_f32 v10, v10, v199
    v_cvt_pk_bf16_f32 v143, v198, v199
    s_mov_b32 s17, 0x1e000
    buffer_load_dwordx4 v[200:203], v8, s[8:11], s17 offen offset:0
    buffer_load_dwordx4 v[204:207], v8, s[8:11], s17 offen offset:1024
    buffer_load_dwordx4 v[208:211], v8, s[8:11], s17 offen offset:2048
    buffer_load_dwordx4 v[212:215], v8, s[8:11], s17 offen offset:3072
    s_waitcnt vmcnt(3)
    v_mfma_f32_16x16x32_bf16 v[184:187], v[200:203], v[152:155], v[216:219]
    v_mfma_f32_16x16x32_bf16 v[188:191], v[200:203], v[168:171], v[220:223]
    s_waitcnt vmcnt(2)
    v_mfma_f32_16x16x32_bf16 v[192:195], v[204:207], v[152:155], v[216:219]
    v_mfma_f32_16x16x32_bf16 v[196:199], v[204:207], v[168:171], v[220:223]
    s_waitcnt vmcnt(1)
    v_mfma_f32_16x16x32_bf16 v[184:187], v[208:211], v[156:159], v[184:187]
    v_mfma_f32_16x16x32_bf16 v[188:191], v[208:211], v[172:175], v[188:191]
    s_waitcnt vmcnt(0)
    v_mfma_f32_16x16x32_bf16 v[192:195], v[212:215], v[156:159], v[192:195]
    v_mfma_f32_16x16x32_bf16 v[196:199], v[212:215], v[172:175], v[196:199]
    s_mov_b32 s17, 0x1f000
    buffer_load_dwordx4 v[200:203], v8, s[8:11], s17 offen offset:0
    buffer_load_dwordx4 v[204:207], v8, s[8:11], s17 offen offset:1024
    buffer_load_dwordx4 v[208:211], v8, s[8:11], s17 offen offset:2048
    buffer_load_dwordx4 v[212:215], v8, s[8:11], s17 offen offset:3072
    s_waitcnt vmcnt(3)
    v_mfma_f32_16x16x32_bf16 v[184:187], v[200:203], v[160:163], v[184:187]
    v_mfma_f32_16x16x32_bf16 v[188:191], v[200:203], v[176:179], v[188:191]
    s_waitcnt vmcnt(2)
    v_mfma_f32_16x16x32_bf16 v[192:195], v[204:207], v[160:163], v[192:195]
    v_mfma_f32_16x16x32_bf16 v[196:199], v[204:207], v[176:179], v[196:199]
    s_waitcnt vmcnt(1)
    v_mfma_f32_16x16x32_bf16 v[184:187], v[208:211], v[164:167], v[184:187]
    v_mfma_f32_16x16x32_bf16 v[188:191], v[208:211], v[180:183], v[188:191]
    s_waitcnt vmcnt(0)
    v_mfma_f32_16x16x32_bf16 v[192:195], v[212:215], v[164:167], v[192:195]
    v_mfma_f32_16x16x32_bf16 v[196:199], v[212:215], v[180:183], v[196:199]
    s_nop 3
    v_exp_f32 v184, v184
    v_exp_f32 v185, v185
    v_add_f32 v9, v9, v184
    v_add_f32 v9, v9, v185
    v_cvt_pk_bf16_f32 v144, v184, v185
    v_exp_f32 v186, v186
    v_exp_f32 v187, v187
    v_add_f32 v9, v9, v186
    v_add_f32 v9, v9, v187
    v_cvt_pk_bf16_f32 v145, v186, v187
    v_exp_f32 v188, v188
    v_exp_f32 v189, v189
    v_add_f32 v10, v10, v188
    v_add_f32 v10, v10, v189
    v_cvt_pk_bf16_f32 v148, v188, v189
    v_exp_f32 v190, v190
    v_exp_f32 v191, v191
    v_add_f32 v10, v10, v190
    v_add_f32 v10, v10, v191
    v_cvt_pk_bf16_f32 v149, v190, v191
    v_exp_f32 v192, v192
    v_exp_f32 v193, v193
    v_add_f32 v9, v9, v192
    v_add_f32 v9, v9, v193
    v_cvt_pk_bf16_f32 v146, v192, v193
    v_exp_f32 v194, v194
    v_exp_f32 v195, v195
    v_add_f32 v9, v9, v194
    v_add_f32 v9, v9, v195
    v_cvt_pk_bf16_f32 v147, v194, v195
    v_exp_f32 v196, v196
    v_exp_f32 v197, v197
    v_add_f32 v10, v10, v196
    v_add_f32 v10, v10, v197
    v_cvt_pk_bf16_f32 v150, v196, v197
    v_exp_f32 v198, v198
    v_exp_f32 v199, v199
    v_add_f32 v10, v10, v198
    v_add_f32 v10, v10, v199
    v_cvt_pk_bf16_f32 v151, v198, v199
    v_mov_b32 v16, v9
    v_mov_b32 v18, v10
    s_nop 0
    v_permlane16_swap_b32 v9, v16
    v_permlane16_swap_b32 v10, v18
    v_add_f32 v9, v9, v16
    v_add_f32 v10, v10, v18
    v_mov_b32 v16, v9
    v_mov_b32 v18, v10
    s_nop 0
    v_permlane32_swap_b32 v9, v16
    v_permlane32_swap_b32 v10, v18
    v_add_f32 v9, v9, v16
    v_add_f32 v10, v10, v18
    s_waitcnt vmcnt(0) lgkmcnt(0)
    s_nop 15
    s_nop 3
    s_branch adaLN_cond__sliding_block_cached__moe_arch_mod__prompt_kernel_fixBb
adaLN_cond__sliding_block_cached__moe_arch_mod__prompt_kernel_o218r:
    s_waitcnt vmcnt(0) lgkmcnt(0)
    s_nop 15
    s_nop 3
    s_mov_b32 s27, 0
adaLN_cond__sliding_block_cached__moe_arch_mod__prompt_kernel_o218p:
    buffer_load_dword v12, v13, s[8:11], s17 offen sc1
    s_waitcnt vmcnt(0)
    v_cmp_ne_u32 vcc, s28, v12
    s_add_u32 s27, s27, 1
    s_cmp_ge_u32 s27, 262144
    s_cbranch_scc1 adaLN_cond__sliding_block_cached__moe_arch_mod__prompt_kernel_o218g
    s_cbranch_vccnz adaLN_cond__sliding_block_cached__moe_arch_mod__prompt_kernel_o218p
adaLN_cond__sliding_block_cached__moe_arch_mod__prompt_kernel_o218g:
    s_waitcnt vmcnt(0) lgkmcnt(0)
    s_nop 15
    s_nop 3
    s_branch adaLN_cond__sliding_block_cached__moe_arch_mod__prompt_kernel_o218b
adaLN_cond__sliding_block_cached__moe_arch_mod__prompt_kernel_o219r:
    s_waitcnt vmcnt(0) lgkmcnt(0)
    s_nop 15
    s_nop 3
    s_mov_b32 s27, 0
adaLN_cond__sliding_block_cached__moe_arch_mod__prompt_kernel_o219p:
    buffer_load_dword v12, v13, s[8:11], s17 offen sc1
    s_waitcnt vmcnt(0)
    v_cmp_ne_u32 vcc, s28, v12
    s_add_u32 s27, s27, 1
    s_cmp_ge_u32 s27, 262144
    s_cbranch_scc1 adaLN_cond__sliding_block_cached__moe_arch_mod__prompt_kernel_o219g
    s_cbranch_vccnz adaLN_cond__sliding_block_cached__moe_arch_mod__prompt_kernel_o219p
adaLN_cond__sliding_block_cached__moe_arch_mod__prompt_kernel_o219g:
    s_waitcnt vmcnt(0) lgkmcnt(0)
    s_nop 15
    s_nop 3
    s_branch adaLN_cond__sliding_block_cached__moe_arch_mod__prompt_kernel_o219b
adaLN_cond__sliding_block_cached__moe_arch_mod__prompt_kernel_o220r:
    s_waitcnt vmcnt(0) lgkmcnt(0)
    s_nop 15
    s_nop 3
    s_mov_b32 s27, 0
adaLN_cond__sliding_block_cached__moe_arch_mod__prompt_kernel_o220p:
    buffer_load_dword v12, v13, s[8:11], s17 offen sc1
    s_waitcnt vmcnt(0)
    v_cmp_ne_u32 vcc, s28, v12
    s_add_u32 s27, s27, 1
    s_cmp_ge_u32 s27, 262144
    s_cbranch_scc1 adaLN_cond__sliding_block_cached__moe_arch_mod__prompt_kernel_o220g
    s_cbranch_vccnz adaLN_cond__sliding_block_cached__moe_arch_mod__prompt_kernel_o220p
adaLN_cond__sliding_block_cached__moe_arch_mod__prompt_kernel_o220g:
    s_waitcnt vmcnt(0) lgkmcnt(0)
    s_nop 15
    s_nop 3
    s_branch adaLN_cond__sliding_block_cached__moe_arch_mod__prompt_kernel_o220b
adaLN_cond__sliding_block_cached__moe_arch_mod__prompt_kernel_mf21r:
    s_waitcnt vmcnt(0) lgkmcnt(0)
    s_nop 15
    s_nop 3
    s_mov_b32 s27, 0
adaLN_cond__sliding_block_cached__moe_arch_mod__prompt_kernel_mf21p:
    s_mov_b32 s16, 0x544000
    buffer_load_dwordx4 v[184:187], v2, s[8:11], s16 offen sc1
    s_waitcnt vmcnt(0)
    v_xor_b32 v16, s28, v184
    v_xor_b32 v17, s28, v185
    v_xor_b32 v18, s28, v186
    v_xor_b32 v19, s28, v187
    v_or3_b32 v16, v16, v17, v18
    v_or_b32 v16, v16, v19
    v_cmp_ne_u32 vcc, 0, v16
    s_add_u32 s27, s27, 1
    s_cmp_ge_u32 s27, 262144
    s_cbranch_scc1 adaLN_cond__sliding_block_cached__moe_arch_mod__prompt_kernel_mf21g
    s_cbranch_vccnz adaLN_cond__sliding_block_cached__moe_arch_mod__prompt_kernel_mf21p
adaLN_cond__sliding_block_cached__moe_arch_mod__prompt_kernel_mf21g:
    s_waitcnt vmcnt(0) lgkmcnt(0)
    s_nop 15
    s_nop 3
    s_branch adaLN_cond__sliding_block_cached__moe_arch_mod__prompt_kernel_mf21b
.section .rodata,"a"
.p2align 6
.amdhsa_kernel adaLN_cond__sliding_block_cached__moe_arch_mod__prompt_kernel
  .amdhsa_next_free_vgpr 256
  .amdhsa_next_free_sgpr 80
  .amdhsa_accum_offset 256
  .amdhsa_group_segment_fixed_size 0
  .amdhsa_kernarg_size 120
  .amdhsa_user_sgpr_count 2
  .amdhsa_user_sgpr_kernarg_segment_ptr 1
  .amdhsa_system_sgpr_workgroup_id_x 1
  .amdhsa_float_denorm_mode_32 3
.end_amdhsa_kernel
```

```asm
; @launch grid=(256,1,1) block=(512,1,1) lds=163840
.amdgcn_target "amdgcn-amd-amdhsa--gfx950"
.text
.globl adaLN_cond__sliding_block_cached__moe_arch_mod__prompt_kernel
.p2align 8
.type adaLN_cond__sliding_block_cached__moe_arch_mod__prompt_kernel,@function
adaLN_cond__sliding_block_cached__moe_arch_mod__prompt_kernel:
    s_cmp_ge_u32 s2, 256
    s_cbranch_scc1 adaLN_cond__sliding_block_cached__moe_arch_mod__prompt_kernel_end
    s_load_dwordx4 s[56:59], s[0:1], 96
    s_load_dwordx2 s[60:61], s[0:1], 112
    s_load_dwordx8 s[48:55], s[0:1], 64
    s_load_dwordx16 s[32:47], s[0:1], 0
    s_memrealtime s[62:63]
    v_lshrrev_b32 v16, 6, v0
    v_and_b32 v1, 63, v0
    v_readfirstlane_b32 s3, v16
    v_lshlrev_b32 v2, 4, v1
    s_and_b32 s12, s2, 3
    s_lshl_b32 s12, s12, 3
    s_bfe_u32 s13, s2, 0x30003
    s_add_u32 s12, s12, s13
    s_bfe_u32 s13, s2, 0x10002
    s_lshl_b32 s13, s13, 2
    s_lshr_b32 s14, s2, 6
    s_add_u32 s13, s13, s14
    v_bfe_u32 v16, v1, 2, 2
    v_lshrrev_b32 v17, 4, v1
    v_and_b32 v18, 3, v1
    v_lshlrev_b32 v19, 6, v17
    v_lshl_add_u32 v19, v18, 4, v19
    v_lshl_add_u32 v3, v16, 13, v19
    s_and_b32 s14, s3, 1
    s_lshl_b32 s14, s14, 5
    v_xor_b32 v3, s14, v3
    v_lshlrev_b32 v4, 11, v17
    v_lshl_add_u32 v4, v16, 6, v4
    v_lshl_add_u32 v4, v18, 3, v4
    v_and_b32 v20, 1, v17
    v_lshlrev_b32 v20, 5, v20
    v_sub_u32 v5, v4, v20
    v_add_u32 v4, v4, v20
    s_lshl_b32 s14, s13, 3
    s_add_u32 s14, s14, s3
    s_lshl_b32 s14, s14, 16
    v_add_u32 v7, s14, v2
    s_cmp_ge_u32 s3, 4
    s_cbranch_scc1 adaLN_cond__sliding_block_cached__moe_arch_mod__prompt_kernel_roleB
    v_mov_b32 v132, 0
    v_mov_b32 v133, 0
    v_lshrrev_b32 v16, 3, v0
    v_and_b32 v17, 7, v0
    v_mul_u32_u24 v135, 24576, v16
    v_lshl_add_u32 v135, v17, 4, v135
    v_lshlrev_b32 v136, 2, v16
    s_and_b32 s14, s2, 31
    s_lshr_b32 s15, s2, 5
    s_mul_i32 s26, s15, 1572864
    s_lshl_b32 s16, s14, 7
    s_add_u32 s26, s26, s16
    s_lshl_b32 s29, s15, 8
    v_lshlrev_b32 v137, 3, v0
    s_lshl_b32 s18, s2, 3
    s_add_u32 s18, s18, s3
    s_lshl_b32 s18, s18, 11
    v_and_b32 v18, 15, v1
    v_lshrrev_b32 v19, 4, v1
    v_lshlrev_b32 v138, 11, v18
    v_lshl_add_u32 v138, v19, 4, v138
    s_lshr_b32 s30, s2, 4
    s_and_b32 s31, s2, 15
    s_lshl_b32 s19, s30, 3
    s_add_u32 s19, s19, s3
    s_lshl_b32 s22, s19, 15
    s_lshl_b32 s23, s31, 7
    s_add_u32 s22, s22, s23
    s_lshl_b32 s23, s2, 12
    s_add_u32 s23, s23, 0x600000
    s_or_b32 s25, s2, s3
    s_cmp_eq_u32 s25, 0
    s_cselect_b32 s25, 0, 0x7ffffff0
    s_waitcnt lgkmcnt(0)
    s_mov_b64 s[64:65], s[58:59]
    s_mov_b32 s66, 0x100
    s_mov_b32 s67, 0x20000
    s_or_b32 s28, s62, 1
    v_mov_b32 v134, s28
    s_mov_b64 exec, 1
    buffer_store_dword v134, v132, s[64:67], s25 offen sc1
    s_mov_b64 exec, -1
    s_mov_b64 s[68:69], s[52:53]
    s_mov_b32 s70, 0x800
    s_mov_b32 s71, 0x20000
    s_mov_b64 s[72:73], s[54:55]
    s_mov_b32 s74, 0xc00000
    s_mov_b32 s75, 0x20000
    s_mov_b64 s[76:77], s[32:33]
    s_mov_b32 s78, 0x400000
    s_mov_b32 s79, 0x20000
    s_mov_b64 s[8:9], s[60:61]
    s_mov_b32 s10, 0x3400000
    s_mov_b32 s11, 0x20000
    buffer_load_dword v72, v136, s[68:71], s29 offen
    buffer_load_dwordx4 v[24:27], v135, s[72:75], s26 offen
    s_add_u32 s26, s26, 12288
    buffer_load_dwordx4 v[28:31], v135, s[72:75], s26 offen
    buffer_load_dwordx4 v[32:35], v2, s[76:79], s18 offen offset:0
    buffer_load_dwordx4 v[36:39], v2, s[76:79], s18 offen offset:1024
    s_cmp_eq_u32 s3, 0
    s_cselect_b32 s25, 0, 0x7ffffff0
    buffer_load_dword v134, v132, s[64:67], s25 offen sc1
    buffer_store_dwordx2 v[132:133], v137, s[8:11], s23 offen sc1
    s_barrier
    buffer_load_dwordx4 v[40:43], v138, s[76:79], s22 offen offset:0
    buffer_load_dwordx4 v[44:47], v138, s[76:79], s22 offen offset:64
    s_mov_b32 s29, s19
    s_waitcnt vmcnt(8)
    v_and_b32 v73, 0xffff0000, v72
    v_lshlrev_b32 v72, 16, v72
    v_mul_f32 v16, 0xbfb8aa3b, v72
    v_exp_f32 v16, v16
    s_nop 0
    v_add_f32 v16, 1.0, v16
    v_rcp_f32 v16, v16
    s_nop 0
    v_mul_f32 v72, v72, v16
    v_mul_f32 v17, 0xbfb8aa3b, v73
    v_exp_f32 v17, v17
    s_nop 0
    v_add_f32 v17, 1.0, v17
    v_rcp_f32 v17, v17
    s_nop 0
    v_mul_f32 v73, v73, v17
    v_cvt_pk_bf16_f32 v16, v72, v73
    v_lshlrev_b32 v72, 16, v16
    v_and_b32 v73, 0xffff0000, v16
    s_lshl_b32 s16, s2, 8
    s_add_u32 s16, s16, 0x550000
    s_mov_b32 exec_lo, 0x01010101
    s_mov_b32 exec_hi, 0x01010101
    buffer_store_dword v16, v136, s[8:11], s16 offen sc1
    s_mov_b64 exec, -1
    v_lshrrev_b32 v74, 16, v72
    v_lshrrev_b32 v75, 16, v73
    s_waitcnt vmcnt(8)
    v_dot2_f32_bf16 v49, v24, v72, 0
    v_dot2_f32_bf16 v48, v24, v74, 0
    v_dot2_f32_bf16 v51, v25, v72, 0
    v_dot2_f32_bf16 v50, v25, v74, 0
    v_dot2_f32_bf16 v53, v26, v72, 0
    v_dot2_f32_bf16 v52, v26, v74, 0
    v_dot2_f32_bf16 v55, v27, v72, 0
    v_dot2_f32_bf16 v54, v27, v74, 0
    s_waitcnt vmcnt(7)
    v_dot2c_f32_bf16 v49, v28, v73
    v_dot2c_f32_bf16 v48, v28, v75
    v_dot2c_f32_bf16 v51, v29, v73
    v_dot2c_f32_bf16 v50, v29, v75
    v_dot2c_f32_bf16 v53, v30, v73
    v_dot2c_f32_bf16 v52, v30, v75
    v_dot2c_f32_bf16 v55, v31, v73
    v_dot2c_f32_bf16 v54, v31, v75
    s_nop 0
    v_permlane32_swap_b32 v48, v52
    v_permlane32_swap_b32 v49, v53
    v_permlane32_swap_b32 v50, v54
    v_permlane32_swap_b32 v51, v55
    v_add_f32 v48, v48, v52
    v_add_f32 v49, v49, v53
    v_add_f32 v50, v50, v54
    v_add_f32 v51, v51, v55
    s_nop 0
    v_permlane16_swap_b32 v48, v50
    v_permlane16_swap_b32 v49, v51
    v_add_f32 v48, v48, v50
    v_add_f32 v49, v49, v51
    s_nop 0
    v_add_f32_dpp v48, v48, v48 row_ror:8 row_mask:0xf bank_mask:0xf
    v_add_f32_dpp v49, v49, v49 row_ror:8 row_mask:0xf bank_mask:0xf
    v_and_b32 v16, 7, v1
    v_lshlrev_b32 v16, 5, v16
    v_lshrrev_b32 v17, 4, v1
    v_lshl_add_u32 v16, v17, 3, v16
    s_lshl_b32 s16, s3, 8
    s_add_u32 s16, s16, 65536
    v_add_u32 v16, s16, v16
    ds_write_b64 v16, v[48:49]
    s_waitcnt vmcnt(6)
    v_lshlrev_b32 v56, 16, v32
    v_and_b32 v57, 0xffff0000, v32
    v_lshlrev_b32 v58, 16, v33
    v_and_b32 v59, 0xffff0000, v33
    v_lshlrev_b32 v60, 16, v34
    v_and_b32 v61, 0xffff0000, v34
    v_lshlrev_b32 v62, 16, v35
    v_and_b32 v63, 0xffff0000, v35
    s_waitcnt vmcnt(5)
    v_lshlrev_b32 v64, 16, v36
    v_and_b32 v65, 0xffff0000, v36
    v_lshlrev_b32 v66, 16, v37
    v_and_b32 v67, 0xffff0000, v37
    v_lshlrev_b32 v68, 16, v38
    v_and_b32 v69, 0xffff0000, v38
    v_lshlrev_b32 v70, 16, v39
    v_and_b32 v71, 0xffff0000, v39
    v_add_f32 v20, v56, v57
    v_add_f32 v21, v58, v59
    v_add_f32 v20, v20, v60
    v_add_f32 v21, v21, v61
    v_add_f32 v20, v20, v62
    v_add_f32 v21, v21, v63
    v_add_f32 v20, v20, v64
    v_add_f32 v21, v21, v65
    v_add_f32 v20, v20, v66
    v_add_f32 v21, v21, v67
    v_add_f32 v20, v20, v68
    v_add_f32 v21, v21, v69
    v_add_f32 v20, v20, v70
    v_add_f32 v21, v21, v71
    v_add_f32 v128, v20, v21
    s_nop 1
    v_add_f32_dpp v128, v128, v128 row_ror:1 row_mask:0xf bank_mask:0xf
    s_nop 1
    v_add_f32_dpp v128, v128, v128 row_ror:2 row_mask:0xf bank_mask:0xf
    s_nop 1
    v_add_f32_dpp v128, v128, v128 row_ror:4 row_mask:0xf bank_mask:0xf
    s_nop 1
    v_add_f32_dpp v128, v128, v128 row_ror:8 row_mask:0xf bank_mask:0xf
    v_mov_b32 v20, v128
    s_nop 1
    v_permlane16_swap_b32 v128, v20
    v_add_f32 v128, v128, v20
    v_mov_b32 v20, v128
    s_nop 1
    v_permlane32_swap_b32 v128, v20
    v_add_f32 v128, v128, v20
    v_mul_f32 v128, 0x3a800000, v128
    v_sub_f32 v18, v56, v128
    v_mul_f32 v20, v18, v18
    v_sub_f32 v19, v57, v128
    v_mul_f32 v21, v19, v19
    v_sub_f32 v18, v58, v128
    v_sub_f32 v19, v59, v128
    v_fmac_f32 v20, v18, v18
    v_fmac_f32 v21, v19, v19
    v_sub_f32 v18, v60, v128
    v_sub_f32 v19, v61, v128
    v_fmac_f32 v20, v18, v18
    v_fmac_f32 v21, v19, v19
    v_sub_f32 v18, v62, v128
    v_sub_f32 v19, v63, v128
    v_fmac_f32 v20, v18, v18
    v_fmac_f32 v21, v19, v19
    v_sub_f32 v18, v64, v128
    v_sub_f32 v19, v65, v128
    v_fmac_f32 v20, v18, v18
    v_fmac_f32 v21, v19, v19
    v_sub_f32 v18, v66, v128
    v_sub_f32 v19, v67, v128
    v_fmac_f32 v20, v18, v18
    v_fmac_f32 v21, v19, v19
    v_sub_f32 v18, v68, v128
    v_sub_f32 v19, v69, v128
    v_fmac_f32 v20, v18, v18
    v_fmac_f32 v21, v19, v19
    v_sub_f32 v18, v70, v128
    v_sub_f32 v19, v71, v128
    v_fmac_f32 v20, v18, v18
    v_fmac_f32 v21, v19, v19
    v_add_f32 v17, v20, v21
    s_nop 1
    v_add_f32_dpp v17, v17, v17 row_ror:1 row_mask:0xf bank_mask:0xf
    s_nop 1
    v_add_f32_dpp v17, v17, v17 row_ror:2 row_mask:0xf bank_mask:0xf
    s_nop 1
    v_add_f32_dpp v17, v17, v17 row_ror:4 row_mask:0xf bank_mask:0xf
    s_nop 1
    v_add_f32_dpp v17, v17, v17 row_ror:8 row_mask:0xf bank_mask:0xf
    v_mov_b32 v20, v17
    s_nop 1
    v_permlane16_swap_b32 v17, v20
    v_add_f32 v17, v17, v20
    v_mov_b32 v20, v17
    s_nop 1
    v_permlane32_swap_b32 v17, v20
    v_add_f32 v17, v17, v20
    v_mul_f32 v17, 0x3a800000, v17
    v_cvt_pk_bf16_f32 v128, v128, v128
    v_lshlrev_b32 v128, 16, v128
    v_cvt_pk_bf16_f32 v17, v17, v17
    v_lshlrev_b32 v17, 16, v17
    v_add_f32 v17, 0x3727c5ac, v17
    v_cvt_pk_bf16_f32 v17, v17, v17
    v_lshlrev_b32 v17, 16, v17
    v_sqrt_f32 v129, v17
    s_nop 0
    v_cvt_pk_bf16_f32 v129, v129, v129
    v_lshlrev_b32 v129, 16, v129
    v_rcp_f32 v130, v129
    s_lshl_b32 s16, s3, 4
    s_add_u32 s16, s16, 67600
    v_mov_b32 v19, s16
    ds_write_b128 v19, v[128:131]
    s_waitcnt vmcnt(4)
    v_cmp_eq_u32 vcc, 0, v134
    s_cmp_eq_u32 s3, 0
    s_cselect_b64 s[62:63], -1, 0
    s_and_b64 vcc, vcc, s[62:63]
    s_cbranch_vccnz adaLN_cond__sliding_block_cached__moe_arch_mod__prompt_kernel_n1r
adaLN_cond__sliding_block_cached__moe_arch_mod__prompt_kernel_n1b:
    v_mov_b32 v19, 67584
    s_cmp_eq_u32 s3, 0
    s_cselect_b64 exec, 1, 0
    ds_write_b32 v19, v134
    s_mov_b64 exec, -1
    v_mov_b32 v19, 67584
    v_and_b32 v17, 31, v1
    v_lshlrev_b32 v18, 3, v17
    v_add_u32 v18, 65536, v18
    v_lshlrev_b32 v17, 4, v17
    s_waitcnt lgkmcnt(0)
    s_barrier
    ds_read_b32 v134, v19
    ds_read_b64 v[96:97], v18 offset:0
    ds_read_b64 v[100:101], v18 offset:256
    ds_read_b64 v[104:105], v18 offset:512
    ds_read_b64 v[108:109], v18 offset:768
    ds_read_b64 v[112:113], v18 offset:1024
    ds_read_b64 v[116:117], v18 offset:1280
    ds_read_b64 v[120:121], v18 offset:1536
    ds_read_b64 v[124:125], v18 offset:1792
    s_waitcnt lgkmcnt(8)
    v_readfirstlane_b32 s28, v134
    v_and_b32 v20, 7, v1
    v_lshlrev_b32 v20, 4, v20
    v_add_u32 v21, 67600, v20
    ds_read_b128 v[128:131], v21
    s_waitcnt lgkmcnt(0)
    v_mov_b32 v131, s28
    s_lshl_b32 s16, s2, 7
    s_add_u32 s16, s16, 0x520000
    s_cmp_eq_u32 s3, 0
    s_cselect_b32 s16, s16, 0x7ffffff0
    s_mov_b64 exec, 0xff
    buffer_store_dwordx4 v[128:131], v20, s[8:11], s16 offen sc1
    s_mov_b64 exec, -1
    v_pk_add_f32 v[96:97], v[96:97], v[112:113]
    v_pk_add_f32 v[100:101], v[100:101], v[116:117]
    v_pk_add_f32 v[104:105], v[104:105], v[120:121]
    v_pk_add_f32 v[108:109], v[108:109], v[124:125]
    v_pk_add_f32 v[96:97], v[96:97], v[104:105]
    v_pk_add_f32 v[100:101], v[100:101], v[108:109]
    v_pk_add_f32 v[96:97], v[96:97], v[100:101]
    v_mov_b32 v98, s28
    v_mov_b32 v99, s28
    s_lshl_b32 s16, s14, 3
    s_add_u32 s16, s16, s15
    s_lshl_b32 s16, s16, 9
    s_add_u32 s16, s16, 0x500000
    s_cmp_eq_u32 s3, 0
    s_cselect_b32 s16, s16, 0x7ffffff0
    s_mov_b64 exec, 0xffffffff
    buffer_store_dwordx4 v[96:99], v17, s[8:11], s16 offen sc1
    s_mov_b64 exec, -1
    s_lshr_b32 s16, s3, 2
    s_lshl_b32 s16, s16, 4
    s_add_u32 s16, s16, s31
    s_lshl_b32 s16, s16, 12
    s_and_b32 s17, s3, 3
    s_lshl_b32 s17, s17, 7
    s_add_u32 s16, s16, s17
    s_add_u32 s16, s16, 0x500000
    v_lshrrev_b32 v139, 3, v1
    v_lshlrev_b32 v139, 9, v139
    v_and_b32 v16, 7, v1
    v_lshl_add_u32 v139, v16, 4, v139
    v_and_b32 v140, 15, v1
    v_lshlrev_b32 v140, 4, v140
    s_lshl_b32 s17, s29, 8
    s_add_u32 s17, s17, 0x520000
    s_waitcnt vmcnt(4)
    v_lshlrev_b32 v56, 16, v40
    v_and_b32 v57, 0xffff0000, v40
    v_lshlrev_b32 v58, 16, v41
    v_and_b32 v59, 0xffff0000, v41
    v_lshlrev_b32 v60, 16, v42
    v_and_b32 v61, 0xffff0000, v42
    v_lshlrev_b32 v62, 16, v43
    v_and_b32 v63, 0xffff0000, v43
    s_waitcnt vmcnt(3)
    v_lshlrev_b32 v64, 16, v44
    v_and_b32 v65, 0xffff0000, v44
    v_lshlrev_b32 v66, 16, v45
    v_and_b32 v67, 0xffff0000, v45
    v_lshlrev_b32 v68, 16, v46
    v_and_b32 v69, 0xffff0000, v46
    v_lshlrev_b32 v70, 16, v47
    v_and_b32 v71, 0xffff0000, v47
    s_mov_b32 s27, 0
adaLN_cond__sliding_block_cached__moe_arch_mod__prompt_kernel_g2p:
    buffer_load_dwordx4 v[76:79], v139, s[8:11], s16 offen sc1
    buffer_load_dwordx4 v[80:83], v140, s[8:11], s17 offen sc1
    s_waitcnt vmcnt(1)
    v_cmp_ne_u32 vcc, s28, v78
    v_cmp_ne_u32 s[62:63], s28, v79
    s_or_b64 vcc, vcc, s[62:63]
    s_waitcnt vmcnt(0)
    v_cmp_ne_u32 s[62:63], s28, v83
    s_or_b64 vcc, vcc, s[62:63]
    s_add_u32 s27, s27, 1
    s_cmp_ge_u32 s27, 262144
    s_cbranch_scc1 adaLN_cond__sliding_block_cached__moe_arch_mod__prompt_kernel_g2g
    s_cbranch_vccnz adaLN_cond__sliding_block_cached__moe_arch_mod__prompt_kernel_g2p
adaLN_cond__sliding_block_cached__moe_arch_mod__prompt_kernel_g2g:
    v_add_f32_dpp v76, v76, v76 row_ror:8 row_mask:0xf bank_mask:0xf
    v_add_f32_dpp v77, v77, v77 row_ror:8 row_mask:0xf bank_mask:0xf
    v_mov_b32 v17, v76
    s_nop 1
    v_permlane16_swap_b32 v76, v17
    v_add_f32 v76, v76, v17
    v_mov_b32 v18, v77
    s_nop 1
    v_permlane16_swap_b32 v77, v18
    v_add_f32 v77, v77, v18
    v_mov_b32 v17, v76
    s_nop 1
    v_permlane32_swap_b32 v76, v17
    v_add_f32 v76, v76, v17
    v_mov_b32 v18, v77
    s_nop 1
    v_permlane32_swap_b32 v77, v18
    v_add_f32 v77, v77, v18
    v_cvt_pk_bf16_f32 v17, v76, v77
    v_lshlrev_b32 v76, 16, v17
    v_and_b32 v77, 0xffff0000, v17
    v_add_f32 v76, 0, v76
    v_add_f32 v77, 0, v77
    s_lshl_b32 s16, s3, 6
    s_add_u32 s16, s16, 69632
    v_lshl_add_u32 v16, v16, 3, s16
    ds_write_b64 v16, v[76:77]
    v_lshrrev_b32 v17, 4, v1
    v_lshlrev_b32 v17, 5, v17
    v_add_u32 v17, 69632, v17
    v_sub_f32 v56, v56, v80
    v_sub_f32 v57, v57, v80
    v_sub_f32 v58, v58, v80
    v_sub_f32 v59, v59, v80
    v_sub_f32 v60, v60, v80
    v_sub_f32 v61, v61, v80
    v_sub_f32 v62, v62, v80
    v_sub_f32 v63, v63, v80
    v_sub_f32 v64, v64, v80
    v_sub_f32 v65, v65, v80
    v_sub_f32 v66, v66, v80
    v_sub_f32 v67, v67, v80
    v_sub_f32 v68, v68, v80
    v_sub_f32 v69, v69, v80
    v_sub_f32 v70, v70, v80
    v_sub_f32 v71, v71, v80
    v_cvt_pk_bf16_f32 v18, v56, v57
    v_lshlrev_b32 v56, 16, v18
    v_and_b32 v57, 0xffff0000, v18
    v_cvt_pk_bf16_f32 v19, v58, v59
    v_lshlrev_b32 v58, 16, v19
    v_and_b32 v59, 0xffff0000, v19
    v_cvt_pk_bf16_f32 v18, v60, v61
    v_lshlrev_b32 v60, 16, v18
    v_and_b32 v61, 0xffff0000, v18
    v_cvt_pk_bf16_f32 v19, v62, v63
    v_lshlrev_b32 v62, 16, v19
    v_and_b32 v63, 0xffff0000, v19
    v_cvt_pk_bf16_f32 v18, v64, v65
    v_lshlrev_b32 v64, 16, v18
    v_and_b32 v65, 0xffff0000, v18
    v_cvt_pk_bf16_f32 v19, v66, v67
    v_lshlrev_b32 v66, 16, v19
    v_and_b32 v67, 0xffff0000, v19
    v_cvt_pk_bf16_f32 v18, v68, v69
    v_lshlrev_b32 v68, 16, v18
    v_and_b32 v69, 0xffff0000, v18
    v_cvt_pk_bf16_f32 v19, v70, v71
    v_lshlrev_b32 v70, 16, v19
    v_and_b32 v71, 0xffff0000, v19
    v_mul_f32 v56, v56, v82
    v_mul_f32 v57, v57, v82
    v_mul_f32 v58, v58, v82
    v_mul_f32 v59, v59, v82
    v_mul_f32 v60, v60, v82
    v_mul_f32 v61, v61, v82
    v_mul_f32 v62, v62, v82
    v_mul_f32 v63, v63, v82
    v_mul_f32 v64, v64, v82
    v_mul_f32 v65, v65, v82
    v_mul_f32 v66, v66, v82
    v_mul_f32 v67, v67, v82
    v_mul_f32 v68, v68, v82
    v_mul_f32 v69, v69, v82
    v_mul_f32 v70, v70, v82
    v_mul_f32 v71, v71, v82
    v_cvt_pk_bf16_f32 v18, v56, v57
    v_lshlrev_b32 v56, 16, v18
    v_and_b32 v57, 0xffff0000, v18
    v_cvt_pk_bf16_f32 v19, v58, v59
    v_lshlrev_b32 v58, 16, v19
    v_and_b32 v59, 0xffff0000, v19
    v_cvt_pk_bf16_f32 v18, v60, v61
    v_lshlrev_b32 v60, 16, v18
    v_and_b32 v61, 0xffff0000, v18
    v_cvt_pk_bf16_f32 v19, v62, v63
    v_lshlrev_b32 v62, 16, v19
    v_and_b32 v63, 0xffff0000, v19
    v_cvt_pk_bf16_f32 v18, v64, v65
    v_lshlrev_b32 v64, 16, v18
    v_and_b32 v65, 0xffff0000, v18
    v_cvt_pk_bf16_f32 v19, v66, v67
    v_lshlrev_b32 v66, 16, v19
    v_and_b32 v67, 0xffff0000, v19
    v_cvt_pk_bf16_f32 v18, v68, v69
    v_lshlrev_b32 v68, 16, v18
    v_and_b32 v69, 0xffff0000, v18
    v_cvt_pk_bf16_f32 v19, v70, v71
    v_lshlrev_b32 v70, 16, v19
    v_and_b32 v71, 0xffff0000, v19
    s_lshl_b32 s16, s29, 15
    s_lshl_b32 s17, s31, 11
    s_add_u32 s16, s16, s17
    s_waitcnt lgkmcnt(0)
    s_barrier
    ds_read_b128 v[96:99], v17 offset:256
    ds_read_b128 v[104:107], v17 offset:0
    ds_read_b128 v[100:103], v17 offset:272
    ds_read_b128 v[108:111], v17 offset:16
    ds_read_b128 v[112:115], v17 offset:384
    ds_read_b128 v[120:123], v17 offset:128
    ds_read_b128 v[116:119], v17 offset:400
    ds_read_b128 v[124:127], v17 offset:144
    s_waitcnt lgkmcnt(7)
    v_pk_mul_f32 v[56:57], v[56:57], v[96:97]
    v_pk_mul_f32 v[58:59], v[58:59], v[98:99]
    s_waitcnt lgkmcnt(5)
    v_pk_mul_f32 v[60:61], v[60:61], v[100:101]
    v_pk_mul_f32 v[62:63], v[62:63], v[102:103]
    v_cvt_pk_bf16_f32 v18, v56, v57
    v_lshlrev_b32 v56, 16, v18
    v_and_b32 v57, 0xffff0000, v18
    v_cvt_pk_bf16_f32 v19, v58, v59
    v_lshlrev_b32 v58, 16, v19
    v_and_b32 v59, 0xffff0000, v19
    v_cvt_pk_bf16_f32 v18, v60, v61
    v_lshlrev_b32 v60, 16, v18
    v_and_b32 v61, 0xffff0000, v18
    v_cvt_pk_bf16_f32 v19, v62, v63
    v_lshlrev_b32 v62, 16, v19
    v_and_b32 v63, 0xffff0000, v19
    v_pk_add_f32 v[56:57], v[56:57], v[104:105]
    v_pk_add_f32 v[58:59], v[58:59], v[106:107]
    s_waitcnt lgkmcnt(4)
    v_pk_add_f32 v[60:61], v[60:61], v[108:109]
    v_pk_add_f32 v[62:63], v[62:63], v[110:111]
    v_cvt_pk_bf16_f32 v32, v56, v57
    v_cvt_pk_bf16_f32 v33, v58, v59
    v_cvt_pk_bf16_f32 v34, v60, v61
    v_cvt_pk_bf16_f32 v35, v62, v63
    buffer_store_dwordx4 v[32:35], v2, s[8:11], s16 offen offset:0 sc1
    s_waitcnt lgkmcnt(3)
    v_pk_mul_f32 v[64:65], v[64:65], v[112:113]
    v_pk_mul_f32 v[66:67], v[66:67], v[114:115]
    s_waitcnt lgkmcnt(1)
    v_pk_mul_f32 v[68:69], v[68:69], v[116:117]
    v_pk_mul_f32 v[70:71], v[70:71], v[118:119]
    v_cvt_pk_bf16_f32 v18, v64, v65
    v_lshlrev_b32 v64, 16, v18
    v_and_b32 v65, 0xffff0000, v18
    v_cvt_pk_bf16_f32 v19, v66, v67
    v_lshlrev_b32 v66, 16, v19
    v_and_b32 v67, 0xffff0000, v19
    v_cvt_pk_bf16_f32 v18, v68, v69
    v_lshlrev_b32 v68, 16, v18
    v_and_b32 v69, 0xffff0000, v18
    v_cvt_pk_bf16_f32 v19, v70, v71
    v_lshlrev_b32 v70, 16, v19
    v_and_b32 v71, 0xffff0000, v19
    v_pk_add_f32 v[64:65], v[64:65], v[120:121]
    v_pk_add_f32 v[66:67], v[66:67], v[122:123]
    s_waitcnt lgkmcnt(0)
    v_pk_add_f32 v[68:69], v[68:69], v[124:125]
    v_pk_add_f32 v[70:71], v[70:71], v[126:127]
    v_cvt_pk_bf16_f32 v36, v64, v65
    v_cvt_pk_bf16_f32 v37, v66, v67
    v_cvt_pk_bf16_f32 v38, v68, v69
    v_cvt_pk_bf16_f32 v39, v70, v71
    buffer_store_dwordx4 v[36:39], v2, s[8:11], s16 offen offset:1024 sc1
    s_lshl_b32 s19, s3, 16
    s_lshl_b32 s20, s3, 11
    s_lshl_b32 s16, s12, 8
    s_add_u32 s4, s38, s16
    s_addc_u32 s5, s39, 0
    s_sub_u32 s6, 0x800000, s16
    s_mov_b32 s7, 0x20000
    s_add_u32 s22, s19, 0x0
    s_add_u32 m0, s20, 0x0
    s_nop 0
    buffer_load_dwordx4 v3, s[4:7], s22 offen lds
    s_add_u32 s22, s19, 0x8000
    s_add_u32 m0, s20, 0x400
    s_nop 0
    buffer_load_dwordx4 v3, s[4:7], s22 offen lds
    s_add_u32 s22, s19, 0x80000
    s_add_u32 m0, s20, 0x4000
    s_nop 0
    buffer_load_dwordx4 v3, s[4:7], s22 offen lds
    s_add_u32 s22, s19, 0x88000
    s_add_u32 m0, s20, 0x4400
    s_nop 0
    buffer_load_dwordx4 v3, s[4:7], s22 offen lds
    s_add_u32 s22, s19, 0x100000
    s_add_u32 m0, s20, 0x8000
    s_nop 0
    buffer_load_dwordx4 v3, s[4:7], s22 offen lds
    s_add_u32 s22, s19, 0x108000
    s_add_u32 m0, s20, 0x8400
    s_nop 0
    buffer_load_dwordx4 v3, s[4:7], s22 offen lds
    v_mov_b32 v134, s28
    s_lshl_b32 s16, s29, 4
    s_add_u32 s16, s16, s31
    s_lshl_b32 s16, s16, 2
    s_add_u32 s16, s16, 0x528000
    v_and_b32 v16, 31, v1
    v_lshlrev_b32 v16, 2, v16
    s_lshl_b32 s17, s13, 3
    s_add_u32 s17, s17, s3
    s_lshl_b32 s17, s17, 7
    s_add_u32 s17, s17, 0x528000
    s_waitcnt vmcnt(6)
    s_mov_b64 exec, 1
    buffer_store_dword v134, v132, s[8:11], s16 offen sc1
    s_mov_b64 exec, -1
    s_sleep 48
    s_mov_b32 s27, 0
adaLN_cond__sliding_block_cached__moe_arch_mod__prompt_kernel_h3p:
    buffer_load_dword v17, v16, s[8:11], s17 offen sc1
    s_waitcnt vmcnt(0)
    v_cmp_ne_u32 vcc, s28, v17
    s_add_u32 s27, s27, 1
    s_cmp_ge_u32 s27, 262144
    s_cbranch_scc1 adaLN_cond__sliding_block_cached__moe_arch_mod__prompt_kernel_h3g
    s_cbranch_vccnz adaLN_cond__sliding_block_cached__moe_arch_mod__prompt_kernel_h3p
adaLN_cond__sliding_block_cached__moe_arch_mod__prompt_kernel_h3g:
    s_mov_b32 s23, 0x0
    buffer_load_dwordx4 v[88:91], v7, s[8:11], s23 offen offset:0 sc1
    s_mov_b32 s23, 0x8000
    buffer_load_dwordx4 v[92:95], v7, s[8:11], s23 offen offset:0 sc1
    s_mov_b32 s23, 0x0
    buffer_load_dwordx4 v[96:99], v7, s[8:11], s23 offen offset:1024 sc1
    s_mov_b32 s23, 0x8000
    buffer_load_dwordx4 v[100:103], v7, s[8:11], s23 offen offset:1024 sc1
    s_mov_b32 s23, 0x800
    buffer_load_dwordx4 v[104:107], v7, s[8:11], s23 offen offset:0 sc1
    s_mov_b32 s23, 0x8800
    buffer_load_dwordx4 v[108:111], v7, s[8:11], s23 offen offset:0 sc1
    s_mov_b32 s23, 0x800
    buffer_load_dwordx4 v[112:115], v7, s[8:11], s23 offen offset:1024 sc1
    s_mov_b32 s23, 0x8800
    buffer_load_dwordx4 v[116:119], v7, s[8:11], s23 offen offset:1024 sc1
    s_lshr_b32 s21, s12, 3
    s_lshl_b32 s21, s21, 17
    s_add_u32 s21, s21, s20
    s_add_u32 s21, s21, 0x400000
    s_barrier
    ds_read_b64_tr_b16 v[224:225], v4 offset:0
    ds_read_b64_tr_b16 v[226:227], v4 offset:1024
    ds_read_b64_tr_b16 v[228:229], v5 offset:32
    ds_read_b64_tr_b16 v[230:231], v5 offset:1056
    ds_read_b64_tr_b16 v[232:233], v4 offset:256
    ds_read_b64_tr_b16 v[234:235], v4 offset:1280
    ds_read_b64_tr_b16 v[236:237], v5 offset:288
    ds_read_b64_tr_b16 v[238:239], v5 offset:1312
    s_waitcnt vmcnt(7) lgkmcnt(6)
    v_mfma_f32_16x16x32_bf16 v[24:27], v[224:227], v[88:91], 0
    ds_read_b64_tr_b16 v[240:241], v4 offset:512
    s_waitcnt vmcnt(6)
    v_mfma_f32_16x16x32_bf16 v[28:31], v[224:227], v[92:95], 0
    ds_read_b64_tr_b16 v[242:243], v4 offset:1536
    s_waitcnt lgkmcnt(6)
    v_mfma_f32_16x16x32_bf16 v[32:35], v[228:231], v[88:91], 0
    ds_read_b64_tr_b16 v[244:245], v5 offset:544
    v_mfma_f32_16x16x32_bf16 v[36:39], v[228:231], v[92:95], 0
    ds_read_b64_tr_b16 v[246:247], v5 offset:1568
    s_mov_b32 s23, 0x1000
    buffer_load_dwordx4 v[120:123], v7, s[8:11], s23 offen offset:0 sc1
    s_waitcnt lgkmcnt(6)
    v_mfma_f32_16x16x32_bf16 v[40:43], v[232:235], v[88:91], 0
    ds_read_b64_tr_b16 v[224:225], v4 offset:768
    v_mfma_f32_16x16x32_bf16 v[44:47], v[232:235], v[92:95], 0
    ds_read_b64_tr_b16 v[226:227], v4 offset:1792
    s_waitcnt lgkmcnt(6)
    v_mfma_f32_16x16x32_bf16 v[48:51], v[236:239], v[88:91], 0
    ds_read_b64_tr_b16 v[228:229], v5 offset:800
    v_mfma_f32_16x16x32_bf16 v[52:55], v[236:239], v[92:95], 0
    ds_read_b64_tr_b16 v[230:231], v5 offset:1824
    s_waitcnt lgkmcnt(6)
    v_mfma_f32_16x16x32_bf16 v[56:59], v[240:243], v[88:91], 0
    ds_read_b64_tr_b16 v[232:233], v4 offset:8192
    v_mfma_f32_16x16x32_bf16 v[60:63], v[240:243], v[92:95], 0
    ds_read_b64_tr_b16 v[234:235], v4 offset:9216
    s_waitcnt lgkmcnt(6)
    v_mfma_f32_16x16x32_bf16 v[64:67], v[244:247], v[88:91], 0
    ds_read_b64_tr_b16 v[236:237], v5 offset:8224
    v_mfma_f32_16x16x32_bf16 v[68:71], v[244:247], v[92:95], 0
    ds_read_b64_tr_b16 v[238:239], v5 offset:9248
    s_mov_b32 s23, 0x9000
    buffer_load_dwordx4 v[124:127], v7, s[8:11], s23 offen offset:0 sc1
    s_waitcnt lgkmcnt(6)
    v_mfma_f32_16x16x32_bf16 v[72:75], v[224:227], v[88:91], 0
    ds_read_b64_tr_b16 v[240:241], v4 offset:8448
    v_mfma_f32_16x16x32_bf16 v[76:79], v[224:227], v[92:95], 0
    ds_read_b64_tr_b16 v[242:243], v4 offset:9472
    s_waitcnt lgkmcnt(6)
    v_mfma_f32_16x16x32_bf16 v[80:83], v[228:231], v[88:91], 0
    ds_read_b64_tr_b16 v[244:245], v5 offset:8480
    v_mfma_f32_16x16x32_bf16 v[84:87], v[228:231], v[92:95], 0
    ds_read_b64_tr_b16 v[246:247], v5 offset:9504
    s_waitcnt vmcnt(7) lgkmcnt(6)
    v_mfma_f32_16x16x32_bf16 v[24:27], v[232:235], v[96:99], v[24:27]
    ds_read_b64_tr_b16 v[224:225], v4 offset:8704
    s_waitcnt vmcnt(6)
    v_mfma_f32_16x16x32_bf16 v[28:31], v[232:235], v[100:103], v[28:31]
    ds_read_b64_tr_b16 v[226:227], v4 offset:9728
    s_waitcnt lgkmcnt(6)
    v_mfma_f32_16x16x32_bf16 v[32:35], v[236:239], v[96:99], v[32:35]
    ds_read_b64_tr_b16 v[228:229], v5 offset:8736
    v_mfma_f32_16x16x32_bf16 v[36:39], v[236:239], v[100:103], v[36:39]
    ds_read_b64_tr_b16 v[230:231], v5 offset:9760
    s_mov_b32 s23, 0x1000
    buffer_load_dwordx4 v[128:131], v7, s[8:11], s23 offen offset:1024 sc1
    s_waitcnt lgkmcnt(6)
    v_mfma_f32_16x16x32_bf16 v[40:43], v[240:243], v[96:99], v[40:43]
    ds_read_b64_tr_b16 v[232:233], v4 offset:8960
    v_mfma_f32_16x16x32_bf16 v[44:47], v[240:243], v[100:103], v[44:47]
    ds_read_b64_tr_b16 v[234:235], v4 offset:9984
    s_waitcnt lgkmcnt(6)
    v_mfma_f32_16x16x32_bf16 v[48:51], v[244:247], v[96:99], v[48:51]
    ds_read_b64_tr_b16 v[236:237], v5 offset:8992
    v_mfma_f32_16x16x32_bf16 v[52:55], v[244:247], v[100:103], v[52:55]
    ds_read_b64_tr_b16 v[238:239], v5 offset:10016
    s_waitcnt lgkmcnt(6)
    v_mfma_f32_16x16x32_bf16 v[56:59], v[224:227], v[96:99], v[56:59]
    v_mfma_f32_16x16x32_bf16 v[60:63], v[224:227], v[100:103], v[60:63]
    s_barrier
    ds_read_b64_tr_b16 v[240:241], v4 offset:16384
    ds_read_b64_tr_b16 v[242:243], v4 offset:17408
    s_waitcnt lgkmcnt(6)
    v_mfma_f32_16x16x32_bf16 v[64:67], v[228:231], v[96:99], v[64:67]
    ds_read_b64_tr_b16 v[244:245], v5 offset:16416
    v_mfma_f32_16x16x32_bf16 v[68:71], v[228:231], v[100:103], v[68:71]
    s_add_u32 s22, s19, 0x180000
    s_add_u32 m0, s20, 0xc000
    s_nop 0
    buffer_load_dwordx4 v3, s[4:7], s22 offen lds
    ds_read_b64_tr_b16 v[246:247], v5 offset:17440
    s_mov_b32 s23, 0x9000
    buffer_load_dwordx4 v[132:135], v7, s[8:11], s23 offen offset:1024 sc1
    s_waitcnt lgkmcnt(6)
    v_mfma_f32_16x16x32_bf16 v[72:75], v[232:235], v[96:99], v[72:75]
    ds_read_b64_tr_b16 v[224:225], v4 offset:16640
    v_mfma_f32_16x16x32_bf16 v[76:79], v[232:235], v[100:103], v[76:79]
    ds_read_b64_tr_b16 v[226:227], v4 offset:17664
    s_waitcnt lgkmcnt(6)
    v_mfma_f32_16x16x32_bf16 v[80:83], v[236:239], v[96:99], v[80:83]
    ds_read_b64_tr_b16 v[228:229], v5 offset:16672
    v_mfma_f32_16x16x32_bf16 v[84:87], v[236:239], v[100:103], v[84:87]
    ds_read_b64_tr_b16 v[230:231], v5 offset:17696
    s_waitcnt vmcnt(8) lgkmcnt(6)
    v_mfma_f32_16x16x32_bf16 v[24:27], v[240:243], v[104:107], v[24:27]
    ds_read_b64_tr_b16 v[232:233], v4 offset:16896
    s_waitcnt vmcnt(7)
    v_mfma_f32_16x16x32_bf16 v[28:31], v[240:243], v[108:111], v[28:31]
    ds_read_b64_tr_b16 v[234:235], v4 offset:17920
    s_waitcnt lgkmcnt(6)
    v_mfma_f32_16x16x32_bf16 v[32:35], v[244:247], v[104:107], v[32:35]
    ds_read_b64_tr_b16 v[236:237], v5 offset:16928
    v_mfma_f32_16x16x32_bf16 v[36:39], v[244:247], v[108:111], v[36:39]
    s_add_u32 s22, s19, 0x188000
    s_add_u32 m0, s20, 0xc400
    s_nop 0
    buffer_load_dwordx4 v3, s[4:7], s22 offen lds
    ds_read_b64_tr_b16 v[238:239], v5 offset:17952
    s_mov_b32 s23, 0x1800
    buffer_load_dwordx4 v[88:91], v7, s[8:11], s23 offen offset:0 sc1
    s_waitcnt lgkmcnt(6)
    v_mfma_f32_16x16x32_bf16 v[40:43], v[224:227], v[104:107], v[40:43]
    ds_read_b64_tr_b16 v[240:241], v4 offset:17152
    v_mfma_f32_16x16x32_bf16 v[44:47], v[224:227], v[108:111], v[44:47]
    ds_read_b64_tr_b16 v[242:243], v4 offset:18176
    s_waitcnt lgkmcnt(6)
    v_mfma_f32_16x16x32_bf16 v[48:51], v[228:231], v[104:107], v[48:51]
    ds_read_b64_tr_b16 v[244:245], v5 offset:17184
    v_mfma_f32_16x16x32_bf16 v[52:55], v[228:231], v[108:111], v[52:55]
    ds_read_b64_tr_b16 v[246:247], v5 offset:18208
    s_waitcnt lgkmcnt(6)
    v_mfma_f32_16x16x32_bf16 v[56:59], v[232:235], v[104:107], v[56:59]
    ds_read_b64_tr_b16 v[224:225], v4 offset:24576
    v_mfma_f32_16x16x32_bf16 v[60:63], v[232:235], v[108:111], v[60:63]
    ds_read_b64_tr_b16 v[226:227], v4 offset:25600
    s_waitcnt lgkmcnt(6)
    v_mfma_f32_16x16x32_bf16 v[64:67], v[236:239], v[104:107], v[64:67]
    ds_read_b64_tr_b16 v[228:229], v5 offset:24608
    v_mfma_f32_16x16x32_bf16 v[68:71], v[236:239], v[108:111], v[68:71]
    ds_read_b64_tr_b16 v[230:231], v5 offset:25632
    s_mov_b32 s23, 0x9800
    buffer_load_dwordx4 v[92:95], v7, s[8:11], s23 offen offset:0 sc1
    s_waitcnt lgkmcnt(6)
    v_mfma_f32_16x16x32_bf16 v[72:75], v[240:243], v[104:107], v[72:75]
    ds_read_b64_tr_b16 v[232:233], v4 offset:24832
    v_mfma_f32_16x16x32_bf16 v[76:79], v[240:243], v[108:111], v[76:79]
    ds_read_b64_tr_b16 v[234:235], v4 offset:25856
    s_waitcnt lgkmcnt(6)
    v_mfma_f32_16x16x32_bf16 v[80:83], v[244:247], v[104:107], v[80:83]
    ds_read_b64_tr_b16 v[236:237], v5 offset:24864
    v_mfma_f32_16x16x32_bf16 v[84:87], v[244:247], v[108:111], v[84:87]
    ds_read_b64_tr_b16 v[238:239], v5 offset:25888
    s_waitcnt vmcnt(9) lgkmcnt(6)
    v_mfma_f32_16x16x32_bf16 v[24:27], v[224:227], v[112:115], v[24:27]
    ds_read_b64_tr_b16 v[240:241], v4 offset:25088
    s_waitcnt vmcnt(8)
    v_mfma_f32_16x16x32_bf16 v[28:31], v[224:227], v[116:119], v[28:31]
    ds_read_b64_tr_b16 v[242:243], v4 offset:26112
    s_waitcnt lgkmcnt(6)
    v_mfma_f32_16x16x32_bf16 v[32:35], v[228:231], v[112:115], v[32:35]
    ds_read_b64_tr_b16 v[244:245], v5 offset:25120
    v_mfma_f32_16x16x32_bf16 v[36:39], v[228:231], v[116:119], v[36:39]
    ds_read_b64_tr_b16 v[246:247], v5 offset:26144
    s_mov_b32 s23, 0x1800
    buffer_load_dwordx4 v[96:99], v7, s[8:11], s23 offen offset:1024 sc1
    s_waitcnt lgkmcnt(6)
    v_mfma_f32_16x16x32_bf16 v[40:43], v[232:235], v[112:115], v[40:43]
    ds_read_b64_tr_b16 v[224:225], v4 offset:25344
    v_mfma_f32_16x16x32_bf16 v[44:47], v[232:235], v[116:119], v[44:47]
    ds_read_b64_tr_b16 v[226:227], v4 offset:26368
    s_waitcnt lgkmcnt(6)
    v_mfma_f32_16x16x32_bf16 v[48:51], v[236:239], v[112:115], v[48:51]
    ds_read_b64_tr_b16 v[228:229], v5 offset:25376
    v_mfma_f32_16x16x32_bf16 v[52:55], v[236:239], v[116:119], v[52:55]
    ds_read_b64_tr_b16 v[230:231], v5 offset:26400
    s_waitcnt lgkmcnt(6)
    v_mfma_f32_16x16x32_bf16 v[56:59], v[240:243], v[112:115], v[56:59]
    v_mfma_f32_16x16x32_bf16 v[60:63], v[240:243], v[116:119], v[60:63]
    s_barrier
    ds_read_b64_tr_b16 v[232:233], v4 offset:32768
    ds_read_b64_tr_b16 v[234:235], v4 offset:33792
    s_waitcnt lgkmcnt(6)
    v_mfma_f32_16x16x32_bf16 v[64:67], v[244:247], v[112:115], v[64:67]
    ds_read_b64_tr_b16 v[236:237], v5 offset:32800
    v_mfma_f32_16x16x32_bf16 v[68:71], v[244:247], v[116:119], v[68:71]
    s_add_u32 s22, s19, 0x200000
    s_add_u32 m0, s20, 0x0
    s_nop 0
    buffer_load_dwordx4 v3, s[4:7], s22 offen lds
    ds_read_b64_tr_b16 v[238:239], v5 offset:33824
    s_mov_b32 s23, 0x9800
    buffer_load_dwordx4 v[100:103], v7, s[8:11], s23 offen offset:1024 sc1
    s_waitcnt lgkmcnt(6)
    v_mfma_f32_16x16x32_bf16 v[72:75], v[224:227], v[112:115], v[72:75]
    ds_read_b64_tr_b16 v[240:241], v4 offset:33024
    v_mfma_f32_16x16x32_bf16 v[76:79], v[224:227], v[116:119], v[76:79]
    ds_read_b64_tr_b16 v[242:243], v4 offset:34048
    s_waitcnt lgkmcnt(6)
    v_mfma_f32_16x16x32_bf16 v[80:83], v[228:231], v[112:115], v[80:83]
    ds_read_b64_tr_b16 v[244:245], v5 offset:33056
    v_mfma_f32_16x16x32_bf16 v[84:87], v[228:231], v[116:119], v[84:87]
    ds_read_b64_tr_b16 v[246:247], v5 offset:34080
    s_waitcnt vmcnt(10) lgkmcnt(6)
    v_mfma_f32_16x16x32_bf16 v[24:27], v[232:235], v[120:123], v[24:27]
    ds_read_b64_tr_b16 v[224:225], v4 offset:33280
    s_waitcnt vmcnt(9)
    v_mfma_f32_16x16x32_bf16 v[28:31], v[232:235], v[124:127], v[28:31]
    ds_read_b64_tr_b16 v[226:227], v4 offset:34304
    s_waitcnt lgkmcnt(6)
    v_mfma_f32_16x16x32_bf16 v[32:35], v[236:239], v[120:123], v[32:35]
    ds_read_b64_tr_b16 v[228:229], v5 offset:33312
    v_mfma_f32_16x16x32_bf16 v[36:39], v[236:239], v[124:127], v[36:39]
    s_add_u32 s22, s19, 0x208000
    s_add_u32 m0, s20, 0x400
    s_nop 0
    buffer_load_dwordx4 v3, s[4:7], s22 offen lds
    ds_read_b64_tr_b16 v[230:231], v5 offset:34336
    s_mov_b32 s23, 0x2000
    buffer_load_dwordx4 v[104:107], v7, s[8:11], s23 offen offset:0 sc1
    s_waitcnt lgkmcnt(6)
    v_mfma_f32_16x16x32_bf16 v[40:43], v[240:243], v[120:123], v[40:43]
    ds_read_b64_tr_b16 v[232:233], v4 offset:33536
    v_mfma_f32_16x16x32_bf16 v[44:47], v[240:243], v[124:127], v[44:47]
    ds_read_b64_tr_b16 v[234:235], v4 offset:34560
    s_waitcnt lgkmcnt(6)
    v_mfma_f32_16x16x32_bf16 v[48:51], v[244:247], v[120:123], v[48:51]
    ds_read_b64_tr_b16 v[236:237], v5 offset:33568
    v_mfma_f32_16x16x32_bf16 v[52:55], v[244:247], v[124:127], v[52:55]
    ds_read_b64_tr_b16 v[238:239], v5 offset:34592
    s_waitcnt lgkmcnt(6)
    v_mfma_f32_16x16x32_bf16 v[56:59], v[224:227], v[120:123], v[56:59]
    ds_read_b64_tr_b16 v[240:241], v4 offset:40960
    v_mfma_f32_16x16x32_bf16 v[60:63], v[224:227], v[124:127], v[60:63]
    ds_read_b64_tr_b16 v[242:243], v4 offset:41984
    s_waitcnt lgkmcnt(6)
    v_mfma_f32_16x16x32_bf16 v[64:67], v[228:231], v[120:123], v[64:67]
    ds_read_b64_tr_b16 v[244:245], v5 offset:40992
    v_mfma_f32_16x16x32_bf16 v[68:71], v[228:231], v[124:127], v[68:71]
    ds_read_b64_tr_b16 v[246:247], v5 offset:42016
    s_mov_b32 s23, 0xa000
    buffer_load_dwordx4 v[108:111], v7, s[8:11], s23 offen offset:0 sc1
    s_waitcnt lgkmcnt(6)
    v_mfma_f32_16x16x32_bf16 v[72:75], v[232:235], v[120:123], v[72:75]
    ds_read_b64_tr_b16 v[224:225], v4 offset:41216
    v_mfma_f32_16x16x32_bf16 v[76:79], v[232:235], v[124:127], v[76:79]
    ds_read_b64_tr_b16 v[226:227], v4 offset:42240
    s_waitcnt lgkmcnt(6)
    v_mfma_f32_16x16x32_bf16 v[80:83], v[236:239], v[120:123], v[80:83]
    ds_read_b64_tr_b16 v[228:229], v5 offset:41248
    v_mfma_f32_16x16x32_bf16 v[84:87], v[236:239], v[124:127], v[84:87]
    ds_read_b64_tr_b16 v[230:231], v5 offset:42272
    s_waitcnt vmcnt(11) lgkmcnt(6)
    v_mfma_f32_16x16x32_bf16 v[24:27], v[240:243], v[128:131], v[24:27]
    ds_read_b64_tr_b16 v[232:233], v4 offset:41472
    s_waitcnt vmcnt(9)
    v_mfma_f32_16x16x32_bf16 v[28:31], v[240:243], v[132:135], v[28:31]
    ds_read_b64_tr_b16 v[234:235], v4 offset:42496
    s_waitcnt lgkmcnt(6)
    v_mfma_f32_16x16x32_bf16 v[32:35], v[244:247], v[128:131], v[32:35]
    ds_read_b64_tr_b16 v[236:237], v5 offset:41504
    v_mfma_f32_16x16x32_bf16 v[36:39], v[244:247], v[132:135], v[36:39]
    ds_read_b64_tr_b16 v[238:239], v5 offset:42528
    s_mov_b32 s23, 0x2000
    buffer_load_dwordx4 v[112:115], v7, s[8:11], s23 offen offset:1024 sc1
    s_waitcnt lgkmcnt(6)
    v_mfma_f32_16x16x32_bf16 v[40:43], v[224:227], v[128:131], v[40:43]
    ds_read_b64_tr_b16 v[240:241], v4 offset:41728
    v_mfma_f32_16x16x32_bf16 v[44:47], v[224:227], v[132:135], v[44:47]
    ds_read_b64_tr_b16 v[242:243], v4 offset:42752
    s_waitcnt lgkmcnt(6)
    v_mfma_f32_16x16x32_bf16 v[48:51], v[228:231], v[128:131], v[48:51]
    ds_read_b64_tr_b16 v[244:245], v5 offset:41760
    v_mfma_f32_16x16x32_bf16 v[52:55], v[228:231], v[132:135], v[52:55]
    ds_read_b64_tr_b16 v[246:247], v5 offset:42784
    s_waitcnt lgkmcnt(6)
    v_mfma_f32_16x16x32_bf16 v[56:59], v[232:235], v[128:131], v[56:59]
    v_mfma_f32_16x16x32_bf16 v[60:63], v[232:235], v[132:135], v[60:63]
    s_waitcnt vmcnt(9)
    s_barrier
    ds_read_b64_tr_b16 v[224:225], v4 offset:49152
    ds_read_b64_tr_b16 v[226:227], v4 offset:50176
    s_waitcnt lgkmcnt(6)
    v_mfma_f32_16x16x32_bf16 v[64:67], v[236:239], v[128:131], v[64:67]
    ds_read_b64_tr_b16 v[228:229], v5 offset:49184
    v_mfma_f32_16x16x32_bf16 v[68:71], v[236:239], v[132:135], v[68:71]
    s_add_u32 s22, s19, 0x280000
    s_add_u32 m0, s20, 0x4000
    s_nop 0
    buffer_load_dwordx4 v3, s[4:7], s22 offen lds
    ds_read_b64_tr_b16 v[230:231], v5 offset:50208
    s_mov_b32 s23, 0xa000
    buffer_load_dwordx4 v[116:119], v7, s[8:11], s23 offen offset:1024 sc1
    s_waitcnt lgkmcnt(6)
    v_mfma_f32_16x16x32_bf16 v[72:75], v[240:243], v[128:131], v[72:75]
    ds_read_b64_tr_b16 v[232:233], v4 offset:49408
    v_mfma_f32_16x16x32_bf16 v[76:79], v[240:243], v[132:135], v[76:79]
    ds_read_b64_tr_b16 v[234:235], v4 offset:50432
    s_waitcnt lgkmcnt(6)
    v_mfma_f32_16x16x32_bf16 v[80:83], v[244:247], v[128:131], v[80:83]
    ds_read_b64_tr_b16 v[236:237], v5 offset:49440
    v_mfma_f32_16x16x32_bf16 v[84:87], v[244:247], v[132:135], v[84:87]
    ds_read_b64_tr_b16 v[238:239], v5 offset:50464
    s_waitcnt vmcnt(10) lgkmcnt(6)
    v_mfma_f32_16x16x32_bf16 v[24:27], v[224:227], v[88:91], v[24:27]
    ds_read_b64_tr_b16 v[240:241], v4 offset:49664
    s_waitcnt vmcnt(9)
    v_mfma_f32_16x16x32_bf16 v[28:31], v[224:227], v[92:95], v[28:31]
    ds_read_b64_tr_b16 v[242:243], v4 offset:50688
    s_waitcnt lgkmcnt(6)
    v_mfma_f32_16x16x32_bf16 v[32:35], v[228:231], v[88:91], v[32:35]
    ds_read_b64_tr_b16 v[244:245], v5 offset:49696
    v_mfma_f32_16x16x32_bf16 v[36:39], v[228:231], v[92:95], v[36:39]
    s_add_u32 s22, s19, 0x288000
    s_add_u32 m0, s20, 0x4400
    s_nop 0
    buffer_load_dwordx4 v3, s[4:7], s22 offen lds
    ds_read_b64_tr_b16 v[246:247], v5 offset:50720
    s_mov_b32 s23, 0x2800
    buffer_load_dwordx4 v[120:123], v7, s[8:11], s23 offen offset:0 sc1
    s_waitcnt lgkmcnt(6)
    v_mfma_f32_16x16x32_bf16 v[40:43], v[232:235], v[88:91], v[40:43]
    ds_read_b64_tr_b16 v[224:225], v4 offset:49920
    v_mfma_f32_16x16x32_bf16 v[44:47], v[232:235], v[92:95], v[44:47]
    ds_read_b64_tr_b16 v[226:227], v4 offset:50944
    s_waitcnt lgkmcnt(6)
    v_mfma_f32_16x16x32_bf16 v[48:51], v[236:239], v[88:91], v[48:51]
    ds_read_b64_tr_b16 v[228:229], v5 offset:49952
    v_mfma_f32_16x16x32_bf16 v[52:55], v[236:239], v[92:95], v[52:55]
    ds_read_b64_tr_b16 v[230:231], v5 offset:50976
    s_waitcnt lgkmcnt(6)
    v_mfma_f32_16x16x32_bf16 v[56:59], v[240:243], v[88:91], v[56:59]
    ds_read_b64_tr_b16 v[232:233], v4 offset:57344
    v_mfma_f32_16x16x32_bf16 v[60:63], v[240:243], v[92:95], v[60:63]
    ds_read_b64_tr_b16 v[234:235], v4 offset:58368
    s_waitcnt lgkmcnt(6)
    v_mfma_f32_16x16x32_bf16 v[64:67], v[244:247], v[88:91], v[64:67]
    ds_read_b64_tr_b16 v[236:237], v5 offset:57376
    v_mfma_f32_16x16x32_bf16 v[68:71], v[244:247], v[92:95], v[68:71]
    ds_read_b64_tr_b16 v[238:239], v5 offset:58400
    s_mov_b32 s23, 0xa800
    buffer_load_dwordx4 v[124:127], v7, s[8:11], s23 offen offset:0 sc1
    s_waitcnt lgkmcnt(6)
    v_mfma_f32_16x16x32_bf16 v[72:75], v[224:227], v[88:91], v[72:75]
    ds_read_b64_tr_b16 v[240:241], v4 offset:57600
    v_mfma_f32_16x16x32_bf16 v[76:79], v[224:227], v[92:95], v[76:79]
    ds_read_b64_tr_b16 v[242:243], v4 offset:58624
    s_waitcnt lgkmcnt(6)
    v_mfma_f32_16x16x32_bf16 v[80:83], v[228:231], v[88:91], v[80:83]
    ds_read_b64_tr_b16 v[244:245], v5 offset:57632
    v_mfma_f32_16x16x32_bf16 v[84:87], v[228:231], v[92:95], v[84:87]
    ds_read_b64_tr_b16 v[246:247], v5 offset:58656
    s_waitcnt vmcnt(11) lgkmcnt(6)
    v_mfma_f32_16x16x32_bf16 v[24:27], v[232:235], v[96:99], v[24:27]
    ds_read_b64_tr_b16 v[224:225], v4 offset:57856
    s_waitcnt vmcnt(9)
    v_mfma_f32_16x16x32_bf16 v[28:31], v[232:235], v[100:103], v[28:31]
    ds_read_b64_tr_b16 v[226:227], v4 offset:58880
    s_waitcnt lgkmcnt(6)
    v_mfma_f32_16x16x32_bf16 v[32:35], v[236:239], v[96:99], v[32:35]
    ds_read_b64_tr_b16 v[228:229], v5 offset:57888
    v_mfma_f32_16x16x32_bf16 v[36:39], v[236:239], v[100:103], v[36:39]
    ds_read_b64_tr_b16 v[230:231], v5 offset:58912
    s_mov_b32 s23, 0x2800
    buffer_load_dwordx4 v[128:131], v7, s[8:11], s23 offen offset:1024 sc1
    s_waitcnt lgkmcnt(6)
    v_mfma_f32_16x16x32_bf16 v[40:43], v[240:243], v[96:99], v[40:43]
    ds_read_b64_tr_b16 v[232:233], v4 offset:58112
    v_mfma_f32_16x16x32_bf16 v[44:47], v[240:243], v[100:103], v[44:47]
    ds_read_b64_tr_b16 v[234:235], v4 offset:59136
    s_waitcnt lgkmcnt(6)
    v_mfma_f32_16x16x32_bf16 v[48:51], v[244:247], v[96:99], v[48:51]
    ds_read_b64_tr_b16 v[236:237], v5 offset:58144
    v_mfma_f32_16x16x32_bf16 v[52:55], v[244:247], v[100:103], v[52:55]
    ds_read_b64_tr_b16 v[238:239], v5 offset:59168
    s_waitcnt lgkmcnt(6)
    v_mfma_f32_16x16x32_bf16 v[56:59], v[224:227], v[96:99], v[56:59]
    v_mfma_f32_16x16x32_bf16 v[60:63], v[224:227], v[100:103], v[60:63]
    s_waitcnt vmcnt(9)
    s_barrier
    ds_read_b64_tr_b16 v[240:241], v4 offset:0
    ds_read_b64_tr_b16 v[242:243], v4 offset:1024
    s_waitcnt lgkmcnt(6)
    v_mfma_f32_16x16x32_bf16 v[64:67], v[228:231], v[96:99], v[64:67]
    ds_read_b64_tr_b16 v[244:245], v5 offset:32
    v_mfma_f32_16x16x32_bf16 v[68:71], v[228:231], v[100:103], v[68:71]
    s_add_u32 s22, s19, 0x300000
    s_add_u32 m0, s20, 0x8000
    s_nop 0
    buffer_load_dwordx4 v3, s[4:7], s22 offen lds
    ds_read_b64_tr_b16 v[246:247], v5 offset:1056
    s_mov_b32 s23, 0xa800
    buffer_load_dwordx4 v[132:135], v7, s[8:11], s23 offen offset:1024 sc1
    s_waitcnt lgkmcnt(6)
    v_mfma_f32_16x16x32_bf16 v[72:75], v[232:235], v[96:99], v[72:75]
    ds_read_b64_tr_b16 v[224:225], v4 offset:256
    v_mfma_f32_16x16x32_bf16 v[76:79], v[232:235], v[100:103], v[76:79]
    ds_read_b64_tr_b16 v[226:227], v4 offset:1280
    s_waitcnt lgkmcnt(6)
    v_mfma_f32_16x16x32_bf16 v[80:83], v[236:239], v[96:99], v[80:83]
    ds_read_b64_tr_b16 v[228:229], v5 offset:288
    v_mfma_f32_16x16x32_bf16 v[84:87], v[236:239], v[100:103], v[84:87]
    ds_read_b64_tr_b16 v[230:231], v5 offset:1312
    s_waitcnt vmcnt(10) lgkmcnt(6)
    v_mfma_f32_16x16x32_bf16 v[24:27], v[240:243], v[104:107], v[24:27]
    ds_read_b64_tr_b16 v[232:233], v4 offset:512
    s_waitcnt vmcnt(9)
    v_mfma_f32_16x16x32_bf16 v[28:31], v[240:243], v[108:111], v[28:31]
    ds_read_b64_tr_b16 v[234:235], v4 offset:1536
    s_waitcnt lgkmcnt(6)
    v_mfma_f32_16x16x32_bf16 v[32:35], v[244:247], v[104:107], v[32:35]
    ds_read_b64_tr_b16 v[236:237], v5 offset:544
    v_mfma_f32_16x16x32_bf16 v[36:39], v[244:247], v[108:111], v[36:39]
    s_add_u32 s22, s19, 0x308000
    s_add_u32 m0, s20, 0x8400
    s_nop 0
    buffer_load_dwordx4 v3, s[4:7], s22 offen lds
    ds_read_b64_tr_b16 v[238:239], v5 offset:1568
    s_mov_b32 s23, 0x3000
    buffer_load_dwordx4 v[88:91], v7, s[8:11], s23 offen offset:0 sc1
    s_waitcnt lgkmcnt(6)
    v_mfma_f32_16x16x32_bf16 v[40:43], v[224:227], v[104:107], v[40:43]
    ds_read_b64_tr_b16 v[240:241], v4 offset:768
    v_mfma_f32_16x16x32_bf16 v[44:47], v[224:227], v[108:111], v[44:47]
    ds_read_b64_tr_b16 v[242:243], v4 offset:1792
    s_waitcnt lgkmcnt(6)
    v_mfma_f32_16x16x32_bf16 v[48:51], v[228:231], v[104:107], v[48:51]
    ds_read_b64_tr_b16 v[244:245], v5 offset:800
    v_mfma_f32_16x16x32_bf16 v[52:55], v[228:231], v[108:111], v[52:55]
    ds_read_b64_tr_b16 v[246:247], v5 offset:1824
    s_waitcnt lgkmcnt(6)
    v_mfma_f32_16x16x32_bf16 v[56:59], v[232:235], v[104:107], v[56:59]
    ds_read_b64_tr_b16 v[224:225], v4 offset:8192
    v_mfma_f32_16x16x32_bf16 v[60:63], v[232:235], v[108:111], v[60:63]
    ds_read_b64_tr_b16 v[226:227], v4 offset:9216
    s_waitcnt lgkmcnt(6)
    v_mfma_f32_16x16x32_bf16 v[64:67], v[236:239], v[104:107], v[64:67]
    ds_read_b64_tr_b16 v[228:229], v5 offset:8224
    v_mfma_f32_16x16x32_bf16 v[68:71], v[236:239], v[108:111], v[68:71]
    ds_read_b64_tr_b16 v[230:231], v5 offset:9248
    s_mov_b32 s23, 0xb000
    buffer_load_dwordx4 v[92:95], v7, s[8:11], s23 offen offset:0 sc1
    s_waitcnt lgkmcnt(6)
    v_mfma_f32_16x16x32_bf16 v[72:75], v[240:243], v[104:107], v[72:75]
    ds_read_b64_tr_b16 v[232:233], v4 offset:8448
    v_mfma_f32_16x16x32_bf16 v[76:79], v[240:243], v[108:111], v[76:79]
    ds_read_b64_tr_b16 v[234:235], v4 offset:9472
    s_waitcnt lgkmcnt(6)
    v_mfma_f32_16x16x32_bf16 v[80:83], v[244:247], v[104:107], v[80:83]
    ds_read_b64_tr_b16 v[236:237], v5 offset:8480
    v_mfma_f32_16x16x32_bf16 v[84:87], v[244:247], v[108:111], v[84:87]
    ds_read_b64_tr_b16 v[238:239], v5 offset:9504
    s_waitcnt vmcnt(11) lgkmcnt(6)
    v_mfma_f32_16x16x32_bf16 v[24:27], v[224:227], v[112:115], v[24:27]
    ds_read_b64_tr_b16 v[240:241], v4 offset:8704
    s_waitcnt vmcnt(9)
    v_mfma_f32_16x16x32_bf16 v[28:31], v[224:227], v[116:119], v[28:31]
    ds_read_b64_tr_b16 v[242:243], v4 offset:9728
    s_waitcnt lgkmcnt(6)
    v_mfma_f32_16x16x32_bf16 v[32:35], v[228:231], v[112:115], v[32:35]
    ds_read_b64_tr_b16 v[244:245], v5 offset:8736
    v_mfma_f32_16x16x32_bf16 v[36:39], v[228:231], v[116:119], v[36:39]
    ds_read_b64_tr_b16 v[246:247], v5 offset:9760
    s_mov_b32 s23, 0x3000
    buffer_load_dwordx4 v[96:99], v7, s[8:11], s23 offen offset:1024 sc1
    s_waitcnt lgkmcnt(6)
    v_mfma_f32_16x16x32_bf16 v[40:43], v[232:235], v[112:115], v[40:43]
    ds_read_b64_tr_b16 v[224:225], v4 offset:8960
    v_mfma_f32_16x16x32_bf16 v[44:47], v[232:235], v[116:119], v[44:47]
    ds_read_b64_tr_b16 v[226:227], v4 offset:9984
    s_waitcnt lgkmcnt(6)
    v_mfma_f32_16x16x32_bf16 v[48:51], v[236:239], v[112:115], v[48:51]
    ds_read_b64_tr_b16 v[228:229], v5 offset:8992
    v_mfma_f32_16x16x32_bf16 v[52:55], v[236:239], v[116:119], v[52:55]
    ds_read_b64_tr_b16 v[230:231], v5 offset:10016
    s_waitcnt lgkmcnt(6)
    v_mfma_f32_16x16x32_bf16 v[56:59], v[240:243], v[112:115], v[56:59]
    v_mfma_f32_16x16x32_bf16 v[60:63], v[240:243], v[116:119], v[60:63]
    s_waitcnt vmcnt(9)
    s_barrier
    ds_read_b64_tr_b16 v[232:233], v4 offset:16384
    ds_read_b64_tr_b16 v[234:235], v4 offset:17408
    s_waitcnt lgkmcnt(6)
    v_mfma_f32_16x16x32_bf16 v[64:67], v[244:247], v[112:115], v[64:67]
    ds_read_b64_tr_b16 v[236:237], v5 offset:16416
    v_mfma_f32_16x16x32_bf16 v[68:71], v[244:247], v[116:119], v[68:71]
    s_add_u32 s22, s19, 0x380000
    s_add_u32 m0, s20, 0xc000
    s_nop 0
    buffer_load_dwordx4 v3, s[4:7], s22 offen lds
    ds_read_b64_tr_b16 v[238:239], v5 offset:17440
    s_mov_b32 s23, 0xb000
    buffer_load_dwordx4 v[100:103], v7, s[8:11], s23 offen offset:1024 sc1
    s_waitcnt lgkmcnt(6)
    v_mfma_f32_16x16x32_bf16 v[72:75], v[224:227], v[112:115], v[72:75]
    ds_read_b64_tr_b16 v[240:241], v4 offset:16640
    v_mfma_f32_16x16x32_bf16 v[76:79], v[224:227], v[116:119], v[76:79]
    ds_read_b64_tr_b16 v[242:243], v4 offset:17664
    s_waitcnt lgkmcnt(6)
    v_mfma_f32_16x16x32_bf16 v[80:83], v[228:231], v[112:115], v[80:83]
    ds_read_b64_tr_b16 v[244:245], v5 offset:16672
    v_mfma_f32_16x16x32_bf16 v[84:87], v[228:231], v[116:119], v[84:87]
    ds_read_b64_tr_b16 v[246:247], v5 offset:17696
    s_waitcnt vmcnt(10) lgkmcnt(6)
    v_mfma_f32_16x16x32_bf16 v[24:27], v[232:235], v[120:123], v[24:27]
    ds_read_b64_tr_b16 v[224:225], v4 offset:16896
    s_waitcnt vmcnt(9)
    v_mfma_f32_16x16x32_bf16 v[28:31], v[232:235], v[124:127], v[28:31]
    ds_read_b64_tr_b16 v[226:227], v4 offset:17920
    s_waitcnt lgkmcnt(6)
    v_mfma_f32_16x16x32_bf16 v[32:35], v[236:239], v[120:123], v[32:35]
    ds_read_b64_tr_b16 v[228:229], v5 offset:16928
    v_mfma_f32_16x16x32_bf16 v[36:39], v[236:239], v[124:127], v[36:39]
    s_add_u32 s22, s19, 0x388000
    s_add_u32 m0, s20, 0xc400
    s_nop 0
    buffer_load_dwordx4 v3, s[4:7], s22 offen lds
    ds_read_b64_tr_b16 v[230:231], v5 offset:17952
    s_mov_b32 s23, 0x3800
    buffer_load_dwordx4 v[104:107], v7, s[8:11], s23 offen offset:0 sc1
    s_waitcnt lgkmcnt(6)
    v_mfma_f32_16x16x32_bf16 v[40:43], v[240:243], v[120:123], v[40:43]
    ds_read_b64_tr_b16 v[232:233], v4 offset:17152
    v_mfma_f32_16x16x32_bf16 v[44:47], v[240:243], v[124:127], v[44:47]
    ds_read_b64_tr_b16 v[234:235], v4 offset:18176
    s_waitcnt lgkmcnt(6)
    v_mfma_f32_16x16x32_bf16 v[48:51], v[244:247], v[120:123], v[48:51]
    ds_read_b64_tr_b16 v[236:237], v5 offset:17184
    v_mfma_f32_16x16x32_bf16 v[52:55], v[244:247], v[124:127], v[52:55]
    ds_read_b64_tr_b16 v[238:239], v5 offset:18208
    s_waitcnt lgkmcnt(6)
    v_mfma_f32_16x16x32_bf16 v[56:59], v[224:227], v[120:123], v[56:59]
    ds_read_b64_tr_b16 v[240:241], v4 offset:24576
    v_mfma_f32_16x16x32_bf16 v[60:63], v[224:227], v[124:127], v[60:63]
    ds_read_b64_tr_b16 v[242:243], v4 offset:25600
    s_waitcnt lgkmcnt(6)
    v_mfma_f32_16x16x32_bf16 v[64:67], v[228:231], v[120:123], v[64:67]
    ds_read_b64_tr_b16 v[244:245], v5 offset:24608
    v_mfma_f32_16x16x32_bf16 v[68:71], v[228:231], v[124:127], v[68:71]
    ds_read_b64_tr_b16 v[246:247], v5 offset:25632
    s_mov_b32 s23, 0xb800
    buffer_load_dwordx4 v[108:111], v7, s[8:11], s23 offen offset:0 sc1
    s_waitcnt lgkmcnt(6)
    v_mfma_f32_16x16x32_bf16 v[72:75], v[232:235], v[120:123], v[72:75]
    ds_read_b64_tr_b16 v[224:225], v4 offset:24832
    v_mfma_f32_16x16x32_bf16 v[76:79], v[232:235], v[124:127], v[76:79]
    ds_read_b64_tr_b16 v[226:227], v4 offset:25856
    s_waitcnt lgkmcnt(6)
    v_mfma_f32_16x16x32_bf16 v[80:83], v[236:239], v[120:123], v[80:83]
    ds_read_b64_tr_b16 v[228:229], v5 offset:24864
    v_mfma_f32_16x16x32_bf16 v[84:87], v[236:239], v[124:127], v[84:87]
    ds_read_b64_tr_b16 v[230:231], v5 offset:25888
    s_waitcnt vmcnt(11) lgkmcnt(6)
    v_mfma_f32_16x16x32_bf16 v[24:27], v[240:243], v[128:131], v[24:27]
    ds_read_b64_tr_b16 v[232:233], v4 offset:25088
    s_waitcnt vmcnt(9)
    v_mfma_f32_16x16x32_bf16 v[28:31], v[240:243], v[132:135], v[28:31]
    ds_read_b64_tr_b16 v[234:235], v4 offset:26112
    s_waitcnt lgkmcnt(6)
    v_mfma_f32_16x16x32_bf16 v[32:35], v[244:247], v[128:131], v[32:35]
    ds_read_b64_tr_b16 v[236:237], v5 offset:25120
    v_mfma_f32_16x16x32_bf16 v[36:39], v[244:247], v[132:135], v[36:39]
    ds_read_b64_tr_b16 v[238:239], v5 offset:26144
    s_mov_b32 s23, 0x3800
    buffer_load_dwordx4 v[112:115], v7, s[8:11], s23 offen offset:1024 sc1
    s_waitcnt lgkmcnt(6)
    v_mfma_f32_16x16x32_bf16 v[40:43], v[224:227], v[128:131], v[40:43]
    ds_read_b64_tr_b16 v[240:241], v4 offset:25344
    v_mfma_f32_16x16x32_bf16 v[44:47], v[224:227], v[132:135], v[44:47]
    ds_read_b64_tr_b16 v[242:243], v4 offset:26368
    s_waitcnt lgkmcnt(6)
    v_mfma_f32_16x16x32_bf16 v[48:51], v[228:231], v[128:131], v[48:51]
    ds_read_b64_tr_b16 v[244:245], v5 offset:25376
    v_mfma_f32_16x16x32_bf16 v[52:55], v[228:231], v[132:135], v[52:55]
    ds_read_b64_tr_b16 v[246:247], v5 offset:26400
    s_waitcnt lgkmcnt(6)
    v_mfma_f32_16x16x32_bf16 v[56:59], v[232:235], v[128:131], v[56:59]
    v_mfma_f32_16x16x32_bf16 v[60:63], v[232:235], v[132:135], v[60:63]
    s_waitcnt vmcnt(9)
    s_barrier
    ds_read_b64_tr_b16 v[224:225], v4 offset:32768
    ds_read_b64_tr_b16 v[226:227], v4 offset:33792
    s_waitcnt lgkmcnt(6)
    v_mfma_f32_16x16x32_bf16 v[64:67], v[236:239], v[128:131], v[64:67]
    ds_read_b64_tr_b16 v[228:229], v5 offset:32800
    v_mfma_f32_16x16x32_bf16 v[68:71], v[236:239], v[132:135], v[68:71]
    s_add_u32 s22, s19, 0x400000
    s_add_u32 m0, s20, 0x0
    s_nop 0
    buffer_load_dwordx4 v3, s[4:7], s22 offen lds
    ds_read_b64_tr_b16 v[230:231], v5 offset:33824
    s_mov_b32 s23, 0xb800
    buffer_load_dwordx4 v[116:119], v7, s[8:11], s23 offen offset:1024 sc1
    s_waitcnt lgkmcnt(6)
    v_mfma_f32_16x16x32_bf16 v[72:75], v[240:243], v[128:131], v[72:75]
    ds_read_b64_tr_b16 v[232:233], v4 offset:33024
    v_mfma_f32_16x16x32_bf16 v[76:79], v[240:243], v[132:135], v[76:79]
    ds_read_b64_tr_b16 v[234:235], v4 offset:34048
    s_waitcnt lgkmcnt(6)
    v_mfma_f32_16x16x32_bf16 v[80:83], v[244:247], v[128:131], v[80:83]
    ds_read_b64_tr_b16 v[236:237], v5 offset:33056
    v_mfma_f32_16x16x32_bf16 v[84:87], v[244:247], v[132:135], v[84:87]
    ds_read_b64_tr_b16 v[238:239], v5 offset:34080
    s_waitcnt vmcnt(10) lgkmcnt(6)
    v_mfma_f32_16x16x32_bf16 v[24:27], v[224:227], v[88:91], v[24:27]
    ds_read_b64_tr_b16 v[240:241], v4 offset:33280
    s_waitcnt vmcnt(9)
    v_mfma_f32_16x16x32_bf16 v[28:31], v[224:227], v[92:95], v[28:31]
    ds_read_b64_tr_b16 v[242:243], v4 offset:34304
    s_waitcnt lgkmcnt(6)
    v_mfma_f32_16x16x32_bf16 v[32:35], v[228:231], v[88:91], v[32:35]
    ds_read_b64_tr_b16 v[244:245], v5 offset:33312
    v_mfma_f32_16x16x32_bf16 v[36:39], v[228:231], v[92:95], v[36:39]
    s_add_u32 s22, s19, 0x408000
    s_add_u32 m0, s20, 0x400
    s_nop 0
    buffer_load_dwordx4 v3, s[4:7], s22 offen lds
    ds_read_b64_tr_b16 v[246:247], v5 offset:34336
    s_mov_b32 s23, 0x4000
    buffer_load_dwordx4 v[120:123], v7, s[8:11], s23 offen offset:0 sc1
    s_waitcnt lgkmcnt(6)
    v_mfma_f32_16x16x32_bf16 v[40:43], v[232:235], v[88:91], v[40:43]
    ds_read_b64_tr_b16 v[224:225], v4 offset:33536
    v_mfma_f32_16x16x32_bf16 v[44:47], v[232:235], v[92:95], v[44:47]
    ds_read_b64_tr_b16 v[226:227], v4 offset:34560
    s_waitcnt lgkmcnt(6)
    v_mfma_f32_16x16x32_bf16 v[48:51], v[236:239], v[88:91], v[48:51]
    ds_read_b64_tr_b16 v[228:229], v5 offset:33568
    v_mfma_f32_16x16x32_bf16 v[52:55], v[236:239], v[92:95], v[52:55]
    ds_read_b64_tr_b16 v[230:231], v5 offset:34592
    s_waitcnt lgkmcnt(6)
    v_mfma_f32_16x16x32_bf16 v[56:59], v[240:243], v[88:91], v[56:59]
    ds_read_b64_tr_b16 v[232:233], v4 offset:40960
    v_mfma_f32_16x16x32_bf16 v[60:63], v[240:243], v[92:95], v[60:63]
    ds_read_b64_tr_b16 v[234:235], v4 offset:41984
    s_waitcnt lgkmcnt(6)
    v_mfma_f32_16x16x32_bf16 v[64:67], v[244:247], v[88:91], v[64:67]
    ds_read_b64_tr_b16 v[236:237], v5 offset:40992
    v_mfma_f32_16x16x32_bf16 v[68:71], v[244:247], v[92:95], v[68:71]
    ds_read_b64_tr_b16 v[238:239], v5 offset:42016
    s_mov_b32 s23, 0xc000
    buffer_load_dwordx4 v[124:127], v7, s[8:11], s23 offen offset:0 sc1
    s_waitcnt lgkmcnt(6)
    v_mfma_f32_16x16x32_bf16 v[72:75], v[224:227], v[88:91], v[72:75]
    ds_read_b64_tr_b16 v[240:241], v4 offset:41216
    v_lshrrev_b32 v21, 4, v1
    v_lshlrev_b32 v21, 9, v21
    v_and_b32 v20, 15, v1
    v_lshl_add_u32 v21, v20, 4, v21
    s_lshr_b32 s18, s12, 3
    s_lshl_b32 s18, s18, 11
    s_add_u32 s18, s18, 0x528100
    buffer_load_dwordx4 v[12:15], v21, s[8:11], s18 offen sc1
    v_mfma_f32_16x16x32_bf16 v[76:79], v[224:227], v[92:95], v[76:79]
    ds_read_b64_tr_b16 v[242:243], v4 offset:42240
    s_waitcnt lgkmcnt(6)
    v_mfma_f32_16x16x32_bf16 v[80:83], v[228:231], v[88:91], v[80:83]
    ds_read_b64_tr_b16 v[244:245], v5 offset:41248
    v_mfma_f32_16x16x32_bf16 v[84:87], v[228:231], v[92:95], v[84:87]
    ds_read_b64_tr_b16 v[246:247], v5 offset:42272
    s_waitcnt vmcnt(12) lgkmcnt(6)
    v_mfma_f32_16x16x32_bf16 v[24:27], v[232:235], v[96:99], v[24:27]
    ds_read_b64_tr_b16 v[224:225], v4 offset:41472
    s_waitcnt vmcnt(10)
    v_mfma_f32_16x16x32_bf16 v[28:31], v[232:235], v[100:103], v[28:31]
    ds_read_b64_tr_b16 v[226:227], v4 offset:42496
    s_waitcnt lgkmcnt(6)
    v_mfma_f32_16x16x32_bf16 v[32:35], v[236:239], v[96:99], v[32:35]
    ds_read_b64_tr_b16 v[228:229], v5 offset:41504
    v_mfma_f32_16x16x32_bf16 v[36:39], v[236:239], v[100:103], v[36:39]
    ds_read_b64_tr_b16 v[230:231], v5 offset:42528
    s_mov_b32 s23, 0x4000
    buffer_load_dwordx4 v[128:131], v7, s[8:11], s23 offen offset:1024 sc1
    s_waitcnt lgkmcnt(6)
    v_mfma_f32_16x16x32_bf16 v[40:43], v[240:243], v[96:99], v[40:43]
    ds_read_b64_tr_b16 v[232:233], v4 offset:41728
    v_mfma_f32_16x16x32_bf16 v[44:47], v[240:243], v[100:103], v[44:47]
    ds_read_b64_tr_b16 v[234:235], v4 offset:42752
    s_waitcnt lgkmcnt(6)
    v_mfma_f32_16x16x32_bf16 v[48:51], v[244:247], v[96:99], v[48:51]
    ds_read_b64_tr_b16 v[236:237], v5 offset:41760
    v_mfma_f32_16x16x32_bf16 v[52:55], v[244:247], v[100:103], v[52:55]
    ds_read_b64_tr_b16 v[238:239], v5 offset:42784
    s_waitcnt lgkmcnt(6)
    v_mfma_f32_16x16x32_bf16 v[56:59], v[224:227], v[96:99], v[56:59]
    v_mfma_f32_16x16x32_bf16 v[60:63], v[224:227], v[100:103], v[60:63]
    s_waitcnt vmcnt(10)
    s_barrier
    ds_read_b64_tr_b16 v[240:241], v4 offset:49152
    ds_read_b64_tr_b16 v[242:243], v4 offset:50176
    s_waitcnt lgkmcnt(6)
    v_mfma_f32_16x16x32_bf16 v[64:67], v[228:231], v[96:99], v[64:67]
    ds_read_b64_tr_b16 v[244:245], v5 offset:49184
    v_mfma_f32_16x16x32_bf16 v[68:71], v[228:231], v[100:103], v[68:71]
    s_add_u32 s22, s19, 0x480000
    s_add_u32 m0, s20, 0x4000
    s_nop 0
    buffer_load_dwordx4 v3, s[4:7], s22 offen lds
    ds_read_b64_tr_b16 v[246:247], v5 offset:50208
    s_mov_b32 s23, 0xc000
    buffer_load_dwordx4 v[132:135], v7, s[8:11], s23 offen offset:1024 sc1
    s_waitcnt lgkmcnt(6)
    v_mfma_f32_16x16x32_bf16 v[72:75], v[232:235], v[96:99], v[72:75]
    ds_read_b64_tr_b16 v[224:225], v4 offset:49408
    v_mfma_f32_16x16x32_bf16 v[76:79], v[232:235], v[100:103], v[76:79]
    ds_read_b64_tr_b16 v[226:227], v4 offset:50432
    s_waitcnt lgkmcnt(6)
    v_mfma_f32_16x16x32_bf16 v[80:83], v[236:239], v[96:99], v[80:83]
    ds_read_b64_tr_b16 v[228:229], v5 offset:49440
    v_mfma_f32_16x16x32_bf16 v[84:87], v[236:239], v[100:103], v[84:87]
    ds_read_b64_tr_b16 v[230:231], v5 offset:50464
    s_waitcnt vmcnt(11) lgkmcnt(6)
    v_mfma_f32_16x16x32_bf16 v[24:27], v[240:243], v[104:107], v[24:27]
    ds_read_b64_tr_b16 v[232:233], v4 offset:49664
    s_waitcnt vmcnt(10)
    v_mfma_f32_16x16x32_bf16 v[28:31], v[240:243], v[108:111], v[28:31]
    ds_read_b64_tr_b16 v[234:235], v4 offset:50688
    s_waitcnt lgkmcnt(6)
    v_mfma_f32_16x16x32_bf16 v[32:35], v[244:247], v[104:107], v[32:35]
    ds_read_b64_tr_b16 v[236:237], v5 offset:49696
    v_mfma_f32_16x16x32_bf16 v[36:39], v[244:247], v[108:111], v[36:39]
    s_add_u32 s22, s19, 0x488000
    s_add_u32 m0, s20, 0x4400
    s_nop 0
    buffer_load_dwordx4 v3, s[4:7], s22 offen lds
    ds_read_b64_tr_b16 v[238:239], v5 offset:50720
    s_mov_b32 s23, 0x4800
    buffer_load_dwordx4 v[88:91], v7, s[8:11], s23 offen offset:0 sc1
    s_waitcnt lgkmcnt(6)
    v_mfma_f32_16x16x32_bf16 v[40:43], v[224:227], v[104:107], v[40:43]
    ds_read_b64_tr_b16 v[240:241], v4 offset:49920
    v_mfma_f32_16x16x32_bf16 v[44:47], v[224:227], v[108:111], v[44:47]
    ds_read_b64_tr_b16 v[242:243], v4 offset:50944
    s_waitcnt lgkmcnt(6)
    v_mfma_f32_16x16x32_bf16 v[48:51], v[228:231], v[104:107], v[48:51]
    ds_read_b64_tr_b16 v[244:245], v5 offset:49952
    v_mfma_f32_16x16x32_bf16 v[52:55], v[228:231], v[108:111], v[52:55]
    ds_read_b64_tr_b16 v[246:247], v5 offset:50976
    s_waitcnt lgkmcnt(6)
    v_mfma_f32_16x16x32_bf16 v[56:59], v[232:235], v[104:107], v[56:59]
    ds_read_b64_tr_b16 v[224:225], v4 offset:57344
    v_mfma_f32_16x16x32_bf16 v[60:63], v[232:235], v[108:111], v[60:63]
    ds_read_b64_tr_b16 v[226:227], v4 offset:58368
    s_waitcnt lgkmcnt(6)
    v_mfma_f32_16x16x32_bf16 v[64:67], v[236:239], v[104:107], v[64:67]
    ds_read_b64_tr_b16 v[228:229], v5 offset:57376
    v_mfma_f32_16x16x32_bf16 v[68:71], v[236:239], v[108:111], v[68:71]
    ds_read_b64_tr_b16 v[230:231], v5 offset:58400
    s_mov_b32 s23, 0xc800
    buffer_load_dwordx4 v[92:95], v7, s[8:11], s23 offen offset:0 sc1
    s_waitcnt lgkmcnt(6)
    v_mfma_f32_16x16x32_bf16 v[72:75], v[240:243], v[104:107], v[72:75]
    ds_read_b64_tr_b16 v[232:233], v4 offset:57600
    v_mfma_f32_16x16x32_bf16 v[76:79], v[240:243], v[108:111], v[76:79]
    ds_read_b64_tr_b16 v[234:235], v4 offset:58624
    s_waitcnt lgkmcnt(6)
    v_mfma_f32_16x16x32_bf16 v[80:83], v[244:247], v[104:107], v[80:83]
    ds_read_b64_tr_b16 v[236:237], v5 offset:57632
    v_mfma_f32_16x16x32_bf16 v[84:87], v[244:247], v[108:111], v[84:87]
    ds_read_b64_tr_b16 v[238:239], v5 offset:58656
    s_waitcnt vmcnt(12) lgkmcnt(6)
    v_mfma_f32_16x16x32_bf16 v[24:27], v[224:227], v[112:115], v[24:27]
    ds_read_b64_tr_b16 v[240:241], v4 offset:57856
    s_waitcnt vmcnt(10)
    v_mfma_f32_16x16x32_bf16 v[28:31], v[224:227], v[116:119], v[28:31]
    ds_read_b64_tr_b16 v[242:243], v4 offset:58880
    s_waitcnt lgkmcnt(6)
    v_mfma_f32_16x16x32_bf16 v[32:35], v[228:231], v[112:115], v[32:35]
    ds_read_b64_tr_b16 v[244:245], v5 offset:57888
    v_mfma_f32_16x16x32_bf16 v[36:39], v[228:231], v[116:119], v[36:39]
    ds_read_b64_tr_b16 v[246:247], v5 offset:58912
    s_mov_b32 s23, 0x4800
    buffer_load_dwordx4 v[96:99], v7, s[8:11], s23 offen offset:1024 sc1
    s_waitcnt lgkmcnt(6)
    v_mfma_f32_16x16x32_bf16 v[40:43], v[232:235], v[112:115], v[40:43]
    ds_read_b64_tr_b16 v[224:225], v4 offset:58112
    v_mfma_f32_16x16x32_bf16 v[44:47], v[232:235], v[116:119], v[44:47]
    ds_read_b64_tr_b16 v[226:227], v4 offset:59136
    s_waitcnt lgkmcnt(6)
    v_mfma_f32_16x16x32_bf16 v[48:51], v[236:239], v[112:115], v[48:51]
    ds_read_b64_tr_b16 v[228:229], v5 offset:58144
    v_mfma_f32_16x16x32_bf16 v[52:55], v[236:239], v[116:119], v[52:55]
    ds_read_b64_tr_b16 v[230:231], v5 offset:59168
    s_waitcnt lgkmcnt(6)
    v_mfma_f32_16x16x32_bf16 v[56:59], v[240:243], v[112:115], v[56:59]
    v_mfma_f32_16x16x32_bf16 v[60:63], v[240:243], v[116:119], v[60:63]
    s_waitcnt vmcnt(10)
    s_barrier
    ds_read_b64_tr_b16 v[232:233], v4 offset:0
    ds_read_b64_tr_b16 v[234:235], v4 offset:1024
    s_waitcnt lgkmcnt(6)
    v_mfma_f32_16x16x32_bf16 v[64:67], v[244:247], v[112:115], v[64:67]
    ds_read_b64_tr_b16 v[236:237], v5 offset:32
    v_mfma_f32_16x16x32_bf16 v[68:71], v[244:247], v[116:119], v[68:71]
    s_add_u32 s22, s19, 0x500000
    s_add_u32 m0, s20, 0x8000
    s_nop 0
    buffer_load_dwordx4 v3, s[4:7], s22 offen lds
    ds_read_b64_tr_b16 v[238:239], v5 offset:1056
    s_mov_b32 s23, 0xc800
    buffer_load_dwordx4 v[100:103], v7, s[8:11], s23 offen offset:1024 sc1
    s_waitcnt lgkmcnt(6)
    v_mfma_f32_16x16x32_bf16 v[72:75], v[224:227], v[112:115], v[72:75]
    ds_read_b64_tr_b16 v[240:241], v4 offset:256
    v_mfma_f32_16x16x32_bf16 v[76:79], v[224:227], v[116:119], v[76:79]
    ds_read_b64_tr_b16 v[242:243], v4 offset:1280
    s_waitcnt lgkmcnt(6)
    v_mfma_f32_16x16x32_bf16 v[80:83], v[228:231], v[112:115], v[80:83]
    ds_read_b64_tr_b16 v[244:245], v5 offset:288
    v_mfma_f32_16x16x32_bf16 v[84:87], v[228:231], v[116:119], v[84:87]
    ds_read_b64_tr_b16 v[246:247], v5 offset:1312
    s_waitcnt vmcnt(11) lgkmcnt(6)
    v_mfma_f32_16x16x32_bf16 v[24:27], v[232:235], v[120:123], v[24:27]
    ds_read_b64_tr_b16 v[224:225], v4 offset:512
    s_waitcnt vmcnt(10)
    v_mfma_f32_16x16x32_bf16 v[28:31], v[232:235], v[124:127], v[28:31]
    ds_read_b64_tr_b16 v[226:227], v4 offset:1536
    s_waitcnt lgkmcnt(6)
    v_mfma_f32_16x16x32_bf16 v[32:35], v[236:239], v[120:123], v[32:35]
    ds_read_b64_tr_b16 v[228:229], v5 offset:544
    v_mfma_f32_16x16x32_bf16 v[36:39], v[236:239], v[124:127], v[36:39]
    s_add_u32 s22, s19, 0x508000
    s_add_u32 m0, s20, 0x8400
    s_nop 0
    buffer_load_dwordx4 v3, s[4:7], s22 offen lds
    ds_read_b64_tr_b16 v[230:231], v5 offset:1568
    s_mov_b32 s23, 0x5000
    buffer_load_dwordx4 v[104:107], v7, s[8:11], s23 offen offset:0 sc1
    s_waitcnt lgkmcnt(6)
    v_mfma_f32_16x16x32_bf16 v[40:43], v[240:243], v[120:123], v[40:43]
    ds_read_b64_tr_b16 v[232:233], v4 offset:768
    v_mfma_f32_16x16x32_bf16 v[44:47], v[240:243], v[124:127], v[44:47]
    ds_read_b64_tr_b16 v[234:235], v4 offset:1792
    s_waitcnt lgkmcnt(6)
    v_mfma_f32_16x16x32_bf16 v[48:51], v[244:247], v[120:123], v[48:51]
    ds_read_b64_tr_b16 v[236:237], v5 offset:800
    v_mfma_f32_16x16x32_bf16 v[52:55], v[244:247], v[124:127], v[52:55]
    ds_read_b64_tr_b16 v[238:239], v5 offset:1824
    s_waitcnt lgkmcnt(6)
    v_mfma_f32_16x16x32_bf16 v[56:59], v[224:227], v[120:123], v[56:59]
    ds_read_b64_tr_b16 v[240:241], v4 offset:8192
    v_mfma_f32_16x16x32_bf16 v[60:63], v[224:227], v[124:127], v[60:63]
    ds_read_b64_tr_b16 v[242:243], v4 offset:9216
    s_waitcnt lgkmcnt(6)
    v_mfma_f32_16x16x32_bf16 v[64:67], v[228:231], v[120:123], v[64:67]
    ds_read_b64_tr_b16 v[244:245], v5 offset:8224
    v_mfma_f32_16x16x32_bf16 v[68:71], v[228:231], v[124:127], v[68:71]
    ds_read_b64_tr_b16 v[246:247], v5 offset:9248
    s_mov_b32 s23, 0xd000
    buffer_load_dwordx4 v[108:111], v7, s[8:11], s23 offen offset:0 sc1
    s_waitcnt lgkmcnt(6)
    v_mfma_f32_16x16x32_bf16 v[72:75], v[232:235], v[120:123], v[72:75]
    ds_read_b64_tr_b16 v[224:225], v4 offset:8448
    v_mfma_f32_16x16x32_bf16 v[76:79], v[232:235], v[124:127], v[76:79]
    ds_read_b64_tr_b16 v[226:227], v4 offset:9472
    s_waitcnt lgkmcnt(6)
    v_mfma_f32_16x16x32_bf16 v[80:83], v[236:239], v[120:123], v[80:83]
    ds_read_b64_tr_b16 v[228:229], v5 offset:8480
    v_mfma_f32_16x16x32_bf16 v[84:87], v[236:239], v[124:127], v[84:87]
    ds_read_b64_tr_b16 v[230:231], v5 offset:9504
    s_waitcnt vmcnt(11) lgkmcnt(6)
    v_mfma_f32_16x16x32_bf16 v[24:27], v[240:243], v[128:131], v[24:27]
    ds_read_b64_tr_b16 v[232:233], v4 offset:8704
    s_waitcnt vmcnt(9)
    v_mfma_f32_16x16x32_bf16 v[28:31], v[240:243], v[132:135], v[28:31]
    ds_read_b64_tr_b16 v[234:235], v4 offset:9728
    s_waitcnt lgkmcnt(6)
    v_mfma_f32_16x16x32_bf16 v[32:35], v[244:247], v[128:131], v[32:35]
    ds_read_b64_tr_b16 v[236:237], v5 offset:8736
    v_mfma_f32_16x16x32_bf16 v[36:39], v[244:247], v[132:135], v[36:39]
    ds_read_b64_tr_b16 v[238:239], v5 offset:9760
    s_mov_b32 s23, 0x5000
    buffer_load_dwordx4 v[112:115], v7, s[8:11], s23 offen offset:1024 sc1
    s_waitcnt lgkmcnt(6)
    v_mfma_f32_16x16x32_bf16 v[40:43], v[224:227], v[128:131], v[40:43]
    ds_read_b64_tr_b16 v[240:241], v4 offset:8960
    v_mfma_f32_16x16x32_bf16 v[44:47], v[224:227], v[132:135], v[44:47]
    ds_read_b64_tr_b16 v[242:243], v4 offset:9984
    s_waitcnt lgkmcnt(6)
    v_mfma_f32_16x16x32_bf16 v[48:51], v[228:231], v[128:131], v[48:51]
    ds_read_b64_tr_b16 v[244:245], v5 offset:8992
    v_mfma_f32_16x16x32_bf16 v[52:55], v[228:231], v[132:135], v[52:55]
    ds_read_b64_tr_b16 v[246:247], v5 offset:10016
    s_waitcnt lgkmcnt(6)
    v_mfma_f32_16x16x32_bf16 v[56:59], v[232:235], v[128:131], v[56:59]
    v_mfma_f32_16x16x32_bf16 v[60:63], v[232:235], v[132:135], v[60:63]
    s_waitcnt vmcnt(9)
    s_barrier
    ds_read_b64_tr_b16 v[224:225], v4 offset:16384
    ds_read_b64_tr_b16 v[226:227], v4 offset:17408
    s_waitcnt lgkmcnt(6)
    v_mfma_f32_16x16x32_bf16 v[64:67], v[236:239], v[128:131], v[64:67]
    ds_read_b64_tr_b16 v[228:229], v5 offset:16416
    v_mfma_f32_16x16x32_bf16 v[68:71], v[236:239], v[132:135], v[68:71]
    s_add_u32 s22, s19, 0x580000
    s_add_u32 m0, s20, 0xc000
    s_nop 0
    buffer_load_dwordx4 v3, s[4:7], s22 offen lds
    ds_read_b64_tr_b16 v[230:231], v5 offset:17440
    s_mov_b32 s23, 0xd000
    buffer_load_dwordx4 v[116:119], v7, s[8:11], s23 offen offset:1024 sc1
    s_waitcnt lgkmcnt(6)
    v_mfma_f32_16x16x32_bf16 v[72:75], v[240:243], v[128:131], v[72:75]
    ds_read_b64_tr_b16 v[232:233], v4 offset:16640
    v_mfma_f32_16x16x32_bf16 v[76:79], v[240:243], v[132:135], v[76:79]
    ds_read_b64_tr_b16 v[234:235], v4 offset:17664
    s_waitcnt lgkmcnt(6)
    v_mfma_f32_16x16x32_bf16 v[80:83], v[244:247], v[128:131], v[80:83]
    ds_read_b64_tr_b16 v[236:237], v5 offset:16672
    v_mfma_f32_16x16x32_bf16 v[84:87], v[244:247], v[132:135], v[84:87]
    ds_read_b64_tr_b16 v[238:239], v5 offset:17696
    s_waitcnt vmcnt(10) lgkmcnt(6)
    v_mfma_f32_16x16x32_bf16 v[24:27], v[224:227], v[88:91], v[24:27]
    ds_read_b64_tr_b16 v[240:241], v4 offset:16896
    s_waitcnt vmcnt(9)
    v_mfma_f32_16x16x32_bf16 v[28:31], v[224:227], v[92:95], v[28:31]
    ds_read_b64_tr_b16 v[242:243], v4 offset:17920
    s_waitcnt lgkmcnt(6)
    v_mfma_f32_16x16x32_bf16 v[32:35], v[228:231], v[88:91], v[32:35]
    ds_read_b64_tr_b16 v[244:245], v5 offset:16928
    v_mfma_f32_16x16x32_bf16 v[36:39], v[228:231], v[92:95], v[36:39]
    s_add_u32 s22, s19, 0x588000
    s_add_u32 m0, s20, 0xc400
    s_nop 0
    buffer_load_dwordx4 v3, s[4:7], s22 offen lds
    ds_read_b64_tr_b16 v[246:247], v5 offset:17952
    s_mov_b32 s23, 0x5800
    buffer_load_dwordx4 v[120:123], v7, s[8:11], s23 offen offset:0 sc1
    s_waitcnt lgkmcnt(6)
    v_mfma_f32_16x16x32_bf16 v[40:43], v[232:235], v[88:91], v[40:43]
    ds_read_b64_tr_b16 v[224:225], v4 offset:17152
    v_mfma_f32_16x16x32_bf16 v[44:47], v[232:235], v[92:95], v[44:47]
    ds_read_b64_tr_b16 v[226:227], v4 offset:18176
    s_waitcnt lgkmcnt(6)
    v_mfma_f32_16x16x32_bf16 v[48:51], v[236:239], v[88:91], v[48:51]
    ds_read_b64_tr_b16 v[228:229], v5 offset:17184
    v_mfma_f32_16x16x32_bf16 v[52:55], v[236:239], v[92:95], v[52:55]
    ds_read_b64_tr_b16 v[230:231], v5 offset:18208
    s_waitcnt lgkmcnt(6)
    v_mfma_f32_16x16x32_bf16 v[56:59], v[240:243], v[88:91], v[56:59]
    ds_read_b64_tr_b16 v[232:233], v4 offset:24576
    v_mfma_f32_16x16x32_bf16 v[60:63], v[240:243], v[92:95], v[60:63]
    ds_read_b64_tr_b16 v[234:235], v4 offset:25600
    s_waitcnt lgkmcnt(6)
    v_mfma_f32_16x16x32_bf16 v[64:67], v[244:247], v[88:91], v[64:67]
    ds_read_b64_tr_b16 v[236:237], v5 offset:24608
    v_mfma_f32_16x16x32_bf16 v[68:71], v[244:247], v[92:95], v[68:71]
    ds_read_b64_tr_b16 v[238:239], v5 offset:25632
    s_mov_b32 s23, 0xd800
    buffer_load_dwordx4 v[124:127], v7, s[8:11], s23 offen offset:0 sc1
    s_waitcnt lgkmcnt(6)
    v_mfma_f32_16x16x32_bf16 v[72:75], v[224:227], v[88:91], v[72:75]
    ds_read_b64_tr_b16 v[240:241], v4 offset:24832
    v_xor_b32 v8, s28, v12
    v_xor_b32 v20, s28, v13
    v_or_b32 v8, v8, v20
    v_xor_b32 v20, s28, v14
    v_or_b32 v8, v8, v20
    v_xor_b32 v20, s28, v15
    v_or_b32 v8, v8, v20
    v_cmp_ne_u32 vcc, 0, v8
    s_cbranch_vccnz adaLN_cond__sliding_block_cached__moe_arch_mod__prompt_kernel_kv4r
adaLN_cond__sliding_block_cached__moe_arch_mod__prompt_kernel_kv4b:
    v_mfma_f32_16x16x32_bf16 v[76:79], v[224:227], v[92:95], v[76:79]
    ds_read_b64_tr_b16 v[242:243], v4 offset:25856
    s_waitcnt lgkmcnt(6)
    v_mfma_f32_16x16x32_bf16 v[80:83], v[228:231], v[88:91], v[80:83]
    ds_read_b64_tr_b16 v[244:245], v5 offset:24864
    v_mfma_f32_16x16x32_bf16 v[84:87], v[228:231], v[92:95], v[84:87]
    ds_read_b64_tr_b16 v[246:247], v5 offset:25888
    s_waitcnt vmcnt(11) lgkmcnt(6)
    v_mfma_f32_16x16x32_bf16 v[24:27], v[232:235], v[96:99], v[24:27]
    ds_read_b64_tr_b16 v[224:225], v4 offset:25088
    s_waitcnt vmcnt(9)
    v_mfma_f32_16x16x32_bf16 v[28:31], v[232:235], v[100:103], v[28:31]
    ds_read_b64_tr_b16 v[226:227], v4 offset:26112
    s_waitcnt lgkmcnt(6)
    v_mfma_f32_16x16x32_bf16 v[32:35], v[236:239], v[96:99], v[32:35]
    ds_read_b64_tr_b16 v[228:229], v5 offset:25120
    v_mfma_f32_16x16x32_bf16 v[36:39], v[236:239], v[100:103], v[36:39]
    ds_read_b64_tr_b16 v[230:231], v5 offset:26144
    s_mov_b32 s23, 0x5800
    buffer_load_dwordx4 v[128:131], v7, s[8:11], s23 offen offset:1024 sc1
    s_waitcnt lgkmcnt(6)
    v_mfma_f32_16x16x32_bf16 v[40:43], v[240:243], v[96:99], v[40:43]
    ds_read_b64_tr_b16 v[232:233], v4 offset:25344
    v_mfma_f32_16x16x32_bf16 v[44:47], v[240:243], v[100:103], v[44:47]
    ds_read_b64_tr_b16 v[234:235], v4 offset:26368
    s_waitcnt lgkmcnt(6)
    v_mfma_f32_16x16x32_bf16 v[48:51], v[244:247], v[96:99], v[48:51]
    ds_read_b64_tr_b16 v[236:237], v5 offset:25376
    v_mfma_f32_16x16x32_bf16 v[52:55], v[244:247], v[100:103], v[52:55]
    ds_read_b64_tr_b16 v[238:239], v5 offset:26400
    s_waitcnt lgkmcnt(6)
    v_mfma_f32_16x16x32_bf16 v[56:59], v[224:227], v[96:99], v[56:59]
    v_mfma_f32_16x16x32_bf16 v[60:63], v[224:227], v[100:103], v[60:63]
    s_waitcnt vmcnt(9)
    s_barrier
    ds_read_b64_tr_b16 v[240:241], v4 offset:32768
    ds_read_b64_tr_b16 v[242:243], v4 offset:33792
    s_waitcnt lgkmcnt(6)
    v_mfma_f32_16x16x32_bf16 v[64:67], v[228:231], v[96:99], v[64:67]
    ds_read_b64_tr_b16 v[244:245], v5 offset:32800
    v_mfma_f32_16x16x32_bf16 v[68:71], v[228:231], v[100:103], v[68:71]
    s_add_u32 s22, s19, 0x600000
    s_add_u32 m0, s20, 0x0
    s_nop 0
    buffer_load_dwordx4 v3, s[4:7], s22 offen lds
    ds_read_b64_tr_b16 v[246:247], v5 offset:33824
    s_mov_b32 s23, 0xd800
    buffer_load_dwordx4 v[132:135], v7, s[8:11], s23 offen offset:1024 sc1
    s_waitcnt lgkmcnt(6)
    v_mfma_f32_16x16x32_bf16 v[72:75], v[232:235], v[96:99], v[72:75]
    ds_read_b64_tr_b16 v[224:225], v4 offset:33024
    v_mfma_f32_16x16x32_bf16 v[76:79], v[232:235], v[100:103], v[76:79]
    ds_read_b64_tr_b16 v[226:227], v4 offset:34048
    s_waitcnt lgkmcnt(6)
    v_mfma_f32_16x16x32_bf16 v[80:83], v[236:239], v[96:99], v[80:83]
    ds_read_b64_tr_b16 v[228:229], v5 offset:33056
    v_mfma_f32_16x16x32_bf16 v[84:87], v[236:239], v[100:103], v[84:87]
    ds_read_b64_tr_b16 v[230:231], v5 offset:34080
    s_waitcnt vmcnt(10) lgkmcnt(6)
    v_mfma_f32_16x16x32_bf16 v[24:27], v[240:243], v[104:107], v[24:27]
    ds_read_b64_tr_b16 v[232:233], v4 offset:33280
    s_waitcnt vmcnt(9)
    v_mfma_f32_16x16x32_bf16 v[28:31], v[240:243], v[108:111], v[28:31]
    ds_read_b64_tr_b16 v[234:235], v4 offset:34304
    s_waitcnt lgkmcnt(6)
    v_mfma_f32_16x16x32_bf16 v[32:35], v[244:247], v[104:107], v[32:35]
    ds_read_b64_tr_b16 v[236:237], v5 offset:33312
    v_mfma_f32_16x16x32_bf16 v[36:39], v[244:247], v[108:111], v[36:39]
    s_add_u32 s22, s19, 0x608000
    s_add_u32 m0, s20, 0x400
    s_nop 0
    buffer_load_dwordx4 v3, s[4:7], s22 offen lds
    ds_read_b64_tr_b16 v[238:239], v5 offset:34336
    s_mov_b32 s23, 0x6000
    buffer_load_dwordx4 v[88:91], v7, s[8:11], s23 offen offset:0 sc1
    s_waitcnt lgkmcnt(6)
    v_mfma_f32_16x16x32_bf16 v[40:43], v[224:227], v[104:107], v[40:43]
    ds_read_b64_tr_b16 v[240:241], v4 offset:33536
    v_mfma_f32_16x16x32_bf16 v[44:47], v[224:227], v[108:111], v[44:47]
    ds_read_b64_tr_b16 v[242:243], v4 offset:34560
    s_waitcnt lgkmcnt(6)
    v_mfma_f32_16x16x32_bf16 v[48:51], v[228:231], v[104:107], v[48:51]
    ds_read_b64_tr_b16 v[244:245], v5 offset:33568
    v_mfma_f32_16x16x32_bf16 v[52:55], v[228:231], v[108:111], v[52:55]
    ds_read_b64_tr_b16 v[246:247], v5 offset:34592
    s_waitcnt lgkmcnt(6)
    v_mfma_f32_16x16x32_bf16 v[56:59], v[232:235], v[104:107], v[56:59]
    ds_read_b64_tr_b16 v[224:225], v4 offset:40960
    v_mfma_f32_16x16x32_bf16 v[60:63], v[232:235], v[108:111], v[60:63]
    ds_read_b64_tr_b16 v[226:227], v4 offset:41984
    s_waitcnt lgkmcnt(6)
    v_mfma_f32_16x16x32_bf16 v[64:67], v[236:239], v[104:107], v[64:67]
    ds_read_b64_tr_b16 v[228:229], v5 offset:40992
    v_mfma_f32_16x16x32_bf16 v[68:71], v[236:239], v[108:111], v[68:71]
    ds_read_b64_tr_b16 v[230:231], v5 offset:42016
    s_mov_b32 s23, 0xe000
    buffer_load_dwordx4 v[92:95], v7, s[8:11], s23 offen offset:0 sc1
    s_waitcnt lgkmcnt(6)
    v_mfma_f32_16x16x32_bf16 v[72:75], v[240:243], v[104:107], v[72:75]
    ds_read_b64_tr_b16 v[232:233], v4 offset:41216
    v_mfma_f32_16x16x32_bf16 v[76:79], v[240:243], v[108:111], v[76:79]
    ds_read_b64_tr_b16 v[234:235], v4 offset:42240
    s_waitcnt lgkmcnt(6)
    v_mfma_f32_16x16x32_bf16 v[80:83], v[244:247], v[104:107], v[80:83]
    ds_read_b64_tr_b16 v[236:237], v5 offset:41248
    v_mfma_f32_16x16x32_bf16 v[84:87], v[244:247], v[108:111], v[84:87]
    ds_read_b64_tr_b16 v[238:239], v5 offset:42272
    s_waitcnt vmcnt(11) lgkmcnt(6)
    v_mfma_f32_16x16x32_bf16 v[24:27], v[224:227], v[112:115], v[24:27]
    ds_read_b64_tr_b16 v[240:241], v4 offset:41472
    s_add_u32 s22, s21, 0x0
    s_add_u32 m0, s20, 0x10000
    s_nop 0
    buffer_load_dwordx4 v2, s[8:11], s22 offen sc1 lds
    s_waitcnt vmcnt(10)
    v_mfma_f32_16x16x32_bf16 v[28:31], v[224:227], v[116:119], v[28:31]
    ds_read_b64_tr_b16 v[242:243], v4 offset:42496
    s_waitcnt lgkmcnt(6)
    v_mfma_f32_16x16x32_bf16 v[32:35], v[228:231], v[112:115], v[32:35]
    ds_read_b64_tr_b16 v[244:245], v5 offset:41504
    v_mfma_f32_16x16x32_bf16 v[36:39], v[228:231], v[116:119], v[36:39]
    ds_read_b64_tr_b16 v[246:247], v5 offset:42528
    s_mov_b32 s23, 0x6000
    buffer_load_dwordx4 v[96:99], v7, s[8:11], s23 offen offset:1024 sc1
    s_waitcnt lgkmcnt(6)
    v_mfma_f32_16x16x32_bf16 v[40:43], v[232:235], v[112:115], v[40:43]
    ds_read_b64_tr_b16 v[224:225], v4 offset:41728
    s_add_u32 s22, s21, 0x400
    s_add_u32 m0, s20, 0x10400
    s_nop 0
    buffer_load_dwordx4 v2, s[8:11], s22 offen sc1 lds
    v_mfma_f32_16x16x32_bf16 v[44:47], v[232:235], v[116:119], v[44:47]
    ds_read_b64_tr_b16 v[226:227], v4 offset:42752
    s_waitcnt lgkmcnt(6)
    v_mfma_f32_16x16x32_bf16 v[48:51], v[236:239], v[112:115], v[48:51]
    ds_read_b64_tr_b16 v[228:229], v5 offset:41760
    v_mfma_f32_16x16x32_bf16 v[52:55], v[236:239], v[116:119], v[52:55]
    ds_read_b64_tr_b16 v[230:231], v5 offset:42784
    s_waitcnt lgkmcnt(6)
    v_mfma_f32_16x16x32_bf16 v[56:59], v[240:243], v[112:115], v[56:59]
    v_mfma_f32_16x16x32_bf16 v[60:63], v[240:243], v[116:119], v[60:63]
    s_waitcnt vmcnt(11)
    s_barrier
    ds_read_b64_tr_b16 v[232:233], v4 offset:49152
    ds_read_b64_tr_b16 v[234:235], v4 offset:50176
    s_waitcnt lgkmcnt(6)
    v_mfma_f32_16x16x32_bf16 v[64:67], v[244:247], v[112:115], v[64:67]
    ds_read_b64_tr_b16 v[236:237], v5 offset:49184
    v_mfma_f32_16x16x32_bf16 v[68:71], v[244:247], v[116:119], v[68:71]
    s_add_u32 s22, s19, 0x680000
    s_add_u32 m0, s20, 0x4000
    s_nop 0
    buffer_load_dwordx4 v3, s[4:7], s22 offen lds
    ds_read_b64_tr_b16 v[238:239], v5 offset:50208
    s_mov_b32 s23, 0xe000
    buffer_load_dwordx4 v[100:103], v7, s[8:11], s23 offen offset:1024 sc1
    s_waitcnt lgkmcnt(6)
    v_mfma_f32_16x16x32_bf16 v[72:75], v[224:227], v[112:115], v[72:75]
    ds_read_b64_tr_b16 v[240:241], v4 offset:49408
    v_mfma_f32_16x16x32_bf16 v[76:79], v[224:227], v[116:119], v[76:79]
    ds_read_b64_tr_b16 v[242:243], v4 offset:50432
    s_waitcnt lgkmcnt(6)
    v_mfma_f32_16x16x32_bf16 v[80:83], v[228:231], v[112:115], v[80:83]
    ds_read_b64_tr_b16 v[244:245], v5 offset:49440
    v_mfma_f32_16x16x32_bf16 v[84:87], v[228:231], v[116:119], v[84:87]
    ds_read_b64_tr_b16 v[246:247], v5 offset:50464
    s_waitcnt vmcnt(12) lgkmcnt(6)
    v_mfma_f32_16x16x32_bf16 v[24:27], v[232:235], v[120:123], v[24:27]
    ds_read_b64_tr_b16 v[224:225], v4 offset:49664
    s_waitcnt vmcnt(11)
    v_mfma_f32_16x16x32_bf16 v[28:31], v[232:235], v[124:127], v[28:31]
    ds_read_b64_tr_b16 v[226:227], v4 offset:50688
    s_waitcnt lgkmcnt(6)
    v_mfma_f32_16x16x32_bf16 v[32:35], v[236:239], v[120:123], v[32:35]
    ds_read_b64_tr_b16 v[228:229], v5 offset:49696
    v_mfma_f32_16x16x32_bf16 v[36:39], v[236:239], v[124:127], v[36:39]
    s_add_u32 s22, s19, 0x688000
    s_add_u32 m0, s20, 0x4400
    s_nop 0
    buffer_load_dwordx4 v3, s[4:7], s22 offen lds
    ds_read_b64_tr_b16 v[230:231], v5 offset:50720
    s_mov_b32 s23, 0x6800
    buffer_load_dwordx4 v[104:107], v7, s[8:11], s23 offen offset:0 sc1
    s_waitcnt lgkmcnt(6)
    v_mfma_f32_16x16x32_bf16 v[40:43], v[240:243], v[120:123], v[40:43]
    ds_read_b64_tr_b16 v[232:233], v4 offset:49920
    v_mfma_f32_16x16x32_bf16 v[44:47], v[240:243], v[124:127], v[44:47]
    ds_read_b64_tr_b16 v[234:235], v4 offset:50944
    s_waitcnt lgkmcnt(6)
    v_mfma_f32_16x16x32_bf16 v[48:51], v[244:247], v[120:123], v[48:51]
    ds_read_b64_tr_b16 v[236:237], v5 offset:49952
    v_mfma_f32_16x16x32_bf16 v[52:55], v[244:247], v[124:127], v[52:55]
    ds_read_b64_tr_b16 v[238:239], v5 offset:50976
    s_waitcnt lgkmcnt(6)
    v_mfma_f32_16x16x32_bf16 v[56:59], v[224:227], v[120:123], v[56:59]
    ds_read_b64_tr_b16 v[240:241], v4 offset:57344
    v_mfma_f32_16x16x32_bf16 v[60:63], v[224:227], v[124:127], v[60:63]
    ds_read_b64_tr_b16 v[242:243], v4 offset:58368
    s_waitcnt lgkmcnt(6)
    v_mfma_f32_16x16x32_bf16 v[64:67], v[228:231], v[120:123], v[64:67]
    ds_read_b64_tr_b16 v[244:245], v5 offset:57376
    v_mfma_f32_16x16x32_bf16 v[68:71], v[228:231], v[124:127], v[68:71]
    ds_read_b64_tr_b16 v[246:247], v5 offset:58400
    s_mov_b32 s23, 0xe800
    buffer_load_dwordx4 v[108:111], v7, s[8:11], s23 offen offset:0 sc1
    s_waitcnt lgkmcnt(6)
    v_mfma_f32_16x16x32_bf16 v[72:75], v[232:235], v[120:123], v[72:75]
    ds_read_b64_tr_b16 v[224:225], v4 offset:57600
    v_mfma_f32_16x16x32_bf16 v[76:79], v[232:235], v[124:127], v[76:79]
    ds_read_b64_tr_b16 v[226:227], v4 offset:58624
    s_waitcnt lgkmcnt(6)
    v_mfma_f32_16x16x32_bf16 v[80:83], v[236:239], v[120:123], v[80:83]
    ds_read_b64_tr_b16 v[228:229], v5 offset:57632
    v_mfma_f32_16x16x32_bf16 v[84:87], v[236:239], v[124:127], v[84:87]
    ds_read_b64_tr_b16 v[230:231], v5 offset:58656
    s_waitcnt vmcnt(13) lgkmcnt(6)
    v_mfma_f32_16x16x32_bf16 v[24:27], v[240:243], v[128:131], v[24:27]
    ds_read_b64_tr_b16 v[232:233], v4 offset:57856
    s_add_u32 s22, s21, 0x4000
    s_add_u32 m0, s20, 0x14000
    s_nop 0
    buffer_load_dwordx4 v2, s[8:11], s22 offen sc1 lds
    s_waitcnt vmcnt(12)
    v_mfma_f32_16x16x32_bf16 v[28:31], v[240:243], v[132:135], v[28:31]
    ds_read_b64_tr_b16 v[234:235], v4 offset:58880
    s_waitcnt lgkmcnt(6)
    v_mfma_f32_16x16x32_bf16 v[32:35], v[244:247], v[128:131], v[32:35]
    ds_read_b64_tr_b16 v[236:237], v5 offset:57888
    v_mfma_f32_16x16x32_bf16 v[36:39], v[244:247], v[132:135], v[36:39]
    ds_read_b64_tr_b16 v[238:239], v5 offset:58912
    s_mov_b32 s23, 0x6800
    buffer_load_dwordx4 v[112:115], v7, s[8:11], s23 offen offset:1024 sc1
    s_waitcnt lgkmcnt(6)
    v_mfma_f32_16x16x32_bf16 v[40:43], v[224:227], v[128:131], v[40:43]
    ds_read_b64_tr_b16 v[240:241], v4 offset:58112
    s_add_u32 s22, s21, 0x4400
    s_add_u32 m0, s20, 0x14400
    s_nop 0
    buffer_load_dwordx4 v2, s[8:11], s22 offen sc1 lds
    v_mfma_f32_16x16x32_bf16 v[44:47], v[224:227], v[132:135], v[44:47]
    ds_read_b64_tr_b16 v[242:243], v4 offset:59136
    s_waitcnt lgkmcnt(6)
    v_mfma_f32_16x16x32_bf16 v[48:51], v[228:231], v[128:131], v[48:51]
    ds_read_b64_tr_b16 v[244:245], v5 offset:58144
    v_mfma_f32_16x16x32_bf16 v[52:55], v[228:231], v[132:135], v[52:55]
    ds_read_b64_tr_b16 v[246:247], v5 offset:59168
    s_waitcnt lgkmcnt(6)
    v_mfma_f32_16x16x32_bf16 v[56:59], v[232:235], v[128:131], v[56:59]
    v_mfma_f32_16x16x32_bf16 v[60:63], v[232:235], v[132:135], v[60:63]
    s_waitcnt vmcnt(13)
    s_barrier
    ds_read_b64_tr_b16 v[224:225], v4 offset:0
    ds_read_b64_tr_b16 v[226:227], v4 offset:1024
    s_waitcnt lgkmcnt(6)
    v_mfma_f32_16x16x32_bf16 v[64:67], v[236:239], v[128:131], v[64:67]
    ds_read_b64_tr_b16 v[228:229], v5 offset:32
    v_mfma_f32_16x16x32_bf16 v[68:71], v[236:239], v[132:135], v[68:71]
    s_add_u32 s22, s19, 0x700000
    s_add_u32 m0, s20, 0x8000
    s_nop 0
    buffer_load_dwordx4 v3, s[4:7], s22 offen lds
    ds_read_b64_tr_b16 v[230:231], v5 offset:1056
    s_mov_b32 s23, 0xe800
    buffer_load_dwordx4 v[116:119], v7, s[8:11], s23 offen offset:1024 sc1
    s_waitcnt lgkmcnt(6)
    v_mfma_f32_16x16x32_bf16 v[72:75], v[240:243], v[128:131], v[72:75]
    ds_read_b64_tr_b16 v[232:233], v4 offset:256
    v_mfma_f32_16x16x32_bf16 v[76:79], v[240:243], v[132:135], v[76:79]
    ds_read_b64_tr_b16 v[234:235], v4 offset:1280
    s_waitcnt lgkmcnt(6)
    v_mfma_f32_16x16x32_bf16 v[80:83], v[244:247], v[128:131], v[80:83]
    ds_read_b64_tr_b16 v[236:237], v5 offset:288
    v_mfma_f32_16x16x32_bf16 v[84:87], v[244:247], v[132:135], v[84:87]
    ds_read_b64_tr_b16 v[238:239], v5 offset:1312
    s_waitcnt vmcnt(14) lgkmcnt(6)
    v_mfma_f32_16x16x32_bf16 v[24:27], v[224:227], v[88:91], v[24:27]
    ds_read_b64_tr_b16 v[240:241], v4 offset:512
    s_waitcnt vmcnt(13)
    v_mfma_f32_16x16x32_bf16 v[28:31], v[224:227], v[92:95], v[28:31]
    ds_read_b64_tr_b16 v[242:243], v4 offset:1536
    s_waitcnt lgkmcnt(6)
    v_mfma_f32_16x16x32_bf16 v[32:35], v[228:231], v[88:91], v[32:35]
    ds_read_b64_tr_b16 v[244:245], v5 offset:544
    v_mfma_f32_16x16x32_bf16 v[36:39], v[228:231], v[92:95], v[36:39]
    s_add_u32 s22, s19, 0x708000
    s_add_u32 m0, s20, 0x8400
    s_nop 0
    buffer_load_dwordx4 v3, s[4:7], s22 offen lds
    ds_read_b64_tr_b16 v[246:247], v5 offset:1568
    s_mov_b32 s23, 0x7000
    buffer_load_dwordx4 v[120:123], v7, s[8:11], s23 offen offset:0 sc1
    s_waitcnt lgkmcnt(6)
    v_mfma_f32_16x16x32_bf16 v[40:43], v[232:235], v[88:91], v[40:43]
    ds_read_b64_tr_b16 v[224:225], v4 offset:768
    v_mfma_f32_16x16x32_bf16 v[44:47], v[232:235], v[92:95], v[44:47]
    ds_read_b64_tr_b16 v[226:227], v4 offset:1792
    s_waitcnt lgkmcnt(6)
    v_mfma_f32_16x16x32_bf16 v[48:51], v[236:239], v[88:91], v[48:51]
    ds_read_b64_tr_b16 v[228:229], v5 offset:800
    v_mfma_f32_16x16x32_bf16 v[52:55], v[236:239], v[92:95], v[52:55]
    ds_read_b64_tr_b16 v[230:231], v5 offset:1824
    s_waitcnt lgkmcnt(6)
    v_mfma_f32_16x16x32_bf16 v[56:59], v[240:243], v[88:91], v[56:59]
    ds_read_b64_tr_b16 v[232:233], v4 offset:8192
    v_mfma_f32_16x16x32_bf16 v[60:63], v[240:243], v[92:95], v[60:63]
    ds_read_b64_tr_b16 v[234:235], v4 offset:9216
    s_waitcnt lgkmcnt(6)
    v_mfma_f32_16x16x32_bf16 v[64:67], v[244:247], v[88:91], v[64:67]
    ds_read_b64_tr_b16 v[236:237], v5 offset:8224
    v_mfma_f32_16x16x32_bf16 v[68:71], v[244:247], v[92:95], v[68:71]
    ds_read_b64_tr_b16 v[238:239], v5 offset:9248
    s_mov_b32 s23, 0xf000
    buffer_load_dwordx4 v[124:127], v7, s[8:11], s23 offen offset:0 sc1
    s_waitcnt lgkmcnt(6)
    v_mfma_f32_16x16x32_bf16 v[72:75], v[224:227], v[88:91], v[72:75]
    ds_read_b64_tr_b16 v[240:241], v4 offset:8448
    v_mfma_f32_16x16x32_bf16 v[76:79], v[224:227], v[92:95], v[76:79]
    ds_read_b64_tr_b16 v[242:243], v4 offset:9472
    s_waitcnt lgkmcnt(6)
    v_mfma_f32_16x16x32_bf16 v[80:83], v[228:231], v[88:91], v[80:83]
    ds_read_b64_tr_b16 v[244:245], v5 offset:8480
    v_mfma_f32_16x16x32_bf16 v[84:87], v[228:231], v[92:95], v[84:87]
    ds_read_b64_tr_b16 v[246:247], v5 offset:9504
    s_waitcnt vmcnt(14) lgkmcnt(6)
    v_mfma_f32_16x16x32_bf16 v[24:27], v[232:235], v[96:99], v[24:27]
    ds_read_b64_tr_b16 v[224:225], v4 offset:8704
    s_add_u32 s22, s21, 0x8000
    s_add_u32 m0, s20, 0x18000
    s_nop 0
    buffer_load_dwordx4 v2, s[8:11], s22 offen sc1 lds
    s_waitcnt vmcnt(12)
    v_mfma_f32_16x16x32_bf16 v[28:31], v[232:235], v[100:103], v[28:31]
    ds_read_b64_tr_b16 v[226:227], v4 offset:9728
    s_waitcnt lgkmcnt(6)
    v_mfma_f32_16x16x32_bf16 v[32:35], v[236:239], v[96:99], v[32:35]
    ds_read_b64_tr_b16 v[228:229], v5 offset:8736
    v_mfma_f32_16x16x32_bf16 v[36:39], v[236:239], v[100:103], v[36:39]
    ds_read_b64_tr_b16 v[230:231], v5 offset:9760
    s_mov_b32 s23, 0x7000
    buffer_load_dwordx4 v[128:131], v7, s[8:11], s23 offen offset:1024 sc1
    s_waitcnt lgkmcnt(6)
    v_mfma_f32_16x16x32_bf16 v[40:43], v[240:243], v[96:99], v[40:43]
    ds_read_b64_tr_b16 v[232:233], v4 offset:8960
    s_add_u32 s22, s21, 0x8400
    s_add_u32 m0, s20, 0x18400
    s_nop 0
    buffer_load_dwordx4 v2, s[8:11], s22 offen sc1 lds
    v_mfma_f32_16x16x32_bf16 v[44:47], v[240:243], v[100:103], v[44:47]
    ds_read_b64_tr_b16 v[234:235], v4 offset:9984
    s_waitcnt lgkmcnt(6)
    v_mfma_f32_16x16x32_bf16 v[48:51], v[244:247], v[96:99], v[48:51]
    ds_read_b64_tr_b16 v[236:237], v5 offset:8992
    v_mfma_f32_16x16x32_bf16 v[52:55], v[244:247], v[100:103], v[52:55]
    ds_read_b64_tr_b16 v[238:239], v5 offset:10016
    s_waitcnt lgkmcnt(6)
    v_mfma_f32_16x16x32_bf16 v[56:59], v[224:227], v[96:99], v[56:59]
    v_mfma_f32_16x16x32_bf16 v[60:63], v[224:227], v[100:103], v[60:63]
    s_waitcnt vmcnt(13)
    s_barrier
    ds_read_b64_tr_b16 v[240:241], v4 offset:16384
    ds_read_b64_tr_b16 v[242:243], v4 offset:17408
    s_waitcnt lgkmcnt(6)
    v_mfma_f32_16x16x32_bf16 v[64:67], v[228:231], v[96:99], v[64:67]
    ds_read_b64_tr_b16 v[244:245], v5 offset:16416
    v_mfma_f32_16x16x32_bf16 v[68:71], v[228:231], v[100:103], v[68:71]
    s_add_u32 s22, s19, 0x780000
    s_add_u32 m0, s20, 0xc000
    s_nop 0
    buffer_load_dwordx4 v3, s[4:7], s22 offen lds
    ds_read_b64_tr_b16 v[246:247], v5 offset:17440
    s_mov_b32 s23, 0xf000
    buffer_load_dwordx4 v[132:135], v7, s[8:11], s23 offen offset:1024 sc1
    s_waitcnt lgkmcnt(6)
    v_mfma_f32_16x16x32_bf16 v[72:75], v[232:235], v[96:99], v[72:75]
    ds_read_b64_tr_b16 v[224:225], v4 offset:16640
    v_mfma_f32_16x16x32_bf16 v[76:79], v[232:235], v[100:103], v[76:79]
    ds_read_b64_tr_b16 v[226:227], v4 offset:17664
    s_waitcnt lgkmcnt(6)
    v_mfma_f32_16x16x32_bf16 v[80:83], v[236:239], v[96:99], v[80:83]
    ds_read_b64_tr_b16 v[228:229], v5 offset:16672
    v_mfma_f32_16x16x32_bf16 v[84:87], v[236:239], v[100:103], v[84:87]
    ds_read_b64_tr_b16 v[230:231], v5 offset:17696
    s_waitcnt vmcnt(14) lgkmcnt(6)
    v_mfma_f32_16x16x32_bf16 v[24:27], v[240:243], v[104:107], v[24:27]
    ds_read_b64_tr_b16 v[232:233], v4 offset:16896
    s_waitcnt vmcnt(13)
    v_mfma_f32_16x16x32_bf16 v[28:31], v[240:243], v[108:111], v[28:31]
    ds_read_b64_tr_b16 v[234:235], v4 offset:17920
    s_waitcnt lgkmcnt(6)
    v_mfma_f32_16x16x32_bf16 v[32:35], v[244:247], v[104:107], v[32:35]
    ds_read_b64_tr_b16 v[236:237], v5 offset:16928
    v_mfma_f32_16x16x32_bf16 v[36:39], v[244:247], v[108:111], v[36:39]
    s_add_u32 s22, s19, 0x788000
    s_add_u32 m0, s20, 0xc400
    s_nop 0
    buffer_load_dwordx4 v3, s[4:7], s22 offen lds
    ds_read_b64_tr_b16 v[238:239], v5 offset:17952
    s_mov_b32 s23, 0x7800
    buffer_load_dwordx4 v[88:91], v7, s[8:11], s23 offen offset:0 sc1
    s_waitcnt lgkmcnt(6)
    v_mfma_f32_16x16x32_bf16 v[40:43], v[224:227], v[104:107], v[40:43]
    ds_read_b64_tr_b16 v[240:241], v4 offset:17152
    v_mfma_f32_16x16x32_bf16 v[44:47], v[224:227], v[108:111], v[44:47]
    ds_read_b64_tr_b16 v[242:243], v4 offset:18176
    s_waitcnt lgkmcnt(6)
    v_mfma_f32_16x16x32_bf16 v[48:51], v[228:231], v[104:107], v[48:51]
    ds_read_b64_tr_b16 v[244:245], v5 offset:17184
    v_mfma_f32_16x16x32_bf16 v[52:55], v[228:231], v[108:111], v[52:55]
    ds_read_b64_tr_b16 v[246:247], v5 offset:18208
    s_waitcnt lgkmcnt(6)
    v_mfma_f32_16x16x32_bf16 v[56:59], v[232:235], v[104:107], v[56:59]
    ds_read_b64_tr_b16 v[224:225], v4 offset:24576
    v_mfma_f32_16x16x32_bf16 v[60:63], v[232:235], v[108:111], v[60:63]
    ds_read_b64_tr_b16 v[226:227], v4 offset:25600
    s_waitcnt lgkmcnt(6)
    v_mfma_f32_16x16x32_bf16 v[64:67], v[236:239], v[104:107], v[64:67]
    ds_read_b64_tr_b16 v[228:229], v5 offset:24608
    v_mfma_f32_16x16x32_bf16 v[68:71], v[236:239], v[108:111], v[68:71]
    ds_read_b64_tr_b16 v[230:231], v5 offset:25632
    s_mov_b32 s23, 0xf800
    buffer_load_dwordx4 v[92:95], v7, s[8:11], s23 offen offset:0 sc1
    s_waitcnt lgkmcnt(6)
    v_mfma_f32_16x16x32_bf16 v[72:75], v[240:243], v[104:107], v[72:75]
    ds_read_b64_tr_b16 v[232:233], v4 offset:24832
    v_mfma_f32_16x16x32_bf16 v[76:79], v[240:243], v[108:111], v[76:79]
    ds_read_b64_tr_b16 v[234:235], v4 offset:25856
    s_waitcnt lgkmcnt(6)
    v_mfma_f32_16x16x32_bf16 v[80:83], v[244:247], v[104:107], v[80:83]
    ds_read_b64_tr_b16 v[236:237], v5 offset:24864
    v_mfma_f32_16x16x32_bf16 v[84:87], v[244:247], v[108:111], v[84:87]
    ds_read_b64_tr_b16 v[238:239], v5 offset:25888
    s_waitcnt vmcnt(14) lgkmcnt(6)
    v_mfma_f32_16x16x32_bf16 v[24:27], v[224:227], v[112:115], v[24:27]
    ds_read_b64_tr_b16 v[240:241], v4 offset:25088
    s_add_u32 s22, s21, 0xc000
    s_add_u32 m0, s20, 0x1c000
    s_nop 0
    buffer_load_dwordx4 v2, s[8:11], s22 offen sc1 lds
    s_waitcnt vmcnt(12)
    v_mfma_f32_16x16x32_bf16 v[28:31], v[224:227], v[116:119], v[28:31]
    ds_read_b64_tr_b16 v[242:243], v4 offset:26112
    s_waitcnt lgkmcnt(6)
    v_mfma_f32_16x16x32_bf16 v[32:35], v[228:231], v[112:115], v[32:35]
    ds_read_b64_tr_b16 v[244:245], v5 offset:25120
    v_mfma_f32_16x16x32_bf16 v[36:39], v[228:231], v[116:119], v[36:39]
    ds_read_b64_tr_b16 v[246:247], v5 offset:26144
    s_mov_b32 s23, 0x7800
    buffer_load_dwordx4 v[96:99], v7, s[8:11], s23 offen offset:1024 sc1
    s_waitcnt lgkmcnt(6)
    v_mfma_f32_16x16x32_bf16 v[40:43], v[232:235], v[112:115], v[40:43]
    ds_read_b64_tr_b16 v[224:225], v4 offset:25344
    s_add_u32 s22, s21, 0xc400
    s_add_u32 m0, s20, 0x1c400
    s_nop 0
    buffer_load_dwordx4 v2, s[8:11], s22 offen sc1 lds
    v_mfma_f32_16x16x32_bf16 v[44:47], v[232:235], v[116:119], v[44:47]
    ds_read_b64_tr_b16 v[226:227], v4 offset:26368
    s_waitcnt lgkmcnt(6)
    v_mfma_f32_16x16x32_bf16 v[48:51], v[236:239], v[112:115], v[48:51]
    ds_read_b64_tr_b16 v[228:229], v5 offset:25376
    v_mfma_f32_16x16x32_bf16 v[52:55], v[236:239], v[116:119], v[52:55]
    ds_read_b64_tr_b16 v[230:231], v5 offset:26400
    s_waitcnt lgkmcnt(6)
    v_mfma_f32_16x16x32_bf16 v[56:59], v[240:243], v[112:115], v[56:59]
    v_mfma_f32_16x16x32_bf16 v[60:63], v[240:243], v[116:119], v[60:63]
    s_waitcnt vmcnt(13)
    s_barrier
    ds_read_b64_tr_b16 v[232:233], v4 offset:32768
    ds_read_b64_tr_b16 v[234:235], v4 offset:33792
    s_waitcnt lgkmcnt(6)
    v_mfma_f32_16x16x32_bf16 v[64:67], v[244:247], v[112:115], v[64:67]
    ds_read_b64_tr_b16 v[236:237], v5 offset:32800
    v_mfma_f32_16x16x32_bf16 v[68:71], v[244:247], v[116:119], v[68:71]
    ds_read_b64_tr_b16 v[238:239], v5 offset:33824
    s_mov_b32 s23, 0xf800
    buffer_load_dwordx4 v[100:103], v7, s[8:11], s23 offen offset:1024 sc1
    s_waitcnt lgkmcnt(6)
    v_mfma_f32_16x16x32_bf16 v[72:75], v[224:227], v[112:115], v[72:75]
    ds_read_b64_tr_b16 v[240:241], v4 offset:33024
    v_mfma_f32_16x16x32_bf16 v[76:79], v[224:227], v[116:119], v[76:79]
    ds_read_b64_tr_b16 v[242:243], v4 offset:34048
    s_waitcnt lgkmcnt(6)
    v_mfma_f32_16x16x32_bf16 v[80:83], v[228:231], v[112:115], v[80:83]
    ds_read_b64_tr_b16 v[244:245], v5 offset:33056
    v_mfma_f32_16x16x32_bf16 v[84:87], v[228:231], v[116:119], v[84:87]
    ds_read_b64_tr_b16 v[246:247], v5 offset:34080
    s_waitcnt vmcnt(13) lgkmcnt(6)
    v_mfma_f32_16x16x32_bf16 v[24:27], v[232:235], v[120:123], v[24:27]
    ds_read_b64_tr_b16 v[224:225], v4 offset:33280
    s_waitcnt vmcnt(12)
    v_mfma_f32_16x16x32_bf16 v[28:31], v[232:235], v[124:127], v[28:31]
    ds_read_b64_tr_b16 v[226:227], v4 offset:34304
    s_waitcnt lgkmcnt(6)
    v_mfma_f32_16x16x32_bf16 v[32:35], v[236:239], v[120:123], v[32:35]
    ds_read_b64_tr_b16 v[228:229], v5 offset:33312
    v_mfma_f32_16x16x32_bf16 v[36:39], v[236:239], v[124:127], v[36:39]
    ds_read_b64_tr_b16 v[230:231], v5 offset:34336
    s_waitcnt lgkmcnt(6)
    v_mfma_f32_16x16x32_bf16 v[40:43], v[240:243], v[120:123], v[40:43]
    ds_read_b64_tr_b16 v[232:233], v4 offset:33536
    v_mfma_f32_16x16x32_bf16 v[44:47], v[240:243], v[124:127], v[44:47]
    ds_read_b64_tr_b16 v[234:235], v4 offset:34560
    s_waitcnt lgkmcnt(6)
    v_mfma_f32_16x16x32_bf16 v[48:51], v[244:247], v[120:123], v[48:51]
    ds_read_b64_tr_b16 v[236:237], v5 offset:33568
    v_mfma_f32_16x16x32_bf16 v[52:55], v[244:247], v[124:127], v[52:55]
    ds_read_b64_tr_b16 v[238:239], v5 offset:34592
    s_waitcnt lgkmcnt(6)
    v_mfma_f32_16x16x32_bf16 v[56:59], v[224:227], v[120:123], v[56:59]
    ds_read_b64_tr_b16 v[240:241], v4 offset:40960
    v_mfma_f32_16x16x32_bf16 v[60:63], v[224:227], v[124:127], v[60:63]
    ds_read_b64_tr_b16 v[242:243], v4 offset:41984
    s_waitcnt lgkmcnt(6)
    v_mfma_f32_16x16x32_bf16 v[64:67], v[228:231], v[120:123], v[64:67]
    ds_read_b64_tr_b16 v[244:245], v5 offset:40992
    v_mfma_f32_16x16x32_bf16 v[68:71], v[228:231], v[124:127], v[68:71]
    ds_read_b64_tr_b16 v[246:247], v5 offset:42016
    s_waitcnt lgkmcnt(6)
    v_mfma_f32_16x16x32_bf16 v[72:75], v[232:235], v[120:123], v[72:75]
    ds_read_b64_tr_b16 v[224:225], v4 offset:41216
    v_mfma_f32_16x16x32_bf16 v[76:79], v[232:235], v[124:127], v[76:79]
    ds_read_b64_tr_b16 v[226:227], v4 offset:42240
    s_waitcnt lgkmcnt(6)
    v_mfma_f32_16x16x32_bf16 v[80:83], v[236:239], v[120:123], v[80:83]
    ds_read_b64_tr_b16 v[228:229], v5 offset:41248
    v_mfma_f32_16x16x32_bf16 v[84:87], v[236:239], v[124:127], v[84:87]
    ds_read_b64_tr_b16 v[230:231], v5 offset:42272
    s_waitcnt vmcnt(10) lgkmcnt(6)
    v_mfma_f32_16x16x32_bf16 v[24:27], v[240:243], v[128:131], v[24:27]
    ds_read_b64_tr_b16 v[232:233], v4 offset:41472
    s_waitcnt vmcnt(7)
    v_mfma_f32_16x16x32_bf16 v[28:31], v[240:243], v[132:135], v[28:31]
    ds_read_b64_tr_b16 v[234:235], v4 offset:42496
    s_waitcnt lgkmcnt(6)
    v_mfma_f32_16x16x32_bf16 v[32:35], v[244:247], v[128:131], v[32:35]
    ds_read_b64_tr_b16 v[236:237], v5 offset:41504
    v_mfma_f32_16x16x32_bf16 v[36:39], v[244:247], v[132:135], v[36:39]
    ds_read_b64_tr_b16 v[238:239], v5 offset:42528
    s_waitcnt lgkmcnt(6)
    v_mfma_f32_16x16x32_bf16 v[40:43], v[224:227], v[128:131], v[40:43]
    ds_read_b64_tr_b16 v[240:241], v4 offset:41728
    v_mfma_f32_16x16x32_bf16 v[44:47], v[224:227], v[132:135], v[44:47]
    ds_read_b64_tr_b16 v[242:243], v4 offset:42752
    s_waitcnt lgkmcnt(6)
    v_mfma_f32_16x16x32_bf16 v[48:51], v[228:231], v[128:131], v[48:51]
    ds_read_b64_tr_b16 v[244:245], v5 offset:41760
    v_mfma_f32_16x16x32_bf16 v[52:55], v[228:231], v[132:135], v[52:55]
    ds_read_b64_tr_b16 v[246:247], v5 offset:42784
    s_waitcnt lgkmcnt(6)
    v_mfma_f32_16x16x32_bf16 v[56:59], v[232:235], v[128:131], v[56:59]
    v_mfma_f32_16x16x32_bf16 v[60:63], v[232:235], v[132:135], v[60:63]
    s_waitcnt vmcnt(6)
    s_barrier
    ds_read_b64_tr_b16 v[224:225], v4 offset:49152
    ds_read_b64_tr_b16 v[226:227], v4 offset:50176
    s_waitcnt lgkmcnt(6)
    v_mfma_f32_16x16x32_bf16 v[64:67], v[236:239], v[128:131], v[64:67]
    ds_read_b64_tr_b16 v[228:229], v5 offset:49184
    v_mfma_f32_16x16x32_bf16 v[68:71], v[236:239], v[132:135], v[68:71]
    ds_read_b64_tr_b16 v[230:231], v5 offset:50208
    s_waitcnt lgkmcnt(6)
    v_mfma_f32_16x16x32_bf16 v[72:75], v[240:243], v[128:131], v[72:75]
    ds_read_b64_tr_b16 v[232:233], v4 offset:49408
    v_mfma_f32_16x16x32_bf16 v[76:79], v[240:243], v[132:135], v[76:79]
    ds_read_b64_tr_b16 v[234:235], v4 offset:50432
    s_waitcnt lgkmcnt(6)
    v_mfma_f32_16x16x32_bf16 v[80:83], v[244:247], v[128:131], v[80:83]
    ds_read_b64_tr_b16 v[236:237], v5 offset:49440
    v_mfma_f32_16x16x32_bf16 v[84:87], v[244:247], v[132:135], v[84:87]
    ds_read_b64_tr_b16 v[238:239], v5 offset:50464
    s_waitcnt vmcnt(5) lgkmcnt(6)
    v_mfma_f32_16x16x32_bf16 v[24:27], v[224:227], v[88:91], v[24:27]
    ds_read_b64_tr_b16 v[240:241], v4 offset:49664
    s_waitcnt vmcnt(4)
    v_mfma_f32_16x16x32_bf16 v[28:31], v[224:227], v[92:95], v[28:31]
    ds_read_b64_tr_b16 v[242:243], v4 offset:50688
    s_waitcnt lgkmcnt(6)
    v_mfma_f32_16x16x32_bf16 v[32:35], v[228:231], v[88:91], v[32:35]
    ds_read_b64_tr_b16 v[244:245], v5 offset:49696
    v_mfma_f32_16x16x32_bf16 v[36:39], v[228:231], v[92:95], v[36:39]
    ds_read_b64_tr_b16 v[246:247], v5 offset:50720
    s_waitcnt lgkmcnt(6)
    v_mfma_f32_16x16x32_bf16 v[40:43], v[232:235], v[88:91], v[40:43]
    ds_read_b64_tr_b16 v[224:225], v4 offset:49920
    v_mfma_f32_16x16x32_bf16 v[44:47], v[232:235], v[92:95], v[44:47]
    ds_read_b64_tr_b16 v[226:227], v4 offset:50944
    s_waitcnt lgkmcnt(6)
    v_mfma_f32_16x16x32_bf16 v[48:51], v[236:239], v[88:91], v[48:51]
    ds_read_b64_tr_b16 v[228:229], v5 offset:49952
    v_mfma_f32_16x16x32_bf16 v[52:55], v[236:239], v[92:95], v[52:55]
    ds_read_b64_tr_b16 v[230:231], v5 offset:50976
    s_waitcnt lgkmcnt(6)
    v_mfma_f32_16x16x32_bf16 v[56:59], v[240:243], v[88:91], v[56:59]
    ds_read_b64_tr_b16 v[232:233], v4 offset:57344
    v_mfma_f32_16x16x32_bf16 v[60:63], v[240:243], v[92:95], v[60:63]
    ds_read_b64_tr_b16 v[234:235], v4 offset:58368
    s_waitcnt lgkmcnt(6)
    v_mfma_f32_16x16x32_bf16 v[64:67], v[244:247], v[88:91], v[64:67]
    ds_read_b64_tr_b16 v[236:237], v5 offset:57376
    v_mfma_f32_16x16x32_bf16 v[68:71], v[244:247], v[92:95], v[68:71]
    ds_read_b64_tr_b16 v[238:239], v5 offset:58400
    s_waitcnt lgkmcnt(6)
    v_mfma_f32_16x16x32_bf16 v[72:75], v[224:227], v[88:91], v[72:75]
    ds_read_b64_tr_b16 v[240:241], v4 offset:57600
    v_mfma_f32_16x16x32_bf16 v[76:79], v[224:227], v[92:95], v[76:79]
    ds_read_b64_tr_b16 v[242:243], v4 offset:58624
    s_waitcnt lgkmcnt(6)
    v_mfma_f32_16x16x32_bf16 v[80:83], v[228:231], v[88:91], v[80:83]
    ds_read_b64_tr_b16 v[244:245], v5 offset:57632
    v_mfma_f32_16x16x32_bf16 v[84:87], v[228:231], v[92:95], v[84:87]
    ds_read_b64_tr_b16 v[246:247], v5 offset:58656
    s_waitcnt vmcnt(2) lgkmcnt(6)
    v_mfma_f32_16x16x32_bf16 v[24:27], v[232:235], v[96:99], v[24:27]
    ds_read_b64_tr_b16 v[224:225], v4 offset:57856
    s_waitcnt vmcnt(0)
    v_mfma_f32_16x16x32_bf16 v[28:31], v[232:235], v[100:103], v[28:31]
    ds_read_b64_tr_b16 v[226:227], v4 offset:58880
    s_waitcnt lgkmcnt(6)
    v_mfma_f32_16x16x32_bf16 v[32:35], v[236:239], v[96:99], v[32:35]
    ds_read_b64_tr_b16 v[228:229], v5 offset:57888
    v_mfma_f32_16x16x32_bf16 v[36:39], v[236:239], v[100:103], v[36:39]
    ds_read_b64_tr_b16 v[230:231], v5 offset:58912
    s_waitcnt lgkmcnt(6)
    v_mfma_f32_16x16x32_bf16 v[40:43], v[240:243], v[96:99], v[40:43]
    ds_read_b64_tr_b16 v[232:233], v4 offset:58112
    v_mfma_f32_16x16x32_bf16 v[44:47], v[240:243], v[100:103], v[44:47]
    ds_read_b64_tr_b16 v[234:235], v4 offset:59136
    s_waitcnt lgkmcnt(6)
    v_mfma_f32_16x16x32_bf16 v[48:51], v[244:247], v[96:99], v[48:51]
    ds_read_b64_tr_b16 v[236:237], v5 offset:58144
    v_mfma_f32_16x16x32_bf16 v[52:55], v[244:247], v[100:103], v[52:55]
    ds_read_b64_tr_b16 v[238:239], v5 offset:59168
    s_waitcnt lgkmcnt(6)
    v_mfma_f32_16x16x32_bf16 v[56:59], v[224:227], v[96:99], v[56:59]
    v_mfma_f32_16x16x32_bf16 v[60:63], v[224:227], v[100:103], v[60:63]
    s_waitcnt lgkmcnt(4)
    v_mfma_f32_16x16x32_bf16 v[64:67], v[228:231], v[96:99], v[64:67]
    v_mfma_f32_16x16x32_bf16 v[68:71], v[228:231], v[100:103], v[68:71]
    s_waitcnt lgkmcnt(2)
    v_mfma_f32_16x16x32_bf16 v[72:75], v[232:235], v[96:99], v[72:75]
    v_mfma_f32_16x16x32_bf16 v[76:79], v[232:235], v[100:103], v[76:79]
    s_waitcnt lgkmcnt(0)
    v_mfma_f32_16x16x32_bf16 v[80:83], v[236:239], v[96:99], v[80:83]
    v_mfma_f32_16x16x32_bf16 v[84:87], v[236:239], v[100:103], v[84:87]
    s_mov_b32 s23, 0x3e0293ee
    v_mul_f32 v16, s23, v24
    v_mul_f32 v17, s23, v25
    v_cvt_pk_bf16_f32 v152, v16, v17
    v_mul_f32 v18, s23, v26
    v_mul_f32 v19, s23, v27
    v_cvt_pk_bf16_f32 v153, v18, v19
    v_mul_f32 v16, s23, v28
    v_mul_f32 v17, s23, v29
    v_cvt_pk_bf16_f32 v168, v16, v17
    v_mul_f32 v18, s23, v30
    v_mul_f32 v19, s23, v31
    v_cvt_pk_bf16_f32 v169, v18, v19
    v_mul_f32 v16, s23, v32
    v_mul_f32 v17, s23, v33
    v_cvt_pk_bf16_f32 v154, v16, v17
    v_mul_f32 v18, s23, v34
    v_mul_f32 v19, s23, v35
    v_cvt_pk_bf16_f32 v155, v18, v19
    v_mul_f32 v16, s23, v36
    v_mul_f32 v17, s23, v37
    v_cvt_pk_bf16_f32 v170, v16, v17
    v_mul_f32 v18, s23, v38
    v_mul_f32 v19, s23, v39
    v_cvt_pk_bf16_f32 v171, v18, v19
    v_mul_f32 v16, s23, v40
    v_mul_f32 v17, s23, v41
    v_cvt_pk_bf16_f32 v156, v16, v17
    v_mul_f32 v18, s23, v42
    v_mul_f32 v19, s23, v43
    v_cvt_pk_bf16_f32 v157, v18, v19
    v_mul_f32 v16, s23, v44
    v_mul_f32 v17, s23, v45
    v_cvt_pk_bf16_f32 v172, v16, v17
    v_mul_f32 v18, s23, v46
    v_mul_f32 v19, s23, v47
    v_cvt_pk_bf16_f32 v173, v18, v19
    v_mul_f32 v16, s23, v48
    v_mul_f32 v17, s23, v49
    v_cvt_pk_bf16_f32 v158, v16, v17
    v_mul_f32 v18, s23, v50
    v_mul_f32 v19, s23, v51
    v_cvt_pk_bf16_f32 v159, v18, v19
    v_mul_f32 v16, s23, v52
    v_mul_f32 v17, s23, v53
    v_cvt_pk_bf16_f32 v174, v16, v17
    v_mul_f32 v18, s23, v54
    v_mul_f32 v19, s23, v55
    v_cvt_pk_bf16_f32 v175, v18, v19
    v_mul_f32 v16, s23, v56
    v_mul_f32 v17, s23, v57
    v_cvt_pk_bf16_f32 v160, v16, v17
    v_mul_f32 v18, s23, v58
    v_mul_f32 v19, s23, v59
    v_cvt_pk_bf16_f32 v161, v18, v19
    v_mul_f32 v16, s23, v60
    v_mul_f32 v17, s23, v61
    v_cvt_pk_bf16_f32 v176, v16, v17
    v_mul_f32 v18, s23, v62
    v_mul_f32 v19, s23, v63
    v_cvt_pk_bf16_f32 v177, v18, v19
    v_mul_f32 v16, s23, v64
    v_mul_f32 v17, s23, v65
    v_cvt_pk_bf16_f32 v162, v16, v17
    v_mul_f32 v18, s23, v66
    v_mul_f32 v19, s23, v67
    v_cvt_pk_bf16_f32 v163, v18, v19
    v_mul_f32 v16, s23, v68
    v_mul_f32 v17, s23, v69
    v_cvt_pk_bf16_f32 v178, v16, v17
    v_mul_f32 v18, s23, v70
    v_mul_f32 v19, s23, v71
    v_cvt_pk_bf16_f32 v179, v18, v19
    v_mul_f32 v16, s23, v72
    v_mul_f32 v17, s23, v73
    v_cvt_pk_bf16_f32 v164, v16, v17
    v_mul_f32 v18, s23, v74
    v_mul_f32 v19, s23, v75
    v_cvt_pk_bf16_f32 v165, v18, v19
    v_mul_f32 v16, s23, v76
    v_mul_f32 v17, s23, v77
    v_cvt_pk_bf16_f32 v180, v16, v17
    v_mul_f32 v18, s23, v78
    v_mul_f32 v19, s23, v79
    v_cvt_pk_bf16_f32 v181, v18, v19
    v_mul_f32 v16, s23, v80
    v_mul_f32 v17, s23, v81
    v_cvt_pk_bf16_f32 v166, v16, v17
    v_mul_f32 v18, s23, v82
    v_mul_f32 v19, s23, v83
    v_cvt_pk_bf16_f32 v167, v18, v19
    v_mul_f32 v16, s23, v84
    v_mul_f32 v17, s23, v85
    v_cvt_pk_bf16_f32 v182, v16, v17
    v_mul_f32 v18, s23, v86
    v_mul_f32 v19, s23, v87
    v_cvt_pk_bf16_f32 v183, v18, v19
    v_add_u32 v4, 0x10000, v2
    v_add_u32 v5, 0x20000, v2
    s_barrier
    ds_read_b128 v[224:227], v4 offset:0
    ds_read_b128 v[228:231], v4 offset:1024
    ds_read_b128 v[232:235], v4 offset:2048
    ds_read_b128 v[236:239], v4 offset:3072
    s_waitcnt lgkmcnt(3)
    v_mfma_f32_16x16x32_bf16 v[184:187], v[224:227], v[152:155], 0
    v_mfma_f32_16x16x32_bf16 v[188:191], v[224:227], v[168:171], 0
    ds_read_b128 v[240:243], v4 offset:4096
    s_and_b32 s29, s2, 7
    s_mul_i32 s29, s29, 28
    s_lshr_b32 s16, s2, 3
    s_add_u32 s29, s29, s16
    s_waitcnt lgkmcnt(3)
    v_mfma_f32_16x16x32_bf16 v[192:195], v[228:231], v[152:155], 0
    s_add_u32 s22, s21, 0x10000
    s_add_u32 m0, s20, 0x20000
    s_nop 0
    buffer_load_dwordx4 v2, s[8:11], s22 offen sc1 lds
    s_mov_b64 s[76:77], s[54:55]
    s_mov_b32 s78, 0xc00000
    s_mov_b32 s79, 0x20000
    v_bfe_u32 v20, v1, 2, 2
    v_lshlrev_b32 v20, 12, v20
    v_add_u32 v6, v3, v20
    s_lshr_b32 s16, s2, 5
    s_lshl_b32 s16, s16, 7
    s_lshl_b32 s17, s3, 3
    s_add_u32 s16, s16, s17
    s_mul_i32 s14, s16, 12288
    s_and_b32 s16, s2, 31
    s_lshl_b32 s16, s16, 8
    s_add_u32 s14, s14, s16
    s_add_u32 s14, s14, 4096
    v_mfma_f32_16x16x32_bf16 v[196:199], v[228:231], v[168:171], 0
    ds_read_b128 v[244:247], v4 offset:5120
    s_waitcnt lgkmcnt(3)
    v_mfma_f32_16x16x32_bf16 v[184:187], v[232:235], v[156:159], v[184:187]
    v_mfma_f32_16x16x32_bf16 v[188:191], v[232:235], v[172:175], v[188:191]
    ds_read_b128 v[224:227], v4 offset:6144
    s_waitcnt lgkmcnt(3)
    v_mfma_f32_16x16x32_bf16 v[192:195], v[236:239], v[156:159], v[192:195]
    v_mfma_f32_16x16x32_bf16 v[196:199], v[236:239], v[172:175], v[196:199]
    ds_read_b128 v[228:231], v4 offset:7168
    s_waitcnt lgkmcnt(3)
    v_mfma_f32_16x16x32_bf16 v[184:187], v[240:243], v[160:163], v[184:187]
    v_mfma_f32_16x16x32_bf16 v[188:191], v[240:243], v[176:179], v[188:191]
    ds_read_b128 v[232:235], v4 offset:8192
    s_waitcnt lgkmcnt(3)
    v_mfma_f32_16x16x32_bf16 v[192:195], v[244:247], v[160:163], v[192:195]
    s_add_u32 s22, s21, 0x10400
    s_add_u32 m0, s20, 0x20400
    s_nop 0
    buffer_load_dwordx4 v2, s[8:11], s22 offen sc1 lds
    v_mfma_f32_16x16x32_bf16 v[196:199], v[244:247], v[176:179], v[196:199]
    ds_read_b128 v[236:239], v4 offset:9216
    s_waitcnt lgkmcnt(3)
    v_mfma_f32_16x16x32_bf16 v[184:187], v[224:227], v[164:167], v[184:187]
    v_mfma_f32_16x16x32_bf16 v[188:191], v[224:227], v[180:183], v[188:191]
    ds_read_b128 v[240:243], v4 offset:10240
    s_waitcnt lgkmcnt(3)
    v_mfma_f32_16x16x32_bf16 v[192:195], v[228:231], v[164:167], v[192:195]
    v_mfma_f32_16x16x32_bf16 v[196:199], v[228:231], v[180:183], v[196:199]
    ds_read_b128 v[244:247], v4 offset:11264
    s_waitcnt lgkmcnt(3)
    v_mfma_f32_16x16x32_bf16 v[200:203], v[232:235], v[152:155], 0
    v_mfma_f32_16x16x32_bf16 v[204:207], v[232:235], v[168:171], 0
    ds_read_b128 v[224:227], v4 offset:12288
    s_waitcnt lgkmcnt(3)
    v_mfma_f32_16x16x32_bf16 v[208:211], v[236:239], v[152:155], 0
    v_mfma_f32_16x16x32_bf16 v[212:215], v[236:239], v[168:171], 0
    ds_read_b128 v[228:231], v4 offset:13312
    s_waitcnt lgkmcnt(3)
    v_mfma_f32_16x16x32_bf16 v[200:203], v[240:243], v[156:159], v[200:203]
    v_mfma_f32_16x16x32_bf16 v[204:207], v[240:243], v[172:175], v[204:207]
    ds_read_b128 v[232:235], v4 offset:14336
    s_waitcnt lgkmcnt(3)
    v_mfma_f32_16x16x32_bf16 v[208:211], v[244:247], v[156:159], v[208:211]
    v_max3_f32 v16, v184, v185, v186
    v_mfma_f32_16x16x32_bf16 v[212:215], v[244:247], v[172:175], v[212:215]
    ds_read_b128 v[236:239], v4 offset:15360
    v_max3_f32 v16, v16, v187, v192
    s_waitcnt lgkmcnt(3)
    v_mfma_f32_16x16x32_bf16 v[200:203], v[224:227], v[160:163], v[200:203]
    v_max3_f32 v16, v16, v193, v194
    v_mfma_f32_16x16x32_bf16 v[204:207], v[224:227], v[176:179], v[204:207]
    s_barrier
    ds_read_b128 v[240:243], v4 offset:16384
    v_max_f32 v16, v16, v195
    s_waitcnt lgkmcnt(3)
    v_mfma_f32_16x16x32_bf16 v[208:211], v[228:231], v[160:163], v[208:211]
    v_max3_f32 v17, v188, v189, v190
    v_mfma_f32_16x16x32_bf16 v[212:215], v[228:231], v[176:179], v[212:215]
    s_add_u32 s22, s21, 0x14000
    s_add_u32 m0, s20, 0x24000
    s_nop 0
    buffer_load_dwordx4 v2, s[8:11], s22 offen sc1 lds
    ds_read_b128 v[244:247], v4 offset:17408
    v_max3_f32 v17, v17, v191, v196
    s_waitcnt lgkmcnt(3)
    v_mfma_f32_16x16x32_bf16 v[200:203], v[232:235], v[164:167], v[200:203]
    v_max3_f32 v17, v17, v197, v198
    v_mfma_f32_16x16x32_bf16 v[204:207], v[232:235], v[180:183], v[204:207]
    ds_read_b128 v[224:227], v4 offset:18432
    v_max_f32 v17, v17, v199
    s_waitcnt lgkmcnt(3)
    v_mfma_f32_16x16x32_bf16 v[208:211], v[236:239], v[164:167], v[208:211]
    v_mfma_f32_16x16x32_bf16 v[212:215], v[236:239], v[180:183], v[212:215]
    ds_read_b128 v[228:231], v4 offset:19456
    v_max3_f32 v16, v16, v200, v201
    v_max3_f32 v16, v16, v202, v203
    s_nop 3
    v_max3_f32 v16, v16, v208, v209
    v_max3_f32 v16, v16, v210, v211
    v_max3_f32 v17, v17, v204, v205
    v_max3_f32 v17, v17, v206, v207
    v_max3_f32 v17, v17, v212, v213
    v_max3_f32 v17, v17, v214, v215
    v_mov_b32 v18, v16
    v_mov_b32 v19, v17
    s_nop 0
    v_permlane16_swap_b32 v16, v18
    v_permlane16_swap_b32 v17, v19
    v_max_f32 v16, v16, v18
    v_max_f32 v17, v17, v19
    v_mov_b32 v18, v16
    v_mov_b32 v19, v17
    s_nop 0
    v_permlane32_swap_b32 v16, v18
    v_permlane32_swap_b32 v17, v19
    v_max_f32 v16, v16, v18
    v_max_f32 v17, v17, v19
    v_sub_f32 v216, 0, v16
    v_sub_f32 v217, 0, v16
    v_sub_f32 v218, 0, v16
    v_sub_f32 v219, 0, v16
    v_sub_f32 v220, 0, v17
    v_sub_f32 v221, 0, v17
    v_sub_f32 v222, 0, v17
    v_sub_f32 v223, 0, v17
    v_add_f32 v184, v184, v216
    v_add_f32 v185, v185, v216
    v_exp_f32 v184, v184
    v_exp_f32 v185, v185
    s_nop 0
    v_add_f32 v9, v184, v185
    v_cvt_pk_bf16_f32 v24, v184, v185
    v_add_f32 v186, v186, v216
    v_add_f32 v187, v187, v216
    v_exp_f32 v186, v186
    v_exp_f32 v187, v187
    v_add_f32 v9, v9, v186
    v_add_f32 v9, v9, v187
    v_cvt_pk_bf16_f32 v25, v186, v187
    v_add_f32 v188, v188, v220
    v_add_f32 v189, v189, v220
    v_exp_f32 v188, v188
    v_exp_f32 v189, v189
    s_nop 0
    v_add_f32 v10, v188, v189
    v_cvt_pk_bf16_f32 v28, v188, v189
    v_add_f32 v190, v190, v220
    v_add_f32 v191, v191, v220
    v_exp_f32 v190, v190
    v_exp_f32 v191, v191
    v_add_f32 v10, v10, v190
    v_add_f32 v10, v10, v191
    v_cvt_pk_bf16_f32 v29, v190, v191
    v_add_f32 v192, v192, v216
    v_add_f32 v193, v193, v216
    v_exp_f32 v192, v192
    v_exp_f32 v193, v193
    v_add_f32 v9, v9, v192
    v_add_f32 v9, v9, v193
    v_cvt_pk_bf16_f32 v26, v192, v193
    v_add_f32 v194, v194, v216
    v_add_f32 v195, v195, v216
    v_exp_f32 v194, v194
    v_exp_f32 v195, v195
    v_add_f32 v9, v9, v194
    v_add_f32 v9, v9, v195
    v_cvt_pk_bf16_f32 v27, v194, v195
    v_add_f32 v196, v196, v220
    v_add_f32 v197, v197, v220
    v_exp_f32 v196, v196
    v_exp_f32 v197, v197
    v_add_f32 v10, v10, v196
    v_add_f32 v10, v10, v197
    v_cvt_pk_bf16_f32 v30, v196, v197
    v_add_f32 v198, v198, v220
    v_add_f32 v199, v199, v220
    v_exp_f32 v198, v198
    v_exp_f32 v199, v199
    v_add_f32 v10, v10, v198
    v_add_f32 v10, v10, v199
    v_cvt_pk_bf16_f32 v31, v198, v199
    s_waitcnt lgkmcnt(3)
    v_mfma_f32_16x16x32_bf16 v[184:187], v[240:243], v[152:155], v[216:219]
    v_mfma_f32_16x16x32_bf16 v[188:191], v[240:243], v[168:171], v[220:223]
    ds_read_b128 v[232:235], v4 offset:20480
    v_add_f32 v200, v200, v216
    v_add_f32 v201, v201, v216
    v_exp_f32 v200, v200
    v_exp_f32 v201, v201
    s_waitcnt lgkmcnt(3)
    v_mfma_f32_16x16x32_bf16 v[192:195], v[244:247], v[152:155], v[216:219]
    v_add_f32 v9, v9, v200
    v_add_f32 v9, v9, v201
    v_cvt_pk_bf16_f32 v32, v200, v201
    v_add_f32 v202, v202, v216
    v_mfma_f32_16x16x32_bf16 v[196:199], v[244:247], v[168:171], v[220:223]
    s_add_u32 s22, s21, 0x14400
    s_add_u32 m0, s20, 0x24400
    s_nop 0
    buffer_load_dwordx4 v2, s[8:11], s22 offen sc1 lds
    ds_read_b128 v[236:239], v4 offset:21504
    v_add_f32 v203, v203, v216
    v_exp_f32 v202, v202
    v_exp_f32 v203, v203
    v_add_f32 v9, v9, v202
    s_waitcnt lgkmcnt(3)
    v_mfma_f32_16x16x32_bf16 v[184:187], v[224:227], v[156:159], v[184:187]
    v_add_f32 v9, v9, v203
    v_cvt_pk_bf16_f32 v33, v202, v203
    v_add_f32 v204, v204, v220
    v_mfma_f32_16x16x32_bf16 v[188:191], v[224:227], v[172:175], v[188:191]
    ds_read_b128 v[240:243], v4 offset:22528
    v_add_f32 v205, v205, v220
    v_exp_f32 v204, v204
    v_exp_f32 v205, v205
    v_add_f32 v10, v10, v204
    s_mov_b64 s[4:5], s[40:41]
    s_mov_b32 s6, 0x800000
    s_mov_b32 s7, 0x20000
    v_bfe_u32 v20, v1, 2, 2
    v_lshlrev_b32 v21, 13, v20
    v_sub_u32 v3, v3, v21
    v_lshl_add_u32 v3, v20, 11, v3
    s_and_b32 s16, s2, 1
    s_lshl_b32 s24, s16, 22
    s_lshr_b32 s16, s2, 5
    s_lshl_b32 s16, s16, 8
    s_add_u32 s24, s24, s16
    s_lshl_b32 s16, s3, 14
    s_add_u32 s24, s24, s16
    s_waitcnt lgkmcnt(3)
    v_mfma_f32_16x16x32_bf16 v[192:195], v[228:231], v[156:159], v[192:195]
    v_add_f32 v10, v10, v205
    v_cvt_pk_bf16_f32 v36, v204, v205
    v_add_f32 v206, v206, v220
    v_add_f32 v207, v207, v220
    v_mfma_f32_16x16x32_bf16 v[196:199], v[228:231], v[172:175], v[196:199]
    ds_read_b128 v[244:247], v4 offset:23552
    v_exp_f32 v206, v206
    v_exp_f32 v207, v207
    v_add_f32 v10, v10, v206
    v_add_f32 v10, v10, v207
    s_waitcnt lgkmcnt(3)
    v_mfma_f32_16x16x32_bf16 v[184:187], v[232:235], v[160:163], v[184:187]
    v_cvt_pk_bf16_f32 v37, v206, v207
    v_add_f32 v208, v208, v216
    v_add_f32 v209, v209, v216
    v_mfma_f32_16x16x32_bf16 v[188:191], v[232:235], v[176:179], v[188:191]
    ds_read_b128 v[224:227], v4 offset:24576
    v_exp_f32 v208, v208
    v_exp_f32 v209, v209
    v_add_f32 v9, v9, v208
    v_add_f32 v9, v9, v209
    s_waitcnt lgkmcnt(3)
    v_mfma_f32_16x16x32_bf16 v[192:195], v[236:239], v[160:163], v[192:195]
    v_cvt_pk_bf16_f32 v34, v208, v209
    v_add_f32 v210, v210, v216
    v_add_f32 v211, v211, v216
    v_exp_f32 v210, v210
    v_mfma_f32_16x16x32_bf16 v[196:199], v[236:239], v[176:179], v[196:199]
    ds_read_b128 v[228:231], v4 offset:25600
    v_exp_f32 v211, v211
    v_add_f32 v9, v9, v210
    v_add_f32 v9, v9, v211
    v_cvt_pk_bf16_f32 v35, v210, v211
    s_waitcnt lgkmcnt(3)
    v_mfma_f32_16x16x32_bf16 v[184:187], v[240:243], v[164:167], v[184:187]
    v_add_f32 v212, v212, v220
    v_add_f32 v213, v213, v220
    v_exp_f32 v212, v212
    v_mfma_f32_16x16x32_bf16 v[188:191], v[240:243], v[180:183], v[188:191]
    ds_read_b128 v[232:235], v4 offset:26624
    v_exp_f32 v213, v213
    v_add_f32 v10, v10, v212
    v_add_f32 v10, v10, v213
    v_cvt_pk_bf16_f32 v38, v212, v213
    s_waitcnt lgkmcnt(3)
    v_mfma_f32_16x16x32_bf16 v[192:195], v[244:247], v[164:167], v[192:195]
    v_add_f32 v214, v214, v220
    v_add_f32 v215, v215, v220
    v_exp_f32 v214, v214
    v_exp_f32 v215, v215
    v_mfma_f32_16x16x32_bf16 v[196:199], v[244:247], v[180:183], v[196:199]
    ds_read_b128 v[236:239], v4 offset:27648
    v_add_f32 v10, v10, v214
    v_add_f32 v10, v10, v215
    v_cvt_pk_bf16_f32 v39, v214, v215
    s_waitcnt lgkmcnt(3)
    v_mfma_f32_16x16x32_bf16 v[200:203], v[224:227], v[152:155], v[216:219]
    v_mfma_f32_16x16x32_bf16 v[204:207], v[224:227], v[168:171], v[220:223]
    ds_read_b128 v[240:243], v4 offset:28672
    v_exp_f32 v184, v184
    v_exp_f32 v185, v185
    v_add_f32 v9, v9, v184
    s_waitcnt lgkmcnt(3)
    v_mfma_f32_16x16x32_bf16 v[208:211], v[228:231], v[152:155], v[216:219]
    v_add_f32 v9, v9, v185
    v_cvt_pk_bf16_f32 v40, v184, v185
    v_exp_f32 v186, v186
    v_mfma_f32_16x16x32_bf16 v[212:215], v[228:231], v[168:171], v[220:223]
    ds_read_b128 v[244:247], v4 offset:29696
    v_exp_f32 v187, v187
    v_add_f32 v9, v9, v186
    s_waitcnt lgkmcnt(3)
    v_mfma_f32_16x16x32_bf16 v[200:203], v[232:235], v[156:159], v[200:203]
    v_add_f32 v9, v9, v187
    v_cvt_pk_bf16_f32 v41, v186, v187
    v_exp_f32 v188, v188
    v_mfma_f32_16x16x32_bf16 v[204:207], v[232:235], v[172:175], v[204:207]
    ds_read_b128 v[224:227], v4 offset:30720
    v_exp_f32 v189, v189
    v_add_f32 v10, v10, v188
    v_add_f32 v10, v10, v189
    s_waitcnt lgkmcnt(3)
    v_mfma_f32_16x16x32_bf16 v[208:211], v[236:239], v[156:159], v[208:211]
    v_cvt_pk_bf16_f32 v44, v188, v189
    v_exp_f32 v190, v190
    v_mfma_f32_16x16x32_bf16 v[212:215], v[236:239], v[172:175], v[212:215]
    ds_read_b128 v[228:231], v4 offset:31744
    v_exp_f32 v191, v191
    v_add_f32 v10, v10, v190
    v_add_f32 v10, v10, v191
    s_waitcnt lgkmcnt(3)
    v_mfma_f32_16x16x32_bf16 v[200:203], v[240:243], v[160:163], v[200:203]
    v_cvt_pk_bf16_f32 v45, v190, v191
    v_exp_f32 v192, v192
    v_exp_f32 v193, v193
    v_mfma_f32_16x16x32_bf16 v[204:207], v[240:243], v[176:179], v[204:207]
    s_barrier
    ds_read_b128 v[232:235], v4 offset:32768
    v_add_f32 v9, v9, v192
    v_add_f32 v9, v9, v193
    s_waitcnt lgkmcnt(3)
    v_mfma_f32_16x16x32_bf16 v[208:211], v[244:247], v[160:163], v[208:211]
    v_cvt_pk_bf16_f32 v42, v192, v193
    v_exp_f32 v194, v194
    v_exp_f32 v195, v195
    v_mfma_f32_16x16x32_bf16 v[212:215], v[244:247], v[176:179], v[212:215]
    s_add_u32 s22, s21, 0x18000
    s_add_u32 m0, s20, 0x10000
    s_nop 0
    buffer_load_dwordx4 v2, s[8:11], s22 offen sc1 lds
    ds_read_b128 v[236:239], v4 offset:33792
    v_add_f32 v9, v9, v194
    v_add_f32 v9, v9, v195
    v_cvt_pk_bf16_f32 v43, v194, v195
    s_waitcnt lgkmcnt(3)
    v_mfma_f32_16x16x32_bf16 v[200:203], v[224:227], v[164:167], v[200:203]
    v_exp_f32 v196, v196
    v_exp_f32 v197, v197
    v_mfma_f32_16x16x32_bf16 v[204:207], v[224:227], v[180:183], v[204:207]
    ds_read_b128 v[240:243], v4 offset:34816
    v_add_f32 v10, v10, v196
    v_add_f32 v10, v10, v197
    v_cvt_pk_bf16_f32 v46, v196, v197
    s_waitcnt lgkmcnt(3)
    v_mfma_f32_16x16x32_bf16 v[208:211], v[228:231], v[164:167], v[208:211]
    v_exp_f32 v198, v198
    v_exp_f32 v199, v199
    v_add_f32 v10, v10, v198
    v_mfma_f32_16x16x32_bf16 v[212:215], v[228:231], v[180:183], v[212:215]
    ds_read_b128 v[244:247], v4 offset:35840
    v_add_f32 v10, v10, v199
    v_cvt_pk_bf16_f32 v47, v198, v199
    s_waitcnt lgkmcnt(3)
    v_mfma_f32_16x16x32_bf16 v[184:187], v[232:235], v[152:155], v[216:219]
    v_mfma_f32_16x16x32_bf16 v[188:191], v[232:235], v[168:171], v[220:223]
    ds_read_b128 v[224:227], v4 offset:36864
    v_exp_f32 v200, v200
    v_exp_f32 v201, v201
    v_add_f32 v9, v9, v200
    s_waitcnt lgkmcnt(3)
    v_mfma_f32_16x16x32_bf16 v[192:195], v[236:239], v[152:155], v[216:219]
    v_add_f32 v9, v9, v201
    v_cvt_pk_bf16_f32 v48, v200, v201
    v_exp_f32 v202, v202
    v_mfma_f32_16x16x32_bf16 v[196:199], v[236:239], v[168:171], v[220:223]
    s_add_u32 s22, s21, 0x18400
    s_add_u32 m0, s20, 0x10400
    s_nop 0
    buffer_load_dwordx4 v2, s[8:11], s22 offen sc1 lds
    ds_read_b128 v[228:231], v4 offset:37888
    v_exp_f32 v203, v203
    v_add_f32 v9, v9, v202
    s_waitcnt lgkmcnt(3)
    v_mfma_f32_16x16x32_bf16 v[184:187], v[240:243], v[156:159], v[184:187]
    v_add_f32 v9, v9, v203
    v_cvt_pk_bf16_f32 v49, v202, v203
    v_exp_f32 v204, v204
    v_mfma_f32_16x16x32_bf16 v[188:191], v[240:243], v[172:175], v[188:191]
    ds_read_b128 v[232:235], v4 offset:38912
    v_exp_f32 v205, v205
    v_add_f32 v10, v10, v204
    v_add_f32 v10, v10, v205
    s_waitcnt lgkmcnt(3)
    v_mfma_f32_16x16x32_bf16 v[192:195], v[244:247], v[156:159], v[192:195]
    v_cvt_pk_bf16_f32 v52, v204, v205
    v_exp_f32 v206, v206
    v_mfma_f32_16x16x32_bf16 v[196:199], v[244:247], v[172:175], v[196:199]
    ds_read_b128 v[236:239], v4 offset:39936
    v_exp_f32 v207, v207
    v_add_f32 v10, v10, v206
    v_add_f32 v10, v10, v207
    s_waitcnt lgkmcnt(3)
    v_mfma_f32_16x16x32_bf16 v[184:187], v[224:227], v[160:163], v[184:187]
    v_cvt_pk_bf16_f32 v53, v206, v207
    v_exp_f32 v208, v208
    v_exp_f32 v209, v209
    v_mfma_f32_16x16x32_bf16 v[188:191], v[224:227], v[176:179], v[188:191]
    ds_read_b128 v[240:243], v4 offset:40960
    v_add_f32 v9, v9, v208
    v_add_f32 v9, v9, v209
    s_waitcnt lgkmcnt(3)
    v_mfma_f32_16x16x32_bf16 v[192:195], v[228:231], v[160:163], v[192:195]
    v_cvt_pk_bf16_f32 v50, v208, v209
    v_exp_f32 v210, v210
    v_exp_f32 v211, v211
    v_mfma_f32_16x16x32_bf16 v[196:199], v[228:231], v[176:179], v[196:199]
    ds_read_b128 v[244:247], v4 offset:41984
    v_add_f32 v9, v9, v210
    v_add_f32 v9, v9, v211
    v_cvt_pk_bf16_f32 v51, v210, v211
    s_waitcnt lgkmcnt(3)
    v_mfma_f32_16x16x32_bf16 v[184:187], v[232:235], v[164:167], v[184:187]
    v_exp_f32 v212, v212
    v_exp_f32 v213, v213
    v_mfma_f32_16x16x32_bf16 v[188:191], v[232:235], v[180:183], v[188:191]
    ds_read_b128 v[224:227], v4 offset:43008
    v_add_f32 v10, v10, v212
    v_add_f32 v10, v10, v213
    v_cvt_pk_bf16_f32 v54, v212, v213
    s_waitcnt lgkmcnt(3)
    v_mfma_f32_16x16x32_bf16 v[192:195], v[236:239], v[164:167], v[192:195]
    v_exp_f32 v214, v214
    v_exp_f32 v215, v215
    v_add_f32 v10, v10, v214
    v_mfma_f32_16x16x32_bf16 v[196:199], v[236:239], v[180:183], v[196:199]
    ds_read_b128 v[228:231], v4 offset:44032
    v_add_f32 v10, v10, v215
    v_cvt_pk_bf16_f32 v55, v214, v215
    s_waitcnt lgkmcnt(3)
    v_mfma_f32_16x16x32_bf16 v[200:203], v[240:243], v[152:155], v[216:219]
    v_mfma_f32_16x16x32_bf16 v[204:207], v[240:243], v[168:171], v[220:223]
    ds_read_b128 v[232:235], v4 offset:45056
    v_exp_f32 v184, v184
    v_exp_f32 v185, v185
    v_add_f32 v9, v9, v184
    s_waitcnt lgkmcnt(3)
    v_mfma_f32_16x16x32_bf16 v[208:211], v[244:247], v[152:155], v[216:219]
    v_add_f32 v9, v9, v185
    v_cvt_pk_bf16_f32 v56, v184, v185
    v_exp_f32 v186, v186
    v_mfma_f32_16x16x32_bf16 v[212:215], v[244:247], v[168:171], v[220:223]
    ds_read_b128 v[236:239], v4 offset:46080
    v_exp_f32 v187, v187
    v_add_f32 v9, v9, v186
    s_waitcnt lgkmcnt(3)
    v_mfma_f32_16x16x32_bf16 v[200:203], v[224:227], v[156:159], v[200:203]
    v_add_f32 v9, v9, v187
    v_cvt_pk_bf16_f32 v57, v186, v187
    v_exp_f32 v188, v188
    v_mfma_f32_16x16x32_bf16 v[204:207], v[224:227], v[172:175], v[204:207]
    ds_read_b128 v[240:243], v4 offset:47104
    v_exp_f32 v189, v189
    v_add_f32 v10, v10, v188
    v_add_f32 v10, v10, v189
    s_waitcnt lgkmcnt(3)
    v_mfma_f32_16x16x32_bf16 v[208:211], v[228:231], v[156:159], v[208:211]
    v_cvt_pk_bf16_f32 v60, v188, v189
    v_exp_f32 v190, v190
    v_mfma_f32_16x16x32_bf16 v[212:215], v[228:231], v[172:175], v[212:215]
    ds_read_b128 v[244:247], v4 offset:48128
    v_exp_f32 v191, v191
    v_add_f32 v10, v10, v190
    v_add_f32 v10, v10, v191
    s_waitcnt lgkmcnt(3)
    v_mfma_f32_16x16x32_bf16 v[200:203], v[232:235], v[160:163], v[200:203]
    v_cvt_pk_bf16_f32 v61, v190, v191
    v_exp_f32 v192, v192
    v_exp_f32 v193, v193
    v_mfma_f32_16x16x32_bf16 v[204:207], v[232:235], v[176:179], v[204:207]
    s_barrier
    ds_read_b128 v[224:227], v4 offset:49152
    v_add_f32 v9, v9, v192
    v_add_f32 v9, v9, v193
    s_waitcnt lgkmcnt(3)
    v_mfma_f32_16x16x32_bf16 v[208:211], v[236:239], v[160:163], v[208:211]
    v_cvt_pk_bf16_f32 v58, v192, v193
    v_exp_f32 v194, v194
    v_exp_f32 v195, v195
    v_mfma_f32_16x16x32_bf16 v[212:215], v[236:239], v[176:179], v[212:215]
    s_add_u32 s22, s21, 0x1c000
    s_add_u32 m0, s20, 0x14000
    s_nop 0
    buffer_load_dwordx4 v2, s[8:11], s22 offen sc1 lds
    ds_read_b128 v[228:231], v4 offset:50176
    v_add_f32 v9, v9, v194
    v_add_f32 v9, v9, v195
    v_cvt_pk_bf16_f32 v59, v194, v195
    s_waitcnt lgkmcnt(3)
    v_mfma_f32_16x16x32_bf16 v[200:203], v[240:243], v[164:167], v[200:203]
    v_exp_f32 v196, v196
    v_exp_f32 v197, v197
    v_mfma_f32_16x16x32_bf16 v[204:207], v[240:243], v[180:183], v[204:207]
    ds_read_b128 v[232:235], v4 offset:51200
    v_add_f32 v10, v10, v196
    v_add_f32 v10, v10, v197
    v_cvt_pk_bf16_f32 v62, v196, v197
    s_waitcnt lgkmcnt(3)
    v_mfma_f32_16x16x32_bf16 v[208:211], v[244:247], v[164:167], v[208:211]
    v_exp_f32 v198, v198
    v_exp_f32 v199, v199
    v_add_f32 v10, v10, v198
    v_mfma_f32_16x16x32_bf16 v[212:215], v[244:247], v[180:183], v[212:215]
    ds_read_b128 v[236:239], v4 offset:52224
    v_add_f32 v10, v10, v199
    v_cvt_pk_bf16_f32 v63, v198, v199
    s_waitcnt lgkmcnt(3)
    v_mfma_f32_16x16x32_bf16 v[184:187], v[224:227], v[152:155], v[216:219]
    v_mfma_f32_16x16x32_bf16 v[188:191], v[224:227], v[168:171], v[220:223]
    ds_read_b128 v[240:243], v4 offset:53248
    v_exp_f32 v200, v200
    v_exp_f32 v201, v201
    v_add_f32 v9, v9, v200
    s_waitcnt lgkmcnt(3)
    v_mfma_f32_16x16x32_bf16 v[192:195], v[228:231], v[152:155], v[216:219]
    v_add_f32 v9, v9, v201
    v_cvt_pk_bf16_f32 v64, v200, v201
    v_exp_f32 v202, v202
    v_mfma_f32_16x16x32_bf16 v[196:199], v[228:231], v[168:171], v[220:223]
    s_add_u32 s22, s21, 0x1c400
    s_add_u32 m0, s20, 0x14400
    s_nop 0
    buffer_load_dwordx4 v2, s[8:11], s22 offen sc1 lds
    ds_read_b128 v[244:247], v4 offset:54272
    v_exp_f32 v203, v203
    v_add_f32 v9, v9, v202
    s_waitcnt lgkmcnt(3)
    v_mfma_f32_16x16x32_bf16 v[184:187], v[232:235], v[156:159], v[184:187]
    v_add_f32 v9, v9, v203
    v_cvt_pk_bf16_f32 v65, v202, v203
    v_exp_f32 v204, v204
    v_mfma_f32_16x16x32_bf16 v[188:191], v[232:235], v[172:175], v[188:191]
    ds_read_b128 v[224:227], v4 offset:55296
    v_exp_f32 v205, v205
    v_add_f32 v10, v10, v204
    v_add_f32 v10, v10, v205
    s_waitcnt lgkmcnt(3)
    v_mfma_f32_16x16x32_bf16 v[192:195], v[236:239], v[156:159], v[192:195]
    v_cvt_pk_bf16_f32 v68, v204, v205
    v_exp_f32 v206, v206
    v_mfma_f32_16x16x32_bf16 v[196:199], v[236:239], v[172:175], v[196:199]
    ds_read_b128 v[228:231], v4 offset:56320
    v_exp_f32 v207, v207
    v_add_f32 v10, v10, v206
    v_add_f32 v10, v10, v207
    s_waitcnt lgkmcnt(3)
    v_mfma_f32_16x16x32_bf16 v[184:187], v[240:243], v[160:163], v[184:187]
    v_cvt_pk_bf16_f32 v69, v206, v207
    v_exp_f32 v208, v208
    v_exp_f32 v209, v209
    v_mfma_f32_16x16x32_bf16 v[188:191], v[240:243], v[176:179], v[188:191]
    ds_read_b128 v[232:235], v4 offset:57344
    v_add_f32 v9, v9, v208
    v_add_f32 v9, v9, v209
    s_waitcnt lgkmcnt(3)
    v_mfma_f32_16x16x32_bf16 v[192:195], v[244:247], v[160:163], v[192:195]
    v_cvt_pk_bf16_f32 v66, v208, v209
    v_exp_f32 v210, v210
    v_exp_f32 v211, v211
    v_mfma_f32_16x16x32_bf16 v[196:199], v[244:247], v[176:179], v[196:199]
    ds_read_b128 v[236:239], v4 offset:58368
    v_add_f32 v9, v9, v210
    v_add_f32 v9, v9, v211
    v_cvt_pk_bf16_f32 v67, v210, v211
    s_waitcnt lgkmcnt(3)
    v_mfma_f32_16x16x32_bf16 v[184:187], v[224:227], v[164:167], v[184:187]
    v_exp_f32 v212, v212
    v_exp_f32 v213, v213
    v_mfma_f32_16x16x32_bf16 v[188:191], v[224:227], v[180:183], v[188:191]
    ds_read_b128 v[240:243], v4 offset:59392
    v_add_f32 v10, v10, v212
    v_add_f32 v10, v10, v213
    v_cvt_pk_bf16_f32 v70, v212, v213
    s_waitcnt lgkmcnt(3)
    v_mfma_f32_16x16x32_bf16 v[192:195], v[228:231], v[164:167], v[192:195]
    v_exp_f32 v214, v214
    v_exp_f32 v215, v215
    v_add_f32 v10, v10, v214
    v_mfma_f32_16x16x32_bf16 v[196:199], v[228:231], v[180:183], v[196:199]
    ds_read_b128 v[244:247], v4 offset:60416
    v_add_f32 v10, v10, v215
    v_cvt_pk_bf16_f32 v71, v214, v215
    s_waitcnt lgkmcnt(3)
    v_mfma_f32_16x16x32_bf16 v[200:203], v[232:235], v[152:155], v[216:219]
    v_mfma_f32_16x16x32_bf16 v[204:207], v[232:235], v[168:171], v[220:223]
    ds_read_b128 v[224:227], v4 offset:61440
    v_exp_f32 v184, v184
    v_exp_f32 v185, v185
    v_add_f32 v9, v9, v184
    s_waitcnt lgkmcnt(3)
    v_mfma_f32_16x16x32_bf16 v[208:211], v[236:239], v[152:155], v[216:219]
    v_add_f32 v9, v9, v185
    v_cvt_pk_bf16_f32 v72, v184, v185
    v_exp_f32 v186, v186
    v_mfma_f32_16x16x32_bf16 v[212:215], v[236:239], v[168:171], v[220:223]
    ds_read_b128 v[228:231], v4 offset:62464
    v_exp_f32 v187, v187
    v_add_f32 v9, v9, v186
    s_waitcnt lgkmcnt(3)
    v_mfma_f32_16x16x32_bf16 v[200:203], v[240:243], v[156:159], v[200:203]
    v_add_f32 v9, v9, v187
    v_cvt_pk_bf16_f32 v73, v186, v187
    v_exp_f32 v188, v188
    v_mfma_f32_16x16x32_bf16 v[204:207], v[240:243], v[172:175], v[204:207]
    ds_read_b128 v[232:235], v4 offset:63488
    v_exp_f32 v189, v189
    v_add_f32 v10, v10, v188
    v_add_f32 v10, v10, v189
    s_waitcnt lgkmcnt(3)
    v_mfma_f32_16x16x32_bf16 v[208:211], v[244:247], v[156:159], v[208:211]
    v_cvt_pk_bf16_f32 v76, v188, v189
    v_exp_f32 v190, v190
    v_mfma_f32_16x16x32_bf16 v[212:215], v[244:247], v[172:175], v[212:215]
    ds_read_b128 v[236:239], v4 offset:64512
    v_exp_f32 v191, v191
    v_add_f32 v10, v10, v190
    v_add_f32 v10, v10, v191
    s_waitcnt lgkmcnt(3)
    v_mfma_f32_16x16x32_bf16 v[200:203], v[224:227], v[160:163], v[200:203]
    v_cvt_pk_bf16_f32 v77, v190, v191
    v_exp_f32 v192, v192
    v_exp_f32 v193, v193
    v_mfma_f32_16x16x32_bf16 v[204:207], v[224:227], v[176:179], v[204:207]
    s_waitcnt vmcnt(6)
    s_barrier
    ds_read_b128 v[240:243], v5 offset:0
    v_add_f32 v9, v9, v192
    v_add_f32 v9, v9, v193
    s_waitcnt lgkmcnt(3)
    v_mfma_f32_16x16x32_bf16 v[208:211], v[228:231], v[160:163], v[208:211]
    v_cvt_pk_bf16_f32 v74, v192, v193
    v_exp_f32 v194, v194
    v_exp_f32 v195, v195
    v_mfma_f32_16x16x32_bf16 v[212:215], v[228:231], v[176:179], v[212:215]
    s_add_u32 s22, s14, 0x0
    s_add_u32 m0, s20, 0x18000
    s_nop 0
    buffer_load_dwordx4 v6, s[76:79], s22 offen lds
    ds_read_b128 v[244:247], v5 offset:1024
    v_add_f32 v9, v9, v194
    v_add_f32 v9, v9, v195
    v_cvt_pk_bf16_f32 v75, v194, v195
    s_waitcnt lgkmcnt(3)
    v_mfma_f32_16x16x32_bf16 v[200:203], v[232:235], v[164:167], v[200:203]
    v_exp_f32 v196, v196
    v_exp_f32 v197, v197
    v_mfma_f32_16x16x32_bf16 v[204:207], v[232:235], v[180:183], v[204:207]
    ds_read_b128 v[224:227], v5 offset:2048
    v_add_f32 v10, v10, v196
    v_add_f32 v10, v10, v197
    v_cvt_pk_bf16_f32 v78, v196, v197
    s_waitcnt lgkmcnt(3)
    v_mfma_f32_16x16x32_bf16 v[208:211], v[236:239], v[164:167], v[208:211]
    v_exp_f32 v198, v198
    v_exp_f32 v199, v199
    v_add_f32 v10, v10, v198
    v_mfma_f32_16x16x32_bf16 v[212:215], v[236:239], v[180:183], v[212:215]
    ds_read_b128 v[228:231], v5 offset:3072
    v_add_f32 v10, v10, v199
    v_cvt_pk_bf16_f32 v79, v198, v199
    s_waitcnt lgkmcnt(3)
    v_mfma_f32_16x16x32_bf16 v[184:187], v[240:243], v[152:155], v[216:219]
    v_mfma_f32_16x16x32_bf16 v[188:191], v[240:243], v[168:171], v[220:223]
    ds_read_b128 v[232:235], v5 offset:4096
    v_exp_f32 v200, v200
    v_exp_f32 v201, v201
    v_add_f32 v9, v9, v200
    s_waitcnt lgkmcnt(3)
    v_mfma_f32_16x16x32_bf16 v[192:195], v[244:247], v[152:155], v[216:219]
    v_add_f32 v9, v9, v201
    v_cvt_pk_bf16_f32 v80, v200, v201
    v_exp_f32 v202, v202
    v_mfma_f32_16x16x32_bf16 v[196:199], v[244:247], v[168:171], v[220:223]
    s_add_u32 s22, s14, 0xc000
    s_add_u32 m0, s20, 0x18400
    s_nop 0
    buffer_load_dwordx4 v6, s[76:79], s22 offen lds
    ds_read_b128 v[236:239], v5 offset:5120
    v_exp_f32 v203, v203
    v_add_f32 v9, v9, v202
    s_waitcnt lgkmcnt(3)
    v_mfma_f32_16x16x32_bf16 v[184:187], v[224:227], v[156:159], v[184:187]
    v_add_f32 v9, v9, v203
    v_cvt_pk_bf16_f32 v81, v202, v203
    v_exp_f32 v204, v204
    v_mfma_f32_16x16x32_bf16 v[188:191], v[224:227], v[172:175], v[188:191]
    ds_read_b128 v[240:243], v5 offset:6144
    v_exp_f32 v205, v205
    v_add_f32 v10, v10, v204
    v_add_f32 v10, v10, v205
    s_waitcnt lgkmcnt(3)
    v_mfma_f32_16x16x32_bf16 v[192:195], v[228:231], v[156:159], v[192:195]
    v_cvt_pk_bf16_f32 v84, v204, v205
    v_exp_f32 v206, v206
    v_mfma_f32_16x16x32_bf16 v[196:199], v[228:231], v[172:175], v[196:199]
    ds_read_b128 v[244:247], v5 offset:7168
    v_exp_f32 v207, v207
    v_add_f32 v10, v10, v206
    v_add_f32 v10, v10, v207
    s_waitcnt lgkmcnt(3)
    v_mfma_f32_16x16x32_bf16 v[184:187], v[232:235], v[160:163], v[184:187]
    v_cvt_pk_bf16_f32 v85, v206, v207
    v_exp_f32 v208, v208
    v_exp_f32 v209, v209
    v_mfma_f32_16x16x32_bf16 v[188:191], v[232:235], v[176:179], v[188:191]
    ds_read_b128 v[224:227], v5 offset:8192
    v_add_f32 v9, v9, v208
    v_add_f32 v9, v9, v209
    s_waitcnt lgkmcnt(3)
    v_mfma_f32_16x16x32_bf16 v[192:195], v[236:239], v[160:163], v[192:195]
    v_cvt_pk_bf16_f32 v82, v208, v209
    v_exp_f32 v210, v210
    v_exp_f32 v211, v211
    v_mfma_f32_16x16x32_bf16 v[196:199], v[236:239], v[176:179], v[196:199]
    ds_read_b128 v[228:231], v5 offset:9216
    v_add_f32 v9, v9, v210
    v_add_f32 v9, v9, v211
    v_cvt_pk_bf16_f32 v83, v210, v211
    s_waitcnt lgkmcnt(3)
    v_mfma_f32_16x16x32_bf16 v[184:187], v[240:243], v[164:167], v[184:187]
    v_exp_f32 v212, v212
    v_exp_f32 v213, v213
    v_mfma_f32_16x16x32_bf16 v[188:191], v[240:243], v[180:183], v[188:191]
    ds_read_b128 v[232:235], v5 offset:10240
    v_add_f32 v10, v10, v212
    v_add_f32 v10, v10, v213
    v_cvt_pk_bf16_f32 v86, v212, v213
    s_waitcnt lgkmcnt(3)
    v_mfma_f32_16x16x32_bf16 v[192:195], v[244:247], v[164:167], v[192:195]
    v_exp_f32 v214, v214
    v_exp_f32 v215, v215
    v_add_f32 v10, v10, v214
    v_mfma_f32_16x16x32_bf16 v[196:199], v[244:247], v[180:183], v[196:199]
    ds_read_b128 v[236:239], v5 offset:11264
    v_add_f32 v10, v10, v215
    v_cvt_pk_bf16_f32 v87, v214, v215
    s_waitcnt lgkmcnt(3)
    v_mfma_f32_16x16x32_bf16 v[200:203], v[224:227], v[152:155], v[216:219]
    v_mfma_f32_16x16x32_bf16 v[204:207], v[224:227], v[168:171], v[220:223]
    ds_read_b128 v[240:243], v5 offset:12288
    v_exp_f32 v184, v184
    v_exp_f32 v185, v185
    v_add_f32 v9, v9, v184
    s_waitcnt lgkmcnt(3)
    v_mfma_f32_16x16x32_bf16 v[208:211], v[228:231], v[152:155], v[216:219]
    v_add_f32 v9, v9, v185
    v_cvt_pk_bf16_f32 v88, v184, v185
    v_exp_f32 v186, v186
    v_mfma_f32_16x16x32_bf16 v[212:215], v[228:231], v[168:171], v[220:223]
    ds_read_b128 v[244:247], v5 offset:13312
    v_exp_f32 v187, v187
    v_add_f32 v9, v9, v186
    s_waitcnt lgkmcnt(3)
    v_mfma_f32_16x16x32_bf16 v[200:203], v[232:235], v[156:159], v[200:203]
    v_add_f32 v9, v9, v187
    v_cvt_pk_bf16_f32 v89, v186, v187
    v_exp_f32 v188, v188
    v_mfma_f32_16x16x32_bf16 v[204:207], v[232:235], v[172:175], v[204:207]
    ds_read_b128 v[224:227], v5 offset:14336
    v_exp_f32 v189, v189
    v_add_f32 v10, v10, v188
    v_add_f32 v10, v10, v189
    s_waitcnt lgkmcnt(3)
    v_mfma_f32_16x16x32_bf16 v[208:211], v[236:239], v[156:159], v[208:211]
    v_cvt_pk_bf16_f32 v92, v188, v189
    v_exp_f32 v190, v190
    v_mfma_f32_16x16x32_bf16 v[212:215], v[236:239], v[172:175], v[212:215]
    ds_read_b128 v[228:231], v5 offset:15360
    v_exp_f32 v191, v191
    v_add_f32 v10, v10, v190
    v_add_f32 v10, v10, v191
    s_waitcnt lgkmcnt(3)
    v_mfma_f32_16x16x32_bf16 v[200:203], v[240:243], v[160:163], v[200:203]
    v_cvt_pk_bf16_f32 v93, v190, v191
    v_exp_f32 v192, v192
    v_exp_f32 v193, v193
    v_mfma_f32_16x16x32_bf16 v[204:207], v[240:243], v[176:179], v[204:207]
    s_waitcnt vmcnt(6)
    s_barrier
    ds_read_b128 v[232:235], v5 offset:16384
    v_add_f32 v9, v9, v192
    v_add_f32 v9, v9, v193
    s_waitcnt lgkmcnt(3)
    v_mfma_f32_16x16x32_bf16 v[208:211], v[244:247], v[160:163], v[208:211]
    v_cvt_pk_bf16_f32 v90, v192, v193
    v_exp_f32 v194, v194
    v_exp_f32 v195, v195
    v_mfma_f32_16x16x32_bf16 v[212:215], v[244:247], v[176:179], v[212:215]
    s_add_u32 s22, s14, 0xc0000
    s_add_u32 m0, s20, 0x1c000
    s_nop 0
    buffer_load_dwordx4 v6, s[76:79], s22 offen lds
    ds_read_b128 v[236:239], v5 offset:17408
    v_add_f32 v9, v9, v194
    v_add_f32 v9, v9, v195
    v_cvt_pk_bf16_f32 v91, v194, v195
    s_waitcnt lgkmcnt(3)
    v_mfma_f32_16x16x32_bf16 v[200:203], v[224:227], v[164:167], v[200:203]
    v_exp_f32 v196, v196
    v_exp_f32 v197, v197
    v_mfma_f32_16x16x32_bf16 v[204:207], v[224:227], v[180:183], v[204:207]
    ds_read_b128 v[240:243], v5 offset:18432
    v_add_f32 v10, v10, v196
    v_add_f32 v10, v10, v197
    v_cvt_pk_bf16_f32 v94, v196, v197
    s_waitcnt lgkmcnt(3)
    v_mfma_f32_16x16x32_bf16 v[208:211], v[228:231], v[164:167], v[208:211]
    v_exp_f32 v198, v198
    v_exp_f32 v199, v199
    v_add_f32 v10, v10, v198
    v_mfma_f32_16x16x32_bf16 v[212:215], v[228:231], v[180:183], v[212:215]
    ds_read_b128 v[244:247], v5 offset:19456
    v_add_f32 v10, v10, v199
    v_cvt_pk_bf16_f32 v95, v198, v199
    s_waitcnt lgkmcnt(3)
    v_mfma_f32_16x16x32_bf16 v[184:187], v[232:235], v[152:155], v[216:219]
    v_mfma_f32_16x16x32_bf16 v[188:191], v[232:235], v[168:171], v[220:223]
    ds_read_b128 v[224:227], v5 offset:20480
    v_exp_f32 v200, v200
    v_exp_f32 v201, v201
    v_add_f32 v9, v9, v200
    s_waitcnt lgkmcnt(3)
    v_mfma_f32_16x16x32_bf16 v[192:195], v[236:239], v[152:155], v[216:219]
    v_add_f32 v9, v9, v201
    v_cvt_pk_bf16_f32 v96, v200, v201
    v_exp_f32 v202, v202
    v_mfma_f32_16x16x32_bf16 v[196:199], v[236:239], v[168:171], v[220:223]
    s_add_u32 s22, s14, 0xcc000
    s_add_u32 m0, s20, 0x1c400
    s_nop 0
    buffer_load_dwordx4 v6, s[76:79], s22 offen lds
    ds_read_b128 v[228:231], v5 offset:21504
    v_exp_f32 v203, v203
    v_add_f32 v9, v9, v202
    s_waitcnt lgkmcnt(3)
    v_mfma_f32_16x16x32_bf16 v[184:187], v[240:243], v[156:159], v[184:187]
    v_add_f32 v9, v9, v203
    v_cvt_pk_bf16_f32 v97, v202, v203
    v_exp_f32 v204, v204
    v_mfma_f32_16x16x32_bf16 v[188:191], v[240:243], v[172:175], v[188:191]
    ds_read_b128 v[232:235], v5 offset:22528
    v_exp_f32 v205, v205
    v_add_f32 v10, v10, v204
    v_add_f32 v10, v10, v205
    s_waitcnt lgkmcnt(3)
    v_mfma_f32_16x16x32_bf16 v[192:195], v[244:247], v[156:159], v[192:195]
    v_cvt_pk_bf16_f32 v100, v204, v205
    v_exp_f32 v206, v206
    v_mfma_f32_16x16x32_bf16 v[196:199], v[244:247], v[172:175], v[196:199]
    ds_read_b128 v[236:239], v5 offset:23552
    v_exp_f32 v207, v207
    v_add_f32 v10, v10, v206
    v_add_f32 v10, v10, v207
    s_waitcnt lgkmcnt(3)
    v_mfma_f32_16x16x32_bf16 v[184:187], v[224:227], v[160:163], v[184:187]
    v_cvt_pk_bf16_f32 v101, v206, v207
    v_exp_f32 v208, v208
    v_exp_f32 v209, v209
    v_mfma_f32_16x16x32_bf16 v[188:191], v[224:227], v[176:179], v[188:191]
    ds_read_b128 v[240:243], v5 offset:24576
    v_add_f32 v9, v9, v208
    v_add_f32 v9, v9, v209
    s_waitcnt lgkmcnt(3)
    v_mfma_f32_16x16x32_bf16 v[192:195], v[228:231], v[160:163], v[192:195]
    v_cvt_pk_bf16_f32 v98, v208, v209
    v_exp_f32 v210, v210
    v_exp_f32 v211, v211
    v_mfma_f32_16x16x32_bf16 v[196:199], v[228:231], v[176:179], v[196:199]
    ds_read_b128 v[244:247], v5 offset:25600
    v_add_f32 v9, v9, v210
    v_add_f32 v9, v9, v211
    v_cvt_pk_bf16_f32 v99, v210, v211
    s_waitcnt lgkmcnt(3)
    v_mfma_f32_16x16x32_bf16 v[184:187], v[232:235], v[164:167], v[184:187]
    v_exp_f32 v212, v212
    v_exp_f32 v213, v213
    v_mfma_f32_16x16x32_bf16 v[188:191], v[232:235], v[180:183], v[188:191]
    ds_read_b128 v[224:227], v5 offset:26624
    v_add_f32 v10, v10, v212
    v_add_f32 v10, v10, v213
    v_cvt_pk_bf16_f32 v102, v212, v213
    s_waitcnt lgkmcnt(3)
    v_mfma_f32_16x16x32_bf16 v[192:195], v[236:239], v[164:167], v[192:195]
    v_exp_f32 v214, v214
    v_exp_f32 v215, v215
    v_add_f32 v10, v10, v214
    v_mfma_f32_16x16x32_bf16 v[196:199], v[236:239], v[180:183], v[196:199]
    ds_read_b128 v[228:231], v5 offset:27648
    v_add_f32 v10, v10, v215
    v_cvt_pk_bf16_f32 v103, v214, v215
    s_waitcnt lgkmcnt(3)
    v_mfma_f32_16x16x32_bf16 v[200:203], v[240:243], v[152:155], v[216:219]
    v_mfma_f32_16x16x32_bf16 v[204:207], v[240:243], v[168:171], v[220:223]
    ds_read_b128 v[232:235], v5 offset:28672
    v_exp_f32 v184, v184
    v_exp_f32 v185, v185
    v_add_f32 v9, v9, v184
    s_waitcnt lgkmcnt(3)
    v_mfma_f32_16x16x32_bf16 v[208:211], v[244:247], v[152:155], v[216:219]
    v_add_f32 v9, v9, v185
    v_cvt_pk_bf16_f32 v104, v184, v185
    v_exp_f32 v186, v186
    v_mfma_f32_16x16x32_bf16 v[212:215], v[244:247], v[168:171], v[220:223]
    ds_read_b128 v[236:239], v5 offset:29696
    v_exp_f32 v187, v187
    v_add_f32 v9, v9, v186
    s_waitcnt lgkmcnt(3)
    v_mfma_f32_16x16x32_bf16 v[200:203], v[224:227], v[156:159], v[200:203]
    v_add_f32 v9, v9, v187
    v_cvt_pk_bf16_f32 v105, v186, v187
    v_exp_f32 v188, v188
    v_mfma_f32_16x16x32_bf16 v[204:207], v[224:227], v[172:175], v[204:207]
    ds_read_b128 v[240:243], v5 offset:30720
    v_exp_f32 v189, v189
    v_add_f32 v10, v10, v188
    v_add_f32 v10, v10, v189
    v_lshrrev_b32 v20, 4, v1
    v_lshlrev_b32 v21, 4, v20
    s_lshl_b32 s16, s2, 8
    s_add_u32 s16, s16, 0x550000
    buffer_load_dwordx4 v[144:147], v21, s[8:11], s16 offen offset:0 sc1
    buffer_load_dwordx4 v[148:151], v21, s[8:11], s16 offen offset:64 sc1
    buffer_load_dwordx4 v[248:251], v21, s[8:11], s16 offen offset:128 sc1
    buffer_load_dwordx4 v[252:255], v21, s[8:11], s16 offen offset:192 sc1
    v_lshlrev_b32 v7, 11, v20
    v_xor_b32 v20, s3, v20
    v_and_b32 v20, 1, v20
    v_lshl_add_u32 v7, v20, 5, v7
    v_bfe_u32 v20, v1, 2, 2
    v_lshl_add_u32 v7, v20, 6, v7
    v_and_b32 v20, 3, v1
    v_lshl_add_u32 v7, v20, 3, v7
    s_lshr_b32 s16, s3, 1
    s_lshl_b32 s16, s16, 8
    s_add_u32 s16, s16, 98304
    v_add_u32 v7, s16, v7
    s_waitcnt lgkmcnt(3)
    v_mfma_f32_16x16x32_bf16 v[208:211], v[228:231], v[156:159], v[208:211]
    v_cvt_pk_bf16_f32 v108, v188, v189
    v_exp_f32 v190, v190
    v_mfma_f32_16x16x32_bf16 v[212:215], v[228:231], v[172:175], v[212:215]
    ds_read_b128 v[244:247], v5 offset:31744
    v_exp_f32 v191, v191
    v_add_f32 v10, v10, v190
    v_add_f32 v10, v10, v191
    s_waitcnt lgkmcnt(3)
    v_mfma_f32_16x16x32_bf16 v[200:203], v[232:235], v[160:163], v[200:203]
    v_cvt_pk_bf16_f32 v109, v190, v191
    v_exp_f32 v192, v192
    v_exp_f32 v193, v193
    v_mfma_f32_16x16x32_bf16 v[204:207], v[232:235], v[176:179], v[204:207]
    s_waitcnt vmcnt(10)
    s_barrier
    ds_read_b128 v[224:227], v4 offset:0
    v_add_f32 v9, v9, v192
    v_add_f32 v9, v9, v193
    s_waitcnt lgkmcnt(3)
    v_mfma_f32_16x16x32_bf16 v[208:211], v[236:239], v[160:163], v[208:211]
    v_cvt_pk_bf16_f32 v106, v192, v193
    v_exp_f32 v194, v194
    v_exp_f32 v195, v195
    v_mfma_f32_16x16x32_bf16 v[212:215], v[236:239], v[176:179], v[212:215]
    s_add_u32 s22, s21, 0x80000
    s_add_u32 m0, s20, 0x20000
    s_nop 0
    buffer_load_dwordx4 v2, s[8:11], s22 offen sc1 lds
    ds_read_b128 v[228:231], v4 offset:1024
    v_add_f32 v9, v9, v194
    v_add_f32 v9, v9, v195
    v_cvt_pk_bf16_f32 v107, v194, v195
    s_waitcnt lgkmcnt(3)
    v_mfma_f32_16x16x32_bf16 v[200:203], v[240:243], v[164:167], v[200:203]
    v_exp_f32 v196, v196
    v_exp_f32 v197, v197
    v_mfma_f32_16x16x32_bf16 v[204:207], v[240:243], v[180:183], v[204:207]
    ds_read_b128 v[232:235], v4 offset:2048
    v_add_f32 v10, v10, v196
    v_add_f32 v10, v10, v197
    v_cvt_pk_bf16_f32 v110, v196, v197
    s_waitcnt lgkmcnt(3)
    v_mfma_f32_16x16x32_bf16 v[208:211], v[244:247], v[164:167], v[208:211]
    v_exp_f32 v198, v198
    v_exp_f32 v199, v199
    v_add_f32 v10, v10, v198
    v_mfma_f32_16x16x32_bf16 v[212:215], v[244:247], v[180:183], v[212:215]
    ds_read_b128 v[236:239], v4 offset:3072
    v_add_f32 v10, v10, v199
    v_cvt_pk_bf16_f32 v111, v198, v199
    s_waitcnt lgkmcnt(3)
    v_mfma_f32_16x16x32_bf16 v[184:187], v[224:227], v[152:155], v[216:219]
    v_mfma_f32_16x16x32_bf16 v[188:191], v[224:227], v[168:171], v[220:223]
    ds_read_b128 v[240:243], v4 offset:4096
    v_exp_f32 v200, v200
    v_exp_f32 v201, v201
    v_add_f32 v9, v9, v200
    s_waitcnt lgkmcnt(3)
    v_mfma_f32_16x16x32_bf16 v[192:195], v[228:231], v[152:155], v[216:219]
    v_add_f32 v9, v9, v201
    v_cvt_pk_bf16_f32 v112, v200, v201
    v_exp_f32 v202, v202
    v_mfma_f32_16x16x32_bf16 v[196:199], v[228:231], v[168:171], v[220:223]
    s_add_u32 s22, s21, 0x80400
    s_add_u32 m0, s20, 0x20400
    s_nop 0
    buffer_load_dwordx4 v2, s[8:11], s22 offen sc1 lds
    ds_read_b128 v[244:247], v4 offset:5120
    v_exp_f32 v203, v203
    v_add_f32 v9, v9, v202
    s_waitcnt lgkmcnt(3)
    v_mfma_f32_16x16x32_bf16 v[184:187], v[232:235], v[156:159], v[184:187]
    v_add_f32 v9, v9, v203
    v_cvt_pk_bf16_f32 v113, v202, v203
    v_exp_f32 v204, v204
    v_mfma_f32_16x16x32_bf16 v[188:191], v[232:235], v[172:175], v[188:191]
    ds_read_b128 v[224:227], v4 offset:6144
    v_exp_f32 v205, v205
    v_add_f32 v10, v10, v204
    v_add_f32 v10, v10, v205
    s_waitcnt lgkmcnt(3)
    v_mfma_f32_16x16x32_bf16 v[192:195], v[236:239], v[156:159], v[192:195]
    v_cvt_pk_bf16_f32 v116, v204, v205
    v_exp_f32 v206, v206
    v_mfma_f32_16x16x32_bf16 v[196:199], v[236:239], v[172:175], v[196:199]
    ds_read_b128 v[228:231], v4 offset:7168
    v_exp_f32 v207, v207
    v_add_f32 v10, v10, v206
    v_add_f32 v10, v10, v207
    s_waitcnt lgkmcnt(3)
    v_mfma_f32_16x16x32_bf16 v[184:187], v[240:243], v[160:163], v[184:187]
    v_cvt_pk_bf16_f32 v117, v206, v207
    v_exp_f32 v208, v208
    v_exp_f32 v209, v209
    v_mfma_f32_16x16x32_bf16 v[188:191], v[240:243], v[176:179], v[188:191]
    ds_read_b128 v[232:235], v4 offset:8192
    v_add_f32 v9, v9, v208
    v_add_f32 v9, v9, v209
    s_waitcnt lgkmcnt(3)
    v_mfma_f32_16x16x32_bf16 v[192:195], v[244:247], v[160:163], v[192:195]
    v_cvt_pk_bf16_f32 v114, v208, v209
    v_exp_f32 v210, v210
    v_exp_f32 v211, v211
    v_mfma_f32_16x16x32_bf16 v[196:199], v[244:247], v[176:179], v[196:199]
    ds_read_b128 v[236:239], v4 offset:9216
    v_add_f32 v9, v9, v210
    v_add_f32 v9, v9, v211
    v_cvt_pk_bf16_f32 v115, v210, v211
    s_waitcnt lgkmcnt(3)
    v_mfma_f32_16x16x32_bf16 v[184:187], v[224:227], v[164:167], v[184:187]
    v_exp_f32 v212, v212
    v_exp_f32 v213, v213
    v_mfma_f32_16x16x32_bf16 v[188:191], v[224:227], v[180:183], v[188:191]
    ds_read_b128 v[240:243], v4 offset:10240
    v_add_f32 v10, v10, v212
    v_add_f32 v10, v10, v213
    v_cvt_pk_bf16_f32 v118, v212, v213
    s_waitcnt lgkmcnt(3)
    v_mfma_f32_16x16x32_bf16 v[192:195], v[228:231], v[164:167], v[192:195]
    v_exp_f32 v214, v214
    v_exp_f32 v215, v215
    v_add_f32 v10, v10, v214
    v_mfma_f32_16x16x32_bf16 v[196:199], v[228:231], v[180:183], v[196:199]
    ds_read_b128 v[244:247], v4 offset:11264
    v_add_f32 v10, v10, v215
    v_cvt_pk_bf16_f32 v119, v214, v215
    s_waitcnt lgkmcnt(3)
    v_mfma_f32_16x16x32_bf16 v[200:203], v[232:235], v[152:155], v[216:219]
    v_mfma_f32_16x16x32_bf16 v[204:207], v[232:235], v[168:171], v[220:223]
    ds_read_b128 v[224:227], v4 offset:12288
    v_exp_f32 v184, v184
    v_exp_f32 v185, v185
    v_add_f32 v9, v9, v184
    s_waitcnt lgkmcnt(3)
    v_mfma_f32_16x16x32_bf16 v[208:211], v[236:239], v[152:155], v[216:219]
    v_add_f32 v9, v9, v185
    v_cvt_pk_bf16_f32 v120, v184, v185
    v_exp_f32 v186, v186
    v_mfma_f32_16x16x32_bf16 v[212:215], v[236:239], v[168:171], v[220:223]
    ds_read_b128 v[228:231], v4 offset:13312
    v_exp_f32 v187, v187
    v_add_f32 v9, v9, v186
    s_waitcnt lgkmcnt(3)
    v_mfma_f32_16x16x32_bf16 v[200:203], v[240:243], v[156:159], v[200:203]
    v_add_f32 v9, v9, v187
    v_cvt_pk_bf16_f32 v121, v186, v187
    v_exp_f32 v188, v188
    v_mfma_f32_16x16x32_bf16 v[204:207], v[240:243], v[172:175], v[204:207]
    ds_read_b128 v[232:235], v4 offset:14336
    v_exp_f32 v189, v189
    v_add_f32 v10, v10, v188
    v_add_f32 v10, v10, v189
    s_waitcnt lgkmcnt(3)
    v_mfma_f32_16x16x32_bf16 v[208:211], v[244:247], v[156:159], v[208:211]
    v_cvt_pk_bf16_f32 v124, v188, v189
    v_exp_f32 v190, v190
    v_mfma_f32_16x16x32_bf16 v[212:215], v[244:247], v[172:175], v[212:215]
    ds_read_b128 v[236:239], v4 offset:15360
    v_exp_f32 v191, v191
    v_add_f32 v10, v10, v190
    v_add_f32 v10, v10, v191
    s_waitcnt lgkmcnt(3)
    v_mfma_f32_16x16x32_bf16 v[200:203], v[224:227], v[160:163], v[200:203]
    v_cvt_pk_bf16_f32 v125, v190, v191
    v_exp_f32 v192, v192
    v_exp_f32 v193, v193
    v_mfma_f32_16x16x32_bf16 v[204:207], v[224:227], v[176:179], v[204:207]
    s_waitcnt vmcnt(10)
    s_waitcnt vmcnt(8)
    s_waitcnt vmcnt(6)
    s_barrier
    ds_read_b128 v[240:243], v4 offset:16384
    v_add_f32 v9, v9, v192
    v_add_f32 v9, v9, v193
    s_waitcnt lgkmcnt(3)
    v_mfma_f32_16x16x32_bf16 v[208:211], v[228:231], v[160:163], v[208:211]
    v_cvt_pk_bf16_f32 v122, v192, v193
    v_exp_f32 v194, v194
    v_exp_f32 v195, v195
    v_mfma_f32_16x16x32_bf16 v[212:215], v[228:231], v[176:179], v[212:215]
    s_add_u32 s22, s21, 0x84000
    s_add_u32 m0, s20, 0x24000
    s_nop 0
    buffer_load_dwordx4 v2, s[8:11], s22 offen sc1 lds
    ds_read_b128 v[244:247], v4 offset:17408
    v_add_f32 v9, v9, v194
    v_add_f32 v9, v9, v195
    v_cvt_pk_bf16_f32 v123, v194, v195
    ds_read_b64_tr_b16 v[136:137], v7 offset:0
    ds_read_b64_tr_b16 v[138:139], v7 offset:1024
    s_waitcnt lgkmcnt(5)
    v_mfma_f32_16x16x32_bf16 v[200:203], v[232:235], v[164:167], v[200:203]
    v_exp_f32 v196, v196
    v_exp_f32 v197, v197
    v_mfma_f32_16x16x32_bf16 v[204:207], v[232:235], v[180:183], v[204:207]
    ds_read_b128 v[224:227], v4 offset:18432
    v_add_f32 v10, v10, v196
    v_add_f32 v10, v10, v197
    v_cvt_pk_bf16_f32 v126, v196, v197
    s_waitcnt lgkmcnt(5)
    v_mfma_f32_16x16x32_bf16 v[208:211], v[236:239], v[164:167], v[208:211]
    v_exp_f32 v198, v198
    v_exp_f32 v199, v199
    v_add_f32 v10, v10, v198
    ds_read_b64_tr_b16 v[140:141], v7 offset:8192
    ds_read_b64_tr_b16 v[142:143], v7 offset:9216
    v_mfma_f32_16x16x32_bf16 v[212:215], v[236:239], v[180:183], v[212:215]
    ds_read_b128 v[228:231], v4 offset:19456
    v_add_f32 v10, v10, v199
    v_cvt_pk_bf16_f32 v127, v198, v199
    s_waitcnt lgkmcnt(7)
    v_mfma_f32_16x16x32_bf16 v[184:187], v[240:243], v[152:155], v[216:219]
    s_waitcnt vmcnt(6) lgkmcnt(4)
    v_mfma_f32_16x16x32_bf16 v[12:15], v[136:139], v[144:147], 0
    v_mfma_f32_16x16x32_bf16 v[188:191], v[240:243], v[168:171], v[220:223]
    ds_read_b128 v[232:235], v4 offset:20480
    v_exp_f32 v200, v200
    v_exp_f32 v201, v201
    v_add_f32 v9, v9, v200
    ds_read_b64_tr_b16 v[136:137], v7 offset:16384
    ds_read_b64_tr_b16 v[138:139], v7 offset:17408
    v_mfma_f32_16x16x32_bf16 v[192:195], v[244:247], v[152:155], v[216:219]
    v_add_f32 v9, v9, v201
    v_cvt_pk_bf16_f32 v128, v200, v201
    v_exp_f32 v202, v202
    v_mfma_f32_16x16x32_bf16 v[196:199], v[244:247], v[168:171], v[220:223]
    s_add_u32 s22, s21, 0x84400
    s_add_u32 m0, s20, 0x24400
    s_nop 0
    buffer_load_dwordx4 v2, s[8:11], s22 offen sc1 lds
    ds_read_b128 v[236:239], v4 offset:21504
    v_exp_f32 v203, v203
    v_add_f32 v9, v9, v202
    s_waitcnt vmcnt(6) lgkmcnt(5)
    v_mfma_f32_16x16x32_bf16 v[12:15], v[140:143], v[148:151], v[12:15]
    v_mfma_f32_16x16x32_bf16 v[184:187], v[224:227], v[156:159], v[184:187]
    v_add_f32 v9, v9, v203
    v_cvt_pk_bf16_f32 v129, v202, v203
    v_exp_f32 v204, v204
    ds_read_b64_tr_b16 v[140:141], v7 offset:24576
    ds_read_b64_tr_b16 v[142:143], v7 offset:25600
    v_mfma_f32_16x16x32_bf16 v[188:191], v[224:227], v[172:175], v[188:191]
    ds_read_b128 v[240:243], v4 offset:22528
    v_exp_f32 v205, v205
    v_add_f32 v10, v10, v204
    v_add_f32 v10, v10, v205
    s_waitcnt lgkmcnt(7)
    v_mfma_f32_16x16x32_bf16 v[192:195], v[228:231], v[156:159], v[192:195]
    v_cvt_pk_bf16_f32 v132, v204, v205
    v_exp_f32 v206, v206
    s_waitcnt vmcnt(5) lgkmcnt(4)
    v_mfma_f32_16x16x32_bf16 v[12:15], v[136:139], v[248:251], v[12:15]
    v_mfma_f32_16x16x32_bf16 v[196:199], v[228:231], v[172:175], v[196:199]
    ds_read_b128 v[244:247], v4 offset:23552
    v_exp_f32 v207, v207
    v_add_f32 v10, v10, v206
    v_add_f32 v10, v10, v207
    v_mfma_f32_16x16x32_bf16 v[184:187], v[232:235], v[160:163], v[184:187]
    v_cvt_pk_bf16_f32 v133, v206, v207
    v_exp_f32 v208, v208
    v_exp_f32 v209, v209
    v_mfma_f32_16x16x32_bf16 v[188:191], v[232:235], v[176:179], v[188:191]
    ds_read_b128 v[224:227], v4 offset:24576
    v_add_f32 v9, v9, v208
    v_add_f32 v9, v9, v209
    s_waitcnt vmcnt(4) lgkmcnt(3)
    v_mfma_f32_16x16x32_bf16 v[12:15], v[140:143], v[252:255], v[12:15]
    v_mfma_f32_16x16x32_bf16 v[192:195], v[236:239], v[160:163], v[192:195]
    v_cvt_pk_bf16_f32 v130, v208, v209
    v_exp_f32 v210, v210
    v_exp_f32 v211, v211
    v_mfma_f32_16x16x32_bf16 v[196:199], v[236:239], v[176:179], v[196:199]
    ds_read_b128 v[228:231], v4 offset:25600
    v_add_f32 v9, v9, v210
    v_add_f32 v9, v9, v211
    v_cvt_pk_bf16_f32 v131, v210, v211
    s_waitcnt lgkmcnt(3)
    v_mfma_f32_16x16x32_bf16 v[184:187], v[240:243], v[164:167], v[184:187]
    v_exp_f32 v212, v212
    v_exp_f32 v213, v213
    v_mfma_f32_16x16x32_bf16 v[188:191], v[240:243], v[180:183], v[188:191]
    ds_read_b128 v[232:235], v4 offset:26624
    v_add_f32 v10, v10, v212
    v_add_f32 v10, v10, v213
    v_cvt_pk_bf16_f32 v134, v212, v213
    s_waitcnt lgkmcnt(3)
    v_mfma_f32_16x16x32_bf16 v[192:195], v[244:247], v[164:167], v[192:195]
    v_exp_f32 v214, v214
    v_exp_f32 v215, v215
    v_add_f32 v10, v10, v214
    v_mfma_f32_16x16x32_bf16 v[196:199], v[244:247], v[180:183], v[196:199]
    ds_read_b128 v[236:239], v4 offset:27648
    v_add_f32 v10, v10, v215
    v_cvt_pk_bf16_f32 v135, v214, v215
    s_waitcnt lgkmcnt(3)
    v_mfma_f32_16x16x32_bf16 v[200:203], v[224:227], v[152:155], v[216:219]
    v_mfma_f32_16x16x32_bf16 v[204:207], v[224:227], v[168:171], v[220:223]
    ds_read_b128 v[240:243], v4 offset:28672
    v_exp_f32 v184, v184
    v_exp_f32 v185, v185
    v_add_f32 v9, v9, v184
    v_lshrrev_b32 v20, 4, v1
    v_lshlrev_b32 v20, 4, v20
    s_lshr_b32 s16, s2, 5
    s_lshl_b32 s16, s16, 14
    s_and_b32 s17, s2, 31
    s_lshl_b32 s17, s17, 9
    s_add_u32 s16, s16, s17
    s_lshl_b32 s17, s3, 6
    s_add_u32 s16, s16, s17
    s_add_u32 s16, s16, 0x580000
    s_mov_b32 exec_lo, 0x10001
    s_mov_b32 exec_hi, 0x10001
    buffer_store_dwordx4 v[12:15], v20, s[8:11], s16 offen sc1
    s_mov_b64 exec, -1
    s_waitcnt lgkmcnt(3)
    v_mfma_f32_16x16x32_bf16 v[208:211], v[228:231], v[152:155], v[216:219]
    v_add_f32 v9, v9, v185
    v_cvt_pk_bf16_f32 v136, v184, v185
    v_exp_f32 v186, v186
    v_mfma_f32_16x16x32_bf16 v[212:215], v[228:231], v[168:171], v[220:223]
    ds_read_b128 v[244:247], v4 offset:29696
    v_exp_f32 v187, v187
    v_add_f32 v9, v9, v186
    s_waitcnt lgkmcnt(3)
    v_mfma_f32_16x16x32_bf16 v[200:203], v[232:235], v[156:159], v[200:203]
    v_add_f32 v9, v9, v187
    v_cvt_pk_bf16_f32 v137, v186, v187
    v_exp_f32 v188, v188
    v_mfma_f32_16x16x32_bf16 v[204:207], v[232:235], v[172:175], v[204:207]
    ds_read_b128 v[224:227], v4 offset:30720
    v_exp_f32 v189, v189
    v_add_f32 v10, v10, v188
    v_add_f32 v10, v10, v189
    s_waitcnt lgkmcnt(3)
    v_mfma_f32_16x16x32_bf16 v[208:211], v[236:239], v[156:159], v[208:211]
    v_cvt_pk_bf16_f32 v140, v188, v189
    v_exp_f32 v190, v190
    v_mfma_f32_16x16x32_bf16 v[212:215], v[236:239], v[172:175], v[212:215]
    ds_read_b128 v[228:231], v4 offset:31744
    v_exp_f32 v191, v191
    v_add_f32 v10, v10, v190
    v_add_f32 v10, v10, v191
    s_waitcnt lgkmcnt(3)
    v_mfma_f32_16x16x32_bf16 v[200:203], v[240:243], v[160:163], v[200:203]
    v_cvt_pk_bf16_f32 v141, v190, v191
    v_exp_f32 v192, v192
    v_exp_f32 v193, v193
    v_mfma_f32_16x16x32_bf16 v[204:207], v[240:243], v[176:179], v[204:207]
    v_add_f32 v9, v9, v192
    v_add_f32 v9, v9, v193
    s_waitcnt lgkmcnt(2)
    v_mfma_f32_16x16x32_bf16 v[208:211], v[244:247], v[160:163], v[208:211]
    v_cvt_pk_bf16_f32 v138, v192, v193
    v_exp_f32 v194, v194
    v_exp_f32 v195, v195
    v_mfma_f32_16x16x32_bf16 v[212:215], v[244:247], v[176:179], v[212:215]
    v_add_f32 v9, v9, v194
    v_add_f32 v9, v9, v195
    v_cvt_pk_bf16_f32 v139, v194, v195
    s_waitcnt lgkmcnt(1)
    v_mfma_f32_16x16x32_bf16 v[200:203], v[224:227], v[164:167], v[200:203]
    v_exp_f32 v196, v196
    v_exp_f32 v197, v197
    v_mfma_f32_16x16x32_bf16 v[204:207], v[224:227], v[180:183], v[204:207]
    v_add_f32 v10, v10, v196
    v_add_f32 v10, v10, v197
    v_cvt_pk_bf16_f32 v142, v196, v197
    s_waitcnt lgkmcnt(0)
    v_mfma_f32_16x16x32_bf16 v[208:211], v[228:231], v[164:167], v[208:211]
    v_exp_f32 v198, v198
    v_exp_f32 v199, v199
    v_add_f32 v10, v10, v198
    v_mfma_f32_16x16x32_bf16 v[212:215], v[228:231], v[180:183], v[212:215]
    v_add_f32 v10, v10, v199
    v_cvt_pk_bf16_f32 v143, v198, v199
    s_waitcnt vmcnt(3)
    s_barrier
    ds_read_b128 v[232:235], v5 offset:0
    ds_read_b128 v[236:239], v5 offset:1024
    ds_read_b128 v[240:243], v5 offset:2048
    ds_read_b128 v[244:247], v5 offset:3072
    v_exp_f32 v200, v200
    v_exp_f32 v201, v201
    v_add_f32 v9, v9, v200
    v_add_f32 v9, v9, v201
    v_cvt_pk_bf16_f32 v144, v200, v201
    v_exp_f32 v202, v202
    v_exp_f32 v203, v203
    v_add_f32 v9, v9, v202
    v_add_f32 v9, v9, v203
    v_cvt_pk_bf16_f32 v145, v202, v203
    v_exp_f32 v204, v204
    v_exp_f32 v205, v205
    v_add_f32 v10, v10, v204
    v_add_f32 v10, v10, v205
    v_cvt_pk_bf16_f32 v148, v204, v205
    v_exp_f32 v206, v206
    v_exp_f32 v207, v207
    v_add_f32 v10, v10, v206
    v_add_f32 v10, v10, v207
    v_cvt_pk_bf16_f32 v149, v206, v207
    v_exp_f32 v208, v208
    v_exp_f32 v209, v209
    v_add_f32 v9, v9, v208
    v_add_f32 v9, v9, v209
    v_cvt_pk_bf16_f32 v146, v208, v209
    v_exp_f32 v210, v210
    v_exp_f32 v211, v211
    v_add_f32 v9, v9, v210
    v_add_f32 v9, v9, v211
    v_cvt_pk_bf16_f32 v147, v210, v211
    v_exp_f32 v212, v212
    v_exp_f32 v213, v213
    v_add_f32 v10, v10, v212
    v_add_f32 v10, v10, v213
    v_cvt_pk_bf16_f32 v150, v212, v213
    v_exp_f32 v214, v214
    v_exp_f32 v215, v215
    v_add_f32 v10, v10, v214
    v_add_f32 v10, v10, v215
    v_cvt_pk_bf16_f32 v151, v214, v215
    v_mov_b32 v16, v9
    v_mov_b32 v18, v10
    s_nop 0
    v_permlane16_swap_b32 v9, v16
    v_permlane16_swap_b32 v10, v18
    v_add_f32 v9, v9, v16
    v_add_f32 v10, v10, v18
    v_mov_b32 v16, v9
    v_mov_b32 v18, v10
    s_nop 0
    v_permlane32_swap_b32 v9, v16
    v_permlane32_swap_b32 v10, v18
    v_add_f32 v9, v9, v16
    v_add_f32 v10, v10, v18
    v_max_f32 v17, v9, v10
    s_mov_b32 s16, 0x71800000
    v_cmp_ngt_f32 vcc, s16, v17
    v_cmp_u_f32 s[76:77], v9, v10
    s_or_b64 vcc, vcc, s[76:77]
    s_cbranch_vccnz adaLN_cond__sliding_block_cached__moe_arch_mod__prompt_kernel_fixA
adaLN_cond__sliding_block_cached__moe_arch_mod__prompt_kernel_fixAb:
    v_rcp_f32 v9, v9
    v_rcp_f32 v10, v10
    s_lshl_b32 s25, s13, 3
    s_add_u32 s25, s25, s3
    s_lshl_b32 s25, s25, 18
    s_lshl_b32 s26, s12, 12
    s_add_u32 s25, s25, s26
    s_add_u32 s25, s25, 0x1000000
    s_add_u32 s26, s25, 131072
    s_lshl_b32 s63, s13, 3
    s_add_u32 s63, s63, s3
    s_lshl_b32 s63, s63, 5
    s_add_u32 s63, s63, s12
    s_lshl_b32 s63, s63, 2
    s_waitcnt lgkmcnt(3)
    v_mfma_f32_16x16x32_bf16 v[184:187], v[232:235], v[24:27], 0
    v_mfma_f32_16x16x32_bf16 v[188:191], v[232:235], v[28:31], 0
    ds_read_b128 v[224:227], v5 offset:4096
    s_waitcnt lgkmcnt(3)
    v_mfma_f32_16x16x32_bf16 v[192:195], v[236:239], v[24:27], 0
    s_add_u32 s22, s21, 0x88000
    s_add_u32 m0, s20, 0x10000
    s_nop 0
    buffer_load_dwordx4 v2, s[8:11], s22 offen sc1 lds
    v_mfma_f32_16x16x32_bf16 v[196:199], v[236:239], v[28:31], 0
    ds_read_b128 v[228:231], v5 offset:5120
    s_waitcnt lgkmcnt(3)
    v_mfma_f32_16x16x32_bf16 v[184:187], v[240:243], v[32:35], v[184:187]
    v_mfma_f32_16x16x32_bf16 v[188:191], v[240:243], v[36:39], v[188:191]
    ds_read_b128 v[232:235], v5 offset:6144
    s_waitcnt lgkmcnt(3)
    v_mfma_f32_16x16x32_bf16 v[192:195], v[244:247], v[32:35], v[192:195]
    s_add_u32 s22, s21, 0x88400
    s_add_u32 m0, s20, 0x10400
    s_nop 0
    buffer_load_dwordx4 v2, s[8:11], s22 offen sc1 lds
    v_mfma_f32_16x16x32_bf16 v[196:199], v[244:247], v[36:39], v[196:199]
    ds_read_b128 v[236:239], v5 offset:7168
    s_waitcnt lgkmcnt(3)
    v_mfma_f32_16x16x32_bf16 v[184:187], v[224:227], v[40:43], v[184:187]
    v_mfma_f32_16x16x32_bf16 v[188:191], v[224:227], v[44:47], v[188:191]
    ds_read_b128 v[240:243], v5 offset:8192
    s_waitcnt lgkmcnt(3)
    v_mfma_f32_16x16x32_bf16 v[192:195], v[228:231], v[40:43], v[192:195]
    s_add_u32 s22, s21, 0x8c000
    s_add_u32 m0, s20, 0x14000
    s_nop 0
    buffer_load_dwordx4 v2, s[8:11], s22 offen sc1 lds
    v_mfma_f32_16x16x32_bf16 v[196:199], v[228:231], v[44:47], v[196:199]
    ds_read_b128 v[244:247], v5 offset:9216
    s_waitcnt lgkmcnt(3)
    v_mfma_f32_16x16x32_bf16 v[184:187], v[232:235], v[48:51], v[184:187]
    v_mfma_f32_16x16x32_bf16 v[188:191], v[232:235], v[52:55], v[188:191]
    ds_read_b128 v[224:227], v5 offset:10240
    s_waitcnt lgkmcnt(3)
    v_mfma_f32_16x16x32_bf16 v[192:195], v[236:239], v[48:51], v[192:195]
    s_add_u32 s22, s21, 0x8c400
    s_add_u32 m0, s20, 0x14400
    s_nop 0
    buffer_load_dwordx4 v2, s[8:11], s22 offen sc1 lds
    v_mfma_f32_16x16x32_bf16 v[196:199], v[236:239], v[52:55], v[196:199]
    ds_read_b128 v[228:231], v5 offset:11264
    s_waitcnt lgkmcnt(3)
    v_mfma_f32_16x16x32_bf16 v[184:187], v[240:243], v[56:59], v[184:187]
    v_mfma_f32_16x16x32_bf16 v[188:191], v[240:243], v[60:63], v[188:191]
    ds_read_b128 v[232:235], v5 offset:12288
    s_waitcnt lgkmcnt(3)
    v_mfma_f32_16x16x32_bf16 v[192:195], v[244:247], v[56:59], v[192:195]
    s_add_u32 s22, s21, 0x90000
    s_add_u32 m0, s20, 0x18000
    s_nop 0
    buffer_load_dwordx4 v2, s[8:11], s22 offen sc1 lds
    v_mfma_f32_16x16x32_bf16 v[196:199], v[244:247], v[60:63], v[196:199]
    ds_read_b128 v[236:239], v5 offset:13312
    s_waitcnt lgkmcnt(3)
    v_mfma_f32_16x16x32_bf16 v[184:187], v[224:227], v[64:67], v[184:187]
    v_mfma_f32_16x16x32_bf16 v[188:191], v[224:227], v[68:71], v[188:191]
    ds_read_b128 v[240:243], v5 offset:14336
    s_waitcnt lgkmcnt(3)
    v_mfma_f32_16x16x32_bf16 v[192:195], v[228:231], v[64:67], v[192:195]
    s_add_u32 s22, s21, 0x90400
    s_add_u32 m0, s20, 0x18400
    s_nop 0
    buffer_load_dwordx4 v2, s[8:11], s22 offen sc1 lds
    s_waitcnt vmcnt(6)
    v_mfma_f32_16x16x32_bf16 v[196:199], v[228:231], v[68:71], v[196:199]
    ds_read_b128 v[244:247], v5 offset:15360
    s_waitcnt lgkmcnt(3)
    v_mfma_f32_16x16x32_bf16 v[184:187], v[232:235], v[72:75], v[184:187]
    v_mfma_f32_16x16x32_bf16 v[188:191], v[232:235], v[76:79], v[188:191]
    s_barrier
    ds_read_b128 v[224:227], v5 offset:16384
    s_waitcnt lgkmcnt(3)
    v_mfma_f32_16x16x32_bf16 v[192:195], v[236:239], v[72:75], v[192:195]
    v_mfma_f32_16x16x32_bf16 v[196:199], v[236:239], v[76:79], v[196:199]
    s_add_u32 s22, s21, 0x94000
    s_add_u32 m0, s20, 0x1c000
    s_nop 0
    buffer_load_dwordx4 v2, s[8:11], s22 offen sc1 lds
    ds_read_b128 v[228:231], v5 offset:17408
    s_waitcnt lgkmcnt(3)
    v_mfma_f32_16x16x32_bf16 v[184:187], v[240:243], v[80:83], v[184:187]
    v_mfma_f32_16x16x32_bf16 v[188:191], v[240:243], v[84:87], v[188:191]
    ds_read_b128 v[232:235], v5 offset:18432
    s_waitcnt lgkmcnt(3)
    v_mfma_f32_16x16x32_bf16 v[192:195], v[244:247], v[80:83], v[192:195]
    v_mov_b32 v251, s28
    v_mov_b32 v252, 0
    s_lshl_b32 s16, s2, 2
    s_add_u32 s16, s16, 0x560000
    s_cmp_eq_u32 s3, 0
    s_cselect_b32 s16, s16, 0x7ffffff0
    s_mov_b64 exec, 1
    buffer_store_dword v251, v252, s[8:11], s16 offen sc1
    s_mov_b64 exec, -1
    v_mfma_f32_16x16x32_bf16 v[196:199], v[244:247], v[84:87], v[196:199]
    ds_read_b128 v[236:239], v5 offset:19456
    s_waitcnt lgkmcnt(3)
    v_mfma_f32_16x16x32_bf16 v[184:187], v[224:227], v[88:91], v[184:187]
    v_mfma_f32_16x16x32_bf16 v[188:191], v[224:227], v[92:95], v[188:191]
    ds_read_b128 v[240:243], v5 offset:20480
    s_waitcnt lgkmcnt(3)
    v_mfma_f32_16x16x32_bf16 v[192:195], v[228:231], v[88:91], v[192:195]
    v_mfma_f32_16x16x32_bf16 v[196:199], v[228:231], v[92:95], v[196:199]
    s_add_u32 s22, s21, 0x94400
    s_add_u32 m0, s20, 0x1c400
    s_nop 0
    buffer_load_dwordx4 v2, s[8:11], s22 offen sc1 lds
    ds_read_b128 v[244:247], v5 offset:21504
    s_waitcnt lgkmcnt(3)
    v_mfma_f32_16x16x32_bf16 v[184:187], v[232:235], v[96:99], v[184:187]
    v_mfma_f32_16x16x32_bf16 v[188:191], v[232:235], v[100:103], v[188:191]
    ds_read_b128 v[224:227], v5 offset:22528
    s_waitcnt lgkmcnt(3)
    v_mfma_f32_16x16x32_bf16 v[192:195], v[236:239], v[96:99], v[192:195]
    v_mfma_f32_16x16x32_bf16 v[196:199], v[236:239], v[100:103], v[196:199]
    ds_read_b128 v[228:231], v5 offset:23552
    s_waitcnt lgkmcnt(3)
    v_mfma_f32_16x16x32_bf16 v[184:187], v[240:243], v[104:107], v[184:187]
    v_mfma_f32_16x16x32_bf16 v[188:191], v[240:243], v[108:111], v[188:191]
    ds_read_b128 v[232:235], v5 offset:24576
    s_waitcnt lgkmcnt(3)
    v_mfma_f32_16x16x32_bf16 v[192:195], v[244:247], v[104:107], v[192:195]
    v_mfma_f32_16x16x32_bf16 v[196:199], v[244:247], v[108:111], v[196:199]
    ds_read_b128 v[236:239], v5 offset:25600
    s_waitcnt lgkmcnt(3)
    v_mfma_f32_16x16x32_bf16 v[184:187], v[224:227], v[112:115], v[184:187]
    v_mfma_f32_16x16x32_bf16 v[188:191], v[224:227], v[116:119], v[188:191]
    ds_read_b128 v[240:243], v5 offset:26624
    s_waitcnt lgkmcnt(3)
    v_mfma_f32_16x16x32_bf16 v[192:195], v[228:231], v[112:115], v[192:195]
    v_mfma_f32_16x16x32_bf16 v[196:199], v[228:231], v[116:119], v[196:199]
    ds_read_b128 v[244:247], v5 offset:27648
    s_waitcnt lgkmcnt(3)
    v_mfma_f32_16x16x32_bf16 v[184:187], v[232:235], v[120:123], v[184:187]
    v_mfma_f32_16x16x32_bf16 v[188:191], v[232:235], v[124:127], v[188:191]
    ds_read_b128 v[224:227], v5 offset:28672
    s_waitcnt lgkmcnt(3)
    v_mfma_f32_16x16x32_bf16 v[192:195], v[236:239], v[120:123], v[192:195]
    v_mfma_f32_16x16x32_bf16 v[196:199], v[236:239], v[124:127], v[196:199]
    ds_read_b128 v[228:231], v5 offset:29696
    s_waitcnt lgkmcnt(3)
    v_mfma_f32_16x16x32_bf16 v[184:187], v[240:243], v[128:131], v[184:187]
    v_mfma_f32_16x16x32_bf16 v[188:191], v[240:243], v[132:135], v[188:191]
    ds_read_b128 v[232:235], v5 offset:30720
    s_waitcnt lgkmcnt(3)
    v_mfma_f32_16x16x32_bf16 v[192:195], v[244:247], v[128:131], v[192:195]
    v_mfma_f32_16x16x32_bf16 v[196:199], v[244:247], v[132:135], v[196:199]
    ds_read_b128 v[236:239], v5 offset:31744
    s_waitcnt lgkmcnt(3)
    v_mfma_f32_16x16x32_bf16 v[184:187], v[224:227], v[136:139], v[184:187]
    v_mfma_f32_16x16x32_bf16 v[188:191], v[224:227], v[140:143], v[188:191]
    s_waitcnt vmcnt(7)
    s_barrier
    ds_read_b128 v[240:243], v4 offset:0
    s_waitcnt lgkmcnt(3)
    v_mfma_f32_16x16x32_bf16 v[192:195], v[228:231], v[136:139], v[192:195]
    v_mfma_f32_16x16x32_bf16 v[196:199], v[228:231], v[140:143], v[196:199]
    s_add_u32 s22, s21, 0x98000
    s_add_u32 m0, s20, 0x20000
    s_nop 0
    buffer_load_dwordx4 v2, s[8:11], s22 offen sc1 lds
    ds_read_b128 v[244:247], v4 offset:1024
    s_waitcnt lgkmcnt(3)
    v_mfma_f32_16x16x32_bf16 v[184:187], v[232:235], v[144:147], v[184:187]
    v_mfma_f32_16x16x32_bf16 v[188:191], v[232:235], v[148:151], v[188:191]
    ds_read_b128 v[224:227], v4 offset:2048
    s_waitcnt lgkmcnt(3)
    v_mfma_f32_16x16x32_bf16 v[192:195], v[236:239], v[144:147], v[192:195]
    v_mfma_f32_16x16x32_bf16 v[196:199], v[236:239], v[148:151], v[196:199]
    ds_read_b128 v[228:231], v4 offset:3072
    s_waitcnt lgkmcnt(3)
    v_mfma_f32_16x16x32_bf16 v[200:203], v[240:243], v[24:27], 0
    v_mfma_f32_16x16x32_bf16 v[204:207], v[240:243], v[28:31], 0
    ds_read_b128 v[232:235], v4 offset:4096
    s_waitcnt lgkmcnt(3)
    v_mfma_f32_16x16x32_bf16 v[208:211], v[244:247], v[24:27], 0
    v_mfma_f32_16x16x32_bf16 v[212:215], v[244:247], v[28:31], 0
    s_add_u32 s22, s21, 0x98400
    s_add_u32 m0, s20, 0x20400
    s_nop 0
    buffer_load_dwordx4 v2, s[8:11], s22 offen sc1 lds
    ds_read_b128 v[236:239], v4 offset:5120
    v_mul_f32 v184, v184, v9
    s_waitcnt lgkmcnt(3)
    v_mfma_f32_16x16x32_bf16 v[200:203], v[224:227], v[32:35], v[200:203]
    v_mul_f32 v185, v185, v9
    v_mfma_f32_16x16x32_bf16 v[204:207], v[224:227], v[36:39], v[204:207]
    ds_read_b128 v[240:243], v4 offset:6144
    v_mul_f32 v186, v186, v9
    s_waitcnt lgkmcnt(3)
    v_mfma_f32_16x16x32_bf16 v[208:211], v[228:231], v[32:35], v[208:211]
    v_mul_f32 v187, v187, v9
    v_and_b32 v250, 7, v1
    v_lshlrev_b32 v250, 7, v250
    s_lshr_b32 s14, s2, 3
    s_lshl_b32 s14, s14, 2
    s_add_u32 s14, s14, 0x560000
    buffer_load_dword v248, v250, s[8:11], s14 offen sc1
    v_mfma_f32_16x16x32_bf16 v[212:215], v[228:231], v[36:39], v[212:215]
    ds_read_b128 v[244:247], v4 offset:7168
    v_mul_f32 v192, v192, v9
    s_waitcnt lgkmcnt(3)
    v_mfma_f32_16x16x32_bf16 v[200:203], v[232:235], v[40:43], v[200:203]
    v_mul_f32 v193, v193, v9
    v_mfma_f32_16x16x32_bf16 v[204:207], v[232:235], v[44:47], v[204:207]
    ds_read_b128 v[224:227], v4 offset:8192
    v_mul_f32 v194, v194, v9
    s_waitcnt lgkmcnt(3)
    v_mfma_f32_16x16x32_bf16 v[208:211], v[236:239], v[40:43], v[208:211]
    v_mul_f32 v195, v195, v9
    v_mfma_f32_16x16x32_bf16 v[212:215], v[236:239], v[44:47], v[212:215]
    ds_read_b128 v[228:231], v4 offset:9216
    v_cvt_pk_bf16_f32 v216, v184, v185
    s_waitcnt lgkmcnt(3)
    v_mfma_f32_16x16x32_bf16 v[200:203], v[240:243], v[48:51], v[200:203]
    v_cvt_pk_bf16_f32 v217, v186, v187
    v_mfma_f32_16x16x32_bf16 v[204:207], v[240:243], v[52:55], v[204:207]
    ds_read_b128 v[232:235], v4 offset:10240
    v_cvt_pk_bf16_f32 v218, v192, v193
    s_waitcnt lgkmcnt(3)
    v_mfma_f32_16x16x32_bf16 v[208:211], v[244:247], v[48:51], v[208:211]
    v_cvt_pk_bf16_f32 v219, v194, v195
    v_mfma_f32_16x16x32_bf16 v[212:215], v[244:247], v[52:55], v[212:215]
    ds_read_b128 v[236:239], v4 offset:11264
    buffer_store_dwordx4 v[216:219], v2, s[8:11], s25 offen offset:0 sc1
    s_waitcnt lgkmcnt(3)
    v_mfma_f32_16x16x32_bf16 v[200:203], v[224:227], v[56:59], v[200:203]
    v_mul_f32 v188, v188, v10
    v_mfma_f32_16x16x32_bf16 v[204:207], v[224:227], v[60:63], v[204:207]
    ds_read_b128 v[240:243], v4 offset:12288
    v_mul_f32 v189, v189, v10
    s_waitcnt lgkmcnt(3)
    v_mfma_f32_16x16x32_bf16 v[208:211], v[228:231], v[56:59], v[208:211]
    v_mul_f32 v190, v190, v10
    v_mfma_f32_16x16x32_bf16 v[212:215], v[228:231], v[60:63], v[212:215]
    ds_read_b128 v[244:247], v4 offset:13312
    v_mul_f32 v191, v191, v10
    s_waitcnt lgkmcnt(3)
    v_mfma_f32_16x16x32_bf16 v[200:203], v[232:235], v[64:67], v[200:203]
    v_mul_f32 v196, v196, v10
    v_mfma_f32_16x16x32_bf16 v[204:207], v[232:235], v[68:71], v[204:207]
    ds_read_b128 v[224:227], v4 offset:14336
    v_mul_f32 v197, v197, v10
    s_waitcnt lgkmcnt(3)
    v_mfma_f32_16x16x32_bf16 v[208:211], v[236:239], v[64:67], v[208:211]
    v_mul_f32 v198, v198, v10
    v_mfma_f32_16x16x32_bf16 v[212:215], v[236:239], v[68:71], v[212:215]
    ds_read_b128 v[228:231], v4 offset:15360
    v_mul_f32 v199, v199, v10
    s_waitcnt lgkmcnt(3)
    v_mfma_f32_16x16x32_bf16 v[200:203], v[240:243], v[72:75], v[200:203]
    v_cvt_pk_bf16_f32 v220, v188, v189
    v_mfma_f32_16x16x32_bf16 v[204:207], v[240:243], v[76:79], v[204:207]
    s_waitcnt vmcnt(9)
    s_barrier
    ds_read_b128 v[232:235], v4 offset:16384
    v_cvt_pk_bf16_f32 v221, v190, v191
    s_waitcnt lgkmcnt(3)
    v_mfma_f32_16x16x32_bf16 v[208:211], v[244:247], v[72:75], v[208:211]
    v_cvt_pk_bf16_f32 v222, v196, v197
    v_mfma_f32_16x16x32_bf16 v[212:215], v[244:247], v[76:79], v[212:215]
    s_add_u32 s22, s21, 0x9c000
    s_add_u32 m0, s20, 0x24000
    s_nop 0
    buffer_load_dwordx4 v2, s[8:11], s22 offen sc1 lds
    ds_read_b128 v[236:239], v4 offset:17408
    v_cvt_pk_bf16_f32 v223, v198, v199
    s_waitcnt lgkmcnt(3)
    v_mfma_f32_16x16x32_bf16 v[200:203], v[224:227], v[80:83], v[200:203]
    buffer_store_dwordx4 v[220:223], v2, s[8:11], s26 offen offset:0 sc1
    v_mfma_f32_16x16x32_bf16 v[204:207], v[224:227], v[84:87], v[204:207]
    ds_read_b128 v[240:243], v4 offset:18432
    s_waitcnt lgkmcnt(3)
    v_mfma_f32_16x16x32_bf16 v[208:211], v[228:231], v[80:83], v[208:211]
    v_mfma_f32_16x16x32_bf16 v[212:215], v[228:231], v[84:87], v[212:215]
    ds_read_b128 v[244:247], v4 offset:19456
    s_waitcnt lgkmcnt(3)
    v_mfma_f32_16x16x32_bf16 v[200:203], v[232:235], v[88:91], v[200:203]
    v_mfma_f32_16x16x32_bf16 v[204:207], v[232:235], v[92:95], v[204:207]
    ds_read_b128 v[224:227], v4 offset:20480
    s_waitcnt lgkmcnt(3)
    v_mfma_f32_16x16x32_bf16 v[208:211], v[236:239], v[88:91], v[208:211]
    v_mfma_f32_16x16x32_bf16 v[212:215], v[236:239], v[92:95], v[212:215]
    s_add_u32 s22, s21, 0x9c400
    s_add_u32 m0, s20, 0x24400
    s_nop 0
    buffer_load_dwordx4 v2, s[8:11], s22 offen sc1 lds
    ds_read_b128 v[228:231], v4 offset:21504
    s_waitcnt lgkmcnt(3)
    v_mfma_f32_16x16x32_bf16 v[200:203], v[240:243], v[96:99], v[200:203]
    v_mfma_f32_16x16x32_bf16 v[204:207], v[240:243], v[100:103], v[204:207]
    ds_read_b128 v[232:235], v4 offset:22528
    s_waitcnt lgkmcnt(3)
    v_mfma_f32_16x16x32_bf16 v[208:211], v[244:247], v[96:99], v[208:211]
    v_mfma_f32_16x16x32_bf16 v[212:215], v[244:247], v[100:103], v[212:215]
    ds_read_b128 v[236:239], v4 offset:23552
    s_waitcnt lgkmcnt(3)
    v_mfma_f32_16x16x32_bf16 v[200:203], v[224:227], v[104:107], v[200:203]
    v_mfma_f32_16x16x32_bf16 v[204:207], v[224:227], v[108:111], v[204:207]
    ds_read_b128 v[240:243], v4 offset:24576
    s_waitcnt lgkmcnt(3)
    v_mfma_f32_16x16x32_bf16 v[208:211], v[228:231], v[104:107], v[208:211]
    v_mfma_f32_16x16x32_bf16 v[212:215], v[228:231], v[108:111], v[212:215]
    ds_read_b128 v[244:247], v4 offset:25600
    s_waitcnt lgkmcnt(3)
    v_mfma_f32_16x16x32_bf16 v[200:203], v[232:235], v[112:115], v[200:203]
    v_mfma_f32_16x16x32_bf16 v[204:207], v[232:235], v[116:119], v[204:207]
    ds_read_b128 v[224:227], v4 offset:26624
    s_waitcnt lgkmcnt(3)
    v_mfma_f32_16x16x32_bf16 v[208:211], v[236:239], v[112:115], v[208:211]
    s_waitcnt vmcnt(4)
    v_cmp_ne_u32 vcc, s28, v248
    s_cbranch_vccnz adaLN_cond__sliding_block_cached__moe_arch_mod__prompt_kernel_mp5r
adaLN_cond__sliding_block_cached__moe_arch_mod__prompt_kernel_mp5b:
    v_mfma_f32_16x16x32_bf16 v[212:215], v[236:239], v[116:119], v[212:215]
    ds_read_b128 v[228:231], v4 offset:27648
    v_lshrrev_b32 v250, 4, v1
    v_lshlrev_b32 v250, 14, v250
    v_and_b32 v253, 15, v1
    v_lshl_add_u32 v250, v253, 2, v250
    s_lshl_b32 s14, s2, 6
    s_add_u32 s14, s14, 0x580000
    buffer_load_dword v249, v250, s[8:11], s14 offen sc1
    s_add_u32 s14, s14, 0x10000
    buffer_load_dword v254, v250, s[8:11], s14 offen sc1
    s_waitcnt lgkmcnt(3)
    v_mfma_f32_16x16x32_bf16 v[200:203], v[240:243], v[120:123], v[200:203]
    v_mfma_f32_16x16x32_bf16 v[204:207], v[240:243], v[124:127], v[204:207]
    ds_read_b128 v[232:235], v4 offset:28672
    s_waitcnt lgkmcnt(3)
    v_mfma_f32_16x16x32_bf16 v[208:211], v[244:247], v[120:123], v[208:211]
    v_mfma_f32_16x16x32_bf16 v[212:215], v[244:247], v[124:127], v[212:215]
    ds_read_b128 v[236:239], v4 offset:29696
    s_waitcnt lgkmcnt(3)
    v_mfma_f32_16x16x32_bf16 v[200:203], v[224:227], v[128:131], v[200:203]
    v_mfma_f32_16x16x32_bf16 v[204:207], v[224:227], v[132:135], v[204:207]
    ds_read_b128 v[240:243], v4 offset:30720
    s_waitcnt lgkmcnt(3)
    v_mfma_f32_16x16x32_bf16 v[208:211], v[228:231], v[128:131], v[208:211]
    v_mfma_f32_16x16x32_bf16 v[212:215], v[228:231], v[132:135], v[212:215]
    ds_read_b128 v[244:247], v4 offset:31744
    s_waitcnt lgkmcnt(3)
    v_mfma_f32_16x16x32_bf16 v[200:203], v[232:235], v[136:139], v[200:203]
    v_mfma_f32_16x16x32_bf16 v[204:207], v[232:235], v[140:143], v[204:207]
    s_barrier
    ds_read_b128 v[224:227], v4 offset:32768
    s_waitcnt lgkmcnt(3)
    v_mfma_f32_16x16x32_bf16 v[208:211], v[236:239], v[136:139], v[208:211]
    v_mfma_f32_16x16x32_bf16 v[212:215], v[236:239], v[140:143], v[212:215]
    s_add_u32 s22, s24, 0x0
    s_add_u32 m0, s20, 0x10000
    s_nop 0
    buffer_load_dwordx4 v3, s[4:7], s22 offen lds
    ds_read_b128 v[228:231], v4 offset:33792
    s_waitcnt lgkmcnt(3)
    v_mfma_f32_16x16x32_bf16 v[200:203], v[240:243], v[144:147], v[200:203]
    v_mfma_f32_16x16x32_bf16 v[204:207], v[240:243], v[148:151], v[204:207]
    ds_read_b128 v[232:235], v4 offset:34816
    s_waitcnt lgkmcnt(3)
    v_mfma_f32_16x16x32_bf16 v[208:211], v[244:247], v[144:147], v[208:211]
    v_mfma_f32_16x16x32_bf16 v[212:215], v[244:247], v[148:151], v[212:215]
    ds_read_b128 v[236:239], v4 offset:35840
    s_waitcnt lgkmcnt(3)
    v_mfma_f32_16x16x32_bf16 v[184:187], v[224:227], v[24:27], 0
    v_mfma_f32_16x16x32_bf16 v[188:191], v[224:227], v[28:31], 0
    ds_read_b128 v[240:243], v4 offset:36864
    s_waitcnt lgkmcnt(3)
    v_mfma_f32_16x16x32_bf16 v[192:195], v[228:231], v[24:27], 0
    v_mfma_f32_16x16x32_bf16 v[196:199], v[228:231], v[28:31], 0
    s_add_u32 s22, s24, 0x2000
    s_add_u32 m0, s20, 0x10400
    s_nop 0
    buffer_load_dwordx4 v3, s[4:7], s22 offen lds
    ds_read_b128 v[244:247], v4 offset:37888
    v_mul_f32 v200, v200, v9
    s_waitcnt lgkmcnt(3)
    v_mfma_f32_16x16x32_bf16 v[184:187], v[232:235], v[32:35], v[184:187]
    v_mul_f32 v201, v201, v9
    v_mfma_f32_16x16x32_bf16 v[188:191], v[232:235], v[36:39], v[188:191]
    ds_read_b128 v[224:227], v4 offset:38912
    v_mul_f32 v202, v202, v9
    s_waitcnt lgkmcnt(3)
    v_mfma_f32_16x16x32_bf16 v[192:195], v[236:239], v[32:35], v[192:195]
    v_mul_f32 v203, v203, v9
    s_waitcnt vmcnt(2)
    v_add_f32 v249, v249, v254
    v_mov_b32 v250, v249
    s_nop 1
    v_permlane16_swap_b32 v249, v250
    v_add_f32 v249, v249, v250
    v_mov_b32 v250, v249
    s_nop 1
    v_permlane32_swap_b32 v249, v250
    v_add_f32 v249, v249, v250
    v_cvt_pk_bf16_f32 v249, v249, v249
    v_lshlrev_b32 v249, 16, v249
    s_lshr_b32 s14, s2, 6
    s_cmp_eq_u32 s14, 2
    s_cselect_b32 s14, 1.0, 0
    v_add_f32 v249, s14, v249
    v_cvt_pk_bf16_f32 v249, v249, v249
    v_lshlrev_b32 v253, 1, v253
    s_lshl_b32 s14, s2, 5
    s_add_u32 s14, s14, 0x540000
    s_cmp_eq_u32 s3, 0
    s_cselect_b32 s14, s14, 0x7ffffff0
    s_mov_b64 exec, 0xffff
    buffer_store_short v249, v253, s[8:11], s14 offen sc1
    s_mov_b64 exec, -1
    v_mfma_f32_16x16x32_bf16 v[196:199], v[236:239], v[36:39], v[196:199]
    ds_read_b128 v[228:231], v4 offset:39936
    v_mul_f32 v208, v208, v9
    s_waitcnt lgkmcnt(3)
    v_mfma_f32_16x16x32_bf16 v[184:187], v[240:243], v[40:43], v[184:187]
    v_mul_f32 v209, v209, v9
    v_mfma_f32_16x16x32_bf16 v[188:191], v[240:243], v[44:47], v[188:191]
    ds_read_b128 v[232:235], v4 offset:40960
    v_mul_f32 v210, v210, v9
    s_waitcnt lgkmcnt(3)
    v_mfma_f32_16x16x32_bf16 v[192:195], v[244:247], v[40:43], v[192:195]
    v_mul_f32 v211, v211, v9
    v_mfma_f32_16x16x32_bf16 v[196:199], v[244:247], v[44:47], v[196:199]
    ds_read_b128 v[236:239], v4 offset:41984
    v_cvt_pk_bf16_f32 v216, v200, v201
    s_waitcnt lgkmcnt(3)
    v_mfma_f32_16x16x32_bf16 v[184:187], v[224:227], v[48:51], v[184:187]
    v_cvt_pk_bf16_f32 v217, v202, v203
    s_add_u32 s16, s63, 0x570000
    v_mov_b32 v7, s28
    v_mov_b32 v8, 0
    s_mov_b64 exec, 1
    buffer_store_dword v7, v8, s[8:11], s16 offen sc1
    s_mov_b64 exec, -1
    v_mfma_f32_16x16x32_bf16 v[188:191], v[224:227], v[52:55], v[188:191]
    ds_read_b128 v[240:243], v4 offset:43008
    v_cvt_pk_bf16_f32 v218, v208, v209
    s_waitcnt lgkmcnt(3)
    v_mfma_f32_16x16x32_bf16 v[192:195], v[228:231], v[48:51], v[192:195]
    v_cvt_pk_bf16_f32 v219, v210, v211
    v_mfma_f32_16x16x32_bf16 v[196:199], v[228:231], v[52:55], v[196:199]
    ds_read_b128 v[244:247], v4 offset:44032
    buffer_store_dwordx4 v[216:219], v2, s[8:11], s25 offen offset:1024 sc1
    s_waitcnt lgkmcnt(3)
    v_mfma_f32_16x16x32_bf16 v[184:187], v[232:235], v[56:59], v[184:187]
    v_mul_f32 v204, v204, v10
    v_mfma_f32_16x16x32_bf16 v[188:191], v[232:235], v[60:63], v[188:191]
    ds_read_b128 v[224:227], v4 offset:45056
    v_mul_f32 v205, v205, v10
    s_waitcnt lgkmcnt(3)
    v_mfma_f32_16x16x32_bf16 v[192:195], v[236:239], v[56:59], v[192:195]
    v_mul_f32 v206, v206, v10
    v_mfma_f32_16x16x32_bf16 v[196:199], v[236:239], v[60:63], v[196:199]
    ds_read_b128 v[228:231], v4 offset:46080
    v_mul_f32 v207, v207, v10
    s_waitcnt lgkmcnt(3)
    v_mfma_f32_16x16x32_bf16 v[184:187], v[240:243], v[64:67], v[184:187]
    v_mul_f32 v212, v212, v10
    v_mfma_f32_16x16x32_bf16 v[188:191], v[240:243], v[68:71], v[188:191]
    ds_read_b128 v[232:235], v4 offset:47104
    v_mul_f32 v213, v213, v10
    s_waitcnt lgkmcnt(3)
    v_mfma_f32_16x16x32_bf16 v[192:195], v[244:247], v[64:67], v[192:195]
    v_mul_f32 v214, v214, v10
    v_mfma_f32_16x16x32_bf16 v[196:199], v[244:247], v[68:71], v[196:199]
    ds_read_b128 v[236:239], v4 offset:48128
    v_mul_f32 v215, v215, v10
    s_waitcnt lgkmcnt(3)
    v_mfma_f32_16x16x32_bf16 v[184:187], v[224:227], v[72:75], v[184:187]
    v_cvt_pk_bf16_f32 v220, v204, v205
    v_mfma_f32_16x16x32_bf16 v[188:191], v[224:227], v[76:79], v[188:191]
    s_barrier
    ds_read_b128 v[240:243], v4 offset:49152
    v_cvt_pk_bf16_f32 v221, v206, v207
    s_waitcnt lgkmcnt(3)
    v_mfma_f32_16x16x32_bf16 v[192:195], v[228:231], v[72:75], v[192:195]
    v_cvt_pk_bf16_f32 v222, v212, v213
    v_mfma_f32_16x16x32_bf16 v[196:199], v[228:231], v[76:79], v[196:199]
    s_add_u32 s22, s24, 0x80000
    s_add_u32 m0, s20, 0x14000
    s_nop 0
    buffer_load_dwordx4 v3, s[4:7], s22 offen lds
    ds_read_b128 v[244:247], v4 offset:50176
    v_cvt_pk_bf16_f32 v223, v214, v215
    s_waitcnt lgkmcnt(3)
    v_mfma_f32_16x16x32_bf16 v[184:187], v[232:235], v[80:83], v[184:187]
    buffer_store_dwordx4 v[220:223], v2, s[8:11], s26 offen offset:1024 sc1
    v_mfma_f32_16x16x32_bf16 v[188:191], v[232:235], v[84:87], v[188:191]
    ds_read_b128 v[224:227], v4 offset:51200
    s_waitcnt lgkmcnt(3)
    v_mfma_f32_16x16x32_bf16 v[192:195], v[236:239], v[80:83], v[192:195]
    v_mfma_f32_16x16x32_bf16 v[196:199], v[236:239], v[84:87], v[196:199]
    ds_read_b128 v[228:231], v4 offset:52224
    s_waitcnt lgkmcnt(3)
    v_mfma_f32_16x16x32_bf16 v[184:187], v[240:243], v[88:91], v[184:187]
    v_mfma_f32_16x16x32_bf16 v[188:191], v[240:243], v[92:95], v[188:191]
    ds_read_b128 v[232:235], v4 offset:53248
    s_waitcnt lgkmcnt(3)
    v_mfma_f32_16x16x32_bf16 v[192:195], v[244:247], v[88:91], v[192:195]
    v_mfma_f32_16x16x32_bf16 v[196:199], v[244:247], v[92:95], v[196:199]
    s_add_u32 s22, s24, 0x82000
    s_add_u32 m0, s20, 0x14400
    s_nop 0
    buffer_load_dwordx4 v3, s[4:7], s22 offen lds
    ds_read_b128 v[236:239], v4 offset:54272
    s_waitcnt lgkmcnt(3)
    v_mfma_f32_16x16x32_bf16 v[184:187], v[224:227], v[96:99], v[184:187]
    v_mfma_f32_16x16x32_bf16 v[188:191], v[224:227], v[100:103], v[188:191]
    ds_read_b128 v[240:243], v4 offset:55296
    s_waitcnt lgkmcnt(3)
    v_mfma_f32_16x16x32_bf16 v[192:195], v[228:231], v[96:99], v[192:195]
    v_mfma_f32_16x16x32_bf16 v[196:199], v[228:231], v[100:103], v[196:199]
    ds_read_b128 v[244:247], v4 offset:56320
    s_waitcnt lgkmcnt(3)
    v_mfma_f32_16x16x32_bf16 v[184:187], v[232:235], v[104:107], v[184:187]
    v_mfma_f32_16x16x32_bf16 v[188:191], v[232:235], v[108:111], v[188:191]
    ds_read_b128 v[224:227], v4 offset:57344
    s_waitcnt lgkmcnt(3)
    v_mfma_f32_16x16x32_bf16 v[192:195], v[236:239], v[104:107], v[192:195]
    v_mfma_f32_16x16x32_bf16 v[196:199], v[236:239], v[108:111], v[196:199]
    ds_read_b128 v[228:231], v4 offset:58368
    s_waitcnt lgkmcnt(3)
    v_mfma_f32_16x16x32_bf16 v[184:187], v[240:243], v[112:115], v[184:187]
    v_mfma_f32_16x16x32_bf16 v[188:191], v[240:243], v[116:119], v[188:191]
    ds_read_b128 v[232:235], v4 offset:59392
    s_waitcnt lgkmcnt(3)
    v_mfma_f32_16x16x32_bf16 v[192:195], v[244:247], v[112:115], v[192:195]
    s_waitcnt vmcnt(5)
    v_mov_b32 v248, s28
    v_mov_b32 v249, 0
    s_lshl_b32 s14, s2, 2
    s_add_u32 s14, s14, 0x544000
    s_cmp_eq_u32 s3, 0
    s_cselect_b32 s14, s14, 0x7ffffff0
    s_mov_b64 exec, 1
    buffer_store_dword v248, v249, s[8:11], s14 offen sc1
    s_mov_b64 exec, -1
    v_mfma_f32_16x16x32_bf16 v[196:199], v[244:247], v[116:119], v[196:199]
    ds_read_b128 v[236:239], v4 offset:60416
    s_waitcnt lgkmcnt(3)
    v_mfma_f32_16x16x32_bf16 v[184:187], v[224:227], v[120:123], v[184:187]
    v_mfma_f32_16x16x32_bf16 v[188:191], v[224:227], v[124:127], v[188:191]
    ds_read_b128 v[240:243], v4 offset:61440
    s_waitcnt lgkmcnt(3)
    v_mfma_f32_16x16x32_bf16 v[192:195], v[228:231], v[120:123], v[192:195]
    v_mfma_f32_16x16x32_bf16 v[196:199], v[228:231], v[124:127], v[196:199]
    ds_read_b128 v[244:247], v4 offset:62464
    s_waitcnt lgkmcnt(3)
    v_mfma_f32_16x16x32_bf16 v[184:187], v[232:235], v[128:131], v[184:187]
    v_mfma_f32_16x16x32_bf16 v[188:191], v[232:235], v[132:135], v[188:191]
    ds_read_b128 v[224:227], v4 offset:63488
    s_waitcnt lgkmcnt(3)
    v_mfma_f32_16x16x32_bf16 v[192:195], v[236:239], v[128:131], v[192:195]
    v_mfma_f32_16x16x32_bf16 v[196:199], v[236:239], v[132:135], v[196:199]
    ds_read_b128 v[228:231], v4 offset:64512
    s_waitcnt lgkmcnt(3)
    v_mfma_f32_16x16x32_bf16 v[184:187], v[240:243], v[136:139], v[184:187]
    v_mfma_f32_16x16x32_bf16 v[188:191], v[240:243], v[140:143], v[188:191]
    s_barrier
    ds_read_b128 v[232:235], v5 offset:0
    s_waitcnt lgkmcnt(3)
    v_mfma_f32_16x16x32_bf16 v[192:195], v[244:247], v[136:139], v[192:195]
    v_mfma_f32_16x16x32_bf16 v[196:199], v[244:247], v[140:143], v[196:199]
    s_add_u32 s22, s24, 0x100000
    s_add_u32 m0, s20, 0x18000
    s_nop 0
    buffer_load_dwordx4 v3, s[4:7], s22 offen lds
    ds_read_b128 v[236:239], v5 offset:1024
    s_waitcnt lgkmcnt(3)
    v_mfma_f32_16x16x32_bf16 v[184:187], v[224:227], v[144:147], v[184:187]
    v_mfma_f32_16x16x32_bf16 v[188:191], v[224:227], v[148:151], v[188:191]
    ds_read_b128 v[240:243], v5 offset:2048
    s_waitcnt lgkmcnt(3)
    v_mfma_f32_16x16x32_bf16 v[192:195], v[228:231], v[144:147], v[192:195]
    v_mfma_f32_16x16x32_bf16 v[196:199], v[228:231], v[148:151], v[196:199]
    ds_read_b128 v[244:247], v5 offset:3072
    s_waitcnt lgkmcnt(3)
    v_mfma_f32_16x16x32_bf16 v[200:203], v[232:235], v[24:27], 0
    v_mfma_f32_16x16x32_bf16 v[204:207], v[232:235], v[28:31], 0
    ds_read_b128 v[224:227], v5 offset:4096
    s_waitcnt lgkmcnt(3)
    v_mfma_f32_16x16x32_bf16 v[208:211], v[236:239], v[24:27], 0
    v_mfma_f32_16x16x32_bf16 v[212:215], v[236:239], v[28:31], 0
    s_add_u32 s22, s24, 0x102000
    s_add_u32 m0, s20, 0x18400
    s_nop 0
    buffer_load_dwordx4 v3, s[4:7], s22 offen lds
    ds_read_b128 v[228:231], v5 offset:5120
    v_mul_f32 v184, v184, v9
    s_waitcnt lgkmcnt(3)
    v_mfma_f32_16x16x32_bf16 v[200:203], v[240:243], v[32:35], v[200:203]
    v_mul_f32 v185, v185, v9
    s_bfe_u32 s30, s2, 0x20001
    s_lshl_b32 s30, s30, 2
    s_bfe_u32 s17, s2, 0x20003
    s_add_u32 s30, s30, s17
    s_lshr_b32 s31, s2, 5
    s_and_b32 s17, s3, 3
    s_lshl_b32 s19, s30, 2
    s_add_u32 s19, s19, s17
    s_and_b32 s16, s2, 1
    s_lshl_b32 s17, s19, 18
    s_lshl_b32 s23, s16, 16
    s_add_u32 s17, s17, s23
    s_add_u32 s17, s17, 0x1000000
    v_add_u32 v6, s17, v2
    s_lshl_b32 s19, s19, 7
    s_lshl_b32 s23, s16, 6
    s_add_u32 s19, s19, s23
    s_add_u32 s19, s19, 0x570000
    v_and_b32 v13, 15, v1
    v_lshlrev_b32 v13, 2, v13
    buffer_load_dword v12, v13, s[8:11], s19 offen sc1
    v_mfma_f32_16x16x32_bf16 v[204:207], v[240:243], v[36:39], v[204:207]
    ds_read_b128 v[232:235], v5 offset:6144
    v_mul_f32 v186, v186, v9
    s_waitcnt lgkmcnt(3)
    v_mfma_f32_16x16x32_bf16 v[208:211], v[244:247], v[32:35], v[208:211]
    v_mul_f32 v187, v187, v9
    v_mfma_f32_16x16x32_bf16 v[212:215], v[244:247], v[36:39], v[212:215]
    ds_read_b128 v[236:239], v5 offset:7168
    v_mul_f32 v192, v192, v9
    s_waitcnt lgkmcnt(3)
    v_mfma_f32_16x16x32_bf16 v[200:203], v[224:227], v[40:43], v[200:203]
    v_mul_f32 v193, v193, v9
    v_mfma_f32_16x16x32_bf16 v[204:207], v[224:227], v[44:47], v[204:207]
    ds_read_b128 v[240:243], v5 offset:8192
    v_mul_f32 v194, v194, v9
    s_waitcnt lgkmcnt(3)
    v_mfma_f32_16x16x32_bf16 v[208:211], v[228:231], v[40:43], v[208:211]
    v_mul_f32 v195, v195, v9
    v_mfma_f32_16x16x32_bf16 v[212:215], v[228:231], v[44:47], v[212:215]
    ds_read_b128 v[244:247], v5 offset:9216
    v_cvt_pk_bf16_f32 v216, v184, v185
    s_waitcnt lgkmcnt(3)
    v_mfma_f32_16x16x32_bf16 v[200:203], v[232:235], v[48:51], v[200:203]
    v_cvt_pk_bf16_f32 v217, v186, v187
    v_mfma_f32_16x16x32_bf16 v[204:207], v[232:235], v[52:55], v[204:207]
    ds_read_b128 v[224:227], v5 offset:10240
    v_cvt_pk_bf16_f32 v218, v192, v193
    s_waitcnt lgkmcnt(3)
    v_mfma_f32_16x16x32_bf16 v[208:211], v[236:239], v[48:51], v[208:211]
    v_cvt_pk_bf16_f32 v219, v194, v195
    v_mfma_f32_16x16x32_bf16 v[212:215], v[236:239], v[52:55], v[212:215]
    ds_read_b128 v[228:231], v5 offset:11264
    buffer_store_dwordx4 v[216:219], v2, s[8:11], s25 offen offset:2048 sc1
    s_waitcnt lgkmcnt(3)
    v_mfma_f32_16x16x32_bf16 v[200:203], v[240:243], v[56:59], v[200:203]
    v_mul_f32 v188, v188, v10
    v_mfma_f32_16x16x32_bf16 v[204:207], v[240:243], v[60:63], v[204:207]
    ds_read_b128 v[232:235], v5 offset:12288
    v_mul_f32 v189, v189, v10
    s_waitcnt lgkmcnt(3)
    v_mfma_f32_16x16x32_bf16 v[208:211], v[244:247], v[56:59], v[208:211]
    v_mul_f32 v190, v190, v10
    v_mfma_f32_16x16x32_bf16 v[212:215], v[244:247], v[60:63], v[212:215]
    ds_read_b128 v[236:239], v5 offset:13312
    v_mul_f32 v191, v191, v10
    s_waitcnt lgkmcnt(3)
    v_mfma_f32_16x16x32_bf16 v[200:203], v[224:227], v[64:67], v[200:203]
    v_mul_f32 v196, v196, v10
    v_mfma_f32_16x16x32_bf16 v[204:207], v[224:227], v[68:71], v[204:207]
    ds_read_b128 v[240:243], v5 offset:14336
    v_mul_f32 v197, v197, v10
    s_waitcnt lgkmcnt(3)
    v_mfma_f32_16x16x32_bf16 v[208:211], v[228:231], v[64:67], v[208:211]
    v_mul_f32 v198, v198, v10
    v_mfma_f32_16x16x32_bf16 v[212:215], v[228:231], v[68:71], v[212:215]
    ds_read_b128 v[244:247], v5 offset:15360
    v_mul_f32 v199, v199, v10
    s_waitcnt lgkmcnt(3)
    v_mfma_f32_16x16x32_bf16 v[200:203], v[232:235], v[72:75], v[200:203]
    v_cvt_pk_bf16_f32 v220, v188, v189
    v_mfma_f32_16x16x32_bf16 v[204:207], v[232:235], v[76:79], v[204:207]
    s_barrier
    ds_read_b128 v[224:227], v5 offset:16384
    v_cvt_pk_bf16_f32 v221, v190, v191
    s_waitcnt lgkmcnt(3)
    v_mfma_f32_16x16x32_bf16 v[208:211], v[236:239], v[72:75], v[208:211]
    v_cvt_pk_bf16_f32 v222, v196, v197
    v_mfma_f32_16x16x32_bf16 v[212:215], v[236:239], v[76:79], v[212:215]
    s_add_u32 s22, s24, 0x180000
    s_add_u32 m0, s20, 0x1c000
    s_nop 0
    buffer_load_dwordx4 v3, s[4:7], s22 offen lds
    ds_read_b128 v[228:231], v5 offset:17408
    v_cvt_pk_bf16_f32 v223, v198, v199
    s_waitcnt lgkmcnt(3)
    v_mfma_f32_16x16x32_bf16 v[200:203], v[240:243], v[80:83], v[200:203]
    buffer_store_dwordx4 v[220:223], v2, s[8:11], s26 offen offset:2048 sc1
    v_mfma_f32_16x16x32_bf16 v[204:207], v[240:243], v[84:87], v[204:207]
    ds_read_b128 v[232:235], v5 offset:18432
    s_waitcnt lgkmcnt(3)
    v_mfma_f32_16x16x32_bf16 v[208:211], v[244:247], v[80:83], v[208:211]
    v_mfma_f32_16x16x32_bf16 v[212:215], v[244:247], v[84:87], v[212:215]
    ds_read_b128 v[236:239], v5 offset:19456
    s_waitcnt lgkmcnt(3)
    v_mfma_f32_16x16x32_bf16 v[200:203], v[224:227], v[88:91], v[200:203]
    v_mfma_f32_16x16x32_bf16 v[204:207], v[224:227], v[92:95], v[204:207]
    ds_read_b128 v[240:243], v5 offset:20480
    s_waitcnt vmcnt(3)
    v_cmp_ne_u32 vcc, s28, v12
    s_cbranch_vccnz adaLN_cond__sliding_block_cached__moe_arch_mod__prompt_kernel_o6r
adaLN_cond__sliding_block_cached__moe_arch_mod__prompt_kernel_o6b:
    s_waitcnt lgkmcnt(3)
    v_mfma_f32_16x16x32_bf16 v[208:211], v[228:231], v[88:91], v[208:211]
    s_mov_b32 s23, 0x0
    buffer_load_dwordx4 v[24:27], v6, s[8:11], s23 offen offset:0 sc1
    v_mfma_f32_16x16x32_bf16 v[212:215], v[228:231], v[92:95], v[212:215]
    s_add_u32 s22, s24, 0x182000
    s_add_u32 m0, s20, 0x1c400
    s_nop 0
    buffer_load_dwordx4 v3, s[4:7], s22 offen lds
    ds_read_b128 v[244:247], v5 offset:21504
    s_waitcnt lgkmcnt(3)
    v_mfma_f32_16x16x32_bf16 v[200:203], v[232:235], v[96:99], v[200:203]
    v_mfma_f32_16x16x32_bf16 v[204:207], v[232:235], v[100:103], v[204:207]
    ds_read_b128 v[224:227], v5 offset:22528
    s_mov_b32 s23, 0x20000
    buffer_load_dwordx4 v[28:31], v6, s[8:11], s23 offen offset:0 sc1
    s_waitcnt lgkmcnt(3)
    v_mfma_f32_16x16x32_bf16 v[208:211], v[236:239], v[96:99], v[208:211]
    s_add_u32 s16, s63, 0x572000
    v_mov_b32 v14, s28
    v_mov_b32 v15, 0
    s_mov_b64 exec, 1
    buffer_store_dword v14, v15, s[8:11], s16 offen sc1
    s_mov_b64 exec, -1
    v_mfma_f32_16x16x32_bf16 v[212:215], v[236:239], v[100:103], v[212:215]
    ds_read_b128 v[228:231], v5 offset:23552
    s_waitcnt lgkmcnt(3)
    v_mfma_f32_16x16x32_bf16 v[200:203], v[240:243], v[104:107], v[200:203]
    s_mov_b32 s23, 0x2000
    buffer_load_dwordx4 v[32:35], v6, s[8:11], s23 offen offset:0 sc1
    v_mfma_f32_16x16x32_bf16 v[204:207], v[240:243], v[108:111], v[204:207]
    ds_read_b128 v[232:235], v5 offset:24576
    s_waitcnt lgkmcnt(3)
    v_mfma_f32_16x16x32_bf16 v[208:211], v[244:247], v[104:107], v[208:211]
    v_mfma_f32_16x16x32_bf16 v[212:215], v[244:247], v[108:111], v[212:215]
    ds_read_b128 v[236:239], v5 offset:25600
    s_mov_b32 s23, 0x22000
    buffer_load_dwordx4 v[36:39], v6, s[8:11], s23 offen offset:0 sc1
    s_waitcnt lgkmcnt(3)
    v_mfma_f32_16x16x32_bf16 v[200:203], v[224:227], v[112:115], v[200:203]
    v_mfma_f32_16x16x32_bf16 v[204:207], v[224:227], v[116:119], v[204:207]
    ds_read_b128 v[240:243], v5 offset:26624
    s_waitcnt lgkmcnt(3)
    v_mfma_f32_16x16x32_bf16 v[208:211], v[228:231], v[112:115], v[208:211]
    s_mov_b32 s23, 0x4000
    buffer_load_dwordx4 v[40:43], v6, s[8:11], s23 offen offset:0 sc1
    v_mfma_f32_16x16x32_bf16 v[212:215], v[228:231], v[116:119], v[212:215]
    ds_read_b128 v[244:247], v5 offset:27648
    s_waitcnt lgkmcnt(3)
    v_mfma_f32_16x16x32_bf16 v[200:203], v[232:235], v[120:123], v[200:203]
    v_mfma_f32_16x16x32_bf16 v[204:207], v[232:235], v[124:127], v[204:207]
    ds_read_b128 v[224:227], v5 offset:28672
    s_mov_b32 s23, 0x24000
    buffer_load_dwordx4 v[44:47], v6, s[8:11], s23 offen offset:0 sc1
    s_waitcnt lgkmcnt(3)
    v_mfma_f32_16x16x32_bf16 v[208:211], v[236:239], v[120:123], v[208:211]
    v_mfma_f32_16x16x32_bf16 v[212:215], v[236:239], v[124:127], v[212:215]
    ds_read_b128 v[228:231], v5 offset:29696
    s_waitcnt lgkmcnt(3)
    v_mfma_f32_16x16x32_bf16 v[200:203], v[240:243], v[128:131], v[200:203]
    s_mov_b32 s23, 0x6000
    buffer_load_dwordx4 v[48:51], v6, s[8:11], s23 offen offset:0 sc1
    v_mfma_f32_16x16x32_bf16 v[204:207], v[240:243], v[132:135], v[204:207]
    ds_read_b128 v[232:235], v5 offset:30720
    s_waitcnt lgkmcnt(3)
    v_mfma_f32_16x16x32_bf16 v[208:211], v[244:247], v[128:131], v[208:211]
    v_mfma_f32_16x16x32_bf16 v[212:215], v[244:247], v[132:135], v[212:215]
    ds_read_b128 v[236:239], v5 offset:31744
    s_mov_b32 s23, 0x26000
    buffer_load_dwordx4 v[52:55], v6, s[8:11], s23 offen offset:0 sc1
    s_waitcnt lgkmcnt(3)
    v_mfma_f32_16x16x32_bf16 v[200:203], v[224:227], v[136:139], v[200:203]
    v_bfe_u32 v18, v1, 2, 2
    v_lshrrev_b32 v19, 4, v1
    v_mfma_f32_16x16x32_bf16 v[204:207], v[224:227], v[140:143], v[204:207]
    v_and_b32 v17, 3, v1
    v_lshlrev_b32 v16, 11, v19
    s_waitcnt lgkmcnt(2)
    v_mfma_f32_16x16x32_bf16 v[208:211], v[228:231], v[136:139], v[208:211]
    v_lshl_add_u32 v16, v18, 6, v16
    v_lshl_add_u32 v16, v17, 3, v16
    v_mfma_f32_16x16x32_bf16 v[212:215], v[228:231], v[140:143], v[212:215]
    v_add_u32 v16, 0x10000, v16
    v_and_b32 v19, 1, v19
    s_waitcnt lgkmcnt(1)
    v_mfma_f32_16x16x32_bf16 v[200:203], v[232:235], v[144:147], v[200:203]
    v_lshlrev_b32 v19, 5, v19
    v_sub_u32 v5, v16, v19
    v_mfma_f32_16x16x32_bf16 v[204:207], v[232:235], v[148:151], v[204:207]
    v_add_u32 v4, v16, v19
    v_add_u32 v7, 0x10000, v4
    s_waitcnt lgkmcnt(0)
    v_mfma_f32_16x16x32_bf16 v[208:211], v[236:239], v[144:147], v[208:211]
    v_add_u32 v8, 0x10000, v5
    v_mfma_f32_16x16x32_bf16 v[212:215], v[236:239], v[148:151], v[212:215]
    v_mul_f32 v200, v200, v9
    v_mul_f32 v201, v201, v9
    v_mul_f32 v202, v202, v9
    v_mul_f32 v203, v203, v9
    s_nop 1
    v_mul_f32 v208, v208, v9
    v_mul_f32 v209, v209, v9
    v_mul_f32 v210, v210, v9
    v_mul_f32 v211, v211, v9
    v_cvt_pk_bf16_f32 v216, v200, v201
    v_cvt_pk_bf16_f32 v217, v202, v203
    v_cvt_pk_bf16_f32 v218, v208, v209
    v_cvt_pk_bf16_f32 v219, v210, v211
    buffer_store_dwordx4 v[216:219], v2, s[8:11], s25 offen offset:3072 sc1
    v_mul_f32 v204, v204, v10
    v_mul_f32 v205, v205, v10
    v_mul_f32 v206, v206, v10
    v_mul_f32 v207, v207, v10
    v_mul_f32 v212, v212, v10
    v_mul_f32 v213, v213, v10
    v_mul_f32 v214, v214, v10
    v_mul_f32 v215, v215, v10
    v_cvt_pk_bf16_f32 v220, v204, v205
    v_cvt_pk_bf16_f32 v221, v206, v207
    v_cvt_pk_bf16_f32 v222, v212, v213
    v_cvt_pk_bf16_f32 v223, v214, v215
    buffer_store_dwordx4 v[220:223], v2, s[8:11], s26 offen offset:3072 sc1
    s_and_b32 s15, s2, 1
    s_barrier
    ds_read_b64_tr_b16 v[224:225], v4 offset:0
    ds_read_b64_tr_b16 v[226:227], v4 offset:1024
    ds_read_b64_tr_b16 v[228:229], v5 offset:32
    ds_read_b64_tr_b16 v[230:231], v5 offset:1056
    ds_read_b64_tr_b16 v[232:233], v4 offset:256
    ds_read_b64_tr_b16 v[234:235], v4 offset:1280
    ds_read_b64_tr_b16 v[236:237], v5 offset:288
    ds_read_b64_tr_b16 v[238:239], v5 offset:1312
    s_waitcnt vmcnt(11) lgkmcnt(6)
    v_mfma_f32_16x16x32_bf16 v[88:91], v[224:227], v[24:27], 0
    ds_read_b64_tr_b16 v[240:241], v4 offset:512
    s_waitcnt vmcnt(9)
    v_mfma_f32_16x16x32_bf16 v[92:95], v[224:227], v[28:31], 0
    s_add_u32 s22, s24, 0x200000
    s_add_u32 m0, s20, 0x20000
    s_nop 0
    buffer_load_dwordx4 v3, s[4:7], s22 offen lds
    ds_read_b64_tr_b16 v[242:243], v4 offset:1536
    s_waitcnt lgkmcnt(6)
    v_mfma_f32_16x16x32_bf16 v[96:99], v[228:231], v[24:27], 0
    ds_read_b64_tr_b16 v[244:245], v5 offset:544
    s_mov_b32 s23, 0x8000
    buffer_load_dwordx4 v[56:59], v6, s[8:11], s23 offen offset:0 sc1
    v_mfma_f32_16x16x32_bf16 v[100:103], v[228:231], v[28:31], 0
    ds_read_b64_tr_b16 v[246:247], v5 offset:1568
    s_waitcnt lgkmcnt(6)
    v_mfma_f32_16x16x32_bf16 v[104:107], v[232:235], v[24:27], 0
    ds_read_b64_tr_b16 v[224:225], v4 offset:768
    v_mfma_f32_16x16x32_bf16 v[108:111], v[232:235], v[28:31], 0
    ds_read_b64_tr_b16 v[226:227], v4 offset:1792
    s_waitcnt lgkmcnt(6)
    v_mfma_f32_16x16x32_bf16 v[112:115], v[236:239], v[24:27], 0
    ds_read_b64_tr_b16 v[228:229], v5 offset:800
    v_mfma_f32_16x16x32_bf16 v[116:119], v[236:239], v[28:31], 0
    ds_read_b64_tr_b16 v[230:231], v5 offset:1824
    s_waitcnt lgkmcnt(6)
    v_mfma_f32_16x16x32_bf16 v[120:123], v[240:243], v[24:27], 0
    s_add_u32 s22, s24, 0x202000
    s_add_u32 m0, s20, 0x20400
    s_nop 0
    buffer_load_dwordx4 v3, s[4:7], s22 offen lds
    s_mov_b32 s23, 0x28000
    buffer_load_dwordx4 v[60:63], v6, s[8:11], s23 offen offset:0 sc1
    v_mfma_f32_16x16x32_bf16 v[124:127], v[240:243], v[28:31], 0
    s_barrier
    ds_read_b64_tr_b16 v[232:233], v4 offset:16384
    ds_read_b64_tr_b16 v[234:235], v4 offset:17408
    s_waitcnt lgkmcnt(6)
    v_mfma_f32_16x16x32_bf16 v[128:131], v[244:247], v[24:27], 0
    s_add_u32 s22, s24, 0x280000
    s_add_u32 m0, s20, 0x24000
    s_nop 0
    buffer_load_dwordx4 v3, s[4:7], s22 offen lds
    ds_read_b64_tr_b16 v[236:237], v5 offset:16416
    v_mfma_f32_16x16x32_bf16 v[132:135], v[244:247], v[28:31], 0
    ds_read_b64_tr_b16 v[238:239], v5 offset:17440
    s_waitcnt lgkmcnt(6)
    v_mfma_f32_16x16x32_bf16 v[136:139], v[224:227], v[24:27], 0
    ds_read_b64_tr_b16 v[240:241], v4 offset:16640
    v_mfma_f32_16x16x32_bf16 v[140:143], v[224:227], v[28:31], 0
    ds_read_b64_tr_b16 v[242:243], v4 offset:17664
    s_waitcnt lgkmcnt(6)
    v_mfma_f32_16x16x32_bf16 v[144:147], v[228:231], v[24:27], 0
    ds_read_b64_tr_b16 v[244:245], v5 offset:16672
    v_mfma_f32_16x16x32_bf16 v[148:151], v[228:231], v[28:31], 0
    ds_read_b64_tr_b16 v[246:247], v5 offset:17696
    s_waitcnt vmcnt(12) lgkmcnt(6)
    v_mfma_f32_16x16x32_bf16 v[88:91], v[232:235], v[32:35], v[88:91]
    ds_read_b64_tr_b16 v[224:225], v4 offset:16896
    s_waitcnt vmcnt(11)
    v_mfma_f32_16x16x32_bf16 v[92:95], v[232:235], v[36:39], v[92:95]
    s_add_u32 s22, s24, 0x282000
    s_add_u32 m0, s20, 0x24400
    s_nop 0
    buffer_load_dwordx4 v3, s[4:7], s22 offen lds
    ds_read_b64_tr_b16 v[226:227], v4 offset:17920
    s_waitcnt lgkmcnt(6)
    v_mfma_f32_16x16x32_bf16 v[96:99], v[236:239], v[32:35], v[96:99]
    ds_read_b64_tr_b16 v[228:229], v5 offset:16928
    s_mov_b32 s23, 0xa000
    buffer_load_dwordx4 v[24:27], v6, s[8:11], s23 offen offset:0 sc1
    v_mfma_f32_16x16x32_bf16 v[100:103], v[236:239], v[36:39], v[100:103]
    ds_read_b64_tr_b16 v[230:231], v5 offset:17952
    s_waitcnt lgkmcnt(6)
    v_mfma_f32_16x16x32_bf16 v[104:107], v[240:243], v[32:35], v[104:107]
    ds_read_b64_tr_b16 v[232:233], v4 offset:17152
    v_mfma_f32_16x16x32_bf16 v[108:111], v[240:243], v[36:39], v[108:111]
    ds_read_b64_tr_b16 v[234:235], v4 offset:18176
    s_waitcnt lgkmcnt(6)
    v_mfma_f32_16x16x32_bf16 v[112:115], v[244:247], v[32:35], v[112:115]
    ds_read_b64_tr_b16 v[236:237], v5 offset:17184
    v_mfma_f32_16x16x32_bf16 v[116:119], v[244:247], v[36:39], v[116:119]
    ds_read_b64_tr_b16 v[238:239], v5 offset:18208
    s_waitcnt lgkmcnt(6)
    v_mfma_f32_16x16x32_bf16 v[120:123], v[224:227], v[32:35], v[120:123]
    s_mov_b32 s23, 0x2a000
    buffer_load_dwordx4 v[28:31], v6, s[8:11], s23 offen offset:0 sc1
    v_mfma_f32_16x16x32_bf16 v[124:127], v[224:227], v[36:39], v[124:127]
    s_barrier
    ds_read_b64_tr_b16 v[240:241], v4 offset:32768
    ds_read_b64_tr_b16 v[242:243], v4 offset:33792
    s_waitcnt lgkmcnt(6)
    v_mfma_f32_16x16x32_bf16 v[128:131], v[228:231], v[32:35], v[128:131]
    s_add_u32 s22, s24, 0x300000
    s_add_u32 m0, s20, 0x10000
    s_nop 0
    buffer_load_dwordx4 v3, s[4:7], s22 offen lds
    ds_read_b64_tr_b16 v[244:245], v5 offset:32800
    v_mfma_f32_16x16x32_bf16 v[132:135], v[228:231], v[36:39], v[132:135]
    ds_read_b64_tr_b16 v[246:247], v5 offset:33824
    s_waitcnt lgkmcnt(6)
    v_mfma_f32_16x16x32_bf16 v[136:139], v[232:235], v[32:35], v[136:139]
    ds_read_b64_tr_b16 v[224:225], v4 offset:33024
    v_mfma_f32_16x16x32_bf16 v[140:143], v[232:235], v[36:39], v[140:143]
    ds_read_b64_tr_b16 v[226:227], v4 offset:34048
    s_waitcnt lgkmcnt(6)
    v_mfma_f32_16x16x32_bf16 v[144:147], v[236:239], v[32:35], v[144:147]
    s_add_u32 s16, s63, 0x574000
    v_mov_b32 v14, s28
    v_mov_b32 v15, 0
    s_mov_b64 exec, 1
    buffer_store_dword v14, v15, s[8:11], s16 offen sc1
    s_mov_b64 exec, -1
    ds_read_b64_tr_b16 v[228:229], v5 offset:33056
    v_mfma_f32_16x16x32_bf16 v[148:151], v[236:239], v[36:39], v[148:151]
    ds_read_b64_tr_b16 v[230:231], v5 offset:34080
    s_waitcnt vmcnt(15) lgkmcnt(6)
    v_mfma_f32_16x16x32_bf16 v[88:91], v[240:243], v[40:43], v[88:91]
    ds_read_b64_tr_b16 v[232:233], v4 offset:33280
    s_waitcnt vmcnt(14)
    v_mfma_f32_16x16x32_bf16 v[92:95], v[240:243], v[44:47], v[92:95]
    s_add_u32 s22, s24, 0x302000
    s_add_u32 m0, s20, 0x10400
    s_nop 0
    buffer_load_dwordx4 v3, s[4:7], s22 offen lds
    ds_read_b64_tr_b16 v[234:235], v4 offset:34304
    s_waitcnt lgkmcnt(6)
    v_mfma_f32_16x16x32_bf16 v[96:99], v[244:247], v[40:43], v[96:99]
    ds_read_b64_tr_b16 v[236:237], v5 offset:33312
    s_mov_b32 s23, 0xc000
    buffer_load_dwordx4 v[32:35], v6, s[8:11], s23 offen offset:0 sc1
    v_mfma_f32_16x16x32_bf16 v[100:103], v[244:247], v[44:47], v[100:103]
    ds_read_b64_tr_b16 v[238:239], v5 offset:34336
    s_waitcnt lgkmcnt(6)
    v_mfma_f32_16x16x32_bf16 v[104:107], v[224:227], v[40:43], v[104:107]
    ds_read_b64_tr_b16 v[240:241], v4 offset:33536
    v_mfma_f32_16x16x32_bf16 v[108:111], v[224:227], v[44:47], v[108:111]
    ds_read_b64_tr_b16 v[242:243], v4 offset:34560
    s_waitcnt lgkmcnt(6)
    v_mfma_f32_16x16x32_bf16 v[112:115], v[228:231], v[40:43], v[112:115]
    ds_read_b64_tr_b16 v[244:245], v5 offset:33568
    v_mfma_f32_16x16x32_bf16 v[116:119], v[228:231], v[44:47], v[116:119]
    ds_read_b64_tr_b16 v[246:247], v5 offset:34592
    s_waitcnt lgkmcnt(6)
    v_mfma_f32_16x16x32_bf16 v[120:123], v[232:235], v[40:43], v[120:123]
    s_mov_b32 s23, 0x2c000
    buffer_load_dwordx4 v[36:39], v6, s[8:11], s23 offen offset:0 sc1
    v_mfma_f32_16x16x32_bf16 v[124:127], v[232:235], v[44:47], v[124:127]
    s_barrier
    ds_read_b64_tr_b16 v[224:225], v4 offset:49152
    ds_read_b64_tr_b16 v[226:227], v4 offset:50176
    s_add_u32 s19, s19, 8192
    buffer_load_dword v12, v13, s[8:11], s19 offen sc1
    s_waitcnt lgkmcnt(6)
    v_mfma_f32_16x16x32_bf16 v[128:131], v[236:239], v[40:43], v[128:131]
    s_add_u32 s22, s24, 0x380000
    s_add_u32 m0, s20, 0x14000
    s_nop 0
    buffer_load_dwordx4 v3, s[4:7], s22 offen lds
    ds_read_b64_tr_b16 v[228:229], v5 offset:49184
    v_mfma_f32_16x16x32_bf16 v[132:135], v[236:239], v[44:47], v[132:135]
    ds_read_b64_tr_b16 v[230:231], v5 offset:50208
    s_waitcnt lgkmcnt(6)
    v_mfma_f32_16x16x32_bf16 v[136:139], v[240:243], v[40:43], v[136:139]
    ds_read_b64_tr_b16 v[232:233], v4 offset:49408
    v_mfma_f32_16x16x32_bf16 v[140:143], v[240:243], v[44:47], v[140:143]
    ds_read_b64_tr_b16 v[234:235], v4 offset:50432
    s_waitcnt lgkmcnt(6)
    v_mfma_f32_16x16x32_bf16 v[144:147], v[244:247], v[40:43], v[144:147]
    ds_read_b64_tr_b16 v[236:237], v5 offset:49440
    v_mfma_f32_16x16x32_bf16 v[148:151], v[244:247], v[44:47], v[148:151]
    ds_read_b64_tr_b16 v[238:239], v5 offset:50464
    s_waitcnt vmcnt(18) lgkmcnt(6)
    v_mfma_f32_16x16x32_bf16 v[88:91], v[224:227], v[48:51], v[88:91]
    ds_read_b64_tr_b16 v[240:241], v4 offset:49664
    s_waitcnt vmcnt(17)
    v_mfma_f32_16x16x32_bf16 v[92:95], v[224:227], v[52:55], v[92:95]
    s_add_u32 s22, s24, 0x382000
    s_add_u32 m0, s20, 0x14400
    s_nop 0
    buffer_load_dwordx4 v3, s[4:7], s22 offen lds
    ds_read_b64_tr_b16 v[242:243], v4 offset:50688
    s_waitcnt lgkmcnt(6)
    v_mfma_f32_16x16x32_bf16 v[96:99], v[228:231], v[48:51], v[96:99]
    ds_read_b64_tr_b16 v[244:245], v5 offset:49696
    s_mov_b32 s23, 0xe000
    buffer_load_dwordx4 v[40:43], v6, s[8:11], s23 offen offset:0 sc1
    v_mfma_f32_16x16x32_bf16 v[100:103], v[228:231], v[52:55], v[100:103]
    ds_read_b64_tr_b16 v[246:247], v5 offset:50720
    s_waitcnt lgkmcnt(6)
    v_mfma_f32_16x16x32_bf16 v[104:107], v[232:235], v[48:51], v[104:107]
    ds_read_b64_tr_b16 v[224:225], v4 offset:49920
    v_mfma_f32_16x16x32_bf16 v[108:111], v[232:235], v[52:55], v[108:111]
    ds_read_b64_tr_b16 v[226:227], v4 offset:50944
    s_waitcnt lgkmcnt(6)
    v_mfma_f32_16x16x32_bf16 v[112:115], v[236:239], v[48:51], v[112:115]
    ds_read_b64_tr_b16 v[228:229], v5 offset:49952
    v_mfma_f32_16x16x32_bf16 v[116:119], v[236:239], v[52:55], v[116:119]
    ds_read_b64_tr_b16 v[230:231], v5 offset:50976
    s_waitcnt lgkmcnt(6)
    v_mfma_f32_16x16x32_bf16 v[120:123], v[240:243], v[48:51], v[120:123]
    s_mov_b32 s23, 0x2e000
    buffer_load_dwordx4 v[44:47], v6, s[8:11], s23 offen offset:0 sc1
    v_mfma_f32_16x16x32_bf16 v[124:127], v[240:243], v[52:55], v[124:127]
    s_waitcnt vmcnt(15)
    s_barrier
    ds_read_b64_tr_b16 v[232:233], v7 offset:0
    ds_read_b64_tr_b16 v[234:235], v7 offset:1024
    s_waitcnt lgkmcnt(6)
    v_mfma_f32_16x16x32_bf16 v[128:131], v[244:247], v[48:51], v[128:131]
    s_add_u32 s22, s24, 0x10000
    s_add_u32 m0, s20, 0x18000
    s_nop 0
    buffer_load_dwordx4 v3, s[4:7], s22 offen lds
    ds_read_b64_tr_b16 v[236:237], v8 offset:32
    v_mfma_f32_16x16x32_bf16 v[132:135], v[244:247], v[52:55], v[132:135]
    ds_read_b64_tr_b16 v[238:239], v8 offset:1056
    s_waitcnt lgkmcnt(6)
    v_mfma_f32_16x16x32_bf16 v[136:139], v[224:227], v[48:51], v[136:139]
    ds_read_b64_tr_b16 v[240:241], v7 offset:256
    v_mfma_f32_16x16x32_bf16 v[140:143], v[224:227], v[52:55], v[140:143]
    ds_read_b64_tr_b16 v[242:243], v7 offset:1280
    s_waitcnt lgkmcnt(6)
    v_mfma_f32_16x16x32_bf16 v[144:147], v[228:231], v[48:51], v[144:147]
    ds_read_b64_tr_b16 v[244:245], v8 offset:288
    v_mfma_f32_16x16x32_bf16 v[148:151], v[228:231], v[52:55], v[148:151]
    ds_read_b64_tr_b16 v[246:247], v8 offset:1312
    s_waitcnt vmcnt(5)
    v_cmp_ne_u32 vcc, s28, v12
    s_cbranch_vccnz adaLN_cond__sliding_block_cached__moe_arch_mod__prompt_kernel_o27r
adaLN_cond__sliding_block_cached__moe_arch_mod__prompt_kernel_o27b:
    s_waitcnt lgkmcnt(6)
    v_mfma_f32_16x16x32_bf16 v[88:91], v[232:235], v[56:59], v[88:91]
    ds_read_b64_tr_b16 v[224:225], v7 offset:512
    v_mfma_f32_16x16x32_bf16 v[92:95], v[232:235], v[60:63], v[92:95]
    s_add_u32 s22, s24, 0x12000
    s_add_u32 m0, s20, 0x18400
    s_nop 0
    buffer_load_dwordx4 v3, s[4:7], s22 offen lds
    ds_read_b64_tr_b16 v[226:227], v7 offset:1536
    s_waitcnt lgkmcnt(6)
    v_mfma_f32_16x16x32_bf16 v[96:99], v[236:239], v[56:59], v[96:99]
    ds_read_b64_tr_b16 v[228:229], v8 offset:544
    s_mov_b32 s23, 0x0
    buffer_load_dwordx4 v[48:51], v6, s[8:11], s23 offen offset:1024 sc1
    v_mfma_f32_16x16x32_bf16 v[100:103], v[236:239], v[60:63], v[100:103]
    ds_read_b64_tr_b16 v[230:231], v8 offset:1568
    s_waitcnt lgkmcnt(6)
    v_mfma_f32_16x16x32_bf16 v[104:107], v[240:243], v[56:59], v[104:107]
    ds_read_b64_tr_b16 v[232:233], v7 offset:768
    v_mfma_f32_16x16x32_bf16 v[108:111], v[240:243], v[60:63], v[108:111]
    ds_read_b64_tr_b16 v[234:235], v7 offset:1792
    s_waitcnt lgkmcnt(6)
    v_mfma_f32_16x16x32_bf16 v[112:115], v[244:247], v[56:59], v[112:115]
    ds_read_b64_tr_b16 v[236:237], v8 offset:800
    v_mfma_f32_16x16x32_bf16 v[116:119], v[244:247], v[60:63], v[116:119]
    ds_read_b64_tr_b16 v[238:239], v8 offset:1824
    s_waitcnt lgkmcnt(6)
    v_mfma_f32_16x16x32_bf16 v[120:123], v[224:227], v[56:59], v[120:123]
    s_mov_b32 s23, 0x20000
    buffer_load_dwordx4 v[52:55], v6, s[8:11], s23 offen offset:1024 sc1
    v_mfma_f32_16x16x32_bf16 v[124:127], v[224:227], v[60:63], v[124:127]
    s_barrier
    ds_read_b64_tr_b16 v[240:241], v7 offset:16384
    ds_read_b64_tr_b16 v[242:243], v7 offset:17408
    s_waitcnt lgkmcnt(6)
    v_mfma_f32_16x16x32_bf16 v[128:131], v[228:231], v[56:59], v[128:131]
    s_add_u32 s22, s24, 0x90000
    s_add_u32 m0, s20, 0x1c000
    s_nop 0
    buffer_load_dwordx4 v3, s[4:7], s22 offen lds
    ds_read_b64_tr_b16 v[244:245], v8 offset:16416
    v_mfma_f32_16x16x32_bf16 v[132:135], v[228:231], v[60:63], v[132:135]
    ds_read_b64_tr_b16 v[246:247], v8 offset:17440
    s_waitcnt lgkmcnt(6)
    v_mfma_f32_16x16x32_bf16 v[136:139], v[232:235], v[56:59], v[136:139]
    ds_read_b64_tr_b16 v[224:225], v7 offset:16640
    v_mfma_f32_16x16x32_bf16 v[140:143], v[232:235], v[60:63], v[140:143]
    ds_read_b64_tr_b16 v[226:227], v7 offset:17664
    s_waitcnt lgkmcnt(6)
    v_mfma_f32_16x16x32_bf16 v[144:147], v[236:239], v[56:59], v[144:147]
    ds_read_b64_tr_b16 v[228:229], v8 offset:16672
    v_mfma_f32_16x16x32_bf16 v[148:151], v[236:239], v[60:63], v[148:151]
    ds_read_b64_tr_b16 v[230:231], v8 offset:17696
    s_waitcnt lgkmcnt(6)
    v_mfma_f32_16x16x32_bf16 v[88:91], v[240:243], v[24:27], v[88:91]
    ds_read_b64_tr_b16 v[232:233], v7 offset:16896
    v_mfma_f32_16x16x32_bf16 v[92:95], v[240:243], v[28:31], v[92:95]
    s_add_u32 s22, s24, 0x92000
    s_add_u32 m0, s20, 0x1c400
    s_nop 0
    buffer_load_dwordx4 v3, s[4:7], s22 offen lds
    ds_read_b64_tr_b16 v[234:235], v7 offset:17920
    s_waitcnt lgkmcnt(6)
    v_mfma_f32_16x16x32_bf16 v[96:99], v[244:247], v[24:27], v[96:99]
    ds_read_b64_tr_b16 v[236:237], v8 offset:16928
    s_mov_b32 s23, 0x2000
    buffer_load_dwordx4 v[56:59], v6, s[8:11], s23 offen offset:1024 sc1
    v_mfma_f32_16x16x32_bf16 v[100:103], v[244:247], v[28:31], v[100:103]
    ds_read_b64_tr_b16 v[238:239], v8 offset:17952
    s_waitcnt lgkmcnt(6)
    v_mfma_f32_16x16x32_bf16 v[104:107], v[224:227], v[24:27], v[104:107]
    ds_read_b64_tr_b16 v[240:241], v7 offset:17152
    v_mfma_f32_16x16x32_bf16 v[108:111], v[224:227], v[28:31], v[108:111]
    ds_read_b64_tr_b16 v[242:243], v7 offset:18176
    s_waitcnt lgkmcnt(6)
    v_mfma_f32_16x16x32_bf16 v[112:115], v[228:231], v[24:27], v[112:115]
    ds_read_b64_tr_b16 v[244:245], v8 offset:17184
    v_mfma_f32_16x16x32_bf16 v[116:119], v[228:231], v[28:31], v[116:119]
    ds_read_b64_tr_b16 v[246:247], v8 offset:18208
    s_waitcnt lgkmcnt(6)
    v_mfma_f32_16x16x32_bf16 v[120:123], v[232:235], v[24:27], v[120:123]
    s_mov_b32 s23, 0x22000
    buffer_load_dwordx4 v[60:63], v6, s[8:11], s23 offen offset:1024 sc1
    v_mfma_f32_16x16x32_bf16 v[124:127], v[232:235], v[28:31], v[124:127]
    s_barrier
    ds_read_b64_tr_b16 v[224:225], v4 offset:0
    ds_read_b64_tr_b16 v[226:227], v4 offset:1024
    s_waitcnt lgkmcnt(6)
    v_mfma_f32_16x16x32_bf16 v[128:131], v[236:239], v[24:27], v[128:131]
    s_add_u32 s16, s63, 0x576000
    v_mov_b32 v14, s28
    v_mov_b32 v15, 0
    s_mov_b64 exec, 1
    buffer_store_dword v14, v15, s[8:11], s16 offen sc1
    s_mov_b64 exec, -1
    s_add_u32 s22, s24, 0x110000
    s_add_u32 m0, s20, 0x20000
    s_nop 0
    buffer_load_dwordx4 v3, s[4:7], s22 offen lds
    ds_read_b64_tr_b16 v[228:229], v5 offset:32
    v_mfma_f32_16x16x32_bf16 v[132:135], v[236:239], v[28:31], v[132:135]
    ds_read_b64_tr_b16 v[230:231], v5 offset:1056
    s_waitcnt lgkmcnt(6)
    v_mfma_f32_16x16x32_bf16 v[136:139], v[240:243], v[24:27], v[136:139]
    ds_read_b64_tr_b16 v[232:233], v4 offset:256
    v_mfma_f32_16x16x32_bf16 v[140:143], v[240:243], v[28:31], v[140:143]
    ds_read_b64_tr_b16 v[234:235], v4 offset:1280
    s_waitcnt lgkmcnt(6)
    v_mfma_f32_16x16x32_bf16 v[144:147], v[244:247], v[24:27], v[144:147]
    ds_read_b64_tr_b16 v[236:237], v5 offset:288
    v_mfma_f32_16x16x32_bf16 v[148:151], v[244:247], v[28:31], v[148:151]
    ds_read_b64_tr_b16 v[238:239], v5 offset:1312
    s_waitcnt lgkmcnt(6)
    v_mfma_f32_16x16x32_bf16 v[88:91], v[224:227], v[32:35], v[88:91]
    ds_read_b64_tr_b16 v[240:241], v4 offset:512
    v_mfma_f32_16x16x32_bf16 v[92:95], v[224:227], v[36:39], v[92:95]
    s_add_u32 s22, s24, 0x112000
    s_add_u32 m0, s20, 0x20400
    s_nop 0
    buffer_load_dwordx4 v3, s[4:7], s22 offen lds
    ds_read_b64_tr_b16 v[242:243], v4 offset:1536
    s_waitcnt lgkmcnt(6)
    v_mfma_f32_16x16x32_bf16 v[96:99], v[228:231], v[32:35], v[96:99]
    ds_read_b64_tr_b16 v[244:245], v5 offset:544
    s_mov_b32 s23, 0x4000
    buffer_load_dwordx4 v[24:27], v6, s[8:11], s23 offen offset:1024 sc1
    v_mfma_f32_16x16x32_bf16 v[100:103], v[228:231], v[36:39], v[100:103]
    ds_read_b64_tr_b16 v[246:247], v5 offset:1568
    s_waitcnt lgkmcnt(6)
    v_mfma_f32_16x16x32_bf16 v[104:107], v[232:235], v[32:35], v[104:107]
    ds_read_b64_tr_b16 v[224:225], v4 offset:768
    v_mfma_f32_16x16x32_bf16 v[108:111], v[232:235], v[36:39], v[108:111]
    ds_read_b64_tr_b16 v[226:227], v4 offset:1792
    s_waitcnt lgkmcnt(6)
    v_mfma_f32_16x16x32_bf16 v[112:115], v[236:239], v[32:35], v[112:115]
    ds_read_b64_tr_b16 v[228:229], v5 offset:800
    v_mfma_f32_16x16x32_bf16 v[116:119], v[236:239], v[36:39], v[116:119]
    ds_read_b64_tr_b16 v[230:231], v5 offset:1824
    s_waitcnt lgkmcnt(6)
    v_mfma_f32_16x16x32_bf16 v[120:123], v[240:243], v[32:35], v[120:123]
    s_mov_b32 s23, 0x24000
    buffer_load_dwordx4 v[28:31], v6, s[8:11], s23 offen offset:1024 sc1
    v_mfma_f32_16x16x32_bf16 v[124:127], v[240:243], v[36:39], v[124:127]
    s_waitcnt vmcnt(15)
    s_barrier
    ds_read_b64_tr_b16 v[232:233], v4 offset:16384
    ds_read_b64_tr_b16 v[234:235], v4 offset:17408
    s_waitcnt lgkmcnt(6)
    v_mfma_f32_16x16x32_bf16 v[128:131], v[244:247], v[32:35], v[128:131]
    s_add_u32 s22, s24, 0x190000
    s_add_u32 m0, s20, 0x24000
    s_nop 0
    buffer_load_dwordx4 v3, s[4:7], s22 offen lds
    ds_read_b64_tr_b16 v[236:237], v5 offset:16416
    v_mfma_f32_16x16x32_bf16 v[132:135], v[244:247], v[36:39], v[132:135]
    ds_read_b64_tr_b16 v[238:239], v5 offset:17440
    s_waitcnt lgkmcnt(6)
    v_mfma_f32_16x16x32_bf16 v[136:139], v[224:227], v[32:35], v[136:139]
    ds_read_b64_tr_b16 v[240:241], v4 offset:16640
    v_mfma_f32_16x16x32_bf16 v[140:143], v[224:227], v[36:39], v[140:143]
    ds_read_b64_tr_b16 v[242:243], v4 offset:17664
    s_waitcnt lgkmcnt(6)
    v_mfma_f32_16x16x32_bf16 v[144:147], v[228:231], v[32:35], v[144:147]
    ds_read_b64_tr_b16 v[244:245], v5 offset:16672
    v_mfma_f32_16x16x32_bf16 v[148:151], v[228:231], v[36:39], v[148:151]
    ds_read_b64_tr_b16 v[246:247], v5 offset:17696
    s_waitcnt vmcnt(15) lgkmcnt(6)
    v_mfma_f32_16x16x32_bf16 v[88:91], v[232:235], v[40:43], v[88:91]
    ds_read_b64_tr_b16 v[224:225], v4 offset:16896
    s_waitcnt vmcnt(14)
    v_mfma_f32_16x16x32_bf16 v[92:95], v[232:235], v[44:47], v[92:95]
    s_add_u32 s22, s24, 0x192000
    s_add_u32 m0, s20, 0x24400
    s_nop 0
    buffer_load_dwordx4 v3, s[4:7], s22 offen lds
    ds_read_b64_tr_b16 v[226:227], v4 offset:17920
    s_waitcnt lgkmcnt(6)
    v_mfma_f32_16x16x32_bf16 v[96:99], v[236:239], v[40:43], v[96:99]
    ds_read_b64_tr_b16 v[228:229], v5 offset:16928
    s_mov_b32 s23, 0x6000
    buffer_load_dwordx4 v[32:35], v6, s[8:11], s23 offen offset:1024 sc1
    v_mfma_f32_16x16x32_bf16 v[100:103], v[236:239], v[44:47], v[100:103]
    ds_read_b64_tr_b16 v[230:231], v5 offset:17952
    s_waitcnt lgkmcnt(6)
    v_mfma_f32_16x16x32_bf16 v[104:107], v[240:243], v[40:43], v[104:107]
    ds_read_b64_tr_b16 v[232:233], v4 offset:17152
    v_mfma_f32_16x16x32_bf16 v[108:111], v[240:243], v[44:47], v[108:111]
    ds_read_b64_tr_b16 v[234:235], v4 offset:18176
    s_waitcnt lgkmcnt(6)
    v_mfma_f32_16x16x32_bf16 v[112:115], v[244:247], v[40:43], v[112:115]
    ds_read_b64_tr_b16 v[236:237], v5 offset:17184
    v_mfma_f32_16x16x32_bf16 v[116:119], v[244:247], v[44:47], v[116:119]
    ds_read_b64_tr_b16 v[238:239], v5 offset:18208
    s_waitcnt lgkmcnt(6)
    v_mfma_f32_16x16x32_bf16 v[120:123], v[224:227], v[40:43], v[120:123]
    s_mov_b32 s23, 0x26000
    buffer_load_dwordx4 v[36:39], v6, s[8:11], s23 offen offset:1024 sc1
    v_mfma_f32_16x16x32_bf16 v[124:127], v[224:227], v[44:47], v[124:127]
    s_waitcnt vmcnt(15)
    s_barrier
    ds_read_b64_tr_b16 v[240:241], v4 offset:32768
    ds_read_b64_tr_b16 v[242:243], v4 offset:33792
    s_waitcnt lgkmcnt(6)
    v_mfma_f32_16x16x32_bf16 v[128:131], v[228:231], v[40:43], v[128:131]
    s_add_u32 s22, s24, 0x210000
    s_add_u32 m0, s20, 0x10000
    s_nop 0
    buffer_load_dwordx4 v3, s[4:7], s22 offen lds
    ds_read_b64_tr_b16 v[244:245], v5 offset:32800
    v_mfma_f32_16x16x32_bf16 v[132:135], v[228:231], v[44:47], v[132:135]
    ds_read_b64_tr_b16 v[246:247], v5 offset:33824
    s_waitcnt lgkmcnt(6)
    v_mfma_f32_16x16x32_bf16 v[136:139], v[232:235], v[40:43], v[136:139]
    ds_read_b64_tr_b16 v[224:225], v4 offset:33024
    v_mfma_f32_16x16x32_bf16 v[140:143], v[232:235], v[44:47], v[140:143]
    ds_read_b64_tr_b16 v[226:227], v4 offset:34048
    s_waitcnt lgkmcnt(6)
    v_mfma_f32_16x16x32_bf16 v[144:147], v[236:239], v[40:43], v[144:147]
    ds_read_b64_tr_b16 v[228:229], v5 offset:33056
    v_mfma_f32_16x16x32_bf16 v[148:151], v[236:239], v[44:47], v[148:151]
    ds_read_b64_tr_b16 v[230:231], v5 offset:34080
    s_waitcnt vmcnt(15) lgkmcnt(6)
    v_mfma_f32_16x16x32_bf16 v[88:91], v[240:243], v[48:51], v[88:91]
    ds_read_b64_tr_b16 v[232:233], v4 offset:33280
    s_waitcnt vmcnt(14)
    v_mfma_f32_16x16x32_bf16 v[92:95], v[240:243], v[52:55], v[92:95]
    s_add_u32 s22, s24, 0x212000
    s_add_u32 m0, s20, 0x10400
    s_nop 0
    buffer_load_dwordx4 v3, s[4:7], s22 offen lds
    ds_read_b64_tr_b16 v[234:235], v4 offset:34304
    s_waitcnt lgkmcnt(6)
    v_mfma_f32_16x16x32_bf16 v[96:99], v[244:247], v[48:51], v[96:99]
    ds_read_b64_tr_b16 v[236:237], v5 offset:33312
    s_mov_b32 s23, 0x8000
    buffer_load_dwordx4 v[40:43], v6, s[8:11], s23 offen offset:1024 sc1
    v_mfma_f32_16x16x32_bf16 v[100:103], v[244:247], v[52:55], v[100:103]
    ds_read_b64_tr_b16 v[238:239], v5 offset:34336
    s_waitcnt lgkmcnt(6)
    v_mfma_f32_16x16x32_bf16 v[104:107], v[224:227], v[48:51], v[104:107]
    ds_read_b64_tr_b16 v[240:241], v4 offset:33536
    v_mfma_f32_16x16x32_bf16 v[108:111], v[224:227], v[52:55], v[108:111]
    ds_read_b64_tr_b16 v[242:243], v4 offset:34560
    s_waitcnt lgkmcnt(6)
    v_mfma_f32_16x16x32_bf16 v[112:115], v[228:231], v[48:51], v[112:115]
    ds_read_b64_tr_b16 v[244:245], v5 offset:33568
    v_mfma_f32_16x16x32_bf16 v[116:119], v[228:231], v[52:55], v[116:119]
    ds_read_b64_tr_b16 v[246:247], v5 offset:34592
    s_waitcnt lgkmcnt(6)
    v_mfma_f32_16x16x32_bf16 v[120:123], v[232:235], v[48:51], v[120:123]
    s_mov_b32 s23, 0x28000
    buffer_load_dwordx4 v[44:47], v6, s[8:11], s23 offen offset:1024 sc1
    v_mfma_f32_16x16x32_bf16 v[124:127], v[232:235], v[52:55], v[124:127]
    s_waitcnt vmcnt(15)
    s_barrier
    ds_read_b64_tr_b16 v[224:225], v4 offset:49152
    ds_read_b64_tr_b16 v[226:227], v4 offset:50176
    s_waitcnt lgkmcnt(6)
    v_mfma_f32_16x16x32_bf16 v[128:131], v[236:239], v[48:51], v[128:131]
    s_add_u32 s22, s24, 0x290000
    s_add_u32 m0, s20, 0x14000
    s_nop 0
    buffer_load_dwordx4 v3, s[4:7], s22 offen lds
    ds_read_b64_tr_b16 v[228:229], v5 offset:49184
    v_mfma_f32_16x16x32_bf16 v[132:135], v[236:239], v[52:55], v[132:135]
    ds_read_b64_tr_b16 v[230:231], v5 offset:50208
    s_waitcnt lgkmcnt(6)
    v_mfma_f32_16x16x32_bf16 v[136:139], v[240:243], v[48:51], v[136:139]
    ds_read_b64_tr_b16 v[232:233], v4 offset:49408
    v_mfma_f32_16x16x32_bf16 v[140:143], v[240:243], v[52:55], v[140:143]
    ds_read_b64_tr_b16 v[234:235], v4 offset:50432
    s_waitcnt lgkmcnt(6)
    v_mfma_f32_16x16x32_bf16 v[144:147], v[244:247], v[48:51], v[144:147]
    ds_read_b64_tr_b16 v[236:237], v5 offset:49440
    v_mfma_f32_16x16x32_bf16 v[148:151], v[244:247], v[52:55], v[148:151]
    ds_read_b64_tr_b16 v[238:239], v5 offset:50464
    s_waitcnt vmcnt(15) lgkmcnt(6)
    v_mfma_f32_16x16x32_bf16 v[88:91], v[224:227], v[56:59], v[88:91]
    ds_read_b64_tr_b16 v[240:241], v4 offset:49664
    s_waitcnt vmcnt(14)
    v_mfma_f32_16x16x32_bf16 v[92:95], v[224:227], v[60:63], v[92:95]
    s_add_u32 s22, s24, 0x292000
    s_add_u32 m0, s20, 0x14400
    s_nop 0
    buffer_load_dwordx4 v3, s[4:7], s22 offen lds
    ds_read_b64_tr_b16 v[242:243], v4 offset:50688
    s_waitcnt lgkmcnt(6)
    v_mfma_f32_16x16x32_bf16 v[96:99], v[228:231], v[56:59], v[96:99]
    ds_read_b64_tr_b16 v[244:245], v5 offset:49696
    s_mov_b32 s23, 0xa000
    buffer_load_dwordx4 v[48:51], v6, s[8:11], s23 offen offset:1024 sc1
    v_mfma_f32_16x16x32_bf16 v[100:103], v[228:231], v[60:63], v[100:103]
    ds_read_b64_tr_b16 v[246:247], v5 offset:50720
    s_waitcnt lgkmcnt(6)
    v_mfma_f32_16x16x32_bf16 v[104:107], v[232:235], v[56:59], v[104:107]
    ds_read_b64_tr_b16 v[224:225], v4 offset:49920
    v_mfma_f32_16x16x32_bf16 v[108:111], v[232:235], v[60:63], v[108:111]
    ds_read_b64_tr_b16 v[226:227], v4 offset:50944
    s_waitcnt lgkmcnt(6)
    v_mfma_f32_16x16x32_bf16 v[112:115], v[236:239], v[56:59], v[112:115]
    ds_read_b64_tr_b16 v[228:229], v5 offset:49952
    v_mfma_f32_16x16x32_bf16 v[116:119], v[236:239], v[60:63], v[116:119]
    ds_read_b64_tr_b16 v[230:231], v5 offset:50976
    s_waitcnt lgkmcnt(6)
    v_mfma_f32_16x16x32_bf16 v[120:123], v[240:243], v[56:59], v[120:123]
    s_mov_b32 s23, 0x2a000
    buffer_load_dwordx4 v[52:55], v6, s[8:11], s23 offen offset:1024 sc1
    v_mfma_f32_16x16x32_bf16 v[124:127], v[240:243], v[60:63], v[124:127]
    s_waitcnt vmcnt(14)
    s_barrier
    ds_read_b64_tr_b16 v[232:233], v7 offset:0
    ds_read_b64_tr_b16 v[234:235], v7 offset:1024
    s_waitcnt lgkmcnt(6)
    v_mfma_f32_16x16x32_bf16 v[128:131], v[244:247], v[56:59], v[128:131]
    s_add_u32 s22, s24, 0x310000
    s_add_u32 m0, s20, 0x18000
    s_nop 0
    buffer_load_dwordx4 v3, s[4:7], s22 offen lds
    ds_read_b64_tr_b16 v[236:237], v8 offset:32
    v_mfma_f32_16x16x32_bf16 v[132:135], v[244:247], v[60:63], v[132:135]
    ds_read_b64_tr_b16 v[238:239], v8 offset:1056
    s_waitcnt lgkmcnt(6)
    v_mfma_f32_16x16x32_bf16 v[136:139], v[224:227], v[56:59], v[136:139]
    ds_read_b64_tr_b16 v[240:241], v7 offset:256
    v_mfma_f32_16x16x32_bf16 v[140:143], v[224:227], v[60:63], v[140:143]
    ds_read_b64_tr_b16 v[242:243], v7 offset:1280
    s_waitcnt lgkmcnt(6)
    v_mfma_f32_16x16x32_bf16 v[144:147], v[228:231], v[56:59], v[144:147]
    ds_read_b64_tr_b16 v[244:245], v8 offset:288
    v_mfma_f32_16x16x32_bf16 v[148:151], v[228:231], v[60:63], v[148:151]
    ds_read_b64_tr_b16 v[246:247], v8 offset:1312
    s_waitcnt vmcnt(14) lgkmcnt(6)
    v_mfma_f32_16x16x32_bf16 v[88:91], v[232:235], v[24:27], v[88:91]
    ds_read_b64_tr_b16 v[224:225], v7 offset:512
    s_waitcnt vmcnt(13)
    v_mfma_f32_16x16x32_bf16 v[92:95], v[232:235], v[28:31], v[92:95]
    s_add_u32 s22, s24, 0x312000
    s_add_u32 m0, s20, 0x18400
    s_nop 0
    buffer_load_dwordx4 v3, s[4:7], s22 offen lds
    ds_read_b64_tr_b16 v[226:227], v7 offset:1536
    s_waitcnt lgkmcnt(6)
    v_mfma_f32_16x16x32_bf16 v[96:99], v[236:239], v[24:27], v[96:99]
    ds_read_b64_tr_b16 v[228:229], v8 offset:544
    s_mov_b32 s23, 0xc000
    buffer_load_dwordx4 v[56:59], v6, s[8:11], s23 offen offset:1024 sc1
    v_mfma_f32_16x16x32_bf16 v[100:103], v[236:239], v[28:31], v[100:103]
    ds_read_b64_tr_b16 v[230:231], v8 offset:1568
    s_waitcnt lgkmcnt(6)
    v_mfma_f32_16x16x32_bf16 v[104:107], v[240:243], v[24:27], v[104:107]
    ds_read_b64_tr_b16 v[232:233], v7 offset:768
    v_mfma_f32_16x16x32_bf16 v[108:111], v[240:243], v[28:31], v[108:111]
    ds_read_b64_tr_b16 v[234:235], v7 offset:1792
    s_waitcnt lgkmcnt(6)
    v_mfma_f32_16x16x32_bf16 v[112:115], v[244:247], v[24:27], v[112:115]
    ds_read_b64_tr_b16 v[236:237], v8 offset:800
    v_mfma_f32_16x16x32_bf16 v[116:119], v[244:247], v[28:31], v[116:119]
    ds_read_b64_tr_b16 v[238:239], v8 offset:1824
    s_waitcnt lgkmcnt(6)
    v_mfma_f32_16x16x32_bf16 v[120:123], v[224:227], v[24:27], v[120:123]
    s_mov_b32 s23, 0x2c000
    buffer_load_dwordx4 v[60:63], v6, s[8:11], s23 offen offset:1024 sc1
    v_mfma_f32_16x16x32_bf16 v[124:127], v[224:227], v[28:31], v[124:127]
    s_waitcnt vmcnt(14)
    s_barrier
    ds_read_b64_tr_b16 v[240:241], v7 offset:16384
    ds_read_b64_tr_b16 v[242:243], v7 offset:17408
    s_add_u32 s19, s19, 8192
    buffer_load_dword v12, v13, s[8:11], s19 offen sc1
    s_waitcnt lgkmcnt(6)
    v_mfma_f32_16x16x32_bf16 v[128:131], v[228:231], v[24:27], v[128:131]
    s_add_u32 s22, s24, 0x390000
    s_add_u32 m0, s20, 0x1c000
    s_nop 0
    buffer_load_dwordx4 v3, s[4:7], s22 offen lds
    ds_read_b64_tr_b16 v[244:245], v8 offset:16416
    v_mfma_f32_16x16x32_bf16 v[132:135], v[228:231], v[28:31], v[132:135]
    ds_read_b64_tr_b16 v[246:247], v8 offset:17440
    s_waitcnt lgkmcnt(6)
    v_mfma_f32_16x16x32_bf16 v[136:139], v[232:235], v[24:27], v[136:139]
    ds_read_b64_tr_b16 v[224:225], v7 offset:16640
    v_mfma_f32_16x16x32_bf16 v[140:143], v[232:235], v[28:31], v[140:143]
    ds_read_b64_tr_b16 v[226:227], v7 offset:17664
    s_waitcnt lgkmcnt(6)
    v_mfma_f32_16x16x32_bf16 v[144:147], v[236:239], v[24:27], v[144:147]
    ds_read_b64_tr_b16 v[228:229], v8 offset:16672
    v_mfma_f32_16x16x32_bf16 v[148:151], v[236:239], v[28:31], v[148:151]
    ds_read_b64_tr_b16 v[230:231], v8 offset:17696
    s_waitcnt vmcnt(15) lgkmcnt(6)
    v_mfma_f32_16x16x32_bf16 v[88:91], v[240:243], v[32:35], v[88:91]
    ds_read_b64_tr_b16 v[232:233], v7 offset:16896
    s_waitcnt vmcnt(14)
    v_mfma_f32_16x16x32_bf16 v[92:95], v[240:243], v[36:39], v[92:95]
    s_add_u32 s22, s24, 0x392000
    s_add_u32 m0, s20, 0x1c400
    s_nop 0
    buffer_load_dwordx4 v3, s[4:7], s22 offen lds
    ds_read_b64_tr_b16 v[234:235], v7 offset:17920
    s_waitcnt lgkmcnt(6)
    v_mfma_f32_16x16x32_bf16 v[96:99], v[244:247], v[32:35], v[96:99]
    ds_read_b64_tr_b16 v[236:237], v8 offset:16928
    s_mov_b32 s23, 0xe000
    buffer_load_dwordx4 v[24:27], v6, s[8:11], s23 offen offset:1024 sc1
    v_mfma_f32_16x16x32_bf16 v[100:103], v[244:247], v[36:39], v[100:103]
    ds_read_b64_tr_b16 v[238:239], v8 offset:17952
    s_waitcnt lgkmcnt(6)
    v_mfma_f32_16x16x32_bf16 v[104:107], v[224:227], v[32:35], v[104:107]
    ds_read_b64_tr_b16 v[240:241], v7 offset:17152
    v_mfma_f32_16x16x32_bf16 v[108:111], v[224:227], v[36:39], v[108:111]
    ds_read_b64_tr_b16 v[242:243], v7 offset:18176
    s_waitcnt lgkmcnt(6)
    v_mfma_f32_16x16x32_bf16 v[112:115], v[228:231], v[32:35], v[112:115]
    ds_read_b64_tr_b16 v[244:245], v8 offset:17184
    v_mfma_f32_16x16x32_bf16 v[116:119], v[228:231], v[36:39], v[116:119]
    ds_read_b64_tr_b16 v[246:247], v8 offset:18208
    s_waitcnt lgkmcnt(6)
    v_mfma_f32_16x16x32_bf16 v[120:123], v[232:235], v[32:35], v[120:123]
    s_mov_b32 s23, 0x2e000
    buffer_load_dwordx4 v[28:31], v6, s[8:11], s23 offen offset:1024 sc1
    v_mfma_f32_16x16x32_bf16 v[124:127], v[232:235], v[36:39], v[124:127]
    s_waitcnt vmcnt(15)
    s_barrier
    ds_read_b64_tr_b16 v[224:225], v4 offset:0
    ds_read_b64_tr_b16 v[226:227], v4 offset:1024
    s_waitcnt lgkmcnt(6)
    v_mfma_f32_16x16x32_bf16 v[128:131], v[236:239], v[32:35], v[128:131]
    s_add_u32 s22, s24, 0x20000
    s_add_u32 m0, s20, 0x20000
    s_nop 0
    buffer_load_dwordx4 v3, s[4:7], s22 offen lds
    ds_read_b64_tr_b16 v[228:229], v5 offset:32
    v_mfma_f32_16x16x32_bf16 v[132:135], v[236:239], v[36:39], v[132:135]
    ds_read_b64_tr_b16 v[230:231], v5 offset:1056
    s_waitcnt lgkmcnt(6)
    v_mfma_f32_16x16x32_bf16 v[136:139], v[240:243], v[32:35], v[136:139]
    ds_read_b64_tr_b16 v[232:233], v4 offset:256
    v_mfma_f32_16x16x32_bf16 v[140:143], v[240:243], v[36:39], v[140:143]
    ds_read_b64_tr_b16 v[234:235], v4 offset:1280
    s_waitcnt lgkmcnt(6)
    v_mfma_f32_16x16x32_bf16 v[144:147], v[244:247], v[32:35], v[144:147]
    ds_read_b64_tr_b16 v[236:237], v5 offset:288
    v_mfma_f32_16x16x32_bf16 v[148:151], v[244:247], v[36:39], v[148:151]
    ds_read_b64_tr_b16 v[238:239], v5 offset:1312
    s_waitcnt vmcnt(5)
    v_cmp_ne_u32 vcc, s28, v12
    s_cbranch_vccnz adaLN_cond__sliding_block_cached__moe_arch_mod__prompt_kernel_o28r
adaLN_cond__sliding_block_cached__moe_arch_mod__prompt_kernel_o28b:
    s_waitcnt lgkmcnt(6)
    v_mfma_f32_16x16x32_bf16 v[88:91], v[224:227], v[40:43], v[88:91]
    ds_read_b64_tr_b16 v[240:241], v4 offset:512
    v_mfma_f32_16x16x32_bf16 v[92:95], v[224:227], v[44:47], v[92:95]
    s_add_u32 s22, s24, 0x22000
    s_add_u32 m0, s20, 0x20400
    s_nop 0
    buffer_load_dwordx4 v3, s[4:7], s22 offen lds
    ds_read_b64_tr_b16 v[242:243], v4 offset:1536
    s_waitcnt lgkmcnt(6)
    v_mfma_f32_16x16x32_bf16 v[96:99], v[228:231], v[40:43], v[96:99]
    ds_read_b64_tr_b16 v[244:245], v5 offset:544
    s_mov_b32 s23, 0x0
    buffer_load_dwordx4 v[32:35], v6, s[8:11], s23 offen offset:2048 sc1
    v_mfma_f32_16x16x32_bf16 v[100:103], v[228:231], v[44:47], v[100:103]
    ds_read_b64_tr_b16 v[246:247], v5 offset:1568
    s_waitcnt lgkmcnt(6)
    v_mfma_f32_16x16x32_bf16 v[104:107], v[232:235], v[40:43], v[104:107]
    ds_read_b64_tr_b16 v[224:225], v4 offset:768
    v_mfma_f32_16x16x32_bf16 v[108:111], v[232:235], v[44:47], v[108:111]
    ds_read_b64_tr_b16 v[226:227], v4 offset:1792
    s_waitcnt lgkmcnt(6)
    v_mfma_f32_16x16x32_bf16 v[112:115], v[236:239], v[40:43], v[112:115]
    ds_read_b64_tr_b16 v[228:229], v5 offset:800
    v_mfma_f32_16x16x32_bf16 v[116:119], v[236:239], v[44:47], v[116:119]
    ds_read_b64_tr_b16 v[230:231], v5 offset:1824
    s_waitcnt lgkmcnt(6)
    v_mfma_f32_16x16x32_bf16 v[120:123], v[240:243], v[40:43], v[120:123]
    s_mov_b32 s23, 0x20000
    buffer_load_dwordx4 v[36:39], v6, s[8:11], s23 offen offset:2048 sc1
    v_mfma_f32_16x16x32_bf16 v[124:127], v[240:243], v[44:47], v[124:127]
    s_barrier
    ds_read_b64_tr_b16 v[232:233], v4 offset:16384
    ds_read_b64_tr_b16 v[234:235], v4 offset:17408
    s_waitcnt lgkmcnt(6)
    v_mfma_f32_16x16x32_bf16 v[128:131], v[244:247], v[40:43], v[128:131]
    s_add_u32 s22, s24, 0xa0000
    s_add_u32 m0, s20, 0x24000
    s_nop 0
    buffer_load_dwordx4 v3, s[4:7], s22 offen lds
    ds_read_b64_tr_b16 v[236:237], v5 offset:16416
    v_mfma_f32_16x16x32_bf16 v[132:135], v[244:247], v[44:47], v[132:135]
    ds_read_b64_tr_b16 v[238:239], v5 offset:17440
    s_waitcnt lgkmcnt(6)
    v_mfma_f32_16x16x32_bf16 v[136:139], v[224:227], v[40:43], v[136:139]
    ds_read_b64_tr_b16 v[240:241], v4 offset:16640
    v_mfma_f32_16x16x32_bf16 v[140:143], v[224:227], v[44:47], v[140:143]
    ds_read_b64_tr_b16 v[242:243], v4 offset:17664
    s_waitcnt lgkmcnt(6)
    v_mfma_f32_16x16x32_bf16 v[144:147], v[228:231], v[40:43], v[144:147]
    ds_read_b64_tr_b16 v[244:245], v5 offset:16672
    v_mfma_f32_16x16x32_bf16 v[148:151], v[228:231], v[44:47], v[148:151]
    ds_read_b64_tr_b16 v[246:247], v5 offset:17696
    s_waitcnt lgkmcnt(6)
    v_mfma_f32_16x16x32_bf16 v[88:91], v[232:235], v[48:51], v[88:91]
    ds_read_b64_tr_b16 v[224:225], v4 offset:16896
    v_mfma_f32_16x16x32_bf16 v[92:95], v[232:235], v[52:55], v[92:95]
    s_add_u32 s22, s24, 0xa2000
    s_add_u32 m0, s20, 0x24400
    s_nop 0
    buffer_load_dwordx4 v3, s[4:7], s22 offen lds
    ds_read_b64_tr_b16 v[226:227], v4 offset:17920
    s_waitcnt lgkmcnt(6)
    v_mfma_f32_16x16x32_bf16 v[96:99], v[236:239], v[48:51], v[96:99]
    ds_read_b64_tr_b16 v[228:229], v5 offset:16928
    s_mov_b32 s23, 0x2000
    buffer_load_dwordx4 v[40:43], v6, s[8:11], s23 offen offset:2048 sc1
    v_mfma_f32_16x16x32_bf16 v[100:103], v[236:239], v[52:55], v[100:103]
    ds_read_b64_tr_b16 v[230:231], v5 offset:17952
    s_waitcnt lgkmcnt(6)
    v_mfma_f32_16x16x32_bf16 v[104:107], v[240:243], v[48:51], v[104:107]
    ds_read_b64_tr_b16 v[232:233], v4 offset:17152
    v_mfma_f32_16x16x32_bf16 v[108:111], v[240:243], v[52:55], v[108:111]
    ds_read_b64_tr_b16 v[234:235], v4 offset:18176
    s_waitcnt lgkmcnt(6)
    v_mfma_f32_16x16x32_bf16 v[112:115], v[244:247], v[48:51], v[112:115]
    ds_read_b64_tr_b16 v[236:237], v5 offset:17184
    v_mfma_f32_16x16x32_bf16 v[116:119], v[244:247], v[52:55], v[116:119]
    ds_read_b64_tr_b16 v[238:239], v5 offset:18208
    s_waitcnt lgkmcnt(6)
    v_mfma_f32_16x16x32_bf16 v[120:123], v[224:227], v[48:51], v[120:123]
    s_mov_b32 s23, 0x22000
    buffer_load_dwordx4 v[44:47], v6, s[8:11], s23 offen offset:2048 sc1
    v_mfma_f32_16x16x32_bf16 v[124:127], v[224:227], v[52:55], v[124:127]
    s_barrier
    ds_read_b64_tr_b16 v[240:241], v4 offset:32768
    ds_read_b64_tr_b16 v[242:243], v4 offset:33792
    s_waitcnt lgkmcnt(6)
    v_mfma_f32_16x16x32_bf16 v[128:131], v[228:231], v[48:51], v[128:131]
    s_add_u32 s22, s24, 0x120000
    s_add_u32 m0, s20, 0x10000
    s_nop 0
    buffer_load_dwordx4 v3, s[4:7], s22 offen lds
    ds_read_b64_tr_b16 v[244:245], v5 offset:32800
    v_mfma_f32_16x16x32_bf16 v[132:135], v[228:231], v[52:55], v[132:135]
    ds_read_b64_tr_b16 v[246:247], v5 offset:33824
    s_waitcnt lgkmcnt(6)
    v_mfma_f32_16x16x32_bf16 v[136:139], v[232:235], v[48:51], v[136:139]
    ds_read_b64_tr_b16 v[224:225], v4 offset:33024
    v_mfma_f32_16x16x32_bf16 v[140:143], v[232:235], v[52:55], v[140:143]
    ds_read_b64_tr_b16 v[226:227], v4 offset:34048
    s_waitcnt lgkmcnt(6)
    v_mfma_f32_16x16x32_bf16 v[144:147], v[236:239], v[48:51], v[144:147]
    ds_read_b64_tr_b16 v[228:229], v5 offset:33056
    v_mfma_f32_16x16x32_bf16 v[148:151], v[236:239], v[52:55], v[148:151]
    ds_read_b64_tr_b16 v[230:231], v5 offset:34080
    s_waitcnt lgkmcnt(6)
    v_mfma_f32_16x16x32_bf16 v[88:91], v[240:243], v[56:59], v[88:91]
    ds_read_b64_tr_b16 v[232:233], v4 offset:33280
    v_mfma_f32_16x16x32_bf16 v[92:95], v[240:243], v[60:63], v[92:95]
    s_add_u32 s22, s24, 0x122000
    s_add_u32 m0, s20, 0x10400
    s_nop 0
    buffer_load_dwordx4 v3, s[4:7], s22 offen lds
    ds_read_b64_tr_b16 v[234:235], v4 offset:34304
    s_waitcnt lgkmcnt(6)
    v_mfma_f32_16x16x32_bf16 v[96:99], v[244:247], v[56:59], v[96:99]
    ds_read_b64_tr_b16 v[236:237], v5 offset:33312
    s_mov_b32 s23, 0x4000
    buffer_load_dwordx4 v[48:51], v6, s[8:11], s23 offen offset:2048 sc1
    v_mfma_f32_16x16x32_bf16 v[100:103], v[244:247], v[60:63], v[100:103]
    ds_read_b64_tr_b16 v[238:239], v5 offset:34336
    s_waitcnt lgkmcnt(6)
    v_mfma_f32_16x16x32_bf16 v[104:107], v[224:227], v[56:59], v[104:107]
    ds_read_b64_tr_b16 v[240:241], v4 offset:33536
    v_mfma_f32_16x16x32_bf16 v[108:111], v[224:227], v[60:63], v[108:111]
    ds_read_b64_tr_b16 v[242:243], v4 offset:34560
    s_waitcnt lgkmcnt(6)
    v_mfma_f32_16x16x32_bf16 v[112:115], v[228:231], v[56:59], v[112:115]
    ds_read_b64_tr_b16 v[244:245], v5 offset:33568
    v_mfma_f32_16x16x32_bf16 v[116:119], v[228:231], v[60:63], v[116:119]
    ds_read_b64_tr_b16 v[246:247], v5 offset:34592
    s_waitcnt lgkmcnt(6)
    v_mfma_f32_16x16x32_bf16 v[120:123], v[232:235], v[56:59], v[120:123]
    s_mov_b32 s23, 0x24000
    buffer_load_dwordx4 v[52:55], v6, s[8:11], s23 offen offset:2048 sc1
    v_mfma_f32_16x16x32_bf16 v[124:127], v[232:235], v[60:63], v[124:127]
    s_waitcnt vmcnt(14)
    s_barrier
    ds_read_b64_tr_b16 v[224:225], v4 offset:49152
    ds_read_b64_tr_b16 v[226:227], v4 offset:50176
    s_waitcnt lgkmcnt(6)
    v_mfma_f32_16x16x32_bf16 v[128:131], v[236:239], v[56:59], v[128:131]
    s_add_u32 s22, s24, 0x1a0000
    s_add_u32 m0, s20, 0x14000
    s_nop 0
    buffer_load_dwordx4 v3, s[4:7], s22 offen lds
    ds_read_b64_tr_b16 v[228:229], v5 offset:49184
    v_mfma_f32_16x16x32_bf16 v[132:135], v[236:239], v[60:63], v[132:135]
    ds_read_b64_tr_b16 v[230:231], v5 offset:50208
    s_waitcnt lgkmcnt(6)
    v_mfma_f32_16x16x32_bf16 v[136:139], v[240:243], v[56:59], v[136:139]
    ds_read_b64_tr_b16 v[232:233], v4 offset:49408
    v_mfma_f32_16x16x32_bf16 v[140:143], v[240:243], v[60:63], v[140:143]
    ds_read_b64_tr_b16 v[234:235], v4 offset:50432
    s_waitcnt lgkmcnt(6)
    v_mfma_f32_16x16x32_bf16 v[144:147], v[244:247], v[56:59], v[144:147]
    ds_read_b64_tr_b16 v[236:237], v5 offset:49440
    v_mfma_f32_16x16x32_bf16 v[148:151], v[244:247], v[60:63], v[148:151]
    ds_read_b64_tr_b16 v[238:239], v5 offset:50464
    s_waitcnt vmcnt(14) lgkmcnt(6)
    v_mfma_f32_16x16x32_bf16 v[88:91], v[224:227], v[24:27], v[88:91]
    ds_read_b64_tr_b16 v[240:241], v4 offset:49664
    s_waitcnt vmcnt(13)
    v_mfma_f32_16x16x32_bf16 v[92:95], v[224:227], v[28:31], v[92:95]
    s_add_u32 s22, s24, 0x1a2000
    s_add_u32 m0, s20, 0x14400
    s_nop 0
    buffer_load_dwordx4 v3, s[4:7], s22 offen lds
    ds_read_b64_tr_b16 v[242:243], v4 offset:50688
    s_waitcnt lgkmcnt(6)
    v_mfma_f32_16x16x32_bf16 v[96:99], v[228:231], v[24:27], v[96:99]
    ds_read_b64_tr_b16 v[244:245], v5 offset:49696
    s_mov_b32 s23, 0x6000
    buffer_load_dwordx4 v[56:59], v6, s[8:11], s23 offen offset:2048 sc1
    v_mfma_f32_16x16x32_bf16 v[100:103], v[228:231], v[28:31], v[100:103]
    ds_read_b64_tr_b16 v[246:247], v5 offset:50720
    s_waitcnt lgkmcnt(6)
    v_mfma_f32_16x16x32_bf16 v[104:107], v[232:235], v[24:27], v[104:107]
    ds_read_b64_tr_b16 v[224:225], v4 offset:49920
    v_mfma_f32_16x16x32_bf16 v[108:111], v[232:235], v[28:31], v[108:111]
    ds_read_b64_tr_b16 v[226:227], v4 offset:50944
    s_waitcnt lgkmcnt(6)
    v_mfma_f32_16x16x32_bf16 v[112:115], v[236:239], v[24:27], v[112:115]
    ds_read_b64_tr_b16 v[228:229], v5 offset:49952
    v_mfma_f32_16x16x32_bf16 v[116:119], v[236:239], v[28:31], v[116:119]
    ds_read_b64_tr_b16 v[230:231], v5 offset:50976
    s_waitcnt lgkmcnt(6)
    v_mfma_f32_16x16x32_bf16 v[120:123], v[240:243], v[24:27], v[120:123]
    s_mov_b32 s23, 0x26000
    buffer_load_dwordx4 v[60:63], v6, s[8:11], s23 offen offset:2048 sc1
    v_mfma_f32_16x16x32_bf16 v[124:127], v[240:243], v[28:31], v[124:127]
    s_waitcnt vmcnt(14)
    s_barrier
    ds_read_b64_tr_b16 v[232:233], v7 offset:0
    ds_read_b64_tr_b16 v[234:235], v7 offset:1024
    s_waitcnt lgkmcnt(6)
    v_mfma_f32_16x16x32_bf16 v[128:131], v[244:247], v[24:27], v[128:131]
    s_add_u32 s22, s24, 0x220000
    s_add_u32 m0, s20, 0x18000
    s_nop 0
    buffer_load_dwordx4 v3, s[4:7], s22 offen lds
    ds_read_b64_tr_b16 v[236:237], v8 offset:32
    v_mfma_f32_16x16x32_bf16 v[132:135], v[244:247], v[28:31], v[132:135]
    ds_read_b64_tr_b16 v[238:239], v8 offset:1056
    s_waitcnt lgkmcnt(6)
    v_mfma_f32_16x16x32_bf16 v[136:139], v[224:227], v[24:27], v[136:139]
    ds_read_b64_tr_b16 v[240:241], v7 offset:256
    v_mfma_f32_16x16x32_bf16 v[140:143], v[224:227], v[28:31], v[140:143]
    ds_read_b64_tr_b16 v[242:243], v7 offset:1280
    s_waitcnt lgkmcnt(6)
    v_mfma_f32_16x16x32_bf16 v[144:147], v[228:231], v[24:27], v[144:147]
    ds_read_b64_tr_b16 v[244:245], v8 offset:288
    v_mfma_f32_16x16x32_bf16 v[148:151], v[228:231], v[28:31], v[148:151]
    ds_read_b64_tr_b16 v[246:247], v8 offset:1312
    s_waitcnt vmcnt(14) lgkmcnt(6)
    v_mfma_f32_16x16x32_bf16 v[88:91], v[232:235], v[32:35], v[88:91]
    ds_read_b64_tr_b16 v[224:225], v7 offset:512
    s_waitcnt vmcnt(13)
    v_mfma_f32_16x16x32_bf16 v[92:95], v[232:235], v[36:39], v[92:95]
    s_add_u32 s22, s24, 0x222000
    s_add_u32 m0, s20, 0x18400
    s_nop 0
    buffer_load_dwordx4 v3, s[4:7], s22 offen lds
    ds_read_b64_tr_b16 v[226:227], v7 offset:1536
    s_waitcnt lgkmcnt(6)
    v_mfma_f32_16x16x32_bf16 v[96:99], v[236:239], v[32:35], v[96:99]
    ds_read_b64_tr_b16 v[228:229], v8 offset:544
    s_mov_b32 s23, 0x8000
    buffer_load_dwordx4 v[24:27], v6, s[8:11], s23 offen offset:2048 sc1
    v_mfma_f32_16x16x32_bf16 v[100:103], v[236:239], v[36:39], v[100:103]
    ds_read_b64_tr_b16 v[230:231], v8 offset:1568
    s_waitcnt lgkmcnt(6)
    v_mfma_f32_16x16x32_bf16 v[104:107], v[240:243], v[32:35], v[104:107]
    ds_read_b64_tr_b16 v[232:233], v7 offset:768
    v_mfma_f32_16x16x32_bf16 v[108:111], v[240:243], v[36:39], v[108:111]
    ds_read_b64_tr_b16 v[234:235], v7 offset:1792
    s_mov_b32 s16, 0x544000
    buffer_load_dwordx4 v[184:187], v2, s[8:11], s16 offen sc1
    s_waitcnt lgkmcnt(6)
    v_mfma_f32_16x16x32_bf16 v[112:115], v[244:247], v[32:35], v[112:115]
    ds_read_b64_tr_b16 v[236:237], v8 offset:800
    v_mfma_f32_16x16x32_bf16 v[116:119], v[244:247], v[36:39], v[116:119]
    ds_read_b64_tr_b16 v[238:239], v8 offset:1824
    s_waitcnt lgkmcnt(6)
    v_mfma_f32_16x16x32_bf16 v[120:123], v[224:227], v[32:35], v[120:123]
    s_mov_b32 s23, 0x28000
    buffer_load_dwordx4 v[28:31], v6, s[8:11], s23 offen offset:2048 sc1
    v_mfma_f32_16x16x32_bf16 v[124:127], v[224:227], v[36:39], v[124:127]
    s_waitcnt vmcnt(15)
    s_barrier
    ds_read_b64_tr_b16 v[240:241], v7 offset:16384
    ds_read_b64_tr_b16 v[242:243], v7 offset:17408
    s_waitcnt lgkmcnt(6)
    v_mfma_f32_16x16x32_bf16 v[128:131], v[228:231], v[32:35], v[128:131]
    s_add_u32 s22, s24, 0x2a0000
    s_add_u32 m0, s20, 0x1c000
    s_nop 0
    buffer_load_dwordx4 v3, s[4:7], s22 offen lds
    ds_read_b64_tr_b16 v[244:245], v8 offset:16416
    v_mfma_f32_16x16x32_bf16 v[132:135], v[228:231], v[36:39], v[132:135]
    ds_read_b64_tr_b16 v[246:247], v8 offset:17440
    s_waitcnt lgkmcnt(6)
    v_mfma_f32_16x16x32_bf16 v[136:139], v[232:235], v[32:35], v[136:139]
    ds_read_b64_tr_b16 v[224:225], v7 offset:16640
    v_mfma_f32_16x16x32_bf16 v[140:143], v[232:235], v[36:39], v[140:143]
    ds_read_b64_tr_b16 v[226:227], v7 offset:17664
    s_waitcnt lgkmcnt(6)
    v_mfma_f32_16x16x32_bf16 v[144:147], v[236:239], v[32:35], v[144:147]
    ds_read_b64_tr_b16 v[228:229], v8 offset:16672
    v_mfma_f32_16x16x32_bf16 v[148:151], v[236:239], v[36:39], v[148:151]
    ds_read_b64_tr_b16 v[230:231], v8 offset:17696
    s_waitcnt vmcnt(15) lgkmcnt(6)
    v_mfma_f32_16x16x32_bf16 v[88:91], v[240:243], v[40:43], v[88:91]
    ds_read_b64_tr_b16 v[232:233], v7 offset:16896
    s_waitcnt vmcnt(14)
    v_mfma_f32_16x16x32_bf16 v[92:95], v[240:243], v[44:47], v[92:95]
    s_add_u32 s22, s24, 0x2a2000
    s_add_u32 m0, s20, 0x1c400
    s_nop 0
    buffer_load_dwordx4 v3, s[4:7], s22 offen lds
    ds_read_b64_tr_b16 v[234:235], v7 offset:17920
    s_waitcnt lgkmcnt(6)
    v_mfma_f32_16x16x32_bf16 v[96:99], v[244:247], v[40:43], v[96:99]
    ds_read_b64_tr_b16 v[236:237], v8 offset:16928
    s_mov_b32 s23, 0xa000
    buffer_load_dwordx4 v[32:35], v6, s[8:11], s23 offen offset:2048 sc1
    v_mfma_f32_16x16x32_bf16 v[100:103], v[244:247], v[44:47], v[100:103]
    ds_read_b64_tr_b16 v[238:239], v8 offset:17952
    s_waitcnt lgkmcnt(6)
    v_mfma_f32_16x16x32_bf16 v[104:107], v[224:227], v[40:43], v[104:107]
    ds_read_b64_tr_b16 v[240:241], v7 offset:17152
    v_mfma_f32_16x16x32_bf16 v[108:111], v[224:227], v[44:47], v[108:111]
    ds_read_b64_tr_b16 v[242:243], v7 offset:18176
    s_waitcnt lgkmcnt(6)
    v_mfma_f32_16x16x32_bf16 v[112:115], v[228:231], v[40:43], v[112:115]
    ds_read_b64_tr_b16 v[244:245], v8 offset:17184
    v_mfma_f32_16x16x32_bf16 v[116:119], v[228:231], v[44:47], v[116:119]
    ds_read_b64_tr_b16 v[246:247], v8 offset:18208
    s_waitcnt lgkmcnt(6)
    v_mfma_f32_16x16x32_bf16 v[120:123], v[232:235], v[40:43], v[120:123]
    s_mov_b32 s23, 0x2a000
    buffer_load_dwordx4 v[36:39], v6, s[8:11], s23 offen offset:2048 sc1
    v_mfma_f32_16x16x32_bf16 v[124:127], v[232:235], v[44:47], v[124:127]
    s_waitcnt vmcnt(15)
    s_barrier
    ds_read_b64_tr_b16 v[224:225], v4 offset:0
    ds_read_b64_tr_b16 v[226:227], v4 offset:1024
    s_waitcnt lgkmcnt(6)
    v_mfma_f32_16x16x32_bf16 v[128:131], v[236:239], v[40:43], v[128:131]
    s_add_u32 s22, s24, 0x320000
    s_add_u32 m0, s20, 0x20000
    s_nop 0
    buffer_load_dwordx4 v3, s[4:7], s22 offen lds
    ds_read_b64_tr_b16 v[228:229], v5 offset:32
    v_mfma_f32_16x16x32_bf16 v[132:135], v[236:239], v[44:47], v[132:135]
    ds_read_b64_tr_b16 v[230:231], v5 offset:1056
    s_waitcnt lgkmcnt(6)
    v_mfma_f32_16x16x32_bf16 v[136:139], v[240:243], v[40:43], v[136:139]
    ds_read_b64_tr_b16 v[232:233], v4 offset:256
    v_mfma_f32_16x16x32_bf16 v[140:143], v[240:243], v[44:47], v[140:143]
    ds_read_b64_tr_b16 v[234:235], v4 offset:1280
    s_waitcnt lgkmcnt(6)
    v_mfma_f32_16x16x32_bf16 v[144:147], v[244:247], v[40:43], v[144:147]
    ds_read_b64_tr_b16 v[236:237], v5 offset:288
    v_mfma_f32_16x16x32_bf16 v[148:151], v[244:247], v[44:47], v[148:151]
    ds_read_b64_tr_b16 v[238:239], v5 offset:1312
    s_waitcnt vmcnt(15) lgkmcnt(6)
    v_mfma_f32_16x16x32_bf16 v[88:91], v[224:227], v[48:51], v[88:91]
    ds_read_b64_tr_b16 v[240:241], v4 offset:512
    s_waitcnt vmcnt(14)
    v_mfma_f32_16x16x32_bf16 v[92:95], v[224:227], v[52:55], v[92:95]
    s_add_u32 s22, s24, 0x322000
    s_add_u32 m0, s20, 0x20400
    s_nop 0
    buffer_load_dwordx4 v3, s[4:7], s22 offen lds
    ds_read_b64_tr_b16 v[242:243], v4 offset:1536
    s_waitcnt lgkmcnt(6)
    v_mfma_f32_16x16x32_bf16 v[96:99], v[228:231], v[48:51], v[96:99]
    ds_read_b64_tr_b16 v[244:245], v5 offset:544
    s_mov_b32 s23, 0xc000
    buffer_load_dwordx4 v[40:43], v6, s[8:11], s23 offen offset:2048 sc1
    v_mfma_f32_16x16x32_bf16 v[100:103], v[228:231], v[52:55], v[100:103]
    ds_read_b64_tr_b16 v[246:247], v5 offset:1568
    s_waitcnt lgkmcnt(6)
    v_mfma_f32_16x16x32_bf16 v[104:107], v[232:235], v[48:51], v[104:107]
    ds_read_b64_tr_b16 v[224:225], v4 offset:768
    v_mfma_f32_16x16x32_bf16 v[108:111], v[232:235], v[52:55], v[108:111]
    ds_read_b64_tr_b16 v[226:227], v4 offset:1792
    s_waitcnt lgkmcnt(6)
    v_mfma_f32_16x16x32_bf16 v[112:115], v[236:239], v[48:51], v[112:115]
    ds_read_b64_tr_b16 v[228:229], v5 offset:800
    v_mfma_f32_16x16x32_bf16 v[116:119], v[236:239], v[52:55], v[116:119]
    ds_read_b64_tr_b16 v[230:231], v5 offset:1824
    s_waitcnt lgkmcnt(6)
    v_mfma_f32_16x16x32_bf16 v[120:123], v[240:243], v[48:51], v[120:123]
    s_mov_b32 s23, 0x2c000
    buffer_load_dwordx4 v[44:47], v6, s[8:11], s23 offen offset:2048 sc1
    v_mfma_f32_16x16x32_bf16 v[124:127], v[240:243], v[52:55], v[124:127]
    s_waitcnt vmcnt(15)
    s_barrier
    ds_read_b64_tr_b16 v[232:233], v4 offset:16384
    ds_read_b64_tr_b16 v[234:235], v4 offset:17408
    s_add_u32 s19, s19, 8192
    buffer_load_dword v12, v13, s[8:11], s19 offen sc1
    s_waitcnt lgkmcnt(6)
    v_mfma_f32_16x16x32_bf16 v[128:131], v[244:247], v[48:51], v[128:131]
    s_add_u32 s22, s24, 0x3a0000
    s_add_u32 m0, s20, 0x24000
    s_nop 0
    buffer_load_dwordx4 v3, s[4:7], s22 offen lds
    ds_read_b64_tr_b16 v[236:237], v5 offset:16416
    v_mfma_f32_16x16x32_bf16 v[132:135], v[244:247], v[52:55], v[132:135]
    ds_read_b64_tr_b16 v[238:239], v5 offset:17440
    s_waitcnt lgkmcnt(6)
    v_mfma_f32_16x16x32_bf16 v[136:139], v[224:227], v[48:51], v[136:139]
    ds_read_b64_tr_b16 v[240:241], v4 offset:16640
    v_mfma_f32_16x16x32_bf16 v[140:143], v[224:227], v[52:55], v[140:143]
    ds_read_b64_tr_b16 v[242:243], v4 offset:17664
    s_waitcnt lgkmcnt(6)
    v_mfma_f32_16x16x32_bf16 v[144:147], v[228:231], v[48:51], v[144:147]
    ds_read_b64_tr_b16 v[244:245], v5 offset:16672
    v_mfma_f32_16x16x32_bf16 v[148:151], v[228:231], v[52:55], v[148:151]
    ds_read_b64_tr_b16 v[246:247], v5 offset:17696
    s_waitcnt vmcnt(16) lgkmcnt(6)
    v_mfma_f32_16x16x32_bf16 v[88:91], v[232:235], v[56:59], v[88:91]
    ds_read_b64_tr_b16 v[224:225], v4 offset:16896
    s_waitcnt vmcnt(15)
    v_mfma_f32_16x16x32_bf16 v[92:95], v[232:235], v[60:63], v[92:95]
    s_add_u32 s22, s24, 0x3a2000
    s_add_u32 m0, s20, 0x24400
    s_nop 0
    buffer_load_dwordx4 v3, s[4:7], s22 offen lds
    ds_read_b64_tr_b16 v[226:227], v4 offset:17920
    s_waitcnt lgkmcnt(6)
    v_mfma_f32_16x16x32_bf16 v[96:99], v[236:239], v[56:59], v[96:99]
    ds_read_b64_tr_b16 v[228:229], v5 offset:16928
    s_mov_b32 s23, 0xe000
    buffer_load_dwordx4 v[48:51], v6, s[8:11], s23 offen offset:2048 sc1
    v_mfma_f32_16x16x32_bf16 v[100:103], v[236:239], v[60:63], v[100:103]
    ds_read_b64_tr_b16 v[230:231], v5 offset:17952
    s_waitcnt lgkmcnt(6)
    v_mfma_f32_16x16x32_bf16 v[104:107], v[240:243], v[56:59], v[104:107]
    ds_read_b64_tr_b16 v[232:233], v4 offset:17152
    v_mfma_f32_16x16x32_bf16 v[108:111], v[240:243], v[60:63], v[108:111]
    ds_read_b64_tr_b16 v[234:235], v4 offset:18176
    s_waitcnt lgkmcnt(6)
    v_mfma_f32_16x16x32_bf16 v[112:115], v[244:247], v[56:59], v[112:115]
    ds_read_b64_tr_b16 v[236:237], v5 offset:17184
    v_mfma_f32_16x16x32_bf16 v[116:119], v[244:247], v[60:63], v[116:119]
    ds_read_b64_tr_b16 v[238:239], v5 offset:18208
    s_waitcnt lgkmcnt(6)
    v_mfma_f32_16x16x32_bf16 v[120:123], v[224:227], v[56:59], v[120:123]
    s_mov_b32 s23, 0x2e000
    buffer_load_dwordx4 v[52:55], v6, s[8:11], s23 offen offset:2048 sc1
    v_mfma_f32_16x16x32_bf16 v[124:127], v[224:227], v[60:63], v[124:127]
    s_waitcnt vmcnt(16)
    s_barrier
    ds_read_b64_tr_b16 v[240:241], v4 offset:32768
    ds_read_b64_tr_b16 v[242:243], v4 offset:33792
    s_waitcnt lgkmcnt(6)
    v_mfma_f32_16x16x32_bf16 v[128:131], v[228:231], v[56:59], v[128:131]
    s_add_u32 s22, s24, 0x30000
    s_add_u32 m0, s20, 0x10000
    s_nop 0
    buffer_load_dwordx4 v3, s[4:7], s22 offen lds
    ds_read_b64_tr_b16 v[244:245], v5 offset:32800
    v_mfma_f32_16x16x32_bf16 v[132:135], v[228:231], v[60:63], v[132:135]
    ds_read_b64_tr_b16 v[246:247], v5 offset:33824
    s_waitcnt lgkmcnt(6)
    v_mfma_f32_16x16x32_bf16 v[136:139], v[232:235], v[56:59], v[136:139]
    ds_read_b64_tr_b16 v[224:225], v4 offset:33024
    v_mfma_f32_16x16x32_bf16 v[140:143], v[232:235], v[60:63], v[140:143]
    ds_read_b64_tr_b16 v[226:227], v4 offset:34048
    s_waitcnt lgkmcnt(6)
    v_mfma_f32_16x16x32_bf16 v[144:147], v[236:239], v[56:59], v[144:147]
    ds_read_b64_tr_b16 v[228:229], v5 offset:33056
    v_mfma_f32_16x16x32_bf16 v[148:151], v[236:239], v[60:63], v[148:151]
    ds_read_b64_tr_b16 v[230:231], v5 offset:34080
    s_waitcnt vmcnt(5)
    v_cmp_ne_u32 vcc, s28, v12
    s_cbranch_vccnz adaLN_cond__sliding_block_cached__moe_arch_mod__prompt_kernel_o29r
adaLN_cond__sliding_block_cached__moe_arch_mod__prompt_kernel_o29b:
    s_waitcnt lgkmcnt(6)
    v_mfma_f32_16x16x32_bf16 v[88:91], v[240:243], v[24:27], v[88:91]
    ds_read_b64_tr_b16 v[232:233], v4 offset:33280
    v_mfma_f32_16x16x32_bf16 v[92:95], v[240:243], v[28:31], v[92:95]
    s_add_u32 s22, s24, 0x32000
    s_add_u32 m0, s20, 0x10400
    s_nop 0
    buffer_load_dwordx4 v3, s[4:7], s22 offen lds
    ds_read_b64_tr_b16 v[234:235], v4 offset:34304
    s_waitcnt lgkmcnt(6)
    v_mfma_f32_16x16x32_bf16 v[96:99], v[244:247], v[24:27], v[96:99]
    ds_read_b64_tr_b16 v[236:237], v5 offset:33312
    s_mov_b32 s23, 0x0
    buffer_load_dwordx4 v[56:59], v6, s[8:11], s23 offen offset:3072 sc1
    v_mfma_f32_16x16x32_bf16 v[100:103], v[244:247], v[28:31], v[100:103]
    ds_read_b64_tr_b16 v[238:239], v5 offset:34336
    s_waitcnt lgkmcnt(6)
    v_mfma_f32_16x16x32_bf16 v[104:107], v[224:227], v[24:27], v[104:107]
    ds_read_b64_tr_b16 v[240:241], v4 offset:33536
    v_mfma_f32_16x16x32_bf16 v[108:111], v[224:227], v[28:31], v[108:111]
    ds_read_b64_tr_b16 v[242:243], v4 offset:34560
    v_xor_b32 v16, s28, v184
    v_xor_b32 v17, s28, v185
    v_xor_b32 v18, s28, v186
    v_xor_b32 v19, s28, v187
    v_or3_b32 v16, v16, v17, v18
    v_or_b32 v16, v16, v19
    v_cmp_ne_u32 vcc, 0, v16
    s_cbranch_vccnz adaLN_cond__sliding_block_cached__moe_arch_mod__prompt_kernel_mf10r
adaLN_cond__sliding_block_cached__moe_arch_mod__prompt_kernel_mf10b:
    s_waitcnt lgkmcnt(6)
    v_mfma_f32_16x16x32_bf16 v[112:115], v[228:231], v[24:27], v[112:115]
    ds_read_b64_tr_b16 v[244:245], v5 offset:33568
    v_mfma_f32_16x16x32_bf16 v[116:119], v[228:231], v[28:31], v[116:119]
    ds_read_b64_tr_b16 v[246:247], v5 offset:34592
    s_waitcnt lgkmcnt(6)
    v_mfma_f32_16x16x32_bf16 v[120:123], v[232:235], v[24:27], v[120:123]
    s_mov_b32 s23, 0x20000
    buffer_load_dwordx4 v[60:63], v6, s[8:11], s23 offen offset:3072 sc1
    v_mfma_f32_16x16x32_bf16 v[124:127], v[232:235], v[28:31], v[124:127]
    s_barrier
    ds_read_b64_tr_b16 v[224:225], v4 offset:49152
    ds_read_b64_tr_b16 v[226:227], v4 offset:50176
    s_waitcnt lgkmcnt(6)
    v_mfma_f32_16x16x32_bf16 v[128:131], v[236:239], v[24:27], v[128:131]
    s_add_u32 s22, s24, 0xb0000
    s_add_u32 m0, s20, 0x14000
    s_nop 0
    buffer_load_dwordx4 v3, s[4:7], s22 offen lds
    ds_read_b64_tr_b16 v[228:229], v5 offset:49184
    v_mfma_f32_16x16x32_bf16 v[132:135], v[236:239], v[28:31], v[132:135]
    ds_read_b64_tr_b16 v[230:231], v5 offset:50208
    s_waitcnt lgkmcnt(6)
    v_mfma_f32_16x16x32_bf16 v[136:139], v[240:243], v[24:27], v[136:139]
    ds_read_b64_tr_b16 v[232:233], v4 offset:49408
    v_mfma_f32_16x16x32_bf16 v[140:143], v[240:243], v[28:31], v[140:143]
    ds_read_b64_tr_b16 v[234:235], v4 offset:50432
    s_waitcnt lgkmcnt(6)
    v_mfma_f32_16x16x32_bf16 v[144:147], v[244:247], v[24:27], v[144:147]
    ds_read_b64_tr_b16 v[236:237], v5 offset:49440
    v_mfma_f32_16x16x32_bf16 v[148:151], v[244:247], v[28:31], v[148:151]
    ds_read_b64_tr_b16 v[238:239], v5 offset:50464
    s_waitcnt lgkmcnt(6)
    v_mfma_f32_16x16x32_bf16 v[88:91], v[224:227], v[32:35], v[88:91]
    ds_read_b64_tr_b16 v[240:241], v4 offset:49664
    v_mfma_f32_16x16x32_bf16 v[92:95], v[224:227], v[36:39], v[92:95]
    s_add_u32 s22, s24, 0xb2000
    s_add_u32 m0, s20, 0x14400
    s_nop 0
    buffer_load_dwordx4 v3, s[4:7], s22 offen lds
    ds_read_b64_tr_b16 v[242:243], v4 offset:50688
    s_waitcnt lgkmcnt(6)
    v_mfma_f32_16x16x32_bf16 v[96:99], v[228:231], v[32:35], v[96:99]
    ds_read_b64_tr_b16 v[244:245], v5 offset:49696
    s_mov_b32 s23, 0x2000
    buffer_load_dwordx4 v[24:27], v6, s[8:11], s23 offen offset:3072 sc1
    v_mfma_f32_16x16x32_bf16 v[100:103], v[228:231], v[36:39], v[100:103]
    ds_read_b64_tr_b16 v[246:247], v5 offset:50720
    s_waitcnt lgkmcnt(6)
    v_mfma_f32_16x16x32_bf16 v[104:107], v[232:235], v[32:35], v[104:107]
    ds_read_b64_tr_b16 v[224:225], v4 offset:49920
    v_mfma_f32_16x16x32_bf16 v[108:111], v[232:235], v[36:39], v[108:111]
    ds_read_b64_tr_b16 v[226:227], v4 offset:50944
    s_waitcnt lgkmcnt(6)
    v_mfma_f32_16x16x32_bf16 v[112:115], v[236:239], v[32:35], v[112:115]
    ds_read_b64_tr_b16 v[228:229], v5 offset:49952
    v_mfma_f32_16x16x32_bf16 v[116:119], v[236:239], v[36:39], v[116:119]
    ds_read_b64_tr_b16 v[230:231], v5 offset:50976
    s_waitcnt lgkmcnt(6)
    v_mfma_f32_16x16x32_bf16 v[120:123], v[240:243], v[32:35], v[120:123]
    s_mov_b32 s23, 0x22000
    buffer_load_dwordx4 v[28:31], v6, s[8:11], s23 offen offset:3072 sc1
    v_mfma_f32_16x16x32_bf16 v[124:127], v[240:243], v[36:39], v[124:127]
    s_barrier
    ds_read_b64_tr_b16 v[232:233], v7 offset:0
    ds_read_b64_tr_b16 v[234:235], v7 offset:1024
    s_waitcnt lgkmcnt(6)
    v_mfma_f32_16x16x32_bf16 v[128:131], v[244:247], v[32:35], v[128:131]
    s_add_u32 s22, s24, 0x130000
    s_add_u32 m0, s20, 0x18000
    s_nop 0
    buffer_load_dwordx4 v3, s[4:7], s22 offen lds
    ds_read_b64_tr_b16 v[236:237], v8 offset:32
    v_mfma_f32_16x16x32_bf16 v[132:135], v[244:247], v[36:39], v[132:135]
    ds_read_b64_tr_b16 v[238:239], v8 offset:1056
    s_waitcnt lgkmcnt(6)
    v_mfma_f32_16x16x32_bf16 v[136:139], v[224:227], v[32:35], v[136:139]
    ds_read_b64_tr_b16 v[240:241], v7 offset:256
    v_mfma_f32_16x16x32_bf16 v[140:143], v[224:227], v[36:39], v[140:143]
    ds_read_b64_tr_b16 v[242:243], v7 offset:1280
    s_waitcnt lgkmcnt(6)
    v_mfma_f32_16x16x32_bf16 v[144:147], v[228:231], v[32:35], v[144:147]
    ds_read_b64_tr_b16 v[244:245], v8 offset:288
    v_mfma_f32_16x16x32_bf16 v[148:151], v[228:231], v[36:39], v[148:151]
    ds_read_b64_tr_b16 v[246:247], v8 offset:1312
    s_waitcnt lgkmcnt(6)
    v_mfma_f32_16x16x32_bf16 v[88:91], v[232:235], v[40:43], v[88:91]
    ds_read_b64_tr_b16 v[224:225], v7 offset:512
    v_mfma_f32_16x16x32_bf16 v[92:95], v[232:235], v[44:47], v[92:95]
    s_add_u32 s22, s24, 0x132000
    s_add_u32 m0, s20, 0x18400
    s_nop 0
    buffer_load_dwordx4 v3, s[4:7], s22 offen lds
    ds_read_b64_tr_b16 v[226:227], v7 offset:1536
    s_waitcnt lgkmcnt(6)
    v_mfma_f32_16x16x32_bf16 v[96:99], v[236:239], v[40:43], v[96:99]
    ds_read_b64_tr_b16 v[228:229], v8 offset:544
    s_mov_b32 s23, 0x4000
    buffer_load_dwordx4 v[32:35], v6, s[8:11], s23 offen offset:3072 sc1
    v_mfma_f32_16x16x32_bf16 v[100:103], v[236:239], v[44:47], v[100:103]
    ds_read_b64_tr_b16 v[230:231], v8 offset:1568
    s_waitcnt lgkmcnt(6)
    v_mfma_f32_16x16x32_bf16 v[104:107], v[240:243], v[40:43], v[104:107]
    ds_read_b64_tr_b16 v[232:233], v7 offset:768
    v_mfma_f32_16x16x32_bf16 v[108:111], v[240:243], v[44:47], v[108:111]
    ds_read_b64_tr_b16 v[234:235], v7 offset:1792
    s_waitcnt lgkmcnt(6)
    v_mfma_f32_16x16x32_bf16 v[112:115], v[244:247], v[40:43], v[112:115]
    ds_read_b64_tr_b16 v[236:237], v8 offset:800
    v_mfma_f32_16x16x32_bf16 v[116:119], v[244:247], v[44:47], v[116:119]
    ds_read_b64_tr_b16 v[238:239], v8 offset:1824
    s_waitcnt lgkmcnt(6)
    v_mfma_f32_16x16x32_bf16 v[120:123], v[224:227], v[40:43], v[120:123]
    s_mov_b32 s23, 0x24000
    buffer_load_dwordx4 v[36:39], v6, s[8:11], s23 offen offset:3072 sc1
    v_mfma_f32_16x16x32_bf16 v[124:127], v[224:227], v[44:47], v[124:127]
    s_waitcnt vmcnt(14)
    s_barrier
    ds_read_b64_tr_b16 v[240:241], v7 offset:16384
    ds_read_b64_tr_b16 v[242:243], v7 offset:17408
    s_waitcnt lgkmcnt(6)
    v_mfma_f32_16x16x32_bf16 v[128:131], v[228:231], v[40:43], v[128:131]
    s_add_u32 s22, s24, 0x1b0000
    s_add_u32 m0, s20, 0x1c000
    s_nop 0
    buffer_load_dwordx4 v3, s[4:7], s22 offen lds
    ds_read_b64_tr_b16 v[244:245], v8 offset:16416
    v_mfma_f32_16x16x32_bf16 v[132:135], v[228:231], v[44:47], v[132:135]
    ds_read_b64_tr_b16 v[246:247], v8 offset:17440
    s_waitcnt lgkmcnt(6)
    v_mfma_f32_16x16x32_bf16 v[136:139], v[232:235], v[40:43], v[136:139]
    ds_read_b64_tr_b16 v[224:225], v7 offset:16640
    v_mfma_f32_16x16x32_bf16 v[140:143], v[232:235], v[44:47], v[140:143]
    ds_read_b64_tr_b16 v[226:227], v7 offset:17664
    s_waitcnt lgkmcnt(6)
    v_mfma_f32_16x16x32_bf16 v[144:147], v[236:239], v[40:43], v[144:147]
    ds_read_b64_tr_b16 v[228:229], v8 offset:16672
    v_mfma_f32_16x16x32_bf16 v[148:151], v[236:239], v[44:47], v[148:151]
    ds_read_b64_tr_b16 v[230:231], v8 offset:17696
    s_waitcnt vmcnt(14) lgkmcnt(6)
    v_mfma_f32_16x16x32_bf16 v[88:91], v[240:243], v[48:51], v[88:91]
    ds_read_b64_tr_b16 v[232:233], v7 offset:16896
    s_waitcnt vmcnt(13)
    v_mfma_f32_16x16x32_bf16 v[92:95], v[240:243], v[52:55], v[92:95]
    s_add_u32 s22, s24, 0x1b2000
    s_add_u32 m0, s20, 0x1c400
    s_nop 0
    buffer_load_dwordx4 v3, s[4:7], s22 offen lds
    ds_read_b64_tr_b16 v[234:235], v7 offset:17920
    s_waitcnt lgkmcnt(6)
    v_mfma_f32_16x16x32_bf16 v[96:99], v[244:247], v[48:51], v[96:99]
    ds_read_b64_tr_b16 v[236:237], v8 offset:16928
    s_mov_b32 s23, 0x6000
    buffer_load_dwordx4 v[40:43], v6, s[8:11], s23 offen offset:3072 sc1
    v_mfma_f32_16x16x32_bf16 v[100:103], v[244:247], v[52:55], v[100:103]
    ds_read_b64_tr_b16 v[238:239], v8 offset:17952
    s_waitcnt lgkmcnt(6)
    v_mfma_f32_16x16x32_bf16 v[104:107], v[224:227], v[48:51], v[104:107]
    ds_read_b64_tr_b16 v[240:241], v7 offset:17152
    v_mfma_f32_16x16x32_bf16 v[108:111], v[224:227], v[52:55], v[108:111]
    ds_read_b64_tr_b16 v[242:243], v7 offset:18176
    s_waitcnt lgkmcnt(6)
    v_mfma_f32_16x16x32_bf16 v[112:115], v[228:231], v[48:51], v[112:115]
    ds_read_b64_tr_b16 v[244:245], v8 offset:17184
    v_mfma_f32_16x16x32_bf16 v[116:119], v[228:231], v[52:55], v[116:119]
    ds_read_b64_tr_b16 v[246:247], v8 offset:18208
    s_waitcnt lgkmcnt(6)
    v_mfma_f32_16x16x32_bf16 v[120:123], v[232:235], v[48:51], v[120:123]
    s_mov_b32 s23, 0x26000
    buffer_load_dwordx4 v[44:47], v6, s[8:11], s23 offen offset:3072 sc1
    v_mfma_f32_16x16x32_bf16 v[124:127], v[232:235], v[52:55], v[124:127]
    s_waitcnt vmcnt(14)
    s_barrier
    ds_read_b64_tr_b16 v[224:225], v4 offset:0
    ds_read_b64_tr_b16 v[226:227], v4 offset:1024
    s_waitcnt lgkmcnt(6)
    v_mfma_f32_16x16x32_bf16 v[128:131], v[236:239], v[48:51], v[128:131]
    s_add_u32 s22, s24, 0x230000
    s_add_u32 m0, s20, 0x20000
    s_nop 0
    buffer_load_dwordx4 v3, s[4:7], s22 offen lds
    ds_read_b64_tr_b16 v[228:229], v5 offset:32
    v_mfma_f32_16x16x32_bf16 v[132:135], v[236:239], v[52:55], v[132:135]
    ds_read_b64_tr_b16 v[230:231], v5 offset:1056
    s_waitcnt lgkmcnt(6)
    v_mfma_f32_16x16x32_bf16 v[136:139], v[240:243], v[48:51], v[136:139]
    ds_read_b64_tr_b16 v[232:233], v4 offset:256
    v_mfma_f32_16x16x32_bf16 v[140:143], v[240:243], v[52:55], v[140:143]
    ds_read_b64_tr_b16 v[234:235], v4 offset:1280
    s_waitcnt lgkmcnt(6)
    v_mfma_f32_16x16x32_bf16 v[144:147], v[244:247], v[48:51], v[144:147]
    ds_read_b64_tr_b16 v[236:237], v5 offset:288
    v_mfma_f32_16x16x32_bf16 v[148:151], v[244:247], v[52:55], v[148:151]
    ds_read_b64_tr_b16 v[238:239], v5 offset:1312
    s_waitcnt vmcnt(14) lgkmcnt(6)
    v_mfma_f32_16x16x32_bf16 v[88:91], v[224:227], v[56:59], v[88:91]
    ds_read_b64_tr_b16 v[240:241], v4 offset:512
    s_waitcnt vmcnt(13)
    v_mfma_f32_16x16x32_bf16 v[92:95], v[224:227], v[60:63], v[92:95]
    s_add_u32 s22, s24, 0x232000
    s_add_u32 m0, s20, 0x20400
    s_nop 0
    buffer_load_dwordx4 v3, s[4:7], s22 offen lds
    ds_read_b64_tr_b16 v[242:243], v4 offset:1536
    s_waitcnt lgkmcnt(6)
    v_mfma_f32_16x16x32_bf16 v[96:99], v[228:231], v[56:59], v[96:99]
    ds_read_b64_tr_b16 v[244:245], v5 offset:544
    s_mov_b32 s23, 0x8000
    buffer_load_dwordx4 v[48:51], v6, s[8:11], s23 offen offset:3072 sc1
    v_mfma_f32_16x16x32_bf16 v[100:103], v[228:231], v[60:63], v[100:103]
    ds_read_b64_tr_b16 v[246:247], v5 offset:1568
    s_waitcnt lgkmcnt(6)
    v_mfma_f32_16x16x32_bf16 v[104:107], v[232:235], v[56:59], v[104:107]
    ds_read_b64_tr_b16 v[224:225], v4 offset:768
    v_mfma_f32_16x16x32_bf16 v[108:111], v[232:235], v[60:63], v[108:111]
    ds_read_b64_tr_b16 v[226:227], v4 offset:1792
    s_waitcnt lgkmcnt(6)
    v_mfma_f32_16x16x32_bf16 v[112:115], v[236:239], v[56:59], v[112:115]
    ds_read_b64_tr_b16 v[228:229], v5 offset:800
    v_mfma_f32_16x16x32_bf16 v[116:119], v[236:239], v[60:63], v[116:119]
    ds_read_b64_tr_b16 v[230:231], v5 offset:1824
    s_waitcnt lgkmcnt(6)
    v_mfma_f32_16x16x32_bf16 v[120:123], v[240:243], v[56:59], v[120:123]
    s_mov_b32 s23, 0x28000
    buffer_load_dwordx4 v[52:55], v6, s[8:11], s23 offen offset:3072 sc1
    v_mfma_f32_16x16x32_bf16 v[124:127], v[240:243], v[60:63], v[124:127]
    s_waitcnt vmcnt(14)
    s_barrier
    ds_read_b64_tr_b16 v[232:233], v4 offset:16384
    ds_read_b64_tr_b16 v[234:235], v4 offset:17408
    s_waitcnt lgkmcnt(6)
    v_mfma_f32_16x16x32_bf16 v[128:131], v[244:247], v[56:59], v[128:131]
    s_add_u32 s22, s24, 0x2b0000
    s_add_u32 m0, s20, 0x24000
    s_nop 0
    buffer_load_dwordx4 v3, s[4:7], s22 offen lds
    ds_read_b64_tr_b16 v[236:237], v5 offset:16416
    v_mfma_f32_16x16x32_bf16 v[132:135], v[244:247], v[60:63], v[132:135]
    ds_read_b64_tr_b16 v[238:239], v5 offset:17440
    s_waitcnt lgkmcnt(6)
    v_mfma_f32_16x16x32_bf16 v[136:139], v[224:227], v[56:59], v[136:139]
    ds_read_b64_tr_b16 v[240:241], v4 offset:16640
    v_mfma_f32_16x16x32_bf16 v[140:143], v[224:227], v[60:63], v[140:143]
    ds_read_b64_tr_b16 v[242:243], v4 offset:17664
    s_waitcnt lgkmcnt(6)
    v_mfma_f32_16x16x32_bf16 v[144:147], v[228:231], v[56:59], v[144:147]
    ds_read_b64_tr_b16 v[244:245], v5 offset:16672
    v_mfma_f32_16x16x32_bf16 v[148:151], v[228:231], v[60:63], v[148:151]
    ds_read_b64_tr_b16 v[246:247], v5 offset:17696
    s_waitcnt vmcnt(14) lgkmcnt(6)
    v_mfma_f32_16x16x32_bf16 v[88:91], v[232:235], v[24:27], v[88:91]
    ds_read_b64_tr_b16 v[224:225], v4 offset:16896
    s_waitcnt vmcnt(13)
    v_mfma_f32_16x16x32_bf16 v[92:95], v[232:235], v[28:31], v[92:95]
    s_add_u32 s22, s24, 0x2b2000
    s_add_u32 m0, s20, 0x24400
    s_nop 0
    buffer_load_dwordx4 v3, s[4:7], s22 offen lds
    ds_read_b64_tr_b16 v[226:227], v4 offset:17920
    s_waitcnt lgkmcnt(6)
    v_mfma_f32_16x16x32_bf16 v[96:99], v[236:239], v[24:27], v[96:99]
    ds_read_b64_tr_b16 v[228:229], v5 offset:16928
    s_mov_b32 s23, 0xa000
    buffer_load_dwordx4 v[56:59], v6, s[8:11], s23 offen offset:3072 sc1
    v_mfma_f32_16x16x32_bf16 v[100:103], v[236:239], v[28:31], v[100:103]
    ds_read_b64_tr_b16 v[230:231], v5 offset:17952
    s_waitcnt lgkmcnt(6)
    v_mfma_f32_16x16x32_bf16 v[104:107], v[240:243], v[24:27], v[104:107]
    ds_read_b64_tr_b16 v[232:233], v4 offset:17152
    v_mfma_f32_16x16x32_bf16 v[108:111], v[240:243], v[28:31], v[108:111]
    ds_read_b64_tr_b16 v[234:235], v4 offset:18176
    s_waitcnt lgkmcnt(6)
    v_mfma_f32_16x16x32_bf16 v[112:115], v[244:247], v[24:27], v[112:115]
    ds_read_b64_tr_b16 v[236:237], v5 offset:17184
    v_mfma_f32_16x16x32_bf16 v[116:119], v[244:247], v[28:31], v[116:119]
    ds_read_b64_tr_b16 v[238:239], v5 offset:18208
    s_waitcnt lgkmcnt(6)
    v_mfma_f32_16x16x32_bf16 v[120:123], v[224:227], v[24:27], v[120:123]
    s_mov_b32 s23, 0x2a000
    buffer_load_dwordx4 v[60:63], v6, s[8:11], s23 offen offset:3072 sc1
    v_mfma_f32_16x16x32_bf16 v[124:127], v[224:227], v[28:31], v[124:127]
    s_waitcnt vmcnt(14)
    s_barrier
    ds_read_b64_tr_b16 v[240:241], v4 offset:32768
    ds_read_b64_tr_b16 v[242:243], v4 offset:33792
    s_waitcnt lgkmcnt(6)
    v_mfma_f32_16x16x32_bf16 v[128:131], v[228:231], v[24:27], v[128:131]
    s_add_u32 s22, s24, 0x330000
    s_add_u32 m0, s20, 0x10000
    s_nop 0
    buffer_load_dwordx4 v3, s[4:7], s22 offen lds
    ds_read_b64_tr_b16 v[244:245], v5 offset:32800
    v_mfma_f32_16x16x32_bf16 v[132:135], v[228:231], v[28:31], v[132:135]
    ds_read_b64_tr_b16 v[246:247], v5 offset:33824
    s_waitcnt lgkmcnt(6)
    v_mfma_f32_16x16x32_bf16 v[136:139], v[232:235], v[24:27], v[136:139]
    ds_read_b64_tr_b16 v[224:225], v4 offset:33024
    v_mfma_f32_16x16x32_bf16 v[140:143], v[232:235], v[28:31], v[140:143]
    ds_read_b64_tr_b16 v[226:227], v4 offset:34048
    s_waitcnt lgkmcnt(6)
    v_mfma_f32_16x16x32_bf16 v[144:147], v[236:239], v[24:27], v[144:147]
    ds_read_b64_tr_b16 v[228:229], v5 offset:33056
    v_mfma_f32_16x16x32_bf16 v[148:151], v[236:239], v[28:31], v[148:151]
    ds_read_b64_tr_b16 v[230:231], v5 offset:34080
    s_waitcnt vmcnt(14) lgkmcnt(6)
    v_mfma_f32_16x16x32_bf16 v[88:91], v[240:243], v[32:35], v[88:91]
    ds_read_b64_tr_b16 v[232:233], v4 offset:33280
    s_waitcnt vmcnt(13)
    v_mfma_f32_16x16x32_bf16 v[92:95], v[240:243], v[36:39], v[92:95]
    s_add_u32 s22, s24, 0x332000
    s_add_u32 m0, s20, 0x10400
    s_nop 0
    buffer_load_dwordx4 v3, s[4:7], s22 offen lds
    ds_read_b64_tr_b16 v[234:235], v4 offset:34304
    s_waitcnt lgkmcnt(6)
    v_mfma_f32_16x16x32_bf16 v[96:99], v[244:247], v[32:35], v[96:99]
    ds_read_b64_tr_b16 v[236:237], v5 offset:33312
    s_mov_b32 s23, 0xc000
    buffer_load_dwordx4 v[24:27], v6, s[8:11], s23 offen offset:3072 sc1
    v_mfma_f32_16x16x32_bf16 v[100:103], v[244:247], v[36:39], v[100:103]
    ds_read_b64_tr_b16 v[238:239], v5 offset:34336
    s_waitcnt lgkmcnt(6)
    v_mfma_f32_16x16x32_bf16 v[104:107], v[224:227], v[32:35], v[104:107]
    ds_read_b64_tr_b16 v[240:241], v4 offset:33536
    v_mfma_f32_16x16x32_bf16 v[108:111], v[224:227], v[36:39], v[108:111]
    ds_read_b64_tr_b16 v[242:243], v4 offset:34560
    v_lshrrev_b32 v16, 4, v1
    v_lshlrev_b32 v16, 3, v16
    s_lshl_b32 s16, s31, 8
    s_add_u32 s16, s16, 0x540000
    buffer_load_dwordx2 v[248:249], v16, s[8:11], s16 offen offset:0 sc1
    buffer_load_dwordx2 v[250:251], v16, s[8:11], s16 offen offset:32 sc1
    buffer_load_dwordx2 v[252:253], v16, s[8:11], s16 offen offset:64 sc1
    buffer_load_dwordx2 v[254:255], v16, s[8:11], s16 offen offset:96 sc1
    s_waitcnt lgkmcnt(6)
    v_mfma_f32_16x16x32_bf16 v[112:115], v[228:231], v[32:35], v[112:115]
    ds_read_b64_tr_b16 v[244:245], v5 offset:33568
    v_mfma_f32_16x16x32_bf16 v[116:119], v[228:231], v[36:39], v[116:119]
    ds_read_b64_tr_b16 v[246:247], v5 offset:34592
    s_waitcnt lgkmcnt(6)
    v_mfma_f32_16x16x32_bf16 v[120:123], v[232:235], v[32:35], v[120:123]
    s_mov_b32 s23, 0x2c000
    buffer_load_dwordx4 v[28:31], v6, s[8:11], s23 offen offset:3072 sc1
    v_mfma_f32_16x16x32_bf16 v[124:127], v[232:235], v[36:39], v[124:127]
    s_waitcnt vmcnt(18)
    s_barrier
    ds_read_b64_tr_b16 v[224:225], v4 offset:49152
    ds_read_b64_tr_b16 v[226:227], v4 offset:50176
    s_waitcnt lgkmcnt(6)
    v_mfma_f32_16x16x32_bf16 v[128:131], v[236:239], v[32:35], v[128:131]
    s_add_u32 s22, s24, 0x3b0000
    s_add_u32 m0, s20, 0x14000
    s_nop 0
    buffer_load_dwordx4 v3, s[4:7], s22 offen lds
    ds_read_b64_tr_b16 v[228:229], v5 offset:49184
    v_mfma_f32_16x16x32_bf16 v[132:135], v[236:239], v[36:39], v[132:135]
    ds_read_b64_tr_b16 v[230:231], v5 offset:50208
    s_waitcnt lgkmcnt(6)
    v_mfma_f32_16x16x32_bf16 v[136:139], v[240:243], v[32:35], v[136:139]
    ds_read_b64_tr_b16 v[232:233], v4 offset:49408
    v_mfma_f32_16x16x32_bf16 v[140:143], v[240:243], v[36:39], v[140:143]
    ds_read_b64_tr_b16 v[234:235], v4 offset:50432
    s_waitcnt lgkmcnt(6)
    v_mfma_f32_16x16x32_bf16 v[144:147], v[244:247], v[32:35], v[144:147]
    ds_read_b64_tr_b16 v[236:237], v5 offset:49440
    v_mfma_f32_16x16x32_bf16 v[148:151], v[244:247], v[36:39], v[148:151]
    ds_read_b64_tr_b16 v[238:239], v5 offset:50464
    s_waitcnt vmcnt(18) lgkmcnt(6)
    v_mfma_f32_16x16x32_bf16 v[88:91], v[224:227], v[40:43], v[88:91]
    ds_read_b64_tr_b16 v[240:241], v4 offset:49664
    s_waitcnt vmcnt(17)
    v_mfma_f32_16x16x32_bf16 v[92:95], v[224:227], v[44:47], v[92:95]
    s_add_u32 s22, s24, 0x3b2000
    s_add_u32 m0, s20, 0x14400
    s_nop 0
    buffer_load_dwordx4 v3, s[4:7], s22 offen lds
    ds_read_b64_tr_b16 v[242:243], v4 offset:50688
    s_waitcnt lgkmcnt(6)
    v_mfma_f32_16x16x32_bf16 v[96:99], v[228:231], v[40:43], v[96:99]
    ds_read_b64_tr_b16 v[244:245], v5 offset:49696
    s_mov_b32 s23, 0xe000
    buffer_load_dwordx4 v[32:35], v6, s[8:11], s23 offen offset:3072 sc1
    v_mfma_f32_16x16x32_bf16 v[100:103], v[228:231], v[44:47], v[100:103]
    ds_read_b64_tr_b16 v[246:247], v5 offset:50720
    s_waitcnt lgkmcnt(6)
    v_mfma_f32_16x16x32_bf16 v[104:107], v[232:235], v[40:43], v[104:107]
    ds_read_b64_tr_b16 v[224:225], v4 offset:49920
    v_mfma_f32_16x16x32_bf16 v[108:111], v[232:235], v[44:47], v[108:111]
    ds_read_b64_tr_b16 v[226:227], v4 offset:50944
    s_waitcnt lgkmcnt(6)
    v_mfma_f32_16x16x32_bf16 v[112:115], v[236:239], v[40:43], v[112:115]
    ds_read_b64_tr_b16 v[228:229], v5 offset:49952
    v_mfma_f32_16x16x32_bf16 v[116:119], v[236:239], v[44:47], v[116:119]
    ds_read_b64_tr_b16 v[230:231], v5 offset:50976
    s_waitcnt lgkmcnt(6)
    v_mfma_f32_16x16x32_bf16 v[120:123], v[240:243], v[40:43], v[120:123]
    s_mov_b32 s23, 0x2e000
    buffer_load_dwordx4 v[36:39], v6, s[8:11], s23 offen offset:3072 sc1
    v_mfma_f32_16x16x32_bf16 v[124:127], v[240:243], v[44:47], v[124:127]
    s_waitcnt vmcnt(18)
    s_barrier
    ds_read_b64_tr_b16 v[232:233], v7 offset:0
    ds_read_b64_tr_b16 v[234:235], v7 offset:1024
    s_waitcnt lgkmcnt(6)
    v_mfma_f32_16x16x32_bf16 v[128:131], v[244:247], v[40:43], v[128:131]
    ds_read_b64_tr_b16 v[236:237], v8 offset:32
    v_mfma_f32_16x16x32_bf16 v[132:135], v[244:247], v[44:47], v[132:135]
    ds_read_b64_tr_b16 v[238:239], v8 offset:1056
    s_waitcnt lgkmcnt(6)
    v_mfma_f32_16x16x32_bf16 v[136:139], v[224:227], v[40:43], v[136:139]
    ds_read_b64_tr_b16 v[240:241], v7 offset:256
    v_mfma_f32_16x16x32_bf16 v[140:143], v[224:227], v[44:47], v[140:143]
    ds_read_b64_tr_b16 v[242:243], v7 offset:1280
    s_waitcnt lgkmcnt(6)
    v_mfma_f32_16x16x32_bf16 v[144:147], v[228:231], v[40:43], v[144:147]
    ds_read_b64_tr_b16 v[244:245], v8 offset:288
    v_mfma_f32_16x16x32_bf16 v[148:151], v[228:231], v[44:47], v[148:151]
    ds_read_b64_tr_b16 v[246:247], v8 offset:1312
    s_waitcnt vmcnt(17) lgkmcnt(6)
    v_mfma_f32_16x16x32_bf16 v[88:91], v[232:235], v[48:51], v[88:91]
    ds_read_b64_tr_b16 v[224:225], v7 offset:512
    s_waitcnt vmcnt(16)
    v_mfma_f32_16x16x32_bf16 v[92:95], v[232:235], v[52:55], v[92:95]
    ds_read_b64_tr_b16 v[226:227], v7 offset:1536
    s_waitcnt lgkmcnt(6)
    v_mfma_f32_16x16x32_bf16 v[96:99], v[236:239], v[48:51], v[96:99]
    ds_read_b64_tr_b16 v[228:229], v8 offset:544
    v_mfma_f32_16x16x32_bf16 v[100:103], v[236:239], v[52:55], v[100:103]
    ds_read_b64_tr_b16 v[230:231], v8 offset:1568
    s_waitcnt lgkmcnt(6)
    v_mfma_f32_16x16x32_bf16 v[104:107], v[240:243], v[48:51], v[104:107]
    ds_read_b64_tr_b16 v[232:233], v7 offset:768
    v_mfma_f32_16x16x32_bf16 v[108:111], v[240:243], v[52:55], v[108:111]
    ds_read_b64_tr_b16 v[234:235], v7 offset:1792
    s_waitcnt lgkmcnt(6)
    v_mfma_f32_16x16x32_bf16 v[112:115], v[244:247], v[48:51], v[112:115]
    ds_read_b64_tr_b16 v[236:237], v8 offset:800
    v_mfma_f32_16x16x32_bf16 v[116:119], v[244:247], v[52:55], v[116:119]
    ds_read_b64_tr_b16 v[238:239], v8 offset:1824
    s_waitcnt lgkmcnt(6)
    v_mfma_f32_16x16x32_bf16 v[120:123], v[224:227], v[48:51], v[120:123]
    v_mfma_f32_16x16x32_bf16 v[124:127], v[224:227], v[52:55], v[124:127]
    s_waitcnt vmcnt(14)
    s_barrier
    ds_read_b64_tr_b16 v[240:241], v7 offset:16384
    ds_read_b64_tr_b16 v[242:243], v7 offset:17408
    s_waitcnt lgkmcnt(6)
    v_mfma_f32_16x16x32_bf16 v[128:131], v[228:231], v[48:51], v[128:131]
    ds_read_b64_tr_b16 v[244:245], v8 offset:16416
    v_mfma_f32_16x16x32_bf16 v[132:135], v[228:231], v[52:55], v[132:135]
    ds_read_b64_tr_b16 v[246:247], v8 offset:17440
    s_waitcnt lgkmcnt(6)
    v_mfma_f32_16x16x32_bf16 v[136:139], v[232:235], v[48:51], v[136:139]
    ds_read_b64_tr_b16 v[224:225], v7 offset:16640
    v_mfma_f32_16x16x32_bf16 v[140:143], v[232:235], v[52:55], v[140:143]
    ds_read_b64_tr_b16 v[226:227], v7 offset:17664
    s_waitcnt lgkmcnt(6)
    v_mfma_f32_16x16x32_bf16 v[144:147], v[236:239], v[48:51], v[144:147]
    ds_read_b64_tr_b16 v[228:229], v8 offset:16672
    v_mfma_f32_16x16x32_bf16 v[148:151], v[236:239], v[52:55], v[148:151]
    ds_read_b64_tr_b16 v[230:231], v8 offset:17696
    s_waitcnt vmcnt(13) lgkmcnt(6)
    v_mfma_f32_16x16x32_bf16 v[88:91], v[240:243], v[56:59], v[88:91]
    ds_read_b64_tr_b16 v[232:233], v7 offset:16896
    s_waitcnt vmcnt(12)
    v_mfma_f32_16x16x32_bf16 v[92:95], v[240:243], v[60:63], v[92:95]
    ds_read_b64_tr_b16 v[234:235], v7 offset:17920
    s_waitcnt lgkmcnt(6)
    v_mfma_f32_16x16x32_bf16 v[96:99], v[244:247], v[56:59], v[96:99]
    ds_read_b64_tr_b16 v[236:237], v8 offset:16928
    v_mfma_f32_16x16x32_bf16 v[100:103], v[244:247], v[60:63], v[100:103]
    ds_read_b64_tr_b16 v[238:239], v8 offset:17952
    s_waitcnt lgkmcnt(6)
    v_mfma_f32_16x16x32_bf16 v[104:107], v[224:227], v[56:59], v[104:107]
    ds_read_b64_tr_b16 v[240:241], v7 offset:17152
    v_mfma_f32_16x16x32_bf16 v[108:111], v[224:227], v[60:63], v[108:111]
    ds_read_b64_tr_b16 v[242:243], v7 offset:18176
    s_waitcnt lgkmcnt(6)
    v_mfma_f32_16x16x32_bf16 v[112:115], v[228:231], v[56:59], v[112:115]
    ds_read_b64_tr_b16 v[244:245], v8 offset:17184
    v_mfma_f32_16x16x32_bf16 v[116:119], v[228:231], v[60:63], v[116:119]
    ds_read_b64_tr_b16 v[246:247], v8 offset:18208
    s_waitcnt lgkmcnt(6)
    v_mfma_f32_16x16x32_bf16 v[120:123], v[232:235], v[56:59], v[120:123]
    v_mfma_f32_16x16x32_bf16 v[124:127], v[232:235], v[60:63], v[124:127]
    s_waitcnt vmcnt(10)
    s_barrier
    ds_read_b64_tr_b16 v[224:225], v4 offset:0
    ds_read_b64_tr_b16 v[226:227], v4 offset:1024
    s_waitcnt lgkmcnt(6)
    v_mfma_f32_16x16x32_bf16 v[128:131], v[236:239], v[56:59], v[128:131]
    ds_read_b64_tr_b16 v[228:229], v5 offset:32
    v_mfma_f32_16x16x32_bf16 v[132:135], v[236:239], v[60:63], v[132:135]
    ds_read_b64_tr_b16 v[230:231], v5 offset:1056
    s_waitcnt lgkmcnt(6)
    v_mfma_f32_16x16x32_bf16 v[136:139], v[240:243], v[56:59], v[136:139]
    ds_read_b64_tr_b16 v[232:233], v4 offset:256
    v_mfma_f32_16x16x32_bf16 v[140:143], v[240:243], v[60:63], v[140:143]
    ds_read_b64_tr_b16 v[234:235], v4 offset:1280
    s_waitcnt lgkmcnt(6)
    v_mfma_f32_16x16x32_bf16 v[144:147], v[244:247], v[56:59], v[144:147]
    ds_read_b64_tr_b16 v[236:237], v5 offset:288
    v_mfma_f32_16x16x32_bf16 v[148:151], v[244:247], v[60:63], v[148:151]
    ds_read_b64_tr_b16 v[238:239], v5 offset:1312
    s_waitcnt vmcnt(9) lgkmcnt(6)
    v_mfma_f32_16x16x32_bf16 v[88:91], v[224:227], v[24:27], v[88:91]
    ds_read_b64_tr_b16 v[240:241], v4 offset:512
    s_waitcnt vmcnt(4)
    v_mfma_f32_16x16x32_bf16 v[92:95], v[224:227], v[28:31], v[92:95]
    ds_read_b64_tr_b16 v[242:243], v4 offset:1536
    s_waitcnt lgkmcnt(6)
    v_mfma_f32_16x16x32_bf16 v[96:99], v[228:231], v[24:27], v[96:99]
    ds_read_b64_tr_b16 v[244:245], v5 offset:544
    v_mfma_f32_16x16x32_bf16 v[100:103], v[228:231], v[28:31], v[100:103]
    ds_read_b64_tr_b16 v[246:247], v5 offset:1568
    s_waitcnt lgkmcnt(6)
    v_mfma_f32_16x16x32_bf16 v[104:107], v[232:235], v[24:27], v[104:107]
    ds_read_b64_tr_b16 v[224:225], v4 offset:768
    v_mfma_f32_16x16x32_bf16 v[108:111], v[232:235], v[28:31], v[108:111]
    ds_read_b64_tr_b16 v[226:227], v4 offset:1792
    s_waitcnt lgkmcnt(6)
    v_mfma_f32_16x16x32_bf16 v[112:115], v[236:239], v[24:27], v[112:115]
    ds_read_b64_tr_b16 v[228:229], v5 offset:800
    v_mfma_f32_16x16x32_bf16 v[116:119], v[236:239], v[28:31], v[116:119]
    ds_read_b64_tr_b16 v[230:231], v5 offset:1824
    s_waitcnt lgkmcnt(6)
    v_mfma_f32_16x16x32_bf16 v[120:123], v[240:243], v[24:27], v[120:123]
    v_mfma_f32_16x16x32_bf16 v[124:127], v[240:243], v[28:31], v[124:127]
    s_waitcnt vmcnt(2)
    s_barrier
    ds_read_b64_tr_b16 v[232:233], v4 offset:16384
    ds_read_b64_tr_b16 v[234:235], v4 offset:17408
    s_waitcnt lgkmcnt(6)
    v_mfma_f32_16x16x32_bf16 v[128:131], v[244:247], v[24:27], v[128:131]
    ds_read_b64_tr_b16 v[236:237], v5 offset:16416
    v_mfma_f32_16x16x32_bf16 v[132:135], v[244:247], v[28:31], v[132:135]
    ds_read_b64_tr_b16 v[238:239], v5 offset:17440
    s_waitcnt lgkmcnt(6)
    v_mfma_f32_16x16x32_bf16 v[136:139], v[224:227], v[24:27], v[136:139]
    ds_read_b64_tr_b16 v[240:241], v4 offset:16640
    v_mfma_f32_16x16x32_bf16 v[140:143], v[224:227], v[28:31], v[140:143]
    ds_read_b64_tr_b16 v[242:243], v4 offset:17664
    s_waitcnt lgkmcnt(6)
    v_mfma_f32_16x16x32_bf16 v[144:147], v[228:231], v[24:27], v[144:147]
    ds_read_b64_tr_b16 v[244:245], v5 offset:16672
    v_mfma_f32_16x16x32_bf16 v[148:151], v[228:231], v[28:31], v[148:151]
    ds_read_b64_tr_b16 v[246:247], v5 offset:17696
    s_waitcnt vmcnt(1) lgkmcnt(6)
    v_mfma_f32_16x16x32_bf16 v[88:91], v[232:235], v[32:35], v[88:91]
    ds_read_b64_tr_b16 v[224:225], v4 offset:16896
    s_waitcnt vmcnt(0)
    v_mfma_f32_16x16x32_bf16 v[92:95], v[232:235], v[36:39], v[92:95]
    ds_read_b64_tr_b16 v[226:227], v4 offset:17920
    s_waitcnt lgkmcnt(6)
    v_mfma_f32_16x16x32_bf16 v[96:99], v[236:239], v[32:35], v[96:99]
    ds_read_b64_tr_b16 v[228:229], v5 offset:16928
    v_mfma_f32_16x16x32_bf16 v[100:103], v[236:239], v[36:39], v[100:103]
    ds_read_b64_tr_b16 v[230:231], v5 offset:17952
    s_waitcnt lgkmcnt(6)
    v_mfma_f32_16x16x32_bf16 v[104:107], v[240:243], v[32:35], v[104:107]
    ds_read_b64_tr_b16 v[232:233], v4 offset:17152
    v_mfma_f32_16x16x32_bf16 v[108:111], v[240:243], v[36:39], v[108:111]
    ds_read_b64_tr_b16 v[234:235], v4 offset:18176
    s_waitcnt lgkmcnt(6)
    v_mfma_f32_16x16x32_bf16 v[112:115], v[244:247], v[32:35], v[112:115]
    ds_read_b64_tr_b16 v[236:237], v5 offset:17184
    v_mfma_f32_16x16x32_bf16 v[116:119], v[244:247], v[36:39], v[116:119]
    ds_read_b64_tr_b16 v[238:239], v5 offset:18208
    s_waitcnt lgkmcnt(6)
    v_mfma_f32_16x16x32_bf16 v[120:123], v[224:227], v[32:35], v[120:123]
    v_mfma_f32_16x16x32_bf16 v[124:127], v[224:227], v[36:39], v[124:127]
    s_waitcnt lgkmcnt(4)
    v_mfma_f32_16x16x32_bf16 v[128:131], v[228:231], v[32:35], v[128:131]
    v_mfma_f32_16x16x32_bf16 v[132:135], v[228:231], v[36:39], v[132:135]
    s_waitcnt lgkmcnt(2)
    v_mfma_f32_16x16x32_bf16 v[136:139], v[232:235], v[32:35], v[136:139]
    v_mfma_f32_16x16x32_bf16 v[140:143], v[232:235], v[36:39], v[140:143]
    s_waitcnt lgkmcnt(0)
    v_mfma_f32_16x16x32_bf16 v[144:147], v[236:239], v[32:35], v[144:147]
    v_mfma_f32_16x16x32_bf16 v[148:151], v[236:239], v[36:39], v[148:151]
    s_lshl_b32 s16, s3, 13
    s_xor_b32 s17, s16, 0x8000
    s_add_u32 s16, s16, 0x18000
    s_add_u32 s17, s17, 0x18000
    v_add_u32 v16, s16, v2
    s_mov_b32 s16, s17
    v_add_u32 v17, s16, v2
    ds_write_b128 v16, v[120:123] offset:0
    ds_write_b128 v16, v[124:127] offset:1024
    ds_write_b128 v16, v[128:131] offset:2048
    ds_write_b128 v16, v[132:135] offset:3072
    ds_write_b128 v16, v[136:139] offset:4096
    ds_write_b128 v16, v[140:143] offset:5120
    ds_write_b128 v16, v[144:147] offset:6144
    ds_write_b128 v16, v[148:151] offset:7168
    v_lshlrev_b32 v24, 16, v248
    v_and_b32 v25, 0xffff0000, v248
    v_lshlrev_b32 v26, 16, v249
    v_and_b32 v27, 0xffff0000, v249
    v_lshlrev_b32 v28, 16, v250
    v_and_b32 v29, 0xffff0000, v250
    v_lshlrev_b32 v30, 16, v251
    v_and_b32 v31, 0xffff0000, v251
    v_lshlrev_b32 v32, 16, v252
    v_and_b32 v33, 0xffff0000, v252
    v_lshlrev_b32 v34, 16, v253
    v_and_b32 v35, 0xffff0000, v253
    v_lshlrev_b32 v36, 16, v254
    v_and_b32 v37, 0xffff0000, v254
    v_lshlrev_b32 v38, 16, v255
    v_and_b32 v39, 0xffff0000, v255
    v_and_b32 v18, 15, v1
    v_lshlrev_b32 v18, 6, v18
    v_lshrrev_b32 v19, 4, v1
    v_and_b32 v20, 1, v19
    v_lshl_add_u32 v18, v20, 5, v18
    v_lshrrev_b32 v19, 1, v19
    v_lshl_add_u32 v18, v19, 4, v18
    s_and_b32 s17, s3, 3
    s_lshl_b32 s18, s30, 2
    s_add_u32 s18, s18, s17
    s_lshl_b32 s18, s18, 16
    s_lshl_b32 s19, s15, 22
    s_add_u32 s18, s18, s19
    s_lshl_b32 s19, s31, 12
    s_add_u32 s18, s18, s19
    s_add_u32 s18, s18, 0x2c00000
    s_add_u32 s19, s18, 32768
    s_waitcnt lgkmcnt(0)
    s_barrier
    ds_read_b128 v[40:43], v17 offset:0
    ds_read_b128 v[44:47], v17 offset:1024
    ds_read_b128 v[48:51], v17 offset:2048
    ds_read_b128 v[52:55], v17 offset:3072
    ds_read_b128 v[56:59], v17 offset:4096
    ds_read_b128 v[60:63], v17 offset:5120
    ds_read_b128 v[64:67], v17 offset:6144
    ds_read_b128 v[68:71], v17 offset:7168
    s_waitcnt lgkmcnt(7)
    v_pk_add_f32 v[88:89], v[88:89], v[40:41]
    v_pk_add_f32 v[90:91], v[90:91], v[42:43]
    v_pk_mul_f32 v[88:89], v[88:89], v[24:25]
    v_pk_mul_f32 v[90:91], v[90:91], v[26:27]
    v_cvt_pk_bf16_f32 v224, v88, v89
    v_cvt_pk_bf16_f32 v225, v90, v91
    s_waitcnt lgkmcnt(5)
    v_pk_add_f32 v[96:97], v[96:97], v[48:49]
    v_pk_add_f32 v[98:99], v[98:99], v[50:51]
    v_pk_mul_f32 v[96:97], v[96:97], v[28:29]
    v_pk_mul_f32 v[98:99], v[98:99], v[30:31]
    v_cvt_pk_bf16_f32 v226, v96, v97
    v_cvt_pk_bf16_f32 v227, v98, v99
    s_nop 0
    v_permlane16_swap_b32 v224, v226
    v_permlane16_swap_b32 v225, v227
    buffer_store_dwordx4 v[224:227], v18, s[8:11], s18 offen offset:0 sc1
    v_pk_add_f32 v[92:93], v[92:93], v[44:45]
    v_pk_add_f32 v[94:95], v[94:95], v[46:47]
    v_pk_mul_f32 v[92:93], v[92:93], v[24:25]
    v_pk_mul_f32 v[94:95], v[94:95], v[26:27]
    v_cvt_pk_bf16_f32 v228, v92, v93
    v_cvt_pk_bf16_f32 v229, v94, v95
    s_waitcnt lgkmcnt(4)
    v_pk_add_f32 v[100:101], v[100:101], v[52:53]
    v_pk_add_f32 v[102:103], v[102:103], v[54:55]
    v_pk_mul_f32 v[100:101], v[100:101], v[28:29]
    v_pk_mul_f32 v[102:103], v[102:103], v[30:31]
    v_cvt_pk_bf16_f32 v230, v100, v101
    v_cvt_pk_bf16_f32 v231, v102, v103
    s_nop 0
    v_permlane16_swap_b32 v228, v230
    v_permlane16_swap_b32 v229, v231
    buffer_store_dwordx4 v[228:231], v18, s[8:11], s19 offen offset:0 sc1
    s_waitcnt lgkmcnt(3)
    v_pk_add_f32 v[104:105], v[104:105], v[56:57]
    v_pk_add_f32 v[106:107], v[106:107], v[58:59]
    v_pk_mul_f32 v[104:105], v[104:105], v[32:33]
    v_pk_mul_f32 v[106:107], v[106:107], v[34:35]
    v_cvt_pk_bf16_f32 v232, v104, v105
    v_cvt_pk_bf16_f32 v233, v106, v107
    s_waitcnt lgkmcnt(1)
    v_pk_add_f32 v[112:113], v[112:113], v[64:65]
    v_pk_add_f32 v[114:115], v[114:115], v[66:67]
    v_pk_mul_f32 v[112:113], v[112:113], v[36:37]
    v_pk_mul_f32 v[114:115], v[114:115], v[38:39]
    v_cvt_pk_bf16_f32 v234, v112, v113
    v_cvt_pk_bf16_f32 v235, v114, v115
    s_nop 0
    v_permlane16_swap_b32 v232, v234
    v_permlane16_swap_b32 v233, v235
    buffer_store_dwordx4 v[232:235], v18, s[8:11], s18 offen offset:1024 sc1
    v_pk_add_f32 v[108:109], v[108:109], v[60:61]
    v_pk_add_f32 v[110:111], v[110:111], v[62:63]
    v_pk_mul_f32 v[108:109], v[108:109], v[32:33]
    v_pk_mul_f32 v[110:111], v[110:111], v[34:35]
    v_cvt_pk_bf16_f32 v236, v108, v109
    v_cvt_pk_bf16_f32 v237, v110, v111
    s_waitcnt lgkmcnt(0)
    v_pk_add_f32 v[116:117], v[116:117], v[68:69]
    v_pk_add_f32 v[118:119], v[118:119], v[70:71]
    v_pk_mul_f32 v[116:117], v[116:117], v[36:37]
    v_pk_mul_f32 v[118:119], v[118:119], v[38:39]
    v_cvt_pk_bf16_f32 v238, v116, v117
    v_cvt_pk_bf16_f32 v239, v118, v119
    s_nop 0
    v_permlane16_swap_b32 v236, v238
    v_permlane16_swap_b32 v237, v239
    buffer_store_dwordx4 v[236:239], v18, s[8:11], s19 offen offset:1024 sc1
    s_mov_b64 s[64:65], s[44:45]
    s_mov_b32 s66, 0x800
    s_mov_b32 s67, 0x20000
    s_mov_b64 s[76:77], s[32:33]
    s_mov_b32 s78, 0x400000
    s_mov_b32 s79, 0x20000
    s_mov_b64 s[68:69], s[56:57]
    s_mov_b32 s70, 0x400000
    s_mov_b32 s71, 0x20000
    s_lshl_b32 s14, s31, 1
    s_add_u32 s14, s14, s15
    s_lshl_b32 s14, s14, 3
    s_add_u32 s14, s14, s3
    s_lshl_b32 s16, s30, 7
    s_add_u32 s14, s14, s16
    s_lshl_b32 s16, s14, 11
    buffer_load_dwordx4 v[216:219], v2, s[76:79], s16 offen offset:0
    buffer_load_dwordx4 v[220:223], v2, s[76:79], s16 offen offset:1024
    s_lshl_b32 s16, s3, 10
    s_add_u32 m0, s16, 81920
    s_add_u32 s16, s16, 0x540800
    buffer_load_dwordx4 v2, s[8:11], s16 offen sc1 lds
    s_lshl_b32 s16, s30, 5
    s_lshl_b32 s17, s31, 1
    s_add_u32 s16, s16, s17
    s_add_u32 s16, s16, s15
    s_lshl_b32 s16, s16, 2
    s_add_u32 s16, s16, 0x530000
    s_cmp_eq_u32 s3, 0
    s_cselect_b32 s16, s16, 0x7ffffff0
    v_mov_b32 v16, s28
    v_mov_b32 v17, 0
    s_lshr_b32 s18, s14, 4
    s_lshl_b32 s18, s18, 15
    s_and_b32 s19, s14, 15
    s_lshl_b32 s19, s19, 6
    s_add_u32 s18, s18, s19
    s_add_u32 s18, s18, 0x2c00000
    s_add_u32 s19, s18, 16384
    v_lshrrev_b32 v18, 2, v1
    v_lshlrev_b32 v18, 10, v18
    v_and_b32 v19, 3, v1
    v_lshl_add_u32 v18, v19, 4, v18
    v_add_u32 v19, 0x400000, v18
    s_lshl_b32 s25, s30, 7
    s_add_u32 s25, s25, 0x530000
    v_and_b32 v20, 15, v1
    v_lshlrev_b32 v20, 2, v20
    s_waitcnt vmcnt(3)
    s_waitcnt vmcnt(0)
    s_barrier
    s_mov_b64 exec, 1
    buffer_store_dword v16, v17, s[8:11], s16 offen sc1
    s_mov_b64 exec, -1
    v_add_u32 v16, 81920, v2
    ds_read_b128 v[184:187], v16 offset:0
    ds_read_b128 v[188:191], v16 offset:1024
    ds_read_b128 v[192:195], v16 offset:2048
    ds_read_b128 v[196:199], v16 offset:3072
    ds_read_b128 v[200:203], v16 offset:4096
    ds_read_b128 v[204:207], v16 offset:5120
    ds_read_b128 v[208:211], v16 offset:6144
    ds_read_b128 v[212:215], v16 offset:7168
    v_mov_b32 v94, 0
    v_mov_b32 v95, 0
    s_waitcnt lgkmcnt(5)
    v_lshlrev_b32 v76, 16, v192
    v_and_b32 v77, 0xffff0000, v192
    s_waitcnt lgkmcnt(1)
    v_lshlrev_b32 v78, 16, v208
    v_and_b32 v79, 0xffff0000, v208
    v_pk_mul_f32 v[60:61], v[76:77], v[78:79]
    v_lshlrev_b32 v76, 16, v184
    v_and_b32 v77, 0xffff0000, v184
    v_fmac_f32 v94, v76, v78
    v_fmac_f32 v94, v77, v79
    v_add_f32 v95, v95, v60
    v_add_f32 v95, v95, v61
    v_lshlrev_b32 v76, 16, v193
    v_and_b32 v77, 0xffff0000, v193
    v_lshlrev_b32 v78, 16, v209
    v_and_b32 v79, 0xffff0000, v209
    v_pk_mul_f32 v[62:63], v[76:77], v[78:79]
    v_lshlrev_b32 v76, 16, v185
    v_and_b32 v77, 0xffff0000, v185
    v_fmac_f32 v94, v76, v78
    v_fmac_f32 v94, v77, v79
    v_add_f32 v95, v95, v62
    v_add_f32 v95, v95, v63
    v_lshlrev_b32 v76, 16, v194
    v_and_b32 v77, 0xffff0000, v194
    v_lshlrev_b32 v78, 16, v210
    v_and_b32 v79, 0xffff0000, v210
    v_pk_mul_f32 v[64:65], v[76:77], v[78:79]
    v_lshlrev_b32 v76, 16, v186
    v_and_b32 v77, 0xffff0000, v186
    v_fmac_f32 v94, v76, v78
    v_fmac_f32 v94, v77, v79
    v_add_f32 v95, v95, v64
    v_add_f32 v95, v95, v65
    v_lshlrev_b32 v76, 16, v195
    v_and_b32 v77, 0xffff0000, v195
    v_lshlrev_b32 v78, 16, v211
    v_and_b32 v79, 0xffff0000, v211
    v_pk_mul_f32 v[66:67], v[76:77], v[78:79]
    v_lshlrev_b32 v76, 16, v187
    v_and_b32 v77, 0xffff0000, v187
    v_fmac_f32 v94, v76, v78
    v_fmac_f32 v94, v77, v79
    v_add_f32 v95, v95, v66
    v_add_f32 v95, v95, v67
    v_lshlrev_b32 v76, 16, v196
    v_and_b32 v77, 0xffff0000, v196
    s_waitcnt lgkmcnt(0)
    v_lshlrev_b32 v78, 16, v212
    v_and_b32 v79, 0xffff0000, v212
    v_pk_mul_f32 v[68:69], v[76:77], v[78:79]
    v_lshlrev_b32 v76, 16, v188
    v_and_b32 v77, 0xffff0000, v188
    v_fmac_f32 v94, v76, v78
    v_fmac_f32 v94, v77, v79
    v_add_f32 v95, v95, v68
    v_add_f32 v95, v95, v69
    v_lshlrev_b32 v76, 16, v197
    v_and_b32 v77, 0xffff0000, v197
    v_lshlrev_b32 v78, 16, v213
    v_and_b32 v79, 0xffff0000, v213
    v_pk_mul_f32 v[70:71], v[76:77], v[78:79]
    v_lshlrev_b32 v76, 16, v189
    v_and_b32 v77, 0xffff0000, v189
    v_fmac_f32 v94, v76, v78
    v_fmac_f32 v94, v77, v79
    v_add_f32 v95, v95, v70
    v_add_f32 v95, v95, v71
    v_lshlrev_b32 v76, 16, v198
    v_and_b32 v77, 0xffff0000, v198
    v_lshlrev_b32 v78, 16, v214
    v_and_b32 v79, 0xffff0000, v214
    v_pk_mul_f32 v[72:73], v[76:77], v[78:79]
    v_lshlrev_b32 v76, 16, v190
    v_and_b32 v77, 0xffff0000, v190
    v_fmac_f32 v94, v76, v78
    v_fmac_f32 v94, v77, v79
    v_add_f32 v95, v95, v72
    v_add_f32 v95, v95, v73
    v_lshlrev_b32 v76, 16, v199
    v_and_b32 v77, 0xffff0000, v199
    v_lshlrev_b32 v78, 16, v215
    v_and_b32 v79, 0xffff0000, v215
    v_pk_mul_f32 v[74:75], v[76:77], v[78:79]
    v_lshlrev_b32 v76, 16, v191
    v_and_b32 v77, 0xffff0000, v191
    v_fmac_f32 v94, v76, v78
    v_fmac_f32 v94, v77, v79
    v_add_f32 v95, v95, v74
    v_add_f32 v95, v95, v75
    v_add_f32_dpp v94, v94, v94 row_ror:1 row_mask:0xf bank_mask:0xf
    s_nop 0
    v_add_f32_dpp v95, v95, v95 row_ror:1 row_mask:0xf bank_mask:0xf
    v_add_f32_dpp v94, v94, v94 row_ror:2 row_mask:0xf bank_mask:0xf
    s_nop 0
    v_add_f32_dpp v95, v95, v95 row_ror:2 row_mask:0xf bank_mask:0xf
    v_add_f32_dpp v94, v94, v94 row_ror:4 row_mask:0xf bank_mask:0xf
    s_nop 0
    v_add_f32_dpp v95, v95, v95 row_ror:4 row_mask:0xf bank_mask:0xf
    v_add_f32_dpp v94, v94, v94 row_ror:8 row_mask:0xf bank_mask:0xf
    s_nop 0
    v_add_f32_dpp v95, v95, v95 row_ror:8 row_mask:0xf bank_mask:0xf
    v_mov_b32 v76, v94
    s_nop 1
    v_permlane16_swap_b32 v94, v76
    v_add_f32 v94, v94, v76
    v_mov_b32 v77, v95
    s_nop 1
    v_permlane16_swap_b32 v95, v77
    v_add_f32 v95, v95, v77
    v_mov_b32 v76, v94
    s_nop 1
    v_permlane32_swap_b32 v94, v76
    v_add_f32 v94, v94, v76
    v_mov_b32 v77, v95
    s_nop 1
    v_permlane32_swap_b32 v95, v77
    v_add_f32 v95, v95, v77
    v_lshlrev_b32 v28, 16, v216
    v_and_b32 v29, 0xffff0000, v216
    v_lshlrev_b32 v30, 16, v217
    v_and_b32 v31, 0xffff0000, v217
    v_lshlrev_b32 v32, 16, v218
    v_and_b32 v33, 0xffff0000, v218
    v_lshlrev_b32 v34, 16, v219
    v_and_b32 v35, 0xffff0000, v219
    v_lshlrev_b32 v36, 16, v220
    v_and_b32 v37, 0xffff0000, v220
    v_lshlrev_b32 v38, 16, v221
    v_and_b32 v39, 0xffff0000, v221
    v_lshlrev_b32 v40, 16, v222
    v_and_b32 v41, 0xffff0000, v222
    v_lshlrev_b32 v42, 16, v223
    v_and_b32 v43, 0xffff0000, v223
    s_sleep 16
    s_mov_b32 s27, 0
adaLN_cond__sliding_block_cached__moe_arch_mod__prompt_kernel_a11p:
    buffer_load_dword v76, v20, s[8:11], s25 offen sc1
    s_waitcnt vmcnt(0)
    v_cmp_ne_u32 vcc, s28, v76
    s_add_u32 s27, s27, 1
    s_cmp_ge_u32 s27, 262144
    s_cbranch_scc1 adaLN_cond__sliding_block_cached__moe_arch_mod__prompt_kernel_a11g
    s_cbranch_vccnz adaLN_cond__sliding_block_cached__moe_arch_mod__prompt_kernel_a11p
adaLN_cond__sliding_block_cached__moe_arch_mod__prompt_kernel_a11g:
    buffer_load_dwordx4 v[44:47], v18, s[8:11], s18 offen sc1
    buffer_load_dwordx4 v[52:55], v19, s[8:11], s18 offen sc1
    buffer_load_dwordx4 v[48:51], v18, s[8:11], s19 offen sc1
    buffer_load_dwordx4 v[56:59], v19, s[8:11], s19 offen sc1
    v_lshlrev_b32 v21, 2, v0
    s_mov_b32 s16, 0x540800
    buffer_load_dword v106, v21, s[8:11], s16 offen sc1
    buffer_load_dword v104, v21, s[8:11], s16 offen offset:2048 sc1
    s_waitcnt vmcnt(5)
    v_lshlrev_b32 v76, 16, v44
    v_and_b32 v77, 0xffff0000, v44
    s_waitcnt vmcnt(4)
    v_lshlrev_b32 v78, 16, v52
    v_and_b32 v79, 0xffff0000, v52
    v_pk_add_f32 v[76:77], v[76:77], v[78:79]
    v_pk_add_f32 v[28:29], v[28:29], v[76:77]
    v_cvt_pk_bf16_f32 v16, v28, v29
    v_lshlrev_b32 v28, 16, v16
    v_and_b32 v29, 0xffff0000, v16
    v_lshlrev_b32 v80, 16, v45
    v_and_b32 v81, 0xffff0000, v45
    v_lshlrev_b32 v82, 16, v53
    v_and_b32 v83, 0xffff0000, v53
    v_pk_add_f32 v[80:81], v[80:81], v[82:83]
    v_pk_add_f32 v[30:31], v[30:31], v[80:81]
    v_cvt_pk_bf16_f32 v17, v30, v31
    v_lshlrev_b32 v30, 16, v17
    v_and_b32 v31, 0xffff0000, v17
    v_lshlrev_b32 v76, 16, v46
    v_and_b32 v77, 0xffff0000, v46
    v_lshlrev_b32 v78, 16, v54
    v_and_b32 v79, 0xffff0000, v54
    v_pk_add_f32 v[76:77], v[76:77], v[78:79]
    v_pk_add_f32 v[32:33], v[32:33], v[76:77]
    v_cvt_pk_bf16_f32 v16, v32, v33
    v_lshlrev_b32 v32, 16, v16
    v_and_b32 v33, 0xffff0000, v16
    v_lshlrev_b32 v80, 16, v47
    v_and_b32 v81, 0xffff0000, v47
    v_lshlrev_b32 v82, 16, v55
    v_and_b32 v83, 0xffff0000, v55
    v_pk_add_f32 v[80:81], v[80:81], v[82:83]
    v_pk_add_f32 v[34:35], v[34:35], v[80:81]
    v_cvt_pk_bf16_f32 v17, v34, v35
    v_lshlrev_b32 v34, 16, v17
    v_and_b32 v35, 0xffff0000, v17
    s_waitcnt vmcnt(3)
    v_lshlrev_b32 v76, 16, v48
    v_and_b32 v77, 0xffff0000, v48
    s_waitcnt vmcnt(2)
    v_lshlrev_b32 v78, 16, v56
    v_and_b32 v79, 0xffff0000, v56
    v_pk_add_f32 v[76:77], v[76:77], v[78:79]
    v_pk_add_f32 v[36:37], v[36:37], v[76:77]
    v_cvt_pk_bf16_f32 v16, v36, v37
    v_lshlrev_b32 v36, 16, v16
    v_and_b32 v37, 0xffff0000, v16
    v_lshlrev_b32 v80, 16, v49
    v_and_b32 v81, 0xffff0000, v49
    v_lshlrev_b32 v82, 16, v57
    v_and_b32 v83, 0xffff0000, v57
    v_pk_add_f32 v[80:81], v[80:81], v[82:83]
    v_pk_add_f32 v[38:39], v[38:39], v[80:81]
    v_cvt_pk_bf16_f32 v17, v38, v39
    v_lshlrev_b32 v38, 16, v17
    v_and_b32 v39, 0xffff0000, v17
    v_lshlrev_b32 v76, 16, v50
    v_and_b32 v77, 0xffff0000, v50
    v_lshlrev_b32 v78, 16, v58
    v_and_b32 v79, 0xffff0000, v58
    v_pk_add_f32 v[76:77], v[76:77], v[78:79]
    v_pk_add_f32 v[40:41], v[40:41], v[76:77]
    v_cvt_pk_bf16_f32 v16, v40, v41
    v_lshlrev_b32 v40, 16, v16
    v_and_b32 v41, 0xffff0000, v16
    v_lshlrev_b32 v80, 16, v51
    v_and_b32 v81, 0xffff0000, v51
    v_lshlrev_b32 v82, 16, v59
    v_and_b32 v83, 0xffff0000, v59
    v_pk_add_f32 v[80:81], v[80:81], v[82:83]
    v_pk_add_f32 v[42:43], v[42:43], v[80:81]
    v_cvt_pk_bf16_f32 v17, v42, v43
    v_lshlrev_b32 v42, 16, v17
    v_and_b32 v43, 0xffff0000, v17
    v_pk_add_f32 v[76:77], v[28:29], v[30:31]
    v_pk_mul_f32 v[78:79], v[28:29], v[28:29]
    v_pk_mul_f32 v[80:81], v[28:29], v[60:61]
    v_pk_fma_f32 v[78:79], v[30:31], v[30:31], v[78:79]
    v_pk_fma_f32 v[80:81], v[30:31], v[62:63], v[80:81]
    v_pk_add_f32 v[76:77], v[76:77], v[32:33]
    v_pk_fma_f32 v[78:79], v[32:33], v[32:33], v[78:79]
    v_pk_fma_f32 v[80:81], v[32:33], v[64:65], v[80:81]
    v_pk_add_f32 v[76:77], v[76:77], v[34:35]
    v_pk_fma_f32 v[78:79], v[34:35], v[34:35], v[78:79]
    v_pk_fma_f32 v[80:81], v[34:35], v[66:67], v[80:81]
    v_pk_add_f32 v[76:77], v[76:77], v[36:37]
    v_pk_fma_f32 v[78:79], v[36:37], v[36:37], v[78:79]
    v_pk_fma_f32 v[80:81], v[36:37], v[68:69], v[80:81]
    v_pk_add_f32 v[76:77], v[76:77], v[38:39]
    v_pk_fma_f32 v[78:79], v[38:39], v[38:39], v[78:79]
    v_pk_fma_f32 v[80:81], v[38:39], v[70:71], v[80:81]
    v_pk_add_f32 v[76:77], v[76:77], v[40:41]
    v_pk_fma_f32 v[78:79], v[40:41], v[40:41], v[78:79]
    v_pk_fma_f32 v[80:81], v[40:41], v[72:73], v[80:81]
    v_pk_add_f32 v[76:77], v[76:77], v[42:43]
    v_pk_fma_f32 v[78:79], v[42:43], v[42:43], v[78:79]
    v_pk_fma_f32 v[80:81], v[42:43], v[74:75], v[80:81]
    v_add_f32 v96, v76, v77
    v_add_f32 v97, v78, v79
    v_add_f32 v98, v80, v81
    v_add_f32_dpp v96, v96, v96 row_ror:1 row_mask:0xf bank_mask:0xf
    v_add_f32_dpp v97, v97, v97 row_ror:1 row_mask:0xf bank_mask:0xf
    v_add_f32_dpp v98, v98, v98 row_ror:1 row_mask:0xf bank_mask:0xf
    v_add_f32_dpp v96, v96, v96 row_ror:2 row_mask:0xf bank_mask:0xf
    v_add_f32_dpp v97, v97, v97 row_ror:2 row_mask:0xf bank_mask:0xf
    v_add_f32_dpp v98, v98, v98 row_ror:2 row_mask:0xf bank_mask:0xf
    v_add_f32_dpp v96, v96, v96 row_ror:4 row_mask:0xf bank_mask:0xf
    v_add_f32_dpp v97, v97, v97 row_ror:4 row_mask:0xf bank_mask:0xf
    v_add_f32_dpp v98, v98, v98 row_ror:4 row_mask:0xf bank_mask:0xf
    v_add_f32_dpp v96, v96, v96 row_ror:8 row_mask:0xf bank_mask:0xf
    v_add_f32_dpp v97, v97, v97 row_ror:8 row_mask:0xf bank_mask:0xf
    v_add_f32_dpp v98, v98, v98 row_ror:8 row_mask:0xf bank_mask:0xf
    v_mov_b32 v76, v96
    s_nop 1
    v_permlane16_swap_b32 v96, v76
    v_add_f32 v96, v96, v76
    v_mov_b32 v77, v97
    s_nop 1
    v_permlane16_swap_b32 v97, v77
    v_add_f32 v97, v97, v77
    v_mov_b32 v78, v98
    s_nop 1
    v_permlane16_swap_b32 v98, v78
    v_add_f32 v98, v98, v78
    v_mov_b32 v76, v96
    s_nop 1
    v_permlane32_swap_b32 v96, v76
    v_add_f32 v96, v96, v76
    v_mov_b32 v77, v97
    s_nop 1
    v_permlane32_swap_b32 v97, v77
    v_add_f32 v97, v97, v77
    v_mov_b32 v78, v98
    s_nop 1
    v_permlane32_swap_b32 v98, v78
    v_add_f32 v98, v98, v78
    v_mul_f32 v96, 0x3a800000, v96
    v_mul_f32 v97, 0x3a800000, v97
    v_fma_f32 v97, -v96, v96, v97
    v_max_f32 v97, 0, v97
    v_fma_f32 v98, -v96, v95, v98
    v_add_f32 v76, 0x3727c5ac, v97
    v_rsq_f32 v76, v76
    s_nop 0
    v_fma_f32 v27, v98, v76, v94
    v_cvt_pk_bf16_f32 v96, v96, v96
    v_lshlrev_b32 v96, 16, v96
    v_cvt_pk_bf16_f32 v97, v97, v97
    v_lshlrev_b32 v97, 16, v97
    v_add_f32 v97, 0x3727c5ac, v97
    v_cvt_pk_bf16_f32 v97, v97, v97
    v_lshlrev_b32 v97, 16, v97
    v_sqrt_f32 v98, v97
    s_nop 0
    v_cvt_pk_bf16_f32 v98, v98, v98
    v_lshlrev_b32 v98, 16, v98
    v_rcp_f32 v99, v98
    v_mov_b32 v25, v96
    v_mov_b32 v26, v98
    v_ashrrev_i32 v16, 31, v27
    v_or_b32 v16, 0x80000000, v16
    v_xor_b32 v24, v27, v16
    v_and_b32 v24, 0xfffff800, v24
    v_max_u32 v24, 0x800, v24
    s_sub_u32 s16, 2047, s14
    v_or_b32 v24, s16, v24
    s_lshl_b32 s16, s3, 4
    s_add_u32 s16, s16, 65536
    v_mov_b32 v16, s16
    ds_write_b128 v16, v[24:27]
    s_waitcnt lgkmcnt(0)
    s_barrier
    v_and_b32 v16, 7, v1
    v_lshlrev_b32 v16, 4, v16
    v_add_u32 v16, 65536, v16
    ds_read_b32 v76, v16
    s_waitcnt lgkmcnt(0)
    v_mov_b32 v77, v76
    s_nop 1
    v_max_u32_dpp v77, v77, v77 row_ror:1 row_mask:0xf bank_mask:0xf
    s_nop 1
    v_max_u32_dpp v77, v77, v77 row_ror:2 row_mask:0xf bank_mask:0xf
    s_nop 1
    v_max_u32_dpp v77, v77, v77 row_ror:4 row_mask:0xf bank_mask:0xf
    v_cmp_eq_u32 vcc, v76, v77
    s_ff1_i32_b64 s16, vcc
    s_lshl_b32 s16, s16, 4
    s_add_u32 s16, s16, 65536
    v_mov_b32 v16, s16
    ds_read_b128 v[24:27], v16
    s_lshl_b32 s16, s2, 4
    s_add_u32 s16, s16, 0x6e0000
    s_cmp_eq_u32 s3, 0
    s_cselect_b32 s16, s16, 0x7ffffff0
    v_mov_b32 v17, 0
    s_mov_b64 exec, 1
    s_waitcnt lgkmcnt(0)
    buffer_store_dwordx4 v[24:27], v17, s[8:11], s16 offen sc1
    s_mov_b64 exec, -1
    v_sub_f32 v44, v28, v96
    v_sub_f32 v45, v29, v96
    v_sub_f32 v46, v30, v96
    v_sub_f32 v47, v31, v96
    v_sub_f32 v48, v32, v96
    v_sub_f32 v49, v33, v96
    v_sub_f32 v50, v34, v96
    v_sub_f32 v51, v35, v96
    v_cvt_pk_bf16_f32 v16, v44, v45
    v_lshlrev_b32 v44, 16, v16
    v_and_b32 v45, 0xffff0000, v16
    v_cvt_pk_bf16_f32 v16, v46, v47
    v_lshlrev_b32 v46, 16, v16
    v_and_b32 v47, 0xffff0000, v16
    v_cvt_pk_bf16_f32 v16, v48, v49
    v_lshlrev_b32 v48, 16, v16
    v_and_b32 v49, 0xffff0000, v16
    v_cvt_pk_bf16_f32 v16, v50, v51
    v_lshlrev_b32 v50, 16, v16
    v_and_b32 v51, 0xffff0000, v16
    v_mul_f32 v52, v44, v99
    v_mul_f32 v53, v45, v99
    v_mul_f32 v54, v46, v99
    v_mul_f32 v55, v47, v99
    v_mul_f32 v56, v48, v99
    v_mul_f32 v57, v49, v99
    v_mul_f32 v58, v50, v99
    v_mul_f32 v59, v51, v99
    v_fma_f32 v44, -v52, v98, v44
    v_fma_f32 v45, -v53, v98, v45
    v_fma_f32 v46, -v54, v98, v46
    v_fma_f32 v47, -v55, v98, v47
    v_fma_f32 v48, -v56, v98, v48
    v_fma_f32 v49, -v57, v98, v49
    v_fma_f32 v50, -v58, v98, v50
    v_fma_f32 v51, -v59, v98, v51
    v_fma_f32 v44, v44, v99, v52
    v_fma_f32 v45, v45, v99, v53
    v_fma_f32 v46, v46, v99, v54
    v_fma_f32 v47, v47, v99, v55
    v_fma_f32 v48, v48, v99, v56
    v_fma_f32 v49, v49, v99, v57
    v_fma_f32 v50, v50, v99, v58
    v_fma_f32 v51, v51, v99, v59
    v_cvt_pk_bf16_f32 v16, v44, v45
    v_lshlrev_b32 v44, 16, v16
    v_and_b32 v45, 0xffff0000, v16
    v_cvt_pk_bf16_f32 v16, v46, v47
    v_lshlrev_b32 v46, 16, v16
    v_and_b32 v47, 0xffff0000, v16
    v_cvt_pk_bf16_f32 v16, v48, v49
    v_lshlrev_b32 v48, 16, v16
    v_and_b32 v49, 0xffff0000, v16
    v_cvt_pk_bf16_f32 v16, v50, v51
    v_lshlrev_b32 v50, 16, v16
    v_and_b32 v51, 0xffff0000, v16
    v_lshlrev_b32 v52, 16, v192
    v_and_b32 v53, 0xffff0000, v192
    v_lshlrev_b32 v54, 16, v193
    v_and_b32 v55, 0xffff0000, v193
    v_lshlrev_b32 v56, 16, v194
    v_and_b32 v57, 0xffff0000, v194
    v_lshlrev_b32 v58, 16, v195
    v_and_b32 v59, 0xffff0000, v195
    v_pk_mul_f32 v[44:45], v[44:45], v[52:53]
    v_pk_mul_f32 v[46:47], v[46:47], v[54:55]
    v_pk_mul_f32 v[48:49], v[48:49], v[56:57]
    v_pk_mul_f32 v[50:51], v[50:51], v[58:59]
    v_cvt_pk_bf16_f32 v16, v44, v45
    v_lshlrev_b32 v44, 16, v16
    v_and_b32 v45, 0xffff0000, v16
    v_cvt_pk_bf16_f32 v16, v46, v47
    v_lshlrev_b32 v46, 16, v16
    v_and_b32 v47, 0xffff0000, v16
    v_cvt_pk_bf16_f32 v16, v48, v49
    v_lshlrev_b32 v48, 16, v16
    v_and_b32 v49, 0xffff0000, v16
    v_cvt_pk_bf16_f32 v16, v50, v51
    v_lshlrev_b32 v50, 16, v16
    v_and_b32 v51, 0xffff0000, v16
    v_lshlrev_b32 v52, 16, v184
    v_and_b32 v53, 0xffff0000, v184
    v_lshlrev_b32 v54, 16, v185
    v_and_b32 v55, 0xffff0000, v185
    v_lshlrev_b32 v56, 16, v186
    v_and_b32 v57, 0xffff0000, v186
    v_lshlrev_b32 v58, 16, v187
    v_and_b32 v59, 0xffff0000, v187
    v_pk_add_f32 v[44:45], v[44:45], v[52:53]
    v_pk_add_f32 v[46:47], v[46:47], v[54:55]
    v_pk_add_f32 v[48:49], v[48:49], v[56:57]
    v_pk_add_f32 v[50:51], v[50:51], v[58:59]
    v_cvt_pk_bf16_f32 v16, v44, v45
    v_lshlrev_b32 v44, 16, v16
    v_and_b32 v45, 0xffff0000, v16
    v_cvt_pk_bf16_f32 v16, v46, v47
    v_lshlrev_b32 v46, 16, v16
    v_and_b32 v47, 0xffff0000, v16
    v_cvt_pk_bf16_f32 v16, v48, v49
    v_lshlrev_b32 v48, 16, v16
    v_and_b32 v49, 0xffff0000, v16
    v_cvt_pk_bf16_f32 v16, v50, v51
    v_lshlrev_b32 v50, 16, v16
    v_and_b32 v51, 0xffff0000, v16
    v_lshlrev_b32 v52, 16, v200
    v_and_b32 v53, 0xffff0000, v200
    v_lshlrev_b32 v54, 16, v201
    v_and_b32 v55, 0xffff0000, v201
    v_lshlrev_b32 v56, 16, v202
    v_and_b32 v57, 0xffff0000, v202
    v_lshlrev_b32 v58, 16, v203
    v_and_b32 v59, 0xffff0000, v203
    v_pk_mul_f32 v[44:45], v[44:45], v[52:53]
    v_pk_mul_f32 v[46:47], v[46:47], v[54:55]
    v_pk_mul_f32 v[48:49], v[48:49], v[56:57]
    v_pk_mul_f32 v[50:51], v[50:51], v[58:59]
    v_cvt_pk_bf16_f32 v16, v44, v45
    v_lshlrev_b32 v44, 16, v16
    v_and_b32 v45, 0xffff0000, v16
    v_cvt_pk_bf16_f32 v16, v46, v47
    v_lshlrev_b32 v46, 16, v16
    v_and_b32 v47, 0xffff0000, v16
    v_cvt_pk_bf16_f32 v16, v48, v49
    v_lshlrev_b32 v48, 16, v16
    v_and_b32 v49, 0xffff0000, v16
    v_cvt_pk_bf16_f32 v16, v50, v51
    v_lshlrev_b32 v50, 16, v16
    v_and_b32 v51, 0xffff0000, v16
    v_pk_add_f32 v[44:45], v[44:45], v[28:29]
    v_pk_add_f32 v[46:47], v[46:47], v[30:31]
    v_pk_add_f32 v[48:49], v[48:49], v[32:33]
    v_pk_add_f32 v[50:51], v[50:51], v[34:35]
    v_cvt_pk_bf16_f32 v28, v44, v45
    v_cvt_pk_bf16_f32 v29, v46, v47
    v_cvt_pk_bf16_f32 v30, v48, v49
    v_cvt_pk_bf16_f32 v31, v50, v51
    v_sub_f32 v44, v36, v96
    v_sub_f32 v45, v37, v96
    v_sub_f32 v46, v38, v96
    v_sub_f32 v47, v39, v96
    v_sub_f32 v48, v40, v96
    v_sub_f32 v49, v41, v96
    v_sub_f32 v50, v42, v96
    v_sub_f32 v51, v43, v96
    v_cvt_pk_bf16_f32 v16, v44, v45
    v_lshlrev_b32 v44, 16, v16
    v_and_b32 v45, 0xffff0000, v16
    v_cvt_pk_bf16_f32 v16, v46, v47
    v_lshlrev_b32 v46, 16, v16
    v_and_b32 v47, 0xffff0000, v16
    v_cvt_pk_bf16_f32 v16, v48, v49
    v_lshlrev_b32 v48, 16, v16
    v_and_b32 v49, 0xffff0000, v16
    v_cvt_pk_bf16_f32 v16, v50, v51
    v_lshlrev_b32 v50, 16, v16
    v_and_b32 v51, 0xffff0000, v16
    v_mul_f32 v52, v44, v99
    v_mul_f32 v53, v45, v99
    v_mul_f32 v54, v46, v99
    v_mul_f32 v55, v47, v99
    v_mul_f32 v56, v48, v99
    v_mul_f32 v57, v49, v99
    v_mul_f32 v58, v50, v99
    v_mul_f32 v59, v51, v99
    v_fma_f32 v44, -v52, v98, v44
    v_fma_f32 v45, -v53, v98, v45
    v_fma_f32 v46, -v54, v98, v46
    v_fma_f32 v47, -v55, v98, v47
    v_fma_f32 v48, -v56, v98, v48
    v_fma_f32 v49, -v57, v98, v49
    v_fma_f32 v50, -v58, v98, v50
    v_fma_f32 v51, -v59, v98, v51
    v_fma_f32 v44, v44, v99, v52
    v_fma_f32 v45, v45, v99, v53
    v_fma_f32 v46, v46, v99, v54
    v_fma_f32 v47, v47, v99, v55
    v_fma_f32 v48, v48, v99, v56
    v_fma_f32 v49, v49, v99, v57
    v_fma_f32 v50, v50, v99, v58
    v_fma_f32 v51, v51, v99, v59
    v_cvt_pk_bf16_f32 v16, v44, v45
    v_lshlrev_b32 v44, 16, v16
    v_and_b32 v45, 0xffff0000, v16
    v_cvt_pk_bf16_f32 v16, v46, v47
    v_lshlrev_b32 v46, 16, v16
    v_and_b32 v47, 0xffff0000, v16
    v_cvt_pk_bf16_f32 v16, v48, v49
    v_lshlrev_b32 v48, 16, v16
    v_and_b32 v49, 0xffff0000, v16
    v_cvt_pk_bf16_f32 v16, v50, v51
    v_lshlrev_b32 v50, 16, v16
    v_and_b32 v51, 0xffff0000, v16
    v_lshlrev_b32 v52, 16, v196
    v_and_b32 v53, 0xffff0000, v196
    v_lshlrev_b32 v54, 16, v197
    v_and_b32 v55, 0xffff0000, v197
    v_lshlrev_b32 v56, 16, v198
    v_and_b32 v57, 0xffff0000, v198
    v_lshlrev_b32 v58, 16, v199
    v_and_b32 v59, 0xffff0000, v199
    v_pk_mul_f32 v[44:45], v[44:45], v[52:53]
    v_pk_mul_f32 v[46:47], v[46:47], v[54:55]
    v_pk_mul_f32 v[48:49], v[48:49], v[56:57]
    v_pk_mul_f32 v[50:51], v[50:51], v[58:59]
    v_cvt_pk_bf16_f32 v16, v44, v45
    v_lshlrev_b32 v44, 16, v16
    v_and_b32 v45, 0xffff0000, v16
    v_cvt_pk_bf16_f32 v16, v46, v47
    v_lshlrev_b32 v46, 16, v16
    v_and_b32 v47, 0xffff0000, v16
    v_cvt_pk_bf16_f32 v16, v48, v49
    v_lshlrev_b32 v48, 16, v16
    v_and_b32 v49, 0xffff0000, v16
    v_cvt_pk_bf16_f32 v16, v50, v51
    v_lshlrev_b32 v50, 16, v16
    v_and_b32 v51, 0xffff0000, v16
    v_lshlrev_b32 v52, 16, v188
    v_and_b32 v53, 0xffff0000, v188
    v_lshlrev_b32 v54, 16, v189
    v_and_b32 v55, 0xffff0000, v189
    v_lshlrev_b32 v56, 16, v190
    v_and_b32 v57, 0xffff0000, v190
    v_lshlrev_b32 v58, 16, v191
    v_and_b32 v59, 0xffff0000, v191
    v_pk_add_f32 v[44:45], v[44:45], v[52:53]
    v_pk_add_f32 v[46:47], v[46:47], v[54:55]
    v_pk_add_f32 v[48:49], v[48:49], v[56:57]
    v_pk_add_f32 v[50:51], v[50:51], v[58:59]
    v_cvt_pk_bf16_f32 v16, v44, v45
    v_lshlrev_b32 v44, 16, v16
    v_and_b32 v45, 0xffff0000, v16
    v_cvt_pk_bf16_f32 v16, v46, v47
    v_lshlrev_b32 v46, 16, v16
    v_and_b32 v47, 0xffff0000, v16
    v_cvt_pk_bf16_f32 v16, v48, v49
    v_lshlrev_b32 v48, 16, v16
    v_and_b32 v49, 0xffff0000, v16
    v_cvt_pk_bf16_f32 v16, v50, v51
    v_lshlrev_b32 v50, 16, v16
    v_and_b32 v51, 0xffff0000, v16
    v_lshlrev_b32 v52, 16, v204
    v_and_b32 v53, 0xffff0000, v204
    v_lshlrev_b32 v54, 16, v205
    v_and_b32 v55, 0xffff0000, v205
    v_lshlrev_b32 v56, 16, v206
    v_and_b32 v57, 0xffff0000, v206
    v_lshlrev_b32 v58, 16, v207
    v_and_b32 v59, 0xffff0000, v207
    v_pk_mul_f32 v[44:45], v[44:45], v[52:53]
    v_pk_mul_f32 v[46:47], v[46:47], v[54:55]
    v_pk_mul_f32 v[48:49], v[48:49], v[56:57]
    v_pk_mul_f32 v[50:51], v[50:51], v[58:59]
    v_cvt_pk_bf16_f32 v16, v44, v45
    v_lshlrev_b32 v44, 16, v16
    v_and_b32 v45, 0xffff0000, v16
    v_cvt_pk_bf16_f32 v16, v46, v47
    v_lshlrev_b32 v46, 16, v16
    v_and_b32 v47, 0xffff0000, v16
    v_cvt_pk_bf16_f32 v16, v48, v49
    v_lshlrev_b32 v48, 16, v16
    v_and_b32 v49, 0xffff0000, v16
    v_cvt_pk_bf16_f32 v16, v50, v51
    v_lshlrev_b32 v50, 16, v16
    v_and_b32 v51, 0xffff0000, v16
    v_pk_add_f32 v[44:45], v[44:45], v[36:37]
    v_pk_add_f32 v[46:47], v[46:47], v[38:39]
    v_pk_add_f32 v[48:49], v[48:49], v[40:41]
    v_pk_add_f32 v[50:51], v[50:51], v[42:43]
    v_cvt_pk_bf16_f32 v36, v44, v45
    v_cvt_pk_bf16_f32 v37, v46, v47
    v_cvt_pk_bf16_f32 v38, v48, v49
    v_cvt_pk_bf16_f32 v39, v50, v51
    v_lshlrev_b32 v18, 4, v0
    s_mov_b32 s16, 0x6e0000
    s_mov_b32 s27, 0
adaLN_cond__sliding_block_cached__moe_arch_mod__prompt_kernel_w12p:
    buffer_load_dwordx4 v[24:27], v18, s[8:11], s16 offen sc1
    s_waitcnt vmcnt(0)
    v_cmp_eq_u32 vcc, 0, v24
    s_add_u32 s27, s27, 1
    s_cmp_ge_u32 s27, 262144
    s_cbranch_scc1 adaLN_cond__sliding_block_cached__moe_arch_mod__prompt_kernel_w12g
    s_cbranch_vccnz adaLN_cond__sliding_block_cached__moe_arch_mod__prompt_kernel_w12p
adaLN_cond__sliding_block_cached__moe_arch_mod__prompt_kernel_w12g:
    v_mov_b32 v76, v24
    s_nop 1
    v_max_u32_dpp v76, v76, v76 row_ror:1 row_mask:0xf bank_mask:0xf
    s_nop 1
    v_max_u32_dpp v76, v76, v76 row_ror:2 row_mask:0xf bank_mask:0xf
    s_nop 1
    v_max_u32_dpp v76, v76, v76 row_ror:4 row_mask:0xf bank_mask:0xf
    s_nop 1
    v_max_u32_dpp v76, v76, v76 row_ror:8 row_mask:0xf bank_mask:0xf
    v_mov_b32 v77, v76
    s_nop 1
    v_permlane16_swap_b32 v76, v77
    v_max_u32 v76, v76, v77
    v_mov_b32 v77, v76
    s_nop 1
    v_permlane32_swap_b32 v76, v77
    v_max_u32 v76, v76, v77
    v_cmp_eq_u32 vcc, v76, v24
    s_lshl_b32 s16, s3, 4
    s_add_u32 s16, s16, 65792
    v_mov_b32 v16, s16
    s_and_saveexec_b64 s[62:63], vcc
    ds_write_b128 v16, v[24:27]
    s_mov_b64 exec, s[62:63]
    s_waitcnt lgkmcnt(0)
    s_barrier
    v_and_b32 v16, 3, v1
    v_lshlrev_b32 v16, 4, v16
    v_add_u32 v16, 65792, v16
    ds_read_b32 v76, v16
    s_waitcnt lgkmcnt(0)
    v_mov_b32 v77, v76
    s_nop 1
    v_max_u32_dpp v77, v77, v77 row_ror:1 row_mask:0xf bank_mask:0xf
    s_nop 1
    v_max_u32_dpp v77, v77, v77 row_ror:2 row_mask:0xf bank_mask:0xf
    v_cmp_eq_u32 vcc, v76, v77
    s_ff1_i32_b64 s16, vcc
    s_lshl_b32 s16, s16, 4
    s_add_u32 s16, s16, 65792
    v_mov_b32 v16, s16
    ds_read_b128 v[24:27], v16
    s_waitcnt lgkmcnt(0)
    v_and_b32 v76, 0x7ff, v24
    v_sub_u32 v76, 2047, v76
    s_nop 0
    v_readfirstlane_b32 s12, v76
    v_rcp_f32 v103, v26
    s_lshr_b32 s18, s12, 4
    s_lshl_b32 s18, s18, 15
    s_and_b32 s19, s12, 15
    s_lshl_b32 s19, s19, 6
    s_add_u32 s18, s18, s19
    s_add_u32 s18, s18, 0x2c00000
    s_add_u32 s19, s18, 0x400000
    v_lshrrev_b32 v18, 4, v0
    v_lshlrev_b32 v18, 10, v18
    v_and_b32 v19, 15, v0
    v_lshl_add_u32 v18, v19, 2, v18
    s_lshl_b32 s13, s12, 11
    buffer_load_dword v100, v18, s[8:11], s18 offen sc1
    buffer_load_dword v101, v18, s[8:11], s19 offen sc1
    buffer_load_dword v102, v21, s[76:79], s13 offen
    s_lshl_b32 s16, s14, 11
    s_cmp_lg_u32 s12, s14
    s_cselect_b32 s16, s16, 0x7ffffff0
    buffer_store_dwordx4 v[28:31], v2, s[68:71], s16 offen offset:0 sc1
    buffer_store_dwordx4 v[36:39], v2, s[68:71], s16 offen offset:1024 sc1
    s_lshl_b32 s16, s3, 13
    v_add_u32 v20, s16, v2
    s_waitcnt vmcnt(4)
    v_lshlrev_b32 v76, 16, v100
    v_and_b32 v77, 0xffff0000, v100
    s_waitcnt vmcnt(3)
    v_lshlrev_b32 v78, 16, v101
    v_and_b32 v79, 0xffff0000, v101
    v_pk_add_f32 v[76:77], v[76:77], v[78:79]
    s_waitcnt vmcnt(2)
    v_lshlrev_b32 v78, 16, v102
    v_and_b32 v79, 0xffff0000, v102
    v_pk_add_f32 v[92:93], v[78:79], v[76:77]
    v_cvt_pk_bf16_f32 v76, v92, v93
    v_lshlrev_b32 v92, 16, v76
    v_and_b32 v93, 0xffff0000, v76
    v_cvt_pk_bf16_f32 v100, v92, v93
    v_and_b32 v105, 0xffff0000, v104
    v_lshlrev_b32 v104, 16, v104
    v_and_b32 v107, 0xffff0000, v106
    v_lshlrev_b32 v106, 16, v106
    v_sub_f32 v92, v92, v25
    v_sub_f32 v93, v93, v25
    v_cvt_pk_bf16_f32 v76, v92, v93
    v_lshlrev_b32 v92, 16, v76
    v_and_b32 v93, 0xffff0000, v76
    v_mul_f32 v77, v92, v103
    v_fma_f32 v92, -v77, v26, v92
    v_fma_f32 v92, v92, v103, v77
    v_mul_f32 v77, v93, v103
    v_fma_f32 v93, -v77, v26, v93
    v_fma_f32 v93, v93, v103, v77
    v_cvt_pk_bf16_f32 v76, v92, v93
    v_lshlrev_b32 v92, 16, v76
    v_and_b32 v93, 0xffff0000, v76
    v_mul_f32 v92, v92, v104
    v_mul_f32 v93, v93, v105
    v_cvt_pk_bf16_f32 v76, v92, v93
    v_lshlrev_b32 v92, 16, v76
    v_and_b32 v93, 0xffff0000, v76
    v_add_f32 v92, v92, v106
    v_add_f32 v93, v93, v107
    v_cvt_pk_bf16_f32 v101, v92, v93
    v_add_u32 v16, 66560, v21
    ds_write_b32 v16, v101
    ds_write_b32 v16, v100 offset:2048
    s_waitcnt lgkmcnt(0)
    s_barrier
    ds_read_b128 v[60:63], v20 offset:0
    ds_read_b128 v[64:67], v20 offset:1024
    ds_read_b128 v[68:71], v20 offset:2048
    ds_read_b128 v[72:75], v20 offset:3072
    ds_read_b128 v[108:111], v20 offset:4096
    ds_read_b128 v[112:115], v20 offset:5120
    ds_read_b128 v[116:119], v20 offset:6144
    ds_read_b128 v[120:123], v20 offset:7168
    s_and_b32 s16, s3, 3
    s_lshl_b32 s16, s16, 7
    s_and_b32 s17, s29, 3
    s_lshl_b32 s17, s17, 9
    s_add_u32 s16, s16, s17
    s_add_u32 s16, s16, 66560
    v_lshrrev_b32 v16, 3, v1
    v_lshlrev_b32 v16, 4, v16
    v_add_u32 v16, s16, v16
    ds_read_b128 v[104:107], v16
    s_waitcnt lgkmcnt(0)
    v_lshlrev_b32 v76, 16, v104
    v_and_b32 v77, 0xffff, v104
    v_dot2_f32_bf16 v85, v60, v76, 0
    v_dot2_f32_bf16 v84, v60, v77, 0
    v_dot2_f32_bf16 v87, v61, v76, 0
    v_dot2_f32_bf16 v86, v61, v77, 0
    v_dot2_f32_bf16 v89, v62, v76, 0
    v_dot2_f32_bf16 v88, v62, v77, 0
    v_dot2_f32_bf16 v91, v63, v76, 0
    v_dot2_f32_bf16 v90, v63, v77, 0
    v_and_b32 v78, 0xffff0000, v104
    v_lshrrev_b32 v79, 16, v104
    v_dot2c_f32_bf16 v85, v64, v78
    v_dot2c_f32_bf16 v84, v64, v79
    v_dot2c_f32_bf16 v87, v65, v78
    v_dot2c_f32_bf16 v86, v65, v79
    v_dot2c_f32_bf16 v89, v66, v78
    v_dot2c_f32_bf16 v88, v66, v79
    v_dot2c_f32_bf16 v91, v67, v78
    v_dot2c_f32_bf16 v90, v67, v79
    v_lshlrev_b32 v80, 16, v105
    v_and_b32 v81, 0xffff, v105
    v_dot2c_f32_bf16 v85, v68, v80
    v_dot2c_f32_bf16 v84, v68, v81
    v_dot2c_f32_bf16 v87, v69, v80
    v_dot2c_f32_bf16 v86, v69, v81
    v_dot2c_f32_bf16 v89, v70, v80
    v_dot2c_f32_bf16 v88, v70, v81
    v_dot2c_f32_bf16 v91, v71, v80
    v_dot2c_f32_bf16 v90, v71, v81
    v_and_b32 v82, 0xffff0000, v105
    v_lshrrev_b32 v83, 16, v105
    v_dot2c_f32_bf16 v85, v72, v82
    v_dot2c_f32_bf16 v84, v72, v83
    v_dot2c_f32_bf16 v87, v73, v82
    v_dot2c_f32_bf16 v86, v73, v83
    v_dot2c_f32_bf16 v89, v74, v82
    v_dot2c_f32_bf16 v88, v74, v83
    v_dot2c_f32_bf16 v91, v75, v82
    v_dot2c_f32_bf16 v90, v75, v83
    v_lshlrev_b32 v76, 16, v106
    v_and_b32 v77, 0xffff, v106
    v_dot2c_f32_bf16 v85, v108, v76
    v_dot2c_f32_bf16 v84, v108, v77
    v_dot2c_f32_bf16 v87, v109, v76
    v_dot2c_f32_bf16 v86, v109, v77
    v_dot2c_f32_bf16 v89, v110, v76
    v_dot2c_f32_bf16 v88, v110, v77
    v_dot2c_f32_bf16 v91, v111, v76
    v_dot2c_f32_bf16 v90, v111, v77
    v_and_b32 v78, 0xffff0000, v106
    v_lshrrev_b32 v79, 16, v106
    v_dot2c_f32_bf16 v85, v112, v78
    v_dot2c_f32_bf16 v84, v112, v79
    v_dot2c_f32_bf16 v87, v113, v78
    v_dot2c_f32_bf16 v86, v113, v79
    v_dot2c_f32_bf16 v89, v114, v78
    v_dot2c_f32_bf16 v88, v114, v79
    v_dot2c_f32_bf16 v91, v115, v78
    v_dot2c_f32_bf16 v90, v115, v79
    v_lshlrev_b32 v80, 16, v107
    v_and_b32 v81, 0xffff, v107
    v_dot2c_f32_bf16 v85, v116, v80
    v_dot2c_f32_bf16 v84, v116, v81
    v_dot2c_f32_bf16 v87, v117, v80
    v_dot2c_f32_bf16 v86, v117, v81
    v_dot2c_f32_bf16 v89, v118, v80
    v_dot2c_f32_bf16 v88, v118, v81
    v_dot2c_f32_bf16 v91, v119, v80
    v_dot2c_f32_bf16 v90, v119, v81
    v_and_b32 v82, 0xffff0000, v107
    v_lshrrev_b32 v83, 16, v107
    v_dot2c_f32_bf16 v85, v120, v82
    v_dot2c_f32_bf16 v84, v120, v83
    v_dot2c_f32_bf16 v87, v121, v82
    v_dot2c_f32_bf16 v86, v121, v83
    v_dot2c_f32_bf16 v89, v122, v82
    v_dot2c_f32_bf16 v88, v122, v83
    v_dot2c_f32_bf16 v91, v123, v82
    v_dot2c_f32_bf16 v90, v123, v83
    s_nop 0
    v_permlane32_swap_b32 v84, v88
    v_permlane32_swap_b32 v85, v89
    v_permlane32_swap_b32 v86, v90
    v_permlane32_swap_b32 v87, v91
    v_add_f32 v84, v84, v88
    v_add_f32 v85, v85, v89
    v_add_f32 v86, v86, v90
    v_add_f32 v87, v87, v91
    s_nop 0
    v_permlane16_swap_b32 v84, v86
    v_permlane16_swap_b32 v85, v87
    v_add_f32 v84, v84, v86
    v_add_f32 v85, v85, v87
    s_nop 0
    v_add_f32_dpp v84, v84, v84 row_ror:8 row_mask:0xf bank_mask:0xf
    v_add_f32_dpp v85, v85, v85 row_ror:8 row_mask:0xf bank_mask:0xf
    v_and_b32 v16, 7, v1
    v_lshlrev_b32 v16, 5, v16
    v_lshrrev_b32 v17, 4, v1
    v_lshl_add_u32 v16, v17, 3, v16
    s_lshl_b32 s16, s3, 8
    s_add_u32 s16, s16, 70656
    v_add_u32 v16, s16, v16
    ds_write_b64 v16, v[84:85]
    s_lshr_b32 s16, s3, 2
    s_lshl_b32 s17, s16, 10
    s_add_u32 s17, s17, 70656
    v_lshlrev_b32 v17, 2, v1
    v_add_u32 v16, s17, v17
    s_and_b32 s17, s29, 3
    s_lshl_b32 s17, s17, 1
    s_add_u32 s17, s17, s16
    s_mul_i32 s17, s17, 14336
    s_lshr_b32 s16, s29, 2
    s_lshl_b32 s16, s16, 8
    s_add_u32 s17, s17, s16
    s_add_u32 s17, s17, 0x6e1000
    s_and_b32 s16, s3, 3
    s_cmp_eq_u32 s16, 0
    s_cselect_b32 s17, s17, 0x7ffffff0
    s_cmp_lt_u32 s2, 224
    s_cselect_b32 s17, s17, 0x7ffffff0
    s_waitcnt lgkmcnt(0)
    s_barrier
    ds_read_b32 v84, v16 offset:0
    ds_read_b32 v85, v16 offset:256
    ds_read_b32 v86, v16 offset:512
    ds_read_b32 v87, v16 offset:768
    s_waitcnt lgkmcnt(2)
    v_add_f32 v84, v84, v85
    s_waitcnt lgkmcnt(0)
    v_add_f32 v86, v86, v87
    v_add_f32 v84, v84, v86
    v_or_b32 v84, 1, v84
    buffer_store_dword v84, v17, s[8:11], s17 offen sc1
    s_barrier
    v_lshlrev_b32 v16, 3, v0
    v_add_u32 v17, 73728, v16
    ds_read_b64 v[84:85], v17 offset:0
    ds_read_b64 v[86:87], v17 offset:4096
    ds_read_b64 v[88:89], v17 offset:8192
    ds_read_b64 v[90:91], v17 offset:12288
    s_waitcnt lgkmcnt(2)
    v_pk_add_f32 v[84:85], v[84:85], v[86:87]
    s_waitcnt lgkmcnt(0)
    v_pk_add_f32 v[88:89], v[88:89], v[90:91]
    v_pk_add_f32 v[84:85], v[84:85], v[88:89]
    v_or_b32 v84, 1, v84
    v_or_b32 v85, 1, v85
    s_lshl_b32 s16, s29, 12
    s_add_u32 s16, s16, 0x600000
    s_cmp_lt_u32 s2, 224
    s_cselect_b32 s16, s16, 0x7ffffff0
    buffer_store_dwordx2 v[84:85], v16, s[8:11], s16 offen sc1
    s_cmp_lt_u32 s2, 224
    s_cbranch_scc1 adaLN_cond__sliding_block_cached__moe_arch_mod__prompt_kernel_end
    s_sub_u32 s16, s2, 224
    s_lshl_b32 s17, s16, 7
    s_add_u32 s17, s17, 0x600000
    v_lshrrev_b32 v16, 3, v0
    v_lshlrev_b32 v16, 12, v16
    v_and_b32 v17, 7, v0
    v_lshl_add_u32 v16, v17, 4, v16
    v_cmp_gt_u32 vcc, 256, v0
    v_bfrev_b32 v17, -2
    s_nop 0
    v_cndmask_b32 v17, v17, v16, vcc
    v_mov_b32 v19, 0
    v_cndmask_b32 v18, 1, v19, vcc
    s_lshl_b32 s18, s16, 6
    v_and_b32 v19, 31, v1
    v_lshlrev_b32 v19, 1, v19
    v_add_u32 v19, s18, v19
    s_mov_b32 s19, 0x541800
    buffer_load_ushort v95, v19, s[8:11], s19 offen sc1
    v_add_u32 v20, 66560, v19
    ds_read_u16 v96, v20
    ds_read_u16 v97, v20 offset:2048
    v_mov_b32 v94, v27
    v_cvt_pk_bf16_f32 v94, v94, v94
    v_lshlrev_b32 v94, 16, v94
    v_mul_f32 v94, 0xbfb8aa3b, v94
    v_exp_f32 v94, v94
    s_nop 0
    v_add_f32 v94, 1.0, v94
    v_rcp_f32 v94, v94
    s_nop 0
    v_cvt_pk_bf16_f32 v94, v94, v94
    v_lshlrev_b32 v94, 16, v94
    s_waitcnt vmcnt(0)
    v_lshlrev_b32 v95, 16, v95
    s_waitcnt lgkmcnt(1)
    v_lshlrev_b32 v96, 16, v96
    s_waitcnt lgkmcnt(0)
    v_lshlrev_b32 v97, 16, v97
    s_mov_b32 s27, 0
adaLN_cond__sliding_block_cached__moe_arch_mod__prompt_kernel_y13p:
    s_add_u32 s19, s17, 0x0
    buffer_load_dwordx4 v[44:47], v16, s[8:11], s19 offen sc1
    s_add_u32 s19, s17, 0x40000
    buffer_load_dwordx4 v[48:51], v16, s[8:11], s19 offen sc1
    s_add_u32 s19, s17, 0x80000
    buffer_load_dwordx4 v[52:55], v16, s[8:11], s19 offen sc1
    s_add_u32 s19, s17, 0xc0000
    buffer_load_dwordx4 v[56:59], v17, s[8:11], s19 offen sc1
    s_waitcnt vmcnt(0)
    v_min3_u32 v98, v56, v57, v58
    v_min_u32 v98, v98, v59
    v_or_b32 v98, v98, v18
    v_min3_u32 v98, v98, v44, v45
    v_min3_u32 v98, v98, v46, v47
    v_min3_u32 v98, v98, v48, v49
    v_min3_u32 v98, v98, v50, v51
    v_min3_u32 v98, v98, v52, v53
    v_min3_u32 v98, v98, v54, v55
    v_cmp_eq_u32 vcc, 0, v98
    s_add_u32 s27, s27, 1
    s_cmp_ge_u32 s27, 262144
    s_cbranch_scc1 adaLN_cond__sliding_block_cached__moe_arch_mod__prompt_kernel_y13g
    s_cbranch_vccnz adaLN_cond__sliding_block_cached__moe_arch_mod__prompt_kernel_y13p
adaLN_cond__sliding_block_cached__moe_arch_mod__prompt_kernel_y13g:
    v_pk_add_f32 v[44:45], v[44:45], v[52:53]
    v_pk_add_f32 v[46:47], v[46:47], v[54:55]
    v_pk_add_f32 v[48:49], v[48:49], v[56:57]
    v_pk_add_f32 v[50:51], v[50:51], v[58:59]
    v_pk_add_f32 v[44:45], v[44:45], v[48:49]
    v_pk_add_f32 v[46:47], v[46:47], v[50:51]
    s_nop 0
    v_add_f32_dpp v44, v44, v44 row_ror:8 row_mask:0xf bank_mask:0xf
    v_add_f32_dpp v45, v45, v45 row_ror:8 row_mask:0xf bank_mask:0xf
    v_add_f32_dpp v46, v46, v46 row_ror:8 row_mask:0xf bank_mask:0xf
    v_add_f32_dpp v47, v47, v47 row_ror:8 row_mask:0xf bank_mask:0xf
    s_nop 0
    v_permlane32_swap_b32 v44, v46
    v_permlane32_swap_b32 v45, v47
    v_add_f32 v44, v44, v46
    v_add_f32 v45, v45, v47
    s_nop 1
    v_permlane16_swap_b32 v44, v45
    v_add_f32 v44, v44, v45
    v_and_b32 v16, 7, v1
    v_lshlrev_b32 v16, 4, v16
    v_lshrrev_b32 v17, 4, v1
    v_lshl_add_u32 v16, v17, 2, v16
    s_lshl_b32 s19, s3, 7
    s_add_u32 s19, s19, 91136
    v_add_u32 v16, s19, v16
    ds_write_b32 v16, v44
    v_and_b32 v16, 31, v1
    v_lshlrev_b32 v16, 2, v16
    v_add_u32 v16, 91136, v16
    s_waitcnt lgkmcnt(0)
    s_barrier
    s_cmp_lg_u32 s3, 0
    s_cbranch_scc1 adaLN_cond__sliding_block_cached__moe_arch_mod__prompt_kernel_end
    ds_read_b32 v44, v16 offset:0
    ds_read_b32 v45, v16 offset:128
    ds_read_b32 v46, v16 offset:256
    ds_read_b32 v47, v16 offset:384
    ds_read_b32 v48, v16 offset:512
    ds_read_b32 v49, v16 offset:640
    ds_read_b32 v50, v16 offset:768
    ds_read_b32 v51, v16 offset:896
    s_waitcnt lgkmcnt(3)
    v_add_f32 v44, v44, v48
    s_waitcnt lgkmcnt(2)
    v_add_f32 v45, v45, v49
    s_waitcnt lgkmcnt(1)
    v_add_f32 v46, v46, v50
    s_waitcnt lgkmcnt(0)
    v_add_f32 v47, v47, v51
    v_add_f32 v44, v44, v46
    v_add_f32 v45, v45, v47
    v_add_f32 v44, v44, v45
    v_cvt_pk_bf16_f32 v44, v44, v44
    v_lshlrev_b32 v44, 16, v44
    v_mul_f32 v44, v44, v94
    v_cvt_pk_bf16_f32 v44, v44, v44
    v_lshlrev_b32 v44, 16, v44
    v_add_f32 v44, v44, v96
    v_cvt_pk_bf16_f32 v44, v44, v44
    v_lshlrev_b32 v44, 16, v44
    v_mul_f32 v44, v44, v95
    v_cvt_pk_bf16_f32 v44, v44, v44
    v_lshlrev_b32 v44, 16, v44
    v_add_f32 v44, v44, v97
    v_cvt_pk_bf16_f32 v44, v44, v44
    s_mov_b64 exec, 0xffffffff
    buffer_store_short v44, v19, s[68:71], s13 offen sc1
    s_branch adaLN_cond__sliding_block_cached__moe_arch_mod__prompt_kernel_end
adaLN_cond__sliding_block_cached__moe_arch_mod__prompt_kernel_roleB:
    v_mov_b32 v132, 0
    v_mov_b32 v133, 0
    v_lshrrev_b32 v16, 3, v0
    v_and_b32 v17, 7, v0
    v_mul_u32_u24 v135, 24576, v16
    v_lshl_add_u32 v135, v17, 4, v135
    v_lshlrev_b32 v136, 2, v16
    s_and_b32 s14, s2, 31
    s_lshr_b32 s15, s2, 5
    s_mul_i32 s26, s15, 1572864
    s_lshl_b32 s16, s14, 7
    s_add_u32 s26, s26, s16
    s_lshl_b32 s29, s15, 8
    v_lshlrev_b32 v137, 3, v0
    s_lshl_b32 s18, s2, 3
    s_add_u32 s18, s18, s3
    s_lshl_b32 s18, s18, 11
    v_and_b32 v18, 15, v1
    v_lshrrev_b32 v19, 4, v1
    v_lshlrev_b32 v138, 11, v18
    v_lshl_add_u32 v138, v19, 4, v138
    s_lshr_b32 s30, s2, 4
    s_and_b32 s31, s2, 15
    s_lshl_b32 s19, s30, 3
    s_add_u32 s19, s19, s3
    s_lshl_b32 s22, s19, 15
    s_lshl_b32 s23, s31, 7
    s_add_u32 s22, s22, s23
    s_lshl_b32 s23, s2, 12
    s_add_u32 s23, s23, 0x600000
    s_or_b32 s25, s2, s3
    s_cmp_eq_u32 s25, 0
    s_cselect_b32 s25, 0, 0x7ffffff0
    s_waitcnt lgkmcnt(0)
    s_mov_b64 s[64:65], s[58:59]
    s_mov_b32 s66, 0x100
    s_mov_b32 s67, 0x20000
    s_or_b32 s28, s62, 1
    v_mov_b32 v134, s28
    s_mov_b64 exec, 1
    buffer_store_dword v134, v132, s[64:67], s25 offen sc1
    s_mov_b64 exec, -1
    s_mov_b64 s[68:69], s[52:53]
    s_mov_b32 s70, 0x800
    s_mov_b32 s71, 0x20000
    s_mov_b64 s[72:73], s[54:55]
    s_mov_b32 s74, 0xc00000
    s_mov_b32 s75, 0x20000
    s_mov_b64 s[76:77], s[32:33]
    s_mov_b32 s78, 0x400000
    s_mov_b32 s79, 0x20000
    s_mov_b64 s[8:9], s[60:61]
    s_mov_b32 s10, 0x3400000
    s_mov_b32 s11, 0x20000
    buffer_load_dword v72, v136, s[68:71], s29 offen
    buffer_load_dwordx4 v[24:27], v135, s[72:75], s26 offen
    s_add_u32 s26, s26, 12288
    buffer_load_dwordx4 v[28:31], v135, s[72:75], s26 offen
    buffer_load_dwordx4 v[32:35], v2, s[76:79], s18 offen offset:0
    buffer_load_dwordx4 v[36:39], v2, s[76:79], s18 offen offset:1024
    buffer_store_dwordx2 v[132:133], v137, s[8:11], s23 offen sc1
    s_barrier
    buffer_load_dwordx4 v[40:43], v138, s[76:79], s22 offen offset:0
    buffer_load_dwordx4 v[44:47], v138, s[76:79], s22 offen offset:64
    s_mov_b32 s29, s19
    s_mov_b64 s[64:65], s[34:35]
    s_mov_b32 s66, 0x200000
    s_mov_b32 s67, 0x20000
    s_mov_b64 s[68:69], s[36:37]
    s_mov_b32 s70, 0x200000
    s_mov_b32 s71, 0x20000
    s_lshl_b32 s20, s2, 2
    s_add_u32 s20, s20, s3
    s_sub_u32 s20, s20, 4
    s_lshr_b32 s22, s20, 8
    s_bfe_u32 s23, s20, 0x40004
    s_and_b32 s24, s20, 15
    s_lshl_b32 s25, s22, 19
    s_lshl_b32 s26, s23, 13
    s_add_u32 s25, s25, s26
    s_add_u32 s25, s25, 393216
    v_and_b32 v16, 15, v1
    v_lshrrev_b32 v17, 4, v1
    s_lshl_b32 s21, s22, 17
    s_cmp_ge_u32 s24, 8
    s_cbranch_scc1 adaLN_cond__sliding_block_cached__moe_arch_mod__prompt_kernel_kvV
    v_lshlrev_b32 v18, 8, v16
    v_lshl_add_u32 v18, v17, 3, v18
    s_and_b32 s26, s24, 1
    s_lshl_b32 s26, s26, 12
    s_add_u32 s25, s25, s26
    s_lshr_b32 s26, s24, 1
    s_lshl_b32 s26, s26, 6
    s_add_u32 s25, s25, s26
    buffer_load_dwordx2 v[84:85], v18, s[64:67], s25 offen
    buffer_load_dwordx2 v[86:87], v18, s[64:67], s25 offen offset:32
    s_lshl_b32 s26, s23, 13
    s_add_u32 s21, s21, s26
    s_lshl_b32 s26, s24, 10
    s_add_u32 s21, s21, s26
    s_add_u32 s21, s21, 0x400000
    s_branch adaLN_cond__sliding_block_cached__moe_arch_mod__prompt_kernel_kvJ
adaLN_cond__sliding_block_cached__moe_arch_mod__prompt_kernel_kvV:
    s_bfe_u32 s26, s24, 0x20001
    s_lshl_b32 s26, s26, 6
    s_add_u32 s25, s25, s26
    s_and_b32 s26, s24, 1
    s_lshl_b32 s26, s26, 3
    s_add_u32 s25, s25, s26
    s_add_u32 s26, s25, 4096
    v_lshrrev_b32 v18, 2, v16
    v_lshlrev_b32 v18, 4, v18
    v_and_b32 v19, 3, v16
    v_lshl_add_u32 v18, v19, 1, v18
    v_lshl_add_u32 v18, v17, 10, v18
    buffer_load_ushort v88, v18, s[68:71], s25 offen offset:0
    buffer_load_ushort v89, v18, s[68:71], s25 offen offset:256
    buffer_load_ushort v90, v18, s[68:71], s25 offen offset:512
    buffer_load_ushort v91, v18, s[68:71], s25 offen offset:768
    buffer_load_ushort v92, v18, s[68:71], s26 offen offset:0
    buffer_load_ushort v93, v18, s[68:71], s26 offen offset:256
    buffer_load_ushort v94, v18, s[68:71], s26 offen offset:512
    buffer_load_ushort v95, v18, s[68:71], s26 offen offset:768
    s_bfe_u32 s26, s24, 0x20001
    s_lshl_b32 s26, s26, 15
    s_add_u32 s21, s21, s26
    s_lshl_b32 s26, s23, 11
    s_add_u32 s21, s21, s26
    s_and_b32 s26, s24, 1
    s_lshl_b32 s26, s26, 10
    s_add_u32 s21, s21, s26
    s_add_u32 s21, s21, 0x480000
adaLN_cond__sliding_block_cached__moe_arch_mod__prompt_kernel_kvJ:
    s_waitcnt vmcnt(9)
    v_and_b32 v73, 0xffff0000, v72
    v_lshlrev_b32 v72, 16, v72
    v_mul_f32 v16, 0xbfb8aa3b, v72
    v_exp_f32 v16, v16
    s_nop 0
    v_add_f32 v16, 1.0, v16
    v_rcp_f32 v16, v16
    s_nop 0
    v_mul_f32 v72, v72, v16
    v_mul_f32 v17, 0xbfb8aa3b, v73
    v_exp_f32 v17, v17
    s_nop 0
    v_add_f32 v17, 1.0, v17
    v_rcp_f32 v17, v17
    s_nop 0
    v_mul_f32 v73, v73, v17
    v_cvt_pk_bf16_f32 v16, v72, v73
    v_lshlrev_b32 v72, 16, v16
    v_and_b32 v73, 0xffff0000, v16
    s_lshl_b32 s16, s2, 8
    s_add_u32 s16, s16, 0x550000
    s_mov_b32 exec_lo, 0x01010101
    s_mov_b32 exec_hi, 0x01010101
    buffer_store_dword v16, v136, s[8:11], s16 offen sc1
    s_mov_b64 exec, -1
    v_lshrrev_b32 v74, 16, v72
    v_lshrrev_b32 v75, 16, v73
    s_waitcnt vmcnt(9)
    v_dot2_f32_bf16 v49, v24, v72, 0
    v_dot2_f32_bf16 v48, v24, v74, 0
    v_dot2_f32_bf16 v51, v25, v72, 0
    v_dot2_f32_bf16 v50, v25, v74, 0
    v_dot2_f32_bf16 v53, v26, v72, 0
    v_dot2_f32_bf16 v52, v26, v74, 0
    v_dot2_f32_bf16 v55, v27, v72, 0
    v_dot2_f32_bf16 v54, v27, v74, 0
    s_waitcnt vmcnt(8)
    v_dot2c_f32_bf16 v49, v28, v73
    v_dot2c_f32_bf16 v48, v28, v75
    v_dot2c_f32_bf16 v51, v29, v73
    v_dot2c_f32_bf16 v50, v29, v75
    v_dot2c_f32_bf16 v53, v30, v73
    v_dot2c_f32_bf16 v52, v30, v75
    v_dot2c_f32_bf16 v55, v31, v73
    v_dot2c_f32_bf16 v54, v31, v75
    s_nop 0
    v_permlane32_swap_b32 v48, v52
    v_permlane32_swap_b32 v49, v53
    v_permlane32_swap_b32 v50, v54
    v_permlane32_swap_b32 v51, v55
    v_add_f32 v48, v48, v52
    v_add_f32 v49, v49, v53
    v_add_f32 v50, v50, v54
    v_add_f32 v51, v51, v55
    s_nop 0
    v_permlane16_swap_b32 v48, v50
    v_permlane16_swap_b32 v49, v51
    v_add_f32 v48, v48, v50
    v_add_f32 v49, v49, v51
    s_nop 0
    v_add_f32_dpp v48, v48, v48 row_ror:8 row_mask:0xf bank_mask:0xf
    v_add_f32_dpp v49, v49, v49 row_ror:8 row_mask:0xf bank_mask:0xf
    v_and_b32 v16, 7, v1
    v_lshlrev_b32 v16, 5, v16
    v_lshrrev_b32 v17, 4, v1
    v_lshl_add_u32 v16, v17, 3, v16
    s_lshl_b32 s16, s3, 8
    s_add_u32 s16, s16, 65536
    v_add_u32 v16, s16, v16
    ds_write_b64 v16, v[48:49]
    s_waitcnt vmcnt(7)
    v_lshlrev_b32 v56, 16, v32
    v_and_b32 v57, 0xffff0000, v32
    v_lshlrev_b32 v58, 16, v33
    v_and_b32 v59, 0xffff0000, v33
    v_lshlrev_b32 v60, 16, v34
    v_and_b32 v61, 0xffff0000, v34
    v_lshlrev_b32 v62, 16, v35
    v_and_b32 v63, 0xffff0000, v35
    s_waitcnt vmcnt(6)
    v_lshlrev_b32 v64, 16, v36
    v_and_b32 v65, 0xffff0000, v36
    v_lshlrev_b32 v66, 16, v37
    v_and_b32 v67, 0xffff0000, v37
    v_lshlrev_b32 v68, 16, v38
    v_and_b32 v69, 0xffff0000, v38
    v_lshlrev_b32 v70, 16, v39
    v_and_b32 v71, 0xffff0000, v39
    v_add_f32 v20, v56, v57
    v_add_f32 v21, v58, v59
    v_add_f32 v20, v20, v60
    v_add_f32 v21, v21, v61
    v_add_f32 v20, v20, v62
    v_add_f32 v21, v21, v63
    v_add_f32 v20, v20, v64
    v_add_f32 v21, v21, v65
    v_add_f32 v20, v20, v66
    v_add_f32 v21, v21, v67
    v_add_f32 v20, v20, v68
    v_add_f32 v21, v21, v69
    v_add_f32 v20, v20, v70
    v_add_f32 v21, v21, v71
    v_add_f32 v128, v20, v21
    s_nop 1
    v_add_f32_dpp v128, v128, v128 row_ror:1 row_mask:0xf bank_mask:0xf
    s_nop 1
    v_add_f32_dpp v128, v128, v128 row_ror:2 row_mask:0xf bank_mask:0xf
    s_nop 1
    v_add_f32_dpp v128, v128, v128 row_ror:4 row_mask:0xf bank_mask:0xf
    s_nop 1
    v_add_f32_dpp v128, v128, v128 row_ror:8 row_mask:0xf bank_mask:0xf
    v_mov_b32 v20, v128
    s_nop 1
    v_permlane16_swap_b32 v128, v20
    v_add_f32 v128, v128, v20
    v_mov_b32 v20, v128
    s_nop 1
    v_permlane32_swap_b32 v128, v20
    v_add_f32 v128, v128, v20
    v_mul_f32 v128, 0x3a800000, v128
    v_sub_f32 v18, v56, v128
    v_mul_f32 v20, v18, v18
    v_sub_f32 v19, v57, v128
    v_mul_f32 v21, v19, v19
    v_sub_f32 v18, v58, v128
    v_sub_f32 v19, v59, v128
    v_fmac_f32 v20, v18, v18
    v_fmac_f32 v21, v19, v19
    v_sub_f32 v18, v60, v128
    v_sub_f32 v19, v61, v128
    v_fmac_f32 v20, v18, v18
    v_fmac_f32 v21, v19, v19
    v_sub_f32 v18, v62, v128
    v_sub_f32 v19, v63, v128
    v_fmac_f32 v20, v18, v18
    v_fmac_f32 v21, v19, v19
    v_sub_f32 v18, v64, v128
    v_sub_f32 v19, v65, v128
    v_fmac_f32 v20, v18, v18
    v_fmac_f32 v21, v19, v19
    v_sub_f32 v18, v66, v128
    v_sub_f32 v19, v67, v128
    v_fmac_f32 v20, v18, v18
    v_fmac_f32 v21, v19, v19
    v_sub_f32 v18, v68, v128
    v_sub_f32 v19, v69, v128
    v_fmac_f32 v20, v18, v18
    v_fmac_f32 v21, v19, v19
    v_sub_f32 v18, v70, v128
    v_sub_f32 v19, v71, v128
    v_fmac_f32 v20, v18, v18
    v_fmac_f32 v21, v19, v19
    v_add_f32 v17, v20, v21
    s_nop 1
    v_add_f32_dpp v17, v17, v17 row_ror:1 row_mask:0xf bank_mask:0xf
    s_nop 1
    v_add_f32_dpp v17, v17, v17 row_ror:2 row_mask:0xf bank_mask:0xf
    s_nop 1
    v_add_f32_dpp v17, v17, v17 row_ror:4 row_mask:0xf bank_mask:0xf
    s_nop 1
    v_add_f32_dpp v17, v17, v17 row_ror:8 row_mask:0xf bank_mask:0xf
    v_mov_b32 v20, v17
    s_nop 1
    v_permlane16_swap_b32 v17, v20
    v_add_f32 v17, v17, v20
    v_mov_b32 v20, v17
    s_nop 1
    v_permlane32_swap_b32 v17, v20
    v_add_f32 v17, v17, v20
    v_mul_f32 v17, 0x3a800000, v17
    v_cvt_pk_bf16_f32 v128, v128, v128
    v_lshlrev_b32 v128, 16, v128
    v_cvt_pk_bf16_f32 v17, v17, v17
    v_lshlrev_b32 v17, 16, v17
    v_add_f32 v17, 0x3727c5ac, v17
    v_cvt_pk_bf16_f32 v17, v17, v17
    v_lshlrev_b32 v17, 16, v17
    v_sqrt_f32 v129, v17
    s_nop 0
    v_cvt_pk_bf16_f32 v129, v129, v129
    v_lshlrev_b32 v129, 16, v129
    v_rcp_f32 v130, v129
    s_lshl_b32 s16, s3, 4
    s_add_u32 s16, s16, 67600
    v_mov_b32 v19, s16
    ds_write_b128 v19, v[128:131]
    v_mov_b32 v19, 67584
    v_and_b32 v17, 31, v1
    v_lshlrev_b32 v18, 3, v17
    v_add_u32 v18, 65536, v18
    v_lshlrev_b32 v17, 4, v17
    s_waitcnt lgkmcnt(0)
    s_barrier
    ds_read_b32 v134, v19
    ds_read_b64 v[96:97], v18 offset:0
    ds_read_b64 v[100:101], v18 offset:256
    ds_read_b64 v[104:105], v18 offset:512
    ds_read_b64 v[108:109], v18 offset:768
    ds_read_b64 v[112:113], v18 offset:1024
    ds_read_b64 v[116:117], v18 offset:1280
    ds_read_b64 v[120:121], v18 offset:1536
    ds_read_b64 v[124:125], v18 offset:1792
    s_waitcnt lgkmcnt(8)
    v_readfirstlane_b32 s28, v134
    v_and_b32 v20, 7, v1
    v_lshlrev_b32 v20, 4, v20
    v_add_u32 v21, 67600, v20
    ds_read_b128 v[128:131], v21
    s_waitcnt lgkmcnt(0)
    v_mov_b32 v131, s28
    s_lshl_b32 s16, s2, 7
    s_add_u32 s16, s16, 0x520000
    s_cmp_eq_u32 s3, 0
    s_cselect_b32 s16, s16, 0x7ffffff0
    s_mov_b64 exec, 0xff
    buffer_store_dwordx4 v[128:131], v20, s[8:11], s16 offen sc1
    s_mov_b64 exec, -1
    v_pk_add_f32 v[96:97], v[96:97], v[112:113]
    v_pk_add_f32 v[100:101], v[100:101], v[116:117]
    v_pk_add_f32 v[104:105], v[104:105], v[120:121]
    v_pk_add_f32 v[108:109], v[108:109], v[124:125]
    v_pk_add_f32 v[96:97], v[96:97], v[104:105]
    v_pk_add_f32 v[100:101], v[100:101], v[108:109]
    v_pk_add_f32 v[96:97], v[96:97], v[100:101]
    v_mov_b32 v98, s28
    v_mov_b32 v99, s28
    s_lshl_b32 s16, s14, 3
    s_add_u32 s16, s16, s15
    s_lshl_b32 s16, s16, 9
    s_add_u32 s16, s16, 0x500000
    s_cmp_eq_u32 s3, 0
    s_cselect_b32 s16, s16, 0x7ffffff0
    s_mov_b64 exec, 0xffffffff
    buffer_store_dwordx4 v[96:99], v17, s[8:11], s16 offen sc1
    s_mov_b64 exec, -1
    s_cmp_lt_u32 s24, 8
    s_cbranch_scc1 adaLN_cond__sliding_block_cached__moe_arch_mod__prompt_kernel_kvS
    s_waitcnt vmcnt(4)
    v_lshl_or_b32 v84, v89, 16, v88
    v_lshl_or_b32 v85, v91, 16, v90
    s_waitcnt vmcnt(3)
    v_lshl_or_b32 v86, v93, 16, v92
    v_lshl_or_b32 v87, v95, 16, v94
adaLN_cond__sliding_block_cached__moe_arch_mod__prompt_kernel_kvS:
    s_waitcnt vmcnt(3)
    buffer_store_dwordx4 v[84:87], v2, s[8:11], s21 offen sc1
    s_lshr_b32 s16, s3, 2
    s_lshl_b32 s16, s16, 4
    s_add_u32 s16, s16, s31
    s_lshl_b32 s16, s16, 12
    s_and_b32 s17, s3, 3
    s_lshl_b32 s17, s17, 7
    s_add_u32 s16, s16, s17
    s_add_u32 s16, s16, 0x500000
    v_lshrrev_b32 v139, 3, v1
    v_lshlrev_b32 v139, 9, v139
    v_and_b32 v16, 7, v1
    v_lshl_add_u32 v139, v16, 4, v139
    v_and_b32 v140, 15, v1
    v_lshlrev_b32 v140, 4, v140
    s_lshl_b32 s17, s29, 8
    s_add_u32 s17, s17, 0x520000
    v_lshlrev_b32 v56, 16, v40
    v_and_b32 v57, 0xffff0000, v40
    v_lshlrev_b32 v58, 16, v41
    v_and_b32 v59, 0xffff0000, v41
    v_lshlrev_b32 v60, 16, v42
    v_and_b32 v61, 0xffff0000, v42
    v_lshlrev_b32 v62, 16, v43
    v_and_b32 v63, 0xffff0000, v43
    v_lshlrev_b32 v64, 16, v44
    v_and_b32 v65, 0xffff0000, v44
    v_lshlrev_b32 v66, 16, v45
    v_and_b32 v67, 0xffff0000, v45
    v_lshlrev_b32 v68, 16, v46
    v_and_b32 v69, 0xffff0000, v46
    v_lshlrev_b32 v70, 16, v47
    v_and_b32 v71, 0xffff0000, v47
    s_mov_b32 s27, 0
adaLN_cond__sliding_block_cached__moe_arch_mod__prompt_kernel_g14p:
    buffer_load_dwordx4 v[76:79], v139, s[8:11], s16 offen sc1
    buffer_load_dwordx4 v[80:83], v140, s[8:11], s17 offen sc1
    s_waitcnt vmcnt(1)
    v_cmp_ne_u32 vcc, s28, v78
    v_cmp_ne_u32 s[62:63], s28, v79
    s_or_b64 vcc, vcc, s[62:63]
    s_waitcnt vmcnt(0)
    v_cmp_ne_u32 s[62:63], s28, v83
    s_or_b64 vcc, vcc, s[62:63]
    s_add_u32 s27, s27, 1
    s_cmp_ge_u32 s27, 262144
    s_cbranch_scc1 adaLN_cond__sliding_block_cached__moe_arch_mod__prompt_kernel_g14g
    s_cbranch_vccnz adaLN_cond__sliding_block_cached__moe_arch_mod__prompt_kernel_g14p
adaLN_cond__sliding_block_cached__moe_arch_mod__prompt_kernel_g14g:
    v_add_f32_dpp v76, v76, v76 row_ror:8 row_mask:0xf bank_mask:0xf
    v_add_f32_dpp v77, v77, v77 row_ror:8 row_mask:0xf bank_mask:0xf
    v_mov_b32 v17, v76
    s_nop 1
    v_permlane16_swap_b32 v76, v17
    v_add_f32 v76, v76, v17
    v_mov_b32 v18, v77
    s_nop 1
    v_permlane16_swap_b32 v77, v18
    v_add_f32 v77, v77, v18
    v_mov_b32 v17, v76
    s_nop 1
    v_permlane32_swap_b32 v76, v17
    v_add_f32 v76, v76, v17
    v_mov_b32 v18, v77
    s_nop 1
    v_permlane32_swap_b32 v77, v18
    v_add_f32 v77, v77, v18
    v_cvt_pk_bf16_f32 v17, v76, v77
    v_lshlrev_b32 v76, 16, v17
    v_and_b32 v77, 0xffff0000, v17
    v_add_f32 v76, 1.0, v76
    v_add_f32 v77, 1.0, v77
    v_cvt_pk_bf16_f32 v17, v76, v77
    v_lshlrev_b32 v76, 16, v17
    v_and_b32 v77, 0xffff0000, v17
    s_lshl_b32 s16, s3, 6
    s_add_u32 s16, s16, 69632
    v_lshl_add_u32 v16, v16, 3, s16
    ds_write_b64 v16, v[76:77]
    v_lshrrev_b32 v17, 4, v1
    v_lshlrev_b32 v17, 5, v17
    v_add_u32 v17, 69632, v17
    v_sub_f32 v56, v56, v80
    v_sub_f32 v57, v57, v80
    v_sub_f32 v58, v58, v80
    v_sub_f32 v59, v59, v80
    v_sub_f32 v60, v60, v80
    v_sub_f32 v61, v61, v80
    v_sub_f32 v62, v62, v80
    v_sub_f32 v63, v63, v80
    v_sub_f32 v64, v64, v80
    v_sub_f32 v65, v65, v80
    v_sub_f32 v66, v66, v80
    v_sub_f32 v67, v67, v80
    v_sub_f32 v68, v68, v80
    v_sub_f32 v69, v69, v80
    v_sub_f32 v70, v70, v80
    v_sub_f32 v71, v71, v80
    v_cvt_pk_bf16_f32 v18, v56, v57
    v_lshlrev_b32 v56, 16, v18
    v_and_b32 v57, 0xffff0000, v18
    v_cvt_pk_bf16_f32 v19, v58, v59
    v_lshlrev_b32 v58, 16, v19
    v_and_b32 v59, 0xffff0000, v19
    v_cvt_pk_bf16_f32 v18, v60, v61
    v_lshlrev_b32 v60, 16, v18
    v_and_b32 v61, 0xffff0000, v18
    v_cvt_pk_bf16_f32 v19, v62, v63
    v_lshlrev_b32 v62, 16, v19
    v_and_b32 v63, 0xffff0000, v19
    v_cvt_pk_bf16_f32 v18, v64, v65
    v_lshlrev_b32 v64, 16, v18
    v_and_b32 v65, 0xffff0000, v18
    v_cvt_pk_bf16_f32 v19, v66, v67
    v_lshlrev_b32 v66, 16, v19
    v_and_b32 v67, 0xffff0000, v19
    v_cvt_pk_bf16_f32 v18, v68, v69
    v_lshlrev_b32 v68, 16, v18
    v_and_b32 v69, 0xffff0000, v18
    v_cvt_pk_bf16_f32 v19, v70, v71
    v_lshlrev_b32 v70, 16, v19
    v_and_b32 v71, 0xffff0000, v19
    v_mul_f32 v56, v56, v82
    v_mul_f32 v57, v57, v82
    v_mul_f32 v58, v58, v82
    v_mul_f32 v59, v59, v82
    v_mul_f32 v60, v60, v82
    v_mul_f32 v61, v61, v82
    v_mul_f32 v62, v62, v82
    v_mul_f32 v63, v63, v82
    v_mul_f32 v64, v64, v82
    v_mul_f32 v65, v65, v82
    v_mul_f32 v66, v66, v82
    v_mul_f32 v67, v67, v82
    v_mul_f32 v68, v68, v82
    v_mul_f32 v69, v69, v82
    v_mul_f32 v70, v70, v82
    v_mul_f32 v71, v71, v82
    v_cvt_pk_bf16_f32 v18, v56, v57
    v_lshlrev_b32 v56, 16, v18
    v_and_b32 v57, 0xffff0000, v18
    v_cvt_pk_bf16_f32 v19, v58, v59
    v_lshlrev_b32 v58, 16, v19
    v_and_b32 v59, 0xffff0000, v19
    v_cvt_pk_bf16_f32 v18, v60, v61
    v_lshlrev_b32 v60, 16, v18
    v_and_b32 v61, 0xffff0000, v18
    v_cvt_pk_bf16_f32 v19, v62, v63
    v_lshlrev_b32 v62, 16, v19
    v_and_b32 v63, 0xffff0000, v19
    v_cvt_pk_bf16_f32 v18, v64, v65
    v_lshlrev_b32 v64, 16, v18
    v_and_b32 v65, 0xffff0000, v18
    v_cvt_pk_bf16_f32 v19, v66, v67
    v_lshlrev_b32 v66, 16, v19
    v_and_b32 v67, 0xffff0000, v19
    v_cvt_pk_bf16_f32 v18, v68, v69
    v_lshlrev_b32 v68, 16, v18
    v_and_b32 v69, 0xffff0000, v18
    v_cvt_pk_bf16_f32 v19, v70, v71
    v_lshlrev_b32 v70, 16, v19
    v_and_b32 v71, 0xffff0000, v19
    s_lshl_b32 s16, s29, 15
    s_lshl_b32 s17, s31, 11
    s_add_u32 s16, s16, s17
    s_waitcnt lgkmcnt(0)
    s_barrier
    ds_read_b128 v[96:99], v17 offset:256
    ds_read_b128 v[104:107], v17 offset:0
    ds_read_b128 v[100:103], v17 offset:272
    ds_read_b128 v[108:111], v17 offset:16
    ds_read_b128 v[112:115], v17 offset:384
    ds_read_b128 v[120:123], v17 offset:128
    ds_read_b128 v[116:119], v17 offset:400
    ds_read_b128 v[124:127], v17 offset:144
    s_waitcnt lgkmcnt(7)
    v_pk_mul_f32 v[56:57], v[56:57], v[96:97]
    v_pk_mul_f32 v[58:59], v[58:59], v[98:99]
    s_waitcnt lgkmcnt(5)
    v_pk_mul_f32 v[60:61], v[60:61], v[100:101]
    v_pk_mul_f32 v[62:63], v[62:63], v[102:103]
    v_cvt_pk_bf16_f32 v18, v56, v57
    v_lshlrev_b32 v56, 16, v18
    v_and_b32 v57, 0xffff0000, v18
    v_cvt_pk_bf16_f32 v19, v58, v59
    v_lshlrev_b32 v58, 16, v19
    v_and_b32 v59, 0xffff0000, v19
    v_cvt_pk_bf16_f32 v18, v60, v61
    v_lshlrev_b32 v60, 16, v18
    v_and_b32 v61, 0xffff0000, v18
    v_cvt_pk_bf16_f32 v19, v62, v63
    v_lshlrev_b32 v62, 16, v19
    v_and_b32 v63, 0xffff0000, v19
    v_pk_add_f32 v[56:57], v[56:57], v[104:105]
    v_pk_add_f32 v[58:59], v[58:59], v[106:107]
    s_waitcnt lgkmcnt(4)
    v_pk_add_f32 v[60:61], v[60:61], v[108:109]
    v_pk_add_f32 v[62:63], v[62:63], v[110:111]
    v_cvt_pk_bf16_f32 v32, v56, v57
    v_cvt_pk_bf16_f32 v33, v58, v59
    v_cvt_pk_bf16_f32 v34, v60, v61
    v_cvt_pk_bf16_f32 v35, v62, v63
    buffer_store_dwordx4 v[32:35], v2, s[8:11], s16 offen offset:0 sc1
    s_waitcnt lgkmcnt(3)
    v_pk_mul_f32 v[64:65], v[64:65], v[112:113]
    v_pk_mul_f32 v[66:67], v[66:67], v[114:115]
    s_waitcnt lgkmcnt(1)
    v_pk_mul_f32 v[68:69], v[68:69], v[116:117]
    v_pk_mul_f32 v[70:71], v[70:71], v[118:119]
    v_cvt_pk_bf16_f32 v18, v64, v65
    v_lshlrev_b32 v64, 16, v18
    v_and_b32 v65, 0xffff0000, v18
    v_cvt_pk_bf16_f32 v19, v66, v67
    v_lshlrev_b32 v66, 16, v19
    v_and_b32 v67, 0xffff0000, v19
    v_cvt_pk_bf16_f32 v18, v68, v69
    v_lshlrev_b32 v68, 16, v18
    v_and_b32 v69, 0xffff0000, v18
    v_cvt_pk_bf16_f32 v19, v70, v71
    v_lshlrev_b32 v70, 16, v19
    v_and_b32 v71, 0xffff0000, v19
    v_pk_add_f32 v[64:65], v[64:65], v[120:121]
    v_pk_add_f32 v[66:67], v[66:67], v[122:123]
    s_waitcnt lgkmcnt(0)
    v_pk_add_f32 v[68:69], v[68:69], v[124:125]
    v_pk_add_f32 v[70:71], v[70:71], v[126:127]
    v_cvt_pk_bf16_f32 v36, v64, v65
    v_cvt_pk_bf16_f32 v37, v66, v67
    v_cvt_pk_bf16_f32 v38, v68, v69
    v_cvt_pk_bf16_f32 v39, v70, v71
    buffer_store_dwordx4 v[36:39], v2, s[8:11], s16 offen offset:1024 sc1
    s_lshl_b32 s19, s3, 16
    s_lshl_b32 s20, s3, 11
    s_lshl_b32 s16, s12, 8
    s_add_u32 s4, s38, s16
    s_addc_u32 s5, s39, 0
    s_sub_u32 s6, 0x800000, s16
    s_mov_b32 s7, 0x20000
    s_add_u32 s22, s19, 0x0
    s_add_u32 m0, s20, 0x0
    s_nop 0
    buffer_load_dwordx4 v3, s[4:7], s22 offen lds
    s_add_u32 s22, s19, 0x8000
    s_add_u32 m0, s20, 0x400
    s_nop 0
    buffer_load_dwordx4 v3, s[4:7], s22 offen lds
    s_add_u32 s22, s19, 0x80000
    s_add_u32 m0, s20, 0x4000
    s_nop 0
    buffer_load_dwordx4 v3, s[4:7], s22 offen lds
    s_add_u32 s22, s19, 0x88000
    s_add_u32 m0, s20, 0x4400
    s_nop 0
    buffer_load_dwordx4 v3, s[4:7], s22 offen lds
    s_add_u32 s22, s19, 0x100000
    s_add_u32 m0, s20, 0x8000
    s_nop 0
    buffer_load_dwordx4 v3, s[4:7], s22 offen lds
    s_add_u32 s22, s19, 0x108000
    s_add_u32 m0, s20, 0x8400
    s_nop 0
    buffer_load_dwordx4 v3, s[4:7], s22 offen lds
    v_mov_b32 v134, s28
    s_lshl_b32 s16, s29, 4
    s_add_u32 s16, s16, s31
    s_lshl_b32 s16, s16, 2
    s_add_u32 s16, s16, 0x528000
    v_and_b32 v16, 31, v1
    v_lshlrev_b32 v16, 2, v16
    s_lshl_b32 s17, s13, 3
    s_add_u32 s17, s17, s3
    s_lshl_b32 s17, s17, 7
    s_add_u32 s17, s17, 0x528000
    s_waitcnt vmcnt(6)
    s_mov_b64 exec, 1
    buffer_store_dword v134, v132, s[8:11], s16 offen sc1
    s_mov_b64 exec, -1
    s_sleep 48
    s_mov_b32 s27, 0
adaLN_cond__sliding_block_cached__moe_arch_mod__prompt_kernel_h15p:
    buffer_load_dword v17, v16, s[8:11], s17 offen sc1
    s_waitcnt vmcnt(0)
    v_cmp_ne_u32 vcc, s28, v17
    s_add_u32 s27, s27, 1
    s_cmp_ge_u32 s27, 262144
    s_cbranch_scc1 adaLN_cond__sliding_block_cached__moe_arch_mod__prompt_kernel_h15g
    s_cbranch_vccnz adaLN_cond__sliding_block_cached__moe_arch_mod__prompt_kernel_h15p
adaLN_cond__sliding_block_cached__moe_arch_mod__prompt_kernel_h15g:
    s_mov_b32 s23, 0x0
    buffer_load_dwordx4 v[88:91], v7, s[8:11], s23 offen offset:0 sc1
    s_mov_b32 s23, 0x8000
    buffer_load_dwordx4 v[92:95], v7, s[8:11], s23 offen offset:0 sc1
    s_mov_b32 s23, 0x0
    buffer_load_dwordx4 v[96:99], v7, s[8:11], s23 offen offset:1024 sc1
    s_mov_b32 s23, 0x8000
    buffer_load_dwordx4 v[100:103], v7, s[8:11], s23 offen offset:1024 sc1
    s_mov_b32 s23, 0x800
    buffer_load_dwordx4 v[104:107], v7, s[8:11], s23 offen offset:0 sc1
    s_mov_b32 s23, 0x8800
    buffer_load_dwordx4 v[108:111], v7, s[8:11], s23 offen offset:0 sc1
    s_mov_b32 s23, 0x800
    buffer_load_dwordx4 v[112:115], v7, s[8:11], s23 offen offset:1024 sc1
    s_mov_b32 s23, 0x8800
    buffer_load_dwordx4 v[116:119], v7, s[8:11], s23 offen offset:1024 sc1
    s_lshr_b32 s21, s12, 3
    s_lshl_b32 s21, s21, 17
    s_add_u32 s21, s21, s20
    s_add_u32 s21, s21, 0x400000
    s_barrier
    ds_read_b64_tr_b16 v[224:225], v4 offset:0
    ds_read_b64_tr_b16 v[226:227], v4 offset:1024
    ds_read_b64_tr_b16 v[228:229], v5 offset:32
    ds_read_b64_tr_b16 v[230:231], v5 offset:1056
    ds_read_b64_tr_b16 v[232:233], v4 offset:256
    ds_read_b64_tr_b16 v[234:235], v4 offset:1280
    ds_read_b64_tr_b16 v[236:237], v5 offset:288
    ds_read_b64_tr_b16 v[238:239], v5 offset:1312
    s_waitcnt vmcnt(7) lgkmcnt(6)
    v_mfma_f32_16x16x32_bf16 v[24:27], v[224:227], v[88:91], 0
    ds_read_b64_tr_b16 v[240:241], v4 offset:512
    s_waitcnt vmcnt(6)
    v_mfma_f32_16x16x32_bf16 v[28:31], v[224:227], v[92:95], 0
    ds_read_b64_tr_b16 v[242:243], v4 offset:1536
    s_waitcnt lgkmcnt(6)
    v_mfma_f32_16x16x32_bf16 v[32:35], v[228:231], v[88:91], 0
    ds_read_b64_tr_b16 v[244:245], v5 offset:544
    v_mfma_f32_16x16x32_bf16 v[36:39], v[228:231], v[92:95], 0
    ds_read_b64_tr_b16 v[246:247], v5 offset:1568
    s_mov_b32 s23, 0x1000
    buffer_load_dwordx4 v[120:123], v7, s[8:11], s23 offen offset:0 sc1
    s_waitcnt lgkmcnt(6)
    v_mfma_f32_16x16x32_bf16 v[40:43], v[232:235], v[88:91], 0
    ds_read_b64_tr_b16 v[224:225], v4 offset:768
    v_mfma_f32_16x16x32_bf16 v[44:47], v[232:235], v[92:95], 0
    ds_read_b64_tr_b16 v[226:227], v4 offset:1792
    s_waitcnt lgkmcnt(6)
    v_mfma_f32_16x16x32_bf16 v[48:51], v[236:239], v[88:91], 0
    ds_read_b64_tr_b16 v[228:229], v5 offset:800
    v_mfma_f32_16x16x32_bf16 v[52:55], v[236:239], v[92:95], 0
    ds_read_b64_tr_b16 v[230:231], v5 offset:1824
    s_waitcnt lgkmcnt(6)
    v_mfma_f32_16x16x32_bf16 v[56:59], v[240:243], v[88:91], 0
    ds_read_b64_tr_b16 v[232:233], v4 offset:8192
    v_mfma_f32_16x16x32_bf16 v[60:63], v[240:243], v[92:95], 0
    ds_read_b64_tr_b16 v[234:235], v4 offset:9216
    s_waitcnt lgkmcnt(6)
    v_mfma_f32_16x16x32_bf16 v[64:67], v[244:247], v[88:91], 0
    ds_read_b64_tr_b16 v[236:237], v5 offset:8224
    v_mfma_f32_16x16x32_bf16 v[68:71], v[244:247], v[92:95], 0
    ds_read_b64_tr_b16 v[238:239], v5 offset:9248
    s_mov_b32 s23, 0x9000
    buffer_load_dwordx4 v[124:127], v7, s[8:11], s23 offen offset:0 sc1
    s_waitcnt lgkmcnt(6)
    v_mfma_f32_16x16x32_bf16 v[72:75], v[224:227], v[88:91], 0
    ds_read_b64_tr_b16 v[240:241], v4 offset:8448
    v_mfma_f32_16x16x32_bf16 v[76:79], v[224:227], v[92:95], 0
    ds_read_b64_tr_b16 v[242:243], v4 offset:9472
    s_waitcnt lgkmcnt(6)
    v_mfma_f32_16x16x32_bf16 v[80:83], v[228:231], v[88:91], 0
    ds_read_b64_tr_b16 v[244:245], v5 offset:8480
    v_mfma_f32_16x16x32_bf16 v[84:87], v[228:231], v[92:95], 0
    ds_read_b64_tr_b16 v[246:247], v5 offset:9504
    s_waitcnt vmcnt(7) lgkmcnt(6)
    v_mfma_f32_16x16x32_bf16 v[24:27], v[232:235], v[96:99], v[24:27]
    ds_read_b64_tr_b16 v[224:225], v4 offset:8704
    s_waitcnt vmcnt(6)
    v_mfma_f32_16x16x32_bf16 v[28:31], v[232:235], v[100:103], v[28:31]
    ds_read_b64_tr_b16 v[226:227], v4 offset:9728
    s_waitcnt lgkmcnt(6)
    v_mfma_f32_16x16x32_bf16 v[32:35], v[236:239], v[96:99], v[32:35]
    ds_read_b64_tr_b16 v[228:229], v5 offset:8736
    v_mfma_f32_16x16x32_bf16 v[36:39], v[236:239], v[100:103], v[36:39]
    ds_read_b64_tr_b16 v[230:231], v5 offset:9760
    s_mov_b32 s23, 0x1000
    buffer_load_dwordx4 v[128:131], v7, s[8:11], s23 offen offset:1024 sc1
    s_waitcnt lgkmcnt(6)
    v_mfma_f32_16x16x32_bf16 v[40:43], v[240:243], v[96:99], v[40:43]
    ds_read_b64_tr_b16 v[232:233], v4 offset:8960
    v_mfma_f32_16x16x32_bf16 v[44:47], v[240:243], v[100:103], v[44:47]
    ds_read_b64_tr_b16 v[234:235], v4 offset:9984
    s_waitcnt lgkmcnt(6)
    v_mfma_f32_16x16x32_bf16 v[48:51], v[244:247], v[96:99], v[48:51]
    ds_read_b64_tr_b16 v[236:237], v5 offset:8992
    v_mfma_f32_16x16x32_bf16 v[52:55], v[244:247], v[100:103], v[52:55]
    ds_read_b64_tr_b16 v[238:239], v5 offset:10016
    s_waitcnt lgkmcnt(6)
    v_mfma_f32_16x16x32_bf16 v[56:59], v[224:227], v[96:99], v[56:59]
    v_mfma_f32_16x16x32_bf16 v[60:63], v[224:227], v[100:103], v[60:63]
    s_barrier
    ds_read_b64_tr_b16 v[240:241], v4 offset:16384
    ds_read_b64_tr_b16 v[242:243], v4 offset:17408
    s_waitcnt lgkmcnt(6)
    v_mfma_f32_16x16x32_bf16 v[64:67], v[228:231], v[96:99], v[64:67]
    ds_read_b64_tr_b16 v[244:245], v5 offset:16416
    v_mfma_f32_16x16x32_bf16 v[68:71], v[228:231], v[100:103], v[68:71]
    s_add_u32 s22, s19, 0x180000
    s_add_u32 m0, s20, 0xc000
    s_nop 0
    buffer_load_dwordx4 v3, s[4:7], s22 offen lds
    ds_read_b64_tr_b16 v[246:247], v5 offset:17440
    s_mov_b32 s23, 0x9000
    buffer_load_dwordx4 v[132:135], v7, s[8:11], s23 offen offset:1024 sc1
    s_waitcnt lgkmcnt(6)
    v_mfma_f32_16x16x32_bf16 v[72:75], v[232:235], v[96:99], v[72:75]
    ds_read_b64_tr_b16 v[224:225], v4 offset:16640
    v_mfma_f32_16x16x32_bf16 v[76:79], v[232:235], v[100:103], v[76:79]
    ds_read_b64_tr_b16 v[226:227], v4 offset:17664
    s_waitcnt lgkmcnt(6)
    v_mfma_f32_16x16x32_bf16 v[80:83], v[236:239], v[96:99], v[80:83]
    ds_read_b64_tr_b16 v[228:229], v5 offset:16672
    v_mfma_f32_16x16x32_bf16 v[84:87], v[236:239], v[100:103], v[84:87]
    ds_read_b64_tr_b16 v[230:231], v5 offset:17696
    s_waitcnt vmcnt(8) lgkmcnt(6)
    v_mfma_f32_16x16x32_bf16 v[24:27], v[240:243], v[104:107], v[24:27]
    ds_read_b64_tr_b16 v[232:233], v4 offset:16896
    s_waitcnt vmcnt(7)
    v_mfma_f32_16x16x32_bf16 v[28:31], v[240:243], v[108:111], v[28:31]
    ds_read_b64_tr_b16 v[234:235], v4 offset:17920
    s_waitcnt lgkmcnt(6)
    v_mfma_f32_16x16x32_bf16 v[32:35], v[244:247], v[104:107], v[32:35]
    ds_read_b64_tr_b16 v[236:237], v5 offset:16928
    v_mfma_f32_16x16x32_bf16 v[36:39], v[244:247], v[108:111], v[36:39]
    s_add_u32 s22, s19, 0x188000
    s_add_u32 m0, s20, 0xc400
    s_nop 0
    buffer_load_dwordx4 v3, s[4:7], s22 offen lds
    ds_read_b64_tr_b16 v[238:239], v5 offset:17952
    s_mov_b32 s23, 0x1800
    buffer_load_dwordx4 v[88:91], v7, s[8:11], s23 offen offset:0 sc1
    s_waitcnt lgkmcnt(6)
    v_mfma_f32_16x16x32_bf16 v[40:43], v[224:227], v[104:107], v[40:43]
    ds_read_b64_tr_b16 v[240:241], v4 offset:17152
    v_mfma_f32_16x16x32_bf16 v[44:47], v[224:227], v[108:111], v[44:47]
    ds_read_b64_tr_b16 v[242:243], v4 offset:18176
    s_waitcnt lgkmcnt(6)
    v_mfma_f32_16x16x32_bf16 v[48:51], v[228:231], v[104:107], v[48:51]
    ds_read_b64_tr_b16 v[244:245], v5 offset:17184
    v_mfma_f32_16x16x32_bf16 v[52:55], v[228:231], v[108:111], v[52:55]
    ds_read_b64_tr_b16 v[246:247], v5 offset:18208
    s_waitcnt lgkmcnt(6)
    v_mfma_f32_16x16x32_bf16 v[56:59], v[232:235], v[104:107], v[56:59]
    ds_read_b64_tr_b16 v[224:225], v4 offset:24576
    v_mfma_f32_16x16x32_bf16 v[60:63], v[232:235], v[108:111], v[60:63]
    ds_read_b64_tr_b16 v[226:227], v4 offset:25600
    s_waitcnt lgkmcnt(6)
    v_mfma_f32_16x16x32_bf16 v[64:67], v[236:239], v[104:107], v[64:67]
    ds_read_b64_tr_b16 v[228:229], v5 offset:24608
    v_mfma_f32_16x16x32_bf16 v[68:71], v[236:239], v[108:111], v[68:71]
    ds_read_b64_tr_b16 v[230:231], v5 offset:25632
    s_mov_b32 s23, 0x9800
    buffer_load_dwordx4 v[92:95], v7, s[8:11], s23 offen offset:0 sc1
    s_waitcnt lgkmcnt(6)
    v_mfma_f32_16x16x32_bf16 v[72:75], v[240:243], v[104:107], v[72:75]
    ds_read_b64_tr_b16 v[232:233], v4 offset:24832
    v_mfma_f32_16x16x32_bf16 v[76:79], v[240:243], v[108:111], v[76:79]
    ds_read_b64_tr_b16 v[234:235], v4 offset:25856
    s_waitcnt lgkmcnt(6)
    v_mfma_f32_16x16x32_bf16 v[80:83], v[244:247], v[104:107], v[80:83]
    ds_read_b64_tr_b16 v[236:237], v5 offset:24864
    v_mfma_f32_16x16x32_bf16 v[84:87], v[244:247], v[108:111], v[84:87]
    ds_read_b64_tr_b16 v[238:239], v5 offset:25888
    s_waitcnt vmcnt(9) lgkmcnt(6)
    v_mfma_f32_16x16x32_bf16 v[24:27], v[224:227], v[112:115], v[24:27]
    ds_read_b64_tr_b16 v[240:241], v4 offset:25088
    s_waitcnt vmcnt(8)
    v_mfma_f32_16x16x32_bf16 v[28:31], v[224:227], v[116:119], v[28:31]
    ds_read_b64_tr_b16 v[242:243], v4 offset:26112
    s_waitcnt lgkmcnt(6)
    v_mfma_f32_16x16x32_bf16 v[32:35], v[228:231], v[112:115], v[32:35]
    ds_read_b64_tr_b16 v[244:245], v5 offset:25120
    v_mfma_f32_16x16x32_bf16 v[36:39], v[228:231], v[116:119], v[36:39]
    ds_read_b64_tr_b16 v[246:247], v5 offset:26144
    s_mov_b32 s23, 0x1800
    buffer_load_dwordx4 v[96:99], v7, s[8:11], s23 offen offset:1024 sc1
    s_waitcnt lgkmcnt(6)
    v_mfma_f32_16x16x32_bf16 v[40:43], v[232:235], v[112:115], v[40:43]
    ds_read_b64_tr_b16 v[224:225], v4 offset:25344
    v_mfma_f32_16x16x32_bf16 v[44:47], v[232:235], v[116:119], v[44:47]
    ds_read_b64_tr_b16 v[226:227], v4 offset:26368
    s_waitcnt lgkmcnt(6)
    v_mfma_f32_16x16x32_bf16 v[48:51], v[236:239], v[112:115], v[48:51]
    ds_read_b64_tr_b16 v[228:229], v5 offset:25376
    v_mfma_f32_16x16x32_bf16 v[52:55], v[236:239], v[116:119], v[52:55]
    ds_read_b64_tr_b16 v[230:231], v5 offset:26400
    s_waitcnt lgkmcnt(6)
    v_mfma_f32_16x16x32_bf16 v[56:59], v[240:243], v[112:115], v[56:59]
    v_mfma_f32_16x16x32_bf16 v[60:63], v[240:243], v[116:119], v[60:63]
    s_barrier
    ds_read_b64_tr_b16 v[232:233], v4 offset:32768
    ds_read_b64_tr_b16 v[234:235], v4 offset:33792
    s_waitcnt lgkmcnt(6)
    v_mfma_f32_16x16x32_bf16 v[64:67], v[244:247], v[112:115], v[64:67]
    ds_read_b64_tr_b16 v[236:237], v5 offset:32800
    v_mfma_f32_16x16x32_bf16 v[68:71], v[244:247], v[116:119], v[68:71]
    s_add_u32 s22, s19, 0x200000
    s_add_u32 m0, s20, 0x0
    s_nop 0
    buffer_load_dwordx4 v3, s[4:7], s22 offen lds
    ds_read_b64_tr_b16 v[238:239], v5 offset:33824
    s_mov_b32 s23, 0x9800
    buffer_load_dwordx4 v[100:103], v7, s[8:11], s23 offen offset:1024 sc1
    s_waitcnt lgkmcnt(6)
    v_mfma_f32_16x16x32_bf16 v[72:75], v[224:227], v[112:115], v[72:75]
    ds_read_b64_tr_b16 v[240:241], v4 offset:33024
    v_mfma_f32_16x16x32_bf16 v[76:79], v[224:227], v[116:119], v[76:79]
    ds_read_b64_tr_b16 v[242:243], v4 offset:34048
    s_waitcnt lgkmcnt(6)
    v_mfma_f32_16x16x32_bf16 v[80:83], v[228:231], v[112:115], v[80:83]
    ds_read_b64_tr_b16 v[244:245], v5 offset:33056
    v_mfma_f32_16x16x32_bf16 v[84:87], v[228:231], v[116:119], v[84:87]
    ds_read_b64_tr_b16 v[246:247], v5 offset:34080
    s_waitcnt vmcnt(10) lgkmcnt(6)
    v_mfma_f32_16x16x32_bf16 v[24:27], v[232:235], v[120:123], v[24:27]
    ds_read_b64_tr_b16 v[224:225], v4 offset:33280
    s_waitcnt vmcnt(9)
    v_mfma_f32_16x16x32_bf16 v[28:31], v[232:235], v[124:127], v[28:31]
    ds_read_b64_tr_b16 v[226:227], v4 offset:34304
    s_waitcnt lgkmcnt(6)
    v_mfma_f32_16x16x32_bf16 v[32:35], v[236:239], v[120:123], v[32:35]
    ds_read_b64_tr_b16 v[228:229], v5 offset:33312
    v_mfma_f32_16x16x32_bf16 v[36:39], v[236:239], v[124:127], v[36:39]
    s_add_u32 s22, s19, 0x208000
    s_add_u32 m0, s20, 0x400
    s_nop 0
    buffer_load_dwordx4 v3, s[4:7], s22 offen lds
    ds_read_b64_tr_b16 v[230:231], v5 offset:34336
    s_mov_b32 s23, 0x2000
    buffer_load_dwordx4 v[104:107], v7, s[8:11], s23 offen offset:0 sc1
    s_waitcnt lgkmcnt(6)
    v_mfma_f32_16x16x32_bf16 v[40:43], v[240:243], v[120:123], v[40:43]
    ds_read_b64_tr_b16 v[232:233], v4 offset:33536
    v_mfma_f32_16x16x32_bf16 v[44:47], v[240:243], v[124:127], v[44:47]
    ds_read_b64_tr_b16 v[234:235], v4 offset:34560
    s_waitcnt lgkmcnt(6)
    v_mfma_f32_16x16x32_bf16 v[48:51], v[244:247], v[120:123], v[48:51]
    ds_read_b64_tr_b16 v[236:237], v5 offset:33568
    v_mfma_f32_16x16x32_bf16 v[52:55], v[244:247], v[124:127], v[52:55]
    ds_read_b64_tr_b16 v[238:239], v5 offset:34592
    s_waitcnt lgkmcnt(6)
    v_mfma_f32_16x16x32_bf16 v[56:59], v[224:227], v[120:123], v[56:59]
    ds_read_b64_tr_b16 v[240:241], v4 offset:40960
    v_mfma_f32_16x16x32_bf16 v[60:63], v[224:227], v[124:127], v[60:63]
    ds_read_b64_tr_b16 v[242:243], v4 offset:41984
    s_waitcnt lgkmcnt(6)
    v_mfma_f32_16x16x32_bf16 v[64:67], v[228:231], v[120:123], v[64:67]
    ds_read_b64_tr_b16 v[244:245], v5 offset:40992
    v_mfma_f32_16x16x32_bf16 v[68:71], v[228:231], v[124:127], v[68:71]
    ds_read_b64_tr_b16 v[246:247], v5 offset:42016
    s_mov_b32 s23, 0xa000
    buffer_load_dwordx4 v[108:111], v7, s[8:11], s23 offen offset:0 sc1
    s_waitcnt lgkmcnt(6)
    v_mfma_f32_16x16x32_bf16 v[72:75], v[232:235], v[120:123], v[72:75]
    ds_read_b64_tr_b16 v[224:225], v4 offset:41216
    v_mfma_f32_16x16x32_bf16 v[76:79], v[232:235], v[124:127], v[76:79]
    ds_read_b64_tr_b16 v[226:227], v4 offset:42240
    s_waitcnt lgkmcnt(6)
    v_mfma_f32_16x16x32_bf16 v[80:83], v[236:239], v[120:123], v[80:83]
    ds_read_b64_tr_b16 v[228:229], v5 offset:41248
    v_mfma_f32_16x16x32_bf16 v[84:87], v[236:239], v[124:127], v[84:87]
    ds_read_b64_tr_b16 v[230:231], v5 offset:42272
    s_waitcnt vmcnt(11) lgkmcnt(6)
    v_mfma_f32_16x16x32_bf16 v[24:27], v[240:243], v[128:131], v[24:27]
    ds_read_b64_tr_b16 v[232:233], v4 offset:41472
    s_waitcnt vmcnt(9)
    v_mfma_f32_16x16x32_bf16 v[28:31], v[240:243], v[132:135], v[28:31]
    ds_read_b64_tr_b16 v[234:235], v4 offset:42496
    s_waitcnt lgkmcnt(6)
    v_mfma_f32_16x16x32_bf16 v[32:35], v[244:247], v[128:131], v[32:35]
    ds_read_b64_tr_b16 v[236:237], v5 offset:41504
    v_mfma_f32_16x16x32_bf16 v[36:39], v[244:247], v[132:135], v[36:39]
    ds_read_b64_tr_b16 v[238:239], v5 offset:42528
    s_mov_b32 s23, 0x2000
    buffer_load_dwordx4 v[112:115], v7, s[8:11], s23 offen offset:1024 sc1
    s_waitcnt lgkmcnt(6)
    v_mfma_f32_16x16x32_bf16 v[40:43], v[224:227], v[128:131], v[40:43]
    ds_read_b64_tr_b16 v[240:241], v4 offset:41728
    v_mfma_f32_16x16x32_bf16 v[44:47], v[224:227], v[132:135], v[44:47]
    ds_read_b64_tr_b16 v[242:243], v4 offset:42752
    s_waitcnt lgkmcnt(6)
    v_mfma_f32_16x16x32_bf16 v[48:51], v[228:231], v[128:131], v[48:51]
    ds_read_b64_tr_b16 v[244:245], v5 offset:41760
    v_mfma_f32_16x16x32_bf16 v[52:55], v[228:231], v[132:135], v[52:55]
    ds_read_b64_tr_b16 v[246:247], v5 offset:42784
    s_waitcnt lgkmcnt(6)
    v_mfma_f32_16x16x32_bf16 v[56:59], v[232:235], v[128:131], v[56:59]
    v_mfma_f32_16x16x32_bf16 v[60:63], v[232:235], v[132:135], v[60:63]
    s_waitcnt vmcnt(9)
    s_barrier
    ds_read_b64_tr_b16 v[224:225], v4 offset:49152
    ds_read_b64_tr_b16 v[226:227], v4 offset:50176
    s_waitcnt lgkmcnt(6)
    v_mfma_f32_16x16x32_bf16 v[64:67], v[236:239], v[128:131], v[64:67]
    ds_read_b64_tr_b16 v[228:229], v5 offset:49184
    v_mfma_f32_16x16x32_bf16 v[68:71], v[236:239], v[132:135], v[68:71]
    s_add_u32 s22, s19, 0x280000
    s_add_u32 m0, s20, 0x4000
    s_nop 0
    buffer_load_dwordx4 v3, s[4:7], s22 offen lds
    ds_read_b64_tr_b16 v[230:231], v5 offset:50208
    s_mov_b32 s23, 0xa000
    buffer_load_dwordx4 v[116:119], v7, s[8:11], s23 offen offset:1024 sc1
    s_waitcnt lgkmcnt(6)
    v_mfma_f32_16x16x32_bf16 v[72:75], v[240:243], v[128:131], v[72:75]
    ds_read_b64_tr_b16 v[232:233], v4 offset:49408
    v_mfma_f32_16x16x32_bf16 v[76:79], v[240:243], v[132:135], v[76:79]
    ds_read_b64_tr_b16 v[234:235], v4 offset:50432
    s_waitcnt lgkmcnt(6)
    v_mfma_f32_16x16x32_bf16 v[80:83], v[244:247], v[128:131], v[80:83]
    ds_read_b64_tr_b16 v[236:237], v5 offset:49440
    v_mfma_f32_16x16x32_bf16 v[84:87], v[244:247], v[132:135], v[84:87]
    ds_read_b64_tr_b16 v[238:239], v5 offset:50464
    s_waitcnt vmcnt(10) lgkmcnt(6)
    v_mfma_f32_16x16x32_bf16 v[24:27], v[224:227], v[88:91], v[24:27]
    ds_read_b64_tr_b16 v[240:241], v4 offset:49664
    s_waitcnt vmcnt(9)
    v_mfma_f32_16x16x32_bf16 v[28:31], v[224:227], v[92:95], v[28:31]
    ds_read_b64_tr_b16 v[242:243], v4 offset:50688
    s_waitcnt lgkmcnt(6)
    v_mfma_f32_16x16x32_bf16 v[32:35], v[228:231], v[88:91], v[32:35]
    ds_read_b64_tr_b16 v[244:245], v5 offset:49696
    v_mfma_f32_16x16x32_bf16 v[36:39], v[228:231], v[92:95], v[36:39]
    s_add_u32 s22, s19, 0x288000
    s_add_u32 m0, s20, 0x4400
    s_nop 0
    buffer_load_dwordx4 v3, s[4:7], s22 offen lds
    ds_read_b64_tr_b16 v[246:247], v5 offset:50720
    s_mov_b32 s23, 0x2800
    buffer_load_dwordx4 v[120:123], v7, s[8:11], s23 offen offset:0 sc1
    s_waitcnt lgkmcnt(6)
    v_mfma_f32_16x16x32_bf16 v[40:43], v[232:235], v[88:91], v[40:43]
    ds_read_b64_tr_b16 v[224:225], v4 offset:49920
    v_mfma_f32_16x16x32_bf16 v[44:47], v[232:235], v[92:95], v[44:47]
    ds_read_b64_tr_b16 v[226:227], v4 offset:50944
    s_waitcnt lgkmcnt(6)
    v_mfma_f32_16x16x32_bf16 v[48:51], v[236:239], v[88:91], v[48:51]
    ds_read_b64_tr_b16 v[228:229], v5 offset:49952
    v_mfma_f32_16x16x32_bf16 v[52:55], v[236:239], v[92:95], v[52:55]
    ds_read_b64_tr_b16 v[230:231], v5 offset:50976
    s_waitcnt lgkmcnt(6)
    v_mfma_f32_16x16x32_bf16 v[56:59], v[240:243], v[88:91], v[56:59]
    ds_read_b64_tr_b16 v[232:233], v4 offset:57344
    v_mfma_f32_16x16x32_bf16 v[60:63], v[240:243], v[92:95], v[60:63]
    ds_read_b64_tr_b16 v[234:235], v4 offset:58368
    s_waitcnt lgkmcnt(6)
    v_mfma_f32_16x16x32_bf16 v[64:67], v[244:247], v[88:91], v[64:67]
    ds_read_b64_tr_b16 v[236:237], v5 offset:57376
    v_mfma_f32_16x16x32_bf16 v[68:71], v[244:247], v[92:95], v[68:71]
    ds_read_b64_tr_b16 v[238:239], v5 offset:58400
    s_mov_b32 s23, 0xa800
    buffer_load_dwordx4 v[124:127], v7, s[8:11], s23 offen offset:0 sc1
    s_waitcnt lgkmcnt(6)
    v_mfma_f32_16x16x32_bf16 v[72:75], v[224:227], v[88:91], v[72:75]
    ds_read_b64_tr_b16 v[240:241], v4 offset:57600
    v_mfma_f32_16x16x32_bf16 v[76:79], v[224:227], v[92:95], v[76:79]
    ds_read_b64_tr_b16 v[242:243], v4 offset:58624
    s_waitcnt lgkmcnt(6)
    v_mfma_f32_16x16x32_bf16 v[80:83], v[228:231], v[88:91], v[80:83]
    ds_read_b64_tr_b16 v[244:245], v5 offset:57632
    v_mfma_f32_16x16x32_bf16 v[84:87], v[228:231], v[92:95], v[84:87]
    ds_read_b64_tr_b16 v[246:247], v5 offset:58656
    s_waitcnt vmcnt(11) lgkmcnt(6)
    v_mfma_f32_16x16x32_bf16 v[24:27], v[232:235], v[96:99], v[24:27]
    ds_read_b64_tr_b16 v[224:225], v4 offset:57856
    s_waitcnt vmcnt(9)
    v_mfma_f32_16x16x32_bf16 v[28:31], v[232:235], v[100:103], v[28:31]
    ds_read_b64_tr_b16 v[226:227], v4 offset:58880
    s_waitcnt lgkmcnt(6)
    v_mfma_f32_16x16x32_bf16 v[32:35], v[236:239], v[96:99], v[32:35]
    ds_read_b64_tr_b16 v[228:229], v5 offset:57888
    v_mfma_f32_16x16x32_bf16 v[36:39], v[236:239], v[100:103], v[36:39]
    ds_read_b64_tr_b16 v[230:231], v5 offset:58912
    s_mov_b32 s23, 0x2800
    buffer_load_dwordx4 v[128:131], v7, s[8:11], s23 offen offset:1024 sc1
    s_waitcnt lgkmcnt(6)
    v_mfma_f32_16x16x32_bf16 v[40:43], v[240:243], v[96:99], v[40:43]
    ds_read_b64_tr_b16 v[232:233], v4 offset:58112
    v_mfma_f32_16x16x32_bf16 v[44:47], v[240:243], v[100:103], v[44:47]
    ds_read_b64_tr_b16 v[234:235], v4 offset:59136
    s_waitcnt lgkmcnt(6)
    v_mfma_f32_16x16x32_bf16 v[48:51], v[244:247], v[96:99], v[48:51]
    ds_read_b64_tr_b16 v[236:237], v5 offset:58144
    v_mfma_f32_16x16x32_bf16 v[52:55], v[244:247], v[100:103], v[52:55]
    ds_read_b64_tr_b16 v[238:239], v5 offset:59168
    s_waitcnt lgkmcnt(6)
    v_mfma_f32_16x16x32_bf16 v[56:59], v[224:227], v[96:99], v[56:59]
    v_mfma_f32_16x16x32_bf16 v[60:63], v[224:227], v[100:103], v[60:63]
    s_waitcnt vmcnt(9)
    s_barrier
    ds_read_b64_tr_b16 v[240:241], v4 offset:0
    ds_read_b64_tr_b16 v[242:243], v4 offset:1024
    s_waitcnt lgkmcnt(6)
    v_mfma_f32_16x16x32_bf16 v[64:67], v[228:231], v[96:99], v[64:67]
    ds_read_b64_tr_b16 v[244:245], v5 offset:32
    v_mfma_f32_16x16x32_bf16 v[68:71], v[228:231], v[100:103], v[68:71]
    s_add_u32 s22, s19, 0x300000
    s_add_u32 m0, s20, 0x8000
    s_nop 0
    buffer_load_dwordx4 v3, s[4:7], s22 offen lds
    ds_read_b64_tr_b16 v[246:247], v5 offset:1056
    s_mov_b32 s23, 0xa800
    buffer_load_dwordx4 v[132:135], v7, s[8:11], s23 offen offset:1024 sc1
    s_waitcnt lgkmcnt(6)
    v_mfma_f32_16x16x32_bf16 v[72:75], v[232:235], v[96:99], v[72:75]
    ds_read_b64_tr_b16 v[224:225], v4 offset:256
    v_mfma_f32_16x16x32_bf16 v[76:79], v[232:235], v[100:103], v[76:79]
    ds_read_b64_tr_b16 v[226:227], v4 offset:1280
    s_waitcnt lgkmcnt(6)
    v_mfma_f32_16x16x32_bf16 v[80:83], v[236:239], v[96:99], v[80:83]
    ds_read_b64_tr_b16 v[228:229], v5 offset:288
    v_mfma_f32_16x16x32_bf16 v[84:87], v[236:239], v[100:103], v[84:87]
    ds_read_b64_tr_b16 v[230:231], v5 offset:1312
    s_waitcnt vmcnt(10) lgkmcnt(6)
    v_mfma_f32_16x16x32_bf16 v[24:27], v[240:243], v[104:107], v[24:27]
    ds_read_b64_tr_b16 v[232:233], v4 offset:512
    s_waitcnt vmcnt(9)
    v_mfma_f32_16x16x32_bf16 v[28:31], v[240:243], v[108:111], v[28:31]
    ds_read_b64_tr_b16 v[234:235], v4 offset:1536
    s_waitcnt lgkmcnt(6)
    v_mfma_f32_16x16x32_bf16 v[32:35], v[244:247], v[104:107], v[32:35]
    ds_read_b64_tr_b16 v[236:237], v5 offset:544
    v_mfma_f32_16x16x32_bf16 v[36:39], v[244:247], v[108:111], v[36:39]
    s_add_u32 s22, s19, 0x308000
    s_add_u32 m0, s20, 0x8400
    s_nop 0
    buffer_load_dwordx4 v3, s[4:7], s22 offen lds
    ds_read_b64_tr_b16 v[238:239], v5 offset:1568
    s_mov_b32 s23, 0x3000
    buffer_load_dwordx4 v[88:91], v7, s[8:11], s23 offen offset:0 sc1
    s_waitcnt lgkmcnt(6)
    v_mfma_f32_16x16x32_bf16 v[40:43], v[224:227], v[104:107], v[40:43]
    ds_read_b64_tr_b16 v[240:241], v4 offset:768
    v_mfma_f32_16x16x32_bf16 v[44:47], v[224:227], v[108:111], v[44:47]
    ds_read_b64_tr_b16 v[242:243], v4 offset:1792
    s_waitcnt lgkmcnt(6)
    v_mfma_f32_16x16x32_bf16 v[48:51], v[228:231], v[104:107], v[48:51]
    ds_read_b64_tr_b16 v[244:245], v5 offset:800
    v_mfma_f32_16x16x32_bf16 v[52:55], v[228:231], v[108:111], v[52:55]
    ds_read_b64_tr_b16 v[246:247], v5 offset:1824
    s_waitcnt lgkmcnt(6)
    v_mfma_f32_16x16x32_bf16 v[56:59], v[232:235], v[104:107], v[56:59]
    ds_read_b64_tr_b16 v[224:225], v4 offset:8192
    v_mfma_f32_16x16x32_bf16 v[60:63], v[232:235], v[108:111], v[60:63]
    ds_read_b64_tr_b16 v[226:227], v4 offset:9216
    s_waitcnt lgkmcnt(6)
    v_mfma_f32_16x16x32_bf16 v[64:67], v[236:239], v[104:107], v[64:67]
    ds_read_b64_tr_b16 v[228:229], v5 offset:8224
    v_mfma_f32_16x16x32_bf16 v[68:71], v[236:239], v[108:111], v[68:71]
    ds_read_b64_tr_b16 v[230:231], v5 offset:9248
    s_mov_b32 s23, 0xb000
    buffer_load_dwordx4 v[92:95], v7, s[8:11], s23 offen offset:0 sc1
    s_waitcnt lgkmcnt(6)
    v_mfma_f32_16x16x32_bf16 v[72:75], v[240:243], v[104:107], v[72:75]
    ds_read_b64_tr_b16 v[232:233], v4 offset:8448
    v_mfma_f32_16x16x32_bf16 v[76:79], v[240:243], v[108:111], v[76:79]
    ds_read_b64_tr_b16 v[234:235], v4 offset:9472
    s_waitcnt lgkmcnt(6)
    v_mfma_f32_16x16x32_bf16 v[80:83], v[244:247], v[104:107], v[80:83]
    ds_read_b64_tr_b16 v[236:237], v5 offset:8480
    v_mfma_f32_16x16x32_bf16 v[84:87], v[244:247], v[108:111], v[84:87]
    ds_read_b64_tr_b16 v[238:239], v5 offset:9504
    s_waitcnt vmcnt(11) lgkmcnt(6)
    v_mfma_f32_16x16x32_bf16 v[24:27], v[224:227], v[112:115], v[24:27]
    ds_read_b64_tr_b16 v[240:241], v4 offset:8704
    s_waitcnt vmcnt(9)
    v_mfma_f32_16x16x32_bf16 v[28:31], v[224:227], v[116:119], v[28:31]
    ds_read_b64_tr_b16 v[242:243], v4 offset:9728
    s_waitcnt lgkmcnt(6)
    v_mfma_f32_16x16x32_bf16 v[32:35], v[228:231], v[112:115], v[32:35]
    ds_read_b64_tr_b16 v[244:245], v5 offset:8736
    v_mfma_f32_16x16x32_bf16 v[36:39], v[228:231], v[116:119], v[36:39]
    ds_read_b64_tr_b16 v[246:247], v5 offset:9760
    s_mov_b32 s23, 0x3000
    buffer_load_dwordx4 v[96:99], v7, s[8:11], s23 offen offset:1024 sc1
    s_waitcnt lgkmcnt(6)
    v_mfma_f32_16x16x32_bf16 v[40:43], v[232:235], v[112:115], v[40:43]
    ds_read_b64_tr_b16 v[224:225], v4 offset:8960
    v_mfma_f32_16x16x32_bf16 v[44:47], v[232:235], v[116:119], v[44:47]
    ds_read_b64_tr_b16 v[226:227], v4 offset:9984
    s_waitcnt lgkmcnt(6)
    v_mfma_f32_16x16x32_bf16 v[48:51], v[236:239], v[112:115], v[48:51]
    ds_read_b64_tr_b16 v[228:229], v5 offset:8992
    v_mfma_f32_16x16x32_bf16 v[52:55], v[236:239], v[116:119], v[52:55]
    ds_read_b64_tr_b16 v[230:231], v5 offset:10016
    s_waitcnt lgkmcnt(6)
    v_mfma_f32_16x16x32_bf16 v[56:59], v[240:243], v[112:115], v[56:59]
    v_mfma_f32_16x16x32_bf16 v[60:63], v[240:243], v[116:119], v[60:63]
    s_waitcnt vmcnt(9)
    s_barrier
    ds_read_b64_tr_b16 v[232:233], v4 offset:16384
    ds_read_b64_tr_b16 v[234:235], v4 offset:17408
    s_waitcnt lgkmcnt(6)
    v_mfma_f32_16x16x32_bf16 v[64:67], v[244:247], v[112:115], v[64:67]
    ds_read_b64_tr_b16 v[236:237], v5 offset:16416
    v_mfma_f32_16x16x32_bf16 v[68:71], v[244:247], v[116:119], v[68:71]
    s_add_u32 s22, s19, 0x380000
    s_add_u32 m0, s20, 0xc000
    s_nop 0
    buffer_load_dwordx4 v3, s[4:7], s22 offen lds
    ds_read_b64_tr_b16 v[238:239], v5 offset:17440
    s_mov_b32 s23, 0xb000
    buffer_load_dwordx4 v[100:103], v7, s[8:11], s23 offen offset:1024 sc1
    s_waitcnt lgkmcnt(6)
    v_mfma_f32_16x16x32_bf16 v[72:75], v[224:227], v[112:115], v[72:75]
    ds_read_b64_tr_b16 v[240:241], v4 offset:16640
    v_mfma_f32_16x16x32_bf16 v[76:79], v[224:227], v[116:119], v[76:79]
    ds_read_b64_tr_b16 v[242:243], v4 offset:17664
    s_waitcnt lgkmcnt(6)
    v_mfma_f32_16x16x32_bf16 v[80:83], v[228:231], v[112:115], v[80:83]
    ds_read_b64_tr_b16 v[244:245], v5 offset:16672
    v_mfma_f32_16x16x32_bf16 v[84:87], v[228:231], v[116:119], v[84:87]
    ds_read_b64_tr_b16 v[246:247], v5 offset:17696
    s_waitcnt vmcnt(10) lgkmcnt(6)
    v_mfma_f32_16x16x32_bf16 v[24:27], v[232:235], v[120:123], v[24:27]
    ds_read_b64_tr_b16 v[224:225], v4 offset:16896
    s_waitcnt vmcnt(9)
    v_mfma_f32_16x16x32_bf16 v[28:31], v[232:235], v[124:127], v[28:31]
    ds_read_b64_tr_b16 v[226:227], v4 offset:17920
    s_waitcnt lgkmcnt(6)
    v_mfma_f32_16x16x32_bf16 v[32:35], v[236:239], v[120:123], v[32:35]
    ds_read_b64_tr_b16 v[228:229], v5 offset:16928
    v_mfma_f32_16x16x32_bf16 v[36:39], v[236:239], v[124:127], v[36:39]
    s_add_u32 s22, s19, 0x388000
    s_add_u32 m0, s20, 0xc400
    s_nop 0
    buffer_load_dwordx4 v3, s[4:7], s22 offen lds
    ds_read_b64_tr_b16 v[230:231], v5 offset:17952
    s_mov_b32 s23, 0x3800
    buffer_load_dwordx4 v[104:107], v7, s[8:11], s23 offen offset:0 sc1
    s_waitcnt lgkmcnt(6)
    v_mfma_f32_16x16x32_bf16 v[40:43], v[240:243], v[120:123], v[40:43]
    ds_read_b64_tr_b16 v[232:233], v4 offset:17152
    v_mfma_f32_16x16x32_bf16 v[44:47], v[240:243], v[124:127], v[44:47]
    ds_read_b64_tr_b16 v[234:235], v4 offset:18176
    s_waitcnt lgkmcnt(6)
    v_mfma_f32_16x16x32_bf16 v[48:51], v[244:247], v[120:123], v[48:51]
    ds_read_b64_tr_b16 v[236:237], v5 offset:17184
    v_mfma_f32_16x16x32_bf16 v[52:55], v[244:247], v[124:127], v[52:55]
    ds_read_b64_tr_b16 v[238:239], v5 offset:18208
    s_waitcnt lgkmcnt(6)
    v_mfma_f32_16x16x32_bf16 v[56:59], v[224:227], v[120:123], v[56:59]
    ds_read_b64_tr_b16 v[240:241], v4 offset:24576
    v_mfma_f32_16x16x32_bf16 v[60:63], v[224:227], v[124:127], v[60:63]
    ds_read_b64_tr_b16 v[242:243], v4 offset:25600
    s_waitcnt lgkmcnt(6)
    v_mfma_f32_16x16x32_bf16 v[64:67], v[228:231], v[120:123], v[64:67]
    ds_read_b64_tr_b16 v[244:245], v5 offset:24608
    v_mfma_f32_16x16x32_bf16 v[68:71], v[228:231], v[124:127], v[68:71]
    ds_read_b64_tr_b16 v[246:247], v5 offset:25632
    s_mov_b32 s23, 0xb800
    buffer_load_dwordx4 v[108:111], v7, s[8:11], s23 offen offset:0 sc1
    s_waitcnt lgkmcnt(6)
    v_mfma_f32_16x16x32_bf16 v[72:75], v[232:235], v[120:123], v[72:75]
    ds_read_b64_tr_b16 v[224:225], v4 offset:24832
    v_mfma_f32_16x16x32_bf16 v[76:79], v[232:235], v[124:127], v[76:79]
    ds_read_b64_tr_b16 v[226:227], v4 offset:25856
    s_waitcnt lgkmcnt(6)
    v_mfma_f32_16x16x32_bf16 v[80:83], v[236:239], v[120:123], v[80:83]
    ds_read_b64_tr_b16 v[228:229], v5 offset:24864
    v_mfma_f32_16x16x32_bf16 v[84:87], v[236:239], v[124:127], v[84:87]
    ds_read_b64_tr_b16 v[230:231], v5 offset:25888
    s_waitcnt vmcnt(11) lgkmcnt(6)
    v_mfma_f32_16x16x32_bf16 v[24:27], v[240:243], v[128:131], v[24:27]
    ds_read_b64_tr_b16 v[232:233], v4 offset:25088
    s_waitcnt vmcnt(9)
    v_mfma_f32_16x16x32_bf16 v[28:31], v[240:243], v[132:135], v[28:31]
    ds_read_b64_tr_b16 v[234:235], v4 offset:26112
    s_waitcnt lgkmcnt(6)
    v_mfma_f32_16x16x32_bf16 v[32:35], v[244:247], v[128:131], v[32:35]
    ds_read_b64_tr_b16 v[236:237], v5 offset:25120
    v_mfma_f32_16x16x32_bf16 v[36:39], v[244:247], v[132:135], v[36:39]
    ds_read_b64_tr_b16 v[238:239], v5 offset:26144
    s_mov_b32 s23, 0x3800
    buffer_load_dwordx4 v[112:115], v7, s[8:11], s23 offen offset:1024 sc1
    s_waitcnt lgkmcnt(6)
    v_mfma_f32_16x16x32_bf16 v[40:43], v[224:227], v[128:131], v[40:43]
    ds_read_b64_tr_b16 v[240:241], v4 offset:25344
    v_mfma_f32_16x16x32_bf16 v[44:47], v[224:227], v[132:135], v[44:47]
    ds_read_b64_tr_b16 v[242:243], v4 offset:26368
    s_waitcnt lgkmcnt(6)
    v_mfma_f32_16x16x32_bf16 v[48:51], v[228:231], v[128:131], v[48:51]
    ds_read_b64_tr_b16 v[244:245], v5 offset:25376
    v_mfma_f32_16x16x32_bf16 v[52:55], v[228:231], v[132:135], v[52:55]
    ds_read_b64_tr_b16 v[246:247], v5 offset:26400
    s_waitcnt lgkmcnt(6)
    v_mfma_f32_16x16x32_bf16 v[56:59], v[232:235], v[128:131], v[56:59]
    v_mfma_f32_16x16x32_bf16 v[60:63], v[232:235], v[132:135], v[60:63]
    s_waitcnt vmcnt(9)
    s_barrier
    ds_read_b64_tr_b16 v[224:225], v4 offset:32768
    ds_read_b64_tr_b16 v[226:227], v4 offset:33792
    s_waitcnt lgkmcnt(6)
    v_mfma_f32_16x16x32_bf16 v[64:67], v[236:239], v[128:131], v[64:67]
    ds_read_b64_tr_b16 v[228:229], v5 offset:32800
    v_mfma_f32_16x16x32_bf16 v[68:71], v[236:239], v[132:135], v[68:71]
    s_add_u32 s22, s19, 0x400000
    s_add_u32 m0, s20, 0x0
    s_nop 0
    buffer_load_dwordx4 v3, s[4:7], s22 offen lds
    ds_read_b64_tr_b16 v[230:231], v5 offset:33824
    s_mov_b32 s23, 0xb800
    buffer_load_dwordx4 v[116:119], v7, s[8:11], s23 offen offset:1024 sc1
    s_waitcnt lgkmcnt(6)
    v_mfma_f32_16x16x32_bf16 v[72:75], v[240:243], v[128:131], v[72:75]
    ds_read_b64_tr_b16 v[232:233], v4 offset:33024
    v_mfma_f32_16x16x32_bf16 v[76:79], v[240:243], v[132:135], v[76:79]
    ds_read_b64_tr_b16 v[234:235], v4 offset:34048
    s_waitcnt lgkmcnt(6)
    v_mfma_f32_16x16x32_bf16 v[80:83], v[244:247], v[128:131], v[80:83]
    ds_read_b64_tr_b16 v[236:237], v5 offset:33056
    v_mfma_f32_16x16x32_bf16 v[84:87], v[244:247], v[132:135], v[84:87]
    ds_read_b64_tr_b16 v[238:239], v5 offset:34080
    s_waitcnt vmcnt(10) lgkmcnt(6)
    v_mfma_f32_16x16x32_bf16 v[24:27], v[224:227], v[88:91], v[24:27]
    ds_read_b64_tr_b16 v[240:241], v4 offset:33280
    s_waitcnt vmcnt(9)
    v_mfma_f32_16x16x32_bf16 v[28:31], v[224:227], v[92:95], v[28:31]
    ds_read_b64_tr_b16 v[242:243], v4 offset:34304
    s_waitcnt lgkmcnt(6)
    v_mfma_f32_16x16x32_bf16 v[32:35], v[228:231], v[88:91], v[32:35]
    ds_read_b64_tr_b16 v[244:245], v5 offset:33312
    v_mfma_f32_16x16x32_bf16 v[36:39], v[228:231], v[92:95], v[36:39]
    s_add_u32 s22, s19, 0x408000
    s_add_u32 m0, s20, 0x400
    s_nop 0
    buffer_load_dwordx4 v3, s[4:7], s22 offen lds
    ds_read_b64_tr_b16 v[246:247], v5 offset:34336
    s_mov_b32 s23, 0x4000
    buffer_load_dwordx4 v[120:123], v7, s[8:11], s23 offen offset:0 sc1
    s_waitcnt lgkmcnt(6)
    v_mfma_f32_16x16x32_bf16 v[40:43], v[232:235], v[88:91], v[40:43]
    ds_read_b64_tr_b16 v[224:225], v4 offset:33536
    v_mfma_f32_16x16x32_bf16 v[44:47], v[232:235], v[92:95], v[44:47]
    ds_read_b64_tr_b16 v[226:227], v4 offset:34560
    s_waitcnt lgkmcnt(6)
    v_mfma_f32_16x16x32_bf16 v[48:51], v[236:239], v[88:91], v[48:51]
    ds_read_b64_tr_b16 v[228:229], v5 offset:33568
    v_mfma_f32_16x16x32_bf16 v[52:55], v[236:239], v[92:95], v[52:55]
    ds_read_b64_tr_b16 v[230:231], v5 offset:34592
    s_waitcnt lgkmcnt(6)
    v_mfma_f32_16x16x32_bf16 v[56:59], v[240:243], v[88:91], v[56:59]
    ds_read_b64_tr_b16 v[232:233], v4 offset:40960
    v_mfma_f32_16x16x32_bf16 v[60:63], v[240:243], v[92:95], v[60:63]
    ds_read_b64_tr_b16 v[234:235], v4 offset:41984
    s_waitcnt lgkmcnt(6)
    v_mfma_f32_16x16x32_bf16 v[64:67], v[244:247], v[88:91], v[64:67]
    ds_read_b64_tr_b16 v[236:237], v5 offset:40992
    v_mfma_f32_16x16x32_bf16 v[68:71], v[244:247], v[92:95], v[68:71]
    ds_read_b64_tr_b16 v[238:239], v5 offset:42016
    s_mov_b32 s23, 0xc000
    buffer_load_dwordx4 v[124:127], v7, s[8:11], s23 offen offset:0 sc1
    s_waitcnt lgkmcnt(6)
    v_mfma_f32_16x16x32_bf16 v[72:75], v[224:227], v[88:91], v[72:75]
    ds_read_b64_tr_b16 v[240:241], v4 offset:41216
    v_lshrrev_b32 v21, 4, v1
    v_lshlrev_b32 v21, 9, v21
    v_and_b32 v20, 15, v1
    v_lshl_add_u32 v21, v20, 4, v21
    s_lshr_b32 s18, s12, 3
    s_lshl_b32 s18, s18, 11
    s_add_u32 s18, s18, 0x528100
    buffer_load_dwordx4 v[12:15], v21, s[8:11], s18 offen sc1
    v_mfma_f32_16x16x32_bf16 v[76:79], v[224:227], v[92:95], v[76:79]
    ds_read_b64_tr_b16 v[242:243], v4 offset:42240
    s_waitcnt lgkmcnt(6)
    v_mfma_f32_16x16x32_bf16 v[80:83], v[228:231], v[88:91], v[80:83]
    ds_read_b64_tr_b16 v[244:245], v5 offset:41248
    v_mfma_f32_16x16x32_bf16 v[84:87], v[228:231], v[92:95], v[84:87]
    ds_read_b64_tr_b16 v[246:247], v5 offset:42272
    s_waitcnt vmcnt(12) lgkmcnt(6)
    v_mfma_f32_16x16x32_bf16 v[24:27], v[232:235], v[96:99], v[24:27]
    ds_read_b64_tr_b16 v[224:225], v4 offset:41472
    s_waitcnt vmcnt(10)
    v_mfma_f32_16x16x32_bf16 v[28:31], v[232:235], v[100:103], v[28:31]
    ds_read_b64_tr_b16 v[226:227], v4 offset:42496
    s_waitcnt lgkmcnt(6)
    v_mfma_f32_16x16x32_bf16 v[32:35], v[236:239], v[96:99], v[32:35]
    ds_read_b64_tr_b16 v[228:229], v5 offset:41504
    v_mfma_f32_16x16x32_bf16 v[36:39], v[236:239], v[100:103], v[36:39]
    ds_read_b64_tr_b16 v[230:231], v5 offset:42528
    s_mov_b32 s23, 0x4000
    buffer_load_dwordx4 v[128:131], v7, s[8:11], s23 offen offset:1024 sc1
    s_waitcnt lgkmcnt(6)
    v_mfma_f32_16x16x32_bf16 v[40:43], v[240:243], v[96:99], v[40:43]
    ds_read_b64_tr_b16 v[232:233], v4 offset:41728
    v_mfma_f32_16x16x32_bf16 v[44:47], v[240:243], v[100:103], v[44:47]
    ds_read_b64_tr_b16 v[234:235], v4 offset:42752
    s_waitcnt lgkmcnt(6)
    v_mfma_f32_16x16x32_bf16 v[48:51], v[244:247], v[96:99], v[48:51]
    ds_read_b64_tr_b16 v[236:237], v5 offset:41760
    v_mfma_f32_16x16x32_bf16 v[52:55], v[244:247], v[100:103], v[52:55]
    ds_read_b64_tr_b16 v[238:239], v5 offset:42784
    s_waitcnt lgkmcnt(6)
    v_mfma_f32_16x16x32_bf16 v[56:59], v[224:227], v[96:99], v[56:59]
    v_mfma_f32_16x16x32_bf16 v[60:63], v[224:227], v[100:103], v[60:63]
    s_waitcnt vmcnt(10)
    s_barrier
    ds_read_b64_tr_b16 v[240:241], v4 offset:49152
    ds_read_b64_tr_b16 v[242:243], v4 offset:50176
    s_waitcnt lgkmcnt(6)
    v_mfma_f32_16x16x32_bf16 v[64:67], v[228:231], v[96:99], v[64:67]
    ds_read_b64_tr_b16 v[244:245], v5 offset:49184
    v_mfma_f32_16x16x32_bf16 v[68:71], v[228:231], v[100:103], v[68:71]
    s_add_u32 s22, s19, 0x480000
    s_add_u32 m0, s20, 0x4000
    s_nop 0
    buffer_load_dwordx4 v3, s[4:7], s22 offen lds
    ds_read_b64_tr_b16 v[246:247], v5 offset:50208
    s_mov_b32 s23, 0xc000
    buffer_load_dwordx4 v[132:135], v7, s[8:11], s23 offen offset:1024 sc1
    s_waitcnt lgkmcnt(6)
    v_mfma_f32_16x16x32_bf16 v[72:75], v[232:235], v[96:99], v[72:75]
    ds_read_b64_tr_b16 v[224:225], v4 offset:49408
    v_mfma_f32_16x16x32_bf16 v[76:79], v[232:235], v[100:103], v[76:79]
    ds_read_b64_tr_b16 v[226:227], v4 offset:50432
    s_waitcnt lgkmcnt(6)
    v_mfma_f32_16x16x32_bf16 v[80:83], v[236:239], v[96:99], v[80:83]
    ds_read_b64_tr_b16 v[228:229], v5 offset:49440
    v_mfma_f32_16x16x32_bf16 v[84:87], v[236:239], v[100:103], v[84:87]
    ds_read_b64_tr_b16 v[230:231], v5 offset:50464
    s_waitcnt vmcnt(11) lgkmcnt(6)
    v_mfma_f32_16x16x32_bf16 v[24:27], v[240:243], v[104:107], v[24:27]
    ds_read_b64_tr_b16 v[232:233], v4 offset:49664
    s_waitcnt vmcnt(10)
    v_mfma_f32_16x16x32_bf16 v[28:31], v[240:243], v[108:111], v[28:31]
    ds_read_b64_tr_b16 v[234:235], v4 offset:50688
    s_waitcnt lgkmcnt(6)
    v_mfma_f32_16x16x32_bf16 v[32:35], v[244:247], v[104:107], v[32:35]
    ds_read_b64_tr_b16 v[236:237], v5 offset:49696
    v_mfma_f32_16x16x32_bf16 v[36:39], v[244:247], v[108:111], v[36:39]
    s_add_u32 s22, s19, 0x488000
    s_add_u32 m0, s20, 0x4400
    s_nop 0
    buffer_load_dwordx4 v3, s[4:7], s22 offen lds
    ds_read_b64_tr_b16 v[238:239], v5 offset:50720
    s_mov_b32 s23, 0x4800
    buffer_load_dwordx4 v[88:91], v7, s[8:11], s23 offen offset:0 sc1
    s_waitcnt lgkmcnt(6)
    v_mfma_f32_16x16x32_bf16 v[40:43], v[224:227], v[104:107], v[40:43]
    ds_read_b64_tr_b16 v[240:241], v4 offset:49920
    v_mfma_f32_16x16x32_bf16 v[44:47], v[224:227], v[108:111], v[44:47]
    ds_read_b64_tr_b16 v[242:243], v4 offset:50944
    s_waitcnt lgkmcnt(6)
    v_mfma_f32_16x16x32_bf16 v[48:51], v[228:231], v[104:107], v[48:51]
    ds_read_b64_tr_b16 v[244:245], v5 offset:49952
    v_mfma_f32_16x16x32_bf16 v[52:55], v[228:231], v[108:111], v[52:55]
    ds_read_b64_tr_b16 v[246:247], v5 offset:50976
    s_waitcnt lgkmcnt(6)
    v_mfma_f32_16x16x32_bf16 v[56:59], v[232:235], v[104:107], v[56:59]
    ds_read_b64_tr_b16 v[224:225], v4 offset:57344
    v_mfma_f32_16x16x32_bf16 v[60:63], v[232:235], v[108:111], v[60:63]
    ds_read_b64_tr_b16 v[226:227], v4 offset:58368
    s_waitcnt lgkmcnt(6)
    v_mfma_f32_16x16x32_bf16 v[64:67], v[236:239], v[104:107], v[64:67]
    ds_read_b64_tr_b16 v[228:229], v5 offset:57376
    v_mfma_f32_16x16x32_bf16 v[68:71], v[236:239], v[108:111], v[68:71]
    ds_read_b64_tr_b16 v[230:231], v5 offset:58400
    s_mov_b32 s23, 0xc800
    buffer_load_dwordx4 v[92:95], v7, s[8:11], s23 offen offset:0 sc1
    s_waitcnt lgkmcnt(6)
    v_mfma_f32_16x16x32_bf16 v[72:75], v[240:243], v[104:107], v[72:75]
    ds_read_b64_tr_b16 v[232:233], v4 offset:57600
    v_mfma_f32_16x16x32_bf16 v[76:79], v[240:243], v[108:111], v[76:79]
    ds_read_b64_tr_b16 v[234:235], v4 offset:58624
    s_waitcnt lgkmcnt(6)
    v_mfma_f32_16x16x32_bf16 v[80:83], v[244:247], v[104:107], v[80:83]
    ds_read_b64_tr_b16 v[236:237], v5 offset:57632
    v_mfma_f32_16x16x32_bf16 v[84:87], v[244:247], v[108:111], v[84:87]
    ds_read_b64_tr_b16 v[238:239], v5 offset:58656
    s_waitcnt vmcnt(12) lgkmcnt(6)
    v_mfma_f32_16x16x32_bf16 v[24:27], v[224:227], v[112:115], v[24:27]
    ds_read_b64_tr_b16 v[240:241], v4 offset:57856
    s_waitcnt vmcnt(10)
    v_mfma_f32_16x16x32_bf16 v[28:31], v[224:227], v[116:119], v[28:31]
    ds_read_b64_tr_b16 v[242:243], v4 offset:58880
    s_waitcnt lgkmcnt(6)
    v_mfma_f32_16x16x32_bf16 v[32:35], v[228:231], v[112:115], v[32:35]
    ds_read_b64_tr_b16 v[244:245], v5 offset:57888
    v_mfma_f32_16x16x32_bf16 v[36:39], v[228:231], v[116:119], v[36:39]
    ds_read_b64_tr_b16 v[246:247], v5 offset:58912
    s_mov_b32 s23, 0x4800
    buffer_load_dwordx4 v[96:99], v7, s[8:11], s23 offen offset:1024 sc1
    s_waitcnt lgkmcnt(6)
    v_mfma_f32_16x16x32_bf16 v[40:43], v[232:235], v[112:115], v[40:43]
    ds_read_b64_tr_b16 v[224:225], v4 offset:58112
    v_mfma_f32_16x16x32_bf16 v[44:47], v[232:235], v[116:119], v[44:47]
    ds_read_b64_tr_b16 v[226:227], v4 offset:59136
    s_waitcnt lgkmcnt(6)
    v_mfma_f32_16x16x32_bf16 v[48:51], v[236:239], v[112:115], v[48:51]
    ds_read_b64_tr_b16 v[228:229], v5 offset:58144
    v_mfma_f32_16x16x32_bf16 v[52:55], v[236:239], v[116:119], v[52:55]
    ds_read_b64_tr_b16 v[230:231], v5 offset:59168
    s_waitcnt lgkmcnt(6)
    v_mfma_f32_16x16x32_bf16 v[56:59], v[240:243], v[112:115], v[56:59]
    v_mfma_f32_16x16x32_bf16 v[60:63], v[240:243], v[116:119], v[60:63]
    s_waitcnt vmcnt(10)
    s_barrier
    ds_read_b64_tr_b16 v[232:233], v4 offset:0
    ds_read_b64_tr_b16 v[234:235], v4 offset:1024
    s_waitcnt lgkmcnt(6)
    v_mfma_f32_16x16x32_bf16 v[64:67], v[244:247], v[112:115], v[64:67]
    ds_read_b64_tr_b16 v[236:237], v5 offset:32
    v_mfma_f32_16x16x32_bf16 v[68:71], v[244:247], v[116:119], v[68:71]
    s_add_u32 s22, s19, 0x500000
    s_add_u32 m0, s20, 0x8000
    s_nop 0
    buffer_load_dwordx4 v3, s[4:7], s22 offen lds
    ds_read_b64_tr_b16 v[238:239], v5 offset:1056
    s_mov_b32 s23, 0xc800
    buffer_load_dwordx4 v[100:103], v7, s[8:11], s23 offen offset:1024 sc1
    s_waitcnt lgkmcnt(6)
    v_mfma_f32_16x16x32_bf16 v[72:75], v[224:227], v[112:115], v[72:75]
    ds_read_b64_tr_b16 v[240:241], v4 offset:256
    v_mfma_f32_16x16x32_bf16 v[76:79], v[224:227], v[116:119], v[76:79]
    ds_read_b64_tr_b16 v[242:243], v4 offset:1280
    s_waitcnt lgkmcnt(6)
    v_mfma_f32_16x16x32_bf16 v[80:83], v[228:231], v[112:115], v[80:83]
    ds_read_b64_tr_b16 v[244:245], v5 offset:288
    v_mfma_f32_16x16x32_bf16 v[84:87], v[228:231], v[116:119], v[84:87]
    ds_read_b64_tr_b16 v[246:247], v5 offset:1312
    s_waitcnt vmcnt(11) lgkmcnt(6)
    v_mfma_f32_16x16x32_bf16 v[24:27], v[232:235], v[120:123], v[24:27]
    ds_read_b64_tr_b16 v[224:225], v4 offset:512
    s_waitcnt vmcnt(10)
    v_mfma_f32_16x16x32_bf16 v[28:31], v[232:235], v[124:127], v[28:31]
    ds_read_b64_tr_b16 v[226:227], v4 offset:1536
    s_waitcnt lgkmcnt(6)
    v_mfma_f32_16x16x32_bf16 v[32:35], v[236:239], v[120:123], v[32:35]
    ds_read_b64_tr_b16 v[228:229], v5 offset:544
    v_mfma_f32_16x16x32_bf16 v[36:39], v[236:239], v[124:127], v[36:39]
    s_add_u32 s22, s19, 0x508000
    s_add_u32 m0, s20, 0x8400
    s_nop 0
    buffer_load_dwordx4 v3, s[4:7], s22 offen lds
    ds_read_b64_tr_b16 v[230:231], v5 offset:1568
    s_mov_b32 s23, 0x5000
    buffer_load_dwordx4 v[104:107], v7, s[8:11], s23 offen offset:0 sc1
    s_waitcnt lgkmcnt(6)
    v_mfma_f32_16x16x32_bf16 v[40:43], v[240:243], v[120:123], v[40:43]
    ds_read_b64_tr_b16 v[232:233], v4 offset:768
    v_mfma_f32_16x16x32_bf16 v[44:47], v[240:243], v[124:127], v[44:47]
    ds_read_b64_tr_b16 v[234:235], v4 offset:1792
    s_waitcnt lgkmcnt(6)
    v_mfma_f32_16x16x32_bf16 v[48:51], v[244:247], v[120:123], v[48:51]
    ds_read_b64_tr_b16 v[236:237], v5 offset:800
    v_mfma_f32_16x16x32_bf16 v[52:55], v[244:247], v[124:127], v[52:55]
    ds_read_b64_tr_b16 v[238:239], v5 offset:1824
    s_waitcnt lgkmcnt(6)
    v_mfma_f32_16x16x32_bf16 v[56:59], v[224:227], v[120:123], v[56:59]
    ds_read_b64_tr_b16 v[240:241], v4 offset:8192
    v_mfma_f32_16x16x32_bf16 v[60:63], v[224:227], v[124:127], v[60:63]
    ds_read_b64_tr_b16 v[242:243], v4 offset:9216
    s_waitcnt lgkmcnt(6)
    v_mfma_f32_16x16x32_bf16 v[64:67], v[228:231], v[120:123], v[64:67]
    ds_read_b64_tr_b16 v[244:245], v5 offset:8224
    v_mfma_f32_16x16x32_bf16 v[68:71], v[228:231], v[124:127], v[68:71]
    ds_read_b64_tr_b16 v[246:247], v5 offset:9248
    s_mov_b32 s23, 0xd000
    buffer_load_dwordx4 v[108:111], v7, s[8:11], s23 offen offset:0 sc1
    s_waitcnt lgkmcnt(6)
    v_mfma_f32_16x16x32_bf16 v[72:75], v[232:235], v[120:123], v[72:75]
    ds_read_b64_tr_b16 v[224:225], v4 offset:8448
    v_mfma_f32_16x16x32_bf16 v[76:79], v[232:235], v[124:127], v[76:79]
    ds_read_b64_tr_b16 v[226:227], v4 offset:9472
    s_waitcnt lgkmcnt(6)
    v_mfma_f32_16x16x32_bf16 v[80:83], v[236:239], v[120:123], v[80:83]
    ds_read_b64_tr_b16 v[228:229], v5 offset:8480
    v_mfma_f32_16x16x32_bf16 v[84:87], v[236:239], v[124:127], v[84:87]
    ds_read_b64_tr_b16 v[230:231], v5 offset:9504
    s_waitcnt vmcnt(11) lgkmcnt(6)
    v_mfma_f32_16x16x32_bf16 v[24:27], v[240:243], v[128:131], v[24:27]
    ds_read_b64_tr_b16 v[232:233], v4 offset:8704
    s_waitcnt vmcnt(9)
    v_mfma_f32_16x16x32_bf16 v[28:31], v[240:243], v[132:135], v[28:31]
    ds_read_b64_tr_b16 v[234:235], v4 offset:9728
    s_waitcnt lgkmcnt(6)
    v_mfma_f32_16x16x32_bf16 v[32:35], v[244:247], v[128:131], v[32:35]
    ds_read_b64_tr_b16 v[236:237], v5 offset:8736
    v_mfma_f32_16x16x32_bf16 v[36:39], v[244:247], v[132:135], v[36:39]
    ds_read_b64_tr_b16 v[238:239], v5 offset:9760
    s_mov_b32 s23, 0x5000
    buffer_load_dwordx4 v[112:115], v7, s[8:11], s23 offen offset:1024 sc1
    s_waitcnt lgkmcnt(6)
    v_mfma_f32_16x16x32_bf16 v[40:43], v[224:227], v[128:131], v[40:43]
    ds_read_b64_tr_b16 v[240:241], v4 offset:8960
    v_mfma_f32_16x16x32_bf16 v[44:47], v[224:227], v[132:135], v[44:47]
    ds_read_b64_tr_b16 v[242:243], v4 offset:9984
    s_waitcnt lgkmcnt(6)
    v_mfma_f32_16x16x32_bf16 v[48:51], v[228:231], v[128:131], v[48:51]
    ds_read_b64_tr_b16 v[244:245], v5 offset:8992
    v_mfma_f32_16x16x32_bf16 v[52:55], v[228:231], v[132:135], v[52:55]
    ds_read_b64_tr_b16 v[246:247], v5 offset:10016
    s_waitcnt lgkmcnt(6)
    v_mfma_f32_16x16x32_bf16 v[56:59], v[232:235], v[128:131], v[56:59]
    v_mfma_f32_16x16x32_bf16 v[60:63], v[232:235], v[132:135], v[60:63]
    s_waitcnt vmcnt(9)
    s_barrier
    ds_read_b64_tr_b16 v[224:225], v4 offset:16384
    ds_read_b64_tr_b16 v[226:227], v4 offset:17408
    s_waitcnt lgkmcnt(6)
    v_mfma_f32_16x16x32_bf16 v[64:67], v[236:239], v[128:131], v[64:67]
    ds_read_b64_tr_b16 v[228:229], v5 offset:16416
    v_mfma_f32_16x16x32_bf16 v[68:71], v[236:239], v[132:135], v[68:71]
    s_add_u32 s22, s19, 0x580000
    s_add_u32 m0, s20, 0xc000
    s_nop 0
    buffer_load_dwordx4 v3, s[4:7], s22 offen lds
    ds_read_b64_tr_b16 v[230:231], v5 offset:17440
    s_mov_b32 s23, 0xd000
    buffer_load_dwordx4 v[116:119], v7, s[8:11], s23 offen offset:1024 sc1
    s_waitcnt lgkmcnt(6)
    v_mfma_f32_16x16x32_bf16 v[72:75], v[240:243], v[128:131], v[72:75]
    ds_read_b64_tr_b16 v[232:233], v4 offset:16640
    v_mfma_f32_16x16x32_bf16 v[76:79], v[240:243], v[132:135], v[76:79]
    ds_read_b64_tr_b16 v[234:235], v4 offset:17664
    s_waitcnt lgkmcnt(6)
    v_mfma_f32_16x16x32_bf16 v[80:83], v[244:247], v[128:131], v[80:83]
    ds_read_b64_tr_b16 v[236:237], v5 offset:16672
    v_mfma_f32_16x16x32_bf16 v[84:87], v[244:247], v[132:135], v[84:87]
    ds_read_b64_tr_b16 v[238:239], v5 offset:17696
    s_waitcnt vmcnt(10) lgkmcnt(6)
    v_mfma_f32_16x16x32_bf16 v[24:27], v[224:227], v[88:91], v[24:27]
    ds_read_b64_tr_b16 v[240:241], v4 offset:16896
    s_waitcnt vmcnt(9)
    v_mfma_f32_16x16x32_bf16 v[28:31], v[224:227], v[92:95], v[28:31]
    ds_read_b64_tr_b16 v[242:243], v4 offset:17920
    s_waitcnt lgkmcnt(6)
    v_mfma_f32_16x16x32_bf16 v[32:35], v[228:231], v[88:91], v[32:35]
    ds_read_b64_tr_b16 v[244:245], v5 offset:16928
    v_mfma_f32_16x16x32_bf16 v[36:39], v[228:231], v[92:95], v[36:39]
    s_add_u32 s22, s19, 0x588000
    s_add_u32 m0, s20, 0xc400
    s_nop 0
    buffer_load_dwordx4 v3, s[4:7], s22 offen lds
    ds_read_b64_tr_b16 v[246:247], v5 offset:17952
    s_mov_b32 s23, 0x5800
    buffer_load_dwordx4 v[120:123], v7, s[8:11], s23 offen offset:0 sc1
    s_waitcnt lgkmcnt(6)
    v_mfma_f32_16x16x32_bf16 v[40:43], v[232:235], v[88:91], v[40:43]
    ds_read_b64_tr_b16 v[224:225], v4 offset:17152
    v_mfma_f32_16x16x32_bf16 v[44:47], v[232:235], v[92:95], v[44:47]
    ds_read_b64_tr_b16 v[226:227], v4 offset:18176
    s_waitcnt lgkmcnt(6)
    v_mfma_f32_16x16x32_bf16 v[48:51], v[236:239], v[88:91], v[48:51]
    ds_read_b64_tr_b16 v[228:229], v5 offset:17184
    v_mfma_f32_16x16x32_bf16 v[52:55], v[236:239], v[92:95], v[52:55]
    ds_read_b64_tr_b16 v[230:231], v5 offset:18208
    s_waitcnt lgkmcnt(6)
    v_mfma_f32_16x16x32_bf16 v[56:59], v[240:243], v[88:91], v[56:59]
    ds_read_b64_tr_b16 v[232:233], v4 offset:24576
    v_mfma_f32_16x16x32_bf16 v[60:63], v[240:243], v[92:95], v[60:63]
    ds_read_b64_tr_b16 v[234:235], v4 offset:25600
    s_waitcnt lgkmcnt(6)
    v_mfma_f32_16x16x32_bf16 v[64:67], v[244:247], v[88:91], v[64:67]
    ds_read_b64_tr_b16 v[236:237], v5 offset:24608
    v_mfma_f32_16x16x32_bf16 v[68:71], v[244:247], v[92:95], v[68:71]
    ds_read_b64_tr_b16 v[238:239], v5 offset:25632
    s_mov_b32 s23, 0xd800
    buffer_load_dwordx4 v[124:127], v7, s[8:11], s23 offen offset:0 sc1
    s_waitcnt lgkmcnt(6)
    v_mfma_f32_16x16x32_bf16 v[72:75], v[224:227], v[88:91], v[72:75]
    ds_read_b64_tr_b16 v[240:241], v4 offset:24832
    v_xor_b32 v8, s28, v12
    v_xor_b32 v20, s28, v13
    v_or_b32 v8, v8, v20
    v_xor_b32 v20, s28, v14
    v_or_b32 v8, v8, v20
    v_xor_b32 v20, s28, v15
    v_or_b32 v8, v8, v20
    v_cmp_ne_u32 vcc, 0, v8
    s_cbranch_vccnz adaLN_cond__sliding_block_cached__moe_arch_mod__prompt_kernel_kv16r
adaLN_cond__sliding_block_cached__moe_arch_mod__prompt_kernel_kv16b:
    v_mfma_f32_16x16x32_bf16 v[76:79], v[224:227], v[92:95], v[76:79]
    ds_read_b64_tr_b16 v[242:243], v4 offset:25856
    s_waitcnt lgkmcnt(6)
    v_mfma_f32_16x16x32_bf16 v[80:83], v[228:231], v[88:91], v[80:83]
    ds_read_b64_tr_b16 v[244:245], v5 offset:24864
    v_mfma_f32_16x16x32_bf16 v[84:87], v[228:231], v[92:95], v[84:87]
    ds_read_b64_tr_b16 v[246:247], v5 offset:25888
    s_waitcnt vmcnt(11) lgkmcnt(6)
    v_mfma_f32_16x16x32_bf16 v[24:27], v[232:235], v[96:99], v[24:27]
    ds_read_b64_tr_b16 v[224:225], v4 offset:25088
    s_waitcnt vmcnt(9)
    v_mfma_f32_16x16x32_bf16 v[28:31], v[232:235], v[100:103], v[28:31]
    ds_read_b64_tr_b16 v[226:227], v4 offset:26112
    s_waitcnt lgkmcnt(6)
    v_mfma_f32_16x16x32_bf16 v[32:35], v[236:239], v[96:99], v[32:35]
    ds_read_b64_tr_b16 v[228:229], v5 offset:25120
    v_mfma_f32_16x16x32_bf16 v[36:39], v[236:239], v[100:103], v[36:39]
    ds_read_b64_tr_b16 v[230:231], v5 offset:26144
    s_mov_b32 s23, 0x5800
    buffer_load_dwordx4 v[128:131], v7, s[8:11], s23 offen offset:1024 sc1
    s_waitcnt lgkmcnt(6)
    v_mfma_f32_16x16x32_bf16 v[40:43], v[240:243], v[96:99], v[40:43]
    ds_read_b64_tr_b16 v[232:233], v4 offset:25344
    v_mfma_f32_16x16x32_bf16 v[44:47], v[240:243], v[100:103], v[44:47]
    ds_read_b64_tr_b16 v[234:235], v4 offset:26368
    s_waitcnt lgkmcnt(6)
    v_mfma_f32_16x16x32_bf16 v[48:51], v[244:247], v[96:99], v[48:51]
    ds_read_b64_tr_b16 v[236:237], v5 offset:25376
    v_mfma_f32_16x16x32_bf16 v[52:55], v[244:247], v[100:103], v[52:55]
    ds_read_b64_tr_b16 v[238:239], v5 offset:26400
    s_waitcnt lgkmcnt(6)
    v_mfma_f32_16x16x32_bf16 v[56:59], v[224:227], v[96:99], v[56:59]
    v_mfma_f32_16x16x32_bf16 v[60:63], v[224:227], v[100:103], v[60:63]
    s_waitcnt vmcnt(9)
    s_barrier
    ds_read_b64_tr_b16 v[240:241], v4 offset:32768
    ds_read_b64_tr_b16 v[242:243], v4 offset:33792
    s_waitcnt lgkmcnt(6)
    v_mfma_f32_16x16x32_bf16 v[64:67], v[228:231], v[96:99], v[64:67]
    ds_read_b64_tr_b16 v[244:245], v5 offset:32800
    v_mfma_f32_16x16x32_bf16 v[68:71], v[228:231], v[100:103], v[68:71]
    s_add_u32 s22, s19, 0x600000
    s_add_u32 m0, s20, 0x0
    s_nop 0
    buffer_load_dwordx4 v3, s[4:7], s22 offen lds
    ds_read_b64_tr_b16 v[246:247], v5 offset:33824
    s_mov_b32 s23, 0xd800
    buffer_load_dwordx4 v[132:135], v7, s[8:11], s23 offen offset:1024 sc1
    s_waitcnt lgkmcnt(6)
    v_mfma_f32_16x16x32_bf16 v[72:75], v[232:235], v[96:99], v[72:75]
    ds_read_b64_tr_b16 v[224:225], v4 offset:33024
    v_mfma_f32_16x16x32_bf16 v[76:79], v[232:235], v[100:103], v[76:79]
    ds_read_b64_tr_b16 v[226:227], v4 offset:34048
    s_waitcnt lgkmcnt(6)
    v_mfma_f32_16x16x32_bf16 v[80:83], v[236:239], v[96:99], v[80:83]
    ds_read_b64_tr_b16 v[228:229], v5 offset:33056
    v_mfma_f32_16x16x32_bf16 v[84:87], v[236:239], v[100:103], v[84:87]
    ds_read_b64_tr_b16 v[230:231], v5 offset:34080
    s_waitcnt vmcnt(10) lgkmcnt(6)
    v_mfma_f32_16x16x32_bf16 v[24:27], v[240:243], v[104:107], v[24:27]
    ds_read_b64_tr_b16 v[232:233], v4 offset:33280
    s_waitcnt vmcnt(9)
    v_mfma_f32_16x16x32_bf16 v[28:31], v[240:243], v[108:111], v[28:31]
    ds_read_b64_tr_b16 v[234:235], v4 offset:34304
    s_waitcnt lgkmcnt(6)
    v_mfma_f32_16x16x32_bf16 v[32:35], v[244:247], v[104:107], v[32:35]
    ds_read_b64_tr_b16 v[236:237], v5 offset:33312
    v_mfma_f32_16x16x32_bf16 v[36:39], v[244:247], v[108:111], v[36:39]
    s_add_u32 s22, s19, 0x608000
    s_add_u32 m0, s20, 0x400
    s_nop 0
    buffer_load_dwordx4 v3, s[4:7], s22 offen lds
    ds_read_b64_tr_b16 v[238:239], v5 offset:34336
    s_mov_b32 s23, 0x6000
    buffer_load_dwordx4 v[88:91], v7, s[8:11], s23 offen offset:0 sc1
    s_waitcnt lgkmcnt(6)
    v_mfma_f32_16x16x32_bf16 v[40:43], v[224:227], v[104:107], v[40:43]
    ds_read_b64_tr_b16 v[240:241], v4 offset:33536
    v_mfma_f32_16x16x32_bf16 v[44:47], v[224:227], v[108:111], v[44:47]
    ds_read_b64_tr_b16 v[242:243], v4 offset:34560
    s_waitcnt lgkmcnt(6)
    v_mfma_f32_16x16x32_bf16 v[48:51], v[228:231], v[104:107], v[48:51]
    ds_read_b64_tr_b16 v[244:245], v5 offset:33568
    v_mfma_f32_16x16x32_bf16 v[52:55], v[228:231], v[108:111], v[52:55]
    ds_read_b64_tr_b16 v[246:247], v5 offset:34592
    s_waitcnt lgkmcnt(6)
    v_mfma_f32_16x16x32_bf16 v[56:59], v[232:235], v[104:107], v[56:59]
    ds_read_b64_tr_b16 v[224:225], v4 offset:40960
    v_mfma_f32_16x16x32_bf16 v[60:63], v[232:235], v[108:111], v[60:63]
    ds_read_b64_tr_b16 v[226:227], v4 offset:41984
    s_waitcnt lgkmcnt(6)
    v_mfma_f32_16x16x32_bf16 v[64:67], v[236:239], v[104:107], v[64:67]
    ds_read_b64_tr_b16 v[228:229], v5 offset:40992
    v_mfma_f32_16x16x32_bf16 v[68:71], v[236:239], v[108:111], v[68:71]
    ds_read_b64_tr_b16 v[230:231], v5 offset:42016
    s_mov_b32 s23, 0xe000
    buffer_load_dwordx4 v[92:95], v7, s[8:11], s23 offen offset:0 sc1
    s_waitcnt lgkmcnt(6)
    v_mfma_f32_16x16x32_bf16 v[72:75], v[240:243], v[104:107], v[72:75]
    ds_read_b64_tr_b16 v[232:233], v4 offset:41216
    v_mfma_f32_16x16x32_bf16 v[76:79], v[240:243], v[108:111], v[76:79]
    ds_read_b64_tr_b16 v[234:235], v4 offset:42240
    s_waitcnt lgkmcnt(6)
    v_mfma_f32_16x16x32_bf16 v[80:83], v[244:247], v[104:107], v[80:83]
    ds_read_b64_tr_b16 v[236:237], v5 offset:41248
    v_mfma_f32_16x16x32_bf16 v[84:87], v[244:247], v[108:111], v[84:87]
    ds_read_b64_tr_b16 v[238:239], v5 offset:42272
    s_waitcnt vmcnt(11) lgkmcnt(6)
    v_mfma_f32_16x16x32_bf16 v[24:27], v[224:227], v[112:115], v[24:27]
    ds_read_b64_tr_b16 v[240:241], v4 offset:41472
    s_add_u32 s22, s21, 0x0
    s_add_u32 m0, s20, 0x10000
    s_nop 0
    buffer_load_dwordx4 v2, s[8:11], s22 offen sc1 lds
    s_waitcnt vmcnt(10)
    v_mfma_f32_16x16x32_bf16 v[28:31], v[224:227], v[116:119], v[28:31]
    ds_read_b64_tr_b16 v[242:243], v4 offset:42496
    s_waitcnt lgkmcnt(6)
    v_mfma_f32_16x16x32_bf16 v[32:35], v[228:231], v[112:115], v[32:35]
    ds_read_b64_tr_b16 v[244:245], v5 offset:41504
    v_mfma_f32_16x16x32_bf16 v[36:39], v[228:231], v[116:119], v[36:39]
    ds_read_b64_tr_b16 v[246:247], v5 offset:42528
    s_mov_b32 s23, 0x6000
    buffer_load_dwordx4 v[96:99], v7, s[8:11], s23 offen offset:1024 sc1
    s_waitcnt lgkmcnt(6)
    v_mfma_f32_16x16x32_bf16 v[40:43], v[232:235], v[112:115], v[40:43]
    ds_read_b64_tr_b16 v[224:225], v4 offset:41728
    s_add_u32 s22, s21, 0x400
    s_add_u32 m0, s20, 0x10400
    s_nop 0
    buffer_load_dwordx4 v2, s[8:11], s22 offen sc1 lds
    v_mfma_f32_16x16x32_bf16 v[44:47], v[232:235], v[116:119], v[44:47]
    ds_read_b64_tr_b16 v[226:227], v4 offset:42752
    s_waitcnt lgkmcnt(6)
    v_mfma_f32_16x16x32_bf16 v[48:51], v[236:239], v[112:115], v[48:51]
    ds_read_b64_tr_b16 v[228:229], v5 offset:41760
    v_mfma_f32_16x16x32_bf16 v[52:55], v[236:239], v[116:119], v[52:55]
    ds_read_b64_tr_b16 v[230:231], v5 offset:42784
    s_waitcnt lgkmcnt(6)
    v_mfma_f32_16x16x32_bf16 v[56:59], v[240:243], v[112:115], v[56:59]
    v_mfma_f32_16x16x32_bf16 v[60:63], v[240:243], v[116:119], v[60:63]
    s_waitcnt vmcnt(11)
    s_barrier
    ds_read_b64_tr_b16 v[232:233], v4 offset:49152
    ds_read_b64_tr_b16 v[234:235], v4 offset:50176
    s_waitcnt lgkmcnt(6)
    v_mfma_f32_16x16x32_bf16 v[64:67], v[244:247], v[112:115], v[64:67]
    ds_read_b64_tr_b16 v[236:237], v5 offset:49184
    v_mfma_f32_16x16x32_bf16 v[68:71], v[244:247], v[116:119], v[68:71]
    s_add_u32 s22, s19, 0x680000
    s_add_u32 m0, s20, 0x4000
    s_nop 0
    buffer_load_dwordx4 v3, s[4:7], s22 offen lds
    ds_read_b64_tr_b16 v[238:239], v5 offset:50208
    s_mov_b32 s23, 0xe000
    buffer_load_dwordx4 v[100:103], v7, s[8:11], s23 offen offset:1024 sc1
    s_waitcnt lgkmcnt(6)
    v_mfma_f32_16x16x32_bf16 v[72:75], v[224:227], v[112:115], v[72:75]
    ds_read_b64_tr_b16 v[240:241], v4 offset:49408
    v_mfma_f32_16x16x32_bf16 v[76:79], v[224:227], v[116:119], v[76:79]
    ds_read_b64_tr_b16 v[242:243], v4 offset:50432
    s_waitcnt lgkmcnt(6)
    v_mfma_f32_16x16x32_bf16 v[80:83], v[228:231], v[112:115], v[80:83]
    ds_read_b64_tr_b16 v[244:245], v5 offset:49440
    v_mfma_f32_16x16x32_bf16 v[84:87], v[228:231], v[116:119], v[84:87]
    ds_read_b64_tr_b16 v[246:247], v5 offset:50464
    s_waitcnt vmcnt(12) lgkmcnt(6)
    v_mfma_f32_16x16x32_bf16 v[24:27], v[232:235], v[120:123], v[24:27]
    ds_read_b64_tr_b16 v[224:225], v4 offset:49664
    s_waitcnt vmcnt(11)
    v_mfma_f32_16x16x32_bf16 v[28:31], v[232:235], v[124:127], v[28:31]
    ds_read_b64_tr_b16 v[226:227], v4 offset:50688
    s_waitcnt lgkmcnt(6)
    v_mfma_f32_16x16x32_bf16 v[32:35], v[236:239], v[120:123], v[32:35]
    ds_read_b64_tr_b16 v[228:229], v5 offset:49696
    v_mfma_f32_16x16x32_bf16 v[36:39], v[236:239], v[124:127], v[36:39]
    s_add_u32 s22, s19, 0x688000
    s_add_u32 m0, s20, 0x4400
    s_nop 0
    buffer_load_dwordx4 v3, s[4:7], s22 offen lds
    ds_read_b64_tr_b16 v[230:231], v5 offset:50720
    s_mov_b32 s23, 0x6800
    buffer_load_dwordx4 v[104:107], v7, s[8:11], s23 offen offset:0 sc1
    s_waitcnt lgkmcnt(6)
    v_mfma_f32_16x16x32_bf16 v[40:43], v[240:243], v[120:123], v[40:43]
    ds_read_b64_tr_b16 v[232:233], v4 offset:49920
    v_mfma_f32_16x16x32_bf16 v[44:47], v[240:243], v[124:127], v[44:47]
    ds_read_b64_tr_b16 v[234:235], v4 offset:50944
    s_waitcnt lgkmcnt(6)
    v_mfma_f32_16x16x32_bf16 v[48:51], v[244:247], v[120:123], v[48:51]
    ds_read_b64_tr_b16 v[236:237], v5 offset:49952
    v_mfma_f32_16x16x32_bf16 v[52:55], v[244:247], v[124:127], v[52:55]
    ds_read_b64_tr_b16 v[238:239], v5 offset:50976
    s_waitcnt lgkmcnt(6)
    v_mfma_f32_16x16x32_bf16 v[56:59], v[224:227], v[120:123], v[56:59]
    ds_read_b64_tr_b16 v[240:241], v4 offset:57344
    v_mfma_f32_16x16x32_bf16 v[60:63], v[224:227], v[124:127], v[60:63]
    ds_read_b64_tr_b16 v[242:243], v4 offset:58368
    s_waitcnt lgkmcnt(6)
    v_mfma_f32_16x16x32_bf16 v[64:67], v[228:231], v[120:123], v[64:67]
    ds_read_b64_tr_b16 v[244:245], v5 offset:57376
    v_mfma_f32_16x16x32_bf16 v[68:71], v[228:231], v[124:127], v[68:71]
    ds_read_b64_tr_b16 v[246:247], v5 offset:58400
    s_mov_b32 s23, 0xe800
    buffer_load_dwordx4 v[108:111], v7, s[8:11], s23 offen offset:0 sc1
    s_waitcnt lgkmcnt(6)
    v_mfma_f32_16x16x32_bf16 v[72:75], v[232:235], v[120:123], v[72:75]
    ds_read_b64_tr_b16 v[224:225], v4 offset:57600
    v_mfma_f32_16x16x32_bf16 v[76:79], v[232:235], v[124:127], v[76:79]
    ds_read_b64_tr_b16 v[226:227], v4 offset:58624
    s_waitcnt lgkmcnt(6)
    v_mfma_f32_16x16x32_bf16 v[80:83], v[236:239], v[120:123], v[80:83]
    ds_read_b64_tr_b16 v[228:229], v5 offset:57632
    v_mfma_f32_16x16x32_bf16 v[84:87], v[236:239], v[124:127], v[84:87]
    ds_read_b64_tr_b16 v[230:231], v5 offset:58656
    s_waitcnt vmcnt(13) lgkmcnt(6)
    v_mfma_f32_16x16x32_bf16 v[24:27], v[240:243], v[128:131], v[24:27]
    ds_read_b64_tr_b16 v[232:233], v4 offset:57856
    s_add_u32 s22, s21, 0x4000
    s_add_u32 m0, s20, 0x14000
    s_nop 0
    buffer_load_dwordx4 v2, s[8:11], s22 offen sc1 lds
    s_waitcnt vmcnt(12)
    v_mfma_f32_16x16x32_bf16 v[28:31], v[240:243], v[132:135], v[28:31]
    ds_read_b64_tr_b16 v[234:235], v4 offset:58880
    s_waitcnt lgkmcnt(6)
    v_mfma_f32_16x16x32_bf16 v[32:35], v[244:247], v[128:131], v[32:35]
    ds_read_b64_tr_b16 v[236:237], v5 offset:57888
    v_mfma_f32_16x16x32_bf16 v[36:39], v[244:247], v[132:135], v[36:39]
    ds_read_b64_tr_b16 v[238:239], v5 offset:58912
    s_mov_b32 s23, 0x6800
    buffer_load_dwordx4 v[112:115], v7, s[8:11], s23 offen offset:1024 sc1
    s_waitcnt lgkmcnt(6)
    v_mfma_f32_16x16x32_bf16 v[40:43], v[224:227], v[128:131], v[40:43]
    ds_read_b64_tr_b16 v[240:241], v4 offset:58112
    s_add_u32 s22, s21, 0x4400
    s_add_u32 m0, s20, 0x14400
    s_nop 0
    buffer_load_dwordx4 v2, s[8:11], s22 offen sc1 lds
    v_mfma_f32_16x16x32_bf16 v[44:47], v[224:227], v[132:135], v[44:47]
    ds_read_b64_tr_b16 v[242:243], v4 offset:59136
    s_waitcnt lgkmcnt(6)
    v_mfma_f32_16x16x32_bf16 v[48:51], v[228:231], v[128:131], v[48:51]
    ds_read_b64_tr_b16 v[244:245], v5 offset:58144
    v_mfma_f32_16x16x32_bf16 v[52:55], v[228:231], v[132:135], v[52:55]
    ds_read_b64_tr_b16 v[246:247], v5 offset:59168
    s_waitcnt lgkmcnt(6)
    v_mfma_f32_16x16x32_bf16 v[56:59], v[232:235], v[128:131], v[56:59]
    v_mfma_f32_16x16x32_bf16 v[60:63], v[232:235], v[132:135], v[60:63]
    s_waitcnt vmcnt(13)
    s_barrier
    ds_read_b64_tr_b16 v[224:225], v4 offset:0
    ds_read_b64_tr_b16 v[226:227], v4 offset:1024
    s_waitcnt lgkmcnt(6)
    v_mfma_f32_16x16x32_bf16 v[64:67], v[236:239], v[128:131], v[64:67]
    ds_read_b64_tr_b16 v[228:229], v5 offset:32
    v_mfma_f32_16x16x32_bf16 v[68:71], v[236:239], v[132:135], v[68:71]
    s_add_u32 s22, s19, 0x700000
    s_add_u32 m0, s20, 0x8000
    s_nop 0
    buffer_load_dwordx4 v3, s[4:7], s22 offen lds
    ds_read_b64_tr_b16 v[230:231], v5 offset:1056
    s_mov_b32 s23, 0xe800
    buffer_load_dwordx4 v[116:119], v7, s[8:11], s23 offen offset:1024 sc1
    s_waitcnt lgkmcnt(6)
    v_mfma_f32_16x16x32_bf16 v[72:75], v[240:243], v[128:131], v[72:75]
    ds_read_b64_tr_b16 v[232:233], v4 offset:256
    v_mfma_f32_16x16x32_bf16 v[76:79], v[240:243], v[132:135], v[76:79]
    ds_read_b64_tr_b16 v[234:235], v4 offset:1280
    s_waitcnt lgkmcnt(6)
    v_mfma_f32_16x16x32_bf16 v[80:83], v[244:247], v[128:131], v[80:83]
    ds_read_b64_tr_b16 v[236:237], v5 offset:288
    v_mfma_f32_16x16x32_bf16 v[84:87], v[244:247], v[132:135], v[84:87]
    ds_read_b64_tr_b16 v[238:239], v5 offset:1312
    s_waitcnt vmcnt(14) lgkmcnt(6)
    v_mfma_f32_16x16x32_bf16 v[24:27], v[224:227], v[88:91], v[24:27]
    ds_read_b64_tr_b16 v[240:241], v4 offset:512
    s_waitcnt vmcnt(13)
    v_mfma_f32_16x16x32_bf16 v[28:31], v[224:227], v[92:95], v[28:31]
    ds_read_b64_tr_b16 v[242:243], v4 offset:1536
    s_waitcnt lgkmcnt(6)
    v_mfma_f32_16x16x32_bf16 v[32:35], v[228:231], v[88:91], v[32:35]
    ds_read_b64_tr_b16 v[244:245], v5 offset:544
    v_mfma_f32_16x16x32_bf16 v[36:39], v[228:231], v[92:95], v[36:39]
    s_add_u32 s22, s19, 0x708000
    s_add_u32 m0, s20, 0x8400
    s_nop 0
    buffer_load_dwordx4 v3, s[4:7], s22 offen lds
    ds_read_b64_tr_b16 v[246:247], v5 offset:1568
    s_mov_b32 s23, 0x7000
    buffer_load_dwordx4 v[120:123], v7, s[8:11], s23 offen offset:0 sc1
    s_waitcnt lgkmcnt(6)
    v_mfma_f32_16x16x32_bf16 v[40:43], v[232:235], v[88:91], v[40:43]
    ds_read_b64_tr_b16 v[224:225], v4 offset:768
    v_mfma_f32_16x16x32_bf16 v[44:47], v[232:235], v[92:95], v[44:47]
    ds_read_b64_tr_b16 v[226:227], v4 offset:1792
    s_waitcnt lgkmcnt(6)
    v_mfma_f32_16x16x32_bf16 v[48:51], v[236:239], v[88:91], v[48:51]
    ds_read_b64_tr_b16 v[228:229], v5 offset:800
    v_mfma_f32_16x16x32_bf16 v[52:55], v[236:239], v[92:95], v[52:55]
    ds_read_b64_tr_b16 v[230:231], v5 offset:1824
    s_waitcnt lgkmcnt(6)
    v_mfma_f32_16x16x32_bf16 v[56:59], v[240:243], v[88:91], v[56:59]
    ds_read_b64_tr_b16 v[232:233], v4 offset:8192
    v_mfma_f32_16x16x32_bf16 v[60:63], v[240:243], v[92:95], v[60:63]
    ds_read_b64_tr_b16 v[234:235], v4 offset:9216
    s_waitcnt lgkmcnt(6)
    v_mfma_f32_16x16x32_bf16 v[64:67], v[244:247], v[88:91], v[64:67]
    ds_read_b64_tr_b16 v[236:237], v5 offset:8224
    v_mfma_f32_16x16x32_bf16 v[68:71], v[244:247], v[92:95], v[68:71]
    ds_read_b64_tr_b16 v[238:239], v5 offset:9248
    s_mov_b32 s23, 0xf000
    buffer_load_dwordx4 v[124:127], v7, s[8:11], s23 offen offset:0 sc1
    s_waitcnt lgkmcnt(6)
    v_mfma_f32_16x16x32_bf16 v[72:75], v[224:227], v[88:91], v[72:75]
    ds_read_b64_tr_b16 v[240:241], v4 offset:8448
    v_mfma_f32_16x16x32_bf16 v[76:79], v[224:227], v[92:95], v[76:79]
    ds_read_b64_tr_b16 v[242:243], v4 offset:9472
    s_waitcnt lgkmcnt(6)
    v_mfma_f32_16x16x32_bf16 v[80:83], v[228:231], v[88:91], v[80:83]
    ds_read_b64_tr_b16 v[244:245], v5 offset:8480
    v_mfma_f32_16x16x32_bf16 v[84:87], v[228:231], v[92:95], v[84:87]
    ds_read_b64_tr_b16 v[246:247], v5 offset:9504
    s_waitcnt vmcnt(14) lgkmcnt(6)
    v_mfma_f32_16x16x32_bf16 v[24:27], v[232:235], v[96:99], v[24:27]
    ds_read_b64_tr_b16 v[224:225], v4 offset:8704
    s_add_u32 s22, s21, 0x8000
    s_add_u32 m0, s20, 0x18000
    s_nop 0
    buffer_load_dwordx4 v2, s[8:11], s22 offen sc1 lds
    s_waitcnt vmcnt(12)
    v_mfma_f32_16x16x32_bf16 v[28:31], v[232:235], v[100:103], v[28:31]
    ds_read_b64_tr_b16 v[226:227], v4 offset:9728
    s_waitcnt lgkmcnt(6)
    v_mfma_f32_16x16x32_bf16 v[32:35], v[236:239], v[96:99], v[32:35]
    ds_read_b64_tr_b16 v[228:229], v5 offset:8736
    v_mfma_f32_16x16x32_bf16 v[36:39], v[236:239], v[100:103], v[36:39]
    ds_read_b64_tr_b16 v[230:231], v5 offset:9760
    s_mov_b32 s23, 0x7000
    buffer_load_dwordx4 v[128:131], v7, s[8:11], s23 offen offset:1024 sc1
    s_waitcnt lgkmcnt(6)
    v_mfma_f32_16x16x32_bf16 v[40:43], v[240:243], v[96:99], v[40:43]
    ds_read_b64_tr_b16 v[232:233], v4 offset:8960
    s_add_u32 s22, s21, 0x8400
    s_add_u32 m0, s20, 0x18400
    s_nop 0
    buffer_load_dwordx4 v2, s[8:11], s22 offen sc1 lds
    v_mfma_f32_16x16x32_bf16 v[44:47], v[240:243], v[100:103], v[44:47]
    ds_read_b64_tr_b16 v[234:235], v4 offset:9984
    s_waitcnt lgkmcnt(6)
    v_mfma_f32_16x16x32_bf16 v[48:51], v[244:247], v[96:99], v[48:51]
    ds_read_b64_tr_b16 v[236:237], v5 offset:8992
    v_mfma_f32_16x16x32_bf16 v[52:55], v[244:247], v[100:103], v[52:55]
    ds_read_b64_tr_b16 v[238:239], v5 offset:10016
    s_waitcnt lgkmcnt(6)
    v_mfma_f32_16x16x32_bf16 v[56:59], v[224:227], v[96:99], v[56:59]
    v_mfma_f32_16x16x32_bf16 v[60:63], v[224:227], v[100:103], v[60:63]
    s_waitcnt vmcnt(13)
    s_barrier
    ds_read_b64_tr_b16 v[240:241], v4 offset:16384
    ds_read_b64_tr_b16 v[242:243], v4 offset:17408
    s_waitcnt lgkmcnt(6)
    v_mfma_f32_16x16x32_bf16 v[64:67], v[228:231], v[96:99], v[64:67]
    ds_read_b64_tr_b16 v[244:245], v5 offset:16416
    v_mfma_f32_16x16x32_bf16 v[68:71], v[228:231], v[100:103], v[68:71]
    s_add_u32 s22, s19, 0x780000
    s_add_u32 m0, s20, 0xc000
    s_nop 0
    buffer_load_dwordx4 v3, s[4:7], s22 offen lds
    ds_read_b64_tr_b16 v[246:247], v5 offset:17440
    s_mov_b32 s23, 0xf000
    buffer_load_dwordx4 v[132:135], v7, s[8:11], s23 offen offset:1024 sc1
    s_waitcnt lgkmcnt(6)
    v_mfma_f32_16x16x32_bf16 v[72:75], v[232:235], v[96:99], v[72:75]
    ds_read_b64_tr_b16 v[224:225], v4 offset:16640
    v_mfma_f32_16x16x32_bf16 v[76:79], v[232:235], v[100:103], v[76:79]
    ds_read_b64_tr_b16 v[226:227], v4 offset:17664
    s_waitcnt lgkmcnt(6)
    v_mfma_f32_16x16x32_bf16 v[80:83], v[236:239], v[96:99], v[80:83]
    ds_read_b64_tr_b16 v[228:229], v5 offset:16672
    v_mfma_f32_16x16x32_bf16 v[84:87], v[236:239], v[100:103], v[84:87]
    ds_read_b64_tr_b16 v[230:231], v5 offset:17696
    s_waitcnt vmcnt(14) lgkmcnt(6)
    v_mfma_f32_16x16x32_bf16 v[24:27], v[240:243], v[104:107], v[24:27]
    ds_read_b64_tr_b16 v[232:233], v4 offset:16896
    s_waitcnt vmcnt(13)
    v_mfma_f32_16x16x32_bf16 v[28:31], v[240:243], v[108:111], v[28:31]
    ds_read_b64_tr_b16 v[234:235], v4 offset:17920
    s_waitcnt lgkmcnt(6)
    v_mfma_f32_16x16x32_bf16 v[32:35], v[244:247], v[104:107], v[32:35]
    ds_read_b64_tr_b16 v[236:237], v5 offset:16928
    v_mfma_f32_16x16x32_bf16 v[36:39], v[244:247], v[108:111], v[36:39]
    s_add_u32 s22, s19, 0x788000
    s_add_u32 m0, s20, 0xc400
    s_nop 0
    buffer_load_dwordx4 v3, s[4:7], s22 offen lds
    ds_read_b64_tr_b16 v[238:239], v5 offset:17952
    s_mov_b32 s23, 0x7800
    buffer_load_dwordx4 v[88:91], v7, s[8:11], s23 offen offset:0 sc1
    s_waitcnt lgkmcnt(6)
    v_mfma_f32_16x16x32_bf16 v[40:43], v[224:227], v[104:107], v[40:43]
    ds_read_b64_tr_b16 v[240:241], v4 offset:17152
    v_mfma_f32_16x16x32_bf16 v[44:47], v[224:227], v[108:111], v[44:47]
    ds_read_b64_tr_b16 v[242:243], v4 offset:18176
    s_waitcnt lgkmcnt(6)
    v_mfma_f32_16x16x32_bf16 v[48:51], v[228:231], v[104:107], v[48:51]
    ds_read_b64_tr_b16 v[244:245], v5 offset:17184
    v_mfma_f32_16x16x32_bf16 v[52:55], v[228:231], v[108:111], v[52:55]
    ds_read_b64_tr_b16 v[246:247], v5 offset:18208
    s_waitcnt lgkmcnt(6)
    v_mfma_f32_16x16x32_bf16 v[56:59], v[232:235], v[104:107], v[56:59]
    ds_read_b64_tr_b16 v[224:225], v4 offset:24576
    v_mfma_f32_16x16x32_bf16 v[60:63], v[232:235], v[108:111], v[60:63]
    ds_read_b64_tr_b16 v[226:227], v4 offset:25600
    s_waitcnt lgkmcnt(6)
    v_mfma_f32_16x16x32_bf16 v[64:67], v[236:239], v[104:107], v[64:67]
    ds_read_b64_tr_b16 v[228:229], v5 offset:24608
    v_mfma_f32_16x16x32_bf16 v[68:71], v[236:239], v[108:111], v[68:71]
    ds_read_b64_tr_b16 v[230:231], v5 offset:25632
    s_mov_b32 s23, 0xf800
    buffer_load_dwordx4 v[92:95], v7, s[8:11], s23 offen offset:0 sc1
    s_waitcnt lgkmcnt(6)
    v_mfma_f32_16x16x32_bf16 v[72:75], v[240:243], v[104:107], v[72:75]
    ds_read_b64_tr_b16 v[232:233], v4 offset:24832
    v_mfma_f32_16x16x32_bf16 v[76:79], v[240:243], v[108:111], v[76:79]
    ds_read_b64_tr_b16 v[234:235], v4 offset:25856
    s_waitcnt lgkmcnt(6)
    v_mfma_f32_16x16x32_bf16 v[80:83], v[244:247], v[104:107], v[80:83]
    ds_read_b64_tr_b16 v[236:237], v5 offset:24864
    v_mfma_f32_16x16x32_bf16 v[84:87], v[244:247], v[108:111], v[84:87]
    ds_read_b64_tr_b16 v[238:239], v5 offset:25888
    s_waitcnt vmcnt(14) lgkmcnt(6)
    v_mfma_f32_16x16x32_bf16 v[24:27], v[224:227], v[112:115], v[24:27]
    ds_read_b64_tr_b16 v[240:241], v4 offset:25088
    s_add_u32 s22, s21, 0xc000
    s_add_u32 m0, s20, 0x1c000
    s_nop 0
    buffer_load_dwordx4 v2, s[8:11], s22 offen sc1 lds
    s_waitcnt vmcnt(12)
    v_mfma_f32_16x16x32_bf16 v[28:31], v[224:227], v[116:119], v[28:31]
    ds_read_b64_tr_b16 v[242:243], v4 offset:26112
    s_waitcnt lgkmcnt(6)
    v_mfma_f32_16x16x32_bf16 v[32:35], v[228:231], v[112:115], v[32:35]
    ds_read_b64_tr_b16 v[244:245], v5 offset:25120
    v_mfma_f32_16x16x32_bf16 v[36:39], v[228:231], v[116:119], v[36:39]
    ds_read_b64_tr_b16 v[246:247], v5 offset:26144
    s_mov_b32 s23, 0x7800
    buffer_load_dwordx4 v[96:99], v7, s[8:11], s23 offen offset:1024 sc1
    s_waitcnt lgkmcnt(6)
    v_mfma_f32_16x16x32_bf16 v[40:43], v[232:235], v[112:115], v[40:43]
    ds_read_b64_tr_b16 v[224:225], v4 offset:25344
    s_add_u32 s22, s21, 0xc400
    s_add_u32 m0, s20, 0x1c400
    s_nop 0
    buffer_load_dwordx4 v2, s[8:11], s22 offen sc1 lds
    v_mfma_f32_16x16x32_bf16 v[44:47], v[232:235], v[116:119], v[44:47]
    ds_read_b64_tr_b16 v[226:227], v4 offset:26368
    s_waitcnt lgkmcnt(6)
    v_mfma_f32_16x16x32_bf16 v[48:51], v[236:239], v[112:115], v[48:51]
    ds_read_b64_tr_b16 v[228:229], v5 offset:25376
    v_mfma_f32_16x16x32_bf16 v[52:55], v[236:239], v[116:119], v[52:55]
    ds_read_b64_tr_b16 v[230:231], v5 offset:26400
    s_waitcnt lgkmcnt(6)
    v_mfma_f32_16x16x32_bf16 v[56:59], v[240:243], v[112:115], v[56:59]
    v_mfma_f32_16x16x32_bf16 v[60:63], v[240:243], v[116:119], v[60:63]
    s_waitcnt vmcnt(13)
    s_barrier
    ds_read_b64_tr_b16 v[232:233], v4 offset:32768
    ds_read_b64_tr_b16 v[234:235], v4 offset:33792
    s_waitcnt lgkmcnt(6)
    v_mfma_f32_16x16x32_bf16 v[64:67], v[244:247], v[112:115], v[64:67]
    ds_read_b64_tr_b16 v[236:237], v5 offset:32800
    v_mfma_f32_16x16x32_bf16 v[68:71], v[244:247], v[116:119], v[68:71]
    ds_read_b64_tr_b16 v[238:239], v5 offset:33824
    s_mov_b32 s23, 0xf800
    buffer_load_dwordx4 v[100:103], v7, s[8:11], s23 offen offset:1024 sc1
    s_waitcnt lgkmcnt(6)
    v_mfma_f32_16x16x32_bf16 v[72:75], v[224:227], v[112:115], v[72:75]
    ds_read_b64_tr_b16 v[240:241], v4 offset:33024
    v_mfma_f32_16x16x32_bf16 v[76:79], v[224:227], v[116:119], v[76:79]
    ds_read_b64_tr_b16 v[242:243], v4 offset:34048
    s_waitcnt lgkmcnt(6)
    v_mfma_f32_16x16x32_bf16 v[80:83], v[228:231], v[112:115], v[80:83]
    ds_read_b64_tr_b16 v[244:245], v5 offset:33056
    v_mfma_f32_16x16x32_bf16 v[84:87], v[228:231], v[116:119], v[84:87]
    ds_read_b64_tr_b16 v[246:247], v5 offset:34080
    s_waitcnt vmcnt(13) lgkmcnt(6)
    v_mfma_f32_16x16x32_bf16 v[24:27], v[232:235], v[120:123], v[24:27]
    ds_read_b64_tr_b16 v[224:225], v4 offset:33280
    s_waitcnt vmcnt(12)
    v_mfma_f32_16x16x32_bf16 v[28:31], v[232:235], v[124:127], v[28:31]
    ds_read_b64_tr_b16 v[226:227], v4 offset:34304
    s_waitcnt lgkmcnt(6)
    v_mfma_f32_16x16x32_bf16 v[32:35], v[236:239], v[120:123], v[32:35]
    ds_read_b64_tr_b16 v[228:229], v5 offset:33312
    v_mfma_f32_16x16x32_bf16 v[36:39], v[236:239], v[124:127], v[36:39]
    ds_read_b64_tr_b16 v[230:231], v5 offset:34336
    s_waitcnt lgkmcnt(6)
    v_mfma_f32_16x16x32_bf16 v[40:43], v[240:243], v[120:123], v[40:43]
    ds_read_b64_tr_b16 v[232:233], v4 offset:33536
    v_mfma_f32_16x16x32_bf16 v[44:47], v[240:243], v[124:127], v[44:47]
    ds_read_b64_tr_b16 v[234:235], v4 offset:34560
    s_waitcnt lgkmcnt(6)
    v_mfma_f32_16x16x32_bf16 v[48:51], v[244:247], v[120:123], v[48:51]
    ds_read_b64_tr_b16 v[236:237], v5 offset:33568
    v_mfma_f32_16x16x32_bf16 v[52:55], v[244:247], v[124:127], v[52:55]
    ds_read_b64_tr_b16 v[238:239], v5 offset:34592
    s_waitcnt lgkmcnt(6)
    v_mfma_f32_16x16x32_bf16 v[56:59], v[224:227], v[120:123], v[56:59]
    ds_read_b64_tr_b16 v[240:241], v4 offset:40960
    v_mfma_f32_16x16x32_bf16 v[60:63], v[224:227], v[124:127], v[60:63]
    ds_read_b64_tr_b16 v[242:243], v4 offset:41984
    s_waitcnt lgkmcnt(6)
    v_mfma_f32_16x16x32_bf16 v[64:67], v[228:231], v[120:123], v[64:67]
    ds_read_b64_tr_b16 v[244:245], v5 offset:40992
    v_mfma_f32_16x16x32_bf16 v[68:71], v[228:231], v[124:127], v[68:71]
    ds_read_b64_tr_b16 v[246:247], v5 offset:42016
    s_waitcnt lgkmcnt(6)
    v_mfma_f32_16x16x32_bf16 v[72:75], v[232:235], v[120:123], v[72:75]
    ds_read_b64_tr_b16 v[224:225], v4 offset:41216
    v_mfma_f32_16x16x32_bf16 v[76:79], v[232:235], v[124:127], v[76:79]
    ds_read_b64_tr_b16 v[226:227], v4 offset:42240
    s_waitcnt lgkmcnt(6)
    v_mfma_f32_16x16x32_bf16 v[80:83], v[236:239], v[120:123], v[80:83]
    ds_read_b64_tr_b16 v[228:229], v5 offset:41248
    v_mfma_f32_16x16x32_bf16 v[84:87], v[236:239], v[124:127], v[84:87]
    ds_read_b64_tr_b16 v[230:231], v5 offset:42272
    s_waitcnt vmcnt(10) lgkmcnt(6)
    v_mfma_f32_16x16x32_bf16 v[24:27], v[240:243], v[128:131], v[24:27]
    ds_read_b64_tr_b16 v[232:233], v4 offset:41472
    s_waitcnt vmcnt(7)
    v_mfma_f32_16x16x32_bf16 v[28:31], v[240:243], v[132:135], v[28:31]
    ds_read_b64_tr_b16 v[234:235], v4 offset:42496
    s_waitcnt lgkmcnt(6)
    v_mfma_f32_16x16x32_bf16 v[32:35], v[244:247], v[128:131], v[32:35]
    ds_read_b64_tr_b16 v[236:237], v5 offset:41504
    v_mfma_f32_16x16x32_bf16 v[36:39], v[244:247], v[132:135], v[36:39]
    ds_read_b64_tr_b16 v[238:239], v5 offset:42528
    s_waitcnt lgkmcnt(6)
    v_mfma_f32_16x16x32_bf16 v[40:43], v[224:227], v[128:131], v[40:43]
    ds_read_b64_tr_b16 v[240:241], v4 offset:41728
    v_mfma_f32_16x16x32_bf16 v[44:47], v[224:227], v[132:135], v[44:47]
    ds_read_b64_tr_b16 v[242:243], v4 offset:42752
    s_waitcnt lgkmcnt(6)
    v_mfma_f32_16x16x32_bf16 v[48:51], v[228:231], v[128:131], v[48:51]
    ds_read_b64_tr_b16 v[244:245], v5 offset:41760
    v_mfma_f32_16x16x32_bf16 v[52:55], v[228:231], v[132:135], v[52:55]
    ds_read_b64_tr_b16 v[246:247], v5 offset:42784
    s_waitcnt lgkmcnt(6)
    v_mfma_f32_16x16x32_bf16 v[56:59], v[232:235], v[128:131], v[56:59]
    v_mfma_f32_16x16x32_bf16 v[60:63], v[232:235], v[132:135], v[60:63]
    s_waitcnt vmcnt(6)
    s_barrier
    ds_read_b64_tr_b16 v[224:225], v4 offset:49152
    ds_read_b64_tr_b16 v[226:227], v4 offset:50176
    s_waitcnt lgkmcnt(6)
    v_mfma_f32_16x16x32_bf16 v[64:67], v[236:239], v[128:131], v[64:67]
    ds_read_b64_tr_b16 v[228:229], v5 offset:49184
    v_mfma_f32_16x16x32_bf16 v[68:71], v[236:239], v[132:135], v[68:71]
    ds_read_b64_tr_b16 v[230:231], v5 offset:50208
    s_waitcnt lgkmcnt(6)
    v_mfma_f32_16x16x32_bf16 v[72:75], v[240:243], v[128:131], v[72:75]
    ds_read_b64_tr_b16 v[232:233], v4 offset:49408
    v_mfma_f32_16x16x32_bf16 v[76:79], v[240:243], v[132:135], v[76:79]
    ds_read_b64_tr_b16 v[234:235], v4 offset:50432
    s_waitcnt lgkmcnt(6)
    v_mfma_f32_16x16x32_bf16 v[80:83], v[244:247], v[128:131], v[80:83]
    ds_read_b64_tr_b16 v[236:237], v5 offset:49440
    v_mfma_f32_16x16x32_bf16 v[84:87], v[244:247], v[132:135], v[84:87]
    ds_read_b64_tr_b16 v[238:239], v5 offset:50464
    s_waitcnt vmcnt(5) lgkmcnt(6)
    v_mfma_f32_16x16x32_bf16 v[24:27], v[224:227], v[88:91], v[24:27]
    ds_read_b64_tr_b16 v[240:241], v4 offset:49664
    s_waitcnt vmcnt(4)
    v_mfma_f32_16x16x32_bf16 v[28:31], v[224:227], v[92:95], v[28:31]
    ds_read_b64_tr_b16 v[242:243], v4 offset:50688
    s_waitcnt lgkmcnt(6)
    v_mfma_f32_16x16x32_bf16 v[32:35], v[228:231], v[88:91], v[32:35]
    ds_read_b64_tr_b16 v[244:245], v5 offset:49696
    v_mfma_f32_16x16x32_bf16 v[36:39], v[228:231], v[92:95], v[36:39]
    ds_read_b64_tr_b16 v[246:247], v5 offset:50720
    s_waitcnt lgkmcnt(6)
    v_mfma_f32_16x16x32_bf16 v[40:43], v[232:235], v[88:91], v[40:43]
    ds_read_b64_tr_b16 v[224:225], v4 offset:49920
    v_mfma_f32_16x16x32_bf16 v[44:47], v[232:235], v[92:95], v[44:47]
    ds_read_b64_tr_b16 v[226:227], v4 offset:50944
    s_waitcnt lgkmcnt(6)
    v_mfma_f32_16x16x32_bf16 v[48:51], v[236:239], v[88:91], v[48:51]
    ds_read_b64_tr_b16 v[228:229], v5 offset:49952
    v_mfma_f32_16x16x32_bf16 v[52:55], v[236:239], v[92:95], v[52:55]
    ds_read_b64_tr_b16 v[230:231], v5 offset:50976
    s_waitcnt lgkmcnt(6)
    v_mfma_f32_16x16x32_bf16 v[56:59], v[240:243], v[88:91], v[56:59]
    ds_read_b64_tr_b16 v[232:233], v4 offset:57344
    v_mfma_f32_16x16x32_bf16 v[60:63], v[240:243], v[92:95], v[60:63]
    ds_read_b64_tr_b16 v[234:235], v4 offset:58368
    s_waitcnt lgkmcnt(6)
    v_mfma_f32_16x16x32_bf16 v[64:67], v[244:247], v[88:91], v[64:67]
    ds_read_b64_tr_b16 v[236:237], v5 offset:57376
    v_mfma_f32_16x16x32_bf16 v[68:71], v[244:247], v[92:95], v[68:71]
    ds_read_b64_tr_b16 v[238:239], v5 offset:58400
    s_waitcnt lgkmcnt(6)
    v_mfma_f32_16x16x32_bf16 v[72:75], v[224:227], v[88:91], v[72:75]
    ds_read_b64_tr_b16 v[240:241], v4 offset:57600
    v_mfma_f32_16x16x32_bf16 v[76:79], v[224:227], v[92:95], v[76:79]
    ds_read_b64_tr_b16 v[242:243], v4 offset:58624
    s_waitcnt lgkmcnt(6)
    v_mfma_f32_16x16x32_bf16 v[80:83], v[228:231], v[88:91], v[80:83]
    ds_read_b64_tr_b16 v[244:245], v5 offset:57632
    v_mfma_f32_16x16x32_bf16 v[84:87], v[228:231], v[92:95], v[84:87]
    ds_read_b64_tr_b16 v[246:247], v5 offset:58656
    s_waitcnt vmcnt(2) lgkmcnt(6)
    v_mfma_f32_16x16x32_bf16 v[24:27], v[232:235], v[96:99], v[24:27]
    ds_read_b64_tr_b16 v[224:225], v4 offset:57856
    s_waitcnt vmcnt(0)
    v_mfma_f32_16x16x32_bf16 v[28:31], v[232:235], v[100:103], v[28:31]
    ds_read_b64_tr_b16 v[226:227], v4 offset:58880
    s_waitcnt lgkmcnt(6)
    v_mfma_f32_16x16x32_bf16 v[32:35], v[236:239], v[96:99], v[32:35]
    ds_read_b64_tr_b16 v[228:229], v5 offset:57888
    v_mfma_f32_16x16x32_bf16 v[36:39], v[236:239], v[100:103], v[36:39]
    ds_read_b64_tr_b16 v[230:231], v5 offset:58912
    s_waitcnt lgkmcnt(6)
    v_mfma_f32_16x16x32_bf16 v[40:43], v[240:243], v[96:99], v[40:43]
    ds_read_b64_tr_b16 v[232:233], v4 offset:58112
    v_mfma_f32_16x16x32_bf16 v[44:47], v[240:243], v[100:103], v[44:47]
    ds_read_b64_tr_b16 v[234:235], v4 offset:59136
    s_waitcnt lgkmcnt(6)
    v_mfma_f32_16x16x32_bf16 v[48:51], v[244:247], v[96:99], v[48:51]
    ds_read_b64_tr_b16 v[236:237], v5 offset:58144
    v_mfma_f32_16x16x32_bf16 v[52:55], v[244:247], v[100:103], v[52:55]
    ds_read_b64_tr_b16 v[238:239], v5 offset:59168
    s_waitcnt lgkmcnt(6)
    v_mfma_f32_16x16x32_bf16 v[56:59], v[224:227], v[96:99], v[56:59]
    v_mfma_f32_16x16x32_bf16 v[60:63], v[224:227], v[100:103], v[60:63]
    s_waitcnt lgkmcnt(4)
    v_mfma_f32_16x16x32_bf16 v[64:67], v[228:231], v[96:99], v[64:67]
    v_mfma_f32_16x16x32_bf16 v[68:71], v[228:231], v[100:103], v[68:71]
    s_waitcnt lgkmcnt(2)
    v_mfma_f32_16x16x32_bf16 v[72:75], v[232:235], v[96:99], v[72:75]
    v_mfma_f32_16x16x32_bf16 v[76:79], v[232:235], v[100:103], v[76:79]
    s_waitcnt lgkmcnt(0)
    v_mfma_f32_16x16x32_bf16 v[80:83], v[236:239], v[96:99], v[80:83]
    v_mfma_f32_16x16x32_bf16 v[84:87], v[236:239], v[100:103], v[84:87]
    s_mov_b32 s23, 0x3e0293ee
    v_mul_f32 v16, s23, v24
    v_mul_f32 v17, s23, v25
    v_cvt_pk_bf16_f32 v152, v16, v17
    v_mul_f32 v18, s23, v26
    v_mul_f32 v19, s23, v27
    v_cvt_pk_bf16_f32 v153, v18, v19
    v_mul_f32 v16, s23, v28
    v_mul_f32 v17, s23, v29
    v_cvt_pk_bf16_f32 v168, v16, v17
    v_mul_f32 v18, s23, v30
    v_mul_f32 v19, s23, v31
    v_cvt_pk_bf16_f32 v169, v18, v19
    v_mul_f32 v16, s23, v32
    v_mul_f32 v17, s23, v33
    v_cvt_pk_bf16_f32 v154, v16, v17
    v_mul_f32 v18, s23, v34
    v_mul_f32 v19, s23, v35
    v_cvt_pk_bf16_f32 v155, v18, v19
    v_mul_f32 v16, s23, v36
    v_mul_f32 v17, s23, v37
    v_cvt_pk_bf16_f32 v170, v16, v17
    v_mul_f32 v18, s23, v38
    v_mul_f32 v19, s23, v39
    v_cvt_pk_bf16_f32 v171, v18, v19
    v_mul_f32 v16, s23, v40
    v_mul_f32 v17, s23, v41
    v_cvt_pk_bf16_f32 v156, v16, v17
    v_mul_f32 v18, s23, v42
    v_mul_f32 v19, s23, v43
    v_cvt_pk_bf16_f32 v157, v18, v19
    v_mul_f32 v16, s23, v44
    v_mul_f32 v17, s23, v45
    v_cvt_pk_bf16_f32 v172, v16, v17
    v_mul_f32 v18, s23, v46
    v_mul_f32 v19, s23, v47
    v_cvt_pk_bf16_f32 v173, v18, v19
    v_mul_f32 v16, s23, v48
    v_mul_f32 v17, s23, v49
    v_cvt_pk_bf16_f32 v158, v16, v17
    v_mul_f32 v18, s23, v50
    v_mul_f32 v19, s23, v51
    v_cvt_pk_bf16_f32 v159, v18, v19
    v_mul_f32 v16, s23, v52
    v_mul_f32 v17, s23, v53
    v_cvt_pk_bf16_f32 v174, v16, v17
    v_mul_f32 v18, s23, v54
    v_mul_f32 v19, s23, v55
    v_cvt_pk_bf16_f32 v175, v18, v19
    v_mul_f32 v16, s23, v56
    v_mul_f32 v17, s23, v57
    v_cvt_pk_bf16_f32 v160, v16, v17
    v_mul_f32 v18, s23, v58
    v_mul_f32 v19, s23, v59
    v_cvt_pk_bf16_f32 v161, v18, v19
    v_mul_f32 v16, s23, v60
    v_mul_f32 v17, s23, v61
    v_cvt_pk_bf16_f32 v176, v16, v17
    v_mul_f32 v18, s23, v62
    v_mul_f32 v19, s23, v63
    v_cvt_pk_bf16_f32 v177, v18, v19
    v_mul_f32 v16, s23, v64
    v_mul_f32 v17, s23, v65
    v_cvt_pk_bf16_f32 v162, v16, v17
    v_mul_f32 v18, s23, v66
    v_mul_f32 v19, s23, v67
    v_cvt_pk_bf16_f32 v163, v18, v19
    v_mul_f32 v16, s23, v68
    v_mul_f32 v17, s23, v69
    v_cvt_pk_bf16_f32 v178, v16, v17
    v_mul_f32 v18, s23, v70
    v_mul_f32 v19, s23, v71
    v_cvt_pk_bf16_f32 v179, v18, v19
    v_mul_f32 v16, s23, v72
    v_mul_f32 v17, s23, v73
    v_cvt_pk_bf16_f32 v164, v16, v17
    v_mul_f32 v18, s23, v74
    v_mul_f32 v19, s23, v75
    v_cvt_pk_bf16_f32 v165, v18, v19
    v_mul_f32 v16, s23, v76
    v_mul_f32 v17, s23, v77
    v_cvt_pk_bf16_f32 v180, v16, v17
    v_mul_f32 v18, s23, v78
    v_mul_f32 v19, s23, v79
    v_cvt_pk_bf16_f32 v181, v18, v19
    v_mul_f32 v16, s23, v80
    v_mul_f32 v17, s23, v81
    v_cvt_pk_bf16_f32 v166, v16, v17
    v_mul_f32 v18, s23, v82
    v_mul_f32 v19, s23, v83
    v_cvt_pk_bf16_f32 v167, v18, v19
    v_mul_f32 v16, s23, v84
    v_mul_f32 v17, s23, v85
    v_cvt_pk_bf16_f32 v182, v16, v17
    v_mul_f32 v18, s23, v86
    v_mul_f32 v19, s23, v87
    v_cvt_pk_bf16_f32 v183, v18, v19
    v_add_u32 v4, 0x10000, v2
    v_add_u32 v5, 0x20000, v2
    s_barrier
    ds_read_b128 v[224:227], v4 offset:0
    ds_read_b128 v[228:231], v4 offset:1024
    ds_read_b128 v[232:235], v4 offset:2048
    ds_read_b128 v[236:239], v4 offset:3072
    s_waitcnt lgkmcnt(3)
    v_mfma_f32_16x16x32_bf16 v[184:187], v[224:227], v[152:155], 0
    v_mfma_f32_16x16x32_bf16 v[188:191], v[224:227], v[168:171], 0
    ds_read_b128 v[240:243], v4 offset:4096
    s_mov_b64 s[64:65], s[46:47]
    s_mov_b32 s66, 0x700000
    s_mov_b32 s67, 0x20000
    s_mov_b64 s[68:69], s[48:49]
    s_mov_b32 s70, 0x700000
    s_mov_b32 s71, 0x20000
    s_cmp_lt_u32 s2, 224
    s_cselect_b32 s66, 7340032, 0
    s_cselect_b32 s70, 7340032, 0
    s_and_b32 s29, s2, 7
    s_mul_i32 s29, s29, 28
    s_lshr_b32 s16, s2, 3
    s_add_u32 s29, s29, s16
    s_sub_u32 s16, s3, 4
    v_lshrrev_b32 v20, 3, v1
    v_lshlrev_b32 v20, 3, v20
    s_lshl_b32 s17, s16, 6
    v_add_u32 v20, s17, v20
    s_mov_b32 s17, 7168
    v_mul_lo_u32 v11, s17, v20
    v_and_b32 v20, 7, v1
    v_lshl_add_u32 v11, v20, 4, v11
    s_and_b32 s17, s29, 3
    s_mul_i32 s18, s17, 1835008
    s_lshr_b32 s17, s29, 2
    s_lshl_b32 s17, s17, 7
    s_add_u32 s18, s18, s17
    s_lshl_b32 s15, s16, 13
    s_waitcnt lgkmcnt(3)
    v_mfma_f32_16x16x32_bf16 v[192:195], v[228:231], v[152:155], 0
    s_add_u32 s22, s21, 0x10000
    s_add_u32 m0, s20, 0x20000
    s_nop 0
    buffer_load_dwordx4 v2, s[8:11], s22 offen sc1 lds
    s_mov_b64 s[76:77], s[54:55]
    s_mov_b32 s78, 0xc00000
    s_mov_b32 s79, 0x20000
    v_bfe_u32 v20, v1, 2, 2
    v_lshlrev_b32 v20, 12, v20
    v_add_u32 v6, v3, v20
    s_lshr_b32 s16, s2, 5
    s_lshl_b32 s16, s16, 7
    s_lshl_b32 s17, s3, 3
    s_add_u32 s16, s16, s17
    s_mul_i32 s14, s16, 12288
    s_and_b32 s16, s2, 31
    s_lshl_b32 s16, s16, 8
    s_add_u32 s14, s14, s16
    s_add_u32 s14, s14, 4096
    v_mfma_f32_16x16x32_bf16 v[196:199], v[228:231], v[168:171], 0
    ds_read_b128 v[244:247], v4 offset:5120
    s_waitcnt lgkmcnt(3)
    v_mfma_f32_16x16x32_bf16 v[184:187], v[232:235], v[156:159], v[184:187]
    v_mfma_f32_16x16x32_bf16 v[188:191], v[232:235], v[172:175], v[188:191]
    ds_read_b128 v[224:227], v4 offset:6144
    s_waitcnt lgkmcnt(3)
    v_mfma_f32_16x16x32_bf16 v[192:195], v[236:239], v[156:159], v[192:195]
    v_mfma_f32_16x16x32_bf16 v[196:199], v[236:239], v[172:175], v[196:199]
    ds_read_b128 v[228:231], v4 offset:7168
    s_waitcnt lgkmcnt(3)
    v_mfma_f32_16x16x32_bf16 v[184:187], v[240:243], v[160:163], v[184:187]
    v_mfma_f32_16x16x32_bf16 v[188:191], v[240:243], v[176:179], v[188:191]
    ds_read_b128 v[232:235], v4 offset:8192
    s_waitcnt lgkmcnt(3)
    v_mfma_f32_16x16x32_bf16 v[192:195], v[244:247], v[160:163], v[192:195]
    s_add_u32 s22, s21, 0x10400
    s_add_u32 m0, s20, 0x20400
    s_nop 0
    buffer_load_dwordx4 v2, s[8:11], s22 offen sc1 lds
    v_mfma_f32_16x16x32_bf16 v[196:199], v[244:247], v[176:179], v[196:199]
    ds_read_b128 v[236:239], v4 offset:9216
    s_waitcnt lgkmcnt(3)
    v_mfma_f32_16x16x32_bf16 v[184:187], v[224:227], v[164:167], v[184:187]
    v_mfma_f32_16x16x32_bf16 v[188:191], v[224:227], v[180:183], v[188:191]
    ds_read_b128 v[240:243], v4 offset:10240
    s_waitcnt lgkmcnt(3)
    v_mfma_f32_16x16x32_bf16 v[192:195], v[228:231], v[164:167], v[192:195]
    v_mfma_f32_16x16x32_bf16 v[196:199], v[228:231], v[180:183], v[196:199]
    ds_read_b128 v[244:247], v4 offset:11264
    s_waitcnt lgkmcnt(3)
    v_mfma_f32_16x16x32_bf16 v[200:203], v[232:235], v[152:155], 0
    v_mfma_f32_16x16x32_bf16 v[204:207], v[232:235], v[168:171], 0
    ds_read_b128 v[224:227], v4 offset:12288
    s_waitcnt lgkmcnt(3)
    v_mfma_f32_16x16x32_bf16 v[208:211], v[236:239], v[152:155], 0
    v_mfma_f32_16x16x32_bf16 v[212:215], v[236:239], v[168:171], 0
    ds_read_b128 v[228:231], v4 offset:13312
    s_waitcnt lgkmcnt(3)
    v_mfma_f32_16x16x32_bf16 v[200:203], v[240:243], v[156:159], v[200:203]
    v_mfma_f32_16x16x32_bf16 v[204:207], v[240:243], v[172:175], v[204:207]
    ds_read_b128 v[232:235], v4 offset:14336
    s_waitcnt lgkmcnt(3)
    v_mfma_f32_16x16x32_bf16 v[208:211], v[244:247], v[156:159], v[208:211]
    v_max3_f32 v16, v184, v185, v186
    v_mfma_f32_16x16x32_bf16 v[212:215], v[244:247], v[172:175], v[212:215]
    ds_read_b128 v[236:239], v4 offset:15360
    v_max3_f32 v16, v16, v187, v192
    s_waitcnt lgkmcnt(3)
    v_mfma_f32_16x16x32_bf16 v[200:203], v[224:227], v[160:163], v[200:203]
    v_max3_f32 v16, v16, v193, v194
    v_mfma_f32_16x16x32_bf16 v[204:207], v[224:227], v[176:179], v[204:207]
    s_barrier
    ds_read_b128 v[240:243], v4 offset:16384
    v_max_f32 v16, v16, v195
    s_waitcnt lgkmcnt(3)
    v_mfma_f32_16x16x32_bf16 v[208:211], v[228:231], v[160:163], v[208:211]
    v_max3_f32 v17, v188, v189, v190
    v_mfma_f32_16x16x32_bf16 v[212:215], v[228:231], v[176:179], v[212:215]
    s_add_u32 s22, s21, 0x14000
    s_add_u32 m0, s20, 0x24000
    s_nop 0
    buffer_load_dwordx4 v2, s[8:11], s22 offen sc1 lds
    ds_read_b128 v[244:247], v4 offset:17408
    v_max3_f32 v17, v17, v191, v196
    s_waitcnt lgkmcnt(3)
    v_mfma_f32_16x16x32_bf16 v[200:203], v[232:235], v[164:167], v[200:203]
    v_max3_f32 v17, v17, v197, v198
    v_mfma_f32_16x16x32_bf16 v[204:207], v[232:235], v[180:183], v[204:207]
    ds_read_b128 v[224:227], v4 offset:18432
    v_max_f32 v17, v17, v199
    s_waitcnt lgkmcnt(3)
    v_mfma_f32_16x16x32_bf16 v[208:211], v[236:239], v[164:167], v[208:211]
    v_mfma_f32_16x16x32_bf16 v[212:215], v[236:239], v[180:183], v[212:215]
    ds_read_b128 v[228:231], v4 offset:19456
    v_max3_f32 v16, v16, v200, v201
    v_max3_f32 v16, v16, v202, v203
    s_nop 3
    v_max3_f32 v16, v16, v208, v209
    v_max3_f32 v16, v16, v210, v211
    v_max3_f32 v17, v17, v204, v205
    v_max3_f32 v17, v17, v206, v207
    v_max3_f32 v17, v17, v212, v213
    v_max3_f32 v17, v17, v214, v215
    v_mov_b32 v18, v16
    v_mov_b32 v19, v17
    s_nop 0
    v_permlane16_swap_b32 v16, v18
    v_permlane16_swap_b32 v17, v19
    v_max_f32 v16, v16, v18
    v_max_f32 v17, v17, v19
    v_mov_b32 v18, v16
    v_mov_b32 v19, v17
    s_nop 0
    v_permlane32_swap_b32 v16, v18
    v_permlane32_swap_b32 v17, v19
    v_max_f32 v16, v16, v18
    v_max_f32 v17, v17, v19
    v_sub_f32 v216, 0, v16
    v_sub_f32 v217, 0, v16
    v_sub_f32 v218, 0, v16
    v_sub_f32 v219, 0, v16
    v_sub_f32 v220, 0, v17
    v_sub_f32 v221, 0, v17
    v_sub_f32 v222, 0, v17
    v_sub_f32 v223, 0, v17
    v_add_f32 v184, v184, v216
    v_add_f32 v185, v185, v216
    v_exp_f32 v184, v184
    v_exp_f32 v185, v185
    s_nop 0
    v_add_f32 v9, v184, v185
    v_cvt_pk_bf16_f32 v24, v184, v185
    v_add_f32 v186, v186, v216
    v_add_f32 v187, v187, v216
    v_exp_f32 v186, v186
    v_exp_f32 v187, v187
    v_add_f32 v9, v9, v186
    v_add_f32 v9, v9, v187
    v_cvt_pk_bf16_f32 v25, v186, v187
    v_add_f32 v188, v188, v220
    v_add_f32 v189, v189, v220
    v_exp_f32 v188, v188
    v_exp_f32 v189, v189
    s_nop 0
    v_add_f32 v10, v188, v189
    v_cvt_pk_bf16_f32 v28, v188, v189
    v_add_f32 v190, v190, v220
    v_add_f32 v191, v191, v220
    v_exp_f32 v190, v190
    v_exp_f32 v191, v191
    v_add_f32 v10, v10, v190
    v_add_f32 v10, v10, v191
    v_cvt_pk_bf16_f32 v29, v190, v191
    v_add_f32 v192, v192, v216
    v_add_f32 v193, v193, v216
    v_exp_f32 v192, v192
    v_exp_f32 v193, v193
    v_add_f32 v9, v9, v192
    v_add_f32 v9, v9, v193
    v_cvt_pk_bf16_f32 v26, v192, v193
    v_add_f32 v194, v194, v216
    v_add_f32 v195, v195, v216
    v_exp_f32 v194, v194
    v_exp_f32 v195, v195
    v_add_f32 v9, v9, v194
    v_add_f32 v9, v9, v195
    v_cvt_pk_bf16_f32 v27, v194, v195
    v_add_f32 v196, v196, v220
    v_add_f32 v197, v197, v220
    v_exp_f32 v196, v196
    v_exp_f32 v197, v197
    v_add_f32 v10, v10, v196
    v_add_f32 v10, v10, v197
    v_cvt_pk_bf16_f32 v30, v196, v197
    v_add_f32 v198, v198, v220
    v_add_f32 v199, v199, v220
    v_exp_f32 v198, v198
    v_exp_f32 v199, v199
    v_add_f32 v10, v10, v198
    v_add_f32 v10, v10, v199
    v_cvt_pk_bf16_f32 v31, v198, v199
    s_waitcnt lgkmcnt(3)
    v_mfma_f32_16x16x32_bf16 v[184:187], v[240:243], v[152:155], v[216:219]
    v_mfma_f32_16x16x32_bf16 v[188:191], v[240:243], v[168:171], v[220:223]
    ds_read_b128 v[232:235], v4 offset:20480
    v_add_f32 v200, v200, v216
    v_add_f32 v201, v201, v216
    v_exp_f32 v200, v200
    v_exp_f32 v201, v201
    s_waitcnt lgkmcnt(3)
    v_mfma_f32_16x16x32_bf16 v[192:195], v[244:247], v[152:155], v[216:219]
    v_add_f32 v9, v9, v200
    v_add_f32 v9, v9, v201
    v_cvt_pk_bf16_f32 v32, v200, v201
    v_add_f32 v202, v202, v216
    v_mfma_f32_16x16x32_bf16 v[196:199], v[244:247], v[168:171], v[220:223]
    s_add_u32 s22, s21, 0x14400
    s_add_u32 m0, s20, 0x24400
    s_nop 0
    buffer_load_dwordx4 v2, s[8:11], s22 offen sc1 lds
    ds_read_b128 v[236:239], v4 offset:21504
    v_add_f32 v203, v203, v216
    v_exp_f32 v202, v202
    v_exp_f32 v203, v203
    v_add_f32 v9, v9, v202
    s_waitcnt lgkmcnt(3)
    v_mfma_f32_16x16x32_bf16 v[184:187], v[224:227], v[156:159], v[184:187]
    v_add_f32 v9, v9, v203
    v_cvt_pk_bf16_f32 v33, v202, v203
    v_add_f32 v204, v204, v220
    s_add_u32 s22, s18, 0
    s_add_u32 m0, s15, 0
    s_nop 0
    buffer_load_dwordx4 v11, s[64:67], s22 offen lds
    v_mfma_f32_16x16x32_bf16 v[188:191], v[224:227], v[172:175], v[188:191]
    ds_read_b128 v[240:243], v4 offset:22528
    v_add_f32 v205, v205, v220
    v_exp_f32 v204, v204
    v_exp_f32 v205, v205
    v_add_f32 v10, v10, v204
    s_mov_b64 s[4:5], s[40:41]
    s_mov_b32 s6, 0x800000
    s_mov_b32 s7, 0x20000
    v_bfe_u32 v20, v1, 2, 2
    v_lshlrev_b32 v21, 13, v20
    v_sub_u32 v3, v3, v21
    v_lshl_add_u32 v3, v20, 11, v3
    s_and_b32 s16, s2, 1
    s_lshl_b32 s24, s16, 22
    s_lshr_b32 s16, s2, 5
    s_lshl_b32 s16, s16, 8
    s_add_u32 s24, s24, s16
    s_lshl_b32 s16, s3, 14
    s_add_u32 s24, s24, s16
    s_add_u32 s24, s24, 196608
    s_waitcnt lgkmcnt(3)
    v_mfma_f32_16x16x32_bf16 v[192:195], v[228:231], v[156:159], v[192:195]
    v_add_f32 v10, v10, v205
    v_cvt_pk_bf16_f32 v36, v204, v205
    v_add_f32 v206, v206, v220
    v_add_f32 v207, v207, v220
    v_mfma_f32_16x16x32_bf16 v[196:199], v[228:231], v[172:175], v[196:199]
    ds_read_b128 v[244:247], v4 offset:23552
    v_exp_f32 v206, v206
    v_exp_f32 v207, v207
    v_add_f32 v10, v10, v206
    v_add_f32 v10, v10, v207
    s_waitcnt lgkmcnt(3)
    v_mfma_f32_16x16x32_bf16 v[184:187], v[232:235], v[160:163], v[184:187]
    v_cvt_pk_bf16_f32 v37, v206, v207
    v_add_f32 v208, v208, v216
    v_add_f32 v209, v209, v216
    s_mov_b64 s[72:73], s[40:41]
    s_mov_b32 s74, 0x800000
    s_mov_b32 s75, 0x20000
    v_lshlrev_b32 v21, 7, v1
    s_lshl_b32 s16, s2, 2
    s_add_u32 s16, s16, s3
    s_sub_u32 s16, s16, 4
    s_lshl_b32 s16, s16, 13
    buffer_load_dword v15, v21, s[72:75], s16 offen
    v_mfma_f32_16x16x32_bf16 v[188:191], v[232:235], v[176:179], v[188:191]
    ds_read_b128 v[224:227], v4 offset:24576
    v_exp_f32 v208, v208
    v_exp_f32 v209, v209
    v_add_f32 v9, v9, v208
    v_add_f32 v9, v9, v209
    s_waitcnt lgkmcnt(3)
    v_mfma_f32_16x16x32_bf16 v[192:195], v[236:239], v[160:163], v[192:195]
    v_cvt_pk_bf16_f32 v34, v208, v209
    v_add_f32 v210, v210, v216
    v_add_f32 v211, v211, v216
    v_exp_f32 v210, v210
    v_mfma_f32_16x16x32_bf16 v[196:199], v[236:239], v[176:179], v[196:199]
    ds_read_b128 v[228:231], v4 offset:25600
    v_exp_f32 v211, v211
    v_add_f32 v9, v9, v210
    v_add_f32 v9, v9, v211
    v_cvt_pk_bf16_f32 v35, v210, v211
    s_waitcnt lgkmcnt(3)
    v_mfma_f32_16x16x32_bf16 v[184:187], v[240:243], v[164:167], v[184:187]
    v_add_f32 v212, v212, v220
    v_add_f32 v213, v213, v220
    v_exp_f32 v212, v212
    v_mfma_f32_16x16x32_bf16 v[188:191], v[240:243], v[180:183], v[188:191]
    ds_read_b128 v[232:235], v4 offset:26624
    v_exp_f32 v213, v213
    v_add_f32 v10, v10, v212
    v_add_f32 v10, v10, v213
    v_cvt_pk_bf16_f32 v38, v212, v213
    s_waitcnt lgkmcnt(3)
    v_mfma_f32_16x16x32_bf16 v[192:195], v[244:247], v[164:167], v[192:195]
    v_add_f32 v214, v214, v220
    v_add_f32 v215, v215, v220
    v_exp_f32 v214, v214
    v_exp_f32 v215, v215
    v_mfma_f32_16x16x32_bf16 v[196:199], v[244:247], v[180:183], v[196:199]
    ds_read_b128 v[236:239], v4 offset:27648
    v_add_f32 v10, v10, v214
    v_add_f32 v10, v10, v215
    v_cvt_pk_bf16_f32 v39, v214, v215
    s_waitcnt lgkmcnt(3)
    v_mfma_f32_16x16x32_bf16 v[200:203], v[224:227], v[152:155], v[216:219]
    v_mfma_f32_16x16x32_bf16 v[204:207], v[224:227], v[168:171], v[220:223]
    ds_read_b128 v[240:243], v4 offset:28672
    v_exp_f32 v184, v184
    v_exp_f32 v185, v185
    v_add_f32 v9, v9, v184
    s_waitcnt lgkmcnt(3)
    v_mfma_f32_16x16x32_bf16 v[208:211], v[228:231], v[152:155], v[216:219]
    v_add_f32 v9, v9, v185
    v_cvt_pk_bf16_f32 v40, v184, v185
    v_exp_f32 v186, v186
    v_mfma_f32_16x16x32_bf16 v[212:215], v[228:231], v[168:171], v[220:223]
    ds_read_b128 v[244:247], v4 offset:29696
    v_exp_f32 v187, v187
    v_add_f32 v9, v9, v186
    s_waitcnt lgkmcnt(3)
    v_mfma_f32_16x16x32_bf16 v[200:203], v[232:235], v[156:159], v[200:203]
    v_add_f32 v9, v9, v187
    v_cvt_pk_bf16_f32 v41, v186, v187
    v_exp_f32 v188, v188
    v_mfma_f32_16x16x32_bf16 v[204:207], v[232:235], v[172:175], v[204:207]
    ds_read_b128 v[224:227], v4 offset:30720
    v_exp_f32 v189, v189
    v_add_f32 v10, v10, v188
    v_add_f32 v10, v10, v189
    s_waitcnt lgkmcnt(3)
    v_mfma_f32_16x16x32_bf16 v[208:211], v[236:239], v[156:159], v[208:211]
    v_cvt_pk_bf16_f32 v44, v188, v189
    v_exp_f32 v190, v190
    v_mfma_f32_16x16x32_bf16 v[212:215], v[236:239], v[172:175], v[212:215]
    ds_read_b128 v[228:231], v4 offset:31744
    v_exp_f32 v191, v191
    v_add_f32 v10, v10, v190
    v_add_f32 v10, v10, v191
    s_waitcnt lgkmcnt(3)
    v_mfma_f32_16x16x32_bf16 v[200:203], v[240:243], v[160:163], v[200:203]
    v_cvt_pk_bf16_f32 v45, v190, v191
    v_exp_f32 v192, v192
    v_exp_f32 v193, v193
    v_mfma_f32_16x16x32_bf16 v[204:207], v[240:243], v[176:179], v[204:207]
    s_barrier
    ds_read_b128 v[232:235], v4 offset:32768
    v_add_f32 v9, v9, v192
    v_add_f32 v9, v9, v193
    s_waitcnt lgkmcnt(3)
    v_mfma_f32_16x16x32_bf16 v[208:211], v[244:247], v[160:163], v[208:211]
    v_cvt_pk_bf16_f32 v42, v192, v193
    v_exp_f32 v194, v194
    v_exp_f32 v195, v195
    v_mfma_f32_16x16x32_bf16 v[212:215], v[244:247], v[176:179], v[212:215]
    s_add_u32 s22, s21, 0x18000
    s_add_u32 m0, s20, 0x10000
    s_nop 0
    buffer_load_dwordx4 v2, s[8:11], s22 offen sc1 lds
    ds_read_b128 v[236:239], v4 offset:33792
    v_add_f32 v9, v9, v194
    v_add_f32 v9, v9, v195
    v_cvt_pk_bf16_f32 v43, v194, v195
    s_add_u32 s22, s18, 7168
    s_add_u32 m0, s15, 1024
    s_nop 0
    buffer_load_dwordx4 v11, s[64:67], s22 offen lds
    s_waitcnt lgkmcnt(3)
    v_mfma_f32_16x16x32_bf16 v[200:203], v[224:227], v[164:167], v[200:203]
    v_exp_f32 v196, v196
    v_exp_f32 v197, v197
    v_mfma_f32_16x16x32_bf16 v[204:207], v[224:227], v[180:183], v[204:207]
    ds_read_b128 v[240:243], v4 offset:34816
    v_add_f32 v10, v10, v196
    v_add_f32 v10, v10, v197
    v_cvt_pk_bf16_f32 v46, v196, v197
    s_waitcnt lgkmcnt(3)
    v_mfma_f32_16x16x32_bf16 v[208:211], v[228:231], v[164:167], v[208:211]
    v_exp_f32 v198, v198
    v_exp_f32 v199, v199
    v_add_f32 v10, v10, v198
    v_mfma_f32_16x16x32_bf16 v[212:215], v[228:231], v[180:183], v[212:215]
    ds_read_b128 v[244:247], v4 offset:35840
    v_add_f32 v10, v10, v199
    v_cvt_pk_bf16_f32 v47, v198, v199
    s_waitcnt lgkmcnt(3)
    v_mfma_f32_16x16x32_bf16 v[184:187], v[232:235], v[152:155], v[216:219]
    v_mfma_f32_16x16x32_bf16 v[188:191], v[232:235], v[168:171], v[220:223]
    ds_read_b128 v[224:227], v4 offset:36864
    v_exp_f32 v200, v200
    v_exp_f32 v201, v201
    v_add_f32 v9, v9, v200
    s_waitcnt lgkmcnt(3)
    v_mfma_f32_16x16x32_bf16 v[192:195], v[236:239], v[152:155], v[216:219]
    v_add_f32 v9, v9, v201
    v_cvt_pk_bf16_f32 v48, v200, v201
    v_exp_f32 v202, v202
    v_mfma_f32_16x16x32_bf16 v[196:199], v[236:239], v[168:171], v[220:223]
    s_add_u32 s22, s21, 0x18400
    s_add_u32 m0, s20, 0x10400
    s_nop 0
    buffer_load_dwordx4 v2, s[8:11], s22 offen sc1 lds
    ds_read_b128 v[228:231], v4 offset:37888
    v_exp_f32 v203, v203
    v_add_f32 v9, v9, v202
    s_waitcnt lgkmcnt(3)
    v_mfma_f32_16x16x32_bf16 v[184:187], v[240:243], v[156:159], v[184:187]
    v_add_f32 v9, v9, v203
    v_cvt_pk_bf16_f32 v49, v202, v203
    v_exp_f32 v204, v204
    v_mfma_f32_16x16x32_bf16 v[188:191], v[240:243], v[172:175], v[188:191]
    ds_read_b128 v[232:235], v4 offset:38912
    v_exp_f32 v205, v205
    v_add_f32 v10, v10, v204
    v_add_f32 v10, v10, v205
    s_waitcnt lgkmcnt(3)
    v_mfma_f32_16x16x32_bf16 v[192:195], v[244:247], v[156:159], v[192:195]
    v_cvt_pk_bf16_f32 v52, v204, v205
    v_exp_f32 v206, v206
    v_mfma_f32_16x16x32_bf16 v[196:199], v[244:247], v[172:175], v[196:199]
    ds_read_b128 v[236:239], v4 offset:39936
    v_exp_f32 v207, v207
    v_add_f32 v10, v10, v206
    v_add_f32 v10, v10, v207
    s_waitcnt lgkmcnt(3)
    v_mfma_f32_16x16x32_bf16 v[184:187], v[224:227], v[160:163], v[184:187]
    v_cvt_pk_bf16_f32 v53, v206, v207
    v_exp_f32 v208, v208
    v_exp_f32 v209, v209
    v_mfma_f32_16x16x32_bf16 v[188:191], v[224:227], v[176:179], v[188:191]
    ds_read_b128 v[240:243], v4 offset:40960
    v_add_f32 v9, v9, v208
    v_add_f32 v9, v9, v209
    s_waitcnt lgkmcnt(3)
    v_mfma_f32_16x16x32_bf16 v[192:195], v[228:231], v[160:163], v[192:195]
    v_cvt_pk_bf16_f32 v50, v208, v209
    v_exp_f32 v210, v210
    v_exp_f32 v211, v211
    v_mfma_f32_16x16x32_bf16 v[196:199], v[228:231], v[176:179], v[196:199]
    ds_read_b128 v[244:247], v4 offset:41984
    v_add_f32 v9, v9, v210
    v_add_f32 v9, v9, v211
    v_cvt_pk_bf16_f32 v51, v210, v211
    s_waitcnt lgkmcnt(3)
    v_mfma_f32_16x16x32_bf16 v[184:187], v[232:235], v[164:167], v[184:187]
    v_exp_f32 v212, v212
    v_exp_f32 v213, v213
    v_mfma_f32_16x16x32_bf16 v[188:191], v[232:235], v[180:183], v[188:191]
    ds_read_b128 v[224:227], v4 offset:43008
    v_add_f32 v10, v10, v212
    v_add_f32 v10, v10, v213
    v_cvt_pk_bf16_f32 v54, v212, v213
    s_waitcnt lgkmcnt(3)
    v_mfma_f32_16x16x32_bf16 v[192:195], v[236:239], v[164:167], v[192:195]
    v_exp_f32 v214, v214
    v_exp_f32 v215, v215
    v_add_f32 v10, v10, v214
    v_mfma_f32_16x16x32_bf16 v[196:199], v[236:239], v[180:183], v[196:199]
    ds_read_b128 v[228:231], v4 offset:44032
    v_add_f32 v10, v10, v215
    v_cvt_pk_bf16_f32 v55, v214, v215
    s_waitcnt lgkmcnt(3)
    v_mfma_f32_16x16x32_bf16 v[200:203], v[240:243], v[152:155], v[216:219]
    v_mfma_f32_16x16x32_bf16 v[204:207], v[240:243], v[168:171], v[220:223]
    ds_read_b128 v[232:235], v4 offset:45056
    v_exp_f32 v184, v184
    v_exp_f32 v185, v185
    v_add_f32 v9, v9, v184
    s_waitcnt lgkmcnt(3)
    v_mfma_f32_16x16x32_bf16 v[208:211], v[244:247], v[152:155], v[216:219]
    v_add_f32 v9, v9, v185
    v_cvt_pk_bf16_f32 v56, v184, v185
    v_exp_f32 v186, v186
    v_mfma_f32_16x16x32_bf16 v[212:215], v[244:247], v[168:171], v[220:223]
    ds_read_b128 v[236:239], v4 offset:46080
    v_exp_f32 v187, v187
    v_add_f32 v9, v9, v186
    s_add_u32 s22, s18, 14336
    s_add_u32 m0, s15, 2048
    s_nop 0
    buffer_load_dwordx4 v11, s[64:67], s22 offen lds
    s_waitcnt lgkmcnt(3)
    v_mfma_f32_16x16x32_bf16 v[200:203], v[224:227], v[156:159], v[200:203]
    v_add_f32 v9, v9, v187
    v_cvt_pk_bf16_f32 v57, v186, v187
    v_exp_f32 v188, v188
    v_mfma_f32_16x16x32_bf16 v[204:207], v[224:227], v[172:175], v[204:207]
    ds_read_b128 v[240:243], v4 offset:47104
    v_exp_f32 v189, v189
    v_add_f32 v10, v10, v188
    v_add_f32 v10, v10, v189
    s_waitcnt lgkmcnt(3)
    v_mfma_f32_16x16x32_bf16 v[208:211], v[228:231], v[156:159], v[208:211]
    v_cvt_pk_bf16_f32 v60, v188, v189
    v_exp_f32 v190, v190
    v_mfma_f32_16x16x32_bf16 v[212:215], v[228:231], v[172:175], v[212:215]
    ds_read_b128 v[244:247], v4 offset:48128
    v_exp_f32 v191, v191
    v_add_f32 v10, v10, v190
    v_add_f32 v10, v10, v191
    s_waitcnt lgkmcnt(3)
    v_mfma_f32_16x16x32_bf16 v[200:203], v[232:235], v[160:163], v[200:203]
    v_cvt_pk_bf16_f32 v61, v190, v191
    v_exp_f32 v192, v192
    v_exp_f32 v193, v193
    v_mfma_f32_16x16x32_bf16 v[204:207], v[232:235], v[176:179], v[204:207]
    s_barrier
    ds_read_b128 v[224:227], v4 offset:49152
    v_add_f32 v9, v9, v192
    v_add_f32 v9, v9, v193
    s_waitcnt lgkmcnt(3)
    v_mfma_f32_16x16x32_bf16 v[208:211], v[236:239], v[160:163], v[208:211]
    v_cvt_pk_bf16_f32 v58, v192, v193
    v_exp_f32 v194, v194
    v_exp_f32 v195, v195
    v_mfma_f32_16x16x32_bf16 v[212:215], v[236:239], v[176:179], v[212:215]
    s_add_u32 s22, s21, 0x1c000
    s_add_u32 m0, s20, 0x14000
    s_nop 0
    buffer_load_dwordx4 v2, s[8:11], s22 offen sc1 lds
    ds_read_b128 v[228:231], v4 offset:50176
    v_add_f32 v9, v9, v194
    v_add_f32 v9, v9, v195
    v_cvt_pk_bf16_f32 v59, v194, v195
    s_waitcnt lgkmcnt(3)
    v_mfma_f32_16x16x32_bf16 v[200:203], v[240:243], v[164:167], v[200:203]
    v_exp_f32 v196, v196
    v_exp_f32 v197, v197
    v_mfma_f32_16x16x32_bf16 v[204:207], v[240:243], v[180:183], v[204:207]
    ds_read_b128 v[232:235], v4 offset:51200
    v_add_f32 v10, v10, v196
    v_add_f32 v10, v10, v197
    v_cvt_pk_bf16_f32 v62, v196, v197
    s_waitcnt lgkmcnt(3)
    v_mfma_f32_16x16x32_bf16 v[208:211], v[244:247], v[164:167], v[208:211]
    v_exp_f32 v198, v198
    v_exp_f32 v199, v199
    v_add_f32 v10, v10, v198
    v_mfma_f32_16x16x32_bf16 v[212:215], v[244:247], v[180:183], v[212:215]
    ds_read_b128 v[236:239], v4 offset:52224
    v_add_f32 v10, v10, v199
    v_cvt_pk_bf16_f32 v63, v198, v199
    s_waitcnt lgkmcnt(3)
    v_mfma_f32_16x16x32_bf16 v[184:187], v[224:227], v[152:155], v[216:219]
    v_mfma_f32_16x16x32_bf16 v[188:191], v[224:227], v[168:171], v[220:223]
    ds_read_b128 v[240:243], v4 offset:53248
    v_exp_f32 v200, v200
    v_exp_f32 v201, v201
    v_add_f32 v9, v9, v200
    s_waitcnt lgkmcnt(3)
    v_mfma_f32_16x16x32_bf16 v[192:195], v[228:231], v[152:155], v[216:219]
    v_add_f32 v9, v9, v201
    v_cvt_pk_bf16_f32 v64, v200, v201
    v_exp_f32 v202, v202
    v_mfma_f32_16x16x32_bf16 v[196:199], v[228:231], v[168:171], v[220:223]
    s_add_u32 s22, s21, 0x1c400
    s_add_u32 m0, s20, 0x14400
    s_nop 0
    buffer_load_dwordx4 v2, s[8:11], s22 offen sc1 lds
    ds_read_b128 v[244:247], v4 offset:54272
    v_exp_f32 v203, v203
    v_add_f32 v9, v9, v202
    s_waitcnt lgkmcnt(3)
    v_mfma_f32_16x16x32_bf16 v[184:187], v[232:235], v[156:159], v[184:187]
    v_add_f32 v9, v9, v203
    v_cvt_pk_bf16_f32 v65, v202, v203
    v_exp_f32 v204, v204
    v_mfma_f32_16x16x32_bf16 v[188:191], v[232:235], v[172:175], v[188:191]
    ds_read_b128 v[224:227], v4 offset:55296
    v_exp_f32 v205, v205
    v_add_f32 v10, v10, v204
    v_add_f32 v10, v10, v205
    s_waitcnt lgkmcnt(3)
    v_mfma_f32_16x16x32_bf16 v[192:195], v[236:239], v[156:159], v[192:195]
    v_cvt_pk_bf16_f32 v68, v204, v205
    v_exp_f32 v206, v206
    v_mfma_f32_16x16x32_bf16 v[196:199], v[236:239], v[172:175], v[196:199]
    ds_read_b128 v[228:231], v4 offset:56320
    v_exp_f32 v207, v207
    v_add_f32 v10, v10, v206
    v_add_f32 v10, v10, v207
    s_waitcnt lgkmcnt(3)
    v_mfma_f32_16x16x32_bf16 v[184:187], v[240:243], v[160:163], v[184:187]
    v_cvt_pk_bf16_f32 v69, v206, v207
    v_exp_f32 v208, v208
    v_exp_f32 v209, v209
    v_mfma_f32_16x16x32_bf16 v[188:191], v[240:243], v[176:179], v[188:191]
    ds_read_b128 v[232:235], v4 offset:57344
    v_add_f32 v9, v9, v208
    v_add_f32 v9, v9, v209
    s_waitcnt lgkmcnt(3)
    v_mfma_f32_16x16x32_bf16 v[192:195], v[244:247], v[160:163], v[192:195]
    v_cvt_pk_bf16_f32 v66, v208, v209
    v_exp_f32 v210, v210
    v_exp_f32 v211, v211
    s_add_u32 s22, s18, 21504
    s_add_u32 m0, s15, 3072
    s_nop 0
    buffer_load_dwordx4 v11, s[64:67], s22 offen lds
    v_mfma_f32_16x16x32_bf16 v[196:199], v[244:247], v[176:179], v[196:199]
    ds_read_b128 v[236:239], v4 offset:58368
    v_add_f32 v9, v9, v210
    v_add_f32 v9, v9, v211
    v_cvt_pk_bf16_f32 v67, v210, v211
    s_waitcnt lgkmcnt(3)
    v_mfma_f32_16x16x32_bf16 v[184:187], v[224:227], v[164:167], v[184:187]
    v_exp_f32 v212, v212
    v_exp_f32 v213, v213
    v_mfma_f32_16x16x32_bf16 v[188:191], v[224:227], v[180:183], v[188:191]
    ds_read_b128 v[240:243], v4 offset:59392
    v_add_f32 v10, v10, v212
    v_add_f32 v10, v10, v213
    v_cvt_pk_bf16_f32 v70, v212, v213
    s_waitcnt lgkmcnt(3)
    v_mfma_f32_16x16x32_bf16 v[192:195], v[228:231], v[164:167], v[192:195]
    v_exp_f32 v214, v214
    v_exp_f32 v215, v215
    v_add_f32 v10, v10, v214
    v_mfma_f32_16x16x32_bf16 v[196:199], v[228:231], v[180:183], v[196:199]
    ds_read_b128 v[244:247], v4 offset:60416
    v_add_f32 v10, v10, v215
    v_cvt_pk_bf16_f32 v71, v214, v215
    s_waitcnt lgkmcnt(3)
    v_mfma_f32_16x16x32_bf16 v[200:203], v[232:235], v[152:155], v[216:219]
    v_mfma_f32_16x16x32_bf16 v[204:207], v[232:235], v[168:171], v[220:223]
    ds_read_b128 v[224:227], v4 offset:61440
    v_exp_f32 v184, v184
    v_exp_f32 v185, v185
    v_add_f32 v9, v9, v184
    s_waitcnt lgkmcnt(3)
    v_mfma_f32_16x16x32_bf16 v[208:211], v[236:239], v[152:155], v[216:219]
    v_add_f32 v9, v9, v185
    v_cvt_pk_bf16_f32 v72, v184, v185
    v_exp_f32 v186, v186
    v_mfma_f32_16x16x32_bf16 v[212:215], v[236:239], v[168:171], v[220:223]
    ds_read_b128 v[228:231], v4 offset:62464
    v_exp_f32 v187, v187
    v_add_f32 v9, v9, v186
    s_waitcnt lgkmcnt(3)
    v_mfma_f32_16x16x32_bf16 v[200:203], v[240:243], v[156:159], v[200:203]
    v_add_f32 v9, v9, v187
    v_cvt_pk_bf16_f32 v73, v186, v187
    v_exp_f32 v188, v188
    v_mfma_f32_16x16x32_bf16 v[204:207], v[240:243], v[172:175], v[204:207]
    ds_read_b128 v[232:235], v4 offset:63488
    v_exp_f32 v189, v189
    v_add_f32 v10, v10, v188
    v_add_f32 v10, v10, v189
    s_waitcnt lgkmcnt(3)
    v_mfma_f32_16x16x32_bf16 v[208:211], v[244:247], v[156:159], v[208:211]
    v_cvt_pk_bf16_f32 v76, v188, v189
    v_exp_f32 v190, v190
    v_mfma_f32_16x16x32_bf16 v[212:215], v[244:247], v[172:175], v[212:215]
    ds_read_b128 v[236:239], v4 offset:64512
    v_exp_f32 v191, v191
    v_add_f32 v10, v10, v190
    v_add_f32 v10, v10, v191
    s_waitcnt lgkmcnt(3)
    v_mfma_f32_16x16x32_bf16 v[200:203], v[224:227], v[160:163], v[200:203]
    v_cvt_pk_bf16_f32 v77, v190, v191
    v_exp_f32 v192, v192
    v_exp_f32 v193, v193
    v_mfma_f32_16x16x32_bf16 v[204:207], v[224:227], v[176:179], v[204:207]
    s_waitcnt vmcnt(11)
    s_barrier
    ds_read_b128 v[240:243], v5 offset:0
    v_add_f32 v9, v9, v192
    v_add_f32 v9, v9, v193
    s_waitcnt lgkmcnt(3)
    v_mfma_f32_16x16x32_bf16 v[208:211], v[228:231], v[160:163], v[208:211]
    v_cvt_pk_bf16_f32 v74, v192, v193
    v_exp_f32 v194, v194
    v_exp_f32 v195, v195
    v_mfma_f32_16x16x32_bf16 v[212:215], v[228:231], v[176:179], v[212:215]
    s_add_u32 s22, s14, 0x0
    s_add_u32 m0, s20, 0x18000
    s_nop 0
    buffer_load_dwordx4 v6, s[76:79], s22 offen lds
    ds_read_b128 v[244:247], v5 offset:1024
    v_add_f32 v9, v9, v194
    v_add_f32 v9, v9, v195
    v_cvt_pk_bf16_f32 v75, v194, v195
    s_waitcnt lgkmcnt(3)
    v_mfma_f32_16x16x32_bf16 v[200:203], v[232:235], v[164:167], v[200:203]
    v_exp_f32 v196, v196
    v_exp_f32 v197, v197
    v_mfma_f32_16x16x32_bf16 v[204:207], v[232:235], v[180:183], v[204:207]
    ds_read_b128 v[224:227], v5 offset:2048
    v_add_f32 v10, v10, v196
    v_add_f32 v10, v10, v197
    v_cvt_pk_bf16_f32 v78, v196, v197
    s_waitcnt lgkmcnt(3)
    v_mfma_f32_16x16x32_bf16 v[208:211], v[236:239], v[164:167], v[208:211]
    v_exp_f32 v198, v198
    v_exp_f32 v199, v199
    v_add_f32 v10, v10, v198
    v_mfma_f32_16x16x32_bf16 v[212:215], v[236:239], v[180:183], v[212:215]
    ds_read_b128 v[228:231], v5 offset:3072
    v_add_f32 v10, v10, v199
    v_cvt_pk_bf16_f32 v79, v198, v199
    s_waitcnt lgkmcnt(3)
    v_mfma_f32_16x16x32_bf16 v[184:187], v[240:243], v[152:155], v[216:219]
    v_mfma_f32_16x16x32_bf16 v[188:191], v[240:243], v[168:171], v[220:223]
    ds_read_b128 v[232:235], v5 offset:4096
    v_exp_f32 v200, v200
    v_exp_f32 v201, v201
    v_add_f32 v9, v9, v200
    s_waitcnt lgkmcnt(3)
    v_mfma_f32_16x16x32_bf16 v[192:195], v[244:247], v[152:155], v[216:219]
    v_add_f32 v9, v9, v201
    v_cvt_pk_bf16_f32 v80, v200, v201
    v_exp_f32 v202, v202
    s_add_u32 s22, s18, 28672
    s_add_u32 m0, s15, 4096
    s_nop 0
    buffer_load_dwordx4 v11, s[64:67], s22 offen lds
    v_mfma_f32_16x16x32_bf16 v[196:199], v[244:247], v[168:171], v[220:223]
    s_add_u32 s22, s14, 0xc000
    s_add_u32 m0, s20, 0x18400
    s_nop 0
    buffer_load_dwordx4 v6, s[76:79], s22 offen lds
    ds_read_b128 v[236:239], v5 offset:5120
    v_exp_f32 v203, v203
    v_add_f32 v9, v9, v202
    s_waitcnt lgkmcnt(3)
    v_mfma_f32_16x16x32_bf16 v[184:187], v[224:227], v[156:159], v[184:187]
    v_add_f32 v9, v9, v203
    v_cvt_pk_bf16_f32 v81, v202, v203
    v_exp_f32 v204, v204
    v_mfma_f32_16x16x32_bf16 v[188:191], v[224:227], v[172:175], v[188:191]
    ds_read_b128 v[240:243], v5 offset:6144
    v_exp_f32 v205, v205
    v_add_f32 v10, v10, v204
    v_add_f32 v10, v10, v205
    s_waitcnt lgkmcnt(3)
    v_mfma_f32_16x16x32_bf16 v[192:195], v[228:231], v[156:159], v[192:195]
    v_cvt_pk_bf16_f32 v84, v204, v205
    v_exp_f32 v206, v206
    v_mfma_f32_16x16x32_bf16 v[196:199], v[228:231], v[172:175], v[196:199]
    ds_read_b128 v[244:247], v5 offset:7168
    v_exp_f32 v207, v207
    v_add_f32 v10, v10, v206
    v_add_f32 v10, v10, v207
    s_waitcnt lgkmcnt(3)
    v_mfma_f32_16x16x32_bf16 v[184:187], v[232:235], v[160:163], v[184:187]
    v_cvt_pk_bf16_f32 v85, v206, v207
    v_exp_f32 v208, v208
    v_exp_f32 v209, v209
    v_mfma_f32_16x16x32_bf16 v[188:191], v[232:235], v[176:179], v[188:191]
    ds_read_b128 v[224:227], v5 offset:8192
    v_add_f32 v9, v9, v208
    v_add_f32 v9, v9, v209
    s_waitcnt lgkmcnt(3)
    v_mfma_f32_16x16x32_bf16 v[192:195], v[236:239], v[160:163], v[192:195]
    v_cvt_pk_bf16_f32 v82, v208, v209
    v_exp_f32 v210, v210
    v_exp_f32 v211, v211
    v_mfma_f32_16x16x32_bf16 v[196:199], v[236:239], v[176:179], v[196:199]
    ds_read_b128 v[228:231], v5 offset:9216
    v_add_f32 v9, v9, v210
    v_add_f32 v9, v9, v211
    v_cvt_pk_bf16_f32 v83, v210, v211
    s_waitcnt lgkmcnt(3)
    v_mfma_f32_16x16x32_bf16 v[184:187], v[240:243], v[164:167], v[184:187]
    v_exp_f32 v212, v212
    v_exp_f32 v213, v213
    v_mfma_f32_16x16x32_bf16 v[188:191], v[240:243], v[180:183], v[188:191]
    ds_read_b128 v[232:235], v5 offset:10240
    v_add_f32 v10, v10, v212
    v_add_f32 v10, v10, v213
    v_cvt_pk_bf16_f32 v86, v212, v213
    s_waitcnt lgkmcnt(3)
    v_mfma_f32_16x16x32_bf16 v[192:195], v[244:247], v[164:167], v[192:195]
    v_exp_f32 v214, v214
    v_exp_f32 v215, v215
    v_add_f32 v10, v10, v214
    v_mfma_f32_16x16x32_bf16 v[196:199], v[244:247], v[180:183], v[196:199]
    ds_read_b128 v[236:239], v5 offset:11264
    v_add_f32 v10, v10, v215
    v_cvt_pk_bf16_f32 v87, v214, v215
    s_waitcnt lgkmcnt(3)
    v_mfma_f32_16x16x32_bf16 v[200:203], v[224:227], v[152:155], v[216:219]
    v_mfma_f32_16x16x32_bf16 v[204:207], v[224:227], v[168:171], v[220:223]
    ds_read_b128 v[240:243], v5 offset:12288
    v_exp_f32 v184, v184
    v_exp_f32 v185, v185
    v_add_f32 v9, v9, v184
    s_waitcnt lgkmcnt(3)
    v_mfma_f32_16x16x32_bf16 v[208:211], v[228:231], v[152:155], v[216:219]
    v_add_f32 v9, v9, v185
    v_cvt_pk_bf16_f32 v88, v184, v185
    v_exp_f32 v186, v186
    v_mfma_f32_16x16x32_bf16 v[212:215], v[228:231], v[168:171], v[220:223]
    ds_read_b128 v[244:247], v5 offset:13312
    v_exp_f32 v187, v187
    v_add_f32 v9, v9, v186
    s_waitcnt lgkmcnt(3)
    v_mfma_f32_16x16x32_bf16 v[200:203], v[232:235], v[156:159], v[200:203]
    v_add_f32 v9, v9, v187
    v_cvt_pk_bf16_f32 v89, v186, v187
    v_exp_f32 v188, v188
    v_mfma_f32_16x16x32_bf16 v[204:207], v[232:235], v[172:175], v[204:207]
    ds_read_b128 v[224:227], v5 offset:14336
    v_exp_f32 v189, v189
    v_add_f32 v10, v10, v188
    v_add_f32 v10, v10, v189
    s_waitcnt lgkmcnt(3)
    v_mfma_f32_16x16x32_bf16 v[208:211], v[236:239], v[156:159], v[208:211]
    v_cvt_pk_bf16_f32 v92, v188, v189
    v_exp_f32 v190, v190
    v_mfma_f32_16x16x32_bf16 v[212:215], v[236:239], v[172:175], v[212:215]
    ds_read_b128 v[228:231], v5 offset:15360
    v_exp_f32 v191, v191
    v_add_f32 v10, v10, v190
    v_add_f32 v10, v10, v191
    s_waitcnt lgkmcnt(3)
    v_mfma_f32_16x16x32_bf16 v[200:203], v[240:243], v[160:163], v[200:203]
    v_cvt_pk_bf16_f32 v93, v190, v191
    v_exp_f32 v192, v192
    v_exp_f32 v193, v193
    v_mfma_f32_16x16x32_bf16 v[204:207], v[240:243], v[176:179], v[204:207]
    s_waitcnt vmcnt(12)
    s_barrier
    ds_read_b128 v[232:235], v5 offset:16384
    v_add_f32 v9, v9, v192
    v_add_f32 v9, v9, v193
    s_add_u32 s22, s18, 35840
    s_add_u32 m0, s15, 5120
    s_nop 0
    buffer_load_dwordx4 v11, s[64:67], s22 offen lds
    s_waitcnt lgkmcnt(3)
    v_mfma_f32_16x16x32_bf16 v[208:211], v[244:247], v[160:163], v[208:211]
    v_cvt_pk_bf16_f32 v90, v192, v193
    v_exp_f32 v194, v194
    v_exp_f32 v195, v195
    v_mfma_f32_16x16x32_bf16 v[212:215], v[244:247], v[176:179], v[212:215]
    s_add_u32 s22, s14, 0xc0000
    s_add_u32 m0, s20, 0x1c000
    s_nop 0
    buffer_load_dwordx4 v6, s[76:79], s22 offen lds
    ds_read_b128 v[236:239], v5 offset:17408
    v_add_f32 v9, v9, v194
    v_add_f32 v9, v9, v195
    v_cvt_pk_bf16_f32 v91, v194, v195
    s_waitcnt lgkmcnt(3)
    v_mfma_f32_16x16x32_bf16 v[200:203], v[224:227], v[164:167], v[200:203]
    v_exp_f32 v196, v196
    v_exp_f32 v197, v197
    v_mfma_f32_16x16x32_bf16 v[204:207], v[224:227], v[180:183], v[204:207]
    ds_read_b128 v[240:243], v5 offset:18432
    v_add_f32 v10, v10, v196
    v_add_f32 v10, v10, v197
    v_cvt_pk_bf16_f32 v94, v196, v197
    s_waitcnt lgkmcnt(3)
    v_mfma_f32_16x16x32_bf16 v[208:211], v[228:231], v[164:167], v[208:211]
    v_exp_f32 v198, v198
    v_exp_f32 v199, v199
    v_add_f32 v10, v10, v198
    v_mfma_f32_16x16x32_bf16 v[212:215], v[228:231], v[180:183], v[212:215]
    ds_read_b128 v[244:247], v5 offset:19456
    v_add_f32 v10, v10, v199
    v_cvt_pk_bf16_f32 v95, v198, v199
    s_waitcnt lgkmcnt(3)
    v_mfma_f32_16x16x32_bf16 v[184:187], v[232:235], v[152:155], v[216:219]
    v_mfma_f32_16x16x32_bf16 v[188:191], v[232:235], v[168:171], v[220:223]
    ds_read_b128 v[224:227], v5 offset:20480
    v_exp_f32 v200, v200
    v_exp_f32 v201, v201
    v_add_f32 v9, v9, v200
    s_waitcnt lgkmcnt(3)
    v_mfma_f32_16x16x32_bf16 v[192:195], v[236:239], v[152:155], v[216:219]
    v_add_f32 v9, v9, v201
    v_cvt_pk_bf16_f32 v96, v200, v201
    v_exp_f32 v202, v202
    v_mfma_f32_16x16x32_bf16 v[196:199], v[236:239], v[168:171], v[220:223]
    s_add_u32 s22, s14, 0xcc000
    s_add_u32 m0, s20, 0x1c400
    s_nop 0
    buffer_load_dwordx4 v6, s[76:79], s22 offen lds
    ds_read_b128 v[228:231], v5 offset:21504
    v_exp_f32 v203, v203
    v_add_f32 v9, v9, v202
    s_waitcnt lgkmcnt(3)
    v_mfma_f32_16x16x32_bf16 v[184:187], v[240:243], v[156:159], v[184:187]
    v_add_f32 v9, v9, v203
    v_cvt_pk_bf16_f32 v97, v202, v203
    v_exp_f32 v204, v204
    v_mfma_f32_16x16x32_bf16 v[188:191], v[240:243], v[172:175], v[188:191]
    ds_read_b128 v[232:235], v5 offset:22528
    v_exp_f32 v205, v205
    v_add_f32 v10, v10, v204
    v_add_f32 v10, v10, v205
    s_waitcnt lgkmcnt(3)
    v_mfma_f32_16x16x32_bf16 v[192:195], v[244:247], v[156:159], v[192:195]
    v_cvt_pk_bf16_f32 v100, v204, v205
    v_exp_f32 v206, v206
    v_mfma_f32_16x16x32_bf16 v[196:199], v[244:247], v[172:175], v[196:199]
    ds_read_b128 v[236:239], v5 offset:23552
    v_exp_f32 v207, v207
    v_add_f32 v10, v10, v206
    v_add_f32 v10, v10, v207
    s_waitcnt lgkmcnt(3)
    v_mfma_f32_16x16x32_bf16 v[184:187], v[224:227], v[160:163], v[184:187]
    v_cvt_pk_bf16_f32 v101, v206, v207
    v_exp_f32 v208, v208
    v_exp_f32 v209, v209
    v_mfma_f32_16x16x32_bf16 v[188:191], v[224:227], v[176:179], v[188:191]
    ds_read_b128 v[240:243], v5 offset:24576
    v_add_f32 v9, v9, v208
    v_add_f32 v9, v9, v209
    s_waitcnt lgkmcnt(3)
    v_mfma_f32_16x16x32_bf16 v[192:195], v[228:231], v[160:163], v[192:195]
    v_cvt_pk_bf16_f32 v98, v208, v209
    v_exp_f32 v210, v210
    v_exp_f32 v211, v211
    v_mfma_f32_16x16x32_bf16 v[196:199], v[228:231], v[176:179], v[196:199]
    ds_read_b128 v[244:247], v5 offset:25600
    v_add_f32 v9, v9, v210
    v_add_f32 v9, v9, v211
    v_cvt_pk_bf16_f32 v99, v210, v211
    s_waitcnt lgkmcnt(3)
    v_mfma_f32_16x16x32_bf16 v[184:187], v[232:235], v[164:167], v[184:187]
    v_exp_f32 v212, v212
    v_exp_f32 v213, v213
    v_mfma_f32_16x16x32_bf16 v[188:191], v[232:235], v[180:183], v[188:191]
    ds_read_b128 v[224:227], v5 offset:26624
    v_add_f32 v10, v10, v212
    v_add_f32 v10, v10, v213
    v_cvt_pk_bf16_f32 v102, v212, v213
    s_waitcnt lgkmcnt(3)
    v_mfma_f32_16x16x32_bf16 v[192:195], v[236:239], v[164:167], v[192:195]
    v_exp_f32 v214, v214
    v_exp_f32 v215, v215
    v_add_f32 v10, v10, v214
    v_mfma_f32_16x16x32_bf16 v[196:199], v[236:239], v[180:183], v[196:199]
    ds_read_b128 v[228:231], v5 offset:27648
    v_add_f32 v10, v10, v215
    v_cvt_pk_bf16_f32 v103, v214, v215
    s_waitcnt lgkmcnt(3)
    v_mfma_f32_16x16x32_bf16 v[200:203], v[240:243], v[152:155], v[216:219]
    v_mfma_f32_16x16x32_bf16 v[204:207], v[240:243], v[168:171], v[220:223]
    ds_read_b128 v[232:235], v5 offset:28672
    v_exp_f32 v184, v184
    v_exp_f32 v185, v185
    v_add_f32 v9, v9, v184
    s_add_u32 s22, s18, 43008
    s_add_u32 m0, s15, 6144
    s_nop 0
    buffer_load_dwordx4 v11, s[64:67], s22 offen lds
    s_waitcnt lgkmcnt(3)
    v_mfma_f32_16x16x32_bf16 v[208:211], v[244:247], v[152:155], v[216:219]
    v_add_f32 v9, v9, v185
    v_cvt_pk_bf16_f32 v104, v184, v185
    v_exp_f32 v186, v186
    v_mfma_f32_16x16x32_bf16 v[212:215], v[244:247], v[168:171], v[220:223]
    ds_read_b128 v[236:239], v5 offset:29696
    v_exp_f32 v187, v187
    v_add_f32 v9, v9, v186
    s_waitcnt lgkmcnt(3)
    v_mfma_f32_16x16x32_bf16 v[200:203], v[224:227], v[156:159], v[200:203]
    v_add_f32 v9, v9, v187
    v_cvt_pk_bf16_f32 v105, v186, v187
    v_exp_f32 v188, v188
    v_mfma_f32_16x16x32_bf16 v[204:207], v[224:227], v[172:175], v[204:207]
    ds_read_b128 v[240:243], v5 offset:30720
    v_exp_f32 v189, v189
    v_add_f32 v10, v10, v188
    v_add_f32 v10, v10, v189
    v_lshrrev_b32 v20, 4, v1
    v_lshlrev_b32 v21, 4, v20
    s_lshl_b32 s16, s2, 8
    s_add_u32 s16, s16, 0x550000
    buffer_load_dwordx4 v[144:147], v21, s[8:11], s16 offen offset:0 sc1
    buffer_load_dwordx4 v[148:151], v21, s[8:11], s16 offen offset:64 sc1
    buffer_load_dwordx4 v[248:251], v21, s[8:11], s16 offen offset:128 sc1
    buffer_load_dwordx4 v[252:255], v21, s[8:11], s16 offen offset:192 sc1
    v_lshlrev_b32 v7, 11, v20
    v_xor_b32 v20, s3, v20
    v_and_b32 v20, 1, v20
    v_lshl_add_u32 v7, v20, 5, v7
    v_bfe_u32 v20, v1, 2, 2
    v_lshl_add_u32 v7, v20, 6, v7
    v_and_b32 v20, 3, v1
    v_lshl_add_u32 v7, v20, 3, v7
    s_lshr_b32 s16, s3, 1
    s_lshl_b32 s16, s16, 8
    s_add_u32 s16, s16, 98304
    v_add_u32 v7, s16, v7
    s_waitcnt lgkmcnt(3)
    v_mfma_f32_16x16x32_bf16 v[208:211], v[228:231], v[156:159], v[208:211]
    v_cvt_pk_bf16_f32 v108, v188, v189
    v_exp_f32 v190, v190
    v_mfma_f32_16x16x32_bf16 v[212:215], v[228:231], v[172:175], v[212:215]
    ds_read_b128 v[244:247], v5 offset:31744
    v_exp_f32 v191, v191
    v_add_f32 v10, v10, v190
    v_add_f32 v10, v10, v191
    s_waitcnt lgkmcnt(3)
    v_mfma_f32_16x16x32_bf16 v[200:203], v[232:235], v[160:163], v[200:203]
    v_cvt_pk_bf16_f32 v109, v190, v191
    v_exp_f32 v192, v192
    v_exp_f32 v193, v193
    v_mfma_f32_16x16x32_bf16 v[204:207], v[232:235], v[176:179], v[204:207]
    s_waitcnt vmcnt(15)
    s_barrier
    ds_read_b128 v[224:227], v4 offset:0
    v_add_f32 v9, v9, v192
    v_add_f32 v9, v9, v193
    s_waitcnt lgkmcnt(3)
    v_mfma_f32_16x16x32_bf16 v[208:211], v[236:239], v[160:163], v[208:211]
    v_cvt_pk_bf16_f32 v106, v192, v193
    v_exp_f32 v194, v194
    v_exp_f32 v195, v195
    v_mfma_f32_16x16x32_bf16 v[212:215], v[236:239], v[176:179], v[212:215]
    s_add_u32 s22, s21, 0x80000
    s_add_u32 m0, s20, 0x20000
    s_nop 0
    buffer_load_dwordx4 v2, s[8:11], s22 offen sc1 lds
    ds_read_b128 v[228:231], v4 offset:1024
    v_add_f32 v9, v9, v194
    v_add_f32 v9, v9, v195
    v_cvt_pk_bf16_f32 v107, v194, v195
    s_waitcnt lgkmcnt(3)
    v_mfma_f32_16x16x32_bf16 v[200:203], v[240:243], v[164:167], v[200:203]
    v_exp_f32 v196, v196
    v_exp_f32 v197, v197
    v_mfma_f32_16x16x32_bf16 v[204:207], v[240:243], v[180:183], v[204:207]
    ds_read_b128 v[232:235], v4 offset:2048
    v_add_f32 v10, v10, v196
    v_add_f32 v10, v10, v197
    v_cvt_pk_bf16_f32 v110, v196, v197
    s_waitcnt lgkmcnt(3)
    v_mfma_f32_16x16x32_bf16 v[208:211], v[244:247], v[164:167], v[208:211]
    v_exp_f32 v198, v198
    v_exp_f32 v199, v199
    v_add_f32 v10, v10, v198
    v_mfma_f32_16x16x32_bf16 v[212:215], v[244:247], v[180:183], v[212:215]
    ds_read_b128 v[236:239], v4 offset:3072
    v_add_f32 v10, v10, v199
    v_cvt_pk_bf16_f32 v111, v198, v199
    s_waitcnt lgkmcnt(3)
    v_mfma_f32_16x16x32_bf16 v[184:187], v[224:227], v[152:155], v[216:219]
    v_mfma_f32_16x16x32_bf16 v[188:191], v[224:227], v[168:171], v[220:223]
    ds_read_b128 v[240:243], v4 offset:4096
    v_exp_f32 v200, v200
    v_exp_f32 v201, v201
    v_add_f32 v9, v9, v200
    s_waitcnt lgkmcnt(3)
    v_mfma_f32_16x16x32_bf16 v[192:195], v[228:231], v[152:155], v[216:219]
    v_add_f32 v9, v9, v201
    v_cvt_pk_bf16_f32 v112, v200, v201
    v_exp_f32 v202, v202
    v_mfma_f32_16x16x32_bf16 v[196:199], v[228:231], v[168:171], v[220:223]
    s_add_u32 s22, s21, 0x80400
    s_add_u32 m0, s20, 0x20400
    s_nop 0
    buffer_load_dwordx4 v2, s[8:11], s22 offen sc1 lds
    ds_read_b128 v[244:247], v4 offset:5120
    v_exp_f32 v203, v203
    v_add_f32 v9, v9, v202
    s_waitcnt lgkmcnt(3)
    v_mfma_f32_16x16x32_bf16 v[184:187], v[232:235], v[156:159], v[184:187]
    v_add_f32 v9, v9, v203
    v_cvt_pk_bf16_f32 v113, v202, v203
    v_exp_f32 v204, v204
    v_mfma_f32_16x16x32_bf16 v[188:191], v[232:235], v[172:175], v[188:191]
    ds_read_b128 v[224:227], v4 offset:6144
    v_exp_f32 v205, v205
    v_add_f32 v10, v10, v204
    v_add_f32 v10, v10, v205
    s_waitcnt lgkmcnt(3)
    v_mfma_f32_16x16x32_bf16 v[192:195], v[236:239], v[156:159], v[192:195]
    v_cvt_pk_bf16_f32 v116, v204, v205
    v_exp_f32 v206, v206
    v_mfma_f32_16x16x32_bf16 v[196:199], v[236:239], v[172:175], v[196:199]
    ds_read_b128 v[228:231], v4 offset:7168
    v_exp_f32 v207, v207
    v_add_f32 v10, v10, v206
    v_add_f32 v10, v10, v207
    s_waitcnt lgkmcnt(3)
    v_mfma_f32_16x16x32_bf16 v[184:187], v[240:243], v[160:163], v[184:187]
    v_cvt_pk_bf16_f32 v117, v206, v207
    v_exp_f32 v208, v208
    v_exp_f32 v209, v209
    s_add_u32 s22, s18, 50176
    s_add_u32 m0, s15, 7168
    s_nop 0
    buffer_load_dwordx4 v11, s[64:67], s22 offen lds
    v_mfma_f32_16x16x32_bf16 v[188:191], v[240:243], v[176:179], v[188:191]
    ds_read_b128 v[232:235], v4 offset:8192
    v_add_f32 v9, v9, v208
    v_add_f32 v9, v9, v209
    s_waitcnt lgkmcnt(3)
    v_mfma_f32_16x16x32_bf16 v[192:195], v[244:247], v[160:163], v[192:195]
    v_cvt_pk_bf16_f32 v114, v208, v209
    v_exp_f32 v210, v210
    v_exp_f32 v211, v211
    v_mfma_f32_16x16x32_bf16 v[196:199], v[244:247], v[176:179], v[196:199]
    ds_read_b128 v[236:239], v4 offset:9216
    v_add_f32 v9, v9, v210
    v_add_f32 v9, v9, v211
    v_cvt_pk_bf16_f32 v115, v210, v211
    s_waitcnt lgkmcnt(3)
    v_mfma_f32_16x16x32_bf16 v[184:187], v[224:227], v[164:167], v[184:187]
    v_exp_f32 v212, v212
    v_exp_f32 v213, v213
    v_mfma_f32_16x16x32_bf16 v[188:191], v[224:227], v[180:183], v[188:191]
    ds_read_b128 v[240:243], v4 offset:10240
    v_add_f32 v10, v10, v212
    v_add_f32 v10, v10, v213
    v_cvt_pk_bf16_f32 v118, v212, v213
    s_waitcnt lgkmcnt(3)
    v_mfma_f32_16x16x32_bf16 v[192:195], v[228:231], v[164:167], v[192:195]
    v_exp_f32 v214, v214
    v_exp_f32 v215, v215
    v_add_f32 v10, v10, v214
    v_mfma_f32_16x16x32_bf16 v[196:199], v[228:231], v[180:183], v[196:199]
    ds_read_b128 v[244:247], v4 offset:11264
    v_add_f32 v10, v10, v215
    v_cvt_pk_bf16_f32 v119, v214, v215
    s_waitcnt lgkmcnt(3)
    v_mfma_f32_16x16x32_bf16 v[200:203], v[232:235], v[152:155], v[216:219]
    v_mfma_f32_16x16x32_bf16 v[204:207], v[232:235], v[168:171], v[220:223]
    ds_read_b128 v[224:227], v4 offset:12288
    v_exp_f32 v184, v184
    v_exp_f32 v185, v185
    v_add_f32 v9, v9, v184
    s_waitcnt lgkmcnt(3)
    v_mfma_f32_16x16x32_bf16 v[208:211], v[236:239], v[152:155], v[216:219]
    v_add_f32 v9, v9, v185
    v_cvt_pk_bf16_f32 v120, v184, v185
    v_exp_f32 v186, v186
    v_mfma_f32_16x16x32_bf16 v[212:215], v[236:239], v[168:171], v[220:223]
    ds_read_b128 v[228:231], v4 offset:13312
    v_exp_f32 v187, v187
    v_add_f32 v9, v9, v186
    s_waitcnt lgkmcnt(3)
    v_mfma_f32_16x16x32_bf16 v[200:203], v[240:243], v[156:159], v[200:203]
    v_add_f32 v9, v9, v187
    v_cvt_pk_bf16_f32 v121, v186, v187
    v_exp_f32 v188, v188
    v_mfma_f32_16x16x32_bf16 v[204:207], v[240:243], v[172:175], v[204:207]
    ds_read_b128 v[232:235], v4 offset:14336
    v_exp_f32 v189, v189
    v_add_f32 v10, v10, v188
    v_add_f32 v10, v10, v189
    s_waitcnt lgkmcnt(3)
    v_mfma_f32_16x16x32_bf16 v[208:211], v[244:247], v[156:159], v[208:211]
    v_cvt_pk_bf16_f32 v124, v188, v189
    v_exp_f32 v190, v190
    v_mfma_f32_16x16x32_bf16 v[212:215], v[244:247], v[172:175], v[212:215]
    ds_read_b128 v[236:239], v4 offset:15360
    v_exp_f32 v191, v191
    v_add_f32 v10, v10, v190
    v_add_f32 v10, v10, v191
    s_waitcnt lgkmcnt(3)
    v_mfma_f32_16x16x32_bf16 v[200:203], v[224:227], v[160:163], v[200:203]
    v_cvt_pk_bf16_f32 v125, v190, v191
    v_exp_f32 v192, v192
    v_exp_f32 v193, v193
    v_mfma_f32_16x16x32_bf16 v[204:207], v[224:227], v[176:179], v[204:207]
    s_waitcnt vmcnt(15)
    s_waitcnt vmcnt(11)
    s_waitcnt vmcnt(8)
    s_barrier
    ds_read_b128 v[240:243], v4 offset:16384
    v_add_f32 v9, v9, v192
    v_add_f32 v9, v9, v193
    s_waitcnt lgkmcnt(3)
    v_mfma_f32_16x16x32_bf16 v[208:211], v[228:231], v[160:163], v[208:211]
    v_cvt_pk_bf16_f32 v122, v192, v193
    v_exp_f32 v194, v194
    v_exp_f32 v195, v195
    v_mfma_f32_16x16x32_bf16 v[212:215], v[228:231], v[176:179], v[212:215]
    s_add_u32 s22, s21, 0x84000
    s_add_u32 m0, s20, 0x24000
    s_nop 0
    buffer_load_dwordx4 v2, s[8:11], s22 offen sc1 lds
    ds_read_b128 v[244:247], v4 offset:17408
    v_add_f32 v9, v9, v194
    v_add_f32 v9, v9, v195
    v_cvt_pk_bf16_f32 v123, v194, v195
    ds_read_b64_tr_b16 v[136:137], v7 offset:0
    ds_read_b64_tr_b16 v[138:139], v7 offset:1024
    s_waitcnt lgkmcnt(5)
    v_mfma_f32_16x16x32_bf16 v[200:203], v[232:235], v[164:167], v[200:203]
    v_exp_f32 v196, v196
    v_exp_f32 v197, v197
    v_mfma_f32_16x16x32_bf16 v[204:207], v[232:235], v[180:183], v[204:207]
    ds_read_b128 v[224:227], v4 offset:18432
    v_add_f32 v10, v10, v196
    v_add_f32 v10, v10, v197
    v_cvt_pk_bf16_f32 v126, v196, v197
    s_waitcnt lgkmcnt(5)
    v_mfma_f32_16x16x32_bf16 v[208:211], v[236:239], v[164:167], v[208:211]
    v_exp_f32 v198, v198
    v_exp_f32 v199, v199
    v_add_f32 v10, v10, v198
    ds_read_b64_tr_b16 v[140:141], v7 offset:8192
    ds_read_b64_tr_b16 v[142:143], v7 offset:9216
    v_mfma_f32_16x16x32_bf16 v[212:215], v[236:239], v[180:183], v[212:215]
    ds_read_b128 v[228:231], v4 offset:19456
    v_add_f32 v10, v10, v199
    v_cvt_pk_bf16_f32 v127, v198, v199
    s_waitcnt lgkmcnt(7)
    v_mfma_f32_16x16x32_bf16 v[184:187], v[240:243], v[152:155], v[216:219]
    s_waitcnt vmcnt(7) lgkmcnt(4)
    v_mfma_f32_16x16x32_bf16 v[12:15], v[136:139], v[144:147], 0
    v_mfma_f32_16x16x32_bf16 v[188:191], v[240:243], v[168:171], v[220:223]
    ds_read_b128 v[232:235], v4 offset:20480
    v_exp_f32 v200, v200
    v_exp_f32 v201, v201
    v_add_f32 v9, v9, v200
    ds_read_b64_tr_b16 v[136:137], v7 offset:16384
    ds_read_b64_tr_b16 v[138:139], v7 offset:17408
    v_mfma_f32_16x16x32_bf16 v[192:195], v[244:247], v[152:155], v[216:219]
    v_add_f32 v9, v9, v201
    v_cvt_pk_bf16_f32 v128, v200, v201
    v_exp_f32 v202, v202
    v_mfma_f32_16x16x32_bf16 v[196:199], v[244:247], v[168:171], v[220:223]
    s_add_u32 s22, s21, 0x84400
    s_add_u32 m0, s20, 0x24400
    s_nop 0
    buffer_load_dwordx4 v2, s[8:11], s22 offen sc1 lds
    ds_read_b128 v[236:239], v4 offset:21504
    v_exp_f32 v203, v203
    v_add_f32 v9, v9, v202
    s_waitcnt vmcnt(7) lgkmcnt(5)
    v_mfma_f32_16x16x32_bf16 v[12:15], v[140:143], v[148:151], v[12:15]
    v_mfma_f32_16x16x32_bf16 v[184:187], v[224:227], v[156:159], v[184:187]
    v_add_f32 v9, v9, v203
    v_cvt_pk_bf16_f32 v129, v202, v203
    v_exp_f32 v204, v204
    ds_read_b64_tr_b16 v[140:141], v7 offset:24576
    ds_read_b64_tr_b16 v[142:143], v7 offset:25600
    v_mfma_f32_16x16x32_bf16 v[188:191], v[224:227], v[172:175], v[188:191]
    ds_read_b128 v[240:243], v4 offset:22528
    v_exp_f32 v205, v205
    v_add_f32 v10, v10, v204
    v_add_f32 v10, v10, v205
    s_waitcnt lgkmcnt(7)
    v_mfma_f32_16x16x32_bf16 v[192:195], v[228:231], v[156:159], v[192:195]
    v_cvt_pk_bf16_f32 v132, v204, v205
    v_exp_f32 v206, v206
    s_waitcnt vmcnt(6) lgkmcnt(4)
    v_mfma_f32_16x16x32_bf16 v[12:15], v[136:139], v[248:251], v[12:15]
    v_mfma_f32_16x16x32_bf16 v[196:199], v[228:231], v[172:175], v[196:199]
    ds_read_b128 v[244:247], v4 offset:23552
    v_exp_f32 v207, v207
    v_add_f32 v10, v10, v206
    v_add_f32 v10, v10, v207
    v_mfma_f32_16x16x32_bf16 v[184:187], v[232:235], v[160:163], v[184:187]
    v_cvt_pk_bf16_f32 v133, v206, v207
    v_exp_f32 v208, v208
    v_exp_f32 v209, v209
    v_mfma_f32_16x16x32_bf16 v[188:191], v[232:235], v[176:179], v[188:191]
    ds_read_b128 v[224:227], v4 offset:24576
    v_add_f32 v9, v9, v208
    v_add_f32 v9, v9, v209
    s_waitcnt vmcnt(5) lgkmcnt(3)
    v_mfma_f32_16x16x32_bf16 v[12:15], v[140:143], v[252:255], v[12:15]
    v_mfma_f32_16x16x32_bf16 v[192:195], v[236:239], v[160:163], v[192:195]
    v_cvt_pk_bf16_f32 v130, v208, v209
    v_exp_f32 v210, v210
    v_exp_f32 v211, v211
    v_mfma_f32_16x16x32_bf16 v[196:199], v[236:239], v[176:179], v[196:199]
    ds_read_b128 v[228:231], v4 offset:25600
    v_add_f32 v9, v9, v210
    v_add_f32 v9, v9, v211
    v_cvt_pk_bf16_f32 v131, v210, v211
    s_waitcnt lgkmcnt(3)
    v_mfma_f32_16x16x32_bf16 v[184:187], v[240:243], v[164:167], v[184:187]
    v_exp_f32 v212, v212
    v_exp_f32 v213, v213
    v_mfma_f32_16x16x32_bf16 v[188:191], v[240:243], v[180:183], v[188:191]
    ds_read_b128 v[232:235], v4 offset:26624
    v_add_f32 v10, v10, v212
    v_add_f32 v10, v10, v213
    v_cvt_pk_bf16_f32 v134, v212, v213
    s_waitcnt lgkmcnt(3)
    v_mfma_f32_16x16x32_bf16 v[192:195], v[244:247], v[164:167], v[192:195]
    v_exp_f32 v214, v214
    v_exp_f32 v215, v215
    v_add_f32 v10, v10, v214
    v_mfma_f32_16x16x32_bf16 v[196:199], v[244:247], v[180:183], v[196:199]
    ds_read_b128 v[236:239], v4 offset:27648
    v_add_f32 v10, v10, v215
    v_cvt_pk_bf16_f32 v135, v214, v215
    s_waitcnt lgkmcnt(3)
    v_mfma_f32_16x16x32_bf16 v[200:203], v[224:227], v[152:155], v[216:219]
    v_mfma_f32_16x16x32_bf16 v[204:207], v[224:227], v[168:171], v[220:223]
    ds_read_b128 v[240:243], v4 offset:28672
    v_exp_f32 v184, v184
    v_exp_f32 v185, v185
    v_add_f32 v9, v9, v184
    v_lshrrev_b32 v20, 4, v1
    v_lshlrev_b32 v20, 4, v20
    s_lshr_b32 s16, s2, 5
    s_lshl_b32 s16, s16, 14
    s_and_b32 s17, s2, 31
    s_lshl_b32 s17, s17, 9
    s_add_u32 s16, s16, s17
    s_lshl_b32 s17, s3, 6
    s_add_u32 s16, s16, s17
    s_add_u32 s16, s16, 0x580000
    s_mov_b32 exec_lo, 0x10001
    s_mov_b32 exec_hi, 0x10001
    buffer_store_dwordx4 v[12:15], v20, s[8:11], s16 offen sc1
    s_mov_b64 exec, -1
    s_waitcnt lgkmcnt(3)
    v_mfma_f32_16x16x32_bf16 v[208:211], v[228:231], v[152:155], v[216:219]
    v_add_f32 v9, v9, v185
    v_cvt_pk_bf16_f32 v136, v184, v185
    v_exp_f32 v186, v186
    v_mfma_f32_16x16x32_bf16 v[212:215], v[228:231], v[168:171], v[220:223]
    ds_read_b128 v[244:247], v4 offset:29696
    v_exp_f32 v187, v187
    v_add_f32 v9, v9, v186
    s_waitcnt lgkmcnt(3)
    v_mfma_f32_16x16x32_bf16 v[200:203], v[232:235], v[156:159], v[200:203]
    v_add_f32 v9, v9, v187
    v_cvt_pk_bf16_f32 v137, v186, v187
    v_exp_f32 v188, v188
    v_mfma_f32_16x16x32_bf16 v[204:207], v[232:235], v[172:175], v[204:207]
    ds_read_b128 v[224:227], v4 offset:30720
    v_exp_f32 v189, v189
    v_add_f32 v10, v10, v188
    v_add_f32 v10, v10, v189
    s_waitcnt lgkmcnt(3)
    v_mfma_f32_16x16x32_bf16 v[208:211], v[236:239], v[156:159], v[208:211]
    v_cvt_pk_bf16_f32 v140, v188, v189
    v_exp_f32 v190, v190
    v_mfma_f32_16x16x32_bf16 v[212:215], v[236:239], v[172:175], v[212:215]
    ds_read_b128 v[228:231], v4 offset:31744
    v_exp_f32 v191, v191
    v_add_f32 v10, v10, v190
    v_add_f32 v10, v10, v191
    s_waitcnt lgkmcnt(3)
    v_mfma_f32_16x16x32_bf16 v[200:203], v[240:243], v[160:163], v[200:203]
    v_cvt_pk_bf16_f32 v141, v190, v191
    v_exp_f32 v192, v192
    v_exp_f32 v193, v193
    v_mfma_f32_16x16x32_bf16 v[204:207], v[240:243], v[176:179], v[204:207]
    v_add_f32 v9, v9, v192
    v_add_f32 v9, v9, v193
    s_waitcnt lgkmcnt(2)
    v_mfma_f32_16x16x32_bf16 v[208:211], v[244:247], v[160:163], v[208:211]
    v_cvt_pk_bf16_f32 v138, v192, v193
    v_exp_f32 v194, v194
    v_exp_f32 v195, v195
    v_mfma_f32_16x16x32_bf16 v[212:215], v[244:247], v[176:179], v[212:215]
    v_add_f32 v9, v9, v194
    v_add_f32 v9, v9, v195
    v_cvt_pk_bf16_f32 v139, v194, v195
    s_waitcnt lgkmcnt(1)
    v_mfma_f32_16x16x32_bf16 v[200:203], v[224:227], v[164:167], v[200:203]
    v_exp_f32 v196, v196
    v_exp_f32 v197, v197
    v_mfma_f32_16x16x32_bf16 v[204:207], v[224:227], v[180:183], v[204:207]
    v_add_f32 v10, v10, v196
    v_add_f32 v10, v10, v197
    v_cvt_pk_bf16_f32 v142, v196, v197
    s_waitcnt lgkmcnt(0)
    v_mfma_f32_16x16x32_bf16 v[208:211], v[228:231], v[164:167], v[208:211]
    v_exp_f32 v198, v198
    v_exp_f32 v199, v199
    v_add_f32 v10, v10, v198
    v_mfma_f32_16x16x32_bf16 v[212:215], v[228:231], v[180:183], v[212:215]
    v_add_f32 v10, v10, v199
    v_cvt_pk_bf16_f32 v143, v198, v199
    s_waitcnt vmcnt(4)
    s_barrier
    ds_read_b128 v[232:235], v5 offset:0
    ds_read_b128 v[236:239], v5 offset:1024
    ds_read_b128 v[240:243], v5 offset:2048
    ds_read_b128 v[244:247], v5 offset:3072
    v_exp_f32 v200, v200
    v_exp_f32 v201, v201
    v_add_f32 v9, v9, v200
    v_add_f32 v9, v9, v201
    v_cvt_pk_bf16_f32 v144, v200, v201
    v_exp_f32 v202, v202
    v_exp_f32 v203, v203
    v_add_f32 v9, v9, v202
    v_add_f32 v9, v9, v203
    v_cvt_pk_bf16_f32 v145, v202, v203
    v_exp_f32 v204, v204
    v_exp_f32 v205, v205
    v_add_f32 v10, v10, v204
    v_add_f32 v10, v10, v205
    v_cvt_pk_bf16_f32 v148, v204, v205
    v_exp_f32 v206, v206
    v_exp_f32 v207, v207
    v_add_f32 v10, v10, v206
    v_add_f32 v10, v10, v207
    v_cvt_pk_bf16_f32 v149, v206, v207
    v_exp_f32 v208, v208
    v_exp_f32 v209, v209
    v_add_f32 v9, v9, v208
    v_add_f32 v9, v9, v209
    v_cvt_pk_bf16_f32 v146, v208, v209
    v_exp_f32 v210, v210
    v_exp_f32 v211, v211
    v_add_f32 v9, v9, v210
    v_add_f32 v9, v9, v211
    v_cvt_pk_bf16_f32 v147, v210, v211
    v_exp_f32 v212, v212
    v_exp_f32 v213, v213
    v_add_f32 v10, v10, v212
    v_add_f32 v10, v10, v213
    v_cvt_pk_bf16_f32 v150, v212, v213
    v_exp_f32 v214, v214
    v_exp_f32 v215, v215
    v_add_f32 v10, v10, v214
    v_add_f32 v10, v10, v215
    v_cvt_pk_bf16_f32 v151, v214, v215
    v_mov_b32 v16, v9
    v_mov_b32 v18, v10
    s_nop 0
    v_permlane16_swap_b32 v9, v16
    v_permlane16_swap_b32 v10, v18
    v_add_f32 v9, v9, v16
    v_add_f32 v10, v10, v18
    v_mov_b32 v16, v9
    v_mov_b32 v18, v10
    s_nop 0
    v_permlane32_swap_b32 v9, v16
    v_permlane32_swap_b32 v10, v18
    v_add_f32 v9, v9, v16
    v_add_f32 v10, v10, v18
    v_max_f32 v17, v9, v10
    s_mov_b32 s16, 0x71800000
    v_cmp_ngt_f32 vcc, s16, v17
    v_cmp_u_f32 s[76:77], v9, v10
    s_or_b64 vcc, vcc, s[76:77]
    s_cbranch_vccnz adaLN_cond__sliding_block_cached__moe_arch_mod__prompt_kernel_fixB
adaLN_cond__sliding_block_cached__moe_arch_mod__prompt_kernel_fixBb:
    v_rcp_f32 v9, v9
    v_rcp_f32 v10, v10
    s_lshl_b32 s25, s13, 3
    s_add_u32 s25, s25, s3
    s_lshl_b32 s25, s25, 18
    s_lshl_b32 s26, s12, 12
    s_add_u32 s25, s25, s26
    s_add_u32 s25, s25, 0x1000000
    s_add_u32 s26, s25, 131072
    s_lshl_b32 s63, s13, 3
    s_add_u32 s63, s63, s3
    s_lshl_b32 s63, s63, 5
    s_add_u32 s63, s63, s12
    s_lshl_b32 s63, s63, 2
    s_waitcnt lgkmcnt(3)
    v_mfma_f32_16x16x32_bf16 v[184:187], v[232:235], v[24:27], 0
    v_mfma_f32_16x16x32_bf16 v[188:191], v[232:235], v[28:31], 0
    ds_read_b128 v[224:227], v5 offset:4096
    s_waitcnt lgkmcnt(3)
    v_mfma_f32_16x16x32_bf16 v[192:195], v[236:239], v[24:27], 0
    s_add_u32 s22, s21, 0x88000
    s_add_u32 m0, s20, 0x10000
    s_nop 0
    buffer_load_dwordx4 v2, s[8:11], s22 offen sc1 lds
    v_mfma_f32_16x16x32_bf16 v[196:199], v[236:239], v[28:31], 0
    ds_read_b128 v[228:231], v5 offset:5120
    s_waitcnt lgkmcnt(3)
    v_mfma_f32_16x16x32_bf16 v[184:187], v[240:243], v[32:35], v[184:187]
    v_mfma_f32_16x16x32_bf16 v[188:191], v[240:243], v[36:39], v[188:191]
    ds_read_b128 v[232:235], v5 offset:6144
    s_waitcnt lgkmcnt(3)
    v_mfma_f32_16x16x32_bf16 v[192:195], v[244:247], v[32:35], v[192:195]
    s_add_u32 s22, s21, 0x88400
    s_add_u32 m0, s20, 0x10400
    s_nop 0
    buffer_load_dwordx4 v2, s[8:11], s22 offen sc1 lds
    v_mfma_f32_16x16x32_bf16 v[196:199], v[244:247], v[36:39], v[196:199]
    ds_read_b128 v[236:239], v5 offset:7168
    s_waitcnt lgkmcnt(3)
    v_mfma_f32_16x16x32_bf16 v[184:187], v[224:227], v[40:43], v[184:187]
    v_mfma_f32_16x16x32_bf16 v[188:191], v[224:227], v[44:47], v[188:191]
    ds_read_b128 v[240:243], v5 offset:8192
    s_waitcnt lgkmcnt(3)
    v_mfma_f32_16x16x32_bf16 v[192:195], v[228:231], v[40:43], v[192:195]
    s_add_u32 s22, s21, 0x8c000
    s_add_u32 m0, s20, 0x14000
    s_nop 0
    buffer_load_dwordx4 v2, s[8:11], s22 offen sc1 lds
    v_mfma_f32_16x16x32_bf16 v[196:199], v[228:231], v[44:47], v[196:199]
    ds_read_b128 v[244:247], v5 offset:9216
    s_waitcnt lgkmcnt(3)
    v_mfma_f32_16x16x32_bf16 v[184:187], v[232:235], v[48:51], v[184:187]
    v_mfma_f32_16x16x32_bf16 v[188:191], v[232:235], v[52:55], v[188:191]
    ds_read_b128 v[224:227], v5 offset:10240
    s_waitcnt lgkmcnt(3)
    v_mfma_f32_16x16x32_bf16 v[192:195], v[236:239], v[48:51], v[192:195]
    s_add_u32 s22, s21, 0x8c400
    s_add_u32 m0, s20, 0x14400
    s_nop 0
    buffer_load_dwordx4 v2, s[8:11], s22 offen sc1 lds
    v_mfma_f32_16x16x32_bf16 v[196:199], v[236:239], v[52:55], v[196:199]
    ds_read_b128 v[228:231], v5 offset:11264
    s_waitcnt lgkmcnt(3)
    v_mfma_f32_16x16x32_bf16 v[184:187], v[240:243], v[56:59], v[184:187]
    v_mfma_f32_16x16x32_bf16 v[188:191], v[240:243], v[60:63], v[188:191]
    ds_read_b128 v[232:235], v5 offset:12288
    s_waitcnt lgkmcnt(3)
    v_mfma_f32_16x16x32_bf16 v[192:195], v[244:247], v[56:59], v[192:195]
    s_add_u32 s22, s21, 0x90000
    s_add_u32 m0, s20, 0x18000
    s_nop 0
    buffer_load_dwordx4 v2, s[8:11], s22 offen sc1 lds
    v_mfma_f32_16x16x32_bf16 v[196:199], v[244:247], v[60:63], v[196:199]
    ds_read_b128 v[236:239], v5 offset:13312
    s_waitcnt lgkmcnt(3)
    v_mfma_f32_16x16x32_bf16 v[184:187], v[224:227], v[64:67], v[184:187]
    v_mfma_f32_16x16x32_bf16 v[188:191], v[224:227], v[68:71], v[188:191]
    ds_read_b128 v[240:243], v5 offset:14336
    s_waitcnt lgkmcnt(3)
    v_mfma_f32_16x16x32_bf16 v[192:195], v[228:231], v[64:67], v[192:195]
    s_add_u32 s22, s21, 0x90400
    s_add_u32 m0, s20, 0x18400
    s_nop 0
    buffer_load_dwordx4 v2, s[8:11], s22 offen sc1 lds
    s_waitcnt vmcnt(6)
    v_mfma_f32_16x16x32_bf16 v[196:199], v[228:231], v[68:71], v[196:199]
    ds_read_b128 v[244:247], v5 offset:15360
    s_waitcnt lgkmcnt(3)
    v_mfma_f32_16x16x32_bf16 v[184:187], v[232:235], v[72:75], v[184:187]
    v_mfma_f32_16x16x32_bf16 v[188:191], v[232:235], v[76:79], v[188:191]
    s_barrier
    ds_read_b128 v[224:227], v5 offset:16384
    s_waitcnt lgkmcnt(3)
    v_mfma_f32_16x16x32_bf16 v[192:195], v[236:239], v[72:75], v[192:195]
    v_mfma_f32_16x16x32_bf16 v[196:199], v[236:239], v[76:79], v[196:199]
    s_add_u32 s22, s21, 0x94000
    s_add_u32 m0, s20, 0x1c000
    s_nop 0
    buffer_load_dwordx4 v2, s[8:11], s22 offen sc1 lds
    ds_read_b128 v[228:231], v5 offset:17408
    s_waitcnt lgkmcnt(3)
    v_mfma_f32_16x16x32_bf16 v[184:187], v[240:243], v[80:83], v[184:187]
    v_mfma_f32_16x16x32_bf16 v[188:191], v[240:243], v[84:87], v[188:191]
    ds_read_b128 v[232:235], v5 offset:18432
    s_waitcnt lgkmcnt(3)
    v_mfma_f32_16x16x32_bf16 v[192:195], v[244:247], v[80:83], v[192:195]
    v_mfma_f32_16x16x32_bf16 v[196:199], v[244:247], v[84:87], v[196:199]
    ds_read_b128 v[236:239], v5 offset:19456
    s_waitcnt lgkmcnt(3)
    v_mfma_f32_16x16x32_bf16 v[184:187], v[224:227], v[88:91], v[184:187]
    v_mfma_f32_16x16x32_bf16 v[188:191], v[224:227], v[92:95], v[188:191]
    ds_read_b128 v[240:243], v5 offset:20480
    s_waitcnt lgkmcnt(3)
    v_mfma_f32_16x16x32_bf16 v[192:195], v[228:231], v[88:91], v[192:195]
    v_mfma_f32_16x16x32_bf16 v[196:199], v[228:231], v[92:95], v[196:199]
    s_add_u32 s22, s21, 0x94400
    s_add_u32 m0, s20, 0x1c400
    s_nop 0
    buffer_load_dwordx4 v2, s[8:11], s22 offen sc1 lds
    ds_read_b128 v[244:247], v5 offset:21504
    s_waitcnt lgkmcnt(3)
    v_mfma_f32_16x16x32_bf16 v[184:187], v[232:235], v[96:99], v[184:187]
    v_mfma_f32_16x16x32_bf16 v[188:191], v[232:235], v[100:103], v[188:191]
    ds_read_b128 v[224:227], v5 offset:22528
    s_waitcnt lgkmcnt(3)
    v_mfma_f32_16x16x32_bf16 v[192:195], v[236:239], v[96:99], v[192:195]
    v_mfma_f32_16x16x32_bf16 v[196:199], v[236:239], v[100:103], v[196:199]
    ds_read_b128 v[228:231], v5 offset:23552
    s_waitcnt lgkmcnt(3)
    v_mfma_f32_16x16x32_bf16 v[184:187], v[240:243], v[104:107], v[184:187]
    v_mfma_f32_16x16x32_bf16 v[188:191], v[240:243], v[108:111], v[188:191]
    ds_read_b128 v[232:235], v5 offset:24576
    s_waitcnt lgkmcnt(3)
    v_mfma_f32_16x16x32_bf16 v[192:195], v[244:247], v[104:107], v[192:195]
    v_mfma_f32_16x16x32_bf16 v[196:199], v[244:247], v[108:111], v[196:199]
    ds_read_b128 v[236:239], v5 offset:25600
    s_waitcnt lgkmcnt(3)
    v_mfma_f32_16x16x32_bf16 v[184:187], v[224:227], v[112:115], v[184:187]
    v_mfma_f32_16x16x32_bf16 v[188:191], v[224:227], v[116:119], v[188:191]
    ds_read_b128 v[240:243], v5 offset:26624
    s_waitcnt lgkmcnt(3)
    v_mfma_f32_16x16x32_bf16 v[192:195], v[228:231], v[112:115], v[192:195]
    v_mfma_f32_16x16x32_bf16 v[196:199], v[228:231], v[116:119], v[196:199]
    ds_read_b128 v[244:247], v5 offset:27648
    s_waitcnt lgkmcnt(3)
    v_mfma_f32_16x16x32_bf16 v[184:187], v[232:235], v[120:123], v[184:187]
    v_mfma_f32_16x16x32_bf16 v[188:191], v[232:235], v[124:127], v[188:191]
    ds_read_b128 v[224:227], v5 offset:28672
    s_waitcnt lgkmcnt(3)
    v_mfma_f32_16x16x32_bf16 v[192:195], v[236:239], v[120:123], v[192:195]
    v_mfma_f32_16x16x32_bf16 v[196:199], v[236:239], v[124:127], v[196:199]
    ds_read_b128 v[228:231], v5 offset:29696
    s_waitcnt lgkmcnt(3)
    v_mfma_f32_16x16x32_bf16 v[184:187], v[240:243], v[128:131], v[184:187]
    v_mfma_f32_16x16x32_bf16 v[188:191], v[240:243], v[132:135], v[188:191]
    ds_read_b128 v[232:235], v5 offset:30720
    s_waitcnt lgkmcnt(3)
    v_mfma_f32_16x16x32_bf16 v[192:195], v[244:247], v[128:131], v[192:195]
    v_mfma_f32_16x16x32_bf16 v[196:199], v[244:247], v[132:135], v[196:199]
    ds_read_b128 v[236:239], v5 offset:31744
    s_waitcnt lgkmcnt(3)
    v_mfma_f32_16x16x32_bf16 v[184:187], v[224:227], v[136:139], v[184:187]
    v_mfma_f32_16x16x32_bf16 v[188:191], v[224:227], v[140:143], v[188:191]
    s_waitcnt vmcnt(6)
    s_barrier
    ds_read_b128 v[240:243], v4 offset:0
    s_waitcnt lgkmcnt(3)
    v_mfma_f32_16x16x32_bf16 v[192:195], v[228:231], v[136:139], v[192:195]
    v_mfma_f32_16x16x32_bf16 v[196:199], v[228:231], v[140:143], v[196:199]
    s_add_u32 s22, s21, 0x98000
    s_add_u32 m0, s20, 0x20000
    s_nop 0
    buffer_load_dwordx4 v2, s[8:11], s22 offen sc1 lds
    ds_read_b128 v[244:247], v4 offset:1024
    s_waitcnt lgkmcnt(3)
    v_mfma_f32_16x16x32_bf16 v[184:187], v[232:235], v[144:147], v[184:187]
    v_mfma_f32_16x16x32_bf16 v[188:191], v[232:235], v[148:151], v[188:191]
    ds_read_b128 v[224:227], v4 offset:2048
    s_waitcnt lgkmcnt(3)
    v_mfma_f32_16x16x32_bf16 v[192:195], v[236:239], v[144:147], v[192:195]
    v_mfma_f32_16x16x32_bf16 v[196:199], v[236:239], v[148:151], v[196:199]
    ds_read_b128 v[228:231], v4 offset:3072
    s_waitcnt lgkmcnt(3)
    v_mfma_f32_16x16x32_bf16 v[200:203], v[240:243], v[24:27], 0
    v_mfma_f32_16x16x32_bf16 v[204:207], v[240:243], v[28:31], 0
    ds_read_b128 v[232:235], v4 offset:4096
    s_waitcnt lgkmcnt(3)
    v_mfma_f32_16x16x32_bf16 v[208:211], v[244:247], v[24:27], 0
    v_mfma_f32_16x16x32_bf16 v[212:215], v[244:247], v[28:31], 0
    s_add_u32 s22, s21, 0x98400
    s_add_u32 m0, s20, 0x20400
    s_nop 0
    buffer_load_dwordx4 v2, s[8:11], s22 offen sc1 lds
    ds_read_b128 v[236:239], v4 offset:5120
    v_mul_f32 v184, v184, v9
    s_waitcnt lgkmcnt(3)
    v_mfma_f32_16x16x32_bf16 v[200:203], v[224:227], v[32:35], v[200:203]
    v_mul_f32 v185, v185, v9
    v_mfma_f32_16x16x32_bf16 v[204:207], v[224:227], v[36:39], v[204:207]
    ds_read_b128 v[240:243], v4 offset:6144
    v_mul_f32 v186, v186, v9
    s_waitcnt lgkmcnt(3)
    v_mfma_f32_16x16x32_bf16 v[208:211], v[228:231], v[32:35], v[208:211]
    v_mul_f32 v187, v187, v9
    v_mfma_f32_16x16x32_bf16 v[212:215], v[228:231], v[36:39], v[212:215]
    ds_read_b128 v[244:247], v4 offset:7168
    v_mul_f32 v192, v192, v9
    s_waitcnt lgkmcnt(3)
    v_mfma_f32_16x16x32_bf16 v[200:203], v[232:235], v[40:43], v[200:203]
    v_mul_f32 v193, v193, v9
    v_mfma_f32_16x16x32_bf16 v[204:207], v[232:235], v[44:47], v[204:207]
    ds_read_b128 v[224:227], v4 offset:8192
    v_mul_f32 v194, v194, v9
    s_waitcnt lgkmcnt(3)
    v_mfma_f32_16x16x32_bf16 v[208:211], v[236:239], v[40:43], v[208:211]
    v_mul_f32 v195, v195, v9
    v_mfma_f32_16x16x32_bf16 v[212:215], v[236:239], v[44:47], v[212:215]
    ds_read_b128 v[228:231], v4 offset:9216
    v_cvt_pk_bf16_f32 v216, v184, v185
    s_waitcnt lgkmcnt(3)
    v_mfma_f32_16x16x32_bf16 v[200:203], v[240:243], v[48:51], v[200:203]
    v_cvt_pk_bf16_f32 v217, v186, v187
    v_mfma_f32_16x16x32_bf16 v[204:207], v[240:243], v[52:55], v[204:207]
    ds_read_b128 v[232:235], v4 offset:10240
    v_cvt_pk_bf16_f32 v218, v192, v193
    s_waitcnt lgkmcnt(3)
    v_mfma_f32_16x16x32_bf16 v[208:211], v[244:247], v[48:51], v[208:211]
    v_cvt_pk_bf16_f32 v219, v194, v195
    v_mfma_f32_16x16x32_bf16 v[212:215], v[244:247], v[52:55], v[212:215]
    ds_read_b128 v[236:239], v4 offset:11264
    buffer_store_dwordx4 v[216:219], v2, s[8:11], s25 offen offset:0 sc1
    s_waitcnt lgkmcnt(3)
    v_mfma_f32_16x16x32_bf16 v[200:203], v[224:227], v[56:59], v[200:203]
    v_mul_f32 v188, v188, v10
    v_mfma_f32_16x16x32_bf16 v[204:207], v[224:227], v[60:63], v[204:207]
    ds_read_b128 v[240:243], v4 offset:12288
    v_mul_f32 v189, v189, v10
    s_waitcnt lgkmcnt(3)
    v_mfma_f32_16x16x32_bf16 v[208:211], v[228:231], v[56:59], v[208:211]
    v_mul_f32 v190, v190, v10
    v_mfma_f32_16x16x32_bf16 v[212:215], v[228:231], v[60:63], v[212:215]
    ds_read_b128 v[244:247], v4 offset:13312
    v_mul_f32 v191, v191, v10
    s_waitcnt lgkmcnt(3)
    v_mfma_f32_16x16x32_bf16 v[200:203], v[232:235], v[64:67], v[200:203]
    v_mul_f32 v196, v196, v10
    v_mfma_f32_16x16x32_bf16 v[204:207], v[232:235], v[68:71], v[204:207]
    ds_read_b128 v[224:227], v4 offset:14336
    v_mul_f32 v197, v197, v10
    s_waitcnt lgkmcnt(3)
    v_mfma_f32_16x16x32_bf16 v[208:211], v[236:239], v[64:67], v[208:211]
    v_mul_f32 v198, v198, v10
    v_mfma_f32_16x16x32_bf16 v[212:215], v[236:239], v[68:71], v[212:215]
    ds_read_b128 v[228:231], v4 offset:15360
    v_mul_f32 v199, v199, v10
    s_waitcnt lgkmcnt(3)
    v_mfma_f32_16x16x32_bf16 v[200:203], v[240:243], v[72:75], v[200:203]
    v_cvt_pk_bf16_f32 v220, v188, v189
    v_mfma_f32_16x16x32_bf16 v[204:207], v[240:243], v[76:79], v[204:207]
    s_waitcnt vmcnt(7)
    s_barrier
    ds_read_b128 v[232:235], v4 offset:16384
    v_cvt_pk_bf16_f32 v221, v190, v191
    s_waitcnt lgkmcnt(3)
    v_mfma_f32_16x16x32_bf16 v[208:211], v[244:247], v[72:75], v[208:211]
    v_cvt_pk_bf16_f32 v222, v196, v197
    v_mfma_f32_16x16x32_bf16 v[212:215], v[244:247], v[76:79], v[212:215]
    s_add_u32 s22, s21, 0x9c000
    s_add_u32 m0, s20, 0x24000
    s_nop 0
    buffer_load_dwordx4 v2, s[8:11], s22 offen sc1 lds
    ds_read_b128 v[236:239], v4 offset:17408
    v_cvt_pk_bf16_f32 v223, v198, v199
    s_waitcnt lgkmcnt(3)
    v_mfma_f32_16x16x32_bf16 v[200:203], v[224:227], v[80:83], v[200:203]
    buffer_store_dwordx4 v[220:223], v2, s[8:11], s26 offen offset:0 sc1
    v_mfma_f32_16x16x32_bf16 v[204:207], v[224:227], v[84:87], v[204:207]
    ds_read_b128 v[240:243], v4 offset:18432
    s_waitcnt lgkmcnt(3)
    v_mfma_f32_16x16x32_bf16 v[208:211], v[228:231], v[80:83], v[208:211]
    v_mfma_f32_16x16x32_bf16 v[212:215], v[228:231], v[84:87], v[212:215]
    ds_read_b128 v[244:247], v4 offset:19456
    s_waitcnt lgkmcnt(3)
    v_mfma_f32_16x16x32_bf16 v[200:203], v[232:235], v[88:91], v[200:203]
    v_mfma_f32_16x16x32_bf16 v[204:207], v[232:235], v[92:95], v[204:207]
    ds_read_b128 v[224:227], v4 offset:20480
    s_waitcnt lgkmcnt(3)
    v_mfma_f32_16x16x32_bf16 v[208:211], v[236:239], v[88:91], v[208:211]
    v_mfma_f32_16x16x32_bf16 v[212:215], v[236:239], v[92:95], v[212:215]
    s_add_u32 s22, s21, 0x9c400
    s_add_u32 m0, s20, 0x24400
    s_nop 0
    buffer_load_dwordx4 v2, s[8:11], s22 offen sc1 lds
    ds_read_b128 v[228:231], v4 offset:21504
    s_waitcnt lgkmcnt(3)
    v_mfma_f32_16x16x32_bf16 v[200:203], v[240:243], v[96:99], v[200:203]
    v_mfma_f32_16x16x32_bf16 v[204:207], v[240:243], v[100:103], v[204:207]
    ds_read_b128 v[232:235], v4 offset:22528
    s_waitcnt lgkmcnt(3)
    v_mfma_f32_16x16x32_bf16 v[208:211], v[244:247], v[96:99], v[208:211]
    v_mfma_f32_16x16x32_bf16 v[212:215], v[244:247], v[100:103], v[212:215]
    ds_read_b128 v[236:239], v4 offset:23552
    s_waitcnt lgkmcnt(3)
    v_mfma_f32_16x16x32_bf16 v[200:203], v[224:227], v[104:107], v[200:203]
    v_mfma_f32_16x16x32_bf16 v[204:207], v[224:227], v[108:111], v[204:207]
    ds_read_b128 v[240:243], v4 offset:24576
    s_waitcnt lgkmcnt(3)
    v_mfma_f32_16x16x32_bf16 v[208:211], v[228:231], v[104:107], v[208:211]
    v_mfma_f32_16x16x32_bf16 v[212:215], v[228:231], v[108:111], v[212:215]
    ds_read_b128 v[244:247], v4 offset:25600
    s_waitcnt lgkmcnt(3)
    v_mfma_f32_16x16x32_bf16 v[200:203], v[232:235], v[112:115], v[200:203]
    v_mfma_f32_16x16x32_bf16 v[204:207], v[232:235], v[116:119], v[204:207]
    ds_read_b128 v[224:227], v4 offset:26624
    s_waitcnt lgkmcnt(3)
    v_mfma_f32_16x16x32_bf16 v[208:211], v[236:239], v[112:115], v[208:211]
    v_mfma_f32_16x16x32_bf16 v[212:215], v[236:239], v[116:119], v[212:215]
    ds_read_b128 v[228:231], v4 offset:27648
    s_waitcnt lgkmcnt(3)
    v_mfma_f32_16x16x32_bf16 v[200:203], v[240:243], v[120:123], v[200:203]
    v_mfma_f32_16x16x32_bf16 v[204:207], v[240:243], v[124:127], v[204:207]
    ds_read_b128 v[232:235], v4 offset:28672
    s_waitcnt lgkmcnt(3)
    v_mfma_f32_16x16x32_bf16 v[208:211], v[244:247], v[120:123], v[208:211]
    v_mfma_f32_16x16x32_bf16 v[212:215], v[244:247], v[124:127], v[212:215]
    ds_read_b128 v[236:239], v4 offset:29696
    s_waitcnt lgkmcnt(3)
    v_mfma_f32_16x16x32_bf16 v[200:203], v[224:227], v[128:131], v[200:203]
    v_mfma_f32_16x16x32_bf16 v[204:207], v[224:227], v[132:135], v[204:207]
    ds_read_b128 v[240:243], v4 offset:30720
    s_waitcnt lgkmcnt(3)
    v_mfma_f32_16x16x32_bf16 v[208:211], v[228:231], v[128:131], v[208:211]
    v_mfma_f32_16x16x32_bf16 v[212:215], v[228:231], v[132:135], v[212:215]
    ds_read_b128 v[244:247], v4 offset:31744
    s_waitcnt lgkmcnt(3)
    v_mfma_f32_16x16x32_bf16 v[200:203], v[232:235], v[136:139], v[200:203]
    v_mfma_f32_16x16x32_bf16 v[204:207], v[232:235], v[140:143], v[204:207]
    s_waitcnt vmcnt(8)
    s_barrier
    ds_read_b128 v[224:227], v4 offset:32768
    s_waitcnt lgkmcnt(3)
    v_mfma_f32_16x16x32_bf16 v[208:211], v[236:239], v[136:139], v[208:211]
    v_mfma_f32_16x16x32_bf16 v[212:215], v[236:239], v[140:143], v[212:215]
    s_add_u32 s22, s24, 0x0
    s_add_u32 m0, s20, 0x10000
    s_nop 0
    buffer_load_dwordx4 v3, s[4:7], s22 offen lds
    ds_read_b128 v[228:231], v4 offset:33792
    s_waitcnt lgkmcnt(3)
    v_mfma_f32_16x16x32_bf16 v[200:203], v[240:243], v[144:147], v[200:203]
    v_mfma_f32_16x16x32_bf16 v[204:207], v[240:243], v[148:151], v[204:207]
    ds_read_b128 v[232:235], v4 offset:34816
    s_waitcnt lgkmcnt(3)
    v_mfma_f32_16x16x32_bf16 v[208:211], v[244:247], v[144:147], v[208:211]
    v_mfma_f32_16x16x32_bf16 v[212:215], v[244:247], v[148:151], v[212:215]
    ds_read_b128 v[236:239], v4 offset:35840
    s_waitcnt lgkmcnt(3)
    v_mfma_f32_16x16x32_bf16 v[184:187], v[224:227], v[24:27], 0
    v_mfma_f32_16x16x32_bf16 v[188:191], v[224:227], v[28:31], 0
    ds_read_b128 v[240:243], v4 offset:36864
    s_waitcnt lgkmcnt(3)
    v_mfma_f32_16x16x32_bf16 v[192:195], v[228:231], v[24:27], 0
    v_mfma_f32_16x16x32_bf16 v[196:199], v[228:231], v[28:31], 0
    s_add_u32 s22, s24, 0x2000
    s_add_u32 m0, s20, 0x10400
    s_nop 0
    buffer_load_dwordx4 v3, s[4:7], s22 offen lds
    ds_read_b128 v[244:247], v4 offset:37888
    v_mul_f32 v200, v200, v9
    s_waitcnt lgkmcnt(3)
    v_mfma_f32_16x16x32_bf16 v[184:187], v[232:235], v[32:35], v[184:187]
    v_mul_f32 v201, v201, v9
    v_mfma_f32_16x16x32_bf16 v[188:191], v[232:235], v[36:39], v[188:191]
    ds_read_b128 v[224:227], v4 offset:38912
    v_mul_f32 v202, v202, v9
    s_waitcnt lgkmcnt(3)
    v_mfma_f32_16x16x32_bf16 v[192:195], v[236:239], v[32:35], v[192:195]
    v_mul_f32 v203, v203, v9
    v_mfma_f32_16x16x32_bf16 v[196:199], v[236:239], v[36:39], v[196:199]
    ds_read_b128 v[228:231], v4 offset:39936
    v_mul_f32 v208, v208, v9
    s_waitcnt lgkmcnt(3)
    v_mfma_f32_16x16x32_bf16 v[184:187], v[240:243], v[40:43], v[184:187]
    v_mul_f32 v209, v209, v9
    v_mfma_f32_16x16x32_bf16 v[188:191], v[240:243], v[44:47], v[188:191]
    ds_read_b128 v[232:235], v4 offset:40960
    v_mul_f32 v210, v210, v9
    s_waitcnt lgkmcnt(3)
    v_mfma_f32_16x16x32_bf16 v[192:195], v[244:247], v[40:43], v[192:195]
    v_mul_f32 v211, v211, v9
    v_mfma_f32_16x16x32_bf16 v[196:199], v[244:247], v[44:47], v[196:199]
    ds_read_b128 v[236:239], v4 offset:41984
    v_cvt_pk_bf16_f32 v216, v200, v201
    s_waitcnt lgkmcnt(3)
    v_mfma_f32_16x16x32_bf16 v[184:187], v[224:227], v[48:51], v[184:187]
    v_cvt_pk_bf16_f32 v217, v202, v203
    s_waitcnt vmcnt(3)
    s_add_u32 s16, s63, 0x570000
    v_mov_b32 v7, s28
    v_mov_b32 v8, 0
    s_mov_b64 exec, 1
    buffer_store_dword v7, v8, s[8:11], s16 offen sc1
    s_mov_b64 exec, -1
    v_mfma_f32_16x16x32_bf16 v[188:191], v[224:227], v[52:55], v[188:191]
    ds_read_b128 v[240:243], v4 offset:43008
    v_cvt_pk_bf16_f32 v218, v208, v209
    s_waitcnt lgkmcnt(3)
    v_mfma_f32_16x16x32_bf16 v[192:195], v[228:231], v[48:51], v[192:195]
    v_cvt_pk_bf16_f32 v219, v210, v211
    v_mfma_f32_16x16x32_bf16 v[196:199], v[228:231], v[52:55], v[196:199]
    ds_read_b128 v[244:247], v4 offset:44032
    buffer_store_dwordx4 v[216:219], v2, s[8:11], s25 offen offset:1024 sc1
    s_waitcnt lgkmcnt(3)
    v_mfma_f32_16x16x32_bf16 v[184:187], v[232:235], v[56:59], v[184:187]
    v_mul_f32 v204, v204, v10
    v_mfma_f32_16x16x32_bf16 v[188:191], v[232:235], v[60:63], v[188:191]
    ds_read_b128 v[224:227], v4 offset:45056
    v_mul_f32 v205, v205, v10
    s_waitcnt lgkmcnt(3)
    v_mfma_f32_16x16x32_bf16 v[192:195], v[236:239], v[56:59], v[192:195]
    v_mul_f32 v206, v206, v10
    v_mfma_f32_16x16x32_bf16 v[196:199], v[236:239], v[60:63], v[196:199]
    ds_read_b128 v[228:231], v4 offset:46080
    v_mul_f32 v207, v207, v10
    s_waitcnt lgkmcnt(3)
    v_mfma_f32_16x16x32_bf16 v[184:187], v[240:243], v[64:67], v[184:187]
    v_mul_f32 v212, v212, v10
    v_mfma_f32_16x16x32_bf16 v[188:191], v[240:243], v[68:71], v[188:191]
    ds_read_b128 v[232:235], v4 offset:47104
    v_mul_f32 v213, v213, v10
    s_waitcnt lgkmcnt(3)
    v_mfma_f32_16x16x32_bf16 v[192:195], v[244:247], v[64:67], v[192:195]
    v_mul_f32 v214, v214, v10
    v_mfma_f32_16x16x32_bf16 v[196:199], v[244:247], v[68:71], v[196:199]
    ds_read_b128 v[236:239], v4 offset:48128
    v_mul_f32 v215, v215, v10
    s_waitcnt lgkmcnt(3)
    v_mfma_f32_16x16x32_bf16 v[184:187], v[224:227], v[72:75], v[184:187]
    v_cvt_pk_bf16_f32 v220, v204, v205
    v_mfma_f32_16x16x32_bf16 v[188:191], v[224:227], v[76:79], v[188:191]
    s_barrier
    ds_read_b128 v[240:243], v4 offset:49152
    v_cvt_pk_bf16_f32 v221, v206, v207
    s_waitcnt lgkmcnt(3)
    v_mfma_f32_16x16x32_bf16 v[192:195], v[228:231], v[72:75], v[192:195]
    v_cvt_pk_bf16_f32 v222, v212, v213
    v_mfma_f32_16x16x32_bf16 v[196:199], v[228:231], v[76:79], v[196:199]
    s_add_u32 s22, s24, 0x80000
    s_add_u32 m0, s20, 0x14000
    s_nop 0
    buffer_load_dwordx4 v3, s[4:7], s22 offen lds
    ds_read_b128 v[244:247], v4 offset:50176
    v_cvt_pk_bf16_f32 v223, v214, v215
    s_waitcnt lgkmcnt(3)
    v_mfma_f32_16x16x32_bf16 v[184:187], v[232:235], v[80:83], v[184:187]
    buffer_store_dwordx4 v[220:223], v2, s[8:11], s26 offen offset:1024 sc1
    v_mfma_f32_16x16x32_bf16 v[188:191], v[232:235], v[84:87], v[188:191]
    ds_read_b128 v[224:227], v4 offset:51200
    s_waitcnt lgkmcnt(3)
    v_mfma_f32_16x16x32_bf16 v[192:195], v[236:239], v[80:83], v[192:195]
    v_mfma_f32_16x16x32_bf16 v[196:199], v[236:239], v[84:87], v[196:199]
    ds_read_b128 v[228:231], v4 offset:52224
    s_waitcnt lgkmcnt(3)
    v_mfma_f32_16x16x32_bf16 v[184:187], v[240:243], v[88:91], v[184:187]
    v_mfma_f32_16x16x32_bf16 v[188:191], v[240:243], v[92:95], v[188:191]
    ds_read_b128 v[232:235], v4 offset:53248
    s_waitcnt lgkmcnt(3)
    v_mfma_f32_16x16x32_bf16 v[192:195], v[244:247], v[88:91], v[192:195]
    v_mfma_f32_16x16x32_bf16 v[196:199], v[244:247], v[92:95], v[196:199]
    s_add_u32 s22, s24, 0x82000
    s_add_u32 m0, s20, 0x14400
    s_nop 0
    buffer_load_dwordx4 v3, s[4:7], s22 offen lds
    ds_read_b128 v[236:239], v4 offset:54272
    s_waitcnt lgkmcnt(3)
    v_mfma_f32_16x16x32_bf16 v[184:187], v[224:227], v[96:99], v[184:187]
    v_mfma_f32_16x16x32_bf16 v[188:191], v[224:227], v[100:103], v[188:191]
    ds_read_b128 v[240:243], v4 offset:55296
    s_waitcnt lgkmcnt(3)
    v_mfma_f32_16x16x32_bf16 v[192:195], v[228:231], v[96:99], v[192:195]
    v_mfma_f32_16x16x32_bf16 v[196:199], v[228:231], v[100:103], v[196:199]
    ds_read_b128 v[244:247], v4 offset:56320
    s_waitcnt lgkmcnt(3)
    v_mfma_f32_16x16x32_bf16 v[184:187], v[232:235], v[104:107], v[184:187]
    v_mfma_f32_16x16x32_bf16 v[188:191], v[232:235], v[108:111], v[188:191]
    ds_read_b128 v[224:227], v4 offset:57344
    s_waitcnt lgkmcnt(3)
    v_mfma_f32_16x16x32_bf16 v[192:195], v[236:239], v[104:107], v[192:195]
    v_mfma_f32_16x16x32_bf16 v[196:199], v[236:239], v[108:111], v[196:199]
    ds_read_b128 v[228:231], v4 offset:58368
    s_waitcnt lgkmcnt(3)
    v_mfma_f32_16x16x32_bf16 v[184:187], v[240:243], v[112:115], v[184:187]
    v_mfma_f32_16x16x32_bf16 v[188:191], v[240:243], v[116:119], v[188:191]
    ds_read_b128 v[232:235], v4 offset:59392
    s_waitcnt lgkmcnt(3)
    v_mfma_f32_16x16x32_bf16 v[192:195], v[244:247], v[112:115], v[192:195]
    v_mfma_f32_16x16x32_bf16 v[196:199], v[244:247], v[116:119], v[196:199]
    ds_read_b128 v[236:239], v4 offset:60416
    s_waitcnt lgkmcnt(3)
    v_mfma_f32_16x16x32_bf16 v[184:187], v[224:227], v[120:123], v[184:187]
    v_mfma_f32_16x16x32_bf16 v[188:191], v[224:227], v[124:127], v[188:191]
    ds_read_b128 v[240:243], v4 offset:61440
    s_waitcnt lgkmcnt(3)
    v_mfma_f32_16x16x32_bf16 v[192:195], v[228:231], v[120:123], v[192:195]
    v_mfma_f32_16x16x32_bf16 v[196:199], v[228:231], v[124:127], v[196:199]
    ds_read_b128 v[244:247], v4 offset:62464
    s_waitcnt lgkmcnt(3)
    v_mfma_f32_16x16x32_bf16 v[184:187], v[232:235], v[128:131], v[184:187]
    v_mfma_f32_16x16x32_bf16 v[188:191], v[232:235], v[132:135], v[188:191]
    ds_read_b128 v[224:227], v4 offset:63488
    s_waitcnt lgkmcnt(3)
    v_mfma_f32_16x16x32_bf16 v[192:195], v[236:239], v[128:131], v[192:195]
    v_mfma_f32_16x16x32_bf16 v[196:199], v[236:239], v[132:135], v[196:199]
    ds_read_b128 v[228:231], v4 offset:64512
    s_waitcnt lgkmcnt(3)
    v_mfma_f32_16x16x32_bf16 v[184:187], v[240:243], v[136:139], v[184:187]
    v_mfma_f32_16x16x32_bf16 v[188:191], v[240:243], v[140:143], v[188:191]
    s_barrier
    ds_read_b128 v[232:235], v5 offset:0
    s_waitcnt lgkmcnt(3)
    v_mfma_f32_16x16x32_bf16 v[192:195], v[244:247], v[136:139], v[192:195]
    v_mfma_f32_16x16x32_bf16 v[196:199], v[244:247], v[140:143], v[196:199]
    s_add_u32 s22, s24, 0x100000
    s_add_u32 m0, s20, 0x18000
    s_nop 0
    buffer_load_dwordx4 v3, s[4:7], s22 offen lds
    ds_read_b128 v[236:239], v5 offset:1024
    s_waitcnt lgkmcnt(3)
    v_mfma_f32_16x16x32_bf16 v[184:187], v[224:227], v[144:147], v[184:187]
    v_mfma_f32_16x16x32_bf16 v[188:191], v[224:227], v[148:151], v[188:191]
    ds_read_b128 v[240:243], v5 offset:2048
    s_waitcnt lgkmcnt(3)
    v_mfma_f32_16x16x32_bf16 v[192:195], v[228:231], v[144:147], v[192:195]
    v_mfma_f32_16x16x32_bf16 v[196:199], v[228:231], v[148:151], v[196:199]
    ds_read_b128 v[244:247], v5 offset:3072
    s_waitcnt lgkmcnt(3)
    v_mfma_f32_16x16x32_bf16 v[200:203], v[232:235], v[24:27], 0
    v_mfma_f32_16x16x32_bf16 v[204:207], v[232:235], v[28:31], 0
    ds_read_b128 v[224:227], v5 offset:4096
    s_waitcnt lgkmcnt(3)
    v_mfma_f32_16x16x32_bf16 v[208:211], v[236:239], v[24:27], 0
    v_mfma_f32_16x16x32_bf16 v[212:215], v[236:239], v[28:31], 0
    s_add_u32 s22, s24, 0x102000
    s_add_u32 m0, s20, 0x18400
    s_nop 0
    buffer_load_dwordx4 v3, s[4:7], s22 offen lds
    ds_read_b128 v[228:231], v5 offset:5120
    v_mul_f32 v184, v184, v9
    s_waitcnt lgkmcnt(3)
    v_mfma_f32_16x16x32_bf16 v[200:203], v[240:243], v[32:35], v[200:203]
    v_mul_f32 v185, v185, v9
    s_bfe_u32 s30, s2, 0x20001
    s_lshl_b32 s30, s30, 2
    s_bfe_u32 s17, s2, 0x20003
    s_add_u32 s30, s30, s17
    s_lshr_b32 s31, s2, 5
    s_and_b32 s17, s3, 3
    s_lshl_b32 s19, s30, 2
    s_add_u32 s19, s19, s17
    s_and_b32 s16, s2, 1
    s_lshl_b32 s17, s19, 18
    s_lshl_b32 s23, s16, 16
    s_add_u32 s17, s17, s23
    s_add_u32 s17, s17, 0x1001000
    v_add_u32 v6, s17, v2
    s_lshl_b32 s19, s19, 7
    s_lshl_b32 s23, s16, 6
    s_add_u32 s19, s19, s23
    s_add_u32 s19, s19, 0x570000
    v_and_b32 v13, 15, v1
    v_lshlrev_b32 v13, 2, v13
    buffer_load_dword v12, v13, s[8:11], s19 offen sc1
    v_mfma_f32_16x16x32_bf16 v[204:207], v[240:243], v[36:39], v[204:207]
    ds_read_b128 v[232:235], v5 offset:6144
    v_mul_f32 v186, v186, v9
    s_waitcnt lgkmcnt(3)
    v_mfma_f32_16x16x32_bf16 v[208:211], v[244:247], v[32:35], v[208:211]
    v_mul_f32 v187, v187, v9
    v_mfma_f32_16x16x32_bf16 v[212:215], v[244:247], v[36:39], v[212:215]
    ds_read_b128 v[236:239], v5 offset:7168
    v_mul_f32 v192, v192, v9
    s_waitcnt lgkmcnt(3)
    v_mfma_f32_16x16x32_bf16 v[200:203], v[224:227], v[40:43], v[200:203]
    v_mul_f32 v193, v193, v9
    v_mfma_f32_16x16x32_bf16 v[204:207], v[224:227], v[44:47], v[204:207]
    ds_read_b128 v[240:243], v5 offset:8192
    v_mul_f32 v194, v194, v9
    s_waitcnt lgkmcnt(3)
    v_mfma_f32_16x16x32_bf16 v[208:211], v[228:231], v[40:43], v[208:211]
    v_mul_f32 v195, v195, v9
    v_mfma_f32_16x16x32_bf16 v[212:215], v[228:231], v[44:47], v[212:215]
    ds_read_b128 v[244:247], v5 offset:9216
    v_cvt_pk_bf16_f32 v216, v184, v185
    s_waitcnt lgkmcnt(3)
    v_mfma_f32_16x16x32_bf16 v[200:203], v[232:235], v[48:51], v[200:203]
    v_cvt_pk_bf16_f32 v217, v186, v187
    v_mfma_f32_16x16x32_bf16 v[204:207], v[232:235], v[52:55], v[204:207]
    ds_read_b128 v[224:227], v5 offset:10240
    v_cvt_pk_bf16_f32 v218, v192, v193
    s_waitcnt lgkmcnt(3)
    v_mfma_f32_16x16x32_bf16 v[208:211], v[236:239], v[48:51], v[208:211]
    v_cvt_pk_bf16_f32 v219, v194, v195
    v_mfma_f32_16x16x32_bf16 v[212:215], v[236:239], v[52:55], v[212:215]
    ds_read_b128 v[228:231], v5 offset:11264
    buffer_store_dwordx4 v[216:219], v2, s[8:11], s25 offen offset:2048 sc1
    s_waitcnt lgkmcnt(3)
    v_mfma_f32_16x16x32_bf16 v[200:203], v[240:243], v[56:59], v[200:203]
    v_mul_f32 v188, v188, v10
    v_mfma_f32_16x16x32_bf16 v[204:207], v[240:243], v[60:63], v[204:207]
    ds_read_b128 v[232:235], v5 offset:12288
    v_mul_f32 v189, v189, v10
    s_waitcnt lgkmcnt(3)
    v_mfma_f32_16x16x32_bf16 v[208:211], v[244:247], v[56:59], v[208:211]
    v_mul_f32 v190, v190, v10
    v_mfma_f32_16x16x32_bf16 v[212:215], v[244:247], v[60:63], v[212:215]
    ds_read_b128 v[236:239], v5 offset:13312
    v_mul_f32 v191, v191, v10
    s_waitcnt lgkmcnt(3)
    v_mfma_f32_16x16x32_bf16 v[200:203], v[224:227], v[64:67], v[200:203]
    v_mul_f32 v196, v196, v10
    v_mfma_f32_16x16x32_bf16 v[204:207], v[224:227], v[68:71], v[204:207]
    ds_read_b128 v[240:243], v5 offset:14336
    v_mul_f32 v197, v197, v10
    s_waitcnt lgkmcnt(3)
    v_mfma_f32_16x16x32_bf16 v[208:211], v[228:231], v[64:67], v[208:211]
    v_mul_f32 v198, v198, v10
    v_mfma_f32_16x16x32_bf16 v[212:215], v[228:231], v[68:71], v[212:215]
    ds_read_b128 v[244:247], v5 offset:15360
    v_mul_f32 v199, v199, v10
    s_waitcnt lgkmcnt(3)
    v_mfma_f32_16x16x32_bf16 v[200:203], v[232:235], v[72:75], v[200:203]
    v_cvt_pk_bf16_f32 v220, v188, v189
    v_mfma_f32_16x16x32_bf16 v[204:207], v[232:235], v[76:79], v[204:207]
    s_waitcnt vmcnt(11)
    s_barrier
    ds_read_b128 v[224:227], v5 offset:16384
    v_cvt_pk_bf16_f32 v221, v190, v191
    s_waitcnt lgkmcnt(3)
    v_mfma_f32_16x16x32_bf16 v[208:211], v[236:239], v[72:75], v[208:211]
    v_cvt_pk_bf16_f32 v222, v196, v197
    v_mfma_f32_16x16x32_bf16 v[212:215], v[236:239], v[76:79], v[212:215]
    s_add_u32 s22, s24, 0x180000
    s_add_u32 m0, s20, 0x1c000
    s_nop 0
    buffer_load_dwordx4 v3, s[4:7], s22 offen lds
    ds_read_b128 v[228:231], v5 offset:17408
    v_cvt_pk_bf16_f32 v223, v198, v199
    s_waitcnt lgkmcnt(3)
    v_mfma_f32_16x16x32_bf16 v[200:203], v[240:243], v[80:83], v[200:203]
    buffer_store_dwordx4 v[220:223], v2, s[8:11], s26 offen offset:2048 sc1
    v_mfma_f32_16x16x32_bf16 v[204:207], v[240:243], v[84:87], v[204:207]
    ds_read_b128 v[232:235], v5 offset:18432
    s_waitcnt lgkmcnt(3)
    v_mfma_f32_16x16x32_bf16 v[208:211], v[244:247], v[80:83], v[208:211]
    v_mfma_f32_16x16x32_bf16 v[212:215], v[244:247], v[84:87], v[212:215]
    ds_read_b128 v[236:239], v5 offset:19456
    s_waitcnt lgkmcnt(3)
    v_mfma_f32_16x16x32_bf16 v[200:203], v[224:227], v[88:91], v[200:203]
    v_mfma_f32_16x16x32_bf16 v[204:207], v[224:227], v[92:95], v[204:207]
    ds_read_b128 v[240:243], v5 offset:20480
    s_waitcnt vmcnt(3)
    v_cmp_ne_u32 vcc, s28, v12
    s_cbranch_vccnz adaLN_cond__sliding_block_cached__moe_arch_mod__prompt_kernel_o17r
adaLN_cond__sliding_block_cached__moe_arch_mod__prompt_kernel_o17b:
    s_waitcnt lgkmcnt(3)
    v_mfma_f32_16x16x32_bf16 v[208:211], v[228:231], v[88:91], v[208:211]
    s_mov_b32 s23, 0x0
    buffer_load_dwordx4 v[24:27], v6, s[8:11], s23 offen offset:0 sc1
    v_mfma_f32_16x16x32_bf16 v[212:215], v[228:231], v[92:95], v[212:215]
    s_add_u32 s22, s24, 0x182000
    s_add_u32 m0, s20, 0x1c400
    s_nop 0
    buffer_load_dwordx4 v3, s[4:7], s22 offen lds
    ds_read_b128 v[244:247], v5 offset:21504
    s_waitcnt lgkmcnt(3)
    v_mfma_f32_16x16x32_bf16 v[200:203], v[232:235], v[96:99], v[200:203]
    v_mfma_f32_16x16x32_bf16 v[204:207], v[232:235], v[100:103], v[204:207]
    ds_read_b128 v[224:227], v5 offset:22528
    s_mov_b32 s23, 0x20000
    buffer_load_dwordx4 v[28:31], v6, s[8:11], s23 offen offset:0 sc1
    s_waitcnt lgkmcnt(3)
    v_mfma_f32_16x16x32_bf16 v[208:211], v[236:239], v[96:99], v[208:211]
    s_add_u32 s16, s63, 0x572000
    v_mov_b32 v14, s28
    v_mov_b32 v15, 0
    s_mov_b64 exec, 1
    buffer_store_dword v14, v15, s[8:11], s16 offen sc1
    s_mov_b64 exec, -1
    v_mfma_f32_16x16x32_bf16 v[212:215], v[236:239], v[100:103], v[212:215]
    ds_read_b128 v[228:231], v5 offset:23552
    s_waitcnt lgkmcnt(3)
    v_mfma_f32_16x16x32_bf16 v[200:203], v[240:243], v[104:107], v[200:203]
    s_mov_b32 s23, 0x2000
    buffer_load_dwordx4 v[32:35], v6, s[8:11], s23 offen offset:0 sc1
    v_mfma_f32_16x16x32_bf16 v[204:207], v[240:243], v[108:111], v[204:207]
    ds_read_b128 v[232:235], v5 offset:24576
    s_waitcnt lgkmcnt(3)
    v_mfma_f32_16x16x32_bf16 v[208:211], v[244:247], v[104:107], v[208:211]
    v_mfma_f32_16x16x32_bf16 v[212:215], v[244:247], v[108:111], v[212:215]
    ds_read_b128 v[236:239], v5 offset:25600
    s_mov_b32 s23, 0x22000
    buffer_load_dwordx4 v[36:39], v6, s[8:11], s23 offen offset:0 sc1
    s_waitcnt lgkmcnt(3)
    v_mfma_f32_16x16x32_bf16 v[200:203], v[224:227], v[112:115], v[200:203]
    v_mfma_f32_16x16x32_bf16 v[204:207], v[224:227], v[116:119], v[204:207]
    ds_read_b128 v[240:243], v5 offset:26624
    s_waitcnt lgkmcnt(3)
    v_mfma_f32_16x16x32_bf16 v[208:211], v[228:231], v[112:115], v[208:211]
    s_mov_b32 s23, 0x4000
    buffer_load_dwordx4 v[40:43], v6, s[8:11], s23 offen offset:0 sc1
    v_mfma_f32_16x16x32_bf16 v[212:215], v[228:231], v[116:119], v[212:215]
    ds_read_b128 v[244:247], v5 offset:27648
    s_waitcnt lgkmcnt(3)
    v_mfma_f32_16x16x32_bf16 v[200:203], v[232:235], v[120:123], v[200:203]
    v_mfma_f32_16x16x32_bf16 v[204:207], v[232:235], v[124:127], v[204:207]
    ds_read_b128 v[224:227], v5 offset:28672
    s_mov_b32 s23, 0x24000
    buffer_load_dwordx4 v[44:47], v6, s[8:11], s23 offen offset:0 sc1
    s_waitcnt lgkmcnt(3)
    v_mfma_f32_16x16x32_bf16 v[208:211], v[236:239], v[120:123], v[208:211]
    v_mfma_f32_16x16x32_bf16 v[212:215], v[236:239], v[124:127], v[212:215]
    ds_read_b128 v[228:231], v5 offset:29696
    s_waitcnt lgkmcnt(3)
    v_mfma_f32_16x16x32_bf16 v[200:203], v[240:243], v[128:131], v[200:203]
    s_mov_b32 s23, 0x6000
    buffer_load_dwordx4 v[48:51], v6, s[8:11], s23 offen offset:0 sc1
    v_mfma_f32_16x16x32_bf16 v[204:207], v[240:243], v[132:135], v[204:207]
    ds_read_b128 v[232:235], v5 offset:30720
    s_waitcnt lgkmcnt(3)
    v_mfma_f32_16x16x32_bf16 v[208:211], v[244:247], v[128:131], v[208:211]
    v_mfma_f32_16x16x32_bf16 v[212:215], v[244:247], v[132:135], v[212:215]
    ds_read_b128 v[236:239], v5 offset:31744
    s_mov_b32 s23, 0x26000
    buffer_load_dwordx4 v[52:55], v6, s[8:11], s23 offen offset:0 sc1
    s_waitcnt lgkmcnt(3)
    v_mfma_f32_16x16x32_bf16 v[200:203], v[224:227], v[136:139], v[200:203]
    v_bfe_u32 v18, v1, 2, 2
    v_lshrrev_b32 v19, 4, v1
    v_mfma_f32_16x16x32_bf16 v[204:207], v[224:227], v[140:143], v[204:207]
    v_and_b32 v17, 3, v1
    v_lshlrev_b32 v16, 11, v19
    s_waitcnt lgkmcnt(2)
    v_mfma_f32_16x16x32_bf16 v[208:211], v[228:231], v[136:139], v[208:211]
    v_lshl_add_u32 v16, v18, 6, v16
    v_lshl_add_u32 v16, v17, 3, v16
    v_mfma_f32_16x16x32_bf16 v[212:215], v[228:231], v[140:143], v[212:215]
    v_add_u32 v16, 0x12000, v16
    v_and_b32 v19, 1, v19
    s_waitcnt lgkmcnt(1)
    v_mfma_f32_16x16x32_bf16 v[200:203], v[232:235], v[144:147], v[200:203]
    v_lshlrev_b32 v19, 5, v19
    v_sub_u32 v5, v16, v19
    v_mfma_f32_16x16x32_bf16 v[204:207], v[232:235], v[148:151], v[204:207]
    v_add_u32 v4, v16, v19
    v_add_u32 v7, 0x10000, v4
    s_waitcnt lgkmcnt(0)
    v_mfma_f32_16x16x32_bf16 v[208:211], v[236:239], v[144:147], v[208:211]
    v_add_u32 v8, 0x10000, v5
    v_mfma_f32_16x16x32_bf16 v[212:215], v[236:239], v[148:151], v[212:215]
    v_mul_f32 v200, v200, v9
    v_mul_f32 v201, v201, v9
    v_mul_f32 v202, v202, v9
    v_mul_f32 v203, v203, v9
    s_nop 1
    v_mul_f32 v208, v208, v9
    v_mul_f32 v209, v209, v9
    v_mul_f32 v210, v210, v9
    v_mul_f32 v211, v211, v9
    v_cvt_pk_bf16_f32 v216, v200, v201
    v_cvt_pk_bf16_f32 v217, v202, v203
    v_cvt_pk_bf16_f32 v218, v208, v209
    v_cvt_pk_bf16_f32 v219, v210, v211
    buffer_store_dwordx4 v[216:219], v2, s[8:11], s25 offen offset:3072 sc1
    v_mul_f32 v204, v204, v10
    v_mul_f32 v205, v205, v10
    v_mul_f32 v206, v206, v10
    v_mul_f32 v207, v207, v10
    v_mul_f32 v212, v212, v10
    v_mul_f32 v213, v213, v10
    v_mul_f32 v214, v214, v10
    v_mul_f32 v215, v215, v10
    v_cvt_pk_bf16_f32 v220, v204, v205
    v_cvt_pk_bf16_f32 v221, v206, v207
    v_cvt_pk_bf16_f32 v222, v212, v213
    v_cvt_pk_bf16_f32 v223, v214, v215
    buffer_store_dwordx4 v[220:223], v2, s[8:11], s26 offen offset:3072 sc1
    s_and_b32 s15, s2, 1
    s_barrier
    ds_read_b64_tr_b16 v[224:225], v4 offset:0
    ds_read_b64_tr_b16 v[226:227], v4 offset:1024
    ds_read_b64_tr_b16 v[228:229], v5 offset:32
    ds_read_b64_tr_b16 v[230:231], v5 offset:1056
    ds_read_b64_tr_b16 v[232:233], v4 offset:256
    ds_read_b64_tr_b16 v[234:235], v4 offset:1280
    ds_read_b64_tr_b16 v[236:237], v5 offset:288
    ds_read_b64_tr_b16 v[238:239], v5 offset:1312
    s_waitcnt vmcnt(11) lgkmcnt(6)
    v_mfma_f32_16x16x32_bf16 v[88:91], v[224:227], v[24:27], 0
    ds_read_b64_tr_b16 v[240:241], v4 offset:512
    s_waitcnt vmcnt(9)
    v_mfma_f32_16x16x32_bf16 v[92:95], v[224:227], v[28:31], 0
    s_add_u32 s22, s24, 0x200000
    s_add_u32 m0, s20, 0x20000
    s_nop 0
    buffer_load_dwordx4 v3, s[4:7], s22 offen lds
    ds_read_b64_tr_b16 v[242:243], v4 offset:1536
    s_waitcnt lgkmcnt(6)
    v_mfma_f32_16x16x32_bf16 v[96:99], v[228:231], v[24:27], 0
    ds_read_b64_tr_b16 v[244:245], v5 offset:544
    s_mov_b32 s23, 0x8000
    buffer_load_dwordx4 v[56:59], v6, s[8:11], s23 offen offset:0 sc1
    v_mfma_f32_16x16x32_bf16 v[100:103], v[228:231], v[28:31], 0
    ds_read_b64_tr_b16 v[246:247], v5 offset:1568
    s_waitcnt lgkmcnt(6)
    v_mfma_f32_16x16x32_bf16 v[104:107], v[232:235], v[24:27], 0
    ds_read_b64_tr_b16 v[224:225], v4 offset:768
    v_mfma_f32_16x16x32_bf16 v[108:111], v[232:235], v[28:31], 0
    ds_read_b64_tr_b16 v[226:227], v4 offset:1792
    s_waitcnt lgkmcnt(6)
    v_mfma_f32_16x16x32_bf16 v[112:115], v[236:239], v[24:27], 0
    ds_read_b64_tr_b16 v[228:229], v5 offset:800
    v_mfma_f32_16x16x32_bf16 v[116:119], v[236:239], v[28:31], 0
    ds_read_b64_tr_b16 v[230:231], v5 offset:1824
    s_waitcnt lgkmcnt(6)
    v_mfma_f32_16x16x32_bf16 v[120:123], v[240:243], v[24:27], 0
    s_add_u32 s22, s24, 0x202000
    s_add_u32 m0, s20, 0x20400
    s_nop 0
    buffer_load_dwordx4 v3, s[4:7], s22 offen lds
    s_mov_b32 s23, 0x28000
    buffer_load_dwordx4 v[60:63], v6, s[8:11], s23 offen offset:0 sc1
    v_mfma_f32_16x16x32_bf16 v[124:127], v[240:243], v[28:31], 0
    s_barrier
    ds_read_b64_tr_b16 v[232:233], v4 offset:16384
    ds_read_b64_tr_b16 v[234:235], v4 offset:17408
    s_waitcnt lgkmcnt(6)
    v_mfma_f32_16x16x32_bf16 v[128:131], v[244:247], v[24:27], 0
    s_add_u32 s22, s24, 0x280000
    s_add_u32 m0, s20, 0x24000
    s_nop 0
    buffer_load_dwordx4 v3, s[4:7], s22 offen lds
    ds_read_b64_tr_b16 v[236:237], v5 offset:16416
    v_mfma_f32_16x16x32_bf16 v[132:135], v[244:247], v[28:31], 0
    ds_read_b64_tr_b16 v[238:239], v5 offset:17440
    s_waitcnt lgkmcnt(6)
    v_mfma_f32_16x16x32_bf16 v[136:139], v[224:227], v[24:27], 0
    ds_read_b64_tr_b16 v[240:241], v4 offset:16640
    v_mfma_f32_16x16x32_bf16 v[140:143], v[224:227], v[28:31], 0
    ds_read_b64_tr_b16 v[242:243], v4 offset:17664
    s_waitcnt lgkmcnt(6)
    v_mfma_f32_16x16x32_bf16 v[144:147], v[228:231], v[24:27], 0
    ds_read_b64_tr_b16 v[244:245], v5 offset:16672
    v_mfma_f32_16x16x32_bf16 v[148:151], v[228:231], v[28:31], 0
    ds_read_b64_tr_b16 v[246:247], v5 offset:17696
    s_waitcnt vmcnt(12) lgkmcnt(6)
    v_mfma_f32_16x16x32_bf16 v[88:91], v[232:235], v[32:35], v[88:91]
    ds_read_b64_tr_b16 v[224:225], v4 offset:16896
    s_waitcnt vmcnt(11)
    v_mfma_f32_16x16x32_bf16 v[92:95], v[232:235], v[36:39], v[92:95]
    s_add_u32 s22, s24, 0x282000
    s_add_u32 m0, s20, 0x24400
    s_nop 0
    buffer_load_dwordx4 v3, s[4:7], s22 offen lds
    ds_read_b64_tr_b16 v[226:227], v4 offset:17920
    s_waitcnt lgkmcnt(6)
    v_mfma_f32_16x16x32_bf16 v[96:99], v[236:239], v[32:35], v[96:99]
    ds_read_b64_tr_b16 v[228:229], v5 offset:16928
    s_mov_b32 s23, 0xa000
    buffer_load_dwordx4 v[24:27], v6, s[8:11], s23 offen offset:0 sc1
    v_mfma_f32_16x16x32_bf16 v[100:103], v[236:239], v[36:39], v[100:103]
    ds_read_b64_tr_b16 v[230:231], v5 offset:17952
    s_waitcnt lgkmcnt(6)
    v_mfma_f32_16x16x32_bf16 v[104:107], v[240:243], v[32:35], v[104:107]
    ds_read_b64_tr_b16 v[232:233], v4 offset:17152
    v_mfma_f32_16x16x32_bf16 v[108:111], v[240:243], v[36:39], v[108:111]
    ds_read_b64_tr_b16 v[234:235], v4 offset:18176
    s_waitcnt lgkmcnt(6)
    v_mfma_f32_16x16x32_bf16 v[112:115], v[244:247], v[32:35], v[112:115]
    ds_read_b64_tr_b16 v[236:237], v5 offset:17184
    v_mfma_f32_16x16x32_bf16 v[116:119], v[244:247], v[36:39], v[116:119]
    ds_read_b64_tr_b16 v[238:239], v5 offset:18208
    s_waitcnt lgkmcnt(6)
    v_mfma_f32_16x16x32_bf16 v[120:123], v[224:227], v[32:35], v[120:123]
    s_mov_b32 s23, 0x2a000
    buffer_load_dwordx4 v[28:31], v6, s[8:11], s23 offen offset:0 sc1
    v_mfma_f32_16x16x32_bf16 v[124:127], v[224:227], v[36:39], v[124:127]
    s_barrier
    ds_read_b64_tr_b16 v[240:241], v4 offset:32768
    ds_read_b64_tr_b16 v[242:243], v4 offset:33792
    s_waitcnt lgkmcnt(6)
    v_mfma_f32_16x16x32_bf16 v[128:131], v[228:231], v[32:35], v[128:131]
    s_add_u32 s22, s24, 0x300000
    s_add_u32 m0, s20, 0x10000
    s_nop 0
    buffer_load_dwordx4 v3, s[4:7], s22 offen lds
    ds_read_b64_tr_b16 v[244:245], v5 offset:32800
    v_mfma_f32_16x16x32_bf16 v[132:135], v[228:231], v[36:39], v[132:135]
    ds_read_b64_tr_b16 v[246:247], v5 offset:33824
    s_waitcnt lgkmcnt(6)
    v_mfma_f32_16x16x32_bf16 v[136:139], v[232:235], v[32:35], v[136:139]
    ds_read_b64_tr_b16 v[224:225], v4 offset:33024
    v_mfma_f32_16x16x32_bf16 v[140:143], v[232:235], v[36:39], v[140:143]
    ds_read_b64_tr_b16 v[226:227], v4 offset:34048
    s_waitcnt lgkmcnt(6)
    v_mfma_f32_16x16x32_bf16 v[144:147], v[236:239], v[32:35], v[144:147]
    s_add_u32 s16, s63, 0x574000
    v_mov_b32 v14, s28
    v_mov_b32 v15, 0
    s_mov_b64 exec, 1
    buffer_store_dword v14, v15, s[8:11], s16 offen sc1
    s_mov_b64 exec, -1
    ds_read_b64_tr_b16 v[228:229], v5 offset:33056
    v_mfma_f32_16x16x32_bf16 v[148:151], v[236:239], v[36:39], v[148:151]
    ds_read_b64_tr_b16 v[230:231], v5 offset:34080
    s_waitcnt vmcnt(15) lgkmcnt(6)
    v_mfma_f32_16x16x32_bf16 v[88:91], v[240:243], v[40:43], v[88:91]
    ds_read_b64_tr_b16 v[232:233], v4 offset:33280
    s_waitcnt vmcnt(14)
    v_mfma_f32_16x16x32_bf16 v[92:95], v[240:243], v[44:47], v[92:95]
    s_add_u32 s22, s24, 0x302000
    s_add_u32 m0, s20, 0x10400
    s_nop 0
    buffer_load_dwordx4 v3, s[4:7], s22 offen lds
    ds_read_b64_tr_b16 v[234:235], v4 offset:34304
    s_waitcnt lgkmcnt(6)
    v_mfma_f32_16x16x32_bf16 v[96:99], v[244:247], v[40:43], v[96:99]
    ds_read_b64_tr_b16 v[236:237], v5 offset:33312
    s_mov_b32 s23, 0xc000
    buffer_load_dwordx4 v[32:35], v6, s[8:11], s23 offen offset:0 sc1
    v_mfma_f32_16x16x32_bf16 v[100:103], v[244:247], v[44:47], v[100:103]
    ds_read_b64_tr_b16 v[238:239], v5 offset:34336
    s_waitcnt lgkmcnt(6)
    v_mfma_f32_16x16x32_bf16 v[104:107], v[224:227], v[40:43], v[104:107]
    ds_read_b64_tr_b16 v[240:241], v4 offset:33536
    v_mfma_f32_16x16x32_bf16 v[108:111], v[224:227], v[44:47], v[108:111]
    ds_read_b64_tr_b16 v[242:243], v4 offset:34560
    s_waitcnt lgkmcnt(6)
    v_mfma_f32_16x16x32_bf16 v[112:115], v[228:231], v[40:43], v[112:115]
    ds_read_b64_tr_b16 v[244:245], v5 offset:33568
    v_mfma_f32_16x16x32_bf16 v[116:119], v[228:231], v[44:47], v[116:119]
    ds_read_b64_tr_b16 v[246:247], v5 offset:34592
    s_waitcnt lgkmcnt(6)
    v_mfma_f32_16x16x32_bf16 v[120:123], v[232:235], v[40:43], v[120:123]
    s_mov_b32 s23, 0x2c000
    buffer_load_dwordx4 v[36:39], v6, s[8:11], s23 offen offset:0 sc1
    v_mfma_f32_16x16x32_bf16 v[124:127], v[232:235], v[44:47], v[124:127]
    s_barrier
    ds_read_b64_tr_b16 v[224:225], v4 offset:49152
    ds_read_b64_tr_b16 v[226:227], v4 offset:50176
    s_add_u32 s19, s19, 8192
    buffer_load_dword v12, v13, s[8:11], s19 offen sc1
    s_waitcnt lgkmcnt(6)
    v_mfma_f32_16x16x32_bf16 v[128:131], v[236:239], v[40:43], v[128:131]
    s_add_u32 s22, s24, 0x380000
    s_add_u32 m0, s20, 0x14000
    s_nop 0
    buffer_load_dwordx4 v3, s[4:7], s22 offen lds
    ds_read_b64_tr_b16 v[228:229], v5 offset:49184
    v_mfma_f32_16x16x32_bf16 v[132:135], v[236:239], v[44:47], v[132:135]
    ds_read_b64_tr_b16 v[230:231], v5 offset:50208
    s_waitcnt lgkmcnt(6)
    v_mfma_f32_16x16x32_bf16 v[136:139], v[240:243], v[40:43], v[136:139]
    ds_read_b64_tr_b16 v[232:233], v4 offset:49408
    v_mfma_f32_16x16x32_bf16 v[140:143], v[240:243], v[44:47], v[140:143]
    ds_read_b64_tr_b16 v[234:235], v4 offset:50432
    s_waitcnt lgkmcnt(6)
    v_mfma_f32_16x16x32_bf16 v[144:147], v[244:247], v[40:43], v[144:147]
    ds_read_b64_tr_b16 v[236:237], v5 offset:49440
    v_mfma_f32_16x16x32_bf16 v[148:151], v[244:247], v[44:47], v[148:151]
    ds_read_b64_tr_b16 v[238:239], v5 offset:50464
    s_waitcnt vmcnt(18) lgkmcnt(6)
    v_mfma_f32_16x16x32_bf16 v[88:91], v[224:227], v[48:51], v[88:91]
    ds_read_b64_tr_b16 v[240:241], v4 offset:49664
    s_waitcnt vmcnt(17)
    v_mfma_f32_16x16x32_bf16 v[92:95], v[224:227], v[52:55], v[92:95]
    s_add_u32 s22, s24, 0x382000
    s_add_u32 m0, s20, 0x14400
    s_nop 0
    buffer_load_dwordx4 v3, s[4:7], s22 offen lds
    ds_read_b64_tr_b16 v[242:243], v4 offset:50688
    s_waitcnt lgkmcnt(6)
    v_mfma_f32_16x16x32_bf16 v[96:99], v[228:231], v[48:51], v[96:99]
    ds_read_b64_tr_b16 v[244:245], v5 offset:49696
    s_mov_b32 s23, 0xe000
    buffer_load_dwordx4 v[40:43], v6, s[8:11], s23 offen offset:0 sc1
    v_mfma_f32_16x16x32_bf16 v[100:103], v[228:231], v[52:55], v[100:103]
    ds_read_b64_tr_b16 v[246:247], v5 offset:50720
    s_waitcnt lgkmcnt(6)
    v_mfma_f32_16x16x32_bf16 v[104:107], v[232:235], v[48:51], v[104:107]
    ds_read_b64_tr_b16 v[224:225], v4 offset:49920
    v_mfma_f32_16x16x32_bf16 v[108:111], v[232:235], v[52:55], v[108:111]
    ds_read_b64_tr_b16 v[226:227], v4 offset:50944
    s_waitcnt lgkmcnt(6)
    v_mfma_f32_16x16x32_bf16 v[112:115], v[236:239], v[48:51], v[112:115]
    ds_read_b64_tr_b16 v[228:229], v5 offset:49952
    v_mfma_f32_16x16x32_bf16 v[116:119], v[236:239], v[52:55], v[116:119]
    ds_read_b64_tr_b16 v[230:231], v5 offset:50976
    s_waitcnt lgkmcnt(6)
    v_mfma_f32_16x16x32_bf16 v[120:123], v[240:243], v[48:51], v[120:123]
    s_mov_b32 s23, 0x2e000
    buffer_load_dwordx4 v[44:47], v6, s[8:11], s23 offen offset:0 sc1
    v_mfma_f32_16x16x32_bf16 v[124:127], v[240:243], v[52:55], v[124:127]
    s_waitcnt vmcnt(15)
    s_barrier
    ds_read_b64_tr_b16 v[232:233], v7 offset:0
    ds_read_b64_tr_b16 v[234:235], v7 offset:1024
    s_waitcnt lgkmcnt(6)
    v_mfma_f32_16x16x32_bf16 v[128:131], v[244:247], v[48:51], v[128:131]
    s_add_u32 s22, s24, 0x10000
    s_add_u32 m0, s20, 0x18000
    s_nop 0
    buffer_load_dwordx4 v3, s[4:7], s22 offen lds
    ds_read_b64_tr_b16 v[236:237], v8 offset:32
    v_mfma_f32_16x16x32_bf16 v[132:135], v[244:247], v[52:55], v[132:135]
    ds_read_b64_tr_b16 v[238:239], v8 offset:1056
    s_waitcnt lgkmcnt(6)
    v_mfma_f32_16x16x32_bf16 v[136:139], v[224:227], v[48:51], v[136:139]
    ds_read_b64_tr_b16 v[240:241], v7 offset:256
    v_mfma_f32_16x16x32_bf16 v[140:143], v[224:227], v[52:55], v[140:143]
    ds_read_b64_tr_b16 v[242:243], v7 offset:1280
    s_waitcnt lgkmcnt(6)
    v_mfma_f32_16x16x32_bf16 v[144:147], v[228:231], v[48:51], v[144:147]
    ds_read_b64_tr_b16 v[244:245], v8 offset:288
    v_mfma_f32_16x16x32_bf16 v[148:151], v[228:231], v[52:55], v[148:151]
    ds_read_b64_tr_b16 v[246:247], v8 offset:1312
    s_waitcnt vmcnt(5)
    v_cmp_ne_u32 vcc, s28, v12
    s_cbranch_vccnz adaLN_cond__sliding_block_cached__moe_arch_mod__prompt_kernel_o218r
adaLN_cond__sliding_block_cached__moe_arch_mod__prompt_kernel_o218b:
    s_waitcnt lgkmcnt(6)
    v_mfma_f32_16x16x32_bf16 v[88:91], v[232:235], v[56:59], v[88:91]
    ds_read_b64_tr_b16 v[224:225], v7 offset:512
    v_mfma_f32_16x16x32_bf16 v[92:95], v[232:235], v[60:63], v[92:95]
    s_add_u32 s22, s24, 0x12000
    s_add_u32 m0, s20, 0x18400
    s_nop 0
    buffer_load_dwordx4 v3, s[4:7], s22 offen lds
    ds_read_b64_tr_b16 v[226:227], v7 offset:1536
    s_waitcnt lgkmcnt(6)
    v_mfma_f32_16x16x32_bf16 v[96:99], v[236:239], v[56:59], v[96:99]
    ds_read_b64_tr_b16 v[228:229], v8 offset:544
    s_mov_b32 s23, 0x0
    buffer_load_dwordx4 v[48:51], v6, s[8:11], s23 offen offset:1024 sc1
    v_mfma_f32_16x16x32_bf16 v[100:103], v[236:239], v[60:63], v[100:103]
    ds_read_b64_tr_b16 v[230:231], v8 offset:1568
    s_waitcnt lgkmcnt(6)
    v_mfma_f32_16x16x32_bf16 v[104:107], v[240:243], v[56:59], v[104:107]
    ds_read_b64_tr_b16 v[232:233], v7 offset:768
    v_mfma_f32_16x16x32_bf16 v[108:111], v[240:243], v[60:63], v[108:111]
    ds_read_b64_tr_b16 v[234:235], v7 offset:1792
    s_waitcnt lgkmcnt(6)
    v_mfma_f32_16x16x32_bf16 v[112:115], v[244:247], v[56:59], v[112:115]
    ds_read_b64_tr_b16 v[236:237], v8 offset:800
    v_mfma_f32_16x16x32_bf16 v[116:119], v[244:247], v[60:63], v[116:119]
    ds_read_b64_tr_b16 v[238:239], v8 offset:1824
    s_waitcnt lgkmcnt(6)
    v_mfma_f32_16x16x32_bf16 v[120:123], v[224:227], v[56:59], v[120:123]
    s_mov_b32 s23, 0x20000
    buffer_load_dwordx4 v[52:55], v6, s[8:11], s23 offen offset:1024 sc1
    v_mfma_f32_16x16x32_bf16 v[124:127], v[224:227], v[60:63], v[124:127]
    s_barrier
    ds_read_b64_tr_b16 v[240:241], v7 offset:16384
    ds_read_b64_tr_b16 v[242:243], v7 offset:17408
    s_waitcnt lgkmcnt(6)
    v_mfma_f32_16x16x32_bf16 v[128:131], v[228:231], v[56:59], v[128:131]
    s_add_u32 s22, s24, 0x90000
    s_add_u32 m0, s20, 0x1c000
    s_nop 0
    buffer_load_dwordx4 v3, s[4:7], s22 offen lds
    ds_read_b64_tr_b16 v[244:245], v8 offset:16416
    v_mfma_f32_16x16x32_bf16 v[132:135], v[228:231], v[60:63], v[132:135]
    ds_read_b64_tr_b16 v[246:247], v8 offset:17440
    s_waitcnt lgkmcnt(6)
    v_mfma_f32_16x16x32_bf16 v[136:139], v[232:235], v[56:59], v[136:139]
    ds_read_b64_tr_b16 v[224:225], v7 offset:16640
    v_mfma_f32_16x16x32_bf16 v[140:143], v[232:235], v[60:63], v[140:143]
    ds_read_b64_tr_b16 v[226:227], v7 offset:17664
    s_waitcnt lgkmcnt(6)
    v_mfma_f32_16x16x32_bf16 v[144:147], v[236:239], v[56:59], v[144:147]
    ds_read_b64_tr_b16 v[228:229], v8 offset:16672
    v_mfma_f32_16x16x32_bf16 v[148:151], v[236:239], v[60:63], v[148:151]
    ds_read_b64_tr_b16 v[230:231], v8 offset:17696
    s_waitcnt lgkmcnt(6)
    v_mfma_f32_16x16x32_bf16 v[88:91], v[240:243], v[24:27], v[88:91]
    ds_read_b64_tr_b16 v[232:233], v7 offset:16896
    v_mfma_f32_16x16x32_bf16 v[92:95], v[240:243], v[28:31], v[92:95]
    s_add_u32 s22, s24, 0x92000
    s_add_u32 m0, s20, 0x1c400
    s_nop 0
    buffer_load_dwordx4 v3, s[4:7], s22 offen lds
    ds_read_b64_tr_b16 v[234:235], v7 offset:17920
    s_waitcnt lgkmcnt(6)
    v_mfma_f32_16x16x32_bf16 v[96:99], v[244:247], v[24:27], v[96:99]
    ds_read_b64_tr_b16 v[236:237], v8 offset:16928
    s_mov_b32 s23, 0x2000
    buffer_load_dwordx4 v[56:59], v6, s[8:11], s23 offen offset:1024 sc1
    v_mfma_f32_16x16x32_bf16 v[100:103], v[244:247], v[28:31], v[100:103]
    ds_read_b64_tr_b16 v[238:239], v8 offset:17952
    s_waitcnt lgkmcnt(6)
    v_mfma_f32_16x16x32_bf16 v[104:107], v[224:227], v[24:27], v[104:107]
    ds_read_b64_tr_b16 v[240:241], v7 offset:17152
    v_mfma_f32_16x16x32_bf16 v[108:111], v[224:227], v[28:31], v[108:111]
    ds_read_b64_tr_b16 v[242:243], v7 offset:18176
    s_waitcnt lgkmcnt(6)
    v_mfma_f32_16x16x32_bf16 v[112:115], v[228:231], v[24:27], v[112:115]
    ds_read_b64_tr_b16 v[244:245], v8 offset:17184
    v_mfma_f32_16x16x32_bf16 v[116:119], v[228:231], v[28:31], v[116:119]
    ds_read_b64_tr_b16 v[246:247], v8 offset:18208
    s_waitcnt lgkmcnt(6)
    v_mfma_f32_16x16x32_bf16 v[120:123], v[232:235], v[24:27], v[120:123]
    s_mov_b32 s23, 0x22000
    buffer_load_dwordx4 v[60:63], v6, s[8:11], s23 offen offset:1024 sc1
    v_mfma_f32_16x16x32_bf16 v[124:127], v[232:235], v[28:31], v[124:127]
    s_barrier
    ds_read_b64_tr_b16 v[224:225], v4 offset:0
    ds_read_b64_tr_b16 v[226:227], v4 offset:1024
    s_waitcnt lgkmcnt(6)
    v_mfma_f32_16x16x32_bf16 v[128:131], v[236:239], v[24:27], v[128:131]
    s_add_u32 s16, s63, 0x576000
    v_mov_b32 v14, s28
    v_mov_b32 v15, 0
    s_mov_b64 exec, 1
    buffer_store_dword v14, v15, s[8:11], s16 offen sc1
    s_mov_b64 exec, -1
    s_add_u32 s22, s24, 0x110000
    s_add_u32 m0, s20, 0x20000
    s_nop 0
    buffer_load_dwordx4 v3, s[4:7], s22 offen lds
    ds_read_b64_tr_b16 v[228:229], v5 offset:32
    v_mfma_f32_16x16x32_bf16 v[132:135], v[236:239], v[28:31], v[132:135]
    ds_read_b64_tr_b16 v[230:231], v5 offset:1056
    s_waitcnt lgkmcnt(6)
    v_mfma_f32_16x16x32_bf16 v[136:139], v[240:243], v[24:27], v[136:139]
    ds_read_b64_tr_b16 v[232:233], v4 offset:256
    v_mfma_f32_16x16x32_bf16 v[140:143], v[240:243], v[28:31], v[140:143]
    ds_read_b64_tr_b16 v[234:235], v4 offset:1280
    s_waitcnt lgkmcnt(6)
    v_mfma_f32_16x16x32_bf16 v[144:147], v[244:247], v[24:27], v[144:147]
    ds_read_b64_tr_b16 v[236:237], v5 offset:288
    v_mfma_f32_16x16x32_bf16 v[148:151], v[244:247], v[28:31], v[148:151]
    ds_read_b64_tr_b16 v[238:239], v5 offset:1312
    s_waitcnt lgkmcnt(6)
    v_mfma_f32_16x16x32_bf16 v[88:91], v[224:227], v[32:35], v[88:91]
    ds_read_b64_tr_b16 v[240:241], v4 offset:512
    v_mfma_f32_16x16x32_bf16 v[92:95], v[224:227], v[36:39], v[92:95]
    s_add_u32 s22, s24, 0x112000
    s_add_u32 m0, s20, 0x20400
    s_nop 0
    buffer_load_dwordx4 v3, s[4:7], s22 offen lds
    ds_read_b64_tr_b16 v[242:243], v4 offset:1536
    s_waitcnt lgkmcnt(6)
    v_mfma_f32_16x16x32_bf16 v[96:99], v[228:231], v[32:35], v[96:99]
    ds_read_b64_tr_b16 v[244:245], v5 offset:544
    s_mov_b32 s23, 0x4000
    buffer_load_dwordx4 v[24:27], v6, s[8:11], s23 offen offset:1024 sc1
    v_mfma_f32_16x16x32_bf16 v[100:103], v[228:231], v[36:39], v[100:103]
    ds_read_b64_tr_b16 v[246:247], v5 offset:1568
    s_waitcnt lgkmcnt(6)
    v_mfma_f32_16x16x32_bf16 v[104:107], v[232:235], v[32:35], v[104:107]
    ds_read_b64_tr_b16 v[224:225], v4 offset:768
    v_mfma_f32_16x16x32_bf16 v[108:111], v[232:235], v[36:39], v[108:111]
    ds_read_b64_tr_b16 v[226:227], v4 offset:1792
    s_waitcnt lgkmcnt(6)
    v_mfma_f32_16x16x32_bf16 v[112:115], v[236:239], v[32:35], v[112:115]
    ds_read_b64_tr_b16 v[228:229], v5 offset:800
    v_mfma_f32_16x16x32_bf16 v[116:119], v[236:239], v[36:39], v[116:119]
    ds_read_b64_tr_b16 v[230:231], v5 offset:1824
    s_waitcnt lgkmcnt(6)
    v_mfma_f32_16x16x32_bf16 v[120:123], v[240:243], v[32:35], v[120:123]
    s_mov_b32 s23, 0x24000
    buffer_load_dwordx4 v[28:31], v6, s[8:11], s23 offen offset:1024 sc1
    v_mfma_f32_16x16x32_bf16 v[124:127], v[240:243], v[36:39], v[124:127]
    s_waitcnt vmcnt(15)
    s_barrier
    ds_read_b64_tr_b16 v[232:233], v4 offset:16384
    ds_read_b64_tr_b16 v[234:235], v4 offset:17408
    s_waitcnt lgkmcnt(6)
    v_mfma_f32_16x16x32_bf16 v[128:131], v[244:247], v[32:35], v[128:131]
    s_add_u32 s22, s24, 0x190000
    s_add_u32 m0, s20, 0x24000
    s_nop 0
    buffer_load_dwordx4 v3, s[4:7], s22 offen lds
    ds_read_b64_tr_b16 v[236:237], v5 offset:16416
    v_mfma_f32_16x16x32_bf16 v[132:135], v[244:247], v[36:39], v[132:135]
    ds_read_b64_tr_b16 v[238:239], v5 offset:17440
    s_waitcnt lgkmcnt(6)
    v_mfma_f32_16x16x32_bf16 v[136:139], v[224:227], v[32:35], v[136:139]
    ds_read_b64_tr_b16 v[240:241], v4 offset:16640
    v_mfma_f32_16x16x32_bf16 v[140:143], v[224:227], v[36:39], v[140:143]
    ds_read_b64_tr_b16 v[242:243], v4 offset:17664
    s_waitcnt lgkmcnt(6)
    v_mfma_f32_16x16x32_bf16 v[144:147], v[228:231], v[32:35], v[144:147]
    ds_read_b64_tr_b16 v[244:245], v5 offset:16672
    v_mfma_f32_16x16x32_bf16 v[148:151], v[228:231], v[36:39], v[148:151]
    ds_read_b64_tr_b16 v[246:247], v5 offset:17696
    s_waitcnt vmcnt(15) lgkmcnt(6)
    v_mfma_f32_16x16x32_bf16 v[88:91], v[232:235], v[40:43], v[88:91]
    ds_read_b64_tr_b16 v[224:225], v4 offset:16896
    s_waitcnt vmcnt(14)
    v_mfma_f32_16x16x32_bf16 v[92:95], v[232:235], v[44:47], v[92:95]
    s_add_u32 s22, s24, 0x192000
    s_add_u32 m0, s20, 0x24400
    s_nop 0
    buffer_load_dwordx4 v3, s[4:7], s22 offen lds
    ds_read_b64_tr_b16 v[226:227], v4 offset:17920
    s_waitcnt lgkmcnt(6)
    v_mfma_f32_16x16x32_bf16 v[96:99], v[236:239], v[40:43], v[96:99]
    ds_read_b64_tr_b16 v[228:229], v5 offset:16928
    s_mov_b32 s23, 0x6000
    buffer_load_dwordx4 v[32:35], v6, s[8:11], s23 offen offset:1024 sc1
    v_mfma_f32_16x16x32_bf16 v[100:103], v[236:239], v[44:47], v[100:103]
    ds_read_b64_tr_b16 v[230:231], v5 offset:17952
    s_waitcnt lgkmcnt(6)
    v_mfma_f32_16x16x32_bf16 v[104:107], v[240:243], v[40:43], v[104:107]
    ds_read_b64_tr_b16 v[232:233], v4 offset:17152
    v_mfma_f32_16x16x32_bf16 v[108:111], v[240:243], v[44:47], v[108:111]
    ds_read_b64_tr_b16 v[234:235], v4 offset:18176
    s_waitcnt lgkmcnt(6)
    v_mfma_f32_16x16x32_bf16 v[112:115], v[244:247], v[40:43], v[112:115]
    ds_read_b64_tr_b16 v[236:237], v5 offset:17184
    v_mfma_f32_16x16x32_bf16 v[116:119], v[244:247], v[44:47], v[116:119]
    ds_read_b64_tr_b16 v[238:239], v5 offset:18208
    s_waitcnt lgkmcnt(6)
    v_mfma_f32_16x16x32_bf16 v[120:123], v[224:227], v[40:43], v[120:123]
    s_mov_b32 s23, 0x26000
    buffer_load_dwordx4 v[36:39], v6, s[8:11], s23 offen offset:1024 sc1
    v_mfma_f32_16x16x32_bf16 v[124:127], v[224:227], v[44:47], v[124:127]
    s_waitcnt vmcnt(15)
    s_barrier
    ds_read_b64_tr_b16 v[240:241], v4 offset:32768
    ds_read_b64_tr_b16 v[242:243], v4 offset:33792
    s_waitcnt lgkmcnt(6)
    v_mfma_f32_16x16x32_bf16 v[128:131], v[228:231], v[40:43], v[128:131]
    s_add_u32 s22, s24, 0x210000
    s_add_u32 m0, s20, 0x10000
    s_nop 0
    buffer_load_dwordx4 v3, s[4:7], s22 offen lds
    ds_read_b64_tr_b16 v[244:245], v5 offset:32800
    v_mfma_f32_16x16x32_bf16 v[132:135], v[228:231], v[44:47], v[132:135]
    ds_read_b64_tr_b16 v[246:247], v5 offset:33824
    s_waitcnt lgkmcnt(6)
    v_mfma_f32_16x16x32_bf16 v[136:139], v[232:235], v[40:43], v[136:139]
    ds_read_b64_tr_b16 v[224:225], v4 offset:33024
    v_mfma_f32_16x16x32_bf16 v[140:143], v[232:235], v[44:47], v[140:143]
    ds_read_b64_tr_b16 v[226:227], v4 offset:34048
    s_waitcnt lgkmcnt(6)
    v_mfma_f32_16x16x32_bf16 v[144:147], v[236:239], v[40:43], v[144:147]
    ds_read_b64_tr_b16 v[228:229], v5 offset:33056
    v_mfma_f32_16x16x32_bf16 v[148:151], v[236:239], v[44:47], v[148:151]
    ds_read_b64_tr_b16 v[230:231], v5 offset:34080
    s_waitcnt vmcnt(15) lgkmcnt(6)
    v_mfma_f32_16x16x32_bf16 v[88:91], v[240:243], v[48:51], v[88:91]
    ds_read_b64_tr_b16 v[232:233], v4 offset:33280
    s_waitcnt vmcnt(14)
    v_mfma_f32_16x16x32_bf16 v[92:95], v[240:243], v[52:55], v[92:95]
    s_add_u32 s22, s24, 0x212000
    s_add_u32 m0, s20, 0x10400
    s_nop 0
    buffer_load_dwordx4 v3, s[4:7], s22 offen lds
    ds_read_b64_tr_b16 v[234:235], v4 offset:34304
    s_waitcnt lgkmcnt(6)
    v_mfma_f32_16x16x32_bf16 v[96:99], v[244:247], v[48:51], v[96:99]
    ds_read_b64_tr_b16 v[236:237], v5 offset:33312
    s_mov_b32 s23, 0x8000
    buffer_load_dwordx4 v[40:43], v6, s[8:11], s23 offen offset:1024 sc1
    v_mfma_f32_16x16x32_bf16 v[100:103], v[244:247], v[52:55], v[100:103]
    ds_read_b64_tr_b16 v[238:239], v5 offset:34336
    s_waitcnt lgkmcnt(6)
    v_mfma_f32_16x16x32_bf16 v[104:107], v[224:227], v[48:51], v[104:107]
    ds_read_b64_tr_b16 v[240:241], v4 offset:33536
    v_mfma_f32_16x16x32_bf16 v[108:111], v[224:227], v[52:55], v[108:111]
    ds_read_b64_tr_b16 v[242:243], v4 offset:34560
    s_waitcnt lgkmcnt(6)
    v_mfma_f32_16x16x32_bf16 v[112:115], v[228:231], v[48:51], v[112:115]
    ds_read_b64_tr_b16 v[244:245], v5 offset:33568
    v_mfma_f32_16x16x32_bf16 v[116:119], v[228:231], v[52:55], v[116:119]
    ds_read_b64_tr_b16 v[246:247], v5 offset:34592
    s_waitcnt lgkmcnt(6)
    v_mfma_f32_16x16x32_bf16 v[120:123], v[232:235], v[48:51], v[120:123]
    s_mov_b32 s23, 0x28000
    buffer_load_dwordx4 v[44:47], v6, s[8:11], s23 offen offset:1024 sc1
    v_mfma_f32_16x16x32_bf16 v[124:127], v[232:235], v[52:55], v[124:127]
    s_waitcnt vmcnt(15)
    s_barrier
    ds_read_b64_tr_b16 v[224:225], v4 offset:49152
    ds_read_b64_tr_b16 v[226:227], v4 offset:50176
    s_waitcnt lgkmcnt(6)
    v_mfma_f32_16x16x32_bf16 v[128:131], v[236:239], v[48:51], v[128:131]
    s_add_u32 s22, s24, 0x290000
    s_add_u32 m0, s20, 0x14000
    s_nop 0
    buffer_load_dwordx4 v3, s[4:7], s22 offen lds
    ds_read_b64_tr_b16 v[228:229], v5 offset:49184
    v_mfma_f32_16x16x32_bf16 v[132:135], v[236:239], v[52:55], v[132:135]
    ds_read_b64_tr_b16 v[230:231], v5 offset:50208
    s_waitcnt lgkmcnt(6)
    v_mfma_f32_16x16x32_bf16 v[136:139], v[240:243], v[48:51], v[136:139]
    ds_read_b64_tr_b16 v[232:233], v4 offset:49408
    v_mfma_f32_16x16x32_bf16 v[140:143], v[240:243], v[52:55], v[140:143]
    ds_read_b64_tr_b16 v[234:235], v4 offset:50432
    s_waitcnt lgkmcnt(6)
    v_mfma_f32_16x16x32_bf16 v[144:147], v[244:247], v[48:51], v[144:147]
    ds_read_b64_tr_b16 v[236:237], v5 offset:49440
    v_mfma_f32_16x16x32_bf16 v[148:151], v[244:247], v[52:55], v[148:151]
    ds_read_b64_tr_b16 v[238:239], v5 offset:50464
    s_waitcnt vmcnt(15) lgkmcnt(6)
    v_mfma_f32_16x16x32_bf16 v[88:91], v[224:227], v[56:59], v[88:91]
    ds_read_b64_tr_b16 v[240:241], v4 offset:49664
    s_waitcnt vmcnt(14)
    v_mfma_f32_16x16x32_bf16 v[92:95], v[224:227], v[60:63], v[92:95]
    s_add_u32 s22, s24, 0x292000
    s_add_u32 m0, s20, 0x14400
    s_nop 0
    buffer_load_dwordx4 v3, s[4:7], s22 offen lds
    ds_read_b64_tr_b16 v[242:243], v4 offset:50688
    s_waitcnt lgkmcnt(6)
    v_mfma_f32_16x16x32_bf16 v[96:99], v[228:231], v[56:59], v[96:99]
    ds_read_b64_tr_b16 v[244:245], v5 offset:49696
    s_mov_b32 s23, 0xa000
    buffer_load_dwordx4 v[48:51], v6, s[8:11], s23 offen offset:1024 sc1
    v_mfma_f32_16x16x32_bf16 v[100:103], v[228:231], v[60:63], v[100:103]
    ds_read_b64_tr_b16 v[246:247], v5 offset:50720
    s_waitcnt lgkmcnt(6)
    v_mfma_f32_16x16x32_bf16 v[104:107], v[232:235], v[56:59], v[104:107]
    ds_read_b64_tr_b16 v[224:225], v4 offset:49920
    v_mfma_f32_16x16x32_bf16 v[108:111], v[232:235], v[60:63], v[108:111]
    ds_read_b64_tr_b16 v[226:227], v4 offset:50944
    s_waitcnt lgkmcnt(6)
    v_mfma_f32_16x16x32_bf16 v[112:115], v[236:239], v[56:59], v[112:115]
    ds_read_b64_tr_b16 v[228:229], v5 offset:49952
    v_mfma_f32_16x16x32_bf16 v[116:119], v[236:239], v[60:63], v[116:119]
    ds_read_b64_tr_b16 v[230:231], v5 offset:50976
    s_waitcnt lgkmcnt(6)
    v_mfma_f32_16x16x32_bf16 v[120:123], v[240:243], v[56:59], v[120:123]
    s_mov_b32 s23, 0x2a000
    buffer_load_dwordx4 v[52:55], v6, s[8:11], s23 offen offset:1024 sc1
    v_mfma_f32_16x16x32_bf16 v[124:127], v[240:243], v[60:63], v[124:127]
    s_waitcnt vmcnt(14)
    s_barrier
    ds_read_b64_tr_b16 v[232:233], v7 offset:0
    ds_read_b64_tr_b16 v[234:235], v7 offset:1024
    s_waitcnt lgkmcnt(6)
    v_mfma_f32_16x16x32_bf16 v[128:131], v[244:247], v[56:59], v[128:131]
    s_add_u32 s22, s24, 0x310000
    s_add_u32 m0, s20, 0x18000
    s_nop 0
    buffer_load_dwordx4 v3, s[4:7], s22 offen lds
    ds_read_b64_tr_b16 v[236:237], v8 offset:32
    v_mfma_f32_16x16x32_bf16 v[132:135], v[244:247], v[60:63], v[132:135]
    ds_read_b64_tr_b16 v[238:239], v8 offset:1056
    s_waitcnt lgkmcnt(6)
    v_mfma_f32_16x16x32_bf16 v[136:139], v[224:227], v[56:59], v[136:139]
    ds_read_b64_tr_b16 v[240:241], v7 offset:256
    v_mfma_f32_16x16x32_bf16 v[140:143], v[224:227], v[60:63], v[140:143]
    ds_read_b64_tr_b16 v[242:243], v7 offset:1280
    s_waitcnt lgkmcnt(6)
    v_mfma_f32_16x16x32_bf16 v[144:147], v[228:231], v[56:59], v[144:147]
    ds_read_b64_tr_b16 v[244:245], v8 offset:288
    v_mfma_f32_16x16x32_bf16 v[148:151], v[228:231], v[60:63], v[148:151]
    ds_read_b64_tr_b16 v[246:247], v8 offset:1312
    s_waitcnt vmcnt(14) lgkmcnt(6)
    v_mfma_f32_16x16x32_bf16 v[88:91], v[232:235], v[24:27], v[88:91]
    ds_read_b64_tr_b16 v[224:225], v7 offset:512
    s_waitcnt vmcnt(13)
    v_mfma_f32_16x16x32_bf16 v[92:95], v[232:235], v[28:31], v[92:95]
    s_add_u32 s22, s24, 0x312000
    s_add_u32 m0, s20, 0x18400
    s_nop 0
    buffer_load_dwordx4 v3, s[4:7], s22 offen lds
    ds_read_b64_tr_b16 v[226:227], v7 offset:1536
    s_waitcnt lgkmcnt(6)
    v_mfma_f32_16x16x32_bf16 v[96:99], v[236:239], v[24:27], v[96:99]
    ds_read_b64_tr_b16 v[228:229], v8 offset:544
    s_mov_b32 s23, 0xc000
    buffer_load_dwordx4 v[56:59], v6, s[8:11], s23 offen offset:1024 sc1
    v_mfma_f32_16x16x32_bf16 v[100:103], v[236:239], v[28:31], v[100:103]
    ds_read_b64_tr_b16 v[230:231], v8 offset:1568
    s_waitcnt lgkmcnt(6)
    v_mfma_f32_16x16x32_bf16 v[104:107], v[240:243], v[24:27], v[104:107]
    ds_read_b64_tr_b16 v[232:233], v7 offset:768
    v_mfma_f32_16x16x32_bf16 v[108:111], v[240:243], v[28:31], v[108:111]
    ds_read_b64_tr_b16 v[234:235], v7 offset:1792
    s_waitcnt lgkmcnt(6)
    v_mfma_f32_16x16x32_bf16 v[112:115], v[244:247], v[24:27], v[112:115]
    ds_read_b64_tr_b16 v[236:237], v8 offset:800
    v_mfma_f32_16x16x32_bf16 v[116:119], v[244:247], v[28:31], v[116:119]
    ds_read_b64_tr_b16 v[238:239], v8 offset:1824
    s_waitcnt lgkmcnt(6)
    v_mfma_f32_16x16x32_bf16 v[120:123], v[224:227], v[24:27], v[120:123]
    s_mov_b32 s23, 0x2c000
    buffer_load_dwordx4 v[60:63], v6, s[8:11], s23 offen offset:1024 sc1
    v_mfma_f32_16x16x32_bf16 v[124:127], v[224:227], v[28:31], v[124:127]
    s_waitcnt vmcnt(14)
    s_barrier
    ds_read_b64_tr_b16 v[240:241], v7 offset:16384
    ds_read_b64_tr_b16 v[242:243], v7 offset:17408
    s_add_u32 s19, s19, 8192
    buffer_load_dword v12, v13, s[8:11], s19 offen sc1
    s_waitcnt lgkmcnt(6)
    v_mfma_f32_16x16x32_bf16 v[128:131], v[228:231], v[24:27], v[128:131]
    s_add_u32 s22, s24, 0x390000
    s_add_u32 m0, s20, 0x1c000
    s_nop 0
    buffer_load_dwordx4 v3, s[4:7], s22 offen lds
    ds_read_b64_tr_b16 v[244:245], v8 offset:16416
    v_mfma_f32_16x16x32_bf16 v[132:135], v[228:231], v[28:31], v[132:135]
    ds_read_b64_tr_b16 v[246:247], v8 offset:17440
    s_waitcnt lgkmcnt(6)
    v_mfma_f32_16x16x32_bf16 v[136:139], v[232:235], v[24:27], v[136:139]
    ds_read_b64_tr_b16 v[224:225], v7 offset:16640
    v_mfma_f32_16x16x32_bf16 v[140:143], v[232:235], v[28:31], v[140:143]
    ds_read_b64_tr_b16 v[226:227], v7 offset:17664
    s_waitcnt lgkmcnt(6)
    v_mfma_f32_16x16x32_bf16 v[144:147], v[236:239], v[24:27], v[144:147]
    ds_read_b64_tr_b16 v[228:229], v8 offset:16672
    v_mfma_f32_16x16x32_bf16 v[148:151], v[236:239], v[28:31], v[148:151]
    ds_read_b64_tr_b16 v[230:231], v8 offset:17696
    s_waitcnt vmcnt(15) lgkmcnt(6)
    v_mfma_f32_16x16x32_bf16 v[88:91], v[240:243], v[32:35], v[88:91]
    ds_read_b64_tr_b16 v[232:233], v7 offset:16896
    s_waitcnt vmcnt(14)
    v_mfma_f32_16x16x32_bf16 v[92:95], v[240:243], v[36:39], v[92:95]
    s_add_u32 s22, s24, 0x392000
    s_add_u32 m0, s20, 0x1c400
    s_nop 0
    buffer_load_dwordx4 v3, s[4:7], s22 offen lds
    ds_read_b64_tr_b16 v[234:235], v7 offset:17920
    s_waitcnt lgkmcnt(6)
    v_mfma_f32_16x16x32_bf16 v[96:99], v[244:247], v[32:35], v[96:99]
    ds_read_b64_tr_b16 v[236:237], v8 offset:16928
    s_mov_b32 s23, 0xe000
    buffer_load_dwordx4 v[24:27], v6, s[8:11], s23 offen offset:1024 sc1
    v_mfma_f32_16x16x32_bf16 v[100:103], v[244:247], v[36:39], v[100:103]
    ds_read_b64_tr_b16 v[238:239], v8 offset:17952
    s_waitcnt lgkmcnt(6)
    v_mfma_f32_16x16x32_bf16 v[104:107], v[224:227], v[32:35], v[104:107]
    ds_read_b64_tr_b16 v[240:241], v7 offset:17152
    v_mfma_f32_16x16x32_bf16 v[108:111], v[224:227], v[36:39], v[108:111]
    ds_read_b64_tr_b16 v[242:243], v7 offset:18176
    s_waitcnt lgkmcnt(6)
    v_mfma_f32_16x16x32_bf16 v[112:115], v[228:231], v[32:35], v[112:115]
    ds_read_b64_tr_b16 v[244:245], v8 offset:17184
    v_mfma_f32_16x16x32_bf16 v[116:119], v[228:231], v[36:39], v[116:119]
    ds_read_b64_tr_b16 v[246:247], v8 offset:18208
    s_waitcnt lgkmcnt(6)
    v_mfma_f32_16x16x32_bf16 v[120:123], v[232:235], v[32:35], v[120:123]
    s_mov_b32 s23, 0x2e000
    buffer_load_dwordx4 v[28:31], v6, s[8:11], s23 offen offset:1024 sc1
    v_mfma_f32_16x16x32_bf16 v[124:127], v[232:235], v[36:39], v[124:127]
    s_waitcnt vmcnt(15)
    s_barrier
    ds_read_b64_tr_b16 v[224:225], v4 offset:0
    ds_read_b64_tr_b16 v[226:227], v4 offset:1024
    s_waitcnt lgkmcnt(6)
    v_mfma_f32_16x16x32_bf16 v[128:131], v[236:239], v[32:35], v[128:131]
    s_add_u32 s22, s24, 0x20000
    s_add_u32 m0, s20, 0x20000
    s_nop 0
    buffer_load_dwordx4 v3, s[4:7], s22 offen lds
    ds_read_b64_tr_b16 v[228:229], v5 offset:32
    v_mfma_f32_16x16x32_bf16 v[132:135], v[236:239], v[36:39], v[132:135]
    ds_read_b64_tr_b16 v[230:231], v5 offset:1056
    s_waitcnt lgkmcnt(6)
    v_mfma_f32_16x16x32_bf16 v[136:139], v[240:243], v[32:35], v[136:139]
    ds_read_b64_tr_b16 v[232:233], v4 offset:256
    v_mfma_f32_16x16x32_bf16 v[140:143], v[240:243], v[36:39], v[140:143]
    ds_read_b64_tr_b16 v[234:235], v4 offset:1280
    s_waitcnt lgkmcnt(6)
    v_mfma_f32_16x16x32_bf16 v[144:147], v[244:247], v[32:35], v[144:147]
    ds_read_b64_tr_b16 v[236:237], v5 offset:288
    v_mfma_f32_16x16x32_bf16 v[148:151], v[244:247], v[36:39], v[148:151]
    ds_read_b64_tr_b16 v[238:239], v5 offset:1312
    s_waitcnt vmcnt(5)
    v_cmp_ne_u32 vcc, s28, v12
    s_cbranch_vccnz adaLN_cond__sliding_block_cached__moe_arch_mod__prompt_kernel_o219r
adaLN_cond__sliding_block_cached__moe_arch_mod__prompt_kernel_o219b:
    s_waitcnt lgkmcnt(6)
    v_mfma_f32_16x16x32_bf16 v[88:91], v[224:227], v[40:43], v[88:91]
    ds_read_b64_tr_b16 v[240:241], v4 offset:512
    v_mfma_f32_16x16x32_bf16 v[92:95], v[224:227], v[44:47], v[92:95]
    s_add_u32 s22, s24, 0x22000
    s_add_u32 m0, s20, 0x20400
    s_nop 0
    buffer_load_dwordx4 v3, s[4:7], s22 offen lds
    ds_read_b64_tr_b16 v[242:243], v4 offset:1536
    s_waitcnt lgkmcnt(6)
    v_mfma_f32_16x16x32_bf16 v[96:99], v[228:231], v[40:43], v[96:99]
    ds_read_b64_tr_b16 v[244:245], v5 offset:544
    s_mov_b32 s23, 0x0
    buffer_load_dwordx4 v[32:35], v6, s[8:11], s23 offen offset:2048 sc1
    v_mfma_f32_16x16x32_bf16 v[100:103], v[228:231], v[44:47], v[100:103]
    ds_read_b64_tr_b16 v[246:247], v5 offset:1568
    s_waitcnt lgkmcnt(6)
    v_mfma_f32_16x16x32_bf16 v[104:107], v[232:235], v[40:43], v[104:107]
    ds_read_b64_tr_b16 v[224:225], v4 offset:768
    v_mfma_f32_16x16x32_bf16 v[108:111], v[232:235], v[44:47], v[108:111]
    ds_read_b64_tr_b16 v[226:227], v4 offset:1792
    s_waitcnt lgkmcnt(6)
    v_mfma_f32_16x16x32_bf16 v[112:115], v[236:239], v[40:43], v[112:115]
    ds_read_b64_tr_b16 v[228:229], v5 offset:800
    v_mfma_f32_16x16x32_bf16 v[116:119], v[236:239], v[44:47], v[116:119]
    ds_read_b64_tr_b16 v[230:231], v5 offset:1824
    s_waitcnt lgkmcnt(6)
    v_mfma_f32_16x16x32_bf16 v[120:123], v[240:243], v[40:43], v[120:123]
    s_mov_b32 s23, 0x20000
    buffer_load_dwordx4 v[36:39], v6, s[8:11], s23 offen offset:2048 sc1
    v_mfma_f32_16x16x32_bf16 v[124:127], v[240:243], v[44:47], v[124:127]
    s_barrier
    ds_read_b64_tr_b16 v[232:233], v4 offset:16384
    ds_read_b64_tr_b16 v[234:235], v4 offset:17408
    s_waitcnt lgkmcnt(6)
    v_mfma_f32_16x16x32_bf16 v[128:131], v[244:247], v[40:43], v[128:131]
    s_add_u32 s22, s24, 0xa0000
    s_add_u32 m0, s20, 0x24000
    s_nop 0
    buffer_load_dwordx4 v3, s[4:7], s22 offen lds
    ds_read_b64_tr_b16 v[236:237], v5 offset:16416
    v_mfma_f32_16x16x32_bf16 v[132:135], v[244:247], v[44:47], v[132:135]
    ds_read_b64_tr_b16 v[238:239], v5 offset:17440
    s_waitcnt lgkmcnt(6)
    v_mfma_f32_16x16x32_bf16 v[136:139], v[224:227], v[40:43], v[136:139]
    ds_read_b64_tr_b16 v[240:241], v4 offset:16640
    v_mfma_f32_16x16x32_bf16 v[140:143], v[224:227], v[44:47], v[140:143]
    ds_read_b64_tr_b16 v[242:243], v4 offset:17664
    s_waitcnt lgkmcnt(6)
    v_mfma_f32_16x16x32_bf16 v[144:147], v[228:231], v[40:43], v[144:147]
    ds_read_b64_tr_b16 v[244:245], v5 offset:16672
    v_mfma_f32_16x16x32_bf16 v[148:151], v[228:231], v[44:47], v[148:151]
    ds_read_b64_tr_b16 v[246:247], v5 offset:17696
    s_waitcnt lgkmcnt(6)
    v_mfma_f32_16x16x32_bf16 v[88:91], v[232:235], v[48:51], v[88:91]
    ds_read_b64_tr_b16 v[224:225], v4 offset:16896
    v_mfma_f32_16x16x32_bf16 v[92:95], v[232:235], v[52:55], v[92:95]
    s_add_u32 s22, s24, 0xa2000
    s_add_u32 m0, s20, 0x24400
    s_nop 0
    buffer_load_dwordx4 v3, s[4:7], s22 offen lds
    ds_read_b64_tr_b16 v[226:227], v4 offset:17920
    s_waitcnt lgkmcnt(6)
    v_mfma_f32_16x16x32_bf16 v[96:99], v[236:239], v[48:51], v[96:99]
    ds_read_b64_tr_b16 v[228:229], v5 offset:16928
    s_mov_b32 s23, 0x2000
    buffer_load_dwordx4 v[40:43], v6, s[8:11], s23 offen offset:2048 sc1
    v_mfma_f32_16x16x32_bf16 v[100:103], v[236:239], v[52:55], v[100:103]
    ds_read_b64_tr_b16 v[230:231], v5 offset:17952
    s_waitcnt lgkmcnt(6)
    v_mfma_f32_16x16x32_bf16 v[104:107], v[240:243], v[48:51], v[104:107]
    ds_read_b64_tr_b16 v[232:233], v4 offset:17152
    v_mfma_f32_16x16x32_bf16 v[108:111], v[240:243], v[52:55], v[108:111]
    ds_read_b64_tr_b16 v[234:235], v4 offset:18176
    s_waitcnt lgkmcnt(6)
    v_mfma_f32_16x16x32_bf16 v[112:115], v[244:247], v[48:51], v[112:115]
    ds_read_b64_tr_b16 v[236:237], v5 offset:17184
    v_mfma_f32_16x16x32_bf16 v[116:119], v[244:247], v[52:55], v[116:119]
    ds_read_b64_tr_b16 v[238:239], v5 offset:18208
    s_waitcnt lgkmcnt(6)
    v_mfma_f32_16x16x32_bf16 v[120:123], v[224:227], v[48:51], v[120:123]
    s_mov_b32 s23, 0x22000
    buffer_load_dwordx4 v[44:47], v6, s[8:11], s23 offen offset:2048 sc1
    v_mfma_f32_16x16x32_bf16 v[124:127], v[224:227], v[52:55], v[124:127]
    s_barrier
    ds_read_b64_tr_b16 v[240:241], v4 offset:32768
    ds_read_b64_tr_b16 v[242:243], v4 offset:33792
    s_waitcnt lgkmcnt(6)
    v_mfma_f32_16x16x32_bf16 v[128:131], v[228:231], v[48:51], v[128:131]
    s_add_u32 s22, s24, 0x120000
    s_add_u32 m0, s20, 0x10000
    s_nop 0
    buffer_load_dwordx4 v3, s[4:7], s22 offen lds
    ds_read_b64_tr_b16 v[244:245], v5 offset:32800
    v_mfma_f32_16x16x32_bf16 v[132:135], v[228:231], v[52:55], v[132:135]
    ds_read_b64_tr_b16 v[246:247], v5 offset:33824
    s_waitcnt lgkmcnt(6)
    v_mfma_f32_16x16x32_bf16 v[136:139], v[232:235], v[48:51], v[136:139]
    ds_read_b64_tr_b16 v[224:225], v4 offset:33024
    v_mfma_f32_16x16x32_bf16 v[140:143], v[232:235], v[52:55], v[140:143]
    ds_read_b64_tr_b16 v[226:227], v4 offset:34048
    s_waitcnt lgkmcnt(6)
    v_mfma_f32_16x16x32_bf16 v[144:147], v[236:239], v[48:51], v[144:147]
    ds_read_b64_tr_b16 v[228:229], v5 offset:33056
    v_mfma_f32_16x16x32_bf16 v[148:151], v[236:239], v[52:55], v[148:151]
    ds_read_b64_tr_b16 v[230:231], v5 offset:34080
    s_waitcnt lgkmcnt(6)
    v_mfma_f32_16x16x32_bf16 v[88:91], v[240:243], v[56:59], v[88:91]
    ds_read_b64_tr_b16 v[232:233], v4 offset:33280
    v_mfma_f32_16x16x32_bf16 v[92:95], v[240:243], v[60:63], v[92:95]
    s_add_u32 s22, s24, 0x122000
    s_add_u32 m0, s20, 0x10400
    s_nop 0
    buffer_load_dwordx4 v3, s[4:7], s22 offen lds
    ds_read_b64_tr_b16 v[234:235], v4 offset:34304
    s_waitcnt lgkmcnt(6)
    v_mfma_f32_16x16x32_bf16 v[96:99], v[244:247], v[56:59], v[96:99]
    ds_read_b64_tr_b16 v[236:237], v5 offset:33312
    s_mov_b32 s23, 0x4000
    buffer_load_dwordx4 v[48:51], v6, s[8:11], s23 offen offset:2048 sc1
    v_mfma_f32_16x16x32_bf16 v[100:103], v[244:247], v[60:63], v[100:103]
    ds_read_b64_tr_b16 v[238:239], v5 offset:34336
    s_waitcnt lgkmcnt(6)
    v_mfma_f32_16x16x32_bf16 v[104:107], v[224:227], v[56:59], v[104:107]
    ds_read_b64_tr_b16 v[240:241], v4 offset:33536
    v_mfma_f32_16x16x32_bf16 v[108:111], v[224:227], v[60:63], v[108:111]
    ds_read_b64_tr_b16 v[242:243], v4 offset:34560
    s_waitcnt lgkmcnt(6)
    v_mfma_f32_16x16x32_bf16 v[112:115], v[228:231], v[56:59], v[112:115]
    ds_read_b64_tr_b16 v[244:245], v5 offset:33568
    v_mfma_f32_16x16x32_bf16 v[116:119], v[228:231], v[60:63], v[116:119]
    ds_read_b64_tr_b16 v[246:247], v5 offset:34592
    s_waitcnt lgkmcnt(6)
    v_mfma_f32_16x16x32_bf16 v[120:123], v[232:235], v[56:59], v[120:123]
    s_mov_b32 s23, 0x24000
    buffer_load_dwordx4 v[52:55], v6, s[8:11], s23 offen offset:2048 sc1
    v_mfma_f32_16x16x32_bf16 v[124:127], v[232:235], v[60:63], v[124:127]
    s_waitcnt vmcnt(14)
    s_barrier
    ds_read_b64_tr_b16 v[224:225], v4 offset:49152
    ds_read_b64_tr_b16 v[226:227], v4 offset:50176
    s_waitcnt lgkmcnt(6)
    v_mfma_f32_16x16x32_bf16 v[128:131], v[236:239], v[56:59], v[128:131]
    s_add_u32 s22, s24, 0x1a0000
    s_add_u32 m0, s20, 0x14000
    s_nop 0
    buffer_load_dwordx4 v3, s[4:7], s22 offen lds
    ds_read_b64_tr_b16 v[228:229], v5 offset:49184
    v_mfma_f32_16x16x32_bf16 v[132:135], v[236:239], v[60:63], v[132:135]
    ds_read_b64_tr_b16 v[230:231], v5 offset:50208
    s_waitcnt lgkmcnt(6)
    v_mfma_f32_16x16x32_bf16 v[136:139], v[240:243], v[56:59], v[136:139]
    ds_read_b64_tr_b16 v[232:233], v4 offset:49408
    v_mfma_f32_16x16x32_bf16 v[140:143], v[240:243], v[60:63], v[140:143]
    ds_read_b64_tr_b16 v[234:235], v4 offset:50432
    s_waitcnt lgkmcnt(6)
    v_mfma_f32_16x16x32_bf16 v[144:147], v[244:247], v[56:59], v[144:147]
    ds_read_b64_tr_b16 v[236:237], v5 offset:49440
    v_mfma_f32_16x16x32_bf16 v[148:151], v[244:247], v[60:63], v[148:151]
    ds_read_b64_tr_b16 v[238:239], v5 offset:50464
    s_waitcnt vmcnt(14) lgkmcnt(6)
    v_mfma_f32_16x16x32_bf16 v[88:91], v[224:227], v[24:27], v[88:91]
    ds_read_b64_tr_b16 v[240:241], v4 offset:49664
    s_waitcnt vmcnt(13)
    v_mfma_f32_16x16x32_bf16 v[92:95], v[224:227], v[28:31], v[92:95]
    s_add_u32 s22, s24, 0x1a2000
    s_add_u32 m0, s20, 0x14400
    s_nop 0
    buffer_load_dwordx4 v3, s[4:7], s22 offen lds
    ds_read_b64_tr_b16 v[242:243], v4 offset:50688
    s_waitcnt lgkmcnt(6)
    v_mfma_f32_16x16x32_bf16 v[96:99], v[228:231], v[24:27], v[96:99]
    ds_read_b64_tr_b16 v[244:245], v5 offset:49696
    s_mov_b32 s23, 0x6000
    buffer_load_dwordx4 v[56:59], v6, s[8:11], s23 offen offset:2048 sc1
    v_mfma_f32_16x16x32_bf16 v[100:103], v[228:231], v[28:31], v[100:103]
    ds_read_b64_tr_b16 v[246:247], v5 offset:50720
    s_waitcnt lgkmcnt(6)
    v_mfma_f32_16x16x32_bf16 v[104:107], v[232:235], v[24:27], v[104:107]
    ds_read_b64_tr_b16 v[224:225], v4 offset:49920
    v_mfma_f32_16x16x32_bf16 v[108:111], v[232:235], v[28:31], v[108:111]
    ds_read_b64_tr_b16 v[226:227], v4 offset:50944
    s_waitcnt lgkmcnt(6)
    v_mfma_f32_16x16x32_bf16 v[112:115], v[236:239], v[24:27], v[112:115]
    ds_read_b64_tr_b16 v[228:229], v5 offset:49952
    v_mfma_f32_16x16x32_bf16 v[116:119], v[236:239], v[28:31], v[116:119]
    ds_read_b64_tr_b16 v[230:231], v5 offset:50976
    s_waitcnt lgkmcnt(6)
    v_mfma_f32_16x16x32_bf16 v[120:123], v[240:243], v[24:27], v[120:123]
    s_mov_b32 s23, 0x26000
    buffer_load_dwordx4 v[60:63], v6, s[8:11], s23 offen offset:2048 sc1
    v_mfma_f32_16x16x32_bf16 v[124:127], v[240:243], v[28:31], v[124:127]
    s_waitcnt vmcnt(14)
    s_barrier
    ds_read_b64_tr_b16 v[232:233], v7 offset:0
    ds_read_b64_tr_b16 v[234:235], v7 offset:1024
    s_waitcnt lgkmcnt(6)
    v_mfma_f32_16x16x32_bf16 v[128:131], v[244:247], v[24:27], v[128:131]
    s_add_u32 s22, s24, 0x220000
    s_add_u32 m0, s20, 0x18000
    s_nop 0
    buffer_load_dwordx4 v3, s[4:7], s22 offen lds
    ds_read_b64_tr_b16 v[236:237], v8 offset:32
    v_mfma_f32_16x16x32_bf16 v[132:135], v[244:247], v[28:31], v[132:135]
    ds_read_b64_tr_b16 v[238:239], v8 offset:1056
    s_waitcnt lgkmcnt(6)
    v_mfma_f32_16x16x32_bf16 v[136:139], v[224:227], v[24:27], v[136:139]
    ds_read_b64_tr_b16 v[240:241], v7 offset:256
    v_mfma_f32_16x16x32_bf16 v[140:143], v[224:227], v[28:31], v[140:143]
    ds_read_b64_tr_b16 v[242:243], v7 offset:1280
    s_waitcnt lgkmcnt(6)
    v_mfma_f32_16x16x32_bf16 v[144:147], v[228:231], v[24:27], v[144:147]
    ds_read_b64_tr_b16 v[244:245], v8 offset:288
    v_mfma_f32_16x16x32_bf16 v[148:151], v[228:231], v[28:31], v[148:151]
    ds_read_b64_tr_b16 v[246:247], v8 offset:1312
    s_waitcnt vmcnt(14) lgkmcnt(6)
    v_mfma_f32_16x16x32_bf16 v[88:91], v[232:235], v[32:35], v[88:91]
    ds_read_b64_tr_b16 v[224:225], v7 offset:512
    s_waitcnt vmcnt(13)
    v_mfma_f32_16x16x32_bf16 v[92:95], v[232:235], v[36:39], v[92:95]
    s_add_u32 s22, s24, 0x222000
    s_add_u32 m0, s20, 0x18400
    s_nop 0
    buffer_load_dwordx4 v3, s[4:7], s22 offen lds
    ds_read_b64_tr_b16 v[226:227], v7 offset:1536
    s_waitcnt lgkmcnt(6)
    v_mfma_f32_16x16x32_bf16 v[96:99], v[236:239], v[32:35], v[96:99]
    ds_read_b64_tr_b16 v[228:229], v8 offset:544
    s_mov_b32 s23, 0x8000
    buffer_load_dwordx4 v[24:27], v6, s[8:11], s23 offen offset:2048 sc1
    v_mfma_f32_16x16x32_bf16 v[100:103], v[236:239], v[36:39], v[100:103]
    ds_read_b64_tr_b16 v[230:231], v8 offset:1568
    s_waitcnt lgkmcnt(6)
    v_mfma_f32_16x16x32_bf16 v[104:107], v[240:243], v[32:35], v[104:107]
    ds_read_b64_tr_b16 v[232:233], v7 offset:768
    v_mfma_f32_16x16x32_bf16 v[108:111], v[240:243], v[36:39], v[108:111]
    ds_read_b64_tr_b16 v[234:235], v7 offset:1792
    s_mov_b32 s16, 0x544000
    buffer_load_dwordx4 v[184:187], v2, s[8:11], s16 offen sc1
    s_waitcnt lgkmcnt(6)
    v_mfma_f32_16x16x32_bf16 v[112:115], v[244:247], v[32:35], v[112:115]
    ds_read_b64_tr_b16 v[236:237], v8 offset:800
    v_mfma_f32_16x16x32_bf16 v[116:119], v[244:247], v[36:39], v[116:119]
    ds_read_b64_tr_b16 v[238:239], v8 offset:1824
    s_waitcnt lgkmcnt(6)
    v_mfma_f32_16x16x32_bf16 v[120:123], v[224:227], v[32:35], v[120:123]
    s_mov_b32 s23, 0x28000
    buffer_load_dwordx4 v[28:31], v6, s[8:11], s23 offen offset:2048 sc1
    v_mfma_f32_16x16x32_bf16 v[124:127], v[224:227], v[36:39], v[124:127]
    s_waitcnt vmcnt(15)
    s_barrier
    ds_read_b64_tr_b16 v[240:241], v7 offset:16384
    ds_read_b64_tr_b16 v[242:243], v7 offset:17408
    s_waitcnt lgkmcnt(6)
    v_mfma_f32_16x16x32_bf16 v[128:131], v[228:231], v[32:35], v[128:131]
    s_add_u32 s22, s24, 0x2a0000
    s_add_u32 m0, s20, 0x1c000
    s_nop 0
    buffer_load_dwordx4 v3, s[4:7], s22 offen lds
    ds_read_b64_tr_b16 v[244:245], v8 offset:16416
    v_mfma_f32_16x16x32_bf16 v[132:135], v[228:231], v[36:39], v[132:135]
    ds_read_b64_tr_b16 v[246:247], v8 offset:17440
    s_waitcnt lgkmcnt(6)
    v_mfma_f32_16x16x32_bf16 v[136:139], v[232:235], v[32:35], v[136:139]
    ds_read_b64_tr_b16 v[224:225], v7 offset:16640
    v_mfma_f32_16x16x32_bf16 v[140:143], v[232:235], v[36:39], v[140:143]
    ds_read_b64_tr_b16 v[226:227], v7 offset:17664
    s_waitcnt lgkmcnt(6)
    v_mfma_f32_16x16x32_bf16 v[144:147], v[236:239], v[32:35], v[144:147]
    ds_read_b64_tr_b16 v[228:229], v8 offset:16672
    v_mfma_f32_16x16x32_bf16 v[148:151], v[236:239], v[36:39], v[148:151]
    ds_read_b64_tr_b16 v[230:231], v8 offset:17696
    s_waitcnt vmcnt(15) lgkmcnt(6)
    v_mfma_f32_16x16x32_bf16 v[88:91], v[240:243], v[40:43], v[88:91]
    ds_read_b64_tr_b16 v[232:233], v7 offset:16896
    s_waitcnt vmcnt(14)
    v_mfma_f32_16x16x32_bf16 v[92:95], v[240:243], v[44:47], v[92:95]
    s_add_u32 s22, s24, 0x2a2000
    s_add_u32 m0, s20, 0x1c400
    s_nop 0
    buffer_load_dwordx4 v3, s[4:7], s22 offen lds
    ds_read_b64_tr_b16 v[234:235], v7 offset:17920
    s_waitcnt lgkmcnt(6)
    v_mfma_f32_16x16x32_bf16 v[96:99], v[244:247], v[40:43], v[96:99]
    ds_read_b64_tr_b16 v[236:237], v8 offset:16928
    s_mov_b32 s23, 0xa000
    buffer_load_dwordx4 v[32:35], v6, s[8:11], s23 offen offset:2048 sc1
    v_mfma_f32_16x16x32_bf16 v[100:103], v[244:247], v[44:47], v[100:103]
    ds_read_b64_tr_b16 v[238:239], v8 offset:17952
    s_waitcnt lgkmcnt(6)
    v_mfma_f32_16x16x32_bf16 v[104:107], v[224:227], v[40:43], v[104:107]
    ds_read_b64_tr_b16 v[240:241], v7 offset:17152
    v_mfma_f32_16x16x32_bf16 v[108:111], v[224:227], v[44:47], v[108:111]
    ds_read_b64_tr_b16 v[242:243], v7 offset:18176
    s_waitcnt lgkmcnt(6)
    v_mfma_f32_16x16x32_bf16 v[112:115], v[228:231], v[40:43], v[112:115]
    ds_read_b64_tr_b16 v[244:245], v8 offset:17184
    v_mfma_f32_16x16x32_bf16 v[116:119], v[228:231], v[44:47], v[116:119]
    ds_read_b64_tr_b16 v[246:247], v8 offset:18208
    s_waitcnt lgkmcnt(6)
    v_mfma_f32_16x16x32_bf16 v[120:123], v[232:235], v[40:43], v[120:123]
    s_mov_b32 s23, 0x2a000
    buffer_load_dwordx4 v[36:39], v6, s[8:11], s23 offen offset:2048 sc1
    v_mfma_f32_16x16x32_bf16 v[124:127], v[232:235], v[44:47], v[124:127]
    s_waitcnt vmcnt(15)
    s_barrier
    ds_read_b64_tr_b16 v[224:225], v4 offset:0
    ds_read_b64_tr_b16 v[226:227], v4 offset:1024
    s_waitcnt lgkmcnt(6)
    v_mfma_f32_16x16x32_bf16 v[128:131], v[236:239], v[40:43], v[128:131]
    s_add_u32 s22, s24, 0x320000
    s_add_u32 m0, s20, 0x20000
    s_nop 0
    buffer_load_dwordx4 v3, s[4:7], s22 offen lds
    ds_read_b64_tr_b16 v[228:229], v5 offset:32
    v_mfma_f32_16x16x32_bf16 v[132:135], v[236:239], v[44:47], v[132:135]
    ds_read_b64_tr_b16 v[230:231], v5 offset:1056
    s_waitcnt lgkmcnt(6)
    v_mfma_f32_16x16x32_bf16 v[136:139], v[240:243], v[40:43], v[136:139]
    ds_read_b64_tr_b16 v[232:233], v4 offset:256
    v_mfma_f32_16x16x32_bf16 v[140:143], v[240:243], v[44:47], v[140:143]
    ds_read_b64_tr_b16 v[234:235], v4 offset:1280
    s_waitcnt lgkmcnt(6)
    v_mfma_f32_16x16x32_bf16 v[144:147], v[244:247], v[40:43], v[144:147]
    ds_read_b64_tr_b16 v[236:237], v5 offset:288
    v_mfma_f32_16x16x32_bf16 v[148:151], v[244:247], v[44:47], v[148:151]
    ds_read_b64_tr_b16 v[238:239], v5 offset:1312
    s_waitcnt vmcnt(15) lgkmcnt(6)
    v_mfma_f32_16x16x32_bf16 v[88:91], v[224:227], v[48:51], v[88:91]
    ds_read_b64_tr_b16 v[240:241], v4 offset:512
    s_waitcnt vmcnt(14)
    v_mfma_f32_16x16x32_bf16 v[92:95], v[224:227], v[52:55], v[92:95]
    s_add_u32 s22, s24, 0x322000
    s_add_u32 m0, s20, 0x20400
    s_nop 0
    buffer_load_dwordx4 v3, s[4:7], s22 offen lds
    ds_read_b64_tr_b16 v[242:243], v4 offset:1536
    s_waitcnt lgkmcnt(6)
    v_mfma_f32_16x16x32_bf16 v[96:99], v[228:231], v[48:51], v[96:99]
    ds_read_b64_tr_b16 v[244:245], v5 offset:544
    s_mov_b32 s23, 0xc000
    buffer_load_dwordx4 v[40:43], v6, s[8:11], s23 offen offset:2048 sc1
    v_mfma_f32_16x16x32_bf16 v[100:103], v[228:231], v[52:55], v[100:103]
    ds_read_b64_tr_b16 v[246:247], v5 offset:1568
    s_waitcnt lgkmcnt(6)
    v_mfma_f32_16x16x32_bf16 v[104:107], v[232:235], v[48:51], v[104:107]
    ds_read_b64_tr_b16 v[224:225], v4 offset:768
    v_mfma_f32_16x16x32_bf16 v[108:111], v[232:235], v[52:55], v[108:111]
    ds_read_b64_tr_b16 v[226:227], v4 offset:1792
    s_waitcnt lgkmcnt(6)
    v_mfma_f32_16x16x32_bf16 v[112:115], v[236:239], v[48:51], v[112:115]
    ds_read_b64_tr_b16 v[228:229], v5 offset:800
    v_mfma_f32_16x16x32_bf16 v[116:119], v[236:239], v[52:55], v[116:119]
    ds_read_b64_tr_b16 v[230:231], v5 offset:1824
    s_waitcnt lgkmcnt(6)
    v_mfma_f32_16x16x32_bf16 v[120:123], v[240:243], v[48:51], v[120:123]
    s_mov_b32 s23, 0x2c000
    buffer_load_dwordx4 v[44:47], v6, s[8:11], s23 offen offset:2048 sc1
    v_mfma_f32_16x16x32_bf16 v[124:127], v[240:243], v[52:55], v[124:127]
    s_waitcnt vmcnt(15)
    s_barrier
    ds_read_b64_tr_b16 v[232:233], v4 offset:16384
    ds_read_b64_tr_b16 v[234:235], v4 offset:17408
    s_add_u32 s19, s19, 8192
    buffer_load_dword v12, v13, s[8:11], s19 offen sc1
    s_waitcnt lgkmcnt(6)
    v_mfma_f32_16x16x32_bf16 v[128:131], v[244:247], v[48:51], v[128:131]
    s_add_u32 s22, s24, 0x3a0000
    s_add_u32 m0, s20, 0x24000
    s_nop 0
    buffer_load_dwordx4 v3, s[4:7], s22 offen lds
    ds_read_b64_tr_b16 v[236:237], v5 offset:16416
    v_mfma_f32_16x16x32_bf16 v[132:135], v[244:247], v[52:55], v[132:135]
    ds_read_b64_tr_b16 v[238:239], v5 offset:17440
    s_waitcnt lgkmcnt(6)
    v_mfma_f32_16x16x32_bf16 v[136:139], v[224:227], v[48:51], v[136:139]
    ds_read_b64_tr_b16 v[240:241], v4 offset:16640
    v_mfma_f32_16x16x32_bf16 v[140:143], v[224:227], v[52:55], v[140:143]
    ds_read_b64_tr_b16 v[242:243], v4 offset:17664
    s_waitcnt lgkmcnt(6)
    v_mfma_f32_16x16x32_bf16 v[144:147], v[228:231], v[48:51], v[144:147]
    ds_read_b64_tr_b16 v[244:245], v5 offset:16672
    v_mfma_f32_16x16x32_bf16 v[148:151], v[228:231], v[52:55], v[148:151]
    ds_read_b64_tr_b16 v[246:247], v5 offset:17696
    s_waitcnt vmcnt(16) lgkmcnt(6)
    v_mfma_f32_16x16x32_bf16 v[88:91], v[232:235], v[56:59], v[88:91]
    ds_read_b64_tr_b16 v[224:225], v4 offset:16896
    s_waitcnt vmcnt(15)
    v_mfma_f32_16x16x32_bf16 v[92:95], v[232:235], v[60:63], v[92:95]
    s_add_u32 s22, s24, 0x3a2000
    s_add_u32 m0, s20, 0x24400
    s_nop 0
    buffer_load_dwordx4 v3, s[4:7], s22 offen lds
    ds_read_b64_tr_b16 v[226:227], v4 offset:17920
    s_waitcnt lgkmcnt(6)
    v_mfma_f32_16x16x32_bf16 v[96:99], v[236:239], v[56:59], v[96:99]
    ds_read_b64_tr_b16 v[228:229], v5 offset:16928
    s_mov_b32 s23, 0xe000
    buffer_load_dwordx4 v[48:51], v6, s[8:11], s23 offen offset:2048 sc1
    v_mfma_f32_16x16x32_bf16 v[100:103], v[236:239], v[60:63], v[100:103]
    ds_read_b64_tr_b16 v[230:231], v5 offset:17952
    s_waitcnt lgkmcnt(6)
    v_mfma_f32_16x16x32_bf16 v[104:107], v[240:243], v[56:59], v[104:107]
    ds_read_b64_tr_b16 v[232:233], v4 offset:17152
    v_mfma_f32_16x16x32_bf16 v[108:111], v[240:243], v[60:63], v[108:111]
    ds_read_b64_tr_b16 v[234:235], v4 offset:18176
    s_waitcnt lgkmcnt(6)
    v_mfma_f32_16x16x32_bf16 v[112:115], v[244:247], v[56:59], v[112:115]
    ds_read_b64_tr_b16 v[236:237], v5 offset:17184
    v_mfma_f32_16x16x32_bf16 v[116:119], v[244:247], v[60:63], v[116:119]
    ds_read_b64_tr_b16 v[238:239], v5 offset:18208
    s_waitcnt lgkmcnt(6)
    v_mfma_f32_16x16x32_bf16 v[120:123], v[224:227], v[56:59], v[120:123]
    s_mov_b32 s23, 0x2e000
    buffer_load_dwordx4 v[52:55], v6, s[8:11], s23 offen offset:2048 sc1
    v_mfma_f32_16x16x32_bf16 v[124:127], v[224:227], v[60:63], v[124:127]
    s_waitcnt vmcnt(16)
    s_barrier
    ds_read_b64_tr_b16 v[240:241], v4 offset:32768
    ds_read_b64_tr_b16 v[242:243], v4 offset:33792
    s_waitcnt lgkmcnt(6)
    v_mfma_f32_16x16x32_bf16 v[128:131], v[228:231], v[56:59], v[128:131]
    s_add_u32 s22, s24, 0x30000
    s_add_u32 m0, s20, 0x10000
    s_nop 0
    buffer_load_dwordx4 v3, s[4:7], s22 offen lds
    ds_read_b64_tr_b16 v[244:245], v5 offset:32800
    v_mfma_f32_16x16x32_bf16 v[132:135], v[228:231], v[60:63], v[132:135]
    ds_read_b64_tr_b16 v[246:247], v5 offset:33824
    s_waitcnt lgkmcnt(6)
    v_mfma_f32_16x16x32_bf16 v[136:139], v[232:235], v[56:59], v[136:139]
    ds_read_b64_tr_b16 v[224:225], v4 offset:33024
    v_mfma_f32_16x16x32_bf16 v[140:143], v[232:235], v[60:63], v[140:143]
    ds_read_b64_tr_b16 v[226:227], v4 offset:34048
    s_waitcnt lgkmcnt(6)
    v_mfma_f32_16x16x32_bf16 v[144:147], v[236:239], v[56:59], v[144:147]
    ds_read_b64_tr_b16 v[228:229], v5 offset:33056
    v_mfma_f32_16x16x32_bf16 v[148:151], v[236:239], v[60:63], v[148:151]
    ds_read_b64_tr_b16 v[230:231], v5 offset:34080
    s_waitcnt vmcnt(5)
    v_cmp_ne_u32 vcc, s28, v12
    s_cbranch_vccnz adaLN_cond__sliding_block_cached__moe_arch_mod__prompt_kernel_o220r
adaLN_cond__sliding_block_cached__moe_arch_mod__prompt_kernel_o220b:
    s_waitcnt lgkmcnt(6)
    v_mfma_f32_16x16x32_bf16 v[88:91], v[240:243], v[24:27], v[88:91]
    ds_read_b64_tr_b16 v[232:233], v4 offset:33280
    v_mfma_f32_16x16x32_bf16 v[92:95], v[240:243], v[28:31], v[92:95]
    s_add_u32 s22, s24, 0x32000
    s_add_u32 m0, s20, 0x10400
    s_nop 0
    buffer_load_dwordx4 v3, s[4:7], s22 offen lds
    ds_read_b64_tr_b16 v[234:235], v4 offset:34304
    s_waitcnt lgkmcnt(6)
    v_mfma_f32_16x16x32_bf16 v[96:99], v[244:247], v[24:27], v[96:99]
    ds_read_b64_tr_b16 v[236:237], v5 offset:33312
    s_mov_b32 s23, 0x0
    buffer_load_dwordx4 v[56:59], v6, s[8:11], s23 offen offset:3072 sc1
    v_mfma_f32_16x16x32_bf16 v[100:103], v[244:247], v[28:31], v[100:103]
    ds_read_b64_tr_b16 v[238:239], v5 offset:34336
    s_waitcnt lgkmcnt(6)
    v_mfma_f32_16x16x32_bf16 v[104:107], v[224:227], v[24:27], v[104:107]
    ds_read_b64_tr_b16 v[240:241], v4 offset:33536
    v_mfma_f32_16x16x32_bf16 v[108:111], v[224:227], v[28:31], v[108:111]
    ds_read_b64_tr_b16 v[242:243], v4 offset:34560
    v_xor_b32 v16, s28, v184
    v_xor_b32 v17, s28, v185
    v_xor_b32 v18, s28, v186
    v_xor_b32 v19, s28, v187
    v_or3_b32 v16, v16, v17, v18
    v_or_b32 v16, v16, v19
    v_cmp_ne_u32 vcc, 0, v16
    s_cbranch_vccnz adaLN_cond__sliding_block_cached__moe_arch_mod__prompt_kernel_mf21r
adaLN_cond__sliding_block_cached__moe_arch_mod__prompt_kernel_mf21b:
    s_waitcnt lgkmcnt(6)
    v_mfma_f32_16x16x32_bf16 v[112:115], v[228:231], v[24:27], v[112:115]
    ds_read_b64_tr_b16 v[244:245], v5 offset:33568
    v_mfma_f32_16x16x32_bf16 v[116:119], v[228:231], v[28:31], v[116:119]
    ds_read_b64_tr_b16 v[246:247], v5 offset:34592
    s_waitcnt lgkmcnt(6)
    v_mfma_f32_16x16x32_bf16 v[120:123], v[232:235], v[24:27], v[120:123]
    s_mov_b32 s23, 0x20000
    buffer_load_dwordx4 v[60:63], v6, s[8:11], s23 offen offset:3072 sc1
    v_mfma_f32_16x16x32_bf16 v[124:127], v[232:235], v[28:31], v[124:127]
    s_barrier
    ds_read_b64_tr_b16 v[224:225], v4 offset:49152
    ds_read_b64_tr_b16 v[226:227], v4 offset:50176
    s_waitcnt lgkmcnt(6)
    v_mfma_f32_16x16x32_bf16 v[128:131], v[236:239], v[24:27], v[128:131]
    s_add_u32 s22, s24, 0xb0000
    s_add_u32 m0, s20, 0x14000
    s_nop 0
    buffer_load_dwordx4 v3, s[4:7], s22 offen lds
    ds_read_b64_tr_b16 v[228:229], v5 offset:49184
    v_mfma_f32_16x16x32_bf16 v[132:135], v[236:239], v[28:31], v[132:135]
    ds_read_b64_tr_b16 v[230:231], v5 offset:50208
    s_waitcnt lgkmcnt(6)
    v_mfma_f32_16x16x32_bf16 v[136:139], v[240:243], v[24:27], v[136:139]
    ds_read_b64_tr_b16 v[232:233], v4 offset:49408
    v_mfma_f32_16x16x32_bf16 v[140:143], v[240:243], v[28:31], v[140:143]
    ds_read_b64_tr_b16 v[234:235], v4 offset:50432
    s_waitcnt lgkmcnt(6)
    v_mfma_f32_16x16x32_bf16 v[144:147], v[244:247], v[24:27], v[144:147]
    ds_read_b64_tr_b16 v[236:237], v5 offset:49440
    v_mfma_f32_16x16x32_bf16 v[148:151], v[244:247], v[28:31], v[148:151]
    ds_read_b64_tr_b16 v[238:239], v5 offset:50464
    s_waitcnt lgkmcnt(6)
    v_mfma_f32_16x16x32_bf16 v[88:91], v[224:227], v[32:35], v[88:91]
    ds_read_b64_tr_b16 v[240:241], v4 offset:49664
    v_mfma_f32_16x16x32_bf16 v[92:95], v[224:227], v[36:39], v[92:95]
    s_add_u32 s22, s24, 0xb2000
    s_add_u32 m0, s20, 0x14400
    s_nop 0
    buffer_load_dwordx4 v3, s[4:7], s22 offen lds
    ds_read_b64_tr_b16 v[242:243], v4 offset:50688
    s_waitcnt lgkmcnt(6)
    v_mfma_f32_16x16x32_bf16 v[96:99], v[228:231], v[32:35], v[96:99]
    ds_read_b64_tr_b16 v[244:245], v5 offset:49696
    s_mov_b32 s23, 0x2000
    buffer_load_dwordx4 v[24:27], v6, s[8:11], s23 offen offset:3072 sc1
    v_mfma_f32_16x16x32_bf16 v[100:103], v[228:231], v[36:39], v[100:103]
    ds_read_b64_tr_b16 v[246:247], v5 offset:50720
    s_waitcnt lgkmcnt(6)
    v_mfma_f32_16x16x32_bf16 v[104:107], v[232:235], v[32:35], v[104:107]
    ds_read_b64_tr_b16 v[224:225], v4 offset:49920
    v_mfma_f32_16x16x32_bf16 v[108:111], v[232:235], v[36:39], v[108:111]
    ds_read_b64_tr_b16 v[226:227], v4 offset:50944
    s_waitcnt lgkmcnt(6)
    v_mfma_f32_16x16x32_bf16 v[112:115], v[236:239], v[32:35], v[112:115]
    ds_read_b64_tr_b16 v[228:229], v5 offset:49952
    v_mfma_f32_16x16x32_bf16 v[116:119], v[236:239], v[36:39], v[116:119]
    ds_read_b64_tr_b16 v[230:231], v5 offset:50976
    s_waitcnt lgkmcnt(6)
    v_mfma_f32_16x16x32_bf16 v[120:123], v[240:243], v[32:35], v[120:123]
    s_mov_b32 s23, 0x22000
    buffer_load_dwordx4 v[28:31], v6, s[8:11], s23 offen offset:3072 sc1
    v_mfma_f32_16x16x32_bf16 v[124:127], v[240:243], v[36:39], v[124:127]
    s_barrier
    ds_read_b64_tr_b16 v[232:233], v7 offset:0
    ds_read_b64_tr_b16 v[234:235], v7 offset:1024
    s_waitcnt lgkmcnt(6)
    v_mfma_f32_16x16x32_bf16 v[128:131], v[244:247], v[32:35], v[128:131]
    s_add_u32 s22, s24, 0x130000
    s_add_u32 m0, s20, 0x18000
    s_nop 0
    buffer_load_dwordx4 v3, s[4:7], s22 offen lds
    ds_read_b64_tr_b16 v[236:237], v8 offset:32
    v_mfma_f32_16x16x32_bf16 v[132:135], v[244:247], v[36:39], v[132:135]
    ds_read_b64_tr_b16 v[238:239], v8 offset:1056
    s_waitcnt lgkmcnt(6)
    v_mfma_f32_16x16x32_bf16 v[136:139], v[224:227], v[32:35], v[136:139]
    ds_read_b64_tr_b16 v[240:241], v7 offset:256
    v_mfma_f32_16x16x32_bf16 v[140:143], v[224:227], v[36:39], v[140:143]
    ds_read_b64_tr_b16 v[242:243], v7 offset:1280
    s_waitcnt lgkmcnt(6)
    v_mfma_f32_16x16x32_bf16 v[144:147], v[228:231], v[32:35], v[144:147]
    ds_read_b64_tr_b16 v[244:245], v8 offset:288
    v_mfma_f32_16x16x32_bf16 v[148:151], v[228:231], v[36:39], v[148:151]
    ds_read_b64_tr_b16 v[246:247], v8 offset:1312
    s_waitcnt lgkmcnt(6)
    v_mfma_f32_16x16x32_bf16 v[88:91], v[232:235], v[40:43], v[88:91]
    ds_read_b64_tr_b16 v[224:225], v7 offset:512
    v_mfma_f32_16x16x32_bf16 v[92:95], v[232:235], v[44:47], v[92:95]
    s_add_u32 s22, s24, 0x132000
    s_add_u32 m0, s20, 0x18400
    s_nop 0
    buffer_load_dwordx4 v3, s[4:7], s22 offen lds
    ds_read_b64_tr_b16 v[226:227], v7 offset:1536
    s_waitcnt lgkmcnt(6)
    v_mfma_f32_16x16x32_bf16 v[96:99], v[236:239], v[40:43], v[96:99]
    ds_read_b64_tr_b16 v[228:229], v8 offset:544
    s_mov_b32 s23, 0x4000
    buffer_load_dwordx4 v[32:35], v6, s[8:11], s23 offen offset:3072 sc1
    v_mfma_f32_16x16x32_bf16 v[100:103], v[236:239], v[44:47], v[100:103]
    ds_read_b64_tr_b16 v[230:231], v8 offset:1568
    s_waitcnt lgkmcnt(6)
    v_mfma_f32_16x16x32_bf16 v[104:107], v[240:243], v[40:43], v[104:107]
    ds_read_b64_tr_b16 v[232:233], v7 offset:768
    v_mfma_f32_16x16x32_bf16 v[108:111], v[240:243], v[44:47], v[108:111]
    ds_read_b64_tr_b16 v[234:235], v7 offset:1792
    s_waitcnt lgkmcnt(6)
    v_mfma_f32_16x16x32_bf16 v[112:115], v[244:247], v[40:43], v[112:115]
    ds_read_b64_tr_b16 v[236:237], v8 offset:800
    v_mfma_f32_16x16x32_bf16 v[116:119], v[244:247], v[44:47], v[116:119]
    ds_read_b64_tr_b16 v[238:239], v8 offset:1824
    s_waitcnt lgkmcnt(6)
    v_mfma_f32_16x16x32_bf16 v[120:123], v[224:227], v[40:43], v[120:123]
    s_mov_b32 s23, 0x24000
    buffer_load_dwordx4 v[36:39], v6, s[8:11], s23 offen offset:3072 sc1
    v_mfma_f32_16x16x32_bf16 v[124:127], v[224:227], v[44:47], v[124:127]
    s_waitcnt vmcnt(14)
    s_barrier
    ds_read_b64_tr_b16 v[240:241], v7 offset:16384
    ds_read_b64_tr_b16 v[242:243], v7 offset:17408
    s_waitcnt lgkmcnt(6)
    v_mfma_f32_16x16x32_bf16 v[128:131], v[228:231], v[40:43], v[128:131]
    s_add_u32 s22, s24, 0x1b0000
    s_add_u32 m0, s20, 0x1c000
    s_nop 0
    buffer_load_dwordx4 v3, s[4:7], s22 offen lds
    ds_read_b64_tr_b16 v[244:245], v8 offset:16416
    v_mfma_f32_16x16x32_bf16 v[132:135], v[228:231], v[44:47], v[132:135]
    ds_read_b64_tr_b16 v[246:247], v8 offset:17440
    s_waitcnt lgkmcnt(6)
    v_mfma_f32_16x16x32_bf16 v[136:139], v[232:235], v[40:43], v[136:139]
    ds_read_b64_tr_b16 v[224:225], v7 offset:16640
    v_mfma_f32_16x16x32_bf16 v[140:143], v[232:235], v[44:47], v[140:143]
    ds_read_b64_tr_b16 v[226:227], v7 offset:17664
    s_waitcnt lgkmcnt(6)
    v_mfma_f32_16x16x32_bf16 v[144:147], v[236:239], v[40:43], v[144:147]
    ds_read_b64_tr_b16 v[228:229], v8 offset:16672
    v_mfma_f32_16x16x32_bf16 v[148:151], v[236:239], v[44:47], v[148:151]
    ds_read_b64_tr_b16 v[230:231], v8 offset:17696
    s_waitcnt vmcnt(14) lgkmcnt(6)
    v_mfma_f32_16x16x32_bf16 v[88:91], v[240:243], v[48:51], v[88:91]
    ds_read_b64_tr_b16 v[232:233], v7 offset:16896
    s_waitcnt vmcnt(13)
    v_mfma_f32_16x16x32_bf16 v[92:95], v[240:243], v[52:55], v[92:95]
    s_add_u32 s22, s24, 0x1b2000
    s_add_u32 m0, s20, 0x1c400
    s_nop 0
    buffer_load_dwordx4 v3, s[4:7], s22 offen lds
    ds_read_b64_tr_b16 v[234:235], v7 offset:17920
    s_waitcnt lgkmcnt(6)
    v_mfma_f32_16x16x32_bf16 v[96:99], v[244:247], v[48:51], v[96:99]
    ds_read_b64_tr_b16 v[236:237], v8 offset:16928
    s_mov_b32 s23, 0x6000
    buffer_load_dwordx4 v[40:43], v6, s[8:11], s23 offen offset:3072 sc1
    v_mfma_f32_16x16x32_bf16 v[100:103], v[244:247], v[52:55], v[100:103]
    ds_read_b64_tr_b16 v[238:239], v8 offset:17952
    s_waitcnt lgkmcnt(6)
    v_mfma_f32_16x16x32_bf16 v[104:107], v[224:227], v[48:51], v[104:107]
    ds_read_b64_tr_b16 v[240:241], v7 offset:17152
    v_mfma_f32_16x16x32_bf16 v[108:111], v[224:227], v[52:55], v[108:111]
    ds_read_b64_tr_b16 v[242:243], v7 offset:18176
    s_waitcnt lgkmcnt(6)
    v_mfma_f32_16x16x32_bf16 v[112:115], v[228:231], v[48:51], v[112:115]
    ds_read_b64_tr_b16 v[244:245], v8 offset:17184
    v_mfma_f32_16x16x32_bf16 v[116:119], v[228:231], v[52:55], v[116:119]
    ds_read_b64_tr_b16 v[246:247], v8 offset:18208
    s_waitcnt lgkmcnt(6)
    v_mfma_f32_16x16x32_bf16 v[120:123], v[232:235], v[48:51], v[120:123]
    s_mov_b32 s23, 0x26000
    buffer_load_dwordx4 v[44:47], v6, s[8:11], s23 offen offset:3072 sc1
    v_mfma_f32_16x16x32_bf16 v[124:127], v[232:235], v[52:55], v[124:127]
    s_waitcnt vmcnt(14)
    s_barrier
    ds_read_b64_tr_b16 v[224:225], v4 offset:0
    ds_read_b64_tr_b16 v[226:227], v4 offset:1024
    s_waitcnt lgkmcnt(6)
    v_mfma_f32_16x16x32_bf16 v[128:131], v[236:239], v[48:51], v[128:131]
    s_add_u32 s22, s24, 0x230000
    s_add_u32 m0, s20, 0x20000
    s_nop 0
    buffer_load_dwordx4 v3, s[4:7], s22 offen lds
    ds_read_b64_tr_b16 v[228:229], v5 offset:32
    v_mfma_f32_16x16x32_bf16 v[132:135], v[236:239], v[52:55], v[132:135]
    ds_read_b64_tr_b16 v[230:231], v5 offset:1056
    s_waitcnt lgkmcnt(6)
    v_mfma_f32_16x16x32_bf16 v[136:139], v[240:243], v[48:51], v[136:139]
    ds_read_b64_tr_b16 v[232:233], v4 offset:256
    v_mfma_f32_16x16x32_bf16 v[140:143], v[240:243], v[52:55], v[140:143]
    ds_read_b64_tr_b16 v[234:235], v4 offset:1280
    s_waitcnt lgkmcnt(6)
    v_mfma_f32_16x16x32_bf16 v[144:147], v[244:247], v[48:51], v[144:147]
    ds_read_b64_tr_b16 v[236:237], v5 offset:288
    v_mfma_f32_16x16x32_bf16 v[148:151], v[244:247], v[52:55], v[148:151]
    ds_read_b64_tr_b16 v[238:239], v5 offset:1312
    s_waitcnt vmcnt(14) lgkmcnt(6)
    v_mfma_f32_16x16x32_bf16 v[88:91], v[224:227], v[56:59], v[88:91]
    ds_read_b64_tr_b16 v[240:241], v4 offset:512
    s_waitcnt vmcnt(13)
    v_mfma_f32_16x16x32_bf16 v[92:95], v[224:227], v[60:63], v[92:95]
    s_add_u32 s22, s24, 0x232000
    s_add_u32 m0, s20, 0x20400
    s_nop 0
    buffer_load_dwordx4 v3, s[4:7], s22 offen lds
    ds_read_b64_tr_b16 v[242:243], v4 offset:1536
    s_waitcnt lgkmcnt(6)
    v_mfma_f32_16x16x32_bf16 v[96:99], v[228:231], v[56:59], v[96:99]
    ds_read_b64_tr_b16 v[244:245], v5 offset:544
    s_mov_b32 s23, 0x8000
    buffer_load_dwordx4 v[48:51], v6, s[8:11], s23 offen offset:3072 sc1
    v_mfma_f32_16x16x32_bf16 v[100:103], v[228:231], v[60:63], v[100:103]
    ds_read_b64_tr_b16 v[246:247], v5 offset:1568
    s_waitcnt lgkmcnt(6)
    v_mfma_f32_16x16x32_bf16 v[104:107], v[232:235], v[56:59], v[104:107]
    ds_read_b64_tr_b16 v[224:225], v4 offset:768
    v_mfma_f32_16x16x32_bf16 v[108:111], v[232:235], v[60:63], v[108:111]
    ds_read_b64_tr_b16 v[226:227], v4 offset:1792
    s_waitcnt lgkmcnt(6)
    v_mfma_f32_16x16x32_bf16 v[112:115], v[236:239], v[56:59], v[112:115]
    ds_read_b64_tr_b16 v[228:229], v5 offset:800
    v_mfma_f32_16x16x32_bf16 v[116:119], v[236:239], v[60:63], v[116:119]
    ds_read_b64_tr_b16 v[230:231], v5 offset:1824
    s_waitcnt lgkmcnt(6)
    v_mfma_f32_16x16x32_bf16 v[120:123], v[240:243], v[56:59], v[120:123]
    s_mov_b32 s23, 0x28000
    buffer_load_dwordx4 v[52:55], v6, s[8:11], s23 offen offset:3072 sc1
    v_mfma_f32_16x16x32_bf16 v[124:127], v[240:243], v[60:63], v[124:127]
    s_waitcnt vmcnt(14)
    s_barrier
    ds_read_b64_tr_b16 v[232:233], v4 offset:16384
    ds_read_b64_tr_b16 v[234:235], v4 offset:17408
    s_waitcnt lgkmcnt(6)
    v_mfma_f32_16x16x32_bf16 v[128:131], v[244:247], v[56:59], v[128:131]
    s_add_u32 s22, s24, 0x2b0000
    s_add_u32 m0, s20, 0x24000
    s_nop 0
    buffer_load_dwordx4 v3, s[4:7], s22 offen lds
    ds_read_b64_tr_b16 v[236:237], v5 offset:16416
    v_mfma_f32_16x16x32_bf16 v[132:135], v[244:247], v[60:63], v[132:135]
    ds_read_b64_tr_b16 v[238:239], v5 offset:17440
    s_waitcnt lgkmcnt(6)
    v_mfma_f32_16x16x32_bf16 v[136:139], v[224:227], v[56:59], v[136:139]
    ds_read_b64_tr_b16 v[240:241], v4 offset:16640
    v_mfma_f32_16x16x32_bf16 v[140:143], v[224:227], v[60:63], v[140:143]
    ds_read_b64_tr_b16 v[242:243], v4 offset:17664
    s_waitcnt lgkmcnt(6)
    v_mfma_f32_16x16x32_bf16 v[144:147], v[228:231], v[56:59], v[144:147]
    ds_read_b64_tr_b16 v[244:245], v5 offset:16672
    v_mfma_f32_16x16x32_bf16 v[148:151], v[228:231], v[60:63], v[148:151]
    ds_read_b64_tr_b16 v[246:247], v5 offset:17696
    s_waitcnt vmcnt(14) lgkmcnt(6)
    v_mfma_f32_16x16x32_bf16 v[88:91], v[232:235], v[24:27], v[88:91]
    ds_read_b64_tr_b16 v[224:225], v4 offset:16896
    s_waitcnt vmcnt(13)
    v_mfma_f32_16x16x32_bf16 v[92:95], v[232:235], v[28:31], v[92:95]
    s_add_u32 s22, s24, 0x2b2000
    s_add_u32 m0, s20, 0x24400
    s_nop 0
    buffer_load_dwordx4 v3, s[4:7], s22 offen lds
    ds_read_b64_tr_b16 v[226:227], v4 offset:17920
    s_waitcnt lgkmcnt(6)
    v_mfma_f32_16x16x32_bf16 v[96:99], v[236:239], v[24:27], v[96:99]
    ds_read_b64_tr_b16 v[228:229], v5 offset:16928
    s_mov_b32 s23, 0xa000
    buffer_load_dwordx4 v[56:59], v6, s[8:11], s23 offen offset:3072 sc1
    v_mfma_f32_16x16x32_bf16 v[100:103], v[236:239], v[28:31], v[100:103]
    ds_read_b64_tr_b16 v[230:231], v5 offset:17952
    s_waitcnt lgkmcnt(6)
    v_mfma_f32_16x16x32_bf16 v[104:107], v[240:243], v[24:27], v[104:107]
    ds_read_b64_tr_b16 v[232:233], v4 offset:17152
    v_mfma_f32_16x16x32_bf16 v[108:111], v[240:243], v[28:31], v[108:111]
    ds_read_b64_tr_b16 v[234:235], v4 offset:18176
    s_waitcnt lgkmcnt(6)
    v_mfma_f32_16x16x32_bf16 v[112:115], v[244:247], v[24:27], v[112:115]
    ds_read_b64_tr_b16 v[236:237], v5 offset:17184
    v_mfma_f32_16x16x32_bf16 v[116:119], v[244:247], v[28:31], v[116:119]
    ds_read_b64_tr_b16 v[238:239], v5 offset:18208
    s_waitcnt lgkmcnt(6)
    v_mfma_f32_16x16x32_bf16 v[120:123], v[224:227], v[24:27], v[120:123]
    s_mov_b32 s23, 0x2a000
    buffer_load_dwordx4 v[60:63], v6, s[8:11], s23 offen offset:3072 sc1
    v_mfma_f32_16x16x32_bf16 v[124:127], v[224:227], v[28:31], v[124:127]
    s_waitcnt vmcnt(14)
    s_barrier
    ds_read_b64_tr_b16 v[240:241], v4 offset:32768
    ds_read_b64_tr_b16 v[242:243], v4 offset:33792
    s_waitcnt lgkmcnt(6)
    v_mfma_f32_16x16x32_bf16 v[128:131], v[228:231], v[24:27], v[128:131]
    s_add_u32 s22, s24, 0x330000
    s_add_u32 m0, s20, 0x10000
    s_nop 0
    buffer_load_dwordx4 v3, s[4:7], s22 offen lds
    ds_read_b64_tr_b16 v[244:245], v5 offset:32800
    v_mfma_f32_16x16x32_bf16 v[132:135], v[228:231], v[28:31], v[132:135]
    ds_read_b64_tr_b16 v[246:247], v5 offset:33824
    s_waitcnt lgkmcnt(6)
    v_mfma_f32_16x16x32_bf16 v[136:139], v[232:235], v[24:27], v[136:139]
    ds_read_b64_tr_b16 v[224:225], v4 offset:33024
    v_mfma_f32_16x16x32_bf16 v[140:143], v[232:235], v[28:31], v[140:143]
    ds_read_b64_tr_b16 v[226:227], v4 offset:34048
    s_waitcnt lgkmcnt(6)
    v_mfma_f32_16x16x32_bf16 v[144:147], v[236:239], v[24:27], v[144:147]
    ds_read_b64_tr_b16 v[228:229], v5 offset:33056
    v_mfma_f32_16x16x32_bf16 v[148:151], v[236:239], v[28:31], v[148:151]
    ds_read_b64_tr_b16 v[230:231], v5 offset:34080
    s_waitcnt vmcnt(14) lgkmcnt(6)
    v_mfma_f32_16x16x32_bf16 v[88:91], v[240:243], v[32:35], v[88:91]
    ds_read_b64_tr_b16 v[232:233], v4 offset:33280
    s_waitcnt vmcnt(13)
    v_mfma_f32_16x16x32_bf16 v[92:95], v[240:243], v[36:39], v[92:95]
    s_add_u32 s22, s24, 0x332000
    s_add_u32 m0, s20, 0x10400
    s_nop 0
    buffer_load_dwordx4 v3, s[4:7], s22 offen lds
    ds_read_b64_tr_b16 v[234:235], v4 offset:34304
    s_waitcnt lgkmcnt(6)
    v_mfma_f32_16x16x32_bf16 v[96:99], v[244:247], v[32:35], v[96:99]
    ds_read_b64_tr_b16 v[236:237], v5 offset:33312
    s_mov_b32 s23, 0xc000
    buffer_load_dwordx4 v[24:27], v6, s[8:11], s23 offen offset:3072 sc1
    v_mfma_f32_16x16x32_bf16 v[100:103], v[244:247], v[36:39], v[100:103]
    ds_read_b64_tr_b16 v[238:239], v5 offset:34336
    s_waitcnt lgkmcnt(6)
    v_mfma_f32_16x16x32_bf16 v[104:107], v[224:227], v[32:35], v[104:107]
    ds_read_b64_tr_b16 v[240:241], v4 offset:33536
    v_mfma_f32_16x16x32_bf16 v[108:111], v[224:227], v[36:39], v[108:111]
    ds_read_b64_tr_b16 v[242:243], v4 offset:34560
    v_lshrrev_b32 v16, 4, v1
    v_lshlrev_b32 v16, 3, v16
    s_lshl_b32 s16, s31, 8
    s_add_u32 s16, s16, 0x540080
    buffer_load_dwordx2 v[248:249], v16, s[8:11], s16 offen offset:0 sc1
    buffer_load_dwordx2 v[250:251], v16, s[8:11], s16 offen offset:32 sc1
    buffer_load_dwordx2 v[252:253], v16, s[8:11], s16 offen offset:64 sc1
    buffer_load_dwordx2 v[254:255], v16, s[8:11], s16 offen offset:96 sc1
    s_waitcnt lgkmcnt(6)
    v_mfma_f32_16x16x32_bf16 v[112:115], v[228:231], v[32:35], v[112:115]
    ds_read_b64_tr_b16 v[244:245], v5 offset:33568
    v_mfma_f32_16x16x32_bf16 v[116:119], v[228:231], v[36:39], v[116:119]
    ds_read_b64_tr_b16 v[246:247], v5 offset:34592
    s_waitcnt lgkmcnt(6)
    v_mfma_f32_16x16x32_bf16 v[120:123], v[232:235], v[32:35], v[120:123]
    s_mov_b32 s23, 0x2c000
    buffer_load_dwordx4 v[28:31], v6, s[8:11], s23 offen offset:3072 sc1
    v_mfma_f32_16x16x32_bf16 v[124:127], v[232:235], v[36:39], v[124:127]
    s_waitcnt vmcnt(18)
    s_barrier
    ds_read_b64_tr_b16 v[224:225], v4 offset:49152
    ds_read_b64_tr_b16 v[226:227], v4 offset:50176
    s_waitcnt lgkmcnt(6)
    v_mfma_f32_16x16x32_bf16 v[128:131], v[236:239], v[32:35], v[128:131]
    s_add_u32 s22, s24, 0x3b0000
    s_add_u32 m0, s20, 0x14000
    s_nop 0
    buffer_load_dwordx4 v3, s[4:7], s22 offen lds
    ds_read_b64_tr_b16 v[228:229], v5 offset:49184
    v_mfma_f32_16x16x32_bf16 v[132:135], v[236:239], v[36:39], v[132:135]
    ds_read_b64_tr_b16 v[230:231], v5 offset:50208
    s_waitcnt lgkmcnt(6)
    v_mfma_f32_16x16x32_bf16 v[136:139], v[240:243], v[32:35], v[136:139]
    ds_read_b64_tr_b16 v[232:233], v4 offset:49408
    v_mfma_f32_16x16x32_bf16 v[140:143], v[240:243], v[36:39], v[140:143]
    ds_read_b64_tr_b16 v[234:235], v4 offset:50432
    s_waitcnt lgkmcnt(6)
    v_mfma_f32_16x16x32_bf16 v[144:147], v[244:247], v[32:35], v[144:147]
    ds_read_b64_tr_b16 v[236:237], v5 offset:49440
    v_mfma_f32_16x16x32_bf16 v[148:151], v[244:247], v[36:39], v[148:151]
    ds_read_b64_tr_b16 v[238:239], v5 offset:50464
    s_waitcnt vmcnt(18) lgkmcnt(6)
    v_mfma_f32_16x16x32_bf16 v[88:91], v[224:227], v[40:43], v[88:91]
    ds_read_b64_tr_b16 v[240:241], v4 offset:49664
    s_waitcnt vmcnt(17)
    v_mfma_f32_16x16x32_bf16 v[92:95], v[224:227], v[44:47], v[92:95]
    s_add_u32 s22, s24, 0x3b2000
    s_add_u32 m0, s20, 0x14400
    s_nop 0
    buffer_load_dwordx4 v3, s[4:7], s22 offen lds
    ds_read_b64_tr_b16 v[242:243], v4 offset:50688
    s_waitcnt lgkmcnt(6)
    v_mfma_f32_16x16x32_bf16 v[96:99], v[228:231], v[40:43], v[96:99]
    ds_read_b64_tr_b16 v[244:245], v5 offset:49696
    s_mov_b32 s23, 0xe000
    buffer_load_dwordx4 v[32:35], v6, s[8:11], s23 offen offset:3072 sc1
    v_mfma_f32_16x16x32_bf16 v[100:103], v[228:231], v[44:47], v[100:103]
    ds_read_b64_tr_b16 v[246:247], v5 offset:50720
    s_waitcnt lgkmcnt(6)
    v_mfma_f32_16x16x32_bf16 v[104:107], v[232:235], v[40:43], v[104:107]
    ds_read_b64_tr_b16 v[224:225], v4 offset:49920
    v_mfma_f32_16x16x32_bf16 v[108:111], v[232:235], v[44:47], v[108:111]
    ds_read_b64_tr_b16 v[226:227], v4 offset:50944
    s_waitcnt lgkmcnt(6)
    v_mfma_f32_16x16x32_bf16 v[112:115], v[236:239], v[40:43], v[112:115]
    ds_read_b64_tr_b16 v[228:229], v5 offset:49952
    v_mfma_f32_16x16x32_bf16 v[116:119], v[236:239], v[44:47], v[116:119]
    ds_read_b64_tr_b16 v[230:231], v5 offset:50976
    s_waitcnt lgkmcnt(6)
    v_mfma_f32_16x16x32_bf16 v[120:123], v[240:243], v[40:43], v[120:123]
    s_mov_b32 s23, 0x2e000
    buffer_load_dwordx4 v[36:39], v6, s[8:11], s23 offen offset:3072 sc1
    v_mfma_f32_16x16x32_bf16 v[124:127], v[240:243], v[44:47], v[124:127]
    s_waitcnt vmcnt(18)
    s_barrier
    ds_read_b64_tr_b16 v[232:233], v7 offset:0
    ds_read_b64_tr_b16 v[234:235], v7 offset:1024
    s_waitcnt lgkmcnt(6)
    v_mfma_f32_16x16x32_bf16 v[128:131], v[244:247], v[40:43], v[128:131]
    ds_read_b64_tr_b16 v[236:237], v8 offset:32
    v_mfma_f32_16x16x32_bf16 v[132:135], v[244:247], v[44:47], v[132:135]
    ds_read_b64_tr_b16 v[238:239], v8 offset:1056
    s_waitcnt lgkmcnt(6)
    v_mfma_f32_16x16x32_bf16 v[136:139], v[224:227], v[40:43], v[136:139]
    ds_read_b64_tr_b16 v[240:241], v7 offset:256
    v_mfma_f32_16x16x32_bf16 v[140:143], v[224:227], v[44:47], v[140:143]
    ds_read_b64_tr_b16 v[242:243], v7 offset:1280
    s_waitcnt lgkmcnt(6)
    v_mfma_f32_16x16x32_bf16 v[144:147], v[228:231], v[40:43], v[144:147]
    ds_read_b64_tr_b16 v[244:245], v8 offset:288
    v_mfma_f32_16x16x32_bf16 v[148:151], v[228:231], v[44:47], v[148:151]
    ds_read_b64_tr_b16 v[246:247], v8 offset:1312
    s_waitcnt vmcnt(17) lgkmcnt(6)
    v_mfma_f32_16x16x32_bf16 v[88:91], v[232:235], v[48:51], v[88:91]
    ds_read_b64_tr_b16 v[224:225], v7 offset:512
    s_waitcnt vmcnt(16)
    v_mfma_f32_16x16x32_bf16 v[92:95], v[232:235], v[52:55], v[92:95]
    ds_read_b64_tr_b16 v[226:227], v7 offset:1536
    s_waitcnt lgkmcnt(6)
    v_mfma_f32_16x16x32_bf16 v[96:99], v[236:239], v[48:51], v[96:99]
    ds_read_b64_tr_b16 v[228:229], v8 offset:544
    v_mfma_f32_16x16x32_bf16 v[100:103], v[236:239], v[52:55], v[100:103]
    ds_read_b64_tr_b16 v[230:231], v8 offset:1568
    s_waitcnt lgkmcnt(6)
    v_mfma_f32_16x16x32_bf16 v[104:107], v[240:243], v[48:51], v[104:107]
    ds_read_b64_tr_b16 v[232:233], v7 offset:768
    v_mfma_f32_16x16x32_bf16 v[108:111], v[240:243], v[52:55], v[108:111]
    ds_read_b64_tr_b16 v[234:235], v7 offset:1792
    s_waitcnt lgkmcnt(6)
    v_mfma_f32_16x16x32_bf16 v[112:115], v[244:247], v[48:51], v[112:115]
    ds_read_b64_tr_b16 v[236:237], v8 offset:800
    v_mfma_f32_16x16x32_bf16 v[116:119], v[244:247], v[52:55], v[116:119]
    ds_read_b64_tr_b16 v[238:239], v8 offset:1824
    s_waitcnt lgkmcnt(6)
    v_mfma_f32_16x16x32_bf16 v[120:123], v[224:227], v[48:51], v[120:123]
    s_mov_b64 s[72:73], s[48:49]
    s_mov_b32 s74, 0x700000
    s_mov_b32 s75, 0x20000
    s_cmp_lt_u32 s2, 224
    s_cselect_b32 s74, 7340032, 0
    s_sub_u32 s16, s3, 4
    v_lshrrev_b32 v20, 3, v1
    v_lshlrev_b32 v20, 3, v20
    s_lshl_b32 s17, s16, 6
    v_add_u32 v20, s17, v20
    s_mov_b32 s17, 7168
    v_mul_lo_u32 v21, s17, v20
    v_and_b32 v20, 7, v1
    v_lshl_add_u32 v21, v20, 4, v21
    s_and_b32 s17, s29, 3
    s_mul_i32 s18, s17, 1835008
    s_lshr_b32 s17, s29, 2
    s_lshl_b32 s17, s17, 7
    s_add_u32 s18, s18, s17
    s_lshl_b32 s16, s16, 13
    s_add_u32 s22, s18, 0
    s_add_u32 m0, s16, 32768
    s_nop 0
    buffer_load_dwordx4 v21, s[72:75], s22 offen lds
    s_add_u32 s22, s18, 7168
    s_add_u32 m0, s16, 33792
    s_nop 0
    buffer_load_dwordx4 v21, s[72:75], s22 offen lds
    s_add_u32 s22, s18, 14336
    s_add_u32 m0, s16, 34816
    s_nop 0
    buffer_load_dwordx4 v21, s[72:75], s22 offen lds
    s_add_u32 s22, s18, 21504
    s_add_u32 m0, s16, 35840
    s_nop 0
    buffer_load_dwordx4 v21, s[72:75], s22 offen lds
    s_add_u32 s22, s18, 28672
    s_add_u32 m0, s16, 36864
    s_nop 0
    buffer_load_dwordx4 v21, s[72:75], s22 offen lds
    s_add_u32 s22, s18, 35840
    s_add_u32 m0, s16, 37888
    s_nop 0
    buffer_load_dwordx4 v21, s[72:75], s22 offen lds
    s_add_u32 s22, s18, 43008
    s_add_u32 m0, s16, 38912
    s_nop 0
    buffer_load_dwordx4 v21, s[72:75], s22 offen lds
    s_add_u32 s22, s18, 50176
    s_add_u32 m0, s16, 39936
    s_nop 0
    buffer_load_dwordx4 v21, s[72:75], s22 offen lds
    v_mfma_f32_16x16x32_bf16 v[124:127], v[224:227], v[52:55], v[124:127]
    s_waitcnt vmcnt(22)
    s_barrier
    ds_read_b64_tr_b16 v[240:241], v7 offset:16384
    ds_read_b64_tr_b16 v[242:243], v7 offset:17408
    s_waitcnt lgkmcnt(6)
    v_mfma_f32_16x16x32_bf16 v[128:131], v[228:231], v[48:51], v[128:131]
    ds_read_b64_tr_b16 v[244:245], v8 offset:16416
    v_mfma_f32_16x16x32_bf16 v[132:135], v[228:231], v[52:55], v[132:135]
    ds_read_b64_tr_b16 v[246:247], v8 offset:17440
    s_waitcnt lgkmcnt(6)
    v_mfma_f32_16x16x32_bf16 v[136:139], v[232:235], v[48:51], v[136:139]
    ds_read_b64_tr_b16 v[224:225], v7 offset:16640
    v_mfma_f32_16x16x32_bf16 v[140:143], v[232:235], v[52:55], v[140:143]
    ds_read_b64_tr_b16 v[226:227], v7 offset:17664
    s_waitcnt lgkmcnt(6)
    v_mfma_f32_16x16x32_bf16 v[144:147], v[236:239], v[48:51], v[144:147]
    ds_read_b64_tr_b16 v[228:229], v8 offset:16672
    v_mfma_f32_16x16x32_bf16 v[148:151], v[236:239], v[52:55], v[148:151]
    ds_read_b64_tr_b16 v[230:231], v8 offset:17696
    s_waitcnt vmcnt(21) lgkmcnt(6)
    v_mfma_f32_16x16x32_bf16 v[88:91], v[240:243], v[56:59], v[88:91]
    ds_read_b64_tr_b16 v[232:233], v7 offset:16896
    s_waitcnt vmcnt(20)
    v_mfma_f32_16x16x32_bf16 v[92:95], v[240:243], v[60:63], v[92:95]
    ds_read_b64_tr_b16 v[234:235], v7 offset:17920
    s_waitcnt lgkmcnt(6)
    v_mfma_f32_16x16x32_bf16 v[96:99], v[244:247], v[56:59], v[96:99]
    ds_read_b64_tr_b16 v[236:237], v8 offset:16928
    v_mfma_f32_16x16x32_bf16 v[100:103], v[244:247], v[60:63], v[100:103]
    ds_read_b64_tr_b16 v[238:239], v8 offset:17952
    s_waitcnt lgkmcnt(6)
    v_mfma_f32_16x16x32_bf16 v[104:107], v[224:227], v[56:59], v[104:107]
    ds_read_b64_tr_b16 v[240:241], v7 offset:17152
    v_mfma_f32_16x16x32_bf16 v[108:111], v[224:227], v[60:63], v[108:111]
    ds_read_b64_tr_b16 v[242:243], v7 offset:18176
    s_waitcnt lgkmcnt(6)
    v_mfma_f32_16x16x32_bf16 v[112:115], v[228:231], v[56:59], v[112:115]
    ds_read_b64_tr_b16 v[244:245], v8 offset:17184
    v_mfma_f32_16x16x32_bf16 v[116:119], v[228:231], v[60:63], v[116:119]
    ds_read_b64_tr_b16 v[246:247], v8 offset:18208
    s_waitcnt lgkmcnt(6)
    v_mfma_f32_16x16x32_bf16 v[120:123], v[232:235], v[56:59], v[120:123]
    v_mfma_f32_16x16x32_bf16 v[124:127], v[232:235], v[60:63], v[124:127]
    s_waitcnt vmcnt(18)
    s_barrier
    ds_read_b64_tr_b16 v[224:225], v4 offset:0
    ds_read_b64_tr_b16 v[226:227], v4 offset:1024
    s_waitcnt lgkmcnt(6)
    v_mfma_f32_16x16x32_bf16 v[128:131], v[236:239], v[56:59], v[128:131]
    ds_read_b64_tr_b16 v[228:229], v5 offset:32
    v_mfma_f32_16x16x32_bf16 v[132:135], v[236:239], v[60:63], v[132:135]
    ds_read_b64_tr_b16 v[230:231], v5 offset:1056
    s_waitcnt lgkmcnt(6)
    v_mfma_f32_16x16x32_bf16 v[136:139], v[240:243], v[56:59], v[136:139]
    ds_read_b64_tr_b16 v[232:233], v4 offset:256
    v_mfma_f32_16x16x32_bf16 v[140:143], v[240:243], v[60:63], v[140:143]
    ds_read_b64_tr_b16 v[234:235], v4 offset:1280
    s_waitcnt lgkmcnt(6)
    v_mfma_f32_16x16x32_bf16 v[144:147], v[244:247], v[56:59], v[144:147]
    ds_read_b64_tr_b16 v[236:237], v5 offset:288
    v_mfma_f32_16x16x32_bf16 v[148:151], v[244:247], v[60:63], v[148:151]
    ds_read_b64_tr_b16 v[238:239], v5 offset:1312
    s_waitcnt vmcnt(17) lgkmcnt(6)
    v_mfma_f32_16x16x32_bf16 v[88:91], v[224:227], v[24:27], v[88:91]
    ds_read_b64_tr_b16 v[240:241], v4 offset:512
    s_waitcnt vmcnt(12)
    v_mfma_f32_16x16x32_bf16 v[92:95], v[224:227], v[28:31], v[92:95]
    ds_read_b64_tr_b16 v[242:243], v4 offset:1536
    s_waitcnt lgkmcnt(6)
    v_mfma_f32_16x16x32_bf16 v[96:99], v[228:231], v[24:27], v[96:99]
    ds_read_b64_tr_b16 v[244:245], v5 offset:544
    v_mfma_f32_16x16x32_bf16 v[100:103], v[228:231], v[28:31], v[100:103]
    ds_read_b64_tr_b16 v[246:247], v5 offset:1568
    s_waitcnt lgkmcnt(6)
    v_mfma_f32_16x16x32_bf16 v[104:107], v[232:235], v[24:27], v[104:107]
    ds_read_b64_tr_b16 v[224:225], v4 offset:768
    v_mfma_f32_16x16x32_bf16 v[108:111], v[232:235], v[28:31], v[108:111]
    ds_read_b64_tr_b16 v[226:227], v4 offset:1792
    s_waitcnt lgkmcnt(6)
    v_mfma_f32_16x16x32_bf16 v[112:115], v[236:239], v[24:27], v[112:115]
    ds_read_b64_tr_b16 v[228:229], v5 offset:800
    v_mfma_f32_16x16x32_bf16 v[116:119], v[236:239], v[28:31], v[116:119]
    ds_read_b64_tr_b16 v[230:231], v5 offset:1824
    s_waitcnt lgkmcnt(6)
    v_mfma_f32_16x16x32_bf16 v[120:123], v[240:243], v[24:27], v[120:123]
    v_mfma_f32_16x16x32_bf16 v[124:127], v[240:243], v[28:31], v[124:127]
    s_waitcnt vmcnt(10)
    s_barrier
    ds_read_b64_tr_b16 v[232:233], v4 offset:16384
    ds_read_b64_tr_b16 v[234:235], v4 offset:17408
    s_waitcnt lgkmcnt(6)
    v_mfma_f32_16x16x32_bf16 v[128:131], v[244:247], v[24:27], v[128:131]
    ds_read_b64_tr_b16 v[236:237], v5 offset:16416
    v_mfma_f32_16x16x32_bf16 v[132:135], v[244:247], v[28:31], v[132:135]
    ds_read_b64_tr_b16 v[238:239], v5 offset:17440
    s_waitcnt lgkmcnt(6)
    v_mfma_f32_16x16x32_bf16 v[136:139], v[224:227], v[24:27], v[136:139]
    ds_read_b64_tr_b16 v[240:241], v4 offset:16640
    v_mfma_f32_16x16x32_bf16 v[140:143], v[224:227], v[28:31], v[140:143]
    ds_read_b64_tr_b16 v[242:243], v4 offset:17664
    s_waitcnt lgkmcnt(6)
    v_mfma_f32_16x16x32_bf16 v[144:147], v[228:231], v[24:27], v[144:147]
    ds_read_b64_tr_b16 v[244:245], v5 offset:16672
    v_mfma_f32_16x16x32_bf16 v[148:151], v[228:231], v[28:31], v[148:151]
    ds_read_b64_tr_b16 v[246:247], v5 offset:17696
    s_waitcnt vmcnt(9) lgkmcnt(6)
    v_mfma_f32_16x16x32_bf16 v[88:91], v[232:235], v[32:35], v[88:91]
    ds_read_b64_tr_b16 v[224:225], v4 offset:16896
    s_waitcnt vmcnt(8)
    v_mfma_f32_16x16x32_bf16 v[92:95], v[232:235], v[36:39], v[92:95]
    ds_read_b64_tr_b16 v[226:227], v4 offset:17920
    s_waitcnt lgkmcnt(6)
    v_mfma_f32_16x16x32_bf16 v[96:99], v[236:239], v[32:35], v[96:99]
    ds_read_b64_tr_b16 v[228:229], v5 offset:16928
    v_mfma_f32_16x16x32_bf16 v[100:103], v[236:239], v[36:39], v[100:103]
    ds_read_b64_tr_b16 v[230:231], v5 offset:17952
    s_waitcnt lgkmcnt(6)
    v_mfma_f32_16x16x32_bf16 v[104:107], v[240:243], v[32:35], v[104:107]
    ds_read_b64_tr_b16 v[232:233], v4 offset:17152
    v_mfma_f32_16x16x32_bf16 v[108:111], v[240:243], v[36:39], v[108:111]
    ds_read_b64_tr_b16 v[234:235], v4 offset:18176
    s_waitcnt lgkmcnt(6)
    v_mfma_f32_16x16x32_bf16 v[112:115], v[244:247], v[32:35], v[112:115]
    ds_read_b64_tr_b16 v[236:237], v5 offset:17184
    v_mfma_f32_16x16x32_bf16 v[116:119], v[244:247], v[36:39], v[116:119]
    ds_read_b64_tr_b16 v[238:239], v5 offset:18208
    s_waitcnt lgkmcnt(6)
    v_mfma_f32_16x16x32_bf16 v[120:123], v[224:227], v[32:35], v[120:123]
    v_mfma_f32_16x16x32_bf16 v[124:127], v[224:227], v[36:39], v[124:127]
    s_waitcnt lgkmcnt(4)
    v_mfma_f32_16x16x32_bf16 v[128:131], v[228:231], v[32:35], v[128:131]
    v_mfma_f32_16x16x32_bf16 v[132:135], v[228:231], v[36:39], v[132:135]
    s_waitcnt lgkmcnt(2)
    v_mfma_f32_16x16x32_bf16 v[136:139], v[232:235], v[32:35], v[136:139]
    v_mfma_f32_16x16x32_bf16 v[140:143], v[232:235], v[36:39], v[140:143]
    s_waitcnt lgkmcnt(0)
    v_mfma_f32_16x16x32_bf16 v[144:147], v[236:239], v[32:35], v[144:147]
    v_mfma_f32_16x16x32_bf16 v[148:151], v[236:239], v[36:39], v[148:151]
    s_lshl_b32 s16, s3, 13
    s_xor_b32 s17, s16, 0x8000
    s_add_u32 s16, s16, 0x18000
    s_add_u32 s17, s17, 0x18000
    v_add_u32 v16, s16, v2
    s_mov_b32 s16, s17
    v_add_u32 v17, s16, v2
    ds_write_b128 v16, v[88:91] offset:0
    ds_write_b128 v16, v[92:95] offset:1024
    ds_write_b128 v16, v[96:99] offset:2048
    ds_write_b128 v16, v[100:103] offset:3072
    ds_write_b128 v16, v[104:107] offset:4096
    ds_write_b128 v16, v[108:111] offset:5120
    ds_write_b128 v16, v[112:115] offset:6144
    ds_write_b128 v16, v[116:119] offset:7168
    v_lshlrev_b32 v24, 16, v248
    v_and_b32 v25, 0xffff0000, v248
    v_lshlrev_b32 v26, 16, v249
    v_and_b32 v27, 0xffff0000, v249
    v_lshlrev_b32 v28, 16, v250
    v_and_b32 v29, 0xffff0000, v250
    v_lshlrev_b32 v30, 16, v251
    v_and_b32 v31, 0xffff0000, v251
    v_lshlrev_b32 v32, 16, v252
    v_and_b32 v33, 0xffff0000, v252
    v_lshlrev_b32 v34, 16, v253
    v_and_b32 v35, 0xffff0000, v253
    v_lshlrev_b32 v36, 16, v254
    v_and_b32 v37, 0xffff0000, v254
    v_lshlrev_b32 v38, 16, v255
    v_and_b32 v39, 0xffff0000, v255
    v_and_b32 v18, 15, v1
    v_lshlrev_b32 v18, 6, v18
    v_lshrrev_b32 v19, 4, v1
    v_and_b32 v20, 1, v19
    v_lshl_add_u32 v18, v20, 5, v18
    v_lshrrev_b32 v19, 1, v19
    v_lshl_add_u32 v18, v19, 4, v18
    s_and_b32 s17, s3, 3
    s_lshl_b32 s18, s30, 2
    s_add_u32 s18, s18, s17
    s_lshl_b32 s18, s18, 16
    s_lshl_b32 s19, s15, 22
    s_add_u32 s18, s18, s19
    s_lshl_b32 s19, s31, 12
    s_add_u32 s18, s18, s19
    s_add_u32 s18, s18, 0x2c00800
    s_add_u32 s19, s18, 32768
    s_waitcnt lgkmcnt(0)
    s_barrier
    ds_read_b128 v[40:43], v17 offset:0
    ds_read_b128 v[44:47], v17 offset:1024
    ds_read_b128 v[48:51], v17 offset:2048
    ds_read_b128 v[52:55], v17 offset:3072
    ds_read_b128 v[56:59], v17 offset:4096
    ds_read_b128 v[60:63], v17 offset:5120
    ds_read_b128 v[64:67], v17 offset:6144
    ds_read_b128 v[68:71], v17 offset:7168
    s_waitcnt lgkmcnt(7)
    v_pk_add_f32 v[120:121], v[120:121], v[40:41]
    v_pk_add_f32 v[122:123], v[122:123], v[42:43]
    v_pk_mul_f32 v[120:121], v[120:121], v[24:25]
    v_pk_mul_f32 v[122:123], v[122:123], v[26:27]
    v_cvt_pk_bf16_f32 v224, v120, v121
    v_cvt_pk_bf16_f32 v225, v122, v123
    s_waitcnt lgkmcnt(5)
    v_pk_add_f32 v[128:129], v[128:129], v[48:49]
    v_pk_add_f32 v[130:131], v[130:131], v[50:51]
    v_pk_mul_f32 v[128:129], v[128:129], v[28:29]
    v_pk_mul_f32 v[130:131], v[130:131], v[30:31]
    v_cvt_pk_bf16_f32 v226, v128, v129
    v_cvt_pk_bf16_f32 v227, v130, v131
    s_nop 0
    v_permlane16_swap_b32 v224, v226
    v_permlane16_swap_b32 v225, v227
    buffer_store_dwordx4 v[224:227], v18, s[8:11], s18 offen offset:0 sc1
    v_pk_add_f32 v[124:125], v[124:125], v[44:45]
    v_pk_add_f32 v[126:127], v[126:127], v[46:47]
    v_pk_mul_f32 v[124:125], v[124:125], v[24:25]
    v_pk_mul_f32 v[126:127], v[126:127], v[26:27]
    v_cvt_pk_bf16_f32 v228, v124, v125
    v_cvt_pk_bf16_f32 v229, v126, v127
    s_waitcnt lgkmcnt(4)
    v_pk_add_f32 v[132:133], v[132:133], v[52:53]
    v_pk_add_f32 v[134:135], v[134:135], v[54:55]
    v_pk_mul_f32 v[132:133], v[132:133], v[28:29]
    v_pk_mul_f32 v[134:135], v[134:135], v[30:31]
    v_cvt_pk_bf16_f32 v230, v132, v133
    v_cvt_pk_bf16_f32 v231, v134, v135
    s_nop 0
    v_permlane16_swap_b32 v228, v230
    v_permlane16_swap_b32 v229, v231
    buffer_store_dwordx4 v[228:231], v18, s[8:11], s19 offen offset:0 sc1
    s_waitcnt lgkmcnt(3)
    v_pk_add_f32 v[136:137], v[136:137], v[56:57]
    v_pk_add_f32 v[138:139], v[138:139], v[58:59]
    v_pk_mul_f32 v[136:137], v[136:137], v[32:33]
    v_pk_mul_f32 v[138:139], v[138:139], v[34:35]
    v_cvt_pk_bf16_f32 v232, v136, v137
    v_cvt_pk_bf16_f32 v233, v138, v139
    s_waitcnt lgkmcnt(1)
    v_pk_add_f32 v[144:145], v[144:145], v[64:65]
    v_pk_add_f32 v[146:147], v[146:147], v[66:67]
    v_pk_mul_f32 v[144:145], v[144:145], v[36:37]
    v_pk_mul_f32 v[146:147], v[146:147], v[38:39]
    v_cvt_pk_bf16_f32 v234, v144, v145
    v_cvt_pk_bf16_f32 v235, v146, v147
    s_nop 0
    v_permlane16_swap_b32 v232, v234
    v_permlane16_swap_b32 v233, v235
    buffer_store_dwordx4 v[232:235], v18, s[8:11], s18 offen offset:1024 sc1
    v_pk_add_f32 v[140:141], v[140:141], v[60:61]
    v_pk_add_f32 v[142:143], v[142:143], v[62:63]
    v_pk_mul_f32 v[140:141], v[140:141], v[32:33]
    v_pk_mul_f32 v[142:143], v[142:143], v[34:35]
    v_cvt_pk_bf16_f32 v236, v140, v141
    v_cvt_pk_bf16_f32 v237, v142, v143
    s_waitcnt lgkmcnt(0)
    v_pk_add_f32 v[148:149], v[148:149], v[68:69]
    v_pk_add_f32 v[150:151], v[150:151], v[70:71]
    v_pk_mul_f32 v[148:149], v[148:149], v[36:37]
    v_pk_mul_f32 v[150:151], v[150:151], v[38:39]
    v_cvt_pk_bf16_f32 v238, v148, v149
    v_cvt_pk_bf16_f32 v239, v150, v151
    s_nop 0
    v_permlane16_swap_b32 v236, v238
    v_permlane16_swap_b32 v237, v239
    buffer_store_dwordx4 v[236:239], v18, s[8:11], s19 offen offset:1024 sc1
    s_mov_b64 s[64:65], s[44:45]
    s_mov_b32 s66, 0x800
    s_mov_b32 s67, 0x20000
    s_mov_b64 s[76:77], s[32:33]
    s_mov_b32 s78, 0x400000
    s_mov_b32 s79, 0x20000
    s_mov_b64 s[68:69], s[56:57]
    s_mov_b32 s70, 0x400000
    s_mov_b32 s71, 0x20000
    s_lshl_b32 s14, s31, 1
    s_add_u32 s14, s14, s15
    s_lshl_b32 s14, s14, 3
    s_add_u32 s14, s14, s3
    s_lshl_b32 s16, s30, 7
    s_add_u32 s14, s14, s16
    s_lshl_b32 s16, s14, 11
    buffer_load_dwordx4 v[216:219], v2, s[76:79], s16 offen offset:0
    buffer_load_dwordx4 v[220:223], v2, s[76:79], s16 offen offset:1024
    s_lshl_b32 s16, s3, 10
    s_add_u32 m0, s16, 81920
    s_add_u32 s17, s16, 0x540800
    s_cmp_lt_u32 s3, 6
    s_cselect_b32 s17, s17, 0x7ffffff0
    s_sub_u32 s23, s16, 6144
    s_cmp_ge_u32 s3, 6
    s_cselect_b32 s23, s23, 0x7ffffff0
    s_cbranch_scc1 adaLN_cond__sliding_block_cached__moe_arch_mod__prompt_kernel_mlw
    buffer_load_dwordx4 v2, s[8:11], s17 offen sc1 lds
    s_branch adaLN_cond__sliding_block_cached__moe_arch_mod__prompt_kernel_mlj
adaLN_cond__sliding_block_cached__moe_arch_mod__prompt_kernel_mlw:
    buffer_load_dwordx4 v2, s[64:67], s23 offen lds
adaLN_cond__sliding_block_cached__moe_arch_mod__prompt_kernel_mlj:
    s_lshl_b32 s16, s30, 5
    s_lshl_b32 s17, s31, 1
    s_add_u32 s16, s16, s17
    s_add_u32 s16, s16, s15
    s_lshl_b32 s16, s16, 2
    s_add_u32 s16, s16, 0x530000
    s_cmp_eq_u32 s3, 0
    s_cselect_b32 s16, s16, 0x7ffffff0
    v_mov_b32 v16, s28
    v_mov_b32 v17, 0
    s_lshr_b32 s18, s14, 4
    s_lshl_b32 s18, s18, 15
    s_and_b32 s19, s14, 15
    s_lshl_b32 s19, s19, 6
    s_add_u32 s18, s18, s19
    s_add_u32 s18, s18, 0x2c00000
    s_add_u32 s19, s18, 16384
    v_lshrrev_b32 v18, 2, v1
    v_lshlrev_b32 v18, 10, v18
    v_and_b32 v19, 3, v1
    v_lshl_add_u32 v18, v19, 4, v18
    v_add_u32 v19, 0x400000, v18
    s_lshl_b32 s25, s30, 7
    s_add_u32 s25, s25, 0x530000
    v_and_b32 v20, 15, v1
    v_lshlrev_b32 v20, 2, v20
    s_waitcnt vmcnt(3)
    s_waitcnt vmcnt(0)
    s_barrier
    s_mov_b64 exec, 1
    buffer_store_dword v16, v17, s[8:11], s16 offen sc1
    s_mov_b64 exec, -1
    v_add_u32 v16, 81920, v2
    ds_read_b128 v[184:187], v16 offset:0
    ds_read_b128 v[188:191], v16 offset:1024
    ds_read_b128 v[192:195], v16 offset:2048
    ds_read_b128 v[196:199], v16 offset:3072
    ds_read_b128 v[200:203], v16 offset:4096
    ds_read_b128 v[204:207], v16 offset:5120
    ds_read_b128 v[208:211], v16 offset:6144
    ds_read_b128 v[212:215], v16 offset:7168
    v_mov_b32 v94, 0
    v_mov_b32 v95, 0
    s_waitcnt lgkmcnt(5)
    v_lshlrev_b32 v76, 16, v192
    v_and_b32 v77, 0xffff0000, v192
    s_waitcnt lgkmcnt(1)
    v_lshlrev_b32 v78, 16, v208
    v_and_b32 v79, 0xffff0000, v208
    v_pk_mul_f32 v[60:61], v[76:77], v[78:79]
    v_lshlrev_b32 v76, 16, v184
    v_and_b32 v77, 0xffff0000, v184
    v_fmac_f32 v94, v76, v78
    v_fmac_f32 v94, v77, v79
    v_add_f32 v95, v95, v60
    v_add_f32 v95, v95, v61
    v_lshlrev_b32 v76, 16, v193
    v_and_b32 v77, 0xffff0000, v193
    v_lshlrev_b32 v78, 16, v209
    v_and_b32 v79, 0xffff0000, v209
    v_pk_mul_f32 v[62:63], v[76:77], v[78:79]
    v_lshlrev_b32 v76, 16, v185
    v_and_b32 v77, 0xffff0000, v185
    v_fmac_f32 v94, v76, v78
    v_fmac_f32 v94, v77, v79
    v_add_f32 v95, v95, v62
    v_add_f32 v95, v95, v63
    v_lshlrev_b32 v76, 16, v194
    v_and_b32 v77, 0xffff0000, v194
    v_lshlrev_b32 v78, 16, v210
    v_and_b32 v79, 0xffff0000, v210
    v_pk_mul_f32 v[64:65], v[76:77], v[78:79]
    v_lshlrev_b32 v76, 16, v186
    v_and_b32 v77, 0xffff0000, v186
    v_fmac_f32 v94, v76, v78
    v_fmac_f32 v94, v77, v79
    v_add_f32 v95, v95, v64
    v_add_f32 v95, v95, v65
    v_lshlrev_b32 v76, 16, v195
    v_and_b32 v77, 0xffff0000, v195
    v_lshlrev_b32 v78, 16, v211
    v_and_b32 v79, 0xffff0000, v211
    v_pk_mul_f32 v[66:67], v[76:77], v[78:79]
    v_lshlrev_b32 v76, 16, v187
    v_and_b32 v77, 0xffff0000, v187
    v_fmac_f32 v94, v76, v78
    v_fmac_f32 v94, v77, v79
    v_add_f32 v95, v95, v66
    v_add_f32 v95, v95, v67
    v_lshlrev_b32 v76, 16, v196
    v_and_b32 v77, 0xffff0000, v196
    s_waitcnt lgkmcnt(0)
    v_lshlrev_b32 v78, 16, v212
    v_and_b32 v79, 0xffff0000, v212
    v_pk_mul_f32 v[68:69], v[76:77], v[78:79]
    v_lshlrev_b32 v76, 16, v188
    v_and_b32 v77, 0xffff0000, v188
    v_fmac_f32 v94, v76, v78
    v_fmac_f32 v94, v77, v79
    v_add_f32 v95, v95, v68
    v_add_f32 v95, v95, v69
    v_lshlrev_b32 v76, 16, v197
    v_and_b32 v77, 0xffff0000, v197
    v_lshlrev_b32 v78, 16, v213
    v_and_b32 v79, 0xffff0000, v213
    v_pk_mul_f32 v[70:71], v[76:77], v[78:79]
    v_lshlrev_b32 v76, 16, v189
    v_and_b32 v77, 0xffff0000, v189
    v_fmac_f32 v94, v76, v78
    v_fmac_f32 v94, v77, v79
    v_add_f32 v95, v95, v70
    v_add_f32 v95, v95, v71
    v_lshlrev_b32 v76, 16, v198
    v_and_b32 v77, 0xffff0000, v198
    v_lshlrev_b32 v78, 16, v214
    v_and_b32 v79, 0xffff0000, v214
    v_pk_mul_f32 v[72:73], v[76:77], v[78:79]
    v_lshlrev_b32 v76, 16, v190
    v_and_b32 v77, 0xffff0000, v190
    v_fmac_f32 v94, v76, v78
    v_fmac_f32 v94, v77, v79
    v_add_f32 v95, v95, v72
    v_add_f32 v95, v95, v73
    v_lshlrev_b32 v76, 16, v199
    v_and_b32 v77, 0xffff0000, v199
    v_lshlrev_b32 v78, 16, v215
    v_and_b32 v79, 0xffff0000, v215
    v_pk_mul_f32 v[74:75], v[76:77], v[78:79]
    v_lshlrev_b32 v76, 16, v191
    v_and_b32 v77, 0xffff0000, v191
    v_fmac_f32 v94, v76, v78
    v_fmac_f32 v94, v77, v79
    v_add_f32 v95, v95, v74
    v_add_f32 v95, v95, v75
    v_add_f32_dpp v94, v94, v94 row_ror:1 row_mask:0xf bank_mask:0xf
    s_nop 0
    v_add_f32_dpp v95, v95, v95 row_ror:1 row_mask:0xf bank_mask:0xf
    v_add_f32_dpp v94, v94, v94 row_ror:2 row_mask:0xf bank_mask:0xf
    s_nop 0
    v_add_f32_dpp v95, v95, v95 row_ror:2 row_mask:0xf bank_mask:0xf
    v_add_f32_dpp v94, v94, v94 row_ror:4 row_mask:0xf bank_mask:0xf
    s_nop 0
    v_add_f32_dpp v95, v95, v95 row_ror:4 row_mask:0xf bank_mask:0xf
    v_add_f32_dpp v94, v94, v94 row_ror:8 row_mask:0xf bank_mask:0xf
    s_nop 0
    v_add_f32_dpp v95, v95, v95 row_ror:8 row_mask:0xf bank_mask:0xf
    v_mov_b32 v76, v94
    s_nop 1
    v_permlane16_swap_b32 v94, v76
    v_add_f32 v94, v94, v76
    v_mov_b32 v77, v95
    s_nop 1
    v_permlane16_swap_b32 v95, v77
    v_add_f32 v95, v95, v77
    v_mov_b32 v76, v94
    s_nop 1
    v_permlane32_swap_b32 v94, v76
    v_add_f32 v94, v94, v76
    v_mov_b32 v77, v95
    s_nop 1
    v_permlane32_swap_b32 v95, v77
    v_add_f32 v95, v95, v77
    v_lshlrev_b32 v28, 16, v216
    v_and_b32 v29, 0xffff0000, v216
    v_lshlrev_b32 v30, 16, v217
    v_and_b32 v31, 0xffff0000, v217
    v_lshlrev_b32 v32, 16, v218
    v_and_b32 v33, 0xffff0000, v218
    v_lshlrev_b32 v34, 16, v219
    v_and_b32 v35, 0xffff0000, v219
    v_lshlrev_b32 v36, 16, v220
    v_and_b32 v37, 0xffff0000, v220
    v_lshlrev_b32 v38, 16, v221
    v_and_b32 v39, 0xffff0000, v221
    v_lshlrev_b32 v40, 16, v222
    v_and_b32 v41, 0xffff0000, v222
    v_lshlrev_b32 v42, 16, v223
    v_and_b32 v43, 0xffff0000, v223
    s_sleep 16
    s_mov_b32 s27, 0
adaLN_cond__sliding_block_cached__moe_arch_mod__prompt_kernel_a22p:
    buffer_load_dword v76, v20, s[8:11], s25 offen sc1
    s_waitcnt vmcnt(0)
    v_cmp_ne_u32 vcc, s28, v76
    s_add_u32 s27, s27, 1
    s_cmp_ge_u32 s27, 262144
    s_cbranch_scc1 adaLN_cond__sliding_block_cached__moe_arch_mod__prompt_kernel_a22g
    s_cbranch_vccnz adaLN_cond__sliding_block_cached__moe_arch_mod__prompt_kernel_a22p
adaLN_cond__sliding_block_cached__moe_arch_mod__prompt_kernel_a22g:
    buffer_load_dwordx4 v[44:47], v18, s[8:11], s18 offen sc1
    buffer_load_dwordx4 v[52:55], v19, s[8:11], s18 offen sc1
    buffer_load_dwordx4 v[48:51], v18, s[8:11], s19 offen sc1
    buffer_load_dwordx4 v[56:59], v19, s[8:11], s19 offen sc1
    v_lshlrev_b32 v21, 2, v0
    s_mov_b32 s16, 0x540800
    buffer_load_dword v106, v21, s[8:11], s16 offen sc1
    buffer_load_dword v104, v21, s[8:11], s16 offen offset:2048 sc1
    s_waitcnt vmcnt(5)
    v_lshlrev_b32 v76, 16, v44
    v_and_b32 v77, 0xffff0000, v44
    s_waitcnt vmcnt(4)
    v_lshlrev_b32 v78, 16, v52
    v_and_b32 v79, 0xffff0000, v52
    v_pk_add_f32 v[76:77], v[76:77], v[78:79]
    v_pk_add_f32 v[28:29], v[28:29], v[76:77]
    v_cvt_pk_bf16_f32 v16, v28, v29
    v_lshlrev_b32 v28, 16, v16
    v_and_b32 v29, 0xffff0000, v16
    v_lshlrev_b32 v80, 16, v45
    v_and_b32 v81, 0xffff0000, v45
    v_lshlrev_b32 v82, 16, v53
    v_and_b32 v83, 0xffff0000, v53
    v_pk_add_f32 v[80:81], v[80:81], v[82:83]
    v_pk_add_f32 v[30:31], v[30:31], v[80:81]
    v_cvt_pk_bf16_f32 v17, v30, v31
    v_lshlrev_b32 v30, 16, v17
    v_and_b32 v31, 0xffff0000, v17
    v_lshlrev_b32 v76, 16, v46
    v_and_b32 v77, 0xffff0000, v46
    v_lshlrev_b32 v78, 16, v54
    v_and_b32 v79, 0xffff0000, v54
    v_pk_add_f32 v[76:77], v[76:77], v[78:79]
    v_pk_add_f32 v[32:33], v[32:33], v[76:77]
    v_cvt_pk_bf16_f32 v16, v32, v33
    v_lshlrev_b32 v32, 16, v16
    v_and_b32 v33, 0xffff0000, v16
    v_lshlrev_b32 v80, 16, v47
    v_and_b32 v81, 0xffff0000, v47
    v_lshlrev_b32 v82, 16, v55
    v_and_b32 v83, 0xffff0000, v55
    v_pk_add_f32 v[80:81], v[80:81], v[82:83]
    v_pk_add_f32 v[34:35], v[34:35], v[80:81]
    v_cvt_pk_bf16_f32 v17, v34, v35
    v_lshlrev_b32 v34, 16, v17
    v_and_b32 v35, 0xffff0000, v17
    s_waitcnt vmcnt(3)
    v_lshlrev_b32 v76, 16, v48
    v_and_b32 v77, 0xffff0000, v48
    s_waitcnt vmcnt(2)
    v_lshlrev_b32 v78, 16, v56
    v_and_b32 v79, 0xffff0000, v56
    v_pk_add_f32 v[76:77], v[76:77], v[78:79]
    v_pk_add_f32 v[36:37], v[36:37], v[76:77]
    v_cvt_pk_bf16_f32 v16, v36, v37
    v_lshlrev_b32 v36, 16, v16
    v_and_b32 v37, 0xffff0000, v16
    v_lshlrev_b32 v80, 16, v49
    v_and_b32 v81, 0xffff0000, v49
    v_lshlrev_b32 v82, 16, v57
    v_and_b32 v83, 0xffff0000, v57
    v_pk_add_f32 v[80:81], v[80:81], v[82:83]
    v_pk_add_f32 v[38:39], v[38:39], v[80:81]
    v_cvt_pk_bf16_f32 v17, v38, v39
    v_lshlrev_b32 v38, 16, v17
    v_and_b32 v39, 0xffff0000, v17
    v_lshlrev_b32 v76, 16, v50
    v_and_b32 v77, 0xffff0000, v50
    v_lshlrev_b32 v78, 16, v58
    v_and_b32 v79, 0xffff0000, v58
    v_pk_add_f32 v[76:77], v[76:77], v[78:79]
    v_pk_add_f32 v[40:41], v[40:41], v[76:77]
    v_cvt_pk_bf16_f32 v16, v40, v41
    v_lshlrev_b32 v40, 16, v16
    v_and_b32 v41, 0xffff0000, v16
    v_lshlrev_b32 v80, 16, v51
    v_and_b32 v81, 0xffff0000, v51
    v_lshlrev_b32 v82, 16, v59
    v_and_b32 v83, 0xffff0000, v59
    v_pk_add_f32 v[80:81], v[80:81], v[82:83]
    v_pk_add_f32 v[42:43], v[42:43], v[80:81]
    v_cvt_pk_bf16_f32 v17, v42, v43
    v_lshlrev_b32 v42, 16, v17
    v_and_b32 v43, 0xffff0000, v17
    v_pk_add_f32 v[76:77], v[28:29], v[30:31]
    v_pk_mul_f32 v[78:79], v[28:29], v[28:29]
    v_pk_mul_f32 v[80:81], v[28:29], v[60:61]
    v_pk_fma_f32 v[78:79], v[30:31], v[30:31], v[78:79]
    v_pk_fma_f32 v[80:81], v[30:31], v[62:63], v[80:81]
    v_pk_add_f32 v[76:77], v[76:77], v[32:33]
    v_pk_fma_f32 v[78:79], v[32:33], v[32:33], v[78:79]
    v_pk_fma_f32 v[80:81], v[32:33], v[64:65], v[80:81]
    v_pk_add_f32 v[76:77], v[76:77], v[34:35]
    v_pk_fma_f32 v[78:79], v[34:35], v[34:35], v[78:79]
    v_pk_fma_f32 v[80:81], v[34:35], v[66:67], v[80:81]
    v_pk_add_f32 v[76:77], v[76:77], v[36:37]
    v_pk_fma_f32 v[78:79], v[36:37], v[36:37], v[78:79]
    v_pk_fma_f32 v[80:81], v[36:37], v[68:69], v[80:81]
    v_pk_add_f32 v[76:77], v[76:77], v[38:39]
    v_pk_fma_f32 v[78:79], v[38:39], v[38:39], v[78:79]
    v_pk_fma_f32 v[80:81], v[38:39], v[70:71], v[80:81]
    v_pk_add_f32 v[76:77], v[76:77], v[40:41]
    v_pk_fma_f32 v[78:79], v[40:41], v[40:41], v[78:79]
    v_pk_fma_f32 v[80:81], v[40:41], v[72:73], v[80:81]
    v_pk_add_f32 v[76:77], v[76:77], v[42:43]
    v_pk_fma_f32 v[78:79], v[42:43], v[42:43], v[78:79]
    v_pk_fma_f32 v[80:81], v[42:43], v[74:75], v[80:81]
    v_add_f32 v96, v76, v77
    v_add_f32 v97, v78, v79
    v_add_f32 v98, v80, v81
    v_add_f32_dpp v96, v96, v96 row_ror:1 row_mask:0xf bank_mask:0xf
    v_add_f32_dpp v97, v97, v97 row_ror:1 row_mask:0xf bank_mask:0xf
    v_add_f32_dpp v98, v98, v98 row_ror:1 row_mask:0xf bank_mask:0xf
    v_add_f32_dpp v96, v96, v96 row_ror:2 row_mask:0xf bank_mask:0xf
    v_add_f32_dpp v97, v97, v97 row_ror:2 row_mask:0xf bank_mask:0xf
    v_add_f32_dpp v98, v98, v98 row_ror:2 row_mask:0xf bank_mask:0xf
    v_add_f32_dpp v96, v96, v96 row_ror:4 row_mask:0xf bank_mask:0xf
    v_add_f32_dpp v97, v97, v97 row_ror:4 row_mask:0xf bank_mask:0xf
    v_add_f32_dpp v98, v98, v98 row_ror:4 row_mask:0xf bank_mask:0xf
    v_add_f32_dpp v96, v96, v96 row_ror:8 row_mask:0xf bank_mask:0xf
    v_add_f32_dpp v97, v97, v97 row_ror:8 row_mask:0xf bank_mask:0xf
    v_add_f32_dpp v98, v98, v98 row_ror:8 row_mask:0xf bank_mask:0xf
    v_mov_b32 v76, v96
    s_nop 1
    v_permlane16_swap_b32 v96, v76
    v_add_f32 v96, v96, v76
    v_mov_b32 v77, v97
    s_nop 1
    v_permlane16_swap_b32 v97, v77
    v_add_f32 v97, v97, v77
    v_mov_b32 v78, v98
    s_nop 1
    v_permlane16_swap_b32 v98, v78
    v_add_f32 v98, v98, v78
    v_mov_b32 v76, v96
    s_nop 1
    v_permlane32_swap_b32 v96, v76
    v_add_f32 v96, v96, v76
    v_mov_b32 v77, v97
    s_nop 1
    v_permlane32_swap_b32 v97, v77
    v_add_f32 v97, v97, v77
    v_mov_b32 v78, v98
    s_nop 1
    v_permlane32_swap_b32 v98, v78
    v_add_f32 v98, v98, v78
    v_mul_f32 v96, 0x3a800000, v96
    v_mul_f32 v97, 0x3a800000, v97
    v_fma_f32 v97, -v96, v96, v97
    v_max_f32 v97, 0, v97
    v_fma_f32 v98, -v96, v95, v98
    v_add_f32 v76, 0x3727c5ac, v97
    v_rsq_f32 v76, v76
    s_nop 0
    v_fma_f32 v27, v98, v76, v94
    v_cvt_pk_bf16_f32 v96, v96, v96
    v_lshlrev_b32 v96, 16, v96
    v_cvt_pk_bf16_f32 v97, v97, v97
    v_lshlrev_b32 v97, 16, v97
    v_add_f32 v97, 0x3727c5ac, v97
    v_cvt_pk_bf16_f32 v97, v97, v97
    v_lshlrev_b32 v97, 16, v97
    v_sqrt_f32 v98, v97
    s_nop 0
    v_cvt_pk_bf16_f32 v98, v98, v98
    v_lshlrev_b32 v98, 16, v98
    v_rcp_f32 v99, v98
    v_mov_b32 v25, v96
    v_mov_b32 v26, v98
    v_ashrrev_i32 v16, 31, v27
    v_or_b32 v16, 0x80000000, v16
    v_xor_b32 v24, v27, v16
    v_and_b32 v24, 0xfffff800, v24
    v_max_u32 v24, 0x800, v24
    s_sub_u32 s16, 2047, s14
    v_or_b32 v24, s16, v24
    s_lshl_b32 s16, s3, 4
    s_add_u32 s16, s16, 65536
    v_mov_b32 v16, s16
    ds_write_b128 v16, v[24:27]
    s_waitcnt lgkmcnt(0)
    s_barrier
    v_and_b32 v16, 7, v1
    v_lshlrev_b32 v16, 4, v16
    v_add_u32 v16, 65536, v16
    ds_read_b32 v76, v16
    s_waitcnt lgkmcnt(0)
    v_mov_b32 v77, v76
    s_nop 1
    v_max_u32_dpp v77, v77, v77 row_ror:1 row_mask:0xf bank_mask:0xf
    s_nop 1
    v_max_u32_dpp v77, v77, v77 row_ror:2 row_mask:0xf bank_mask:0xf
    s_nop 1
    v_max_u32_dpp v77, v77, v77 row_ror:4 row_mask:0xf bank_mask:0xf
    v_cmp_eq_u32 vcc, v76, v77
    s_ff1_i32_b64 s16, vcc
    s_lshl_b32 s16, s16, 4
    s_add_u32 s16, s16, 65536
    v_mov_b32 v16, s16
    ds_read_b128 v[24:27], v16
    s_lshl_b32 s16, s2, 4
    s_add_u32 s16, s16, 0x6e0000
    s_cmp_eq_u32 s3, 0
    s_cselect_b32 s16, s16, 0x7ffffff0
    v_mov_b32 v17, 0
    s_mov_b64 exec, 1
    s_waitcnt lgkmcnt(0)
    buffer_store_dwordx4 v[24:27], v17, s[8:11], s16 offen sc1
    s_mov_b64 exec, -1
    s_mov_b64 s[72:73], s[50:51]
    s_mov_b32 s74, 0x700000
    s_mov_b32 s75, 0x20000
    s_cmp_lt_u32 s2, 224
    s_cselect_b32 s74, 7340032, 0
    s_lshl_b32 s17, s29, 4
    s_sub_u32 s16, s3, 4
    s_lshl_b32 s16, s16, 2
    s_add_u32 s16, s16, s17
    s_lshl_b32 s16, s16, 11
    s_add_u32 s17, s16, 0
    buffer_load_dwordx4 v[152:155], v2, s[72:75], s17 offen offset:0
    buffer_load_dwordx4 v[156:159], v2, s[72:75], s17 offen offset:1024
    s_add_u32 s17, s16, 2048
    buffer_load_dwordx4 v[160:163], v2, s[72:75], s17 offen offset:0
    buffer_load_dwordx4 v[164:167], v2, s[72:75], s17 offen offset:1024
    s_add_u32 s17, s16, 4096
    buffer_load_dwordx4 v[168:171], v2, s[72:75], s17 offen offset:0
    buffer_load_dwordx4 v[172:175], v2, s[72:75], s17 offen offset:1024
    s_add_u32 s17, s16, 6144
    buffer_load_dwordx4 v[176:179], v2, s[72:75], s17 offen offset:0
    buffer_load_dwordx4 v[180:183], v2, s[72:75], s17 offen offset:1024
    v_sub_f32 v44, v28, v96
    v_sub_f32 v45, v29, v96
    v_sub_f32 v46, v30, v96
    v_sub_f32 v47, v31, v96
    v_sub_f32 v48, v32, v96
    v_sub_f32 v49, v33, v96
    v_sub_f32 v50, v34, v96
    v_sub_f32 v51, v35, v96
    v_cvt_pk_bf16_f32 v16, v44, v45
    v_lshlrev_b32 v44, 16, v16
    v_and_b32 v45, 0xffff0000, v16
    v_cvt_pk_bf16_f32 v16, v46, v47
    v_lshlrev_b32 v46, 16, v16
    v_and_b32 v47, 0xffff0000, v16
    v_cvt_pk_bf16_f32 v16, v48, v49
    v_lshlrev_b32 v48, 16, v16
    v_and_b32 v49, 0xffff0000, v16
    v_cvt_pk_bf16_f32 v16, v50, v51
    v_lshlrev_b32 v50, 16, v16
    v_and_b32 v51, 0xffff0000, v16
    v_mul_f32 v52, v44, v99
    v_mul_f32 v53, v45, v99
    v_mul_f32 v54, v46, v99
    v_mul_f32 v55, v47, v99
    v_mul_f32 v56, v48, v99
    v_mul_f32 v57, v49, v99
    v_mul_f32 v58, v50, v99
    v_mul_f32 v59, v51, v99
    v_fma_f32 v44, -v52, v98, v44
    v_fma_f32 v45, -v53, v98, v45
    v_fma_f32 v46, -v54, v98, v46
    v_fma_f32 v47, -v55, v98, v47
    v_fma_f32 v48, -v56, v98, v48
    v_fma_f32 v49, -v57, v98, v49
    v_fma_f32 v50, -v58, v98, v50
    v_fma_f32 v51, -v59, v98, v51
    v_fma_f32 v44, v44, v99, v52
    v_fma_f32 v45, v45, v99, v53
    v_fma_f32 v46, v46, v99, v54
    v_fma_f32 v47, v47, v99, v55
    v_fma_f32 v48, v48, v99, v56
    v_fma_f32 v49, v49, v99, v57
    v_fma_f32 v50, v50, v99, v58
    v_fma_f32 v51, v51, v99, v59
    v_cvt_pk_bf16_f32 v16, v44, v45
    v_lshlrev_b32 v44, 16, v16
    v_and_b32 v45, 0xffff0000, v16
    v_cvt_pk_bf16_f32 v16, v46, v47
    v_lshlrev_b32 v46, 16, v16
    v_and_b32 v47, 0xffff0000, v16
    v_cvt_pk_bf16_f32 v16, v48, v49
    v_lshlrev_b32 v48, 16, v16
    v_and_b32 v49, 0xffff0000, v16
    v_cvt_pk_bf16_f32 v16, v50, v51
    v_lshlrev_b32 v50, 16, v16
    v_and_b32 v51, 0xffff0000, v16
    v_lshlrev_b32 v52, 16, v192
    v_and_b32 v53, 0xffff0000, v192
    v_lshlrev_b32 v54, 16, v193
    v_and_b32 v55, 0xffff0000, v193
    v_lshlrev_b32 v56, 16, v194
    v_and_b32 v57, 0xffff0000, v194
    v_lshlrev_b32 v58, 16, v195
    v_and_b32 v59, 0xffff0000, v195
    v_pk_mul_f32 v[44:45], v[44:45], v[52:53]
    v_pk_mul_f32 v[46:47], v[46:47], v[54:55]
    v_pk_mul_f32 v[48:49], v[48:49], v[56:57]
    v_pk_mul_f32 v[50:51], v[50:51], v[58:59]
    v_cvt_pk_bf16_f32 v16, v44, v45
    v_lshlrev_b32 v44, 16, v16
    v_and_b32 v45, 0xffff0000, v16
    v_cvt_pk_bf16_f32 v16, v46, v47
    v_lshlrev_b32 v46, 16, v16
    v_and_b32 v47, 0xffff0000, v16
    v_cvt_pk_bf16_f32 v16, v48, v49
    v_lshlrev_b32 v48, 16, v16
    v_and_b32 v49, 0xffff0000, v16
    v_cvt_pk_bf16_f32 v16, v50, v51
    v_lshlrev_b32 v50, 16, v16
    v_and_b32 v51, 0xffff0000, v16
    v_lshlrev_b32 v52, 16, v184
    v_and_b32 v53, 0xffff0000, v184
    v_lshlrev_b32 v54, 16, v185
    v_and_b32 v55, 0xffff0000, v185
    v_lshlrev_b32 v56, 16, v186
    v_and_b32 v57, 0xffff0000, v186
    v_lshlrev_b32 v58, 16, v187
    v_and_b32 v59, 0xffff0000, v187
    v_pk_add_f32 v[44:45], v[44:45], v[52:53]
    v_pk_add_f32 v[46:47], v[46:47], v[54:55]
    v_pk_add_f32 v[48:49], v[48:49], v[56:57]
    v_pk_add_f32 v[50:51], v[50:51], v[58:59]
    v_cvt_pk_bf16_f32 v16, v44, v45
    v_lshlrev_b32 v44, 16, v16
    v_and_b32 v45, 0xffff0000, v16
    v_cvt_pk_bf16_f32 v16, v46, v47
    v_lshlrev_b32 v46, 16, v16
    v_and_b32 v47, 0xffff0000, v16
    v_cvt_pk_bf16_f32 v16, v48, v49
    v_lshlrev_b32 v48, 16, v16
    v_and_b32 v49, 0xffff0000, v16
    v_cvt_pk_bf16_f32 v16, v50, v51
    v_lshlrev_b32 v50, 16, v16
    v_and_b32 v51, 0xffff0000, v16
    v_lshlrev_b32 v52, 16, v200
    v_and_b32 v53, 0xffff0000, v200
    v_lshlrev_b32 v54, 16, v201
    v_and_b32 v55, 0xffff0000, v201
    v_lshlrev_b32 v56, 16, v202
    v_and_b32 v57, 0xffff0000, v202
    v_lshlrev_b32 v58, 16, v203
    v_and_b32 v59, 0xffff0000, v203
    v_pk_mul_f32 v[44:45], v[44:45], v[52:53]
    v_pk_mul_f32 v[46:47], v[46:47], v[54:55]
    v_pk_mul_f32 v[48:49], v[48:49], v[56:57]
    v_pk_mul_f32 v[50:51], v[50:51], v[58:59]
    v_cvt_pk_bf16_f32 v16, v44, v45
    v_lshlrev_b32 v44, 16, v16
    v_and_b32 v45, 0xffff0000, v16
    v_cvt_pk_bf16_f32 v16, v46, v47
    v_lshlrev_b32 v46, 16, v16
    v_and_b32 v47, 0xffff0000, v16
    v_cvt_pk_bf16_f32 v16, v48, v49
    v_lshlrev_b32 v48, 16, v16
    v_and_b32 v49, 0xffff0000, v16
    v_cvt_pk_bf16_f32 v16, v50, v51
    v_lshlrev_b32 v50, 16, v16
    v_and_b32 v51, 0xffff0000, v16
    v_pk_add_f32 v[44:45], v[44:45], v[28:29]
    v_pk_add_f32 v[46:47], v[46:47], v[30:31]
    v_pk_add_f32 v[48:49], v[48:49], v[32:33]
    v_pk_add_f32 v[50:51], v[50:51], v[34:35]
    v_cvt_pk_bf16_f32 v28, v44, v45
    v_cvt_pk_bf16_f32 v29, v46, v47
    v_cvt_pk_bf16_f32 v30, v48, v49
    v_cvt_pk_bf16_f32 v31, v50, v51
    v_sub_f32 v44, v36, v96
    v_sub_f32 v45, v37, v96
    v_sub_f32 v46, v38, v96
    v_sub_f32 v47, v39, v96
    v_sub_f32 v48, v40, v96
    v_sub_f32 v49, v41, v96
    v_sub_f32 v50, v42, v96
    v_sub_f32 v51, v43, v96
    v_cvt_pk_bf16_f32 v16, v44, v45
    v_lshlrev_b32 v44, 16, v16
    v_and_b32 v45, 0xffff0000, v16
    v_cvt_pk_bf16_f32 v16, v46, v47
    v_lshlrev_b32 v46, 16, v16
    v_and_b32 v47, 0xffff0000, v16
    v_cvt_pk_bf16_f32 v16, v48, v49
    v_lshlrev_b32 v48, 16, v16
    v_and_b32 v49, 0xffff0000, v16
    v_cvt_pk_bf16_f32 v16, v50, v51
    v_lshlrev_b32 v50, 16, v16
    v_and_b32 v51, 0xffff0000, v16
    v_mul_f32 v52, v44, v99
    v_mul_f32 v53, v45, v99
    v_mul_f32 v54, v46, v99
    v_mul_f32 v55, v47, v99
    v_mul_f32 v56, v48, v99
    v_mul_f32 v57, v49, v99
    v_mul_f32 v58, v50, v99
    v_mul_f32 v59, v51, v99
    v_fma_f32 v44, -v52, v98, v44
    v_fma_f32 v45, -v53, v98, v45
    v_fma_f32 v46, -v54, v98, v46
    v_fma_f32 v47, -v55, v98, v47
    v_fma_f32 v48, -v56, v98, v48
    v_fma_f32 v49, -v57, v98, v49
    v_fma_f32 v50, -v58, v98, v50
    v_fma_f32 v51, -v59, v98, v51
    v_fma_f32 v44, v44, v99, v52
    v_fma_f32 v45, v45, v99, v53
    v_fma_f32 v46, v46, v99, v54
    v_fma_f32 v47, v47, v99, v55
    v_fma_f32 v48, v48, v99, v56
    v_fma_f32 v49, v49, v99, v57
    v_fma_f32 v50, v50, v99, v58
    v_fma_f32 v51, v51, v99, v59
    v_cvt_pk_bf16_f32 v16, v44, v45
    v_lshlrev_b32 v44, 16, v16
    v_and_b32 v45, 0xffff0000, v16
    v_cvt_pk_bf16_f32 v16, v46, v47
    v_lshlrev_b32 v46, 16, v16
    v_and_b32 v47, 0xffff0000, v16
    v_cvt_pk_bf16_f32 v16, v48, v49
    v_lshlrev_b32 v48, 16, v16
    v_and_b32 v49, 0xffff0000, v16
    v_cvt_pk_bf16_f32 v16, v50, v51
    v_lshlrev_b32 v50, 16, v16
    v_and_b32 v51, 0xffff0000, v16
    v_lshlrev_b32 v52, 16, v196
    v_and_b32 v53, 0xffff0000, v196
    v_lshlrev_b32 v54, 16, v197
    v_and_b32 v55, 0xffff0000, v197
    v_lshlrev_b32 v56, 16, v198
    v_and_b32 v57, 0xffff0000, v198
    v_lshlrev_b32 v58, 16, v199
    v_and_b32 v59, 0xffff0000, v199
    v_pk_mul_f32 v[44:45], v[44:45], v[52:53]
    v_pk_mul_f32 v[46:47], v[46:47], v[54:55]
    v_pk_mul_f32 v[48:49], v[48:49], v[56:57]
    v_pk_mul_f32 v[50:51], v[50:51], v[58:59]
    v_cvt_pk_bf16_f32 v16, v44, v45
    v_lshlrev_b32 v44, 16, v16
    v_and_b32 v45, 0xffff0000, v16
    v_cvt_pk_bf16_f32 v16, v46, v47
    v_lshlrev_b32 v46, 16, v16
    v_and_b32 v47, 0xffff0000, v16
    v_cvt_pk_bf16_f32 v16, v48, v49
    v_lshlrev_b32 v48, 16, v16
    v_and_b32 v49, 0xffff0000, v16
    v_cvt_pk_bf16_f32 v16, v50, v51
    v_lshlrev_b32 v50, 16, v16
    v_and_b32 v51, 0xffff0000, v16
    v_lshlrev_b32 v52, 16, v188
    v_and_b32 v53, 0xffff0000, v188
    v_lshlrev_b32 v54, 16, v189
    v_and_b32 v55, 0xffff0000, v189
    v_lshlrev_b32 v56, 16, v190
    v_and_b32 v57, 0xffff0000, v190
    v_lshlrev_b32 v58, 16, v191
    v_and_b32 v59, 0xffff0000, v191
    v_pk_add_f32 v[44:45], v[44:45], v[52:53]
    v_pk_add_f32 v[46:47], v[46:47], v[54:55]
    v_pk_add_f32 v[48:49], v[48:49], v[56:57]
    v_pk_add_f32 v[50:51], v[50:51], v[58:59]
    v_cvt_pk_bf16_f32 v16, v44, v45
    v_lshlrev_b32 v44, 16, v16
    v_and_b32 v45, 0xffff0000, v16
    v_cvt_pk_bf16_f32 v16, v46, v47
    v_lshlrev_b32 v46, 16, v16
    v_and_b32 v47, 0xffff0000, v16
    v_cvt_pk_bf16_f32 v16, v48, v49
    v_lshlrev_b32 v48, 16, v16
    v_and_b32 v49, 0xffff0000, v16
    v_cvt_pk_bf16_f32 v16, v50, v51
    v_lshlrev_b32 v50, 16, v16
    v_and_b32 v51, 0xffff0000, v16
    v_lshlrev_b32 v52, 16, v204
    v_and_b32 v53, 0xffff0000, v204
    v_lshlrev_b32 v54, 16, v205
    v_and_b32 v55, 0xffff0000, v205
    v_lshlrev_b32 v56, 16, v206
    v_and_b32 v57, 0xffff0000, v206
    v_lshlrev_b32 v58, 16, v207
    v_and_b32 v59, 0xffff0000, v207
    v_pk_mul_f32 v[44:45], v[44:45], v[52:53]
    v_pk_mul_f32 v[46:47], v[46:47], v[54:55]
    v_pk_mul_f32 v[48:49], v[48:49], v[56:57]
    v_pk_mul_f32 v[50:51], v[50:51], v[58:59]
    v_cvt_pk_bf16_f32 v16, v44, v45
    v_lshlrev_b32 v44, 16, v16
    v_and_b32 v45, 0xffff0000, v16
    v_cvt_pk_bf16_f32 v16, v46, v47
    v_lshlrev_b32 v46, 16, v16
    v_and_b32 v47, 0xffff0000, v16
    v_cvt_pk_bf16_f32 v16, v48, v49
    v_lshlrev_b32 v48, 16, v16
    v_and_b32 v49, 0xffff0000, v16
    v_cvt_pk_bf16_f32 v16, v50, v51
    v_lshlrev_b32 v50, 16, v16
    v_and_b32 v51, 0xffff0000, v16
    v_pk_add_f32 v[44:45], v[44:45], v[36:37]
    v_pk_add_f32 v[46:47], v[46:47], v[38:39]
    v_pk_add_f32 v[48:49], v[48:49], v[40:41]
    v_pk_add_f32 v[50:51], v[50:51], v[42:43]
    v_cvt_pk_bf16_f32 v36, v44, v45
    v_cvt_pk_bf16_f32 v37, v46, v47
    v_cvt_pk_bf16_f32 v38, v48, v49
    v_cvt_pk_bf16_f32 v39, v50, v51
    s_barrier
    v_and_b32 v16, 3, v1
    v_lshlrev_b32 v16, 4, v16
    v_add_u32 v16, 65792, v16
    ds_read_b32 v76, v16
    s_waitcnt lgkmcnt(0)
    v_mov_b32 v77, v76
    s_nop 1
    v_max_u32_dpp v77, v77, v77 row_ror:1 row_mask:0xf bank_mask:0xf
    s_nop 1
    v_max_u32_dpp v77, v77, v77 row_ror:2 row_mask:0xf bank_mask:0xf
    v_cmp_eq_u32 vcc, v76, v77
    s_ff1_i32_b64 s16, vcc
    s_lshl_b32 s16, s16, 4
    s_add_u32 s16, s16, 65792
    v_mov_b32 v16, s16
    ds_read_b128 v[24:27], v16
    s_waitcnt lgkmcnt(0)
    v_and_b32 v76, 0x7ff, v24
    v_sub_u32 v76, 2047, v76
    s_nop 0
    v_readfirstlane_b32 s12, v76
    v_rcp_f32 v103, v26
    s_lshr_b32 s18, s12, 4
    s_lshl_b32 s18, s18, 15
    s_and_b32 s19, s12, 15
    s_lshl_b32 s19, s19, 6
    s_add_u32 s18, s18, s19
    s_add_u32 s18, s18, 0x2c00000
    s_add_u32 s19, s18, 0x400000
    v_lshrrev_b32 v18, 4, v0
    v_lshlrev_b32 v18, 10, v18
    v_and_b32 v19, 15, v0
    v_lshl_add_u32 v18, v19, 2, v18
    s_lshl_b32 s13, s12, 11
    buffer_load_dword v100, v18, s[8:11], s18 offen sc1
    buffer_load_dword v101, v18, s[8:11], s19 offen sc1
    buffer_load_dword v102, v21, s[76:79], s13 offen
    s_lshl_b32 s16, s14, 11
    s_cmp_lg_u32 s12, s14
    s_cselect_b32 s16, s16, 0x7ffffff0
    buffer_store_dwordx4 v[28:31], v2, s[68:71], s16 offen offset:0 sc1
    buffer_store_dwordx4 v[36:39], v2, s[68:71], s16 offen offset:1024 sc1
    s_lshl_b32 s16, s3, 13
    v_add_u32 v20, s16, v2
    s_waitcnt vmcnt(4)
    v_lshlrev_b32 v76, 16, v100
    v_and_b32 v77, 0xffff0000, v100
    s_waitcnt vmcnt(3)
    v_lshlrev_b32 v78, 16, v101
    v_and_b32 v79, 0xffff0000, v101
    v_pk_add_f32 v[76:77], v[76:77], v[78:79]
    s_waitcnt vmcnt(2)
    v_lshlrev_b32 v78, 16, v102
    v_and_b32 v79, 0xffff0000, v102
    v_pk_add_f32 v[92:93], v[78:79], v[76:77]
    v_cvt_pk_bf16_f32 v76, v92, v93
    v_lshlrev_b32 v92, 16, v76
    v_and_b32 v93, 0xffff0000, v76
    v_cvt_pk_bf16_f32 v100, v92, v93
    v_and_b32 v105, 0xffff0000, v104
    v_lshlrev_b32 v104, 16, v104
    v_and_b32 v107, 0xffff0000, v106
    v_lshlrev_b32 v106, 16, v106
    v_sub_f32 v92, v92, v25
    v_sub_f32 v93, v93, v25
    v_cvt_pk_bf16_f32 v76, v92, v93
    v_lshlrev_b32 v92, 16, v76
    v_and_b32 v93, 0xffff0000, v76
    v_mul_f32 v77, v92, v103
    v_fma_f32 v92, -v77, v26, v92
    v_fma_f32 v92, v92, v103, v77
    v_mul_f32 v77, v93, v103
    v_fma_f32 v93, -v77, v26, v93
    v_fma_f32 v93, v93, v103, v77
    v_cvt_pk_bf16_f32 v76, v92, v93
    v_lshlrev_b32 v92, 16, v76
    v_and_b32 v93, 0xffff0000, v76
    v_mul_f32 v92, v92, v104
    v_mul_f32 v93, v93, v105
    v_cvt_pk_bf16_f32 v76, v92, v93
    v_lshlrev_b32 v92, 16, v76
    v_and_b32 v93, 0xffff0000, v76
    v_add_f32 v92, v92, v106
    v_add_f32 v93, v93, v107
    v_cvt_pk_bf16_f32 v101, v92, v93
    v_add_u32 v16, 66560, v21
    ds_write_b32 v16, v101
    ds_write_b32 v16, v100 offset:2048
    s_waitcnt lgkmcnt(0)
    s_barrier
    ds_read_b128 v[60:63], v20 offset:0
    ds_read_b128 v[64:67], v20 offset:1024
    ds_read_b128 v[68:71], v20 offset:2048
    ds_read_b128 v[72:75], v20 offset:3072
    ds_read_b128 v[108:111], v20 offset:4096
    ds_read_b128 v[112:115], v20 offset:5120
    ds_read_b128 v[116:119], v20 offset:6144
    ds_read_b128 v[120:123], v20 offset:7168
    s_and_b32 s16, s3, 3
    s_lshl_b32 s16, s16, 7
    s_and_b32 s17, s29, 3
    s_lshl_b32 s17, s17, 9
    s_add_u32 s16, s16, s17
    s_add_u32 s16, s16, 66560
    v_lshrrev_b32 v16, 3, v1
    v_lshlrev_b32 v16, 4, v16
    v_add_u32 v16, s16, v16
    ds_read_b128 v[104:107], v16
    s_waitcnt lgkmcnt(0)
    v_lshlrev_b32 v76, 16, v104
    v_and_b32 v77, 0xffff, v104
    v_dot2_f32_bf16 v85, v60, v76, 0
    v_dot2_f32_bf16 v84, v60, v77, 0
    v_dot2_f32_bf16 v87, v61, v76, 0
    v_dot2_f32_bf16 v86, v61, v77, 0
    v_dot2_f32_bf16 v89, v62, v76, 0
    v_dot2_f32_bf16 v88, v62, v77, 0
    v_dot2_f32_bf16 v91, v63, v76, 0
    v_dot2_f32_bf16 v90, v63, v77, 0
    v_and_b32 v78, 0xffff0000, v104
    v_lshrrev_b32 v79, 16, v104
    v_dot2c_f32_bf16 v85, v64, v78
    v_dot2c_f32_bf16 v84, v64, v79
    v_dot2c_f32_bf16 v87, v65, v78
    v_dot2c_f32_bf16 v86, v65, v79
    v_dot2c_f32_bf16 v89, v66, v78
    v_dot2c_f32_bf16 v88, v66, v79
    v_dot2c_f32_bf16 v91, v67, v78
    v_dot2c_f32_bf16 v90, v67, v79
    v_lshlrev_b32 v80, 16, v105
    v_and_b32 v81, 0xffff, v105
    v_dot2c_f32_bf16 v85, v68, v80
    v_dot2c_f32_bf16 v84, v68, v81
    v_dot2c_f32_bf16 v87, v69, v80
    v_dot2c_f32_bf16 v86, v69, v81
    v_dot2c_f32_bf16 v89, v70, v80
    v_dot2c_f32_bf16 v88, v70, v81
    v_dot2c_f32_bf16 v91, v71, v80
    v_dot2c_f32_bf16 v90, v71, v81
    v_and_b32 v82, 0xffff0000, v105
    v_lshrrev_b32 v83, 16, v105
    v_dot2c_f32_bf16 v85, v72, v82
    v_dot2c_f32_bf16 v84, v72, v83
    v_dot2c_f32_bf16 v87, v73, v82
    v_dot2c_f32_bf16 v86, v73, v83
    v_dot2c_f32_bf16 v89, v74, v82
    v_dot2c_f32_bf16 v88, v74, v83
    v_dot2c_f32_bf16 v91, v75, v82
    v_dot2c_f32_bf16 v90, v75, v83
    v_lshlrev_b32 v76, 16, v106
    v_and_b32 v77, 0xffff, v106
    v_dot2c_f32_bf16 v85, v108, v76
    v_dot2c_f32_bf16 v84, v108, v77
    v_dot2c_f32_bf16 v87, v109, v76
    v_dot2c_f32_bf16 v86, v109, v77
    v_dot2c_f32_bf16 v89, v110, v76
    v_dot2c_f32_bf16 v88, v110, v77
    v_dot2c_f32_bf16 v91, v111, v76
    v_dot2c_f32_bf16 v90, v111, v77
    v_and_b32 v78, 0xffff0000, v106
    v_lshrrev_b32 v79, 16, v106
    v_dot2c_f32_bf16 v85, v112, v78
    v_dot2c_f32_bf16 v84, v112, v79
    v_dot2c_f32_bf16 v87, v113, v78
    v_dot2c_f32_bf16 v86, v113, v79
    v_dot2c_f32_bf16 v89, v114, v78
    v_dot2c_f32_bf16 v88, v114, v79
    v_dot2c_f32_bf16 v91, v115, v78
    v_dot2c_f32_bf16 v90, v115, v79
    v_lshlrev_b32 v80, 16, v107
    v_and_b32 v81, 0xffff, v107
    v_dot2c_f32_bf16 v85, v116, v80
    v_dot2c_f32_bf16 v84, v116, v81
    v_dot2c_f32_bf16 v87, v117, v80
    v_dot2c_f32_bf16 v86, v117, v81
    v_dot2c_f32_bf16 v89, v118, v80
    v_dot2c_f32_bf16 v88, v118, v81
    v_dot2c_f32_bf16 v91, v119, v80
    v_dot2c_f32_bf16 v90, v119, v81
    v_and_b32 v82, 0xffff0000, v107
    v_lshrrev_b32 v83, 16, v107
    v_dot2c_f32_bf16 v85, v120, v82
    v_dot2c_f32_bf16 v84, v120, v83
    v_dot2c_f32_bf16 v87, v121, v82
    v_dot2c_f32_bf16 v86, v121, v83
    v_dot2c_f32_bf16 v89, v122, v82
    v_dot2c_f32_bf16 v88, v122, v83
    v_dot2c_f32_bf16 v91, v123, v82
    v_dot2c_f32_bf16 v90, v123, v83
    s_nop 0
    v_permlane32_swap_b32 v84, v88
    v_permlane32_swap_b32 v85, v89
    v_permlane32_swap_b32 v86, v90
    v_permlane32_swap_b32 v87, v91
    v_add_f32 v84, v84, v88
    v_add_f32 v85, v85, v89
    v_add_f32 v86, v86, v90
    v_add_f32 v87, v87, v91
    s_nop 0
    v_permlane16_swap_b32 v84, v86
    v_permlane16_swap_b32 v85, v87
    v_add_f32 v84, v84, v86
    v_add_f32 v85, v85, v87
    s_nop 0
    v_add_f32_dpp v84, v84, v84 row_ror:8 row_mask:0xf bank_mask:0xf
    v_add_f32_dpp v85, v85, v85 row_ror:8 row_mask:0xf bank_mask:0xf
    v_and_b32 v16, 7, v1
    v_lshlrev_b32 v16, 5, v16
    v_lshrrev_b32 v17, 4, v1
    v_lshl_add_u32 v16, v17, 3, v16
    s_lshl_b32 s16, s3, 8
    s_add_u32 s16, s16, 70656
    v_add_u32 v16, s16, v16
    ds_write_b64 v16, v[84:85]
    s_lshr_b32 s16, s3, 2
    s_lshl_b32 s17, s16, 10
    s_add_u32 s17, s17, 70656
    v_lshlrev_b32 v17, 2, v1
    v_add_u32 v16, s17, v17
    s_and_b32 s17, s29, 3
    s_lshl_b32 s17, s17, 1
    s_add_u32 s17, s17, s16
    s_mul_i32 s17, s17, 14336
    s_lshr_b32 s16, s29, 2
    s_lshl_b32 s16, s16, 8
    s_add_u32 s17, s17, s16
    s_add_u32 s17, s17, 0x6e1000
    s_and_b32 s16, s3, 3
    s_cmp_eq_u32 s16, 0
    s_cselect_b32 s17, s17, 0x7ffffff0
    s_cmp_lt_u32 s2, 224
    s_cselect_b32 s17, s17, 0x7ffffff0
    s_waitcnt lgkmcnt(0)
    s_barrier
    ds_read_b32 v84, v16 offset:0
    ds_read_b32 v85, v16 offset:256
    ds_read_b32 v86, v16 offset:512
    ds_read_b32 v87, v16 offset:768
    s_waitcnt lgkmcnt(2)
    v_add_f32 v84, v84, v85
    s_waitcnt lgkmcnt(0)
    v_add_f32 v86, v86, v87
    v_add_f32 v84, v84, v86
    v_or_b32 v84, 1, v84
    buffer_store_dword v84, v17, s[8:11], s17 offen sc1
    v_lshrrev_b32 v16, 4, v1
    v_mul_u32_u24 v16, 28672, v16
    v_and_b32 v17, 15, v1
    v_lshl_add_u32 v16, v17, 2, v16
    s_lshl_b32 s16, s29, 6
    s_add_u32 s16, s16, 0x6e1000
    s_add_u32 s17, s16, 14336
    s_mov_b32 s27, 0
adaLN_cond__sliding_block_cached__moe_arch_mod__prompt_kernel_gu23p:
    buffer_load_dword v84, v16, s[8:11], s16 offen sc1
    buffer_load_dword v85, v16, s[8:11], s17 offen sc1
    s_waitcnt vmcnt(0)
    v_min_u32 v86, v84, v85
    v_cmp_eq_u32 vcc, 0, v86
    s_cmp_lt_u32 s2, 224
    s_cselect_b64 s[62:63], -1, 0
    s_and_b64 vcc, vcc, s[62:63]
    s_add_u32 s27, s27, 1
    s_cmp_ge_u32 s27, 262144
    s_cbranch_scc1 adaLN_cond__sliding_block_cached__moe_arch_mod__prompt_kernel_gu23g
    s_cbranch_vccnz adaLN_cond__sliding_block_cached__moe_arch_mod__prompt_kernel_gu23p
adaLN_cond__sliding_block_cached__moe_arch_mod__prompt_kernel_gu23g:
    v_mov_b32 v86, v84
    s_nop 1
    v_permlane16_swap_b32 v84, v86
    v_add_f32 v84, v84, v86
    v_mov_b32 v87, v85
    s_nop 1
    v_permlane16_swap_b32 v85, v87
    v_add_f32 v85, v85, v87
    v_mov_b32 v86, v84
    s_nop 1
    v_permlane32_swap_b32 v84, v86
    v_add_f32 v84, v84, v86
    v_mov_b32 v87, v85
    s_nop 1
    v_permlane32_swap_b32 v85, v87
    v_add_f32 v85, v85, v87
    v_cvt_pk_bf16_f32 v86, v84, v85
    v_lshlrev_b32 v84, 16, v86
    v_and_b32 v85, 0xffff0000, v86
    v_mul_f32 v86, 0xbfb8aa3b, v84
    v_exp_f32 v86, v86
    s_nop 0
    v_add_f32 v86, 1.0, v86
    v_rcp_f32 v86, v86
    s_nop 0
    v_mul_f32 v84, v84, v86
    v_cvt_pk_bf16_f32 v84, v84, v84
    v_lshlrev_b32 v84, 16, v84
    v_mul_f32 v84, v84, v85
    v_cvt_pk_bf16_f32 v84, v84, v84
    v_lshlrev_b32 v84, 16, v84
    s_sub_u32 s16, s3, 4
    s_lshl_b32 s16, s16, 2
    s_add_u32 s17, s16, 0
    v_readlane_b32 s20, v84, s17
    s_lshr_b32 s4, s20, 16
    s_add_u32 s17, s16, 1
    v_readlane_b32 s21, v84, s17
    s_lshr_b32 s5, s21, 16
    s_add_u32 s17, s16, 2
    v_readlane_b32 s22, v84, s17
    s_lshr_b32 s6, s22, 16
    s_add_u32 s17, s16, 3
    v_readlane_b32 s23, v84, s17
    s_lshr_b32 s7, s23, 16
    v_dot2_f32_bf16 v45, v152, s20, 0
    v_dot2_f32_bf16 v44, v152, s4, 0
    v_dot2_f32_bf16 v47, v153, s20, 0
    v_dot2_f32_bf16 v46, v153, s4, 0
    v_dot2_f32_bf16 v49, v154, s20, 0
    v_dot2_f32_bf16 v48, v154, s4, 0
    v_dot2_f32_bf16 v51, v155, s20, 0
    v_dot2_f32_bf16 v50, v155, s4, 0
    v_dot2_f32_bf16 v53, v156, s20, 0
    v_dot2_f32_bf16 v52, v156, s4, 0
    v_dot2_f32_bf16 v55, v157, s20, 0
    v_dot2_f32_bf16 v54, v157, s4, 0
    v_dot2_f32_bf16 v57, v158, s20, 0
    v_dot2_f32_bf16 v56, v158, s4, 0
    v_dot2_f32_bf16 v59, v159, s20, 0
    v_dot2_f32_bf16 v58, v159, s4, 0
    v_dot2c_f32_bf16 v45, s21, v160
    v_dot2c_f32_bf16 v44, s5, v160
    v_dot2c_f32_bf16 v47, s21, v161
    v_dot2c_f32_bf16 v46, s5, v161
    v_dot2c_f32_bf16 v49, s21, v162
    v_dot2c_f32_bf16 v48, s5, v162
    v_dot2c_f32_bf16 v51, s21, v163
    v_dot2c_f32_bf16 v50, s5, v163
    v_dot2c_f32_bf16 v53, s21, v164
    v_dot2c_f32_bf16 v52, s5, v164
    v_dot2c_f32_bf16 v55, s21, v165
    v_dot2c_f32_bf16 v54, s5, v165
    v_dot2c_f32_bf16 v57, s21, v166
    v_dot2c_f32_bf16 v56, s5, v166
    v_dot2c_f32_bf16 v59, s21, v167
    v_dot2c_f32_bf16 v58, s5, v167
    v_dot2c_f32_bf16 v45, s22, v168
    v_dot2c_f32_bf16 v44, s6, v168
    v_dot2c_f32_bf16 v47, s22, v169
    v_dot2c_f32_bf16 v46, s6, v169
    v_dot2c_f32_bf16 v49, s22, v170
    v_dot2c_f32_bf16 v48, s6, v170
    v_dot2c_f32_bf16 v51, s22, v171
    v_dot2c_f32_bf16 v50, s6, v171
    v_dot2c_f32_bf16 v53, s22, v172
    v_dot2c_f32_bf16 v52, s6, v172
    v_dot2c_f32_bf16 v55, s22, v173
    v_dot2c_f32_bf16 v54, s6, v173
    v_dot2c_f32_bf16 v57, s22, v174
    v_dot2c_f32_bf16 v56, s6, v174
    v_dot2c_f32_bf16 v59, s22, v175
    v_dot2c_f32_bf16 v58, s6, v175
    v_dot2c_f32_bf16 v45, s23, v176
    v_dot2c_f32_bf16 v44, s7, v176
    v_dot2c_f32_bf16 v47, s23, v177
    v_dot2c_f32_bf16 v46, s7, v177
    v_dot2c_f32_bf16 v49, s23, v178
    v_dot2c_f32_bf16 v48, s7, v178
    v_dot2c_f32_bf16 v51, s23, v179
    v_dot2c_f32_bf16 v50, s7, v179
    v_dot2c_f32_bf16 v53, s23, v180
    v_dot2c_f32_bf16 v52, s7, v180
    v_dot2c_f32_bf16 v55, s23, v181
    v_dot2c_f32_bf16 v54, s7, v181
    v_dot2c_f32_bf16 v57, s23, v182
    v_dot2c_f32_bf16 v56, s7, v182
    v_dot2c_f32_bf16 v59, s23, v183
    v_dot2c_f32_bf16 v58, s7, v183
    s_sub_u32 s16, s3, 4
    s_lshl_b32 s16, s16, 12
    s_add_u32 s16, s16, 73728
    v_lshlrev_b32 v16, 5, v1
    v_add_u32 v16, s16, v16
    ds_write_b128 v16, v[44:47] offset:0
    ds_write_b128 v16, v[48:51] offset:16
    ds_write_b128 v16, v[52:55] offset:2048
    ds_write_b128 v16, v[56:59] offset:2064
    s_waitcnt lgkmcnt(0)
    s_barrier
    v_lshlrev_b32 v16, 3, v0
    v_add_u32 v17, 73728, v16
    ds_read_b64 v[84:85], v17 offset:0
    ds_read_b64 v[86:87], v17 offset:4096
    ds_read_b64 v[88:89], v17 offset:8192
    ds_read_b64 v[90:91], v17 offset:12288
    s_waitcnt lgkmcnt(2)
    v_pk_add_f32 v[84:85], v[84:85], v[86:87]
    s_waitcnt lgkmcnt(0)
    v_pk_add_f32 v[88:89], v[88:89], v[90:91]
    v_pk_add_f32 v[84:85], v[84:85], v[88:89]
    v_or_b32 v84, 1, v84
    v_or_b32 v85, 1, v85
    s_lshl_b32 s16, s29, 12
    s_add_u32 s16, s16, 0x600000
    s_cmp_lt_u32 s2, 224
    s_cselect_b32 s16, s16, 0x7ffffff0
    buffer_store_dwordx2 v[84:85], v16, s[8:11], s16 offen sc1
    s_cmp_lt_u32 s2, 224
    s_cbranch_scc1 adaLN_cond__sliding_block_cached__moe_arch_mod__prompt_kernel_end
    s_sub_u32 s16, s2, 224
    s_lshl_b32 s17, s16, 7
    s_add_u32 s17, s17, 0x600000
    v_lshrrev_b32 v16, 3, v0
    v_lshlrev_b32 v16, 12, v16
    v_and_b32 v17, 7, v0
    v_lshl_add_u32 v16, v17, 4, v16
    v_cmp_gt_u32 vcc, 256, v0
    v_bfrev_b32 v17, -2
    s_nop 0
    v_cndmask_b32 v17, v17, v16, vcc
    v_mov_b32 v19, 0
    v_cndmask_b32 v18, 1, v19, vcc
    s_lshl_b32 s18, s16, 6
    v_and_b32 v19, 31, v1
    v_lshlrev_b32 v19, 1, v19
    v_add_u32 v19, s18, v19
    s_mov_b32 s19, 0x541800
    buffer_load_ushort v95, v19, s[8:11], s19 offen sc1
    v_add_u32 v20, 66560, v19
    ds_read_u16 v96, v20
    ds_read_u16 v97, v20 offset:2048
    v_mov_b32 v94, v27
    v_cvt_pk_bf16_f32 v94, v94, v94
    v_lshlrev_b32 v94, 16, v94
    v_mul_f32 v94, 0xbfb8aa3b, v94
    v_exp_f32 v94, v94
    s_nop 0
    v_add_f32 v94, 1.0, v94
    v_rcp_f32 v94, v94
    s_nop 0
    v_cvt_pk_bf16_f32 v94, v94, v94
    v_lshlrev_b32 v94, 16, v94
    s_waitcnt vmcnt(0)
    v_lshlrev_b32 v95, 16, v95
    s_waitcnt lgkmcnt(1)
    v_lshlrev_b32 v96, 16, v96
    s_waitcnt lgkmcnt(0)
    v_lshlrev_b32 v97, 16, v97
    s_mov_b32 s27, 0
adaLN_cond__sliding_block_cached__moe_arch_mod__prompt_kernel_y24p:
    s_add_u32 s19, s17, 0x0
    buffer_load_dwordx4 v[44:47], v16, s[8:11], s19 offen sc1
    s_add_u32 s19, s17, 0x40000
    buffer_load_dwordx4 v[48:51], v16, s[8:11], s19 offen sc1
    s_add_u32 s19, s17, 0x80000
    buffer_load_dwordx4 v[52:55], v16, s[8:11], s19 offen sc1
    s_add_u32 s19, s17, 0xc0000
    buffer_load_dwordx4 v[56:59], v17, s[8:11], s19 offen sc1
    s_waitcnt vmcnt(0)
    v_min3_u32 v98, v56, v57, v58
    v_min_u32 v98, v98, v59
    v_or_b32 v98, v98, v18
    v_min3_u32 v98, v98, v44, v45
    v_min3_u32 v98, v98, v46, v47
    v_min3_u32 v98, v98, v48, v49
    v_min3_u32 v98, v98, v50, v51
    v_min3_u32 v98, v98, v52, v53
    v_min3_u32 v98, v98, v54, v55
    v_cmp_eq_u32 vcc, 0, v98
    s_add_u32 s27, s27, 1
    s_cmp_ge_u32 s27, 262144
    s_cbranch_scc1 adaLN_cond__sliding_block_cached__moe_arch_mod__prompt_kernel_y24g
    s_cbranch_vccnz adaLN_cond__sliding_block_cached__moe_arch_mod__prompt_kernel_y24p
adaLN_cond__sliding_block_cached__moe_arch_mod__prompt_kernel_y24g:
    v_pk_add_f32 v[44:45], v[44:45], v[52:53]
    v_pk_add_f32 v[46:47], v[46:47], v[54:55]
    v_pk_add_f32 v[48:49], v[48:49], v[56:57]
    v_pk_add_f32 v[50:51], v[50:51], v[58:59]
    v_pk_add_f32 v[44:45], v[44:45], v[48:49]
    v_pk_add_f32 v[46:47], v[46:47], v[50:51]
    s_nop 0
    v_add_f32_dpp v44, v44, v44 row_ror:8 row_mask:0xf bank_mask:0xf
    v_add_f32_dpp v45, v45, v45 row_ror:8 row_mask:0xf bank_mask:0xf
    v_add_f32_dpp v46, v46, v46 row_ror:8 row_mask:0xf bank_mask:0xf
    v_add_f32_dpp v47, v47, v47 row_ror:8 row_mask:0xf bank_mask:0xf
    s_nop 0
    v_permlane32_swap_b32 v44, v46
    v_permlane32_swap_b32 v45, v47
    v_add_f32 v44, v44, v46
    v_add_f32 v45, v45, v47
    s_nop 1
    v_permlane16_swap_b32 v44, v45
    v_add_f32 v44, v44, v45
    v_and_b32 v16, 7, v1
    v_lshlrev_b32 v16, 4, v16
    v_lshrrev_b32 v17, 4, v1
    v_lshl_add_u32 v16, v17, 2, v16
    s_lshl_b32 s19, s3, 7
    s_add_u32 s19, s19, 91136
    v_add_u32 v16, s19, v16
    ds_write_b32 v16, v44
    v_and_b32 v16, 31, v1
    v_lshlrev_b32 v16, 2, v16
    v_add_u32 v16, 91136, v16
    s_waitcnt lgkmcnt(0)
    s_barrier
    s_cmp_lg_u32 s3, 0
    s_cbranch_scc1 adaLN_cond__sliding_block_cached__moe_arch_mod__prompt_kernel_end
    ds_read_b32 v44, v16 offset:0
    ds_read_b32 v45, v16 offset:128
    ds_read_b32 v46, v16 offset:256
    ds_read_b32 v47, v16 offset:384
    ds_read_b32 v48, v16 offset:512
    ds_read_b32 v49, v16 offset:640
    ds_read_b32 v50, v16 offset:768
    ds_read_b32 v51, v16 offset:896
    s_waitcnt lgkmcnt(3)
    v_add_f32 v44, v44, v48
    s_waitcnt lgkmcnt(2)
    v_add_f32 v45, v45, v49
    s_waitcnt lgkmcnt(1)
    v_add_f32 v46, v46, v50
    s_waitcnt lgkmcnt(0)
    v_add_f32 v47, v47, v51
    v_add_f32 v44, v44, v46
    v_add_f32 v45, v45, v47
    v_add_f32 v44, v44, v45
    v_cvt_pk_bf16_f32 v44, v44, v44
    v_lshlrev_b32 v44, 16, v44
    v_mul_f32 v44, v44, v94
    v_cvt_pk_bf16_f32 v44, v44, v44
    v_lshlrev_b32 v44, 16, v44
    v_add_f32 v44, v44, v96
    v_cvt_pk_bf16_f32 v44, v44, v44
    v_lshlrev_b32 v44, 16, v44
    v_mul_f32 v44, v44, v95
    v_cvt_pk_bf16_f32 v44, v44, v44
    v_lshlrev_b32 v44, 16, v44
    v_add_f32 v44, v44, v97
    v_cvt_pk_bf16_f32 v44, v44, v44
    s_mov_b64 exec, 0xffffffff
    buffer_store_short v44, v19, s[68:71], s13 offen sc1
adaLN_cond__sliding_block_cached__moe_arch_mod__prompt_kernel_end:
    s_endpgm
adaLN_cond__sliding_block_cached__moe_arch_mod__prompt_kernel_n1r:
    s_mov_b32 s27, 0
adaLN_cond__sliding_block_cached__moe_arch_mod__prompt_kernel_n1p:
    buffer_load_dword v134, v132, s[64:67], 0 offen sc1
    s_waitcnt vmcnt(0)
    v_cmp_eq_u32 vcc, 0, v134
    s_cmp_eq_u32 s3, 0
    s_cselect_b64 s[62:63], -1, 0
    s_and_b64 vcc, vcc, s[62:63]
    s_add_u32 s27, s27, 1
    s_cmp_ge_u32 s27, 262144
    s_cbranch_scc1 adaLN_cond__sliding_block_cached__moe_arch_mod__prompt_kernel_n1g
    s_cbranch_vccnz adaLN_cond__sliding_block_cached__moe_arch_mod__prompt_kernel_n1p
adaLN_cond__sliding_block_cached__moe_arch_mod__prompt_kernel_n1g:
    s_waitcnt vmcnt(0) lgkmcnt(0)
    s_nop 15
    s_nop 3
    s_branch adaLN_cond__sliding_block_cached__moe_arch_mod__prompt_kernel_n1b
adaLN_cond__sliding_block_cached__moe_arch_mod__prompt_kernel_kv4r:
    s_waitcnt vmcnt(0) lgkmcnt(0)
    s_nop 15
    s_nop 3
    s_mov_b32 s27, 0
adaLN_cond__sliding_block_cached__moe_arch_mod__prompt_kernel_kv4p:
    buffer_load_dwordx4 v[12:15], v21, s[8:11], s18 offen sc1
    s_waitcnt vmcnt(0)
    v_xor_b32 v8, s28, v12
    v_xor_b32 v20, s28, v13
    v_or_b32 v8, v8, v20
    v_xor_b32 v20, s28, v14
    v_or_b32 v8, v8, v20
    v_xor_b32 v20, s28, v15
    v_or_b32 v8, v8, v20
    v_cmp_ne_u32 vcc, 0, v8
    s_add_u32 s27, s27, 1
    s_cmp_ge_u32 s27, 262144
    s_cbranch_scc1 adaLN_cond__sliding_block_cached__moe_arch_mod__prompt_kernel_kv4g
    s_cbranch_vccnz adaLN_cond__sliding_block_cached__moe_arch_mod__prompt_kernel_kv4p
adaLN_cond__sliding_block_cached__moe_arch_mod__prompt_kernel_kv4g:
    s_waitcnt vmcnt(0) lgkmcnt(0)
    s_nop 15
    s_nop 3
    s_branch adaLN_cond__sliding_block_cached__moe_arch_mod__prompt_kernel_kv4b
adaLN_cond__sliding_block_cached__moe_arch_mod__prompt_kernel_fixA:
    s_waitcnt vmcnt(0) lgkmcnt(0)
    s_nop 15
    s_nop 3
    s_lshr_b32 s16, s12, 3
    s_lshl_b32 s16, s16, 17
    s_add_u32 s16, s16, 0x400000
    v_add_u32 v8, s16, v2
    v_mov_b32 v16, 0xff7fffff
    v_mov_b32 v17, 0xff7fffff
    s_mov_b32 s16, 0
adaLN_cond__sliding_block_cached__moe_arch_mod__prompt_kernel_fixAm:
    s_add_u32 s17, s16, 0
    buffer_load_dwordx4 v[200:203], v8, s[8:11], s17 offen offset:0
    buffer_load_dwordx4 v[204:207], v8, s[8:11], s17 offen offset:1024
    buffer_load_dwordx4 v[208:211], v8, s[8:11], s17 offen offset:2048
    buffer_load_dwordx4 v[212:215], v8, s[8:11], s17 offen offset:3072
    s_waitcnt vmcnt(3)
    v_mfma_f32_16x16x32_bf16 v[184:187], v[200:203], v[152:155], 0
    v_mfma_f32_16x16x32_bf16 v[188:191], v[200:203], v[168:171], 0
    s_waitcnt vmcnt(2)
    v_mfma_f32_16x16x32_bf16 v[192:195], v[204:207], v[152:155], 0
    v_mfma_f32_16x16x32_bf16 v[196:199], v[204:207], v[168:171], 0
    s_waitcnt vmcnt(1)
    v_mfma_f32_16x16x32_bf16 v[184:187], v[208:211], v[156:159], v[184:187]
    v_mfma_f32_16x16x32_bf16 v[188:191], v[208:211], v[172:175], v[188:191]
    s_waitcnt vmcnt(0)
    v_mfma_f32_16x16x32_bf16 v[192:195], v[212:215], v[156:159], v[192:195]
    v_mfma_f32_16x16x32_bf16 v[196:199], v[212:215], v[172:175], v[196:199]
    s_add_u32 s17, s16, 4096
    buffer_load_dwordx4 v[200:203], v8, s[8:11], s17 offen offset:0
    buffer_load_dwordx4 v[204:207], v8, s[8:11], s17 offen offset:1024
    buffer_load_dwordx4 v[208:211], v8, s[8:11], s17 offen offset:2048
    buffer_load_dwordx4 v[212:215], v8, s[8:11], s17 offen offset:3072
    s_waitcnt vmcnt(3)
    v_mfma_f32_16x16x32_bf16 v[184:187], v[200:203], v[160:163], v[184:187]
    v_mfma_f32_16x16x32_bf16 v[188:191], v[200:203], v[176:179], v[188:191]
    s_waitcnt vmcnt(2)
    v_mfma_f32_16x16x32_bf16 v[192:195], v[204:207], v[160:163], v[192:195]
    v_mfma_f32_16x16x32_bf16 v[196:199], v[204:207], v[176:179], v[196:199]
    s_waitcnt vmcnt(1)
    v_mfma_f32_16x16x32_bf16 v[184:187], v[208:211], v[164:167], v[184:187]
    v_mfma_f32_16x16x32_bf16 v[188:191], v[208:211], v[180:183], v[188:191]
    s_waitcnt vmcnt(0)
    v_mfma_f32_16x16x32_bf16 v[192:195], v[212:215], v[164:167], v[192:195]
    v_mfma_f32_16x16x32_bf16 v[196:199], v[212:215], v[180:183], v[196:199]
    s_nop 3
    v_max3_f32 v16, v16, v184, v185
    v_max3_f32 v16, v16, v186, v187
    v_max3_f32 v17, v17, v188, v189
    v_max3_f32 v17, v17, v190, v191
    v_max3_f32 v16, v16, v192, v193
    v_max3_f32 v16, v16, v194, v195
    v_max3_f32 v17, v17, v196, v197
    v_max3_f32 v17, v17, v198, v199
    s_add_u32 s16, s16, 8192
    s_cmp_lt_u32 s16, 0x20000
    s_cbranch_scc1 adaLN_cond__sliding_block_cached__moe_arch_mod__prompt_kernel_fixAm
    v_mov_b32 v18, v16
    v_mov_b32 v19, v17
    s_nop 0
    v_permlane16_swap_b32 v16, v18
    v_permlane16_swap_b32 v17, v19
    v_max_f32 v16, v16, v18
    v_max_f32 v17, v17, v19
    v_mov_b32 v18, v16
    v_mov_b32 v19, v17
    s_nop 0
    v_permlane32_swap_b32 v16, v18
    v_permlane32_swap_b32 v17, v19
    v_max_f32 v16, v16, v18
    v_max_f32 v17, v17, v19
    v_sub_f32 v216, 0, v16
    v_sub_f32 v217, 0, v16
    v_sub_f32 v218, 0, v16
    v_sub_f32 v219, 0, v16
    v_sub_f32 v220, 0, v17
    v_sub_f32 v221, 0, v17
    v_sub_f32 v222, 0, v17
    v_sub_f32 v223, 0, v17
    s_mov_b32 s17, 0x0
    buffer_load_dwordx4 v[200:203], v8, s[8:11], s17 offen offset:0
    buffer_load_dwordx4 v[204:207], v8, s[8:11], s17 offen offset:1024
    buffer_load_dwordx4 v[208:211], v8, s[8:11], s17 offen offset:2048
    buffer_load_dwordx4 v[212:215], v8, s[8:11], s17 offen offset:3072
    s_waitcnt vmcnt(3)
    v_mfma_f32_16x16x32_bf16 v[184:187], v[200:203], v[152:155], v[216:219]
    v_mfma_f32_16x16x32_bf16 v[188:191], v[200:203], v[168:171], v[220:223]
    s_waitcnt vmcnt(2)
    v_mfma_f32_16x16x32_bf16 v[192:195], v[204:207], v[152:155], v[216:219]
    v_mfma_f32_16x16x32_bf16 v[196:199], v[204:207], v[168:171], v[220:223]
    s_waitcnt vmcnt(1)
    v_mfma_f32_16x16x32_bf16 v[184:187], v[208:211], v[156:159], v[184:187]
    v_mfma_f32_16x16x32_bf16 v[188:191], v[208:211], v[172:175], v[188:191]
    s_waitcnt vmcnt(0)
    v_mfma_f32_16x16x32_bf16 v[192:195], v[212:215], v[156:159], v[192:195]
    v_mfma_f32_16x16x32_bf16 v[196:199], v[212:215], v[172:175], v[196:199]
    s_mov_b32 s17, 0x1000
    buffer_load_dwordx4 v[200:203], v8, s[8:11], s17 offen offset:0
    buffer_load_dwordx4 v[204:207], v8, s[8:11], s17 offen offset:1024
    buffer_load_dwordx4 v[208:211], v8, s[8:11], s17 offen offset:2048
    buffer_load_dwordx4 v[212:215], v8, s[8:11], s17 offen offset:3072
    s_waitcnt vmcnt(3)
    v_mfma_f32_16x16x32_bf16 v[184:187], v[200:203], v[160:163], v[184:187]
    v_mfma_f32_16x16x32_bf16 v[188:191], v[200:203], v[176:179], v[188:191]
    s_waitcnt vmcnt(2)
    v_mfma_f32_16x16x32_bf16 v[192:195], v[204:207], v[160:163], v[192:195]
    v_mfma_f32_16x16x32_bf16 v[196:199], v[204:207], v[176:179], v[196:199]
    s_waitcnt vmcnt(1)
    v_mfma_f32_16x16x32_bf16 v[184:187], v[208:211], v[164:167], v[184:187]
    v_mfma_f32_16x16x32_bf16 v[188:191], v[208:211], v[180:183], v[188:191]
    s_waitcnt vmcnt(0)
    v_mfma_f32_16x16x32_bf16 v[192:195], v[212:215], v[164:167], v[192:195]
    v_mfma_f32_16x16x32_bf16 v[196:199], v[212:215], v[180:183], v[196:199]
    s_nop 3
    v_exp_f32 v184, v184
    v_exp_f32 v185, v185
    s_nop 0
    v_add_f32 v9, v184, v185
    v_cvt_pk_bf16_f32 v24, v184, v185
    v_exp_f32 v186, v186
    v_exp_f32 v187, v187
    v_add_f32 v9, v9, v186
    v_add_f32 v9, v9, v187
    v_cvt_pk_bf16_f32 v25, v186, v187
    v_exp_f32 v188, v188
    v_exp_f32 v189, v189
    s_nop 0
    v_add_f32 v10, v188, v189
    v_cvt_pk_bf16_f32 v28, v188, v189
    v_exp_f32 v190, v190
    v_exp_f32 v191, v191
    v_add_f32 v10, v10, v190
    v_add_f32 v10, v10, v191
    v_cvt_pk_bf16_f32 v29, v190, v191
    v_exp_f32 v192, v192
    v_exp_f32 v193, v193
    v_add_f32 v9, v9, v192
    v_add_f32 v9, v9, v193
    v_cvt_pk_bf16_f32 v26, v192, v193
    v_exp_f32 v194, v194
    v_exp_f32 v195, v195
    v_add_f32 v9, v9, v194
    v_add_f32 v9, v9, v195
    v_cvt_pk_bf16_f32 v27, v194, v195
    v_exp_f32 v196, v196
    v_exp_f32 v197, v197
    v_add_f32 v10, v10, v196
    v_add_f32 v10, v10, v197
    v_cvt_pk_bf16_f32 v30, v196, v197
    v_exp_f32 v198, v198
    v_exp_f32 v199, v199
    v_add_f32 v10, v10, v198
    v_add_f32 v10, v10, v199
    v_cvt_pk_bf16_f32 v31, v198, v199
    s_mov_b32 s17, 0x2000
    buffer_load_dwordx4 v[200:203], v8, s[8:11], s17 offen offset:0
    buffer_load_dwordx4 v[204:207], v8, s[8:11], s17 offen offset:1024
    buffer_load_dwordx4 v[208:211], v8, s[8:11], s17 offen offset:2048
    buffer_load_dwordx4 v[212:215], v8, s[8:11], s17 offen offset:3072
    s_waitcnt vmcnt(3)
    v_mfma_f32_16x16x32_bf16 v[184:187], v[200:203], v[152:155], v[216:219]
    v_mfma_f32_16x16x32_bf16 v[188:191], v[200:203], v[168:171], v[220:223]
    s_waitcnt vmcnt(2)
    v_mfma_f32_16x16x32_bf16 v[192:195], v[204:207], v[152:155], v[216:219]
    v_mfma_f32_16x16x32_bf16 v[196:199], v[204:207], v[168:171], v[220:223]
    s_waitcnt vmcnt(1)
    v_mfma_f32_16x16x32_bf16 v[184:187], v[208:211], v[156:159], v[184:187]
    v_mfma_f32_16x16x32_bf16 v[188:191], v[208:211], v[172:175], v[188:191]
    s_waitcnt vmcnt(0)
    v_mfma_f32_16x16x32_bf16 v[192:195], v[212:215], v[156:159], v[192:195]
    v_mfma_f32_16x16x32_bf16 v[196:199], v[212:215], v[172:175], v[196:199]
    s_mov_b32 s17, 0x3000
    buffer_load_dwordx4 v[200:203], v8, s[8:11], s17 offen offset:0
    buffer_load_dwordx4 v[204:207], v8, s[8:11], s17 offen offset:1024
    buffer_load_dwordx4 v[208:211], v8, s[8:11], s17 offen offset:2048
    buffer_load_dwordx4 v[212:215], v8, s[8:11], s17 offen offset:3072
    s_waitcnt vmcnt(3)
    v_mfma_f32_16x16x32_bf16 v[184:187], v[200:203], v[160:163], v[184:187]
    v_mfma_f32_16x16x32_bf16 v[188:191], v[200:203], v[176:179], v[188:191]
    s_waitcnt vmcnt(2)
    v_mfma_f32_16x16x32_bf16 v[192:195], v[204:207], v[160:163], v[192:195]
    v_mfma_f32_16x16x32_bf16 v[196:199], v[204:207], v[176:179], v[196:199]
    s_waitcnt vmcnt(1)
    v_mfma_f32_16x16x32_bf16 v[184:187], v[208:211], v[164:167], v[184:187]
    v_mfma_f32_16x16x32_bf16 v[188:191], v[208:211], v[180:183], v[188:191]
    s_waitcnt vmcnt(0)
    v_mfma_f32_16x16x32_bf16 v[192:195], v[212:215], v[164:167], v[192:195]
    v_mfma_f32_16x16x32_bf16 v[196:199], v[212:215], v[180:183], v[196:199]
    s_nop 3
    v_exp_f32 v184, v184
    v_exp_f32 v185, v185
    v_add_f32 v9, v9, v184
    v_add_f32 v9, v9, v185
    v_cvt_pk_bf16_f32 v32, v184, v185
    v_exp_f32 v186, v186
    v_exp_f32 v187, v187
    v_add_f32 v9, v9, v186
    v_add_f32 v9, v9, v187
    v_cvt_pk_bf16_f32 v33, v186, v187
    v_exp_f32 v188, v188
    v_exp_f32 v189, v189
    v_add_f32 v10, v10, v188
    v_add_f32 v10, v10, v189
    v_cvt_pk_bf16_f32 v36, v188, v189
    v_exp_f32 v190, v190
    v_exp_f32 v191, v191
    v_add_f32 v10, v10, v190
    v_add_f32 v10, v10, v191
    v_cvt_pk_bf16_f32 v37, v190, v191
    v_exp_f32 v192, v192
    v_exp_f32 v193, v193
    v_add_f32 v9, v9, v192
    v_add_f32 v9, v9, v193
    v_cvt_pk_bf16_f32 v34, v192, v193
    v_exp_f32 v194, v194
    v_exp_f32 v195, v195
    v_add_f32 v9, v9, v194
    v_add_f32 v9, v9, v195
    v_cvt_pk_bf16_f32 v35, v194, v195
    v_exp_f32 v196, v196
    v_exp_f32 v197, v197
    v_add_f32 v10, v10, v196
    v_add_f32 v10, v10, v197
    v_cvt_pk_bf16_f32 v38, v196, v197
    v_exp_f32 v198, v198
    v_exp_f32 v199, v199
    v_add_f32 v10, v10, v198
    v_add_f32 v10, v10, v199
    v_cvt_pk_bf16_f32 v39, v198, v199
    s_mov_b32 s17, 0x4000
    buffer_load_dwordx4 v[200:203], v8, s[8:11], s17 offen offset:0
    buffer_load_dwordx4 v[204:207], v8, s[8:11], s17 offen offset:1024
    buffer_load_dwordx4 v[208:211], v8, s[8:11], s17 offen offset:2048
    buffer_load_dwordx4 v[212:215], v8, s[8:11], s17 offen offset:3072
    s_waitcnt vmcnt(3)
    v_mfma_f32_16x16x32_bf16 v[184:187], v[200:203], v[152:155], v[216:219]
    v_mfma_f32_16x16x32_bf16 v[188:191], v[200:203], v[168:171], v[220:223]
    s_waitcnt vmcnt(2)
    v_mfma_f32_16x16x32_bf16 v[192:195], v[204:207], v[152:155], v[216:219]
    v_mfma_f32_16x16x32_bf16 v[196:199], v[204:207], v[168:171], v[220:223]
    s_waitcnt vmcnt(1)
    v_mfma_f32_16x16x32_bf16 v[184:187], v[208:211], v[156:159], v[184:187]
    v_mfma_f32_16x16x32_bf16 v[188:191], v[208:211], v[172:175], v[188:191]
    s_waitcnt vmcnt(0)
    v_mfma_f32_16x16x32_bf16 v[192:195], v[212:215], v[156:159], v[192:195]
    v_mfma_f32_16x16x32_bf16 v[196:199], v[212:215], v[172:175], v[196:199]
    s_mov_b32 s17, 0x5000
    buffer_load_dwordx4 v[200:203], v8, s[8:11], s17 offen offset:0
    buffer_load_dwordx4 v[204:207], v8, s[8:11], s17 offen offset:1024
    buffer_load_dwordx4 v[208:211], v8, s[8:11], s17 offen offset:2048
    buffer_load_dwordx4 v[212:215], v8, s[8:11], s17 offen offset:3072
    s_waitcnt vmcnt(3)
    v_mfma_f32_16x16x32_bf16 v[184:187], v[200:203], v[160:163], v[184:187]
    v_mfma_f32_16x16x32_bf16 v[188:191], v[200:203], v[176:179], v[188:191]
    s_waitcnt vmcnt(2)
    v_mfma_f32_16x16x32_bf16 v[192:195], v[204:207], v[160:163], v[192:195]
    v_mfma_f32_16x16x32_bf16 v[196:199], v[204:207], v[176:179], v[196:199]
    s_waitcnt vmcnt(1)
    v_mfma_f32_16x16x32_bf16 v[184:187], v[208:211], v[164:167], v[184:187]
    v_mfma_f32_16x16x32_bf16 v[188:191], v[208:211], v[180:183], v[188:191]
    s_waitcnt vmcnt(0)
    v_mfma_f32_16x16x32_bf16 v[192:195], v[212:215], v[164:167], v[192:195]
    v_mfma_f32_16x16x32_bf16 v[196:199], v[212:215], v[180:183], v[196:199]
    s_nop 3
    v_exp_f32 v184, v184
    v_exp_f32 v185, v185
    v_add_f32 v9, v9, v184
    v_add_f32 v9, v9, v185
    v_cvt_pk_bf16_f32 v40, v184, v185
    v_exp_f32 v186, v186
    v_exp_f32 v187, v187
    v_add_f32 v9, v9, v186
    v_add_f32 v9, v9, v187
    v_cvt_pk_bf16_f32 v41, v186, v187
    v_exp_f32 v188, v188
    v_exp_f32 v189, v189
    v_add_f32 v10, v10, v188
    v_add_f32 v10, v10, v189
    v_cvt_pk_bf16_f32 v44, v188, v189
    v_exp_f32 v190, v190
    v_exp_f32 v191, v191
    v_add_f32 v10, v10, v190
    v_add_f32 v10, v10, v191
    v_cvt_pk_bf16_f32 v45, v190, v191
    v_exp_f32 v192, v192
    v_exp_f32 v193, v193
    v_add_f32 v9, v9, v192
    v_add_f32 v9, v9, v193
    v_cvt_pk_bf16_f32 v42, v192, v193
    v_exp_f32 v194, v194
    v_exp_f32 v195, v195
    v_add_f32 v9, v9, v194
    v_add_f32 v9, v9, v195
    v_cvt_pk_bf16_f32 v43, v194, v195
    v_exp_f32 v196, v196
    v_exp_f32 v197, v197
    v_add_f32 v10, v10, v196
    v_add_f32 v10, v10, v197
    v_cvt_pk_bf16_f32 v46, v196, v197
    v_exp_f32 v198, v198
    v_exp_f32 v199, v199
    v_add_f32 v10, v10, v198
    v_add_f32 v10, v10, v199
    v_cvt_pk_bf16_f32 v47, v198, v199
    s_mov_b32 s17, 0x6000
    buffer_load_dwordx4 v[200:203], v8, s[8:11], s17 offen offset:0
    buffer_load_dwordx4 v[204:207], v8, s[8:11], s17 offen offset:1024
    buffer_load_dwordx4 v[208:211], v8, s[8:11], s17 offen offset:2048
    buffer_load_dwordx4 v[212:215], v8, s[8:11], s17 offen offset:3072
    s_waitcnt vmcnt(3)
    v_mfma_f32_16x16x32_bf16 v[184:187], v[200:203], v[152:155], v[216:219]
    v_mfma_f32_16x16x32_bf16 v[188:191], v[200:203], v[168:171], v[220:223]
    s_waitcnt vmcnt(2)
    v_mfma_f32_16x16x32_bf16 v[192:195], v[204:207], v[152:155], v[216:219]
    v_mfma_f32_16x16x32_bf16 v[196:199], v[204:207], v[168:171], v[220:223]
    s_waitcnt vmcnt(1)
    v_mfma_f32_16x16x32_bf16 v[184:187], v[208:211], v[156:159], v[184:187]
    v_mfma_f32_16x16x32_bf16 v[188:191], v[208:211], v[172:175], v[188:191]
    s_waitcnt vmcnt(0)
    v_mfma_f32_16x16x32_bf16 v[192:195], v[212:215], v[156:159], v[192:195]
    v_mfma_f32_16x16x32_bf16 v[196:199], v[212:215], v[172:175], v[196:199]
    s_mov_b32 s17, 0x7000
    buffer_load_dwordx4 v[200:203], v8, s[8:11], s17 offen offset:0
    buffer_load_dwordx4 v[204:207], v8, s[8:11], s17 offen offset:1024
    buffer_load_dwordx4 v[208:211], v8, s[8:11], s17 offen offset:2048
    buffer_load_dwordx4 v[212:215], v8, s[8:11], s17 offen offset:3072
    s_waitcnt vmcnt(3)
    v_mfma_f32_16x16x32_bf16 v[184:187], v[200:203], v[160:163], v[184:187]
    v_mfma_f32_16x16x32_bf16 v[188:191], v[200:203], v[176:179], v[188:191]
    s_waitcnt vmcnt(2)
    v_mfma_f32_16x16x32_bf16 v[192:195], v[204:207], v[160:163], v[192:195]
    v_mfma_f32_16x16x32_bf16 v[196:199], v[204:207], v[176:179], v[196:199]
    s_waitcnt vmcnt(1)
    v_mfma_f32_16x16x32_bf16 v[184:187], v[208:211], v[164:167], v[184:187]
    v_mfma_f32_16x16x32_bf16 v[188:191], v[208:211], v[180:183], v[188:191]
    s_waitcnt vmcnt(0)
    v_mfma_f32_16x16x32_bf16 v[192:195], v[212:215], v[164:167], v[192:195]
    v_mfma_f32_16x16x32_bf16 v[196:199], v[212:215], v[180:183], v[196:199]
    s_nop 3
    v_exp_f32 v184, v184
    v_exp_f32 v185, v185
    v_add_f32 v9, v9, v184
    v_add_f32 v9, v9, v185
    v_cvt_pk_bf16_f32 v48, v184, v185
    v_exp_f32 v186, v186
    v_exp_f32 v187, v187
    v_add_f32 v9, v9, v186
    v_add_f32 v9, v9, v187
    v_cvt_pk_bf16_f32 v49, v186, v187
    v_exp_f32 v188, v188
    v_exp_f32 v189, v189
    v_add_f32 v10, v10, v188
    v_add_f32 v10, v10, v189
    v_cvt_pk_bf16_f32 v52, v188, v189
    v_exp_f32 v190, v190
    v_exp_f32 v191, v191
    v_add_f32 v10, v10, v190
    v_add_f32 v10, v10, v191
    v_cvt_pk_bf16_f32 v53, v190, v191
    v_exp_f32 v192, v192
    v_exp_f32 v193, v193
    v_add_f32 v9, v9, v192
    v_add_f32 v9, v9, v193
    v_cvt_pk_bf16_f32 v50, v192, v193
    v_exp_f32 v194, v194
    v_exp_f32 v195, v195
    v_add_f32 v9, v9, v194
    v_add_f32 v9, v9, v195
    v_cvt_pk_bf16_f32 v51, v194, v195
    v_exp_f32 v196, v196
    v_exp_f32 v197, v197
    v_add_f32 v10, v10, v196
    v_add_f32 v10, v10, v197
    v_cvt_pk_bf16_f32 v54, v196, v197
    v_exp_f32 v198, v198
    v_exp_f32 v199, v199
    v_add_f32 v10, v10, v198
    v_add_f32 v10, v10, v199
    v_cvt_pk_bf16_f32 v55, v198, v199
    s_mov_b32 s17, 0x8000
    buffer_load_dwordx4 v[200:203], v8, s[8:11], s17 offen offset:0
    buffer_load_dwordx4 v[204:207], v8, s[8:11], s17 offen offset:1024
    buffer_load_dwordx4 v[208:211], v8, s[8:11], s17 offen offset:2048
    buffer_load_dwordx4 v[212:215], v8, s[8:11], s17 offen offset:3072
    s_waitcnt vmcnt(3)
    v_mfma_f32_16x16x32_bf16 v[184:187], v[200:203], v[152:155], v[216:219]
    v_mfma_f32_16x16x32_bf16 v[188:191], v[200:203], v[168:171], v[220:223]
    s_waitcnt vmcnt(2)
    v_mfma_f32_16x16x32_bf16 v[192:195], v[204:207], v[152:155], v[216:219]
    v_mfma_f32_16x16x32_bf16 v[196:199], v[204:207], v[168:171], v[220:223]
    s_waitcnt vmcnt(1)
    v_mfma_f32_16x16x32_bf16 v[184:187], v[208:211], v[156:159], v[184:187]
    v_mfma_f32_16x16x32_bf16 v[188:191], v[208:211], v[172:175], v[188:191]
    s_waitcnt vmcnt(0)
    v_mfma_f32_16x16x32_bf16 v[192:195], v[212:215], v[156:159], v[192:195]
    v_mfma_f32_16x16x32_bf16 v[196:199], v[212:215], v[172:175], v[196:199]
    s_mov_b32 s17, 0x9000
    buffer_load_dwordx4 v[200:203], v8, s[8:11], s17 offen offset:0
    buffer_load_dwordx4 v[204:207], v8, s[8:11], s17 offen offset:1024
    buffer_load_dwordx4 v[208:211], v8, s[8:11], s17 offen offset:2048
    buffer_load_dwordx4 v[212:215], v8, s[8:11], s17 offen offset:3072
    s_waitcnt vmcnt(3)
    v_mfma_f32_16x16x32_bf16 v[184:187], v[200:203], v[160:163], v[184:187]
    v_mfma_f32_16x16x32_bf16 v[188:191], v[200:203], v[176:179], v[188:191]
    s_waitcnt vmcnt(2)
    v_mfma_f32_16x16x32_bf16 v[192:195], v[204:207], v[160:163], v[192:195]
    v_mfma_f32_16x16x32_bf16 v[196:199], v[204:207], v[176:179], v[196:199]
    s_waitcnt vmcnt(1)
    v_mfma_f32_16x16x32_bf16 v[184:187], v[208:211], v[164:167], v[184:187]
    v_mfma_f32_16x16x32_bf16 v[188:191], v[208:211], v[180:183], v[188:191]
    s_waitcnt vmcnt(0)
    v_mfma_f32_16x16x32_bf16 v[192:195], v[212:215], v[164:167], v[192:195]
    v_mfma_f32_16x16x32_bf16 v[196:199], v[212:215], v[180:183], v[196:199]
    s_nop 3
    v_exp_f32 v184, v184
    v_exp_f32 v185, v185
    v_add_f32 v9, v9, v184
    v_add_f32 v9, v9, v185
    v_cvt_pk_bf16_f32 v56, v184, v185
    v_exp_f32 v186, v186
    v_exp_f32 v187, v187
    v_add_f32 v9, v9, v186
    v_add_f32 v9, v9, v187
    v_cvt_pk_bf16_f32 v57, v186, v187
    v_exp_f32 v188, v188
    v_exp_f32 v189, v189
    v_add_f32 v10, v10, v188
    v_add_f32 v10, v10, v189
    v_cvt_pk_bf16_f32 v60, v188, v189
    v_exp_f32 v190, v190
    v_exp_f32 v191, v191
    v_add_f32 v10, v10, v190
    v_add_f32 v10, v10, v191
    v_cvt_pk_bf16_f32 v61, v190, v191
    v_exp_f32 v192, v192
    v_exp_f32 v193, v193
    v_add_f32 v9, v9, v192
    v_add_f32 v9, v9, v193
    v_cvt_pk_bf16_f32 v58, v192, v193
    v_exp_f32 v194, v194
    v_exp_f32 v195, v195
    v_add_f32 v9, v9, v194
    v_add_f32 v9, v9, v195
    v_cvt_pk_bf16_f32 v59, v194, v195
    v_exp_f32 v196, v196
    v_exp_f32 v197, v197
    v_add_f32 v10, v10, v196
    v_add_f32 v10, v10, v197
    v_cvt_pk_bf16_f32 v62, v196, v197
    v_exp_f32 v198, v198
    v_exp_f32 v199, v199
    v_add_f32 v10, v10, v198
    v_add_f32 v10, v10, v199
    v_cvt_pk_bf16_f32 v63, v198, v199
    s_mov_b32 s17, 0xa000
    buffer_load_dwordx4 v[200:203], v8, s[8:11], s17 offen offset:0
    buffer_load_dwordx4 v[204:207], v8, s[8:11], s17 offen offset:1024
    buffer_load_dwordx4 v[208:211], v8, s[8:11], s17 offen offset:2048
    buffer_load_dwordx4 v[212:215], v8, s[8:11], s17 offen offset:3072
    s_waitcnt vmcnt(3)
    v_mfma_f32_16x16x32_bf16 v[184:187], v[200:203], v[152:155], v[216:219]
    v_mfma_f32_16x16x32_bf16 v[188:191], v[200:203], v[168:171], v[220:223]
    s_waitcnt vmcnt(2)
    v_mfma_f32_16x16x32_bf16 v[192:195], v[204:207], v[152:155], v[216:219]
    v_mfma_f32_16x16x32_bf16 v[196:199], v[204:207], v[168:171], v[220:223]
    s_waitcnt vmcnt(1)
    v_mfma_f32_16x16x32_bf16 v[184:187], v[208:211], v[156:159], v[184:187]
    v_mfma_f32_16x16x32_bf16 v[188:191], v[208:211], v[172:175], v[188:191]
    s_waitcnt vmcnt(0)
    v_mfma_f32_16x16x32_bf16 v[192:195], v[212:215], v[156:159], v[192:195]
    v_mfma_f32_16x16x32_bf16 v[196:199], v[212:215], v[172:175], v[196:199]
    s_mov_b32 s17, 0xb000
    buffer_load_dwordx4 v[200:203], v8, s[8:11], s17 offen offset:0
    buffer_load_dwordx4 v[204:207], v8, s[8:11], s17 offen offset:1024
    buffer_load_dwordx4 v[208:211], v8, s[8:11], s17 offen offset:2048
    buffer_load_dwordx4 v[212:215], v8, s[8:11], s17 offen offset:3072
    s_waitcnt vmcnt(3)
    v_mfma_f32_16x16x32_bf16 v[184:187], v[200:203], v[160:163], v[184:187]
    v_mfma_f32_16x16x32_bf16 v[188:191], v[200:203], v[176:179], v[188:191]
    s_waitcnt vmcnt(2)
    v_mfma_f32_16x16x32_bf16 v[192:195], v[204:207], v[160:163], v[192:195]
    v_mfma_f32_16x16x32_bf16 v[196:199], v[204:207], v[176:179], v[196:199]
    s_waitcnt vmcnt(1)
    v_mfma_f32_16x16x32_bf16 v[184:187], v[208:211], v[164:167], v[184:187]
    v_mfma_f32_16x16x32_bf16 v[188:191], v[208:211], v[180:183], v[188:191]
    s_waitcnt vmcnt(0)
    v_mfma_f32_16x16x32_bf16 v[192:195], v[212:215], v[164:167], v[192:195]
    v_mfma_f32_16x16x32_bf16 v[196:199], v[212:215], v[180:183], v[196:199]
    s_nop 3
    v_exp_f32 v184, v184
    v_exp_f32 v185, v185
    v_add_f32 v9, v9, v184
    v_add_f32 v9, v9, v185
    v_cvt_pk_bf16_f32 v64, v184, v185
    v_exp_f32 v186, v186
    v_exp_f32 v187, v187
    v_add_f32 v9, v9, v186
    v_add_f32 v9, v9, v187
    v_cvt_pk_bf16_f32 v65, v186, v187
    v_exp_f32 v188, v188
    v_exp_f32 v189, v189
    v_add_f32 v10, v10, v188
    v_add_f32 v10, v10, v189
    v_cvt_pk_bf16_f32 v68, v188, v189
    v_exp_f32 v190, v190
    v_exp_f32 v191, v191
    v_add_f32 v10, v10, v190
    v_add_f32 v10, v10, v191
    v_cvt_pk_bf16_f32 v69, v190, v191
    v_exp_f32 v192, v192
    v_exp_f32 v193, v193
    v_add_f32 v9, v9, v192
    v_add_f32 v9, v9, v193
    v_cvt_pk_bf16_f32 v66, v192, v193
    v_exp_f32 v194, v194
    v_exp_f32 v195, v195
    v_add_f32 v9, v9, v194
    v_add_f32 v9, v9, v195
    v_cvt_pk_bf16_f32 v67, v194, v195
    v_exp_f32 v196, v196
    v_exp_f32 v197, v197
    v_add_f32 v10, v10, v196
    v_add_f32 v10, v10, v197
    v_cvt_pk_bf16_f32 v70, v196, v197
    v_exp_f32 v198, v198
    v_exp_f32 v199, v199
    v_add_f32 v10, v10, v198
    v_add_f32 v10, v10, v199
    v_cvt_pk_bf16_f32 v71, v198, v199
    s_mov_b32 s17, 0xc000
    buffer_load_dwordx4 v[200:203], v8, s[8:11], s17 offen offset:0
    buffer_load_dwordx4 v[204:207], v8, s[8:11], s17 offen offset:1024
    buffer_load_dwordx4 v[208:211], v8, s[8:11], s17 offen offset:2048
    buffer_load_dwordx4 v[212:215], v8, s[8:11], s17 offen offset:3072
    s_waitcnt vmcnt(3)
    v_mfma_f32_16x16x32_bf16 v[184:187], v[200:203], v[152:155], v[216:219]
    v_mfma_f32_16x16x32_bf16 v[188:191], v[200:203], v[168:171], v[220:223]
    s_waitcnt vmcnt(2)
    v_mfma_f32_16x16x32_bf16 v[192:195], v[204:207], v[152:155], v[216:219]
    v_mfma_f32_16x16x32_bf16 v[196:199], v[204:207], v[168:171], v[220:223]
    s_waitcnt vmcnt(1)
    v_mfma_f32_16x16x32_bf16 v[184:187], v[208:211], v[156:159], v[184:187]
    v_mfma_f32_16x16x32_bf16 v[188:191], v[208:211], v[172:175], v[188:191]
    s_waitcnt vmcnt(0)
    v_mfma_f32_16x16x32_bf16 v[192:195], v[212:215], v[156:159], v[192:195]
    v_mfma_f32_16x16x32_bf16 v[196:199], v[212:215], v[172:175], v[196:199]
    s_mov_b32 s17, 0xd000
    buffer_load_dwordx4 v[200:203], v8, s[8:11], s17 offen offset:0
    buffer_load_dwordx4 v[204:207], v8, s[8:11], s17 offen offset:1024
    buffer_load_dwordx4 v[208:211], v8, s[8:11], s17 offen offset:2048
    buffer_load_dwordx4 v[212:215], v8, s[8:11], s17 offen offset:3072
    s_waitcnt vmcnt(3)
    v_mfma_f32_16x16x32_bf16 v[184:187], v[200:203], v[160:163], v[184:187]
    v_mfma_f32_16x16x32_bf16 v[188:191], v[200:203], v[176:179], v[188:191]
    s_waitcnt vmcnt(2)
    v_mfma_f32_16x16x32_bf16 v[192:195], v[204:207], v[160:163], v[192:195]
    v_mfma_f32_16x16x32_bf16 v[196:199], v[204:207], v[176:179], v[196:199]
    s_waitcnt vmcnt(1)
    v_mfma_f32_16x16x32_bf16 v[184:187], v[208:211], v[164:167], v[184:187]
    v_mfma_f32_16x16x32_bf16 v[188:191], v[208:211], v[180:183], v[188:191]
    s_waitcnt vmcnt(0)
    v_mfma_f32_16x16x32_bf16 v[192:195], v[212:215], v[164:167], v[192:195]
    v_mfma_f32_16x16x32_bf16 v[196:199], v[212:215], v[180:183], v[196:199]
    s_nop 3
    v_exp_f32 v184, v184
    v_exp_f32 v185, v185
    v_add_f32 v9, v9, v184
    v_add_f32 v9, v9, v185
    v_cvt_pk_bf16_f32 v72, v184, v185
    v_exp_f32 v186, v186
    v_exp_f32 v187, v187
    v_add_f32 v9, v9, v186
    v_add_f32 v9, v9, v187
    v_cvt_pk_bf16_f32 v73, v186, v187
    v_exp_f32 v188, v188
    v_exp_f32 v189, v189
    v_add_f32 v10, v10, v188
    v_add_f32 v10, v10, v189
    v_cvt_pk_bf16_f32 v76, v188, v189
    v_exp_f32 v190, v190
    v_exp_f32 v191, v191
    v_add_f32 v10, v10, v190
    v_add_f32 v10, v10, v191
    v_cvt_pk_bf16_f32 v77, v190, v191
    v_exp_f32 v192, v192
    v_exp_f32 v193, v193
    v_add_f32 v9, v9, v192
    v_add_f32 v9, v9, v193
    v_cvt_pk_bf16_f32 v74, v192, v193
    v_exp_f32 v194, v194
    v_exp_f32 v195, v195
    v_add_f32 v9, v9, v194
    v_add_f32 v9, v9, v195
    v_cvt_pk_bf16_f32 v75, v194, v195
    v_exp_f32 v196, v196
    v_exp_f32 v197, v197
    v_add_f32 v10, v10, v196
    v_add_f32 v10, v10, v197
    v_cvt_pk_bf16_f32 v78, v196, v197
    v_exp_f32 v198, v198
    v_exp_f32 v199, v199
    v_add_f32 v10, v10, v198
    v_add_f32 v10, v10, v199
    v_cvt_pk_bf16_f32 v79, v198, v199
    s_mov_b32 s17, 0xe000
    buffer_load_dwordx4 v[200:203], v8, s[8:11], s17 offen offset:0
    buffer_load_dwordx4 v[204:207], v8, s[8:11], s17 offen offset:1024
    buffer_load_dwordx4 v[208:211], v8, s[8:11], s17 offen offset:2048
    buffer_load_dwordx4 v[212:215], v8, s[8:11], s17 offen offset:3072
    s_waitcnt vmcnt(3)
    v_mfma_f32_16x16x32_bf16 v[184:187], v[200:203], v[152:155], v[216:219]
    v_mfma_f32_16x16x32_bf16 v[188:191], v[200:203], v[168:171], v[220:223]
    s_waitcnt vmcnt(2)
    v_mfma_f32_16x16x32_bf16 v[192:195], v[204:207], v[152:155], v[216:219]
    v_mfma_f32_16x16x32_bf16 v[196:199], v[204:207], v[168:171], v[220:223]
    s_waitcnt vmcnt(1)
    v_mfma_f32_16x16x32_bf16 v[184:187], v[208:211], v[156:159], v[184:187]
    v_mfma_f32_16x16x32_bf16 v[188:191], v[208:211], v[172:175], v[188:191]
    s_waitcnt vmcnt(0)
    v_mfma_f32_16x16x32_bf16 v[192:195], v[212:215], v[156:159], v[192:195]
    v_mfma_f32_16x16x32_bf16 v[196:199], v[212:215], v[172:175], v[196:199]
    s_mov_b32 s17, 0xf000
    buffer_load_dwordx4 v[200:203], v8, s[8:11], s17 offen offset:0
    buffer_load_dwordx4 v[204:207], v8, s[8:11], s17 offen offset:1024
    buffer_load_dwordx4 v[208:211], v8, s[8:11], s17 offen offset:2048
    buffer_load_dwordx4 v[212:215], v8, s[8:11], s17 offen offset:3072
    s_waitcnt vmcnt(3)
    v_mfma_f32_16x16x32_bf16 v[184:187], v[200:203], v[160:163], v[184:187]
    v_mfma_f32_16x16x32_bf16 v[188:191], v[200:203], v[176:179], v[188:191]
    s_waitcnt vmcnt(2)
    v_mfma_f32_16x16x32_bf16 v[192:195], v[204:207], v[160:163], v[192:195]
    v_mfma_f32_16x16x32_bf16 v[196:199], v[204:207], v[176:179], v[196:199]
    s_waitcnt vmcnt(1)
    v_mfma_f32_16x16x32_bf16 v[184:187], v[208:211], v[164:167], v[184:187]
    v_mfma_f32_16x16x32_bf16 v[188:191], v[208:211], v[180:183], v[188:191]
    s_waitcnt vmcnt(0)
    v_mfma_f32_16x16x32_bf16 v[192:195], v[212:215], v[164:167], v[192:195]
    v_mfma_f32_16x16x32_bf16 v[196:199], v[212:215], v[180:183], v[196:199]
    s_nop 3
    v_exp_f32 v184, v184
    v_exp_f32 v185, v185
    v_add_f32 v9, v9, v184
    v_add_f32 v9, v9, v185
    v_cvt_pk_bf16_f32 v80, v184, v185
    v_exp_f32 v186, v186
    v_exp_f32 v187, v187
    v_add_f32 v9, v9, v186
    v_add_f32 v9, v9, v187
    v_cvt_pk_bf16_f32 v81, v186, v187
    v_exp_f32 v188, v188
    v_exp_f32 v189, v189
    v_add_f32 v10, v10, v188
    v_add_f32 v10, v10, v189
    v_cvt_pk_bf16_f32 v84, v188, v189
    v_exp_f32 v190, v190
    v_exp_f32 v191, v191
    v_add_f32 v10, v10, v190
    v_add_f32 v10, v10, v191
    v_cvt_pk_bf16_f32 v85, v190, v191
    v_exp_f32 v192, v192
    v_exp_f32 v193, v193
    v_add_f32 v9, v9, v192
    v_add_f32 v9, v9, v193
    v_cvt_pk_bf16_f32 v82, v192, v193
    v_exp_f32 v194, v194
    v_exp_f32 v195, v195
    v_add_f32 v9, v9, v194
    v_add_f32 v9, v9, v195
    v_cvt_pk_bf16_f32 v83, v194, v195
    v_exp_f32 v196, v196
    v_exp_f32 v197, v197
    v_add_f32 v10, v10, v196
    v_add_f32 v10, v10, v197
    v_cvt_pk_bf16_f32 v86, v196, v197
    v_exp_f32 v198, v198
    v_exp_f32 v199, v199
    v_add_f32 v10, v10, v198
    v_add_f32 v10, v10, v199
    v_cvt_pk_bf16_f32 v87, v198, v199
    s_mov_b32 s17, 0x10000
    buffer_load_dwordx4 v[200:203], v8, s[8:11], s17 offen offset:0
    buffer_load_dwordx4 v[204:207], v8, s[8:11], s17 offen offset:1024
    buffer_load_dwordx4 v[208:211], v8, s[8:11], s17 offen offset:2048
    buffer_load_dwordx4 v[212:215], v8, s[8:11], s17 offen offset:3072
    s_waitcnt vmcnt(3)
    v_mfma_f32_16x16x32_bf16 v[184:187], v[200:203], v[152:155], v[216:219]
    v_mfma_f32_16x16x32_bf16 v[188:191], v[200:203], v[168:171], v[220:223]
    s_waitcnt vmcnt(2)
    v_mfma_f32_16x16x32_bf16 v[192:195], v[204:207], v[152:155], v[216:219]
    v_mfma_f32_16x16x32_bf16 v[196:199], v[204:207], v[168:171], v[220:223]
    s_waitcnt vmcnt(1)
    v_mfma_f32_16x16x32_bf16 v[184:187], v[208:211], v[156:159], v[184:187]
    v_mfma_f32_16x16x32_bf16 v[188:191], v[208:211], v[172:175], v[188:191]
    s_waitcnt vmcnt(0)
    v_mfma_f32_16x16x32_bf16 v[192:195], v[212:215], v[156:159], v[192:195]
    v_mfma_f32_16x16x32_bf16 v[196:199], v[212:215], v[172:175], v[196:199]
    s_mov_b32 s17, 0x11000
    buffer_load_dwordx4 v[200:203], v8, s[8:11], s17 offen offset:0
    buffer_load_dwordx4 v[204:207], v8, s[8:11], s17 offen offset:1024
    buffer_load_dwordx4 v[208:211], v8, s[8:11], s17 offen offset:2048
    buffer_load_dwordx4 v[212:215], v8, s[8:11], s17 offen offset:3072
    s_waitcnt vmcnt(3)
    v_mfma_f32_16x16x32_bf16 v[184:187], v[200:203], v[160:163], v[184:187]
    v_mfma_f32_16x16x32_bf16 v[188:191], v[200:203], v[176:179], v[188:191]
    s_waitcnt vmcnt(2)
    v_mfma_f32_16x16x32_bf16 v[192:195], v[204:207], v[160:163], v[192:195]
    v_mfma_f32_16x16x32_bf16 v[196:199], v[204:207], v[176:179], v[196:199]
    s_waitcnt vmcnt(1)
    v_mfma_f32_16x16x32_bf16 v[184:187], v[208:211], v[164:167], v[184:187]
    v_mfma_f32_16x16x32_bf16 v[188:191], v[208:211], v[180:183], v[188:191]
    s_waitcnt vmcnt(0)
    v_mfma_f32_16x16x32_bf16 v[192:195], v[212:215], v[164:167], v[192:195]
    v_mfma_f32_16x16x32_bf16 v[196:199], v[212:215], v[180:183], v[196:199]
    s_nop 3
    v_exp_f32 v184, v184
    v_exp_f32 v185, v185
    v_add_f32 v9, v9, v184
    v_add_f32 v9, v9, v185
    v_cvt_pk_bf16_f32 v88, v184, v185
    v_exp_f32 v186, v186
    v_exp_f32 v187, v187
    v_add_f32 v9, v9, v186
    v_add_f32 v9, v9, v187
    v_cvt_pk_bf16_f32 v89, v186, v187
    v_exp_f32 v188, v188
    v_exp_f32 v189, v189
    v_add_f32 v10, v10, v188
    v_add_f32 v10, v10, v189
    v_cvt_pk_bf16_f32 v92, v188, v189
    v_exp_f32 v190, v190
    v_exp_f32 v191, v191
    v_add_f32 v10, v10, v190
    v_add_f32 v10, v10, v191
    v_cvt_pk_bf16_f32 v93, v190, v191
    v_exp_f32 v192, v192
    v_exp_f32 v193, v193
    v_add_f32 v9, v9, v192
    v_add_f32 v9, v9, v193
    v_cvt_pk_bf16_f32 v90, v192, v193
    v_exp_f32 v194, v194
    v_exp_f32 v195, v195
    v_add_f32 v9, v9, v194
    v_add_f32 v9, v9, v195
    v_cvt_pk_bf16_f32 v91, v194, v195
    v_exp_f32 v196, v196
    v_exp_f32 v197, v197
    v_add_f32 v10, v10, v196
    v_add_f32 v10, v10, v197
    v_cvt_pk_bf16_f32 v94, v196, v197
    v_exp_f32 v198, v198
    v_exp_f32 v199, v199
    v_add_f32 v10, v10, v198
    v_add_f32 v10, v10, v199
    v_cvt_pk_bf16_f32 v95, v198, v199
    s_mov_b32 s17, 0x12000
    buffer_load_dwordx4 v[200:203], v8, s[8:11], s17 offen offset:0
    buffer_load_dwordx4 v[204:207], v8, s[8:11], s17 offen offset:1024
    buffer_load_dwordx4 v[208:211], v8, s[8:11], s17 offen offset:2048
    buffer_load_dwordx4 v[212:215], v8, s[8:11], s17 offen offset:3072
    s_waitcnt vmcnt(3)
    v_mfma_f32_16x16x32_bf16 v[184:187], v[200:203], v[152:155], v[216:219]
    v_mfma_f32_16x16x32_bf16 v[188:191], v[200:203], v[168:171], v[220:223]
    s_waitcnt vmcnt(2)
    v_mfma_f32_16x16x32_bf16 v[192:195], v[204:207], v[152:155], v[216:219]
    v_mfma_f32_16x16x32_bf16 v[196:199], v[204:207], v[168:171], v[220:223]
    s_waitcnt vmcnt(1)
    v_mfma_f32_16x16x32_bf16 v[184:187], v[208:211], v[156:159], v[184:187]
    v_mfma_f32_16x16x32_bf16 v[188:191], v[208:211], v[172:175], v[188:191]
    s_waitcnt vmcnt(0)
    v_mfma_f32_16x16x32_bf16 v[192:195], v[212:215], v[156:159], v[192:195]
    v_mfma_f32_16x16x32_bf16 v[196:199], v[212:215], v[172:175], v[196:199]
    s_mov_b32 s17, 0x13000
    buffer_load_dwordx4 v[200:203], v8, s[8:11], s17 offen offset:0
    buffer_load_dwordx4 v[204:207], v8, s[8:11], s17 offen offset:1024
    buffer_load_dwordx4 v[208:211], v8, s[8:11], s17 offen offset:2048
    buffer_load_dwordx4 v[212:215], v8, s[8:11], s17 offen offset:3072
    s_waitcnt vmcnt(3)
    v_mfma_f32_16x16x32_bf16 v[184:187], v[200:203], v[160:163], v[184:187]
    v_mfma_f32_16x16x32_bf16 v[188:191], v[200:203], v[176:179], v[188:191]
    s_waitcnt vmcnt(2)
    v_mfma_f32_16x16x32_bf16 v[192:195], v[204:207], v[160:163], v[192:195]
    v_mfma_f32_16x16x32_bf16 v[196:199], v[204:207], v[176:179], v[196:199]
    s_waitcnt vmcnt(1)
    v_mfma_f32_16x16x32_bf16 v[184:187], v[208:211], v[164:167], v[184:187]
    v_mfma_f32_16x16x32_bf16 v[188:191], v[208:211], v[180:183], v[188:191]
    s_waitcnt vmcnt(0)
    v_mfma_f32_16x16x32_bf16 v[192:195], v[212:215], v[164:167], v[192:195]
    v_mfma_f32_16x16x32_bf16 v[196:199], v[212:215], v[180:183], v[196:199]
    s_nop 3
    v_exp_f32 v184, v184
    v_exp_f32 v185, v185
    v_add_f32 v9, v9, v184
    v_add_f32 v9, v9, v185
    v_cvt_pk_bf16_f32 v96, v184, v185
    v_exp_f32 v186, v186
    v_exp_f32 v187, v187
    v_add_f32 v9, v9, v186
    v_add_f32 v9, v9, v187
    v_cvt_pk_bf16_f32 v97, v186, v187
    v_exp_f32 v188, v188
    v_exp_f32 v189, v189
    v_add_f32 v10, v10, v188
    v_add_f32 v10, v10, v189
    v_cvt_pk_bf16_f32 v100, v188, v189
    v_exp_f32 v190, v190
    v_exp_f32 v191, v191
    v_add_f32 v10, v10, v190
    v_add_f32 v10, v10, v191
    v_cvt_pk_bf16_f32 v101, v190, v191
    v_exp_f32 v192, v192
    v_exp_f32 v193, v193
    v_add_f32 v9, v9, v192
    v_add_f32 v9, v9, v193
    v_cvt_pk_bf16_f32 v98, v192, v193
    v_exp_f32 v194, v194
    v_exp_f32 v195, v195
    v_add_f32 v9, v9, v194
    v_add_f32 v9, v9, v195
    v_cvt_pk_bf16_f32 v99, v194, v195
    v_exp_f32 v196, v196
    v_exp_f32 v197, v197
    v_add_f32 v10, v10, v196
    v_add_f32 v10, v10, v197
    v_cvt_pk_bf16_f32 v102, v196, v197
    v_exp_f32 v198, v198
    v_exp_f32 v199, v199
    v_add_f32 v10, v10, v198
    v_add_f32 v10, v10, v199
    v_cvt_pk_bf16_f32 v103, v198, v199
    s_mov_b32 s17, 0x14000
    buffer_load_dwordx4 v[200:203], v8, s[8:11], s17 offen offset:0
    buffer_load_dwordx4 v[204:207], v8, s[8:11], s17 offen offset:1024
    buffer_load_dwordx4 v[208:211], v8, s[8:11], s17 offen offset:2048
    buffer_load_dwordx4 v[212:215], v8, s[8:11], s17 offen offset:3072
    s_waitcnt vmcnt(3)
    v_mfma_f32_16x16x32_bf16 v[184:187], v[200:203], v[152:155], v[216:219]
    v_mfma_f32_16x16x32_bf16 v[188:191], v[200:203], v[168:171], v[220:223]
    s_waitcnt vmcnt(2)
    v_mfma_f32_16x16x32_bf16 v[192:195], v[204:207], v[152:155], v[216:219]
    v_mfma_f32_16x16x32_bf16 v[196:199], v[204:207], v[168:171], v[220:223]
    s_waitcnt vmcnt(1)
    v_mfma_f32_16x16x32_bf16 v[184:187], v[208:211], v[156:159], v[184:187]
    v_mfma_f32_16x16x32_bf16 v[188:191], v[208:211], v[172:175], v[188:191]
    s_waitcnt vmcnt(0)
    v_mfma_f32_16x16x32_bf16 v[192:195], v[212:215], v[156:159], v[192:195]
    v_mfma_f32_16x16x32_bf16 v[196:199], v[212:215], v[172:175], v[196:199]
    s_mov_b32 s17, 0x15000
    buffer_load_dwordx4 v[200:203], v8, s[8:11], s17 offen offset:0
    buffer_load_dwordx4 v[204:207], v8, s[8:11], s17 offen offset:1024
    buffer_load_dwordx4 v[208:211], v8, s[8:11], s17 offen offset:2048
    buffer_load_dwordx4 v[212:215], v8, s[8:11], s17 offen offset:3072
    s_waitcnt vmcnt(3)
    v_mfma_f32_16x16x32_bf16 v[184:187], v[200:203], v[160:163], v[184:187]
    v_mfma_f32_16x16x32_bf16 v[188:191], v[200:203], v[176:179], v[188:191]
    s_waitcnt vmcnt(2)
    v_mfma_f32_16x16x32_bf16 v[192:195], v[204:207], v[160:163], v[192:195]
    v_mfma_f32_16x16x32_bf16 v[196:199], v[204:207], v[176:179], v[196:199]
    s_waitcnt vmcnt(1)
    v_mfma_f32_16x16x32_bf16 v[184:187], v[208:211], v[164:167], v[184:187]
    v_mfma_f32_16x16x32_bf16 v[188:191], v[208:211], v[180:183], v[188:191]
    s_waitcnt vmcnt(0)
    v_mfma_f32_16x16x32_bf16 v[192:195], v[212:215], v[164:167], v[192:195]
    v_mfma_f32_16x16x32_bf16 v[196:199], v[212:215], v[180:183], v[196:199]
    s_nop 3
    v_exp_f32 v184, v184
    v_exp_f32 v185, v185
    v_add_f32 v9, v9, v184
    v_add_f32 v9, v9, v185
    v_cvt_pk_bf16_f32 v104, v184, v185
    v_exp_f32 v186, v186
    v_exp_f32 v187, v187
    v_add_f32 v9, v9, v186
    v_add_f32 v9, v9, v187
    v_cvt_pk_bf16_f32 v105, v186, v187
    v_exp_f32 v188, v188
    v_exp_f32 v189, v189
    v_add_f32 v10, v10, v188
    v_add_f32 v10, v10, v189
    v_cvt_pk_bf16_f32 v108, v188, v189
    v_exp_f32 v190, v190
    v_exp_f32 v191, v191
    v_add_f32 v10, v10, v190
    v_add_f32 v10, v10, v191
    v_cvt_pk_bf16_f32 v109, v190, v191
    v_exp_f32 v192, v192
    v_exp_f32 v193, v193
    v_add_f32 v9, v9, v192
    v_add_f32 v9, v9, v193
    v_cvt_pk_bf16_f32 v106, v192, v193
    v_exp_f32 v194, v194
    v_exp_f32 v195, v195
    v_add_f32 v9, v9, v194
    v_add_f32 v9, v9, v195
    v_cvt_pk_bf16_f32 v107, v194, v195
    v_exp_f32 v196, v196
    v_exp_f32 v197, v197
    v_add_f32 v10, v10, v196
    v_add_f32 v10, v10, v197
    v_cvt_pk_bf16_f32 v110, v196, v197
    v_exp_f32 v198, v198
    v_exp_f32 v199, v199
    v_add_f32 v10, v10, v198
    v_add_f32 v10, v10, v199
    v_cvt_pk_bf16_f32 v111, v198, v199
    s_mov_b32 s17, 0x16000
    buffer_load_dwordx4 v[200:203], v8, s[8:11], s17 offen offset:0
    buffer_load_dwordx4 v[204:207], v8, s[8:11], s17 offen offset:1024
    buffer_load_dwordx4 v[208:211], v8, s[8:11], s17 offen offset:2048
    buffer_load_dwordx4 v[212:215], v8, s[8:11], s17 offen offset:3072
    s_waitcnt vmcnt(3)
    v_mfma_f32_16x16x32_bf16 v[184:187], v[200:203], v[152:155], v[216:219]
    v_mfma_f32_16x16x32_bf16 v[188:191], v[200:203], v[168:171], v[220:223]
    s_waitcnt vmcnt(2)
    v_mfma_f32_16x16x32_bf16 v[192:195], v[204:207], v[152:155], v[216:219]
    v_mfma_f32_16x16x32_bf16 v[196:199], v[204:207], v[168:171], v[220:223]
    s_waitcnt vmcnt(1)
    v_mfma_f32_16x16x32_bf16 v[184:187], v[208:211], v[156:159], v[184:187]
    v_mfma_f32_16x16x32_bf16 v[188:191], v[208:211], v[172:175], v[188:191]
    s_waitcnt vmcnt(0)
    v_mfma_f32_16x16x32_bf16 v[192:195], v[212:215], v[156:159], v[192:195]
    v_mfma_f32_16x16x32_bf16 v[196:199], v[212:215], v[172:175], v[196:199]
    s_mov_b32 s17, 0x17000
    buffer_load_dwordx4 v[200:203], v8, s[8:11], s17 offen offset:0
    buffer_load_dwordx4 v[204:207], v8, s[8:11], s17 offen offset:1024
    buffer_load_dwordx4 v[208:211], v8, s[8:11], s17 offen offset:2048
    buffer_load_dwordx4 v[212:215], v8, s[8:11], s17 offen offset:3072
    s_waitcnt vmcnt(3)
    v_mfma_f32_16x16x32_bf16 v[184:187], v[200:203], v[160:163], v[184:187]
    v_mfma_f32_16x16x32_bf16 v[188:191], v[200:203], v[176:179], v[188:191]
    s_waitcnt vmcnt(2)
    v_mfma_f32_16x16x32_bf16 v[192:195], v[204:207], v[160:163], v[192:195]
    v_mfma_f32_16x16x32_bf16 v[196:199], v[204:207], v[176:179], v[196:199]
    s_waitcnt vmcnt(1)
    v_mfma_f32_16x16x32_bf16 v[184:187], v[208:211], v[164:167], v[184:187]
    v_mfma_f32_16x16x32_bf16 v[188:191], v[208:211], v[180:183], v[188:191]
    s_waitcnt vmcnt(0)
    v_mfma_f32_16x16x32_bf16 v[192:195], v[212:215], v[164:167], v[192:195]
    v_mfma_f32_16x16x32_bf16 v[196:199], v[212:215], v[180:183], v[196:199]
    s_nop 3
    v_exp_f32 v184, v184
    v_exp_f32 v185, v185
    v_add_f32 v9, v9, v184
    v_add_f32 v9, v9, v185
    v_cvt_pk_bf16_f32 v112, v184, v185
    v_exp_f32 v186, v186
    v_exp_f32 v187, v187
    v_add_f32 v9, v9, v186
    v_add_f32 v9, v9, v187
    v_cvt_pk_bf16_f32 v113, v186, v187
    v_exp_f32 v188, v188
    v_exp_f32 v189, v189
    v_add_f32 v10, v10, v188
    v_add_f32 v10, v10, v189
    v_cvt_pk_bf16_f32 v116, v188, v189
    v_exp_f32 v190, v190
    v_exp_f32 v191, v191
    v_add_f32 v10, v10, v190
    v_add_f32 v10, v10, v191
    v_cvt_pk_bf16_f32 v117, v190, v191
    v_exp_f32 v192, v192
    v_exp_f32 v193, v193
    v_add_f32 v9, v9, v192
    v_add_f32 v9, v9, v193
    v_cvt_pk_bf16_f32 v114, v192, v193
    v_exp_f32 v194, v194
    v_exp_f32 v195, v195
    v_add_f32 v9, v9, v194
    v_add_f32 v9, v9, v195
    v_cvt_pk_bf16_f32 v115, v194, v195
    v_exp_f32 v196, v196
    v_exp_f32 v197, v197
    v_add_f32 v10, v10, v196
    v_add_f32 v10, v10, v197
    v_cvt_pk_bf16_f32 v118, v196, v197
    v_exp_f32 v198, v198
    v_exp_f32 v199, v199
    v_add_f32 v10, v10, v198
    v_add_f32 v10, v10, v199
    v_cvt_pk_bf16_f32 v119, v198, v199
    s_mov_b32 s17, 0x18000
    buffer_load_dwordx4 v[200:203], v8, s[8:11], s17 offen offset:0
    buffer_load_dwordx4 v[204:207], v8, s[8:11], s17 offen offset:1024
    buffer_load_dwordx4 v[208:211], v8, s[8:11], s17 offen offset:2048
    buffer_load_dwordx4 v[212:215], v8, s[8:11], s17 offen offset:3072
    s_waitcnt vmcnt(3)
    v_mfma_f32_16x16x32_bf16 v[184:187], v[200:203], v[152:155], v[216:219]
    v_mfma_f32_16x16x32_bf16 v[188:191], v[200:203], v[168:171], v[220:223]
    s_waitcnt vmcnt(2)
    v_mfma_f32_16x16x32_bf16 v[192:195], v[204:207], v[152:155], v[216:219]
    v_mfma_f32_16x16x32_bf16 v[196:199], v[204:207], v[168:171], v[220:223]
    s_waitcnt vmcnt(1)
    v_mfma_f32_16x16x32_bf16 v[184:187], v[208:211], v[156:159], v[184:187]
    v_mfma_f32_16x16x32_bf16 v[188:191], v[208:211], v[172:175], v[188:191]
    s_waitcnt vmcnt(0)
    v_mfma_f32_16x16x32_bf16 v[192:195], v[212:215], v[156:159], v[192:195]
    v_mfma_f32_16x16x32_bf16 v[196:199], v[212:215], v[172:175], v[196:199]
    s_mov_b32 s17, 0x19000
    buffer_load_dwordx4 v[200:203], v8, s[8:11], s17 offen offset:0
    buffer_load_dwordx4 v[204:207], v8, s[8:11], s17 offen offset:1024
    buffer_load_dwordx4 v[208:211], v8, s[8:11], s17 offen offset:2048
    buffer_load_dwordx4 v[212:215], v8, s[8:11], s17 offen offset:3072
    s_waitcnt vmcnt(3)
    v_mfma_f32_16x16x32_bf16 v[184:187], v[200:203], v[160:163], v[184:187]
    v_mfma_f32_16x16x32_bf16 v[188:191], v[200:203], v[176:179], v[188:191]
    s_waitcnt vmcnt(2)
    v_mfma_f32_16x16x32_bf16 v[192:195], v[204:207], v[160:163], v[192:195]
    v_mfma_f32_16x16x32_bf16 v[196:199], v[204:207], v[176:179], v[196:199]
    s_waitcnt vmcnt(1)
    v_mfma_f32_16x16x32_bf16 v[184:187], v[208:211], v[164:167], v[184:187]
    v_mfma_f32_16x16x32_bf16 v[188:191], v[208:211], v[180:183], v[188:191]
    s_waitcnt vmcnt(0)
    v_mfma_f32_16x16x32_bf16 v[192:195], v[212:215], v[164:167], v[192:195]
    v_mfma_f32_16x16x32_bf16 v[196:199], v[212:215], v[180:183], v[196:199]
    s_nop 3
    v_exp_f32 v184, v184
    v_exp_f32 v185, v185
    v_add_f32 v9, v9, v184
    v_add_f32 v9, v9, v185
    v_cvt_pk_bf16_f32 v120, v184, v185
    v_exp_f32 v186, v186
    v_exp_f32 v187, v187
    v_add_f32 v9, v9, v186
    v_add_f32 v9, v9, v187
    v_cvt_pk_bf16_f32 v121, v186, v187
    v_exp_f32 v188, v188
    v_exp_f32 v189, v189
    v_add_f32 v10, v10, v188
    v_add_f32 v10, v10, v189
    v_cvt_pk_bf16_f32 v124, v188, v189
    v_exp_f32 v190, v190
    v_exp_f32 v191, v191
    v_add_f32 v10, v10, v190
    v_add_f32 v10, v10, v191
    v_cvt_pk_bf16_f32 v125, v190, v191
    v_exp_f32 v192, v192
    v_exp_f32 v193, v193
    v_add_f32 v9, v9, v192
    v_add_f32 v9, v9, v193
    v_cvt_pk_bf16_f32 v122, v192, v193
    v_exp_f32 v194, v194
    v_exp_f32 v195, v195
    v_add_f32 v9, v9, v194
    v_add_f32 v9, v9, v195
    v_cvt_pk_bf16_f32 v123, v194, v195
    v_exp_f32 v196, v196
    v_exp_f32 v197, v197
    v_add_f32 v10, v10, v196
    v_add_f32 v10, v10, v197
    v_cvt_pk_bf16_f32 v126, v196, v197
    v_exp_f32 v198, v198
    v_exp_f32 v199, v199
    v_add_f32 v10, v10, v198
    v_add_f32 v10, v10, v199
    v_cvt_pk_bf16_f32 v127, v198, v199
    s_mov_b32 s17, 0x1a000
    buffer_load_dwordx4 v[200:203], v8, s[8:11], s17 offen offset:0
    buffer_load_dwordx4 v[204:207], v8, s[8:11], s17 offen offset:1024
    buffer_load_dwordx4 v[208:211], v8, s[8:11], s17 offen offset:2048
    buffer_load_dwordx4 v[212:215], v8, s[8:11], s17 offen offset:3072
    s_waitcnt vmcnt(3)
    v_mfma_f32_16x16x32_bf16 v[184:187], v[200:203], v[152:155], v[216:219]
    v_mfma_f32_16x16x32_bf16 v[188:191], v[200:203], v[168:171], v[220:223]
    s_waitcnt vmcnt(2)
    v_mfma_f32_16x16x32_bf16 v[192:195], v[204:207], v[152:155], v[216:219]
    v_mfma_f32_16x16x32_bf16 v[196:199], v[204:207], v[168:171], v[220:223]
    s_waitcnt vmcnt(1)
    v_mfma_f32_16x16x32_bf16 v[184:187], v[208:211], v[156:159], v[184:187]
    v_mfma_f32_16x16x32_bf16 v[188:191], v[208:211], v[172:175], v[188:191]
    s_waitcnt vmcnt(0)
    v_mfma_f32_16x16x32_bf16 v[192:195], v[212:215], v[156:159], v[192:195]
    v_mfma_f32_16x16x32_bf16 v[196:199], v[212:215], v[172:175], v[196:199]
    s_mov_b32 s17, 0x1b000
    buffer_load_dwordx4 v[200:203], v8, s[8:11], s17 offen offset:0
    buffer_load_dwordx4 v[204:207], v8, s[8:11], s17 offen offset:1024
    buffer_load_dwordx4 v[208:211], v8, s[8:11], s17 offen offset:2048
    buffer_load_dwordx4 v[212:215], v8, s[8:11], s17 offen offset:3072
    s_waitcnt vmcnt(3)
    v_mfma_f32_16x16x32_bf16 v[184:187], v[200:203], v[160:163], v[184:187]
    v_mfma_f32_16x16x32_bf16 v[188:191], v[200:203], v[176:179], v[188:191]
    s_waitcnt vmcnt(2)
    v_mfma_f32_16x16x32_bf16 v[192:195], v[204:207], v[160:163], v[192:195]
    v_mfma_f32_16x16x32_bf16 v[196:199], v[204:207], v[176:179], v[196:199]
    s_waitcnt vmcnt(1)
    v_mfma_f32_16x16x32_bf16 v[184:187], v[208:211], v[164:167], v[184:187]
    v_mfma_f32_16x16x32_bf16 v[188:191], v[208:211], v[180:183], v[188:191]
    s_waitcnt vmcnt(0)
    v_mfma_f32_16x16x32_bf16 v[192:195], v[212:215], v[164:167], v[192:195]
    v_mfma_f32_16x16x32_bf16 v[196:199], v[212:215], v[180:183], v[196:199]
    s_nop 3
    v_exp_f32 v184, v184
    v_exp_f32 v185, v185
    v_add_f32 v9, v9, v184
    v_add_f32 v9, v9, v185
    v_cvt_pk_bf16_f32 v128, v184, v185
    v_exp_f32 v186, v186
    v_exp_f32 v187, v187
    v_add_f32 v9, v9, v186
    v_add_f32 v9, v9, v187
    v_cvt_pk_bf16_f32 v129, v186, v187
    v_exp_f32 v188, v188
    v_exp_f32 v189, v189
    v_add_f32 v10, v10, v188
    v_add_f32 v10, v10, v189
    v_cvt_pk_bf16_f32 v132, v188, v189
    v_exp_f32 v190, v190
    v_exp_f32 v191, v191
    v_add_f32 v10, v10, v190
    v_add_f32 v10, v10, v191
    v_cvt_pk_bf16_f32 v133, v190, v191
    v_exp_f32 v192, v192
    v_exp_f32 v193, v193
    v_add_f32 v9, v9, v192
    v_add_f32 v9, v9, v193
    v_cvt_pk_bf16_f32 v130, v192, v193
    v_exp_f32 v194, v194
    v_exp_f32 v195, v195
    v_add_f32 v9, v9, v194
    v_add_f32 v9, v9, v195
    v_cvt_pk_bf16_f32 v131, v194, v195
    v_exp_f32 v196, v196
    v_exp_f32 v197, v197
    v_add_f32 v10, v10, v196
    v_add_f32 v10, v10, v197
    v_cvt_pk_bf16_f32 v134, v196, v197
    v_exp_f32 v198, v198
    v_exp_f32 v199, v199
    v_add_f32 v10, v10, v198
    v_add_f32 v10, v10, v199
    v_cvt_pk_bf16_f32 v135, v198, v199
    s_mov_b32 s17, 0x1c000
    buffer_load_dwordx4 v[200:203], v8, s[8:11], s17 offen offset:0
    buffer_load_dwordx4 v[204:207], v8, s[8:11], s17 offen offset:1024
    buffer_load_dwordx4 v[208:211], v8, s[8:11], s17 offen offset:2048
    buffer_load_dwordx4 v[212:215], v8, s[8:11], s17 offen offset:3072
    s_waitcnt vmcnt(3)
    v_mfma_f32_16x16x32_bf16 v[184:187], v[200:203], v[152:155], v[216:219]
    v_mfma_f32_16x16x32_bf16 v[188:191], v[200:203], v[168:171], v[220:223]
    s_waitcnt vmcnt(2)
    v_mfma_f32_16x16x32_bf16 v[192:195], v[204:207], v[152:155], v[216:219]
    v_mfma_f32_16x16x32_bf16 v[196:199], v[204:207], v[168:171], v[220:223]
    s_waitcnt vmcnt(1)
    v_mfma_f32_16x16x32_bf16 v[184:187], v[208:211], v[156:159], v[184:187]
    v_mfma_f32_16x16x32_bf16 v[188:191], v[208:211], v[172:175], v[188:191]
    s_waitcnt vmcnt(0)
    v_mfma_f32_16x16x32_bf16 v[192:195], v[212:215], v[156:159], v[192:195]
    v_mfma_f32_16x16x32_bf16 v[196:199], v[212:215], v[172:175], v[196:199]
    s_mov_b32 s17, 0x1d000
    buffer_load_dwordx4 v[200:203], v8, s[8:11], s17 offen offset:0
    buffer_load_dwordx4 v[204:207], v8, s[8:11], s17 offen offset:1024
    buffer_load_dwordx4 v[208:211], v8, s[8:11], s17 offen offset:2048
    buffer_load_dwordx4 v[212:215], v8, s[8:11], s17 offen offset:3072
    s_waitcnt vmcnt(3)
    v_mfma_f32_16x16x32_bf16 v[184:187], v[200:203], v[160:163], v[184:187]
    v_mfma_f32_16x16x32_bf16 v[188:191], v[200:203], v[176:179], v[188:191]
    s_waitcnt vmcnt(2)
    v_mfma_f32_16x16x32_bf16 v[192:195], v[204:207], v[160:163], v[192:195]
    v_mfma_f32_16x16x32_bf16 v[196:199], v[204:207], v[176:179], v[196:199]
    s_waitcnt vmcnt(1)
    v_mfma_f32_16x16x32_bf16 v[184:187], v[208:211], v[164:167], v[184:187]
    v_mfma_f32_16x16x32_bf16 v[188:191], v[208:211], v[180:183], v[188:191]
    s_waitcnt vmcnt(0)
    v_mfma_f32_16x16x32_bf16 v[192:195], v[212:215], v[164:167], v[192:195]
    v_mfma_f32_16x16x32_bf16 v[196:199], v[212:215], v[180:183], v[196:199]
    s_nop 3
    v_exp_f32 v184, v184
    v_exp_f32 v185, v185
    v_add_f32 v9, v9, v184
    v_add_f32 v9, v9, v185
    v_cvt_pk_bf16_f32 v136, v184, v185
    v_exp_f32 v186, v186
    v_exp_f32 v187, v187
    v_add_f32 v9, v9, v186
    v_add_f32 v9, v9, v187
    v_cvt_pk_bf16_f32 v137, v186, v187
    v_exp_f32 v188, v188
    v_exp_f32 v189, v189
    v_add_f32 v10, v10, v188
    v_add_f32 v10, v10, v189
    v_cvt_pk_bf16_f32 v140, v188, v189
    v_exp_f32 v190, v190
    v_exp_f32 v191, v191
    v_add_f32 v10, v10, v190
    v_add_f32 v10, v10, v191
    v_cvt_pk_bf16_f32 v141, v190, v191
    v_exp_f32 v192, v192
    v_exp_f32 v193, v193
    v_add_f32 v9, v9, v192
    v_add_f32 v9, v9, v193
    v_cvt_pk_bf16_f32 v138, v192, v193
    v_exp_f32 v194, v194
    v_exp_f32 v195, v195
    v_add_f32 v9, v9, v194
    v_add_f32 v9, v9, v195
    v_cvt_pk_bf16_f32 v139, v194, v195
    v_exp_f32 v196, v196
    v_exp_f32 v197, v197
    v_add_f32 v10, v10, v196
    v_add_f32 v10, v10, v197
    v_cvt_pk_bf16_f32 v142, v196, v197
    v_exp_f32 v198, v198
    v_exp_f32 v199, v199
    v_add_f32 v10, v10, v198
    v_add_f32 v10, v10, v199
    v_cvt_pk_bf16_f32 v143, v198, v199
    s_mov_b32 s17, 0x1e000
    buffer_load_dwordx4 v[200:203], v8, s[8:11], s17 offen offset:0
    buffer_load_dwordx4 v[204:207], v8, s[8:11], s17 offen offset:1024
    buffer_load_dwordx4 v[208:211], v8, s[8:11], s17 offen offset:2048
    buffer_load_dwordx4 v[212:215], v8, s[8:11], s17 offen offset:3072
    s_waitcnt vmcnt(3)
    v_mfma_f32_16x16x32_bf16 v[184:187], v[200:203], v[152:155], v[216:219]
    v_mfma_f32_16x16x32_bf16 v[188:191], v[200:203], v[168:171], v[220:223]
    s_waitcnt vmcnt(2)
    v_mfma_f32_16x16x32_bf16 v[192:195], v[204:207], v[152:155], v[216:219]
    v_mfma_f32_16x16x32_bf16 v[196:199], v[204:207], v[168:171], v[220:223]
    s_waitcnt vmcnt(1)
    v_mfma_f32_16x16x32_bf16 v[184:187], v[208:211], v[156:159], v[184:187]
    v_mfma_f32_16x16x32_bf16 v[188:191], v[208:211], v[172:175], v[188:191]
    s_waitcnt vmcnt(0)
    v_mfma_f32_16x16x32_bf16 v[192:195], v[212:215], v[156:159], v[192:195]
    v_mfma_f32_16x16x32_bf16 v[196:199], v[212:215], v[172:175], v[196:199]
    s_mov_b32 s17, 0x1f000
    buffer_load_dwordx4 v[200:203], v8, s[8:11], s17 offen offset:0
    buffer_load_dwordx4 v[204:207], v8, s[8:11], s17 offen offset:1024
    buffer_load_dwordx4 v[208:211], v8, s[8:11], s17 offen offset:2048
    buffer_load_dwordx4 v[212:215], v8, s[8:11], s17 offen offset:3072
    s_waitcnt vmcnt(3)
    v_mfma_f32_16x16x32_bf16 v[184:187], v[200:203], v[160:163], v[184:187]
    v_mfma_f32_16x16x32_bf16 v[188:191], v[200:203], v[176:179], v[188:191]
    s_waitcnt vmcnt(2)
    v_mfma_f32_16x16x32_bf16 v[192:195], v[204:207], v[160:163], v[192:195]
    v_mfma_f32_16x16x32_bf16 v[196:199], v[204:207], v[176:179], v[196:199]
    s_waitcnt vmcnt(1)
    v_mfma_f32_16x16x32_bf16 v[184:187], v[208:211], v[164:167], v[184:187]
    v_mfma_f32_16x16x32_bf16 v[188:191], v[208:211], v[180:183], v[188:191]
    s_waitcnt vmcnt(0)
    v_mfma_f32_16x16x32_bf16 v[192:195], v[212:215], v[164:167], v[192:195]
    v_mfma_f32_16x16x32_bf16 v[196:199], v[212:215], v[180:183], v[196:199]
    s_nop 3
    v_exp_f32 v184, v184
    v_exp_f32 v185, v185
    v_add_f32 v9, v9, v184
    v_add_f32 v9, v9, v185
    v_cvt_pk_bf16_f32 v144, v184, v185
    v_exp_f32 v186, v186
    v_exp_f32 v187, v187
    v_add_f32 v9, v9, v186
    v_add_f32 v9, v9, v187
    v_cvt_pk_bf16_f32 v145, v186, v187
    v_exp_f32 v188, v188
    v_exp_f32 v189, v189
    v_add_f32 v10, v10, v188
    v_add_f32 v10, v10, v189
    v_cvt_pk_bf16_f32 v148, v188, v189
    v_exp_f32 v190, v190
    v_exp_f32 v191, v191
    v_add_f32 v10, v10, v190
    v_add_f32 v10, v10, v191
    v_cvt_pk_bf16_f32 v149, v190, v191
    v_exp_f32 v192, v192
    v_exp_f32 v193, v193
    v_add_f32 v9, v9, v192
    v_add_f32 v9, v9, v193
    v_cvt_pk_bf16_f32 v146, v192, v193
    v_exp_f32 v194, v194
    v_exp_f32 v195, v195
    v_add_f32 v9, v9, v194
    v_add_f32 v9, v9, v195
    v_cvt_pk_bf16_f32 v147, v194, v195
    v_exp_f32 v196, v196
    v_exp_f32 v197, v197
    v_add_f32 v10, v10, v196
    v_add_f32 v10, v10, v197
    v_cvt_pk_bf16_f32 v150, v196, v197
    v_exp_f32 v198, v198
    v_exp_f32 v199, v199
    v_add_f32 v10, v10, v198
    v_add_f32 v10, v10, v199
    v_cvt_pk_bf16_f32 v151, v198, v199
    v_mov_b32 v16, v9
    v_mov_b32 v18, v10
    s_nop 0
    v_permlane16_swap_b32 v9, v16
    v_permlane16_swap_b32 v10, v18
    v_add_f32 v9, v9, v16
    v_add_f32 v10, v10, v18
    v_mov_b32 v16, v9
    v_mov_b32 v18, v10
    s_nop 0
    v_permlane32_swap_b32 v9, v16
    v_permlane32_swap_b32 v10, v18
    v_add_f32 v9, v9, v16
    v_add_f32 v10, v10, v18
    s_waitcnt vmcnt(0) lgkmcnt(0)
    s_nop 15
    s_nop 3
    s_branch adaLN_cond__sliding_block_cached__moe_arch_mod__prompt_kernel_fixAb
adaLN_cond__sliding_block_cached__moe_arch_mod__prompt_kernel_mp5r:
    s_waitcnt vmcnt(0) lgkmcnt(0)
    s_nop 15
    s_nop 3
    s_mov_b32 s27, 0
adaLN_cond__sliding_block_cached__moe_arch_mod__prompt_kernel_mp5p:
    buffer_load_dword v248, v250, s[8:11], s14 offen sc1
    s_waitcnt vmcnt(0)
    v_cmp_ne_u32 vcc, s28, v248
    s_add_u32 s27, s27, 1
    s_cmp_ge_u32 s27, 262144
    s_cbranch_scc1 adaLN_cond__sliding_block_cached__moe_arch_mod__prompt_kernel_mp5g
    s_cbranch_vccnz adaLN_cond__sliding_block_cached__moe_arch_mod__prompt_kernel_mp5p
adaLN_cond__sliding_block_cached__moe_arch_mod__prompt_kernel_mp5g:
    s_waitcnt vmcnt(0) lgkmcnt(0)
    s_nop 15
    s_nop 3
    s_branch adaLN_cond__sliding_block_cached__moe_arch_mod__prompt_kernel_mp5b
adaLN_cond__sliding_block_cached__moe_arch_mod__prompt_kernel_o6r:
    s_waitcnt vmcnt(0) lgkmcnt(0)
    s_nop 15
    s_nop 3
    s_mov_b32 s27, 0
adaLN_cond__sliding_block_cached__moe_arch_mod__prompt_kernel_o6p:
    buffer_load_dword v12, v13, s[8:11], s19 offen sc1
    s_waitcnt vmcnt(0)
    v_cmp_ne_u32 vcc, s28, v12
    s_add_u32 s27, s27, 1
    s_cmp_ge_u32 s27, 262144
    s_cbranch_scc1 adaLN_cond__sliding_block_cached__moe_arch_mod__prompt_kernel_o6g
    s_cbranch_vccnz adaLN_cond__sliding_block_cached__moe_arch_mod__prompt_kernel_o6p
adaLN_cond__sliding_block_cached__moe_arch_mod__prompt_kernel_o6g:
    s_waitcnt vmcnt(0) lgkmcnt(0)
    s_nop 15
    s_nop 3
    s_branch adaLN_cond__sliding_block_cached__moe_arch_mod__prompt_kernel_o6b
adaLN_cond__sliding_block_cached__moe_arch_mod__prompt_kernel_o27r:
    s_waitcnt vmcnt(0) lgkmcnt(0)
    s_nop 15
    s_nop 3
    s_mov_b32 s27, 0
adaLN_cond__sliding_block_cached__moe_arch_mod__prompt_kernel_o27p:
    buffer_load_dword v12, v13, s[8:11], s19 offen sc1
    s_waitcnt vmcnt(0)
    v_cmp_ne_u32 vcc, s28, v12
    s_add_u32 s27, s27, 1
    s_cmp_ge_u32 s27, 262144
    s_cbranch_scc1 adaLN_cond__sliding_block_cached__moe_arch_mod__prompt_kernel_o27g
    s_cbranch_vccnz adaLN_cond__sliding_block_cached__moe_arch_mod__prompt_kernel_o27p
adaLN_cond__sliding_block_cached__moe_arch_mod__prompt_kernel_o27g:
    s_waitcnt vmcnt(0) lgkmcnt(0)
    s_nop 15
    s_nop 3
    s_branch adaLN_cond__sliding_block_cached__moe_arch_mod__prompt_kernel_o27b
adaLN_cond__sliding_block_cached__moe_arch_mod__prompt_kernel_o28r:
    s_waitcnt vmcnt(0) lgkmcnt(0)
    s_nop 15
    s_nop 3
    s_mov_b32 s27, 0
adaLN_cond__sliding_block_cached__moe_arch_mod__prompt_kernel_o28p:
    buffer_load_dword v12, v13, s[8:11], s19 offen sc1
    s_waitcnt vmcnt(0)
    v_cmp_ne_u32 vcc, s28, v12
    s_add_u32 s27, s27, 1
    s_cmp_ge_u32 s27, 262144
    s_cbranch_scc1 adaLN_cond__sliding_block_cached__moe_arch_mod__prompt_kernel_o28g
    s_cbranch_vccnz adaLN_cond__sliding_block_cached__moe_arch_mod__prompt_kernel_o28p
adaLN_cond__sliding_block_cached__moe_arch_mod__prompt_kernel_o28g:
    s_waitcnt vmcnt(0) lgkmcnt(0)
    s_nop 15
    s_nop 3
    s_branch adaLN_cond__sliding_block_cached__moe_arch_mod__prompt_kernel_o28b
adaLN_cond__sliding_block_cached__moe_arch_mod__prompt_kernel_o29r:
    s_waitcnt vmcnt(0) lgkmcnt(0)
    s_nop 15
    s_nop 3
    s_mov_b32 s27, 0
adaLN_cond__sliding_block_cached__moe_arch_mod__prompt_kernel_o29p:
    buffer_load_dword v12, v13, s[8:11], s19 offen sc1
    s_waitcnt vmcnt(0)
    v_cmp_ne_u32 vcc, s28, v12
    s_add_u32 s27, s27, 1
    s_cmp_ge_u32 s27, 262144
    s_cbranch_scc1 adaLN_cond__sliding_block_cached__moe_arch_mod__prompt_kernel_o29g
    s_cbranch_vccnz adaLN_cond__sliding_block_cached__moe_arch_mod__prompt_kernel_o29p
adaLN_cond__sliding_block_cached__moe_arch_mod__prompt_kernel_o29g:
    s_waitcnt vmcnt(0) lgkmcnt(0)
    s_nop 15
    s_nop 3
    s_branch adaLN_cond__sliding_block_cached__moe_arch_mod__prompt_kernel_o29b
adaLN_cond__sliding_block_cached__moe_arch_mod__prompt_kernel_mf10r:
    s_waitcnt vmcnt(0) lgkmcnt(0)
    s_nop 15
    s_nop 3
    s_mov_b32 s27, 0
adaLN_cond__sliding_block_cached__moe_arch_mod__prompt_kernel_mf10p:
    s_mov_b32 s16, 0x544000
    buffer_load_dwordx4 v[184:187], v2, s[8:11], s16 offen sc1
    s_waitcnt vmcnt(0)
    v_xor_b32 v16, s28, v184
    v_xor_b32 v17, s28, v185
    v_xor_b32 v18, s28, v186
    v_xor_b32 v19, s28, v187
    v_or3_b32 v16, v16, v17, v18
    v_or_b32 v16, v16, v19
    v_cmp_ne_u32 vcc, 0, v16
    s_add_u32 s27, s27, 1
    s_cmp_ge_u32 s27, 262144
    s_cbranch_scc1 adaLN_cond__sliding_block_cached__moe_arch_mod__prompt_kernel_mf10g
    s_cbranch_vccnz adaLN_cond__sliding_block_cached__moe_arch_mod__prompt_kernel_mf10p
adaLN_cond__sliding_block_cached__moe_arch_mod__prompt_kernel_mf10g:
    s_waitcnt vmcnt(0) lgkmcnt(0)
    s_nop 15
    s_nop 3
    s_branch adaLN_cond__sliding_block_cached__moe_arch_mod__prompt_kernel_mf10b
adaLN_cond__sliding_block_cached__moe_arch_mod__prompt_kernel_kv16r:
    s_waitcnt vmcnt(0) lgkmcnt(0)
    s_nop 15
    s_nop 3
    s_mov_b32 s27, 0
adaLN_cond__sliding_block_cached__moe_arch_mod__prompt_kernel_kv16p:
    buffer_load_dwordx4 v[12:15], v21, s[8:11], s18 offen sc1
    s_waitcnt vmcnt(0)
    v_xor_b32 v8, s28, v12
    v_xor_b32 v20, s28, v13
    v_or_b32 v8, v8, v20
    v_xor_b32 v20, s28, v14
    v_or_b32 v8, v8, v20
    v_xor_b32 v20, s28, v15
    v_or_b32 v8, v8, v20
    v_cmp_ne_u32 vcc, 0, v8
    s_add_u32 s27, s27, 1
    s_cmp_ge_u32 s27, 262144
    s_cbranch_scc1 adaLN_cond__sliding_block_cached__moe_arch_mod__prompt_kernel_kv16g
    s_cbranch_vccnz adaLN_cond__sliding_block_cached__moe_arch_mod__prompt_kernel_kv16p
adaLN_cond__sliding_block_cached__moe_arch_mod__prompt_kernel_kv16g:
    s_waitcnt vmcnt(0) lgkmcnt(0)
    s_nop 15
    s_nop 3
    s_branch adaLN_cond__sliding_block_cached__moe_arch_mod__prompt_kernel_kv16b
adaLN_cond__sliding_block_cached__moe_arch_mod__prompt_kernel_fixB:
    s_waitcnt vmcnt(0) lgkmcnt(0)
    s_nop 15
    s_nop 3
    s_lshr_b32 s16, s12, 3
    s_lshl_b32 s16, s16, 17
    s_add_u32 s16, s16, 0x400000
    v_add_u32 v8, s16, v2
    v_mov_b32 v16, 0xff7fffff
    v_mov_b32 v17, 0xff7fffff
    s_mov_b32 s16, 0
adaLN_cond__sliding_block_cached__moe_arch_mod__prompt_kernel_fixBm:
    s_add_u32 s17, s16, 0
    buffer_load_dwordx4 v[200:203], v8, s[8:11], s17 offen offset:0
    buffer_load_dwordx4 v[204:207], v8, s[8:11], s17 offen offset:1024
    buffer_load_dwordx4 v[208:211], v8, s[8:11], s17 offen offset:2048
    buffer_load_dwordx4 v[212:215], v8, s[8:11], s17 offen offset:3072
    s_waitcnt vmcnt(3)
    v_mfma_f32_16x16x32_bf16 v[184:187], v[200:203], v[152:155], 0
    v_mfma_f32_16x16x32_bf16 v[188:191], v[200:203], v[168:171], 0
    s_waitcnt vmcnt(2)
    v_mfma_f32_16x16x32_bf16 v[192:195], v[204:207], v[152:155], 0
    v_mfma_f32_16x16x32_bf16 v[196:199], v[204:207], v[168:171], 0
    s_waitcnt vmcnt(1)
    v_mfma_f32_16x16x32_bf16 v[184:187], v[208:211], v[156:159], v[184:187]
    v_mfma_f32_16x16x32_bf16 v[188:191], v[208:211], v[172:175], v[188:191]
    s_waitcnt vmcnt(0)
    v_mfma_f32_16x16x32_bf16 v[192:195], v[212:215], v[156:159], v[192:195]
    v_mfma_f32_16x16x32_bf16 v[196:199], v[212:215], v[172:175], v[196:199]
    s_add_u32 s17, s16, 4096
    buffer_load_dwordx4 v[200:203], v8, s[8:11], s17 offen offset:0
    buffer_load_dwordx4 v[204:207], v8, s[8:11], s17 offen offset:1024
    buffer_load_dwordx4 v[208:211], v8, s[8:11], s17 offen offset:2048
    buffer_load_dwordx4 v[212:215], v8, s[8:11], s17 offen offset:3072
    s_waitcnt vmcnt(3)
    v_mfma_f32_16x16x32_bf16 v[184:187], v[200:203], v[160:163], v[184:187]
    v_mfma_f32_16x16x32_bf16 v[188:191], v[200:203], v[176:179], v[188:191]
    s_waitcnt vmcnt(2)
    v_mfma_f32_16x16x32_bf16 v[192:195], v[204:207], v[160:163], v[192:195]
    v_mfma_f32_16x16x32_bf16 v[196:199], v[204:207], v[176:179], v[196:199]
    s_waitcnt vmcnt(1)
    v_mfma_f32_16x16x32_bf16 v[184:187], v[208:211], v[164:167], v[184:187]
    v_mfma_f32_16x16x32_bf16 v[188:191], v[208:211], v[180:183], v[188:191]
    s_waitcnt vmcnt(0)
    v_mfma_f32_16x16x32_bf16 v[192:195], v[212:215], v[164:167], v[192:195]
    v_mfma_f32_16x16x32_bf16 v[196:199], v[212:215], v[180:183], v[196:199]
    s_nop 3
    v_max3_f32 v16, v16, v184, v185
    v_max3_f32 v16, v16, v186, v187
    v_max3_f32 v17, v17, v188, v189
    v_max3_f32 v17, v17, v190, v191
    v_max3_f32 v16, v16, v192, v193
    v_max3_f32 v16, v16, v194, v195
    v_max3_f32 v17, v17, v196, v197
    v_max3_f32 v17, v17, v198, v199
    s_add_u32 s16, s16, 8192
    s_cmp_lt_u32 s16, 0x20000
    s_cbranch_scc1 adaLN_cond__sliding_block_cached__moe_arch_mod__prompt_kernel_fixBm
    v_mov_b32 v18, v16
    v_mov_b32 v19, v17
    s_nop 0
    v_permlane16_swap_b32 v16, v18
    v_permlane16_swap_b32 v17, v19
    v_max_f32 v16, v16, v18
    v_max_f32 v17, v17, v19
    v_mov_b32 v18, v16
    v_mov_b32 v19, v17
    s_nop 0
    v_permlane32_swap_b32 v16, v18
    v_permlane32_swap_b32 v17, v19
    v_max_f32 v16, v16, v18
    v_max_f32 v17, v17, v19
    v_sub_f32 v216, 0, v16
    v_sub_f32 v217, 0, v16
    v_sub_f32 v218, 0, v16
    v_sub_f32 v219, 0, v16
    v_sub_f32 v220, 0, v17
    v_sub_f32 v221, 0, v17
    v_sub_f32 v222, 0, v17
    v_sub_f32 v223, 0, v17
    s_mov_b32 s17, 0x0
    buffer_load_dwordx4 v[200:203], v8, s[8:11], s17 offen offset:0
    buffer_load_dwordx4 v[204:207], v8, s[8:11], s17 offen offset:1024
    buffer_load_dwordx4 v[208:211], v8, s[8:11], s17 offen offset:2048
    buffer_load_dwordx4 v[212:215], v8, s[8:11], s17 offen offset:3072
    s_waitcnt vmcnt(3)
    v_mfma_f32_16x16x32_bf16 v[184:187], v[200:203], v[152:155], v[216:219]
    v_mfma_f32_16x16x32_bf16 v[188:191], v[200:203], v[168:171], v[220:223]
    s_waitcnt vmcnt(2)
    v_mfma_f32_16x16x32_bf16 v[192:195], v[204:207], v[152:155], v[216:219]
    v_mfma_f32_16x16x32_bf16 v[196:199], v[204:207], v[168:171], v[220:223]
    s_waitcnt vmcnt(1)
    v_mfma_f32_16x16x32_bf16 v[184:187], v[208:211], v[156:159], v[184:187]
    v_mfma_f32_16x16x32_bf16 v[188:191], v[208:211], v[172:175], v[188:191]
    s_waitcnt vmcnt(0)
    v_mfma_f32_16x16x32_bf16 v[192:195], v[212:215], v[156:159], v[192:195]
    v_mfma_f32_16x16x32_bf16 v[196:199], v[212:215], v[172:175], v[196:199]
    s_mov_b32 s17, 0x1000
    buffer_load_dwordx4 v[200:203], v8, s[8:11], s17 offen offset:0
    buffer_load_dwordx4 v[204:207], v8, s[8:11], s17 offen offset:1024
    buffer_load_dwordx4 v[208:211], v8, s[8:11], s17 offen offset:2048
    buffer_load_dwordx4 v[212:215], v8, s[8:11], s17 offen offset:3072
    s_waitcnt vmcnt(3)
    v_mfma_f32_16x16x32_bf16 v[184:187], v[200:203], v[160:163], v[184:187]
    v_mfma_f32_16x16x32_bf16 v[188:191], v[200:203], v[176:179], v[188:191]
    s_waitcnt vmcnt(2)
    v_mfma_f32_16x16x32_bf16 v[192:195], v[204:207], v[160:163], v[192:195]
    v_mfma_f32_16x16x32_bf16 v[196:199], v[204:207], v[176:179], v[196:199]
    s_waitcnt vmcnt(1)
    v_mfma_f32_16x16x32_bf16 v[184:187], v[208:211], v[164:167], v[184:187]
    v_mfma_f32_16x16x32_bf16 v[188:191], v[208:211], v[180:183], v[188:191]
    s_waitcnt vmcnt(0)
    v_mfma_f32_16x16x32_bf16 v[192:195], v[212:215], v[164:167], v[192:195]
    v_mfma_f32_16x16x32_bf16 v[196:199], v[212:215], v[180:183], v[196:199]
    s_nop 3
    v_exp_f32 v184, v184
    v_exp_f32 v185, v185
    s_nop 0
    v_add_f32 v9, v184, v185
    v_cvt_pk_bf16_f32 v24, v184, v185
    v_exp_f32 v186, v186
    v_exp_f32 v187, v187
    v_add_f32 v9, v9, v186
    v_add_f32 v9, v9, v187
    v_cvt_pk_bf16_f32 v25, v186, v187
    v_exp_f32 v188, v188
    v_exp_f32 v189, v189
    s_nop 0
    v_add_f32 v10, v188, v189
    v_cvt_pk_bf16_f32 v28, v188, v189
    v_exp_f32 v190, v190
    v_exp_f32 v191, v191
    v_add_f32 v10, v10, v190
    v_add_f32 v10, v10, v191
    v_cvt_pk_bf16_f32 v29, v190, v191
    v_exp_f32 v192, v192
    v_exp_f32 v193, v193
    v_add_f32 v9, v9, v192
    v_add_f32 v9, v9, v193
    v_cvt_pk_bf16_f32 v26, v192, v193
    v_exp_f32 v194, v194
    v_exp_f32 v195, v195
    v_add_f32 v9, v9, v194
    v_add_f32 v9, v9, v195
    v_cvt_pk_bf16_f32 v27, v194, v195
    v_exp_f32 v196, v196
    v_exp_f32 v197, v197
    v_add_f32 v10, v10, v196
    v_add_f32 v10, v10, v197
    v_cvt_pk_bf16_f32 v30, v196, v197
    v_exp_f32 v198, v198
    v_exp_f32 v199, v199
    v_add_f32 v10, v10, v198
    v_add_f32 v10, v10, v199
    v_cvt_pk_bf16_f32 v31, v198, v199
    s_mov_b32 s17, 0x2000
    buffer_load_dwordx4 v[200:203], v8, s[8:11], s17 offen offset:0
    buffer_load_dwordx4 v[204:207], v8, s[8:11], s17 offen offset:1024
    buffer_load_dwordx4 v[208:211], v8, s[8:11], s17 offen offset:2048
    buffer_load_dwordx4 v[212:215], v8, s[8:11], s17 offen offset:3072
    s_waitcnt vmcnt(3)
    v_mfma_f32_16x16x32_bf16 v[184:187], v[200:203], v[152:155], v[216:219]
    v_mfma_f32_16x16x32_bf16 v[188:191], v[200:203], v[168:171], v[220:223]
    s_waitcnt vmcnt(2)
    v_mfma_f32_16x16x32_bf16 v[192:195], v[204:207], v[152:155], v[216:219]
    v_mfma_f32_16x16x32_bf16 v[196:199], v[204:207], v[168:171], v[220:223]
    s_waitcnt vmcnt(1)
    v_mfma_f32_16x16x32_bf16 v[184:187], v[208:211], v[156:159], v[184:187]
    v_mfma_f32_16x16x32_bf16 v[188:191], v[208:211], v[172:175], v[188:191]
    s_waitcnt vmcnt(0)
    v_mfma_f32_16x16x32_bf16 v[192:195], v[212:215], v[156:159], v[192:195]
    v_mfma_f32_16x16x32_bf16 v[196:199], v[212:215], v[172:175], v[196:199]
    s_mov_b32 s17, 0x3000
    buffer_load_dwordx4 v[200:203], v8, s[8:11], s17 offen offset:0
    buffer_load_dwordx4 v[204:207], v8, s[8:11], s17 offen offset:1024
    buffer_load_dwordx4 v[208:211], v8, s[8:11], s17 offen offset:2048
    buffer_load_dwordx4 v[212:215], v8, s[8:11], s17 offen offset:3072
    s_waitcnt vmcnt(3)
    v_mfma_f32_16x16x32_bf16 v[184:187], v[200:203], v[160:163], v[184:187]
    v_mfma_f32_16x16x32_bf16 v[188:191], v[200:203], v[176:179], v[188:191]
    s_waitcnt vmcnt(2)
    v_mfma_f32_16x16x32_bf16 v[192:195], v[204:207], v[160:163], v[192:195]
    v_mfma_f32_16x16x32_bf16 v[196:199], v[204:207], v[176:179], v[196:199]
    s_waitcnt vmcnt(1)
    v_mfma_f32_16x16x32_bf16 v[184:187], v[208:211], v[164:167], v[184:187]
    v_mfma_f32_16x16x32_bf16 v[188:191], v[208:211], v[180:183], v[188:191]
    s_waitcnt vmcnt(0)
    v_mfma_f32_16x16x32_bf16 v[192:195], v[212:215], v[164:167], v[192:195]
    v_mfma_f32_16x16x32_bf16 v[196:199], v[212:215], v[180:183], v[196:199]
    s_nop 3
    v_exp_f32 v184, v184
    v_exp_f32 v185, v185
    v_add_f32 v9, v9, v184
    v_add_f32 v9, v9, v185
    v_cvt_pk_bf16_f32 v32, v184, v185
    v_exp_f32 v186, v186
    v_exp_f32 v187, v187
    v_add_f32 v9, v9, v186
    v_add_f32 v9, v9, v187
    v_cvt_pk_bf16_f32 v33, v186, v187
    v_exp_f32 v188, v188
    v_exp_f32 v189, v189
    v_add_f32 v10, v10, v188
    v_add_f32 v10, v10, v189
    v_cvt_pk_bf16_f32 v36, v188, v189
    v_exp_f32 v190, v190
    v_exp_f32 v191, v191
    v_add_f32 v10, v10, v190
    v_add_f32 v10, v10, v191
    v_cvt_pk_bf16_f32 v37, v190, v191
    v_exp_f32 v192, v192
    v_exp_f32 v193, v193
    v_add_f32 v9, v9, v192
    v_add_f32 v9, v9, v193
    v_cvt_pk_bf16_f32 v34, v192, v193
    v_exp_f32 v194, v194
    v_exp_f32 v195, v195
    v_add_f32 v9, v9, v194
    v_add_f32 v9, v9, v195
    v_cvt_pk_bf16_f32 v35, v194, v195
    v_exp_f32 v196, v196
    v_exp_f32 v197, v197
    v_add_f32 v10, v10, v196
    v_add_f32 v10, v10, v197
    v_cvt_pk_bf16_f32 v38, v196, v197
    v_exp_f32 v198, v198
    v_exp_f32 v199, v199
    v_add_f32 v10, v10, v198
    v_add_f32 v10, v10, v199
    v_cvt_pk_bf16_f32 v39, v198, v199
    s_mov_b32 s17, 0x4000
    buffer_load_dwordx4 v[200:203], v8, s[8:11], s17 offen offset:0
    buffer_load_dwordx4 v[204:207], v8, s[8:11], s17 offen offset:1024
    buffer_load_dwordx4 v[208:211], v8, s[8:11], s17 offen offset:2048
    buffer_load_dwordx4 v[212:215], v8, s[8:11], s17 offen offset:3072
    s_waitcnt vmcnt(3)
    v_mfma_f32_16x16x32_bf16 v[184:187], v[200:203], v[152:155], v[216:219]
    v_mfma_f32_16x16x32_bf16 v[188:191], v[200:203], v[168:171], v[220:223]
    s_waitcnt vmcnt(2)
    v_mfma_f32_16x16x32_bf16 v[192:195], v[204:207], v[152:155], v[216:219]
    v_mfma_f32_16x16x32_bf16 v[196:199], v[204:207], v[168:171], v[220:223]
    s_waitcnt vmcnt(1)
    v_mfma_f32_16x16x32_bf16 v[184:187], v[208:211], v[156:159], v[184:187]
    v_mfma_f32_16x16x32_bf16 v[188:191], v[208:211], v[172:175], v[188:191]
    s_waitcnt vmcnt(0)
    v_mfma_f32_16x16x32_bf16 v[192:195], v[212:215], v[156:159], v[192:195]
    v_mfma_f32_16x16x32_bf16 v[196:199], v[212:215], v[172:175], v[196:199]
    s_mov_b32 s17, 0x5000
    buffer_load_dwordx4 v[200:203], v8, s[8:11], s17 offen offset:0
    buffer_load_dwordx4 v[204:207], v8, s[8:11], s17 offen offset:1024
    buffer_load_dwordx4 v[208:211], v8, s[8:11], s17 offen offset:2048
    buffer_load_dwordx4 v[212:215], v8, s[8:11], s17 offen offset:3072
    s_waitcnt vmcnt(3)
    v_mfma_f32_16x16x32_bf16 v[184:187], v[200:203], v[160:163], v[184:187]
    v_mfma_f32_16x16x32_bf16 v[188:191], v[200:203], v[176:179], v[188:191]
    s_waitcnt vmcnt(2)
    v_mfma_f32_16x16x32_bf16 v[192:195], v[204:207], v[160:163], v[192:195]
    v_mfma_f32_16x16x32_bf16 v[196:199], v[204:207], v[176:179], v[196:199]
    s_waitcnt vmcnt(1)
    v_mfma_f32_16x16x32_bf16 v[184:187], v[208:211], v[164:167], v[184:187]
    v_mfma_f32_16x16x32_bf16 v[188:191], v[208:211], v[180:183], v[188:191]
    s_waitcnt vmcnt(0)
    v_mfma_f32_16x16x32_bf16 v[192:195], v[212:215], v[164:167], v[192:195]
    v_mfma_f32_16x16x32_bf16 v[196:199], v[212:215], v[180:183], v[196:199]
    s_nop 3
    v_exp_f32 v184, v184
    v_exp_f32 v185, v185
    v_add_f32 v9, v9, v184
    v_add_f32 v9, v9, v185
    v_cvt_pk_bf16_f32 v40, v184, v185
    v_exp_f32 v186, v186
    v_exp_f32 v187, v187
    v_add_f32 v9, v9, v186
    v_add_f32 v9, v9, v187
    v_cvt_pk_bf16_f32 v41, v186, v187
    v_exp_f32 v188, v188
    v_exp_f32 v189, v189
    v_add_f32 v10, v10, v188
    v_add_f32 v10, v10, v189
    v_cvt_pk_bf16_f32 v44, v188, v189
    v_exp_f32 v190, v190
    v_exp_f32 v191, v191
    v_add_f32 v10, v10, v190
    v_add_f32 v10, v10, v191
    v_cvt_pk_bf16_f32 v45, v190, v191
    v_exp_f32 v192, v192
    v_exp_f32 v193, v193
    v_add_f32 v9, v9, v192
    v_add_f32 v9, v9, v193
    v_cvt_pk_bf16_f32 v42, v192, v193
    v_exp_f32 v194, v194
    v_exp_f32 v195, v195
    v_add_f32 v9, v9, v194
    v_add_f32 v9, v9, v195
    v_cvt_pk_bf16_f32 v43, v194, v195
    v_exp_f32 v196, v196
    v_exp_f32 v197, v197
    v_add_f32 v10, v10, v196
    v_add_f32 v10, v10, v197
    v_cvt_pk_bf16_f32 v46, v196, v197
    v_exp_f32 v198, v198
    v_exp_f32 v199, v199
    v_add_f32 v10, v10, v198
    v_add_f32 v10, v10, v199
    v_cvt_pk_bf16_f32 v47, v198, v199
    s_mov_b32 s17, 0x6000
    buffer_load_dwordx4 v[200:203], v8, s[8:11], s17 offen offset:0
    buffer_load_dwordx4 v[204:207], v8, s[8:11], s17 offen offset:1024
    buffer_load_dwordx4 v[208:211], v8, s[8:11], s17 offen offset:2048
    buffer_load_dwordx4 v[212:215], v8, s[8:11], s17 offen offset:3072
    s_waitcnt vmcnt(3)
    v_mfma_f32_16x16x32_bf16 v[184:187], v[200:203], v[152:155], v[216:219]
    v_mfma_f32_16x16x32_bf16 v[188:191], v[200:203], v[168:171], v[220:223]
    s_waitcnt vmcnt(2)
    v_mfma_f32_16x16x32_bf16 v[192:195], v[204:207], v[152:155], v[216:219]
    v_mfma_f32_16x16x32_bf16 v[196:199], v[204:207], v[168:171], v[220:223]
    s_waitcnt vmcnt(1)
    v_mfma_f32_16x16x32_bf16 v[184:187], v[208:211], v[156:159], v[184:187]
    v_mfma_f32_16x16x32_bf16 v[188:191], v[208:211], v[172:175], v[188:191]
    s_waitcnt vmcnt(0)
    v_mfma_f32_16x16x32_bf16 v[192:195], v[212:215], v[156:159], v[192:195]
    v_mfma_f32_16x16x32_bf16 v[196:199], v[212:215], v[172:175], v[196:199]
    s_mov_b32 s17, 0x7000
    buffer_load_dwordx4 v[200:203], v8, s[8:11], s17 offen offset:0
    buffer_load_dwordx4 v[204:207], v8, s[8:11], s17 offen offset:1024
    buffer_load_dwordx4 v[208:211], v8, s[8:11], s17 offen offset:2048
    buffer_load_dwordx4 v[212:215], v8, s[8:11], s17 offen offset:3072
    s_waitcnt vmcnt(3)
    v_mfma_f32_16x16x32_bf16 v[184:187], v[200:203], v[160:163], v[184:187]
    v_mfma_f32_16x16x32_bf16 v[188:191], v[200:203], v[176:179], v[188:191]
    s_waitcnt vmcnt(2)
    v_mfma_f32_16x16x32_bf16 v[192:195], v[204:207], v[160:163], v[192:195]
    v_mfma_f32_16x16x32_bf16 v[196:199], v[204:207], v[176:179], v[196:199]
    s_waitcnt vmcnt(1)
    v_mfma_f32_16x16x32_bf16 v[184:187], v[208:211], v[164:167], v[184:187]
    v_mfma_f32_16x16x32_bf16 v[188:191], v[208:211], v[180:183], v[188:191]
    s_waitcnt vmcnt(0)
    v_mfma_f32_16x16x32_bf16 v[192:195], v[212:215], v[164:167], v[192:195]
    v_mfma_f32_16x16x32_bf16 v[196:199], v[212:215], v[180:183], v[196:199]
    s_nop 3
    v_exp_f32 v184, v184
    v_exp_f32 v185, v185
    v_add_f32 v9, v9, v184
    v_add_f32 v9, v9, v185
    v_cvt_pk_bf16_f32 v48, v184, v185
    v_exp_f32 v186, v186
    v_exp_f32 v187, v187
    v_add_f32 v9, v9, v186
    v_add_f32 v9, v9, v187
    v_cvt_pk_bf16_f32 v49, v186, v187
    v_exp_f32 v188, v188
    v_exp_f32 v189, v189
    v_add_f32 v10, v10, v188
    v_add_f32 v10, v10, v189
    v_cvt_pk_bf16_f32 v52, v188, v189
    v_exp_f32 v190, v190
    v_exp_f32 v191, v191
    v_add_f32 v10, v10, v190
    v_add_f32 v10, v10, v191
    v_cvt_pk_bf16_f32 v53, v190, v191
    v_exp_f32 v192, v192
    v_exp_f32 v193, v193
    v_add_f32 v9, v9, v192
    v_add_f32 v9, v9, v193
    v_cvt_pk_bf16_f32 v50, v192, v193
    v_exp_f32 v194, v194
    v_exp_f32 v195, v195
    v_add_f32 v9, v9, v194
    v_add_f32 v9, v9, v195
    v_cvt_pk_bf16_f32 v51, v194, v195
    v_exp_f32 v196, v196
    v_exp_f32 v197, v197
    v_add_f32 v10, v10, v196
    v_add_f32 v10, v10, v197
    v_cvt_pk_bf16_f32 v54, v196, v197
    v_exp_f32 v198, v198
    v_exp_f32 v199, v199
    v_add_f32 v10, v10, v198
    v_add_f32 v10, v10, v199
    v_cvt_pk_bf16_f32 v55, v198, v199
    s_mov_b32 s17, 0x8000
    buffer_load_dwordx4 v[200:203], v8, s[8:11], s17 offen offset:0
    buffer_load_dwordx4 v[204:207], v8, s[8:11], s17 offen offset:1024
    buffer_load_dwordx4 v[208:211], v8, s[8:11], s17 offen offset:2048
    buffer_load_dwordx4 v[212:215], v8, s[8:11], s17 offen offset:3072
    s_waitcnt vmcnt(3)
    v_mfma_f32_16x16x32_bf16 v[184:187], v[200:203], v[152:155], v[216:219]
    v_mfma_f32_16x16x32_bf16 v[188:191], v[200:203], v[168:171], v[220:223]
    s_waitcnt vmcnt(2)
    v_mfma_f32_16x16x32_bf16 v[192:195], v[204:207], v[152:155], v[216:219]
    v_mfma_f32_16x16x32_bf16 v[196:199], v[204:207], v[168:171], v[220:223]
    s_waitcnt vmcnt(1)
    v_mfma_f32_16x16x32_bf16 v[184:187], v[208:211], v[156:159], v[184:187]
    v_mfma_f32_16x16x32_bf16 v[188:191], v[208:211], v[172:175], v[188:191]
    s_waitcnt vmcnt(0)
    v_mfma_f32_16x16x32_bf16 v[192:195], v[212:215], v[156:159], v[192:195]
    v_mfma_f32_16x16x32_bf16 v[196:199], v[212:215], v[172:175], v[196:199]
    s_mov_b32 s17, 0x9000
    buffer_load_dwordx4 v[200:203], v8, s[8:11], s17 offen offset:0
    buffer_load_dwordx4 v[204:207], v8, s[8:11], s17 offen offset:1024
    buffer_load_dwordx4 v[208:211], v8, s[8:11], s17 offen offset:2048
    buffer_load_dwordx4 v[212:215], v8, s[8:11], s17 offen offset:3072
    s_waitcnt vmcnt(3)
    v_mfma_f32_16x16x32_bf16 v[184:187], v[200:203], v[160:163], v[184:187]
    v_mfma_f32_16x16x32_bf16 v[188:191], v[200:203], v[176:179], v[188:191]
    s_waitcnt vmcnt(2)
    v_mfma_f32_16x16x32_bf16 v[192:195], v[204:207], v[160:163], v[192:195]
    v_mfma_f32_16x16x32_bf16 v[196:199], v[204:207], v[176:179], v[196:199]
    s_waitcnt vmcnt(1)
    v_mfma_f32_16x16x32_bf16 v[184:187], v[208:211], v[164:167], v[184:187]
    v_mfma_f32_16x16x32_bf16 v[188:191], v[208:211], v[180:183], v[188:191]
    s_waitcnt vmcnt(0)
    v_mfma_f32_16x16x32_bf16 v[192:195], v[212:215], v[164:167], v[192:195]
    v_mfma_f32_16x16x32_bf16 v[196:199], v[212:215], v[180:183], v[196:199]
    s_nop 3
    v_exp_f32 v184, v184
    v_exp_f32 v185, v185
    v_add_f32 v9, v9, v184
    v_add_f32 v9, v9, v185
    v_cvt_pk_bf16_f32 v56, v184, v185
    v_exp_f32 v186, v186
    v_exp_f32 v187, v187
    v_add_f32 v9, v9, v186
    v_add_f32 v9, v9, v187
    v_cvt_pk_bf16_f32 v57, v186, v187
    v_exp_f32 v188, v188
    v_exp_f32 v189, v189
    v_add_f32 v10, v10, v188
    v_add_f32 v10, v10, v189
    v_cvt_pk_bf16_f32 v60, v188, v189
    v_exp_f32 v190, v190
    v_exp_f32 v191, v191
    v_add_f32 v10, v10, v190
    v_add_f32 v10, v10, v191
    v_cvt_pk_bf16_f32 v61, v190, v191
    v_exp_f32 v192, v192
    v_exp_f32 v193, v193
    v_add_f32 v9, v9, v192
    v_add_f32 v9, v9, v193
    v_cvt_pk_bf16_f32 v58, v192, v193
    v_exp_f32 v194, v194
    v_exp_f32 v195, v195
    v_add_f32 v9, v9, v194
    v_add_f32 v9, v9, v195
    v_cvt_pk_bf16_f32 v59, v194, v195
    v_exp_f32 v196, v196
    v_exp_f32 v197, v197
    v_add_f32 v10, v10, v196
    v_add_f32 v10, v10, v197
    v_cvt_pk_bf16_f32 v62, v196, v197
    v_exp_f32 v198, v198
    v_exp_f32 v199, v199
    v_add_f32 v10, v10, v198
    v_add_f32 v10, v10, v199
    v_cvt_pk_bf16_f32 v63, v198, v199
    s_mov_b32 s17, 0xa000
    buffer_load_dwordx4 v[200:203], v8, s[8:11], s17 offen offset:0
    buffer_load_dwordx4 v[204:207], v8, s[8:11], s17 offen offset:1024
    buffer_load_dwordx4 v[208:211], v8, s[8:11], s17 offen offset:2048
    buffer_load_dwordx4 v[212:215], v8, s[8:11], s17 offen offset:3072
    s_waitcnt vmcnt(3)
    v_mfma_f32_16x16x32_bf16 v[184:187], v[200:203], v[152:155], v[216:219]
    v_mfma_f32_16x16x32_bf16 v[188:191], v[200:203], v[168:171], v[220:223]
    s_waitcnt vmcnt(2)
    v_mfma_f32_16x16x32_bf16 v[192:195], v[204:207], v[152:155], v[216:219]
    v_mfma_f32_16x16x32_bf16 v[196:199], v[204:207], v[168:171], v[220:223]
    s_waitcnt vmcnt(1)
    v_mfma_f32_16x16x32_bf16 v[184:187], v[208:211], v[156:159], v[184:187]
    v_mfma_f32_16x16x32_bf16 v[188:191], v[208:211], v[172:175], v[188:191]
    s_waitcnt vmcnt(0)
    v_mfma_f32_16x16x32_bf16 v[192:195], v[212:215], v[156:159], v[192:195]
    v_mfma_f32_16x16x32_bf16 v[196:199], v[212:215], v[172:175], v[196:199]
    s_mov_b32 s17, 0xb000
    buffer_load_dwordx4 v[200:203], v8, s[8:11], s17 offen offset:0
    buffer_load_dwordx4 v[204:207], v8, s[8:11], s17 offen offset:1024
    buffer_load_dwordx4 v[208:211], v8, s[8:11], s17 offen offset:2048
    buffer_load_dwordx4 v[212:215], v8, s[8:11], s17 offen offset:3072
    s_waitcnt vmcnt(3)
    v_mfma_f32_16x16x32_bf16 v[184:187], v[200:203], v[160:163], v[184:187]
    v_mfma_f32_16x16x32_bf16 v[188:191], v[200:203], v[176:179], v[188:191]
    s_waitcnt vmcnt(2)
    v_mfma_f32_16x16x32_bf16 v[192:195], v[204:207], v[160:163], v[192:195]
    v_mfma_f32_16x16x32_bf16 v[196:199], v[204:207], v[176:179], v[196:199]
    s_waitcnt vmcnt(1)
    v_mfma_f32_16x16x32_bf16 v[184:187], v[208:211], v[164:167], v[184:187]
    v_mfma_f32_16x16x32_bf16 v[188:191], v[208:211], v[180:183], v[188:191]
    s_waitcnt vmcnt(0)
    v_mfma_f32_16x16x32_bf16 v[192:195], v[212:215], v[164:167], v[192:195]
    v_mfma_f32_16x16x32_bf16 v[196:199], v[212:215], v[180:183], v[196:199]
    s_nop 3
    v_exp_f32 v184, v184
    v_exp_f32 v185, v185
    v_add_f32 v9, v9, v184
    v_add_f32 v9, v9, v185
    v_cvt_pk_bf16_f32 v64, v184, v185
    v_exp_f32 v186, v186
    v_exp_f32 v187, v187
    v_add_f32 v9, v9, v186
    v_add_f32 v9, v9, v187
    v_cvt_pk_bf16_f32 v65, v186, v187
    v_exp_f32 v188, v188
    v_exp_f32 v189, v189
    v_add_f32 v10, v10, v188
    v_add_f32 v10, v10, v189
    v_cvt_pk_bf16_f32 v68, v188, v189
    v_exp_f32 v190, v190
    v_exp_f32 v191, v191
    v_add_f32 v10, v10, v190
    v_add_f32 v10, v10, v191
    v_cvt_pk_bf16_f32 v69, v190, v191
    v_exp_f32 v192, v192
    v_exp_f32 v193, v193
    v_add_f32 v9, v9, v192
    v_add_f32 v9, v9, v193
    v_cvt_pk_bf16_f32 v66, v192, v193
    v_exp_f32 v194, v194
    v_exp_f32 v195, v195
    v_add_f32 v9, v9, v194
    v_add_f32 v9, v9, v195
    v_cvt_pk_bf16_f32 v67, v194, v195
    v_exp_f32 v196, v196
    v_exp_f32 v197, v197
    v_add_f32 v10, v10, v196
    v_add_f32 v10, v10, v197
    v_cvt_pk_bf16_f32 v70, v196, v197
    v_exp_f32 v198, v198
    v_exp_f32 v199, v199
    v_add_f32 v10, v10, v198
    v_add_f32 v10, v10, v199
    v_cvt_pk_bf16_f32 v71, v198, v199
    s_mov_b32 s17, 0xc000
    buffer_load_dwordx4 v[200:203], v8, s[8:11], s17 offen offset:0
    buffer_load_dwordx4 v[204:207], v8, s[8:11], s17 offen offset:1024
    buffer_load_dwordx4 v[208:211], v8, s[8:11], s17 offen offset:2048
    buffer_load_dwordx4 v[212:215], v8, s[8:11], s17 offen offset:3072
    s_waitcnt vmcnt(3)
    v_mfma_f32_16x16x32_bf16 v[184:187], v[200:203], v[152:155], v[216:219]
    v_mfma_f32_16x16x32_bf16 v[188:191], v[200:203], v[168:171], v[220:223]
    s_waitcnt vmcnt(2)
    v_mfma_f32_16x16x32_bf16 v[192:195], v[204:207], v[152:155], v[216:219]
    v_mfma_f32_16x16x32_bf16 v[196:199], v[204:207], v[168:171], v[220:223]
    s_waitcnt vmcnt(1)
    v_mfma_f32_16x16x32_bf16 v[184:187], v[208:211], v[156:159], v[184:187]
    v_mfma_f32_16x16x32_bf16 v[188:191], v[208:211], v[172:175], v[188:191]
    s_waitcnt vmcnt(0)
    v_mfma_f32_16x16x32_bf16 v[192:195], v[212:215], v[156:159], v[192:195]
    v_mfma_f32_16x16x32_bf16 v[196:199], v[212:215], v[172:175], v[196:199]
    s_mov_b32 s17, 0xd000
    buffer_load_dwordx4 v[200:203], v8, s[8:11], s17 offen offset:0
    buffer_load_dwordx4 v[204:207], v8, s[8:11], s17 offen offset:1024
    buffer_load_dwordx4 v[208:211], v8, s[8:11], s17 offen offset:2048
    buffer_load_dwordx4 v[212:215], v8, s[8:11], s17 offen offset:3072
    s_waitcnt vmcnt(3)
    v_mfma_f32_16x16x32_bf16 v[184:187], v[200:203], v[160:163], v[184:187]
    v_mfma_f32_16x16x32_bf16 v[188:191], v[200:203], v[176:179], v[188:191]
    s_waitcnt vmcnt(2)
    v_mfma_f32_16x16x32_bf16 v[192:195], v[204:207], v[160:163], v[192:195]
    v_mfma_f32_16x16x32_bf16 v[196:199], v[204:207], v[176:179], v[196:199]
    s_waitcnt vmcnt(1)
    v_mfma_f32_16x16x32_bf16 v[184:187], v[208:211], v[164:167], v[184:187]
    v_mfma_f32_16x16x32_bf16 v[188:191], v[208:211], v[180:183], v[188:191]
    s_waitcnt vmcnt(0)
    v_mfma_f32_16x16x32_bf16 v[192:195], v[212:215], v[164:167], v[192:195]
    v_mfma_f32_16x16x32_bf16 v[196:199], v[212:215], v[180:183], v[196:199]
    s_nop 3
    v_exp_f32 v184, v184
    v_exp_f32 v185, v185
    v_add_f32 v9, v9, v184
    v_add_f32 v9, v9, v185
    v_cvt_pk_bf16_f32 v72, v184, v185
    v_exp_f32 v186, v186
    v_exp_f32 v187, v187
    v_add_f32 v9, v9, v186
    v_add_f32 v9, v9, v187
    v_cvt_pk_bf16_f32 v73, v186, v187
    v_exp_f32 v188, v188
    v_exp_f32 v189, v189
    v_add_f32 v10, v10, v188
    v_add_f32 v10, v10, v189
    v_cvt_pk_bf16_f32 v76, v188, v189
    v_exp_f32 v190, v190
    v_exp_f32 v191, v191
    v_add_f32 v10, v10, v190
    v_add_f32 v10, v10, v191
    v_cvt_pk_bf16_f32 v77, v190, v191
    v_exp_f32 v192, v192
    v_exp_f32 v193, v193
    v_add_f32 v9, v9, v192
    v_add_f32 v9, v9, v193
    v_cvt_pk_bf16_f32 v74, v192, v193
    v_exp_f32 v194, v194
    v_exp_f32 v195, v195
    v_add_f32 v9, v9, v194
    v_add_f32 v9, v9, v195
    v_cvt_pk_bf16_f32 v75, v194, v195
    v_exp_f32 v196, v196
    v_exp_f32 v197, v197
    v_add_f32 v10, v10, v196
    v_add_f32 v10, v10, v197
    v_cvt_pk_bf16_f32 v78, v196, v197
    v_exp_f32 v198, v198
    v_exp_f32 v199, v199
    v_add_f32 v10, v10, v198
    v_add_f32 v10, v10, v199
    v_cvt_pk_bf16_f32 v79, v198, v199
    s_mov_b32 s17, 0xe000
    buffer_load_dwordx4 v[200:203], v8, s[8:11], s17 offen offset:0
    buffer_load_dwordx4 v[204:207], v8, s[8:11], s17 offen offset:1024
    buffer_load_dwordx4 v[208:211], v8, s[8:11], s17 offen offset:2048
    buffer_load_dwordx4 v[212:215], v8, s[8:11], s17 offen offset:3072
    s_waitcnt vmcnt(3)
    v_mfma_f32_16x16x32_bf16 v[184:187], v[200:203], v[152:155], v[216:219]
    v_mfma_f32_16x16x32_bf16 v[188:191], v[200:203], v[168:171], v[220:223]
    s_waitcnt vmcnt(2)
    v_mfma_f32_16x16x32_bf16 v[192:195], v[204:207], v[152:155], v[216:219]
    v_mfma_f32_16x16x32_bf16 v[196:199], v[204:207], v[168:171], v[220:223]
    s_waitcnt vmcnt(1)
    v_mfma_f32_16x16x32_bf16 v[184:187], v[208:211], v[156:159], v[184:187]
    v_mfma_f32_16x16x32_bf16 v[188:191], v[208:211], v[172:175], v[188:191]
    s_waitcnt vmcnt(0)
    v_mfma_f32_16x16x32_bf16 v[192:195], v[212:215], v[156:159], v[192:195]
    v_mfma_f32_16x16x32_bf16 v[196:199], v[212:215], v[172:175], v[196:199]
    s_mov_b32 s17, 0xf000
    buffer_load_dwordx4 v[200:203], v8, s[8:11], s17 offen offset:0
    buffer_load_dwordx4 v[204:207], v8, s[8:11], s17 offen offset:1024
    buffer_load_dwordx4 v[208:211], v8, s[8:11], s17 offen offset:2048
    buffer_load_dwordx4 v[212:215], v8, s[8:11], s17 offen offset:3072
    s_waitcnt vmcnt(3)
    v_mfma_f32_16x16x32_bf16 v[184:187], v[200:203], v[160:163], v[184:187]
    v_mfma_f32_16x16x32_bf16 v[188:191], v[200:203], v[176:179], v[188:191]
    s_waitcnt vmcnt(2)
    v_mfma_f32_16x16x32_bf16 v[192:195], v[204:207], v[160:163], v[192:195]
    v_mfma_f32_16x16x32_bf16 v[196:199], v[204:207], v[176:179], v[196:199]
    s_waitcnt vmcnt(1)
    v_mfma_f32_16x16x32_bf16 v[184:187], v[208:211], v[164:167], v[184:187]
    v_mfma_f32_16x16x32_bf16 v[188:191], v[208:211], v[180:183], v[188:191]
    s_waitcnt vmcnt(0)
    v_mfma_f32_16x16x32_bf16 v[192:195], v[212:215], v[164:167], v[192:195]
    v_mfma_f32_16x16x32_bf16 v[196:199], v[212:215], v[180:183], v[196:199]
    s_nop 3
    v_exp_f32 v184, v184
    v_exp_f32 v185, v185
    v_add_f32 v9, v9, v184
    v_add_f32 v9, v9, v185
    v_cvt_pk_bf16_f32 v80, v184, v185
    v_exp_f32 v186, v186
    v_exp_f32 v187, v187
    v_add_f32 v9, v9, v186
    v_add_f32 v9, v9, v187
    v_cvt_pk_bf16_f32 v81, v186, v187
    v_exp_f32 v188, v188
    v_exp_f32 v189, v189
    v_add_f32 v10, v10, v188
    v_add_f32 v10, v10, v189
    v_cvt_pk_bf16_f32 v84, v188, v189
    v_exp_f32 v190, v190
    v_exp_f32 v191, v191
    v_add_f32 v10, v10, v190
    v_add_f32 v10, v10, v191
    v_cvt_pk_bf16_f32 v85, v190, v191
    v_exp_f32 v192, v192
    v_exp_f32 v193, v193
    v_add_f32 v9, v9, v192
    v_add_f32 v9, v9, v193
    v_cvt_pk_bf16_f32 v82, v192, v193
    v_exp_f32 v194, v194
    v_exp_f32 v195, v195
    v_add_f32 v9, v9, v194
    v_add_f32 v9, v9, v195
    v_cvt_pk_bf16_f32 v83, v194, v195
    v_exp_f32 v196, v196
    v_exp_f32 v197, v197
    v_add_f32 v10, v10, v196
    v_add_f32 v10, v10, v197
    v_cvt_pk_bf16_f32 v86, v196, v197
    v_exp_f32 v198, v198
    v_exp_f32 v199, v199
    v_add_f32 v10, v10, v198
    v_add_f32 v10, v10, v199
    v_cvt_pk_bf16_f32 v87, v198, v199
    s_mov_b32 s17, 0x10000
    buffer_load_dwordx4 v[200:203], v8, s[8:11], s17 offen offset:0
    buffer_load_dwordx4 v[204:207], v8, s[8:11], s17 offen offset:1024
    buffer_load_dwordx4 v[208:211], v8, s[8:11], s17 offen offset:2048
    buffer_load_dwordx4 v[212:215], v8, s[8:11], s17 offen offset:3072
    s_waitcnt vmcnt(3)
    v_mfma_f32_16x16x32_bf16 v[184:187], v[200:203], v[152:155], v[216:219]
    v_mfma_f32_16x16x32_bf16 v[188:191], v[200:203], v[168:171], v[220:223]
    s_waitcnt vmcnt(2)
    v_mfma_f32_16x16x32_bf16 v[192:195], v[204:207], v[152:155], v[216:219]
    v_mfma_f32_16x16x32_bf16 v[196:199], v[204:207], v[168:171], v[220:223]
    s_waitcnt vmcnt(1)
    v_mfma_f32_16x16x32_bf16 v[184:187], v[208:211], v[156:159], v[184:187]
    v_mfma_f32_16x16x32_bf16 v[188:191], v[208:211], v[172:175], v[188:191]
    s_waitcnt vmcnt(0)
    v_mfma_f32_16x16x32_bf16 v[192:195], v[212:215], v[156:159], v[192:195]
    v_mfma_f32_16x16x32_bf16 v[196:199], v[212:215], v[172:175], v[196:199]
    s_mov_b32 s17, 0x11000
    buffer_load_dwordx4 v[200:203], v8, s[8:11], s17 offen offset:0
    buffer_load_dwordx4 v[204:207], v8, s[8:11], s17 offen offset:1024
    buffer_load_dwordx4 v[208:211], v8, s[8:11], s17 offen offset:2048
    buffer_load_dwordx4 v[212:215], v8, s[8:11], s17 offen offset:3072
    s_waitcnt vmcnt(3)
    v_mfma_f32_16x16x32_bf16 v[184:187], v[200:203], v[160:163], v[184:187]
    v_mfma_f32_16x16x32_bf16 v[188:191], v[200:203], v[176:179], v[188:191]
    s_waitcnt vmcnt(2)
    v_mfma_f32_16x16x32_bf16 v[192:195], v[204:207], v[160:163], v[192:195]
    v_mfma_f32_16x16x32_bf16 v[196:199], v[204:207], v[176:179], v[196:199]
    s_waitcnt vmcnt(1)
    v_mfma_f32_16x16x32_bf16 v[184:187], v[208:211], v[164:167], v[184:187]
    v_mfma_f32_16x16x32_bf16 v[188:191], v[208:211], v[180:183], v[188:191]
    s_waitcnt vmcnt(0)
    v_mfma_f32_16x16x32_bf16 v[192:195], v[212:215], v[164:167], v[192:195]
    v_mfma_f32_16x16x32_bf16 v[196:199], v[212:215], v[180:183], v[196:199]
    s_nop 3
    v_exp_f32 v184, v184
    v_exp_f32 v185, v185
    v_add_f32 v9, v9, v184
    v_add_f32 v9, v9, v185
    v_cvt_pk_bf16_f32 v88, v184, v185
    v_exp_f32 v186, v186
    v_exp_f32 v187, v187
    v_add_f32 v9, v9, v186
    v_add_f32 v9, v9, v187
    v_cvt_pk_bf16_f32 v89, v186, v187
    v_exp_f32 v188, v188
    v_exp_f32 v189, v189
    v_add_f32 v10, v10, v188
    v_add_f32 v10, v10, v189
    v_cvt_pk_bf16_f32 v92, v188, v189
    v_exp_f32 v190, v190
    v_exp_f32 v191, v191
    v_add_f32 v10, v10, v190
    v_add_f32 v10, v10, v191
    v_cvt_pk_bf16_f32 v93, v190, v191
    v_exp_f32 v192, v192
    v_exp_f32 v193, v193
    v_add_f32 v9, v9, v192
    v_add_f32 v9, v9, v193
    v_cvt_pk_bf16_f32 v90, v192, v193
    v_exp_f32 v194, v194
    v_exp_f32 v195, v195
    v_add_f32 v9, v9, v194
    v_add_f32 v9, v9, v195
    v_cvt_pk_bf16_f32 v91, v194, v195
    v_exp_f32 v196, v196
    v_exp_f32 v197, v197
    v_add_f32 v10, v10, v196
    v_add_f32 v10, v10, v197
    v_cvt_pk_bf16_f32 v94, v196, v197
    v_exp_f32 v198, v198
    v_exp_f32 v199, v199
    v_add_f32 v10, v10, v198
    v_add_f32 v10, v10, v199
    v_cvt_pk_bf16_f32 v95, v198, v199
    s_mov_b32 s17, 0x12000
    buffer_load_dwordx4 v[200:203], v8, s[8:11], s17 offen offset:0
    buffer_load_dwordx4 v[204:207], v8, s[8:11], s17 offen offset:1024
    buffer_load_dwordx4 v[208:211], v8, s[8:11], s17 offen offset:2048
    buffer_load_dwordx4 v[212:215], v8, s[8:11], s17 offen offset:3072
    s_waitcnt vmcnt(3)
    v_mfma_f32_16x16x32_bf16 v[184:187], v[200:203], v[152:155], v[216:219]
    v_mfma_f32_16x16x32_bf16 v[188:191], v[200:203], v[168:171], v[220:223]
    s_waitcnt vmcnt(2)
    v_mfma_f32_16x16x32_bf16 v[192:195], v[204:207], v[152:155], v[216:219]
    v_mfma_f32_16x16x32_bf16 v[196:199], v[204:207], v[168:171], v[220:223]
    s_waitcnt vmcnt(1)
    v_mfma_f32_16x16x32_bf16 v[184:187], v[208:211], v[156:159], v[184:187]
    v_mfma_f32_16x16x32_bf16 v[188:191], v[208:211], v[172:175], v[188:191]
    s_waitcnt vmcnt(0)
    v_mfma_f32_16x16x32_bf16 v[192:195], v[212:215], v[156:159], v[192:195]
    v_mfma_f32_16x16x32_bf16 v[196:199], v[212:215], v[172:175], v[196:199]
    s_mov_b32 s17, 0x13000
    buffer_load_dwordx4 v[200:203], v8, s[8:11], s17 offen offset:0
    buffer_load_dwordx4 v[204:207], v8, s[8:11], s17 offen offset:1024
    buffer_load_dwordx4 v[208:211], v8, s[8:11], s17 offen offset:2048
    buffer_load_dwordx4 v[212:215], v8, s[8:11], s17 offen offset:3072
    s_waitcnt vmcnt(3)
    v_mfma_f32_16x16x32_bf16 v[184:187], v[200:203], v[160:163], v[184:187]
    v_mfma_f32_16x16x32_bf16 v[188:191], v[200:203], v[176:179], v[188:191]
    s_waitcnt vmcnt(2)
    v_mfma_f32_16x16x32_bf16 v[192:195], v[204:207], v[160:163], v[192:195]
    v_mfma_f32_16x16x32_bf16 v[196:199], v[204:207], v[176:179], v[196:199]
    s_waitcnt vmcnt(1)
    v_mfma_f32_16x16x32_bf16 v[184:187], v[208:211], v[164:167], v[184:187]
    v_mfma_f32_16x16x32_bf16 v[188:191], v[208:211], v[180:183], v[188:191]
    s_waitcnt vmcnt(0)
    v_mfma_f32_16x16x32_bf16 v[192:195], v[212:215], v[164:167], v[192:195]
    v_mfma_f32_16x16x32_bf16 v[196:199], v[212:215], v[180:183], v[196:199]
    s_nop 3
    v_exp_f32 v184, v184
    v_exp_f32 v185, v185
    v_add_f32 v9, v9, v184
    v_add_f32 v9, v9, v185
    v_cvt_pk_bf16_f32 v96, v184, v185
    v_exp_f32 v186, v186
    v_exp_f32 v187, v187
    v_add_f32 v9, v9, v186
    v_add_f32 v9, v9, v187
    v_cvt_pk_bf16_f32 v97, v186, v187
    v_exp_f32 v188, v188
    v_exp_f32 v189, v189
    v_add_f32 v10, v10, v188
    v_add_f32 v10, v10, v189
    v_cvt_pk_bf16_f32 v100, v188, v189
    v_exp_f32 v190, v190
    v_exp_f32 v191, v191
    v_add_f32 v10, v10, v190
    v_add_f32 v10, v10, v191
    v_cvt_pk_bf16_f32 v101, v190, v191
    v_exp_f32 v192, v192
    v_exp_f32 v193, v193
    v_add_f32 v9, v9, v192
    v_add_f32 v9, v9, v193
    v_cvt_pk_bf16_f32 v98, v192, v193
    v_exp_f32 v194, v194
    v_exp_f32 v195, v195
    v_add_f32 v9, v9, v194
    v_add_f32 v9, v9, v195
    v_cvt_pk_bf16_f32 v99, v194, v195
    v_exp_f32 v196, v196
    v_exp_f32 v197, v197
    v_add_f32 v10, v10, v196
    v_add_f32 v10, v10, v197
    v_cvt_pk_bf16_f32 v102, v196, v197
    v_exp_f32 v198, v198
    v_exp_f32 v199, v199
    v_add_f32 v10, v10, v198
    v_add_f32 v10, v10, v199
    v_cvt_pk_bf16_f32 v103, v198, v199
    s_mov_b32 s17, 0x14000
    buffer_load_dwordx4 v[200:203], v8, s[8:11], s17 offen offset:0
    buffer_load_dwordx4 v[204:207], v8, s[8:11], s17 offen offset:1024
    buffer_load_dwordx4 v[208:211], v8, s[8:11], s17 offen offset:2048
    buffer_load_dwordx4 v[212:215], v8, s[8:11], s17 offen offset:3072
    s_waitcnt vmcnt(3)
    v_mfma_f32_16x16x32_bf16 v[184:187], v[200:203], v[152:155], v[216:219]
    v_mfma_f32_16x16x32_bf16 v[188:191], v[200:203], v[168:171], v[220:223]
    s_waitcnt vmcnt(2)
    v_mfma_f32_16x16x32_bf16 v[192:195], v[204:207], v[152:155], v[216:219]
    v_mfma_f32_16x16x32_bf16 v[196:199], v[204:207], v[168:171], v[220:223]
    s_waitcnt vmcnt(1)
    v_mfma_f32_16x16x32_bf16 v[184:187], v[208:211], v[156:159], v[184:187]
    v_mfma_f32_16x16x32_bf16 v[188:191], v[208:211], v[172:175], v[188:191]
    s_waitcnt vmcnt(0)
    v_mfma_f32_16x16x32_bf16 v[192:195], v[212:215], v[156:159], v[192:195]
    v_mfma_f32_16x16x32_bf16 v[196:199], v[212:215], v[172:175], v[196:199]
    s_mov_b32 s17, 0x15000
    buffer_load_dwordx4 v[200:203], v8, s[8:11], s17 offen offset:0
    buffer_load_dwordx4 v[204:207], v8, s[8:11], s17 offen offset:1024
    buffer_load_dwordx4 v[208:211], v8, s[8:11], s17 offen offset:2048
    buffer_load_dwordx4 v[212:215], v8, s[8:11], s17 offen offset:3072
    s_waitcnt vmcnt(3)
    v_mfma_f32_16x16x32_bf16 v[184:187], v[200:203], v[160:163], v[184:187]
    v_mfma_f32_16x16x32_bf16 v[188:191], v[200:203], v[176:179], v[188:191]
    s_waitcnt vmcnt(2)
    v_mfma_f32_16x16x32_bf16 v[192:195], v[204:207], v[160:163], v[192:195]
    v_mfma_f32_16x16x32_bf16 v[196:199], v[204:207], v[176:179], v[196:199]
    s_waitcnt vmcnt(1)
    v_mfma_f32_16x16x32_bf16 v[184:187], v[208:211], v[164:167], v[184:187]
    v_mfma_f32_16x16x32_bf16 v[188:191], v[208:211], v[180:183], v[188:191]
    s_waitcnt vmcnt(0)
    v_mfma_f32_16x16x32_bf16 v[192:195], v[212:215], v[164:167], v[192:195]
    v_mfma_f32_16x16x32_bf16 v[196:199], v[212:215], v[180:183], v[196:199]
    s_nop 3
    v_exp_f32 v184, v184
    v_exp_f32 v185, v185
    v_add_f32 v9, v9, v184
    v_add_f32 v9, v9, v185
    v_cvt_pk_bf16_f32 v104, v184, v185
    v_exp_f32 v186, v186
    v_exp_f32 v187, v187
    v_add_f32 v9, v9, v186
    v_add_f32 v9, v9, v187
    v_cvt_pk_bf16_f32 v105, v186, v187
    v_exp_f32 v188, v188
    v_exp_f32 v189, v189
    v_add_f32 v10, v10, v188
    v_add_f32 v10, v10, v189
    v_cvt_pk_bf16_f32 v108, v188, v189
    v_exp_f32 v190, v190
    v_exp_f32 v191, v191
    v_add_f32 v10, v10, v190
    v_add_f32 v10, v10, v191
    v_cvt_pk_bf16_f32 v109, v190, v191
    v_exp_f32 v192, v192
    v_exp_f32 v193, v193
    v_add_f32 v9, v9, v192
    v_add_f32 v9, v9, v193
    v_cvt_pk_bf16_f32 v106, v192, v193
    v_exp_f32 v194, v194
    v_exp_f32 v195, v195
    v_add_f32 v9, v9, v194
    v_add_f32 v9, v9, v195
    v_cvt_pk_bf16_f32 v107, v194, v195
    v_exp_f32 v196, v196
    v_exp_f32 v197, v197
    v_add_f32 v10, v10, v196
    v_add_f32 v10, v10, v197
    v_cvt_pk_bf16_f32 v110, v196, v197
    v_exp_f32 v198, v198
    v_exp_f32 v199, v199
    v_add_f32 v10, v10, v198
    v_add_f32 v10, v10, v199
    v_cvt_pk_bf16_f32 v111, v198, v199
    s_mov_b32 s17, 0x16000
    buffer_load_dwordx4 v[200:203], v8, s[8:11], s17 offen offset:0
    buffer_load_dwordx4 v[204:207], v8, s[8:11], s17 offen offset:1024
    buffer_load_dwordx4 v[208:211], v8, s[8:11], s17 offen offset:2048
    buffer_load_dwordx4 v[212:215], v8, s[8:11], s17 offen offset:3072
    s_waitcnt vmcnt(3)
    v_mfma_f32_16x16x32_bf16 v[184:187], v[200:203], v[152:155], v[216:219]
    v_mfma_f32_16x16x32_bf16 v[188:191], v[200:203], v[168:171], v[220:223]
    s_waitcnt vmcnt(2)
    v_mfma_f32_16x16x32_bf16 v[192:195], v[204:207], v[152:155], v[216:219]
    v_mfma_f32_16x16x32_bf16 v[196:199], v[204:207], v[168:171], v[220:223]
    s_waitcnt vmcnt(1)
    v_mfma_f32_16x16x32_bf16 v[184:187], v[208:211], v[156:159], v[184:187]
    v_mfma_f32_16x16x32_bf16 v[188:191], v[208:211], v[172:175], v[188:191]
    s_waitcnt vmcnt(0)
    v_mfma_f32_16x16x32_bf16 v[192:195], v[212:215], v[156:159], v[192:195]
    v_mfma_f32_16x16x32_bf16 v[196:199], v[212:215], v[172:175], v[196:199]
    s_mov_b32 s17, 0x17000
    buffer_load_dwordx4 v[200:203], v8, s[8:11], s17 offen offset:0
    buffer_load_dwordx4 v[204:207], v8, s[8:11], s17 offen offset:1024
    buffer_load_dwordx4 v[208:211], v8, s[8:11], s17 offen offset:2048
    buffer_load_dwordx4 v[212:215], v8, s[8:11], s17 offen offset:3072
    s_waitcnt vmcnt(3)
    v_mfma_f32_16x16x32_bf16 v[184:187], v[200:203], v[160:163], v[184:187]
    v_mfma_f32_16x16x32_bf16 v[188:191], v[200:203], v[176:179], v[188:191]
    s_waitcnt vmcnt(2)
    v_mfma_f32_16x16x32_bf16 v[192:195], v[204:207], v[160:163], v[192:195]
    v_mfma_f32_16x16x32_bf16 v[196:199], v[204:207], v[176:179], v[196:199]
    s_waitcnt vmcnt(1)
    v_mfma_f32_16x16x32_bf16 v[184:187], v[208:211], v[164:167], v[184:187]
    v_mfma_f32_16x16x32_bf16 v[188:191], v[208:211], v[180:183], v[188:191]
    s_waitcnt vmcnt(0)
    v_mfma_f32_16x16x32_bf16 v[192:195], v[212:215], v[164:167], v[192:195]
    v_mfma_f32_16x16x32_bf16 v[196:199], v[212:215], v[180:183], v[196:199]
    s_nop 3
    v_exp_f32 v184, v184
    v_exp_f32 v185, v185
    v_add_f32 v9, v9, v184
    v_add_f32 v9, v9, v185
    v_cvt_pk_bf16_f32 v112, v184, v185
    v_exp_f32 v186, v186
    v_exp_f32 v187, v187
    v_add_f32 v9, v9, v186
    v_add_f32 v9, v9, v187
    v_cvt_pk_bf16_f32 v113, v186, v187
    v_exp_f32 v188, v188
    v_exp_f32 v189, v189
    v_add_f32 v10, v10, v188
    v_add_f32 v10, v10, v189
    v_cvt_pk_bf16_f32 v116, v188, v189
    v_exp_f32 v190, v190
    v_exp_f32 v191, v191
    v_add_f32 v10, v10, v190
    v_add_f32 v10, v10, v191
    v_cvt_pk_bf16_f32 v117, v190, v191
    v_exp_f32 v192, v192
    v_exp_f32 v193, v193
    v_add_f32 v9, v9, v192
    v_add_f32 v9, v9, v193
    v_cvt_pk_bf16_f32 v114, v192, v193
    v_exp_f32 v194, v194
    v_exp_f32 v195, v195
    v_add_f32 v9, v9, v194
    v_add_f32 v9, v9, v195
    v_cvt_pk_bf16_f32 v115, v194, v195
    v_exp_f32 v196, v196
    v_exp_f32 v197, v197
    v_add_f32 v10, v10, v196
    v_add_f32 v10, v10, v197
    v_cvt_pk_bf16_f32 v118, v196, v197
    v_exp_f32 v198, v198
    v_exp_f32 v199, v199
    v_add_f32 v10, v10, v198
    v_add_f32 v10, v10, v199
    v_cvt_pk_bf16_f32 v119, v198, v199
    s_mov_b32 s17, 0x18000
    buffer_load_dwordx4 v[200:203], v8, s[8:11], s17 offen offset:0
    buffer_load_dwordx4 v[204:207], v8, s[8:11], s17 offen offset:1024
    buffer_load_dwordx4 v[208:211], v8, s[8:11], s17 offen offset:2048
    buffer_load_dwordx4 v[212:215], v8, s[8:11], s17 offen offset:3072
    s_waitcnt vmcnt(3)
    v_mfma_f32_16x16x32_bf16 v[184:187], v[200:203], v[152:155], v[216:219]
    v_mfma_f32_16x16x32_bf16 v[188:191], v[200:203], v[168:171], v[220:223]
    s_waitcnt vmcnt(2)
    v_mfma_f32_16x16x32_bf16 v[192:195], v[204:207], v[152:155], v[216:219]
    v_mfma_f32_16x16x32_bf16 v[196:199], v[204:207], v[168:171], v[220:223]
    s_waitcnt vmcnt(1)
    v_mfma_f32_16x16x32_bf16 v[184:187], v[208:211], v[156:159], v[184:187]
    v_mfma_f32_16x16x32_bf16 v[188:191], v[208:211], v[172:175], v[188:191]
    s_waitcnt vmcnt(0)
    v_mfma_f32_16x16x32_bf16 v[192:195], v[212:215], v[156:159], v[192:195]
    v_mfma_f32_16x16x32_bf16 v[196:199], v[212:215], v[172:175], v[196:199]
    s_mov_b32 s17, 0x19000
    buffer_load_dwordx4 v[200:203], v8, s[8:11], s17 offen offset:0
    buffer_load_dwordx4 v[204:207], v8, s[8:11], s17 offen offset:1024
    buffer_load_dwordx4 v[208:211], v8, s[8:11], s17 offen offset:2048
    buffer_load_dwordx4 v[212:215], v8, s[8:11], s17 offen offset:3072
    s_waitcnt vmcnt(3)
    v_mfma_f32_16x16x32_bf16 v[184:187], v[200:203], v[160:163], v[184:187]
    v_mfma_f32_16x16x32_bf16 v[188:191], v[200:203], v[176:179], v[188:191]
    s_waitcnt vmcnt(2)
    v_mfma_f32_16x16x32_bf16 v[192:195], v[204:207], v[160:163], v[192:195]
    v_mfma_f32_16x16x32_bf16 v[196:199], v[204:207], v[176:179], v[196:199]
    s_waitcnt vmcnt(1)
    v_mfma_f32_16x16x32_bf16 v[184:187], v[208:211], v[164:167], v[184:187]
    v_mfma_f32_16x16x32_bf16 v[188:191], v[208:211], v[180:183], v[188:191]
    s_waitcnt vmcnt(0)
    v_mfma_f32_16x16x32_bf16 v[192:195], v[212:215], v[164:167], v[192:195]
    v_mfma_f32_16x16x32_bf16 v[196:199], v[212:215], v[180:183], v[196:199]
    s_nop 3
    v_exp_f32 v184, v184
    v_exp_f32 v185, v185
    v_add_f32 v9, v9, v184
    v_add_f32 v9, v9, v185
    v_cvt_pk_bf16_f32 v120, v184, v185
    v_exp_f32 v186, v186
    v_exp_f32 v187, v187
    v_add_f32 v9, v9, v186
    v_add_f32 v9, v9, v187
    v_cvt_pk_bf16_f32 v121, v186, v187
    v_exp_f32 v188, v188
    v_exp_f32 v189, v189
    v_add_f32 v10, v10, v188
    v_add_f32 v10, v10, v189
    v_cvt_pk_bf16_f32 v124, v188, v189
    v_exp_f32 v190, v190
    v_exp_f32 v191, v191
    v_add_f32 v10, v10, v190
    v_add_f32 v10, v10, v191
    v_cvt_pk_bf16_f32 v125, v190, v191
    v_exp_f32 v192, v192
    v_exp_f32 v193, v193
    v_add_f32 v9, v9, v192
    v_add_f32 v9, v9, v193
    v_cvt_pk_bf16_f32 v122, v192, v193
    v_exp_f32 v194, v194
    v_exp_f32 v195, v195
    v_add_f32 v9, v9, v194
    v_add_f32 v9, v9, v195
    v_cvt_pk_bf16_f32 v123, v194, v195
    v_exp_f32 v196, v196
    v_exp_f32 v197, v197
    v_add_f32 v10, v10, v196
    v_add_f32 v10, v10, v197
    v_cvt_pk_bf16_f32 v126, v196, v197
    v_exp_f32 v198, v198
    v_exp_f32 v199, v199
    v_add_f32 v10, v10, v198
    v_add_f32 v10, v10, v199
    v_cvt_pk_bf16_f32 v127, v198, v199
    s_mov_b32 s17, 0x1a000
    buffer_load_dwordx4 v[200:203], v8, s[8:11], s17 offen offset:0
    buffer_load_dwordx4 v[204:207], v8, s[8:11], s17 offen offset:1024
    buffer_load_dwordx4 v[208:211], v8, s[8:11], s17 offen offset:2048
    buffer_load_dwordx4 v[212:215], v8, s[8:11], s17 offen offset:3072
    s_waitcnt vmcnt(3)
    v_mfma_f32_16x16x32_bf16 v[184:187], v[200:203], v[152:155], v[216:219]
    v_mfma_f32_16x16x32_bf16 v[188:191], v[200:203], v[168:171], v[220:223]
    s_waitcnt vmcnt(2)
    v_mfma_f32_16x16x32_bf16 v[192:195], v[204:207], v[152:155], v[216:219]
    v_mfma_f32_16x16x32_bf16 v[196:199], v[204:207], v[168:171], v[220:223]
    s_waitcnt vmcnt(1)
    v_mfma_f32_16x16x32_bf16 v[184:187], v[208:211], v[156:159], v[184:187]
    v_mfma_f32_16x16x32_bf16 v[188:191], v[208:211], v[172:175], v[188:191]
    s_waitcnt vmcnt(0)
    v_mfma_f32_16x16x32_bf16 v[192:195], v[212:215], v[156:159], v[192:195]
    v_mfma_f32_16x16x32_bf16 v[196:199], v[212:215], v[172:175], v[196:199]
    s_mov_b32 s17, 0x1b000
    buffer_load_dwordx4 v[200:203], v8, s[8:11], s17 offen offset:0
    buffer_load_dwordx4 v[204:207], v8, s[8:11], s17 offen offset:1024
    buffer_load_dwordx4 v[208:211], v8, s[8:11], s17 offen offset:2048
    buffer_load_dwordx4 v[212:215], v8, s[8:11], s17 offen offset:3072
    s_waitcnt vmcnt(3)
    v_mfma_f32_16x16x32_bf16 v[184:187], v[200:203], v[160:163], v[184:187]
    v_mfma_f32_16x16x32_bf16 v[188:191], v[200:203], v[176:179], v[188:191]
    s_waitcnt vmcnt(2)
    v_mfma_f32_16x16x32_bf16 v[192:195], v[204:207], v[160:163], v[192:195]
    v_mfma_f32_16x16x32_bf16 v[196:199], v[204:207], v[176:179], v[196:199]
    s_waitcnt vmcnt(1)
    v_mfma_f32_16x16x32_bf16 v[184:187], v[208:211], v[164:167], v[184:187]
    v_mfma_f32_16x16x32_bf16 v[188:191], v[208:211], v[180:183], v[188:191]
    s_waitcnt vmcnt(0)
    v_mfma_f32_16x16x32_bf16 v[192:195], v[212:215], v[164:167], v[192:195]
    v_mfma_f32_16x16x32_bf16 v[196:199], v[212:215], v[180:183], v[196:199]
    s_nop 3
    v_exp_f32 v184, v184
    v_exp_f32 v185, v185
    v_add_f32 v9, v9, v184
    v_add_f32 v9, v9, v185
    v_cvt_pk_bf16_f32 v128, v184, v185
    v_exp_f32 v186, v186
    v_exp_f32 v187, v187
    v_add_f32 v9, v9, v186
    v_add_f32 v9, v9, v187
    v_cvt_pk_bf16_f32 v129, v186, v187
    v_exp_f32 v188, v188
    v_exp_f32 v189, v189
    v_add_f32 v10, v10, v188
    v_add_f32 v10, v10, v189
    v_cvt_pk_bf16_f32 v132, v188, v189
    v_exp_f32 v190, v190
    v_exp_f32 v191, v191
    v_add_f32 v10, v10, v190
    v_add_f32 v10, v10, v191
    v_cvt_pk_bf16_f32 v133, v190, v191
    v_exp_f32 v192, v192
    v_exp_f32 v193, v193
    v_add_f32 v9, v9, v192
    v_add_f32 v9, v9, v193
    v_cvt_pk_bf16_f32 v130, v192, v193
    v_exp_f32 v194, v194
    v_exp_f32 v195, v195
    v_add_f32 v9, v9, v194
    v_add_f32 v9, v9, v195
    v_cvt_pk_bf16_f32 v131, v194, v195
    v_exp_f32 v196, v196
    v_exp_f32 v197, v197
    v_add_f32 v10, v10, v196
    v_add_f32 v10, v10, v197
    v_cvt_pk_bf16_f32 v134, v196, v197
    v_exp_f32 v198, v198
    v_exp_f32 v199, v199
    v_add_f32 v10, v10, v198
    v_add_f32 v10, v10, v199
    v_cvt_pk_bf16_f32 v135, v198, v199
    s_mov_b32 s17, 0x1c000
    buffer_load_dwordx4 v[200:203], v8, s[8:11], s17 offen offset:0
    buffer_load_dwordx4 v[204:207], v8, s[8:11], s17 offen offset:1024
    buffer_load_dwordx4 v[208:211], v8, s[8:11], s17 offen offset:2048
    buffer_load_dwordx4 v[212:215], v8, s[8:11], s17 offen offset:3072
    s_waitcnt vmcnt(3)
    v_mfma_f32_16x16x32_bf16 v[184:187], v[200:203], v[152:155], v[216:219]
    v_mfma_f32_16x16x32_bf16 v[188:191], v[200:203], v[168:171], v[220:223]
    s_waitcnt vmcnt(2)
    v_mfma_f32_16x16x32_bf16 v[192:195], v[204:207], v[152:155], v[216:219]
    v_mfma_f32_16x16x32_bf16 v[196:199], v[204:207], v[168:171], v[220:223]
    s_waitcnt vmcnt(1)
    v_mfma_f32_16x16x32_bf16 v[184:187], v[208:211], v[156:159], v[184:187]
    v_mfma_f32_16x16x32_bf16 v[188:191], v[208:211], v[172:175], v[188:191]
    s_waitcnt vmcnt(0)
    v_mfma_f32_16x16x32_bf16 v[192:195], v[212:215], v[156:159], v[192:195]
    v_mfma_f32_16x16x32_bf16 v[196:199], v[212:215], v[172:175], v[196:199]
    s_mov_b32 s17, 0x1d000
    buffer_load_dwordx4 v[200:203], v8, s[8:11], s17 offen offset:0
    buffer_load_dwordx4 v[204:207], v8, s[8:11], s17 offen offset:1024
    buffer_load_dwordx4 v[208:211], v8, s[8:11], s17 offen offset:2048
    buffer_load_dwordx4 v[212:215], v8, s[8:11], s17 offen offset:3072
    s_waitcnt vmcnt(3)
    v_mfma_f32_16x16x32_bf16 v[184:187], v[200:203], v[160:163], v[184:187]
    v_mfma_f32_16x16x32_bf16 v[188:191], v[200:203], v[176:179], v[188:191]
    s_waitcnt vmcnt(2)
    v_mfma_f32_16x16x32_bf16 v[192:195], v[204:207], v[160:163], v[192:195]
    v_mfma_f32_16x16x32_bf16 v[196:199], v[204:207], v[176:179], v[196:199]
    s_waitcnt vmcnt(1)
    v_mfma_f32_16x16x32_bf16 v[184:187], v[208:211], v[164:167], v[184:187]
    v_mfma_f32_16x16x32_bf16 v[188:191], v[208:211], v[180:183], v[188:191]
    s_waitcnt vmcnt(0)
    v_mfma_f32_16x16x32_bf16 v[192:195], v[212:215], v[164:167], v[192:195]
    v_mfma_f32_16x16x32_bf16 v[196:199], v[212:215], v[180:183], v[196:199]
    s_nop 3
    v_exp_f32 v184, v184
    v_exp_f32 v185, v185
    v_add_f32 v9, v9, v184
    v_add_f32 v9, v9, v185
    v_cvt_pk_bf16_f32 v136, v184, v185
    v_exp_f32 v186, v186
    v_exp_f32 v187, v187
    v_add_f32 v9, v9, v186
    v_add_f32 v9, v9, v187
    v_cvt_pk_bf16_f32 v137, v186, v187
    v_exp_f32 v188, v188
    v_exp_f32 v189, v189
    v_add_f32 v10, v10, v188
    v_add_f32 v10, v10, v189
    v_cvt_pk_bf16_f32 v140, v188, v189
    v_exp_f32 v190, v190
    v_exp_f32 v191, v191
    v_add_f32 v10, v10, v190
    v_add_f32 v10, v10, v191
    v_cvt_pk_bf16_f32 v141, v190, v191
    v_exp_f32 v192, v192
    v_exp_f32 v193, v193
    v_add_f32 v9, v9, v192
    v_add_f32 v9, v9, v193
    v_cvt_pk_bf16_f32 v138, v192, v193
    v_exp_f32 v194, v194
    v_exp_f32 v195, v195
    v_add_f32 v9, v9, v194
    v_add_f32 v9, v9, v195
    v_cvt_pk_bf16_f32 v139, v194, v195
    v_exp_f32 v196, v196
    v_exp_f32 v197, v197
    v_add_f32 v10, v10, v196
    v_add_f32 v10, v10, v197
    v_cvt_pk_bf16_f32 v142, v196, v197
    v_exp_f32 v198, v198
    v_exp_f32 v199, v199
    v_add_f32 v10, v10, v198
    v_add_f32 v10, v10, v199
    v_cvt_pk_bf16_f32 v143, v198, v199
    s_mov_b32 s17, 0x1e000
    buffer_load_dwordx4 v[200:203], v8, s[8:11], s17 offen offset:0
    buffer_load_dwordx4 v[204:207], v8, s[8:11], s17 offen offset:1024
    buffer_load_dwordx4 v[208:211], v8, s[8:11], s17 offen offset:2048
    buffer_load_dwordx4 v[212:215], v8, s[8:11], s17 offen offset:3072
    s_waitcnt vmcnt(3)
    v_mfma_f32_16x16x32_bf16 v[184:187], v[200:203], v[152:155], v[216:219]
    v_mfma_f32_16x16x32_bf16 v[188:191], v[200:203], v[168:171], v[220:223]
    s_waitcnt vmcnt(2)
    v_mfma_f32_16x16x32_bf16 v[192:195], v[204:207], v[152:155], v[216:219]
    v_mfma_f32_16x16x32_bf16 v[196:199], v[204:207], v[168:171], v[220:223]
    s_waitcnt vmcnt(1)
    v_mfma_f32_16x16x32_bf16 v[184:187], v[208:211], v[156:159], v[184:187]
    v_mfma_f32_16x16x32_bf16 v[188:191], v[208:211], v[172:175], v[188:191]
    s_waitcnt vmcnt(0)
    v_mfma_f32_16x16x32_bf16 v[192:195], v[212:215], v[156:159], v[192:195]
    v_mfma_f32_16x16x32_bf16 v[196:199], v[212:215], v[172:175], v[196:199]
    s_mov_b32 s17, 0x1f000
    buffer_load_dwordx4 v[200:203], v8, s[8:11], s17 offen offset:0
    buffer_load_dwordx4 v[204:207], v8, s[8:11], s17 offen offset:1024
    buffer_load_dwordx4 v[208:211], v8, s[8:11], s17 offen offset:2048
    buffer_load_dwordx4 v[212:215], v8, s[8:11], s17 offen offset:3072
    s_waitcnt vmcnt(3)
    v_mfma_f32_16x16x32_bf16 v[184:187], v[200:203], v[160:163], v[184:187]
    v_mfma_f32_16x16x32_bf16 v[188:191], v[200:203], v[176:179], v[188:191]
    s_waitcnt vmcnt(2)
    v_mfma_f32_16x16x32_bf16 v[192:195], v[204:207], v[160:163], v[192:195]
    v_mfma_f32_16x16x32_bf16 v[196:199], v[204:207], v[176:179], v[196:199]
    s_waitcnt vmcnt(1)
    v_mfma_f32_16x16x32_bf16 v[184:187], v[208:211], v[164:167], v[184:187]
    v_mfma_f32_16x16x32_bf16 v[188:191], v[208:211], v[180:183], v[188:191]
    s_waitcnt vmcnt(0)
    v_mfma_f32_16x16x32_bf16 v[192:195], v[212:215], v[164:167], v[192:195]
    v_mfma_f32_16x16x32_bf16 v[196:199], v[212:215], v[180:183], v[196:199]
    s_nop 3
    v_exp_f32 v184, v184
    v_exp_f32 v185, v185
    v_add_f32 v9, v9, v184
    v_add_f32 v9, v9, v185
    v_cvt_pk_bf16_f32 v144, v184, v185
    v_exp_f32 v186, v186
    v_exp_f32 v187, v187
    v_add_f32 v9, v9, v186
    v_add_f32 v9, v9, v187
    v_cvt_pk_bf16_f32 v145, v186, v187
    v_exp_f32 v188, v188
    v_exp_f32 v189, v189
    v_add_f32 v10, v10, v188
    v_add_f32 v10, v10, v189
    v_cvt_pk_bf16_f32 v148, v188, v189
    v_exp_f32 v190, v190
    v_exp_f32 v191, v191
    v_add_f32 v10, v10, v190
    v_add_f32 v10, v10, v191
    v_cvt_pk_bf16_f32 v149, v190, v191
    v_exp_f32 v192, v192
    v_exp_f32 v193, v193
    v_add_f32 v9, v9, v192
    v_add_f32 v9, v9, v193
    v_cvt_pk_bf16_f32 v146, v192, v193
    v_exp_f32 v194, v194
    v_exp_f32 v195, v195
    v_add_f32 v9, v9, v194
    v_add_f32 v9, v9, v195
    v_cvt_pk_bf16_f32 v147, v194, v195
    v_exp_f32 v196, v196
    v_exp_f32 v197, v197
    v_add_f32 v10, v10, v196
    v_add_f32 v10, v10, v197
    v_cvt_pk_bf16_f32 v150, v196, v197
    v_exp_f32 v198, v198
    v_exp_f32 v199, v199
    v_add_f32 v10, v10, v198
    v_add_f32 v10, v10, v199
    v_cvt_pk_bf16_f32 v151, v198, v199
    v_mov_b32 v16, v9
    v_mov_b32 v18, v10
    s_nop 0
    v_permlane16_swap_b32 v9, v16
    v_permlane16_swap_b32 v10, v18
    v_add_f32 v9, v9, v16
    v_add_f32 v10, v10, v18
    v_mov_b32 v16, v9
    v_mov_b32 v18, v10
    s_nop 0
    v_permlane32_swap_b32 v9, v16
    v_permlane32_swap_b32 v10, v18
    v_add_f32 v9, v9, v16
    v_add_f32 v10, v10, v18
    s_waitcnt vmcnt(0) lgkmcnt(0)
    s_nop 15
    s_nop 3
    s_branch adaLN_cond__sliding_block_cached__moe_arch_mod__prompt_kernel_fixBb
adaLN_cond__sliding_block_cached__moe_arch_mod__prompt_kernel_o17r:
    s_waitcnt vmcnt(0) lgkmcnt(0)
    s_nop 15
    s_nop 3
    s_mov_b32 s27, 0
adaLN_cond__sliding_block_cached__moe_arch_mod__prompt_kernel_o17p:
    buffer_load_dword v12, v13, s[8:11], s19 offen sc1
    s_waitcnt vmcnt(0)
    v_cmp_ne_u32 vcc, s28, v12
    s_add_u32 s27, s27, 1
    s_cmp_ge_u32 s27, 262144
    s_cbranch_scc1 adaLN_cond__sliding_block_cached__moe_arch_mod__prompt_kernel_o17g
    s_cbranch_vccnz adaLN_cond__sliding_block_cached__moe_arch_mod__prompt_kernel_o17p
adaLN_cond__sliding_block_cached__moe_arch_mod__prompt_kernel_o17g:
    s_waitcnt vmcnt(0) lgkmcnt(0)
    s_nop 15
    s_nop 3
    s_branch adaLN_cond__sliding_block_cached__moe_arch_mod__prompt_kernel_o17b
adaLN_cond__sliding_block_cached__moe_arch_mod__prompt_kernel_o218r:
    s_waitcnt vmcnt(0) lgkmcnt(0)
    s_nop 15
    s_nop 3
    s_mov_b32 s27, 0
adaLN_cond__sliding_block_cached__moe_arch_mod__prompt_kernel_o218p:
    buffer_load_dword v12, v13, s[8:11], s19 offen sc1
    s_waitcnt vmcnt(0)
    v_cmp_ne_u32 vcc, s28, v12
    s_add_u32 s27, s27, 1
    s_cmp_ge_u32 s27, 262144
    s_cbranch_scc1 adaLN_cond__sliding_block_cached__moe_arch_mod__prompt_kernel_o218g
    s_cbranch_vccnz adaLN_cond__sliding_block_cached__moe_arch_mod__prompt_kernel_o218p
adaLN_cond__sliding_block_cached__moe_arch_mod__prompt_kernel_o218g:
    s_waitcnt vmcnt(0) lgkmcnt(0)
    s_nop 15
    s_nop 3
    s_branch adaLN_cond__sliding_block_cached__moe_arch_mod__prompt_kernel_o218b
adaLN_cond__sliding_block_cached__moe_arch_mod__prompt_kernel_o219r:
    s_waitcnt vmcnt(0) lgkmcnt(0)
    s_nop 15
    s_nop 3
    s_mov_b32 s27, 0
adaLN_cond__sliding_block_cached__moe_arch_mod__prompt_kernel_o219p:
    buffer_load_dword v12, v13, s[8:11], s19 offen sc1
    s_waitcnt vmcnt(0)
    v_cmp_ne_u32 vcc, s28, v12
    s_add_u32 s27, s27, 1
    s_cmp_ge_u32 s27, 262144
    s_cbranch_scc1 adaLN_cond__sliding_block_cached__moe_arch_mod__prompt_kernel_o219g
    s_cbranch_vccnz adaLN_cond__sliding_block_cached__moe_arch_mod__prompt_kernel_o219p
adaLN_cond__sliding_block_cached__moe_arch_mod__prompt_kernel_o219g:
    s_waitcnt vmcnt(0) lgkmcnt(0)
    s_nop 15
    s_nop 3
    s_branch adaLN_cond__sliding_block_cached__moe_arch_mod__prompt_kernel_o219b
adaLN_cond__sliding_block_cached__moe_arch_mod__prompt_kernel_o220r:
    s_waitcnt vmcnt(0) lgkmcnt(0)
    s_nop 15
    s_nop 3
    s_mov_b32 s27, 0
adaLN_cond__sliding_block_cached__moe_arch_mod__prompt_kernel_o220p:
    buffer_load_dword v12, v13, s[8:11], s19 offen sc1
    s_waitcnt vmcnt(0)
    v_cmp_ne_u32 vcc, s28, v12
    s_add_u32 s27, s27, 1
    s_cmp_ge_u32 s27, 262144
    s_cbranch_scc1 adaLN_cond__sliding_block_cached__moe_arch_mod__prompt_kernel_o220g
    s_cbranch_vccnz adaLN_cond__sliding_block_cached__moe_arch_mod__prompt_kernel_o220p
adaLN_cond__sliding_block_cached__moe_arch_mod__prompt_kernel_o220g:
    s_waitcnt vmcnt(0) lgkmcnt(0)
    s_nop 15
    s_nop 3
    s_branch adaLN_cond__sliding_block_cached__moe_arch_mod__prompt_kernel_o220b
adaLN_cond__sliding_block_cached__moe_arch_mod__prompt_kernel_mf21r:
    s_waitcnt vmcnt(0) lgkmcnt(0)
    s_nop 15
    s_nop 3
    s_mov_b32 s27, 0
adaLN_cond__sliding_block_cached__moe_arch_mod__prompt_kernel_mf21p:
    s_mov_b32 s16, 0x544000
    buffer_load_dwordx4 v[184:187], v2, s[8:11], s16 offen sc1
    s_waitcnt vmcnt(0)
    v_xor_b32 v16, s28, v184
    v_xor_b32 v17, s28, v185
    v_xor_b32 v18, s28, v186
    v_xor_b32 v19, s28, v187
    v_or3_b32 v16, v16, v17, v18
    v_or_b32 v16, v16, v19
    v_cmp_ne_u32 vcc, 0, v16
    s_add_u32 s27, s27, 1
    s_cmp_ge_u32 s27, 262144
    s_cbranch_scc1 adaLN_cond__sliding_block_cached__moe_arch_mod__prompt_kernel_mf21g
    s_cbranch_vccnz adaLN_cond__sliding_block_cached__moe_arch_mod__prompt_kernel_mf21p
adaLN_cond__sliding_block_cached__moe_arch_mod__prompt_kernel_mf21g:
    s_waitcnt vmcnt(0) lgkmcnt(0)
    s_nop 15
    s_nop 3
    s_branch adaLN_cond__sliding_block_cached__moe_arch_mod__prompt_kernel_mf21b
.section .rodata,"a"
.p2align 6
.amdhsa_kernel adaLN_cond__sliding_block_cached__moe_arch_mod__prompt_kernel
  .amdhsa_next_free_vgpr 256
  .amdhsa_next_free_sgpr 80
  .amdhsa_accum_offset 256
  .amdhsa_group_segment_fixed_size 0
  .amdhsa_kernarg_size 120
  .amdhsa_user_sgpr_count 2
  .amdhsa_user_sgpr_kernarg_segment_ptr 1
  .amdhsa_system_sgpr_workgroup_id_x 1
  .amdhsa_float_denorm_mode_32 3
.end_amdhsa_kernel
```

```asm
; @launch grid=(256,1,1) block=(512,1,1) lds=163840
.amdgcn_target "amdgcn-amd-amdhsa--gfx950"
.text
.globl adaLN_cond__sliding_block_cached__moe_arch_mod__prompt_kernel
.p2align 8
.type adaLN_cond__sliding_block_cached__moe_arch_mod__prompt_kernel,@function
adaLN_cond__sliding_block_cached__moe_arch_mod__prompt_kernel:
    s_cmp_ge_u32 s2, 256
    s_cbranch_scc1 adaLN_cond__sliding_block_cached__moe_arch_mod__prompt_kernel_end
    s_load_dwordx4 s[56:59], s[0:1], 96
    s_load_dwordx2 s[60:61], s[0:1], 112
    s_load_dwordx8 s[48:55], s[0:1], 64
    s_load_dwordx16 s[32:47], s[0:1], 0
    s_memrealtime s[62:63]
    v_lshrrev_b32 v16, 6, v0
    v_and_b32 v1, 63, v0
    v_readfirstlane_b32 s3, v16
    v_lshlrev_b32 v2, 4, v1
    s_and_b32 s12, s2, 3
    s_lshl_b32 s12, s12, 3
    s_bfe_u32 s13, s2, 0x30003
    s_add_u32 s12, s12, s13
    s_bfe_u32 s13, s2, 0x10002
    s_lshl_b32 s13, s13, 2
    s_lshr_b32 s14, s2, 6
    s_add_u32 s13, s13, s14
    v_bfe_u32 v16, v1, 2, 2
    v_lshrrev_b32 v17, 4, v1
    v_and_b32 v18, 3, v1
    v_lshlrev_b32 v19, 6, v17
    v_lshl_add_u32 v19, v18, 4, v19
    v_lshl_add_u32 v3, v16, 13, v19
    s_and_b32 s14, s3, 1
    s_lshl_b32 s14, s14, 5
    v_xor_b32 v3, s14, v3
    v_lshlrev_b32 v4, 11, v17
    v_lshl_add_u32 v4, v16, 6, v4
    v_lshl_add_u32 v4, v18, 3, v4
    v_and_b32 v20, 1, v17
    v_lshlrev_b32 v20, 5, v20
    v_sub_u32 v5, v4, v20
    v_add_u32 v4, v4, v20
    s_lshl_b32 s14, s13, 3
    s_add_u32 s14, s14, s3
    s_lshl_b32 s14, s14, 16
    v_add_u32 v7, s14, v2
    s_cmp_ge_u32 s3, 4
    s_cbranch_scc1 adaLN_cond__sliding_block_cached__moe_arch_mod__prompt_kernel_roleB
    v_mov_b32 v132, 0
    v_mov_b32 v133, 0
    v_lshrrev_b32 v16, 3, v0
    v_and_b32 v17, 7, v0
    v_mul_u32_u24 v135, 24576, v16
    v_lshl_add_u32 v135, v17, 4, v135
    v_lshlrev_b32 v136, 2, v16
    s_and_b32 s14, s2, 31
    s_lshr_b32 s15, s2, 5
    s_mul_i32 s26, s15, 1572864
    s_lshl_b32 s16, s14, 7
    s_add_u32 s26, s26, s16
    s_lshl_b32 s29, s15, 8
    v_lshlrev_b32 v137, 3, v0
    s_lshl_b32 s18, s2, 3
    s_add_u32 s18, s18, s3
    s_lshl_b32 s18, s18, 11
    v_and_b32 v18, 15, v1
    v_lshrrev_b32 v19, 4, v1
    v_lshlrev_b32 v138, 11, v18
    v_lshl_add_u32 v138, v19, 4, v138
    s_lshr_b32 s30, s2, 4
    s_and_b32 s31, s2, 15
    s_lshl_b32 s19, s30, 3
    s_add_u32 s19, s19, s3
    s_lshl_b32 s22, s19, 15
    s_lshl_b32 s23, s31, 7
    s_add_u32 s22, s22, s23
    s_lshl_b32 s23, s2, 12
    s_add_u32 s23, s23, 0x600000
    s_or_b32 s25, s2, s3
    s_cmp_eq_u32 s25, 0
    s_cselect_b32 s25, 0, 0x7ffffff0
    s_waitcnt lgkmcnt(0)
    s_mov_b64 s[64:65], s[58:59]
    s_mov_b32 s66, 0x100
    s_mov_b32 s67, 0x20000
    s_or_b32 s28, s62, 1
    v_mov_b32 v134, s28
    s_mov_b64 exec, 1
    buffer_store_dword v134, v132, s[64:67], s25 offen sc1
    s_mov_b64 exec, -1
    s_mov_b64 s[68:69], s[52:53]
    s_mov_b32 s70, 0x800
    s_mov_b32 s71, 0x20000
    s_mov_b64 s[72:73], s[54:55]
    s_mov_b32 s74, 0xc00000
    s_mov_b32 s75, 0x20000
    s_mov_b64 s[76:77], s[32:33]
    s_mov_b32 s78, 0x400000
    s_mov_b32 s79, 0x20000
    s_mov_b64 s[8:9], s[60:61]
    s_mov_b32 s10, 0x3400000
    s_mov_b32 s11, 0x20000
    buffer_load_dword v72, v136, s[68:71], s29 offen
    buffer_load_dwordx4 v[24:27], v135, s[72:75], s26 offen
    s_add_u32 s26, s26, 12288
    buffer_load_dwordx4 v[28:31], v135, s[72:75], s26 offen
    buffer_load_dwordx4 v[32:35], v2, s[76:79], s18 offen offset:0
    buffer_load_dwordx4 v[36:39], v2, s[76:79], s18 offen offset:1024
    s_cmp_eq_u32 s3, 0
    s_cselect_b32 s25, 0, 0x7ffffff0
    buffer_load_dword v134, v132, s[64:67], s25 offen sc1
    buffer_store_dwordx2 v[132:133], v137, s[8:11], s23 offen sc1
    s_barrier
    buffer_load_dwordx4 v[40:43], v138, s[76:79], s22 offen offset:0
    buffer_load_dwordx4 v[44:47], v138, s[76:79], s22 offen offset:64
    s_mov_b32 s29, s19
    s_waitcnt vmcnt(8)
    v_and_b32 v73, 0xffff0000, v72
    v_lshlrev_b32 v72, 16, v72
    v_mul_f32 v16, 0xbfb8aa3b, v72
    v_exp_f32 v16, v16
    s_nop 0
    v_add_f32 v16, 1.0, v16
    v_rcp_f32 v16, v16
    s_nop 0
    v_mul_f32 v72, v72, v16
    v_mul_f32 v17, 0xbfb8aa3b, v73
    v_exp_f32 v17, v17
    s_nop 0
    v_add_f32 v17, 1.0, v17
    v_rcp_f32 v17, v17
    s_nop 0
    v_mul_f32 v73, v73, v17
    v_cvt_pk_bf16_f32 v16, v72, v73
    v_lshlrev_b32 v72, 16, v16
    v_and_b32 v73, 0xffff0000, v16
    s_lshl_b32 s16, s2, 8
    s_add_u32 s16, s16, 0x550000
    s_mov_b32 exec_lo, 0x01010101
    s_mov_b32 exec_hi, 0x01010101
    buffer_store_dword v16, v136, s[8:11], s16 offen sc1
    s_mov_b64 exec, -1
    v_lshrrev_b32 v74, 16, v72
    v_lshrrev_b32 v75, 16, v73
    s_waitcnt vmcnt(8)
    v_dot2_f32_bf16 v49, v24, v72, 0
    v_dot2_f32_bf16 v48, v24, v74, 0
    v_dot2_f32_bf16 v51, v25, v72, 0
    v_dot2_f32_bf16 v50, v25, v74, 0
    v_dot2_f32_bf16 v53, v26, v72, 0
    v_dot2_f32_bf16 v52, v26, v74, 0
    v_dot2_f32_bf16 v55, v27, v72, 0
    v_dot2_f32_bf16 v54, v27, v74, 0
    s_waitcnt vmcnt(7)
    v_dot2c_f32_bf16 v49, v28, v73
    v_dot2c_f32_bf16 v48, v28, v75
    v_dot2c_f32_bf16 v51, v29, v73
    v_dot2c_f32_bf16 v50, v29, v75
    v_dot2c_f32_bf16 v53, v30, v73
    v_dot2c_f32_bf16 v52, v30, v75
    v_dot2c_f32_bf16 v55, v31, v73
    v_dot2c_f32_bf16 v54, v31, v75
    s_nop 0
    v_permlane32_swap_b32 v48, v52
    v_permlane32_swap_b32 v49, v53
    v_permlane32_swap_b32 v50, v54
    v_permlane32_swap_b32 v51, v55
    v_add_f32 v48, v48, v52
    v_add_f32 v49, v49, v53
    v_add_f32 v50, v50, v54
    v_add_f32 v51, v51, v55
    s_nop 0
    v_permlane16_swap_b32 v48, v50
    v_permlane16_swap_b32 v49, v51
    v_add_f32 v48, v48, v50
    v_add_f32 v49, v49, v51
    s_nop 0
    v_add_f32_dpp v48, v48, v48 row_ror:8 row_mask:0xf bank_mask:0xf
    v_add_f32_dpp v49, v49, v49 row_ror:8 row_mask:0xf bank_mask:0xf
    v_and_b32 v16, 7, v1
    v_lshlrev_b32 v16, 5, v16
    v_lshrrev_b32 v17, 4, v1
    v_lshl_add_u32 v16, v17, 3, v16
    s_lshl_b32 s16, s3, 8
    s_add_u32 s16, s16, 65536
    v_add_u32 v16, s16, v16
    ds_write_b64 v16, v[48:49]
    s_waitcnt vmcnt(6)
    v_lshlrev_b32 v56, 16, v32
    v_and_b32 v57, 0xffff0000, v32
    v_lshlrev_b32 v58, 16, v33
    v_and_b32 v59, 0xffff0000, v33
    v_lshlrev_b32 v60, 16, v34
    v_and_b32 v61, 0xffff0000, v34
    v_lshlrev_b32 v62, 16, v35
    v_and_b32 v63, 0xffff0000, v35
    s_waitcnt vmcnt(5)
    v_lshlrev_b32 v64, 16, v36
    v_and_b32 v65, 0xffff0000, v36
    v_lshlrev_b32 v66, 16, v37
    v_and_b32 v67, 0xffff0000, v37
    v_lshlrev_b32 v68, 16, v38
    v_and_b32 v69, 0xffff0000, v38
    v_lshlrev_b32 v70, 16, v39
    v_and_b32 v71, 0xffff0000, v39
    v_add_f32 v20, v56, v57
    v_add_f32 v21, v58, v59
    v_add_f32 v20, v20, v60
    v_add_f32 v21, v21, v61
    v_add_f32 v20, v20, v62
    v_add_f32 v21, v21, v63
    v_add_f32 v20, v20, v64
    v_add_f32 v21, v21, v65
    v_add_f32 v20, v20, v66
    v_add_f32 v21, v21, v67
    v_add_f32 v20, v20, v68
    v_add_f32 v21, v21, v69
    v_add_f32 v20, v20, v70
    v_add_f32 v21, v21, v71
    v_add_f32 v128, v20, v21
    s_nop 1
    v_add_f32_dpp v128, v128, v128 row_ror:1 row_mask:0xf bank_mask:0xf
    s_nop 1
    v_add_f32_dpp v128, v128, v128 row_ror:2 row_mask:0xf bank_mask:0xf
    s_nop 1
    v_add_f32_dpp v128, v128, v128 row_ror:4 row_mask:0xf bank_mask:0xf
    s_nop 1
    v_add_f32_dpp v128, v128, v128 row_ror:8 row_mask:0xf bank_mask:0xf
    v_mov_b32 v20, v128
    s_nop 1
    v_permlane16_swap_b32 v128, v20
    v_add_f32 v128, v128, v20
    v_mov_b32 v20, v128
    s_nop 1
    v_permlane32_swap_b32 v128, v20
    v_add_f32 v128, v128, v20
    v_mul_f32 v128, 0x3a800000, v128
    v_sub_f32 v18, v56, v128
    v_mul_f32 v20, v18, v18
    v_sub_f32 v19, v57, v128
    v_mul_f32 v21, v19, v19
    v_sub_f32 v18, v58, v128
    v_sub_f32 v19, v59, v128
    v_fmac_f32 v20, v18, v18
    v_fmac_f32 v21, v19, v19
    v_sub_f32 v18, v60, v128
    v_sub_f32 v19, v61, v128
    v_fmac_f32 v20, v18, v18
    v_fmac_f32 v21, v19, v19
    v_sub_f32 v18, v62, v128
    v_sub_f32 v19, v63, v128
    v_fmac_f32 v20, v18, v18
    v_fmac_f32 v21, v19, v19
    v_sub_f32 v18, v64, v128
    v_sub_f32 v19, v65, v128
    v_fmac_f32 v20, v18, v18
    v_fmac_f32 v21, v19, v19
    v_sub_f32 v18, v66, v128
    v_sub_f32 v19, v67, v128
    v_fmac_f32 v20, v18, v18
    v_fmac_f32 v21, v19, v19
    v_sub_f32 v18, v68, v128
    v_sub_f32 v19, v69, v128
    v_fmac_f32 v20, v18, v18
    v_fmac_f32 v21, v19, v19
    v_sub_f32 v18, v70, v128
    v_sub_f32 v19, v71, v128
    v_fmac_f32 v20, v18, v18
    v_fmac_f32 v21, v19, v19
    v_add_f32 v17, v20, v21
    s_nop 1
    v_add_f32_dpp v17, v17, v17 row_ror:1 row_mask:0xf bank_mask:0xf
    s_nop 1
    v_add_f32_dpp v17, v17, v17 row_ror:2 row_mask:0xf bank_mask:0xf
    s_nop 1
    v_add_f32_dpp v17, v17, v17 row_ror:4 row_mask:0xf bank_mask:0xf
    s_nop 1
    v_add_f32_dpp v17, v17, v17 row_ror:8 row_mask:0xf bank_mask:0xf
    v_mov_b32 v20, v17
    s_nop 1
    v_permlane16_swap_b32 v17, v20
    v_add_f32 v17, v17, v20
    v_mov_b32 v20, v17
    s_nop 1
    v_permlane32_swap_b32 v17, v20
    v_add_f32 v17, v17, v20
    v_mul_f32 v17, 0x3a800000, v17
    v_cvt_pk_bf16_f32 v128, v128, v128
    v_lshlrev_b32 v128, 16, v128
    v_cvt_pk_bf16_f32 v17, v17, v17
    v_lshlrev_b32 v17, 16, v17
    v_add_f32 v17, 0x3727c5ac, v17
    v_cvt_pk_bf16_f32 v17, v17, v17
    v_lshlrev_b32 v17, 16, v17
    v_sqrt_f32 v129, v17
    s_nop 0
    v_cvt_pk_bf16_f32 v129, v129, v129
    v_lshlrev_b32 v129, 16, v129
    v_rcp_f32 v130, v129
    s_lshl_b32 s16, s3, 4
    s_add_u32 s16, s16, 67600
    v_mov_b32 v19, s16
    ds_write_b128 v19, v[128:131]
    s_waitcnt vmcnt(4)
    v_cmp_eq_u32 vcc, 0, v134
    s_cmp_eq_u32 s3, 0
    s_cselect_b64 s[62:63], -1, 0
    s_and_b64 vcc, vcc, s[62:63]
    s_cbranch_vccnz adaLN_cond__sliding_block_cached__moe_arch_mod__prompt_kernel_n1r
adaLN_cond__sliding_block_cached__moe_arch_mod__prompt_kernel_n1b:
    v_mov_b32 v19, 67584
    s_cmp_eq_u32 s3, 0
    s_cselect_b64 exec, 1, 0
    ds_write_b32 v19, v134
    s_mov_b64 exec, -1
    v_mov_b32 v19, 67584
    v_and_b32 v17, 31, v1
    v_lshlrev_b32 v18, 3, v17
    v_add_u32 v18, 65536, v18
    v_lshlrev_b32 v17, 4, v17
    s_waitcnt lgkmcnt(0)
    s_barrier
    ds_read_b32 v134, v19
    ds_read_b64 v[96:97], v18 offset:0
    ds_read_b64 v[100:101], v18 offset:256
    ds_read_b64 v[104:105], v18 offset:512
    ds_read_b64 v[108:109], v18 offset:768
    ds_read_b64 v[112:113], v18 offset:1024
    ds_read_b64 v[116:117], v18 offset:1280
    ds_read_b64 v[120:121], v18 offset:1536
    ds_read_b64 v[124:125], v18 offset:1792
    s_waitcnt lgkmcnt(8)
    v_readfirstlane_b32 s28, v134
    v_and_b32 v20, 7, v1
    v_lshlrev_b32 v20, 4, v20
    v_add_u32 v21, 67600, v20
    ds_read_b128 v[128:131], v21
    s_waitcnt lgkmcnt(0)
    v_mov_b32 v131, s28
    s_lshl_b32 s16, s2, 7
    s_add_u32 s16, s16, 0x520000
    s_cmp_eq_u32 s3, 0
    s_cselect_b32 s16, s16, 0x7ffffff0
    s_mov_b64 exec, 0xff
    buffer_store_dwordx4 v[128:131], v20, s[8:11], s16 offen sc1
    s_mov_b64 exec, -1
    v_pk_add_f32 v[96:97], v[96:97], v[112:113]
    v_pk_add_f32 v[100:101], v[100:101], v[116:117]
    v_pk_add_f32 v[104:105], v[104:105], v[120:121]
    v_pk_add_f32 v[108:109], v[108:109], v[124:125]
    v_pk_add_f32 v[96:97], v[96:97], v[104:105]
    v_pk_add_f32 v[100:101], v[100:101], v[108:109]
    v_pk_add_f32 v[96:97], v[96:97], v[100:101]
    v_mov_b32 v98, s28
    v_mov_b32 v99, s28
    s_lshl_b32 s16, s14, 3
    s_add_u32 s16, s16, s15
    s_lshl_b32 s16, s16, 9
    s_add_u32 s16, s16, 0x500000
    s_cmp_eq_u32 s3, 0
    s_cselect_b32 s16, s16, 0x7ffffff0
    s_mov_b64 exec, 0xffffffff
    buffer_store_dwordx4 v[96:99], v17, s[8:11], s16 offen sc1
    s_mov_b64 exec, -1
    s_lshr_b32 s16, s3, 2
    s_lshl_b32 s16, s16, 4
    s_add_u32 s16, s16, s31
    s_lshl_b32 s16, s16, 12
    s_and_b32 s17, s3, 3
    s_lshl_b32 s17, s17, 7
    s_add_u32 s16, s16, s17
    s_add_u32 s16, s16, 0x500000
    v_lshrrev_b32 v139, 3, v1
    v_lshlrev_b32 v139, 9, v139
    v_and_b32 v16, 7, v1
    v_lshl_add_u32 v139, v16, 4, v139
    v_and_b32 v140, 15, v1
    v_lshlrev_b32 v140, 4, v140
    s_lshl_b32 s17, s29, 8
    s_add_u32 s17, s17, 0x520000
    s_waitcnt vmcnt(4)
    v_lshlrev_b32 v56, 16, v40
    v_and_b32 v57, 0xffff0000, v40
    v_lshlrev_b32 v58, 16, v41
    v_and_b32 v59, 0xffff0000, v41
    v_lshlrev_b32 v60, 16, v42
    v_and_b32 v61, 0xffff0000, v42
    v_lshlrev_b32 v62, 16, v43
    v_and_b32 v63, 0xffff0000, v43
    s_waitcnt vmcnt(3)
    v_lshlrev_b32 v64, 16, v44
    v_and_b32 v65, 0xffff0000, v44
    v_lshlrev_b32 v66, 16, v45
    v_and_b32 v67, 0xffff0000, v45
    v_lshlrev_b32 v68, 16, v46
    v_and_b32 v69, 0xffff0000, v46
    v_lshlrev_b32 v70, 16, v47
    v_and_b32 v71, 0xffff0000, v47
    s_mov_b32 s27, 0
adaLN_cond__sliding_block_cached__moe_arch_mod__prompt_kernel_g2p:
    buffer_load_dwordx4 v[76:79], v139, s[8:11], s16 offen sc1
    buffer_load_dwordx4 v[80:83], v140, s[8:11], s17 offen sc1
    s_waitcnt vmcnt(1)
    v_cmp_ne_u32 vcc, s28, v78
    v_cmp_ne_u32 s[62:63], s28, v79
    s_or_b64 vcc, vcc, s[62:63]
    s_waitcnt vmcnt(0)
    v_cmp_ne_u32 s[62:63], s28, v83
    s_or_b64 vcc, vcc, s[62:63]
    s_add_u32 s27, s27, 1
    s_cmp_ge_u32 s27, 262144
    s_cbranch_scc1 adaLN_cond__sliding_block_cached__moe_arch_mod__prompt_kernel_g2g
    s_cbranch_vccnz adaLN_cond__sliding_block_cached__moe_arch_mod__prompt_kernel_g2p
adaLN_cond__sliding_block_cached__moe_arch_mod__prompt_kernel_g2g:
    v_add_f32_dpp v76, v76, v76 row_ror:8 row_mask:0xf bank_mask:0xf
    v_add_f32_dpp v77, v77, v77 row_ror:8 row_mask:0xf bank_mask:0xf
    v_mov_b32 v17, v76
    s_nop 1
    v_permlane16_swap_b32 v76, v17
    v_add_f32 v76, v76, v17
    v_mov_b32 v18, v77
    s_nop 1
    v_permlane16_swap_b32 v77, v18
    v_add_f32 v77, v77, v18
    v_mov_b32 v17, v76
    s_nop 1
    v_permlane32_swap_b32 v76, v17
    v_add_f32 v76, v76, v17
    v_mov_b32 v18, v77
    s_nop 1
    v_permlane32_swap_b32 v77, v18
    v_add_f32 v77, v77, v18
    v_cvt_pk_bf16_f32 v17, v76, v77
    v_lshlrev_b32 v76, 16, v17
    v_and_b32 v77, 0xffff0000, v17
    v_add_f32 v76, 0, v76
    v_add_f32 v77, 0, v77
    s_lshl_b32 s16, s3, 6
    s_add_u32 s16, s16, 69632
    v_lshl_add_u32 v16, v16, 3, s16
    ds_write_b64 v16, v[76:77]
    v_lshrrev_b32 v17, 4, v1
    v_lshlrev_b32 v17, 5, v17
    v_add_u32 v17, 69632, v17
    v_sub_f32 v56, v56, v80
    v_sub_f32 v57, v57, v80
    v_sub_f32 v58, v58, v80
    v_sub_f32 v59, v59, v80
    v_sub_f32 v60, v60, v80
    v_sub_f32 v61, v61, v80
    v_sub_f32 v62, v62, v80
    v_sub_f32 v63, v63, v80
    v_sub_f32 v64, v64, v80
    v_sub_f32 v65, v65, v80
    v_sub_f32 v66, v66, v80
    v_sub_f32 v67, v67, v80
    v_sub_f32 v68, v68, v80
    v_sub_f32 v69, v69, v80
    v_sub_f32 v70, v70, v80
    v_sub_f32 v71, v71, v80
    v_cvt_pk_bf16_f32 v18, v56, v57
    v_lshlrev_b32 v56, 16, v18
    v_and_b32 v57, 0xffff0000, v18
    v_cvt_pk_bf16_f32 v19, v58, v59
    v_lshlrev_b32 v58, 16, v19
    v_and_b32 v59, 0xffff0000, v19
    v_cvt_pk_bf16_f32 v18, v60, v61
    v_lshlrev_b32 v60, 16, v18
    v_and_b32 v61, 0xffff0000, v18
    v_cvt_pk_bf16_f32 v19, v62, v63
    v_lshlrev_b32 v62, 16, v19
    v_and_b32 v63, 0xffff0000, v19
    v_cvt_pk_bf16_f32 v18, v64, v65
    v_lshlrev_b32 v64, 16, v18
    v_and_b32 v65, 0xffff0000, v18
    v_cvt_pk_bf16_f32 v19, v66, v67
    v_lshlrev_b32 v66, 16, v19
    v_and_b32 v67, 0xffff0000, v19
    v_cvt_pk_bf16_f32 v18, v68, v69
    v_lshlrev_b32 v68, 16, v18
    v_and_b32 v69, 0xffff0000, v18
    v_cvt_pk_bf16_f32 v19, v70, v71
    v_lshlrev_b32 v70, 16, v19
    v_and_b32 v71, 0xffff0000, v19
    v_mul_f32 v56, v56, v82
    v_mul_f32 v57, v57, v82
    v_mul_f32 v58, v58, v82
    v_mul_f32 v59, v59, v82
    v_mul_f32 v60, v60, v82
    v_mul_f32 v61, v61, v82
    v_mul_f32 v62, v62, v82
    v_mul_f32 v63, v63, v82
    v_mul_f32 v64, v64, v82
    v_mul_f32 v65, v65, v82
    v_mul_f32 v66, v66, v82
    v_mul_f32 v67, v67, v82
    v_mul_f32 v68, v68, v82
    v_mul_f32 v69, v69, v82
    v_mul_f32 v70, v70, v82
    v_mul_f32 v71, v71, v82
    v_cvt_pk_bf16_f32 v18, v56, v57
    v_lshlrev_b32 v56, 16, v18
    v_and_b32 v57, 0xffff0000, v18
    v_cvt_pk_bf16_f32 v19, v58, v59
    v_lshlrev_b32 v58, 16, v19
    v_and_b32 v59, 0xffff0000, v19
    v_cvt_pk_bf16_f32 v18, v60, v61
    v_lshlrev_b32 v60, 16, v18
    v_and_b32 v61, 0xffff0000, v18
    v_cvt_pk_bf16_f32 v19, v62, v63
    v_lshlrev_b32 v62, 16, v19
    v_and_b32 v63, 0xffff0000, v19
    v_cvt_pk_bf16_f32 v18, v64, v65
    v_lshlrev_b32 v64, 16, v18
    v_and_b32 v65, 0xffff0000, v18
    v_cvt_pk_bf16_f32 v19, v66, v67
    v_lshlrev_b32 v66, 16, v19
    v_and_b32 v67, 0xffff0000, v19
    v_cvt_pk_bf16_f32 v18, v68, v69
    v_lshlrev_b32 v68, 16, v18
    v_and_b32 v69, 0xffff0000, v18
    v_cvt_pk_bf16_f32 v19, v70, v71
    v_lshlrev_b32 v70, 16, v19
    v_and_b32 v71, 0xffff0000, v19
    s_lshl_b32 s16, s29, 15
    s_lshl_b32 s17, s31, 11
    s_add_u32 s16, s16, s17
    s_waitcnt lgkmcnt(0)
    s_barrier
    ds_read_b128 v[96:99], v17 offset:256
    ds_read_b128 v[104:107], v17 offset:0
    ds_read_b128 v[100:103], v17 offset:272
    ds_read_b128 v[108:111], v17 offset:16
    ds_read_b128 v[112:115], v17 offset:384
    ds_read_b128 v[120:123], v17 offset:128
    ds_read_b128 v[116:119], v17 offset:400
    ds_read_b128 v[124:127], v17 offset:144
    s_waitcnt lgkmcnt(7)
    v_pk_mul_f32 v[56:57], v[56:57], v[96:97]
    v_pk_mul_f32 v[58:59], v[58:59], v[98:99]
    s_waitcnt lgkmcnt(5)
    v_pk_mul_f32 v[60:61], v[60:61], v[100:101]
    v_pk_mul_f32 v[62:63], v[62:63], v[102:103]
    v_cvt_pk_bf16_f32 v18, v56, v57
    v_lshlrev_b32 v56, 16, v18
    v_and_b32 v57, 0xffff0000, v18
    v_cvt_pk_bf16_f32 v19, v58, v59
    v_lshlrev_b32 v58, 16, v19
    v_and_b32 v59, 0xffff0000, v19
    v_cvt_pk_bf16_f32 v18, v60, v61
    v_lshlrev_b32 v60, 16, v18
    v_and_b32 v61, 0xffff0000, v18
    v_cvt_pk_bf16_f32 v19, v62, v63
    v_lshlrev_b32 v62, 16, v19
    v_and_b32 v63, 0xffff0000, v19
    v_pk_add_f32 v[56:57], v[56:57], v[104:105]
    v_pk_add_f32 v[58:59], v[58:59], v[106:107]
    s_waitcnt lgkmcnt(4)
    v_pk_add_f32 v[60:61], v[60:61], v[108:109]
    v_pk_add_f32 v[62:63], v[62:63], v[110:111]
    v_cvt_pk_bf16_f32 v32, v56, v57
    v_cvt_pk_bf16_f32 v33, v58, v59
    v_cvt_pk_bf16_f32 v34, v60, v61
    v_cvt_pk_bf16_f32 v35, v62, v63
    buffer_store_dwordx4 v[32:35], v2, s[8:11], s16 offen offset:0 sc1
    s_waitcnt lgkmcnt(3)
    v_pk_mul_f32 v[64:65], v[64:65], v[112:113]
    v_pk_mul_f32 v[66:67], v[66:67], v[114:115]
    s_waitcnt lgkmcnt(1)
    v_pk_mul_f32 v[68:69], v[68:69], v[116:117]
    v_pk_mul_f32 v[70:71], v[70:71], v[118:119]
    v_cvt_pk_bf16_f32 v18, v64, v65
    v_lshlrev_b32 v64, 16, v18
    v_and_b32 v65, 0xffff0000, v18
    v_cvt_pk_bf16_f32 v19, v66, v67
    v_lshlrev_b32 v66, 16, v19
    v_and_b32 v67, 0xffff0000, v19
    v_cvt_pk_bf16_f32 v18, v68, v69
    v_lshlrev_b32 v68, 16, v18
    v_and_b32 v69, 0xffff0000, v18
    v_cvt_pk_bf16_f32 v19, v70, v71
    v_lshlrev_b32 v70, 16, v19
    v_and_b32 v71, 0xffff0000, v19
    v_pk_add_f32 v[64:65], v[64:65], v[120:121]
    v_pk_add_f32 v[66:67], v[66:67], v[122:123]
    s_waitcnt lgkmcnt(0)
    v_pk_add_f32 v[68:69], v[68:69], v[124:125]
    v_pk_add_f32 v[70:71], v[70:71], v[126:127]
    v_cvt_pk_bf16_f32 v36, v64, v65
    v_cvt_pk_bf16_f32 v37, v66, v67
    v_cvt_pk_bf16_f32 v38, v68, v69
    v_cvt_pk_bf16_f32 v39, v70, v71
    buffer_store_dwordx4 v[36:39], v2, s[8:11], s16 offen offset:1024 sc1
    s_lshl_b32 s19, s3, 16
    s_lshl_b32 s20, s3, 11
    s_lshl_b32 s16, s12, 8
    s_add_u32 s4, s38, s16
    s_addc_u32 s5, s39, 0
    s_sub_u32 s6, 0x800000, s16
    s_mov_b32 s7, 0x20000
    v_mov_b32 v134, s28
    s_lshl_b32 s16, s29, 4
    s_add_u32 s16, s16, s31
    s_lshl_b32 s16, s16, 2
    s_add_u32 s16, s16, 0x528000
    v_and_b32 v16, 31, v1
    v_lshlrev_b32 v16, 2, v16
    s_lshl_b32 s17, s13, 3
    s_add_u32 s17, s17, s3
    s_lshl_b32 s17, s17, 7
    s_add_u32 s17, s17, 0x528000
    s_waitcnt vmcnt(0)
    s_mov_b64 exec, 1
    buffer_store_dword v134, v132, s[8:11], s16 offen sc1
    s_mov_b64 exec, -1
    s_add_u32 s22, s19, 0x0
    s_add_u32 m0, s20, 0x0
    s_nop 0
    buffer_load_dwordx4 v3, s[4:7], s22 offen lds
    s_add_u32 s22, s19, 0x8000
    s_add_u32 m0, s20, 0x400
    s_nop 0
    buffer_load_dwordx4 v3, s[4:7], s22 offen lds
    s_add_u32 s22, s19, 0x80000
    s_add_u32 m0, s20, 0x4000
    s_nop 0
    buffer_load_dwordx4 v3, s[4:7], s22 offen lds
    s_add_u32 s22, s19, 0x88000
    s_add_u32 m0, s20, 0x4400
    s_nop 0
    buffer_load_dwordx4 v3, s[4:7], s22 offen lds
    s_add_u32 s22, s19, 0x100000
    s_add_u32 m0, s20, 0x8000
    s_nop 0
    buffer_load_dwordx4 v3, s[4:7], s22 offen lds
    s_add_u32 s22, s19, 0x108000
    s_add_u32 m0, s20, 0x8400
    s_nop 0
    buffer_load_dwordx4 v3, s[4:7], s22 offen lds
    s_add_u32 s22, s19, 0x180000
    s_add_u32 m0, s20, 0xc000
    s_nop 0
    buffer_load_dwordx4 v3, s[4:7], s22 offen lds
    s_add_u32 s22, s19, 0x188000
    s_add_u32 m0, s20, 0xc400
    s_nop 0
    buffer_load_dwordx4 v3, s[4:7], s22 offen lds
    s_sleep 40
    s_mov_b32 s27, 0
adaLN_cond__sliding_block_cached__moe_arch_mod__prompt_kernel_h3p:
    buffer_load_dword v17, v16, s[8:11], s17 offen sc1
    s_waitcnt vmcnt(0)
    v_cmp_ne_u32 vcc, s28, v17
    s_add_u32 s27, s27, 1
    s_cmp_ge_u32 s27, 262144
    s_cbranch_scc1 adaLN_cond__sliding_block_cached__moe_arch_mod__prompt_kernel_h3g
    s_cbranch_vccnz adaLN_cond__sliding_block_cached__moe_arch_mod__prompt_kernel_h3p
adaLN_cond__sliding_block_cached__moe_arch_mod__prompt_kernel_h3g:
    v_add_u32 v11, 0x20000, v4
    v_add_u32 v6, 0x20000, v5
    s_mov_b32 s23, 0x0
    buffer_load_dwordx4 v[88:91], v7, s[8:11], s23 offen offset:0 sc1
    s_mov_b32 s23, 0x8000
    buffer_load_dwordx4 v[92:95], v7, s[8:11], s23 offen offset:0 sc1
    s_mov_b32 s23, 0x0
    buffer_load_dwordx4 v[96:99], v7, s[8:11], s23 offen offset:1024 sc1
    s_mov_b32 s23, 0x8000
    buffer_load_dwordx4 v[100:103], v7, s[8:11], s23 offen offset:1024 sc1
    s_mov_b32 s23, 0x800
    buffer_load_dwordx4 v[104:107], v7, s[8:11], s23 offen offset:0 sc1
    s_mov_b32 s23, 0x8800
    buffer_load_dwordx4 v[108:111], v7, s[8:11], s23 offen offset:0 sc1
    s_mov_b32 s23, 0x800
    buffer_load_dwordx4 v[112:115], v7, s[8:11], s23 offen offset:1024 sc1
    s_mov_b32 s23, 0x8800
    buffer_load_dwordx4 v[116:119], v7, s[8:11], s23 offen offset:1024 sc1
    s_lshr_b32 s21, s12, 3
    s_lshl_b32 s21, s21, 17
    s_add_u32 s21, s21, s20
    s_add_u32 s21, s21, 0x400000
    s_barrier
    ds_read_b64_tr_b16 v[224:225], v4 offset:0
    ds_read_b64_tr_b16 v[226:227], v4 offset:1024
    ds_read_b64_tr_b16 v[228:229], v5 offset:32
    ds_read_b64_tr_b16 v[230:231], v5 offset:1056
    ds_read_b64_tr_b16 v[232:233], v4 offset:256
    ds_read_b64_tr_b16 v[234:235], v4 offset:1280
    ds_read_b64_tr_b16 v[236:237], v5 offset:288
    ds_read_b64_tr_b16 v[238:239], v5 offset:1312
    s_waitcnt vmcnt(7) lgkmcnt(6)
    v_mfma_f32_16x16x32_bf16 v[24:27], v[224:227], v[88:91], 0
    ds_read_b64_tr_b16 v[240:241], v4 offset:512
    s_waitcnt vmcnt(6)
    v_mfma_f32_16x16x32_bf16 v[28:31], v[224:227], v[92:95], 0
    ds_read_b64_tr_b16 v[242:243], v4 offset:1536
    s_waitcnt lgkmcnt(6)
    v_mfma_f32_16x16x32_bf16 v[32:35], v[228:231], v[88:91], 0
    ds_read_b64_tr_b16 v[244:245], v5 offset:544
    v_mfma_f32_16x16x32_bf16 v[36:39], v[228:231], v[92:95], 0
    ds_read_b64_tr_b16 v[246:247], v5 offset:1568
    s_mov_b32 s23, 0x1000
    buffer_load_dwordx4 v[120:123], v7, s[8:11], s23 offen offset:0 sc1
    s_waitcnt lgkmcnt(6)
    v_mfma_f32_16x16x32_bf16 v[40:43], v[232:235], v[88:91], 0
    ds_read_b64_tr_b16 v[224:225], v4 offset:768
    v_mfma_f32_16x16x32_bf16 v[44:47], v[232:235], v[92:95], 0
    ds_read_b64_tr_b16 v[226:227], v4 offset:1792
    s_waitcnt lgkmcnt(6)
    v_mfma_f32_16x16x32_bf16 v[48:51], v[236:239], v[88:91], 0
    ds_read_b64_tr_b16 v[228:229], v5 offset:800
    v_mfma_f32_16x16x32_bf16 v[52:55], v[236:239], v[92:95], 0
    ds_read_b64_tr_b16 v[230:231], v5 offset:1824
    s_waitcnt lgkmcnt(6)
    v_mfma_f32_16x16x32_bf16 v[56:59], v[240:243], v[88:91], 0
    ds_read_b64_tr_b16 v[232:233], v4 offset:8192
    v_mfma_f32_16x16x32_bf16 v[60:63], v[240:243], v[92:95], 0
    ds_read_b64_tr_b16 v[234:235], v4 offset:9216
    s_waitcnt lgkmcnt(6)
    v_mfma_f32_16x16x32_bf16 v[64:67], v[244:247], v[88:91], 0
    ds_read_b64_tr_b16 v[236:237], v5 offset:8224
    v_mfma_f32_16x16x32_bf16 v[68:71], v[244:247], v[92:95], 0
    ds_read_b64_tr_b16 v[238:239], v5 offset:9248
    s_mov_b32 s23, 0x9000
    buffer_load_dwordx4 v[124:127], v7, s[8:11], s23 offen offset:0 sc1
    s_waitcnt lgkmcnt(6)
    v_mfma_f32_16x16x32_bf16 v[72:75], v[224:227], v[88:91], 0
    ds_read_b64_tr_b16 v[240:241], v4 offset:8448
    v_mfma_f32_16x16x32_bf16 v[76:79], v[224:227], v[92:95], 0
    ds_read_b64_tr_b16 v[242:243], v4 offset:9472
    s_waitcnt lgkmcnt(6)
    v_mfma_f32_16x16x32_bf16 v[80:83], v[228:231], v[88:91], 0
    ds_read_b64_tr_b16 v[244:245], v5 offset:8480
    v_mfma_f32_16x16x32_bf16 v[84:87], v[228:231], v[92:95], 0
    ds_read_b64_tr_b16 v[246:247], v5 offset:9504
    s_waitcnt vmcnt(7) lgkmcnt(6)
    v_mfma_f32_16x16x32_bf16 v[24:27], v[232:235], v[96:99], v[24:27]
    ds_read_b64_tr_b16 v[224:225], v4 offset:8704
    s_waitcnt vmcnt(6)
    v_mfma_f32_16x16x32_bf16 v[28:31], v[232:235], v[100:103], v[28:31]
    ds_read_b64_tr_b16 v[226:227], v4 offset:9728
    s_waitcnt lgkmcnt(6)
    v_mfma_f32_16x16x32_bf16 v[32:35], v[236:239], v[96:99], v[32:35]
    ds_read_b64_tr_b16 v[228:229], v5 offset:8736
    v_mfma_f32_16x16x32_bf16 v[36:39], v[236:239], v[100:103], v[36:39]
    ds_read_b64_tr_b16 v[230:231], v5 offset:9760
    s_mov_b32 s23, 0x1000
    buffer_load_dwordx4 v[128:131], v7, s[8:11], s23 offen offset:1024 sc1
    s_waitcnt lgkmcnt(6)
    v_mfma_f32_16x16x32_bf16 v[40:43], v[240:243], v[96:99], v[40:43]
    ds_read_b64_tr_b16 v[232:233], v4 offset:8960
    v_mfma_f32_16x16x32_bf16 v[44:47], v[240:243], v[100:103], v[44:47]
    ds_read_b64_tr_b16 v[234:235], v4 offset:9984
    s_waitcnt lgkmcnt(6)
    v_mfma_f32_16x16x32_bf16 v[48:51], v[244:247], v[96:99], v[48:51]
    ds_read_b64_tr_b16 v[236:237], v5 offset:8992
    v_mfma_f32_16x16x32_bf16 v[52:55], v[244:247], v[100:103], v[52:55]
    ds_read_b64_tr_b16 v[238:239], v5 offset:10016
    s_waitcnt lgkmcnt(6)
    v_mfma_f32_16x16x32_bf16 v[56:59], v[224:227], v[96:99], v[56:59]
    v_mfma_f32_16x16x32_bf16 v[60:63], v[224:227], v[100:103], v[60:63]
    s_barrier
    ds_read_b64_tr_b16 v[240:241], v4 offset:16384
    ds_read_b64_tr_b16 v[242:243], v4 offset:17408
    s_waitcnt lgkmcnt(6)
    v_mfma_f32_16x16x32_bf16 v[64:67], v[228:231], v[96:99], v[64:67]
    ds_read_b64_tr_b16 v[244:245], v5 offset:16416
    v_mfma_f32_16x16x32_bf16 v[68:71], v[228:231], v[100:103], v[68:71]
    s_add_u32 s22, s19, 0x200000
    s_add_u32 m0, s20, 0x20000
    s_nop 0
    buffer_load_dwordx4 v3, s[4:7], s22 offen lds
    ds_read_b64_tr_b16 v[246:247], v5 offset:17440
    s_mov_b32 s23, 0x9000
    buffer_load_dwordx4 v[132:135], v7, s[8:11], s23 offen offset:1024 sc1
    s_waitcnt lgkmcnt(6)
    v_mfma_f32_16x16x32_bf16 v[72:75], v[232:235], v[96:99], v[72:75]
    ds_read_b64_tr_b16 v[224:225], v4 offset:16640
    v_mfma_f32_16x16x32_bf16 v[76:79], v[232:235], v[100:103], v[76:79]
    ds_read_b64_tr_b16 v[226:227], v4 offset:17664
    s_waitcnt lgkmcnt(6)
    v_mfma_f32_16x16x32_bf16 v[80:83], v[236:239], v[96:99], v[80:83]
    ds_read_b64_tr_b16 v[228:229], v5 offset:16672
    v_mfma_f32_16x16x32_bf16 v[84:87], v[236:239], v[100:103], v[84:87]
    ds_read_b64_tr_b16 v[230:231], v5 offset:17696
    s_waitcnt vmcnt(8) lgkmcnt(6)
    v_mfma_f32_16x16x32_bf16 v[24:27], v[240:243], v[104:107], v[24:27]
    ds_read_b64_tr_b16 v[232:233], v4 offset:16896
    s_waitcnt vmcnt(7)
    v_mfma_f32_16x16x32_bf16 v[28:31], v[240:243], v[108:111], v[28:31]
    ds_read_b64_tr_b16 v[234:235], v4 offset:17920
    s_waitcnt lgkmcnt(6)
    v_mfma_f32_16x16x32_bf16 v[32:35], v[244:247], v[104:107], v[32:35]
    ds_read_b64_tr_b16 v[236:237], v5 offset:16928
    v_mfma_f32_16x16x32_bf16 v[36:39], v[244:247], v[108:111], v[36:39]
    s_add_u32 s22, s19, 0x208000
    s_add_u32 m0, s20, 0x20400
    s_nop 0
    buffer_load_dwordx4 v3, s[4:7], s22 offen lds
    ds_read_b64_tr_b16 v[238:239], v5 offset:17952
    s_mov_b32 s23, 0x1800
    buffer_load_dwordx4 v[88:91], v7, s[8:11], s23 offen offset:0 sc1
    s_waitcnt lgkmcnt(6)
    v_mfma_f32_16x16x32_bf16 v[40:43], v[224:227], v[104:107], v[40:43]
    ds_read_b64_tr_b16 v[240:241], v4 offset:17152
    v_mfma_f32_16x16x32_bf16 v[44:47], v[224:227], v[108:111], v[44:47]
    ds_read_b64_tr_b16 v[242:243], v4 offset:18176
    s_waitcnt lgkmcnt(6)
    v_mfma_f32_16x16x32_bf16 v[48:51], v[228:231], v[104:107], v[48:51]
    ds_read_b64_tr_b16 v[244:245], v5 offset:17184
    v_mfma_f32_16x16x32_bf16 v[52:55], v[228:231], v[108:111], v[52:55]
    ds_read_b64_tr_b16 v[246:247], v5 offset:18208
    s_waitcnt lgkmcnt(6)
    v_mfma_f32_16x16x32_bf16 v[56:59], v[232:235], v[104:107], v[56:59]
    ds_read_b64_tr_b16 v[224:225], v4 offset:24576
    v_mfma_f32_16x16x32_bf16 v[60:63], v[232:235], v[108:111], v[60:63]
    ds_read_b64_tr_b16 v[226:227], v4 offset:25600
    s_waitcnt lgkmcnt(6)
    v_mfma_f32_16x16x32_bf16 v[64:67], v[236:239], v[104:107], v[64:67]
    ds_read_b64_tr_b16 v[228:229], v5 offset:24608
    v_mfma_f32_16x16x32_bf16 v[68:71], v[236:239], v[108:111], v[68:71]
    ds_read_b64_tr_b16 v[230:231], v5 offset:25632
    s_mov_b32 s23, 0x9800
    buffer_load_dwordx4 v[92:95], v7, s[8:11], s23 offen offset:0 sc1
    s_waitcnt lgkmcnt(6)
    v_mfma_f32_16x16x32_bf16 v[72:75], v[240:243], v[104:107], v[72:75]
    ds_read_b64_tr_b16 v[232:233], v4 offset:24832
    v_mfma_f32_16x16x32_bf16 v[76:79], v[240:243], v[108:111], v[76:79]
    ds_read_b64_tr_b16 v[234:235], v4 offset:25856
    s_waitcnt lgkmcnt(6)
    v_mfma_f32_16x16x32_bf16 v[80:83], v[244:247], v[104:107], v[80:83]
    ds_read_b64_tr_b16 v[236:237], v5 offset:24864
    v_mfma_f32_16x16x32_bf16 v[84:87], v[244:247], v[108:111], v[84:87]
    ds_read_b64_tr_b16 v[238:239], v5 offset:25888
    s_waitcnt vmcnt(9) lgkmcnt(6)
    v_mfma_f32_16x16x32_bf16 v[24:27], v[224:227], v[112:115], v[24:27]
    ds_read_b64_tr_b16 v[240:241], v4 offset:25088
    s_waitcnt vmcnt(8)
    v_mfma_f32_16x16x32_bf16 v[28:31], v[224:227], v[116:119], v[28:31]
    ds_read_b64_tr_b16 v[242:243], v4 offset:26112
    s_waitcnt lgkmcnt(6)
    v_mfma_f32_16x16x32_bf16 v[32:35], v[228:231], v[112:115], v[32:35]
    ds_read_b64_tr_b16 v[244:245], v5 offset:25120
    v_mfma_f32_16x16x32_bf16 v[36:39], v[228:231], v[116:119], v[36:39]
    ds_read_b64_tr_b16 v[246:247], v5 offset:26144
    s_mov_b32 s23, 0x1800
    buffer_load_dwordx4 v[96:99], v7, s[8:11], s23 offen offset:1024 sc1
    s_waitcnt lgkmcnt(6)
    v_mfma_f32_16x16x32_bf16 v[40:43], v[232:235], v[112:115], v[40:43]
    ds_read_b64_tr_b16 v[224:225], v4 offset:25344
    v_mfma_f32_16x16x32_bf16 v[44:47], v[232:235], v[116:119], v[44:47]
    ds_read_b64_tr_b16 v[226:227], v4 offset:26368
    s_waitcnt lgkmcnt(6)
    v_mfma_f32_16x16x32_bf16 v[48:51], v[236:239], v[112:115], v[48:51]
    ds_read_b64_tr_b16 v[228:229], v5 offset:25376
    v_mfma_f32_16x16x32_bf16 v[52:55], v[236:239], v[116:119], v[52:55]
    ds_read_b64_tr_b16 v[230:231], v5 offset:26400
    s_waitcnt lgkmcnt(6)
    v_mfma_f32_16x16x32_bf16 v[56:59], v[240:243], v[112:115], v[56:59]
    v_mfma_f32_16x16x32_bf16 v[60:63], v[240:243], v[116:119], v[60:63]
    s_barrier
    ds_read_b64_tr_b16 v[232:233], v4 offset:32768
    ds_read_b64_tr_b16 v[234:235], v4 offset:33792
    s_waitcnt lgkmcnt(6)
    v_mfma_f32_16x16x32_bf16 v[64:67], v[244:247], v[112:115], v[64:67]
    ds_read_b64_tr_b16 v[236:237], v5 offset:32800
    v_mfma_f32_16x16x32_bf16 v[68:71], v[244:247], v[116:119], v[68:71]
    s_add_u32 s22, s19, 0x280000
    s_add_u32 m0, s20, 0x0
    s_nop 0
    buffer_load_dwordx4 v3, s[4:7], s22 offen lds
    ds_read_b64_tr_b16 v[238:239], v5 offset:33824
    s_mov_b32 s23, 0x9800
    buffer_load_dwordx4 v[100:103], v7, s[8:11], s23 offen offset:1024 sc1
    s_waitcnt lgkmcnt(6)
    v_mfma_f32_16x16x32_bf16 v[72:75], v[224:227], v[112:115], v[72:75]
    ds_read_b64_tr_b16 v[240:241], v4 offset:33024
    v_mfma_f32_16x16x32_bf16 v[76:79], v[224:227], v[116:119], v[76:79]
    ds_read_b64_tr_b16 v[242:243], v4 offset:34048
    s_waitcnt lgkmcnt(6)
    v_mfma_f32_16x16x32_bf16 v[80:83], v[228:231], v[112:115], v[80:83]
    ds_read_b64_tr_b16 v[244:245], v5 offset:33056
    v_mfma_f32_16x16x32_bf16 v[84:87], v[228:231], v[116:119], v[84:87]
    ds_read_b64_tr_b16 v[246:247], v5 offset:34080
    s_waitcnt vmcnt(10) lgkmcnt(6)
    v_mfma_f32_16x16x32_bf16 v[24:27], v[232:235], v[120:123], v[24:27]
    ds_read_b64_tr_b16 v[224:225], v4 offset:33280
    s_waitcnt vmcnt(9)
    v_mfma_f32_16x16x32_bf16 v[28:31], v[232:235], v[124:127], v[28:31]
    ds_read_b64_tr_b16 v[226:227], v4 offset:34304
    s_waitcnt lgkmcnt(6)
    v_mfma_f32_16x16x32_bf16 v[32:35], v[236:239], v[120:123], v[32:35]
    ds_read_b64_tr_b16 v[228:229], v5 offset:33312
    v_mfma_f32_16x16x32_bf16 v[36:39], v[236:239], v[124:127], v[36:39]
    s_add_u32 s22, s19, 0x288000
    s_add_u32 m0, s20, 0x400
    s_nop 0
    buffer_load_dwordx4 v3, s[4:7], s22 offen lds
    ds_read_b64_tr_b16 v[230:231], v5 offset:34336
    s_mov_b32 s23, 0x2000
    buffer_load_dwordx4 v[104:107], v7, s[8:11], s23 offen offset:0 sc1
    s_waitcnt lgkmcnt(6)
    v_mfma_f32_16x16x32_bf16 v[40:43], v[240:243], v[120:123], v[40:43]
    ds_read_b64_tr_b16 v[232:233], v4 offset:33536
    v_mfma_f32_16x16x32_bf16 v[44:47], v[240:243], v[124:127], v[44:47]
    ds_read_b64_tr_b16 v[234:235], v4 offset:34560
    s_waitcnt lgkmcnt(6)
    v_mfma_f32_16x16x32_bf16 v[48:51], v[244:247], v[120:123], v[48:51]
    ds_read_b64_tr_b16 v[236:237], v5 offset:33568
    v_mfma_f32_16x16x32_bf16 v[52:55], v[244:247], v[124:127], v[52:55]
    ds_read_b64_tr_b16 v[238:239], v5 offset:34592
    s_waitcnt lgkmcnt(6)
    v_mfma_f32_16x16x32_bf16 v[56:59], v[224:227], v[120:123], v[56:59]
    ds_read_b64_tr_b16 v[240:241], v4 offset:40960
    v_mfma_f32_16x16x32_bf16 v[60:63], v[224:227], v[124:127], v[60:63]
    ds_read_b64_tr_b16 v[242:243], v4 offset:41984
    s_waitcnt lgkmcnt(6)
    v_mfma_f32_16x16x32_bf16 v[64:67], v[228:231], v[120:123], v[64:67]
    ds_read_b64_tr_b16 v[244:245], v5 offset:40992
    v_mfma_f32_16x16x32_bf16 v[68:71], v[228:231], v[124:127], v[68:71]
    ds_read_b64_tr_b16 v[246:247], v5 offset:42016
    s_mov_b32 s23, 0xa000
    buffer_load_dwordx4 v[108:111], v7, s[8:11], s23 offen offset:0 sc1
    s_waitcnt lgkmcnt(6)
    v_mfma_f32_16x16x32_bf16 v[72:75], v[232:235], v[120:123], v[72:75]
    ds_read_b64_tr_b16 v[224:225], v4 offset:41216
    v_mfma_f32_16x16x32_bf16 v[76:79], v[232:235], v[124:127], v[76:79]
    ds_read_b64_tr_b16 v[226:227], v4 offset:42240
    s_waitcnt lgkmcnt(6)
    v_mfma_f32_16x16x32_bf16 v[80:83], v[236:239], v[120:123], v[80:83]
    ds_read_b64_tr_b16 v[228:229], v5 offset:41248
    v_mfma_f32_16x16x32_bf16 v[84:87], v[236:239], v[124:127], v[84:87]
    ds_read_b64_tr_b16 v[230:231], v5 offset:42272
    s_waitcnt vmcnt(11) lgkmcnt(6)
    v_mfma_f32_16x16x32_bf16 v[24:27], v[240:243], v[128:131], v[24:27]
    ds_read_b64_tr_b16 v[232:233], v4 offset:41472
    s_waitcnt vmcnt(9)
    v_mfma_f32_16x16x32_bf16 v[28:31], v[240:243], v[132:135], v[28:31]
    ds_read_b64_tr_b16 v[234:235], v4 offset:42496
    s_waitcnt lgkmcnt(6)
    v_mfma_f32_16x16x32_bf16 v[32:35], v[244:247], v[128:131], v[32:35]
    ds_read_b64_tr_b16 v[236:237], v5 offset:41504
    v_mfma_f32_16x16x32_bf16 v[36:39], v[244:247], v[132:135], v[36:39]
    ds_read_b64_tr_b16 v[238:239], v5 offset:42528
    s_mov_b32 s23, 0x2000
    buffer_load_dwordx4 v[112:115], v7, s[8:11], s23 offen offset:1024 sc1
    s_waitcnt lgkmcnt(6)
    v_mfma_f32_16x16x32_bf16 v[40:43], v[224:227], v[128:131], v[40:43]
    ds_read_b64_tr_b16 v[240:241], v4 offset:41728
    v_mfma_f32_16x16x32_bf16 v[44:47], v[224:227], v[132:135], v[44:47]
    ds_read_b64_tr_b16 v[242:243], v4 offset:42752
    s_waitcnt lgkmcnt(6)
    v_mfma_f32_16x16x32_bf16 v[48:51], v[228:231], v[128:131], v[48:51]
    ds_read_b64_tr_b16 v[244:245], v5 offset:41760
    v_mfma_f32_16x16x32_bf16 v[52:55], v[228:231], v[132:135], v[52:55]
    ds_read_b64_tr_b16 v[246:247], v5 offset:42784
    s_waitcnt lgkmcnt(6)
    v_mfma_f32_16x16x32_bf16 v[56:59], v[232:235], v[128:131], v[56:59]
    v_mfma_f32_16x16x32_bf16 v[60:63], v[232:235], v[132:135], v[60:63]
    s_barrier
    ds_read_b64_tr_b16 v[224:225], v4 offset:49152
    ds_read_b64_tr_b16 v[226:227], v4 offset:50176
    s_waitcnt lgkmcnt(6)
    v_mfma_f32_16x16x32_bf16 v[64:67], v[236:239], v[128:131], v[64:67]
    ds_read_b64_tr_b16 v[228:229], v5 offset:49184
    v_mfma_f32_16x16x32_bf16 v[68:71], v[236:239], v[132:135], v[68:71]
    s_add_u32 s22, s19, 0x300000
    s_add_u32 m0, s20, 0x4000
    s_nop 0
    buffer_load_dwordx4 v3, s[4:7], s22 offen lds
    ds_read_b64_tr_b16 v[230:231], v5 offset:50208
    s_mov_b32 s23, 0xa000
    buffer_load_dwordx4 v[116:119], v7, s[8:11], s23 offen offset:1024 sc1
    s_waitcnt lgkmcnt(6)
    v_mfma_f32_16x16x32_bf16 v[72:75], v[240:243], v[128:131], v[72:75]
    ds_read_b64_tr_b16 v[232:233], v4 offset:49408
    v_mfma_f32_16x16x32_bf16 v[76:79], v[240:243], v[132:135], v[76:79]
    ds_read_b64_tr_b16 v[234:235], v4 offset:50432
    s_waitcnt lgkmcnt(6)
    v_mfma_f32_16x16x32_bf16 v[80:83], v[244:247], v[128:131], v[80:83]
    ds_read_b64_tr_b16 v[236:237], v5 offset:49440
    v_mfma_f32_16x16x32_bf16 v[84:87], v[244:247], v[132:135], v[84:87]
    ds_read_b64_tr_b16 v[238:239], v5 offset:50464
    s_waitcnt vmcnt(10) lgkmcnt(6)
    v_mfma_f32_16x16x32_bf16 v[24:27], v[224:227], v[88:91], v[24:27]
    ds_read_b64_tr_b16 v[240:241], v4 offset:49664
    s_waitcnt vmcnt(9)
    v_mfma_f32_16x16x32_bf16 v[28:31], v[224:227], v[92:95], v[28:31]
    ds_read_b64_tr_b16 v[242:243], v4 offset:50688
    s_waitcnt lgkmcnt(6)
    v_mfma_f32_16x16x32_bf16 v[32:35], v[228:231], v[88:91], v[32:35]
    ds_read_b64_tr_b16 v[244:245], v5 offset:49696
    v_mfma_f32_16x16x32_bf16 v[36:39], v[228:231], v[92:95], v[36:39]
    s_add_u32 s22, s19, 0x308000
    s_add_u32 m0, s20, 0x4400
    s_nop 0
    buffer_load_dwordx4 v3, s[4:7], s22 offen lds
    ds_read_b64_tr_b16 v[246:247], v5 offset:50720
    s_mov_b32 s23, 0x2800
    buffer_load_dwordx4 v[120:123], v7, s[8:11], s23 offen offset:0 sc1
    s_waitcnt lgkmcnt(6)
    v_mfma_f32_16x16x32_bf16 v[40:43], v[232:235], v[88:91], v[40:43]
    ds_read_b64_tr_b16 v[224:225], v4 offset:49920
    v_mfma_f32_16x16x32_bf16 v[44:47], v[232:235], v[92:95], v[44:47]
    ds_read_b64_tr_b16 v[226:227], v4 offset:50944
    s_waitcnt lgkmcnt(6)
    v_mfma_f32_16x16x32_bf16 v[48:51], v[236:239], v[88:91], v[48:51]
    ds_read_b64_tr_b16 v[228:229], v5 offset:49952
    v_mfma_f32_16x16x32_bf16 v[52:55], v[236:239], v[92:95], v[52:55]
    ds_read_b64_tr_b16 v[230:231], v5 offset:50976
    s_waitcnt lgkmcnt(6)
    v_mfma_f32_16x16x32_bf16 v[56:59], v[240:243], v[88:91], v[56:59]
    ds_read_b64_tr_b16 v[232:233], v4 offset:57344
    v_mfma_f32_16x16x32_bf16 v[60:63], v[240:243], v[92:95], v[60:63]
    ds_read_b64_tr_b16 v[234:235], v4 offset:58368
    s_waitcnt lgkmcnt(6)
    v_mfma_f32_16x16x32_bf16 v[64:67], v[244:247], v[88:91], v[64:67]
    ds_read_b64_tr_b16 v[236:237], v5 offset:57376
    v_mfma_f32_16x16x32_bf16 v[68:71], v[244:247], v[92:95], v[68:71]
    ds_read_b64_tr_b16 v[238:239], v5 offset:58400
    s_mov_b32 s23, 0xa800
    buffer_load_dwordx4 v[124:127], v7, s[8:11], s23 offen offset:0 sc1
    s_waitcnt lgkmcnt(6)
    v_mfma_f32_16x16x32_bf16 v[72:75], v[224:227], v[88:91], v[72:75]
    ds_read_b64_tr_b16 v[240:241], v4 offset:57600
    v_mfma_f32_16x16x32_bf16 v[76:79], v[224:227], v[92:95], v[76:79]
    ds_read_b64_tr_b16 v[242:243], v4 offset:58624
    s_waitcnt lgkmcnt(6)
    v_mfma_f32_16x16x32_bf16 v[80:83], v[228:231], v[88:91], v[80:83]
    ds_read_b64_tr_b16 v[244:245], v5 offset:57632
    v_mfma_f32_16x16x32_bf16 v[84:87], v[228:231], v[92:95], v[84:87]
    ds_read_b64_tr_b16 v[246:247], v5 offset:58656
    s_waitcnt vmcnt(11) lgkmcnt(6)
    v_mfma_f32_16x16x32_bf16 v[24:27], v[232:235], v[96:99], v[24:27]
    ds_read_b64_tr_b16 v[224:225], v4 offset:57856
    s_waitcnt vmcnt(9)
    v_mfma_f32_16x16x32_bf16 v[28:31], v[232:235], v[100:103], v[28:31]
    ds_read_b64_tr_b16 v[226:227], v4 offset:58880
    s_waitcnt lgkmcnt(6)
    v_mfma_f32_16x16x32_bf16 v[32:35], v[236:239], v[96:99], v[32:35]
    ds_read_b64_tr_b16 v[228:229], v5 offset:57888
    v_mfma_f32_16x16x32_bf16 v[36:39], v[236:239], v[100:103], v[36:39]
    ds_read_b64_tr_b16 v[230:231], v5 offset:58912
    s_mov_b32 s23, 0x2800
    buffer_load_dwordx4 v[128:131], v7, s[8:11], s23 offen offset:1024 sc1
    s_waitcnt lgkmcnt(6)
    v_mfma_f32_16x16x32_bf16 v[40:43], v[240:243], v[96:99], v[40:43]
    ds_read_b64_tr_b16 v[232:233], v4 offset:58112
    v_mfma_f32_16x16x32_bf16 v[44:47], v[240:243], v[100:103], v[44:47]
    ds_read_b64_tr_b16 v[234:235], v4 offset:59136
    s_waitcnt lgkmcnt(6)
    v_mfma_f32_16x16x32_bf16 v[48:51], v[244:247], v[96:99], v[48:51]
    ds_read_b64_tr_b16 v[236:237], v5 offset:58144
    v_mfma_f32_16x16x32_bf16 v[52:55], v[244:247], v[100:103], v[52:55]
    ds_read_b64_tr_b16 v[238:239], v5 offset:59168
    s_waitcnt lgkmcnt(6)
    v_mfma_f32_16x16x32_bf16 v[56:59], v[224:227], v[96:99], v[56:59]
    v_mfma_f32_16x16x32_bf16 v[60:63], v[224:227], v[100:103], v[60:63]
    s_barrier
    ds_read_b64_tr_b16 v[240:241], v11 offset:0
    ds_read_b64_tr_b16 v[242:243], v11 offset:1024
    s_waitcnt lgkmcnt(6)
    v_mfma_f32_16x16x32_bf16 v[64:67], v[228:231], v[96:99], v[64:67]
    ds_read_b64_tr_b16 v[244:245], v6 offset:32
    v_mfma_f32_16x16x32_bf16 v[68:71], v[228:231], v[100:103], v[68:71]
    s_add_u32 s22, s19, 0x380000
    s_add_u32 m0, s20, 0x8000
    s_nop 0
    buffer_load_dwordx4 v3, s[4:7], s22 offen lds
    ds_read_b64_tr_b16 v[246:247], v6 offset:1056
    s_mov_b32 s23, 0xa800
    buffer_load_dwordx4 v[132:135], v7, s[8:11], s23 offen offset:1024 sc1
    s_waitcnt lgkmcnt(6)
    v_mfma_f32_16x16x32_bf16 v[72:75], v[232:235], v[96:99], v[72:75]
    ds_read_b64_tr_b16 v[224:225], v11 offset:256
    v_mfma_f32_16x16x32_bf16 v[76:79], v[232:235], v[100:103], v[76:79]
    ds_read_b64_tr_b16 v[226:227], v11 offset:1280
    s_waitcnt lgkmcnt(6)
    v_mfma_f32_16x16x32_bf16 v[80:83], v[236:239], v[96:99], v[80:83]
    ds_read_b64_tr_b16 v[228:229], v6 offset:288
    v_mfma_f32_16x16x32_bf16 v[84:87], v[236:239], v[100:103], v[84:87]
    ds_read_b64_tr_b16 v[230:231], v6 offset:1312
    s_waitcnt vmcnt(10) lgkmcnt(6)
    v_mfma_f32_16x16x32_bf16 v[24:27], v[240:243], v[104:107], v[24:27]
    ds_read_b64_tr_b16 v[232:233], v11 offset:512
    s_waitcnt vmcnt(9)
    v_mfma_f32_16x16x32_bf16 v[28:31], v[240:243], v[108:111], v[28:31]
    ds_read_b64_tr_b16 v[234:235], v11 offset:1536
    s_waitcnt lgkmcnt(6)
    v_mfma_f32_16x16x32_bf16 v[32:35], v[244:247], v[104:107], v[32:35]
    ds_read_b64_tr_b16 v[236:237], v6 offset:544
    v_mfma_f32_16x16x32_bf16 v[36:39], v[244:247], v[108:111], v[36:39]
    s_add_u32 s22, s19, 0x388000
    s_add_u32 m0, s20, 0x8400
    s_nop 0
    buffer_load_dwordx4 v3, s[4:7], s22 offen lds
    ds_read_b64_tr_b16 v[238:239], v6 offset:1568
    s_mov_b32 s23, 0x3000
    buffer_load_dwordx4 v[88:91], v7, s[8:11], s23 offen offset:0 sc1
    s_waitcnt lgkmcnt(6)
    v_mfma_f32_16x16x32_bf16 v[40:43], v[224:227], v[104:107], v[40:43]
    ds_read_b64_tr_b16 v[240:241], v11 offset:768
    v_mfma_f32_16x16x32_bf16 v[44:47], v[224:227], v[108:111], v[44:47]
    ds_read_b64_tr_b16 v[242:243], v11 offset:1792
    s_waitcnt lgkmcnt(6)
    v_mfma_f32_16x16x32_bf16 v[48:51], v[228:231], v[104:107], v[48:51]
    ds_read_b64_tr_b16 v[244:245], v6 offset:800
    v_mfma_f32_16x16x32_bf16 v[52:55], v[228:231], v[108:111], v[52:55]
    ds_read_b64_tr_b16 v[246:247], v6 offset:1824
    s_waitcnt lgkmcnt(6)
    v_mfma_f32_16x16x32_bf16 v[56:59], v[232:235], v[104:107], v[56:59]
    ds_read_b64_tr_b16 v[224:225], v11 offset:8192
    v_mfma_f32_16x16x32_bf16 v[60:63], v[232:235], v[108:111], v[60:63]
    ds_read_b64_tr_b16 v[226:227], v11 offset:9216
    s_waitcnt lgkmcnt(6)
    v_mfma_f32_16x16x32_bf16 v[64:67], v[236:239], v[104:107], v[64:67]
    ds_read_b64_tr_b16 v[228:229], v6 offset:8224
    v_mfma_f32_16x16x32_bf16 v[68:71], v[236:239], v[108:111], v[68:71]
    ds_read_b64_tr_b16 v[230:231], v6 offset:9248
    s_mov_b32 s23, 0xb000
    buffer_load_dwordx4 v[92:95], v7, s[8:11], s23 offen offset:0 sc1
    s_waitcnt lgkmcnt(6)
    v_mfma_f32_16x16x32_bf16 v[72:75], v[240:243], v[104:107], v[72:75]
    ds_read_b64_tr_b16 v[232:233], v11 offset:8448
    v_mfma_f32_16x16x32_bf16 v[76:79], v[240:243], v[108:111], v[76:79]
    ds_read_b64_tr_b16 v[234:235], v11 offset:9472
    s_waitcnt lgkmcnt(6)
    v_mfma_f32_16x16x32_bf16 v[80:83], v[244:247], v[104:107], v[80:83]
    ds_read_b64_tr_b16 v[236:237], v6 offset:8480
    v_mfma_f32_16x16x32_bf16 v[84:87], v[244:247], v[108:111], v[84:87]
    ds_read_b64_tr_b16 v[238:239], v6 offset:9504
    s_waitcnt vmcnt(11) lgkmcnt(6)
    v_mfma_f32_16x16x32_bf16 v[24:27], v[224:227], v[112:115], v[24:27]
    ds_read_b64_tr_b16 v[240:241], v11 offset:8704
    s_waitcnt vmcnt(9)
    v_mfma_f32_16x16x32_bf16 v[28:31], v[224:227], v[116:119], v[28:31]
    ds_read_b64_tr_b16 v[242:243], v11 offset:9728
    s_waitcnt lgkmcnt(6)
    v_mfma_f32_16x16x32_bf16 v[32:35], v[228:231], v[112:115], v[32:35]
    ds_read_b64_tr_b16 v[244:245], v6 offset:8736
    v_mfma_f32_16x16x32_bf16 v[36:39], v[228:231], v[116:119], v[36:39]
    ds_read_b64_tr_b16 v[246:247], v6 offset:9760
    s_mov_b32 s23, 0x3000
    buffer_load_dwordx4 v[96:99], v7, s[8:11], s23 offen offset:1024 sc1
    s_waitcnt lgkmcnt(6)
    v_mfma_f32_16x16x32_bf16 v[40:43], v[232:235], v[112:115], v[40:43]
    ds_read_b64_tr_b16 v[224:225], v11 offset:8960
    v_mfma_f32_16x16x32_bf16 v[44:47], v[232:235], v[116:119], v[44:47]
    ds_read_b64_tr_b16 v[226:227], v11 offset:9984
    s_waitcnt lgkmcnt(6)
    v_mfma_f32_16x16x32_bf16 v[48:51], v[236:239], v[112:115], v[48:51]
    ds_read_b64_tr_b16 v[228:229], v6 offset:8992
    v_mfma_f32_16x16x32_bf16 v[52:55], v[236:239], v[116:119], v[52:55]
    ds_read_b64_tr_b16 v[230:231], v6 offset:10016
    s_waitcnt lgkmcnt(6)
    v_mfma_f32_16x16x32_bf16 v[56:59], v[240:243], v[112:115], v[56:59]
    v_mfma_f32_16x16x32_bf16 v[60:63], v[240:243], v[116:119], v[60:63]
    s_barrier
    ds_read_b64_tr_b16 v[232:233], v4 offset:0
    ds_read_b64_tr_b16 v[234:235], v4 offset:1024
    s_waitcnt lgkmcnt(6)
    v_mfma_f32_16x16x32_bf16 v[64:67], v[244:247], v[112:115], v[64:67]
    ds_read_b64_tr_b16 v[236:237], v5 offset:32
    v_mfma_f32_16x16x32_bf16 v[68:71], v[244:247], v[116:119], v[68:71]
    s_add_u32 s22, s19, 0x400000
    s_add_u32 m0, s20, 0xc000
    s_nop 0
    buffer_load_dwordx4 v3, s[4:7], s22 offen lds
    ds_read_b64_tr_b16 v[238:239], v5 offset:1056
    s_mov_b32 s23, 0xb000
    buffer_load_dwordx4 v[100:103], v7, s[8:11], s23 offen offset:1024 sc1
    s_waitcnt lgkmcnt(6)
    v_mfma_f32_16x16x32_bf16 v[72:75], v[224:227], v[112:115], v[72:75]
    ds_read_b64_tr_b16 v[240:241], v4 offset:256
    v_mfma_f32_16x16x32_bf16 v[76:79], v[224:227], v[116:119], v[76:79]
    ds_read_b64_tr_b16 v[242:243], v4 offset:1280
    s_waitcnt lgkmcnt(6)
    v_mfma_f32_16x16x32_bf16 v[80:83], v[228:231], v[112:115], v[80:83]
    ds_read_b64_tr_b16 v[244:245], v5 offset:288
    v_mfma_f32_16x16x32_bf16 v[84:87], v[228:231], v[116:119], v[84:87]
    ds_read_b64_tr_b16 v[246:247], v5 offset:1312
    s_waitcnt vmcnt(10) lgkmcnt(6)
    v_mfma_f32_16x16x32_bf16 v[24:27], v[232:235], v[120:123], v[24:27]
    ds_read_b64_tr_b16 v[224:225], v4 offset:512
    s_waitcnt vmcnt(9)
    v_mfma_f32_16x16x32_bf16 v[28:31], v[232:235], v[124:127], v[28:31]
    ds_read_b64_tr_b16 v[226:227], v4 offset:1536
    s_waitcnt lgkmcnt(6)
    v_mfma_f32_16x16x32_bf16 v[32:35], v[236:239], v[120:123], v[32:35]
    ds_read_b64_tr_b16 v[228:229], v5 offset:544
    v_mfma_f32_16x16x32_bf16 v[36:39], v[236:239], v[124:127], v[36:39]
    s_add_u32 s22, s19, 0x408000
    s_add_u32 m0, s20, 0xc400
    s_nop 0
    buffer_load_dwordx4 v3, s[4:7], s22 offen lds
    ds_read_b64_tr_b16 v[230:231], v5 offset:1568
    s_mov_b32 s23, 0x3800
    buffer_load_dwordx4 v[104:107], v7, s[8:11], s23 offen offset:0 sc1
    s_waitcnt lgkmcnt(6)
    v_mfma_f32_16x16x32_bf16 v[40:43], v[240:243], v[120:123], v[40:43]
    ds_read_b64_tr_b16 v[232:233], v4 offset:768
    v_mfma_f32_16x16x32_bf16 v[44:47], v[240:243], v[124:127], v[44:47]
    ds_read_b64_tr_b16 v[234:235], v4 offset:1792
    s_waitcnt lgkmcnt(6)
    v_mfma_f32_16x16x32_bf16 v[48:51], v[244:247], v[120:123], v[48:51]
    ds_read_b64_tr_b16 v[236:237], v5 offset:800
    v_mfma_f32_16x16x32_bf16 v[52:55], v[244:247], v[124:127], v[52:55]
    ds_read_b64_tr_b16 v[238:239], v5 offset:1824
    s_waitcnt lgkmcnt(6)
    v_mfma_f32_16x16x32_bf16 v[56:59], v[224:227], v[120:123], v[56:59]
    ds_read_b64_tr_b16 v[240:241], v4 offset:8192
    v_mfma_f32_16x16x32_bf16 v[60:63], v[224:227], v[124:127], v[60:63]
    ds_read_b64_tr_b16 v[242:243], v4 offset:9216
    s_waitcnt lgkmcnt(6)
    v_mfma_f32_16x16x32_bf16 v[64:67], v[228:231], v[120:123], v[64:67]
    ds_read_b64_tr_b16 v[244:245], v5 offset:8224
    v_mfma_f32_16x16x32_bf16 v[68:71], v[228:231], v[124:127], v[68:71]
    ds_read_b64_tr_b16 v[246:247], v5 offset:9248
    s_mov_b32 s23, 0xb800
    buffer_load_dwordx4 v[108:111], v7, s[8:11], s23 offen offset:0 sc1
    s_waitcnt lgkmcnt(6)
    v_mfma_f32_16x16x32_bf16 v[72:75], v[232:235], v[120:123], v[72:75]
    ds_read_b64_tr_b16 v[224:225], v4 offset:8448
    v_mfma_f32_16x16x32_bf16 v[76:79], v[232:235], v[124:127], v[76:79]
    ds_read_b64_tr_b16 v[226:227], v4 offset:9472
    s_waitcnt lgkmcnt(6)
    v_mfma_f32_16x16x32_bf16 v[80:83], v[236:239], v[120:123], v[80:83]
    ds_read_b64_tr_b16 v[228:229], v5 offset:8480
    v_mfma_f32_16x16x32_bf16 v[84:87], v[236:239], v[124:127], v[84:87]
    ds_read_b64_tr_b16 v[230:231], v5 offset:9504
    s_waitcnt vmcnt(11) lgkmcnt(6)
    v_mfma_f32_16x16x32_bf16 v[24:27], v[240:243], v[128:131], v[24:27]
    ds_read_b64_tr_b16 v[232:233], v4 offset:8704
    s_waitcnt vmcnt(9)
    v_mfma_f32_16x16x32_bf16 v[28:31], v[240:243], v[132:135], v[28:31]
    ds_read_b64_tr_b16 v[234:235], v4 offset:9728
    s_waitcnt lgkmcnt(6)
    v_mfma_f32_16x16x32_bf16 v[32:35], v[244:247], v[128:131], v[32:35]
    ds_read_b64_tr_b16 v[236:237], v5 offset:8736
    v_mfma_f32_16x16x32_bf16 v[36:39], v[244:247], v[132:135], v[36:39]
    ds_read_b64_tr_b16 v[238:239], v5 offset:9760
    s_mov_b32 s23, 0x3800
    buffer_load_dwordx4 v[112:115], v7, s[8:11], s23 offen offset:1024 sc1
    s_waitcnt lgkmcnt(6)
    v_mfma_f32_16x16x32_bf16 v[40:43], v[224:227], v[128:131], v[40:43]
    ds_read_b64_tr_b16 v[240:241], v4 offset:8960
    v_mfma_f32_16x16x32_bf16 v[44:47], v[224:227], v[132:135], v[44:47]
    ds_read_b64_tr_b16 v[242:243], v4 offset:9984
    s_waitcnt lgkmcnt(6)
    v_mfma_f32_16x16x32_bf16 v[48:51], v[228:231], v[128:131], v[48:51]
    ds_read_b64_tr_b16 v[244:245], v5 offset:8992
    v_mfma_f32_16x16x32_bf16 v[52:55], v[228:231], v[132:135], v[52:55]
    ds_read_b64_tr_b16 v[246:247], v5 offset:10016
    s_waitcnt lgkmcnt(6)
    v_mfma_f32_16x16x32_bf16 v[56:59], v[232:235], v[128:131], v[56:59]
    v_mfma_f32_16x16x32_bf16 v[60:63], v[232:235], v[132:135], v[60:63]
    s_barrier
    ds_read_b64_tr_b16 v[224:225], v4 offset:16384
    ds_read_b64_tr_b16 v[226:227], v4 offset:17408
    s_waitcnt lgkmcnt(6)
    v_mfma_f32_16x16x32_bf16 v[64:67], v[236:239], v[128:131], v[64:67]
    ds_read_b64_tr_b16 v[228:229], v5 offset:16416
    v_mfma_f32_16x16x32_bf16 v[68:71], v[236:239], v[132:135], v[68:71]
    s_add_u32 s22, s19, 0x480000
    s_add_u32 m0, s20, 0x20000
    s_nop 0
    buffer_load_dwordx4 v3, s[4:7], s22 offen lds
    ds_read_b64_tr_b16 v[230:231], v5 offset:17440
    s_mov_b32 s23, 0xb800
    buffer_load_dwordx4 v[116:119], v7, s[8:11], s23 offen offset:1024 sc1
    s_waitcnt lgkmcnt(6)
    v_mfma_f32_16x16x32_bf16 v[72:75], v[240:243], v[128:131], v[72:75]
    ds_read_b64_tr_b16 v[232:233], v4 offset:16640
    v_mfma_f32_16x16x32_bf16 v[76:79], v[240:243], v[132:135], v[76:79]
    ds_read_b64_tr_b16 v[234:235], v4 offset:17664
    s_waitcnt lgkmcnt(6)
    v_mfma_f32_16x16x32_bf16 v[80:83], v[244:247], v[128:131], v[80:83]
    ds_read_b64_tr_b16 v[236:237], v5 offset:16672
    v_mfma_f32_16x16x32_bf16 v[84:87], v[244:247], v[132:135], v[84:87]
    ds_read_b64_tr_b16 v[238:239], v5 offset:17696
    s_waitcnt vmcnt(10) lgkmcnt(6)
    v_mfma_f32_16x16x32_bf16 v[24:27], v[224:227], v[88:91], v[24:27]
    ds_read_b64_tr_b16 v[240:241], v4 offset:16896
    s_waitcnt vmcnt(9)
    v_mfma_f32_16x16x32_bf16 v[28:31], v[224:227], v[92:95], v[28:31]
    ds_read_b64_tr_b16 v[242:243], v4 offset:17920
    s_waitcnt lgkmcnt(6)
    v_mfma_f32_16x16x32_bf16 v[32:35], v[228:231], v[88:91], v[32:35]
    ds_read_b64_tr_b16 v[244:245], v5 offset:16928
    v_mfma_f32_16x16x32_bf16 v[36:39], v[228:231], v[92:95], v[36:39]
    s_add_u32 s22, s19, 0x488000
    s_add_u32 m0, s20, 0x20400
    s_nop 0
    buffer_load_dwordx4 v3, s[4:7], s22 offen lds
    ds_read_b64_tr_b16 v[246:247], v5 offset:17952
    s_mov_b32 s23, 0x4000
    buffer_load_dwordx4 v[120:123], v7, s[8:11], s23 offen offset:0 sc1
    s_waitcnt lgkmcnt(6)
    v_mfma_f32_16x16x32_bf16 v[40:43], v[232:235], v[88:91], v[40:43]
    ds_read_b64_tr_b16 v[224:225], v4 offset:17152
    v_mfma_f32_16x16x32_bf16 v[44:47], v[232:235], v[92:95], v[44:47]
    ds_read_b64_tr_b16 v[226:227], v4 offset:18176
    s_waitcnt lgkmcnt(6)
    v_mfma_f32_16x16x32_bf16 v[48:51], v[236:239], v[88:91], v[48:51]
    ds_read_b64_tr_b16 v[228:229], v5 offset:17184
    v_mfma_f32_16x16x32_bf16 v[52:55], v[236:239], v[92:95], v[52:55]
    ds_read_b64_tr_b16 v[230:231], v5 offset:18208
    s_waitcnt lgkmcnt(6)
    v_mfma_f32_16x16x32_bf16 v[56:59], v[240:243], v[88:91], v[56:59]
    ds_read_b64_tr_b16 v[232:233], v4 offset:24576
    v_mfma_f32_16x16x32_bf16 v[60:63], v[240:243], v[92:95], v[60:63]
    ds_read_b64_tr_b16 v[234:235], v4 offset:25600
    s_waitcnt lgkmcnt(6)
    v_mfma_f32_16x16x32_bf16 v[64:67], v[244:247], v[88:91], v[64:67]
    ds_read_b64_tr_b16 v[236:237], v5 offset:24608
    v_mfma_f32_16x16x32_bf16 v[68:71], v[244:247], v[92:95], v[68:71]
    ds_read_b64_tr_b16 v[238:239], v5 offset:25632
    s_mov_b32 s23, 0xc000
    buffer_load_dwordx4 v[124:127], v7, s[8:11], s23 offen offset:0 sc1
    s_waitcnt lgkmcnt(6)
    v_mfma_f32_16x16x32_bf16 v[72:75], v[224:227], v[88:91], v[72:75]
    ds_read_b64_tr_b16 v[240:241], v4 offset:24832
    v_lshrrev_b32 v21, 4, v1
    v_lshlrev_b32 v21, 9, v21
    v_and_b32 v20, 15, v1
    v_lshl_add_u32 v21, v20, 4, v21
    s_lshr_b32 s18, s12, 3
    s_lshl_b32 s18, s18, 11
    s_add_u32 s18, s18, 0x528100
    buffer_load_dwordx4 v[12:15], v21, s[8:11], s18 offen sc1
    v_mfma_f32_16x16x32_bf16 v[76:79], v[224:227], v[92:95], v[76:79]
    ds_read_b64_tr_b16 v[242:243], v4 offset:25856
    s_waitcnt lgkmcnt(6)
    v_mfma_f32_16x16x32_bf16 v[80:83], v[228:231], v[88:91], v[80:83]
    ds_read_b64_tr_b16 v[244:245], v5 offset:24864
    v_mfma_f32_16x16x32_bf16 v[84:87], v[228:231], v[92:95], v[84:87]
    ds_read_b64_tr_b16 v[246:247], v5 offset:25888
    s_waitcnt vmcnt(12) lgkmcnt(6)
    v_mfma_f32_16x16x32_bf16 v[24:27], v[232:235], v[96:99], v[24:27]
    ds_read_b64_tr_b16 v[224:225], v4 offset:25088
    s_waitcnt vmcnt(10)
    v_mfma_f32_16x16x32_bf16 v[28:31], v[232:235], v[100:103], v[28:31]
    ds_read_b64_tr_b16 v[226:227], v4 offset:26112
    s_waitcnt lgkmcnt(6)
    v_mfma_f32_16x16x32_bf16 v[32:35], v[236:239], v[96:99], v[32:35]
    ds_read_b64_tr_b16 v[228:229], v5 offset:25120
    v_mfma_f32_16x16x32_bf16 v[36:39], v[236:239], v[100:103], v[36:39]
    ds_read_b64_tr_b16 v[230:231], v5 offset:26144
    s_mov_b32 s23, 0x4000
    buffer_load_dwordx4 v[128:131], v7, s[8:11], s23 offen offset:1024 sc1
    s_waitcnt lgkmcnt(6)
    v_mfma_f32_16x16x32_bf16 v[40:43], v[240:243], v[96:99], v[40:43]
    ds_read_b64_tr_b16 v[232:233], v4 offset:25344
    v_mfma_f32_16x16x32_bf16 v[44:47], v[240:243], v[100:103], v[44:47]
    ds_read_b64_tr_b16 v[234:235], v4 offset:26368
    s_waitcnt lgkmcnt(6)
    v_mfma_f32_16x16x32_bf16 v[48:51], v[244:247], v[96:99], v[48:51]
    ds_read_b64_tr_b16 v[236:237], v5 offset:25376
    v_mfma_f32_16x16x32_bf16 v[52:55], v[244:247], v[100:103], v[52:55]
    ds_read_b64_tr_b16 v[238:239], v5 offset:26400
    s_waitcnt lgkmcnt(6)
    v_mfma_f32_16x16x32_bf16 v[56:59], v[224:227], v[96:99], v[56:59]
    v_mfma_f32_16x16x32_bf16 v[60:63], v[224:227], v[100:103], v[60:63]
    s_barrier
    ds_read_b64_tr_b16 v[240:241], v4 offset:32768
    ds_read_b64_tr_b16 v[242:243], v4 offset:33792
    s_waitcnt lgkmcnt(6)
    v_mfma_f32_16x16x32_bf16 v[64:67], v[228:231], v[96:99], v[64:67]
    ds_read_b64_tr_b16 v[244:245], v5 offset:32800
    v_mfma_f32_16x16x32_bf16 v[68:71], v[228:231], v[100:103], v[68:71]
    s_add_u32 s22, s19, 0x500000
    s_add_u32 m0, s20, 0x0
    s_nop 0
    buffer_load_dwordx4 v3, s[4:7], s22 offen lds
    ds_read_b64_tr_b16 v[246:247], v5 offset:33824
    s_mov_b32 s23, 0xc000
    buffer_load_dwordx4 v[132:135], v7, s[8:11], s23 offen offset:1024 sc1
    s_waitcnt lgkmcnt(6)
    v_mfma_f32_16x16x32_bf16 v[72:75], v[232:235], v[96:99], v[72:75]
    ds_read_b64_tr_b16 v[224:225], v4 offset:33024
    v_mfma_f32_16x16x32_bf16 v[76:79], v[232:235], v[100:103], v[76:79]
    ds_read_b64_tr_b16 v[226:227], v4 offset:34048
    s_waitcnt lgkmcnt(6)
    v_mfma_f32_16x16x32_bf16 v[80:83], v[236:239], v[96:99], v[80:83]
    ds_read_b64_tr_b16 v[228:229], v5 offset:33056
    v_mfma_f32_16x16x32_bf16 v[84:87], v[236:239], v[100:103], v[84:87]
    ds_read_b64_tr_b16 v[230:231], v5 offset:34080
    s_waitcnt vmcnt(11) lgkmcnt(6)
    v_mfma_f32_16x16x32_bf16 v[24:27], v[240:243], v[104:107], v[24:27]
    ds_read_b64_tr_b16 v[232:233], v4 offset:33280
    s_waitcnt vmcnt(10)
    v_mfma_f32_16x16x32_bf16 v[28:31], v[240:243], v[108:111], v[28:31]
    ds_read_b64_tr_b16 v[234:235], v4 offset:34304
    s_waitcnt lgkmcnt(6)
    v_mfma_f32_16x16x32_bf16 v[32:35], v[244:247], v[104:107], v[32:35]
    ds_read_b64_tr_b16 v[236:237], v5 offset:33312
    v_mfma_f32_16x16x32_bf16 v[36:39], v[244:247], v[108:111], v[36:39]
    s_add_u32 s22, s19, 0x508000
    s_add_u32 m0, s20, 0x400
    s_nop 0
    buffer_load_dwordx4 v3, s[4:7], s22 offen lds
    ds_read_b64_tr_b16 v[238:239], v5 offset:34336
    s_mov_b32 s23, 0x4800
    buffer_load_dwordx4 v[88:91], v7, s[8:11], s23 offen offset:0 sc1
    s_waitcnt lgkmcnt(6)
    v_mfma_f32_16x16x32_bf16 v[40:43], v[224:227], v[104:107], v[40:43]
    ds_read_b64_tr_b16 v[240:241], v4 offset:33536
    v_mfma_f32_16x16x32_bf16 v[44:47], v[224:227], v[108:111], v[44:47]
    ds_read_b64_tr_b16 v[242:243], v4 offset:34560
    s_waitcnt lgkmcnt(6)
    v_mfma_f32_16x16x32_bf16 v[48:51], v[228:231], v[104:107], v[48:51]
    ds_read_b64_tr_b16 v[244:245], v5 offset:33568
    v_mfma_f32_16x16x32_bf16 v[52:55], v[228:231], v[108:111], v[52:55]
    ds_read_b64_tr_b16 v[246:247], v5 offset:34592
    s_waitcnt lgkmcnt(6)
    v_mfma_f32_16x16x32_bf16 v[56:59], v[232:235], v[104:107], v[56:59]
    ds_read_b64_tr_b16 v[224:225], v4 offset:40960
    v_mfma_f32_16x16x32_bf16 v[60:63], v[232:235], v[108:111], v[60:63]
    ds_read_b64_tr_b16 v[226:227], v4 offset:41984
    s_waitcnt lgkmcnt(6)
    v_mfma_f32_16x16x32_bf16 v[64:67], v[236:239], v[104:107], v[64:67]
    ds_read_b64_tr_b16 v[228:229], v5 offset:40992
    v_mfma_f32_16x16x32_bf16 v[68:71], v[236:239], v[108:111], v[68:71]
    ds_read_b64_tr_b16 v[230:231], v5 offset:42016
    s_mov_b32 s23, 0xc800
    buffer_load_dwordx4 v[92:95], v7, s[8:11], s23 offen offset:0 sc1
    s_waitcnt lgkmcnt(6)
    v_mfma_f32_16x16x32_bf16 v[72:75], v[240:243], v[104:107], v[72:75]
    ds_read_b64_tr_b16 v[232:233], v4 offset:41216
    v_mfma_f32_16x16x32_bf16 v[76:79], v[240:243], v[108:111], v[76:79]
    ds_read_b64_tr_b16 v[234:235], v4 offset:42240
    s_waitcnt lgkmcnt(6)
    v_mfma_f32_16x16x32_bf16 v[80:83], v[244:247], v[104:107], v[80:83]
    ds_read_b64_tr_b16 v[236:237], v5 offset:41248
    v_mfma_f32_16x16x32_bf16 v[84:87], v[244:247], v[108:111], v[84:87]
    ds_read_b64_tr_b16 v[238:239], v5 offset:42272
    s_waitcnt vmcnt(12) lgkmcnt(6)
    v_mfma_f32_16x16x32_bf16 v[24:27], v[224:227], v[112:115], v[24:27]
    ds_read_b64_tr_b16 v[240:241], v4 offset:41472
    s_waitcnt vmcnt(10)
    v_mfma_f32_16x16x32_bf16 v[28:31], v[224:227], v[116:119], v[28:31]
    ds_read_b64_tr_b16 v[242:243], v4 offset:42496
    s_waitcnt lgkmcnt(6)
    v_mfma_f32_16x16x32_bf16 v[32:35], v[228:231], v[112:115], v[32:35]
    ds_read_b64_tr_b16 v[244:245], v5 offset:41504
    v_mfma_f32_16x16x32_bf16 v[36:39], v[228:231], v[116:119], v[36:39]
    ds_read_b64_tr_b16 v[246:247], v5 offset:42528
    s_mov_b32 s23, 0x4800
    buffer_load_dwordx4 v[96:99], v7, s[8:11], s23 offen offset:1024 sc1
    s_waitcnt lgkmcnt(6)
    v_mfma_f32_16x16x32_bf16 v[40:43], v[232:235], v[112:115], v[40:43]
    ds_read_b64_tr_b16 v[224:225], v4 offset:41728
    v_mfma_f32_16x16x32_bf16 v[44:47], v[232:235], v[116:119], v[44:47]
    ds_read_b64_tr_b16 v[226:227], v4 offset:42752
    s_waitcnt lgkmcnt(6)
    v_mfma_f32_16x16x32_bf16 v[48:51], v[236:239], v[112:115], v[48:51]
    ds_read_b64_tr_b16 v[228:229], v5 offset:41760
    v_mfma_f32_16x16x32_bf16 v[52:55], v[236:239], v[116:119], v[52:55]
    ds_read_b64_tr_b16 v[230:231], v5 offset:42784
    s_waitcnt lgkmcnt(6)
    v_mfma_f32_16x16x32_bf16 v[56:59], v[240:243], v[112:115], v[56:59]
    v_mfma_f32_16x16x32_bf16 v[60:63], v[240:243], v[116:119], v[60:63]
    s_barrier
    ds_read_b64_tr_b16 v[232:233], v4 offset:49152
    ds_read_b64_tr_b16 v[234:235], v4 offset:50176
    s_waitcnt lgkmcnt(6)
    v_mfma_f32_16x16x32_bf16 v[64:67], v[244:247], v[112:115], v[64:67]
    ds_read_b64_tr_b16 v[236:237], v5 offset:49184
    v_mfma_f32_16x16x32_bf16 v[68:71], v[244:247], v[116:119], v[68:71]
    s_add_u32 s22, s19, 0x580000
    s_add_u32 m0, s20, 0x4000
    s_nop 0
    buffer_load_dwordx4 v3, s[4:7], s22 offen lds
    ds_read_b64_tr_b16 v[238:239], v5 offset:50208
    s_mov_b32 s23, 0xc800
    buffer_load_dwordx4 v[100:103], v7, s[8:11], s23 offen offset:1024 sc1
    s_waitcnt lgkmcnt(6)
    v_mfma_f32_16x16x32_bf16 v[72:75], v[224:227], v[112:115], v[72:75]
    ds_read_b64_tr_b16 v[240:241], v4 offset:49408
    v_mfma_f32_16x16x32_bf16 v[76:79], v[224:227], v[116:119], v[76:79]
    ds_read_b64_tr_b16 v[242:243], v4 offset:50432
    s_waitcnt lgkmcnt(6)
    v_mfma_f32_16x16x32_bf16 v[80:83], v[228:231], v[112:115], v[80:83]
    ds_read_b64_tr_b16 v[244:245], v5 offset:49440
    v_mfma_f32_16x16x32_bf16 v[84:87], v[228:231], v[116:119], v[84:87]
    ds_read_b64_tr_b16 v[246:247], v5 offset:50464
    s_waitcnt vmcnt(11) lgkmcnt(6)
    v_mfma_f32_16x16x32_bf16 v[24:27], v[232:235], v[120:123], v[24:27]
    ds_read_b64_tr_b16 v[224:225], v4 offset:49664
    s_waitcnt vmcnt(10)
    v_mfma_f32_16x16x32_bf16 v[28:31], v[232:235], v[124:127], v[28:31]
    ds_read_b64_tr_b16 v[226:227], v4 offset:50688
    s_waitcnt lgkmcnt(6)
    v_mfma_f32_16x16x32_bf16 v[32:35], v[236:239], v[120:123], v[32:35]
    ds_read_b64_tr_b16 v[228:229], v5 offset:49696
    v_mfma_f32_16x16x32_bf16 v[36:39], v[236:239], v[124:127], v[36:39]
    s_add_u32 s22, s19, 0x588000
    s_add_u32 m0, s20, 0x4400
    s_nop 0
    buffer_load_dwordx4 v3, s[4:7], s22 offen lds
    ds_read_b64_tr_b16 v[230:231], v5 offset:50720
    s_mov_b32 s23, 0x5000
    buffer_load_dwordx4 v[104:107], v7, s[8:11], s23 offen offset:0 sc1
    s_waitcnt lgkmcnt(6)
    v_mfma_f32_16x16x32_bf16 v[40:43], v[240:243], v[120:123], v[40:43]
    ds_read_b64_tr_b16 v[232:233], v4 offset:49920
    v_mfma_f32_16x16x32_bf16 v[44:47], v[240:243], v[124:127], v[44:47]
    ds_read_b64_tr_b16 v[234:235], v4 offset:50944
    s_waitcnt lgkmcnt(6)
    v_mfma_f32_16x16x32_bf16 v[48:51], v[244:247], v[120:123], v[48:51]
    ds_read_b64_tr_b16 v[236:237], v5 offset:49952
    v_mfma_f32_16x16x32_bf16 v[52:55], v[244:247], v[124:127], v[52:55]
    ds_read_b64_tr_b16 v[238:239], v5 offset:50976
    s_waitcnt lgkmcnt(6)
    v_mfma_f32_16x16x32_bf16 v[56:59], v[224:227], v[120:123], v[56:59]
    ds_read_b64_tr_b16 v[240:241], v4 offset:57344
    v_mfma_f32_16x16x32_bf16 v[60:63], v[224:227], v[124:127], v[60:63]
    ds_read_b64_tr_b16 v[242:243], v4 offset:58368
    s_waitcnt lgkmcnt(6)
    v_mfma_f32_16x16x32_bf16 v[64:67], v[228:231], v[120:123], v[64:67]
    ds_read_b64_tr_b16 v[244:245], v5 offset:57376
    v_mfma_f32_16x16x32_bf16 v[68:71], v[228:231], v[124:127], v[68:71]
    ds_read_b64_tr_b16 v[246:247], v5 offset:58400
    s_mov_b32 s23, 0xd000
    buffer_load_dwordx4 v[108:111], v7, s[8:11], s23 offen offset:0 sc1
    s_waitcnt lgkmcnt(6)
    v_mfma_f32_16x16x32_bf16 v[72:75], v[232:235], v[120:123], v[72:75]
    ds_read_b64_tr_b16 v[224:225], v4 offset:57600
    v_mfma_f32_16x16x32_bf16 v[76:79], v[232:235], v[124:127], v[76:79]
    ds_read_b64_tr_b16 v[226:227], v4 offset:58624
    s_waitcnt lgkmcnt(6)
    v_mfma_f32_16x16x32_bf16 v[80:83], v[236:239], v[120:123], v[80:83]
    ds_read_b64_tr_b16 v[228:229], v5 offset:57632
    v_mfma_f32_16x16x32_bf16 v[84:87], v[236:239], v[124:127], v[84:87]
    ds_read_b64_tr_b16 v[230:231], v5 offset:58656
    s_waitcnt vmcnt(11) lgkmcnt(6)
    v_mfma_f32_16x16x32_bf16 v[24:27], v[240:243], v[128:131], v[24:27]
    ds_read_b64_tr_b16 v[232:233], v4 offset:57856
    s_waitcnt vmcnt(9)
    v_mfma_f32_16x16x32_bf16 v[28:31], v[240:243], v[132:135], v[28:31]
    ds_read_b64_tr_b16 v[234:235], v4 offset:58880
    s_waitcnt lgkmcnt(6)
    v_mfma_f32_16x16x32_bf16 v[32:35], v[244:247], v[128:131], v[32:35]
    ds_read_b64_tr_b16 v[236:237], v5 offset:57888
    v_mfma_f32_16x16x32_bf16 v[36:39], v[244:247], v[132:135], v[36:39]
    ds_read_b64_tr_b16 v[238:239], v5 offset:58912
    s_mov_b32 s23, 0x5000
    buffer_load_dwordx4 v[112:115], v7, s[8:11], s23 offen offset:1024 sc1
    s_waitcnt lgkmcnt(6)
    v_mfma_f32_16x16x32_bf16 v[40:43], v[224:227], v[128:131], v[40:43]
    ds_read_b64_tr_b16 v[240:241], v4 offset:58112
    v_mfma_f32_16x16x32_bf16 v[44:47], v[224:227], v[132:135], v[44:47]
    ds_read_b64_tr_b16 v[242:243], v4 offset:59136
    s_waitcnt lgkmcnt(6)
    v_mfma_f32_16x16x32_bf16 v[48:51], v[228:231], v[128:131], v[48:51]
    ds_read_b64_tr_b16 v[244:245], v5 offset:58144
    v_mfma_f32_16x16x32_bf16 v[52:55], v[228:231], v[132:135], v[52:55]
    ds_read_b64_tr_b16 v[246:247], v5 offset:59168
    s_waitcnt lgkmcnt(6)
    v_mfma_f32_16x16x32_bf16 v[56:59], v[232:235], v[128:131], v[56:59]
    v_mfma_f32_16x16x32_bf16 v[60:63], v[232:235], v[132:135], v[60:63]
    s_barrier
    ds_read_b64_tr_b16 v[224:225], v11 offset:0
    ds_read_b64_tr_b16 v[226:227], v11 offset:1024
    s_waitcnt lgkmcnt(6)
    v_mfma_f32_16x16x32_bf16 v[64:67], v[236:239], v[128:131], v[64:67]
    ds_read_b64_tr_b16 v[228:229], v6 offset:32
    v_mfma_f32_16x16x32_bf16 v[68:71], v[236:239], v[132:135], v[68:71]
    s_add_u32 s22, s19, 0x600000
    s_add_u32 m0, s20, 0x8000
    s_nop 0
    buffer_load_dwordx4 v3, s[4:7], s22 offen lds
    ds_read_b64_tr_b16 v[230:231], v6 offset:1056
    s_mov_b32 s23, 0xd000
    buffer_load_dwordx4 v[116:119], v7, s[8:11], s23 offen offset:1024 sc1
    s_waitcnt lgkmcnt(6)
    v_mfma_f32_16x16x32_bf16 v[72:75], v[240:243], v[128:131], v[72:75]
    ds_read_b64_tr_b16 v[232:233], v11 offset:256
    v_mfma_f32_16x16x32_bf16 v[76:79], v[240:243], v[132:135], v[76:79]
    ds_read_b64_tr_b16 v[234:235], v11 offset:1280
    s_waitcnt lgkmcnt(6)
    v_mfma_f32_16x16x32_bf16 v[80:83], v[244:247], v[128:131], v[80:83]
    ds_read_b64_tr_b16 v[236:237], v6 offset:288
    v_mfma_f32_16x16x32_bf16 v[84:87], v[244:247], v[132:135], v[84:87]
    ds_read_b64_tr_b16 v[238:239], v6 offset:1312
    s_waitcnt vmcnt(10) lgkmcnt(6)
    v_mfma_f32_16x16x32_bf16 v[24:27], v[224:227], v[88:91], v[24:27]
    ds_read_b64_tr_b16 v[240:241], v11 offset:512
    s_waitcnt vmcnt(9)
    v_mfma_f32_16x16x32_bf16 v[28:31], v[224:227], v[92:95], v[28:31]
    ds_read_b64_tr_b16 v[242:243], v11 offset:1536
    s_waitcnt lgkmcnt(6)
    v_mfma_f32_16x16x32_bf16 v[32:35], v[228:231], v[88:91], v[32:35]
    ds_read_b64_tr_b16 v[244:245], v6 offset:544
    v_mfma_f32_16x16x32_bf16 v[36:39], v[228:231], v[92:95], v[36:39]
    s_add_u32 s22, s19, 0x608000
    s_add_u32 m0, s20, 0x8400
    s_nop 0
    buffer_load_dwordx4 v3, s[4:7], s22 offen lds
    ds_read_b64_tr_b16 v[246:247], v6 offset:1568
    s_mov_b32 s23, 0x5800
    buffer_load_dwordx4 v[120:123], v7, s[8:11], s23 offen offset:0 sc1
    s_waitcnt lgkmcnt(6)
    v_mfma_f32_16x16x32_bf16 v[40:43], v[232:235], v[88:91], v[40:43]
    ds_read_b64_tr_b16 v[224:225], v11 offset:768
    v_mfma_f32_16x16x32_bf16 v[44:47], v[232:235], v[92:95], v[44:47]
    ds_read_b64_tr_b16 v[226:227], v11 offset:1792
    s_waitcnt lgkmcnt(6)
    v_mfma_f32_16x16x32_bf16 v[48:51], v[236:239], v[88:91], v[48:51]
    ds_read_b64_tr_b16 v[228:229], v6 offset:800
    v_mfma_f32_16x16x32_bf16 v[52:55], v[236:239], v[92:95], v[52:55]
    ds_read_b64_tr_b16 v[230:231], v6 offset:1824
    s_waitcnt lgkmcnt(6)
    v_mfma_f32_16x16x32_bf16 v[56:59], v[240:243], v[88:91], v[56:59]
    ds_read_b64_tr_b16 v[232:233], v11 offset:8192
    v_mfma_f32_16x16x32_bf16 v[60:63], v[240:243], v[92:95], v[60:63]
    ds_read_b64_tr_b16 v[234:235], v11 offset:9216
    s_waitcnt lgkmcnt(6)
    v_mfma_f32_16x16x32_bf16 v[64:67], v[244:247], v[88:91], v[64:67]
    ds_read_b64_tr_b16 v[236:237], v6 offset:8224
    v_mfma_f32_16x16x32_bf16 v[68:71], v[244:247], v[92:95], v[68:71]
    ds_read_b64_tr_b16 v[238:239], v6 offset:9248
    s_mov_b32 s23, 0xd800
    buffer_load_dwordx4 v[124:127], v7, s[8:11], s23 offen offset:0 sc1
    s_waitcnt lgkmcnt(6)
    v_mfma_f32_16x16x32_bf16 v[72:75], v[224:227], v[88:91], v[72:75]
    ds_read_b64_tr_b16 v[240:241], v11 offset:8448
    v_xor_b32 v8, s28, v12
    v_xor_b32 v20, s28, v13
    v_or_b32 v8, v8, v20
    v_xor_b32 v20, s28, v14
    v_or_b32 v8, v8, v20
    v_xor_b32 v20, s28, v15
    v_or_b32 v8, v8, v20
    v_cmp_ne_u32 vcc, 0, v8
    s_cbranch_vccnz adaLN_cond__sliding_block_cached__moe_arch_mod__prompt_kernel_kv4r
adaLN_cond__sliding_block_cached__moe_arch_mod__prompt_kernel_kv4b:
    v_mfma_f32_16x16x32_bf16 v[76:79], v[224:227], v[92:95], v[76:79]
    ds_read_b64_tr_b16 v[242:243], v11 offset:9472
    v_mov_b32 v20, 0
    s_mov_b32 s16, 0x564000
    buffer_load_dword v8, v20, s[8:11], s16 offen sc1
    s_waitcnt lgkmcnt(6)
    v_mfma_f32_16x16x32_bf16 v[80:83], v[228:231], v[88:91], v[80:83]
    ds_read_b64_tr_b16 v[244:245], v6 offset:8480
    v_mfma_f32_16x16x32_bf16 v[84:87], v[228:231], v[92:95], v[84:87]
    ds_read_b64_tr_b16 v[246:247], v6 offset:9504
    s_waitcnt vmcnt(12) lgkmcnt(6)
    v_mfma_f32_16x16x32_bf16 v[24:27], v[232:235], v[96:99], v[24:27]
    ds_read_b64_tr_b16 v[224:225], v11 offset:8704
    s_waitcnt vmcnt(10)
    v_mfma_f32_16x16x32_bf16 v[28:31], v[232:235], v[100:103], v[28:31]
    ds_read_b64_tr_b16 v[226:227], v11 offset:9728
    s_waitcnt lgkmcnt(6)
    v_mfma_f32_16x16x32_bf16 v[32:35], v[236:239], v[96:99], v[32:35]
    ds_read_b64_tr_b16 v[228:229], v6 offset:8736
    v_mfma_f32_16x16x32_bf16 v[36:39], v[236:239], v[100:103], v[36:39]
    ds_read_b64_tr_b16 v[230:231], v6 offset:9760
    s_mov_b32 s23, 0x5800
    buffer_load_dwordx4 v[128:131], v7, s[8:11], s23 offen offset:1024 sc1
    s_waitcnt lgkmcnt(6)
    v_mfma_f32_16x16x32_bf16 v[40:43], v[240:243], v[96:99], v[40:43]
    ds_read_b64_tr_b16 v[232:233], v11 offset:8960
    v_mfma_f32_16x16x32_bf16 v[44:47], v[240:243], v[100:103], v[44:47]
    ds_read_b64_tr_b16 v[234:235], v11 offset:9984
    s_waitcnt lgkmcnt(6)
    v_mfma_f32_16x16x32_bf16 v[48:51], v[244:247], v[96:99], v[48:51]
    ds_read_b64_tr_b16 v[236:237], v6 offset:8992
    v_mfma_f32_16x16x32_bf16 v[52:55], v[244:247], v[100:103], v[52:55]
    ds_read_b64_tr_b16 v[238:239], v6 offset:10016
    s_waitcnt lgkmcnt(6)
    v_mfma_f32_16x16x32_bf16 v[56:59], v[224:227], v[96:99], v[56:59]
    v_mfma_f32_16x16x32_bf16 v[60:63], v[224:227], v[100:103], v[60:63]
    s_barrier
    ds_read_b64_tr_b16 v[240:241], v4 offset:0
    ds_read_b64_tr_b16 v[242:243], v4 offset:1024
    s_waitcnt lgkmcnt(6)
    v_mfma_f32_16x16x32_bf16 v[64:67], v[228:231], v[96:99], v[64:67]
    ds_read_b64_tr_b16 v[244:245], v5 offset:32
    v_mfma_f32_16x16x32_bf16 v[68:71], v[228:231], v[100:103], v[68:71]
    s_add_u32 s22, s19, 0x680000
    s_add_u32 m0, s20, 0xc000
    s_nop 0
    buffer_load_dwordx4 v3, s[4:7], s22 offen lds
    ds_read_b64_tr_b16 v[246:247], v5 offset:1056
    s_mov_b32 s23, 0xd800
    buffer_load_dwordx4 v[132:135], v7, s[8:11], s23 offen offset:1024 sc1
    s_waitcnt lgkmcnt(6)
    v_mfma_f32_16x16x32_bf16 v[72:75], v[232:235], v[96:99], v[72:75]
    ds_read_b64_tr_b16 v[224:225], v4 offset:256
    v_mfma_f32_16x16x32_bf16 v[76:79], v[232:235], v[100:103], v[76:79]
    ds_read_b64_tr_b16 v[226:227], v4 offset:1280
    s_waitcnt lgkmcnt(6)
    v_mfma_f32_16x16x32_bf16 v[80:83], v[236:239], v[96:99], v[80:83]
    ds_read_b64_tr_b16 v[228:229], v5 offset:288
    v_mfma_f32_16x16x32_bf16 v[84:87], v[236:239], v[100:103], v[84:87]
    ds_read_b64_tr_b16 v[230:231], v5 offset:1312
    s_waitcnt vmcnt(11) lgkmcnt(6)
    v_mfma_f32_16x16x32_bf16 v[24:27], v[240:243], v[104:107], v[24:27]
    ds_read_b64_tr_b16 v[232:233], v4 offset:512
    s_waitcnt vmcnt(10)
    v_mfma_f32_16x16x32_bf16 v[28:31], v[240:243], v[108:111], v[28:31]
    ds_read_b64_tr_b16 v[234:235], v4 offset:1536
    s_waitcnt lgkmcnt(6)
    v_mfma_f32_16x16x32_bf16 v[32:35], v[244:247], v[104:107], v[32:35]
    ds_read_b64_tr_b16 v[236:237], v5 offset:544
    v_mfma_f32_16x16x32_bf16 v[36:39], v[244:247], v[108:111], v[36:39]
    s_add_u32 s22, s19, 0x688000
    s_add_u32 m0, s20, 0xc400
    s_nop 0
    buffer_load_dwordx4 v3, s[4:7], s22 offen lds
    ds_read_b64_tr_b16 v[238:239], v5 offset:1568
    s_mov_b32 s23, 0x6000
    buffer_load_dwordx4 v[88:91], v7, s[8:11], s23 offen offset:0 sc1
    s_waitcnt lgkmcnt(6)
    v_mfma_f32_16x16x32_bf16 v[40:43], v[224:227], v[104:107], v[40:43]
    ds_read_b64_tr_b16 v[240:241], v4 offset:768
    v_mfma_f32_16x16x32_bf16 v[44:47], v[224:227], v[108:111], v[44:47]
    ds_read_b64_tr_b16 v[242:243], v4 offset:1792
    s_waitcnt lgkmcnt(6)
    v_mfma_f32_16x16x32_bf16 v[48:51], v[228:231], v[104:107], v[48:51]
    ds_read_b64_tr_b16 v[244:245], v5 offset:800
    v_mfma_f32_16x16x32_bf16 v[52:55], v[228:231], v[108:111], v[52:55]
    ds_read_b64_tr_b16 v[246:247], v5 offset:1824
    s_waitcnt lgkmcnt(6)
    v_mfma_f32_16x16x32_bf16 v[56:59], v[232:235], v[104:107], v[56:59]
    ds_read_b64_tr_b16 v[224:225], v4 offset:8192
    v_mfma_f32_16x16x32_bf16 v[60:63], v[232:235], v[108:111], v[60:63]
    ds_read_b64_tr_b16 v[226:227], v4 offset:9216
    s_waitcnt lgkmcnt(6)
    v_mfma_f32_16x16x32_bf16 v[64:67], v[236:239], v[104:107], v[64:67]
    ds_read_b64_tr_b16 v[228:229], v5 offset:8224
    v_mfma_f32_16x16x32_bf16 v[68:71], v[236:239], v[108:111], v[68:71]
    ds_read_b64_tr_b16 v[230:231], v5 offset:9248
    s_mov_b32 s23, 0xe000
    buffer_load_dwordx4 v[92:95], v7, s[8:11], s23 offen offset:0 sc1
    s_waitcnt lgkmcnt(6)
    v_mfma_f32_16x16x32_bf16 v[72:75], v[240:243], v[104:107], v[72:75]
    ds_read_b64_tr_b16 v[232:233], v4 offset:8448
    v_mfma_f32_16x16x32_bf16 v[76:79], v[240:243], v[108:111], v[76:79]
    ds_read_b64_tr_b16 v[234:235], v4 offset:9472
    s_waitcnt lgkmcnt(6)
    v_mfma_f32_16x16x32_bf16 v[80:83], v[244:247], v[104:107], v[80:83]
    ds_read_b64_tr_b16 v[236:237], v5 offset:8480
    v_mfma_f32_16x16x32_bf16 v[84:87], v[244:247], v[108:111], v[84:87]
    ds_read_b64_tr_b16 v[238:239], v5 offset:9504
    s_waitcnt vmcnt(12) lgkmcnt(6)
    v_mfma_f32_16x16x32_bf16 v[24:27], v[224:227], v[112:115], v[24:27]
    ds_read_b64_tr_b16 v[240:241], v4 offset:8704
    s_add_u32 s22, s21, 0x0
    s_add_u32 m0, s20, 0x10000
    s_nop 0
    buffer_load_dwordx4 v2, s[8:11], s22 offen sc1 lds
    s_waitcnt vmcnt(11)
    v_mfma_f32_16x16x32_bf16 v[28:31], v[224:227], v[116:119], v[28:31]
    ds_read_b64_tr_b16 v[242:243], v4 offset:9728
    s_waitcnt lgkmcnt(6)
    v_mfma_f32_16x16x32_bf16 v[32:35], v[228:231], v[112:115], v[32:35]
    ds_read_b64_tr_b16 v[244:245], v5 offset:8736
    v_mfma_f32_16x16x32_bf16 v[36:39], v[228:231], v[116:119], v[36:39]
    ds_read_b64_tr_b16 v[246:247], v5 offset:9760
    s_mov_b32 s23, 0x6000
    buffer_load_dwordx4 v[96:99], v7, s[8:11], s23 offen offset:1024 sc1
    s_waitcnt lgkmcnt(6)
    v_mfma_f32_16x16x32_bf16 v[40:43], v[232:235], v[112:115], v[40:43]
    ds_read_b64_tr_b16 v[224:225], v4 offset:8960
    s_add_u32 s22, s21, 0x400
    s_add_u32 m0, s20, 0x10400
    s_nop 0
    buffer_load_dwordx4 v2, s[8:11], s22 offen sc1 lds
    v_mfma_f32_16x16x32_bf16 v[44:47], v[232:235], v[116:119], v[44:47]
    ds_read_b64_tr_b16 v[226:227], v4 offset:9984
    s_waitcnt lgkmcnt(6)
    v_mfma_f32_16x16x32_bf16 v[48:51], v[236:239], v[112:115], v[48:51]
    ds_read_b64_tr_b16 v[228:229], v5 offset:8992
    v_mfma_f32_16x16x32_bf16 v[52:55], v[236:239], v[116:119], v[52:55]
    ds_read_b64_tr_b16 v[230:231], v5 offset:10016
    s_waitcnt lgkmcnt(6)
    v_mfma_f32_16x16x32_bf16 v[56:59], v[240:243], v[112:115], v[56:59]
    v_mfma_f32_16x16x32_bf16 v[60:63], v[240:243], v[116:119], v[60:63]
    s_barrier
    ds_read_b64_tr_b16 v[232:233], v4 offset:16384
    ds_read_b64_tr_b16 v[234:235], v4 offset:17408
    s_waitcnt lgkmcnt(6)
    v_mfma_f32_16x16x32_bf16 v[64:67], v[244:247], v[112:115], v[64:67]
    ds_read_b64_tr_b16 v[236:237], v5 offset:16416
    v_mfma_f32_16x16x32_bf16 v[68:71], v[244:247], v[116:119], v[68:71]
    s_add_u32 s22, s19, 0x700000
    s_add_u32 m0, s20, 0x20000
    s_nop 0
    buffer_load_dwordx4 v3, s[4:7], s22 offen lds
    ds_read_b64_tr_b16 v[238:239], v5 offset:17440
    s_mov_b32 s23, 0xe000
    buffer_load_dwordx4 v[100:103], v7, s[8:11], s23 offen offset:1024 sc1
    s_waitcnt lgkmcnt(6)
    v_mfma_f32_16x16x32_bf16 v[72:75], v[224:227], v[112:115], v[72:75]
    ds_read_b64_tr_b16 v[240:241], v4 offset:16640
    v_mfma_f32_16x16x32_bf16 v[76:79], v[224:227], v[116:119], v[76:79]
    ds_read_b64_tr_b16 v[242:243], v4 offset:17664
    s_waitcnt lgkmcnt(6)
    v_mfma_f32_16x16x32_bf16 v[80:83], v[228:231], v[112:115], v[80:83]
    ds_read_b64_tr_b16 v[244:245], v5 offset:16672
    v_mfma_f32_16x16x32_bf16 v[84:87], v[228:231], v[116:119], v[84:87]
    ds_read_b64_tr_b16 v[246:247], v5 offset:17696
    s_waitcnt vmcnt(13) lgkmcnt(6)
    v_mfma_f32_16x16x32_bf16 v[24:27], v[232:235], v[120:123], v[24:27]
    ds_read_b64_tr_b16 v[224:225], v4 offset:16896
    s_waitcnt vmcnt(12)
    v_mfma_f32_16x16x32_bf16 v[28:31], v[232:235], v[124:127], v[28:31]
    ds_read_b64_tr_b16 v[226:227], v4 offset:17920
    s_waitcnt lgkmcnt(6)
    v_mfma_f32_16x16x32_bf16 v[32:35], v[236:239], v[120:123], v[32:35]
    ds_read_b64_tr_b16 v[228:229], v5 offset:16928
    v_mfma_f32_16x16x32_bf16 v[36:39], v[236:239], v[124:127], v[36:39]
    s_add_u32 s22, s19, 0x708000
    s_add_u32 m0, s20, 0x20400
    s_nop 0
    buffer_load_dwordx4 v3, s[4:7], s22 offen lds
    ds_read_b64_tr_b16 v[230:231], v5 offset:17952
    s_mov_b32 s23, 0x6800
    buffer_load_dwordx4 v[104:107], v7, s[8:11], s23 offen offset:0 sc1
    s_waitcnt lgkmcnt(6)
    v_mfma_f32_16x16x32_bf16 v[40:43], v[240:243], v[120:123], v[40:43]
    ds_read_b64_tr_b16 v[232:233], v4 offset:17152
    v_mfma_f32_16x16x32_bf16 v[44:47], v[240:243], v[124:127], v[44:47]
    ds_read_b64_tr_b16 v[234:235], v4 offset:18176
    s_waitcnt lgkmcnt(6)
    v_mfma_f32_16x16x32_bf16 v[48:51], v[244:247], v[120:123], v[48:51]
    ds_read_b64_tr_b16 v[236:237], v5 offset:17184
    v_mfma_f32_16x16x32_bf16 v[52:55], v[244:247], v[124:127], v[52:55]
    ds_read_b64_tr_b16 v[238:239], v5 offset:18208
    s_waitcnt lgkmcnt(6)
    v_mfma_f32_16x16x32_bf16 v[56:59], v[224:227], v[120:123], v[56:59]
    ds_read_b64_tr_b16 v[240:241], v4 offset:24576
    v_mfma_f32_16x16x32_bf16 v[60:63], v[224:227], v[124:127], v[60:63]
    ds_read_b64_tr_b16 v[242:243], v4 offset:25600
    s_waitcnt lgkmcnt(6)
    v_mfma_f32_16x16x32_bf16 v[64:67], v[228:231], v[120:123], v[64:67]
    ds_read_b64_tr_b16 v[244:245], v5 offset:24608
    v_mfma_f32_16x16x32_bf16 v[68:71], v[228:231], v[124:127], v[68:71]
    ds_read_b64_tr_b16 v[246:247], v5 offset:25632
    s_mov_b32 s23, 0xe800
    buffer_load_dwordx4 v[108:111], v7, s[8:11], s23 offen offset:0 sc1
    s_waitcnt lgkmcnt(6)
    v_mfma_f32_16x16x32_bf16 v[72:75], v[232:235], v[120:123], v[72:75]
    ds_read_b64_tr_b16 v[224:225], v4 offset:24832
    v_mfma_f32_16x16x32_bf16 v[76:79], v[232:235], v[124:127], v[76:79]
    ds_read_b64_tr_b16 v[226:227], v4 offset:25856
    s_waitcnt lgkmcnt(6)
    v_mfma_f32_16x16x32_bf16 v[80:83], v[236:239], v[120:123], v[80:83]
    ds_read_b64_tr_b16 v[228:229], v5 offset:24864
    v_mfma_f32_16x16x32_bf16 v[84:87], v[236:239], v[124:127], v[84:87]
    ds_read_b64_tr_b16 v[230:231], v5 offset:25888
    s_waitcnt vmcnt(13) lgkmcnt(6)
    v_mfma_f32_16x16x32_bf16 v[24:27], v[240:243], v[128:131], v[24:27]
    ds_read_b64_tr_b16 v[232:233], v4 offset:25088
    s_add_u32 s22, s21, 0x4000
    s_add_u32 m0, s20, 0x14000
    s_nop 0
    buffer_load_dwordx4 v2, s[8:11], s22 offen sc1 lds
    s_waitcnt vmcnt(12)
    v_mfma_f32_16x16x32_bf16 v[28:31], v[240:243], v[132:135], v[28:31]
    ds_read_b64_tr_b16 v[234:235], v4 offset:26112
    s_waitcnt lgkmcnt(6)
    v_mfma_f32_16x16x32_bf16 v[32:35], v[244:247], v[128:131], v[32:35]
    ds_read_b64_tr_b16 v[236:237], v5 offset:25120
    v_mfma_f32_16x16x32_bf16 v[36:39], v[244:247], v[132:135], v[36:39]
    ds_read_b64_tr_b16 v[238:239], v5 offset:26144
    s_mov_b32 s23, 0x6800
    buffer_load_dwordx4 v[112:115], v7, s[8:11], s23 offen offset:1024 sc1
    s_waitcnt lgkmcnt(6)
    v_mfma_f32_16x16x32_bf16 v[40:43], v[224:227], v[128:131], v[40:43]
    ds_read_b64_tr_b16 v[240:241], v4 offset:25344
    s_add_u32 s22, s21, 0x4400
    s_add_u32 m0, s20, 0x14400
    s_nop 0
    buffer_load_dwordx4 v2, s[8:11], s22 offen sc1 lds
    v_mfma_f32_16x16x32_bf16 v[44:47], v[224:227], v[132:135], v[44:47]
    ds_read_b64_tr_b16 v[242:243], v4 offset:26368
    s_waitcnt lgkmcnt(6)
    v_mfma_f32_16x16x32_bf16 v[48:51], v[228:231], v[128:131], v[48:51]
    ds_read_b64_tr_b16 v[244:245], v5 offset:25376
    v_mfma_f32_16x16x32_bf16 v[52:55], v[228:231], v[132:135], v[52:55]
    ds_read_b64_tr_b16 v[246:247], v5 offset:26400
    s_waitcnt lgkmcnt(6)
    v_mfma_f32_16x16x32_bf16 v[56:59], v[232:235], v[128:131], v[56:59]
    v_mfma_f32_16x16x32_bf16 v[60:63], v[232:235], v[132:135], v[60:63]
    s_barrier
    ds_read_b64_tr_b16 v[224:225], v4 offset:32768
    ds_read_b64_tr_b16 v[226:227], v4 offset:33792
    s_waitcnt lgkmcnt(6)
    v_mfma_f32_16x16x32_bf16 v[64:67], v[236:239], v[128:131], v[64:67]
    ds_read_b64_tr_b16 v[228:229], v5 offset:32800
    v_mfma_f32_16x16x32_bf16 v[68:71], v[236:239], v[132:135], v[68:71]
    s_add_u32 s22, s19, 0x780000
    s_add_u32 m0, s20, 0x0
    s_nop 0
    buffer_load_dwordx4 v3, s[4:7], s22 offen lds
    ds_read_b64_tr_b16 v[230:231], v5 offset:33824
    s_mov_b32 s23, 0xe800
    buffer_load_dwordx4 v[116:119], v7, s[8:11], s23 offen offset:1024 sc1
    s_waitcnt lgkmcnt(6)
    v_mfma_f32_16x16x32_bf16 v[72:75], v[240:243], v[128:131], v[72:75]
    ds_read_b64_tr_b16 v[232:233], v4 offset:33024
    v_mfma_f32_16x16x32_bf16 v[76:79], v[240:243], v[132:135], v[76:79]
    ds_read_b64_tr_b16 v[234:235], v4 offset:34048
    s_waitcnt lgkmcnt(6)
    v_mfma_f32_16x16x32_bf16 v[80:83], v[244:247], v[128:131], v[80:83]
    ds_read_b64_tr_b16 v[236:237], v5 offset:33056
    v_mfma_f32_16x16x32_bf16 v[84:87], v[244:247], v[132:135], v[84:87]
    ds_read_b64_tr_b16 v[238:239], v5 offset:34080
    s_waitcnt vmcnt(14) lgkmcnt(6)
    v_mfma_f32_16x16x32_bf16 v[24:27], v[224:227], v[88:91], v[24:27]
    ds_read_b64_tr_b16 v[240:241], v4 offset:33280
    s_waitcnt vmcnt(13)
    v_mfma_f32_16x16x32_bf16 v[28:31], v[224:227], v[92:95], v[28:31]
    ds_read_b64_tr_b16 v[242:243], v4 offset:34304
    s_waitcnt lgkmcnt(6)
    v_mfma_f32_16x16x32_bf16 v[32:35], v[228:231], v[88:91], v[32:35]
    ds_read_b64_tr_b16 v[244:245], v5 offset:33312
    v_mfma_f32_16x16x32_bf16 v[36:39], v[228:231], v[92:95], v[36:39]
    s_add_u32 s22, s19, 0x788000
    s_add_u32 m0, s20, 0x400
    s_nop 0
    buffer_load_dwordx4 v3, s[4:7], s22 offen lds
    ds_read_b64_tr_b16 v[246:247], v5 offset:34336
    s_mov_b32 s23, 0x7000
    buffer_load_dwordx4 v[120:123], v7, s[8:11], s23 offen offset:0 sc1
    s_waitcnt lgkmcnt(6)
    v_mfma_f32_16x16x32_bf16 v[40:43], v[232:235], v[88:91], v[40:43]
    ds_read_b64_tr_b16 v[224:225], v4 offset:33536
    v_mfma_f32_16x16x32_bf16 v[44:47], v[232:235], v[92:95], v[44:47]
    ds_read_b64_tr_b16 v[226:227], v4 offset:34560
    s_waitcnt lgkmcnt(6)
    v_mfma_f32_16x16x32_bf16 v[48:51], v[236:239], v[88:91], v[48:51]
    ds_read_b64_tr_b16 v[228:229], v5 offset:33568
    v_mfma_f32_16x16x32_bf16 v[52:55], v[236:239], v[92:95], v[52:55]
    ds_read_b64_tr_b16 v[230:231], v5 offset:34592
    s_waitcnt lgkmcnt(6)
    v_mfma_f32_16x16x32_bf16 v[56:59], v[240:243], v[88:91], v[56:59]
    ds_read_b64_tr_b16 v[232:233], v4 offset:40960
    v_mfma_f32_16x16x32_bf16 v[60:63], v[240:243], v[92:95], v[60:63]
    ds_read_b64_tr_b16 v[234:235], v4 offset:41984
    s_waitcnt lgkmcnt(6)
    v_mfma_f32_16x16x32_bf16 v[64:67], v[244:247], v[88:91], v[64:67]
    ds_read_b64_tr_b16 v[236:237], v5 offset:40992
    v_mfma_f32_16x16x32_bf16 v[68:71], v[244:247], v[92:95], v[68:71]
    ds_read_b64_tr_b16 v[238:239], v5 offset:42016
    s_mov_b32 s23, 0xf000
    buffer_load_dwordx4 v[124:127], v7, s[8:11], s23 offen offset:0 sc1
    s_waitcnt lgkmcnt(6)
    v_mfma_f32_16x16x32_bf16 v[72:75], v[224:227], v[88:91], v[72:75]
    ds_read_b64_tr_b16 v[240:241], v4 offset:41216
    v_mfma_f32_16x16x32_bf16 v[76:79], v[224:227], v[92:95], v[76:79]
    ds_read_b64_tr_b16 v[242:243], v4 offset:42240
    s_waitcnt lgkmcnt(6)
    v_mfma_f32_16x16x32_bf16 v[80:83], v[228:231], v[88:91], v[80:83]
    ds_read_b64_tr_b16 v[244:245], v5 offset:41248
    v_mfma_f32_16x16x32_bf16 v[84:87], v[228:231], v[92:95], v[84:87]
    ds_read_b64_tr_b16 v[246:247], v5 offset:42272
    s_waitcnt vmcnt(14) lgkmcnt(6)
    v_mfma_f32_16x16x32_bf16 v[24:27], v[232:235], v[96:99], v[24:27]
    ds_read_b64_tr_b16 v[224:225], v4 offset:41472
    s_add_u32 s22, s21, 0x8000
    s_add_u32 m0, s20, 0x18000
    s_nop 0
    buffer_load_dwordx4 v2, s[8:11], s22 offen sc1 lds
    s_waitcnt vmcnt(12)
    v_mfma_f32_16x16x32_bf16 v[28:31], v[232:235], v[100:103], v[28:31]
    ds_read_b64_tr_b16 v[226:227], v4 offset:42496
    s_waitcnt lgkmcnt(6)
    v_mfma_f32_16x16x32_bf16 v[32:35], v[236:239], v[96:99], v[32:35]
    ds_read_b64_tr_b16 v[228:229], v5 offset:41504
    v_mfma_f32_16x16x32_bf16 v[36:39], v[236:239], v[100:103], v[36:39]
    ds_read_b64_tr_b16 v[230:231], v5 offset:42528
    s_mov_b32 s23, 0x7000
    buffer_load_dwordx4 v[128:131], v7, s[8:11], s23 offen offset:1024 sc1
    s_waitcnt lgkmcnt(6)
    v_mfma_f32_16x16x32_bf16 v[40:43], v[240:243], v[96:99], v[40:43]
    ds_read_b64_tr_b16 v[232:233], v4 offset:41728
    s_add_u32 s22, s21, 0x8400
    s_add_u32 m0, s20, 0x18400
    s_nop 0
    buffer_load_dwordx4 v2, s[8:11], s22 offen sc1 lds
    v_mfma_f32_16x16x32_bf16 v[44:47], v[240:243], v[100:103], v[44:47]
    ds_read_b64_tr_b16 v[234:235], v4 offset:42752
    s_waitcnt lgkmcnt(6)
    v_mfma_f32_16x16x32_bf16 v[48:51], v[244:247], v[96:99], v[48:51]
    ds_read_b64_tr_b16 v[236:237], v5 offset:41760
    v_mfma_f32_16x16x32_bf16 v[52:55], v[244:247], v[100:103], v[52:55]
    ds_read_b64_tr_b16 v[238:239], v5 offset:42784
    s_waitcnt lgkmcnt(6)
    v_mfma_f32_16x16x32_bf16 v[56:59], v[224:227], v[96:99], v[56:59]
    v_mfma_f32_16x16x32_bf16 v[60:63], v[224:227], v[100:103], v[60:63]
    s_barrier
    ds_read_b64_tr_b16 v[240:241], v4 offset:49152
    ds_read_b64_tr_b16 v[242:243], v4 offset:50176
    s_waitcnt lgkmcnt(6)
    v_mfma_f32_16x16x32_bf16 v[64:67], v[228:231], v[96:99], v[64:67]
    ds_read_b64_tr_b16 v[244:245], v5 offset:49184
    v_mfma_f32_16x16x32_bf16 v[68:71], v[228:231], v[100:103], v[68:71]
    ds_read_b64_tr_b16 v[246:247], v5 offset:50208
    s_mov_b32 s23, 0xf000
    buffer_load_dwordx4 v[132:135], v7, s[8:11], s23 offen offset:1024 sc1
    s_waitcnt lgkmcnt(6)
    v_mfma_f32_16x16x32_bf16 v[72:75], v[232:235], v[96:99], v[72:75]
    ds_read_b64_tr_b16 v[224:225], v4 offset:49408
    v_mfma_f32_16x16x32_bf16 v[76:79], v[232:235], v[100:103], v[76:79]
    ds_read_b64_tr_b16 v[226:227], v4 offset:50432
    s_waitcnt lgkmcnt(6)
    v_mfma_f32_16x16x32_bf16 v[80:83], v[236:239], v[96:99], v[80:83]
    ds_read_b64_tr_b16 v[228:229], v5 offset:49440
    v_mfma_f32_16x16x32_bf16 v[84:87], v[236:239], v[100:103], v[84:87]
    ds_read_b64_tr_b16 v[230:231], v5 offset:50464
    s_waitcnt vmcnt(13) lgkmcnt(6)
    v_mfma_f32_16x16x32_bf16 v[24:27], v[240:243], v[104:107], v[24:27]
    ds_read_b64_tr_b16 v[232:233], v4 offset:49664
    s_waitcnt vmcnt(12)
    v_mfma_f32_16x16x32_bf16 v[28:31], v[240:243], v[108:111], v[28:31]
    ds_read_b64_tr_b16 v[234:235], v4 offset:50688
    s_waitcnt lgkmcnt(6)
    v_mfma_f32_16x16x32_bf16 v[32:35], v[244:247], v[104:107], v[32:35]
    ds_read_b64_tr_b16 v[236:237], v5 offset:49696
    v_mfma_f32_16x16x32_bf16 v[36:39], v[244:247], v[108:111], v[36:39]
    ds_read_b64_tr_b16 v[238:239], v5 offset:50720
    s_mov_b32 s23, 0x7800
    buffer_load_dwordx4 v[88:91], v7, s[8:11], s23 offen offset:0 sc1
    s_waitcnt lgkmcnt(6)
    v_mfma_f32_16x16x32_bf16 v[40:43], v[224:227], v[104:107], v[40:43]
    ds_read_b64_tr_b16 v[240:241], v4 offset:49920
    v_mfma_f32_16x16x32_bf16 v[44:47], v[224:227], v[108:111], v[44:47]
    ds_read_b64_tr_b16 v[242:243], v4 offset:50944
    s_waitcnt lgkmcnt(6)
    v_mfma_f32_16x16x32_bf16 v[48:51], v[228:231], v[104:107], v[48:51]
    ds_read_b64_tr_b16 v[244:245], v5 offset:49952
    v_mfma_f32_16x16x32_bf16 v[52:55], v[228:231], v[108:111], v[52:55]
    ds_read_b64_tr_b16 v[246:247], v5 offset:50976
    s_waitcnt lgkmcnt(6)
    v_mfma_f32_16x16x32_bf16 v[56:59], v[232:235], v[104:107], v[56:59]
    ds_read_b64_tr_b16 v[224:225], v4 offset:57344
    v_mfma_f32_16x16x32_bf16 v[60:63], v[232:235], v[108:111], v[60:63]
    ds_read_b64_tr_b16 v[226:227], v4 offset:58368
    s_waitcnt lgkmcnt(6)
    v_mfma_f32_16x16x32_bf16 v[64:67], v[236:239], v[104:107], v[64:67]
    ds_read_b64_tr_b16 v[228:229], v5 offset:57376
    v_mfma_f32_16x16x32_bf16 v[68:71], v[236:239], v[108:111], v[68:71]
    ds_read_b64_tr_b16 v[230:231], v5 offset:58400
    s_mov_b32 s23, 0xf800
    buffer_load_dwordx4 v[92:95], v7, s[8:11], s23 offen offset:0 sc1
    s_waitcnt lgkmcnt(6)
    v_mfma_f32_16x16x32_bf16 v[72:75], v[240:243], v[104:107], v[72:75]
    ds_read_b64_tr_b16 v[232:233], v4 offset:57600
    v_mfma_f32_16x16x32_bf16 v[76:79], v[240:243], v[108:111], v[76:79]
    ds_read_b64_tr_b16 v[234:235], v4 offset:58624
    s_waitcnt lgkmcnt(6)
    v_mfma_f32_16x16x32_bf16 v[80:83], v[244:247], v[104:107], v[80:83]
    ds_read_b64_tr_b16 v[236:237], v5 offset:57632
    v_mfma_f32_16x16x32_bf16 v[84:87], v[244:247], v[108:111], v[84:87]
    ds_read_b64_tr_b16 v[238:239], v5 offset:58656
    s_waitcnt vmcnt(12) lgkmcnt(6)
    v_mfma_f32_16x16x32_bf16 v[24:27], v[224:227], v[112:115], v[24:27]
    ds_read_b64_tr_b16 v[240:241], v4 offset:57856
    s_add_u32 s22, s21, 0xc000
    s_add_u32 m0, s20, 0x1c000
    s_nop 0
    buffer_load_dwordx4 v2, s[8:11], s22 offen sc1 lds
    s_waitcnt vmcnt(10)
    v_mfma_f32_16x16x32_bf16 v[28:31], v[224:227], v[116:119], v[28:31]
    ds_read_b64_tr_b16 v[242:243], v4 offset:58880
    s_waitcnt lgkmcnt(6)
    v_mfma_f32_16x16x32_bf16 v[32:35], v[228:231], v[112:115], v[32:35]
    ds_read_b64_tr_b16 v[244:245], v5 offset:57888
    v_mfma_f32_16x16x32_bf16 v[36:39], v[228:231], v[116:119], v[36:39]
    ds_read_b64_tr_b16 v[246:247], v5 offset:58912
    s_mov_b32 s23, 0x7800
    buffer_load_dwordx4 v[96:99], v7, s[8:11], s23 offen offset:1024 sc1
    s_waitcnt lgkmcnt(6)
    v_mfma_f32_16x16x32_bf16 v[40:43], v[232:235], v[112:115], v[40:43]
    ds_read_b64_tr_b16 v[224:225], v4 offset:58112
    s_add_u32 s22, s21, 0xc400
    s_add_u32 m0, s20, 0x1c400
    s_nop 0
    buffer_load_dwordx4 v2, s[8:11], s22 offen sc1 lds
    v_mfma_f32_16x16x32_bf16 v[44:47], v[232:235], v[116:119], v[44:47]
    ds_read_b64_tr_b16 v[226:227], v4 offset:59136
    s_waitcnt lgkmcnt(6)
    v_mfma_f32_16x16x32_bf16 v[48:51], v[236:239], v[112:115], v[48:51]
    ds_read_b64_tr_b16 v[228:229], v5 offset:58144
    v_mfma_f32_16x16x32_bf16 v[52:55], v[236:239], v[116:119], v[52:55]
    ds_read_b64_tr_b16 v[230:231], v5 offset:59168
    s_waitcnt lgkmcnt(6)
    v_mfma_f32_16x16x32_bf16 v[56:59], v[240:243], v[112:115], v[56:59]
    v_mfma_f32_16x16x32_bf16 v[60:63], v[240:243], v[116:119], v[60:63]
    s_barrier
    ds_read_b64_tr_b16 v[232:233], v11 offset:0
    ds_read_b64_tr_b16 v[234:235], v11 offset:1024
    s_waitcnt lgkmcnt(6)
    v_mfma_f32_16x16x32_bf16 v[64:67], v[244:247], v[112:115], v[64:67]
    ds_read_b64_tr_b16 v[236:237], v6 offset:32
    v_mfma_f32_16x16x32_bf16 v[68:71], v[244:247], v[116:119], v[68:71]
    ds_read_b64_tr_b16 v[238:239], v6 offset:1056
    s_mov_b32 s23, 0xf800
    buffer_load_dwordx4 v[100:103], v7, s[8:11], s23 offen offset:1024 sc1
    s_waitcnt lgkmcnt(6)
    v_mfma_f32_16x16x32_bf16 v[72:75], v[224:227], v[112:115], v[72:75]
    ds_read_b64_tr_b16 v[240:241], v11 offset:256
    v_mfma_f32_16x16x32_bf16 v[76:79], v[224:227], v[116:119], v[76:79]
    ds_read_b64_tr_b16 v[242:243], v11 offset:1280
    s_waitcnt lgkmcnt(6)
    v_mfma_f32_16x16x32_bf16 v[80:83], v[228:231], v[112:115], v[80:83]
    ds_read_b64_tr_b16 v[244:245], v6 offset:288
    v_mfma_f32_16x16x32_bf16 v[84:87], v[228:231], v[116:119], v[84:87]
    ds_read_b64_tr_b16 v[246:247], v6 offset:1312
    s_waitcnt vmcnt(11) lgkmcnt(6)
    v_mfma_f32_16x16x32_bf16 v[24:27], v[232:235], v[120:123], v[24:27]
    ds_read_b64_tr_b16 v[224:225], v11 offset:512
    s_waitcnt vmcnt(10)
    v_mfma_f32_16x16x32_bf16 v[28:31], v[232:235], v[124:127], v[28:31]
    ds_read_b64_tr_b16 v[226:227], v11 offset:1536
    s_waitcnt lgkmcnt(6)
    v_mfma_f32_16x16x32_bf16 v[32:35], v[236:239], v[120:123], v[32:35]
    ds_read_b64_tr_b16 v[228:229], v6 offset:544
    v_mfma_f32_16x16x32_bf16 v[36:39], v[236:239], v[124:127], v[36:39]
    ds_read_b64_tr_b16 v[230:231], v6 offset:1568
    s_waitcnt lgkmcnt(6)
    v_mfma_f32_16x16x32_bf16 v[40:43], v[240:243], v[120:123], v[40:43]
    ds_read_b64_tr_b16 v[232:233], v11 offset:768
    v_mfma_f32_16x16x32_bf16 v[44:47], v[240:243], v[124:127], v[44:47]
    ds_read_b64_tr_b16 v[234:235], v11 offset:1792
    s_waitcnt lgkmcnt(6)
    v_mfma_f32_16x16x32_bf16 v[48:51], v[244:247], v[120:123], v[48:51]
    ds_read_b64_tr_b16 v[236:237], v6 offset:800
    v_mfma_f32_16x16x32_bf16 v[52:55], v[244:247], v[124:127], v[52:55]
    ds_read_b64_tr_b16 v[238:239], v6 offset:1824
    s_waitcnt lgkmcnt(6)
    v_mfma_f32_16x16x32_bf16 v[56:59], v[224:227], v[120:123], v[56:59]
    ds_read_b64_tr_b16 v[240:241], v11 offset:8192
    v_mfma_f32_16x16x32_bf16 v[60:63], v[224:227], v[124:127], v[60:63]
    ds_read_b64_tr_b16 v[242:243], v11 offset:9216
    s_waitcnt lgkmcnt(6)
    v_mfma_f32_16x16x32_bf16 v[64:67], v[228:231], v[120:123], v[64:67]
    ds_read_b64_tr_b16 v[244:245], v6 offset:8224
    v_mfma_f32_16x16x32_bf16 v[68:71], v[228:231], v[124:127], v[68:71]
    ds_read_b64_tr_b16 v[246:247], v6 offset:9248
    s_waitcnt lgkmcnt(6)
    v_mfma_f32_16x16x32_bf16 v[72:75], v[232:235], v[120:123], v[72:75]
    ds_read_b64_tr_b16 v[224:225], v11 offset:8448
    v_mfma_f32_16x16x32_bf16 v[76:79], v[232:235], v[124:127], v[76:79]
    ds_read_b64_tr_b16 v[226:227], v11 offset:9472
    s_waitcnt lgkmcnt(6)
    v_mfma_f32_16x16x32_bf16 v[80:83], v[236:239], v[120:123], v[80:83]
    ds_read_b64_tr_b16 v[228:229], v6 offset:8480
    v_mfma_f32_16x16x32_bf16 v[84:87], v[236:239], v[124:127], v[84:87]
    ds_read_b64_tr_b16 v[230:231], v6 offset:9504
    s_waitcnt vmcnt(8) lgkmcnt(6)
    v_mfma_f32_16x16x32_bf16 v[24:27], v[240:243], v[128:131], v[24:27]
    ds_read_b64_tr_b16 v[232:233], v11 offset:8704
    s_waitcnt vmcnt(6)
    v_mfma_f32_16x16x32_bf16 v[28:31], v[240:243], v[132:135], v[28:31]
    ds_read_b64_tr_b16 v[234:235], v11 offset:9728
    s_waitcnt lgkmcnt(6)
    v_mfma_f32_16x16x32_bf16 v[32:35], v[244:247], v[128:131], v[32:35]
    ds_read_b64_tr_b16 v[236:237], v6 offset:8736
    v_mfma_f32_16x16x32_bf16 v[36:39], v[244:247], v[132:135], v[36:39]
    ds_read_b64_tr_b16 v[238:239], v6 offset:9760
    s_waitcnt lgkmcnt(6)
    v_mfma_f32_16x16x32_bf16 v[40:43], v[224:227], v[128:131], v[40:43]
    ds_read_b64_tr_b16 v[240:241], v11 offset:8960
    v_mfma_f32_16x16x32_bf16 v[44:47], v[224:227], v[132:135], v[44:47]
    ds_read_b64_tr_b16 v[242:243], v11 offset:9984
    s_waitcnt lgkmcnt(6)
    v_mfma_f32_16x16x32_bf16 v[48:51], v[228:231], v[128:131], v[48:51]
    ds_read_b64_tr_b16 v[244:245], v6 offset:8992
    v_mfma_f32_16x16x32_bf16 v[52:55], v[228:231], v[132:135], v[52:55]
    ds_read_b64_tr_b16 v[246:247], v6 offset:10016
    s_waitcnt lgkmcnt(6)
    v_mfma_f32_16x16x32_bf16 v[56:59], v[232:235], v[128:131], v[56:59]
    v_mfma_f32_16x16x32_bf16 v[60:63], v[232:235], v[132:135], v[60:63]
    s_barrier
    ds_read_b64_tr_b16 v[224:225], v4 offset:0
    ds_read_b64_tr_b16 v[226:227], v4 offset:1024
    s_waitcnt lgkmcnt(6)
    v_mfma_f32_16x16x32_bf16 v[64:67], v[236:239], v[128:131], v[64:67]
    ds_read_b64_tr_b16 v[228:229], v5 offset:32
    v_mfma_f32_16x16x32_bf16 v[68:71], v[236:239], v[132:135], v[68:71]
    ds_read_b64_tr_b16 v[230:231], v5 offset:1056
    s_waitcnt lgkmcnt(6)
    v_mfma_f32_16x16x32_bf16 v[72:75], v[240:243], v[128:131], v[72:75]
    ds_read_b64_tr_b16 v[232:233], v4 offset:256
    v_mfma_f32_16x16x32_bf16 v[76:79], v[240:243], v[132:135], v[76:79]
    ds_read_b64_tr_b16 v[234:235], v4 offset:1280
    s_waitcnt lgkmcnt(6)
    v_mfma_f32_16x16x32_bf16 v[80:83], v[244:247], v[128:131], v[80:83]
    ds_read_b64_tr_b16 v[236:237], v5 offset:288
    v_mfma_f32_16x16x32_bf16 v[84:87], v[244:247], v[132:135], v[84:87]
    ds_read_b64_tr_b16 v[238:239], v5 offset:1312
    s_waitcnt vmcnt(5) lgkmcnt(6)
    v_mfma_f32_16x16x32_bf16 v[24:27], v[224:227], v[88:91], v[24:27]
    ds_read_b64_tr_b16 v[240:241], v4 offset:512
    s_waitcnt vmcnt(4)
    v_mfma_f32_16x16x32_bf16 v[28:31], v[224:227], v[92:95], v[28:31]
    ds_read_b64_tr_b16 v[242:243], v4 offset:1536
    s_waitcnt lgkmcnt(6)
    v_mfma_f32_16x16x32_bf16 v[32:35], v[228:231], v[88:91], v[32:35]
    ds_read_b64_tr_b16 v[244:245], v5 offset:544
    v_mfma_f32_16x16x32_bf16 v[36:39], v[228:231], v[92:95], v[36:39]
    ds_read_b64_tr_b16 v[246:247], v5 offset:1568
    s_waitcnt lgkmcnt(6)
    v_mfma_f32_16x16x32_bf16 v[40:43], v[232:235], v[88:91], v[40:43]
    ds_read_b64_tr_b16 v[224:225], v4 offset:768
    v_mfma_f32_16x16x32_bf16 v[44:47], v[232:235], v[92:95], v[44:47]
    ds_read_b64_tr_b16 v[226:227], v4 offset:1792
    s_waitcnt lgkmcnt(6)
    v_mfma_f32_16x16x32_bf16 v[48:51], v[236:239], v[88:91], v[48:51]
    ds_read_b64_tr_b16 v[228:229], v5 offset:800
    v_mfma_f32_16x16x32_bf16 v[52:55], v[236:239], v[92:95], v[52:55]
    ds_read_b64_tr_b16 v[230:231], v5 offset:1824
    s_waitcnt lgkmcnt(6)
    v_mfma_f32_16x16x32_bf16 v[56:59], v[240:243], v[88:91], v[56:59]
    ds_read_b64_tr_b16 v[232:233], v4 offset:8192
    v_mfma_f32_16x16x32_bf16 v[60:63], v[240:243], v[92:95], v[60:63]
    ds_read_b64_tr_b16 v[234:235], v4 offset:9216
    s_waitcnt lgkmcnt(6)
    v_mfma_f32_16x16x32_bf16 v[64:67], v[244:247], v[88:91], v[64:67]
    ds_read_b64_tr_b16 v[236:237], v5 offset:8224
    v_mfma_f32_16x16x32_bf16 v[68:71], v[244:247], v[92:95], v[68:71]
    ds_read_b64_tr_b16 v[238:239], v5 offset:9248
    s_waitcnt lgkmcnt(6)
    v_mfma_f32_16x16x32_bf16 v[72:75], v[224:227], v[88:91], v[72:75]
    ds_read_b64_tr_b16 v[240:241], v4 offset:8448
    v_mfma_f32_16x16x32_bf16 v[76:79], v[224:227], v[92:95], v[76:79]
    ds_read_b64_tr_b16 v[242:243], v4 offset:9472
    s_waitcnt lgkmcnt(6)
    v_mfma_f32_16x16x32_bf16 v[80:83], v[228:231], v[88:91], v[80:83]
    ds_read_b64_tr_b16 v[244:245], v5 offset:8480
    v_mfma_f32_16x16x32_bf16 v[84:87], v[228:231], v[92:95], v[84:87]
    ds_read_b64_tr_b16 v[246:247], v5 offset:9504
    s_waitcnt vmcnt(2) lgkmcnt(6)
    v_mfma_f32_16x16x32_bf16 v[24:27], v[232:235], v[96:99], v[24:27]
    ds_read_b64_tr_b16 v[224:225], v4 offset:8704
    s_waitcnt vmcnt(0)
    v_mfma_f32_16x16x32_bf16 v[28:31], v[232:235], v[100:103], v[28:31]
    ds_read_b64_tr_b16 v[226:227], v4 offset:9728
    s_waitcnt lgkmcnt(6)
    v_mfma_f32_16x16x32_bf16 v[32:35], v[236:239], v[96:99], v[32:35]
    ds_read_b64_tr_b16 v[228:229], v5 offset:8736
    v_mfma_f32_16x16x32_bf16 v[36:39], v[236:239], v[100:103], v[36:39]
    ds_read_b64_tr_b16 v[230:231], v5 offset:9760
    s_waitcnt lgkmcnt(6)
    v_mfma_f32_16x16x32_bf16 v[40:43], v[240:243], v[96:99], v[40:43]
    ds_read_b64_tr_b16 v[232:233], v4 offset:8960
    v_mfma_f32_16x16x32_bf16 v[44:47], v[240:243], v[100:103], v[44:47]
    ds_read_b64_tr_b16 v[234:235], v4 offset:9984
    s_waitcnt lgkmcnt(6)
    v_mfma_f32_16x16x32_bf16 v[48:51], v[244:247], v[96:99], v[48:51]
    ds_read_b64_tr_b16 v[236:237], v5 offset:8992
    v_mfma_f32_16x16x32_bf16 v[52:55], v[244:247], v[100:103], v[52:55]
    ds_read_b64_tr_b16 v[238:239], v5 offset:10016
    s_waitcnt lgkmcnt(6)
    v_mfma_f32_16x16x32_bf16 v[56:59], v[224:227], v[96:99], v[56:59]
    v_mfma_f32_16x16x32_bf16 v[60:63], v[224:227], v[100:103], v[60:63]
    s_waitcnt lgkmcnt(4)
    v_mfma_f32_16x16x32_bf16 v[64:67], v[228:231], v[96:99], v[64:67]
    v_mfma_f32_16x16x32_bf16 v[68:71], v[228:231], v[100:103], v[68:71]
    s_waitcnt lgkmcnt(2)
    v_mfma_f32_16x16x32_bf16 v[72:75], v[232:235], v[96:99], v[72:75]
    v_mfma_f32_16x16x32_bf16 v[76:79], v[232:235], v[100:103], v[76:79]
    s_waitcnt lgkmcnt(0)
    v_mfma_f32_16x16x32_bf16 v[80:83], v[236:239], v[96:99], v[80:83]
    v_mfma_f32_16x16x32_bf16 v[84:87], v[236:239], v[100:103], v[84:87]
    s_mov_b32 s23, 0x3e0293ee
    v_mul_f32 v16, s23, v24
    v_mul_f32 v17, s23, v25
    v_cvt_pk_bf16_f32 v152, v16, v17
    v_mul_f32 v18, s23, v26
    v_mul_f32 v19, s23, v27
    v_cvt_pk_bf16_f32 v153, v18, v19
    v_mul_f32 v16, s23, v28
    v_mul_f32 v17, s23, v29
    v_cvt_pk_bf16_f32 v168, v16, v17
    v_mul_f32 v18, s23, v30
    v_mul_f32 v19, s23, v31
    v_cvt_pk_bf16_f32 v169, v18, v19
    v_mul_f32 v16, s23, v32
    v_mul_f32 v17, s23, v33
    v_cvt_pk_bf16_f32 v154, v16, v17
    v_mul_f32 v18, s23, v34
    v_mul_f32 v19, s23, v35
    v_cvt_pk_bf16_f32 v155, v18, v19
    v_mul_f32 v16, s23, v36
    v_mul_f32 v17, s23, v37
    v_cvt_pk_bf16_f32 v170, v16, v17
    v_mul_f32 v18, s23, v38
    v_mul_f32 v19, s23, v39
    v_cvt_pk_bf16_f32 v171, v18, v19
    v_mul_f32 v16, s23, v40
    v_mul_f32 v17, s23, v41
    v_cvt_pk_bf16_f32 v156, v16, v17
    v_mul_f32 v18, s23, v42
    v_mul_f32 v19, s23, v43
    v_cvt_pk_bf16_f32 v157, v18, v19
    v_mul_f32 v16, s23, v44
    v_mul_f32 v17, s23, v45
    v_cvt_pk_bf16_f32 v172, v16, v17
    v_mul_f32 v18, s23, v46
    v_mul_f32 v19, s23, v47
    v_cvt_pk_bf16_f32 v173, v18, v19
    v_mul_f32 v16, s23, v48
    v_mul_f32 v17, s23, v49
    v_cvt_pk_bf16_f32 v158, v16, v17
    v_mul_f32 v18, s23, v50
    v_mul_f32 v19, s23, v51
    v_cvt_pk_bf16_f32 v159, v18, v19
    v_mul_f32 v16, s23, v52
    v_mul_f32 v17, s23, v53
    v_cvt_pk_bf16_f32 v174, v16, v17
    v_mul_f32 v18, s23, v54
    v_mul_f32 v19, s23, v55
    v_cvt_pk_bf16_f32 v175, v18, v19
    v_mul_f32 v16, s23, v56
    v_mul_f32 v17, s23, v57
    v_cvt_pk_bf16_f32 v160, v16, v17
    v_mul_f32 v18, s23, v58
    v_mul_f32 v19, s23, v59
    v_cvt_pk_bf16_f32 v161, v18, v19
    v_mul_f32 v16, s23, v60
    v_mul_f32 v17, s23, v61
    v_cvt_pk_bf16_f32 v176, v16, v17
    v_mul_f32 v18, s23, v62
    v_mul_f32 v19, s23, v63
    v_cvt_pk_bf16_f32 v177, v18, v19
    v_mul_f32 v16, s23, v64
    v_mul_f32 v17, s23, v65
    v_cvt_pk_bf16_f32 v162, v16, v17
    v_mul_f32 v18, s23, v66
    v_mul_f32 v19, s23, v67
    v_cvt_pk_bf16_f32 v163, v18, v19
    v_mul_f32 v16, s23, v68
    v_mul_f32 v17, s23, v69
    v_cvt_pk_bf16_f32 v178, v16, v17
    v_mul_f32 v18, s23, v70
    v_mul_f32 v19, s23, v71
    v_cvt_pk_bf16_f32 v179, v18, v19
    v_mul_f32 v16, s23, v72
    v_mul_f32 v17, s23, v73
    v_cvt_pk_bf16_f32 v164, v16, v17
    v_mul_f32 v18, s23, v74
    v_mul_f32 v19, s23, v75
    v_cvt_pk_bf16_f32 v165, v18, v19
    v_mul_f32 v16, s23, v76
    v_mul_f32 v17, s23, v77
    v_cvt_pk_bf16_f32 v180, v16, v17
    v_mul_f32 v18, s23, v78
    v_mul_f32 v19, s23, v79
    v_cvt_pk_bf16_f32 v181, v18, v19
    v_mul_f32 v16, s23, v80
    v_mul_f32 v17, s23, v81
    v_cvt_pk_bf16_f32 v166, v16, v17
    v_mul_f32 v18, s23, v82
    v_mul_f32 v19, s23, v83
    v_cvt_pk_bf16_f32 v167, v18, v19
    v_mul_f32 v16, s23, v84
    v_mul_f32 v17, s23, v85
    v_cvt_pk_bf16_f32 v182, v16, v17
    v_mul_f32 v18, s23, v86
    v_mul_f32 v19, s23, v87
    v_cvt_pk_bf16_f32 v183, v18, v19
    v_add_u32 v4, 0x10000, v2
    v_add_u32 v5, 0x20000, v2
    s_barrier
    ds_read_b128 v[224:227], v4 offset:0
    ds_read_b128 v[228:231], v4 offset:1024
    ds_read_b128 v[232:235], v4 offset:2048
    ds_read_b128 v[236:239], v4 offset:3072
    s_waitcnt lgkmcnt(3)
    v_mfma_f32_16x16x32_bf16 v[184:187], v[224:227], v[152:155], 0
    v_mfma_f32_16x16x32_bf16 v[188:191], v[224:227], v[168:171], 0
    ds_read_b128 v[240:243], v4 offset:4096
    s_and_b32 s29, s2, 7
    s_mul_i32 s29, s29, 28
    s_lshr_b32 s16, s2, 3
    s_add_u32 s29, s29, s16
    s_waitcnt lgkmcnt(3)
    v_mfma_f32_16x16x32_bf16 v[192:195], v[228:231], v[152:155], 0
    s_add_u32 s22, s21, 0x10000
    s_add_u32 m0, s20, 0x20000
    s_nop 0
    buffer_load_dwordx4 v2, s[8:11], s22 offen sc1 lds
    s_mov_b64 s[76:77], s[54:55]
    s_mov_b32 s78, 0xc00000
    s_mov_b32 s79, 0x20000
    v_bfe_u32 v20, v1, 2, 2
    v_lshlrev_b32 v20, 12, v20
    v_add_u32 v6, v3, v20
    s_lshr_b32 s16, s2, 5
    s_lshl_b32 s16, s16, 7
    s_lshl_b32 s17, s3, 3
    s_add_u32 s16, s16, s17
    s_mul_i32 s14, s16, 12288
    s_and_b32 s16, s2, 31
    s_lshl_b32 s16, s16, 8
    s_add_u32 s14, s14, s16
    s_add_u32 s14, s14, 4096
    v_mfma_f32_16x16x32_bf16 v[196:199], v[228:231], v[168:171], 0
    ds_read_b128 v[244:247], v4 offset:5120
    s_waitcnt lgkmcnt(3)
    v_mfma_f32_16x16x32_bf16 v[184:187], v[232:235], v[156:159], v[184:187]
    v_mfma_f32_16x16x32_bf16 v[188:191], v[232:235], v[172:175], v[188:191]
    ds_read_b128 v[224:227], v4 offset:6144
    s_waitcnt lgkmcnt(3)
    v_mfma_f32_16x16x32_bf16 v[192:195], v[236:239], v[156:159], v[192:195]
    v_mfma_f32_16x16x32_bf16 v[196:199], v[236:239], v[172:175], v[196:199]
    ds_read_b128 v[228:231], v4 offset:7168
    s_waitcnt lgkmcnt(3)
    v_mfma_f32_16x16x32_bf16 v[184:187], v[240:243], v[160:163], v[184:187]
    v_mfma_f32_16x16x32_bf16 v[188:191], v[240:243], v[176:179], v[188:191]
    ds_read_b128 v[232:235], v4 offset:8192
    s_waitcnt lgkmcnt(3)
    v_mfma_f32_16x16x32_bf16 v[192:195], v[244:247], v[160:163], v[192:195]
    s_add_u32 s22, s21, 0x10400
    s_add_u32 m0, s20, 0x20400
    s_nop 0
    buffer_load_dwordx4 v2, s[8:11], s22 offen sc1 lds
    v_mfma_f32_16x16x32_bf16 v[196:199], v[244:247], v[176:179], v[196:199]
    ds_read_b128 v[236:239], v4 offset:9216
    s_waitcnt lgkmcnt(3)
    v_mfma_f32_16x16x32_bf16 v[184:187], v[224:227], v[164:167], v[184:187]
    v_mfma_f32_16x16x32_bf16 v[188:191], v[224:227], v[180:183], v[188:191]
    ds_read_b128 v[240:243], v4 offset:10240
    s_waitcnt lgkmcnt(3)
    v_mfma_f32_16x16x32_bf16 v[192:195], v[228:231], v[164:167], v[192:195]
    v_mfma_f32_16x16x32_bf16 v[196:199], v[228:231], v[180:183], v[196:199]
    ds_read_b128 v[244:247], v4 offset:11264
    s_waitcnt lgkmcnt(3)
    v_mfma_f32_16x16x32_bf16 v[200:203], v[232:235], v[152:155], 0
    v_mfma_f32_16x16x32_bf16 v[204:207], v[232:235], v[168:171], 0
    ds_read_b128 v[224:227], v4 offset:12288
    s_waitcnt lgkmcnt(3)
    v_mfma_f32_16x16x32_bf16 v[208:211], v[236:239], v[152:155], 0
    v_mfma_f32_16x16x32_bf16 v[212:215], v[236:239], v[168:171], 0
    ds_read_b128 v[228:231], v4 offset:13312
    s_waitcnt lgkmcnt(3)
    v_mfma_f32_16x16x32_bf16 v[200:203], v[240:243], v[156:159], v[200:203]
    v_mfma_f32_16x16x32_bf16 v[204:207], v[240:243], v[172:175], v[204:207]
    ds_read_b128 v[232:235], v4 offset:14336
    s_waitcnt lgkmcnt(3)
    v_mfma_f32_16x16x32_bf16 v[208:211], v[244:247], v[156:159], v[208:211]
    v_max3_f32 v16, v184, v185, v186
    v_mfma_f32_16x16x32_bf16 v[212:215], v[244:247], v[172:175], v[212:215]
    ds_read_b128 v[236:239], v4 offset:15360
    v_max3_f32 v16, v16, v187, v192
    s_waitcnt lgkmcnt(3)
    v_mfma_f32_16x16x32_bf16 v[200:203], v[224:227], v[160:163], v[200:203]
    v_max3_f32 v16, v16, v193, v194
    v_mfma_f32_16x16x32_bf16 v[204:207], v[224:227], v[176:179], v[204:207]
    s_barrier
    ds_read_b128 v[240:243], v4 offset:16384
    v_max_f32 v16, v16, v195
    s_waitcnt lgkmcnt(3)
    v_mfma_f32_16x16x32_bf16 v[208:211], v[228:231], v[160:163], v[208:211]
    v_max3_f32 v17, v188, v189, v190
    v_mfma_f32_16x16x32_bf16 v[212:215], v[228:231], v[176:179], v[212:215]
    s_add_u32 s22, s21, 0x14000
    s_add_u32 m0, s20, 0x24000
    s_nop 0
    buffer_load_dwordx4 v2, s[8:11], s22 offen sc1 lds
    ds_read_b128 v[244:247], v4 offset:17408
    v_max3_f32 v17, v17, v191, v196
    s_waitcnt lgkmcnt(3)
    v_mfma_f32_16x16x32_bf16 v[200:203], v[232:235], v[164:167], v[200:203]
    v_max3_f32 v17, v17, v197, v198
    v_mfma_f32_16x16x32_bf16 v[204:207], v[232:235], v[180:183], v[204:207]
    ds_read_b128 v[224:227], v4 offset:18432
    v_max_f32 v17, v17, v199
    s_waitcnt lgkmcnt(3)
    v_mfma_f32_16x16x32_bf16 v[208:211], v[236:239], v[164:167], v[208:211]
    v_mfma_f32_16x16x32_bf16 v[212:215], v[236:239], v[180:183], v[212:215]
    ds_read_b128 v[228:231], v4 offset:19456
    v_max3_f32 v16, v16, v200, v201
    v_max3_f32 v16, v16, v202, v203
    s_nop 3
    v_max3_f32 v16, v16, v208, v209
    v_max3_f32 v16, v16, v210, v211
    v_max3_f32 v17, v17, v204, v205
    v_max3_f32 v17, v17, v206, v207
    v_max3_f32 v17, v17, v212, v213
    v_max3_f32 v17, v17, v214, v215
    v_mov_b32 v18, v16
    v_mov_b32 v19, v17
    s_nop 0
    v_permlane16_swap_b32 v16, v18
    v_permlane16_swap_b32 v17, v19
    v_max_f32 v16, v16, v18
    v_max_f32 v17, v17, v19
    v_mov_b32 v18, v16
    v_mov_b32 v19, v17
    s_nop 0
    v_permlane32_swap_b32 v16, v18
    v_permlane32_swap_b32 v17, v19
    v_max_f32 v16, v16, v18
    v_max_f32 v17, v17, v19
    v_sub_f32 v216, 0, v16
    v_sub_f32 v217, 0, v16
    v_sub_f32 v218, 0, v16
    v_sub_f32 v219, 0, v16
    v_sub_f32 v220, 0, v17
    v_sub_f32 v221, 0, v17
    v_sub_f32 v222, 0, v17
    v_sub_f32 v223, 0, v17
    v_add_f32 v184, v184, v216
    v_add_f32 v185, v185, v216
    v_exp_f32 v184, v184
    v_exp_f32 v185, v185
    s_nop 0
    v_add_f32 v9, v184, v185
    v_cvt_pk_bf16_f32 v24, v184, v185
    v_add_f32 v186, v186, v216
    v_add_f32 v187, v187, v216
    v_exp_f32 v186, v186
    v_exp_f32 v187, v187
    v_add_f32 v9, v9, v186
    v_add_f32 v9, v9, v187
    v_cvt_pk_bf16_f32 v25, v186, v187
    v_add_f32 v188, v188, v220
    v_add_f32 v189, v189, v220
    v_exp_f32 v188, v188
    v_exp_f32 v189, v189
    s_nop 0
    v_add_f32 v10, v188, v189
    v_cvt_pk_bf16_f32 v28, v188, v189
    v_add_f32 v190, v190, v220
    v_add_f32 v191, v191, v220
    v_exp_f32 v190, v190
    v_exp_f32 v191, v191
    v_add_f32 v10, v10, v190
    v_add_f32 v10, v10, v191
    v_cvt_pk_bf16_f32 v29, v190, v191
    v_add_f32 v192, v192, v216
    v_add_f32 v193, v193, v216
    v_exp_f32 v192, v192
    v_exp_f32 v193, v193
    v_add_f32 v9, v9, v192
    v_add_f32 v9, v9, v193
    v_cvt_pk_bf16_f32 v26, v192, v193
    v_add_f32 v194, v194, v216
    v_add_f32 v195, v195, v216
    v_exp_f32 v194, v194
    v_exp_f32 v195, v195
    v_add_f32 v9, v9, v194
    v_add_f32 v9, v9, v195
    v_cvt_pk_bf16_f32 v27, v194, v195
    v_add_f32 v196, v196, v220
    v_add_f32 v197, v197, v220
    v_exp_f32 v196, v196
    v_exp_f32 v197, v197
    v_add_f32 v10, v10, v196
    v_add_f32 v10, v10, v197
    v_cvt_pk_bf16_f32 v30, v196, v197
    v_add_f32 v198, v198, v220
    v_add_f32 v199, v199, v220
    v_exp_f32 v198, v198
    v_exp_f32 v199, v199
    v_add_f32 v10, v10, v198
    v_add_f32 v10, v10, v199
    v_cvt_pk_bf16_f32 v31, v198, v199
    s_waitcnt lgkmcnt(3)
    v_mfma_f32_16x16x32_bf16 v[184:187], v[240:243], v[152:155], v[216:219]
    v_mfma_f32_16x16x32_bf16 v[188:191], v[240:243], v[168:171], v[220:223]
    ds_read_b128 v[232:235], v4 offset:20480
    v_add_f32 v200, v200, v216
    v_add_f32 v201, v201, v216
    v_exp_f32 v200, v200
    v_exp_f32 v201, v201
    s_waitcnt lgkmcnt(3)
    v_mfma_f32_16x16x32_bf16 v[192:195], v[244:247], v[152:155], v[216:219]
    v_add_f32 v9, v9, v200
    v_add_f32 v9, v9, v201
    v_cvt_pk_bf16_f32 v32, v200, v201
    v_add_f32 v202, v202, v216
    v_mfma_f32_16x16x32_bf16 v[196:199], v[244:247], v[168:171], v[220:223]
    s_add_u32 s22, s21, 0x14400
    s_add_u32 m0, s20, 0x24400
    s_nop 0
    buffer_load_dwordx4 v2, s[8:11], s22 offen sc1 lds
    ds_read_b128 v[236:239], v4 offset:21504
    v_add_f32 v203, v203, v216
    v_exp_f32 v202, v202
    v_exp_f32 v203, v203
    v_add_f32 v9, v9, v202
    s_waitcnt lgkmcnt(3)
    v_mfma_f32_16x16x32_bf16 v[184:187], v[224:227], v[156:159], v[184:187]
    v_add_f32 v9, v9, v203
    v_cvt_pk_bf16_f32 v33, v202, v203
    v_add_f32 v204, v204, v220
    v_mfma_f32_16x16x32_bf16 v[188:191], v[224:227], v[172:175], v[188:191]
    ds_read_b128 v[240:243], v4 offset:22528
    v_add_f32 v205, v205, v220
    v_exp_f32 v204, v204
    v_exp_f32 v205, v205
    v_add_f32 v10, v10, v204
    s_mov_b64 s[4:5], s[40:41]
    s_mov_b32 s6, 0x800000
    s_mov_b32 s7, 0x20000
    v_bfe_u32 v20, v1, 2, 2
    v_lshlrev_b32 v21, 13, v20
    v_sub_u32 v3, v3, v21
    v_lshl_add_u32 v3, v20, 11, v3
    s_and_b32 s16, s2, 1
    s_lshl_b32 s24, s16, 22
    s_lshr_b32 s16, s2, 5
    s_lshl_b32 s16, s16, 8
    s_add_u32 s24, s24, s16
    s_lshl_b32 s16, s3, 14
    s_add_u32 s24, s24, s16
    s_waitcnt lgkmcnt(3)
    v_mfma_f32_16x16x32_bf16 v[192:195], v[228:231], v[156:159], v[192:195]
    v_add_f32 v10, v10, v205
    v_cvt_pk_bf16_f32 v36, v204, v205
    v_add_f32 v206, v206, v220
    v_add_f32 v207, v207, v220
    v_mfma_f32_16x16x32_bf16 v[196:199], v[228:231], v[172:175], v[196:199]
    ds_read_b128 v[244:247], v4 offset:23552
    v_exp_f32 v206, v206
    v_exp_f32 v207, v207
    v_add_f32 v10, v10, v206
    v_add_f32 v10, v10, v207
    s_waitcnt lgkmcnt(3)
    v_mfma_f32_16x16x32_bf16 v[184:187], v[232:235], v[160:163], v[184:187]
    v_cvt_pk_bf16_f32 v37, v206, v207
    v_add_f32 v208, v208, v216
    v_add_f32 v209, v209, v216
    v_mfma_f32_16x16x32_bf16 v[188:191], v[232:235], v[176:179], v[188:191]
    ds_read_b128 v[224:227], v4 offset:24576
    v_exp_f32 v208, v208
    v_exp_f32 v209, v209
    v_add_f32 v9, v9, v208
    v_add_f32 v9, v9, v209
    s_waitcnt lgkmcnt(3)
    v_mfma_f32_16x16x32_bf16 v[192:195], v[236:239], v[160:163], v[192:195]
    v_cvt_pk_bf16_f32 v34, v208, v209
    v_add_f32 v210, v210, v216
    v_add_f32 v211, v211, v216
    v_exp_f32 v210, v210
    v_mfma_f32_16x16x32_bf16 v[196:199], v[236:239], v[176:179], v[196:199]
    ds_read_b128 v[228:231], v4 offset:25600
    v_exp_f32 v211, v211
    v_add_f32 v9, v9, v210
    v_add_f32 v9, v9, v211
    v_cvt_pk_bf16_f32 v35, v210, v211
    s_waitcnt lgkmcnt(3)
    v_mfma_f32_16x16x32_bf16 v[184:187], v[240:243], v[164:167], v[184:187]
    v_add_f32 v212, v212, v220
    v_add_f32 v213, v213, v220
    v_exp_f32 v212, v212
    v_mfma_f32_16x16x32_bf16 v[188:191], v[240:243], v[180:183], v[188:191]
    ds_read_b128 v[232:235], v4 offset:26624
    v_exp_f32 v213, v213
    v_add_f32 v10, v10, v212
    v_add_f32 v10, v10, v213
    v_cvt_pk_bf16_f32 v38, v212, v213
    s_waitcnt lgkmcnt(3)
    v_mfma_f32_16x16x32_bf16 v[192:195], v[244:247], v[164:167], v[192:195]
    v_add_f32 v214, v214, v220
    v_add_f32 v215, v215, v220
    v_exp_f32 v214, v214
    v_exp_f32 v215, v215
    v_mfma_f32_16x16x32_bf16 v[196:199], v[244:247], v[180:183], v[196:199]
    ds_read_b128 v[236:239], v4 offset:27648
    v_add_f32 v10, v10, v214
    v_add_f32 v10, v10, v215
    v_cvt_pk_bf16_f32 v39, v214, v215
    s_waitcnt lgkmcnt(3)
    v_mfma_f32_16x16x32_bf16 v[200:203], v[224:227], v[152:155], v[216:219]
    v_mfma_f32_16x16x32_bf16 v[204:207], v[224:227], v[168:171], v[220:223]
    ds_read_b128 v[240:243], v4 offset:28672
    v_exp_f32 v184, v184
    v_exp_f32 v185, v185
    v_add_f32 v9, v9, v184
    s_waitcnt lgkmcnt(3)
    v_mfma_f32_16x16x32_bf16 v[208:211], v[228:231], v[152:155], v[216:219]
    v_add_f32 v9, v9, v185
    v_cvt_pk_bf16_f32 v40, v184, v185
    v_exp_f32 v186, v186
    v_mfma_f32_16x16x32_bf16 v[212:215], v[228:231], v[168:171], v[220:223]
    ds_read_b128 v[244:247], v4 offset:29696
    v_exp_f32 v187, v187
    v_add_f32 v9, v9, v186
    s_waitcnt lgkmcnt(3)
    v_mfma_f32_16x16x32_bf16 v[200:203], v[232:235], v[156:159], v[200:203]
    v_add_f32 v9, v9, v187
    v_cvt_pk_bf16_f32 v41, v186, v187
    v_exp_f32 v188, v188
    v_mfma_f32_16x16x32_bf16 v[204:207], v[232:235], v[172:175], v[204:207]
    ds_read_b128 v[224:227], v4 offset:30720
    v_exp_f32 v189, v189
    v_add_f32 v10, v10, v188
    v_add_f32 v10, v10, v189
    s_waitcnt lgkmcnt(3)
    v_mfma_f32_16x16x32_bf16 v[208:211], v[236:239], v[156:159], v[208:211]
    v_cvt_pk_bf16_f32 v44, v188, v189
    v_exp_f32 v190, v190
    v_mfma_f32_16x16x32_bf16 v[212:215], v[236:239], v[172:175], v[212:215]
    ds_read_b128 v[228:231], v4 offset:31744
    v_exp_f32 v191, v191
    v_add_f32 v10, v10, v190
    v_add_f32 v10, v10, v191
    s_waitcnt lgkmcnt(3)
    v_mfma_f32_16x16x32_bf16 v[200:203], v[240:243], v[160:163], v[200:203]
    v_cvt_pk_bf16_f32 v45, v190, v191
    v_exp_f32 v192, v192
    v_exp_f32 v193, v193
    v_mfma_f32_16x16x32_bf16 v[204:207], v[240:243], v[176:179], v[204:207]
    s_barrier
    ds_read_b128 v[232:235], v4 offset:32768
    v_add_f32 v9, v9, v192
    v_add_f32 v9, v9, v193
    s_waitcnt lgkmcnt(3)
    v_mfma_f32_16x16x32_bf16 v[208:211], v[244:247], v[160:163], v[208:211]
    v_cvt_pk_bf16_f32 v42, v192, v193
    v_exp_f32 v194, v194
    v_exp_f32 v195, v195
    v_mfma_f32_16x16x32_bf16 v[212:215], v[244:247], v[176:179], v[212:215]
    s_add_u32 s22, s21, 0x18000
    s_add_u32 m0, s20, 0x10000
    s_nop 0
    buffer_load_dwordx4 v2, s[8:11], s22 offen sc1 lds
    ds_read_b128 v[236:239], v4 offset:33792
    v_add_f32 v9, v9, v194
    v_add_f32 v9, v9, v195
    v_cvt_pk_bf16_f32 v43, v194, v195
    s_waitcnt lgkmcnt(3)
    v_mfma_f32_16x16x32_bf16 v[200:203], v[224:227], v[164:167], v[200:203]
    v_exp_f32 v196, v196
    v_exp_f32 v197, v197
    v_mfma_f32_16x16x32_bf16 v[204:207], v[224:227], v[180:183], v[204:207]
    ds_read_b128 v[240:243], v4 offset:34816
    v_add_f32 v10, v10, v196
    v_add_f32 v10, v10, v197
    v_cvt_pk_bf16_f32 v46, v196, v197
    s_waitcnt lgkmcnt(3)
    v_mfma_f32_16x16x32_bf16 v[208:211], v[228:231], v[164:167], v[208:211]
    v_exp_f32 v198, v198
    v_exp_f32 v199, v199
    v_add_f32 v10, v10, v198
    v_mfma_f32_16x16x32_bf16 v[212:215], v[228:231], v[180:183], v[212:215]
    ds_read_b128 v[244:247], v4 offset:35840
    v_add_f32 v10, v10, v199
    v_cvt_pk_bf16_f32 v47, v198, v199
    s_waitcnt lgkmcnt(3)
    v_mfma_f32_16x16x32_bf16 v[184:187], v[232:235], v[152:155], v[216:219]
    v_mfma_f32_16x16x32_bf16 v[188:191], v[232:235], v[168:171], v[220:223]
    ds_read_b128 v[224:227], v4 offset:36864
    v_exp_f32 v200, v200
    v_exp_f32 v201, v201
    v_add_f32 v9, v9, v200
    s_waitcnt lgkmcnt(3)
    v_mfma_f32_16x16x32_bf16 v[192:195], v[236:239], v[152:155], v[216:219]
    v_add_f32 v9, v9, v201
    v_cvt_pk_bf16_f32 v48, v200, v201
    v_exp_f32 v202, v202
    v_mfma_f32_16x16x32_bf16 v[196:199], v[236:239], v[168:171], v[220:223]
    s_add_u32 s22, s21, 0x18400
    s_add_u32 m0, s20, 0x10400
    s_nop 0
    buffer_load_dwordx4 v2, s[8:11], s22 offen sc1 lds
    ds_read_b128 v[228:231], v4 offset:37888
    v_exp_f32 v203, v203
    v_add_f32 v9, v9, v202
    s_waitcnt lgkmcnt(3)
    v_mfma_f32_16x16x32_bf16 v[184:187], v[240:243], v[156:159], v[184:187]
    v_add_f32 v9, v9, v203
    v_cvt_pk_bf16_f32 v49, v202, v203
    v_exp_f32 v204, v204
    v_mfma_f32_16x16x32_bf16 v[188:191], v[240:243], v[172:175], v[188:191]
    ds_read_b128 v[232:235], v4 offset:38912
    v_exp_f32 v205, v205
    v_add_f32 v10, v10, v204
    v_add_f32 v10, v10, v205
    s_waitcnt lgkmcnt(3)
    v_mfma_f32_16x16x32_bf16 v[192:195], v[244:247], v[156:159], v[192:195]
    v_cvt_pk_bf16_f32 v52, v204, v205
    v_exp_f32 v206, v206
    v_mfma_f32_16x16x32_bf16 v[196:199], v[244:247], v[172:175], v[196:199]
    ds_read_b128 v[236:239], v4 offset:39936
    v_exp_f32 v207, v207
    v_add_f32 v10, v10, v206
    v_add_f32 v10, v10, v207
    s_waitcnt lgkmcnt(3)
    v_mfma_f32_16x16x32_bf16 v[184:187], v[224:227], v[160:163], v[184:187]
    v_cvt_pk_bf16_f32 v53, v206, v207
    v_exp_f32 v208, v208
    v_exp_f32 v209, v209
    v_mfma_f32_16x16x32_bf16 v[188:191], v[224:227], v[176:179], v[188:191]
    ds_read_b128 v[240:243], v4 offset:40960
    v_add_f32 v9, v9, v208
    v_add_f32 v9, v9, v209
    s_waitcnt lgkmcnt(3)
    v_mfma_f32_16x16x32_bf16 v[192:195], v[228:231], v[160:163], v[192:195]
    v_cvt_pk_bf16_f32 v50, v208, v209
    v_exp_f32 v210, v210
    v_exp_f32 v211, v211
    v_mfma_f32_16x16x32_bf16 v[196:199], v[228:231], v[176:179], v[196:199]
    ds_read_b128 v[244:247], v4 offset:41984
    v_add_f32 v9, v9, v210
    v_add_f32 v9, v9, v211
    v_cvt_pk_bf16_f32 v51, v210, v211
    s_waitcnt lgkmcnt(3)
    v_mfma_f32_16x16x32_bf16 v[184:187], v[232:235], v[164:167], v[184:187]
    v_exp_f32 v212, v212
    v_exp_f32 v213, v213
    v_mfma_f32_16x16x32_bf16 v[188:191], v[232:235], v[180:183], v[188:191]
    ds_read_b128 v[224:227], v4 offset:43008
    v_add_f32 v10, v10, v212
    v_add_f32 v10, v10, v213
    v_cvt_pk_bf16_f32 v54, v212, v213
    s_waitcnt lgkmcnt(3)
    v_mfma_f32_16x16x32_bf16 v[192:195], v[236:239], v[164:167], v[192:195]
    v_exp_f32 v214, v214
    v_exp_f32 v215, v215
    v_add_f32 v10, v10, v214
    v_mfma_f32_16x16x32_bf16 v[196:199], v[236:239], v[180:183], v[196:199]
    ds_read_b128 v[228:231], v4 offset:44032
    v_add_f32 v10, v10, v215
    v_cvt_pk_bf16_f32 v55, v214, v215
    s_waitcnt lgkmcnt(3)
    v_mfma_f32_16x16x32_bf16 v[200:203], v[240:243], v[152:155], v[216:219]
    v_mfma_f32_16x16x32_bf16 v[204:207], v[240:243], v[168:171], v[220:223]
    ds_read_b128 v[232:235], v4 offset:45056
    v_exp_f32 v184, v184
    v_exp_f32 v185, v185
    v_add_f32 v9, v9, v184
    s_waitcnt lgkmcnt(3)
    v_mfma_f32_16x16x32_bf16 v[208:211], v[244:247], v[152:155], v[216:219]
    v_add_f32 v9, v9, v185
    v_cvt_pk_bf16_f32 v56, v184, v185
    v_exp_f32 v186, v186
    v_mfma_f32_16x16x32_bf16 v[212:215], v[244:247], v[168:171], v[220:223]
    ds_read_b128 v[236:239], v4 offset:46080
    v_exp_f32 v187, v187
    v_add_f32 v9, v9, v186
    s_waitcnt lgkmcnt(3)
    v_mfma_f32_16x16x32_bf16 v[200:203], v[224:227], v[156:159], v[200:203]
    v_add_f32 v9, v9, v187
    v_cvt_pk_bf16_f32 v57, v186, v187
    v_exp_f32 v188, v188
    v_mfma_f32_16x16x32_bf16 v[204:207], v[224:227], v[172:175], v[204:207]
    ds_read_b128 v[240:243], v4 offset:47104
    v_exp_f32 v189, v189
    v_add_f32 v10, v10, v188
    v_add_f32 v10, v10, v189
    s_waitcnt lgkmcnt(3)
    v_mfma_f32_16x16x32_bf16 v[208:211], v[228:231], v[156:159], v[208:211]
    v_cvt_pk_bf16_f32 v60, v188, v189
    v_exp_f32 v190, v190
    v_mfma_f32_16x16x32_bf16 v[212:215], v[228:231], v[172:175], v[212:215]
    ds_read_b128 v[244:247], v4 offset:48128
    v_exp_f32 v191, v191
    v_add_f32 v10, v10, v190
    v_add_f32 v10, v10, v191
    s_waitcnt lgkmcnt(3)
    v_mfma_f32_16x16x32_bf16 v[200:203], v[232:235], v[160:163], v[200:203]
    v_cvt_pk_bf16_f32 v61, v190, v191
    v_exp_f32 v192, v192
    v_exp_f32 v193, v193
    v_mfma_f32_16x16x32_bf16 v[204:207], v[232:235], v[176:179], v[204:207]
    s_barrier
    ds_read_b128 v[224:227], v4 offset:49152
    v_add_f32 v9, v9, v192
    v_add_f32 v9, v9, v193
    s_waitcnt lgkmcnt(3)
    v_mfma_f32_16x16x32_bf16 v[208:211], v[236:239], v[160:163], v[208:211]
    v_cvt_pk_bf16_f32 v58, v192, v193
    v_exp_f32 v194, v194
    v_exp_f32 v195, v195
    v_mfma_f32_16x16x32_bf16 v[212:215], v[236:239], v[176:179], v[212:215]
    s_add_u32 s22, s21, 0x1c000
    s_add_u32 m0, s20, 0x14000
    s_nop 0
    buffer_load_dwordx4 v2, s[8:11], s22 offen sc1 lds
    ds_read_b128 v[228:231], v4 offset:50176
    v_add_f32 v9, v9, v194
    v_add_f32 v9, v9, v195
    v_cvt_pk_bf16_f32 v59, v194, v195
    s_waitcnt lgkmcnt(3)
    v_mfma_f32_16x16x32_bf16 v[200:203], v[240:243], v[164:167], v[200:203]
    v_exp_f32 v196, v196
    v_exp_f32 v197, v197
    v_mfma_f32_16x16x32_bf16 v[204:207], v[240:243], v[180:183], v[204:207]
    ds_read_b128 v[232:235], v4 offset:51200
    v_add_f32 v10, v10, v196
    v_add_f32 v10, v10, v197
    v_cvt_pk_bf16_f32 v62, v196, v197
    s_waitcnt lgkmcnt(3)
    v_mfma_f32_16x16x32_bf16 v[208:211], v[244:247], v[164:167], v[208:211]
    v_exp_f32 v198, v198
    v_exp_f32 v199, v199
    v_add_f32 v10, v10, v198
    v_mfma_f32_16x16x32_bf16 v[212:215], v[244:247], v[180:183], v[212:215]
    ds_read_b128 v[236:239], v4 offset:52224
    v_add_f32 v10, v10, v199
    v_cvt_pk_bf16_f32 v63, v198, v199
    s_waitcnt lgkmcnt(3)
    v_mfma_f32_16x16x32_bf16 v[184:187], v[224:227], v[152:155], v[216:219]
    v_mfma_f32_16x16x32_bf16 v[188:191], v[224:227], v[168:171], v[220:223]
    ds_read_b128 v[240:243], v4 offset:53248
    v_exp_f32 v200, v200
    v_exp_f32 v201, v201
    v_add_f32 v9, v9, v200
    s_waitcnt lgkmcnt(3)
    v_mfma_f32_16x16x32_bf16 v[192:195], v[228:231], v[152:155], v[216:219]
    v_add_f32 v9, v9, v201
    v_cvt_pk_bf16_f32 v64, v200, v201
    v_exp_f32 v202, v202
    v_mfma_f32_16x16x32_bf16 v[196:199], v[228:231], v[168:171], v[220:223]
    s_add_u32 s22, s21, 0x1c400
    s_add_u32 m0, s20, 0x14400
    s_nop 0
    buffer_load_dwordx4 v2, s[8:11], s22 offen sc1 lds
    ds_read_b128 v[244:247], v4 offset:54272
    v_exp_f32 v203, v203
    v_add_f32 v9, v9, v202
    s_waitcnt lgkmcnt(3)
    v_mfma_f32_16x16x32_bf16 v[184:187], v[232:235], v[156:159], v[184:187]
    v_add_f32 v9, v9, v203
    v_cvt_pk_bf16_f32 v65, v202, v203
    v_exp_f32 v204, v204
    v_mfma_f32_16x16x32_bf16 v[188:191], v[232:235], v[172:175], v[188:191]
    ds_read_b128 v[224:227], v4 offset:55296
    v_exp_f32 v205, v205
    v_add_f32 v10, v10, v204
    v_add_f32 v10, v10, v205
    s_waitcnt lgkmcnt(3)
    v_mfma_f32_16x16x32_bf16 v[192:195], v[236:239], v[156:159], v[192:195]
    v_cvt_pk_bf16_f32 v68, v204, v205
    v_exp_f32 v206, v206
    v_mfma_f32_16x16x32_bf16 v[196:199], v[236:239], v[172:175], v[196:199]
    ds_read_b128 v[228:231], v4 offset:56320
    v_exp_f32 v207, v207
    v_add_f32 v10, v10, v206
    v_add_f32 v10, v10, v207
    s_waitcnt lgkmcnt(3)
    v_mfma_f32_16x16x32_bf16 v[184:187], v[240:243], v[160:163], v[184:187]
    v_cvt_pk_bf16_f32 v69, v206, v207
    v_exp_f32 v208, v208
    v_exp_f32 v209, v209
    v_mfma_f32_16x16x32_bf16 v[188:191], v[240:243], v[176:179], v[188:191]
    ds_read_b128 v[232:235], v4 offset:57344
    v_add_f32 v9, v9, v208
    v_add_f32 v9, v9, v209
    s_waitcnt lgkmcnt(3)
    v_mfma_f32_16x16x32_bf16 v[192:195], v[244:247], v[160:163], v[192:195]
    v_cvt_pk_bf16_f32 v66, v208, v209
    v_exp_f32 v210, v210
    v_exp_f32 v211, v211
    v_mfma_f32_16x16x32_bf16 v[196:199], v[244:247], v[176:179], v[196:199]
    ds_read_b128 v[236:239], v4 offset:58368
    v_add_f32 v9, v9, v210
    v_add_f32 v9, v9, v211
    v_cvt_pk_bf16_f32 v67, v210, v211
    s_waitcnt lgkmcnt(3)
    v_mfma_f32_16x16x32_bf16 v[184:187], v[224:227], v[164:167], v[184:187]
    v_exp_f32 v212, v212
    v_exp_f32 v213, v213
    v_mfma_f32_16x16x32_bf16 v[188:191], v[224:227], v[180:183], v[188:191]
    ds_read_b128 v[240:243], v4 offset:59392
    v_add_f32 v10, v10, v212
    v_add_f32 v10, v10, v213
    v_cvt_pk_bf16_f32 v70, v212, v213
    s_waitcnt lgkmcnt(3)
    v_mfma_f32_16x16x32_bf16 v[192:195], v[228:231], v[164:167], v[192:195]
    v_exp_f32 v214, v214
    v_exp_f32 v215, v215
    v_add_f32 v10, v10, v214
    v_mfma_f32_16x16x32_bf16 v[196:199], v[228:231], v[180:183], v[196:199]
    ds_read_b128 v[244:247], v4 offset:60416
    v_add_f32 v10, v10, v215
    v_cvt_pk_bf16_f32 v71, v214, v215
    s_waitcnt lgkmcnt(3)
    v_mfma_f32_16x16x32_bf16 v[200:203], v[232:235], v[152:155], v[216:219]
    v_mfma_f32_16x16x32_bf16 v[204:207], v[232:235], v[168:171], v[220:223]
    ds_read_b128 v[224:227], v4 offset:61440
    v_exp_f32 v184, v184
    v_exp_f32 v185, v185
    v_add_f32 v9, v9, v184
    s_waitcnt lgkmcnt(3)
    v_mfma_f32_16x16x32_bf16 v[208:211], v[236:239], v[152:155], v[216:219]
    v_add_f32 v9, v9, v185
    v_cvt_pk_bf16_f32 v72, v184, v185
    v_exp_f32 v186, v186
    v_mfma_f32_16x16x32_bf16 v[212:215], v[236:239], v[168:171], v[220:223]
    ds_read_b128 v[228:231], v4 offset:62464
    v_exp_f32 v187, v187
    v_add_f32 v9, v9, v186
    s_waitcnt lgkmcnt(3)
    v_mfma_f32_16x16x32_bf16 v[200:203], v[240:243], v[156:159], v[200:203]
    v_add_f32 v9, v9, v187
    v_cvt_pk_bf16_f32 v73, v186, v187
    v_exp_f32 v188, v188
    v_mfma_f32_16x16x32_bf16 v[204:207], v[240:243], v[172:175], v[204:207]
    ds_read_b128 v[232:235], v4 offset:63488
    v_exp_f32 v189, v189
    v_add_f32 v10, v10, v188
    v_add_f32 v10, v10, v189
    s_waitcnt lgkmcnt(3)
    v_mfma_f32_16x16x32_bf16 v[208:211], v[244:247], v[156:159], v[208:211]
    v_cvt_pk_bf16_f32 v76, v188, v189
    v_exp_f32 v190, v190
    v_mfma_f32_16x16x32_bf16 v[212:215], v[244:247], v[172:175], v[212:215]
    ds_read_b128 v[236:239], v4 offset:64512
    v_exp_f32 v191, v191
    v_add_f32 v10, v10, v190
    v_add_f32 v10, v10, v191
    s_waitcnt lgkmcnt(3)
    v_mfma_f32_16x16x32_bf16 v[200:203], v[224:227], v[160:163], v[200:203]
    v_cvt_pk_bf16_f32 v77, v190, v191
    v_exp_f32 v192, v192
    v_exp_f32 v193, v193
    v_mfma_f32_16x16x32_bf16 v[204:207], v[224:227], v[176:179], v[204:207]
    s_waitcnt vmcnt(6)
    s_barrier
    ds_read_b128 v[240:243], v5 offset:0
    v_add_f32 v9, v9, v192
    v_add_f32 v9, v9, v193
    s_waitcnt lgkmcnt(3)
    v_mfma_f32_16x16x32_bf16 v[208:211], v[228:231], v[160:163], v[208:211]
    v_cvt_pk_bf16_f32 v74, v192, v193
    v_exp_f32 v194, v194
    v_exp_f32 v195, v195
    v_mfma_f32_16x16x32_bf16 v[212:215], v[228:231], v[176:179], v[212:215]
    s_add_u32 s22, s14, 0x0
    s_add_u32 m0, s20, 0x18000
    s_nop 0
    buffer_load_dwordx4 v6, s[76:79], s22 offen lds
    ds_read_b128 v[244:247], v5 offset:1024
    v_add_f32 v9, v9, v194
    v_add_f32 v9, v9, v195
    v_cvt_pk_bf16_f32 v75, v194, v195
    s_waitcnt lgkmcnt(3)
    v_mfma_f32_16x16x32_bf16 v[200:203], v[232:235], v[164:167], v[200:203]
    v_exp_f32 v196, v196
    v_exp_f32 v197, v197
    v_mfma_f32_16x16x32_bf16 v[204:207], v[232:235], v[180:183], v[204:207]
    ds_read_b128 v[224:227], v5 offset:2048
    v_add_f32 v10, v10, v196
    v_add_f32 v10, v10, v197
    v_cvt_pk_bf16_f32 v78, v196, v197
    s_waitcnt lgkmcnt(3)
    v_mfma_f32_16x16x32_bf16 v[208:211], v[236:239], v[164:167], v[208:211]
    v_exp_f32 v198, v198
    v_exp_f32 v199, v199
    v_add_f32 v10, v10, v198
    v_mfma_f32_16x16x32_bf16 v[212:215], v[236:239], v[180:183], v[212:215]
    ds_read_b128 v[228:231], v5 offset:3072
    v_add_f32 v10, v10, v199
    v_cvt_pk_bf16_f32 v79, v198, v199
    s_waitcnt lgkmcnt(3)
    v_mfma_f32_16x16x32_bf16 v[184:187], v[240:243], v[152:155], v[216:219]
    v_mfma_f32_16x16x32_bf16 v[188:191], v[240:243], v[168:171], v[220:223]
    ds_read_b128 v[232:235], v5 offset:4096
    v_exp_f32 v200, v200
    v_exp_f32 v201, v201
    v_add_f32 v9, v9, v200
    s_waitcnt lgkmcnt(3)
    v_mfma_f32_16x16x32_bf16 v[192:195], v[244:247], v[152:155], v[216:219]
    v_add_f32 v9, v9, v201
    v_cvt_pk_bf16_f32 v80, v200, v201
    v_exp_f32 v202, v202
    v_mfma_f32_16x16x32_bf16 v[196:199], v[244:247], v[168:171], v[220:223]
    s_add_u32 s22, s14, 0xc000
    s_add_u32 m0, s20, 0x18400
    s_nop 0
    buffer_load_dwordx4 v6, s[76:79], s22 offen lds
    ds_read_b128 v[236:239], v5 offset:5120
    v_exp_f32 v203, v203
    v_add_f32 v9, v9, v202
    s_waitcnt lgkmcnt(3)
    v_mfma_f32_16x16x32_bf16 v[184:187], v[224:227], v[156:159], v[184:187]
    v_add_f32 v9, v9, v203
    v_cvt_pk_bf16_f32 v81, v202, v203
    v_exp_f32 v204, v204
    v_mfma_f32_16x16x32_bf16 v[188:191], v[224:227], v[172:175], v[188:191]
    ds_read_b128 v[240:243], v5 offset:6144
    v_exp_f32 v205, v205
    v_add_f32 v10, v10, v204
    v_add_f32 v10, v10, v205
    s_waitcnt lgkmcnt(3)
    v_mfma_f32_16x16x32_bf16 v[192:195], v[228:231], v[156:159], v[192:195]
    v_cvt_pk_bf16_f32 v84, v204, v205
    v_exp_f32 v206, v206
    v_mfma_f32_16x16x32_bf16 v[196:199], v[228:231], v[172:175], v[196:199]
    ds_read_b128 v[244:247], v5 offset:7168
    v_exp_f32 v207, v207
    v_add_f32 v10, v10, v206
    v_add_f32 v10, v10, v207
    s_waitcnt lgkmcnt(3)
    v_mfma_f32_16x16x32_bf16 v[184:187], v[232:235], v[160:163], v[184:187]
    v_cvt_pk_bf16_f32 v85, v206, v207
    v_exp_f32 v208, v208
    v_exp_f32 v209, v209
    v_mfma_f32_16x16x32_bf16 v[188:191], v[232:235], v[176:179], v[188:191]
    ds_read_b128 v[224:227], v5 offset:8192
    v_add_f32 v9, v9, v208
    v_add_f32 v9, v9, v209
    s_waitcnt lgkmcnt(3)
    v_mfma_f32_16x16x32_bf16 v[192:195], v[236:239], v[160:163], v[192:195]
    v_cvt_pk_bf16_f32 v82, v208, v209
    v_exp_f32 v210, v210
    v_exp_f32 v211, v211
    v_mfma_f32_16x16x32_bf16 v[196:199], v[236:239], v[176:179], v[196:199]
    ds_read_b128 v[228:231], v5 offset:9216
    v_add_f32 v9, v9, v210
    v_add_f32 v9, v9, v211
    v_cvt_pk_bf16_f32 v83, v210, v211
    s_waitcnt lgkmcnt(3)
    v_mfma_f32_16x16x32_bf16 v[184:187], v[240:243], v[164:167], v[184:187]
    v_exp_f32 v212, v212
    v_exp_f32 v213, v213
    v_mfma_f32_16x16x32_bf16 v[188:191], v[240:243], v[180:183], v[188:191]
    ds_read_b128 v[232:235], v5 offset:10240
    v_add_f32 v10, v10, v212
    v_add_f32 v10, v10, v213
    v_cvt_pk_bf16_f32 v86, v212, v213
    s_waitcnt lgkmcnt(3)
    v_mfma_f32_16x16x32_bf16 v[192:195], v[244:247], v[164:167], v[192:195]
    v_exp_f32 v214, v214
    v_exp_f32 v215, v215
    v_add_f32 v10, v10, v214
    v_mfma_f32_16x16x32_bf16 v[196:199], v[244:247], v[180:183], v[196:199]
    ds_read_b128 v[236:239], v5 offset:11264
    v_add_f32 v10, v10, v215
    v_cvt_pk_bf16_f32 v87, v214, v215
    s_waitcnt lgkmcnt(3)
    v_mfma_f32_16x16x32_bf16 v[200:203], v[224:227], v[152:155], v[216:219]
    v_mfma_f32_16x16x32_bf16 v[204:207], v[224:227], v[168:171], v[220:223]
    ds_read_b128 v[240:243], v5 offset:12288
    v_exp_f32 v184, v184
    v_exp_f32 v185, v185
    v_add_f32 v9, v9, v184
    s_waitcnt lgkmcnt(3)
    v_mfma_f32_16x16x32_bf16 v[208:211], v[228:231], v[152:155], v[216:219]
    v_add_f32 v9, v9, v185
    v_cvt_pk_bf16_f32 v88, v184, v185
    v_exp_f32 v186, v186
    v_mfma_f32_16x16x32_bf16 v[212:215], v[228:231], v[168:171], v[220:223]
    ds_read_b128 v[244:247], v5 offset:13312
    v_exp_f32 v187, v187
    v_add_f32 v9, v9, v186
    s_waitcnt lgkmcnt(3)
    v_mfma_f32_16x16x32_bf16 v[200:203], v[232:235], v[156:159], v[200:203]
    v_add_f32 v9, v9, v187
    v_cvt_pk_bf16_f32 v89, v186, v187
    v_exp_f32 v188, v188
    v_mfma_f32_16x16x32_bf16 v[204:207], v[232:235], v[172:175], v[204:207]
    ds_read_b128 v[224:227], v5 offset:14336
    v_exp_f32 v189, v189
    v_add_f32 v10, v10, v188
    v_add_f32 v10, v10, v189
    s_waitcnt lgkmcnt(3)
    v_mfma_f32_16x16x32_bf16 v[208:211], v[236:239], v[156:159], v[208:211]
    v_cvt_pk_bf16_f32 v92, v188, v189
    v_exp_f32 v190, v190
    v_mfma_f32_16x16x32_bf16 v[212:215], v[236:239], v[172:175], v[212:215]
    ds_read_b128 v[228:231], v5 offset:15360
    v_exp_f32 v191, v191
    v_add_f32 v10, v10, v190
    v_add_f32 v10, v10, v191
    s_waitcnt lgkmcnt(3)
    v_mfma_f32_16x16x32_bf16 v[200:203], v[240:243], v[160:163], v[200:203]
    v_cvt_pk_bf16_f32 v93, v190, v191
    v_exp_f32 v192, v192
    v_exp_f32 v193, v193
    v_mfma_f32_16x16x32_bf16 v[204:207], v[240:243], v[176:179], v[204:207]
    s_waitcnt vmcnt(6)
    s_barrier
    ds_read_b128 v[232:235], v5 offset:16384
    v_add_f32 v9, v9, v192
    v_add_f32 v9, v9, v193
    s_waitcnt lgkmcnt(3)
    v_mfma_f32_16x16x32_bf16 v[208:211], v[244:247], v[160:163], v[208:211]
    v_cvt_pk_bf16_f32 v90, v192, v193
    v_exp_f32 v194, v194
    v_exp_f32 v195, v195
    v_mfma_f32_16x16x32_bf16 v[212:215], v[244:247], v[176:179], v[212:215]
    s_add_u32 s22, s14, 0xc0000
    s_add_u32 m0, s20, 0x1c000
    s_nop 0
    buffer_load_dwordx4 v6, s[76:79], s22 offen lds
    ds_read_b128 v[236:239], v5 offset:17408
    v_add_f32 v9, v9, v194
    v_add_f32 v9, v9, v195
    v_cvt_pk_bf16_f32 v91, v194, v195
    s_waitcnt lgkmcnt(3)
    v_mfma_f32_16x16x32_bf16 v[200:203], v[224:227], v[164:167], v[200:203]
    v_exp_f32 v196, v196
    v_exp_f32 v197, v197
    v_mfma_f32_16x16x32_bf16 v[204:207], v[224:227], v[180:183], v[204:207]
    ds_read_b128 v[240:243], v5 offset:18432
    v_add_f32 v10, v10, v196
    v_add_f32 v10, v10, v197
    v_cvt_pk_bf16_f32 v94, v196, v197
    s_waitcnt lgkmcnt(3)
    v_mfma_f32_16x16x32_bf16 v[208:211], v[228:231], v[164:167], v[208:211]
    v_exp_f32 v198, v198
    v_exp_f32 v199, v199
    v_add_f32 v10, v10, v198
    v_mfma_f32_16x16x32_bf16 v[212:215], v[228:231], v[180:183], v[212:215]
    ds_read_b128 v[244:247], v5 offset:19456
    v_add_f32 v10, v10, v199
    v_cvt_pk_bf16_f32 v95, v198, v199
    s_waitcnt lgkmcnt(3)
    v_mfma_f32_16x16x32_bf16 v[184:187], v[232:235], v[152:155], v[216:219]
    v_mfma_f32_16x16x32_bf16 v[188:191], v[232:235], v[168:171], v[220:223]
    ds_read_b128 v[224:227], v5 offset:20480
    v_exp_f32 v200, v200
    v_exp_f32 v201, v201
    v_add_f32 v9, v9, v200
    s_waitcnt lgkmcnt(3)
    v_mfma_f32_16x16x32_bf16 v[192:195], v[236:239], v[152:155], v[216:219]
    v_add_f32 v9, v9, v201
    v_cvt_pk_bf16_f32 v96, v200, v201
    v_exp_f32 v202, v202
    v_mfma_f32_16x16x32_bf16 v[196:199], v[236:239], v[168:171], v[220:223]
    s_add_u32 s22, s14, 0xcc000
    s_add_u32 m0, s20, 0x1c400
    s_nop 0
    buffer_load_dwordx4 v6, s[76:79], s22 offen lds
    ds_read_b128 v[228:231], v5 offset:21504
    v_exp_f32 v203, v203
    v_add_f32 v9, v9, v202
    s_waitcnt lgkmcnt(3)
    v_mfma_f32_16x16x32_bf16 v[184:187], v[240:243], v[156:159], v[184:187]
    v_add_f32 v9, v9, v203
    v_cvt_pk_bf16_f32 v97, v202, v203
    v_exp_f32 v204, v204
    v_mfma_f32_16x16x32_bf16 v[188:191], v[240:243], v[172:175], v[188:191]
    ds_read_b128 v[232:235], v5 offset:22528
    v_exp_f32 v205, v205
    v_add_f32 v10, v10, v204
    v_add_f32 v10, v10, v205
    s_waitcnt lgkmcnt(3)
    v_mfma_f32_16x16x32_bf16 v[192:195], v[244:247], v[156:159], v[192:195]
    v_cvt_pk_bf16_f32 v100, v204, v205
    v_exp_f32 v206, v206
    v_mfma_f32_16x16x32_bf16 v[196:199], v[244:247], v[172:175], v[196:199]
    ds_read_b128 v[236:239], v5 offset:23552
    v_exp_f32 v207, v207
    v_add_f32 v10, v10, v206
    v_add_f32 v10, v10, v207
    s_waitcnt lgkmcnt(3)
    v_mfma_f32_16x16x32_bf16 v[184:187], v[224:227], v[160:163], v[184:187]
    v_cvt_pk_bf16_f32 v101, v206, v207
    v_exp_f32 v208, v208
    v_exp_f32 v209, v209
    v_mfma_f32_16x16x32_bf16 v[188:191], v[224:227], v[176:179], v[188:191]
    ds_read_b128 v[240:243], v5 offset:24576
    v_add_f32 v9, v9, v208
    v_add_f32 v9, v9, v209
    s_waitcnt lgkmcnt(3)
    v_mfma_f32_16x16x32_bf16 v[192:195], v[228:231], v[160:163], v[192:195]
    v_cvt_pk_bf16_f32 v98, v208, v209
    v_exp_f32 v210, v210
    v_exp_f32 v211, v211
    v_mfma_f32_16x16x32_bf16 v[196:199], v[228:231], v[176:179], v[196:199]
    ds_read_b128 v[244:247], v5 offset:25600
    v_add_f32 v9, v9, v210
    v_add_f32 v9, v9, v211
    v_cvt_pk_bf16_f32 v99, v210, v211
    s_waitcnt lgkmcnt(3)
    v_mfma_f32_16x16x32_bf16 v[184:187], v[232:235], v[164:167], v[184:187]
    v_exp_f32 v212, v212
    v_exp_f32 v213, v213
    v_mfma_f32_16x16x32_bf16 v[188:191], v[232:235], v[180:183], v[188:191]
    ds_read_b128 v[224:227], v5 offset:26624
    v_add_f32 v10, v10, v212
    v_add_f32 v10, v10, v213
    v_cvt_pk_bf16_f32 v102, v212, v213
    s_waitcnt lgkmcnt(3)
    v_mfma_f32_16x16x32_bf16 v[192:195], v[236:239], v[164:167], v[192:195]
    v_exp_f32 v214, v214
    v_exp_f32 v215, v215
    v_add_f32 v10, v10, v214
    v_mfma_f32_16x16x32_bf16 v[196:199], v[236:239], v[180:183], v[196:199]
    ds_read_b128 v[228:231], v5 offset:27648
    v_add_f32 v10, v10, v215
    v_cvt_pk_bf16_f32 v103, v214, v215
    s_waitcnt lgkmcnt(3)
    v_mfma_f32_16x16x32_bf16 v[200:203], v[240:243], v[152:155], v[216:219]
    v_mfma_f32_16x16x32_bf16 v[204:207], v[240:243], v[168:171], v[220:223]
    ds_read_b128 v[232:235], v5 offset:28672
    v_exp_f32 v184, v184
    v_exp_f32 v185, v185
    v_add_f32 v9, v9, v184
    s_waitcnt lgkmcnt(3)
    v_mfma_f32_16x16x32_bf16 v[208:211], v[244:247], v[152:155], v[216:219]
    v_add_f32 v9, v9, v185
    v_cvt_pk_bf16_f32 v104, v184, v185
    v_exp_f32 v186, v186
    v_mfma_f32_16x16x32_bf16 v[212:215], v[244:247], v[168:171], v[220:223]
    ds_read_b128 v[236:239], v5 offset:29696
    v_exp_f32 v187, v187
    v_add_f32 v9, v9, v186
    s_waitcnt lgkmcnt(3)
    v_mfma_f32_16x16x32_bf16 v[200:203], v[224:227], v[156:159], v[200:203]
    v_add_f32 v9, v9, v187
    v_cvt_pk_bf16_f32 v105, v186, v187
    v_exp_f32 v188, v188
    v_mfma_f32_16x16x32_bf16 v[204:207], v[224:227], v[172:175], v[204:207]
    ds_read_b128 v[240:243], v5 offset:30720
    v_exp_f32 v189, v189
    v_add_f32 v10, v10, v188
    v_add_f32 v10, v10, v189
    v_lshrrev_b32 v20, 4, v1
    v_lshlrev_b32 v21, 4, v20
    s_lshl_b32 s16, s2, 8
    s_add_u32 s16, s16, 0x550000
    buffer_load_dwordx4 v[144:147], v21, s[8:11], s16 offen offset:0 sc1
    buffer_load_dwordx4 v[148:151], v21, s[8:11], s16 offen offset:64 sc1
    buffer_load_dwordx4 v[248:251], v21, s[8:11], s16 offen offset:128 sc1
    buffer_load_dwordx4 v[252:255], v21, s[8:11], s16 offen offset:192 sc1
    v_lshlrev_b32 v7, 11, v20
    v_xor_b32 v20, s3, v20
    v_and_b32 v20, 1, v20
    v_lshl_add_u32 v7, v20, 5, v7
    v_bfe_u32 v20, v1, 2, 2
    v_lshl_add_u32 v7, v20, 6, v7
    v_and_b32 v20, 3, v1
    v_lshl_add_u32 v7, v20, 3, v7
    s_lshr_b32 s16, s3, 1
    s_lshl_b32 s16, s16, 8
    s_add_u32 s16, s16, 98304
    v_add_u32 v7, s16, v7
    s_waitcnt lgkmcnt(3)
    v_mfma_f32_16x16x32_bf16 v[208:211], v[228:231], v[156:159], v[208:211]
    v_cvt_pk_bf16_f32 v108, v188, v189
    v_exp_f32 v190, v190
    v_mfma_f32_16x16x32_bf16 v[212:215], v[228:231], v[172:175], v[212:215]
    ds_read_b128 v[244:247], v5 offset:31744
    v_exp_f32 v191, v191
    v_add_f32 v10, v10, v190
    v_add_f32 v10, v10, v191
    s_waitcnt lgkmcnt(3)
    v_mfma_f32_16x16x32_bf16 v[200:203], v[232:235], v[160:163], v[200:203]
    v_cvt_pk_bf16_f32 v109, v190, v191
    v_exp_f32 v192, v192
    v_exp_f32 v193, v193
    v_mfma_f32_16x16x32_bf16 v[204:207], v[232:235], v[176:179], v[204:207]
    s_waitcnt vmcnt(10)
    s_barrier
    ds_read_b128 v[224:227], v4 offset:0
    v_add_f32 v9, v9, v192
    v_add_f32 v9, v9, v193
    s_waitcnt lgkmcnt(3)
    v_mfma_f32_16x16x32_bf16 v[208:211], v[236:239], v[160:163], v[208:211]
    v_cvt_pk_bf16_f32 v106, v192, v193
    v_exp_f32 v194, v194
    v_exp_f32 v195, v195
    v_mfma_f32_16x16x32_bf16 v[212:215], v[236:239], v[176:179], v[212:215]
    s_add_u32 s22, s21, 0x80000
    s_add_u32 m0, s20, 0x20000
    s_nop 0
    buffer_load_dwordx4 v2, s[8:11], s22 offen sc1 lds
    ds_read_b128 v[228:231], v4 offset:1024
    v_add_f32 v9, v9, v194
    v_add_f32 v9, v9, v195
    v_cvt_pk_bf16_f32 v107, v194, v195
    s_waitcnt lgkmcnt(3)
    v_mfma_f32_16x16x32_bf16 v[200:203], v[240:243], v[164:167], v[200:203]
    v_exp_f32 v196, v196
    v_exp_f32 v197, v197
    v_mfma_f32_16x16x32_bf16 v[204:207], v[240:243], v[180:183], v[204:207]
    ds_read_b128 v[232:235], v4 offset:2048
    v_add_f32 v10, v10, v196
    v_add_f32 v10, v10, v197
    v_cvt_pk_bf16_f32 v110, v196, v197
    s_waitcnt lgkmcnt(3)
    v_mfma_f32_16x16x32_bf16 v[208:211], v[244:247], v[164:167], v[208:211]
    v_exp_f32 v198, v198
    v_exp_f32 v199, v199
    v_add_f32 v10, v10, v198
    v_mfma_f32_16x16x32_bf16 v[212:215], v[244:247], v[180:183], v[212:215]
    ds_read_b128 v[236:239], v4 offset:3072
    v_add_f32 v10, v10, v199
    v_cvt_pk_bf16_f32 v111, v198, v199
    s_waitcnt lgkmcnt(3)
    v_mfma_f32_16x16x32_bf16 v[184:187], v[224:227], v[152:155], v[216:219]
    v_mfma_f32_16x16x32_bf16 v[188:191], v[224:227], v[168:171], v[220:223]
    ds_read_b128 v[240:243], v4 offset:4096
    v_exp_f32 v200, v200
    v_exp_f32 v201, v201
    v_add_f32 v9, v9, v200
    s_waitcnt lgkmcnt(3)
    v_mfma_f32_16x16x32_bf16 v[192:195], v[228:231], v[152:155], v[216:219]
    v_add_f32 v9, v9, v201
    v_cvt_pk_bf16_f32 v112, v200, v201
    v_exp_f32 v202, v202
    v_mfma_f32_16x16x32_bf16 v[196:199], v[228:231], v[168:171], v[220:223]
    s_add_u32 s22, s21, 0x80400
    s_add_u32 m0, s20, 0x20400
    s_nop 0
    buffer_load_dwordx4 v2, s[8:11], s22 offen sc1 lds
    ds_read_b128 v[244:247], v4 offset:5120
    v_exp_f32 v203, v203
    v_add_f32 v9, v9, v202
    s_waitcnt lgkmcnt(3)
    v_mfma_f32_16x16x32_bf16 v[184:187], v[232:235], v[156:159], v[184:187]
    v_add_f32 v9, v9, v203
    v_cvt_pk_bf16_f32 v113, v202, v203
    v_exp_f32 v204, v204
    v_mfma_f32_16x16x32_bf16 v[188:191], v[232:235], v[172:175], v[188:191]
    ds_read_b128 v[224:227], v4 offset:6144
    v_exp_f32 v205, v205
    v_add_f32 v10, v10, v204
    v_add_f32 v10, v10, v205
    s_waitcnt lgkmcnt(3)
    v_mfma_f32_16x16x32_bf16 v[192:195], v[236:239], v[156:159], v[192:195]
    v_cvt_pk_bf16_f32 v116, v204, v205
    v_exp_f32 v206, v206
    v_mfma_f32_16x16x32_bf16 v[196:199], v[236:239], v[172:175], v[196:199]
    ds_read_b128 v[228:231], v4 offset:7168
    v_exp_f32 v207, v207
    v_add_f32 v10, v10, v206
    v_add_f32 v10, v10, v207
    s_waitcnt lgkmcnt(3)
    v_mfma_f32_16x16x32_bf16 v[184:187], v[240:243], v[160:163], v[184:187]
    v_cvt_pk_bf16_f32 v117, v206, v207
    v_exp_f32 v208, v208
    v_exp_f32 v209, v209
    v_mfma_f32_16x16x32_bf16 v[188:191], v[240:243], v[176:179], v[188:191]
    ds_read_b128 v[232:235], v4 offset:8192
    v_add_f32 v9, v9, v208
    v_add_f32 v9, v9, v209
    s_waitcnt lgkmcnt(3)
    v_mfma_f32_16x16x32_bf16 v[192:195], v[244:247], v[160:163], v[192:195]
    v_cvt_pk_bf16_f32 v114, v208, v209
    v_exp_f32 v210, v210
    v_exp_f32 v211, v211
    v_mfma_f32_16x16x32_bf16 v[196:199], v[244:247], v[176:179], v[196:199]
    ds_read_b128 v[236:239], v4 offset:9216
    v_add_f32 v9, v9, v210
    v_add_f32 v9, v9, v211
    v_cvt_pk_bf16_f32 v115, v210, v211
    s_waitcnt lgkmcnt(3)
    v_mfma_f32_16x16x32_bf16 v[184:187], v[224:227], v[164:167], v[184:187]
    v_exp_f32 v212, v212
    v_exp_f32 v213, v213
    v_mfma_f32_16x16x32_bf16 v[188:191], v[224:227], v[180:183], v[188:191]
    ds_read_b128 v[240:243], v4 offset:10240
    v_add_f32 v10, v10, v212
    v_add_f32 v10, v10, v213
    v_cvt_pk_bf16_f32 v118, v212, v213
    s_waitcnt lgkmcnt(3)
    v_mfma_f32_16x16x32_bf16 v[192:195], v[228:231], v[164:167], v[192:195]
    v_exp_f32 v214, v214
    v_exp_f32 v215, v215
    v_add_f32 v10, v10, v214
    v_mfma_f32_16x16x32_bf16 v[196:199], v[228:231], v[180:183], v[196:199]
    ds_read_b128 v[244:247], v4 offset:11264
    v_add_f32 v10, v10, v215
    v_cvt_pk_bf16_f32 v119, v214, v215
    s_waitcnt lgkmcnt(3)
    v_mfma_f32_16x16x32_bf16 v[200:203], v[232:235], v[152:155], v[216:219]
    v_mfma_f32_16x16x32_bf16 v[204:207], v[232:235], v[168:171], v[220:223]
    ds_read_b128 v[224:227], v4 offset:12288
    v_exp_f32 v184, v184
    v_exp_f32 v185, v185
    v_add_f32 v9, v9, v184
    s_waitcnt lgkmcnt(3)
    v_mfma_f32_16x16x32_bf16 v[208:211], v[236:239], v[152:155], v[216:219]
    v_add_f32 v9, v9, v185
    v_cvt_pk_bf16_f32 v120, v184, v185
    v_exp_f32 v186, v186
    v_mfma_f32_16x16x32_bf16 v[212:215], v[236:239], v[168:171], v[220:223]
    ds_read_b128 v[228:231], v4 offset:13312
    v_exp_f32 v187, v187
    v_add_f32 v9, v9, v186
    s_waitcnt lgkmcnt(3)
    v_mfma_f32_16x16x32_bf16 v[200:203], v[240:243], v[156:159], v[200:203]
    v_add_f32 v9, v9, v187
    v_cvt_pk_bf16_f32 v121, v186, v187
    v_exp_f32 v188, v188
    v_mfma_f32_16x16x32_bf16 v[204:207], v[240:243], v[172:175], v[204:207]
    ds_read_b128 v[232:235], v4 offset:14336
    v_exp_f32 v189, v189
    v_add_f32 v10, v10, v188
    v_add_f32 v10, v10, v189
    s_waitcnt lgkmcnt(3)
    v_mfma_f32_16x16x32_bf16 v[208:211], v[244:247], v[156:159], v[208:211]
    v_cvt_pk_bf16_f32 v124, v188, v189
    v_exp_f32 v190, v190
    v_mfma_f32_16x16x32_bf16 v[212:215], v[244:247], v[172:175], v[212:215]
    ds_read_b128 v[236:239], v4 offset:15360
    v_exp_f32 v191, v191
    v_add_f32 v10, v10, v190
    v_add_f32 v10, v10, v191
    s_waitcnt lgkmcnt(3)
    v_mfma_f32_16x16x32_bf16 v[200:203], v[224:227], v[160:163], v[200:203]
    v_cvt_pk_bf16_f32 v125, v190, v191
    v_exp_f32 v192, v192
    v_exp_f32 v193, v193
    v_mfma_f32_16x16x32_bf16 v[204:207], v[224:227], v[176:179], v[204:207]
    s_waitcnt vmcnt(10)
    s_waitcnt vmcnt(8)
    s_waitcnt vmcnt(6)
    s_barrier
    ds_read_b128 v[240:243], v4 offset:16384
    v_add_f32 v9, v9, v192
    v_add_f32 v9, v9, v193
    s_waitcnt lgkmcnt(3)
    v_mfma_f32_16x16x32_bf16 v[208:211], v[228:231], v[160:163], v[208:211]
    v_cvt_pk_bf16_f32 v122, v192, v193
    v_exp_f32 v194, v194
    v_exp_f32 v195, v195
    v_mfma_f32_16x16x32_bf16 v[212:215], v[228:231], v[176:179], v[212:215]
    s_add_u32 s22, s21, 0x84000
    s_add_u32 m0, s20, 0x24000
    s_nop 0
    buffer_load_dwordx4 v2, s[8:11], s22 offen sc1 lds
    ds_read_b128 v[244:247], v4 offset:17408
    v_add_f32 v9, v9, v194
    v_add_f32 v9, v9, v195
    v_cvt_pk_bf16_f32 v123, v194, v195
    ds_read_b64_tr_b16 v[136:137], v7 offset:0
    ds_read_b64_tr_b16 v[138:139], v7 offset:1024
    s_waitcnt lgkmcnt(5)
    v_mfma_f32_16x16x32_bf16 v[200:203], v[232:235], v[164:167], v[200:203]
    v_exp_f32 v196, v196
    v_exp_f32 v197, v197
    v_mfma_f32_16x16x32_bf16 v[204:207], v[232:235], v[180:183], v[204:207]
    ds_read_b128 v[224:227], v4 offset:18432
    v_add_f32 v10, v10, v196
    v_add_f32 v10, v10, v197
    v_cvt_pk_bf16_f32 v126, v196, v197
    s_waitcnt lgkmcnt(5)
    v_mfma_f32_16x16x32_bf16 v[208:211], v[236:239], v[164:167], v[208:211]
    v_exp_f32 v198, v198
    v_exp_f32 v199, v199
    v_add_f32 v10, v10, v198
    ds_read_b64_tr_b16 v[140:141], v7 offset:8192
    ds_read_b64_tr_b16 v[142:143], v7 offset:9216
    v_mfma_f32_16x16x32_bf16 v[212:215], v[236:239], v[180:183], v[212:215]
    ds_read_b128 v[228:231], v4 offset:19456
    v_add_f32 v10, v10, v199
    v_cvt_pk_bf16_f32 v127, v198, v199
    s_waitcnt lgkmcnt(7)
    v_mfma_f32_16x16x32_bf16 v[184:187], v[240:243], v[152:155], v[216:219]
    s_waitcnt vmcnt(6) lgkmcnt(4)
    v_mfma_f32_16x16x32_bf16 v[12:15], v[136:139], v[144:147], 0
    v_mfma_f32_16x16x32_bf16 v[188:191], v[240:243], v[168:171], v[220:223]
    ds_read_b128 v[232:235], v4 offset:20480
    v_exp_f32 v200, v200
    v_exp_f32 v201, v201
    v_add_f32 v9, v9, v200
    ds_read_b64_tr_b16 v[136:137], v7 offset:16384
    ds_read_b64_tr_b16 v[138:139], v7 offset:17408
    v_mfma_f32_16x16x32_bf16 v[192:195], v[244:247], v[152:155], v[216:219]
    v_add_f32 v9, v9, v201
    v_cvt_pk_bf16_f32 v128, v200, v201
    v_exp_f32 v202, v202
    v_mfma_f32_16x16x32_bf16 v[196:199], v[244:247], v[168:171], v[220:223]
    s_add_u32 s22, s21, 0x84400
    s_add_u32 m0, s20, 0x24400
    s_nop 0
    buffer_load_dwordx4 v2, s[8:11], s22 offen sc1 lds
    ds_read_b128 v[236:239], v4 offset:21504
    v_exp_f32 v203, v203
    v_add_f32 v9, v9, v202
    s_waitcnt vmcnt(6) lgkmcnt(5)
    v_mfma_f32_16x16x32_bf16 v[12:15], v[140:143], v[148:151], v[12:15]
    v_mfma_f32_16x16x32_bf16 v[184:187], v[224:227], v[156:159], v[184:187]
    v_add_f32 v9, v9, v203
    v_cvt_pk_bf16_f32 v129, v202, v203
    v_exp_f32 v204, v204
    ds_read_b64_tr_b16 v[140:141], v7 offset:24576
    ds_read_b64_tr_b16 v[142:143], v7 offset:25600
    v_mfma_f32_16x16x32_bf16 v[188:191], v[224:227], v[172:175], v[188:191]
    ds_read_b128 v[240:243], v4 offset:22528
    v_exp_f32 v205, v205
    v_add_f32 v10, v10, v204
    v_add_f32 v10, v10, v205
    s_waitcnt lgkmcnt(7)
    v_mfma_f32_16x16x32_bf16 v[192:195], v[228:231], v[156:159], v[192:195]
    v_cvt_pk_bf16_f32 v132, v204, v205
    v_exp_f32 v206, v206
    s_waitcnt vmcnt(5) lgkmcnt(4)
    v_mfma_f32_16x16x32_bf16 v[12:15], v[136:139], v[248:251], v[12:15]
    v_mfma_f32_16x16x32_bf16 v[196:199], v[228:231], v[172:175], v[196:199]
    ds_read_b128 v[244:247], v4 offset:23552
    v_exp_f32 v207, v207
    v_add_f32 v10, v10, v206
    v_add_f32 v10, v10, v207
    v_mfma_f32_16x16x32_bf16 v[184:187], v[232:235], v[160:163], v[184:187]
    v_cvt_pk_bf16_f32 v133, v206, v207
    v_exp_f32 v208, v208
    v_exp_f32 v209, v209
    v_mfma_f32_16x16x32_bf16 v[188:191], v[232:235], v[176:179], v[188:191]
    ds_read_b128 v[224:227], v4 offset:24576
    v_add_f32 v9, v9, v208
    v_add_f32 v9, v9, v209
    s_waitcnt vmcnt(4) lgkmcnt(3)
    v_mfma_f32_16x16x32_bf16 v[12:15], v[140:143], v[252:255], v[12:15]
    v_mfma_f32_16x16x32_bf16 v[192:195], v[236:239], v[160:163], v[192:195]
    v_cvt_pk_bf16_f32 v130, v208, v209
    v_exp_f32 v210, v210
    v_exp_f32 v211, v211
    v_mfma_f32_16x16x32_bf16 v[196:199], v[236:239], v[176:179], v[196:199]
    ds_read_b128 v[228:231], v4 offset:25600
    v_add_f32 v9, v9, v210
    v_add_f32 v9, v9, v211
    v_cvt_pk_bf16_f32 v131, v210, v211
    s_waitcnt lgkmcnt(3)
    v_mfma_f32_16x16x32_bf16 v[184:187], v[240:243], v[164:167], v[184:187]
    v_exp_f32 v212, v212
    v_exp_f32 v213, v213
    v_mfma_f32_16x16x32_bf16 v[188:191], v[240:243], v[180:183], v[188:191]
    ds_read_b128 v[232:235], v4 offset:26624
    v_add_f32 v10, v10, v212
    v_add_f32 v10, v10, v213
    v_cvt_pk_bf16_f32 v134, v212, v213
    s_waitcnt lgkmcnt(3)
    v_mfma_f32_16x16x32_bf16 v[192:195], v[244:247], v[164:167], v[192:195]
    v_exp_f32 v214, v214
    v_exp_f32 v215, v215
    v_add_f32 v10, v10, v214
    v_mfma_f32_16x16x32_bf16 v[196:199], v[244:247], v[180:183], v[196:199]
    ds_read_b128 v[236:239], v4 offset:27648
    v_add_f32 v10, v10, v215
    v_cvt_pk_bf16_f32 v135, v214, v215
    s_waitcnt lgkmcnt(3)
    v_mfma_f32_16x16x32_bf16 v[200:203], v[224:227], v[152:155], v[216:219]
    v_mfma_f32_16x16x32_bf16 v[204:207], v[224:227], v[168:171], v[220:223]
    ds_read_b128 v[240:243], v4 offset:28672
    v_exp_f32 v184, v184
    v_exp_f32 v185, v185
    v_add_f32 v9, v9, v184
    v_lshrrev_b32 v20, 4, v1
    v_lshlrev_b32 v20, 4, v20
    s_lshr_b32 s16, s2, 5
    s_lshl_b32 s16, s16, 14
    s_and_b32 s17, s2, 31
    s_lshl_b32 s17, s17, 9
    s_add_u32 s16, s16, s17
    s_lshl_b32 s17, s3, 6
    s_add_u32 s16, s16, s17
    s_add_u32 s16, s16, 0x580000
    s_mov_b32 exec_lo, 0x10001
    s_mov_b32 exec_hi, 0x10001
    buffer_store_dwordx4 v[12:15], v20, s[8:11], s16 offen sc1
    s_mov_b64 exec, -1
    s_waitcnt lgkmcnt(3)
    v_mfma_f32_16x16x32_bf16 v[208:211], v[228:231], v[152:155], v[216:219]
    v_add_f32 v9, v9, v185
    v_cvt_pk_bf16_f32 v136, v184, v185
    v_exp_f32 v186, v186
    v_mfma_f32_16x16x32_bf16 v[212:215], v[228:231], v[168:171], v[220:223]
    ds_read_b128 v[244:247], v4 offset:29696
    v_exp_f32 v187, v187
    v_add_f32 v9, v9, v186
    s_waitcnt lgkmcnt(3)
    v_mfma_f32_16x16x32_bf16 v[200:203], v[232:235], v[156:159], v[200:203]
    v_add_f32 v9, v9, v187
    v_cvt_pk_bf16_f32 v137, v186, v187
    v_exp_f32 v188, v188
    v_mfma_f32_16x16x32_bf16 v[204:207], v[232:235], v[172:175], v[204:207]
    ds_read_b128 v[224:227], v4 offset:30720
    v_exp_f32 v189, v189
    v_add_f32 v10, v10, v188
    v_add_f32 v10, v10, v189
    s_waitcnt lgkmcnt(3)
    v_mfma_f32_16x16x32_bf16 v[208:211], v[236:239], v[156:159], v[208:211]
    v_cvt_pk_bf16_f32 v140, v188, v189
    v_exp_f32 v190, v190
    v_mfma_f32_16x16x32_bf16 v[212:215], v[236:239], v[172:175], v[212:215]
    ds_read_b128 v[228:231], v4 offset:31744
    v_exp_f32 v191, v191
    v_add_f32 v10, v10, v190
    v_add_f32 v10, v10, v191
    s_waitcnt lgkmcnt(3)
    v_mfma_f32_16x16x32_bf16 v[200:203], v[240:243], v[160:163], v[200:203]
    v_cvt_pk_bf16_f32 v141, v190, v191
    v_exp_f32 v192, v192
    v_exp_f32 v193, v193
    v_mfma_f32_16x16x32_bf16 v[204:207], v[240:243], v[176:179], v[204:207]
    v_add_f32 v9, v9, v192
    v_add_f32 v9, v9, v193
    s_waitcnt lgkmcnt(2)
    v_mfma_f32_16x16x32_bf16 v[208:211], v[244:247], v[160:163], v[208:211]
    v_cvt_pk_bf16_f32 v138, v192, v193
    v_exp_f32 v194, v194
    v_exp_f32 v195, v195
    v_mfma_f32_16x16x32_bf16 v[212:215], v[244:247], v[176:179], v[212:215]
    v_add_f32 v9, v9, v194
    v_add_f32 v9, v9, v195
    v_cvt_pk_bf16_f32 v139, v194, v195
    s_waitcnt lgkmcnt(1)
    v_mfma_f32_16x16x32_bf16 v[200:203], v[224:227], v[164:167], v[200:203]
    v_exp_f32 v196, v196
    v_exp_f32 v197, v197
    v_mfma_f32_16x16x32_bf16 v[204:207], v[224:227], v[180:183], v[204:207]
    v_add_f32 v10, v10, v196
    v_add_f32 v10, v10, v197
    v_cvt_pk_bf16_f32 v142, v196, v197
    s_waitcnt lgkmcnt(0)
    v_mfma_f32_16x16x32_bf16 v[208:211], v[228:231], v[164:167], v[208:211]
    v_exp_f32 v198, v198
    v_exp_f32 v199, v199
    v_add_f32 v10, v10, v198
    v_mfma_f32_16x16x32_bf16 v[212:215], v[228:231], v[180:183], v[212:215]
    v_add_f32 v10, v10, v199
    v_cvt_pk_bf16_f32 v143, v198, v199
    s_waitcnt vmcnt(3)
    s_barrier
    ds_read_b128 v[232:235], v5 offset:0
    ds_read_b128 v[236:239], v5 offset:1024
    ds_read_b128 v[240:243], v5 offset:2048
    ds_read_b128 v[244:247], v5 offset:3072
    v_exp_f32 v200, v200
    v_exp_f32 v201, v201
    v_add_f32 v9, v9, v200
    v_add_f32 v9, v9, v201
    v_cvt_pk_bf16_f32 v144, v200, v201
    v_exp_f32 v202, v202
    v_exp_f32 v203, v203
    v_add_f32 v9, v9, v202
    v_add_f32 v9, v9, v203
    v_cvt_pk_bf16_f32 v145, v202, v203
    v_exp_f32 v204, v204
    v_exp_f32 v205, v205
    v_add_f32 v10, v10, v204
    v_add_f32 v10, v10, v205
    v_cvt_pk_bf16_f32 v148, v204, v205
    v_exp_f32 v206, v206
    v_exp_f32 v207, v207
    v_add_f32 v10, v10, v206
    v_add_f32 v10, v10, v207
    v_cvt_pk_bf16_f32 v149, v206, v207
    v_exp_f32 v208, v208
    v_exp_f32 v209, v209
    v_add_f32 v9, v9, v208
    v_add_f32 v9, v9, v209
    v_cvt_pk_bf16_f32 v146, v208, v209
    v_exp_f32 v210, v210
    v_exp_f32 v211, v211
    v_add_f32 v9, v9, v210
    v_add_f32 v9, v9, v211
    v_cvt_pk_bf16_f32 v147, v210, v211
    v_exp_f32 v212, v212
    v_exp_f32 v213, v213
    v_add_f32 v10, v10, v212
    v_add_f32 v10, v10, v213
    v_cvt_pk_bf16_f32 v150, v212, v213
    v_exp_f32 v214, v214
    v_exp_f32 v215, v215
    v_add_f32 v10, v10, v214
    v_add_f32 v10, v10, v215
    v_cvt_pk_bf16_f32 v151, v214, v215
    v_mov_b32 v16, v9
    v_mov_b32 v18, v10
    s_nop 0
    v_permlane16_swap_b32 v9, v16
    v_permlane16_swap_b32 v10, v18
    v_add_f32 v9, v9, v16
    v_add_f32 v10, v10, v18
    v_mov_b32 v16, v9
    v_mov_b32 v18, v10
    s_nop 0
    v_permlane32_swap_b32 v9, v16
    v_permlane32_swap_b32 v10, v18
    v_add_f32 v9, v9, v16
    v_add_f32 v10, v10, v18
    v_max_f32 v17, v9, v10
    v_readfirstlane_b32 s17, v8
    s_cmp_eq_u32 s17, s28
    s_cselect_b32 s16, 0, 0x71800000
    v_cmp_ngt_f32 vcc, s16, v17
    v_cmp_u_f32 s[76:77], v9, v10
    s_or_b64 vcc, vcc, s[76:77]
    s_cbranch_vccnz adaLN_cond__sliding_block_cached__moe_arch_mod__prompt_kernel_fixA
adaLN_cond__sliding_block_cached__moe_arch_mod__prompt_kernel_fixAb:
    v_rcp_f32 v9, v9
    v_rcp_f32 v10, v10
    s_lshl_b32 s25, s13, 3
    s_add_u32 s25, s25, s3
    s_lshl_b32 s25, s25, 18
    s_lshl_b32 s26, s12, 12
    s_add_u32 s25, s25, s26
    s_add_u32 s25, s25, 0x1000000
    s_add_u32 s26, s25, 131072
    s_lshl_b32 s63, s13, 3
    s_add_u32 s63, s63, s3
    s_lshl_b32 s63, s63, 5
    s_add_u32 s63, s63, s12
    s_lshl_b32 s63, s63, 2
    s_waitcnt lgkmcnt(3)
    v_mfma_f32_16x16x32_bf16 v[184:187], v[232:235], v[24:27], 0
    v_mfma_f32_16x16x32_bf16 v[188:191], v[232:235], v[28:31], 0
    ds_read_b128 v[224:227], v5 offset:4096
    s_waitcnt lgkmcnt(3)
    v_mfma_f32_16x16x32_bf16 v[192:195], v[236:239], v[24:27], 0
    s_add_u32 s22, s21, 0x88000
    s_add_u32 m0, s20, 0x10000
    s_nop 0
    buffer_load_dwordx4 v2, s[8:11], s22 offen sc1 lds
    v_mfma_f32_16x16x32_bf16 v[196:199], v[236:239], v[28:31], 0
    ds_read_b128 v[228:231], v5 offset:5120
    s_waitcnt lgkmcnt(3)
    v_mfma_f32_16x16x32_bf16 v[184:187], v[240:243], v[32:35], v[184:187]
    v_mfma_f32_16x16x32_bf16 v[188:191], v[240:243], v[36:39], v[188:191]
    ds_read_b128 v[232:235], v5 offset:6144
    s_waitcnt lgkmcnt(3)
    v_mfma_f32_16x16x32_bf16 v[192:195], v[244:247], v[32:35], v[192:195]
    s_add_u32 s22, s21, 0x88400
    s_add_u32 m0, s20, 0x10400
    s_nop 0
    buffer_load_dwordx4 v2, s[8:11], s22 offen sc1 lds
    v_mfma_f32_16x16x32_bf16 v[196:199], v[244:247], v[36:39], v[196:199]
    ds_read_b128 v[236:239], v5 offset:7168
    s_waitcnt lgkmcnt(3)
    v_mfma_f32_16x16x32_bf16 v[184:187], v[224:227], v[40:43], v[184:187]
    v_mfma_f32_16x16x32_bf16 v[188:191], v[224:227], v[44:47], v[188:191]
    ds_read_b128 v[240:243], v5 offset:8192
    s_waitcnt lgkmcnt(3)
    v_mfma_f32_16x16x32_bf16 v[192:195], v[228:231], v[40:43], v[192:195]
    s_add_u32 s22, s21, 0x8c000
    s_add_u32 m0, s20, 0x14000
    s_nop 0
    buffer_load_dwordx4 v2, s[8:11], s22 offen sc1 lds
    v_mfma_f32_16x16x32_bf16 v[196:199], v[228:231], v[44:47], v[196:199]
    ds_read_b128 v[244:247], v5 offset:9216
    s_waitcnt lgkmcnt(3)
    v_mfma_f32_16x16x32_bf16 v[184:187], v[232:235], v[48:51], v[184:187]
    v_mfma_f32_16x16x32_bf16 v[188:191], v[232:235], v[52:55], v[188:191]
    ds_read_b128 v[224:227], v5 offset:10240
    s_waitcnt lgkmcnt(3)
    v_mfma_f32_16x16x32_bf16 v[192:195], v[236:239], v[48:51], v[192:195]
    s_add_u32 s22, s21, 0x8c400
    s_add_u32 m0, s20, 0x14400
    s_nop 0
    buffer_load_dwordx4 v2, s[8:11], s22 offen sc1 lds
    v_mfma_f32_16x16x32_bf16 v[196:199], v[236:239], v[52:55], v[196:199]
    ds_read_b128 v[228:231], v5 offset:11264
    s_waitcnt lgkmcnt(3)
    v_mfma_f32_16x16x32_bf16 v[184:187], v[240:243], v[56:59], v[184:187]
    v_mfma_f32_16x16x32_bf16 v[188:191], v[240:243], v[60:63], v[188:191]
    ds_read_b128 v[232:235], v5 offset:12288
    s_waitcnt lgkmcnt(3)
    v_mfma_f32_16x16x32_bf16 v[192:195], v[244:247], v[56:59], v[192:195]
    s_add_u32 s22, s21, 0x90000
    s_add_u32 m0, s20, 0x18000
    s_nop 0
    buffer_load_dwordx4 v2, s[8:11], s22 offen sc1 lds
    v_mfma_f32_16x16x32_bf16 v[196:199], v[244:247], v[60:63], v[196:199]
    ds_read_b128 v[236:239], v5 offset:13312
    s_waitcnt lgkmcnt(3)
    v_mfma_f32_16x16x32_bf16 v[184:187], v[224:227], v[64:67], v[184:187]
    v_mfma_f32_16x16x32_bf16 v[188:191], v[224:227], v[68:71], v[188:191]
    ds_read_b128 v[240:243], v5 offset:14336
    s_waitcnt lgkmcnt(3)
    v_mfma_f32_16x16x32_bf16 v[192:195], v[228:231], v[64:67], v[192:195]
    s_add_u32 s22, s21, 0x90400
    s_add_u32 m0, s20, 0x18400
    s_nop 0
    buffer_load_dwordx4 v2, s[8:11], s22 offen sc1 lds
    s_waitcnt vmcnt(6)
    v_mfma_f32_16x16x32_bf16 v[196:199], v[228:231], v[68:71], v[196:199]
    ds_read_b128 v[244:247], v5 offset:15360
    s_waitcnt lgkmcnt(3)
    v_mfma_f32_16x16x32_bf16 v[184:187], v[232:235], v[72:75], v[184:187]
    v_mfma_f32_16x16x32_bf16 v[188:191], v[232:235], v[76:79], v[188:191]
    s_barrier
    ds_read_b128 v[224:227], v5 offset:16384
    s_waitcnt lgkmcnt(3)
    v_mfma_f32_16x16x32_bf16 v[192:195], v[236:239], v[72:75], v[192:195]
    v_mfma_f32_16x16x32_bf16 v[196:199], v[236:239], v[76:79], v[196:199]
    s_add_u32 s22, s21, 0x94000
    s_add_u32 m0, s20, 0x1c000
    s_nop 0
    buffer_load_dwordx4 v2, s[8:11], s22 offen sc1 lds
    ds_read_b128 v[228:231], v5 offset:17408
    s_waitcnt lgkmcnt(3)
    v_mfma_f32_16x16x32_bf16 v[184:187], v[240:243], v[80:83], v[184:187]
    v_mfma_f32_16x16x32_bf16 v[188:191], v[240:243], v[84:87], v[188:191]
    ds_read_b128 v[232:235], v5 offset:18432
    s_waitcnt lgkmcnt(3)
    v_mfma_f32_16x16x32_bf16 v[192:195], v[244:247], v[80:83], v[192:195]
    v_mov_b32 v251, s28
    v_mov_b32 v252, 0
    s_lshl_b32 s16, s2, 2
    s_add_u32 s16, s16, 0x560000
    s_cmp_eq_u32 s3, 0
    s_cselect_b32 s16, s16, 0x7ffffff0
    s_mov_b64 exec, 1
    buffer_store_dword v251, v252, s[8:11], s16 offen sc1
    s_mov_b64 exec, -1
    v_mfma_f32_16x16x32_bf16 v[196:199], v[244:247], v[84:87], v[196:199]
    ds_read_b128 v[236:239], v5 offset:19456
    s_waitcnt lgkmcnt(3)
    v_mfma_f32_16x16x32_bf16 v[184:187], v[224:227], v[88:91], v[184:187]
    v_mfma_f32_16x16x32_bf16 v[188:191], v[224:227], v[92:95], v[188:191]
    ds_read_b128 v[240:243], v5 offset:20480
    s_waitcnt lgkmcnt(3)
    v_mfma_f32_16x16x32_bf16 v[192:195], v[228:231], v[88:91], v[192:195]
    v_mfma_f32_16x16x32_bf16 v[196:199], v[228:231], v[92:95], v[196:199]
    s_add_u32 s22, s21, 0x94400
    s_add_u32 m0, s20, 0x1c400
    s_nop 0
    buffer_load_dwordx4 v2, s[8:11], s22 offen sc1 lds
    ds_read_b128 v[244:247], v5 offset:21504
    s_waitcnt lgkmcnt(3)
    v_mfma_f32_16x16x32_bf16 v[184:187], v[232:235], v[96:99], v[184:187]
    v_mfma_f32_16x16x32_bf16 v[188:191], v[232:235], v[100:103], v[188:191]
    ds_read_b128 v[224:227], v5 offset:22528
    s_waitcnt lgkmcnt(3)
    v_mfma_f32_16x16x32_bf16 v[192:195], v[236:239], v[96:99], v[192:195]
    v_mfma_f32_16x16x32_bf16 v[196:199], v[236:239], v[100:103], v[196:199]
    ds_read_b128 v[228:231], v5 offset:23552
    s_waitcnt lgkmcnt(3)
    v_mfma_f32_16x16x32_bf16 v[184:187], v[240:243], v[104:107], v[184:187]
    v_mfma_f32_16x16x32_bf16 v[188:191], v[240:243], v[108:111], v[188:191]
    ds_read_b128 v[232:235], v5 offset:24576
    s_waitcnt lgkmcnt(3)
    v_mfma_f32_16x16x32_bf16 v[192:195], v[244:247], v[104:107], v[192:195]
    v_mfma_f32_16x16x32_bf16 v[196:199], v[244:247], v[108:111], v[196:199]
    ds_read_b128 v[236:239], v5 offset:25600
    s_waitcnt lgkmcnt(3)
    v_mfma_f32_16x16x32_bf16 v[184:187], v[224:227], v[112:115], v[184:187]
    v_mfma_f32_16x16x32_bf16 v[188:191], v[224:227], v[116:119], v[188:191]
    ds_read_b128 v[240:243], v5 offset:26624
    s_waitcnt lgkmcnt(3)
    v_mfma_f32_16x16x32_bf16 v[192:195], v[228:231], v[112:115], v[192:195]
    v_mfma_f32_16x16x32_bf16 v[196:199], v[228:231], v[116:119], v[196:199]
    ds_read_b128 v[244:247], v5 offset:27648
    s_waitcnt lgkmcnt(3)
    v_mfma_f32_16x16x32_bf16 v[184:187], v[232:235], v[120:123], v[184:187]
    v_mfma_f32_16x16x32_bf16 v[188:191], v[232:235], v[124:127], v[188:191]
    ds_read_b128 v[224:227], v5 offset:28672
    s_waitcnt lgkmcnt(3)
    v_mfma_f32_16x16x32_bf16 v[192:195], v[236:239], v[120:123], v[192:195]
    v_mfma_f32_16x16x32_bf16 v[196:199], v[236:239], v[124:127], v[196:199]
    ds_read_b128 v[228:231], v5 offset:29696
    s_waitcnt lgkmcnt(3)
    v_mfma_f32_16x16x32_bf16 v[184:187], v[240:243], v[128:131], v[184:187]
    v_mfma_f32_16x16x32_bf16 v[188:191], v[240:243], v[132:135], v[188:191]
    ds_read_b128 v[232:235], v5 offset:30720
    s_waitcnt lgkmcnt(3)
    v_mfma_f32_16x16x32_bf16 v[192:195], v[244:247], v[128:131], v[192:195]
    v_mfma_f32_16x16x32_bf16 v[196:199], v[244:247], v[132:135], v[196:199]
    ds_read_b128 v[236:239], v5 offset:31744
    s_waitcnt lgkmcnt(3)
    v_mfma_f32_16x16x32_bf16 v[184:187], v[224:227], v[136:139], v[184:187]
    v_mfma_f32_16x16x32_bf16 v[188:191], v[224:227], v[140:143], v[188:191]
    s_waitcnt vmcnt(7)
    s_barrier
    ds_read_b128 v[240:243], v4 offset:0
    s_waitcnt lgkmcnt(3)
    v_mfma_f32_16x16x32_bf16 v[192:195], v[228:231], v[136:139], v[192:195]
    v_mfma_f32_16x16x32_bf16 v[196:199], v[228:231], v[140:143], v[196:199]
    s_add_u32 s22, s21, 0x98000
    s_add_u32 m0, s20, 0x20000
    s_nop 0
    buffer_load_dwordx4 v2, s[8:11], s22 offen sc1 lds
    ds_read_b128 v[244:247], v4 offset:1024
    s_waitcnt lgkmcnt(3)
    v_mfma_f32_16x16x32_bf16 v[184:187], v[232:235], v[144:147], v[184:187]
    v_mfma_f32_16x16x32_bf16 v[188:191], v[232:235], v[148:151], v[188:191]
    ds_read_b128 v[224:227], v4 offset:2048
    s_waitcnt lgkmcnt(3)
    v_mfma_f32_16x16x32_bf16 v[192:195], v[236:239], v[144:147], v[192:195]
    v_mfma_f32_16x16x32_bf16 v[196:199], v[236:239], v[148:151], v[196:199]
    ds_read_b128 v[228:231], v4 offset:3072
    s_waitcnt lgkmcnt(3)
    v_mfma_f32_16x16x32_bf16 v[200:203], v[240:243], v[24:27], 0
    v_mfma_f32_16x16x32_bf16 v[204:207], v[240:243], v[28:31], 0
    ds_read_b128 v[232:235], v4 offset:4096
    s_waitcnt lgkmcnt(3)
    v_mfma_f32_16x16x32_bf16 v[208:211], v[244:247], v[24:27], 0
    v_mfma_f32_16x16x32_bf16 v[212:215], v[244:247], v[28:31], 0
    s_add_u32 s22, s21, 0x98400
    s_add_u32 m0, s20, 0x20400
    s_nop 0
    buffer_load_dwordx4 v2, s[8:11], s22 offen sc1 lds
    ds_read_b128 v[236:239], v4 offset:5120
    v_mul_f32 v184, v184, v9
    s_waitcnt lgkmcnt(3)
    v_mfma_f32_16x16x32_bf16 v[200:203], v[224:227], v[32:35], v[200:203]
    v_mul_f32 v185, v185, v9
    v_mfma_f32_16x16x32_bf16 v[204:207], v[224:227], v[36:39], v[204:207]
    ds_read_b128 v[240:243], v4 offset:6144
    v_mul_f32 v186, v186, v9
    s_waitcnt lgkmcnt(3)
    v_mfma_f32_16x16x32_bf16 v[208:211], v[228:231], v[32:35], v[208:211]
    v_mul_f32 v187, v187, v9
    v_and_b32 v250, 7, v1
    v_lshlrev_b32 v250, 7, v250
    s_lshr_b32 s14, s2, 3
    s_lshl_b32 s14, s14, 2
    s_add_u32 s14, s14, 0x560000
    buffer_load_dword v248, v250, s[8:11], s14 offen sc1
    v_mfma_f32_16x16x32_bf16 v[212:215], v[228:231], v[36:39], v[212:215]
    ds_read_b128 v[244:247], v4 offset:7168
    v_mul_f32 v192, v192, v9
    s_waitcnt lgkmcnt(3)
    v_mfma_f32_16x16x32_bf16 v[200:203], v[232:235], v[40:43], v[200:203]
    v_mul_f32 v193, v193, v9
    v_mfma_f32_16x16x32_bf16 v[204:207], v[232:235], v[44:47], v[204:207]
    ds_read_b128 v[224:227], v4 offset:8192
    v_mul_f32 v194, v194, v9
    s_waitcnt lgkmcnt(3)
    v_mfma_f32_16x16x32_bf16 v[208:211], v[236:239], v[40:43], v[208:211]
    v_mul_f32 v195, v195, v9
    v_mfma_f32_16x16x32_bf16 v[212:215], v[236:239], v[44:47], v[212:215]
    ds_read_b128 v[228:231], v4 offset:9216
    v_cvt_pk_bf16_f32 v216, v184, v185
    s_waitcnt lgkmcnt(3)
    v_mfma_f32_16x16x32_bf16 v[200:203], v[240:243], v[48:51], v[200:203]
    v_cvt_pk_bf16_f32 v217, v186, v187
    v_mfma_f32_16x16x32_bf16 v[204:207], v[240:243], v[52:55], v[204:207]
    ds_read_b128 v[232:235], v4 offset:10240
    v_cvt_pk_bf16_f32 v218, v192, v193
    s_waitcnt lgkmcnt(3)
    v_mfma_f32_16x16x32_bf16 v[208:211], v[244:247], v[48:51], v[208:211]
    v_cvt_pk_bf16_f32 v219, v194, v195
    v_mfma_f32_16x16x32_bf16 v[212:215], v[244:247], v[52:55], v[212:215]
    ds_read_b128 v[236:239], v4 offset:11264
    buffer_store_dwordx4 v[216:219], v2, s[8:11], s25 offen offset:0 sc1
    s_waitcnt lgkmcnt(3)
    v_mfma_f32_16x16x32_bf16 v[200:203], v[224:227], v[56:59], v[200:203]
    v_mul_f32 v188, v188, v10
    v_mfma_f32_16x16x32_bf16 v[204:207], v[224:227], v[60:63], v[204:207]
    ds_read_b128 v[240:243], v4 offset:12288
    v_mul_f32 v189, v189, v10
    s_waitcnt lgkmcnt(3)
    v_mfma_f32_16x16x32_bf16 v[208:211], v[228:231], v[56:59], v[208:211]
    v_mul_f32 v190, v190, v10
    v_mfma_f32_16x16x32_bf16 v[212:215], v[228:231], v[60:63], v[212:215]
    ds_read_b128 v[244:247], v4 offset:13312
    v_mul_f32 v191, v191, v10
    s_waitcnt lgkmcnt(3)
    v_mfma_f32_16x16x32_bf16 v[200:203], v[232:235], v[64:67], v[200:203]
    v_mul_f32 v196, v196, v10
    v_mfma_f32_16x16x32_bf16 v[204:207], v[232:235], v[68:71], v[204:207]
    ds_read_b128 v[224:227], v4 offset:14336
    v_mul_f32 v197, v197, v10
    s_waitcnt lgkmcnt(3)
    v_mfma_f32_16x16x32_bf16 v[208:211], v[236:239], v[64:67], v[208:211]
    v_mul_f32 v198, v198, v10
    v_mfma_f32_16x16x32_bf16 v[212:215], v[236:239], v[68:71], v[212:215]
    ds_read_b128 v[228:231], v4 offset:15360
    v_mul_f32 v199, v199, v10
    s_waitcnt lgkmcnt(3)
    v_mfma_f32_16x16x32_bf16 v[200:203], v[240:243], v[72:75], v[200:203]
    v_cvt_pk_bf16_f32 v220, v188, v189
    v_mfma_f32_16x16x32_bf16 v[204:207], v[240:243], v[76:79], v[204:207]
    s_waitcnt vmcnt(9)
    s_barrier
    ds_read_b128 v[232:235], v4 offset:16384
    v_cvt_pk_bf16_f32 v221, v190, v191
    s_waitcnt lgkmcnt(3)
    v_mfma_f32_16x16x32_bf16 v[208:211], v[244:247], v[72:75], v[208:211]
    v_cvt_pk_bf16_f32 v222, v196, v197
    v_mfma_f32_16x16x32_bf16 v[212:215], v[244:247], v[76:79], v[212:215]
    s_add_u32 s22, s21, 0x9c000
    s_add_u32 m0, s20, 0x24000
    s_nop 0
    buffer_load_dwordx4 v2, s[8:11], s22 offen sc1 lds
    ds_read_b128 v[236:239], v4 offset:17408
    v_cvt_pk_bf16_f32 v223, v198, v199
    s_waitcnt lgkmcnt(3)
    v_mfma_f32_16x16x32_bf16 v[200:203], v[224:227], v[80:83], v[200:203]
    buffer_store_dwordx4 v[220:223], v2, s[8:11], s26 offen offset:0 sc1
    v_mfma_f32_16x16x32_bf16 v[204:207], v[224:227], v[84:87], v[204:207]
    ds_read_b128 v[240:243], v4 offset:18432
    s_waitcnt lgkmcnt(3)
    v_mfma_f32_16x16x32_bf16 v[208:211], v[228:231], v[80:83], v[208:211]
    v_mfma_f32_16x16x32_bf16 v[212:215], v[228:231], v[84:87], v[212:215]
    ds_read_b128 v[244:247], v4 offset:19456
    s_waitcnt lgkmcnt(3)
    v_mfma_f32_16x16x32_bf16 v[200:203], v[232:235], v[88:91], v[200:203]
    v_mfma_f32_16x16x32_bf16 v[204:207], v[232:235], v[92:95], v[204:207]
    ds_read_b128 v[224:227], v4 offset:20480
    s_waitcnt lgkmcnt(3)
    v_mfma_f32_16x16x32_bf16 v[208:211], v[236:239], v[88:91], v[208:211]
    v_mfma_f32_16x16x32_bf16 v[212:215], v[236:239], v[92:95], v[212:215]
    s_add_u32 s22, s21, 0x9c400
    s_add_u32 m0, s20, 0x24400
    s_nop 0
    buffer_load_dwordx4 v2, s[8:11], s22 offen sc1 lds
    ds_read_b128 v[228:231], v4 offset:21504
    s_waitcnt lgkmcnt(3)
    v_mfma_f32_16x16x32_bf16 v[200:203], v[240:243], v[96:99], v[200:203]
    v_mfma_f32_16x16x32_bf16 v[204:207], v[240:243], v[100:103], v[204:207]
    ds_read_b128 v[232:235], v4 offset:22528
    s_waitcnt lgkmcnt(3)
    v_mfma_f32_16x16x32_bf16 v[208:211], v[244:247], v[96:99], v[208:211]
    v_mfma_f32_16x16x32_bf16 v[212:215], v[244:247], v[100:103], v[212:215]
    ds_read_b128 v[236:239], v4 offset:23552
    s_waitcnt lgkmcnt(3)
    v_mfma_f32_16x16x32_bf16 v[200:203], v[224:227], v[104:107], v[200:203]
    v_mfma_f32_16x16x32_bf16 v[204:207], v[224:227], v[108:111], v[204:207]
    ds_read_b128 v[240:243], v4 offset:24576
    s_waitcnt lgkmcnt(3)
    v_mfma_f32_16x16x32_bf16 v[208:211], v[228:231], v[104:107], v[208:211]
    v_mfma_f32_16x16x32_bf16 v[212:215], v[228:231], v[108:111], v[212:215]
    ds_read_b128 v[244:247], v4 offset:25600
    s_waitcnt lgkmcnt(3)
    v_mfma_f32_16x16x32_bf16 v[200:203], v[232:235], v[112:115], v[200:203]
    v_mfma_f32_16x16x32_bf16 v[204:207], v[232:235], v[116:119], v[204:207]
    ds_read_b128 v[224:227], v4 offset:26624
    s_waitcnt lgkmcnt(3)
    v_mfma_f32_16x16x32_bf16 v[208:211], v[236:239], v[112:115], v[208:211]
    s_waitcnt vmcnt(4)
    v_cmp_ne_u32 vcc, s28, v248
    s_cbranch_vccnz adaLN_cond__sliding_block_cached__moe_arch_mod__prompt_kernel_mp5r
adaLN_cond__sliding_block_cached__moe_arch_mod__prompt_kernel_mp5b:
    v_mfma_f32_16x16x32_bf16 v[212:215], v[236:239], v[116:119], v[212:215]
    ds_read_b128 v[228:231], v4 offset:27648
    v_lshrrev_b32 v250, 4, v1
    v_lshlrev_b32 v250, 14, v250
    v_and_b32 v253, 15, v1
    v_lshl_add_u32 v250, v253, 2, v250
    s_lshl_b32 s14, s2, 6
    s_add_u32 s14, s14, 0x580000
    buffer_load_dword v249, v250, s[8:11], s14 offen sc1
    s_add_u32 s14, s14, 0x10000
    buffer_load_dword v254, v250, s[8:11], s14 offen sc1
    s_waitcnt lgkmcnt(3)
    v_mfma_f32_16x16x32_bf16 v[200:203], v[240:243], v[120:123], v[200:203]
    v_mfma_f32_16x16x32_bf16 v[204:207], v[240:243], v[124:127], v[204:207]
    ds_read_b128 v[232:235], v4 offset:28672
    s_waitcnt lgkmcnt(3)
    v_mfma_f32_16x16x32_bf16 v[208:211], v[244:247], v[120:123], v[208:211]
    v_mfma_f32_16x16x32_bf16 v[212:215], v[244:247], v[124:127], v[212:215]
    ds_read_b128 v[236:239], v4 offset:29696
    s_waitcnt lgkmcnt(3)
    v_mfma_f32_16x16x32_bf16 v[200:203], v[224:227], v[128:131], v[200:203]
    v_mfma_f32_16x16x32_bf16 v[204:207], v[224:227], v[132:135], v[204:207]
    ds_read_b128 v[240:243], v4 offset:30720
    s_waitcnt lgkmcnt(3)
    v_mfma_f32_16x16x32_bf16 v[208:211], v[228:231], v[128:131], v[208:211]
    v_mfma_f32_16x16x32_bf16 v[212:215], v[228:231], v[132:135], v[212:215]
    ds_read_b128 v[244:247], v4 offset:31744
    s_waitcnt lgkmcnt(3)
    v_mfma_f32_16x16x32_bf16 v[200:203], v[232:235], v[136:139], v[200:203]
    v_mfma_f32_16x16x32_bf16 v[204:207], v[232:235], v[140:143], v[204:207]
    s_barrier
    ds_read_b128 v[224:227], v4 offset:32768
    s_waitcnt lgkmcnt(3)
    v_mfma_f32_16x16x32_bf16 v[208:211], v[236:239], v[136:139], v[208:211]
    v_mfma_f32_16x16x32_bf16 v[212:215], v[236:239], v[140:143], v[212:215]
    s_add_u32 s22, s24, 0x0
    s_add_u32 m0, s20, 0x10000
    s_nop 0
    buffer_load_dwordx4 v3, s[4:7], s22 offen lds
    ds_read_b128 v[228:231], v4 offset:33792
    s_waitcnt lgkmcnt(3)
    v_mfma_f32_16x16x32_bf16 v[200:203], v[240:243], v[144:147], v[200:203]
    v_mfma_f32_16x16x32_bf16 v[204:207], v[240:243], v[148:151], v[204:207]
    ds_read_b128 v[232:235], v4 offset:34816
    s_waitcnt lgkmcnt(3)
    v_mfma_f32_16x16x32_bf16 v[208:211], v[244:247], v[144:147], v[208:211]
    v_mfma_f32_16x16x32_bf16 v[212:215], v[244:247], v[148:151], v[212:215]
    ds_read_b128 v[236:239], v4 offset:35840
    s_waitcnt lgkmcnt(3)
    v_mfma_f32_16x16x32_bf16 v[184:187], v[224:227], v[24:27], 0
    v_mfma_f32_16x16x32_bf16 v[188:191], v[224:227], v[28:31], 0
    ds_read_b128 v[240:243], v4 offset:36864
    s_waitcnt lgkmcnt(3)
    v_mfma_f32_16x16x32_bf16 v[192:195], v[228:231], v[24:27], 0
    v_mfma_f32_16x16x32_bf16 v[196:199], v[228:231], v[28:31], 0
    s_add_u32 s22, s24, 0x2000
    s_add_u32 m0, s20, 0x10400
    s_nop 0
    buffer_load_dwordx4 v3, s[4:7], s22 offen lds
    ds_read_b128 v[244:247], v4 offset:37888
    v_mul_f32 v200, v200, v9
    s_waitcnt lgkmcnt(3)
    v_mfma_f32_16x16x32_bf16 v[184:187], v[232:235], v[32:35], v[184:187]
    v_mul_f32 v201, v201, v9
    v_mfma_f32_16x16x32_bf16 v[188:191], v[232:235], v[36:39], v[188:191]
    ds_read_b128 v[224:227], v4 offset:38912
    v_mul_f32 v202, v202, v9
    s_waitcnt lgkmcnt(3)
    v_mfma_f32_16x16x32_bf16 v[192:195], v[236:239], v[32:35], v[192:195]
    v_mul_f32 v203, v203, v9
    s_waitcnt vmcnt(2)
    v_add_f32 v249, v249, v254
    v_mov_b32 v250, v249
    s_nop 1
    v_permlane16_swap_b32 v249, v250
    v_add_f32 v249, v249, v250
    v_mov_b32 v250, v249
    s_nop 1
    v_permlane32_swap_b32 v249, v250
    v_add_f32 v249, v249, v250
    v_cvt_pk_bf16_f32 v249, v249, v249
    v_lshlrev_b32 v249, 16, v249
    s_lshr_b32 s14, s2, 6
    s_cmp_eq_u32 s14, 2
    s_cselect_b32 s14, 1.0, 0
    v_add_f32 v249, s14, v249
    v_cvt_pk_bf16_f32 v249, v249, v249
    v_lshlrev_b32 v253, 1, v253
    s_lshl_b32 s14, s2, 5
    s_add_u32 s14, s14, 0x540000
    s_cmp_eq_u32 s3, 0
    s_cselect_b32 s14, s14, 0x7ffffff0
    s_mov_b64 exec, 0xffff
    buffer_store_short v249, v253, s[8:11], s14 offen sc1
    s_mov_b64 exec, -1
    v_mfma_f32_16x16x32_bf16 v[196:199], v[236:239], v[36:39], v[196:199]
    ds_read_b128 v[228:231], v4 offset:39936
    v_mul_f32 v208, v208, v9
    s_waitcnt lgkmcnt(3)
    v_mfma_f32_16x16x32_bf16 v[184:187], v[240:243], v[40:43], v[184:187]
    v_mul_f32 v209, v209, v9
    v_mfma_f32_16x16x32_bf16 v[188:191], v[240:243], v[44:47], v[188:191]
    ds_read_b128 v[232:235], v4 offset:40960
    v_mul_f32 v210, v210, v9
    s_waitcnt lgkmcnt(3)
    v_mfma_f32_16x16x32_bf16 v[192:195], v[244:247], v[40:43], v[192:195]
    v_mul_f32 v211, v211, v9
    v_mfma_f32_16x16x32_bf16 v[196:199], v[244:247], v[44:47], v[196:199]
    ds_read_b128 v[236:239], v4 offset:41984
    v_cvt_pk_bf16_f32 v216, v200, v201
    s_waitcnt lgkmcnt(3)
    v_mfma_f32_16x16x32_bf16 v[184:187], v[224:227], v[48:51], v[184:187]
    v_cvt_pk_bf16_f32 v217, v202, v203
    s_add_u32 s16, s63, 0x570000
    v_mov_b32 v7, s28
    v_mov_b32 v8, 0
    s_mov_b64 exec, 1
    buffer_store_dword v7, v8, s[8:11], s16 offen sc1
    s_mov_b64 exec, -1
    v_mfma_f32_16x16x32_bf16 v[188:191], v[224:227], v[52:55], v[188:191]
    ds_read_b128 v[240:243], v4 offset:43008
    v_cvt_pk_bf16_f32 v218, v208, v209
    s_waitcnt lgkmcnt(3)
    v_mfma_f32_16x16x32_bf16 v[192:195], v[228:231], v[48:51], v[192:195]
    v_cvt_pk_bf16_f32 v219, v210, v211
    v_mfma_f32_16x16x32_bf16 v[196:199], v[228:231], v[52:55], v[196:199]
    ds_read_b128 v[244:247], v4 offset:44032
    buffer_store_dwordx4 v[216:219], v2, s[8:11], s25 offen offset:1024 sc1
    s_waitcnt lgkmcnt(3)
    v_mfma_f32_16x16x32_bf16 v[184:187], v[232:235], v[56:59], v[184:187]
    v_mul_f32 v204, v204, v10
    v_mfma_f32_16x16x32_bf16 v[188:191], v[232:235], v[60:63], v[188:191]
    ds_read_b128 v[224:227], v4 offset:45056
    v_mul_f32 v205, v205, v10
    s_waitcnt lgkmcnt(3)
    v_mfma_f32_16x16x32_bf16 v[192:195], v[236:239], v[56:59], v[192:195]
    v_mul_f32 v206, v206, v10
    v_mfma_f32_16x16x32_bf16 v[196:199], v[236:239], v[60:63], v[196:199]
    ds_read_b128 v[228:231], v4 offset:46080
    v_mul_f32 v207, v207, v10
    s_waitcnt lgkmcnt(3)
    v_mfma_f32_16x16x32_bf16 v[184:187], v[240:243], v[64:67], v[184:187]
    v_mul_f32 v212, v212, v10
    v_mfma_f32_16x16x32_bf16 v[188:191], v[240:243], v[68:71], v[188:191]
    ds_read_b128 v[232:235], v4 offset:47104
    v_mul_f32 v213, v213, v10
    s_waitcnt lgkmcnt(3)
    v_mfma_f32_16x16x32_bf16 v[192:195], v[244:247], v[64:67], v[192:195]
    v_mul_f32 v214, v214, v10
    v_mfma_f32_16x16x32_bf16 v[196:199], v[244:247], v[68:71], v[196:199]
    ds_read_b128 v[236:239], v4 offset:48128
    v_mul_f32 v215, v215, v10
    s_waitcnt lgkmcnt(3)
    v_mfma_f32_16x16x32_bf16 v[184:187], v[224:227], v[72:75], v[184:187]
    v_cvt_pk_bf16_f32 v220, v204, v205
    v_mfma_f32_16x16x32_bf16 v[188:191], v[224:227], v[76:79], v[188:191]
    s_barrier
    ds_read_b128 v[240:243], v4 offset:49152
    v_cvt_pk_bf16_f32 v221, v206, v207
    s_waitcnt lgkmcnt(3)
    v_mfma_f32_16x16x32_bf16 v[192:195], v[228:231], v[72:75], v[192:195]
    v_cvt_pk_bf16_f32 v222, v212, v213
    v_mfma_f32_16x16x32_bf16 v[196:199], v[228:231], v[76:79], v[196:199]
    s_add_u32 s22, s24, 0x80000
    s_add_u32 m0, s20, 0x14000
    s_nop 0
    buffer_load_dwordx4 v3, s[4:7], s22 offen lds
    ds_read_b128 v[244:247], v4 offset:50176
    v_cvt_pk_bf16_f32 v223, v214, v215
    s_waitcnt lgkmcnt(3)
    v_mfma_f32_16x16x32_bf16 v[184:187], v[232:235], v[80:83], v[184:187]
    buffer_store_dwordx4 v[220:223], v2, s[8:11], s26 offen offset:1024 sc1
    v_mfma_f32_16x16x32_bf16 v[188:191], v[232:235], v[84:87], v[188:191]
    ds_read_b128 v[224:227], v4 offset:51200
    s_waitcnt lgkmcnt(3)
    v_mfma_f32_16x16x32_bf16 v[192:195], v[236:239], v[80:83], v[192:195]
    v_mfma_f32_16x16x32_bf16 v[196:199], v[236:239], v[84:87], v[196:199]
    ds_read_b128 v[228:231], v4 offset:52224
    s_waitcnt lgkmcnt(3)
    v_mfma_f32_16x16x32_bf16 v[184:187], v[240:243], v[88:91], v[184:187]
    v_mfma_f32_16x16x32_bf16 v[188:191], v[240:243], v[92:95], v[188:191]
    ds_read_b128 v[232:235], v4 offset:53248
    s_waitcnt lgkmcnt(3)
    v_mfma_f32_16x16x32_bf16 v[192:195], v[244:247], v[88:91], v[192:195]
    v_mfma_f32_16x16x32_bf16 v[196:199], v[244:247], v[92:95], v[196:199]
    s_add_u32 s22, s24, 0x82000
    s_add_u32 m0, s20, 0x14400
    s_nop 0
    buffer_load_dwordx4 v3, s[4:7], s22 offen lds
    ds_read_b128 v[236:239], v4 offset:54272
    s_waitcnt lgkmcnt(3)
    v_mfma_f32_16x16x32_bf16 v[184:187], v[224:227], v[96:99], v[184:187]
    v_mfma_f32_16x16x32_bf16 v[188:191], v[224:227], v[100:103], v[188:191]
    ds_read_b128 v[240:243], v4 offset:55296
    s_waitcnt lgkmcnt(3)
    v_mfma_f32_16x16x32_bf16 v[192:195], v[228:231], v[96:99], v[192:195]
    v_mfma_f32_16x16x32_bf16 v[196:199], v[228:231], v[100:103], v[196:199]
    ds_read_b128 v[244:247], v4 offset:56320
    s_waitcnt lgkmcnt(3)
    v_mfma_f32_16x16x32_bf16 v[184:187], v[232:235], v[104:107], v[184:187]
    v_mfma_f32_16x16x32_bf16 v[188:191], v[232:235], v[108:111], v[188:191]
    ds_read_b128 v[224:227], v4 offset:57344
    s_waitcnt lgkmcnt(3)
    v_mfma_f32_16x16x32_bf16 v[192:195], v[236:239], v[104:107], v[192:195]
    v_mfma_f32_16x16x32_bf16 v[196:199], v[236:239], v[108:111], v[196:199]
    ds_read_b128 v[228:231], v4 offset:58368
    s_waitcnt lgkmcnt(3)
    v_mfma_f32_16x16x32_bf16 v[184:187], v[240:243], v[112:115], v[184:187]
    v_mfma_f32_16x16x32_bf16 v[188:191], v[240:243], v[116:119], v[188:191]
    ds_read_b128 v[232:235], v4 offset:59392
    s_waitcnt lgkmcnt(3)
    v_mfma_f32_16x16x32_bf16 v[192:195], v[244:247], v[112:115], v[192:195]
    s_waitcnt vmcnt(5)
    v_mov_b32 v248, s28
    v_mov_b32 v249, 0
    s_lshl_b32 s14, s2, 2
    s_add_u32 s14, s14, 0x544000
    s_cmp_eq_u32 s3, 0
    s_cselect_b32 s14, s14, 0x7ffffff0
    s_mov_b64 exec, 1
    buffer_store_dword v248, v249, s[8:11], s14 offen sc1
    s_mov_b64 exec, -1
    v_mfma_f32_16x16x32_bf16 v[196:199], v[244:247], v[116:119], v[196:199]
    ds_read_b128 v[236:239], v4 offset:60416
    s_waitcnt lgkmcnt(3)
    v_mfma_f32_16x16x32_bf16 v[184:187], v[224:227], v[120:123], v[184:187]
    v_mfma_f32_16x16x32_bf16 v[188:191], v[224:227], v[124:127], v[188:191]
    ds_read_b128 v[240:243], v4 offset:61440
    s_waitcnt lgkmcnt(3)
    v_mfma_f32_16x16x32_bf16 v[192:195], v[228:231], v[120:123], v[192:195]
    v_mfma_f32_16x16x32_bf16 v[196:199], v[228:231], v[124:127], v[196:199]
    ds_read_b128 v[244:247], v4 offset:62464
    s_waitcnt lgkmcnt(3)
    v_mfma_f32_16x16x32_bf16 v[184:187], v[232:235], v[128:131], v[184:187]
    v_mfma_f32_16x16x32_bf16 v[188:191], v[232:235], v[132:135], v[188:191]
    ds_read_b128 v[224:227], v4 offset:63488
    s_waitcnt lgkmcnt(3)
    v_mfma_f32_16x16x32_bf16 v[192:195], v[236:239], v[128:131], v[192:195]
    v_mfma_f32_16x16x32_bf16 v[196:199], v[236:239], v[132:135], v[196:199]
    ds_read_b128 v[228:231], v4 offset:64512
    s_waitcnt lgkmcnt(3)
    v_mfma_f32_16x16x32_bf16 v[184:187], v[240:243], v[136:139], v[184:187]
    v_mfma_f32_16x16x32_bf16 v[188:191], v[240:243], v[140:143], v[188:191]
    s_barrier
    ds_read_b128 v[232:235], v5 offset:0
    s_waitcnt lgkmcnt(3)
    v_mfma_f32_16x16x32_bf16 v[192:195], v[244:247], v[136:139], v[192:195]
    v_mfma_f32_16x16x32_bf16 v[196:199], v[244:247], v[140:143], v[196:199]
    s_add_u32 s22, s24, 0x100000
    s_add_u32 m0, s20, 0x18000
    s_nop 0
    buffer_load_dwordx4 v3, s[4:7], s22 offen lds
    ds_read_b128 v[236:239], v5 offset:1024
    s_waitcnt lgkmcnt(3)
    v_mfma_f32_16x16x32_bf16 v[184:187], v[224:227], v[144:147], v[184:187]
    v_mfma_f32_16x16x32_bf16 v[188:191], v[224:227], v[148:151], v[188:191]
    ds_read_b128 v[240:243], v5 offset:2048
    s_waitcnt lgkmcnt(3)
    v_mfma_f32_16x16x32_bf16 v[192:195], v[228:231], v[144:147], v[192:195]
    v_mfma_f32_16x16x32_bf16 v[196:199], v[228:231], v[148:151], v[196:199]
    ds_read_b128 v[244:247], v5 offset:3072
    s_waitcnt lgkmcnt(3)
    v_mfma_f32_16x16x32_bf16 v[200:203], v[232:235], v[24:27], 0
    v_mfma_f32_16x16x32_bf16 v[204:207], v[232:235], v[28:31], 0
    ds_read_b128 v[224:227], v5 offset:4096
    s_waitcnt lgkmcnt(3)
    v_mfma_f32_16x16x32_bf16 v[208:211], v[236:239], v[24:27], 0
    v_mfma_f32_16x16x32_bf16 v[212:215], v[236:239], v[28:31], 0
    s_add_u32 s22, s24, 0x102000
    s_add_u32 m0, s20, 0x18400
    s_nop 0
    buffer_load_dwordx4 v3, s[4:7], s22 offen lds
    ds_read_b128 v[228:231], v5 offset:5120
    v_mul_f32 v184, v184, v9
    s_waitcnt lgkmcnt(3)
    v_mfma_f32_16x16x32_bf16 v[200:203], v[240:243], v[32:35], v[200:203]
    v_mul_f32 v185, v185, v9
    s_bfe_u32 s30, s2, 0x20001
    s_lshl_b32 s30, s30, 2
    s_bfe_u32 s17, s2, 0x20003
    s_add_u32 s30, s30, s17
    s_lshr_b32 s31, s2, 5
    s_and_b32 s17, s3, 3
    s_lshl_b32 s19, s30, 2
    s_add_u32 s19, s19, s17
    s_and_b32 s16, s2, 1
    s_lshl_b32 s17, s19, 18
    s_lshl_b32 s23, s16, 16
    s_add_u32 s17, s17, s23
    s_add_u32 s17, s17, 0x1000000
    v_add_u32 v6, s17, v2
    s_lshl_b32 s19, s19, 7
    s_lshl_b32 s23, s16, 6
    s_add_u32 s19, s19, s23
    s_add_u32 s19, s19, 0x570000
    v_and_b32 v13, 15, v1
    v_lshlrev_b32 v13, 2, v13
    buffer_load_dword v12, v13, s[8:11], s19 offen sc1
    v_mfma_f32_16x16x32_bf16 v[204:207], v[240:243], v[36:39], v[204:207]
    ds_read_b128 v[232:235], v5 offset:6144
    v_mul_f32 v186, v186, v9
    s_waitcnt lgkmcnt(3)
    v_mfma_f32_16x16x32_bf16 v[208:211], v[244:247], v[32:35], v[208:211]
    v_mul_f32 v187, v187, v9
    v_mfma_f32_16x16x32_bf16 v[212:215], v[244:247], v[36:39], v[212:215]
    ds_read_b128 v[236:239], v5 offset:7168
    v_mul_f32 v192, v192, v9
    s_waitcnt lgkmcnt(3)
    v_mfma_f32_16x16x32_bf16 v[200:203], v[224:227], v[40:43], v[200:203]
    v_mul_f32 v193, v193, v9
    v_mfma_f32_16x16x32_bf16 v[204:207], v[224:227], v[44:47], v[204:207]
    ds_read_b128 v[240:243], v5 offset:8192
    v_mul_f32 v194, v194, v9
    s_waitcnt lgkmcnt(3)
    v_mfma_f32_16x16x32_bf16 v[208:211], v[228:231], v[40:43], v[208:211]
    v_mul_f32 v195, v195, v9
    v_mfma_f32_16x16x32_bf16 v[212:215], v[228:231], v[44:47], v[212:215]
    ds_read_b128 v[244:247], v5 offset:9216
    v_cvt_pk_bf16_f32 v216, v184, v185
    s_waitcnt lgkmcnt(3)
    v_mfma_f32_16x16x32_bf16 v[200:203], v[232:235], v[48:51], v[200:203]
    v_cvt_pk_bf16_f32 v217, v186, v187
    v_mfma_f32_16x16x32_bf16 v[204:207], v[232:235], v[52:55], v[204:207]
    ds_read_b128 v[224:227], v5 offset:10240
    v_cvt_pk_bf16_f32 v218, v192, v193
    s_waitcnt lgkmcnt(3)
    v_mfma_f32_16x16x32_bf16 v[208:211], v[236:239], v[48:51], v[208:211]
    v_cvt_pk_bf16_f32 v219, v194, v195
    v_mfma_f32_16x16x32_bf16 v[212:215], v[236:239], v[52:55], v[212:215]
    ds_read_b128 v[228:231], v5 offset:11264
    buffer_store_dwordx4 v[216:219], v2, s[8:11], s25 offen offset:2048 sc1
    s_waitcnt lgkmcnt(3)
    v_mfma_f32_16x16x32_bf16 v[200:203], v[240:243], v[56:59], v[200:203]
    v_mul_f32 v188, v188, v10
    v_mfma_f32_16x16x32_bf16 v[204:207], v[240:243], v[60:63], v[204:207]
    ds_read_b128 v[232:235], v5 offset:12288
    v_mul_f32 v189, v189, v10
    s_waitcnt lgkmcnt(3)
    v_mfma_f32_16x16x32_bf16 v[208:211], v[244:247], v[56:59], v[208:211]
    v_mul_f32 v190, v190, v10
    v_mfma_f32_16x16x32_bf16 v[212:215], v[244:247], v[60:63], v[212:215]
    ds_read_b128 v[236:239], v5 offset:13312
    v_mul_f32 v191, v191, v10
    s_waitcnt lgkmcnt(3)
    v_mfma_f32_16x16x32_bf16 v[200:203], v[224:227], v[64:67], v[200:203]
    v_mul_f32 v196, v196, v10
    v_mfma_f32_16x16x32_bf16 v[204:207], v[224:227], v[68:71], v[204:207]
    ds_read_b128 v[240:243], v5 offset:14336
    v_mul_f32 v197, v197, v10
    s_waitcnt lgkmcnt(3)
    v_mfma_f32_16x16x32_bf16 v[208:211], v[228:231], v[64:67], v[208:211]
    v_mul_f32 v198, v198, v10
    v_mfma_f32_16x16x32_bf16 v[212:215], v[228:231], v[68:71], v[212:215]
    ds_read_b128 v[244:247], v5 offset:15360
    v_mul_f32 v199, v199, v10
    s_waitcnt lgkmcnt(3)
    v_mfma_f32_16x16x32_bf16 v[200:203], v[232:235], v[72:75], v[200:203]
    v_cvt_pk_bf16_f32 v220, v188, v189
    v_mfma_f32_16x16x32_bf16 v[204:207], v[232:235], v[76:79], v[204:207]
    s_barrier
    ds_read_b128 v[224:227], v5 offset:16384
    v_cvt_pk_bf16_f32 v221, v190, v191
    s_waitcnt lgkmcnt(3)
    v_mfma_f32_16x16x32_bf16 v[208:211], v[236:239], v[72:75], v[208:211]
    v_cvt_pk_bf16_f32 v222, v196, v197
    v_mfma_f32_16x16x32_bf16 v[212:215], v[236:239], v[76:79], v[212:215]
    s_add_u32 s22, s24, 0x180000
    s_add_u32 m0, s20, 0x1c000
    s_nop 0
    buffer_load_dwordx4 v3, s[4:7], s22 offen lds
    ds_read_b128 v[228:231], v5 offset:17408
    v_cvt_pk_bf16_f32 v223, v198, v199
    s_waitcnt lgkmcnt(3)
    v_mfma_f32_16x16x32_bf16 v[200:203], v[240:243], v[80:83], v[200:203]
    buffer_store_dwordx4 v[220:223], v2, s[8:11], s26 offen offset:2048 sc1
    v_mfma_f32_16x16x32_bf16 v[204:207], v[240:243], v[84:87], v[204:207]
    ds_read_b128 v[232:235], v5 offset:18432
    s_waitcnt lgkmcnt(3)
    v_mfma_f32_16x16x32_bf16 v[208:211], v[244:247], v[80:83], v[208:211]
    v_mfma_f32_16x16x32_bf16 v[212:215], v[244:247], v[84:87], v[212:215]
    ds_read_b128 v[236:239], v5 offset:19456
    s_waitcnt lgkmcnt(3)
    v_mfma_f32_16x16x32_bf16 v[200:203], v[224:227], v[88:91], v[200:203]
    v_mfma_f32_16x16x32_bf16 v[204:207], v[224:227], v[92:95], v[204:207]
    ds_read_b128 v[240:243], v5 offset:20480
    s_waitcnt vmcnt(3)
    v_cmp_ne_u32 vcc, s28, v12
    s_cbranch_vccnz adaLN_cond__sliding_block_cached__moe_arch_mod__prompt_kernel_o6r
adaLN_cond__sliding_block_cached__moe_arch_mod__prompt_kernel_o6b:
    s_waitcnt lgkmcnt(3)
    v_mfma_f32_16x16x32_bf16 v[208:211], v[228:231], v[88:91], v[208:211]
    s_mov_b32 s23, 0x0
    buffer_load_dwordx4 v[24:27], v6, s[8:11], s23 offen offset:0 sc1
    v_mfma_f32_16x16x32_bf16 v[212:215], v[228:231], v[92:95], v[212:215]
    s_add_u32 s22, s24, 0x182000
    s_add_u32 m0, s20, 0x1c400
    s_nop 0
    buffer_load_dwordx4 v3, s[4:7], s22 offen lds
    ds_read_b128 v[244:247], v5 offset:21504
    s_waitcnt lgkmcnt(3)
    v_mfma_f32_16x16x32_bf16 v[200:203], v[232:235], v[96:99], v[200:203]
    v_mfma_f32_16x16x32_bf16 v[204:207], v[232:235], v[100:103], v[204:207]
    ds_read_b128 v[224:227], v5 offset:22528
    s_mov_b32 s23, 0x20000
    buffer_load_dwordx4 v[28:31], v6, s[8:11], s23 offen offset:0 sc1
    s_waitcnt lgkmcnt(3)
    v_mfma_f32_16x16x32_bf16 v[208:211], v[236:239], v[96:99], v[208:211]
    s_add_u32 s16, s63, 0x572000
    v_mov_b32 v14, s28
    v_mov_b32 v15, 0
    s_mov_b64 exec, 1
    buffer_store_dword v14, v15, s[8:11], s16 offen sc1
    s_mov_b64 exec, -1
    v_mfma_f32_16x16x32_bf16 v[212:215], v[236:239], v[100:103], v[212:215]
    ds_read_b128 v[228:231], v5 offset:23552
    s_waitcnt lgkmcnt(3)
    v_mfma_f32_16x16x32_bf16 v[200:203], v[240:243], v[104:107], v[200:203]
    s_mov_b32 s23, 0x2000
    buffer_load_dwordx4 v[32:35], v6, s[8:11], s23 offen offset:0 sc1
    v_mfma_f32_16x16x32_bf16 v[204:207], v[240:243], v[108:111], v[204:207]
    ds_read_b128 v[232:235], v5 offset:24576
    s_waitcnt lgkmcnt(3)
    v_mfma_f32_16x16x32_bf16 v[208:211], v[244:247], v[104:107], v[208:211]
    v_mfma_f32_16x16x32_bf16 v[212:215], v[244:247], v[108:111], v[212:215]
    ds_read_b128 v[236:239], v5 offset:25600
    s_mov_b32 s23, 0x22000
    buffer_load_dwordx4 v[36:39], v6, s[8:11], s23 offen offset:0 sc1
    s_waitcnt lgkmcnt(3)
    v_mfma_f32_16x16x32_bf16 v[200:203], v[224:227], v[112:115], v[200:203]
    v_mfma_f32_16x16x32_bf16 v[204:207], v[224:227], v[116:119], v[204:207]
    ds_read_b128 v[240:243], v5 offset:26624
    s_waitcnt lgkmcnt(3)
    v_mfma_f32_16x16x32_bf16 v[208:211], v[228:231], v[112:115], v[208:211]
    s_mov_b32 s23, 0x4000
    buffer_load_dwordx4 v[40:43], v6, s[8:11], s23 offen offset:0 sc1
    v_mfma_f32_16x16x32_bf16 v[212:215], v[228:231], v[116:119], v[212:215]
    ds_read_b128 v[244:247], v5 offset:27648
    s_waitcnt lgkmcnt(3)
    v_mfma_f32_16x16x32_bf16 v[200:203], v[232:235], v[120:123], v[200:203]
    v_mfma_f32_16x16x32_bf16 v[204:207], v[232:235], v[124:127], v[204:207]
    ds_read_b128 v[224:227], v5 offset:28672
    s_mov_b32 s23, 0x24000
    buffer_load_dwordx4 v[44:47], v6, s[8:11], s23 offen offset:0 sc1
    s_waitcnt lgkmcnt(3)
    v_mfma_f32_16x16x32_bf16 v[208:211], v[236:239], v[120:123], v[208:211]
    v_mfma_f32_16x16x32_bf16 v[212:215], v[236:239], v[124:127], v[212:215]
    ds_read_b128 v[228:231], v5 offset:29696
    s_waitcnt lgkmcnt(3)
    v_mfma_f32_16x16x32_bf16 v[200:203], v[240:243], v[128:131], v[200:203]
    s_mov_b32 s23, 0x6000
    buffer_load_dwordx4 v[48:51], v6, s[8:11], s23 offen offset:0 sc1
    v_mfma_f32_16x16x32_bf16 v[204:207], v[240:243], v[132:135], v[204:207]
    ds_read_b128 v[232:235], v5 offset:30720
    s_waitcnt lgkmcnt(3)
    v_mfma_f32_16x16x32_bf16 v[208:211], v[244:247], v[128:131], v[208:211]
    v_mfma_f32_16x16x32_bf16 v[212:215], v[244:247], v[132:135], v[212:215]
    ds_read_b128 v[236:239], v5 offset:31744
    s_mov_b32 s23, 0x26000
    buffer_load_dwordx4 v[52:55], v6, s[8:11], s23 offen offset:0 sc1
    s_waitcnt lgkmcnt(3)
    v_mfma_f32_16x16x32_bf16 v[200:203], v[224:227], v[136:139], v[200:203]
    v_bfe_u32 v18, v1, 2, 2
    v_lshrrev_b32 v19, 4, v1
    v_mfma_f32_16x16x32_bf16 v[204:207], v[224:227], v[140:143], v[204:207]
    v_and_b32 v17, 3, v1
    v_lshlrev_b32 v16, 11, v19
    s_waitcnt lgkmcnt(2)
    v_mfma_f32_16x16x32_bf16 v[208:211], v[228:231], v[136:139], v[208:211]
    v_lshl_add_u32 v16, v18, 6, v16
    v_lshl_add_u32 v16, v17, 3, v16
    v_mfma_f32_16x16x32_bf16 v[212:215], v[228:231], v[140:143], v[212:215]
    v_add_u32 v16, 0x10000, v16
    v_and_b32 v19, 1, v19
    s_waitcnt lgkmcnt(1)
    v_mfma_f32_16x16x32_bf16 v[200:203], v[232:235], v[144:147], v[200:203]
    v_lshlrev_b32 v19, 5, v19
    v_sub_u32 v5, v16, v19
    v_mfma_f32_16x16x32_bf16 v[204:207], v[232:235], v[148:151], v[204:207]
    v_add_u32 v4, v16, v19
    v_add_u32 v7, 0x10000, v4
    s_waitcnt lgkmcnt(0)
    v_mfma_f32_16x16x32_bf16 v[208:211], v[236:239], v[144:147], v[208:211]
    v_add_u32 v8, 0x10000, v5
    v_mfma_f32_16x16x32_bf16 v[212:215], v[236:239], v[148:151], v[212:215]
    v_mul_f32 v200, v200, v9
    v_mul_f32 v201, v201, v9
    v_mul_f32 v202, v202, v9
    v_mul_f32 v203, v203, v9
    s_nop 1
    v_mul_f32 v208, v208, v9
    v_mul_f32 v209, v209, v9
    v_mul_f32 v210, v210, v9
    v_mul_f32 v211, v211, v9
    v_cvt_pk_bf16_f32 v216, v200, v201
    v_cvt_pk_bf16_f32 v217, v202, v203
    v_cvt_pk_bf16_f32 v218, v208, v209
    v_cvt_pk_bf16_f32 v219, v210, v211
    buffer_store_dwordx4 v[216:219], v2, s[8:11], s25 offen offset:3072 sc1
    v_mul_f32 v204, v204, v10
    v_mul_f32 v205, v205, v10
    v_mul_f32 v206, v206, v10
    v_mul_f32 v207, v207, v10
    v_mul_f32 v212, v212, v10
    v_mul_f32 v213, v213, v10
    v_mul_f32 v214, v214, v10
    v_mul_f32 v215, v215, v10
    v_cvt_pk_bf16_f32 v220, v204, v205
    v_cvt_pk_bf16_f32 v221, v206, v207
    v_cvt_pk_bf16_f32 v222, v212, v213
    v_cvt_pk_bf16_f32 v223, v214, v215
    buffer_store_dwordx4 v[220:223], v2, s[8:11], s26 offen offset:3072 sc1
    s_and_b32 s15, s2, 1
    s_barrier
    ds_read_b64_tr_b16 v[224:225], v4 offset:0
    ds_read_b64_tr_b16 v[226:227], v4 offset:1024
    ds_read_b64_tr_b16 v[228:229], v5 offset:32
    ds_read_b64_tr_b16 v[230:231], v5 offset:1056
    ds_read_b64_tr_b16 v[232:233], v4 offset:256
    ds_read_b64_tr_b16 v[234:235], v4 offset:1280
    ds_read_b64_tr_b16 v[236:237], v5 offset:288
    ds_read_b64_tr_b16 v[238:239], v5 offset:1312
    s_waitcnt vmcnt(11) lgkmcnt(6)
    v_mfma_f32_16x16x32_bf16 v[88:91], v[224:227], v[24:27], 0
    ds_read_b64_tr_b16 v[240:241], v4 offset:512
    s_waitcnt vmcnt(9)
    v_mfma_f32_16x16x32_bf16 v[92:95], v[224:227], v[28:31], 0
    s_add_u32 s22, s24, 0x200000
    s_add_u32 m0, s20, 0x20000
    s_nop 0
    buffer_load_dwordx4 v3, s[4:7], s22 offen lds
    ds_read_b64_tr_b16 v[242:243], v4 offset:1536
    s_waitcnt lgkmcnt(6)
    v_mfma_f32_16x16x32_bf16 v[96:99], v[228:231], v[24:27], 0
    ds_read_b64_tr_b16 v[244:245], v5 offset:544
    s_mov_b32 s23, 0x8000
    buffer_load_dwordx4 v[56:59], v6, s[8:11], s23 offen offset:0 sc1
    v_mfma_f32_16x16x32_bf16 v[100:103], v[228:231], v[28:31], 0
    ds_read_b64_tr_b16 v[246:247], v5 offset:1568
    s_waitcnt lgkmcnt(6)
    v_mfma_f32_16x16x32_bf16 v[104:107], v[232:235], v[24:27], 0
    s_add_u32 s22, s24, 0x202000
    s_add_u32 m0, s20, 0x20400
    s_nop 0
    buffer_load_dwordx4 v3, s[4:7], s22 offen lds
    ds_read_b64_tr_b16 v[224:225], v4 offset:768
    v_mfma_f32_16x16x32_bf16 v[108:111], v[232:235], v[28:31], 0
    ds_read_b64_tr_b16 v[226:227], v4 offset:1792
    s_mov_b32 s23, 0x28000
    buffer_load_dwordx4 v[60:63], v6, s[8:11], s23 offen offset:0 sc1
    s_waitcnt lgkmcnt(6)
    v_mfma_f32_16x16x32_bf16 v[112:115], v[236:239], v[24:27], 0
    ds_read_b64_tr_b16 v[228:229], v5 offset:800
    v_mfma_f32_16x16x32_bf16 v[116:119], v[236:239], v[28:31], 0
    ds_read_b64_tr_b16 v[230:231], v5 offset:1824
    s_waitcnt lgkmcnt(6)
    v_mfma_f32_16x16x32_bf16 v[120:123], v[240:243], v[24:27], 0
    v_mfma_f32_16x16x32_bf16 v[124:127], v[240:243], v[28:31], 0
    s_barrier
    ds_read_b64_tr_b16 v[232:233], v4 offset:16384
    ds_read_b64_tr_b16 v[234:235], v4 offset:17408
    s_waitcnt lgkmcnt(6)
    v_mfma_f32_16x16x32_bf16 v[128:131], v[244:247], v[24:27], 0
    s_add_u32 s22, s24, 0x280000
    s_add_u32 m0, s20, 0x24000
    s_nop 0
    buffer_load_dwordx4 v3, s[4:7], s22 offen lds
    ds_read_b64_tr_b16 v[236:237], v5 offset:16416
    v_mfma_f32_16x16x32_bf16 v[132:135], v[244:247], v[28:31], 0
    ds_read_b64_tr_b16 v[238:239], v5 offset:17440
    s_waitcnt lgkmcnt(6)
    v_mfma_f32_16x16x32_bf16 v[136:139], v[224:227], v[24:27], 0
    ds_read_b64_tr_b16 v[240:241], v4 offset:16640
    v_mfma_f32_16x16x32_bf16 v[140:143], v[224:227], v[28:31], 0
    s_add_u32 s22, s24, 0x282000
    s_add_u32 m0, s20, 0x24400
    s_nop 0
    buffer_load_dwordx4 v3, s[4:7], s22 offen lds
    ds_read_b64_tr_b16 v[242:243], v4 offset:17664
    s_waitcnt lgkmcnt(6)
    v_mfma_f32_16x16x32_bf16 v[144:147], v[228:231], v[24:27], 0
    ds_read_b64_tr_b16 v[244:245], v5 offset:16672
    v_mfma_f32_16x16x32_bf16 v[148:151], v[228:231], v[28:31], 0
    ds_read_b64_tr_b16 v[246:247], v5 offset:17696
    s_waitcnt vmcnt(13) lgkmcnt(6)
    v_mfma_f32_16x16x32_bf16 v[88:91], v[232:235], v[32:35], v[88:91]
    ds_read_b64_tr_b16 v[224:225], v4 offset:16896
    s_waitcnt vmcnt(12)
    v_mfma_f32_16x16x32_bf16 v[92:95], v[232:235], v[36:39], v[92:95]
    ds_read_b64_tr_b16 v[226:227], v4 offset:17920
    s_waitcnt lgkmcnt(6)
    v_mfma_f32_16x16x32_bf16 v[96:99], v[236:239], v[32:35], v[96:99]
    ds_read_b64_tr_b16 v[228:229], v5 offset:16928
    s_mov_b32 s23, 0xa000
    buffer_load_dwordx4 v[24:27], v6, s[8:11], s23 offen offset:0 sc1
    v_mfma_f32_16x16x32_bf16 v[100:103], v[236:239], v[36:39], v[100:103]
    ds_read_b64_tr_b16 v[230:231], v5 offset:17952
    s_waitcnt lgkmcnt(6)
    v_mfma_f32_16x16x32_bf16 v[104:107], v[240:243], v[32:35], v[104:107]
    ds_read_b64_tr_b16 v[232:233], v4 offset:17152
    v_mfma_f32_16x16x32_bf16 v[108:111], v[240:243], v[36:39], v[108:111]
    ds_read_b64_tr_b16 v[234:235], v4 offset:18176
    s_mov_b32 s23, 0x2a000
    buffer_load_dwordx4 v[28:31], v6, s[8:11], s23 offen offset:0 sc1
    s_waitcnt lgkmcnt(6)
    v_mfma_f32_16x16x32_bf16 v[112:115], v[244:247], v[32:35], v[112:115]
    ds_read_b64_tr_b16 v[236:237], v5 offset:17184
    v_mfma_f32_16x16x32_bf16 v[116:119], v[244:247], v[36:39], v[116:119]
    ds_read_b64_tr_b16 v[238:239], v5 offset:18208
    s_waitcnt lgkmcnt(6)
    v_mfma_f32_16x16x32_bf16 v[120:123], v[224:227], v[32:35], v[120:123]
    v_mfma_f32_16x16x32_bf16 v[124:127], v[224:227], v[36:39], v[124:127]
    s_barrier
    ds_read_b64_tr_b16 v[240:241], v4 offset:32768
    ds_read_b64_tr_b16 v[242:243], v4 offset:33792
    s_waitcnt lgkmcnt(6)
    v_mfma_f32_16x16x32_bf16 v[128:131], v[228:231], v[32:35], v[128:131]
    s_add_u32 s22, s24, 0x300000
    s_add_u32 m0, s20, 0x10000
    s_nop 0
    buffer_load_dwordx4 v3, s[4:7], s22 offen lds
    ds_read_b64_tr_b16 v[244:245], v5 offset:32800
    v_mfma_f32_16x16x32_bf16 v[132:135], v[228:231], v[36:39], v[132:135]
    ds_read_b64_tr_b16 v[246:247], v5 offset:33824
    s_waitcnt lgkmcnt(6)
    v_mfma_f32_16x16x32_bf16 v[136:139], v[232:235], v[32:35], v[136:139]
    ds_read_b64_tr_b16 v[224:225], v4 offset:33024
    v_mfma_f32_16x16x32_bf16 v[140:143], v[232:235], v[36:39], v[140:143]
    s_add_u32 s22, s24, 0x302000
    s_add_u32 m0, s20, 0x10400
    s_nop 0
    buffer_load_dwordx4 v3, s[4:7], s22 offen lds
    ds_read_b64_tr_b16 v[226:227], v4 offset:34048
    s_waitcnt lgkmcnt(6)
    v_mfma_f32_16x16x32_bf16 v[144:147], v[236:239], v[32:35], v[144:147]
    s_add_u32 s16, s63, 0x574000
    v_mov_b32 v14, s28
    v_mov_b32 v15, 0
    s_mov_b64 exec, 1
    buffer_store_dword v14, v15, s[8:11], s16 offen sc1
    s_mov_b64 exec, -1
    ds_read_b64_tr_b16 v[228:229], v5 offset:33056
    v_mfma_f32_16x16x32_bf16 v[148:151], v[236:239], v[36:39], v[148:151]
    ds_read_b64_tr_b16 v[230:231], v5 offset:34080
    s_waitcnt vmcnt(16) lgkmcnt(6)
    v_mfma_f32_16x16x32_bf16 v[88:91], v[240:243], v[40:43], v[88:91]
    ds_read_b64_tr_b16 v[232:233], v4 offset:33280
    s_waitcnt vmcnt(15)
    v_mfma_f32_16x16x32_bf16 v[92:95], v[240:243], v[44:47], v[92:95]
    ds_read_b64_tr_b16 v[234:235], v4 offset:34304
    s_waitcnt lgkmcnt(6)
    v_mfma_f32_16x16x32_bf16 v[96:99], v[244:247], v[40:43], v[96:99]
    ds_read_b64_tr_b16 v[236:237], v5 offset:33312
    s_mov_b32 s23, 0xc000
    buffer_load_dwordx4 v[32:35], v6, s[8:11], s23 offen offset:0 sc1
    v_mfma_f32_16x16x32_bf16 v[100:103], v[244:247], v[44:47], v[100:103]
    ds_read_b64_tr_b16 v[238:239], v5 offset:34336
    s_waitcnt lgkmcnt(6)
    v_mfma_f32_16x16x32_bf16 v[104:107], v[224:227], v[40:43], v[104:107]
    ds_read_b64_tr_b16 v[240:241], v4 offset:33536
    v_mfma_f32_16x16x32_bf16 v[108:111], v[224:227], v[44:47], v[108:111]
    ds_read_b64_tr_b16 v[242:243], v4 offset:34560
    s_mov_b32 s23, 0x2c000
    buffer_load_dwordx4 v[36:39], v6, s[8:11], s23 offen offset:0 sc1
    s_waitcnt lgkmcnt(6)
    v_mfma_f32_16x16x32_bf16 v[112:115], v[228:231], v[40:43], v[112:115]
    ds_read_b64_tr_b16 v[244:245], v5 offset:33568
    v_mfma_f32_16x16x32_bf16 v[116:119], v[228:231], v[44:47], v[116:119]
    ds_read_b64_tr_b16 v[246:247], v5 offset:34592
    s_waitcnt lgkmcnt(6)
    v_mfma_f32_16x16x32_bf16 v[120:123], v[232:235], v[40:43], v[120:123]
    v_mfma_f32_16x16x32_bf16 v[124:127], v[232:235], v[44:47], v[124:127]
    s_barrier
    ds_read_b64_tr_b16 v[224:225], v4 offset:49152
    ds_read_b64_tr_b16 v[226:227], v4 offset:50176
    s_add_u32 s19, s19, 8192
    buffer_load_dword v12, v13, s[8:11], s19 offen sc1
    s_waitcnt lgkmcnt(6)
    v_mfma_f32_16x16x32_bf16 v[128:131], v[236:239], v[40:43], v[128:131]
    s_add_u32 s22, s24, 0x380000
    s_add_u32 m0, s20, 0x14000
    s_nop 0
    buffer_load_dwordx4 v3, s[4:7], s22 offen lds
    ds_read_b64_tr_b16 v[228:229], v5 offset:49184
    v_mfma_f32_16x16x32_bf16 v[132:135], v[236:239], v[44:47], v[132:135]
    ds_read_b64_tr_b16 v[230:231], v5 offset:50208
    s_waitcnt lgkmcnt(6)
    v_mfma_f32_16x16x32_bf16 v[136:139], v[240:243], v[40:43], v[136:139]
    ds_read_b64_tr_b16 v[232:233], v4 offset:49408
    v_mfma_f32_16x16x32_bf16 v[140:143], v[240:243], v[44:47], v[140:143]
    s_add_u32 s22, s24, 0x382000
    s_add_u32 m0, s20, 0x14400
    s_nop 0
    buffer_load_dwordx4 v3, s[4:7], s22 offen lds
    ds_read_b64_tr_b16 v[234:235], v4 offset:50432
    s_waitcnt lgkmcnt(6)
    v_mfma_f32_16x16x32_bf16 v[144:147], v[244:247], v[40:43], v[144:147]
    ds_read_b64_tr_b16 v[236:237], v5 offset:49440
    v_mfma_f32_16x16x32_bf16 v[148:151], v[244:247], v[44:47], v[148:151]
    ds_read_b64_tr_b16 v[238:239], v5 offset:50464
    s_waitcnt vmcnt(19) lgkmcnt(6)
    v_mfma_f32_16x16x32_bf16 v[88:91], v[224:227], v[48:51], v[88:91]
    ds_read_b64_tr_b16 v[240:241], v4 offset:49664
    s_waitcnt vmcnt(18)
    v_mfma_f32_16x16x32_bf16 v[92:95], v[224:227], v[52:55], v[92:95]
    ds_read_b64_tr_b16 v[242:243], v4 offset:50688
    s_waitcnt lgkmcnt(6)
    v_mfma_f32_16x16x32_bf16 v[96:99], v[228:231], v[48:51], v[96:99]
    ds_read_b64_tr_b16 v[244:245], v5 offset:49696
    s_mov_b32 s23, 0xe000
    buffer_load_dwordx4 v[40:43], v6, s[8:11], s23 offen offset:0 sc1
    v_mfma_f32_16x16x32_bf16 v[100:103], v[228:231], v[52:55], v[100:103]
    ds_read_b64_tr_b16 v[246:247], v5 offset:50720
    s_waitcnt lgkmcnt(6)
    v_mfma_f32_16x16x32_bf16 v[104:107], v[232:235], v[48:51], v[104:107]
    ds_read_b64_tr_b16 v[224:225], v4 offset:49920
    v_mfma_f32_16x16x32_bf16 v[108:111], v[232:235], v[52:55], v[108:111]
    ds_read_b64_tr_b16 v[226:227], v4 offset:50944
    s_mov_b32 s23, 0x2e000
    buffer_load_dwordx4 v[44:47], v6, s[8:11], s23 offen offset:0 sc1
    s_waitcnt lgkmcnt(6)
    v_mfma_f32_16x16x32_bf16 v[112:115], v[236:239], v[48:51], v[112:115]
    ds_read_b64_tr_b16 v[228:229], v5 offset:49952
    v_mfma_f32_16x16x32_bf16 v[116:119], v[236:239], v[52:55], v[116:119]
    ds_read_b64_tr_b16 v[230:231], v5 offset:50976
    s_waitcnt lgkmcnt(6)
    v_mfma_f32_16x16x32_bf16 v[120:123], v[240:243], v[48:51], v[120:123]
    v_mfma_f32_16x16x32_bf16 v[124:127], v[240:243], v[52:55], v[124:127]
    s_waitcnt vmcnt(15)
    s_barrier
    ds_read_b64_tr_b16 v[232:233], v7 offset:0
    ds_read_b64_tr_b16 v[234:235], v7 offset:1024
    s_waitcnt lgkmcnt(6)
    v_mfma_f32_16x16x32_bf16 v[128:131], v[244:247], v[48:51], v[128:131]
    s_add_u32 s22, s24, 0x10000
    s_add_u32 m0, s20, 0x18000
    s_nop 0
    buffer_load_dwordx4 v3, s[4:7], s22 offen lds
    ds_read_b64_tr_b16 v[236:237], v8 offset:32
    v_mfma_f32_16x16x32_bf16 v[132:135], v[244:247], v[52:55], v[132:135]
    ds_read_b64_tr_b16 v[238:239], v8 offset:1056
    s_waitcnt lgkmcnt(6)
    v_mfma_f32_16x16x32_bf16 v[136:139], v[224:227], v[48:51], v[136:139]
    ds_read_b64_tr_b16 v[240:241], v7 offset:256
    v_mfma_f32_16x16x32_bf16 v[140:143], v[224:227], v[52:55], v[140:143]
    s_add_u32 s22, s24, 0x12000
    s_add_u32 m0, s20, 0x18400
    s_nop 0
    buffer_load_dwordx4 v3, s[4:7], s22 offen lds
    ds_read_b64_tr_b16 v[242:243], v7 offset:1280
    s_waitcnt lgkmcnt(6)
    v_mfma_f32_16x16x32_bf16 v[144:147], v[228:231], v[48:51], v[144:147]
    ds_read_b64_tr_b16 v[244:245], v8 offset:288
    v_mfma_f32_16x16x32_bf16 v[148:151], v[228:231], v[52:55], v[148:151]
    ds_read_b64_tr_b16 v[246:247], v8 offset:1312
    s_waitcnt vmcnt(6)
    v_cmp_ne_u32 vcc, s28, v12
    s_cbranch_vccnz adaLN_cond__sliding_block_cached__moe_arch_mod__prompt_kernel_o27r
adaLN_cond__sliding_block_cached__moe_arch_mod__prompt_kernel_o27b:
    s_waitcnt lgkmcnt(6)
    v_mfma_f32_16x16x32_bf16 v[88:91], v[232:235], v[56:59], v[88:91]
    ds_read_b64_tr_b16 v[224:225], v7 offset:512
    v_mfma_f32_16x16x32_bf16 v[92:95], v[232:235], v[60:63], v[92:95]
    ds_read_b64_tr_b16 v[226:227], v7 offset:1536
    s_waitcnt lgkmcnt(6)
    v_mfma_f32_16x16x32_bf16 v[96:99], v[236:239], v[56:59], v[96:99]
    ds_read_b64_tr_b16 v[228:229], v8 offset:544
    s_mov_b32 s23, 0x0
    buffer_load_dwordx4 v[48:51], v6, s[8:11], s23 offen offset:1024 sc1
    v_mfma_f32_16x16x32_bf16 v[100:103], v[236:239], v[60:63], v[100:103]
    ds_read_b64_tr_b16 v[230:231], v8 offset:1568
    s_waitcnt lgkmcnt(6)
    v_mfma_f32_16x16x32_bf16 v[104:107], v[240:243], v[56:59], v[104:107]
    ds_read_b64_tr_b16 v[232:233], v7 offset:768
    v_mfma_f32_16x16x32_bf16 v[108:111], v[240:243], v[60:63], v[108:111]
    ds_read_b64_tr_b16 v[234:235], v7 offset:1792
    s_mov_b32 s23, 0x20000
    buffer_load_dwordx4 v[52:55], v6, s[8:11], s23 offen offset:1024 sc1
    s_waitcnt lgkmcnt(6)
    v_mfma_f32_16x16x32_bf16 v[112:115], v[244:247], v[56:59], v[112:115]
    ds_read_b64_tr_b16 v[236:237], v8 offset:800
    v_mfma_f32_16x16x32_bf16 v[116:119], v[244:247], v[60:63], v[116:119]
    ds_read_b64_tr_b16 v[238:239], v8 offset:1824
    s_waitcnt lgkmcnt(6)
    v_mfma_f32_16x16x32_bf16 v[120:123], v[224:227], v[56:59], v[120:123]
    v_mfma_f32_16x16x32_bf16 v[124:127], v[224:227], v[60:63], v[124:127]
    s_barrier
    ds_read_b64_tr_b16 v[240:241], v7 offset:16384
    ds_read_b64_tr_b16 v[242:243], v7 offset:17408
    s_waitcnt lgkmcnt(6)
    v_mfma_f32_16x16x32_bf16 v[128:131], v[228:231], v[56:59], v[128:131]
    s_add_u32 s22, s24, 0x90000
    s_add_u32 m0, s20, 0x1c000
    s_nop 0
    buffer_load_dwordx4 v3, s[4:7], s22 offen lds
    ds_read_b64_tr_b16 v[244:245], v8 offset:16416
    v_mfma_f32_16x16x32_bf16 v[132:135], v[228:231], v[60:63], v[132:135]
    ds_read_b64_tr_b16 v[246:247], v8 offset:17440
    s_waitcnt lgkmcnt(6)
    v_mfma_f32_16x16x32_bf16 v[136:139], v[232:235], v[56:59], v[136:139]
    ds_read_b64_tr_b16 v[224:225], v7 offset:16640
    v_mfma_f32_16x16x32_bf16 v[140:143], v[232:235], v[60:63], v[140:143]
    s_add_u32 s22, s24, 0x92000
    s_add_u32 m0, s20, 0x1c400
    s_nop 0
    buffer_load_dwordx4 v3, s[4:7], s22 offen lds
    ds_read_b64_tr_b16 v[226:227], v7 offset:17664
    s_waitcnt lgkmcnt(6)
    v_mfma_f32_16x16x32_bf16 v[144:147], v[236:239], v[56:59], v[144:147]
    ds_read_b64_tr_b16 v[228:229], v8 offset:16672
    v_mfma_f32_16x16x32_bf16 v[148:151], v[236:239], v[60:63], v[148:151]
    ds_read_b64_tr_b16 v[230:231], v8 offset:17696
    s_waitcnt lgkmcnt(6)
    v_mfma_f32_16x16x32_bf16 v[88:91], v[240:243], v[24:27], v[88:91]
    ds_read_b64_tr_b16 v[232:233], v7 offset:16896
    v_mfma_f32_16x16x32_bf16 v[92:95], v[240:243], v[28:31], v[92:95]
    ds_read_b64_tr_b16 v[234:235], v7 offset:17920
    s_waitcnt lgkmcnt(6)
    v_mfma_f32_16x16x32_bf16 v[96:99], v[244:247], v[24:27], v[96:99]
    ds_read_b64_tr_b16 v[236:237], v8 offset:16928
    s_mov_b32 s23, 0x2000
    buffer_load_dwordx4 v[56:59], v6, s[8:11], s23 offen offset:1024 sc1
    v_mfma_f32_16x16x32_bf16 v[100:103], v[244:247], v[28:31], v[100:103]
    ds_read_b64_tr_b16 v[238:239], v8 offset:17952
    s_waitcnt lgkmcnt(6)
    v_mfma_f32_16x16x32_bf16 v[104:107], v[224:227], v[24:27], v[104:107]
    ds_read_b64_tr_b16 v[240:241], v7 offset:17152
    v_mfma_f32_16x16x32_bf16 v[108:111], v[224:227], v[28:31], v[108:111]
    ds_read_b64_tr_b16 v[242:243], v7 offset:18176
    s_mov_b32 s23, 0x22000
    buffer_load_dwordx4 v[60:63], v6, s[8:11], s23 offen offset:1024 sc1
    s_waitcnt lgkmcnt(6)
    v_mfma_f32_16x16x32_bf16 v[112:115], v[228:231], v[24:27], v[112:115]
    ds_read_b64_tr_b16 v[244:245], v8 offset:17184
    v_mfma_f32_16x16x32_bf16 v[116:119], v[228:231], v[28:31], v[116:119]
    ds_read_b64_tr_b16 v[246:247], v8 offset:18208
    s_waitcnt lgkmcnt(6)
    v_mfma_f32_16x16x32_bf16 v[120:123], v[232:235], v[24:27], v[120:123]
    v_mfma_f32_16x16x32_bf16 v[124:127], v[232:235], v[28:31], v[124:127]
    s_barrier
    ds_read_b64_tr_b16 v[224:225], v4 offset:0
    ds_read_b64_tr_b16 v[226:227], v4 offset:1024
    s_waitcnt lgkmcnt(6)
    v_mfma_f32_16x16x32_bf16 v[128:131], v[236:239], v[24:27], v[128:131]
    s_add_u32 s16, s63, 0x576000
    v_mov_b32 v14, s28
    v_mov_b32 v15, 0
    s_mov_b64 exec, 1
    buffer_store_dword v14, v15, s[8:11], s16 offen sc1
    s_mov_b64 exec, -1
    s_add_u32 s22, s24, 0x110000
    s_add_u32 m0, s20, 0x20000
    s_nop 0
    buffer_load_dwordx4 v3, s[4:7], s22 offen lds
    ds_read_b64_tr_b16 v[228:229], v5 offset:32
    v_mfma_f32_16x16x32_bf16 v[132:135], v[236:239], v[28:31], v[132:135]
    ds_read_b64_tr_b16 v[230:231], v5 offset:1056
    s_waitcnt lgkmcnt(6)
    v_mfma_f32_16x16x32_bf16 v[136:139], v[240:243], v[24:27], v[136:139]
    ds_read_b64_tr_b16 v[232:233], v4 offset:256
    v_mfma_f32_16x16x32_bf16 v[140:143], v[240:243], v[28:31], v[140:143]
    s_add_u32 s22, s24, 0x112000
    s_add_u32 m0, s20, 0x20400
    s_nop 0
    buffer_load_dwordx4 v3, s[4:7], s22 offen lds
    ds_read_b64_tr_b16 v[234:235], v4 offset:1280
    s_waitcnt lgkmcnt(6)
    v_mfma_f32_16x16x32_bf16 v[144:147], v[244:247], v[24:27], v[144:147]
    ds_read_b64_tr_b16 v[236:237], v5 offset:288
    v_mfma_f32_16x16x32_bf16 v[148:151], v[244:247], v[28:31], v[148:151]
    ds_read_b64_tr_b16 v[238:239], v5 offset:1312
    s_waitcnt lgkmcnt(6)
    v_mfma_f32_16x16x32_bf16 v[88:91], v[224:227], v[32:35], v[88:91]
    ds_read_b64_tr_b16 v[240:241], v4 offset:512
    v_mfma_f32_16x16x32_bf16 v[92:95], v[224:227], v[36:39], v[92:95]
    ds_read_b64_tr_b16 v[242:243], v4 offset:1536
    s_waitcnt lgkmcnt(6)
    v_mfma_f32_16x16x32_bf16 v[96:99], v[228:231], v[32:35], v[96:99]
    ds_read_b64_tr_b16 v[244:245], v5 offset:544
    s_mov_b32 s23, 0x4000
    buffer_load_dwordx4 v[24:27], v6, s[8:11], s23 offen offset:1024 sc1
    v_mfma_f32_16x16x32_bf16 v[100:103], v[228:231], v[36:39], v[100:103]
    ds_read_b64_tr_b16 v[246:247], v5 offset:1568
    s_waitcnt lgkmcnt(6)
    v_mfma_f32_16x16x32_bf16 v[104:107], v[232:235], v[32:35], v[104:107]
    ds_read_b64_tr_b16 v[224:225], v4 offset:768
    v_mfma_f32_16x16x32_bf16 v[108:111], v[232:235], v[36:39], v[108:111]
    ds_read_b64_tr_b16 v[226:227], v4 offset:1792
    s_mov_b32 s23, 0x24000
    buffer_load_dwordx4 v[28:31], v6, s[8:11], s23 offen offset:1024 sc1
    s_waitcnt lgkmcnt(6)
    v_mfma_f32_16x16x32_bf16 v[112:115], v[236:239], v[32:35], v[112:115]
    ds_read_b64_tr_b16 v[228:229], v5 offset:800
    v_mfma_f32_16x16x32_bf16 v[116:119], v[236:239], v[36:39], v[116:119]
    ds_read_b64_tr_b16 v[230:231], v5 offset:1824
    s_waitcnt lgkmcnt(6)
    v_mfma_f32_16x16x32_bf16 v[120:123], v[240:243], v[32:35], v[120:123]
    v_mfma_f32_16x16x32_bf16 v[124:127], v[240:243], v[36:39], v[124:127]
    s_waitcnt vmcnt(15)
    s_barrier
    ds_read_b64_tr_b16 v[232:233], v4 offset:16384
    ds_read_b64_tr_b16 v[234:235], v4 offset:17408
    s_waitcnt lgkmcnt(6)
    v_mfma_f32_16x16x32_bf16 v[128:131], v[244:247], v[32:35], v[128:131]
    s_add_u32 s22, s24, 0x190000
    s_add_u32 m0, s20, 0x24000
    s_nop 0
    buffer_load_dwordx4 v3, s[4:7], s22 offen lds
    ds_read_b64_tr_b16 v[236:237], v5 offset:16416
    v_mfma_f32_16x16x32_bf16 v[132:135], v[244:247], v[36:39], v[132:135]
    ds_read_b64_tr_b16 v[238:239], v5 offset:17440
    s_waitcnt lgkmcnt(6)
    v_mfma_f32_16x16x32_bf16 v[136:139], v[224:227], v[32:35], v[136:139]
    ds_read_b64_tr_b16 v[240:241], v4 offset:16640
    v_mfma_f32_16x16x32_bf16 v[140:143], v[224:227], v[36:39], v[140:143]
    s_add_u32 s22, s24, 0x192000
    s_add_u32 m0, s20, 0x24400
    s_nop 0
    buffer_load_dwordx4 v3, s[4:7], s22 offen lds
    ds_read_b64_tr_b16 v[242:243], v4 offset:17664
    s_waitcnt lgkmcnt(6)
    v_mfma_f32_16x16x32_bf16 v[144:147], v[228:231], v[32:35], v[144:147]
    ds_read_b64_tr_b16 v[244:245], v5 offset:16672
    v_mfma_f32_16x16x32_bf16 v[148:151], v[228:231], v[36:39], v[148:151]
    ds_read_b64_tr_b16 v[246:247], v5 offset:17696
    s_waitcnt vmcnt(16) lgkmcnt(6)
    v_mfma_f32_16x16x32_bf16 v[88:91], v[232:235], v[40:43], v[88:91]
    ds_read_b64_tr_b16 v[224:225], v4 offset:16896
    s_waitcnt vmcnt(15)
    v_mfma_f32_16x16x32_bf16 v[92:95], v[232:235], v[44:47], v[92:95]
    ds_read_b64_tr_b16 v[226:227], v4 offset:17920
    s_waitcnt lgkmcnt(6)
    v_mfma_f32_16x16x32_bf16 v[96:99], v[236:239], v[40:43], v[96:99]
    ds_read_b64_tr_b16 v[228:229], v5 offset:16928
    s_mov_b32 s23, 0x6000
    buffer_load_dwordx4 v[32:35], v6, s[8:11], s23 offen offset:1024 sc1
    v_mfma_f32_16x16x32_bf16 v[100:103], v[236:239], v[44:47], v[100:103]
    ds_read_b64_tr_b16 v[230:231], v5 offset:17952
    s_waitcnt lgkmcnt(6)
    v_mfma_f32_16x16x32_bf16 v[104:107], v[240:243], v[40:43], v[104:107]
    ds_read_b64_tr_b16 v[232:233], v4 offset:17152
    v_mfma_f32_16x16x32_bf16 v[108:111], v[240:243], v[44:47], v[108:111]
    ds_read_b64_tr_b16 v[234:235], v4 offset:18176
    s_mov_b32 s23, 0x26000
    buffer_load_dwordx4 v[36:39], v6, s[8:11], s23 offen offset:1024 sc1
    s_waitcnt lgkmcnt(6)
    v_mfma_f32_16x16x32_bf16 v[112:115], v[244:247], v[40:43], v[112:115]
    ds_read_b64_tr_b16 v[236:237], v5 offset:17184
    v_mfma_f32_16x16x32_bf16 v[116:119], v[244:247], v[44:47], v[116:119]
    ds_read_b64_tr_b16 v[238:239], v5 offset:18208
    s_waitcnt lgkmcnt(6)
    v_mfma_f32_16x16x32_bf16 v[120:123], v[224:227], v[40:43], v[120:123]
    v_mfma_f32_16x16x32_bf16 v[124:127], v[224:227], v[44:47], v[124:127]
    s_waitcnt vmcnt(15)
    s_barrier
    ds_read_b64_tr_b16 v[240:241], v4 offset:32768
    ds_read_b64_tr_b16 v[242:243], v4 offset:33792
    s_waitcnt lgkmcnt(6)
    v_mfma_f32_16x16x32_bf16 v[128:131], v[228:231], v[40:43], v[128:131]
    s_add_u32 s22, s24, 0x210000
    s_add_u32 m0, s20, 0x10000
    s_nop 0
    buffer_load_dwordx4 v3, s[4:7], s22 offen lds
    ds_read_b64_tr_b16 v[244:245], v5 offset:32800
    v_mfma_f32_16x16x32_bf16 v[132:135], v[228:231], v[44:47], v[132:135]
    ds_read_b64_tr_b16 v[246:247], v5 offset:33824
    s_waitcnt lgkmcnt(6)
    v_mfma_f32_16x16x32_bf16 v[136:139], v[232:235], v[40:43], v[136:139]
    ds_read_b64_tr_b16 v[224:225], v4 offset:33024
    v_mfma_f32_16x16x32_bf16 v[140:143], v[232:235], v[44:47], v[140:143]
    s_add_u32 s22, s24, 0x212000
    s_add_u32 m0, s20, 0x10400
    s_nop 0
    buffer_load_dwordx4 v3, s[4:7], s22 offen lds
    ds_read_b64_tr_b16 v[226:227], v4 offset:34048
    s_waitcnt lgkmcnt(6)
    v_mfma_f32_16x16x32_bf16 v[144:147], v[236:239], v[40:43], v[144:147]
    ds_read_b64_tr_b16 v[228:229], v5 offset:33056
    v_mfma_f32_16x16x32_bf16 v[148:151], v[236:239], v[44:47], v[148:151]
    ds_read_b64_tr_b16 v[230:231], v5 offset:34080
    s_waitcnt vmcnt(16) lgkmcnt(6)
    v_mfma_f32_16x16x32_bf16 v[88:91], v[240:243], v[48:51], v[88:91]
    ds_read_b64_tr_b16 v[232:233], v4 offset:33280
    s_waitcnt vmcnt(15)
    v_mfma_f32_16x16x32_bf16 v[92:95], v[240:243], v[52:55], v[92:95]
    ds_read_b64_tr_b16 v[234:235], v4 offset:34304
    s_waitcnt lgkmcnt(6)
    v_mfma_f32_16x16x32_bf16 v[96:99], v[244:247], v[48:51], v[96:99]
    ds_read_b64_tr_b16 v[236:237], v5 offset:33312
    s_mov_b32 s23, 0x8000
    buffer_load_dwordx4 v[40:43], v6, s[8:11], s23 offen offset:1024 sc1
    v_mfma_f32_16x16x32_bf16 v[100:103], v[244:247], v[52:55], v[100:103]
    ds_read_b64_tr_b16 v[238:239], v5 offset:34336
    s_waitcnt lgkmcnt(6)
    v_mfma_f32_16x16x32_bf16 v[104:107], v[224:227], v[48:51], v[104:107]
    ds_read_b64_tr_b16 v[240:241], v4 offset:33536
    v_mfma_f32_16x16x32_bf16 v[108:111], v[224:227], v[52:55], v[108:111]
    ds_read_b64_tr_b16 v[242:243], v4 offset:34560
    s_mov_b32 s23, 0x28000
    buffer_load_dwordx4 v[44:47], v6, s[8:11], s23 offen offset:1024 sc1
    s_waitcnt lgkmcnt(6)
    v_mfma_f32_16x16x32_bf16 v[112:115], v[228:231], v[48:51], v[112:115]
    ds_read_b64_tr_b16 v[244:245], v5 offset:33568
    v_mfma_f32_16x16x32_bf16 v[116:119], v[228:231], v[52:55], v[116:119]
    ds_read_b64_tr_b16 v[246:247], v5 offset:34592
    s_waitcnt lgkmcnt(6)
    v_mfma_f32_16x16x32_bf16 v[120:123], v[232:235], v[48:51], v[120:123]
    v_mfma_f32_16x16x32_bf16 v[124:127], v[232:235], v[52:55], v[124:127]
    s_waitcnt vmcnt(15)
    s_barrier
    ds_read_b64_tr_b16 v[224:225], v4 offset:49152
    ds_read_b64_tr_b16 v[226:227], v4 offset:50176
    s_waitcnt lgkmcnt(6)
    v_mfma_f32_16x16x32_bf16 v[128:131], v[236:239], v[48:51], v[128:131]
    s_add_u32 s22, s24, 0x290000
    s_add_u32 m0, s20, 0x14000
    s_nop 0
    buffer_load_dwordx4 v3, s[4:7], s22 offen lds
    ds_read_b64_tr_b16 v[228:229], v5 offset:49184
    v_mfma_f32_16x16x32_bf16 v[132:135], v[236:239], v[52:55], v[132:135]
    ds_read_b64_tr_b16 v[230:231], v5 offset:50208
    s_waitcnt lgkmcnt(6)
    v_mfma_f32_16x16x32_bf16 v[136:139], v[240:243], v[48:51], v[136:139]
    ds_read_b64_tr_b16 v[232:233], v4 offset:49408
    v_mfma_f32_16x16x32_bf16 v[140:143], v[240:243], v[52:55], v[140:143]
    s_add_u32 s22, s24, 0x292000
    s_add_u32 m0, s20, 0x14400
    s_nop 0
    buffer_load_dwordx4 v3, s[4:7], s22 offen lds
    ds_read_b64_tr_b16 v[234:235], v4 offset:50432
    s_waitcnt lgkmcnt(6)
    v_mfma_f32_16x16x32_bf16 v[144:147], v[244:247], v[48:51], v[144:147]
    ds_read_b64_tr_b16 v[236:237], v5 offset:49440
    v_mfma_f32_16x16x32_bf16 v[148:151], v[244:247], v[52:55], v[148:151]
    ds_read_b64_tr_b16 v[238:239], v5 offset:50464
    s_waitcnt vmcnt(16) lgkmcnt(6)
    v_mfma_f32_16x16x32_bf16 v[88:91], v[224:227], v[56:59], v[88:91]
    ds_read_b64_tr_b16 v[240:241], v4 offset:49664
    s_waitcnt vmcnt(15)
    v_mfma_f32_16x16x32_bf16 v[92:95], v[224:227], v[60:63], v[92:95]
    ds_read_b64_tr_b16 v[242:243], v4 offset:50688
    s_waitcnt lgkmcnt(6)
    v_mfma_f32_16x16x32_bf16 v[96:99], v[228:231], v[56:59], v[96:99]
    ds_read_b64_tr_b16 v[244:245], v5 offset:49696
    s_mov_b32 s23, 0xa000
    buffer_load_dwordx4 v[48:51], v6, s[8:11], s23 offen offset:1024 sc1
    v_mfma_f32_16x16x32_bf16 v[100:103], v[228:231], v[60:63], v[100:103]
    ds_read_b64_tr_b16 v[246:247], v5 offset:50720
    s_waitcnt lgkmcnt(6)
    v_mfma_f32_16x16x32_bf16 v[104:107], v[232:235], v[56:59], v[104:107]
    ds_read_b64_tr_b16 v[224:225], v4 offset:49920
    v_mfma_f32_16x16x32_bf16 v[108:111], v[232:235], v[60:63], v[108:111]
    ds_read_b64_tr_b16 v[226:227], v4 offset:50944
    s_mov_b32 s23, 0x2a000
    buffer_load_dwordx4 v[52:55], v6, s[8:11], s23 offen offset:1024 sc1
    s_waitcnt lgkmcnt(6)
    v_mfma_f32_16x16x32_bf16 v[112:115], v[236:239], v[56:59], v[112:115]
    ds_read_b64_tr_b16 v[228:229], v5 offset:49952
    v_mfma_f32_16x16x32_bf16 v[116:119], v[236:239], v[60:63], v[116:119]
    ds_read_b64_tr_b16 v[230:231], v5 offset:50976
    s_waitcnt lgkmcnt(6)
    v_mfma_f32_16x16x32_bf16 v[120:123], v[240:243], v[56:59], v[120:123]
    v_mfma_f32_16x16x32_bf16 v[124:127], v[240:243], v[60:63], v[124:127]
    s_waitcnt vmcnt(14)
    s_barrier
    ds_read_b64_tr_b16 v[232:233], v7 offset:0
    ds_read_b64_tr_b16 v[234:235], v7 offset:1024
    s_waitcnt lgkmcnt(6)
    v_mfma_f32_16x16x32_bf16 v[128:131], v[244:247], v[56:59], v[128:131]
    s_add_u32 s22, s24, 0x310000
    s_add_u32 m0, s20, 0x18000
    s_nop 0
    buffer_load_dwordx4 v3, s[4:7], s22 offen lds
    ds_read_b64_tr_b16 v[236:237], v8 offset:32
    v_mfma_f32_16x16x32_bf16 v[132:135], v[244:247], v[60:63], v[132:135]
    ds_read_b64_tr_b16 v[238:239], v8 offset:1056
    s_waitcnt lgkmcnt(6)
    v_mfma_f32_16x16x32_bf16 v[136:139], v[224:227], v[56:59], v[136:139]
    ds_read_b64_tr_b16 v[240:241], v7 offset:256
    v_mfma_f32_16x16x32_bf16 v[140:143], v[224:227], v[60:63], v[140:143]
    s_add_u32 s22, s24, 0x312000
    s_add_u32 m0, s20, 0x18400
    s_nop 0
    buffer_load_dwordx4 v3, s[4:7], s22 offen lds
    ds_read_b64_tr_b16 v[242:243], v7 offset:1280
    s_waitcnt lgkmcnt(6)
    v_mfma_f32_16x16x32_bf16 v[144:147], v[228:231], v[56:59], v[144:147]
    ds_read_b64_tr_b16 v[244:245], v8 offset:288
    v_mfma_f32_16x16x32_bf16 v[148:151], v[228:231], v[60:63], v[148:151]
    ds_read_b64_tr_b16 v[246:247], v8 offset:1312
    s_waitcnt vmcnt(15) lgkmcnt(6)
    v_mfma_f32_16x16x32_bf16 v[88:91], v[232:235], v[24:27], v[88:91]
    ds_read_b64_tr_b16 v[224:225], v7 offset:512
    s_waitcnt vmcnt(14)
    v_mfma_f32_16x16x32_bf16 v[92:95], v[232:235], v[28:31], v[92:95]
    ds_read_b64_tr_b16 v[226:227], v7 offset:1536
    s_waitcnt lgkmcnt(6)
    v_mfma_f32_16x16x32_bf16 v[96:99], v[236:239], v[24:27], v[96:99]
    ds_read_b64_tr_b16 v[228:229], v8 offset:544
    s_mov_b32 s23, 0xc000
    buffer_load_dwordx4 v[56:59], v6, s[8:11], s23 offen offset:1024 sc1
    v_mfma_f32_16x16x32_bf16 v[100:103], v[236:239], v[28:31], v[100:103]
    ds_read_b64_tr_b16 v[230:231], v8 offset:1568
    s_waitcnt lgkmcnt(6)
    v_mfma_f32_16x16x32_bf16 v[104:107], v[240:243], v[24:27], v[104:107]
    ds_read_b64_tr_b16 v[232:233], v7 offset:768
    v_mfma_f32_16x16x32_bf16 v[108:111], v[240:243], v[28:31], v[108:111]
    ds_read_b64_tr_b16 v[234:235], v7 offset:1792
    s_mov_b32 s23, 0x2c000
    buffer_load_dwordx4 v[60:63], v6, s[8:11], s23 offen offset:1024 sc1
    s_waitcnt lgkmcnt(6)
    v_mfma_f32_16x16x32_bf16 v[112:115], v[244:247], v[24:27], v[112:115]
    ds_read_b64_tr_b16 v[236:237], v8 offset:800
    v_mfma_f32_16x16x32_bf16 v[116:119], v[244:247], v[28:31], v[116:119]
    ds_read_b64_tr_b16 v[238:239], v8 offset:1824
    s_waitcnt lgkmcnt(6)
    v_mfma_f32_16x16x32_bf16 v[120:123], v[224:227], v[24:27], v[120:123]
    v_mfma_f32_16x16x32_bf16 v[124:127], v[224:227], v[28:31], v[124:127]
    s_waitcnt vmcnt(14)
    s_barrier
    ds_read_b64_tr_b16 v[240:241], v7 offset:16384
    ds_read_b64_tr_b16 v[242:243], v7 offset:17408
    s_add_u32 s19, s19, 8192
    buffer_load_dword v12, v13, s[8:11], s19 offen sc1
    s_waitcnt lgkmcnt(6)
    v_mfma_f32_16x16x32_bf16 v[128:131], v[228:231], v[24:27], v[128:131]
    s_add_u32 s22, s24, 0x390000
    s_add_u32 m0, s20, 0x1c000
    s_nop 0
    buffer_load_dwordx4 v3, s[4:7], s22 offen lds
    ds_read_b64_tr_b16 v[244:245], v8 offset:16416
    v_mfma_f32_16x16x32_bf16 v[132:135], v[228:231], v[28:31], v[132:135]
    ds_read_b64_tr_b16 v[246:247], v8 offset:17440
    s_waitcnt lgkmcnt(6)
    v_mfma_f32_16x16x32_bf16 v[136:139], v[232:235], v[24:27], v[136:139]
    ds_read_b64_tr_b16 v[224:225], v7 offset:16640
    v_mfma_f32_16x16x32_bf16 v[140:143], v[232:235], v[28:31], v[140:143]
    s_add_u32 s22, s24, 0x392000
    s_add_u32 m0, s20, 0x1c400
    s_nop 0
    buffer_load_dwordx4 v3, s[4:7], s22 offen lds
    ds_read_b64_tr_b16 v[226:227], v7 offset:17664
    s_waitcnt lgkmcnt(6)
    v_mfma_f32_16x16x32_bf16 v[144:147], v[236:239], v[24:27], v[144:147]
    ds_read_b64_tr_b16 v[228:229], v8 offset:16672
    v_mfma_f32_16x16x32_bf16 v[148:151], v[236:239], v[28:31], v[148:151]
    ds_read_b64_tr_b16 v[230:231], v8 offset:17696
    s_waitcnt vmcnt(16) lgkmcnt(6)
    v_mfma_f32_16x16x32_bf16 v[88:91], v[240:243], v[32:35], v[88:91]
    ds_read_b64_tr_b16 v[232:233], v7 offset:16896
    s_waitcnt vmcnt(15)
    v_mfma_f32_16x16x32_bf16 v[92:95], v[240:243], v[36:39], v[92:95]
    ds_read_b64_tr_b16 v[234:235], v7 offset:17920
    s_waitcnt lgkmcnt(6)
    v_mfma_f32_16x16x32_bf16 v[96:99], v[244:247], v[32:35], v[96:99]
    ds_read_b64_tr_b16 v[236:237], v8 offset:16928
    s_mov_b32 s23, 0xe000
    buffer_load_dwordx4 v[24:27], v6, s[8:11], s23 offen offset:1024 sc1
    v_mfma_f32_16x16x32_bf16 v[100:103], v[244:247], v[36:39], v[100:103]
    ds_read_b64_tr_b16 v[238:239], v8 offset:17952
    s_waitcnt lgkmcnt(6)
    v_mfma_f32_16x16x32_bf16 v[104:107], v[224:227], v[32:35], v[104:107]
    ds_read_b64_tr_b16 v[240:241], v7 offset:17152
    v_mfma_f32_16x16x32_bf16 v[108:111], v[224:227], v[36:39], v[108:111]
    ds_read_b64_tr_b16 v[242:243], v7 offset:18176
    s_mov_b32 s23, 0x2e000
    buffer_load_dwordx4 v[28:31], v6, s[8:11], s23 offen offset:1024 sc1
    s_waitcnt lgkmcnt(6)
    v_mfma_f32_16x16x32_bf16 v[112:115], v[228:231], v[32:35], v[112:115]
    ds_read_b64_tr_b16 v[244:245], v8 offset:17184
    v_mfma_f32_16x16x32_bf16 v[116:119], v[228:231], v[36:39], v[116:119]
    ds_read_b64_tr_b16 v[246:247], v8 offset:18208
    s_waitcnt lgkmcnt(6)
    v_mfma_f32_16x16x32_bf16 v[120:123], v[232:235], v[32:35], v[120:123]
    v_mfma_f32_16x16x32_bf16 v[124:127], v[232:235], v[36:39], v[124:127]
    s_waitcnt vmcnt(15)
    s_barrier
    ds_read_b64_tr_b16 v[224:225], v4 offset:0
    ds_read_b64_tr_b16 v[226:227], v4 offset:1024
    s_waitcnt lgkmcnt(6)
    v_mfma_f32_16x16x32_bf16 v[128:131], v[236:239], v[32:35], v[128:131]
    s_add_u32 s22, s24, 0x20000
    s_add_u32 m0, s20, 0x20000
    s_nop 0
    buffer_load_dwordx4 v3, s[4:7], s22 offen lds
    ds_read_b64_tr_b16 v[228:229], v5 offset:32
    v_mfma_f32_16x16x32_bf16 v[132:135], v[236:239], v[36:39], v[132:135]
    ds_read_b64_tr_b16 v[230:231], v5 offset:1056
    s_waitcnt lgkmcnt(6)
    v_mfma_f32_16x16x32_bf16 v[136:139], v[240:243], v[32:35], v[136:139]
    ds_read_b64_tr_b16 v[232:233], v4 offset:256
    v_mfma_f32_16x16x32_bf16 v[140:143], v[240:243], v[36:39], v[140:143]
    s_add_u32 s22, s24, 0x22000
    s_add_u32 m0, s20, 0x20400
    s_nop 0
    buffer_load_dwordx4 v3, s[4:7], s22 offen lds
    ds_read_b64_tr_b16 v[234:235], v4 offset:1280
    s_waitcnt lgkmcnt(6)
    v_mfma_f32_16x16x32_bf16 v[144:147], v[244:247], v[32:35], v[144:147]
    ds_read_b64_tr_b16 v[236:237], v5 offset:288
    v_mfma_f32_16x16x32_bf16 v[148:151], v[244:247], v[36:39], v[148:151]
    ds_read_b64_tr_b16 v[238:239], v5 offset:1312
    s_waitcnt vmcnt(6)
    v_cmp_ne_u32 vcc, s28, v12
    s_cbranch_vccnz adaLN_cond__sliding_block_cached__moe_arch_mod__prompt_kernel_o28r
adaLN_cond__sliding_block_cached__moe_arch_mod__prompt_kernel_o28b:
    s_waitcnt lgkmcnt(6)
    v_mfma_f32_16x16x32_bf16 v[88:91], v[224:227], v[40:43], v[88:91]
    ds_read_b64_tr_b16 v[240:241], v4 offset:512
    v_mfma_f32_16x16x32_bf16 v[92:95], v[224:227], v[44:47], v[92:95]
    ds_read_b64_tr_b16 v[242:243], v4 offset:1536
    s_waitcnt lgkmcnt(6)
    v_mfma_f32_16x16x32_bf16 v[96:99], v[228:231], v[40:43], v[96:99]
    ds_read_b64_tr_b16 v[244:245], v5 offset:544
    s_mov_b32 s23, 0x0
    buffer_load_dwordx4 v[32:35], v6, s[8:11], s23 offen offset:2048 sc1
    v_mfma_f32_16x16x32_bf16 v[100:103], v[228:231], v[44:47], v[100:103]
    ds_read_b64_tr_b16 v[246:247], v5 offset:1568
    s_waitcnt lgkmcnt(6)
    v_mfma_f32_16x16x32_bf16 v[104:107], v[232:235], v[40:43], v[104:107]
    ds_read_b64_tr_b16 v[224:225], v4 offset:768
    v_mfma_f32_16x16x32_bf16 v[108:111], v[232:235], v[44:47], v[108:111]
    ds_read_b64_tr_b16 v[226:227], v4 offset:1792
    s_mov_b32 s23, 0x20000
    buffer_load_dwordx4 v[36:39], v6, s[8:11], s23 offen offset:2048 sc1
    s_waitcnt lgkmcnt(6)
    v_mfma_f32_16x16x32_bf16 v[112:115], v[236:239], v[40:43], v[112:115]
    ds_read_b64_tr_b16 v[228:229], v5 offset:800
    v_mfma_f32_16x16x32_bf16 v[116:119], v[236:239], v[44:47], v[116:119]
    ds_read_b64_tr_b16 v[230:231], v5 offset:1824
    s_waitcnt lgkmcnt(6)
    v_mfma_f32_16x16x32_bf16 v[120:123], v[240:243], v[40:43], v[120:123]
    v_mfma_f32_16x16x32_bf16 v[124:127], v[240:243], v[44:47], v[124:127]
    s_barrier
    ds_read_b64_tr_b16 v[232:233], v4 offset:16384
    ds_read_b64_tr_b16 v[234:235], v4 offset:17408
    s_waitcnt lgkmcnt(6)
    v_mfma_f32_16x16x32_bf16 v[128:131], v[244:247], v[40:43], v[128:131]
    s_add_u32 s22, s24, 0xa0000
    s_add_u32 m0, s20, 0x24000
    s_nop 0
    buffer_load_dwordx4 v3, s[4:7], s22 offen lds
    ds_read_b64_tr_b16 v[236:237], v5 offset:16416
    v_mfma_f32_16x16x32_bf16 v[132:135], v[244:247], v[44:47], v[132:135]
    ds_read_b64_tr_b16 v[238:239], v5 offset:17440
    s_waitcnt lgkmcnt(6)
    v_mfma_f32_16x16x32_bf16 v[136:139], v[224:227], v[40:43], v[136:139]
    ds_read_b64_tr_b16 v[240:241], v4 offset:16640
    v_mfma_f32_16x16x32_bf16 v[140:143], v[224:227], v[44:47], v[140:143]
    s_add_u32 s22, s24, 0xa2000
    s_add_u32 m0, s20, 0x24400
    s_nop 0
    buffer_load_dwordx4 v3, s[4:7], s22 offen lds
    ds_read_b64_tr_b16 v[242:243], v4 offset:17664
    s_waitcnt lgkmcnt(6)
    v_mfma_f32_16x16x32_bf16 v[144:147], v[228:231], v[40:43], v[144:147]
    ds_read_b64_tr_b16 v[244:245], v5 offset:16672
    v_mfma_f32_16x16x32_bf16 v[148:151], v[228:231], v[44:47], v[148:151]
    ds_read_b64_tr_b16 v[246:247], v5 offset:17696
    s_waitcnt lgkmcnt(6)
    v_mfma_f32_16x16x32_bf16 v[88:91], v[232:235], v[48:51], v[88:91]
    ds_read_b64_tr_b16 v[224:225], v4 offset:16896
    v_mfma_f32_16x16x32_bf16 v[92:95], v[232:235], v[52:55], v[92:95]
    ds_read_b64_tr_b16 v[226:227], v4 offset:17920
    s_waitcnt lgkmcnt(6)
    v_mfma_f32_16x16x32_bf16 v[96:99], v[236:239], v[48:51], v[96:99]
    ds_read_b64_tr_b16 v[228:229], v5 offset:16928
    s_mov_b32 s23, 0x2000
    buffer_load_dwordx4 v[40:43], v6, s[8:11], s23 offen offset:2048 sc1
    v_mfma_f32_16x16x32_bf16 v[100:103], v[236:239], v[52:55], v[100:103]
    ds_read_b64_tr_b16 v[230:231], v5 offset:17952
    s_waitcnt lgkmcnt(6)
    v_mfma_f32_16x16x32_bf16 v[104:107], v[240:243], v[48:51], v[104:107]
    ds_read_b64_tr_b16 v[232:233], v4 offset:17152
    v_mfma_f32_16x16x32_bf16 v[108:111], v[240:243], v[52:55], v[108:111]
    ds_read_b64_tr_b16 v[234:235], v4 offset:18176
    s_mov_b32 s23, 0x22000
    buffer_load_dwordx4 v[44:47], v6, s[8:11], s23 offen offset:2048 sc1
    s_waitcnt lgkmcnt(6)
    v_mfma_f32_16x16x32_bf16 v[112:115], v[244:247], v[48:51], v[112:115]
    ds_read_b64_tr_b16 v[236:237], v5 offset:17184
    v_mfma_f32_16x16x32_bf16 v[116:119], v[244:247], v[52:55], v[116:119]
    ds_read_b64_tr_b16 v[238:239], v5 offset:18208
    s_waitcnt lgkmcnt(6)
    v_mfma_f32_16x16x32_bf16 v[120:123], v[224:227], v[48:51], v[120:123]
    v_mfma_f32_16x16x32_bf16 v[124:127], v[224:227], v[52:55], v[124:127]
    s_barrier
    ds_read_b64_tr_b16 v[240:241], v4 offset:32768
    ds_read_b64_tr_b16 v[242:243], v4 offset:33792
    s_waitcnt lgkmcnt(6)
    v_mfma_f32_16x16x32_bf16 v[128:131], v[228:231], v[48:51], v[128:131]
    s_add_u32 s22, s24, 0x120000
    s_add_u32 m0, s20, 0x10000
    s_nop 0
    buffer_load_dwordx4 v3, s[4:7], s22 offen lds
    ds_read_b64_tr_b16 v[244:245], v5 offset:32800
    v_mfma_f32_16x16x32_bf16 v[132:135], v[228:231], v[52:55], v[132:135]
    ds_read_b64_tr_b16 v[246:247], v5 offset:33824
    s_waitcnt lgkmcnt(6)
    v_mfma_f32_16x16x32_bf16 v[136:139], v[232:235], v[48:51], v[136:139]
    ds_read_b64_tr_b16 v[224:225], v4 offset:33024
    v_mfma_f32_16x16x32_bf16 v[140:143], v[232:235], v[52:55], v[140:143]
    s_add_u32 s22, s24, 0x122000
    s_add_u32 m0, s20, 0x10400
    s_nop 0
    buffer_load_dwordx4 v3, s[4:7], s22 offen lds
    ds_read_b64_tr_b16 v[226:227], v4 offset:34048
    s_waitcnt lgkmcnt(6)
    v_mfma_f32_16x16x32_bf16 v[144:147], v[236:239], v[48:51], v[144:147]
    ds_read_b64_tr_b16 v[228:229], v5 offset:33056
    v_mfma_f32_16x16x32_bf16 v[148:151], v[236:239], v[52:55], v[148:151]
    ds_read_b64_tr_b16 v[230:231], v5 offset:34080
    s_waitcnt lgkmcnt(6)
    v_mfma_f32_16x16x32_bf16 v[88:91], v[240:243], v[56:59], v[88:91]
    ds_read_b64_tr_b16 v[232:233], v4 offset:33280
    v_mfma_f32_16x16x32_bf16 v[92:95], v[240:243], v[60:63], v[92:95]
    ds_read_b64_tr_b16 v[234:235], v4 offset:34304
    s_waitcnt lgkmcnt(6)
    v_mfma_f32_16x16x32_bf16 v[96:99], v[244:247], v[56:59], v[96:99]
    ds_read_b64_tr_b16 v[236:237], v5 offset:33312
    s_mov_b32 s23, 0x4000
    buffer_load_dwordx4 v[48:51], v6, s[8:11], s23 offen offset:2048 sc1
    v_mfma_f32_16x16x32_bf16 v[100:103], v[244:247], v[60:63], v[100:103]
    ds_read_b64_tr_b16 v[238:239], v5 offset:34336
    s_waitcnt lgkmcnt(6)
    v_mfma_f32_16x16x32_bf16 v[104:107], v[224:227], v[56:59], v[104:107]
    ds_read_b64_tr_b16 v[240:241], v4 offset:33536
    v_mfma_f32_16x16x32_bf16 v[108:111], v[224:227], v[60:63], v[108:111]
    ds_read_b64_tr_b16 v[242:243], v4 offset:34560
    s_mov_b32 s23, 0x24000
    buffer_load_dwordx4 v[52:55], v6, s[8:11], s23 offen offset:2048 sc1
    s_waitcnt lgkmcnt(6)
    v_mfma_f32_16x16x32_bf16 v[112:115], v[228:231], v[56:59], v[112:115]
    ds_read_b64_tr_b16 v[244:245], v5 offset:33568
    v_mfma_f32_16x16x32_bf16 v[116:119], v[228:231], v[60:63], v[116:119]
    ds_read_b64_tr_b16 v[246:247], v5 offset:34592
    s_waitcnt lgkmcnt(6)
    v_mfma_f32_16x16x32_bf16 v[120:123], v[232:235], v[56:59], v[120:123]
    v_mfma_f32_16x16x32_bf16 v[124:127], v[232:235], v[60:63], v[124:127]
    s_waitcnt vmcnt(14)
    s_barrier
    ds_read_b64_tr_b16 v[224:225], v4 offset:49152
    ds_read_b64_tr_b16 v[226:227], v4 offset:50176
    s_waitcnt lgkmcnt(6)
    v_mfma_f32_16x16x32_bf16 v[128:131], v[236:239], v[56:59], v[128:131]
    s_add_u32 s22, s24, 0x1a0000
    s_add_u32 m0, s20, 0x14000
    s_nop 0
    buffer_load_dwordx4 v3, s[4:7], s22 offen lds
    ds_read_b64_tr_b16 v[228:229], v5 offset:49184
    v_mfma_f32_16x16x32_bf16 v[132:135], v[236:239], v[60:63], v[132:135]
    ds_read_b64_tr_b16 v[230:231], v5 offset:50208
    s_waitcnt lgkmcnt(6)
    v_mfma_f32_16x16x32_bf16 v[136:139], v[240:243], v[56:59], v[136:139]
    ds_read_b64_tr_b16 v[232:233], v4 offset:49408
    v_mfma_f32_16x16x32_bf16 v[140:143], v[240:243], v[60:63], v[140:143]
    s_add_u32 s22, s24, 0x1a2000
    s_add_u32 m0, s20, 0x14400
    s_nop 0
    buffer_load_dwordx4 v3, s[4:7], s22 offen lds
    ds_read_b64_tr_b16 v[234:235], v4 offset:50432
    s_waitcnt lgkmcnt(6)
    v_mfma_f32_16x16x32_bf16 v[144:147], v[244:247], v[56:59], v[144:147]
    ds_read_b64_tr_b16 v[236:237], v5 offset:49440
    v_mfma_f32_16x16x32_bf16 v[148:151], v[244:247], v[60:63], v[148:151]
    ds_read_b64_tr_b16 v[238:239], v5 offset:50464
    s_waitcnt vmcnt(15) lgkmcnt(6)
    v_mfma_f32_16x16x32_bf16 v[88:91], v[224:227], v[24:27], v[88:91]
    ds_read_b64_tr_b16 v[240:241], v4 offset:49664
    s_waitcnt vmcnt(14)
    v_mfma_f32_16x16x32_bf16 v[92:95], v[224:227], v[28:31], v[92:95]
    ds_read_b64_tr_b16 v[242:243], v4 offset:50688
    s_waitcnt lgkmcnt(6)
    v_mfma_f32_16x16x32_bf16 v[96:99], v[228:231], v[24:27], v[96:99]
    ds_read_b64_tr_b16 v[244:245], v5 offset:49696
    s_mov_b32 s23, 0x6000
    buffer_load_dwordx4 v[56:59], v6, s[8:11], s23 offen offset:2048 sc1
    v_mfma_f32_16x16x32_bf16 v[100:103], v[228:231], v[28:31], v[100:103]
    ds_read_b64_tr_b16 v[246:247], v5 offset:50720
    s_waitcnt lgkmcnt(6)
    v_mfma_f32_16x16x32_bf16 v[104:107], v[232:235], v[24:27], v[104:107]
    ds_read_b64_tr_b16 v[224:225], v4 offset:49920
    v_mfma_f32_16x16x32_bf16 v[108:111], v[232:235], v[28:31], v[108:111]
    ds_read_b64_tr_b16 v[226:227], v4 offset:50944
    s_mov_b32 s23, 0x26000
    buffer_load_dwordx4 v[60:63], v6, s[8:11], s23 offen offset:2048 sc1
    s_waitcnt lgkmcnt(6)
    v_mfma_f32_16x16x32_bf16 v[112:115], v[236:239], v[24:27], v[112:115]
    ds_read_b64_tr_b16 v[228:229], v5 offset:49952
    v_mfma_f32_16x16x32_bf16 v[116:119], v[236:239], v[28:31], v[116:119]
    ds_read_b64_tr_b16 v[230:231], v5 offset:50976
    s_waitcnt lgkmcnt(6)
    v_mfma_f32_16x16x32_bf16 v[120:123], v[240:243], v[24:27], v[120:123]
    v_mfma_f32_16x16x32_bf16 v[124:127], v[240:243], v[28:31], v[124:127]
    s_waitcnt vmcnt(14)
    s_barrier
    ds_read_b64_tr_b16 v[232:233], v7 offset:0
    ds_read_b64_tr_b16 v[234:235], v7 offset:1024
    s_waitcnt lgkmcnt(6)
    v_mfma_f32_16x16x32_bf16 v[128:131], v[244:247], v[24:27], v[128:131]
    s_add_u32 s22, s24, 0x220000
    s_add_u32 m0, s20, 0x18000
    s_nop 0
    buffer_load_dwordx4 v3, s[4:7], s22 offen lds
    ds_read_b64_tr_b16 v[236:237], v8 offset:32
    v_mfma_f32_16x16x32_bf16 v[132:135], v[244:247], v[28:31], v[132:135]
    ds_read_b64_tr_b16 v[238:239], v8 offset:1056
    s_waitcnt lgkmcnt(6)
    v_mfma_f32_16x16x32_bf16 v[136:139], v[224:227], v[24:27], v[136:139]
    ds_read_b64_tr_b16 v[240:241], v7 offset:256
    v_mfma_f32_16x16x32_bf16 v[140:143], v[224:227], v[28:31], v[140:143]
    s_add_u32 s22, s24, 0x222000
    s_add_u32 m0, s20, 0x18400
    s_nop 0
    buffer_load_dwordx4 v3, s[4:7], s22 offen lds
    ds_read_b64_tr_b16 v[242:243], v7 offset:1280
    s_waitcnt lgkmcnt(6)
    v_mfma_f32_16x16x32_bf16 v[144:147], v[228:231], v[24:27], v[144:147]
    ds_read_b64_tr_b16 v[244:245], v8 offset:288
    v_mfma_f32_16x16x32_bf16 v[148:151], v[228:231], v[28:31], v[148:151]
    ds_read_b64_tr_b16 v[246:247], v8 offset:1312
    s_waitcnt vmcnt(15) lgkmcnt(6)
    v_mfma_f32_16x16x32_bf16 v[88:91], v[232:235], v[32:35], v[88:91]
    ds_read_b64_tr_b16 v[224:225], v7 offset:512
    s_waitcnt vmcnt(14)
    v_mfma_f32_16x16x32_bf16 v[92:95], v[232:235], v[36:39], v[92:95]
    ds_read_b64_tr_b16 v[226:227], v7 offset:1536
    s_waitcnt lgkmcnt(6)
    v_mfma_f32_16x16x32_bf16 v[96:99], v[236:239], v[32:35], v[96:99]
    ds_read_b64_tr_b16 v[228:229], v8 offset:544
    s_mov_b32 s23, 0x8000
    buffer_load_dwordx4 v[24:27], v6, s[8:11], s23 offen offset:2048 sc1
    v_mfma_f32_16x16x32_bf16 v[100:103], v[236:239], v[36:39], v[100:103]
    ds_read_b64_tr_b16 v[230:231], v8 offset:1568
    s_waitcnt lgkmcnt(6)
    v_mfma_f32_16x16x32_bf16 v[104:107], v[240:243], v[32:35], v[104:107]
    ds_read_b64_tr_b16 v[232:233], v7 offset:768
    v_mfma_f32_16x16x32_bf16 v[108:111], v[240:243], v[36:39], v[108:111]
    ds_read_b64_tr_b16 v[234:235], v7 offset:1792
    s_mov_b32 s23, 0x28000
    buffer_load_dwordx4 v[28:31], v6, s[8:11], s23 offen offset:2048 sc1
    s_mov_b32 s16, 0x544000
    buffer_load_dwordx4 v[184:187], v2, s[8:11], s16 offen sc1
    s_waitcnt lgkmcnt(6)
    v_mfma_f32_16x16x32_bf16 v[112:115], v[244:247], v[32:35], v[112:115]
    ds_read_b64_tr_b16 v[236:237], v8 offset:800
    v_mfma_f32_16x16x32_bf16 v[116:119], v[244:247], v[36:39], v[116:119]
    ds_read_b64_tr_b16 v[238:239], v8 offset:1824
    s_waitcnt lgkmcnt(6)
    v_mfma_f32_16x16x32_bf16 v[120:123], v[224:227], v[32:35], v[120:123]
    v_mfma_f32_16x16x32_bf16 v[124:127], v[224:227], v[36:39], v[124:127]
    s_waitcnt vmcnt(15)
    s_barrier
    ds_read_b64_tr_b16 v[240:241], v7 offset:16384
    ds_read_b64_tr_b16 v[242:243], v7 offset:17408
    s_waitcnt lgkmcnt(6)
    v_mfma_f32_16x16x32_bf16 v[128:131], v[228:231], v[32:35], v[128:131]
    s_add_u32 s22, s24, 0x2a0000
    s_add_u32 m0, s20, 0x1c000
    s_nop 0
    buffer_load_dwordx4 v3, s[4:7], s22 offen lds
    ds_read_b64_tr_b16 v[244:245], v8 offset:16416
    v_mfma_f32_16x16x32_bf16 v[132:135], v[228:231], v[36:39], v[132:135]
    ds_read_b64_tr_b16 v[246:247], v8 offset:17440
    s_waitcnt lgkmcnt(6)
    v_mfma_f32_16x16x32_bf16 v[136:139], v[232:235], v[32:35], v[136:139]
    ds_read_b64_tr_b16 v[224:225], v7 offset:16640
    v_mfma_f32_16x16x32_bf16 v[140:143], v[232:235], v[36:39], v[140:143]
    s_add_u32 s22, s24, 0x2a2000
    s_add_u32 m0, s20, 0x1c400
    s_nop 0
    buffer_load_dwordx4 v3, s[4:7], s22 offen lds
    ds_read_b64_tr_b16 v[226:227], v7 offset:17664
    s_waitcnt lgkmcnt(6)
    v_mfma_f32_16x16x32_bf16 v[144:147], v[236:239], v[32:35], v[144:147]
    ds_read_b64_tr_b16 v[228:229], v8 offset:16672
    v_mfma_f32_16x16x32_bf16 v[148:151], v[236:239], v[36:39], v[148:151]
    ds_read_b64_tr_b16 v[230:231], v8 offset:17696
    s_waitcnt vmcnt(16) lgkmcnt(6)
    v_mfma_f32_16x16x32_bf16 v[88:91], v[240:243], v[40:43], v[88:91]
    ds_read_b64_tr_b16 v[232:233], v7 offset:16896
    s_waitcnt vmcnt(15)
    v_mfma_f32_16x16x32_bf16 v[92:95], v[240:243], v[44:47], v[92:95]
    ds_read_b64_tr_b16 v[234:235], v7 offset:17920
    s_waitcnt lgkmcnt(6)
    v_mfma_f32_16x16x32_bf16 v[96:99], v[244:247], v[40:43], v[96:99]
    ds_read_b64_tr_b16 v[236:237], v8 offset:16928
    s_mov_b32 s23, 0xa000
    buffer_load_dwordx4 v[32:35], v6, s[8:11], s23 offen offset:2048 sc1
    v_mfma_f32_16x16x32_bf16 v[100:103], v[244:247], v[44:47], v[100:103]
    ds_read_b64_tr_b16 v[238:239], v8 offset:17952
    s_waitcnt lgkmcnt(6)
    v_mfma_f32_16x16x32_bf16 v[104:107], v[224:227], v[40:43], v[104:107]
    ds_read_b64_tr_b16 v[240:241], v7 offset:17152
    v_mfma_f32_16x16x32_bf16 v[108:111], v[224:227], v[44:47], v[108:111]
    ds_read_b64_tr_b16 v[242:243], v7 offset:18176
    s_mov_b32 s23, 0x2a000
    buffer_load_dwordx4 v[36:39], v6, s[8:11], s23 offen offset:2048 sc1
    s_waitcnt lgkmcnt(6)
    v_mfma_f32_16x16x32_bf16 v[112:115], v[228:231], v[40:43], v[112:115]
    ds_read_b64_tr_b16 v[244:245], v8 offset:17184
    v_mfma_f32_16x16x32_bf16 v[116:119], v[228:231], v[44:47], v[116:119]
    ds_read_b64_tr_b16 v[246:247], v8 offset:18208
    s_waitcnt lgkmcnt(6)
    v_mfma_f32_16x16x32_bf16 v[120:123], v[232:235], v[40:43], v[120:123]
    v_mfma_f32_16x16x32_bf16 v[124:127], v[232:235], v[44:47], v[124:127]
    s_waitcnt vmcnt(15)
    s_barrier
    ds_read_b64_tr_b16 v[224:225], v4 offset:0
    ds_read_b64_tr_b16 v[226:227], v4 offset:1024
    s_waitcnt lgkmcnt(6)
    v_mfma_f32_16x16x32_bf16 v[128:131], v[236:239], v[40:43], v[128:131]
    s_add_u32 s22, s24, 0x320000
    s_add_u32 m0, s20, 0x20000
    s_nop 0
    buffer_load_dwordx4 v3, s[4:7], s22 offen lds
    ds_read_b64_tr_b16 v[228:229], v5 offset:32
    v_mfma_f32_16x16x32_bf16 v[132:135], v[236:239], v[44:47], v[132:135]
    ds_read_b64_tr_b16 v[230:231], v5 offset:1056
    s_waitcnt lgkmcnt(6)
    v_mfma_f32_16x16x32_bf16 v[136:139], v[240:243], v[40:43], v[136:139]
    ds_read_b64_tr_b16 v[232:233], v4 offset:256
    v_mfma_f32_16x16x32_bf16 v[140:143], v[240:243], v[44:47], v[140:143]
    s_add_u32 s22, s24, 0x322000
    s_add_u32 m0, s20, 0x20400
    s_nop 0
    buffer_load_dwordx4 v3, s[4:7], s22 offen lds
    ds_read_b64_tr_b16 v[234:235], v4 offset:1280
    s_waitcnt lgkmcnt(6)
    v_mfma_f32_16x16x32_bf16 v[144:147], v[244:247], v[40:43], v[144:147]
    ds_read_b64_tr_b16 v[236:237], v5 offset:288
    v_mfma_f32_16x16x32_bf16 v[148:151], v[244:247], v[44:47], v[148:151]
    ds_read_b64_tr_b16 v[238:239], v5 offset:1312
    s_waitcnt vmcnt(16) lgkmcnt(6)
    v_mfma_f32_16x16x32_bf16 v[88:91], v[224:227], v[48:51], v[88:91]
    ds_read_b64_tr_b16 v[240:241], v4 offset:512
    s_waitcnt vmcnt(15)
    v_mfma_f32_16x16x32_bf16 v[92:95], v[224:227], v[52:55], v[92:95]
    ds_read_b64_tr_b16 v[242:243], v4 offset:1536
    s_waitcnt lgkmcnt(6)
    v_mfma_f32_16x16x32_bf16 v[96:99], v[228:231], v[48:51], v[96:99]
    ds_read_b64_tr_b16 v[244:245], v5 offset:544
    s_mov_b32 s23, 0xc000
    buffer_load_dwordx4 v[40:43], v6, s[8:11], s23 offen offset:2048 sc1
    v_mfma_f32_16x16x32_bf16 v[100:103], v[228:231], v[52:55], v[100:103]
    ds_read_b64_tr_b16 v[246:247], v5 offset:1568
    s_waitcnt lgkmcnt(6)
    v_mfma_f32_16x16x32_bf16 v[104:107], v[232:235], v[48:51], v[104:107]
    ds_read_b64_tr_b16 v[224:225], v4 offset:768
    v_mfma_f32_16x16x32_bf16 v[108:111], v[232:235], v[52:55], v[108:111]
    ds_read_b64_tr_b16 v[226:227], v4 offset:1792
    s_mov_b32 s23, 0x2c000
    buffer_load_dwordx4 v[44:47], v6, s[8:11], s23 offen offset:2048 sc1
    s_waitcnt lgkmcnt(6)
    v_mfma_f32_16x16x32_bf16 v[112:115], v[236:239], v[48:51], v[112:115]
    ds_read_b64_tr_b16 v[228:229], v5 offset:800
    v_mfma_f32_16x16x32_bf16 v[116:119], v[236:239], v[52:55], v[116:119]
    ds_read_b64_tr_b16 v[230:231], v5 offset:1824
    s_waitcnt lgkmcnt(6)
    v_mfma_f32_16x16x32_bf16 v[120:123], v[240:243], v[48:51], v[120:123]
    v_mfma_f32_16x16x32_bf16 v[124:127], v[240:243], v[52:55], v[124:127]
    s_waitcnt vmcnt(15)
    s_barrier
    ds_read_b64_tr_b16 v[232:233], v4 offset:16384
    ds_read_b64_tr_b16 v[234:235], v4 offset:17408
    s_add_u32 s19, s19, 8192
    buffer_load_dword v12, v13, s[8:11], s19 offen sc1
    s_waitcnt lgkmcnt(6)
    v_mfma_f32_16x16x32_bf16 v[128:131], v[244:247], v[48:51], v[128:131]
    s_add_u32 s22, s24, 0x3a0000
    s_add_u32 m0, s20, 0x24000
    s_nop 0
    buffer_load_dwordx4 v3, s[4:7], s22 offen lds
    ds_read_b64_tr_b16 v[236:237], v5 offset:16416
    v_mfma_f32_16x16x32_bf16 v[132:135], v[244:247], v[52:55], v[132:135]
    ds_read_b64_tr_b16 v[238:239], v5 offset:17440
    s_waitcnt lgkmcnt(6)
    v_mfma_f32_16x16x32_bf16 v[136:139], v[224:227], v[48:51], v[136:139]
    ds_read_b64_tr_b16 v[240:241], v4 offset:16640
    v_mfma_f32_16x16x32_bf16 v[140:143], v[224:227], v[52:55], v[140:143]
    s_add_u32 s22, s24, 0x3a2000
    s_add_u32 m0, s20, 0x24400
    s_nop 0
    buffer_load_dwordx4 v3, s[4:7], s22 offen lds
    ds_read_b64_tr_b16 v[242:243], v4 offset:17664
    s_waitcnt lgkmcnt(6)
    v_mfma_f32_16x16x32_bf16 v[144:147], v[228:231], v[48:51], v[144:147]
    ds_read_b64_tr_b16 v[244:245], v5 offset:16672
    v_mfma_f32_16x16x32_bf16 v[148:151], v[228:231], v[52:55], v[148:151]
    ds_read_b64_tr_b16 v[246:247], v5 offset:17696
    s_waitcnt vmcnt(17) lgkmcnt(6)
    v_mfma_f32_16x16x32_bf16 v[88:91], v[232:235], v[56:59], v[88:91]
    ds_read_b64_tr_b16 v[224:225], v4 offset:16896
    s_waitcnt vmcnt(16)
    v_mfma_f32_16x16x32_bf16 v[92:95], v[232:235], v[60:63], v[92:95]
    ds_read_b64_tr_b16 v[226:227], v4 offset:17920
    s_waitcnt lgkmcnt(6)
    v_mfma_f32_16x16x32_bf16 v[96:99], v[236:239], v[56:59], v[96:99]
    ds_read_b64_tr_b16 v[228:229], v5 offset:16928
    s_mov_b32 s23, 0xe000
    buffer_load_dwordx4 v[48:51], v6, s[8:11], s23 offen offset:2048 sc1
    v_mfma_f32_16x16x32_bf16 v[100:103], v[236:239], v[60:63], v[100:103]
    ds_read_b64_tr_b16 v[230:231], v5 offset:17952
    s_waitcnt lgkmcnt(6)
    v_mfma_f32_16x16x32_bf16 v[104:107], v[240:243], v[56:59], v[104:107]
    ds_read_b64_tr_b16 v[232:233], v4 offset:17152
    v_mfma_f32_16x16x32_bf16 v[108:111], v[240:243], v[60:63], v[108:111]
    ds_read_b64_tr_b16 v[234:235], v4 offset:18176
    s_mov_b32 s23, 0x2e000
    buffer_load_dwordx4 v[52:55], v6, s[8:11], s23 offen offset:2048 sc1
    s_waitcnt lgkmcnt(6)
    v_mfma_f32_16x16x32_bf16 v[112:115], v[244:247], v[56:59], v[112:115]
    ds_read_b64_tr_b16 v[236:237], v5 offset:17184
    v_mfma_f32_16x16x32_bf16 v[116:119], v[244:247], v[60:63], v[116:119]
    ds_read_b64_tr_b16 v[238:239], v5 offset:18208
    s_waitcnt lgkmcnt(6)
    v_mfma_f32_16x16x32_bf16 v[120:123], v[224:227], v[56:59], v[120:123]
    v_mfma_f32_16x16x32_bf16 v[124:127], v[224:227], v[60:63], v[124:127]
    s_waitcnt vmcnt(16)
    s_barrier
    ds_read_b64_tr_b16 v[240:241], v4 offset:32768
    ds_read_b64_tr_b16 v[242:243], v4 offset:33792
    s_waitcnt lgkmcnt(6)
    v_mfma_f32_16x16x32_bf16 v[128:131], v[228:231], v[56:59], v[128:131]
    s_add_u32 s22, s24, 0x30000
    s_add_u32 m0, s20, 0x10000
    s_nop 0
    buffer_load_dwordx4 v3, s[4:7], s22 offen lds
    ds_read_b64_tr_b16 v[244:245], v5 offset:32800
    v_mfma_f32_16x16x32_bf16 v[132:135], v[228:231], v[60:63], v[132:135]
    ds_read_b64_tr_b16 v[246:247], v5 offset:33824
    s_waitcnt lgkmcnt(6)
    v_mfma_f32_16x16x32_bf16 v[136:139], v[232:235], v[56:59], v[136:139]
    ds_read_b64_tr_b16 v[224:225], v4 offset:33024
    v_mfma_f32_16x16x32_bf16 v[140:143], v[232:235], v[60:63], v[140:143]
    s_add_u32 s22, s24, 0x32000
    s_add_u32 m0, s20, 0x10400
    s_nop 0
    buffer_load_dwordx4 v3, s[4:7], s22 offen lds
    ds_read_b64_tr_b16 v[226:227], v4 offset:34048
    s_waitcnt lgkmcnt(6)
    v_mfma_f32_16x16x32_bf16 v[144:147], v[236:239], v[56:59], v[144:147]
    ds_read_b64_tr_b16 v[228:229], v5 offset:33056
    v_mfma_f32_16x16x32_bf16 v[148:151], v[236:239], v[60:63], v[148:151]
    ds_read_b64_tr_b16 v[230:231], v5 offset:34080
    s_waitcnt vmcnt(6)
    v_cmp_ne_u32 vcc, s28, v12
    s_cbranch_vccnz adaLN_cond__sliding_block_cached__moe_arch_mod__prompt_kernel_o29r
adaLN_cond__sliding_block_cached__moe_arch_mod__prompt_kernel_o29b:
    s_waitcnt lgkmcnt(6)
    v_mfma_f32_16x16x32_bf16 v[88:91], v[240:243], v[24:27], v[88:91]
    ds_read_b64_tr_b16 v[232:233], v4 offset:33280
    v_mfma_f32_16x16x32_bf16 v[92:95], v[240:243], v[28:31], v[92:95]
    ds_read_b64_tr_b16 v[234:235], v4 offset:34304
    s_waitcnt lgkmcnt(6)
    v_mfma_f32_16x16x32_bf16 v[96:99], v[244:247], v[24:27], v[96:99]
    ds_read_b64_tr_b16 v[236:237], v5 offset:33312
    s_mov_b32 s23, 0x0
    buffer_load_dwordx4 v[56:59], v6, s[8:11], s23 offen offset:3072 sc1
    v_mfma_f32_16x16x32_bf16 v[100:103], v[244:247], v[28:31], v[100:103]
    ds_read_b64_tr_b16 v[238:239], v5 offset:34336
    s_waitcnt lgkmcnt(6)
    v_mfma_f32_16x16x32_bf16 v[104:107], v[224:227], v[24:27], v[104:107]
    ds_read_b64_tr_b16 v[240:241], v4 offset:33536
    v_mfma_f32_16x16x32_bf16 v[108:111], v[224:227], v[28:31], v[108:111]
    ds_read_b64_tr_b16 v[242:243], v4 offset:34560
    s_mov_b32 s23, 0x20000
    buffer_load_dwordx4 v[60:63], v6, s[8:11], s23 offen offset:3072 sc1
    v_xor_b32 v16, s28, v184
    v_xor_b32 v17, s28, v185
    v_xor_b32 v18, s28, v186
    v_xor_b32 v19, s28, v187
    v_or3_b32 v16, v16, v17, v18
    v_or_b32 v16, v16, v19
    v_cmp_ne_u32 vcc, 0, v16
    s_cbranch_vccnz adaLN_cond__sliding_block_cached__moe_arch_mod__prompt_kernel_mf10r
adaLN_cond__sliding_block_cached__moe_arch_mod__prompt_kernel_mf10b:
    s_waitcnt lgkmcnt(6)
    v_mfma_f32_16x16x32_bf16 v[112:115], v[228:231], v[24:27], v[112:115]
    ds_read_b64_tr_b16 v[244:245], v5 offset:33568
    v_mfma_f32_16x16x32_bf16 v[116:119], v[228:231], v[28:31], v[116:119]
    ds_read_b64_tr_b16 v[246:247], v5 offset:34592
    s_waitcnt lgkmcnt(6)
    v_mfma_f32_16x16x32_bf16 v[120:123], v[232:235], v[24:27], v[120:123]
    v_mfma_f32_16x16x32_bf16 v[124:127], v[232:235], v[28:31], v[124:127]
    s_barrier
    ds_read_b64_tr_b16 v[224:225], v4 offset:49152
    ds_read_b64_tr_b16 v[226:227], v4 offset:50176
    s_waitcnt lgkmcnt(6)
    v_mfma_f32_16x16x32_bf16 v[128:131], v[236:239], v[24:27], v[128:131]
    s_add_u32 s22, s24, 0xb0000
    s_add_u32 m0, s20, 0x14000
    s_nop 0
    buffer_load_dwordx4 v3, s[4:7], s22 offen lds
    ds_read_b64_tr_b16 v[228:229], v5 offset:49184
    v_mfma_f32_16x16x32_bf16 v[132:135], v[236:239], v[28:31], v[132:135]
    ds_read_b64_tr_b16 v[230:231], v5 offset:50208
    s_waitcnt lgkmcnt(6)
    v_mfma_f32_16x16x32_bf16 v[136:139], v[240:243], v[24:27], v[136:139]
    ds_read_b64_tr_b16 v[232:233], v4 offset:49408
    v_mfma_f32_16x16x32_bf16 v[140:143], v[240:243], v[28:31], v[140:143]
    s_add_u32 s22, s24, 0xb2000
    s_add_u32 m0, s20, 0x14400
    s_nop 0
    buffer_load_dwordx4 v3, s[4:7], s22 offen lds
    ds_read_b64_tr_b16 v[234:235], v4 offset:50432
    s_waitcnt lgkmcnt(6)
    v_mfma_f32_16x16x32_bf16 v[144:147], v[244:247], v[24:27], v[144:147]
    ds_read_b64_tr_b16 v[236:237], v5 offset:49440
    v_mfma_f32_16x16x32_bf16 v[148:151], v[244:247], v[28:31], v[148:151]
    ds_read_b64_tr_b16 v[238:239], v5 offset:50464
    s_waitcnt lgkmcnt(6)
    v_mfma_f32_16x16x32_bf16 v[88:91], v[224:227], v[32:35], v[88:91]
    ds_read_b64_tr_b16 v[240:241], v4 offset:49664
    v_mfma_f32_16x16x32_bf16 v[92:95], v[224:227], v[36:39], v[92:95]
    ds_read_b64_tr_b16 v[242:243], v4 offset:50688
    s_waitcnt lgkmcnt(6)
    v_mfma_f32_16x16x32_bf16 v[96:99], v[228:231], v[32:35], v[96:99]
    ds_read_b64_tr_b16 v[244:245], v5 offset:49696
    s_mov_b32 s23, 0x2000
    buffer_load_dwordx4 v[24:27], v6, s[8:11], s23 offen offset:3072 sc1
    v_mfma_f32_16x16x32_bf16 v[100:103], v[228:231], v[36:39], v[100:103]
    ds_read_b64_tr_b16 v[246:247], v5 offset:50720
    s_waitcnt lgkmcnt(6)
    v_mfma_f32_16x16x32_bf16 v[104:107], v[232:235], v[32:35], v[104:107]
    ds_read_b64_tr_b16 v[224:225], v4 offset:49920
    v_mfma_f32_16x16x32_bf16 v[108:111], v[232:235], v[36:39], v[108:111]
    ds_read_b64_tr_b16 v[226:227], v4 offset:50944
    s_mov_b32 s23, 0x22000
    buffer_load_dwordx4 v[28:31], v6, s[8:11], s23 offen offset:3072 sc1
    s_waitcnt lgkmcnt(6)
    v_mfma_f32_16x16x32_bf16 v[112:115], v[236:239], v[32:35], v[112:115]
    ds_read_b64_tr_b16 v[228:229], v5 offset:49952
    v_mfma_f32_16x16x32_bf16 v[116:119], v[236:239], v[36:39], v[116:119]
    ds_read_b64_tr_b16 v[230:231], v5 offset:50976
    s_waitcnt lgkmcnt(6)
    v_mfma_f32_16x16x32_bf16 v[120:123], v[240:243], v[32:35], v[120:123]
    v_mfma_f32_16x16x32_bf16 v[124:127], v[240:243], v[36:39], v[124:127]
    s_barrier
    ds_read_b64_tr_b16 v[232:233], v7 offset:0
    ds_read_b64_tr_b16 v[234:235], v7 offset:1024
    s_waitcnt lgkmcnt(6)
    v_mfma_f32_16x16x32_bf16 v[128:131], v[244:247], v[32:35], v[128:131]
    s_add_u32 s22, s24, 0x130000
    s_add_u32 m0, s20, 0x18000
    s_nop 0
    buffer_load_dwordx4 v3, s[4:7], s22 offen lds
    ds_read_b64_tr_b16 v[236:237], v8 offset:32
    v_mfma_f32_16x16x32_bf16 v[132:135], v[244:247], v[36:39], v[132:135]
    ds_read_b64_tr_b16 v[238:239], v8 offset:1056
    s_waitcnt lgkmcnt(6)
    v_mfma_f32_16x16x32_bf16 v[136:139], v[224:227], v[32:35], v[136:139]
    ds_read_b64_tr_b16 v[240:241], v7 offset:256
    v_mfma_f32_16x16x32_bf16 v[140:143], v[224:227], v[36:39], v[140:143]
    s_add_u32 s22, s24, 0x132000
    s_add_u32 m0, s20, 0x18400
    s_nop 0
    buffer_load_dwordx4 v3, s[4:7], s22 offen lds
    ds_read_b64_tr_b16 v[242:243], v7 offset:1280
    s_waitcnt lgkmcnt(6)
    v_mfma_f32_16x16x32_bf16 v[144:147], v[228:231], v[32:35], v[144:147]
    ds_read_b64_tr_b16 v[244:245], v8 offset:288
    v_mfma_f32_16x16x32_bf16 v[148:151], v[228:231], v[36:39], v[148:151]
    ds_read_b64_tr_b16 v[246:247], v8 offset:1312
    s_waitcnt lgkmcnt(6)
    v_mfma_f32_16x16x32_bf16 v[88:91], v[232:235], v[40:43], v[88:91]
    ds_read_b64_tr_b16 v[224:225], v7 offset:512
    v_mfma_f32_16x16x32_bf16 v[92:95], v[232:235], v[44:47], v[92:95]
    ds_read_b64_tr_b16 v[226:227], v7 offset:1536
    s_waitcnt lgkmcnt(6)
    v_mfma_f32_16x16x32_bf16 v[96:99], v[236:239], v[40:43], v[96:99]
    ds_read_b64_tr_b16 v[228:229], v8 offset:544
    s_mov_b32 s23, 0x4000
    buffer_load_dwordx4 v[32:35], v6, s[8:11], s23 offen offset:3072 sc1
    v_mfma_f32_16x16x32_bf16 v[100:103], v[236:239], v[44:47], v[100:103]
    ds_read_b64_tr_b16 v[230:231], v8 offset:1568
    s_waitcnt lgkmcnt(6)
    v_mfma_f32_16x16x32_bf16 v[104:107], v[240:243], v[40:43], v[104:107]
    ds_read_b64_tr_b16 v[232:233], v7 offset:768
    v_mfma_f32_16x16x32_bf16 v[108:111], v[240:243], v[44:47], v[108:111]
    ds_read_b64_tr_b16 v[234:235], v7 offset:1792
    s_mov_b32 s23, 0x24000
    buffer_load_dwordx4 v[36:39], v6, s[8:11], s23 offen offset:3072 sc1
    s_waitcnt lgkmcnt(6)
    v_mfma_f32_16x16x32_bf16 v[112:115], v[244:247], v[40:43], v[112:115]
    ds_read_b64_tr_b16 v[236:237], v8 offset:800
    v_mfma_f32_16x16x32_bf16 v[116:119], v[244:247], v[44:47], v[116:119]
    ds_read_b64_tr_b16 v[238:239], v8 offset:1824
    s_waitcnt lgkmcnt(6)
    v_mfma_f32_16x16x32_bf16 v[120:123], v[224:227], v[40:43], v[120:123]
    v_mfma_f32_16x16x32_bf16 v[124:127], v[224:227], v[44:47], v[124:127]
    s_waitcnt vmcnt(14)
    s_barrier
    ds_read_b64_tr_b16 v[240:241], v7 offset:16384
    ds_read_b64_tr_b16 v[242:243], v7 offset:17408
    s_waitcnt lgkmcnt(6)
    v_mfma_f32_16x16x32_bf16 v[128:131], v[228:231], v[40:43], v[128:131]
    s_add_u32 s22, s24, 0x1b0000
    s_add_u32 m0, s20, 0x1c000
    s_nop 0
    buffer_load_dwordx4 v3, s[4:7], s22 offen lds
    ds_read_b64_tr_b16 v[244:245], v8 offset:16416
    v_mfma_f32_16x16x32_bf16 v[132:135], v[228:231], v[44:47], v[132:135]
    ds_read_b64_tr_b16 v[246:247], v8 offset:17440
    s_waitcnt lgkmcnt(6)
    v_mfma_f32_16x16x32_bf16 v[136:139], v[232:235], v[40:43], v[136:139]
    ds_read_b64_tr_b16 v[224:225], v7 offset:16640
    v_mfma_f32_16x16x32_bf16 v[140:143], v[232:235], v[44:47], v[140:143]
    s_add_u32 s22, s24, 0x1b2000
    s_add_u32 m0, s20, 0x1c400
    s_nop 0
    buffer_load_dwordx4 v3, s[4:7], s22 offen lds
    ds_read_b64_tr_b16 v[226:227], v7 offset:17664
    s_waitcnt lgkmcnt(6)
    v_mfma_f32_16x16x32_bf16 v[144:147], v[236:239], v[40:43], v[144:147]
    ds_read_b64_tr_b16 v[228:229], v8 offset:16672
    v_mfma_f32_16x16x32_bf16 v[148:151], v[236:239], v[44:47], v[148:151]
    ds_read_b64_tr_b16 v[230:231], v8 offset:17696
    s_waitcnt vmcnt(15) lgkmcnt(6)
    v_mfma_f32_16x16x32_bf16 v[88:91], v[240:243], v[48:51], v[88:91]
    ds_read_b64_tr_b16 v[232:233], v7 offset:16896
    s_waitcnt vmcnt(14)
    v_mfma_f32_16x16x32_bf16 v[92:95], v[240:243], v[52:55], v[92:95]
    ds_read_b64_tr_b16 v[234:235], v7 offset:17920
    s_waitcnt lgkmcnt(6)
    v_mfma_f32_16x16x32_bf16 v[96:99], v[244:247], v[48:51], v[96:99]
    ds_read_b64_tr_b16 v[236:237], v8 offset:16928
    s_mov_b32 s23, 0x6000
    buffer_load_dwordx4 v[40:43], v6, s[8:11], s23 offen offset:3072 sc1
    v_mfma_f32_16x16x32_bf16 v[100:103], v[244:247], v[52:55], v[100:103]
    ds_read_b64_tr_b16 v[238:239], v8 offset:17952
    s_waitcnt lgkmcnt(6)
    v_mfma_f32_16x16x32_bf16 v[104:107], v[224:227], v[48:51], v[104:107]
    ds_read_b64_tr_b16 v[240:241], v7 offset:17152
    v_mfma_f32_16x16x32_bf16 v[108:111], v[224:227], v[52:55], v[108:111]
    ds_read_b64_tr_b16 v[242:243], v7 offset:18176
    s_mov_b32 s23, 0x26000
    buffer_load_dwordx4 v[44:47], v6, s[8:11], s23 offen offset:3072 sc1
    s_waitcnt lgkmcnt(6)
    v_mfma_f32_16x16x32_bf16 v[112:115], v[228:231], v[48:51], v[112:115]
    ds_read_b64_tr_b16 v[244:245], v8 offset:17184
    v_mfma_f32_16x16x32_bf16 v[116:119], v[228:231], v[52:55], v[116:119]
    ds_read_b64_tr_b16 v[246:247], v8 offset:18208
    s_waitcnt lgkmcnt(6)
    v_mfma_f32_16x16x32_bf16 v[120:123], v[232:235], v[48:51], v[120:123]
    v_mfma_f32_16x16x32_bf16 v[124:127], v[232:235], v[52:55], v[124:127]
    s_waitcnt vmcnt(14)
    s_barrier
    ds_read_b64_tr_b16 v[224:225], v4 offset:0
    ds_read_b64_tr_b16 v[226:227], v4 offset:1024
    s_waitcnt lgkmcnt(6)
    v_mfma_f32_16x16x32_bf16 v[128:131], v[236:239], v[48:51], v[128:131]
    s_add_u32 s22, s24, 0x230000
    s_add_u32 m0, s20, 0x20000
    s_nop 0
    buffer_load_dwordx4 v3, s[4:7], s22 offen lds
    ds_read_b64_tr_b16 v[228:229], v5 offset:32
    v_mfma_f32_16x16x32_bf16 v[132:135], v[236:239], v[52:55], v[132:135]
    ds_read_b64_tr_b16 v[230:231], v5 offset:1056
    s_waitcnt lgkmcnt(6)
    v_mfma_f32_16x16x32_bf16 v[136:139], v[240:243], v[48:51], v[136:139]
    ds_read_b64_tr_b16 v[232:233], v4 offset:256
    v_mfma_f32_16x16x32_bf16 v[140:143], v[240:243], v[52:55], v[140:143]
    s_add_u32 s22, s24, 0x232000
    s_add_u32 m0, s20, 0x20400
    s_nop 0
    buffer_load_dwordx4 v3, s[4:7], s22 offen lds
    ds_read_b64_tr_b16 v[234:235], v4 offset:1280
    s_waitcnt lgkmcnt(6)
    v_mfma_f32_16x16x32_bf16 v[144:147], v[244:247], v[48:51], v[144:147]
    ds_read_b64_tr_b16 v[236:237], v5 offset:288
    v_mfma_f32_16x16x32_bf16 v[148:151], v[244:247], v[52:55], v[148:151]
    ds_read_b64_tr_b16 v[238:239], v5 offset:1312
    s_waitcnt vmcnt(15) lgkmcnt(6)
    v_mfma_f32_16x16x32_bf16 v[88:91], v[224:227], v[56:59], v[88:91]
    ds_read_b64_tr_b16 v[240:241], v4 offset:512
    s_waitcnt vmcnt(14)
    v_mfma_f32_16x16x32_bf16 v[92:95], v[224:227], v[60:63], v[92:95]
    ds_read_b64_tr_b16 v[242:243], v4 offset:1536
    s_waitcnt lgkmcnt(6)
    v_mfma_f32_16x16x32_bf16 v[96:99], v[228:231], v[56:59], v[96:99]
    ds_read_b64_tr_b16 v[244:245], v5 offset:544
    s_mov_b32 s23, 0x8000
    buffer_load_dwordx4 v[48:51], v6, s[8:11], s23 offen offset:3072 sc1
    v_mfma_f32_16x16x32_bf16 v[100:103], v[228:231], v[60:63], v[100:103]
    ds_read_b64_tr_b16 v[246:247], v5 offset:1568
    s_waitcnt lgkmcnt(6)
    v_mfma_f32_16x16x32_bf16 v[104:107], v[232:235], v[56:59], v[104:107]
    ds_read_b64_tr_b16 v[224:225], v4 offset:768
    v_mfma_f32_16x16x32_bf16 v[108:111], v[232:235], v[60:63], v[108:111]
    ds_read_b64_tr_b16 v[226:227], v4 offset:1792
    s_mov_b32 s23, 0x28000
    buffer_load_dwordx4 v[52:55], v6, s[8:11], s23 offen offset:3072 sc1
    s_waitcnt lgkmcnt(6)
    v_mfma_f32_16x16x32_bf16 v[112:115], v[236:239], v[56:59], v[112:115]
    ds_read_b64_tr_b16 v[228:229], v5 offset:800
    v_mfma_f32_16x16x32_bf16 v[116:119], v[236:239], v[60:63], v[116:119]
    ds_read_b64_tr_b16 v[230:231], v5 offset:1824
    s_waitcnt lgkmcnt(6)
    v_mfma_f32_16x16x32_bf16 v[120:123], v[240:243], v[56:59], v[120:123]
    v_mfma_f32_16x16x32_bf16 v[124:127], v[240:243], v[60:63], v[124:127]
    s_waitcnt vmcnt(14)
    s_barrier
    ds_read_b64_tr_b16 v[232:233], v4 offset:16384
    ds_read_b64_tr_b16 v[234:235], v4 offset:17408
    s_waitcnt lgkmcnt(6)
    v_mfma_f32_16x16x32_bf16 v[128:131], v[244:247], v[56:59], v[128:131]
    s_add_u32 s22, s24, 0x2b0000
    s_add_u32 m0, s20, 0x24000
    s_nop 0
    buffer_load_dwordx4 v3, s[4:7], s22 offen lds
    ds_read_b64_tr_b16 v[236:237], v5 offset:16416
    v_mfma_f32_16x16x32_bf16 v[132:135], v[244:247], v[60:63], v[132:135]
    ds_read_b64_tr_b16 v[238:239], v5 offset:17440
    s_waitcnt lgkmcnt(6)
    v_mfma_f32_16x16x32_bf16 v[136:139], v[224:227], v[56:59], v[136:139]
    ds_read_b64_tr_b16 v[240:241], v4 offset:16640
    v_mfma_f32_16x16x32_bf16 v[140:143], v[224:227], v[60:63], v[140:143]
    s_add_u32 s22, s24, 0x2b2000
    s_add_u32 m0, s20, 0x24400
    s_nop 0
    buffer_load_dwordx4 v3, s[4:7], s22 offen lds
    ds_read_b64_tr_b16 v[242:243], v4 offset:17664
    s_waitcnt lgkmcnt(6)
    v_mfma_f32_16x16x32_bf16 v[144:147], v[228:231], v[56:59], v[144:147]
    ds_read_b64_tr_b16 v[244:245], v5 offset:16672
    v_mfma_f32_16x16x32_bf16 v[148:151], v[228:231], v[60:63], v[148:151]
    ds_read_b64_tr_b16 v[246:247], v5 offset:17696
    s_waitcnt vmcnt(15) lgkmcnt(6)
    v_mfma_f32_16x16x32_bf16 v[88:91], v[232:235], v[24:27], v[88:91]
    ds_read_b64_tr_b16 v[224:225], v4 offset:16896
    s_waitcnt vmcnt(14)
    v_mfma_f32_16x16x32_bf16 v[92:95], v[232:235], v[28:31], v[92:95]
    ds_read_b64_tr_b16 v[226:227], v4 offset:17920
    s_waitcnt lgkmcnt(6)
    v_mfma_f32_16x16x32_bf16 v[96:99], v[236:239], v[24:27], v[96:99]
    ds_read_b64_tr_b16 v[228:229], v5 offset:16928
    s_mov_b32 s23, 0xa000
    buffer_load_dwordx4 v[56:59], v6, s[8:11], s23 offen offset:3072 sc1
    v_mfma_f32_16x16x32_bf16 v[100:103], v[236:239], v[28:31], v[100:103]
    ds_read_b64_tr_b16 v[230:231], v5 offset:17952
    s_waitcnt lgkmcnt(6)
    v_mfma_f32_16x16x32_bf16 v[104:107], v[240:243], v[24:27], v[104:107]
    ds_read_b64_tr_b16 v[232:233], v4 offset:17152
    v_mfma_f32_16x16x32_bf16 v[108:111], v[240:243], v[28:31], v[108:111]
    ds_read_b64_tr_b16 v[234:235], v4 offset:18176
    s_mov_b32 s23, 0x2a000
    buffer_load_dwordx4 v[60:63], v6, s[8:11], s23 offen offset:3072 sc1
    s_waitcnt lgkmcnt(6)
    v_mfma_f32_16x16x32_bf16 v[112:115], v[244:247], v[24:27], v[112:115]
    ds_read_b64_tr_b16 v[236:237], v5 offset:17184
    v_mfma_f32_16x16x32_bf16 v[116:119], v[244:247], v[28:31], v[116:119]
    ds_read_b64_tr_b16 v[238:239], v5 offset:18208
    s_waitcnt lgkmcnt(6)
    v_mfma_f32_16x16x32_bf16 v[120:123], v[224:227], v[24:27], v[120:123]
    v_mfma_f32_16x16x32_bf16 v[124:127], v[224:227], v[28:31], v[124:127]
    s_waitcnt vmcnt(14)
    s_barrier
    ds_read_b64_tr_b16 v[240:241], v4 offset:32768
    ds_read_b64_tr_b16 v[242:243], v4 offset:33792
    s_waitcnt lgkmcnt(6)
    v_mfma_f32_16x16x32_bf16 v[128:131], v[228:231], v[24:27], v[128:131]
    s_add_u32 s22, s24, 0x330000
    s_add_u32 m0, s20, 0x10000
    s_nop 0
    buffer_load_dwordx4 v3, s[4:7], s22 offen lds
    ds_read_b64_tr_b16 v[244:245], v5 offset:32800
    v_mfma_f32_16x16x32_bf16 v[132:135], v[228:231], v[28:31], v[132:135]
    ds_read_b64_tr_b16 v[246:247], v5 offset:33824
    s_waitcnt lgkmcnt(6)
    v_mfma_f32_16x16x32_bf16 v[136:139], v[232:235], v[24:27], v[136:139]
    ds_read_b64_tr_b16 v[224:225], v4 offset:33024
    v_mfma_f32_16x16x32_bf16 v[140:143], v[232:235], v[28:31], v[140:143]
    s_add_u32 s22, s24, 0x332000
    s_add_u32 m0, s20, 0x10400
    s_nop 0
    buffer_load_dwordx4 v3, s[4:7], s22 offen lds
    ds_read_b64_tr_b16 v[226:227], v4 offset:34048
    s_waitcnt lgkmcnt(6)
    v_mfma_f32_16x16x32_bf16 v[144:147], v[236:239], v[24:27], v[144:147]
    ds_read_b64_tr_b16 v[228:229], v5 offset:33056
    v_mfma_f32_16x16x32_bf16 v[148:151], v[236:239], v[28:31], v[148:151]
    ds_read_b64_tr_b16 v[230:231], v5 offset:34080
    s_waitcnt vmcnt(15) lgkmcnt(6)
    v_mfma_f32_16x16x32_bf16 v[88:91], v[240:243], v[32:35], v[88:91]
    ds_read_b64_tr_b16 v[232:233], v4 offset:33280
    s_waitcnt vmcnt(14)
    v_mfma_f32_16x16x32_bf16 v[92:95], v[240:243], v[36:39], v[92:95]
    ds_read_b64_tr_b16 v[234:235], v4 offset:34304
    s_waitcnt lgkmcnt(6)
    v_mfma_f32_16x16x32_bf16 v[96:99], v[244:247], v[32:35], v[96:99]
    ds_read_b64_tr_b16 v[236:237], v5 offset:33312
    s_mov_b32 s23, 0xc000
    buffer_load_dwordx4 v[24:27], v6, s[8:11], s23 offen offset:3072 sc1
    v_mfma_f32_16x16x32_bf16 v[100:103], v[244:247], v[36:39], v[100:103]
    ds_read_b64_tr_b16 v[238:239], v5 offset:34336
    s_waitcnt lgkmcnt(6)
    v_mfma_f32_16x16x32_bf16 v[104:107], v[224:227], v[32:35], v[104:107]
    ds_read_b64_tr_b16 v[240:241], v4 offset:33536
    v_mfma_f32_16x16x32_bf16 v[108:111], v[224:227], v[36:39], v[108:111]
    ds_read_b64_tr_b16 v[242:243], v4 offset:34560
    s_mov_b32 s23, 0x2c000
    buffer_load_dwordx4 v[28:31], v6, s[8:11], s23 offen offset:3072 sc1
    v_lshrrev_b32 v16, 4, v1
    v_lshlrev_b32 v16, 3, v16
    s_lshl_b32 s16, s31, 8
    s_add_u32 s16, s16, 0x540000
    buffer_load_dwordx2 v[248:249], v16, s[8:11], s16 offen offset:0 sc1
    buffer_load_dwordx2 v[250:251], v16, s[8:11], s16 offen offset:32 sc1
    buffer_load_dwordx2 v[252:253], v16, s[8:11], s16 offen offset:64 sc1
    buffer_load_dwordx2 v[254:255], v16, s[8:11], s16 offen offset:96 sc1
    s_waitcnt lgkmcnt(6)
    v_mfma_f32_16x16x32_bf16 v[112:115], v[228:231], v[32:35], v[112:115]
    ds_read_b64_tr_b16 v[244:245], v5 offset:33568
    v_mfma_f32_16x16x32_bf16 v[116:119], v[228:231], v[36:39], v[116:119]
    ds_read_b64_tr_b16 v[246:247], v5 offset:34592
    s_waitcnt lgkmcnt(6)
    v_mfma_f32_16x16x32_bf16 v[120:123], v[232:235], v[32:35], v[120:123]
    v_mfma_f32_16x16x32_bf16 v[124:127], v[232:235], v[36:39], v[124:127]
    s_waitcnt vmcnt(18)
    s_barrier
    ds_read_b64_tr_b16 v[224:225], v4 offset:49152
    ds_read_b64_tr_b16 v[226:227], v4 offset:50176
    s_waitcnt lgkmcnt(6)
    v_mfma_f32_16x16x32_bf16 v[128:131], v[236:239], v[32:35], v[128:131]
    s_add_u32 s22, s24, 0x3b0000
    s_add_u32 m0, s20, 0x14000
    s_nop 0
    buffer_load_dwordx4 v3, s[4:7], s22 offen lds
    ds_read_b64_tr_b16 v[228:229], v5 offset:49184
    v_mfma_f32_16x16x32_bf16 v[132:135], v[236:239], v[36:39], v[132:135]
    ds_read_b64_tr_b16 v[230:231], v5 offset:50208
    s_waitcnt lgkmcnt(6)
    v_mfma_f32_16x16x32_bf16 v[136:139], v[240:243], v[32:35], v[136:139]
    ds_read_b64_tr_b16 v[232:233], v4 offset:49408
    v_mfma_f32_16x16x32_bf16 v[140:143], v[240:243], v[36:39], v[140:143]
    s_add_u32 s22, s24, 0x3b2000
    s_add_u32 m0, s20, 0x14400
    s_nop 0
    buffer_load_dwordx4 v3, s[4:7], s22 offen lds
    ds_read_b64_tr_b16 v[234:235], v4 offset:50432
    s_waitcnt lgkmcnt(6)
    v_mfma_f32_16x16x32_bf16 v[144:147], v[244:247], v[32:35], v[144:147]
    ds_read_b64_tr_b16 v[236:237], v5 offset:49440
    v_mfma_f32_16x16x32_bf16 v[148:151], v[244:247], v[36:39], v[148:151]
    ds_read_b64_tr_b16 v[238:239], v5 offset:50464
    s_waitcnt vmcnt(19) lgkmcnt(6)
    v_mfma_f32_16x16x32_bf16 v[88:91], v[224:227], v[40:43], v[88:91]
    ds_read_b64_tr_b16 v[240:241], v4 offset:49664
    s_waitcnt vmcnt(18)
    v_mfma_f32_16x16x32_bf16 v[92:95], v[224:227], v[44:47], v[92:95]
    ds_read_b64_tr_b16 v[242:243], v4 offset:50688
    s_waitcnt lgkmcnt(6)
    v_mfma_f32_16x16x32_bf16 v[96:99], v[228:231], v[40:43], v[96:99]
    ds_read_b64_tr_b16 v[244:245], v5 offset:49696
    s_mov_b32 s23, 0xe000
    buffer_load_dwordx4 v[32:35], v6, s[8:11], s23 offen offset:3072 sc1
    v_mfma_f32_16x16x32_bf16 v[100:103], v[228:231], v[44:47], v[100:103]
    ds_read_b64_tr_b16 v[246:247], v5 offset:50720
    s_waitcnt lgkmcnt(6)
    v_mfma_f32_16x16x32_bf16 v[104:107], v[232:235], v[40:43], v[104:107]
    ds_read_b64_tr_b16 v[224:225], v4 offset:49920
    v_mfma_f32_16x16x32_bf16 v[108:111], v[232:235], v[44:47], v[108:111]
    ds_read_b64_tr_b16 v[226:227], v4 offset:50944
    s_mov_b32 s23, 0x2e000
    buffer_load_dwordx4 v[36:39], v6, s[8:11], s23 offen offset:3072 sc1
    s_waitcnt lgkmcnt(6)
    v_mfma_f32_16x16x32_bf16 v[112:115], v[236:239], v[40:43], v[112:115]
    ds_read_b64_tr_b16 v[228:229], v5 offset:49952
    v_mfma_f32_16x16x32_bf16 v[116:119], v[236:239], v[44:47], v[116:119]
    ds_read_b64_tr_b16 v[230:231], v5 offset:50976
    s_waitcnt lgkmcnt(6)
    v_mfma_f32_16x16x32_bf16 v[120:123], v[240:243], v[40:43], v[120:123]
    v_mfma_f32_16x16x32_bf16 v[124:127], v[240:243], v[44:47], v[124:127]
    s_waitcnt vmcnt(18)
    s_barrier
    ds_read_b64_tr_b16 v[232:233], v7 offset:0
    ds_read_b64_tr_b16 v[234:235], v7 offset:1024
    s_waitcnt lgkmcnt(6)
    v_mfma_f32_16x16x32_bf16 v[128:131], v[244:247], v[40:43], v[128:131]
    ds_read_b64_tr_b16 v[236:237], v8 offset:32
    v_mfma_f32_16x16x32_bf16 v[132:135], v[244:247], v[44:47], v[132:135]
    ds_read_b64_tr_b16 v[238:239], v8 offset:1056
    s_waitcnt lgkmcnt(6)
    v_mfma_f32_16x16x32_bf16 v[136:139], v[224:227], v[40:43], v[136:139]
    ds_read_b64_tr_b16 v[240:241], v7 offset:256
    v_mfma_f32_16x16x32_bf16 v[140:143], v[224:227], v[44:47], v[140:143]
    ds_read_b64_tr_b16 v[242:243], v7 offset:1280
    s_waitcnt lgkmcnt(6)
    v_mfma_f32_16x16x32_bf16 v[144:147], v[228:231], v[40:43], v[144:147]
    ds_read_b64_tr_b16 v[244:245], v8 offset:288
    v_mfma_f32_16x16x32_bf16 v[148:151], v[228:231], v[44:47], v[148:151]
    ds_read_b64_tr_b16 v[246:247], v8 offset:1312
    s_waitcnt vmcnt(17) lgkmcnt(6)
    v_mfma_f32_16x16x32_bf16 v[88:91], v[232:235], v[48:51], v[88:91]
    ds_read_b64_tr_b16 v[224:225], v7 offset:512
    s_waitcnt vmcnt(16)
    v_mfma_f32_16x16x32_bf16 v[92:95], v[232:235], v[52:55], v[92:95]
    ds_read_b64_tr_b16 v[226:227], v7 offset:1536
    s_waitcnt lgkmcnt(6)
    v_mfma_f32_16x16x32_bf16 v[96:99], v[236:239], v[48:51], v[96:99]
    ds_read_b64_tr_b16 v[228:229], v8 offset:544
    v_mfma_f32_16x16x32_bf16 v[100:103], v[236:239], v[52:55], v[100:103]
    ds_read_b64_tr_b16 v[230:231], v8 offset:1568
    s_waitcnt lgkmcnt(6)
    v_mfma_f32_16x16x32_bf16 v[104:107], v[240:243], v[48:51], v[104:107]
    ds_read_b64_tr_b16 v[232:233], v7 offset:768
    v_mfma_f32_16x16x32_bf16 v[108:111], v[240:243], v[52:55], v[108:111]
    ds_read_b64_tr_b16 v[234:235], v7 offset:1792
    s_waitcnt lgkmcnt(6)
    v_mfma_f32_16x16x32_bf16 v[112:115], v[244:247], v[48:51], v[112:115]
    ds_read_b64_tr_b16 v[236:237], v8 offset:800
    v_mfma_f32_16x16x32_bf16 v[116:119], v[244:247], v[52:55], v[116:119]
    ds_read_b64_tr_b16 v[238:239], v8 offset:1824
    s_waitcnt lgkmcnt(6)
    v_mfma_f32_16x16x32_bf16 v[120:123], v[224:227], v[48:51], v[120:123]
    v_mfma_f32_16x16x32_bf16 v[124:127], v[224:227], v[52:55], v[124:127]
    s_waitcnt vmcnt(14)
    s_barrier
    ds_read_b64_tr_b16 v[240:241], v7 offset:16384
    ds_read_b64_tr_b16 v[242:243], v7 offset:17408
    s_waitcnt lgkmcnt(6)
    v_mfma_f32_16x16x32_bf16 v[128:131], v[228:231], v[48:51], v[128:131]
    ds_read_b64_tr_b16 v[244:245], v8 offset:16416
    v_mfma_f32_16x16x32_bf16 v[132:135], v[228:231], v[52:55], v[132:135]
    ds_read_b64_tr_b16 v[246:247], v8 offset:17440
    s_waitcnt lgkmcnt(6)
    v_mfma_f32_16x16x32_bf16 v[136:139], v[232:235], v[48:51], v[136:139]
    ds_read_b64_tr_b16 v[224:225], v7 offset:16640
    v_mfma_f32_16x16x32_bf16 v[140:143], v[232:235], v[52:55], v[140:143]
    ds_read_b64_tr_b16 v[226:227], v7 offset:17664
    s_waitcnt lgkmcnt(6)
    v_mfma_f32_16x16x32_bf16 v[144:147], v[236:239], v[48:51], v[144:147]
    ds_read_b64_tr_b16 v[228:229], v8 offset:16672
    v_mfma_f32_16x16x32_bf16 v[148:151], v[236:239], v[52:55], v[148:151]
    ds_read_b64_tr_b16 v[230:231], v8 offset:17696
    s_waitcnt vmcnt(13) lgkmcnt(6)
    v_mfma_f32_16x16x32_bf16 v[88:91], v[240:243], v[56:59], v[88:91]
    ds_read_b64_tr_b16 v[232:233], v7 offset:16896
    s_waitcnt vmcnt(12)
    v_mfma_f32_16x16x32_bf16 v[92:95], v[240:243], v[60:63], v[92:95]
    ds_read_b64_tr_b16 v[234:235], v7 offset:17920
    s_waitcnt lgkmcnt(6)
    v_mfma_f32_16x16x32_bf16 v[96:99], v[244:247], v[56:59], v[96:99]
    ds_read_b64_tr_b16 v[236:237], v8 offset:16928
    v_mfma_f32_16x16x32_bf16 v[100:103], v[244:247], v[60:63], v[100:103]
    ds_read_b64_tr_b16 v[238:239], v8 offset:17952
    s_waitcnt lgkmcnt(6)
    v_mfma_f32_16x16x32_bf16 v[104:107], v[224:227], v[56:59], v[104:107]
    ds_read_b64_tr_b16 v[240:241], v7 offset:17152
    v_mfma_f32_16x16x32_bf16 v[108:111], v[224:227], v[60:63], v[108:111]
    ds_read_b64_tr_b16 v[242:243], v7 offset:18176
    s_waitcnt lgkmcnt(6)
    v_mfma_f32_16x16x32_bf16 v[112:115], v[228:231], v[56:59], v[112:115]
    ds_read_b64_tr_b16 v[244:245], v8 offset:17184
    v_mfma_f32_16x16x32_bf16 v[116:119], v[228:231], v[60:63], v[116:119]
    ds_read_b64_tr_b16 v[246:247], v8 offset:18208
    s_waitcnt lgkmcnt(6)
    v_mfma_f32_16x16x32_bf16 v[120:123], v[232:235], v[56:59], v[120:123]
    v_mfma_f32_16x16x32_bf16 v[124:127], v[232:235], v[60:63], v[124:127]
    s_waitcnt vmcnt(10)
    s_barrier
    ds_read_b64_tr_b16 v[224:225], v4 offset:0
    ds_read_b64_tr_b16 v[226:227], v4 offset:1024
    s_waitcnt lgkmcnt(6)
    v_mfma_f32_16x16x32_bf16 v[128:131], v[236:239], v[56:59], v[128:131]
    ds_read_b64_tr_b16 v[228:229], v5 offset:32
    v_mfma_f32_16x16x32_bf16 v[132:135], v[236:239], v[60:63], v[132:135]
    ds_read_b64_tr_b16 v[230:231], v5 offset:1056
    s_waitcnt lgkmcnt(6)
    v_mfma_f32_16x16x32_bf16 v[136:139], v[240:243], v[56:59], v[136:139]
    ds_read_b64_tr_b16 v[232:233], v4 offset:256
    v_mfma_f32_16x16x32_bf16 v[140:143], v[240:243], v[60:63], v[140:143]
    ds_read_b64_tr_b16 v[234:235], v4 offset:1280
    s_waitcnt lgkmcnt(6)
    v_mfma_f32_16x16x32_bf16 v[144:147], v[244:247], v[56:59], v[144:147]
    ds_read_b64_tr_b16 v[236:237], v5 offset:288
    v_mfma_f32_16x16x32_bf16 v[148:151], v[244:247], v[60:63], v[148:151]
    ds_read_b64_tr_b16 v[238:239], v5 offset:1312
    s_waitcnt vmcnt(9) lgkmcnt(6)
    v_mfma_f32_16x16x32_bf16 v[88:91], v[224:227], v[24:27], v[88:91]
    ds_read_b64_tr_b16 v[240:241], v4 offset:512
    s_waitcnt vmcnt(8)
    v_mfma_f32_16x16x32_bf16 v[92:95], v[224:227], v[28:31], v[92:95]
    ds_read_b64_tr_b16 v[242:243], v4 offset:1536
    s_waitcnt lgkmcnt(6)
    v_mfma_f32_16x16x32_bf16 v[96:99], v[228:231], v[24:27], v[96:99]
    ds_read_b64_tr_b16 v[244:245], v5 offset:544
    v_mfma_f32_16x16x32_bf16 v[100:103], v[228:231], v[28:31], v[100:103]
    ds_read_b64_tr_b16 v[246:247], v5 offset:1568
    s_waitcnt lgkmcnt(6)
    v_mfma_f32_16x16x32_bf16 v[104:107], v[232:235], v[24:27], v[104:107]
    ds_read_b64_tr_b16 v[224:225], v4 offset:768
    v_mfma_f32_16x16x32_bf16 v[108:111], v[232:235], v[28:31], v[108:111]
    ds_read_b64_tr_b16 v[226:227], v4 offset:1792
    s_waitcnt lgkmcnt(6)
    v_mfma_f32_16x16x32_bf16 v[112:115], v[236:239], v[24:27], v[112:115]
    ds_read_b64_tr_b16 v[228:229], v5 offset:800
    v_mfma_f32_16x16x32_bf16 v[116:119], v[236:239], v[28:31], v[116:119]
    ds_read_b64_tr_b16 v[230:231], v5 offset:1824
    s_waitcnt lgkmcnt(6)
    v_mfma_f32_16x16x32_bf16 v[120:123], v[240:243], v[24:27], v[120:123]
    v_mfma_f32_16x16x32_bf16 v[124:127], v[240:243], v[28:31], v[124:127]
    s_waitcnt vmcnt(2)
    s_barrier
    ds_read_b64_tr_b16 v[232:233], v4 offset:16384
    ds_read_b64_tr_b16 v[234:235], v4 offset:17408
    s_waitcnt lgkmcnt(6)
    v_mfma_f32_16x16x32_bf16 v[128:131], v[244:247], v[24:27], v[128:131]
    ds_read_b64_tr_b16 v[236:237], v5 offset:16416
    v_mfma_f32_16x16x32_bf16 v[132:135], v[244:247], v[28:31], v[132:135]
    ds_read_b64_tr_b16 v[238:239], v5 offset:17440
    s_waitcnt lgkmcnt(6)
    v_mfma_f32_16x16x32_bf16 v[136:139], v[224:227], v[24:27], v[136:139]
    ds_read_b64_tr_b16 v[240:241], v4 offset:16640
    v_mfma_f32_16x16x32_bf16 v[140:143], v[224:227], v[28:31], v[140:143]
    ds_read_b64_tr_b16 v[242:243], v4 offset:17664
    s_waitcnt lgkmcnt(6)
    v_mfma_f32_16x16x32_bf16 v[144:147], v[228:231], v[24:27], v[144:147]
    ds_read_b64_tr_b16 v[244:245], v5 offset:16672
    v_mfma_f32_16x16x32_bf16 v[148:151], v[228:231], v[28:31], v[148:151]
    ds_read_b64_tr_b16 v[246:247], v5 offset:17696
    s_waitcnt vmcnt(1) lgkmcnt(6)
    v_mfma_f32_16x16x32_bf16 v[88:91], v[232:235], v[32:35], v[88:91]
    ds_read_b64_tr_b16 v[224:225], v4 offset:16896
    s_waitcnt vmcnt(0)
    v_mfma_f32_16x16x32_bf16 v[92:95], v[232:235], v[36:39], v[92:95]
    ds_read_b64_tr_b16 v[226:227], v4 offset:17920
    s_waitcnt lgkmcnt(6)
    v_mfma_f32_16x16x32_bf16 v[96:99], v[236:239], v[32:35], v[96:99]
    ds_read_b64_tr_b16 v[228:229], v5 offset:16928
    v_mfma_f32_16x16x32_bf16 v[100:103], v[236:239], v[36:39], v[100:103]
    ds_read_b64_tr_b16 v[230:231], v5 offset:17952
    s_waitcnt lgkmcnt(6)
    v_mfma_f32_16x16x32_bf16 v[104:107], v[240:243], v[32:35], v[104:107]
    ds_read_b64_tr_b16 v[232:233], v4 offset:17152
    v_mfma_f32_16x16x32_bf16 v[108:111], v[240:243], v[36:39], v[108:111]
    ds_read_b64_tr_b16 v[234:235], v4 offset:18176
    s_waitcnt lgkmcnt(6)
    v_mfma_f32_16x16x32_bf16 v[112:115], v[244:247], v[32:35], v[112:115]
    ds_read_b64_tr_b16 v[236:237], v5 offset:17184
    v_mfma_f32_16x16x32_bf16 v[116:119], v[244:247], v[36:39], v[116:119]
    ds_read_b64_tr_b16 v[238:239], v5 offset:18208
    s_waitcnt lgkmcnt(6)
    v_mfma_f32_16x16x32_bf16 v[120:123], v[224:227], v[32:35], v[120:123]
    v_mfma_f32_16x16x32_bf16 v[124:127], v[224:227], v[36:39], v[124:127]
    s_waitcnt lgkmcnt(4)
    v_mfma_f32_16x16x32_bf16 v[128:131], v[228:231], v[32:35], v[128:131]
    v_mfma_f32_16x16x32_bf16 v[132:135], v[228:231], v[36:39], v[132:135]
    s_waitcnt lgkmcnt(2)
    v_mfma_f32_16x16x32_bf16 v[136:139], v[232:235], v[32:35], v[136:139]
    v_mfma_f32_16x16x32_bf16 v[140:143], v[232:235], v[36:39], v[140:143]
    s_waitcnt lgkmcnt(0)
    v_mfma_f32_16x16x32_bf16 v[144:147], v[236:239], v[32:35], v[144:147]
    v_mfma_f32_16x16x32_bf16 v[148:151], v[236:239], v[36:39], v[148:151]
    s_lshl_b32 s16, s3, 13
    s_xor_b32 s17, s16, 0x8000
    s_add_u32 s16, s16, 0x18000
    s_add_u32 s17, s17, 0x18000
    v_add_u32 v16, s16, v2
    s_mov_b32 s16, s17
    v_add_u32 v17, s16, v2
    ds_write_b128 v16, v[120:123] offset:0
    ds_write_b128 v16, v[124:127] offset:1024
    ds_write_b128 v16, v[128:131] offset:2048
    ds_write_b128 v16, v[132:135] offset:3072
    ds_write_b128 v16, v[136:139] offset:4096
    ds_write_b128 v16, v[140:143] offset:5120
    ds_write_b128 v16, v[144:147] offset:6144
    ds_write_b128 v16, v[148:151] offset:7168
    v_lshlrev_b32 v24, 16, v248
    v_and_b32 v25, 0xffff0000, v248
    v_lshlrev_b32 v26, 16, v249
    v_and_b32 v27, 0xffff0000, v249
    v_lshlrev_b32 v28, 16, v250
    v_and_b32 v29, 0xffff0000, v250
    v_lshlrev_b32 v30, 16, v251
    v_and_b32 v31, 0xffff0000, v251
    v_lshlrev_b32 v32, 16, v252
    v_and_b32 v33, 0xffff0000, v252
    v_lshlrev_b32 v34, 16, v253
    v_and_b32 v35, 0xffff0000, v253
    v_lshlrev_b32 v36, 16, v254
    v_and_b32 v37, 0xffff0000, v254
    v_lshlrev_b32 v38, 16, v255
    v_and_b32 v39, 0xffff0000, v255
    v_and_b32 v18, 15, v1
    v_lshlrev_b32 v18, 6, v18
    v_lshrrev_b32 v19, 4, v1
    v_and_b32 v20, 1, v19
    v_lshl_add_u32 v18, v20, 5, v18
    v_lshrrev_b32 v19, 1, v19
    v_lshl_add_u32 v18, v19, 4, v18
    s_and_b32 s17, s3, 3
    s_lshl_b32 s18, s30, 2
    s_add_u32 s18, s18, s17
    s_lshl_b32 s18, s18, 16
    s_lshl_b32 s19, s15, 22
    s_add_u32 s18, s18, s19
    s_lshl_b32 s19, s31, 12
    s_add_u32 s18, s18, s19
    s_add_u32 s18, s18, 0x2c00000
    s_add_u32 s19, s18, 32768
    s_waitcnt lgkmcnt(0)
    s_barrier
    ds_read_b128 v[40:43], v17 offset:0
    ds_read_b128 v[44:47], v17 offset:1024
    ds_read_b128 v[48:51], v17 offset:2048
    ds_read_b128 v[52:55], v17 offset:3072
    ds_read_b128 v[56:59], v17 offset:4096
    ds_read_b128 v[60:63], v17 offset:5120
    ds_read_b128 v[64:67], v17 offset:6144
    ds_read_b128 v[68:71], v17 offset:7168
    s_waitcnt lgkmcnt(7)
    v_pk_add_f32 v[88:89], v[88:89], v[40:41]
    v_pk_add_f32 v[90:91], v[90:91], v[42:43]
    v_pk_mul_f32 v[88:89], v[88:89], v[24:25]
    v_pk_mul_f32 v[90:91], v[90:91], v[26:27]
    v_cvt_pk_bf16_f32 v224, v88, v89
    v_cvt_pk_bf16_f32 v225, v90, v91
    s_waitcnt lgkmcnt(5)
    v_pk_add_f32 v[96:97], v[96:97], v[48:49]
    v_pk_add_f32 v[98:99], v[98:99], v[50:51]
    v_pk_mul_f32 v[96:97], v[96:97], v[28:29]
    v_pk_mul_f32 v[98:99], v[98:99], v[30:31]
    v_cvt_pk_bf16_f32 v226, v96, v97
    v_cvt_pk_bf16_f32 v227, v98, v99
    s_nop 0
    v_permlane16_swap_b32 v224, v226
    v_permlane16_swap_b32 v225, v227
    buffer_store_dwordx4 v[224:227], v18, s[8:11], s18 offen offset:0 sc1
    v_pk_add_f32 v[92:93], v[92:93], v[44:45]
    v_pk_add_f32 v[94:95], v[94:95], v[46:47]
    v_pk_mul_f32 v[92:93], v[92:93], v[24:25]
    v_pk_mul_f32 v[94:95], v[94:95], v[26:27]
    v_cvt_pk_bf16_f32 v228, v92, v93
    v_cvt_pk_bf16_f32 v229, v94, v95
    s_waitcnt lgkmcnt(4)
    v_pk_add_f32 v[100:101], v[100:101], v[52:53]
    v_pk_add_f32 v[102:103], v[102:103], v[54:55]
    v_pk_mul_f32 v[100:101], v[100:101], v[28:29]
    v_pk_mul_f32 v[102:103], v[102:103], v[30:31]
    v_cvt_pk_bf16_f32 v230, v100, v101
    v_cvt_pk_bf16_f32 v231, v102, v103
    s_nop 0
    v_permlane16_swap_b32 v228, v230
    v_permlane16_swap_b32 v229, v231
    buffer_store_dwordx4 v[228:231], v18, s[8:11], s19 offen offset:0 sc1
    s_waitcnt lgkmcnt(3)
    v_pk_add_f32 v[104:105], v[104:105], v[56:57]
    v_pk_add_f32 v[106:107], v[106:107], v[58:59]
    v_pk_mul_f32 v[104:105], v[104:105], v[32:33]
    v_pk_mul_f32 v[106:107], v[106:107], v[34:35]
    v_cvt_pk_bf16_f32 v232, v104, v105
    v_cvt_pk_bf16_f32 v233, v106, v107
    s_waitcnt lgkmcnt(1)
    v_pk_add_f32 v[112:113], v[112:113], v[64:65]
    v_pk_add_f32 v[114:115], v[114:115], v[66:67]
    v_pk_mul_f32 v[112:113], v[112:113], v[36:37]
    v_pk_mul_f32 v[114:115], v[114:115], v[38:39]
    v_cvt_pk_bf16_f32 v234, v112, v113
    v_cvt_pk_bf16_f32 v235, v114, v115
    s_nop 0
    v_permlane16_swap_b32 v232, v234
    v_permlane16_swap_b32 v233, v235
    buffer_store_dwordx4 v[232:235], v18, s[8:11], s18 offen offset:1024 sc1
    v_pk_add_f32 v[108:109], v[108:109], v[60:61]
    v_pk_add_f32 v[110:111], v[110:111], v[62:63]
    v_pk_mul_f32 v[108:109], v[108:109], v[32:33]
    v_pk_mul_f32 v[110:111], v[110:111], v[34:35]
    v_cvt_pk_bf16_f32 v236, v108, v109
    v_cvt_pk_bf16_f32 v237, v110, v111
    s_waitcnt lgkmcnt(0)
    v_pk_add_f32 v[116:117], v[116:117], v[68:69]
    v_pk_add_f32 v[118:119], v[118:119], v[70:71]
    v_pk_mul_f32 v[116:117], v[116:117], v[36:37]
    v_pk_mul_f32 v[118:119], v[118:119], v[38:39]
    v_cvt_pk_bf16_f32 v238, v116, v117
    v_cvt_pk_bf16_f32 v239, v118, v119
    s_nop 0
    v_permlane16_swap_b32 v236, v238
    v_permlane16_swap_b32 v237, v239
    buffer_store_dwordx4 v[236:239], v18, s[8:11], s19 offen offset:1024 sc1
    s_mov_b64 s[64:65], s[44:45]
    s_mov_b32 s66, 0x800
    s_mov_b32 s67, 0x20000
    s_mov_b64 s[76:77], s[32:33]
    s_mov_b32 s78, 0x400000
    s_mov_b32 s79, 0x20000
    s_mov_b64 s[68:69], s[56:57]
    s_mov_b32 s70, 0x400000
    s_mov_b32 s71, 0x20000
    s_lshl_b32 s14, s31, 1
    s_add_u32 s14, s14, s15
    s_lshl_b32 s14, s14, 3
    s_add_u32 s14, s14, s3
    s_lshl_b32 s16, s30, 7
    s_add_u32 s14, s14, s16
    s_lshl_b32 s16, s14, 11
    buffer_load_dwordx4 v[216:219], v2, s[76:79], s16 offen offset:0
    buffer_load_dwordx4 v[220:223], v2, s[76:79], s16 offen offset:1024
    s_lshl_b32 s16, s3, 10
    s_add_u32 m0, s16, 81920
    s_add_u32 s16, s16, 0x540800
    buffer_load_dwordx4 v2, s[8:11], s16 offen sc1 lds
    s_lshl_b32 s16, s30, 5
    s_lshl_b32 s17, s31, 1
    s_add_u32 s16, s16, s17
    s_add_u32 s16, s16, s15
    s_lshl_b32 s16, s16, 2
    s_add_u32 s16, s16, 0x530000
    s_cmp_eq_u32 s3, 0
    s_cselect_b32 s16, s16, 0x7ffffff0
    v_mov_b32 v16, s28
    v_mov_b32 v17, 0
    s_lshr_b32 s18, s14, 4
    s_lshl_b32 s18, s18, 15
    s_and_b32 s19, s14, 15
    s_lshl_b32 s19, s19, 6
    s_add_u32 s18, s18, s19
    s_add_u32 s18, s18, 0x2c00000
    s_add_u32 s19, s18, 16384
    v_lshrrev_b32 v18, 2, v1
    v_lshlrev_b32 v18, 10, v18
    v_and_b32 v19, 3, v1
    v_lshl_add_u32 v18, v19, 4, v18
    v_add_u32 v19, 0x400000, v18
    s_lshl_b32 s25, s30, 7
    s_add_u32 s25, s25, 0x530000
    v_and_b32 v20, 15, v1
    v_lshlrev_b32 v20, 2, v20
    s_waitcnt vmcnt(3)
    s_waitcnt vmcnt(0)
    s_barrier
    s_mov_b64 exec, 1
    buffer_store_dword v16, v17, s[8:11], s16 offen sc1
    s_mov_b64 exec, -1
    v_add_u32 v16, 81920, v2
    ds_read_b128 v[184:187], v16 offset:0
    ds_read_b128 v[188:191], v16 offset:1024
    ds_read_b128 v[192:195], v16 offset:2048
    ds_read_b128 v[196:199], v16 offset:3072
    ds_read_b128 v[200:203], v16 offset:4096
    ds_read_b128 v[204:207], v16 offset:5120
    ds_read_b128 v[208:211], v16 offset:6144
    ds_read_b128 v[212:215], v16 offset:7168
    v_mov_b32 v94, 0
    v_mov_b32 v95, 0
    s_waitcnt lgkmcnt(5)
    v_lshlrev_b32 v76, 16, v192
    v_and_b32 v77, 0xffff0000, v192
    s_waitcnt lgkmcnt(1)
    v_lshlrev_b32 v78, 16, v208
    v_and_b32 v79, 0xffff0000, v208
    v_pk_mul_f32 v[60:61], v[76:77], v[78:79]
    v_lshlrev_b32 v76, 16, v184
    v_and_b32 v77, 0xffff0000, v184
    v_fmac_f32 v94, v76, v78
    v_fmac_f32 v94, v77, v79
    v_add_f32 v95, v95, v60
    v_add_f32 v95, v95, v61
    v_lshlrev_b32 v76, 16, v193
    v_and_b32 v77, 0xffff0000, v193
    v_lshlrev_b32 v78, 16, v209
    v_and_b32 v79, 0xffff0000, v209
    v_pk_mul_f32 v[62:63], v[76:77], v[78:79]
    v_lshlrev_b32 v76, 16, v185
    v_and_b32 v77, 0xffff0000, v185
    v_fmac_f32 v94, v76, v78
    v_fmac_f32 v94, v77, v79
    v_add_f32 v95, v95, v62
    v_add_f32 v95, v95, v63
    v_lshlrev_b32 v76, 16, v194
    v_and_b32 v77, 0xffff0000, v194
    v_lshlrev_b32 v78, 16, v210
    v_and_b32 v79, 0xffff0000, v210
    v_pk_mul_f32 v[64:65], v[76:77], v[78:79]
    v_lshlrev_b32 v76, 16, v186
    v_and_b32 v77, 0xffff0000, v186
    v_fmac_f32 v94, v76, v78
    v_fmac_f32 v94, v77, v79
    v_add_f32 v95, v95, v64
    v_add_f32 v95, v95, v65
    v_lshlrev_b32 v76, 16, v195
    v_and_b32 v77, 0xffff0000, v195
    v_lshlrev_b32 v78, 16, v211
    v_and_b32 v79, 0xffff0000, v211
    v_pk_mul_f32 v[66:67], v[76:77], v[78:79]
    v_lshlrev_b32 v76, 16, v187
    v_and_b32 v77, 0xffff0000, v187
    v_fmac_f32 v94, v76, v78
    v_fmac_f32 v94, v77, v79
    v_add_f32 v95, v95, v66
    v_add_f32 v95, v95, v67
    v_lshlrev_b32 v76, 16, v196
    v_and_b32 v77, 0xffff0000, v196
    s_waitcnt lgkmcnt(0)
    v_lshlrev_b32 v78, 16, v212
    v_and_b32 v79, 0xffff0000, v212
    v_pk_mul_f32 v[68:69], v[76:77], v[78:79]
    v_lshlrev_b32 v76, 16, v188
    v_and_b32 v77, 0xffff0000, v188
    v_fmac_f32 v94, v76, v78
    v_fmac_f32 v94, v77, v79
    v_add_f32 v95, v95, v68
    v_add_f32 v95, v95, v69
    v_lshlrev_b32 v76, 16, v197
    v_and_b32 v77, 0xffff0000, v197
    v_lshlrev_b32 v78, 16, v213
    v_and_b32 v79, 0xffff0000, v213
    v_pk_mul_f32 v[70:71], v[76:77], v[78:79]
    v_lshlrev_b32 v76, 16, v189
    v_and_b32 v77, 0xffff0000, v189
    v_fmac_f32 v94, v76, v78
    v_fmac_f32 v94, v77, v79
    v_add_f32 v95, v95, v70
    v_add_f32 v95, v95, v71
    v_lshlrev_b32 v76, 16, v198
    v_and_b32 v77, 0xffff0000, v198
    v_lshlrev_b32 v78, 16, v214
    v_and_b32 v79, 0xffff0000, v214
    v_pk_mul_f32 v[72:73], v[76:77], v[78:79]
    v_lshlrev_b32 v76, 16, v190
    v_and_b32 v77, 0xffff0000, v190
    v_fmac_f32 v94, v76, v78
    v_fmac_f32 v94, v77, v79
    v_add_f32 v95, v95, v72
    v_add_f32 v95, v95, v73
    v_lshlrev_b32 v76, 16, v199
    v_and_b32 v77, 0xffff0000, v199
    v_lshlrev_b32 v78, 16, v215
    v_and_b32 v79, 0xffff0000, v215
    v_pk_mul_f32 v[74:75], v[76:77], v[78:79]
    v_lshlrev_b32 v76, 16, v191
    v_and_b32 v77, 0xffff0000, v191
    v_fmac_f32 v94, v76, v78
    v_fmac_f32 v94, v77, v79
    v_add_f32 v95, v95, v74
    v_add_f32 v95, v95, v75
    v_add_f32_dpp v94, v94, v94 row_ror:1 row_mask:0xf bank_mask:0xf
    s_nop 0
    v_add_f32_dpp v95, v95, v95 row_ror:1 row_mask:0xf bank_mask:0xf
    v_add_f32_dpp v94, v94, v94 row_ror:2 row_mask:0xf bank_mask:0xf
    s_nop 0
    v_add_f32_dpp v95, v95, v95 row_ror:2 row_mask:0xf bank_mask:0xf
    v_add_f32_dpp v94, v94, v94 row_ror:4 row_mask:0xf bank_mask:0xf
    s_nop 0
    v_add_f32_dpp v95, v95, v95 row_ror:4 row_mask:0xf bank_mask:0xf
    v_add_f32_dpp v94, v94, v94 row_ror:8 row_mask:0xf bank_mask:0xf
    s_nop 0
    v_add_f32_dpp v95, v95, v95 row_ror:8 row_mask:0xf bank_mask:0xf
    v_mov_b32 v76, v94
    s_nop 1
    v_permlane16_swap_b32 v94, v76
    v_add_f32 v94, v94, v76
    v_mov_b32 v77, v95
    s_nop 1
    v_permlane16_swap_b32 v95, v77
    v_add_f32 v95, v95, v77
    v_mov_b32 v76, v94
    s_nop 1
    v_permlane32_swap_b32 v94, v76
    v_add_f32 v94, v94, v76
    v_mov_b32 v77, v95
    s_nop 1
    v_permlane32_swap_b32 v95, v77
    v_add_f32 v95, v95, v77
    v_lshlrev_b32 v28, 16, v216
    v_and_b32 v29, 0xffff0000, v216
    v_lshlrev_b32 v30, 16, v217
    v_and_b32 v31, 0xffff0000, v217
    v_lshlrev_b32 v32, 16, v218
    v_and_b32 v33, 0xffff0000, v218
    v_lshlrev_b32 v34, 16, v219
    v_and_b32 v35, 0xffff0000, v219
    v_lshlrev_b32 v36, 16, v220
    v_and_b32 v37, 0xffff0000, v220
    v_lshlrev_b32 v38, 16, v221
    v_and_b32 v39, 0xffff0000, v221
    v_lshlrev_b32 v40, 16, v222
    v_and_b32 v41, 0xffff0000, v222
    v_lshlrev_b32 v42, 16, v223
    v_and_b32 v43, 0xffff0000, v223
    s_sleep 16
    s_mov_b32 s27, 0
adaLN_cond__sliding_block_cached__moe_arch_mod__prompt_kernel_a11p:
    buffer_load_dword v76, v20, s[8:11], s25 offen sc1
    s_waitcnt vmcnt(0)
    v_cmp_ne_u32 vcc, s28, v76
    s_add_u32 s27, s27, 1
    s_cmp_ge_u32 s27, 262144
    s_cbranch_scc1 adaLN_cond__sliding_block_cached__moe_arch_mod__prompt_kernel_a11g
    s_cbranch_vccnz adaLN_cond__sliding_block_cached__moe_arch_mod__prompt_kernel_a11p
adaLN_cond__sliding_block_cached__moe_arch_mod__prompt_kernel_a11g:
    buffer_load_dwordx4 v[44:47], v18, s[8:11], s18 offen sc1
    buffer_load_dwordx4 v[52:55], v19, s[8:11], s18 offen sc1
    buffer_load_dwordx4 v[48:51], v18, s[8:11], s19 offen sc1
    buffer_load_dwordx4 v[56:59], v19, s[8:11], s19 offen sc1
    v_lshlrev_b32 v21, 2, v0
    s_mov_b32 s16, 0x540800
    buffer_load_dword v106, v21, s[8:11], s16 offen sc1
    buffer_load_dword v104, v21, s[8:11], s16 offen offset:2048 sc1
    s_waitcnt vmcnt(5)
    v_lshlrev_b32 v76, 16, v44
    v_and_b32 v77, 0xffff0000, v44
    s_waitcnt vmcnt(4)
    v_lshlrev_b32 v78, 16, v52
    v_and_b32 v79, 0xffff0000, v52
    v_pk_add_f32 v[76:77], v[76:77], v[78:79]
    v_pk_add_f32 v[28:29], v[28:29], v[76:77]
    v_cvt_pk_bf16_f32 v16, v28, v29
    v_lshlrev_b32 v28, 16, v16
    v_and_b32 v29, 0xffff0000, v16
    v_lshlrev_b32 v80, 16, v45
    v_and_b32 v81, 0xffff0000, v45
    v_lshlrev_b32 v82, 16, v53
    v_and_b32 v83, 0xffff0000, v53
    v_pk_add_f32 v[80:81], v[80:81], v[82:83]
    v_pk_add_f32 v[30:31], v[30:31], v[80:81]
    v_cvt_pk_bf16_f32 v17, v30, v31
    v_lshlrev_b32 v30, 16, v17
    v_and_b32 v31, 0xffff0000, v17
    v_lshlrev_b32 v76, 16, v46
    v_and_b32 v77, 0xffff0000, v46
    v_lshlrev_b32 v78, 16, v54
    v_and_b32 v79, 0xffff0000, v54
    v_pk_add_f32 v[76:77], v[76:77], v[78:79]
    v_pk_add_f32 v[32:33], v[32:33], v[76:77]
    v_cvt_pk_bf16_f32 v16, v32, v33
    v_lshlrev_b32 v32, 16, v16
    v_and_b32 v33, 0xffff0000, v16
    v_lshlrev_b32 v80, 16, v47
    v_and_b32 v81, 0xffff0000, v47
    v_lshlrev_b32 v82, 16, v55
    v_and_b32 v83, 0xffff0000, v55
    v_pk_add_f32 v[80:81], v[80:81], v[82:83]
    v_pk_add_f32 v[34:35], v[34:35], v[80:81]
    v_cvt_pk_bf16_f32 v17, v34, v35
    v_lshlrev_b32 v34, 16, v17
    v_and_b32 v35, 0xffff0000, v17
    s_waitcnt vmcnt(3)
    v_lshlrev_b32 v76, 16, v48
    v_and_b32 v77, 0xffff0000, v48
    s_waitcnt vmcnt(2)
    v_lshlrev_b32 v78, 16, v56
    v_and_b32 v79, 0xffff0000, v56
    v_pk_add_f32 v[76:77], v[76:77], v[78:79]
    v_pk_add_f32 v[36:37], v[36:37], v[76:77]
    v_cvt_pk_bf16_f32 v16, v36, v37
    v_lshlrev_b32 v36, 16, v16
    v_and_b32 v37, 0xffff0000, v16
    v_lshlrev_b32 v80, 16, v49
    v_and_b32 v81, 0xffff0000, v49
    v_lshlrev_b32 v82, 16, v57
    v_and_b32 v83, 0xffff0000, v57
    v_pk_add_f32 v[80:81], v[80:81], v[82:83]
    v_pk_add_f32 v[38:39], v[38:39], v[80:81]
    v_cvt_pk_bf16_f32 v17, v38, v39
    v_lshlrev_b32 v38, 16, v17
    v_and_b32 v39, 0xffff0000, v17
    v_lshlrev_b32 v76, 16, v50
    v_and_b32 v77, 0xffff0000, v50
    v_lshlrev_b32 v78, 16, v58
    v_and_b32 v79, 0xffff0000, v58
    v_pk_add_f32 v[76:77], v[76:77], v[78:79]
    v_pk_add_f32 v[40:41], v[40:41], v[76:77]
    v_cvt_pk_bf16_f32 v16, v40, v41
    v_lshlrev_b32 v40, 16, v16
    v_and_b32 v41, 0xffff0000, v16
    v_lshlrev_b32 v80, 16, v51
    v_and_b32 v81, 0xffff0000, v51
    v_lshlrev_b32 v82, 16, v59
    v_and_b32 v83, 0xffff0000, v59
    v_pk_add_f32 v[80:81], v[80:81], v[82:83]
    v_pk_add_f32 v[42:43], v[42:43], v[80:81]
    v_cvt_pk_bf16_f32 v17, v42, v43
    v_lshlrev_b32 v42, 16, v17
    v_and_b32 v43, 0xffff0000, v17
    v_pk_add_f32 v[76:77], v[28:29], v[30:31]
    v_pk_mul_f32 v[78:79], v[28:29], v[28:29]
    v_pk_mul_f32 v[80:81], v[28:29], v[60:61]
    v_pk_fma_f32 v[78:79], v[30:31], v[30:31], v[78:79]
    v_pk_fma_f32 v[80:81], v[30:31], v[62:63], v[80:81]
    v_pk_add_f32 v[76:77], v[76:77], v[32:33]
    v_pk_fma_f32 v[78:79], v[32:33], v[32:33], v[78:79]
    v_pk_fma_f32 v[80:81], v[32:33], v[64:65], v[80:81]
    v_pk_add_f32 v[76:77], v[76:77], v[34:35]
    v_pk_fma_f32 v[78:79], v[34:35], v[34:35], v[78:79]
    v_pk_fma_f32 v[80:81], v[34:35], v[66:67], v[80:81]
    v_pk_add_f32 v[76:77], v[76:77], v[36:37]
    v_pk_fma_f32 v[78:79], v[36:37], v[36:37], v[78:79]
    v_pk_fma_f32 v[80:81], v[36:37], v[68:69], v[80:81]
    v_pk_add_f32 v[76:77], v[76:77], v[38:39]
    v_pk_fma_f32 v[78:79], v[38:39], v[38:39], v[78:79]
    v_pk_fma_f32 v[80:81], v[38:39], v[70:71], v[80:81]
    v_pk_add_f32 v[76:77], v[76:77], v[40:41]
    v_pk_fma_f32 v[78:79], v[40:41], v[40:41], v[78:79]
    v_pk_fma_f32 v[80:81], v[40:41], v[72:73], v[80:81]
    v_pk_add_f32 v[76:77], v[76:77], v[42:43]
    v_pk_fma_f32 v[78:79], v[42:43], v[42:43], v[78:79]
    v_pk_fma_f32 v[80:81], v[42:43], v[74:75], v[80:81]
    v_add_f32 v96, v76, v77
    v_add_f32 v97, v78, v79
    v_add_f32 v98, v80, v81
    v_add_f32_dpp v96, v96, v96 row_ror:1 row_mask:0xf bank_mask:0xf
    v_add_f32_dpp v97, v97, v97 row_ror:1 row_mask:0xf bank_mask:0xf
    v_add_f32_dpp v98, v98, v98 row_ror:1 row_mask:0xf bank_mask:0xf
    v_add_f32_dpp v96, v96, v96 row_ror:2 row_mask:0xf bank_mask:0xf
    v_add_f32_dpp v97, v97, v97 row_ror:2 row_mask:0xf bank_mask:0xf
    v_add_f32_dpp v98, v98, v98 row_ror:2 row_mask:0xf bank_mask:0xf
    v_add_f32_dpp v96, v96, v96 row_ror:4 row_mask:0xf bank_mask:0xf
    v_add_f32_dpp v97, v97, v97 row_ror:4 row_mask:0xf bank_mask:0xf
    v_add_f32_dpp v98, v98, v98 row_ror:4 row_mask:0xf bank_mask:0xf
    v_add_f32_dpp v96, v96, v96 row_ror:8 row_mask:0xf bank_mask:0xf
    v_add_f32_dpp v97, v97, v97 row_ror:8 row_mask:0xf bank_mask:0xf
    v_add_f32_dpp v98, v98, v98 row_ror:8 row_mask:0xf bank_mask:0xf
    v_mov_b32 v76, v96
    s_nop 1
    v_permlane16_swap_b32 v96, v76
    v_add_f32 v96, v96, v76
    v_mov_b32 v77, v97
    s_nop 1
    v_permlane16_swap_b32 v97, v77
    v_add_f32 v97, v97, v77
    v_mov_b32 v78, v98
    s_nop 1
    v_permlane16_swap_b32 v98, v78
    v_add_f32 v98, v98, v78
    v_mov_b32 v76, v96
    s_nop 1
    v_permlane32_swap_b32 v96, v76
    v_add_f32 v96, v96, v76
    v_mov_b32 v77, v97
    s_nop 1
    v_permlane32_swap_b32 v97, v77
    v_add_f32 v97, v97, v77
    v_mov_b32 v78, v98
    s_nop 1
    v_permlane32_swap_b32 v98, v78
    v_add_f32 v98, v98, v78
    v_mul_f32 v96, 0x3a800000, v96
    v_mul_f32 v97, 0x3a800000, v97
    v_fma_f32 v97, -v96, v96, v97
    v_max_f32 v97, 0, v97
    v_fma_f32 v98, -v96, v95, v98
    v_add_f32 v76, 0x3727c5ac, v97
    v_rsq_f32 v76, v76
    s_nop 0
    v_fma_f32 v27, v98, v76, v94
    v_cvt_pk_bf16_f32 v96, v96, v96
    v_lshlrev_b32 v96, 16, v96
    v_cvt_pk_bf16_f32 v97, v97, v97
    v_lshlrev_b32 v97, 16, v97
    v_add_f32 v97, 0x3727c5ac, v97
    v_cvt_pk_bf16_f32 v97, v97, v97
    v_lshlrev_b32 v97, 16, v97
    v_sqrt_f32 v98, v97
    s_nop 0
    v_cvt_pk_bf16_f32 v98, v98, v98
    v_lshlrev_b32 v98, 16, v98
    v_rcp_f32 v99, v98
    v_mov_b32 v25, v96
    v_mov_b32 v26, v98
    v_ashrrev_i32 v16, 31, v27
    v_or_b32 v16, 0x80000000, v16
    v_xor_b32 v24, v27, v16
    v_and_b32 v24, 0xfffff800, v24
    v_max_u32 v24, 0x800, v24
    s_sub_u32 s16, 2047, s14
    v_or_b32 v24, s16, v24
    s_lshl_b32 s16, s3, 4
    s_add_u32 s16, s16, 65536
    v_mov_b32 v16, s16
    ds_write_b128 v16, v[24:27]
    s_waitcnt lgkmcnt(0)
    s_barrier
    v_and_b32 v16, 7, v1
    v_lshlrev_b32 v16, 4, v16
    v_add_u32 v16, 65536, v16
    ds_read_b32 v76, v16
    s_waitcnt lgkmcnt(0)
    v_mov_b32 v77, v76
    s_nop 1
    v_max_u32_dpp v77, v77, v77 row_ror:1 row_mask:0xf bank_mask:0xf
    s_nop 1
    v_max_u32_dpp v77, v77, v77 row_ror:2 row_mask:0xf bank_mask:0xf
    s_nop 1
    v_max_u32_dpp v77, v77, v77 row_ror:4 row_mask:0xf bank_mask:0xf
    v_cmp_eq_u32 vcc, v76, v77
    s_ff1_i32_b64 s16, vcc
    s_lshl_b32 s16, s16, 4
    s_add_u32 s16, s16, 65536
    v_mov_b32 v16, s16
    ds_read_b128 v[24:27], v16
    s_lshl_b32 s16, s2, 4
    s_add_u32 s16, s16, 0x6e0000
    s_cmp_eq_u32 s3, 0
    s_cselect_b32 s16, s16, 0x7ffffff0
    v_mov_b32 v17, 0
    s_mov_b64 exec, 1
    s_waitcnt lgkmcnt(0)
    buffer_store_dwordx4 v[24:27], v17, s[8:11], s16 offen sc1
    s_mov_b64 exec, -1
    v_sub_f32 v44, v28, v96
    v_sub_f32 v45, v29, v96
    v_sub_f32 v46, v30, v96
    v_sub_f32 v47, v31, v96
    v_sub_f32 v48, v32, v96
    v_sub_f32 v49, v33, v96
    v_sub_f32 v50, v34, v96
    v_sub_f32 v51, v35, v96
    v_cvt_pk_bf16_f32 v16, v44, v45
    v_lshlrev_b32 v44, 16, v16
    v_and_b32 v45, 0xffff0000, v16
    v_cvt_pk_bf16_f32 v16, v46, v47
    v_lshlrev_b32 v46, 16, v16
    v_and_b32 v47, 0xffff0000, v16
    v_cvt_pk_bf16_f32 v16, v48, v49
    v_lshlrev_b32 v48, 16, v16
    v_and_b32 v49, 0xffff0000, v16
    v_cvt_pk_bf16_f32 v16, v50, v51
    v_lshlrev_b32 v50, 16, v16
    v_and_b32 v51, 0xffff0000, v16
    v_mul_f32 v52, v44, v99
    v_mul_f32 v53, v45, v99
    v_mul_f32 v54, v46, v99
    v_mul_f32 v55, v47, v99
    v_mul_f32 v56, v48, v99
    v_mul_f32 v57, v49, v99
    v_mul_f32 v58, v50, v99
    v_mul_f32 v59, v51, v99
    v_fma_f32 v44, -v52, v98, v44
    v_fma_f32 v45, -v53, v98, v45
    v_fma_f32 v46, -v54, v98, v46
    v_fma_f32 v47, -v55, v98, v47
    v_fma_f32 v48, -v56, v98, v48
    v_fma_f32 v49, -v57, v98, v49
    v_fma_f32 v50, -v58, v98, v50
    v_fma_f32 v51, -v59, v98, v51
    v_fma_f32 v44, v44, v99, v52
    v_fma_f32 v45, v45, v99, v53
    v_fma_f32 v46, v46, v99, v54
    v_fma_f32 v47, v47, v99, v55
    v_fma_f32 v48, v48, v99, v56
    v_fma_f32 v49, v49, v99, v57
    v_fma_f32 v50, v50, v99, v58
    v_fma_f32 v51, v51, v99, v59
    v_cvt_pk_bf16_f32 v16, v44, v45
    v_lshlrev_b32 v44, 16, v16
    v_and_b32 v45, 0xffff0000, v16
    v_cvt_pk_bf16_f32 v16, v46, v47
    v_lshlrev_b32 v46, 16, v16
    v_and_b32 v47, 0xffff0000, v16
    v_cvt_pk_bf16_f32 v16, v48, v49
    v_lshlrev_b32 v48, 16, v16
    v_and_b32 v49, 0xffff0000, v16
    v_cvt_pk_bf16_f32 v16, v50, v51
    v_lshlrev_b32 v50, 16, v16
    v_and_b32 v51, 0xffff0000, v16
    v_lshlrev_b32 v52, 16, v192
    v_and_b32 v53, 0xffff0000, v192
    v_lshlrev_b32 v54, 16, v193
    v_and_b32 v55, 0xffff0000, v193
    v_lshlrev_b32 v56, 16, v194
    v_and_b32 v57, 0xffff0000, v194
    v_lshlrev_b32 v58, 16, v195
    v_and_b32 v59, 0xffff0000, v195
    v_pk_mul_f32 v[44:45], v[44:45], v[52:53]
    v_pk_mul_f32 v[46:47], v[46:47], v[54:55]
    v_pk_mul_f32 v[48:49], v[48:49], v[56:57]
    v_pk_mul_f32 v[50:51], v[50:51], v[58:59]
    v_cvt_pk_bf16_f32 v16, v44, v45
    v_lshlrev_b32 v44, 16, v16
    v_and_b32 v45, 0xffff0000, v16
    v_cvt_pk_bf16_f32 v16, v46, v47
    v_lshlrev_b32 v46, 16, v16
    v_and_b32 v47, 0xffff0000, v16
    v_cvt_pk_bf16_f32 v16, v48, v49
    v_lshlrev_b32 v48, 16, v16
    v_and_b32 v49, 0xffff0000, v16
    v_cvt_pk_bf16_f32 v16, v50, v51
    v_lshlrev_b32 v50, 16, v16
    v_and_b32 v51, 0xffff0000, v16
    v_lshlrev_b32 v52, 16, v184
    v_and_b32 v53, 0xffff0000, v184
    v_lshlrev_b32 v54, 16, v185
    v_and_b32 v55, 0xffff0000, v185
    v_lshlrev_b32 v56, 16, v186
    v_and_b32 v57, 0xffff0000, v186
    v_lshlrev_b32 v58, 16, v187
    v_and_b32 v59, 0xffff0000, v187
    v_pk_add_f32 v[44:45], v[44:45], v[52:53]
    v_pk_add_f32 v[46:47], v[46:47], v[54:55]
    v_pk_add_f32 v[48:49], v[48:49], v[56:57]
    v_pk_add_f32 v[50:51], v[50:51], v[58:59]
    v_cvt_pk_bf16_f32 v16, v44, v45
    v_lshlrev_b32 v44, 16, v16
    v_and_b32 v45, 0xffff0000, v16
    v_cvt_pk_bf16_f32 v16, v46, v47
    v_lshlrev_b32 v46, 16, v16
    v_and_b32 v47, 0xffff0000, v16
    v_cvt_pk_bf16_f32 v16, v48, v49
    v_lshlrev_b32 v48, 16, v16
    v_and_b32 v49, 0xffff0000, v16
    v_cvt_pk_bf16_f32 v16, v50, v51
    v_lshlrev_b32 v50, 16, v16
    v_and_b32 v51, 0xffff0000, v16
    v_lshlrev_b32 v52, 16, v200
    v_and_b32 v53, 0xffff0000, v200
    v_lshlrev_b32 v54, 16, v201
    v_and_b32 v55, 0xffff0000, v201
    v_lshlrev_b32 v56, 16, v202
    v_and_b32 v57, 0xffff0000, v202
    v_lshlrev_b32 v58, 16, v203
    v_and_b32 v59, 0xffff0000, v203
    v_pk_mul_f32 v[44:45], v[44:45], v[52:53]
    v_pk_mul_f32 v[46:47], v[46:47], v[54:55]
    v_pk_mul_f32 v[48:49], v[48:49], v[56:57]
    v_pk_mul_f32 v[50:51], v[50:51], v[58:59]
    v_cvt_pk_bf16_f32 v16, v44, v45
    v_lshlrev_b32 v44, 16, v16
    v_and_b32 v45, 0xffff0000, v16
    v_cvt_pk_bf16_f32 v16, v46, v47
    v_lshlrev_b32 v46, 16, v16
    v_and_b32 v47, 0xffff0000, v16
    v_cvt_pk_bf16_f32 v16, v48, v49
    v_lshlrev_b32 v48, 16, v16
    v_and_b32 v49, 0xffff0000, v16
    v_cvt_pk_bf16_f32 v16, v50, v51
    v_lshlrev_b32 v50, 16, v16
    v_and_b32 v51, 0xffff0000, v16
    v_pk_add_f32 v[44:45], v[44:45], v[28:29]
    v_pk_add_f32 v[46:47], v[46:47], v[30:31]
    v_pk_add_f32 v[48:49], v[48:49], v[32:33]
    v_pk_add_f32 v[50:51], v[50:51], v[34:35]
    v_cvt_pk_bf16_f32 v28, v44, v45
    v_cvt_pk_bf16_f32 v29, v46, v47
    v_cvt_pk_bf16_f32 v30, v48, v49
    v_cvt_pk_bf16_f32 v31, v50, v51
    v_sub_f32 v44, v36, v96
    v_sub_f32 v45, v37, v96
    v_sub_f32 v46, v38, v96
    v_sub_f32 v47, v39, v96
    v_sub_f32 v48, v40, v96
    v_sub_f32 v49, v41, v96
    v_sub_f32 v50, v42, v96
    v_sub_f32 v51, v43, v96
    v_cvt_pk_bf16_f32 v16, v44, v45
    v_lshlrev_b32 v44, 16, v16
    v_and_b32 v45, 0xffff0000, v16
    v_cvt_pk_bf16_f32 v16, v46, v47
    v_lshlrev_b32 v46, 16, v16
    v_and_b32 v47, 0xffff0000, v16
    v_cvt_pk_bf16_f32 v16, v48, v49
    v_lshlrev_b32 v48, 16, v16
    v_and_b32 v49, 0xffff0000, v16
    v_cvt_pk_bf16_f32 v16, v50, v51
    v_lshlrev_b32 v50, 16, v16
    v_and_b32 v51, 0xffff0000, v16
    v_mul_f32 v52, v44, v99
    v_mul_f32 v53, v45, v99
    v_mul_f32 v54, v46, v99
    v_mul_f32 v55, v47, v99
    v_mul_f32 v56, v48, v99
    v_mul_f32 v57, v49, v99
    v_mul_f32 v58, v50, v99
    v_mul_f32 v59, v51, v99
    v_fma_f32 v44, -v52, v98, v44
    v_fma_f32 v45, -v53, v98, v45
    v_fma_f32 v46, -v54, v98, v46
    v_fma_f32 v47, -v55, v98, v47
    v_fma_f32 v48, -v56, v98, v48
    v_fma_f32 v49, -v57, v98, v49
    v_fma_f32 v50, -v58, v98, v50
    v_fma_f32 v51, -v59, v98, v51
    v_fma_f32 v44, v44, v99, v52
    v_fma_f32 v45, v45, v99, v53
    v_fma_f32 v46, v46, v99, v54
    v_fma_f32 v47, v47, v99, v55
    v_fma_f32 v48, v48, v99, v56
    v_fma_f32 v49, v49, v99, v57
    v_fma_f32 v50, v50, v99, v58
    v_fma_f32 v51, v51, v99, v59
    v_cvt_pk_bf16_f32 v16, v44, v45
    v_lshlrev_b32 v44, 16, v16
    v_and_b32 v45, 0xffff0000, v16
    v_cvt_pk_bf16_f32 v16, v46, v47
    v_lshlrev_b32 v46, 16, v16
    v_and_b32 v47, 0xffff0000, v16
    v_cvt_pk_bf16_f32 v16, v48, v49
    v_lshlrev_b32 v48, 16, v16
    v_and_b32 v49, 0xffff0000, v16
    v_cvt_pk_bf16_f32 v16, v50, v51
    v_lshlrev_b32 v50, 16, v16
    v_and_b32 v51, 0xffff0000, v16
    v_lshlrev_b32 v52, 16, v196
    v_and_b32 v53, 0xffff0000, v196
    v_lshlrev_b32 v54, 16, v197
    v_and_b32 v55, 0xffff0000, v197
    v_lshlrev_b32 v56, 16, v198
    v_and_b32 v57, 0xffff0000, v198
    v_lshlrev_b32 v58, 16, v199
    v_and_b32 v59, 0xffff0000, v199
    v_pk_mul_f32 v[44:45], v[44:45], v[52:53]
    v_pk_mul_f32 v[46:47], v[46:47], v[54:55]
    v_pk_mul_f32 v[48:49], v[48:49], v[56:57]
    v_pk_mul_f32 v[50:51], v[50:51], v[58:59]
    v_cvt_pk_bf16_f32 v16, v44, v45
    v_lshlrev_b32 v44, 16, v16
    v_and_b32 v45, 0xffff0000, v16
    v_cvt_pk_bf16_f32 v16, v46, v47
    v_lshlrev_b32 v46, 16, v16
    v_and_b32 v47, 0xffff0000, v16
    v_cvt_pk_bf16_f32 v16, v48, v49
    v_lshlrev_b32 v48, 16, v16
    v_and_b32 v49, 0xffff0000, v16
    v_cvt_pk_bf16_f32 v16, v50, v51
    v_lshlrev_b32 v50, 16, v16
    v_and_b32 v51, 0xffff0000, v16
    v_lshlrev_b32 v52, 16, v188
    v_and_b32 v53, 0xffff0000, v188
    v_lshlrev_b32 v54, 16, v189
    v_and_b32 v55, 0xffff0000, v189
    v_lshlrev_b32 v56, 16, v190
    v_and_b32 v57, 0xffff0000, v190
    v_lshlrev_b32 v58, 16, v191
    v_and_b32 v59, 0xffff0000, v191
    v_pk_add_f32 v[44:45], v[44:45], v[52:53]
    v_pk_add_f32 v[46:47], v[46:47], v[54:55]
    v_pk_add_f32 v[48:49], v[48:49], v[56:57]
    v_pk_add_f32 v[50:51], v[50:51], v[58:59]
    v_cvt_pk_bf16_f32 v16, v44, v45
    v_lshlrev_b32 v44, 16, v16
    v_and_b32 v45, 0xffff0000, v16
    v_cvt_pk_bf16_f32 v16, v46, v47
    v_lshlrev_b32 v46, 16, v16
    v_and_b32 v47, 0xffff0000, v16
    v_cvt_pk_bf16_f32 v16, v48, v49
    v_lshlrev_b32 v48, 16, v16
    v_and_b32 v49, 0xffff0000, v16
    v_cvt_pk_bf16_f32 v16, v50, v51
    v_lshlrev_b32 v50, 16, v16
    v_and_b32 v51, 0xffff0000, v16
    v_lshlrev_b32 v52, 16, v204
    v_and_b32 v53, 0xffff0000, v204
    v_lshlrev_b32 v54, 16, v205
    v_and_b32 v55, 0xffff0000, v205
    v_lshlrev_b32 v56, 16, v206
    v_and_b32 v57, 0xffff0000, v206
    v_lshlrev_b32 v58, 16, v207
    v_and_b32 v59, 0xffff0000, v207
    v_pk_mul_f32 v[44:45], v[44:45], v[52:53]
    v_pk_mul_f32 v[46:47], v[46:47], v[54:55]
    v_pk_mul_f32 v[48:49], v[48:49], v[56:57]
    v_pk_mul_f32 v[50:51], v[50:51], v[58:59]
    v_cvt_pk_bf16_f32 v16, v44, v45
    v_lshlrev_b32 v44, 16, v16
    v_and_b32 v45, 0xffff0000, v16
    v_cvt_pk_bf16_f32 v16, v46, v47
    v_lshlrev_b32 v46, 16, v16
    v_and_b32 v47, 0xffff0000, v16
    v_cvt_pk_bf16_f32 v16, v48, v49
    v_lshlrev_b32 v48, 16, v16
    v_and_b32 v49, 0xffff0000, v16
    v_cvt_pk_bf16_f32 v16, v50, v51
    v_lshlrev_b32 v50, 16, v16
    v_and_b32 v51, 0xffff0000, v16
    v_pk_add_f32 v[44:45], v[44:45], v[36:37]
    v_pk_add_f32 v[46:47], v[46:47], v[38:39]
    v_pk_add_f32 v[48:49], v[48:49], v[40:41]
    v_pk_add_f32 v[50:51], v[50:51], v[42:43]
    v_cvt_pk_bf16_f32 v36, v44, v45
    v_cvt_pk_bf16_f32 v37, v46, v47
    v_cvt_pk_bf16_f32 v38, v48, v49
    v_cvt_pk_bf16_f32 v39, v50, v51
    v_lshlrev_b32 v18, 4, v0
    s_mov_b32 s16, 0x6e0000
    s_mov_b32 s27, 0
adaLN_cond__sliding_block_cached__moe_arch_mod__prompt_kernel_w12p:
    buffer_load_dwordx4 v[24:27], v18, s[8:11], s16 offen sc1
    s_waitcnt vmcnt(0)
    v_cmp_eq_u32 vcc, 0, v24
    s_add_u32 s27, s27, 1
    s_cmp_ge_u32 s27, 262144
    s_cbranch_scc1 adaLN_cond__sliding_block_cached__moe_arch_mod__prompt_kernel_w12g
    s_cbranch_vccnz adaLN_cond__sliding_block_cached__moe_arch_mod__prompt_kernel_w12p
adaLN_cond__sliding_block_cached__moe_arch_mod__prompt_kernel_w12g:
    v_mov_b32 v76, v24
    s_nop 1
    v_max_u32_dpp v76, v76, v76 row_ror:1 row_mask:0xf bank_mask:0xf
    s_nop 1
    v_max_u32_dpp v76, v76, v76 row_ror:2 row_mask:0xf bank_mask:0xf
    s_nop 1
    v_max_u32_dpp v76, v76, v76 row_ror:4 row_mask:0xf bank_mask:0xf
    s_nop 1
    v_max_u32_dpp v76, v76, v76 row_ror:8 row_mask:0xf bank_mask:0xf
    v_mov_b32 v77, v76
    s_nop 1
    v_permlane16_swap_b32 v76, v77
    v_max_u32 v76, v76, v77
    v_mov_b32 v77, v76
    s_nop 1
    v_permlane32_swap_b32 v76, v77
    v_max_u32 v76, v76, v77
    v_cmp_eq_u32 vcc, v76, v24
    s_lshl_b32 s16, s3, 4
    s_add_u32 s16, s16, 65792
    v_mov_b32 v16, s16
    s_and_saveexec_b64 s[62:63], vcc
    ds_write_b128 v16, v[24:27]
    s_mov_b64 exec, s[62:63]
    s_waitcnt lgkmcnt(0)
    s_barrier
    v_and_b32 v16, 3, v1
    v_lshlrev_b32 v16, 4, v16
    v_add_u32 v16, 65792, v16
    ds_read_b32 v76, v16
    s_waitcnt lgkmcnt(0)
    v_mov_b32 v77, v76
    s_nop 1
    v_max_u32_dpp v77, v77, v77 row_ror:1 row_mask:0xf bank_mask:0xf
    s_nop 1
    v_max_u32_dpp v77, v77, v77 row_ror:2 row_mask:0xf bank_mask:0xf
    v_cmp_eq_u32 vcc, v76, v77
    s_ff1_i32_b64 s16, vcc
    s_lshl_b32 s16, s16, 4
    s_add_u32 s16, s16, 65792
    v_mov_b32 v16, s16
    ds_read_b128 v[24:27], v16
    s_waitcnt lgkmcnt(0)
    v_and_b32 v76, 0x7ff, v24
    v_sub_u32 v76, 2047, v76
    s_nop 0
    v_readfirstlane_b32 s12, v76
    v_rcp_f32 v103, v26
    s_lshr_b32 s18, s12, 4
    s_lshl_b32 s18, s18, 15
    s_and_b32 s19, s12, 15
    s_lshl_b32 s19, s19, 6
    s_add_u32 s18, s18, s19
    s_add_u32 s18, s18, 0x2c00000
    s_add_u32 s19, s18, 0x400000
    v_lshrrev_b32 v18, 4, v0
    v_lshlrev_b32 v18, 10, v18
    v_and_b32 v19, 15, v0
    v_lshl_add_u32 v18, v19, 2, v18
    s_lshl_b32 s13, s12, 11
    buffer_load_dword v100, v18, s[8:11], s18 offen sc1
    buffer_load_dword v101, v18, s[8:11], s19 offen sc1
    buffer_load_dword v102, v21, s[76:79], s13 offen
    s_lshl_b32 s16, s14, 11
    s_cmp_lg_u32 s12, s14
    s_cselect_b32 s16, s16, 0x7ffffff0
    buffer_store_dwordx4 v[28:31], v2, s[68:71], s16 offen offset:0 sc1
    buffer_store_dwordx4 v[36:39], v2, s[68:71], s16 offen offset:1024 sc1
    s_lshl_b32 s16, s3, 13
    v_add_u32 v20, s16, v2
    s_waitcnt vmcnt(4)
    v_lshlrev_b32 v76, 16, v100
    v_and_b32 v77, 0xffff0000, v100
    s_waitcnt vmcnt(3)
    v_lshlrev_b32 v78, 16, v101
    v_and_b32 v79, 0xffff0000, v101
    v_pk_add_f32 v[76:77], v[76:77], v[78:79]
    s_waitcnt vmcnt(2)
    v_lshlrev_b32 v78, 16, v102
    v_and_b32 v79, 0xffff0000, v102
    v_pk_add_f32 v[92:93], v[78:79], v[76:77]
    v_cvt_pk_bf16_f32 v76, v92, v93
    v_lshlrev_b32 v92, 16, v76
    v_and_b32 v93, 0xffff0000, v76
    v_cvt_pk_bf16_f32 v100, v92, v93
    v_and_b32 v105, 0xffff0000, v104
    v_lshlrev_b32 v104, 16, v104
    v_and_b32 v107, 0xffff0000, v106
    v_lshlrev_b32 v106, 16, v106
    v_sub_f32 v92, v92, v25
    v_sub_f32 v93, v93, v25
    v_cvt_pk_bf16_f32 v76, v92, v93
    v_lshlrev_b32 v92, 16, v76
    v_and_b32 v93, 0xffff0000, v76
    v_mul_f32 v77, v92, v103
    v_fma_f32 v92, -v77, v26, v92
    v_fma_f32 v92, v92, v103, v77
    v_mul_f32 v77, v93, v103
    v_fma_f32 v93, -v77, v26, v93
    v_fma_f32 v93, v93, v103, v77
    v_cvt_pk_bf16_f32 v76, v92, v93
    v_lshlrev_b32 v92, 16, v76
    v_and_b32 v93, 0xffff0000, v76
    v_mul_f32 v92, v92, v104
    v_mul_f32 v93, v93, v105
    v_cvt_pk_bf16_f32 v76, v92, v93
    v_lshlrev_b32 v92, 16, v76
    v_and_b32 v93, 0xffff0000, v76
    v_add_f32 v92, v92, v106
    v_add_f32 v93, v93, v107
    v_cvt_pk_bf16_f32 v101, v92, v93
    v_add_u32 v16, 66560, v21
    ds_write_b32 v16, v101
    ds_write_b32 v16, v100 offset:2048
    s_waitcnt lgkmcnt(0)
    s_barrier
    ds_read_b128 v[60:63], v20 offset:0
    ds_read_b128 v[64:67], v20 offset:1024
    ds_read_b128 v[68:71], v20 offset:2048
    ds_read_b128 v[72:75], v20 offset:3072
    ds_read_b128 v[108:111], v20 offset:4096
    ds_read_b128 v[112:115], v20 offset:5120
    ds_read_b128 v[116:119], v20 offset:6144
    ds_read_b128 v[120:123], v20 offset:7168
    s_and_b32 s16, s3, 3
    s_lshl_b32 s16, s16, 7
    s_and_b32 s17, s29, 3
    s_lshl_b32 s17, s17, 9
    s_add_u32 s16, s16, s17
    s_add_u32 s16, s16, 66560
    v_lshrrev_b32 v16, 3, v1
    v_lshlrev_b32 v16, 4, v16
    v_add_u32 v16, s16, v16
    ds_read_b128 v[104:107], v16
    s_waitcnt lgkmcnt(0)
    v_lshlrev_b32 v76, 16, v104
    v_and_b32 v77, 0xffff, v104
    v_dot2_f32_bf16 v85, v60, v76, 0
    v_dot2_f32_bf16 v84, v60, v77, 0
    v_dot2_f32_bf16 v87, v61, v76, 0
    v_dot2_f32_bf16 v86, v61, v77, 0
    v_dot2_f32_bf16 v89, v62, v76, 0
    v_dot2_f32_bf16 v88, v62, v77, 0
    v_dot2_f32_bf16 v91, v63, v76, 0
    v_dot2_f32_bf16 v90, v63, v77, 0
    v_and_b32 v78, 0xffff0000, v104
    v_lshrrev_b32 v79, 16, v104
    v_dot2c_f32_bf16 v85, v64, v78
    v_dot2c_f32_bf16 v84, v64, v79
    v_dot2c_f32_bf16 v87, v65, v78
    v_dot2c_f32_bf16 v86, v65, v79
    v_dot2c_f32_bf16 v89, v66, v78
    v_dot2c_f32_bf16 v88, v66, v79
    v_dot2c_f32_bf16 v91, v67, v78
    v_dot2c_f32_bf16 v90, v67, v79
    v_lshlrev_b32 v80, 16, v105
    v_and_b32 v81, 0xffff, v105
    v_dot2c_f32_bf16 v85, v68, v80
    v_dot2c_f32_bf16 v84, v68, v81
    v_dot2c_f32_bf16 v87, v69, v80
    v_dot2c_f32_bf16 v86, v69, v81
    v_dot2c_f32_bf16 v89, v70, v80
    v_dot2c_f32_bf16 v88, v70, v81
    v_dot2c_f32_bf16 v91, v71, v80
    v_dot2c_f32_bf16 v90, v71, v81
    v_and_b32 v82, 0xffff0000, v105
    v_lshrrev_b32 v83, 16, v105
    v_dot2c_f32_bf16 v85, v72, v82
    v_dot2c_f32_bf16 v84, v72, v83
    v_dot2c_f32_bf16 v87, v73, v82
    v_dot2c_f32_bf16 v86, v73, v83
    v_dot2c_f32_bf16 v89, v74, v82
    v_dot2c_f32_bf16 v88, v74, v83
    v_dot2c_f32_bf16 v91, v75, v82
    v_dot2c_f32_bf16 v90, v75, v83
    v_lshlrev_b32 v76, 16, v106
    v_and_b32 v77, 0xffff, v106
    v_dot2c_f32_bf16 v85, v108, v76
    v_dot2c_f32_bf16 v84, v108, v77
    v_dot2c_f32_bf16 v87, v109, v76
    v_dot2c_f32_bf16 v86, v109, v77
    v_dot2c_f32_bf16 v89, v110, v76
    v_dot2c_f32_bf16 v88, v110, v77
    v_dot2c_f32_bf16 v91, v111, v76
    v_dot2c_f32_bf16 v90, v111, v77
    v_and_b32 v78, 0xffff0000, v106
    v_lshrrev_b32 v79, 16, v106
    v_dot2c_f32_bf16 v85, v112, v78
    v_dot2c_f32_bf16 v84, v112, v79
    v_dot2c_f32_bf16 v87, v113, v78
    v_dot2c_f32_bf16 v86, v113, v79
    v_dot2c_f32_bf16 v89, v114, v78
    v_dot2c_f32_bf16 v88, v114, v79
    v_dot2c_f32_bf16 v91, v115, v78
    v_dot2c_f32_bf16 v90, v115, v79
    v_lshlrev_b32 v80, 16, v107
    v_and_b32 v81, 0xffff, v107
    v_dot2c_f32_bf16 v85, v116, v80
    v_dot2c_f32_bf16 v84, v116, v81
    v_dot2c_f32_bf16 v87, v117, v80
    v_dot2c_f32_bf16 v86, v117, v81
    v_dot2c_f32_bf16 v89, v118, v80
    v_dot2c_f32_bf16 v88, v118, v81
    v_dot2c_f32_bf16 v91, v119, v80
    v_dot2c_f32_bf16 v90, v119, v81
    v_and_b32 v82, 0xffff0000, v107
    v_lshrrev_b32 v83, 16, v107
    v_dot2c_f32_bf16 v85, v120, v82
    v_dot2c_f32_bf16 v84, v120, v83
    v_dot2c_f32_bf16 v87, v121, v82
    v_dot2c_f32_bf16 v86, v121, v83
    v_dot2c_f32_bf16 v89, v122, v82
    v_dot2c_f32_bf16 v88, v122, v83
    v_dot2c_f32_bf16 v91, v123, v82
    v_dot2c_f32_bf16 v90, v123, v83
    s_nop 0
    v_permlane32_swap_b32 v84, v88
    v_permlane32_swap_b32 v85, v89
    v_permlane32_swap_b32 v86, v90
    v_permlane32_swap_b32 v87, v91
    v_add_f32 v84, v84, v88
    v_add_f32 v85, v85, v89
    v_add_f32 v86, v86, v90
    v_add_f32 v87, v87, v91
    s_nop 0
    v_permlane16_swap_b32 v84, v86
    v_permlane16_swap_b32 v85, v87
    v_add_f32 v84, v84, v86
    v_add_f32 v85, v85, v87
    s_nop 0
    v_add_f32_dpp v84, v84, v84 row_ror:8 row_mask:0xf bank_mask:0xf
    v_add_f32_dpp v85, v85, v85 row_ror:8 row_mask:0xf bank_mask:0xf
    v_and_b32 v16, 7, v1
    v_lshlrev_b32 v16, 5, v16
    v_lshrrev_b32 v17, 4, v1
    v_lshl_add_u32 v16, v17, 3, v16
    s_lshl_b32 s16, s3, 8
    s_add_u32 s16, s16, 70656
    v_add_u32 v16, s16, v16
    ds_write_b64 v16, v[84:85]
    s_lshr_b32 s16, s3, 2
    s_lshl_b32 s17, s16, 10
    s_add_u32 s17, s17, 70656
    v_lshlrev_b32 v17, 2, v1
    v_add_u32 v16, s17, v17
    s_and_b32 s17, s29, 3
    s_lshl_b32 s17, s17, 1
    s_add_u32 s17, s17, s16
    s_mul_i32 s17, s17, 14336
    s_lshr_b32 s16, s29, 2
    s_lshl_b32 s16, s16, 8
    s_add_u32 s17, s17, s16
    s_add_u32 s17, s17, 0x6e1000
    s_and_b32 s16, s3, 3
    s_cmp_eq_u32 s16, 0
    s_cselect_b32 s17, s17, 0x7ffffff0
    s_cmp_lt_u32 s2, 224
    s_cselect_b32 s17, s17, 0x7ffffff0
    s_waitcnt lgkmcnt(0)
    s_barrier
    ds_read_b32 v84, v16 offset:0
    ds_read_b32 v85, v16 offset:256
    ds_read_b32 v86, v16 offset:512
    ds_read_b32 v87, v16 offset:768
    s_waitcnt lgkmcnt(2)
    v_add_f32 v84, v84, v85
    s_waitcnt lgkmcnt(0)
    v_add_f32 v86, v86, v87
    v_add_f32 v84, v84, v86
    v_or_b32 v84, 1, v84
    buffer_store_dword v84, v17, s[8:11], s17 offen sc1
    s_barrier
    v_lshlrev_b32 v16, 3, v0
    v_add_u32 v17, 73728, v16
    ds_read_b64 v[84:85], v17 offset:0
    ds_read_b64 v[86:87], v17 offset:4096
    ds_read_b64 v[88:89], v17 offset:8192
    ds_read_b64 v[90:91], v17 offset:12288
    s_waitcnt lgkmcnt(2)
    v_pk_add_f32 v[84:85], v[84:85], v[86:87]
    s_waitcnt lgkmcnt(0)
    v_pk_add_f32 v[88:89], v[88:89], v[90:91]
    v_pk_add_f32 v[84:85], v[84:85], v[88:89]
    v_or_b32 v84, 1, v84
    v_or_b32 v85, 1, v85
    s_lshl_b32 s16, s29, 12
    s_add_u32 s16, s16, 0x600000
    s_cmp_lt_u32 s2, 224
    s_cselect_b32 s16, s16, 0x7ffffff0
    buffer_store_dwordx2 v[84:85], v16, s[8:11], s16 offen sc1
    s_cmp_lt_u32 s2, 224
    s_cbranch_scc1 adaLN_cond__sliding_block_cached__moe_arch_mod__prompt_kernel_end
    s_sub_u32 s16, s2, 224
    s_lshl_b32 s17, s16, 7
    s_add_u32 s17, s17, 0x600000
    v_lshrrev_b32 v16, 3, v0
    v_lshlrev_b32 v16, 12, v16
    v_and_b32 v17, 7, v0
    v_lshl_add_u32 v16, v17, 4, v16
    v_cmp_gt_u32 vcc, 256, v0
    v_bfrev_b32 v17, -2
    s_nop 0
    v_cndmask_b32 v17, v17, v16, vcc
    v_mov_b32 v19, 0
    v_cndmask_b32 v18, 1, v19, vcc
    s_lshl_b32 s18, s16, 6
    v_and_b32 v19, 31, v1
    v_lshlrev_b32 v19, 1, v19
    v_add_u32 v19, s18, v19
    s_mov_b32 s19, 0x541800
    buffer_load_ushort v95, v19, s[8:11], s19 offen sc1
    v_add_u32 v20, 66560, v19
    ds_read_u16 v96, v20
    ds_read_u16 v97, v20 offset:2048
    v_mov_b32 v94, v27
    v_cvt_pk_bf16_f32 v94, v94, v94
    v_lshlrev_b32 v94, 16, v94
    v_mul_f32 v94, 0xbfb8aa3b, v94
    v_exp_f32 v94, v94
    s_nop 0
    v_add_f32 v94, 1.0, v94
    v_rcp_f32 v94, v94
    s_nop 0
    v_cvt_pk_bf16_f32 v94, v94, v94
    v_lshlrev_b32 v94, 16, v94
    s_waitcnt vmcnt(0)
    v_lshlrev_b32 v95, 16, v95
    s_waitcnt lgkmcnt(1)
    v_lshlrev_b32 v96, 16, v96
    s_waitcnt lgkmcnt(0)
    v_lshlrev_b32 v97, 16, v97
    s_mov_b32 s27, 0
adaLN_cond__sliding_block_cached__moe_arch_mod__prompt_kernel_y13p:
    s_add_u32 s19, s17, 0x0
    buffer_load_dwordx4 v[44:47], v16, s[8:11], s19 offen sc1
    s_add_u32 s19, s17, 0x40000
    buffer_load_dwordx4 v[48:51], v16, s[8:11], s19 offen sc1
    s_add_u32 s19, s17, 0x80000
    buffer_load_dwordx4 v[52:55], v16, s[8:11], s19 offen sc1
    s_add_u32 s19, s17, 0xc0000
    buffer_load_dwordx4 v[56:59], v17, s[8:11], s19 offen sc1
    s_waitcnt vmcnt(0)
    v_min3_u32 v98, v56, v57, v58
    v_min_u32 v98, v98, v59
    v_or_b32 v98, v98, v18
    v_min3_u32 v98, v98, v44, v45
    v_min3_u32 v98, v98, v46, v47
    v_min3_u32 v98, v98, v48, v49
    v_min3_u32 v98, v98, v50, v51
    v_min3_u32 v98, v98, v52, v53
    v_min3_u32 v98, v98, v54, v55
    v_cmp_eq_u32 vcc, 0, v98
    s_add_u32 s27, s27, 1
    s_cmp_ge_u32 s27, 262144
    s_cbranch_scc1 adaLN_cond__sliding_block_cached__moe_arch_mod__prompt_kernel_y13g
    s_cbranch_vccnz adaLN_cond__sliding_block_cached__moe_arch_mod__prompt_kernel_y13p
adaLN_cond__sliding_block_cached__moe_arch_mod__prompt_kernel_y13g:
    v_pk_add_f32 v[44:45], v[44:45], v[52:53]
    v_pk_add_f32 v[46:47], v[46:47], v[54:55]
    v_pk_add_f32 v[48:49], v[48:49], v[56:57]
    v_pk_add_f32 v[50:51], v[50:51], v[58:59]
    v_pk_add_f32 v[44:45], v[44:45], v[48:49]
    v_pk_add_f32 v[46:47], v[46:47], v[50:51]
    s_nop 0
    v_add_f32_dpp v44, v44, v44 row_ror:8 row_mask:0xf bank_mask:0xf
    v_add_f32_dpp v45, v45, v45 row_ror:8 row_mask:0xf bank_mask:0xf
    v_add_f32_dpp v46, v46, v46 row_ror:8 row_mask:0xf bank_mask:0xf
    v_add_f32_dpp v47, v47, v47 row_ror:8 row_mask:0xf bank_mask:0xf
    s_nop 0
    v_permlane32_swap_b32 v44, v46
    v_permlane32_swap_b32 v45, v47
    v_add_f32 v44, v44, v46
    v_add_f32 v45, v45, v47
    s_nop 1
    v_permlane16_swap_b32 v44, v45
    v_add_f32 v44, v44, v45
    v_and_b32 v16, 7, v1
    v_lshlrev_b32 v16, 4, v16
    v_lshrrev_b32 v17, 4, v1
    v_lshl_add_u32 v16, v17, 2, v16
    s_lshl_b32 s19, s3, 7
    s_add_u32 s19, s19, 91136
    v_add_u32 v16, s19, v16
    ds_write_b32 v16, v44
    v_and_b32 v16, 31, v1
    v_lshlrev_b32 v16, 2, v16
    v_add_u32 v16, 91136, v16
    s_waitcnt lgkmcnt(0)
    s_barrier
    s_cmp_lg_u32 s3, 0
    s_cbranch_scc1 adaLN_cond__sliding_block_cached__moe_arch_mod__prompt_kernel_end
    ds_read_b32 v44, v16 offset:0
    ds_read_b32 v45, v16 offset:128
    ds_read_b32 v46, v16 offset:256
    ds_read_b32 v47, v16 offset:384
    ds_read_b32 v48, v16 offset:512
    ds_read_b32 v49, v16 offset:640
    ds_read_b32 v50, v16 offset:768
    ds_read_b32 v51, v16 offset:896
    s_waitcnt lgkmcnt(3)
    v_add_f32 v44, v44, v48
    s_waitcnt lgkmcnt(2)
    v_add_f32 v45, v45, v49
    s_waitcnt lgkmcnt(1)
    v_add_f32 v46, v46, v50
    s_waitcnt lgkmcnt(0)
    v_add_f32 v47, v47, v51
    v_add_f32 v44, v44, v46
    v_add_f32 v45, v45, v47
    v_add_f32 v44, v44, v45
    v_cvt_pk_bf16_f32 v44, v44, v44
    v_lshlrev_b32 v44, 16, v44
    v_mul_f32 v44, v44, v94
    v_cvt_pk_bf16_f32 v44, v44, v44
    v_lshlrev_b32 v44, 16, v44
    v_add_f32 v44, v44, v96
    v_cvt_pk_bf16_f32 v44, v44, v44
    v_lshlrev_b32 v44, 16, v44
    v_mul_f32 v44, v44, v95
    v_cvt_pk_bf16_f32 v44, v44, v44
    v_lshlrev_b32 v44, 16, v44
    v_add_f32 v44, v44, v97
    v_cvt_pk_bf16_f32 v44, v44, v44
    s_mov_b64 exec, 0xffffffff
    buffer_store_short v44, v19, s[68:71], s13 offen sc1
    s_branch adaLN_cond__sliding_block_cached__moe_arch_mod__prompt_kernel_end
adaLN_cond__sliding_block_cached__moe_arch_mod__prompt_kernel_roleB:
    v_mov_b32 v132, 0
    v_mov_b32 v133, 0
    v_lshrrev_b32 v16, 3, v0
    v_and_b32 v17, 7, v0
    v_mul_u32_u24 v135, 24576, v16
    v_lshl_add_u32 v135, v17, 4, v135
    v_lshlrev_b32 v136, 2, v16
    s_and_b32 s14, s2, 31
    s_lshr_b32 s15, s2, 5
    s_mul_i32 s26, s15, 1572864
    s_lshl_b32 s16, s14, 7
    s_add_u32 s26, s26, s16
    s_lshl_b32 s29, s15, 8
    v_lshlrev_b32 v137, 3, v0
    s_lshl_b32 s18, s2, 3
    s_add_u32 s18, s18, s3
    s_lshl_b32 s18, s18, 11
    v_and_b32 v18, 15, v1
    v_lshrrev_b32 v19, 4, v1
    v_lshlrev_b32 v138, 11, v18
    v_lshl_add_u32 v138, v19, 4, v138
    s_lshr_b32 s30, s2, 4
    s_and_b32 s31, s2, 15
    s_lshl_b32 s19, s30, 3
    s_add_u32 s19, s19, s3
    s_lshl_b32 s22, s19, 15
    s_lshl_b32 s23, s31, 7
    s_add_u32 s22, s22, s23
    s_lshl_b32 s23, s2, 12
    s_add_u32 s23, s23, 0x600000
    s_or_b32 s25, s2, s3
    s_cmp_eq_u32 s25, 0
    s_cselect_b32 s25, 0, 0x7ffffff0
    s_waitcnt lgkmcnt(0)
    s_mov_b64 s[64:65], s[58:59]
    s_mov_b32 s66, 0x100
    s_mov_b32 s67, 0x20000
    s_or_b32 s28, s62, 1
    v_mov_b32 v134, s28
    s_mov_b64 exec, 1
    buffer_store_dword v134, v132, s[64:67], s25 offen sc1
    s_mov_b64 exec, -1
    s_mov_b64 s[68:69], s[52:53]
    s_mov_b32 s70, 0x800
    s_mov_b32 s71, 0x20000
    s_mov_b64 s[72:73], s[54:55]
    s_mov_b32 s74, 0xc00000
    s_mov_b32 s75, 0x20000
    s_mov_b64 s[76:77], s[32:33]
    s_mov_b32 s78, 0x400000
    s_mov_b32 s79, 0x20000
    s_mov_b64 s[8:9], s[60:61]
    s_mov_b32 s10, 0x3400000
    s_mov_b32 s11, 0x20000
    buffer_load_dword v72, v136, s[68:71], s29 offen
    buffer_load_dwordx4 v[24:27], v135, s[72:75], s26 offen
    s_add_u32 s26, s26, 12288
    buffer_load_dwordx4 v[28:31], v135, s[72:75], s26 offen
    buffer_load_dwordx4 v[32:35], v2, s[76:79], s18 offen offset:0
    buffer_load_dwordx4 v[36:39], v2, s[76:79], s18 offen offset:1024
    buffer_store_dwordx2 v[132:133], v137, s[8:11], s23 offen sc1
    s_barrier
    buffer_load_dwordx4 v[40:43], v138, s[76:79], s22 offen offset:0
    buffer_load_dwordx4 v[44:47], v138, s[76:79], s22 offen offset:64
    s_mov_b32 s29, s19
    s_mov_b64 s[64:65], s[34:35]
    s_mov_b32 s66, 0x200000
    s_mov_b32 s67, 0x20000
    s_mov_b64 s[68:69], s[36:37]
    s_mov_b32 s70, 0x200000
    s_mov_b32 s71, 0x20000
    s_lshl_b32 s20, s2, 2
    s_add_u32 s20, s20, s3
    s_sub_u32 s20, s20, 4
    s_lshr_b32 s22, s20, 8
    s_bfe_u32 s23, s20, 0x40004
    s_and_b32 s24, s20, 15
    s_lshl_b32 s25, s22, 19
    s_lshl_b32 s26, s23, 13
    s_add_u32 s25, s25, s26
    s_add_u32 s25, s25, 393216
    v_and_b32 v16, 15, v1
    v_lshrrev_b32 v17, 4, v1
    s_lshl_b32 s21, s22, 17
    s_cmp_ge_u32 s24, 8
    s_cbranch_scc1 adaLN_cond__sliding_block_cached__moe_arch_mod__prompt_kernel_kvV
    v_lshlrev_b32 v18, 8, v16
    v_lshl_add_u32 v18, v17, 3, v18
    s_and_b32 s26, s24, 1
    s_lshl_b32 s26, s26, 12
    s_add_u32 s25, s25, s26
    s_lshr_b32 s26, s24, 1
    s_lshl_b32 s26, s26, 6
    s_add_u32 s25, s25, s26
    buffer_load_dwordx2 v[84:85], v18, s[64:67], s25 offen
    buffer_load_dwordx2 v[86:87], v18, s[64:67], s25 offen offset:32
    s_lshl_b32 s26, s23, 13
    s_add_u32 s21, s21, s26
    s_lshl_b32 s26, s24, 10
    s_add_u32 s21, s21, s26
    s_add_u32 s21, s21, 0x400000
    s_branch adaLN_cond__sliding_block_cached__moe_arch_mod__prompt_kernel_kvJ
adaLN_cond__sliding_block_cached__moe_arch_mod__prompt_kernel_kvV:
    s_bfe_u32 s26, s24, 0x20001
    s_lshl_b32 s26, s26, 6
    s_add_u32 s25, s25, s26
    s_and_b32 s26, s24, 1
    s_lshl_b32 s26, s26, 3
    s_add_u32 s25, s25, s26
    s_add_u32 s26, s25, 4096
    v_lshrrev_b32 v18, 2, v16
    v_lshlrev_b32 v18, 4, v18
    v_and_b32 v19, 3, v16
    v_lshl_add_u32 v18, v19, 1, v18
    v_lshl_add_u32 v18, v17, 10, v18
    buffer_load_ushort v88, v18, s[68:71], s25 offen offset:0
    buffer_load_ushort v89, v18, s[68:71], s25 offen offset:256
    buffer_load_ushort v90, v18, s[68:71], s25 offen offset:512
    buffer_load_ushort v91, v18, s[68:71], s25 offen offset:768
    buffer_load_ushort v92, v18, s[68:71], s26 offen offset:0
    buffer_load_ushort v93, v18, s[68:71], s26 offen offset:256
    buffer_load_ushort v94, v18, s[68:71], s26 offen offset:512
    buffer_load_ushort v95, v18, s[68:71], s26 offen offset:768
    s_bfe_u32 s26, s24, 0x20001
    s_lshl_b32 s26, s26, 15
    s_add_u32 s21, s21, s26
    s_lshl_b32 s26, s23, 11
    s_add_u32 s21, s21, s26
    s_and_b32 s26, s24, 1
    s_lshl_b32 s26, s26, 10
    s_add_u32 s21, s21, s26
    s_add_u32 s21, s21, 0x480000
adaLN_cond__sliding_block_cached__moe_arch_mod__prompt_kernel_kvJ:
    s_waitcnt vmcnt(9)
    v_and_b32 v73, 0xffff0000, v72
    v_lshlrev_b32 v72, 16, v72
    v_mul_f32 v16, 0xbfb8aa3b, v72
    v_exp_f32 v16, v16
    s_nop 0
    v_add_f32 v16, 1.0, v16
    v_rcp_f32 v16, v16
    s_nop 0
    v_mul_f32 v72, v72, v16
    v_mul_f32 v17, 0xbfb8aa3b, v73
    v_exp_f32 v17, v17
    s_nop 0
    v_add_f32 v17, 1.0, v17
    v_rcp_f32 v17, v17
    s_nop 0
    v_mul_f32 v73, v73, v17
    v_cvt_pk_bf16_f32 v16, v72, v73
    v_lshlrev_b32 v72, 16, v16
    v_and_b32 v73, 0xffff0000, v16
    s_lshl_b32 s16, s2, 8
    s_add_u32 s16, s16, 0x550000
    s_mov_b32 exec_lo, 0x01010101
    s_mov_b32 exec_hi, 0x01010101
    buffer_store_dword v16, v136, s[8:11], s16 offen sc1
    s_mov_b64 exec, -1
    v_lshrrev_b32 v74, 16, v72
    v_lshrrev_b32 v75, 16, v73
    s_waitcnt vmcnt(9)
    v_dot2_f32_bf16 v49, v24, v72, 0
    v_dot2_f32_bf16 v48, v24, v74, 0
    v_dot2_f32_bf16 v51, v25, v72, 0
    v_dot2_f32_bf16 v50, v25, v74, 0
    v_dot2_f32_bf16 v53, v26, v72, 0
    v_dot2_f32_bf16 v52, v26, v74, 0
    v_dot2_f32_bf16 v55, v27, v72, 0
    v_dot2_f32_bf16 v54, v27, v74, 0
    s_waitcnt vmcnt(8)
    v_dot2c_f32_bf16 v49, v28, v73
    v_dot2c_f32_bf16 v48, v28, v75
    v_dot2c_f32_bf16 v51, v29, v73
    v_dot2c_f32_bf16 v50, v29, v75
    v_dot2c_f32_bf16 v53, v30, v73
    v_dot2c_f32_bf16 v52, v30, v75
    v_dot2c_f32_bf16 v55, v31, v73
    v_dot2c_f32_bf16 v54, v31, v75
    s_nop 0
    v_permlane32_swap_b32 v48, v52
    v_permlane32_swap_b32 v49, v53
    v_permlane32_swap_b32 v50, v54
    v_permlane32_swap_b32 v51, v55
    v_add_f32 v48, v48, v52
    v_add_f32 v49, v49, v53
    v_add_f32 v50, v50, v54
    v_add_f32 v51, v51, v55
    s_nop 0
    v_permlane16_swap_b32 v48, v50
    v_permlane16_swap_b32 v49, v51
    v_add_f32 v48, v48, v50
    v_add_f32 v49, v49, v51
    s_nop 0
    v_add_f32_dpp v48, v48, v48 row_ror:8 row_mask:0xf bank_mask:0xf
    v_add_f32_dpp v49, v49, v49 row_ror:8 row_mask:0xf bank_mask:0xf
    v_and_b32 v16, 7, v1
    v_lshlrev_b32 v16, 5, v16
    v_lshrrev_b32 v17, 4, v1
    v_lshl_add_u32 v16, v17, 3, v16
    s_lshl_b32 s16, s3, 8
    s_add_u32 s16, s16, 65536
    v_add_u32 v16, s16, v16
    ds_write_b64 v16, v[48:49]
    s_waitcnt vmcnt(7)
    v_lshlrev_b32 v56, 16, v32
    v_and_b32 v57, 0xffff0000, v32
    v_lshlrev_b32 v58, 16, v33
    v_and_b32 v59, 0xffff0000, v33
    v_lshlrev_b32 v60, 16, v34
    v_and_b32 v61, 0xffff0000, v34
    v_lshlrev_b32 v62, 16, v35
    v_and_b32 v63, 0xffff0000, v35
    s_waitcnt vmcnt(6)
    v_lshlrev_b32 v64, 16, v36
    v_and_b32 v65, 0xffff0000, v36
    v_lshlrev_b32 v66, 16, v37
    v_and_b32 v67, 0xffff0000, v37
    v_lshlrev_b32 v68, 16, v38
    v_and_b32 v69, 0xffff0000, v38
    v_lshlrev_b32 v70, 16, v39
    v_and_b32 v71, 0xffff0000, v39
    v_add_f32 v20, v56, v57
    v_add_f32 v21, v58, v59
    v_add_f32 v20, v20, v60
    v_add_f32 v21, v21, v61
    v_add_f32 v20, v20, v62
    v_add_f32 v21, v21, v63
    v_add_f32 v20, v20, v64
    v_add_f32 v21, v21, v65
    v_add_f32 v20, v20, v66
    v_add_f32 v21, v21, v67
    v_add_f32 v20, v20, v68
    v_add_f32 v21, v21, v69
    v_add_f32 v20, v20, v70
    v_add_f32 v21, v21, v71
    v_add_f32 v128, v20, v21
    s_nop 1
    v_add_f32_dpp v128, v128, v128 row_ror:1 row_mask:0xf bank_mask:0xf
    s_nop 1
    v_add_f32_dpp v128, v128, v128 row_ror:2 row_mask:0xf bank_mask:0xf
    s_nop 1
    v_add_f32_dpp v128, v128, v128 row_ror:4 row_mask:0xf bank_mask:0xf
    s_nop 1
    v_add_f32_dpp v128, v128, v128 row_ror:8 row_mask:0xf bank_mask:0xf
    v_mov_b32 v20, v128
    s_nop 1
    v_permlane16_swap_b32 v128, v20
    v_add_f32 v128, v128, v20
    v_mov_b32 v20, v128
    s_nop 1
    v_permlane32_swap_b32 v128, v20
    v_add_f32 v128, v128, v20
    v_mul_f32 v128, 0x3a800000, v128
    v_sub_f32 v18, v56, v128
    v_mul_f32 v20, v18, v18
    v_sub_f32 v19, v57, v128
    v_mul_f32 v21, v19, v19
    v_sub_f32 v18, v58, v128
    v_sub_f32 v19, v59, v128
    v_fmac_f32 v20, v18, v18
    v_fmac_f32 v21, v19, v19
    v_sub_f32 v18, v60, v128
    v_sub_f32 v19, v61, v128
    v_fmac_f32 v20, v18, v18
    v_fmac_f32 v21, v19, v19
    v_sub_f32 v18, v62, v128
    v_sub_f32 v19, v63, v128
    v_fmac_f32 v20, v18, v18
    v_fmac_f32 v21, v19, v19
    v_sub_f32 v18, v64, v128
    v_sub_f32 v19, v65, v128
    v_fmac_f32 v20, v18, v18
    v_fmac_f32 v21, v19, v19
    v_sub_f32 v18, v66, v128
    v_sub_f32 v19, v67, v128
    v_fmac_f32 v20, v18, v18
    v_fmac_f32 v21, v19, v19
    v_sub_f32 v18, v68, v128
    v_sub_f32 v19, v69, v128
    v_fmac_f32 v20, v18, v18
    v_fmac_f32 v21, v19, v19
    v_sub_f32 v18, v70, v128
    v_sub_f32 v19, v71, v128
    v_fmac_f32 v20, v18, v18
    v_fmac_f32 v21, v19, v19
    v_add_f32 v17, v20, v21
    s_nop 1
    v_add_f32_dpp v17, v17, v17 row_ror:1 row_mask:0xf bank_mask:0xf
    s_nop 1
    v_add_f32_dpp v17, v17, v17 row_ror:2 row_mask:0xf bank_mask:0xf
    s_nop 1
    v_add_f32_dpp v17, v17, v17 row_ror:4 row_mask:0xf bank_mask:0xf
    s_nop 1
    v_add_f32_dpp v17, v17, v17 row_ror:8 row_mask:0xf bank_mask:0xf
    v_mov_b32 v20, v17
    s_nop 1
    v_permlane16_swap_b32 v17, v20
    v_add_f32 v17, v17, v20
    v_mov_b32 v20, v17
    s_nop 1
    v_permlane32_swap_b32 v17, v20
    v_add_f32 v17, v17, v20
    v_mul_f32 v17, 0x3a800000, v17
    v_cvt_pk_bf16_f32 v128, v128, v128
    v_lshlrev_b32 v128, 16, v128
    v_cvt_pk_bf16_f32 v17, v17, v17
    v_lshlrev_b32 v17, 16, v17
    v_add_f32 v17, 0x3727c5ac, v17
    v_cvt_pk_bf16_f32 v17, v17, v17
    v_lshlrev_b32 v17, 16, v17
    v_sqrt_f32 v129, v17
    s_nop 0
    v_cvt_pk_bf16_f32 v129, v129, v129
    v_lshlrev_b32 v129, 16, v129
    v_rcp_f32 v130, v129
    s_lshl_b32 s16, s3, 4
    s_add_u32 s16, s16, 67600
    v_mov_b32 v19, s16
    ds_write_b128 v19, v[128:131]
    v_mov_b32 v19, 67584
    v_and_b32 v17, 31, v1
    v_lshlrev_b32 v18, 3, v17
    v_add_u32 v18, 65536, v18
    v_lshlrev_b32 v17, 4, v17
    s_waitcnt lgkmcnt(0)
    s_barrier
    ds_read_b32 v134, v19
    ds_read_b64 v[96:97], v18 offset:0
    ds_read_b64 v[100:101], v18 offset:256
    ds_read_b64 v[104:105], v18 offset:512
    ds_read_b64 v[108:109], v18 offset:768
    ds_read_b64 v[112:113], v18 offset:1024
    ds_read_b64 v[116:117], v18 offset:1280
    ds_read_b64 v[120:121], v18 offset:1536
    ds_read_b64 v[124:125], v18 offset:1792
    s_waitcnt lgkmcnt(8)
    v_readfirstlane_b32 s28, v134
    v_and_b32 v20, 7, v1
    v_lshlrev_b32 v20, 4, v20
    v_add_u32 v21, 67600, v20
    ds_read_b128 v[128:131], v21
    s_waitcnt lgkmcnt(0)
    v_mov_b32 v131, s28
    s_lshl_b32 s16, s2, 7
    s_add_u32 s16, s16, 0x520000
    s_cmp_eq_u32 s3, 0
    s_cselect_b32 s16, s16, 0x7ffffff0
    s_mov_b64 exec, 0xff
    buffer_store_dwordx4 v[128:131], v20, s[8:11], s16 offen sc1
    s_mov_b64 exec, -1
    v_pk_add_f32 v[96:97], v[96:97], v[112:113]
    v_pk_add_f32 v[100:101], v[100:101], v[116:117]
    v_pk_add_f32 v[104:105], v[104:105], v[120:121]
    v_pk_add_f32 v[108:109], v[108:109], v[124:125]
    v_pk_add_f32 v[96:97], v[96:97], v[104:105]
    v_pk_add_f32 v[100:101], v[100:101], v[108:109]
    v_pk_add_f32 v[96:97], v[96:97], v[100:101]
    v_mov_b32 v98, s28
    v_mov_b32 v99, s28
    s_lshl_b32 s16, s14, 3
    s_add_u32 s16, s16, s15
    s_lshl_b32 s16, s16, 9
    s_add_u32 s16, s16, 0x500000
    s_cmp_eq_u32 s3, 0
    s_cselect_b32 s16, s16, 0x7ffffff0
    s_mov_b64 exec, 0xffffffff
    buffer_store_dwordx4 v[96:99], v17, s[8:11], s16 offen sc1
    s_mov_b64 exec, -1
    s_cmp_lt_u32 s24, 8
    s_cbranch_scc1 adaLN_cond__sliding_block_cached__moe_arch_mod__prompt_kernel_kvS
    s_waitcnt vmcnt(4)
    v_lshl_or_b32 v84, v89, 16, v88
    v_lshl_or_b32 v85, v91, 16, v90
    s_waitcnt vmcnt(3)
    v_lshl_or_b32 v86, v93, 16, v92
    v_lshl_or_b32 v87, v95, 16, v94
    v_and_b32 v88, 0x7fff, v88
    v_and_b32 v89, 0x7fff, v89
    v_and_b32 v90, 0x7fff, v90
    v_and_b32 v91, 0x7fff, v91
    v_and_b32 v92, 0x7fff, v92
    v_and_b32 v93, 0x7fff, v93
    v_and_b32 v94, 0x7fff, v94
    v_and_b32 v95, 0x7fff, v95
    v_max3_u32 v88, v88, v89, v90
    v_max3_u32 v91, v91, v92, v93
    v_max3_u32 v88, v88, v94, v95
    v_max_u32 v88, v88, v91
    v_cmp_le_u32 vcc, 0x4980, v88
    v_mov_b32 v89, s28
    s_mov_b32 s16, 0x564000
    s_and_saveexec_b64 s[62:63], vcc
    buffer_store_dword v89, v132, s[8:11], s16 offen sc1
    s_mov_b64 exec, s[62:63]
adaLN_cond__sliding_block_cached__moe_arch_mod__prompt_kernel_kvS:
    s_waitcnt vmcnt(3)
    buffer_store_dwordx4 v[84:87], v2, s[8:11], s21 offen sc1
    s_lshr_b32 s16, s3, 2
    s_lshl_b32 s16, s16, 4
    s_add_u32 s16, s16, s31
    s_lshl_b32 s16, s16, 12
    s_and_b32 s17, s3, 3
    s_lshl_b32 s17, s17, 7
    s_add_u32 s16, s16, s17
    s_add_u32 s16, s16, 0x500000
    v_lshrrev_b32 v139, 3, v1
    v_lshlrev_b32 v139, 9, v139
    v_and_b32 v16, 7, v1
    v_lshl_add_u32 v139, v16, 4, v139
    v_and_b32 v140, 15, v1
    v_lshlrev_b32 v140, 4, v140
    s_lshl_b32 s17, s29, 8
    s_add_u32 s17, s17, 0x520000
    v_lshlrev_b32 v56, 16, v40
    v_and_b32 v57, 0xffff0000, v40
    v_lshlrev_b32 v58, 16, v41
    v_and_b32 v59, 0xffff0000, v41
    v_lshlrev_b32 v60, 16, v42
    v_and_b32 v61, 0xffff0000, v42
    v_lshlrev_b32 v62, 16, v43
    v_and_b32 v63, 0xffff0000, v43
    v_lshlrev_b32 v64, 16, v44
    v_and_b32 v65, 0xffff0000, v44
    v_lshlrev_b32 v66, 16, v45
    v_and_b32 v67, 0xffff0000, v45
    v_lshlrev_b32 v68, 16, v46
    v_and_b32 v69, 0xffff0000, v46
    v_lshlrev_b32 v70, 16, v47
    v_and_b32 v71, 0xffff0000, v47
    s_mov_b32 s27, 0
adaLN_cond__sliding_block_cached__moe_arch_mod__prompt_kernel_g14p:
    buffer_load_dwordx4 v[76:79], v139, s[8:11], s16 offen sc1
    buffer_load_dwordx4 v[80:83], v140, s[8:11], s17 offen sc1
    s_waitcnt vmcnt(1)
    v_cmp_ne_u32 vcc, s28, v78
    v_cmp_ne_u32 s[62:63], s28, v79
    s_or_b64 vcc, vcc, s[62:63]
    s_waitcnt vmcnt(0)
    v_cmp_ne_u32 s[62:63], s28, v83
    s_or_b64 vcc, vcc, s[62:63]
    s_add_u32 s27, s27, 1
    s_cmp_ge_u32 s27, 262144
    s_cbranch_scc1 adaLN_cond__sliding_block_cached__moe_arch_mod__prompt_kernel_g14g
    s_cbranch_vccnz adaLN_cond__sliding_block_cached__moe_arch_mod__prompt_kernel_g14p
adaLN_cond__sliding_block_cached__moe_arch_mod__prompt_kernel_g14g:
    v_add_f32_dpp v76, v76, v76 row_ror:8 row_mask:0xf bank_mask:0xf
    v_add_f32_dpp v77, v77, v77 row_ror:8 row_mask:0xf bank_mask:0xf
    v_mov_b32 v17, v76
    s_nop 1
    v_permlane16_swap_b32 v76, v17
    v_add_f32 v76, v76, v17
    v_mov_b32 v18, v77
    s_nop 1
    v_permlane16_swap_b32 v77, v18
    v_add_f32 v77, v77, v18
    v_mov_b32 v17, v76
    s_nop 1
    v_permlane32_swap_b32 v76, v17
    v_add_f32 v76, v76, v17
    v_mov_b32 v18, v77
    s_nop 1
    v_permlane32_swap_b32 v77, v18
    v_add_f32 v77, v77, v18
    v_cvt_pk_bf16_f32 v17, v76, v77
    v_lshlrev_b32 v76, 16, v17
    v_and_b32 v77, 0xffff0000, v17
    v_add_f32 v76, 1.0, v76
    v_add_f32 v77, 1.0, v77
    v_cvt_pk_bf16_f32 v17, v76, v77
    v_lshlrev_b32 v76, 16, v17
    v_and_b32 v77, 0xffff0000, v17
    s_lshl_b32 s16, s3, 6
    s_add_u32 s16, s16, 69632
    v_lshl_add_u32 v16, v16, 3, s16
    ds_write_b64 v16, v[76:77]
    v_lshrrev_b32 v17, 4, v1
    v_lshlrev_b32 v17, 5, v17
    v_add_u32 v17, 69632, v17
    v_sub_f32 v56, v56, v80
    v_sub_f32 v57, v57, v80
    v_sub_f32 v58, v58, v80
    v_sub_f32 v59, v59, v80
    v_sub_f32 v60, v60, v80
    v_sub_f32 v61, v61, v80
    v_sub_f32 v62, v62, v80
    v_sub_f32 v63, v63, v80
    v_sub_f32 v64, v64, v80
    v_sub_f32 v65, v65, v80
    v_sub_f32 v66, v66, v80
    v_sub_f32 v67, v67, v80
    v_sub_f32 v68, v68, v80
    v_sub_f32 v69, v69, v80
    v_sub_f32 v70, v70, v80
    v_sub_f32 v71, v71, v80
    v_cvt_pk_bf16_f32 v18, v56, v57
    v_lshlrev_b32 v56, 16, v18
    v_and_b32 v57, 0xffff0000, v18
    v_cvt_pk_bf16_f32 v19, v58, v59
    v_lshlrev_b32 v58, 16, v19
    v_and_b32 v59, 0xffff0000, v19
    v_cvt_pk_bf16_f32 v18, v60, v61
    v_lshlrev_b32 v60, 16, v18
    v_and_b32 v61, 0xffff0000, v18
    v_cvt_pk_bf16_f32 v19, v62, v63
    v_lshlrev_b32 v62, 16, v19
    v_and_b32 v63, 0xffff0000, v19
    v_cvt_pk_bf16_f32 v18, v64, v65
    v_lshlrev_b32 v64, 16, v18
    v_and_b32 v65, 0xffff0000, v18
    v_cvt_pk_bf16_f32 v19, v66, v67
    v_lshlrev_b32 v66, 16, v19
    v_and_b32 v67, 0xffff0000, v19
    v_cvt_pk_bf16_f32 v18, v68, v69
    v_lshlrev_b32 v68, 16, v18
    v_and_b32 v69, 0xffff0000, v18
    v_cvt_pk_bf16_f32 v19, v70, v71
    v_lshlrev_b32 v70, 16, v19
    v_and_b32 v71, 0xffff0000, v19
    v_mul_f32 v56, v56, v82
    v_mul_f32 v57, v57, v82
    v_mul_f32 v58, v58, v82
    v_mul_f32 v59, v59, v82
    v_mul_f32 v60, v60, v82
    v_mul_f32 v61, v61, v82
    v_mul_f32 v62, v62, v82
    v_mul_f32 v63, v63, v82
    v_mul_f32 v64, v64, v82
    v_mul_f32 v65, v65, v82
    v_mul_f32 v66, v66, v82
    v_mul_f32 v67, v67, v82
    v_mul_f32 v68, v68, v82
    v_mul_f32 v69, v69, v82
    v_mul_f32 v70, v70, v82
    v_mul_f32 v71, v71, v82
    v_cvt_pk_bf16_f32 v18, v56, v57
    v_lshlrev_b32 v56, 16, v18
    v_and_b32 v57, 0xffff0000, v18
    v_cvt_pk_bf16_f32 v19, v58, v59
    v_lshlrev_b32 v58, 16, v19
    v_and_b32 v59, 0xffff0000, v19
    v_cvt_pk_bf16_f32 v18, v60, v61
    v_lshlrev_b32 v60, 16, v18
    v_and_b32 v61, 0xffff0000, v18
    v_cvt_pk_bf16_f32 v19, v62, v63
    v_lshlrev_b32 v62, 16, v19
    v_and_b32 v63, 0xffff0000, v19
    v_cvt_pk_bf16_f32 v18, v64, v65
    v_lshlrev_b32 v64, 16, v18
    v_and_b32 v65, 0xffff0000, v18
    v_cvt_pk_bf16_f32 v19, v66, v67
    v_lshlrev_b32 v66, 16, v19
    v_and_b32 v67, 0xffff0000, v19
    v_cvt_pk_bf16_f32 v18, v68, v69
    v_lshlrev_b32 v68, 16, v18
    v_and_b32 v69, 0xffff0000, v18
    v_cvt_pk_bf16_f32 v19, v70, v71
    v_lshlrev_b32 v70, 16, v19
    v_and_b32 v71, 0xffff0000, v19
    s_lshl_b32 s16, s29, 15
    s_lshl_b32 s17, s31, 11
    s_add_u32 s16, s16, s17
    s_waitcnt lgkmcnt(0)
    s_barrier
    ds_read_b128 v[96:99], v17 offset:256
    ds_read_b128 v[104:107], v17 offset:0
    ds_read_b128 v[100:103], v17 offset:272
    ds_read_b128 v[108:111], v17 offset:16
    ds_read_b128 v[112:115], v17 offset:384
    ds_read_b128 v[120:123], v17 offset:128
    ds_read_b128 v[116:119], v17 offset:400
    ds_read_b128 v[124:127], v17 offset:144
    s_waitcnt lgkmcnt(7)
    v_pk_mul_f32 v[56:57], v[56:57], v[96:97]
    v_pk_mul_f32 v[58:59], v[58:59], v[98:99]
    s_waitcnt lgkmcnt(5)
    v_pk_mul_f32 v[60:61], v[60:61], v[100:101]
    v_pk_mul_f32 v[62:63], v[62:63], v[102:103]
    v_cvt_pk_bf16_f32 v18, v56, v57
    v_lshlrev_b32 v56, 16, v18
    v_and_b32 v57, 0xffff0000, v18
    v_cvt_pk_bf16_f32 v19, v58, v59
    v_lshlrev_b32 v58, 16, v19
    v_and_b32 v59, 0xffff0000, v19
    v_cvt_pk_bf16_f32 v18, v60, v61
    v_lshlrev_b32 v60, 16, v18
    v_and_b32 v61, 0xffff0000, v18
    v_cvt_pk_bf16_f32 v19, v62, v63
    v_lshlrev_b32 v62, 16, v19
    v_and_b32 v63, 0xffff0000, v19
    v_pk_add_f32 v[56:57], v[56:57], v[104:105]
    v_pk_add_f32 v[58:59], v[58:59], v[106:107]
    s_waitcnt lgkmcnt(4)
    v_pk_add_f32 v[60:61], v[60:61], v[108:109]
    v_pk_add_f32 v[62:63], v[62:63], v[110:111]
    v_cvt_pk_bf16_f32 v32, v56, v57
    v_cvt_pk_bf16_f32 v33, v58, v59
    v_cvt_pk_bf16_f32 v34, v60, v61
    v_cvt_pk_bf16_f32 v35, v62, v63
    buffer_store_dwordx4 v[32:35], v2, s[8:11], s16 offen offset:0 sc1
    s_waitcnt lgkmcnt(3)
    v_pk_mul_f32 v[64:65], v[64:65], v[112:113]
    v_pk_mul_f32 v[66:67], v[66:67], v[114:115]
    s_waitcnt lgkmcnt(1)
    v_pk_mul_f32 v[68:69], v[68:69], v[116:117]
    v_pk_mul_f32 v[70:71], v[70:71], v[118:119]
    v_cvt_pk_bf16_f32 v18, v64, v65
    v_lshlrev_b32 v64, 16, v18
    v_and_b32 v65, 0xffff0000, v18
    v_cvt_pk_bf16_f32 v19, v66, v67
    v_lshlrev_b32 v66, 16, v19
    v_and_b32 v67, 0xffff0000, v19
    v_cvt_pk_bf16_f32 v18, v68, v69
    v_lshlrev_b32 v68, 16, v18
    v_and_b32 v69, 0xffff0000, v18
    v_cvt_pk_bf16_f32 v19, v70, v71
    v_lshlrev_b32 v70, 16, v19
    v_and_b32 v71, 0xffff0000, v19
    v_pk_add_f32 v[64:65], v[64:65], v[120:121]
    v_pk_add_f32 v[66:67], v[66:67], v[122:123]
    s_waitcnt lgkmcnt(0)
    v_pk_add_f32 v[68:69], v[68:69], v[124:125]
    v_pk_add_f32 v[70:71], v[70:71], v[126:127]
    v_cvt_pk_bf16_f32 v36, v64, v65
    v_cvt_pk_bf16_f32 v37, v66, v67
    v_cvt_pk_bf16_f32 v38, v68, v69
    v_cvt_pk_bf16_f32 v39, v70, v71
    buffer_store_dwordx4 v[36:39], v2, s[8:11], s16 offen offset:1024 sc1
    s_lshl_b32 s19, s3, 16
    s_lshl_b32 s20, s3, 11
    s_lshl_b32 s16, s12, 8
    s_add_u32 s4, s38, s16
    s_addc_u32 s5, s39, 0
    s_sub_u32 s6, 0x800000, s16
    s_mov_b32 s7, 0x20000
    v_mov_b32 v134, s28
    s_lshl_b32 s16, s29, 4
    s_add_u32 s16, s16, s31
    s_lshl_b32 s16, s16, 2
    s_add_u32 s16, s16, 0x528000
    v_and_b32 v16, 31, v1
    v_lshlrev_b32 v16, 2, v16
    s_lshl_b32 s17, s13, 3
    s_add_u32 s17, s17, s3
    s_lshl_b32 s17, s17, 7
    s_add_u32 s17, s17, 0x528000
    s_waitcnt vmcnt(0)
    s_mov_b64 exec, 1
    buffer_store_dword v134, v132, s[8:11], s16 offen sc1
    s_mov_b64 exec, -1
    s_add_u32 s22, s19, 0x0
    s_add_u32 m0, s20, 0x0
    s_nop 0
    buffer_load_dwordx4 v3, s[4:7], s22 offen lds
    s_add_u32 s22, s19, 0x8000
    s_add_u32 m0, s20, 0x400
    s_nop 0
    buffer_load_dwordx4 v3, s[4:7], s22 offen lds
    s_add_u32 s22, s19, 0x80000
    s_add_u32 m0, s20, 0x4000
    s_nop 0
    buffer_load_dwordx4 v3, s[4:7], s22 offen lds
    s_add_u32 s22, s19, 0x88000
    s_add_u32 m0, s20, 0x4400
    s_nop 0
    buffer_load_dwordx4 v3, s[4:7], s22 offen lds
    s_add_u32 s22, s19, 0x100000
    s_add_u32 m0, s20, 0x8000
    s_nop 0
    buffer_load_dwordx4 v3, s[4:7], s22 offen lds
    s_add_u32 s22, s19, 0x108000
    s_add_u32 m0, s20, 0x8400
    s_nop 0
    buffer_load_dwordx4 v3, s[4:7], s22 offen lds
    s_add_u32 s22, s19, 0x180000
    s_add_u32 m0, s20, 0xc000
    s_nop 0
    buffer_load_dwordx4 v3, s[4:7], s22 offen lds
    s_add_u32 s22, s19, 0x188000
    s_add_u32 m0, s20, 0xc400
    s_nop 0
    buffer_load_dwordx4 v3, s[4:7], s22 offen lds
    s_sleep 40
    s_mov_b32 s27, 0
adaLN_cond__sliding_block_cached__moe_arch_mod__prompt_kernel_h15p:
    buffer_load_dword v17, v16, s[8:11], s17 offen sc1
    s_waitcnt vmcnt(0)
    v_cmp_ne_u32 vcc, s28, v17
    s_add_u32 s27, s27, 1
    s_cmp_ge_u32 s27, 262144
    s_cbranch_scc1 adaLN_cond__sliding_block_cached__moe_arch_mod__prompt_kernel_h15g
    s_cbranch_vccnz adaLN_cond__sliding_block_cached__moe_arch_mod__prompt_kernel_h15p
adaLN_cond__sliding_block_cached__moe_arch_mod__prompt_kernel_h15g:
    v_add_u32 v11, 0x20000, v4
    v_add_u32 v6, 0x20000, v5
    s_mov_b32 s23, 0x0
    buffer_load_dwordx4 v[88:91], v7, s[8:11], s23 offen offset:0 sc1
    s_mov_b32 s23, 0x8000
    buffer_load_dwordx4 v[92:95], v7, s[8:11], s23 offen offset:0 sc1
    s_mov_b32 s23, 0x0
    buffer_load_dwordx4 v[96:99], v7, s[8:11], s23 offen offset:1024 sc1
    s_mov_b32 s23, 0x8000
    buffer_load_dwordx4 v[100:103], v7, s[8:11], s23 offen offset:1024 sc1
    s_mov_b32 s23, 0x800
    buffer_load_dwordx4 v[104:107], v7, s[8:11], s23 offen offset:0 sc1
    s_mov_b32 s23, 0x8800
    buffer_load_dwordx4 v[108:111], v7, s[8:11], s23 offen offset:0 sc1
    s_mov_b32 s23, 0x800
    buffer_load_dwordx4 v[112:115], v7, s[8:11], s23 offen offset:1024 sc1
    s_mov_b32 s23, 0x8800
    buffer_load_dwordx4 v[116:119], v7, s[8:11], s23 offen offset:1024 sc1
    s_lshr_b32 s21, s12, 3
    s_lshl_b32 s21, s21, 17
    s_add_u32 s21, s21, s20
    s_add_u32 s21, s21, 0x400000
    s_barrier
    ds_read_b64_tr_b16 v[224:225], v4 offset:0
    ds_read_b64_tr_b16 v[226:227], v4 offset:1024
    ds_read_b64_tr_b16 v[228:229], v5 offset:32
    ds_read_b64_tr_b16 v[230:231], v5 offset:1056
    ds_read_b64_tr_b16 v[232:233], v4 offset:256
    ds_read_b64_tr_b16 v[234:235], v4 offset:1280
    ds_read_b64_tr_b16 v[236:237], v5 offset:288
    ds_read_b64_tr_b16 v[238:239], v5 offset:1312
    s_waitcnt vmcnt(7) lgkmcnt(6)
    v_mfma_f32_16x16x32_bf16 v[24:27], v[224:227], v[88:91], 0
    ds_read_b64_tr_b16 v[240:241], v4 offset:512
    s_waitcnt vmcnt(6)
    v_mfma_f32_16x16x32_bf16 v[28:31], v[224:227], v[92:95], 0
    ds_read_b64_tr_b16 v[242:243], v4 offset:1536
    s_waitcnt lgkmcnt(6)
    v_mfma_f32_16x16x32_bf16 v[32:35], v[228:231], v[88:91], 0
    ds_read_b64_tr_b16 v[244:245], v5 offset:544
    v_mfma_f32_16x16x32_bf16 v[36:39], v[228:231], v[92:95], 0
    ds_read_b64_tr_b16 v[246:247], v5 offset:1568
    s_mov_b32 s23, 0x1000
    buffer_load_dwordx4 v[120:123], v7, s[8:11], s23 offen offset:0 sc1
    s_waitcnt lgkmcnt(6)
    v_mfma_f32_16x16x32_bf16 v[40:43], v[232:235], v[88:91], 0
    ds_read_b64_tr_b16 v[224:225], v4 offset:768
    v_mfma_f32_16x16x32_bf16 v[44:47], v[232:235], v[92:95], 0
    ds_read_b64_tr_b16 v[226:227], v4 offset:1792
    s_waitcnt lgkmcnt(6)
    v_mfma_f32_16x16x32_bf16 v[48:51], v[236:239], v[88:91], 0
    ds_read_b64_tr_b16 v[228:229], v5 offset:800
    v_mfma_f32_16x16x32_bf16 v[52:55], v[236:239], v[92:95], 0
    ds_read_b64_tr_b16 v[230:231], v5 offset:1824
    s_waitcnt lgkmcnt(6)
    v_mfma_f32_16x16x32_bf16 v[56:59], v[240:243], v[88:91], 0
    ds_read_b64_tr_b16 v[232:233], v4 offset:8192
    v_mfma_f32_16x16x32_bf16 v[60:63], v[240:243], v[92:95], 0
    ds_read_b64_tr_b16 v[234:235], v4 offset:9216
    s_waitcnt lgkmcnt(6)
    v_mfma_f32_16x16x32_bf16 v[64:67], v[244:247], v[88:91], 0
    ds_read_b64_tr_b16 v[236:237], v5 offset:8224
    v_mfma_f32_16x16x32_bf16 v[68:71], v[244:247], v[92:95], 0
    ds_read_b64_tr_b16 v[238:239], v5 offset:9248
    s_mov_b32 s23, 0x9000
    buffer_load_dwordx4 v[124:127], v7, s[8:11], s23 offen offset:0 sc1
    s_waitcnt lgkmcnt(6)
    v_mfma_f32_16x16x32_bf16 v[72:75], v[224:227], v[88:91], 0
    ds_read_b64_tr_b16 v[240:241], v4 offset:8448
    v_mfma_f32_16x16x32_bf16 v[76:79], v[224:227], v[92:95], 0
    ds_read_b64_tr_b16 v[242:243], v4 offset:9472
    s_waitcnt lgkmcnt(6)
    v_mfma_f32_16x16x32_bf16 v[80:83], v[228:231], v[88:91], 0
    ds_read_b64_tr_b16 v[244:245], v5 offset:8480
    v_mfma_f32_16x16x32_bf16 v[84:87], v[228:231], v[92:95], 0
    ds_read_b64_tr_b16 v[246:247], v5 offset:9504
    s_waitcnt vmcnt(7) lgkmcnt(6)
    v_mfma_f32_16x16x32_bf16 v[24:27], v[232:235], v[96:99], v[24:27]
    ds_read_b64_tr_b16 v[224:225], v4 offset:8704
    s_waitcnt vmcnt(6)
    v_mfma_f32_16x16x32_bf16 v[28:31], v[232:235], v[100:103], v[28:31]
    ds_read_b64_tr_b16 v[226:227], v4 offset:9728
    s_waitcnt lgkmcnt(6)
    v_mfma_f32_16x16x32_bf16 v[32:35], v[236:239], v[96:99], v[32:35]
    ds_read_b64_tr_b16 v[228:229], v5 offset:8736
    v_mfma_f32_16x16x32_bf16 v[36:39], v[236:239], v[100:103], v[36:39]
    ds_read_b64_tr_b16 v[230:231], v5 offset:9760
    s_mov_b32 s23, 0x1000
    buffer_load_dwordx4 v[128:131], v7, s[8:11], s23 offen offset:1024 sc1
    s_waitcnt lgkmcnt(6)
    v_mfma_f32_16x16x32_bf16 v[40:43], v[240:243], v[96:99], v[40:43]
    ds_read_b64_tr_b16 v[232:233], v4 offset:8960
    v_mfma_f32_16x16x32_bf16 v[44:47], v[240:243], v[100:103], v[44:47]
    ds_read_b64_tr_b16 v[234:235], v4 offset:9984
    s_waitcnt lgkmcnt(6)
    v_mfma_f32_16x16x32_bf16 v[48:51], v[244:247], v[96:99], v[48:51]
    ds_read_b64_tr_b16 v[236:237], v5 offset:8992
    v_mfma_f32_16x16x32_bf16 v[52:55], v[244:247], v[100:103], v[52:55]
    ds_read_b64_tr_b16 v[238:239], v5 offset:10016
    s_waitcnt lgkmcnt(6)
    v_mfma_f32_16x16x32_bf16 v[56:59], v[224:227], v[96:99], v[56:59]
    v_mfma_f32_16x16x32_bf16 v[60:63], v[224:227], v[100:103], v[60:63]
    s_barrier
    ds_read_b64_tr_b16 v[240:241], v4 offset:16384
    ds_read_b64_tr_b16 v[242:243], v4 offset:17408
    s_waitcnt lgkmcnt(6)
    v_mfma_f32_16x16x32_bf16 v[64:67], v[228:231], v[96:99], v[64:67]
    ds_read_b64_tr_b16 v[244:245], v5 offset:16416
    v_mfma_f32_16x16x32_bf16 v[68:71], v[228:231], v[100:103], v[68:71]
    s_add_u32 s22, s19, 0x200000
    s_add_u32 m0, s20, 0x20000
    s_nop 0
    buffer_load_dwordx4 v3, s[4:7], s22 offen lds
    ds_read_b64_tr_b16 v[246:247], v5 offset:17440
    s_mov_b32 s23, 0x9000
    buffer_load_dwordx4 v[132:135], v7, s[8:11], s23 offen offset:1024 sc1
    s_waitcnt lgkmcnt(6)
    v_mfma_f32_16x16x32_bf16 v[72:75], v[232:235], v[96:99], v[72:75]
    ds_read_b64_tr_b16 v[224:225], v4 offset:16640
    v_mfma_f32_16x16x32_bf16 v[76:79], v[232:235], v[100:103], v[76:79]
    ds_read_b64_tr_b16 v[226:227], v4 offset:17664
    s_waitcnt lgkmcnt(6)
    v_mfma_f32_16x16x32_bf16 v[80:83], v[236:239], v[96:99], v[80:83]
    ds_read_b64_tr_b16 v[228:229], v5 offset:16672
    v_mfma_f32_16x16x32_bf16 v[84:87], v[236:239], v[100:103], v[84:87]
    ds_read_b64_tr_b16 v[230:231], v5 offset:17696
    s_waitcnt vmcnt(8) lgkmcnt(6)
    v_mfma_f32_16x16x32_bf16 v[24:27], v[240:243], v[104:107], v[24:27]
    ds_read_b64_tr_b16 v[232:233], v4 offset:16896
    s_waitcnt vmcnt(7)
    v_mfma_f32_16x16x32_bf16 v[28:31], v[240:243], v[108:111], v[28:31]
    ds_read_b64_tr_b16 v[234:235], v4 offset:17920
    s_waitcnt lgkmcnt(6)
    v_mfma_f32_16x16x32_bf16 v[32:35], v[244:247], v[104:107], v[32:35]
    ds_read_b64_tr_b16 v[236:237], v5 offset:16928
    v_mfma_f32_16x16x32_bf16 v[36:39], v[244:247], v[108:111], v[36:39]
    s_add_u32 s22, s19, 0x208000
    s_add_u32 m0, s20, 0x20400
    s_nop 0
    buffer_load_dwordx4 v3, s[4:7], s22 offen lds
    ds_read_b64_tr_b16 v[238:239], v5 offset:17952
    s_mov_b32 s23, 0x1800
    buffer_load_dwordx4 v[88:91], v7, s[8:11], s23 offen offset:0 sc1
    s_waitcnt lgkmcnt(6)
    v_mfma_f32_16x16x32_bf16 v[40:43], v[224:227], v[104:107], v[40:43]
    ds_read_b64_tr_b16 v[240:241], v4 offset:17152
    v_mfma_f32_16x16x32_bf16 v[44:47], v[224:227], v[108:111], v[44:47]
    ds_read_b64_tr_b16 v[242:243], v4 offset:18176
    s_waitcnt lgkmcnt(6)
    v_mfma_f32_16x16x32_bf16 v[48:51], v[228:231], v[104:107], v[48:51]
    ds_read_b64_tr_b16 v[244:245], v5 offset:17184
    v_mfma_f32_16x16x32_bf16 v[52:55], v[228:231], v[108:111], v[52:55]
    ds_read_b64_tr_b16 v[246:247], v5 offset:18208
    s_waitcnt lgkmcnt(6)
    v_mfma_f32_16x16x32_bf16 v[56:59], v[232:235], v[104:107], v[56:59]
    ds_read_b64_tr_b16 v[224:225], v4 offset:24576
    v_mfma_f32_16x16x32_bf16 v[60:63], v[232:235], v[108:111], v[60:63]
    ds_read_b64_tr_b16 v[226:227], v4 offset:25600
    s_waitcnt lgkmcnt(6)
    v_mfma_f32_16x16x32_bf16 v[64:67], v[236:239], v[104:107], v[64:67]
    ds_read_b64_tr_b16 v[228:229], v5 offset:24608
    v_mfma_f32_16x16x32_bf16 v[68:71], v[236:239], v[108:111], v[68:71]
    ds_read_b64_tr_b16 v[230:231], v5 offset:25632
    s_mov_b32 s23, 0x9800
    buffer_load_dwordx4 v[92:95], v7, s[8:11], s23 offen offset:0 sc1
    s_waitcnt lgkmcnt(6)
    v_mfma_f32_16x16x32_bf16 v[72:75], v[240:243], v[104:107], v[72:75]
    ds_read_b64_tr_b16 v[232:233], v4 offset:24832
    v_mfma_f32_16x16x32_bf16 v[76:79], v[240:243], v[108:111], v[76:79]
    ds_read_b64_tr_b16 v[234:235], v4 offset:25856
    s_waitcnt lgkmcnt(6)
    v_mfma_f32_16x16x32_bf16 v[80:83], v[244:247], v[104:107], v[80:83]
    ds_read_b64_tr_b16 v[236:237], v5 offset:24864
    v_mfma_f32_16x16x32_bf16 v[84:87], v[244:247], v[108:111], v[84:87]
    ds_read_b64_tr_b16 v[238:239], v5 offset:25888
    s_waitcnt vmcnt(9) lgkmcnt(6)
    v_mfma_f32_16x16x32_bf16 v[24:27], v[224:227], v[112:115], v[24:27]
    ds_read_b64_tr_b16 v[240:241], v4 offset:25088
    s_waitcnt vmcnt(8)
    v_mfma_f32_16x16x32_bf16 v[28:31], v[224:227], v[116:119], v[28:31]
    ds_read_b64_tr_b16 v[242:243], v4 offset:26112
    s_waitcnt lgkmcnt(6)
    v_mfma_f32_16x16x32_bf16 v[32:35], v[228:231], v[112:115], v[32:35]
    ds_read_b64_tr_b16 v[244:245], v5 offset:25120
    v_mfma_f32_16x16x32_bf16 v[36:39], v[228:231], v[116:119], v[36:39]
    ds_read_b64_tr_b16 v[246:247], v5 offset:26144
    s_mov_b32 s23, 0x1800
    buffer_load_dwordx4 v[96:99], v7, s[8:11], s23 offen offset:1024 sc1
    s_waitcnt lgkmcnt(6)
    v_mfma_f32_16x16x32_bf16 v[40:43], v[232:235], v[112:115], v[40:43]
    ds_read_b64_tr_b16 v[224:225], v4 offset:25344
    v_mfma_f32_16x16x32_bf16 v[44:47], v[232:235], v[116:119], v[44:47]
    ds_read_b64_tr_b16 v[226:227], v4 offset:26368
    s_waitcnt lgkmcnt(6)
    v_mfma_f32_16x16x32_bf16 v[48:51], v[236:239], v[112:115], v[48:51]
    ds_read_b64_tr_b16 v[228:229], v5 offset:25376
    v_mfma_f32_16x16x32_bf16 v[52:55], v[236:239], v[116:119], v[52:55]
    ds_read_b64_tr_b16 v[230:231], v5 offset:26400
    s_waitcnt lgkmcnt(6)
    v_mfma_f32_16x16x32_bf16 v[56:59], v[240:243], v[112:115], v[56:59]
    v_mfma_f32_16x16x32_bf16 v[60:63], v[240:243], v[116:119], v[60:63]
    s_barrier
    ds_read_b64_tr_b16 v[232:233], v4 offset:32768
    ds_read_b64_tr_b16 v[234:235], v4 offset:33792
    s_waitcnt lgkmcnt(6)
    v_mfma_f32_16x16x32_bf16 v[64:67], v[244:247], v[112:115], v[64:67]
    ds_read_b64_tr_b16 v[236:237], v5 offset:32800
    v_mfma_f32_16x16x32_bf16 v[68:71], v[244:247], v[116:119], v[68:71]
    s_add_u32 s22, s19, 0x280000
    s_add_u32 m0, s20, 0x0
    s_nop 0
    buffer_load_dwordx4 v3, s[4:7], s22 offen lds
    ds_read_b64_tr_b16 v[238:239], v5 offset:33824
    s_mov_b32 s23, 0x9800
    buffer_load_dwordx4 v[100:103], v7, s[8:11], s23 offen offset:1024 sc1
    s_waitcnt lgkmcnt(6)
    v_mfma_f32_16x16x32_bf16 v[72:75], v[224:227], v[112:115], v[72:75]
    ds_read_b64_tr_b16 v[240:241], v4 offset:33024
    v_mfma_f32_16x16x32_bf16 v[76:79], v[224:227], v[116:119], v[76:79]
    ds_read_b64_tr_b16 v[242:243], v4 offset:34048
    s_waitcnt lgkmcnt(6)
    v_mfma_f32_16x16x32_bf16 v[80:83], v[228:231], v[112:115], v[80:83]
    ds_read_b64_tr_b16 v[244:245], v5 offset:33056
    v_mfma_f32_16x16x32_bf16 v[84:87], v[228:231], v[116:119], v[84:87]
    ds_read_b64_tr_b16 v[246:247], v5 offset:34080
    s_waitcnt vmcnt(10) lgkmcnt(6)
    v_mfma_f32_16x16x32_bf16 v[24:27], v[232:235], v[120:123], v[24:27]
    ds_read_b64_tr_b16 v[224:225], v4 offset:33280
    s_waitcnt vmcnt(9)
    v_mfma_f32_16x16x32_bf16 v[28:31], v[232:235], v[124:127], v[28:31]
    ds_read_b64_tr_b16 v[226:227], v4 offset:34304
    s_waitcnt lgkmcnt(6)
    v_mfma_f32_16x16x32_bf16 v[32:35], v[236:239], v[120:123], v[32:35]
    ds_read_b64_tr_b16 v[228:229], v5 offset:33312
    v_mfma_f32_16x16x32_bf16 v[36:39], v[236:239], v[124:127], v[36:39]
    s_add_u32 s22, s19, 0x288000
    s_add_u32 m0, s20, 0x400
    s_nop 0
    buffer_load_dwordx4 v3, s[4:7], s22 offen lds
    ds_read_b64_tr_b16 v[230:231], v5 offset:34336
    s_mov_b32 s23, 0x2000
    buffer_load_dwordx4 v[104:107], v7, s[8:11], s23 offen offset:0 sc1
    s_waitcnt lgkmcnt(6)
    v_mfma_f32_16x16x32_bf16 v[40:43], v[240:243], v[120:123], v[40:43]
    ds_read_b64_tr_b16 v[232:233], v4 offset:33536
    v_mfma_f32_16x16x32_bf16 v[44:47], v[240:243], v[124:127], v[44:47]
    ds_read_b64_tr_b16 v[234:235], v4 offset:34560
    s_waitcnt lgkmcnt(6)
    v_mfma_f32_16x16x32_bf16 v[48:51], v[244:247], v[120:123], v[48:51]
    ds_read_b64_tr_b16 v[236:237], v5 offset:33568
    v_mfma_f32_16x16x32_bf16 v[52:55], v[244:247], v[124:127], v[52:55]
    ds_read_b64_tr_b16 v[238:239], v5 offset:34592
    s_waitcnt lgkmcnt(6)
    v_mfma_f32_16x16x32_bf16 v[56:59], v[224:227], v[120:123], v[56:59]
    ds_read_b64_tr_b16 v[240:241], v4 offset:40960
    v_mfma_f32_16x16x32_bf16 v[60:63], v[224:227], v[124:127], v[60:63]
    ds_read_b64_tr_b16 v[242:243], v4 offset:41984
    s_waitcnt lgkmcnt(6)
    v_mfma_f32_16x16x32_bf16 v[64:67], v[228:231], v[120:123], v[64:67]
    ds_read_b64_tr_b16 v[244:245], v5 offset:40992
    v_mfma_f32_16x16x32_bf16 v[68:71], v[228:231], v[124:127], v[68:71]
    ds_read_b64_tr_b16 v[246:247], v5 offset:42016
    s_mov_b32 s23, 0xa000
    buffer_load_dwordx4 v[108:111], v7, s[8:11], s23 offen offset:0 sc1
    s_waitcnt lgkmcnt(6)
    v_mfma_f32_16x16x32_bf16 v[72:75], v[232:235], v[120:123], v[72:75]
    ds_read_b64_tr_b16 v[224:225], v4 offset:41216
    v_mfma_f32_16x16x32_bf16 v[76:79], v[232:235], v[124:127], v[76:79]
    ds_read_b64_tr_b16 v[226:227], v4 offset:42240
    s_waitcnt lgkmcnt(6)
    v_mfma_f32_16x16x32_bf16 v[80:83], v[236:239], v[120:123], v[80:83]
    ds_read_b64_tr_b16 v[228:229], v5 offset:41248
    v_mfma_f32_16x16x32_bf16 v[84:87], v[236:239], v[124:127], v[84:87]
    ds_read_b64_tr_b16 v[230:231], v5 offset:42272
    s_waitcnt vmcnt(11) lgkmcnt(6)
    v_mfma_f32_16x16x32_bf16 v[24:27], v[240:243], v[128:131], v[24:27]
    ds_read_b64_tr_b16 v[232:233], v4 offset:41472
    s_waitcnt vmcnt(9)
    v_mfma_f32_16x16x32_bf16 v[28:31], v[240:243], v[132:135], v[28:31]
    ds_read_b64_tr_b16 v[234:235], v4 offset:42496
    s_waitcnt lgkmcnt(6)
    v_mfma_f32_16x16x32_bf16 v[32:35], v[244:247], v[128:131], v[32:35]
    ds_read_b64_tr_b16 v[236:237], v5 offset:41504
    v_mfma_f32_16x16x32_bf16 v[36:39], v[244:247], v[132:135], v[36:39]
    ds_read_b64_tr_b16 v[238:239], v5 offset:42528
    s_mov_b32 s23, 0x2000
    buffer_load_dwordx4 v[112:115], v7, s[8:11], s23 offen offset:1024 sc1
    s_waitcnt lgkmcnt(6)
    v_mfma_f32_16x16x32_bf16 v[40:43], v[224:227], v[128:131], v[40:43]
    ds_read_b64_tr_b16 v[240:241], v4 offset:41728
    v_mfma_f32_16x16x32_bf16 v[44:47], v[224:227], v[132:135], v[44:47]
    ds_read_b64_tr_b16 v[242:243], v4 offset:42752
    s_waitcnt lgkmcnt(6)
    v_mfma_f32_16x16x32_bf16 v[48:51], v[228:231], v[128:131], v[48:51]
    ds_read_b64_tr_b16 v[244:245], v5 offset:41760
    v_mfma_f32_16x16x32_bf16 v[52:55], v[228:231], v[132:135], v[52:55]
    ds_read_b64_tr_b16 v[246:247], v5 offset:42784
    s_waitcnt lgkmcnt(6)
    v_mfma_f32_16x16x32_bf16 v[56:59], v[232:235], v[128:131], v[56:59]
    v_mfma_f32_16x16x32_bf16 v[60:63], v[232:235], v[132:135], v[60:63]
    s_barrier
    ds_read_b64_tr_b16 v[224:225], v4 offset:49152
    ds_read_b64_tr_b16 v[226:227], v4 offset:50176
    s_waitcnt lgkmcnt(6)
    v_mfma_f32_16x16x32_bf16 v[64:67], v[236:239], v[128:131], v[64:67]
    ds_read_b64_tr_b16 v[228:229], v5 offset:49184
    v_mfma_f32_16x16x32_bf16 v[68:71], v[236:239], v[132:135], v[68:71]
    s_add_u32 s22, s19, 0x300000
    s_add_u32 m0, s20, 0x4000
    s_nop 0
    buffer_load_dwordx4 v3, s[4:7], s22 offen lds
    ds_read_b64_tr_b16 v[230:231], v5 offset:50208
    s_mov_b32 s23, 0xa000
    buffer_load_dwordx4 v[116:119], v7, s[8:11], s23 offen offset:1024 sc1
    s_waitcnt lgkmcnt(6)
    v_mfma_f32_16x16x32_bf16 v[72:75], v[240:243], v[128:131], v[72:75]
    ds_read_b64_tr_b16 v[232:233], v4 offset:49408
    v_mfma_f32_16x16x32_bf16 v[76:79], v[240:243], v[132:135], v[76:79]
    ds_read_b64_tr_b16 v[234:235], v4 offset:50432
    s_waitcnt lgkmcnt(6)
    v_mfma_f32_16x16x32_bf16 v[80:83], v[244:247], v[128:131], v[80:83]
    ds_read_b64_tr_b16 v[236:237], v5 offset:49440
    v_mfma_f32_16x16x32_bf16 v[84:87], v[244:247], v[132:135], v[84:87]
    ds_read_b64_tr_b16 v[238:239], v5 offset:50464
    s_waitcnt vmcnt(10) lgkmcnt(6)
    v_mfma_f32_16x16x32_bf16 v[24:27], v[224:227], v[88:91], v[24:27]
    ds_read_b64_tr_b16 v[240:241], v4 offset:49664
    s_waitcnt vmcnt(9)
    v_mfma_f32_16x16x32_bf16 v[28:31], v[224:227], v[92:95], v[28:31]
    ds_read_b64_tr_b16 v[242:243], v4 offset:50688
    s_waitcnt lgkmcnt(6)
    v_mfma_f32_16x16x32_bf16 v[32:35], v[228:231], v[88:91], v[32:35]
    ds_read_b64_tr_b16 v[244:245], v5 offset:49696
    v_mfma_f32_16x16x32_bf16 v[36:39], v[228:231], v[92:95], v[36:39]
    s_add_u32 s22, s19, 0x308000
    s_add_u32 m0, s20, 0x4400
    s_nop 0
    buffer_load_dwordx4 v3, s[4:7], s22 offen lds
    ds_read_b64_tr_b16 v[246:247], v5 offset:50720
    s_mov_b32 s23, 0x2800
    buffer_load_dwordx4 v[120:123], v7, s[8:11], s23 offen offset:0 sc1
    s_waitcnt lgkmcnt(6)
    v_mfma_f32_16x16x32_bf16 v[40:43], v[232:235], v[88:91], v[40:43]
    ds_read_b64_tr_b16 v[224:225], v4 offset:49920
    v_mfma_f32_16x16x32_bf16 v[44:47], v[232:235], v[92:95], v[44:47]
    ds_read_b64_tr_b16 v[226:227], v4 offset:50944
    s_waitcnt lgkmcnt(6)
    v_mfma_f32_16x16x32_bf16 v[48:51], v[236:239], v[88:91], v[48:51]
    ds_read_b64_tr_b16 v[228:229], v5 offset:49952
    v_mfma_f32_16x16x32_bf16 v[52:55], v[236:239], v[92:95], v[52:55]
    ds_read_b64_tr_b16 v[230:231], v5 offset:50976
    s_waitcnt lgkmcnt(6)
    v_mfma_f32_16x16x32_bf16 v[56:59], v[240:243], v[88:91], v[56:59]
    ds_read_b64_tr_b16 v[232:233], v4 offset:57344
    v_mfma_f32_16x16x32_bf16 v[60:63], v[240:243], v[92:95], v[60:63]
    ds_read_b64_tr_b16 v[234:235], v4 offset:58368
    s_waitcnt lgkmcnt(6)
    v_mfma_f32_16x16x32_bf16 v[64:67], v[244:247], v[88:91], v[64:67]
    ds_read_b64_tr_b16 v[236:237], v5 offset:57376
    v_mfma_f32_16x16x32_bf16 v[68:71], v[244:247], v[92:95], v[68:71]
    ds_read_b64_tr_b16 v[238:239], v5 offset:58400
    s_mov_b32 s23, 0xa800
    buffer_load_dwordx4 v[124:127], v7, s[8:11], s23 offen offset:0 sc1
    s_waitcnt lgkmcnt(6)
    v_mfma_f32_16x16x32_bf16 v[72:75], v[224:227], v[88:91], v[72:75]
    ds_read_b64_tr_b16 v[240:241], v4 offset:57600
    v_mfma_f32_16x16x32_bf16 v[76:79], v[224:227], v[92:95], v[76:79]
    ds_read_b64_tr_b16 v[242:243], v4 offset:58624
    s_waitcnt lgkmcnt(6)
    v_mfma_f32_16x16x32_bf16 v[80:83], v[228:231], v[88:91], v[80:83]
    ds_read_b64_tr_b16 v[244:245], v5 offset:57632
    v_mfma_f32_16x16x32_bf16 v[84:87], v[228:231], v[92:95], v[84:87]
    ds_read_b64_tr_b16 v[246:247], v5 offset:58656
    s_waitcnt vmcnt(11) lgkmcnt(6)
    v_mfma_f32_16x16x32_bf16 v[24:27], v[232:235], v[96:99], v[24:27]
    ds_read_b64_tr_b16 v[224:225], v4 offset:57856
    s_waitcnt vmcnt(9)
    v_mfma_f32_16x16x32_bf16 v[28:31], v[232:235], v[100:103], v[28:31]
    ds_read_b64_tr_b16 v[226:227], v4 offset:58880
    s_waitcnt lgkmcnt(6)
    v_mfma_f32_16x16x32_bf16 v[32:35], v[236:239], v[96:99], v[32:35]
    ds_read_b64_tr_b16 v[228:229], v5 offset:57888
    v_mfma_f32_16x16x32_bf16 v[36:39], v[236:239], v[100:103], v[36:39]
    ds_read_b64_tr_b16 v[230:231], v5 offset:58912
    s_mov_b32 s23, 0x2800
    buffer_load_dwordx4 v[128:131], v7, s[8:11], s23 offen offset:1024 sc1
    s_waitcnt lgkmcnt(6)
    v_mfma_f32_16x16x32_bf16 v[40:43], v[240:243], v[96:99], v[40:43]
    ds_read_b64_tr_b16 v[232:233], v4 offset:58112
    v_mfma_f32_16x16x32_bf16 v[44:47], v[240:243], v[100:103], v[44:47]
    ds_read_b64_tr_b16 v[234:235], v4 offset:59136
    s_waitcnt lgkmcnt(6)
    v_mfma_f32_16x16x32_bf16 v[48:51], v[244:247], v[96:99], v[48:51]
    ds_read_b64_tr_b16 v[236:237], v5 offset:58144
    v_mfma_f32_16x16x32_bf16 v[52:55], v[244:247], v[100:103], v[52:55]
    ds_read_b64_tr_b16 v[238:239], v5 offset:59168
    s_waitcnt lgkmcnt(6)
    v_mfma_f32_16x16x32_bf16 v[56:59], v[224:227], v[96:99], v[56:59]
    v_mfma_f32_16x16x32_bf16 v[60:63], v[224:227], v[100:103], v[60:63]
    s_barrier
    ds_read_b64_tr_b16 v[240:241], v11 offset:0
    ds_read_b64_tr_b16 v[242:243], v11 offset:1024
    s_waitcnt lgkmcnt(6)
    v_mfma_f32_16x16x32_bf16 v[64:67], v[228:231], v[96:99], v[64:67]
    ds_read_b64_tr_b16 v[244:245], v6 offset:32
    v_mfma_f32_16x16x32_bf16 v[68:71], v[228:231], v[100:103], v[68:71]
    s_add_u32 s22, s19, 0x380000
    s_add_u32 m0, s20, 0x8000
    s_nop 0
    buffer_load_dwordx4 v3, s[4:7], s22 offen lds
    ds_read_b64_tr_b16 v[246:247], v6 offset:1056
    s_mov_b32 s23, 0xa800
    buffer_load_dwordx4 v[132:135], v7, s[8:11], s23 offen offset:1024 sc1
    s_waitcnt lgkmcnt(6)
    v_mfma_f32_16x16x32_bf16 v[72:75], v[232:235], v[96:99], v[72:75]
    ds_read_b64_tr_b16 v[224:225], v11 offset:256
    v_mfma_f32_16x16x32_bf16 v[76:79], v[232:235], v[100:103], v[76:79]
    ds_read_b64_tr_b16 v[226:227], v11 offset:1280
    s_waitcnt lgkmcnt(6)
    v_mfma_f32_16x16x32_bf16 v[80:83], v[236:239], v[96:99], v[80:83]
    ds_read_b64_tr_b16 v[228:229], v6 offset:288
    v_mfma_f32_16x16x32_bf16 v[84:87], v[236:239], v[100:103], v[84:87]
    ds_read_b64_tr_b16 v[230:231], v6 offset:1312
    s_waitcnt vmcnt(10) lgkmcnt(6)
    v_mfma_f32_16x16x32_bf16 v[24:27], v[240:243], v[104:107], v[24:27]
    ds_read_b64_tr_b16 v[232:233], v11 offset:512
    s_waitcnt vmcnt(9)
    v_mfma_f32_16x16x32_bf16 v[28:31], v[240:243], v[108:111], v[28:31]
    ds_read_b64_tr_b16 v[234:235], v11 offset:1536
    s_waitcnt lgkmcnt(6)
    v_mfma_f32_16x16x32_bf16 v[32:35], v[244:247], v[104:107], v[32:35]
    ds_read_b64_tr_b16 v[236:237], v6 offset:544
    v_mfma_f32_16x16x32_bf16 v[36:39], v[244:247], v[108:111], v[36:39]
    s_add_u32 s22, s19, 0x388000
    s_add_u32 m0, s20, 0x8400
    s_nop 0
    buffer_load_dwordx4 v3, s[4:7], s22 offen lds
    ds_read_b64_tr_b16 v[238:239], v6 offset:1568
    s_mov_b32 s23, 0x3000
    buffer_load_dwordx4 v[88:91], v7, s[8:11], s23 offen offset:0 sc1
    s_waitcnt lgkmcnt(6)
    v_mfma_f32_16x16x32_bf16 v[40:43], v[224:227], v[104:107], v[40:43]
    ds_read_b64_tr_b16 v[240:241], v11 offset:768
    v_mfma_f32_16x16x32_bf16 v[44:47], v[224:227], v[108:111], v[44:47]
    ds_read_b64_tr_b16 v[242:243], v11 offset:1792
    s_waitcnt lgkmcnt(6)
    v_mfma_f32_16x16x32_bf16 v[48:51], v[228:231], v[104:107], v[48:51]
    ds_read_b64_tr_b16 v[244:245], v6 offset:800
    v_mfma_f32_16x16x32_bf16 v[52:55], v[228:231], v[108:111], v[52:55]
    ds_read_b64_tr_b16 v[246:247], v6 offset:1824
    s_waitcnt lgkmcnt(6)
    v_mfma_f32_16x16x32_bf16 v[56:59], v[232:235], v[104:107], v[56:59]
    ds_read_b64_tr_b16 v[224:225], v11 offset:8192
    v_mfma_f32_16x16x32_bf16 v[60:63], v[232:235], v[108:111], v[60:63]
    ds_read_b64_tr_b16 v[226:227], v11 offset:9216
    s_waitcnt lgkmcnt(6)
    v_mfma_f32_16x16x32_bf16 v[64:67], v[236:239], v[104:107], v[64:67]
    ds_read_b64_tr_b16 v[228:229], v6 offset:8224
    v_mfma_f32_16x16x32_bf16 v[68:71], v[236:239], v[108:111], v[68:71]
    ds_read_b64_tr_b16 v[230:231], v6 offset:9248
    s_mov_b32 s23, 0xb000
    buffer_load_dwordx4 v[92:95], v7, s[8:11], s23 offen offset:0 sc1
    s_waitcnt lgkmcnt(6)
    v_mfma_f32_16x16x32_bf16 v[72:75], v[240:243], v[104:107], v[72:75]
    ds_read_b64_tr_b16 v[232:233], v11 offset:8448
    v_mfma_f32_16x16x32_bf16 v[76:79], v[240:243], v[108:111], v[76:79]
    ds_read_b64_tr_b16 v[234:235], v11 offset:9472
    s_waitcnt lgkmcnt(6)
    v_mfma_f32_16x16x32_bf16 v[80:83], v[244:247], v[104:107], v[80:83]
    ds_read_b64_tr_b16 v[236:237], v6 offset:8480
    v_mfma_f32_16x16x32_bf16 v[84:87], v[244:247], v[108:111], v[84:87]
    ds_read_b64_tr_b16 v[238:239], v6 offset:9504
    s_waitcnt vmcnt(11) lgkmcnt(6)
    v_mfma_f32_16x16x32_bf16 v[24:27], v[224:227], v[112:115], v[24:27]
    ds_read_b64_tr_b16 v[240:241], v11 offset:8704
    s_waitcnt vmcnt(9)
    v_mfma_f32_16x16x32_bf16 v[28:31], v[224:227], v[116:119], v[28:31]
    ds_read_b64_tr_b16 v[242:243], v11 offset:9728
    s_waitcnt lgkmcnt(6)
    v_mfma_f32_16x16x32_bf16 v[32:35], v[228:231], v[112:115], v[32:35]
    ds_read_b64_tr_b16 v[244:245], v6 offset:8736
    v_mfma_f32_16x16x32_bf16 v[36:39], v[228:231], v[116:119], v[36:39]
    ds_read_b64_tr_b16 v[246:247], v6 offset:9760
    s_mov_b32 s23, 0x3000
    buffer_load_dwordx4 v[96:99], v7, s[8:11], s23 offen offset:1024 sc1
    s_waitcnt lgkmcnt(6)
    v_mfma_f32_16x16x32_bf16 v[40:43], v[232:235], v[112:115], v[40:43]
    ds_read_b64_tr_b16 v[224:225], v11 offset:8960
    v_mfma_f32_16x16x32_bf16 v[44:47], v[232:235], v[116:119], v[44:47]
    ds_read_b64_tr_b16 v[226:227], v11 offset:9984
    s_waitcnt lgkmcnt(6)
    v_mfma_f32_16x16x32_bf16 v[48:51], v[236:239], v[112:115], v[48:51]
    ds_read_b64_tr_b16 v[228:229], v6 offset:8992
    v_mfma_f32_16x16x32_bf16 v[52:55], v[236:239], v[116:119], v[52:55]
    ds_read_b64_tr_b16 v[230:231], v6 offset:10016
    s_waitcnt lgkmcnt(6)
    v_mfma_f32_16x16x32_bf16 v[56:59], v[240:243], v[112:115], v[56:59]
    v_mfma_f32_16x16x32_bf16 v[60:63], v[240:243], v[116:119], v[60:63]
    s_barrier
    ds_read_b64_tr_b16 v[232:233], v4 offset:0
    ds_read_b64_tr_b16 v[234:235], v4 offset:1024
    s_waitcnt lgkmcnt(6)
    v_mfma_f32_16x16x32_bf16 v[64:67], v[244:247], v[112:115], v[64:67]
    ds_read_b64_tr_b16 v[236:237], v5 offset:32
    v_mfma_f32_16x16x32_bf16 v[68:71], v[244:247], v[116:119], v[68:71]
    s_add_u32 s22, s19, 0x400000
    s_add_u32 m0, s20, 0xc000
    s_nop 0
    buffer_load_dwordx4 v3, s[4:7], s22 offen lds
    ds_read_b64_tr_b16 v[238:239], v5 offset:1056
    s_mov_b32 s23, 0xb000
    buffer_load_dwordx4 v[100:103], v7, s[8:11], s23 offen offset:1024 sc1
    s_waitcnt lgkmcnt(6)
    v_mfma_f32_16x16x32_bf16 v[72:75], v[224:227], v[112:115], v[72:75]
    ds_read_b64_tr_b16 v[240:241], v4 offset:256
    v_mfma_f32_16x16x32_bf16 v[76:79], v[224:227], v[116:119], v[76:79]
    ds_read_b64_tr_b16 v[242:243], v4 offset:1280
    s_waitcnt lgkmcnt(6)
    v_mfma_f32_16x16x32_bf16 v[80:83], v[228:231], v[112:115], v[80:83]
    ds_read_b64_tr_b16 v[244:245], v5 offset:288
    v_mfma_f32_16x16x32_bf16 v[84:87], v[228:231], v[116:119], v[84:87]
    ds_read_b64_tr_b16 v[246:247], v5 offset:1312
    s_waitcnt vmcnt(10) lgkmcnt(6)
    v_mfma_f32_16x16x32_bf16 v[24:27], v[232:235], v[120:123], v[24:27]
    ds_read_b64_tr_b16 v[224:225], v4 offset:512
    s_waitcnt vmcnt(9)
    v_mfma_f32_16x16x32_bf16 v[28:31], v[232:235], v[124:127], v[28:31]
    ds_read_b64_tr_b16 v[226:227], v4 offset:1536
    s_waitcnt lgkmcnt(6)
    v_mfma_f32_16x16x32_bf16 v[32:35], v[236:239], v[120:123], v[32:35]
    ds_read_b64_tr_b16 v[228:229], v5 offset:544
    v_mfma_f32_16x16x32_bf16 v[36:39], v[236:239], v[124:127], v[36:39]
    s_add_u32 s22, s19, 0x408000
    s_add_u32 m0, s20, 0xc400
    s_nop 0
    buffer_load_dwordx4 v3, s[4:7], s22 offen lds
    ds_read_b64_tr_b16 v[230:231], v5 offset:1568
    s_mov_b32 s23, 0x3800
    buffer_load_dwordx4 v[104:107], v7, s[8:11], s23 offen offset:0 sc1
    s_waitcnt lgkmcnt(6)
    v_mfma_f32_16x16x32_bf16 v[40:43], v[240:243], v[120:123], v[40:43]
    ds_read_b64_tr_b16 v[232:233], v4 offset:768
    v_mfma_f32_16x16x32_bf16 v[44:47], v[240:243], v[124:127], v[44:47]
    ds_read_b64_tr_b16 v[234:235], v4 offset:1792
    s_waitcnt lgkmcnt(6)
    v_mfma_f32_16x16x32_bf16 v[48:51], v[244:247], v[120:123], v[48:51]
    ds_read_b64_tr_b16 v[236:237], v5 offset:800
    v_mfma_f32_16x16x32_bf16 v[52:55], v[244:247], v[124:127], v[52:55]
    ds_read_b64_tr_b16 v[238:239], v5 offset:1824
    s_waitcnt lgkmcnt(6)
    v_mfma_f32_16x16x32_bf16 v[56:59], v[224:227], v[120:123], v[56:59]
    ds_read_b64_tr_b16 v[240:241], v4 offset:8192
    v_mfma_f32_16x16x32_bf16 v[60:63], v[224:227], v[124:127], v[60:63]
    ds_read_b64_tr_b16 v[242:243], v4 offset:9216
    s_waitcnt lgkmcnt(6)
    v_mfma_f32_16x16x32_bf16 v[64:67], v[228:231], v[120:123], v[64:67]
    ds_read_b64_tr_b16 v[244:245], v5 offset:8224
    v_mfma_f32_16x16x32_bf16 v[68:71], v[228:231], v[124:127], v[68:71]
    ds_read_b64_tr_b16 v[246:247], v5 offset:9248
    s_mov_b32 s23, 0xb800
    buffer_load_dwordx4 v[108:111], v7, s[8:11], s23 offen offset:0 sc1
    s_waitcnt lgkmcnt(6)
    v_mfma_f32_16x16x32_bf16 v[72:75], v[232:235], v[120:123], v[72:75]
    ds_read_b64_tr_b16 v[224:225], v4 offset:8448
    v_mfma_f32_16x16x32_bf16 v[76:79], v[232:235], v[124:127], v[76:79]
    ds_read_b64_tr_b16 v[226:227], v4 offset:9472
    s_waitcnt lgkmcnt(6)
    v_mfma_f32_16x16x32_bf16 v[80:83], v[236:239], v[120:123], v[80:83]
    ds_read_b64_tr_b16 v[228:229], v5 offset:8480
    v_mfma_f32_16x16x32_bf16 v[84:87], v[236:239], v[124:127], v[84:87]
    ds_read_b64_tr_b16 v[230:231], v5 offset:9504
    s_waitcnt vmcnt(11) lgkmcnt(6)
    v_mfma_f32_16x16x32_bf16 v[24:27], v[240:243], v[128:131], v[24:27]
    ds_read_b64_tr_b16 v[232:233], v4 offset:8704
    s_waitcnt vmcnt(9)
    v_mfma_f32_16x16x32_bf16 v[28:31], v[240:243], v[132:135], v[28:31]
    ds_read_b64_tr_b16 v[234:235], v4 offset:9728
    s_waitcnt lgkmcnt(6)
    v_mfma_f32_16x16x32_bf16 v[32:35], v[244:247], v[128:131], v[32:35]
    ds_read_b64_tr_b16 v[236:237], v5 offset:8736
    v_mfma_f32_16x16x32_bf16 v[36:39], v[244:247], v[132:135], v[36:39]
    ds_read_b64_tr_b16 v[238:239], v5 offset:9760
    s_mov_b32 s23, 0x3800
    buffer_load_dwordx4 v[112:115], v7, s[8:11], s23 offen offset:1024 sc1
    s_waitcnt lgkmcnt(6)
    v_mfma_f32_16x16x32_bf16 v[40:43], v[224:227], v[128:131], v[40:43]
    ds_read_b64_tr_b16 v[240:241], v4 offset:8960
    v_mfma_f32_16x16x32_bf16 v[44:47], v[224:227], v[132:135], v[44:47]
    ds_read_b64_tr_b16 v[242:243], v4 offset:9984
    s_waitcnt lgkmcnt(6)
    v_mfma_f32_16x16x32_bf16 v[48:51], v[228:231], v[128:131], v[48:51]
    ds_read_b64_tr_b16 v[244:245], v5 offset:8992
    v_mfma_f32_16x16x32_bf16 v[52:55], v[228:231], v[132:135], v[52:55]
    ds_read_b64_tr_b16 v[246:247], v5 offset:10016
    s_waitcnt lgkmcnt(6)
    v_mfma_f32_16x16x32_bf16 v[56:59], v[232:235], v[128:131], v[56:59]
    v_mfma_f32_16x16x32_bf16 v[60:63], v[232:235], v[132:135], v[60:63]
    s_barrier
    ds_read_b64_tr_b16 v[224:225], v4 offset:16384
    ds_read_b64_tr_b16 v[226:227], v4 offset:17408
    s_waitcnt lgkmcnt(6)
    v_mfma_f32_16x16x32_bf16 v[64:67], v[236:239], v[128:131], v[64:67]
    ds_read_b64_tr_b16 v[228:229], v5 offset:16416
    v_mfma_f32_16x16x32_bf16 v[68:71], v[236:239], v[132:135], v[68:71]
    s_add_u32 s22, s19, 0x480000
    s_add_u32 m0, s20, 0x20000
    s_nop 0
    buffer_load_dwordx4 v3, s[4:7], s22 offen lds
    ds_read_b64_tr_b16 v[230:231], v5 offset:17440
    s_mov_b32 s23, 0xb800
    buffer_load_dwordx4 v[116:119], v7, s[8:11], s23 offen offset:1024 sc1
    s_waitcnt lgkmcnt(6)
    v_mfma_f32_16x16x32_bf16 v[72:75], v[240:243], v[128:131], v[72:75]
    ds_read_b64_tr_b16 v[232:233], v4 offset:16640
    v_mfma_f32_16x16x32_bf16 v[76:79], v[240:243], v[132:135], v[76:79]
    ds_read_b64_tr_b16 v[234:235], v4 offset:17664
    s_waitcnt lgkmcnt(6)
    v_mfma_f32_16x16x32_bf16 v[80:83], v[244:247], v[128:131], v[80:83]
    ds_read_b64_tr_b16 v[236:237], v5 offset:16672
    v_mfma_f32_16x16x32_bf16 v[84:87], v[244:247], v[132:135], v[84:87]
    ds_read_b64_tr_b16 v[238:239], v5 offset:17696
    s_waitcnt vmcnt(10) lgkmcnt(6)
    v_mfma_f32_16x16x32_bf16 v[24:27], v[224:227], v[88:91], v[24:27]
    ds_read_b64_tr_b16 v[240:241], v4 offset:16896
    s_waitcnt vmcnt(9)
    v_mfma_f32_16x16x32_bf16 v[28:31], v[224:227], v[92:95], v[28:31]
    ds_read_b64_tr_b16 v[242:243], v4 offset:17920
    s_waitcnt lgkmcnt(6)
    v_mfma_f32_16x16x32_bf16 v[32:35], v[228:231], v[88:91], v[32:35]
    ds_read_b64_tr_b16 v[244:245], v5 offset:16928
    v_mfma_f32_16x16x32_bf16 v[36:39], v[228:231], v[92:95], v[36:39]
    s_add_u32 s22, s19, 0x488000
    s_add_u32 m0, s20, 0x20400
    s_nop 0
    buffer_load_dwordx4 v3, s[4:7], s22 offen lds
    ds_read_b64_tr_b16 v[246:247], v5 offset:17952
    s_mov_b32 s23, 0x4000
    buffer_load_dwordx4 v[120:123], v7, s[8:11], s23 offen offset:0 sc1
    s_waitcnt lgkmcnt(6)
    v_mfma_f32_16x16x32_bf16 v[40:43], v[232:235], v[88:91], v[40:43]
    ds_read_b64_tr_b16 v[224:225], v4 offset:17152
    v_mfma_f32_16x16x32_bf16 v[44:47], v[232:235], v[92:95], v[44:47]
    ds_read_b64_tr_b16 v[226:227], v4 offset:18176
    s_waitcnt lgkmcnt(6)
    v_mfma_f32_16x16x32_bf16 v[48:51], v[236:239], v[88:91], v[48:51]
    ds_read_b64_tr_b16 v[228:229], v5 offset:17184
    v_mfma_f32_16x16x32_bf16 v[52:55], v[236:239], v[92:95], v[52:55]
    ds_read_b64_tr_b16 v[230:231], v5 offset:18208
    s_waitcnt lgkmcnt(6)
    v_mfma_f32_16x16x32_bf16 v[56:59], v[240:243], v[88:91], v[56:59]
    ds_read_b64_tr_b16 v[232:233], v4 offset:24576
    v_mfma_f32_16x16x32_bf16 v[60:63], v[240:243], v[92:95], v[60:63]
    ds_read_b64_tr_b16 v[234:235], v4 offset:25600
    s_waitcnt lgkmcnt(6)
    v_mfma_f32_16x16x32_bf16 v[64:67], v[244:247], v[88:91], v[64:67]
    ds_read_b64_tr_b16 v[236:237], v5 offset:24608
    v_mfma_f32_16x16x32_bf16 v[68:71], v[244:247], v[92:95], v[68:71]
    ds_read_b64_tr_b16 v[238:239], v5 offset:25632
    s_mov_b32 s23, 0xc000
    buffer_load_dwordx4 v[124:127], v7, s[8:11], s23 offen offset:0 sc1
    s_waitcnt lgkmcnt(6)
    v_mfma_f32_16x16x32_bf16 v[72:75], v[224:227], v[88:91], v[72:75]
    ds_read_b64_tr_b16 v[240:241], v4 offset:24832
    v_lshrrev_b32 v21, 4, v1
    v_lshlrev_b32 v21, 9, v21
    v_and_b32 v20, 15, v1
    v_lshl_add_u32 v21, v20, 4, v21
    s_lshr_b32 s18, s12, 3
    s_lshl_b32 s18, s18, 11
    s_add_u32 s18, s18, 0x528100
    buffer_load_dwordx4 v[12:15], v21, s[8:11], s18 offen sc1
    v_mfma_f32_16x16x32_bf16 v[76:79], v[224:227], v[92:95], v[76:79]
    ds_read_b64_tr_b16 v[242:243], v4 offset:25856
    s_waitcnt lgkmcnt(6)
    v_mfma_f32_16x16x32_bf16 v[80:83], v[228:231], v[88:91], v[80:83]
    ds_read_b64_tr_b16 v[244:245], v5 offset:24864
    v_mfma_f32_16x16x32_bf16 v[84:87], v[228:231], v[92:95], v[84:87]
    ds_read_b64_tr_b16 v[246:247], v5 offset:25888
    s_waitcnt vmcnt(12) lgkmcnt(6)
    v_mfma_f32_16x16x32_bf16 v[24:27], v[232:235], v[96:99], v[24:27]
    ds_read_b64_tr_b16 v[224:225], v4 offset:25088
    s_waitcnt vmcnt(10)
    v_mfma_f32_16x16x32_bf16 v[28:31], v[232:235], v[100:103], v[28:31]
    ds_read_b64_tr_b16 v[226:227], v4 offset:26112
    s_waitcnt lgkmcnt(6)
    v_mfma_f32_16x16x32_bf16 v[32:35], v[236:239], v[96:99], v[32:35]
    ds_read_b64_tr_b16 v[228:229], v5 offset:25120
    v_mfma_f32_16x16x32_bf16 v[36:39], v[236:239], v[100:103], v[36:39]
    ds_read_b64_tr_b16 v[230:231], v5 offset:26144
    s_mov_b32 s23, 0x4000
    buffer_load_dwordx4 v[128:131], v7, s[8:11], s23 offen offset:1024 sc1
    s_waitcnt lgkmcnt(6)
    v_mfma_f32_16x16x32_bf16 v[40:43], v[240:243], v[96:99], v[40:43]
    ds_read_b64_tr_b16 v[232:233], v4 offset:25344
    v_mfma_f32_16x16x32_bf16 v[44:47], v[240:243], v[100:103], v[44:47]
    ds_read_b64_tr_b16 v[234:235], v4 offset:26368
    s_waitcnt lgkmcnt(6)
    v_mfma_f32_16x16x32_bf16 v[48:51], v[244:247], v[96:99], v[48:51]
    ds_read_b64_tr_b16 v[236:237], v5 offset:25376
    v_mfma_f32_16x16x32_bf16 v[52:55], v[244:247], v[100:103], v[52:55]
    ds_read_b64_tr_b16 v[238:239], v5 offset:26400
    s_waitcnt lgkmcnt(6)
    v_mfma_f32_16x16x32_bf16 v[56:59], v[224:227], v[96:99], v[56:59]
    v_mfma_f32_16x16x32_bf16 v[60:63], v[224:227], v[100:103], v[60:63]
    s_barrier
    ds_read_b64_tr_b16 v[240:241], v4 offset:32768
    ds_read_b64_tr_b16 v[242:243], v4 offset:33792
    s_waitcnt lgkmcnt(6)
    v_mfma_f32_16x16x32_bf16 v[64:67], v[228:231], v[96:99], v[64:67]
    ds_read_b64_tr_b16 v[244:245], v5 offset:32800
    v_mfma_f32_16x16x32_bf16 v[68:71], v[228:231], v[100:103], v[68:71]
    s_add_u32 s22, s19, 0x500000
    s_add_u32 m0, s20, 0x0
    s_nop 0
    buffer_load_dwordx4 v3, s[4:7], s22 offen lds
    ds_read_b64_tr_b16 v[246:247], v5 offset:33824
    s_mov_b32 s23, 0xc000
    buffer_load_dwordx4 v[132:135], v7, s[8:11], s23 offen offset:1024 sc1
    s_waitcnt lgkmcnt(6)
    v_mfma_f32_16x16x32_bf16 v[72:75], v[232:235], v[96:99], v[72:75]
    ds_read_b64_tr_b16 v[224:225], v4 offset:33024
    v_mfma_f32_16x16x32_bf16 v[76:79], v[232:235], v[100:103], v[76:79]
    ds_read_b64_tr_b16 v[226:227], v4 offset:34048
    s_waitcnt lgkmcnt(6)
    v_mfma_f32_16x16x32_bf16 v[80:83], v[236:239], v[96:99], v[80:83]
    ds_read_b64_tr_b16 v[228:229], v5 offset:33056
    v_mfma_f32_16x16x32_bf16 v[84:87], v[236:239], v[100:103], v[84:87]
    ds_read_b64_tr_b16 v[230:231], v5 offset:34080
    s_waitcnt vmcnt(11) lgkmcnt(6)
    v_mfma_f32_16x16x32_bf16 v[24:27], v[240:243], v[104:107], v[24:27]
    ds_read_b64_tr_b16 v[232:233], v4 offset:33280
    s_waitcnt vmcnt(10)
    v_mfma_f32_16x16x32_bf16 v[28:31], v[240:243], v[108:111], v[28:31]
    ds_read_b64_tr_b16 v[234:235], v4 offset:34304
    s_waitcnt lgkmcnt(6)
    v_mfma_f32_16x16x32_bf16 v[32:35], v[244:247], v[104:107], v[32:35]
    ds_read_b64_tr_b16 v[236:237], v5 offset:33312
    v_mfma_f32_16x16x32_bf16 v[36:39], v[244:247], v[108:111], v[36:39]
    s_add_u32 s22, s19, 0x508000
    s_add_u32 m0, s20, 0x400
    s_nop 0
    buffer_load_dwordx4 v3, s[4:7], s22 offen lds
    ds_read_b64_tr_b16 v[238:239], v5 offset:34336
    s_mov_b32 s23, 0x4800
    buffer_load_dwordx4 v[88:91], v7, s[8:11], s23 offen offset:0 sc1
    s_waitcnt lgkmcnt(6)
    v_mfma_f32_16x16x32_bf16 v[40:43], v[224:227], v[104:107], v[40:43]
    ds_read_b64_tr_b16 v[240:241], v4 offset:33536
    v_mfma_f32_16x16x32_bf16 v[44:47], v[224:227], v[108:111], v[44:47]
    ds_read_b64_tr_b16 v[242:243], v4 offset:34560
    s_waitcnt lgkmcnt(6)
    v_mfma_f32_16x16x32_bf16 v[48:51], v[228:231], v[104:107], v[48:51]
    ds_read_b64_tr_b16 v[244:245], v5 offset:33568
    v_mfma_f32_16x16x32_bf16 v[52:55], v[228:231], v[108:111], v[52:55]
    ds_read_b64_tr_b16 v[246:247], v5 offset:34592
    s_waitcnt lgkmcnt(6)
    v_mfma_f32_16x16x32_bf16 v[56:59], v[232:235], v[104:107], v[56:59]
    ds_read_b64_tr_b16 v[224:225], v4 offset:40960
    v_mfma_f32_16x16x32_bf16 v[60:63], v[232:235], v[108:111], v[60:63]
    ds_read_b64_tr_b16 v[226:227], v4 offset:41984
    s_waitcnt lgkmcnt(6)
    v_mfma_f32_16x16x32_bf16 v[64:67], v[236:239], v[104:107], v[64:67]
    ds_read_b64_tr_b16 v[228:229], v5 offset:40992
    v_mfma_f32_16x16x32_bf16 v[68:71], v[236:239], v[108:111], v[68:71]
    ds_read_b64_tr_b16 v[230:231], v5 offset:42016
    s_mov_b32 s23, 0xc800
    buffer_load_dwordx4 v[92:95], v7, s[8:11], s23 offen offset:0 sc1
    s_waitcnt lgkmcnt(6)
    v_mfma_f32_16x16x32_bf16 v[72:75], v[240:243], v[104:107], v[72:75]
    ds_read_b64_tr_b16 v[232:233], v4 offset:41216
    v_mfma_f32_16x16x32_bf16 v[76:79], v[240:243], v[108:111], v[76:79]
    ds_read_b64_tr_b16 v[234:235], v4 offset:42240
    s_waitcnt lgkmcnt(6)
    v_mfma_f32_16x16x32_bf16 v[80:83], v[244:247], v[104:107], v[80:83]
    ds_read_b64_tr_b16 v[236:237], v5 offset:41248
    v_mfma_f32_16x16x32_bf16 v[84:87], v[244:247], v[108:111], v[84:87]
    ds_read_b64_tr_b16 v[238:239], v5 offset:42272
    s_waitcnt vmcnt(12) lgkmcnt(6)
    v_mfma_f32_16x16x32_bf16 v[24:27], v[224:227], v[112:115], v[24:27]
    ds_read_b64_tr_b16 v[240:241], v4 offset:41472
    s_waitcnt vmcnt(10)
    v_mfma_f32_16x16x32_bf16 v[28:31], v[224:227], v[116:119], v[28:31]
    ds_read_b64_tr_b16 v[242:243], v4 offset:42496
    s_waitcnt lgkmcnt(6)
    v_mfma_f32_16x16x32_bf16 v[32:35], v[228:231], v[112:115], v[32:35]
    ds_read_b64_tr_b16 v[244:245], v5 offset:41504
    v_mfma_f32_16x16x32_bf16 v[36:39], v[228:231], v[116:119], v[36:39]
    ds_read_b64_tr_b16 v[246:247], v5 offset:42528
    s_mov_b32 s23, 0x4800
    buffer_load_dwordx4 v[96:99], v7, s[8:11], s23 offen offset:1024 sc1
    s_waitcnt lgkmcnt(6)
    v_mfma_f32_16x16x32_bf16 v[40:43], v[232:235], v[112:115], v[40:43]
    ds_read_b64_tr_b16 v[224:225], v4 offset:41728
    v_mfma_f32_16x16x32_bf16 v[44:47], v[232:235], v[116:119], v[44:47]
    ds_read_b64_tr_b16 v[226:227], v4 offset:42752
    s_waitcnt lgkmcnt(6)
    v_mfma_f32_16x16x32_bf16 v[48:51], v[236:239], v[112:115], v[48:51]
    ds_read_b64_tr_b16 v[228:229], v5 offset:41760
    v_mfma_f32_16x16x32_bf16 v[52:55], v[236:239], v[116:119], v[52:55]
    ds_read_b64_tr_b16 v[230:231], v5 offset:42784
    s_waitcnt lgkmcnt(6)
    v_mfma_f32_16x16x32_bf16 v[56:59], v[240:243], v[112:115], v[56:59]
    v_mfma_f32_16x16x32_bf16 v[60:63], v[240:243], v[116:119], v[60:63]
    s_barrier
    ds_read_b64_tr_b16 v[232:233], v4 offset:49152
    ds_read_b64_tr_b16 v[234:235], v4 offset:50176
    s_waitcnt lgkmcnt(6)
    v_mfma_f32_16x16x32_bf16 v[64:67], v[244:247], v[112:115], v[64:67]
    ds_read_b64_tr_b16 v[236:237], v5 offset:49184
    v_mfma_f32_16x16x32_bf16 v[68:71], v[244:247], v[116:119], v[68:71]
    s_add_u32 s22, s19, 0x580000
    s_add_u32 m0, s20, 0x4000
    s_nop 0
    buffer_load_dwordx4 v3, s[4:7], s22 offen lds
    ds_read_b64_tr_b16 v[238:239], v5 offset:50208
    s_mov_b32 s23, 0xc800
    buffer_load_dwordx4 v[100:103], v7, s[8:11], s23 offen offset:1024 sc1
    s_waitcnt lgkmcnt(6)
    v_mfma_f32_16x16x32_bf16 v[72:75], v[224:227], v[112:115], v[72:75]
    ds_read_b64_tr_b16 v[240:241], v4 offset:49408
    v_mfma_f32_16x16x32_bf16 v[76:79], v[224:227], v[116:119], v[76:79]
    ds_read_b64_tr_b16 v[242:243], v4 offset:50432
    s_waitcnt lgkmcnt(6)
    v_mfma_f32_16x16x32_bf16 v[80:83], v[228:231], v[112:115], v[80:83]
    ds_read_b64_tr_b16 v[244:245], v5 offset:49440
    v_mfma_f32_16x16x32_bf16 v[84:87], v[228:231], v[116:119], v[84:87]
    ds_read_b64_tr_b16 v[246:247], v5 offset:50464
    s_waitcnt vmcnt(11) lgkmcnt(6)
    v_mfma_f32_16x16x32_bf16 v[24:27], v[232:235], v[120:123], v[24:27]
    ds_read_b64_tr_b16 v[224:225], v4 offset:49664
    s_waitcnt vmcnt(10)
    v_mfma_f32_16x16x32_bf16 v[28:31], v[232:235], v[124:127], v[28:31]
    ds_read_b64_tr_b16 v[226:227], v4 offset:50688
    s_waitcnt lgkmcnt(6)
    v_mfma_f32_16x16x32_bf16 v[32:35], v[236:239], v[120:123], v[32:35]
    ds_read_b64_tr_b16 v[228:229], v5 offset:49696
    v_mfma_f32_16x16x32_bf16 v[36:39], v[236:239], v[124:127], v[36:39]
    s_add_u32 s22, s19, 0x588000
    s_add_u32 m0, s20, 0x4400
    s_nop 0
    buffer_load_dwordx4 v3, s[4:7], s22 offen lds
    ds_read_b64_tr_b16 v[230:231], v5 offset:50720
    s_mov_b32 s23, 0x5000
    buffer_load_dwordx4 v[104:107], v7, s[8:11], s23 offen offset:0 sc1
    s_waitcnt lgkmcnt(6)
    v_mfma_f32_16x16x32_bf16 v[40:43], v[240:243], v[120:123], v[40:43]
    ds_read_b64_tr_b16 v[232:233], v4 offset:49920
    v_mfma_f32_16x16x32_bf16 v[44:47], v[240:243], v[124:127], v[44:47]
    ds_read_b64_tr_b16 v[234:235], v4 offset:50944
    s_waitcnt lgkmcnt(6)
    v_mfma_f32_16x16x32_bf16 v[48:51], v[244:247], v[120:123], v[48:51]
    ds_read_b64_tr_b16 v[236:237], v5 offset:49952
    v_mfma_f32_16x16x32_bf16 v[52:55], v[244:247], v[124:127], v[52:55]
    ds_read_b64_tr_b16 v[238:239], v5 offset:50976
    s_waitcnt lgkmcnt(6)
    v_mfma_f32_16x16x32_bf16 v[56:59], v[224:227], v[120:123], v[56:59]
    ds_read_b64_tr_b16 v[240:241], v4 offset:57344
    v_mfma_f32_16x16x32_bf16 v[60:63], v[224:227], v[124:127], v[60:63]
    ds_read_b64_tr_b16 v[242:243], v4 offset:58368
    s_waitcnt lgkmcnt(6)
    v_mfma_f32_16x16x32_bf16 v[64:67], v[228:231], v[120:123], v[64:67]
    ds_read_b64_tr_b16 v[244:245], v5 offset:57376
    v_mfma_f32_16x16x32_bf16 v[68:71], v[228:231], v[124:127], v[68:71]
    ds_read_b64_tr_b16 v[246:247], v5 offset:58400
    s_mov_b32 s23, 0xd000
    buffer_load_dwordx4 v[108:111], v7, s[8:11], s23 offen offset:0 sc1
    s_waitcnt lgkmcnt(6)
    v_mfma_f32_16x16x32_bf16 v[72:75], v[232:235], v[120:123], v[72:75]
    ds_read_b64_tr_b16 v[224:225], v4 offset:57600
    v_mfma_f32_16x16x32_bf16 v[76:79], v[232:235], v[124:127], v[76:79]
    ds_read_b64_tr_b16 v[226:227], v4 offset:58624
    s_waitcnt lgkmcnt(6)
    v_mfma_f32_16x16x32_bf16 v[80:83], v[236:239], v[120:123], v[80:83]
    ds_read_b64_tr_b16 v[228:229], v5 offset:57632
    v_mfma_f32_16x16x32_bf16 v[84:87], v[236:239], v[124:127], v[84:87]
    ds_read_b64_tr_b16 v[230:231], v5 offset:58656
    s_waitcnt vmcnt(11) lgkmcnt(6)
    v_mfma_f32_16x16x32_bf16 v[24:27], v[240:243], v[128:131], v[24:27]
    ds_read_b64_tr_b16 v[232:233], v4 offset:57856
    s_waitcnt vmcnt(9)
    v_mfma_f32_16x16x32_bf16 v[28:31], v[240:243], v[132:135], v[28:31]
    ds_read_b64_tr_b16 v[234:235], v4 offset:58880
    s_waitcnt lgkmcnt(6)
    v_mfma_f32_16x16x32_bf16 v[32:35], v[244:247], v[128:131], v[32:35]
    ds_read_b64_tr_b16 v[236:237], v5 offset:57888
    v_mfma_f32_16x16x32_bf16 v[36:39], v[244:247], v[132:135], v[36:39]
    ds_read_b64_tr_b16 v[238:239], v5 offset:58912
    s_mov_b32 s23, 0x5000
    buffer_load_dwordx4 v[112:115], v7, s[8:11], s23 offen offset:1024 sc1
    s_waitcnt lgkmcnt(6)
    v_mfma_f32_16x16x32_bf16 v[40:43], v[224:227], v[128:131], v[40:43]
    ds_read_b64_tr_b16 v[240:241], v4 offset:58112
    v_mfma_f32_16x16x32_bf16 v[44:47], v[224:227], v[132:135], v[44:47]
    ds_read_b64_tr_b16 v[242:243], v4 offset:59136
    s_waitcnt lgkmcnt(6)
    v_mfma_f32_16x16x32_bf16 v[48:51], v[228:231], v[128:131], v[48:51]
    ds_read_b64_tr_b16 v[244:245], v5 offset:58144
    v_mfma_f32_16x16x32_bf16 v[52:55], v[228:231], v[132:135], v[52:55]
    ds_read_b64_tr_b16 v[246:247], v5 offset:59168
    s_waitcnt lgkmcnt(6)
    v_mfma_f32_16x16x32_bf16 v[56:59], v[232:235], v[128:131], v[56:59]
    v_mfma_f32_16x16x32_bf16 v[60:63], v[232:235], v[132:135], v[60:63]
    s_barrier
    ds_read_b64_tr_b16 v[224:225], v11 offset:0
    ds_read_b64_tr_b16 v[226:227], v11 offset:1024
    s_waitcnt lgkmcnt(6)
    v_mfma_f32_16x16x32_bf16 v[64:67], v[236:239], v[128:131], v[64:67]
    ds_read_b64_tr_b16 v[228:229], v6 offset:32
    v_mfma_f32_16x16x32_bf16 v[68:71], v[236:239], v[132:135], v[68:71]
    s_add_u32 s22, s19, 0x600000
    s_add_u32 m0, s20, 0x8000
    s_nop 0
    buffer_load_dwordx4 v3, s[4:7], s22 offen lds
    ds_read_b64_tr_b16 v[230:231], v6 offset:1056
    s_mov_b32 s23, 0xd000
    buffer_load_dwordx4 v[116:119], v7, s[8:11], s23 offen offset:1024 sc1
    s_waitcnt lgkmcnt(6)
    v_mfma_f32_16x16x32_bf16 v[72:75], v[240:243], v[128:131], v[72:75]
    ds_read_b64_tr_b16 v[232:233], v11 offset:256
    v_mfma_f32_16x16x32_bf16 v[76:79], v[240:243], v[132:135], v[76:79]
    ds_read_b64_tr_b16 v[234:235], v11 offset:1280
    s_waitcnt lgkmcnt(6)
    v_mfma_f32_16x16x32_bf16 v[80:83], v[244:247], v[128:131], v[80:83]
    ds_read_b64_tr_b16 v[236:237], v6 offset:288
    v_mfma_f32_16x16x32_bf16 v[84:87], v[244:247], v[132:135], v[84:87]
    ds_read_b64_tr_b16 v[238:239], v6 offset:1312
    s_waitcnt vmcnt(10) lgkmcnt(6)
    v_mfma_f32_16x16x32_bf16 v[24:27], v[224:227], v[88:91], v[24:27]
    ds_read_b64_tr_b16 v[240:241], v11 offset:512
    s_waitcnt vmcnt(9)
    v_mfma_f32_16x16x32_bf16 v[28:31], v[224:227], v[92:95], v[28:31]
    ds_read_b64_tr_b16 v[242:243], v11 offset:1536
    s_waitcnt lgkmcnt(6)
    v_mfma_f32_16x16x32_bf16 v[32:35], v[228:231], v[88:91], v[32:35]
    ds_read_b64_tr_b16 v[244:245], v6 offset:544
    v_mfma_f32_16x16x32_bf16 v[36:39], v[228:231], v[92:95], v[36:39]
    s_add_u32 s22, s19, 0x608000
    s_add_u32 m0, s20, 0x8400
    s_nop 0
    buffer_load_dwordx4 v3, s[4:7], s22 offen lds
    ds_read_b64_tr_b16 v[246:247], v6 offset:1568
    s_mov_b32 s23, 0x5800
    buffer_load_dwordx4 v[120:123], v7, s[8:11], s23 offen offset:0 sc1
    s_waitcnt lgkmcnt(6)
    v_mfma_f32_16x16x32_bf16 v[40:43], v[232:235], v[88:91], v[40:43]
    ds_read_b64_tr_b16 v[224:225], v11 offset:768
    v_mfma_f32_16x16x32_bf16 v[44:47], v[232:235], v[92:95], v[44:47]
    ds_read_b64_tr_b16 v[226:227], v11 offset:1792
    s_waitcnt lgkmcnt(6)
    v_mfma_f32_16x16x32_bf16 v[48:51], v[236:239], v[88:91], v[48:51]
    ds_read_b64_tr_b16 v[228:229], v6 offset:800
    v_mfma_f32_16x16x32_bf16 v[52:55], v[236:239], v[92:95], v[52:55]
    ds_read_b64_tr_b16 v[230:231], v6 offset:1824
    s_waitcnt lgkmcnt(6)
    v_mfma_f32_16x16x32_bf16 v[56:59], v[240:243], v[88:91], v[56:59]
    ds_read_b64_tr_b16 v[232:233], v11 offset:8192
    v_mfma_f32_16x16x32_bf16 v[60:63], v[240:243], v[92:95], v[60:63]
    ds_read_b64_tr_b16 v[234:235], v11 offset:9216
    s_waitcnt lgkmcnt(6)
    v_mfma_f32_16x16x32_bf16 v[64:67], v[244:247], v[88:91], v[64:67]
    ds_read_b64_tr_b16 v[236:237], v6 offset:8224
    v_mfma_f32_16x16x32_bf16 v[68:71], v[244:247], v[92:95], v[68:71]
    ds_read_b64_tr_b16 v[238:239], v6 offset:9248
    s_mov_b32 s23, 0xd800
    buffer_load_dwordx4 v[124:127], v7, s[8:11], s23 offen offset:0 sc1
    s_waitcnt lgkmcnt(6)
    v_mfma_f32_16x16x32_bf16 v[72:75], v[224:227], v[88:91], v[72:75]
    ds_read_b64_tr_b16 v[240:241], v11 offset:8448
    v_xor_b32 v8, s28, v12
    v_xor_b32 v20, s28, v13
    v_or_b32 v8, v8, v20
    v_xor_b32 v20, s28, v14
    v_or_b32 v8, v8, v20
    v_xor_b32 v20, s28, v15
    v_or_b32 v8, v8, v20
    v_cmp_ne_u32 vcc, 0, v8
    s_cbranch_vccnz adaLN_cond__sliding_block_cached__moe_arch_mod__prompt_kernel_kv16r
adaLN_cond__sliding_block_cached__moe_arch_mod__prompt_kernel_kv16b:
    v_mfma_f32_16x16x32_bf16 v[76:79], v[224:227], v[92:95], v[76:79]
    ds_read_b64_tr_b16 v[242:243], v11 offset:9472
    v_mov_b32 v20, 0
    s_mov_b32 s16, 0x564000
    buffer_load_dword v8, v20, s[8:11], s16 offen sc1
    s_waitcnt lgkmcnt(6)
    v_mfma_f32_16x16x32_bf16 v[80:83], v[228:231], v[88:91], v[80:83]
    ds_read_b64_tr_b16 v[244:245], v6 offset:8480
    v_mfma_f32_16x16x32_bf16 v[84:87], v[228:231], v[92:95], v[84:87]
    ds_read_b64_tr_b16 v[246:247], v6 offset:9504
    s_waitcnt vmcnt(12) lgkmcnt(6)
    v_mfma_f32_16x16x32_bf16 v[24:27], v[232:235], v[96:99], v[24:27]
    ds_read_b64_tr_b16 v[224:225], v11 offset:8704
    s_waitcnt vmcnt(10)
    v_mfma_f32_16x16x32_bf16 v[28:31], v[232:235], v[100:103], v[28:31]
    ds_read_b64_tr_b16 v[226:227], v11 offset:9728
    s_waitcnt lgkmcnt(6)
    v_mfma_f32_16x16x32_bf16 v[32:35], v[236:239], v[96:99], v[32:35]
    ds_read_b64_tr_b16 v[228:229], v6 offset:8736
    v_mfma_f32_16x16x32_bf16 v[36:39], v[236:239], v[100:103], v[36:39]
    ds_read_b64_tr_b16 v[230:231], v6 offset:9760
    s_mov_b32 s23, 0x5800
    buffer_load_dwordx4 v[128:131], v7, s[8:11], s23 offen offset:1024 sc1
    s_waitcnt lgkmcnt(6)
    v_mfma_f32_16x16x32_bf16 v[40:43], v[240:243], v[96:99], v[40:43]
    ds_read_b64_tr_b16 v[232:233], v11 offset:8960
    v_mfma_f32_16x16x32_bf16 v[44:47], v[240:243], v[100:103], v[44:47]
    ds_read_b64_tr_b16 v[234:235], v11 offset:9984
    s_waitcnt lgkmcnt(6)
    v_mfma_f32_16x16x32_bf16 v[48:51], v[244:247], v[96:99], v[48:51]
    ds_read_b64_tr_b16 v[236:237], v6 offset:8992
    v_mfma_f32_16x16x32_bf16 v[52:55], v[244:247], v[100:103], v[52:55]
    ds_read_b64_tr_b16 v[238:239], v6 offset:10016
    s_waitcnt lgkmcnt(6)
    v_mfma_f32_16x16x32_bf16 v[56:59], v[224:227], v[96:99], v[56:59]
    v_mfma_f32_16x16x32_bf16 v[60:63], v[224:227], v[100:103], v[60:63]
    s_barrier
    ds_read_b64_tr_b16 v[240:241], v4 offset:0
    ds_read_b64_tr_b16 v[242:243], v4 offset:1024
    s_waitcnt lgkmcnt(6)
    v_mfma_f32_16x16x32_bf16 v[64:67], v[228:231], v[96:99], v[64:67]
    ds_read_b64_tr_b16 v[244:245], v5 offset:32
    v_mfma_f32_16x16x32_bf16 v[68:71], v[228:231], v[100:103], v[68:71]
    s_add_u32 s22, s19, 0x680000
    s_add_u32 m0, s20, 0xc000
    s_nop 0
    buffer_load_dwordx4 v3, s[4:7], s22 offen lds
    ds_read_b64_tr_b16 v[246:247], v5 offset:1056
    s_mov_b32 s23, 0xd800
    buffer_load_dwordx4 v[132:135], v7, s[8:11], s23 offen offset:1024 sc1
    s_waitcnt lgkmcnt(6)
    v_mfma_f32_16x16x32_bf16 v[72:75], v[232:235], v[96:99], v[72:75]
    ds_read_b64_tr_b16 v[224:225], v4 offset:256
    v_mfma_f32_16x16x32_bf16 v[76:79], v[232:235], v[100:103], v[76:79]
    ds_read_b64_tr_b16 v[226:227], v4 offset:1280
    s_waitcnt lgkmcnt(6)
    v_mfma_f32_16x16x32_bf16 v[80:83], v[236:239], v[96:99], v[80:83]
    ds_read_b64_tr_b16 v[228:229], v5 offset:288
    v_mfma_f32_16x16x32_bf16 v[84:87], v[236:239], v[100:103], v[84:87]
    ds_read_b64_tr_b16 v[230:231], v5 offset:1312
    s_waitcnt vmcnt(11) lgkmcnt(6)
    v_mfma_f32_16x16x32_bf16 v[24:27], v[240:243], v[104:107], v[24:27]
    ds_read_b64_tr_b16 v[232:233], v4 offset:512
    s_waitcnt vmcnt(10)
    v_mfma_f32_16x16x32_bf16 v[28:31], v[240:243], v[108:111], v[28:31]
    ds_read_b64_tr_b16 v[234:235], v4 offset:1536
    s_waitcnt lgkmcnt(6)
    v_mfma_f32_16x16x32_bf16 v[32:35], v[244:247], v[104:107], v[32:35]
    ds_read_b64_tr_b16 v[236:237], v5 offset:544
    v_mfma_f32_16x16x32_bf16 v[36:39], v[244:247], v[108:111], v[36:39]
    s_add_u32 s22, s19, 0x688000
    s_add_u32 m0, s20, 0xc400
    s_nop 0
    buffer_load_dwordx4 v3, s[4:7], s22 offen lds
    ds_read_b64_tr_b16 v[238:239], v5 offset:1568
    s_mov_b32 s23, 0x6000
    buffer_load_dwordx4 v[88:91], v7, s[8:11], s23 offen offset:0 sc1
    s_waitcnt lgkmcnt(6)
    v_mfma_f32_16x16x32_bf16 v[40:43], v[224:227], v[104:107], v[40:43]
    ds_read_b64_tr_b16 v[240:241], v4 offset:768
    v_mfma_f32_16x16x32_bf16 v[44:47], v[224:227], v[108:111], v[44:47]
    ds_read_b64_tr_b16 v[242:243], v4 offset:1792
    s_waitcnt lgkmcnt(6)
    v_mfma_f32_16x16x32_bf16 v[48:51], v[228:231], v[104:107], v[48:51]
    ds_read_b64_tr_b16 v[244:245], v5 offset:800
    v_mfma_f32_16x16x32_bf16 v[52:55], v[228:231], v[108:111], v[52:55]
    ds_read_b64_tr_b16 v[246:247], v5 offset:1824
    s_waitcnt lgkmcnt(6)
    v_mfma_f32_16x16x32_bf16 v[56:59], v[232:235], v[104:107], v[56:59]
    ds_read_b64_tr_b16 v[224:225], v4 offset:8192
    v_mfma_f32_16x16x32_bf16 v[60:63], v[232:235], v[108:111], v[60:63]
    ds_read_b64_tr_b16 v[226:227], v4 offset:9216
    s_waitcnt lgkmcnt(6)
    v_mfma_f32_16x16x32_bf16 v[64:67], v[236:239], v[104:107], v[64:67]
    ds_read_b64_tr_b16 v[228:229], v5 offset:8224
    v_mfma_f32_16x16x32_bf16 v[68:71], v[236:239], v[108:111], v[68:71]
    ds_read_b64_tr_b16 v[230:231], v5 offset:9248
    s_mov_b32 s23, 0xe000
    buffer_load_dwordx4 v[92:95], v7, s[8:11], s23 offen offset:0 sc1
    s_waitcnt lgkmcnt(6)
    v_mfma_f32_16x16x32_bf16 v[72:75], v[240:243], v[104:107], v[72:75]
    ds_read_b64_tr_b16 v[232:233], v4 offset:8448
    v_mfma_f32_16x16x32_bf16 v[76:79], v[240:243], v[108:111], v[76:79]
    ds_read_b64_tr_b16 v[234:235], v4 offset:9472
    s_waitcnt lgkmcnt(6)
    v_mfma_f32_16x16x32_bf16 v[80:83], v[244:247], v[104:107], v[80:83]
    ds_read_b64_tr_b16 v[236:237], v5 offset:8480
    v_mfma_f32_16x16x32_bf16 v[84:87], v[244:247], v[108:111], v[84:87]
    ds_read_b64_tr_b16 v[238:239], v5 offset:9504
    s_waitcnt vmcnt(12) lgkmcnt(6)
    v_mfma_f32_16x16x32_bf16 v[24:27], v[224:227], v[112:115], v[24:27]
    ds_read_b64_tr_b16 v[240:241], v4 offset:8704
    s_add_u32 s22, s21, 0x0
    s_add_u32 m0, s20, 0x10000
    s_nop 0
    buffer_load_dwordx4 v2, s[8:11], s22 offen sc1 lds
    s_waitcnt vmcnt(11)
    v_mfma_f32_16x16x32_bf16 v[28:31], v[224:227], v[116:119], v[28:31]
    ds_read_b64_tr_b16 v[242:243], v4 offset:9728
    s_waitcnt lgkmcnt(6)
    v_mfma_f32_16x16x32_bf16 v[32:35], v[228:231], v[112:115], v[32:35]
    ds_read_b64_tr_b16 v[244:245], v5 offset:8736
    v_mfma_f32_16x16x32_bf16 v[36:39], v[228:231], v[116:119], v[36:39]
    ds_read_b64_tr_b16 v[246:247], v5 offset:9760
    s_mov_b32 s23, 0x6000
    buffer_load_dwordx4 v[96:99], v7, s[8:11], s23 offen offset:1024 sc1
    s_waitcnt lgkmcnt(6)
    v_mfma_f32_16x16x32_bf16 v[40:43], v[232:235], v[112:115], v[40:43]
    ds_read_b64_tr_b16 v[224:225], v4 offset:8960
    s_add_u32 s22, s21, 0x400
    s_add_u32 m0, s20, 0x10400
    s_nop 0
    buffer_load_dwordx4 v2, s[8:11], s22 offen sc1 lds
    v_mfma_f32_16x16x32_bf16 v[44:47], v[232:235], v[116:119], v[44:47]
    ds_read_b64_tr_b16 v[226:227], v4 offset:9984
    s_waitcnt lgkmcnt(6)
    v_mfma_f32_16x16x32_bf16 v[48:51], v[236:239], v[112:115], v[48:51]
    ds_read_b64_tr_b16 v[228:229], v5 offset:8992
    v_mfma_f32_16x16x32_bf16 v[52:55], v[236:239], v[116:119], v[52:55]
    ds_read_b64_tr_b16 v[230:231], v5 offset:10016
    s_waitcnt lgkmcnt(6)
    v_mfma_f32_16x16x32_bf16 v[56:59], v[240:243], v[112:115], v[56:59]
    v_mfma_f32_16x16x32_bf16 v[60:63], v[240:243], v[116:119], v[60:63]
    s_barrier
    ds_read_b64_tr_b16 v[232:233], v4 offset:16384
    ds_read_b64_tr_b16 v[234:235], v4 offset:17408
    s_waitcnt lgkmcnt(6)
    v_mfma_f32_16x16x32_bf16 v[64:67], v[244:247], v[112:115], v[64:67]
    ds_read_b64_tr_b16 v[236:237], v5 offset:16416
    v_mfma_f32_16x16x32_bf16 v[68:71], v[244:247], v[116:119], v[68:71]
    s_add_u32 s22, s19, 0x700000
    s_add_u32 m0, s20, 0x20000
    s_nop 0
    buffer_load_dwordx4 v3, s[4:7], s22 offen lds
    ds_read_b64_tr_b16 v[238:239], v5 offset:17440
    s_mov_b32 s23, 0xe000
    buffer_load_dwordx4 v[100:103], v7, s[8:11], s23 offen offset:1024 sc1
    s_waitcnt lgkmcnt(6)
    v_mfma_f32_16x16x32_bf16 v[72:75], v[224:227], v[112:115], v[72:75]
    ds_read_b64_tr_b16 v[240:241], v4 offset:16640
    v_mfma_f32_16x16x32_bf16 v[76:79], v[224:227], v[116:119], v[76:79]
    ds_read_b64_tr_b16 v[242:243], v4 offset:17664
    s_waitcnt lgkmcnt(6)
    v_mfma_f32_16x16x32_bf16 v[80:83], v[228:231], v[112:115], v[80:83]
    ds_read_b64_tr_b16 v[244:245], v5 offset:16672
    v_mfma_f32_16x16x32_bf16 v[84:87], v[228:231], v[116:119], v[84:87]
    ds_read_b64_tr_b16 v[246:247], v5 offset:17696
    s_waitcnt vmcnt(13) lgkmcnt(6)
    v_mfma_f32_16x16x32_bf16 v[24:27], v[232:235], v[120:123], v[24:27]
    ds_read_b64_tr_b16 v[224:225], v4 offset:16896
    s_waitcnt vmcnt(12)
    v_mfma_f32_16x16x32_bf16 v[28:31], v[232:235], v[124:127], v[28:31]
    ds_read_b64_tr_b16 v[226:227], v4 offset:17920
    s_waitcnt lgkmcnt(6)
    v_mfma_f32_16x16x32_bf16 v[32:35], v[236:239], v[120:123], v[32:35]
    ds_read_b64_tr_b16 v[228:229], v5 offset:16928
    v_mfma_f32_16x16x32_bf16 v[36:39], v[236:239], v[124:127], v[36:39]
    s_add_u32 s22, s19, 0x708000
    s_add_u32 m0, s20, 0x20400
    s_nop 0
    buffer_load_dwordx4 v3, s[4:7], s22 offen lds
    ds_read_b64_tr_b16 v[230:231], v5 offset:17952
    s_mov_b32 s23, 0x6800
    buffer_load_dwordx4 v[104:107], v7, s[8:11], s23 offen offset:0 sc1
    s_waitcnt lgkmcnt(6)
    v_mfma_f32_16x16x32_bf16 v[40:43], v[240:243], v[120:123], v[40:43]
    ds_read_b64_tr_b16 v[232:233], v4 offset:17152
    v_mfma_f32_16x16x32_bf16 v[44:47], v[240:243], v[124:127], v[44:47]
    ds_read_b64_tr_b16 v[234:235], v4 offset:18176
    s_waitcnt lgkmcnt(6)
    v_mfma_f32_16x16x32_bf16 v[48:51], v[244:247], v[120:123], v[48:51]
    ds_read_b64_tr_b16 v[236:237], v5 offset:17184
    v_mfma_f32_16x16x32_bf16 v[52:55], v[244:247], v[124:127], v[52:55]
    ds_read_b64_tr_b16 v[238:239], v5 offset:18208
    s_waitcnt lgkmcnt(6)
    v_mfma_f32_16x16x32_bf16 v[56:59], v[224:227], v[120:123], v[56:59]
    ds_read_b64_tr_b16 v[240:241], v4 offset:24576
    v_mfma_f32_16x16x32_bf16 v[60:63], v[224:227], v[124:127], v[60:63]
    ds_read_b64_tr_b16 v[242:243], v4 offset:25600
    s_waitcnt lgkmcnt(6)
    v_mfma_f32_16x16x32_bf16 v[64:67], v[228:231], v[120:123], v[64:67]
    ds_read_b64_tr_b16 v[244:245], v5 offset:24608
    v_mfma_f32_16x16x32_bf16 v[68:71], v[228:231], v[124:127], v[68:71]
    ds_read_b64_tr_b16 v[246:247], v5 offset:25632
    s_mov_b32 s23, 0xe800
    buffer_load_dwordx4 v[108:111], v7, s[8:11], s23 offen offset:0 sc1
    s_waitcnt lgkmcnt(6)
    v_mfma_f32_16x16x32_bf16 v[72:75], v[232:235], v[120:123], v[72:75]
    ds_read_b64_tr_b16 v[224:225], v4 offset:24832
    v_mfma_f32_16x16x32_bf16 v[76:79], v[232:235], v[124:127], v[76:79]
    ds_read_b64_tr_b16 v[226:227], v4 offset:25856
    s_waitcnt lgkmcnt(6)
    v_mfma_f32_16x16x32_bf16 v[80:83], v[236:239], v[120:123], v[80:83]
    ds_read_b64_tr_b16 v[228:229], v5 offset:24864
    v_mfma_f32_16x16x32_bf16 v[84:87], v[236:239], v[124:127], v[84:87]
    ds_read_b64_tr_b16 v[230:231], v5 offset:25888
    s_waitcnt vmcnt(13) lgkmcnt(6)
    v_mfma_f32_16x16x32_bf16 v[24:27], v[240:243], v[128:131], v[24:27]
    ds_read_b64_tr_b16 v[232:233], v4 offset:25088
    s_add_u32 s22, s21, 0x4000
    s_add_u32 m0, s20, 0x14000
    s_nop 0
    buffer_load_dwordx4 v2, s[8:11], s22 offen sc1 lds
    s_waitcnt vmcnt(12)
    v_mfma_f32_16x16x32_bf16 v[28:31], v[240:243], v[132:135], v[28:31]
    ds_read_b64_tr_b16 v[234:235], v4 offset:26112
    s_waitcnt lgkmcnt(6)
    v_mfma_f32_16x16x32_bf16 v[32:35], v[244:247], v[128:131], v[32:35]
    ds_read_b64_tr_b16 v[236:237], v5 offset:25120
    v_mfma_f32_16x16x32_bf16 v[36:39], v[244:247], v[132:135], v[36:39]
    ds_read_b64_tr_b16 v[238:239], v5 offset:26144
    s_mov_b32 s23, 0x6800
    buffer_load_dwordx4 v[112:115], v7, s[8:11], s23 offen offset:1024 sc1
    s_waitcnt lgkmcnt(6)
    v_mfma_f32_16x16x32_bf16 v[40:43], v[224:227], v[128:131], v[40:43]
    ds_read_b64_tr_b16 v[240:241], v4 offset:25344
    s_add_u32 s22, s21, 0x4400
    s_add_u32 m0, s20, 0x14400
    s_nop 0
    buffer_load_dwordx4 v2, s[8:11], s22 offen sc1 lds
    v_mfma_f32_16x16x32_bf16 v[44:47], v[224:227], v[132:135], v[44:47]
    ds_read_b64_tr_b16 v[242:243], v4 offset:26368
    s_waitcnt lgkmcnt(6)
    v_mfma_f32_16x16x32_bf16 v[48:51], v[228:231], v[128:131], v[48:51]
    ds_read_b64_tr_b16 v[244:245], v5 offset:25376
    v_mfma_f32_16x16x32_bf16 v[52:55], v[228:231], v[132:135], v[52:55]
    ds_read_b64_tr_b16 v[246:247], v5 offset:26400
    s_waitcnt lgkmcnt(6)
    v_mfma_f32_16x16x32_bf16 v[56:59], v[232:235], v[128:131], v[56:59]
    v_mfma_f32_16x16x32_bf16 v[60:63], v[232:235], v[132:135], v[60:63]
    s_barrier
    ds_read_b64_tr_b16 v[224:225], v4 offset:32768
    ds_read_b64_tr_b16 v[226:227], v4 offset:33792
    s_waitcnt lgkmcnt(6)
    v_mfma_f32_16x16x32_bf16 v[64:67], v[236:239], v[128:131], v[64:67]
    ds_read_b64_tr_b16 v[228:229], v5 offset:32800
    v_mfma_f32_16x16x32_bf16 v[68:71], v[236:239], v[132:135], v[68:71]
    s_add_u32 s22, s19, 0x780000
    s_add_u32 m0, s20, 0x0
    s_nop 0
    buffer_load_dwordx4 v3, s[4:7], s22 offen lds
    ds_read_b64_tr_b16 v[230:231], v5 offset:33824
    s_mov_b32 s23, 0xe800
    buffer_load_dwordx4 v[116:119], v7, s[8:11], s23 offen offset:1024 sc1
    s_waitcnt lgkmcnt(6)
    v_mfma_f32_16x16x32_bf16 v[72:75], v[240:243], v[128:131], v[72:75]
    ds_read_b64_tr_b16 v[232:233], v4 offset:33024
    v_mfma_f32_16x16x32_bf16 v[76:79], v[240:243], v[132:135], v[76:79]
    ds_read_b64_tr_b16 v[234:235], v4 offset:34048
    s_waitcnt lgkmcnt(6)
    v_mfma_f32_16x16x32_bf16 v[80:83], v[244:247], v[128:131], v[80:83]
    ds_read_b64_tr_b16 v[236:237], v5 offset:33056
    v_mfma_f32_16x16x32_bf16 v[84:87], v[244:247], v[132:135], v[84:87]
    ds_read_b64_tr_b16 v[238:239], v5 offset:34080
    s_waitcnt vmcnt(14) lgkmcnt(6)
    v_mfma_f32_16x16x32_bf16 v[24:27], v[224:227], v[88:91], v[24:27]
    ds_read_b64_tr_b16 v[240:241], v4 offset:33280
    s_waitcnt vmcnt(13)
    v_mfma_f32_16x16x32_bf16 v[28:31], v[224:227], v[92:95], v[28:31]
    ds_read_b64_tr_b16 v[242:243], v4 offset:34304
    s_waitcnt lgkmcnt(6)
    v_mfma_f32_16x16x32_bf16 v[32:35], v[228:231], v[88:91], v[32:35]
    ds_read_b64_tr_b16 v[244:245], v5 offset:33312
    v_mfma_f32_16x16x32_bf16 v[36:39], v[228:231], v[92:95], v[36:39]
    s_add_u32 s22, s19, 0x788000
    s_add_u32 m0, s20, 0x400
    s_nop 0
    buffer_load_dwordx4 v3, s[4:7], s22 offen lds
    ds_read_b64_tr_b16 v[246:247], v5 offset:34336
    s_mov_b32 s23, 0x7000
    buffer_load_dwordx4 v[120:123], v7, s[8:11], s23 offen offset:0 sc1
    s_waitcnt lgkmcnt(6)
    v_mfma_f32_16x16x32_bf16 v[40:43], v[232:235], v[88:91], v[40:43]
    ds_read_b64_tr_b16 v[224:225], v4 offset:33536
    v_mfma_f32_16x16x32_bf16 v[44:47], v[232:235], v[92:95], v[44:47]
    ds_read_b64_tr_b16 v[226:227], v4 offset:34560
    s_waitcnt lgkmcnt(6)
    v_mfma_f32_16x16x32_bf16 v[48:51], v[236:239], v[88:91], v[48:51]
    ds_read_b64_tr_b16 v[228:229], v5 offset:33568
    v_mfma_f32_16x16x32_bf16 v[52:55], v[236:239], v[92:95], v[52:55]
    ds_read_b64_tr_b16 v[230:231], v5 offset:34592
    s_waitcnt lgkmcnt(6)
    v_mfma_f32_16x16x32_bf16 v[56:59], v[240:243], v[88:91], v[56:59]
    ds_read_b64_tr_b16 v[232:233], v4 offset:40960
    v_mfma_f32_16x16x32_bf16 v[60:63], v[240:243], v[92:95], v[60:63]
    ds_read_b64_tr_b16 v[234:235], v4 offset:41984
    s_waitcnt lgkmcnt(6)
    v_mfma_f32_16x16x32_bf16 v[64:67], v[244:247], v[88:91], v[64:67]
    ds_read_b64_tr_b16 v[236:237], v5 offset:40992
    v_mfma_f32_16x16x32_bf16 v[68:71], v[244:247], v[92:95], v[68:71]
    ds_read_b64_tr_b16 v[238:239], v5 offset:42016
    s_mov_b32 s23, 0xf000
    buffer_load_dwordx4 v[124:127], v7, s[8:11], s23 offen offset:0 sc1
    s_waitcnt lgkmcnt(6)
    v_mfma_f32_16x16x32_bf16 v[72:75], v[224:227], v[88:91], v[72:75]
    ds_read_b64_tr_b16 v[240:241], v4 offset:41216
    v_mfma_f32_16x16x32_bf16 v[76:79], v[224:227], v[92:95], v[76:79]
    ds_read_b64_tr_b16 v[242:243], v4 offset:42240
    s_waitcnt lgkmcnt(6)
    v_mfma_f32_16x16x32_bf16 v[80:83], v[228:231], v[88:91], v[80:83]
    ds_read_b64_tr_b16 v[244:245], v5 offset:41248
    v_mfma_f32_16x16x32_bf16 v[84:87], v[228:231], v[92:95], v[84:87]
    ds_read_b64_tr_b16 v[246:247], v5 offset:42272
    s_waitcnt vmcnt(14) lgkmcnt(6)
    v_mfma_f32_16x16x32_bf16 v[24:27], v[232:235], v[96:99], v[24:27]
    ds_read_b64_tr_b16 v[224:225], v4 offset:41472
    s_add_u32 s22, s21, 0x8000
    s_add_u32 m0, s20, 0x18000
    s_nop 0
    buffer_load_dwordx4 v2, s[8:11], s22 offen sc1 lds
    s_waitcnt vmcnt(12)
    v_mfma_f32_16x16x32_bf16 v[28:31], v[232:235], v[100:103], v[28:31]
    ds_read_b64_tr_b16 v[226:227], v4 offset:42496
    s_waitcnt lgkmcnt(6)
    v_mfma_f32_16x16x32_bf16 v[32:35], v[236:239], v[96:99], v[32:35]
    ds_read_b64_tr_b16 v[228:229], v5 offset:41504
    v_mfma_f32_16x16x32_bf16 v[36:39], v[236:239], v[100:103], v[36:39]
    ds_read_b64_tr_b16 v[230:231], v5 offset:42528
    s_mov_b32 s23, 0x7000
    buffer_load_dwordx4 v[128:131], v7, s[8:11], s23 offen offset:1024 sc1
    s_waitcnt lgkmcnt(6)
    v_mfma_f32_16x16x32_bf16 v[40:43], v[240:243], v[96:99], v[40:43]
    ds_read_b64_tr_b16 v[232:233], v4 offset:41728
    s_add_u32 s22, s21, 0x8400
    s_add_u32 m0, s20, 0x18400
    s_nop 0
    buffer_load_dwordx4 v2, s[8:11], s22 offen sc1 lds
    v_mfma_f32_16x16x32_bf16 v[44:47], v[240:243], v[100:103], v[44:47]
    ds_read_b64_tr_b16 v[234:235], v4 offset:42752
    s_waitcnt lgkmcnt(6)
    v_mfma_f32_16x16x32_bf16 v[48:51], v[244:247], v[96:99], v[48:51]
    ds_read_b64_tr_b16 v[236:237], v5 offset:41760
    v_mfma_f32_16x16x32_bf16 v[52:55], v[244:247], v[100:103], v[52:55]
    ds_read_b64_tr_b16 v[238:239], v5 offset:42784
    s_waitcnt lgkmcnt(6)
    v_mfma_f32_16x16x32_bf16 v[56:59], v[224:227], v[96:99], v[56:59]
    v_mfma_f32_16x16x32_bf16 v[60:63], v[224:227], v[100:103], v[60:63]
    s_barrier
    ds_read_b64_tr_b16 v[240:241], v4 offset:49152
    ds_read_b64_tr_b16 v[242:243], v4 offset:50176
    s_waitcnt lgkmcnt(6)
    v_mfma_f32_16x16x32_bf16 v[64:67], v[228:231], v[96:99], v[64:67]
    ds_read_b64_tr_b16 v[244:245], v5 offset:49184
    v_mfma_f32_16x16x32_bf16 v[68:71], v[228:231], v[100:103], v[68:71]
    ds_read_b64_tr_b16 v[246:247], v5 offset:50208
    s_mov_b32 s23, 0xf000
    buffer_load_dwordx4 v[132:135], v7, s[8:11], s23 offen offset:1024 sc1
    s_waitcnt lgkmcnt(6)
    v_mfma_f32_16x16x32_bf16 v[72:75], v[232:235], v[96:99], v[72:75]
    ds_read_b64_tr_b16 v[224:225], v4 offset:49408
    v_mfma_f32_16x16x32_bf16 v[76:79], v[232:235], v[100:103], v[76:79]
    ds_read_b64_tr_b16 v[226:227], v4 offset:50432
    s_waitcnt lgkmcnt(6)
    v_mfma_f32_16x16x32_bf16 v[80:83], v[236:239], v[96:99], v[80:83]
    ds_read_b64_tr_b16 v[228:229], v5 offset:49440
    v_mfma_f32_16x16x32_bf16 v[84:87], v[236:239], v[100:103], v[84:87]
    ds_read_b64_tr_b16 v[230:231], v5 offset:50464
    s_waitcnt vmcnt(13) lgkmcnt(6)
    v_mfma_f32_16x16x32_bf16 v[24:27], v[240:243], v[104:107], v[24:27]
    ds_read_b64_tr_b16 v[232:233], v4 offset:49664
    s_waitcnt vmcnt(12)
    v_mfma_f32_16x16x32_bf16 v[28:31], v[240:243], v[108:111], v[28:31]
    ds_read_b64_tr_b16 v[234:235], v4 offset:50688
    s_waitcnt lgkmcnt(6)
    v_mfma_f32_16x16x32_bf16 v[32:35], v[244:247], v[104:107], v[32:35]
    ds_read_b64_tr_b16 v[236:237], v5 offset:49696
    v_mfma_f32_16x16x32_bf16 v[36:39], v[244:247], v[108:111], v[36:39]
    ds_read_b64_tr_b16 v[238:239], v5 offset:50720
    s_mov_b32 s23, 0x7800
    buffer_load_dwordx4 v[88:91], v7, s[8:11], s23 offen offset:0 sc1
    s_waitcnt lgkmcnt(6)
    v_mfma_f32_16x16x32_bf16 v[40:43], v[224:227], v[104:107], v[40:43]
    ds_read_b64_tr_b16 v[240:241], v4 offset:49920
    v_mfma_f32_16x16x32_bf16 v[44:47], v[224:227], v[108:111], v[44:47]
    ds_read_b64_tr_b16 v[242:243], v4 offset:50944
    s_waitcnt lgkmcnt(6)
    v_mfma_f32_16x16x32_bf16 v[48:51], v[228:231], v[104:107], v[48:51]
    ds_read_b64_tr_b16 v[244:245], v5 offset:49952
    v_mfma_f32_16x16x32_bf16 v[52:55], v[228:231], v[108:111], v[52:55]
    ds_read_b64_tr_b16 v[246:247], v5 offset:50976
    s_waitcnt lgkmcnt(6)
    v_mfma_f32_16x16x32_bf16 v[56:59], v[232:235], v[104:107], v[56:59]
    ds_read_b64_tr_b16 v[224:225], v4 offset:57344
    v_mfma_f32_16x16x32_bf16 v[60:63], v[232:235], v[108:111], v[60:63]
    ds_read_b64_tr_b16 v[226:227], v4 offset:58368
    s_waitcnt lgkmcnt(6)
    v_mfma_f32_16x16x32_bf16 v[64:67], v[236:239], v[104:107], v[64:67]
    ds_read_b64_tr_b16 v[228:229], v5 offset:57376
    v_mfma_f32_16x16x32_bf16 v[68:71], v[236:239], v[108:111], v[68:71]
    ds_read_b64_tr_b16 v[230:231], v5 offset:58400
    s_mov_b32 s23, 0xf800
    buffer_load_dwordx4 v[92:95], v7, s[8:11], s23 offen offset:0 sc1
    s_waitcnt lgkmcnt(6)
    v_mfma_f32_16x16x32_bf16 v[72:75], v[240:243], v[104:107], v[72:75]
    ds_read_b64_tr_b16 v[232:233], v4 offset:57600
    v_mfma_f32_16x16x32_bf16 v[76:79], v[240:243], v[108:111], v[76:79]
    ds_read_b64_tr_b16 v[234:235], v4 offset:58624
    s_waitcnt lgkmcnt(6)
    v_mfma_f32_16x16x32_bf16 v[80:83], v[244:247], v[104:107], v[80:83]
    ds_read_b64_tr_b16 v[236:237], v5 offset:57632
    v_mfma_f32_16x16x32_bf16 v[84:87], v[244:247], v[108:111], v[84:87]
    ds_read_b64_tr_b16 v[238:239], v5 offset:58656
    s_waitcnt vmcnt(12) lgkmcnt(6)
    v_mfma_f32_16x16x32_bf16 v[24:27], v[224:227], v[112:115], v[24:27]
    ds_read_b64_tr_b16 v[240:241], v4 offset:57856
    s_add_u32 s22, s21, 0xc000
    s_add_u32 m0, s20, 0x1c000
    s_nop 0
    buffer_load_dwordx4 v2, s[8:11], s22 offen sc1 lds
    s_waitcnt vmcnt(10)
    v_mfma_f32_16x16x32_bf16 v[28:31], v[224:227], v[116:119], v[28:31]
    ds_read_b64_tr_b16 v[242:243], v4 offset:58880
    s_waitcnt lgkmcnt(6)
    v_mfma_f32_16x16x32_bf16 v[32:35], v[228:231], v[112:115], v[32:35]
    ds_read_b64_tr_b16 v[244:245], v5 offset:57888
    v_mfma_f32_16x16x32_bf16 v[36:39], v[228:231], v[116:119], v[36:39]
    ds_read_b64_tr_b16 v[246:247], v5 offset:58912
    s_mov_b32 s23, 0x7800
    buffer_load_dwordx4 v[96:99], v7, s[8:11], s23 offen offset:1024 sc1
    s_waitcnt lgkmcnt(6)
    v_mfma_f32_16x16x32_bf16 v[40:43], v[232:235], v[112:115], v[40:43]
    ds_read_b64_tr_b16 v[224:225], v4 offset:58112
    s_add_u32 s22, s21, 0xc400
    s_add_u32 m0, s20, 0x1c400
    s_nop 0
    buffer_load_dwordx4 v2, s[8:11], s22 offen sc1 lds
    v_mfma_f32_16x16x32_bf16 v[44:47], v[232:235], v[116:119], v[44:47]
    ds_read_b64_tr_b16 v[226:227], v4 offset:59136
    s_waitcnt lgkmcnt(6)
    v_mfma_f32_16x16x32_bf16 v[48:51], v[236:239], v[112:115], v[48:51]
    ds_read_b64_tr_b16 v[228:229], v5 offset:58144
    v_mfma_f32_16x16x32_bf16 v[52:55], v[236:239], v[116:119], v[52:55]
    ds_read_b64_tr_b16 v[230:231], v5 offset:59168
    s_waitcnt lgkmcnt(6)
    v_mfma_f32_16x16x32_bf16 v[56:59], v[240:243], v[112:115], v[56:59]
    v_mfma_f32_16x16x32_bf16 v[60:63], v[240:243], v[116:119], v[60:63]
    s_barrier
    ds_read_b64_tr_b16 v[232:233], v11 offset:0
    ds_read_b64_tr_b16 v[234:235], v11 offset:1024
    s_waitcnt lgkmcnt(6)
    v_mfma_f32_16x16x32_bf16 v[64:67], v[244:247], v[112:115], v[64:67]
    ds_read_b64_tr_b16 v[236:237], v6 offset:32
    v_mfma_f32_16x16x32_bf16 v[68:71], v[244:247], v[116:119], v[68:71]
    ds_read_b64_tr_b16 v[238:239], v6 offset:1056
    s_mov_b32 s23, 0xf800
    buffer_load_dwordx4 v[100:103], v7, s[8:11], s23 offen offset:1024 sc1
    s_waitcnt lgkmcnt(6)
    v_mfma_f32_16x16x32_bf16 v[72:75], v[224:227], v[112:115], v[72:75]
    ds_read_b64_tr_b16 v[240:241], v11 offset:256
    v_mfma_f32_16x16x32_bf16 v[76:79], v[224:227], v[116:119], v[76:79]
    ds_read_b64_tr_b16 v[242:243], v11 offset:1280
    s_waitcnt lgkmcnt(6)
    v_mfma_f32_16x16x32_bf16 v[80:83], v[228:231], v[112:115], v[80:83]
    ds_read_b64_tr_b16 v[244:245], v6 offset:288
    v_mfma_f32_16x16x32_bf16 v[84:87], v[228:231], v[116:119], v[84:87]
    ds_read_b64_tr_b16 v[246:247], v6 offset:1312
    s_waitcnt vmcnt(11) lgkmcnt(6)
    v_mfma_f32_16x16x32_bf16 v[24:27], v[232:235], v[120:123], v[24:27]
    ds_read_b64_tr_b16 v[224:225], v11 offset:512
    s_waitcnt vmcnt(10)
    v_mfma_f32_16x16x32_bf16 v[28:31], v[232:235], v[124:127], v[28:31]
    ds_read_b64_tr_b16 v[226:227], v11 offset:1536
    s_waitcnt lgkmcnt(6)
    v_mfma_f32_16x16x32_bf16 v[32:35], v[236:239], v[120:123], v[32:35]
    ds_read_b64_tr_b16 v[228:229], v6 offset:544
    v_mfma_f32_16x16x32_bf16 v[36:39], v[236:239], v[124:127], v[36:39]
    ds_read_b64_tr_b16 v[230:231], v6 offset:1568
    s_waitcnt lgkmcnt(6)
    v_mfma_f32_16x16x32_bf16 v[40:43], v[240:243], v[120:123], v[40:43]
    ds_read_b64_tr_b16 v[232:233], v11 offset:768
    v_mfma_f32_16x16x32_bf16 v[44:47], v[240:243], v[124:127], v[44:47]
    ds_read_b64_tr_b16 v[234:235], v11 offset:1792
    s_waitcnt lgkmcnt(6)
    v_mfma_f32_16x16x32_bf16 v[48:51], v[244:247], v[120:123], v[48:51]
    ds_read_b64_tr_b16 v[236:237], v6 offset:800
    v_mfma_f32_16x16x32_bf16 v[52:55], v[244:247], v[124:127], v[52:55]
    ds_read_b64_tr_b16 v[238:239], v6 offset:1824
    s_waitcnt lgkmcnt(6)
    v_mfma_f32_16x16x32_bf16 v[56:59], v[224:227], v[120:123], v[56:59]
    ds_read_b64_tr_b16 v[240:241], v11 offset:8192
    v_mfma_f32_16x16x32_bf16 v[60:63], v[224:227], v[124:127], v[60:63]
    ds_read_b64_tr_b16 v[242:243], v11 offset:9216
    s_waitcnt lgkmcnt(6)
    v_mfma_f32_16x16x32_bf16 v[64:67], v[228:231], v[120:123], v[64:67]
    ds_read_b64_tr_b16 v[244:245], v6 offset:8224
    v_mfma_f32_16x16x32_bf16 v[68:71], v[228:231], v[124:127], v[68:71]
    ds_read_b64_tr_b16 v[246:247], v6 offset:9248
    s_waitcnt lgkmcnt(6)
    v_mfma_f32_16x16x32_bf16 v[72:75], v[232:235], v[120:123], v[72:75]
    ds_read_b64_tr_b16 v[224:225], v11 offset:8448
    v_mfma_f32_16x16x32_bf16 v[76:79], v[232:235], v[124:127], v[76:79]
    ds_read_b64_tr_b16 v[226:227], v11 offset:9472
    s_waitcnt lgkmcnt(6)
    v_mfma_f32_16x16x32_bf16 v[80:83], v[236:239], v[120:123], v[80:83]
    ds_read_b64_tr_b16 v[228:229], v6 offset:8480
    v_mfma_f32_16x16x32_bf16 v[84:87], v[236:239], v[124:127], v[84:87]
    ds_read_b64_tr_b16 v[230:231], v6 offset:9504
    s_waitcnt vmcnt(8) lgkmcnt(6)
    v_mfma_f32_16x16x32_bf16 v[24:27], v[240:243], v[128:131], v[24:27]
    ds_read_b64_tr_b16 v[232:233], v11 offset:8704
    s_waitcnt vmcnt(6)
    v_mfma_f32_16x16x32_bf16 v[28:31], v[240:243], v[132:135], v[28:31]
    ds_read_b64_tr_b16 v[234:235], v11 offset:9728
    s_waitcnt lgkmcnt(6)
    v_mfma_f32_16x16x32_bf16 v[32:35], v[244:247], v[128:131], v[32:35]
    ds_read_b64_tr_b16 v[236:237], v6 offset:8736
    v_mfma_f32_16x16x32_bf16 v[36:39], v[244:247], v[132:135], v[36:39]
    ds_read_b64_tr_b16 v[238:239], v6 offset:9760
    s_waitcnt lgkmcnt(6)
    v_mfma_f32_16x16x32_bf16 v[40:43], v[224:227], v[128:131], v[40:43]
    ds_read_b64_tr_b16 v[240:241], v11 offset:8960
    v_mfma_f32_16x16x32_bf16 v[44:47], v[224:227], v[132:135], v[44:47]
    ds_read_b64_tr_b16 v[242:243], v11 offset:9984
    s_waitcnt lgkmcnt(6)
    v_mfma_f32_16x16x32_bf16 v[48:51], v[228:231], v[128:131], v[48:51]
    ds_read_b64_tr_b16 v[244:245], v6 offset:8992
    v_mfma_f32_16x16x32_bf16 v[52:55], v[228:231], v[132:135], v[52:55]
    ds_read_b64_tr_b16 v[246:247], v6 offset:10016
    s_waitcnt lgkmcnt(6)
    v_mfma_f32_16x16x32_bf16 v[56:59], v[232:235], v[128:131], v[56:59]
    v_mfma_f32_16x16x32_bf16 v[60:63], v[232:235], v[132:135], v[60:63]
    s_barrier
    ds_read_b64_tr_b16 v[224:225], v4 offset:0
    ds_read_b64_tr_b16 v[226:227], v4 offset:1024
    s_waitcnt lgkmcnt(6)
    v_mfma_f32_16x16x32_bf16 v[64:67], v[236:239], v[128:131], v[64:67]
    ds_read_b64_tr_b16 v[228:229], v5 offset:32
    v_mfma_f32_16x16x32_bf16 v[68:71], v[236:239], v[132:135], v[68:71]
    ds_read_b64_tr_b16 v[230:231], v5 offset:1056
    s_waitcnt lgkmcnt(6)
    v_mfma_f32_16x16x32_bf16 v[72:75], v[240:243], v[128:131], v[72:75]
    ds_read_b64_tr_b16 v[232:233], v4 offset:256
    v_mfma_f32_16x16x32_bf16 v[76:79], v[240:243], v[132:135], v[76:79]
    ds_read_b64_tr_b16 v[234:235], v4 offset:1280
    s_waitcnt lgkmcnt(6)
    v_mfma_f32_16x16x32_bf16 v[80:83], v[244:247], v[128:131], v[80:83]
    ds_read_b64_tr_b16 v[236:237], v5 offset:288
    v_mfma_f32_16x16x32_bf16 v[84:87], v[244:247], v[132:135], v[84:87]
    ds_read_b64_tr_b16 v[238:239], v5 offset:1312
    s_waitcnt vmcnt(5) lgkmcnt(6)
    v_mfma_f32_16x16x32_bf16 v[24:27], v[224:227], v[88:91], v[24:27]
    ds_read_b64_tr_b16 v[240:241], v4 offset:512
    s_waitcnt vmcnt(4)
    v_mfma_f32_16x16x32_bf16 v[28:31], v[224:227], v[92:95], v[28:31]
    ds_read_b64_tr_b16 v[242:243], v4 offset:1536
    s_waitcnt lgkmcnt(6)
    v_mfma_f32_16x16x32_bf16 v[32:35], v[228:231], v[88:91], v[32:35]
    ds_read_b64_tr_b16 v[244:245], v5 offset:544
    v_mfma_f32_16x16x32_bf16 v[36:39], v[228:231], v[92:95], v[36:39]
    ds_read_b64_tr_b16 v[246:247], v5 offset:1568
    s_waitcnt lgkmcnt(6)
    v_mfma_f32_16x16x32_bf16 v[40:43], v[232:235], v[88:91], v[40:43]
    ds_read_b64_tr_b16 v[224:225], v4 offset:768
    v_mfma_f32_16x16x32_bf16 v[44:47], v[232:235], v[92:95], v[44:47]
    ds_read_b64_tr_b16 v[226:227], v4 offset:1792
    s_waitcnt lgkmcnt(6)
    v_mfma_f32_16x16x32_bf16 v[48:51], v[236:239], v[88:91], v[48:51]
    ds_read_b64_tr_b16 v[228:229], v5 offset:800
    v_mfma_f32_16x16x32_bf16 v[52:55], v[236:239], v[92:95], v[52:55]
    ds_read_b64_tr_b16 v[230:231], v5 offset:1824
    s_waitcnt lgkmcnt(6)
    v_mfma_f32_16x16x32_bf16 v[56:59], v[240:243], v[88:91], v[56:59]
    ds_read_b64_tr_b16 v[232:233], v4 offset:8192
    v_mfma_f32_16x16x32_bf16 v[60:63], v[240:243], v[92:95], v[60:63]
    ds_read_b64_tr_b16 v[234:235], v4 offset:9216
    s_waitcnt lgkmcnt(6)
    v_mfma_f32_16x16x32_bf16 v[64:67], v[244:247], v[88:91], v[64:67]
    ds_read_b64_tr_b16 v[236:237], v5 offset:8224
    v_mfma_f32_16x16x32_bf16 v[68:71], v[244:247], v[92:95], v[68:71]
    ds_read_b64_tr_b16 v[238:239], v5 offset:9248
    s_waitcnt lgkmcnt(6)
    v_mfma_f32_16x16x32_bf16 v[72:75], v[224:227], v[88:91], v[72:75]
    ds_read_b64_tr_b16 v[240:241], v4 offset:8448
    v_mfma_f32_16x16x32_bf16 v[76:79], v[224:227], v[92:95], v[76:79]
    ds_read_b64_tr_b16 v[242:243], v4 offset:9472
    s_waitcnt lgkmcnt(6)
    v_mfma_f32_16x16x32_bf16 v[80:83], v[228:231], v[88:91], v[80:83]
    ds_read_b64_tr_b16 v[244:245], v5 offset:8480
    v_mfma_f32_16x16x32_bf16 v[84:87], v[228:231], v[92:95], v[84:87]
    ds_read_b64_tr_b16 v[246:247], v5 offset:9504
    s_waitcnt vmcnt(2) lgkmcnt(6)
    v_mfma_f32_16x16x32_bf16 v[24:27], v[232:235], v[96:99], v[24:27]
    ds_read_b64_tr_b16 v[224:225], v4 offset:8704
    s_waitcnt vmcnt(0)
    v_mfma_f32_16x16x32_bf16 v[28:31], v[232:235], v[100:103], v[28:31]
    ds_read_b64_tr_b16 v[226:227], v4 offset:9728
    s_waitcnt lgkmcnt(6)
    v_mfma_f32_16x16x32_bf16 v[32:35], v[236:239], v[96:99], v[32:35]
    ds_read_b64_tr_b16 v[228:229], v5 offset:8736
    v_mfma_f32_16x16x32_bf16 v[36:39], v[236:239], v[100:103], v[36:39]
    ds_read_b64_tr_b16 v[230:231], v5 offset:9760
    s_waitcnt lgkmcnt(6)
    v_mfma_f32_16x16x32_bf16 v[40:43], v[240:243], v[96:99], v[40:43]
    ds_read_b64_tr_b16 v[232:233], v4 offset:8960
    v_mfma_f32_16x16x32_bf16 v[44:47], v[240:243], v[100:103], v[44:47]
    ds_read_b64_tr_b16 v[234:235], v4 offset:9984
    s_waitcnt lgkmcnt(6)
    v_mfma_f32_16x16x32_bf16 v[48:51], v[244:247], v[96:99], v[48:51]
    ds_read_b64_tr_b16 v[236:237], v5 offset:8992
    v_mfma_f32_16x16x32_bf16 v[52:55], v[244:247], v[100:103], v[52:55]
    ds_read_b64_tr_b16 v[238:239], v5 offset:10016
    s_waitcnt lgkmcnt(6)
    v_mfma_f32_16x16x32_bf16 v[56:59], v[224:227], v[96:99], v[56:59]
    v_mfma_f32_16x16x32_bf16 v[60:63], v[224:227], v[100:103], v[60:63]
    s_waitcnt lgkmcnt(4)
    v_mfma_f32_16x16x32_bf16 v[64:67], v[228:231], v[96:99], v[64:67]
    v_mfma_f32_16x16x32_bf16 v[68:71], v[228:231], v[100:103], v[68:71]
    s_waitcnt lgkmcnt(2)
    v_mfma_f32_16x16x32_bf16 v[72:75], v[232:235], v[96:99], v[72:75]
    v_mfma_f32_16x16x32_bf16 v[76:79], v[232:235], v[100:103], v[76:79]
    s_waitcnt lgkmcnt(0)
    v_mfma_f32_16x16x32_bf16 v[80:83], v[236:239], v[96:99], v[80:83]
    v_mfma_f32_16x16x32_bf16 v[84:87], v[236:239], v[100:103], v[84:87]
    s_mov_b32 s23, 0x3e0293ee
    v_mul_f32 v16, s23, v24
    v_mul_f32 v17, s23, v25
    v_cvt_pk_bf16_f32 v152, v16, v17
    v_mul_f32 v18, s23, v26
    v_mul_f32 v19, s23, v27
    v_cvt_pk_bf16_f32 v153, v18, v19
    v_mul_f32 v16, s23, v28
    v_mul_f32 v17, s23, v29
    v_cvt_pk_bf16_f32 v168, v16, v17
    v_mul_f32 v18, s23, v30
    v_mul_f32 v19, s23, v31
    v_cvt_pk_bf16_f32 v169, v18, v19
    v_mul_f32 v16, s23, v32
    v_mul_f32 v17, s23, v33
    v_cvt_pk_bf16_f32 v154, v16, v17
    v_mul_f32 v18, s23, v34
    v_mul_f32 v19, s23, v35
    v_cvt_pk_bf16_f32 v155, v18, v19
    v_mul_f32 v16, s23, v36
    v_mul_f32 v17, s23, v37
    v_cvt_pk_bf16_f32 v170, v16, v17
    v_mul_f32 v18, s23, v38
    v_mul_f32 v19, s23, v39
    v_cvt_pk_bf16_f32 v171, v18, v19
    v_mul_f32 v16, s23, v40
    v_mul_f32 v17, s23, v41
    v_cvt_pk_bf16_f32 v156, v16, v17
    v_mul_f32 v18, s23, v42
    v_mul_f32 v19, s23, v43
    v_cvt_pk_bf16_f32 v157, v18, v19
    v_mul_f32 v16, s23, v44
    v_mul_f32 v17, s23, v45
    v_cvt_pk_bf16_f32 v172, v16, v17
    v_mul_f32 v18, s23, v46
    v_mul_f32 v19, s23, v47
    v_cvt_pk_bf16_f32 v173, v18, v19
    v_mul_f32 v16, s23, v48
    v_mul_f32 v17, s23, v49
    v_cvt_pk_bf16_f32 v158, v16, v17
    v_mul_f32 v18, s23, v50
    v_mul_f32 v19, s23, v51
    v_cvt_pk_bf16_f32 v159, v18, v19
    v_mul_f32 v16, s23, v52
    v_mul_f32 v17, s23, v53
    v_cvt_pk_bf16_f32 v174, v16, v17
    v_mul_f32 v18, s23, v54
    v_mul_f32 v19, s23, v55
    v_cvt_pk_bf16_f32 v175, v18, v19
    v_mul_f32 v16, s23, v56
    v_mul_f32 v17, s23, v57
    v_cvt_pk_bf16_f32 v160, v16, v17
    v_mul_f32 v18, s23, v58
    v_mul_f32 v19, s23, v59
    v_cvt_pk_bf16_f32 v161, v18, v19
    v_mul_f32 v16, s23, v60
    v_mul_f32 v17, s23, v61
    v_cvt_pk_bf16_f32 v176, v16, v17
    v_mul_f32 v18, s23, v62
    v_mul_f32 v19, s23, v63
    v_cvt_pk_bf16_f32 v177, v18, v19
    v_mul_f32 v16, s23, v64
    v_mul_f32 v17, s23, v65
    v_cvt_pk_bf16_f32 v162, v16, v17
    v_mul_f32 v18, s23, v66
    v_mul_f32 v19, s23, v67
    v_cvt_pk_bf16_f32 v163, v18, v19
    v_mul_f32 v16, s23, v68
    v_mul_f32 v17, s23, v69
    v_cvt_pk_bf16_f32 v178, v16, v17
    v_mul_f32 v18, s23, v70
    v_mul_f32 v19, s23, v71
    v_cvt_pk_bf16_f32 v179, v18, v19
    v_mul_f32 v16, s23, v72
    v_mul_f32 v17, s23, v73
    v_cvt_pk_bf16_f32 v164, v16, v17
    v_mul_f32 v18, s23, v74
    v_mul_f32 v19, s23, v75
    v_cvt_pk_bf16_f32 v165, v18, v19
    v_mul_f32 v16, s23, v76
    v_mul_f32 v17, s23, v77
    v_cvt_pk_bf16_f32 v180, v16, v17
    v_mul_f32 v18, s23, v78
    v_mul_f32 v19, s23, v79
    v_cvt_pk_bf16_f32 v181, v18, v19
    v_mul_f32 v16, s23, v80
    v_mul_f32 v17, s23, v81
    v_cvt_pk_bf16_f32 v166, v16, v17
    v_mul_f32 v18, s23, v82
    v_mul_f32 v19, s23, v83
    v_cvt_pk_bf16_f32 v167, v18, v19
    v_mul_f32 v16, s23, v84
    v_mul_f32 v17, s23, v85
    v_cvt_pk_bf16_f32 v182, v16, v17
    v_mul_f32 v18, s23, v86
    v_mul_f32 v19, s23, v87
    v_cvt_pk_bf16_f32 v183, v18, v19
    v_add_u32 v4, 0x10000, v2
    v_add_u32 v5, 0x20000, v2
    s_barrier
    ds_read_b128 v[224:227], v4 offset:0
    ds_read_b128 v[228:231], v4 offset:1024
    ds_read_b128 v[232:235], v4 offset:2048
    ds_read_b128 v[236:239], v4 offset:3072
    s_waitcnt lgkmcnt(3)
    v_mfma_f32_16x16x32_bf16 v[184:187], v[224:227], v[152:155], 0
    v_mfma_f32_16x16x32_bf16 v[188:191], v[224:227], v[168:171], 0
    ds_read_b128 v[240:243], v4 offset:4096
    s_mov_b64 s[64:65], s[46:47]
    s_mov_b32 s66, 0x700000
    s_mov_b32 s67, 0x20000
    s_mov_b64 s[68:69], s[48:49]
    s_mov_b32 s70, 0x700000
    s_mov_b32 s71, 0x20000
    s_cmp_lt_u32 s2, 224
    s_cselect_b32 s66, 7340032, 0
    s_cselect_b32 s70, 7340032, 0
    s_and_b32 s29, s2, 7
    s_mul_i32 s29, s29, 28
    s_lshr_b32 s16, s2, 3
    s_add_u32 s29, s29, s16
    s_sub_u32 s16, s3, 4
    v_lshrrev_b32 v20, 3, v1
    v_lshlrev_b32 v20, 3, v20
    s_lshl_b32 s17, s16, 6
    v_add_u32 v20, s17, v20
    s_mov_b32 s17, 7168
    v_mul_lo_u32 v11, s17, v20
    v_and_b32 v20, 7, v1
    v_lshl_add_u32 v11, v20, 4, v11
    s_and_b32 s17, s29, 3
    s_mul_i32 s18, s17, 1835008
    s_lshr_b32 s17, s29, 2
    s_lshl_b32 s17, s17, 7
    s_add_u32 s18, s18, s17
    s_lshl_b32 s15, s16, 13
    s_waitcnt lgkmcnt(3)
    v_mfma_f32_16x16x32_bf16 v[192:195], v[228:231], v[152:155], 0
    s_add_u32 s22, s21, 0x10000
    s_add_u32 m0, s20, 0x20000
    s_nop 0
    buffer_load_dwordx4 v2, s[8:11], s22 offen sc1 lds
    s_mov_b64 s[76:77], s[54:55]
    s_mov_b32 s78, 0xc00000
    s_mov_b32 s79, 0x20000
    v_bfe_u32 v20, v1, 2, 2
    v_lshlrev_b32 v20, 12, v20
    v_add_u32 v6, v3, v20
    s_lshr_b32 s16, s2, 5
    s_lshl_b32 s16, s16, 7
    s_lshl_b32 s17, s3, 3
    s_add_u32 s16, s16, s17
    s_mul_i32 s14, s16, 12288
    s_and_b32 s16, s2, 31
    s_lshl_b32 s16, s16, 8
    s_add_u32 s14, s14, s16
    s_add_u32 s14, s14, 4096
    v_mfma_f32_16x16x32_bf16 v[196:199], v[228:231], v[168:171], 0
    ds_read_b128 v[244:247], v4 offset:5120
    s_waitcnt lgkmcnt(3)
    v_mfma_f32_16x16x32_bf16 v[184:187], v[232:235], v[156:159], v[184:187]
    v_mfma_f32_16x16x32_bf16 v[188:191], v[232:235], v[172:175], v[188:191]
    ds_read_b128 v[224:227], v4 offset:6144
    s_waitcnt lgkmcnt(3)
    v_mfma_f32_16x16x32_bf16 v[192:195], v[236:239], v[156:159], v[192:195]
    v_mfma_f32_16x16x32_bf16 v[196:199], v[236:239], v[172:175], v[196:199]
    ds_read_b128 v[228:231], v4 offset:7168
    s_waitcnt lgkmcnt(3)
    v_mfma_f32_16x16x32_bf16 v[184:187], v[240:243], v[160:163], v[184:187]
    v_mfma_f32_16x16x32_bf16 v[188:191], v[240:243], v[176:179], v[188:191]
    ds_read_b128 v[232:235], v4 offset:8192
    s_waitcnt lgkmcnt(3)
    v_mfma_f32_16x16x32_bf16 v[192:195], v[244:247], v[160:163], v[192:195]
    s_add_u32 s22, s21, 0x10400
    s_add_u32 m0, s20, 0x20400
    s_nop 0
    buffer_load_dwordx4 v2, s[8:11], s22 offen sc1 lds
    v_mfma_f32_16x16x32_bf16 v[196:199], v[244:247], v[176:179], v[196:199]
    ds_read_b128 v[236:239], v4 offset:9216
    s_waitcnt lgkmcnt(3)
    v_mfma_f32_16x16x32_bf16 v[184:187], v[224:227], v[164:167], v[184:187]
    v_mfma_f32_16x16x32_bf16 v[188:191], v[224:227], v[180:183], v[188:191]
    ds_read_b128 v[240:243], v4 offset:10240
    s_waitcnt lgkmcnt(3)
    v_mfma_f32_16x16x32_bf16 v[192:195], v[228:231], v[164:167], v[192:195]
    v_mfma_f32_16x16x32_bf16 v[196:199], v[228:231], v[180:183], v[196:199]
    ds_read_b128 v[244:247], v4 offset:11264
    s_waitcnt lgkmcnt(3)
    v_mfma_f32_16x16x32_bf16 v[200:203], v[232:235], v[152:155], 0
    v_mfma_f32_16x16x32_bf16 v[204:207], v[232:235], v[168:171], 0
    ds_read_b128 v[224:227], v4 offset:12288
    s_waitcnt lgkmcnt(3)
    v_mfma_f32_16x16x32_bf16 v[208:211], v[236:239], v[152:155], 0
    v_mfma_f32_16x16x32_bf16 v[212:215], v[236:239], v[168:171], 0
    ds_read_b128 v[228:231], v4 offset:13312
    s_waitcnt lgkmcnt(3)
    v_mfma_f32_16x16x32_bf16 v[200:203], v[240:243], v[156:159], v[200:203]
    v_mfma_f32_16x16x32_bf16 v[204:207], v[240:243], v[172:175], v[204:207]
    ds_read_b128 v[232:235], v4 offset:14336
    s_waitcnt lgkmcnt(3)
    v_mfma_f32_16x16x32_bf16 v[208:211], v[244:247], v[156:159], v[208:211]
    v_max3_f32 v16, v184, v185, v186
    v_mfma_f32_16x16x32_bf16 v[212:215], v[244:247], v[172:175], v[212:215]
    ds_read_b128 v[236:239], v4 offset:15360
    v_max3_f32 v16, v16, v187, v192
    s_waitcnt lgkmcnt(3)
    v_mfma_f32_16x16x32_bf16 v[200:203], v[224:227], v[160:163], v[200:203]
    v_max3_f32 v16, v16, v193, v194
    v_mfma_f32_16x16x32_bf16 v[204:207], v[224:227], v[176:179], v[204:207]
    s_barrier
    ds_read_b128 v[240:243], v4 offset:16384
    v_max_f32 v16, v16, v195
    s_waitcnt lgkmcnt(3)
    v_mfma_f32_16x16x32_bf16 v[208:211], v[228:231], v[160:163], v[208:211]
    v_max3_f32 v17, v188, v189, v190
    v_mfma_f32_16x16x32_bf16 v[212:215], v[228:231], v[176:179], v[212:215]
    s_add_u32 s22, s21, 0x14000
    s_add_u32 m0, s20, 0x24000
    s_nop 0
    buffer_load_dwordx4 v2, s[8:11], s22 offen sc1 lds
    ds_read_b128 v[244:247], v4 offset:17408
    v_max3_f32 v17, v17, v191, v196
    s_waitcnt lgkmcnt(3)
    v_mfma_f32_16x16x32_bf16 v[200:203], v[232:235], v[164:167], v[200:203]
    v_max3_f32 v17, v17, v197, v198
    v_mfma_f32_16x16x32_bf16 v[204:207], v[232:235], v[180:183], v[204:207]
    ds_read_b128 v[224:227], v4 offset:18432
    v_max_f32 v17, v17, v199
    s_waitcnt lgkmcnt(3)
    v_mfma_f32_16x16x32_bf16 v[208:211], v[236:239], v[164:167], v[208:211]
    v_mfma_f32_16x16x32_bf16 v[212:215], v[236:239], v[180:183], v[212:215]
    ds_read_b128 v[228:231], v4 offset:19456
    v_max3_f32 v16, v16, v200, v201
    v_max3_f32 v16, v16, v202, v203
    s_nop 3
    v_max3_f32 v16, v16, v208, v209
    v_max3_f32 v16, v16, v210, v211
    v_max3_f32 v17, v17, v204, v205
    v_max3_f32 v17, v17, v206, v207
    v_max3_f32 v17, v17, v212, v213
    v_max3_f32 v17, v17, v214, v215
    v_mov_b32 v18, v16
    v_mov_b32 v19, v17
    s_nop 0
    v_permlane16_swap_b32 v16, v18
    v_permlane16_swap_b32 v17, v19
    v_max_f32 v16, v16, v18
    v_max_f32 v17, v17, v19
    v_mov_b32 v18, v16
    v_mov_b32 v19, v17
    s_nop 0
    v_permlane32_swap_b32 v16, v18
    v_permlane32_swap_b32 v17, v19
    v_max_f32 v16, v16, v18
    v_max_f32 v17, v17, v19
    v_sub_f32 v216, 0, v16
    v_sub_f32 v217, 0, v16
    v_sub_f32 v218, 0, v16
    v_sub_f32 v219, 0, v16
    v_sub_f32 v220, 0, v17
    v_sub_f32 v221, 0, v17
    v_sub_f32 v222, 0, v17
    v_sub_f32 v223, 0, v17
    v_add_f32 v184, v184, v216
    v_add_f32 v185, v185, v216
    v_exp_f32 v184, v184
    v_exp_f32 v185, v185
    s_nop 0
    v_add_f32 v9, v184, v185
    v_cvt_pk_bf16_f32 v24, v184, v185
    v_add_f32 v186, v186, v216
    v_add_f32 v187, v187, v216
    v_exp_f32 v186, v186
    v_exp_f32 v187, v187
    v_add_f32 v9, v9, v186
    v_add_f32 v9, v9, v187
    v_cvt_pk_bf16_f32 v25, v186, v187
    v_add_f32 v188, v188, v220
    v_add_f32 v189, v189, v220
    v_exp_f32 v188, v188
    v_exp_f32 v189, v189
    s_nop 0
    v_add_f32 v10, v188, v189
    v_cvt_pk_bf16_f32 v28, v188, v189
    v_add_f32 v190, v190, v220
    v_add_f32 v191, v191, v220
    v_exp_f32 v190, v190
    v_exp_f32 v191, v191
    v_add_f32 v10, v10, v190
    v_add_f32 v10, v10, v191
    v_cvt_pk_bf16_f32 v29, v190, v191
    v_add_f32 v192, v192, v216
    v_add_f32 v193, v193, v216
    v_exp_f32 v192, v192
    v_exp_f32 v193, v193
    v_add_f32 v9, v9, v192
    v_add_f32 v9, v9, v193
    v_cvt_pk_bf16_f32 v26, v192, v193
    v_add_f32 v194, v194, v216
    v_add_f32 v195, v195, v216
    v_exp_f32 v194, v194
    v_exp_f32 v195, v195
    v_add_f32 v9, v9, v194
    v_add_f32 v9, v9, v195
    v_cvt_pk_bf16_f32 v27, v194, v195
    v_add_f32 v196, v196, v220
    v_add_f32 v197, v197, v220
    v_exp_f32 v196, v196
    v_exp_f32 v197, v197
    v_add_f32 v10, v10, v196
    v_add_f32 v10, v10, v197
    v_cvt_pk_bf16_f32 v30, v196, v197
    v_add_f32 v198, v198, v220
    v_add_f32 v199, v199, v220
    v_exp_f32 v198, v198
    v_exp_f32 v199, v199
    v_add_f32 v10, v10, v198
    v_add_f32 v10, v10, v199
    v_cvt_pk_bf16_f32 v31, v198, v199
    s_waitcnt lgkmcnt(3)
    v_mfma_f32_16x16x32_bf16 v[184:187], v[240:243], v[152:155], v[216:219]
    v_mfma_f32_16x16x32_bf16 v[188:191], v[240:243], v[168:171], v[220:223]
    ds_read_b128 v[232:235], v4 offset:20480
    v_add_f32 v200, v200, v216
    v_add_f32 v201, v201, v216
    v_exp_f32 v200, v200
    v_exp_f32 v201, v201
    s_waitcnt lgkmcnt(3)
    v_mfma_f32_16x16x32_bf16 v[192:195], v[244:247], v[152:155], v[216:219]
    v_add_f32 v9, v9, v200
    v_add_f32 v9, v9, v201
    v_cvt_pk_bf16_f32 v32, v200, v201
    v_add_f32 v202, v202, v216
    v_mfma_f32_16x16x32_bf16 v[196:199], v[244:247], v[168:171], v[220:223]
    s_add_u32 s22, s21, 0x14400
    s_add_u32 m0, s20, 0x24400
    s_nop 0
    buffer_load_dwordx4 v2, s[8:11], s22 offen sc1 lds
    ds_read_b128 v[236:239], v4 offset:21504
    v_add_f32 v203, v203, v216
    v_exp_f32 v202, v202
    v_exp_f32 v203, v203
    v_add_f32 v9, v9, v202
    s_waitcnt lgkmcnt(3)
    v_mfma_f32_16x16x32_bf16 v[184:187], v[224:227], v[156:159], v[184:187]
    v_add_f32 v9, v9, v203
    v_cvt_pk_bf16_f32 v33, v202, v203
    v_add_f32 v204, v204, v220
    s_add_u32 s22, s18, 0
    s_add_u32 m0, s15, 0
    s_nop 0
    buffer_load_dwordx4 v11, s[64:67], s22 offen lds
    v_mfma_f32_16x16x32_bf16 v[188:191], v[224:227], v[172:175], v[188:191]
    ds_read_b128 v[240:243], v4 offset:22528
    v_add_f32 v205, v205, v220
    v_exp_f32 v204, v204
    v_exp_f32 v205, v205
    v_add_f32 v10, v10, v204
    s_mov_b64 s[4:5], s[40:41]
    s_mov_b32 s6, 0x800000
    s_mov_b32 s7, 0x20000
    v_bfe_u32 v20, v1, 2, 2
    v_lshlrev_b32 v21, 13, v20
    v_sub_u32 v3, v3, v21
    v_lshl_add_u32 v3, v20, 11, v3
    s_and_b32 s16, s2, 1
    s_lshl_b32 s24, s16, 22
    s_lshr_b32 s16, s2, 5
    s_lshl_b32 s16, s16, 8
    s_add_u32 s24, s24, s16
    s_lshl_b32 s16, s3, 14
    s_add_u32 s24, s24, s16
    s_add_u32 s24, s24, 196608
    s_waitcnt lgkmcnt(3)
    v_mfma_f32_16x16x32_bf16 v[192:195], v[228:231], v[156:159], v[192:195]
    v_add_f32 v10, v10, v205
    v_cvt_pk_bf16_f32 v36, v204, v205
    v_add_f32 v206, v206, v220
    v_add_f32 v207, v207, v220
    v_mfma_f32_16x16x32_bf16 v[196:199], v[228:231], v[172:175], v[196:199]
    ds_read_b128 v[244:247], v4 offset:23552
    v_exp_f32 v206, v206
    v_exp_f32 v207, v207
    v_add_f32 v10, v10, v206
    v_add_f32 v10, v10, v207
    s_waitcnt lgkmcnt(3)
    v_mfma_f32_16x16x32_bf16 v[184:187], v[232:235], v[160:163], v[184:187]
    v_cvt_pk_bf16_f32 v37, v206, v207
    v_add_f32 v208, v208, v216
    v_add_f32 v209, v209, v216
    s_mov_b64 s[72:73], s[40:41]
    s_mov_b32 s74, 0x800000
    s_mov_b32 s75, 0x20000
    v_lshlrev_b32 v21, 7, v1
    s_lshl_b32 s16, s2, 2
    s_add_u32 s16, s16, s3
    s_sub_u32 s16, s16, 4
    s_lshl_b32 s16, s16, 13
    buffer_load_dword v15, v21, s[72:75], s16 offen
    v_mfma_f32_16x16x32_bf16 v[188:191], v[232:235], v[176:179], v[188:191]
    ds_read_b128 v[224:227], v4 offset:24576
    v_exp_f32 v208, v208
    v_exp_f32 v209, v209
    v_add_f32 v9, v9, v208
    v_add_f32 v9, v9, v209
    s_waitcnt lgkmcnt(3)
    v_mfma_f32_16x16x32_bf16 v[192:195], v[236:239], v[160:163], v[192:195]
    v_cvt_pk_bf16_f32 v34, v208, v209
    v_add_f32 v210, v210, v216
    v_add_f32 v211, v211, v216
    v_exp_f32 v210, v210
    v_mfma_f32_16x16x32_bf16 v[196:199], v[236:239], v[176:179], v[196:199]
    ds_read_b128 v[228:231], v4 offset:25600
    v_exp_f32 v211, v211
    v_add_f32 v9, v9, v210
    v_add_f32 v9, v9, v211
    v_cvt_pk_bf16_f32 v35, v210, v211
    s_waitcnt lgkmcnt(3)
    v_mfma_f32_16x16x32_bf16 v[184:187], v[240:243], v[164:167], v[184:187]
    v_add_f32 v212, v212, v220
    v_add_f32 v213, v213, v220
    v_exp_f32 v212, v212
    v_mfma_f32_16x16x32_bf16 v[188:191], v[240:243], v[180:183], v[188:191]
    ds_read_b128 v[232:235], v4 offset:26624
    v_exp_f32 v213, v213
    v_add_f32 v10, v10, v212
    v_add_f32 v10, v10, v213
    v_cvt_pk_bf16_f32 v38, v212, v213
    s_waitcnt lgkmcnt(3)
    v_mfma_f32_16x16x32_bf16 v[192:195], v[244:247], v[164:167], v[192:195]
    v_add_f32 v214, v214, v220
    v_add_f32 v215, v215, v220
    v_exp_f32 v214, v214
    v_exp_f32 v215, v215
    v_mfma_f32_16x16x32_bf16 v[196:199], v[244:247], v[180:183], v[196:199]
    ds_read_b128 v[236:239], v4 offset:27648
    v_add_f32 v10, v10, v214
    v_add_f32 v10, v10, v215
    v_cvt_pk_bf16_f32 v39, v214, v215
    s_waitcnt lgkmcnt(3)
    v_mfma_f32_16x16x32_bf16 v[200:203], v[224:227], v[152:155], v[216:219]
    v_mfma_f32_16x16x32_bf16 v[204:207], v[224:227], v[168:171], v[220:223]
    ds_read_b128 v[240:243], v4 offset:28672
    v_exp_f32 v184, v184
    v_exp_f32 v185, v185
    v_add_f32 v9, v9, v184
    s_waitcnt lgkmcnt(3)
    v_mfma_f32_16x16x32_bf16 v[208:211], v[228:231], v[152:155], v[216:219]
    v_add_f32 v9, v9, v185
    v_cvt_pk_bf16_f32 v40, v184, v185
    v_exp_f32 v186, v186
    v_mfma_f32_16x16x32_bf16 v[212:215], v[228:231], v[168:171], v[220:223]
    ds_read_b128 v[244:247], v4 offset:29696
    v_exp_f32 v187, v187
    v_add_f32 v9, v9, v186
    s_waitcnt lgkmcnt(3)
    v_mfma_f32_16x16x32_bf16 v[200:203], v[232:235], v[156:159], v[200:203]
    v_add_f32 v9, v9, v187
    v_cvt_pk_bf16_f32 v41, v186, v187
    v_exp_f32 v188, v188
    v_mfma_f32_16x16x32_bf16 v[204:207], v[232:235], v[172:175], v[204:207]
    ds_read_b128 v[224:227], v4 offset:30720
    v_exp_f32 v189, v189
    v_add_f32 v10, v10, v188
    v_add_f32 v10, v10, v189
    s_waitcnt lgkmcnt(3)
    v_mfma_f32_16x16x32_bf16 v[208:211], v[236:239], v[156:159], v[208:211]
    v_cvt_pk_bf16_f32 v44, v188, v189
    v_exp_f32 v190, v190
    v_mfma_f32_16x16x32_bf16 v[212:215], v[236:239], v[172:175], v[212:215]
    ds_read_b128 v[228:231], v4 offset:31744
    v_exp_f32 v191, v191
    v_add_f32 v10, v10, v190
    v_add_f32 v10, v10, v191
    s_waitcnt lgkmcnt(3)
    v_mfma_f32_16x16x32_bf16 v[200:203], v[240:243], v[160:163], v[200:203]
    v_cvt_pk_bf16_f32 v45, v190, v191
    v_exp_f32 v192, v192
    v_exp_f32 v193, v193
    v_mfma_f32_16x16x32_bf16 v[204:207], v[240:243], v[176:179], v[204:207]
    s_barrier
    ds_read_b128 v[232:235], v4 offset:32768
    v_add_f32 v9, v9, v192
    v_add_f32 v9, v9, v193
    s_waitcnt lgkmcnt(3)
    v_mfma_f32_16x16x32_bf16 v[208:211], v[244:247], v[160:163], v[208:211]
    v_cvt_pk_bf16_f32 v42, v192, v193
    v_exp_f32 v194, v194
    v_exp_f32 v195, v195
    v_mfma_f32_16x16x32_bf16 v[212:215], v[244:247], v[176:179], v[212:215]
    s_add_u32 s22, s21, 0x18000
    s_add_u32 m0, s20, 0x10000
    s_nop 0
    buffer_load_dwordx4 v2, s[8:11], s22 offen sc1 lds
    ds_read_b128 v[236:239], v4 offset:33792
    v_add_f32 v9, v9, v194
    v_add_f32 v9, v9, v195
    v_cvt_pk_bf16_f32 v43, v194, v195
    s_add_u32 s22, s18, 7168
    s_add_u32 m0, s15, 1024
    s_nop 0
    buffer_load_dwordx4 v11, s[64:67], s22 offen lds
    s_waitcnt lgkmcnt(3)
    v_mfma_f32_16x16x32_bf16 v[200:203], v[224:227], v[164:167], v[200:203]
    v_exp_f32 v196, v196
    v_exp_f32 v197, v197
    v_mfma_f32_16x16x32_bf16 v[204:207], v[224:227], v[180:183], v[204:207]
    ds_read_b128 v[240:243], v4 offset:34816
    v_add_f32 v10, v10, v196
    v_add_f32 v10, v10, v197
    v_cvt_pk_bf16_f32 v46, v196, v197
    s_waitcnt lgkmcnt(3)
    v_mfma_f32_16x16x32_bf16 v[208:211], v[228:231], v[164:167], v[208:211]
    v_exp_f32 v198, v198
    v_exp_f32 v199, v199
    v_add_f32 v10, v10, v198
    v_mfma_f32_16x16x32_bf16 v[212:215], v[228:231], v[180:183], v[212:215]
    ds_read_b128 v[244:247], v4 offset:35840
    v_add_f32 v10, v10, v199
    v_cvt_pk_bf16_f32 v47, v198, v199
    s_waitcnt lgkmcnt(3)
    v_mfma_f32_16x16x32_bf16 v[184:187], v[232:235], v[152:155], v[216:219]
    v_mfma_f32_16x16x32_bf16 v[188:191], v[232:235], v[168:171], v[220:223]
    ds_read_b128 v[224:227], v4 offset:36864
    v_exp_f32 v200, v200
    v_exp_f32 v201, v201
    v_add_f32 v9, v9, v200
    s_waitcnt lgkmcnt(3)
    v_mfma_f32_16x16x32_bf16 v[192:195], v[236:239], v[152:155], v[216:219]
    v_add_f32 v9, v9, v201
    v_cvt_pk_bf16_f32 v48, v200, v201
    v_exp_f32 v202, v202
    v_mfma_f32_16x16x32_bf16 v[196:199], v[236:239], v[168:171], v[220:223]
    s_add_u32 s22, s21, 0x18400
    s_add_u32 m0, s20, 0x10400
    s_nop 0
    buffer_load_dwordx4 v2, s[8:11], s22 offen sc1 lds
    ds_read_b128 v[228:231], v4 offset:37888
    v_exp_f32 v203, v203
    v_add_f32 v9, v9, v202
    s_waitcnt lgkmcnt(3)
    v_mfma_f32_16x16x32_bf16 v[184:187], v[240:243], v[156:159], v[184:187]
    v_add_f32 v9, v9, v203
    v_cvt_pk_bf16_f32 v49, v202, v203
    v_exp_f32 v204, v204
    v_mfma_f32_16x16x32_bf16 v[188:191], v[240:243], v[172:175], v[188:191]
    ds_read_b128 v[232:235], v4 offset:38912
    v_exp_f32 v205, v205
    v_add_f32 v10, v10, v204
    v_add_f32 v10, v10, v205
    s_waitcnt lgkmcnt(3)
    v_mfma_f32_16x16x32_bf16 v[192:195], v[244:247], v[156:159], v[192:195]
    v_cvt_pk_bf16_f32 v52, v204, v205
    v_exp_f32 v206, v206
    v_mfma_f32_16x16x32_bf16 v[196:199], v[244:247], v[172:175], v[196:199]
    ds_read_b128 v[236:239], v4 offset:39936
    v_exp_f32 v207, v207
    v_add_f32 v10, v10, v206
    v_add_f32 v10, v10, v207
    s_waitcnt lgkmcnt(3)
    v_mfma_f32_16x16x32_bf16 v[184:187], v[224:227], v[160:163], v[184:187]
    v_cvt_pk_bf16_f32 v53, v206, v207
    v_exp_f32 v208, v208
    v_exp_f32 v209, v209
    v_mfma_f32_16x16x32_bf16 v[188:191], v[224:227], v[176:179], v[188:191]
    ds_read_b128 v[240:243], v4 offset:40960
    v_add_f32 v9, v9, v208
    v_add_f32 v9, v9, v209
    s_waitcnt lgkmcnt(3)
    v_mfma_f32_16x16x32_bf16 v[192:195], v[228:231], v[160:163], v[192:195]
    v_cvt_pk_bf16_f32 v50, v208, v209
    v_exp_f32 v210, v210
    v_exp_f32 v211, v211
    v_mfma_f32_16x16x32_bf16 v[196:199], v[228:231], v[176:179], v[196:199]
    ds_read_b128 v[244:247], v4 offset:41984
    v_add_f32 v9, v9, v210
    v_add_f32 v9, v9, v211
    v_cvt_pk_bf16_f32 v51, v210, v211
    s_waitcnt lgkmcnt(3)
    v_mfma_f32_16x16x32_bf16 v[184:187], v[232:235], v[164:167], v[184:187]
    v_exp_f32 v212, v212
    v_exp_f32 v213, v213
    v_mfma_f32_16x16x32_bf16 v[188:191], v[232:235], v[180:183], v[188:191]
    ds_read_b128 v[224:227], v4 offset:43008
    v_add_f32 v10, v10, v212
    v_add_f32 v10, v10, v213
    v_cvt_pk_bf16_f32 v54, v212, v213
    s_waitcnt lgkmcnt(3)
    v_mfma_f32_16x16x32_bf16 v[192:195], v[236:239], v[164:167], v[192:195]
    v_exp_f32 v214, v214
    v_exp_f32 v215, v215
    v_add_f32 v10, v10, v214
    v_mfma_f32_16x16x32_bf16 v[196:199], v[236:239], v[180:183], v[196:199]
    ds_read_b128 v[228:231], v4 offset:44032
    v_add_f32 v10, v10, v215
    v_cvt_pk_bf16_f32 v55, v214, v215
    s_waitcnt lgkmcnt(3)
    v_mfma_f32_16x16x32_bf16 v[200:203], v[240:243], v[152:155], v[216:219]
    v_mfma_f32_16x16x32_bf16 v[204:207], v[240:243], v[168:171], v[220:223]
    ds_read_b128 v[232:235], v4 offset:45056
    v_exp_f32 v184, v184
    v_exp_f32 v185, v185
    v_add_f32 v9, v9, v184
    s_waitcnt lgkmcnt(3)
    v_mfma_f32_16x16x32_bf16 v[208:211], v[244:247], v[152:155], v[216:219]
    v_add_f32 v9, v9, v185
    v_cvt_pk_bf16_f32 v56, v184, v185
    v_exp_f32 v186, v186
    v_mfma_f32_16x16x32_bf16 v[212:215], v[244:247], v[168:171], v[220:223]
    ds_read_b128 v[236:239], v4 offset:46080
    v_exp_f32 v187, v187
    v_add_f32 v9, v9, v186
    s_add_u32 s22, s18, 14336
    s_add_u32 m0, s15, 2048
    s_nop 0
    buffer_load_dwordx4 v11, s[64:67], s22 offen lds
    s_waitcnt lgkmcnt(3)
    v_mfma_f32_16x16x32_bf16 v[200:203], v[224:227], v[156:159], v[200:203]
    v_add_f32 v9, v9, v187
    v_cvt_pk_bf16_f32 v57, v186, v187
    v_exp_f32 v188, v188
    v_mfma_f32_16x16x32_bf16 v[204:207], v[224:227], v[172:175], v[204:207]
    ds_read_b128 v[240:243], v4 offset:47104
    v_exp_f32 v189, v189
    v_add_f32 v10, v10, v188
    v_add_f32 v10, v10, v189
    s_waitcnt lgkmcnt(3)
    v_mfma_f32_16x16x32_bf16 v[208:211], v[228:231], v[156:159], v[208:211]
    v_cvt_pk_bf16_f32 v60, v188, v189
    v_exp_f32 v190, v190
    v_mfma_f32_16x16x32_bf16 v[212:215], v[228:231], v[172:175], v[212:215]
    ds_read_b128 v[244:247], v4 offset:48128
    v_exp_f32 v191, v191
    v_add_f32 v10, v10, v190
    v_add_f32 v10, v10, v191
    s_waitcnt lgkmcnt(3)
    v_mfma_f32_16x16x32_bf16 v[200:203], v[232:235], v[160:163], v[200:203]
    v_cvt_pk_bf16_f32 v61, v190, v191
    v_exp_f32 v192, v192
    v_exp_f32 v193, v193
    v_mfma_f32_16x16x32_bf16 v[204:207], v[232:235], v[176:179], v[204:207]
    s_barrier
    ds_read_b128 v[224:227], v4 offset:49152
    v_add_f32 v9, v9, v192
    v_add_f32 v9, v9, v193
    s_waitcnt lgkmcnt(3)
    v_mfma_f32_16x16x32_bf16 v[208:211], v[236:239], v[160:163], v[208:211]
    v_cvt_pk_bf16_f32 v58, v192, v193
    v_exp_f32 v194, v194
    v_exp_f32 v195, v195
    v_mfma_f32_16x16x32_bf16 v[212:215], v[236:239], v[176:179], v[212:215]
    s_add_u32 s22, s21, 0x1c000
    s_add_u32 m0, s20, 0x14000
    s_nop 0
    buffer_load_dwordx4 v2, s[8:11], s22 offen sc1 lds
    ds_read_b128 v[228:231], v4 offset:50176
    v_add_f32 v9, v9, v194
    v_add_f32 v9, v9, v195
    v_cvt_pk_bf16_f32 v59, v194, v195
    s_waitcnt lgkmcnt(3)
    v_mfma_f32_16x16x32_bf16 v[200:203], v[240:243], v[164:167], v[200:203]
    v_exp_f32 v196, v196
    v_exp_f32 v197, v197
    v_mfma_f32_16x16x32_bf16 v[204:207], v[240:243], v[180:183], v[204:207]
    ds_read_b128 v[232:235], v4 offset:51200
    v_add_f32 v10, v10, v196
    v_add_f32 v10, v10, v197
    v_cvt_pk_bf16_f32 v62, v196, v197
    s_waitcnt lgkmcnt(3)
    v_mfma_f32_16x16x32_bf16 v[208:211], v[244:247], v[164:167], v[208:211]
    v_exp_f32 v198, v198
    v_exp_f32 v199, v199
    v_add_f32 v10, v10, v198
    v_mfma_f32_16x16x32_bf16 v[212:215], v[244:247], v[180:183], v[212:215]
    ds_read_b128 v[236:239], v4 offset:52224
    v_add_f32 v10, v10, v199
    v_cvt_pk_bf16_f32 v63, v198, v199
    s_waitcnt lgkmcnt(3)
    v_mfma_f32_16x16x32_bf16 v[184:187], v[224:227], v[152:155], v[216:219]
    v_mfma_f32_16x16x32_bf16 v[188:191], v[224:227], v[168:171], v[220:223]
    ds_read_b128 v[240:243], v4 offset:53248
    v_exp_f32 v200, v200
    v_exp_f32 v201, v201
    v_add_f32 v9, v9, v200
    s_waitcnt lgkmcnt(3)
    v_mfma_f32_16x16x32_bf16 v[192:195], v[228:231], v[152:155], v[216:219]
    v_add_f32 v9, v9, v201
    v_cvt_pk_bf16_f32 v64, v200, v201
    v_exp_f32 v202, v202
    v_mfma_f32_16x16x32_bf16 v[196:199], v[228:231], v[168:171], v[220:223]
    s_add_u32 s22, s21, 0x1c400
    s_add_u32 m0, s20, 0x14400
    s_nop 0
    buffer_load_dwordx4 v2, s[8:11], s22 offen sc1 lds
    ds_read_b128 v[244:247], v4 offset:54272
    v_exp_f32 v203, v203
    v_add_f32 v9, v9, v202
    s_waitcnt lgkmcnt(3)
    v_mfma_f32_16x16x32_bf16 v[184:187], v[232:235], v[156:159], v[184:187]
    v_add_f32 v9, v9, v203
    v_cvt_pk_bf16_f32 v65, v202, v203
    v_exp_f32 v204, v204
    v_mfma_f32_16x16x32_bf16 v[188:191], v[232:235], v[172:175], v[188:191]
    ds_read_b128 v[224:227], v4 offset:55296
    v_exp_f32 v205, v205
    v_add_f32 v10, v10, v204
    v_add_f32 v10, v10, v205
    s_waitcnt lgkmcnt(3)
    v_mfma_f32_16x16x32_bf16 v[192:195], v[236:239], v[156:159], v[192:195]
    v_cvt_pk_bf16_f32 v68, v204, v205
    v_exp_f32 v206, v206
    v_mfma_f32_16x16x32_bf16 v[196:199], v[236:239], v[172:175], v[196:199]
    ds_read_b128 v[228:231], v4 offset:56320
    v_exp_f32 v207, v207
    v_add_f32 v10, v10, v206
    v_add_f32 v10, v10, v207
    s_waitcnt lgkmcnt(3)
    v_mfma_f32_16x16x32_bf16 v[184:187], v[240:243], v[160:163], v[184:187]
    v_cvt_pk_bf16_f32 v69, v206, v207
    v_exp_f32 v208, v208
    v_exp_f32 v209, v209
    v_mfma_f32_16x16x32_bf16 v[188:191], v[240:243], v[176:179], v[188:191]
    ds_read_b128 v[232:235], v4 offset:57344
    v_add_f32 v9, v9, v208
    v_add_f32 v9, v9, v209
    s_waitcnt lgkmcnt(3)
    v_mfma_f32_16x16x32_bf16 v[192:195], v[244:247], v[160:163], v[192:195]
    v_cvt_pk_bf16_f32 v66, v208, v209
    v_exp_f32 v210, v210
    v_exp_f32 v211, v211
    s_add_u32 s22, s18, 21504
    s_add_u32 m0, s15, 3072
    s_nop 0
    buffer_load_dwordx4 v11, s[64:67], s22 offen lds
    v_mfma_f32_16x16x32_bf16 v[196:199], v[244:247], v[176:179], v[196:199]
    ds_read_b128 v[236:239], v4 offset:58368
    v_add_f32 v9, v9, v210
    v_add_f32 v9, v9, v211
    v_cvt_pk_bf16_f32 v67, v210, v211
    s_waitcnt lgkmcnt(3)
    v_mfma_f32_16x16x32_bf16 v[184:187], v[224:227], v[164:167], v[184:187]
    v_exp_f32 v212, v212
    v_exp_f32 v213, v213
    v_mfma_f32_16x16x32_bf16 v[188:191], v[224:227], v[180:183], v[188:191]
    ds_read_b128 v[240:243], v4 offset:59392
    v_add_f32 v10, v10, v212
    v_add_f32 v10, v10, v213
    v_cvt_pk_bf16_f32 v70, v212, v213
    s_waitcnt lgkmcnt(3)
    v_mfma_f32_16x16x32_bf16 v[192:195], v[228:231], v[164:167], v[192:195]
    v_exp_f32 v214, v214
    v_exp_f32 v215, v215
    v_add_f32 v10, v10, v214
    v_mfma_f32_16x16x32_bf16 v[196:199], v[228:231], v[180:183], v[196:199]
    ds_read_b128 v[244:247], v4 offset:60416
    v_add_f32 v10, v10, v215
    v_cvt_pk_bf16_f32 v71, v214, v215
    s_waitcnt lgkmcnt(3)
    v_mfma_f32_16x16x32_bf16 v[200:203], v[232:235], v[152:155], v[216:219]
    v_mfma_f32_16x16x32_bf16 v[204:207], v[232:235], v[168:171], v[220:223]
    ds_read_b128 v[224:227], v4 offset:61440
    v_exp_f32 v184, v184
    v_exp_f32 v185, v185
    v_add_f32 v9, v9, v184
    s_waitcnt lgkmcnt(3)
    v_mfma_f32_16x16x32_bf16 v[208:211], v[236:239], v[152:155], v[216:219]
    v_add_f32 v9, v9, v185
    v_cvt_pk_bf16_f32 v72, v184, v185
    v_exp_f32 v186, v186
    v_mfma_f32_16x16x32_bf16 v[212:215], v[236:239], v[168:171], v[220:223]
    ds_read_b128 v[228:231], v4 offset:62464
    v_exp_f32 v187, v187
    v_add_f32 v9, v9, v186
    s_waitcnt lgkmcnt(3)
    v_mfma_f32_16x16x32_bf16 v[200:203], v[240:243], v[156:159], v[200:203]
    v_add_f32 v9, v9, v187
    v_cvt_pk_bf16_f32 v73, v186, v187
    v_exp_f32 v188, v188
    v_mfma_f32_16x16x32_bf16 v[204:207], v[240:243], v[172:175], v[204:207]
    ds_read_b128 v[232:235], v4 offset:63488
    v_exp_f32 v189, v189
    v_add_f32 v10, v10, v188
    v_add_f32 v10, v10, v189
    s_waitcnt lgkmcnt(3)
    v_mfma_f32_16x16x32_bf16 v[208:211], v[244:247], v[156:159], v[208:211]
    v_cvt_pk_bf16_f32 v76, v188, v189
    v_exp_f32 v190, v190
    v_mfma_f32_16x16x32_bf16 v[212:215], v[244:247], v[172:175], v[212:215]
    ds_read_b128 v[236:239], v4 offset:64512
    v_exp_f32 v191, v191
    v_add_f32 v10, v10, v190
    v_add_f32 v10, v10, v191
    s_waitcnt lgkmcnt(3)
    v_mfma_f32_16x16x32_bf16 v[200:203], v[224:227], v[160:163], v[200:203]
    v_cvt_pk_bf16_f32 v77, v190, v191
    v_exp_f32 v192, v192
    v_exp_f32 v193, v193
    v_mfma_f32_16x16x32_bf16 v[204:207], v[224:227], v[176:179], v[204:207]
    s_waitcnt vmcnt(11)
    s_barrier
    ds_read_b128 v[240:243], v5 offset:0
    v_add_f32 v9, v9, v192
    v_add_f32 v9, v9, v193
    s_waitcnt lgkmcnt(3)
    v_mfma_f32_16x16x32_bf16 v[208:211], v[228:231], v[160:163], v[208:211]
    v_cvt_pk_bf16_f32 v74, v192, v193
    v_exp_f32 v194, v194
    v_exp_f32 v195, v195
    v_mfma_f32_16x16x32_bf16 v[212:215], v[228:231], v[176:179], v[212:215]
    s_add_u32 s22, s14, 0x0
    s_add_u32 m0, s20, 0x18000
    s_nop 0
    buffer_load_dwordx4 v6, s[76:79], s22 offen lds
    ds_read_b128 v[244:247], v5 offset:1024
    v_add_f32 v9, v9, v194
    v_add_f32 v9, v9, v195
    v_cvt_pk_bf16_f32 v75, v194, v195
    s_waitcnt lgkmcnt(3)
    v_mfma_f32_16x16x32_bf16 v[200:203], v[232:235], v[164:167], v[200:203]
    v_exp_f32 v196, v196
    v_exp_f32 v197, v197
    v_mfma_f32_16x16x32_bf16 v[204:207], v[232:235], v[180:183], v[204:207]
    ds_read_b128 v[224:227], v5 offset:2048
    v_add_f32 v10, v10, v196
    v_add_f32 v10, v10, v197
    v_cvt_pk_bf16_f32 v78, v196, v197
    s_waitcnt lgkmcnt(3)
    v_mfma_f32_16x16x32_bf16 v[208:211], v[236:239], v[164:167], v[208:211]
    v_exp_f32 v198, v198
    v_exp_f32 v199, v199
    v_add_f32 v10, v10, v198
    v_mfma_f32_16x16x32_bf16 v[212:215], v[236:239], v[180:183], v[212:215]
    ds_read_b128 v[228:231], v5 offset:3072
    v_add_f32 v10, v10, v199
    v_cvt_pk_bf16_f32 v79, v198, v199
    s_waitcnt lgkmcnt(3)
    v_mfma_f32_16x16x32_bf16 v[184:187], v[240:243], v[152:155], v[216:219]
    v_mfma_f32_16x16x32_bf16 v[188:191], v[240:243], v[168:171], v[220:223]
    ds_read_b128 v[232:235], v5 offset:4096
    v_exp_f32 v200, v200
    v_exp_f32 v201, v201
    v_add_f32 v9, v9, v200
    s_waitcnt lgkmcnt(3)
    v_mfma_f32_16x16x32_bf16 v[192:195], v[244:247], v[152:155], v[216:219]
    v_add_f32 v9, v9, v201
    v_cvt_pk_bf16_f32 v80, v200, v201
    v_exp_f32 v202, v202
    s_add_u32 s22, s18, 28672
    s_add_u32 m0, s15, 4096
    s_nop 0
    buffer_load_dwordx4 v11, s[64:67], s22 offen lds
    v_mfma_f32_16x16x32_bf16 v[196:199], v[244:247], v[168:171], v[220:223]
    s_add_u32 s22, s14, 0xc000
    s_add_u32 m0, s20, 0x18400
    s_nop 0
    buffer_load_dwordx4 v6, s[76:79], s22 offen lds
    ds_read_b128 v[236:239], v5 offset:5120
    v_exp_f32 v203, v203
    v_add_f32 v9, v9, v202
    s_waitcnt lgkmcnt(3)
    v_mfma_f32_16x16x32_bf16 v[184:187], v[224:227], v[156:159], v[184:187]
    v_add_f32 v9, v9, v203
    v_cvt_pk_bf16_f32 v81, v202, v203
    v_exp_f32 v204, v204
    v_mfma_f32_16x16x32_bf16 v[188:191], v[224:227], v[172:175], v[188:191]
    ds_read_b128 v[240:243], v5 offset:6144
    v_exp_f32 v205, v205
    v_add_f32 v10, v10, v204
    v_add_f32 v10, v10, v205
    s_waitcnt lgkmcnt(3)
    v_mfma_f32_16x16x32_bf16 v[192:195], v[228:231], v[156:159], v[192:195]
    v_cvt_pk_bf16_f32 v84, v204, v205
    v_exp_f32 v206, v206
    v_mfma_f32_16x16x32_bf16 v[196:199], v[228:231], v[172:175], v[196:199]
    ds_read_b128 v[244:247], v5 offset:7168
    v_exp_f32 v207, v207
    v_add_f32 v10, v10, v206
    v_add_f32 v10, v10, v207
    s_waitcnt lgkmcnt(3)
    v_mfma_f32_16x16x32_bf16 v[184:187], v[232:235], v[160:163], v[184:187]
    v_cvt_pk_bf16_f32 v85, v206, v207
    v_exp_f32 v208, v208
    v_exp_f32 v209, v209
    v_mfma_f32_16x16x32_bf16 v[188:191], v[232:235], v[176:179], v[188:191]
    ds_read_b128 v[224:227], v5 offset:8192
    v_add_f32 v9, v9, v208
    v_add_f32 v9, v9, v209
    s_waitcnt lgkmcnt(3)
    v_mfma_f32_16x16x32_bf16 v[192:195], v[236:239], v[160:163], v[192:195]
    v_cvt_pk_bf16_f32 v82, v208, v209
    v_exp_f32 v210, v210
    v_exp_f32 v211, v211
    v_mfma_f32_16x16x32_bf16 v[196:199], v[236:239], v[176:179], v[196:199]
    ds_read_b128 v[228:231], v5 offset:9216
    v_add_f32 v9, v9, v210
    v_add_f32 v9, v9, v211
    v_cvt_pk_bf16_f32 v83, v210, v211
    s_waitcnt lgkmcnt(3)
    v_mfma_f32_16x16x32_bf16 v[184:187], v[240:243], v[164:167], v[184:187]
    v_exp_f32 v212, v212
    v_exp_f32 v213, v213
    v_mfma_f32_16x16x32_bf16 v[188:191], v[240:243], v[180:183], v[188:191]
    ds_read_b128 v[232:235], v5 offset:10240
    v_add_f32 v10, v10, v212
    v_add_f32 v10, v10, v213
    v_cvt_pk_bf16_f32 v86, v212, v213
    s_waitcnt lgkmcnt(3)
    v_mfma_f32_16x16x32_bf16 v[192:195], v[244:247], v[164:167], v[192:195]
    v_exp_f32 v214, v214
    v_exp_f32 v215, v215
    v_add_f32 v10, v10, v214
    v_mfma_f32_16x16x32_bf16 v[196:199], v[244:247], v[180:183], v[196:199]
    ds_read_b128 v[236:239], v5 offset:11264
    v_add_f32 v10, v10, v215
    v_cvt_pk_bf16_f32 v87, v214, v215
    s_waitcnt lgkmcnt(3)
    v_mfma_f32_16x16x32_bf16 v[200:203], v[224:227], v[152:155], v[216:219]
    v_mfma_f32_16x16x32_bf16 v[204:207], v[224:227], v[168:171], v[220:223]
    ds_read_b128 v[240:243], v5 offset:12288
    v_exp_f32 v184, v184
    v_exp_f32 v185, v185
    v_add_f32 v9, v9, v184
    s_waitcnt lgkmcnt(3)
    v_mfma_f32_16x16x32_bf16 v[208:211], v[228:231], v[152:155], v[216:219]
    v_add_f32 v9, v9, v185
    v_cvt_pk_bf16_f32 v88, v184, v185
    v_exp_f32 v186, v186
    v_mfma_f32_16x16x32_bf16 v[212:215], v[228:231], v[168:171], v[220:223]
    ds_read_b128 v[244:247], v5 offset:13312
    v_exp_f32 v187, v187
    v_add_f32 v9, v9, v186
    s_waitcnt lgkmcnt(3)
    v_mfma_f32_16x16x32_bf16 v[200:203], v[232:235], v[156:159], v[200:203]
    v_add_f32 v9, v9, v187
    v_cvt_pk_bf16_f32 v89, v186, v187
    v_exp_f32 v188, v188
    v_mfma_f32_16x16x32_bf16 v[204:207], v[232:235], v[172:175], v[204:207]
    ds_read_b128 v[224:227], v5 offset:14336
    v_exp_f32 v189, v189
    v_add_f32 v10, v10, v188
    v_add_f32 v10, v10, v189
    s_waitcnt lgkmcnt(3)
    v_mfma_f32_16x16x32_bf16 v[208:211], v[236:239], v[156:159], v[208:211]
    v_cvt_pk_bf16_f32 v92, v188, v189
    v_exp_f32 v190, v190
    v_mfma_f32_16x16x32_bf16 v[212:215], v[236:239], v[172:175], v[212:215]
    ds_read_b128 v[228:231], v5 offset:15360
    v_exp_f32 v191, v191
    v_add_f32 v10, v10, v190
    v_add_f32 v10, v10, v191
    s_waitcnt lgkmcnt(3)
    v_mfma_f32_16x16x32_bf16 v[200:203], v[240:243], v[160:163], v[200:203]
    v_cvt_pk_bf16_f32 v93, v190, v191
    v_exp_f32 v192, v192
    v_exp_f32 v193, v193
    v_mfma_f32_16x16x32_bf16 v[204:207], v[240:243], v[176:179], v[204:207]
    s_waitcnt vmcnt(12)
    s_barrier
    ds_read_b128 v[232:235], v5 offset:16384
    v_add_f32 v9, v9, v192
    v_add_f32 v9, v9, v193
    s_add_u32 s22, s18, 35840
    s_add_u32 m0, s15, 5120
    s_nop 0
    buffer_load_dwordx4 v11, s[64:67], s22 offen lds
    s_waitcnt lgkmcnt(3)
    v_mfma_f32_16x16x32_bf16 v[208:211], v[244:247], v[160:163], v[208:211]
    v_cvt_pk_bf16_f32 v90, v192, v193
    v_exp_f32 v194, v194
    v_exp_f32 v195, v195
    v_mfma_f32_16x16x32_bf16 v[212:215], v[244:247], v[176:179], v[212:215]
    s_add_u32 s22, s14, 0xc0000
    s_add_u32 m0, s20, 0x1c000
    s_nop 0
    buffer_load_dwordx4 v6, s[76:79], s22 offen lds
    ds_read_b128 v[236:239], v5 offset:17408
    v_add_f32 v9, v9, v194
    v_add_f32 v9, v9, v195
    v_cvt_pk_bf16_f32 v91, v194, v195
    s_waitcnt lgkmcnt(3)
    v_mfma_f32_16x16x32_bf16 v[200:203], v[224:227], v[164:167], v[200:203]
    v_exp_f32 v196, v196
    v_exp_f32 v197, v197
    v_mfma_f32_16x16x32_bf16 v[204:207], v[224:227], v[180:183], v[204:207]
    ds_read_b128 v[240:243], v5 offset:18432
    v_add_f32 v10, v10, v196
    v_add_f32 v10, v10, v197
    v_cvt_pk_bf16_f32 v94, v196, v197
    s_waitcnt lgkmcnt(3)
    v_mfma_f32_16x16x32_bf16 v[208:211], v[228:231], v[164:167], v[208:211]
    v_exp_f32 v198, v198
    v_exp_f32 v199, v199
    v_add_f32 v10, v10, v198
    v_mfma_f32_16x16x32_bf16 v[212:215], v[228:231], v[180:183], v[212:215]
    ds_read_b128 v[244:247], v5 offset:19456
    v_add_f32 v10, v10, v199
    v_cvt_pk_bf16_f32 v95, v198, v199
    s_waitcnt lgkmcnt(3)
    v_mfma_f32_16x16x32_bf16 v[184:187], v[232:235], v[152:155], v[216:219]
    v_mfma_f32_16x16x32_bf16 v[188:191], v[232:235], v[168:171], v[220:223]
    ds_read_b128 v[224:227], v5 offset:20480
    v_exp_f32 v200, v200
    v_exp_f32 v201, v201
    v_add_f32 v9, v9, v200
    s_waitcnt lgkmcnt(3)
    v_mfma_f32_16x16x32_bf16 v[192:195], v[236:239], v[152:155], v[216:219]
    v_add_f32 v9, v9, v201
    v_cvt_pk_bf16_f32 v96, v200, v201
    v_exp_f32 v202, v202
    v_mfma_f32_16x16x32_bf16 v[196:199], v[236:239], v[168:171], v[220:223]
    s_add_u32 s22, s14, 0xcc000
    s_add_u32 m0, s20, 0x1c400
    s_nop 0
    buffer_load_dwordx4 v6, s[76:79], s22 offen lds
    ds_read_b128 v[228:231], v5 offset:21504
    v_exp_f32 v203, v203
    v_add_f32 v9, v9, v202
    s_waitcnt lgkmcnt(3)
    v_mfma_f32_16x16x32_bf16 v[184:187], v[240:243], v[156:159], v[184:187]
    v_add_f32 v9, v9, v203
    v_cvt_pk_bf16_f32 v97, v202, v203
    v_exp_f32 v204, v204
    v_mfma_f32_16x16x32_bf16 v[188:191], v[240:243], v[172:175], v[188:191]
    ds_read_b128 v[232:235], v5 offset:22528
    v_exp_f32 v205, v205
    v_add_f32 v10, v10, v204
    v_add_f32 v10, v10, v205
    s_waitcnt lgkmcnt(3)
    v_mfma_f32_16x16x32_bf16 v[192:195], v[244:247], v[156:159], v[192:195]
    v_cvt_pk_bf16_f32 v100, v204, v205
    v_exp_f32 v206, v206
    v_mfma_f32_16x16x32_bf16 v[196:199], v[244:247], v[172:175], v[196:199]
    ds_read_b128 v[236:239], v5 offset:23552
    v_exp_f32 v207, v207
    v_add_f32 v10, v10, v206
    v_add_f32 v10, v10, v207
    s_waitcnt lgkmcnt(3)
    v_mfma_f32_16x16x32_bf16 v[184:187], v[224:227], v[160:163], v[184:187]
    v_cvt_pk_bf16_f32 v101, v206, v207
    v_exp_f32 v208, v208
    v_exp_f32 v209, v209
    v_mfma_f32_16x16x32_bf16 v[188:191], v[224:227], v[176:179], v[188:191]
    ds_read_b128 v[240:243], v5 offset:24576
    v_add_f32 v9, v9, v208
    v_add_f32 v9, v9, v209
    s_waitcnt lgkmcnt(3)
    v_mfma_f32_16x16x32_bf16 v[192:195], v[228:231], v[160:163], v[192:195]
    v_cvt_pk_bf16_f32 v98, v208, v209
    v_exp_f32 v210, v210
    v_exp_f32 v211, v211
    v_mfma_f32_16x16x32_bf16 v[196:199], v[228:231], v[176:179], v[196:199]
    ds_read_b128 v[244:247], v5 offset:25600
    v_add_f32 v9, v9, v210
    v_add_f32 v9, v9, v211
    v_cvt_pk_bf16_f32 v99, v210, v211
    s_waitcnt lgkmcnt(3)
    v_mfma_f32_16x16x32_bf16 v[184:187], v[232:235], v[164:167], v[184:187]
    v_exp_f32 v212, v212
    v_exp_f32 v213, v213
    v_mfma_f32_16x16x32_bf16 v[188:191], v[232:235], v[180:183], v[188:191]
    ds_read_b128 v[224:227], v5 offset:26624
    v_add_f32 v10, v10, v212
    v_add_f32 v10, v10, v213
    v_cvt_pk_bf16_f32 v102, v212, v213
    s_waitcnt lgkmcnt(3)
    v_mfma_f32_16x16x32_bf16 v[192:195], v[236:239], v[164:167], v[192:195]
    v_exp_f32 v214, v214
    v_exp_f32 v215, v215
    v_add_f32 v10, v10, v214
    v_mfma_f32_16x16x32_bf16 v[196:199], v[236:239], v[180:183], v[196:199]
    ds_read_b128 v[228:231], v5 offset:27648
    v_add_f32 v10, v10, v215
    v_cvt_pk_bf16_f32 v103, v214, v215
    s_waitcnt lgkmcnt(3)
    v_mfma_f32_16x16x32_bf16 v[200:203], v[240:243], v[152:155], v[216:219]
    v_mfma_f32_16x16x32_bf16 v[204:207], v[240:243], v[168:171], v[220:223]
    ds_read_b128 v[232:235], v5 offset:28672
    v_exp_f32 v184, v184
    v_exp_f32 v185, v185
    v_add_f32 v9, v9, v184
    s_add_u32 s22, s18, 43008
    s_add_u32 m0, s15, 6144
    s_nop 0
    buffer_load_dwordx4 v11, s[64:67], s22 offen lds
    s_waitcnt lgkmcnt(3)
    v_mfma_f32_16x16x32_bf16 v[208:211], v[244:247], v[152:155], v[216:219]
    v_add_f32 v9, v9, v185
    v_cvt_pk_bf16_f32 v104, v184, v185
    v_exp_f32 v186, v186
    v_mfma_f32_16x16x32_bf16 v[212:215], v[244:247], v[168:171], v[220:223]
    ds_read_b128 v[236:239], v5 offset:29696
    v_exp_f32 v187, v187
    v_add_f32 v9, v9, v186
    s_waitcnt lgkmcnt(3)
    v_mfma_f32_16x16x32_bf16 v[200:203], v[224:227], v[156:159], v[200:203]
    v_add_f32 v9, v9, v187
    v_cvt_pk_bf16_f32 v105, v186, v187
    v_exp_f32 v188, v188
    v_mfma_f32_16x16x32_bf16 v[204:207], v[224:227], v[172:175], v[204:207]
    ds_read_b128 v[240:243], v5 offset:30720
    v_exp_f32 v189, v189
    v_add_f32 v10, v10, v188
    v_add_f32 v10, v10, v189
    v_lshrrev_b32 v20, 4, v1
    v_lshlrev_b32 v21, 4, v20
    s_lshl_b32 s16, s2, 8
    s_add_u32 s16, s16, 0x550000
    buffer_load_dwordx4 v[144:147], v21, s[8:11], s16 offen offset:0 sc1
    buffer_load_dwordx4 v[148:151], v21, s[8:11], s16 offen offset:64 sc1
    buffer_load_dwordx4 v[248:251], v21, s[8:11], s16 offen offset:128 sc1
    buffer_load_dwordx4 v[252:255], v21, s[8:11], s16 offen offset:192 sc1
    v_lshlrev_b32 v7, 11, v20
    v_xor_b32 v20, s3, v20
    v_and_b32 v20, 1, v20
    v_lshl_add_u32 v7, v20, 5, v7
    v_bfe_u32 v20, v1, 2, 2
    v_lshl_add_u32 v7, v20, 6, v7
    v_and_b32 v20, 3, v1
    v_lshl_add_u32 v7, v20, 3, v7
    s_lshr_b32 s16, s3, 1
    s_lshl_b32 s16, s16, 8
    s_add_u32 s16, s16, 98304
    v_add_u32 v7, s16, v7
    s_waitcnt lgkmcnt(3)
    v_mfma_f32_16x16x32_bf16 v[208:211], v[228:231], v[156:159], v[208:211]
    v_cvt_pk_bf16_f32 v108, v188, v189
    v_exp_f32 v190, v190
    v_mfma_f32_16x16x32_bf16 v[212:215], v[228:231], v[172:175], v[212:215]
    ds_read_b128 v[244:247], v5 offset:31744
    v_exp_f32 v191, v191
    v_add_f32 v10, v10, v190
    v_add_f32 v10, v10, v191
    s_waitcnt lgkmcnt(3)
    v_mfma_f32_16x16x32_bf16 v[200:203], v[232:235], v[160:163], v[200:203]
    v_cvt_pk_bf16_f32 v109, v190, v191
    v_exp_f32 v192, v192
    v_exp_f32 v193, v193
    v_mfma_f32_16x16x32_bf16 v[204:207], v[232:235], v[176:179], v[204:207]
    s_waitcnt vmcnt(15)
    s_barrier
    ds_read_b128 v[224:227], v4 offset:0
    v_add_f32 v9, v9, v192
    v_add_f32 v9, v9, v193
    s_waitcnt lgkmcnt(3)
    v_mfma_f32_16x16x32_bf16 v[208:211], v[236:239], v[160:163], v[208:211]
    v_cvt_pk_bf16_f32 v106, v192, v193
    v_exp_f32 v194, v194
    v_exp_f32 v195, v195
    v_mfma_f32_16x16x32_bf16 v[212:215], v[236:239], v[176:179], v[212:215]
    s_add_u32 s22, s21, 0x80000
    s_add_u32 m0, s20, 0x20000
    s_nop 0
    buffer_load_dwordx4 v2, s[8:11], s22 offen sc1 lds
    ds_read_b128 v[228:231], v4 offset:1024
    v_add_f32 v9, v9, v194
    v_add_f32 v9, v9, v195
    v_cvt_pk_bf16_f32 v107, v194, v195
    s_waitcnt lgkmcnt(3)
    v_mfma_f32_16x16x32_bf16 v[200:203], v[240:243], v[164:167], v[200:203]
    v_exp_f32 v196, v196
    v_exp_f32 v197, v197
    v_mfma_f32_16x16x32_bf16 v[204:207], v[240:243], v[180:183], v[204:207]
    ds_read_b128 v[232:235], v4 offset:2048
    v_add_f32 v10, v10, v196
    v_add_f32 v10, v10, v197
    v_cvt_pk_bf16_f32 v110, v196, v197
    s_waitcnt lgkmcnt(3)
    v_mfma_f32_16x16x32_bf16 v[208:211], v[244:247], v[164:167], v[208:211]
    v_exp_f32 v198, v198
    v_exp_f32 v199, v199
    v_add_f32 v10, v10, v198
    v_mfma_f32_16x16x32_bf16 v[212:215], v[244:247], v[180:183], v[212:215]
    ds_read_b128 v[236:239], v4 offset:3072
    v_add_f32 v10, v10, v199
    v_cvt_pk_bf16_f32 v111, v198, v199
    s_waitcnt lgkmcnt(3)
    v_mfma_f32_16x16x32_bf16 v[184:187], v[224:227], v[152:155], v[216:219]
    v_mfma_f32_16x16x32_bf16 v[188:191], v[224:227], v[168:171], v[220:223]
    ds_read_b128 v[240:243], v4 offset:4096
    v_exp_f32 v200, v200
    v_exp_f32 v201, v201
    v_add_f32 v9, v9, v200
    s_waitcnt lgkmcnt(3)
    v_mfma_f32_16x16x32_bf16 v[192:195], v[228:231], v[152:155], v[216:219]
    v_add_f32 v9, v9, v201
    v_cvt_pk_bf16_f32 v112, v200, v201
    v_exp_f32 v202, v202
    v_mfma_f32_16x16x32_bf16 v[196:199], v[228:231], v[168:171], v[220:223]
    s_add_u32 s22, s21, 0x80400
    s_add_u32 m0, s20, 0x20400
    s_nop 0
    buffer_load_dwordx4 v2, s[8:11], s22 offen sc1 lds
    ds_read_b128 v[244:247], v4 offset:5120
    v_exp_f32 v203, v203
    v_add_f32 v9, v9, v202
    s_waitcnt lgkmcnt(3)
    v_mfma_f32_16x16x32_bf16 v[184:187], v[232:235], v[156:159], v[184:187]
    v_add_f32 v9, v9, v203
    v_cvt_pk_bf16_f32 v113, v202, v203
    v_exp_f32 v204, v204
    v_mfma_f32_16x16x32_bf16 v[188:191], v[232:235], v[172:175], v[188:191]
    ds_read_b128 v[224:227], v4 offset:6144
    v_exp_f32 v205, v205
    v_add_f32 v10, v10, v204
    v_add_f32 v10, v10, v205
    s_waitcnt lgkmcnt(3)
    v_mfma_f32_16x16x32_bf16 v[192:195], v[236:239], v[156:159], v[192:195]
    v_cvt_pk_bf16_f32 v116, v204, v205
    v_exp_f32 v206, v206
    v_mfma_f32_16x16x32_bf16 v[196:199], v[236:239], v[172:175], v[196:199]
    ds_read_b128 v[228:231], v4 offset:7168
    v_exp_f32 v207, v207
    v_add_f32 v10, v10, v206
    v_add_f32 v10, v10, v207
    s_waitcnt lgkmcnt(3)
    v_mfma_f32_16x16x32_bf16 v[184:187], v[240:243], v[160:163], v[184:187]
    v_cvt_pk_bf16_f32 v117, v206, v207
    v_exp_f32 v208, v208
    v_exp_f32 v209, v209
    s_add_u32 s22, s18, 50176
    s_add_u32 m0, s15, 7168
    s_nop 0
    buffer_load_dwordx4 v11, s[64:67], s22 offen lds
    v_mfma_f32_16x16x32_bf16 v[188:191], v[240:243], v[176:179], v[188:191]
    ds_read_b128 v[232:235], v4 offset:8192
    v_add_f32 v9, v9, v208
    v_add_f32 v9, v9, v209
    s_waitcnt lgkmcnt(3)
    v_mfma_f32_16x16x32_bf16 v[192:195], v[244:247], v[160:163], v[192:195]
    v_cvt_pk_bf16_f32 v114, v208, v209
    v_exp_f32 v210, v210
    v_exp_f32 v211, v211
    v_mfma_f32_16x16x32_bf16 v[196:199], v[244:247], v[176:179], v[196:199]
    ds_read_b128 v[236:239], v4 offset:9216
    v_add_f32 v9, v9, v210
    v_add_f32 v9, v9, v211
    v_cvt_pk_bf16_f32 v115, v210, v211
    s_waitcnt lgkmcnt(3)
    v_mfma_f32_16x16x32_bf16 v[184:187], v[224:227], v[164:167], v[184:187]
    v_exp_f32 v212, v212
    v_exp_f32 v213, v213
    v_mfma_f32_16x16x32_bf16 v[188:191], v[224:227], v[180:183], v[188:191]
    ds_read_b128 v[240:243], v4 offset:10240
    v_add_f32 v10, v10, v212
    v_add_f32 v10, v10, v213
    v_cvt_pk_bf16_f32 v118, v212, v213
    s_waitcnt lgkmcnt(3)
    v_mfma_f32_16x16x32_bf16 v[192:195], v[228:231], v[164:167], v[192:195]
    v_exp_f32 v214, v214
    v_exp_f32 v215, v215
    v_add_f32 v10, v10, v214
    v_mfma_f32_16x16x32_bf16 v[196:199], v[228:231], v[180:183], v[196:199]
    ds_read_b128 v[244:247], v4 offset:11264
    v_add_f32 v10, v10, v215
    v_cvt_pk_bf16_f32 v119, v214, v215
    s_waitcnt lgkmcnt(3)
    v_mfma_f32_16x16x32_bf16 v[200:203], v[232:235], v[152:155], v[216:219]
    v_mfma_f32_16x16x32_bf16 v[204:207], v[232:235], v[168:171], v[220:223]
    ds_read_b128 v[224:227], v4 offset:12288
    v_exp_f32 v184, v184
    v_exp_f32 v185, v185
    v_add_f32 v9, v9, v184
    s_waitcnt lgkmcnt(3)
    v_mfma_f32_16x16x32_bf16 v[208:211], v[236:239], v[152:155], v[216:219]
    v_add_f32 v9, v9, v185
    v_cvt_pk_bf16_f32 v120, v184, v185
    v_exp_f32 v186, v186
    v_mfma_f32_16x16x32_bf16 v[212:215], v[236:239], v[168:171], v[220:223]
    ds_read_b128 v[228:231], v4 offset:13312
    v_exp_f32 v187, v187
    v_add_f32 v9, v9, v186
    s_waitcnt lgkmcnt(3)
    v_mfma_f32_16x16x32_bf16 v[200:203], v[240:243], v[156:159], v[200:203]
    v_add_f32 v9, v9, v187
    v_cvt_pk_bf16_f32 v121, v186, v187
    v_exp_f32 v188, v188
    v_mfma_f32_16x16x32_bf16 v[204:207], v[240:243], v[172:175], v[204:207]
    ds_read_b128 v[232:235], v4 offset:14336
    v_exp_f32 v189, v189
    v_add_f32 v10, v10, v188
    v_add_f32 v10, v10, v189
    s_waitcnt lgkmcnt(3)
    v_mfma_f32_16x16x32_bf16 v[208:211], v[244:247], v[156:159], v[208:211]
    v_cvt_pk_bf16_f32 v124, v188, v189
    v_exp_f32 v190, v190
    v_mfma_f32_16x16x32_bf16 v[212:215], v[244:247], v[172:175], v[212:215]
    ds_read_b128 v[236:239], v4 offset:15360
    v_exp_f32 v191, v191
    v_add_f32 v10, v10, v190
    v_add_f32 v10, v10, v191
    s_waitcnt lgkmcnt(3)
    v_mfma_f32_16x16x32_bf16 v[200:203], v[224:227], v[160:163], v[200:203]
    v_cvt_pk_bf16_f32 v125, v190, v191
    v_exp_f32 v192, v192
    v_exp_f32 v193, v193
    v_mfma_f32_16x16x32_bf16 v[204:207], v[224:227], v[176:179], v[204:207]
    s_waitcnt vmcnt(15)
    s_waitcnt vmcnt(11)
    s_waitcnt vmcnt(8)
    s_barrier
    ds_read_b128 v[240:243], v4 offset:16384
    v_add_f32 v9, v9, v192
    v_add_f32 v9, v9, v193
    s_waitcnt lgkmcnt(3)
    v_mfma_f32_16x16x32_bf16 v[208:211], v[228:231], v[160:163], v[208:211]
    v_cvt_pk_bf16_f32 v122, v192, v193
    v_exp_f32 v194, v194
    v_exp_f32 v195, v195
    v_mfma_f32_16x16x32_bf16 v[212:215], v[228:231], v[176:179], v[212:215]
    s_add_u32 s22, s21, 0x84000
    s_add_u32 m0, s20, 0x24000
    s_nop 0
    buffer_load_dwordx4 v2, s[8:11], s22 offen sc1 lds
    ds_read_b128 v[244:247], v4 offset:17408
    v_add_f32 v9, v9, v194
    v_add_f32 v9, v9, v195
    v_cvt_pk_bf16_f32 v123, v194, v195
    ds_read_b64_tr_b16 v[136:137], v7 offset:0
    ds_read_b64_tr_b16 v[138:139], v7 offset:1024
    s_waitcnt lgkmcnt(5)
    v_mfma_f32_16x16x32_bf16 v[200:203], v[232:235], v[164:167], v[200:203]
    v_exp_f32 v196, v196
    v_exp_f32 v197, v197
    v_mfma_f32_16x16x32_bf16 v[204:207], v[232:235], v[180:183], v[204:207]
    ds_read_b128 v[224:227], v4 offset:18432
    v_add_f32 v10, v10, v196
    v_add_f32 v10, v10, v197
    v_cvt_pk_bf16_f32 v126, v196, v197
    s_waitcnt lgkmcnt(5)
    v_mfma_f32_16x16x32_bf16 v[208:211], v[236:239], v[164:167], v[208:211]
    v_exp_f32 v198, v198
    v_exp_f32 v199, v199
    v_add_f32 v10, v10, v198
    ds_read_b64_tr_b16 v[140:141], v7 offset:8192
    ds_read_b64_tr_b16 v[142:143], v7 offset:9216
    v_mfma_f32_16x16x32_bf16 v[212:215], v[236:239], v[180:183], v[212:215]
    ds_read_b128 v[228:231], v4 offset:19456
    v_add_f32 v10, v10, v199
    v_cvt_pk_bf16_f32 v127, v198, v199
    s_waitcnt lgkmcnt(7)
    v_mfma_f32_16x16x32_bf16 v[184:187], v[240:243], v[152:155], v[216:219]
    s_waitcnt vmcnt(7) lgkmcnt(4)
    v_mfma_f32_16x16x32_bf16 v[12:15], v[136:139], v[144:147], 0
    v_mfma_f32_16x16x32_bf16 v[188:191], v[240:243], v[168:171], v[220:223]
    ds_read_b128 v[232:235], v4 offset:20480
    v_exp_f32 v200, v200
    v_exp_f32 v201, v201
    v_add_f32 v9, v9, v200
    ds_read_b64_tr_b16 v[136:137], v7 offset:16384
    ds_read_b64_tr_b16 v[138:139], v7 offset:17408
    v_mfma_f32_16x16x32_bf16 v[192:195], v[244:247], v[152:155], v[216:219]
    v_add_f32 v9, v9, v201
    v_cvt_pk_bf16_f32 v128, v200, v201
    v_exp_f32 v202, v202
    v_mfma_f32_16x16x32_bf16 v[196:199], v[244:247], v[168:171], v[220:223]
    s_add_u32 s22, s21, 0x84400
    s_add_u32 m0, s20, 0x24400
    s_nop 0
    buffer_load_dwordx4 v2, s[8:11], s22 offen sc1 lds
    ds_read_b128 v[236:239], v4 offset:21504
    v_exp_f32 v203, v203
    v_add_f32 v9, v9, v202
    s_waitcnt vmcnt(7) lgkmcnt(5)
    v_mfma_f32_16x16x32_bf16 v[12:15], v[140:143], v[148:151], v[12:15]
    v_mfma_f32_16x16x32_bf16 v[184:187], v[224:227], v[156:159], v[184:187]
    v_add_f32 v9, v9, v203
    v_cvt_pk_bf16_f32 v129, v202, v203
    v_exp_f32 v204, v204
    ds_read_b64_tr_b16 v[140:141], v7 offset:24576
    ds_read_b64_tr_b16 v[142:143], v7 offset:25600
    v_mfma_f32_16x16x32_bf16 v[188:191], v[224:227], v[172:175], v[188:191]
    ds_read_b128 v[240:243], v4 offset:22528
    v_exp_f32 v205, v205
    v_add_f32 v10, v10, v204
    v_add_f32 v10, v10, v205
    s_waitcnt lgkmcnt(7)
    v_mfma_f32_16x16x32_bf16 v[192:195], v[228:231], v[156:159], v[192:195]
    v_cvt_pk_bf16_f32 v132, v204, v205
    v_exp_f32 v206, v206
    s_waitcnt vmcnt(6) lgkmcnt(4)
    v_mfma_f32_16x16x32_bf16 v[12:15], v[136:139], v[248:251], v[12:15]
    v_mfma_f32_16x16x32_bf16 v[196:199], v[228:231], v[172:175], v[196:199]
    ds_read_b128 v[244:247], v4 offset:23552
    v_exp_f32 v207, v207
    v_add_f32 v10, v10, v206
    v_add_f32 v10, v10, v207
    v_mfma_f32_16x16x32_bf16 v[184:187], v[232:235], v[160:163], v[184:187]
    v_cvt_pk_bf16_f32 v133, v206, v207
    v_exp_f32 v208, v208
    v_exp_f32 v209, v209
    v_mfma_f32_16x16x32_bf16 v[188:191], v[232:235], v[176:179], v[188:191]
    ds_read_b128 v[224:227], v4 offset:24576
    v_add_f32 v9, v9, v208
    v_add_f32 v9, v9, v209
    s_waitcnt vmcnt(5) lgkmcnt(3)
    v_mfma_f32_16x16x32_bf16 v[12:15], v[140:143], v[252:255], v[12:15]
    v_mfma_f32_16x16x32_bf16 v[192:195], v[236:239], v[160:163], v[192:195]
    v_cvt_pk_bf16_f32 v130, v208, v209
    v_exp_f32 v210, v210
    v_exp_f32 v211, v211
    v_mfma_f32_16x16x32_bf16 v[196:199], v[236:239], v[176:179], v[196:199]
    ds_read_b128 v[228:231], v4 offset:25600
    v_add_f32 v9, v9, v210
    v_add_f32 v9, v9, v211
    v_cvt_pk_bf16_f32 v131, v210, v211
    s_waitcnt lgkmcnt(3)
    v_mfma_f32_16x16x32_bf16 v[184:187], v[240:243], v[164:167], v[184:187]
    v_exp_f32 v212, v212
    v_exp_f32 v213, v213
    v_mfma_f32_16x16x32_bf16 v[188:191], v[240:243], v[180:183], v[188:191]
    ds_read_b128 v[232:235], v4 offset:26624
    v_add_f32 v10, v10, v212
    v_add_f32 v10, v10, v213
    v_cvt_pk_bf16_f32 v134, v212, v213
    s_waitcnt lgkmcnt(3)
    v_mfma_f32_16x16x32_bf16 v[192:195], v[244:247], v[164:167], v[192:195]
    v_exp_f32 v214, v214
    v_exp_f32 v215, v215
    v_add_f32 v10, v10, v214
    v_mfma_f32_16x16x32_bf16 v[196:199], v[244:247], v[180:183], v[196:199]
    ds_read_b128 v[236:239], v4 offset:27648
    v_add_f32 v10, v10, v215
    v_cvt_pk_bf16_f32 v135, v214, v215
    s_waitcnt lgkmcnt(3)
    v_mfma_f32_16x16x32_bf16 v[200:203], v[224:227], v[152:155], v[216:219]
    v_mfma_f32_16x16x32_bf16 v[204:207], v[224:227], v[168:171], v[220:223]
    ds_read_b128 v[240:243], v4 offset:28672
    v_exp_f32 v184, v184
    v_exp_f32 v185, v185
    v_add_f32 v9, v9, v184
    v_lshrrev_b32 v20, 4, v1
    v_lshlrev_b32 v20, 4, v20
    s_lshr_b32 s16, s2, 5
    s_lshl_b32 s16, s16, 14
    s_and_b32 s17, s2, 31
    s_lshl_b32 s17, s17, 9
    s_add_u32 s16, s16, s17
    s_lshl_b32 s17, s3, 6
    s_add_u32 s16, s16, s17
    s_add_u32 s16, s16, 0x580000
    s_mov_b32 exec_lo, 0x10001
    s_mov_b32 exec_hi, 0x10001
    buffer_store_dwordx4 v[12:15], v20, s[8:11], s16 offen sc1
    s_mov_b64 exec, -1
    s_waitcnt lgkmcnt(3)
    v_mfma_f32_16x16x32_bf16 v[208:211], v[228:231], v[152:155], v[216:219]
    v_add_f32 v9, v9, v185
    v_cvt_pk_bf16_f32 v136, v184, v185
    v_exp_f32 v186, v186
    v_mfma_f32_16x16x32_bf16 v[212:215], v[228:231], v[168:171], v[220:223]
    ds_read_b128 v[244:247], v4 offset:29696
    v_exp_f32 v187, v187
    v_add_f32 v9, v9, v186
    s_waitcnt lgkmcnt(3)
    v_mfma_f32_16x16x32_bf16 v[200:203], v[232:235], v[156:159], v[200:203]
    v_add_f32 v9, v9, v187
    v_cvt_pk_bf16_f32 v137, v186, v187
    v_exp_f32 v188, v188
    v_mfma_f32_16x16x32_bf16 v[204:207], v[232:235], v[172:175], v[204:207]
    ds_read_b128 v[224:227], v4 offset:30720
    v_exp_f32 v189, v189
    v_add_f32 v10, v10, v188
    v_add_f32 v10, v10, v189
    s_waitcnt lgkmcnt(3)
    v_mfma_f32_16x16x32_bf16 v[208:211], v[236:239], v[156:159], v[208:211]
    v_cvt_pk_bf16_f32 v140, v188, v189
    v_exp_f32 v190, v190
    v_mfma_f32_16x16x32_bf16 v[212:215], v[236:239], v[172:175], v[212:215]
    ds_read_b128 v[228:231], v4 offset:31744
    v_exp_f32 v191, v191
    v_add_f32 v10, v10, v190
    v_add_f32 v10, v10, v191
    s_waitcnt lgkmcnt(3)
    v_mfma_f32_16x16x32_bf16 v[200:203], v[240:243], v[160:163], v[200:203]
    v_cvt_pk_bf16_f32 v141, v190, v191
    v_exp_f32 v192, v192
    v_exp_f32 v193, v193
    v_mfma_f32_16x16x32_bf16 v[204:207], v[240:243], v[176:179], v[204:207]
    v_add_f32 v9, v9, v192
    v_add_f32 v9, v9, v193
    s_waitcnt lgkmcnt(2)
    v_mfma_f32_16x16x32_bf16 v[208:211], v[244:247], v[160:163], v[208:211]
    v_cvt_pk_bf16_f32 v138, v192, v193
    v_exp_f32 v194, v194
    v_exp_f32 v195, v195
    v_mfma_f32_16x16x32_bf16 v[212:215], v[244:247], v[176:179], v[212:215]
    v_add_f32 v9, v9, v194
    v_add_f32 v9, v9, v195
    v_cvt_pk_bf16_f32 v139, v194, v195
    s_waitcnt lgkmcnt(1)
    v_mfma_f32_16x16x32_bf16 v[200:203], v[224:227], v[164:167], v[200:203]
    v_exp_f32 v196, v196
    v_exp_f32 v197, v197
    v_mfma_f32_16x16x32_bf16 v[204:207], v[224:227], v[180:183], v[204:207]
    v_add_f32 v10, v10, v196
    v_add_f32 v10, v10, v197
    v_cvt_pk_bf16_f32 v142, v196, v197
    s_waitcnt lgkmcnt(0)
    v_mfma_f32_16x16x32_bf16 v[208:211], v[228:231], v[164:167], v[208:211]
    v_exp_f32 v198, v198
    v_exp_f32 v199, v199
    v_add_f32 v10, v10, v198
    v_mfma_f32_16x16x32_bf16 v[212:215], v[228:231], v[180:183], v[212:215]
    v_add_f32 v10, v10, v199
    v_cvt_pk_bf16_f32 v143, v198, v199
    s_waitcnt vmcnt(4)
    s_barrier
    ds_read_b128 v[232:235], v5 offset:0
    ds_read_b128 v[236:239], v5 offset:1024
    ds_read_b128 v[240:243], v5 offset:2048
    ds_read_b128 v[244:247], v5 offset:3072
    v_exp_f32 v200, v200
    v_exp_f32 v201, v201
    v_add_f32 v9, v9, v200
    v_add_f32 v9, v9, v201
    v_cvt_pk_bf16_f32 v144, v200, v201
    v_exp_f32 v202, v202
    v_exp_f32 v203, v203
    v_add_f32 v9, v9, v202
    v_add_f32 v9, v9, v203
    v_cvt_pk_bf16_f32 v145, v202, v203
    v_exp_f32 v204, v204
    v_exp_f32 v205, v205
    v_add_f32 v10, v10, v204
    v_add_f32 v10, v10, v205
    v_cvt_pk_bf16_f32 v148, v204, v205
    v_exp_f32 v206, v206
    v_exp_f32 v207, v207
    v_add_f32 v10, v10, v206
    v_add_f32 v10, v10, v207
    v_cvt_pk_bf16_f32 v149, v206, v207
    v_exp_f32 v208, v208
    v_exp_f32 v209, v209
    v_add_f32 v9, v9, v208
    v_add_f32 v9, v9, v209
    v_cvt_pk_bf16_f32 v146, v208, v209
    v_exp_f32 v210, v210
    v_exp_f32 v211, v211
    v_add_f32 v9, v9, v210
    v_add_f32 v9, v9, v211
    v_cvt_pk_bf16_f32 v147, v210, v211
    v_exp_f32 v212, v212
    v_exp_f32 v213, v213
    v_add_f32 v10, v10, v212
    v_add_f32 v10, v10, v213
    v_cvt_pk_bf16_f32 v150, v212, v213
    v_exp_f32 v214, v214
    v_exp_f32 v215, v215
    v_add_f32 v10, v10, v214
    v_add_f32 v10, v10, v215
    v_cvt_pk_bf16_f32 v151, v214, v215
    v_mov_b32 v16, v9
    v_mov_b32 v18, v10
    s_nop 0
    v_permlane16_swap_b32 v9, v16
    v_permlane16_swap_b32 v10, v18
    v_add_f32 v9, v9, v16
    v_add_f32 v10, v10, v18
    v_mov_b32 v16, v9
    v_mov_b32 v18, v10
    s_nop 0
    v_permlane32_swap_b32 v9, v16
    v_permlane32_swap_b32 v10, v18
    v_add_f32 v9, v9, v16
    v_add_f32 v10, v10, v18
    v_max_f32 v17, v9, v10
    v_readfirstlane_b32 s17, v8
    s_cmp_eq_u32 s17, s28
    s_cselect_b32 s16, 0, 0x71800000
    v_cmp_ngt_f32 vcc, s16, v17
    v_cmp_u_f32 s[76:77], v9, v10
    s_or_b64 vcc, vcc, s[76:77]
    s_cbranch_vccnz adaLN_cond__sliding_block_cached__moe_arch_mod__prompt_kernel_fixB
adaLN_cond__sliding_block_cached__moe_arch_mod__prompt_kernel_fixBb:
    v_rcp_f32 v9, v9
    v_rcp_f32 v10, v10
    s_lshl_b32 s25, s13, 3
    s_add_u32 s25, s25, s3
    s_lshl_b32 s25, s25, 18
    s_lshl_b32 s26, s12, 12
    s_add_u32 s25, s25, s26
    s_add_u32 s25, s25, 0x1000000
    s_add_u32 s26, s25, 131072
    s_lshl_b32 s63, s13, 3
    s_add_u32 s63, s63, s3
    s_lshl_b32 s63, s63, 5
    s_add_u32 s63, s63, s12
    s_lshl_b32 s63, s63, 2
    s_waitcnt lgkmcnt(3)
    v_mfma_f32_16x16x32_bf16 v[184:187], v[232:235], v[24:27], 0
    v_mfma_f32_16x16x32_bf16 v[188:191], v[232:235], v[28:31], 0
    ds_read_b128 v[224:227], v5 offset:4096
    s_waitcnt lgkmcnt(3)
    v_mfma_f32_16x16x32_bf16 v[192:195], v[236:239], v[24:27], 0
    s_add_u32 s22, s21, 0x88000
    s_add_u32 m0, s20, 0x10000
    s_nop 0
    buffer_load_dwordx4 v2, s[8:11], s22 offen sc1 lds
    v_mfma_f32_16x16x32_bf16 v[196:199], v[236:239], v[28:31], 0
    ds_read_b128 v[228:231], v5 offset:5120
    s_waitcnt lgkmcnt(3)
    v_mfma_f32_16x16x32_bf16 v[184:187], v[240:243], v[32:35], v[184:187]
    v_mfma_f32_16x16x32_bf16 v[188:191], v[240:243], v[36:39], v[188:191]
    ds_read_b128 v[232:235], v5 offset:6144
    s_waitcnt lgkmcnt(3)
    v_mfma_f32_16x16x32_bf16 v[192:195], v[244:247], v[32:35], v[192:195]
    s_add_u32 s22, s21, 0x88400
    s_add_u32 m0, s20, 0x10400
    s_nop 0
    buffer_load_dwordx4 v2, s[8:11], s22 offen sc1 lds
    v_mfma_f32_16x16x32_bf16 v[196:199], v[244:247], v[36:39], v[196:199]
    ds_read_b128 v[236:239], v5 offset:7168
    s_waitcnt lgkmcnt(3)
    v_mfma_f32_16x16x32_bf16 v[184:187], v[224:227], v[40:43], v[184:187]
    v_mfma_f32_16x16x32_bf16 v[188:191], v[224:227], v[44:47], v[188:191]
    ds_read_b128 v[240:243], v5 offset:8192
    s_waitcnt lgkmcnt(3)
    v_mfma_f32_16x16x32_bf16 v[192:195], v[228:231], v[40:43], v[192:195]
    s_add_u32 s22, s21, 0x8c000
    s_add_u32 m0, s20, 0x14000
    s_nop 0
    buffer_load_dwordx4 v2, s[8:11], s22 offen sc1 lds
    v_mfma_f32_16x16x32_bf16 v[196:199], v[228:231], v[44:47], v[196:199]
    ds_read_b128 v[244:247], v5 offset:9216
    s_waitcnt lgkmcnt(3)
    v_mfma_f32_16x16x32_bf16 v[184:187], v[232:235], v[48:51], v[184:187]
    v_mfma_f32_16x16x32_bf16 v[188:191], v[232:235], v[52:55], v[188:191]
    ds_read_b128 v[224:227], v5 offset:10240
    s_waitcnt lgkmcnt(3)
    v_mfma_f32_16x16x32_bf16 v[192:195], v[236:239], v[48:51], v[192:195]
    s_add_u32 s22, s21, 0x8c400
    s_add_u32 m0, s20, 0x14400
    s_nop 0
    buffer_load_dwordx4 v2, s[8:11], s22 offen sc1 lds
    v_mfma_f32_16x16x32_bf16 v[196:199], v[236:239], v[52:55], v[196:199]
    ds_read_b128 v[228:231], v5 offset:11264
    s_waitcnt lgkmcnt(3)
    v_mfma_f32_16x16x32_bf16 v[184:187], v[240:243], v[56:59], v[184:187]
    v_mfma_f32_16x16x32_bf16 v[188:191], v[240:243], v[60:63], v[188:191]
    ds_read_b128 v[232:235], v5 offset:12288
    s_waitcnt lgkmcnt(3)
    v_mfma_f32_16x16x32_bf16 v[192:195], v[244:247], v[56:59], v[192:195]
    s_add_u32 s22, s21, 0x90000
    s_add_u32 m0, s20, 0x18000
    s_nop 0
    buffer_load_dwordx4 v2, s[8:11], s22 offen sc1 lds
    v_mfma_f32_16x16x32_bf16 v[196:199], v[244:247], v[60:63], v[196:199]
    ds_read_b128 v[236:239], v5 offset:13312
    s_waitcnt lgkmcnt(3)
    v_mfma_f32_16x16x32_bf16 v[184:187], v[224:227], v[64:67], v[184:187]
    v_mfma_f32_16x16x32_bf16 v[188:191], v[224:227], v[68:71], v[188:191]
    ds_read_b128 v[240:243], v5 offset:14336
    s_waitcnt lgkmcnt(3)
    v_mfma_f32_16x16x32_bf16 v[192:195], v[228:231], v[64:67], v[192:195]
    s_add_u32 s22, s21, 0x90400
    s_add_u32 m0, s20, 0x18400
    s_nop 0
    buffer_load_dwordx4 v2, s[8:11], s22 offen sc1 lds
    s_waitcnt vmcnt(6)
    v_mfma_f32_16x16x32_bf16 v[196:199], v[228:231], v[68:71], v[196:199]
    ds_read_b128 v[244:247], v5 offset:15360
    s_waitcnt lgkmcnt(3)
    v_mfma_f32_16x16x32_bf16 v[184:187], v[232:235], v[72:75], v[184:187]
    v_mfma_f32_16x16x32_bf16 v[188:191], v[232:235], v[76:79], v[188:191]
    s_barrier
    ds_read_b128 v[224:227], v5 offset:16384
    s_waitcnt lgkmcnt(3)
    v_mfma_f32_16x16x32_bf16 v[192:195], v[236:239], v[72:75], v[192:195]
    v_mfma_f32_16x16x32_bf16 v[196:199], v[236:239], v[76:79], v[196:199]
    s_add_u32 s22, s21, 0x94000
    s_add_u32 m0, s20, 0x1c000
    s_nop 0
    buffer_load_dwordx4 v2, s[8:11], s22 offen sc1 lds
    ds_read_b128 v[228:231], v5 offset:17408
    s_waitcnt lgkmcnt(3)
    v_mfma_f32_16x16x32_bf16 v[184:187], v[240:243], v[80:83], v[184:187]
    v_mfma_f32_16x16x32_bf16 v[188:191], v[240:243], v[84:87], v[188:191]
    ds_read_b128 v[232:235], v5 offset:18432
    s_waitcnt lgkmcnt(3)
    v_mfma_f32_16x16x32_bf16 v[192:195], v[244:247], v[80:83], v[192:195]
    v_mfma_f32_16x16x32_bf16 v[196:199], v[244:247], v[84:87], v[196:199]
    ds_read_b128 v[236:239], v5 offset:19456
    s_waitcnt lgkmcnt(3)
    v_mfma_f32_16x16x32_bf16 v[184:187], v[224:227], v[88:91], v[184:187]
    v_mfma_f32_16x16x32_bf16 v[188:191], v[224:227], v[92:95], v[188:191]
    ds_read_b128 v[240:243], v5 offset:20480
    s_waitcnt lgkmcnt(3)
    v_mfma_f32_16x16x32_bf16 v[192:195], v[228:231], v[88:91], v[192:195]
    v_mfma_f32_16x16x32_bf16 v[196:199], v[228:231], v[92:95], v[196:199]
    s_add_u32 s22, s21, 0x94400
    s_add_u32 m0, s20, 0x1c400
    s_nop 0
    buffer_load_dwordx4 v2, s[8:11], s22 offen sc1 lds
    ds_read_b128 v[244:247], v5 offset:21504
    s_waitcnt lgkmcnt(3)
    v_mfma_f32_16x16x32_bf16 v[184:187], v[232:235], v[96:99], v[184:187]
    v_mfma_f32_16x16x32_bf16 v[188:191], v[232:235], v[100:103], v[188:191]
    ds_read_b128 v[224:227], v5 offset:22528
    s_waitcnt lgkmcnt(3)
    v_mfma_f32_16x16x32_bf16 v[192:195], v[236:239], v[96:99], v[192:195]
    v_mfma_f32_16x16x32_bf16 v[196:199], v[236:239], v[100:103], v[196:199]
    ds_read_b128 v[228:231], v5 offset:23552
    s_waitcnt lgkmcnt(3)
    v_mfma_f32_16x16x32_bf16 v[184:187], v[240:243], v[104:107], v[184:187]
    v_mfma_f32_16x16x32_bf16 v[188:191], v[240:243], v[108:111], v[188:191]
    ds_read_b128 v[232:235], v5 offset:24576
    s_waitcnt lgkmcnt(3)
    v_mfma_f32_16x16x32_bf16 v[192:195], v[244:247], v[104:107], v[192:195]
    v_mfma_f32_16x16x32_bf16 v[196:199], v[244:247], v[108:111], v[196:199]
    ds_read_b128 v[236:239], v5 offset:25600
    s_waitcnt lgkmcnt(3)
    v_mfma_f32_16x16x32_bf16 v[184:187], v[224:227], v[112:115], v[184:187]
    v_mfma_f32_16x16x32_bf16 v[188:191], v[224:227], v[116:119], v[188:191]
    ds_read_b128 v[240:243], v5 offset:26624
    s_waitcnt lgkmcnt(3)
    v_mfma_f32_16x16x32_bf16 v[192:195], v[228:231], v[112:115], v[192:195]
    v_mfma_f32_16x16x32_bf16 v[196:199], v[228:231], v[116:119], v[196:199]
    ds_read_b128 v[244:247], v5 offset:27648
    s_waitcnt lgkmcnt(3)
    v_mfma_f32_16x16x32_bf16 v[184:187], v[232:235], v[120:123], v[184:187]
    v_mfma_f32_16x16x32_bf16 v[188:191], v[232:235], v[124:127], v[188:191]
    ds_read_b128 v[224:227], v5 offset:28672
    s_waitcnt lgkmcnt(3)
    v_mfma_f32_16x16x32_bf16 v[192:195], v[236:239], v[120:123], v[192:195]
    v_mfma_f32_16x16x32_bf16 v[196:199], v[236:239], v[124:127], v[196:199]
    ds_read_b128 v[228:231], v5 offset:29696
    s_waitcnt lgkmcnt(3)
    v_mfma_f32_16x16x32_bf16 v[184:187], v[240:243], v[128:131], v[184:187]
    v_mfma_f32_16x16x32_bf16 v[188:191], v[240:243], v[132:135], v[188:191]
    ds_read_b128 v[232:235], v5 offset:30720
    s_waitcnt lgkmcnt(3)
    v_mfma_f32_16x16x32_bf16 v[192:195], v[244:247], v[128:131], v[192:195]
    v_mfma_f32_16x16x32_bf16 v[196:199], v[244:247], v[132:135], v[196:199]
    ds_read_b128 v[236:239], v5 offset:31744
    s_waitcnt lgkmcnt(3)
    v_mfma_f32_16x16x32_bf16 v[184:187], v[224:227], v[136:139], v[184:187]
    v_mfma_f32_16x16x32_bf16 v[188:191], v[224:227], v[140:143], v[188:191]
    s_waitcnt vmcnt(6)
    s_barrier
    ds_read_b128 v[240:243], v4 offset:0
    s_waitcnt lgkmcnt(3)
    v_mfma_f32_16x16x32_bf16 v[192:195], v[228:231], v[136:139], v[192:195]
    v_mfma_f32_16x16x32_bf16 v[196:199], v[228:231], v[140:143], v[196:199]
    s_add_u32 s22, s21, 0x98000
    s_add_u32 m0, s20, 0x20000
    s_nop 0
    buffer_load_dwordx4 v2, s[8:11], s22 offen sc1 lds
    ds_read_b128 v[244:247], v4 offset:1024
    s_waitcnt lgkmcnt(3)
    v_mfma_f32_16x16x32_bf16 v[184:187], v[232:235], v[144:147], v[184:187]
    v_mfma_f32_16x16x32_bf16 v[188:191], v[232:235], v[148:151], v[188:191]
    ds_read_b128 v[224:227], v4 offset:2048
    s_waitcnt lgkmcnt(3)
    v_mfma_f32_16x16x32_bf16 v[192:195], v[236:239], v[144:147], v[192:195]
    v_mfma_f32_16x16x32_bf16 v[196:199], v[236:239], v[148:151], v[196:199]
    ds_read_b128 v[228:231], v4 offset:3072
    s_waitcnt lgkmcnt(3)
    v_mfma_f32_16x16x32_bf16 v[200:203], v[240:243], v[24:27], 0
    v_mfma_f32_16x16x32_bf16 v[204:207], v[240:243], v[28:31], 0
    ds_read_b128 v[232:235], v4 offset:4096
    s_waitcnt lgkmcnt(3)
    v_mfma_f32_16x16x32_bf16 v[208:211], v[244:247], v[24:27], 0
    v_mfma_f32_16x16x32_bf16 v[212:215], v[244:247], v[28:31], 0
    s_add_u32 s22, s21, 0x98400
    s_add_u32 m0, s20, 0x20400
    s_nop 0
    buffer_load_dwordx4 v2, s[8:11], s22 offen sc1 lds
    ds_read_b128 v[236:239], v4 offset:5120
    v_mul_f32 v184, v184, v9
    s_waitcnt lgkmcnt(3)
    v_mfma_f32_16x16x32_bf16 v[200:203], v[224:227], v[32:35], v[200:203]
    v_mul_f32 v185, v185, v9
    v_mfma_f32_16x16x32_bf16 v[204:207], v[224:227], v[36:39], v[204:207]
    ds_read_b128 v[240:243], v4 offset:6144
    v_mul_f32 v186, v186, v9
    s_waitcnt lgkmcnt(3)
    v_mfma_f32_16x16x32_bf16 v[208:211], v[228:231], v[32:35], v[208:211]
    v_mul_f32 v187, v187, v9
    v_mfma_f32_16x16x32_bf16 v[212:215], v[228:231], v[36:39], v[212:215]
    ds_read_b128 v[244:247], v4 offset:7168
    v_mul_f32 v192, v192, v9
    s_waitcnt lgkmcnt(3)
    v_mfma_f32_16x16x32_bf16 v[200:203], v[232:235], v[40:43], v[200:203]
    v_mul_f32 v193, v193, v9
    v_mfma_f32_16x16x32_bf16 v[204:207], v[232:235], v[44:47], v[204:207]
    ds_read_b128 v[224:227], v4 offset:8192
    v_mul_f32 v194, v194, v9
    s_waitcnt lgkmcnt(3)
    v_mfma_f32_16x16x32_bf16 v[208:211], v[236:239], v[40:43], v[208:211]
    v_mul_f32 v195, v195, v9
    v_mfma_f32_16x16x32_bf16 v[212:215], v[236:239], v[44:47], v[212:215]
    ds_read_b128 v[228:231], v4 offset:9216
    v_cvt_pk_bf16_f32 v216, v184, v185
    s_waitcnt lgkmcnt(3)
    v_mfma_f32_16x16x32_bf16 v[200:203], v[240:243], v[48:51], v[200:203]
    v_cvt_pk_bf16_f32 v217, v186, v187
    v_mfma_f32_16x16x32_bf16 v[204:207], v[240:243], v[52:55], v[204:207]
    ds_read_b128 v[232:235], v4 offset:10240
    v_cvt_pk_bf16_f32 v218, v192, v193
    s_waitcnt lgkmcnt(3)
    v_mfma_f32_16x16x32_bf16 v[208:211], v[244:247], v[48:51], v[208:211]
    v_cvt_pk_bf16_f32 v219, v194, v195
    v_mfma_f32_16x16x32_bf16 v[212:215], v[244:247], v[52:55], v[212:215]
    ds_read_b128 v[236:239], v4 offset:11264
    buffer_store_dwordx4 v[216:219], v2, s[8:11], s25 offen offset:0 sc1
    s_waitcnt lgkmcnt(3)
    v_mfma_f32_16x16x32_bf16 v[200:203], v[224:227], v[56:59], v[200:203]
    v_mul_f32 v188, v188, v10
    v_mfma_f32_16x16x32_bf16 v[204:207], v[224:227], v[60:63], v[204:207]
    ds_read_b128 v[240:243], v4 offset:12288
    v_mul_f32 v189, v189, v10
    s_waitcnt lgkmcnt(3)
    v_mfma_f32_16x16x32_bf16 v[208:211], v[228:231], v[56:59], v[208:211]
    v_mul_f32 v190, v190, v10
    v_mfma_f32_16x16x32_bf16 v[212:215], v[228:231], v[60:63], v[212:215]
    ds_read_b128 v[244:247], v4 offset:13312
    v_mul_f32 v191, v191, v10
    s_waitcnt lgkmcnt(3)
    v_mfma_f32_16x16x32_bf16 v[200:203], v[232:235], v[64:67], v[200:203]
    v_mul_f32 v196, v196, v10
    v_mfma_f32_16x16x32_bf16 v[204:207], v[232:235], v[68:71], v[204:207]
    ds_read_b128 v[224:227], v4 offset:14336
    v_mul_f32 v197, v197, v10
    s_waitcnt lgkmcnt(3)
    v_mfma_f32_16x16x32_bf16 v[208:211], v[236:239], v[64:67], v[208:211]
    v_mul_f32 v198, v198, v10
    v_mfma_f32_16x16x32_bf16 v[212:215], v[236:239], v[68:71], v[212:215]
    ds_read_b128 v[228:231], v4 offset:15360
    v_mul_f32 v199, v199, v10
    s_waitcnt lgkmcnt(3)
    v_mfma_f32_16x16x32_bf16 v[200:203], v[240:243], v[72:75], v[200:203]
    v_cvt_pk_bf16_f32 v220, v188, v189
    v_mfma_f32_16x16x32_bf16 v[204:207], v[240:243], v[76:79], v[204:207]
    s_waitcnt vmcnt(7)
    s_barrier
    ds_read_b128 v[232:235], v4 offset:16384
    v_cvt_pk_bf16_f32 v221, v190, v191
    s_waitcnt lgkmcnt(3)
    v_mfma_f32_16x16x32_bf16 v[208:211], v[244:247], v[72:75], v[208:211]
    v_cvt_pk_bf16_f32 v222, v196, v197
    v_mfma_f32_16x16x32_bf16 v[212:215], v[244:247], v[76:79], v[212:215]
    s_add_u32 s22, s21, 0x9c000
    s_add_u32 m0, s20, 0x24000
    s_nop 0
    buffer_load_dwordx4 v2, s[8:11], s22 offen sc1 lds
    ds_read_b128 v[236:239], v4 offset:17408
    v_cvt_pk_bf16_f32 v223, v198, v199
    s_waitcnt lgkmcnt(3)
    v_mfma_f32_16x16x32_bf16 v[200:203], v[224:227], v[80:83], v[200:203]
    buffer_store_dwordx4 v[220:223], v2, s[8:11], s26 offen offset:0 sc1
    v_mfma_f32_16x16x32_bf16 v[204:207], v[224:227], v[84:87], v[204:207]
    ds_read_b128 v[240:243], v4 offset:18432
    s_waitcnt lgkmcnt(3)
    v_mfma_f32_16x16x32_bf16 v[208:211], v[228:231], v[80:83], v[208:211]
    v_mfma_f32_16x16x32_bf16 v[212:215], v[228:231], v[84:87], v[212:215]
    ds_read_b128 v[244:247], v4 offset:19456
    s_waitcnt lgkmcnt(3)
    v_mfma_f32_16x16x32_bf16 v[200:203], v[232:235], v[88:91], v[200:203]
    v_mfma_f32_16x16x32_bf16 v[204:207], v[232:235], v[92:95], v[204:207]
    ds_read_b128 v[224:227], v4 offset:20480
    s_waitcnt lgkmcnt(3)
    v_mfma_f32_16x16x32_bf16 v[208:211], v[236:239], v[88:91], v[208:211]
    v_mfma_f32_16x16x32_bf16 v[212:215], v[236:239], v[92:95], v[212:215]
    s_add_u32 s22, s21, 0x9c400
    s_add_u32 m0, s20, 0x24400
    s_nop 0
    buffer_load_dwordx4 v2, s[8:11], s22 offen sc1 lds
    ds_read_b128 v[228:231], v4 offset:21504
    s_waitcnt lgkmcnt(3)
    v_mfma_f32_16x16x32_bf16 v[200:203], v[240:243], v[96:99], v[200:203]
    v_mfma_f32_16x16x32_bf16 v[204:207], v[240:243], v[100:103], v[204:207]
    ds_read_b128 v[232:235], v4 offset:22528
    s_waitcnt lgkmcnt(3)
    v_mfma_f32_16x16x32_bf16 v[208:211], v[244:247], v[96:99], v[208:211]
    v_mfma_f32_16x16x32_bf16 v[212:215], v[244:247], v[100:103], v[212:215]
    ds_read_b128 v[236:239], v4 offset:23552
    s_waitcnt lgkmcnt(3)
    v_mfma_f32_16x16x32_bf16 v[200:203], v[224:227], v[104:107], v[200:203]
    v_mfma_f32_16x16x32_bf16 v[204:207], v[224:227], v[108:111], v[204:207]
    ds_read_b128 v[240:243], v4 offset:24576
    s_waitcnt lgkmcnt(3)
    v_mfma_f32_16x16x32_bf16 v[208:211], v[228:231], v[104:107], v[208:211]
    v_mfma_f32_16x16x32_bf16 v[212:215], v[228:231], v[108:111], v[212:215]
    ds_read_b128 v[244:247], v4 offset:25600
    s_waitcnt lgkmcnt(3)
    v_mfma_f32_16x16x32_bf16 v[200:203], v[232:235], v[112:115], v[200:203]
    v_mfma_f32_16x16x32_bf16 v[204:207], v[232:235], v[116:119], v[204:207]
    ds_read_b128 v[224:227], v4 offset:26624
    s_waitcnt lgkmcnt(3)
    v_mfma_f32_16x16x32_bf16 v[208:211], v[236:239], v[112:115], v[208:211]
    v_mfma_f32_16x16x32_bf16 v[212:215], v[236:239], v[116:119], v[212:215]
    ds_read_b128 v[228:231], v4 offset:27648
    s_waitcnt lgkmcnt(3)
    v_mfma_f32_16x16x32_bf16 v[200:203], v[240:243], v[120:123], v[200:203]
    v_mfma_f32_16x16x32_bf16 v[204:207], v[240:243], v[124:127], v[204:207]
    ds_read_b128 v[232:235], v4 offset:28672
    s_waitcnt lgkmcnt(3)
    v_mfma_f32_16x16x32_bf16 v[208:211], v[244:247], v[120:123], v[208:211]
    v_mfma_f32_16x16x32_bf16 v[212:215], v[244:247], v[124:127], v[212:215]
    ds_read_b128 v[236:239], v4 offset:29696
    s_waitcnt lgkmcnt(3)
    v_mfma_f32_16x16x32_bf16 v[200:203], v[224:227], v[128:131], v[200:203]
    v_mfma_f32_16x16x32_bf16 v[204:207], v[224:227], v[132:135], v[204:207]
    ds_read_b128 v[240:243], v4 offset:30720
    s_waitcnt lgkmcnt(3)
    v_mfma_f32_16x16x32_bf16 v[208:211], v[228:231], v[128:131], v[208:211]
    v_mfma_f32_16x16x32_bf16 v[212:215], v[228:231], v[132:135], v[212:215]
    ds_read_b128 v[244:247], v4 offset:31744
    s_waitcnt lgkmcnt(3)
    v_mfma_f32_16x16x32_bf16 v[200:203], v[232:235], v[136:139], v[200:203]
    v_mfma_f32_16x16x32_bf16 v[204:207], v[232:235], v[140:143], v[204:207]
    s_waitcnt vmcnt(8)
    s_barrier
    ds_read_b128 v[224:227], v4 offset:32768
    s_waitcnt lgkmcnt(3)
    v_mfma_f32_16x16x32_bf16 v[208:211], v[236:239], v[136:139], v[208:211]
    v_mfma_f32_16x16x32_bf16 v[212:215], v[236:239], v[140:143], v[212:215]
    s_add_u32 s22, s24, 0x0
    s_add_u32 m0, s20, 0x10000
    s_nop 0
    buffer_load_dwordx4 v3, s[4:7], s22 offen lds
    ds_read_b128 v[228:231], v4 offset:33792
    s_waitcnt lgkmcnt(3)
    v_mfma_f32_16x16x32_bf16 v[200:203], v[240:243], v[144:147], v[200:203]
    v_mfma_f32_16x16x32_bf16 v[204:207], v[240:243], v[148:151], v[204:207]
    ds_read_b128 v[232:235], v4 offset:34816
    s_waitcnt lgkmcnt(3)
    v_mfma_f32_16x16x32_bf16 v[208:211], v[244:247], v[144:147], v[208:211]
    v_mfma_f32_16x16x32_bf16 v[212:215], v[244:247], v[148:151], v[212:215]
    ds_read_b128 v[236:239], v4 offset:35840
    s_waitcnt lgkmcnt(3)
    v_mfma_f32_16x16x32_bf16 v[184:187], v[224:227], v[24:27], 0
    v_mfma_f32_16x16x32_bf16 v[188:191], v[224:227], v[28:31], 0
    ds_read_b128 v[240:243], v4 offset:36864
    s_waitcnt lgkmcnt(3)
    v_mfma_f32_16x16x32_bf16 v[192:195], v[228:231], v[24:27], 0
    v_mfma_f32_16x16x32_bf16 v[196:199], v[228:231], v[28:31], 0
    s_add_u32 s22, s24, 0x2000
    s_add_u32 m0, s20, 0x10400
    s_nop 0
    buffer_load_dwordx4 v3, s[4:7], s22 offen lds
    ds_read_b128 v[244:247], v4 offset:37888
    v_mul_f32 v200, v200, v9
    s_waitcnt lgkmcnt(3)
    v_mfma_f32_16x16x32_bf16 v[184:187], v[232:235], v[32:35], v[184:187]
    v_mul_f32 v201, v201, v9
    v_mfma_f32_16x16x32_bf16 v[188:191], v[232:235], v[36:39], v[188:191]
    ds_read_b128 v[224:227], v4 offset:38912
    v_mul_f32 v202, v202, v9
    s_waitcnt lgkmcnt(3)
    v_mfma_f32_16x16x32_bf16 v[192:195], v[236:239], v[32:35], v[192:195]
    v_mul_f32 v203, v203, v9
    v_mfma_f32_16x16x32_bf16 v[196:199], v[236:239], v[36:39], v[196:199]
    ds_read_b128 v[228:231], v4 offset:39936
    v_mul_f32 v208, v208, v9
    s_waitcnt lgkmcnt(3)
    v_mfma_f32_16x16x32_bf16 v[184:187], v[240:243], v[40:43], v[184:187]
    v_mul_f32 v209, v209, v9
    v_mfma_f32_16x16x32_bf16 v[188:191], v[240:243], v[44:47], v[188:191]
    ds_read_b128 v[232:235], v4 offset:40960
    v_mul_f32 v210, v210, v9
    s_waitcnt lgkmcnt(3)
    v_mfma_f32_16x16x32_bf16 v[192:195], v[244:247], v[40:43], v[192:195]
    v_mul_f32 v211, v211, v9
    v_mfma_f32_16x16x32_bf16 v[196:199], v[244:247], v[44:47], v[196:199]
    ds_read_b128 v[236:239], v4 offset:41984
    v_cvt_pk_bf16_f32 v216, v200, v201
    s_waitcnt lgkmcnt(3)
    v_mfma_f32_16x16x32_bf16 v[184:187], v[224:227], v[48:51], v[184:187]
    v_cvt_pk_bf16_f32 v217, v202, v203
    s_waitcnt vmcnt(3)
    s_add_u32 s16, s63, 0x570000
    v_mov_b32 v7, s28
    v_mov_b32 v8, 0
    s_mov_b64 exec, 1
    buffer_store_dword v7, v8, s[8:11], s16 offen sc1
    s_mov_b64 exec, -1
    v_mfma_f32_16x16x32_bf16 v[188:191], v[224:227], v[52:55], v[188:191]
    ds_read_b128 v[240:243], v4 offset:43008
    v_cvt_pk_bf16_f32 v218, v208, v209
    s_waitcnt lgkmcnt(3)
    v_mfma_f32_16x16x32_bf16 v[192:195], v[228:231], v[48:51], v[192:195]
    v_cvt_pk_bf16_f32 v219, v210, v211
    v_mfma_f32_16x16x32_bf16 v[196:199], v[228:231], v[52:55], v[196:199]
    ds_read_b128 v[244:247], v4 offset:44032
    buffer_store_dwordx4 v[216:219], v2, s[8:11], s25 offen offset:1024 sc1
    s_waitcnt lgkmcnt(3)
    v_mfma_f32_16x16x32_bf16 v[184:187], v[232:235], v[56:59], v[184:187]
    v_mul_f32 v204, v204, v10
    v_mfma_f32_16x16x32_bf16 v[188:191], v[232:235], v[60:63], v[188:191]
    ds_read_b128 v[224:227], v4 offset:45056
    v_mul_f32 v205, v205, v10
    s_waitcnt lgkmcnt(3)
    v_mfma_f32_16x16x32_bf16 v[192:195], v[236:239], v[56:59], v[192:195]
    v_mul_f32 v206, v206, v10
    v_mfma_f32_16x16x32_bf16 v[196:199], v[236:239], v[60:63], v[196:199]
    ds_read_b128 v[228:231], v4 offset:46080
    v_mul_f32 v207, v207, v10
    s_waitcnt lgkmcnt(3)
    v_mfma_f32_16x16x32_bf16 v[184:187], v[240:243], v[64:67], v[184:187]
    v_mul_f32 v212, v212, v10
    v_mfma_f32_16x16x32_bf16 v[188:191], v[240:243], v[68:71], v[188:191]
    ds_read_b128 v[232:235], v4 offset:47104
    v_mul_f32 v213, v213, v10
    s_waitcnt lgkmcnt(3)
    v_mfma_f32_16x16x32_bf16 v[192:195], v[244:247], v[64:67], v[192:195]
    v_mul_f32 v214, v214, v10
    v_mfma_f32_16x16x32_bf16 v[196:199], v[244:247], v[68:71], v[196:199]
    ds_read_b128 v[236:239], v4 offset:48128
    v_mul_f32 v215, v215, v10
    s_waitcnt lgkmcnt(3)
    v_mfma_f32_16x16x32_bf16 v[184:187], v[224:227], v[72:75], v[184:187]
    v_cvt_pk_bf16_f32 v220, v204, v205
    v_mfma_f32_16x16x32_bf16 v[188:191], v[224:227], v[76:79], v[188:191]
    s_barrier
    ds_read_b128 v[240:243], v4 offset:49152
    v_cvt_pk_bf16_f32 v221, v206, v207
    s_waitcnt lgkmcnt(3)
    v_mfma_f32_16x16x32_bf16 v[192:195], v[228:231], v[72:75], v[192:195]
    v_cvt_pk_bf16_f32 v222, v212, v213
    v_mfma_f32_16x16x32_bf16 v[196:199], v[228:231], v[76:79], v[196:199]
    s_add_u32 s22, s24, 0x80000
    s_add_u32 m0, s20, 0x14000
    s_nop 0
    buffer_load_dwordx4 v3, s[4:7], s22 offen lds
    ds_read_b128 v[244:247], v4 offset:50176
    v_cvt_pk_bf16_f32 v223, v214, v215
    s_waitcnt lgkmcnt(3)
    v_mfma_f32_16x16x32_bf16 v[184:187], v[232:235], v[80:83], v[184:187]
    buffer_store_dwordx4 v[220:223], v2, s[8:11], s26 offen offset:1024 sc1
    v_mfma_f32_16x16x32_bf16 v[188:191], v[232:235], v[84:87], v[188:191]
    ds_read_b128 v[224:227], v4 offset:51200
    s_waitcnt lgkmcnt(3)
    v_mfma_f32_16x16x32_bf16 v[192:195], v[236:239], v[80:83], v[192:195]
    v_mfma_f32_16x16x32_bf16 v[196:199], v[236:239], v[84:87], v[196:199]
    ds_read_b128 v[228:231], v4 offset:52224
    s_waitcnt lgkmcnt(3)
    v_mfma_f32_16x16x32_bf16 v[184:187], v[240:243], v[88:91], v[184:187]
    v_mfma_f32_16x16x32_bf16 v[188:191], v[240:243], v[92:95], v[188:191]
    ds_read_b128 v[232:235], v4 offset:53248
    s_waitcnt lgkmcnt(3)
    v_mfma_f32_16x16x32_bf16 v[192:195], v[244:247], v[88:91], v[192:195]
    v_mfma_f32_16x16x32_bf16 v[196:199], v[244:247], v[92:95], v[196:199]
    s_add_u32 s22, s24, 0x82000
    s_add_u32 m0, s20, 0x14400
    s_nop 0
    buffer_load_dwordx4 v3, s[4:7], s22 offen lds
    ds_read_b128 v[236:239], v4 offset:54272
    s_waitcnt lgkmcnt(3)
    v_mfma_f32_16x16x32_bf16 v[184:187], v[224:227], v[96:99], v[184:187]
    v_mfma_f32_16x16x32_bf16 v[188:191], v[224:227], v[100:103], v[188:191]
    ds_read_b128 v[240:243], v4 offset:55296
    s_waitcnt lgkmcnt(3)
    v_mfma_f32_16x16x32_bf16 v[192:195], v[228:231], v[96:99], v[192:195]
    v_mfma_f32_16x16x32_bf16 v[196:199], v[228:231], v[100:103], v[196:199]
    ds_read_b128 v[244:247], v4 offset:56320
    s_waitcnt lgkmcnt(3)
    v_mfma_f32_16x16x32_bf16 v[184:187], v[232:235], v[104:107], v[184:187]
    v_mfma_f32_16x16x32_bf16 v[188:191], v[232:235], v[108:111], v[188:191]
    ds_read_b128 v[224:227], v4 offset:57344
    s_waitcnt lgkmcnt(3)
    v_mfma_f32_16x16x32_bf16 v[192:195], v[236:239], v[104:107], v[192:195]
    v_mfma_f32_16x16x32_bf16 v[196:199], v[236:239], v[108:111], v[196:199]
    ds_read_b128 v[228:231], v4 offset:58368
    s_waitcnt lgkmcnt(3)
    v_mfma_f32_16x16x32_bf16 v[184:187], v[240:243], v[112:115], v[184:187]
    v_mfma_f32_16x16x32_bf16 v[188:191], v[240:243], v[116:119], v[188:191]
    ds_read_b128 v[232:235], v4 offset:59392
    s_waitcnt lgkmcnt(3)
    v_mfma_f32_16x16x32_bf16 v[192:195], v[244:247], v[112:115], v[192:195]
    v_mfma_f32_16x16x32_bf16 v[196:199], v[244:247], v[116:119], v[196:199]
    ds_read_b128 v[236:239], v4 offset:60416
    s_waitcnt lgkmcnt(3)
    v_mfma_f32_16x16x32_bf16 v[184:187], v[224:227], v[120:123], v[184:187]
    v_mfma_f32_16x16x32_bf16 v[188:191], v[224:227], v[124:127], v[188:191]
    ds_read_b128 v[240:243], v4 offset:61440
    s_waitcnt lgkmcnt(3)
    v_mfma_f32_16x16x32_bf16 v[192:195], v[228:231], v[120:123], v[192:195]
    v_mfma_f32_16x16x32_bf16 v[196:199], v[228:231], v[124:127], v[196:199]
    ds_read_b128 v[244:247], v4 offset:62464
    s_waitcnt lgkmcnt(3)
    v_mfma_f32_16x16x32_bf16 v[184:187], v[232:235], v[128:131], v[184:187]
    v_mfma_f32_16x16x32_bf16 v[188:191], v[232:235], v[132:135], v[188:191]
    ds_read_b128 v[224:227], v4 offset:63488
    s_waitcnt lgkmcnt(3)
    v_mfma_f32_16x16x32_bf16 v[192:195], v[236:239], v[128:131], v[192:195]
    v_mfma_f32_16x16x32_bf16 v[196:199], v[236:239], v[132:135], v[196:199]
    ds_read_b128 v[228:231], v4 offset:64512
    s_waitcnt lgkmcnt(3)
    v_mfma_f32_16x16x32_bf16 v[184:187], v[240:243], v[136:139], v[184:187]
    v_mfma_f32_16x16x32_bf16 v[188:191], v[240:243], v[140:143], v[188:191]
    s_barrier
    ds_read_b128 v[232:235], v5 offset:0
    s_waitcnt lgkmcnt(3)
    v_mfma_f32_16x16x32_bf16 v[192:195], v[244:247], v[136:139], v[192:195]
    v_mfma_f32_16x16x32_bf16 v[196:199], v[244:247], v[140:143], v[196:199]
    s_add_u32 s22, s24, 0x100000
    s_add_u32 m0, s20, 0x18000
    s_nop 0
    buffer_load_dwordx4 v3, s[4:7], s22 offen lds
    ds_read_b128 v[236:239], v5 offset:1024
    s_waitcnt lgkmcnt(3)
    v_mfma_f32_16x16x32_bf16 v[184:187], v[224:227], v[144:147], v[184:187]
    v_mfma_f32_16x16x32_bf16 v[188:191], v[224:227], v[148:151], v[188:191]
    ds_read_b128 v[240:243], v5 offset:2048
    s_waitcnt lgkmcnt(3)
    v_mfma_f32_16x16x32_bf16 v[192:195], v[228:231], v[144:147], v[192:195]
    v_mfma_f32_16x16x32_bf16 v[196:199], v[228:231], v[148:151], v[196:199]
    ds_read_b128 v[244:247], v5 offset:3072
    s_waitcnt lgkmcnt(3)
    v_mfma_f32_16x16x32_bf16 v[200:203], v[232:235], v[24:27], 0
    v_mfma_f32_16x16x32_bf16 v[204:207], v[232:235], v[28:31], 0
    ds_read_b128 v[224:227], v5 offset:4096
    s_waitcnt lgkmcnt(3)
    v_mfma_f32_16x16x32_bf16 v[208:211], v[236:239], v[24:27], 0
    v_mfma_f32_16x16x32_bf16 v[212:215], v[236:239], v[28:31], 0
    s_add_u32 s22, s24, 0x102000
    s_add_u32 m0, s20, 0x18400
    s_nop 0
    buffer_load_dwordx4 v3, s[4:7], s22 offen lds
    ds_read_b128 v[228:231], v5 offset:5120
    v_mul_f32 v184, v184, v9
    s_waitcnt lgkmcnt(3)
    v_mfma_f32_16x16x32_bf16 v[200:203], v[240:243], v[32:35], v[200:203]
    v_mul_f32 v185, v185, v9
    s_bfe_u32 s30, s2, 0x20001
    s_lshl_b32 s30, s30, 2
    s_bfe_u32 s17, s2, 0x20003
    s_add_u32 s30, s30, s17
    s_lshr_b32 s31, s2, 5
    s_and_b32 s17, s3, 3
    s_lshl_b32 s19, s30, 2
    s_add_u32 s19, s19, s17
    s_and_b32 s16, s2, 1
    s_lshl_b32 s17, s19, 18
    s_lshl_b32 s23, s16, 16
    s_add_u32 s17, s17, s23
    s_add_u32 s17, s17, 0x1001000
    v_add_u32 v6, s17, v2
    s_lshl_b32 s19, s19, 7
    s_lshl_b32 s23, s16, 6
    s_add_u32 s19, s19, s23
    s_add_u32 s19, s19, 0x570000
    v_and_b32 v13, 15, v1
    v_lshlrev_b32 v13, 2, v13
    buffer_load_dword v12, v13, s[8:11], s19 offen sc1
    v_mfma_f32_16x16x32_bf16 v[204:207], v[240:243], v[36:39], v[204:207]
    ds_read_b128 v[232:235], v5 offset:6144
    v_mul_f32 v186, v186, v9
    s_waitcnt lgkmcnt(3)
    v_mfma_f32_16x16x32_bf16 v[208:211], v[244:247], v[32:35], v[208:211]
    v_mul_f32 v187, v187, v9
    v_mfma_f32_16x16x32_bf16 v[212:215], v[244:247], v[36:39], v[212:215]
    ds_read_b128 v[236:239], v5 offset:7168
    v_mul_f32 v192, v192, v9
    s_waitcnt lgkmcnt(3)
    v_mfma_f32_16x16x32_bf16 v[200:203], v[224:227], v[40:43], v[200:203]
    v_mul_f32 v193, v193, v9
    v_mfma_f32_16x16x32_bf16 v[204:207], v[224:227], v[44:47], v[204:207]
    ds_read_b128 v[240:243], v5 offset:8192
    v_mul_f32 v194, v194, v9
    s_waitcnt lgkmcnt(3)
    v_mfma_f32_16x16x32_bf16 v[208:211], v[228:231], v[40:43], v[208:211]
    v_mul_f32 v195, v195, v9
    v_mfma_f32_16x16x32_bf16 v[212:215], v[228:231], v[44:47], v[212:215]
    ds_read_b128 v[244:247], v5 offset:9216
    v_cvt_pk_bf16_f32 v216, v184, v185
    s_waitcnt lgkmcnt(3)
    v_mfma_f32_16x16x32_bf16 v[200:203], v[232:235], v[48:51], v[200:203]
    v_cvt_pk_bf16_f32 v217, v186, v187
    v_mfma_f32_16x16x32_bf16 v[204:207], v[232:235], v[52:55], v[204:207]
    ds_read_b128 v[224:227], v5 offset:10240
    v_cvt_pk_bf16_f32 v218, v192, v193
    s_waitcnt lgkmcnt(3)
    v_mfma_f32_16x16x32_bf16 v[208:211], v[236:239], v[48:51], v[208:211]
    v_cvt_pk_bf16_f32 v219, v194, v195
    v_mfma_f32_16x16x32_bf16 v[212:215], v[236:239], v[52:55], v[212:215]
    ds_read_b128 v[228:231], v5 offset:11264
    buffer_store_dwordx4 v[216:219], v2, s[8:11], s25 offen offset:2048 sc1
    s_waitcnt lgkmcnt(3)
    v_mfma_f32_16x16x32_bf16 v[200:203], v[240:243], v[56:59], v[200:203]
    v_mul_f32 v188, v188, v10
    v_mfma_f32_16x16x32_bf16 v[204:207], v[240:243], v[60:63], v[204:207]
    ds_read_b128 v[232:235], v5 offset:12288
    v_mul_f32 v189, v189, v10
    s_waitcnt lgkmcnt(3)
    v_mfma_f32_16x16x32_bf16 v[208:211], v[244:247], v[56:59], v[208:211]
    v_mul_f32 v190, v190, v10
    v_mfma_f32_16x16x32_bf16 v[212:215], v[244:247], v[60:63], v[212:215]
    ds_read_b128 v[236:239], v5 offset:13312
    v_mul_f32 v191, v191, v10
    s_waitcnt lgkmcnt(3)
    v_mfma_f32_16x16x32_bf16 v[200:203], v[224:227], v[64:67], v[200:203]
    v_mul_f32 v196, v196, v10
    v_mfma_f32_16x16x32_bf16 v[204:207], v[224:227], v[68:71], v[204:207]
    ds_read_b128 v[240:243], v5 offset:14336
    v_mul_f32 v197, v197, v10
    s_waitcnt lgkmcnt(3)
    v_mfma_f32_16x16x32_bf16 v[208:211], v[228:231], v[64:67], v[208:211]
    v_mul_f32 v198, v198, v10
    v_mfma_f32_16x16x32_bf16 v[212:215], v[228:231], v[68:71], v[212:215]
    ds_read_b128 v[244:247], v5 offset:15360
    v_mul_f32 v199, v199, v10
    s_waitcnt lgkmcnt(3)
    v_mfma_f32_16x16x32_bf16 v[200:203], v[232:235], v[72:75], v[200:203]
    v_cvt_pk_bf16_f32 v220, v188, v189
    v_mfma_f32_16x16x32_bf16 v[204:207], v[232:235], v[76:79], v[204:207]
    s_waitcnt vmcnt(11)
    s_barrier
    ds_read_b128 v[224:227], v5 offset:16384
    v_cvt_pk_bf16_f32 v221, v190, v191
    s_waitcnt lgkmcnt(3)
    v_mfma_f32_16x16x32_bf16 v[208:211], v[236:239], v[72:75], v[208:211]
    v_cvt_pk_bf16_f32 v222, v196, v197
    v_mfma_f32_16x16x32_bf16 v[212:215], v[236:239], v[76:79], v[212:215]
    s_add_u32 s22, s24, 0x180000
    s_add_u32 m0, s20, 0x1c000
    s_nop 0
    buffer_load_dwordx4 v3, s[4:7], s22 offen lds
    ds_read_b128 v[228:231], v5 offset:17408
    v_cvt_pk_bf16_f32 v223, v198, v199
    s_waitcnt lgkmcnt(3)
    v_mfma_f32_16x16x32_bf16 v[200:203], v[240:243], v[80:83], v[200:203]
    buffer_store_dwordx4 v[220:223], v2, s[8:11], s26 offen offset:2048 sc1
    v_mfma_f32_16x16x32_bf16 v[204:207], v[240:243], v[84:87], v[204:207]
    ds_read_b128 v[232:235], v5 offset:18432
    s_waitcnt lgkmcnt(3)
    v_mfma_f32_16x16x32_bf16 v[208:211], v[244:247], v[80:83], v[208:211]
    v_mfma_f32_16x16x32_bf16 v[212:215], v[244:247], v[84:87], v[212:215]
    ds_read_b128 v[236:239], v5 offset:19456
    s_waitcnt lgkmcnt(3)
    v_mfma_f32_16x16x32_bf16 v[200:203], v[224:227], v[88:91], v[200:203]
    v_mfma_f32_16x16x32_bf16 v[204:207], v[224:227], v[92:95], v[204:207]
    ds_read_b128 v[240:243], v5 offset:20480
    s_waitcnt vmcnt(3)
    v_cmp_ne_u32 vcc, s28, v12
    s_cbranch_vccnz adaLN_cond__sliding_block_cached__moe_arch_mod__prompt_kernel_o17r
adaLN_cond__sliding_block_cached__moe_arch_mod__prompt_kernel_o17b:
    s_waitcnt lgkmcnt(3)
    v_mfma_f32_16x16x32_bf16 v[208:211], v[228:231], v[88:91], v[208:211]
    s_mov_b32 s23, 0x0
    buffer_load_dwordx4 v[24:27], v6, s[8:11], s23 offen offset:0 sc1
    v_mfma_f32_16x16x32_bf16 v[212:215], v[228:231], v[92:95], v[212:215]
    s_add_u32 s22, s24, 0x182000
    s_add_u32 m0, s20, 0x1c400
    s_nop 0
    buffer_load_dwordx4 v3, s[4:7], s22 offen lds
    ds_read_b128 v[244:247], v5 offset:21504
    s_waitcnt lgkmcnt(3)
    v_mfma_f32_16x16x32_bf16 v[200:203], v[232:235], v[96:99], v[200:203]
    v_mfma_f32_16x16x32_bf16 v[204:207], v[232:235], v[100:103], v[204:207]
    ds_read_b128 v[224:227], v5 offset:22528
    s_mov_b32 s23, 0x20000
    buffer_load_dwordx4 v[28:31], v6, s[8:11], s23 offen offset:0 sc1
    s_waitcnt lgkmcnt(3)
    v_mfma_f32_16x16x32_bf16 v[208:211], v[236:239], v[96:99], v[208:211]
    s_add_u32 s16, s63, 0x572000
    v_mov_b32 v14, s28
    v_mov_b32 v15, 0
    s_mov_b64 exec, 1
    buffer_store_dword v14, v15, s[8:11], s16 offen sc1
    s_mov_b64 exec, -1
    v_mfma_f32_16x16x32_bf16 v[212:215], v[236:239], v[100:103], v[212:215]
    ds_read_b128 v[228:231], v5 offset:23552
    s_waitcnt lgkmcnt(3)
    v_mfma_f32_16x16x32_bf16 v[200:203], v[240:243], v[104:107], v[200:203]
    s_mov_b32 s23, 0x2000
    buffer_load_dwordx4 v[32:35], v6, s[8:11], s23 offen offset:0 sc1
    v_mfma_f32_16x16x32_bf16 v[204:207], v[240:243], v[108:111], v[204:207]
    ds_read_b128 v[232:235], v5 offset:24576
    s_waitcnt lgkmcnt(3)
    v_mfma_f32_16x16x32_bf16 v[208:211], v[244:247], v[104:107], v[208:211]
    v_mfma_f32_16x16x32_bf16 v[212:215], v[244:247], v[108:111], v[212:215]
    ds_read_b128 v[236:239], v5 offset:25600
    s_mov_b32 s23, 0x22000
    buffer_load_dwordx4 v[36:39], v6, s[8:11], s23 offen offset:0 sc1
    s_waitcnt lgkmcnt(3)
    v_mfma_f32_16x16x32_bf16 v[200:203], v[224:227], v[112:115], v[200:203]
    v_mfma_f32_16x16x32_bf16 v[204:207], v[224:227], v[116:119], v[204:207]
    ds_read_b128 v[240:243], v5 offset:26624
    s_waitcnt lgkmcnt(3)
    v_mfma_f32_16x16x32_bf16 v[208:211], v[228:231], v[112:115], v[208:211]
    s_mov_b32 s23, 0x4000
    buffer_load_dwordx4 v[40:43], v6, s[8:11], s23 offen offset:0 sc1
    v_mfma_f32_16x16x32_bf16 v[212:215], v[228:231], v[116:119], v[212:215]
    ds_read_b128 v[244:247], v5 offset:27648
    s_waitcnt lgkmcnt(3)
    v_mfma_f32_16x16x32_bf16 v[200:203], v[232:235], v[120:123], v[200:203]
    v_mfma_f32_16x16x32_bf16 v[204:207], v[232:235], v[124:127], v[204:207]
    ds_read_b128 v[224:227], v5 offset:28672
    s_mov_b32 s23, 0x24000
    buffer_load_dwordx4 v[44:47], v6, s[8:11], s23 offen offset:0 sc1
    s_waitcnt lgkmcnt(3)
    v_mfma_f32_16x16x32_bf16 v[208:211], v[236:239], v[120:123], v[208:211]
    v_mfma_f32_16x16x32_bf16 v[212:215], v[236:239], v[124:127], v[212:215]
    ds_read_b128 v[228:231], v5 offset:29696
    s_waitcnt lgkmcnt(3)
    v_mfma_f32_16x16x32_bf16 v[200:203], v[240:243], v[128:131], v[200:203]
    s_mov_b32 s23, 0x6000
    buffer_load_dwordx4 v[48:51], v6, s[8:11], s23 offen offset:0 sc1
    v_mfma_f32_16x16x32_bf16 v[204:207], v[240:243], v[132:135], v[204:207]
    ds_read_b128 v[232:235], v5 offset:30720
    s_waitcnt lgkmcnt(3)
    v_mfma_f32_16x16x32_bf16 v[208:211], v[244:247], v[128:131], v[208:211]
    v_mfma_f32_16x16x32_bf16 v[212:215], v[244:247], v[132:135], v[212:215]
    ds_read_b128 v[236:239], v5 offset:31744
    s_mov_b32 s23, 0x26000
    buffer_load_dwordx4 v[52:55], v6, s[8:11], s23 offen offset:0 sc1
    s_waitcnt lgkmcnt(3)
    v_mfma_f32_16x16x32_bf16 v[200:203], v[224:227], v[136:139], v[200:203]
    v_bfe_u32 v18, v1, 2, 2
    v_lshrrev_b32 v19, 4, v1
    v_mfma_f32_16x16x32_bf16 v[204:207], v[224:227], v[140:143], v[204:207]
    v_and_b32 v17, 3, v1
    v_lshlrev_b32 v16, 11, v19
    s_waitcnt lgkmcnt(2)
    v_mfma_f32_16x16x32_bf16 v[208:211], v[228:231], v[136:139], v[208:211]
    v_lshl_add_u32 v16, v18, 6, v16
    v_lshl_add_u32 v16, v17, 3, v16
    v_mfma_f32_16x16x32_bf16 v[212:215], v[228:231], v[140:143], v[212:215]
    v_add_u32 v16, 0x12000, v16
    v_and_b32 v19, 1, v19
    s_waitcnt lgkmcnt(1)
    v_mfma_f32_16x16x32_bf16 v[200:203], v[232:235], v[144:147], v[200:203]
    v_lshlrev_b32 v19, 5, v19
    v_sub_u32 v5, v16, v19
    v_mfma_f32_16x16x32_bf16 v[204:207], v[232:235], v[148:151], v[204:207]
    v_add_u32 v4, v16, v19
    v_add_u32 v7, 0x10000, v4
    s_waitcnt lgkmcnt(0)
    v_mfma_f32_16x16x32_bf16 v[208:211], v[236:239], v[144:147], v[208:211]
    v_add_u32 v8, 0x10000, v5
    v_mfma_f32_16x16x32_bf16 v[212:215], v[236:239], v[148:151], v[212:215]
    v_mul_f32 v200, v200, v9
    v_mul_f32 v201, v201, v9
    v_mul_f32 v202, v202, v9
    v_mul_f32 v203, v203, v9
    s_nop 1
    v_mul_f32 v208, v208, v9
    v_mul_f32 v209, v209, v9
    v_mul_f32 v210, v210, v9
    v_mul_f32 v211, v211, v9
    v_cvt_pk_bf16_f32 v216, v200, v201
    v_cvt_pk_bf16_f32 v217, v202, v203
    v_cvt_pk_bf16_f32 v218, v208, v209
    v_cvt_pk_bf16_f32 v219, v210, v211
    buffer_store_dwordx4 v[216:219], v2, s[8:11], s25 offen offset:3072 sc1
    v_mul_f32 v204, v204, v10
    v_mul_f32 v205, v205, v10
    v_mul_f32 v206, v206, v10
    v_mul_f32 v207, v207, v10
    v_mul_f32 v212, v212, v10
    v_mul_f32 v213, v213, v10
    v_mul_f32 v214, v214, v10
    v_mul_f32 v215, v215, v10
    v_cvt_pk_bf16_f32 v220, v204, v205
    v_cvt_pk_bf16_f32 v221, v206, v207
    v_cvt_pk_bf16_f32 v222, v212, v213
    v_cvt_pk_bf16_f32 v223, v214, v215
    buffer_store_dwordx4 v[220:223], v2, s[8:11], s26 offen offset:3072 sc1
    s_and_b32 s15, s2, 1
    s_barrier
    ds_read_b64_tr_b16 v[224:225], v4 offset:0
    ds_read_b64_tr_b16 v[226:227], v4 offset:1024
    ds_read_b64_tr_b16 v[228:229], v5 offset:32
    ds_read_b64_tr_b16 v[230:231], v5 offset:1056
    ds_read_b64_tr_b16 v[232:233], v4 offset:256
    ds_read_b64_tr_b16 v[234:235], v4 offset:1280
    ds_read_b64_tr_b16 v[236:237], v5 offset:288
    ds_read_b64_tr_b16 v[238:239], v5 offset:1312
    s_waitcnt vmcnt(11) lgkmcnt(6)
    v_mfma_f32_16x16x32_bf16 v[88:91], v[224:227], v[24:27], 0
    ds_read_b64_tr_b16 v[240:241], v4 offset:512
    s_waitcnt vmcnt(9)
    v_mfma_f32_16x16x32_bf16 v[92:95], v[224:227], v[28:31], 0
    ds_read_b64_tr_b16 v[242:243], v4 offset:1536
    s_waitcnt lgkmcnt(6)
    v_mfma_f32_16x16x32_bf16 v[96:99], v[228:231], v[24:27], 0
    ds_read_b64_tr_b16 v[244:245], v5 offset:544
    v_mfma_f32_16x16x32_bf16 v[100:103], v[228:231], v[28:31], 0
    ds_read_b64_tr_b16 v[246:247], v5 offset:1568
    s_waitcnt lgkmcnt(6)
    v_mfma_f32_16x16x32_bf16 v[104:107], v[232:235], v[24:27], 0
    ds_read_b64_tr_b16 v[224:225], v4 offset:768
    v_mfma_f32_16x16x32_bf16 v[108:111], v[232:235], v[28:31], 0
    ds_read_b64_tr_b16 v[226:227], v4 offset:1792
    s_waitcnt lgkmcnt(6)
    v_mfma_f32_16x16x32_bf16 v[112:115], v[236:239], v[24:27], 0
    ds_read_b64_tr_b16 v[228:229], v5 offset:800
    v_mfma_f32_16x16x32_bf16 v[116:119], v[236:239], v[28:31], 0
    ds_read_b64_tr_b16 v[230:231], v5 offset:1824
    s_waitcnt lgkmcnt(6)
    v_mfma_f32_16x16x32_bf16 v[120:123], v[240:243], v[24:27], 0
    s_add_u32 s22, s24, 0x200000
    s_add_u32 m0, s20, 0x20000
    s_nop 0
    buffer_load_dwordx4 v3, s[4:7], s22 offen lds
    v_mfma_f32_16x16x32_bf16 v[124:127], v[240:243], v[28:31], 0
    s_barrier
    ds_read_b64_tr_b16 v[232:233], v4 offset:16384
    ds_read_b64_tr_b16 v[234:235], v4 offset:17408
    s_waitcnt lgkmcnt(6)
    v_mfma_f32_16x16x32_bf16 v[128:131], v[244:247], v[24:27], 0
    ds_read_b64_tr_b16 v[236:237], v5 offset:16416
    s_mov_b32 s23, 0x8000
    buffer_load_dwordx4 v[56:59], v6, s[8:11], s23 offen offset:0 sc1
    v_mfma_f32_16x16x32_bf16 v[132:135], v[244:247], v[28:31], 0
    s_add_u32 s22, s24, 0x202000
    s_add_u32 m0, s20, 0x20400
    s_nop 0
    buffer_load_dwordx4 v3, s[4:7], s22 offen lds
    ds_read_b64_tr_b16 v[238:239], v5 offset:17440
    s_waitcnt lgkmcnt(6)
    v_mfma_f32_16x16x32_bf16 v[136:139], v[224:227], v[24:27], 0
    ds_read_b64_tr_b16 v[240:241], v4 offset:16640
    v_mfma_f32_16x16x32_bf16 v[140:143], v[224:227], v[28:31], 0
    ds_read_b64_tr_b16 v[242:243], v4 offset:17664
    s_mov_b32 s23, 0x28000
    buffer_load_dwordx4 v[60:63], v6, s[8:11], s23 offen offset:0 sc1
    s_waitcnt lgkmcnt(6)
    v_mfma_f32_16x16x32_bf16 v[144:147], v[228:231], v[24:27], 0
    ds_read_b64_tr_b16 v[244:245], v5 offset:16672
    v_mfma_f32_16x16x32_bf16 v[148:151], v[228:231], v[28:31], 0
    ds_read_b64_tr_b16 v[246:247], v5 offset:17696
    s_waitcnt vmcnt(11) lgkmcnt(6)
    v_mfma_f32_16x16x32_bf16 v[88:91], v[232:235], v[32:35], v[88:91]
    ds_read_b64_tr_b16 v[224:225], v4 offset:16896
    s_waitcnt vmcnt(10)
    v_mfma_f32_16x16x32_bf16 v[92:95], v[232:235], v[36:39], v[92:95]
    s_add_u32 s22, s24, 0x280000
    s_add_u32 m0, s20, 0x24000
    s_nop 0
    buffer_load_dwordx4 v3, s[4:7], s22 offen lds
    ds_read_b64_tr_b16 v[226:227], v4 offset:17920
    s_waitcnt lgkmcnt(6)
    v_mfma_f32_16x16x32_bf16 v[96:99], v[236:239], v[32:35], v[96:99]
    ds_read_b64_tr_b16 v[228:229], v5 offset:16928
    v_mfma_f32_16x16x32_bf16 v[100:103], v[236:239], v[36:39], v[100:103]
    ds_read_b64_tr_b16 v[230:231], v5 offset:17952
    s_waitcnt lgkmcnt(6)
    v_mfma_f32_16x16x32_bf16 v[104:107], v[240:243], v[32:35], v[104:107]
    s_add_u32 s22, s24, 0x282000
    s_add_u32 m0, s20, 0x24400
    s_nop 0
    buffer_load_dwordx4 v3, s[4:7], s22 offen lds
    ds_read_b64_tr_b16 v[232:233], v4 offset:17152
    v_mfma_f32_16x16x32_bf16 v[108:111], v[240:243], v[36:39], v[108:111]
    ds_read_b64_tr_b16 v[234:235], v4 offset:18176
    s_waitcnt lgkmcnt(6)
    v_mfma_f32_16x16x32_bf16 v[112:115], v[244:247], v[32:35], v[112:115]
    ds_read_b64_tr_b16 v[236:237], v5 offset:17184
    v_mfma_f32_16x16x32_bf16 v[116:119], v[244:247], v[36:39], v[116:119]
    ds_read_b64_tr_b16 v[238:239], v5 offset:18208
    s_waitcnt lgkmcnt(6)
    v_mfma_f32_16x16x32_bf16 v[120:123], v[224:227], v[32:35], v[120:123]
    v_mfma_f32_16x16x32_bf16 v[124:127], v[224:227], v[36:39], v[124:127]
    s_barrier
    ds_read_b64_tr_b16 v[240:241], v4 offset:32768
    ds_read_b64_tr_b16 v[242:243], v4 offset:33792
    s_waitcnt lgkmcnt(6)
    v_mfma_f32_16x16x32_bf16 v[128:131], v[228:231], v[32:35], v[128:131]
    ds_read_b64_tr_b16 v[244:245], v5 offset:32800
    s_mov_b32 s23, 0xa000
    buffer_load_dwordx4 v[24:27], v6, s[8:11], s23 offen offset:0 sc1
    v_mfma_f32_16x16x32_bf16 v[132:135], v[228:231], v[36:39], v[132:135]
    ds_read_b64_tr_b16 v[246:247], v5 offset:33824
    s_waitcnt lgkmcnt(6)
    v_mfma_f32_16x16x32_bf16 v[136:139], v[232:235], v[32:35], v[136:139]
    ds_read_b64_tr_b16 v[224:225], v4 offset:33024
    v_mfma_f32_16x16x32_bf16 v[140:143], v[232:235], v[36:39], v[140:143]
    ds_read_b64_tr_b16 v[226:227], v4 offset:34048
    s_mov_b32 s23, 0x2a000
    buffer_load_dwordx4 v[28:31], v6, s[8:11], s23 offen offset:0 sc1
    s_waitcnt lgkmcnt(6)
    v_mfma_f32_16x16x32_bf16 v[144:147], v[236:239], v[32:35], v[144:147]
    s_add_u32 s16, s63, 0x574000
    v_mov_b32 v14, s28
    v_mov_b32 v15, 0
    s_mov_b64 exec, 1
    buffer_store_dword v14, v15, s[8:11], s16 offen sc1
    s_mov_b64 exec, -1
    ds_read_b64_tr_b16 v[228:229], v5 offset:33056
    v_mfma_f32_16x16x32_bf16 v[148:151], v[236:239], v[36:39], v[148:151]
    ds_read_b64_tr_b16 v[230:231], v5 offset:34080
    s_waitcnt vmcnt(14) lgkmcnt(6)
    v_mfma_f32_16x16x32_bf16 v[88:91], v[240:243], v[40:43], v[88:91]
    ds_read_b64_tr_b16 v[232:233], v4 offset:33280
    s_waitcnt vmcnt(13)
    v_mfma_f32_16x16x32_bf16 v[92:95], v[240:243], v[44:47], v[92:95]
    s_add_u32 s22, s24, 0x300000
    s_add_u32 m0, s20, 0x10000
    s_nop 0
    buffer_load_dwordx4 v3, s[4:7], s22 offen lds
    ds_read_b64_tr_b16 v[234:235], v4 offset:34304
    s_waitcnt lgkmcnt(6)
    v_mfma_f32_16x16x32_bf16 v[96:99], v[244:247], v[40:43], v[96:99]
    ds_read_b64_tr_b16 v[236:237], v5 offset:33312
    v_mfma_f32_16x16x32_bf16 v[100:103], v[244:247], v[44:47], v[100:103]
    ds_read_b64_tr_b16 v[238:239], v5 offset:34336
    s_waitcnt lgkmcnt(6)
    v_mfma_f32_16x16x32_bf16 v[104:107], v[224:227], v[40:43], v[104:107]
    s_add_u32 s22, s24, 0x302000
    s_add_u32 m0, s20, 0x10400
    s_nop 0
    buffer_load_dwordx4 v3, s[4:7], s22 offen lds
    ds_read_b64_tr_b16 v[240:241], v4 offset:33536
    v_mfma_f32_16x16x32_bf16 v[108:111], v[224:227], v[44:47], v[108:111]
    ds_read_b64_tr_b16 v[242:243], v4 offset:34560
    s_waitcnt lgkmcnt(6)
    v_mfma_f32_16x16x32_bf16 v[112:115], v[228:231], v[40:43], v[112:115]
    ds_read_b64_tr_b16 v[244:245], v5 offset:33568
    v_mfma_f32_16x16x32_bf16 v[116:119], v[228:231], v[44:47], v[116:119]
    ds_read_b64_tr_b16 v[246:247], v5 offset:34592
    s_waitcnt lgkmcnt(6)
    v_mfma_f32_16x16x32_bf16 v[120:123], v[232:235], v[40:43], v[120:123]
    v_mfma_f32_16x16x32_bf16 v[124:127], v[232:235], v[44:47], v[124:127]
    s_barrier
    ds_read_b64_tr_b16 v[224:225], v4 offset:49152
    ds_read_b64_tr_b16 v[226:227], v4 offset:50176
    s_add_u32 s19, s19, 8192
    buffer_load_dword v12, v13, s[8:11], s19 offen sc1
    s_waitcnt lgkmcnt(6)
    v_mfma_f32_16x16x32_bf16 v[128:131], v[236:239], v[40:43], v[128:131]
    ds_read_b64_tr_b16 v[228:229], v5 offset:49184
    s_mov_b32 s23, 0xc000
    buffer_load_dwordx4 v[32:35], v6, s[8:11], s23 offen offset:0 sc1
    v_mfma_f32_16x16x32_bf16 v[132:135], v[236:239], v[44:47], v[132:135]
    ds_read_b64_tr_b16 v[230:231], v5 offset:50208
    s_waitcnt lgkmcnt(6)
    v_mfma_f32_16x16x32_bf16 v[136:139], v[240:243], v[40:43], v[136:139]
    ds_read_b64_tr_b16 v[232:233], v4 offset:49408
    v_mfma_f32_16x16x32_bf16 v[140:143], v[240:243], v[44:47], v[140:143]
    ds_read_b64_tr_b16 v[234:235], v4 offset:50432
    s_mov_b32 s23, 0x2c000
    buffer_load_dwordx4 v[36:39], v6, s[8:11], s23 offen offset:0 sc1
    s_waitcnt lgkmcnt(6)
    v_mfma_f32_16x16x32_bf16 v[144:147], v[244:247], v[40:43], v[144:147]
    ds_read_b64_tr_b16 v[236:237], v5 offset:49440
    v_mfma_f32_16x16x32_bf16 v[148:151], v[244:247], v[44:47], v[148:151]
    ds_read_b64_tr_b16 v[238:239], v5 offset:50464
    s_waitcnt vmcnt(17) lgkmcnt(6)
    v_mfma_f32_16x16x32_bf16 v[88:91], v[224:227], v[48:51], v[88:91]
    ds_read_b64_tr_b16 v[240:241], v4 offset:49664
    s_waitcnt vmcnt(16)
    v_mfma_f32_16x16x32_bf16 v[92:95], v[224:227], v[52:55], v[92:95]
    s_add_u32 s22, s24, 0x380000
    s_add_u32 m0, s20, 0x14000
    s_nop 0
    buffer_load_dwordx4 v3, s[4:7], s22 offen lds
    ds_read_b64_tr_b16 v[242:243], v4 offset:50688
    s_waitcnt lgkmcnt(6)
    v_mfma_f32_16x16x32_bf16 v[96:99], v[228:231], v[48:51], v[96:99]
    ds_read_b64_tr_b16 v[244:245], v5 offset:49696
    v_mfma_f32_16x16x32_bf16 v[100:103], v[228:231], v[52:55], v[100:103]
    ds_read_b64_tr_b16 v[246:247], v5 offset:50720
    s_waitcnt lgkmcnt(6)
    v_mfma_f32_16x16x32_bf16 v[104:107], v[232:235], v[48:51], v[104:107]
    s_add_u32 s22, s24, 0x382000
    s_add_u32 m0, s20, 0x14400
    s_nop 0
    buffer_load_dwordx4 v3, s[4:7], s22 offen lds
    ds_read_b64_tr_b16 v[224:225], v4 offset:49920
    v_mfma_f32_16x16x32_bf16 v[108:111], v[232:235], v[52:55], v[108:111]
    ds_read_b64_tr_b16 v[226:227], v4 offset:50944
    s_waitcnt lgkmcnt(6)
    v_mfma_f32_16x16x32_bf16 v[112:115], v[236:239], v[48:51], v[112:115]
    ds_read_b64_tr_b16 v[228:229], v5 offset:49952
    v_mfma_f32_16x16x32_bf16 v[116:119], v[236:239], v[52:55], v[116:119]
    ds_read_b64_tr_b16 v[230:231], v5 offset:50976
    s_waitcnt lgkmcnt(6)
    v_mfma_f32_16x16x32_bf16 v[120:123], v[240:243], v[48:51], v[120:123]
    v_mfma_f32_16x16x32_bf16 v[124:127], v[240:243], v[52:55], v[124:127]
    s_waitcnt vmcnt(13)
    s_barrier
    ds_read_b64_tr_b16 v[232:233], v7 offset:0
    ds_read_b64_tr_b16 v[234:235], v7 offset:1024
    s_waitcnt lgkmcnt(6)
    v_mfma_f32_16x16x32_bf16 v[128:131], v[244:247], v[48:51], v[128:131]
    ds_read_b64_tr_b16 v[236:237], v8 offset:32
    s_mov_b32 s23, 0xe000
    buffer_load_dwordx4 v[40:43], v6, s[8:11], s23 offen offset:0 sc1
    v_mfma_f32_16x16x32_bf16 v[132:135], v[244:247], v[52:55], v[132:135]
    ds_read_b64_tr_b16 v[238:239], v8 offset:1056
    s_waitcnt lgkmcnt(6)
    v_mfma_f32_16x16x32_bf16 v[136:139], v[224:227], v[48:51], v[136:139]
    ds_read_b64_tr_b16 v[240:241], v7 offset:256
    v_mfma_f32_16x16x32_bf16 v[140:143], v[224:227], v[52:55], v[140:143]
    ds_read_b64_tr_b16 v[242:243], v7 offset:1280
    s_mov_b32 s23, 0x2e000
    buffer_load_dwordx4 v[44:47], v6, s[8:11], s23 offen offset:0 sc1
    s_waitcnt lgkmcnt(6)
    v_mfma_f32_16x16x32_bf16 v[144:147], v[228:231], v[48:51], v[144:147]
    ds_read_b64_tr_b16 v[244:245], v8 offset:288
    v_mfma_f32_16x16x32_bf16 v[148:151], v[228:231], v[52:55], v[148:151]
    ds_read_b64_tr_b16 v[246:247], v8 offset:1312
    s_waitcnt vmcnt(6)
    v_cmp_ne_u32 vcc, s28, v12
    s_cbranch_vccnz adaLN_cond__sliding_block_cached__moe_arch_mod__prompt_kernel_o218r
adaLN_cond__sliding_block_cached__moe_arch_mod__prompt_kernel_o218b:
    s_waitcnt lgkmcnt(6)
    v_mfma_f32_16x16x32_bf16 v[88:91], v[232:235], v[56:59], v[88:91]
    ds_read_b64_tr_b16 v[224:225], v7 offset:512
    v_mfma_f32_16x16x32_bf16 v[92:95], v[232:235], v[60:63], v[92:95]
    s_add_u32 s22, s24, 0x10000
    s_add_u32 m0, s20, 0x18000
    s_nop 0
    buffer_load_dwordx4 v3, s[4:7], s22 offen lds
    ds_read_b64_tr_b16 v[226:227], v7 offset:1536
    s_waitcnt lgkmcnt(6)
    v_mfma_f32_16x16x32_bf16 v[96:99], v[236:239], v[56:59], v[96:99]
    ds_read_b64_tr_b16 v[228:229], v8 offset:544
    v_mfma_f32_16x16x32_bf16 v[100:103], v[236:239], v[60:63], v[100:103]
    ds_read_b64_tr_b16 v[230:231], v8 offset:1568
    s_waitcnt lgkmcnt(6)
    v_mfma_f32_16x16x32_bf16 v[104:107], v[240:243], v[56:59], v[104:107]
    s_add_u32 s22, s24, 0x12000
    s_add_u32 m0, s20, 0x18400
    s_nop 0
    buffer_load_dwordx4 v3, s[4:7], s22 offen lds
    ds_read_b64_tr_b16 v[232:233], v7 offset:768
    v_mfma_f32_16x16x32_bf16 v[108:111], v[240:243], v[60:63], v[108:111]
    ds_read_b64_tr_b16 v[234:235], v7 offset:1792
    s_waitcnt lgkmcnt(6)
    v_mfma_f32_16x16x32_bf16 v[112:115], v[244:247], v[56:59], v[112:115]
    ds_read_b64_tr_b16 v[236:237], v8 offset:800
    v_mfma_f32_16x16x32_bf16 v[116:119], v[244:247], v[60:63], v[116:119]
    ds_read_b64_tr_b16 v[238:239], v8 offset:1824
    s_waitcnt lgkmcnt(6)
    v_mfma_f32_16x16x32_bf16 v[120:123], v[224:227], v[56:59], v[120:123]
    v_mfma_f32_16x16x32_bf16 v[124:127], v[224:227], v[60:63], v[124:127]
    s_barrier
    ds_read_b64_tr_b16 v[240:241], v7 offset:16384
    ds_read_b64_tr_b16 v[242:243], v7 offset:17408
    s_waitcnt lgkmcnt(6)
    v_mfma_f32_16x16x32_bf16 v[128:131], v[228:231], v[56:59], v[128:131]
    ds_read_b64_tr_b16 v[244:245], v8 offset:16416
    s_mov_b32 s23, 0x0
    buffer_load_dwordx4 v[48:51], v6, s[8:11], s23 offen offset:1024 sc1
    v_mfma_f32_16x16x32_bf16 v[132:135], v[228:231], v[60:63], v[132:135]
    ds_read_b64_tr_b16 v[246:247], v8 offset:17440
    s_waitcnt lgkmcnt(6)
    v_mfma_f32_16x16x32_bf16 v[136:139], v[232:235], v[56:59], v[136:139]
    ds_read_b64_tr_b16 v[224:225], v7 offset:16640
    v_mfma_f32_16x16x32_bf16 v[140:143], v[232:235], v[60:63], v[140:143]
    ds_read_b64_tr_b16 v[226:227], v7 offset:17664
    s_mov_b32 s23, 0x20000
    buffer_load_dwordx4 v[52:55], v6, s[8:11], s23 offen offset:1024 sc1
    s_waitcnt lgkmcnt(6)
    v_mfma_f32_16x16x32_bf16 v[144:147], v[236:239], v[56:59], v[144:147]
    ds_read_b64_tr_b16 v[228:229], v8 offset:16672
    v_mfma_f32_16x16x32_bf16 v[148:151], v[236:239], v[60:63], v[148:151]
    ds_read_b64_tr_b16 v[230:231], v8 offset:17696
    s_waitcnt lgkmcnt(6)
    v_mfma_f32_16x16x32_bf16 v[88:91], v[240:243], v[24:27], v[88:91]
    ds_read_b64_tr_b16 v[232:233], v7 offset:16896
    v_mfma_f32_16x16x32_bf16 v[92:95], v[240:243], v[28:31], v[92:95]
    s_add_u32 s22, s24, 0x90000
    s_add_u32 m0, s20, 0x1c000
    s_nop 0
    buffer_load_dwordx4 v3, s[4:7], s22 offen lds
    ds_read_b64_tr_b16 v[234:235], v7 offset:17920
    s_waitcnt lgkmcnt(6)
    v_mfma_f32_16x16x32_bf16 v[96:99], v[244:247], v[24:27], v[96:99]
    ds_read_b64_tr_b16 v[236:237], v8 offset:16928
    v_mfma_f32_16x16x32_bf16 v[100:103], v[244:247], v[28:31], v[100:103]
    ds_read_b64_tr_b16 v[238:239], v8 offset:17952
    s_waitcnt lgkmcnt(6)
    v_mfma_f32_16x16x32_bf16 v[104:107], v[224:227], v[24:27], v[104:107]
    s_add_u32 s22, s24, 0x92000
    s_add_u32 m0, s20, 0x1c400
    s_nop 0
    buffer_load_dwordx4 v3, s[4:7], s22 offen lds
    ds_read_b64_tr_b16 v[240:241], v7 offset:17152
    v_mfma_f32_16x16x32_bf16 v[108:111], v[224:227], v[28:31], v[108:111]
    ds_read_b64_tr_b16 v[242:243], v7 offset:18176
    s_waitcnt lgkmcnt(6)
    v_mfma_f32_16x16x32_bf16 v[112:115], v[228:231], v[24:27], v[112:115]
    ds_read_b64_tr_b16 v[244:245], v8 offset:17184
    v_mfma_f32_16x16x32_bf16 v[116:119], v[228:231], v[28:31], v[116:119]
    ds_read_b64_tr_b16 v[246:247], v8 offset:18208
    s_waitcnt lgkmcnt(6)
    v_mfma_f32_16x16x32_bf16 v[120:123], v[232:235], v[24:27], v[120:123]
    v_mfma_f32_16x16x32_bf16 v[124:127], v[232:235], v[28:31], v[124:127]
    s_barrier
    ds_read_b64_tr_b16 v[224:225], v4 offset:0
    ds_read_b64_tr_b16 v[226:227], v4 offset:1024
    s_waitcnt lgkmcnt(6)
    v_mfma_f32_16x16x32_bf16 v[128:131], v[236:239], v[24:27], v[128:131]
    s_add_u32 s16, s63, 0x576000
    v_mov_b32 v14, s28
    v_mov_b32 v15, 0
    s_mov_b64 exec, 1
    buffer_store_dword v14, v15, s[8:11], s16 offen sc1
    s_mov_b64 exec, -1
    ds_read_b64_tr_b16 v[228:229], v5 offset:32
    s_mov_b32 s23, 0x2000
    buffer_load_dwordx4 v[56:59], v6, s[8:11], s23 offen offset:1024 sc1
    v_mfma_f32_16x16x32_bf16 v[132:135], v[236:239], v[28:31], v[132:135]
    ds_read_b64_tr_b16 v[230:231], v5 offset:1056
    s_waitcnt lgkmcnt(6)
    v_mfma_f32_16x16x32_bf16 v[136:139], v[240:243], v[24:27], v[136:139]
    ds_read_b64_tr_b16 v[232:233], v4 offset:256
    v_mfma_f32_16x16x32_bf16 v[140:143], v[240:243], v[28:31], v[140:143]
    ds_read_b64_tr_b16 v[234:235], v4 offset:1280
    s_mov_b32 s23, 0x22000
    buffer_load_dwordx4 v[60:63], v6, s[8:11], s23 offen offset:1024 sc1
    s_waitcnt lgkmcnt(6)
    v_mfma_f32_16x16x32_bf16 v[144:147], v[244:247], v[24:27], v[144:147]
    ds_read_b64_tr_b16 v[236:237], v5 offset:288
    v_mfma_f32_16x16x32_bf16 v[148:151], v[244:247], v[28:31], v[148:151]
    ds_read_b64_tr_b16 v[238:239], v5 offset:1312
    s_waitcnt vmcnt(14) lgkmcnt(6)
    v_mfma_f32_16x16x32_bf16 v[88:91], v[224:227], v[32:35], v[88:91]
    ds_read_b64_tr_b16 v[240:241], v4 offset:512
    s_waitcnt vmcnt(13)
    v_mfma_f32_16x16x32_bf16 v[92:95], v[224:227], v[36:39], v[92:95]
    s_add_u32 s22, s24, 0x110000
    s_add_u32 m0, s20, 0x20000
    s_nop 0
    buffer_load_dwordx4 v3, s[4:7], s22 offen lds
    ds_read_b64_tr_b16 v[242:243], v4 offset:1536
    s_waitcnt lgkmcnt(6)
    v_mfma_f32_16x16x32_bf16 v[96:99], v[228:231], v[32:35], v[96:99]
    ds_read_b64_tr_b16 v[244:245], v5 offset:544
    v_mfma_f32_16x16x32_bf16 v[100:103], v[228:231], v[36:39], v[100:103]
    ds_read_b64_tr_b16 v[246:247], v5 offset:1568
    s_waitcnt lgkmcnt(6)
    v_mfma_f32_16x16x32_bf16 v[104:107], v[232:235], v[32:35], v[104:107]
    s_add_u32 s22, s24, 0x112000
    s_add_u32 m0, s20, 0x20400
    s_nop 0
    buffer_load_dwordx4 v3, s[4:7], s22 offen lds
    ds_read_b64_tr_b16 v[224:225], v4 offset:768
    v_mfma_f32_16x16x32_bf16 v[108:111], v[232:235], v[36:39], v[108:111]
    ds_read_b64_tr_b16 v[226:227], v4 offset:1792
    s_waitcnt lgkmcnt(6)
    v_mfma_f32_16x16x32_bf16 v[112:115], v[236:239], v[32:35], v[112:115]
    ds_read_b64_tr_b16 v[228:229], v5 offset:800
    v_mfma_f32_16x16x32_bf16 v[116:119], v[236:239], v[36:39], v[116:119]
    ds_read_b64_tr_b16 v[230:231], v5 offset:1824
    s_waitcnt lgkmcnt(6)
    v_mfma_f32_16x16x32_bf16 v[120:123], v[240:243], v[32:35], v[120:123]
    v_mfma_f32_16x16x32_bf16 v[124:127], v[240:243], v[36:39], v[124:127]
    s_waitcnt vmcnt(13)
    s_barrier
    ds_read_b64_tr_b16 v[232:233], v4 offset:16384
    ds_read_b64_tr_b16 v[234:235], v4 offset:17408
    s_waitcnt lgkmcnt(6)
    v_mfma_f32_16x16x32_bf16 v[128:131], v[244:247], v[32:35], v[128:131]
    ds_read_b64_tr_b16 v[236:237], v5 offset:16416
    s_mov_b32 s23, 0x4000
    buffer_load_dwordx4 v[24:27], v6, s[8:11], s23 offen offset:1024 sc1
    v_mfma_f32_16x16x32_bf16 v[132:135], v[244:247], v[36:39], v[132:135]
    ds_read_b64_tr_b16 v[238:239], v5 offset:17440
    s_waitcnt lgkmcnt(6)
    v_mfma_f32_16x16x32_bf16 v[136:139], v[224:227], v[32:35], v[136:139]
    ds_read_b64_tr_b16 v[240:241], v4 offset:16640
    v_mfma_f32_16x16x32_bf16 v[140:143], v[224:227], v[36:39], v[140:143]
    ds_read_b64_tr_b16 v[242:243], v4 offset:17664
    s_mov_b32 s23, 0x24000
    buffer_load_dwordx4 v[28:31], v6, s[8:11], s23 offen offset:1024 sc1
    s_waitcnt lgkmcnt(6)
    v_mfma_f32_16x16x32_bf16 v[144:147], v[228:231], v[32:35], v[144:147]
    ds_read_b64_tr_b16 v[244:245], v5 offset:16672
    v_mfma_f32_16x16x32_bf16 v[148:151], v[228:231], v[36:39], v[148:151]
    ds_read_b64_tr_b16 v[246:247], v5 offset:17696
    s_waitcnt vmcnt(14) lgkmcnt(6)
    v_mfma_f32_16x16x32_bf16 v[88:91], v[232:235], v[40:43], v[88:91]
    ds_read_b64_tr_b16 v[224:225], v4 offset:16896
    s_waitcnt vmcnt(13)
    v_mfma_f32_16x16x32_bf16 v[92:95], v[232:235], v[44:47], v[92:95]
    s_add_u32 s22, s24, 0x190000
    s_add_u32 m0, s20, 0x24000
    s_nop 0
    buffer_load_dwordx4 v3, s[4:7], s22 offen lds
    ds_read_b64_tr_b16 v[226:227], v4 offset:17920
    s_waitcnt lgkmcnt(6)
    v_mfma_f32_16x16x32_bf16 v[96:99], v[236:239], v[40:43], v[96:99]
    ds_read_b64_tr_b16 v[228:229], v5 offset:16928
    v_mfma_f32_16x16x32_bf16 v[100:103], v[236:239], v[44:47], v[100:103]
    ds_read_b64_tr_b16 v[230:231], v5 offset:17952
    s_waitcnt lgkmcnt(6)
    v_mfma_f32_16x16x32_bf16 v[104:107], v[240:243], v[40:43], v[104:107]
    s_add_u32 s22, s24, 0x192000
    s_add_u32 m0, s20, 0x24400
    s_nop 0
    buffer_load_dwordx4 v3, s[4:7], s22 offen lds
    ds_read_b64_tr_b16 v[232:233], v4 offset:17152
    v_mfma_f32_16x16x32_bf16 v[108:111], v[240:243], v[44:47], v[108:111]
    ds_read_b64_tr_b16 v[234:235], v4 offset:18176
    s_waitcnt lgkmcnt(6)
    v_mfma_f32_16x16x32_bf16 v[112:115], v[244:247], v[40:43], v[112:115]
    ds_read_b64_tr_b16 v[236:237], v5 offset:17184
    v_mfma_f32_16x16x32_bf16 v[116:119], v[244:247], v[44:47], v[116:119]
    ds_read_b64_tr_b16 v[238:239], v5 offset:18208
    s_waitcnt lgkmcnt(6)
    v_mfma_f32_16x16x32_bf16 v[120:123], v[224:227], v[40:43], v[120:123]
    v_mfma_f32_16x16x32_bf16 v[124:127], v[224:227], v[44:47], v[124:127]
    s_waitcnt vmcnt(13)
    s_barrier
    ds_read_b64_tr_b16 v[240:241], v4 offset:32768
    ds_read_b64_tr_b16 v[242:243], v4 offset:33792
    s_waitcnt lgkmcnt(6)
    v_mfma_f32_16x16x32_bf16 v[128:131], v[228:231], v[40:43], v[128:131]
    ds_read_b64_tr_b16 v[244:245], v5 offset:32800
    s_mov_b32 s23, 0x6000
    buffer_load_dwordx4 v[32:35], v6, s[8:11], s23 offen offset:1024 sc1
    v_mfma_f32_16x16x32_bf16 v[132:135], v[228:231], v[44:47], v[132:135]
    ds_read_b64_tr_b16 v[246:247], v5 offset:33824
    s_waitcnt lgkmcnt(6)
    v_mfma_f32_16x16x32_bf16 v[136:139], v[232:235], v[40:43], v[136:139]
    ds_read_b64_tr_b16 v[224:225], v4 offset:33024
    v_mfma_f32_16x16x32_bf16 v[140:143], v[232:235], v[44:47], v[140:143]
    ds_read_b64_tr_b16 v[226:227], v4 offset:34048
    s_mov_b32 s23, 0x26000
    buffer_load_dwordx4 v[36:39], v6, s[8:11], s23 offen offset:1024 sc1
    s_waitcnt lgkmcnt(6)
    v_mfma_f32_16x16x32_bf16 v[144:147], v[236:239], v[40:43], v[144:147]
    ds_read_b64_tr_b16 v[228:229], v5 offset:33056
    v_mfma_f32_16x16x32_bf16 v[148:151], v[236:239], v[44:47], v[148:151]
    ds_read_b64_tr_b16 v[230:231], v5 offset:34080
    s_waitcnt vmcnt(14) lgkmcnt(6)
    v_mfma_f32_16x16x32_bf16 v[88:91], v[240:243], v[48:51], v[88:91]
    ds_read_b64_tr_b16 v[232:233], v4 offset:33280
    s_waitcnt vmcnt(13)
    v_mfma_f32_16x16x32_bf16 v[92:95], v[240:243], v[52:55], v[92:95]
    s_add_u32 s22, s24, 0x210000
    s_add_u32 m0, s20, 0x10000
    s_nop 0
    buffer_load_dwordx4 v3, s[4:7], s22 offen lds
    ds_read_b64_tr_b16 v[234:235], v4 offset:34304
    s_waitcnt lgkmcnt(6)
    v_mfma_f32_16x16x32_bf16 v[96:99], v[244:247], v[48:51], v[96:99]
    ds_read_b64_tr_b16 v[236:237], v5 offset:33312
    v_mfma_f32_16x16x32_bf16 v[100:103], v[244:247], v[52:55], v[100:103]
    ds_read_b64_tr_b16 v[238:239], v5 offset:34336
    s_waitcnt lgkmcnt(6)
    v_mfma_f32_16x16x32_bf16 v[104:107], v[224:227], v[48:51], v[104:107]
    s_add_u32 s22, s24, 0x212000
    s_add_u32 m0, s20, 0x10400
    s_nop 0
    buffer_load_dwordx4 v3, s[4:7], s22 offen lds
    ds_read_b64_tr_b16 v[240:241], v4 offset:33536
    v_mfma_f32_16x16x32_bf16 v[108:111], v[224:227], v[52:55], v[108:111]
    ds_read_b64_tr_b16 v[242:243], v4 offset:34560
    s_waitcnt lgkmcnt(6)
    v_mfma_f32_16x16x32_bf16 v[112:115], v[228:231], v[48:51], v[112:115]
    ds_read_b64_tr_b16 v[244:245], v5 offset:33568
    v_mfma_f32_16x16x32_bf16 v[116:119], v[228:231], v[52:55], v[116:119]
    ds_read_b64_tr_b16 v[246:247], v5 offset:34592
    s_waitcnt lgkmcnt(6)
    v_mfma_f32_16x16x32_bf16 v[120:123], v[232:235], v[48:51], v[120:123]
    v_mfma_f32_16x16x32_bf16 v[124:127], v[232:235], v[52:55], v[124:127]
    s_waitcnt vmcnt(13)
    s_barrier
    ds_read_b64_tr_b16 v[224:225], v4 offset:49152
    ds_read_b64_tr_b16 v[226:227], v4 offset:50176
    s_waitcnt lgkmcnt(6)
    v_mfma_f32_16x16x32_bf16 v[128:131], v[236:239], v[48:51], v[128:131]
    ds_read_b64_tr_b16 v[228:229], v5 offset:49184
    s_mov_b32 s23, 0x8000
    buffer_load_dwordx4 v[40:43], v6, s[8:11], s23 offen offset:1024 sc1
    v_mfma_f32_16x16x32_bf16 v[132:135], v[236:239], v[52:55], v[132:135]
    ds_read_b64_tr_b16 v[230:231], v5 offset:50208
    s_waitcnt lgkmcnt(6)
    v_mfma_f32_16x16x32_bf16 v[136:139], v[240:243], v[48:51], v[136:139]
    ds_read_b64_tr_b16 v[232:233], v4 offset:49408
    v_mfma_f32_16x16x32_bf16 v[140:143], v[240:243], v[52:55], v[140:143]
    ds_read_b64_tr_b16 v[234:235], v4 offset:50432
    s_mov_b32 s23, 0x28000
    buffer_load_dwordx4 v[44:47], v6, s[8:11], s23 offen offset:1024 sc1
    s_waitcnt lgkmcnt(6)
    v_mfma_f32_16x16x32_bf16 v[144:147], v[244:247], v[48:51], v[144:147]
    ds_read_b64_tr_b16 v[236:237], v5 offset:49440
    v_mfma_f32_16x16x32_bf16 v[148:151], v[244:247], v[52:55], v[148:151]
    ds_read_b64_tr_b16 v[238:239], v5 offset:50464
    s_waitcnt vmcnt(13) lgkmcnt(6)
    v_mfma_f32_16x16x32_bf16 v[88:91], v[224:227], v[56:59], v[88:91]
    ds_read_b64_tr_b16 v[240:241], v4 offset:49664
    s_waitcnt vmcnt(12)
    v_mfma_f32_16x16x32_bf16 v[92:95], v[224:227], v[60:63], v[92:95]
    s_add_u32 s22, s24, 0x290000
    s_add_u32 m0, s20, 0x14000
    s_nop 0
    buffer_load_dwordx4 v3, s[4:7], s22 offen lds
    ds_read_b64_tr_b16 v[242:243], v4 offset:50688
    s_waitcnt lgkmcnt(6)
    v_mfma_f32_16x16x32_bf16 v[96:99], v[228:231], v[56:59], v[96:99]
    ds_read_b64_tr_b16 v[244:245], v5 offset:49696
    v_mfma_f32_16x16x32_bf16 v[100:103], v[228:231], v[60:63], v[100:103]
    ds_read_b64_tr_b16 v[246:247], v5 offset:50720
    s_waitcnt lgkmcnt(6)
    v_mfma_f32_16x16x32_bf16 v[104:107], v[232:235], v[56:59], v[104:107]
    s_add_u32 s22, s24, 0x292000
    s_add_u32 m0, s20, 0x14400
    s_nop 0
    buffer_load_dwordx4 v3, s[4:7], s22 offen lds
    ds_read_b64_tr_b16 v[224:225], v4 offset:49920
    v_mfma_f32_16x16x32_bf16 v[108:111], v[232:235], v[60:63], v[108:111]
    ds_read_b64_tr_b16 v[226:227], v4 offset:50944
    s_waitcnt lgkmcnt(6)
    v_mfma_f32_16x16x32_bf16 v[112:115], v[236:239], v[56:59], v[112:115]
    ds_read_b64_tr_b16 v[228:229], v5 offset:49952
    v_mfma_f32_16x16x32_bf16 v[116:119], v[236:239], v[60:63], v[116:119]
    ds_read_b64_tr_b16 v[230:231], v5 offset:50976
    s_waitcnt lgkmcnt(6)
    v_mfma_f32_16x16x32_bf16 v[120:123], v[240:243], v[56:59], v[120:123]
    v_mfma_f32_16x16x32_bf16 v[124:127], v[240:243], v[60:63], v[124:127]
    s_waitcnt vmcnt(12)
    s_barrier
    ds_read_b64_tr_b16 v[232:233], v7 offset:0
    ds_read_b64_tr_b16 v[234:235], v7 offset:1024
    s_waitcnt lgkmcnt(6)
    v_mfma_f32_16x16x32_bf16 v[128:131], v[244:247], v[56:59], v[128:131]
    ds_read_b64_tr_b16 v[236:237], v8 offset:32
    s_mov_b32 s23, 0xa000
    buffer_load_dwordx4 v[48:51], v6, s[8:11], s23 offen offset:1024 sc1
    v_mfma_f32_16x16x32_bf16 v[132:135], v[244:247], v[60:63], v[132:135]
    ds_read_b64_tr_b16 v[238:239], v8 offset:1056
    s_waitcnt lgkmcnt(6)
    v_mfma_f32_16x16x32_bf16 v[136:139], v[224:227], v[56:59], v[136:139]
    ds_read_b64_tr_b16 v[240:241], v7 offset:256
    v_mfma_f32_16x16x32_bf16 v[140:143], v[224:227], v[60:63], v[140:143]
    ds_read_b64_tr_b16 v[242:243], v7 offset:1280
    s_mov_b32 s23, 0x2a000
    buffer_load_dwordx4 v[52:55], v6, s[8:11], s23 offen offset:1024 sc1
    s_waitcnt lgkmcnt(6)
    v_mfma_f32_16x16x32_bf16 v[144:147], v[228:231], v[56:59], v[144:147]
    ds_read_b64_tr_b16 v[244:245], v8 offset:288
    v_mfma_f32_16x16x32_bf16 v[148:151], v[228:231], v[60:63], v[148:151]
    ds_read_b64_tr_b16 v[246:247], v8 offset:1312
    s_waitcnt vmcnt(13) lgkmcnt(6)
    v_mfma_f32_16x16x32_bf16 v[88:91], v[232:235], v[24:27], v[88:91]
    ds_read_b64_tr_b16 v[224:225], v7 offset:512
    s_waitcnt vmcnt(12)
    v_mfma_f32_16x16x32_bf16 v[92:95], v[232:235], v[28:31], v[92:95]
    s_add_u32 s22, s24, 0x310000
    s_add_u32 m0, s20, 0x18000
    s_nop 0
    buffer_load_dwordx4 v3, s[4:7], s22 offen lds
    ds_read_b64_tr_b16 v[226:227], v7 offset:1536
    s_waitcnt lgkmcnt(6)
    v_mfma_f32_16x16x32_bf16 v[96:99], v[236:239], v[24:27], v[96:99]
    ds_read_b64_tr_b16 v[228:229], v8 offset:544
    v_mfma_f32_16x16x32_bf16 v[100:103], v[236:239], v[28:31], v[100:103]
    ds_read_b64_tr_b16 v[230:231], v8 offset:1568
    s_waitcnt lgkmcnt(6)
    v_mfma_f32_16x16x32_bf16 v[104:107], v[240:243], v[24:27], v[104:107]
    s_add_u32 s22, s24, 0x312000
    s_add_u32 m0, s20, 0x18400
    s_nop 0
    buffer_load_dwordx4 v3, s[4:7], s22 offen lds
    ds_read_b64_tr_b16 v[232:233], v7 offset:768
    v_mfma_f32_16x16x32_bf16 v[108:111], v[240:243], v[28:31], v[108:111]
    ds_read_b64_tr_b16 v[234:235], v7 offset:1792
    s_waitcnt lgkmcnt(6)
    v_mfma_f32_16x16x32_bf16 v[112:115], v[244:247], v[24:27], v[112:115]
    ds_read_b64_tr_b16 v[236:237], v8 offset:800
    v_mfma_f32_16x16x32_bf16 v[116:119], v[244:247], v[28:31], v[116:119]
    ds_read_b64_tr_b16 v[238:239], v8 offset:1824
    s_waitcnt lgkmcnt(6)
    v_mfma_f32_16x16x32_bf16 v[120:123], v[224:227], v[24:27], v[120:123]
    v_mfma_f32_16x16x32_bf16 v[124:127], v[224:227], v[28:31], v[124:127]
    s_waitcnt vmcnt(12)
    s_barrier
    ds_read_b64_tr_b16 v[240:241], v7 offset:16384
    ds_read_b64_tr_b16 v[242:243], v7 offset:17408
    s_add_u32 s19, s19, 8192
    buffer_load_dword v12, v13, s[8:11], s19 offen sc1
    s_waitcnt lgkmcnt(6)
    v_mfma_f32_16x16x32_bf16 v[128:131], v[228:231], v[24:27], v[128:131]
    ds_read_b64_tr_b16 v[244:245], v8 offset:16416
    s_mov_b32 s23, 0xc000
    buffer_load_dwordx4 v[56:59], v6, s[8:11], s23 offen offset:1024 sc1
    v_mfma_f32_16x16x32_bf16 v[132:135], v[228:231], v[28:31], v[132:135]
    ds_read_b64_tr_b16 v[246:247], v8 offset:17440
    s_waitcnt lgkmcnt(6)
    v_mfma_f32_16x16x32_bf16 v[136:139], v[232:235], v[24:27], v[136:139]
    ds_read_b64_tr_b16 v[224:225], v7 offset:16640
    v_mfma_f32_16x16x32_bf16 v[140:143], v[232:235], v[28:31], v[140:143]
    ds_read_b64_tr_b16 v[226:227], v7 offset:17664
    s_mov_b32 s23, 0x2c000
    buffer_load_dwordx4 v[60:63], v6, s[8:11], s23 offen offset:1024 sc1
    s_waitcnt lgkmcnt(6)
    v_mfma_f32_16x16x32_bf16 v[144:147], v[236:239], v[24:27], v[144:147]
    ds_read_b64_tr_b16 v[228:229], v8 offset:16672
    v_mfma_f32_16x16x32_bf16 v[148:151], v[236:239], v[28:31], v[148:151]
    ds_read_b64_tr_b16 v[230:231], v8 offset:17696
    s_waitcnt vmcnt(14) lgkmcnt(6)
    v_mfma_f32_16x16x32_bf16 v[88:91], v[240:243], v[32:35], v[88:91]
    ds_read_b64_tr_b16 v[232:233], v7 offset:16896
    s_waitcnt vmcnt(13)
    v_mfma_f32_16x16x32_bf16 v[92:95], v[240:243], v[36:39], v[92:95]
    s_add_u32 s22, s24, 0x390000
    s_add_u32 m0, s20, 0x1c000
    s_nop 0
    buffer_load_dwordx4 v3, s[4:7], s22 offen lds
    ds_read_b64_tr_b16 v[234:235], v7 offset:17920
    s_waitcnt lgkmcnt(6)
    v_mfma_f32_16x16x32_bf16 v[96:99], v[244:247], v[32:35], v[96:99]
    ds_read_b64_tr_b16 v[236:237], v8 offset:16928
    v_mfma_f32_16x16x32_bf16 v[100:103], v[244:247], v[36:39], v[100:103]
    ds_read_b64_tr_b16 v[238:239], v8 offset:17952
    s_waitcnt lgkmcnt(6)
    v_mfma_f32_16x16x32_bf16 v[104:107], v[224:227], v[32:35], v[104:107]
    s_add_u32 s22, s24, 0x392000
    s_add_u32 m0, s20, 0x1c400
    s_nop 0
    buffer_load_dwordx4 v3, s[4:7], s22 offen lds
    ds_read_b64_tr_b16 v[240:241], v7 offset:17152
    v_mfma_f32_16x16x32_bf16 v[108:111], v[224:227], v[36:39], v[108:111]
    ds_read_b64_tr_b16 v[242:243], v7 offset:18176
    s_waitcnt lgkmcnt(6)
    v_mfma_f32_16x16x32_bf16 v[112:115], v[228:231], v[32:35], v[112:115]
    ds_read_b64_tr_b16 v[244:245], v8 offset:17184
    v_mfma_f32_16x16x32_bf16 v[116:119], v[228:231], v[36:39], v[116:119]
    ds_read_b64_tr_b16 v[246:247], v8 offset:18208
    s_waitcnt lgkmcnt(6)
    v_mfma_f32_16x16x32_bf16 v[120:123], v[232:235], v[32:35], v[120:123]
    v_mfma_f32_16x16x32_bf16 v[124:127], v[232:235], v[36:39], v[124:127]
    s_waitcnt vmcnt(13)
    s_barrier
    ds_read_b64_tr_b16 v[224:225], v4 offset:0
    ds_read_b64_tr_b16 v[226:227], v4 offset:1024
    s_waitcnt lgkmcnt(6)
    v_mfma_f32_16x16x32_bf16 v[128:131], v[236:239], v[32:35], v[128:131]
    ds_read_b64_tr_b16 v[228:229], v5 offset:32
    s_mov_b32 s23, 0xe000
    buffer_load_dwordx4 v[24:27], v6, s[8:11], s23 offen offset:1024 sc1
    v_mfma_f32_16x16x32_bf16 v[132:135], v[236:239], v[36:39], v[132:135]
    ds_read_b64_tr_b16 v[230:231], v5 offset:1056
    s_waitcnt lgkmcnt(6)
    v_mfma_f32_16x16x32_bf16 v[136:139], v[240:243], v[32:35], v[136:139]
    ds_read_b64_tr_b16 v[232:233], v4 offset:256
    v_mfma_f32_16x16x32_bf16 v[140:143], v[240:243], v[36:39], v[140:143]
    ds_read_b64_tr_b16 v[234:235], v4 offset:1280
    s_mov_b32 s23, 0x2e000
    buffer_load_dwordx4 v[28:31], v6, s[8:11], s23 offen offset:1024 sc1
    s_waitcnt lgkmcnt(6)
    v_mfma_f32_16x16x32_bf16 v[144:147], v[244:247], v[32:35], v[144:147]
    ds_read_b64_tr_b16 v[236:237], v5 offset:288
    v_mfma_f32_16x16x32_bf16 v[148:151], v[244:247], v[36:39], v[148:151]
    ds_read_b64_tr_b16 v[238:239], v5 offset:1312
    s_waitcnt vmcnt(6)
    v_cmp_ne_u32 vcc, s28, v12
    s_cbranch_vccnz adaLN_cond__sliding_block_cached__moe_arch_mod__prompt_kernel_o219r
adaLN_cond__sliding_block_cached__moe_arch_mod__prompt_kernel_o219b:
    s_waitcnt lgkmcnt(6)
    v_mfma_f32_16x16x32_bf16 v[88:91], v[224:227], v[40:43], v[88:91]
    ds_read_b64_tr_b16 v[240:241], v4 offset:512
    v_mfma_f32_16x16x32_bf16 v[92:95], v[224:227], v[44:47], v[92:95]
    s_add_u32 s22, s24, 0x20000
    s_add_u32 m0, s20, 0x20000
    s_nop 0
    buffer_load_dwordx4 v3, s[4:7], s22 offen lds
    ds_read_b64_tr_b16 v[242:243], v4 offset:1536
    s_waitcnt lgkmcnt(6)
    v_mfma_f32_16x16x32_bf16 v[96:99], v[228:231], v[40:43], v[96:99]
    ds_read_b64_tr_b16 v[244:245], v5 offset:544
    v_mfma_f32_16x16x32_bf16 v[100:103], v[228:231], v[44:47], v[100:103]
    ds_read_b64_tr_b16 v[246:247], v5 offset:1568
    s_waitcnt lgkmcnt(6)
    v_mfma_f32_16x16x32_bf16 v[104:107], v[232:235], v[40:43], v[104:107]
    s_add_u32 s22, s24, 0x22000
    s_add_u32 m0, s20, 0x20400
    s_nop 0
    buffer_load_dwordx4 v3, s[4:7], s22 offen lds
    ds_read_b64_tr_b16 v[224:225], v4 offset:768
    v_mfma_f32_16x16x32_bf16 v[108:111], v[232:235], v[44:47], v[108:111]
    ds_read_b64_tr_b16 v[226:227], v4 offset:1792
    s_waitcnt lgkmcnt(6)
    v_mfma_f32_16x16x32_bf16 v[112:115], v[236:239], v[40:43], v[112:115]
    ds_read_b64_tr_b16 v[228:229], v5 offset:800
    v_mfma_f32_16x16x32_bf16 v[116:119], v[236:239], v[44:47], v[116:119]
    ds_read_b64_tr_b16 v[230:231], v5 offset:1824
    s_waitcnt lgkmcnt(6)
    v_mfma_f32_16x16x32_bf16 v[120:123], v[240:243], v[40:43], v[120:123]
    v_mfma_f32_16x16x32_bf16 v[124:127], v[240:243], v[44:47], v[124:127]
    s_barrier
    ds_read_b64_tr_b16 v[232:233], v4 offset:16384
    ds_read_b64_tr_b16 v[234:235], v4 offset:17408
    s_waitcnt lgkmcnt(6)
    v_mfma_f32_16x16x32_bf16 v[128:131], v[244:247], v[40:43], v[128:131]
    ds_read_b64_tr_b16 v[236:237], v5 offset:16416
    s_mov_b32 s23, 0x0
    buffer_load_dwordx4 v[32:35], v6, s[8:11], s23 offen offset:2048 sc1
    v_mfma_f32_16x16x32_bf16 v[132:135], v[244:247], v[44:47], v[132:135]
    ds_read_b64_tr_b16 v[238:239], v5 offset:17440
    s_waitcnt lgkmcnt(6)
    v_mfma_f32_16x16x32_bf16 v[136:139], v[224:227], v[40:43], v[136:139]
    ds_read_b64_tr_b16 v[240:241], v4 offset:16640
    v_mfma_f32_16x16x32_bf16 v[140:143], v[224:227], v[44:47], v[140:143]
    ds_read_b64_tr_b16 v[242:243], v4 offset:17664
    s_mov_b32 s23, 0x20000
    buffer_load_dwordx4 v[36:39], v6, s[8:11], s23 offen offset:2048 sc1
    s_waitcnt lgkmcnt(6)
    v_mfma_f32_16x16x32_bf16 v[144:147], v[228:231], v[40:43], v[144:147]
    ds_read_b64_tr_b16 v[244:245], v5 offset:16672
    v_mfma_f32_16x16x32_bf16 v[148:151], v[228:231], v[44:47], v[148:151]
    ds_read_b64_tr_b16 v[246:247], v5 offset:17696
    s_waitcnt lgkmcnt(6)
    v_mfma_f32_16x16x32_bf16 v[88:91], v[232:235], v[48:51], v[88:91]
    ds_read_b64_tr_b16 v[224:225], v4 offset:16896
    v_mfma_f32_16x16x32_bf16 v[92:95], v[232:235], v[52:55], v[92:95]
    s_add_u32 s22, s24, 0xa0000
    s_add_u32 m0, s20, 0x24000
    s_nop 0
    buffer_load_dwordx4 v3, s[4:7], s22 offen lds
    ds_read_b64_tr_b16 v[226:227], v4 offset:17920
    s_waitcnt lgkmcnt(6)
    v_mfma_f32_16x16x32_bf16 v[96:99], v[236:239], v[48:51], v[96:99]
    ds_read_b64_tr_b16 v[228:229], v5 offset:16928
    v_mfma_f32_16x16x32_bf16 v[100:103], v[236:239], v[52:55], v[100:103]
    ds_read_b64_tr_b16 v[230:231], v5 offset:17952
    s_waitcnt lgkmcnt(6)
    v_mfma_f32_16x16x32_bf16 v[104:107], v[240:243], v[48:51], v[104:107]
    s_add_u32 s22, s24, 0xa2000
    s_add_u32 m0, s20, 0x24400
    s_nop 0
    buffer_load_dwordx4 v3, s[4:7], s22 offen lds
    ds_read_b64_tr_b16 v[232:233], v4 offset:17152
    v_mfma_f32_16x16x32_bf16 v[108:111], v[240:243], v[52:55], v[108:111]
    ds_read_b64_tr_b16 v[234:235], v4 offset:18176
    s_waitcnt lgkmcnt(6)
    v_mfma_f32_16x16x32_bf16 v[112:115], v[244:247], v[48:51], v[112:115]
    ds_read_b64_tr_b16 v[236:237], v5 offset:17184
    v_mfma_f32_16x16x32_bf16 v[116:119], v[244:247], v[52:55], v[116:119]
    ds_read_b64_tr_b16 v[238:239], v5 offset:18208
    s_waitcnt lgkmcnt(6)
    v_mfma_f32_16x16x32_bf16 v[120:123], v[224:227], v[48:51], v[120:123]
    v_mfma_f32_16x16x32_bf16 v[124:127], v[224:227], v[52:55], v[124:127]
    s_barrier
    ds_read_b64_tr_b16 v[240:241], v4 offset:32768
    ds_read_b64_tr_b16 v[242:243], v4 offset:33792
    s_waitcnt lgkmcnt(6)
    v_mfma_f32_16x16x32_bf16 v[128:131], v[228:231], v[48:51], v[128:131]
    ds_read_b64_tr_b16 v[244:245], v5 offset:32800
    s_mov_b32 s23, 0x2000
    buffer_load_dwordx4 v[40:43], v6, s[8:11], s23 offen offset:2048 sc1
    v_mfma_f32_16x16x32_bf16 v[132:135], v[228:231], v[52:55], v[132:135]
    ds_read_b64_tr_b16 v[246:247], v5 offset:33824
    s_waitcnt lgkmcnt(6)
    v_mfma_f32_16x16x32_bf16 v[136:139], v[232:235], v[48:51], v[136:139]
    ds_read_b64_tr_b16 v[224:225], v4 offset:33024
    v_mfma_f32_16x16x32_bf16 v[140:143], v[232:235], v[52:55], v[140:143]
    ds_read_b64_tr_b16 v[226:227], v4 offset:34048
    s_mov_b32 s23, 0x22000
    buffer_load_dwordx4 v[44:47], v6, s[8:11], s23 offen offset:2048 sc1
    s_waitcnt lgkmcnt(6)
    v_mfma_f32_16x16x32_bf16 v[144:147], v[236:239], v[48:51], v[144:147]
    ds_read_b64_tr_b16 v[228:229], v5 offset:33056
    v_mfma_f32_16x16x32_bf16 v[148:151], v[236:239], v[52:55], v[148:151]
    ds_read_b64_tr_b16 v[230:231], v5 offset:34080
    s_waitcnt vmcnt(13) lgkmcnt(6)
    v_mfma_f32_16x16x32_bf16 v[88:91], v[240:243], v[56:59], v[88:91]
    ds_read_b64_tr_b16 v[232:233], v4 offset:33280
    s_waitcnt vmcnt(12)
    v_mfma_f32_16x16x32_bf16 v[92:95], v[240:243], v[60:63], v[92:95]
    s_add_u32 s22, s24, 0x120000
    s_add_u32 m0, s20, 0x10000
    s_nop 0
    buffer_load_dwordx4 v3, s[4:7], s22 offen lds
    ds_read_b64_tr_b16 v[234:235], v4 offset:34304
    s_waitcnt lgkmcnt(6)
    v_mfma_f32_16x16x32_bf16 v[96:99], v[244:247], v[56:59], v[96:99]
    ds_read_b64_tr_b16 v[236:237], v5 offset:33312
    v_mfma_f32_16x16x32_bf16 v[100:103], v[244:247], v[60:63], v[100:103]
    ds_read_b64_tr_b16 v[238:239], v5 offset:34336
    s_waitcnt lgkmcnt(6)
    v_mfma_f32_16x16x32_bf16 v[104:107], v[224:227], v[56:59], v[104:107]
    s_add_u32 s22, s24, 0x122000
    s_add_u32 m0, s20, 0x10400
    s_nop 0
    buffer_load_dwordx4 v3, s[4:7], s22 offen lds
    ds_read_b64_tr_b16 v[240:241], v4 offset:33536
    v_mfma_f32_16x16x32_bf16 v[108:111], v[224:227], v[60:63], v[108:111]
    ds_read_b64_tr_b16 v[242:243], v4 offset:34560
    s_waitcnt lgkmcnt(6)
    v_mfma_f32_16x16x32_bf16 v[112:115], v[228:231], v[56:59], v[112:115]
    ds_read_b64_tr_b16 v[244:245], v5 offset:33568
    v_mfma_f32_16x16x32_bf16 v[116:119], v[228:231], v[60:63], v[116:119]
    ds_read_b64_tr_b16 v[246:247], v5 offset:34592
    s_waitcnt lgkmcnt(6)
    v_mfma_f32_16x16x32_bf16 v[120:123], v[232:235], v[56:59], v[120:123]
    v_mfma_f32_16x16x32_bf16 v[124:127], v[232:235], v[60:63], v[124:127]
    s_waitcnt vmcnt(12)
    s_barrier
    ds_read_b64_tr_b16 v[224:225], v4 offset:49152
    ds_read_b64_tr_b16 v[226:227], v4 offset:50176
    s_waitcnt lgkmcnt(6)
    v_mfma_f32_16x16x32_bf16 v[128:131], v[236:239], v[56:59], v[128:131]
    ds_read_b64_tr_b16 v[228:229], v5 offset:49184
    s_mov_b32 s23, 0x4000
    buffer_load_dwordx4 v[48:51], v6, s[8:11], s23 offen offset:2048 sc1
    v_mfma_f32_16x16x32_bf16 v[132:135], v[236:239], v[60:63], v[132:135]
    ds_read_b64_tr_b16 v[230:231], v5 offset:50208
    s_waitcnt lgkmcnt(6)
    v_mfma_f32_16x16x32_bf16 v[136:139], v[240:243], v[56:59], v[136:139]
    ds_read_b64_tr_b16 v[232:233], v4 offset:49408
    v_mfma_f32_16x16x32_bf16 v[140:143], v[240:243], v[60:63], v[140:143]
    ds_read_b64_tr_b16 v[234:235], v4 offset:50432
    s_mov_b32 s23, 0x24000
    buffer_load_dwordx4 v[52:55], v6, s[8:11], s23 offen offset:2048 sc1
    s_waitcnt lgkmcnt(6)
    v_mfma_f32_16x16x32_bf16 v[144:147], v[244:247], v[56:59], v[144:147]
    ds_read_b64_tr_b16 v[236:237], v5 offset:49440
    v_mfma_f32_16x16x32_bf16 v[148:151], v[244:247], v[60:63], v[148:151]
    ds_read_b64_tr_b16 v[238:239], v5 offset:50464
    s_waitcnt vmcnt(13) lgkmcnt(6)
    v_mfma_f32_16x16x32_bf16 v[88:91], v[224:227], v[24:27], v[88:91]
    ds_read_b64_tr_b16 v[240:241], v4 offset:49664
    s_waitcnt vmcnt(12)
    v_mfma_f32_16x16x32_bf16 v[92:95], v[224:227], v[28:31], v[92:95]
    s_add_u32 s22, s24, 0x1a0000
    s_add_u32 m0, s20, 0x14000
    s_nop 0
    buffer_load_dwordx4 v3, s[4:7], s22 offen lds
    ds_read_b64_tr_b16 v[242:243], v4 offset:50688
    s_waitcnt lgkmcnt(6)
    v_mfma_f32_16x16x32_bf16 v[96:99], v[228:231], v[24:27], v[96:99]
    ds_read_b64_tr_b16 v[244:245], v5 offset:49696
    v_mfma_f32_16x16x32_bf16 v[100:103], v[228:231], v[28:31], v[100:103]
    ds_read_b64_tr_b16 v[246:247], v5 offset:50720
    s_waitcnt lgkmcnt(6)
    v_mfma_f32_16x16x32_bf16 v[104:107], v[232:235], v[24:27], v[104:107]
    s_add_u32 s22, s24, 0x1a2000
    s_add_u32 m0, s20, 0x14400
    s_nop 0
    buffer_load_dwordx4 v3, s[4:7], s22 offen lds
    ds_read_b64_tr_b16 v[224:225], v4 offset:49920
    v_mfma_f32_16x16x32_bf16 v[108:111], v[232:235], v[28:31], v[108:111]
    ds_read_b64_tr_b16 v[226:227], v4 offset:50944
    s_waitcnt lgkmcnt(6)
    v_mfma_f32_16x16x32_bf16 v[112:115], v[236:239], v[24:27], v[112:115]
    ds_read_b64_tr_b16 v[228:229], v5 offset:49952
    v_mfma_f32_16x16x32_bf16 v[116:119], v[236:239], v[28:31], v[116:119]
    ds_read_b64_tr_b16 v[230:231], v5 offset:50976
    s_waitcnt lgkmcnt(6)
    v_mfma_f32_16x16x32_bf16 v[120:123], v[240:243], v[24:27], v[120:123]
    v_mfma_f32_16x16x32_bf16 v[124:127], v[240:243], v[28:31], v[124:127]
    s_waitcnt vmcnt(12)
    s_barrier
    ds_read_b64_tr_b16 v[232:233], v7 offset:0
    ds_read_b64_tr_b16 v[234:235], v7 offset:1024
    s_waitcnt lgkmcnt(6)
    v_mfma_f32_16x16x32_bf16 v[128:131], v[244:247], v[24:27], v[128:131]
    ds_read_b64_tr_b16 v[236:237], v8 offset:32
    s_mov_b32 s23, 0x6000
    buffer_load_dwordx4 v[56:59], v6, s[8:11], s23 offen offset:2048 sc1
    v_mfma_f32_16x16x32_bf16 v[132:135], v[244:247], v[28:31], v[132:135]
    ds_read_b64_tr_b16 v[238:239], v8 offset:1056
    s_waitcnt lgkmcnt(6)
    v_mfma_f32_16x16x32_bf16 v[136:139], v[224:227], v[24:27], v[136:139]
    ds_read_b64_tr_b16 v[240:241], v7 offset:256
    v_mfma_f32_16x16x32_bf16 v[140:143], v[224:227], v[28:31], v[140:143]
    ds_read_b64_tr_b16 v[242:243], v7 offset:1280
    s_mov_b32 s23, 0x26000
    buffer_load_dwordx4 v[60:63], v6, s[8:11], s23 offen offset:2048 sc1
    s_waitcnt lgkmcnt(6)
    v_mfma_f32_16x16x32_bf16 v[144:147], v[228:231], v[24:27], v[144:147]
    ds_read_b64_tr_b16 v[244:245], v8 offset:288
    v_mfma_f32_16x16x32_bf16 v[148:151], v[228:231], v[28:31], v[148:151]
    ds_read_b64_tr_b16 v[246:247], v8 offset:1312
    s_waitcnt vmcnt(13) lgkmcnt(6)
    v_mfma_f32_16x16x32_bf16 v[88:91], v[232:235], v[32:35], v[88:91]
    ds_read_b64_tr_b16 v[224:225], v7 offset:512
    s_waitcnt vmcnt(12)
    v_mfma_f32_16x16x32_bf16 v[92:95], v[232:235], v[36:39], v[92:95]
    s_add_u32 s22, s24, 0x220000
    s_add_u32 m0, s20, 0x18000
    s_nop 0
    buffer_load_dwordx4 v3, s[4:7], s22 offen lds
    ds_read_b64_tr_b16 v[226:227], v7 offset:1536
    s_waitcnt lgkmcnt(6)
    v_mfma_f32_16x16x32_bf16 v[96:99], v[236:239], v[32:35], v[96:99]
    ds_read_b64_tr_b16 v[228:229], v8 offset:544
    v_mfma_f32_16x16x32_bf16 v[100:103], v[236:239], v[36:39], v[100:103]
    ds_read_b64_tr_b16 v[230:231], v8 offset:1568
    s_waitcnt lgkmcnt(6)
    v_mfma_f32_16x16x32_bf16 v[104:107], v[240:243], v[32:35], v[104:107]
    s_add_u32 s22, s24, 0x222000
    s_add_u32 m0, s20, 0x18400
    s_nop 0
    buffer_load_dwordx4 v3, s[4:7], s22 offen lds
    ds_read_b64_tr_b16 v[232:233], v7 offset:768
    v_mfma_f32_16x16x32_bf16 v[108:111], v[240:243], v[36:39], v[108:111]
    ds_read_b64_tr_b16 v[234:235], v7 offset:1792
    s_mov_b32 s16, 0x544000
    buffer_load_dwordx4 v[184:187], v2, s[8:11], s16 offen sc1
    s_waitcnt lgkmcnt(6)
    v_mfma_f32_16x16x32_bf16 v[112:115], v[244:247], v[32:35], v[112:115]
    ds_read_b64_tr_b16 v[236:237], v8 offset:800
    v_mfma_f32_16x16x32_bf16 v[116:119], v[244:247], v[36:39], v[116:119]
    ds_read_b64_tr_b16 v[238:239], v8 offset:1824
    s_waitcnt lgkmcnt(6)
    v_mfma_f32_16x16x32_bf16 v[120:123], v[224:227], v[32:35], v[120:123]
    v_mfma_f32_16x16x32_bf16 v[124:127], v[224:227], v[36:39], v[124:127]
    s_waitcnt vmcnt(13)
    s_barrier
    ds_read_b64_tr_b16 v[240:241], v7 offset:16384
    ds_read_b64_tr_b16 v[242:243], v7 offset:17408
    s_waitcnt lgkmcnt(6)
    v_mfma_f32_16x16x32_bf16 v[128:131], v[228:231], v[32:35], v[128:131]
    ds_read_b64_tr_b16 v[244:245], v8 offset:16416
    s_mov_b32 s23, 0x8000
    buffer_load_dwordx4 v[24:27], v6, s[8:11], s23 offen offset:2048 sc1
    v_mfma_f32_16x16x32_bf16 v[132:135], v[228:231], v[36:39], v[132:135]
    ds_read_b64_tr_b16 v[246:247], v8 offset:17440
    s_waitcnt lgkmcnt(6)
    v_mfma_f32_16x16x32_bf16 v[136:139], v[232:235], v[32:35], v[136:139]
    ds_read_b64_tr_b16 v[224:225], v7 offset:16640
    v_mfma_f32_16x16x32_bf16 v[140:143], v[232:235], v[36:39], v[140:143]
    ds_read_b64_tr_b16 v[226:227], v7 offset:17664
    s_mov_b32 s23, 0x28000
    buffer_load_dwordx4 v[28:31], v6, s[8:11], s23 offen offset:2048 sc1
    s_waitcnt lgkmcnt(6)
    v_mfma_f32_16x16x32_bf16 v[144:147], v[236:239], v[32:35], v[144:147]
    ds_read_b64_tr_b16 v[228:229], v8 offset:16672
    v_mfma_f32_16x16x32_bf16 v[148:151], v[236:239], v[36:39], v[148:151]
    ds_read_b64_tr_b16 v[230:231], v8 offset:17696
    s_waitcnt vmcnt(14) lgkmcnt(6)
    v_mfma_f32_16x16x32_bf16 v[88:91], v[240:243], v[40:43], v[88:91]
    ds_read_b64_tr_b16 v[232:233], v7 offset:16896
    s_waitcnt vmcnt(13)
    v_mfma_f32_16x16x32_bf16 v[92:95], v[240:243], v[44:47], v[92:95]
    s_add_u32 s22, s24, 0x2a0000
    s_add_u32 m0, s20, 0x1c000
    s_nop 0
    buffer_load_dwordx4 v3, s[4:7], s22 offen lds
    ds_read_b64_tr_b16 v[234:235], v7 offset:17920
    s_waitcnt lgkmcnt(6)
    v_mfma_f32_16x16x32_bf16 v[96:99], v[244:247], v[40:43], v[96:99]
    ds_read_b64_tr_b16 v[236:237], v8 offset:16928
    v_mfma_f32_16x16x32_bf16 v[100:103], v[244:247], v[44:47], v[100:103]
    ds_read_b64_tr_b16 v[238:239], v8 offset:17952
    s_waitcnt lgkmcnt(6)
    v_mfma_f32_16x16x32_bf16 v[104:107], v[224:227], v[40:43], v[104:107]
    s_add_u32 s22, s24, 0x2a2000
    s_add_u32 m0, s20, 0x1c400
    s_nop 0
    buffer_load_dwordx4 v3, s[4:7], s22 offen lds
    ds_read_b64_tr_b16 v[240:241], v7 offset:17152
    v_mfma_f32_16x16x32_bf16 v[108:111], v[224:227], v[44:47], v[108:111]
    ds_read_b64_tr_b16 v[242:243], v7 offset:18176
    s_waitcnt lgkmcnt(6)
    v_mfma_f32_16x16x32_bf16 v[112:115], v[228:231], v[40:43], v[112:115]
    ds_read_b64_tr_b16 v[244:245], v8 offset:17184
    v_mfma_f32_16x16x32_bf16 v[116:119], v[228:231], v[44:47], v[116:119]
    ds_read_b64_tr_b16 v[246:247], v8 offset:18208
    s_waitcnt lgkmcnt(6)
    v_mfma_f32_16x16x32_bf16 v[120:123], v[232:235], v[40:43], v[120:123]
    v_mfma_f32_16x16x32_bf16 v[124:127], v[232:235], v[44:47], v[124:127]
    s_waitcnt vmcnt(13)
    s_barrier
    ds_read_b64_tr_b16 v[224:225], v4 offset:0
    ds_read_b64_tr_b16 v[226:227], v4 offset:1024
    s_waitcnt lgkmcnt(6)
    v_mfma_f32_16x16x32_bf16 v[128:131], v[236:239], v[40:43], v[128:131]
    ds_read_b64_tr_b16 v[228:229], v5 offset:32
    s_mov_b32 s23, 0xa000
    buffer_load_dwordx4 v[32:35], v6, s[8:11], s23 offen offset:2048 sc1
    v_mfma_f32_16x16x32_bf16 v[132:135], v[236:239], v[44:47], v[132:135]
    ds_read_b64_tr_b16 v[230:231], v5 offset:1056
    s_waitcnt lgkmcnt(6)
    v_mfma_f32_16x16x32_bf16 v[136:139], v[240:243], v[40:43], v[136:139]
    ds_read_b64_tr_b16 v[232:233], v4 offset:256
    v_mfma_f32_16x16x32_bf16 v[140:143], v[240:243], v[44:47], v[140:143]
    ds_read_b64_tr_b16 v[234:235], v4 offset:1280
    s_mov_b32 s23, 0x2a000
    buffer_load_dwordx4 v[36:39], v6, s[8:11], s23 offen offset:2048 sc1
    s_waitcnt lgkmcnt(6)
    v_mfma_f32_16x16x32_bf16 v[144:147], v[244:247], v[40:43], v[144:147]
    ds_read_b64_tr_b16 v[236:237], v5 offset:288
    v_mfma_f32_16x16x32_bf16 v[148:151], v[244:247], v[44:47], v[148:151]
    ds_read_b64_tr_b16 v[238:239], v5 offset:1312
    s_waitcnt vmcnt(14) lgkmcnt(6)
    v_mfma_f32_16x16x32_bf16 v[88:91], v[224:227], v[48:51], v[88:91]
    ds_read_b64_tr_b16 v[240:241], v4 offset:512
    s_waitcnt vmcnt(13)
    v_mfma_f32_16x16x32_bf16 v[92:95], v[224:227], v[52:55], v[92:95]
    s_add_u32 s22, s24, 0x320000
    s_add_u32 m0, s20, 0x20000
    s_nop 0
    buffer_load_dwordx4 v3, s[4:7], s22 offen lds
    ds_read_b64_tr_b16 v[242:243], v4 offset:1536
    s_waitcnt lgkmcnt(6)
    v_mfma_f32_16x16x32_bf16 v[96:99], v[228:231], v[48:51], v[96:99]
    ds_read_b64_tr_b16 v[244:245], v5 offset:544
    v_mfma_f32_16x16x32_bf16 v[100:103], v[228:231], v[52:55], v[100:103]
    ds_read_b64_tr_b16 v[246:247], v5 offset:1568
    s_waitcnt lgkmcnt(6)
    v_mfma_f32_16x16x32_bf16 v[104:107], v[232:235], v[48:51], v[104:107]
    s_add_u32 s22, s24, 0x322000
    s_add_u32 m0, s20, 0x20400
    s_nop 0
    buffer_load_dwordx4 v3, s[4:7], s22 offen lds
    ds_read_b64_tr_b16 v[224:225], v4 offset:768
    v_mfma_f32_16x16x32_bf16 v[108:111], v[232:235], v[52:55], v[108:111]
    ds_read_b64_tr_b16 v[226:227], v4 offset:1792
    s_waitcnt lgkmcnt(6)
    v_mfma_f32_16x16x32_bf16 v[112:115], v[236:239], v[48:51], v[112:115]
    ds_read_b64_tr_b16 v[228:229], v5 offset:800
    v_mfma_f32_16x16x32_bf16 v[116:119], v[236:239], v[52:55], v[116:119]
    ds_read_b64_tr_b16 v[230:231], v5 offset:1824
    s_waitcnt lgkmcnt(6)
    v_mfma_f32_16x16x32_bf16 v[120:123], v[240:243], v[48:51], v[120:123]
    v_mfma_f32_16x16x32_bf16 v[124:127], v[240:243], v[52:55], v[124:127]
    s_waitcnt vmcnt(13)
    s_barrier
    ds_read_b64_tr_b16 v[232:233], v4 offset:16384
    ds_read_b64_tr_b16 v[234:235], v4 offset:17408
    s_add_u32 s19, s19, 8192
    buffer_load_dword v12, v13, s[8:11], s19 offen sc1
    s_waitcnt lgkmcnt(6)
    v_mfma_f32_16x16x32_bf16 v[128:131], v[244:247], v[48:51], v[128:131]
    ds_read_b64_tr_b16 v[236:237], v5 offset:16416
    s_mov_b32 s23, 0xc000
    buffer_load_dwordx4 v[40:43], v6, s[8:11], s23 offen offset:2048 sc1
    v_mfma_f32_16x16x32_bf16 v[132:135], v[244:247], v[52:55], v[132:135]
    ds_read_b64_tr_b16 v[238:239], v5 offset:17440
    s_waitcnt lgkmcnt(6)
    v_mfma_f32_16x16x32_bf16 v[136:139], v[224:227], v[48:51], v[136:139]
    ds_read_b64_tr_b16 v[240:241], v4 offset:16640
    v_mfma_f32_16x16x32_bf16 v[140:143], v[224:227], v[52:55], v[140:143]
    ds_read_b64_tr_b16 v[242:243], v4 offset:17664
    s_mov_b32 s23, 0x2c000
    buffer_load_dwordx4 v[44:47], v6, s[8:11], s23 offen offset:2048 sc1
    s_waitcnt lgkmcnt(6)
    v_mfma_f32_16x16x32_bf16 v[144:147], v[228:231], v[48:51], v[144:147]
    ds_read_b64_tr_b16 v[244:245], v5 offset:16672
    v_mfma_f32_16x16x32_bf16 v[148:151], v[228:231], v[52:55], v[148:151]
    ds_read_b64_tr_b16 v[246:247], v5 offset:17696
    s_waitcnt vmcnt(15) lgkmcnt(6)
    v_mfma_f32_16x16x32_bf16 v[88:91], v[232:235], v[56:59], v[88:91]
    ds_read_b64_tr_b16 v[224:225], v4 offset:16896
    s_waitcnt vmcnt(14)
    v_mfma_f32_16x16x32_bf16 v[92:95], v[232:235], v[60:63], v[92:95]
    s_add_u32 s22, s24, 0x3a0000
    s_add_u32 m0, s20, 0x24000
    s_nop 0
    buffer_load_dwordx4 v3, s[4:7], s22 offen lds
    ds_read_b64_tr_b16 v[226:227], v4 offset:17920
    s_waitcnt lgkmcnt(6)
    v_mfma_f32_16x16x32_bf16 v[96:99], v[236:239], v[56:59], v[96:99]
    ds_read_b64_tr_b16 v[228:229], v5 offset:16928
    v_mfma_f32_16x16x32_bf16 v[100:103], v[236:239], v[60:63], v[100:103]
    ds_read_b64_tr_b16 v[230:231], v5 offset:17952
    s_waitcnt lgkmcnt(6)
    v_mfma_f32_16x16x32_bf16 v[104:107], v[240:243], v[56:59], v[104:107]
    s_add_u32 s22, s24, 0x3a2000
    s_add_u32 m0, s20, 0x24400
    s_nop 0
    buffer_load_dwordx4 v3, s[4:7], s22 offen lds
    ds_read_b64_tr_b16 v[232:233], v4 offset:17152
    v_mfma_f32_16x16x32_bf16 v[108:111], v[240:243], v[60:63], v[108:111]
    ds_read_b64_tr_b16 v[234:235], v4 offset:18176
    s_waitcnt lgkmcnt(6)
    v_mfma_f32_16x16x32_bf16 v[112:115], v[244:247], v[56:59], v[112:115]
    ds_read_b64_tr_b16 v[236:237], v5 offset:17184
    v_mfma_f32_16x16x32_bf16 v[116:119], v[244:247], v[60:63], v[116:119]
    ds_read_b64_tr_b16 v[238:239], v5 offset:18208
    s_waitcnt lgkmcnt(6)
    v_mfma_f32_16x16x32_bf16 v[120:123], v[224:227], v[56:59], v[120:123]
    v_mfma_f32_16x16x32_bf16 v[124:127], v[224:227], v[60:63], v[124:127]
    s_waitcnt vmcnt(14)
    s_barrier
    ds_read_b64_tr_b16 v[240:241], v4 offset:32768
    ds_read_b64_tr_b16 v[242:243], v4 offset:33792
    s_waitcnt lgkmcnt(6)
    v_mfma_f32_16x16x32_bf16 v[128:131], v[228:231], v[56:59], v[128:131]
    ds_read_b64_tr_b16 v[244:245], v5 offset:32800
    s_mov_b32 s23, 0xe000
    buffer_load_dwordx4 v[48:51], v6, s[8:11], s23 offen offset:2048 sc1
    v_mfma_f32_16x16x32_bf16 v[132:135], v[228:231], v[60:63], v[132:135]
    ds_read_b64_tr_b16 v[246:247], v5 offset:33824
    s_waitcnt lgkmcnt(6)
    v_mfma_f32_16x16x32_bf16 v[136:139], v[232:235], v[56:59], v[136:139]
    ds_read_b64_tr_b16 v[224:225], v4 offset:33024
    v_mfma_f32_16x16x32_bf16 v[140:143], v[232:235], v[60:63], v[140:143]
    ds_read_b64_tr_b16 v[226:227], v4 offset:34048
    s_mov_b32 s23, 0x2e000
    buffer_load_dwordx4 v[52:55], v6, s[8:11], s23 offen offset:2048 sc1
    s_waitcnt lgkmcnt(6)
    v_mfma_f32_16x16x32_bf16 v[144:147], v[236:239], v[56:59], v[144:147]
    ds_read_b64_tr_b16 v[228:229], v5 offset:33056
    v_mfma_f32_16x16x32_bf16 v[148:151], v[236:239], v[60:63], v[148:151]
    ds_read_b64_tr_b16 v[230:231], v5 offset:34080
    s_waitcnt vmcnt(6)
    v_cmp_ne_u32 vcc, s28, v12
    s_cbranch_vccnz adaLN_cond__sliding_block_cached__moe_arch_mod__prompt_kernel_o220r
adaLN_cond__sliding_block_cached__moe_arch_mod__prompt_kernel_o220b:
    s_waitcnt lgkmcnt(6)
    v_mfma_f32_16x16x32_bf16 v[88:91], v[240:243], v[24:27], v[88:91]
    ds_read_b64_tr_b16 v[232:233], v4 offset:33280
    v_mfma_f32_16x16x32_bf16 v[92:95], v[240:243], v[28:31], v[92:95]
    s_add_u32 s22, s24, 0x30000
    s_add_u32 m0, s20, 0x10000
    s_nop 0
    buffer_load_dwordx4 v3, s[4:7], s22 offen lds
    ds_read_b64_tr_b16 v[234:235], v4 offset:34304
    s_waitcnt lgkmcnt(6)
    v_mfma_f32_16x16x32_bf16 v[96:99], v[244:247], v[24:27], v[96:99]
    ds_read_b64_tr_b16 v[236:237], v5 offset:33312
    v_mfma_f32_16x16x32_bf16 v[100:103], v[244:247], v[28:31], v[100:103]
    ds_read_b64_tr_b16 v[238:239], v5 offset:34336
    s_waitcnt lgkmcnt(6)
    v_mfma_f32_16x16x32_bf16 v[104:107], v[224:227], v[24:27], v[104:107]
    s_add_u32 s22, s24, 0x32000
    s_add_u32 m0, s20, 0x10400
    s_nop 0
    buffer_load_dwordx4 v3, s[4:7], s22 offen lds
    ds_read_b64_tr_b16 v[240:241], v4 offset:33536
    v_mfma_f32_16x16x32_bf16 v[108:111], v[224:227], v[28:31], v[108:111]
    ds_read_b64_tr_b16 v[242:243], v4 offset:34560
    v_xor_b32 v16, s28, v184
    v_xor_b32 v17, s28, v185
    v_xor_b32 v18, s28, v186
    v_xor_b32 v19, s28, v187
    v_or3_b32 v16, v16, v17, v18
    v_or_b32 v16, v16, v19
    v_cmp_ne_u32 vcc, 0, v16
    s_cbranch_vccnz adaLN_cond__sliding_block_cached__moe_arch_mod__prompt_kernel_mf21r
adaLN_cond__sliding_block_cached__moe_arch_mod__prompt_kernel_mf21b:
    s_waitcnt lgkmcnt(6)
    v_mfma_f32_16x16x32_bf16 v[112:115], v[228:231], v[24:27], v[112:115]
    ds_read_b64_tr_b16 v[244:245], v5 offset:33568
    v_mfma_f32_16x16x32_bf16 v[116:119], v[228:231], v[28:31], v[116:119]
    ds_read_b64_tr_b16 v[246:247], v5 offset:34592
    s_waitcnt lgkmcnt(6)
    v_mfma_f32_16x16x32_bf16 v[120:123], v[232:235], v[24:27], v[120:123]
    v_mfma_f32_16x16x32_bf16 v[124:127], v[232:235], v[28:31], v[124:127]
    s_barrier
    ds_read_b64_tr_b16 v[224:225], v4 offset:49152
    ds_read_b64_tr_b16 v[226:227], v4 offset:50176
    s_waitcnt lgkmcnt(6)
    v_mfma_f32_16x16x32_bf16 v[128:131], v[236:239], v[24:27], v[128:131]
    ds_read_b64_tr_b16 v[228:229], v5 offset:49184
    s_mov_b32 s23, 0x0
    buffer_load_dwordx4 v[56:59], v6, s[8:11], s23 offen offset:3072 sc1
    v_mfma_f32_16x16x32_bf16 v[132:135], v[236:239], v[28:31], v[132:135]
    ds_read_b64_tr_b16 v[230:231], v5 offset:50208
    s_waitcnt lgkmcnt(6)
    v_mfma_f32_16x16x32_bf16 v[136:139], v[240:243], v[24:27], v[136:139]
    ds_read_b64_tr_b16 v[232:233], v4 offset:49408
    v_mfma_f32_16x16x32_bf16 v[140:143], v[240:243], v[28:31], v[140:143]
    ds_read_b64_tr_b16 v[234:235], v4 offset:50432
    s_mov_b32 s23, 0x20000
    buffer_load_dwordx4 v[60:63], v6, s[8:11], s23 offen offset:3072 sc1
    s_waitcnt lgkmcnt(6)
    v_mfma_f32_16x16x32_bf16 v[144:147], v[244:247], v[24:27], v[144:147]
    ds_read_b64_tr_b16 v[236:237], v5 offset:49440
    v_mfma_f32_16x16x32_bf16 v[148:151], v[244:247], v[28:31], v[148:151]
    ds_read_b64_tr_b16 v[238:239], v5 offset:50464
    s_waitcnt lgkmcnt(6)
    v_mfma_f32_16x16x32_bf16 v[88:91], v[224:227], v[32:35], v[88:91]
    ds_read_b64_tr_b16 v[240:241], v4 offset:49664
    v_mfma_f32_16x16x32_bf16 v[92:95], v[224:227], v[36:39], v[92:95]
    s_add_u32 s22, s24, 0xb0000
    s_add_u32 m0, s20, 0x14000
    s_nop 0
    buffer_load_dwordx4 v3, s[4:7], s22 offen lds
    ds_read_b64_tr_b16 v[242:243], v4 offset:50688
    s_waitcnt lgkmcnt(6)
    v_mfma_f32_16x16x32_bf16 v[96:99], v[228:231], v[32:35], v[96:99]
    ds_read_b64_tr_b16 v[244:245], v5 offset:49696
    v_mfma_f32_16x16x32_bf16 v[100:103], v[228:231], v[36:39], v[100:103]
    ds_read_b64_tr_b16 v[246:247], v5 offset:50720
    s_waitcnt lgkmcnt(6)
    v_mfma_f32_16x16x32_bf16 v[104:107], v[232:235], v[32:35], v[104:107]
    s_add_u32 s22, s24, 0xb2000
    s_add_u32 m0, s20, 0x14400
    s_nop 0
    buffer_load_dwordx4 v3, s[4:7], s22 offen lds
    ds_read_b64_tr_b16 v[224:225], v4 offset:49920
    v_mfma_f32_16x16x32_bf16 v[108:111], v[232:235], v[36:39], v[108:111]
    ds_read_b64_tr_b16 v[226:227], v4 offset:50944
    s_waitcnt lgkmcnt(6)
    v_mfma_f32_16x16x32_bf16 v[112:115], v[236:239], v[32:35], v[112:115]
    ds_read_b64_tr_b16 v[228:229], v5 offset:49952
    v_mfma_f32_16x16x32_bf16 v[116:119], v[236:239], v[36:39], v[116:119]
    ds_read_b64_tr_b16 v[230:231], v5 offset:50976
    s_waitcnt lgkmcnt(6)
    v_mfma_f32_16x16x32_bf16 v[120:123], v[240:243], v[32:35], v[120:123]
    v_mfma_f32_16x16x32_bf16 v[124:127], v[240:243], v[36:39], v[124:127]
    s_barrier
    ds_read_b64_tr_b16 v[232:233], v7 offset:0
    ds_read_b64_tr_b16 v[234:235], v7 offset:1024
    s_waitcnt lgkmcnt(6)
    v_mfma_f32_16x16x32_bf16 v[128:131], v[244:247], v[32:35], v[128:131]
    ds_read_b64_tr_b16 v[236:237], v8 offset:32
    s_mov_b32 s23, 0x2000
    buffer_load_dwordx4 v[24:27], v6, s[8:11], s23 offen offset:3072 sc1
    v_mfma_f32_16x16x32_bf16 v[132:135], v[244:247], v[36:39], v[132:135]
    ds_read_b64_tr_b16 v[238:239], v8 offset:1056
    s_waitcnt lgkmcnt(6)
    v_mfma_f32_16x16x32_bf16 v[136:139], v[224:227], v[32:35], v[136:139]
    ds_read_b64_tr_b16 v[240:241], v7 offset:256
    v_mfma_f32_16x16x32_bf16 v[140:143], v[224:227], v[36:39], v[140:143]
    ds_read_b64_tr_b16 v[242:243], v7 offset:1280
    s_mov_b32 s23, 0x22000
    buffer_load_dwordx4 v[28:31], v6, s[8:11], s23 offen offset:3072 sc1
    s_waitcnt lgkmcnt(6)
    v_mfma_f32_16x16x32_bf16 v[144:147], v[228:231], v[32:35], v[144:147]
    ds_read_b64_tr_b16 v[244:245], v8 offset:288
    v_mfma_f32_16x16x32_bf16 v[148:151], v[228:231], v[36:39], v[148:151]
    ds_read_b64_tr_b16 v[246:247], v8 offset:1312
    s_waitcnt vmcnt(13) lgkmcnt(6)
    v_mfma_f32_16x16x32_bf16 v[88:91], v[232:235], v[40:43], v[88:91]
    ds_read_b64_tr_b16 v[224:225], v7 offset:512
    s_waitcnt vmcnt(12)
    v_mfma_f32_16x16x32_bf16 v[92:95], v[232:235], v[44:47], v[92:95]
    s_add_u32 s22, s24, 0x130000
    s_add_u32 m0, s20, 0x18000
    s_nop 0
    buffer_load_dwordx4 v3, s[4:7], s22 offen lds
    ds_read_b64_tr_b16 v[226:227], v7 offset:1536
    s_waitcnt lgkmcnt(6)
    v_mfma_f32_16x16x32_bf16 v[96:99], v[236:239], v[40:43], v[96:99]
    ds_read_b64_tr_b16 v[228:229], v8 offset:544
    v_mfma_f32_16x16x32_bf16 v[100:103], v[236:239], v[44:47], v[100:103]
    ds_read_b64_tr_b16 v[230:231], v8 offset:1568
    s_waitcnt lgkmcnt(6)
    v_mfma_f32_16x16x32_bf16 v[104:107], v[240:243], v[40:43], v[104:107]
    s_add_u32 s22, s24, 0x132000
    s_add_u32 m0, s20, 0x18400
    s_nop 0
    buffer_load_dwordx4 v3, s[4:7], s22 offen lds
    ds_read_b64_tr_b16 v[232:233], v7 offset:768
    v_mfma_f32_16x16x32_bf16 v[108:111], v[240:243], v[44:47], v[108:111]
    ds_read_b64_tr_b16 v[234:235], v7 offset:1792
    s_waitcnt lgkmcnt(6)
    v_mfma_f32_16x16x32_bf16 v[112:115], v[244:247], v[40:43], v[112:115]
    ds_read_b64_tr_b16 v[236:237], v8 offset:800
    v_mfma_f32_16x16x32_bf16 v[116:119], v[244:247], v[44:47], v[116:119]
    ds_read_b64_tr_b16 v[238:239], v8 offset:1824
    s_waitcnt lgkmcnt(6)
    v_mfma_f32_16x16x32_bf16 v[120:123], v[224:227], v[40:43], v[120:123]
    v_mfma_f32_16x16x32_bf16 v[124:127], v[224:227], v[44:47], v[124:127]
    s_waitcnt vmcnt(12)
    s_barrier
    ds_read_b64_tr_b16 v[240:241], v7 offset:16384
    ds_read_b64_tr_b16 v[242:243], v7 offset:17408
    s_waitcnt lgkmcnt(6)
    v_mfma_f32_16x16x32_bf16 v[128:131], v[228:231], v[40:43], v[128:131]
    ds_read_b64_tr_b16 v[244:245], v8 offset:16416
    s_mov_b32 s23, 0x4000
    buffer_load_dwordx4 v[32:35], v6, s[8:11], s23 offen offset:3072 sc1
    v_mfma_f32_16x16x32_bf16 v[132:135], v[228:231], v[44:47], v[132:135]
    ds_read_b64_tr_b16 v[246:247], v8 offset:17440
    s_waitcnt lgkmcnt(6)
    v_mfma_f32_16x16x32_bf16 v[136:139], v[232:235], v[40:43], v[136:139]
    ds_read_b64_tr_b16 v[224:225], v7 offset:16640
    v_mfma_f32_16x16x32_bf16 v[140:143], v[232:235], v[44:47], v[140:143]
    ds_read_b64_tr_b16 v[226:227], v7 offset:17664
    s_mov_b32 s23, 0x24000
    buffer_load_dwordx4 v[36:39], v6, s[8:11], s23 offen offset:3072 sc1
    s_waitcnt lgkmcnt(6)
    v_mfma_f32_16x16x32_bf16 v[144:147], v[236:239], v[40:43], v[144:147]
    ds_read_b64_tr_b16 v[228:229], v8 offset:16672
    v_mfma_f32_16x16x32_bf16 v[148:151], v[236:239], v[44:47], v[148:151]
    ds_read_b64_tr_b16 v[230:231], v8 offset:17696
    s_waitcnt vmcnt(13) lgkmcnt(6)
    v_mfma_f32_16x16x32_bf16 v[88:91], v[240:243], v[48:51], v[88:91]
    ds_read_b64_tr_b16 v[232:233], v7 offset:16896
    s_waitcnt vmcnt(12)
    v_mfma_f32_16x16x32_bf16 v[92:95], v[240:243], v[52:55], v[92:95]
    s_add_u32 s22, s24, 0x1b0000
    s_add_u32 m0, s20, 0x1c000
    s_nop 0
    buffer_load_dwordx4 v3, s[4:7], s22 offen lds
    ds_read_b64_tr_b16 v[234:235], v7 offset:17920
    s_waitcnt lgkmcnt(6)
    v_mfma_f32_16x16x32_bf16 v[96:99], v[244:247], v[48:51], v[96:99]
    ds_read_b64_tr_b16 v[236:237], v8 offset:16928
    v_mfma_f32_16x16x32_bf16 v[100:103], v[244:247], v[52:55], v[100:103]
    ds_read_b64_tr_b16 v[238:239], v8 offset:17952
    s_waitcnt lgkmcnt(6)
    v_mfma_f32_16x16x32_bf16 v[104:107], v[224:227], v[48:51], v[104:107]
    s_add_u32 s22, s24, 0x1b2000
    s_add_u32 m0, s20, 0x1c400
    s_nop 0
    buffer_load_dwordx4 v3, s[4:7], s22 offen lds
    ds_read_b64_tr_b16 v[240:241], v7 offset:17152
    v_mfma_f32_16x16x32_bf16 v[108:111], v[224:227], v[52:55], v[108:111]
    ds_read_b64_tr_b16 v[242:243], v7 offset:18176
    s_waitcnt lgkmcnt(6)
    v_mfma_f32_16x16x32_bf16 v[112:115], v[228:231], v[48:51], v[112:115]
    ds_read_b64_tr_b16 v[244:245], v8 offset:17184
    v_mfma_f32_16x16x32_bf16 v[116:119], v[228:231], v[52:55], v[116:119]
    ds_read_b64_tr_b16 v[246:247], v8 offset:18208
    s_waitcnt lgkmcnt(6)
    v_mfma_f32_16x16x32_bf16 v[120:123], v[232:235], v[48:51], v[120:123]
    v_mfma_f32_16x16x32_bf16 v[124:127], v[232:235], v[52:55], v[124:127]
    s_waitcnt vmcnt(12)
    s_barrier
    ds_read_b64_tr_b16 v[224:225], v4 offset:0
    ds_read_b64_tr_b16 v[226:227], v4 offset:1024
    s_waitcnt lgkmcnt(6)
    v_mfma_f32_16x16x32_bf16 v[128:131], v[236:239], v[48:51], v[128:131]
    ds_read_b64_tr_b16 v[228:229], v5 offset:32
    s_mov_b32 s23, 0x6000
    buffer_load_dwordx4 v[40:43], v6, s[8:11], s23 offen offset:3072 sc1
    v_mfma_f32_16x16x32_bf16 v[132:135], v[236:239], v[52:55], v[132:135]
    ds_read_b64_tr_b16 v[230:231], v5 offset:1056
    s_waitcnt lgkmcnt(6)
    v_mfma_f32_16x16x32_bf16 v[136:139], v[240:243], v[48:51], v[136:139]
    ds_read_b64_tr_b16 v[232:233], v4 offset:256
    v_mfma_f32_16x16x32_bf16 v[140:143], v[240:243], v[52:55], v[140:143]
    ds_read_b64_tr_b16 v[234:235], v4 offset:1280
    s_mov_b32 s23, 0x26000
    buffer_load_dwordx4 v[44:47], v6, s[8:11], s23 offen offset:3072 sc1
    s_waitcnt lgkmcnt(6)
    v_mfma_f32_16x16x32_bf16 v[144:147], v[244:247], v[48:51], v[144:147]
    ds_read_b64_tr_b16 v[236:237], v5 offset:288
    v_mfma_f32_16x16x32_bf16 v[148:151], v[244:247], v[52:55], v[148:151]
    ds_read_b64_tr_b16 v[238:239], v5 offset:1312
    s_waitcnt vmcnt(13) lgkmcnt(6)
    v_mfma_f32_16x16x32_bf16 v[88:91], v[224:227], v[56:59], v[88:91]
    ds_read_b64_tr_b16 v[240:241], v4 offset:512
    s_waitcnt vmcnt(12)
    v_mfma_f32_16x16x32_bf16 v[92:95], v[224:227], v[60:63], v[92:95]
    s_add_u32 s22, s24, 0x230000
    s_add_u32 m0, s20, 0x20000
    s_nop 0
    buffer_load_dwordx4 v3, s[4:7], s22 offen lds
    ds_read_b64_tr_b16 v[242:243], v4 offset:1536
    s_waitcnt lgkmcnt(6)
    v_mfma_f32_16x16x32_bf16 v[96:99], v[228:231], v[56:59], v[96:99]
    ds_read_b64_tr_b16 v[244:245], v5 offset:544
    v_mfma_f32_16x16x32_bf16 v[100:103], v[228:231], v[60:63], v[100:103]
    ds_read_b64_tr_b16 v[246:247], v5 offset:1568
    s_waitcnt lgkmcnt(6)
    v_mfma_f32_16x16x32_bf16 v[104:107], v[232:235], v[56:59], v[104:107]
    s_add_u32 s22, s24, 0x232000
    s_add_u32 m0, s20, 0x20400
    s_nop 0
    buffer_load_dwordx4 v3, s[4:7], s22 offen lds
    ds_read_b64_tr_b16 v[224:225], v4 offset:768
    v_mfma_f32_16x16x32_bf16 v[108:111], v[232:235], v[60:63], v[108:111]
    ds_read_b64_tr_b16 v[226:227], v4 offset:1792
    s_waitcnt lgkmcnt(6)
    v_mfma_f32_16x16x32_bf16 v[112:115], v[236:239], v[56:59], v[112:115]
    ds_read_b64_tr_b16 v[228:229], v5 offset:800
    v_mfma_f32_16x16x32_bf16 v[116:119], v[236:239], v[60:63], v[116:119]
    ds_read_b64_tr_b16 v[230:231], v5 offset:1824
    s_waitcnt lgkmcnt(6)
    v_mfma_f32_16x16x32_bf16 v[120:123], v[240:243], v[56:59], v[120:123]
    v_mfma_f32_16x16x32_bf16 v[124:127], v[240:243], v[60:63], v[124:127]
    s_waitcnt vmcnt(12)
    s_barrier
    ds_read_b64_tr_b16 v[232:233], v4 offset:16384
    ds_read_b64_tr_b16 v[234:235], v4 offset:17408
    s_waitcnt lgkmcnt(6)
    v_mfma_f32_16x16x32_bf16 v[128:131], v[244:247], v[56:59], v[128:131]
    ds_read_b64_tr_b16 v[236:237], v5 offset:16416
    s_mov_b32 s23, 0x8000
    buffer_load_dwordx4 v[48:51], v6, s[8:11], s23 offen offset:3072 sc1
    v_mfma_f32_16x16x32_bf16 v[132:135], v[244:247], v[60:63], v[132:135]
    ds_read_b64_tr_b16 v[238:239], v5 offset:17440
    s_waitcnt lgkmcnt(6)
    v_mfma_f32_16x16x32_bf16 v[136:139], v[224:227], v[56:59], v[136:139]
    ds_read_b64_tr_b16 v[240:241], v4 offset:16640
    v_mfma_f32_16x16x32_bf16 v[140:143], v[224:227], v[60:63], v[140:143]
    ds_read_b64_tr_b16 v[242:243], v4 offset:17664
    s_mov_b32 s23, 0x28000
    buffer_load_dwordx4 v[52:55], v6, s[8:11], s23 offen offset:3072 sc1
    s_waitcnt lgkmcnt(6)
    v_mfma_f32_16x16x32_bf16 v[144:147], v[228:231], v[56:59], v[144:147]
    ds_read_b64_tr_b16 v[244:245], v5 offset:16672
    v_mfma_f32_16x16x32_bf16 v[148:151], v[228:231], v[60:63], v[148:151]
    ds_read_b64_tr_b16 v[246:247], v5 offset:17696
    s_waitcnt vmcnt(13) lgkmcnt(6)
    v_mfma_f32_16x16x32_bf16 v[88:91], v[232:235], v[24:27], v[88:91]
    ds_read_b64_tr_b16 v[224:225], v4 offset:16896
    s_waitcnt vmcnt(12)
    v_mfma_f32_16x16x32_bf16 v[92:95], v[232:235], v[28:31], v[92:95]
    s_add_u32 s22, s24, 0x2b0000
    s_add_u32 m0, s20, 0x24000
    s_nop 0
    buffer_load_dwordx4 v3, s[4:7], s22 offen lds
    ds_read_b64_tr_b16 v[226:227], v4 offset:17920
    s_waitcnt lgkmcnt(6)
    v_mfma_f32_16x16x32_bf16 v[96:99], v[236:239], v[24:27], v[96:99]
    ds_read_b64_tr_b16 v[228:229], v5 offset:16928
    v_mfma_f32_16x16x32_bf16 v[100:103], v[236:239], v[28:31], v[100:103]
    ds_read_b64_tr_b16 v[230:231], v5 offset:17952
    s_waitcnt lgkmcnt(6)
    v_mfma_f32_16x16x32_bf16 v[104:107], v[240:243], v[24:27], v[104:107]
    s_add_u32 s22, s24, 0x2b2000
    s_add_u32 m0, s20, 0x24400
    s_nop 0
    buffer_load_dwordx4 v3, s[4:7], s22 offen lds
    ds_read_b64_tr_b16 v[232:233], v4 offset:17152
    v_mfma_f32_16x16x32_bf16 v[108:111], v[240:243], v[28:31], v[108:111]
    ds_read_b64_tr_b16 v[234:235], v4 offset:18176
    s_waitcnt lgkmcnt(6)
    v_mfma_f32_16x16x32_bf16 v[112:115], v[244:247], v[24:27], v[112:115]
    ds_read_b64_tr_b16 v[236:237], v5 offset:17184
    v_mfma_f32_16x16x32_bf16 v[116:119], v[244:247], v[28:31], v[116:119]
    ds_read_b64_tr_b16 v[238:239], v5 offset:18208
    s_waitcnt lgkmcnt(6)
    v_mfma_f32_16x16x32_bf16 v[120:123], v[224:227], v[24:27], v[120:123]
    v_mfma_f32_16x16x32_bf16 v[124:127], v[224:227], v[28:31], v[124:127]
    s_waitcnt vmcnt(12)
    s_barrier
    ds_read_b64_tr_b16 v[240:241], v4 offset:32768
    ds_read_b64_tr_b16 v[242:243], v4 offset:33792
    s_waitcnt lgkmcnt(6)
    v_mfma_f32_16x16x32_bf16 v[128:131], v[228:231], v[24:27], v[128:131]
    ds_read_b64_tr_b16 v[244:245], v5 offset:32800
    s_mov_b32 s23, 0xa000
    buffer_load_dwordx4 v[56:59], v6, s[8:11], s23 offen offset:3072 sc1
    v_mfma_f32_16x16x32_bf16 v[132:135], v[228:231], v[28:31], v[132:135]
    ds_read_b64_tr_b16 v[246:247], v5 offset:33824
    s_waitcnt lgkmcnt(6)
    v_mfma_f32_16x16x32_bf16 v[136:139], v[232:235], v[24:27], v[136:139]
    ds_read_b64_tr_b16 v[224:225], v4 offset:33024
    v_mfma_f32_16x16x32_bf16 v[140:143], v[232:235], v[28:31], v[140:143]
    ds_read_b64_tr_b16 v[226:227], v4 offset:34048
    s_mov_b32 s23, 0x2a000
    buffer_load_dwordx4 v[60:63], v6, s[8:11], s23 offen offset:3072 sc1
    s_waitcnt lgkmcnt(6)
    v_mfma_f32_16x16x32_bf16 v[144:147], v[236:239], v[24:27], v[144:147]
    ds_read_b64_tr_b16 v[228:229], v5 offset:33056
    v_mfma_f32_16x16x32_bf16 v[148:151], v[236:239], v[28:31], v[148:151]
    ds_read_b64_tr_b16 v[230:231], v5 offset:34080
    s_waitcnt vmcnt(13) lgkmcnt(6)
    v_mfma_f32_16x16x32_bf16 v[88:91], v[240:243], v[32:35], v[88:91]
    ds_read_b64_tr_b16 v[232:233], v4 offset:33280
    s_waitcnt vmcnt(12)
    v_mfma_f32_16x16x32_bf16 v[92:95], v[240:243], v[36:39], v[92:95]
    s_add_u32 s22, s24, 0x330000
    s_add_u32 m0, s20, 0x10000
    s_nop 0
    buffer_load_dwordx4 v3, s[4:7], s22 offen lds
    ds_read_b64_tr_b16 v[234:235], v4 offset:34304
    s_waitcnt lgkmcnt(6)
    v_mfma_f32_16x16x32_bf16 v[96:99], v[244:247], v[32:35], v[96:99]
    ds_read_b64_tr_b16 v[236:237], v5 offset:33312
    v_mfma_f32_16x16x32_bf16 v[100:103], v[244:247], v[36:39], v[100:103]
    ds_read_b64_tr_b16 v[238:239], v5 offset:34336
    s_waitcnt lgkmcnt(6)
    v_mfma_f32_16x16x32_bf16 v[104:107], v[224:227], v[32:35], v[104:107]
    s_add_u32 s22, s24, 0x332000
    s_add_u32 m0, s20, 0x10400
    s_nop 0
    buffer_load_dwordx4 v3, s[4:7], s22 offen lds
    ds_read_b64_tr_b16 v[240:241], v4 offset:33536
    v_mfma_f32_16x16x32_bf16 v[108:111], v[224:227], v[36:39], v[108:111]
    ds_read_b64_tr_b16 v[242:243], v4 offset:34560
    v_lshrrev_b32 v16, 4, v1
    v_lshlrev_b32 v16, 3, v16
    s_lshl_b32 s16, s31, 8
    s_add_u32 s16, s16, 0x540080
    buffer_load_dwordx2 v[248:249], v16, s[8:11], s16 offen offset:0 sc1
    buffer_load_dwordx2 v[250:251], v16, s[8:11], s16 offen offset:32 sc1
    buffer_load_dwordx2 v[252:253], v16, s[8:11], s16 offen offset:64 sc1
    buffer_load_dwordx2 v[254:255], v16, s[8:11], s16 offen offset:96 sc1
    s_waitcnt lgkmcnt(6)
    v_mfma_f32_16x16x32_bf16 v[112:115], v[228:231], v[32:35], v[112:115]
    ds_read_b64_tr_b16 v[244:245], v5 offset:33568
    v_mfma_f32_16x16x32_bf16 v[116:119], v[228:231], v[36:39], v[116:119]
    ds_read_b64_tr_b16 v[246:247], v5 offset:34592
    s_waitcnt lgkmcnt(6)
    v_mfma_f32_16x16x32_bf16 v[120:123], v[232:235], v[32:35], v[120:123]
    v_mfma_f32_16x16x32_bf16 v[124:127], v[232:235], v[36:39], v[124:127]
    s_waitcnt vmcnt(16)
    s_barrier
    ds_read_b64_tr_b16 v[224:225], v4 offset:49152
    ds_read_b64_tr_b16 v[226:227], v4 offset:50176
    s_waitcnt lgkmcnt(6)
    v_mfma_f32_16x16x32_bf16 v[128:131], v[236:239], v[32:35], v[128:131]
    ds_read_b64_tr_b16 v[228:229], v5 offset:49184
    s_mov_b32 s23, 0xc000
    buffer_load_dwordx4 v[24:27], v6, s[8:11], s23 offen offset:3072 sc1
    v_mfma_f32_16x16x32_bf16 v[132:135], v[236:239], v[36:39], v[132:135]
    ds_read_b64_tr_b16 v[230:231], v5 offset:50208
    s_waitcnt lgkmcnt(6)
    v_mfma_f32_16x16x32_bf16 v[136:139], v[240:243], v[32:35], v[136:139]
    ds_read_b64_tr_b16 v[232:233], v4 offset:49408
    v_mfma_f32_16x16x32_bf16 v[140:143], v[240:243], v[36:39], v[140:143]
    ds_read_b64_tr_b16 v[234:235], v4 offset:50432
    s_mov_b32 s23, 0x2c000
    buffer_load_dwordx4 v[28:31], v6, s[8:11], s23 offen offset:3072 sc1
    s_waitcnt lgkmcnt(6)
    v_mfma_f32_16x16x32_bf16 v[144:147], v[244:247], v[32:35], v[144:147]
    ds_read_b64_tr_b16 v[236:237], v5 offset:49440
    v_mfma_f32_16x16x32_bf16 v[148:151], v[244:247], v[36:39], v[148:151]
    ds_read_b64_tr_b16 v[238:239], v5 offset:50464
    s_waitcnt vmcnt(17) lgkmcnt(6)
    v_mfma_f32_16x16x32_bf16 v[88:91], v[224:227], v[40:43], v[88:91]
    ds_read_b64_tr_b16 v[240:241], v4 offset:49664
    s_waitcnt vmcnt(16)
    v_mfma_f32_16x16x32_bf16 v[92:95], v[224:227], v[44:47], v[92:95]
    s_add_u32 s22, s24, 0x3b0000
    s_add_u32 m0, s20, 0x14000
    s_nop 0
    buffer_load_dwordx4 v3, s[4:7], s22 offen lds
    ds_read_b64_tr_b16 v[242:243], v4 offset:50688
    s_waitcnt lgkmcnt(6)
    v_mfma_f32_16x16x32_bf16 v[96:99], v[228:231], v[40:43], v[96:99]
    ds_read_b64_tr_b16 v[244:245], v5 offset:49696
    v_mfma_f32_16x16x32_bf16 v[100:103], v[228:231], v[44:47], v[100:103]
    ds_read_b64_tr_b16 v[246:247], v5 offset:50720
    s_waitcnt lgkmcnt(6)
    v_mfma_f32_16x16x32_bf16 v[104:107], v[232:235], v[40:43], v[104:107]
    s_add_u32 s22, s24, 0x3b2000
    s_add_u32 m0, s20, 0x14400
    s_nop 0
    buffer_load_dwordx4 v3, s[4:7], s22 offen lds
    ds_read_b64_tr_b16 v[224:225], v4 offset:49920
    v_mfma_f32_16x16x32_bf16 v[108:111], v[232:235], v[44:47], v[108:111]
    ds_read_b64_tr_b16 v[226:227], v4 offset:50944
    s_waitcnt lgkmcnt(6)
    v_mfma_f32_16x16x32_bf16 v[112:115], v[236:239], v[40:43], v[112:115]
    ds_read_b64_tr_b16 v[228:229], v5 offset:49952
    v_mfma_f32_16x16x32_bf16 v[116:119], v[236:239], v[44:47], v[116:119]
    ds_read_b64_tr_b16 v[230:231], v5 offset:50976
    s_waitcnt lgkmcnt(6)
    v_mfma_f32_16x16x32_bf16 v[120:123], v[240:243], v[40:43], v[120:123]
    v_mfma_f32_16x16x32_bf16 v[124:127], v[240:243], v[44:47], v[124:127]
    s_waitcnt vmcnt(16)
    s_barrier
    ds_read_b64_tr_b16 v[232:233], v7 offset:0
    ds_read_b64_tr_b16 v[234:235], v7 offset:1024
    s_waitcnt lgkmcnt(6)
    v_mfma_f32_16x16x32_bf16 v[128:131], v[244:247], v[40:43], v[128:131]
    ds_read_b64_tr_b16 v[236:237], v8 offset:32
    s_mov_b32 s23, 0xe000
    buffer_load_dwordx4 v[32:35], v6, s[8:11], s23 offen offset:3072 sc1
    v_mfma_f32_16x16x32_bf16 v[132:135], v[244:247], v[44:47], v[132:135]
    ds_read_b64_tr_b16 v[238:239], v8 offset:1056
    s_waitcnt lgkmcnt(6)
    v_mfma_f32_16x16x32_bf16 v[136:139], v[224:227], v[40:43], v[136:139]
    ds_read_b64_tr_b16 v[240:241], v7 offset:256
    v_mfma_f32_16x16x32_bf16 v[140:143], v[224:227], v[44:47], v[140:143]
    ds_read_b64_tr_b16 v[242:243], v7 offset:1280
    s_mov_b32 s23, 0x2e000
    buffer_load_dwordx4 v[36:39], v6, s[8:11], s23 offen offset:3072 sc1
    s_waitcnt lgkmcnt(6)
    v_mfma_f32_16x16x32_bf16 v[144:147], v[228:231], v[40:43], v[144:147]
    ds_read_b64_tr_b16 v[244:245], v8 offset:288
    v_mfma_f32_16x16x32_bf16 v[148:151], v[228:231], v[44:47], v[148:151]
    ds_read_b64_tr_b16 v[246:247], v8 offset:1312
    s_waitcnt vmcnt(17) lgkmcnt(6)
    v_mfma_f32_16x16x32_bf16 v[88:91], v[232:235], v[48:51], v[88:91]
    ds_read_b64_tr_b16 v[224:225], v7 offset:512
    s_waitcnt vmcnt(16)
    v_mfma_f32_16x16x32_bf16 v[92:95], v[232:235], v[52:55], v[92:95]
    ds_read_b64_tr_b16 v[226:227], v7 offset:1536
    s_waitcnt lgkmcnt(6)
    v_mfma_f32_16x16x32_bf16 v[96:99], v[236:239], v[48:51], v[96:99]
    ds_read_b64_tr_b16 v[228:229], v8 offset:544
    v_mfma_f32_16x16x32_bf16 v[100:103], v[236:239], v[52:55], v[100:103]
    ds_read_b64_tr_b16 v[230:231], v8 offset:1568
    s_waitcnt lgkmcnt(6)
    v_mfma_f32_16x16x32_bf16 v[104:107], v[240:243], v[48:51], v[104:107]
    ds_read_b64_tr_b16 v[232:233], v7 offset:768
    v_mfma_f32_16x16x32_bf16 v[108:111], v[240:243], v[52:55], v[108:111]
    ds_read_b64_tr_b16 v[234:235], v7 offset:1792
    s_waitcnt lgkmcnt(6)
    v_mfma_f32_16x16x32_bf16 v[112:115], v[244:247], v[48:51], v[112:115]
    ds_read_b64_tr_b16 v[236:237], v8 offset:800
    v_mfma_f32_16x16x32_bf16 v[116:119], v[244:247], v[52:55], v[116:119]
    ds_read_b64_tr_b16 v[238:239], v8 offset:1824
    s_waitcnt lgkmcnt(6)
    v_mfma_f32_16x16x32_bf16 v[120:123], v[224:227], v[48:51], v[120:123]
    s_mov_b64 s[72:73], s[48:49]
    s_mov_b32 s74, 0x700000
    s_mov_b32 s75, 0x20000
    s_cmp_lt_u32 s2, 224
    s_cselect_b32 s74, 7340032, 0
    s_sub_u32 s16, s3, 4
    v_lshrrev_b32 v20, 3, v1
    v_lshlrev_b32 v20, 3, v20
    s_lshl_b32 s17, s16, 6
    v_add_u32 v20, s17, v20
    s_mov_b32 s17, 7168
    v_mul_lo_u32 v21, s17, v20
    v_and_b32 v20, 7, v1
    v_lshl_add_u32 v21, v20, 4, v21
    s_and_b32 s17, s29, 3
    s_mul_i32 s18, s17, 1835008
    s_lshr_b32 s17, s29, 2
    s_lshl_b32 s17, s17, 7
    s_add_u32 s18, s18, s17
    s_lshl_b32 s16, s16, 13
    s_add_u32 s22, s18, 0
    s_add_u32 m0, s16, 32768
    s_nop 0
    buffer_load_dwordx4 v21, s[72:75], s22 offen lds
    s_add_u32 s22, s18, 7168
    s_add_u32 m0, s16, 33792
    s_nop 0
    buffer_load_dwordx4 v21, s[72:75], s22 offen lds
    s_add_u32 s22, s18, 14336
    s_add_u32 m0, s16, 34816
    s_nop 0
    buffer_load_dwordx4 v21, s[72:75], s22 offen lds
    s_add_u32 s22, s18, 21504
    s_add_u32 m0, s16, 35840
    s_nop 0
    buffer_load_dwordx4 v21, s[72:75], s22 offen lds
    s_add_u32 s22, s18, 28672
    s_add_u32 m0, s16, 36864
    s_nop 0
    buffer_load_dwordx4 v21, s[72:75], s22 offen lds
    s_add_u32 s22, s18, 35840
    s_add_u32 m0, s16, 37888
    s_nop 0
    buffer_load_dwordx4 v21, s[72:75], s22 offen lds
    s_add_u32 s22, s18, 43008
    s_add_u32 m0, s16, 38912
    s_nop 0
    buffer_load_dwordx4 v21, s[72:75], s22 offen lds
    s_add_u32 s22, s18, 50176
    s_add_u32 m0, s16, 39936
    s_nop 0
    buffer_load_dwordx4 v21, s[72:75], s22 offen lds
    v_mfma_f32_16x16x32_bf16 v[124:127], v[224:227], v[52:55], v[124:127]
    s_waitcnt vmcnt(22)
    s_barrier
    ds_read_b64_tr_b16 v[240:241], v7 offset:16384
    ds_read_b64_tr_b16 v[242:243], v7 offset:17408
    s_waitcnt lgkmcnt(6)
    v_mfma_f32_16x16x32_bf16 v[128:131], v[228:231], v[48:51], v[128:131]
    ds_read_b64_tr_b16 v[244:245], v8 offset:16416
    v_mfma_f32_16x16x32_bf16 v[132:135], v[228:231], v[52:55], v[132:135]
    ds_read_b64_tr_b16 v[246:247], v8 offset:17440
    s_waitcnt lgkmcnt(6)
    v_mfma_f32_16x16x32_bf16 v[136:139], v[232:235], v[48:51], v[136:139]
    ds_read_b64_tr_b16 v[224:225], v7 offset:16640
    v_mfma_f32_16x16x32_bf16 v[140:143], v[232:235], v[52:55], v[140:143]
    ds_read_b64_tr_b16 v[226:227], v7 offset:17664
    s_waitcnt lgkmcnt(6)
    v_mfma_f32_16x16x32_bf16 v[144:147], v[236:239], v[48:51], v[144:147]
    ds_read_b64_tr_b16 v[228:229], v8 offset:16672
    v_mfma_f32_16x16x32_bf16 v[148:151], v[236:239], v[52:55], v[148:151]
    ds_read_b64_tr_b16 v[230:231], v8 offset:17696
    s_waitcnt vmcnt(21) lgkmcnt(6)
    v_mfma_f32_16x16x32_bf16 v[88:91], v[240:243], v[56:59], v[88:91]
    ds_read_b64_tr_b16 v[232:233], v7 offset:16896
    s_waitcnt vmcnt(20)
    v_mfma_f32_16x16x32_bf16 v[92:95], v[240:243], v[60:63], v[92:95]
    ds_read_b64_tr_b16 v[234:235], v7 offset:17920
    s_waitcnt lgkmcnt(6)
    v_mfma_f32_16x16x32_bf16 v[96:99], v[244:247], v[56:59], v[96:99]
    ds_read_b64_tr_b16 v[236:237], v8 offset:16928
    v_mfma_f32_16x16x32_bf16 v[100:103], v[244:247], v[60:63], v[100:103]
    ds_read_b64_tr_b16 v[238:239], v8 offset:17952
    s_waitcnt lgkmcnt(6)
    v_mfma_f32_16x16x32_bf16 v[104:107], v[224:227], v[56:59], v[104:107]
    ds_read_b64_tr_b16 v[240:241], v7 offset:17152
    v_mfma_f32_16x16x32_bf16 v[108:111], v[224:227], v[60:63], v[108:111]
    ds_read_b64_tr_b16 v[242:243], v7 offset:18176
    s_waitcnt lgkmcnt(6)
    v_mfma_f32_16x16x32_bf16 v[112:115], v[228:231], v[56:59], v[112:115]
    ds_read_b64_tr_b16 v[244:245], v8 offset:17184
    v_mfma_f32_16x16x32_bf16 v[116:119], v[228:231], v[60:63], v[116:119]
    ds_read_b64_tr_b16 v[246:247], v8 offset:18208
    s_waitcnt lgkmcnt(6)
    v_mfma_f32_16x16x32_bf16 v[120:123], v[232:235], v[56:59], v[120:123]
    v_mfma_f32_16x16x32_bf16 v[124:127], v[232:235], v[60:63], v[124:127]
    s_waitcnt vmcnt(18)
    s_barrier
    ds_read_b64_tr_b16 v[224:225], v4 offset:0
    ds_read_b64_tr_b16 v[226:227], v4 offset:1024
    s_waitcnt lgkmcnt(6)
    v_mfma_f32_16x16x32_bf16 v[128:131], v[236:239], v[56:59], v[128:131]
    ds_read_b64_tr_b16 v[228:229], v5 offset:32
    v_mfma_f32_16x16x32_bf16 v[132:135], v[236:239], v[60:63], v[132:135]
    ds_read_b64_tr_b16 v[230:231], v5 offset:1056
    s_waitcnt lgkmcnt(6)
    v_mfma_f32_16x16x32_bf16 v[136:139], v[240:243], v[56:59], v[136:139]
    ds_read_b64_tr_b16 v[232:233], v4 offset:256
    v_mfma_f32_16x16x32_bf16 v[140:143], v[240:243], v[60:63], v[140:143]
    ds_read_b64_tr_b16 v[234:235], v4 offset:1280
    s_waitcnt lgkmcnt(6)
    v_mfma_f32_16x16x32_bf16 v[144:147], v[244:247], v[56:59], v[144:147]
    ds_read_b64_tr_b16 v[236:237], v5 offset:288
    v_mfma_f32_16x16x32_bf16 v[148:151], v[244:247], v[60:63], v[148:151]
    ds_read_b64_tr_b16 v[238:239], v5 offset:1312
    s_waitcnt vmcnt(13) lgkmcnt(6)
    v_mfma_f32_16x16x32_bf16 v[88:91], v[224:227], v[24:27], v[88:91]
    ds_read_b64_tr_b16 v[240:241], v4 offset:512
    s_waitcnt vmcnt(12)
    v_mfma_f32_16x16x32_bf16 v[92:95], v[224:227], v[28:31], v[92:95]
    ds_read_b64_tr_b16 v[242:243], v4 offset:1536
    s_waitcnt lgkmcnt(6)
    v_mfma_f32_16x16x32_bf16 v[96:99], v[228:231], v[24:27], v[96:99]
    ds_read_b64_tr_b16 v[244:245], v5 offset:544
    v_mfma_f32_16x16x32_bf16 v[100:103], v[228:231], v[28:31], v[100:103]
    ds_read_b64_tr_b16 v[246:247], v5 offset:1568
    s_waitcnt lgkmcnt(6)
    v_mfma_f32_16x16x32_bf16 v[104:107], v[232:235], v[24:27], v[104:107]
    ds_read_b64_tr_b16 v[224:225], v4 offset:768
    v_mfma_f32_16x16x32_bf16 v[108:111], v[232:235], v[28:31], v[108:111]
    ds_read_b64_tr_b16 v[226:227], v4 offset:1792
    s_waitcnt lgkmcnt(6)
    v_mfma_f32_16x16x32_bf16 v[112:115], v[236:239], v[24:27], v[112:115]
    ds_read_b64_tr_b16 v[228:229], v5 offset:800
    v_mfma_f32_16x16x32_bf16 v[116:119], v[236:239], v[28:31], v[116:119]
    ds_read_b64_tr_b16 v[230:231], v5 offset:1824
    s_waitcnt lgkmcnt(6)
    v_mfma_f32_16x16x32_bf16 v[120:123], v[240:243], v[24:27], v[120:123]
    v_mfma_f32_16x16x32_bf16 v[124:127], v[240:243], v[28:31], v[124:127]
    s_waitcnt vmcnt(10)
    s_barrier
    ds_read_b64_tr_b16 v[232:233], v4 offset:16384
    ds_read_b64_tr_b16 v[234:235], v4 offset:17408
    s_waitcnt lgkmcnt(6)
    v_mfma_f32_16x16x32_bf16 v[128:131], v[244:247], v[24:27], v[128:131]
    ds_read_b64_tr_b16 v[236:237], v5 offset:16416
    v_mfma_f32_16x16x32_bf16 v[132:135], v[244:247], v[28:31], v[132:135]
    ds_read_b64_tr_b16 v[238:239], v5 offset:17440
    s_waitcnt lgkmcnt(6)
    v_mfma_f32_16x16x32_bf16 v[136:139], v[224:227], v[24:27], v[136:139]
    ds_read_b64_tr_b16 v[240:241], v4 offset:16640
    v_mfma_f32_16x16x32_bf16 v[140:143], v[224:227], v[28:31], v[140:143]
    ds_read_b64_tr_b16 v[242:243], v4 offset:17664
    s_waitcnt lgkmcnt(6)
    v_mfma_f32_16x16x32_bf16 v[144:147], v[228:231], v[24:27], v[144:147]
    ds_read_b64_tr_b16 v[244:245], v5 offset:16672
    v_mfma_f32_16x16x32_bf16 v[148:151], v[228:231], v[28:31], v[148:151]
    ds_read_b64_tr_b16 v[246:247], v5 offset:17696
    s_waitcnt vmcnt(9) lgkmcnt(6)
    v_mfma_f32_16x16x32_bf16 v[88:91], v[232:235], v[32:35], v[88:91]
    ds_read_b64_tr_b16 v[224:225], v4 offset:16896
    s_waitcnt vmcnt(8)
    v_mfma_f32_16x16x32_bf16 v[92:95], v[232:235], v[36:39], v[92:95]
    ds_read_b64_tr_b16 v[226:227], v4 offset:17920
    s_waitcnt lgkmcnt(6)
    v_mfma_f32_16x16x32_bf16 v[96:99], v[236:239], v[32:35], v[96:99]
    ds_read_b64_tr_b16 v[228:229], v5 offset:16928
    v_mfma_f32_16x16x32_bf16 v[100:103], v[236:239], v[36:39], v[100:103]
    ds_read_b64_tr_b16 v[230:231], v5 offset:17952
    s_waitcnt lgkmcnt(6)
    v_mfma_f32_16x16x32_bf16 v[104:107], v[240:243], v[32:35], v[104:107]
    ds_read_b64_tr_b16 v[232:233], v4 offset:17152
    v_mfma_f32_16x16x32_bf16 v[108:111], v[240:243], v[36:39], v[108:111]
    ds_read_b64_tr_b16 v[234:235], v4 offset:18176
    s_waitcnt lgkmcnt(6)
    v_mfma_f32_16x16x32_bf16 v[112:115], v[244:247], v[32:35], v[112:115]
    ds_read_b64_tr_b16 v[236:237], v5 offset:17184
    v_mfma_f32_16x16x32_bf16 v[116:119], v[244:247], v[36:39], v[116:119]
    ds_read_b64_tr_b16 v[238:239], v5 offset:18208
    s_waitcnt lgkmcnt(6)
    v_mfma_f32_16x16x32_bf16 v[120:123], v[224:227], v[32:35], v[120:123]
    v_mfma_f32_16x16x32_bf16 v[124:127], v[224:227], v[36:39], v[124:127]
    s_waitcnt lgkmcnt(4)
    v_mfma_f32_16x16x32_bf16 v[128:131], v[228:231], v[32:35], v[128:131]
    v_mfma_f32_16x16x32_bf16 v[132:135], v[228:231], v[36:39], v[132:135]
    s_waitcnt lgkmcnt(2)
    v_mfma_f32_16x16x32_bf16 v[136:139], v[232:235], v[32:35], v[136:139]
    v_mfma_f32_16x16x32_bf16 v[140:143], v[232:235], v[36:39], v[140:143]
    s_waitcnt lgkmcnt(0)
    v_mfma_f32_16x16x32_bf16 v[144:147], v[236:239], v[32:35], v[144:147]
    v_mfma_f32_16x16x32_bf16 v[148:151], v[236:239], v[36:39], v[148:151]
    s_lshl_b32 s16, s3, 13
    s_xor_b32 s17, s16, 0x8000
    s_add_u32 s16, s16, 0x18000
    s_add_u32 s17, s17, 0x18000
    v_add_u32 v16, s16, v2
    s_mov_b32 s16, s17
    v_add_u32 v17, s16, v2
    ds_write_b128 v16, v[88:91] offset:0
    ds_write_b128 v16, v[92:95] offset:1024
    ds_write_b128 v16, v[96:99] offset:2048
    ds_write_b128 v16, v[100:103] offset:3072
    ds_write_b128 v16, v[104:107] offset:4096
    ds_write_b128 v16, v[108:111] offset:5120
    ds_write_b128 v16, v[112:115] offset:6144
    ds_write_b128 v16, v[116:119] offset:7168
    v_lshlrev_b32 v24, 16, v248
    v_and_b32 v25, 0xffff0000, v248
    v_lshlrev_b32 v26, 16, v249
    v_and_b32 v27, 0xffff0000, v249
    v_lshlrev_b32 v28, 16, v250
    v_and_b32 v29, 0xffff0000, v250
    v_lshlrev_b32 v30, 16, v251
    v_and_b32 v31, 0xffff0000, v251
    v_lshlrev_b32 v32, 16, v252
    v_and_b32 v33, 0xffff0000, v252
    v_lshlrev_b32 v34, 16, v253
    v_and_b32 v35, 0xffff0000, v253
    v_lshlrev_b32 v36, 16, v254
    v_and_b32 v37, 0xffff0000, v254
    v_lshlrev_b32 v38, 16, v255
    v_and_b32 v39, 0xffff0000, v255
    v_and_b32 v18, 15, v1
    v_lshlrev_b32 v18, 6, v18
    v_lshrrev_b32 v19, 4, v1
    v_and_b32 v20, 1, v19
    v_lshl_add_u32 v18, v20, 5, v18
    v_lshrrev_b32 v19, 1, v19
    v_lshl_add_u32 v18, v19, 4, v18
    s_and_b32 s17, s3, 3
    s_lshl_b32 s18, s30, 2
    s_add_u32 s18, s18, s17
    s_lshl_b32 s18, s18, 16
    s_lshl_b32 s19, s15, 22
    s_add_u32 s18, s18, s19
    s_lshl_b32 s19, s31, 12
    s_add_u32 s18, s18, s19
    s_add_u32 s18, s18, 0x2c00800
    s_add_u32 s19, s18, 32768
    s_waitcnt lgkmcnt(0)
    s_barrier
    ds_read_b128 v[40:43], v17 offset:0
    ds_read_b128 v[44:47], v17 offset:1024
    ds_read_b128 v[48:51], v17 offset:2048
    ds_read_b128 v[52:55], v17 offset:3072
    ds_read_b128 v[56:59], v17 offset:4096
    ds_read_b128 v[60:63], v17 offset:5120
    ds_read_b128 v[64:67], v17 offset:6144
    ds_read_b128 v[68:71], v17 offset:7168
    s_waitcnt lgkmcnt(7)
    v_pk_add_f32 v[120:121], v[120:121], v[40:41]
    v_pk_add_f32 v[122:123], v[122:123], v[42:43]
    v_pk_mul_f32 v[120:121], v[120:121], v[24:25]
    v_pk_mul_f32 v[122:123], v[122:123], v[26:27]
    v_cvt_pk_bf16_f32 v224, v120, v121
    v_cvt_pk_bf16_f32 v225, v122, v123
    s_waitcnt lgkmcnt(5)
    v_pk_add_f32 v[128:129], v[128:129], v[48:49]
    v_pk_add_f32 v[130:131], v[130:131], v[50:51]
    v_pk_mul_f32 v[128:129], v[128:129], v[28:29]
    v_pk_mul_f32 v[130:131], v[130:131], v[30:31]
    v_cvt_pk_bf16_f32 v226, v128, v129
    v_cvt_pk_bf16_f32 v227, v130, v131
    s_nop 0
    v_permlane16_swap_b32 v224, v226
    v_permlane16_swap_b32 v225, v227
    buffer_store_dwordx4 v[224:227], v18, s[8:11], s18 offen offset:0 sc1
    v_pk_add_f32 v[124:125], v[124:125], v[44:45]
    v_pk_add_f32 v[126:127], v[126:127], v[46:47]
    v_pk_mul_f32 v[124:125], v[124:125], v[24:25]
    v_pk_mul_f32 v[126:127], v[126:127], v[26:27]
    v_cvt_pk_bf16_f32 v228, v124, v125
    v_cvt_pk_bf16_f32 v229, v126, v127
    s_waitcnt lgkmcnt(4)
    v_pk_add_f32 v[132:133], v[132:133], v[52:53]
    v_pk_add_f32 v[134:135], v[134:135], v[54:55]
    v_pk_mul_f32 v[132:133], v[132:133], v[28:29]
    v_pk_mul_f32 v[134:135], v[134:135], v[30:31]
    v_cvt_pk_bf16_f32 v230, v132, v133
    v_cvt_pk_bf16_f32 v231, v134, v135
    s_nop 0
    v_permlane16_swap_b32 v228, v230
    v_permlane16_swap_b32 v229, v231
    buffer_store_dwordx4 v[228:231], v18, s[8:11], s19 offen offset:0 sc1
    s_waitcnt lgkmcnt(3)
    v_pk_add_f32 v[136:137], v[136:137], v[56:57]
    v_pk_add_f32 v[138:139], v[138:139], v[58:59]
    v_pk_mul_f32 v[136:137], v[136:137], v[32:33]
    v_pk_mul_f32 v[138:139], v[138:139], v[34:35]
    v_cvt_pk_bf16_f32 v232, v136, v137
    v_cvt_pk_bf16_f32 v233, v138, v139
    s_waitcnt lgkmcnt(1)
    v_pk_add_f32 v[144:145], v[144:145], v[64:65]
    v_pk_add_f32 v[146:147], v[146:147], v[66:67]
    v_pk_mul_f32 v[144:145], v[144:145], v[36:37]
    v_pk_mul_f32 v[146:147], v[146:147], v[38:39]
    v_cvt_pk_bf16_f32 v234, v144, v145
    v_cvt_pk_bf16_f32 v235, v146, v147
    s_nop 0
    v_permlane16_swap_b32 v232, v234
    v_permlane16_swap_b32 v233, v235
    buffer_store_dwordx4 v[232:235], v18, s[8:11], s18 offen offset:1024 sc1
    v_pk_add_f32 v[140:141], v[140:141], v[60:61]
    v_pk_add_f32 v[142:143], v[142:143], v[62:63]
    v_pk_mul_f32 v[140:141], v[140:141], v[32:33]
    v_pk_mul_f32 v[142:143], v[142:143], v[34:35]
    v_cvt_pk_bf16_f32 v236, v140, v141
    v_cvt_pk_bf16_f32 v237, v142, v143
    s_waitcnt lgkmcnt(0)
    v_pk_add_f32 v[148:149], v[148:149], v[68:69]
    v_pk_add_f32 v[150:151], v[150:151], v[70:71]
    v_pk_mul_f32 v[148:149], v[148:149], v[36:37]
    v_pk_mul_f32 v[150:151], v[150:151], v[38:39]
    v_cvt_pk_bf16_f32 v238, v148, v149
    v_cvt_pk_bf16_f32 v239, v150, v151
    s_nop 0
    v_permlane16_swap_b32 v236, v238
    v_permlane16_swap_b32 v237, v239
    buffer_store_dwordx4 v[236:239], v18, s[8:11], s19 offen offset:1024 sc1
    s_mov_b64 s[64:65], s[44:45]
    s_mov_b32 s66, 0x800
    s_mov_b32 s67, 0x20000
    s_mov_b64 s[76:77], s[32:33]
    s_mov_b32 s78, 0x400000
    s_mov_b32 s79, 0x20000
    s_mov_b64 s[68:69], s[56:57]
    s_mov_b32 s70, 0x400000
    s_mov_b32 s71, 0x20000
    s_lshl_b32 s14, s31, 1
    s_add_u32 s14, s14, s15
    s_lshl_b32 s14, s14, 3
    s_add_u32 s14, s14, s3
    s_lshl_b32 s16, s30, 7
    s_add_u32 s14, s14, s16
    s_lshl_b32 s16, s14, 11
    buffer_load_dwordx4 v[216:219], v2, s[76:79], s16 offen offset:0
    buffer_load_dwordx4 v[220:223], v2, s[76:79], s16 offen offset:1024
    s_lshl_b32 s16, s3, 10
    s_add_u32 m0, s16, 81920
    s_add_u32 s17, s16, 0x540800
    s_cmp_lt_u32 s3, 6
    s_cselect_b32 s17, s17, 0x7ffffff0
    s_sub_u32 s23, s16, 6144
    s_cmp_ge_u32 s3, 6
    s_cselect_b32 s23, s23, 0x7ffffff0
    s_cbranch_scc1 adaLN_cond__sliding_block_cached__moe_arch_mod__prompt_kernel_mlw
    buffer_load_dwordx4 v2, s[8:11], s17 offen sc1 lds
    s_branch adaLN_cond__sliding_block_cached__moe_arch_mod__prompt_kernel_mlj
adaLN_cond__sliding_block_cached__moe_arch_mod__prompt_kernel_mlw:
    buffer_load_dwordx4 v2, s[64:67], s23 offen lds
adaLN_cond__sliding_block_cached__moe_arch_mod__prompt_kernel_mlj:
    s_lshl_b32 s16, s30, 5
    s_lshl_b32 s17, s31, 1
    s_add_u32 s16, s16, s17
    s_add_u32 s16, s16, s15
    s_lshl_b32 s16, s16, 2
    s_add_u32 s16, s16, 0x530000
    s_cmp_eq_u32 s3, 0
    s_cselect_b32 s16, s16, 0x7ffffff0
    v_mov_b32 v16, s28
    v_mov_b32 v17, 0
    s_lshr_b32 s18, s14, 4
    s_lshl_b32 s18, s18, 15
    s_and_b32 s19, s14, 15
    s_lshl_b32 s19, s19, 6
    s_add_u32 s18, s18, s19
    s_add_u32 s18, s18, 0x2c00000
    s_add_u32 s19, s18, 16384
    v_lshrrev_b32 v18, 2, v1
    v_lshlrev_b32 v18, 10, v18
    v_and_b32 v19, 3, v1
    v_lshl_add_u32 v18, v19, 4, v18
    v_add_u32 v19, 0x400000, v18
    s_lshl_b32 s25, s30, 7
    s_add_u32 s25, s25, 0x530000
    v_and_b32 v20, 15, v1
    v_lshlrev_b32 v20, 2, v20
    s_waitcnt vmcnt(3)
    s_waitcnt vmcnt(0)
    s_barrier
    s_mov_b64 exec, 1
    buffer_store_dword v16, v17, s[8:11], s16 offen sc1
    s_mov_b64 exec, -1
    v_add_u32 v16, 81920, v2
    ds_read_b128 v[184:187], v16 offset:0
    ds_read_b128 v[188:191], v16 offset:1024
    ds_read_b128 v[192:195], v16 offset:2048
    ds_read_b128 v[196:199], v16 offset:3072
    ds_read_b128 v[200:203], v16 offset:4096
    ds_read_b128 v[204:207], v16 offset:5120
    ds_read_b128 v[208:211], v16 offset:6144
    ds_read_b128 v[212:215], v16 offset:7168
    v_mov_b32 v94, 0
    v_mov_b32 v95, 0
    s_waitcnt lgkmcnt(5)
    v_lshlrev_b32 v76, 16, v192
    v_and_b32 v77, 0xffff0000, v192
    s_waitcnt lgkmcnt(1)
    v_lshlrev_b32 v78, 16, v208
    v_and_b32 v79, 0xffff0000, v208
    v_pk_mul_f32 v[60:61], v[76:77], v[78:79]
    v_lshlrev_b32 v76, 16, v184
    v_and_b32 v77, 0xffff0000, v184
    v_fmac_f32 v94, v76, v78
    v_fmac_f32 v94, v77, v79
    v_add_f32 v95, v95, v60
    v_add_f32 v95, v95, v61
    v_lshlrev_b32 v76, 16, v193
    v_and_b32 v77, 0xffff0000, v193
    v_lshlrev_b32 v78, 16, v209
    v_and_b32 v79, 0xffff0000, v209
    v_pk_mul_f32 v[62:63], v[76:77], v[78:79]
    v_lshlrev_b32 v76, 16, v185
    v_and_b32 v77, 0xffff0000, v185
    v_fmac_f32 v94, v76, v78
    v_fmac_f32 v94, v77, v79
    v_add_f32 v95, v95, v62
    v_add_f32 v95, v95, v63
    v_lshlrev_b32 v76, 16, v194
    v_and_b32 v77, 0xffff0000, v194
    v_lshlrev_b32 v78, 16, v210
    v_and_b32 v79, 0xffff0000, v210
    v_pk_mul_f32 v[64:65], v[76:77], v[78:79]
    v_lshlrev_b32 v76, 16, v186
    v_and_b32 v77, 0xffff0000, v186
    v_fmac_f32 v94, v76, v78
    v_fmac_f32 v94, v77, v79
    v_add_f32 v95, v95, v64
    v_add_f32 v95, v95, v65
    v_lshlrev_b32 v76, 16, v195
    v_and_b32 v77, 0xffff0000, v195
    v_lshlrev_b32 v78, 16, v211
    v_and_b32 v79, 0xffff0000, v211
    v_pk_mul_f32 v[66:67], v[76:77], v[78:79]
    v_lshlrev_b32 v76, 16, v187
    v_and_b32 v77, 0xffff0000, v187
    v_fmac_f32 v94, v76, v78
    v_fmac_f32 v94, v77, v79
    v_add_f32 v95, v95, v66
    v_add_f32 v95, v95, v67
    v_lshlrev_b32 v76, 16, v196
    v_and_b32 v77, 0xffff0000, v196
    s_waitcnt lgkmcnt(0)
    v_lshlrev_b32 v78, 16, v212
    v_and_b32 v79, 0xffff0000, v212
    v_pk_mul_f32 v[68:69], v[76:77], v[78:79]
    v_lshlrev_b32 v76, 16, v188
    v_and_b32 v77, 0xffff0000, v188
    v_fmac_f32 v94, v76, v78
    v_fmac_f32 v94, v77, v79
    v_add_f32 v95, v95, v68
    v_add_f32 v95, v95, v69
    v_lshlrev_b32 v76, 16, v197
    v_and_b32 v77, 0xffff0000, v197
    v_lshlrev_b32 v78, 16, v213
    v_and_b32 v79, 0xffff0000, v213
    v_pk_mul_f32 v[70:71], v[76:77], v[78:79]
    v_lshlrev_b32 v76, 16, v189
    v_and_b32 v77, 0xffff0000, v189
    v_fmac_f32 v94, v76, v78
    v_fmac_f32 v94, v77, v79
    v_add_f32 v95, v95, v70
    v_add_f32 v95, v95, v71
    v_lshlrev_b32 v76, 16, v198
    v_and_b32 v77, 0xffff0000, v198
    v_lshlrev_b32 v78, 16, v214
    v_and_b32 v79, 0xffff0000, v214
    v_pk_mul_f32 v[72:73], v[76:77], v[78:79]
    v_lshlrev_b32 v76, 16, v190
    v_and_b32 v77, 0xffff0000, v190
    v_fmac_f32 v94, v76, v78
    v_fmac_f32 v94, v77, v79
    v_add_f32 v95, v95, v72
    v_add_f32 v95, v95, v73
    v_lshlrev_b32 v76, 16, v199
    v_and_b32 v77, 0xffff0000, v199
    v_lshlrev_b32 v78, 16, v215
    v_and_b32 v79, 0xffff0000, v215
    v_pk_mul_f32 v[74:75], v[76:77], v[78:79]
    v_lshlrev_b32 v76, 16, v191
    v_and_b32 v77, 0xffff0000, v191
    v_fmac_f32 v94, v76, v78
    v_fmac_f32 v94, v77, v79
    v_add_f32 v95, v95, v74
    v_add_f32 v95, v95, v75
    v_add_f32_dpp v94, v94, v94 row_ror:1 row_mask:0xf bank_mask:0xf
    s_nop 0
    v_add_f32_dpp v95, v95, v95 row_ror:1 row_mask:0xf bank_mask:0xf
    v_add_f32_dpp v94, v94, v94 row_ror:2 row_mask:0xf bank_mask:0xf
    s_nop 0
    v_add_f32_dpp v95, v95, v95 row_ror:2 row_mask:0xf bank_mask:0xf
    v_add_f32_dpp v94, v94, v94 row_ror:4 row_mask:0xf bank_mask:0xf
    s_nop 0
    v_add_f32_dpp v95, v95, v95 row_ror:4 row_mask:0xf bank_mask:0xf
    v_add_f32_dpp v94, v94, v94 row_ror:8 row_mask:0xf bank_mask:0xf
    s_nop 0
    v_add_f32_dpp v95, v95, v95 row_ror:8 row_mask:0xf bank_mask:0xf
    v_mov_b32 v76, v94
    s_nop 1
    v_permlane16_swap_b32 v94, v76
    v_add_f32 v94, v94, v76
    v_mov_b32 v77, v95
    s_nop 1
    v_permlane16_swap_b32 v95, v77
    v_add_f32 v95, v95, v77
    v_mov_b32 v76, v94
    s_nop 1
    v_permlane32_swap_b32 v94, v76
    v_add_f32 v94, v94, v76
    v_mov_b32 v77, v95
    s_nop 1
    v_permlane32_swap_b32 v95, v77
    v_add_f32 v95, v95, v77
    v_lshlrev_b32 v28, 16, v216
    v_and_b32 v29, 0xffff0000, v216
    v_lshlrev_b32 v30, 16, v217
    v_and_b32 v31, 0xffff0000, v217
    v_lshlrev_b32 v32, 16, v218
    v_and_b32 v33, 0xffff0000, v218
    v_lshlrev_b32 v34, 16, v219
    v_and_b32 v35, 0xffff0000, v219
    v_lshlrev_b32 v36, 16, v220
    v_and_b32 v37, 0xffff0000, v220
    v_lshlrev_b32 v38, 16, v221
    v_and_b32 v39, 0xffff0000, v221
    v_lshlrev_b32 v40, 16, v222
    v_and_b32 v41, 0xffff0000, v222
    v_lshlrev_b32 v42, 16, v223
    v_and_b32 v43, 0xffff0000, v223
    s_sleep 16
    s_mov_b32 s27, 0
adaLN_cond__sliding_block_cached__moe_arch_mod__prompt_kernel_a22p:
    buffer_load_dword v76, v20, s[8:11], s25 offen sc1
    s_waitcnt vmcnt(0)
    v_cmp_ne_u32 vcc, s28, v76
    s_add_u32 s27, s27, 1
    s_cmp_ge_u32 s27, 262144
    s_cbranch_scc1 adaLN_cond__sliding_block_cached__moe_arch_mod__prompt_kernel_a22g
    s_cbranch_vccnz adaLN_cond__sliding_block_cached__moe_arch_mod__prompt_kernel_a22p
adaLN_cond__sliding_block_cached__moe_arch_mod__prompt_kernel_a22g:
    buffer_load_dwordx4 v[44:47], v18, s[8:11], s18 offen sc1
    buffer_load_dwordx4 v[52:55], v19, s[8:11], s18 offen sc1
    buffer_load_dwordx4 v[48:51], v18, s[8:11], s19 offen sc1
    buffer_load_dwordx4 v[56:59], v19, s[8:11], s19 offen sc1
    v_lshlrev_b32 v21, 2, v0
    s_mov_b32 s16, 0x540800
    buffer_load_dword v106, v21, s[8:11], s16 offen sc1
    buffer_load_dword v104, v21, s[8:11], s16 offen offset:2048 sc1
    s_waitcnt vmcnt(5)
    v_lshlrev_b32 v76, 16, v44
    v_and_b32 v77, 0xffff0000, v44
    s_waitcnt vmcnt(4)
    v_lshlrev_b32 v78, 16, v52
    v_and_b32 v79, 0xffff0000, v52
    v_pk_add_f32 v[76:77], v[76:77], v[78:79]
    v_pk_add_f32 v[28:29], v[28:29], v[76:77]
    v_cvt_pk_bf16_f32 v16, v28, v29
    v_lshlrev_b32 v28, 16, v16
    v_and_b32 v29, 0xffff0000, v16
    v_lshlrev_b32 v80, 16, v45
    v_and_b32 v81, 0xffff0000, v45
    v_lshlrev_b32 v82, 16, v53
    v_and_b32 v83, 0xffff0000, v53
    v_pk_add_f32 v[80:81], v[80:81], v[82:83]
    v_pk_add_f32 v[30:31], v[30:31], v[80:81]
    v_cvt_pk_bf16_f32 v17, v30, v31
    v_lshlrev_b32 v30, 16, v17
    v_and_b32 v31, 0xffff0000, v17
    v_lshlrev_b32 v76, 16, v46
    v_and_b32 v77, 0xffff0000, v46
    v_lshlrev_b32 v78, 16, v54
    v_and_b32 v79, 0xffff0000, v54
    v_pk_add_f32 v[76:77], v[76:77], v[78:79]
    v_pk_add_f32 v[32:33], v[32:33], v[76:77]
    v_cvt_pk_bf16_f32 v16, v32, v33
    v_lshlrev_b32 v32, 16, v16
    v_and_b32 v33, 0xffff0000, v16
    v_lshlrev_b32 v80, 16, v47
    v_and_b32 v81, 0xffff0000, v47
    v_lshlrev_b32 v82, 16, v55
    v_and_b32 v83, 0xffff0000, v55
    v_pk_add_f32 v[80:81], v[80:81], v[82:83]
    v_pk_add_f32 v[34:35], v[34:35], v[80:81]
    v_cvt_pk_bf16_f32 v17, v34, v35
    v_lshlrev_b32 v34, 16, v17
    v_and_b32 v35, 0xffff0000, v17
    s_waitcnt vmcnt(3)
    v_lshlrev_b32 v76, 16, v48
    v_and_b32 v77, 0xffff0000, v48
    s_waitcnt vmcnt(2)
    v_lshlrev_b32 v78, 16, v56
    v_and_b32 v79, 0xffff0000, v56
    v_pk_add_f32 v[76:77], v[76:77], v[78:79]
    v_pk_add_f32 v[36:37], v[36:37], v[76:77]
    v_cvt_pk_bf16_f32 v16, v36, v37
    v_lshlrev_b32 v36, 16, v16
    v_and_b32 v37, 0xffff0000, v16
    v_lshlrev_b32 v80, 16, v49
    v_and_b32 v81, 0xffff0000, v49
    v_lshlrev_b32 v82, 16, v57
    v_and_b32 v83, 0xffff0000, v57
    v_pk_add_f32 v[80:81], v[80:81], v[82:83]
    v_pk_add_f32 v[38:39], v[38:39], v[80:81]
    v_cvt_pk_bf16_f32 v17, v38, v39
    v_lshlrev_b32 v38, 16, v17
    v_and_b32 v39, 0xffff0000, v17
    v_lshlrev_b32 v76, 16, v50
    v_and_b32 v77, 0xffff0000, v50
    v_lshlrev_b32 v78, 16, v58
    v_and_b32 v79, 0xffff0000, v58
    v_pk_add_f32 v[76:77], v[76:77], v[78:79]
    v_pk_add_f32 v[40:41], v[40:41], v[76:77]
    v_cvt_pk_bf16_f32 v16, v40, v41
    v_lshlrev_b32 v40, 16, v16
    v_and_b32 v41, 0xffff0000, v16
    v_lshlrev_b32 v80, 16, v51
    v_and_b32 v81, 0xffff0000, v51
    v_lshlrev_b32 v82, 16, v59
    v_and_b32 v83, 0xffff0000, v59
    v_pk_add_f32 v[80:81], v[80:81], v[82:83]
    v_pk_add_f32 v[42:43], v[42:43], v[80:81]
    v_cvt_pk_bf16_f32 v17, v42, v43
    v_lshlrev_b32 v42, 16, v17
    v_and_b32 v43, 0xffff0000, v17
    v_pk_add_f32 v[76:77], v[28:29], v[30:31]
    v_pk_mul_f32 v[78:79], v[28:29], v[28:29]
    v_pk_mul_f32 v[80:81], v[28:29], v[60:61]
    v_pk_fma_f32 v[78:79], v[30:31], v[30:31], v[78:79]
    v_pk_fma_f32 v[80:81], v[30:31], v[62:63], v[80:81]
    v_pk_add_f32 v[76:77], v[76:77], v[32:33]
    v_pk_fma_f32 v[78:79], v[32:33], v[32:33], v[78:79]
    v_pk_fma_f32 v[80:81], v[32:33], v[64:65], v[80:81]
    v_pk_add_f32 v[76:77], v[76:77], v[34:35]
    v_pk_fma_f32 v[78:79], v[34:35], v[34:35], v[78:79]
    v_pk_fma_f32 v[80:81], v[34:35], v[66:67], v[80:81]
    v_pk_add_f32 v[76:77], v[76:77], v[36:37]
    v_pk_fma_f32 v[78:79], v[36:37], v[36:37], v[78:79]
    v_pk_fma_f32 v[80:81], v[36:37], v[68:69], v[80:81]
    v_pk_add_f32 v[76:77], v[76:77], v[38:39]
    v_pk_fma_f32 v[78:79], v[38:39], v[38:39], v[78:79]
    v_pk_fma_f32 v[80:81], v[38:39], v[70:71], v[80:81]
    v_pk_add_f32 v[76:77], v[76:77], v[40:41]
    v_pk_fma_f32 v[78:79], v[40:41], v[40:41], v[78:79]
    v_pk_fma_f32 v[80:81], v[40:41], v[72:73], v[80:81]
    v_pk_add_f32 v[76:77], v[76:77], v[42:43]
    v_pk_fma_f32 v[78:79], v[42:43], v[42:43], v[78:79]
    v_pk_fma_f32 v[80:81], v[42:43], v[74:75], v[80:81]
    v_add_f32 v96, v76, v77
    v_add_f32 v97, v78, v79
    v_add_f32 v98, v80, v81
    v_add_f32_dpp v96, v96, v96 row_ror:1 row_mask:0xf bank_mask:0xf
    v_add_f32_dpp v97, v97, v97 row_ror:1 row_mask:0xf bank_mask:0xf
    v_add_f32_dpp v98, v98, v98 row_ror:1 row_mask:0xf bank_mask:0xf
    v_add_f32_dpp v96, v96, v96 row_ror:2 row_mask:0xf bank_mask:0xf
    v_add_f32_dpp v97, v97, v97 row_ror:2 row_mask:0xf bank_mask:0xf
    v_add_f32_dpp v98, v98, v98 row_ror:2 row_mask:0xf bank_mask:0xf
    v_add_f32_dpp v96, v96, v96 row_ror:4 row_mask:0xf bank_mask:0xf
    v_add_f32_dpp v97, v97, v97 row_ror:4 row_mask:0xf bank_mask:0xf
    v_add_f32_dpp v98, v98, v98 row_ror:4 row_mask:0xf bank_mask:0xf
    v_add_f32_dpp v96, v96, v96 row_ror:8 row_mask:0xf bank_mask:0xf
    v_add_f32_dpp v97, v97, v97 row_ror:8 row_mask:0xf bank_mask:0xf
    v_add_f32_dpp v98, v98, v98 row_ror:8 row_mask:0xf bank_mask:0xf
    v_mov_b32 v76, v96
    s_nop 1
    v_permlane16_swap_b32 v96, v76
    v_add_f32 v96, v96, v76
    v_mov_b32 v77, v97
    s_nop 1
    v_permlane16_swap_b32 v97, v77
    v_add_f32 v97, v97, v77
    v_mov_b32 v78, v98
    s_nop 1
    v_permlane16_swap_b32 v98, v78
    v_add_f32 v98, v98, v78
    v_mov_b32 v76, v96
    s_nop 1
    v_permlane32_swap_b32 v96, v76
    v_add_f32 v96, v96, v76
    v_mov_b32 v77, v97
    s_nop 1
    v_permlane32_swap_b32 v97, v77
    v_add_f32 v97, v97, v77
    v_mov_b32 v78, v98
    s_nop 1
    v_permlane32_swap_b32 v98, v78
    v_add_f32 v98, v98, v78
    v_mul_f32 v96, 0x3a800000, v96
    v_mul_f32 v97, 0x3a800000, v97
    v_fma_f32 v97, -v96, v96, v97
    v_max_f32 v97, 0, v97
    v_fma_f32 v98, -v96, v95, v98
    v_add_f32 v76, 0x3727c5ac, v97
    v_rsq_f32 v76, v76
    s_nop 0
    v_fma_f32 v27, v98, v76, v94
    v_cvt_pk_bf16_f32 v96, v96, v96
    v_lshlrev_b32 v96, 16, v96
    v_cvt_pk_bf16_f32 v97, v97, v97
    v_lshlrev_b32 v97, 16, v97
    v_add_f32 v97, 0x3727c5ac, v97
    v_cvt_pk_bf16_f32 v97, v97, v97
    v_lshlrev_b32 v97, 16, v97
    v_sqrt_f32 v98, v97
    s_nop 0
    v_cvt_pk_bf16_f32 v98, v98, v98
    v_lshlrev_b32 v98, 16, v98
    v_rcp_f32 v99, v98
    v_mov_b32 v25, v96
    v_mov_b32 v26, v98
    v_ashrrev_i32 v16, 31, v27
    v_or_b32 v16, 0x80000000, v16
    v_xor_b32 v24, v27, v16
    v_and_b32 v24, 0xfffff800, v24
    v_max_u32 v24, 0x800, v24
    s_sub_u32 s16, 2047, s14
    v_or_b32 v24, s16, v24
    s_lshl_b32 s16, s3, 4
    s_add_u32 s16, s16, 65536
    v_mov_b32 v16, s16
    ds_write_b128 v16, v[24:27]
    s_waitcnt lgkmcnt(0)
    s_barrier
    v_and_b32 v16, 7, v1
    v_lshlrev_b32 v16, 4, v16
    v_add_u32 v16, 65536, v16
    ds_read_b32 v76, v16
    s_waitcnt lgkmcnt(0)
    v_mov_b32 v77, v76
    s_nop 1
    v_max_u32_dpp v77, v77, v77 row_ror:1 row_mask:0xf bank_mask:0xf
    s_nop 1
    v_max_u32_dpp v77, v77, v77 row_ror:2 row_mask:0xf bank_mask:0xf
    s_nop 1
    v_max_u32_dpp v77, v77, v77 row_ror:4 row_mask:0xf bank_mask:0xf
    v_cmp_eq_u32 vcc, v76, v77
    s_ff1_i32_b64 s16, vcc
    s_lshl_b32 s16, s16, 4
    s_add_u32 s16, s16, 65536
    v_mov_b32 v16, s16
    ds_read_b128 v[24:27], v16
    s_lshl_b32 s16, s2, 4
    s_add_u32 s16, s16, 0x6e0000
    s_cmp_eq_u32 s3, 0
    s_cselect_b32 s16, s16, 0x7ffffff0
    v_mov_b32 v17, 0
    s_mov_b64 exec, 1
    s_waitcnt lgkmcnt(0)
    buffer_store_dwordx4 v[24:27], v17, s[8:11], s16 offen sc1
    s_mov_b64 exec, -1
    s_mov_b64 s[72:73], s[50:51]
    s_mov_b32 s74, 0x700000
    s_mov_b32 s75, 0x20000
    s_cmp_lt_u32 s2, 224
    s_cselect_b32 s74, 7340032, 0
    s_lshl_b32 s17, s29, 4
    s_sub_u32 s16, s3, 4
    s_lshl_b32 s16, s16, 2
    s_add_u32 s16, s16, s17
    s_lshl_b32 s16, s16, 11
    s_add_u32 s17, s16, 0
    buffer_load_dwordx4 v[152:155], v2, s[72:75], s17 offen offset:0
    buffer_load_dwordx4 v[156:159], v2, s[72:75], s17 offen offset:1024
    s_add_u32 s17, s16, 2048
    buffer_load_dwordx4 v[160:163], v2, s[72:75], s17 offen offset:0
    buffer_load_dwordx4 v[164:167], v2, s[72:75], s17 offen offset:1024
    s_add_u32 s17, s16, 4096
    buffer_load_dwordx4 v[168:171], v2, s[72:75], s17 offen offset:0
    buffer_load_dwordx4 v[172:175], v2, s[72:75], s17 offen offset:1024
    s_add_u32 s17, s16, 6144
    buffer_load_dwordx4 v[176:179], v2, s[72:75], s17 offen offset:0
    buffer_load_dwordx4 v[180:183], v2, s[72:75], s17 offen offset:1024
    v_sub_f32 v44, v28, v96
    v_sub_f32 v45, v29, v96
    v_sub_f32 v46, v30, v96
    v_sub_f32 v47, v31, v96
    v_sub_f32 v48, v32, v96
    v_sub_f32 v49, v33, v96
    v_sub_f32 v50, v34, v96
    v_sub_f32 v51, v35, v96
    v_cvt_pk_bf16_f32 v16, v44, v45
    v_lshlrev_b32 v44, 16, v16
    v_and_b32 v45, 0xffff0000, v16
    v_cvt_pk_bf16_f32 v16, v46, v47
    v_lshlrev_b32 v46, 16, v16
    v_and_b32 v47, 0xffff0000, v16
    v_cvt_pk_bf16_f32 v16, v48, v49
    v_lshlrev_b32 v48, 16, v16
    v_and_b32 v49, 0xffff0000, v16
    v_cvt_pk_bf16_f32 v16, v50, v51
    v_lshlrev_b32 v50, 16, v16
    v_and_b32 v51, 0xffff0000, v16
    v_mul_f32 v52, v44, v99
    v_mul_f32 v53, v45, v99
    v_mul_f32 v54, v46, v99
    v_mul_f32 v55, v47, v99
    v_mul_f32 v56, v48, v99
    v_mul_f32 v57, v49, v99
    v_mul_f32 v58, v50, v99
    v_mul_f32 v59, v51, v99
    v_fma_f32 v44, -v52, v98, v44
    v_fma_f32 v45, -v53, v98, v45
    v_fma_f32 v46, -v54, v98, v46
    v_fma_f32 v47, -v55, v98, v47
    v_fma_f32 v48, -v56, v98, v48
    v_fma_f32 v49, -v57, v98, v49
    v_fma_f32 v50, -v58, v98, v50
    v_fma_f32 v51, -v59, v98, v51
    v_fma_f32 v44, v44, v99, v52
    v_fma_f32 v45, v45, v99, v53
    v_fma_f32 v46, v46, v99, v54
    v_fma_f32 v47, v47, v99, v55
    v_fma_f32 v48, v48, v99, v56
    v_fma_f32 v49, v49, v99, v57
    v_fma_f32 v50, v50, v99, v58
    v_fma_f32 v51, v51, v99, v59
    v_cvt_pk_bf16_f32 v16, v44, v45
    v_lshlrev_b32 v44, 16, v16
    v_and_b32 v45, 0xffff0000, v16
    v_cvt_pk_bf16_f32 v16, v46, v47
    v_lshlrev_b32 v46, 16, v16
    v_and_b32 v47, 0xffff0000, v16
    v_cvt_pk_bf16_f32 v16, v48, v49
    v_lshlrev_b32 v48, 16, v16
    v_and_b32 v49, 0xffff0000, v16
    v_cvt_pk_bf16_f32 v16, v50, v51
    v_lshlrev_b32 v50, 16, v16
    v_and_b32 v51, 0xffff0000, v16
    v_lshlrev_b32 v52, 16, v192
    v_and_b32 v53, 0xffff0000, v192
    v_lshlrev_b32 v54, 16, v193
    v_and_b32 v55, 0xffff0000, v193
    v_lshlrev_b32 v56, 16, v194
    v_and_b32 v57, 0xffff0000, v194
    v_lshlrev_b32 v58, 16, v195
    v_and_b32 v59, 0xffff0000, v195
    v_pk_mul_f32 v[44:45], v[44:45], v[52:53]
    v_pk_mul_f32 v[46:47], v[46:47], v[54:55]
    v_pk_mul_f32 v[48:49], v[48:49], v[56:57]
    v_pk_mul_f32 v[50:51], v[50:51], v[58:59]
    v_cvt_pk_bf16_f32 v16, v44, v45
    v_lshlrev_b32 v44, 16, v16
    v_and_b32 v45, 0xffff0000, v16
    v_cvt_pk_bf16_f32 v16, v46, v47
    v_lshlrev_b32 v46, 16, v16
    v_and_b32 v47, 0xffff0000, v16
    v_cvt_pk_bf16_f32 v16, v48, v49
    v_lshlrev_b32 v48, 16, v16
    v_and_b32 v49, 0xffff0000, v16
    v_cvt_pk_bf16_f32 v16, v50, v51
    v_lshlrev_b32 v50, 16, v16
    v_and_b32 v51, 0xffff0000, v16
    v_lshlrev_b32 v52, 16, v184
    v_and_b32 v53, 0xffff0000, v184
    v_lshlrev_b32 v54, 16, v185
    v_and_b32 v55, 0xffff0000, v185
    v_lshlrev_b32 v56, 16, v186
    v_and_b32 v57, 0xffff0000, v186
    v_lshlrev_b32 v58, 16, v187
    v_and_b32 v59, 0xffff0000, v187
    v_pk_add_f32 v[44:45], v[44:45], v[52:53]
    v_pk_add_f32 v[46:47], v[46:47], v[54:55]
    v_pk_add_f32 v[48:49], v[48:49], v[56:57]
    v_pk_add_f32 v[50:51], v[50:51], v[58:59]
    v_cvt_pk_bf16_f32 v16, v44, v45
    v_lshlrev_b32 v44, 16, v16
    v_and_b32 v45, 0xffff0000, v16
    v_cvt_pk_bf16_f32 v16, v46, v47
    v_lshlrev_b32 v46, 16, v16
    v_and_b32 v47, 0xffff0000, v16
    v_cvt_pk_bf16_f32 v16, v48, v49
    v_lshlrev_b32 v48, 16, v16
    v_and_b32 v49, 0xffff0000, v16
    v_cvt_pk_bf16_f32 v16, v50, v51
    v_lshlrev_b32 v50, 16, v16
    v_and_b32 v51, 0xffff0000, v16
    v_lshlrev_b32 v52, 16, v200
    v_and_b32 v53, 0xffff0000, v200
    v_lshlrev_b32 v54, 16, v201
    v_and_b32 v55, 0xffff0000, v201
    v_lshlrev_b32 v56, 16, v202
    v_and_b32 v57, 0xffff0000, v202
    v_lshlrev_b32 v58, 16, v203
    v_and_b32 v59, 0xffff0000, v203
    v_pk_mul_f32 v[44:45], v[44:45], v[52:53]
    v_pk_mul_f32 v[46:47], v[46:47], v[54:55]
    v_pk_mul_f32 v[48:49], v[48:49], v[56:57]
    v_pk_mul_f32 v[50:51], v[50:51], v[58:59]
    v_cvt_pk_bf16_f32 v16, v44, v45
    v_lshlrev_b32 v44, 16, v16
    v_and_b32 v45, 0xffff0000, v16
    v_cvt_pk_bf16_f32 v16, v46, v47
    v_lshlrev_b32 v46, 16, v16
    v_and_b32 v47, 0xffff0000, v16
    v_cvt_pk_bf16_f32 v16, v48, v49
    v_lshlrev_b32 v48, 16, v16
    v_and_b32 v49, 0xffff0000, v16
    v_cvt_pk_bf16_f32 v16, v50, v51
    v_lshlrev_b32 v50, 16, v16
    v_and_b32 v51, 0xffff0000, v16
    v_pk_add_f32 v[44:45], v[44:45], v[28:29]
    v_pk_add_f32 v[46:47], v[46:47], v[30:31]
    v_pk_add_f32 v[48:49], v[48:49], v[32:33]
    v_pk_add_f32 v[50:51], v[50:51], v[34:35]
    v_cvt_pk_bf16_f32 v28, v44, v45
    v_cvt_pk_bf16_f32 v29, v46, v47
    v_cvt_pk_bf16_f32 v30, v48, v49
    v_cvt_pk_bf16_f32 v31, v50, v51
    v_sub_f32 v44, v36, v96
    v_sub_f32 v45, v37, v96
    v_sub_f32 v46, v38, v96
    v_sub_f32 v47, v39, v96
    v_sub_f32 v48, v40, v96
    v_sub_f32 v49, v41, v96
    v_sub_f32 v50, v42, v96
    v_sub_f32 v51, v43, v96
    v_cvt_pk_bf16_f32 v16, v44, v45
    v_lshlrev_b32 v44, 16, v16
    v_and_b32 v45, 0xffff0000, v16
    v_cvt_pk_bf16_f32 v16, v46, v47
    v_lshlrev_b32 v46, 16, v16
    v_and_b32 v47, 0xffff0000, v16
    v_cvt_pk_bf16_f32 v16, v48, v49
    v_lshlrev_b32 v48, 16, v16
    v_and_b32 v49, 0xffff0000, v16
    v_cvt_pk_bf16_f32 v16, v50, v51
    v_lshlrev_b32 v50, 16, v16
    v_and_b32 v51, 0xffff0000, v16
    v_mul_f32 v52, v44, v99
    v_mul_f32 v53, v45, v99
    v_mul_f32 v54, v46, v99
    v_mul_f32 v55, v47, v99
    v_mul_f32 v56, v48, v99
    v_mul_f32 v57, v49, v99
    v_mul_f32 v58, v50, v99
    v_mul_f32 v59, v51, v99
    v_fma_f32 v44, -v52, v98, v44
    v_fma_f32 v45, -v53, v98, v45
    v_fma_f32 v46, -v54, v98, v46
    v_fma_f32 v47, -v55, v98, v47
    v_fma_f32 v48, -v56, v98, v48
    v_fma_f32 v49, -v57, v98, v49
    v_fma_f32 v50, -v58, v98, v50
    v_fma_f32 v51, -v59, v98, v51
    v_fma_f32 v44, v44, v99, v52
    v_fma_f32 v45, v45, v99, v53
    v_fma_f32 v46, v46, v99, v54
    v_fma_f32 v47, v47, v99, v55
    v_fma_f32 v48, v48, v99, v56
    v_fma_f32 v49, v49, v99, v57
    v_fma_f32 v50, v50, v99, v58
    v_fma_f32 v51, v51, v99, v59
    v_cvt_pk_bf16_f32 v16, v44, v45
    v_lshlrev_b32 v44, 16, v16
    v_and_b32 v45, 0xffff0000, v16
    v_cvt_pk_bf16_f32 v16, v46, v47
    v_lshlrev_b32 v46, 16, v16
    v_and_b32 v47, 0xffff0000, v16
    v_cvt_pk_bf16_f32 v16, v48, v49
    v_lshlrev_b32 v48, 16, v16
    v_and_b32 v49, 0xffff0000, v16
    v_cvt_pk_bf16_f32 v16, v50, v51
    v_lshlrev_b32 v50, 16, v16
    v_and_b32 v51, 0xffff0000, v16
    v_lshlrev_b32 v52, 16, v196
    v_and_b32 v53, 0xffff0000, v196
    v_lshlrev_b32 v54, 16, v197
    v_and_b32 v55, 0xffff0000, v197
    v_lshlrev_b32 v56, 16, v198
    v_and_b32 v57, 0xffff0000, v198
    v_lshlrev_b32 v58, 16, v199
    v_and_b32 v59, 0xffff0000, v199
    v_pk_mul_f32 v[44:45], v[44:45], v[52:53]
    v_pk_mul_f32 v[46:47], v[46:47], v[54:55]
    v_pk_mul_f32 v[48:49], v[48:49], v[56:57]
    v_pk_mul_f32 v[50:51], v[50:51], v[58:59]
    v_cvt_pk_bf16_f32 v16, v44, v45
    v_lshlrev_b32 v44, 16, v16
    v_and_b32 v45, 0xffff0000, v16
    v_cvt_pk_bf16_f32 v16, v46, v47
    v_lshlrev_b32 v46, 16, v16
    v_and_b32 v47, 0xffff0000, v16
    v_cvt_pk_bf16_f32 v16, v48, v49
    v_lshlrev_b32 v48, 16, v16
    v_and_b32 v49, 0xffff0000, v16
    v_cvt_pk_bf16_f32 v16, v50, v51
    v_lshlrev_b32 v50, 16, v16
    v_and_b32 v51, 0xffff0000, v16
    v_lshlrev_b32 v52, 16, v188
    v_and_b32 v53, 0xffff0000, v188
    v_lshlrev_b32 v54, 16, v189
    v_and_b32 v55, 0xffff0000, v189
    v_lshlrev_b32 v56, 16, v190
    v_and_b32 v57, 0xffff0000, v190
    v_lshlrev_b32 v58, 16, v191
    v_and_b32 v59, 0xffff0000, v191
    v_pk_add_f32 v[44:45], v[44:45], v[52:53]
    v_pk_add_f32 v[46:47], v[46:47], v[54:55]
    v_pk_add_f32 v[48:49], v[48:49], v[56:57]
    v_pk_add_f32 v[50:51], v[50:51], v[58:59]
    v_cvt_pk_bf16_f32 v16, v44, v45
    v_lshlrev_b32 v44, 16, v16
    v_and_b32 v45, 0xffff0000, v16
    v_cvt_pk_bf16_f32 v16, v46, v47
    v_lshlrev_b32 v46, 16, v16
    v_and_b32 v47, 0xffff0000, v16
    v_cvt_pk_bf16_f32 v16, v48, v49
    v_lshlrev_b32 v48, 16, v16
    v_and_b32 v49, 0xffff0000, v16
    v_cvt_pk_bf16_f32 v16, v50, v51
    v_lshlrev_b32 v50, 16, v16
    v_and_b32 v51, 0xffff0000, v16
    v_lshlrev_b32 v52, 16, v204
    v_and_b32 v53, 0xffff0000, v204
    v_lshlrev_b32 v54, 16, v205
    v_and_b32 v55, 0xffff0000, v205
    v_lshlrev_b32 v56, 16, v206
    v_and_b32 v57, 0xffff0000, v206
    v_lshlrev_b32 v58, 16, v207
    v_and_b32 v59, 0xffff0000, v207
    v_pk_mul_f32 v[44:45], v[44:45], v[52:53]
    v_pk_mul_f32 v[46:47], v[46:47], v[54:55]
    v_pk_mul_f32 v[48:49], v[48:49], v[56:57]
    v_pk_mul_f32 v[50:51], v[50:51], v[58:59]
    v_cvt_pk_bf16_f32 v16, v44, v45
    v_lshlrev_b32 v44, 16, v16
    v_and_b32 v45, 0xffff0000, v16
    v_cvt_pk_bf16_f32 v16, v46, v47
    v_lshlrev_b32 v46, 16, v16
    v_and_b32 v47, 0xffff0000, v16
    v_cvt_pk_bf16_f32 v16, v48, v49
    v_lshlrev_b32 v48, 16, v16
    v_and_b32 v49, 0xffff0000, v16
    v_cvt_pk_bf16_f32 v16, v50, v51
    v_lshlrev_b32 v50, 16, v16
    v_and_b32 v51, 0xffff0000, v16
    v_pk_add_f32 v[44:45], v[44:45], v[36:37]
    v_pk_add_f32 v[46:47], v[46:47], v[38:39]
    v_pk_add_f32 v[48:49], v[48:49], v[40:41]
    v_pk_add_f32 v[50:51], v[50:51], v[42:43]
    v_cvt_pk_bf16_f32 v36, v44, v45
    v_cvt_pk_bf16_f32 v37, v46, v47
    v_cvt_pk_bf16_f32 v38, v48, v49
    v_cvt_pk_bf16_f32 v39, v50, v51
    s_barrier
    v_and_b32 v16, 3, v1
    v_lshlrev_b32 v16, 4, v16
    v_add_u32 v16, 65792, v16
    ds_read_b32 v76, v16
    s_waitcnt lgkmcnt(0)
    v_mov_b32 v77, v76
    s_nop 1
    v_max_u32_dpp v77, v77, v77 row_ror:1 row_mask:0xf bank_mask:0xf
    s_nop 1
    v_max_u32_dpp v77, v77, v77 row_ror:2 row_mask:0xf bank_mask:0xf
    v_cmp_eq_u32 vcc, v76, v77
    s_ff1_i32_b64 s16, vcc
    s_lshl_b32 s16, s16, 4
    s_add_u32 s16, s16, 65792
    v_mov_b32 v16, s16
    ds_read_b128 v[24:27], v16
    s_waitcnt lgkmcnt(0)
    v_and_b32 v76, 0x7ff, v24
    v_sub_u32 v76, 2047, v76
    s_nop 0
    v_readfirstlane_b32 s12, v76
    v_rcp_f32 v103, v26
    s_lshr_b32 s18, s12, 4
    s_lshl_b32 s18, s18, 15
    s_and_b32 s19, s12, 15
    s_lshl_b32 s19, s19, 6
    s_add_u32 s18, s18, s19
    s_add_u32 s18, s18, 0x2c00000
    s_add_u32 s19, s18, 0x400000
    v_lshrrev_b32 v18, 4, v0
    v_lshlrev_b32 v18, 10, v18
    v_and_b32 v19, 15, v0
    v_lshl_add_u32 v18, v19, 2, v18
    s_lshl_b32 s13, s12, 11
    buffer_load_dword v100, v18, s[8:11], s18 offen sc1
    buffer_load_dword v101, v18, s[8:11], s19 offen sc1
    buffer_load_dword v102, v21, s[76:79], s13 offen
    s_lshl_b32 s16, s14, 11
    s_cmp_lg_u32 s12, s14
    s_cselect_b32 s16, s16, 0x7ffffff0
    buffer_store_dwordx4 v[28:31], v2, s[68:71], s16 offen offset:0 sc1
    buffer_store_dwordx4 v[36:39], v2, s[68:71], s16 offen offset:1024 sc1
    s_lshl_b32 s16, s3, 13
    v_add_u32 v20, s16, v2
    s_waitcnt vmcnt(4)
    v_lshlrev_b32 v76, 16, v100
    v_and_b32 v77, 0xffff0000, v100
    s_waitcnt vmcnt(3)
    v_lshlrev_b32 v78, 16, v101
    v_and_b32 v79, 0xffff0000, v101
    v_pk_add_f32 v[76:77], v[76:77], v[78:79]
    s_waitcnt vmcnt(2)
    v_lshlrev_b32 v78, 16, v102
    v_and_b32 v79, 0xffff0000, v102
    v_pk_add_f32 v[92:93], v[78:79], v[76:77]
    v_cvt_pk_bf16_f32 v76, v92, v93
    v_lshlrev_b32 v92, 16, v76
    v_and_b32 v93, 0xffff0000, v76
    v_cvt_pk_bf16_f32 v100, v92, v93
    v_and_b32 v105, 0xffff0000, v104
    v_lshlrev_b32 v104, 16, v104
    v_and_b32 v107, 0xffff0000, v106
    v_lshlrev_b32 v106, 16, v106
    v_sub_f32 v92, v92, v25
    v_sub_f32 v93, v93, v25
    v_cvt_pk_bf16_f32 v76, v92, v93
    v_lshlrev_b32 v92, 16, v76
    v_and_b32 v93, 0xffff0000, v76
    v_mul_f32 v77, v92, v103
    v_fma_f32 v92, -v77, v26, v92
    v_fma_f32 v92, v92, v103, v77
    v_mul_f32 v77, v93, v103
    v_fma_f32 v93, -v77, v26, v93
    v_fma_f32 v93, v93, v103, v77
    v_cvt_pk_bf16_f32 v76, v92, v93
    v_lshlrev_b32 v92, 16, v76
    v_and_b32 v93, 0xffff0000, v76
    v_mul_f32 v92, v92, v104
    v_mul_f32 v93, v93, v105
    v_cvt_pk_bf16_f32 v76, v92, v93
    v_lshlrev_b32 v92, 16, v76
    v_and_b32 v93, 0xffff0000, v76
    v_add_f32 v92, v92, v106
    v_add_f32 v93, v93, v107
    v_cvt_pk_bf16_f32 v101, v92, v93
    v_add_u32 v16, 66560, v21
    ds_write_b32 v16, v101
    ds_write_b32 v16, v100 offset:2048
    s_waitcnt lgkmcnt(0)
    s_barrier
    ds_read_b128 v[60:63], v20 offset:0
    ds_read_b128 v[64:67], v20 offset:1024
    ds_read_b128 v[68:71], v20 offset:2048
    ds_read_b128 v[72:75], v20 offset:3072
    ds_read_b128 v[108:111], v20 offset:4096
    ds_read_b128 v[112:115], v20 offset:5120
    ds_read_b128 v[116:119], v20 offset:6144
    ds_read_b128 v[120:123], v20 offset:7168
    s_and_b32 s16, s3, 3
    s_lshl_b32 s16, s16, 7
    s_and_b32 s17, s29, 3
    s_lshl_b32 s17, s17, 9
    s_add_u32 s16, s16, s17
    s_add_u32 s16, s16, 66560
    v_lshrrev_b32 v16, 3, v1
    v_lshlrev_b32 v16, 4, v16
    v_add_u32 v16, s16, v16
    ds_read_b128 v[104:107], v16
    s_waitcnt lgkmcnt(0)
    v_lshlrev_b32 v76, 16, v104
    v_and_b32 v77, 0xffff, v104
    v_dot2_f32_bf16 v85, v60, v76, 0
    v_dot2_f32_bf16 v84, v60, v77, 0
    v_dot2_f32_bf16 v87, v61, v76, 0
    v_dot2_f32_bf16 v86, v61, v77, 0
    v_dot2_f32_bf16 v89, v62, v76, 0
    v_dot2_f32_bf16 v88, v62, v77, 0
    v_dot2_f32_bf16 v91, v63, v76, 0
    v_dot2_f32_bf16 v90, v63, v77, 0
    v_and_b32 v78, 0xffff0000, v104
    v_lshrrev_b32 v79, 16, v104
    v_dot2c_f32_bf16 v85, v64, v78
    v_dot2c_f32_bf16 v84, v64, v79
    v_dot2c_f32_bf16 v87, v65, v78
    v_dot2c_f32_bf16 v86, v65, v79
    v_dot2c_f32_bf16 v89, v66, v78
    v_dot2c_f32_bf16 v88, v66, v79
    v_dot2c_f32_bf16 v91, v67, v78
    v_dot2c_f32_bf16 v90, v67, v79
    v_lshlrev_b32 v80, 16, v105
    v_and_b32 v81, 0xffff, v105
    v_dot2c_f32_bf16 v85, v68, v80
    v_dot2c_f32_bf16 v84, v68, v81
    v_dot2c_f32_bf16 v87, v69, v80
    v_dot2c_f32_bf16 v86, v69, v81
    v_dot2c_f32_bf16 v89, v70, v80
    v_dot2c_f32_bf16 v88, v70, v81
    v_dot2c_f32_bf16 v91, v71, v80
    v_dot2c_f32_bf16 v90, v71, v81
    v_and_b32 v82, 0xffff0000, v105
    v_lshrrev_b32 v83, 16, v105
    v_dot2c_f32_bf16 v85, v72, v82
    v_dot2c_f32_bf16 v84, v72, v83
    v_dot2c_f32_bf16 v87, v73, v82
    v_dot2c_f32_bf16 v86, v73, v83
    v_dot2c_f32_bf16 v89, v74, v82
    v_dot2c_f32_bf16 v88, v74, v83
    v_dot2c_f32_bf16 v91, v75, v82
    v_dot2c_f32_bf16 v90, v75, v83
    v_lshlrev_b32 v76, 16, v106
    v_and_b32 v77, 0xffff, v106
    v_dot2c_f32_bf16 v85, v108, v76
    v_dot2c_f32_bf16 v84, v108, v77
    v_dot2c_f32_bf16 v87, v109, v76
    v_dot2c_f32_bf16 v86, v109, v77
    v_dot2c_f32_bf16 v89, v110, v76
    v_dot2c_f32_bf16 v88, v110, v77
    v_dot2c_f32_bf16 v91, v111, v76
    v_dot2c_f32_bf16 v90, v111, v77
    v_and_b32 v78, 0xffff0000, v106
    v_lshrrev_b32 v79, 16, v106
    v_dot2c_f32_bf16 v85, v112, v78
    v_dot2c_f32_bf16 v84, v112, v79
    v_dot2c_f32_bf16 v87, v113, v78
    v_dot2c_f32_bf16 v86, v113, v79
    v_dot2c_f32_bf16 v89, v114, v78
    v_dot2c_f32_bf16 v88, v114, v79
    v_dot2c_f32_bf16 v91, v115, v78
    v_dot2c_f32_bf16 v90, v115, v79
    v_lshlrev_b32 v80, 16, v107
    v_and_b32 v81, 0xffff, v107
    v_dot2c_f32_bf16 v85, v116, v80
    v_dot2c_f32_bf16 v84, v116, v81
    v_dot2c_f32_bf16 v87, v117, v80
    v_dot2c_f32_bf16 v86, v117, v81
    v_dot2c_f32_bf16 v89, v118, v80
    v_dot2c_f32_bf16 v88, v118, v81
    v_dot2c_f32_bf16 v91, v119, v80
    v_dot2c_f32_bf16 v90, v119, v81
    v_and_b32 v82, 0xffff0000, v107
    v_lshrrev_b32 v83, 16, v107
    v_dot2c_f32_bf16 v85, v120, v82
    v_dot2c_f32_bf16 v84, v120, v83
    v_dot2c_f32_bf16 v87, v121, v82
    v_dot2c_f32_bf16 v86, v121, v83
    v_dot2c_f32_bf16 v89, v122, v82
    v_dot2c_f32_bf16 v88, v122, v83
    v_dot2c_f32_bf16 v91, v123, v82
    v_dot2c_f32_bf16 v90, v123, v83
    s_nop 0
    v_permlane32_swap_b32 v84, v88
    v_permlane32_swap_b32 v85, v89
    v_permlane32_swap_b32 v86, v90
    v_permlane32_swap_b32 v87, v91
    v_add_f32 v84, v84, v88
    v_add_f32 v85, v85, v89
    v_add_f32 v86, v86, v90
    v_add_f32 v87, v87, v91
    s_nop 0
    v_permlane16_swap_b32 v84, v86
    v_permlane16_swap_b32 v85, v87
    v_add_f32 v84, v84, v86
    v_add_f32 v85, v85, v87
    s_nop 0
    v_add_f32_dpp v84, v84, v84 row_ror:8 row_mask:0xf bank_mask:0xf
    v_add_f32_dpp v85, v85, v85 row_ror:8 row_mask:0xf bank_mask:0xf
    v_and_b32 v16, 7, v1
    v_lshlrev_b32 v16, 5, v16
    v_lshrrev_b32 v17, 4, v1
    v_lshl_add_u32 v16, v17, 3, v16
    s_lshl_b32 s16, s3, 8
    s_add_u32 s16, s16, 70656
    v_add_u32 v16, s16, v16
    ds_write_b64 v16, v[84:85]
    s_lshr_b32 s16, s3, 2
    s_lshl_b32 s17, s16, 10
    s_add_u32 s17, s17, 70656
    v_lshlrev_b32 v17, 2, v1
    v_add_u32 v16, s17, v17
    s_and_b32 s17, s29, 3
    s_lshl_b32 s17, s17, 1
    s_add_u32 s17, s17, s16
    s_mul_i32 s17, s17, 14336
    s_lshr_b32 s16, s29, 2
    s_lshl_b32 s16, s16, 8
    s_add_u32 s17, s17, s16
    s_add_u32 s17, s17, 0x6e1000
    s_and_b32 s16, s3, 3
    s_cmp_eq_u32 s16, 0
    s_cselect_b32 s17, s17, 0x7ffffff0
    s_cmp_lt_u32 s2, 224
    s_cselect_b32 s17, s17, 0x7ffffff0
    s_waitcnt lgkmcnt(0)
    s_barrier
    ds_read_b32 v84, v16 offset:0
    ds_read_b32 v85, v16 offset:256
    ds_read_b32 v86, v16 offset:512
    ds_read_b32 v87, v16 offset:768
    s_waitcnt lgkmcnt(2)
    v_add_f32 v84, v84, v85
    s_waitcnt lgkmcnt(0)
    v_add_f32 v86, v86, v87
    v_add_f32 v84, v84, v86
    v_or_b32 v84, 1, v84
    buffer_store_dword v84, v17, s[8:11], s17 offen sc1
    v_lshrrev_b32 v16, 4, v1
    v_mul_u32_u24 v16, 28672, v16
    v_and_b32 v17, 15, v1
    v_lshl_add_u32 v16, v17, 2, v16
    s_lshl_b32 s16, s29, 6
    s_add_u32 s16, s16, 0x6e1000
    s_add_u32 s17, s16, 14336
    s_mov_b32 s27, 0
adaLN_cond__sliding_block_cached__moe_arch_mod__prompt_kernel_gu23p:
    buffer_load_dword v84, v16, s[8:11], s16 offen sc1
    buffer_load_dword v85, v16, s[8:11], s17 offen sc1
    s_waitcnt vmcnt(0)
    v_min_u32 v86, v84, v85
    v_cmp_eq_u32 vcc, 0, v86
    s_cmp_lt_u32 s2, 224
    s_cselect_b64 s[62:63], -1, 0
    s_and_b64 vcc, vcc, s[62:63]
    s_add_u32 s27, s27, 1
    s_cmp_ge_u32 s27, 262144
    s_cbranch_scc1 adaLN_cond__sliding_block_cached__moe_arch_mod__prompt_kernel_gu23g
    s_cbranch_vccnz adaLN_cond__sliding_block_cached__moe_arch_mod__prompt_kernel_gu23p
adaLN_cond__sliding_block_cached__moe_arch_mod__prompt_kernel_gu23g:
    v_mov_b32 v86, v84
    s_nop 1
    v_permlane16_swap_b32 v84, v86
    v_add_f32 v84, v84, v86
    v_mov_b32 v87, v85
    s_nop 1
    v_permlane16_swap_b32 v85, v87
    v_add_f32 v85, v85, v87
    v_mov_b32 v86, v84
    s_nop 1
    v_permlane32_swap_b32 v84, v86
    v_add_f32 v84, v84, v86
    v_mov_b32 v87, v85
    s_nop 1
    v_permlane32_swap_b32 v85, v87
    v_add_f32 v85, v85, v87
    v_cvt_pk_bf16_f32 v86, v84, v85
    v_lshlrev_b32 v84, 16, v86
    v_and_b32 v85, 0xffff0000, v86
    v_mul_f32 v86, 0xbfb8aa3b, v84
    v_exp_f32 v86, v86
    s_nop 0
    v_add_f32 v86, 1.0, v86
    v_rcp_f32 v86, v86
    s_nop 0
    v_mul_f32 v84, v84, v86
    v_cvt_pk_bf16_f32 v84, v84, v84
    v_lshlrev_b32 v84, 16, v84
    v_mul_f32 v84, v84, v85
    v_cvt_pk_bf16_f32 v84, v84, v84
    v_lshlrev_b32 v84, 16, v84
    s_sub_u32 s16, s3, 4
    s_lshl_b32 s16, s16, 2
    s_add_u32 s17, s16, 0
    v_readlane_b32 s20, v84, s17
    s_lshr_b32 s4, s20, 16
    s_add_u32 s17, s16, 1
    v_readlane_b32 s21, v84, s17
    s_lshr_b32 s5, s21, 16
    s_add_u32 s17, s16, 2
    v_readlane_b32 s22, v84, s17
    s_lshr_b32 s6, s22, 16
    s_add_u32 s17, s16, 3
    v_readlane_b32 s23, v84, s17
    s_lshr_b32 s7, s23, 16
    v_dot2_f32_bf16 v45, v152, s20, 0
    v_dot2_f32_bf16 v44, v152, s4, 0
    v_dot2_f32_bf16 v47, v153, s20, 0
    v_dot2_f32_bf16 v46, v153, s4, 0
    v_dot2_f32_bf16 v49, v154, s20, 0
    v_dot2_f32_bf16 v48, v154, s4, 0
    v_dot2_f32_bf16 v51, v155, s20, 0
    v_dot2_f32_bf16 v50, v155, s4, 0
    v_dot2_f32_bf16 v53, v156, s20, 0
    v_dot2_f32_bf16 v52, v156, s4, 0
    v_dot2_f32_bf16 v55, v157, s20, 0
    v_dot2_f32_bf16 v54, v157, s4, 0
    v_dot2_f32_bf16 v57, v158, s20, 0
    v_dot2_f32_bf16 v56, v158, s4, 0
    v_dot2_f32_bf16 v59, v159, s20, 0
    v_dot2_f32_bf16 v58, v159, s4, 0
    v_dot2c_f32_bf16 v45, s21, v160
    v_dot2c_f32_bf16 v44, s5, v160
    v_dot2c_f32_bf16 v47, s21, v161
    v_dot2c_f32_bf16 v46, s5, v161
    v_dot2c_f32_bf16 v49, s21, v162
    v_dot2c_f32_bf16 v48, s5, v162
    v_dot2c_f32_bf16 v51, s21, v163
    v_dot2c_f32_bf16 v50, s5, v163
    v_dot2c_f32_bf16 v53, s21, v164
    v_dot2c_f32_bf16 v52, s5, v164
    v_dot2c_f32_bf16 v55, s21, v165
    v_dot2c_f32_bf16 v54, s5, v165
    v_dot2c_f32_bf16 v57, s21, v166
    v_dot2c_f32_bf16 v56, s5, v166
    v_dot2c_f32_bf16 v59, s21, v167
    v_dot2c_f32_bf16 v58, s5, v167
    v_dot2c_f32_bf16 v45, s22, v168
    v_dot2c_f32_bf16 v44, s6, v168
    v_dot2c_f32_bf16 v47, s22, v169
    v_dot2c_f32_bf16 v46, s6, v169
    v_dot2c_f32_bf16 v49, s22, v170
    v_dot2c_f32_bf16 v48, s6, v170
    v_dot2c_f32_bf16 v51, s22, v171
    v_dot2c_f32_bf16 v50, s6, v171
    v_dot2c_f32_bf16 v53, s22, v172
    v_dot2c_f32_bf16 v52, s6, v172
    v_dot2c_f32_bf16 v55, s22, v173
    v_dot2c_f32_bf16 v54, s6, v173
    v_dot2c_f32_bf16 v57, s22, v174
    v_dot2c_f32_bf16 v56, s6, v174
    v_dot2c_f32_bf16 v59, s22, v175
    v_dot2c_f32_bf16 v58, s6, v175
    v_dot2c_f32_bf16 v45, s23, v176
    v_dot2c_f32_bf16 v44, s7, v176
    v_dot2c_f32_bf16 v47, s23, v177
    v_dot2c_f32_bf16 v46, s7, v177
    v_dot2c_f32_bf16 v49, s23, v178
    v_dot2c_f32_bf16 v48, s7, v178
    v_dot2c_f32_bf16 v51, s23, v179
    v_dot2c_f32_bf16 v50, s7, v179
    v_dot2c_f32_bf16 v53, s23, v180
    v_dot2c_f32_bf16 v52, s7, v180
    v_dot2c_f32_bf16 v55, s23, v181
    v_dot2c_f32_bf16 v54, s7, v181
    v_dot2c_f32_bf16 v57, s23, v182
    v_dot2c_f32_bf16 v56, s7, v182
    v_dot2c_f32_bf16 v59, s23, v183
    v_dot2c_f32_bf16 v58, s7, v183
    s_sub_u32 s16, s3, 4
    s_lshl_b32 s16, s16, 12
    s_add_u32 s16, s16, 73728
    v_lshlrev_b32 v16, 5, v1
    v_add_u32 v16, s16, v16
    ds_write_b128 v16, v[44:47] offset:0
    ds_write_b128 v16, v[48:51] offset:16
    ds_write_b128 v16, v[52:55] offset:2048
    ds_write_b128 v16, v[56:59] offset:2064
    s_waitcnt lgkmcnt(0)
    s_barrier
    v_lshlrev_b32 v16, 3, v0
    v_add_u32 v17, 73728, v16
    ds_read_b64 v[84:85], v17 offset:0
    ds_read_b64 v[86:87], v17 offset:4096
    ds_read_b64 v[88:89], v17 offset:8192
    ds_read_b64 v[90:91], v17 offset:12288
    s_waitcnt lgkmcnt(2)
    v_pk_add_f32 v[84:85], v[84:85], v[86:87]
    s_waitcnt lgkmcnt(0)
    v_pk_add_f32 v[88:89], v[88:89], v[90:91]
    v_pk_add_f32 v[84:85], v[84:85], v[88:89]
    v_or_b32 v84, 1, v84
    v_or_b32 v85, 1, v85
    s_lshl_b32 s16, s29, 12
    s_add_u32 s16, s16, 0x600000
    s_cmp_lt_u32 s2, 224
    s_cselect_b32 s16, s16, 0x7ffffff0
    buffer_store_dwordx2 v[84:85], v16, s[8:11], s16 offen sc1
    s_cmp_lt_u32 s2, 224
    s_cbranch_scc1 adaLN_cond__sliding_block_cached__moe_arch_mod__prompt_kernel_end
    s_sub_u32 s16, s2, 224
    s_lshl_b32 s17, s16, 7
    s_add_u32 s17, s17, 0x600000
    v_lshrrev_b32 v16, 3, v0
    v_lshlrev_b32 v16, 12, v16
    v_and_b32 v17, 7, v0
    v_lshl_add_u32 v16, v17, 4, v16
    v_cmp_gt_u32 vcc, 256, v0
    v_bfrev_b32 v17, -2
    s_nop 0
    v_cndmask_b32 v17, v17, v16, vcc
    v_mov_b32 v19, 0
    v_cndmask_b32 v18, 1, v19, vcc
    s_lshl_b32 s18, s16, 6
    v_and_b32 v19, 31, v1
    v_lshlrev_b32 v19, 1, v19
    v_add_u32 v19, s18, v19
    s_mov_b32 s19, 0x541800
    buffer_load_ushort v95, v19, s[8:11], s19 offen sc1
    v_add_u32 v20, 66560, v19
    ds_read_u16 v96, v20
    ds_read_u16 v97, v20 offset:2048
    v_mov_b32 v94, v27
    v_cvt_pk_bf16_f32 v94, v94, v94
    v_lshlrev_b32 v94, 16, v94
    v_mul_f32 v94, 0xbfb8aa3b, v94
    v_exp_f32 v94, v94
    s_nop 0
    v_add_f32 v94, 1.0, v94
    v_rcp_f32 v94, v94
    s_nop 0
    v_cvt_pk_bf16_f32 v94, v94, v94
    v_lshlrev_b32 v94, 16, v94
    s_waitcnt vmcnt(0)
    v_lshlrev_b32 v95, 16, v95
    s_waitcnt lgkmcnt(1)
    v_lshlrev_b32 v96, 16, v96
    s_waitcnt lgkmcnt(0)
    v_lshlrev_b32 v97, 16, v97
    s_mov_b32 s27, 0
adaLN_cond__sliding_block_cached__moe_arch_mod__prompt_kernel_y24p:
    s_add_u32 s19, s17, 0x0
    buffer_load_dwordx4 v[44:47], v16, s[8:11], s19 offen sc1
    s_add_u32 s19, s17, 0x40000
    buffer_load_dwordx4 v[48:51], v16, s[8:11], s19 offen sc1
    s_add_u32 s19, s17, 0x80000
    buffer_load_dwordx4 v[52:55], v16, s[8:11], s19 offen sc1
    s_add_u32 s19, s17, 0xc0000
    buffer_load_dwordx4 v[56:59], v17, s[8:11], s19 offen sc1
    s_waitcnt vmcnt(0)
    v_min3_u32 v98, v56, v57, v58
    v_min_u32 v98, v98, v59
    v_or_b32 v98, v98, v18
    v_min3_u32 v98, v98, v44, v45
    v_min3_u32 v98, v98, v46, v47
    v_min3_u32 v98, v98, v48, v49
    v_min3_u32 v98, v98, v50, v51
    v_min3_u32 v98, v98, v52, v53
    v_min3_u32 v98, v98, v54, v55
    v_cmp_eq_u32 vcc, 0, v98
    s_add_u32 s27, s27, 1
    s_cmp_ge_u32 s27, 262144
    s_cbranch_scc1 adaLN_cond__sliding_block_cached__moe_arch_mod__prompt_kernel_y24g
    s_cbranch_vccnz adaLN_cond__sliding_block_cached__moe_arch_mod__prompt_kernel_y24p
adaLN_cond__sliding_block_cached__moe_arch_mod__prompt_kernel_y24g:
    v_pk_add_f32 v[44:45], v[44:45], v[52:53]
    v_pk_add_f32 v[46:47], v[46:47], v[54:55]
    v_pk_add_f32 v[48:49], v[48:49], v[56:57]
    v_pk_add_f32 v[50:51], v[50:51], v[58:59]
    v_pk_add_f32 v[44:45], v[44:45], v[48:49]
    v_pk_add_f32 v[46:47], v[46:47], v[50:51]
    s_nop 0
    v_add_f32_dpp v44, v44, v44 row_ror:8 row_mask:0xf bank_mask:0xf
    v_add_f32_dpp v45, v45, v45 row_ror:8 row_mask:0xf bank_mask:0xf
    v_add_f32_dpp v46, v46, v46 row_ror:8 row_mask:0xf bank_mask:0xf
    v_add_f32_dpp v47, v47, v47 row_ror:8 row_mask:0xf bank_mask:0xf
    s_nop 0
    v_permlane32_swap_b32 v44, v46
    v_permlane32_swap_b32 v45, v47
    v_add_f32 v44, v44, v46
    v_add_f32 v45, v45, v47
    s_nop 1
    v_permlane16_swap_b32 v44, v45
    v_add_f32 v44, v44, v45
    v_and_b32 v16, 7, v1
    v_lshlrev_b32 v16, 4, v16
    v_lshrrev_b32 v17, 4, v1
    v_lshl_add_u32 v16, v17, 2, v16
    s_lshl_b32 s19, s3, 7
    s_add_u32 s19, s19, 91136
    v_add_u32 v16, s19, v16
    ds_write_b32 v16, v44
    v_and_b32 v16, 31, v1
    v_lshlrev_b32 v16, 2, v16
    v_add_u32 v16, 91136, v16
    s_waitcnt lgkmcnt(0)
    s_barrier
    s_cmp_lg_u32 s3, 0
    s_cbranch_scc1 adaLN_cond__sliding_block_cached__moe_arch_mod__prompt_kernel_end
    ds_read_b32 v44, v16 offset:0
    ds_read_b32 v45, v16 offset:128
    ds_read_b32 v46, v16 offset:256
    ds_read_b32 v47, v16 offset:384
    ds_read_b32 v48, v16 offset:512
    ds_read_b32 v49, v16 offset:640
    ds_read_b32 v50, v16 offset:768
    ds_read_b32 v51, v16 offset:896
    s_waitcnt lgkmcnt(3)
    v_add_f32 v44, v44, v48
    s_waitcnt lgkmcnt(2)
    v_add_f32 v45, v45, v49
    s_waitcnt lgkmcnt(1)
    v_add_f32 v46, v46, v50
    s_waitcnt lgkmcnt(0)
    v_add_f32 v47, v47, v51
    v_add_f32 v44, v44, v46
    v_add_f32 v45, v45, v47
    v_add_f32 v44, v44, v45
    v_cvt_pk_bf16_f32 v44, v44, v44
    v_lshlrev_b32 v44, 16, v44
    v_mul_f32 v44, v44, v94
    v_cvt_pk_bf16_f32 v44, v44, v44
    v_lshlrev_b32 v44, 16, v44
    v_add_f32 v44, v44, v96
    v_cvt_pk_bf16_f32 v44, v44, v44
    v_lshlrev_b32 v44, 16, v44
    v_mul_f32 v44, v44, v95
    v_cvt_pk_bf16_f32 v44, v44, v44
    v_lshlrev_b32 v44, 16, v44
    v_add_f32 v44, v44, v97
    v_cvt_pk_bf16_f32 v44, v44, v44
    s_mov_b64 exec, 0xffffffff
    buffer_store_short v44, v19, s[68:71], s13 offen sc1
adaLN_cond__sliding_block_cached__moe_arch_mod__prompt_kernel_end:
    s_endpgm
adaLN_cond__sliding_block_cached__moe_arch_mod__prompt_kernel_n1r:
    s_mov_b32 s27, 0
adaLN_cond__sliding_block_cached__moe_arch_mod__prompt_kernel_n1p:
    buffer_load_dword v134, v132, s[64:67], 0 offen sc1
    s_waitcnt vmcnt(0)
    v_cmp_eq_u32 vcc, 0, v134
    s_cmp_eq_u32 s3, 0
    s_cselect_b64 s[62:63], -1, 0
    s_and_b64 vcc, vcc, s[62:63]
    s_add_u32 s27, s27, 1
    s_cmp_ge_u32 s27, 262144
    s_cbranch_scc1 adaLN_cond__sliding_block_cached__moe_arch_mod__prompt_kernel_n1g
    s_cbranch_vccnz adaLN_cond__sliding_block_cached__moe_arch_mod__prompt_kernel_n1p
adaLN_cond__sliding_block_cached__moe_arch_mod__prompt_kernel_n1g:
    s_waitcnt vmcnt(0) lgkmcnt(0)
    s_nop 15
    s_nop 3
    s_branch adaLN_cond__sliding_block_cached__moe_arch_mod__prompt_kernel_n1b
adaLN_cond__sliding_block_cached__moe_arch_mod__prompt_kernel_kv4r:
    s_waitcnt vmcnt(0) lgkmcnt(0)
    s_nop 15
    s_nop 3
    s_mov_b32 s27, 0
adaLN_cond__sliding_block_cached__moe_arch_mod__prompt_kernel_kv4p:
    buffer_load_dwordx4 v[12:15], v21, s[8:11], s18 offen sc1
    s_waitcnt vmcnt(0)
    v_xor_b32 v8, s28, v12
    v_xor_b32 v20, s28, v13
    v_or_b32 v8, v8, v20
    v_xor_b32 v20, s28, v14
    v_or_b32 v8, v8, v20
    v_xor_b32 v20, s28, v15
    v_or_b32 v8, v8, v20
    v_cmp_ne_u32 vcc, 0, v8
    s_add_u32 s27, s27, 1
    s_cmp_ge_u32 s27, 262144
    s_cbranch_scc1 adaLN_cond__sliding_block_cached__moe_arch_mod__prompt_kernel_kv4g
    s_cbranch_vccnz adaLN_cond__sliding_block_cached__moe_arch_mod__prompt_kernel_kv4p
adaLN_cond__sliding_block_cached__moe_arch_mod__prompt_kernel_kv4g:
    s_waitcnt vmcnt(0) lgkmcnt(0)
    s_nop 15
    s_nop 3
    s_branch adaLN_cond__sliding_block_cached__moe_arch_mod__prompt_kernel_kv4b
adaLN_cond__sliding_block_cached__moe_arch_mod__prompt_kernel_fixA:
    s_waitcnt vmcnt(0) lgkmcnt(0)
    s_nop 15
    s_nop 3
    s_lshr_b32 s16, s12, 3
    s_lshl_b32 s16, s16, 17
    s_add_u32 s16, s16, 0x400000
    v_add_u32 v8, s16, v2
    v_mov_b32 v16, 0xff7fffff
    v_mov_b32 v17, 0xff7fffff
    s_mov_b32 s16, 0
adaLN_cond__sliding_block_cached__moe_arch_mod__prompt_kernel_fixAm:
    s_add_u32 s17, s16, 0
    buffer_load_dwordx4 v[200:203], v8, s[8:11], s17 offen offset:0
    buffer_load_dwordx4 v[204:207], v8, s[8:11], s17 offen offset:1024
    buffer_load_dwordx4 v[208:211], v8, s[8:11], s17 offen offset:2048
    buffer_load_dwordx4 v[212:215], v8, s[8:11], s17 offen offset:3072
    s_waitcnt vmcnt(3)
    v_mfma_f32_16x16x32_bf16 v[184:187], v[200:203], v[152:155], 0
    v_mfma_f32_16x16x32_bf16 v[188:191], v[200:203], v[168:171], 0
    s_waitcnt vmcnt(2)
    v_mfma_f32_16x16x32_bf16 v[192:195], v[204:207], v[152:155], 0
    v_mfma_f32_16x16x32_bf16 v[196:199], v[204:207], v[168:171], 0
    s_waitcnt vmcnt(1)
    v_mfma_f32_16x16x32_bf16 v[184:187], v[208:211], v[156:159], v[184:187]
    v_mfma_f32_16x16x32_bf16 v[188:191], v[208:211], v[172:175], v[188:191]
    s_waitcnt vmcnt(0)
    v_mfma_f32_16x16x32_bf16 v[192:195], v[212:215], v[156:159], v[192:195]
    v_mfma_f32_16x16x32_bf16 v[196:199], v[212:215], v[172:175], v[196:199]
    s_add_u32 s17, s16, 4096
    buffer_load_dwordx4 v[200:203], v8, s[8:11], s17 offen offset:0
    buffer_load_dwordx4 v[204:207], v8, s[8:11], s17 offen offset:1024
    buffer_load_dwordx4 v[208:211], v8, s[8:11], s17 offen offset:2048
    buffer_load_dwordx4 v[212:215], v8, s[8:11], s17 offen offset:3072
    s_waitcnt vmcnt(3)
    v_mfma_f32_16x16x32_bf16 v[184:187], v[200:203], v[160:163], v[184:187]
    v_mfma_f32_16x16x32_bf16 v[188:191], v[200:203], v[176:179], v[188:191]
    s_waitcnt vmcnt(2)
    v_mfma_f32_16x16x32_bf16 v[192:195], v[204:207], v[160:163], v[192:195]
    v_mfma_f32_16x16x32_bf16 v[196:199], v[204:207], v[176:179], v[196:199]
    s_waitcnt vmcnt(1)
    v_mfma_f32_16x16x32_bf16 v[184:187], v[208:211], v[164:167], v[184:187]
    v_mfma_f32_16x16x32_bf16 v[188:191], v[208:211], v[180:183], v[188:191]
    s_waitcnt vmcnt(0)
    v_mfma_f32_16x16x32_bf16 v[192:195], v[212:215], v[164:167], v[192:195]
    v_mfma_f32_16x16x32_bf16 v[196:199], v[212:215], v[180:183], v[196:199]
    s_nop 3
    v_max3_f32 v16, v16, v184, v185
    v_max3_f32 v16, v16, v186, v187
    v_max3_f32 v17, v17, v188, v189
    v_max3_f32 v17, v17, v190, v191
    v_max3_f32 v16, v16, v192, v193
    v_max3_f32 v16, v16, v194, v195
    v_max3_f32 v17, v17, v196, v197
    v_max3_f32 v17, v17, v198, v199
    s_add_u32 s16, s16, 8192
    s_cmp_lt_u32 s16, 0x20000
    s_cbranch_scc1 adaLN_cond__sliding_block_cached__moe_arch_mod__prompt_kernel_fixAm
    v_mov_b32 v18, v16
    v_mov_b32 v19, v17
    s_nop 0
    v_permlane16_swap_b32 v16, v18
    v_permlane16_swap_b32 v17, v19
    v_max_f32 v16, v16, v18
    v_max_f32 v17, v17, v19
    v_mov_b32 v18, v16
    v_mov_b32 v19, v17
    s_nop 0
    v_permlane32_swap_b32 v16, v18
    v_permlane32_swap_b32 v17, v19
    v_max_f32 v16, v16, v18
    v_max_f32 v17, v17, v19
    v_sub_f32 v216, 0, v16
    v_sub_f32 v217, 0, v16
    v_sub_f32 v218, 0, v16
    v_sub_f32 v219, 0, v16
    v_sub_f32 v220, 0, v17
    v_sub_f32 v221, 0, v17
    v_sub_f32 v222, 0, v17
    v_sub_f32 v223, 0, v17
    s_mov_b32 s17, 0x0
    buffer_load_dwordx4 v[200:203], v8, s[8:11], s17 offen offset:0
    buffer_load_dwordx4 v[204:207], v8, s[8:11], s17 offen offset:1024
    buffer_load_dwordx4 v[208:211], v8, s[8:11], s17 offen offset:2048
    buffer_load_dwordx4 v[212:215], v8, s[8:11], s17 offen offset:3072
    s_waitcnt vmcnt(3)
    v_mfma_f32_16x16x32_bf16 v[184:187], v[200:203], v[152:155], v[216:219]
    v_mfma_f32_16x16x32_bf16 v[188:191], v[200:203], v[168:171], v[220:223]
    s_waitcnt vmcnt(2)
    v_mfma_f32_16x16x32_bf16 v[192:195], v[204:207], v[152:155], v[216:219]
    v_mfma_f32_16x16x32_bf16 v[196:199], v[204:207], v[168:171], v[220:223]
    s_waitcnt vmcnt(1)
    v_mfma_f32_16x16x32_bf16 v[184:187], v[208:211], v[156:159], v[184:187]
    v_mfma_f32_16x16x32_bf16 v[188:191], v[208:211], v[172:175], v[188:191]
    s_waitcnt vmcnt(0)
    v_mfma_f32_16x16x32_bf16 v[192:195], v[212:215], v[156:159], v[192:195]
    v_mfma_f32_16x16x32_bf16 v[196:199], v[212:215], v[172:175], v[196:199]
    s_mov_b32 s17, 0x1000
    buffer_load_dwordx4 v[200:203], v8, s[8:11], s17 offen offset:0
    buffer_load_dwordx4 v[204:207], v8, s[8:11], s17 offen offset:1024
    buffer_load_dwordx4 v[208:211], v8, s[8:11], s17 offen offset:2048
    buffer_load_dwordx4 v[212:215], v8, s[8:11], s17 offen offset:3072
    s_waitcnt vmcnt(3)
    v_mfma_f32_16x16x32_bf16 v[184:187], v[200:203], v[160:163], v[184:187]
    v_mfma_f32_16x16x32_bf16 v[188:191], v[200:203], v[176:179], v[188:191]
    s_waitcnt vmcnt(2)
    v_mfma_f32_16x16x32_bf16 v[192:195], v[204:207], v[160:163], v[192:195]
    v_mfma_f32_16x16x32_bf16 v[196:199], v[204:207], v[176:179], v[196:199]
    s_waitcnt vmcnt(1)
    v_mfma_f32_16x16x32_bf16 v[184:187], v[208:211], v[164:167], v[184:187]
    v_mfma_f32_16x16x32_bf16 v[188:191], v[208:211], v[180:183], v[188:191]
    s_waitcnt vmcnt(0)
    v_mfma_f32_16x16x32_bf16 v[192:195], v[212:215], v[164:167], v[192:195]
    v_mfma_f32_16x16x32_bf16 v[196:199], v[212:215], v[180:183], v[196:199]
    s_nop 3
    v_exp_f32 v184, v184
    v_exp_f32 v185, v185
    s_nop 0
    v_add_f32 v9, v184, v185
    v_cvt_pk_bf16_f32 v24, v184, v185
    v_exp_f32 v186, v186
    v_exp_f32 v187, v187
    v_add_f32 v9, v9, v186
    v_add_f32 v9, v9, v187
    v_cvt_pk_bf16_f32 v25, v186, v187
    v_exp_f32 v188, v188
    v_exp_f32 v189, v189
    s_nop 0
    v_add_f32 v10, v188, v189
    v_cvt_pk_bf16_f32 v28, v188, v189
    v_exp_f32 v190, v190
    v_exp_f32 v191, v191
    v_add_f32 v10, v10, v190
    v_add_f32 v10, v10, v191
    v_cvt_pk_bf16_f32 v29, v190, v191
    v_exp_f32 v192, v192
    v_exp_f32 v193, v193
    v_add_f32 v9, v9, v192
    v_add_f32 v9, v9, v193
    v_cvt_pk_bf16_f32 v26, v192, v193
    v_exp_f32 v194, v194
    v_exp_f32 v195, v195
    v_add_f32 v9, v9, v194
    v_add_f32 v9, v9, v195
    v_cvt_pk_bf16_f32 v27, v194, v195
    v_exp_f32 v196, v196
    v_exp_f32 v197, v197
    v_add_f32 v10, v10, v196
    v_add_f32 v10, v10, v197
    v_cvt_pk_bf16_f32 v30, v196, v197
    v_exp_f32 v198, v198
    v_exp_f32 v199, v199
    v_add_f32 v10, v10, v198
    v_add_f32 v10, v10, v199
    v_cvt_pk_bf16_f32 v31, v198, v199
    s_mov_b32 s17, 0x2000
    buffer_load_dwordx4 v[200:203], v8, s[8:11], s17 offen offset:0
    buffer_load_dwordx4 v[204:207], v8, s[8:11], s17 offen offset:1024
    buffer_load_dwordx4 v[208:211], v8, s[8:11], s17 offen offset:2048
    buffer_load_dwordx4 v[212:215], v8, s[8:11], s17 offen offset:3072
    s_waitcnt vmcnt(3)
    v_mfma_f32_16x16x32_bf16 v[184:187], v[200:203], v[152:155], v[216:219]
    v_mfma_f32_16x16x32_bf16 v[188:191], v[200:203], v[168:171], v[220:223]
    s_waitcnt vmcnt(2)
    v_mfma_f32_16x16x32_bf16 v[192:195], v[204:207], v[152:155], v[216:219]
    v_mfma_f32_16x16x32_bf16 v[196:199], v[204:207], v[168:171], v[220:223]
    s_waitcnt vmcnt(1)
    v_mfma_f32_16x16x32_bf16 v[184:187], v[208:211], v[156:159], v[184:187]
    v_mfma_f32_16x16x32_bf16 v[188:191], v[208:211], v[172:175], v[188:191]
    s_waitcnt vmcnt(0)
    v_mfma_f32_16x16x32_bf16 v[192:195], v[212:215], v[156:159], v[192:195]
    v_mfma_f32_16x16x32_bf16 v[196:199], v[212:215], v[172:175], v[196:199]
    s_mov_b32 s17, 0x3000
    buffer_load_dwordx4 v[200:203], v8, s[8:11], s17 offen offset:0
    buffer_load_dwordx4 v[204:207], v8, s[8:11], s17 offen offset:1024
    buffer_load_dwordx4 v[208:211], v8, s[8:11], s17 offen offset:2048
    buffer_load_dwordx4 v[212:215], v8, s[8:11], s17 offen offset:3072
    s_waitcnt vmcnt(3)
    v_mfma_f32_16x16x32_bf16 v[184:187], v[200:203], v[160:163], v[184:187]
    v_mfma_f32_16x16x32_bf16 v[188:191], v[200:203], v[176:179], v[188:191]
    s_waitcnt vmcnt(2)
    v_mfma_f32_16x16x32_bf16 v[192:195], v[204:207], v[160:163], v[192:195]
    v_mfma_f32_16x16x32_bf16 v[196:199], v[204:207], v[176:179], v[196:199]
    s_waitcnt vmcnt(1)
    v_mfma_f32_16x16x32_bf16 v[184:187], v[208:211], v[164:167], v[184:187]
    v_mfma_f32_16x16x32_bf16 v[188:191], v[208:211], v[180:183], v[188:191]
    s_waitcnt vmcnt(0)
    v_mfma_f32_16x16x32_bf16 v[192:195], v[212:215], v[164:167], v[192:195]
    v_mfma_f32_16x16x32_bf16 v[196:199], v[212:215], v[180:183], v[196:199]
    s_nop 3
    v_exp_f32 v184, v184
    v_exp_f32 v185, v185
    v_add_f32 v9, v9, v184
    v_add_f32 v9, v9, v185
    v_cvt_pk_bf16_f32 v32, v184, v185
    v_exp_f32 v186, v186
    v_exp_f32 v187, v187
    v_add_f32 v9, v9, v186
    v_add_f32 v9, v9, v187
    v_cvt_pk_bf16_f32 v33, v186, v187
    v_exp_f32 v188, v188
    v_exp_f32 v189, v189
    v_add_f32 v10, v10, v188
    v_add_f32 v10, v10, v189
    v_cvt_pk_bf16_f32 v36, v188, v189
    v_exp_f32 v190, v190
    v_exp_f32 v191, v191
    v_add_f32 v10, v10, v190
    v_add_f32 v10, v10, v191
    v_cvt_pk_bf16_f32 v37, v190, v191
    v_exp_f32 v192, v192
    v_exp_f32 v193, v193
    v_add_f32 v9, v9, v192
    v_add_f32 v9, v9, v193
    v_cvt_pk_bf16_f32 v34, v192, v193
    v_exp_f32 v194, v194
    v_exp_f32 v195, v195
    v_add_f32 v9, v9, v194
    v_add_f32 v9, v9, v195
    v_cvt_pk_bf16_f32 v35, v194, v195
    v_exp_f32 v196, v196
    v_exp_f32 v197, v197
    v_add_f32 v10, v10, v196
    v_add_f32 v10, v10, v197
    v_cvt_pk_bf16_f32 v38, v196, v197
    v_exp_f32 v198, v198
    v_exp_f32 v199, v199
    v_add_f32 v10, v10, v198
    v_add_f32 v10, v10, v199
    v_cvt_pk_bf16_f32 v39, v198, v199
    s_mov_b32 s17, 0x4000
    buffer_load_dwordx4 v[200:203], v8, s[8:11], s17 offen offset:0
    buffer_load_dwordx4 v[204:207], v8, s[8:11], s17 offen offset:1024
    buffer_load_dwordx4 v[208:211], v8, s[8:11], s17 offen offset:2048
    buffer_load_dwordx4 v[212:215], v8, s[8:11], s17 offen offset:3072
    s_waitcnt vmcnt(3)
    v_mfma_f32_16x16x32_bf16 v[184:187], v[200:203], v[152:155], v[216:219]
    v_mfma_f32_16x16x32_bf16 v[188:191], v[200:203], v[168:171], v[220:223]
    s_waitcnt vmcnt(2)
    v_mfma_f32_16x16x32_bf16 v[192:195], v[204:207], v[152:155], v[216:219]
    v_mfma_f32_16x16x32_bf16 v[196:199], v[204:207], v[168:171], v[220:223]
    s_waitcnt vmcnt(1)
    v_mfma_f32_16x16x32_bf16 v[184:187], v[208:211], v[156:159], v[184:187]
    v_mfma_f32_16x16x32_bf16 v[188:191], v[208:211], v[172:175], v[188:191]
    s_waitcnt vmcnt(0)
    v_mfma_f32_16x16x32_bf16 v[192:195], v[212:215], v[156:159], v[192:195]
    v_mfma_f32_16x16x32_bf16 v[196:199], v[212:215], v[172:175], v[196:199]
    s_mov_b32 s17, 0x5000
    buffer_load_dwordx4 v[200:203], v8, s[8:11], s17 offen offset:0
    buffer_load_dwordx4 v[204:207], v8, s[8:11], s17 offen offset:1024
    buffer_load_dwordx4 v[208:211], v8, s[8:11], s17 offen offset:2048
    buffer_load_dwordx4 v[212:215], v8, s[8:11], s17 offen offset:3072
    s_waitcnt vmcnt(3)
    v_mfma_f32_16x16x32_bf16 v[184:187], v[200:203], v[160:163], v[184:187]
    v_mfma_f32_16x16x32_bf16 v[188:191], v[200:203], v[176:179], v[188:191]
    s_waitcnt vmcnt(2)
    v_mfma_f32_16x16x32_bf16 v[192:195], v[204:207], v[160:163], v[192:195]
    v_mfma_f32_16x16x32_bf16 v[196:199], v[204:207], v[176:179], v[196:199]
    s_waitcnt vmcnt(1)
    v_mfma_f32_16x16x32_bf16 v[184:187], v[208:211], v[164:167], v[184:187]
    v_mfma_f32_16x16x32_bf16 v[188:191], v[208:211], v[180:183], v[188:191]
    s_waitcnt vmcnt(0)
    v_mfma_f32_16x16x32_bf16 v[192:195], v[212:215], v[164:167], v[192:195]
    v_mfma_f32_16x16x32_bf16 v[196:199], v[212:215], v[180:183], v[196:199]
    s_nop 3
    v_exp_f32 v184, v184
    v_exp_f32 v185, v185
    v_add_f32 v9, v9, v184
    v_add_f32 v9, v9, v185
    v_cvt_pk_bf16_f32 v40, v184, v185
    v_exp_f32 v186, v186
    v_exp_f32 v187, v187
    v_add_f32 v9, v9, v186
    v_add_f32 v9, v9, v187
    v_cvt_pk_bf16_f32 v41, v186, v187
    v_exp_f32 v188, v188
    v_exp_f32 v189, v189
    v_add_f32 v10, v10, v188
    v_add_f32 v10, v10, v189
    v_cvt_pk_bf16_f32 v44, v188, v189
    v_exp_f32 v190, v190
    v_exp_f32 v191, v191
    v_add_f32 v10, v10, v190
    v_add_f32 v10, v10, v191
    v_cvt_pk_bf16_f32 v45, v190, v191
    v_exp_f32 v192, v192
    v_exp_f32 v193, v193
    v_add_f32 v9, v9, v192
    v_add_f32 v9, v9, v193
    v_cvt_pk_bf16_f32 v42, v192, v193
    v_exp_f32 v194, v194
    v_exp_f32 v195, v195
    v_add_f32 v9, v9, v194
    v_add_f32 v9, v9, v195
    v_cvt_pk_bf16_f32 v43, v194, v195
    v_exp_f32 v196, v196
    v_exp_f32 v197, v197
    v_add_f32 v10, v10, v196
    v_add_f32 v10, v10, v197
    v_cvt_pk_bf16_f32 v46, v196, v197
    v_exp_f32 v198, v198
    v_exp_f32 v199, v199
    v_add_f32 v10, v10, v198
    v_add_f32 v10, v10, v199
    v_cvt_pk_bf16_f32 v47, v198, v199
    s_mov_b32 s17, 0x6000
    buffer_load_dwordx4 v[200:203], v8, s[8:11], s17 offen offset:0
    buffer_load_dwordx4 v[204:207], v8, s[8:11], s17 offen offset:1024
    buffer_load_dwordx4 v[208:211], v8, s[8:11], s17 offen offset:2048
    buffer_load_dwordx4 v[212:215], v8, s[8:11], s17 offen offset:3072
    s_waitcnt vmcnt(3)
    v_mfma_f32_16x16x32_bf16 v[184:187], v[200:203], v[152:155], v[216:219]
    v_mfma_f32_16x16x32_bf16 v[188:191], v[200:203], v[168:171], v[220:223]
    s_waitcnt vmcnt(2)
    v_mfma_f32_16x16x32_bf16 v[192:195], v[204:207], v[152:155], v[216:219]
    v_mfma_f32_16x16x32_bf16 v[196:199], v[204:207], v[168:171], v[220:223]
    s_waitcnt vmcnt(1)
    v_mfma_f32_16x16x32_bf16 v[184:187], v[208:211], v[156:159], v[184:187]
    v_mfma_f32_16x16x32_bf16 v[188:191], v[208:211], v[172:175], v[188:191]
    s_waitcnt vmcnt(0)
    v_mfma_f32_16x16x32_bf16 v[192:195], v[212:215], v[156:159], v[192:195]
    v_mfma_f32_16x16x32_bf16 v[196:199], v[212:215], v[172:175], v[196:199]
    s_mov_b32 s17, 0x7000
    buffer_load_dwordx4 v[200:203], v8, s[8:11], s17 offen offset:0
    buffer_load_dwordx4 v[204:207], v8, s[8:11], s17 offen offset:1024
    buffer_load_dwordx4 v[208:211], v8, s[8:11], s17 offen offset:2048
    buffer_load_dwordx4 v[212:215], v8, s[8:11], s17 offen offset:3072
    s_waitcnt vmcnt(3)
    v_mfma_f32_16x16x32_bf16 v[184:187], v[200:203], v[160:163], v[184:187]
    v_mfma_f32_16x16x32_bf16 v[188:191], v[200:203], v[176:179], v[188:191]
    s_waitcnt vmcnt(2)
    v_mfma_f32_16x16x32_bf16 v[192:195], v[204:207], v[160:163], v[192:195]
    v_mfma_f32_16x16x32_bf16 v[196:199], v[204:207], v[176:179], v[196:199]
    s_waitcnt vmcnt(1)
    v_mfma_f32_16x16x32_bf16 v[184:187], v[208:211], v[164:167], v[184:187]
    v_mfma_f32_16x16x32_bf16 v[188:191], v[208:211], v[180:183], v[188:191]
    s_waitcnt vmcnt(0)
    v_mfma_f32_16x16x32_bf16 v[192:195], v[212:215], v[164:167], v[192:195]
    v_mfma_f32_16x16x32_bf16 v[196:199], v[212:215], v[180:183], v[196:199]
    s_nop 3
    v_exp_f32 v184, v184
    v_exp_f32 v185, v185
    v_add_f32 v9, v9, v184
    v_add_f32 v9, v9, v185
    v_cvt_pk_bf16_f32 v48, v184, v185
    v_exp_f32 v186, v186
    v_exp_f32 v187, v187
    v_add_f32 v9, v9, v186
    v_add_f32 v9, v9, v187
    v_cvt_pk_bf16_f32 v49, v186, v187
    v_exp_f32 v188, v188
    v_exp_f32 v189, v189
    v_add_f32 v10, v10, v188
    v_add_f32 v10, v10, v189
    v_cvt_pk_bf16_f32 v52, v188, v189
    v_exp_f32 v190, v190
    v_exp_f32 v191, v191
    v_add_f32 v10, v10, v190
    v_add_f32 v10, v10, v191
    v_cvt_pk_bf16_f32 v53, v190, v191
    v_exp_f32 v192, v192
    v_exp_f32 v193, v193
    v_add_f32 v9, v9, v192
    v_add_f32 v9, v9, v193
    v_cvt_pk_bf16_f32 v50, v192, v193
    v_exp_f32 v194, v194
    v_exp_f32 v195, v195
    v_add_f32 v9, v9, v194
    v_add_f32 v9, v9, v195
    v_cvt_pk_bf16_f32 v51, v194, v195
    v_exp_f32 v196, v196
    v_exp_f32 v197, v197
    v_add_f32 v10, v10, v196
    v_add_f32 v10, v10, v197
    v_cvt_pk_bf16_f32 v54, v196, v197
    v_exp_f32 v198, v198
    v_exp_f32 v199, v199
    v_add_f32 v10, v10, v198
    v_add_f32 v10, v10, v199
    v_cvt_pk_bf16_f32 v55, v198, v199
    s_mov_b32 s17, 0x8000
    buffer_load_dwordx4 v[200:203], v8, s[8:11], s17 offen offset:0
    buffer_load_dwordx4 v[204:207], v8, s[8:11], s17 offen offset:1024
    buffer_load_dwordx4 v[208:211], v8, s[8:11], s17 offen offset:2048
    buffer_load_dwordx4 v[212:215], v8, s[8:11], s17 offen offset:3072
    s_waitcnt vmcnt(3)
    v_mfma_f32_16x16x32_bf16 v[184:187], v[200:203], v[152:155], v[216:219]
    v_mfma_f32_16x16x32_bf16 v[188:191], v[200:203], v[168:171], v[220:223]
    s_waitcnt vmcnt(2)
    v_mfma_f32_16x16x32_bf16 v[192:195], v[204:207], v[152:155], v[216:219]
    v_mfma_f32_16x16x32_bf16 v[196:199], v[204:207], v[168:171], v[220:223]
    s_waitcnt vmcnt(1)
    v_mfma_f32_16x16x32_bf16 v[184:187], v[208:211], v[156:159], v[184:187]
    v_mfma_f32_16x16x32_bf16 v[188:191], v[208:211], v[172:175], v[188:191]
    s_waitcnt vmcnt(0)
    v_mfma_f32_16x16x32_bf16 v[192:195], v[212:215], v[156:159], v[192:195]
    v_mfma_f32_16x16x32_bf16 v[196:199], v[212:215], v[172:175], v[196:199]
    s_mov_b32 s17, 0x9000
    buffer_load_dwordx4 v[200:203], v8, s[8:11], s17 offen offset:0
    buffer_load_dwordx4 v[204:207], v8, s[8:11], s17 offen offset:1024
    buffer_load_dwordx4 v[208:211], v8, s[8:11], s17 offen offset:2048
    buffer_load_dwordx4 v[212:215], v8, s[8:11], s17 offen offset:3072
    s_waitcnt vmcnt(3)
    v_mfma_f32_16x16x32_bf16 v[184:187], v[200:203], v[160:163], v[184:187]
    v_mfma_f32_16x16x32_bf16 v[188:191], v[200:203], v[176:179], v[188:191]
    s_waitcnt vmcnt(2)
    v_mfma_f32_16x16x32_bf16 v[192:195], v[204:207], v[160:163], v[192:195]
    v_mfma_f32_16x16x32_bf16 v[196:199], v[204:207], v[176:179], v[196:199]
    s_waitcnt vmcnt(1)
    v_mfma_f32_16x16x32_bf16 v[184:187], v[208:211], v[164:167], v[184:187]
    v_mfma_f32_16x16x32_bf16 v[188:191], v[208:211], v[180:183], v[188:191]
    s_waitcnt vmcnt(0)
    v_mfma_f32_16x16x32_bf16 v[192:195], v[212:215], v[164:167], v[192:195]
    v_mfma_f32_16x16x32_bf16 v[196:199], v[212:215], v[180:183], v[196:199]
    s_nop 3
    v_exp_f32 v184, v184
    v_exp_f32 v185, v185
    v_add_f32 v9, v9, v184
    v_add_f32 v9, v9, v185
    v_cvt_pk_bf16_f32 v56, v184, v185
    v_exp_f32 v186, v186
    v_exp_f32 v187, v187
    v_add_f32 v9, v9, v186
    v_add_f32 v9, v9, v187
    v_cvt_pk_bf16_f32 v57, v186, v187
    v_exp_f32 v188, v188
    v_exp_f32 v189, v189
    v_add_f32 v10, v10, v188
    v_add_f32 v10, v10, v189
    v_cvt_pk_bf16_f32 v60, v188, v189
    v_exp_f32 v190, v190
    v_exp_f32 v191, v191
    v_add_f32 v10, v10, v190
    v_add_f32 v10, v10, v191
    v_cvt_pk_bf16_f32 v61, v190, v191
    v_exp_f32 v192, v192
    v_exp_f32 v193, v193
    v_add_f32 v9, v9, v192
    v_add_f32 v9, v9, v193
    v_cvt_pk_bf16_f32 v58, v192, v193
    v_exp_f32 v194, v194
    v_exp_f32 v195, v195
    v_add_f32 v9, v9, v194
    v_add_f32 v9, v9, v195
    v_cvt_pk_bf16_f32 v59, v194, v195
    v_exp_f32 v196, v196
    v_exp_f32 v197, v197
    v_add_f32 v10, v10, v196
    v_add_f32 v10, v10, v197
    v_cvt_pk_bf16_f32 v62, v196, v197
    v_exp_f32 v198, v198
    v_exp_f32 v199, v199
    v_add_f32 v10, v10, v198
    v_add_f32 v10, v10, v199
    v_cvt_pk_bf16_f32 v63, v198, v199
    s_mov_b32 s17, 0xa000
    buffer_load_dwordx4 v[200:203], v8, s[8:11], s17 offen offset:0
    buffer_load_dwordx4 v[204:207], v8, s[8:11], s17 offen offset:1024
    buffer_load_dwordx4 v[208:211], v8, s[8:11], s17 offen offset:2048
    buffer_load_dwordx4 v[212:215], v8, s[8:11], s17 offen offset:3072
    s_waitcnt vmcnt(3)
    v_mfma_f32_16x16x32_bf16 v[184:187], v[200:203], v[152:155], v[216:219]
    v_mfma_f32_16x16x32_bf16 v[188:191], v[200:203], v[168:171], v[220:223]
    s_waitcnt vmcnt(2)
    v_mfma_f32_16x16x32_bf16 v[192:195], v[204:207], v[152:155], v[216:219]
    v_mfma_f32_16x16x32_bf16 v[196:199], v[204:207], v[168:171], v[220:223]
    s_waitcnt vmcnt(1)
    v_mfma_f32_16x16x32_bf16 v[184:187], v[208:211], v[156:159], v[184:187]
    v_mfma_f32_16x16x32_bf16 v[188:191], v[208:211], v[172:175], v[188:191]
    s_waitcnt vmcnt(0)
    v_mfma_f32_16x16x32_bf16 v[192:195], v[212:215], v[156:159], v[192:195]
    v_mfma_f32_16x16x32_bf16 v[196:199], v[212:215], v[172:175], v[196:199]
    s_mov_b32 s17, 0xb000
    buffer_load_dwordx4 v[200:203], v8, s[8:11], s17 offen offset:0
    buffer_load_dwordx4 v[204:207], v8, s[8:11], s17 offen offset:1024
    buffer_load_dwordx4 v[208:211], v8, s[8:11], s17 offen offset:2048
    buffer_load_dwordx4 v[212:215], v8, s[8:11], s17 offen offset:3072
    s_waitcnt vmcnt(3)
    v_mfma_f32_16x16x32_bf16 v[184:187], v[200:203], v[160:163], v[184:187]
    v_mfma_f32_16x16x32_bf16 v[188:191], v[200:203], v[176:179], v[188:191]
    s_waitcnt vmcnt(2)
    v_mfma_f32_16x16x32_bf16 v[192:195], v[204:207], v[160:163], v[192:195]
    v_mfma_f32_16x16x32_bf16 v[196:199], v[204:207], v[176:179], v[196:199]
    s_waitcnt vmcnt(1)
    v_mfma_f32_16x16x32_bf16 v[184:187], v[208:211], v[164:167], v[184:187]
    v_mfma_f32_16x16x32_bf16 v[188:191], v[208:211], v[180:183], v[188:191]
    s_waitcnt vmcnt(0)
    v_mfma_f32_16x16x32_bf16 v[192:195], v[212:215], v[164:167], v[192:195]
    v_mfma_f32_16x16x32_bf16 v[196:199], v[212:215], v[180:183], v[196:199]
    s_nop 3
    v_exp_f32 v184, v184
    v_exp_f32 v185, v185
    v_add_f32 v9, v9, v184
    v_add_f32 v9, v9, v185
    v_cvt_pk_bf16_f32 v64, v184, v185
    v_exp_f32 v186, v186
    v_exp_f32 v187, v187
    v_add_f32 v9, v9, v186
    v_add_f32 v9, v9, v187
    v_cvt_pk_bf16_f32 v65, v186, v187
    v_exp_f32 v188, v188
    v_exp_f32 v189, v189
    v_add_f32 v10, v10, v188
    v_add_f32 v10, v10, v189
    v_cvt_pk_bf16_f32 v68, v188, v189
    v_exp_f32 v190, v190
    v_exp_f32 v191, v191
    v_add_f32 v10, v10, v190
    v_add_f32 v10, v10, v191
    v_cvt_pk_bf16_f32 v69, v190, v191
    v_exp_f32 v192, v192
    v_exp_f32 v193, v193
    v_add_f32 v9, v9, v192
    v_add_f32 v9, v9, v193
    v_cvt_pk_bf16_f32 v66, v192, v193
    v_exp_f32 v194, v194
    v_exp_f32 v195, v195
    v_add_f32 v9, v9, v194
    v_add_f32 v9, v9, v195
    v_cvt_pk_bf16_f32 v67, v194, v195
    v_exp_f32 v196, v196
    v_exp_f32 v197, v197
    v_add_f32 v10, v10, v196
    v_add_f32 v10, v10, v197
    v_cvt_pk_bf16_f32 v70, v196, v197
    v_exp_f32 v198, v198
    v_exp_f32 v199, v199
    v_add_f32 v10, v10, v198
    v_add_f32 v10, v10, v199
    v_cvt_pk_bf16_f32 v71, v198, v199
    s_mov_b32 s17, 0xc000
    buffer_load_dwordx4 v[200:203], v8, s[8:11], s17 offen offset:0
    buffer_load_dwordx4 v[204:207], v8, s[8:11], s17 offen offset:1024
    buffer_load_dwordx4 v[208:211], v8, s[8:11], s17 offen offset:2048
    buffer_load_dwordx4 v[212:215], v8, s[8:11], s17 offen offset:3072
    s_waitcnt vmcnt(3)
    v_mfma_f32_16x16x32_bf16 v[184:187], v[200:203], v[152:155], v[216:219]
    v_mfma_f32_16x16x32_bf16 v[188:191], v[200:203], v[168:171], v[220:223]
    s_waitcnt vmcnt(2)
    v_mfma_f32_16x16x32_bf16 v[192:195], v[204:207], v[152:155], v[216:219]
    v_mfma_f32_16x16x32_bf16 v[196:199], v[204:207], v[168:171], v[220:223]
    s_waitcnt vmcnt(1)
    v_mfma_f32_16x16x32_bf16 v[184:187], v[208:211], v[156:159], v[184:187]
    v_mfma_f32_16x16x32_bf16 v[188:191], v[208:211], v[172:175], v[188:191]
    s_waitcnt vmcnt(0)
    v_mfma_f32_16x16x32_bf16 v[192:195], v[212:215], v[156:159], v[192:195]
    v_mfma_f32_16x16x32_bf16 v[196:199], v[212:215], v[172:175], v[196:199]
    s_mov_b32 s17, 0xd000
    buffer_load_dwordx4 v[200:203], v8, s[8:11], s17 offen offset:0
    buffer_load_dwordx4 v[204:207], v8, s[8:11], s17 offen offset:1024
    buffer_load_dwordx4 v[208:211], v8, s[8:11], s17 offen offset:2048
    buffer_load_dwordx4 v[212:215], v8, s[8:11], s17 offen offset:3072
    s_waitcnt vmcnt(3)
    v_mfma_f32_16x16x32_bf16 v[184:187], v[200:203], v[160:163], v[184:187]
    v_mfma_f32_16x16x32_bf16 v[188:191], v[200:203], v[176:179], v[188:191]
    s_waitcnt vmcnt(2)
    v_mfma_f32_16x16x32_bf16 v[192:195], v[204:207], v[160:163], v[192:195]
    v_mfma_f32_16x16x32_bf16 v[196:199], v[204:207], v[176:179], v[196:199]
    s_waitcnt vmcnt(1)
    v_mfma_f32_16x16x32_bf16 v[184:187], v[208:211], v[164:167], v[184:187]
    v_mfma_f32_16x16x32_bf16 v[188:191], v[208:211], v[180:183], v[188:191]
    s_waitcnt vmcnt(0)
    v_mfma_f32_16x16x32_bf16 v[192:195], v[212:215], v[164:167], v[192:195]
    v_mfma_f32_16x16x32_bf16 v[196:199], v[212:215], v[180:183], v[196:199]
    s_nop 3
    v_exp_f32 v184, v184
    v_exp_f32 v185, v185
    v_add_f32 v9, v9, v184
    v_add_f32 v9, v9, v185
    v_cvt_pk_bf16_f32 v72, v184, v185
    v_exp_f32 v186, v186
    v_exp_f32 v187, v187
    v_add_f32 v9, v9, v186
    v_add_f32 v9, v9, v187
    v_cvt_pk_bf16_f32 v73, v186, v187
    v_exp_f32 v188, v188
    v_exp_f32 v189, v189
    v_add_f32 v10, v10, v188
    v_add_f32 v10, v10, v189
    v_cvt_pk_bf16_f32 v76, v188, v189
    v_exp_f32 v190, v190
    v_exp_f32 v191, v191
    v_add_f32 v10, v10, v190
    v_add_f32 v10, v10, v191
    v_cvt_pk_bf16_f32 v77, v190, v191
    v_exp_f32 v192, v192
    v_exp_f32 v193, v193
    v_add_f32 v9, v9, v192
    v_add_f32 v9, v9, v193
    v_cvt_pk_bf16_f32 v74, v192, v193
    v_exp_f32 v194, v194
    v_exp_f32 v195, v195
    v_add_f32 v9, v9, v194
    v_add_f32 v9, v9, v195
    v_cvt_pk_bf16_f32 v75, v194, v195
    v_exp_f32 v196, v196
    v_exp_f32 v197, v197
    v_add_f32 v10, v10, v196
    v_add_f32 v10, v10, v197
    v_cvt_pk_bf16_f32 v78, v196, v197
    v_exp_f32 v198, v198
    v_exp_f32 v199, v199
    v_add_f32 v10, v10, v198
    v_add_f32 v10, v10, v199
    v_cvt_pk_bf16_f32 v79, v198, v199
    s_mov_b32 s17, 0xe000
    buffer_load_dwordx4 v[200:203], v8, s[8:11], s17 offen offset:0
    buffer_load_dwordx4 v[204:207], v8, s[8:11], s17 offen offset:1024
    buffer_load_dwordx4 v[208:211], v8, s[8:11], s17 offen offset:2048
    buffer_load_dwordx4 v[212:215], v8, s[8:11], s17 offen offset:3072
    s_waitcnt vmcnt(3)
    v_mfma_f32_16x16x32_bf16 v[184:187], v[200:203], v[152:155], v[216:219]
    v_mfma_f32_16x16x32_bf16 v[188:191], v[200:203], v[168:171], v[220:223]
    s_waitcnt vmcnt(2)
    v_mfma_f32_16x16x32_bf16 v[192:195], v[204:207], v[152:155], v[216:219]
    v_mfma_f32_16x16x32_bf16 v[196:199], v[204:207], v[168:171], v[220:223]
    s_waitcnt vmcnt(1)
    v_mfma_f32_16x16x32_bf16 v[184:187], v[208:211], v[156:159], v[184:187]
    v_mfma_f32_16x16x32_bf16 v[188:191], v[208:211], v[172:175], v[188:191]
    s_waitcnt vmcnt(0)
    v_mfma_f32_16x16x32_bf16 v[192:195], v[212:215], v[156:159], v[192:195]
    v_mfma_f32_16x16x32_bf16 v[196:199], v[212:215], v[172:175], v[196:199]
    s_mov_b32 s17, 0xf000
    buffer_load_dwordx4 v[200:203], v8, s[8:11], s17 offen offset:0
    buffer_load_dwordx4 v[204:207], v8, s[8:11], s17 offen offset:1024
    buffer_load_dwordx4 v[208:211], v8, s[8:11], s17 offen offset:2048
    buffer_load_dwordx4 v[212:215], v8, s[8:11], s17 offen offset:3072
    s_waitcnt vmcnt(3)
    v_mfma_f32_16x16x32_bf16 v[184:187], v[200:203], v[160:163], v[184:187]
    v_mfma_f32_16x16x32_bf16 v[188:191], v[200:203], v[176:179], v[188:191]
    s_waitcnt vmcnt(2)
    v_mfma_f32_16x16x32_bf16 v[192:195], v[204:207], v[160:163], v[192:195]
    v_mfma_f32_16x16x32_bf16 v[196:199], v[204:207], v[176:179], v[196:199]
    s_waitcnt vmcnt(1)
    v_mfma_f32_16x16x32_bf16 v[184:187], v[208:211], v[164:167], v[184:187]
    v_mfma_f32_16x16x32_bf16 v[188:191], v[208:211], v[180:183], v[188:191]
    s_waitcnt vmcnt(0)
    v_mfma_f32_16x16x32_bf16 v[192:195], v[212:215], v[164:167], v[192:195]
    v_mfma_f32_16x16x32_bf16 v[196:199], v[212:215], v[180:183], v[196:199]
    s_nop 3
    v_exp_f32 v184, v184
    v_exp_f32 v185, v185
    v_add_f32 v9, v9, v184
    v_add_f32 v9, v9, v185
    v_cvt_pk_bf16_f32 v80, v184, v185
    v_exp_f32 v186, v186
    v_exp_f32 v187, v187
    v_add_f32 v9, v9, v186
    v_add_f32 v9, v9, v187
    v_cvt_pk_bf16_f32 v81, v186, v187
    v_exp_f32 v188, v188
    v_exp_f32 v189, v189
    v_add_f32 v10, v10, v188
    v_add_f32 v10, v10, v189
    v_cvt_pk_bf16_f32 v84, v188, v189
    v_exp_f32 v190, v190
    v_exp_f32 v191, v191
    v_add_f32 v10, v10, v190
    v_add_f32 v10, v10, v191
    v_cvt_pk_bf16_f32 v85, v190, v191
    v_exp_f32 v192, v192
    v_exp_f32 v193, v193
    v_add_f32 v9, v9, v192
    v_add_f32 v9, v9, v193
    v_cvt_pk_bf16_f32 v82, v192, v193
    v_exp_f32 v194, v194
    v_exp_f32 v195, v195
    v_add_f32 v9, v9, v194
    v_add_f32 v9, v9, v195
    v_cvt_pk_bf16_f32 v83, v194, v195
    v_exp_f32 v196, v196
    v_exp_f32 v197, v197
    v_add_f32 v10, v10, v196
    v_add_f32 v10, v10, v197
    v_cvt_pk_bf16_f32 v86, v196, v197
    v_exp_f32 v198, v198
    v_exp_f32 v199, v199
    v_add_f32 v10, v10, v198
    v_add_f32 v10, v10, v199
    v_cvt_pk_bf16_f32 v87, v198, v199
    s_mov_b32 s17, 0x10000
    buffer_load_dwordx4 v[200:203], v8, s[8:11], s17 offen offset:0
    buffer_load_dwordx4 v[204:207], v8, s[8:11], s17 offen offset:1024
    buffer_load_dwordx4 v[208:211], v8, s[8:11], s17 offen offset:2048
    buffer_load_dwordx4 v[212:215], v8, s[8:11], s17 offen offset:3072
    s_waitcnt vmcnt(3)
    v_mfma_f32_16x16x32_bf16 v[184:187], v[200:203], v[152:155], v[216:219]
    v_mfma_f32_16x16x32_bf16 v[188:191], v[200:203], v[168:171], v[220:223]
    s_waitcnt vmcnt(2)
    v_mfma_f32_16x16x32_bf16 v[192:195], v[204:207], v[152:155], v[216:219]
    v_mfma_f32_16x16x32_bf16 v[196:199], v[204:207], v[168:171], v[220:223]
    s_waitcnt vmcnt(1)
    v_mfma_f32_16x16x32_bf16 v[184:187], v[208:211], v[156:159], v[184:187]
    v_mfma_f32_16x16x32_bf16 v[188:191], v[208:211], v[172:175], v[188:191]
    s_waitcnt vmcnt(0)
    v_mfma_f32_16x16x32_bf16 v[192:195], v[212:215], v[156:159], v[192:195]
    v_mfma_f32_16x16x32_bf16 v[196:199], v[212:215], v[172:175], v[196:199]
    s_mov_b32 s17, 0x11000
    buffer_load_dwordx4 v[200:203], v8, s[8:11], s17 offen offset:0
    buffer_load_dwordx4 v[204:207], v8, s[8:11], s17 offen offset:1024
    buffer_load_dwordx4 v[208:211], v8, s[8:11], s17 offen offset:2048
    buffer_load_dwordx4 v[212:215], v8, s[8:11], s17 offen offset:3072
    s_waitcnt vmcnt(3)
    v_mfma_f32_16x16x32_bf16 v[184:187], v[200:203], v[160:163], v[184:187]
    v_mfma_f32_16x16x32_bf16 v[188:191], v[200:203], v[176:179], v[188:191]
    s_waitcnt vmcnt(2)
    v_mfma_f32_16x16x32_bf16 v[192:195], v[204:207], v[160:163], v[192:195]
    v_mfma_f32_16x16x32_bf16 v[196:199], v[204:207], v[176:179], v[196:199]
    s_waitcnt vmcnt(1)
    v_mfma_f32_16x16x32_bf16 v[184:187], v[208:211], v[164:167], v[184:187]
    v_mfma_f32_16x16x32_bf16 v[188:191], v[208:211], v[180:183], v[188:191]
    s_waitcnt vmcnt(0)
    v_mfma_f32_16x16x32_bf16 v[192:195], v[212:215], v[164:167], v[192:195]
    v_mfma_f32_16x16x32_bf16 v[196:199], v[212:215], v[180:183], v[196:199]
    s_nop 3
    v_exp_f32 v184, v184
    v_exp_f32 v185, v185
    v_add_f32 v9, v9, v184
    v_add_f32 v9, v9, v185
    v_cvt_pk_bf16_f32 v88, v184, v185
    v_exp_f32 v186, v186
    v_exp_f32 v187, v187
    v_add_f32 v9, v9, v186
    v_add_f32 v9, v9, v187
    v_cvt_pk_bf16_f32 v89, v186, v187
    v_exp_f32 v188, v188
    v_exp_f32 v189, v189
    v_add_f32 v10, v10, v188
    v_add_f32 v10, v10, v189
    v_cvt_pk_bf16_f32 v92, v188, v189
    v_exp_f32 v190, v190
    v_exp_f32 v191, v191
    v_add_f32 v10, v10, v190
    v_add_f32 v10, v10, v191
    v_cvt_pk_bf16_f32 v93, v190, v191
    v_exp_f32 v192, v192
    v_exp_f32 v193, v193
    v_add_f32 v9, v9, v192
    v_add_f32 v9, v9, v193
    v_cvt_pk_bf16_f32 v90, v192, v193
    v_exp_f32 v194, v194
    v_exp_f32 v195, v195
    v_add_f32 v9, v9, v194
    v_add_f32 v9, v9, v195
    v_cvt_pk_bf16_f32 v91, v194, v195
    v_exp_f32 v196, v196
    v_exp_f32 v197, v197
    v_add_f32 v10, v10, v196
    v_add_f32 v10, v10, v197
    v_cvt_pk_bf16_f32 v94, v196, v197
    v_exp_f32 v198, v198
    v_exp_f32 v199, v199
    v_add_f32 v10, v10, v198
    v_add_f32 v10, v10, v199
    v_cvt_pk_bf16_f32 v95, v198, v199
    s_mov_b32 s17, 0x12000
    buffer_load_dwordx4 v[200:203], v8, s[8:11], s17 offen offset:0
    buffer_load_dwordx4 v[204:207], v8, s[8:11], s17 offen offset:1024
    buffer_load_dwordx4 v[208:211], v8, s[8:11], s17 offen offset:2048
    buffer_load_dwordx4 v[212:215], v8, s[8:11], s17 offen offset:3072
    s_waitcnt vmcnt(3)
    v_mfma_f32_16x16x32_bf16 v[184:187], v[200:203], v[152:155], v[216:219]
    v_mfma_f32_16x16x32_bf16 v[188:191], v[200:203], v[168:171], v[220:223]
    s_waitcnt vmcnt(2)
    v_mfma_f32_16x16x32_bf16 v[192:195], v[204:207], v[152:155], v[216:219]
    v_mfma_f32_16x16x32_bf16 v[196:199], v[204:207], v[168:171], v[220:223]
    s_waitcnt vmcnt(1)
    v_mfma_f32_16x16x32_bf16 v[184:187], v[208:211], v[156:159], v[184:187]
    v_mfma_f32_16x16x32_bf16 v[188:191], v[208:211], v[172:175], v[188:191]
    s_waitcnt vmcnt(0)
    v_mfma_f32_16x16x32_bf16 v[192:195], v[212:215], v[156:159], v[192:195]
    v_mfma_f32_16x16x32_bf16 v[196:199], v[212:215], v[172:175], v[196:199]
    s_mov_b32 s17, 0x13000
    buffer_load_dwordx4 v[200:203], v8, s[8:11], s17 offen offset:0
    buffer_load_dwordx4 v[204:207], v8, s[8:11], s17 offen offset:1024
    buffer_load_dwordx4 v[208:211], v8, s[8:11], s17 offen offset:2048
    buffer_load_dwordx4 v[212:215], v8, s[8:11], s17 offen offset:3072
    s_waitcnt vmcnt(3)
    v_mfma_f32_16x16x32_bf16 v[184:187], v[200:203], v[160:163], v[184:187]
    v_mfma_f32_16x16x32_bf16 v[188:191], v[200:203], v[176:179], v[188:191]
    s_waitcnt vmcnt(2)
    v_mfma_f32_16x16x32_bf16 v[192:195], v[204:207], v[160:163], v[192:195]
    v_mfma_f32_16x16x32_bf16 v[196:199], v[204:207], v[176:179], v[196:199]
    s_waitcnt vmcnt(1)
    v_mfma_f32_16x16x32_bf16 v[184:187], v[208:211], v[164:167], v[184:187]
    v_mfma_f32_16x16x32_bf16 v[188:191], v[208:211], v[180:183], v[188:191]
    s_waitcnt vmcnt(0)
    v_mfma_f32_16x16x32_bf16 v[192:195], v[212:215], v[164:167], v[192:195]
    v_mfma_f32_16x16x32_bf16 v[196:199], v[212:215], v[180:183], v[196:199]
    s_nop 3
    v_exp_f32 v184, v184
    v_exp_f32 v185, v185
    v_add_f32 v9, v9, v184
    v_add_f32 v9, v9, v185
    v_cvt_pk_bf16_f32 v96, v184, v185
    v_exp_f32 v186, v186
    v_exp_f32 v187, v187
    v_add_f32 v9, v9, v186
    v_add_f32 v9, v9, v187
    v_cvt_pk_bf16_f32 v97, v186, v187
    v_exp_f32 v188, v188
    v_exp_f32 v189, v189
    v_add_f32 v10, v10, v188
    v_add_f32 v10, v10, v189
    v_cvt_pk_bf16_f32 v100, v188, v189
    v_exp_f32 v190, v190
    v_exp_f32 v191, v191
    v_add_f32 v10, v10, v190
    v_add_f32 v10, v10, v191
    v_cvt_pk_bf16_f32 v101, v190, v191
    v_exp_f32 v192, v192
    v_exp_f32 v193, v193
    v_add_f32 v9, v9, v192
    v_add_f32 v9, v9, v193
    v_cvt_pk_bf16_f32 v98, v192, v193
    v_exp_f32 v194, v194
    v_exp_f32 v195, v195
    v_add_f32 v9, v9, v194
    v_add_f32 v9, v9, v195
    v_cvt_pk_bf16_f32 v99, v194, v195
    v_exp_f32 v196, v196
    v_exp_f32 v197, v197
    v_add_f32 v10, v10, v196
    v_add_f32 v10, v10, v197
    v_cvt_pk_bf16_f32 v102, v196, v197
    v_exp_f32 v198, v198
    v_exp_f32 v199, v199
    v_add_f32 v10, v10, v198
    v_add_f32 v10, v10, v199
    v_cvt_pk_bf16_f32 v103, v198, v199
    s_mov_b32 s17, 0x14000
    buffer_load_dwordx4 v[200:203], v8, s[8:11], s17 offen offset:0
    buffer_load_dwordx4 v[204:207], v8, s[8:11], s17 offen offset:1024
    buffer_load_dwordx4 v[208:211], v8, s[8:11], s17 offen offset:2048
    buffer_load_dwordx4 v[212:215], v8, s[8:11], s17 offen offset:3072
    s_waitcnt vmcnt(3)
    v_mfma_f32_16x16x32_bf16 v[184:187], v[200:203], v[152:155], v[216:219]
    v_mfma_f32_16x16x32_bf16 v[188:191], v[200:203], v[168:171], v[220:223]
    s_waitcnt vmcnt(2)
    v_mfma_f32_16x16x32_bf16 v[192:195], v[204:207], v[152:155], v[216:219]
    v_mfma_f32_16x16x32_bf16 v[196:199], v[204:207], v[168:171], v[220:223]
    s_waitcnt vmcnt(1)
    v_mfma_f32_16x16x32_bf16 v[184:187], v[208:211], v[156:159], v[184:187]
    v_mfma_f32_16x16x32_bf16 v[188:191], v[208:211], v[172:175], v[188:191]
    s_waitcnt vmcnt(0)
    v_mfma_f32_16x16x32_bf16 v[192:195], v[212:215], v[156:159], v[192:195]
    v_mfma_f32_16x16x32_bf16 v[196:199], v[212:215], v[172:175], v[196:199]
    s_mov_b32 s17, 0x15000
    buffer_load_dwordx4 v[200:203], v8, s[8:11], s17 offen offset:0
    buffer_load_dwordx4 v[204:207], v8, s[8:11], s17 offen offset:1024
    buffer_load_dwordx4 v[208:211], v8, s[8:11], s17 offen offset:2048
    buffer_load_dwordx4 v[212:215], v8, s[8:11], s17 offen offset:3072
    s_waitcnt vmcnt(3)
    v_mfma_f32_16x16x32_bf16 v[184:187], v[200:203], v[160:163], v[184:187]
    v_mfma_f32_16x16x32_bf16 v[188:191], v[200:203], v[176:179], v[188:191]
    s_waitcnt vmcnt(2)
    v_mfma_f32_16x16x32_bf16 v[192:195], v[204:207], v[160:163], v[192:195]
    v_mfma_f32_16x16x32_bf16 v[196:199], v[204:207], v[176:179], v[196:199]
    s_waitcnt vmcnt(1)
    v_mfma_f32_16x16x32_bf16 v[184:187], v[208:211], v[164:167], v[184:187]
    v_mfma_f32_16x16x32_bf16 v[188:191], v[208:211], v[180:183], v[188:191]
    s_waitcnt vmcnt(0)
    v_mfma_f32_16x16x32_bf16 v[192:195], v[212:215], v[164:167], v[192:195]
    v_mfma_f32_16x16x32_bf16 v[196:199], v[212:215], v[180:183], v[196:199]
    s_nop 3
    v_exp_f32 v184, v184
    v_exp_f32 v185, v185
    v_add_f32 v9, v9, v184
    v_add_f32 v9, v9, v185
    v_cvt_pk_bf16_f32 v104, v184, v185
    v_exp_f32 v186, v186
    v_exp_f32 v187, v187
    v_add_f32 v9, v9, v186
    v_add_f32 v9, v9, v187
    v_cvt_pk_bf16_f32 v105, v186, v187
    v_exp_f32 v188, v188
    v_exp_f32 v189, v189
    v_add_f32 v10, v10, v188
    v_add_f32 v10, v10, v189
    v_cvt_pk_bf16_f32 v108, v188, v189
    v_exp_f32 v190, v190
    v_exp_f32 v191, v191
    v_add_f32 v10, v10, v190
    v_add_f32 v10, v10, v191
    v_cvt_pk_bf16_f32 v109, v190, v191
    v_exp_f32 v192, v192
    v_exp_f32 v193, v193
    v_add_f32 v9, v9, v192
    v_add_f32 v9, v9, v193
    v_cvt_pk_bf16_f32 v106, v192, v193
    v_exp_f32 v194, v194
    v_exp_f32 v195, v195
    v_add_f32 v9, v9, v194
    v_add_f32 v9, v9, v195
    v_cvt_pk_bf16_f32 v107, v194, v195
    v_exp_f32 v196, v196
    v_exp_f32 v197, v197
    v_add_f32 v10, v10, v196
    v_add_f32 v10, v10, v197
    v_cvt_pk_bf16_f32 v110, v196, v197
    v_exp_f32 v198, v198
    v_exp_f32 v199, v199
    v_add_f32 v10, v10, v198
    v_add_f32 v10, v10, v199
    v_cvt_pk_bf16_f32 v111, v198, v199
    s_mov_b32 s17, 0x16000
    buffer_load_dwordx4 v[200:203], v8, s[8:11], s17 offen offset:0
    buffer_load_dwordx4 v[204:207], v8, s[8:11], s17 offen offset:1024
    buffer_load_dwordx4 v[208:211], v8, s[8:11], s17 offen offset:2048
    buffer_load_dwordx4 v[212:215], v8, s[8:11], s17 offen offset:3072
    s_waitcnt vmcnt(3)
    v_mfma_f32_16x16x32_bf16 v[184:187], v[200:203], v[152:155], v[216:219]
    v_mfma_f32_16x16x32_bf16 v[188:191], v[200:203], v[168:171], v[220:223]
    s_waitcnt vmcnt(2)
    v_mfma_f32_16x16x32_bf16 v[192:195], v[204:207], v[152:155], v[216:219]
    v_mfma_f32_16x16x32_bf16 v[196:199], v[204:207], v[168:171], v[220:223]
    s_waitcnt vmcnt(1)
    v_mfma_f32_16x16x32_bf16 v[184:187], v[208:211], v[156:159], v[184:187]
    v_mfma_f32_16x16x32_bf16 v[188:191], v[208:211], v[172:175], v[188:191]
    s_waitcnt vmcnt(0)
    v_mfma_f32_16x16x32_bf16 v[192:195], v[212:215], v[156:159], v[192:195]
    v_mfma_f32_16x16x32_bf16 v[196:199], v[212:215], v[172:175], v[196:199]
    s_mov_b32 s17, 0x17000
    buffer_load_dwordx4 v[200:203], v8, s[8:11], s17 offen offset:0
    buffer_load_dwordx4 v[204:207], v8, s[8:11], s17 offen offset:1024
    buffer_load_dwordx4 v[208:211], v8, s[8:11], s17 offen offset:2048
    buffer_load_dwordx4 v[212:215], v8, s[8:11], s17 offen offset:3072
    s_waitcnt vmcnt(3)
    v_mfma_f32_16x16x32_bf16 v[184:187], v[200:203], v[160:163], v[184:187]
    v_mfma_f32_16x16x32_bf16 v[188:191], v[200:203], v[176:179], v[188:191]
    s_waitcnt vmcnt(2)
    v_mfma_f32_16x16x32_bf16 v[192:195], v[204:207], v[160:163], v[192:195]
    v_mfma_f32_16x16x32_bf16 v[196:199], v[204:207], v[176:179], v[196:199]
    s_waitcnt vmcnt(1)
    v_mfma_f32_16x16x32_bf16 v[184:187], v[208:211], v[164:167], v[184:187]
    v_mfma_f32_16x16x32_bf16 v[188:191], v[208:211], v[180:183], v[188:191]
    s_waitcnt vmcnt(0)
    v_mfma_f32_16x16x32_bf16 v[192:195], v[212:215], v[164:167], v[192:195]
    v_mfma_f32_16x16x32_bf16 v[196:199], v[212:215], v[180:183], v[196:199]
    s_nop 3
    v_exp_f32 v184, v184
    v_exp_f32 v185, v185
    v_add_f32 v9, v9, v184
    v_add_f32 v9, v9, v185
    v_cvt_pk_bf16_f32 v112, v184, v185
    v_exp_f32 v186, v186
    v_exp_f32 v187, v187
    v_add_f32 v9, v9, v186
    v_add_f32 v9, v9, v187
    v_cvt_pk_bf16_f32 v113, v186, v187
    v_exp_f32 v188, v188
    v_exp_f32 v189, v189
    v_add_f32 v10, v10, v188
    v_add_f32 v10, v10, v189
    v_cvt_pk_bf16_f32 v116, v188, v189
    v_exp_f32 v190, v190
    v_exp_f32 v191, v191
    v_add_f32 v10, v10, v190
    v_add_f32 v10, v10, v191
    v_cvt_pk_bf16_f32 v117, v190, v191
    v_exp_f32 v192, v192
    v_exp_f32 v193, v193
    v_add_f32 v9, v9, v192
    v_add_f32 v9, v9, v193
    v_cvt_pk_bf16_f32 v114, v192, v193
    v_exp_f32 v194, v194
    v_exp_f32 v195, v195
    v_add_f32 v9, v9, v194
    v_add_f32 v9, v9, v195
    v_cvt_pk_bf16_f32 v115, v194, v195
    v_exp_f32 v196, v196
    v_exp_f32 v197, v197
    v_add_f32 v10, v10, v196
    v_add_f32 v10, v10, v197
    v_cvt_pk_bf16_f32 v118, v196, v197
    v_exp_f32 v198, v198
    v_exp_f32 v199, v199
    v_add_f32 v10, v10, v198
    v_add_f32 v10, v10, v199
    v_cvt_pk_bf16_f32 v119, v198, v199
    s_mov_b32 s17, 0x18000
    buffer_load_dwordx4 v[200:203], v8, s[8:11], s17 offen offset:0
    buffer_load_dwordx4 v[204:207], v8, s[8:11], s17 offen offset:1024
    buffer_load_dwordx4 v[208:211], v8, s[8:11], s17 offen offset:2048
    buffer_load_dwordx4 v[212:215], v8, s[8:11], s17 offen offset:3072
    s_waitcnt vmcnt(3)
    v_mfma_f32_16x16x32_bf16 v[184:187], v[200:203], v[152:155], v[216:219]
    v_mfma_f32_16x16x32_bf16 v[188:191], v[200:203], v[168:171], v[220:223]
    s_waitcnt vmcnt(2)
    v_mfma_f32_16x16x32_bf16 v[192:195], v[204:207], v[152:155], v[216:219]
    v_mfma_f32_16x16x32_bf16 v[196:199], v[204:207], v[168:171], v[220:223]
    s_waitcnt vmcnt(1)
    v_mfma_f32_16x16x32_bf16 v[184:187], v[208:211], v[156:159], v[184:187]
    v_mfma_f32_16x16x32_bf16 v[188:191], v[208:211], v[172:175], v[188:191]
    s_waitcnt vmcnt(0)
    v_mfma_f32_16x16x32_bf16 v[192:195], v[212:215], v[156:159], v[192:195]
    v_mfma_f32_16x16x32_bf16 v[196:199], v[212:215], v[172:175], v[196:199]
    s_mov_b32 s17, 0x19000
    buffer_load_dwordx4 v[200:203], v8, s[8:11], s17 offen offset:0
    buffer_load_dwordx4 v[204:207], v8, s[8:11], s17 offen offset:1024
    buffer_load_dwordx4 v[208:211], v8, s[8:11], s17 offen offset:2048
    buffer_load_dwordx4 v[212:215], v8, s[8:11], s17 offen offset:3072
    s_waitcnt vmcnt(3)
    v_mfma_f32_16x16x32_bf16 v[184:187], v[200:203], v[160:163], v[184:187]
    v_mfma_f32_16x16x32_bf16 v[188:191], v[200:203], v[176:179], v[188:191]
    s_waitcnt vmcnt(2)
    v_mfma_f32_16x16x32_bf16 v[192:195], v[204:207], v[160:163], v[192:195]
    v_mfma_f32_16x16x32_bf16 v[196:199], v[204:207], v[176:179], v[196:199]
    s_waitcnt vmcnt(1)
    v_mfma_f32_16x16x32_bf16 v[184:187], v[208:211], v[164:167], v[184:187]
    v_mfma_f32_16x16x32_bf16 v[188:191], v[208:211], v[180:183], v[188:191]
    s_waitcnt vmcnt(0)
    v_mfma_f32_16x16x32_bf16 v[192:195], v[212:215], v[164:167], v[192:195]
    v_mfma_f32_16x16x32_bf16 v[196:199], v[212:215], v[180:183], v[196:199]
    s_nop 3
    v_exp_f32 v184, v184
    v_exp_f32 v185, v185
    v_add_f32 v9, v9, v184
    v_add_f32 v9, v9, v185
    v_cvt_pk_bf16_f32 v120, v184, v185
    v_exp_f32 v186, v186
    v_exp_f32 v187, v187
    v_add_f32 v9, v9, v186
    v_add_f32 v9, v9, v187
    v_cvt_pk_bf16_f32 v121, v186, v187
    v_exp_f32 v188, v188
    v_exp_f32 v189, v189
    v_add_f32 v10, v10, v188
    v_add_f32 v10, v10, v189
    v_cvt_pk_bf16_f32 v124, v188, v189
    v_exp_f32 v190, v190
    v_exp_f32 v191, v191
    v_add_f32 v10, v10, v190
    v_add_f32 v10, v10, v191
    v_cvt_pk_bf16_f32 v125, v190, v191
    v_exp_f32 v192, v192
    v_exp_f32 v193, v193
    v_add_f32 v9, v9, v192
    v_add_f32 v9, v9, v193
    v_cvt_pk_bf16_f32 v122, v192, v193
    v_exp_f32 v194, v194
    v_exp_f32 v195, v195
    v_add_f32 v9, v9, v194
    v_add_f32 v9, v9, v195
    v_cvt_pk_bf16_f32 v123, v194, v195
    v_exp_f32 v196, v196
    v_exp_f32 v197, v197
    v_add_f32 v10, v10, v196
    v_add_f32 v10, v10, v197
    v_cvt_pk_bf16_f32 v126, v196, v197
    v_exp_f32 v198, v198
    v_exp_f32 v199, v199
    v_add_f32 v10, v10, v198
    v_add_f32 v10, v10, v199
    v_cvt_pk_bf16_f32 v127, v198, v199
    s_mov_b32 s17, 0x1a000
    buffer_load_dwordx4 v[200:203], v8, s[8:11], s17 offen offset:0
    buffer_load_dwordx4 v[204:207], v8, s[8:11], s17 offen offset:1024
    buffer_load_dwordx4 v[208:211], v8, s[8:11], s17 offen offset:2048
    buffer_load_dwordx4 v[212:215], v8, s[8:11], s17 offen offset:3072
    s_waitcnt vmcnt(3)
    v_mfma_f32_16x16x32_bf16 v[184:187], v[200:203], v[152:155], v[216:219]
    v_mfma_f32_16x16x32_bf16 v[188:191], v[200:203], v[168:171], v[220:223]
    s_waitcnt vmcnt(2)
    v_mfma_f32_16x16x32_bf16 v[192:195], v[204:207], v[152:155], v[216:219]
    v_mfma_f32_16x16x32_bf16 v[196:199], v[204:207], v[168:171], v[220:223]
    s_waitcnt vmcnt(1)
    v_mfma_f32_16x16x32_bf16 v[184:187], v[208:211], v[156:159], v[184:187]
    v_mfma_f32_16x16x32_bf16 v[188:191], v[208:211], v[172:175], v[188:191]
    s_waitcnt vmcnt(0)
    v_mfma_f32_16x16x32_bf16 v[192:195], v[212:215], v[156:159], v[192:195]
    v_mfma_f32_16x16x32_bf16 v[196:199], v[212:215], v[172:175], v[196:199]
    s_mov_b32 s17, 0x1b000
    buffer_load_dwordx4 v[200:203], v8, s[8:11], s17 offen offset:0
    buffer_load_dwordx4 v[204:207], v8, s[8:11], s17 offen offset:1024
    buffer_load_dwordx4 v[208:211], v8, s[8:11], s17 offen offset:2048
    buffer_load_dwordx4 v[212:215], v8, s[8:11], s17 offen offset:3072
    s_waitcnt vmcnt(3)
    v_mfma_f32_16x16x32_bf16 v[184:187], v[200:203], v[160:163], v[184:187]
    v_mfma_f32_16x16x32_bf16 v[188:191], v[200:203], v[176:179], v[188:191]
    s_waitcnt vmcnt(2)
    v_mfma_f32_16x16x32_bf16 v[192:195], v[204:207], v[160:163], v[192:195]
    v_mfma_f32_16x16x32_bf16 v[196:199], v[204:207], v[176:179], v[196:199]
    s_waitcnt vmcnt(1)
    v_mfma_f32_16x16x32_bf16 v[184:187], v[208:211], v[164:167], v[184:187]
    v_mfma_f32_16x16x32_bf16 v[188:191], v[208:211], v[180:183], v[188:191]
    s_waitcnt vmcnt(0)
    v_mfma_f32_16x16x32_bf16 v[192:195], v[212:215], v[164:167], v[192:195]
    v_mfma_f32_16x16x32_bf16 v[196:199], v[212:215], v[180:183], v[196:199]
    s_nop 3
    v_exp_f32 v184, v184
    v_exp_f32 v185, v185
    v_add_f32 v9, v9, v184
    v_add_f32 v9, v9, v185
    v_cvt_pk_bf16_f32 v128, v184, v185
    v_exp_f32 v186, v186
    v_exp_f32 v187, v187
    v_add_f32 v9, v9, v186
    v_add_f32 v9, v9, v187
    v_cvt_pk_bf16_f32 v129, v186, v187
    v_exp_f32 v188, v188
    v_exp_f32 v189, v189
    v_add_f32 v10, v10, v188
    v_add_f32 v10, v10, v189
    v_cvt_pk_bf16_f32 v132, v188, v189
    v_exp_f32 v190, v190
    v_exp_f32 v191, v191
    v_add_f32 v10, v10, v190
    v_add_f32 v10, v10, v191
    v_cvt_pk_bf16_f32 v133, v190, v191
    v_exp_f32 v192, v192
    v_exp_f32 v193, v193
    v_add_f32 v9, v9, v192
    v_add_f32 v9, v9, v193
    v_cvt_pk_bf16_f32 v130, v192, v193
    v_exp_f32 v194, v194
    v_exp_f32 v195, v195
    v_add_f32 v9, v9, v194
    v_add_f32 v9, v9, v195
    v_cvt_pk_bf16_f32 v131, v194, v195
    v_exp_f32 v196, v196
    v_exp_f32 v197, v197
    v_add_f32 v10, v10, v196
    v_add_f32 v10, v10, v197
    v_cvt_pk_bf16_f32 v134, v196, v197
    v_exp_f32 v198, v198
    v_exp_f32 v199, v199
    v_add_f32 v10, v10, v198
    v_add_f32 v10, v10, v199
    v_cvt_pk_bf16_f32 v135, v198, v199
    s_mov_b32 s17, 0x1c000
    buffer_load_dwordx4 v[200:203], v8, s[8:11], s17 offen offset:0
    buffer_load_dwordx4 v[204:207], v8, s[8:11], s17 offen offset:1024
    buffer_load_dwordx4 v[208:211], v8, s[8:11], s17 offen offset:2048
    buffer_load_dwordx4 v[212:215], v8, s[8:11], s17 offen offset:3072
    s_waitcnt vmcnt(3)
    v_mfma_f32_16x16x32_bf16 v[184:187], v[200:203], v[152:155], v[216:219]
    v_mfma_f32_16x16x32_bf16 v[188:191], v[200:203], v[168:171], v[220:223]
    s_waitcnt vmcnt(2)
    v_mfma_f32_16x16x32_bf16 v[192:195], v[204:207], v[152:155], v[216:219]
    v_mfma_f32_16x16x32_bf16 v[196:199], v[204:207], v[168:171], v[220:223]
    s_waitcnt vmcnt(1)
    v_mfma_f32_16x16x32_bf16 v[184:187], v[208:211], v[156:159], v[184:187]
    v_mfma_f32_16x16x32_bf16 v[188:191], v[208:211], v[172:175], v[188:191]
    s_waitcnt vmcnt(0)
    v_mfma_f32_16x16x32_bf16 v[192:195], v[212:215], v[156:159], v[192:195]
    v_mfma_f32_16x16x32_bf16 v[196:199], v[212:215], v[172:175], v[196:199]
    s_mov_b32 s17, 0x1d000
    buffer_load_dwordx4 v[200:203], v8, s[8:11], s17 offen offset:0
    buffer_load_dwordx4 v[204:207], v8, s[8:11], s17 offen offset:1024
    buffer_load_dwordx4 v[208:211], v8, s[8:11], s17 offen offset:2048
    buffer_load_dwordx4 v[212:215], v8, s[8:11], s17 offen offset:3072
    s_waitcnt vmcnt(3)
    v_mfma_f32_16x16x32_bf16 v[184:187], v[200:203], v[160:163], v[184:187]
    v_mfma_f32_16x16x32_bf16 v[188:191], v[200:203], v[176:179], v[188:191]
    s_waitcnt vmcnt(2)
    v_mfma_f32_16x16x32_bf16 v[192:195], v[204:207], v[160:163], v[192:195]
    v_mfma_f32_16x16x32_bf16 v[196:199], v[204:207], v[176:179], v[196:199]
    s_waitcnt vmcnt(1)
    v_mfma_f32_16x16x32_bf16 v[184:187], v[208:211], v[164:167], v[184:187]
    v_mfma_f32_16x16x32_bf16 v[188:191], v[208:211], v[180:183], v[188:191]
    s_waitcnt vmcnt(0)
    v_mfma_f32_16x16x32_bf16 v[192:195], v[212:215], v[164:167], v[192:195]
    v_mfma_f32_16x16x32_bf16 v[196:199], v[212:215], v[180:183], v[196:199]
    s_nop 3
    v_exp_f32 v184, v184
    v_exp_f32 v185, v185
    v_add_f32 v9, v9, v184
    v_add_f32 v9, v9, v185
    v_cvt_pk_bf16_f32 v136, v184, v185
    v_exp_f32 v186, v186
    v_exp_f32 v187, v187
    v_add_f32 v9, v9, v186
    v_add_f32 v9, v9, v187
    v_cvt_pk_bf16_f32 v137, v186, v187
    v_exp_f32 v188, v188
    v_exp_f32 v189, v189
    v_add_f32 v10, v10, v188
    v_add_f32 v10, v10, v189
    v_cvt_pk_bf16_f32 v140, v188, v189
    v_exp_f32 v190, v190
    v_exp_f32 v191, v191
    v_add_f32 v10, v10, v190
    v_add_f32 v10, v10, v191
    v_cvt_pk_bf16_f32 v141, v190, v191
    v_exp_f32 v192, v192
    v_exp_f32 v193, v193
    v_add_f32 v9, v9, v192
    v_add_f32 v9, v9, v193
    v_cvt_pk_bf16_f32 v138, v192, v193
    v_exp_f32 v194, v194
    v_exp_f32 v195, v195
    v_add_f32 v9, v9, v194
    v_add_f32 v9, v9, v195
    v_cvt_pk_bf16_f32 v139, v194, v195
    v_exp_f32 v196, v196
    v_exp_f32 v197, v197
    v_add_f32 v10, v10, v196
    v_add_f32 v10, v10, v197
    v_cvt_pk_bf16_f32 v142, v196, v197
    v_exp_f32 v198, v198
    v_exp_f32 v199, v199
    v_add_f32 v10, v10, v198
    v_add_f32 v10, v10, v199
    v_cvt_pk_bf16_f32 v143, v198, v199
    s_mov_b32 s17, 0x1e000
    buffer_load_dwordx4 v[200:203], v8, s[8:11], s17 offen offset:0
    buffer_load_dwordx4 v[204:207], v8, s[8:11], s17 offen offset:1024
    buffer_load_dwordx4 v[208:211], v8, s[8:11], s17 offen offset:2048
    buffer_load_dwordx4 v[212:215], v8, s[8:11], s17 offen offset:3072
    s_waitcnt vmcnt(3)
    v_mfma_f32_16x16x32_bf16 v[184:187], v[200:203], v[152:155], v[216:219]
    v_mfma_f32_16x16x32_bf16 v[188:191], v[200:203], v[168:171], v[220:223]
    s_waitcnt vmcnt(2)
    v_mfma_f32_16x16x32_bf16 v[192:195], v[204:207], v[152:155], v[216:219]
    v_mfma_f32_16x16x32_bf16 v[196:199], v[204:207], v[168:171], v[220:223]
    s_waitcnt vmcnt(1)
    v_mfma_f32_16x16x32_bf16 v[184:187], v[208:211], v[156:159], v[184:187]
    v_mfma_f32_16x16x32_bf16 v[188:191], v[208:211], v[172:175], v[188:191]
    s_waitcnt vmcnt(0)
    v_mfma_f32_16x16x32_bf16 v[192:195], v[212:215], v[156:159], v[192:195]
    v_mfma_f32_16x16x32_bf16 v[196:199], v[212:215], v[172:175], v[196:199]
    s_mov_b32 s17, 0x1f000
    buffer_load_dwordx4 v[200:203], v8, s[8:11], s17 offen offset:0
    buffer_load_dwordx4 v[204:207], v8, s[8:11], s17 offen offset:1024
    buffer_load_dwordx4 v[208:211], v8, s[8:11], s17 offen offset:2048
    buffer_load_dwordx4 v[212:215], v8, s[8:11], s17 offen offset:3072
    s_waitcnt vmcnt(3)
    v_mfma_f32_16x16x32_bf16 v[184:187], v[200:203], v[160:163], v[184:187]
    v_mfma_f32_16x16x32_bf16 v[188:191], v[200:203], v[176:179], v[188:191]
    s_waitcnt vmcnt(2)
    v_mfma_f32_16x16x32_bf16 v[192:195], v[204:207], v[160:163], v[192:195]
    v_mfma_f32_16x16x32_bf16 v[196:199], v[204:207], v[176:179], v[196:199]
    s_waitcnt vmcnt(1)
    v_mfma_f32_16x16x32_bf16 v[184:187], v[208:211], v[164:167], v[184:187]
    v_mfma_f32_16x16x32_bf16 v[188:191], v[208:211], v[180:183], v[188:191]
    s_waitcnt vmcnt(0)
    v_mfma_f32_16x16x32_bf16 v[192:195], v[212:215], v[164:167], v[192:195]
    v_mfma_f32_16x16x32_bf16 v[196:199], v[212:215], v[180:183], v[196:199]
    s_nop 3
    v_exp_f32 v184, v184
    v_exp_f32 v185, v185
    v_add_f32 v9, v9, v184
    v_add_f32 v9, v9, v185
    v_cvt_pk_bf16_f32 v144, v184, v185
    v_exp_f32 v186, v186
    v_exp_f32 v187, v187
    v_add_f32 v9, v9, v186
    v_add_f32 v9, v9, v187
    v_cvt_pk_bf16_f32 v145, v186, v187
    v_exp_f32 v188, v188
    v_exp_f32 v189, v189
    v_add_f32 v10, v10, v188
    v_add_f32 v10, v10, v189
    v_cvt_pk_bf16_f32 v148, v188, v189
    v_exp_f32 v190, v190
    v_exp_f32 v191, v191
    v_add_f32 v10, v10, v190
    v_add_f32 v10, v10, v191
    v_cvt_pk_bf16_f32 v149, v190, v191
    v_exp_f32 v192, v192
    v_exp_f32 v193, v193
    v_add_f32 v9, v9, v192
    v_add_f32 v9, v9, v193
    v_cvt_pk_bf16_f32 v146, v192, v193
    v_exp_f32 v194, v194
    v_exp_f32 v195, v195
    v_add_f32 v9, v9, v194
    v_add_f32 v9, v9, v195
    v_cvt_pk_bf16_f32 v147, v194, v195
    v_exp_f32 v196, v196
    v_exp_f32 v197, v197
    v_add_f32 v10, v10, v196
    v_add_f32 v10, v10, v197
    v_cvt_pk_bf16_f32 v150, v196, v197
    v_exp_f32 v198, v198
    v_exp_f32 v199, v199
    v_add_f32 v10, v10, v198
    v_add_f32 v10, v10, v199
    v_cvt_pk_bf16_f32 v151, v198, v199
    v_mov_b32 v16, v9
    v_mov_b32 v18, v10
    s_nop 0
    v_permlane16_swap_b32 v9, v16
    v_permlane16_swap_b32 v10, v18
    v_add_f32 v9, v9, v16
    v_add_f32 v10, v10, v18
    v_mov_b32 v16, v9
    v_mov_b32 v18, v10
    s_nop 0
    v_permlane32_swap_b32 v9, v16
    v_permlane32_swap_b32 v10, v18
    v_add_f32 v9, v9, v16
    v_add_f32 v10, v10, v18
    s_waitcnt vmcnt(0) lgkmcnt(0)
    s_nop 15
    s_nop 3
    s_branch adaLN_cond__sliding_block_cached__moe_arch_mod__prompt_kernel_fixAb
adaLN_cond__sliding_block_cached__moe_arch_mod__prompt_kernel_mp5r:
    s_waitcnt vmcnt(0) lgkmcnt(0)
    s_nop 15
    s_nop 3
    s_mov_b32 s27, 0
adaLN_cond__sliding_block_cached__moe_arch_mod__prompt_kernel_mp5p:
    buffer_load_dword v248, v250, s[8:11], s14 offen sc1
    s_waitcnt vmcnt(0)
    v_cmp_ne_u32 vcc, s28, v248
    s_add_u32 s27, s27, 1
    s_cmp_ge_u32 s27, 262144
    s_cbranch_scc1 adaLN_cond__sliding_block_cached__moe_arch_mod__prompt_kernel_mp5g
    s_cbranch_vccnz adaLN_cond__sliding_block_cached__moe_arch_mod__prompt_kernel_mp5p
adaLN_cond__sliding_block_cached__moe_arch_mod__prompt_kernel_mp5g:
    s_waitcnt vmcnt(0) lgkmcnt(0)
    s_nop 15
    s_nop 3
    s_branch adaLN_cond__sliding_block_cached__moe_arch_mod__prompt_kernel_mp5b
adaLN_cond__sliding_block_cached__moe_arch_mod__prompt_kernel_o6r:
    s_waitcnt vmcnt(0) lgkmcnt(0)
    s_nop 15
    s_nop 3
    s_mov_b32 s27, 0
adaLN_cond__sliding_block_cached__moe_arch_mod__prompt_kernel_o6p:
    buffer_load_dword v12, v13, s[8:11], s19 offen sc1
    s_waitcnt vmcnt(0)
    v_cmp_ne_u32 vcc, s28, v12
    s_add_u32 s27, s27, 1
    s_cmp_ge_u32 s27, 262144
    s_cbranch_scc1 adaLN_cond__sliding_block_cached__moe_arch_mod__prompt_kernel_o6g
    s_cbranch_vccnz adaLN_cond__sliding_block_cached__moe_arch_mod__prompt_kernel_o6p
adaLN_cond__sliding_block_cached__moe_arch_mod__prompt_kernel_o6g:
    s_waitcnt vmcnt(0) lgkmcnt(0)
    s_nop 15
    s_nop 3
    s_branch adaLN_cond__sliding_block_cached__moe_arch_mod__prompt_kernel_o6b
adaLN_cond__sliding_block_cached__moe_arch_mod__prompt_kernel_o27r:
    s_waitcnt vmcnt(0) lgkmcnt(0)
    s_nop 15
    s_nop 3
    s_mov_b32 s27, 0
adaLN_cond__sliding_block_cached__moe_arch_mod__prompt_kernel_o27p:
    buffer_load_dword v12, v13, s[8:11], s19 offen sc1
    s_waitcnt vmcnt(0)
    v_cmp_ne_u32 vcc, s28, v12
    s_add_u32 s27, s27, 1
    s_cmp_ge_u32 s27, 262144
    s_cbranch_scc1 adaLN_cond__sliding_block_cached__moe_arch_mod__prompt_kernel_o27g
    s_cbranch_vccnz adaLN_cond__sliding_block_cached__moe_arch_mod__prompt_kernel_o27p
adaLN_cond__sliding_block_cached__moe_arch_mod__prompt_kernel_o27g:
    s_waitcnt vmcnt(0) lgkmcnt(0)
    s_nop 15
    s_nop 3
    s_branch adaLN_cond__sliding_block_cached__moe_arch_mod__prompt_kernel_o27b
adaLN_cond__sliding_block_cached__moe_arch_mod__prompt_kernel_o28r:
    s_waitcnt vmcnt(0) lgkmcnt(0)
    s_nop 15
    s_nop 3
    s_mov_b32 s27, 0
adaLN_cond__sliding_block_cached__moe_arch_mod__prompt_kernel_o28p:
    buffer_load_dword v12, v13, s[8:11], s19 offen sc1
    s_waitcnt vmcnt(0)
    v_cmp_ne_u32 vcc, s28, v12
    s_add_u32 s27, s27, 1
    s_cmp_ge_u32 s27, 262144
    s_cbranch_scc1 adaLN_cond__sliding_block_cached__moe_arch_mod__prompt_kernel_o28g
    s_cbranch_vccnz adaLN_cond__sliding_block_cached__moe_arch_mod__prompt_kernel_o28p
adaLN_cond__sliding_block_cached__moe_arch_mod__prompt_kernel_o28g:
    s_waitcnt vmcnt(0) lgkmcnt(0)
    s_nop 15
    s_nop 3
    s_branch adaLN_cond__sliding_block_cached__moe_arch_mod__prompt_kernel_o28b
adaLN_cond__sliding_block_cached__moe_arch_mod__prompt_kernel_o29r:
    s_waitcnt vmcnt(0) lgkmcnt(0)
    s_nop 15
    s_nop 3
    s_mov_b32 s27, 0
adaLN_cond__sliding_block_cached__moe_arch_mod__prompt_kernel_o29p:
    buffer_load_dword v12, v13, s[8:11], s19 offen sc1
    s_waitcnt vmcnt(0)
    v_cmp_ne_u32 vcc, s28, v12
    s_add_u32 s27, s27, 1
    s_cmp_ge_u32 s27, 262144
    s_cbranch_scc1 adaLN_cond__sliding_block_cached__moe_arch_mod__prompt_kernel_o29g
    s_cbranch_vccnz adaLN_cond__sliding_block_cached__moe_arch_mod__prompt_kernel_o29p
adaLN_cond__sliding_block_cached__moe_arch_mod__prompt_kernel_o29g:
    s_waitcnt vmcnt(0) lgkmcnt(0)
    s_nop 15
    s_nop 3
    s_branch adaLN_cond__sliding_block_cached__moe_arch_mod__prompt_kernel_o29b
adaLN_cond__sliding_block_cached__moe_arch_mod__prompt_kernel_mf10r:
    s_waitcnt vmcnt(0) lgkmcnt(0)
    s_nop 15
    s_nop 3
    s_mov_b32 s27, 0
adaLN_cond__sliding_block_cached__moe_arch_mod__prompt_kernel_mf10p:
    s_mov_b32 s16, 0x544000
    buffer_load_dwordx4 v[184:187], v2, s[8:11], s16 offen sc1
    s_waitcnt vmcnt(0)
    v_xor_b32 v16, s28, v184
    v_xor_b32 v17, s28, v185
    v_xor_b32 v18, s28, v186
    v_xor_b32 v19, s28, v187
    v_or3_b32 v16, v16, v17, v18
    v_or_b32 v16, v16, v19
    v_cmp_ne_u32 vcc, 0, v16
    s_add_u32 s27, s27, 1
    s_cmp_ge_u32 s27, 262144
    s_cbranch_scc1 adaLN_cond__sliding_block_cached__moe_arch_mod__prompt_kernel_mf10g
    s_cbranch_vccnz adaLN_cond__sliding_block_cached__moe_arch_mod__prompt_kernel_mf10p
adaLN_cond__sliding_block_cached__moe_arch_mod__prompt_kernel_mf10g:
    s_waitcnt vmcnt(0) lgkmcnt(0)
    s_nop 15
    s_nop 3
    s_branch adaLN_cond__sliding_block_cached__moe_arch_mod__prompt_kernel_mf10b
adaLN_cond__sliding_block_cached__moe_arch_mod__prompt_kernel_kv16r:
    s_waitcnt vmcnt(0) lgkmcnt(0)
    s_nop 15
    s_nop 3
    s_mov_b32 s27, 0
adaLN_cond__sliding_block_cached__moe_arch_mod__prompt_kernel_kv16p:
    buffer_load_dwordx4 v[12:15], v21, s[8:11], s18 offen sc1
    s_waitcnt vmcnt(0)
    v_xor_b32 v8, s28, v12
    v_xor_b32 v20, s28, v13
    v_or_b32 v8, v8, v20
    v_xor_b32 v20, s28, v14
    v_or_b32 v8, v8, v20
    v_xor_b32 v20, s28, v15
    v_or_b32 v8, v8, v20
    v_cmp_ne_u32 vcc, 0, v8
    s_add_u32 s27, s27, 1
    s_cmp_ge_u32 s27, 262144
    s_cbranch_scc1 adaLN_cond__sliding_block_cached__moe_arch_mod__prompt_kernel_kv16g
    s_cbranch_vccnz adaLN_cond__sliding_block_cached__moe_arch_mod__prompt_kernel_kv16p
adaLN_cond__sliding_block_cached__moe_arch_mod__prompt_kernel_kv16g:
    s_waitcnt vmcnt(0) lgkmcnt(0)
    s_nop 15
    s_nop 3
    s_branch adaLN_cond__sliding_block_cached__moe_arch_mod__prompt_kernel_kv16b
adaLN_cond__sliding_block_cached__moe_arch_mod__prompt_kernel_fixB:
    s_waitcnt vmcnt(0) lgkmcnt(0)
    s_nop 15
    s_nop 3
    s_lshr_b32 s16, s12, 3
    s_lshl_b32 s16, s16, 17
    s_add_u32 s16, s16, 0x400000
    v_add_u32 v8, s16, v2
    v_mov_b32 v16, 0xff7fffff
    v_mov_b32 v17, 0xff7fffff
    s_mov_b32 s16, 0
adaLN_cond__sliding_block_cached__moe_arch_mod__prompt_kernel_fixBm:
    s_add_u32 s17, s16, 0
    buffer_load_dwordx4 v[200:203], v8, s[8:11], s17 offen offset:0
    buffer_load_dwordx4 v[204:207], v8, s[8:11], s17 offen offset:1024
    buffer_load_dwordx4 v[208:211], v8, s[8:11], s17 offen offset:2048
    buffer_load_dwordx4 v[212:215], v8, s[8:11], s17 offen offset:3072
    s_waitcnt vmcnt(3)
    v_mfma_f32_16x16x32_bf16 v[184:187], v[200:203], v[152:155], 0
    v_mfma_f32_16x16x32_bf16 v[188:191], v[200:203], v[168:171], 0
    s_waitcnt vmcnt(2)
    v_mfma_f32_16x16x32_bf16 v[192:195], v[204:207], v[152:155], 0
    v_mfma_f32_16x16x32_bf16 v[196:199], v[204:207], v[168:171], 0
    s_waitcnt vmcnt(1)
    v_mfma_f32_16x16x32_bf16 v[184:187], v[208:211], v[156:159], v[184:187]
    v_mfma_f32_16x16x32_bf16 v[188:191], v[208:211], v[172:175], v[188:191]
    s_waitcnt vmcnt(0)
    v_mfma_f32_16x16x32_bf16 v[192:195], v[212:215], v[156:159], v[192:195]
    v_mfma_f32_16x16x32_bf16 v[196:199], v[212:215], v[172:175], v[196:199]
    s_add_u32 s17, s16, 4096
    buffer_load_dwordx4 v[200:203], v8, s[8:11], s17 offen offset:0
    buffer_load_dwordx4 v[204:207], v8, s[8:11], s17 offen offset:1024
    buffer_load_dwordx4 v[208:211], v8, s[8:11], s17 offen offset:2048
    buffer_load_dwordx4 v[212:215], v8, s[8:11], s17 offen offset:3072
    s_waitcnt vmcnt(3)
    v_mfma_f32_16x16x32_bf16 v[184:187], v[200:203], v[160:163], v[184:187]
    v_mfma_f32_16x16x32_bf16 v[188:191], v[200:203], v[176:179], v[188:191]
    s_waitcnt vmcnt(2)
    v_mfma_f32_16x16x32_bf16 v[192:195], v[204:207], v[160:163], v[192:195]
    v_mfma_f32_16x16x32_bf16 v[196:199], v[204:207], v[176:179], v[196:199]
    s_waitcnt vmcnt(1)
    v_mfma_f32_16x16x32_bf16 v[184:187], v[208:211], v[164:167], v[184:187]
    v_mfma_f32_16x16x32_bf16 v[188:191], v[208:211], v[180:183], v[188:191]
    s_waitcnt vmcnt(0)
    v_mfma_f32_16x16x32_bf16 v[192:195], v[212:215], v[164:167], v[192:195]
    v_mfma_f32_16x16x32_bf16 v[196:199], v[212:215], v[180:183], v[196:199]
    s_nop 3
    v_max3_f32 v16, v16, v184, v185
    v_max3_f32 v16, v16, v186, v187
    v_max3_f32 v17, v17, v188, v189
    v_max3_f32 v17, v17, v190, v191
    v_max3_f32 v16, v16, v192, v193
    v_max3_f32 v16, v16, v194, v195
    v_max3_f32 v17, v17, v196, v197
    v_max3_f32 v17, v17, v198, v199
    s_add_u32 s16, s16, 8192
    s_cmp_lt_u32 s16, 0x20000
    s_cbranch_scc1 adaLN_cond__sliding_block_cached__moe_arch_mod__prompt_kernel_fixBm
    v_mov_b32 v18, v16
    v_mov_b32 v19, v17
    s_nop 0
    v_permlane16_swap_b32 v16, v18
    v_permlane16_swap_b32 v17, v19
    v_max_f32 v16, v16, v18
    v_max_f32 v17, v17, v19
    v_mov_b32 v18, v16
    v_mov_b32 v19, v17
    s_nop 0
    v_permlane32_swap_b32 v16, v18
    v_permlane32_swap_b32 v17, v19
    v_max_f32 v16, v16, v18
    v_max_f32 v17, v17, v19
    v_sub_f32 v216, 0, v16
    v_sub_f32 v217, 0, v16
    v_sub_f32 v218, 0, v16
    v_sub_f32 v219, 0, v16
    v_sub_f32 v220, 0, v17
    v_sub_f32 v221, 0, v17
    v_sub_f32 v222, 0, v17
    v_sub_f32 v223, 0, v17
    s_mov_b32 s17, 0x0
    buffer_load_dwordx4 v[200:203], v8, s[8:11], s17 offen offset:0
    buffer_load_dwordx4 v[204:207], v8, s[8:11], s17 offen offset:1024
    buffer_load_dwordx4 v[208:211], v8, s[8:11], s17 offen offset:2048
    buffer_load_dwordx4 v[212:215], v8, s[8:11], s17 offen offset:3072
    s_waitcnt vmcnt(3)
    v_mfma_f32_16x16x32_bf16 v[184:187], v[200:203], v[152:155], v[216:219]
    v_mfma_f32_16x16x32_bf16 v[188:191], v[200:203], v[168:171], v[220:223]
    s_waitcnt vmcnt(2)
    v_mfma_f32_16x16x32_bf16 v[192:195], v[204:207], v[152:155], v[216:219]
    v_mfma_f32_16x16x32_bf16 v[196:199], v[204:207], v[168:171], v[220:223]
    s_waitcnt vmcnt(1)
    v_mfma_f32_16x16x32_bf16 v[184:187], v[208:211], v[156:159], v[184:187]
    v_mfma_f32_16x16x32_bf16 v[188:191], v[208:211], v[172:175], v[188:191]
    s_waitcnt vmcnt(0)
    v_mfma_f32_16x16x32_bf16 v[192:195], v[212:215], v[156:159], v[192:195]
    v_mfma_f32_16x16x32_bf16 v[196:199], v[212:215], v[172:175], v[196:199]
    s_mov_b32 s17, 0x1000
    buffer_load_dwordx4 v[200:203], v8, s[8:11], s17 offen offset:0
    buffer_load_dwordx4 v[204:207], v8, s[8:11], s17 offen offset:1024
    buffer_load_dwordx4 v[208:211], v8, s[8:11], s17 offen offset:2048
    buffer_load_dwordx4 v[212:215], v8, s[8:11], s17 offen offset:3072
    s_waitcnt vmcnt(3)
    v_mfma_f32_16x16x32_bf16 v[184:187], v[200:203], v[160:163], v[184:187]
    v_mfma_f32_16x16x32_bf16 v[188:191], v[200:203], v[176:179], v[188:191]
    s_waitcnt vmcnt(2)
    v_mfma_f32_16x16x32_bf16 v[192:195], v[204:207], v[160:163], v[192:195]
    v_mfma_f32_16x16x32_bf16 v[196:199], v[204:207], v[176:179], v[196:199]
    s_waitcnt vmcnt(1)
    v_mfma_f32_16x16x32_bf16 v[184:187], v[208:211], v[164:167], v[184:187]
    v_mfma_f32_16x16x32_bf16 v[188:191], v[208:211], v[180:183], v[188:191]
    s_waitcnt vmcnt(0)
    v_mfma_f32_16x16x32_bf16 v[192:195], v[212:215], v[164:167], v[192:195]
    v_mfma_f32_16x16x32_bf16 v[196:199], v[212:215], v[180:183], v[196:199]
    s_nop 3
    v_exp_f32 v184, v184
    v_exp_f32 v185, v185
    s_nop 0
    v_add_f32 v9, v184, v185
    v_cvt_pk_bf16_f32 v24, v184, v185
    v_exp_f32 v186, v186
    v_exp_f32 v187, v187
    v_add_f32 v9, v9, v186
    v_add_f32 v9, v9, v187
    v_cvt_pk_bf16_f32 v25, v186, v187
    v_exp_f32 v188, v188
    v_exp_f32 v189, v189
    s_nop 0
    v_add_f32 v10, v188, v189
    v_cvt_pk_bf16_f32 v28, v188, v189
    v_exp_f32 v190, v190
    v_exp_f32 v191, v191
    v_add_f32 v10, v10, v190
    v_add_f32 v10, v10, v191
    v_cvt_pk_bf16_f32 v29, v190, v191
    v_exp_f32 v192, v192
    v_exp_f32 v193, v193
    v_add_f32 v9, v9, v192
    v_add_f32 v9, v9, v193
    v_cvt_pk_bf16_f32 v26, v192, v193
    v_exp_f32 v194, v194
    v_exp_f32 v195, v195
    v_add_f32 v9, v9, v194
    v_add_f32 v9, v9, v195
    v_cvt_pk_bf16_f32 v27, v194, v195
    v_exp_f32 v196, v196
    v_exp_f32 v197, v197
    v_add_f32 v10, v10, v196
    v_add_f32 v10, v10, v197
    v_cvt_pk_bf16_f32 v30, v196, v197
    v_exp_f32 v198, v198
    v_exp_f32 v199, v199
    v_add_f32 v10, v10, v198
    v_add_f32 v10, v10, v199
    v_cvt_pk_bf16_f32 v31, v198, v199
    s_mov_b32 s17, 0x2000
    buffer_load_dwordx4 v[200:203], v8, s[8:11], s17 offen offset:0
    buffer_load_dwordx4 v[204:207], v8, s[8:11], s17 offen offset:1024
    buffer_load_dwordx4 v[208:211], v8, s[8:11], s17 offen offset:2048
    buffer_load_dwordx4 v[212:215], v8, s[8:11], s17 offen offset:3072
    s_waitcnt vmcnt(3)
    v_mfma_f32_16x16x32_bf16 v[184:187], v[200:203], v[152:155], v[216:219]
    v_mfma_f32_16x16x32_bf16 v[188:191], v[200:203], v[168:171], v[220:223]
    s_waitcnt vmcnt(2)
    v_mfma_f32_16x16x32_bf16 v[192:195], v[204:207], v[152:155], v[216:219]
    v_mfma_f32_16x16x32_bf16 v[196:199], v[204:207], v[168:171], v[220:223]
    s_waitcnt vmcnt(1)
    v_mfma_f32_16x16x32_bf16 v[184:187], v[208:211], v[156:159], v[184:187]
    v_mfma_f32_16x16x32_bf16 v[188:191], v[208:211], v[172:175], v[188:191]
    s_waitcnt vmcnt(0)
    v_mfma_f32_16x16x32_bf16 v[192:195], v[212:215], v[156:159], v[192:195]
    v_mfma_f32_16x16x32_bf16 v[196:199], v[212:215], v[172:175], v[196:199]
    s_mov_b32 s17, 0x3000
    buffer_load_dwordx4 v[200:203], v8, s[8:11], s17 offen offset:0
    buffer_load_dwordx4 v[204:207], v8, s[8:11], s17 offen offset:1024
    buffer_load_dwordx4 v[208:211], v8, s[8:11], s17 offen offset:2048
    buffer_load_dwordx4 v[212:215], v8, s[8:11], s17 offen offset:3072
    s_waitcnt vmcnt(3)
    v_mfma_f32_16x16x32_bf16 v[184:187], v[200:203], v[160:163], v[184:187]
    v_mfma_f32_16x16x32_bf16 v[188:191], v[200:203], v[176:179], v[188:191]
    s_waitcnt vmcnt(2)
    v_mfma_f32_16x16x32_bf16 v[192:195], v[204:207], v[160:163], v[192:195]
    v_mfma_f32_16x16x32_bf16 v[196:199], v[204:207], v[176:179], v[196:199]
    s_waitcnt vmcnt(1)
    v_mfma_f32_16x16x32_bf16 v[184:187], v[208:211], v[164:167], v[184:187]
    v_mfma_f32_16x16x32_bf16 v[188:191], v[208:211], v[180:183], v[188:191]
    s_waitcnt vmcnt(0)
    v_mfma_f32_16x16x32_bf16 v[192:195], v[212:215], v[164:167], v[192:195]
    v_mfma_f32_16x16x32_bf16 v[196:199], v[212:215], v[180:183], v[196:199]
    s_nop 3
    v_exp_f32 v184, v184
    v_exp_f32 v185, v185
    v_add_f32 v9, v9, v184
    v_add_f32 v9, v9, v185
    v_cvt_pk_bf16_f32 v32, v184, v185
    v_exp_f32 v186, v186
    v_exp_f32 v187, v187
    v_add_f32 v9, v9, v186
    v_add_f32 v9, v9, v187
    v_cvt_pk_bf16_f32 v33, v186, v187
    v_exp_f32 v188, v188
    v_exp_f32 v189, v189
    v_add_f32 v10, v10, v188
    v_add_f32 v10, v10, v189
    v_cvt_pk_bf16_f32 v36, v188, v189
    v_exp_f32 v190, v190
    v_exp_f32 v191, v191
    v_add_f32 v10, v10, v190
    v_add_f32 v10, v10, v191
    v_cvt_pk_bf16_f32 v37, v190, v191
    v_exp_f32 v192, v192
    v_exp_f32 v193, v193
    v_add_f32 v9, v9, v192
    v_add_f32 v9, v9, v193
    v_cvt_pk_bf16_f32 v34, v192, v193
    v_exp_f32 v194, v194
    v_exp_f32 v195, v195
    v_add_f32 v9, v9, v194
    v_add_f32 v9, v9, v195
    v_cvt_pk_bf16_f32 v35, v194, v195
    v_exp_f32 v196, v196
    v_exp_f32 v197, v197
    v_add_f32 v10, v10, v196
    v_add_f32 v10, v10, v197
    v_cvt_pk_bf16_f32 v38, v196, v197
    v_exp_f32 v198, v198
    v_exp_f32 v199, v199
    v_add_f32 v10, v10, v198
    v_add_f32 v10, v10, v199
    v_cvt_pk_bf16_f32 v39, v198, v199
    s_mov_b32 s17, 0x4000
    buffer_load_dwordx4 v[200:203], v8, s[8:11], s17 offen offset:0
    buffer_load_dwordx4 v[204:207], v8, s[8:11], s17 offen offset:1024
    buffer_load_dwordx4 v[208:211], v8, s[8:11], s17 offen offset:2048
    buffer_load_dwordx4 v[212:215], v8, s[8:11], s17 offen offset:3072
    s_waitcnt vmcnt(3)
    v_mfma_f32_16x16x32_bf16 v[184:187], v[200:203], v[152:155], v[216:219]
    v_mfma_f32_16x16x32_bf16 v[188:191], v[200:203], v[168:171], v[220:223]
    s_waitcnt vmcnt(2)
    v_mfma_f32_16x16x32_bf16 v[192:195], v[204:207], v[152:155], v[216:219]
    v_mfma_f32_16x16x32_bf16 v[196:199], v[204:207], v[168:171], v[220:223]
    s_waitcnt vmcnt(1)
    v_mfma_f32_16x16x32_bf16 v[184:187], v[208:211], v[156:159], v[184:187]
    v_mfma_f32_16x16x32_bf16 v[188:191], v[208:211], v[172:175], v[188:191]
    s_waitcnt vmcnt(0)
    v_mfma_f32_16x16x32_bf16 v[192:195], v[212:215], v[156:159], v[192:195]
    v_mfma_f32_16x16x32_bf16 v[196:199], v[212:215], v[172:175], v[196:199]
    s_mov_b32 s17, 0x5000
    buffer_load_dwordx4 v[200:203], v8, s[8:11], s17 offen offset:0
    buffer_load_dwordx4 v[204:207], v8, s[8:11], s17 offen offset:1024
    buffer_load_dwordx4 v[208:211], v8, s[8:11], s17 offen offset:2048
    buffer_load_dwordx4 v[212:215], v8, s[8:11], s17 offen offset:3072
    s_waitcnt vmcnt(3)
    v_mfma_f32_16x16x32_bf16 v[184:187], v[200:203], v[160:163], v[184:187]
    v_mfma_f32_16x16x32_bf16 v[188:191], v[200:203], v[176:179], v[188:191]
    s_waitcnt vmcnt(2)
    v_mfma_f32_16x16x32_bf16 v[192:195], v[204:207], v[160:163], v[192:195]
    v_mfma_f32_16x16x32_bf16 v[196:199], v[204:207], v[176:179], v[196:199]
    s_waitcnt vmcnt(1)
    v_mfma_f32_16x16x32_bf16 v[184:187], v[208:211], v[164:167], v[184:187]
    v_mfma_f32_16x16x32_bf16 v[188:191], v[208:211], v[180:183], v[188:191]
    s_waitcnt vmcnt(0)
    v_mfma_f32_16x16x32_bf16 v[192:195], v[212:215], v[164:167], v[192:195]
    v_mfma_f32_16x16x32_bf16 v[196:199], v[212:215], v[180:183], v[196:199]
    s_nop 3
    v_exp_f32 v184, v184
    v_exp_f32 v185, v185
    v_add_f32 v9, v9, v184
    v_add_f32 v9, v9, v185
    v_cvt_pk_bf16_f32 v40, v184, v185
    v_exp_f32 v186, v186
    v_exp_f32 v187, v187
    v_add_f32 v9, v9, v186
    v_add_f32 v9, v9, v187
    v_cvt_pk_bf16_f32 v41, v186, v187
    v_exp_f32 v188, v188
    v_exp_f32 v189, v189
    v_add_f32 v10, v10, v188
    v_add_f32 v10, v10, v189
    v_cvt_pk_bf16_f32 v44, v188, v189
    v_exp_f32 v190, v190
    v_exp_f32 v191, v191
    v_add_f32 v10, v10, v190
    v_add_f32 v10, v10, v191
    v_cvt_pk_bf16_f32 v45, v190, v191
    v_exp_f32 v192, v192
    v_exp_f32 v193, v193
    v_add_f32 v9, v9, v192
    v_add_f32 v9, v9, v193
    v_cvt_pk_bf16_f32 v42, v192, v193
    v_exp_f32 v194, v194
    v_exp_f32 v195, v195
    v_add_f32 v9, v9, v194
    v_add_f32 v9, v9, v195
    v_cvt_pk_bf16_f32 v43, v194, v195
    v_exp_f32 v196, v196
    v_exp_f32 v197, v197
    v_add_f32 v10, v10, v196
    v_add_f32 v10, v10, v197
    v_cvt_pk_bf16_f32 v46, v196, v197
    v_exp_f32 v198, v198
    v_exp_f32 v199, v199
    v_add_f32 v10, v10, v198
    v_add_f32 v10, v10, v199
    v_cvt_pk_bf16_f32 v47, v198, v199
    s_mov_b32 s17, 0x6000
    buffer_load_dwordx4 v[200:203], v8, s[8:11], s17 offen offset:0
    buffer_load_dwordx4 v[204:207], v8, s[8:11], s17 offen offset:1024
    buffer_load_dwordx4 v[208:211], v8, s[8:11], s17 offen offset:2048
    buffer_load_dwordx4 v[212:215], v8, s[8:11], s17 offen offset:3072
    s_waitcnt vmcnt(3)
    v_mfma_f32_16x16x32_bf16 v[184:187], v[200:203], v[152:155], v[216:219]
    v_mfma_f32_16x16x32_bf16 v[188:191], v[200:203], v[168:171], v[220:223]
    s_waitcnt vmcnt(2)
    v_mfma_f32_16x16x32_bf16 v[192:195], v[204:207], v[152:155], v[216:219]
    v_mfma_f32_16x16x32_bf16 v[196:199], v[204:207], v[168:171], v[220:223]
    s_waitcnt vmcnt(1)
    v_mfma_f32_16x16x32_bf16 v[184:187], v[208:211], v[156:159], v[184:187]
    v_mfma_f32_16x16x32_bf16 v[188:191], v[208:211], v[172:175], v[188:191]
    s_waitcnt vmcnt(0)
    v_mfma_f32_16x16x32_bf16 v[192:195], v[212:215], v[156:159], v[192:195]
    v_mfma_f32_16x16x32_bf16 v[196:199], v[212:215], v[172:175], v[196:199]
    s_mov_b32 s17, 0x7000
    buffer_load_dwordx4 v[200:203], v8, s[8:11], s17 offen offset:0
    buffer_load_dwordx4 v[204:207], v8, s[8:11], s17 offen offset:1024
    buffer_load_dwordx4 v[208:211], v8, s[8:11], s17 offen offset:2048
    buffer_load_dwordx4 v[212:215], v8, s[8:11], s17 offen offset:3072
    s_waitcnt vmcnt(3)
    v_mfma_f32_16x16x32_bf16 v[184:187], v[200:203], v[160:163], v[184:187]
    v_mfma_f32_16x16x32_bf16 v[188:191], v[200:203], v[176:179], v[188:191]
    s_waitcnt vmcnt(2)
    v_mfma_f32_16x16x32_bf16 v[192:195], v[204:207], v[160:163], v[192:195]
    v_mfma_f32_16x16x32_bf16 v[196:199], v[204:207], v[176:179], v[196:199]
    s_waitcnt vmcnt(1)
    v_mfma_f32_16x16x32_bf16 v[184:187], v[208:211], v[164:167], v[184:187]
    v_mfma_f32_16x16x32_bf16 v[188:191], v[208:211], v[180:183], v[188:191]
    s_waitcnt vmcnt(0)
    v_mfma_f32_16x16x32_bf16 v[192:195], v[212:215], v[164:167], v[192:195]
    v_mfma_f32_16x16x32_bf16 v[196:199], v[212:215], v[180:183], v[196:199]
    s_nop 3
    v_exp_f32 v184, v184
    v_exp_f32 v185, v185
    v_add_f32 v9, v9, v184
    v_add_f32 v9, v9, v185
    v_cvt_pk_bf16_f32 v48, v184, v185
    v_exp_f32 v186, v186
    v_exp_f32 v187, v187
    v_add_f32 v9, v9, v186
    v_add_f32 v9, v9, v187
    v_cvt_pk_bf16_f32 v49, v186, v187
    v_exp_f32 v188, v188
    v_exp_f32 v189, v189
    v_add_f32 v10, v10, v188
    v_add_f32 v10, v10, v189
    v_cvt_pk_bf16_f32 v52, v188, v189
    v_exp_f32 v190, v190
    v_exp_f32 v191, v191
    v_add_f32 v10, v10, v190
    v_add_f32 v10, v10, v191
    v_cvt_pk_bf16_f32 v53, v190, v191
    v_exp_f32 v192, v192
    v_exp_f32 v193, v193
    v_add_f32 v9, v9, v192
    v_add_f32 v9, v9, v193
    v_cvt_pk_bf16_f32 v50, v192, v193
    v_exp_f32 v194, v194
    v_exp_f32 v195, v195
    v_add_f32 v9, v9, v194
    v_add_f32 v9, v9, v195
    v_cvt_pk_bf16_f32 v51, v194, v195
    v_exp_f32 v196, v196
    v_exp_f32 v197, v197
    v_add_f32 v10, v10, v196
    v_add_f32 v10, v10, v197
    v_cvt_pk_bf16_f32 v54, v196, v197
    v_exp_f32 v198, v198
    v_exp_f32 v199, v199
    v_add_f32 v10, v10, v198
    v_add_f32 v10, v10, v199
    v_cvt_pk_bf16_f32 v55, v198, v199
    s_mov_b32 s17, 0x8000
    buffer_load_dwordx4 v[200:203], v8, s[8:11], s17 offen offset:0
    buffer_load_dwordx4 v[204:207], v8, s[8:11], s17 offen offset:1024
    buffer_load_dwordx4 v[208:211], v8, s[8:11], s17 offen offset:2048
    buffer_load_dwordx4 v[212:215], v8, s[8:11], s17 offen offset:3072
    s_waitcnt vmcnt(3)
    v_mfma_f32_16x16x32_bf16 v[184:187], v[200:203], v[152:155], v[216:219]
    v_mfma_f32_16x16x32_bf16 v[188:191], v[200:203], v[168:171], v[220:223]
    s_waitcnt vmcnt(2)
    v_mfma_f32_16x16x32_bf16 v[192:195], v[204:207], v[152:155], v[216:219]
    v_mfma_f32_16x16x32_bf16 v[196:199], v[204:207], v[168:171], v[220:223]
    s_waitcnt vmcnt(1)
    v_mfma_f32_16x16x32_bf16 v[184:187], v[208:211], v[156:159], v[184:187]
    v_mfma_f32_16x16x32_bf16 v[188:191], v[208:211], v[172:175], v[188:191]
    s_waitcnt vmcnt(0)
    v_mfma_f32_16x16x32_bf16 v[192:195], v[212:215], v[156:159], v[192:195]
    v_mfma_f32_16x16x32_bf16 v[196:199], v[212:215], v[172:175], v[196:199]
    s_mov_b32 s17, 0x9000
    buffer_load_dwordx4 v[200:203], v8, s[8:11], s17 offen offset:0
    buffer_load_dwordx4 v[204:207], v8, s[8:11], s17 offen offset:1024
    buffer_load_dwordx4 v[208:211], v8, s[8:11], s17 offen offset:2048
    buffer_load_dwordx4 v[212:215], v8, s[8:11], s17 offen offset:3072
    s_waitcnt vmcnt(3)
    v_mfma_f32_16x16x32_bf16 v[184:187], v[200:203], v[160:163], v[184:187]
    v_mfma_f32_16x16x32_bf16 v[188:191], v[200:203], v[176:179], v[188:191]
    s_waitcnt vmcnt(2)
    v_mfma_f32_16x16x32_bf16 v[192:195], v[204:207], v[160:163], v[192:195]
    v_mfma_f32_16x16x32_bf16 v[196:199], v[204:207], v[176:179], v[196:199]
    s_waitcnt vmcnt(1)
    v_mfma_f32_16x16x32_bf16 v[184:187], v[208:211], v[164:167], v[184:187]
    v_mfma_f32_16x16x32_bf16 v[188:191], v[208:211], v[180:183], v[188:191]
    s_waitcnt vmcnt(0)
    v_mfma_f32_16x16x32_bf16 v[192:195], v[212:215], v[164:167], v[192:195]
    v_mfma_f32_16x16x32_bf16 v[196:199], v[212:215], v[180:183], v[196:199]
    s_nop 3
    v_exp_f32 v184, v184
    v_exp_f32 v185, v185
    v_add_f32 v9, v9, v184
    v_add_f32 v9, v9, v185
    v_cvt_pk_bf16_f32 v56, v184, v185
    v_exp_f32 v186, v186
    v_exp_f32 v187, v187
    v_add_f32 v9, v9, v186
    v_add_f32 v9, v9, v187
    v_cvt_pk_bf16_f32 v57, v186, v187
    v_exp_f32 v188, v188
    v_exp_f32 v189, v189
    v_add_f32 v10, v10, v188
    v_add_f32 v10, v10, v189
    v_cvt_pk_bf16_f32 v60, v188, v189
    v_exp_f32 v190, v190
    v_exp_f32 v191, v191
    v_add_f32 v10, v10, v190
    v_add_f32 v10, v10, v191
    v_cvt_pk_bf16_f32 v61, v190, v191
    v_exp_f32 v192, v192
    v_exp_f32 v193, v193
    v_add_f32 v9, v9, v192
    v_add_f32 v9, v9, v193
    v_cvt_pk_bf16_f32 v58, v192, v193
    v_exp_f32 v194, v194
    v_exp_f32 v195, v195
    v_add_f32 v9, v9, v194
    v_add_f32 v9, v9, v195
    v_cvt_pk_bf16_f32 v59, v194, v195
    v_exp_f32 v196, v196
    v_exp_f32 v197, v197
    v_add_f32 v10, v10, v196
    v_add_f32 v10, v10, v197
    v_cvt_pk_bf16_f32 v62, v196, v197
    v_exp_f32 v198, v198
    v_exp_f32 v199, v199
    v_add_f32 v10, v10, v198
    v_add_f32 v10, v10, v199
    v_cvt_pk_bf16_f32 v63, v198, v199
    s_mov_b32 s17, 0xa000
    buffer_load_dwordx4 v[200:203], v8, s[8:11], s17 offen offset:0
    buffer_load_dwordx4 v[204:207], v8, s[8:11], s17 offen offset:1024
    buffer_load_dwordx4 v[208:211], v8, s[8:11], s17 offen offset:2048
    buffer_load_dwordx4 v[212:215], v8, s[8:11], s17 offen offset:3072
    s_waitcnt vmcnt(3)
    v_mfma_f32_16x16x32_bf16 v[184:187], v[200:203], v[152:155], v[216:219]
    v_mfma_f32_16x16x32_bf16 v[188:191], v[200:203], v[168:171], v[220:223]
    s_waitcnt vmcnt(2)
    v_mfma_f32_16x16x32_bf16 v[192:195], v[204:207], v[152:155], v[216:219]
    v_mfma_f32_16x16x32_bf16 v[196:199], v[204:207], v[168:171], v[220:223]
    s_waitcnt vmcnt(1)
    v_mfma_f32_16x16x32_bf16 v[184:187], v[208:211], v[156:159], v[184:187]
    v_mfma_f32_16x16x32_bf16 v[188:191], v[208:211], v[172:175], v[188:191]
    s_waitcnt vmcnt(0)
    v_mfma_f32_16x16x32_bf16 v[192:195], v[212:215], v[156:159], v[192:195]
    v_mfma_f32_16x16x32_bf16 v[196:199], v[212:215], v[172:175], v[196:199]
    s_mov_b32 s17, 0xb000
    buffer_load_dwordx4 v[200:203], v8, s[8:11], s17 offen offset:0
    buffer_load_dwordx4 v[204:207], v8, s[8:11], s17 offen offset:1024
    buffer_load_dwordx4 v[208:211], v8, s[8:11], s17 offen offset:2048
    buffer_load_dwordx4 v[212:215], v8, s[8:11], s17 offen offset:3072
    s_waitcnt vmcnt(3)
    v_mfma_f32_16x16x32_bf16 v[184:187], v[200:203], v[160:163], v[184:187]
    v_mfma_f32_16x16x32_bf16 v[188:191], v[200:203], v[176:179], v[188:191]
    s_waitcnt vmcnt(2)
    v_mfma_f32_16x16x32_bf16 v[192:195], v[204:207], v[160:163], v[192:195]
    v_mfma_f32_16x16x32_bf16 v[196:199], v[204:207], v[176:179], v[196:199]
    s_waitcnt vmcnt(1)
    v_mfma_f32_16x16x32_bf16 v[184:187], v[208:211], v[164:167], v[184:187]
    v_mfma_f32_16x16x32_bf16 v[188:191], v[208:211], v[180:183], v[188:191]
    s_waitcnt vmcnt(0)
    v_mfma_f32_16x16x32_bf16 v[192:195], v[212:215], v[164:167], v[192:195]
    v_mfma_f32_16x16x32_bf16 v[196:199], v[212:215], v[180:183], v[196:199]
    s_nop 3
    v_exp_f32 v184, v184
    v_exp_f32 v185, v185
    v_add_f32 v9, v9, v184
    v_add_f32 v9, v9, v185
    v_cvt_pk_bf16_f32 v64, v184, v185
    v_exp_f32 v186, v186
    v_exp_f32 v187, v187
    v_add_f32 v9, v9, v186
    v_add_f32 v9, v9, v187
    v_cvt_pk_bf16_f32 v65, v186, v187
    v_exp_f32 v188, v188
    v_exp_f32 v189, v189
    v_add_f32 v10, v10, v188
    v_add_f32 v10, v10, v189
    v_cvt_pk_bf16_f32 v68, v188, v189
    v_exp_f32 v190, v190
    v_exp_f32 v191, v191
    v_add_f32 v10, v10, v190
    v_add_f32 v10, v10, v191
    v_cvt_pk_bf16_f32 v69, v190, v191
    v_exp_f32 v192, v192
    v_exp_f32 v193, v193
    v_add_f32 v9, v9, v192
    v_add_f32 v9, v9, v193
    v_cvt_pk_bf16_f32 v66, v192, v193
    v_exp_f32 v194, v194
    v_exp_f32 v195, v195
    v_add_f32 v9, v9, v194
    v_add_f32 v9, v9, v195
    v_cvt_pk_bf16_f32 v67, v194, v195
    v_exp_f32 v196, v196
    v_exp_f32 v197, v197
    v_add_f32 v10, v10, v196
    v_add_f32 v10, v10, v197
    v_cvt_pk_bf16_f32 v70, v196, v197
    v_exp_f32 v198, v198
    v_exp_f32 v199, v199
    v_add_f32 v10, v10, v198
    v_add_f32 v10, v10, v199
    v_cvt_pk_bf16_f32 v71, v198, v199
    s_mov_b32 s17, 0xc000
    buffer_load_dwordx4 v[200:203], v8, s[8:11], s17 offen offset:0
    buffer_load_dwordx4 v[204:207], v8, s[8:11], s17 offen offset:1024
    buffer_load_dwordx4 v[208:211], v8, s[8:11], s17 offen offset:2048
    buffer_load_dwordx4 v[212:215], v8, s[8:11], s17 offen offset:3072
    s_waitcnt vmcnt(3)
    v_mfma_f32_16x16x32_bf16 v[184:187], v[200:203], v[152:155], v[216:219]
    v_mfma_f32_16x16x32_bf16 v[188:191], v[200:203], v[168:171], v[220:223]
    s_waitcnt vmcnt(2)
    v_mfma_f32_16x16x32_bf16 v[192:195], v[204:207], v[152:155], v[216:219]
    v_mfma_f32_16x16x32_bf16 v[196:199], v[204:207], v[168:171], v[220:223]
    s_waitcnt vmcnt(1)
    v_mfma_f32_16x16x32_bf16 v[184:187], v[208:211], v[156:159], v[184:187]
    v_mfma_f32_16x16x32_bf16 v[188:191], v[208:211], v[172:175], v[188:191]
    s_waitcnt vmcnt(0)
    v_mfma_f32_16x16x32_bf16 v[192:195], v[212:215], v[156:159], v[192:195]
    v_mfma_f32_16x16x32_bf16 v[196:199], v[212:215], v[172:175], v[196:199]
    s_mov_b32 s17, 0xd000
    buffer_load_dwordx4 v[200:203], v8, s[8:11], s17 offen offset:0
    buffer_load_dwordx4 v[204:207], v8, s[8:11], s17 offen offset:1024
    buffer_load_dwordx4 v[208:211], v8, s[8:11], s17 offen offset:2048
    buffer_load_dwordx4 v[212:215], v8, s[8:11], s17 offen offset:3072
    s_waitcnt vmcnt(3)
    v_mfma_f32_16x16x32_bf16 v[184:187], v[200:203], v[160:163], v[184:187]
    v_mfma_f32_16x16x32_bf16 v[188:191], v[200:203], v[176:179], v[188:191]
    s_waitcnt vmcnt(2)
    v_mfma_f32_16x16x32_bf16 v[192:195], v[204:207], v[160:163], v[192:195]
    v_mfma_f32_16x16x32_bf16 v[196:199], v[204:207], v[176:179], v[196:199]
    s_waitcnt vmcnt(1)
    v_mfma_f32_16x16x32_bf16 v[184:187], v[208:211], v[164:167], v[184:187]
    v_mfma_f32_16x16x32_bf16 v[188:191], v[208:211], v[180:183], v[188:191]
    s_waitcnt vmcnt(0)
    v_mfma_f32_16x16x32_bf16 v[192:195], v[212:215], v[164:167], v[192:195]
    v_mfma_f32_16x16x32_bf16 v[196:199], v[212:215], v[180:183], v[196:199]
    s_nop 3
    v_exp_f32 v184, v184
    v_exp_f32 v185, v185
    v_add_f32 v9, v9, v184
    v_add_f32 v9, v9, v185
    v_cvt_pk_bf16_f32 v72, v184, v185
    v_exp_f32 v186, v186
    v_exp_f32 v187, v187
    v_add_f32 v9, v9, v186
    v_add_f32 v9, v9, v187
    v_cvt_pk_bf16_f32 v73, v186, v187
    v_exp_f32 v188, v188
    v_exp_f32 v189, v189
    v_add_f32 v10, v10, v188
    v_add_f32 v10, v10, v189
    v_cvt_pk_bf16_f32 v76, v188, v189
    v_exp_f32 v190, v190
    v_exp_f32 v191, v191
    v_add_f32 v10, v10, v190
    v_add_f32 v10, v10, v191
    v_cvt_pk_bf16_f32 v77, v190, v191
    v_exp_f32 v192, v192
    v_exp_f32 v193, v193
    v_add_f32 v9, v9, v192
    v_add_f32 v9, v9, v193
    v_cvt_pk_bf16_f32 v74, v192, v193
    v_exp_f32 v194, v194
    v_exp_f32 v195, v195
    v_add_f32 v9, v9, v194
    v_add_f32 v9, v9, v195
    v_cvt_pk_bf16_f32 v75, v194, v195
    v_exp_f32 v196, v196
    v_exp_f32 v197, v197
    v_add_f32 v10, v10, v196
    v_add_f32 v10, v10, v197
    v_cvt_pk_bf16_f32 v78, v196, v197
    v_exp_f32 v198, v198
    v_exp_f32 v199, v199
    v_add_f32 v10, v10, v198
    v_add_f32 v10, v10, v199
    v_cvt_pk_bf16_f32 v79, v198, v199
    s_mov_b32 s17, 0xe000
    buffer_load_dwordx4 v[200:203], v8, s[8:11], s17 offen offset:0
    buffer_load_dwordx4 v[204:207], v8, s[8:11], s17 offen offset:1024
    buffer_load_dwordx4 v[208:211], v8, s[8:11], s17 offen offset:2048
    buffer_load_dwordx4 v[212:215], v8, s[8:11], s17 offen offset:3072
    s_waitcnt vmcnt(3)
    v_mfma_f32_16x16x32_bf16 v[184:187], v[200:203], v[152:155], v[216:219]
    v_mfma_f32_16x16x32_bf16 v[188:191], v[200:203], v[168:171], v[220:223]
    s_waitcnt vmcnt(2)
    v_mfma_f32_16x16x32_bf16 v[192:195], v[204:207], v[152:155], v[216:219]
    v_mfma_f32_16x16x32_bf16 v[196:199], v[204:207], v[168:171], v[220:223]
    s_waitcnt vmcnt(1)
    v_mfma_f32_16x16x32_bf16 v[184:187], v[208:211], v[156:159], v[184:187]
    v_mfma_f32_16x16x32_bf16 v[188:191], v[208:211], v[172:175], v[188:191]
    s_waitcnt vmcnt(0)
    v_mfma_f32_16x16x32_bf16 v[192:195], v[212:215], v[156:159], v[192:195]
    v_mfma_f32_16x16x32_bf16 v[196:199], v[212:215], v[172:175], v[196:199]
    s_mov_b32 s17, 0xf000
    buffer_load_dwordx4 v[200:203], v8, s[8:11], s17 offen offset:0
    buffer_load_dwordx4 v[204:207], v8, s[8:11], s17 offen offset:1024
    buffer_load_dwordx4 v[208:211], v8, s[8:11], s17 offen offset:2048
    buffer_load_dwordx4 v[212:215], v8, s[8:11], s17 offen offset:3072
    s_waitcnt vmcnt(3)
    v_mfma_f32_16x16x32_bf16 v[184:187], v[200:203], v[160:163], v[184:187]
    v_mfma_f32_16x16x32_bf16 v[188:191], v[200:203], v[176:179], v[188:191]
    s_waitcnt vmcnt(2)
    v_mfma_f32_16x16x32_bf16 v[192:195], v[204:207], v[160:163], v[192:195]
    v_mfma_f32_16x16x32_bf16 v[196:199], v[204:207], v[176:179], v[196:199]
    s_waitcnt vmcnt(1)
    v_mfma_f32_16x16x32_bf16 v[184:187], v[208:211], v[164:167], v[184:187]
    v_mfma_f32_16x16x32_bf16 v[188:191], v[208:211], v[180:183], v[188:191]
    s_waitcnt vmcnt(0)
    v_mfma_f32_16x16x32_bf16 v[192:195], v[212:215], v[164:167], v[192:195]
    v_mfma_f32_16x16x32_bf16 v[196:199], v[212:215], v[180:183], v[196:199]
    s_nop 3
    v_exp_f32 v184, v184
    v_exp_f32 v185, v185
    v_add_f32 v9, v9, v184
    v_add_f32 v9, v9, v185
    v_cvt_pk_bf16_f32 v80, v184, v185
    v_exp_f32 v186, v186
    v_exp_f32 v187, v187
    v_add_f32 v9, v9, v186
    v_add_f32 v9, v9, v187
    v_cvt_pk_bf16_f32 v81, v186, v187
    v_exp_f32 v188, v188
    v_exp_f32 v189, v189
    v_add_f32 v10, v10, v188
    v_add_f32 v10, v10, v189
    v_cvt_pk_bf16_f32 v84, v188, v189
    v_exp_f32 v190, v190
    v_exp_f32 v191, v191
    v_add_f32 v10, v10, v190
    v_add_f32 v10, v10, v191
    v_cvt_pk_bf16_f32 v85, v190, v191
    v_exp_f32 v192, v192
    v_exp_f32 v193, v193
    v_add_f32 v9, v9, v192
    v_add_f32 v9, v9, v193
    v_cvt_pk_bf16_f32 v82, v192, v193
    v_exp_f32 v194, v194
    v_exp_f32 v195, v195
    v_add_f32 v9, v9, v194
    v_add_f32 v9, v9, v195
    v_cvt_pk_bf16_f32 v83, v194, v195
    v_exp_f32 v196, v196
    v_exp_f32 v197, v197
    v_add_f32 v10, v10, v196
    v_add_f32 v10, v10, v197
    v_cvt_pk_bf16_f32 v86, v196, v197
    v_exp_f32 v198, v198
    v_exp_f32 v199, v199
    v_add_f32 v10, v10, v198
    v_add_f32 v10, v10, v199
    v_cvt_pk_bf16_f32 v87, v198, v199
    s_mov_b32 s17, 0x10000
    buffer_load_dwordx4 v[200:203], v8, s[8:11], s17 offen offset:0
    buffer_load_dwordx4 v[204:207], v8, s[8:11], s17 offen offset:1024
    buffer_load_dwordx4 v[208:211], v8, s[8:11], s17 offen offset:2048
    buffer_load_dwordx4 v[212:215], v8, s[8:11], s17 offen offset:3072
    s_waitcnt vmcnt(3)
    v_mfma_f32_16x16x32_bf16 v[184:187], v[200:203], v[152:155], v[216:219]
    v_mfma_f32_16x16x32_bf16 v[188:191], v[200:203], v[168:171], v[220:223]
    s_waitcnt vmcnt(2)
    v_mfma_f32_16x16x32_bf16 v[192:195], v[204:207], v[152:155], v[216:219]
    v_mfma_f32_16x16x32_bf16 v[196:199], v[204:207], v[168:171], v[220:223]
    s_waitcnt vmcnt(1)
    v_mfma_f32_16x16x32_bf16 v[184:187], v[208:211], v[156:159], v[184:187]
    v_mfma_f32_16x16x32_bf16 v[188:191], v[208:211], v[172:175], v[188:191]
    s_waitcnt vmcnt(0)
    v_mfma_f32_16x16x32_bf16 v[192:195], v[212:215], v[156:159], v[192:195]
    v_mfma_f32_16x16x32_bf16 v[196:199], v[212:215], v[172:175], v[196:199]
    s_mov_b32 s17, 0x11000
    buffer_load_dwordx4 v[200:203], v8, s[8:11], s17 offen offset:0
    buffer_load_dwordx4 v[204:207], v8, s[8:11], s17 offen offset:1024
    buffer_load_dwordx4 v[208:211], v8, s[8:11], s17 offen offset:2048
    buffer_load_dwordx4 v[212:215], v8, s[8:11], s17 offen offset:3072
    s_waitcnt vmcnt(3)
    v_mfma_f32_16x16x32_bf16 v[184:187], v[200:203], v[160:163], v[184:187]
    v_mfma_f32_16x16x32_bf16 v[188:191], v[200:203], v[176:179], v[188:191]
    s_waitcnt vmcnt(2)
    v_mfma_f32_16x16x32_bf16 v[192:195], v[204:207], v[160:163], v[192:195]
    v_mfma_f32_16x16x32_bf16 v[196:199], v[204:207], v[176:179], v[196:199]
    s_waitcnt vmcnt(1)
    v_mfma_f32_16x16x32_bf16 v[184:187], v[208:211], v[164:167], v[184:187]
    v_mfma_f32_16x16x32_bf16 v[188:191], v[208:211], v[180:183], v[188:191]
    s_waitcnt vmcnt(0)
    v_mfma_f32_16x16x32_bf16 v[192:195], v[212:215], v[164:167], v[192:195]
    v_mfma_f32_16x16x32_bf16 v[196:199], v[212:215], v[180:183], v[196:199]
    s_nop 3
    v_exp_f32 v184, v184
    v_exp_f32 v185, v185
    v_add_f32 v9, v9, v184
    v_add_f32 v9, v9, v185
    v_cvt_pk_bf16_f32 v88, v184, v185
    v_exp_f32 v186, v186
    v_exp_f32 v187, v187
    v_add_f32 v9, v9, v186
    v_add_f32 v9, v9, v187
    v_cvt_pk_bf16_f32 v89, v186, v187
    v_exp_f32 v188, v188
    v_exp_f32 v189, v189
    v_add_f32 v10, v10, v188
    v_add_f32 v10, v10, v189
    v_cvt_pk_bf16_f32 v92, v188, v189
    v_exp_f32 v190, v190
    v_exp_f32 v191, v191
    v_add_f32 v10, v10, v190
    v_add_f32 v10, v10, v191
    v_cvt_pk_bf16_f32 v93, v190, v191
    v_exp_f32 v192, v192
    v_exp_f32 v193, v193
    v_add_f32 v9, v9, v192
    v_add_f32 v9, v9, v193
    v_cvt_pk_bf16_f32 v90, v192, v193
    v_exp_f32 v194, v194
    v_exp_f32 v195, v195
    v_add_f32 v9, v9, v194
    v_add_f32 v9, v9, v195
    v_cvt_pk_bf16_f32 v91, v194, v195
    v_exp_f32 v196, v196
    v_exp_f32 v197, v197
    v_add_f32 v10, v10, v196
    v_add_f32 v10, v10, v197
    v_cvt_pk_bf16_f32 v94, v196, v197
    v_exp_f32 v198, v198
    v_exp_f32 v199, v199
    v_add_f32 v10, v10, v198
    v_add_f32 v10, v10, v199
    v_cvt_pk_bf16_f32 v95, v198, v199
    s_mov_b32 s17, 0x12000
    buffer_load_dwordx4 v[200:203], v8, s[8:11], s17 offen offset:0
    buffer_load_dwordx4 v[204:207], v8, s[8:11], s17 offen offset:1024
    buffer_load_dwordx4 v[208:211], v8, s[8:11], s17 offen offset:2048
    buffer_load_dwordx4 v[212:215], v8, s[8:11], s17 offen offset:3072
    s_waitcnt vmcnt(3)
    v_mfma_f32_16x16x32_bf16 v[184:187], v[200:203], v[152:155], v[216:219]
    v_mfma_f32_16x16x32_bf16 v[188:191], v[200:203], v[168:171], v[220:223]
    s_waitcnt vmcnt(2)
    v_mfma_f32_16x16x32_bf16 v[192:195], v[204:207], v[152:155], v[216:219]
    v_mfma_f32_16x16x32_bf16 v[196:199], v[204:207], v[168:171], v[220:223]
    s_waitcnt vmcnt(1)
    v_mfma_f32_16x16x32_bf16 v[184:187], v[208:211], v[156:159], v[184:187]
    v_mfma_f32_16x16x32_bf16 v[188:191], v[208:211], v[172:175], v[188:191]
    s_waitcnt vmcnt(0)
    v_mfma_f32_16x16x32_bf16 v[192:195], v[212:215], v[156:159], v[192:195]
    v_mfma_f32_16x16x32_bf16 v[196:199], v[212:215], v[172:175], v[196:199]
    s_mov_b32 s17, 0x13000
    buffer_load_dwordx4 v[200:203], v8, s[8:11], s17 offen offset:0
    buffer_load_dwordx4 v[204:207], v8, s[8:11], s17 offen offset:1024
    buffer_load_dwordx4 v[208:211], v8, s[8:11], s17 offen offset:2048
    buffer_load_dwordx4 v[212:215], v8, s[8:11], s17 offen offset:3072
    s_waitcnt vmcnt(3)
    v_mfma_f32_16x16x32_bf16 v[184:187], v[200:203], v[160:163], v[184:187]
    v_mfma_f32_16x16x32_bf16 v[188:191], v[200:203], v[176:179], v[188:191]
    s_waitcnt vmcnt(2)
    v_mfma_f32_16x16x32_bf16 v[192:195], v[204:207], v[160:163], v[192:195]
    v_mfma_f32_16x16x32_bf16 v[196:199], v[204:207], v[176:179], v[196:199]
    s_waitcnt vmcnt(1)
    v_mfma_f32_16x16x32_bf16 v[184:187], v[208:211], v[164:167], v[184:187]
    v_mfma_f32_16x16x32_bf16 v[188:191], v[208:211], v[180:183], v[188:191]
    s_waitcnt vmcnt(0)
    v_mfma_f32_16x16x32_bf16 v[192:195], v[212:215], v[164:167], v[192:195]
    v_mfma_f32_16x16x32_bf16 v[196:199], v[212:215], v[180:183], v[196:199]
    s_nop 3
    v_exp_f32 v184, v184
    v_exp_f32 v185, v185
    v_add_f32 v9, v9, v184
    v_add_f32 v9, v9, v185
    v_cvt_pk_bf16_f32 v96, v184, v185
    v_exp_f32 v186, v186
    v_exp_f32 v187, v187
    v_add_f32 v9, v9, v186
    v_add_f32 v9, v9, v187
    v_cvt_pk_bf16_f32 v97, v186, v187
    v_exp_f32 v188, v188
    v_exp_f32 v189, v189
    v_add_f32 v10, v10, v188
    v_add_f32 v10, v10, v189
    v_cvt_pk_bf16_f32 v100, v188, v189
    v_exp_f32 v190, v190
    v_exp_f32 v191, v191
    v_add_f32 v10, v10, v190
    v_add_f32 v10, v10, v191
    v_cvt_pk_bf16_f32 v101, v190, v191
    v_exp_f32 v192, v192
    v_exp_f32 v193, v193
    v_add_f32 v9, v9, v192
    v_add_f32 v9, v9, v193
    v_cvt_pk_bf16_f32 v98, v192, v193
    v_exp_f32 v194, v194
    v_exp_f32 v195, v195
    v_add_f32 v9, v9, v194
    v_add_f32 v9, v9, v195
    v_cvt_pk_bf16_f32 v99, v194, v195
    v_exp_f32 v196, v196
    v_exp_f32 v197, v197
    v_add_f32 v10, v10, v196
    v_add_f32 v10, v10, v197
    v_cvt_pk_bf16_f32 v102, v196, v197
    v_exp_f32 v198, v198
    v_exp_f32 v199, v199
    v_add_f32 v10, v10, v198
    v_add_f32 v10, v10, v199
    v_cvt_pk_bf16_f32 v103, v198, v199
    s_mov_b32 s17, 0x14000
    buffer_load_dwordx4 v[200:203], v8, s[8:11], s17 offen offset:0
    buffer_load_dwordx4 v[204:207], v8, s[8:11], s17 offen offset:1024
    buffer_load_dwordx4 v[208:211], v8, s[8:11], s17 offen offset:2048
    buffer_load_dwordx4 v[212:215], v8, s[8:11], s17 offen offset:3072
    s_waitcnt vmcnt(3)
    v_mfma_f32_16x16x32_bf16 v[184:187], v[200:203], v[152:155], v[216:219]
    v_mfma_f32_16x16x32_bf16 v[188:191], v[200:203], v[168:171], v[220:223]
    s_waitcnt vmcnt(2)
    v_mfma_f32_16x16x32_bf16 v[192:195], v[204:207], v[152:155], v[216:219]
    v_mfma_f32_16x16x32_bf16 v[196:199], v[204:207], v[168:171], v[220:223]
    s_waitcnt vmcnt(1)
    v_mfma_f32_16x16x32_bf16 v[184:187], v[208:211], v[156:159], v[184:187]
    v_mfma_f32_16x16x32_bf16 v[188:191], v[208:211], v[172:175], v[188:191]
    s_waitcnt vmcnt(0)
    v_mfma_f32_16x16x32_bf16 v[192:195], v[212:215], v[156:159], v[192:195]
    v_mfma_f32_16x16x32_bf16 v[196:199], v[212:215], v[172:175], v[196:199]
    s_mov_b32 s17, 0x15000
    buffer_load_dwordx4 v[200:203], v8, s[8:11], s17 offen offset:0
    buffer_load_dwordx4 v[204:207], v8, s[8:11], s17 offen offset:1024
    buffer_load_dwordx4 v[208:211], v8, s[8:11], s17 offen offset:2048
    buffer_load_dwordx4 v[212:215], v8, s[8:11], s17 offen offset:3072
    s_waitcnt vmcnt(3)
    v_mfma_f32_16x16x32_bf16 v[184:187], v[200:203], v[160:163], v[184:187]
    v_mfma_f32_16x16x32_bf16 v[188:191], v[200:203], v[176:179], v[188:191]
    s_waitcnt vmcnt(2)
    v_mfma_f32_16x16x32_bf16 v[192:195], v[204:207], v[160:163], v[192:195]
    v_mfma_f32_16x16x32_bf16 v[196:199], v[204:207], v[176:179], v[196:199]
    s_waitcnt vmcnt(1)
    v_mfma_f32_16x16x32_bf16 v[184:187], v[208:211], v[164:167], v[184:187]
    v_mfma_f32_16x16x32_bf16 v[188:191], v[208:211], v[180:183], v[188:191]
    s_waitcnt vmcnt(0)
    v_mfma_f32_16x16x32_bf16 v[192:195], v[212:215], v[164:167], v[192:195]
    v_mfma_f32_16x16x32_bf16 v[196:199], v[212:215], v[180:183], v[196:199]
    s_nop 3
    v_exp_f32 v184, v184
    v_exp_f32 v185, v185
    v_add_f32 v9, v9, v184
    v_add_f32 v9, v9, v185
    v_cvt_pk_bf16_f32 v104, v184, v185
    v_exp_f32 v186, v186
    v_exp_f32 v187, v187
    v_add_f32 v9, v9, v186
    v_add_f32 v9, v9, v187
    v_cvt_pk_bf16_f32 v105, v186, v187
    v_exp_f32 v188, v188
    v_exp_f32 v189, v189
    v_add_f32 v10, v10, v188
    v_add_f32 v10, v10, v189
    v_cvt_pk_bf16_f32 v108, v188, v189
    v_exp_f32 v190, v190
    v_exp_f32 v191, v191
    v_add_f32 v10, v10, v190
    v_add_f32 v10, v10, v191
    v_cvt_pk_bf16_f32 v109, v190, v191
    v_exp_f32 v192, v192
    v_exp_f32 v193, v193
    v_add_f32 v9, v9, v192
    v_add_f32 v9, v9, v193
    v_cvt_pk_bf16_f32 v106, v192, v193
    v_exp_f32 v194, v194
    v_exp_f32 v195, v195
    v_add_f32 v9, v9, v194
    v_add_f32 v9, v9, v195
    v_cvt_pk_bf16_f32 v107, v194, v195
    v_exp_f32 v196, v196
    v_exp_f32 v197, v197
    v_add_f32 v10, v10, v196
    v_add_f32 v10, v10, v197
    v_cvt_pk_bf16_f32 v110, v196, v197
    v_exp_f32 v198, v198
    v_exp_f32 v199, v199
    v_add_f32 v10, v10, v198
    v_add_f32 v10, v10, v199
    v_cvt_pk_bf16_f32 v111, v198, v199
    s_mov_b32 s17, 0x16000
    buffer_load_dwordx4 v[200:203], v8, s[8:11], s17 offen offset:0
    buffer_load_dwordx4 v[204:207], v8, s[8:11], s17 offen offset:1024
    buffer_load_dwordx4 v[208:211], v8, s[8:11], s17 offen offset:2048
    buffer_load_dwordx4 v[212:215], v8, s[8:11], s17 offen offset:3072
    s_waitcnt vmcnt(3)
    v_mfma_f32_16x16x32_bf16 v[184:187], v[200:203], v[152:155], v[216:219]
    v_mfma_f32_16x16x32_bf16 v[188:191], v[200:203], v[168:171], v[220:223]
    s_waitcnt vmcnt(2)
    v_mfma_f32_16x16x32_bf16 v[192:195], v[204:207], v[152:155], v[216:219]
    v_mfma_f32_16x16x32_bf16 v[196:199], v[204:207], v[168:171], v[220:223]
    s_waitcnt vmcnt(1)
    v_mfma_f32_16x16x32_bf16 v[184:187], v[208:211], v[156:159], v[184:187]
    v_mfma_f32_16x16x32_bf16 v[188:191], v[208:211], v[172:175], v[188:191]
    s_waitcnt vmcnt(0)
    v_mfma_f32_16x16x32_bf16 v[192:195], v[212:215], v[156:159], v[192:195]
    v_mfma_f32_16x16x32_bf16 v[196:199], v[212:215], v[172:175], v[196:199]
    s_mov_b32 s17, 0x17000
    buffer_load_dwordx4 v[200:203], v8, s[8:11], s17 offen offset:0
    buffer_load_dwordx4 v[204:207], v8, s[8:11], s17 offen offset:1024
    buffer_load_dwordx4 v[208:211], v8, s[8:11], s17 offen offset:2048
    buffer_load_dwordx4 v[212:215], v8, s[8:11], s17 offen offset:3072
    s_waitcnt vmcnt(3)
    v_mfma_f32_16x16x32_bf16 v[184:187], v[200:203], v[160:163], v[184:187]
    v_mfma_f32_16x16x32_bf16 v[188:191], v[200:203], v[176:179], v[188:191]
    s_waitcnt vmcnt(2)
    v_mfma_f32_16x16x32_bf16 v[192:195], v[204:207], v[160:163], v[192:195]
    v_mfma_f32_16x16x32_bf16 v[196:199], v[204:207], v[176:179], v[196:199]
    s_waitcnt vmcnt(1)
    v_mfma_f32_16x16x32_bf16 v[184:187], v[208:211], v[164:167], v[184:187]
    v_mfma_f32_16x16x32_bf16 v[188:191], v[208:211], v[180:183], v[188:191]
    s_waitcnt vmcnt(0)
    v_mfma_f32_16x16x32_bf16 v[192:195], v[212:215], v[164:167], v[192:195]
    v_mfma_f32_16x16x32_bf16 v[196:199], v[212:215], v[180:183], v[196:199]
    s_nop 3
    v_exp_f32 v184, v184
    v_exp_f32 v185, v185
    v_add_f32 v9, v9, v184
    v_add_f32 v9, v9, v185
    v_cvt_pk_bf16_f32 v112, v184, v185
    v_exp_f32 v186, v186
    v_exp_f32 v187, v187
    v_add_f32 v9, v9, v186
    v_add_f32 v9, v9, v187
    v_cvt_pk_bf16_f32 v113, v186, v187
    v_exp_f32 v188, v188
    v_exp_f32 v189, v189
    v_add_f32 v10, v10, v188
    v_add_f32 v10, v10, v189
    v_cvt_pk_bf16_f32 v116, v188, v189
    v_exp_f32 v190, v190
    v_exp_f32 v191, v191
    v_add_f32 v10, v10, v190
    v_add_f32 v10, v10, v191
    v_cvt_pk_bf16_f32 v117, v190, v191
    v_exp_f32 v192, v192
    v_exp_f32 v193, v193
    v_add_f32 v9, v9, v192
    v_add_f32 v9, v9, v193
    v_cvt_pk_bf16_f32 v114, v192, v193
    v_exp_f32 v194, v194
    v_exp_f32 v195, v195
    v_add_f32 v9, v9, v194
    v_add_f32 v9, v9, v195
    v_cvt_pk_bf16_f32 v115, v194, v195
    v_exp_f32 v196, v196
    v_exp_f32 v197, v197
    v_add_f32 v10, v10, v196
    v_add_f32 v10, v10, v197
    v_cvt_pk_bf16_f32 v118, v196, v197
    v_exp_f32 v198, v198
    v_exp_f32 v199, v199
    v_add_f32 v10, v10, v198
    v_add_f32 v10, v10, v199
    v_cvt_pk_bf16_f32 v119, v198, v199
    s_mov_b32 s17, 0x18000
    buffer_load_dwordx4 v[200:203], v8, s[8:11], s17 offen offset:0
    buffer_load_dwordx4 v[204:207], v8, s[8:11], s17 offen offset:1024
    buffer_load_dwordx4 v[208:211], v8, s[8:11], s17 offen offset:2048
    buffer_load_dwordx4 v[212:215], v8, s[8:11], s17 offen offset:3072
    s_waitcnt vmcnt(3)
    v_mfma_f32_16x16x32_bf16 v[184:187], v[200:203], v[152:155], v[216:219]
    v_mfma_f32_16x16x32_bf16 v[188:191], v[200:203], v[168:171], v[220:223]
    s_waitcnt vmcnt(2)
    v_mfma_f32_16x16x32_bf16 v[192:195], v[204:207], v[152:155], v[216:219]
    v_mfma_f32_16x16x32_bf16 v[196:199], v[204:207], v[168:171], v[220:223]
    s_waitcnt vmcnt(1)
    v_mfma_f32_16x16x32_bf16 v[184:187], v[208:211], v[156:159], v[184:187]
    v_mfma_f32_16x16x32_bf16 v[188:191], v[208:211], v[172:175], v[188:191]
    s_waitcnt vmcnt(0)
    v_mfma_f32_16x16x32_bf16 v[192:195], v[212:215], v[156:159], v[192:195]
    v_mfma_f32_16x16x32_bf16 v[196:199], v[212:215], v[172:175], v[196:199]
    s_mov_b32 s17, 0x19000
    buffer_load_dwordx4 v[200:203], v8, s[8:11], s17 offen offset:0
    buffer_load_dwordx4 v[204:207], v8, s[8:11], s17 offen offset:1024
    buffer_load_dwordx4 v[208:211], v8, s[8:11], s17 offen offset:2048
    buffer_load_dwordx4 v[212:215], v8, s[8:11], s17 offen offset:3072
    s_waitcnt vmcnt(3)
    v_mfma_f32_16x16x32_bf16 v[184:187], v[200:203], v[160:163], v[184:187]
    v_mfma_f32_16x16x32_bf16 v[188:191], v[200:203], v[176:179], v[188:191]
    s_waitcnt vmcnt(2)
    v_mfma_f32_16x16x32_bf16 v[192:195], v[204:207], v[160:163], v[192:195]
    v_mfma_f32_16x16x32_bf16 v[196:199], v[204:207], v[176:179], v[196:199]
    s_waitcnt vmcnt(1)
    v_mfma_f32_16x16x32_bf16 v[184:187], v[208:211], v[164:167], v[184:187]
    v_mfma_f32_16x16x32_bf16 v[188:191], v[208:211], v[180:183], v[188:191]
    s_waitcnt vmcnt(0)
    v_mfma_f32_16x16x32_bf16 v[192:195], v[212:215], v[164:167], v[192:195]
    v_mfma_f32_16x16x32_bf16 v[196:199], v[212:215], v[180:183], v[196:199]
    s_nop 3
    v_exp_f32 v184, v184
    v_exp_f32 v185, v185
    v_add_f32 v9, v9, v184
    v_add_f32 v9, v9, v185
    v_cvt_pk_bf16_f32 v120, v184, v185
    v_exp_f32 v186, v186
    v_exp_f32 v187, v187
    v_add_f32 v9, v9, v186
    v_add_f32 v9, v9, v187
    v_cvt_pk_bf16_f32 v121, v186, v187
    v_exp_f32 v188, v188
    v_exp_f32 v189, v189
    v_add_f32 v10, v10, v188
    v_add_f32 v10, v10, v189
    v_cvt_pk_bf16_f32 v124, v188, v189
    v_exp_f32 v190, v190
    v_exp_f32 v191, v191
    v_add_f32 v10, v10, v190
    v_add_f32 v10, v10, v191
    v_cvt_pk_bf16_f32 v125, v190, v191
    v_exp_f32 v192, v192
    v_exp_f32 v193, v193
    v_add_f32 v9, v9, v192
    v_add_f32 v9, v9, v193
    v_cvt_pk_bf16_f32 v122, v192, v193
    v_exp_f32 v194, v194
    v_exp_f32 v195, v195
    v_add_f32 v9, v9, v194
    v_add_f32 v9, v9, v195
    v_cvt_pk_bf16_f32 v123, v194, v195
    v_exp_f32 v196, v196
    v_exp_f32 v197, v197
    v_add_f32 v10, v10, v196
    v_add_f32 v10, v10, v197
    v_cvt_pk_bf16_f32 v126, v196, v197
    v_exp_f32 v198, v198
    v_exp_f32 v199, v199
    v_add_f32 v10, v10, v198
    v_add_f32 v10, v10, v199
    v_cvt_pk_bf16_f32 v127, v198, v199
    s_mov_b32 s17, 0x1a000
    buffer_load_dwordx4 v[200:203], v8, s[8:11], s17 offen offset:0
    buffer_load_dwordx4 v[204:207], v8, s[8:11], s17 offen offset:1024
    buffer_load_dwordx4 v[208:211], v8, s[8:11], s17 offen offset:2048
    buffer_load_dwordx4 v[212:215], v8, s[8:11], s17 offen offset:3072
    s_waitcnt vmcnt(3)
    v_mfma_f32_16x16x32_bf16 v[184:187], v[200:203], v[152:155], v[216:219]
    v_mfma_f32_16x16x32_bf16 v[188:191], v[200:203], v[168:171], v[220:223]
    s_waitcnt vmcnt(2)
    v_mfma_f32_16x16x32_bf16 v[192:195], v[204:207], v[152:155], v[216:219]
    v_mfma_f32_16x16x32_bf16 v[196:199], v[204:207], v[168:171], v[220:223]
    s_waitcnt vmcnt(1)
    v_mfma_f32_16x16x32_bf16 v[184:187], v[208:211], v[156:159], v[184:187]
    v_mfma_f32_16x16x32_bf16 v[188:191], v[208:211], v[172:175], v[188:191]
    s_waitcnt vmcnt(0)
    v_mfma_f32_16x16x32_bf16 v[192:195], v[212:215], v[156:159], v[192:195]
    v_mfma_f32_16x16x32_bf16 v[196:199], v[212:215], v[172:175], v[196:199]
    s_mov_b32 s17, 0x1b000
    buffer_load_dwordx4 v[200:203], v8, s[8:11], s17 offen offset:0
    buffer_load_dwordx4 v[204:207], v8, s[8:11], s17 offen offset:1024
    buffer_load_dwordx4 v[208:211], v8, s[8:11], s17 offen offset:2048
    buffer_load_dwordx4 v[212:215], v8, s[8:11], s17 offen offset:3072
    s_waitcnt vmcnt(3)
    v_mfma_f32_16x16x32_bf16 v[184:187], v[200:203], v[160:163], v[184:187]
    v_mfma_f32_16x16x32_bf16 v[188:191], v[200:203], v[176:179], v[188:191]
    s_waitcnt vmcnt(2)
    v_mfma_f32_16x16x32_bf16 v[192:195], v[204:207], v[160:163], v[192:195]
    v_mfma_f32_16x16x32_bf16 v[196:199], v[204:207], v[176:179], v[196:199]
    s_waitcnt vmcnt(1)
    v_mfma_f32_16x16x32_bf16 v[184:187], v[208:211], v[164:167], v[184:187]
    v_mfma_f32_16x16x32_bf16 v[188:191], v[208:211], v[180:183], v[188:191]
    s_waitcnt vmcnt(0)
    v_mfma_f32_16x16x32_bf16 v[192:195], v[212:215], v[164:167], v[192:195]
    v_mfma_f32_16x16x32_bf16 v[196:199], v[212:215], v[180:183], v[196:199]
    s_nop 3
    v_exp_f32 v184, v184
    v_exp_f32 v185, v185
    v_add_f32 v9, v9, v184
    v_add_f32 v9, v9, v185
    v_cvt_pk_bf16_f32 v128, v184, v185
    v_exp_f32 v186, v186
    v_exp_f32 v187, v187
    v_add_f32 v9, v9, v186
    v_add_f32 v9, v9, v187
    v_cvt_pk_bf16_f32 v129, v186, v187
    v_exp_f32 v188, v188
    v_exp_f32 v189, v189
    v_add_f32 v10, v10, v188
    v_add_f32 v10, v10, v189
    v_cvt_pk_bf16_f32 v132, v188, v189
    v_exp_f32 v190, v190
    v_exp_f32 v191, v191
    v_add_f32 v10, v10, v190
    v_add_f32 v10, v10, v191
    v_cvt_pk_bf16_f32 v133, v190, v191
    v_exp_f32 v192, v192
    v_exp_f32 v193, v193
    v_add_f32 v9, v9, v192
    v_add_f32 v9, v9, v193
    v_cvt_pk_bf16_f32 v130, v192, v193
    v_exp_f32 v194, v194
    v_exp_f32 v195, v195
    v_add_f32 v9, v9, v194
    v_add_f32 v9, v9, v195
    v_cvt_pk_bf16_f32 v131, v194, v195
    v_exp_f32 v196, v196
    v_exp_f32 v197, v197
    v_add_f32 v10, v10, v196
    v_add_f32 v10, v10, v197
    v_cvt_pk_bf16_f32 v134, v196, v197
    v_exp_f32 v198, v198
    v_exp_f32 v199, v199
    v_add_f32 v10, v10, v198
    v_add_f32 v10, v10, v199
    v_cvt_pk_bf16_f32 v135, v198, v199
    s_mov_b32 s17, 0x1c000
    buffer_load_dwordx4 v[200:203], v8, s[8:11], s17 offen offset:0
    buffer_load_dwordx4 v[204:207], v8, s[8:11], s17 offen offset:1024
    buffer_load_dwordx4 v[208:211], v8, s[8:11], s17 offen offset:2048
    buffer_load_dwordx4 v[212:215], v8, s[8:11], s17 offen offset:3072
    s_waitcnt vmcnt(3)
    v_mfma_f32_16x16x32_bf16 v[184:187], v[200:203], v[152:155], v[216:219]
    v_mfma_f32_16x16x32_bf16 v[188:191], v[200:203], v[168:171], v[220:223]
    s_waitcnt vmcnt(2)
    v_mfma_f32_16x16x32_bf16 v[192:195], v[204:207], v[152:155], v[216:219]
    v_mfma_f32_16x16x32_bf16 v[196:199], v[204:207], v[168:171], v[220:223]
    s_waitcnt vmcnt(1)
    v_mfma_f32_16x16x32_bf16 v[184:187], v[208:211], v[156:159], v[184:187]
    v_mfma_f32_16x16x32_bf16 v[188:191], v[208:211], v[172:175], v[188:191]
    s_waitcnt vmcnt(0)
    v_mfma_f32_16x16x32_bf16 v[192:195], v[212:215], v[156:159], v[192:195]
    v_mfma_f32_16x16x32_bf16 v[196:199], v[212:215], v[172:175], v[196:199]
    s_mov_b32 s17, 0x1d000
    buffer_load_dwordx4 v[200:203], v8, s[8:11], s17 offen offset:0
    buffer_load_dwordx4 v[204:207], v8, s[8:11], s17 offen offset:1024
    buffer_load_dwordx4 v[208:211], v8, s[8:11], s17 offen offset:2048
    buffer_load_dwordx4 v[212:215], v8, s[8:11], s17 offen offset:3072
    s_waitcnt vmcnt(3)
    v_mfma_f32_16x16x32_bf16 v[184:187], v[200:203], v[160:163], v[184:187]
    v_mfma_f32_16x16x32_bf16 v[188:191], v[200:203], v[176:179], v[188:191]
    s_waitcnt vmcnt(2)
    v_mfma_f32_16x16x32_bf16 v[192:195], v[204:207], v[160:163], v[192:195]
    v_mfma_f32_16x16x32_bf16 v[196:199], v[204:207], v[176:179], v[196:199]
    s_waitcnt vmcnt(1)
    v_mfma_f32_16x16x32_bf16 v[184:187], v[208:211], v[164:167], v[184:187]
    v_mfma_f32_16x16x32_bf16 v[188:191], v[208:211], v[180:183], v[188:191]
    s_waitcnt vmcnt(0)
    v_mfma_f32_16x16x32_bf16 v[192:195], v[212:215], v[164:167], v[192:195]
    v_mfma_f32_16x16x32_bf16 v[196:199], v[212:215], v[180:183], v[196:199]
    s_nop 3
    v_exp_f32 v184, v184
    v_exp_f32 v185, v185
    v_add_f32 v9, v9, v184
    v_add_f32 v9, v9, v185
    v_cvt_pk_bf16_f32 v136, v184, v185
    v_exp_f32 v186, v186
    v_exp_f32 v187, v187
    v_add_f32 v9, v9, v186
    v_add_f32 v9, v9, v187
    v_cvt_pk_bf16_f32 v137, v186, v187
    v_exp_f32 v188, v188
    v_exp_f32 v189, v189
    v_add_f32 v10, v10, v188
    v_add_f32 v10, v10, v189
    v_cvt_pk_bf16_f32 v140, v188, v189
    v_exp_f32 v190, v190
    v_exp_f32 v191, v191
    v_add_f32 v10, v10, v190
    v_add_f32 v10, v10, v191
    v_cvt_pk_bf16_f32 v141, v190, v191
    v_exp_f32 v192, v192
    v_exp_f32 v193, v193
    v_add_f32 v9, v9, v192
    v_add_f32 v9, v9, v193
    v_cvt_pk_bf16_f32 v138, v192, v193
    v_exp_f32 v194, v194
    v_exp_f32 v195, v195
    v_add_f32 v9, v9, v194
    v_add_f32 v9, v9, v195
    v_cvt_pk_bf16_f32 v139, v194, v195
    v_exp_f32 v196, v196
    v_exp_f32 v197, v197
    v_add_f32 v10, v10, v196
    v_add_f32 v10, v10, v197
    v_cvt_pk_bf16_f32 v142, v196, v197
    v_exp_f32 v198, v198
    v_exp_f32 v199, v199
    v_add_f32 v10, v10, v198
    v_add_f32 v10, v10, v199
    v_cvt_pk_bf16_f32 v143, v198, v199
    s_mov_b32 s17, 0x1e000
    buffer_load_dwordx4 v[200:203], v8, s[8:11], s17 offen offset:0
    buffer_load_dwordx4 v[204:207], v8, s[8:11], s17 offen offset:1024
    buffer_load_dwordx4 v[208:211], v8, s[8:11], s17 offen offset:2048
    buffer_load_dwordx4 v[212:215], v8, s[8:11], s17 offen offset:3072
    s_waitcnt vmcnt(3)
    v_mfma_f32_16x16x32_bf16 v[184:187], v[200:203], v[152:155], v[216:219]
    v_mfma_f32_16x16x32_bf16 v[188:191], v[200:203], v[168:171], v[220:223]
    s_waitcnt vmcnt(2)
    v_mfma_f32_16x16x32_bf16 v[192:195], v[204:207], v[152:155], v[216:219]
    v_mfma_f32_16x16x32_bf16 v[196:199], v[204:207], v[168:171], v[220:223]
    s_waitcnt vmcnt(1)
    v_mfma_f32_16x16x32_bf16 v[184:187], v[208:211], v[156:159], v[184:187]
    v_mfma_f32_16x16x32_bf16 v[188:191], v[208:211], v[172:175], v[188:191]
    s_waitcnt vmcnt(0)
    v_mfma_f32_16x16x32_bf16 v[192:195], v[212:215], v[156:159], v[192:195]
    v_mfma_f32_16x16x32_bf16 v[196:199], v[212:215], v[172:175], v[196:199]
    s_mov_b32 s17, 0x1f000
    buffer_load_dwordx4 v[200:203], v8, s[8:11], s17 offen offset:0
    buffer_load_dwordx4 v[204:207], v8, s[8:11], s17 offen offset:1024
    buffer_load_dwordx4 v[208:211], v8, s[8:11], s17 offen offset:2048
    buffer_load_dwordx4 v[212:215], v8, s[8:11], s17 offen offset:3072
    s_waitcnt vmcnt(3)
    v_mfma_f32_16x16x32_bf16 v[184:187], v[200:203], v[160:163], v[184:187]
    v_mfma_f32_16x16x32_bf16 v[188:191], v[200:203], v[176:179], v[188:191]
    s_waitcnt vmcnt(2)
    v_mfma_f32_16x16x32_bf16 v[192:195], v[204:207], v[160:163], v[192:195]
    v_mfma_f32_16x16x32_bf16 v[196:199], v[204:207], v[176:179], v[196:199]
    s_waitcnt vmcnt(1)
    v_mfma_f32_16x16x32_bf16 v[184:187], v[208:211], v[164:167], v[184:187]
    v_mfma_f32_16x16x32_bf16 v[188:191], v[208:211], v[180:183], v[188:191]
    s_waitcnt vmcnt(0)
    v_mfma_f32_16x16x32_bf16 v[192:195], v[212:215], v[164:167], v[192:195]
    v_mfma_f32_16x16x32_bf16 v[196:199], v[212:215], v[180:183], v[196:199]
    s_nop 3
    v_exp_f32 v184, v184
    v_exp_f32 v185, v185
    v_add_f32 v9, v9, v184
    v_add_f32 v9, v9, v185
    v_cvt_pk_bf16_f32 v144, v184, v185
    v_exp_f32 v186, v186
    v_exp_f32 v187, v187
    v_add_f32 v9, v9, v186
    v_add_f32 v9, v9, v187
    v_cvt_pk_bf16_f32 v145, v186, v187
    v_exp_f32 v188, v188
    v_exp_f32 v189, v189
    v_add_f32 v10, v10, v188
    v_add_f32 v10, v10, v189
    v_cvt_pk_bf16_f32 v148, v188, v189
    v_exp_f32 v190, v190
    v_exp_f32 v191, v191
    v_add_f32 v10, v10, v190
    v_add_f32 v10, v10, v191
    v_cvt_pk_bf16_f32 v149, v190, v191
    v_exp_f32 v192, v192
    v_exp_f32 v193, v193
    v_add_f32 v9, v9, v192
    v_add_f32 v9, v9, v193
    v_cvt_pk_bf16_f32 v146, v192, v193
    v_exp_f32 v194, v194
    v_exp_f32 v195, v195
    v_add_f32 v9, v9, v194
    v_add_f32 v9, v9, v195
    v_cvt_pk_bf16_f32 v147, v194, v195
    v_exp_f32 v196, v196
    v_exp_f32 v197, v197
    v_add_f32 v10, v10, v196
    v_add_f32 v10, v10, v197
    v_cvt_pk_bf16_f32 v150, v196, v197
    v_exp_f32 v198, v198
    v_exp_f32 v199, v199
    v_add_f32 v10, v10, v198
    v_add_f32 v10, v10, v199
    v_cvt_pk_bf16_f32 v151, v198, v199
    v_mov_b32 v16, v9
    v_mov_b32 v18, v10
    s_nop 0
    v_permlane16_swap_b32 v9, v16
    v_permlane16_swap_b32 v10, v18
    v_add_f32 v9, v9, v16
    v_add_f32 v10, v10, v18
    v_mov_b32 v16, v9
    v_mov_b32 v18, v10
    s_nop 0
    v_permlane32_swap_b32 v9, v16
    v_permlane32_swap_b32 v10, v18
    v_add_f32 v9, v9, v16
    v_add_f32 v10, v10, v18
    s_waitcnt vmcnt(0) lgkmcnt(0)
    s_nop 15
    s_nop 3
    s_branch adaLN_cond__sliding_block_cached__moe_arch_mod__prompt_kernel_fixBb
adaLN_cond__sliding_block_cached__moe_arch_mod__prompt_kernel_o17r:
    s_waitcnt vmcnt(0) lgkmcnt(0)
    s_nop 15
    s_nop 3
    s_mov_b32 s27, 0
adaLN_cond__sliding_block_cached__moe_arch_mod__prompt_kernel_o17p:
    buffer_load_dword v12, v13, s[8:11], s19 offen sc1
    s_waitcnt vmcnt(0)
    v_cmp_ne_u32 vcc, s28, v12
    s_add_u32 s27, s27, 1
    s_cmp_ge_u32 s27, 262144
    s_cbranch_scc1 adaLN_cond__sliding_block_cached__moe_arch_mod__prompt_kernel_o17g
    s_cbranch_vccnz adaLN_cond__sliding_block_cached__moe_arch_mod__prompt_kernel_o17p
adaLN_cond__sliding_block_cached__moe_arch_mod__prompt_kernel_o17g:
    s_waitcnt vmcnt(0) lgkmcnt(0)
    s_nop 15
    s_nop 3
    s_branch adaLN_cond__sliding_block_cached__moe_arch_mod__prompt_kernel_o17b
adaLN_cond__sliding_block_cached__moe_arch_mod__prompt_kernel_o218r:
    s_waitcnt vmcnt(0) lgkmcnt(0)
    s_nop 15
    s_nop 3
    s_mov_b32 s27, 0
adaLN_cond__sliding_block_cached__moe_arch_mod__prompt_kernel_o218p:
    buffer_load_dword v12, v13, s[8:11], s19 offen sc1
    s_waitcnt vmcnt(0)
    v_cmp_ne_u32 vcc, s28, v12
    s_add_u32 s27, s27, 1
    s_cmp_ge_u32 s27, 262144
    s_cbranch_scc1 adaLN_cond__sliding_block_cached__moe_arch_mod__prompt_kernel_o218g
    s_cbranch_vccnz adaLN_cond__sliding_block_cached__moe_arch_mod__prompt_kernel_o218p
adaLN_cond__sliding_block_cached__moe_arch_mod__prompt_kernel_o218g:
    s_waitcnt vmcnt(0) lgkmcnt(0)
    s_nop 15
    s_nop 3
    s_branch adaLN_cond__sliding_block_cached__moe_arch_mod__prompt_kernel_o218b
adaLN_cond__sliding_block_cached__moe_arch_mod__prompt_kernel_o219r:
    s_waitcnt vmcnt(0) lgkmcnt(0)
    s_nop 15
    s_nop 3
    s_mov_b32 s27, 0
adaLN_cond__sliding_block_cached__moe_arch_mod__prompt_kernel_o219p:
    buffer_load_dword v12, v13, s[8:11], s19 offen sc1
    s_waitcnt vmcnt(0)
    v_cmp_ne_u32 vcc, s28, v12
    s_add_u32 s27, s27, 1
    s_cmp_ge_u32 s27, 262144
    s_cbranch_scc1 adaLN_cond__sliding_block_cached__moe_arch_mod__prompt_kernel_o219g
    s_cbranch_vccnz adaLN_cond__sliding_block_cached__moe_arch_mod__prompt_kernel_o219p
adaLN_cond__sliding_block_cached__moe_arch_mod__prompt_kernel_o219g:
    s_waitcnt vmcnt(0) lgkmcnt(0)
    s_nop 15
    s_nop 3
    s_branch adaLN_cond__sliding_block_cached__moe_arch_mod__prompt_kernel_o219b
adaLN_cond__sliding_block_cached__moe_arch_mod__prompt_kernel_o220r:
    s_waitcnt vmcnt(0) lgkmcnt(0)
    s_nop 15
    s_nop 3
    s_mov_b32 s27, 0
adaLN_cond__sliding_block_cached__moe_arch_mod__prompt_kernel_o220p:
    buffer_load_dword v12, v13, s[8:11], s19 offen sc1
    s_waitcnt vmcnt(0)
    v_cmp_ne_u32 vcc, s28, v12
    s_add_u32 s27, s27, 1
    s_cmp_ge_u32 s27, 262144
    s_cbranch_scc1 adaLN_cond__sliding_block_cached__moe_arch_mod__prompt_kernel_o220g
    s_cbranch_vccnz adaLN_cond__sliding_block_cached__moe_arch_mod__prompt_kernel_o220p
adaLN_cond__sliding_block_cached__moe_arch_mod__prompt_kernel_o220g:
    s_waitcnt vmcnt(0) lgkmcnt(0)
    s_nop 15
    s_nop 3
    s_branch adaLN_cond__sliding_block_cached__moe_arch_mod__prompt_kernel_o220b
adaLN_cond__sliding_block_cached__moe_arch_mod__prompt_kernel_mf21r:
    s_waitcnt vmcnt(0) lgkmcnt(0)
    s_nop 15
    s_nop 3
    s_mov_b32 s27, 0
adaLN_cond__sliding_block_cached__moe_arch_mod__prompt_kernel_mf21p:
    s_mov_b32 s16, 0x544000
    buffer_load_dwordx4 v[184:187], v2, s[8:11], s16 offen sc1
    s_waitcnt vmcnt(0)
    v_xor_b32 v16, s28, v184
    v_xor_b32 v17, s28, v185
    v_xor_b32 v18, s28, v186
    v_xor_b32 v19, s28, v187
    v_or3_b32 v16, v16, v17, v18
    v_or_b32 v16, v16, v19
    v_cmp_ne_u32 vcc, 0, v16
    s_add_u32 s27, s27, 1
    s_cmp_ge_u32 s27, 262144
    s_cbranch_scc1 adaLN_cond__sliding_block_cached__moe_arch_mod__prompt_kernel_mf21g
    s_cbranch_vccnz adaLN_cond__sliding_block_cached__moe_arch_mod__prompt_kernel_mf21p
adaLN_cond__sliding_block_cached__moe_arch_mod__prompt_kernel_mf21g:
    s_waitcnt vmcnt(0) lgkmcnt(0)
    s_nop 15
    s_nop 3
    s_branch adaLN_cond__sliding_block_cached__moe_arch_mod__prompt_kernel_mf21b
.section .rodata,"a"
.p2align 6
.amdhsa_kernel adaLN_cond__sliding_block_cached__moe_arch_mod__prompt_kernel
  .amdhsa_next_free_vgpr 256
  .amdhsa_next_free_sgpr 80
  .amdhsa_accum_offset 256
  .amdhsa_group_segment_fixed_size 0
  .amdhsa_kernarg_size 120
  .amdhsa_user_sgpr_count 2
  .amdhsa_user_sgpr_kernarg_segment_ptr 1
  .amdhsa_system_sgpr_workgroup_id_x 1
  .amdhsa_float_denorm_mode_32 3
.end_amdhsa_kernel
```

```asm
; @launch grid=(256,1,1) block=(512,1,1) lds=163840
.amdgcn_target "amdgcn-amd-amdhsa--gfx950"
.text
.globl adaLN_cond__sliding_block_cached__moe_arch_mod__prompt_kernel
.p2align 8
.type adaLN_cond__sliding_block_cached__moe_arch_mod__prompt_kernel,@function
adaLN_cond__sliding_block_cached__moe_arch_mod__prompt_kernel:
    s_cmp_ge_u32 s2, 256
    s_cbranch_scc1 adaLN_cond__sliding_block_cached__moe_arch_mod__prompt_kernel_end
    s_load_dwordx4 s[56:59], s[0:1], 96
    s_load_dwordx2 s[60:61], s[0:1], 112
    s_load_dwordx8 s[48:55], s[0:1], 64
    s_load_dwordx16 s[32:47], s[0:1], 0
    s_memrealtime s[62:63]
    v_lshrrev_b32 v16, 6, v0
    v_and_b32 v1, 63, v0
    v_readfirstlane_b32 s3, v16
    v_lshlrev_b32 v2, 4, v1
    s_and_b32 s12, s2, 3
    s_lshl_b32 s12, s12, 3
    s_bfe_u32 s13, s2, 0x30003
    s_add_u32 s12, s12, s13
    s_bfe_u32 s13, s2, 0x10002
    s_lshl_b32 s13, s13, 2
    s_lshr_b32 s14, s2, 6
    s_add_u32 s13, s13, s14
    v_bfe_u32 v16, v1, 2, 2
    v_lshrrev_b32 v17, 4, v1
    v_and_b32 v18, 3, v1
    v_lshlrev_b32 v19, 6, v17
    v_lshl_add_u32 v19, v18, 4, v19
    v_lshl_add_u32 v3, v16, 13, v19
    s_and_b32 s14, s3, 1
    s_lshl_b32 s14, s14, 5
    v_xor_b32 v3, s14, v3
    v_lshlrev_b32 v4, 11, v17
    v_lshl_add_u32 v4, v16, 6, v4
    v_lshl_add_u32 v4, v18, 3, v4
    v_and_b32 v20, 1, v17
    v_lshlrev_b32 v20, 5, v20
    v_sub_u32 v5, v4, v20
    v_add_u32 v4, v4, v20
    s_lshl_b32 s14, s13, 3
    s_add_u32 s14, s14, s3
    s_lshl_b32 s14, s14, 16
    v_add_u32 v7, s14, v2
    s_cmp_ge_u32 s3, 4
    s_cbranch_scc1 adaLN_cond__sliding_block_cached__moe_arch_mod__prompt_kernel_roleB
    v_mov_b32 v132, 0
    v_mov_b32 v133, 0
    v_lshrrev_b32 v16, 3, v0
    v_and_b32 v17, 7, v0
    v_mul_u32_u24 v135, 24576, v16
    v_lshl_add_u32 v135, v17, 4, v135
    v_lshlrev_b32 v136, 2, v16
    s_and_b32 s14, s2, 31
    s_lshr_b32 s15, s2, 5
    s_mul_i32 s26, s15, 1572864
    s_lshl_b32 s16, s14, 7
    s_add_u32 s26, s26, s16
    s_lshl_b32 s29, s15, 8
    v_lshlrev_b32 v137, 3, v0
    s_lshl_b32 s18, s2, 3
    s_add_u32 s18, s18, s3
    s_lshl_b32 s18, s18, 11
    v_and_b32 v18, 15, v1
    v_lshrrev_b32 v19, 4, v1
    v_lshlrev_b32 v138, 11, v18
    v_lshl_add_u32 v138, v19, 4, v138
    s_lshr_b32 s30, s2, 4
    s_and_b32 s31, s2, 15
    s_lshl_b32 s19, s30, 3
    s_add_u32 s19, s19, s3
    s_lshl_b32 s22, s19, 15
    s_lshl_b32 s23, s31, 7
    s_add_u32 s22, s22, s23
    s_lshl_b32 s23, s2, 12
    s_add_u32 s23, s23, 0x600000
    s_or_b32 s25, s2, s3
    s_cmp_eq_u32 s25, 0
    s_cselect_b32 s25, 0, 0x7ffffff0
    s_waitcnt lgkmcnt(0)
    s_mov_b64 s[64:65], s[58:59]
    s_mov_b32 s66, 0x100
    s_mov_b32 s67, 0x20000
    s_or_b32 s28, s62, 1
    v_mov_b32 v134, s28
    s_mov_b64 exec, 1
    buffer_store_dword v134, v132, s[64:67], s25 offen sc1
    s_mov_b64 exec, -1
    s_mov_b64 s[68:69], s[52:53]
    s_mov_b32 s70, 0x800
    s_mov_b32 s71, 0x20000
    s_mov_b64 s[72:73], s[54:55]
    s_mov_b32 s74, 0xc00000
    s_mov_b32 s75, 0x20000
    s_mov_b64 s[76:77], s[32:33]
    s_mov_b32 s78, 0x400000
    s_mov_b32 s79, 0x20000
    s_mov_b64 s[8:9], s[60:61]
    s_mov_b32 s10, 0x3400000
    s_mov_b32 s11, 0x20000
    buffer_load_dword v72, v136, s[68:71], s29 offen
    buffer_load_dwordx4 v[24:27], v135, s[72:75], s26 offen
    s_add_u32 s26, s26, 12288
    buffer_load_dwordx4 v[28:31], v135, s[72:75], s26 offen
    buffer_load_dwordx4 v[32:35], v2, s[76:79], s18 offen offset:0
    buffer_load_dwordx4 v[36:39], v2, s[76:79], s18 offen offset:1024
    s_cmp_eq_u32 s3, 0
    s_cselect_b32 s25, 0, 0x7ffffff0
    buffer_load_dword v134, v132, s[64:67], s25 offen sc1
    buffer_store_dwordx2 v[132:133], v137, s[8:11], s23 offen sc1
    s_barrier
    buffer_load_dwordx4 v[40:43], v138, s[76:79], s22 offen offset:0
    buffer_load_dwordx4 v[44:47], v138, s[76:79], s22 offen offset:64
    s_mov_b32 s29, s19
    s_waitcnt vmcnt(8)
    v_and_b32 v73, 0xffff0000, v72
    v_lshlrev_b32 v72, 16, v72
    v_mul_f32 v16, 0xbfb8aa3b, v72
    v_exp_f32 v16, v16
    s_nop 0
    v_add_f32 v16, 1.0, v16
    v_rcp_f32 v16, v16
    s_nop 0
    v_mul_f32 v72, v72, v16
    v_mul_f32 v17, 0xbfb8aa3b, v73
    v_exp_f32 v17, v17
    s_nop 0
    v_add_f32 v17, 1.0, v17
    v_rcp_f32 v17, v17
    s_nop 0
    v_mul_f32 v73, v73, v17
    v_cvt_pk_bf16_f32 v16, v72, v73
    v_lshlrev_b32 v72, 16, v16
    v_and_b32 v73, 0xffff0000, v16
    s_lshl_b32 s16, s2, 8
    s_add_u32 s16, s16, 0x550000
    s_mov_b32 exec_lo, 0x01010101
    s_mov_b32 exec_hi, 0x01010101
    buffer_store_dword v16, v136, s[8:11], s16 offen sc1
    s_mov_b64 exec, -1
    v_lshrrev_b32 v74, 16, v72
    v_lshrrev_b32 v75, 16, v73
    s_waitcnt vmcnt(8)
    v_dot2_f32_bf16 v49, v24, v72, 0
    v_dot2_f32_bf16 v48, v24, v74, 0
    v_dot2_f32_bf16 v51, v25, v72, 0
    v_dot2_f32_bf16 v50, v25, v74, 0
    v_dot2_f32_bf16 v53, v26, v72, 0
    v_dot2_f32_bf16 v52, v26, v74, 0
    v_dot2_f32_bf16 v55, v27, v72, 0
    v_dot2_f32_bf16 v54, v27, v74, 0
    s_waitcnt vmcnt(7)
    v_dot2c_f32_bf16 v49, v28, v73
    v_dot2c_f32_bf16 v48, v28, v75
    v_dot2c_f32_bf16 v51, v29, v73
    v_dot2c_f32_bf16 v50, v29, v75
    v_dot2c_f32_bf16 v53, v30, v73
    v_dot2c_f32_bf16 v52, v30, v75
    v_dot2c_f32_bf16 v55, v31, v73
    v_dot2c_f32_bf16 v54, v31, v75
    s_nop 0
    v_permlane32_swap_b32 v48, v52
    v_permlane32_swap_b32 v49, v53
    v_permlane32_swap_b32 v50, v54
    v_permlane32_swap_b32 v51, v55
    v_add_f32 v48, v48, v52
    v_add_f32 v49, v49, v53
    v_add_f32 v50, v50, v54
    v_add_f32 v51, v51, v55
    s_nop 0
    v_permlane16_swap_b32 v48, v50
    v_permlane16_swap_b32 v49, v51
    v_add_f32 v48, v48, v50
    v_add_f32 v49, v49, v51
    s_nop 0
    v_add_f32_dpp v48, v48, v48 row_ror:8 row_mask:0xf bank_mask:0xf
    v_add_f32_dpp v49, v49, v49 row_ror:8 row_mask:0xf bank_mask:0xf
    v_and_b32 v16, 7, v1
    v_lshlrev_b32 v16, 5, v16
    v_lshrrev_b32 v17, 4, v1
    v_lshl_add_u32 v16, v17, 3, v16
    s_lshl_b32 s16, s3, 8
    s_add_u32 s16, s16, 65536
    v_add_u32 v16, s16, v16
    ds_write_b64 v16, v[48:49]
    s_waitcnt vmcnt(6)
    v_lshlrev_b32 v56, 16, v32
    v_and_b32 v57, 0xffff0000, v32
    v_lshlrev_b32 v58, 16, v33
    v_and_b32 v59, 0xffff0000, v33
    v_lshlrev_b32 v60, 16, v34
    v_and_b32 v61, 0xffff0000, v34
    v_lshlrev_b32 v62, 16, v35
    v_and_b32 v63, 0xffff0000, v35
    s_waitcnt vmcnt(5)
    v_lshlrev_b32 v64, 16, v36
    v_and_b32 v65, 0xffff0000, v36
    v_lshlrev_b32 v66, 16, v37
    v_and_b32 v67, 0xffff0000, v37
    v_lshlrev_b32 v68, 16, v38
    v_and_b32 v69, 0xffff0000, v38
    v_lshlrev_b32 v70, 16, v39
    v_and_b32 v71, 0xffff0000, v39
    v_add_f32 v20, v56, v57
    v_add_f32 v21, v58, v59
    v_add_f32 v20, v20, v60
    v_add_f32 v21, v21, v61
    v_add_f32 v20, v20, v62
    v_add_f32 v21, v21, v63
    v_add_f32 v20, v20, v64
    v_add_f32 v21, v21, v65
    v_add_f32 v20, v20, v66
    v_add_f32 v21, v21, v67
    v_add_f32 v20, v20, v68
    v_add_f32 v21, v21, v69
    v_add_f32 v20, v20, v70
    v_add_f32 v21, v21, v71
    v_add_f32 v128, v20, v21
    s_nop 1
    v_add_f32_dpp v128, v128, v128 row_ror:1 row_mask:0xf bank_mask:0xf
    s_nop 1
    v_add_f32_dpp v128, v128, v128 row_ror:2 row_mask:0xf bank_mask:0xf
    s_nop 1
    v_add_f32_dpp v128, v128, v128 row_ror:4 row_mask:0xf bank_mask:0xf
    s_nop 1
    v_add_f32_dpp v128, v128, v128 row_ror:8 row_mask:0xf bank_mask:0xf
    v_mov_b32 v20, v128
    s_nop 1
    v_permlane16_swap_b32 v128, v20
    v_add_f32 v128, v128, v20
    v_mov_b32 v20, v128
    s_nop 1
    v_permlane32_swap_b32 v128, v20
    v_add_f32 v128, v128, v20
    v_mul_f32 v128, 0x3a800000, v128
    v_sub_f32 v18, v56, v128
    v_mul_f32 v20, v18, v18
    v_sub_f32 v19, v57, v128
    v_mul_f32 v21, v19, v19
    v_sub_f32 v18, v58, v128
    v_sub_f32 v19, v59, v128
    v_fmac_f32 v20, v18, v18
    v_fmac_f32 v21, v19, v19
    v_sub_f32 v18, v60, v128
    v_sub_f32 v19, v61, v128
    v_fmac_f32 v20, v18, v18
    v_fmac_f32 v21, v19, v19
    v_sub_f32 v18, v62, v128
    v_sub_f32 v19, v63, v128
    v_fmac_f32 v20, v18, v18
    v_fmac_f32 v21, v19, v19
    v_sub_f32 v18, v64, v128
    v_sub_f32 v19, v65, v128
    v_fmac_f32 v20, v18, v18
    v_fmac_f32 v21, v19, v19
    v_sub_f32 v18, v66, v128
    v_sub_f32 v19, v67, v128
    v_fmac_f32 v20, v18, v18
    v_fmac_f32 v21, v19, v19
    v_sub_f32 v18, v68, v128
    v_sub_f32 v19, v69, v128
    v_fmac_f32 v20, v18, v18
    v_fmac_f32 v21, v19, v19
    v_sub_f32 v18, v70, v128
    v_sub_f32 v19, v71, v128
    v_fmac_f32 v20, v18, v18
    v_fmac_f32 v21, v19, v19
    v_add_f32 v17, v20, v21
    s_nop 1
    v_add_f32_dpp v17, v17, v17 row_ror:1 row_mask:0xf bank_mask:0xf
    s_nop 1
    v_add_f32_dpp v17, v17, v17 row_ror:2 row_mask:0xf bank_mask:0xf
    s_nop 1
    v_add_f32_dpp v17, v17, v17 row_ror:4 row_mask:0xf bank_mask:0xf
    s_nop 1
    v_add_f32_dpp v17, v17, v17 row_ror:8 row_mask:0xf bank_mask:0xf
    v_mov_b32 v20, v17
    s_nop 1
    v_permlane16_swap_b32 v17, v20
    v_add_f32 v17, v17, v20
    v_mov_b32 v20, v17
    s_nop 1
    v_permlane32_swap_b32 v17, v20
    v_add_f32 v17, v17, v20
    v_mul_f32 v17, 0x3a800000, v17
    v_cvt_pk_bf16_f32 v128, v128, v128
    v_lshlrev_b32 v128, 16, v128
    v_cvt_pk_bf16_f32 v17, v17, v17
    v_lshlrev_b32 v17, 16, v17
    v_add_f32 v17, 0x3727c5ac, v17
    v_cvt_pk_bf16_f32 v17, v17, v17
    v_lshlrev_b32 v17, 16, v17
    v_sqrt_f32 v129, v17
    s_nop 0
    v_cvt_pk_bf16_f32 v129, v129, v129
    v_lshlrev_b32 v129, 16, v129
    v_rcp_f32 v130, v129
    s_lshl_b32 s16, s3, 4
    s_add_u32 s16, s16, 67600
    v_mov_b32 v19, s16
    ds_write_b128 v19, v[128:131]
    s_waitcnt vmcnt(4)
    v_cmp_eq_u32 vcc, 0, v134
    s_cmp_eq_u32 s3, 0
    s_cselect_b64 s[62:63], -1, 0
    s_and_b64 vcc, vcc, s[62:63]
    s_cbranch_vccnz adaLN_cond__sliding_block_cached__moe_arch_mod__prompt_kernel_n1r
adaLN_cond__sliding_block_cached__moe_arch_mod__prompt_kernel_n1b:
    v_mov_b32 v19, 67584
    s_cmp_eq_u32 s3, 0
    s_cselect_b64 exec, 1, 0
    ds_write_b32 v19, v134
    s_mov_b64 exec, -1
    v_mov_b32 v19, 67584
    v_and_b32 v17, 31, v1
    v_lshlrev_b32 v18, 3, v17
    v_add_u32 v18, 65536, v18
    v_lshlrev_b32 v17, 4, v17
    s_waitcnt lgkmcnt(0)
    s_barrier
    ds_read_b32 v134, v19
    ds_read_b64 v[96:97], v18 offset:0
    ds_read_b64 v[100:101], v18 offset:256
    ds_read_b64 v[104:105], v18 offset:512
    ds_read_b64 v[108:109], v18 offset:768
    ds_read_b64 v[112:113], v18 offset:1024
    ds_read_b64 v[116:117], v18 offset:1280
    ds_read_b64 v[120:121], v18 offset:1536
    ds_read_b64 v[124:125], v18 offset:1792
    s_waitcnt lgkmcnt(8)
    v_readfirstlane_b32 s28, v134
    v_and_b32 v20, 7, v1
    v_lshlrev_b32 v20, 4, v20
    v_add_u32 v21, 67600, v20
    ds_read_b128 v[128:131], v21
    s_waitcnt lgkmcnt(0)
    v_mov_b32 v131, s28
    s_lshl_b32 s16, s2, 7
    s_add_u32 s16, s16, 0x520000
    s_cmp_eq_u32 s3, 0
    s_cselect_b32 s16, s16, 0x7ffffff0
    s_mov_b64 exec, 0xff
    buffer_store_dwordx4 v[128:131], v20, s[8:11], s16 offen sc1
    s_mov_b64 exec, -1
    v_pk_add_f32 v[96:97], v[96:97], v[112:113]
    v_pk_add_f32 v[100:101], v[100:101], v[116:117]
    v_pk_add_f32 v[104:105], v[104:105], v[120:121]
    v_pk_add_f32 v[108:109], v[108:109], v[124:125]
    v_pk_add_f32 v[96:97], v[96:97], v[104:105]
    v_pk_add_f32 v[100:101], v[100:101], v[108:109]
    v_pk_add_f32 v[96:97], v[96:97], v[100:101]
    v_mov_b32 v98, s28
    v_mov_b32 v99, s28
    s_lshl_b32 s16, s14, 3
    s_add_u32 s16, s16, s15
    s_lshl_b32 s16, s16, 9
    s_add_u32 s16, s16, 0x500000
    s_cmp_eq_u32 s3, 0
    s_cselect_b32 s16, s16, 0x7ffffff0
    s_mov_b64 exec, 0xffffffff
    buffer_store_dwordx4 v[96:99], v17, s[8:11], s16 offen sc1
    s_mov_b64 exec, -1
    s_lshr_b32 s16, s3, 2
    s_lshl_b32 s16, s16, 4
    s_add_u32 s16, s16, s31
    s_lshl_b32 s16, s16, 12
    s_and_b32 s17, s3, 3
    s_lshl_b32 s17, s17, 7
    s_add_u32 s16, s16, s17
    s_add_u32 s16, s16, 0x500000
    v_lshrrev_b32 v139, 3, v1
    v_lshlrev_b32 v139, 9, v139
    v_and_b32 v16, 7, v1
    v_lshl_add_u32 v139, v16, 4, v139
    v_and_b32 v140, 15, v1
    v_lshlrev_b32 v140, 4, v140
    s_lshl_b32 s17, s29, 8
    s_add_u32 s17, s17, 0x520000
    s_waitcnt vmcnt(4)
    v_lshlrev_b32 v56, 16, v40
    v_and_b32 v57, 0xffff0000, v40
    v_lshlrev_b32 v58, 16, v41
    v_and_b32 v59, 0xffff0000, v41
    v_lshlrev_b32 v60, 16, v42
    v_and_b32 v61, 0xffff0000, v42
    v_lshlrev_b32 v62, 16, v43
    v_and_b32 v63, 0xffff0000, v43
    s_waitcnt vmcnt(3)
    v_lshlrev_b32 v64, 16, v44
    v_and_b32 v65, 0xffff0000, v44
    v_lshlrev_b32 v66, 16, v45
    v_and_b32 v67, 0xffff0000, v45
    v_lshlrev_b32 v68, 16, v46
    v_and_b32 v69, 0xffff0000, v46
    v_lshlrev_b32 v70, 16, v47
    v_and_b32 v71, 0xffff0000, v47
    s_mov_b32 s27, 0
adaLN_cond__sliding_block_cached__moe_arch_mod__prompt_kernel_g2p:
    buffer_load_dwordx4 v[76:79], v139, s[8:11], s16 offen sc1
    buffer_load_dwordx4 v[80:83], v140, s[8:11], s17 offen sc1
    s_waitcnt vmcnt(1)
    v_cmp_ne_u32 vcc, s28, v78
    v_cmp_ne_u32 s[62:63], s28, v79
    s_or_b64 vcc, vcc, s[62:63]
    s_waitcnt vmcnt(0)
    v_cmp_ne_u32 s[62:63], s28, v83
    s_or_b64 vcc, vcc, s[62:63]
    s_add_u32 s27, s27, 1
    s_cmp_ge_u32 s27, 262144
    s_cbranch_scc1 adaLN_cond__sliding_block_cached__moe_arch_mod__prompt_kernel_g2g
    s_cbranch_vccnz adaLN_cond__sliding_block_cached__moe_arch_mod__prompt_kernel_g2p
adaLN_cond__sliding_block_cached__moe_arch_mod__prompt_kernel_g2g:
    v_add_f32_dpp v76, v76, v76 row_ror:8 row_mask:0xf bank_mask:0xf
    v_add_f32_dpp v77, v77, v77 row_ror:8 row_mask:0xf bank_mask:0xf
    v_mov_b32 v17, v76
    s_nop 1
    v_permlane16_swap_b32 v76, v17
    v_add_f32 v76, v76, v17
    v_mov_b32 v18, v77
    s_nop 1
    v_permlane16_swap_b32 v77, v18
    v_add_f32 v77, v77, v18
    v_mov_b32 v17, v76
    s_nop 1
    v_permlane32_swap_b32 v76, v17
    v_add_f32 v76, v76, v17
    v_mov_b32 v18, v77
    s_nop 1
    v_permlane32_swap_b32 v77, v18
    v_add_f32 v77, v77, v18
    v_cvt_pk_bf16_f32 v17, v76, v77
    v_lshlrev_b32 v76, 16, v17
    v_and_b32 v77, 0xffff0000, v17
    v_add_f32 v76, 0, v76
    v_add_f32 v77, 0, v77
    s_lshl_b32 s16, s3, 6
    s_add_u32 s16, s16, 69632
    v_lshl_add_u32 v16, v16, 3, s16
    ds_write_b64 v16, v[76:77]
    v_lshrrev_b32 v17, 4, v1
    v_lshlrev_b32 v17, 5, v17
    v_add_u32 v17, 69632, v17
    v_sub_f32 v56, v56, v80
    v_sub_f32 v57, v57, v80
    v_sub_f32 v58, v58, v80
    v_sub_f32 v59, v59, v80
    v_sub_f32 v60, v60, v80
    v_sub_f32 v61, v61, v80
    v_sub_f32 v62, v62, v80
    v_sub_f32 v63, v63, v80
    v_sub_f32 v64, v64, v80
    v_sub_f32 v65, v65, v80
    v_sub_f32 v66, v66, v80
    v_sub_f32 v67, v67, v80
    v_sub_f32 v68, v68, v80
    v_sub_f32 v69, v69, v80
    v_sub_f32 v70, v70, v80
    v_sub_f32 v71, v71, v80
    v_cvt_pk_bf16_f32 v18, v56, v57
    v_lshlrev_b32 v56, 16, v18
    v_and_b32 v57, 0xffff0000, v18
    v_cvt_pk_bf16_f32 v19, v58, v59
    v_lshlrev_b32 v58, 16, v19
    v_and_b32 v59, 0xffff0000, v19
    v_cvt_pk_bf16_f32 v18, v60, v61
    v_lshlrev_b32 v60, 16, v18
    v_and_b32 v61, 0xffff0000, v18
    v_cvt_pk_bf16_f32 v19, v62, v63
    v_lshlrev_b32 v62, 16, v19
    v_and_b32 v63, 0xffff0000, v19
    v_cvt_pk_bf16_f32 v18, v64, v65
    v_lshlrev_b32 v64, 16, v18
    v_and_b32 v65, 0xffff0000, v18
    v_cvt_pk_bf16_f32 v19, v66, v67
    v_lshlrev_b32 v66, 16, v19
    v_and_b32 v67, 0xffff0000, v19
    v_cvt_pk_bf16_f32 v18, v68, v69
    v_lshlrev_b32 v68, 16, v18
    v_and_b32 v69, 0xffff0000, v18
    v_cvt_pk_bf16_f32 v19, v70, v71
    v_lshlrev_b32 v70, 16, v19
    v_and_b32 v71, 0xffff0000, v19
    v_mul_f32 v56, v56, v82
    v_mul_f32 v57, v57, v82
    v_mul_f32 v58, v58, v82
    v_mul_f32 v59, v59, v82
    v_mul_f32 v60, v60, v82
    v_mul_f32 v61, v61, v82
    v_mul_f32 v62, v62, v82
    v_mul_f32 v63, v63, v82
    v_mul_f32 v64, v64, v82
    v_mul_f32 v65, v65, v82
    v_mul_f32 v66, v66, v82
    v_mul_f32 v67, v67, v82
    v_mul_f32 v68, v68, v82
    v_mul_f32 v69, v69, v82
    v_mul_f32 v70, v70, v82
    v_mul_f32 v71, v71, v82
    v_cvt_pk_bf16_f32 v18, v56, v57
    v_lshlrev_b32 v56, 16, v18
    v_and_b32 v57, 0xffff0000, v18
    v_cvt_pk_bf16_f32 v19, v58, v59
    v_lshlrev_b32 v58, 16, v19
    v_and_b32 v59, 0xffff0000, v19
    v_cvt_pk_bf16_f32 v18, v60, v61
    v_lshlrev_b32 v60, 16, v18
    v_and_b32 v61, 0xffff0000, v18
    v_cvt_pk_bf16_f32 v19, v62, v63
    v_lshlrev_b32 v62, 16, v19
    v_and_b32 v63, 0xffff0000, v19
    v_cvt_pk_bf16_f32 v18, v64, v65
    v_lshlrev_b32 v64, 16, v18
    v_and_b32 v65, 0xffff0000, v18
    v_cvt_pk_bf16_f32 v19, v66, v67
    v_lshlrev_b32 v66, 16, v19
    v_and_b32 v67, 0xffff0000, v19
    v_cvt_pk_bf16_f32 v18, v68, v69
    v_lshlrev_b32 v68, 16, v18
    v_and_b32 v69, 0xffff0000, v18
    v_cvt_pk_bf16_f32 v19, v70, v71
    v_lshlrev_b32 v70, 16, v19
    v_and_b32 v71, 0xffff0000, v19
    s_lshl_b32 s16, s29, 15
    s_lshl_b32 s17, s31, 11
    s_add_u32 s16, s16, s17
    s_waitcnt lgkmcnt(0)
    s_barrier
    ds_read_b128 v[96:99], v17 offset:256
    ds_read_b128 v[104:107], v17 offset:0
    ds_read_b128 v[100:103], v17 offset:272
    ds_read_b128 v[108:111], v17 offset:16
    ds_read_b128 v[112:115], v17 offset:384
    ds_read_b128 v[120:123], v17 offset:128
    ds_read_b128 v[116:119], v17 offset:400
    ds_read_b128 v[124:127], v17 offset:144
    s_waitcnt lgkmcnt(7)
    v_pk_mul_f32 v[56:57], v[56:57], v[96:97]
    v_pk_mul_f32 v[58:59], v[58:59], v[98:99]
    s_waitcnt lgkmcnt(5)
    v_pk_mul_f32 v[60:61], v[60:61], v[100:101]
    v_pk_mul_f32 v[62:63], v[62:63], v[102:103]
    v_cvt_pk_bf16_f32 v18, v56, v57
    v_lshlrev_b32 v56, 16, v18
    v_and_b32 v57, 0xffff0000, v18
    v_cvt_pk_bf16_f32 v19, v58, v59
    v_lshlrev_b32 v58, 16, v19
    v_and_b32 v59, 0xffff0000, v19
    v_cvt_pk_bf16_f32 v18, v60, v61
    v_lshlrev_b32 v60, 16, v18
    v_and_b32 v61, 0xffff0000, v18
    v_cvt_pk_bf16_f32 v19, v62, v63
    v_lshlrev_b32 v62, 16, v19
    v_and_b32 v63, 0xffff0000, v19
    v_pk_add_f32 v[56:57], v[56:57], v[104:105]
    v_pk_add_f32 v[58:59], v[58:59], v[106:107]
    s_waitcnt lgkmcnt(4)
    v_pk_add_f32 v[60:61], v[60:61], v[108:109]
    v_pk_add_f32 v[62:63], v[62:63], v[110:111]
    v_cvt_pk_bf16_f32 v32, v56, v57
    v_cvt_pk_bf16_f32 v33, v58, v59
    v_cvt_pk_bf16_f32 v34, v60, v61
    v_cvt_pk_bf16_f32 v35, v62, v63
    buffer_store_dwordx4 v[32:35], v2, s[8:11], s16 offen offset:0 sc1
    s_waitcnt lgkmcnt(3)
    v_pk_mul_f32 v[64:65], v[64:65], v[112:113]
    v_pk_mul_f32 v[66:67], v[66:67], v[114:115]
    s_waitcnt lgkmcnt(1)
    v_pk_mul_f32 v[68:69], v[68:69], v[116:117]
    v_pk_mul_f32 v[70:71], v[70:71], v[118:119]
    v_cvt_pk_bf16_f32 v18, v64, v65
    v_lshlrev_b32 v64, 16, v18
    v_and_b32 v65, 0xffff0000, v18
    v_cvt_pk_bf16_f32 v19, v66, v67
    v_lshlrev_b32 v66, 16, v19
    v_and_b32 v67, 0xffff0000, v19
    v_cvt_pk_bf16_f32 v18, v68, v69
    v_lshlrev_b32 v68, 16, v18
    v_and_b32 v69, 0xffff0000, v18
    v_cvt_pk_bf16_f32 v19, v70, v71
    v_lshlrev_b32 v70, 16, v19
    v_and_b32 v71, 0xffff0000, v19
    v_pk_add_f32 v[64:65], v[64:65], v[120:121]
    v_pk_add_f32 v[66:67], v[66:67], v[122:123]
    s_waitcnt lgkmcnt(0)
    v_pk_add_f32 v[68:69], v[68:69], v[124:125]
    v_pk_add_f32 v[70:71], v[70:71], v[126:127]
    v_cvt_pk_bf16_f32 v36, v64, v65
    v_cvt_pk_bf16_f32 v37, v66, v67
    v_cvt_pk_bf16_f32 v38, v68, v69
    v_cvt_pk_bf16_f32 v39, v70, v71
    buffer_store_dwordx4 v[36:39], v2, s[8:11], s16 offen offset:1024 sc1
    s_lshl_b32 s19, s3, 16
    s_lshl_b32 s20, s3, 11
    s_lshl_b32 s16, s12, 8
    s_add_u32 s4, s38, s16
    s_addc_u32 s5, s39, 0
    s_sub_u32 s6, 0x800000, s16
    s_mov_b32 s7, 0x20000
    v_mov_b32 v134, s28
    s_lshl_b32 s16, s29, 4
    s_add_u32 s16, s16, s31
    s_lshl_b32 s16, s16, 2
    s_add_u32 s16, s16, 0x528000
    v_and_b32 v16, 31, v1
    v_lshlrev_b32 v16, 2, v16
    s_lshl_b32 s17, s13, 3
    s_add_u32 s17, s17, s3
    s_lshl_b32 s17, s17, 7
    s_add_u32 s17, s17, 0x528000
    s_waitcnt vmcnt(0)
    s_mov_b64 exec, 1
    buffer_store_dword v134, v132, s[8:11], s16 offen sc1
    s_mov_b64 exec, -1
    s_add_u32 s22, s19, 0x0
    s_add_u32 m0, s20, 0x0
    s_nop 0
    buffer_load_dwordx4 v3, s[4:7], s22 offen lds
    s_add_u32 s22, s19, 0x8000
    s_add_u32 m0, s20, 0x400
    s_nop 0
    buffer_load_dwordx4 v3, s[4:7], s22 offen lds
    s_add_u32 s22, s19, 0x80000
    s_add_u32 m0, s20, 0x4000
    s_nop 0
    buffer_load_dwordx4 v3, s[4:7], s22 offen lds
    s_add_u32 s22, s19, 0x88000
    s_add_u32 m0, s20, 0x4400
    s_nop 0
    buffer_load_dwordx4 v3, s[4:7], s22 offen lds
    s_add_u32 s22, s19, 0x100000
    s_add_u32 m0, s20, 0x8000
    s_nop 0
    buffer_load_dwordx4 v3, s[4:7], s22 offen lds
    s_add_u32 s22, s19, 0x108000
    s_add_u32 m0, s20, 0x8400
    s_nop 0
    buffer_load_dwordx4 v3, s[4:7], s22 offen lds
    s_sleep 40
    s_mov_b32 s27, 0
adaLN_cond__sliding_block_cached__moe_arch_mod__prompt_kernel_h3p:
    buffer_load_dword v17, v16, s[8:11], s17 offen sc1
    s_waitcnt vmcnt(0)
    v_cmp_ne_u32 vcc, s28, v17
    s_add_u32 s27, s27, 1
    s_cmp_ge_u32 s27, 262144
    s_cbranch_scc1 adaLN_cond__sliding_block_cached__moe_arch_mod__prompt_kernel_h3g
    s_cbranch_vccnz adaLN_cond__sliding_block_cached__moe_arch_mod__prompt_kernel_h3p
adaLN_cond__sliding_block_cached__moe_arch_mod__prompt_kernel_h3g:
    s_mov_b32 s23, 0x0
    buffer_load_dwordx4 v[88:91], v7, s[8:11], s23 offen offset:0 sc1
    s_mov_b32 s23, 0x8000
    buffer_load_dwordx4 v[92:95], v7, s[8:11], s23 offen offset:0 sc1
    s_mov_b32 s23, 0x0
    buffer_load_dwordx4 v[96:99], v7, s[8:11], s23 offen offset:1024 sc1
    s_mov_b32 s23, 0x8000
    buffer_load_dwordx4 v[100:103], v7, s[8:11], s23 offen offset:1024 sc1
    s_mov_b32 s23, 0x800
    buffer_load_dwordx4 v[104:107], v7, s[8:11], s23 offen offset:0 sc1
    s_mov_b32 s23, 0x8800
    buffer_load_dwordx4 v[108:111], v7, s[8:11], s23 offen offset:0 sc1
    s_mov_b32 s23, 0x800
    buffer_load_dwordx4 v[112:115], v7, s[8:11], s23 offen offset:1024 sc1
    s_mov_b32 s23, 0x8800
    buffer_load_dwordx4 v[116:119], v7, s[8:11], s23 offen offset:1024 sc1
    s_lshr_b32 s21, s12, 3
    s_lshl_b32 s21, s21, 17
    s_add_u32 s21, s21, s20
    s_add_u32 s21, s21, 0x400000
    s_barrier
    ds_read_b64_tr_b16 v[224:225], v4 offset:0
    ds_read_b64_tr_b16 v[226:227], v4 offset:1024
    ds_read_b64_tr_b16 v[228:229], v5 offset:32
    ds_read_b64_tr_b16 v[230:231], v5 offset:1056
    ds_read_b64_tr_b16 v[232:233], v4 offset:256
    ds_read_b64_tr_b16 v[234:235], v4 offset:1280
    ds_read_b64_tr_b16 v[236:237], v5 offset:288
    ds_read_b64_tr_b16 v[238:239], v5 offset:1312
    s_waitcnt vmcnt(7) lgkmcnt(6)
    v_mfma_f32_16x16x32_bf16 v[24:27], v[224:227], v[88:91], 0
    ds_read_b64_tr_b16 v[240:241], v4 offset:512
    s_waitcnt vmcnt(6)
    v_mfma_f32_16x16x32_bf16 v[28:31], v[224:227], v[92:95], 0
    ds_read_b64_tr_b16 v[242:243], v4 offset:1536
    s_waitcnt lgkmcnt(6)
    v_mfma_f32_16x16x32_bf16 v[32:35], v[228:231], v[88:91], 0
    ds_read_b64_tr_b16 v[244:245], v5 offset:544
    v_mfma_f32_16x16x32_bf16 v[36:39], v[228:231], v[92:95], 0
    ds_read_b64_tr_b16 v[246:247], v5 offset:1568
    s_mov_b32 s23, 0x1000
    buffer_load_dwordx4 v[120:123], v7, s[8:11], s23 offen offset:0 sc1
    s_waitcnt lgkmcnt(6)
    v_mfma_f32_16x16x32_bf16 v[40:43], v[232:235], v[88:91], 0
    ds_read_b64_tr_b16 v[224:225], v4 offset:768
    v_mfma_f32_16x16x32_bf16 v[44:47], v[232:235], v[92:95], 0
    ds_read_b64_tr_b16 v[226:227], v4 offset:1792
    s_waitcnt lgkmcnt(6)
    v_mfma_f32_16x16x32_bf16 v[48:51], v[236:239], v[88:91], 0
    ds_read_b64_tr_b16 v[228:229], v5 offset:800
    v_mfma_f32_16x16x32_bf16 v[52:55], v[236:239], v[92:95], 0
    ds_read_b64_tr_b16 v[230:231], v5 offset:1824
    s_waitcnt lgkmcnt(6)
    v_mfma_f32_16x16x32_bf16 v[56:59], v[240:243], v[88:91], 0
    ds_read_b64_tr_b16 v[232:233], v4 offset:8192
    v_mfma_f32_16x16x32_bf16 v[60:63], v[240:243], v[92:95], 0
    ds_read_b64_tr_b16 v[234:235], v4 offset:9216
    s_waitcnt lgkmcnt(6)
    v_mfma_f32_16x16x32_bf16 v[64:67], v[244:247], v[88:91], 0
    ds_read_b64_tr_b16 v[236:237], v5 offset:8224
    v_mfma_f32_16x16x32_bf16 v[68:71], v[244:247], v[92:95], 0
    ds_read_b64_tr_b16 v[238:239], v5 offset:9248
    s_mov_b32 s23, 0x9000
    buffer_load_dwordx4 v[124:127], v7, s[8:11], s23 offen offset:0 sc1
    s_waitcnt lgkmcnt(6)
    v_mfma_f32_16x16x32_bf16 v[72:75], v[224:227], v[88:91], 0
    ds_read_b64_tr_b16 v[240:241], v4 offset:8448
    v_mfma_f32_16x16x32_bf16 v[76:79], v[224:227], v[92:95], 0
    ds_read_b64_tr_b16 v[242:243], v4 offset:9472
    s_waitcnt lgkmcnt(6)
    v_mfma_f32_16x16x32_bf16 v[80:83], v[228:231], v[88:91], 0
    ds_read_b64_tr_b16 v[244:245], v5 offset:8480
    v_mfma_f32_16x16x32_bf16 v[84:87], v[228:231], v[92:95], 0
    ds_read_b64_tr_b16 v[246:247], v5 offset:9504
    s_waitcnt vmcnt(7) lgkmcnt(6)
    v_mfma_f32_16x16x32_bf16 v[24:27], v[232:235], v[96:99], v[24:27]
    ds_read_b64_tr_b16 v[224:225], v4 offset:8704
    s_waitcnt vmcnt(6)
    v_mfma_f32_16x16x32_bf16 v[28:31], v[232:235], v[100:103], v[28:31]
    ds_read_b64_tr_b16 v[226:227], v4 offset:9728
    s_waitcnt lgkmcnt(6)
    v_mfma_f32_16x16x32_bf16 v[32:35], v[236:239], v[96:99], v[32:35]
    ds_read_b64_tr_b16 v[228:229], v5 offset:8736
    v_mfma_f32_16x16x32_bf16 v[36:39], v[236:239], v[100:103], v[36:39]
    ds_read_b64_tr_b16 v[230:231], v5 offset:9760
    s_mov_b32 s23, 0x1000
    buffer_load_dwordx4 v[128:131], v7, s[8:11], s23 offen offset:1024 sc1
    s_waitcnt lgkmcnt(6)
    v_mfma_f32_16x16x32_bf16 v[40:43], v[240:243], v[96:99], v[40:43]
    ds_read_b64_tr_b16 v[232:233], v4 offset:8960
    v_mfma_f32_16x16x32_bf16 v[44:47], v[240:243], v[100:103], v[44:47]
    ds_read_b64_tr_b16 v[234:235], v4 offset:9984
    s_waitcnt lgkmcnt(6)
    v_mfma_f32_16x16x32_bf16 v[48:51], v[244:247], v[96:99], v[48:51]
    ds_read_b64_tr_b16 v[236:237], v5 offset:8992
    v_mfma_f32_16x16x32_bf16 v[52:55], v[244:247], v[100:103], v[52:55]
    ds_read_b64_tr_b16 v[238:239], v5 offset:10016
    s_waitcnt lgkmcnt(6)
    v_mfma_f32_16x16x32_bf16 v[56:59], v[224:227], v[96:99], v[56:59]
    v_mfma_f32_16x16x32_bf16 v[60:63], v[224:227], v[100:103], v[60:63]
    s_barrier
    ds_read_b64_tr_b16 v[240:241], v4 offset:16384
    ds_read_b64_tr_b16 v[242:243], v4 offset:17408
    s_waitcnt lgkmcnt(6)
    v_mfma_f32_16x16x32_bf16 v[64:67], v[228:231], v[96:99], v[64:67]
    ds_read_b64_tr_b16 v[244:245], v5 offset:16416
    v_mfma_f32_16x16x32_bf16 v[68:71], v[228:231], v[100:103], v[68:71]
    s_add_u32 s22, s19, 0x180000
    s_add_u32 m0, s20, 0xc000
    s_nop 0
    buffer_load_dwordx4 v3, s[4:7], s22 offen lds
    ds_read_b64_tr_b16 v[246:247], v5 offset:17440
    s_mov_b32 s23, 0x9000
    buffer_load_dwordx4 v[132:135], v7, s[8:11], s23 offen offset:1024 sc1
    s_waitcnt lgkmcnt(6)
    v_mfma_f32_16x16x32_bf16 v[72:75], v[232:235], v[96:99], v[72:75]
    ds_read_b64_tr_b16 v[224:225], v4 offset:16640
    v_mfma_f32_16x16x32_bf16 v[76:79], v[232:235], v[100:103], v[76:79]
    ds_read_b64_tr_b16 v[226:227], v4 offset:17664
    s_waitcnt lgkmcnt(6)
    v_mfma_f32_16x16x32_bf16 v[80:83], v[236:239], v[96:99], v[80:83]
    ds_read_b64_tr_b16 v[228:229], v5 offset:16672
    v_mfma_f32_16x16x32_bf16 v[84:87], v[236:239], v[100:103], v[84:87]
    ds_read_b64_tr_b16 v[230:231], v5 offset:17696
    s_waitcnt vmcnt(8) lgkmcnt(6)
    v_mfma_f32_16x16x32_bf16 v[24:27], v[240:243], v[104:107], v[24:27]
    ds_read_b64_tr_b16 v[232:233], v4 offset:16896
    s_waitcnt vmcnt(7)
    v_mfma_f32_16x16x32_bf16 v[28:31], v[240:243], v[108:111], v[28:31]
    ds_read_b64_tr_b16 v[234:235], v4 offset:17920
    s_waitcnt lgkmcnt(6)
    v_mfma_f32_16x16x32_bf16 v[32:35], v[244:247], v[104:107], v[32:35]
    ds_read_b64_tr_b16 v[236:237], v5 offset:16928
    v_mfma_f32_16x16x32_bf16 v[36:39], v[244:247], v[108:111], v[36:39]
    s_add_u32 s22, s19, 0x188000
    s_add_u32 m0, s20, 0xc400
    s_nop 0
    buffer_load_dwordx4 v3, s[4:7], s22 offen lds
    ds_read_b64_tr_b16 v[238:239], v5 offset:17952
    s_mov_b32 s23, 0x1800
    buffer_load_dwordx4 v[88:91], v7, s[8:11], s23 offen offset:0 sc1
    s_waitcnt lgkmcnt(6)
    v_mfma_f32_16x16x32_bf16 v[40:43], v[224:227], v[104:107], v[40:43]
    ds_read_b64_tr_b16 v[240:241], v4 offset:17152
    v_mfma_f32_16x16x32_bf16 v[44:47], v[224:227], v[108:111], v[44:47]
    ds_read_b64_tr_b16 v[242:243], v4 offset:18176
    s_waitcnt lgkmcnt(6)
    v_mfma_f32_16x16x32_bf16 v[48:51], v[228:231], v[104:107], v[48:51]
    ds_read_b64_tr_b16 v[244:245], v5 offset:17184
    v_mfma_f32_16x16x32_bf16 v[52:55], v[228:231], v[108:111], v[52:55]
    ds_read_b64_tr_b16 v[246:247], v5 offset:18208
    s_waitcnt lgkmcnt(6)
    v_mfma_f32_16x16x32_bf16 v[56:59], v[232:235], v[104:107], v[56:59]
    ds_read_b64_tr_b16 v[224:225], v4 offset:24576
    v_mfma_f32_16x16x32_bf16 v[60:63], v[232:235], v[108:111], v[60:63]
    ds_read_b64_tr_b16 v[226:227], v4 offset:25600
    s_waitcnt lgkmcnt(6)
    v_mfma_f32_16x16x32_bf16 v[64:67], v[236:239], v[104:107], v[64:67]
    ds_read_b64_tr_b16 v[228:229], v5 offset:24608
    v_mfma_f32_16x16x32_bf16 v[68:71], v[236:239], v[108:111], v[68:71]
    ds_read_b64_tr_b16 v[230:231], v5 offset:25632
    s_mov_b32 s23, 0x9800
    buffer_load_dwordx4 v[92:95], v7, s[8:11], s23 offen offset:0 sc1
    s_waitcnt lgkmcnt(6)
    v_mfma_f32_16x16x32_bf16 v[72:75], v[240:243], v[104:107], v[72:75]
    ds_read_b64_tr_b16 v[232:233], v4 offset:24832
    v_mfma_f32_16x16x32_bf16 v[76:79], v[240:243], v[108:111], v[76:79]
    ds_read_b64_tr_b16 v[234:235], v4 offset:25856
    s_waitcnt lgkmcnt(6)
    v_mfma_f32_16x16x32_bf16 v[80:83], v[244:247], v[104:107], v[80:83]
    ds_read_b64_tr_b16 v[236:237], v5 offset:24864
    v_mfma_f32_16x16x32_bf16 v[84:87], v[244:247], v[108:111], v[84:87]
    ds_read_b64_tr_b16 v[238:239], v5 offset:25888
    s_waitcnt vmcnt(9) lgkmcnt(6)
    v_mfma_f32_16x16x32_bf16 v[24:27], v[224:227], v[112:115], v[24:27]
    ds_read_b64_tr_b16 v[240:241], v4 offset:25088
    s_waitcnt vmcnt(8)
    v_mfma_f32_16x16x32_bf16 v[28:31], v[224:227], v[116:119], v[28:31]
    ds_read_b64_tr_b16 v[242:243], v4 offset:26112
    s_waitcnt lgkmcnt(6)
    v_mfma_f32_16x16x32_bf16 v[32:35], v[228:231], v[112:115], v[32:35]
    ds_read_b64_tr_b16 v[244:245], v5 offset:25120
    v_mfma_f32_16x16x32_bf16 v[36:39], v[228:231], v[116:119], v[36:39]
    ds_read_b64_tr_b16 v[246:247], v5 offset:26144
    s_mov_b32 s23, 0x1800
    buffer_load_dwordx4 v[96:99], v7, s[8:11], s23 offen offset:1024 sc1
    s_waitcnt lgkmcnt(6)
    v_mfma_f32_16x16x32_bf16 v[40:43], v[232:235], v[112:115], v[40:43]
    ds_read_b64_tr_b16 v[224:225], v4 offset:25344
    v_mfma_f32_16x16x32_bf16 v[44:47], v[232:235], v[116:119], v[44:47]
    ds_read_b64_tr_b16 v[226:227], v4 offset:26368
    s_waitcnt lgkmcnt(6)
    v_mfma_f32_16x16x32_bf16 v[48:51], v[236:239], v[112:115], v[48:51]
    ds_read_b64_tr_b16 v[228:229], v5 offset:25376
    v_mfma_f32_16x16x32_bf16 v[52:55], v[236:239], v[116:119], v[52:55]
    ds_read_b64_tr_b16 v[230:231], v5 offset:26400
    s_waitcnt lgkmcnt(6)
    v_mfma_f32_16x16x32_bf16 v[56:59], v[240:243], v[112:115], v[56:59]
    v_mfma_f32_16x16x32_bf16 v[60:63], v[240:243], v[116:119], v[60:63]
    s_barrier
    ds_read_b64_tr_b16 v[232:233], v4 offset:32768
    ds_read_b64_tr_b16 v[234:235], v4 offset:33792
    s_waitcnt lgkmcnt(6)
    v_mfma_f32_16x16x32_bf16 v[64:67], v[244:247], v[112:115], v[64:67]
    ds_read_b64_tr_b16 v[236:237], v5 offset:32800
    v_mfma_f32_16x16x32_bf16 v[68:71], v[244:247], v[116:119], v[68:71]
    s_add_u32 s22, s19, 0x200000
    s_add_u32 m0, s20, 0x0
    s_nop 0
    buffer_load_dwordx4 v3, s[4:7], s22 offen lds
    ds_read_b64_tr_b16 v[238:239], v5 offset:33824
    s_mov_b32 s23, 0x9800
    buffer_load_dwordx4 v[100:103], v7, s[8:11], s23 offen offset:1024 sc1
    s_waitcnt lgkmcnt(6)
    v_mfma_f32_16x16x32_bf16 v[72:75], v[224:227], v[112:115], v[72:75]
    ds_read_b64_tr_b16 v[240:241], v4 offset:33024
    v_mfma_f32_16x16x32_bf16 v[76:79], v[224:227], v[116:119], v[76:79]
    ds_read_b64_tr_b16 v[242:243], v4 offset:34048
    s_waitcnt lgkmcnt(6)
    v_mfma_f32_16x16x32_bf16 v[80:83], v[228:231], v[112:115], v[80:83]
    ds_read_b64_tr_b16 v[244:245], v5 offset:33056
    v_mfma_f32_16x16x32_bf16 v[84:87], v[228:231], v[116:119], v[84:87]
    ds_read_b64_tr_b16 v[246:247], v5 offset:34080
    s_waitcnt vmcnt(10) lgkmcnt(6)
    v_mfma_f32_16x16x32_bf16 v[24:27], v[232:235], v[120:123], v[24:27]
    ds_read_b64_tr_b16 v[224:225], v4 offset:33280
    s_waitcnt vmcnt(9)
    v_mfma_f32_16x16x32_bf16 v[28:31], v[232:235], v[124:127], v[28:31]
    ds_read_b64_tr_b16 v[226:227], v4 offset:34304
    s_waitcnt lgkmcnt(6)
    v_mfma_f32_16x16x32_bf16 v[32:35], v[236:239], v[120:123], v[32:35]
    ds_read_b64_tr_b16 v[228:229], v5 offset:33312
    v_mfma_f32_16x16x32_bf16 v[36:39], v[236:239], v[124:127], v[36:39]
    s_add_u32 s22, s19, 0x208000
    s_add_u32 m0, s20, 0x400
    s_nop 0
    buffer_load_dwordx4 v3, s[4:7], s22 offen lds
    ds_read_b64_tr_b16 v[230:231], v5 offset:34336
    s_mov_b32 s23, 0x2000
    buffer_load_dwordx4 v[104:107], v7, s[8:11], s23 offen offset:0 sc1
    s_waitcnt lgkmcnt(6)
    v_mfma_f32_16x16x32_bf16 v[40:43], v[240:243], v[120:123], v[40:43]
    ds_read_b64_tr_b16 v[232:233], v4 offset:33536
    v_mfma_f32_16x16x32_bf16 v[44:47], v[240:243], v[124:127], v[44:47]
    ds_read_b64_tr_b16 v[234:235], v4 offset:34560
    s_waitcnt lgkmcnt(6)
    v_mfma_f32_16x16x32_bf16 v[48:51], v[244:247], v[120:123], v[48:51]
    ds_read_b64_tr_b16 v[236:237], v5 offset:33568
    v_mfma_f32_16x16x32_bf16 v[52:55], v[244:247], v[124:127], v[52:55]
    ds_read_b64_tr_b16 v[238:239], v5 offset:34592
    s_waitcnt lgkmcnt(6)
    v_mfma_f32_16x16x32_bf16 v[56:59], v[224:227], v[120:123], v[56:59]
    ds_read_b64_tr_b16 v[240:241], v4 offset:40960
    v_mfma_f32_16x16x32_bf16 v[60:63], v[224:227], v[124:127], v[60:63]
    ds_read_b64_tr_b16 v[242:243], v4 offset:41984
    s_waitcnt lgkmcnt(6)
    v_mfma_f32_16x16x32_bf16 v[64:67], v[228:231], v[120:123], v[64:67]
    ds_read_b64_tr_b16 v[244:245], v5 offset:40992
    v_mfma_f32_16x16x32_bf16 v[68:71], v[228:231], v[124:127], v[68:71]
    ds_read_b64_tr_b16 v[246:247], v5 offset:42016
    s_mov_b32 s23, 0xa000
    buffer_load_dwordx4 v[108:111], v7, s[8:11], s23 offen offset:0 sc1
    s_waitcnt lgkmcnt(6)
    v_mfma_f32_16x16x32_bf16 v[72:75], v[232:235], v[120:123], v[72:75]
    ds_read_b64_tr_b16 v[224:225], v4 offset:41216
    v_mfma_f32_16x16x32_bf16 v[76:79], v[232:235], v[124:127], v[76:79]
    ds_read_b64_tr_b16 v[226:227], v4 offset:42240
    s_waitcnt lgkmcnt(6)
    v_mfma_f32_16x16x32_bf16 v[80:83], v[236:239], v[120:123], v[80:83]
    ds_read_b64_tr_b16 v[228:229], v5 offset:41248
    v_mfma_f32_16x16x32_bf16 v[84:87], v[236:239], v[124:127], v[84:87]
    ds_read_b64_tr_b16 v[230:231], v5 offset:42272
    s_waitcnt vmcnt(11) lgkmcnt(6)
    v_mfma_f32_16x16x32_bf16 v[24:27], v[240:243], v[128:131], v[24:27]
    ds_read_b64_tr_b16 v[232:233], v4 offset:41472
    s_waitcnt vmcnt(9)
    v_mfma_f32_16x16x32_bf16 v[28:31], v[240:243], v[132:135], v[28:31]
    ds_read_b64_tr_b16 v[234:235], v4 offset:42496
    s_waitcnt lgkmcnt(6)
    v_mfma_f32_16x16x32_bf16 v[32:35], v[244:247], v[128:131], v[32:35]
    ds_read_b64_tr_b16 v[236:237], v5 offset:41504
    v_mfma_f32_16x16x32_bf16 v[36:39], v[244:247], v[132:135], v[36:39]
    ds_read_b64_tr_b16 v[238:239], v5 offset:42528
    s_mov_b32 s23, 0x2000
    buffer_load_dwordx4 v[112:115], v7, s[8:11], s23 offen offset:1024 sc1
    s_waitcnt lgkmcnt(6)
    v_mfma_f32_16x16x32_bf16 v[40:43], v[224:227], v[128:131], v[40:43]
    ds_read_b64_tr_b16 v[240:241], v4 offset:41728
    v_mfma_f32_16x16x32_bf16 v[44:47], v[224:227], v[132:135], v[44:47]
    ds_read_b64_tr_b16 v[242:243], v4 offset:42752
    s_waitcnt lgkmcnt(6)
    v_mfma_f32_16x16x32_bf16 v[48:51], v[228:231], v[128:131], v[48:51]
    ds_read_b64_tr_b16 v[244:245], v5 offset:41760
    v_mfma_f32_16x16x32_bf16 v[52:55], v[228:231], v[132:135], v[52:55]
    ds_read_b64_tr_b16 v[246:247], v5 offset:42784
    s_waitcnt lgkmcnt(6)
    v_mfma_f32_16x16x32_bf16 v[56:59], v[232:235], v[128:131], v[56:59]
    v_mfma_f32_16x16x32_bf16 v[60:63], v[232:235], v[132:135], v[60:63]
    s_waitcnt vmcnt(9)
    s_barrier
    ds_read_b64_tr_b16 v[224:225], v4 offset:49152
    ds_read_b64_tr_b16 v[226:227], v4 offset:50176
    s_waitcnt lgkmcnt(6)
    v_mfma_f32_16x16x32_bf16 v[64:67], v[236:239], v[128:131], v[64:67]
    ds_read_b64_tr_b16 v[228:229], v5 offset:49184
    v_mfma_f32_16x16x32_bf16 v[68:71], v[236:239], v[132:135], v[68:71]
    s_add_u32 s22, s19, 0x280000
    s_add_u32 m0, s20, 0x4000
    s_nop 0
    buffer_load_dwordx4 v3, s[4:7], s22 offen lds
    ds_read_b64_tr_b16 v[230:231], v5 offset:50208
    s_mov_b32 s23, 0xa000
    buffer_load_dwordx4 v[116:119], v7, s[8:11], s23 offen offset:1024 sc1
    s_waitcnt lgkmcnt(6)
    v_mfma_f32_16x16x32_bf16 v[72:75], v[240:243], v[128:131], v[72:75]
    ds_read_b64_tr_b16 v[232:233], v4 offset:49408
    v_mfma_f32_16x16x32_bf16 v[76:79], v[240:243], v[132:135], v[76:79]
    ds_read_b64_tr_b16 v[234:235], v4 offset:50432
    s_waitcnt lgkmcnt(6)
    v_mfma_f32_16x16x32_bf16 v[80:83], v[244:247], v[128:131], v[80:83]
    ds_read_b64_tr_b16 v[236:237], v5 offset:49440
    v_mfma_f32_16x16x32_bf16 v[84:87], v[244:247], v[132:135], v[84:87]
    ds_read_b64_tr_b16 v[238:239], v5 offset:50464
    s_waitcnt vmcnt(10) lgkmcnt(6)
    v_mfma_f32_16x16x32_bf16 v[24:27], v[224:227], v[88:91], v[24:27]
    ds_read_b64_tr_b16 v[240:241], v4 offset:49664
    s_waitcnt vmcnt(9)
    v_mfma_f32_16x16x32_bf16 v[28:31], v[224:227], v[92:95], v[28:31]
    ds_read_b64_tr_b16 v[242:243], v4 offset:50688
    s_waitcnt lgkmcnt(6)
    v_mfma_f32_16x16x32_bf16 v[32:35], v[228:231], v[88:91], v[32:35]
    ds_read_b64_tr_b16 v[244:245], v5 offset:49696
    v_mfma_f32_16x16x32_bf16 v[36:39], v[228:231], v[92:95], v[36:39]
    s_add_u32 s22, s19, 0x288000
    s_add_u32 m0, s20, 0x4400
    s_nop 0
    buffer_load_dwordx4 v3, s[4:7], s22 offen lds
    ds_read_b64_tr_b16 v[246:247], v5 offset:50720
    s_mov_b32 s23, 0x2800
    buffer_load_dwordx4 v[120:123], v7, s[8:11], s23 offen offset:0 sc1
    s_waitcnt lgkmcnt(6)
    v_mfma_f32_16x16x32_bf16 v[40:43], v[232:235], v[88:91], v[40:43]
    ds_read_b64_tr_b16 v[224:225], v4 offset:49920
    v_mfma_f32_16x16x32_bf16 v[44:47], v[232:235], v[92:95], v[44:47]
    ds_read_b64_tr_b16 v[226:227], v4 offset:50944
    s_waitcnt lgkmcnt(6)
    v_mfma_f32_16x16x32_bf16 v[48:51], v[236:239], v[88:91], v[48:51]
    ds_read_b64_tr_b16 v[228:229], v5 offset:49952
    v_mfma_f32_16x16x32_bf16 v[52:55], v[236:239], v[92:95], v[52:55]
    ds_read_b64_tr_b16 v[230:231], v5 offset:50976
    s_waitcnt lgkmcnt(6)
    v_mfma_f32_16x16x32_bf16 v[56:59], v[240:243], v[88:91], v[56:59]
    ds_read_b64_tr_b16 v[232:233], v4 offset:57344
    v_mfma_f32_16x16x32_bf16 v[60:63], v[240:243], v[92:95], v[60:63]
    ds_read_b64_tr_b16 v[234:235], v4 offset:58368
    s_waitcnt lgkmcnt(6)
    v_mfma_f32_16x16x32_bf16 v[64:67], v[244:247], v[88:91], v[64:67]
    ds_read_b64_tr_b16 v[236:237], v5 offset:57376
    v_mfma_f32_16x16x32_bf16 v[68:71], v[244:247], v[92:95], v[68:71]
    ds_read_b64_tr_b16 v[238:239], v5 offset:58400
    s_mov_b32 s23, 0xa800
    buffer_load_dwordx4 v[124:127], v7, s[8:11], s23 offen offset:0 sc1
    s_waitcnt lgkmcnt(6)
    v_mfma_f32_16x16x32_bf16 v[72:75], v[224:227], v[88:91], v[72:75]
    ds_read_b64_tr_b16 v[240:241], v4 offset:57600
    v_mfma_f32_16x16x32_bf16 v[76:79], v[224:227], v[92:95], v[76:79]
    ds_read_b64_tr_b16 v[242:243], v4 offset:58624
    s_waitcnt lgkmcnt(6)
    v_mfma_f32_16x16x32_bf16 v[80:83], v[228:231], v[88:91], v[80:83]
    ds_read_b64_tr_b16 v[244:245], v5 offset:57632
    v_mfma_f32_16x16x32_bf16 v[84:87], v[228:231], v[92:95], v[84:87]
    ds_read_b64_tr_b16 v[246:247], v5 offset:58656
    s_waitcnt vmcnt(11) lgkmcnt(6)
    v_mfma_f32_16x16x32_bf16 v[24:27], v[232:235], v[96:99], v[24:27]
    ds_read_b64_tr_b16 v[224:225], v4 offset:57856
    s_waitcnt vmcnt(9)
    v_mfma_f32_16x16x32_bf16 v[28:31], v[232:235], v[100:103], v[28:31]
    ds_read_b64_tr_b16 v[226:227], v4 offset:58880
    s_waitcnt lgkmcnt(6)
    v_mfma_f32_16x16x32_bf16 v[32:35], v[236:239], v[96:99], v[32:35]
    ds_read_b64_tr_b16 v[228:229], v5 offset:57888
    v_mfma_f32_16x16x32_bf16 v[36:39], v[236:239], v[100:103], v[36:39]
    ds_read_b64_tr_b16 v[230:231], v5 offset:58912
    s_mov_b32 s23, 0x2800
    buffer_load_dwordx4 v[128:131], v7, s[8:11], s23 offen offset:1024 sc1
    s_waitcnt lgkmcnt(6)
    v_mfma_f32_16x16x32_bf16 v[40:43], v[240:243], v[96:99], v[40:43]
    ds_read_b64_tr_b16 v[232:233], v4 offset:58112
    v_mfma_f32_16x16x32_bf16 v[44:47], v[240:243], v[100:103], v[44:47]
    ds_read_b64_tr_b16 v[234:235], v4 offset:59136
    s_waitcnt lgkmcnt(6)
    v_mfma_f32_16x16x32_bf16 v[48:51], v[244:247], v[96:99], v[48:51]
    ds_read_b64_tr_b16 v[236:237], v5 offset:58144
    v_mfma_f32_16x16x32_bf16 v[52:55], v[244:247], v[100:103], v[52:55]
    ds_read_b64_tr_b16 v[238:239], v5 offset:59168
    s_waitcnt lgkmcnt(6)
    v_mfma_f32_16x16x32_bf16 v[56:59], v[224:227], v[96:99], v[56:59]
    v_mfma_f32_16x16x32_bf16 v[60:63], v[224:227], v[100:103], v[60:63]
    s_waitcnt vmcnt(9)
    s_barrier
    ds_read_b64_tr_b16 v[240:241], v4 offset:0
    ds_read_b64_tr_b16 v[242:243], v4 offset:1024
    s_waitcnt lgkmcnt(6)
    v_mfma_f32_16x16x32_bf16 v[64:67], v[228:231], v[96:99], v[64:67]
    ds_read_b64_tr_b16 v[244:245], v5 offset:32
    v_mfma_f32_16x16x32_bf16 v[68:71], v[228:231], v[100:103], v[68:71]
    s_add_u32 s22, s19, 0x300000
    s_add_u32 m0, s20, 0x8000
    s_nop 0
    buffer_load_dwordx4 v3, s[4:7], s22 offen lds
    ds_read_b64_tr_b16 v[246:247], v5 offset:1056
    s_mov_b32 s23, 0xa800
    buffer_load_dwordx4 v[132:135], v7, s[8:11], s23 offen offset:1024 sc1
    s_waitcnt lgkmcnt(6)
    v_mfma_f32_16x16x32_bf16 v[72:75], v[232:235], v[96:99], v[72:75]
    ds_read_b64_tr_b16 v[224:225], v4 offset:256
    v_mfma_f32_16x16x32_bf16 v[76:79], v[232:235], v[100:103], v[76:79]
    ds_read_b64_tr_b16 v[226:227], v4 offset:1280
    s_waitcnt lgkmcnt(6)
    v_mfma_f32_16x16x32_bf16 v[80:83], v[236:239], v[96:99], v[80:83]
    ds_read_b64_tr_b16 v[228:229], v5 offset:288
    v_mfma_f32_16x16x32_bf16 v[84:87], v[236:239], v[100:103], v[84:87]
    ds_read_b64_tr_b16 v[230:231], v5 offset:1312
    s_waitcnt vmcnt(10) lgkmcnt(6)
    v_mfma_f32_16x16x32_bf16 v[24:27], v[240:243], v[104:107], v[24:27]
    ds_read_b64_tr_b16 v[232:233], v4 offset:512
    s_waitcnt vmcnt(9)
    v_mfma_f32_16x16x32_bf16 v[28:31], v[240:243], v[108:111], v[28:31]
    ds_read_b64_tr_b16 v[234:235], v4 offset:1536
    s_waitcnt lgkmcnt(6)
    v_mfma_f32_16x16x32_bf16 v[32:35], v[244:247], v[104:107], v[32:35]
    ds_read_b64_tr_b16 v[236:237], v5 offset:544
    v_mfma_f32_16x16x32_bf16 v[36:39], v[244:247], v[108:111], v[36:39]
    s_add_u32 s22, s19, 0x308000
    s_add_u32 m0, s20, 0x8400
    s_nop 0
    buffer_load_dwordx4 v3, s[4:7], s22 offen lds
    ds_read_b64_tr_b16 v[238:239], v5 offset:1568
    s_mov_b32 s23, 0x3000
    buffer_load_dwordx4 v[88:91], v7, s[8:11], s23 offen offset:0 sc1
    s_waitcnt lgkmcnt(6)
    v_mfma_f32_16x16x32_bf16 v[40:43], v[224:227], v[104:107], v[40:43]
    ds_read_b64_tr_b16 v[240:241], v4 offset:768
    v_mfma_f32_16x16x32_bf16 v[44:47], v[224:227], v[108:111], v[44:47]
    ds_read_b64_tr_b16 v[242:243], v4 offset:1792
    s_waitcnt lgkmcnt(6)
    v_mfma_f32_16x16x32_bf16 v[48:51], v[228:231], v[104:107], v[48:51]
    ds_read_b64_tr_b16 v[244:245], v5 offset:800
    v_mfma_f32_16x16x32_bf16 v[52:55], v[228:231], v[108:111], v[52:55]
    ds_read_b64_tr_b16 v[246:247], v5 offset:1824
    s_waitcnt lgkmcnt(6)
    v_mfma_f32_16x16x32_bf16 v[56:59], v[232:235], v[104:107], v[56:59]
    ds_read_b64_tr_b16 v[224:225], v4 offset:8192
    v_mfma_f32_16x16x32_bf16 v[60:63], v[232:235], v[108:111], v[60:63]
    ds_read_b64_tr_b16 v[226:227], v4 offset:9216
    s_waitcnt lgkmcnt(6)
    v_mfma_f32_16x16x32_bf16 v[64:67], v[236:239], v[104:107], v[64:67]
    ds_read_b64_tr_b16 v[228:229], v5 offset:8224
    v_mfma_f32_16x16x32_bf16 v[68:71], v[236:239], v[108:111], v[68:71]
    ds_read_b64_tr_b16 v[230:231], v5 offset:9248
    s_mov_b32 s23, 0xb000
    buffer_load_dwordx4 v[92:95], v7, s[8:11], s23 offen offset:0 sc1
    s_waitcnt lgkmcnt(6)
    v_mfma_f32_16x16x32_bf16 v[72:75], v[240:243], v[104:107], v[72:75]
    ds_read_b64_tr_b16 v[232:233], v4 offset:8448
    v_mfma_f32_16x16x32_bf16 v[76:79], v[240:243], v[108:111], v[76:79]
    ds_read_b64_tr_b16 v[234:235], v4 offset:9472
    s_waitcnt lgkmcnt(6)
    v_mfma_f32_16x16x32_bf16 v[80:83], v[244:247], v[104:107], v[80:83]
    ds_read_b64_tr_b16 v[236:237], v5 offset:8480
    v_mfma_f32_16x16x32_bf16 v[84:87], v[244:247], v[108:111], v[84:87]
    ds_read_b64_tr_b16 v[238:239], v5 offset:9504
    s_waitcnt vmcnt(11) lgkmcnt(6)
    v_mfma_f32_16x16x32_bf16 v[24:27], v[224:227], v[112:115], v[24:27]
    ds_read_b64_tr_b16 v[240:241], v4 offset:8704
    s_waitcnt vmcnt(9)
    v_mfma_f32_16x16x32_bf16 v[28:31], v[224:227], v[116:119], v[28:31]
    ds_read_b64_tr_b16 v[242:243], v4 offset:9728
    s_waitcnt lgkmcnt(6)
    v_mfma_f32_16x16x32_bf16 v[32:35], v[228:231], v[112:115], v[32:35]
    ds_read_b64_tr_b16 v[244:245], v5 offset:8736
    v_mfma_f32_16x16x32_bf16 v[36:39], v[228:231], v[116:119], v[36:39]
    ds_read_b64_tr_b16 v[246:247], v5 offset:9760
    s_mov_b32 s23, 0x3000
    buffer_load_dwordx4 v[96:99], v7, s[8:11], s23 offen offset:1024 sc1
    s_waitcnt lgkmcnt(6)
    v_mfma_f32_16x16x32_bf16 v[40:43], v[232:235], v[112:115], v[40:43]
    ds_read_b64_tr_b16 v[224:225], v4 offset:8960
    v_mfma_f32_16x16x32_bf16 v[44:47], v[232:235], v[116:119], v[44:47]
    ds_read_b64_tr_b16 v[226:227], v4 offset:9984
    s_waitcnt lgkmcnt(6)
    v_mfma_f32_16x16x32_bf16 v[48:51], v[236:239], v[112:115], v[48:51]
    ds_read_b64_tr_b16 v[228:229], v5 offset:8992
    v_mfma_f32_16x16x32_bf16 v[52:55], v[236:239], v[116:119], v[52:55]
    ds_read_b64_tr_b16 v[230:231], v5 offset:10016
    s_waitcnt lgkmcnt(6)
    v_mfma_f32_16x16x32_bf16 v[56:59], v[240:243], v[112:115], v[56:59]
    v_mfma_f32_16x16x32_bf16 v[60:63], v[240:243], v[116:119], v[60:63]
    s_waitcnt vmcnt(9)
    s_barrier
    ds_read_b64_tr_b16 v[232:233], v4 offset:16384
    ds_read_b64_tr_b16 v[234:235], v4 offset:17408
    s_waitcnt lgkmcnt(6)
    v_mfma_f32_16x16x32_bf16 v[64:67], v[244:247], v[112:115], v[64:67]
    ds_read_b64_tr_b16 v[236:237], v5 offset:16416
    v_mfma_f32_16x16x32_bf16 v[68:71], v[244:247], v[116:119], v[68:71]
    s_add_u32 s22, s19, 0x380000
    s_add_u32 m0, s20, 0xc000
    s_nop 0
    buffer_load_dwordx4 v3, s[4:7], s22 offen lds
    ds_read_b64_tr_b16 v[238:239], v5 offset:17440
    s_mov_b32 s23, 0xb000
    buffer_load_dwordx4 v[100:103], v7, s[8:11], s23 offen offset:1024 sc1
    s_waitcnt lgkmcnt(6)
    v_mfma_f32_16x16x32_bf16 v[72:75], v[224:227], v[112:115], v[72:75]
    ds_read_b64_tr_b16 v[240:241], v4 offset:16640
    v_mfma_f32_16x16x32_bf16 v[76:79], v[224:227], v[116:119], v[76:79]
    ds_read_b64_tr_b16 v[242:243], v4 offset:17664
    s_waitcnt lgkmcnt(6)
    v_mfma_f32_16x16x32_bf16 v[80:83], v[228:231], v[112:115], v[80:83]
    ds_read_b64_tr_b16 v[244:245], v5 offset:16672
    v_mfma_f32_16x16x32_bf16 v[84:87], v[228:231], v[116:119], v[84:87]
    ds_read_b64_tr_b16 v[246:247], v5 offset:17696
    s_waitcnt vmcnt(10) lgkmcnt(6)
    v_mfma_f32_16x16x32_bf16 v[24:27], v[232:235], v[120:123], v[24:27]
    ds_read_b64_tr_b16 v[224:225], v4 offset:16896
    s_waitcnt vmcnt(9)
    v_mfma_f32_16x16x32_bf16 v[28:31], v[232:235], v[124:127], v[28:31]
    ds_read_b64_tr_b16 v[226:227], v4 offset:17920
    s_waitcnt lgkmcnt(6)
    v_mfma_f32_16x16x32_bf16 v[32:35], v[236:239], v[120:123], v[32:35]
    ds_read_b64_tr_b16 v[228:229], v5 offset:16928
    v_mfma_f32_16x16x32_bf16 v[36:39], v[236:239], v[124:127], v[36:39]
    s_add_u32 s22, s19, 0x388000
    s_add_u32 m0, s20, 0xc400
    s_nop 0
    buffer_load_dwordx4 v3, s[4:7], s22 offen lds
    ds_read_b64_tr_b16 v[230:231], v5 offset:17952
    s_mov_b32 s23, 0x3800
    buffer_load_dwordx4 v[104:107], v7, s[8:11], s23 offen offset:0 sc1
    s_waitcnt lgkmcnt(6)
    v_mfma_f32_16x16x32_bf16 v[40:43], v[240:243], v[120:123], v[40:43]
    ds_read_b64_tr_b16 v[232:233], v4 offset:17152
    v_mfma_f32_16x16x32_bf16 v[44:47], v[240:243], v[124:127], v[44:47]
    ds_read_b64_tr_b16 v[234:235], v4 offset:18176
    s_waitcnt lgkmcnt(6)
    v_mfma_f32_16x16x32_bf16 v[48:51], v[244:247], v[120:123], v[48:51]
    ds_read_b64_tr_b16 v[236:237], v5 offset:17184
    v_mfma_f32_16x16x32_bf16 v[52:55], v[244:247], v[124:127], v[52:55]
    ds_read_b64_tr_b16 v[238:239], v5 offset:18208
    s_waitcnt lgkmcnt(6)
    v_mfma_f32_16x16x32_bf16 v[56:59], v[224:227], v[120:123], v[56:59]
    ds_read_b64_tr_b16 v[240:241], v4 offset:24576
    v_mfma_f32_16x16x32_bf16 v[60:63], v[224:227], v[124:127], v[60:63]
    ds_read_b64_tr_b16 v[242:243], v4 offset:25600
    s_waitcnt lgkmcnt(6)
    v_mfma_f32_16x16x32_bf16 v[64:67], v[228:231], v[120:123], v[64:67]
    ds_read_b64_tr_b16 v[244:245], v5 offset:24608
    v_mfma_f32_16x16x32_bf16 v[68:71], v[228:231], v[124:127], v[68:71]
    ds_read_b64_tr_b16 v[246:247], v5 offset:25632
    s_mov_b32 s23, 0xb800
    buffer_load_dwordx4 v[108:111], v7, s[8:11], s23 offen offset:0 sc1
    s_waitcnt lgkmcnt(6)
    v_mfma_f32_16x16x32_bf16 v[72:75], v[232:235], v[120:123], v[72:75]
    ds_read_b64_tr_b16 v[224:225], v4 offset:24832
    v_mfma_f32_16x16x32_bf16 v[76:79], v[232:235], v[124:127], v[76:79]
    ds_read_b64_tr_b16 v[226:227], v4 offset:25856
    s_waitcnt lgkmcnt(6)
    v_mfma_f32_16x16x32_bf16 v[80:83], v[236:239], v[120:123], v[80:83]
    ds_read_b64_tr_b16 v[228:229], v5 offset:24864
    v_mfma_f32_16x16x32_bf16 v[84:87], v[236:239], v[124:127], v[84:87]
    ds_read_b64_tr_b16 v[230:231], v5 offset:25888
    s_waitcnt vmcnt(11) lgkmcnt(6)
    v_mfma_f32_16x16x32_bf16 v[24:27], v[240:243], v[128:131], v[24:27]
    ds_read_b64_tr_b16 v[232:233], v4 offset:25088
    s_waitcnt vmcnt(9)
    v_mfma_f32_16x16x32_bf16 v[28:31], v[240:243], v[132:135], v[28:31]
    ds_read_b64_tr_b16 v[234:235], v4 offset:26112
    s_waitcnt lgkmcnt(6)
    v_mfma_f32_16x16x32_bf16 v[32:35], v[244:247], v[128:131], v[32:35]
    ds_read_b64_tr_b16 v[236:237], v5 offset:25120
    v_mfma_f32_16x16x32_bf16 v[36:39], v[244:247], v[132:135], v[36:39]
    ds_read_b64_tr_b16 v[238:239], v5 offset:26144
    s_mov_b32 s23, 0x3800
    buffer_load_dwordx4 v[112:115], v7, s[8:11], s23 offen offset:1024 sc1
    s_waitcnt lgkmcnt(6)
    v_mfma_f32_16x16x32_bf16 v[40:43], v[224:227], v[128:131], v[40:43]
    ds_read_b64_tr_b16 v[240:241], v4 offset:25344
    v_mfma_f32_16x16x32_bf16 v[44:47], v[224:227], v[132:135], v[44:47]
    ds_read_b64_tr_b16 v[242:243], v4 offset:26368
    s_waitcnt lgkmcnt(6)
    v_mfma_f32_16x16x32_bf16 v[48:51], v[228:231], v[128:131], v[48:51]
    ds_read_b64_tr_b16 v[244:245], v5 offset:25376
    v_mfma_f32_16x16x32_bf16 v[52:55], v[228:231], v[132:135], v[52:55]
    ds_read_b64_tr_b16 v[246:247], v5 offset:26400
    s_waitcnt lgkmcnt(6)
    v_mfma_f32_16x16x32_bf16 v[56:59], v[232:235], v[128:131], v[56:59]
    v_mfma_f32_16x16x32_bf16 v[60:63], v[232:235], v[132:135], v[60:63]
    s_waitcnt vmcnt(9)
    s_barrier
    ds_read_b64_tr_b16 v[224:225], v4 offset:32768
    ds_read_b64_tr_b16 v[226:227], v4 offset:33792
    s_waitcnt lgkmcnt(6)
    v_mfma_f32_16x16x32_bf16 v[64:67], v[236:239], v[128:131], v[64:67]
    ds_read_b64_tr_b16 v[228:229], v5 offset:32800
    v_mfma_f32_16x16x32_bf16 v[68:71], v[236:239], v[132:135], v[68:71]
    s_add_u32 s22, s19, 0x400000
    s_add_u32 m0, s20, 0x0
    s_nop 0
    buffer_load_dwordx4 v3, s[4:7], s22 offen lds
    ds_read_b64_tr_b16 v[230:231], v5 offset:33824
    s_mov_b32 s23, 0xb800
    buffer_load_dwordx4 v[116:119], v7, s[8:11], s23 offen offset:1024 sc1
    s_waitcnt lgkmcnt(6)
    v_mfma_f32_16x16x32_bf16 v[72:75], v[240:243], v[128:131], v[72:75]
    ds_read_b64_tr_b16 v[232:233], v4 offset:33024
    v_mfma_f32_16x16x32_bf16 v[76:79], v[240:243], v[132:135], v[76:79]
    ds_read_b64_tr_b16 v[234:235], v4 offset:34048
    s_waitcnt lgkmcnt(6)
    v_mfma_f32_16x16x32_bf16 v[80:83], v[244:247], v[128:131], v[80:83]
    ds_read_b64_tr_b16 v[236:237], v5 offset:33056
    v_mfma_f32_16x16x32_bf16 v[84:87], v[244:247], v[132:135], v[84:87]
    ds_read_b64_tr_b16 v[238:239], v5 offset:34080
    s_waitcnt vmcnt(10) lgkmcnt(6)
    v_mfma_f32_16x16x32_bf16 v[24:27], v[224:227], v[88:91], v[24:27]
    ds_read_b64_tr_b16 v[240:241], v4 offset:33280
    s_waitcnt vmcnt(9)
    v_mfma_f32_16x16x32_bf16 v[28:31], v[224:227], v[92:95], v[28:31]
    ds_read_b64_tr_b16 v[242:243], v4 offset:34304
    s_waitcnt lgkmcnt(6)
    v_mfma_f32_16x16x32_bf16 v[32:35], v[228:231], v[88:91], v[32:35]
    ds_read_b64_tr_b16 v[244:245], v5 offset:33312
    v_mfma_f32_16x16x32_bf16 v[36:39], v[228:231], v[92:95], v[36:39]
    s_add_u32 s22, s19, 0x408000
    s_add_u32 m0, s20, 0x400
    s_nop 0
    buffer_load_dwordx4 v3, s[4:7], s22 offen lds
    ds_read_b64_tr_b16 v[246:247], v5 offset:34336
    s_mov_b32 s23, 0x4000
    buffer_load_dwordx4 v[120:123], v7, s[8:11], s23 offen offset:0 sc1
    s_waitcnt lgkmcnt(6)
    v_mfma_f32_16x16x32_bf16 v[40:43], v[232:235], v[88:91], v[40:43]
    ds_read_b64_tr_b16 v[224:225], v4 offset:33536
    v_mfma_f32_16x16x32_bf16 v[44:47], v[232:235], v[92:95], v[44:47]
    ds_read_b64_tr_b16 v[226:227], v4 offset:34560
    s_waitcnt lgkmcnt(6)
    v_mfma_f32_16x16x32_bf16 v[48:51], v[236:239], v[88:91], v[48:51]
    ds_read_b64_tr_b16 v[228:229], v5 offset:33568
    v_mfma_f32_16x16x32_bf16 v[52:55], v[236:239], v[92:95], v[52:55]
    ds_read_b64_tr_b16 v[230:231], v5 offset:34592
    s_waitcnt lgkmcnt(6)
    v_mfma_f32_16x16x32_bf16 v[56:59], v[240:243], v[88:91], v[56:59]
    ds_read_b64_tr_b16 v[232:233], v4 offset:40960
    v_mfma_f32_16x16x32_bf16 v[60:63], v[240:243], v[92:95], v[60:63]
    ds_read_b64_tr_b16 v[234:235], v4 offset:41984
    s_waitcnt lgkmcnt(6)
    v_mfma_f32_16x16x32_bf16 v[64:67], v[244:247], v[88:91], v[64:67]
    ds_read_b64_tr_b16 v[236:237], v5 offset:40992
    v_mfma_f32_16x16x32_bf16 v[68:71], v[244:247], v[92:95], v[68:71]
    ds_read_b64_tr_b16 v[238:239], v5 offset:42016
    s_mov_b32 s23, 0xc000
    buffer_load_dwordx4 v[124:127], v7, s[8:11], s23 offen offset:0 sc1
    s_waitcnt lgkmcnt(6)
    v_mfma_f32_16x16x32_bf16 v[72:75], v[224:227], v[88:91], v[72:75]
    ds_read_b64_tr_b16 v[240:241], v4 offset:41216
    v_lshrrev_b32 v21, 4, v1
    v_lshlrev_b32 v21, 9, v21
    v_and_b32 v20, 15, v1
    v_lshl_add_u32 v21, v20, 4, v21
    s_lshr_b32 s18, s12, 3
    s_lshl_b32 s18, s18, 11
    s_add_u32 s18, s18, 0x528100
    buffer_load_dwordx4 v[12:15], v21, s[8:11], s18 offen sc1
    v_mfma_f32_16x16x32_bf16 v[76:79], v[224:227], v[92:95], v[76:79]
    ds_read_b64_tr_b16 v[242:243], v4 offset:42240
    s_waitcnt lgkmcnt(6)
    v_mfma_f32_16x16x32_bf16 v[80:83], v[228:231], v[88:91], v[80:83]
    ds_read_b64_tr_b16 v[244:245], v5 offset:41248
    v_mfma_f32_16x16x32_bf16 v[84:87], v[228:231], v[92:95], v[84:87]
    ds_read_b64_tr_b16 v[246:247], v5 offset:42272
    s_waitcnt vmcnt(12) lgkmcnt(6)
    v_mfma_f32_16x16x32_bf16 v[24:27], v[232:235], v[96:99], v[24:27]
    ds_read_b64_tr_b16 v[224:225], v4 offset:41472
    s_waitcnt vmcnt(10)
    v_mfma_f32_16x16x32_bf16 v[28:31], v[232:235], v[100:103], v[28:31]
    ds_read_b64_tr_b16 v[226:227], v4 offset:42496
    s_waitcnt lgkmcnt(6)
    v_mfma_f32_16x16x32_bf16 v[32:35], v[236:239], v[96:99], v[32:35]
    ds_read_b64_tr_b16 v[228:229], v5 offset:41504
    v_mfma_f32_16x16x32_bf16 v[36:39], v[236:239], v[100:103], v[36:39]
    ds_read_b64_tr_b16 v[230:231], v5 offset:42528
    s_mov_b32 s23, 0x4000
    buffer_load_dwordx4 v[128:131], v7, s[8:11], s23 offen offset:1024 sc1
    s_waitcnt lgkmcnt(6)
    v_mfma_f32_16x16x32_bf16 v[40:43], v[240:243], v[96:99], v[40:43]
    ds_read_b64_tr_b16 v[232:233], v4 offset:41728
    v_mfma_f32_16x16x32_bf16 v[44:47], v[240:243], v[100:103], v[44:47]
    ds_read_b64_tr_b16 v[234:235], v4 offset:42752
    s_waitcnt lgkmcnt(6)
    v_mfma_f32_16x16x32_bf16 v[48:51], v[244:247], v[96:99], v[48:51]
    ds_read_b64_tr_b16 v[236:237], v5 offset:41760
    v_mfma_f32_16x16x32_bf16 v[52:55], v[244:247], v[100:103], v[52:55]
    ds_read_b64_tr_b16 v[238:239], v5 offset:42784
    s_waitcnt lgkmcnt(6)
    v_mfma_f32_16x16x32_bf16 v[56:59], v[224:227], v[96:99], v[56:59]
    v_mfma_f32_16x16x32_bf16 v[60:63], v[224:227], v[100:103], v[60:63]
    s_waitcnt vmcnt(10)
    s_barrier
    ds_read_b64_tr_b16 v[240:241], v4 offset:49152
    ds_read_b64_tr_b16 v[242:243], v4 offset:50176
    s_waitcnt lgkmcnt(6)
    v_mfma_f32_16x16x32_bf16 v[64:67], v[228:231], v[96:99], v[64:67]
    ds_read_b64_tr_b16 v[244:245], v5 offset:49184
    v_mfma_f32_16x16x32_bf16 v[68:71], v[228:231], v[100:103], v[68:71]
    s_add_u32 s22, s19, 0x480000
    s_add_u32 m0, s20, 0x4000
    s_nop 0
    buffer_load_dwordx4 v3, s[4:7], s22 offen lds
    ds_read_b64_tr_b16 v[246:247], v5 offset:50208
    s_mov_b32 s23, 0xc000
    buffer_load_dwordx4 v[132:135], v7, s[8:11], s23 offen offset:1024 sc1
    s_waitcnt lgkmcnt(6)
    v_mfma_f32_16x16x32_bf16 v[72:75], v[232:235], v[96:99], v[72:75]
    ds_read_b64_tr_b16 v[224:225], v4 offset:49408
    v_mfma_f32_16x16x32_bf16 v[76:79], v[232:235], v[100:103], v[76:79]
    ds_read_b64_tr_b16 v[226:227], v4 offset:50432
    s_waitcnt lgkmcnt(6)
    v_mfma_f32_16x16x32_bf16 v[80:83], v[236:239], v[96:99], v[80:83]
    ds_read_b64_tr_b16 v[228:229], v5 offset:49440
    v_mfma_f32_16x16x32_bf16 v[84:87], v[236:239], v[100:103], v[84:87]
    ds_read_b64_tr_b16 v[230:231], v5 offset:50464
    s_waitcnt vmcnt(11) lgkmcnt(6)
    v_mfma_f32_16x16x32_bf16 v[24:27], v[240:243], v[104:107], v[24:27]
    ds_read_b64_tr_b16 v[232:233], v4 offset:49664
    s_waitcnt vmcnt(10)
    v_mfma_f32_16x16x32_bf16 v[28:31], v[240:243], v[108:111], v[28:31]
    ds_read_b64_tr_b16 v[234:235], v4 offset:50688
    s_waitcnt lgkmcnt(6)
    v_mfma_f32_16x16x32_bf16 v[32:35], v[244:247], v[104:107], v[32:35]
    ds_read_b64_tr_b16 v[236:237], v5 offset:49696
    v_mfma_f32_16x16x32_bf16 v[36:39], v[244:247], v[108:111], v[36:39]
    s_add_u32 s22, s19, 0x488000
    s_add_u32 m0, s20, 0x4400
    s_nop 0
    buffer_load_dwordx4 v3, s[4:7], s22 offen lds
    ds_read_b64_tr_b16 v[238:239], v5 offset:50720
    s_mov_b32 s23, 0x4800
    buffer_load_dwordx4 v[88:91], v7, s[8:11], s23 offen offset:0 sc1
    s_waitcnt lgkmcnt(6)
    v_mfma_f32_16x16x32_bf16 v[40:43], v[224:227], v[104:107], v[40:43]
    ds_read_b64_tr_b16 v[240:241], v4 offset:49920
    v_mfma_f32_16x16x32_bf16 v[44:47], v[224:227], v[108:111], v[44:47]
    ds_read_b64_tr_b16 v[242:243], v4 offset:50944
    s_waitcnt lgkmcnt(6)
    v_mfma_f32_16x16x32_bf16 v[48:51], v[228:231], v[104:107], v[48:51]
    ds_read_b64_tr_b16 v[244:245], v5 offset:49952
    v_mfma_f32_16x16x32_bf16 v[52:55], v[228:231], v[108:111], v[52:55]
    ds_read_b64_tr_b16 v[246:247], v5 offset:50976
    s_waitcnt lgkmcnt(6)
    v_mfma_f32_16x16x32_bf16 v[56:59], v[232:235], v[104:107], v[56:59]
    ds_read_b64_tr_b16 v[224:225], v4 offset:57344
    v_mfma_f32_16x16x32_bf16 v[60:63], v[232:235], v[108:111], v[60:63]
    ds_read_b64_tr_b16 v[226:227], v4 offset:58368
    s_waitcnt lgkmcnt(6)
    v_mfma_f32_16x16x32_bf16 v[64:67], v[236:239], v[104:107], v[64:67]
    ds_read_b64_tr_b16 v[228:229], v5 offset:57376
    v_mfma_f32_16x16x32_bf16 v[68:71], v[236:239], v[108:111], v[68:71]
    ds_read_b64_tr_b16 v[230:231], v5 offset:58400
    s_mov_b32 s23, 0xc800
    buffer_load_dwordx4 v[92:95], v7, s[8:11], s23 offen offset:0 sc1
    s_waitcnt lgkmcnt(6)
    v_mfma_f32_16x16x32_bf16 v[72:75], v[240:243], v[104:107], v[72:75]
    ds_read_b64_tr_b16 v[232:233], v4 offset:57600
    v_mfma_f32_16x16x32_bf16 v[76:79], v[240:243], v[108:111], v[76:79]
    ds_read_b64_tr_b16 v[234:235], v4 offset:58624
    s_waitcnt lgkmcnt(6)
    v_mfma_f32_16x16x32_bf16 v[80:83], v[244:247], v[104:107], v[80:83]
    ds_read_b64_tr_b16 v[236:237], v5 offset:57632
    v_mfma_f32_16x16x32_bf16 v[84:87], v[244:247], v[108:111], v[84:87]
    ds_read_b64_tr_b16 v[238:239], v5 offset:58656
    s_waitcnt vmcnt(12) lgkmcnt(6)
    v_mfma_f32_16x16x32_bf16 v[24:27], v[224:227], v[112:115], v[24:27]
    ds_read_b64_tr_b16 v[240:241], v4 offset:57856
    s_waitcnt vmcnt(10)
    v_mfma_f32_16x16x32_bf16 v[28:31], v[224:227], v[116:119], v[28:31]
    ds_read_b64_tr_b16 v[242:243], v4 offset:58880
    s_waitcnt lgkmcnt(6)
    v_mfma_f32_16x16x32_bf16 v[32:35], v[228:231], v[112:115], v[32:35]
    ds_read_b64_tr_b16 v[244:245], v5 offset:57888
    v_mfma_f32_16x16x32_bf16 v[36:39], v[228:231], v[116:119], v[36:39]
    ds_read_b64_tr_b16 v[246:247], v5 offset:58912
    s_mov_b32 s23, 0x4800
    buffer_load_dwordx4 v[96:99], v7, s[8:11], s23 offen offset:1024 sc1
    s_waitcnt lgkmcnt(6)
    v_mfma_f32_16x16x32_bf16 v[40:43], v[232:235], v[112:115], v[40:43]
    ds_read_b64_tr_b16 v[224:225], v4 offset:58112
    v_mfma_f32_16x16x32_bf16 v[44:47], v[232:235], v[116:119], v[44:47]
    ds_read_b64_tr_b16 v[226:227], v4 offset:59136
    s_waitcnt lgkmcnt(6)
    v_mfma_f32_16x16x32_bf16 v[48:51], v[236:239], v[112:115], v[48:51]
    ds_read_b64_tr_b16 v[228:229], v5 offset:58144
    v_mfma_f32_16x16x32_bf16 v[52:55], v[236:239], v[116:119], v[52:55]
    ds_read_b64_tr_b16 v[230:231], v5 offset:59168
    s_waitcnt lgkmcnt(6)
    v_mfma_f32_16x16x32_bf16 v[56:59], v[240:243], v[112:115], v[56:59]
    v_mfma_f32_16x16x32_bf16 v[60:63], v[240:243], v[116:119], v[60:63]
    s_waitcnt vmcnt(10)
    s_barrier
    ds_read_b64_tr_b16 v[232:233], v4 offset:0
    ds_read_b64_tr_b16 v[234:235], v4 offset:1024
    s_waitcnt lgkmcnt(6)
    v_mfma_f32_16x16x32_bf16 v[64:67], v[244:247], v[112:115], v[64:67]
    ds_read_b64_tr_b16 v[236:237], v5 offset:32
    v_mfma_f32_16x16x32_bf16 v[68:71], v[244:247], v[116:119], v[68:71]
    s_add_u32 s22, s19, 0x500000
    s_add_u32 m0, s20, 0x8000
    s_nop 0
    buffer_load_dwordx4 v3, s[4:7], s22 offen lds
    ds_read_b64_tr_b16 v[238:239], v5 offset:1056
    s_mov_b32 s23, 0xc800
    buffer_load_dwordx4 v[100:103], v7, s[8:11], s23 offen offset:1024 sc1
    s_waitcnt lgkmcnt(6)
    v_mfma_f32_16x16x32_bf16 v[72:75], v[224:227], v[112:115], v[72:75]
    ds_read_b64_tr_b16 v[240:241], v4 offset:256
    v_mfma_f32_16x16x32_bf16 v[76:79], v[224:227], v[116:119], v[76:79]
    ds_read_b64_tr_b16 v[242:243], v4 offset:1280
    s_waitcnt lgkmcnt(6)
    v_mfma_f32_16x16x32_bf16 v[80:83], v[228:231], v[112:115], v[80:83]
    ds_read_b64_tr_b16 v[244:245], v5 offset:288
    v_mfma_f32_16x16x32_bf16 v[84:87], v[228:231], v[116:119], v[84:87]
    ds_read_b64_tr_b16 v[246:247], v5 offset:1312
    s_waitcnt vmcnt(11) lgkmcnt(6)
    v_mfma_f32_16x16x32_bf16 v[24:27], v[232:235], v[120:123], v[24:27]
    ds_read_b64_tr_b16 v[224:225], v4 offset:512
    s_waitcnt vmcnt(10)
    v_mfma_f32_16x16x32_bf16 v[28:31], v[232:235], v[124:127], v[28:31]
    ds_read_b64_tr_b16 v[226:227], v4 offset:1536
    s_waitcnt lgkmcnt(6)
    v_mfma_f32_16x16x32_bf16 v[32:35], v[236:239], v[120:123], v[32:35]
    ds_read_b64_tr_b16 v[228:229], v5 offset:544
    v_mfma_f32_16x16x32_bf16 v[36:39], v[236:239], v[124:127], v[36:39]
    s_add_u32 s22, s19, 0x508000
    s_add_u32 m0, s20, 0x8400
    s_nop 0
    buffer_load_dwordx4 v3, s[4:7], s22 offen lds
    ds_read_b64_tr_b16 v[230:231], v5 offset:1568
    s_mov_b32 s23, 0x5000
    buffer_load_dwordx4 v[104:107], v7, s[8:11], s23 offen offset:0 sc1
    s_waitcnt lgkmcnt(6)
    v_mfma_f32_16x16x32_bf16 v[40:43], v[240:243], v[120:123], v[40:43]
    ds_read_b64_tr_b16 v[232:233], v4 offset:768
    v_mfma_f32_16x16x32_bf16 v[44:47], v[240:243], v[124:127], v[44:47]
    ds_read_b64_tr_b16 v[234:235], v4 offset:1792
    s_waitcnt lgkmcnt(6)
    v_mfma_f32_16x16x32_bf16 v[48:51], v[244:247], v[120:123], v[48:51]
    ds_read_b64_tr_b16 v[236:237], v5 offset:800
    v_mfma_f32_16x16x32_bf16 v[52:55], v[244:247], v[124:127], v[52:55]
    ds_read_b64_tr_b16 v[238:239], v5 offset:1824
    s_waitcnt lgkmcnt(6)
    v_mfma_f32_16x16x32_bf16 v[56:59], v[224:227], v[120:123], v[56:59]
    ds_read_b64_tr_b16 v[240:241], v4 offset:8192
    v_mfma_f32_16x16x32_bf16 v[60:63], v[224:227], v[124:127], v[60:63]
    ds_read_b64_tr_b16 v[242:243], v4 offset:9216
    s_waitcnt lgkmcnt(6)
    v_mfma_f32_16x16x32_bf16 v[64:67], v[228:231], v[120:123], v[64:67]
    ds_read_b64_tr_b16 v[244:245], v5 offset:8224
    v_mfma_f32_16x16x32_bf16 v[68:71], v[228:231], v[124:127], v[68:71]
    ds_read_b64_tr_b16 v[246:247], v5 offset:9248
    s_mov_b32 s23, 0xd000
    buffer_load_dwordx4 v[108:111], v7, s[8:11], s23 offen offset:0 sc1
    s_waitcnt lgkmcnt(6)
    v_mfma_f32_16x16x32_bf16 v[72:75], v[232:235], v[120:123], v[72:75]
    ds_read_b64_tr_b16 v[224:225], v4 offset:8448
    v_mfma_f32_16x16x32_bf16 v[76:79], v[232:235], v[124:127], v[76:79]
    ds_read_b64_tr_b16 v[226:227], v4 offset:9472
    s_waitcnt lgkmcnt(6)
    v_mfma_f32_16x16x32_bf16 v[80:83], v[236:239], v[120:123], v[80:83]
    ds_read_b64_tr_b16 v[228:229], v5 offset:8480
    v_mfma_f32_16x16x32_bf16 v[84:87], v[236:239], v[124:127], v[84:87]
    ds_read_b64_tr_b16 v[230:231], v5 offset:9504
    s_waitcnt vmcnt(11) lgkmcnt(6)
    v_mfma_f32_16x16x32_bf16 v[24:27], v[240:243], v[128:131], v[24:27]
    ds_read_b64_tr_b16 v[232:233], v4 offset:8704
    s_waitcnt vmcnt(9)
    v_mfma_f32_16x16x32_bf16 v[28:31], v[240:243], v[132:135], v[28:31]
    ds_read_b64_tr_b16 v[234:235], v4 offset:9728
    s_waitcnt lgkmcnt(6)
    v_mfma_f32_16x16x32_bf16 v[32:35], v[244:247], v[128:131], v[32:35]
    ds_read_b64_tr_b16 v[236:237], v5 offset:8736
    v_mfma_f32_16x16x32_bf16 v[36:39], v[244:247], v[132:135], v[36:39]
    ds_read_b64_tr_b16 v[238:239], v5 offset:9760
    s_mov_b32 s23, 0x5000
    buffer_load_dwordx4 v[112:115], v7, s[8:11], s23 offen offset:1024 sc1
    s_waitcnt lgkmcnt(6)
    v_mfma_f32_16x16x32_bf16 v[40:43], v[224:227], v[128:131], v[40:43]
    ds_read_b64_tr_b16 v[240:241], v4 offset:8960
    v_mfma_f32_16x16x32_bf16 v[44:47], v[224:227], v[132:135], v[44:47]
    ds_read_b64_tr_b16 v[242:243], v4 offset:9984
    s_waitcnt lgkmcnt(6)
    v_mfma_f32_16x16x32_bf16 v[48:51], v[228:231], v[128:131], v[48:51]
    ds_read_b64_tr_b16 v[244:245], v5 offset:8992
    v_mfma_f32_16x16x32_bf16 v[52:55], v[228:231], v[132:135], v[52:55]
    ds_read_b64_tr_b16 v[246:247], v5 offset:10016
    s_waitcnt lgkmcnt(6)
    v_mfma_f32_16x16x32_bf16 v[56:59], v[232:235], v[128:131], v[56:59]
    v_mfma_f32_16x16x32_bf16 v[60:63], v[232:235], v[132:135], v[60:63]
    s_waitcnt vmcnt(9)
    s_barrier
    ds_read_b64_tr_b16 v[224:225], v4 offset:16384
    ds_read_b64_tr_b16 v[226:227], v4 offset:17408
    s_waitcnt lgkmcnt(6)
    v_mfma_f32_16x16x32_bf16 v[64:67], v[236:239], v[128:131], v[64:67]
    ds_read_b64_tr_b16 v[228:229], v5 offset:16416
    v_mfma_f32_16x16x32_bf16 v[68:71], v[236:239], v[132:135], v[68:71]
    s_add_u32 s22, s19, 0x580000
    s_add_u32 m0, s20, 0xc000
    s_nop 0
    buffer_load_dwordx4 v3, s[4:7], s22 offen lds
    ds_read_b64_tr_b16 v[230:231], v5 offset:17440
    s_mov_b32 s23, 0xd000
    buffer_load_dwordx4 v[116:119], v7, s[8:11], s23 offen offset:1024 sc1
    s_waitcnt lgkmcnt(6)
    v_mfma_f32_16x16x32_bf16 v[72:75], v[240:243], v[128:131], v[72:75]
    ds_read_b64_tr_b16 v[232:233], v4 offset:16640
    v_mfma_f32_16x16x32_bf16 v[76:79], v[240:243], v[132:135], v[76:79]
    ds_read_b64_tr_b16 v[234:235], v4 offset:17664
    s_waitcnt lgkmcnt(6)
    v_mfma_f32_16x16x32_bf16 v[80:83], v[244:247], v[128:131], v[80:83]
    ds_read_b64_tr_b16 v[236:237], v5 offset:16672
    v_mfma_f32_16x16x32_bf16 v[84:87], v[244:247], v[132:135], v[84:87]
    ds_read_b64_tr_b16 v[238:239], v5 offset:17696
    s_waitcnt vmcnt(10) lgkmcnt(6)
    v_mfma_f32_16x16x32_bf16 v[24:27], v[224:227], v[88:91], v[24:27]
    ds_read_b64_tr_b16 v[240:241], v4 offset:16896
    s_waitcnt vmcnt(9)
    v_mfma_f32_16x16x32_bf16 v[28:31], v[224:227], v[92:95], v[28:31]
    ds_read_b64_tr_b16 v[242:243], v4 offset:17920
    s_waitcnt lgkmcnt(6)
    v_mfma_f32_16x16x32_bf16 v[32:35], v[228:231], v[88:91], v[32:35]
    ds_read_b64_tr_b16 v[244:245], v5 offset:16928
    v_mfma_f32_16x16x32_bf16 v[36:39], v[228:231], v[92:95], v[36:39]
    s_add_u32 s22, s19, 0x588000
    s_add_u32 m0, s20, 0xc400
    s_nop 0
    buffer_load_dwordx4 v3, s[4:7], s22 offen lds
    ds_read_b64_tr_b16 v[246:247], v5 offset:17952
    s_mov_b32 s23, 0x5800
    buffer_load_dwordx4 v[120:123], v7, s[8:11], s23 offen offset:0 sc1
    s_waitcnt lgkmcnt(6)
    v_mfma_f32_16x16x32_bf16 v[40:43], v[232:235], v[88:91], v[40:43]
    ds_read_b64_tr_b16 v[224:225], v4 offset:17152
    v_mfma_f32_16x16x32_bf16 v[44:47], v[232:235], v[92:95], v[44:47]
    ds_read_b64_tr_b16 v[226:227], v4 offset:18176
    s_waitcnt lgkmcnt(6)
    v_mfma_f32_16x16x32_bf16 v[48:51], v[236:239], v[88:91], v[48:51]
    ds_read_b64_tr_b16 v[228:229], v5 offset:17184
    v_mfma_f32_16x16x32_bf16 v[52:55], v[236:239], v[92:95], v[52:55]
    ds_read_b64_tr_b16 v[230:231], v5 offset:18208
    s_waitcnt lgkmcnt(6)
    v_mfma_f32_16x16x32_bf16 v[56:59], v[240:243], v[88:91], v[56:59]
    ds_read_b64_tr_b16 v[232:233], v4 offset:24576
    v_mfma_f32_16x16x32_bf16 v[60:63], v[240:243], v[92:95], v[60:63]
    ds_read_b64_tr_b16 v[234:235], v4 offset:25600
    s_waitcnt lgkmcnt(6)
    v_mfma_f32_16x16x32_bf16 v[64:67], v[244:247], v[88:91], v[64:67]
    ds_read_b64_tr_b16 v[236:237], v5 offset:24608
    v_mfma_f32_16x16x32_bf16 v[68:71], v[244:247], v[92:95], v[68:71]
    ds_read_b64_tr_b16 v[238:239], v5 offset:25632
    s_mov_b32 s23, 0xd800
    buffer_load_dwordx4 v[124:127], v7, s[8:11], s23 offen offset:0 sc1
    s_waitcnt lgkmcnt(6)
    v_mfma_f32_16x16x32_bf16 v[72:75], v[224:227], v[88:91], v[72:75]
    ds_read_b64_tr_b16 v[240:241], v4 offset:24832
    v_xor_b32 v8, s28, v12
    v_xor_b32 v20, s28, v13
    v_or_b32 v8, v8, v20
    v_xor_b32 v20, s28, v14
    v_or_b32 v8, v8, v20
    v_xor_b32 v20, s28, v15
    v_or_b32 v8, v8, v20
    v_cmp_ne_u32 vcc, 0, v8
    s_cbranch_vccnz adaLN_cond__sliding_block_cached__moe_arch_mod__prompt_kernel_kv4r
adaLN_cond__sliding_block_cached__moe_arch_mod__prompt_kernel_kv4b:
    v_mfma_f32_16x16x32_bf16 v[76:79], v[224:227], v[92:95], v[76:79]
    ds_read_b64_tr_b16 v[242:243], v4 offset:25856
    v_mov_b32 v20, 0
    s_mov_b32 s16, 0x564000
    buffer_load_dword v8, v20, s[8:11], s16 offen sc1
    s_waitcnt lgkmcnt(6)
    v_mfma_f32_16x16x32_bf16 v[80:83], v[228:231], v[88:91], v[80:83]
    ds_read_b64_tr_b16 v[244:245], v5 offset:24864
    v_mfma_f32_16x16x32_bf16 v[84:87], v[228:231], v[92:95], v[84:87]
    ds_read_b64_tr_b16 v[246:247], v5 offset:25888
    s_waitcnt vmcnt(12) lgkmcnt(6)
    v_mfma_f32_16x16x32_bf16 v[24:27], v[232:235], v[96:99], v[24:27]
    ds_read_b64_tr_b16 v[224:225], v4 offset:25088
    s_waitcnt vmcnt(10)
    v_mfma_f32_16x16x32_bf16 v[28:31], v[232:235], v[100:103], v[28:31]
    ds_read_b64_tr_b16 v[226:227], v4 offset:26112
    s_waitcnt lgkmcnt(6)
    v_mfma_f32_16x16x32_bf16 v[32:35], v[236:239], v[96:99], v[32:35]
    ds_read_b64_tr_b16 v[228:229], v5 offset:25120
    v_mfma_f32_16x16x32_bf16 v[36:39], v[236:239], v[100:103], v[36:39]
    ds_read_b64_tr_b16 v[230:231], v5 offset:26144
    s_mov_b32 s23, 0x5800
    buffer_load_dwordx4 v[128:131], v7, s[8:11], s23 offen offset:1024 sc1
    s_waitcnt lgkmcnt(6)
    v_mfma_f32_16x16x32_bf16 v[40:43], v[240:243], v[96:99], v[40:43]
    ds_read_b64_tr_b16 v[232:233], v4 offset:25344
    s_mov_b64 s[76:77], s[54:55]
    s_mov_b32 s78, 0xc00000
    s_mov_b32 s79, 0x20000
    v_bfe_u32 v20, v1, 2, 2
    v_lshlrev_b32 v20, 12, v20
    v_add_u32 v6, v3, v20
    s_lshr_b32 s16, s2, 5
    s_lshl_b32 s16, s16, 7
    s_lshl_b32 s17, s3, 3
    s_add_u32 s16, s16, s17
    s_mul_i32 s14, s16, 12288
    s_and_b32 s16, s2, 31
    s_lshl_b32 s16, s16, 8
    s_add_u32 s14, s14, s16
    s_add_u32 s14, s14, 4096
    v_mfma_f32_16x16x32_bf16 v[44:47], v[240:243], v[100:103], v[44:47]
    ds_read_b64_tr_b16 v[234:235], v4 offset:26368
    s_waitcnt lgkmcnt(6)
    v_mfma_f32_16x16x32_bf16 v[48:51], v[244:247], v[96:99], v[48:51]
    ds_read_b64_tr_b16 v[236:237], v5 offset:25376
    v_mfma_f32_16x16x32_bf16 v[52:55], v[244:247], v[100:103], v[52:55]
    ds_read_b64_tr_b16 v[238:239], v5 offset:26400
    s_waitcnt lgkmcnt(6)
    v_mfma_f32_16x16x32_bf16 v[56:59], v[224:227], v[96:99], v[56:59]
    v_mfma_f32_16x16x32_bf16 v[60:63], v[224:227], v[100:103], v[60:63]
    s_waitcnt vmcnt(10)
    s_barrier
    ds_read_b64_tr_b16 v[240:241], v4 offset:32768
    ds_read_b64_tr_b16 v[242:243], v4 offset:33792
    s_waitcnt lgkmcnt(6)
    v_mfma_f32_16x16x32_bf16 v[64:67], v[228:231], v[96:99], v[64:67]
    ds_read_b64_tr_b16 v[244:245], v5 offset:32800
    v_mfma_f32_16x16x32_bf16 v[68:71], v[228:231], v[100:103], v[68:71]
    s_add_u32 s22, s19, 0x600000
    s_add_u32 m0, s20, 0x0
    s_nop 0
    buffer_load_dwordx4 v3, s[4:7], s22 offen lds
    ds_read_b64_tr_b16 v[246:247], v5 offset:33824
    s_mov_b32 s23, 0xd800
    buffer_load_dwordx4 v[132:135], v7, s[8:11], s23 offen offset:1024 sc1
    s_waitcnt lgkmcnt(6)
    v_mfma_f32_16x16x32_bf16 v[72:75], v[232:235], v[96:99], v[72:75]
    ds_read_b64_tr_b16 v[224:225], v4 offset:33024
    v_mfma_f32_16x16x32_bf16 v[76:79], v[232:235], v[100:103], v[76:79]
    ds_read_b64_tr_b16 v[226:227], v4 offset:34048
    s_waitcnt lgkmcnt(6)
    v_mfma_f32_16x16x32_bf16 v[80:83], v[236:239], v[96:99], v[80:83]
    ds_read_b64_tr_b16 v[228:229], v5 offset:33056
    v_mfma_f32_16x16x32_bf16 v[84:87], v[236:239], v[100:103], v[84:87]
    ds_read_b64_tr_b16 v[230:231], v5 offset:34080
    s_waitcnt vmcnt(11) lgkmcnt(6)
    v_mfma_f32_16x16x32_bf16 v[24:27], v[240:243], v[104:107], v[24:27]
    ds_read_b64_tr_b16 v[232:233], v4 offset:33280
    s_waitcnt vmcnt(10)
    v_mfma_f32_16x16x32_bf16 v[28:31], v[240:243], v[108:111], v[28:31]
    ds_read_b64_tr_b16 v[234:235], v4 offset:34304
    s_waitcnt lgkmcnt(6)
    v_mfma_f32_16x16x32_bf16 v[32:35], v[244:247], v[104:107], v[32:35]
    ds_read_b64_tr_b16 v[236:237], v5 offset:33312
    v_mfma_f32_16x16x32_bf16 v[36:39], v[244:247], v[108:111], v[36:39]
    s_add_u32 s22, s19, 0x608000
    s_add_u32 m0, s20, 0x400
    s_nop 0
    buffer_load_dwordx4 v3, s[4:7], s22 offen lds
    ds_read_b64_tr_b16 v[238:239], v5 offset:34336
    s_mov_b32 s23, 0x6000
    buffer_load_dwordx4 v[88:91], v7, s[8:11], s23 offen offset:0 sc1
    s_waitcnt lgkmcnt(6)
    v_mfma_f32_16x16x32_bf16 v[40:43], v[224:227], v[104:107], v[40:43]
    ds_read_b64_tr_b16 v[240:241], v4 offset:33536
    v_mfma_f32_16x16x32_bf16 v[44:47], v[224:227], v[108:111], v[44:47]
    ds_read_b64_tr_b16 v[242:243], v4 offset:34560
    s_waitcnt lgkmcnt(6)
    v_mfma_f32_16x16x32_bf16 v[48:51], v[228:231], v[104:107], v[48:51]
    ds_read_b64_tr_b16 v[244:245], v5 offset:33568
    v_mfma_f32_16x16x32_bf16 v[52:55], v[228:231], v[108:111], v[52:55]
    ds_read_b64_tr_b16 v[246:247], v5 offset:34592
    s_waitcnt lgkmcnt(6)
    v_mfma_f32_16x16x32_bf16 v[56:59], v[232:235], v[104:107], v[56:59]
    ds_read_b64_tr_b16 v[224:225], v4 offset:40960
    v_mfma_f32_16x16x32_bf16 v[60:63], v[232:235], v[108:111], v[60:63]
    ds_read_b64_tr_b16 v[226:227], v4 offset:41984
    s_waitcnt lgkmcnt(6)
    v_mfma_f32_16x16x32_bf16 v[64:67], v[236:239], v[104:107], v[64:67]
    ds_read_b64_tr_b16 v[228:229], v5 offset:40992
    v_mfma_f32_16x16x32_bf16 v[68:71], v[236:239], v[108:111], v[68:71]
    ds_read_b64_tr_b16 v[230:231], v5 offset:42016
    s_mov_b32 s23, 0xe000
    buffer_load_dwordx4 v[92:95], v7, s[8:11], s23 offen offset:0 sc1
    s_waitcnt lgkmcnt(6)
    v_mfma_f32_16x16x32_bf16 v[72:75], v[240:243], v[104:107], v[72:75]
    ds_read_b64_tr_b16 v[232:233], v4 offset:41216
    v_mfma_f32_16x16x32_bf16 v[76:79], v[240:243], v[108:111], v[76:79]
    ds_read_b64_tr_b16 v[234:235], v4 offset:42240
    s_waitcnt lgkmcnt(6)
    v_mfma_f32_16x16x32_bf16 v[80:83], v[244:247], v[104:107], v[80:83]
    ds_read_b64_tr_b16 v[236:237], v5 offset:41248
    v_mfma_f32_16x16x32_bf16 v[84:87], v[244:247], v[108:111], v[84:87]
    ds_read_b64_tr_b16 v[238:239], v5 offset:42272
    s_waitcnt vmcnt(12) lgkmcnt(6)
    v_mfma_f32_16x16x32_bf16 v[24:27], v[224:227], v[112:115], v[24:27]
    ds_read_b64_tr_b16 v[240:241], v4 offset:41472
    s_add_u32 s22, s14, 0x0
    s_add_u32 m0, s20, 0x10000
    s_nop 0
    buffer_load_dwordx4 v6, s[76:79], s22 offen lds
    s_waitcnt vmcnt(11)
    v_mfma_f32_16x16x32_bf16 v[28:31], v[224:227], v[116:119], v[28:31]
    ds_read_b64_tr_b16 v[242:243], v4 offset:42496
    s_waitcnt lgkmcnt(6)
    v_mfma_f32_16x16x32_bf16 v[32:35], v[228:231], v[112:115], v[32:35]
    ds_read_b64_tr_b16 v[244:245], v5 offset:41504
    v_mfma_f32_16x16x32_bf16 v[36:39], v[228:231], v[116:119], v[36:39]
    ds_read_b64_tr_b16 v[246:247], v5 offset:42528
    s_mov_b32 s23, 0x6000
    buffer_load_dwordx4 v[96:99], v7, s[8:11], s23 offen offset:1024 sc1
    s_waitcnt lgkmcnt(6)
    v_mfma_f32_16x16x32_bf16 v[40:43], v[232:235], v[112:115], v[40:43]
    ds_read_b64_tr_b16 v[224:225], v4 offset:41728
    s_add_u32 s22, s14, 0xc000
    s_add_u32 m0, s20, 0x10400
    s_nop 0
    buffer_load_dwordx4 v6, s[76:79], s22 offen lds
    v_mfma_f32_16x16x32_bf16 v[44:47], v[232:235], v[116:119], v[44:47]
    ds_read_b64_tr_b16 v[226:227], v4 offset:42752
    s_waitcnt lgkmcnt(6)
    v_mfma_f32_16x16x32_bf16 v[48:51], v[236:239], v[112:115], v[48:51]
    ds_read_b64_tr_b16 v[228:229], v5 offset:41760
    v_mfma_f32_16x16x32_bf16 v[52:55], v[236:239], v[116:119], v[52:55]
    ds_read_b64_tr_b16 v[230:231], v5 offset:42784
    s_waitcnt lgkmcnt(6)
    v_mfma_f32_16x16x32_bf16 v[56:59], v[240:243], v[112:115], v[56:59]
    v_mfma_f32_16x16x32_bf16 v[60:63], v[240:243], v[116:119], v[60:63]
    s_waitcnt vmcnt(12)
    s_barrier
    ds_read_b64_tr_b16 v[232:233], v4 offset:49152
    ds_read_b64_tr_b16 v[234:235], v4 offset:50176
    s_waitcnt lgkmcnt(6)
    v_mfma_f32_16x16x32_bf16 v[64:67], v[244:247], v[112:115], v[64:67]
    ds_read_b64_tr_b16 v[236:237], v5 offset:49184
    v_mfma_f32_16x16x32_bf16 v[68:71], v[244:247], v[116:119], v[68:71]
    s_add_u32 s22, s19, 0x680000
    s_add_u32 m0, s20, 0x4000
    s_nop 0
    buffer_load_dwordx4 v3, s[4:7], s22 offen lds
    ds_read_b64_tr_b16 v[238:239], v5 offset:50208
    s_mov_b32 s23, 0xe000
    buffer_load_dwordx4 v[100:103], v7, s[8:11], s23 offen offset:1024 sc1
    s_waitcnt lgkmcnt(6)
    v_mfma_f32_16x16x32_bf16 v[72:75], v[224:227], v[112:115], v[72:75]
    ds_read_b64_tr_b16 v[240:241], v4 offset:49408
    v_mfma_f32_16x16x32_bf16 v[76:79], v[224:227], v[116:119], v[76:79]
    ds_read_b64_tr_b16 v[242:243], v4 offset:50432
    s_waitcnt lgkmcnt(6)
    v_mfma_f32_16x16x32_bf16 v[80:83], v[228:231], v[112:115], v[80:83]
    ds_read_b64_tr_b16 v[244:245], v5 offset:49440
    v_mfma_f32_16x16x32_bf16 v[84:87], v[228:231], v[116:119], v[84:87]
    ds_read_b64_tr_b16 v[246:247], v5 offset:50464
    s_waitcnt vmcnt(13) lgkmcnt(6)
    v_mfma_f32_16x16x32_bf16 v[24:27], v[232:235], v[120:123], v[24:27]
    ds_read_b64_tr_b16 v[224:225], v4 offset:49664
    s_waitcnt vmcnt(12)
    v_mfma_f32_16x16x32_bf16 v[28:31], v[232:235], v[124:127], v[28:31]
    ds_read_b64_tr_b16 v[226:227], v4 offset:50688
    s_waitcnt lgkmcnt(6)
    v_mfma_f32_16x16x32_bf16 v[32:35], v[236:239], v[120:123], v[32:35]
    ds_read_b64_tr_b16 v[228:229], v5 offset:49696
    v_mfma_f32_16x16x32_bf16 v[36:39], v[236:239], v[124:127], v[36:39]
    s_add_u32 s22, s19, 0x688000
    s_add_u32 m0, s20, 0x4400
    s_nop 0
    buffer_load_dwordx4 v3, s[4:7], s22 offen lds
    ds_read_b64_tr_b16 v[230:231], v5 offset:50720
    s_mov_b32 s23, 0x6800
    buffer_load_dwordx4 v[104:107], v7, s[8:11], s23 offen offset:0 sc1
    s_waitcnt lgkmcnt(6)
    v_mfma_f32_16x16x32_bf16 v[40:43], v[240:243], v[120:123], v[40:43]
    ds_read_b64_tr_b16 v[232:233], v4 offset:49920
    v_mfma_f32_16x16x32_bf16 v[44:47], v[240:243], v[124:127], v[44:47]
    ds_read_b64_tr_b16 v[234:235], v4 offset:50944
    s_waitcnt lgkmcnt(6)
    v_mfma_f32_16x16x32_bf16 v[48:51], v[244:247], v[120:123], v[48:51]
    ds_read_b64_tr_b16 v[236:237], v5 offset:49952
    v_mfma_f32_16x16x32_bf16 v[52:55], v[244:247], v[124:127], v[52:55]
    ds_read_b64_tr_b16 v[238:239], v5 offset:50976
    s_waitcnt lgkmcnt(6)
    v_mfma_f32_16x16x32_bf16 v[56:59], v[224:227], v[120:123], v[56:59]
    ds_read_b64_tr_b16 v[240:241], v4 offset:57344
    v_mfma_f32_16x16x32_bf16 v[60:63], v[224:227], v[124:127], v[60:63]
    ds_read_b64_tr_b16 v[242:243], v4 offset:58368
    s_waitcnt lgkmcnt(6)
    v_mfma_f32_16x16x32_bf16 v[64:67], v[228:231], v[120:123], v[64:67]
    ds_read_b64_tr_b16 v[244:245], v5 offset:57376
    v_mfma_f32_16x16x32_bf16 v[68:71], v[228:231], v[124:127], v[68:71]
    ds_read_b64_tr_b16 v[246:247], v5 offset:58400
    s_mov_b32 s23, 0xe800
    buffer_load_dwordx4 v[108:111], v7, s[8:11], s23 offen offset:0 sc1
    s_waitcnt lgkmcnt(6)
    v_mfma_f32_16x16x32_bf16 v[72:75], v[232:235], v[120:123], v[72:75]
    ds_read_b64_tr_b16 v[224:225], v4 offset:57600
    v_mfma_f32_16x16x32_bf16 v[76:79], v[232:235], v[124:127], v[76:79]
    ds_read_b64_tr_b16 v[226:227], v4 offset:58624
    s_waitcnt lgkmcnt(6)
    v_mfma_f32_16x16x32_bf16 v[80:83], v[236:239], v[120:123], v[80:83]
    ds_read_b64_tr_b16 v[228:229], v5 offset:57632
    v_mfma_f32_16x16x32_bf16 v[84:87], v[236:239], v[124:127], v[84:87]
    ds_read_b64_tr_b16 v[230:231], v5 offset:58656
    s_waitcnt vmcnt(13) lgkmcnt(6)
    v_mfma_f32_16x16x32_bf16 v[24:27], v[240:243], v[128:131], v[24:27]
    ds_read_b64_tr_b16 v[232:233], v4 offset:57856
    s_add_u32 s22, s14, 0xc0000
    s_add_u32 m0, s20, 0x14000
    s_nop 0
    buffer_load_dwordx4 v6, s[76:79], s22 offen lds
    s_waitcnt vmcnt(12)
    v_mfma_f32_16x16x32_bf16 v[28:31], v[240:243], v[132:135], v[28:31]
    ds_read_b64_tr_b16 v[234:235], v4 offset:58880
    s_waitcnt lgkmcnt(6)
    v_mfma_f32_16x16x32_bf16 v[32:35], v[244:247], v[128:131], v[32:35]
    ds_read_b64_tr_b16 v[236:237], v5 offset:57888
    v_mfma_f32_16x16x32_bf16 v[36:39], v[244:247], v[132:135], v[36:39]
    ds_read_b64_tr_b16 v[238:239], v5 offset:58912
    s_mov_b32 s23, 0x6800
    buffer_load_dwordx4 v[112:115], v7, s[8:11], s23 offen offset:1024 sc1
    s_waitcnt lgkmcnt(6)
    v_mfma_f32_16x16x32_bf16 v[40:43], v[224:227], v[128:131], v[40:43]
    ds_read_b64_tr_b16 v[240:241], v4 offset:58112
    s_add_u32 s22, s14, 0xcc000
    s_add_u32 m0, s20, 0x14400
    s_nop 0
    buffer_load_dwordx4 v6, s[76:79], s22 offen lds
    v_mfma_f32_16x16x32_bf16 v[44:47], v[224:227], v[132:135], v[44:47]
    ds_read_b64_tr_b16 v[242:243], v4 offset:59136
    s_waitcnt lgkmcnt(6)
    v_mfma_f32_16x16x32_bf16 v[48:51], v[228:231], v[128:131], v[48:51]
    ds_read_b64_tr_b16 v[244:245], v5 offset:58144
    v_mfma_f32_16x16x32_bf16 v[52:55], v[228:231], v[132:135], v[52:55]
    ds_read_b64_tr_b16 v[246:247], v5 offset:59168
    s_waitcnt lgkmcnt(6)
    v_mfma_f32_16x16x32_bf16 v[56:59], v[232:235], v[128:131], v[56:59]
    v_mfma_f32_16x16x32_bf16 v[60:63], v[232:235], v[132:135], v[60:63]
    s_waitcnt vmcnt(13)
    s_barrier
    ds_read_b64_tr_b16 v[224:225], v4 offset:0
    ds_read_b64_tr_b16 v[226:227], v4 offset:1024
    s_waitcnt lgkmcnt(6)
    v_mfma_f32_16x16x32_bf16 v[64:67], v[236:239], v[128:131], v[64:67]
    ds_read_b64_tr_b16 v[228:229], v5 offset:32
    v_mfma_f32_16x16x32_bf16 v[68:71], v[236:239], v[132:135], v[68:71]
    s_add_u32 s22, s19, 0x700000
    s_add_u32 m0, s20, 0x8000
    s_nop 0
    buffer_load_dwordx4 v3, s[4:7], s22 offen lds
    ds_read_b64_tr_b16 v[230:231], v5 offset:1056
    s_mov_b32 s23, 0xe800
    buffer_load_dwordx4 v[116:119], v7, s[8:11], s23 offen offset:1024 sc1
    s_waitcnt lgkmcnt(6)
    v_mfma_f32_16x16x32_bf16 v[72:75], v[240:243], v[128:131], v[72:75]
    ds_read_b64_tr_b16 v[232:233], v4 offset:256
    v_mfma_f32_16x16x32_bf16 v[76:79], v[240:243], v[132:135], v[76:79]
    ds_read_b64_tr_b16 v[234:235], v4 offset:1280
    s_waitcnt lgkmcnt(6)
    v_mfma_f32_16x16x32_bf16 v[80:83], v[244:247], v[128:131], v[80:83]
    ds_read_b64_tr_b16 v[236:237], v5 offset:288
    v_mfma_f32_16x16x32_bf16 v[84:87], v[244:247], v[132:135], v[84:87]
    ds_read_b64_tr_b16 v[238:239], v5 offset:1312
    s_waitcnt vmcnt(14) lgkmcnt(6)
    v_mfma_f32_16x16x32_bf16 v[24:27], v[224:227], v[88:91], v[24:27]
    ds_read_b64_tr_b16 v[240:241], v4 offset:512
    s_waitcnt vmcnt(13)
    v_mfma_f32_16x16x32_bf16 v[28:31], v[224:227], v[92:95], v[28:31]
    ds_read_b64_tr_b16 v[242:243], v4 offset:1536
    s_waitcnt lgkmcnt(6)
    v_mfma_f32_16x16x32_bf16 v[32:35], v[228:231], v[88:91], v[32:35]
    ds_read_b64_tr_b16 v[244:245], v5 offset:544
    v_mfma_f32_16x16x32_bf16 v[36:39], v[228:231], v[92:95], v[36:39]
    s_add_u32 s22, s19, 0x708000
    s_add_u32 m0, s20, 0x8400
    s_nop 0
    buffer_load_dwordx4 v3, s[4:7], s22 offen lds
    ds_read_b64_tr_b16 v[246:247], v5 offset:1568
    s_mov_b32 s23, 0x7000
    buffer_load_dwordx4 v[120:123], v7, s[8:11], s23 offen offset:0 sc1
    s_waitcnt lgkmcnt(6)
    v_mfma_f32_16x16x32_bf16 v[40:43], v[232:235], v[88:91], v[40:43]
    ds_read_b64_tr_b16 v[224:225], v4 offset:768
    v_mfma_f32_16x16x32_bf16 v[44:47], v[232:235], v[92:95], v[44:47]
    ds_read_b64_tr_b16 v[226:227], v4 offset:1792
    s_waitcnt lgkmcnt(6)
    v_mfma_f32_16x16x32_bf16 v[48:51], v[236:239], v[88:91], v[48:51]
    ds_read_b64_tr_b16 v[228:229], v5 offset:800
    v_mfma_f32_16x16x32_bf16 v[52:55], v[236:239], v[92:95], v[52:55]
    ds_read_b64_tr_b16 v[230:231], v5 offset:1824
    s_waitcnt lgkmcnt(6)
    v_mfma_f32_16x16x32_bf16 v[56:59], v[240:243], v[88:91], v[56:59]
    ds_read_b64_tr_b16 v[232:233], v4 offset:8192
    v_mfma_f32_16x16x32_bf16 v[60:63], v[240:243], v[92:95], v[60:63]
    ds_read_b64_tr_b16 v[234:235], v4 offset:9216
    s_waitcnt lgkmcnt(6)
    v_mfma_f32_16x16x32_bf16 v[64:67], v[244:247], v[88:91], v[64:67]
    ds_read_b64_tr_b16 v[236:237], v5 offset:8224
    v_mfma_f32_16x16x32_bf16 v[68:71], v[244:247], v[92:95], v[68:71]
    ds_read_b64_tr_b16 v[238:239], v5 offset:9248
    s_mov_b32 s23, 0xf000
    buffer_load_dwordx4 v[124:127], v7, s[8:11], s23 offen offset:0 sc1
    s_waitcnt lgkmcnt(6)
    v_mfma_f32_16x16x32_bf16 v[72:75], v[224:227], v[88:91], v[72:75]
    ds_read_b64_tr_b16 v[240:241], v4 offset:8448
    v_mfma_f32_16x16x32_bf16 v[76:79], v[224:227], v[92:95], v[76:79]
    ds_read_b64_tr_b16 v[242:243], v4 offset:9472
    s_waitcnt lgkmcnt(6)
    v_mfma_f32_16x16x32_bf16 v[80:83], v[228:231], v[88:91], v[80:83]
    ds_read_b64_tr_b16 v[244:245], v5 offset:8480
    v_mfma_f32_16x16x32_bf16 v[84:87], v[228:231], v[92:95], v[84:87]
    ds_read_b64_tr_b16 v[246:247], v5 offset:9504
    s_waitcnt vmcnt(14) lgkmcnt(6)
    v_mfma_f32_16x16x32_bf16 v[24:27], v[232:235], v[96:99], v[24:27]
    ds_read_b64_tr_b16 v[224:225], v4 offset:8704
    s_add_u32 s22, s21, 0x0
    s_add_u32 m0, s20, 0x18000
    s_nop 0
    buffer_load_dwordx4 v2, s[8:11], s22 offen sc1 lds
    s_waitcnt vmcnt(12)
    v_mfma_f32_16x16x32_bf16 v[28:31], v[232:235], v[100:103], v[28:31]
    ds_read_b64_tr_b16 v[226:227], v4 offset:9728
    s_waitcnt lgkmcnt(6)
    v_mfma_f32_16x16x32_bf16 v[32:35], v[236:239], v[96:99], v[32:35]
    ds_read_b64_tr_b16 v[228:229], v5 offset:8736
    v_mfma_f32_16x16x32_bf16 v[36:39], v[236:239], v[100:103], v[36:39]
    ds_read_b64_tr_b16 v[230:231], v5 offset:9760
    s_mov_b32 s23, 0x7000
    buffer_load_dwordx4 v[128:131], v7, s[8:11], s23 offen offset:1024 sc1
    s_waitcnt lgkmcnt(6)
    v_mfma_f32_16x16x32_bf16 v[40:43], v[240:243], v[96:99], v[40:43]
    ds_read_b64_tr_b16 v[232:233], v4 offset:8960
    s_add_u32 s22, s21, 0x400
    s_add_u32 m0, s20, 0x18400
    s_nop 0
    buffer_load_dwordx4 v2, s[8:11], s22 offen sc1 lds
    v_mfma_f32_16x16x32_bf16 v[44:47], v[240:243], v[100:103], v[44:47]
    ds_read_b64_tr_b16 v[234:235], v4 offset:9984
    s_waitcnt lgkmcnt(6)
    v_mfma_f32_16x16x32_bf16 v[48:51], v[244:247], v[96:99], v[48:51]
    ds_read_b64_tr_b16 v[236:237], v5 offset:8992
    v_mfma_f32_16x16x32_bf16 v[52:55], v[244:247], v[100:103], v[52:55]
    ds_read_b64_tr_b16 v[238:239], v5 offset:10016
    s_waitcnt lgkmcnt(6)
    v_mfma_f32_16x16x32_bf16 v[56:59], v[224:227], v[96:99], v[56:59]
    v_mfma_f32_16x16x32_bf16 v[60:63], v[224:227], v[100:103], v[60:63]
    s_waitcnt vmcnt(13)
    s_barrier
    ds_read_b64_tr_b16 v[240:241], v4 offset:16384
    ds_read_b64_tr_b16 v[242:243], v4 offset:17408
    s_waitcnt lgkmcnt(6)
    v_mfma_f32_16x16x32_bf16 v[64:67], v[228:231], v[96:99], v[64:67]
    ds_read_b64_tr_b16 v[244:245], v5 offset:16416
    v_mfma_f32_16x16x32_bf16 v[68:71], v[228:231], v[100:103], v[68:71]
    s_add_u32 s22, s19, 0x780000
    s_add_u32 m0, s20, 0xc000
    s_nop 0
    buffer_load_dwordx4 v3, s[4:7], s22 offen lds
    ds_read_b64_tr_b16 v[246:247], v5 offset:17440
    s_mov_b32 s23, 0xf000
    buffer_load_dwordx4 v[132:135], v7, s[8:11], s23 offen offset:1024 sc1
    s_waitcnt lgkmcnt(6)
    v_mfma_f32_16x16x32_bf16 v[72:75], v[232:235], v[96:99], v[72:75]
    ds_read_b64_tr_b16 v[224:225], v4 offset:16640
    v_mfma_f32_16x16x32_bf16 v[76:79], v[232:235], v[100:103], v[76:79]
    ds_read_b64_tr_b16 v[226:227], v4 offset:17664
    s_waitcnt lgkmcnt(6)
    v_mfma_f32_16x16x32_bf16 v[80:83], v[236:239], v[96:99], v[80:83]
    ds_read_b64_tr_b16 v[228:229], v5 offset:16672
    v_mfma_f32_16x16x32_bf16 v[84:87], v[236:239], v[100:103], v[84:87]
    ds_read_b64_tr_b16 v[230:231], v5 offset:17696
    s_waitcnt vmcnt(14) lgkmcnt(6)
    v_mfma_f32_16x16x32_bf16 v[24:27], v[240:243], v[104:107], v[24:27]
    ds_read_b64_tr_b16 v[232:233], v4 offset:16896
    s_waitcnt vmcnt(13)
    v_mfma_f32_16x16x32_bf16 v[28:31], v[240:243], v[108:111], v[28:31]
    ds_read_b64_tr_b16 v[234:235], v4 offset:17920
    s_waitcnt lgkmcnt(6)
    v_mfma_f32_16x16x32_bf16 v[32:35], v[244:247], v[104:107], v[32:35]
    ds_read_b64_tr_b16 v[236:237], v5 offset:16928
    v_mfma_f32_16x16x32_bf16 v[36:39], v[244:247], v[108:111], v[36:39]
    s_add_u32 s22, s19, 0x788000
    s_add_u32 m0, s20, 0xc400
    s_nop 0
    buffer_load_dwordx4 v3, s[4:7], s22 offen lds
    ds_read_b64_tr_b16 v[238:239], v5 offset:17952
    s_mov_b32 s23, 0x7800
    buffer_load_dwordx4 v[88:91], v7, s[8:11], s23 offen offset:0 sc1
    s_waitcnt lgkmcnt(6)
    v_mfma_f32_16x16x32_bf16 v[40:43], v[224:227], v[104:107], v[40:43]
    ds_read_b64_tr_b16 v[240:241], v4 offset:17152
    v_lshrrev_b32 v20, 4, v1
    v_lshlrev_b32 v21, 4, v20
    s_lshl_b32 s16, s2, 8
    s_add_u32 s16, s16, 0x550000
    buffer_load_dwordx4 v[136:139], v21, s[8:11], s16 offen offset:0 sc1
    buffer_load_dwordx4 v[140:143], v21, s[8:11], s16 offen offset:64 sc1
    buffer_load_dwordx4 v[144:147], v21, s[8:11], s16 offen offset:128 sc1
    buffer_load_dwordx4 v[148:151], v21, s[8:11], s16 offen offset:192 sc1
    v_lshlrev_b32 v11, 11, v20
    v_xor_b32 v20, s3, v20
    v_and_b32 v20, 1, v20
    v_lshl_add_u32 v11, v20, 5, v11
    v_bfe_u32 v20, v1, 2, 2
    v_lshl_add_u32 v11, v20, 6, v11
    v_and_b32 v20, 3, v1
    v_lshl_add_u32 v11, v20, 3, v11
    s_lshr_b32 s16, s3, 1
    s_lshl_b32 s16, s16, 8
    s_add_u32 s16, s16, 65536
    v_add_u32 v11, s16, v11
    v_mfma_f32_16x16x32_bf16 v[44:47], v[224:227], v[108:111], v[44:47]
    ds_read_b64_tr_b16 v[242:243], v4 offset:18176
    s_waitcnt lgkmcnt(6)
    v_mfma_f32_16x16x32_bf16 v[48:51], v[228:231], v[104:107], v[48:51]
    ds_read_b64_tr_b16 v[244:245], v5 offset:17184
    v_mfma_f32_16x16x32_bf16 v[52:55], v[228:231], v[108:111], v[52:55]
    ds_read_b64_tr_b16 v[246:247], v5 offset:18208
    s_waitcnt lgkmcnt(6)
    v_mfma_f32_16x16x32_bf16 v[56:59], v[232:235], v[104:107], v[56:59]
    ds_read_b64_tr_b16 v[224:225], v4 offset:24576
    v_mfma_f32_16x16x32_bf16 v[60:63], v[232:235], v[108:111], v[60:63]
    ds_read_b64_tr_b16 v[226:227], v4 offset:25600
    s_waitcnt lgkmcnt(6)
    v_mfma_f32_16x16x32_bf16 v[64:67], v[236:239], v[104:107], v[64:67]
    ds_read_b64_tr_b16 v[228:229], v5 offset:24608
    v_mfma_f32_16x16x32_bf16 v[68:71], v[236:239], v[108:111], v[68:71]
    ds_read_b64_tr_b16 v[230:231], v5 offset:25632
    s_mov_b32 s23, 0xf800
    buffer_load_dwordx4 v[92:95], v7, s[8:11], s23 offen offset:0 sc1
    s_waitcnt lgkmcnt(6)
    v_mfma_f32_16x16x32_bf16 v[72:75], v[240:243], v[104:107], v[72:75]
    ds_read_b64_tr_b16 v[232:233], v4 offset:24832
    v_mfma_f32_16x16x32_bf16 v[76:79], v[240:243], v[108:111], v[76:79]
    ds_read_b64_tr_b16 v[234:235], v4 offset:25856
    s_waitcnt lgkmcnt(6)
    v_mfma_f32_16x16x32_bf16 v[80:83], v[244:247], v[104:107], v[80:83]
    ds_read_b64_tr_b16 v[236:237], v5 offset:24864
    v_mfma_f32_16x16x32_bf16 v[84:87], v[244:247], v[108:111], v[84:87]
    ds_read_b64_tr_b16 v[238:239], v5 offset:25888
    s_waitcnt vmcnt(18) lgkmcnt(6)
    v_mfma_f32_16x16x32_bf16 v[24:27], v[224:227], v[112:115], v[24:27]
    ds_read_b64_tr_b16 v[240:241], v4 offset:25088
    s_add_u32 s22, s21, 0x4000
    s_add_u32 m0, s20, 0x1c000
    s_nop 0
    buffer_load_dwordx4 v2, s[8:11], s22 offen sc1 lds
    s_waitcnt vmcnt(16)
    v_mfma_f32_16x16x32_bf16 v[28:31], v[224:227], v[116:119], v[28:31]
    ds_read_b64_tr_b16 v[242:243], v4 offset:26112
    s_waitcnt lgkmcnt(6)
    v_mfma_f32_16x16x32_bf16 v[32:35], v[228:231], v[112:115], v[32:35]
    ds_read_b64_tr_b16 v[244:245], v5 offset:25120
    v_mfma_f32_16x16x32_bf16 v[36:39], v[228:231], v[116:119], v[36:39]
    ds_read_b64_tr_b16 v[246:247], v5 offset:26144
    s_mov_b32 s23, 0x7800
    buffer_load_dwordx4 v[96:99], v7, s[8:11], s23 offen offset:1024 sc1
    s_waitcnt lgkmcnt(6)
    v_mfma_f32_16x16x32_bf16 v[40:43], v[232:235], v[112:115], v[40:43]
    ds_read_b64_tr_b16 v[224:225], v4 offset:25344
    s_add_u32 s22, s21, 0x4400
    s_add_u32 m0, s20, 0x1c400
    s_nop 0
    buffer_load_dwordx4 v2, s[8:11], s22 offen sc1 lds
    v_mfma_f32_16x16x32_bf16 v[44:47], v[232:235], v[116:119], v[44:47]
    ds_read_b64_tr_b16 v[226:227], v4 offset:26368
    s_waitcnt lgkmcnt(6)
    v_mfma_f32_16x16x32_bf16 v[48:51], v[236:239], v[112:115], v[48:51]
    ds_read_b64_tr_b16 v[228:229], v5 offset:25376
    v_mfma_f32_16x16x32_bf16 v[52:55], v[236:239], v[116:119], v[52:55]
    ds_read_b64_tr_b16 v[230:231], v5 offset:26400
    s_waitcnt lgkmcnt(6)
    v_mfma_f32_16x16x32_bf16 v[56:59], v[240:243], v[112:115], v[56:59]
    v_mfma_f32_16x16x32_bf16 v[60:63], v[240:243], v[116:119], v[60:63]
    s_waitcnt vmcnt(17)
    s_barrier
    ds_read_b64_tr_b16 v[232:233], v4 offset:32768
    ds_read_b64_tr_b16 v[234:235], v4 offset:33792
    s_waitcnt lgkmcnt(6)
    v_mfma_f32_16x16x32_bf16 v[64:67], v[244:247], v[112:115], v[64:67]
    ds_read_b64_tr_b16 v[236:237], v5 offset:32800
    v_mfma_f32_16x16x32_bf16 v[68:71], v[244:247], v[116:119], v[68:71]
    ds_read_b64_tr_b16 v[238:239], v5 offset:33824
    s_mov_b32 s23, 0xf800
    buffer_load_dwordx4 v[100:103], v7, s[8:11], s23 offen offset:1024 sc1
    s_waitcnt lgkmcnt(6)
    v_mfma_f32_16x16x32_bf16 v[72:75], v[224:227], v[112:115], v[72:75]
    ds_read_b64_tr_b16 v[240:241], v4 offset:33024
    v_mfma_f32_16x16x32_bf16 v[76:79], v[224:227], v[116:119], v[76:79]
    ds_read_b64_tr_b16 v[242:243], v4 offset:34048
    s_waitcnt lgkmcnt(6)
    v_mfma_f32_16x16x32_bf16 v[80:83], v[228:231], v[112:115], v[80:83]
    ds_read_b64_tr_b16 v[244:245], v5 offset:33056
    v_mfma_f32_16x16x32_bf16 v[84:87], v[228:231], v[116:119], v[84:87]
    ds_read_b64_tr_b16 v[246:247], v5 offset:34080
    s_waitcnt vmcnt(17) lgkmcnt(6)
    v_mfma_f32_16x16x32_bf16 v[24:27], v[232:235], v[120:123], v[24:27]
    ds_read_b64_tr_b16 v[224:225], v4 offset:33280
    s_waitcnt vmcnt(16)
    v_mfma_f32_16x16x32_bf16 v[28:31], v[232:235], v[124:127], v[28:31]
    ds_read_b64_tr_b16 v[226:227], v4 offset:34304
    s_waitcnt lgkmcnt(6)
    v_mfma_f32_16x16x32_bf16 v[32:35], v[236:239], v[120:123], v[32:35]
    ds_read_b64_tr_b16 v[228:229], v5 offset:33312
    v_mfma_f32_16x16x32_bf16 v[36:39], v[236:239], v[124:127], v[36:39]
    ds_read_b64_tr_b16 v[230:231], v5 offset:34336
    s_waitcnt lgkmcnt(6)
    v_mfma_f32_16x16x32_bf16 v[40:43], v[240:243], v[120:123], v[40:43]
    ds_read_b64_tr_b16 v[232:233], v4 offset:33536
    v_mfma_f32_16x16x32_bf16 v[44:47], v[240:243], v[124:127], v[44:47]
    ds_read_b64_tr_b16 v[234:235], v4 offset:34560
    s_waitcnt lgkmcnt(6)
    v_mfma_f32_16x16x32_bf16 v[48:51], v[244:247], v[120:123], v[48:51]
    ds_read_b64_tr_b16 v[236:237], v5 offset:33568
    v_mfma_f32_16x16x32_bf16 v[52:55], v[244:247], v[124:127], v[52:55]
    ds_read_b64_tr_b16 v[238:239], v5 offset:34592
    s_waitcnt lgkmcnt(6)
    v_mfma_f32_16x16x32_bf16 v[56:59], v[224:227], v[120:123], v[56:59]
    ds_read_b64_tr_b16 v[240:241], v4 offset:40960
    v_mfma_f32_16x16x32_bf16 v[60:63], v[224:227], v[124:127], v[60:63]
    ds_read_b64_tr_b16 v[242:243], v4 offset:41984
    s_waitcnt lgkmcnt(6)
    v_mfma_f32_16x16x32_bf16 v[64:67], v[228:231], v[120:123], v[64:67]
    ds_read_b64_tr_b16 v[244:245], v5 offset:40992
    v_mfma_f32_16x16x32_bf16 v[68:71], v[228:231], v[124:127], v[68:71]
    ds_read_b64_tr_b16 v[246:247], v5 offset:42016
    s_waitcnt lgkmcnt(6)
    v_mfma_f32_16x16x32_bf16 v[72:75], v[232:235], v[120:123], v[72:75]
    ds_read_b64_tr_b16 v[224:225], v4 offset:41216
    v_mfma_f32_16x16x32_bf16 v[76:79], v[232:235], v[124:127], v[76:79]
    ds_read_b64_tr_b16 v[226:227], v4 offset:42240
    s_waitcnt lgkmcnt(6)
    v_mfma_f32_16x16x32_bf16 v[80:83], v[236:239], v[120:123], v[80:83]
    ds_read_b64_tr_b16 v[228:229], v5 offset:41248
    v_mfma_f32_16x16x32_bf16 v[84:87], v[236:239], v[124:127], v[84:87]
    ds_read_b64_tr_b16 v[230:231], v5 offset:42272
    s_waitcnt vmcnt(14) lgkmcnt(6)
    v_mfma_f32_16x16x32_bf16 v[24:27], v[240:243], v[128:131], v[24:27]
    ds_read_b64_tr_b16 v[232:233], v4 offset:41472
    s_waitcnt vmcnt(11)
    v_mfma_f32_16x16x32_bf16 v[28:31], v[240:243], v[132:135], v[28:31]
    ds_read_b64_tr_b16 v[234:235], v4 offset:42496
    s_waitcnt lgkmcnt(6)
    v_mfma_f32_16x16x32_bf16 v[32:35], v[244:247], v[128:131], v[32:35]
    ds_read_b64_tr_b16 v[236:237], v5 offset:41504
    v_mfma_f32_16x16x32_bf16 v[36:39], v[244:247], v[132:135], v[36:39]
    ds_read_b64_tr_b16 v[238:239], v5 offset:42528
    s_waitcnt lgkmcnt(6)
    v_mfma_f32_16x16x32_bf16 v[40:43], v[224:227], v[128:131], v[40:43]
    ds_read_b64_tr_b16 v[240:241], v4 offset:41728
    v_mfma_f32_16x16x32_bf16 v[44:47], v[224:227], v[132:135], v[44:47]
    ds_read_b64_tr_b16 v[242:243], v4 offset:42752
    s_waitcnt lgkmcnt(6)
    v_mfma_f32_16x16x32_bf16 v[48:51], v[228:231], v[128:131], v[48:51]
    ds_read_b64_tr_b16 v[244:245], v5 offset:41760
    v_mfma_f32_16x16x32_bf16 v[52:55], v[228:231], v[132:135], v[52:55]
    ds_read_b64_tr_b16 v[246:247], v5 offset:42784
    s_waitcnt lgkmcnt(6)
    v_mfma_f32_16x16x32_bf16 v[56:59], v[232:235], v[128:131], v[56:59]
    v_mfma_f32_16x16x32_bf16 v[60:63], v[232:235], v[132:135], v[60:63]
    s_waitcnt vmcnt(10)
    s_barrier
    ds_read_b64_tr_b16 v[224:225], v4 offset:49152
    ds_read_b64_tr_b16 v[226:227], v4 offset:50176
    s_waitcnt lgkmcnt(6)
    v_mfma_f32_16x16x32_bf16 v[64:67], v[236:239], v[128:131], v[64:67]
    ds_read_b64_tr_b16 v[228:229], v5 offset:49184
    v_mfma_f32_16x16x32_bf16 v[68:71], v[236:239], v[132:135], v[68:71]
    ds_read_b64_tr_b16 v[230:231], v5 offset:50208
    s_waitcnt lgkmcnt(6)
    v_mfma_f32_16x16x32_bf16 v[72:75], v[240:243], v[128:131], v[72:75]
    ds_read_b64_tr_b16 v[232:233], v4 offset:49408
    v_mfma_f32_16x16x32_bf16 v[76:79], v[240:243], v[132:135], v[76:79]
    ds_read_b64_tr_b16 v[234:235], v4 offset:50432
    s_waitcnt lgkmcnt(6)
    v_mfma_f32_16x16x32_bf16 v[80:83], v[244:247], v[128:131], v[80:83]
    ds_read_b64_tr_b16 v[236:237], v5 offset:49440
    v_mfma_f32_16x16x32_bf16 v[84:87], v[244:247], v[132:135], v[84:87]
    ds_read_b64_tr_b16 v[238:239], v5 offset:50464
    s_waitcnt vmcnt(9) lgkmcnt(6)
    v_mfma_f32_16x16x32_bf16 v[24:27], v[224:227], v[88:91], v[24:27]
    ds_read_b64_tr_b16 v[240:241], v4 offset:49664
    s_waitcnt vmcnt(4)
    v_mfma_f32_16x16x32_bf16 v[28:31], v[224:227], v[92:95], v[28:31]
    ds_read_b64_tr_b16 v[242:243], v4 offset:50688
    s_waitcnt lgkmcnt(6)
    v_mfma_f32_16x16x32_bf16 v[32:35], v[228:231], v[88:91], v[32:35]
    ds_read_b64_tr_b16 v[244:245], v5 offset:49696
    v_mfma_f32_16x16x32_bf16 v[36:39], v[228:231], v[92:95], v[36:39]
    ds_read_b64_tr_b16 v[246:247], v5 offset:50720
    s_waitcnt lgkmcnt(6)
    v_mfma_f32_16x16x32_bf16 v[40:43], v[232:235], v[88:91], v[40:43]
    ds_read_b64_tr_b16 v[224:225], v4 offset:49920
    v_mfma_f32_16x16x32_bf16 v[44:47], v[232:235], v[92:95], v[44:47]
    ds_read_b64_tr_b16 v[226:227], v4 offset:50944
    s_waitcnt lgkmcnt(6)
    v_mfma_f32_16x16x32_bf16 v[48:51], v[236:239], v[88:91], v[48:51]
    ds_read_b64_tr_b16 v[228:229], v5 offset:49952
    v_mfma_f32_16x16x32_bf16 v[52:55], v[236:239], v[92:95], v[52:55]
    ds_read_b64_tr_b16 v[230:231], v5 offset:50976
    s_waitcnt lgkmcnt(6)
    v_mfma_f32_16x16x32_bf16 v[56:59], v[240:243], v[88:91], v[56:59]
    ds_read_b64_tr_b16 v[232:233], v4 offset:57344
    v_mfma_f32_16x16x32_bf16 v[60:63], v[240:243], v[92:95], v[60:63]
    ds_read_b64_tr_b16 v[234:235], v4 offset:58368
    s_waitcnt lgkmcnt(6)
    v_mfma_f32_16x16x32_bf16 v[64:67], v[244:247], v[88:91], v[64:67]
    ds_read_b64_tr_b16 v[236:237], v5 offset:57376
    v_mfma_f32_16x16x32_bf16 v[68:71], v[244:247], v[92:95], v[68:71]
    ds_read_b64_tr_b16 v[238:239], v5 offset:58400
    s_waitcnt lgkmcnt(6)
    v_mfma_f32_16x16x32_bf16 v[72:75], v[224:227], v[88:91], v[72:75]
    ds_read_b64_tr_b16 v[240:241], v4 offset:57600
    v_mfma_f32_16x16x32_bf16 v[76:79], v[224:227], v[92:95], v[76:79]
    ds_read_b64_tr_b16 v[242:243], v4 offset:58624
    s_waitcnt lgkmcnt(6)
    v_mfma_f32_16x16x32_bf16 v[80:83], v[228:231], v[88:91], v[80:83]
    ds_read_b64_tr_b16 v[244:245], v5 offset:57632
    v_mfma_f32_16x16x32_bf16 v[84:87], v[228:231], v[92:95], v[84:87]
    ds_read_b64_tr_b16 v[246:247], v5 offset:58656
    s_waitcnt vmcnt(2) lgkmcnt(6)
    v_mfma_f32_16x16x32_bf16 v[24:27], v[232:235], v[96:99], v[24:27]
    ds_read_b64_tr_b16 v[224:225], v4 offset:57856
    s_waitcnt vmcnt(0)
    v_mfma_f32_16x16x32_bf16 v[28:31], v[232:235], v[100:103], v[28:31]
    ds_read_b64_tr_b16 v[226:227], v4 offset:58880
    s_waitcnt lgkmcnt(6)
    v_mfma_f32_16x16x32_bf16 v[32:35], v[236:239], v[96:99], v[32:35]
    ds_read_b64_tr_b16 v[228:229], v5 offset:57888
    v_mfma_f32_16x16x32_bf16 v[36:39], v[236:239], v[100:103], v[36:39]
    ds_read_b64_tr_b16 v[230:231], v5 offset:58912
    s_waitcnt lgkmcnt(6)
    v_mfma_f32_16x16x32_bf16 v[40:43], v[240:243], v[96:99], v[40:43]
    ds_read_b64_tr_b16 v[232:233], v4 offset:58112
    v_mfma_f32_16x16x32_bf16 v[44:47], v[240:243], v[100:103], v[44:47]
    ds_read_b64_tr_b16 v[234:235], v4 offset:59136
    s_waitcnt lgkmcnt(6)
    v_mfma_f32_16x16x32_bf16 v[48:51], v[244:247], v[96:99], v[48:51]
    ds_read_b64_tr_b16 v[236:237], v5 offset:58144
    v_mfma_f32_16x16x32_bf16 v[52:55], v[244:247], v[100:103], v[52:55]
    ds_read_b64_tr_b16 v[238:239], v5 offset:59168
    s_waitcnt lgkmcnt(6)
    v_mfma_f32_16x16x32_bf16 v[56:59], v[224:227], v[96:99], v[56:59]
    v_mfma_f32_16x16x32_bf16 v[60:63], v[224:227], v[100:103], v[60:63]
    s_waitcnt lgkmcnt(4)
    v_mfma_f32_16x16x32_bf16 v[64:67], v[228:231], v[96:99], v[64:67]
    v_mfma_f32_16x16x32_bf16 v[68:71], v[228:231], v[100:103], v[68:71]
    s_waitcnt lgkmcnt(2)
    v_mfma_f32_16x16x32_bf16 v[72:75], v[232:235], v[96:99], v[72:75]
    v_mfma_f32_16x16x32_bf16 v[76:79], v[232:235], v[100:103], v[76:79]
    s_waitcnt lgkmcnt(0)
    v_mfma_f32_16x16x32_bf16 v[80:83], v[236:239], v[96:99], v[80:83]
    v_mfma_f32_16x16x32_bf16 v[84:87], v[236:239], v[100:103], v[84:87]
    s_barrier
    s_add_u32 s22, s21, 0x8000
    s_add_u32 m0, s20, 0x20000
    s_nop 0
    buffer_load_dwordx4 v2, s[8:11], s22 offen sc1 lds
    s_add_u32 s22, s21, 0x8400
    s_add_u32 m0, s20, 0x20400
    s_nop 0
    buffer_load_dwordx4 v2, s[8:11], s22 offen sc1 lds
    s_add_u32 s22, s21, 0xc000
    s_add_u32 m0, s20, 0x24000
    s_nop 0
    buffer_load_dwordx4 v2, s[8:11], s22 offen sc1 lds
    s_add_u32 s22, s21, 0xc400
    s_add_u32 m0, s20, 0x24400
    s_nop 0
    buffer_load_dwordx4 v2, s[8:11], s22 offen sc1 lds
    ds_read_b64_tr_b16 v[88:89], v11 offset:0
    ds_read_b64_tr_b16 v[90:91], v11 offset:1024
    ds_read_b64_tr_b16 v[92:93], v11 offset:8192
    ds_read_b64_tr_b16 v[94:95], v11 offset:9216
    ds_read_b64_tr_b16 v[96:97], v11 offset:16384
    ds_read_b64_tr_b16 v[98:99], v11 offset:17408
    ds_read_b64_tr_b16 v[100:101], v11 offset:24576
    ds_read_b64_tr_b16 v[102:103], v11 offset:25600
    s_mov_b32 s23, 0x3e0293ee
    v_mul_f32 v24, s23, v24
    v_mul_f32 v25, s23, v25
    v_mul_f32 v26, s23, v26
    v_mul_f32 v27, s23, v27
    v_mul_f32 v28, s23, v28
    v_mul_f32 v29, s23, v29
    v_mul_f32 v30, s23, v30
    v_mul_f32 v31, s23, v31
    v_mul_f32 v32, s23, v32
    v_mul_f32 v33, s23, v33
    v_mul_f32 v34, s23, v34
    v_mul_f32 v35, s23, v35
    v_mul_f32 v36, s23, v36
    v_mul_f32 v37, s23, v37
    v_mul_f32 v38, s23, v38
    v_mul_f32 v39, s23, v39
    v_cvt_pk_bf16_f32 v152, v24, v25
    v_cvt_pk_bf16_f32 v153, v26, v27
    v_cvt_pk_bf16_f32 v168, v28, v29
    v_cvt_pk_bf16_f32 v169, v30, v31
    v_cvt_pk_bf16_f32 v154, v32, v33
    v_cvt_pk_bf16_f32 v155, v34, v35
    v_cvt_pk_bf16_f32 v170, v36, v37
    v_cvt_pk_bf16_f32 v171, v38, v39
    s_waitcnt lgkmcnt(6)
    v_mfma_f32_16x16x32_bf16 v[104:107], v[88:91], v[136:139], 0
    s_waitcnt lgkmcnt(4)
    v_mfma_f32_16x16x32_bf16 v[104:107], v[92:95], v[140:143], v[104:107]
    s_waitcnt lgkmcnt(2)
    v_mfma_f32_16x16x32_bf16 v[104:107], v[96:99], v[144:147], v[104:107]
    s_waitcnt lgkmcnt(0)
    v_mfma_f32_16x16x32_bf16 v[104:107], v[100:103], v[148:151], v[104:107]
    v_add_u32 v4, 0x10000, v2
    v_add_u32 v5, 0x20000, v2
    s_barrier
    ds_read_b128 v[224:227], v4 offset:32768
    ds_read_b128 v[228:231], v4 offset:33792
    ds_read_b128 v[232:235], v4 offset:34816
    ds_read_b128 v[236:239], v4 offset:35840
    v_mov_b32 v12, 0x3f803f80
    v_mov_b32 v13, 0x3f803f80
    v_mov_b32 v14, 0x3f803f80
    v_mov_b32 v15, 0x3f803f80
    s_waitcnt lgkmcnt(3)
    v_mfma_f32_16x16x32_bf16 v[184:187], v[224:227], v[152:155], 0
    v_mul_f32 v40, s23, v40
    v_mul_f32 v41, s23, v41
    v_mul_f32 v42, s23, v42
    v_mul_f32 v43, s23, v43
    v_mul_f32 v44, s23, v44
    v_mul_f32 v45, s23, v45
    v_lshrrev_b32 v20, 4, v1
    v_lshlrev_b32 v20, 4, v20
    s_lshr_b32 s16, s2, 5
    s_lshl_b32 s16, s16, 14
    s_and_b32 s17, s2, 31
    s_lshl_b32 s17, s17, 9
    s_add_u32 s16, s16, s17
    s_lshl_b32 s17, s3, 6
    s_add_u32 s16, s16, s17
    s_add_u32 s16, s16, 0x580000
    s_mov_b32 exec_lo, 0x10001
    s_mov_b32 exec_hi, 0x10001
    buffer_store_dwordx4 v[104:107], v20, s[8:11], s16 offen sc1
    s_mov_b64 exec, -1
    v_mfma_f32_16x16x32_bf16 v[188:191], v[224:227], v[168:171], 0
    ds_read_b128 v[240:243], v4 offset:36864
    v_mul_f32 v46, s23, v46
    v_mul_f32 v47, s23, v47
    v_mul_f32 v48, s23, v48
    v_mul_f32 v49, s23, v49
    v_mul_f32 v50, s23, v50
    v_mul_f32 v51, s23, v51
    s_and_b32 s29, s2, 7
    s_mul_i32 s29, s29, 28
    s_lshr_b32 s16, s2, 3
    s_add_u32 s29, s29, s16
    s_waitcnt lgkmcnt(3)
    v_mfma_f32_16x16x32_bf16 v[192:195], v[228:231], v[152:155], 0
    s_add_u32 s22, s21, 0x10000
    s_add_u32 m0, s20, 0x10000
    s_nop 0
    buffer_load_dwordx4 v2, s[8:11], s22 offen sc1 lds
    v_mul_f32 v52, s23, v52
    v_mul_f32 v53, s23, v53
    v_mul_f32 v54, s23, v54
    v_mul_f32 v55, s23, v55
    v_cvt_pk_bf16_f32 v156, v40, v41
    v_cvt_pk_bf16_f32 v157, v42, v43
    v_mfma_f32_16x16x32_bf16 v[196:199], v[228:231], v[168:171], 0
    ds_read_b128 v[244:247], v4 offset:37888
    v_cvt_pk_bf16_f32 v172, v44, v45
    v_cvt_pk_bf16_f32 v173, v46, v47
    v_cvt_pk_bf16_f32 v158, v48, v49
    v_cvt_pk_bf16_f32 v159, v50, v51
    v_cvt_pk_bf16_f32 v174, v52, v53
    v_cvt_pk_bf16_f32 v175, v54, v55
    s_waitcnt lgkmcnt(3)
    v_mfma_f32_16x16x32_bf16 v[184:187], v[232:235], v[156:159], v[184:187]
    v_mul_f32 v56, s23, v56
    v_mul_f32 v57, s23, v57
    v_mul_f32 v58, s23, v58
    v_mul_f32 v59, s23, v59
    v_mul_f32 v60, s23, v60
    v_mul_f32 v61, s23, v61
    v_mfma_f32_16x16x32_bf16 v[188:191], v[232:235], v[172:175], v[188:191]
    ds_read_b128 v[224:227], v4 offset:38912
    v_mul_f32 v62, s23, v62
    v_mul_f32 v63, s23, v63
    v_mul_f32 v64, s23, v64
    v_mul_f32 v65, s23, v65
    v_mul_f32 v66, s23, v66
    v_mul_f32 v67, s23, v67
    s_waitcnt lgkmcnt(3)
    v_mfma_f32_16x16x32_bf16 v[192:195], v[236:239], v[156:159], v[192:195]
    v_mul_f32 v68, s23, v68
    v_mul_f32 v69, s23, v69
    v_mul_f32 v70, s23, v70
    v_mul_f32 v71, s23, v71
    v_cvt_pk_bf16_f32 v160, v56, v57
    v_cvt_pk_bf16_f32 v161, v58, v59
    v_mfma_f32_16x16x32_bf16 v[196:199], v[236:239], v[172:175], v[196:199]
    ds_read_b128 v[228:231], v4 offset:39936
    v_cvt_pk_bf16_f32 v176, v60, v61
    v_cvt_pk_bf16_f32 v177, v62, v63
    v_cvt_pk_bf16_f32 v162, v64, v65
    v_cvt_pk_bf16_f32 v163, v66, v67
    v_cvt_pk_bf16_f32 v178, v68, v69
    v_cvt_pk_bf16_f32 v179, v70, v71
    s_waitcnt lgkmcnt(3)
    v_mfma_f32_16x16x32_bf16 v[184:187], v[240:243], v[160:163], v[184:187]
    v_mul_f32 v72, s23, v72
    v_mul_f32 v73, s23, v73
    v_mul_f32 v74, s23, v74
    v_mul_f32 v75, s23, v75
    v_mul_f32 v76, s23, v76
    v_mul_f32 v77, s23, v77
    v_mfma_f32_16x16x32_bf16 v[188:191], v[240:243], v[176:179], v[188:191]
    ds_read_b128 v[232:235], v4 offset:40960
    v_mul_f32 v78, s23, v78
    v_mul_f32 v79, s23, v79
    v_mul_f32 v80, s23, v80
    v_mul_f32 v81, s23, v81
    v_mul_f32 v82, s23, v82
    v_mul_f32 v83, s23, v83
    s_waitcnt lgkmcnt(3)
    v_mfma_f32_16x16x32_bf16 v[192:195], v[244:247], v[160:163], v[192:195]
    s_add_u32 s22, s21, 0x10400
    s_add_u32 m0, s20, 0x10400
    s_nop 0
    buffer_load_dwordx4 v2, s[8:11], s22 offen sc1 lds
    v_mul_f32 v84, s23, v84
    v_mul_f32 v85, s23, v85
    v_mul_f32 v86, s23, v86
    v_mul_f32 v87, s23, v87
    v_cvt_pk_bf16_f32 v164, v72, v73
    v_cvt_pk_bf16_f32 v165, v74, v75
    v_mfma_f32_16x16x32_bf16 v[196:199], v[244:247], v[176:179], v[196:199]
    ds_read_b128 v[236:239], v4 offset:41984
    v_cvt_pk_bf16_f32 v180, v76, v77
    v_cvt_pk_bf16_f32 v181, v78, v79
    v_cvt_pk_bf16_f32 v166, v80, v81
    v_cvt_pk_bf16_f32 v167, v82, v83
    v_cvt_pk_bf16_f32 v182, v84, v85
    v_cvt_pk_bf16_f32 v183, v86, v87
    s_waitcnt lgkmcnt(3)
    v_mfma_f32_16x16x32_bf16 v[184:187], v[224:227], v[164:167], v[184:187]
    v_mfma_f32_16x16x32_bf16 v[188:191], v[224:227], v[180:183], v[188:191]
    ds_read_b128 v[240:243], v4 offset:43008
    s_waitcnt lgkmcnt(3)
    v_mfma_f32_16x16x32_bf16 v[192:195], v[228:231], v[164:167], v[192:195]
    v_mfma_f32_16x16x32_bf16 v[196:199], v[228:231], v[180:183], v[196:199]
    ds_read_b128 v[244:247], v4 offset:44032
    s_waitcnt lgkmcnt(3)
    v_mfma_f32_16x16x32_bf16 v[200:203], v[232:235], v[152:155], 0
    v_mfma_f32_16x16x32_bf16 v[204:207], v[232:235], v[168:171], 0
    ds_read_b128 v[224:227], v4 offset:45056
    s_waitcnt lgkmcnt(3)
    v_mfma_f32_16x16x32_bf16 v[208:211], v[236:239], v[152:155], 0
    v_mfma_f32_16x16x32_bf16 v[212:215], v[236:239], v[168:171], 0
    ds_read_b128 v[228:231], v4 offset:46080
    s_waitcnt lgkmcnt(3)
    v_mfma_f32_16x16x32_bf16 v[200:203], v[240:243], v[156:159], v[200:203]
    v_mfma_f32_16x16x32_bf16 v[204:207], v[240:243], v[172:175], v[204:207]
    ds_read_b128 v[232:235], v4 offset:47104
    s_waitcnt lgkmcnt(3)
    v_mfma_f32_16x16x32_bf16 v[208:211], v[244:247], v[156:159], v[208:211]
    v_max3_f32 v16, v184, v185, v186
    v_mfma_f32_16x16x32_bf16 v[212:215], v[244:247], v[172:175], v[212:215]
    ds_read_b128 v[236:239], v4 offset:48128
    v_max3_f32 v16, v16, v187, v192
    s_waitcnt lgkmcnt(3)
    v_mfma_f32_16x16x32_bf16 v[200:203], v[224:227], v[160:163], v[200:203]
    v_max3_f32 v16, v16, v193, v194
    v_mfma_f32_16x16x32_bf16 v[204:207], v[224:227], v[176:179], v[204:207]
    s_barrier
    ds_read_b128 v[240:243], v4 offset:49152
    v_max_f32 v16, v16, v195
    s_waitcnt lgkmcnt(3)
    v_mfma_f32_16x16x32_bf16 v[208:211], v[228:231], v[160:163], v[208:211]
    v_max3_f32 v17, v188, v189, v190
    v_mfma_f32_16x16x32_bf16 v[212:215], v[228:231], v[176:179], v[212:215]
    s_add_u32 s22, s21, 0x14000
    s_add_u32 m0, s20, 0x14000
    s_nop 0
    buffer_load_dwordx4 v2, s[8:11], s22 offen sc1 lds
    ds_read_b128 v[244:247], v4 offset:50176
    v_max3_f32 v17, v17, v191, v196
    s_waitcnt lgkmcnt(3)
    v_mfma_f32_16x16x32_bf16 v[200:203], v[232:235], v[164:167], v[200:203]
    v_max3_f32 v17, v17, v197, v198
    v_mfma_f32_16x16x32_bf16 v[204:207], v[232:235], v[180:183], v[204:207]
    ds_read_b128 v[224:227], v4 offset:51200
    v_max_f32 v17, v17, v199
    s_waitcnt lgkmcnt(3)
    v_mfma_f32_16x16x32_bf16 v[208:211], v[236:239], v[164:167], v[208:211]
    v_mfma_f32_16x16x32_bf16 v[212:215], v[236:239], v[180:183], v[212:215]
    ds_read_b128 v[228:231], v4 offset:52224
    v_max3_f32 v16, v16, v200, v201
    v_max3_f32 v16, v16, v202, v203
    s_nop 3
    v_max3_f32 v16, v16, v208, v209
    v_max3_f32 v16, v16, v210, v211
    v_max3_f32 v17, v17, v204, v205
    v_max3_f32 v17, v17, v206, v207
    v_max3_f32 v17, v17, v212, v213
    v_max3_f32 v17, v17, v214, v215
    v_mov_b32 v18, v16
    v_mov_b32 v19, v17
    s_nop 0
    v_permlane16_swap_b32 v16, v18
    v_permlane16_swap_b32 v17, v19
    v_max_f32 v16, v16, v18
    v_max_f32 v17, v17, v19
    v_mov_b32 v18, v16
    v_mov_b32 v19, v17
    s_nop 0
    v_permlane32_swap_b32 v16, v18
    v_permlane32_swap_b32 v17, v19
    v_max_f32 v16, v16, v18
    v_max_f32 v17, v17, v19
    v_sub_f32 v216, 0, v16
    v_sub_f32 v217, 0, v16
    v_sub_f32 v218, 0, v16
    v_sub_f32 v219, 0, v16
    v_sub_f32 v220, 0, v17
    v_sub_f32 v221, 0, v17
    v_sub_f32 v222, 0, v17
    v_sub_f32 v223, 0, v17
    v_add_f32 v184, v184, v216
    v_add_f32 v185, v185, v216
    v_exp_f32 v184, v184
    v_exp_f32 v185, v185
    s_nop 0
    v_cvt_pk_bf16_f32 v24, v184, v185
    v_add_f32 v186, v186, v216
    v_add_f32 v187, v187, v216
    v_exp_f32 v186, v186
    v_exp_f32 v187, v187
    s_nop 0
    v_cvt_pk_bf16_f32 v25, v186, v187
    v_add_f32 v188, v188, v220
    v_add_f32 v189, v189, v220
    v_exp_f32 v188, v188
    v_exp_f32 v189, v189
    s_nop 0
    v_cvt_pk_bf16_f32 v28, v188, v189
    v_add_f32 v190, v190, v220
    v_add_f32 v191, v191, v220
    v_exp_f32 v190, v190
    v_exp_f32 v191, v191
    s_nop 0
    v_cvt_pk_bf16_f32 v29, v190, v191
    v_add_f32 v192, v192, v216
    v_add_f32 v193, v193, v216
    v_exp_f32 v192, v192
    v_exp_f32 v193, v193
    s_nop 0
    v_cvt_pk_bf16_f32 v26, v192, v193
    v_add_f32 v194, v194, v216
    v_add_f32 v195, v195, v216
    v_exp_f32 v194, v194
    v_exp_f32 v195, v195
    s_nop 0
    v_cvt_pk_bf16_f32 v27, v194, v195
    v_add_f32 v196, v196, v220
    v_add_f32 v197, v197, v220
    v_exp_f32 v196, v196
    v_exp_f32 v197, v197
    s_nop 0
    v_cvt_pk_bf16_f32 v30, v196, v197
    v_add_f32 v198, v198, v220
    v_add_f32 v199, v199, v220
    v_exp_f32 v198, v198
    v_exp_f32 v199, v199
    s_nop 0
    v_cvt_pk_bf16_f32 v31, v198, v199
    s_waitcnt lgkmcnt(3)
    v_mfma_f32_16x16x32_bf16 v[184:187], v[240:243], v[152:155], v[216:219]
    v_mfma_f32_16x16x32_bf16 v[188:191], v[240:243], v[168:171], v[220:223]
    ds_read_b128 v[232:235], v4 offset:53248
    v_add_f32 v200, v200, v216
    v_add_f32 v201, v201, v216
    v_exp_f32 v200, v200
    v_mfma_f32_16x16x32_bf16 v[248:251], v[12:15], v[24:27], 0
    s_waitcnt lgkmcnt(3)
    v_mfma_f32_16x16x32_bf16 v[192:195], v[244:247], v[152:155], v[216:219]
    v_exp_f32 v201, v201
    s_nop 0
    v_cvt_pk_bf16_f32 v32, v200, v201
    v_add_f32 v202, v202, v216
    v_mfma_f32_16x16x32_bf16 v[196:199], v[244:247], v[168:171], v[220:223]
    s_add_u32 s22, s21, 0x14400
    s_add_u32 m0, s20, 0x14400
    s_nop 0
    buffer_load_dwordx4 v2, s[8:11], s22 offen sc1 lds
    ds_read_b128 v[236:239], v4 offset:54272
    v_add_f32 v203, v203, v216
    v_exp_f32 v202, v202
    v_mfma_f32_16x16x32_bf16 v[252:255], v[12:15], v[28:31], 0
    s_waitcnt lgkmcnt(3)
    v_mfma_f32_16x16x32_bf16 v[184:187], v[224:227], v[156:159], v[184:187]
    v_exp_f32 v203, v203
    s_nop 0
    v_cvt_pk_bf16_f32 v33, v202, v203
    v_add_f32 v204, v204, v220
    v_mfma_f32_16x16x32_bf16 v[188:191], v[224:227], v[172:175], v[188:191]
    ds_read_b128 v[240:243], v4 offset:55296
    v_add_f32 v205, v205, v220
    v_exp_f32 v204, v204
    v_exp_f32 v205, v205
    s_mov_b64 s[4:5], s[40:41]
    s_mov_b32 s6, 0x800000
    s_mov_b32 s7, 0x20000
    v_bfe_u32 v20, v1, 2, 2
    v_lshlrev_b32 v21, 13, v20
    v_sub_u32 v3, v3, v21
    v_lshl_add_u32 v3, v20, 11, v3
    s_and_b32 s16, s2, 1
    s_lshl_b32 s24, s16, 22
    s_lshr_b32 s16, s2, 5
    s_lshl_b32 s16, s16, 8
    s_add_u32 s24, s24, s16
    s_lshl_b32 s16, s3, 14
    s_add_u32 s24, s24, s16
    s_waitcnt lgkmcnt(3)
    v_mfma_f32_16x16x32_bf16 v[192:195], v[228:231], v[156:159], v[192:195]
    v_cvt_pk_bf16_f32 v36, v204, v205
    v_add_f32 v206, v206, v220
    v_mfma_f32_16x16x32_bf16 v[196:199], v[228:231], v[172:175], v[196:199]
    ds_read_b128 v[244:247], v4 offset:56320
    v_add_f32 v207, v207, v220
    v_exp_f32 v206, v206
    v_exp_f32 v207, v207
    s_waitcnt lgkmcnt(3)
    v_mfma_f32_16x16x32_bf16 v[184:187], v[232:235], v[160:163], v[184:187]
    v_cvt_pk_bf16_f32 v37, v206, v207
    v_add_f32 v208, v208, v216
    v_add_f32 v209, v209, v216
    v_mfma_f32_16x16x32_bf16 v[188:191], v[232:235], v[176:179], v[188:191]
    ds_read_b128 v[224:227], v4 offset:57344
    v_exp_f32 v208, v208
    v_exp_f32 v209, v209
    s_waitcnt lgkmcnt(3)
    v_mfma_f32_16x16x32_bf16 v[192:195], v[236:239], v[160:163], v[192:195]
    v_cvt_pk_bf16_f32 v34, v208, v209
    v_add_f32 v210, v210, v216
    v_add_f32 v211, v211, v216
    v_mfma_f32_16x16x32_bf16 v[196:199], v[236:239], v[176:179], v[196:199]
    ds_read_b128 v[228:231], v4 offset:58368
    v_exp_f32 v210, v210
    v_exp_f32 v211, v211
    s_nop 0
    v_cvt_pk_bf16_f32 v35, v210, v211
    s_waitcnt lgkmcnt(3)
    v_mfma_f32_16x16x32_bf16 v[184:187], v[240:243], v[164:167], v[184:187]
    v_add_f32 v212, v212, v220
    v_add_f32 v213, v213, v220
    v_mfma_f32_16x16x32_bf16 v[188:191], v[240:243], v[180:183], v[188:191]
    ds_read_b128 v[232:235], v4 offset:59392
    v_exp_f32 v212, v212
    v_exp_f32 v213, v213
    s_nop 0
    v_cvt_pk_bf16_f32 v38, v212, v213
    s_waitcnt lgkmcnt(3)
    v_mfma_f32_16x16x32_bf16 v[192:195], v[244:247], v[164:167], v[192:195]
    v_add_f32 v214, v214, v220
    v_add_f32 v215, v215, v220
    v_exp_f32 v214, v214
    v_mfma_f32_16x16x32_bf16 v[196:199], v[244:247], v[180:183], v[196:199]
    ds_read_b128 v[236:239], v4 offset:60416
    v_exp_f32 v215, v215
    s_nop 0
    v_cvt_pk_bf16_f32 v39, v214, v215
    s_waitcnt lgkmcnt(3)
    v_mfma_f32_16x16x32_bf16 v[200:203], v[224:227], v[152:155], v[216:219]
    v_mfma_f32_16x16x32_bf16 v[204:207], v[224:227], v[168:171], v[220:223]
    ds_read_b128 v[240:243], v4 offset:61440
    v_exp_f32 v184, v184
    v_exp_f32 v185, v185
    v_mfma_f32_16x16x32_bf16 v[248:251], v[12:15], v[32:35], v[248:251]
    s_waitcnt lgkmcnt(3)
    v_mfma_f32_16x16x32_bf16 v[208:211], v[228:231], v[152:155], v[216:219]
    v_cvt_pk_bf16_f32 v40, v184, v185
    v_exp_f32 v186, v186
    v_mfma_f32_16x16x32_bf16 v[212:215], v[228:231], v[168:171], v[220:223]
    ds_read_b128 v[244:247], v4 offset:62464
    v_exp_f32 v187, v187
    v_mfma_f32_16x16x32_bf16 v[252:255], v[12:15], v[36:39], v[252:255]
    s_waitcnt lgkmcnt(3)
    v_mfma_f32_16x16x32_bf16 v[200:203], v[232:235], v[156:159], v[200:203]
    v_cvt_pk_bf16_f32 v41, v186, v187
    v_exp_f32 v188, v188
    v_mfma_f32_16x16x32_bf16 v[204:207], v[232:235], v[172:175], v[204:207]
    ds_read_b128 v[224:227], v4 offset:63488
    v_exp_f32 v189, v189
    s_waitcnt lgkmcnt(3)
    v_mfma_f32_16x16x32_bf16 v[208:211], v[236:239], v[156:159], v[208:211]
    v_cvt_pk_bf16_f32 v44, v188, v189
    v_exp_f32 v190, v190
    v_mfma_f32_16x16x32_bf16 v[212:215], v[236:239], v[172:175], v[212:215]
    ds_read_b128 v[228:231], v4 offset:64512
    v_exp_f32 v191, v191
    s_nop 0
    v_cvt_pk_bf16_f32 v45, v190, v191
    s_waitcnt lgkmcnt(3)
    v_mfma_f32_16x16x32_bf16 v[200:203], v[240:243], v[160:163], v[200:203]
    v_exp_f32 v192, v192
    v_mfma_f32_16x16x32_bf16 v[204:207], v[240:243], v[176:179], v[204:207]
    s_waitcnt vmcnt(7)
    s_barrier
    ds_read_b128 v[232:235], v5 offset:0
    v_exp_f32 v193, v193
    s_nop 0
    v_cvt_pk_bf16_f32 v42, v192, v193
    s_waitcnt lgkmcnt(3)
    v_mfma_f32_16x16x32_bf16 v[208:211], v[244:247], v[160:163], v[208:211]
    v_exp_f32 v194, v194
    v_mfma_f32_16x16x32_bf16 v[212:215], v[244:247], v[176:179], v[212:215]
    s_add_u32 s22, s21, 0x18000
    s_add_u32 m0, s20, 0x18000
    s_nop 0
    buffer_load_dwordx4 v2, s[8:11], s22 offen sc1 lds
    ds_read_b128 v[236:239], v5 offset:1024
    v_exp_f32 v195, v195
    s_nop 0
    v_cvt_pk_bf16_f32 v43, v194, v195
    s_waitcnt lgkmcnt(3)
    v_mfma_f32_16x16x32_bf16 v[200:203], v[224:227], v[164:167], v[200:203]
    v_exp_f32 v196, v196
    v_exp_f32 v197, v197
    v_mfma_f32_16x16x32_bf16 v[204:207], v[224:227], v[180:183], v[204:207]
    ds_read_b128 v[240:243], v5 offset:2048
    v_cvt_pk_bf16_f32 v46, v196, v197
    s_waitcnt lgkmcnt(3)
    v_mfma_f32_16x16x32_bf16 v[208:211], v[228:231], v[164:167], v[208:211]
    v_exp_f32 v198, v198
    v_exp_f32 v199, v199
    v_mfma_f32_16x16x32_bf16 v[212:215], v[228:231], v[180:183], v[212:215]
    ds_read_b128 v[244:247], v5 offset:3072
    v_cvt_pk_bf16_f32 v47, v198, v199
    s_waitcnt lgkmcnt(3)
    v_mfma_f32_16x16x32_bf16 v[184:187], v[232:235], v[152:155], v[216:219]
    v_mfma_f32_16x16x32_bf16 v[188:191], v[232:235], v[168:171], v[220:223]
    ds_read_b128 v[224:227], v5 offset:4096
    v_exp_f32 v200, v200
    v_exp_f32 v201, v201
    v_mfma_f32_16x16x32_bf16 v[248:251], v[12:15], v[40:43], v[248:251]
    s_waitcnt lgkmcnt(3)
    v_mfma_f32_16x16x32_bf16 v[192:195], v[236:239], v[152:155], v[216:219]
    v_cvt_pk_bf16_f32 v48, v200, v201
    v_exp_f32 v202, v202
    v_mfma_f32_16x16x32_bf16 v[196:199], v[236:239], v[168:171], v[220:223]
    s_add_u32 s22, s21, 0x18400
    s_add_u32 m0, s20, 0x18400
    s_nop 0
    buffer_load_dwordx4 v2, s[8:11], s22 offen sc1 lds
    ds_read_b128 v[228:231], v5 offset:5120
    v_exp_f32 v203, v203
    v_mfma_f32_16x16x32_bf16 v[252:255], v[12:15], v[44:47], v[252:255]
    s_waitcnt lgkmcnt(3)
    v_mfma_f32_16x16x32_bf16 v[184:187], v[240:243], v[156:159], v[184:187]
    v_cvt_pk_bf16_f32 v49, v202, v203
    v_exp_f32 v204, v204
    v_mfma_f32_16x16x32_bf16 v[188:191], v[240:243], v[172:175], v[188:191]
    ds_read_b128 v[232:235], v5 offset:6144
    v_exp_f32 v205, v205
    s_waitcnt lgkmcnt(3)
    v_mfma_f32_16x16x32_bf16 v[192:195], v[244:247], v[156:159], v[192:195]
    v_cvt_pk_bf16_f32 v52, v204, v205
    v_exp_f32 v206, v206
    v_mfma_f32_16x16x32_bf16 v[196:199], v[244:247], v[172:175], v[196:199]
    ds_read_b128 v[236:239], v5 offset:7168
    v_exp_f32 v207, v207
    s_nop 0
    v_cvt_pk_bf16_f32 v53, v206, v207
    s_waitcnt lgkmcnt(3)
    v_mfma_f32_16x16x32_bf16 v[184:187], v[224:227], v[160:163], v[184:187]
    v_exp_f32 v208, v208
    v_mfma_f32_16x16x32_bf16 v[188:191], v[224:227], v[176:179], v[188:191]
    ds_read_b128 v[240:243], v5 offset:8192
    v_exp_f32 v209, v209
    s_nop 0
    v_cvt_pk_bf16_f32 v50, v208, v209
    s_waitcnt lgkmcnt(3)
    v_mfma_f32_16x16x32_bf16 v[192:195], v[228:231], v[160:163], v[192:195]
    v_exp_f32 v210, v210
    v_mfma_f32_16x16x32_bf16 v[196:199], v[228:231], v[176:179], v[196:199]
    ds_read_b128 v[244:247], v5 offset:9216
    v_exp_f32 v211, v211
    s_nop 0
    v_cvt_pk_bf16_f32 v51, v210, v211
    s_waitcnt lgkmcnt(3)
    v_mfma_f32_16x16x32_bf16 v[184:187], v[232:235], v[164:167], v[184:187]
    v_exp_f32 v212, v212
    v_exp_f32 v213, v213
    v_mfma_f32_16x16x32_bf16 v[188:191], v[232:235], v[180:183], v[188:191]
    ds_read_b128 v[224:227], v5 offset:10240
    v_cvt_pk_bf16_f32 v54, v212, v213
    s_waitcnt lgkmcnt(3)
    v_mfma_f32_16x16x32_bf16 v[192:195], v[236:239], v[164:167], v[192:195]
    v_exp_f32 v214, v214
    v_exp_f32 v215, v215
    v_mfma_f32_16x16x32_bf16 v[196:199], v[236:239], v[180:183], v[196:199]
    ds_read_b128 v[228:231], v5 offset:11264
    v_cvt_pk_bf16_f32 v55, v214, v215
    s_waitcnt lgkmcnt(3)
    v_mfma_f32_16x16x32_bf16 v[200:203], v[240:243], v[152:155], v[216:219]
    v_mfma_f32_16x16x32_bf16 v[204:207], v[240:243], v[168:171], v[220:223]
    ds_read_b128 v[232:235], v5 offset:12288
    v_exp_f32 v184, v184
    v_exp_f32 v185, v185
    v_mfma_f32_16x16x32_bf16 v[248:251], v[12:15], v[48:51], v[248:251]
    s_waitcnt lgkmcnt(3)
    v_mfma_f32_16x16x32_bf16 v[208:211], v[244:247], v[152:155], v[216:219]
    v_cvt_pk_bf16_f32 v56, v184, v185
    v_exp_f32 v186, v186
    v_mfma_f32_16x16x32_bf16 v[212:215], v[244:247], v[168:171], v[220:223]
    ds_read_b128 v[236:239], v5 offset:13312
    v_exp_f32 v187, v187
    v_mfma_f32_16x16x32_bf16 v[252:255], v[12:15], v[52:55], v[252:255]
    s_waitcnt lgkmcnt(3)
    v_mfma_f32_16x16x32_bf16 v[200:203], v[224:227], v[156:159], v[200:203]
    v_cvt_pk_bf16_f32 v57, v186, v187
    v_exp_f32 v188, v188
    v_mfma_f32_16x16x32_bf16 v[204:207], v[224:227], v[172:175], v[204:207]
    ds_read_b128 v[240:243], v5 offset:14336
    v_exp_f32 v189, v189
    s_waitcnt lgkmcnt(3)
    v_mfma_f32_16x16x32_bf16 v[208:211], v[228:231], v[156:159], v[208:211]
    v_cvt_pk_bf16_f32 v60, v188, v189
    v_exp_f32 v190, v190
    s_waitcnt vmcnt(6)
    v_mfma_f32_16x16x32_bf16 v[212:215], v[228:231], v[172:175], v[212:215]
    ds_read_b128 v[244:247], v5 offset:15360
    v_exp_f32 v191, v191
    s_nop 0
    v_cvt_pk_bf16_f32 v61, v190, v191
    s_waitcnt lgkmcnt(3)
    v_mfma_f32_16x16x32_bf16 v[200:203], v[232:235], v[160:163], v[200:203]
    v_exp_f32 v192, v192
    v_mfma_f32_16x16x32_bf16 v[204:207], v[232:235], v[176:179], v[204:207]
    s_barrier
    ds_read_b128 v[224:227], v5 offset:16384
    v_exp_f32 v193, v193
    s_nop 0
    v_cvt_pk_bf16_f32 v58, v192, v193
    s_waitcnt lgkmcnt(3)
    v_mfma_f32_16x16x32_bf16 v[208:211], v[236:239], v[160:163], v[208:211]
    v_exp_f32 v194, v194
    v_mfma_f32_16x16x32_bf16 v[212:215], v[236:239], v[176:179], v[212:215]
    s_add_u32 s22, s21, 0x1c000
    s_add_u32 m0, s20, 0x1c000
    s_nop 0
    buffer_load_dwordx4 v2, s[8:11], s22 offen sc1 lds
    ds_read_b128 v[228:231], v5 offset:17408
    v_exp_f32 v195, v195
    s_nop 0
    v_cvt_pk_bf16_f32 v59, v194, v195
    s_waitcnt lgkmcnt(3)
    v_mfma_f32_16x16x32_bf16 v[200:203], v[240:243], v[164:167], v[200:203]
    v_exp_f32 v196, v196
    v_exp_f32 v197, v197
    v_mfma_f32_16x16x32_bf16 v[204:207], v[240:243], v[180:183], v[204:207]
    ds_read_b128 v[232:235], v5 offset:18432
    v_cvt_pk_bf16_f32 v62, v196, v197
    s_waitcnt lgkmcnt(3)
    v_mfma_f32_16x16x32_bf16 v[208:211], v[244:247], v[164:167], v[208:211]
    v_exp_f32 v198, v198
    v_exp_f32 v199, v199
    v_mov_b32 v20, s28
    v_mov_b32 v21, 0
    s_lshl_b32 s16, s2, 2
    s_add_u32 s16, s16, 0x560000
    s_cmp_eq_u32 s3, 0
    s_cselect_b32 s16, s16, 0x7ffffff0
    s_mov_b64 exec, 1
    buffer_store_dword v20, v21, s[8:11], s16 offen sc1
    s_mov_b64 exec, -1
    v_mfma_f32_16x16x32_bf16 v[212:215], v[244:247], v[180:183], v[212:215]
    ds_read_b128 v[236:239], v5 offset:19456
    v_cvt_pk_bf16_f32 v63, v198, v199
    s_waitcnt lgkmcnt(3)
    v_mfma_f32_16x16x32_bf16 v[184:187], v[224:227], v[152:155], v[216:219]
    v_mfma_f32_16x16x32_bf16 v[188:191], v[224:227], v[168:171], v[220:223]
    ds_read_b128 v[240:243], v5 offset:20480
    v_exp_f32 v200, v200
    v_exp_f32 v201, v201
    v_mfma_f32_16x16x32_bf16 v[248:251], v[12:15], v[56:59], v[248:251]
    s_waitcnt lgkmcnt(3)
    v_mfma_f32_16x16x32_bf16 v[192:195], v[228:231], v[152:155], v[216:219]
    v_cvt_pk_bf16_f32 v64, v200, v201
    v_exp_f32 v202, v202
    v_mfma_f32_16x16x32_bf16 v[196:199], v[228:231], v[168:171], v[220:223]
    s_add_u32 s22, s21, 0x1c400
    s_add_u32 m0, s20, 0x1c400
    s_nop 0
    buffer_load_dwordx4 v2, s[8:11], s22 offen sc1 lds
    ds_read_b128 v[244:247], v5 offset:21504
    v_exp_f32 v203, v203
    v_mfma_f32_16x16x32_bf16 v[252:255], v[12:15], v[60:63], v[252:255]
    s_waitcnt lgkmcnt(3)
    v_mfma_f32_16x16x32_bf16 v[184:187], v[232:235], v[156:159], v[184:187]
    v_cvt_pk_bf16_f32 v65, v202, v203
    v_exp_f32 v204, v204
    v_mfma_f32_16x16x32_bf16 v[188:191], v[232:235], v[172:175], v[188:191]
    ds_read_b128 v[224:227], v5 offset:22528
    v_exp_f32 v205, v205
    s_waitcnt lgkmcnt(3)
    v_mfma_f32_16x16x32_bf16 v[192:195], v[236:239], v[156:159], v[192:195]
    v_cvt_pk_bf16_f32 v68, v204, v205
    v_exp_f32 v206, v206
    v_mfma_f32_16x16x32_bf16 v[196:199], v[236:239], v[172:175], v[196:199]
    ds_read_b128 v[228:231], v5 offset:23552
    v_exp_f32 v207, v207
    s_nop 0
    v_cvt_pk_bf16_f32 v69, v206, v207
    s_waitcnt lgkmcnt(3)
    v_mfma_f32_16x16x32_bf16 v[184:187], v[240:243], v[160:163], v[184:187]
    v_exp_f32 v208, v208
    v_mfma_f32_16x16x32_bf16 v[188:191], v[240:243], v[176:179], v[188:191]
    ds_read_b128 v[232:235], v5 offset:24576
    v_exp_f32 v209, v209
    s_nop 0
    v_cvt_pk_bf16_f32 v66, v208, v209
    s_waitcnt lgkmcnt(3)
    v_mfma_f32_16x16x32_bf16 v[192:195], v[244:247], v[160:163], v[192:195]
    v_exp_f32 v210, v210
    v_mfma_f32_16x16x32_bf16 v[196:199], v[244:247], v[176:179], v[196:199]
    ds_read_b128 v[236:239], v5 offset:25600
    v_exp_f32 v211, v211
    s_nop 0
    v_cvt_pk_bf16_f32 v67, v210, v211
    s_waitcnt lgkmcnt(3)
    v_mfma_f32_16x16x32_bf16 v[184:187], v[224:227], v[164:167], v[184:187]
    v_exp_f32 v212, v212
    v_exp_f32 v213, v213
    v_mfma_f32_16x16x32_bf16 v[188:191], v[224:227], v[180:183], v[188:191]
    ds_read_b128 v[240:243], v5 offset:26624
    v_cvt_pk_bf16_f32 v70, v212, v213
    s_waitcnt lgkmcnt(3)
    v_mfma_f32_16x16x32_bf16 v[192:195], v[228:231], v[164:167], v[192:195]
    v_exp_f32 v214, v214
    v_exp_f32 v215, v215
    v_mfma_f32_16x16x32_bf16 v[196:199], v[228:231], v[180:183], v[196:199]
    ds_read_b128 v[244:247], v5 offset:27648
    v_cvt_pk_bf16_f32 v71, v214, v215
    s_waitcnt lgkmcnt(3)
    v_mfma_f32_16x16x32_bf16 v[200:203], v[232:235], v[152:155], v[216:219]
    v_mfma_f32_16x16x32_bf16 v[204:207], v[232:235], v[168:171], v[220:223]
    ds_read_b128 v[224:227], v5 offset:28672
    v_exp_f32 v184, v184
    v_exp_f32 v185, v185
    v_mfma_f32_16x16x32_bf16 v[248:251], v[12:15], v[64:67], v[248:251]
    s_waitcnt lgkmcnt(3)
    v_mfma_f32_16x16x32_bf16 v[208:211], v[236:239], v[152:155], v[216:219]
    v_cvt_pk_bf16_f32 v72, v184, v185
    v_exp_f32 v186, v186
    v_mfma_f32_16x16x32_bf16 v[212:215], v[236:239], v[168:171], v[220:223]
    ds_read_b128 v[228:231], v5 offset:29696
    v_exp_f32 v187, v187
    v_mfma_f32_16x16x32_bf16 v[252:255], v[12:15], v[68:71], v[252:255]
    s_waitcnt lgkmcnt(3)
    v_mfma_f32_16x16x32_bf16 v[200:203], v[240:243], v[156:159], v[200:203]
    v_cvt_pk_bf16_f32 v73, v186, v187
    v_exp_f32 v188, v188
    v_mfma_f32_16x16x32_bf16 v[204:207], v[240:243], v[172:175], v[204:207]
    ds_read_b128 v[232:235], v5 offset:30720
    v_exp_f32 v189, v189
    s_waitcnt lgkmcnt(3)
    v_mfma_f32_16x16x32_bf16 v[208:211], v[244:247], v[156:159], v[208:211]
    v_cvt_pk_bf16_f32 v76, v188, v189
    v_exp_f32 v190, v190
    v_mfma_f32_16x16x32_bf16 v[212:215], v[244:247], v[172:175], v[212:215]
    ds_read_b128 v[236:239], v5 offset:31744
    v_exp_f32 v191, v191
    s_nop 0
    v_cvt_pk_bf16_f32 v77, v190, v191
    s_waitcnt lgkmcnt(3)
    v_mfma_f32_16x16x32_bf16 v[200:203], v[224:227], v[160:163], v[200:203]
    v_exp_f32 v192, v192
    v_mfma_f32_16x16x32_bf16 v[204:207], v[224:227], v[176:179], v[204:207]
    s_waitcnt vmcnt(7)
    s_barrier
    ds_read_b128 v[240:243], v4 offset:0
    v_exp_f32 v193, v193
    s_nop 0
    v_cvt_pk_bf16_f32 v74, v192, v193
    s_waitcnt lgkmcnt(3)
    v_mfma_f32_16x16x32_bf16 v[208:211], v[228:231], v[160:163], v[208:211]
    v_exp_f32 v194, v194
    v_mfma_f32_16x16x32_bf16 v[212:215], v[228:231], v[176:179], v[212:215]
    s_add_u32 s22, s21, 0x80000
    s_add_u32 m0, s20, 0x20000
    s_nop 0
    buffer_load_dwordx4 v2, s[8:11], s22 offen sc1 lds
    ds_read_b128 v[244:247], v4 offset:1024
    v_exp_f32 v195, v195
    s_nop 0
    v_cvt_pk_bf16_f32 v75, v194, v195
    s_waitcnt lgkmcnt(3)
    v_mfma_f32_16x16x32_bf16 v[200:203], v[232:235], v[164:167], v[200:203]
    v_exp_f32 v196, v196
    v_exp_f32 v197, v197
    v_mfma_f32_16x16x32_bf16 v[204:207], v[232:235], v[180:183], v[204:207]
    ds_read_b128 v[224:227], v4 offset:2048
    v_cvt_pk_bf16_f32 v78, v196, v197
    s_waitcnt lgkmcnt(3)
    v_mfma_f32_16x16x32_bf16 v[208:211], v[236:239], v[164:167], v[208:211]
    v_exp_f32 v198, v198
    v_exp_f32 v199, v199
    v_mfma_f32_16x16x32_bf16 v[212:215], v[236:239], v[180:183], v[212:215]
    ds_read_b128 v[228:231], v4 offset:3072
    v_cvt_pk_bf16_f32 v79, v198, v199
    s_waitcnt lgkmcnt(3)
    v_mfma_f32_16x16x32_bf16 v[184:187], v[240:243], v[152:155], v[216:219]
    v_mfma_f32_16x16x32_bf16 v[188:191], v[240:243], v[168:171], v[220:223]
    ds_read_b128 v[232:235], v4 offset:4096
    v_exp_f32 v200, v200
    v_exp_f32 v201, v201
    v_mfma_f32_16x16x32_bf16 v[248:251], v[12:15], v[72:75], v[248:251]
    s_waitcnt lgkmcnt(3)
    v_mfma_f32_16x16x32_bf16 v[192:195], v[244:247], v[152:155], v[216:219]
    v_cvt_pk_bf16_f32 v80, v200, v201
    v_exp_f32 v202, v202
    v_mfma_f32_16x16x32_bf16 v[196:199], v[244:247], v[168:171], v[220:223]
    s_add_u32 s22, s21, 0x80400
    s_add_u32 m0, s20, 0x20400
    s_nop 0
    buffer_load_dwordx4 v2, s[8:11], s22 offen sc1 lds
    ds_read_b128 v[236:239], v4 offset:5120
    v_exp_f32 v203, v203
    v_mfma_f32_16x16x32_bf16 v[252:255], v[12:15], v[76:79], v[252:255]
    s_waitcnt lgkmcnt(3)
    v_mfma_f32_16x16x32_bf16 v[184:187], v[224:227], v[156:159], v[184:187]
    v_cvt_pk_bf16_f32 v81, v202, v203
    v_exp_f32 v204, v204
    v_mfma_f32_16x16x32_bf16 v[188:191], v[224:227], v[172:175], v[188:191]
    ds_read_b128 v[240:243], v4 offset:6144
    v_exp_f32 v205, v205
    s_waitcnt lgkmcnt(3)
    v_mfma_f32_16x16x32_bf16 v[192:195], v[228:231], v[156:159], v[192:195]
    v_cvt_pk_bf16_f32 v84, v204, v205
    v_exp_f32 v206, v206
    v_mfma_f32_16x16x32_bf16 v[196:199], v[228:231], v[172:175], v[196:199]
    ds_read_b128 v[244:247], v4 offset:7168
    v_exp_f32 v207, v207
    s_nop 0
    v_cvt_pk_bf16_f32 v85, v206, v207
    s_waitcnt lgkmcnt(3)
    v_mfma_f32_16x16x32_bf16 v[184:187], v[232:235], v[160:163], v[184:187]
    v_exp_f32 v208, v208
    v_mfma_f32_16x16x32_bf16 v[188:191], v[232:235], v[176:179], v[188:191]
    ds_read_b128 v[224:227], v4 offset:8192
    v_exp_f32 v209, v209
    s_nop 0
    v_cvt_pk_bf16_f32 v82, v208, v209
    s_waitcnt lgkmcnt(3)
    v_mfma_f32_16x16x32_bf16 v[192:195], v[236:239], v[160:163], v[192:195]
    v_exp_f32 v210, v210
    v_mfma_f32_16x16x32_bf16 v[196:199], v[236:239], v[176:179], v[196:199]
    ds_read_b128 v[228:231], v4 offset:9216
    v_exp_f32 v211, v211
    s_nop 0
    v_cvt_pk_bf16_f32 v83, v210, v211
    s_waitcnt lgkmcnt(3)
    v_mfma_f32_16x16x32_bf16 v[184:187], v[240:243], v[164:167], v[184:187]
    v_exp_f32 v212, v212
    v_exp_f32 v213, v213
    v_mfma_f32_16x16x32_bf16 v[188:191], v[240:243], v[180:183], v[188:191]
    ds_read_b128 v[232:235], v4 offset:10240
    v_cvt_pk_bf16_f32 v86, v212, v213
    s_waitcnt lgkmcnt(3)
    v_mfma_f32_16x16x32_bf16 v[192:195], v[244:247], v[164:167], v[192:195]
    v_exp_f32 v214, v214
    v_exp_f32 v215, v215
    v_mfma_f32_16x16x32_bf16 v[196:199], v[244:247], v[180:183], v[196:199]
    ds_read_b128 v[236:239], v4 offset:11264
    v_cvt_pk_bf16_f32 v87, v214, v215
    s_waitcnt lgkmcnt(3)
    v_mfma_f32_16x16x32_bf16 v[200:203], v[224:227], v[152:155], v[216:219]
    v_mfma_f32_16x16x32_bf16 v[204:207], v[224:227], v[168:171], v[220:223]
    ds_read_b128 v[240:243], v4 offset:12288
    v_exp_f32 v184, v184
    v_exp_f32 v185, v185
    v_mfma_f32_16x16x32_bf16 v[248:251], v[12:15], v[80:83], v[248:251]
    s_waitcnt lgkmcnt(3)
    v_mfma_f32_16x16x32_bf16 v[208:211], v[228:231], v[152:155], v[216:219]
    v_cvt_pk_bf16_f32 v88, v184, v185
    v_exp_f32 v186, v186
    v_mfma_f32_16x16x32_bf16 v[212:215], v[228:231], v[168:171], v[220:223]
    ds_read_b128 v[244:247], v4 offset:13312
    v_exp_f32 v187, v187
    v_mfma_f32_16x16x32_bf16 v[252:255], v[12:15], v[84:87], v[252:255]
    s_waitcnt lgkmcnt(3)
    v_mfma_f32_16x16x32_bf16 v[200:203], v[232:235], v[156:159], v[200:203]
    v_cvt_pk_bf16_f32 v89, v186, v187
    v_exp_f32 v188, v188
    v_mfma_f32_16x16x32_bf16 v[204:207], v[232:235], v[172:175], v[204:207]
    ds_read_b128 v[224:227], v4 offset:14336
    v_exp_f32 v189, v189
    s_waitcnt lgkmcnt(3)
    v_mfma_f32_16x16x32_bf16 v[208:211], v[236:239], v[156:159], v[208:211]
    v_cvt_pk_bf16_f32 v92, v188, v189
    v_exp_f32 v190, v190
    v_mfma_f32_16x16x32_bf16 v[212:215], v[236:239], v[172:175], v[212:215]
    ds_read_b128 v[228:231], v4 offset:15360
    v_exp_f32 v191, v191
    s_nop 0
    v_cvt_pk_bf16_f32 v93, v190, v191
    s_waitcnt lgkmcnt(3)
    v_mfma_f32_16x16x32_bf16 v[200:203], v[240:243], v[160:163], v[200:203]
    v_exp_f32 v192, v192
    v_mfma_f32_16x16x32_bf16 v[204:207], v[240:243], v[176:179], v[204:207]
    s_waitcnt vmcnt(7)
    s_barrier
    ds_read_b128 v[232:235], v4 offset:16384
    v_exp_f32 v193, v193
    s_nop 0
    v_cvt_pk_bf16_f32 v90, v192, v193
    s_waitcnt lgkmcnt(3)
    v_mfma_f32_16x16x32_bf16 v[208:211], v[244:247], v[160:163], v[208:211]
    v_exp_f32 v194, v194
    v_mfma_f32_16x16x32_bf16 v[212:215], v[244:247], v[176:179], v[212:215]
    s_add_u32 s22, s21, 0x84000
    s_add_u32 m0, s20, 0x24000
    s_nop 0
    buffer_load_dwordx4 v2, s[8:11], s22 offen sc1 lds
    ds_read_b128 v[236:239], v4 offset:17408
    v_exp_f32 v195, v195
    s_nop 0
    v_cvt_pk_bf16_f32 v91, v194, v195
    s_waitcnt lgkmcnt(3)
    v_mfma_f32_16x16x32_bf16 v[200:203], v[224:227], v[164:167], v[200:203]
    v_exp_f32 v196, v196
    v_exp_f32 v197, v197
    v_mfma_f32_16x16x32_bf16 v[204:207], v[224:227], v[180:183], v[204:207]
    ds_read_b128 v[240:243], v4 offset:18432
    v_cvt_pk_bf16_f32 v94, v196, v197
    s_waitcnt lgkmcnt(3)
    v_mfma_f32_16x16x32_bf16 v[208:211], v[228:231], v[164:167], v[208:211]
    v_exp_f32 v198, v198
    v_exp_f32 v199, v199
    v_mfma_f32_16x16x32_bf16 v[212:215], v[228:231], v[180:183], v[212:215]
    ds_read_b128 v[244:247], v4 offset:19456
    v_cvt_pk_bf16_f32 v95, v198, v199
    s_waitcnt lgkmcnt(3)
    v_mfma_f32_16x16x32_bf16 v[184:187], v[232:235], v[152:155], v[216:219]
    v_mfma_f32_16x16x32_bf16 v[188:191], v[232:235], v[168:171], v[220:223]
    ds_read_b128 v[224:227], v4 offset:20480
    v_exp_f32 v200, v200
    v_exp_f32 v201, v201
    v_mfma_f32_16x16x32_bf16 v[248:251], v[12:15], v[88:91], v[248:251]
    s_waitcnt lgkmcnt(3)
    v_mfma_f32_16x16x32_bf16 v[192:195], v[236:239], v[152:155], v[216:219]
    v_cvt_pk_bf16_f32 v96, v200, v201
    v_exp_f32 v202, v202
    v_mfma_f32_16x16x32_bf16 v[196:199], v[236:239], v[168:171], v[220:223]
    s_add_u32 s22, s21, 0x84400
    s_add_u32 m0, s20, 0x24400
    s_nop 0
    buffer_load_dwordx4 v2, s[8:11], s22 offen sc1 lds
    ds_read_b128 v[228:231], v4 offset:21504
    v_exp_f32 v203, v203
    v_mfma_f32_16x16x32_bf16 v[252:255], v[12:15], v[92:95], v[252:255]
    s_waitcnt lgkmcnt(3)
    v_mfma_f32_16x16x32_bf16 v[184:187], v[240:243], v[156:159], v[184:187]
    v_cvt_pk_bf16_f32 v97, v202, v203
    v_exp_f32 v204, v204
    v_mfma_f32_16x16x32_bf16 v[188:191], v[240:243], v[172:175], v[188:191]
    ds_read_b128 v[232:235], v4 offset:22528
    v_exp_f32 v205, v205
    s_waitcnt lgkmcnt(3)
    v_mfma_f32_16x16x32_bf16 v[192:195], v[244:247], v[156:159], v[192:195]
    v_cvt_pk_bf16_f32 v100, v204, v205
    v_exp_f32 v206, v206
    v_mfma_f32_16x16x32_bf16 v[196:199], v[244:247], v[172:175], v[196:199]
    ds_read_b128 v[236:239], v4 offset:23552
    v_exp_f32 v207, v207
    s_nop 0
    v_cvt_pk_bf16_f32 v101, v206, v207
    s_waitcnt lgkmcnt(3)
    v_mfma_f32_16x16x32_bf16 v[184:187], v[224:227], v[160:163], v[184:187]
    v_exp_f32 v208, v208
    v_mfma_f32_16x16x32_bf16 v[188:191], v[224:227], v[176:179], v[188:191]
    ds_read_b128 v[240:243], v4 offset:24576
    v_exp_f32 v209, v209
    s_nop 0
    v_cvt_pk_bf16_f32 v98, v208, v209
    s_waitcnt lgkmcnt(3)
    v_mfma_f32_16x16x32_bf16 v[192:195], v[228:231], v[160:163], v[192:195]
    v_exp_f32 v210, v210
    v_mfma_f32_16x16x32_bf16 v[196:199], v[228:231], v[176:179], v[196:199]
    ds_read_b128 v[244:247], v4 offset:25600
    v_exp_f32 v211, v211
    s_nop 0
    v_cvt_pk_bf16_f32 v99, v210, v211
    s_waitcnt lgkmcnt(3)
    v_mfma_f32_16x16x32_bf16 v[184:187], v[232:235], v[164:167], v[184:187]
    v_exp_f32 v212, v212
    v_exp_f32 v213, v213
    v_mfma_f32_16x16x32_bf16 v[188:191], v[232:235], v[180:183], v[188:191]
    ds_read_b128 v[224:227], v4 offset:26624
    v_cvt_pk_bf16_f32 v102, v212, v213
    s_waitcnt lgkmcnt(3)
    v_mfma_f32_16x16x32_bf16 v[192:195], v[236:239], v[164:167], v[192:195]
    v_exp_f32 v214, v214
    v_exp_f32 v215, v215
    v_mfma_f32_16x16x32_bf16 v[196:199], v[236:239], v[180:183], v[196:199]
    ds_read_b128 v[228:231], v4 offset:27648
    v_cvt_pk_bf16_f32 v103, v214, v215
    s_waitcnt lgkmcnt(3)
    v_mfma_f32_16x16x32_bf16 v[200:203], v[240:243], v[152:155], v[216:219]
    v_mfma_f32_16x16x32_bf16 v[204:207], v[240:243], v[168:171], v[220:223]
    ds_read_b128 v[232:235], v4 offset:28672
    v_exp_f32 v184, v184
    v_exp_f32 v185, v185
    v_mfma_f32_16x16x32_bf16 v[248:251], v[12:15], v[96:99], v[248:251]
    s_waitcnt lgkmcnt(3)
    v_mfma_f32_16x16x32_bf16 v[208:211], v[244:247], v[152:155], v[216:219]
    v_cvt_pk_bf16_f32 v104, v184, v185
    v_exp_f32 v186, v186
    v_mfma_f32_16x16x32_bf16 v[212:215], v[244:247], v[168:171], v[220:223]
    ds_read_b128 v[236:239], v4 offset:29696
    v_exp_f32 v187, v187
    v_mfma_f32_16x16x32_bf16 v[252:255], v[12:15], v[100:103], v[252:255]
    s_waitcnt lgkmcnt(3)
    v_mfma_f32_16x16x32_bf16 v[200:203], v[224:227], v[156:159], v[200:203]
    v_cvt_pk_bf16_f32 v105, v186, v187
    v_exp_f32 v188, v188
    v_mfma_f32_16x16x32_bf16 v[204:207], v[224:227], v[172:175], v[204:207]
    ds_read_b128 v[240:243], v4 offset:30720
    v_exp_f32 v189, v189
    s_waitcnt lgkmcnt(3)
    v_mfma_f32_16x16x32_bf16 v[208:211], v[228:231], v[156:159], v[208:211]
    v_cvt_pk_bf16_f32 v108, v188, v189
    v_exp_f32 v190, v190
    v_mfma_f32_16x16x32_bf16 v[212:215], v[228:231], v[172:175], v[212:215]
    ds_read_b128 v[244:247], v4 offset:31744
    v_exp_f32 v191, v191
    s_nop 0
    v_cvt_pk_bf16_f32 v109, v190, v191
    s_waitcnt lgkmcnt(3)
    v_mfma_f32_16x16x32_bf16 v[200:203], v[232:235], v[160:163], v[200:203]
    v_exp_f32 v192, v192
    v_mfma_f32_16x16x32_bf16 v[204:207], v[232:235], v[176:179], v[204:207]
    s_waitcnt vmcnt(7)
    s_barrier
    ds_read_b128 v[224:227], v4 offset:32768
    v_exp_f32 v193, v193
    s_nop 0
    v_cvt_pk_bf16_f32 v106, v192, v193
    s_waitcnt lgkmcnt(3)
    v_mfma_f32_16x16x32_bf16 v[208:211], v[236:239], v[160:163], v[208:211]
    v_exp_f32 v194, v194
    v_mfma_f32_16x16x32_bf16 v[212:215], v[236:239], v[176:179], v[212:215]
    s_add_u32 s22, s21, 0x88000
    s_add_u32 m0, s20, 0x10000
    s_nop 0
    buffer_load_dwordx4 v2, s[8:11], s22 offen sc1 lds
    ds_read_b128 v[228:231], v4 offset:33792
    v_exp_f32 v195, v195
    s_nop 0
    v_cvt_pk_bf16_f32 v107, v194, v195
    s_waitcnt lgkmcnt(3)
    v_mfma_f32_16x16x32_bf16 v[200:203], v[240:243], v[164:167], v[200:203]
    v_exp_f32 v196, v196
    v_exp_f32 v197, v197
    v_mfma_f32_16x16x32_bf16 v[204:207], v[240:243], v[180:183], v[204:207]
    ds_read_b128 v[232:235], v4 offset:34816
    v_cvt_pk_bf16_f32 v110, v196, v197
    s_waitcnt lgkmcnt(3)
    v_mfma_f32_16x16x32_bf16 v[208:211], v[244:247], v[164:167], v[208:211]
    v_exp_f32 v198, v198
    v_exp_f32 v199, v199
    v_mfma_f32_16x16x32_bf16 v[212:215], v[244:247], v[180:183], v[212:215]
    ds_read_b128 v[236:239], v4 offset:35840
    v_cvt_pk_bf16_f32 v111, v198, v199
    s_waitcnt lgkmcnt(3)
    v_mfma_f32_16x16x32_bf16 v[184:187], v[224:227], v[152:155], v[216:219]
    v_mfma_f32_16x16x32_bf16 v[188:191], v[224:227], v[168:171], v[220:223]
    ds_read_b128 v[240:243], v4 offset:36864
    v_exp_f32 v200, v200
    v_exp_f32 v201, v201
    v_mfma_f32_16x16x32_bf16 v[248:251], v[12:15], v[104:107], v[248:251]
    s_waitcnt lgkmcnt(3)
    v_mfma_f32_16x16x32_bf16 v[192:195], v[228:231], v[152:155], v[216:219]
    v_cvt_pk_bf16_f32 v112, v200, v201
    v_exp_f32 v202, v202
    v_mfma_f32_16x16x32_bf16 v[196:199], v[228:231], v[168:171], v[220:223]
    s_add_u32 s22, s21, 0x88400
    s_add_u32 m0, s20, 0x10400
    s_nop 0
    buffer_load_dwordx4 v2, s[8:11], s22 offen sc1 lds
    ds_read_b128 v[244:247], v4 offset:37888
    v_exp_f32 v203, v203
    v_mfma_f32_16x16x32_bf16 v[252:255], v[12:15], v[108:111], v[252:255]
    s_waitcnt lgkmcnt(3)
    v_mfma_f32_16x16x32_bf16 v[184:187], v[232:235], v[156:159], v[184:187]
    v_cvt_pk_bf16_f32 v113, v202, v203
    v_exp_f32 v204, v204
    v_mfma_f32_16x16x32_bf16 v[188:191], v[232:235], v[172:175], v[188:191]
    ds_read_b128 v[224:227], v4 offset:38912
    v_exp_f32 v205, v205
    s_waitcnt lgkmcnt(3)
    v_mfma_f32_16x16x32_bf16 v[192:195], v[236:239], v[156:159], v[192:195]
    v_cvt_pk_bf16_f32 v116, v204, v205
    v_exp_f32 v206, v206
    v_mfma_f32_16x16x32_bf16 v[196:199], v[236:239], v[172:175], v[196:199]
    ds_read_b128 v[228:231], v4 offset:39936
    v_exp_f32 v207, v207
    s_nop 0
    v_cvt_pk_bf16_f32 v117, v206, v207
    s_waitcnt lgkmcnt(3)
    v_mfma_f32_16x16x32_bf16 v[184:187], v[240:243], v[160:163], v[184:187]
    v_exp_f32 v208, v208
    v_mfma_f32_16x16x32_bf16 v[188:191], v[240:243], v[176:179], v[188:191]
    ds_read_b128 v[232:235], v4 offset:40960
    v_exp_f32 v209, v209
    s_nop 0
    v_cvt_pk_bf16_f32 v114, v208, v209
    s_waitcnt lgkmcnt(3)
    v_mfma_f32_16x16x32_bf16 v[192:195], v[244:247], v[160:163], v[192:195]
    v_exp_f32 v210, v210
    v_mfma_f32_16x16x32_bf16 v[196:199], v[244:247], v[176:179], v[196:199]
    ds_read_b128 v[236:239], v4 offset:41984
    v_exp_f32 v211, v211
    s_nop 0
    v_cvt_pk_bf16_f32 v115, v210, v211
    s_waitcnt lgkmcnt(3)
    v_mfma_f32_16x16x32_bf16 v[184:187], v[224:227], v[164:167], v[184:187]
    v_exp_f32 v212, v212
    v_exp_f32 v213, v213
    v_mfma_f32_16x16x32_bf16 v[188:191], v[224:227], v[180:183], v[188:191]
    ds_read_b128 v[240:243], v4 offset:43008
    v_cvt_pk_bf16_f32 v118, v212, v213
    s_waitcnt lgkmcnt(3)
    v_mfma_f32_16x16x32_bf16 v[192:195], v[228:231], v[164:167], v[192:195]
    v_exp_f32 v214, v214
    v_exp_f32 v215, v215
    v_mfma_f32_16x16x32_bf16 v[196:199], v[228:231], v[180:183], v[196:199]
    ds_read_b128 v[244:247], v4 offset:44032
    v_cvt_pk_bf16_f32 v119, v214, v215
    s_waitcnt lgkmcnt(3)
    v_mfma_f32_16x16x32_bf16 v[200:203], v[232:235], v[152:155], v[216:219]
    v_mfma_f32_16x16x32_bf16 v[204:207], v[232:235], v[168:171], v[220:223]
    ds_read_b128 v[224:227], v4 offset:45056
    v_exp_f32 v184, v184
    v_exp_f32 v185, v185
    v_mfma_f32_16x16x32_bf16 v[248:251], v[12:15], v[112:115], v[248:251]
    s_waitcnt lgkmcnt(3)
    v_mfma_f32_16x16x32_bf16 v[208:211], v[236:239], v[152:155], v[216:219]
    v_cvt_pk_bf16_f32 v120, v184, v185
    v_exp_f32 v186, v186
    v_mfma_f32_16x16x32_bf16 v[212:215], v[236:239], v[168:171], v[220:223]
    ds_read_b128 v[228:231], v4 offset:46080
    v_exp_f32 v187, v187
    v_mfma_f32_16x16x32_bf16 v[252:255], v[12:15], v[116:119], v[252:255]
    s_waitcnt lgkmcnt(3)
    v_mfma_f32_16x16x32_bf16 v[200:203], v[240:243], v[156:159], v[200:203]
    v_cvt_pk_bf16_f32 v121, v186, v187
    v_exp_f32 v188, v188
    v_mfma_f32_16x16x32_bf16 v[204:207], v[240:243], v[172:175], v[204:207]
    ds_read_b128 v[232:235], v4 offset:47104
    v_exp_f32 v189, v189
    s_waitcnt lgkmcnt(3)
    v_mfma_f32_16x16x32_bf16 v[208:211], v[244:247], v[156:159], v[208:211]
    v_cvt_pk_bf16_f32 v124, v188, v189
    v_exp_f32 v190, v190
    v_mfma_f32_16x16x32_bf16 v[212:215], v[244:247], v[172:175], v[212:215]
    ds_read_b128 v[236:239], v4 offset:48128
    v_exp_f32 v191, v191
    s_nop 0
    v_cvt_pk_bf16_f32 v125, v190, v191
    s_waitcnt lgkmcnt(3)
    v_mfma_f32_16x16x32_bf16 v[200:203], v[224:227], v[160:163], v[200:203]
    v_exp_f32 v192, v192
    v_mfma_f32_16x16x32_bf16 v[204:207], v[224:227], v[176:179], v[204:207]
    s_waitcnt vmcnt(6)
    s_barrier
    ds_read_b128 v[240:243], v4 offset:49152
    v_exp_f32 v193, v193
    s_nop 0
    v_cvt_pk_bf16_f32 v122, v192, v193
    s_waitcnt lgkmcnt(3)
    v_mfma_f32_16x16x32_bf16 v[208:211], v[228:231], v[160:163], v[208:211]
    v_exp_f32 v194, v194
    v_mfma_f32_16x16x32_bf16 v[212:215], v[228:231], v[176:179], v[212:215]
    s_add_u32 s22, s21, 0x8c000
    s_add_u32 m0, s20, 0x14000
    s_nop 0
    buffer_load_dwordx4 v2, s[8:11], s22 offen sc1 lds
    ds_read_b128 v[244:247], v4 offset:50176
    v_exp_f32 v195, v195
    s_nop 0
    v_cvt_pk_bf16_f32 v123, v194, v195
    s_waitcnt lgkmcnt(3)
    v_mfma_f32_16x16x32_bf16 v[200:203], v[232:235], v[164:167], v[200:203]
    v_exp_f32 v196, v196
    v_exp_f32 v197, v197
    v_mfma_f32_16x16x32_bf16 v[204:207], v[232:235], v[180:183], v[204:207]
    ds_read_b128 v[224:227], v4 offset:51200
    v_cvt_pk_bf16_f32 v126, v196, v197
    s_waitcnt lgkmcnt(3)
    v_mfma_f32_16x16x32_bf16 v[208:211], v[236:239], v[164:167], v[208:211]
    v_exp_f32 v198, v198
    v_exp_f32 v199, v199
    v_mfma_f32_16x16x32_bf16 v[212:215], v[236:239], v[180:183], v[212:215]
    ds_read_b128 v[228:231], v4 offset:52224
    v_cvt_pk_bf16_f32 v127, v198, v199
    s_waitcnt lgkmcnt(3)
    v_mfma_f32_16x16x32_bf16 v[184:187], v[240:243], v[152:155], v[216:219]
    v_mfma_f32_16x16x32_bf16 v[188:191], v[240:243], v[168:171], v[220:223]
    ds_read_b128 v[232:235], v4 offset:53248
    v_exp_f32 v200, v200
    v_exp_f32 v201, v201
    v_mfma_f32_16x16x32_bf16 v[248:251], v[12:15], v[120:123], v[248:251]
    s_waitcnt lgkmcnt(3)
    v_mfma_f32_16x16x32_bf16 v[192:195], v[244:247], v[152:155], v[216:219]
    v_cvt_pk_bf16_f32 v128, v200, v201
    v_exp_f32 v202, v202
    v_mfma_f32_16x16x32_bf16 v[196:199], v[244:247], v[168:171], v[220:223]
    s_add_u32 s22, s21, 0x8c400
    s_add_u32 m0, s20, 0x14400
    s_nop 0
    buffer_load_dwordx4 v2, s[8:11], s22 offen sc1 lds
    ds_read_b128 v[236:239], v4 offset:54272
    v_exp_f32 v203, v203
    v_mfma_f32_16x16x32_bf16 v[252:255], v[12:15], v[124:127], v[252:255]
    s_waitcnt lgkmcnt(3)
    v_mfma_f32_16x16x32_bf16 v[184:187], v[224:227], v[156:159], v[184:187]
    v_cvt_pk_bf16_f32 v129, v202, v203
    v_exp_f32 v204, v204
    v_mfma_f32_16x16x32_bf16 v[188:191], v[224:227], v[172:175], v[188:191]
    ds_read_b128 v[240:243], v4 offset:55296
    v_exp_f32 v205, v205
    s_waitcnt lgkmcnt(3)
    v_mfma_f32_16x16x32_bf16 v[192:195], v[228:231], v[156:159], v[192:195]
    v_cvt_pk_bf16_f32 v132, v204, v205
    v_exp_f32 v206, v206
    v_mfma_f32_16x16x32_bf16 v[196:199], v[228:231], v[172:175], v[196:199]
    ds_read_b128 v[244:247], v4 offset:56320
    v_exp_f32 v207, v207
    s_nop 0
    v_cvt_pk_bf16_f32 v133, v206, v207
    s_waitcnt lgkmcnt(3)
    v_mfma_f32_16x16x32_bf16 v[184:187], v[232:235], v[160:163], v[184:187]
    v_exp_f32 v208, v208
    v_mfma_f32_16x16x32_bf16 v[188:191], v[232:235], v[176:179], v[188:191]
    ds_read_b128 v[224:227], v4 offset:57344
    v_exp_f32 v209, v209
    s_nop 0
    v_cvt_pk_bf16_f32 v130, v208, v209
    s_waitcnt lgkmcnt(3)
    v_mfma_f32_16x16x32_bf16 v[192:195], v[236:239], v[160:163], v[192:195]
    v_exp_f32 v210, v210
    v_mfma_f32_16x16x32_bf16 v[196:199], v[236:239], v[176:179], v[196:199]
    ds_read_b128 v[228:231], v4 offset:58368
    v_exp_f32 v211, v211
    s_nop 0
    v_cvt_pk_bf16_f32 v131, v210, v211
    s_waitcnt lgkmcnt(3)
    v_mfma_f32_16x16x32_bf16 v[184:187], v[240:243], v[164:167], v[184:187]
    v_exp_f32 v212, v212
    v_exp_f32 v213, v213
    v_mfma_f32_16x16x32_bf16 v[188:191], v[240:243], v[180:183], v[188:191]
    ds_read_b128 v[232:235], v4 offset:59392
    v_cvt_pk_bf16_f32 v134, v212, v213
    s_waitcnt lgkmcnt(3)
    v_mfma_f32_16x16x32_bf16 v[192:195], v[244:247], v[164:167], v[192:195]
    v_exp_f32 v214, v214
    v_exp_f32 v215, v215
    v_mfma_f32_16x16x32_bf16 v[196:199], v[244:247], v[180:183], v[196:199]
    ds_read_b128 v[236:239], v4 offset:60416
    v_cvt_pk_bf16_f32 v135, v214, v215
    s_waitcnt lgkmcnt(3)
    v_mfma_f32_16x16x32_bf16 v[200:203], v[224:227], v[152:155], v[216:219]
    v_mfma_f32_16x16x32_bf16 v[204:207], v[224:227], v[168:171], v[220:223]
    ds_read_b128 v[240:243], v4 offset:61440
    v_exp_f32 v184, v184
    v_exp_f32 v185, v185
    v_mfma_f32_16x16x32_bf16 v[248:251], v[12:15], v[128:131], v[248:251]
    s_waitcnt lgkmcnt(3)
    v_mfma_f32_16x16x32_bf16 v[208:211], v[228:231], v[152:155], v[216:219]
    v_cvt_pk_bf16_f32 v136, v184, v185
    v_exp_f32 v186, v186
    v_mfma_f32_16x16x32_bf16 v[212:215], v[228:231], v[168:171], v[220:223]
    ds_read_b128 v[244:247], v4 offset:62464
    v_exp_f32 v187, v187
    v_mfma_f32_16x16x32_bf16 v[252:255], v[12:15], v[132:135], v[252:255]
    s_waitcnt lgkmcnt(3)
    v_mfma_f32_16x16x32_bf16 v[200:203], v[232:235], v[156:159], v[200:203]
    v_cvt_pk_bf16_f32 v137, v186, v187
    v_exp_f32 v188, v188
    v_mfma_f32_16x16x32_bf16 v[204:207], v[232:235], v[172:175], v[204:207]
    ds_read_b128 v[224:227], v4 offset:63488
    v_exp_f32 v189, v189
    s_waitcnt lgkmcnt(3)
    v_mfma_f32_16x16x32_bf16 v[208:211], v[236:239], v[156:159], v[208:211]
    v_cvt_pk_bf16_f32 v140, v188, v189
    v_exp_f32 v190, v190
    v_mfma_f32_16x16x32_bf16 v[212:215], v[236:239], v[172:175], v[212:215]
    ds_read_b128 v[228:231], v4 offset:64512
    v_exp_f32 v191, v191
    s_nop 0
    v_cvt_pk_bf16_f32 v141, v190, v191
    s_waitcnt lgkmcnt(3)
    v_mfma_f32_16x16x32_bf16 v[200:203], v[240:243], v[160:163], v[200:203]
    v_exp_f32 v192, v192
    v_mfma_f32_16x16x32_bf16 v[204:207], v[240:243], v[176:179], v[204:207]
    v_exp_f32 v193, v193
    s_nop 0
    v_cvt_pk_bf16_f32 v138, v192, v193
    s_waitcnt lgkmcnt(2)
    v_mfma_f32_16x16x32_bf16 v[208:211], v[244:247], v[160:163], v[208:211]
    v_exp_f32 v194, v194
    v_mfma_f32_16x16x32_bf16 v[212:215], v[244:247], v[176:179], v[212:215]
    v_exp_f32 v195, v195
    s_nop 0
    v_cvt_pk_bf16_f32 v139, v194, v195
    s_waitcnt lgkmcnt(1)
    v_mfma_f32_16x16x32_bf16 v[200:203], v[224:227], v[164:167], v[200:203]
    v_exp_f32 v196, v196
    v_exp_f32 v197, v197
    v_mfma_f32_16x16x32_bf16 v[204:207], v[224:227], v[180:183], v[204:207]
    v_cvt_pk_bf16_f32 v142, v196, v197
    s_waitcnt lgkmcnt(0)
    v_mfma_f32_16x16x32_bf16 v[208:211], v[228:231], v[164:167], v[208:211]
    v_exp_f32 v198, v198
    v_exp_f32 v199, v199
    v_mfma_f32_16x16x32_bf16 v[212:215], v[228:231], v[180:183], v[212:215]
    v_cvt_pk_bf16_f32 v143, v198, v199
    s_waitcnt vmcnt(6)
    s_barrier
    ds_read_b128 v[232:235], v5 offset:0
    ds_read_b128 v[236:239], v5 offset:1024
    ds_read_b128 v[240:243], v5 offset:2048
    ds_read_b128 v[244:247], v5 offset:3072
    v_mfma_f32_16x16x32_bf16 v[248:251], v[12:15], v[136:139], v[248:251]
    v_mfma_f32_16x16x32_bf16 v[252:255], v[12:15], v[140:143], v[252:255]
    v_exp_f32 v200, v200
    v_exp_f32 v201, v201
    s_nop 0
    v_cvt_pk_bf16_f32 v144, v200, v201
    v_exp_f32 v202, v202
    v_exp_f32 v203, v203
    s_nop 0
    v_cvt_pk_bf16_f32 v145, v202, v203
    v_exp_f32 v204, v204
    v_exp_f32 v205, v205
    s_nop 0
    v_cvt_pk_bf16_f32 v148, v204, v205
    v_exp_f32 v206, v206
    v_exp_f32 v207, v207
    s_nop 0
    v_cvt_pk_bf16_f32 v149, v206, v207
    v_exp_f32 v208, v208
    v_exp_f32 v209, v209
    s_nop 0
    v_cvt_pk_bf16_f32 v146, v208, v209
    v_exp_f32 v210, v210
    v_exp_f32 v211, v211
    s_nop 0
    v_cvt_pk_bf16_f32 v147, v210, v211
    v_exp_f32 v212, v212
    v_exp_f32 v213, v213
    s_nop 0
    v_cvt_pk_bf16_f32 v150, v212, v213
    v_exp_f32 v214, v214
    v_exp_f32 v215, v215
    s_nop 0
    v_cvt_pk_bf16_f32 v151, v214, v215
    v_mfma_f32_16x16x32_bf16 v[248:251], v[12:15], v[144:147], v[248:251]
    s_nop 0
    v_mfma_f32_16x16x32_bf16 v[252:255], v[12:15], v[148:151], v[252:255]
    s_nop 5
    v_mov_b32 v9, v248
    s_nop 0
    v_mov_b32 v10, v252
    v_max_f32 v17, v9, v10
    v_readfirstlane_b32 s17, v8
    s_cmp_eq_u32 s17, s28
    s_cselect_b32 s16, 0, 0x71800000
    v_cmp_ngt_f32 vcc, s16, v17
    v_cmp_u_f32 s[76:77], v9, v10
    s_or_b64 vcc, vcc, s[76:77]
    s_cbranch_vccnz adaLN_cond__sliding_block_cached__moe_arch_mod__prompt_kernel_fixA
adaLN_cond__sliding_block_cached__moe_arch_mod__prompt_kernel_fixAb:
    v_rcp_f32 v9, v9
    v_rcp_f32 v10, v10
    s_lshl_b32 s25, s13, 3
    s_add_u32 s25, s25, s3
    s_lshl_b32 s25, s25, 18
    s_lshl_b32 s26, s12, 12
    s_add_u32 s25, s25, s26
    s_add_u32 s25, s25, 0x1000000
    s_add_u32 s26, s25, 131072
    s_lshl_b32 s63, s13, 3
    s_add_u32 s63, s63, s3
    s_lshl_b32 s63, s63, 5
    s_add_u32 s63, s63, s12
    s_lshl_b32 s63, s63, 2
    s_waitcnt lgkmcnt(3)
    v_mfma_f32_16x16x32_bf16 v[184:187], v[232:235], v[24:27], 0
    v_mfma_f32_16x16x32_bf16 v[188:191], v[232:235], v[28:31], 0
    ds_read_b128 v[224:227], v5 offset:4096
    s_waitcnt lgkmcnt(3)
    v_mfma_f32_16x16x32_bf16 v[192:195], v[236:239], v[24:27], 0
    s_add_u32 s22, s21, 0x90000
    s_add_u32 m0, s20, 0x18000
    s_nop 0
    buffer_load_dwordx4 v2, s[8:11], s22 offen sc1 lds
    v_mfma_f32_16x16x32_bf16 v[196:199], v[236:239], v[28:31], 0
    ds_read_b128 v[228:231], v5 offset:5120
    s_waitcnt lgkmcnt(3)
    v_mfma_f32_16x16x32_bf16 v[184:187], v[240:243], v[32:35], v[184:187]
    v_mfma_f32_16x16x32_bf16 v[188:191], v[240:243], v[36:39], v[188:191]
    ds_read_b128 v[232:235], v5 offset:6144
    s_waitcnt lgkmcnt(3)
    v_mfma_f32_16x16x32_bf16 v[192:195], v[244:247], v[32:35], v[192:195]
    v_mfma_f32_16x16x32_bf16 v[196:199], v[244:247], v[36:39], v[196:199]
    ds_read_b128 v[236:239], v5 offset:7168
    s_waitcnt lgkmcnt(3)
    v_mfma_f32_16x16x32_bf16 v[184:187], v[224:227], v[40:43], v[184:187]
    v_mfma_f32_16x16x32_bf16 v[188:191], v[224:227], v[44:47], v[188:191]
    ds_read_b128 v[240:243], v5 offset:8192
    s_waitcnt lgkmcnt(3)
    v_mfma_f32_16x16x32_bf16 v[192:195], v[228:231], v[40:43], v[192:195]
    s_add_u32 s22, s21, 0x90400
    s_add_u32 m0, s20, 0x18400
    s_nop 0
    buffer_load_dwordx4 v2, s[8:11], s22 offen sc1 lds
    v_and_b32 v250, 7, v1
    v_lshlrev_b32 v250, 7, v250
    s_lshr_b32 s14, s2, 3
    s_lshl_b32 s14, s14, 2
    s_add_u32 s14, s14, 0x560000
    buffer_load_dword v248, v250, s[8:11], s14 offen sc1
    v_mfma_f32_16x16x32_bf16 v[196:199], v[228:231], v[44:47], v[196:199]
    ds_read_b128 v[244:247], v5 offset:9216
    s_waitcnt lgkmcnt(3)
    v_mfma_f32_16x16x32_bf16 v[184:187], v[232:235], v[48:51], v[184:187]
    v_mfma_f32_16x16x32_bf16 v[188:191], v[232:235], v[52:55], v[188:191]
    ds_read_b128 v[224:227], v5 offset:10240
    s_waitcnt lgkmcnt(3)
    v_mfma_f32_16x16x32_bf16 v[192:195], v[236:239], v[48:51], v[192:195]
    v_mfma_f32_16x16x32_bf16 v[196:199], v[236:239], v[52:55], v[196:199]
    ds_read_b128 v[228:231], v5 offset:11264
    s_waitcnt lgkmcnt(3)
    v_mfma_f32_16x16x32_bf16 v[184:187], v[240:243], v[56:59], v[184:187]
    v_mfma_f32_16x16x32_bf16 v[188:191], v[240:243], v[60:63], v[188:191]
    ds_read_b128 v[232:235], v5 offset:12288
    s_waitcnt lgkmcnt(3)
    v_mfma_f32_16x16x32_bf16 v[192:195], v[244:247], v[56:59], v[192:195]
    v_mfma_f32_16x16x32_bf16 v[196:199], v[244:247], v[60:63], v[196:199]
    ds_read_b128 v[236:239], v5 offset:13312
    s_waitcnt lgkmcnt(3)
    v_mfma_f32_16x16x32_bf16 v[184:187], v[224:227], v[64:67], v[184:187]
    v_mfma_f32_16x16x32_bf16 v[188:191], v[224:227], v[68:71], v[188:191]
    ds_read_b128 v[240:243], v5 offset:14336
    s_waitcnt lgkmcnt(3)
    v_mfma_f32_16x16x32_bf16 v[192:195], v[228:231], v[64:67], v[192:195]
    v_mfma_f32_16x16x32_bf16 v[196:199], v[228:231], v[68:71], v[196:199]
    ds_read_b128 v[244:247], v5 offset:15360
    s_waitcnt lgkmcnt(3)
    v_mfma_f32_16x16x32_bf16 v[184:187], v[232:235], v[72:75], v[184:187]
    v_mfma_f32_16x16x32_bf16 v[188:191], v[232:235], v[76:79], v[188:191]
    s_waitcnt vmcnt(7)
    s_barrier
    ds_read_b128 v[224:227], v5 offset:16384
    s_waitcnt lgkmcnt(3)
    v_mfma_f32_16x16x32_bf16 v[192:195], v[236:239], v[72:75], v[192:195]
    v_mfma_f32_16x16x32_bf16 v[196:199], v[236:239], v[76:79], v[196:199]
    s_add_u32 s22, s21, 0x94000
    s_add_u32 m0, s20, 0x1c000
    s_nop 0
    buffer_load_dwordx4 v2, s[8:11], s22 offen sc1 lds
    ds_read_b128 v[228:231], v5 offset:17408
    s_waitcnt lgkmcnt(3)
    v_mfma_f32_16x16x32_bf16 v[184:187], v[240:243], v[80:83], v[184:187]
    v_mfma_f32_16x16x32_bf16 v[188:191], v[240:243], v[84:87], v[188:191]
    ds_read_b128 v[232:235], v5 offset:18432
    s_waitcnt lgkmcnt(3)
    v_mfma_f32_16x16x32_bf16 v[192:195], v[244:247], v[80:83], v[192:195]
    v_mfma_f32_16x16x32_bf16 v[196:199], v[244:247], v[84:87], v[196:199]
    ds_read_b128 v[236:239], v5 offset:19456
    s_waitcnt lgkmcnt(3)
    v_mfma_f32_16x16x32_bf16 v[184:187], v[224:227], v[88:91], v[184:187]
    v_mfma_f32_16x16x32_bf16 v[188:191], v[224:227], v[92:95], v[188:191]
    ds_read_b128 v[240:243], v5 offset:20480
    s_waitcnt lgkmcnt(3)
    v_mfma_f32_16x16x32_bf16 v[192:195], v[228:231], v[88:91], v[192:195]
    v_mfma_f32_16x16x32_bf16 v[196:199], v[228:231], v[92:95], v[196:199]
    s_add_u32 s22, s21, 0x94400
    s_add_u32 m0, s20, 0x1c400
    s_nop 0
    buffer_load_dwordx4 v2, s[8:11], s22 offen sc1 lds
    ds_read_b128 v[244:247], v5 offset:21504
    s_waitcnt lgkmcnt(3)
    v_mfma_f32_16x16x32_bf16 v[184:187], v[232:235], v[96:99], v[184:187]
    v_mfma_f32_16x16x32_bf16 v[188:191], v[232:235], v[100:103], v[188:191]
    ds_read_b128 v[224:227], v5 offset:22528
    s_waitcnt lgkmcnt(3)
    v_mfma_f32_16x16x32_bf16 v[192:195], v[236:239], v[96:99], v[192:195]
    v_mfma_f32_16x16x32_bf16 v[196:199], v[236:239], v[100:103], v[196:199]
    ds_read_b128 v[228:231], v5 offset:23552
    s_waitcnt lgkmcnt(3)
    v_mfma_f32_16x16x32_bf16 v[184:187], v[240:243], v[104:107], v[184:187]
    v_mfma_f32_16x16x32_bf16 v[188:191], v[240:243], v[108:111], v[188:191]
    ds_read_b128 v[232:235], v5 offset:24576
    s_waitcnt lgkmcnt(3)
    v_mfma_f32_16x16x32_bf16 v[192:195], v[244:247], v[104:107], v[192:195]
    v_mfma_f32_16x16x32_bf16 v[196:199], v[244:247], v[108:111], v[196:199]
    ds_read_b128 v[236:239], v5 offset:25600
    s_waitcnt lgkmcnt(3)
    v_mfma_f32_16x16x32_bf16 v[184:187], v[224:227], v[112:115], v[184:187]
    s_waitcnt vmcnt(2)
    v_cmp_ne_u32 vcc, s28, v248
    s_cbranch_vccnz adaLN_cond__sliding_block_cached__moe_arch_mod__prompt_kernel_mp5r
adaLN_cond__sliding_block_cached__moe_arch_mod__prompt_kernel_mp5b:
    v_mfma_f32_16x16x32_bf16 v[188:191], v[224:227], v[116:119], v[188:191]
    ds_read_b128 v[240:243], v5 offset:26624
    v_lshrrev_b32 v250, 4, v1
    v_lshlrev_b32 v250, 14, v250
    v_and_b32 v253, 15, v1
    v_lshl_add_u32 v250, v253, 2, v250
    s_lshl_b32 s14, s2, 6
    s_add_u32 s14, s14, 0x580000
    buffer_load_dword v249, v250, s[8:11], s14 offen sc1
    s_add_u32 s14, s14, 0x10000
    buffer_load_dword v254, v250, s[8:11], s14 offen sc1
    s_waitcnt lgkmcnt(3)
    v_mfma_f32_16x16x32_bf16 v[192:195], v[228:231], v[112:115], v[192:195]
    v_mfma_f32_16x16x32_bf16 v[196:199], v[228:231], v[116:119], v[196:199]
    ds_read_b128 v[244:247], v5 offset:27648
    s_waitcnt lgkmcnt(3)
    v_mfma_f32_16x16x32_bf16 v[184:187], v[232:235], v[120:123], v[184:187]
    v_mfma_f32_16x16x32_bf16 v[188:191], v[232:235], v[124:127], v[188:191]
    ds_read_b128 v[224:227], v5 offset:28672
    s_waitcnt lgkmcnt(3)
    v_mfma_f32_16x16x32_bf16 v[192:195], v[236:239], v[120:123], v[192:195]
    v_mfma_f32_16x16x32_bf16 v[196:199], v[236:239], v[124:127], v[196:199]
    ds_read_b128 v[228:231], v5 offset:29696
    s_waitcnt lgkmcnt(3)
    v_mfma_f32_16x16x32_bf16 v[184:187], v[240:243], v[128:131], v[184:187]
    v_mfma_f32_16x16x32_bf16 v[188:191], v[240:243], v[132:135], v[188:191]
    ds_read_b128 v[232:235], v5 offset:30720
    s_waitcnt lgkmcnt(3)
    v_mfma_f32_16x16x32_bf16 v[192:195], v[244:247], v[128:131], v[192:195]
    v_mfma_f32_16x16x32_bf16 v[196:199], v[244:247], v[132:135], v[196:199]
    ds_read_b128 v[236:239], v5 offset:31744
    s_waitcnt lgkmcnt(3)
    v_mfma_f32_16x16x32_bf16 v[184:187], v[224:227], v[136:139], v[184:187]
    v_mfma_f32_16x16x32_bf16 v[188:191], v[224:227], v[140:143], v[188:191]
    s_barrier
    ds_read_b128 v[240:243], v4 offset:0
    s_waitcnt lgkmcnt(3)
    v_mfma_f32_16x16x32_bf16 v[192:195], v[228:231], v[136:139], v[192:195]
    v_mfma_f32_16x16x32_bf16 v[196:199], v[228:231], v[140:143], v[196:199]
    s_add_u32 s22, s21, 0x98000
    s_add_u32 m0, s20, 0x20000
    s_nop 0
    buffer_load_dwordx4 v2, s[8:11], s22 offen sc1 lds
    ds_read_b128 v[244:247], v4 offset:1024
    s_waitcnt lgkmcnt(3)
    v_mfma_f32_16x16x32_bf16 v[184:187], v[232:235], v[144:147], v[184:187]
    v_mfma_f32_16x16x32_bf16 v[188:191], v[232:235], v[148:151], v[188:191]
    ds_read_b128 v[224:227], v4 offset:2048
    s_waitcnt lgkmcnt(3)
    v_mfma_f32_16x16x32_bf16 v[192:195], v[236:239], v[144:147], v[192:195]
    v_mfma_f32_16x16x32_bf16 v[196:199], v[236:239], v[148:151], v[196:199]
    ds_read_b128 v[228:231], v4 offset:3072
    s_waitcnt lgkmcnt(3)
    v_mfma_f32_16x16x32_bf16 v[200:203], v[240:243], v[24:27], 0
    v_mfma_f32_16x16x32_bf16 v[204:207], v[240:243], v[28:31], 0
    ds_read_b128 v[232:235], v4 offset:4096
    s_waitcnt lgkmcnt(3)
    v_mfma_f32_16x16x32_bf16 v[208:211], v[244:247], v[24:27], 0
    v_mfma_f32_16x16x32_bf16 v[212:215], v[244:247], v[28:31], 0
    s_add_u32 s22, s21, 0x98400
    s_add_u32 m0, s20, 0x20400
    s_nop 0
    buffer_load_dwordx4 v2, s[8:11], s22 offen sc1 lds
    ds_read_b128 v[236:239], v4 offset:5120
    v_mul_f32 v184, v184, v9
    s_waitcnt lgkmcnt(3)
    v_mfma_f32_16x16x32_bf16 v[200:203], v[224:227], v[32:35], v[200:203]
    v_mul_f32 v185, v185, v9
    s_waitcnt vmcnt(2)
    v_add_f32 v249, v249, v254
    v_mov_b32 v250, v249
    s_nop 1
    v_permlane16_swap_b32 v249, v250
    v_add_f32 v249, v249, v250
    v_mov_b32 v250, v249
    s_nop 1
    v_permlane32_swap_b32 v249, v250
    v_add_f32 v249, v249, v250
    v_cvt_pk_bf16_f32 v249, v249, v249
    v_lshlrev_b32 v249, 16, v249
    s_lshr_b32 s14, s2, 6
    s_cmp_eq_u32 s14, 2
    s_cselect_b32 s14, 1.0, 0
    v_add_f32 v249, s14, v249
    v_cvt_pk_bf16_f32 v249, v249, v249
    v_lshlrev_b32 v253, 1, v253
    s_lshl_b32 s14, s2, 5
    s_add_u32 s14, s14, 0x540000
    s_cmp_eq_u32 s3, 0
    s_cselect_b32 s14, s14, 0x7ffffff0
    s_mov_b64 exec, 0xffff
    buffer_store_short v249, v253, s[8:11], s14 offen sc1
    s_mov_b64 exec, -1
    v_mfma_f32_16x16x32_bf16 v[204:207], v[224:227], v[36:39], v[204:207]
    ds_read_b128 v[240:243], v4 offset:6144
    v_mul_f32 v186, v186, v9
    s_waitcnt lgkmcnt(3)
    v_mfma_f32_16x16x32_bf16 v[208:211], v[228:231], v[32:35], v[208:211]
    v_mul_f32 v187, v187, v9
    v_mfma_f32_16x16x32_bf16 v[212:215], v[228:231], v[36:39], v[212:215]
    ds_read_b128 v[244:247], v4 offset:7168
    v_mul_f32 v192, v192, v9
    s_waitcnt lgkmcnt(3)
    v_mfma_f32_16x16x32_bf16 v[200:203], v[232:235], v[40:43], v[200:203]
    v_mul_f32 v193, v193, v9
    v_mfma_f32_16x16x32_bf16 v[204:207], v[232:235], v[44:47], v[204:207]
    ds_read_b128 v[224:227], v4 offset:8192
    v_mul_f32 v194, v194, v9
    s_waitcnt lgkmcnt(3)
    v_mfma_f32_16x16x32_bf16 v[208:211], v[236:239], v[40:43], v[208:211]
    v_mul_f32 v195, v195, v9
    v_mfma_f32_16x16x32_bf16 v[212:215], v[236:239], v[44:47], v[212:215]
    ds_read_b128 v[228:231], v4 offset:9216
    v_cvt_pk_bf16_f32 v216, v184, v185
    s_waitcnt lgkmcnt(3)
    v_mfma_f32_16x16x32_bf16 v[200:203], v[240:243], v[48:51], v[200:203]
    v_cvt_pk_bf16_f32 v217, v186, v187
    v_mfma_f32_16x16x32_bf16 v[204:207], v[240:243], v[52:55], v[204:207]
    ds_read_b128 v[232:235], v4 offset:10240
    v_cvt_pk_bf16_f32 v218, v192, v193
    s_waitcnt lgkmcnt(3)
    v_mfma_f32_16x16x32_bf16 v[208:211], v[244:247], v[48:51], v[208:211]
    v_cvt_pk_bf16_f32 v219, v194, v195
    v_mfma_f32_16x16x32_bf16 v[212:215], v[244:247], v[52:55], v[212:215]
    ds_read_b128 v[236:239], v4 offset:11264
    buffer_store_dwordx4 v[216:219], v2, s[8:11], s25 offen offset:0 sc1
    s_waitcnt lgkmcnt(3)
    v_mfma_f32_16x16x32_bf16 v[200:203], v[224:227], v[56:59], v[200:203]
    v_mul_f32 v188, v188, v10
    v_mfma_f32_16x16x32_bf16 v[204:207], v[224:227], v[60:63], v[204:207]
    ds_read_b128 v[240:243], v4 offset:12288
    v_mul_f32 v189, v189, v10
    s_waitcnt lgkmcnt(3)
    v_mfma_f32_16x16x32_bf16 v[208:211], v[228:231], v[56:59], v[208:211]
    v_mul_f32 v190, v190, v10
    v_mfma_f32_16x16x32_bf16 v[212:215], v[228:231], v[60:63], v[212:215]
    ds_read_b128 v[244:247], v4 offset:13312
    v_mul_f32 v191, v191, v10
    s_waitcnt lgkmcnt(3)
    v_mfma_f32_16x16x32_bf16 v[200:203], v[232:235], v[64:67], v[200:203]
    v_mul_f32 v196, v196, v10
    v_mfma_f32_16x16x32_bf16 v[204:207], v[232:235], v[68:71], v[204:207]
    ds_read_b128 v[224:227], v4 offset:14336
    v_mul_f32 v197, v197, v10
    s_waitcnt lgkmcnt(3)
    v_mfma_f32_16x16x32_bf16 v[208:211], v[236:239], v[64:67], v[208:211]
    v_mul_f32 v198, v198, v10
    v_mfma_f32_16x16x32_bf16 v[212:215], v[236:239], v[68:71], v[212:215]
    ds_read_b128 v[228:231], v4 offset:15360
    v_mul_f32 v199, v199, v10
    s_waitcnt lgkmcnt(3)
    v_mfma_f32_16x16x32_bf16 v[200:203], v[240:243], v[72:75], v[200:203]
    v_cvt_pk_bf16_f32 v220, v188, v189
    v_mfma_f32_16x16x32_bf16 v[204:207], v[240:243], v[76:79], v[204:207]
    s_barrier
    ds_read_b128 v[232:235], v4 offset:16384
    v_cvt_pk_bf16_f32 v221, v190, v191
    s_waitcnt lgkmcnt(3)
    v_mfma_f32_16x16x32_bf16 v[208:211], v[244:247], v[72:75], v[208:211]
    v_cvt_pk_bf16_f32 v222, v196, v197
    v_mfma_f32_16x16x32_bf16 v[212:215], v[244:247], v[76:79], v[212:215]
    s_add_u32 s22, s21, 0x9c000
    s_add_u32 m0, s20, 0x24000
    s_nop 0
    buffer_load_dwordx4 v2, s[8:11], s22 offen sc1 lds
    ds_read_b128 v[236:239], v4 offset:17408
    v_cvt_pk_bf16_f32 v223, v198, v199
    s_waitcnt lgkmcnt(3)
    v_mfma_f32_16x16x32_bf16 v[200:203], v[224:227], v[80:83], v[200:203]
    buffer_store_dwordx4 v[220:223], v2, s[8:11], s26 offen offset:0 sc1
    v_mfma_f32_16x16x32_bf16 v[204:207], v[224:227], v[84:87], v[204:207]
    ds_read_b128 v[240:243], v4 offset:18432
    s_waitcnt lgkmcnt(3)
    v_mfma_f32_16x16x32_bf16 v[208:211], v[228:231], v[80:83], v[208:211]
    v_mfma_f32_16x16x32_bf16 v[212:215], v[228:231], v[84:87], v[212:215]
    ds_read_b128 v[244:247], v4 offset:19456
    s_waitcnt lgkmcnt(3)
    v_mfma_f32_16x16x32_bf16 v[200:203], v[232:235], v[88:91], v[200:203]
    v_mfma_f32_16x16x32_bf16 v[204:207], v[232:235], v[92:95], v[204:207]
    ds_read_b128 v[224:227], v4 offset:20480
    s_waitcnt lgkmcnt(3)
    v_mfma_f32_16x16x32_bf16 v[208:211], v[236:239], v[88:91], v[208:211]
    v_mfma_f32_16x16x32_bf16 v[212:215], v[236:239], v[92:95], v[212:215]
    s_add_u32 s22, s21, 0x9c400
    s_add_u32 m0, s20, 0x24400
    s_nop 0
    buffer_load_dwordx4 v2, s[8:11], s22 offen sc1 lds
    ds_read_b128 v[228:231], v4 offset:21504
    s_waitcnt lgkmcnt(3)
    v_mfma_f32_16x16x32_bf16 v[200:203], v[240:243], v[96:99], v[200:203]
    v_mfma_f32_16x16x32_bf16 v[204:207], v[240:243], v[100:103], v[204:207]
    ds_read_b128 v[232:235], v4 offset:22528
    s_waitcnt lgkmcnt(3)
    v_mfma_f32_16x16x32_bf16 v[208:211], v[244:247], v[96:99], v[208:211]
    v_mfma_f32_16x16x32_bf16 v[212:215], v[244:247], v[100:103], v[212:215]
    ds_read_b128 v[236:239], v4 offset:23552
    s_waitcnt lgkmcnt(3)
    v_mfma_f32_16x16x32_bf16 v[200:203], v[224:227], v[104:107], v[200:203]
    v_mfma_f32_16x16x32_bf16 v[204:207], v[224:227], v[108:111], v[204:207]
    ds_read_b128 v[240:243], v4 offset:24576
    s_waitcnt lgkmcnt(3)
    v_mfma_f32_16x16x32_bf16 v[208:211], v[228:231], v[104:107], v[208:211]
    v_mfma_f32_16x16x32_bf16 v[212:215], v[228:231], v[108:111], v[212:215]
    ds_read_b128 v[244:247], v4 offset:25600
    s_waitcnt lgkmcnt(3)
    v_mfma_f32_16x16x32_bf16 v[200:203], v[232:235], v[112:115], v[200:203]
    s_waitcnt vmcnt(4)
    v_mov_b32 v248, s28
    v_mov_b32 v249, 0
    s_lshl_b32 s14, s2, 2
    s_add_u32 s14, s14, 0x544000
    s_cmp_eq_u32 s3, 0
    s_cselect_b32 s14, s14, 0x7ffffff0
    s_mov_b64 exec, 1
    buffer_store_dword v248, v249, s[8:11], s14 offen sc1
    s_mov_b64 exec, -1
    v_mfma_f32_16x16x32_bf16 v[204:207], v[232:235], v[116:119], v[204:207]
    ds_read_b128 v[224:227], v4 offset:26624
    s_waitcnt lgkmcnt(3)
    v_mfma_f32_16x16x32_bf16 v[208:211], v[236:239], v[112:115], v[208:211]
    v_mfma_f32_16x16x32_bf16 v[212:215], v[236:239], v[116:119], v[212:215]
    ds_read_b128 v[228:231], v4 offset:27648
    s_waitcnt lgkmcnt(3)
    v_mfma_f32_16x16x32_bf16 v[200:203], v[240:243], v[120:123], v[200:203]
    v_mfma_f32_16x16x32_bf16 v[204:207], v[240:243], v[124:127], v[204:207]
    ds_read_b128 v[232:235], v4 offset:28672
    s_waitcnt lgkmcnt(3)
    v_mfma_f32_16x16x32_bf16 v[208:211], v[244:247], v[120:123], v[208:211]
    v_mfma_f32_16x16x32_bf16 v[212:215], v[244:247], v[124:127], v[212:215]
    ds_read_b128 v[236:239], v4 offset:29696
    s_waitcnt lgkmcnt(3)
    v_mfma_f32_16x16x32_bf16 v[200:203], v[224:227], v[128:131], v[200:203]
    v_mfma_f32_16x16x32_bf16 v[204:207], v[224:227], v[132:135], v[204:207]
    ds_read_b128 v[240:243], v4 offset:30720
    s_waitcnt lgkmcnt(3)
    v_mfma_f32_16x16x32_bf16 v[208:211], v[228:231], v[128:131], v[208:211]
    v_mfma_f32_16x16x32_bf16 v[212:215], v[228:231], v[132:135], v[212:215]
    ds_read_b128 v[244:247], v4 offset:31744
    s_waitcnt lgkmcnt(3)
    v_mfma_f32_16x16x32_bf16 v[200:203], v[232:235], v[136:139], v[200:203]
    v_mfma_f32_16x16x32_bf16 v[204:207], v[232:235], v[140:143], v[204:207]
    s_barrier
    ds_read_b128 v[224:227], v4 offset:32768
    s_waitcnt lgkmcnt(3)
    v_mfma_f32_16x16x32_bf16 v[208:211], v[236:239], v[136:139], v[208:211]
    v_mfma_f32_16x16x32_bf16 v[212:215], v[236:239], v[140:143], v[212:215]
    s_add_u32 s22, s24, 0x0
    s_add_u32 m0, s20, 0x10000
    s_nop 0
    buffer_load_dwordx4 v3, s[4:7], s22 offen lds
    ds_read_b128 v[228:231], v4 offset:33792
    s_waitcnt lgkmcnt(3)
    v_mfma_f32_16x16x32_bf16 v[200:203], v[240:243], v[144:147], v[200:203]
    v_mfma_f32_16x16x32_bf16 v[204:207], v[240:243], v[148:151], v[204:207]
    ds_read_b128 v[232:235], v4 offset:34816
    s_waitcnt lgkmcnt(3)
    v_mfma_f32_16x16x32_bf16 v[208:211], v[244:247], v[144:147], v[208:211]
    v_mfma_f32_16x16x32_bf16 v[212:215], v[244:247], v[148:151], v[212:215]
    ds_read_b128 v[236:239], v4 offset:35840
    s_waitcnt lgkmcnt(3)
    v_mfma_f32_16x16x32_bf16 v[184:187], v[224:227], v[24:27], 0
    v_mfma_f32_16x16x32_bf16 v[188:191], v[224:227], v[28:31], 0
    ds_read_b128 v[240:243], v4 offset:36864
    s_waitcnt lgkmcnt(3)
    v_mfma_f32_16x16x32_bf16 v[192:195], v[228:231], v[24:27], 0
    v_mfma_f32_16x16x32_bf16 v[196:199], v[228:231], v[28:31], 0
    s_add_u32 s22, s24, 0x2000
    s_add_u32 m0, s20, 0x10400
    s_nop 0
    buffer_load_dwordx4 v3, s[4:7], s22 offen lds
    ds_read_b128 v[244:247], v4 offset:37888
    v_mul_f32 v200, v200, v9
    s_waitcnt lgkmcnt(3)
    v_mfma_f32_16x16x32_bf16 v[184:187], v[232:235], v[32:35], v[184:187]
    v_mul_f32 v201, v201, v9
    v_mfma_f32_16x16x32_bf16 v[188:191], v[232:235], v[36:39], v[188:191]
    ds_read_b128 v[224:227], v4 offset:38912
    v_mul_f32 v202, v202, v9
    s_waitcnt lgkmcnt(3)
    v_mfma_f32_16x16x32_bf16 v[192:195], v[236:239], v[32:35], v[192:195]
    v_mul_f32 v203, v203, v9
    v_mfma_f32_16x16x32_bf16 v[196:199], v[236:239], v[36:39], v[196:199]
    ds_read_b128 v[228:231], v4 offset:39936
    v_mul_f32 v208, v208, v9
    s_waitcnt lgkmcnt(3)
    v_mfma_f32_16x16x32_bf16 v[184:187], v[240:243], v[40:43], v[184:187]
    v_mul_f32 v209, v209, v9
    v_mfma_f32_16x16x32_bf16 v[188:191], v[240:243], v[44:47], v[188:191]
    ds_read_b128 v[232:235], v4 offset:40960
    v_mul_f32 v210, v210, v9
    s_waitcnt lgkmcnt(3)
    v_mfma_f32_16x16x32_bf16 v[192:195], v[244:247], v[40:43], v[192:195]
    v_mul_f32 v211, v211, v9
    v_mfma_f32_16x16x32_bf16 v[196:199], v[244:247], v[44:47], v[196:199]
    ds_read_b128 v[236:239], v4 offset:41984
    v_cvt_pk_bf16_f32 v216, v200, v201
    s_waitcnt lgkmcnt(3)
    v_mfma_f32_16x16x32_bf16 v[184:187], v[224:227], v[48:51], v[184:187]
    v_cvt_pk_bf16_f32 v217, v202, v203
    s_waitcnt vmcnt(4)
    s_add_u32 s16, s63, 0x570000
    v_mov_b32 v7, s28
    v_mov_b32 v8, 0
    s_mov_b64 exec, 1
    buffer_store_dword v7, v8, s[8:11], s16 offen sc1
    s_mov_b64 exec, -1
    v_mfma_f32_16x16x32_bf16 v[188:191], v[224:227], v[52:55], v[188:191]
    ds_read_b128 v[240:243], v4 offset:43008
    v_cvt_pk_bf16_f32 v218, v208, v209
    s_waitcnt lgkmcnt(3)
    v_mfma_f32_16x16x32_bf16 v[192:195], v[228:231], v[48:51], v[192:195]
    v_cvt_pk_bf16_f32 v219, v210, v211
    v_mfma_f32_16x16x32_bf16 v[196:199], v[228:231], v[52:55], v[196:199]
    ds_read_b128 v[244:247], v4 offset:44032
    buffer_store_dwordx4 v[216:219], v2, s[8:11], s25 offen offset:1024 sc1
    s_waitcnt lgkmcnt(3)
    v_mfma_f32_16x16x32_bf16 v[184:187], v[232:235], v[56:59], v[184:187]
    v_mul_f32 v204, v204, v10
    v_mfma_f32_16x16x32_bf16 v[188:191], v[232:235], v[60:63], v[188:191]
    ds_read_b128 v[224:227], v4 offset:45056
    v_mul_f32 v205, v205, v10
    s_waitcnt lgkmcnt(3)
    v_mfma_f32_16x16x32_bf16 v[192:195], v[236:239], v[56:59], v[192:195]
    v_mul_f32 v206, v206, v10
    v_mfma_f32_16x16x32_bf16 v[196:199], v[236:239], v[60:63], v[196:199]
    ds_read_b128 v[228:231], v4 offset:46080
    v_mul_f32 v207, v207, v10
    s_waitcnt lgkmcnt(3)
    v_mfma_f32_16x16x32_bf16 v[184:187], v[240:243], v[64:67], v[184:187]
    v_mul_f32 v212, v212, v10
    v_mfma_f32_16x16x32_bf16 v[188:191], v[240:243], v[68:71], v[188:191]
    ds_read_b128 v[232:235], v4 offset:47104
    v_mul_f32 v213, v213, v10
    s_waitcnt lgkmcnt(3)
    v_mfma_f32_16x16x32_bf16 v[192:195], v[244:247], v[64:67], v[192:195]
    v_mul_f32 v214, v214, v10
    v_mfma_f32_16x16x32_bf16 v[196:199], v[244:247], v[68:71], v[196:199]
    ds_read_b128 v[236:239], v4 offset:48128
    v_mul_f32 v215, v215, v10
    s_waitcnt lgkmcnt(3)
    v_mfma_f32_16x16x32_bf16 v[184:187], v[224:227], v[72:75], v[184:187]
    v_cvt_pk_bf16_f32 v220, v204, v205
    v_mfma_f32_16x16x32_bf16 v[188:191], v[224:227], v[76:79], v[188:191]
    s_barrier
    ds_read_b128 v[240:243], v4 offset:49152
    v_cvt_pk_bf16_f32 v221, v206, v207
    s_waitcnt lgkmcnt(3)
    v_mfma_f32_16x16x32_bf16 v[192:195], v[228:231], v[72:75], v[192:195]
    v_cvt_pk_bf16_f32 v222, v212, v213
    v_mfma_f32_16x16x32_bf16 v[196:199], v[228:231], v[76:79], v[196:199]
    s_add_u32 s22, s24, 0x80000
    s_add_u32 m0, s20, 0x14000
    s_nop 0
    buffer_load_dwordx4 v3, s[4:7], s22 offen lds
    ds_read_b128 v[244:247], v4 offset:50176
    v_cvt_pk_bf16_f32 v223, v214, v215
    s_waitcnt lgkmcnt(3)
    v_mfma_f32_16x16x32_bf16 v[184:187], v[232:235], v[80:83], v[184:187]
    buffer_store_dwordx4 v[220:223], v2, s[8:11], s26 offen offset:1024 sc1
    v_mfma_f32_16x16x32_bf16 v[188:191], v[232:235], v[84:87], v[188:191]
    ds_read_b128 v[224:227], v4 offset:51200
    s_waitcnt lgkmcnt(3)
    v_mfma_f32_16x16x32_bf16 v[192:195], v[236:239], v[80:83], v[192:195]
    v_mfma_f32_16x16x32_bf16 v[196:199], v[236:239], v[84:87], v[196:199]
    ds_read_b128 v[228:231], v4 offset:52224
    s_waitcnt lgkmcnt(3)
    v_mfma_f32_16x16x32_bf16 v[184:187], v[240:243], v[88:91], v[184:187]
    v_mfma_f32_16x16x32_bf16 v[188:191], v[240:243], v[92:95], v[188:191]
    ds_read_b128 v[232:235], v4 offset:53248
    s_waitcnt lgkmcnt(3)
    v_mfma_f32_16x16x32_bf16 v[192:195], v[244:247], v[88:91], v[192:195]
    v_mfma_f32_16x16x32_bf16 v[196:199], v[244:247], v[92:95], v[196:199]
    s_add_u32 s22, s24, 0x82000
    s_add_u32 m0, s20, 0x14400
    s_nop 0
    buffer_load_dwordx4 v3, s[4:7], s22 offen lds
    ds_read_b128 v[236:239], v4 offset:54272
    s_waitcnt lgkmcnt(3)
    v_mfma_f32_16x16x32_bf16 v[184:187], v[224:227], v[96:99], v[184:187]
    v_mfma_f32_16x16x32_bf16 v[188:191], v[224:227], v[100:103], v[188:191]
    ds_read_b128 v[240:243], v4 offset:55296
    s_waitcnt lgkmcnt(3)
    v_mfma_f32_16x16x32_bf16 v[192:195], v[228:231], v[96:99], v[192:195]
    v_mfma_f32_16x16x32_bf16 v[196:199], v[228:231], v[100:103], v[196:199]
    ds_read_b128 v[244:247], v4 offset:56320
    s_waitcnt lgkmcnt(3)
    v_mfma_f32_16x16x32_bf16 v[184:187], v[232:235], v[104:107], v[184:187]
    v_mfma_f32_16x16x32_bf16 v[188:191], v[232:235], v[108:111], v[188:191]
    ds_read_b128 v[224:227], v4 offset:57344
    s_waitcnt lgkmcnt(3)
    v_mfma_f32_16x16x32_bf16 v[192:195], v[236:239], v[104:107], v[192:195]
    v_mfma_f32_16x16x32_bf16 v[196:199], v[236:239], v[108:111], v[196:199]
    ds_read_b128 v[228:231], v4 offset:58368
    s_waitcnt lgkmcnt(3)
    v_mfma_f32_16x16x32_bf16 v[184:187], v[240:243], v[112:115], v[184:187]
    v_mfma_f32_16x16x32_bf16 v[188:191], v[240:243], v[116:119], v[188:191]
    ds_read_b128 v[232:235], v4 offset:59392
    s_waitcnt lgkmcnt(3)
    v_mfma_f32_16x16x32_bf16 v[192:195], v[244:247], v[112:115], v[192:195]
    v_mfma_f32_16x16x32_bf16 v[196:199], v[244:247], v[116:119], v[196:199]
    ds_read_b128 v[236:239], v4 offset:60416
    s_waitcnt lgkmcnt(3)
    v_mfma_f32_16x16x32_bf16 v[184:187], v[224:227], v[120:123], v[184:187]
    v_mfma_f32_16x16x32_bf16 v[188:191], v[224:227], v[124:127], v[188:191]
    ds_read_b128 v[240:243], v4 offset:61440
    s_waitcnt lgkmcnt(3)
    v_mfma_f32_16x16x32_bf16 v[192:195], v[228:231], v[120:123], v[192:195]
    v_mfma_f32_16x16x32_bf16 v[196:199], v[228:231], v[124:127], v[196:199]
    ds_read_b128 v[244:247], v4 offset:62464
    s_waitcnt lgkmcnt(3)
    v_mfma_f32_16x16x32_bf16 v[184:187], v[232:235], v[128:131], v[184:187]
    v_mfma_f32_16x16x32_bf16 v[188:191], v[232:235], v[132:135], v[188:191]
    ds_read_b128 v[224:227], v4 offset:63488
    s_waitcnt lgkmcnt(3)
    v_mfma_f32_16x16x32_bf16 v[192:195], v[236:239], v[128:131], v[192:195]
    v_mfma_f32_16x16x32_bf16 v[196:199], v[236:239], v[132:135], v[196:199]
    ds_read_b128 v[228:231], v4 offset:64512
    s_waitcnt lgkmcnt(3)
    v_mfma_f32_16x16x32_bf16 v[184:187], v[240:243], v[136:139], v[184:187]
    v_mfma_f32_16x16x32_bf16 v[188:191], v[240:243], v[140:143], v[188:191]
    s_barrier
    ds_read_b128 v[232:235], v5 offset:0
    s_waitcnt lgkmcnt(3)
    v_mfma_f32_16x16x32_bf16 v[192:195], v[244:247], v[136:139], v[192:195]
    v_mfma_f32_16x16x32_bf16 v[196:199], v[244:247], v[140:143], v[196:199]
    s_add_u32 s22, s24, 0x100000
    s_add_u32 m0, s20, 0x18000
    s_nop 0
    buffer_load_dwordx4 v3, s[4:7], s22 offen lds
    ds_read_b128 v[236:239], v5 offset:1024
    s_waitcnt lgkmcnt(3)
    v_mfma_f32_16x16x32_bf16 v[184:187], v[224:227], v[144:147], v[184:187]
    v_mfma_f32_16x16x32_bf16 v[188:191], v[224:227], v[148:151], v[188:191]
    ds_read_b128 v[240:243], v5 offset:2048
    s_waitcnt lgkmcnt(3)
    v_mfma_f32_16x16x32_bf16 v[192:195], v[228:231], v[144:147], v[192:195]
    v_mfma_f32_16x16x32_bf16 v[196:199], v[228:231], v[148:151], v[196:199]
    ds_read_b128 v[244:247], v5 offset:3072
    s_waitcnt lgkmcnt(3)
    v_mfma_f32_16x16x32_bf16 v[200:203], v[232:235], v[24:27], 0
    v_mfma_f32_16x16x32_bf16 v[204:207], v[232:235], v[28:31], 0
    ds_read_b128 v[224:227], v5 offset:4096
    s_waitcnt lgkmcnt(3)
    v_mfma_f32_16x16x32_bf16 v[208:211], v[236:239], v[24:27], 0
    v_mfma_f32_16x16x32_bf16 v[212:215], v[236:239], v[28:31], 0
    s_add_u32 s22, s24, 0x102000
    s_add_u32 m0, s20, 0x18400
    s_nop 0
    buffer_load_dwordx4 v3, s[4:7], s22 offen lds
    ds_read_b128 v[228:231], v5 offset:5120
    v_mul_f32 v184, v184, v9
    s_waitcnt lgkmcnt(3)
    v_mfma_f32_16x16x32_bf16 v[200:203], v[240:243], v[32:35], v[200:203]
    v_mul_f32 v185, v185, v9
    s_bfe_u32 s30, s2, 0x20001
    s_lshl_b32 s30, s30, 2
    s_bfe_u32 s17, s2, 0x20003
    s_add_u32 s30, s30, s17
    s_lshr_b32 s31, s2, 5
    s_and_b32 s17, s3, 3
    s_lshl_b32 s19, s30, 2
    s_add_u32 s19, s19, s17
    s_and_b32 s16, s2, 1
    s_lshl_b32 s17, s19, 18
    s_lshl_b32 s23, s16, 16
    s_add_u32 s17, s17, s23
    s_add_u32 s17, s17, 0x1000000
    v_add_u32 v6, s17, v2
    s_lshl_b32 s19, s19, 7
    s_lshl_b32 s23, s16, 6
    s_add_u32 s19, s19, s23
    s_add_u32 s19, s19, 0x570000
    v_and_b32 v13, 15, v1
    v_lshlrev_b32 v13, 2, v13
    buffer_load_dword v12, v13, s[8:11], s19 offen sc1
    v_mfma_f32_16x16x32_bf16 v[204:207], v[240:243], v[36:39], v[204:207]
    ds_read_b128 v[232:235], v5 offset:6144
    v_mul_f32 v186, v186, v9
    s_waitcnt lgkmcnt(3)
    v_mfma_f32_16x16x32_bf16 v[208:211], v[244:247], v[32:35], v[208:211]
    v_mul_f32 v187, v187, v9
    v_mfma_f32_16x16x32_bf16 v[212:215], v[244:247], v[36:39], v[212:215]
    ds_read_b128 v[236:239], v5 offset:7168
    v_mul_f32 v192, v192, v9
    s_waitcnt lgkmcnt(3)
    v_mfma_f32_16x16x32_bf16 v[200:203], v[224:227], v[40:43], v[200:203]
    v_mul_f32 v193, v193, v9
    v_mfma_f32_16x16x32_bf16 v[204:207], v[224:227], v[44:47], v[204:207]
    ds_read_b128 v[240:243], v5 offset:8192
    v_mul_f32 v194, v194, v9
    s_waitcnt lgkmcnt(3)
    v_mfma_f32_16x16x32_bf16 v[208:211], v[228:231], v[40:43], v[208:211]
    v_mul_f32 v195, v195, v9
    v_mfma_f32_16x16x32_bf16 v[212:215], v[228:231], v[44:47], v[212:215]
    ds_read_b128 v[244:247], v5 offset:9216
    v_cvt_pk_bf16_f32 v216, v184, v185
    s_waitcnt lgkmcnt(3)
    v_mfma_f32_16x16x32_bf16 v[200:203], v[232:235], v[48:51], v[200:203]
    v_cvt_pk_bf16_f32 v217, v186, v187
    v_mfma_f32_16x16x32_bf16 v[204:207], v[232:235], v[52:55], v[204:207]
    ds_read_b128 v[224:227], v5 offset:10240
    v_cvt_pk_bf16_f32 v218, v192, v193
    s_waitcnt lgkmcnt(3)
    v_mfma_f32_16x16x32_bf16 v[208:211], v[236:239], v[48:51], v[208:211]
    v_cvt_pk_bf16_f32 v219, v194, v195
    v_mfma_f32_16x16x32_bf16 v[212:215], v[236:239], v[52:55], v[212:215]
    ds_read_b128 v[228:231], v5 offset:11264
    buffer_store_dwordx4 v[216:219], v2, s[8:11], s25 offen offset:2048 sc1
    s_waitcnt lgkmcnt(3)
    v_mfma_f32_16x16x32_bf16 v[200:203], v[240:243], v[56:59], v[200:203]
    v_mul_f32 v188, v188, v10
    v_mfma_f32_16x16x32_bf16 v[204:207], v[240:243], v[60:63], v[204:207]
    ds_read_b128 v[232:235], v5 offset:12288
    v_mul_f32 v189, v189, v10
    s_waitcnt lgkmcnt(3)
    v_mfma_f32_16x16x32_bf16 v[208:211], v[244:247], v[56:59], v[208:211]
    v_mul_f32 v190, v190, v10
    v_mfma_f32_16x16x32_bf16 v[212:215], v[244:247], v[60:63], v[212:215]
    ds_read_b128 v[236:239], v5 offset:13312
    v_mul_f32 v191, v191, v10
    s_waitcnt lgkmcnt(3)
    v_mfma_f32_16x16x32_bf16 v[200:203], v[224:227], v[64:67], v[200:203]
    v_mul_f32 v196, v196, v10
    v_mfma_f32_16x16x32_bf16 v[204:207], v[224:227], v[68:71], v[204:207]
    ds_read_b128 v[240:243], v5 offset:14336
    v_mul_f32 v197, v197, v10
    s_waitcnt lgkmcnt(3)
    v_mfma_f32_16x16x32_bf16 v[208:211], v[228:231], v[64:67], v[208:211]
    v_mul_f32 v198, v198, v10
    v_mfma_f32_16x16x32_bf16 v[212:215], v[228:231], v[68:71], v[212:215]
    ds_read_b128 v[244:247], v5 offset:15360
    v_mul_f32 v199, v199, v10
    s_waitcnt lgkmcnt(3)
    v_mfma_f32_16x16x32_bf16 v[200:203], v[232:235], v[72:75], v[200:203]
    v_cvt_pk_bf16_f32 v220, v188, v189
    v_mfma_f32_16x16x32_bf16 v[204:207], v[232:235], v[76:79], v[204:207]
    s_waitcnt vmcnt(12)
    s_barrier
    ds_read_b128 v[224:227], v5 offset:16384
    v_cvt_pk_bf16_f32 v221, v190, v191
    s_waitcnt lgkmcnt(3)
    v_mfma_f32_16x16x32_bf16 v[208:211], v[236:239], v[72:75], v[208:211]
    v_cvt_pk_bf16_f32 v222, v196, v197
    v_mfma_f32_16x16x32_bf16 v[212:215], v[236:239], v[76:79], v[212:215]
    s_add_u32 s22, s24, 0x180000
    s_add_u32 m0, s20, 0x1c000
    s_nop 0
    buffer_load_dwordx4 v3, s[4:7], s22 offen lds
    ds_read_b128 v[228:231], v5 offset:17408
    v_cvt_pk_bf16_f32 v223, v198, v199
    s_waitcnt lgkmcnt(3)
    v_mfma_f32_16x16x32_bf16 v[200:203], v[240:243], v[80:83], v[200:203]
    buffer_store_dwordx4 v[220:223], v2, s[8:11], s26 offen offset:2048 sc1
    v_mfma_f32_16x16x32_bf16 v[204:207], v[240:243], v[84:87], v[204:207]
    ds_read_b128 v[232:235], v5 offset:18432
    s_waitcnt lgkmcnt(3)
    v_mfma_f32_16x16x32_bf16 v[208:211], v[244:247], v[80:83], v[208:211]
    v_mfma_f32_16x16x32_bf16 v[212:215], v[244:247], v[84:87], v[212:215]
    ds_read_b128 v[236:239], v5 offset:19456
    s_waitcnt lgkmcnt(3)
    v_mfma_f32_16x16x32_bf16 v[200:203], v[224:227], v[88:91], v[200:203]
    v_mfma_f32_16x16x32_bf16 v[204:207], v[224:227], v[92:95], v[204:207]
    ds_read_b128 v[240:243], v5 offset:20480
    s_waitcnt vmcnt(3)
    v_cmp_ne_u32 vcc, s28, v12
    s_cbranch_vccnz adaLN_cond__sliding_block_cached__moe_arch_mod__prompt_kernel_o6r
adaLN_cond__sliding_block_cached__moe_arch_mod__prompt_kernel_o6b:
    s_waitcnt lgkmcnt(3)
    v_mfma_f32_16x16x32_bf16 v[208:211], v[228:231], v[88:91], v[208:211]
    s_mov_b32 s23, 0x0
    buffer_load_dwordx4 v[24:27], v6, s[8:11], s23 offen offset:0 sc1
    v_mfma_f32_16x16x32_bf16 v[212:215], v[228:231], v[92:95], v[212:215]
    s_add_u32 s22, s24, 0x182000
    s_add_u32 m0, s20, 0x1c400
    s_nop 0
    buffer_load_dwordx4 v3, s[4:7], s22 offen lds
    ds_read_b128 v[244:247], v5 offset:21504
    s_waitcnt lgkmcnt(3)
    v_mfma_f32_16x16x32_bf16 v[200:203], v[232:235], v[96:99], v[200:203]
    v_mfma_f32_16x16x32_bf16 v[204:207], v[232:235], v[100:103], v[204:207]
    ds_read_b128 v[224:227], v5 offset:22528
    s_mov_b32 s23, 0x20000
    buffer_load_dwordx4 v[28:31], v6, s[8:11], s23 offen offset:0 sc1
    s_waitcnt lgkmcnt(3)
    v_mfma_f32_16x16x32_bf16 v[208:211], v[236:239], v[96:99], v[208:211]
    s_add_u32 s16, s63, 0x572000
    v_mov_b32 v14, s28
    v_mov_b32 v15, 0
    s_mov_b64 exec, 1
    buffer_store_dword v14, v15, s[8:11], s16 offen sc1
    s_mov_b64 exec, -1
    v_mfma_f32_16x16x32_bf16 v[212:215], v[236:239], v[100:103], v[212:215]
    ds_read_b128 v[228:231], v5 offset:23552
    s_waitcnt lgkmcnt(3)
    v_mfma_f32_16x16x32_bf16 v[200:203], v[240:243], v[104:107], v[200:203]
    v_mfma_f32_16x16x32_bf16 v[204:207], v[240:243], v[108:111], v[204:207]
    ds_read_b128 v[232:235], v5 offset:24576
    s_mov_b32 s23, 0x2000
    buffer_load_dwordx4 v[32:35], v6, s[8:11], s23 offen offset:0 sc1
    s_waitcnt lgkmcnt(3)
    v_mfma_f32_16x16x32_bf16 v[208:211], v[244:247], v[104:107], v[208:211]
    v_mfma_f32_16x16x32_bf16 v[212:215], v[244:247], v[108:111], v[212:215]
    ds_read_b128 v[236:239], v5 offset:25600
    s_waitcnt lgkmcnt(3)
    v_mfma_f32_16x16x32_bf16 v[200:203], v[224:227], v[112:115], v[200:203]
    s_mov_b32 s23, 0x22000
    buffer_load_dwordx4 v[36:39], v6, s[8:11], s23 offen offset:0 sc1
    v_mfma_f32_16x16x32_bf16 v[204:207], v[224:227], v[116:119], v[204:207]
    ds_read_b128 v[240:243], v5 offset:26624
    s_waitcnt lgkmcnt(3)
    v_mfma_f32_16x16x32_bf16 v[208:211], v[228:231], v[112:115], v[208:211]
    v_mfma_f32_16x16x32_bf16 v[212:215], v[228:231], v[116:119], v[212:215]
    ds_read_b128 v[244:247], v5 offset:27648
    s_waitcnt lgkmcnt(3)
    v_mfma_f32_16x16x32_bf16 v[200:203], v[232:235], v[120:123], v[200:203]
    s_mov_b32 s23, 0x4000
    buffer_load_dwordx4 v[40:43], v6, s[8:11], s23 offen offset:0 sc1
    v_mfma_f32_16x16x32_bf16 v[204:207], v[232:235], v[124:127], v[204:207]
    ds_read_b128 v[224:227], v5 offset:28672
    s_waitcnt lgkmcnt(3)
    v_mfma_f32_16x16x32_bf16 v[208:211], v[236:239], v[120:123], v[208:211]
    v_mfma_f32_16x16x32_bf16 v[212:215], v[236:239], v[124:127], v[212:215]
    ds_read_b128 v[228:231], v5 offset:29696
    s_waitcnt lgkmcnt(3)
    v_mfma_f32_16x16x32_bf16 v[200:203], v[240:243], v[128:131], v[200:203]
    s_mov_b32 s23, 0x24000
    buffer_load_dwordx4 v[44:47], v6, s[8:11], s23 offen offset:0 sc1
    v_mfma_f32_16x16x32_bf16 v[204:207], v[240:243], v[132:135], v[204:207]
    ds_read_b128 v[232:235], v5 offset:30720
    s_waitcnt lgkmcnt(3)
    v_mfma_f32_16x16x32_bf16 v[208:211], v[244:247], v[128:131], v[208:211]
    v_mfma_f32_16x16x32_bf16 v[212:215], v[244:247], v[132:135], v[212:215]
    ds_read_b128 v[236:239], v5 offset:31744
    s_mov_b32 s23, 0x6000
    buffer_load_dwordx4 v[48:51], v6, s[8:11], s23 offen offset:0 sc1
    s_waitcnt lgkmcnt(3)
    v_mfma_f32_16x16x32_bf16 v[200:203], v[224:227], v[136:139], v[200:203]
    v_bfe_u32 v18, v1, 2, 2
    v_lshrrev_b32 v19, 4, v1
    v_mfma_f32_16x16x32_bf16 v[204:207], v[224:227], v[140:143], v[204:207]
    v_and_b32 v17, 3, v1
    v_lshlrev_b32 v16, 11, v19
    s_waitcnt lgkmcnt(2)
    v_mfma_f32_16x16x32_bf16 v[208:211], v[228:231], v[136:139], v[208:211]
    v_lshl_add_u32 v16, v18, 6, v16
    v_lshl_add_u32 v16, v17, 3, v16
    v_mfma_f32_16x16x32_bf16 v[212:215], v[228:231], v[140:143], v[212:215]
    s_mov_b32 s23, 0x26000
    buffer_load_dwordx4 v[52:55], v6, s[8:11], s23 offen offset:0 sc1
    v_add_u32 v16, 0x10000, v16
    v_and_b32 v19, 1, v19
    s_waitcnt lgkmcnt(1)
    v_mfma_f32_16x16x32_bf16 v[200:203], v[232:235], v[144:147], v[200:203]
    v_lshlrev_b32 v19, 5, v19
    v_sub_u32 v5, v16, v19
    v_mfma_f32_16x16x32_bf16 v[204:207], v[232:235], v[148:151], v[204:207]
    v_add_u32 v4, v16, v19
    v_add_u32 v7, 0x10000, v4
    s_waitcnt lgkmcnt(0)
    v_mfma_f32_16x16x32_bf16 v[208:211], v[236:239], v[144:147], v[208:211]
    v_add_u32 v8, 0x10000, v5
    v_mfma_f32_16x16x32_bf16 v[212:215], v[236:239], v[148:151], v[212:215]
    v_mul_f32 v200, v200, v9
    v_mul_f32 v201, v201, v9
    v_mul_f32 v202, v202, v9
    v_mul_f32 v203, v203, v9
    s_nop 1
    v_mul_f32 v208, v208, v9
    v_mul_f32 v209, v209, v9
    v_mul_f32 v210, v210, v9
    v_mul_f32 v211, v211, v9
    v_cvt_pk_bf16_f32 v216, v200, v201
    v_cvt_pk_bf16_f32 v217, v202, v203
    v_cvt_pk_bf16_f32 v218, v208, v209
    v_cvt_pk_bf16_f32 v219, v210, v211
    buffer_store_dwordx4 v[216:219], v2, s[8:11], s25 offen offset:3072 sc1
    v_mul_f32 v204, v204, v10
    v_mul_f32 v205, v205, v10
    v_mul_f32 v206, v206, v10
    v_mul_f32 v207, v207, v10
    v_mul_f32 v212, v212, v10
    v_mul_f32 v213, v213, v10
    v_mul_f32 v214, v214, v10
    v_mul_f32 v215, v215, v10
    v_cvt_pk_bf16_f32 v220, v204, v205
    v_cvt_pk_bf16_f32 v221, v206, v207
    v_cvt_pk_bf16_f32 v222, v212, v213
    v_cvt_pk_bf16_f32 v223, v214, v215
    buffer_store_dwordx4 v[220:223], v2, s[8:11], s26 offen offset:3072 sc1
    s_and_b32 s15, s2, 1
    s_barrier
    ds_read_b64_tr_b16 v[224:225], v4 offset:0
    ds_read_b64_tr_b16 v[226:227], v4 offset:1024
    ds_read_b64_tr_b16 v[228:229], v5 offset:32
    ds_read_b64_tr_b16 v[230:231], v5 offset:1056
    ds_read_b64_tr_b16 v[232:233], v4 offset:256
    ds_read_b64_tr_b16 v[234:235], v4 offset:1280
    ds_read_b64_tr_b16 v[236:237], v5 offset:288
    ds_read_b64_tr_b16 v[238:239], v5 offset:1312
    s_waitcnt vmcnt(11) lgkmcnt(6)
    v_mfma_f32_16x16x32_bf16 v[88:91], v[224:227], v[24:27], 0
    ds_read_b64_tr_b16 v[240:241], v4 offset:512
    s_waitcnt vmcnt(9)
    v_mfma_f32_16x16x32_bf16 v[92:95], v[224:227], v[28:31], 0
    s_add_u32 s22, s24, 0x200000
    s_add_u32 m0, s20, 0x20000
    s_nop 0
    buffer_load_dwordx4 v3, s[4:7], s22 offen lds
    ds_read_b64_tr_b16 v[242:243], v4 offset:1536
    s_waitcnt lgkmcnt(6)
    v_mfma_f32_16x16x32_bf16 v[96:99], v[228:231], v[24:27], 0
    ds_read_b64_tr_b16 v[244:245], v5 offset:544
    s_mov_b32 s23, 0x8000
    buffer_load_dwordx4 v[56:59], v6, s[8:11], s23 offen offset:0 sc1
    v_mfma_f32_16x16x32_bf16 v[100:103], v[228:231], v[28:31], 0
    ds_read_b64_tr_b16 v[246:247], v5 offset:1568
    s_waitcnt lgkmcnt(6)
    v_mfma_f32_16x16x32_bf16 v[104:107], v[232:235], v[24:27], 0
    s_add_u32 s22, s24, 0x202000
    s_add_u32 m0, s20, 0x20400
    s_nop 0
    buffer_load_dwordx4 v3, s[4:7], s22 offen lds
    ds_read_b64_tr_b16 v[224:225], v4 offset:768
    v_mfma_f32_16x16x32_bf16 v[108:111], v[232:235], v[28:31], 0
    ds_read_b64_tr_b16 v[226:227], v4 offset:1792
    s_mov_b32 s23, 0x28000
    buffer_load_dwordx4 v[60:63], v6, s[8:11], s23 offen offset:0 sc1
    s_waitcnt lgkmcnt(6)
    v_mfma_f32_16x16x32_bf16 v[112:115], v[236:239], v[24:27], 0
    ds_read_b64_tr_b16 v[228:229], v5 offset:800
    v_mfma_f32_16x16x32_bf16 v[116:119], v[236:239], v[28:31], 0
    ds_read_b64_tr_b16 v[230:231], v5 offset:1824
    s_waitcnt lgkmcnt(6)
    v_mfma_f32_16x16x32_bf16 v[120:123], v[240:243], v[24:27], 0
    v_mfma_f32_16x16x32_bf16 v[124:127], v[240:243], v[28:31], 0
    s_barrier
    ds_read_b64_tr_b16 v[232:233], v4 offset:16384
    ds_read_b64_tr_b16 v[234:235], v4 offset:17408
    s_waitcnt lgkmcnt(6)
    v_mfma_f32_16x16x32_bf16 v[128:131], v[244:247], v[24:27], 0
    s_add_u32 s22, s24, 0x280000
    s_add_u32 m0, s20, 0x24000
    s_nop 0
    buffer_load_dwordx4 v3, s[4:7], s22 offen lds
    ds_read_b64_tr_b16 v[236:237], v5 offset:16416
    v_mfma_f32_16x16x32_bf16 v[132:135], v[244:247], v[28:31], 0
    ds_read_b64_tr_b16 v[238:239], v5 offset:17440
    s_waitcnt lgkmcnt(6)
    v_mfma_f32_16x16x32_bf16 v[136:139], v[224:227], v[24:27], 0
    ds_read_b64_tr_b16 v[240:241], v4 offset:16640
    v_mfma_f32_16x16x32_bf16 v[140:143], v[224:227], v[28:31], 0
    s_add_u32 s22, s24, 0x282000
    s_add_u32 m0, s20, 0x24400
    s_nop 0
    buffer_load_dwordx4 v3, s[4:7], s22 offen lds
    ds_read_b64_tr_b16 v[242:243], v4 offset:17664
    s_waitcnt lgkmcnt(6)
    v_mfma_f32_16x16x32_bf16 v[144:147], v[228:231], v[24:27], 0
    ds_read_b64_tr_b16 v[244:245], v5 offset:16672
    v_mfma_f32_16x16x32_bf16 v[148:151], v[228:231], v[28:31], 0
    ds_read_b64_tr_b16 v[246:247], v5 offset:17696
    s_waitcnt vmcnt(13) lgkmcnt(6)
    v_mfma_f32_16x16x32_bf16 v[88:91], v[232:235], v[32:35], v[88:91]
    ds_read_b64_tr_b16 v[224:225], v4 offset:16896
    s_waitcnt vmcnt(12)
    v_mfma_f32_16x16x32_bf16 v[92:95], v[232:235], v[36:39], v[92:95]
    ds_read_b64_tr_b16 v[226:227], v4 offset:17920
    s_waitcnt lgkmcnt(6)
    v_mfma_f32_16x16x32_bf16 v[96:99], v[236:239], v[32:35], v[96:99]
    ds_read_b64_tr_b16 v[228:229], v5 offset:16928
    s_mov_b32 s23, 0xa000
    buffer_load_dwordx4 v[24:27], v6, s[8:11], s23 offen offset:0 sc1
    v_mfma_f32_16x16x32_bf16 v[100:103], v[236:239], v[36:39], v[100:103]
    ds_read_b64_tr_b16 v[230:231], v5 offset:17952
    s_waitcnt lgkmcnt(6)
    v_mfma_f32_16x16x32_bf16 v[104:107], v[240:243], v[32:35], v[104:107]
    ds_read_b64_tr_b16 v[232:233], v4 offset:17152
    v_mfma_f32_16x16x32_bf16 v[108:111], v[240:243], v[36:39], v[108:111]
    ds_read_b64_tr_b16 v[234:235], v4 offset:18176
    s_mov_b32 s23, 0x2a000
    buffer_load_dwordx4 v[28:31], v6, s[8:11], s23 offen offset:0 sc1
    s_waitcnt lgkmcnt(6)
    v_mfma_f32_16x16x32_bf16 v[112:115], v[244:247], v[32:35], v[112:115]
    ds_read_b64_tr_b16 v[236:237], v5 offset:17184
    v_mfma_f32_16x16x32_bf16 v[116:119], v[244:247], v[36:39], v[116:119]
    ds_read_b64_tr_b16 v[238:239], v5 offset:18208
    s_waitcnt lgkmcnt(6)
    v_mfma_f32_16x16x32_bf16 v[120:123], v[224:227], v[32:35], v[120:123]
    v_mfma_f32_16x16x32_bf16 v[124:127], v[224:227], v[36:39], v[124:127]
    s_barrier
    ds_read_b64_tr_b16 v[240:241], v4 offset:32768
    ds_read_b64_tr_b16 v[242:243], v4 offset:33792
    s_waitcnt lgkmcnt(6)
    v_mfma_f32_16x16x32_bf16 v[128:131], v[228:231], v[32:35], v[128:131]
    s_add_u32 s22, s24, 0x300000
    s_add_u32 m0, s20, 0x10000
    s_nop 0
    buffer_load_dwordx4 v3, s[4:7], s22 offen lds
    ds_read_b64_tr_b16 v[244:245], v5 offset:32800
    v_mfma_f32_16x16x32_bf16 v[132:135], v[228:231], v[36:39], v[132:135]
    ds_read_b64_tr_b16 v[246:247], v5 offset:33824
    s_waitcnt lgkmcnt(6)
    v_mfma_f32_16x16x32_bf16 v[136:139], v[232:235], v[32:35], v[136:139]
    ds_read_b64_tr_b16 v[224:225], v4 offset:33024
    v_mfma_f32_16x16x32_bf16 v[140:143], v[232:235], v[36:39], v[140:143]
    s_add_u32 s22, s24, 0x302000
    s_add_u32 m0, s20, 0x10400
    s_nop 0
    buffer_load_dwordx4 v3, s[4:7], s22 offen lds
    ds_read_b64_tr_b16 v[226:227], v4 offset:34048
    s_waitcnt lgkmcnt(6)
    v_mfma_f32_16x16x32_bf16 v[144:147], v[236:239], v[32:35], v[144:147]
    s_add_u32 s16, s63, 0x574000
    v_mov_b32 v14, s28
    v_mov_b32 v15, 0
    s_mov_b64 exec, 1
    buffer_store_dword v14, v15, s[8:11], s16 offen sc1
    s_mov_b64 exec, -1
    ds_read_b64_tr_b16 v[228:229], v5 offset:33056
    v_mfma_f32_16x16x32_bf16 v[148:151], v[236:239], v[36:39], v[148:151]
    ds_read_b64_tr_b16 v[230:231], v5 offset:34080
    s_waitcnt vmcnt(16) lgkmcnt(6)
    v_mfma_f32_16x16x32_bf16 v[88:91], v[240:243], v[40:43], v[88:91]
    ds_read_b64_tr_b16 v[232:233], v4 offset:33280
    s_waitcnt vmcnt(15)
    v_mfma_f32_16x16x32_bf16 v[92:95], v[240:243], v[44:47], v[92:95]
    ds_read_b64_tr_b16 v[234:235], v4 offset:34304
    s_waitcnt lgkmcnt(6)
    v_mfma_f32_16x16x32_bf16 v[96:99], v[244:247], v[40:43], v[96:99]
    ds_read_b64_tr_b16 v[236:237], v5 offset:33312
    s_mov_b32 s23, 0xc000
    buffer_load_dwordx4 v[32:35], v6, s[8:11], s23 offen offset:0 sc1
    v_mfma_f32_16x16x32_bf16 v[100:103], v[244:247], v[44:47], v[100:103]
    ds_read_b64_tr_b16 v[238:239], v5 offset:34336
    s_waitcnt lgkmcnt(6)
    v_mfma_f32_16x16x32_bf16 v[104:107], v[224:227], v[40:43], v[104:107]
    ds_read_b64_tr_b16 v[240:241], v4 offset:33536
    v_mfma_f32_16x16x32_bf16 v[108:111], v[224:227], v[44:47], v[108:111]
    ds_read_b64_tr_b16 v[242:243], v4 offset:34560
    s_mov_b32 s23, 0x2c000
    buffer_load_dwordx4 v[36:39], v6, s[8:11], s23 offen offset:0 sc1
    s_waitcnt lgkmcnt(6)
    v_mfma_f32_16x16x32_bf16 v[112:115], v[228:231], v[40:43], v[112:115]
    ds_read_b64_tr_b16 v[244:245], v5 offset:33568
    v_mfma_f32_16x16x32_bf16 v[116:119], v[228:231], v[44:47], v[116:119]
    ds_read_b64_tr_b16 v[246:247], v5 offset:34592
    s_waitcnt lgkmcnt(6)
    v_mfma_f32_16x16x32_bf16 v[120:123], v[232:235], v[40:43], v[120:123]
    v_mfma_f32_16x16x32_bf16 v[124:127], v[232:235], v[44:47], v[124:127]
    s_barrier
    ds_read_b64_tr_b16 v[224:225], v4 offset:49152
    ds_read_b64_tr_b16 v[226:227], v4 offset:50176
    s_add_u32 s19, s19, 8192
    buffer_load_dword v12, v13, s[8:11], s19 offen sc1
    s_waitcnt lgkmcnt(6)
    v_mfma_f32_16x16x32_bf16 v[128:131], v[236:239], v[40:43], v[128:131]
    s_add_u32 s22, s24, 0x380000
    s_add_u32 m0, s20, 0x14000
    s_nop 0
    buffer_load_dwordx4 v3, s[4:7], s22 offen lds
    ds_read_b64_tr_b16 v[228:229], v5 offset:49184
    v_mfma_f32_16x16x32_bf16 v[132:135], v[236:239], v[44:47], v[132:135]
    ds_read_b64_tr_b16 v[230:231], v5 offset:50208
    s_waitcnt lgkmcnt(6)
    v_mfma_f32_16x16x32_bf16 v[136:139], v[240:243], v[40:43], v[136:139]
    ds_read_b64_tr_b16 v[232:233], v4 offset:49408
    v_mfma_f32_16x16x32_bf16 v[140:143], v[240:243], v[44:47], v[140:143]
    s_add_u32 s22, s24, 0x382000
    s_add_u32 m0, s20, 0x14400
    s_nop 0
    buffer_load_dwordx4 v3, s[4:7], s22 offen lds
    ds_read_b64_tr_b16 v[234:235], v4 offset:50432
    s_waitcnt lgkmcnt(6)
    v_mfma_f32_16x16x32_bf16 v[144:147], v[244:247], v[40:43], v[144:147]
    ds_read_b64_tr_b16 v[236:237], v5 offset:49440
    v_mfma_f32_16x16x32_bf16 v[148:151], v[244:247], v[44:47], v[148:151]
    ds_read_b64_tr_b16 v[238:239], v5 offset:50464
    s_waitcnt vmcnt(19) lgkmcnt(6)
    v_mfma_f32_16x16x32_bf16 v[88:91], v[224:227], v[48:51], v[88:91]
    ds_read_b64_tr_b16 v[240:241], v4 offset:49664
    s_waitcnt vmcnt(18)
    v_mfma_f32_16x16x32_bf16 v[92:95], v[224:227], v[52:55], v[92:95]
    ds_read_b64_tr_b16 v[242:243], v4 offset:50688
    s_waitcnt lgkmcnt(6)
    v_mfma_f32_16x16x32_bf16 v[96:99], v[228:231], v[48:51], v[96:99]
    ds_read_b64_tr_b16 v[244:245], v5 offset:49696
    s_mov_b32 s23, 0xe000
    buffer_load_dwordx4 v[40:43], v6, s[8:11], s23 offen offset:0 sc1
    v_mfma_f32_16x16x32_bf16 v[100:103], v[228:231], v[52:55], v[100:103]
    ds_read_b64_tr_b16 v[246:247], v5 offset:50720
    s_waitcnt lgkmcnt(6)
    v_mfma_f32_16x16x32_bf16 v[104:107], v[232:235], v[48:51], v[104:107]
    ds_read_b64_tr_b16 v[224:225], v4 offset:49920
    v_mfma_f32_16x16x32_bf16 v[108:111], v[232:235], v[52:55], v[108:111]
    ds_read_b64_tr_b16 v[226:227], v4 offset:50944
    s_mov_b32 s23, 0x2e000
    buffer_load_dwordx4 v[44:47], v6, s[8:11], s23 offen offset:0 sc1
    s_waitcnt lgkmcnt(6)
    v_mfma_f32_16x16x32_bf16 v[112:115], v[236:239], v[48:51], v[112:115]
    ds_read_b64_tr_b16 v[228:229], v5 offset:49952
    v_mfma_f32_16x16x32_bf16 v[116:119], v[236:239], v[52:55], v[116:119]
    ds_read_b64_tr_b16 v[230:231], v5 offset:50976
    s_waitcnt lgkmcnt(6)
    v_mfma_f32_16x16x32_bf16 v[120:123], v[240:243], v[48:51], v[120:123]
    v_mfma_f32_16x16x32_bf16 v[124:127], v[240:243], v[52:55], v[124:127]
    s_waitcnt vmcnt(15)
    s_barrier
    ds_read_b64_tr_b16 v[232:233], v7 offset:0
    ds_read_b64_tr_b16 v[234:235], v7 offset:1024
    s_waitcnt lgkmcnt(6)
    v_mfma_f32_16x16x32_bf16 v[128:131], v[244:247], v[48:51], v[128:131]
    s_add_u32 s22, s24, 0x10000
    s_add_u32 m0, s20, 0x18000
    s_nop 0
    buffer_load_dwordx4 v3, s[4:7], s22 offen lds
    ds_read_b64_tr_b16 v[236:237], v8 offset:32
    v_mfma_f32_16x16x32_bf16 v[132:135], v[244:247], v[52:55], v[132:135]
    ds_read_b64_tr_b16 v[238:239], v8 offset:1056
    s_waitcnt lgkmcnt(6)
    v_mfma_f32_16x16x32_bf16 v[136:139], v[224:227], v[48:51], v[136:139]
    ds_read_b64_tr_b16 v[240:241], v7 offset:256
    v_mfma_f32_16x16x32_bf16 v[140:143], v[224:227], v[52:55], v[140:143]
    s_add_u32 s22, s24, 0x12000
    s_add_u32 m0, s20, 0x18400
    s_nop 0
    buffer_load_dwordx4 v3, s[4:7], s22 offen lds
    ds_read_b64_tr_b16 v[242:243], v7 offset:1280
    s_waitcnt lgkmcnt(6)
    v_mfma_f32_16x16x32_bf16 v[144:147], v[228:231], v[48:51], v[144:147]
    ds_read_b64_tr_b16 v[244:245], v8 offset:288
    v_mfma_f32_16x16x32_bf16 v[148:151], v[228:231], v[52:55], v[148:151]
    ds_read_b64_tr_b16 v[246:247], v8 offset:1312
    s_waitcnt vmcnt(6)
    v_cmp_ne_u32 vcc, s28, v12
    s_cbranch_vccnz adaLN_cond__sliding_block_cached__moe_arch_mod__prompt_kernel_o27r
adaLN_cond__sliding_block_cached__moe_arch_mod__prompt_kernel_o27b:
    s_waitcnt lgkmcnt(6)
    v_mfma_f32_16x16x32_bf16 v[88:91], v[232:235], v[56:59], v[88:91]
    ds_read_b64_tr_b16 v[224:225], v7 offset:512
    v_mfma_f32_16x16x32_bf16 v[92:95], v[232:235], v[60:63], v[92:95]
    ds_read_b64_tr_b16 v[226:227], v7 offset:1536
    s_waitcnt lgkmcnt(6)
    v_mfma_f32_16x16x32_bf16 v[96:99], v[236:239], v[56:59], v[96:99]
    ds_read_b64_tr_b16 v[228:229], v8 offset:544
    s_mov_b32 s23, 0x0
    buffer_load_dwordx4 v[48:51], v6, s[8:11], s23 offen offset:1024 sc1
    v_mfma_f32_16x16x32_bf16 v[100:103], v[236:239], v[60:63], v[100:103]
    ds_read_b64_tr_b16 v[230:231], v8 offset:1568
    s_waitcnt lgkmcnt(6)
    v_mfma_f32_16x16x32_bf16 v[104:107], v[240:243], v[56:59], v[104:107]
    ds_read_b64_tr_b16 v[232:233], v7 offset:768
    v_mfma_f32_16x16x32_bf16 v[108:111], v[240:243], v[60:63], v[108:111]
    ds_read_b64_tr_b16 v[234:235], v7 offset:1792
    s_mov_b32 s23, 0x20000
    buffer_load_dwordx4 v[52:55], v6, s[8:11], s23 offen offset:1024 sc1
    s_waitcnt lgkmcnt(6)
    v_mfma_f32_16x16x32_bf16 v[112:115], v[244:247], v[56:59], v[112:115]
    ds_read_b64_tr_b16 v[236:237], v8 offset:800
    v_mfma_f32_16x16x32_bf16 v[116:119], v[244:247], v[60:63], v[116:119]
    ds_read_b64_tr_b16 v[238:239], v8 offset:1824
    s_waitcnt lgkmcnt(6)
    v_mfma_f32_16x16x32_bf16 v[120:123], v[224:227], v[56:59], v[120:123]
    v_mfma_f32_16x16x32_bf16 v[124:127], v[224:227], v[60:63], v[124:127]
    s_barrier
    ds_read_b64_tr_b16 v[240:241], v7 offset:16384
    ds_read_b64_tr_b16 v[242:243], v7 offset:17408
    s_waitcnt lgkmcnt(6)
    v_mfma_f32_16x16x32_bf16 v[128:131], v[228:231], v[56:59], v[128:131]
    s_add_u32 s22, s24, 0x90000
    s_add_u32 m0, s20, 0x1c000
    s_nop 0
    buffer_load_dwordx4 v3, s[4:7], s22 offen lds
    ds_read_b64_tr_b16 v[244:245], v8 offset:16416
    v_mfma_f32_16x16x32_bf16 v[132:135], v[228:231], v[60:63], v[132:135]
    ds_read_b64_tr_b16 v[246:247], v8 offset:17440
    s_waitcnt lgkmcnt(6)
    v_mfma_f32_16x16x32_bf16 v[136:139], v[232:235], v[56:59], v[136:139]
    ds_read_b64_tr_b16 v[224:225], v7 offset:16640
    v_mfma_f32_16x16x32_bf16 v[140:143], v[232:235], v[60:63], v[140:143]
    s_add_u32 s22, s24, 0x92000
    s_add_u32 m0, s20, 0x1c400
    s_nop 0
    buffer_load_dwordx4 v3, s[4:7], s22 offen lds
    ds_read_b64_tr_b16 v[226:227], v7 offset:17664
    s_waitcnt lgkmcnt(6)
    v_mfma_f32_16x16x32_bf16 v[144:147], v[236:239], v[56:59], v[144:147]
    ds_read_b64_tr_b16 v[228:229], v8 offset:16672
    v_mfma_f32_16x16x32_bf16 v[148:151], v[236:239], v[60:63], v[148:151]
    ds_read_b64_tr_b16 v[230:231], v8 offset:17696
    s_waitcnt lgkmcnt(6)
    v_mfma_f32_16x16x32_bf16 v[88:91], v[240:243], v[24:27], v[88:91]
    ds_read_b64_tr_b16 v[232:233], v7 offset:16896
    v_mfma_f32_16x16x32_bf16 v[92:95], v[240:243], v[28:31], v[92:95]
    ds_read_b64_tr_b16 v[234:235], v7 offset:17920
    s_waitcnt lgkmcnt(6)
    v_mfma_f32_16x16x32_bf16 v[96:99], v[244:247], v[24:27], v[96:99]
    ds_read_b64_tr_b16 v[236:237], v8 offset:16928
    s_mov_b32 s23, 0x2000
    buffer_load_dwordx4 v[56:59], v6, s[8:11], s23 offen offset:1024 sc1
    v_mfma_f32_16x16x32_bf16 v[100:103], v[244:247], v[28:31], v[100:103]
    ds_read_b64_tr_b16 v[238:239], v8 offset:17952
    s_waitcnt lgkmcnt(6)
    v_mfma_f32_16x16x32_bf16 v[104:107], v[224:227], v[24:27], v[104:107]
    ds_read_b64_tr_b16 v[240:241], v7 offset:17152
    v_mfma_f32_16x16x32_bf16 v[108:111], v[224:227], v[28:31], v[108:111]
    ds_read_b64_tr_b16 v[242:243], v7 offset:18176
    s_mov_b32 s23, 0x22000
    buffer_load_dwordx4 v[60:63], v6, s[8:11], s23 offen offset:1024 sc1
    s_waitcnt lgkmcnt(6)
    v_mfma_f32_16x16x32_bf16 v[112:115], v[228:231], v[24:27], v[112:115]
    ds_read_b64_tr_b16 v[244:245], v8 offset:17184
    v_mfma_f32_16x16x32_bf16 v[116:119], v[228:231], v[28:31], v[116:119]
    ds_read_b64_tr_b16 v[246:247], v8 offset:18208
    s_waitcnt lgkmcnt(6)
    v_mfma_f32_16x16x32_bf16 v[120:123], v[232:235], v[24:27], v[120:123]
    v_mfma_f32_16x16x32_bf16 v[124:127], v[232:235], v[28:31], v[124:127]
    s_barrier
    ds_read_b64_tr_b16 v[224:225], v4 offset:0
    ds_read_b64_tr_b16 v[226:227], v4 offset:1024
    s_waitcnt lgkmcnt(6)
    v_mfma_f32_16x16x32_bf16 v[128:131], v[236:239], v[24:27], v[128:131]
    s_add_u32 s16, s63, 0x576000
    v_mov_b32 v14, s28
    v_mov_b32 v15, 0
    s_mov_b64 exec, 1
    buffer_store_dword v14, v15, s[8:11], s16 offen sc1
    s_mov_b64 exec, -1
    s_add_u32 s22, s24, 0x110000
    s_add_u32 m0, s20, 0x20000
    s_nop 0
    buffer_load_dwordx4 v3, s[4:7], s22 offen lds
    ds_read_b64_tr_b16 v[228:229], v5 offset:32
    v_mfma_f32_16x16x32_bf16 v[132:135], v[236:239], v[28:31], v[132:135]
    ds_read_b64_tr_b16 v[230:231], v5 offset:1056
    s_waitcnt lgkmcnt(6)
    v_mfma_f32_16x16x32_bf16 v[136:139], v[240:243], v[24:27], v[136:139]
    ds_read_b64_tr_b16 v[232:233], v4 offset:256
    v_mfma_f32_16x16x32_bf16 v[140:143], v[240:243], v[28:31], v[140:143]
    s_add_u32 s22, s24, 0x112000
    s_add_u32 m0, s20, 0x20400
    s_nop 0
    buffer_load_dwordx4 v3, s[4:7], s22 offen lds
    ds_read_b64_tr_b16 v[234:235], v4 offset:1280
    s_waitcnt lgkmcnt(6)
    v_mfma_f32_16x16x32_bf16 v[144:147], v[244:247], v[24:27], v[144:147]
    ds_read_b64_tr_b16 v[236:237], v5 offset:288
    v_mfma_f32_16x16x32_bf16 v[148:151], v[244:247], v[28:31], v[148:151]
    ds_read_b64_tr_b16 v[238:239], v5 offset:1312
    s_waitcnt lgkmcnt(6)
    v_mfma_f32_16x16x32_bf16 v[88:91], v[224:227], v[32:35], v[88:91]
    ds_read_b64_tr_b16 v[240:241], v4 offset:512
    v_mfma_f32_16x16x32_bf16 v[92:95], v[224:227], v[36:39], v[92:95]
    ds_read_b64_tr_b16 v[242:243], v4 offset:1536
    s_waitcnt lgkmcnt(6)
    v_mfma_f32_16x16x32_bf16 v[96:99], v[228:231], v[32:35], v[96:99]
    ds_read_b64_tr_b16 v[244:245], v5 offset:544
    s_mov_b32 s23, 0x4000
    buffer_load_dwordx4 v[24:27], v6, s[8:11], s23 offen offset:1024 sc1
    v_mfma_f32_16x16x32_bf16 v[100:103], v[228:231], v[36:39], v[100:103]
    ds_read_b64_tr_b16 v[246:247], v5 offset:1568
    s_waitcnt lgkmcnt(6)
    v_mfma_f32_16x16x32_bf16 v[104:107], v[232:235], v[32:35], v[104:107]
    ds_read_b64_tr_b16 v[224:225], v4 offset:768
    v_mfma_f32_16x16x32_bf16 v[108:111], v[232:235], v[36:39], v[108:111]
    ds_read_b64_tr_b16 v[226:227], v4 offset:1792
    s_mov_b32 s23, 0x24000
    buffer_load_dwordx4 v[28:31], v6, s[8:11], s23 offen offset:1024 sc1
    s_waitcnt lgkmcnt(6)
    v_mfma_f32_16x16x32_bf16 v[112:115], v[236:239], v[32:35], v[112:115]
    ds_read_b64_tr_b16 v[228:229], v5 offset:800
    v_mfma_f32_16x16x32_bf16 v[116:119], v[236:239], v[36:39], v[116:119]
    ds_read_b64_tr_b16 v[230:231], v5 offset:1824
    s_waitcnt lgkmcnt(6)
    v_mfma_f32_16x16x32_bf16 v[120:123], v[240:243], v[32:35], v[120:123]
    v_mfma_f32_16x16x32_bf16 v[124:127], v[240:243], v[36:39], v[124:127]
    s_waitcnt vmcnt(15)
    s_barrier
    ds_read_b64_tr_b16 v[232:233], v4 offset:16384
    ds_read_b64_tr_b16 v[234:235], v4 offset:17408
    s_waitcnt lgkmcnt(6)
    v_mfma_f32_16x16x32_bf16 v[128:131], v[244:247], v[32:35], v[128:131]
    s_add_u32 s22, s24, 0x190000
    s_add_u32 m0, s20, 0x24000
    s_nop 0
    buffer_load_dwordx4 v3, s[4:7], s22 offen lds
    ds_read_b64_tr_b16 v[236:237], v5 offset:16416
    v_mfma_f32_16x16x32_bf16 v[132:135], v[244:247], v[36:39], v[132:135]
    ds_read_b64_tr_b16 v[238:239], v5 offset:17440
    s_waitcnt lgkmcnt(6)
    v_mfma_f32_16x16x32_bf16 v[136:139], v[224:227], v[32:35], v[136:139]
    ds_read_b64_tr_b16 v[240:241], v4 offset:16640
    v_mfma_f32_16x16x32_bf16 v[140:143], v[224:227], v[36:39], v[140:143]
    s_add_u32 s22, s24, 0x192000
    s_add_u32 m0, s20, 0x24400
    s_nop 0
    buffer_load_dwordx4 v3, s[4:7], s22 offen lds
    ds_read_b64_tr_b16 v[242:243], v4 offset:17664
    s_waitcnt lgkmcnt(6)
    v_mfma_f32_16x16x32_bf16 v[144:147], v[228:231], v[32:35], v[144:147]
    ds_read_b64_tr_b16 v[244:245], v5 offset:16672
    v_mfma_f32_16x16x32_bf16 v[148:151], v[228:231], v[36:39], v[148:151]
    ds_read_b64_tr_b16 v[246:247], v5 offset:17696
    s_waitcnt vmcnt(16) lgkmcnt(6)
    v_mfma_f32_16x16x32_bf16 v[88:91], v[232:235], v[40:43], v[88:91]
    ds_read_b64_tr_b16 v[224:225], v4 offset:16896
    s_waitcnt vmcnt(15)
    v_mfma_f32_16x16x32_bf16 v[92:95], v[232:235], v[44:47], v[92:95]
    ds_read_b64_tr_b16 v[226:227], v4 offset:17920
    s_waitcnt lgkmcnt(6)
    v_mfma_f32_16x16x32_bf16 v[96:99], v[236:239], v[40:43], v[96:99]
    ds_read_b64_tr_b16 v[228:229], v5 offset:16928
    s_mov_b32 s23, 0x6000
    buffer_load_dwordx4 v[32:35], v6, s[8:11], s23 offen offset:1024 sc1
    v_mfma_f32_16x16x32_bf16 v[100:103], v[236:239], v[44:47], v[100:103]
    ds_read_b64_tr_b16 v[230:231], v5 offset:17952
    s_waitcnt lgkmcnt(6)
    v_mfma_f32_16x16x32_bf16 v[104:107], v[240:243], v[40:43], v[104:107]
    ds_read_b64_tr_b16 v[232:233], v4 offset:17152
    v_mfma_f32_16x16x32_bf16 v[108:111], v[240:243], v[44:47], v[108:111]
    ds_read_b64_tr_b16 v[234:235], v4 offset:18176
    s_mov_b32 s23, 0x26000
    buffer_load_dwordx4 v[36:39], v6, s[8:11], s23 offen offset:1024 sc1
    s_waitcnt lgkmcnt(6)
    v_mfma_f32_16x16x32_bf16 v[112:115], v[244:247], v[40:43], v[112:115]
    ds_read_b64_tr_b16 v[236:237], v5 offset:17184
    v_mfma_f32_16x16x32_bf16 v[116:119], v[244:247], v[44:47], v[116:119]
    ds_read_b64_tr_b16 v[238:239], v5 offset:18208
    s_waitcnt lgkmcnt(6)
    v_mfma_f32_16x16x32_bf16 v[120:123], v[224:227], v[40:43], v[120:123]
    v_mfma_f32_16x16x32_bf16 v[124:127], v[224:227], v[44:47], v[124:127]
    s_waitcnt vmcnt(15)
    s_barrier
    ds_read_b64_tr_b16 v[240:241], v4 offset:32768
    ds_read_b64_tr_b16 v[242:243], v4 offset:33792
    s_waitcnt lgkmcnt(6)
    v_mfma_f32_16x16x32_bf16 v[128:131], v[228:231], v[40:43], v[128:131]
    s_add_u32 s22, s24, 0x210000
    s_add_u32 m0, s20, 0x10000
    s_nop 0
    buffer_load_dwordx4 v3, s[4:7], s22 offen lds
    ds_read_b64_tr_b16 v[244:245], v5 offset:32800
    v_mfma_f32_16x16x32_bf16 v[132:135], v[228:231], v[44:47], v[132:135]
    ds_read_b64_tr_b16 v[246:247], v5 offset:33824
    s_waitcnt lgkmcnt(6)
    v_mfma_f32_16x16x32_bf16 v[136:139], v[232:235], v[40:43], v[136:139]
    ds_read_b64_tr_b16 v[224:225], v4 offset:33024
    v_mfma_f32_16x16x32_bf16 v[140:143], v[232:235], v[44:47], v[140:143]
    s_add_u32 s22, s24, 0x212000
    s_add_u32 m0, s20, 0x10400
    s_nop 0
    buffer_load_dwordx4 v3, s[4:7], s22 offen lds
    ds_read_b64_tr_b16 v[226:227], v4 offset:34048
    s_waitcnt lgkmcnt(6)
    v_mfma_f32_16x16x32_bf16 v[144:147], v[236:239], v[40:43], v[144:147]
    ds_read_b64_tr_b16 v[228:229], v5 offset:33056
    v_mfma_f32_16x16x32_bf16 v[148:151], v[236:239], v[44:47], v[148:151]
    ds_read_b64_tr_b16 v[230:231], v5 offset:34080
    s_waitcnt vmcnt(16) lgkmcnt(6)
    v_mfma_f32_16x16x32_bf16 v[88:91], v[240:243], v[48:51], v[88:91]
    ds_read_b64_tr_b16 v[232:233], v4 offset:33280
    s_waitcnt vmcnt(15)
    v_mfma_f32_16x16x32_bf16 v[92:95], v[240:243], v[52:55], v[92:95]
    ds_read_b64_tr_b16 v[234:235], v4 offset:34304
    s_waitcnt lgkmcnt(6)
    v_mfma_f32_16x16x32_bf16 v[96:99], v[244:247], v[48:51], v[96:99]
    ds_read_b64_tr_b16 v[236:237], v5 offset:33312
    s_mov_b32 s23, 0x8000
    buffer_load_dwordx4 v[40:43], v6, s[8:11], s23 offen offset:1024 sc1
    v_mfma_f32_16x16x32_bf16 v[100:103], v[244:247], v[52:55], v[100:103]
    ds_read_b64_tr_b16 v[238:239], v5 offset:34336
    s_waitcnt lgkmcnt(6)
    v_mfma_f32_16x16x32_bf16 v[104:107], v[224:227], v[48:51], v[104:107]
    ds_read_b64_tr_b16 v[240:241], v4 offset:33536
    v_mfma_f32_16x16x32_bf16 v[108:111], v[224:227], v[52:55], v[108:111]
    ds_read_b64_tr_b16 v[242:243], v4 offset:34560
    s_mov_b32 s23, 0x28000
    buffer_load_dwordx4 v[44:47], v6, s[8:11], s23 offen offset:1024 sc1
    s_waitcnt lgkmcnt(6)
    v_mfma_f32_16x16x32_bf16 v[112:115], v[228:231], v[48:51], v[112:115]
    ds_read_b64_tr_b16 v[244:245], v5 offset:33568
    v_mfma_f32_16x16x32_bf16 v[116:119], v[228:231], v[52:55], v[116:119]
    ds_read_b64_tr_b16 v[246:247], v5 offset:34592
    s_waitcnt lgkmcnt(6)
    v_mfma_f32_16x16x32_bf16 v[120:123], v[232:235], v[48:51], v[120:123]
    v_mfma_f32_16x16x32_bf16 v[124:127], v[232:235], v[52:55], v[124:127]
    s_waitcnt vmcnt(15)
    s_barrier
    ds_read_b64_tr_b16 v[224:225], v4 offset:49152
    ds_read_b64_tr_b16 v[226:227], v4 offset:50176
    s_waitcnt lgkmcnt(6)
    v_mfma_f32_16x16x32_bf16 v[128:131], v[236:239], v[48:51], v[128:131]
    s_add_u32 s22, s24, 0x290000
    s_add_u32 m0, s20, 0x14000
    s_nop 0
    buffer_load_dwordx4 v3, s[4:7], s22 offen lds
    ds_read_b64_tr_b16 v[228:229], v5 offset:49184
    v_mfma_f32_16x16x32_bf16 v[132:135], v[236:239], v[52:55], v[132:135]
    ds_read_b64_tr_b16 v[230:231], v5 offset:50208
    s_waitcnt lgkmcnt(6)
    v_mfma_f32_16x16x32_bf16 v[136:139], v[240:243], v[48:51], v[136:139]
    ds_read_b64_tr_b16 v[232:233], v4 offset:49408
    v_mfma_f32_16x16x32_bf16 v[140:143], v[240:243], v[52:55], v[140:143]
    s_add_u32 s22, s24, 0x292000
    s_add_u32 m0, s20, 0x14400
    s_nop 0
    buffer_load_dwordx4 v3, s[4:7], s22 offen lds
    ds_read_b64_tr_b16 v[234:235], v4 offset:50432
    s_waitcnt lgkmcnt(6)
    v_mfma_f32_16x16x32_bf16 v[144:147], v[244:247], v[48:51], v[144:147]
    ds_read_b64_tr_b16 v[236:237], v5 offset:49440
    v_mfma_f32_16x16x32_bf16 v[148:151], v[244:247], v[52:55], v[148:151]
    ds_read_b64_tr_b16 v[238:239], v5 offset:50464
    s_waitcnt vmcnt(16) lgkmcnt(6)
    v_mfma_f32_16x16x32_bf16 v[88:91], v[224:227], v[56:59], v[88:91]
    ds_read_b64_tr_b16 v[240:241], v4 offset:49664
    s_waitcnt vmcnt(15)
    v_mfma_f32_16x16x32_bf16 v[92:95], v[224:227], v[60:63], v[92:95]
    ds_read_b64_tr_b16 v[242:243], v4 offset:50688
    s_waitcnt lgkmcnt(6)
    v_mfma_f32_16x16x32_bf16 v[96:99], v[228:231], v[56:59], v[96:99]
    ds_read_b64_tr_b16 v[244:245], v5 offset:49696
    s_mov_b32 s23, 0xa000
    buffer_load_dwordx4 v[48:51], v6, s[8:11], s23 offen offset:1024 sc1
    v_mfma_f32_16x16x32_bf16 v[100:103], v[228:231], v[60:63], v[100:103]
    ds_read_b64_tr_b16 v[246:247], v5 offset:50720
    s_waitcnt lgkmcnt(6)
    v_mfma_f32_16x16x32_bf16 v[104:107], v[232:235], v[56:59], v[104:107]
    ds_read_b64_tr_b16 v[224:225], v4 offset:49920
    v_mfma_f32_16x16x32_bf16 v[108:111], v[232:235], v[60:63], v[108:111]
    ds_read_b64_tr_b16 v[226:227], v4 offset:50944
    s_mov_b32 s23, 0x2a000
    buffer_load_dwordx4 v[52:55], v6, s[8:11], s23 offen offset:1024 sc1
    s_waitcnt lgkmcnt(6)
    v_mfma_f32_16x16x32_bf16 v[112:115], v[236:239], v[56:59], v[112:115]
    ds_read_b64_tr_b16 v[228:229], v5 offset:49952
    v_mfma_f32_16x16x32_bf16 v[116:119], v[236:239], v[60:63], v[116:119]
    ds_read_b64_tr_b16 v[230:231], v5 offset:50976
    s_waitcnt lgkmcnt(6)
    v_mfma_f32_16x16x32_bf16 v[120:123], v[240:243], v[56:59], v[120:123]
    v_mfma_f32_16x16x32_bf16 v[124:127], v[240:243], v[60:63], v[124:127]
    s_waitcnt vmcnt(14)
    s_barrier
    ds_read_b64_tr_b16 v[232:233], v7 offset:0
    ds_read_b64_tr_b16 v[234:235], v7 offset:1024
    s_waitcnt lgkmcnt(6)
    v_mfma_f32_16x16x32_bf16 v[128:131], v[244:247], v[56:59], v[128:131]
    s_add_u32 s22, s24, 0x310000
    s_add_u32 m0, s20, 0x18000
    s_nop 0
    buffer_load_dwordx4 v3, s[4:7], s22 offen lds
    ds_read_b64_tr_b16 v[236:237], v8 offset:32
    v_mfma_f32_16x16x32_bf16 v[132:135], v[244:247], v[60:63], v[132:135]
    ds_read_b64_tr_b16 v[238:239], v8 offset:1056
    s_waitcnt lgkmcnt(6)
    v_mfma_f32_16x16x32_bf16 v[136:139], v[224:227], v[56:59], v[136:139]
    ds_read_b64_tr_b16 v[240:241], v7 offset:256
    v_mfma_f32_16x16x32_bf16 v[140:143], v[224:227], v[60:63], v[140:143]
    s_add_u32 s22, s24, 0x312000
    s_add_u32 m0, s20, 0x18400
    s_nop 0
    buffer_load_dwordx4 v3, s[4:7], s22 offen lds
    ds_read_b64_tr_b16 v[242:243], v7 offset:1280
    s_waitcnt lgkmcnt(6)
    v_mfma_f32_16x16x32_bf16 v[144:147], v[228:231], v[56:59], v[144:147]
    ds_read_b64_tr_b16 v[244:245], v8 offset:288
    v_mfma_f32_16x16x32_bf16 v[148:151], v[228:231], v[60:63], v[148:151]
    ds_read_b64_tr_b16 v[246:247], v8 offset:1312
    s_waitcnt vmcnt(15) lgkmcnt(6)
    v_mfma_f32_16x16x32_bf16 v[88:91], v[232:235], v[24:27], v[88:91]
    ds_read_b64_tr_b16 v[224:225], v7 offset:512
    s_waitcnt vmcnt(14)
    v_mfma_f32_16x16x32_bf16 v[92:95], v[232:235], v[28:31], v[92:95]
    ds_read_b64_tr_b16 v[226:227], v7 offset:1536
    s_waitcnt lgkmcnt(6)
    v_mfma_f32_16x16x32_bf16 v[96:99], v[236:239], v[24:27], v[96:99]
    ds_read_b64_tr_b16 v[228:229], v8 offset:544
    s_mov_b32 s23, 0xc000
    buffer_load_dwordx4 v[56:59], v6, s[8:11], s23 offen offset:1024 sc1
    v_mfma_f32_16x16x32_bf16 v[100:103], v[236:239], v[28:31], v[100:103]
    ds_read_b64_tr_b16 v[230:231], v8 offset:1568
    s_waitcnt lgkmcnt(6)
    v_mfma_f32_16x16x32_bf16 v[104:107], v[240:243], v[24:27], v[104:107]
    ds_read_b64_tr_b16 v[232:233], v7 offset:768
    v_mfma_f32_16x16x32_bf16 v[108:111], v[240:243], v[28:31], v[108:111]
    ds_read_b64_tr_b16 v[234:235], v7 offset:1792
    s_mov_b32 s23, 0x2c000
    buffer_load_dwordx4 v[60:63], v6, s[8:11], s23 offen offset:1024 sc1
    s_waitcnt lgkmcnt(6)
    v_mfma_f32_16x16x32_bf16 v[112:115], v[244:247], v[24:27], v[112:115]
    ds_read_b64_tr_b16 v[236:237], v8 offset:800
    v_mfma_f32_16x16x32_bf16 v[116:119], v[244:247], v[28:31], v[116:119]
    ds_read_b64_tr_b16 v[238:239], v8 offset:1824
    s_waitcnt lgkmcnt(6)
    v_mfma_f32_16x16x32_bf16 v[120:123], v[224:227], v[24:27], v[120:123]
    v_mfma_f32_16x16x32_bf16 v[124:127], v[224:227], v[28:31], v[124:127]
    s_waitcnt vmcnt(14)
    s_barrier
    ds_read_b64_tr_b16 v[240:241], v7 offset:16384
    ds_read_b64_tr_b16 v[242:243], v7 offset:17408
    s_add_u32 s19, s19, 8192
    buffer_load_dword v12, v13, s[8:11], s19 offen sc1
    s_waitcnt lgkmcnt(6)
    v_mfma_f32_16x16x32_bf16 v[128:131], v[228:231], v[24:27], v[128:131]
    s_add_u32 s22, s24, 0x390000
    s_add_u32 m0, s20, 0x1c000
    s_nop 0
    buffer_load_dwordx4 v3, s[4:7], s22 offen lds
    ds_read_b64_tr_b16 v[244:245], v8 offset:16416
    v_mfma_f32_16x16x32_bf16 v[132:135], v[228:231], v[28:31], v[132:135]
    ds_read_b64_tr_b16 v[246:247], v8 offset:17440
    s_waitcnt lgkmcnt(6)
    v_mfma_f32_16x16x32_bf16 v[136:139], v[232:235], v[24:27], v[136:139]
    ds_read_b64_tr_b16 v[224:225], v7 offset:16640
    v_mfma_f32_16x16x32_bf16 v[140:143], v[232:235], v[28:31], v[140:143]
    s_add_u32 s22, s24, 0x392000
    s_add_u32 m0, s20, 0x1c400
    s_nop 0
    buffer_load_dwordx4 v3, s[4:7], s22 offen lds
    ds_read_b64_tr_b16 v[226:227], v7 offset:17664
    s_waitcnt lgkmcnt(6)
    v_mfma_f32_16x16x32_bf16 v[144:147], v[236:239], v[24:27], v[144:147]
    ds_read_b64_tr_b16 v[228:229], v8 offset:16672
    v_mfma_f32_16x16x32_bf16 v[148:151], v[236:239], v[28:31], v[148:151]
    ds_read_b64_tr_b16 v[230:231], v8 offset:17696
    s_waitcnt vmcnt(16) lgkmcnt(6)
    v_mfma_f32_16x16x32_bf16 v[88:91], v[240:243], v[32:35], v[88:91]
    ds_read_b64_tr_b16 v[232:233], v7 offset:16896
    s_waitcnt vmcnt(15)
    v_mfma_f32_16x16x32_bf16 v[92:95], v[240:243], v[36:39], v[92:95]
    ds_read_b64_tr_b16 v[234:235], v7 offset:17920
    s_waitcnt lgkmcnt(6)
    v_mfma_f32_16x16x32_bf16 v[96:99], v[244:247], v[32:35], v[96:99]
    ds_read_b64_tr_b16 v[236:237], v8 offset:16928
    s_mov_b32 s23, 0xe000
    buffer_load_dwordx4 v[24:27], v6, s[8:11], s23 offen offset:1024 sc1
    v_mfma_f32_16x16x32_bf16 v[100:103], v[244:247], v[36:39], v[100:103]
    ds_read_b64_tr_b16 v[238:239], v8 offset:17952
    s_waitcnt lgkmcnt(6)
    v_mfma_f32_16x16x32_bf16 v[104:107], v[224:227], v[32:35], v[104:107]
    ds_read_b64_tr_b16 v[240:241], v7 offset:17152
    v_mfma_f32_16x16x32_bf16 v[108:111], v[224:227], v[36:39], v[108:111]
    ds_read_b64_tr_b16 v[242:243], v7 offset:18176
    s_mov_b32 s23, 0x2e000
    buffer_load_dwordx4 v[28:31], v6, s[8:11], s23 offen offset:1024 sc1
    s_waitcnt lgkmcnt(6)
    v_mfma_f32_16x16x32_bf16 v[112:115], v[228:231], v[32:35], v[112:115]
    ds_read_b64_tr_b16 v[244:245], v8 offset:17184
    v_mfma_f32_16x16x32_bf16 v[116:119], v[228:231], v[36:39], v[116:119]
    ds_read_b64_tr_b16 v[246:247], v8 offset:18208
    s_waitcnt lgkmcnt(6)
    v_mfma_f32_16x16x32_bf16 v[120:123], v[232:235], v[32:35], v[120:123]
    v_mfma_f32_16x16x32_bf16 v[124:127], v[232:235], v[36:39], v[124:127]
    s_waitcnt vmcnt(15)
    s_barrier
    ds_read_b64_tr_b16 v[224:225], v4 offset:0
    ds_read_b64_tr_b16 v[226:227], v4 offset:1024
    s_waitcnt lgkmcnt(6)
    v_mfma_f32_16x16x32_bf16 v[128:131], v[236:239], v[32:35], v[128:131]
    s_add_u32 s22, s24, 0x20000
    s_add_u32 m0, s20, 0x20000
    s_nop 0
    buffer_load_dwordx4 v3, s[4:7], s22 offen lds
    ds_read_b64_tr_b16 v[228:229], v5 offset:32
    v_mfma_f32_16x16x32_bf16 v[132:135], v[236:239], v[36:39], v[132:135]
    ds_read_b64_tr_b16 v[230:231], v5 offset:1056
    s_waitcnt lgkmcnt(6)
    v_mfma_f32_16x16x32_bf16 v[136:139], v[240:243], v[32:35], v[136:139]
    ds_read_b64_tr_b16 v[232:233], v4 offset:256
    v_mfma_f32_16x16x32_bf16 v[140:143], v[240:243], v[36:39], v[140:143]
    s_add_u32 s22, s24, 0x22000
    s_add_u32 m0, s20, 0x20400
    s_nop 0
    buffer_load_dwordx4 v3, s[4:7], s22 offen lds
    ds_read_b64_tr_b16 v[234:235], v4 offset:1280
    s_waitcnt lgkmcnt(6)
    v_mfma_f32_16x16x32_bf16 v[144:147], v[244:247], v[32:35], v[144:147]
    ds_read_b64_tr_b16 v[236:237], v5 offset:288
    v_mfma_f32_16x16x32_bf16 v[148:151], v[244:247], v[36:39], v[148:151]
    ds_read_b64_tr_b16 v[238:239], v5 offset:1312
    s_waitcnt vmcnt(6)
    v_cmp_ne_u32 vcc, s28, v12
    s_cbranch_vccnz adaLN_cond__sliding_block_cached__moe_arch_mod__prompt_kernel_o28r
adaLN_cond__sliding_block_cached__moe_arch_mod__prompt_kernel_o28b:
    s_waitcnt lgkmcnt(6)
    v_mfma_f32_16x16x32_bf16 v[88:91], v[224:227], v[40:43], v[88:91]
    ds_read_b64_tr_b16 v[240:241], v4 offset:512
    v_mfma_f32_16x16x32_bf16 v[92:95], v[224:227], v[44:47], v[92:95]
    ds_read_b64_tr_b16 v[242:243], v4 offset:1536
    s_waitcnt lgkmcnt(6)
    v_mfma_f32_16x16x32_bf16 v[96:99], v[228:231], v[40:43], v[96:99]
    ds_read_b64_tr_b16 v[244:245], v5 offset:544
    s_mov_b32 s23, 0x0
    buffer_load_dwordx4 v[32:35], v6, s[8:11], s23 offen offset:2048 sc1
    v_mfma_f32_16x16x32_bf16 v[100:103], v[228:231], v[44:47], v[100:103]
    ds_read_b64_tr_b16 v[246:247], v5 offset:1568
    s_waitcnt lgkmcnt(6)
    v_mfma_f32_16x16x32_bf16 v[104:107], v[232:235], v[40:43], v[104:107]
    ds_read_b64_tr_b16 v[224:225], v4 offset:768
    v_mfma_f32_16x16x32_bf16 v[108:111], v[232:235], v[44:47], v[108:111]
    ds_read_b64_tr_b16 v[226:227], v4 offset:1792
    s_mov_b32 s23, 0x20000
    buffer_load_dwordx4 v[36:39], v6, s[8:11], s23 offen offset:2048 sc1
    s_waitcnt lgkmcnt(6)
    v_mfma_f32_16x16x32_bf16 v[112:115], v[236:239], v[40:43], v[112:115]
    ds_read_b64_tr_b16 v[228:229], v5 offset:800
    v_mfma_f32_16x16x32_bf16 v[116:119], v[236:239], v[44:47], v[116:119]
    ds_read_b64_tr_b16 v[230:231], v5 offset:1824
    s_waitcnt lgkmcnt(6)
    v_mfma_f32_16x16x32_bf16 v[120:123], v[240:243], v[40:43], v[120:123]
    v_mfma_f32_16x16x32_bf16 v[124:127], v[240:243], v[44:47], v[124:127]
    s_barrier
    ds_read_b64_tr_b16 v[232:233], v4 offset:16384
    ds_read_b64_tr_b16 v[234:235], v4 offset:17408
    s_waitcnt lgkmcnt(6)
    v_mfma_f32_16x16x32_bf16 v[128:131], v[244:247], v[40:43], v[128:131]
    s_add_u32 s22, s24, 0xa0000
    s_add_u32 m0, s20, 0x24000
    s_nop 0
    buffer_load_dwordx4 v3, s[4:7], s22 offen lds
    ds_read_b64_tr_b16 v[236:237], v5 offset:16416
    v_mfma_f32_16x16x32_bf16 v[132:135], v[244:247], v[44:47], v[132:135]
    ds_read_b64_tr_b16 v[238:239], v5 offset:17440
    s_waitcnt lgkmcnt(6)
    v_mfma_f32_16x16x32_bf16 v[136:139], v[224:227], v[40:43], v[136:139]
    ds_read_b64_tr_b16 v[240:241], v4 offset:16640
    v_mfma_f32_16x16x32_bf16 v[140:143], v[224:227], v[44:47], v[140:143]
    s_add_u32 s22, s24, 0xa2000
    s_add_u32 m0, s20, 0x24400
    s_nop 0
    buffer_load_dwordx4 v3, s[4:7], s22 offen lds
    ds_read_b64_tr_b16 v[242:243], v4 offset:17664
    s_waitcnt lgkmcnt(6)
    v_mfma_f32_16x16x32_bf16 v[144:147], v[228:231], v[40:43], v[144:147]
    ds_read_b64_tr_b16 v[244:245], v5 offset:16672
    v_mfma_f32_16x16x32_bf16 v[148:151], v[228:231], v[44:47], v[148:151]
    ds_read_b64_tr_b16 v[246:247], v5 offset:17696
    s_waitcnt lgkmcnt(6)
    v_mfma_f32_16x16x32_bf16 v[88:91], v[232:235], v[48:51], v[88:91]
    ds_read_b64_tr_b16 v[224:225], v4 offset:16896
    v_mfma_f32_16x16x32_bf16 v[92:95], v[232:235], v[52:55], v[92:95]
    ds_read_b64_tr_b16 v[226:227], v4 offset:17920
    s_waitcnt lgkmcnt(6)
    v_mfma_f32_16x16x32_bf16 v[96:99], v[236:239], v[48:51], v[96:99]
    ds_read_b64_tr_b16 v[228:229], v5 offset:16928
    s_mov_b32 s23, 0x2000
    buffer_load_dwordx4 v[40:43], v6, s[8:11], s23 offen offset:2048 sc1
    v_mfma_f32_16x16x32_bf16 v[100:103], v[236:239], v[52:55], v[100:103]
    ds_read_b64_tr_b16 v[230:231], v5 offset:17952
    s_waitcnt lgkmcnt(6)
    v_mfma_f32_16x16x32_bf16 v[104:107], v[240:243], v[48:51], v[104:107]
    ds_read_b64_tr_b16 v[232:233], v4 offset:17152
    v_mfma_f32_16x16x32_bf16 v[108:111], v[240:243], v[52:55], v[108:111]
    ds_read_b64_tr_b16 v[234:235], v4 offset:18176
    s_mov_b32 s23, 0x22000
    buffer_load_dwordx4 v[44:47], v6, s[8:11], s23 offen offset:2048 sc1
    s_waitcnt lgkmcnt(6)
    v_mfma_f32_16x16x32_bf16 v[112:115], v[244:247], v[48:51], v[112:115]
    ds_read_b64_tr_b16 v[236:237], v5 offset:17184
    v_mfma_f32_16x16x32_bf16 v[116:119], v[244:247], v[52:55], v[116:119]
    ds_read_b64_tr_b16 v[238:239], v5 offset:18208
    s_waitcnt lgkmcnt(6)
    v_mfma_f32_16x16x32_bf16 v[120:123], v[224:227], v[48:51], v[120:123]
    v_mfma_f32_16x16x32_bf16 v[124:127], v[224:227], v[52:55], v[124:127]
    s_barrier
    ds_read_b64_tr_b16 v[240:241], v4 offset:32768
    ds_read_b64_tr_b16 v[242:243], v4 offset:33792
    s_waitcnt lgkmcnt(6)
    v_mfma_f32_16x16x32_bf16 v[128:131], v[228:231], v[48:51], v[128:131]
    s_add_u32 s22, s24, 0x120000
    s_add_u32 m0, s20, 0x10000
    s_nop 0
    buffer_load_dwordx4 v3, s[4:7], s22 offen lds
    ds_read_b64_tr_b16 v[244:245], v5 offset:32800
    v_mfma_f32_16x16x32_bf16 v[132:135], v[228:231], v[52:55], v[132:135]
    ds_read_b64_tr_b16 v[246:247], v5 offset:33824
    s_waitcnt lgkmcnt(6)
    v_mfma_f32_16x16x32_bf16 v[136:139], v[232:235], v[48:51], v[136:139]
    ds_read_b64_tr_b16 v[224:225], v4 offset:33024
    v_mfma_f32_16x16x32_bf16 v[140:143], v[232:235], v[52:55], v[140:143]
    s_add_u32 s22, s24, 0x122000
    s_add_u32 m0, s20, 0x10400
    s_nop 0
    buffer_load_dwordx4 v3, s[4:7], s22 offen lds
    ds_read_b64_tr_b16 v[226:227], v4 offset:34048
    s_waitcnt lgkmcnt(6)
    v_mfma_f32_16x16x32_bf16 v[144:147], v[236:239], v[48:51], v[144:147]
    ds_read_b64_tr_b16 v[228:229], v5 offset:33056
    v_mfma_f32_16x16x32_bf16 v[148:151], v[236:239], v[52:55], v[148:151]
    ds_read_b64_tr_b16 v[230:231], v5 offset:34080
    s_waitcnt lgkmcnt(6)
    v_mfma_f32_16x16x32_bf16 v[88:91], v[240:243], v[56:59], v[88:91]
    ds_read_b64_tr_b16 v[232:233], v4 offset:33280
    v_mfma_f32_16x16x32_bf16 v[92:95], v[240:243], v[60:63], v[92:95]
    ds_read_b64_tr_b16 v[234:235], v4 offset:34304
    s_waitcnt lgkmcnt(6)
    v_mfma_f32_16x16x32_bf16 v[96:99], v[244:247], v[56:59], v[96:99]
    ds_read_b64_tr_b16 v[236:237], v5 offset:33312
    s_mov_b32 s23, 0x4000
    buffer_load_dwordx4 v[48:51], v6, s[8:11], s23 offen offset:2048 sc1
    v_mfma_f32_16x16x32_bf16 v[100:103], v[244:247], v[60:63], v[100:103]
    ds_read_b64_tr_b16 v[238:239], v5 offset:34336
    s_waitcnt lgkmcnt(6)
    v_mfma_f32_16x16x32_bf16 v[104:107], v[224:227], v[56:59], v[104:107]
    ds_read_b64_tr_b16 v[240:241], v4 offset:33536
    v_mfma_f32_16x16x32_bf16 v[108:111], v[224:227], v[60:63], v[108:111]
    ds_read_b64_tr_b16 v[242:243], v4 offset:34560
    s_mov_b32 s23, 0x24000
    buffer_load_dwordx4 v[52:55], v6, s[8:11], s23 offen offset:2048 sc1
    s_waitcnt lgkmcnt(6)
    v_mfma_f32_16x16x32_bf16 v[112:115], v[228:231], v[56:59], v[112:115]
    ds_read_b64_tr_b16 v[244:245], v5 offset:33568
    v_mfma_f32_16x16x32_bf16 v[116:119], v[228:231], v[60:63], v[116:119]
    ds_read_b64_tr_b16 v[246:247], v5 offset:34592
    s_waitcnt lgkmcnt(6)
    v_mfma_f32_16x16x32_bf16 v[120:123], v[232:235], v[56:59], v[120:123]
    v_mfma_f32_16x16x32_bf16 v[124:127], v[232:235], v[60:63], v[124:127]
    s_waitcnt vmcnt(14)
    s_barrier
    ds_read_b64_tr_b16 v[224:225], v4 offset:49152
    ds_read_b64_tr_b16 v[226:227], v4 offset:50176
    s_waitcnt lgkmcnt(6)
    v_mfma_f32_16x16x32_bf16 v[128:131], v[236:239], v[56:59], v[128:131]
    s_add_u32 s22, s24, 0x1a0000
    s_add_u32 m0, s20, 0x14000
    s_nop 0
    buffer_load_dwordx4 v3, s[4:7], s22 offen lds
    ds_read_b64_tr_b16 v[228:229], v5 offset:49184
    v_mfma_f32_16x16x32_bf16 v[132:135], v[236:239], v[60:63], v[132:135]
    ds_read_b64_tr_b16 v[230:231], v5 offset:50208
    s_waitcnt lgkmcnt(6)
    v_mfma_f32_16x16x32_bf16 v[136:139], v[240:243], v[56:59], v[136:139]
    ds_read_b64_tr_b16 v[232:233], v4 offset:49408
    v_mfma_f32_16x16x32_bf16 v[140:143], v[240:243], v[60:63], v[140:143]
    s_add_u32 s22, s24, 0x1a2000
    s_add_u32 m0, s20, 0x14400
    s_nop 0
    buffer_load_dwordx4 v3, s[4:7], s22 offen lds
    ds_read_b64_tr_b16 v[234:235], v4 offset:50432
    s_waitcnt lgkmcnt(6)
    v_mfma_f32_16x16x32_bf16 v[144:147], v[244:247], v[56:59], v[144:147]
    ds_read_b64_tr_b16 v[236:237], v5 offset:49440
    v_mfma_f32_16x16x32_bf16 v[148:151], v[244:247], v[60:63], v[148:151]
    ds_read_b64_tr_b16 v[238:239], v5 offset:50464
    s_waitcnt vmcnt(15) lgkmcnt(6)
    v_mfma_f32_16x16x32_bf16 v[88:91], v[224:227], v[24:27], v[88:91]
    ds_read_b64_tr_b16 v[240:241], v4 offset:49664
    s_waitcnt vmcnt(14)
    v_mfma_f32_16x16x32_bf16 v[92:95], v[224:227], v[28:31], v[92:95]
    ds_read_b64_tr_b16 v[242:243], v4 offset:50688
    s_waitcnt lgkmcnt(6)
    v_mfma_f32_16x16x32_bf16 v[96:99], v[228:231], v[24:27], v[96:99]
    ds_read_b64_tr_b16 v[244:245], v5 offset:49696
    s_mov_b32 s23, 0x6000
    buffer_load_dwordx4 v[56:59], v6, s[8:11], s23 offen offset:2048 sc1
    v_mfma_f32_16x16x32_bf16 v[100:103], v[228:231], v[28:31], v[100:103]
    ds_read_b64_tr_b16 v[246:247], v5 offset:50720
    s_waitcnt lgkmcnt(6)
    v_mfma_f32_16x16x32_bf16 v[104:107], v[232:235], v[24:27], v[104:107]
    ds_read_b64_tr_b16 v[224:225], v4 offset:49920
    v_mfma_f32_16x16x32_bf16 v[108:111], v[232:235], v[28:31], v[108:111]
    ds_read_b64_tr_b16 v[226:227], v4 offset:50944
    s_mov_b32 s23, 0x26000
    buffer_load_dwordx4 v[60:63], v6, s[8:11], s23 offen offset:2048 sc1
    s_waitcnt lgkmcnt(6)
    v_mfma_f32_16x16x32_bf16 v[112:115], v[236:239], v[24:27], v[112:115]
    ds_read_b64_tr_b16 v[228:229], v5 offset:49952
    v_mfma_f32_16x16x32_bf16 v[116:119], v[236:239], v[28:31], v[116:119]
    ds_read_b64_tr_b16 v[230:231], v5 offset:50976
    s_waitcnt lgkmcnt(6)
    v_mfma_f32_16x16x32_bf16 v[120:123], v[240:243], v[24:27], v[120:123]
    v_mfma_f32_16x16x32_bf16 v[124:127], v[240:243], v[28:31], v[124:127]
    s_waitcnt vmcnt(14)
    s_barrier
    ds_read_b64_tr_b16 v[232:233], v7 offset:0
    ds_read_b64_tr_b16 v[234:235], v7 offset:1024
    s_waitcnt lgkmcnt(6)
    v_mfma_f32_16x16x32_bf16 v[128:131], v[244:247], v[24:27], v[128:131]
    s_add_u32 s22, s24, 0x220000
    s_add_u32 m0, s20, 0x18000
    s_nop 0
    buffer_load_dwordx4 v3, s[4:7], s22 offen lds
    ds_read_b64_tr_b16 v[236:237], v8 offset:32
    v_mfma_f32_16x16x32_bf16 v[132:135], v[244:247], v[28:31], v[132:135]
    ds_read_b64_tr_b16 v[238:239], v8 offset:1056
    s_waitcnt lgkmcnt(6)
    v_mfma_f32_16x16x32_bf16 v[136:139], v[224:227], v[24:27], v[136:139]
    ds_read_b64_tr_b16 v[240:241], v7 offset:256
    v_mfma_f32_16x16x32_bf16 v[140:143], v[224:227], v[28:31], v[140:143]
    s_add_u32 s22, s24, 0x222000
    s_add_u32 m0, s20, 0x18400
    s_nop 0
    buffer_load_dwordx4 v3, s[4:7], s22 offen lds
    ds_read_b64_tr_b16 v[242:243], v7 offset:1280
    s_waitcnt lgkmcnt(6)
    v_mfma_f32_16x16x32_bf16 v[144:147], v[228:231], v[24:27], v[144:147]
    ds_read_b64_tr_b16 v[244:245], v8 offset:288
    v_mfma_f32_16x16x32_bf16 v[148:151], v[228:231], v[28:31], v[148:151]
    ds_read_b64_tr_b16 v[246:247], v8 offset:1312
    s_waitcnt vmcnt(15) lgkmcnt(6)
    v_mfma_f32_16x16x32_bf16 v[88:91], v[232:235], v[32:35], v[88:91]
    ds_read_b64_tr_b16 v[224:225], v7 offset:512
    s_waitcnt vmcnt(14)
    v_mfma_f32_16x16x32_bf16 v[92:95], v[232:235], v[36:39], v[92:95]
    ds_read_b64_tr_b16 v[226:227], v7 offset:1536
    s_waitcnt lgkmcnt(6)
    v_mfma_f32_16x16x32_bf16 v[96:99], v[236:239], v[32:35], v[96:99]
    ds_read_b64_tr_b16 v[228:229], v8 offset:544
    s_mov_b32 s23, 0x8000
    buffer_load_dwordx4 v[24:27], v6, s[8:11], s23 offen offset:2048 sc1
    v_mfma_f32_16x16x32_bf16 v[100:103], v[236:239], v[36:39], v[100:103]
    ds_read_b64_tr_b16 v[230:231], v8 offset:1568
    s_waitcnt lgkmcnt(6)
    v_mfma_f32_16x16x32_bf16 v[104:107], v[240:243], v[32:35], v[104:107]
    ds_read_b64_tr_b16 v[232:233], v7 offset:768
    v_mfma_f32_16x16x32_bf16 v[108:111], v[240:243], v[36:39], v[108:111]
    ds_read_b64_tr_b16 v[234:235], v7 offset:1792
    s_mov_b32 s23, 0x28000
    buffer_load_dwordx4 v[28:31], v6, s[8:11], s23 offen offset:2048 sc1
    s_mov_b32 s16, 0x544000
    buffer_load_dwordx4 v[184:187], v2, s[8:11], s16 offen sc1
    s_waitcnt lgkmcnt(6)
    v_mfma_f32_16x16x32_bf16 v[112:115], v[244:247], v[32:35], v[112:115]
    ds_read_b64_tr_b16 v[236:237], v8 offset:800
    v_mfma_f32_16x16x32_bf16 v[116:119], v[244:247], v[36:39], v[116:119]
    ds_read_b64_tr_b16 v[238:239], v8 offset:1824
    s_waitcnt lgkmcnt(6)
    v_mfma_f32_16x16x32_bf16 v[120:123], v[224:227], v[32:35], v[120:123]
    v_mfma_f32_16x16x32_bf16 v[124:127], v[224:227], v[36:39], v[124:127]
    s_waitcnt vmcnt(15)
    s_barrier
    ds_read_b64_tr_b16 v[240:241], v7 offset:16384
    ds_read_b64_tr_b16 v[242:243], v7 offset:17408
    s_waitcnt lgkmcnt(6)
    v_mfma_f32_16x16x32_bf16 v[128:131], v[228:231], v[32:35], v[128:131]
    s_add_u32 s22, s24, 0x2a0000
    s_add_u32 m0, s20, 0x1c000
    s_nop 0
    buffer_load_dwordx4 v3, s[4:7], s22 offen lds
    ds_read_b64_tr_b16 v[244:245], v8 offset:16416
    v_mfma_f32_16x16x32_bf16 v[132:135], v[228:231], v[36:39], v[132:135]
    ds_read_b64_tr_b16 v[246:247], v8 offset:17440
    s_waitcnt lgkmcnt(6)
    v_mfma_f32_16x16x32_bf16 v[136:139], v[232:235], v[32:35], v[136:139]
    ds_read_b64_tr_b16 v[224:225], v7 offset:16640
    v_mfma_f32_16x16x32_bf16 v[140:143], v[232:235], v[36:39], v[140:143]
    s_add_u32 s22, s24, 0x2a2000
    s_add_u32 m0, s20, 0x1c400
    s_nop 0
    buffer_load_dwordx4 v3, s[4:7], s22 offen lds
    ds_read_b64_tr_b16 v[226:227], v7 offset:17664
    s_waitcnt lgkmcnt(6)
    v_mfma_f32_16x16x32_bf16 v[144:147], v[236:239], v[32:35], v[144:147]
    ds_read_b64_tr_b16 v[228:229], v8 offset:16672
    v_mfma_f32_16x16x32_bf16 v[148:151], v[236:239], v[36:39], v[148:151]
    ds_read_b64_tr_b16 v[230:231], v8 offset:17696
    s_waitcnt vmcnt(16) lgkmcnt(6)
    v_mfma_f32_16x16x32_bf16 v[88:91], v[240:243], v[40:43], v[88:91]
    ds_read_b64_tr_b16 v[232:233], v7 offset:16896
    s_waitcnt vmcnt(15)
    v_mfma_f32_16x16x32_bf16 v[92:95], v[240:243], v[44:47], v[92:95]
    ds_read_b64_tr_b16 v[234:235], v7 offset:17920
    s_waitcnt lgkmcnt(6)
    v_mfma_f32_16x16x32_bf16 v[96:99], v[244:247], v[40:43], v[96:99]
    ds_read_b64_tr_b16 v[236:237], v8 offset:16928
    s_mov_b32 s23, 0xa000
    buffer_load_dwordx4 v[32:35], v6, s[8:11], s23 offen offset:2048 sc1
    v_mfma_f32_16x16x32_bf16 v[100:103], v[244:247], v[44:47], v[100:103]
    ds_read_b64_tr_b16 v[238:239], v8 offset:17952
    s_waitcnt lgkmcnt(6)
    v_mfma_f32_16x16x32_bf16 v[104:107], v[224:227], v[40:43], v[104:107]
    ds_read_b64_tr_b16 v[240:241], v7 offset:17152
    v_mfma_f32_16x16x32_bf16 v[108:111], v[224:227], v[44:47], v[108:111]
    ds_read_b64_tr_b16 v[242:243], v7 offset:18176
    s_mov_b32 s23, 0x2a000
    buffer_load_dwordx4 v[36:39], v6, s[8:11], s23 offen offset:2048 sc1
    s_waitcnt lgkmcnt(6)
    v_mfma_f32_16x16x32_bf16 v[112:115], v[228:231], v[40:43], v[112:115]
    ds_read_b64_tr_b16 v[244:245], v8 offset:17184
    v_mfma_f32_16x16x32_bf16 v[116:119], v[228:231], v[44:47], v[116:119]
    ds_read_b64_tr_b16 v[246:247], v8 offset:18208
    s_waitcnt lgkmcnt(6)
    v_mfma_f32_16x16x32_bf16 v[120:123], v[232:235], v[40:43], v[120:123]
    v_mfma_f32_16x16x32_bf16 v[124:127], v[232:235], v[44:47], v[124:127]
    s_waitcnt vmcnt(15)
    s_barrier
    ds_read_b64_tr_b16 v[224:225], v4 offset:0
    ds_read_b64_tr_b16 v[226:227], v4 offset:1024
    s_waitcnt lgkmcnt(6)
    v_mfma_f32_16x16x32_bf16 v[128:131], v[236:239], v[40:43], v[128:131]
    s_add_u32 s22, s24, 0x320000
    s_add_u32 m0, s20, 0x20000
    s_nop 0
    buffer_load_dwordx4 v3, s[4:7], s22 offen lds
    ds_read_b64_tr_b16 v[228:229], v5 offset:32
    v_mfma_f32_16x16x32_bf16 v[132:135], v[236:239], v[44:47], v[132:135]
    ds_read_b64_tr_b16 v[230:231], v5 offset:1056
    s_waitcnt lgkmcnt(6)
    v_mfma_f32_16x16x32_bf16 v[136:139], v[240:243], v[40:43], v[136:139]
    ds_read_b64_tr_b16 v[232:233], v4 offset:256
    v_mfma_f32_16x16x32_bf16 v[140:143], v[240:243], v[44:47], v[140:143]
    s_add_u32 s22, s24, 0x322000
    s_add_u32 m0, s20, 0x20400
    s_nop 0
    buffer_load_dwordx4 v3, s[4:7], s22 offen lds
    ds_read_b64_tr_b16 v[234:235], v4 offset:1280
    s_waitcnt lgkmcnt(6)
    v_mfma_f32_16x16x32_bf16 v[144:147], v[244:247], v[40:43], v[144:147]
    ds_read_b64_tr_b16 v[236:237], v5 offset:288
    v_mfma_f32_16x16x32_bf16 v[148:151], v[244:247], v[44:47], v[148:151]
    ds_read_b64_tr_b16 v[238:239], v5 offset:1312
    s_waitcnt vmcnt(16) lgkmcnt(6)
    v_mfma_f32_16x16x32_bf16 v[88:91], v[224:227], v[48:51], v[88:91]
    ds_read_b64_tr_b16 v[240:241], v4 offset:512
    s_waitcnt vmcnt(15)
    v_mfma_f32_16x16x32_bf16 v[92:95], v[224:227], v[52:55], v[92:95]
    ds_read_b64_tr_b16 v[242:243], v4 offset:1536
    s_waitcnt lgkmcnt(6)
    v_mfma_f32_16x16x32_bf16 v[96:99], v[228:231], v[48:51], v[96:99]
    ds_read_b64_tr_b16 v[244:245], v5 offset:544
    s_mov_b32 s23, 0xc000
    buffer_load_dwordx4 v[40:43], v6, s[8:11], s23 offen offset:2048 sc1
    v_mfma_f32_16x16x32_bf16 v[100:103], v[228:231], v[52:55], v[100:103]
    ds_read_b64_tr_b16 v[246:247], v5 offset:1568
    s_waitcnt lgkmcnt(6)
    v_mfma_f32_16x16x32_bf16 v[104:107], v[232:235], v[48:51], v[104:107]
    ds_read_b64_tr_b16 v[224:225], v4 offset:768
    v_mfma_f32_16x16x32_bf16 v[108:111], v[232:235], v[52:55], v[108:111]
    ds_read_b64_tr_b16 v[226:227], v4 offset:1792
    s_mov_b32 s23, 0x2c000
    buffer_load_dwordx4 v[44:47], v6, s[8:11], s23 offen offset:2048 sc1
    s_waitcnt lgkmcnt(6)
    v_mfma_f32_16x16x32_bf16 v[112:115], v[236:239], v[48:51], v[112:115]
    ds_read_b64_tr_b16 v[228:229], v5 offset:800
    v_mfma_f32_16x16x32_bf16 v[116:119], v[236:239], v[52:55], v[116:119]
    ds_read_b64_tr_b16 v[230:231], v5 offset:1824
    s_waitcnt lgkmcnt(6)
    v_mfma_f32_16x16x32_bf16 v[120:123], v[240:243], v[48:51], v[120:123]
    v_mfma_f32_16x16x32_bf16 v[124:127], v[240:243], v[52:55], v[124:127]
    s_waitcnt vmcnt(15)
    s_barrier
    ds_read_b64_tr_b16 v[232:233], v4 offset:16384
    ds_read_b64_tr_b16 v[234:235], v4 offset:17408
    s_add_u32 s19, s19, 8192
    buffer_load_dword v12, v13, s[8:11], s19 offen sc1
    s_waitcnt lgkmcnt(6)
    v_mfma_f32_16x16x32_bf16 v[128:131], v[244:247], v[48:51], v[128:131]
    s_add_u32 s22, s24, 0x3a0000
    s_add_u32 m0, s20, 0x24000
    s_nop 0
    buffer_load_dwordx4 v3, s[4:7], s22 offen lds
    ds_read_b64_tr_b16 v[236:237], v5 offset:16416
    v_mfma_f32_16x16x32_bf16 v[132:135], v[244:247], v[52:55], v[132:135]
    ds_read_b64_tr_b16 v[238:239], v5 offset:17440
    s_waitcnt lgkmcnt(6)
    v_mfma_f32_16x16x32_bf16 v[136:139], v[224:227], v[48:51], v[136:139]
    ds_read_b64_tr_b16 v[240:241], v4 offset:16640
    v_mfma_f32_16x16x32_bf16 v[140:143], v[224:227], v[52:55], v[140:143]
    s_add_u32 s22, s24, 0x3a2000
    s_add_u32 m0, s20, 0x24400
    s_nop 0
    buffer_load_dwordx4 v3, s[4:7], s22 offen lds
    ds_read_b64_tr_b16 v[242:243], v4 offset:17664
    s_waitcnt lgkmcnt(6)
    v_mfma_f32_16x16x32_bf16 v[144:147], v[228:231], v[48:51], v[144:147]
    ds_read_b64_tr_b16 v[244:245], v5 offset:16672
    v_mfma_f32_16x16x32_bf16 v[148:151], v[228:231], v[52:55], v[148:151]
    ds_read_b64_tr_b16 v[246:247], v5 offset:17696
    s_waitcnt vmcnt(17) lgkmcnt(6)
    v_mfma_f32_16x16x32_bf16 v[88:91], v[232:235], v[56:59], v[88:91]
    ds_read_b64_tr_b16 v[224:225], v4 offset:16896
    s_waitcnt vmcnt(16)
    v_mfma_f32_16x16x32_bf16 v[92:95], v[232:235], v[60:63], v[92:95]
    ds_read_b64_tr_b16 v[226:227], v4 offset:17920
    s_waitcnt lgkmcnt(6)
    v_mfma_f32_16x16x32_bf16 v[96:99], v[236:239], v[56:59], v[96:99]
    ds_read_b64_tr_b16 v[228:229], v5 offset:16928
    s_mov_b32 s23, 0xe000
    buffer_load_dwordx4 v[48:51], v6, s[8:11], s23 offen offset:2048 sc1
    v_mfma_f32_16x16x32_bf16 v[100:103], v[236:239], v[60:63], v[100:103]
    ds_read_b64_tr_b16 v[230:231], v5 offset:17952
    s_waitcnt lgkmcnt(6)
    v_mfma_f32_16x16x32_bf16 v[104:107], v[240:243], v[56:59], v[104:107]
    ds_read_b64_tr_b16 v[232:233], v4 offset:17152
    v_mfma_f32_16x16x32_bf16 v[108:111], v[240:243], v[60:63], v[108:111]
    ds_read_b64_tr_b16 v[234:235], v4 offset:18176
    s_mov_b32 s23, 0x2e000
    buffer_load_dwordx4 v[52:55], v6, s[8:11], s23 offen offset:2048 sc1
    s_waitcnt lgkmcnt(6)
    v_mfma_f32_16x16x32_bf16 v[112:115], v[244:247], v[56:59], v[112:115]
    ds_read_b64_tr_b16 v[236:237], v5 offset:17184
    v_mfma_f32_16x16x32_bf16 v[116:119], v[244:247], v[60:63], v[116:119]
    ds_read_b64_tr_b16 v[238:239], v5 offset:18208
    s_waitcnt lgkmcnt(6)
    v_mfma_f32_16x16x32_bf16 v[120:123], v[224:227], v[56:59], v[120:123]
    v_mfma_f32_16x16x32_bf16 v[124:127], v[224:227], v[60:63], v[124:127]
    s_waitcnt vmcnt(16)
    s_barrier
    ds_read_b64_tr_b16 v[240:241], v4 offset:32768
    ds_read_b64_tr_b16 v[242:243], v4 offset:33792
    s_waitcnt lgkmcnt(6)
    v_mfma_f32_16x16x32_bf16 v[128:131], v[228:231], v[56:59], v[128:131]
    s_add_u32 s22, s24, 0x30000
    s_add_u32 m0, s20, 0x10000
    s_nop 0
    buffer_load_dwordx4 v3, s[4:7], s22 offen lds
    ds_read_b64_tr_b16 v[244:245], v5 offset:32800
    v_mfma_f32_16x16x32_bf16 v[132:135], v[228:231], v[60:63], v[132:135]
    ds_read_b64_tr_b16 v[246:247], v5 offset:33824
    s_waitcnt lgkmcnt(6)
    v_mfma_f32_16x16x32_bf16 v[136:139], v[232:235], v[56:59], v[136:139]
    ds_read_b64_tr_b16 v[224:225], v4 offset:33024
    v_mfma_f32_16x16x32_bf16 v[140:143], v[232:235], v[60:63], v[140:143]
    s_add_u32 s22, s24, 0x32000
    s_add_u32 m0, s20, 0x10400
    s_nop 0
    buffer_load_dwordx4 v3, s[4:7], s22 offen lds
    ds_read_b64_tr_b16 v[226:227], v4 offset:34048
    s_waitcnt lgkmcnt(6)
    v_mfma_f32_16x16x32_bf16 v[144:147], v[236:239], v[56:59], v[144:147]
    ds_read_b64_tr_b16 v[228:229], v5 offset:33056
    v_mfma_f32_16x16x32_bf16 v[148:151], v[236:239], v[60:63], v[148:151]
    ds_read_b64_tr_b16 v[230:231], v5 offset:34080
    s_waitcnt vmcnt(6)
    v_cmp_ne_u32 vcc, s28, v12
    s_cbranch_vccnz adaLN_cond__sliding_block_cached__moe_arch_mod__prompt_kernel_o29r
adaLN_cond__sliding_block_cached__moe_arch_mod__prompt_kernel_o29b:
    s_waitcnt lgkmcnt(6)
    v_mfma_f32_16x16x32_bf16 v[88:91], v[240:243], v[24:27], v[88:91]
    ds_read_b64_tr_b16 v[232:233], v4 offset:33280
    v_mfma_f32_16x16x32_bf16 v[92:95], v[240:243], v[28:31], v[92:95]
    ds_read_b64_tr_b16 v[234:235], v4 offset:34304
    s_waitcnt lgkmcnt(6)
    v_mfma_f32_16x16x32_bf16 v[96:99], v[244:247], v[24:27], v[96:99]
    ds_read_b64_tr_b16 v[236:237], v5 offset:33312
    s_mov_b32 s23, 0x0
    buffer_load_dwordx4 v[56:59], v6, s[8:11], s23 offen offset:3072 sc1
    v_mfma_f32_16x16x32_bf16 v[100:103], v[244:247], v[28:31], v[100:103]
    ds_read_b64_tr_b16 v[238:239], v5 offset:34336
    s_waitcnt lgkmcnt(6)
    v_mfma_f32_16x16x32_bf16 v[104:107], v[224:227], v[24:27], v[104:107]
    ds_read_b64_tr_b16 v[240:241], v4 offset:33536
    v_mfma_f32_16x16x32_bf16 v[108:111], v[224:227], v[28:31], v[108:111]
    ds_read_b64_tr_b16 v[242:243], v4 offset:34560
    s_mov_b32 s23, 0x20000
    buffer_load_dwordx4 v[60:63], v6, s[8:11], s23 offen offset:3072 sc1
    v_xor_b32 v16, s28, v184
    v_xor_b32 v17, s28, v185
    v_xor_b32 v18, s28, v186
    v_xor_b32 v19, s28, v187
    v_or3_b32 v16, v16, v17, v18
    v_or_b32 v16, v16, v19
    v_cmp_ne_u32 vcc, 0, v16
    s_cbranch_vccnz adaLN_cond__sliding_block_cached__moe_arch_mod__prompt_kernel_mf10r
adaLN_cond__sliding_block_cached__moe_arch_mod__prompt_kernel_mf10b:
    s_waitcnt lgkmcnt(6)
    v_mfma_f32_16x16x32_bf16 v[112:115], v[228:231], v[24:27], v[112:115]
    ds_read_b64_tr_b16 v[244:245], v5 offset:33568
    v_mfma_f32_16x16x32_bf16 v[116:119], v[228:231], v[28:31], v[116:119]
    ds_read_b64_tr_b16 v[246:247], v5 offset:34592
    s_waitcnt lgkmcnt(6)
    v_mfma_f32_16x16x32_bf16 v[120:123], v[232:235], v[24:27], v[120:123]
    v_mfma_f32_16x16x32_bf16 v[124:127], v[232:235], v[28:31], v[124:127]
    s_barrier
    ds_read_b64_tr_b16 v[224:225], v4 offset:49152
    ds_read_b64_tr_b16 v[226:227], v4 offset:50176
    s_waitcnt lgkmcnt(6)
    v_mfma_f32_16x16x32_bf16 v[128:131], v[236:239], v[24:27], v[128:131]
    s_add_u32 s22, s24, 0xb0000
    s_add_u32 m0, s20, 0x14000
    s_nop 0
    buffer_load_dwordx4 v3, s[4:7], s22 offen lds
    ds_read_b64_tr_b16 v[228:229], v5 offset:49184
    v_mfma_f32_16x16x32_bf16 v[132:135], v[236:239], v[28:31], v[132:135]
    ds_read_b64_tr_b16 v[230:231], v5 offset:50208
    s_waitcnt lgkmcnt(6)
    v_mfma_f32_16x16x32_bf16 v[136:139], v[240:243], v[24:27], v[136:139]
    ds_read_b64_tr_b16 v[232:233], v4 offset:49408
    v_mfma_f32_16x16x32_bf16 v[140:143], v[240:243], v[28:31], v[140:143]
    s_add_u32 s22, s24, 0xb2000
    s_add_u32 m0, s20, 0x14400
    s_nop 0
    buffer_load_dwordx4 v3, s[4:7], s22 offen lds
    ds_read_b64_tr_b16 v[234:235], v4 offset:50432
    s_waitcnt lgkmcnt(6)
    v_mfma_f32_16x16x32_bf16 v[144:147], v[244:247], v[24:27], v[144:147]
    ds_read_b64_tr_b16 v[236:237], v5 offset:49440
    v_mfma_f32_16x16x32_bf16 v[148:151], v[244:247], v[28:31], v[148:151]
    ds_read_b64_tr_b16 v[238:239], v5 offset:50464
    s_waitcnt lgkmcnt(6)
    v_mfma_f32_16x16x32_bf16 v[88:91], v[224:227], v[32:35], v[88:91]
    ds_read_b64_tr_b16 v[240:241], v4 offset:49664
    v_mfma_f32_16x16x32_bf16 v[92:95], v[224:227], v[36:39], v[92:95]
    ds_read_b64_tr_b16 v[242:243], v4 offset:50688
    s_waitcnt lgkmcnt(6)
    v_mfma_f32_16x16x32_bf16 v[96:99], v[228:231], v[32:35], v[96:99]
    ds_read_b64_tr_b16 v[244:245], v5 offset:49696
    s_mov_b32 s23, 0x2000
    buffer_load_dwordx4 v[24:27], v6, s[8:11], s23 offen offset:3072 sc1
    v_mfma_f32_16x16x32_bf16 v[100:103], v[228:231], v[36:39], v[100:103]
    ds_read_b64_tr_b16 v[246:247], v5 offset:50720
    s_waitcnt lgkmcnt(6)
    v_mfma_f32_16x16x32_bf16 v[104:107], v[232:235], v[32:35], v[104:107]
    ds_read_b64_tr_b16 v[224:225], v4 offset:49920
    v_mfma_f32_16x16x32_bf16 v[108:111], v[232:235], v[36:39], v[108:111]
    ds_read_b64_tr_b16 v[226:227], v4 offset:50944
    s_mov_b32 s23, 0x22000
    buffer_load_dwordx4 v[28:31], v6, s[8:11], s23 offen offset:3072 sc1
    s_waitcnt lgkmcnt(6)
    v_mfma_f32_16x16x32_bf16 v[112:115], v[236:239], v[32:35], v[112:115]
    ds_read_b64_tr_b16 v[228:229], v5 offset:49952
    v_mfma_f32_16x16x32_bf16 v[116:119], v[236:239], v[36:39], v[116:119]
    ds_read_b64_tr_b16 v[230:231], v5 offset:50976
    s_waitcnt lgkmcnt(6)
    v_mfma_f32_16x16x32_bf16 v[120:123], v[240:243], v[32:35], v[120:123]
    v_mfma_f32_16x16x32_bf16 v[124:127], v[240:243], v[36:39], v[124:127]
    s_barrier
    ds_read_b64_tr_b16 v[232:233], v7 offset:0
    ds_read_b64_tr_b16 v[234:235], v7 offset:1024
    s_waitcnt lgkmcnt(6)
    v_mfma_f32_16x16x32_bf16 v[128:131], v[244:247], v[32:35], v[128:131]
    s_add_u32 s22, s24, 0x130000
    s_add_u32 m0, s20, 0x18000
    s_nop 0
    buffer_load_dwordx4 v3, s[4:7], s22 offen lds
    ds_read_b64_tr_b16 v[236:237], v8 offset:32
    v_mfma_f32_16x16x32_bf16 v[132:135], v[244:247], v[36:39], v[132:135]
    ds_read_b64_tr_b16 v[238:239], v8 offset:1056
    s_waitcnt lgkmcnt(6)
    v_mfma_f32_16x16x32_bf16 v[136:139], v[224:227], v[32:35], v[136:139]
    ds_read_b64_tr_b16 v[240:241], v7 offset:256
    v_mfma_f32_16x16x32_bf16 v[140:143], v[224:227], v[36:39], v[140:143]
    s_add_u32 s22, s24, 0x132000
    s_add_u32 m0, s20, 0x18400
    s_nop 0
    buffer_load_dwordx4 v3, s[4:7], s22 offen lds
    ds_read_b64_tr_b16 v[242:243], v7 offset:1280
    s_waitcnt lgkmcnt(6)
    v_mfma_f32_16x16x32_bf16 v[144:147], v[228:231], v[32:35], v[144:147]
    ds_read_b64_tr_b16 v[244:245], v8 offset:288
    v_mfma_f32_16x16x32_bf16 v[148:151], v[228:231], v[36:39], v[148:151]
    ds_read_b64_tr_b16 v[246:247], v8 offset:1312
    s_waitcnt lgkmcnt(6)
    v_mfma_f32_16x16x32_bf16 v[88:91], v[232:235], v[40:43], v[88:91]
    ds_read_b64_tr_b16 v[224:225], v7 offset:512
    v_mfma_f32_16x16x32_bf16 v[92:95], v[232:235], v[44:47], v[92:95]
    ds_read_b64_tr_b16 v[226:227], v7 offset:1536
    s_waitcnt lgkmcnt(6)
    v_mfma_f32_16x16x32_bf16 v[96:99], v[236:239], v[40:43], v[96:99]
    ds_read_b64_tr_b16 v[228:229], v8 offset:544
    s_mov_b32 s23, 0x4000
    buffer_load_dwordx4 v[32:35], v6, s[8:11], s23 offen offset:3072 sc1
    v_mfma_f32_16x16x32_bf16 v[100:103], v[236:239], v[44:47], v[100:103]
    ds_read_b64_tr_b16 v[230:231], v8 offset:1568
    s_waitcnt lgkmcnt(6)
    v_mfma_f32_16x16x32_bf16 v[104:107], v[240:243], v[40:43], v[104:107]
    ds_read_b64_tr_b16 v[232:233], v7 offset:768
    v_mfma_f32_16x16x32_bf16 v[108:111], v[240:243], v[44:47], v[108:111]
    ds_read_b64_tr_b16 v[234:235], v7 offset:1792
    s_mov_b32 s23, 0x24000
    buffer_load_dwordx4 v[36:39], v6, s[8:11], s23 offen offset:3072 sc1
    s_waitcnt lgkmcnt(6)
    v_mfma_f32_16x16x32_bf16 v[112:115], v[244:247], v[40:43], v[112:115]
    ds_read_b64_tr_b16 v[236:237], v8 offset:800
    v_mfma_f32_16x16x32_bf16 v[116:119], v[244:247], v[44:47], v[116:119]
    ds_read_b64_tr_b16 v[238:239], v8 offset:1824
    s_waitcnt lgkmcnt(6)
    v_mfma_f32_16x16x32_bf16 v[120:123], v[224:227], v[40:43], v[120:123]
    v_mfma_f32_16x16x32_bf16 v[124:127], v[224:227], v[44:47], v[124:127]
    s_waitcnt vmcnt(14)
    s_barrier
    ds_read_b64_tr_b16 v[240:241], v7 offset:16384
    ds_read_b64_tr_b16 v[242:243], v7 offset:17408
    s_waitcnt lgkmcnt(6)
    v_mfma_f32_16x16x32_bf16 v[128:131], v[228:231], v[40:43], v[128:131]
    s_add_u32 s22, s24, 0x1b0000
    s_add_u32 m0, s20, 0x1c000
    s_nop 0
    buffer_load_dwordx4 v3, s[4:7], s22 offen lds
    ds_read_b64_tr_b16 v[244:245], v8 offset:16416
    v_mfma_f32_16x16x32_bf16 v[132:135], v[228:231], v[44:47], v[132:135]
    ds_read_b64_tr_b16 v[246:247], v8 offset:17440
    s_waitcnt lgkmcnt(6)
    v_mfma_f32_16x16x32_bf16 v[136:139], v[232:235], v[40:43], v[136:139]
    ds_read_b64_tr_b16 v[224:225], v7 offset:16640
    v_mfma_f32_16x16x32_bf16 v[140:143], v[232:235], v[44:47], v[140:143]
    s_add_u32 s22, s24, 0x1b2000
    s_add_u32 m0, s20, 0x1c400
    s_nop 0
    buffer_load_dwordx4 v3, s[4:7], s22 offen lds
    ds_read_b64_tr_b16 v[226:227], v7 offset:17664
    s_waitcnt lgkmcnt(6)
    v_mfma_f32_16x16x32_bf16 v[144:147], v[236:239], v[40:43], v[144:147]
    ds_read_b64_tr_b16 v[228:229], v8 offset:16672
    v_mfma_f32_16x16x32_bf16 v[148:151], v[236:239], v[44:47], v[148:151]
    ds_read_b64_tr_b16 v[230:231], v8 offset:17696
    s_waitcnt vmcnt(15) lgkmcnt(6)
    v_mfma_f32_16x16x32_bf16 v[88:91], v[240:243], v[48:51], v[88:91]
    ds_read_b64_tr_b16 v[232:233], v7 offset:16896
    s_waitcnt vmcnt(14)
    v_mfma_f32_16x16x32_bf16 v[92:95], v[240:243], v[52:55], v[92:95]
    ds_read_b64_tr_b16 v[234:235], v7 offset:17920
    s_waitcnt lgkmcnt(6)
    v_mfma_f32_16x16x32_bf16 v[96:99], v[244:247], v[48:51], v[96:99]
    ds_read_b64_tr_b16 v[236:237], v8 offset:16928
    s_mov_b32 s23, 0x6000
    buffer_load_dwordx4 v[40:43], v6, s[8:11], s23 offen offset:3072 sc1
    v_mfma_f32_16x16x32_bf16 v[100:103], v[244:247], v[52:55], v[100:103]
    ds_read_b64_tr_b16 v[238:239], v8 offset:17952
    s_waitcnt lgkmcnt(6)
    v_mfma_f32_16x16x32_bf16 v[104:107], v[224:227], v[48:51], v[104:107]
    ds_read_b64_tr_b16 v[240:241], v7 offset:17152
    v_mfma_f32_16x16x32_bf16 v[108:111], v[224:227], v[52:55], v[108:111]
    ds_read_b64_tr_b16 v[242:243], v7 offset:18176
    s_mov_b32 s23, 0x26000
    buffer_load_dwordx4 v[44:47], v6, s[8:11], s23 offen offset:3072 sc1
    s_waitcnt lgkmcnt(6)
    v_mfma_f32_16x16x32_bf16 v[112:115], v[228:231], v[48:51], v[112:115]
    ds_read_b64_tr_b16 v[244:245], v8 offset:17184
    v_mfma_f32_16x16x32_bf16 v[116:119], v[228:231], v[52:55], v[116:119]
    ds_read_b64_tr_b16 v[246:247], v8 offset:18208
    s_waitcnt lgkmcnt(6)
    v_mfma_f32_16x16x32_bf16 v[120:123], v[232:235], v[48:51], v[120:123]
    v_mfma_f32_16x16x32_bf16 v[124:127], v[232:235], v[52:55], v[124:127]
    s_waitcnt vmcnt(14)
    s_barrier
    ds_read_b64_tr_b16 v[224:225], v4 offset:0
    ds_read_b64_tr_b16 v[226:227], v4 offset:1024
    s_waitcnt lgkmcnt(6)
    v_mfma_f32_16x16x32_bf16 v[128:131], v[236:239], v[48:51], v[128:131]
    s_add_u32 s22, s24, 0x230000
    s_add_u32 m0, s20, 0x20000
    s_nop 0
    buffer_load_dwordx4 v3, s[4:7], s22 offen lds
    ds_read_b64_tr_b16 v[228:229], v5 offset:32
    v_mfma_f32_16x16x32_bf16 v[132:135], v[236:239], v[52:55], v[132:135]
    ds_read_b64_tr_b16 v[230:231], v5 offset:1056
    s_waitcnt lgkmcnt(6)
    v_mfma_f32_16x16x32_bf16 v[136:139], v[240:243], v[48:51], v[136:139]
    ds_read_b64_tr_b16 v[232:233], v4 offset:256
    v_mfma_f32_16x16x32_bf16 v[140:143], v[240:243], v[52:55], v[140:143]
    s_add_u32 s22, s24, 0x232000
    s_add_u32 m0, s20, 0x20400
    s_nop 0
    buffer_load_dwordx4 v3, s[4:7], s22 offen lds
    ds_read_b64_tr_b16 v[234:235], v4 offset:1280
    s_waitcnt lgkmcnt(6)
    v_mfma_f32_16x16x32_bf16 v[144:147], v[244:247], v[48:51], v[144:147]
    ds_read_b64_tr_b16 v[236:237], v5 offset:288
    v_mfma_f32_16x16x32_bf16 v[148:151], v[244:247], v[52:55], v[148:151]
    ds_read_b64_tr_b16 v[238:239], v5 offset:1312
    s_waitcnt vmcnt(15) lgkmcnt(6)
    v_mfma_f32_16x16x32_bf16 v[88:91], v[224:227], v[56:59], v[88:91]
    ds_read_b64_tr_b16 v[240:241], v4 offset:512
    s_waitcnt vmcnt(14)
    v_mfma_f32_16x16x32_bf16 v[92:95], v[224:227], v[60:63], v[92:95]
    ds_read_b64_tr_b16 v[242:243], v4 offset:1536
    s_waitcnt lgkmcnt(6)
    v_mfma_f32_16x16x32_bf16 v[96:99], v[228:231], v[56:59], v[96:99]
    ds_read_b64_tr_b16 v[244:245], v5 offset:544
    s_mov_b32 s23, 0x8000
    buffer_load_dwordx4 v[48:51], v6, s[8:11], s23 offen offset:3072 sc1
    v_mfma_f32_16x16x32_bf16 v[100:103], v[228:231], v[60:63], v[100:103]
    ds_read_b64_tr_b16 v[246:247], v5 offset:1568
    s_waitcnt lgkmcnt(6)
    v_mfma_f32_16x16x32_bf16 v[104:107], v[232:235], v[56:59], v[104:107]
    ds_read_b64_tr_b16 v[224:225], v4 offset:768
    v_mfma_f32_16x16x32_bf16 v[108:111], v[232:235], v[60:63], v[108:111]
    ds_read_b64_tr_b16 v[226:227], v4 offset:1792
    s_mov_b32 s23, 0x28000
    buffer_load_dwordx4 v[52:55], v6, s[8:11], s23 offen offset:3072 sc1
    s_waitcnt lgkmcnt(6)
    v_mfma_f32_16x16x32_bf16 v[112:115], v[236:239], v[56:59], v[112:115]
    ds_read_b64_tr_b16 v[228:229], v5 offset:800
    v_mfma_f32_16x16x32_bf16 v[116:119], v[236:239], v[60:63], v[116:119]
    ds_read_b64_tr_b16 v[230:231], v5 offset:1824
    s_waitcnt lgkmcnt(6)
    v_mfma_f32_16x16x32_bf16 v[120:123], v[240:243], v[56:59], v[120:123]
    v_mfma_f32_16x16x32_bf16 v[124:127], v[240:243], v[60:63], v[124:127]
    s_waitcnt vmcnt(14)
    s_barrier
    ds_read_b64_tr_b16 v[232:233], v4 offset:16384
    ds_read_b64_tr_b16 v[234:235], v4 offset:17408
    s_waitcnt lgkmcnt(6)
    v_mfma_f32_16x16x32_bf16 v[128:131], v[244:247], v[56:59], v[128:131]
    s_add_u32 s22, s24, 0x2b0000
    s_add_u32 m0, s20, 0x24000
    s_nop 0
    buffer_load_dwordx4 v3, s[4:7], s22 offen lds
    ds_read_b64_tr_b16 v[236:237], v5 offset:16416
    v_mfma_f32_16x16x32_bf16 v[132:135], v[244:247], v[60:63], v[132:135]
    ds_read_b64_tr_b16 v[238:239], v5 offset:17440
    s_waitcnt lgkmcnt(6)
    v_mfma_f32_16x16x32_bf16 v[136:139], v[224:227], v[56:59], v[136:139]
    ds_read_b64_tr_b16 v[240:241], v4 offset:16640
    v_mfma_f32_16x16x32_bf16 v[140:143], v[224:227], v[60:63], v[140:143]
    s_add_u32 s22, s24, 0x2b2000
    s_add_u32 m0, s20, 0x24400
    s_nop 0
    buffer_load_dwordx4 v3, s[4:7], s22 offen lds
    ds_read_b64_tr_b16 v[242:243], v4 offset:17664
    s_waitcnt lgkmcnt(6)
    v_mfma_f32_16x16x32_bf16 v[144:147], v[228:231], v[56:59], v[144:147]
    ds_read_b64_tr_b16 v[244:245], v5 offset:16672
    v_mfma_f32_16x16x32_bf16 v[148:151], v[228:231], v[60:63], v[148:151]
    ds_read_b64_tr_b16 v[246:247], v5 offset:17696
    s_waitcnt vmcnt(15) lgkmcnt(6)
    v_mfma_f32_16x16x32_bf16 v[88:91], v[232:235], v[24:27], v[88:91]
    ds_read_b64_tr_b16 v[224:225], v4 offset:16896
    s_waitcnt vmcnt(14)
    v_mfma_f32_16x16x32_bf16 v[92:95], v[232:235], v[28:31], v[92:95]
    ds_read_b64_tr_b16 v[226:227], v4 offset:17920
    s_waitcnt lgkmcnt(6)
    v_mfma_f32_16x16x32_bf16 v[96:99], v[236:239], v[24:27], v[96:99]
    ds_read_b64_tr_b16 v[228:229], v5 offset:16928
    s_mov_b32 s23, 0xa000
    buffer_load_dwordx4 v[56:59], v6, s[8:11], s23 offen offset:3072 sc1
    v_mfma_f32_16x16x32_bf16 v[100:103], v[236:239], v[28:31], v[100:103]
    ds_read_b64_tr_b16 v[230:231], v5 offset:17952
    s_waitcnt lgkmcnt(6)
    v_mfma_f32_16x16x32_bf16 v[104:107], v[240:243], v[24:27], v[104:107]
    ds_read_b64_tr_b16 v[232:233], v4 offset:17152
    v_mfma_f32_16x16x32_bf16 v[108:111], v[240:243], v[28:31], v[108:111]
    ds_read_b64_tr_b16 v[234:235], v4 offset:18176
    s_mov_b32 s23, 0x2a000
    buffer_load_dwordx4 v[60:63], v6, s[8:11], s23 offen offset:3072 sc1
    s_waitcnt lgkmcnt(6)
    v_mfma_f32_16x16x32_bf16 v[112:115], v[244:247], v[24:27], v[112:115]
    ds_read_b64_tr_b16 v[236:237], v5 offset:17184
    v_mfma_f32_16x16x32_bf16 v[116:119], v[244:247], v[28:31], v[116:119]
    ds_read_b64_tr_b16 v[238:239], v5 offset:18208
    s_waitcnt lgkmcnt(6)
    v_mfma_f32_16x16x32_bf16 v[120:123], v[224:227], v[24:27], v[120:123]
    v_mfma_f32_16x16x32_bf16 v[124:127], v[224:227], v[28:31], v[124:127]
    s_waitcnt vmcnt(14)
    s_barrier
    ds_read_b64_tr_b16 v[240:241], v4 offset:32768
    ds_read_b64_tr_b16 v[242:243], v4 offset:33792
    s_waitcnt lgkmcnt(6)
    v_mfma_f32_16x16x32_bf16 v[128:131], v[228:231], v[24:27], v[128:131]
    s_add_u32 s22, s24, 0x330000
    s_add_u32 m0, s20, 0x10000
    s_nop 0
    buffer_load_dwordx4 v3, s[4:7], s22 offen lds
    ds_read_b64_tr_b16 v[244:245], v5 offset:32800
    v_mfma_f32_16x16x32_bf16 v[132:135], v[228:231], v[28:31], v[132:135]
    ds_read_b64_tr_b16 v[246:247], v5 offset:33824
    s_waitcnt lgkmcnt(6)
    v_mfma_f32_16x16x32_bf16 v[136:139], v[232:235], v[24:27], v[136:139]
    ds_read_b64_tr_b16 v[224:225], v4 offset:33024
    v_mfma_f32_16x16x32_bf16 v[140:143], v[232:235], v[28:31], v[140:143]
    s_add_u32 s22, s24, 0x332000
    s_add_u32 m0, s20, 0x10400
    s_nop 0
    buffer_load_dwordx4 v3, s[4:7], s22 offen lds
    ds_read_b64_tr_b16 v[226:227], v4 offset:34048
    s_waitcnt lgkmcnt(6)
    v_mfma_f32_16x16x32_bf16 v[144:147], v[236:239], v[24:27], v[144:147]
    ds_read_b64_tr_b16 v[228:229], v5 offset:33056
    v_mfma_f32_16x16x32_bf16 v[148:151], v[236:239], v[28:31], v[148:151]
    ds_read_b64_tr_b16 v[230:231], v5 offset:34080
    s_waitcnt vmcnt(15) lgkmcnt(6)
    v_mfma_f32_16x16x32_bf16 v[88:91], v[240:243], v[32:35], v[88:91]
    ds_read_b64_tr_b16 v[232:233], v4 offset:33280
    s_waitcnt vmcnt(14)
    v_mfma_f32_16x16x32_bf16 v[92:95], v[240:243], v[36:39], v[92:95]
    ds_read_b64_tr_b16 v[234:235], v4 offset:34304
    s_waitcnt lgkmcnt(6)
    v_mfma_f32_16x16x32_bf16 v[96:99], v[244:247], v[32:35], v[96:99]
    ds_read_b64_tr_b16 v[236:237], v5 offset:33312
    s_mov_b32 s23, 0xc000
    buffer_load_dwordx4 v[24:27], v6, s[8:11], s23 offen offset:3072 sc1
    v_mfma_f32_16x16x32_bf16 v[100:103], v[244:247], v[36:39], v[100:103]
    ds_read_b64_tr_b16 v[238:239], v5 offset:34336
    s_waitcnt lgkmcnt(6)
    v_mfma_f32_16x16x32_bf16 v[104:107], v[224:227], v[32:35], v[104:107]
    ds_read_b64_tr_b16 v[240:241], v4 offset:33536
    v_mfma_f32_16x16x32_bf16 v[108:111], v[224:227], v[36:39], v[108:111]
    ds_read_b64_tr_b16 v[242:243], v4 offset:34560
    s_mov_b32 s23, 0x2c000
    buffer_load_dwordx4 v[28:31], v6, s[8:11], s23 offen offset:3072 sc1
    v_lshrrev_b32 v16, 4, v1
    v_lshlrev_b32 v16, 3, v16
    s_lshl_b32 s16, s31, 8
    s_add_u32 s16, s16, 0x540000
    buffer_load_dwordx2 v[248:249], v16, s[8:11], s16 offen offset:0 sc1
    buffer_load_dwordx2 v[250:251], v16, s[8:11], s16 offen offset:32 sc1
    buffer_load_dwordx2 v[252:253], v16, s[8:11], s16 offen offset:64 sc1
    buffer_load_dwordx2 v[254:255], v16, s[8:11], s16 offen offset:96 sc1
    s_waitcnt lgkmcnt(6)
    v_mfma_f32_16x16x32_bf16 v[112:115], v[228:231], v[32:35], v[112:115]
    ds_read_b64_tr_b16 v[244:245], v5 offset:33568
    v_mfma_f32_16x16x32_bf16 v[116:119], v[228:231], v[36:39], v[116:119]
    ds_read_b64_tr_b16 v[246:247], v5 offset:34592
    s_waitcnt lgkmcnt(6)
    v_mfma_f32_16x16x32_bf16 v[120:123], v[232:235], v[32:35], v[120:123]
    v_mfma_f32_16x16x32_bf16 v[124:127], v[232:235], v[36:39], v[124:127]
    s_waitcnt vmcnt(18)
    s_barrier
    ds_read_b64_tr_b16 v[224:225], v4 offset:49152
    ds_read_b64_tr_b16 v[226:227], v4 offset:50176
    s_waitcnt lgkmcnt(6)
    v_mfma_f32_16x16x32_bf16 v[128:131], v[236:239], v[32:35], v[128:131]
    s_add_u32 s22, s24, 0x3b0000
    s_add_u32 m0, s20, 0x14000
    s_nop 0
    buffer_load_dwordx4 v3, s[4:7], s22 offen lds
    ds_read_b64_tr_b16 v[228:229], v5 offset:49184
    v_mfma_f32_16x16x32_bf16 v[132:135], v[236:239], v[36:39], v[132:135]
    ds_read_b64_tr_b16 v[230:231], v5 offset:50208
    s_waitcnt lgkmcnt(6)
    v_mfma_f32_16x16x32_bf16 v[136:139], v[240:243], v[32:35], v[136:139]
    ds_read_b64_tr_b16 v[232:233], v4 offset:49408
    v_mfma_f32_16x16x32_bf16 v[140:143], v[240:243], v[36:39], v[140:143]
    s_add_u32 s22, s24, 0x3b2000
    s_add_u32 m0, s20, 0x14400
    s_nop 0
    buffer_load_dwordx4 v3, s[4:7], s22 offen lds
    ds_read_b64_tr_b16 v[234:235], v4 offset:50432
    s_waitcnt lgkmcnt(6)
    v_mfma_f32_16x16x32_bf16 v[144:147], v[244:247], v[32:35], v[144:147]
    ds_read_b64_tr_b16 v[236:237], v5 offset:49440
    v_mfma_f32_16x16x32_bf16 v[148:151], v[244:247], v[36:39], v[148:151]
    ds_read_b64_tr_b16 v[238:239], v5 offset:50464
    s_waitcnt vmcnt(19) lgkmcnt(6)
    v_mfma_f32_16x16x32_bf16 v[88:91], v[224:227], v[40:43], v[88:91]
    ds_read_b64_tr_b16 v[240:241], v4 offset:49664
    s_waitcnt vmcnt(18)
    v_mfma_f32_16x16x32_bf16 v[92:95], v[224:227], v[44:47], v[92:95]
    ds_read_b64_tr_b16 v[242:243], v4 offset:50688
    s_waitcnt lgkmcnt(6)
    v_mfma_f32_16x16x32_bf16 v[96:99], v[228:231], v[40:43], v[96:99]
    ds_read_b64_tr_b16 v[244:245], v5 offset:49696
    s_mov_b32 s23, 0xe000
    buffer_load_dwordx4 v[32:35], v6, s[8:11], s23 offen offset:3072 sc1
    v_mfma_f32_16x16x32_bf16 v[100:103], v[228:231], v[44:47], v[100:103]
    ds_read_b64_tr_b16 v[246:247], v5 offset:50720
    s_waitcnt lgkmcnt(6)
    v_mfma_f32_16x16x32_bf16 v[104:107], v[232:235], v[40:43], v[104:107]
    ds_read_b64_tr_b16 v[224:225], v4 offset:49920
    v_mfma_f32_16x16x32_bf16 v[108:111], v[232:235], v[44:47], v[108:111]
    ds_read_b64_tr_b16 v[226:227], v4 offset:50944
    s_mov_b32 s23, 0x2e000
    buffer_load_dwordx4 v[36:39], v6, s[8:11], s23 offen offset:3072 sc1
    s_waitcnt lgkmcnt(6)
    v_mfma_f32_16x16x32_bf16 v[112:115], v[236:239], v[40:43], v[112:115]
    ds_read_b64_tr_b16 v[228:229], v5 offset:49952
    v_mfma_f32_16x16x32_bf16 v[116:119], v[236:239], v[44:47], v[116:119]
    ds_read_b64_tr_b16 v[230:231], v5 offset:50976
    s_waitcnt lgkmcnt(6)
    v_mfma_f32_16x16x32_bf16 v[120:123], v[240:243], v[40:43], v[120:123]
    v_mfma_f32_16x16x32_bf16 v[124:127], v[240:243], v[44:47], v[124:127]
    s_waitcnt vmcnt(18)
    s_barrier
    ds_read_b64_tr_b16 v[232:233], v7 offset:0
    ds_read_b64_tr_b16 v[234:235], v7 offset:1024
    s_waitcnt lgkmcnt(6)
    v_mfma_f32_16x16x32_bf16 v[128:131], v[244:247], v[40:43], v[128:131]
    ds_read_b64_tr_b16 v[236:237], v8 offset:32
    v_mfma_f32_16x16x32_bf16 v[132:135], v[244:247], v[44:47], v[132:135]
    ds_read_b64_tr_b16 v[238:239], v8 offset:1056
    s_waitcnt lgkmcnt(6)
    v_mfma_f32_16x16x32_bf16 v[136:139], v[224:227], v[40:43], v[136:139]
    ds_read_b64_tr_b16 v[240:241], v7 offset:256
    v_mfma_f32_16x16x32_bf16 v[140:143], v[224:227], v[44:47], v[140:143]
    ds_read_b64_tr_b16 v[242:243], v7 offset:1280
    s_waitcnt lgkmcnt(6)
    v_mfma_f32_16x16x32_bf16 v[144:147], v[228:231], v[40:43], v[144:147]
    ds_read_b64_tr_b16 v[244:245], v8 offset:288
    v_mfma_f32_16x16x32_bf16 v[148:151], v[228:231], v[44:47], v[148:151]
    ds_read_b64_tr_b16 v[246:247], v8 offset:1312
    s_waitcnt vmcnt(17) lgkmcnt(6)
    v_mfma_f32_16x16x32_bf16 v[88:91], v[232:235], v[48:51], v[88:91]
    ds_read_b64_tr_b16 v[224:225], v7 offset:512
    s_waitcnt vmcnt(16)
    v_mfma_f32_16x16x32_bf16 v[92:95], v[232:235], v[52:55], v[92:95]
    ds_read_b64_tr_b16 v[226:227], v7 offset:1536
    s_waitcnt lgkmcnt(6)
    v_mfma_f32_16x16x32_bf16 v[96:99], v[236:239], v[48:51], v[96:99]
    ds_read_b64_tr_b16 v[228:229], v8 offset:544
    v_mfma_f32_16x16x32_bf16 v[100:103], v[236:239], v[52:55], v[100:103]
    ds_read_b64_tr_b16 v[230:231], v8 offset:1568
    s_waitcnt lgkmcnt(6)
    v_mfma_f32_16x16x32_bf16 v[104:107], v[240:243], v[48:51], v[104:107]
    ds_read_b64_tr_b16 v[232:233], v7 offset:768
    v_mfma_f32_16x16x32_bf16 v[108:111], v[240:243], v[52:55], v[108:111]
    ds_read_b64_tr_b16 v[234:235], v7 offset:1792
    s_waitcnt lgkmcnt(6)
    v_mfma_f32_16x16x32_bf16 v[112:115], v[244:247], v[48:51], v[112:115]
    ds_read_b64_tr_b16 v[236:237], v8 offset:800
    v_mfma_f32_16x16x32_bf16 v[116:119], v[244:247], v[52:55], v[116:119]
    ds_read_b64_tr_b16 v[238:239], v8 offset:1824
    s_waitcnt lgkmcnt(6)
    v_mfma_f32_16x16x32_bf16 v[120:123], v[224:227], v[48:51], v[120:123]
    v_mfma_f32_16x16x32_bf16 v[124:127], v[224:227], v[52:55], v[124:127]
    s_waitcnt vmcnt(14)
    s_barrier
    ds_read_b64_tr_b16 v[240:241], v7 offset:16384
    ds_read_b64_tr_b16 v[242:243], v7 offset:17408
    s_waitcnt lgkmcnt(6)
    v_mfma_f32_16x16x32_bf16 v[128:131], v[228:231], v[48:51], v[128:131]
    ds_read_b64_tr_b16 v[244:245], v8 offset:16416
    v_mfma_f32_16x16x32_bf16 v[132:135], v[228:231], v[52:55], v[132:135]
    ds_read_b64_tr_b16 v[246:247], v8 offset:17440
    s_waitcnt lgkmcnt(6)
    v_mfma_f32_16x16x32_bf16 v[136:139], v[232:235], v[48:51], v[136:139]
    ds_read_b64_tr_b16 v[224:225], v7 offset:16640
    v_mfma_f32_16x16x32_bf16 v[140:143], v[232:235], v[52:55], v[140:143]
    ds_read_b64_tr_b16 v[226:227], v7 offset:17664
    s_waitcnt lgkmcnt(6)
    v_mfma_f32_16x16x32_bf16 v[144:147], v[236:239], v[48:51], v[144:147]
    ds_read_b64_tr_b16 v[228:229], v8 offset:16672
    v_mfma_f32_16x16x32_bf16 v[148:151], v[236:239], v[52:55], v[148:151]
    ds_read_b64_tr_b16 v[230:231], v8 offset:17696
    s_waitcnt vmcnt(13) lgkmcnt(6)
    v_mfma_f32_16x16x32_bf16 v[88:91], v[240:243], v[56:59], v[88:91]
    ds_read_b64_tr_b16 v[232:233], v7 offset:16896
    s_waitcnt vmcnt(12)
    v_mfma_f32_16x16x32_bf16 v[92:95], v[240:243], v[60:63], v[92:95]
    ds_read_b64_tr_b16 v[234:235], v7 offset:17920
    s_waitcnt lgkmcnt(6)
    v_mfma_f32_16x16x32_bf16 v[96:99], v[244:247], v[56:59], v[96:99]
    ds_read_b64_tr_b16 v[236:237], v8 offset:16928
    v_mfma_f32_16x16x32_bf16 v[100:103], v[244:247], v[60:63], v[100:103]
    ds_read_b64_tr_b16 v[238:239], v8 offset:17952
    s_waitcnt lgkmcnt(6)
    v_mfma_f32_16x16x32_bf16 v[104:107], v[224:227], v[56:59], v[104:107]
    ds_read_b64_tr_b16 v[240:241], v7 offset:17152
    v_mfma_f32_16x16x32_bf16 v[108:111], v[224:227], v[60:63], v[108:111]
    ds_read_b64_tr_b16 v[242:243], v7 offset:18176
    s_waitcnt lgkmcnt(6)
    v_mfma_f32_16x16x32_bf16 v[112:115], v[228:231], v[56:59], v[112:115]
    ds_read_b64_tr_b16 v[244:245], v8 offset:17184
    v_mfma_f32_16x16x32_bf16 v[116:119], v[228:231], v[60:63], v[116:119]
    ds_read_b64_tr_b16 v[246:247], v8 offset:18208
    s_waitcnt lgkmcnt(6)
    v_mfma_f32_16x16x32_bf16 v[120:123], v[232:235], v[56:59], v[120:123]
    v_mfma_f32_16x16x32_bf16 v[124:127], v[232:235], v[60:63], v[124:127]
    s_waitcnt vmcnt(10)
    s_barrier
    ds_read_b64_tr_b16 v[224:225], v4 offset:0
    ds_read_b64_tr_b16 v[226:227], v4 offset:1024
    s_waitcnt lgkmcnt(6)
    v_mfma_f32_16x16x32_bf16 v[128:131], v[236:239], v[56:59], v[128:131]
    ds_read_b64_tr_b16 v[228:229], v5 offset:32
    v_mfma_f32_16x16x32_bf16 v[132:135], v[236:239], v[60:63], v[132:135]
    ds_read_b64_tr_b16 v[230:231], v5 offset:1056
    s_waitcnt lgkmcnt(6)
    v_mfma_f32_16x16x32_bf16 v[136:139], v[240:243], v[56:59], v[136:139]
    ds_read_b64_tr_b16 v[232:233], v4 offset:256
    v_mfma_f32_16x16x32_bf16 v[140:143], v[240:243], v[60:63], v[140:143]
    ds_read_b64_tr_b16 v[234:235], v4 offset:1280
    s_waitcnt lgkmcnt(6)
    v_mfma_f32_16x16x32_bf16 v[144:147], v[244:247], v[56:59], v[144:147]
    ds_read_b64_tr_b16 v[236:237], v5 offset:288
    v_mfma_f32_16x16x32_bf16 v[148:151], v[244:247], v[60:63], v[148:151]
    ds_read_b64_tr_b16 v[238:239], v5 offset:1312
    s_waitcnt vmcnt(9) lgkmcnt(6)
    v_mfma_f32_16x16x32_bf16 v[88:91], v[224:227], v[24:27], v[88:91]
    ds_read_b64_tr_b16 v[240:241], v4 offset:512
    s_waitcnt vmcnt(8)
    v_mfma_f32_16x16x32_bf16 v[92:95], v[224:227], v[28:31], v[92:95]
    ds_read_b64_tr_b16 v[242:243], v4 offset:1536
    s_waitcnt lgkmcnt(6)
    v_mfma_f32_16x16x32_bf16 v[96:99], v[228:231], v[24:27], v[96:99]
    ds_read_b64_tr_b16 v[244:245], v5 offset:544
    v_mfma_f32_16x16x32_bf16 v[100:103], v[228:231], v[28:31], v[100:103]
    ds_read_b64_tr_b16 v[246:247], v5 offset:1568
    s_waitcnt lgkmcnt(6)
    v_mfma_f32_16x16x32_bf16 v[104:107], v[232:235], v[24:27], v[104:107]
    ds_read_b64_tr_b16 v[224:225], v4 offset:768
    v_mfma_f32_16x16x32_bf16 v[108:111], v[232:235], v[28:31], v[108:111]
    ds_read_b64_tr_b16 v[226:227], v4 offset:1792
    s_waitcnt lgkmcnt(6)
    v_mfma_f32_16x16x32_bf16 v[112:115], v[236:239], v[24:27], v[112:115]
    ds_read_b64_tr_b16 v[228:229], v5 offset:800
    v_mfma_f32_16x16x32_bf16 v[116:119], v[236:239], v[28:31], v[116:119]
    ds_read_b64_tr_b16 v[230:231], v5 offset:1824
    s_waitcnt lgkmcnt(6)
    v_mfma_f32_16x16x32_bf16 v[120:123], v[240:243], v[24:27], v[120:123]
    v_mfma_f32_16x16x32_bf16 v[124:127], v[240:243], v[28:31], v[124:127]
    s_waitcnt vmcnt(2)
    s_barrier
    ds_read_b64_tr_b16 v[232:233], v4 offset:16384
    ds_read_b64_tr_b16 v[234:235], v4 offset:17408
    s_waitcnt lgkmcnt(6)
    v_mfma_f32_16x16x32_bf16 v[128:131], v[244:247], v[24:27], v[128:131]
    ds_read_b64_tr_b16 v[236:237], v5 offset:16416
    v_mfma_f32_16x16x32_bf16 v[132:135], v[244:247], v[28:31], v[132:135]
    ds_read_b64_tr_b16 v[238:239], v5 offset:17440
    s_waitcnt lgkmcnt(6)
    v_mfma_f32_16x16x32_bf16 v[136:139], v[224:227], v[24:27], v[136:139]
    ds_read_b64_tr_b16 v[240:241], v4 offset:16640
    v_mfma_f32_16x16x32_bf16 v[140:143], v[224:227], v[28:31], v[140:143]
    ds_read_b64_tr_b16 v[242:243], v4 offset:17664
    s_waitcnt lgkmcnt(6)
    v_mfma_f32_16x16x32_bf16 v[144:147], v[228:231], v[24:27], v[144:147]
    ds_read_b64_tr_b16 v[244:245], v5 offset:16672
    v_mfma_f32_16x16x32_bf16 v[148:151], v[228:231], v[28:31], v[148:151]
    ds_read_b64_tr_b16 v[246:247], v5 offset:17696
    s_waitcnt vmcnt(1) lgkmcnt(6)
    v_mfma_f32_16x16x32_bf16 v[88:91], v[232:235], v[32:35], v[88:91]
    ds_read_b64_tr_b16 v[224:225], v4 offset:16896
    s_waitcnt vmcnt(0)
    v_mfma_f32_16x16x32_bf16 v[92:95], v[232:235], v[36:39], v[92:95]
    ds_read_b64_tr_b16 v[226:227], v4 offset:17920
    s_waitcnt lgkmcnt(6)
    v_mfma_f32_16x16x32_bf16 v[96:99], v[236:239], v[32:35], v[96:99]
    ds_read_b64_tr_b16 v[228:229], v5 offset:16928
    v_mfma_f32_16x16x32_bf16 v[100:103], v[236:239], v[36:39], v[100:103]
    ds_read_b64_tr_b16 v[230:231], v5 offset:17952
    s_waitcnt lgkmcnt(6)
    v_mfma_f32_16x16x32_bf16 v[104:107], v[240:243], v[32:35], v[104:107]
    ds_read_b64_tr_b16 v[232:233], v4 offset:17152
    v_mfma_f32_16x16x32_bf16 v[108:111], v[240:243], v[36:39], v[108:111]
    ds_read_b64_tr_b16 v[234:235], v4 offset:18176
    s_waitcnt lgkmcnt(6)
    v_mfma_f32_16x16x32_bf16 v[112:115], v[244:247], v[32:35], v[112:115]
    ds_read_b64_tr_b16 v[236:237], v5 offset:17184
    v_mfma_f32_16x16x32_bf16 v[116:119], v[244:247], v[36:39], v[116:119]
    ds_read_b64_tr_b16 v[238:239], v5 offset:18208
    s_waitcnt lgkmcnt(6)
    v_mfma_f32_16x16x32_bf16 v[120:123], v[224:227], v[32:35], v[120:123]
    v_mfma_f32_16x16x32_bf16 v[124:127], v[224:227], v[36:39], v[124:127]
    s_waitcnt lgkmcnt(4)
    v_mfma_f32_16x16x32_bf16 v[128:131], v[228:231], v[32:35], v[128:131]
    v_mfma_f32_16x16x32_bf16 v[132:135], v[228:231], v[36:39], v[132:135]
    s_waitcnt lgkmcnt(2)
    v_mfma_f32_16x16x32_bf16 v[136:139], v[232:235], v[32:35], v[136:139]
    v_mfma_f32_16x16x32_bf16 v[140:143], v[232:235], v[36:39], v[140:143]
    s_waitcnt lgkmcnt(0)
    v_mfma_f32_16x16x32_bf16 v[144:147], v[236:239], v[32:35], v[144:147]
    v_mfma_f32_16x16x32_bf16 v[148:151], v[236:239], v[36:39], v[148:151]
    s_lshl_b32 s16, s3, 13
    s_xor_b32 s17, s16, 0x8000
    s_add_u32 s16, s16, 0x18000
    s_add_u32 s17, s17, 0x18000
    v_add_u32 v16, s16, v2
    s_mov_b32 s16, s17
    v_add_u32 v17, s16, v2
    ds_write_b128 v16, v[120:123] offset:0
    ds_write_b128 v16, v[124:127] offset:1024
    ds_write_b128 v16, v[128:131] offset:2048
    ds_write_b128 v16, v[132:135] offset:3072
    ds_write_b128 v16, v[136:139] offset:4096
    ds_write_b128 v16, v[140:143] offset:5120
    ds_write_b128 v16, v[144:147] offset:6144
    ds_write_b128 v16, v[148:151] offset:7168
    v_lshlrev_b32 v24, 16, v248
    v_and_b32 v25, 0xffff0000, v248
    v_lshlrev_b32 v26, 16, v249
    v_and_b32 v27, 0xffff0000, v249
    v_lshlrev_b32 v28, 16, v250
    v_and_b32 v29, 0xffff0000, v250
    v_lshlrev_b32 v30, 16, v251
    v_and_b32 v31, 0xffff0000, v251
    v_lshlrev_b32 v32, 16, v252
    v_and_b32 v33, 0xffff0000, v252
    v_lshlrev_b32 v34, 16, v253
    v_and_b32 v35, 0xffff0000, v253
    v_lshlrev_b32 v36, 16, v254
    v_and_b32 v37, 0xffff0000, v254
    v_lshlrev_b32 v38, 16, v255
    v_and_b32 v39, 0xffff0000, v255
    v_and_b32 v18, 15, v1
    v_lshlrev_b32 v18, 6, v18
    v_lshrrev_b32 v19, 4, v1
    v_and_b32 v20, 1, v19
    v_lshl_add_u32 v18, v20, 5, v18
    v_lshrrev_b32 v19, 1, v19
    v_lshl_add_u32 v18, v19, 4, v18
    s_and_b32 s17, s3, 3
    s_lshl_b32 s18, s30, 2
    s_add_u32 s18, s18, s17
    s_lshl_b32 s18, s18, 16
    s_lshl_b32 s19, s15, 22
    s_add_u32 s18, s18, s19
    s_lshl_b32 s19, s31, 12
    s_add_u32 s18, s18, s19
    s_add_u32 s18, s18, 0x2c00000
    s_add_u32 s19, s18, 32768
    s_waitcnt lgkmcnt(0)
    s_barrier
    ds_read_b128 v[40:43], v17 offset:0
    ds_read_b128 v[44:47], v17 offset:1024
    ds_read_b128 v[48:51], v17 offset:2048
    ds_read_b128 v[52:55], v17 offset:3072
    ds_read_b128 v[56:59], v17 offset:4096
    ds_read_b128 v[60:63], v17 offset:5120
    ds_read_b128 v[64:67], v17 offset:6144
    ds_read_b128 v[68:71], v17 offset:7168
    s_waitcnt lgkmcnt(7)
    v_pk_add_f32 v[88:89], v[88:89], v[40:41]
    v_pk_add_f32 v[90:91], v[90:91], v[42:43]
    v_pk_mul_f32 v[88:89], v[88:89], v[24:25]
    v_pk_mul_f32 v[90:91], v[90:91], v[26:27]
    v_cvt_pk_bf16_f32 v224, v88, v89
    v_cvt_pk_bf16_f32 v225, v90, v91
    s_waitcnt lgkmcnt(5)
    v_pk_add_f32 v[96:97], v[96:97], v[48:49]
    v_pk_add_f32 v[98:99], v[98:99], v[50:51]
    v_pk_mul_f32 v[96:97], v[96:97], v[28:29]
    v_pk_mul_f32 v[98:99], v[98:99], v[30:31]
    v_cvt_pk_bf16_f32 v226, v96, v97
    v_cvt_pk_bf16_f32 v227, v98, v99
    s_nop 0
    v_permlane16_swap_b32 v224, v226
    v_permlane16_swap_b32 v225, v227
    buffer_store_dwordx4 v[224:227], v18, s[8:11], s18 offen offset:0 sc1
    v_pk_add_f32 v[92:93], v[92:93], v[44:45]
    v_pk_add_f32 v[94:95], v[94:95], v[46:47]
    v_pk_mul_f32 v[92:93], v[92:93], v[24:25]
    v_pk_mul_f32 v[94:95], v[94:95], v[26:27]
    v_cvt_pk_bf16_f32 v228, v92, v93
    v_cvt_pk_bf16_f32 v229, v94, v95
    s_waitcnt lgkmcnt(4)
    v_pk_add_f32 v[100:101], v[100:101], v[52:53]
    v_pk_add_f32 v[102:103], v[102:103], v[54:55]
    v_pk_mul_f32 v[100:101], v[100:101], v[28:29]
    v_pk_mul_f32 v[102:103], v[102:103], v[30:31]
    v_cvt_pk_bf16_f32 v230, v100, v101
    v_cvt_pk_bf16_f32 v231, v102, v103
    s_nop 0
    v_permlane16_swap_b32 v228, v230
    v_permlane16_swap_b32 v229, v231
    buffer_store_dwordx4 v[228:231], v18, s[8:11], s19 offen offset:0 sc1
    s_waitcnt lgkmcnt(3)
    v_pk_add_f32 v[104:105], v[104:105], v[56:57]
    v_pk_add_f32 v[106:107], v[106:107], v[58:59]
    v_pk_mul_f32 v[104:105], v[104:105], v[32:33]
    v_pk_mul_f32 v[106:107], v[106:107], v[34:35]
    v_cvt_pk_bf16_f32 v232, v104, v105
    v_cvt_pk_bf16_f32 v233, v106, v107
    s_waitcnt lgkmcnt(1)
    v_pk_add_f32 v[112:113], v[112:113], v[64:65]
    v_pk_add_f32 v[114:115], v[114:115], v[66:67]
    v_pk_mul_f32 v[112:113], v[112:113], v[36:37]
    v_pk_mul_f32 v[114:115], v[114:115], v[38:39]
    v_cvt_pk_bf16_f32 v234, v112, v113
    v_cvt_pk_bf16_f32 v235, v114, v115
    s_nop 0
    v_permlane16_swap_b32 v232, v234
    v_permlane16_swap_b32 v233, v235
    buffer_store_dwordx4 v[232:235], v18, s[8:11], s18 offen offset:1024 sc1
    v_pk_add_f32 v[108:109], v[108:109], v[60:61]
    v_pk_add_f32 v[110:111], v[110:111], v[62:63]
    v_pk_mul_f32 v[108:109], v[108:109], v[32:33]
    v_pk_mul_f32 v[110:111], v[110:111], v[34:35]
    v_cvt_pk_bf16_f32 v236, v108, v109
    v_cvt_pk_bf16_f32 v237, v110, v111
    s_waitcnt lgkmcnt(0)
    v_pk_add_f32 v[116:117], v[116:117], v[68:69]
    v_pk_add_f32 v[118:119], v[118:119], v[70:71]
    v_pk_mul_f32 v[116:117], v[116:117], v[36:37]
    v_pk_mul_f32 v[118:119], v[118:119], v[38:39]
    v_cvt_pk_bf16_f32 v238, v116, v117
    v_cvt_pk_bf16_f32 v239, v118, v119
    s_nop 0
    v_permlane16_swap_b32 v236, v238
    v_permlane16_swap_b32 v237, v239
    buffer_store_dwordx4 v[236:239], v18, s[8:11], s19 offen offset:1024 sc1
    s_mov_b64 s[64:65], s[44:45]
    s_mov_b32 s66, 0x800
    s_mov_b32 s67, 0x20000
    s_mov_b64 s[76:77], s[32:33]
    s_mov_b32 s78, 0x400000
    s_mov_b32 s79, 0x20000
    s_mov_b64 s[68:69], s[56:57]
    s_mov_b32 s70, 0x400000
    s_mov_b32 s71, 0x20000
    s_lshl_b32 s14, s31, 1
    s_add_u32 s14, s14, s15
    s_lshl_b32 s14, s14, 3
    s_add_u32 s14, s14, s3
    s_lshl_b32 s16, s30, 7
    s_add_u32 s14, s14, s16
    s_lshl_b32 s16, s14, 11
    buffer_load_dwordx4 v[216:219], v2, s[76:79], s16 offen offset:0
    buffer_load_dwordx4 v[220:223], v2, s[76:79], s16 offen offset:1024
    s_lshl_b32 s16, s3, 10
    s_add_u32 m0, s16, 81920
    s_add_u32 s16, s16, 0x540800
    buffer_load_dwordx4 v2, s[8:11], s16 offen sc1 lds
    s_lshl_b32 s16, s30, 5
    s_lshl_b32 s17, s31, 1
    s_add_u32 s16, s16, s17
    s_add_u32 s16, s16, s15
    s_lshl_b32 s16, s16, 2
    s_add_u32 s16, s16, 0x530000
    s_cmp_eq_u32 s3, 0
    s_cselect_b32 s16, s16, 0x7ffffff0
    v_mov_b32 v16, s28
    v_mov_b32 v17, 0
    s_lshr_b32 s18, s14, 4
    s_lshl_b32 s18, s18, 15
    s_and_b32 s19, s14, 15
    s_lshl_b32 s19, s19, 6
    s_add_u32 s18, s18, s19
    s_add_u32 s18, s18, 0x2c00000
    s_add_u32 s19, s18, 16384
    v_lshrrev_b32 v18, 2, v1
    v_lshlrev_b32 v18, 10, v18
    v_and_b32 v19, 3, v1
    v_lshl_add_u32 v18, v19, 4, v18
    v_add_u32 v19, 0x400000, v18
    s_lshl_b32 s25, s30, 7
    s_add_u32 s25, s25, 0x530000
    v_and_b32 v20, 15, v1
    v_lshlrev_b32 v20, 2, v20
    s_waitcnt vmcnt(3)
    s_waitcnt vmcnt(0)
    s_barrier
    s_mov_b64 exec, 1
    buffer_store_dword v16, v17, s[8:11], s16 offen sc1
    s_mov_b64 exec, -1
    v_add_u32 v16, 81920, v2
    ds_read_b128 v[184:187], v16 offset:0
    ds_read_b128 v[188:191], v16 offset:1024
    ds_read_b128 v[192:195], v16 offset:2048
    ds_read_b128 v[196:199], v16 offset:3072
    ds_read_b128 v[200:203], v16 offset:4096
    ds_read_b128 v[204:207], v16 offset:5120
    ds_read_b128 v[208:211], v16 offset:6144
    ds_read_b128 v[212:215], v16 offset:7168
    v_mov_b32 v94, 0
    v_mov_b32 v95, 0
    s_waitcnt lgkmcnt(5)
    v_lshlrev_b32 v76, 16, v192
    v_and_b32 v77, 0xffff0000, v192
    s_waitcnt lgkmcnt(1)
    v_lshlrev_b32 v78, 16, v208
    v_and_b32 v79, 0xffff0000, v208
    v_pk_mul_f32 v[60:61], v[76:77], v[78:79]
    v_lshlrev_b32 v76, 16, v184
    v_and_b32 v77, 0xffff0000, v184
    v_fmac_f32 v94, v76, v78
    v_fmac_f32 v94, v77, v79
    v_add_f32 v95, v95, v60
    v_add_f32 v95, v95, v61
    v_lshlrev_b32 v76, 16, v193
    v_and_b32 v77, 0xffff0000, v193
    v_lshlrev_b32 v78, 16, v209
    v_and_b32 v79, 0xffff0000, v209
    v_pk_mul_f32 v[62:63], v[76:77], v[78:79]
    v_lshlrev_b32 v76, 16, v185
    v_and_b32 v77, 0xffff0000, v185
    v_fmac_f32 v94, v76, v78
    v_fmac_f32 v94, v77, v79
    v_add_f32 v95, v95, v62
    v_add_f32 v95, v95, v63
    v_lshlrev_b32 v76, 16, v194
    v_and_b32 v77, 0xffff0000, v194
    v_lshlrev_b32 v78, 16, v210
    v_and_b32 v79, 0xffff0000, v210
    v_pk_mul_f32 v[64:65], v[76:77], v[78:79]
    v_lshlrev_b32 v76, 16, v186
    v_and_b32 v77, 0xffff0000, v186
    v_fmac_f32 v94, v76, v78
    v_fmac_f32 v94, v77, v79
    v_add_f32 v95, v95, v64
    v_add_f32 v95, v95, v65
    v_lshlrev_b32 v76, 16, v195
    v_and_b32 v77, 0xffff0000, v195
    v_lshlrev_b32 v78, 16, v211
    v_and_b32 v79, 0xffff0000, v211
    v_pk_mul_f32 v[66:67], v[76:77], v[78:79]
    v_lshlrev_b32 v76, 16, v187
    v_and_b32 v77, 0xffff0000, v187
    v_fmac_f32 v94, v76, v78
    v_fmac_f32 v94, v77, v79
    v_add_f32 v95, v95, v66
    v_add_f32 v95, v95, v67
    v_lshlrev_b32 v76, 16, v196
    v_and_b32 v77, 0xffff0000, v196
    s_waitcnt lgkmcnt(0)
    v_lshlrev_b32 v78, 16, v212
    v_and_b32 v79, 0xffff0000, v212
    v_pk_mul_f32 v[68:69], v[76:77], v[78:79]
    v_lshlrev_b32 v76, 16, v188
    v_and_b32 v77, 0xffff0000, v188
    v_fmac_f32 v94, v76, v78
    v_fmac_f32 v94, v77, v79
    v_add_f32 v95, v95, v68
    v_add_f32 v95, v95, v69
    v_lshlrev_b32 v76, 16, v197
    v_and_b32 v77, 0xffff0000, v197
    v_lshlrev_b32 v78, 16, v213
    v_and_b32 v79, 0xffff0000, v213
    v_pk_mul_f32 v[70:71], v[76:77], v[78:79]
    v_lshlrev_b32 v76, 16, v189
    v_and_b32 v77, 0xffff0000, v189
    v_fmac_f32 v94, v76, v78
    v_fmac_f32 v94, v77, v79
    v_add_f32 v95, v95, v70
    v_add_f32 v95, v95, v71
    v_lshlrev_b32 v76, 16, v198
    v_and_b32 v77, 0xffff0000, v198
    v_lshlrev_b32 v78, 16, v214
    v_and_b32 v79, 0xffff0000, v214
    v_pk_mul_f32 v[72:73], v[76:77], v[78:79]
    v_lshlrev_b32 v76, 16, v190
    v_and_b32 v77, 0xffff0000, v190
    v_fmac_f32 v94, v76, v78
    v_fmac_f32 v94, v77, v79
    v_add_f32 v95, v95, v72
    v_add_f32 v95, v95, v73
    v_lshlrev_b32 v76, 16, v199
    v_and_b32 v77, 0xffff0000, v199
    v_lshlrev_b32 v78, 16, v215
    v_and_b32 v79, 0xffff0000, v215
    v_pk_mul_f32 v[74:75], v[76:77], v[78:79]
    v_lshlrev_b32 v76, 16, v191
    v_and_b32 v77, 0xffff0000, v191
    v_fmac_f32 v94, v76, v78
    v_fmac_f32 v94, v77, v79
    v_add_f32 v95, v95, v74
    v_add_f32 v95, v95, v75
    v_add_f32_dpp v94, v94, v94 row_ror:1 row_mask:0xf bank_mask:0xf
    s_nop 0
    v_add_f32_dpp v95, v95, v95 row_ror:1 row_mask:0xf bank_mask:0xf
    v_add_f32_dpp v94, v94, v94 row_ror:2 row_mask:0xf bank_mask:0xf
    s_nop 0
    v_add_f32_dpp v95, v95, v95 row_ror:2 row_mask:0xf bank_mask:0xf
    v_add_f32_dpp v94, v94, v94 row_ror:4 row_mask:0xf bank_mask:0xf
    s_nop 0
    v_add_f32_dpp v95, v95, v95 row_ror:4 row_mask:0xf bank_mask:0xf
    v_add_f32_dpp v94, v94, v94 row_ror:8 row_mask:0xf bank_mask:0xf
    s_nop 0
    v_add_f32_dpp v95, v95, v95 row_ror:8 row_mask:0xf bank_mask:0xf
    v_mov_b32 v76, v94
    s_nop 1
    v_permlane16_swap_b32 v94, v76
    v_add_f32 v94, v94, v76
    v_mov_b32 v77, v95
    s_nop 1
    v_permlane16_swap_b32 v95, v77
    v_add_f32 v95, v95, v77
    v_mov_b32 v76, v94
    s_nop 1
    v_permlane32_swap_b32 v94, v76
    v_add_f32 v94, v94, v76
    v_mov_b32 v77, v95
    s_nop 1
    v_permlane32_swap_b32 v95, v77
    v_add_f32 v95, v95, v77
    v_lshlrev_b32 v28, 16, v216
    v_and_b32 v29, 0xffff0000, v216
    v_lshlrev_b32 v30, 16, v217
    v_and_b32 v31, 0xffff0000, v217
    v_lshlrev_b32 v32, 16, v218
    v_and_b32 v33, 0xffff0000, v218
    v_lshlrev_b32 v34, 16, v219
    v_and_b32 v35, 0xffff0000, v219
    v_lshlrev_b32 v36, 16, v220
    v_and_b32 v37, 0xffff0000, v220
    v_lshlrev_b32 v38, 16, v221
    v_and_b32 v39, 0xffff0000, v221
    v_lshlrev_b32 v40, 16, v222
    v_and_b32 v41, 0xffff0000, v222
    v_lshlrev_b32 v42, 16, v223
    v_and_b32 v43, 0xffff0000, v223
    s_sleep 16
    s_mov_b32 s27, 0
adaLN_cond__sliding_block_cached__moe_arch_mod__prompt_kernel_a11p:
    buffer_load_dword v76, v20, s[8:11], s25 offen sc1
    s_waitcnt vmcnt(0)
    v_cmp_ne_u32 vcc, s28, v76
    s_add_u32 s27, s27, 1
    s_cmp_ge_u32 s27, 262144
    s_cbranch_scc1 adaLN_cond__sliding_block_cached__moe_arch_mod__prompt_kernel_a11g
    s_cbranch_vccnz adaLN_cond__sliding_block_cached__moe_arch_mod__prompt_kernel_a11p
adaLN_cond__sliding_block_cached__moe_arch_mod__prompt_kernel_a11g:
    buffer_load_dwordx4 v[44:47], v18, s[8:11], s18 offen sc1
    buffer_load_dwordx4 v[52:55], v19, s[8:11], s18 offen sc1
    buffer_load_dwordx4 v[48:51], v18, s[8:11], s19 offen sc1
    buffer_load_dwordx4 v[56:59], v19, s[8:11], s19 offen sc1
    v_lshlrev_b32 v21, 2, v0
    s_mov_b32 s16, 0x540800
    buffer_load_dword v106, v21, s[8:11], s16 offen sc1
    buffer_load_dword v104, v21, s[8:11], s16 offen offset:2048 sc1
    s_waitcnt vmcnt(5)
    v_lshlrev_b32 v76, 16, v44
    v_and_b32 v77, 0xffff0000, v44
    s_waitcnt vmcnt(4)
    v_lshlrev_b32 v78, 16, v52
    v_and_b32 v79, 0xffff0000, v52
    v_pk_add_f32 v[76:77], v[76:77], v[78:79]
    v_pk_add_f32 v[28:29], v[28:29], v[76:77]
    v_cvt_pk_bf16_f32 v16, v28, v29
    v_lshlrev_b32 v28, 16, v16
    v_and_b32 v29, 0xffff0000, v16
    v_lshlrev_b32 v80, 16, v45
    v_and_b32 v81, 0xffff0000, v45
    v_lshlrev_b32 v82, 16, v53
    v_and_b32 v83, 0xffff0000, v53
    v_pk_add_f32 v[80:81], v[80:81], v[82:83]
    v_pk_add_f32 v[30:31], v[30:31], v[80:81]
    v_cvt_pk_bf16_f32 v17, v30, v31
    v_lshlrev_b32 v30, 16, v17
    v_and_b32 v31, 0xffff0000, v17
    v_lshlrev_b32 v76, 16, v46
    v_and_b32 v77, 0xffff0000, v46
    v_lshlrev_b32 v78, 16, v54
    v_and_b32 v79, 0xffff0000, v54
    v_pk_add_f32 v[76:77], v[76:77], v[78:79]
    v_pk_add_f32 v[32:33], v[32:33], v[76:77]
    v_cvt_pk_bf16_f32 v16, v32, v33
    v_lshlrev_b32 v32, 16, v16
    v_and_b32 v33, 0xffff0000, v16
    v_lshlrev_b32 v80, 16, v47
    v_and_b32 v81, 0xffff0000, v47
    v_lshlrev_b32 v82, 16, v55
    v_and_b32 v83, 0xffff0000, v55
    v_pk_add_f32 v[80:81], v[80:81], v[82:83]
    v_pk_add_f32 v[34:35], v[34:35], v[80:81]
    v_cvt_pk_bf16_f32 v17, v34, v35
    v_lshlrev_b32 v34, 16, v17
    v_and_b32 v35, 0xffff0000, v17
    s_waitcnt vmcnt(3)
    v_lshlrev_b32 v76, 16, v48
    v_and_b32 v77, 0xffff0000, v48
    s_waitcnt vmcnt(2)
    v_lshlrev_b32 v78, 16, v56
    v_and_b32 v79, 0xffff0000, v56
    v_pk_add_f32 v[76:77], v[76:77], v[78:79]
    v_pk_add_f32 v[36:37], v[36:37], v[76:77]
    v_cvt_pk_bf16_f32 v16, v36, v37
    v_lshlrev_b32 v36, 16, v16
    v_and_b32 v37, 0xffff0000, v16
    v_lshlrev_b32 v80, 16, v49
    v_and_b32 v81, 0xffff0000, v49
    v_lshlrev_b32 v82, 16, v57
    v_and_b32 v83, 0xffff0000, v57
    v_pk_add_f32 v[80:81], v[80:81], v[82:83]
    v_pk_add_f32 v[38:39], v[38:39], v[80:81]
    v_cvt_pk_bf16_f32 v17, v38, v39
    v_lshlrev_b32 v38, 16, v17
    v_and_b32 v39, 0xffff0000, v17
    v_lshlrev_b32 v76, 16, v50
    v_and_b32 v77, 0xffff0000, v50
    v_lshlrev_b32 v78, 16, v58
    v_and_b32 v79, 0xffff0000, v58
    v_pk_add_f32 v[76:77], v[76:77], v[78:79]
    v_pk_add_f32 v[40:41], v[40:41], v[76:77]
    v_cvt_pk_bf16_f32 v16, v40, v41
    v_lshlrev_b32 v40, 16, v16
    v_and_b32 v41, 0xffff0000, v16
    v_lshlrev_b32 v80, 16, v51
    v_and_b32 v81, 0xffff0000, v51
    v_lshlrev_b32 v82, 16, v59
    v_and_b32 v83, 0xffff0000, v59
    v_pk_add_f32 v[80:81], v[80:81], v[82:83]
    v_pk_add_f32 v[42:43], v[42:43], v[80:81]
    v_cvt_pk_bf16_f32 v17, v42, v43
    v_lshlrev_b32 v42, 16, v17
    v_and_b32 v43, 0xffff0000, v17
    v_pk_add_f32 v[76:77], v[28:29], v[30:31]
    v_pk_mul_f32 v[78:79], v[28:29], v[28:29]
    v_pk_mul_f32 v[80:81], v[28:29], v[60:61]
    v_pk_fma_f32 v[78:79], v[30:31], v[30:31], v[78:79]
    v_pk_fma_f32 v[80:81], v[30:31], v[62:63], v[80:81]
    v_pk_add_f32 v[76:77], v[76:77], v[32:33]
    v_pk_fma_f32 v[78:79], v[32:33], v[32:33], v[78:79]
    v_pk_fma_f32 v[80:81], v[32:33], v[64:65], v[80:81]
    v_pk_add_f32 v[76:77], v[76:77], v[34:35]
    v_pk_fma_f32 v[78:79], v[34:35], v[34:35], v[78:79]
    v_pk_fma_f32 v[80:81], v[34:35], v[66:67], v[80:81]
    v_pk_add_f32 v[76:77], v[76:77], v[36:37]
    v_pk_fma_f32 v[78:79], v[36:37], v[36:37], v[78:79]
    v_pk_fma_f32 v[80:81], v[36:37], v[68:69], v[80:81]
    v_pk_add_f32 v[76:77], v[76:77], v[38:39]
    v_pk_fma_f32 v[78:79], v[38:39], v[38:39], v[78:79]
    v_pk_fma_f32 v[80:81], v[38:39], v[70:71], v[80:81]
    v_pk_add_f32 v[76:77], v[76:77], v[40:41]
    v_pk_fma_f32 v[78:79], v[40:41], v[40:41], v[78:79]
    v_pk_fma_f32 v[80:81], v[40:41], v[72:73], v[80:81]
    v_pk_add_f32 v[76:77], v[76:77], v[42:43]
    v_pk_fma_f32 v[78:79], v[42:43], v[42:43], v[78:79]
    v_pk_fma_f32 v[80:81], v[42:43], v[74:75], v[80:81]
    v_add_f32 v96, v76, v77
    v_add_f32 v97, v78, v79
    v_add_f32 v98, v80, v81
    v_add_f32_dpp v96, v96, v96 row_ror:1 row_mask:0xf bank_mask:0xf
    v_add_f32_dpp v97, v97, v97 row_ror:1 row_mask:0xf bank_mask:0xf
    v_add_f32_dpp v98, v98, v98 row_ror:1 row_mask:0xf bank_mask:0xf
    v_add_f32_dpp v96, v96, v96 row_ror:2 row_mask:0xf bank_mask:0xf
    v_add_f32_dpp v97, v97, v97 row_ror:2 row_mask:0xf bank_mask:0xf
    v_add_f32_dpp v98, v98, v98 row_ror:2 row_mask:0xf bank_mask:0xf
    v_add_f32_dpp v96, v96, v96 row_ror:4 row_mask:0xf bank_mask:0xf
    v_add_f32_dpp v97, v97, v97 row_ror:4 row_mask:0xf bank_mask:0xf
    v_add_f32_dpp v98, v98, v98 row_ror:4 row_mask:0xf bank_mask:0xf
    v_add_f32_dpp v96, v96, v96 row_ror:8 row_mask:0xf bank_mask:0xf
    v_add_f32_dpp v97, v97, v97 row_ror:8 row_mask:0xf bank_mask:0xf
    v_add_f32_dpp v98, v98, v98 row_ror:8 row_mask:0xf bank_mask:0xf
    v_mov_b32 v76, v96
    s_nop 1
    v_permlane16_swap_b32 v96, v76
    v_add_f32 v96, v96, v76
    v_mov_b32 v77, v97
    s_nop 1
    v_permlane16_swap_b32 v97, v77
    v_add_f32 v97, v97, v77
    v_mov_b32 v78, v98
    s_nop 1
    v_permlane16_swap_b32 v98, v78
    v_add_f32 v98, v98, v78
    v_mov_b32 v76, v96
    s_nop 1
    v_permlane32_swap_b32 v96, v76
    v_add_f32 v96, v96, v76
    v_mov_b32 v77, v97
    s_nop 1
    v_permlane32_swap_b32 v97, v77
    v_add_f32 v97, v97, v77
    v_mov_b32 v78, v98
    s_nop 1
    v_permlane32_swap_b32 v98, v78
    v_add_f32 v98, v98, v78
    v_mul_f32 v96, 0x3a800000, v96
    v_mul_f32 v97, 0x3a800000, v97
    v_fma_f32 v97, -v96, v96, v97
    v_max_f32 v97, 0, v97
    v_fma_f32 v98, -v96, v95, v98
    v_add_f32 v76, 0x3727c5ac, v97
    v_rsq_f32 v76, v76
    s_nop 0
    v_fma_f32 v27, v98, v76, v94
    v_cvt_pk_bf16_f32 v96, v96, v96
    v_lshlrev_b32 v96, 16, v96
    v_cvt_pk_bf16_f32 v97, v97, v97
    v_lshlrev_b32 v97, 16, v97
    v_add_f32 v97, 0x3727c5ac, v97
    v_cvt_pk_bf16_f32 v97, v97, v97
    v_lshlrev_b32 v97, 16, v97
    v_sqrt_f32 v98, v97
    s_nop 0
    v_cvt_pk_bf16_f32 v98, v98, v98
    v_lshlrev_b32 v98, 16, v98
    v_rcp_f32 v99, v98
    v_mov_b32 v25, v96
    v_mov_b32 v26, v98
    v_ashrrev_i32 v16, 31, v27
    v_or_b32 v16, 0x80000000, v16
    v_xor_b32 v24, v27, v16
    v_and_b32 v24, 0xfffff800, v24
    v_max_u32 v24, 0x800, v24
    s_sub_u32 s16, 2047, s14
    v_or_b32 v24, s16, v24
    s_lshl_b32 s16, s3, 4
    s_add_u32 s16, s16, 65536
    v_mov_b32 v16, s16
    ds_write_b128 v16, v[24:27]
    s_waitcnt lgkmcnt(0)
    s_barrier
    v_and_b32 v16, 7, v1
    v_lshlrev_b32 v16, 4, v16
    v_add_u32 v16, 65536, v16
    ds_read_b32 v76, v16
    s_waitcnt lgkmcnt(0)
    v_mov_b32 v77, v76
    s_nop 1
    v_max_u32_dpp v77, v77, v77 row_ror:1 row_mask:0xf bank_mask:0xf
    s_nop 1
    v_max_u32_dpp v77, v77, v77 row_ror:2 row_mask:0xf bank_mask:0xf
    s_nop 1
    v_max_u32_dpp v77, v77, v77 row_ror:4 row_mask:0xf bank_mask:0xf
    v_cmp_eq_u32 vcc, v76, v77
    s_ff1_i32_b64 s16, vcc
    s_lshl_b32 s16, s16, 4
    s_add_u32 s16, s16, 65536
    v_mov_b32 v16, s16
    ds_read_b128 v[24:27], v16
    s_lshl_b32 s16, s2, 4
    s_add_u32 s16, s16, 0x6e0000
    s_cmp_eq_u32 s3, 0
    s_cselect_b32 s16, s16, 0x7ffffff0
    v_mov_b32 v17, 0
    s_mov_b64 exec, 1
    s_waitcnt lgkmcnt(0)
    buffer_store_dwordx4 v[24:27], v17, s[8:11], s16 offen sc1
    s_mov_b64 exec, -1
    v_sub_f32 v44, v28, v96
    v_sub_f32 v45, v29, v96
    v_sub_f32 v46, v30, v96
    v_sub_f32 v47, v31, v96
    v_sub_f32 v48, v32, v96
    v_sub_f32 v49, v33, v96
    v_sub_f32 v50, v34, v96
    v_sub_f32 v51, v35, v96
    v_cvt_pk_bf16_f32 v16, v44, v45
    v_lshlrev_b32 v44, 16, v16
    v_and_b32 v45, 0xffff0000, v16
    v_cvt_pk_bf16_f32 v16, v46, v47
    v_lshlrev_b32 v46, 16, v16
    v_and_b32 v47, 0xffff0000, v16
    v_cvt_pk_bf16_f32 v16, v48, v49
    v_lshlrev_b32 v48, 16, v16
    v_and_b32 v49, 0xffff0000, v16
    v_cvt_pk_bf16_f32 v16, v50, v51
    v_lshlrev_b32 v50, 16, v16
    v_and_b32 v51, 0xffff0000, v16
    v_mul_f32 v52, v44, v99
    v_mul_f32 v53, v45, v99
    v_mul_f32 v54, v46, v99
    v_mul_f32 v55, v47, v99
    v_mul_f32 v56, v48, v99
    v_mul_f32 v57, v49, v99
    v_mul_f32 v58, v50, v99
    v_mul_f32 v59, v51, v99
    v_fma_f32 v44, -v52, v98, v44
    v_fma_f32 v45, -v53, v98, v45
    v_fma_f32 v46, -v54, v98, v46
    v_fma_f32 v47, -v55, v98, v47
    v_fma_f32 v48, -v56, v98, v48
    v_fma_f32 v49, -v57, v98, v49
    v_fma_f32 v50, -v58, v98, v50
    v_fma_f32 v51, -v59, v98, v51
    v_fma_f32 v44, v44, v99, v52
    v_fma_f32 v45, v45, v99, v53
    v_fma_f32 v46, v46, v99, v54
    v_fma_f32 v47, v47, v99, v55
    v_fma_f32 v48, v48, v99, v56
    v_fma_f32 v49, v49, v99, v57
    v_fma_f32 v50, v50, v99, v58
    v_fma_f32 v51, v51, v99, v59
    v_cvt_pk_bf16_f32 v16, v44, v45
    v_lshlrev_b32 v44, 16, v16
    v_and_b32 v45, 0xffff0000, v16
    v_cvt_pk_bf16_f32 v16, v46, v47
    v_lshlrev_b32 v46, 16, v16
    v_and_b32 v47, 0xffff0000, v16
    v_cvt_pk_bf16_f32 v16, v48, v49
    v_lshlrev_b32 v48, 16, v16
    v_and_b32 v49, 0xffff0000, v16
    v_cvt_pk_bf16_f32 v16, v50, v51
    v_lshlrev_b32 v50, 16, v16
    v_and_b32 v51, 0xffff0000, v16
    v_lshlrev_b32 v52, 16, v192
    v_and_b32 v53, 0xffff0000, v192
    v_lshlrev_b32 v54, 16, v193
    v_and_b32 v55, 0xffff0000, v193
    v_lshlrev_b32 v56, 16, v194
    v_and_b32 v57, 0xffff0000, v194
    v_lshlrev_b32 v58, 16, v195
    v_and_b32 v59, 0xffff0000, v195
    v_pk_mul_f32 v[44:45], v[44:45], v[52:53]
    v_pk_mul_f32 v[46:47], v[46:47], v[54:55]
    v_pk_mul_f32 v[48:49], v[48:49], v[56:57]
    v_pk_mul_f32 v[50:51], v[50:51], v[58:59]
    v_cvt_pk_bf16_f32 v16, v44, v45
    v_lshlrev_b32 v44, 16, v16
    v_and_b32 v45, 0xffff0000, v16
    v_cvt_pk_bf16_f32 v16, v46, v47
    v_lshlrev_b32 v46, 16, v16
    v_and_b32 v47, 0xffff0000, v16
    v_cvt_pk_bf16_f32 v16, v48, v49
    v_lshlrev_b32 v48, 16, v16
    v_and_b32 v49, 0xffff0000, v16
    v_cvt_pk_bf16_f32 v16, v50, v51
    v_lshlrev_b32 v50, 16, v16
    v_and_b32 v51, 0xffff0000, v16
    v_lshlrev_b32 v52, 16, v184
    v_and_b32 v53, 0xffff0000, v184
    v_lshlrev_b32 v54, 16, v185
    v_and_b32 v55, 0xffff0000, v185
    v_lshlrev_b32 v56, 16, v186
    v_and_b32 v57, 0xffff0000, v186
    v_lshlrev_b32 v58, 16, v187
    v_and_b32 v59, 0xffff0000, v187
    v_pk_add_f32 v[44:45], v[44:45], v[52:53]
    v_pk_add_f32 v[46:47], v[46:47], v[54:55]
    v_pk_add_f32 v[48:49], v[48:49], v[56:57]
    v_pk_add_f32 v[50:51], v[50:51], v[58:59]
    v_cvt_pk_bf16_f32 v16, v44, v45
    v_lshlrev_b32 v44, 16, v16
    v_and_b32 v45, 0xffff0000, v16
    v_cvt_pk_bf16_f32 v16, v46, v47
    v_lshlrev_b32 v46, 16, v16
    v_and_b32 v47, 0xffff0000, v16
    v_cvt_pk_bf16_f32 v16, v48, v49
    v_lshlrev_b32 v48, 16, v16
    v_and_b32 v49, 0xffff0000, v16
    v_cvt_pk_bf16_f32 v16, v50, v51
    v_lshlrev_b32 v50, 16, v16
    v_and_b32 v51, 0xffff0000, v16
    v_lshlrev_b32 v52, 16, v200
    v_and_b32 v53, 0xffff0000, v200
    v_lshlrev_b32 v54, 16, v201
    v_and_b32 v55, 0xffff0000, v201
    v_lshlrev_b32 v56, 16, v202
    v_and_b32 v57, 0xffff0000, v202
    v_lshlrev_b32 v58, 16, v203
    v_and_b32 v59, 0xffff0000, v203
    v_pk_mul_f32 v[44:45], v[44:45], v[52:53]
    v_pk_mul_f32 v[46:47], v[46:47], v[54:55]
    v_pk_mul_f32 v[48:49], v[48:49], v[56:57]
    v_pk_mul_f32 v[50:51], v[50:51], v[58:59]
    v_cvt_pk_bf16_f32 v16, v44, v45
    v_lshlrev_b32 v44, 16, v16
    v_and_b32 v45, 0xffff0000, v16
    v_cvt_pk_bf16_f32 v16, v46, v47
    v_lshlrev_b32 v46, 16, v16
    v_and_b32 v47, 0xffff0000, v16
    v_cvt_pk_bf16_f32 v16, v48, v49
    v_lshlrev_b32 v48, 16, v16
    v_and_b32 v49, 0xffff0000, v16
    v_cvt_pk_bf16_f32 v16, v50, v51
    v_lshlrev_b32 v50, 16, v16
    v_and_b32 v51, 0xffff0000, v16
    v_pk_add_f32 v[44:45], v[44:45], v[28:29]
    v_pk_add_f32 v[46:47], v[46:47], v[30:31]
    v_pk_add_f32 v[48:49], v[48:49], v[32:33]
    v_pk_add_f32 v[50:51], v[50:51], v[34:35]
    v_cvt_pk_bf16_f32 v28, v44, v45
    v_cvt_pk_bf16_f32 v29, v46, v47
    v_cvt_pk_bf16_f32 v30, v48, v49
    v_cvt_pk_bf16_f32 v31, v50, v51
    v_sub_f32 v44, v36, v96
    v_sub_f32 v45, v37, v96
    v_sub_f32 v46, v38, v96
    v_sub_f32 v47, v39, v96
    v_sub_f32 v48, v40, v96
    v_sub_f32 v49, v41, v96
    v_sub_f32 v50, v42, v96
    v_sub_f32 v51, v43, v96
    v_cvt_pk_bf16_f32 v16, v44, v45
    v_lshlrev_b32 v44, 16, v16
    v_and_b32 v45, 0xffff0000, v16
    v_cvt_pk_bf16_f32 v16, v46, v47
    v_lshlrev_b32 v46, 16, v16
    v_and_b32 v47, 0xffff0000, v16
    v_cvt_pk_bf16_f32 v16, v48, v49
    v_lshlrev_b32 v48, 16, v16
    v_and_b32 v49, 0xffff0000, v16
    v_cvt_pk_bf16_f32 v16, v50, v51
    v_lshlrev_b32 v50, 16, v16
    v_and_b32 v51, 0xffff0000, v16
    v_mul_f32 v52, v44, v99
    v_mul_f32 v53, v45, v99
    v_mul_f32 v54, v46, v99
    v_mul_f32 v55, v47, v99
    v_mul_f32 v56, v48, v99
    v_mul_f32 v57, v49, v99
    v_mul_f32 v58, v50, v99
    v_mul_f32 v59, v51, v99
    v_fma_f32 v44, -v52, v98, v44
    v_fma_f32 v45, -v53, v98, v45
    v_fma_f32 v46, -v54, v98, v46
    v_fma_f32 v47, -v55, v98, v47
    v_fma_f32 v48, -v56, v98, v48
    v_fma_f32 v49, -v57, v98, v49
    v_fma_f32 v50, -v58, v98, v50
    v_fma_f32 v51, -v59, v98, v51
    v_fma_f32 v44, v44, v99, v52
    v_fma_f32 v45, v45, v99, v53
    v_fma_f32 v46, v46, v99, v54
    v_fma_f32 v47, v47, v99, v55
    v_fma_f32 v48, v48, v99, v56
    v_fma_f32 v49, v49, v99, v57
    v_fma_f32 v50, v50, v99, v58
    v_fma_f32 v51, v51, v99, v59
    v_cvt_pk_bf16_f32 v16, v44, v45
    v_lshlrev_b32 v44, 16, v16
    v_and_b32 v45, 0xffff0000, v16
    v_cvt_pk_bf16_f32 v16, v46, v47
    v_lshlrev_b32 v46, 16, v16
    v_and_b32 v47, 0xffff0000, v16
    v_cvt_pk_bf16_f32 v16, v48, v49
    v_lshlrev_b32 v48, 16, v16
    v_and_b32 v49, 0xffff0000, v16
    v_cvt_pk_bf16_f32 v16, v50, v51
    v_lshlrev_b32 v50, 16, v16
    v_and_b32 v51, 0xffff0000, v16
    v_lshlrev_b32 v52, 16, v196
    v_and_b32 v53, 0xffff0000, v196
    v_lshlrev_b32 v54, 16, v197
    v_and_b32 v55, 0xffff0000, v197
    v_lshlrev_b32 v56, 16, v198
    v_and_b32 v57, 0xffff0000, v198
    v_lshlrev_b32 v58, 16, v199
    v_and_b32 v59, 0xffff0000, v199
    v_pk_mul_f32 v[44:45], v[44:45], v[52:53]
    v_pk_mul_f32 v[46:47], v[46:47], v[54:55]
    v_pk_mul_f32 v[48:49], v[48:49], v[56:57]
    v_pk_mul_f32 v[50:51], v[50:51], v[58:59]
    v_cvt_pk_bf16_f32 v16, v44, v45
    v_lshlrev_b32 v44, 16, v16
    v_and_b32 v45, 0xffff0000, v16
    v_cvt_pk_bf16_f32 v16, v46, v47
    v_lshlrev_b32 v46, 16, v16
    v_and_b32 v47, 0xffff0000, v16
    v_cvt_pk_bf16_f32 v16, v48, v49
    v_lshlrev_b32 v48, 16, v16
    v_and_b32 v49, 0xffff0000, v16
    v_cvt_pk_bf16_f32 v16, v50, v51
    v_lshlrev_b32 v50, 16, v16
    v_and_b32 v51, 0xffff0000, v16
    v_lshlrev_b32 v52, 16, v188
    v_and_b32 v53, 0xffff0000, v188
    v_lshlrev_b32 v54, 16, v189
    v_and_b32 v55, 0xffff0000, v189
    v_lshlrev_b32 v56, 16, v190
    v_and_b32 v57, 0xffff0000, v190
    v_lshlrev_b32 v58, 16, v191
    v_and_b32 v59, 0xffff0000, v191
    v_pk_add_f32 v[44:45], v[44:45], v[52:53]
    v_pk_add_f32 v[46:47], v[46:47], v[54:55]
    v_pk_add_f32 v[48:49], v[48:49], v[56:57]
    v_pk_add_f32 v[50:51], v[50:51], v[58:59]
    v_cvt_pk_bf16_f32 v16, v44, v45
    v_lshlrev_b32 v44, 16, v16
    v_and_b32 v45, 0xffff0000, v16
    v_cvt_pk_bf16_f32 v16, v46, v47
    v_lshlrev_b32 v46, 16, v16
    v_and_b32 v47, 0xffff0000, v16
    v_cvt_pk_bf16_f32 v16, v48, v49
    v_lshlrev_b32 v48, 16, v16
    v_and_b32 v49, 0xffff0000, v16
    v_cvt_pk_bf16_f32 v16, v50, v51
    v_lshlrev_b32 v50, 16, v16
    v_and_b32 v51, 0xffff0000, v16
    v_lshlrev_b32 v52, 16, v204
    v_and_b32 v53, 0xffff0000, v204
    v_lshlrev_b32 v54, 16, v205
    v_and_b32 v55, 0xffff0000, v205
    v_lshlrev_b32 v56, 16, v206
    v_and_b32 v57, 0xffff0000, v206
    v_lshlrev_b32 v58, 16, v207
    v_and_b32 v59, 0xffff0000, v207
    v_pk_mul_f32 v[44:45], v[44:45], v[52:53]
    v_pk_mul_f32 v[46:47], v[46:47], v[54:55]
    v_pk_mul_f32 v[48:49], v[48:49], v[56:57]
    v_pk_mul_f32 v[50:51], v[50:51], v[58:59]
    v_cvt_pk_bf16_f32 v16, v44, v45
    v_lshlrev_b32 v44, 16, v16
    v_and_b32 v45, 0xffff0000, v16
    v_cvt_pk_bf16_f32 v16, v46, v47
    v_lshlrev_b32 v46, 16, v16
    v_and_b32 v47, 0xffff0000, v16
    v_cvt_pk_bf16_f32 v16, v48, v49
    v_lshlrev_b32 v48, 16, v16
    v_and_b32 v49, 0xffff0000, v16
    v_cvt_pk_bf16_f32 v16, v50, v51
    v_lshlrev_b32 v50, 16, v16
    v_and_b32 v51, 0xffff0000, v16
    v_pk_add_f32 v[44:45], v[44:45], v[36:37]
    v_pk_add_f32 v[46:47], v[46:47], v[38:39]
    v_pk_add_f32 v[48:49], v[48:49], v[40:41]
    v_pk_add_f32 v[50:51], v[50:51], v[42:43]
    v_cvt_pk_bf16_f32 v36, v44, v45
    v_cvt_pk_bf16_f32 v37, v46, v47
    v_cvt_pk_bf16_f32 v38, v48, v49
    v_cvt_pk_bf16_f32 v39, v50, v51
    v_lshlrev_b32 v18, 4, v0
    s_mov_b32 s16, 0x6e0000
    s_mov_b32 s27, 0
adaLN_cond__sliding_block_cached__moe_arch_mod__prompt_kernel_w12p:
    buffer_load_dwordx4 v[24:27], v18, s[8:11], s16 offen sc1
    s_waitcnt vmcnt(0)
    v_cmp_eq_u32 vcc, 0, v24
    s_add_u32 s27, s27, 1
    s_cmp_ge_u32 s27, 262144
    s_cbranch_scc1 adaLN_cond__sliding_block_cached__moe_arch_mod__prompt_kernel_w12g
    s_cbranch_vccnz adaLN_cond__sliding_block_cached__moe_arch_mod__prompt_kernel_w12p
adaLN_cond__sliding_block_cached__moe_arch_mod__prompt_kernel_w12g:
    v_mov_b32 v76, v24
    s_nop 1
    v_max_u32_dpp v76, v76, v76 row_ror:1 row_mask:0xf bank_mask:0xf
    s_nop 1
    v_max_u32_dpp v76, v76, v76 row_ror:2 row_mask:0xf bank_mask:0xf
    s_nop 1
    v_max_u32_dpp v76, v76, v76 row_ror:4 row_mask:0xf bank_mask:0xf
    s_nop 1
    v_max_u32_dpp v76, v76, v76 row_ror:8 row_mask:0xf bank_mask:0xf
    v_mov_b32 v77, v76
    s_nop 1
    v_permlane16_swap_b32 v76, v77
    v_max_u32 v76, v76, v77
    v_mov_b32 v77, v76
    s_nop 1
    v_permlane32_swap_b32 v76, v77
    v_max_u32 v76, v76, v77
    v_cmp_eq_u32 vcc, v76, v24
    s_lshl_b32 s16, s3, 4
    s_add_u32 s16, s16, 65792
    v_mov_b32 v16, s16
    s_and_saveexec_b64 s[62:63], vcc
    ds_write_b128 v16, v[24:27]
    s_mov_b64 exec, s[62:63]
    s_waitcnt lgkmcnt(0)
    s_barrier
    v_and_b32 v16, 3, v1
    v_lshlrev_b32 v16, 4, v16
    v_add_u32 v16, 65792, v16
    ds_read_b32 v76, v16
    s_waitcnt lgkmcnt(0)
    v_mov_b32 v77, v76
    s_nop 1
    v_max_u32_dpp v77, v77, v77 row_ror:1 row_mask:0xf bank_mask:0xf
    s_nop 1
    v_max_u32_dpp v77, v77, v77 row_ror:2 row_mask:0xf bank_mask:0xf
    v_cmp_eq_u32 vcc, v76, v77
    s_ff1_i32_b64 s16, vcc
    s_lshl_b32 s16, s16, 4
    s_add_u32 s16, s16, 65792
    v_mov_b32 v16, s16
    ds_read_b128 v[24:27], v16
    s_waitcnt lgkmcnt(0)
    v_and_b32 v76, 0x7ff, v24
    v_sub_u32 v76, 2047, v76
    s_nop 0
    v_readfirstlane_b32 s12, v76
    v_rcp_f32 v103, v26
    s_lshr_b32 s18, s12, 4
    s_lshl_b32 s18, s18, 15
    s_and_b32 s19, s12, 15
    s_lshl_b32 s19, s19, 6
    s_add_u32 s18, s18, s19
    s_add_u32 s18, s18, 0x2c00000
    s_add_u32 s19, s18, 0x400000
    v_lshrrev_b32 v18, 4, v0
    v_lshlrev_b32 v18, 10, v18
    v_and_b32 v19, 15, v0
    v_lshl_add_u32 v18, v19, 2, v18
    s_lshl_b32 s13, s12, 11
    buffer_load_dword v100, v18, s[8:11], s18 offen sc1
    buffer_load_dword v101, v18, s[8:11], s19 offen sc1
    buffer_load_dword v102, v21, s[76:79], s13 offen
    s_lshl_b32 s16, s14, 11
    s_cmp_lg_u32 s12, s14
    s_cselect_b32 s16, s16, 0x7ffffff0
    buffer_store_dwordx4 v[28:31], v2, s[68:71], s16 offen offset:0 sc1
    buffer_store_dwordx4 v[36:39], v2, s[68:71], s16 offen offset:1024 sc1
    s_lshl_b32 s16, s3, 13
    v_add_u32 v20, s16, v2
    s_waitcnt vmcnt(4)
    v_lshlrev_b32 v76, 16, v100
    v_and_b32 v77, 0xffff0000, v100
    s_waitcnt vmcnt(3)
    v_lshlrev_b32 v78, 16, v101
    v_and_b32 v79, 0xffff0000, v101
    v_pk_add_f32 v[76:77], v[76:77], v[78:79]
    s_waitcnt vmcnt(2)
    v_lshlrev_b32 v78, 16, v102
    v_and_b32 v79, 0xffff0000, v102
    v_pk_add_f32 v[92:93], v[78:79], v[76:77]
    v_cvt_pk_bf16_f32 v76, v92, v93
    v_lshlrev_b32 v92, 16, v76
    v_and_b32 v93, 0xffff0000, v76
    v_cvt_pk_bf16_f32 v100, v92, v93
    v_and_b32 v105, 0xffff0000, v104
    v_lshlrev_b32 v104, 16, v104
    v_and_b32 v107, 0xffff0000, v106
    v_lshlrev_b32 v106, 16, v106
    v_sub_f32 v92, v92, v25
    v_sub_f32 v93, v93, v25
    v_cvt_pk_bf16_f32 v76, v92, v93
    v_lshlrev_b32 v92, 16, v76
    v_and_b32 v93, 0xffff0000, v76
    v_mul_f32 v77, v92, v103
    v_fma_f32 v92, -v77, v26, v92
    v_fma_f32 v92, v92, v103, v77
    v_mul_f32 v77, v93, v103
    v_fma_f32 v93, -v77, v26, v93
    v_fma_f32 v93, v93, v103, v77
    v_cvt_pk_bf16_f32 v76, v92, v93
    v_lshlrev_b32 v92, 16, v76
    v_and_b32 v93, 0xffff0000, v76
    v_mul_f32 v92, v92, v104
    v_mul_f32 v93, v93, v105
    v_cvt_pk_bf16_f32 v76, v92, v93
    v_lshlrev_b32 v92, 16, v76
    v_and_b32 v93, 0xffff0000, v76
    v_add_f32 v92, v92, v106
    v_add_f32 v93, v93, v107
    v_cvt_pk_bf16_f32 v101, v92, v93
    v_add_u32 v16, 66560, v21
    ds_write_b32 v16, v101
    ds_write_b32 v16, v100 offset:2048
    s_waitcnt lgkmcnt(0)
    s_barrier
    ds_read_b128 v[60:63], v20 offset:0
    ds_read_b128 v[64:67], v20 offset:1024
    ds_read_b128 v[68:71], v20 offset:2048
    ds_read_b128 v[72:75], v20 offset:3072
    ds_read_b128 v[108:111], v20 offset:4096
    ds_read_b128 v[112:115], v20 offset:5120
    ds_read_b128 v[116:119], v20 offset:6144
    ds_read_b128 v[120:123], v20 offset:7168
    s_and_b32 s16, s3, 3
    s_lshl_b32 s16, s16, 7
    s_and_b32 s17, s29, 3
    s_lshl_b32 s17, s17, 9
    s_add_u32 s16, s16, s17
    s_add_u32 s16, s16, 66560
    v_lshrrev_b32 v16, 3, v1
    v_lshlrev_b32 v16, 4, v16
    v_add_u32 v16, s16, v16
    ds_read_b128 v[104:107], v16
    s_waitcnt lgkmcnt(0)
    v_lshlrev_b32 v76, 16, v104
    v_and_b32 v77, 0xffff, v104
    v_dot2_f32_bf16 v85, v60, v76, 0
    v_dot2_f32_bf16 v84, v60, v77, 0
    v_dot2_f32_bf16 v87, v61, v76, 0
    v_dot2_f32_bf16 v86, v61, v77, 0
    v_dot2_f32_bf16 v89, v62, v76, 0
    v_dot2_f32_bf16 v88, v62, v77, 0
    v_dot2_f32_bf16 v91, v63, v76, 0
    v_dot2_f32_bf16 v90, v63, v77, 0
    v_and_b32 v78, 0xffff0000, v104
    v_lshrrev_b32 v79, 16, v104
    v_dot2c_f32_bf16 v85, v64, v78
    v_dot2c_f32_bf16 v84, v64, v79
    v_dot2c_f32_bf16 v87, v65, v78
    v_dot2c_f32_bf16 v86, v65, v79
    v_dot2c_f32_bf16 v89, v66, v78
    v_dot2c_f32_bf16 v88, v66, v79
    v_dot2c_f32_bf16 v91, v67, v78
    v_dot2c_f32_bf16 v90, v67, v79
    v_lshlrev_b32 v80, 16, v105
    v_and_b32 v81, 0xffff, v105
    v_dot2c_f32_bf16 v85, v68, v80
    v_dot2c_f32_bf16 v84, v68, v81
    v_dot2c_f32_bf16 v87, v69, v80
    v_dot2c_f32_bf16 v86, v69, v81
    v_dot2c_f32_bf16 v89, v70, v80
    v_dot2c_f32_bf16 v88, v70, v81
    v_dot2c_f32_bf16 v91, v71, v80
    v_dot2c_f32_bf16 v90, v71, v81
    v_and_b32 v82, 0xffff0000, v105
    v_lshrrev_b32 v83, 16, v105
    v_dot2c_f32_bf16 v85, v72, v82
    v_dot2c_f32_bf16 v84, v72, v83
    v_dot2c_f32_bf16 v87, v73, v82
    v_dot2c_f32_bf16 v86, v73, v83
    v_dot2c_f32_bf16 v89, v74, v82
    v_dot2c_f32_bf16 v88, v74, v83
    v_dot2c_f32_bf16 v91, v75, v82
    v_dot2c_f32_bf16 v90, v75, v83
    v_lshlrev_b32 v76, 16, v106
    v_and_b32 v77, 0xffff, v106
    v_dot2c_f32_bf16 v85, v108, v76
    v_dot2c_f32_bf16 v84, v108, v77
    v_dot2c_f32_bf16 v87, v109, v76
    v_dot2c_f32_bf16 v86, v109, v77
    v_dot2c_f32_bf16 v89, v110, v76
    v_dot2c_f32_bf16 v88, v110, v77
    v_dot2c_f32_bf16 v91, v111, v76
    v_dot2c_f32_bf16 v90, v111, v77
    v_and_b32 v78, 0xffff0000, v106
    v_lshrrev_b32 v79, 16, v106
    v_dot2c_f32_bf16 v85, v112, v78
    v_dot2c_f32_bf16 v84, v112, v79
    v_dot2c_f32_bf16 v87, v113, v78
    v_dot2c_f32_bf16 v86, v113, v79
    v_dot2c_f32_bf16 v89, v114, v78
    v_dot2c_f32_bf16 v88, v114, v79
    v_dot2c_f32_bf16 v91, v115, v78
    v_dot2c_f32_bf16 v90, v115, v79
    v_lshlrev_b32 v80, 16, v107
    v_and_b32 v81, 0xffff, v107
    v_dot2c_f32_bf16 v85, v116, v80
    v_dot2c_f32_bf16 v84, v116, v81
    v_dot2c_f32_bf16 v87, v117, v80
    v_dot2c_f32_bf16 v86, v117, v81
    v_dot2c_f32_bf16 v89, v118, v80
    v_dot2c_f32_bf16 v88, v118, v81
    v_dot2c_f32_bf16 v91, v119, v80
    v_dot2c_f32_bf16 v90, v119, v81
    v_and_b32 v82, 0xffff0000, v107
    v_lshrrev_b32 v83, 16, v107
    v_dot2c_f32_bf16 v85, v120, v82
    v_dot2c_f32_bf16 v84, v120, v83
    v_dot2c_f32_bf16 v87, v121, v82
    v_dot2c_f32_bf16 v86, v121, v83
    v_dot2c_f32_bf16 v89, v122, v82
    v_dot2c_f32_bf16 v88, v122, v83
    v_dot2c_f32_bf16 v91, v123, v82
    v_dot2c_f32_bf16 v90, v123, v83
    s_nop 0
    v_permlane32_swap_b32 v84, v88
    v_permlane32_swap_b32 v85, v89
    v_permlane32_swap_b32 v86, v90
    v_permlane32_swap_b32 v87, v91
    v_add_f32 v84, v84, v88
    v_add_f32 v85, v85, v89
    v_add_f32 v86, v86, v90
    v_add_f32 v87, v87, v91
    s_nop 0
    v_permlane16_swap_b32 v84, v86
    v_permlane16_swap_b32 v85, v87
    v_add_f32 v84, v84, v86
    v_add_f32 v85, v85, v87
    s_nop 0
    v_add_f32_dpp v84, v84, v84 row_ror:8 row_mask:0xf bank_mask:0xf
    v_add_f32_dpp v85, v85, v85 row_ror:8 row_mask:0xf bank_mask:0xf
    v_and_b32 v16, 7, v1
    v_lshlrev_b32 v16, 5, v16
    v_lshrrev_b32 v17, 4, v1
    v_lshl_add_u32 v16, v17, 3, v16
    s_lshl_b32 s16, s3, 8
    s_add_u32 s16, s16, 70656
    v_add_u32 v16, s16, v16
    ds_write_b64 v16, v[84:85]
    s_lshr_b32 s16, s3, 2
    s_lshl_b32 s17, s16, 10
    s_add_u32 s17, s17, 70656
    v_lshlrev_b32 v17, 2, v1
    v_add_u32 v16, s17, v17
    s_and_b32 s17, s29, 3
    s_lshl_b32 s17, s17, 1
    s_add_u32 s17, s17, s16
    s_mul_i32 s17, s17, 14336
    s_lshr_b32 s16, s29, 2
    s_lshl_b32 s16, s16, 8
    s_add_u32 s17, s17, s16
    s_add_u32 s17, s17, 0x6e1000
    s_and_b32 s16, s3, 3
    s_cmp_eq_u32 s16, 0
    s_cselect_b32 s17, s17, 0x7ffffff0
    s_cmp_lt_u32 s2, 224
    s_cselect_b32 s17, s17, 0x7ffffff0
    s_waitcnt lgkmcnt(0)
    s_barrier
    ds_read_b32 v84, v16 offset:0
    ds_read_b32 v85, v16 offset:256
    ds_read_b32 v86, v16 offset:512
    ds_read_b32 v87, v16 offset:768
    s_waitcnt lgkmcnt(2)
    v_add_f32 v84, v84, v85
    s_waitcnt lgkmcnt(0)
    v_add_f32 v86, v86, v87
    v_add_f32 v84, v84, v86
    v_or_b32 v84, 1, v84
    buffer_store_dword v84, v17, s[8:11], s17 offen sc1
    s_barrier
    v_lshlrev_b32 v16, 3, v0
    v_add_u32 v17, 73728, v16
    ds_read_b64 v[84:85], v17 offset:0
    ds_read_b64 v[86:87], v17 offset:4096
    ds_read_b64 v[88:89], v17 offset:8192
    ds_read_b64 v[90:91], v17 offset:12288
    s_waitcnt lgkmcnt(2)
    v_pk_add_f32 v[84:85], v[84:85], v[86:87]
    s_waitcnt lgkmcnt(0)
    v_pk_add_f32 v[88:89], v[88:89], v[90:91]
    v_pk_add_f32 v[84:85], v[84:85], v[88:89]
    v_or_b32 v84, 1, v84
    v_or_b32 v85, 1, v85
    s_lshl_b32 s16, s29, 12
    s_add_u32 s16, s16, 0x600000
    s_cmp_lt_u32 s2, 224
    s_cselect_b32 s16, s16, 0x7ffffff0
    buffer_store_dwordx2 v[84:85], v16, s[8:11], s16 offen sc1
    s_cmp_lt_u32 s2, 224
    s_cbranch_scc1 adaLN_cond__sliding_block_cached__moe_arch_mod__prompt_kernel_end
    s_sub_u32 s16, s2, 224
    s_lshl_b32 s17, s16, 7
    s_add_u32 s17, s17, 0x600000
    v_lshrrev_b32 v16, 3, v0
    v_lshlrev_b32 v16, 12, v16
    v_and_b32 v17, 7, v0
    v_lshl_add_u32 v16, v17, 4, v16
    v_cmp_gt_u32 vcc, 256, v0
    v_bfrev_b32 v17, -2
    s_nop 0
    v_cndmask_b32 v17, v17, v16, vcc
    v_mov_b32 v19, 0
    v_cndmask_b32 v18, 1, v19, vcc
    s_lshl_b32 s18, s16, 6
    v_and_b32 v19, 31, v1
    v_lshlrev_b32 v19, 1, v19
    v_add_u32 v19, s18, v19
    s_mov_b32 s19, 0x541800
    buffer_load_ushort v95, v19, s[8:11], s19 offen sc1
    v_add_u32 v20, 66560, v19
    ds_read_u16 v96, v20
    ds_read_u16 v97, v20 offset:2048
    v_mov_b32 v94, v27
    v_cvt_pk_bf16_f32 v94, v94, v94
    v_lshlrev_b32 v94, 16, v94
    v_mul_f32 v94, 0xbfb8aa3b, v94
    v_exp_f32 v94, v94
    s_nop 0
    v_add_f32 v94, 1.0, v94
    v_rcp_f32 v94, v94
    s_nop 0
    v_cvt_pk_bf16_f32 v94, v94, v94
    v_lshlrev_b32 v94, 16, v94
    s_waitcnt vmcnt(0)
    v_lshlrev_b32 v95, 16, v95
    s_waitcnt lgkmcnt(1)
    v_lshlrev_b32 v96, 16, v96
    s_waitcnt lgkmcnt(0)
    v_lshlrev_b32 v97, 16, v97
    s_mov_b32 s27, 0
adaLN_cond__sliding_block_cached__moe_arch_mod__prompt_kernel_y13p:
    s_add_u32 s19, s17, 0x0
    buffer_load_dwordx4 v[44:47], v16, s[8:11], s19 offen sc1
    s_add_u32 s19, s17, 0x40000
    buffer_load_dwordx4 v[48:51], v16, s[8:11], s19 offen sc1
    s_add_u32 s19, s17, 0x80000
    buffer_load_dwordx4 v[52:55], v16, s[8:11], s19 offen sc1
    s_add_u32 s19, s17, 0xc0000
    buffer_load_dwordx4 v[56:59], v17, s[8:11], s19 offen sc1
    s_waitcnt vmcnt(0)
    v_min3_u32 v98, v56, v57, v58
    v_min_u32 v98, v98, v59
    v_or_b32 v98, v98, v18
    v_min3_u32 v98, v98, v44, v45
    v_min3_u32 v98, v98, v46, v47
    v_min3_u32 v98, v98, v48, v49
    v_min3_u32 v98, v98, v50, v51
    v_min3_u32 v98, v98, v52, v53
    v_min3_u32 v98, v98, v54, v55
    v_cmp_eq_u32 vcc, 0, v98
    s_add_u32 s27, s27, 1
    s_cmp_ge_u32 s27, 262144
    s_cbranch_scc1 adaLN_cond__sliding_block_cached__moe_arch_mod__prompt_kernel_y13g
    s_cbranch_vccnz adaLN_cond__sliding_block_cached__moe_arch_mod__prompt_kernel_y13p
adaLN_cond__sliding_block_cached__moe_arch_mod__prompt_kernel_y13g:
    v_pk_add_f32 v[44:45], v[44:45], v[52:53]
    v_pk_add_f32 v[46:47], v[46:47], v[54:55]
    v_pk_add_f32 v[48:49], v[48:49], v[56:57]
    v_pk_add_f32 v[50:51], v[50:51], v[58:59]
    v_pk_add_f32 v[44:45], v[44:45], v[48:49]
    v_pk_add_f32 v[46:47], v[46:47], v[50:51]
    s_nop 0
    v_add_f32_dpp v44, v44, v44 row_ror:8 row_mask:0xf bank_mask:0xf
    v_add_f32_dpp v45, v45, v45 row_ror:8 row_mask:0xf bank_mask:0xf
    v_add_f32_dpp v46, v46, v46 row_ror:8 row_mask:0xf bank_mask:0xf
    v_add_f32_dpp v47, v47, v47 row_ror:8 row_mask:0xf bank_mask:0xf
    s_nop 0
    v_permlane32_swap_b32 v44, v46
    v_permlane32_swap_b32 v45, v47
    v_add_f32 v44, v44, v46
    v_add_f32 v45, v45, v47
    s_nop 1
    v_permlane16_swap_b32 v44, v45
    v_add_f32 v44, v44, v45
    v_and_b32 v16, 7, v1
    v_lshlrev_b32 v16, 4, v16
    v_lshrrev_b32 v17, 4, v1
    v_lshl_add_u32 v16, v17, 2, v16
    s_lshl_b32 s19, s3, 7
    s_add_u32 s19, s19, 91136
    v_add_u32 v16, s19, v16
    ds_write_b32 v16, v44
    v_and_b32 v16, 31, v1
    v_lshlrev_b32 v16, 2, v16
    v_add_u32 v16, 91136, v16
    s_waitcnt lgkmcnt(0)
    s_barrier
    s_cmp_lg_u32 s3, 0
    s_cbranch_scc1 adaLN_cond__sliding_block_cached__moe_arch_mod__prompt_kernel_end
    ds_read_b32 v44, v16 offset:0
    ds_read_b32 v45, v16 offset:128
    ds_read_b32 v46, v16 offset:256
    ds_read_b32 v47, v16 offset:384
    ds_read_b32 v48, v16 offset:512
    ds_read_b32 v49, v16 offset:640
    ds_read_b32 v50, v16 offset:768
    ds_read_b32 v51, v16 offset:896
    s_waitcnt lgkmcnt(3)
    v_add_f32 v44, v44, v48
    s_waitcnt lgkmcnt(2)
    v_add_f32 v45, v45, v49
    s_waitcnt lgkmcnt(1)
    v_add_f32 v46, v46, v50
    s_waitcnt lgkmcnt(0)
    v_add_f32 v47, v47, v51
    v_add_f32 v44, v44, v46
    v_add_f32 v45, v45, v47
    v_add_f32 v44, v44, v45
    v_cvt_pk_bf16_f32 v44, v44, v44
    v_lshlrev_b32 v44, 16, v44
    v_mul_f32 v44, v44, v94
    v_cvt_pk_bf16_f32 v44, v44, v44
    v_lshlrev_b32 v44, 16, v44
    v_add_f32 v44, v44, v96
    v_cvt_pk_bf16_f32 v44, v44, v44
    v_lshlrev_b32 v44, 16, v44
    v_mul_f32 v44, v44, v95
    v_cvt_pk_bf16_f32 v44, v44, v44
    v_lshlrev_b32 v44, 16, v44
    v_add_f32 v44, v44, v97
    v_cvt_pk_bf16_f32 v44, v44, v44
    s_mov_b64 exec, 0xffffffff
    buffer_store_short v44, v19, s[68:71], s13 offen sc1
    s_branch adaLN_cond__sliding_block_cached__moe_arch_mod__prompt_kernel_end
adaLN_cond__sliding_block_cached__moe_arch_mod__prompt_kernel_roleB:
    v_mov_b32 v132, 0
    v_mov_b32 v133, 0
    v_lshrrev_b32 v16, 3, v0
    v_and_b32 v17, 7, v0
    v_mul_u32_u24 v135, 24576, v16
    v_lshl_add_u32 v135, v17, 4, v135
    v_lshlrev_b32 v136, 2, v16
    s_and_b32 s14, s2, 31
    s_lshr_b32 s15, s2, 5
    s_mul_i32 s26, s15, 1572864
    s_lshl_b32 s16, s14, 7
    s_add_u32 s26, s26, s16
    s_lshl_b32 s29, s15, 8
    v_lshlrev_b32 v137, 3, v0
    s_lshl_b32 s18, s2, 3
    s_add_u32 s18, s18, s3
    s_lshl_b32 s18, s18, 11
    v_and_b32 v18, 15, v1
    v_lshrrev_b32 v19, 4, v1
    v_lshlrev_b32 v138, 11, v18
    v_lshl_add_u32 v138, v19, 4, v138
    s_lshr_b32 s30, s2, 4
    s_and_b32 s31, s2, 15
    s_lshl_b32 s19, s30, 3
    s_add_u32 s19, s19, s3
    s_lshl_b32 s22, s19, 15
    s_lshl_b32 s23, s31, 7
    s_add_u32 s22, s22, s23
    s_lshl_b32 s23, s2, 12
    s_add_u32 s23, s23, 0x600000
    s_or_b32 s25, s2, s3
    s_cmp_eq_u32 s25, 0
    s_cselect_b32 s25, 0, 0x7ffffff0
    s_waitcnt lgkmcnt(0)
    s_mov_b64 s[64:65], s[58:59]
    s_mov_b32 s66, 0x100
    s_mov_b32 s67, 0x20000
    s_or_b32 s28, s62, 1
    v_mov_b32 v134, s28
    s_mov_b64 exec, 1
    buffer_store_dword v134, v132, s[64:67], s25 offen sc1
    s_mov_b64 exec, -1
    s_mov_b64 s[68:69], s[52:53]
    s_mov_b32 s70, 0x800
    s_mov_b32 s71, 0x20000
    s_mov_b64 s[72:73], s[54:55]
    s_mov_b32 s74, 0xc00000
    s_mov_b32 s75, 0x20000
    s_mov_b64 s[76:77], s[32:33]
    s_mov_b32 s78, 0x400000
    s_mov_b32 s79, 0x20000
    s_mov_b64 s[8:9], s[60:61]
    s_mov_b32 s10, 0x3400000
    s_mov_b32 s11, 0x20000
    buffer_load_dword v72, v136, s[68:71], s29 offen
    buffer_load_dwordx4 v[24:27], v135, s[72:75], s26 offen
    s_add_u32 s26, s26, 12288
    buffer_load_dwordx4 v[28:31], v135, s[72:75], s26 offen
    buffer_load_dwordx4 v[32:35], v2, s[76:79], s18 offen offset:0
    buffer_load_dwordx4 v[36:39], v2, s[76:79], s18 offen offset:1024
    buffer_store_dwordx2 v[132:133], v137, s[8:11], s23 offen sc1
    s_barrier
    buffer_load_dwordx4 v[40:43], v138, s[76:79], s22 offen offset:0
    buffer_load_dwordx4 v[44:47], v138, s[76:79], s22 offen offset:64
    s_mov_b32 s29, s19
    s_mov_b64 s[64:65], s[34:35]
    s_mov_b32 s66, 0x200000
    s_mov_b32 s67, 0x20000
    s_mov_b64 s[68:69], s[36:37]
    s_mov_b32 s70, 0x200000
    s_mov_b32 s71, 0x20000
    s_lshl_b32 s20, s2, 2
    s_add_u32 s20, s20, s3
    s_sub_u32 s20, s20, 4
    s_lshr_b32 s22, s20, 8
    s_bfe_u32 s23, s20, 0x40004
    s_and_b32 s24, s20, 15
    s_lshl_b32 s25, s22, 19
    s_lshl_b32 s26, s23, 13
    s_add_u32 s25, s25, s26
    s_add_u32 s25, s25, 393216
    v_and_b32 v16, 15, v1
    v_lshrrev_b32 v17, 4, v1
    s_lshl_b32 s21, s22, 17
    s_cmp_ge_u32 s24, 8
    s_cbranch_scc1 adaLN_cond__sliding_block_cached__moe_arch_mod__prompt_kernel_kvV
    v_lshlrev_b32 v18, 8, v16
    v_lshl_add_u32 v18, v17, 3, v18
    s_and_b32 s26, s24, 1
    s_lshl_b32 s26, s26, 12
    s_add_u32 s25, s25, s26
    s_lshr_b32 s26, s24, 1
    s_lshl_b32 s26, s26, 6
    s_add_u32 s25, s25, s26
    buffer_load_dwordx2 v[84:85], v18, s[64:67], s25 offen
    buffer_load_dwordx2 v[86:87], v18, s[64:67], s25 offen offset:32
    s_lshl_b32 s26, s23, 13
    s_add_u32 s21, s21, s26
    s_lshl_b32 s26, s24, 10
    s_add_u32 s21, s21, s26
    s_add_u32 s21, s21, 0x400000
    s_branch adaLN_cond__sliding_block_cached__moe_arch_mod__prompt_kernel_kvJ
adaLN_cond__sliding_block_cached__moe_arch_mod__prompt_kernel_kvV:
    s_bfe_u32 s26, s24, 0x20001
    s_lshl_b32 s26, s26, 6
    s_add_u32 s25, s25, s26
    s_and_b32 s26, s24, 1
    s_lshl_b32 s26, s26, 3
    s_add_u32 s25, s25, s26
    s_add_u32 s26, s25, 4096
    v_lshrrev_b32 v18, 2, v16
    v_lshlrev_b32 v18, 4, v18
    v_and_b32 v19, 3, v16
    v_lshl_add_u32 v18, v19, 1, v18
    v_lshl_add_u32 v18, v17, 10, v18
    buffer_load_ushort v88, v18, s[68:71], s25 offen offset:0
    buffer_load_ushort v89, v18, s[68:71], s25 offen offset:256
    buffer_load_ushort v90, v18, s[68:71], s25 offen offset:512
    buffer_load_ushort v91, v18, s[68:71], s25 offen offset:768
    buffer_load_ushort v92, v18, s[68:71], s26 offen offset:0
    buffer_load_ushort v93, v18, s[68:71], s26 offen offset:256
    buffer_load_ushort v94, v18, s[68:71], s26 offen offset:512
    buffer_load_ushort v95, v18, s[68:71], s26 offen offset:768
    s_bfe_u32 s26, s24, 0x20001
    s_lshl_b32 s26, s26, 15
    s_add_u32 s21, s21, s26
    s_lshl_b32 s26, s23, 11
    s_add_u32 s21, s21, s26
    s_and_b32 s26, s24, 1
    s_lshl_b32 s26, s26, 10
    s_add_u32 s21, s21, s26
    s_add_u32 s21, s21, 0x480000
adaLN_cond__sliding_block_cached__moe_arch_mod__prompt_kernel_kvJ:
    s_waitcnt vmcnt(9)
    v_and_b32 v73, 0xffff0000, v72
    v_lshlrev_b32 v72, 16, v72
    v_mul_f32 v16, 0xbfb8aa3b, v72
    v_exp_f32 v16, v16
    s_nop 0
    v_add_f32 v16, 1.0, v16
    v_rcp_f32 v16, v16
    s_nop 0
    v_mul_f32 v72, v72, v16
    v_mul_f32 v17, 0xbfb8aa3b, v73
    v_exp_f32 v17, v17
    s_nop 0
    v_add_f32 v17, 1.0, v17
    v_rcp_f32 v17, v17
    s_nop 0
    v_mul_f32 v73, v73, v17
    v_cvt_pk_bf16_f32 v16, v72, v73
    v_lshlrev_b32 v72, 16, v16
    v_and_b32 v73, 0xffff0000, v16
    s_lshl_b32 s16, s2, 8
    s_add_u32 s16, s16, 0x550000
    s_mov_b32 exec_lo, 0x01010101
    s_mov_b32 exec_hi, 0x01010101
    buffer_store_dword v16, v136, s[8:11], s16 offen sc1
    s_mov_b64 exec, -1
    v_lshrrev_b32 v74, 16, v72
    v_lshrrev_b32 v75, 16, v73
    s_waitcnt vmcnt(9)
    v_dot2_f32_bf16 v49, v24, v72, 0
    v_dot2_f32_bf16 v48, v24, v74, 0
    v_dot2_f32_bf16 v51, v25, v72, 0
    v_dot2_f32_bf16 v50, v25, v74, 0
    v_dot2_f32_bf16 v53, v26, v72, 0
    v_dot2_f32_bf16 v52, v26, v74, 0
    v_dot2_f32_bf16 v55, v27, v72, 0
    v_dot2_f32_bf16 v54, v27, v74, 0
    s_waitcnt vmcnt(8)
    v_dot2c_f32_bf16 v49, v28, v73
    v_dot2c_f32_bf16 v48, v28, v75
    v_dot2c_f32_bf16 v51, v29, v73
    v_dot2c_f32_bf16 v50, v29, v75
    v_dot2c_f32_bf16 v53, v30, v73
    v_dot2c_f32_bf16 v52, v30, v75
    v_dot2c_f32_bf16 v55, v31, v73
    v_dot2c_f32_bf16 v54, v31, v75
    s_nop 0
    v_permlane32_swap_b32 v48, v52
    v_permlane32_swap_b32 v49, v53
    v_permlane32_swap_b32 v50, v54
    v_permlane32_swap_b32 v51, v55
    v_add_f32 v48, v48, v52
    v_add_f32 v49, v49, v53
    v_add_f32 v50, v50, v54
    v_add_f32 v51, v51, v55
    s_nop 0
    v_permlane16_swap_b32 v48, v50
    v_permlane16_swap_b32 v49, v51
    v_add_f32 v48, v48, v50
    v_add_f32 v49, v49, v51
    s_nop 0
    v_add_f32_dpp v48, v48, v48 row_ror:8 row_mask:0xf bank_mask:0xf
    v_add_f32_dpp v49, v49, v49 row_ror:8 row_mask:0xf bank_mask:0xf
    v_and_b32 v16, 7, v1
    v_lshlrev_b32 v16, 5, v16
    v_lshrrev_b32 v17, 4, v1
    v_lshl_add_u32 v16, v17, 3, v16
    s_lshl_b32 s16, s3, 8
    s_add_u32 s16, s16, 65536
    v_add_u32 v16, s16, v16
    ds_write_b64 v16, v[48:49]
    s_waitcnt vmcnt(7)
    v_lshlrev_b32 v56, 16, v32
    v_and_b32 v57, 0xffff0000, v32
    v_lshlrev_b32 v58, 16, v33
    v_and_b32 v59, 0xffff0000, v33
    v_lshlrev_b32 v60, 16, v34
    v_and_b32 v61, 0xffff0000, v34
    v_lshlrev_b32 v62, 16, v35
    v_and_b32 v63, 0xffff0000, v35
    s_waitcnt vmcnt(6)
    v_lshlrev_b32 v64, 16, v36
    v_and_b32 v65, 0xffff0000, v36
    v_lshlrev_b32 v66, 16, v37
    v_and_b32 v67, 0xffff0000, v37
    v_lshlrev_b32 v68, 16, v38
    v_and_b32 v69, 0xffff0000, v38
    v_lshlrev_b32 v70, 16, v39
    v_and_b32 v71, 0xffff0000, v39
    v_add_f32 v20, v56, v57
    v_add_f32 v21, v58, v59
    v_add_f32 v20, v20, v60
    v_add_f32 v21, v21, v61
    v_add_f32 v20, v20, v62
    v_add_f32 v21, v21, v63
    v_add_f32 v20, v20, v64
    v_add_f32 v21, v21, v65
    v_add_f32 v20, v20, v66
    v_add_f32 v21, v21, v67
    v_add_f32 v20, v20, v68
    v_add_f32 v21, v21, v69
    v_add_f32 v20, v20, v70
    v_add_f32 v21, v21, v71
    v_add_f32 v128, v20, v21
    s_nop 1
    v_add_f32_dpp v128, v128, v128 row_ror:1 row_mask:0xf bank_mask:0xf
    s_nop 1
    v_add_f32_dpp v128, v128, v128 row_ror:2 row_mask:0xf bank_mask:0xf
    s_nop 1
    v_add_f32_dpp v128, v128, v128 row_ror:4 row_mask:0xf bank_mask:0xf
    s_nop 1
    v_add_f32_dpp v128, v128, v128 row_ror:8 row_mask:0xf bank_mask:0xf
    v_mov_b32 v20, v128
    s_nop 1
    v_permlane16_swap_b32 v128, v20
    v_add_f32 v128, v128, v20
    v_mov_b32 v20, v128
    s_nop 1
    v_permlane32_swap_b32 v128, v20
    v_add_f32 v128, v128, v20
    v_mul_f32 v128, 0x3a800000, v128
    v_sub_f32 v18, v56, v128
    v_mul_f32 v20, v18, v18
    v_sub_f32 v19, v57, v128
    v_mul_f32 v21, v19, v19
    v_sub_f32 v18, v58, v128
    v_sub_f32 v19, v59, v128
    v_fmac_f32 v20, v18, v18
    v_fmac_f32 v21, v19, v19
    v_sub_f32 v18, v60, v128
    v_sub_f32 v19, v61, v128
    v_fmac_f32 v20, v18, v18
    v_fmac_f32 v21, v19, v19
    v_sub_f32 v18, v62, v128
    v_sub_f32 v19, v63, v128
    v_fmac_f32 v20, v18, v18
    v_fmac_f32 v21, v19, v19
    v_sub_f32 v18, v64, v128
    v_sub_f32 v19, v65, v128
    v_fmac_f32 v20, v18, v18
    v_fmac_f32 v21, v19, v19
    v_sub_f32 v18, v66, v128
    v_sub_f32 v19, v67, v128
    v_fmac_f32 v20, v18, v18
    v_fmac_f32 v21, v19, v19
    v_sub_f32 v18, v68, v128
    v_sub_f32 v19, v69, v128
    v_fmac_f32 v20, v18, v18
    v_fmac_f32 v21, v19, v19
    v_sub_f32 v18, v70, v128
    v_sub_f32 v19, v71, v128
    v_fmac_f32 v20, v18, v18
    v_fmac_f32 v21, v19, v19
    v_add_f32 v17, v20, v21
    s_nop 1
    v_add_f32_dpp v17, v17, v17 row_ror:1 row_mask:0xf bank_mask:0xf
    s_nop 1
    v_add_f32_dpp v17, v17, v17 row_ror:2 row_mask:0xf bank_mask:0xf
    s_nop 1
    v_add_f32_dpp v17, v17, v17 row_ror:4 row_mask:0xf bank_mask:0xf
    s_nop 1
    v_add_f32_dpp v17, v17, v17 row_ror:8 row_mask:0xf bank_mask:0xf
    v_mov_b32 v20, v17
    s_nop 1
    v_permlane16_swap_b32 v17, v20
    v_add_f32 v17, v17, v20
    v_mov_b32 v20, v17
    s_nop 1
    v_permlane32_swap_b32 v17, v20
    v_add_f32 v17, v17, v20
    v_mul_f32 v17, 0x3a800000, v17
    v_cvt_pk_bf16_f32 v128, v128, v128
    v_lshlrev_b32 v128, 16, v128
    v_cvt_pk_bf16_f32 v17, v17, v17
    v_lshlrev_b32 v17, 16, v17
    v_add_f32 v17, 0x3727c5ac, v17
    v_cvt_pk_bf16_f32 v17, v17, v17
    v_lshlrev_b32 v17, 16, v17
    v_sqrt_f32 v129, v17
    s_nop 0
    v_cvt_pk_bf16_f32 v129, v129, v129
    v_lshlrev_b32 v129, 16, v129
    v_rcp_f32 v130, v129
    s_lshl_b32 s16, s3, 4
    s_add_u32 s16, s16, 67600
    v_mov_b32 v19, s16
    ds_write_b128 v19, v[128:131]
    v_mov_b32 v19, 67584
    v_and_b32 v17, 31, v1
    v_lshlrev_b32 v18, 3, v17
    v_add_u32 v18, 65536, v18
    v_lshlrev_b32 v17, 4, v17
    s_waitcnt lgkmcnt(0)
    s_barrier
    ds_read_b32 v134, v19
    ds_read_b64 v[96:97], v18 offset:0
    ds_read_b64 v[100:101], v18 offset:256
    ds_read_b64 v[104:105], v18 offset:512
    ds_read_b64 v[108:109], v18 offset:768
    ds_read_b64 v[112:113], v18 offset:1024
    ds_read_b64 v[116:117], v18 offset:1280
    ds_read_b64 v[120:121], v18 offset:1536
    ds_read_b64 v[124:125], v18 offset:1792
    s_waitcnt lgkmcnt(8)
    v_readfirstlane_b32 s28, v134
    v_and_b32 v20, 7, v1
    v_lshlrev_b32 v20, 4, v20
    v_add_u32 v21, 67600, v20
    ds_read_b128 v[128:131], v21
    s_waitcnt lgkmcnt(0)
    v_mov_b32 v131, s28
    s_lshl_b32 s16, s2, 7
    s_add_u32 s16, s16, 0x520000
    s_cmp_eq_u32 s3, 0
    s_cselect_b32 s16, s16, 0x7ffffff0
    s_mov_b64 exec, 0xff
    buffer_store_dwordx4 v[128:131], v20, s[8:11], s16 offen sc1
    s_mov_b64 exec, -1
    v_pk_add_f32 v[96:97], v[96:97], v[112:113]
    v_pk_add_f32 v[100:101], v[100:101], v[116:117]
    v_pk_add_f32 v[104:105], v[104:105], v[120:121]
    v_pk_add_f32 v[108:109], v[108:109], v[124:125]
    v_pk_add_f32 v[96:97], v[96:97], v[104:105]
    v_pk_add_f32 v[100:101], v[100:101], v[108:109]
    v_pk_add_f32 v[96:97], v[96:97], v[100:101]
    v_mov_b32 v98, s28
    v_mov_b32 v99, s28
    s_lshl_b32 s16, s14, 3
    s_add_u32 s16, s16, s15
    s_lshl_b32 s16, s16, 9
    s_add_u32 s16, s16, 0x500000
    s_cmp_eq_u32 s3, 0
    s_cselect_b32 s16, s16, 0x7ffffff0
    s_mov_b64 exec, 0xffffffff
    buffer_store_dwordx4 v[96:99], v17, s[8:11], s16 offen sc1
    s_mov_b64 exec, -1
    s_cmp_lt_u32 s24, 8
    s_cbranch_scc1 adaLN_cond__sliding_block_cached__moe_arch_mod__prompt_kernel_kvS
    s_waitcnt vmcnt(4)
    v_lshl_or_b32 v84, v89, 16, v88
    v_lshl_or_b32 v85, v91, 16, v90
    s_waitcnt vmcnt(3)
    v_lshl_or_b32 v86, v93, 16, v92
    v_lshl_or_b32 v87, v95, 16, v94
    v_and_b32 v88, 0x7fff, v88
    v_and_b32 v89, 0x7fff, v89
    v_and_b32 v90, 0x7fff, v90
    v_and_b32 v91, 0x7fff, v91
    v_and_b32 v92, 0x7fff, v92
    v_and_b32 v93, 0x7fff, v93
    v_and_b32 v94, 0x7fff, v94
    v_and_b32 v95, 0x7fff, v95
    v_max3_u32 v88, v88, v89, v90
    v_max3_u32 v91, v91, v92, v93
    v_max3_u32 v88, v88, v94, v95
    v_max_u32 v88, v88, v91
    v_cmp_le_u32 vcc, 0x4980, v88
    v_mov_b32 v89, s28
    s_mov_b32 s16, 0x564000
    s_and_saveexec_b64 s[62:63], vcc
    buffer_store_dword v89, v132, s[8:11], s16 offen sc1
    s_mov_b64 exec, s[62:63]
adaLN_cond__sliding_block_cached__moe_arch_mod__prompt_kernel_kvS:
    s_waitcnt vmcnt(3)
    buffer_store_dwordx4 v[84:87], v2, s[8:11], s21 offen sc1
    s_lshr_b32 s16, s3, 2
    s_lshl_b32 s16, s16, 4
    s_add_u32 s16, s16, s31
    s_lshl_b32 s16, s16, 12
    s_and_b32 s17, s3, 3
    s_lshl_b32 s17, s17, 7
    s_add_u32 s16, s16, s17
    s_add_u32 s16, s16, 0x500000
    v_lshrrev_b32 v139, 3, v1
    v_lshlrev_b32 v139, 9, v139
    v_and_b32 v16, 7, v1
    v_lshl_add_u32 v139, v16, 4, v139
    v_and_b32 v140, 15, v1
    v_lshlrev_b32 v140, 4, v140
    s_lshl_b32 s17, s29, 8
    s_add_u32 s17, s17, 0x520000
    v_lshlrev_b32 v56, 16, v40
    v_and_b32 v57, 0xffff0000, v40
    v_lshlrev_b32 v58, 16, v41
    v_and_b32 v59, 0xffff0000, v41
    v_lshlrev_b32 v60, 16, v42
    v_and_b32 v61, 0xffff0000, v42
    v_lshlrev_b32 v62, 16, v43
    v_and_b32 v63, 0xffff0000, v43
    v_lshlrev_b32 v64, 16, v44
    v_and_b32 v65, 0xffff0000, v44
    v_lshlrev_b32 v66, 16, v45
    v_and_b32 v67, 0xffff0000, v45
    v_lshlrev_b32 v68, 16, v46
    v_and_b32 v69, 0xffff0000, v46
    v_lshlrev_b32 v70, 16, v47
    v_and_b32 v71, 0xffff0000, v47
    s_mov_b32 s27, 0
adaLN_cond__sliding_block_cached__moe_arch_mod__prompt_kernel_g14p:
    buffer_load_dwordx4 v[76:79], v139, s[8:11], s16 offen sc1
    buffer_load_dwordx4 v[80:83], v140, s[8:11], s17 offen sc1
    s_waitcnt vmcnt(1)
    v_cmp_ne_u32 vcc, s28, v78
    v_cmp_ne_u32 s[62:63], s28, v79
    s_or_b64 vcc, vcc, s[62:63]
    s_waitcnt vmcnt(0)
    v_cmp_ne_u32 s[62:63], s28, v83
    s_or_b64 vcc, vcc, s[62:63]
    s_add_u32 s27, s27, 1
    s_cmp_ge_u32 s27, 262144
    s_cbranch_scc1 adaLN_cond__sliding_block_cached__moe_arch_mod__prompt_kernel_g14g
    s_cbranch_vccnz adaLN_cond__sliding_block_cached__moe_arch_mod__prompt_kernel_g14p
adaLN_cond__sliding_block_cached__moe_arch_mod__prompt_kernel_g14g:
    v_add_f32_dpp v76, v76, v76 row_ror:8 row_mask:0xf bank_mask:0xf
    v_add_f32_dpp v77, v77, v77 row_ror:8 row_mask:0xf bank_mask:0xf
    v_mov_b32 v17, v76
    s_nop 1
    v_permlane16_swap_b32 v76, v17
    v_add_f32 v76, v76, v17
    v_mov_b32 v18, v77
    s_nop 1
    v_permlane16_swap_b32 v77, v18
    v_add_f32 v77, v77, v18
    v_mov_b32 v17, v76
    s_nop 1
    v_permlane32_swap_b32 v76, v17
    v_add_f32 v76, v76, v17
    v_mov_b32 v18, v77
    s_nop 1
    v_permlane32_swap_b32 v77, v18
    v_add_f32 v77, v77, v18
    v_cvt_pk_bf16_f32 v17, v76, v77
    v_lshlrev_b32 v76, 16, v17
    v_and_b32 v77, 0xffff0000, v17
    v_add_f32 v76, 1.0, v76
    v_add_f32 v77, 1.0, v77
    v_cvt_pk_bf16_f32 v17, v76, v77
    v_lshlrev_b32 v76, 16, v17
    v_and_b32 v77, 0xffff0000, v17
    s_lshl_b32 s16, s3, 6
    s_add_u32 s16, s16, 69632
    v_lshl_add_u32 v16, v16, 3, s16
    ds_write_b64 v16, v[76:77]
    v_lshrrev_b32 v17, 4, v1
    v_lshlrev_b32 v17, 5, v17
    v_add_u32 v17, 69632, v17
    v_sub_f32 v56, v56, v80
    v_sub_f32 v57, v57, v80
    v_sub_f32 v58, v58, v80
    v_sub_f32 v59, v59, v80
    v_sub_f32 v60, v60, v80
    v_sub_f32 v61, v61, v80
    v_sub_f32 v62, v62, v80
    v_sub_f32 v63, v63, v80
    v_sub_f32 v64, v64, v80
    v_sub_f32 v65, v65, v80
    v_sub_f32 v66, v66, v80
    v_sub_f32 v67, v67, v80
    v_sub_f32 v68, v68, v80
    v_sub_f32 v69, v69, v80
    v_sub_f32 v70, v70, v80
    v_sub_f32 v71, v71, v80
    v_cvt_pk_bf16_f32 v18, v56, v57
    v_lshlrev_b32 v56, 16, v18
    v_and_b32 v57, 0xffff0000, v18
    v_cvt_pk_bf16_f32 v19, v58, v59
    v_lshlrev_b32 v58, 16, v19
    v_and_b32 v59, 0xffff0000, v19
    v_cvt_pk_bf16_f32 v18, v60, v61
    v_lshlrev_b32 v60, 16, v18
    v_and_b32 v61, 0xffff0000, v18
    v_cvt_pk_bf16_f32 v19, v62, v63
    v_lshlrev_b32 v62, 16, v19
    v_and_b32 v63, 0xffff0000, v19
    v_cvt_pk_bf16_f32 v18, v64, v65
    v_lshlrev_b32 v64, 16, v18
    v_and_b32 v65, 0xffff0000, v18
    v_cvt_pk_bf16_f32 v19, v66, v67
    v_lshlrev_b32 v66, 16, v19
    v_and_b32 v67, 0xffff0000, v19
    v_cvt_pk_bf16_f32 v18, v68, v69
    v_lshlrev_b32 v68, 16, v18
    v_and_b32 v69, 0xffff0000, v18
    v_cvt_pk_bf16_f32 v19, v70, v71
    v_lshlrev_b32 v70, 16, v19
    v_and_b32 v71, 0xffff0000, v19
    v_mul_f32 v56, v56, v82
    v_mul_f32 v57, v57, v82
    v_mul_f32 v58, v58, v82
    v_mul_f32 v59, v59, v82
    v_mul_f32 v60, v60, v82
    v_mul_f32 v61, v61, v82
    v_mul_f32 v62, v62, v82
    v_mul_f32 v63, v63, v82
    v_mul_f32 v64, v64, v82
    v_mul_f32 v65, v65, v82
    v_mul_f32 v66, v66, v82
    v_mul_f32 v67, v67, v82
    v_mul_f32 v68, v68, v82
    v_mul_f32 v69, v69, v82
    v_mul_f32 v70, v70, v82
    v_mul_f32 v71, v71, v82
    v_cvt_pk_bf16_f32 v18, v56, v57
    v_lshlrev_b32 v56, 16, v18
    v_and_b32 v57, 0xffff0000, v18
    v_cvt_pk_bf16_f32 v19, v58, v59
    v_lshlrev_b32 v58, 16, v19
    v_and_b32 v59, 0xffff0000, v19
    v_cvt_pk_bf16_f32 v18, v60, v61
    v_lshlrev_b32 v60, 16, v18
    v_and_b32 v61, 0xffff0000, v18
    v_cvt_pk_bf16_f32 v19, v62, v63
    v_lshlrev_b32 v62, 16, v19
    v_and_b32 v63, 0xffff0000, v19
    v_cvt_pk_bf16_f32 v18, v64, v65
    v_lshlrev_b32 v64, 16, v18
    v_and_b32 v65, 0xffff0000, v18
    v_cvt_pk_bf16_f32 v19, v66, v67
    v_lshlrev_b32 v66, 16, v19
    v_and_b32 v67, 0xffff0000, v19
    v_cvt_pk_bf16_f32 v18, v68, v69
    v_lshlrev_b32 v68, 16, v18
    v_and_b32 v69, 0xffff0000, v18
    v_cvt_pk_bf16_f32 v19, v70, v71
    v_lshlrev_b32 v70, 16, v19
    v_and_b32 v71, 0xffff0000, v19
    s_lshl_b32 s16, s29, 15
    s_lshl_b32 s17, s31, 11
    s_add_u32 s16, s16, s17
    s_waitcnt lgkmcnt(0)
    s_barrier
    ds_read_b128 v[96:99], v17 offset:256
    ds_read_b128 v[104:107], v17 offset:0
    ds_read_b128 v[100:103], v17 offset:272
    ds_read_b128 v[108:111], v17 offset:16
    ds_read_b128 v[112:115], v17 offset:384
    ds_read_b128 v[120:123], v17 offset:128
    ds_read_b128 v[116:119], v17 offset:400
    ds_read_b128 v[124:127], v17 offset:144
    s_waitcnt lgkmcnt(7)
    v_pk_mul_f32 v[56:57], v[56:57], v[96:97]
    v_pk_mul_f32 v[58:59], v[58:59], v[98:99]
    s_waitcnt lgkmcnt(5)
    v_pk_mul_f32 v[60:61], v[60:61], v[100:101]
    v_pk_mul_f32 v[62:63], v[62:63], v[102:103]
    v_cvt_pk_bf16_f32 v18, v56, v57
    v_lshlrev_b32 v56, 16, v18
    v_and_b32 v57, 0xffff0000, v18
    v_cvt_pk_bf16_f32 v19, v58, v59
    v_lshlrev_b32 v58, 16, v19
    v_and_b32 v59, 0xffff0000, v19
    v_cvt_pk_bf16_f32 v18, v60, v61
    v_lshlrev_b32 v60, 16, v18
    v_and_b32 v61, 0xffff0000, v18
    v_cvt_pk_bf16_f32 v19, v62, v63
    v_lshlrev_b32 v62, 16, v19
    v_and_b32 v63, 0xffff0000, v19
    v_pk_add_f32 v[56:57], v[56:57], v[104:105]
    v_pk_add_f32 v[58:59], v[58:59], v[106:107]
    s_waitcnt lgkmcnt(4)
    v_pk_add_f32 v[60:61], v[60:61], v[108:109]
    v_pk_add_f32 v[62:63], v[62:63], v[110:111]
    v_cvt_pk_bf16_f32 v32, v56, v57
    v_cvt_pk_bf16_f32 v33, v58, v59
    v_cvt_pk_bf16_f32 v34, v60, v61
    v_cvt_pk_bf16_f32 v35, v62, v63
    buffer_store_dwordx4 v[32:35], v2, s[8:11], s16 offen offset:0 sc1
    s_waitcnt lgkmcnt(3)
    v_pk_mul_f32 v[64:65], v[64:65], v[112:113]
    v_pk_mul_f32 v[66:67], v[66:67], v[114:115]
    s_waitcnt lgkmcnt(1)
    v_pk_mul_f32 v[68:69], v[68:69], v[116:117]
    v_pk_mul_f32 v[70:71], v[70:71], v[118:119]
    v_cvt_pk_bf16_f32 v18, v64, v65
    v_lshlrev_b32 v64, 16, v18
    v_and_b32 v65, 0xffff0000, v18
    v_cvt_pk_bf16_f32 v19, v66, v67
    v_lshlrev_b32 v66, 16, v19
    v_and_b32 v67, 0xffff0000, v19
    v_cvt_pk_bf16_f32 v18, v68, v69
    v_lshlrev_b32 v68, 16, v18
    v_and_b32 v69, 0xffff0000, v18
    v_cvt_pk_bf16_f32 v19, v70, v71
    v_lshlrev_b32 v70, 16, v19
    v_and_b32 v71, 0xffff0000, v19
    v_pk_add_f32 v[64:65], v[64:65], v[120:121]
    v_pk_add_f32 v[66:67], v[66:67], v[122:123]
    s_waitcnt lgkmcnt(0)
    v_pk_add_f32 v[68:69], v[68:69], v[124:125]
    v_pk_add_f32 v[70:71], v[70:71], v[126:127]
    v_cvt_pk_bf16_f32 v36, v64, v65
    v_cvt_pk_bf16_f32 v37, v66, v67
    v_cvt_pk_bf16_f32 v38, v68, v69
    v_cvt_pk_bf16_f32 v39, v70, v71
    buffer_store_dwordx4 v[36:39], v2, s[8:11], s16 offen offset:1024 sc1
    s_lshl_b32 s19, s3, 16
    s_lshl_b32 s20, s3, 11
    s_lshl_b32 s16, s12, 8
    s_add_u32 s4, s38, s16
    s_addc_u32 s5, s39, 0
    s_sub_u32 s6, 0x800000, s16
    s_mov_b32 s7, 0x20000
    v_mov_b32 v134, s28
    s_lshl_b32 s16, s29, 4
    s_add_u32 s16, s16, s31
    s_lshl_b32 s16, s16, 2
    s_add_u32 s16, s16, 0x528000
    v_and_b32 v16, 31, v1
    v_lshlrev_b32 v16, 2, v16
    s_lshl_b32 s17, s13, 3
    s_add_u32 s17, s17, s3
    s_lshl_b32 s17, s17, 7
    s_add_u32 s17, s17, 0x528000
    s_waitcnt vmcnt(0)
    s_mov_b64 exec, 1
    buffer_store_dword v134, v132, s[8:11], s16 offen sc1
    s_mov_b64 exec, -1
    s_add_u32 s22, s19, 0x0
    s_add_u32 m0, s20, 0x0
    s_nop 0
    buffer_load_dwordx4 v3, s[4:7], s22 offen lds
    s_add_u32 s22, s19, 0x8000
    s_add_u32 m0, s20, 0x400
    s_nop 0
    buffer_load_dwordx4 v3, s[4:7], s22 offen lds
    s_add_u32 s22, s19, 0x80000
    s_add_u32 m0, s20, 0x4000
    s_nop 0
    buffer_load_dwordx4 v3, s[4:7], s22 offen lds
    s_add_u32 s22, s19, 0x88000
    s_add_u32 m0, s20, 0x4400
    s_nop 0
    buffer_load_dwordx4 v3, s[4:7], s22 offen lds
    s_add_u32 s22, s19, 0x100000
    s_add_u32 m0, s20, 0x8000
    s_nop 0
    buffer_load_dwordx4 v3, s[4:7], s22 offen lds
    s_add_u32 s22, s19, 0x108000
    s_add_u32 m0, s20, 0x8400
    s_nop 0
    buffer_load_dwordx4 v3, s[4:7], s22 offen lds
    s_sleep 40
    s_mov_b32 s27, 0
adaLN_cond__sliding_block_cached__moe_arch_mod__prompt_kernel_h15p:
    buffer_load_dword v17, v16, s[8:11], s17 offen sc1
    s_waitcnt vmcnt(0)
    v_cmp_ne_u32 vcc, s28, v17
    s_add_u32 s27, s27, 1
    s_cmp_ge_u32 s27, 262144
    s_cbranch_scc1 adaLN_cond__sliding_block_cached__moe_arch_mod__prompt_kernel_h15g
    s_cbranch_vccnz adaLN_cond__sliding_block_cached__moe_arch_mod__prompt_kernel_h15p
adaLN_cond__sliding_block_cached__moe_arch_mod__prompt_kernel_h15g:
    s_mov_b32 s23, 0x0
    buffer_load_dwordx4 v[88:91], v7, s[8:11], s23 offen offset:0 sc1
    s_mov_b32 s23, 0x8000
    buffer_load_dwordx4 v[92:95], v7, s[8:11], s23 offen offset:0 sc1
    s_mov_b32 s23, 0x0
    buffer_load_dwordx4 v[96:99], v7, s[8:11], s23 offen offset:1024 sc1
    s_mov_b32 s23, 0x8000
    buffer_load_dwordx4 v[100:103], v7, s[8:11], s23 offen offset:1024 sc1
    s_mov_b32 s23, 0x800
    buffer_load_dwordx4 v[104:107], v7, s[8:11], s23 offen offset:0 sc1
    s_mov_b32 s23, 0x8800
    buffer_load_dwordx4 v[108:111], v7, s[8:11], s23 offen offset:0 sc1
    s_mov_b32 s23, 0x800
    buffer_load_dwordx4 v[112:115], v7, s[8:11], s23 offen offset:1024 sc1
    s_mov_b32 s23, 0x8800
    buffer_load_dwordx4 v[116:119], v7, s[8:11], s23 offen offset:1024 sc1
    s_lshr_b32 s21, s12, 3
    s_lshl_b32 s21, s21, 17
    s_add_u32 s21, s21, s20
    s_add_u32 s21, s21, 0x400000
    s_barrier
    ds_read_b64_tr_b16 v[224:225], v4 offset:0
    ds_read_b64_tr_b16 v[226:227], v4 offset:1024
    ds_read_b64_tr_b16 v[228:229], v5 offset:32
    ds_read_b64_tr_b16 v[230:231], v5 offset:1056
    ds_read_b64_tr_b16 v[232:233], v4 offset:256
    ds_read_b64_tr_b16 v[234:235], v4 offset:1280
    ds_read_b64_tr_b16 v[236:237], v5 offset:288
    ds_read_b64_tr_b16 v[238:239], v5 offset:1312
    s_waitcnt vmcnt(7) lgkmcnt(6)
    v_mfma_f32_16x16x32_bf16 v[24:27], v[224:227], v[88:91], 0
    ds_read_b64_tr_b16 v[240:241], v4 offset:512
    s_waitcnt vmcnt(6)
    v_mfma_f32_16x16x32_bf16 v[28:31], v[224:227], v[92:95], 0
    ds_read_b64_tr_b16 v[242:243], v4 offset:1536
    s_waitcnt lgkmcnt(6)
    v_mfma_f32_16x16x32_bf16 v[32:35], v[228:231], v[88:91], 0
    ds_read_b64_tr_b16 v[244:245], v5 offset:544
    v_mfma_f32_16x16x32_bf16 v[36:39], v[228:231], v[92:95], 0
    ds_read_b64_tr_b16 v[246:247], v5 offset:1568
    s_mov_b32 s23, 0x1000
    buffer_load_dwordx4 v[120:123], v7, s[8:11], s23 offen offset:0 sc1
    s_waitcnt lgkmcnt(6)
    v_mfma_f32_16x16x32_bf16 v[40:43], v[232:235], v[88:91], 0
    ds_read_b64_tr_b16 v[224:225], v4 offset:768
    v_mfma_f32_16x16x32_bf16 v[44:47], v[232:235], v[92:95], 0
    ds_read_b64_tr_b16 v[226:227], v4 offset:1792
    s_waitcnt lgkmcnt(6)
    v_mfma_f32_16x16x32_bf16 v[48:51], v[236:239], v[88:91], 0
    ds_read_b64_tr_b16 v[228:229], v5 offset:800
    v_mfma_f32_16x16x32_bf16 v[52:55], v[236:239], v[92:95], 0
    ds_read_b64_tr_b16 v[230:231], v5 offset:1824
    s_waitcnt lgkmcnt(6)
    v_mfma_f32_16x16x32_bf16 v[56:59], v[240:243], v[88:91], 0
    ds_read_b64_tr_b16 v[232:233], v4 offset:8192
    v_mfma_f32_16x16x32_bf16 v[60:63], v[240:243], v[92:95], 0
    ds_read_b64_tr_b16 v[234:235], v4 offset:9216
    s_waitcnt lgkmcnt(6)
    v_mfma_f32_16x16x32_bf16 v[64:67], v[244:247], v[88:91], 0
    ds_read_b64_tr_b16 v[236:237], v5 offset:8224
    v_mfma_f32_16x16x32_bf16 v[68:71], v[244:247], v[92:95], 0
    ds_read_b64_tr_b16 v[238:239], v5 offset:9248
    s_mov_b32 s23, 0x9000
    buffer_load_dwordx4 v[124:127], v7, s[8:11], s23 offen offset:0 sc1
    s_waitcnt lgkmcnt(6)
    v_mfma_f32_16x16x32_bf16 v[72:75], v[224:227], v[88:91], 0
    ds_read_b64_tr_b16 v[240:241], v4 offset:8448
    v_mfma_f32_16x16x32_bf16 v[76:79], v[224:227], v[92:95], 0
    ds_read_b64_tr_b16 v[242:243], v4 offset:9472
    s_waitcnt lgkmcnt(6)
    v_mfma_f32_16x16x32_bf16 v[80:83], v[228:231], v[88:91], 0
    ds_read_b64_tr_b16 v[244:245], v5 offset:8480
    v_mfma_f32_16x16x32_bf16 v[84:87], v[228:231], v[92:95], 0
    ds_read_b64_tr_b16 v[246:247], v5 offset:9504
    s_waitcnt vmcnt(7) lgkmcnt(6)
    v_mfma_f32_16x16x32_bf16 v[24:27], v[232:235], v[96:99], v[24:27]
    ds_read_b64_tr_b16 v[224:225], v4 offset:8704
    s_waitcnt vmcnt(6)
    v_mfma_f32_16x16x32_bf16 v[28:31], v[232:235], v[100:103], v[28:31]
    ds_read_b64_tr_b16 v[226:227], v4 offset:9728
    s_waitcnt lgkmcnt(6)
    v_mfma_f32_16x16x32_bf16 v[32:35], v[236:239], v[96:99], v[32:35]
    ds_read_b64_tr_b16 v[228:229], v5 offset:8736
    v_mfma_f32_16x16x32_bf16 v[36:39], v[236:239], v[100:103], v[36:39]
    ds_read_b64_tr_b16 v[230:231], v5 offset:9760
    s_mov_b32 s23, 0x1000
    buffer_load_dwordx4 v[128:131], v7, s[8:11], s23 offen offset:1024 sc1
    s_waitcnt lgkmcnt(6)
    v_mfma_f32_16x16x32_bf16 v[40:43], v[240:243], v[96:99], v[40:43]
    ds_read_b64_tr_b16 v[232:233], v4 offset:8960
    v_mfma_f32_16x16x32_bf16 v[44:47], v[240:243], v[100:103], v[44:47]
    ds_read_b64_tr_b16 v[234:235], v4 offset:9984
    s_waitcnt lgkmcnt(6)
    v_mfma_f32_16x16x32_bf16 v[48:51], v[244:247], v[96:99], v[48:51]
    ds_read_b64_tr_b16 v[236:237], v5 offset:8992
    v_mfma_f32_16x16x32_bf16 v[52:55], v[244:247], v[100:103], v[52:55]
    ds_read_b64_tr_b16 v[238:239], v5 offset:10016
    s_waitcnt lgkmcnt(6)
    v_mfma_f32_16x16x32_bf16 v[56:59], v[224:227], v[96:99], v[56:59]
    v_mfma_f32_16x16x32_bf16 v[60:63], v[224:227], v[100:103], v[60:63]
    s_barrier
    ds_read_b64_tr_b16 v[240:241], v4 offset:16384
    ds_read_b64_tr_b16 v[242:243], v4 offset:17408
    s_waitcnt lgkmcnt(6)
    v_mfma_f32_16x16x32_bf16 v[64:67], v[228:231], v[96:99], v[64:67]
    ds_read_b64_tr_b16 v[244:245], v5 offset:16416
    v_mfma_f32_16x16x32_bf16 v[68:71], v[228:231], v[100:103], v[68:71]
    s_add_u32 s22, s19, 0x180000
    s_add_u32 m0, s20, 0xc000
    s_nop 0
    buffer_load_dwordx4 v3, s[4:7], s22 offen lds
    ds_read_b64_tr_b16 v[246:247], v5 offset:17440
    s_mov_b32 s23, 0x9000
    buffer_load_dwordx4 v[132:135], v7, s[8:11], s23 offen offset:1024 sc1
    s_waitcnt lgkmcnt(6)
    v_mfma_f32_16x16x32_bf16 v[72:75], v[232:235], v[96:99], v[72:75]
    ds_read_b64_tr_b16 v[224:225], v4 offset:16640
    v_mfma_f32_16x16x32_bf16 v[76:79], v[232:235], v[100:103], v[76:79]
    ds_read_b64_tr_b16 v[226:227], v4 offset:17664
    s_waitcnt lgkmcnt(6)
    v_mfma_f32_16x16x32_bf16 v[80:83], v[236:239], v[96:99], v[80:83]
    ds_read_b64_tr_b16 v[228:229], v5 offset:16672
    v_mfma_f32_16x16x32_bf16 v[84:87], v[236:239], v[100:103], v[84:87]
    ds_read_b64_tr_b16 v[230:231], v5 offset:17696
    s_waitcnt vmcnt(8) lgkmcnt(6)
    v_mfma_f32_16x16x32_bf16 v[24:27], v[240:243], v[104:107], v[24:27]
    ds_read_b64_tr_b16 v[232:233], v4 offset:16896
    s_waitcnt vmcnt(7)
    v_mfma_f32_16x16x32_bf16 v[28:31], v[240:243], v[108:111], v[28:31]
    ds_read_b64_tr_b16 v[234:235], v4 offset:17920
    s_waitcnt lgkmcnt(6)
    v_mfma_f32_16x16x32_bf16 v[32:35], v[244:247], v[104:107], v[32:35]
    ds_read_b64_tr_b16 v[236:237], v5 offset:16928
    v_mfma_f32_16x16x32_bf16 v[36:39], v[244:247], v[108:111], v[36:39]
    s_add_u32 s22, s19, 0x188000
    s_add_u32 m0, s20, 0xc400
    s_nop 0
    buffer_load_dwordx4 v3, s[4:7], s22 offen lds
    ds_read_b64_tr_b16 v[238:239], v5 offset:17952
    s_mov_b32 s23, 0x1800
    buffer_load_dwordx4 v[88:91], v7, s[8:11], s23 offen offset:0 sc1
    s_waitcnt lgkmcnt(6)
    v_mfma_f32_16x16x32_bf16 v[40:43], v[224:227], v[104:107], v[40:43]
    ds_read_b64_tr_b16 v[240:241], v4 offset:17152
    v_mfma_f32_16x16x32_bf16 v[44:47], v[224:227], v[108:111], v[44:47]
    ds_read_b64_tr_b16 v[242:243], v4 offset:18176
    s_waitcnt lgkmcnt(6)
    v_mfma_f32_16x16x32_bf16 v[48:51], v[228:231], v[104:107], v[48:51]
    ds_read_b64_tr_b16 v[244:245], v5 offset:17184
    v_mfma_f32_16x16x32_bf16 v[52:55], v[228:231], v[108:111], v[52:55]
    ds_read_b64_tr_b16 v[246:247], v5 offset:18208
    s_waitcnt lgkmcnt(6)
    v_mfma_f32_16x16x32_bf16 v[56:59], v[232:235], v[104:107], v[56:59]
    ds_read_b64_tr_b16 v[224:225], v4 offset:24576
    v_mfma_f32_16x16x32_bf16 v[60:63], v[232:235], v[108:111], v[60:63]
    ds_read_b64_tr_b16 v[226:227], v4 offset:25600
    s_waitcnt lgkmcnt(6)
    v_mfma_f32_16x16x32_bf16 v[64:67], v[236:239], v[104:107], v[64:67]
    ds_read_b64_tr_b16 v[228:229], v5 offset:24608
    v_mfma_f32_16x16x32_bf16 v[68:71], v[236:239], v[108:111], v[68:71]
    ds_read_b64_tr_b16 v[230:231], v5 offset:25632
    s_mov_b32 s23, 0x9800
    buffer_load_dwordx4 v[92:95], v7, s[8:11], s23 offen offset:0 sc1
    s_waitcnt lgkmcnt(6)
    v_mfma_f32_16x16x32_bf16 v[72:75], v[240:243], v[104:107], v[72:75]
    ds_read_b64_tr_b16 v[232:233], v4 offset:24832
    v_mfma_f32_16x16x32_bf16 v[76:79], v[240:243], v[108:111], v[76:79]
    ds_read_b64_tr_b16 v[234:235], v4 offset:25856
    s_waitcnt lgkmcnt(6)
    v_mfma_f32_16x16x32_bf16 v[80:83], v[244:247], v[104:107], v[80:83]
    ds_read_b64_tr_b16 v[236:237], v5 offset:24864
    v_mfma_f32_16x16x32_bf16 v[84:87], v[244:247], v[108:111], v[84:87]
    ds_read_b64_tr_b16 v[238:239], v5 offset:25888
    s_waitcnt vmcnt(9) lgkmcnt(6)
    v_mfma_f32_16x16x32_bf16 v[24:27], v[224:227], v[112:115], v[24:27]
    ds_read_b64_tr_b16 v[240:241], v4 offset:25088
    s_waitcnt vmcnt(8)
    v_mfma_f32_16x16x32_bf16 v[28:31], v[224:227], v[116:119], v[28:31]
    ds_read_b64_tr_b16 v[242:243], v4 offset:26112
    s_waitcnt lgkmcnt(6)
    v_mfma_f32_16x16x32_bf16 v[32:35], v[228:231], v[112:115], v[32:35]
    ds_read_b64_tr_b16 v[244:245], v5 offset:25120
    v_mfma_f32_16x16x32_bf16 v[36:39], v[228:231], v[116:119], v[36:39]
    ds_read_b64_tr_b16 v[246:247], v5 offset:26144
    s_mov_b32 s23, 0x1800
    buffer_load_dwordx4 v[96:99], v7, s[8:11], s23 offen offset:1024 sc1
    s_waitcnt lgkmcnt(6)
    v_mfma_f32_16x16x32_bf16 v[40:43], v[232:235], v[112:115], v[40:43]
    ds_read_b64_tr_b16 v[224:225], v4 offset:25344
    v_mfma_f32_16x16x32_bf16 v[44:47], v[232:235], v[116:119], v[44:47]
    ds_read_b64_tr_b16 v[226:227], v4 offset:26368
    s_waitcnt lgkmcnt(6)
    v_mfma_f32_16x16x32_bf16 v[48:51], v[236:239], v[112:115], v[48:51]
    ds_read_b64_tr_b16 v[228:229], v5 offset:25376
    v_mfma_f32_16x16x32_bf16 v[52:55], v[236:239], v[116:119], v[52:55]
    ds_read_b64_tr_b16 v[230:231], v5 offset:26400
    s_waitcnt lgkmcnt(6)
    v_mfma_f32_16x16x32_bf16 v[56:59], v[240:243], v[112:115], v[56:59]
    v_mfma_f32_16x16x32_bf16 v[60:63], v[240:243], v[116:119], v[60:63]
    s_barrier
    ds_read_b64_tr_b16 v[232:233], v4 offset:32768
    ds_read_b64_tr_b16 v[234:235], v4 offset:33792
    s_waitcnt lgkmcnt(6)
    v_mfma_f32_16x16x32_bf16 v[64:67], v[244:247], v[112:115], v[64:67]
    ds_read_b64_tr_b16 v[236:237], v5 offset:32800
    v_mfma_f32_16x16x32_bf16 v[68:71], v[244:247], v[116:119], v[68:71]
    s_add_u32 s22, s19, 0x200000
    s_add_u32 m0, s20, 0x0
    s_nop 0
    buffer_load_dwordx4 v3, s[4:7], s22 offen lds
    ds_read_b64_tr_b16 v[238:239], v5 offset:33824
    s_mov_b32 s23, 0x9800
    buffer_load_dwordx4 v[100:103], v7, s[8:11], s23 offen offset:1024 sc1
    s_waitcnt lgkmcnt(6)
    v_mfma_f32_16x16x32_bf16 v[72:75], v[224:227], v[112:115], v[72:75]
    ds_read_b64_tr_b16 v[240:241], v4 offset:33024
    v_mfma_f32_16x16x32_bf16 v[76:79], v[224:227], v[116:119], v[76:79]
    ds_read_b64_tr_b16 v[242:243], v4 offset:34048
    s_waitcnt lgkmcnt(6)
    v_mfma_f32_16x16x32_bf16 v[80:83], v[228:231], v[112:115], v[80:83]
    ds_read_b64_tr_b16 v[244:245], v5 offset:33056
    v_mfma_f32_16x16x32_bf16 v[84:87], v[228:231], v[116:119], v[84:87]
    ds_read_b64_tr_b16 v[246:247], v5 offset:34080
    s_waitcnt vmcnt(10) lgkmcnt(6)
    v_mfma_f32_16x16x32_bf16 v[24:27], v[232:235], v[120:123], v[24:27]
    ds_read_b64_tr_b16 v[224:225], v4 offset:33280
    s_waitcnt vmcnt(9)
    v_mfma_f32_16x16x32_bf16 v[28:31], v[232:235], v[124:127], v[28:31]
    ds_read_b64_tr_b16 v[226:227], v4 offset:34304
    s_waitcnt lgkmcnt(6)
    v_mfma_f32_16x16x32_bf16 v[32:35], v[236:239], v[120:123], v[32:35]
    ds_read_b64_tr_b16 v[228:229], v5 offset:33312
    v_mfma_f32_16x16x32_bf16 v[36:39], v[236:239], v[124:127], v[36:39]
    s_add_u32 s22, s19, 0x208000
    s_add_u32 m0, s20, 0x400
    s_nop 0
    buffer_load_dwordx4 v3, s[4:7], s22 offen lds
    ds_read_b64_tr_b16 v[230:231], v5 offset:34336
    s_mov_b32 s23, 0x2000
    buffer_load_dwordx4 v[104:107], v7, s[8:11], s23 offen offset:0 sc1
    s_waitcnt lgkmcnt(6)
    v_mfma_f32_16x16x32_bf16 v[40:43], v[240:243], v[120:123], v[40:43]
    ds_read_b64_tr_b16 v[232:233], v4 offset:33536
    v_mfma_f32_16x16x32_bf16 v[44:47], v[240:243], v[124:127], v[44:47]
    ds_read_b64_tr_b16 v[234:235], v4 offset:34560
    s_waitcnt lgkmcnt(6)
    v_mfma_f32_16x16x32_bf16 v[48:51], v[244:247], v[120:123], v[48:51]
    ds_read_b64_tr_b16 v[236:237], v5 offset:33568
    v_mfma_f32_16x16x32_bf16 v[52:55], v[244:247], v[124:127], v[52:55]
    ds_read_b64_tr_b16 v[238:239], v5 offset:34592
    s_waitcnt lgkmcnt(6)
    v_mfma_f32_16x16x32_bf16 v[56:59], v[224:227], v[120:123], v[56:59]
    ds_read_b64_tr_b16 v[240:241], v4 offset:40960
    v_mfma_f32_16x16x32_bf16 v[60:63], v[224:227], v[124:127], v[60:63]
    ds_read_b64_tr_b16 v[242:243], v4 offset:41984
    s_waitcnt lgkmcnt(6)
    v_mfma_f32_16x16x32_bf16 v[64:67], v[228:231], v[120:123], v[64:67]
    ds_read_b64_tr_b16 v[244:245], v5 offset:40992
    v_mfma_f32_16x16x32_bf16 v[68:71], v[228:231], v[124:127], v[68:71]
    ds_read_b64_tr_b16 v[246:247], v5 offset:42016
    s_mov_b32 s23, 0xa000
    buffer_load_dwordx4 v[108:111], v7, s[8:11], s23 offen offset:0 sc1
    s_waitcnt lgkmcnt(6)
    v_mfma_f32_16x16x32_bf16 v[72:75], v[232:235], v[120:123], v[72:75]
    ds_read_b64_tr_b16 v[224:225], v4 offset:41216
    v_mfma_f32_16x16x32_bf16 v[76:79], v[232:235], v[124:127], v[76:79]
    ds_read_b64_tr_b16 v[226:227], v4 offset:42240
    s_waitcnt lgkmcnt(6)
    v_mfma_f32_16x16x32_bf16 v[80:83], v[236:239], v[120:123], v[80:83]
    ds_read_b64_tr_b16 v[228:229], v5 offset:41248
    v_mfma_f32_16x16x32_bf16 v[84:87], v[236:239], v[124:127], v[84:87]
    ds_read_b64_tr_b16 v[230:231], v5 offset:42272
    s_waitcnt vmcnt(11) lgkmcnt(6)
    v_mfma_f32_16x16x32_bf16 v[24:27], v[240:243], v[128:131], v[24:27]
    ds_read_b64_tr_b16 v[232:233], v4 offset:41472
    s_waitcnt vmcnt(9)
    v_mfma_f32_16x16x32_bf16 v[28:31], v[240:243], v[132:135], v[28:31]
    ds_read_b64_tr_b16 v[234:235], v4 offset:42496
    s_waitcnt lgkmcnt(6)
    v_mfma_f32_16x16x32_bf16 v[32:35], v[244:247], v[128:131], v[32:35]
    ds_read_b64_tr_b16 v[236:237], v5 offset:41504
    v_mfma_f32_16x16x32_bf16 v[36:39], v[244:247], v[132:135], v[36:39]
    ds_read_b64_tr_b16 v[238:239], v5 offset:42528
    s_mov_b32 s23, 0x2000
    buffer_load_dwordx4 v[112:115], v7, s[8:11], s23 offen offset:1024 sc1
    s_waitcnt lgkmcnt(6)
    v_mfma_f32_16x16x32_bf16 v[40:43], v[224:227], v[128:131], v[40:43]
    ds_read_b64_tr_b16 v[240:241], v4 offset:41728
    v_mfma_f32_16x16x32_bf16 v[44:47], v[224:227], v[132:135], v[44:47]
    ds_read_b64_tr_b16 v[242:243], v4 offset:42752
    s_waitcnt lgkmcnt(6)
    v_mfma_f32_16x16x32_bf16 v[48:51], v[228:231], v[128:131], v[48:51]
    ds_read_b64_tr_b16 v[244:245], v5 offset:41760
    v_mfma_f32_16x16x32_bf16 v[52:55], v[228:231], v[132:135], v[52:55]
    ds_read_b64_tr_b16 v[246:247], v5 offset:42784
    s_waitcnt lgkmcnt(6)
    v_mfma_f32_16x16x32_bf16 v[56:59], v[232:235], v[128:131], v[56:59]
    v_mfma_f32_16x16x32_bf16 v[60:63], v[232:235], v[132:135], v[60:63]
    s_waitcnt vmcnt(9)
    s_barrier
    ds_read_b64_tr_b16 v[224:225], v4 offset:49152
    ds_read_b64_tr_b16 v[226:227], v4 offset:50176
    s_waitcnt lgkmcnt(6)
    v_mfma_f32_16x16x32_bf16 v[64:67], v[236:239], v[128:131], v[64:67]
    ds_read_b64_tr_b16 v[228:229], v5 offset:49184
    v_mfma_f32_16x16x32_bf16 v[68:71], v[236:239], v[132:135], v[68:71]
    s_add_u32 s22, s19, 0x280000
    s_add_u32 m0, s20, 0x4000
    s_nop 0
    buffer_load_dwordx4 v3, s[4:7], s22 offen lds
    ds_read_b64_tr_b16 v[230:231], v5 offset:50208
    s_mov_b32 s23, 0xa000
    buffer_load_dwordx4 v[116:119], v7, s[8:11], s23 offen offset:1024 sc1
    s_waitcnt lgkmcnt(6)
    v_mfma_f32_16x16x32_bf16 v[72:75], v[240:243], v[128:131], v[72:75]
    ds_read_b64_tr_b16 v[232:233], v4 offset:49408
    v_mfma_f32_16x16x32_bf16 v[76:79], v[240:243], v[132:135], v[76:79]
    ds_read_b64_tr_b16 v[234:235], v4 offset:50432
    s_waitcnt lgkmcnt(6)
    v_mfma_f32_16x16x32_bf16 v[80:83], v[244:247], v[128:131], v[80:83]
    ds_read_b64_tr_b16 v[236:237], v5 offset:49440
    v_mfma_f32_16x16x32_bf16 v[84:87], v[244:247], v[132:135], v[84:87]
    ds_read_b64_tr_b16 v[238:239], v5 offset:50464
    s_waitcnt vmcnt(10) lgkmcnt(6)
    v_mfma_f32_16x16x32_bf16 v[24:27], v[224:227], v[88:91], v[24:27]
    ds_read_b64_tr_b16 v[240:241], v4 offset:49664
    s_waitcnt vmcnt(9)
    v_mfma_f32_16x16x32_bf16 v[28:31], v[224:227], v[92:95], v[28:31]
    ds_read_b64_tr_b16 v[242:243], v4 offset:50688
    s_waitcnt lgkmcnt(6)
    v_mfma_f32_16x16x32_bf16 v[32:35], v[228:231], v[88:91], v[32:35]
    ds_read_b64_tr_b16 v[244:245], v5 offset:49696
    v_mfma_f32_16x16x32_bf16 v[36:39], v[228:231], v[92:95], v[36:39]
    s_add_u32 s22, s19, 0x288000
    s_add_u32 m0, s20, 0x4400
    s_nop 0
    buffer_load_dwordx4 v3, s[4:7], s22 offen lds
    ds_read_b64_tr_b16 v[246:247], v5 offset:50720
    s_mov_b32 s23, 0x2800
    buffer_load_dwordx4 v[120:123], v7, s[8:11], s23 offen offset:0 sc1
    s_waitcnt lgkmcnt(6)
    v_mfma_f32_16x16x32_bf16 v[40:43], v[232:235], v[88:91], v[40:43]
    ds_read_b64_tr_b16 v[224:225], v4 offset:49920
    v_mfma_f32_16x16x32_bf16 v[44:47], v[232:235], v[92:95], v[44:47]
    ds_read_b64_tr_b16 v[226:227], v4 offset:50944
    s_waitcnt lgkmcnt(6)
    v_mfma_f32_16x16x32_bf16 v[48:51], v[236:239], v[88:91], v[48:51]
    ds_read_b64_tr_b16 v[228:229], v5 offset:49952
    v_mfma_f32_16x16x32_bf16 v[52:55], v[236:239], v[92:95], v[52:55]
    ds_read_b64_tr_b16 v[230:231], v5 offset:50976
    s_waitcnt lgkmcnt(6)
    v_mfma_f32_16x16x32_bf16 v[56:59], v[240:243], v[88:91], v[56:59]
    ds_read_b64_tr_b16 v[232:233], v4 offset:57344
    v_mfma_f32_16x16x32_bf16 v[60:63], v[240:243], v[92:95], v[60:63]
    ds_read_b64_tr_b16 v[234:235], v4 offset:58368
    s_waitcnt lgkmcnt(6)
    v_mfma_f32_16x16x32_bf16 v[64:67], v[244:247], v[88:91], v[64:67]
    ds_read_b64_tr_b16 v[236:237], v5 offset:57376
    v_mfma_f32_16x16x32_bf16 v[68:71], v[244:247], v[92:95], v[68:71]
    ds_read_b64_tr_b16 v[238:239], v5 offset:58400
    s_mov_b32 s23, 0xa800
    buffer_load_dwordx4 v[124:127], v7, s[8:11], s23 offen offset:0 sc1
    s_waitcnt lgkmcnt(6)
    v_mfma_f32_16x16x32_bf16 v[72:75], v[224:227], v[88:91], v[72:75]
    ds_read_b64_tr_b16 v[240:241], v4 offset:57600
    v_mfma_f32_16x16x32_bf16 v[76:79], v[224:227], v[92:95], v[76:79]
    ds_read_b64_tr_b16 v[242:243], v4 offset:58624
    s_waitcnt lgkmcnt(6)
    v_mfma_f32_16x16x32_bf16 v[80:83], v[228:231], v[88:91], v[80:83]
    ds_read_b64_tr_b16 v[244:245], v5 offset:57632
    v_mfma_f32_16x16x32_bf16 v[84:87], v[228:231], v[92:95], v[84:87]
    ds_read_b64_tr_b16 v[246:247], v5 offset:58656
    s_waitcnt vmcnt(11) lgkmcnt(6)
    v_mfma_f32_16x16x32_bf16 v[24:27], v[232:235], v[96:99], v[24:27]
    ds_read_b64_tr_b16 v[224:225], v4 offset:57856
    s_waitcnt vmcnt(9)
    v_mfma_f32_16x16x32_bf16 v[28:31], v[232:235], v[100:103], v[28:31]
    ds_read_b64_tr_b16 v[226:227], v4 offset:58880
    s_waitcnt lgkmcnt(6)
    v_mfma_f32_16x16x32_bf16 v[32:35], v[236:239], v[96:99], v[32:35]
    ds_read_b64_tr_b16 v[228:229], v5 offset:57888
    v_mfma_f32_16x16x32_bf16 v[36:39], v[236:239], v[100:103], v[36:39]
    ds_read_b64_tr_b16 v[230:231], v5 offset:58912
    s_mov_b32 s23, 0x2800
    buffer_load_dwordx4 v[128:131], v7, s[8:11], s23 offen offset:1024 sc1
    s_waitcnt lgkmcnt(6)
    v_mfma_f32_16x16x32_bf16 v[40:43], v[240:243], v[96:99], v[40:43]
    ds_read_b64_tr_b16 v[232:233], v4 offset:58112
    v_mfma_f32_16x16x32_bf16 v[44:47], v[240:243], v[100:103], v[44:47]
    ds_read_b64_tr_b16 v[234:235], v4 offset:59136
    s_waitcnt lgkmcnt(6)
    v_mfma_f32_16x16x32_bf16 v[48:51], v[244:247], v[96:99], v[48:51]
    ds_read_b64_tr_b16 v[236:237], v5 offset:58144
    v_mfma_f32_16x16x32_bf16 v[52:55], v[244:247], v[100:103], v[52:55]
    ds_read_b64_tr_b16 v[238:239], v5 offset:59168
    s_waitcnt lgkmcnt(6)
    v_mfma_f32_16x16x32_bf16 v[56:59], v[224:227], v[96:99], v[56:59]
    v_mfma_f32_16x16x32_bf16 v[60:63], v[224:227], v[100:103], v[60:63]
    s_waitcnt vmcnt(9)
    s_barrier
    ds_read_b64_tr_b16 v[240:241], v4 offset:0
    ds_read_b64_tr_b16 v[242:243], v4 offset:1024
    s_waitcnt lgkmcnt(6)
    v_mfma_f32_16x16x32_bf16 v[64:67], v[228:231], v[96:99], v[64:67]
    ds_read_b64_tr_b16 v[244:245], v5 offset:32
    v_mfma_f32_16x16x32_bf16 v[68:71], v[228:231], v[100:103], v[68:71]
    s_add_u32 s22, s19, 0x300000
    s_add_u32 m0, s20, 0x8000
    s_nop 0
    buffer_load_dwordx4 v3, s[4:7], s22 offen lds
    ds_read_b64_tr_b16 v[246:247], v5 offset:1056
    s_mov_b32 s23, 0xa800
    buffer_load_dwordx4 v[132:135], v7, s[8:11], s23 offen offset:1024 sc1
    s_waitcnt lgkmcnt(6)
    v_mfma_f32_16x16x32_bf16 v[72:75], v[232:235], v[96:99], v[72:75]
    ds_read_b64_tr_b16 v[224:225], v4 offset:256
    v_mfma_f32_16x16x32_bf16 v[76:79], v[232:235], v[100:103], v[76:79]
    ds_read_b64_tr_b16 v[226:227], v4 offset:1280
    s_waitcnt lgkmcnt(6)
    v_mfma_f32_16x16x32_bf16 v[80:83], v[236:239], v[96:99], v[80:83]
    ds_read_b64_tr_b16 v[228:229], v5 offset:288
    v_mfma_f32_16x16x32_bf16 v[84:87], v[236:239], v[100:103], v[84:87]
    ds_read_b64_tr_b16 v[230:231], v5 offset:1312
    s_waitcnt vmcnt(10) lgkmcnt(6)
    v_mfma_f32_16x16x32_bf16 v[24:27], v[240:243], v[104:107], v[24:27]
    ds_read_b64_tr_b16 v[232:233], v4 offset:512
    s_waitcnt vmcnt(9)
    v_mfma_f32_16x16x32_bf16 v[28:31], v[240:243], v[108:111], v[28:31]
    ds_read_b64_tr_b16 v[234:235], v4 offset:1536
    s_waitcnt lgkmcnt(6)
    v_mfma_f32_16x16x32_bf16 v[32:35], v[244:247], v[104:107], v[32:35]
    ds_read_b64_tr_b16 v[236:237], v5 offset:544
    v_mfma_f32_16x16x32_bf16 v[36:39], v[244:247], v[108:111], v[36:39]
    s_add_u32 s22, s19, 0x308000
    s_add_u32 m0, s20, 0x8400
    s_nop 0
    buffer_load_dwordx4 v3, s[4:7], s22 offen lds
    ds_read_b64_tr_b16 v[238:239], v5 offset:1568
    s_mov_b32 s23, 0x3000
    buffer_load_dwordx4 v[88:91], v7, s[8:11], s23 offen offset:0 sc1
    s_waitcnt lgkmcnt(6)
    v_mfma_f32_16x16x32_bf16 v[40:43], v[224:227], v[104:107], v[40:43]
    ds_read_b64_tr_b16 v[240:241], v4 offset:768
    v_mfma_f32_16x16x32_bf16 v[44:47], v[224:227], v[108:111], v[44:47]
    ds_read_b64_tr_b16 v[242:243], v4 offset:1792
    s_waitcnt lgkmcnt(6)
    v_mfma_f32_16x16x32_bf16 v[48:51], v[228:231], v[104:107], v[48:51]
    ds_read_b64_tr_b16 v[244:245], v5 offset:800
    v_mfma_f32_16x16x32_bf16 v[52:55], v[228:231], v[108:111], v[52:55]
    ds_read_b64_tr_b16 v[246:247], v5 offset:1824
    s_waitcnt lgkmcnt(6)
    v_mfma_f32_16x16x32_bf16 v[56:59], v[232:235], v[104:107], v[56:59]
    ds_read_b64_tr_b16 v[224:225], v4 offset:8192
    v_mfma_f32_16x16x32_bf16 v[60:63], v[232:235], v[108:111], v[60:63]
    ds_read_b64_tr_b16 v[226:227], v4 offset:9216
    s_waitcnt lgkmcnt(6)
    v_mfma_f32_16x16x32_bf16 v[64:67], v[236:239], v[104:107], v[64:67]
    ds_read_b64_tr_b16 v[228:229], v5 offset:8224
    v_mfma_f32_16x16x32_bf16 v[68:71], v[236:239], v[108:111], v[68:71]
    ds_read_b64_tr_b16 v[230:231], v5 offset:9248
    s_mov_b32 s23, 0xb000
    buffer_load_dwordx4 v[92:95], v7, s[8:11], s23 offen offset:0 sc1
    s_waitcnt lgkmcnt(6)
    v_mfma_f32_16x16x32_bf16 v[72:75], v[240:243], v[104:107], v[72:75]
    ds_read_b64_tr_b16 v[232:233], v4 offset:8448
    v_mfma_f32_16x16x32_bf16 v[76:79], v[240:243], v[108:111], v[76:79]
    ds_read_b64_tr_b16 v[234:235], v4 offset:9472
    s_waitcnt lgkmcnt(6)
    v_mfma_f32_16x16x32_bf16 v[80:83], v[244:247], v[104:107], v[80:83]
    ds_read_b64_tr_b16 v[236:237], v5 offset:8480
    v_mfma_f32_16x16x32_bf16 v[84:87], v[244:247], v[108:111], v[84:87]
    ds_read_b64_tr_b16 v[238:239], v5 offset:9504
    s_waitcnt vmcnt(11) lgkmcnt(6)
    v_mfma_f32_16x16x32_bf16 v[24:27], v[224:227], v[112:115], v[24:27]
    ds_read_b64_tr_b16 v[240:241], v4 offset:8704
    s_waitcnt vmcnt(9)
    v_mfma_f32_16x16x32_bf16 v[28:31], v[224:227], v[116:119], v[28:31]
    ds_read_b64_tr_b16 v[242:243], v4 offset:9728
    s_waitcnt lgkmcnt(6)
    v_mfma_f32_16x16x32_bf16 v[32:35], v[228:231], v[112:115], v[32:35]
    ds_read_b64_tr_b16 v[244:245], v5 offset:8736
    v_mfma_f32_16x16x32_bf16 v[36:39], v[228:231], v[116:119], v[36:39]
    ds_read_b64_tr_b16 v[246:247], v5 offset:9760
    s_mov_b32 s23, 0x3000
    buffer_load_dwordx4 v[96:99], v7, s[8:11], s23 offen offset:1024 sc1
    s_waitcnt lgkmcnt(6)
    v_mfma_f32_16x16x32_bf16 v[40:43], v[232:235], v[112:115], v[40:43]
    ds_read_b64_tr_b16 v[224:225], v4 offset:8960
    v_mfma_f32_16x16x32_bf16 v[44:47], v[232:235], v[116:119], v[44:47]
    ds_read_b64_tr_b16 v[226:227], v4 offset:9984
    s_waitcnt lgkmcnt(6)
    v_mfma_f32_16x16x32_bf16 v[48:51], v[236:239], v[112:115], v[48:51]
    ds_read_b64_tr_b16 v[228:229], v5 offset:8992
    v_mfma_f32_16x16x32_bf16 v[52:55], v[236:239], v[116:119], v[52:55]
    ds_read_b64_tr_b16 v[230:231], v5 offset:10016
    s_waitcnt lgkmcnt(6)
    v_mfma_f32_16x16x32_bf16 v[56:59], v[240:243], v[112:115], v[56:59]
    v_mfma_f32_16x16x32_bf16 v[60:63], v[240:243], v[116:119], v[60:63]
    s_waitcnt vmcnt(9)
    s_barrier
    ds_read_b64_tr_b16 v[232:233], v4 offset:16384
    ds_read_b64_tr_b16 v[234:235], v4 offset:17408
    s_waitcnt lgkmcnt(6)
    v_mfma_f32_16x16x32_bf16 v[64:67], v[244:247], v[112:115], v[64:67]
    ds_read_b64_tr_b16 v[236:237], v5 offset:16416
    v_mfma_f32_16x16x32_bf16 v[68:71], v[244:247], v[116:119], v[68:71]
    s_add_u32 s22, s19, 0x380000
    s_add_u32 m0, s20, 0xc000
    s_nop 0
    buffer_load_dwordx4 v3, s[4:7], s22 offen lds
    ds_read_b64_tr_b16 v[238:239], v5 offset:17440
    s_mov_b32 s23, 0xb000
    buffer_load_dwordx4 v[100:103], v7, s[8:11], s23 offen offset:1024 sc1
    s_waitcnt lgkmcnt(6)
    v_mfma_f32_16x16x32_bf16 v[72:75], v[224:227], v[112:115], v[72:75]
    ds_read_b64_tr_b16 v[240:241], v4 offset:16640
    v_mfma_f32_16x16x32_bf16 v[76:79], v[224:227], v[116:119], v[76:79]
    ds_read_b64_tr_b16 v[242:243], v4 offset:17664
    s_waitcnt lgkmcnt(6)
    v_mfma_f32_16x16x32_bf16 v[80:83], v[228:231], v[112:115], v[80:83]
    ds_read_b64_tr_b16 v[244:245], v5 offset:16672
    v_mfma_f32_16x16x32_bf16 v[84:87], v[228:231], v[116:119], v[84:87]
    ds_read_b64_tr_b16 v[246:247], v5 offset:17696
    s_waitcnt vmcnt(10) lgkmcnt(6)
    v_mfma_f32_16x16x32_bf16 v[24:27], v[232:235], v[120:123], v[24:27]
    ds_read_b64_tr_b16 v[224:225], v4 offset:16896
    s_waitcnt vmcnt(9)
    v_mfma_f32_16x16x32_bf16 v[28:31], v[232:235], v[124:127], v[28:31]
    ds_read_b64_tr_b16 v[226:227], v4 offset:17920
    s_waitcnt lgkmcnt(6)
    v_mfma_f32_16x16x32_bf16 v[32:35], v[236:239], v[120:123], v[32:35]
    ds_read_b64_tr_b16 v[228:229], v5 offset:16928
    v_mfma_f32_16x16x32_bf16 v[36:39], v[236:239], v[124:127], v[36:39]
    s_add_u32 s22, s19, 0x388000
    s_add_u32 m0, s20, 0xc400
    s_nop 0
    buffer_load_dwordx4 v3, s[4:7], s22 offen lds
    ds_read_b64_tr_b16 v[230:231], v5 offset:17952
    s_mov_b32 s23, 0x3800
    buffer_load_dwordx4 v[104:107], v7, s[8:11], s23 offen offset:0 sc1
    s_waitcnt lgkmcnt(6)
    v_mfma_f32_16x16x32_bf16 v[40:43], v[240:243], v[120:123], v[40:43]
    ds_read_b64_tr_b16 v[232:233], v4 offset:17152
    v_mfma_f32_16x16x32_bf16 v[44:47], v[240:243], v[124:127], v[44:47]
    ds_read_b64_tr_b16 v[234:235], v4 offset:18176
    s_waitcnt lgkmcnt(6)
    v_mfma_f32_16x16x32_bf16 v[48:51], v[244:247], v[120:123], v[48:51]
    ds_read_b64_tr_b16 v[236:237], v5 offset:17184
    v_mfma_f32_16x16x32_bf16 v[52:55], v[244:247], v[124:127], v[52:55]
    ds_read_b64_tr_b16 v[238:239], v5 offset:18208
    s_waitcnt lgkmcnt(6)
    v_mfma_f32_16x16x32_bf16 v[56:59], v[224:227], v[120:123], v[56:59]
    ds_read_b64_tr_b16 v[240:241], v4 offset:24576
    v_mfma_f32_16x16x32_bf16 v[60:63], v[224:227], v[124:127], v[60:63]
    ds_read_b64_tr_b16 v[242:243], v4 offset:25600
    s_waitcnt lgkmcnt(6)
    v_mfma_f32_16x16x32_bf16 v[64:67], v[228:231], v[120:123], v[64:67]
    ds_read_b64_tr_b16 v[244:245], v5 offset:24608
    v_mfma_f32_16x16x32_bf16 v[68:71], v[228:231], v[124:127], v[68:71]
    ds_read_b64_tr_b16 v[246:247], v5 offset:25632
    s_mov_b32 s23, 0xb800
    buffer_load_dwordx4 v[108:111], v7, s[8:11], s23 offen offset:0 sc1
    s_waitcnt lgkmcnt(6)
    v_mfma_f32_16x16x32_bf16 v[72:75], v[232:235], v[120:123], v[72:75]
    ds_read_b64_tr_b16 v[224:225], v4 offset:24832
    v_mfma_f32_16x16x32_bf16 v[76:79], v[232:235], v[124:127], v[76:79]
    ds_read_b64_tr_b16 v[226:227], v4 offset:25856
    s_waitcnt lgkmcnt(6)
    v_mfma_f32_16x16x32_bf16 v[80:83], v[236:239], v[120:123], v[80:83]
    ds_read_b64_tr_b16 v[228:229], v5 offset:24864
    v_mfma_f32_16x16x32_bf16 v[84:87], v[236:239], v[124:127], v[84:87]
    ds_read_b64_tr_b16 v[230:231], v5 offset:25888
    s_waitcnt vmcnt(11) lgkmcnt(6)
    v_mfma_f32_16x16x32_bf16 v[24:27], v[240:243], v[128:131], v[24:27]
    ds_read_b64_tr_b16 v[232:233], v4 offset:25088
    s_waitcnt vmcnt(9)
    v_mfma_f32_16x16x32_bf16 v[28:31], v[240:243], v[132:135], v[28:31]
    ds_read_b64_tr_b16 v[234:235], v4 offset:26112
    s_waitcnt lgkmcnt(6)
    v_mfma_f32_16x16x32_bf16 v[32:35], v[244:247], v[128:131], v[32:35]
    ds_read_b64_tr_b16 v[236:237], v5 offset:25120
    v_mfma_f32_16x16x32_bf16 v[36:39], v[244:247], v[132:135], v[36:39]
    ds_read_b64_tr_b16 v[238:239], v5 offset:26144
    s_mov_b32 s23, 0x3800
    buffer_load_dwordx4 v[112:115], v7, s[8:11], s23 offen offset:1024 sc1
    s_waitcnt lgkmcnt(6)
    v_mfma_f32_16x16x32_bf16 v[40:43], v[224:227], v[128:131], v[40:43]
    ds_read_b64_tr_b16 v[240:241], v4 offset:25344
    v_mfma_f32_16x16x32_bf16 v[44:47], v[224:227], v[132:135], v[44:47]
    ds_read_b64_tr_b16 v[242:243], v4 offset:26368
    s_waitcnt lgkmcnt(6)
    v_mfma_f32_16x16x32_bf16 v[48:51], v[228:231], v[128:131], v[48:51]
    ds_read_b64_tr_b16 v[244:245], v5 offset:25376
    v_mfma_f32_16x16x32_bf16 v[52:55], v[228:231], v[132:135], v[52:55]
    ds_read_b64_tr_b16 v[246:247], v5 offset:26400
    s_waitcnt lgkmcnt(6)
    v_mfma_f32_16x16x32_bf16 v[56:59], v[232:235], v[128:131], v[56:59]
    v_mfma_f32_16x16x32_bf16 v[60:63], v[232:235], v[132:135], v[60:63]
    s_waitcnt vmcnt(9)
    s_barrier
    ds_read_b64_tr_b16 v[224:225], v4 offset:32768
    ds_read_b64_tr_b16 v[226:227], v4 offset:33792
    s_waitcnt lgkmcnt(6)
    v_mfma_f32_16x16x32_bf16 v[64:67], v[236:239], v[128:131], v[64:67]
    ds_read_b64_tr_b16 v[228:229], v5 offset:32800
    v_mfma_f32_16x16x32_bf16 v[68:71], v[236:239], v[132:135], v[68:71]
    s_add_u32 s22, s19, 0x400000
    s_add_u32 m0, s20, 0x0
    s_nop 0
    buffer_load_dwordx4 v3, s[4:7], s22 offen lds
    ds_read_b64_tr_b16 v[230:231], v5 offset:33824
    s_mov_b32 s23, 0xb800
    buffer_load_dwordx4 v[116:119], v7, s[8:11], s23 offen offset:1024 sc1
    s_waitcnt lgkmcnt(6)
    v_mfma_f32_16x16x32_bf16 v[72:75], v[240:243], v[128:131], v[72:75]
    ds_read_b64_tr_b16 v[232:233], v4 offset:33024
    v_mfma_f32_16x16x32_bf16 v[76:79], v[240:243], v[132:135], v[76:79]
    ds_read_b64_tr_b16 v[234:235], v4 offset:34048
    s_waitcnt lgkmcnt(6)
    v_mfma_f32_16x16x32_bf16 v[80:83], v[244:247], v[128:131], v[80:83]
    ds_read_b64_tr_b16 v[236:237], v5 offset:33056
    v_mfma_f32_16x16x32_bf16 v[84:87], v[244:247], v[132:135], v[84:87]
    ds_read_b64_tr_b16 v[238:239], v5 offset:34080
    s_waitcnt vmcnt(10) lgkmcnt(6)
    v_mfma_f32_16x16x32_bf16 v[24:27], v[224:227], v[88:91], v[24:27]
    ds_read_b64_tr_b16 v[240:241], v4 offset:33280
    s_waitcnt vmcnt(9)
    v_mfma_f32_16x16x32_bf16 v[28:31], v[224:227], v[92:95], v[28:31]
    ds_read_b64_tr_b16 v[242:243], v4 offset:34304
    s_waitcnt lgkmcnt(6)
    v_mfma_f32_16x16x32_bf16 v[32:35], v[228:231], v[88:91], v[32:35]
    ds_read_b64_tr_b16 v[244:245], v5 offset:33312
    v_mfma_f32_16x16x32_bf16 v[36:39], v[228:231], v[92:95], v[36:39]
    s_add_u32 s22, s19, 0x408000
    s_add_u32 m0, s20, 0x400
    s_nop 0
    buffer_load_dwordx4 v3, s[4:7], s22 offen lds
    ds_read_b64_tr_b16 v[246:247], v5 offset:34336
    s_mov_b32 s23, 0x4000
    buffer_load_dwordx4 v[120:123], v7, s[8:11], s23 offen offset:0 sc1
    s_waitcnt lgkmcnt(6)
    v_mfma_f32_16x16x32_bf16 v[40:43], v[232:235], v[88:91], v[40:43]
    ds_read_b64_tr_b16 v[224:225], v4 offset:33536
    v_mfma_f32_16x16x32_bf16 v[44:47], v[232:235], v[92:95], v[44:47]
    ds_read_b64_tr_b16 v[226:227], v4 offset:34560
    s_waitcnt lgkmcnt(6)
    v_mfma_f32_16x16x32_bf16 v[48:51], v[236:239], v[88:91], v[48:51]
    ds_read_b64_tr_b16 v[228:229], v5 offset:33568
    v_mfma_f32_16x16x32_bf16 v[52:55], v[236:239], v[92:95], v[52:55]
    ds_read_b64_tr_b16 v[230:231], v5 offset:34592
    s_waitcnt lgkmcnt(6)
    v_mfma_f32_16x16x32_bf16 v[56:59], v[240:243], v[88:91], v[56:59]
    ds_read_b64_tr_b16 v[232:233], v4 offset:40960
    v_mfma_f32_16x16x32_bf16 v[60:63], v[240:243], v[92:95], v[60:63]
    ds_read_b64_tr_b16 v[234:235], v4 offset:41984
    s_waitcnt lgkmcnt(6)
    v_mfma_f32_16x16x32_bf16 v[64:67], v[244:247], v[88:91], v[64:67]
    ds_read_b64_tr_b16 v[236:237], v5 offset:40992
    v_mfma_f32_16x16x32_bf16 v[68:71], v[244:247], v[92:95], v[68:71]
    ds_read_b64_tr_b16 v[238:239], v5 offset:42016
    s_mov_b32 s23, 0xc000
    buffer_load_dwordx4 v[124:127], v7, s[8:11], s23 offen offset:0 sc1
    s_waitcnt lgkmcnt(6)
    v_mfma_f32_16x16x32_bf16 v[72:75], v[224:227], v[88:91], v[72:75]
    ds_read_b64_tr_b16 v[240:241], v4 offset:41216
    v_lshrrev_b32 v21, 4, v1
    v_lshlrev_b32 v21, 9, v21
    v_and_b32 v20, 15, v1
    v_lshl_add_u32 v21, v20, 4, v21
    s_lshr_b32 s18, s12, 3
    s_lshl_b32 s18, s18, 11
    s_add_u32 s18, s18, 0x528100
    buffer_load_dwordx4 v[12:15], v21, s[8:11], s18 offen sc1
    v_mfma_f32_16x16x32_bf16 v[76:79], v[224:227], v[92:95], v[76:79]
    ds_read_b64_tr_b16 v[242:243], v4 offset:42240
    s_waitcnt lgkmcnt(6)
    v_mfma_f32_16x16x32_bf16 v[80:83], v[228:231], v[88:91], v[80:83]
    ds_read_b64_tr_b16 v[244:245], v5 offset:41248
    v_mfma_f32_16x16x32_bf16 v[84:87], v[228:231], v[92:95], v[84:87]
    ds_read_b64_tr_b16 v[246:247], v5 offset:42272
    s_waitcnt vmcnt(12) lgkmcnt(6)
    v_mfma_f32_16x16x32_bf16 v[24:27], v[232:235], v[96:99], v[24:27]
    ds_read_b64_tr_b16 v[224:225], v4 offset:41472
    s_waitcnt vmcnt(10)
    v_mfma_f32_16x16x32_bf16 v[28:31], v[232:235], v[100:103], v[28:31]
    ds_read_b64_tr_b16 v[226:227], v4 offset:42496
    s_waitcnt lgkmcnt(6)
    v_mfma_f32_16x16x32_bf16 v[32:35], v[236:239], v[96:99], v[32:35]
    ds_read_b64_tr_b16 v[228:229], v5 offset:41504
    v_mfma_f32_16x16x32_bf16 v[36:39], v[236:239], v[100:103], v[36:39]
    ds_read_b64_tr_b16 v[230:231], v5 offset:42528
    s_mov_b32 s23, 0x4000
    buffer_load_dwordx4 v[128:131], v7, s[8:11], s23 offen offset:1024 sc1
    s_waitcnt lgkmcnt(6)
    v_mfma_f32_16x16x32_bf16 v[40:43], v[240:243], v[96:99], v[40:43]
    ds_read_b64_tr_b16 v[232:233], v4 offset:41728
    v_mfma_f32_16x16x32_bf16 v[44:47], v[240:243], v[100:103], v[44:47]
    ds_read_b64_tr_b16 v[234:235], v4 offset:42752
    s_waitcnt lgkmcnt(6)
    v_mfma_f32_16x16x32_bf16 v[48:51], v[244:247], v[96:99], v[48:51]
    ds_read_b64_tr_b16 v[236:237], v5 offset:41760
    v_mfma_f32_16x16x32_bf16 v[52:55], v[244:247], v[100:103], v[52:55]
    ds_read_b64_tr_b16 v[238:239], v5 offset:42784
    s_waitcnt lgkmcnt(6)
    v_mfma_f32_16x16x32_bf16 v[56:59], v[224:227], v[96:99], v[56:59]
    v_mfma_f32_16x16x32_bf16 v[60:63], v[224:227], v[100:103], v[60:63]
    s_waitcnt vmcnt(10)
    s_barrier
    ds_read_b64_tr_b16 v[240:241], v4 offset:49152
    ds_read_b64_tr_b16 v[242:243], v4 offset:50176
    s_waitcnt lgkmcnt(6)
    v_mfma_f32_16x16x32_bf16 v[64:67], v[228:231], v[96:99], v[64:67]
    ds_read_b64_tr_b16 v[244:245], v5 offset:49184
    v_mfma_f32_16x16x32_bf16 v[68:71], v[228:231], v[100:103], v[68:71]
    s_add_u32 s22, s19, 0x480000
    s_add_u32 m0, s20, 0x4000
    s_nop 0
    buffer_load_dwordx4 v3, s[4:7], s22 offen lds
    ds_read_b64_tr_b16 v[246:247], v5 offset:50208
    s_mov_b32 s23, 0xc000
    buffer_load_dwordx4 v[132:135], v7, s[8:11], s23 offen offset:1024 sc1
    s_waitcnt lgkmcnt(6)
    v_mfma_f32_16x16x32_bf16 v[72:75], v[232:235], v[96:99], v[72:75]
    ds_read_b64_tr_b16 v[224:225], v4 offset:49408
    v_mfma_f32_16x16x32_bf16 v[76:79], v[232:235], v[100:103], v[76:79]
    ds_read_b64_tr_b16 v[226:227], v4 offset:50432
    s_waitcnt lgkmcnt(6)
    v_mfma_f32_16x16x32_bf16 v[80:83], v[236:239], v[96:99], v[80:83]
    ds_read_b64_tr_b16 v[228:229], v5 offset:49440
    v_mfma_f32_16x16x32_bf16 v[84:87], v[236:239], v[100:103], v[84:87]
    ds_read_b64_tr_b16 v[230:231], v5 offset:50464
    s_waitcnt vmcnt(11) lgkmcnt(6)
    v_mfma_f32_16x16x32_bf16 v[24:27], v[240:243], v[104:107], v[24:27]
    ds_read_b64_tr_b16 v[232:233], v4 offset:49664
    s_waitcnt vmcnt(10)
    v_mfma_f32_16x16x32_bf16 v[28:31], v[240:243], v[108:111], v[28:31]
    ds_read_b64_tr_b16 v[234:235], v4 offset:50688
    s_waitcnt lgkmcnt(6)
    v_mfma_f32_16x16x32_bf16 v[32:35], v[244:247], v[104:107], v[32:35]
    ds_read_b64_tr_b16 v[236:237], v5 offset:49696
    v_mfma_f32_16x16x32_bf16 v[36:39], v[244:247], v[108:111], v[36:39]
    s_add_u32 s22, s19, 0x488000
    s_add_u32 m0, s20, 0x4400
    s_nop 0
    buffer_load_dwordx4 v3, s[4:7], s22 offen lds
    ds_read_b64_tr_b16 v[238:239], v5 offset:50720
    s_mov_b32 s23, 0x4800
    buffer_load_dwordx4 v[88:91], v7, s[8:11], s23 offen offset:0 sc1
    s_waitcnt lgkmcnt(6)
    v_mfma_f32_16x16x32_bf16 v[40:43], v[224:227], v[104:107], v[40:43]
    ds_read_b64_tr_b16 v[240:241], v4 offset:49920
    v_mfma_f32_16x16x32_bf16 v[44:47], v[224:227], v[108:111], v[44:47]
    ds_read_b64_tr_b16 v[242:243], v4 offset:50944
    s_waitcnt lgkmcnt(6)
    v_mfma_f32_16x16x32_bf16 v[48:51], v[228:231], v[104:107], v[48:51]
    ds_read_b64_tr_b16 v[244:245], v5 offset:49952
    v_mfma_f32_16x16x32_bf16 v[52:55], v[228:231], v[108:111], v[52:55]
    ds_read_b64_tr_b16 v[246:247], v5 offset:50976
    s_waitcnt lgkmcnt(6)
    v_mfma_f32_16x16x32_bf16 v[56:59], v[232:235], v[104:107], v[56:59]
    ds_read_b64_tr_b16 v[224:225], v4 offset:57344
    v_mfma_f32_16x16x32_bf16 v[60:63], v[232:235], v[108:111], v[60:63]
    ds_read_b64_tr_b16 v[226:227], v4 offset:58368
    s_waitcnt lgkmcnt(6)
    v_mfma_f32_16x16x32_bf16 v[64:67], v[236:239], v[104:107], v[64:67]
    ds_read_b64_tr_b16 v[228:229], v5 offset:57376
    v_mfma_f32_16x16x32_bf16 v[68:71], v[236:239], v[108:111], v[68:71]
    ds_read_b64_tr_b16 v[230:231], v5 offset:58400
    s_mov_b32 s23, 0xc800
    buffer_load_dwordx4 v[92:95], v7, s[8:11], s23 offen offset:0 sc1
    s_waitcnt lgkmcnt(6)
    v_mfma_f32_16x16x32_bf16 v[72:75], v[240:243], v[104:107], v[72:75]
    ds_read_b64_tr_b16 v[232:233], v4 offset:57600
    v_mfma_f32_16x16x32_bf16 v[76:79], v[240:243], v[108:111], v[76:79]
    ds_read_b64_tr_b16 v[234:235], v4 offset:58624
    s_waitcnt lgkmcnt(6)
    v_mfma_f32_16x16x32_bf16 v[80:83], v[244:247], v[104:107], v[80:83]
    ds_read_b64_tr_b16 v[236:237], v5 offset:57632
    v_mfma_f32_16x16x32_bf16 v[84:87], v[244:247], v[108:111], v[84:87]
    ds_read_b64_tr_b16 v[238:239], v5 offset:58656
    s_waitcnt vmcnt(12) lgkmcnt(6)
    v_mfma_f32_16x16x32_bf16 v[24:27], v[224:227], v[112:115], v[24:27]
    ds_read_b64_tr_b16 v[240:241], v4 offset:57856
    s_waitcnt vmcnt(10)
    v_mfma_f32_16x16x32_bf16 v[28:31], v[224:227], v[116:119], v[28:31]
    ds_read_b64_tr_b16 v[242:243], v4 offset:58880
    s_waitcnt lgkmcnt(6)
    v_mfma_f32_16x16x32_bf16 v[32:35], v[228:231], v[112:115], v[32:35]
    ds_read_b64_tr_b16 v[244:245], v5 offset:57888
    v_mfma_f32_16x16x32_bf16 v[36:39], v[228:231], v[116:119], v[36:39]
    ds_read_b64_tr_b16 v[246:247], v5 offset:58912
    s_mov_b32 s23, 0x4800
    buffer_load_dwordx4 v[96:99], v7, s[8:11], s23 offen offset:1024 sc1
    s_waitcnt lgkmcnt(6)
    v_mfma_f32_16x16x32_bf16 v[40:43], v[232:235], v[112:115], v[40:43]
    ds_read_b64_tr_b16 v[224:225], v4 offset:58112
    v_mfma_f32_16x16x32_bf16 v[44:47], v[232:235], v[116:119], v[44:47]
    ds_read_b64_tr_b16 v[226:227], v4 offset:59136
    s_waitcnt lgkmcnt(6)
    v_mfma_f32_16x16x32_bf16 v[48:51], v[236:239], v[112:115], v[48:51]
    ds_read_b64_tr_b16 v[228:229], v5 offset:58144
    v_mfma_f32_16x16x32_bf16 v[52:55], v[236:239], v[116:119], v[52:55]
    ds_read_b64_tr_b16 v[230:231], v5 offset:59168
    s_waitcnt lgkmcnt(6)
    v_mfma_f32_16x16x32_bf16 v[56:59], v[240:243], v[112:115], v[56:59]
    v_mfma_f32_16x16x32_bf16 v[60:63], v[240:243], v[116:119], v[60:63]
    s_waitcnt vmcnt(10)
    s_barrier
    ds_read_b64_tr_b16 v[232:233], v4 offset:0
    ds_read_b64_tr_b16 v[234:235], v4 offset:1024
    s_waitcnt lgkmcnt(6)
    v_mfma_f32_16x16x32_bf16 v[64:67], v[244:247], v[112:115], v[64:67]
    ds_read_b64_tr_b16 v[236:237], v5 offset:32
    v_mfma_f32_16x16x32_bf16 v[68:71], v[244:247], v[116:119], v[68:71]
    s_add_u32 s22, s19, 0x500000
    s_add_u32 m0, s20, 0x8000
    s_nop 0
    buffer_load_dwordx4 v3, s[4:7], s22 offen lds
    ds_read_b64_tr_b16 v[238:239], v5 offset:1056
    s_mov_b32 s23, 0xc800
    buffer_load_dwordx4 v[100:103], v7, s[8:11], s23 offen offset:1024 sc1
    s_waitcnt lgkmcnt(6)
    v_mfma_f32_16x16x32_bf16 v[72:75], v[224:227], v[112:115], v[72:75]
    ds_read_b64_tr_b16 v[240:241], v4 offset:256
    v_mfma_f32_16x16x32_bf16 v[76:79], v[224:227], v[116:119], v[76:79]
    ds_read_b64_tr_b16 v[242:243], v4 offset:1280
    s_waitcnt lgkmcnt(6)
    v_mfma_f32_16x16x32_bf16 v[80:83], v[228:231], v[112:115], v[80:83]
    ds_read_b64_tr_b16 v[244:245], v5 offset:288
    v_mfma_f32_16x16x32_bf16 v[84:87], v[228:231], v[116:119], v[84:87]
    ds_read_b64_tr_b16 v[246:247], v5 offset:1312
    s_waitcnt vmcnt(11) lgkmcnt(6)
    v_mfma_f32_16x16x32_bf16 v[24:27], v[232:235], v[120:123], v[24:27]
    ds_read_b64_tr_b16 v[224:225], v4 offset:512
    s_waitcnt vmcnt(10)
    v_mfma_f32_16x16x32_bf16 v[28:31], v[232:235], v[124:127], v[28:31]
    ds_read_b64_tr_b16 v[226:227], v4 offset:1536
    s_waitcnt lgkmcnt(6)
    v_mfma_f32_16x16x32_bf16 v[32:35], v[236:239], v[120:123], v[32:35]
    ds_read_b64_tr_b16 v[228:229], v5 offset:544
    v_mfma_f32_16x16x32_bf16 v[36:39], v[236:239], v[124:127], v[36:39]
    s_add_u32 s22, s19, 0x508000
    s_add_u32 m0, s20, 0x8400
    s_nop 0
    buffer_load_dwordx4 v3, s[4:7], s22 offen lds
    ds_read_b64_tr_b16 v[230:231], v5 offset:1568
    s_mov_b32 s23, 0x5000
    buffer_load_dwordx4 v[104:107], v7, s[8:11], s23 offen offset:0 sc1
    s_waitcnt lgkmcnt(6)
    v_mfma_f32_16x16x32_bf16 v[40:43], v[240:243], v[120:123], v[40:43]
    ds_read_b64_tr_b16 v[232:233], v4 offset:768
    v_mfma_f32_16x16x32_bf16 v[44:47], v[240:243], v[124:127], v[44:47]
    ds_read_b64_tr_b16 v[234:235], v4 offset:1792
    s_waitcnt lgkmcnt(6)
    v_mfma_f32_16x16x32_bf16 v[48:51], v[244:247], v[120:123], v[48:51]
    ds_read_b64_tr_b16 v[236:237], v5 offset:800
    v_mfma_f32_16x16x32_bf16 v[52:55], v[244:247], v[124:127], v[52:55]
    ds_read_b64_tr_b16 v[238:239], v5 offset:1824
    s_waitcnt lgkmcnt(6)
    v_mfma_f32_16x16x32_bf16 v[56:59], v[224:227], v[120:123], v[56:59]
    ds_read_b64_tr_b16 v[240:241], v4 offset:8192
    v_mfma_f32_16x16x32_bf16 v[60:63], v[224:227], v[124:127], v[60:63]
    ds_read_b64_tr_b16 v[242:243], v4 offset:9216
    s_waitcnt lgkmcnt(6)
    v_mfma_f32_16x16x32_bf16 v[64:67], v[228:231], v[120:123], v[64:67]
    ds_read_b64_tr_b16 v[244:245], v5 offset:8224
    v_mfma_f32_16x16x32_bf16 v[68:71], v[228:231], v[124:127], v[68:71]
    ds_read_b64_tr_b16 v[246:247], v5 offset:9248
    s_mov_b32 s23, 0xd000
    buffer_load_dwordx4 v[108:111], v7, s[8:11], s23 offen offset:0 sc1
    s_waitcnt lgkmcnt(6)
    v_mfma_f32_16x16x32_bf16 v[72:75], v[232:235], v[120:123], v[72:75]
    ds_read_b64_tr_b16 v[224:225], v4 offset:8448
    v_mfma_f32_16x16x32_bf16 v[76:79], v[232:235], v[124:127], v[76:79]
    ds_read_b64_tr_b16 v[226:227], v4 offset:9472
    s_waitcnt lgkmcnt(6)
    v_mfma_f32_16x16x32_bf16 v[80:83], v[236:239], v[120:123], v[80:83]
    ds_read_b64_tr_b16 v[228:229], v5 offset:8480
    v_mfma_f32_16x16x32_bf16 v[84:87], v[236:239], v[124:127], v[84:87]
    ds_read_b64_tr_b16 v[230:231], v5 offset:9504
    s_waitcnt vmcnt(11) lgkmcnt(6)
    v_mfma_f32_16x16x32_bf16 v[24:27], v[240:243], v[128:131], v[24:27]
    ds_read_b64_tr_b16 v[232:233], v4 offset:8704
    s_waitcnt vmcnt(9)
    v_mfma_f32_16x16x32_bf16 v[28:31], v[240:243], v[132:135], v[28:31]
    ds_read_b64_tr_b16 v[234:235], v4 offset:9728
    s_waitcnt lgkmcnt(6)
    v_mfma_f32_16x16x32_bf16 v[32:35], v[244:247], v[128:131], v[32:35]
    ds_read_b64_tr_b16 v[236:237], v5 offset:8736
    v_mfma_f32_16x16x32_bf16 v[36:39], v[244:247], v[132:135], v[36:39]
    ds_read_b64_tr_b16 v[238:239], v5 offset:9760
    s_mov_b32 s23, 0x5000
    buffer_load_dwordx4 v[112:115], v7, s[8:11], s23 offen offset:1024 sc1
    s_waitcnt lgkmcnt(6)
    v_mfma_f32_16x16x32_bf16 v[40:43], v[224:227], v[128:131], v[40:43]
    ds_read_b64_tr_b16 v[240:241], v4 offset:8960
    v_mfma_f32_16x16x32_bf16 v[44:47], v[224:227], v[132:135], v[44:47]
    ds_read_b64_tr_b16 v[242:243], v4 offset:9984
    s_waitcnt lgkmcnt(6)
    v_mfma_f32_16x16x32_bf16 v[48:51], v[228:231], v[128:131], v[48:51]
    ds_read_b64_tr_b16 v[244:245], v5 offset:8992
    v_mfma_f32_16x16x32_bf16 v[52:55], v[228:231], v[132:135], v[52:55]
    ds_read_b64_tr_b16 v[246:247], v5 offset:10016
    s_waitcnt lgkmcnt(6)
    v_mfma_f32_16x16x32_bf16 v[56:59], v[232:235], v[128:131], v[56:59]
    v_mfma_f32_16x16x32_bf16 v[60:63], v[232:235], v[132:135], v[60:63]
    s_waitcnt vmcnt(9)
    s_barrier
    ds_read_b64_tr_b16 v[224:225], v4 offset:16384
    ds_read_b64_tr_b16 v[226:227], v4 offset:17408
    s_waitcnt lgkmcnt(6)
    v_mfma_f32_16x16x32_bf16 v[64:67], v[236:239], v[128:131], v[64:67]
    ds_read_b64_tr_b16 v[228:229], v5 offset:16416
    v_mfma_f32_16x16x32_bf16 v[68:71], v[236:239], v[132:135], v[68:71]
    s_add_u32 s22, s19, 0x580000
    s_add_u32 m0, s20, 0xc000
    s_nop 0
    buffer_load_dwordx4 v3, s[4:7], s22 offen lds
    ds_read_b64_tr_b16 v[230:231], v5 offset:17440
    s_mov_b32 s23, 0xd000
    buffer_load_dwordx4 v[116:119], v7, s[8:11], s23 offen offset:1024 sc1
    s_waitcnt lgkmcnt(6)
    v_mfma_f32_16x16x32_bf16 v[72:75], v[240:243], v[128:131], v[72:75]
    ds_read_b64_tr_b16 v[232:233], v4 offset:16640
    v_mfma_f32_16x16x32_bf16 v[76:79], v[240:243], v[132:135], v[76:79]
    ds_read_b64_tr_b16 v[234:235], v4 offset:17664
    s_waitcnt lgkmcnt(6)
    v_mfma_f32_16x16x32_bf16 v[80:83], v[244:247], v[128:131], v[80:83]
    ds_read_b64_tr_b16 v[236:237], v5 offset:16672
    v_mfma_f32_16x16x32_bf16 v[84:87], v[244:247], v[132:135], v[84:87]
    ds_read_b64_tr_b16 v[238:239], v5 offset:17696
    s_waitcnt vmcnt(10) lgkmcnt(6)
    v_mfma_f32_16x16x32_bf16 v[24:27], v[224:227], v[88:91], v[24:27]
    ds_read_b64_tr_b16 v[240:241], v4 offset:16896
    s_waitcnt vmcnt(9)
    v_mfma_f32_16x16x32_bf16 v[28:31], v[224:227], v[92:95], v[28:31]
    ds_read_b64_tr_b16 v[242:243], v4 offset:17920
    s_waitcnt lgkmcnt(6)
    v_mfma_f32_16x16x32_bf16 v[32:35], v[228:231], v[88:91], v[32:35]
    ds_read_b64_tr_b16 v[244:245], v5 offset:16928
    v_mfma_f32_16x16x32_bf16 v[36:39], v[228:231], v[92:95], v[36:39]
    s_add_u32 s22, s19, 0x588000
    s_add_u32 m0, s20, 0xc400
    s_nop 0
    buffer_load_dwordx4 v3, s[4:7], s22 offen lds
    ds_read_b64_tr_b16 v[246:247], v5 offset:17952
    s_mov_b32 s23, 0x5800
    buffer_load_dwordx4 v[120:123], v7, s[8:11], s23 offen offset:0 sc1
    s_waitcnt lgkmcnt(6)
    v_mfma_f32_16x16x32_bf16 v[40:43], v[232:235], v[88:91], v[40:43]
    ds_read_b64_tr_b16 v[224:225], v4 offset:17152
    v_mfma_f32_16x16x32_bf16 v[44:47], v[232:235], v[92:95], v[44:47]
    ds_read_b64_tr_b16 v[226:227], v4 offset:18176
    s_waitcnt lgkmcnt(6)
    v_mfma_f32_16x16x32_bf16 v[48:51], v[236:239], v[88:91], v[48:51]
    ds_read_b64_tr_b16 v[228:229], v5 offset:17184
    v_mfma_f32_16x16x32_bf16 v[52:55], v[236:239], v[92:95], v[52:55]
    ds_read_b64_tr_b16 v[230:231], v5 offset:18208
    s_waitcnt lgkmcnt(6)
    v_mfma_f32_16x16x32_bf16 v[56:59], v[240:243], v[88:91], v[56:59]
    ds_read_b64_tr_b16 v[232:233], v4 offset:24576
    v_mfma_f32_16x16x32_bf16 v[60:63], v[240:243], v[92:95], v[60:63]
    ds_read_b64_tr_b16 v[234:235], v4 offset:25600
    s_waitcnt lgkmcnt(6)
    v_mfma_f32_16x16x32_bf16 v[64:67], v[244:247], v[88:91], v[64:67]
    ds_read_b64_tr_b16 v[236:237], v5 offset:24608
    v_mfma_f32_16x16x32_bf16 v[68:71], v[244:247], v[92:95], v[68:71]
    ds_read_b64_tr_b16 v[238:239], v5 offset:25632
    s_mov_b32 s23, 0xd800
    buffer_load_dwordx4 v[124:127], v7, s[8:11], s23 offen offset:0 sc1
    s_waitcnt lgkmcnt(6)
    v_mfma_f32_16x16x32_bf16 v[72:75], v[224:227], v[88:91], v[72:75]
    ds_read_b64_tr_b16 v[240:241], v4 offset:24832
    v_xor_b32 v8, s28, v12
    v_xor_b32 v20, s28, v13
    v_or_b32 v8, v8, v20
    v_xor_b32 v20, s28, v14
    v_or_b32 v8, v8, v20
    v_xor_b32 v20, s28, v15
    v_or_b32 v8, v8, v20
    v_cmp_ne_u32 vcc, 0, v8
    s_cbranch_vccnz adaLN_cond__sliding_block_cached__moe_arch_mod__prompt_kernel_kv16r
adaLN_cond__sliding_block_cached__moe_arch_mod__prompt_kernel_kv16b:
    v_mfma_f32_16x16x32_bf16 v[76:79], v[224:227], v[92:95], v[76:79]
    ds_read_b64_tr_b16 v[242:243], v4 offset:25856
    v_mov_b32 v20, 0
    s_mov_b32 s16, 0x564000
    buffer_load_dword v8, v20, s[8:11], s16 offen sc1
    s_waitcnt lgkmcnt(6)
    v_mfma_f32_16x16x32_bf16 v[80:83], v[228:231], v[88:91], v[80:83]
    ds_read_b64_tr_b16 v[244:245], v5 offset:24864
    v_mfma_f32_16x16x32_bf16 v[84:87], v[228:231], v[92:95], v[84:87]
    ds_read_b64_tr_b16 v[246:247], v5 offset:25888
    s_waitcnt vmcnt(12) lgkmcnt(6)
    v_mfma_f32_16x16x32_bf16 v[24:27], v[232:235], v[96:99], v[24:27]
    ds_read_b64_tr_b16 v[224:225], v4 offset:25088
    s_waitcnt vmcnt(10)
    v_mfma_f32_16x16x32_bf16 v[28:31], v[232:235], v[100:103], v[28:31]
    ds_read_b64_tr_b16 v[226:227], v4 offset:26112
    s_waitcnt lgkmcnt(6)
    v_mfma_f32_16x16x32_bf16 v[32:35], v[236:239], v[96:99], v[32:35]
    ds_read_b64_tr_b16 v[228:229], v5 offset:25120
    v_mfma_f32_16x16x32_bf16 v[36:39], v[236:239], v[100:103], v[36:39]
    ds_read_b64_tr_b16 v[230:231], v5 offset:26144
    s_mov_b32 s23, 0x5800
    buffer_load_dwordx4 v[128:131], v7, s[8:11], s23 offen offset:1024 sc1
    s_waitcnt lgkmcnt(6)
    v_mfma_f32_16x16x32_bf16 v[40:43], v[240:243], v[96:99], v[40:43]
    ds_read_b64_tr_b16 v[232:233], v4 offset:25344
    s_mov_b64 s[76:77], s[54:55]
    s_mov_b32 s78, 0xc00000
    s_mov_b32 s79, 0x20000
    v_bfe_u32 v20, v1, 2, 2
    v_lshlrev_b32 v20, 12, v20
    v_add_u32 v6, v3, v20
    s_lshr_b32 s16, s2, 5
    s_lshl_b32 s16, s16, 7
    s_lshl_b32 s17, s3, 3
    s_add_u32 s16, s16, s17
    s_mul_i32 s14, s16, 12288
    s_and_b32 s16, s2, 31
    s_lshl_b32 s16, s16, 8
    s_add_u32 s14, s14, s16
    s_add_u32 s14, s14, 4096
    v_mfma_f32_16x16x32_bf16 v[44:47], v[240:243], v[100:103], v[44:47]
    ds_read_b64_tr_b16 v[234:235], v4 offset:26368
    s_waitcnt lgkmcnt(6)
    v_mfma_f32_16x16x32_bf16 v[48:51], v[244:247], v[96:99], v[48:51]
    ds_read_b64_tr_b16 v[236:237], v5 offset:25376
    v_mfma_f32_16x16x32_bf16 v[52:55], v[244:247], v[100:103], v[52:55]
    ds_read_b64_tr_b16 v[238:239], v5 offset:26400
    s_waitcnt lgkmcnt(6)
    v_mfma_f32_16x16x32_bf16 v[56:59], v[224:227], v[96:99], v[56:59]
    v_mfma_f32_16x16x32_bf16 v[60:63], v[224:227], v[100:103], v[60:63]
    s_waitcnt vmcnt(10)
    s_barrier
    ds_read_b64_tr_b16 v[240:241], v4 offset:32768
    ds_read_b64_tr_b16 v[242:243], v4 offset:33792
    s_waitcnt lgkmcnt(6)
    v_mfma_f32_16x16x32_bf16 v[64:67], v[228:231], v[96:99], v[64:67]
    ds_read_b64_tr_b16 v[244:245], v5 offset:32800
    v_mfma_f32_16x16x32_bf16 v[68:71], v[228:231], v[100:103], v[68:71]
    s_add_u32 s22, s19, 0x600000
    s_add_u32 m0, s20, 0x0
    s_nop 0
    buffer_load_dwordx4 v3, s[4:7], s22 offen lds
    ds_read_b64_tr_b16 v[246:247], v5 offset:33824
    s_mov_b32 s23, 0xd800
    buffer_load_dwordx4 v[132:135], v7, s[8:11], s23 offen offset:1024 sc1
    s_waitcnt lgkmcnt(6)
    v_mfma_f32_16x16x32_bf16 v[72:75], v[232:235], v[96:99], v[72:75]
    ds_read_b64_tr_b16 v[224:225], v4 offset:33024
    v_mfma_f32_16x16x32_bf16 v[76:79], v[232:235], v[100:103], v[76:79]
    ds_read_b64_tr_b16 v[226:227], v4 offset:34048
    s_waitcnt lgkmcnt(6)
    v_mfma_f32_16x16x32_bf16 v[80:83], v[236:239], v[96:99], v[80:83]
    ds_read_b64_tr_b16 v[228:229], v5 offset:33056
    v_mfma_f32_16x16x32_bf16 v[84:87], v[236:239], v[100:103], v[84:87]
    ds_read_b64_tr_b16 v[230:231], v5 offset:34080
    s_waitcnt vmcnt(11) lgkmcnt(6)
    v_mfma_f32_16x16x32_bf16 v[24:27], v[240:243], v[104:107], v[24:27]
    ds_read_b64_tr_b16 v[232:233], v4 offset:33280
    s_waitcnt vmcnt(10)
    v_mfma_f32_16x16x32_bf16 v[28:31], v[240:243], v[108:111], v[28:31]
    ds_read_b64_tr_b16 v[234:235], v4 offset:34304
    s_waitcnt lgkmcnt(6)
    v_mfma_f32_16x16x32_bf16 v[32:35], v[244:247], v[104:107], v[32:35]
    ds_read_b64_tr_b16 v[236:237], v5 offset:33312
    v_mfma_f32_16x16x32_bf16 v[36:39], v[244:247], v[108:111], v[36:39]
    s_add_u32 s22, s19, 0x608000
    s_add_u32 m0, s20, 0x400
    s_nop 0
    buffer_load_dwordx4 v3, s[4:7], s22 offen lds
    ds_read_b64_tr_b16 v[238:239], v5 offset:34336
    s_mov_b32 s23, 0x6000
    buffer_load_dwordx4 v[88:91], v7, s[8:11], s23 offen offset:0 sc1
    s_waitcnt lgkmcnt(6)
    v_mfma_f32_16x16x32_bf16 v[40:43], v[224:227], v[104:107], v[40:43]
    ds_read_b64_tr_b16 v[240:241], v4 offset:33536
    v_mfma_f32_16x16x32_bf16 v[44:47], v[224:227], v[108:111], v[44:47]
    ds_read_b64_tr_b16 v[242:243], v4 offset:34560
    s_waitcnt lgkmcnt(6)
    v_mfma_f32_16x16x32_bf16 v[48:51], v[228:231], v[104:107], v[48:51]
    ds_read_b64_tr_b16 v[244:245], v5 offset:33568
    v_mfma_f32_16x16x32_bf16 v[52:55], v[228:231], v[108:111], v[52:55]
    ds_read_b64_tr_b16 v[246:247], v5 offset:34592
    s_waitcnt lgkmcnt(6)
    v_mfma_f32_16x16x32_bf16 v[56:59], v[232:235], v[104:107], v[56:59]
    ds_read_b64_tr_b16 v[224:225], v4 offset:40960
    v_mfma_f32_16x16x32_bf16 v[60:63], v[232:235], v[108:111], v[60:63]
    ds_read_b64_tr_b16 v[226:227], v4 offset:41984
    s_waitcnt lgkmcnt(6)
    v_mfma_f32_16x16x32_bf16 v[64:67], v[236:239], v[104:107], v[64:67]
    ds_read_b64_tr_b16 v[228:229], v5 offset:40992
    v_mfma_f32_16x16x32_bf16 v[68:71], v[236:239], v[108:111], v[68:71]
    ds_read_b64_tr_b16 v[230:231], v5 offset:42016
    s_mov_b32 s23, 0xe000
    buffer_load_dwordx4 v[92:95], v7, s[8:11], s23 offen offset:0 sc1
    s_waitcnt lgkmcnt(6)
    v_mfma_f32_16x16x32_bf16 v[72:75], v[240:243], v[104:107], v[72:75]
    ds_read_b64_tr_b16 v[232:233], v4 offset:41216
    v_mfma_f32_16x16x32_bf16 v[76:79], v[240:243], v[108:111], v[76:79]
    ds_read_b64_tr_b16 v[234:235], v4 offset:42240
    s_waitcnt lgkmcnt(6)
    v_mfma_f32_16x16x32_bf16 v[80:83], v[244:247], v[104:107], v[80:83]
    ds_read_b64_tr_b16 v[236:237], v5 offset:41248
    v_mfma_f32_16x16x32_bf16 v[84:87], v[244:247], v[108:111], v[84:87]
    ds_read_b64_tr_b16 v[238:239], v5 offset:42272
    s_waitcnt vmcnt(12) lgkmcnt(6)
    v_mfma_f32_16x16x32_bf16 v[24:27], v[224:227], v[112:115], v[24:27]
    ds_read_b64_tr_b16 v[240:241], v4 offset:41472
    s_add_u32 s22, s14, 0x0
    s_add_u32 m0, s20, 0x10000
    s_nop 0
    buffer_load_dwordx4 v6, s[76:79], s22 offen lds
    s_waitcnt vmcnt(11)
    v_mfma_f32_16x16x32_bf16 v[28:31], v[224:227], v[116:119], v[28:31]
    ds_read_b64_tr_b16 v[242:243], v4 offset:42496
    s_waitcnt lgkmcnt(6)
    v_mfma_f32_16x16x32_bf16 v[32:35], v[228:231], v[112:115], v[32:35]
    ds_read_b64_tr_b16 v[244:245], v5 offset:41504
    v_mfma_f32_16x16x32_bf16 v[36:39], v[228:231], v[116:119], v[36:39]
    ds_read_b64_tr_b16 v[246:247], v5 offset:42528
    s_mov_b32 s23, 0x6000
    buffer_load_dwordx4 v[96:99], v7, s[8:11], s23 offen offset:1024 sc1
    s_waitcnt lgkmcnt(6)
    v_mfma_f32_16x16x32_bf16 v[40:43], v[232:235], v[112:115], v[40:43]
    ds_read_b64_tr_b16 v[224:225], v4 offset:41728
    s_add_u32 s22, s14, 0xc000
    s_add_u32 m0, s20, 0x10400
    s_nop 0
    buffer_load_dwordx4 v6, s[76:79], s22 offen lds
    v_mfma_f32_16x16x32_bf16 v[44:47], v[232:235], v[116:119], v[44:47]
    ds_read_b64_tr_b16 v[226:227], v4 offset:42752
    s_waitcnt lgkmcnt(6)
    v_mfma_f32_16x16x32_bf16 v[48:51], v[236:239], v[112:115], v[48:51]
    ds_read_b64_tr_b16 v[228:229], v5 offset:41760
    v_mfma_f32_16x16x32_bf16 v[52:55], v[236:239], v[116:119], v[52:55]
    ds_read_b64_tr_b16 v[230:231], v5 offset:42784
    s_waitcnt lgkmcnt(6)
    v_mfma_f32_16x16x32_bf16 v[56:59], v[240:243], v[112:115], v[56:59]
    v_mfma_f32_16x16x32_bf16 v[60:63], v[240:243], v[116:119], v[60:63]
    s_waitcnt vmcnt(12)
    s_barrier
    ds_read_b64_tr_b16 v[232:233], v4 offset:49152
    ds_read_b64_tr_b16 v[234:235], v4 offset:50176
    s_waitcnt lgkmcnt(6)
    v_mfma_f32_16x16x32_bf16 v[64:67], v[244:247], v[112:115], v[64:67]
    ds_read_b64_tr_b16 v[236:237], v5 offset:49184
    v_mfma_f32_16x16x32_bf16 v[68:71], v[244:247], v[116:119], v[68:71]
    s_add_u32 s22, s19, 0x680000
    s_add_u32 m0, s20, 0x4000
    s_nop 0
    buffer_load_dwordx4 v3, s[4:7], s22 offen lds
    ds_read_b64_tr_b16 v[238:239], v5 offset:50208
    s_mov_b32 s23, 0xe000
    buffer_load_dwordx4 v[100:103], v7, s[8:11], s23 offen offset:1024 sc1
    s_waitcnt lgkmcnt(6)
    v_mfma_f32_16x16x32_bf16 v[72:75], v[224:227], v[112:115], v[72:75]
    ds_read_b64_tr_b16 v[240:241], v4 offset:49408
    v_mfma_f32_16x16x32_bf16 v[76:79], v[224:227], v[116:119], v[76:79]
    ds_read_b64_tr_b16 v[242:243], v4 offset:50432
    s_waitcnt lgkmcnt(6)
    v_mfma_f32_16x16x32_bf16 v[80:83], v[228:231], v[112:115], v[80:83]
    ds_read_b64_tr_b16 v[244:245], v5 offset:49440
    v_mfma_f32_16x16x32_bf16 v[84:87], v[228:231], v[116:119], v[84:87]
    ds_read_b64_tr_b16 v[246:247], v5 offset:50464
    s_waitcnt vmcnt(13) lgkmcnt(6)
    v_mfma_f32_16x16x32_bf16 v[24:27], v[232:235], v[120:123], v[24:27]
    ds_read_b64_tr_b16 v[224:225], v4 offset:49664
    s_waitcnt vmcnt(12)
    v_mfma_f32_16x16x32_bf16 v[28:31], v[232:235], v[124:127], v[28:31]
    ds_read_b64_tr_b16 v[226:227], v4 offset:50688
    s_waitcnt lgkmcnt(6)
    v_mfma_f32_16x16x32_bf16 v[32:35], v[236:239], v[120:123], v[32:35]
    ds_read_b64_tr_b16 v[228:229], v5 offset:49696
    v_mfma_f32_16x16x32_bf16 v[36:39], v[236:239], v[124:127], v[36:39]
    s_add_u32 s22, s19, 0x688000
    s_add_u32 m0, s20, 0x4400
    s_nop 0
    buffer_load_dwordx4 v3, s[4:7], s22 offen lds
    ds_read_b64_tr_b16 v[230:231], v5 offset:50720
    s_mov_b32 s23, 0x6800
    buffer_load_dwordx4 v[104:107], v7, s[8:11], s23 offen offset:0 sc1
    s_waitcnt lgkmcnt(6)
    v_mfma_f32_16x16x32_bf16 v[40:43], v[240:243], v[120:123], v[40:43]
    ds_read_b64_tr_b16 v[232:233], v4 offset:49920
    v_mfma_f32_16x16x32_bf16 v[44:47], v[240:243], v[124:127], v[44:47]
    ds_read_b64_tr_b16 v[234:235], v4 offset:50944
    s_waitcnt lgkmcnt(6)
    v_mfma_f32_16x16x32_bf16 v[48:51], v[244:247], v[120:123], v[48:51]
    ds_read_b64_tr_b16 v[236:237], v5 offset:49952
    v_mfma_f32_16x16x32_bf16 v[52:55], v[244:247], v[124:127], v[52:55]
    ds_read_b64_tr_b16 v[238:239], v5 offset:50976
    s_waitcnt lgkmcnt(6)
    v_mfma_f32_16x16x32_bf16 v[56:59], v[224:227], v[120:123], v[56:59]
    ds_read_b64_tr_b16 v[240:241], v4 offset:57344
    v_mfma_f32_16x16x32_bf16 v[60:63], v[224:227], v[124:127], v[60:63]
    ds_read_b64_tr_b16 v[242:243], v4 offset:58368
    s_waitcnt lgkmcnt(6)
    v_mfma_f32_16x16x32_bf16 v[64:67], v[228:231], v[120:123], v[64:67]
    ds_read_b64_tr_b16 v[244:245], v5 offset:57376
    v_mfma_f32_16x16x32_bf16 v[68:71], v[228:231], v[124:127], v[68:71]
    ds_read_b64_tr_b16 v[246:247], v5 offset:58400
    s_mov_b32 s23, 0xe800
    buffer_load_dwordx4 v[108:111], v7, s[8:11], s23 offen offset:0 sc1
    s_waitcnt lgkmcnt(6)
    v_mfma_f32_16x16x32_bf16 v[72:75], v[232:235], v[120:123], v[72:75]
    ds_read_b64_tr_b16 v[224:225], v4 offset:57600
    v_mfma_f32_16x16x32_bf16 v[76:79], v[232:235], v[124:127], v[76:79]
    ds_read_b64_tr_b16 v[226:227], v4 offset:58624
    s_waitcnt lgkmcnt(6)
    v_mfma_f32_16x16x32_bf16 v[80:83], v[236:239], v[120:123], v[80:83]
    ds_read_b64_tr_b16 v[228:229], v5 offset:57632
    v_mfma_f32_16x16x32_bf16 v[84:87], v[236:239], v[124:127], v[84:87]
    ds_read_b64_tr_b16 v[230:231], v5 offset:58656
    s_waitcnt vmcnt(13) lgkmcnt(6)
    v_mfma_f32_16x16x32_bf16 v[24:27], v[240:243], v[128:131], v[24:27]
    ds_read_b64_tr_b16 v[232:233], v4 offset:57856
    s_add_u32 s22, s14, 0xc0000
    s_add_u32 m0, s20, 0x14000
    s_nop 0
    buffer_load_dwordx4 v6, s[76:79], s22 offen lds
    s_waitcnt vmcnt(12)
    v_mfma_f32_16x16x32_bf16 v[28:31], v[240:243], v[132:135], v[28:31]
    ds_read_b64_tr_b16 v[234:235], v4 offset:58880
    s_waitcnt lgkmcnt(6)
    v_mfma_f32_16x16x32_bf16 v[32:35], v[244:247], v[128:131], v[32:35]
    ds_read_b64_tr_b16 v[236:237], v5 offset:57888
    v_mfma_f32_16x16x32_bf16 v[36:39], v[244:247], v[132:135], v[36:39]
    ds_read_b64_tr_b16 v[238:239], v5 offset:58912
    s_mov_b32 s23, 0x6800
    buffer_load_dwordx4 v[112:115], v7, s[8:11], s23 offen offset:1024 sc1
    s_waitcnt lgkmcnt(6)
    v_mfma_f32_16x16x32_bf16 v[40:43], v[224:227], v[128:131], v[40:43]
    ds_read_b64_tr_b16 v[240:241], v4 offset:58112
    s_add_u32 s22, s14, 0xcc000
    s_add_u32 m0, s20, 0x14400
    s_nop 0
    buffer_load_dwordx4 v6, s[76:79], s22 offen lds
    v_mfma_f32_16x16x32_bf16 v[44:47], v[224:227], v[132:135], v[44:47]
    ds_read_b64_tr_b16 v[242:243], v4 offset:59136
    s_waitcnt lgkmcnt(6)
    v_mfma_f32_16x16x32_bf16 v[48:51], v[228:231], v[128:131], v[48:51]
    ds_read_b64_tr_b16 v[244:245], v5 offset:58144
    v_mfma_f32_16x16x32_bf16 v[52:55], v[228:231], v[132:135], v[52:55]
    ds_read_b64_tr_b16 v[246:247], v5 offset:59168
    s_waitcnt lgkmcnt(6)
    v_mfma_f32_16x16x32_bf16 v[56:59], v[232:235], v[128:131], v[56:59]
    v_mfma_f32_16x16x32_bf16 v[60:63], v[232:235], v[132:135], v[60:63]
    s_waitcnt vmcnt(13)
    s_barrier
    ds_read_b64_tr_b16 v[224:225], v4 offset:0
    ds_read_b64_tr_b16 v[226:227], v4 offset:1024
    s_waitcnt lgkmcnt(6)
    v_mfma_f32_16x16x32_bf16 v[64:67], v[236:239], v[128:131], v[64:67]
    ds_read_b64_tr_b16 v[228:229], v5 offset:32
    v_mfma_f32_16x16x32_bf16 v[68:71], v[236:239], v[132:135], v[68:71]
    s_add_u32 s22, s19, 0x700000
    s_add_u32 m0, s20, 0x8000
    s_nop 0
    buffer_load_dwordx4 v3, s[4:7], s22 offen lds
    ds_read_b64_tr_b16 v[230:231], v5 offset:1056
    s_mov_b32 s23, 0xe800
    buffer_load_dwordx4 v[116:119], v7, s[8:11], s23 offen offset:1024 sc1
    s_waitcnt lgkmcnt(6)
    v_mfma_f32_16x16x32_bf16 v[72:75], v[240:243], v[128:131], v[72:75]
    ds_read_b64_tr_b16 v[232:233], v4 offset:256
    v_mfma_f32_16x16x32_bf16 v[76:79], v[240:243], v[132:135], v[76:79]
    ds_read_b64_tr_b16 v[234:235], v4 offset:1280
    s_waitcnt lgkmcnt(6)
    v_mfma_f32_16x16x32_bf16 v[80:83], v[244:247], v[128:131], v[80:83]
    ds_read_b64_tr_b16 v[236:237], v5 offset:288
    v_mfma_f32_16x16x32_bf16 v[84:87], v[244:247], v[132:135], v[84:87]
    ds_read_b64_tr_b16 v[238:239], v5 offset:1312
    s_waitcnt vmcnt(14) lgkmcnt(6)
    v_mfma_f32_16x16x32_bf16 v[24:27], v[224:227], v[88:91], v[24:27]
    ds_read_b64_tr_b16 v[240:241], v4 offset:512
    s_waitcnt vmcnt(13)
    v_mfma_f32_16x16x32_bf16 v[28:31], v[224:227], v[92:95], v[28:31]
    ds_read_b64_tr_b16 v[242:243], v4 offset:1536
    s_waitcnt lgkmcnt(6)
    v_mfma_f32_16x16x32_bf16 v[32:35], v[228:231], v[88:91], v[32:35]
    ds_read_b64_tr_b16 v[244:245], v5 offset:544
    v_mfma_f32_16x16x32_bf16 v[36:39], v[228:231], v[92:95], v[36:39]
    s_add_u32 s22, s19, 0x708000
    s_add_u32 m0, s20, 0x8400
    s_nop 0
    buffer_load_dwordx4 v3, s[4:7], s22 offen lds
    ds_read_b64_tr_b16 v[246:247], v5 offset:1568
    s_mov_b32 s23, 0x7000
    buffer_load_dwordx4 v[120:123], v7, s[8:11], s23 offen offset:0 sc1
    s_waitcnt lgkmcnt(6)
    v_mfma_f32_16x16x32_bf16 v[40:43], v[232:235], v[88:91], v[40:43]
    ds_read_b64_tr_b16 v[224:225], v4 offset:768
    v_mfma_f32_16x16x32_bf16 v[44:47], v[232:235], v[92:95], v[44:47]
    ds_read_b64_tr_b16 v[226:227], v4 offset:1792
    s_waitcnt lgkmcnt(6)
    v_mfma_f32_16x16x32_bf16 v[48:51], v[236:239], v[88:91], v[48:51]
    ds_read_b64_tr_b16 v[228:229], v5 offset:800
    v_mfma_f32_16x16x32_bf16 v[52:55], v[236:239], v[92:95], v[52:55]
    ds_read_b64_tr_b16 v[230:231], v5 offset:1824
    s_waitcnt lgkmcnt(6)
    v_mfma_f32_16x16x32_bf16 v[56:59], v[240:243], v[88:91], v[56:59]
    ds_read_b64_tr_b16 v[232:233], v4 offset:8192
    v_mfma_f32_16x16x32_bf16 v[60:63], v[240:243], v[92:95], v[60:63]
    ds_read_b64_tr_b16 v[234:235], v4 offset:9216
    s_waitcnt lgkmcnt(6)
    v_mfma_f32_16x16x32_bf16 v[64:67], v[244:247], v[88:91], v[64:67]
    ds_read_b64_tr_b16 v[236:237], v5 offset:8224
    v_mfma_f32_16x16x32_bf16 v[68:71], v[244:247], v[92:95], v[68:71]
    ds_read_b64_tr_b16 v[238:239], v5 offset:9248
    s_mov_b32 s23, 0xf000
    buffer_load_dwordx4 v[124:127], v7, s[8:11], s23 offen offset:0 sc1
    s_waitcnt lgkmcnt(6)
    v_mfma_f32_16x16x32_bf16 v[72:75], v[224:227], v[88:91], v[72:75]
    ds_read_b64_tr_b16 v[240:241], v4 offset:8448
    v_mfma_f32_16x16x32_bf16 v[76:79], v[224:227], v[92:95], v[76:79]
    ds_read_b64_tr_b16 v[242:243], v4 offset:9472
    s_waitcnt lgkmcnt(6)
    v_mfma_f32_16x16x32_bf16 v[80:83], v[228:231], v[88:91], v[80:83]
    ds_read_b64_tr_b16 v[244:245], v5 offset:8480
    v_mfma_f32_16x16x32_bf16 v[84:87], v[228:231], v[92:95], v[84:87]
    ds_read_b64_tr_b16 v[246:247], v5 offset:9504
    s_waitcnt vmcnt(14) lgkmcnt(6)
    v_mfma_f32_16x16x32_bf16 v[24:27], v[232:235], v[96:99], v[24:27]
    ds_read_b64_tr_b16 v[224:225], v4 offset:8704
    s_add_u32 s22, s21, 0x0
    s_add_u32 m0, s20, 0x18000
    s_nop 0
    buffer_load_dwordx4 v2, s[8:11], s22 offen sc1 lds
    s_waitcnt vmcnt(12)
    v_mfma_f32_16x16x32_bf16 v[28:31], v[232:235], v[100:103], v[28:31]
    ds_read_b64_tr_b16 v[226:227], v4 offset:9728
    s_waitcnt lgkmcnt(6)
    v_mfma_f32_16x16x32_bf16 v[32:35], v[236:239], v[96:99], v[32:35]
    ds_read_b64_tr_b16 v[228:229], v5 offset:8736
    v_mfma_f32_16x16x32_bf16 v[36:39], v[236:239], v[100:103], v[36:39]
    ds_read_b64_tr_b16 v[230:231], v5 offset:9760
    s_mov_b32 s23, 0x7000
    buffer_load_dwordx4 v[128:131], v7, s[8:11], s23 offen offset:1024 sc1
    s_waitcnt lgkmcnt(6)
    v_mfma_f32_16x16x32_bf16 v[40:43], v[240:243], v[96:99], v[40:43]
    ds_read_b64_tr_b16 v[232:233], v4 offset:8960
    s_add_u32 s22, s21, 0x400
    s_add_u32 m0, s20, 0x18400
    s_nop 0
    buffer_load_dwordx4 v2, s[8:11], s22 offen sc1 lds
    v_mfma_f32_16x16x32_bf16 v[44:47], v[240:243], v[100:103], v[44:47]
    ds_read_b64_tr_b16 v[234:235], v4 offset:9984
    s_waitcnt lgkmcnt(6)
    v_mfma_f32_16x16x32_bf16 v[48:51], v[244:247], v[96:99], v[48:51]
    ds_read_b64_tr_b16 v[236:237], v5 offset:8992
    v_mfma_f32_16x16x32_bf16 v[52:55], v[244:247], v[100:103], v[52:55]
    ds_read_b64_tr_b16 v[238:239], v5 offset:10016
    s_waitcnt lgkmcnt(6)
    v_mfma_f32_16x16x32_bf16 v[56:59], v[224:227], v[96:99], v[56:59]
    v_mfma_f32_16x16x32_bf16 v[60:63], v[224:227], v[100:103], v[60:63]
    s_waitcnt vmcnt(13)
    s_barrier
    ds_read_b64_tr_b16 v[240:241], v4 offset:16384
    ds_read_b64_tr_b16 v[242:243], v4 offset:17408
    s_waitcnt lgkmcnt(6)
    v_mfma_f32_16x16x32_bf16 v[64:67], v[228:231], v[96:99], v[64:67]
    ds_read_b64_tr_b16 v[244:245], v5 offset:16416
    v_mfma_f32_16x16x32_bf16 v[68:71], v[228:231], v[100:103], v[68:71]
    s_add_u32 s22, s19, 0x780000
    s_add_u32 m0, s20, 0xc000
    s_nop 0
    buffer_load_dwordx4 v3, s[4:7], s22 offen lds
    ds_read_b64_tr_b16 v[246:247], v5 offset:17440
    s_mov_b32 s23, 0xf000
    buffer_load_dwordx4 v[132:135], v7, s[8:11], s23 offen offset:1024 sc1
    s_waitcnt lgkmcnt(6)
    v_mfma_f32_16x16x32_bf16 v[72:75], v[232:235], v[96:99], v[72:75]
    ds_read_b64_tr_b16 v[224:225], v4 offset:16640
    v_mfma_f32_16x16x32_bf16 v[76:79], v[232:235], v[100:103], v[76:79]
    ds_read_b64_tr_b16 v[226:227], v4 offset:17664
    s_waitcnt lgkmcnt(6)
    v_mfma_f32_16x16x32_bf16 v[80:83], v[236:239], v[96:99], v[80:83]
    ds_read_b64_tr_b16 v[228:229], v5 offset:16672
    v_mfma_f32_16x16x32_bf16 v[84:87], v[236:239], v[100:103], v[84:87]
    ds_read_b64_tr_b16 v[230:231], v5 offset:17696
    s_waitcnt vmcnt(14) lgkmcnt(6)
    v_mfma_f32_16x16x32_bf16 v[24:27], v[240:243], v[104:107], v[24:27]
    ds_read_b64_tr_b16 v[232:233], v4 offset:16896
    s_waitcnt vmcnt(13)
    v_mfma_f32_16x16x32_bf16 v[28:31], v[240:243], v[108:111], v[28:31]
    ds_read_b64_tr_b16 v[234:235], v4 offset:17920
    s_waitcnt lgkmcnt(6)
    v_mfma_f32_16x16x32_bf16 v[32:35], v[244:247], v[104:107], v[32:35]
    ds_read_b64_tr_b16 v[236:237], v5 offset:16928
    v_mfma_f32_16x16x32_bf16 v[36:39], v[244:247], v[108:111], v[36:39]
    s_add_u32 s22, s19, 0x788000
    s_add_u32 m0, s20, 0xc400
    s_nop 0
    buffer_load_dwordx4 v3, s[4:7], s22 offen lds
    ds_read_b64_tr_b16 v[238:239], v5 offset:17952
    s_mov_b32 s23, 0x7800
    buffer_load_dwordx4 v[88:91], v7, s[8:11], s23 offen offset:0 sc1
    s_waitcnt lgkmcnt(6)
    v_mfma_f32_16x16x32_bf16 v[40:43], v[224:227], v[104:107], v[40:43]
    ds_read_b64_tr_b16 v[240:241], v4 offset:17152
    v_lshrrev_b32 v20, 4, v1
    v_lshlrev_b32 v21, 4, v20
    s_lshl_b32 s16, s2, 8
    s_add_u32 s16, s16, 0x550000
    buffer_load_dwordx4 v[136:139], v21, s[8:11], s16 offen offset:0 sc1
    buffer_load_dwordx4 v[140:143], v21, s[8:11], s16 offen offset:64 sc1
    buffer_load_dwordx4 v[144:147], v21, s[8:11], s16 offen offset:128 sc1
    buffer_load_dwordx4 v[148:151], v21, s[8:11], s16 offen offset:192 sc1
    v_lshlrev_b32 v11, 11, v20
    v_xor_b32 v20, s3, v20
    v_and_b32 v20, 1, v20
    v_lshl_add_u32 v11, v20, 5, v11
    v_bfe_u32 v20, v1, 2, 2
    v_lshl_add_u32 v11, v20, 6, v11
    v_and_b32 v20, 3, v1
    v_lshl_add_u32 v11, v20, 3, v11
    s_lshr_b32 s16, s3, 1
    s_lshl_b32 s16, s16, 8
    s_add_u32 s16, s16, 65536
    v_add_u32 v11, s16, v11
    v_mfma_f32_16x16x32_bf16 v[44:47], v[224:227], v[108:111], v[44:47]
    ds_read_b64_tr_b16 v[242:243], v4 offset:18176
    s_waitcnt lgkmcnt(6)
    v_mfma_f32_16x16x32_bf16 v[48:51], v[228:231], v[104:107], v[48:51]
    ds_read_b64_tr_b16 v[244:245], v5 offset:17184
    v_mfma_f32_16x16x32_bf16 v[52:55], v[228:231], v[108:111], v[52:55]
    ds_read_b64_tr_b16 v[246:247], v5 offset:18208
    s_waitcnt lgkmcnt(6)
    v_mfma_f32_16x16x32_bf16 v[56:59], v[232:235], v[104:107], v[56:59]
    ds_read_b64_tr_b16 v[224:225], v4 offset:24576
    v_mfma_f32_16x16x32_bf16 v[60:63], v[232:235], v[108:111], v[60:63]
    ds_read_b64_tr_b16 v[226:227], v4 offset:25600
    s_waitcnt lgkmcnt(6)
    v_mfma_f32_16x16x32_bf16 v[64:67], v[236:239], v[104:107], v[64:67]
    ds_read_b64_tr_b16 v[228:229], v5 offset:24608
    v_mfma_f32_16x16x32_bf16 v[68:71], v[236:239], v[108:111], v[68:71]
    ds_read_b64_tr_b16 v[230:231], v5 offset:25632
    s_mov_b32 s23, 0xf800
    buffer_load_dwordx4 v[92:95], v7, s[8:11], s23 offen offset:0 sc1
    s_waitcnt lgkmcnt(6)
    v_mfma_f32_16x16x32_bf16 v[72:75], v[240:243], v[104:107], v[72:75]
    ds_read_b64_tr_b16 v[232:233], v4 offset:24832
    v_mfma_f32_16x16x32_bf16 v[76:79], v[240:243], v[108:111], v[76:79]
    ds_read_b64_tr_b16 v[234:235], v4 offset:25856
    s_waitcnt lgkmcnt(6)
    v_mfma_f32_16x16x32_bf16 v[80:83], v[244:247], v[104:107], v[80:83]
    ds_read_b64_tr_b16 v[236:237], v5 offset:24864
    v_mfma_f32_16x16x32_bf16 v[84:87], v[244:247], v[108:111], v[84:87]
    ds_read_b64_tr_b16 v[238:239], v5 offset:25888
    s_waitcnt vmcnt(18) lgkmcnt(6)
    v_mfma_f32_16x16x32_bf16 v[24:27], v[224:227], v[112:115], v[24:27]
    ds_read_b64_tr_b16 v[240:241], v4 offset:25088
    s_add_u32 s22, s21, 0x4000
    s_add_u32 m0, s20, 0x1c000
    s_nop 0
    buffer_load_dwordx4 v2, s[8:11], s22 offen sc1 lds
    s_waitcnt vmcnt(16)
    v_mfma_f32_16x16x32_bf16 v[28:31], v[224:227], v[116:119], v[28:31]
    ds_read_b64_tr_b16 v[242:243], v4 offset:26112
    s_waitcnt lgkmcnt(6)
    v_mfma_f32_16x16x32_bf16 v[32:35], v[228:231], v[112:115], v[32:35]
    ds_read_b64_tr_b16 v[244:245], v5 offset:25120
    v_mfma_f32_16x16x32_bf16 v[36:39], v[228:231], v[116:119], v[36:39]
    ds_read_b64_tr_b16 v[246:247], v5 offset:26144
    s_mov_b32 s23, 0x7800
    buffer_load_dwordx4 v[96:99], v7, s[8:11], s23 offen offset:1024 sc1
    s_waitcnt lgkmcnt(6)
    v_mfma_f32_16x16x32_bf16 v[40:43], v[232:235], v[112:115], v[40:43]
    ds_read_b64_tr_b16 v[224:225], v4 offset:25344
    s_add_u32 s22, s21, 0x4400
    s_add_u32 m0, s20, 0x1c400
    s_nop 0
    buffer_load_dwordx4 v2, s[8:11], s22 offen sc1 lds
    v_mfma_f32_16x16x32_bf16 v[44:47], v[232:235], v[116:119], v[44:47]
    ds_read_b64_tr_b16 v[226:227], v4 offset:26368
    s_waitcnt lgkmcnt(6)
    v_mfma_f32_16x16x32_bf16 v[48:51], v[236:239], v[112:115], v[48:51]
    ds_read_b64_tr_b16 v[228:229], v5 offset:25376
    v_mfma_f32_16x16x32_bf16 v[52:55], v[236:239], v[116:119], v[52:55]
    ds_read_b64_tr_b16 v[230:231], v5 offset:26400
    s_waitcnt lgkmcnt(6)
    v_mfma_f32_16x16x32_bf16 v[56:59], v[240:243], v[112:115], v[56:59]
    v_mfma_f32_16x16x32_bf16 v[60:63], v[240:243], v[116:119], v[60:63]
    s_waitcnt vmcnt(17)
    s_barrier
    ds_read_b64_tr_b16 v[232:233], v4 offset:32768
    ds_read_b64_tr_b16 v[234:235], v4 offset:33792
    s_waitcnt lgkmcnt(6)
    v_mfma_f32_16x16x32_bf16 v[64:67], v[244:247], v[112:115], v[64:67]
    ds_read_b64_tr_b16 v[236:237], v5 offset:32800
    v_mfma_f32_16x16x32_bf16 v[68:71], v[244:247], v[116:119], v[68:71]
    ds_read_b64_tr_b16 v[238:239], v5 offset:33824
    s_mov_b32 s23, 0xf800
    buffer_load_dwordx4 v[100:103], v7, s[8:11], s23 offen offset:1024 sc1
    s_waitcnt lgkmcnt(6)
    v_mfma_f32_16x16x32_bf16 v[72:75], v[224:227], v[112:115], v[72:75]
    ds_read_b64_tr_b16 v[240:241], v4 offset:33024
    v_mfma_f32_16x16x32_bf16 v[76:79], v[224:227], v[116:119], v[76:79]
    ds_read_b64_tr_b16 v[242:243], v4 offset:34048
    s_waitcnt lgkmcnt(6)
    v_mfma_f32_16x16x32_bf16 v[80:83], v[228:231], v[112:115], v[80:83]
    ds_read_b64_tr_b16 v[244:245], v5 offset:33056
    v_mfma_f32_16x16x32_bf16 v[84:87], v[228:231], v[116:119], v[84:87]
    ds_read_b64_tr_b16 v[246:247], v5 offset:34080
    s_waitcnt vmcnt(17) lgkmcnt(6)
    v_mfma_f32_16x16x32_bf16 v[24:27], v[232:235], v[120:123], v[24:27]
    ds_read_b64_tr_b16 v[224:225], v4 offset:33280
    s_waitcnt vmcnt(16)
    v_mfma_f32_16x16x32_bf16 v[28:31], v[232:235], v[124:127], v[28:31]
    ds_read_b64_tr_b16 v[226:227], v4 offset:34304
    s_waitcnt lgkmcnt(6)
    v_mfma_f32_16x16x32_bf16 v[32:35], v[236:239], v[120:123], v[32:35]
    ds_read_b64_tr_b16 v[228:229], v5 offset:33312
    v_mfma_f32_16x16x32_bf16 v[36:39], v[236:239], v[124:127], v[36:39]
    ds_read_b64_tr_b16 v[230:231], v5 offset:34336
    s_waitcnt lgkmcnt(6)
    v_mfma_f32_16x16x32_bf16 v[40:43], v[240:243], v[120:123], v[40:43]
    ds_read_b64_tr_b16 v[232:233], v4 offset:33536
    v_mfma_f32_16x16x32_bf16 v[44:47], v[240:243], v[124:127], v[44:47]
    ds_read_b64_tr_b16 v[234:235], v4 offset:34560
    s_waitcnt lgkmcnt(6)
    v_mfma_f32_16x16x32_bf16 v[48:51], v[244:247], v[120:123], v[48:51]
    ds_read_b64_tr_b16 v[236:237], v5 offset:33568
    v_mfma_f32_16x16x32_bf16 v[52:55], v[244:247], v[124:127], v[52:55]
    ds_read_b64_tr_b16 v[238:239], v5 offset:34592
    s_waitcnt lgkmcnt(6)
    v_mfma_f32_16x16x32_bf16 v[56:59], v[224:227], v[120:123], v[56:59]
    ds_read_b64_tr_b16 v[240:241], v4 offset:40960
    v_mfma_f32_16x16x32_bf16 v[60:63], v[224:227], v[124:127], v[60:63]
    ds_read_b64_tr_b16 v[242:243], v4 offset:41984
    s_waitcnt lgkmcnt(6)
    v_mfma_f32_16x16x32_bf16 v[64:67], v[228:231], v[120:123], v[64:67]
    ds_read_b64_tr_b16 v[244:245], v5 offset:40992
    v_mfma_f32_16x16x32_bf16 v[68:71], v[228:231], v[124:127], v[68:71]
    ds_read_b64_tr_b16 v[246:247], v5 offset:42016
    s_waitcnt lgkmcnt(6)
    v_mfma_f32_16x16x32_bf16 v[72:75], v[232:235], v[120:123], v[72:75]
    ds_read_b64_tr_b16 v[224:225], v4 offset:41216
    v_mfma_f32_16x16x32_bf16 v[76:79], v[232:235], v[124:127], v[76:79]
    ds_read_b64_tr_b16 v[226:227], v4 offset:42240
    s_waitcnt lgkmcnt(6)
    v_mfma_f32_16x16x32_bf16 v[80:83], v[236:239], v[120:123], v[80:83]
    ds_read_b64_tr_b16 v[228:229], v5 offset:41248
    v_mfma_f32_16x16x32_bf16 v[84:87], v[236:239], v[124:127], v[84:87]
    ds_read_b64_tr_b16 v[230:231], v5 offset:42272
    s_waitcnt vmcnt(14) lgkmcnt(6)
    v_mfma_f32_16x16x32_bf16 v[24:27], v[240:243], v[128:131], v[24:27]
    ds_read_b64_tr_b16 v[232:233], v4 offset:41472
    s_waitcnt vmcnt(11)
    v_mfma_f32_16x16x32_bf16 v[28:31], v[240:243], v[132:135], v[28:31]
    ds_read_b64_tr_b16 v[234:235], v4 offset:42496
    s_waitcnt lgkmcnt(6)
    v_mfma_f32_16x16x32_bf16 v[32:35], v[244:247], v[128:131], v[32:35]
    ds_read_b64_tr_b16 v[236:237], v5 offset:41504
    v_mfma_f32_16x16x32_bf16 v[36:39], v[244:247], v[132:135], v[36:39]
    ds_read_b64_tr_b16 v[238:239], v5 offset:42528
    s_waitcnt lgkmcnt(6)
    v_mfma_f32_16x16x32_bf16 v[40:43], v[224:227], v[128:131], v[40:43]
    ds_read_b64_tr_b16 v[240:241], v4 offset:41728
    v_mfma_f32_16x16x32_bf16 v[44:47], v[224:227], v[132:135], v[44:47]
    ds_read_b64_tr_b16 v[242:243], v4 offset:42752
    s_waitcnt lgkmcnt(6)
    v_mfma_f32_16x16x32_bf16 v[48:51], v[228:231], v[128:131], v[48:51]
    ds_read_b64_tr_b16 v[244:245], v5 offset:41760
    v_mfma_f32_16x16x32_bf16 v[52:55], v[228:231], v[132:135], v[52:55]
    ds_read_b64_tr_b16 v[246:247], v5 offset:42784
    s_waitcnt lgkmcnt(6)
    v_mfma_f32_16x16x32_bf16 v[56:59], v[232:235], v[128:131], v[56:59]
    v_mfma_f32_16x16x32_bf16 v[60:63], v[232:235], v[132:135], v[60:63]
    s_waitcnt vmcnt(10)
    s_barrier
    ds_read_b64_tr_b16 v[224:225], v4 offset:49152
    ds_read_b64_tr_b16 v[226:227], v4 offset:50176
    s_waitcnt lgkmcnt(6)
    v_mfma_f32_16x16x32_bf16 v[64:67], v[236:239], v[128:131], v[64:67]
    ds_read_b64_tr_b16 v[228:229], v5 offset:49184
    v_mfma_f32_16x16x32_bf16 v[68:71], v[236:239], v[132:135], v[68:71]
    ds_read_b64_tr_b16 v[230:231], v5 offset:50208
    s_waitcnt lgkmcnt(6)
    v_mfma_f32_16x16x32_bf16 v[72:75], v[240:243], v[128:131], v[72:75]
    ds_read_b64_tr_b16 v[232:233], v4 offset:49408
    v_mfma_f32_16x16x32_bf16 v[76:79], v[240:243], v[132:135], v[76:79]
    ds_read_b64_tr_b16 v[234:235], v4 offset:50432
    s_waitcnt lgkmcnt(6)
    v_mfma_f32_16x16x32_bf16 v[80:83], v[244:247], v[128:131], v[80:83]
    ds_read_b64_tr_b16 v[236:237], v5 offset:49440
    v_mfma_f32_16x16x32_bf16 v[84:87], v[244:247], v[132:135], v[84:87]
    ds_read_b64_tr_b16 v[238:239], v5 offset:50464
    s_waitcnt vmcnt(9) lgkmcnt(6)
    v_mfma_f32_16x16x32_bf16 v[24:27], v[224:227], v[88:91], v[24:27]
    ds_read_b64_tr_b16 v[240:241], v4 offset:49664
    s_waitcnt vmcnt(4)
    v_mfma_f32_16x16x32_bf16 v[28:31], v[224:227], v[92:95], v[28:31]
    ds_read_b64_tr_b16 v[242:243], v4 offset:50688
    s_waitcnt lgkmcnt(6)
    v_mfma_f32_16x16x32_bf16 v[32:35], v[228:231], v[88:91], v[32:35]
    ds_read_b64_tr_b16 v[244:245], v5 offset:49696
    v_mfma_f32_16x16x32_bf16 v[36:39], v[228:231], v[92:95], v[36:39]
    ds_read_b64_tr_b16 v[246:247], v5 offset:50720
    s_waitcnt lgkmcnt(6)
    v_mfma_f32_16x16x32_bf16 v[40:43], v[232:235], v[88:91], v[40:43]
    ds_read_b64_tr_b16 v[224:225], v4 offset:49920
    v_mfma_f32_16x16x32_bf16 v[44:47], v[232:235], v[92:95], v[44:47]
    ds_read_b64_tr_b16 v[226:227], v4 offset:50944
    s_waitcnt lgkmcnt(6)
    v_mfma_f32_16x16x32_bf16 v[48:51], v[236:239], v[88:91], v[48:51]
    ds_read_b64_tr_b16 v[228:229], v5 offset:49952
    v_mfma_f32_16x16x32_bf16 v[52:55], v[236:239], v[92:95], v[52:55]
    ds_read_b64_tr_b16 v[230:231], v5 offset:50976
    s_waitcnt lgkmcnt(6)
    v_mfma_f32_16x16x32_bf16 v[56:59], v[240:243], v[88:91], v[56:59]
    ds_read_b64_tr_b16 v[232:233], v4 offset:57344
    v_mfma_f32_16x16x32_bf16 v[60:63], v[240:243], v[92:95], v[60:63]
    ds_read_b64_tr_b16 v[234:235], v4 offset:58368
    s_waitcnt lgkmcnt(6)
    v_mfma_f32_16x16x32_bf16 v[64:67], v[244:247], v[88:91], v[64:67]
    ds_read_b64_tr_b16 v[236:237], v5 offset:57376
    v_mfma_f32_16x16x32_bf16 v[68:71], v[244:247], v[92:95], v[68:71]
    ds_read_b64_tr_b16 v[238:239], v5 offset:58400
    s_waitcnt lgkmcnt(6)
    v_mfma_f32_16x16x32_bf16 v[72:75], v[224:227], v[88:91], v[72:75]
    ds_read_b64_tr_b16 v[240:241], v4 offset:57600
    v_mfma_f32_16x16x32_bf16 v[76:79], v[224:227], v[92:95], v[76:79]
    ds_read_b64_tr_b16 v[242:243], v4 offset:58624
    s_waitcnt lgkmcnt(6)
    v_mfma_f32_16x16x32_bf16 v[80:83], v[228:231], v[88:91], v[80:83]
    ds_read_b64_tr_b16 v[244:245], v5 offset:57632
    v_mfma_f32_16x16x32_bf16 v[84:87], v[228:231], v[92:95], v[84:87]
    ds_read_b64_tr_b16 v[246:247], v5 offset:58656
    s_waitcnt vmcnt(2) lgkmcnt(6)
    v_mfma_f32_16x16x32_bf16 v[24:27], v[232:235], v[96:99], v[24:27]
    ds_read_b64_tr_b16 v[224:225], v4 offset:57856
    s_waitcnt vmcnt(0)
    v_mfma_f32_16x16x32_bf16 v[28:31], v[232:235], v[100:103], v[28:31]
    ds_read_b64_tr_b16 v[226:227], v4 offset:58880
    s_waitcnt lgkmcnt(6)
    v_mfma_f32_16x16x32_bf16 v[32:35], v[236:239], v[96:99], v[32:35]
    ds_read_b64_tr_b16 v[228:229], v5 offset:57888
    v_mfma_f32_16x16x32_bf16 v[36:39], v[236:239], v[100:103], v[36:39]
    ds_read_b64_tr_b16 v[230:231], v5 offset:58912
    s_waitcnt lgkmcnt(6)
    v_mfma_f32_16x16x32_bf16 v[40:43], v[240:243], v[96:99], v[40:43]
    ds_read_b64_tr_b16 v[232:233], v4 offset:58112
    v_mfma_f32_16x16x32_bf16 v[44:47], v[240:243], v[100:103], v[44:47]
    ds_read_b64_tr_b16 v[234:235], v4 offset:59136
    s_waitcnt lgkmcnt(6)
    v_mfma_f32_16x16x32_bf16 v[48:51], v[244:247], v[96:99], v[48:51]
    ds_read_b64_tr_b16 v[236:237], v5 offset:58144
    v_mfma_f32_16x16x32_bf16 v[52:55], v[244:247], v[100:103], v[52:55]
    ds_read_b64_tr_b16 v[238:239], v5 offset:59168
    s_waitcnt lgkmcnt(6)
    v_mfma_f32_16x16x32_bf16 v[56:59], v[224:227], v[96:99], v[56:59]
    v_mfma_f32_16x16x32_bf16 v[60:63], v[224:227], v[100:103], v[60:63]
    s_waitcnt lgkmcnt(4)
    v_mfma_f32_16x16x32_bf16 v[64:67], v[228:231], v[96:99], v[64:67]
    v_mfma_f32_16x16x32_bf16 v[68:71], v[228:231], v[100:103], v[68:71]
    s_waitcnt lgkmcnt(2)
    v_mfma_f32_16x16x32_bf16 v[72:75], v[232:235], v[96:99], v[72:75]
    v_mfma_f32_16x16x32_bf16 v[76:79], v[232:235], v[100:103], v[76:79]
    s_waitcnt lgkmcnt(0)
    v_mfma_f32_16x16x32_bf16 v[80:83], v[236:239], v[96:99], v[80:83]
    v_mfma_f32_16x16x32_bf16 v[84:87], v[236:239], v[100:103], v[84:87]
    s_barrier
    s_add_u32 s22, s21, 0x8000
    s_add_u32 m0, s20, 0x20000
    s_nop 0
    buffer_load_dwordx4 v2, s[8:11], s22 offen sc1 lds
    s_add_u32 s22, s21, 0x8400
    s_add_u32 m0, s20, 0x20400
    s_nop 0
    buffer_load_dwordx4 v2, s[8:11], s22 offen sc1 lds
    s_add_u32 s22, s21, 0xc000
    s_add_u32 m0, s20, 0x24000
    s_nop 0
    buffer_load_dwordx4 v2, s[8:11], s22 offen sc1 lds
    s_add_u32 s22, s21, 0xc400
    s_add_u32 m0, s20, 0x24400
    s_nop 0
    buffer_load_dwordx4 v2, s[8:11], s22 offen sc1 lds
    ds_read_b64_tr_b16 v[88:89], v11 offset:0
    ds_read_b64_tr_b16 v[90:91], v11 offset:1024
    ds_read_b64_tr_b16 v[92:93], v11 offset:8192
    ds_read_b64_tr_b16 v[94:95], v11 offset:9216
    ds_read_b64_tr_b16 v[96:97], v11 offset:16384
    ds_read_b64_tr_b16 v[98:99], v11 offset:17408
    ds_read_b64_tr_b16 v[100:101], v11 offset:24576
    ds_read_b64_tr_b16 v[102:103], v11 offset:25600
    s_mov_b32 s23, 0x3e0293ee
    v_mul_f32 v24, s23, v24
    v_mul_f32 v25, s23, v25
    v_mul_f32 v26, s23, v26
    v_mul_f32 v27, s23, v27
    v_mul_f32 v28, s23, v28
    v_mul_f32 v29, s23, v29
    v_mul_f32 v30, s23, v30
    v_mul_f32 v31, s23, v31
    v_mul_f32 v32, s23, v32
    v_mul_f32 v33, s23, v33
    v_mul_f32 v34, s23, v34
    v_mul_f32 v35, s23, v35
    v_mul_f32 v36, s23, v36
    v_mul_f32 v37, s23, v37
    v_mul_f32 v38, s23, v38
    v_mul_f32 v39, s23, v39
    v_cvt_pk_bf16_f32 v152, v24, v25
    v_cvt_pk_bf16_f32 v153, v26, v27
    v_cvt_pk_bf16_f32 v168, v28, v29
    v_cvt_pk_bf16_f32 v169, v30, v31
    v_cvt_pk_bf16_f32 v154, v32, v33
    v_cvt_pk_bf16_f32 v155, v34, v35
    v_cvt_pk_bf16_f32 v170, v36, v37
    v_cvt_pk_bf16_f32 v171, v38, v39
    s_waitcnt lgkmcnt(6)
    v_mfma_f32_16x16x32_bf16 v[104:107], v[88:91], v[136:139], 0
    s_waitcnt lgkmcnt(4)
    v_mfma_f32_16x16x32_bf16 v[104:107], v[92:95], v[140:143], v[104:107]
    s_waitcnt lgkmcnt(2)
    v_mfma_f32_16x16x32_bf16 v[104:107], v[96:99], v[144:147], v[104:107]
    s_waitcnt lgkmcnt(0)
    v_mfma_f32_16x16x32_bf16 v[104:107], v[100:103], v[148:151], v[104:107]
    v_add_u32 v4, 0x10000, v2
    v_add_u32 v5, 0x20000, v2
    s_barrier
    ds_read_b128 v[224:227], v4 offset:32768
    ds_read_b128 v[228:231], v4 offset:33792
    ds_read_b128 v[232:235], v4 offset:34816
    ds_read_b128 v[236:239], v4 offset:35840
    v_mov_b32 v12, 0x3f803f80
    v_mov_b32 v13, 0x3f803f80
    v_mov_b32 v14, 0x3f803f80
    v_mov_b32 v15, 0x3f803f80
    s_waitcnt lgkmcnt(3)
    v_mfma_f32_16x16x32_bf16 v[184:187], v[224:227], v[152:155], 0
    v_mul_f32 v40, s23, v40
    v_mul_f32 v41, s23, v41
    v_mul_f32 v42, s23, v42
    v_mul_f32 v43, s23, v43
    v_mul_f32 v44, s23, v44
    v_mul_f32 v45, s23, v45
    v_lshrrev_b32 v20, 4, v1
    v_lshlrev_b32 v20, 4, v20
    s_lshr_b32 s16, s2, 5
    s_lshl_b32 s16, s16, 14
    s_and_b32 s17, s2, 31
    s_lshl_b32 s17, s17, 9
    s_add_u32 s16, s16, s17
    s_lshl_b32 s17, s3, 6
    s_add_u32 s16, s16, s17
    s_add_u32 s16, s16, 0x580000
    s_mov_b32 exec_lo, 0x10001
    s_mov_b32 exec_hi, 0x10001
    buffer_store_dwordx4 v[104:107], v20, s[8:11], s16 offen sc1
    s_mov_b64 exec, -1
    v_mfma_f32_16x16x32_bf16 v[188:191], v[224:227], v[168:171], 0
    ds_read_b128 v[240:243], v4 offset:36864
    v_mul_f32 v46, s23, v46
    v_mul_f32 v47, s23, v47
    v_mul_f32 v48, s23, v48
    v_mul_f32 v49, s23, v49
    v_mul_f32 v50, s23, v50
    v_mul_f32 v51, s23, v51
    s_mov_b64 s[64:65], s[46:47]
    s_mov_b32 s66, 0x700000
    s_mov_b32 s67, 0x20000
    s_mov_b64 s[68:69], s[48:49]
    s_mov_b32 s70, 0x700000
    s_mov_b32 s71, 0x20000
    s_cmp_lt_u32 s2, 224
    s_cselect_b32 s66, 7340032, 0
    s_cselect_b32 s70, 7340032, 0
    s_and_b32 s29, s2, 7
    s_mul_i32 s29, s29, 28
    s_lshr_b32 s16, s2, 3
    s_add_u32 s29, s29, s16
    s_sub_u32 s16, s3, 4
    v_lshrrev_b32 v20, 3, v1
    v_lshlrev_b32 v20, 3, v20
    s_lshl_b32 s17, s16, 6
    v_add_u32 v20, s17, v20
    s_mov_b32 s17, 7168
    v_mul_lo_u32 v11, s17, v20
    v_and_b32 v20, 7, v1
    v_lshl_add_u32 v11, v20, 4, v11
    s_and_b32 s17, s29, 3
    s_mul_i32 s18, s17, 1835008
    s_lshr_b32 s17, s29, 2
    s_lshl_b32 s17, s17, 7
    s_add_u32 s18, s18, s17
    s_lshl_b32 s15, s16, 13
    s_waitcnt lgkmcnt(3)
    v_mfma_f32_16x16x32_bf16 v[192:195], v[228:231], v[152:155], 0
    s_add_u32 s22, s21, 0x10000
    s_add_u32 m0, s20, 0x10000
    s_nop 0
    buffer_load_dwordx4 v2, s[8:11], s22 offen sc1 lds
    v_mul_f32 v52, s23, v52
    v_mul_f32 v53, s23, v53
    v_mul_f32 v54, s23, v54
    v_mul_f32 v55, s23, v55
    v_cvt_pk_bf16_f32 v156, v40, v41
    v_cvt_pk_bf16_f32 v157, v42, v43
    v_mfma_f32_16x16x32_bf16 v[196:199], v[228:231], v[168:171], 0
    ds_read_b128 v[244:247], v4 offset:37888
    v_cvt_pk_bf16_f32 v172, v44, v45
    v_cvt_pk_bf16_f32 v173, v46, v47
    v_cvt_pk_bf16_f32 v158, v48, v49
    v_cvt_pk_bf16_f32 v159, v50, v51
    v_cvt_pk_bf16_f32 v174, v52, v53
    v_cvt_pk_bf16_f32 v175, v54, v55
    s_waitcnt lgkmcnt(3)
    v_mfma_f32_16x16x32_bf16 v[184:187], v[232:235], v[156:159], v[184:187]
    v_mul_f32 v56, s23, v56
    v_mul_f32 v57, s23, v57
    v_mul_f32 v58, s23, v58
    v_mul_f32 v59, s23, v59
    v_mul_f32 v60, s23, v60
    v_mul_f32 v61, s23, v61
    v_mfma_f32_16x16x32_bf16 v[188:191], v[232:235], v[172:175], v[188:191]
    ds_read_b128 v[224:227], v4 offset:38912
    v_mul_f32 v62, s23, v62
    v_mul_f32 v63, s23, v63
    v_mul_f32 v64, s23, v64
    v_mul_f32 v65, s23, v65
    v_mul_f32 v66, s23, v66
    v_mul_f32 v67, s23, v67
    s_waitcnt lgkmcnt(3)
    v_mfma_f32_16x16x32_bf16 v[192:195], v[236:239], v[156:159], v[192:195]
    v_mul_f32 v68, s23, v68
    v_mul_f32 v69, s23, v69
    v_mul_f32 v70, s23, v70
    v_mul_f32 v71, s23, v71
    v_cvt_pk_bf16_f32 v160, v56, v57
    v_cvt_pk_bf16_f32 v161, v58, v59
    v_mfma_f32_16x16x32_bf16 v[196:199], v[236:239], v[172:175], v[196:199]
    ds_read_b128 v[228:231], v4 offset:39936
    v_cvt_pk_bf16_f32 v176, v60, v61
    v_cvt_pk_bf16_f32 v177, v62, v63
    v_cvt_pk_bf16_f32 v162, v64, v65
    v_cvt_pk_bf16_f32 v163, v66, v67
    v_cvt_pk_bf16_f32 v178, v68, v69
    v_cvt_pk_bf16_f32 v179, v70, v71
    s_waitcnt lgkmcnt(3)
    v_mfma_f32_16x16x32_bf16 v[184:187], v[240:243], v[160:163], v[184:187]
    v_mul_f32 v72, s23, v72
    v_mul_f32 v73, s23, v73
    v_mul_f32 v74, s23, v74
    v_mul_f32 v75, s23, v75
    v_mul_f32 v76, s23, v76
    v_mul_f32 v77, s23, v77
    v_mfma_f32_16x16x32_bf16 v[188:191], v[240:243], v[176:179], v[188:191]
    ds_read_b128 v[232:235], v4 offset:40960
    v_mul_f32 v78, s23, v78
    v_mul_f32 v79, s23, v79
    v_mul_f32 v80, s23, v80
    v_mul_f32 v81, s23, v81
    v_mul_f32 v82, s23, v82
    v_mul_f32 v83, s23, v83
    s_waitcnt lgkmcnt(3)
    v_mfma_f32_16x16x32_bf16 v[192:195], v[244:247], v[160:163], v[192:195]
    s_add_u32 s22, s21, 0x10400
    s_add_u32 m0, s20, 0x10400
    s_nop 0
    buffer_load_dwordx4 v2, s[8:11], s22 offen sc1 lds
    v_mul_f32 v84, s23, v84
    v_mul_f32 v85, s23, v85
    v_mul_f32 v86, s23, v86
    v_mul_f32 v87, s23, v87
    v_cvt_pk_bf16_f32 v164, v72, v73
    v_cvt_pk_bf16_f32 v165, v74, v75
    v_mfma_f32_16x16x32_bf16 v[196:199], v[244:247], v[176:179], v[196:199]
    ds_read_b128 v[236:239], v4 offset:41984
    v_cvt_pk_bf16_f32 v180, v76, v77
    v_cvt_pk_bf16_f32 v181, v78, v79
    v_cvt_pk_bf16_f32 v166, v80, v81
    v_cvt_pk_bf16_f32 v167, v82, v83
    v_cvt_pk_bf16_f32 v182, v84, v85
    v_cvt_pk_bf16_f32 v183, v86, v87
    s_waitcnt lgkmcnt(3)
    v_mfma_f32_16x16x32_bf16 v[184:187], v[224:227], v[164:167], v[184:187]
    v_mfma_f32_16x16x32_bf16 v[188:191], v[224:227], v[180:183], v[188:191]
    ds_read_b128 v[240:243], v4 offset:43008
    s_waitcnt lgkmcnt(3)
    v_mfma_f32_16x16x32_bf16 v[192:195], v[228:231], v[164:167], v[192:195]
    v_mfma_f32_16x16x32_bf16 v[196:199], v[228:231], v[180:183], v[196:199]
    ds_read_b128 v[244:247], v4 offset:44032
    s_waitcnt lgkmcnt(3)
    v_mfma_f32_16x16x32_bf16 v[200:203], v[232:235], v[152:155], 0
    v_mfma_f32_16x16x32_bf16 v[204:207], v[232:235], v[168:171], 0
    ds_read_b128 v[224:227], v4 offset:45056
    s_waitcnt lgkmcnt(3)
    v_mfma_f32_16x16x32_bf16 v[208:211], v[236:239], v[152:155], 0
    v_mfma_f32_16x16x32_bf16 v[212:215], v[236:239], v[168:171], 0
    ds_read_b128 v[228:231], v4 offset:46080
    s_waitcnt lgkmcnt(3)
    v_mfma_f32_16x16x32_bf16 v[200:203], v[240:243], v[156:159], v[200:203]
    v_mfma_f32_16x16x32_bf16 v[204:207], v[240:243], v[172:175], v[204:207]
    ds_read_b128 v[232:235], v4 offset:47104
    s_waitcnt lgkmcnt(3)
    v_mfma_f32_16x16x32_bf16 v[208:211], v[244:247], v[156:159], v[208:211]
    v_max3_f32 v16, v184, v185, v186
    v_mfma_f32_16x16x32_bf16 v[212:215], v[244:247], v[172:175], v[212:215]
    ds_read_b128 v[236:239], v4 offset:48128
    v_max3_f32 v16, v16, v187, v192
    s_waitcnt lgkmcnt(3)
    v_mfma_f32_16x16x32_bf16 v[200:203], v[224:227], v[160:163], v[200:203]
    v_max3_f32 v16, v16, v193, v194
    v_mfma_f32_16x16x32_bf16 v[204:207], v[224:227], v[176:179], v[204:207]
    s_barrier
    ds_read_b128 v[240:243], v4 offset:49152
    v_max_f32 v16, v16, v195
    s_waitcnt lgkmcnt(3)
    v_mfma_f32_16x16x32_bf16 v[208:211], v[228:231], v[160:163], v[208:211]
    v_max3_f32 v17, v188, v189, v190
    v_mfma_f32_16x16x32_bf16 v[212:215], v[228:231], v[176:179], v[212:215]
    s_add_u32 s22, s21, 0x14000
    s_add_u32 m0, s20, 0x14000
    s_nop 0
    buffer_load_dwordx4 v2, s[8:11], s22 offen sc1 lds
    ds_read_b128 v[244:247], v4 offset:50176
    v_max3_f32 v17, v17, v191, v196
    s_waitcnt lgkmcnt(3)
    v_mfma_f32_16x16x32_bf16 v[200:203], v[232:235], v[164:167], v[200:203]
    v_max3_f32 v17, v17, v197, v198
    v_mfma_f32_16x16x32_bf16 v[204:207], v[232:235], v[180:183], v[204:207]
    ds_read_b128 v[224:227], v4 offset:51200
    v_max_f32 v17, v17, v199
    s_waitcnt lgkmcnt(3)
    v_mfma_f32_16x16x32_bf16 v[208:211], v[236:239], v[164:167], v[208:211]
    v_mfma_f32_16x16x32_bf16 v[212:215], v[236:239], v[180:183], v[212:215]
    ds_read_b128 v[228:231], v4 offset:52224
    v_max3_f32 v16, v16, v200, v201
    v_max3_f32 v16, v16, v202, v203
    s_nop 3
    v_max3_f32 v16, v16, v208, v209
    v_max3_f32 v16, v16, v210, v211
    v_max3_f32 v17, v17, v204, v205
    v_max3_f32 v17, v17, v206, v207
    v_max3_f32 v17, v17, v212, v213
    v_max3_f32 v17, v17, v214, v215
    v_mov_b32 v18, v16
    v_mov_b32 v19, v17
    s_nop 0
    v_permlane16_swap_b32 v16, v18
    v_permlane16_swap_b32 v17, v19
    v_max_f32 v16, v16, v18
    v_max_f32 v17, v17, v19
    v_mov_b32 v18, v16
    v_mov_b32 v19, v17
    s_nop 0
    v_permlane32_swap_b32 v16, v18
    v_permlane32_swap_b32 v17, v19
    v_max_f32 v16, v16, v18
    v_max_f32 v17, v17, v19
    v_sub_f32 v216, 0, v16
    v_sub_f32 v217, 0, v16
    v_sub_f32 v218, 0, v16
    v_sub_f32 v219, 0, v16
    v_sub_f32 v220, 0, v17
    v_sub_f32 v221, 0, v17
    v_sub_f32 v222, 0, v17
    v_sub_f32 v223, 0, v17
    v_add_f32 v184, v184, v216
    v_add_f32 v185, v185, v216
    v_exp_f32 v184, v184
    v_exp_f32 v185, v185
    s_nop 0
    v_cvt_pk_bf16_f32 v24, v184, v185
    v_add_f32 v186, v186, v216
    v_add_f32 v187, v187, v216
    v_exp_f32 v186, v186
    v_exp_f32 v187, v187
    s_nop 0
    v_cvt_pk_bf16_f32 v25, v186, v187
    v_add_f32 v188, v188, v220
    v_add_f32 v189, v189, v220
    v_exp_f32 v188, v188
    v_exp_f32 v189, v189
    s_nop 0
    v_cvt_pk_bf16_f32 v28, v188, v189
    v_add_f32 v190, v190, v220
    v_add_f32 v191, v191, v220
    v_exp_f32 v190, v190
    v_exp_f32 v191, v191
    s_nop 0
    v_cvt_pk_bf16_f32 v29, v190, v191
    v_add_f32 v192, v192, v216
    v_add_f32 v193, v193, v216
    v_exp_f32 v192, v192
    v_exp_f32 v193, v193
    s_nop 0
    v_cvt_pk_bf16_f32 v26, v192, v193
    v_add_f32 v194, v194, v216
    v_add_f32 v195, v195, v216
    v_exp_f32 v194, v194
    v_exp_f32 v195, v195
    s_nop 0
    v_cvt_pk_bf16_f32 v27, v194, v195
    v_add_f32 v196, v196, v220
    v_add_f32 v197, v197, v220
    v_exp_f32 v196, v196
    v_exp_f32 v197, v197
    s_nop 0
    v_cvt_pk_bf16_f32 v30, v196, v197
    v_add_f32 v198, v198, v220
    v_add_f32 v199, v199, v220
    v_exp_f32 v198, v198
    v_exp_f32 v199, v199
    s_nop 0
    v_cvt_pk_bf16_f32 v31, v198, v199
    s_waitcnt lgkmcnt(3)
    v_mfma_f32_16x16x32_bf16 v[184:187], v[240:243], v[152:155], v[216:219]
    v_mfma_f32_16x16x32_bf16 v[188:191], v[240:243], v[168:171], v[220:223]
    ds_read_b128 v[232:235], v4 offset:53248
    v_add_f32 v200, v200, v216
    v_add_f32 v201, v201, v216
    v_exp_f32 v200, v200
    v_mfma_f32_16x16x32_bf16 v[248:251], v[12:15], v[24:27], 0
    s_waitcnt lgkmcnt(3)
    v_mfma_f32_16x16x32_bf16 v[192:195], v[244:247], v[152:155], v[216:219]
    v_exp_f32 v201, v201
    s_nop 0
    v_cvt_pk_bf16_f32 v32, v200, v201
    v_add_f32 v202, v202, v216
    v_mfma_f32_16x16x32_bf16 v[196:199], v[244:247], v[168:171], v[220:223]
    s_add_u32 s22, s21, 0x14400
    s_add_u32 m0, s20, 0x14400
    s_nop 0
    buffer_load_dwordx4 v2, s[8:11], s22 offen sc1 lds
    ds_read_b128 v[236:239], v4 offset:54272
    v_add_f32 v203, v203, v216
    v_exp_f32 v202, v202
    v_mfma_f32_16x16x32_bf16 v[252:255], v[12:15], v[28:31], 0
    s_waitcnt lgkmcnt(3)
    v_mfma_f32_16x16x32_bf16 v[184:187], v[224:227], v[156:159], v[184:187]
    v_exp_f32 v203, v203
    s_nop 0
    v_cvt_pk_bf16_f32 v33, v202, v203
    v_add_f32 v204, v204, v220
    s_add_u32 s22, s18, 0
    s_add_u32 m0, s15, 0
    s_nop 0
    buffer_load_dwordx4 v11, s[64:67], s22 offen lds
    v_mfma_f32_16x16x32_bf16 v[188:191], v[224:227], v[172:175], v[188:191]
    ds_read_b128 v[240:243], v4 offset:55296
    v_add_f32 v205, v205, v220
    v_exp_f32 v204, v204
    v_exp_f32 v205, v205
    s_mov_b64 s[4:5], s[40:41]
    s_mov_b32 s6, 0x800000
    s_mov_b32 s7, 0x20000
    v_bfe_u32 v20, v1, 2, 2
    v_lshlrev_b32 v21, 13, v20
    v_sub_u32 v3, v3, v21
    v_lshl_add_u32 v3, v20, 11, v3
    s_and_b32 s16, s2, 1
    s_lshl_b32 s24, s16, 22
    s_lshr_b32 s16, s2, 5
    s_lshl_b32 s16, s16, 8
    s_add_u32 s24, s24, s16
    s_lshl_b32 s16, s3, 14
    s_add_u32 s24, s24, s16
    s_add_u32 s24, s24, 196608
    s_waitcnt lgkmcnt(3)
    v_mfma_f32_16x16x32_bf16 v[192:195], v[228:231], v[156:159], v[192:195]
    v_cvt_pk_bf16_f32 v36, v204, v205
    v_add_f32 v206, v206, v220
    v_mfma_f32_16x16x32_bf16 v[196:199], v[228:231], v[172:175], v[196:199]
    ds_read_b128 v[244:247], v4 offset:56320
    v_add_f32 v207, v207, v220
    v_exp_f32 v206, v206
    v_exp_f32 v207, v207
    s_waitcnt lgkmcnt(3)
    v_mfma_f32_16x16x32_bf16 v[184:187], v[232:235], v[160:163], v[184:187]
    v_cvt_pk_bf16_f32 v37, v206, v207
    v_add_f32 v208, v208, v216
    v_add_f32 v209, v209, v216
    s_mov_b64 s[72:73], s[40:41]
    s_mov_b32 s74, 0x800000
    s_mov_b32 s75, 0x20000
    v_lshlrev_b32 v21, 7, v1
    s_lshl_b32 s16, s2, 2
    s_add_u32 s16, s16, s3
    s_sub_u32 s16, s16, 4
    s_lshl_b32 s16, s16, 13
    buffer_load_dword v7, v21, s[72:75], s16 offen
    v_mfma_f32_16x16x32_bf16 v[188:191], v[232:235], v[176:179], v[188:191]
    ds_read_b128 v[224:227], v4 offset:57344
    v_exp_f32 v208, v208
    v_exp_f32 v209, v209
    s_waitcnt lgkmcnt(3)
    v_mfma_f32_16x16x32_bf16 v[192:195], v[236:239], v[160:163], v[192:195]
    v_cvt_pk_bf16_f32 v34, v208, v209
    v_add_f32 v210, v210, v216
    v_add_f32 v211, v211, v216
    v_mfma_f32_16x16x32_bf16 v[196:199], v[236:239], v[176:179], v[196:199]
    ds_read_b128 v[228:231], v4 offset:58368
    v_exp_f32 v210, v210
    v_exp_f32 v211, v211
    s_nop 0
    v_cvt_pk_bf16_f32 v35, v210, v211
    s_waitcnt lgkmcnt(3)
    v_mfma_f32_16x16x32_bf16 v[184:187], v[240:243], v[164:167], v[184:187]
    v_add_f32 v212, v212, v220
    v_add_f32 v213, v213, v220
    v_mfma_f32_16x16x32_bf16 v[188:191], v[240:243], v[180:183], v[188:191]
    ds_read_b128 v[232:235], v4 offset:59392
    v_exp_f32 v212, v212
    v_exp_f32 v213, v213
    s_nop 0
    v_cvt_pk_bf16_f32 v38, v212, v213
    s_waitcnt lgkmcnt(3)
    v_mfma_f32_16x16x32_bf16 v[192:195], v[244:247], v[164:167], v[192:195]
    v_add_f32 v214, v214, v220
    v_add_f32 v215, v215, v220
    v_exp_f32 v214, v214
    v_mfma_f32_16x16x32_bf16 v[196:199], v[244:247], v[180:183], v[196:199]
    ds_read_b128 v[236:239], v4 offset:60416
    v_exp_f32 v215, v215
    s_nop 0
    v_cvt_pk_bf16_f32 v39, v214, v215
    s_waitcnt lgkmcnt(3)
    v_mfma_f32_16x16x32_bf16 v[200:203], v[224:227], v[152:155], v[216:219]
    v_mfma_f32_16x16x32_bf16 v[204:207], v[224:227], v[168:171], v[220:223]
    ds_read_b128 v[240:243], v4 offset:61440
    v_exp_f32 v184, v184
    v_exp_f32 v185, v185
    v_mfma_f32_16x16x32_bf16 v[248:251], v[12:15], v[32:35], v[248:251]
    s_waitcnt lgkmcnt(3)
    v_mfma_f32_16x16x32_bf16 v[208:211], v[228:231], v[152:155], v[216:219]
    v_cvt_pk_bf16_f32 v40, v184, v185
    v_exp_f32 v186, v186
    v_mfma_f32_16x16x32_bf16 v[212:215], v[228:231], v[168:171], v[220:223]
    ds_read_b128 v[244:247], v4 offset:62464
    v_exp_f32 v187, v187
    v_mfma_f32_16x16x32_bf16 v[252:255], v[12:15], v[36:39], v[252:255]
    s_waitcnt lgkmcnt(3)
    v_mfma_f32_16x16x32_bf16 v[200:203], v[232:235], v[156:159], v[200:203]
    v_cvt_pk_bf16_f32 v41, v186, v187
    v_exp_f32 v188, v188
    v_mfma_f32_16x16x32_bf16 v[204:207], v[232:235], v[172:175], v[204:207]
    ds_read_b128 v[224:227], v4 offset:63488
    v_exp_f32 v189, v189
    s_waitcnt lgkmcnt(3)
    v_mfma_f32_16x16x32_bf16 v[208:211], v[236:239], v[156:159], v[208:211]
    v_cvt_pk_bf16_f32 v44, v188, v189
    v_exp_f32 v190, v190
    v_mfma_f32_16x16x32_bf16 v[212:215], v[236:239], v[172:175], v[212:215]
    ds_read_b128 v[228:231], v4 offset:64512
    v_exp_f32 v191, v191
    s_nop 0
    v_cvt_pk_bf16_f32 v45, v190, v191
    s_waitcnt lgkmcnt(3)
    v_mfma_f32_16x16x32_bf16 v[200:203], v[240:243], v[160:163], v[200:203]
    v_exp_f32 v192, v192
    v_mfma_f32_16x16x32_bf16 v[204:207], v[240:243], v[176:179], v[204:207]
    s_waitcnt vmcnt(9)
    s_barrier
    ds_read_b128 v[232:235], v5 offset:0
    v_exp_f32 v193, v193
    s_nop 0
    v_cvt_pk_bf16_f32 v42, v192, v193
    s_waitcnt lgkmcnt(3)
    v_mfma_f32_16x16x32_bf16 v[208:211], v[244:247], v[160:163], v[208:211]
    v_exp_f32 v194, v194
    v_mfma_f32_16x16x32_bf16 v[212:215], v[244:247], v[176:179], v[212:215]
    s_add_u32 s22, s21, 0x18000
    s_add_u32 m0, s20, 0x18000
    s_nop 0
    buffer_load_dwordx4 v2, s[8:11], s22 offen sc1 lds
    ds_read_b128 v[236:239], v5 offset:1024
    v_exp_f32 v195, v195
    s_nop 0
    v_cvt_pk_bf16_f32 v43, v194, v195
    s_add_u32 s22, s18, 7168
    s_add_u32 m0, s15, 1024
    s_nop 0
    buffer_load_dwordx4 v11, s[64:67], s22 offen lds
    s_waitcnt lgkmcnt(3)
    v_mfma_f32_16x16x32_bf16 v[200:203], v[224:227], v[164:167], v[200:203]
    v_exp_f32 v196, v196
    v_exp_f32 v197, v197
    v_mfma_f32_16x16x32_bf16 v[204:207], v[224:227], v[180:183], v[204:207]
    ds_read_b128 v[240:243], v5 offset:2048
    v_cvt_pk_bf16_f32 v46, v196, v197
    s_waitcnt lgkmcnt(3)
    v_mfma_f32_16x16x32_bf16 v[208:211], v[228:231], v[164:167], v[208:211]
    v_exp_f32 v198, v198
    v_exp_f32 v199, v199
    v_mfma_f32_16x16x32_bf16 v[212:215], v[228:231], v[180:183], v[212:215]
    ds_read_b128 v[244:247], v5 offset:3072
    v_cvt_pk_bf16_f32 v47, v198, v199
    s_waitcnt lgkmcnt(3)
    v_mfma_f32_16x16x32_bf16 v[184:187], v[232:235], v[152:155], v[216:219]
    v_mfma_f32_16x16x32_bf16 v[188:191], v[232:235], v[168:171], v[220:223]
    ds_read_b128 v[224:227], v5 offset:4096
    v_exp_f32 v200, v200
    v_exp_f32 v201, v201
    v_mfma_f32_16x16x32_bf16 v[248:251], v[12:15], v[40:43], v[248:251]
    s_waitcnt lgkmcnt(3)
    v_mfma_f32_16x16x32_bf16 v[192:195], v[236:239], v[152:155], v[216:219]
    v_cvt_pk_bf16_f32 v48, v200, v201
    v_exp_f32 v202, v202
    v_mfma_f32_16x16x32_bf16 v[196:199], v[236:239], v[168:171], v[220:223]
    s_add_u32 s22, s21, 0x18400
    s_add_u32 m0, s20, 0x18400
    s_nop 0
    buffer_load_dwordx4 v2, s[8:11], s22 offen sc1 lds
    ds_read_b128 v[228:231], v5 offset:5120
    v_exp_f32 v203, v203
    v_mfma_f32_16x16x32_bf16 v[252:255], v[12:15], v[44:47], v[252:255]
    s_waitcnt lgkmcnt(3)
    v_mfma_f32_16x16x32_bf16 v[184:187], v[240:243], v[156:159], v[184:187]
    v_cvt_pk_bf16_f32 v49, v202, v203
    v_exp_f32 v204, v204
    v_mfma_f32_16x16x32_bf16 v[188:191], v[240:243], v[172:175], v[188:191]
    ds_read_b128 v[232:235], v5 offset:6144
    v_exp_f32 v205, v205
    s_waitcnt lgkmcnt(3)
    v_mfma_f32_16x16x32_bf16 v[192:195], v[244:247], v[156:159], v[192:195]
    v_cvt_pk_bf16_f32 v52, v204, v205
    v_exp_f32 v206, v206
    v_mfma_f32_16x16x32_bf16 v[196:199], v[244:247], v[172:175], v[196:199]
    ds_read_b128 v[236:239], v5 offset:7168
    v_exp_f32 v207, v207
    s_nop 0
    v_cvt_pk_bf16_f32 v53, v206, v207
    s_waitcnt lgkmcnt(3)
    v_mfma_f32_16x16x32_bf16 v[184:187], v[224:227], v[160:163], v[184:187]
    v_exp_f32 v208, v208
    v_mfma_f32_16x16x32_bf16 v[188:191], v[224:227], v[176:179], v[188:191]
    ds_read_b128 v[240:243], v5 offset:8192
    v_exp_f32 v209, v209
    s_nop 0
    v_cvt_pk_bf16_f32 v50, v208, v209
    s_waitcnt lgkmcnt(3)
    v_mfma_f32_16x16x32_bf16 v[192:195], v[228:231], v[160:163], v[192:195]
    v_exp_f32 v210, v210
    v_mfma_f32_16x16x32_bf16 v[196:199], v[228:231], v[176:179], v[196:199]
    ds_read_b128 v[244:247], v5 offset:9216
    v_exp_f32 v211, v211
    s_nop 0
    v_cvt_pk_bf16_f32 v51, v210, v211
    s_waitcnt lgkmcnt(3)
    v_mfma_f32_16x16x32_bf16 v[184:187], v[232:235], v[164:167], v[184:187]
    v_exp_f32 v212, v212
    v_exp_f32 v213, v213
    v_mfma_f32_16x16x32_bf16 v[188:191], v[232:235], v[180:183], v[188:191]
    ds_read_b128 v[224:227], v5 offset:10240
    v_cvt_pk_bf16_f32 v54, v212, v213
    s_waitcnt lgkmcnt(3)
    v_mfma_f32_16x16x32_bf16 v[192:195], v[236:239], v[164:167], v[192:195]
    v_exp_f32 v214, v214
    v_exp_f32 v215, v215
    v_mfma_f32_16x16x32_bf16 v[196:199], v[236:239], v[180:183], v[196:199]
    ds_read_b128 v[228:231], v5 offset:11264
    v_cvt_pk_bf16_f32 v55, v214, v215
    s_waitcnt lgkmcnt(3)
    v_mfma_f32_16x16x32_bf16 v[200:203], v[240:243], v[152:155], v[216:219]
    v_mfma_f32_16x16x32_bf16 v[204:207], v[240:243], v[168:171], v[220:223]
    ds_read_b128 v[232:235], v5 offset:12288
    v_exp_f32 v184, v184
    v_exp_f32 v185, v185
    v_mfma_f32_16x16x32_bf16 v[248:251], v[12:15], v[48:51], v[248:251]
    s_waitcnt lgkmcnt(3)
    v_mfma_f32_16x16x32_bf16 v[208:211], v[244:247], v[152:155], v[216:219]
    v_cvt_pk_bf16_f32 v56, v184, v185
    v_exp_f32 v186, v186
    v_mfma_f32_16x16x32_bf16 v[212:215], v[244:247], v[168:171], v[220:223]
    ds_read_b128 v[236:239], v5 offset:13312
    v_exp_f32 v187, v187
    s_add_u32 s22, s18, 14336
    s_add_u32 m0, s15, 2048
    s_nop 0
    buffer_load_dwordx4 v11, s[64:67], s22 offen lds
    v_mfma_f32_16x16x32_bf16 v[252:255], v[12:15], v[52:55], v[252:255]
    s_waitcnt lgkmcnt(3)
    v_mfma_f32_16x16x32_bf16 v[200:203], v[224:227], v[156:159], v[200:203]
    v_cvt_pk_bf16_f32 v57, v186, v187
    v_exp_f32 v188, v188
    v_mfma_f32_16x16x32_bf16 v[204:207], v[224:227], v[172:175], v[204:207]
    ds_read_b128 v[240:243], v5 offset:14336
    v_exp_f32 v189, v189
    s_waitcnt lgkmcnt(3)
    v_mfma_f32_16x16x32_bf16 v[208:211], v[228:231], v[156:159], v[208:211]
    v_cvt_pk_bf16_f32 v60, v188, v189
    v_exp_f32 v190, v190
    s_waitcnt vmcnt(10)
    v_mfma_f32_16x16x32_bf16 v[212:215], v[228:231], v[172:175], v[212:215]
    ds_read_b128 v[244:247], v5 offset:15360
    v_exp_f32 v191, v191
    s_nop 0
    v_cvt_pk_bf16_f32 v61, v190, v191
    s_waitcnt lgkmcnt(3)
    v_mfma_f32_16x16x32_bf16 v[200:203], v[232:235], v[160:163], v[200:203]
    v_exp_f32 v192, v192
    v_mfma_f32_16x16x32_bf16 v[204:207], v[232:235], v[176:179], v[204:207]
    s_barrier
    ds_read_b128 v[224:227], v5 offset:16384
    v_exp_f32 v193, v193
    s_nop 0
    v_cvt_pk_bf16_f32 v58, v192, v193
    s_waitcnt lgkmcnt(3)
    v_mfma_f32_16x16x32_bf16 v[208:211], v[236:239], v[160:163], v[208:211]
    v_exp_f32 v194, v194
    v_mfma_f32_16x16x32_bf16 v[212:215], v[236:239], v[176:179], v[212:215]
    s_add_u32 s22, s21, 0x1c000
    s_add_u32 m0, s20, 0x1c000
    s_nop 0
    buffer_load_dwordx4 v2, s[8:11], s22 offen sc1 lds
    ds_read_b128 v[228:231], v5 offset:17408
    v_exp_f32 v195, v195
    s_nop 0
    v_cvt_pk_bf16_f32 v59, v194, v195
    s_waitcnt lgkmcnt(3)
    v_mfma_f32_16x16x32_bf16 v[200:203], v[240:243], v[164:167], v[200:203]
    v_exp_f32 v196, v196
    v_exp_f32 v197, v197
    v_mfma_f32_16x16x32_bf16 v[204:207], v[240:243], v[180:183], v[204:207]
    ds_read_b128 v[232:235], v5 offset:18432
    v_cvt_pk_bf16_f32 v62, v196, v197
    s_waitcnt lgkmcnt(3)
    v_mfma_f32_16x16x32_bf16 v[208:211], v[244:247], v[164:167], v[208:211]
    v_exp_f32 v198, v198
    v_exp_f32 v199, v199
    v_mfma_f32_16x16x32_bf16 v[212:215], v[244:247], v[180:183], v[212:215]
    ds_read_b128 v[236:239], v5 offset:19456
    v_cvt_pk_bf16_f32 v63, v198, v199
    s_waitcnt lgkmcnt(3)
    v_mfma_f32_16x16x32_bf16 v[184:187], v[224:227], v[152:155], v[216:219]
    v_mfma_f32_16x16x32_bf16 v[188:191], v[224:227], v[168:171], v[220:223]
    ds_read_b128 v[240:243], v5 offset:20480
    v_exp_f32 v200, v200
    v_exp_f32 v201, v201
    v_mfma_f32_16x16x32_bf16 v[248:251], v[12:15], v[56:59], v[248:251]
    s_waitcnt lgkmcnt(3)
    v_mfma_f32_16x16x32_bf16 v[192:195], v[228:231], v[152:155], v[216:219]
    v_cvt_pk_bf16_f32 v64, v200, v201
    v_exp_f32 v202, v202
    v_mfma_f32_16x16x32_bf16 v[196:199], v[228:231], v[168:171], v[220:223]
    s_add_u32 s22, s21, 0x1c400
    s_add_u32 m0, s20, 0x1c400
    s_nop 0
    buffer_load_dwordx4 v2, s[8:11], s22 offen sc1 lds
    ds_read_b128 v[244:247], v5 offset:21504
    v_exp_f32 v203, v203
    v_mfma_f32_16x16x32_bf16 v[252:255], v[12:15], v[60:63], v[252:255]
    s_waitcnt lgkmcnt(3)
    v_mfma_f32_16x16x32_bf16 v[184:187], v[232:235], v[156:159], v[184:187]
    v_cvt_pk_bf16_f32 v65, v202, v203
    v_exp_f32 v204, v204
    v_mfma_f32_16x16x32_bf16 v[188:191], v[232:235], v[172:175], v[188:191]
    ds_read_b128 v[224:227], v5 offset:22528
    v_exp_f32 v205, v205
    s_waitcnt lgkmcnt(3)
    v_mfma_f32_16x16x32_bf16 v[192:195], v[236:239], v[156:159], v[192:195]
    v_cvt_pk_bf16_f32 v68, v204, v205
    v_exp_f32 v206, v206
    v_mfma_f32_16x16x32_bf16 v[196:199], v[236:239], v[172:175], v[196:199]
    ds_read_b128 v[228:231], v5 offset:23552
    v_exp_f32 v207, v207
    s_nop 0
    v_cvt_pk_bf16_f32 v69, v206, v207
    s_waitcnt lgkmcnt(3)
    v_mfma_f32_16x16x32_bf16 v[184:187], v[240:243], v[160:163], v[184:187]
    v_exp_f32 v208, v208
    v_mfma_f32_16x16x32_bf16 v[188:191], v[240:243], v[176:179], v[188:191]
    ds_read_b128 v[232:235], v5 offset:24576
    v_exp_f32 v209, v209
    s_nop 0
    v_cvt_pk_bf16_f32 v66, v208, v209
    s_waitcnt lgkmcnt(3)
    v_mfma_f32_16x16x32_bf16 v[192:195], v[244:247], v[160:163], v[192:195]
    v_exp_f32 v210, v210
    s_add_u32 s22, s18, 21504
    s_add_u32 m0, s15, 3072
    s_nop 0
    buffer_load_dwordx4 v11, s[64:67], s22 offen lds
    v_mfma_f32_16x16x32_bf16 v[196:199], v[244:247], v[176:179], v[196:199]
    ds_read_b128 v[236:239], v5 offset:25600
    v_exp_f32 v211, v211
    s_nop 0
    v_cvt_pk_bf16_f32 v67, v210, v211
    s_waitcnt lgkmcnt(3)
    v_mfma_f32_16x16x32_bf16 v[184:187], v[224:227], v[164:167], v[184:187]
    v_exp_f32 v212, v212
    v_exp_f32 v213, v213
    v_mfma_f32_16x16x32_bf16 v[188:191], v[224:227], v[180:183], v[188:191]
    ds_read_b128 v[240:243], v5 offset:26624
    v_cvt_pk_bf16_f32 v70, v212, v213
    s_waitcnt lgkmcnt(3)
    v_mfma_f32_16x16x32_bf16 v[192:195], v[228:231], v[164:167], v[192:195]
    v_exp_f32 v214, v214
    v_exp_f32 v215, v215
    v_mfma_f32_16x16x32_bf16 v[196:199], v[228:231], v[180:183], v[196:199]
    ds_read_b128 v[244:247], v5 offset:27648
    v_cvt_pk_bf16_f32 v71, v214, v215
    s_waitcnt lgkmcnt(3)
    v_mfma_f32_16x16x32_bf16 v[200:203], v[232:235], v[152:155], v[216:219]
    v_mfma_f32_16x16x32_bf16 v[204:207], v[232:235], v[168:171], v[220:223]
    ds_read_b128 v[224:227], v5 offset:28672
    v_exp_f32 v184, v184
    v_exp_f32 v185, v185
    v_mfma_f32_16x16x32_bf16 v[248:251], v[12:15], v[64:67], v[248:251]
    s_waitcnt lgkmcnt(3)
    v_mfma_f32_16x16x32_bf16 v[208:211], v[236:239], v[152:155], v[216:219]
    v_cvt_pk_bf16_f32 v72, v184, v185
    v_exp_f32 v186, v186
    v_mfma_f32_16x16x32_bf16 v[212:215], v[236:239], v[168:171], v[220:223]
    ds_read_b128 v[228:231], v5 offset:29696
    v_exp_f32 v187, v187
    v_mfma_f32_16x16x32_bf16 v[252:255], v[12:15], v[68:71], v[252:255]
    s_waitcnt lgkmcnt(3)
    v_mfma_f32_16x16x32_bf16 v[200:203], v[240:243], v[156:159], v[200:203]
    v_cvt_pk_bf16_f32 v73, v186, v187
    v_exp_f32 v188, v188
    v_mfma_f32_16x16x32_bf16 v[204:207], v[240:243], v[172:175], v[204:207]
    ds_read_b128 v[232:235], v5 offset:30720
    v_exp_f32 v189, v189
    s_waitcnt lgkmcnt(3)
    v_mfma_f32_16x16x32_bf16 v[208:211], v[244:247], v[156:159], v[208:211]
    v_cvt_pk_bf16_f32 v76, v188, v189
    v_exp_f32 v190, v190
    v_mfma_f32_16x16x32_bf16 v[212:215], v[244:247], v[172:175], v[212:215]
    ds_read_b128 v[236:239], v5 offset:31744
    v_exp_f32 v191, v191
    s_nop 0
    v_cvt_pk_bf16_f32 v77, v190, v191
    s_waitcnt lgkmcnt(3)
    v_mfma_f32_16x16x32_bf16 v[200:203], v[224:227], v[160:163], v[200:203]
    v_exp_f32 v192, v192
    v_mfma_f32_16x16x32_bf16 v[204:207], v[224:227], v[176:179], v[204:207]
    s_waitcnt vmcnt(11)
    s_barrier
    ds_read_b128 v[240:243], v4 offset:0
    v_exp_f32 v193, v193
    s_nop 0
    v_cvt_pk_bf16_f32 v74, v192, v193
    s_waitcnt lgkmcnt(3)
    v_mfma_f32_16x16x32_bf16 v[208:211], v[228:231], v[160:163], v[208:211]
    v_exp_f32 v194, v194
    v_mfma_f32_16x16x32_bf16 v[212:215], v[228:231], v[176:179], v[212:215]
    s_add_u32 s22, s21, 0x80000
    s_add_u32 m0, s20, 0x20000
    s_nop 0
    buffer_load_dwordx4 v2, s[8:11], s22 offen sc1 lds
    ds_read_b128 v[244:247], v4 offset:1024
    v_exp_f32 v195, v195
    s_nop 0
    v_cvt_pk_bf16_f32 v75, v194, v195
    s_waitcnt lgkmcnt(3)
    v_mfma_f32_16x16x32_bf16 v[200:203], v[232:235], v[164:167], v[200:203]
    v_exp_f32 v196, v196
    v_exp_f32 v197, v197
    v_mfma_f32_16x16x32_bf16 v[204:207], v[232:235], v[180:183], v[204:207]
    ds_read_b128 v[224:227], v4 offset:2048
    v_cvt_pk_bf16_f32 v78, v196, v197
    s_waitcnt lgkmcnt(3)
    v_mfma_f32_16x16x32_bf16 v[208:211], v[236:239], v[164:167], v[208:211]
    v_exp_f32 v198, v198
    v_exp_f32 v199, v199
    v_mfma_f32_16x16x32_bf16 v[212:215], v[236:239], v[180:183], v[212:215]
    ds_read_b128 v[228:231], v4 offset:3072
    v_cvt_pk_bf16_f32 v79, v198, v199
    s_waitcnt lgkmcnt(3)
    v_mfma_f32_16x16x32_bf16 v[184:187], v[240:243], v[152:155], v[216:219]
    v_mfma_f32_16x16x32_bf16 v[188:191], v[240:243], v[168:171], v[220:223]
    ds_read_b128 v[232:235], v4 offset:4096
    v_exp_f32 v200, v200
    v_exp_f32 v201, v201
    v_mfma_f32_16x16x32_bf16 v[248:251], v[12:15], v[72:75], v[248:251]
    s_waitcnt lgkmcnt(3)
    v_mfma_f32_16x16x32_bf16 v[192:195], v[244:247], v[152:155], v[216:219]
    v_cvt_pk_bf16_f32 v80, v200, v201
    v_exp_f32 v202, v202
    s_add_u32 s22, s18, 28672
    s_add_u32 m0, s15, 4096
    s_nop 0
    buffer_load_dwordx4 v11, s[64:67], s22 offen lds
    v_mfma_f32_16x16x32_bf16 v[196:199], v[244:247], v[168:171], v[220:223]
    s_add_u32 s22, s21, 0x80400
    s_add_u32 m0, s20, 0x20400
    s_nop 0
    buffer_load_dwordx4 v2, s[8:11], s22 offen sc1 lds
    ds_read_b128 v[236:239], v4 offset:5120
    v_exp_f32 v203, v203
    v_mfma_f32_16x16x32_bf16 v[252:255], v[12:15], v[76:79], v[252:255]
    s_waitcnt lgkmcnt(3)
    v_mfma_f32_16x16x32_bf16 v[184:187], v[224:227], v[156:159], v[184:187]
    v_cvt_pk_bf16_f32 v81, v202, v203
    v_exp_f32 v204, v204
    v_mfma_f32_16x16x32_bf16 v[188:191], v[224:227], v[172:175], v[188:191]
    ds_read_b128 v[240:243], v4 offset:6144
    v_exp_f32 v205, v205
    s_waitcnt lgkmcnt(3)
    v_mfma_f32_16x16x32_bf16 v[192:195], v[228:231], v[156:159], v[192:195]
    v_cvt_pk_bf16_f32 v84, v204, v205
    v_exp_f32 v206, v206
    v_mfma_f32_16x16x32_bf16 v[196:199], v[228:231], v[172:175], v[196:199]
    ds_read_b128 v[244:247], v4 offset:7168
    v_exp_f32 v207, v207
    s_nop 0
    v_cvt_pk_bf16_f32 v85, v206, v207
    s_waitcnt lgkmcnt(3)
    v_mfma_f32_16x16x32_bf16 v[184:187], v[232:235], v[160:163], v[184:187]
    v_exp_f32 v208, v208
    v_mfma_f32_16x16x32_bf16 v[188:191], v[232:235], v[176:179], v[188:191]
    ds_read_b128 v[224:227], v4 offset:8192
    v_exp_f32 v209, v209
    s_nop 0
    v_cvt_pk_bf16_f32 v82, v208, v209
    s_waitcnt lgkmcnt(3)
    v_mfma_f32_16x16x32_bf16 v[192:195], v[236:239], v[160:163], v[192:195]
    v_exp_f32 v210, v210
    v_mfma_f32_16x16x32_bf16 v[196:199], v[236:239], v[176:179], v[196:199]
    ds_read_b128 v[228:231], v4 offset:9216
    v_exp_f32 v211, v211
    s_nop 0
    v_cvt_pk_bf16_f32 v83, v210, v211
    s_waitcnt lgkmcnt(3)
    v_mfma_f32_16x16x32_bf16 v[184:187], v[240:243], v[164:167], v[184:187]
    v_exp_f32 v212, v212
    v_exp_f32 v213, v213
    v_mfma_f32_16x16x32_bf16 v[188:191], v[240:243], v[180:183], v[188:191]
    ds_read_b128 v[232:235], v4 offset:10240
    v_cvt_pk_bf16_f32 v86, v212, v213
    s_waitcnt lgkmcnt(3)
    v_mfma_f32_16x16x32_bf16 v[192:195], v[244:247], v[164:167], v[192:195]
    v_exp_f32 v214, v214
    v_exp_f32 v215, v215
    v_mfma_f32_16x16x32_bf16 v[196:199], v[244:247], v[180:183], v[196:199]
    ds_read_b128 v[236:239], v4 offset:11264
    v_cvt_pk_bf16_f32 v87, v214, v215
    s_waitcnt lgkmcnt(3)
    v_mfma_f32_16x16x32_bf16 v[200:203], v[224:227], v[152:155], v[216:219]
    v_mfma_f32_16x16x32_bf16 v[204:207], v[224:227], v[168:171], v[220:223]
    ds_read_b128 v[240:243], v4 offset:12288
    v_exp_f32 v184, v184
    v_exp_f32 v185, v185
    v_mfma_f32_16x16x32_bf16 v[248:251], v[12:15], v[80:83], v[248:251]
    s_waitcnt lgkmcnt(3)
    v_mfma_f32_16x16x32_bf16 v[208:211], v[228:231], v[152:155], v[216:219]
    v_cvt_pk_bf16_f32 v88, v184, v185
    v_exp_f32 v186, v186
    v_mfma_f32_16x16x32_bf16 v[212:215], v[228:231], v[168:171], v[220:223]
    ds_read_b128 v[244:247], v4 offset:13312
    v_exp_f32 v187, v187
    v_mfma_f32_16x16x32_bf16 v[252:255], v[12:15], v[84:87], v[252:255]
    s_waitcnt lgkmcnt(3)
    v_mfma_f32_16x16x32_bf16 v[200:203], v[232:235], v[156:159], v[200:203]
    v_cvt_pk_bf16_f32 v89, v186, v187
    v_exp_f32 v188, v188
    v_mfma_f32_16x16x32_bf16 v[204:207], v[232:235], v[172:175], v[204:207]
    ds_read_b128 v[224:227], v4 offset:14336
    v_exp_f32 v189, v189
    s_waitcnt lgkmcnt(3)
    v_mfma_f32_16x16x32_bf16 v[208:211], v[236:239], v[156:159], v[208:211]
    v_cvt_pk_bf16_f32 v92, v188, v189
    v_exp_f32 v190, v190
    v_mfma_f32_16x16x32_bf16 v[212:215], v[236:239], v[172:175], v[212:215]
    ds_read_b128 v[228:231], v4 offset:15360
    v_exp_f32 v191, v191
    s_nop 0
    v_cvt_pk_bf16_f32 v93, v190, v191
    s_waitcnt lgkmcnt(3)
    v_mfma_f32_16x16x32_bf16 v[200:203], v[240:243], v[160:163], v[200:203]
    v_exp_f32 v192, v192
    v_mfma_f32_16x16x32_bf16 v[204:207], v[240:243], v[176:179], v[204:207]
    s_waitcnt vmcnt(12)
    s_barrier
    ds_read_b128 v[232:235], v4 offset:16384
    v_exp_f32 v193, v193
    s_nop 0
    v_cvt_pk_bf16_f32 v90, v192, v193
    s_add_u32 s22, s18, 35840
    s_add_u32 m0, s15, 5120
    s_nop 0
    buffer_load_dwordx4 v11, s[64:67], s22 offen lds
    s_waitcnt lgkmcnt(3)
    v_mfma_f32_16x16x32_bf16 v[208:211], v[244:247], v[160:163], v[208:211]
    v_exp_f32 v194, v194
    v_mfma_f32_16x16x32_bf16 v[212:215], v[244:247], v[176:179], v[212:215]
    s_add_u32 s22, s21, 0x84000
    s_add_u32 m0, s20, 0x24000
    s_nop 0
    buffer_load_dwordx4 v2, s[8:11], s22 offen sc1 lds
    ds_read_b128 v[236:239], v4 offset:17408
    v_exp_f32 v195, v195
    s_nop 0
    v_cvt_pk_bf16_f32 v91, v194, v195
    s_waitcnt lgkmcnt(3)
    v_mfma_f32_16x16x32_bf16 v[200:203], v[224:227], v[164:167], v[200:203]
    v_exp_f32 v196, v196
    v_exp_f32 v197, v197
    v_mfma_f32_16x16x32_bf16 v[204:207], v[224:227], v[180:183], v[204:207]
    ds_read_b128 v[240:243], v4 offset:18432
    v_cvt_pk_bf16_f32 v94, v196, v197
    s_waitcnt lgkmcnt(3)
    v_mfma_f32_16x16x32_bf16 v[208:211], v[228:231], v[164:167], v[208:211]
    v_exp_f32 v198, v198
    v_exp_f32 v199, v199
    v_mfma_f32_16x16x32_bf16 v[212:215], v[228:231], v[180:183], v[212:215]
    ds_read_b128 v[244:247], v4 offset:19456
    v_cvt_pk_bf16_f32 v95, v198, v199
    s_waitcnt lgkmcnt(3)
    v_mfma_f32_16x16x32_bf16 v[184:187], v[232:235], v[152:155], v[216:219]
    v_mfma_f32_16x16x32_bf16 v[188:191], v[232:235], v[168:171], v[220:223]
    ds_read_b128 v[224:227], v4 offset:20480
    v_exp_f32 v200, v200
    v_exp_f32 v201, v201
    v_mfma_f32_16x16x32_bf16 v[248:251], v[12:15], v[88:91], v[248:251]
    s_waitcnt lgkmcnt(3)
    v_mfma_f32_16x16x32_bf16 v[192:195], v[236:239], v[152:155], v[216:219]
    v_cvt_pk_bf16_f32 v96, v200, v201
    v_exp_f32 v202, v202
    v_mfma_f32_16x16x32_bf16 v[196:199], v[236:239], v[168:171], v[220:223]
    s_add_u32 s22, s21, 0x84400
    s_add_u32 m0, s20, 0x24400
    s_nop 0
    buffer_load_dwordx4 v2, s[8:11], s22 offen sc1 lds
    ds_read_b128 v[228:231], v4 offset:21504
    v_exp_f32 v203, v203
    v_mfma_f32_16x16x32_bf16 v[252:255], v[12:15], v[92:95], v[252:255]
    s_waitcnt lgkmcnt(3)
    v_mfma_f32_16x16x32_bf16 v[184:187], v[240:243], v[156:159], v[184:187]
    v_cvt_pk_bf16_f32 v97, v202, v203
    v_exp_f32 v204, v204
    v_mfma_f32_16x16x32_bf16 v[188:191], v[240:243], v[172:175], v[188:191]
    ds_read_b128 v[232:235], v4 offset:22528
    v_exp_f32 v205, v205
    s_waitcnt lgkmcnt(3)
    v_mfma_f32_16x16x32_bf16 v[192:195], v[244:247], v[156:159], v[192:195]
    v_cvt_pk_bf16_f32 v100, v204, v205
    v_exp_f32 v206, v206
    v_mfma_f32_16x16x32_bf16 v[196:199], v[244:247], v[172:175], v[196:199]
    ds_read_b128 v[236:239], v4 offset:23552
    v_exp_f32 v207, v207
    s_nop 0
    v_cvt_pk_bf16_f32 v101, v206, v207
    s_waitcnt lgkmcnt(3)
    v_mfma_f32_16x16x32_bf16 v[184:187], v[224:227], v[160:163], v[184:187]
    v_exp_f32 v208, v208
    v_mfma_f32_16x16x32_bf16 v[188:191], v[224:227], v[176:179], v[188:191]
    ds_read_b128 v[240:243], v4 offset:24576
    v_exp_f32 v209, v209
    s_nop 0
    v_cvt_pk_bf16_f32 v98, v208, v209
    s_waitcnt lgkmcnt(3)
    v_mfma_f32_16x16x32_bf16 v[192:195], v[228:231], v[160:163], v[192:195]
    v_exp_f32 v210, v210
    v_mfma_f32_16x16x32_bf16 v[196:199], v[228:231], v[176:179], v[196:199]
    ds_read_b128 v[244:247], v4 offset:25600
    v_exp_f32 v211, v211
    s_nop 0
    v_cvt_pk_bf16_f32 v99, v210, v211
    s_waitcnt lgkmcnt(3)
    v_mfma_f32_16x16x32_bf16 v[184:187], v[232:235], v[164:167], v[184:187]
    v_exp_f32 v212, v212
    v_exp_f32 v213, v213
    v_mfma_f32_16x16x32_bf16 v[188:191], v[232:235], v[180:183], v[188:191]
    ds_read_b128 v[224:227], v4 offset:26624
    v_cvt_pk_bf16_f32 v102, v212, v213
    s_waitcnt lgkmcnt(3)
    v_mfma_f32_16x16x32_bf16 v[192:195], v[236:239], v[164:167], v[192:195]
    v_exp_f32 v214, v214
    v_exp_f32 v215, v215
    v_mfma_f32_16x16x32_bf16 v[196:199], v[236:239], v[180:183], v[196:199]
    ds_read_b128 v[228:231], v4 offset:27648
    v_cvt_pk_bf16_f32 v103, v214, v215
    s_waitcnt lgkmcnt(3)
    v_mfma_f32_16x16x32_bf16 v[200:203], v[240:243], v[152:155], v[216:219]
    v_mfma_f32_16x16x32_bf16 v[204:207], v[240:243], v[168:171], v[220:223]
    ds_read_b128 v[232:235], v4 offset:28672
    v_exp_f32 v184, v184
    v_exp_f32 v185, v185
    s_add_u32 s22, s18, 43008
    s_add_u32 m0, s15, 6144
    s_nop 0
    buffer_load_dwordx4 v11, s[64:67], s22 offen lds
    v_mfma_f32_16x16x32_bf16 v[248:251], v[12:15], v[96:99], v[248:251]
    s_waitcnt lgkmcnt(3)
    v_mfma_f32_16x16x32_bf16 v[208:211], v[244:247], v[152:155], v[216:219]
    v_cvt_pk_bf16_f32 v104, v184, v185
    v_exp_f32 v186, v186
    v_mfma_f32_16x16x32_bf16 v[212:215], v[244:247], v[168:171], v[220:223]
    ds_read_b128 v[236:239], v4 offset:29696
    v_exp_f32 v187, v187
    v_mfma_f32_16x16x32_bf16 v[252:255], v[12:15], v[100:103], v[252:255]
    s_waitcnt lgkmcnt(3)
    v_mfma_f32_16x16x32_bf16 v[200:203], v[224:227], v[156:159], v[200:203]
    v_cvt_pk_bf16_f32 v105, v186, v187
    v_exp_f32 v188, v188
    v_mfma_f32_16x16x32_bf16 v[204:207], v[224:227], v[172:175], v[204:207]
    ds_read_b128 v[240:243], v4 offset:30720
    v_exp_f32 v189, v189
    s_waitcnt lgkmcnt(3)
    v_mfma_f32_16x16x32_bf16 v[208:211], v[228:231], v[156:159], v[208:211]
    v_cvt_pk_bf16_f32 v108, v188, v189
    v_exp_f32 v190, v190
    v_mfma_f32_16x16x32_bf16 v[212:215], v[228:231], v[172:175], v[212:215]
    ds_read_b128 v[244:247], v4 offset:31744
    v_exp_f32 v191, v191
    s_nop 0
    v_cvt_pk_bf16_f32 v109, v190, v191
    s_waitcnt lgkmcnt(3)
    v_mfma_f32_16x16x32_bf16 v[200:203], v[232:235], v[160:163], v[200:203]
    v_exp_f32 v192, v192
    v_mfma_f32_16x16x32_bf16 v[204:207], v[232:235], v[176:179], v[204:207]
    s_waitcnt vmcnt(11)
    s_barrier
    ds_read_b128 v[224:227], v4 offset:32768
    v_exp_f32 v193, v193
    s_nop 0
    v_cvt_pk_bf16_f32 v106, v192, v193
    s_waitcnt lgkmcnt(3)
    v_mfma_f32_16x16x32_bf16 v[208:211], v[236:239], v[160:163], v[208:211]
    v_exp_f32 v194, v194
    v_mfma_f32_16x16x32_bf16 v[212:215], v[236:239], v[176:179], v[212:215]
    s_add_u32 s22, s21, 0x88000
    s_add_u32 m0, s20, 0x10000
    s_nop 0
    buffer_load_dwordx4 v2, s[8:11], s22 offen sc1 lds
    ds_read_b128 v[228:231], v4 offset:33792
    v_exp_f32 v195, v195
    s_nop 0
    v_cvt_pk_bf16_f32 v107, v194, v195
    s_waitcnt lgkmcnt(3)
    v_mfma_f32_16x16x32_bf16 v[200:203], v[240:243], v[164:167], v[200:203]
    v_exp_f32 v196, v196
    v_exp_f32 v197, v197
    v_mfma_f32_16x16x32_bf16 v[204:207], v[240:243], v[180:183], v[204:207]
    ds_read_b128 v[232:235], v4 offset:34816
    v_cvt_pk_bf16_f32 v110, v196, v197
    s_waitcnt lgkmcnt(3)
    v_mfma_f32_16x16x32_bf16 v[208:211], v[244:247], v[164:167], v[208:211]
    v_exp_f32 v198, v198
    v_exp_f32 v199, v199
    v_mfma_f32_16x16x32_bf16 v[212:215], v[244:247], v[180:183], v[212:215]
    ds_read_b128 v[236:239], v4 offset:35840
    v_cvt_pk_bf16_f32 v111, v198, v199
    s_waitcnt lgkmcnt(3)
    v_mfma_f32_16x16x32_bf16 v[184:187], v[224:227], v[152:155], v[216:219]
    v_mfma_f32_16x16x32_bf16 v[188:191], v[224:227], v[168:171], v[220:223]
    ds_read_b128 v[240:243], v4 offset:36864
    v_exp_f32 v200, v200
    v_exp_f32 v201, v201
    v_mfma_f32_16x16x32_bf16 v[248:251], v[12:15], v[104:107], v[248:251]
    s_waitcnt lgkmcnt(3)
    v_mfma_f32_16x16x32_bf16 v[192:195], v[228:231], v[152:155], v[216:219]
    v_cvt_pk_bf16_f32 v112, v200, v201
    v_exp_f32 v202, v202
    v_mfma_f32_16x16x32_bf16 v[196:199], v[228:231], v[168:171], v[220:223]
    s_add_u32 s22, s21, 0x88400
    s_add_u32 m0, s20, 0x10400
    s_nop 0
    buffer_load_dwordx4 v2, s[8:11], s22 offen sc1 lds
    ds_read_b128 v[244:247], v4 offset:37888
    v_exp_f32 v203, v203
    v_mfma_f32_16x16x32_bf16 v[252:255], v[12:15], v[108:111], v[252:255]
    s_waitcnt lgkmcnt(3)
    v_mfma_f32_16x16x32_bf16 v[184:187], v[232:235], v[156:159], v[184:187]
    v_cvt_pk_bf16_f32 v113, v202, v203
    v_exp_f32 v204, v204
    v_mfma_f32_16x16x32_bf16 v[188:191], v[232:235], v[172:175], v[188:191]
    ds_read_b128 v[224:227], v4 offset:38912
    v_exp_f32 v205, v205
    s_waitcnt lgkmcnt(3)
    v_mfma_f32_16x16x32_bf16 v[192:195], v[236:239], v[156:159], v[192:195]
    v_cvt_pk_bf16_f32 v116, v204, v205
    v_exp_f32 v206, v206
    v_mfma_f32_16x16x32_bf16 v[196:199], v[236:239], v[172:175], v[196:199]
    ds_read_b128 v[228:231], v4 offset:39936
    v_exp_f32 v207, v207
    s_nop 0
    v_cvt_pk_bf16_f32 v117, v206, v207
    s_waitcnt lgkmcnt(3)
    v_mfma_f32_16x16x32_bf16 v[184:187], v[240:243], v[160:163], v[184:187]
    v_exp_f32 v208, v208
    s_add_u32 s22, s18, 50176
    s_add_u32 m0, s15, 7168
    s_nop 0
    buffer_load_dwordx4 v11, s[64:67], s22 offen lds
    v_mfma_f32_16x16x32_bf16 v[188:191], v[240:243], v[176:179], v[188:191]
    ds_read_b128 v[232:235], v4 offset:40960
    v_exp_f32 v209, v209
    s_nop 0
    v_cvt_pk_bf16_f32 v114, v208, v209
    s_waitcnt lgkmcnt(3)
    v_mfma_f32_16x16x32_bf16 v[192:195], v[244:247], v[160:163], v[192:195]
    v_exp_f32 v210, v210
    v_mfma_f32_16x16x32_bf16 v[196:199], v[244:247], v[176:179], v[196:199]
    ds_read_b128 v[236:239], v4 offset:41984
    v_exp_f32 v211, v211
    s_nop 0
    v_cvt_pk_bf16_f32 v115, v210, v211
    s_waitcnt lgkmcnt(3)
    v_mfma_f32_16x16x32_bf16 v[184:187], v[224:227], v[164:167], v[184:187]
    v_exp_f32 v212, v212
    v_exp_f32 v213, v213
    v_mfma_f32_16x16x32_bf16 v[188:191], v[224:227], v[180:183], v[188:191]
    ds_read_b128 v[240:243], v4 offset:43008
    v_cvt_pk_bf16_f32 v118, v212, v213
    s_waitcnt lgkmcnt(3)
    v_mfma_f32_16x16x32_bf16 v[192:195], v[228:231], v[164:167], v[192:195]
    v_exp_f32 v214, v214
    v_exp_f32 v215, v215
    v_mfma_f32_16x16x32_bf16 v[196:199], v[228:231], v[180:183], v[196:199]
    ds_read_b128 v[244:247], v4 offset:44032
    v_cvt_pk_bf16_f32 v119, v214, v215
    s_waitcnt lgkmcnt(3)
    v_mfma_f32_16x16x32_bf16 v[200:203], v[232:235], v[152:155], v[216:219]
    v_mfma_f32_16x16x32_bf16 v[204:207], v[232:235], v[168:171], v[220:223]
    ds_read_b128 v[224:227], v4 offset:45056
    v_exp_f32 v184, v184
    v_exp_f32 v185, v185
    v_mfma_f32_16x16x32_bf16 v[248:251], v[12:15], v[112:115], v[248:251]
    s_waitcnt lgkmcnt(3)
    v_mfma_f32_16x16x32_bf16 v[208:211], v[236:239], v[152:155], v[216:219]
    v_cvt_pk_bf16_f32 v120, v184, v185
    v_exp_f32 v186, v186
    v_mfma_f32_16x16x32_bf16 v[212:215], v[236:239], v[168:171], v[220:223]
    ds_read_b128 v[228:231], v4 offset:46080
    v_exp_f32 v187, v187
    v_mfma_f32_16x16x32_bf16 v[252:255], v[12:15], v[116:119], v[252:255]
    s_waitcnt lgkmcnt(3)
    v_mfma_f32_16x16x32_bf16 v[200:203], v[240:243], v[156:159], v[200:203]
    v_cvt_pk_bf16_f32 v121, v186, v187
    v_exp_f32 v188, v188
    v_mfma_f32_16x16x32_bf16 v[204:207], v[240:243], v[172:175], v[204:207]
    ds_read_b128 v[232:235], v4 offset:47104
    v_exp_f32 v189, v189
    s_waitcnt lgkmcnt(3)
    v_mfma_f32_16x16x32_bf16 v[208:211], v[244:247], v[156:159], v[208:211]
    v_cvt_pk_bf16_f32 v124, v188, v189
    v_exp_f32 v190, v190
    v_mfma_f32_16x16x32_bf16 v[212:215], v[244:247], v[172:175], v[212:215]
    ds_read_b128 v[236:239], v4 offset:48128
    v_exp_f32 v191, v191
    s_nop 0
    v_cvt_pk_bf16_f32 v125, v190, v191
    s_waitcnt lgkmcnt(3)
    v_mfma_f32_16x16x32_bf16 v[200:203], v[224:227], v[160:163], v[200:203]
    v_exp_f32 v192, v192
    v_mfma_f32_16x16x32_bf16 v[204:207], v[224:227], v[176:179], v[204:207]
    s_waitcnt vmcnt(11)
    s_barrier
    ds_read_b128 v[240:243], v4 offset:49152
    v_exp_f32 v193, v193
    s_nop 0
    v_cvt_pk_bf16_f32 v122, v192, v193
    s_waitcnt lgkmcnt(3)
    v_mfma_f32_16x16x32_bf16 v[208:211], v[228:231], v[160:163], v[208:211]
    v_exp_f32 v194, v194
    v_mfma_f32_16x16x32_bf16 v[212:215], v[228:231], v[176:179], v[212:215]
    s_add_u32 s22, s21, 0x8c000
    s_add_u32 m0, s20, 0x14000
    s_nop 0
    buffer_load_dwordx4 v2, s[8:11], s22 offen sc1 lds
    ds_read_b128 v[244:247], v4 offset:50176
    v_exp_f32 v195, v195
    s_nop 0
    v_cvt_pk_bf16_f32 v123, v194, v195
    s_waitcnt lgkmcnt(3)
    v_mfma_f32_16x16x32_bf16 v[200:203], v[232:235], v[164:167], v[200:203]
    v_exp_f32 v196, v196
    v_exp_f32 v197, v197
    v_mfma_f32_16x16x32_bf16 v[204:207], v[232:235], v[180:183], v[204:207]
    ds_read_b128 v[224:227], v4 offset:51200
    v_cvt_pk_bf16_f32 v126, v196, v197
    s_waitcnt lgkmcnt(3)
    v_mfma_f32_16x16x32_bf16 v[208:211], v[236:239], v[164:167], v[208:211]
    v_exp_f32 v198, v198
    v_exp_f32 v199, v199
    v_mfma_f32_16x16x32_bf16 v[212:215], v[236:239], v[180:183], v[212:215]
    ds_read_b128 v[228:231], v4 offset:52224
    v_cvt_pk_bf16_f32 v127, v198, v199
    s_waitcnt lgkmcnt(3)
    v_mfma_f32_16x16x32_bf16 v[184:187], v[240:243], v[152:155], v[216:219]
    v_mfma_f32_16x16x32_bf16 v[188:191], v[240:243], v[168:171], v[220:223]
    ds_read_b128 v[232:235], v4 offset:53248
    v_exp_f32 v200, v200
    v_exp_f32 v201, v201
    v_mfma_f32_16x16x32_bf16 v[248:251], v[12:15], v[120:123], v[248:251]
    s_waitcnt lgkmcnt(3)
    v_mfma_f32_16x16x32_bf16 v[192:195], v[244:247], v[152:155], v[216:219]
    v_cvt_pk_bf16_f32 v128, v200, v201
    v_exp_f32 v202, v202
    v_mfma_f32_16x16x32_bf16 v[196:199], v[244:247], v[168:171], v[220:223]
    s_add_u32 s22, s21, 0x8c400
    s_add_u32 m0, s20, 0x14400
    s_nop 0
    buffer_load_dwordx4 v2, s[8:11], s22 offen sc1 lds
    ds_read_b128 v[236:239], v4 offset:54272
    v_exp_f32 v203, v203
    v_mfma_f32_16x16x32_bf16 v[252:255], v[12:15], v[124:127], v[252:255]
    s_waitcnt lgkmcnt(3)
    v_mfma_f32_16x16x32_bf16 v[184:187], v[224:227], v[156:159], v[184:187]
    v_cvt_pk_bf16_f32 v129, v202, v203
    v_exp_f32 v204, v204
    v_mfma_f32_16x16x32_bf16 v[188:191], v[224:227], v[172:175], v[188:191]
    ds_read_b128 v[240:243], v4 offset:55296
    v_exp_f32 v205, v205
    s_waitcnt lgkmcnt(3)
    v_mfma_f32_16x16x32_bf16 v[192:195], v[228:231], v[156:159], v[192:195]
    v_cvt_pk_bf16_f32 v132, v204, v205
    v_exp_f32 v206, v206
    v_mfma_f32_16x16x32_bf16 v[196:199], v[228:231], v[172:175], v[196:199]
    ds_read_b128 v[244:247], v4 offset:56320
    v_exp_f32 v207, v207
    s_nop 0
    v_cvt_pk_bf16_f32 v133, v206, v207
    s_waitcnt lgkmcnt(3)
    v_mfma_f32_16x16x32_bf16 v[184:187], v[232:235], v[160:163], v[184:187]
    v_exp_f32 v208, v208
    v_mfma_f32_16x16x32_bf16 v[188:191], v[232:235], v[176:179], v[188:191]
    ds_read_b128 v[224:227], v4 offset:57344
    v_exp_f32 v209, v209
    s_nop 0
    v_cvt_pk_bf16_f32 v130, v208, v209
    s_waitcnt lgkmcnt(3)
    v_mfma_f32_16x16x32_bf16 v[192:195], v[236:239], v[160:163], v[192:195]
    v_exp_f32 v210, v210
    v_mfma_f32_16x16x32_bf16 v[196:199], v[236:239], v[176:179], v[196:199]
    ds_read_b128 v[228:231], v4 offset:58368
    v_exp_f32 v211, v211
    s_nop 0
    v_cvt_pk_bf16_f32 v131, v210, v211
    s_waitcnt lgkmcnt(3)
    v_mfma_f32_16x16x32_bf16 v[184:187], v[240:243], v[164:167], v[184:187]
    v_exp_f32 v212, v212
    v_exp_f32 v213, v213
    v_mfma_f32_16x16x32_bf16 v[188:191], v[240:243], v[180:183], v[188:191]
    ds_read_b128 v[232:235], v4 offset:59392
    v_cvt_pk_bf16_f32 v134, v212, v213
    s_waitcnt lgkmcnt(3)
    v_mfma_f32_16x16x32_bf16 v[192:195], v[244:247], v[164:167], v[192:195]
    v_exp_f32 v214, v214
    v_exp_f32 v215, v215
    v_mfma_f32_16x16x32_bf16 v[196:199], v[244:247], v[180:183], v[196:199]
    ds_read_b128 v[236:239], v4 offset:60416
    v_cvt_pk_bf16_f32 v135, v214, v215
    s_waitcnt lgkmcnt(3)
    v_mfma_f32_16x16x32_bf16 v[200:203], v[224:227], v[152:155], v[216:219]
    v_mfma_f32_16x16x32_bf16 v[204:207], v[224:227], v[168:171], v[220:223]
    ds_read_b128 v[240:243], v4 offset:61440
    v_exp_f32 v184, v184
    v_exp_f32 v185, v185
    v_mfma_f32_16x16x32_bf16 v[248:251], v[12:15], v[128:131], v[248:251]
    s_waitcnt lgkmcnt(3)
    v_mfma_f32_16x16x32_bf16 v[208:211], v[228:231], v[152:155], v[216:219]
    v_cvt_pk_bf16_f32 v136, v184, v185
    v_exp_f32 v186, v186
    v_mfma_f32_16x16x32_bf16 v[212:215], v[228:231], v[168:171], v[220:223]
    ds_read_b128 v[244:247], v4 offset:62464
    v_exp_f32 v187, v187
    v_mfma_f32_16x16x32_bf16 v[252:255], v[12:15], v[132:135], v[252:255]
    s_waitcnt lgkmcnt(3)
    v_mfma_f32_16x16x32_bf16 v[200:203], v[232:235], v[156:159], v[200:203]
    v_cvt_pk_bf16_f32 v137, v186, v187
    v_exp_f32 v188, v188
    v_mfma_f32_16x16x32_bf16 v[204:207], v[232:235], v[172:175], v[204:207]
    ds_read_b128 v[224:227], v4 offset:63488
    v_exp_f32 v189, v189
    s_waitcnt lgkmcnt(3)
    v_mfma_f32_16x16x32_bf16 v[208:211], v[236:239], v[156:159], v[208:211]
    v_cvt_pk_bf16_f32 v140, v188, v189
    v_exp_f32 v190, v190
    v_mfma_f32_16x16x32_bf16 v[212:215], v[236:239], v[172:175], v[212:215]
    ds_read_b128 v[228:231], v4 offset:64512
    v_exp_f32 v191, v191
    s_nop 0
    v_cvt_pk_bf16_f32 v141, v190, v191
    s_waitcnt lgkmcnt(3)
    v_mfma_f32_16x16x32_bf16 v[200:203], v[240:243], v[160:163], v[200:203]
    v_exp_f32 v192, v192
    v_mfma_f32_16x16x32_bf16 v[204:207], v[240:243], v[176:179], v[204:207]
    v_exp_f32 v193, v193
    s_nop 0
    v_cvt_pk_bf16_f32 v138, v192, v193
    s_waitcnt lgkmcnt(2)
    v_mfma_f32_16x16x32_bf16 v[208:211], v[244:247], v[160:163], v[208:211]
    v_exp_f32 v194, v194
    v_mfma_f32_16x16x32_bf16 v[212:215], v[244:247], v[176:179], v[212:215]
    v_exp_f32 v195, v195
    s_nop 0
    v_cvt_pk_bf16_f32 v139, v194, v195
    s_waitcnt lgkmcnt(1)
    v_mfma_f32_16x16x32_bf16 v[200:203], v[224:227], v[164:167], v[200:203]
    v_exp_f32 v196, v196
    v_exp_f32 v197, v197
    v_mfma_f32_16x16x32_bf16 v[204:207], v[224:227], v[180:183], v[204:207]
    v_cvt_pk_bf16_f32 v142, v196, v197
    s_waitcnt lgkmcnt(0)
    v_mfma_f32_16x16x32_bf16 v[208:211], v[228:231], v[164:167], v[208:211]
    v_exp_f32 v198, v198
    v_exp_f32 v199, v199
    v_mfma_f32_16x16x32_bf16 v[212:215], v[228:231], v[180:183], v[212:215]
    v_cvt_pk_bf16_f32 v143, v198, v199
    s_waitcnt vmcnt(9)
    s_barrier
    ds_read_b128 v[232:235], v5 offset:0
    ds_read_b128 v[236:239], v5 offset:1024
    ds_read_b128 v[240:243], v5 offset:2048
    ds_read_b128 v[244:247], v5 offset:3072
    v_mfma_f32_16x16x32_bf16 v[248:251], v[12:15], v[136:139], v[248:251]
    v_mfma_f32_16x16x32_bf16 v[252:255], v[12:15], v[140:143], v[252:255]
    v_exp_f32 v200, v200
    v_exp_f32 v201, v201
    s_nop 0
    v_cvt_pk_bf16_f32 v144, v200, v201
    v_exp_f32 v202, v202
    v_exp_f32 v203, v203
    s_nop 0
    v_cvt_pk_bf16_f32 v145, v202, v203
    v_exp_f32 v204, v204
    v_exp_f32 v205, v205
    s_nop 0
    v_cvt_pk_bf16_f32 v148, v204, v205
    v_exp_f32 v206, v206
    v_exp_f32 v207, v207
    s_nop 0
    v_cvt_pk_bf16_f32 v149, v206, v207
    v_exp_f32 v208, v208
    v_exp_f32 v209, v209
    s_nop 0
    v_cvt_pk_bf16_f32 v146, v208, v209
    v_exp_f32 v210, v210
    v_exp_f32 v211, v211
    s_nop 0
    v_cvt_pk_bf16_f32 v147, v210, v211
    v_exp_f32 v212, v212
    v_exp_f32 v213, v213
    s_nop 0
    v_cvt_pk_bf16_f32 v150, v212, v213
    v_exp_f32 v214, v214
    v_exp_f32 v215, v215
    s_nop 0
    v_cvt_pk_bf16_f32 v151, v214, v215
    v_mfma_f32_16x16x32_bf16 v[248:251], v[12:15], v[144:147], v[248:251]
    s_nop 0
    v_mfma_f32_16x16x32_bf16 v[252:255], v[12:15], v[148:151], v[252:255]
    s_nop 5
    v_mov_b32 v9, v248
    s_nop 0
    v_mov_b32 v10, v252
    v_max_f32 v17, v9, v10
    v_readfirstlane_b32 s17, v8
    s_cmp_eq_u32 s17, s28
    s_cselect_b32 s16, 0, 0x71800000
    v_cmp_ngt_f32 vcc, s16, v17
    v_cmp_u_f32 s[76:77], v9, v10
    s_or_b64 vcc, vcc, s[76:77]
    s_cbranch_vccnz adaLN_cond__sliding_block_cached__moe_arch_mod__prompt_kernel_fixB
adaLN_cond__sliding_block_cached__moe_arch_mod__prompt_kernel_fixBb:
    v_rcp_f32 v9, v9
    v_rcp_f32 v10, v10
    s_lshl_b32 s25, s13, 3
    s_add_u32 s25, s25, s3
    s_lshl_b32 s25, s25, 18
    s_lshl_b32 s26, s12, 12
    s_add_u32 s25, s25, s26
    s_add_u32 s25, s25, 0x1000000
    s_add_u32 s26, s25, 131072
    s_lshl_b32 s63, s13, 3
    s_add_u32 s63, s63, s3
    s_lshl_b32 s63, s63, 5
    s_add_u32 s63, s63, s12
    s_lshl_b32 s63, s63, 2
    s_waitcnt lgkmcnt(3)
    v_mfma_f32_16x16x32_bf16 v[184:187], v[232:235], v[24:27], 0
    v_mfma_f32_16x16x32_bf16 v[188:191], v[232:235], v[28:31], 0
    ds_read_b128 v[224:227], v5 offset:4096
    s_waitcnt lgkmcnt(3)
    v_mfma_f32_16x16x32_bf16 v[192:195], v[236:239], v[24:27], 0
    s_add_u32 s22, s21, 0x90000
    s_add_u32 m0, s20, 0x18000
    s_nop 0
    buffer_load_dwordx4 v2, s[8:11], s22 offen sc1 lds
    v_mfma_f32_16x16x32_bf16 v[196:199], v[236:239], v[28:31], 0
    ds_read_b128 v[228:231], v5 offset:5120
    s_waitcnt lgkmcnt(3)
    v_mfma_f32_16x16x32_bf16 v[184:187], v[240:243], v[32:35], v[184:187]
    v_mfma_f32_16x16x32_bf16 v[188:191], v[240:243], v[36:39], v[188:191]
    ds_read_b128 v[232:235], v5 offset:6144
    s_waitcnt lgkmcnt(3)
    v_mfma_f32_16x16x32_bf16 v[192:195], v[244:247], v[32:35], v[192:195]
    v_mfma_f32_16x16x32_bf16 v[196:199], v[244:247], v[36:39], v[196:199]
    ds_read_b128 v[236:239], v5 offset:7168
    s_waitcnt lgkmcnt(3)
    v_mfma_f32_16x16x32_bf16 v[184:187], v[224:227], v[40:43], v[184:187]
    v_mfma_f32_16x16x32_bf16 v[188:191], v[224:227], v[44:47], v[188:191]
    ds_read_b128 v[240:243], v5 offset:8192
    s_waitcnt lgkmcnt(3)
    v_mfma_f32_16x16x32_bf16 v[192:195], v[228:231], v[40:43], v[192:195]
    s_add_u32 s22, s21, 0x90400
    s_add_u32 m0, s20, 0x18400
    s_nop 0
    buffer_load_dwordx4 v2, s[8:11], s22 offen sc1 lds
    v_mfma_f32_16x16x32_bf16 v[196:199], v[228:231], v[44:47], v[196:199]
    ds_read_b128 v[244:247], v5 offset:9216
    s_waitcnt lgkmcnt(3)
    v_mfma_f32_16x16x32_bf16 v[184:187], v[232:235], v[48:51], v[184:187]
    v_mfma_f32_16x16x32_bf16 v[188:191], v[232:235], v[52:55], v[188:191]
    ds_read_b128 v[224:227], v5 offset:10240
    s_waitcnt lgkmcnt(3)
    v_mfma_f32_16x16x32_bf16 v[192:195], v[236:239], v[48:51], v[192:195]
    v_mfma_f32_16x16x32_bf16 v[196:199], v[236:239], v[52:55], v[196:199]
    ds_read_b128 v[228:231], v5 offset:11264
    s_waitcnt lgkmcnt(3)
    v_mfma_f32_16x16x32_bf16 v[184:187], v[240:243], v[56:59], v[184:187]
    v_mfma_f32_16x16x32_bf16 v[188:191], v[240:243], v[60:63], v[188:191]
    ds_read_b128 v[232:235], v5 offset:12288
    s_waitcnt lgkmcnt(3)
    v_mfma_f32_16x16x32_bf16 v[192:195], v[244:247], v[56:59], v[192:195]
    v_mfma_f32_16x16x32_bf16 v[196:199], v[244:247], v[60:63], v[196:199]
    ds_read_b128 v[236:239], v5 offset:13312
    s_waitcnt lgkmcnt(3)
    v_mfma_f32_16x16x32_bf16 v[184:187], v[224:227], v[64:67], v[184:187]
    v_mfma_f32_16x16x32_bf16 v[188:191], v[224:227], v[68:71], v[188:191]
    ds_read_b128 v[240:243], v5 offset:14336
    s_waitcnt lgkmcnt(3)
    v_mfma_f32_16x16x32_bf16 v[192:195], v[228:231], v[64:67], v[192:195]
    v_mfma_f32_16x16x32_bf16 v[196:199], v[228:231], v[68:71], v[196:199]
    ds_read_b128 v[244:247], v5 offset:15360
    s_waitcnt lgkmcnt(3)
    v_mfma_f32_16x16x32_bf16 v[184:187], v[232:235], v[72:75], v[184:187]
    v_mfma_f32_16x16x32_bf16 v[188:191], v[232:235], v[76:79], v[188:191]
    s_waitcnt vmcnt(8)
    s_barrier
    ds_read_b128 v[224:227], v5 offset:16384
    s_waitcnt lgkmcnt(3)
    v_mfma_f32_16x16x32_bf16 v[192:195], v[236:239], v[72:75], v[192:195]
    v_mfma_f32_16x16x32_bf16 v[196:199], v[236:239], v[76:79], v[196:199]
    s_add_u32 s22, s21, 0x94000
    s_add_u32 m0, s20, 0x1c000
    s_nop 0
    buffer_load_dwordx4 v2, s[8:11], s22 offen sc1 lds
    ds_read_b128 v[228:231], v5 offset:17408
    s_waitcnt lgkmcnt(3)
    v_mfma_f32_16x16x32_bf16 v[184:187], v[240:243], v[80:83], v[184:187]
    v_mfma_f32_16x16x32_bf16 v[188:191], v[240:243], v[84:87], v[188:191]
    ds_read_b128 v[232:235], v5 offset:18432
    s_waitcnt lgkmcnt(3)
    v_mfma_f32_16x16x32_bf16 v[192:195], v[244:247], v[80:83], v[192:195]
    v_mfma_f32_16x16x32_bf16 v[196:199], v[244:247], v[84:87], v[196:199]
    ds_read_b128 v[236:239], v5 offset:19456
    s_waitcnt lgkmcnt(3)
    v_mfma_f32_16x16x32_bf16 v[184:187], v[224:227], v[88:91], v[184:187]
    v_mfma_f32_16x16x32_bf16 v[188:191], v[224:227], v[92:95], v[188:191]
    ds_read_b128 v[240:243], v5 offset:20480
    s_waitcnt lgkmcnt(3)
    v_mfma_f32_16x16x32_bf16 v[192:195], v[228:231], v[88:91], v[192:195]
    v_mfma_f32_16x16x32_bf16 v[196:199], v[228:231], v[92:95], v[196:199]
    s_add_u32 s22, s21, 0x94400
    s_add_u32 m0, s20, 0x1c400
    s_nop 0
    buffer_load_dwordx4 v2, s[8:11], s22 offen sc1 lds
    ds_read_b128 v[244:247], v5 offset:21504
    s_waitcnt lgkmcnt(3)
    v_mfma_f32_16x16x32_bf16 v[184:187], v[232:235], v[96:99], v[184:187]
    v_mfma_f32_16x16x32_bf16 v[188:191], v[232:235], v[100:103], v[188:191]
    ds_read_b128 v[224:227], v5 offset:22528
    s_waitcnt lgkmcnt(3)
    v_mfma_f32_16x16x32_bf16 v[192:195], v[236:239], v[96:99], v[192:195]
    v_mfma_f32_16x16x32_bf16 v[196:199], v[236:239], v[100:103], v[196:199]
    ds_read_b128 v[228:231], v5 offset:23552
    s_waitcnt lgkmcnt(3)
    v_mfma_f32_16x16x32_bf16 v[184:187], v[240:243], v[104:107], v[184:187]
    v_mfma_f32_16x16x32_bf16 v[188:191], v[240:243], v[108:111], v[188:191]
    ds_read_b128 v[232:235], v5 offset:24576
    s_waitcnt lgkmcnt(3)
    v_mfma_f32_16x16x32_bf16 v[192:195], v[244:247], v[104:107], v[192:195]
    v_mfma_f32_16x16x32_bf16 v[196:199], v[244:247], v[108:111], v[196:199]
    ds_read_b128 v[236:239], v5 offset:25600
    s_waitcnt lgkmcnt(3)
    v_mfma_f32_16x16x32_bf16 v[184:187], v[224:227], v[112:115], v[184:187]
    v_mfma_f32_16x16x32_bf16 v[188:191], v[224:227], v[116:119], v[188:191]
    ds_read_b128 v[240:243], v5 offset:26624
    s_waitcnt lgkmcnt(3)
    v_mfma_f32_16x16x32_bf16 v[192:195], v[228:231], v[112:115], v[192:195]
    v_mfma_f32_16x16x32_bf16 v[196:199], v[228:231], v[116:119], v[196:199]
    ds_read_b128 v[244:247], v5 offset:27648
    s_waitcnt lgkmcnt(3)
    v_mfma_f32_16x16x32_bf16 v[184:187], v[232:235], v[120:123], v[184:187]
    v_mfma_f32_16x16x32_bf16 v[188:191], v[232:235], v[124:127], v[188:191]
    ds_read_b128 v[224:227], v5 offset:28672
    s_waitcnt lgkmcnt(3)
    v_mfma_f32_16x16x32_bf16 v[192:195], v[236:239], v[120:123], v[192:195]
    v_mfma_f32_16x16x32_bf16 v[196:199], v[236:239], v[124:127], v[196:199]
    ds_read_b128 v[228:231], v5 offset:29696
    s_waitcnt lgkmcnt(3)
    v_mfma_f32_16x16x32_bf16 v[184:187], v[240:243], v[128:131], v[184:187]
    v_mfma_f32_16x16x32_bf16 v[188:191], v[240:243], v[132:135], v[188:191]
    ds_read_b128 v[232:235], v5 offset:30720
    s_waitcnt lgkmcnt(3)
    v_mfma_f32_16x16x32_bf16 v[192:195], v[244:247], v[128:131], v[192:195]
    v_mfma_f32_16x16x32_bf16 v[196:199], v[244:247], v[132:135], v[196:199]
    ds_read_b128 v[236:239], v5 offset:31744
    s_waitcnt lgkmcnt(3)
    v_mfma_f32_16x16x32_bf16 v[184:187], v[224:227], v[136:139], v[184:187]
    v_mfma_f32_16x16x32_bf16 v[188:191], v[224:227], v[140:143], v[188:191]
    s_waitcnt vmcnt(7)
    s_barrier
    ds_read_b128 v[240:243], v4 offset:0
    s_waitcnt lgkmcnt(3)
    v_mfma_f32_16x16x32_bf16 v[192:195], v[228:231], v[136:139], v[192:195]
    v_mfma_f32_16x16x32_bf16 v[196:199], v[228:231], v[140:143], v[196:199]
    s_add_u32 s22, s21, 0x98000
    s_add_u32 m0, s20, 0x20000
    s_nop 0
    buffer_load_dwordx4 v2, s[8:11], s22 offen sc1 lds
    ds_read_b128 v[244:247], v4 offset:1024
    s_waitcnt lgkmcnt(3)
    v_mfma_f32_16x16x32_bf16 v[184:187], v[232:235], v[144:147], v[184:187]
    v_mfma_f32_16x16x32_bf16 v[188:191], v[232:235], v[148:151], v[188:191]
    ds_read_b128 v[224:227], v4 offset:2048
    s_waitcnt lgkmcnt(3)
    v_mfma_f32_16x16x32_bf16 v[192:195], v[236:239], v[144:147], v[192:195]
    v_mfma_f32_16x16x32_bf16 v[196:199], v[236:239], v[148:151], v[196:199]
    ds_read_b128 v[228:231], v4 offset:3072
    s_waitcnt lgkmcnt(3)
    v_mfma_f32_16x16x32_bf16 v[200:203], v[240:243], v[24:27], 0
    v_mfma_f32_16x16x32_bf16 v[204:207], v[240:243], v[28:31], 0
    ds_read_b128 v[232:235], v4 offset:4096
    s_waitcnt lgkmcnt(3)
    v_mfma_f32_16x16x32_bf16 v[208:211], v[244:247], v[24:27], 0
    v_mfma_f32_16x16x32_bf16 v[212:215], v[244:247], v[28:31], 0
    s_add_u32 s22, s21, 0x98400
    s_add_u32 m0, s20, 0x20400
    s_nop 0
    buffer_load_dwordx4 v2, s[8:11], s22 offen sc1 lds
    ds_read_b128 v[236:239], v4 offset:5120
    v_mul_f32 v184, v184, v9
    s_waitcnt lgkmcnt(3)
    v_mfma_f32_16x16x32_bf16 v[200:203], v[224:227], v[32:35], v[200:203]
    v_mul_f32 v185, v185, v9
    v_mfma_f32_16x16x32_bf16 v[204:207], v[224:227], v[36:39], v[204:207]
    ds_read_b128 v[240:243], v4 offset:6144
    v_mul_f32 v186, v186, v9
    s_waitcnt lgkmcnt(3)
    v_mfma_f32_16x16x32_bf16 v[208:211], v[228:231], v[32:35], v[208:211]
    v_mul_f32 v187, v187, v9
    v_mfma_f32_16x16x32_bf16 v[212:215], v[228:231], v[36:39], v[212:215]
    ds_read_b128 v[244:247], v4 offset:7168
    v_mul_f32 v192, v192, v9
    s_waitcnt lgkmcnt(3)
    v_mfma_f32_16x16x32_bf16 v[200:203], v[232:235], v[40:43], v[200:203]
    v_mul_f32 v193, v193, v9
    v_mfma_f32_16x16x32_bf16 v[204:207], v[232:235], v[44:47], v[204:207]
    ds_read_b128 v[224:227], v4 offset:8192
    v_mul_f32 v194, v194, v9
    s_waitcnt lgkmcnt(3)
    v_mfma_f32_16x16x32_bf16 v[208:211], v[236:239], v[40:43], v[208:211]
    v_mul_f32 v195, v195, v9
    v_mfma_f32_16x16x32_bf16 v[212:215], v[236:239], v[44:47], v[212:215]
    ds_read_b128 v[228:231], v4 offset:9216
    v_cvt_pk_bf16_f32 v216, v184, v185
    s_waitcnt lgkmcnt(3)
    v_mfma_f32_16x16x32_bf16 v[200:203], v[240:243], v[48:51], v[200:203]
    v_cvt_pk_bf16_f32 v217, v186, v187
    v_mfma_f32_16x16x32_bf16 v[204:207], v[240:243], v[52:55], v[204:207]
    ds_read_b128 v[232:235], v4 offset:10240
    v_cvt_pk_bf16_f32 v218, v192, v193
    s_waitcnt lgkmcnt(3)
    v_mfma_f32_16x16x32_bf16 v[208:211], v[244:247], v[48:51], v[208:211]
    v_cvt_pk_bf16_f32 v219, v194, v195
    v_mfma_f32_16x16x32_bf16 v[212:215], v[244:247], v[52:55], v[212:215]
    ds_read_b128 v[236:239], v4 offset:11264
    buffer_store_dwordx4 v[216:219], v2, s[8:11], s25 offen offset:0 sc1
    s_waitcnt lgkmcnt(3)
    v_mfma_f32_16x16x32_bf16 v[200:203], v[224:227], v[56:59], v[200:203]
    v_mul_f32 v188, v188, v10
    v_mfma_f32_16x16x32_bf16 v[204:207], v[224:227], v[60:63], v[204:207]
    ds_read_b128 v[240:243], v4 offset:12288
    v_mul_f32 v189, v189, v10
    s_waitcnt lgkmcnt(3)
    v_mfma_f32_16x16x32_bf16 v[208:211], v[228:231], v[56:59], v[208:211]
    v_mul_f32 v190, v190, v10
    v_mfma_f32_16x16x32_bf16 v[212:215], v[228:231], v[60:63], v[212:215]
    ds_read_b128 v[244:247], v4 offset:13312
    v_mul_f32 v191, v191, v10
    s_waitcnt lgkmcnt(3)
    v_mfma_f32_16x16x32_bf16 v[200:203], v[232:235], v[64:67], v[200:203]
    v_mul_f32 v196, v196, v10
    v_mfma_f32_16x16x32_bf16 v[204:207], v[232:235], v[68:71], v[204:207]
    ds_read_b128 v[224:227], v4 offset:14336
    v_mul_f32 v197, v197, v10
    s_waitcnt lgkmcnt(3)
    v_mfma_f32_16x16x32_bf16 v[208:211], v[236:239], v[64:67], v[208:211]
    v_mul_f32 v198, v198, v10
    v_mfma_f32_16x16x32_bf16 v[212:215], v[236:239], v[68:71], v[212:215]
    ds_read_b128 v[228:231], v4 offset:15360
    v_mul_f32 v199, v199, v10
    s_waitcnt lgkmcnt(3)
    v_mfma_f32_16x16x32_bf16 v[200:203], v[240:243], v[72:75], v[200:203]
    v_cvt_pk_bf16_f32 v220, v188, v189
    v_mfma_f32_16x16x32_bf16 v[204:207], v[240:243], v[76:79], v[204:207]
    s_waitcnt vmcnt(7)
    s_barrier
    ds_read_b128 v[232:235], v4 offset:16384
    v_cvt_pk_bf16_f32 v221, v190, v191
    s_waitcnt lgkmcnt(3)
    v_mfma_f32_16x16x32_bf16 v[208:211], v[244:247], v[72:75], v[208:211]
    v_cvt_pk_bf16_f32 v222, v196, v197
    v_mfma_f32_16x16x32_bf16 v[212:215], v[244:247], v[76:79], v[212:215]
    s_add_u32 s22, s21, 0x9c000
    s_add_u32 m0, s20, 0x24000
    s_nop 0
    buffer_load_dwordx4 v2, s[8:11], s22 offen sc1 lds
    ds_read_b128 v[236:239], v4 offset:17408
    v_cvt_pk_bf16_f32 v223, v198, v199
    s_waitcnt lgkmcnt(3)
    v_mfma_f32_16x16x32_bf16 v[200:203], v[224:227], v[80:83], v[200:203]
    buffer_store_dwordx4 v[220:223], v2, s[8:11], s26 offen offset:0 sc1
    v_mfma_f32_16x16x32_bf16 v[204:207], v[224:227], v[84:87], v[204:207]
    ds_read_b128 v[240:243], v4 offset:18432
    s_waitcnt lgkmcnt(3)
    v_mfma_f32_16x16x32_bf16 v[208:211], v[228:231], v[80:83], v[208:211]
    v_mfma_f32_16x16x32_bf16 v[212:215], v[228:231], v[84:87], v[212:215]
    ds_read_b128 v[244:247], v4 offset:19456
    s_waitcnt lgkmcnt(3)
    v_mfma_f32_16x16x32_bf16 v[200:203], v[232:235], v[88:91], v[200:203]
    v_mfma_f32_16x16x32_bf16 v[204:207], v[232:235], v[92:95], v[204:207]
    ds_read_b128 v[224:227], v4 offset:20480
    s_waitcnt lgkmcnt(3)
    v_mfma_f32_16x16x32_bf16 v[208:211], v[236:239], v[88:91], v[208:211]
    v_mfma_f32_16x16x32_bf16 v[212:215], v[236:239], v[92:95], v[212:215]
    s_add_u32 s22, s21, 0x9c400
    s_add_u32 m0, s20, 0x24400
    s_nop 0
    buffer_load_dwordx4 v2, s[8:11], s22 offen sc1 lds
    ds_read_b128 v[228:231], v4 offset:21504
    s_waitcnt lgkmcnt(3)
    v_mfma_f32_16x16x32_bf16 v[200:203], v[240:243], v[96:99], v[200:203]
    v_mfma_f32_16x16x32_bf16 v[204:207], v[240:243], v[100:103], v[204:207]
    ds_read_b128 v[232:235], v4 offset:22528
    s_waitcnt lgkmcnt(3)
    v_mfma_f32_16x16x32_bf16 v[208:211], v[244:247], v[96:99], v[208:211]
    v_mfma_f32_16x16x32_bf16 v[212:215], v[244:247], v[100:103], v[212:215]
    ds_read_b128 v[236:239], v4 offset:23552
    s_waitcnt lgkmcnt(3)
    v_mfma_f32_16x16x32_bf16 v[200:203], v[224:227], v[104:107], v[200:203]
    v_mfma_f32_16x16x32_bf16 v[204:207], v[224:227], v[108:111], v[204:207]
    ds_read_b128 v[240:243], v4 offset:24576
    s_waitcnt lgkmcnt(3)
    v_mfma_f32_16x16x32_bf16 v[208:211], v[228:231], v[104:107], v[208:211]
    v_mfma_f32_16x16x32_bf16 v[212:215], v[228:231], v[108:111], v[212:215]
    ds_read_b128 v[244:247], v4 offset:25600
    s_waitcnt lgkmcnt(3)
    v_mfma_f32_16x16x32_bf16 v[200:203], v[232:235], v[112:115], v[200:203]
    v_mfma_f32_16x16x32_bf16 v[204:207], v[232:235], v[116:119], v[204:207]
    ds_read_b128 v[224:227], v4 offset:26624
    s_waitcnt lgkmcnt(3)
    v_mfma_f32_16x16x32_bf16 v[208:211], v[236:239], v[112:115], v[208:211]
    v_mfma_f32_16x16x32_bf16 v[212:215], v[236:239], v[116:119], v[212:215]
    ds_read_b128 v[228:231], v4 offset:27648
    s_waitcnt lgkmcnt(3)
    v_mfma_f32_16x16x32_bf16 v[200:203], v[240:243], v[120:123], v[200:203]
    v_mfma_f32_16x16x32_bf16 v[204:207], v[240:243], v[124:127], v[204:207]
    ds_read_b128 v[232:235], v4 offset:28672
    s_waitcnt lgkmcnt(3)
    v_mfma_f32_16x16x32_bf16 v[208:211], v[244:247], v[120:123], v[208:211]
    v_mfma_f32_16x16x32_bf16 v[212:215], v[244:247], v[124:127], v[212:215]
    ds_read_b128 v[236:239], v4 offset:29696
    s_waitcnt lgkmcnt(3)
    v_mfma_f32_16x16x32_bf16 v[200:203], v[224:227], v[128:131], v[200:203]
    v_mfma_f32_16x16x32_bf16 v[204:207], v[224:227], v[132:135], v[204:207]
    ds_read_b128 v[240:243], v4 offset:30720
    s_waitcnt lgkmcnt(3)
    v_mfma_f32_16x16x32_bf16 v[208:211], v[228:231], v[128:131], v[208:211]
    v_mfma_f32_16x16x32_bf16 v[212:215], v[228:231], v[132:135], v[212:215]
    ds_read_b128 v[244:247], v4 offset:31744
    s_waitcnt lgkmcnt(3)
    v_mfma_f32_16x16x32_bf16 v[200:203], v[232:235], v[136:139], v[200:203]
    v_mfma_f32_16x16x32_bf16 v[204:207], v[232:235], v[140:143], v[204:207]
    s_waitcnt vmcnt(8)
    s_barrier
    ds_read_b128 v[224:227], v4 offset:32768
    s_waitcnt lgkmcnt(3)
    v_mfma_f32_16x16x32_bf16 v[208:211], v[236:239], v[136:139], v[208:211]
    v_mfma_f32_16x16x32_bf16 v[212:215], v[236:239], v[140:143], v[212:215]
    s_add_u32 s22, s24, 0x0
    s_add_u32 m0, s20, 0x10000
    s_nop 0
    buffer_load_dwordx4 v3, s[4:7], s22 offen lds
    ds_read_b128 v[228:231], v4 offset:33792
    s_waitcnt lgkmcnt(3)
    v_mfma_f32_16x16x32_bf16 v[200:203], v[240:243], v[144:147], v[200:203]
    v_mfma_f32_16x16x32_bf16 v[204:207], v[240:243], v[148:151], v[204:207]
    ds_read_b128 v[232:235], v4 offset:34816
    s_waitcnt lgkmcnt(3)
    v_mfma_f32_16x16x32_bf16 v[208:211], v[244:247], v[144:147], v[208:211]
    v_mfma_f32_16x16x32_bf16 v[212:215], v[244:247], v[148:151], v[212:215]
    ds_read_b128 v[236:239], v4 offset:35840
    s_waitcnt lgkmcnt(3)
    v_mfma_f32_16x16x32_bf16 v[184:187], v[224:227], v[24:27], 0
    v_mfma_f32_16x16x32_bf16 v[188:191], v[224:227], v[28:31], 0
    ds_read_b128 v[240:243], v4 offset:36864
    s_waitcnt lgkmcnt(3)
    v_mfma_f32_16x16x32_bf16 v[192:195], v[228:231], v[24:27], 0
    v_mfma_f32_16x16x32_bf16 v[196:199], v[228:231], v[28:31], 0
    s_add_u32 s22, s24, 0x2000
    s_add_u32 m0, s20, 0x10400
    s_nop 0
    buffer_load_dwordx4 v3, s[4:7], s22 offen lds
    ds_read_b128 v[244:247], v4 offset:37888
    v_mul_f32 v200, v200, v9
    s_waitcnt lgkmcnt(3)
    v_mfma_f32_16x16x32_bf16 v[184:187], v[232:235], v[32:35], v[184:187]
    v_mul_f32 v201, v201, v9
    v_mfma_f32_16x16x32_bf16 v[188:191], v[232:235], v[36:39], v[188:191]
    ds_read_b128 v[224:227], v4 offset:38912
    v_mul_f32 v202, v202, v9
    s_waitcnt lgkmcnt(3)
    v_mfma_f32_16x16x32_bf16 v[192:195], v[236:239], v[32:35], v[192:195]
    v_mul_f32 v203, v203, v9
    v_mfma_f32_16x16x32_bf16 v[196:199], v[236:239], v[36:39], v[196:199]
    ds_read_b128 v[228:231], v4 offset:39936
    v_mul_f32 v208, v208, v9
    s_waitcnt lgkmcnt(3)
    v_mfma_f32_16x16x32_bf16 v[184:187], v[240:243], v[40:43], v[184:187]
    v_mul_f32 v209, v209, v9
    v_mfma_f32_16x16x32_bf16 v[188:191], v[240:243], v[44:47], v[188:191]
    ds_read_b128 v[232:235], v4 offset:40960
    v_mul_f32 v210, v210, v9
    s_waitcnt lgkmcnt(3)
    v_mfma_f32_16x16x32_bf16 v[192:195], v[244:247], v[40:43], v[192:195]
    v_mul_f32 v211, v211, v9
    v_mfma_f32_16x16x32_bf16 v[196:199], v[244:247], v[44:47], v[196:199]
    ds_read_b128 v[236:239], v4 offset:41984
    v_cvt_pk_bf16_f32 v216, v200, v201
    s_waitcnt lgkmcnt(3)
    v_mfma_f32_16x16x32_bf16 v[184:187], v[224:227], v[48:51], v[184:187]
    v_cvt_pk_bf16_f32 v217, v202, v203
    s_waitcnt vmcnt(3)
    s_add_u32 s16, s63, 0x570000
    v_mov_b32 v7, s28
    v_mov_b32 v8, 0
    s_mov_b64 exec, 1
    buffer_store_dword v7, v8, s[8:11], s16 offen sc1
    s_mov_b64 exec, -1
    v_mfma_f32_16x16x32_bf16 v[188:191], v[224:227], v[52:55], v[188:191]
    ds_read_b128 v[240:243], v4 offset:43008
    v_cvt_pk_bf16_f32 v218, v208, v209
    s_waitcnt lgkmcnt(3)
    v_mfma_f32_16x16x32_bf16 v[192:195], v[228:231], v[48:51], v[192:195]
    v_cvt_pk_bf16_f32 v219, v210, v211
    v_mfma_f32_16x16x32_bf16 v[196:199], v[228:231], v[52:55], v[196:199]
    ds_read_b128 v[244:247], v4 offset:44032
    buffer_store_dwordx4 v[216:219], v2, s[8:11], s25 offen offset:1024 sc1
    s_waitcnt lgkmcnt(3)
    v_mfma_f32_16x16x32_bf16 v[184:187], v[232:235], v[56:59], v[184:187]
    v_mul_f32 v204, v204, v10
    v_mfma_f32_16x16x32_bf16 v[188:191], v[232:235], v[60:63], v[188:191]
    ds_read_b128 v[224:227], v4 offset:45056
    v_mul_f32 v205, v205, v10
    s_waitcnt lgkmcnt(3)
    v_mfma_f32_16x16x32_bf16 v[192:195], v[236:239], v[56:59], v[192:195]
    v_mul_f32 v206, v206, v10
    v_mfma_f32_16x16x32_bf16 v[196:199], v[236:239], v[60:63], v[196:199]
    ds_read_b128 v[228:231], v4 offset:46080
    v_mul_f32 v207, v207, v10
    s_waitcnt lgkmcnt(3)
    v_mfma_f32_16x16x32_bf16 v[184:187], v[240:243], v[64:67], v[184:187]
    v_mul_f32 v212, v212, v10
    v_mfma_f32_16x16x32_bf16 v[188:191], v[240:243], v[68:71], v[188:191]
    ds_read_b128 v[232:235], v4 offset:47104
    v_mul_f32 v213, v213, v10
    s_waitcnt lgkmcnt(3)
    v_mfma_f32_16x16x32_bf16 v[192:195], v[244:247], v[64:67], v[192:195]
    v_mul_f32 v214, v214, v10
    v_mfma_f32_16x16x32_bf16 v[196:199], v[244:247], v[68:71], v[196:199]
    ds_read_b128 v[236:239], v4 offset:48128
    v_mul_f32 v215, v215, v10
    s_waitcnt lgkmcnt(3)
    v_mfma_f32_16x16x32_bf16 v[184:187], v[224:227], v[72:75], v[184:187]
    v_cvt_pk_bf16_f32 v220, v204, v205
    v_mfma_f32_16x16x32_bf16 v[188:191], v[224:227], v[76:79], v[188:191]
    s_barrier
    ds_read_b128 v[240:243], v4 offset:49152
    v_cvt_pk_bf16_f32 v221, v206, v207
    s_waitcnt lgkmcnt(3)
    v_mfma_f32_16x16x32_bf16 v[192:195], v[228:231], v[72:75], v[192:195]
    v_cvt_pk_bf16_f32 v222, v212, v213
    v_mfma_f32_16x16x32_bf16 v[196:199], v[228:231], v[76:79], v[196:199]
    s_add_u32 s22, s24, 0x80000
    s_add_u32 m0, s20, 0x14000
    s_nop 0
    buffer_load_dwordx4 v3, s[4:7], s22 offen lds
    ds_read_b128 v[244:247], v4 offset:50176
    v_cvt_pk_bf16_f32 v223, v214, v215
    s_waitcnt lgkmcnt(3)
    v_mfma_f32_16x16x32_bf16 v[184:187], v[232:235], v[80:83], v[184:187]
    buffer_store_dwordx4 v[220:223], v2, s[8:11], s26 offen offset:1024 sc1
    v_mfma_f32_16x16x32_bf16 v[188:191], v[232:235], v[84:87], v[188:191]
    ds_read_b128 v[224:227], v4 offset:51200
    s_waitcnt lgkmcnt(3)
    v_mfma_f32_16x16x32_bf16 v[192:195], v[236:239], v[80:83], v[192:195]
    v_mfma_f32_16x16x32_bf16 v[196:199], v[236:239], v[84:87], v[196:199]
    ds_read_b128 v[228:231], v4 offset:52224
    s_waitcnt lgkmcnt(3)
    v_mfma_f32_16x16x32_bf16 v[184:187], v[240:243], v[88:91], v[184:187]
    v_mfma_f32_16x16x32_bf16 v[188:191], v[240:243], v[92:95], v[188:191]
    ds_read_b128 v[232:235], v4 offset:53248
    s_waitcnt lgkmcnt(3)
    v_mfma_f32_16x16x32_bf16 v[192:195], v[244:247], v[88:91], v[192:195]
    v_mfma_f32_16x16x32_bf16 v[196:199], v[244:247], v[92:95], v[196:199]
    s_add_u32 s22, s24, 0x82000
    s_add_u32 m0, s20, 0x14400
    s_nop 0
    buffer_load_dwordx4 v3, s[4:7], s22 offen lds
    ds_read_b128 v[236:239], v4 offset:54272
    s_waitcnt lgkmcnt(3)
    v_mfma_f32_16x16x32_bf16 v[184:187], v[224:227], v[96:99], v[184:187]
    v_mfma_f32_16x16x32_bf16 v[188:191], v[224:227], v[100:103], v[188:191]
    ds_read_b128 v[240:243], v4 offset:55296
    s_waitcnt lgkmcnt(3)
    v_mfma_f32_16x16x32_bf16 v[192:195], v[228:231], v[96:99], v[192:195]
    v_mfma_f32_16x16x32_bf16 v[196:199], v[228:231], v[100:103], v[196:199]
    ds_read_b128 v[244:247], v4 offset:56320
    s_waitcnt lgkmcnt(3)
    v_mfma_f32_16x16x32_bf16 v[184:187], v[232:235], v[104:107], v[184:187]
    v_mfma_f32_16x16x32_bf16 v[188:191], v[232:235], v[108:111], v[188:191]
    ds_read_b128 v[224:227], v4 offset:57344
    s_waitcnt lgkmcnt(3)
    v_mfma_f32_16x16x32_bf16 v[192:195], v[236:239], v[104:107], v[192:195]
    v_mfma_f32_16x16x32_bf16 v[196:199], v[236:239], v[108:111], v[196:199]
    ds_read_b128 v[228:231], v4 offset:58368
    s_waitcnt lgkmcnt(3)
    v_mfma_f32_16x16x32_bf16 v[184:187], v[240:243], v[112:115], v[184:187]
    v_mfma_f32_16x16x32_bf16 v[188:191], v[240:243], v[116:119], v[188:191]
    ds_read_b128 v[232:235], v4 offset:59392
    s_waitcnt lgkmcnt(3)
    v_mfma_f32_16x16x32_bf16 v[192:195], v[244:247], v[112:115], v[192:195]
    v_mfma_f32_16x16x32_bf16 v[196:199], v[244:247], v[116:119], v[196:199]
    ds_read_b128 v[236:239], v4 offset:60416
    s_waitcnt lgkmcnt(3)
    v_mfma_f32_16x16x32_bf16 v[184:187], v[224:227], v[120:123], v[184:187]
    v_mfma_f32_16x16x32_bf16 v[188:191], v[224:227], v[124:127], v[188:191]
    ds_read_b128 v[240:243], v4 offset:61440
    s_waitcnt lgkmcnt(3)
    v_mfma_f32_16x16x32_bf16 v[192:195], v[228:231], v[120:123], v[192:195]
    v_mfma_f32_16x16x32_bf16 v[196:199], v[228:231], v[124:127], v[196:199]
    ds_read_b128 v[244:247], v4 offset:62464
    s_waitcnt lgkmcnt(3)
    v_mfma_f32_16x16x32_bf16 v[184:187], v[232:235], v[128:131], v[184:187]
    v_mfma_f32_16x16x32_bf16 v[188:191], v[232:235], v[132:135], v[188:191]
    ds_read_b128 v[224:227], v4 offset:63488
    s_waitcnt lgkmcnt(3)
    v_mfma_f32_16x16x32_bf16 v[192:195], v[236:239], v[128:131], v[192:195]
    v_mfma_f32_16x16x32_bf16 v[196:199], v[236:239], v[132:135], v[196:199]
    ds_read_b128 v[228:231], v4 offset:64512
    s_waitcnt lgkmcnt(3)
    v_mfma_f32_16x16x32_bf16 v[184:187], v[240:243], v[136:139], v[184:187]
    v_mfma_f32_16x16x32_bf16 v[188:191], v[240:243], v[140:143], v[188:191]
    s_barrier
    ds_read_b128 v[232:235], v5 offset:0
    s_waitcnt lgkmcnt(3)
    v_mfma_f32_16x16x32_bf16 v[192:195], v[244:247], v[136:139], v[192:195]
    v_mfma_f32_16x16x32_bf16 v[196:199], v[244:247], v[140:143], v[196:199]
    s_add_u32 s22, s24, 0x100000
    s_add_u32 m0, s20, 0x18000
    s_nop 0
    buffer_load_dwordx4 v3, s[4:7], s22 offen lds
    ds_read_b128 v[236:239], v5 offset:1024
    s_waitcnt lgkmcnt(3)
    v_mfma_f32_16x16x32_bf16 v[184:187], v[224:227], v[144:147], v[184:187]
    v_mfma_f32_16x16x32_bf16 v[188:191], v[224:227], v[148:151], v[188:191]
    ds_read_b128 v[240:243], v5 offset:2048
    s_waitcnt lgkmcnt(3)
    v_mfma_f32_16x16x32_bf16 v[192:195], v[228:231], v[144:147], v[192:195]
    v_mfma_f32_16x16x32_bf16 v[196:199], v[228:231], v[148:151], v[196:199]
    ds_read_b128 v[244:247], v5 offset:3072
    s_waitcnt lgkmcnt(3)
    v_mfma_f32_16x16x32_bf16 v[200:203], v[232:235], v[24:27], 0
    v_mfma_f32_16x16x32_bf16 v[204:207], v[232:235], v[28:31], 0
    ds_read_b128 v[224:227], v5 offset:4096
    s_waitcnt lgkmcnt(3)
    v_mfma_f32_16x16x32_bf16 v[208:211], v[236:239], v[24:27], 0
    v_mfma_f32_16x16x32_bf16 v[212:215], v[236:239], v[28:31], 0
    s_add_u32 s22, s24, 0x102000
    s_add_u32 m0, s20, 0x18400
    s_nop 0
    buffer_load_dwordx4 v3, s[4:7], s22 offen lds
    ds_read_b128 v[228:231], v5 offset:5120
    v_mul_f32 v184, v184, v9
    s_waitcnt lgkmcnt(3)
    v_mfma_f32_16x16x32_bf16 v[200:203], v[240:243], v[32:35], v[200:203]
    v_mul_f32 v185, v185, v9
    s_bfe_u32 s30, s2, 0x20001
    s_lshl_b32 s30, s30, 2
    s_bfe_u32 s17, s2, 0x20003
    s_add_u32 s30, s30, s17
    s_lshr_b32 s31, s2, 5
    s_and_b32 s17, s3, 3
    s_lshl_b32 s19, s30, 2
    s_add_u32 s19, s19, s17
    s_and_b32 s16, s2, 1
    s_lshl_b32 s17, s19, 18
    s_lshl_b32 s23, s16, 16
    s_add_u32 s17, s17, s23
    s_add_u32 s17, s17, 0x1001000
    v_add_u32 v6, s17, v2
    s_lshl_b32 s19, s19, 7
    s_lshl_b32 s23, s16, 6
    s_add_u32 s19, s19, s23
    s_add_u32 s19, s19, 0x570000
    v_and_b32 v13, 15, v1
    v_lshlrev_b32 v13, 2, v13
    buffer_load_dword v12, v13, s[8:11], s19 offen sc1
    v_mfma_f32_16x16x32_bf16 v[204:207], v[240:243], v[36:39], v[204:207]
    ds_read_b128 v[232:235], v5 offset:6144
    v_mul_f32 v186, v186, v9
    s_waitcnt lgkmcnt(3)
    v_mfma_f32_16x16x32_bf16 v[208:211], v[244:247], v[32:35], v[208:211]
    v_mul_f32 v187, v187, v9
    v_mfma_f32_16x16x32_bf16 v[212:215], v[244:247], v[36:39], v[212:215]
    ds_read_b128 v[236:239], v5 offset:7168
    v_mul_f32 v192, v192, v9
    s_waitcnt lgkmcnt(3)
    v_mfma_f32_16x16x32_bf16 v[200:203], v[224:227], v[40:43], v[200:203]
    v_mul_f32 v193, v193, v9
    v_mfma_f32_16x16x32_bf16 v[204:207], v[224:227], v[44:47], v[204:207]
    ds_read_b128 v[240:243], v5 offset:8192
    v_mul_f32 v194, v194, v9
    s_waitcnt lgkmcnt(3)
    v_mfma_f32_16x16x32_bf16 v[208:211], v[228:231], v[40:43], v[208:211]
    v_mul_f32 v195, v195, v9
    v_mfma_f32_16x16x32_bf16 v[212:215], v[228:231], v[44:47], v[212:215]
    ds_read_b128 v[244:247], v5 offset:9216
    v_cvt_pk_bf16_f32 v216, v184, v185
    s_waitcnt lgkmcnt(3)
    v_mfma_f32_16x16x32_bf16 v[200:203], v[232:235], v[48:51], v[200:203]
    v_cvt_pk_bf16_f32 v217, v186, v187
    v_mfma_f32_16x16x32_bf16 v[204:207], v[232:235], v[52:55], v[204:207]
    ds_read_b128 v[224:227], v5 offset:10240
    v_cvt_pk_bf16_f32 v218, v192, v193
    s_waitcnt lgkmcnt(3)
    v_mfma_f32_16x16x32_bf16 v[208:211], v[236:239], v[48:51], v[208:211]
    v_cvt_pk_bf16_f32 v219, v194, v195
    v_mfma_f32_16x16x32_bf16 v[212:215], v[236:239], v[52:55], v[212:215]
    ds_read_b128 v[228:231], v5 offset:11264
    buffer_store_dwordx4 v[216:219], v2, s[8:11], s25 offen offset:2048 sc1
    s_waitcnt lgkmcnt(3)
    v_mfma_f32_16x16x32_bf16 v[200:203], v[240:243], v[56:59], v[200:203]
    v_mul_f32 v188, v188, v10
    v_mfma_f32_16x16x32_bf16 v[204:207], v[240:243], v[60:63], v[204:207]
    ds_read_b128 v[232:235], v5 offset:12288
    v_mul_f32 v189, v189, v10
    s_waitcnt lgkmcnt(3)
    v_mfma_f32_16x16x32_bf16 v[208:211], v[244:247], v[56:59], v[208:211]
    v_mul_f32 v190, v190, v10
    v_mfma_f32_16x16x32_bf16 v[212:215], v[244:247], v[60:63], v[212:215]
    ds_read_b128 v[236:239], v5 offset:13312
    v_mul_f32 v191, v191, v10
    s_waitcnt lgkmcnt(3)
    v_mfma_f32_16x16x32_bf16 v[200:203], v[224:227], v[64:67], v[200:203]
    v_mul_f32 v196, v196, v10
    v_mfma_f32_16x16x32_bf16 v[204:207], v[224:227], v[68:71], v[204:207]
    ds_read_b128 v[240:243], v5 offset:14336
    v_mul_f32 v197, v197, v10
    s_waitcnt lgkmcnt(3)
    v_mfma_f32_16x16x32_bf16 v[208:211], v[228:231], v[64:67], v[208:211]
    v_mul_f32 v198, v198, v10
    v_mfma_f32_16x16x32_bf16 v[212:215], v[228:231], v[68:71], v[212:215]
    ds_read_b128 v[244:247], v5 offset:15360
    v_mul_f32 v199, v199, v10
    s_waitcnt lgkmcnt(3)
    v_mfma_f32_16x16x32_bf16 v[200:203], v[232:235], v[72:75], v[200:203]
    v_cvt_pk_bf16_f32 v220, v188, v189
    v_mfma_f32_16x16x32_bf16 v[204:207], v[232:235], v[76:79], v[204:207]
    s_waitcnt vmcnt(11)
    s_barrier
    ds_read_b128 v[224:227], v5 offset:16384
    v_cvt_pk_bf16_f32 v221, v190, v191
    s_waitcnt lgkmcnt(3)
    v_mfma_f32_16x16x32_bf16 v[208:211], v[236:239], v[72:75], v[208:211]
    v_cvt_pk_bf16_f32 v222, v196, v197
    v_mfma_f32_16x16x32_bf16 v[212:215], v[236:239], v[76:79], v[212:215]
    s_add_u32 s22, s24, 0x180000
    s_add_u32 m0, s20, 0x1c000
    s_nop 0
    buffer_load_dwordx4 v3, s[4:7], s22 offen lds
    ds_read_b128 v[228:231], v5 offset:17408
    v_cvt_pk_bf16_f32 v223, v198, v199
    s_waitcnt lgkmcnt(3)
    v_mfma_f32_16x16x32_bf16 v[200:203], v[240:243], v[80:83], v[200:203]
    buffer_store_dwordx4 v[220:223], v2, s[8:11], s26 offen offset:2048 sc1
    v_mfma_f32_16x16x32_bf16 v[204:207], v[240:243], v[84:87], v[204:207]
    ds_read_b128 v[232:235], v5 offset:18432
    s_waitcnt lgkmcnt(3)
    v_mfma_f32_16x16x32_bf16 v[208:211], v[244:247], v[80:83], v[208:211]
    v_mfma_f32_16x16x32_bf16 v[212:215], v[244:247], v[84:87], v[212:215]
    ds_read_b128 v[236:239], v5 offset:19456
    s_waitcnt lgkmcnt(3)
    v_mfma_f32_16x16x32_bf16 v[200:203], v[224:227], v[88:91], v[200:203]
    v_mfma_f32_16x16x32_bf16 v[204:207], v[224:227], v[92:95], v[204:207]
    ds_read_b128 v[240:243], v5 offset:20480
    s_waitcnt vmcnt(3)
    v_cmp_ne_u32 vcc, s28, v12
    s_cbranch_vccnz adaLN_cond__sliding_block_cached__moe_arch_mod__prompt_kernel_o17r
adaLN_cond__sliding_block_cached__moe_arch_mod__prompt_kernel_o17b:
    s_waitcnt lgkmcnt(3)
    v_mfma_f32_16x16x32_bf16 v[208:211], v[228:231], v[88:91], v[208:211]
    s_mov_b32 s23, 0x0
    buffer_load_dwordx4 v[24:27], v6, s[8:11], s23 offen offset:0 sc1
    v_mfma_f32_16x16x32_bf16 v[212:215], v[228:231], v[92:95], v[212:215]
    s_add_u32 s22, s24, 0x182000
    s_add_u32 m0, s20, 0x1c400
    s_nop 0
    buffer_load_dwordx4 v3, s[4:7], s22 offen lds
    ds_read_b128 v[244:247], v5 offset:21504
    s_waitcnt lgkmcnt(3)
    v_mfma_f32_16x16x32_bf16 v[200:203], v[232:235], v[96:99], v[200:203]
    v_mfma_f32_16x16x32_bf16 v[204:207], v[232:235], v[100:103], v[204:207]
    ds_read_b128 v[224:227], v5 offset:22528
    s_mov_b32 s23, 0x20000
    buffer_load_dwordx4 v[28:31], v6, s[8:11], s23 offen offset:0 sc1
    s_waitcnt lgkmcnt(3)
    v_mfma_f32_16x16x32_bf16 v[208:211], v[236:239], v[96:99], v[208:211]
    s_add_u32 s16, s63, 0x572000
    v_mov_b32 v14, s28
    v_mov_b32 v15, 0
    s_mov_b64 exec, 1
    buffer_store_dword v14, v15, s[8:11], s16 offen sc1
    s_mov_b64 exec, -1
    v_mfma_f32_16x16x32_bf16 v[212:215], v[236:239], v[100:103], v[212:215]
    ds_read_b128 v[228:231], v5 offset:23552
    s_waitcnt lgkmcnt(3)
    v_mfma_f32_16x16x32_bf16 v[200:203], v[240:243], v[104:107], v[200:203]
    v_mfma_f32_16x16x32_bf16 v[204:207], v[240:243], v[108:111], v[204:207]
    ds_read_b128 v[232:235], v5 offset:24576
    s_mov_b32 s23, 0x2000
    buffer_load_dwordx4 v[32:35], v6, s[8:11], s23 offen offset:0 sc1
    s_waitcnt lgkmcnt(3)
    v_mfma_f32_16x16x32_bf16 v[208:211], v[244:247], v[104:107], v[208:211]
    v_mfma_f32_16x16x32_bf16 v[212:215], v[244:247], v[108:111], v[212:215]
    ds_read_b128 v[236:239], v5 offset:25600
    s_waitcnt lgkmcnt(3)
    v_mfma_f32_16x16x32_bf16 v[200:203], v[224:227], v[112:115], v[200:203]
    s_mov_b32 s23, 0x22000
    buffer_load_dwordx4 v[36:39], v6, s[8:11], s23 offen offset:0 sc1
    v_mfma_f32_16x16x32_bf16 v[204:207], v[224:227], v[116:119], v[204:207]
    ds_read_b128 v[240:243], v5 offset:26624
    s_waitcnt lgkmcnt(3)
    v_mfma_f32_16x16x32_bf16 v[208:211], v[228:231], v[112:115], v[208:211]
    v_mfma_f32_16x16x32_bf16 v[212:215], v[228:231], v[116:119], v[212:215]
    ds_read_b128 v[244:247], v5 offset:27648
    s_waitcnt lgkmcnt(3)
    v_mfma_f32_16x16x32_bf16 v[200:203], v[232:235], v[120:123], v[200:203]
    s_mov_b32 s23, 0x4000
    buffer_load_dwordx4 v[40:43], v6, s[8:11], s23 offen offset:0 sc1
    v_mfma_f32_16x16x32_bf16 v[204:207], v[232:235], v[124:127], v[204:207]
    ds_read_b128 v[224:227], v5 offset:28672
    s_waitcnt lgkmcnt(3)
    v_mfma_f32_16x16x32_bf16 v[208:211], v[236:239], v[120:123], v[208:211]
    v_mfma_f32_16x16x32_bf16 v[212:215], v[236:239], v[124:127], v[212:215]
    ds_read_b128 v[228:231], v5 offset:29696
    s_waitcnt lgkmcnt(3)
    v_mfma_f32_16x16x32_bf16 v[200:203], v[240:243], v[128:131], v[200:203]
    s_mov_b32 s23, 0x24000
    buffer_load_dwordx4 v[44:47], v6, s[8:11], s23 offen offset:0 sc1
    v_mfma_f32_16x16x32_bf16 v[204:207], v[240:243], v[132:135], v[204:207]
    ds_read_b128 v[232:235], v5 offset:30720
    s_waitcnt lgkmcnt(3)
    v_mfma_f32_16x16x32_bf16 v[208:211], v[244:247], v[128:131], v[208:211]
    v_mfma_f32_16x16x32_bf16 v[212:215], v[244:247], v[132:135], v[212:215]
    ds_read_b128 v[236:239], v5 offset:31744
    s_mov_b32 s23, 0x6000
    buffer_load_dwordx4 v[48:51], v6, s[8:11], s23 offen offset:0 sc1
    s_waitcnt lgkmcnt(3)
    v_mfma_f32_16x16x32_bf16 v[200:203], v[224:227], v[136:139], v[200:203]
    v_bfe_u32 v18, v1, 2, 2
    v_lshrrev_b32 v19, 4, v1
    v_mfma_f32_16x16x32_bf16 v[204:207], v[224:227], v[140:143], v[204:207]
    v_and_b32 v17, 3, v1
    v_lshlrev_b32 v16, 11, v19
    s_waitcnt lgkmcnt(2)
    v_mfma_f32_16x16x32_bf16 v[208:211], v[228:231], v[136:139], v[208:211]
    v_lshl_add_u32 v16, v18, 6, v16
    v_lshl_add_u32 v16, v17, 3, v16
    v_mfma_f32_16x16x32_bf16 v[212:215], v[228:231], v[140:143], v[212:215]
    s_mov_b32 s23, 0x26000
    buffer_load_dwordx4 v[52:55], v6, s[8:11], s23 offen offset:0 sc1
    v_add_u32 v16, 0x12000, v16
    v_and_b32 v19, 1, v19
    s_waitcnt lgkmcnt(1)
    v_mfma_f32_16x16x32_bf16 v[200:203], v[232:235], v[144:147], v[200:203]
    v_lshlrev_b32 v19, 5, v19
    v_sub_u32 v5, v16, v19
    v_mfma_f32_16x16x32_bf16 v[204:207], v[232:235], v[148:151], v[204:207]
    v_add_u32 v4, v16, v19
    v_add_u32 v7, 0x10000, v4
    s_waitcnt lgkmcnt(0)
    v_mfma_f32_16x16x32_bf16 v[208:211], v[236:239], v[144:147], v[208:211]
    v_add_u32 v8, 0x10000, v5
    v_mfma_f32_16x16x32_bf16 v[212:215], v[236:239], v[148:151], v[212:215]
    v_mul_f32 v200, v200, v9
    v_mul_f32 v201, v201, v9
    v_mul_f32 v202, v202, v9
    v_mul_f32 v203, v203, v9
    s_nop 1
    v_mul_f32 v208, v208, v9
    v_mul_f32 v209, v209, v9
    v_mul_f32 v210, v210, v9
    v_mul_f32 v211, v211, v9
    v_cvt_pk_bf16_f32 v216, v200, v201
    v_cvt_pk_bf16_f32 v217, v202, v203
    v_cvt_pk_bf16_f32 v218, v208, v209
    v_cvt_pk_bf16_f32 v219, v210, v211
    buffer_store_dwordx4 v[216:219], v2, s[8:11], s25 offen offset:3072 sc1
    v_mul_f32 v204, v204, v10
    v_mul_f32 v205, v205, v10
    v_mul_f32 v206, v206, v10
    v_mul_f32 v207, v207, v10
    v_mul_f32 v212, v212, v10
    v_mul_f32 v213, v213, v10
    v_mul_f32 v214, v214, v10
    v_mul_f32 v215, v215, v10
    v_cvt_pk_bf16_f32 v220, v204, v205
    v_cvt_pk_bf16_f32 v221, v206, v207
    v_cvt_pk_bf16_f32 v222, v212, v213
    v_cvt_pk_bf16_f32 v223, v214, v215
    buffer_store_dwordx4 v[220:223], v2, s[8:11], s26 offen offset:3072 sc1
    s_and_b32 s15, s2, 1
    s_barrier
    ds_read_b64_tr_b16 v[224:225], v4 offset:0
    ds_read_b64_tr_b16 v[226:227], v4 offset:1024
    ds_read_b64_tr_b16 v[228:229], v5 offset:32
    ds_read_b64_tr_b16 v[230:231], v5 offset:1056
    ds_read_b64_tr_b16 v[232:233], v4 offset:256
    ds_read_b64_tr_b16 v[234:235], v4 offset:1280
    ds_read_b64_tr_b16 v[236:237], v5 offset:288
    ds_read_b64_tr_b16 v[238:239], v5 offset:1312
    s_waitcnt vmcnt(11) lgkmcnt(6)
    v_mfma_f32_16x16x32_bf16 v[88:91], v[224:227], v[24:27], 0
    ds_read_b64_tr_b16 v[240:241], v4 offset:512
    s_waitcnt vmcnt(9)
    v_mfma_f32_16x16x32_bf16 v[92:95], v[224:227], v[28:31], 0
    ds_read_b64_tr_b16 v[242:243], v4 offset:1536
    s_waitcnt lgkmcnt(6)
    v_mfma_f32_16x16x32_bf16 v[96:99], v[228:231], v[24:27], 0
    ds_read_b64_tr_b16 v[244:245], v5 offset:544
    v_mfma_f32_16x16x32_bf16 v[100:103], v[228:231], v[28:31], 0
    ds_read_b64_tr_b16 v[246:247], v5 offset:1568
    s_waitcnt lgkmcnt(6)
    v_mfma_f32_16x16x32_bf16 v[104:107], v[232:235], v[24:27], 0
    ds_read_b64_tr_b16 v[224:225], v4 offset:768
    v_mfma_f32_16x16x32_bf16 v[108:111], v[232:235], v[28:31], 0
    ds_read_b64_tr_b16 v[226:227], v4 offset:1792
    s_waitcnt lgkmcnt(6)
    v_mfma_f32_16x16x32_bf16 v[112:115], v[236:239], v[24:27], 0
    ds_read_b64_tr_b16 v[228:229], v5 offset:800
    v_mfma_f32_16x16x32_bf16 v[116:119], v[236:239], v[28:31], 0
    ds_read_b64_tr_b16 v[230:231], v5 offset:1824
    s_waitcnt lgkmcnt(6)
    v_mfma_f32_16x16x32_bf16 v[120:123], v[240:243], v[24:27], 0
    s_add_u32 s22, s24, 0x200000
    s_add_u32 m0, s20, 0x20000
    s_nop 0
    buffer_load_dwordx4 v3, s[4:7], s22 offen lds
    v_mfma_f32_16x16x32_bf16 v[124:127], v[240:243], v[28:31], 0
    s_barrier
    ds_read_b64_tr_b16 v[232:233], v4 offset:16384
    ds_read_b64_tr_b16 v[234:235], v4 offset:17408
    s_waitcnt lgkmcnt(6)
    v_mfma_f32_16x16x32_bf16 v[128:131], v[244:247], v[24:27], 0
    ds_read_b64_tr_b16 v[236:237], v5 offset:16416
    s_mov_b32 s23, 0x8000
    buffer_load_dwordx4 v[56:59], v6, s[8:11], s23 offen offset:0 sc1
    v_mfma_f32_16x16x32_bf16 v[132:135], v[244:247], v[28:31], 0
    s_add_u32 s22, s24, 0x202000
    s_add_u32 m0, s20, 0x20400
    s_nop 0
    buffer_load_dwordx4 v3, s[4:7], s22 offen lds
    ds_read_b64_tr_b16 v[238:239], v5 offset:17440
    s_waitcnt lgkmcnt(6)
    v_mfma_f32_16x16x32_bf16 v[136:139], v[224:227], v[24:27], 0
    ds_read_b64_tr_b16 v[240:241], v4 offset:16640
    v_mfma_f32_16x16x32_bf16 v[140:143], v[224:227], v[28:31], 0
    ds_read_b64_tr_b16 v[242:243], v4 offset:17664
    s_mov_b32 s23, 0x28000
    buffer_load_dwordx4 v[60:63], v6, s[8:11], s23 offen offset:0 sc1
    s_waitcnt lgkmcnt(6)
    v_mfma_f32_16x16x32_bf16 v[144:147], v[228:231], v[24:27], 0
    ds_read_b64_tr_b16 v[244:245], v5 offset:16672
    v_mfma_f32_16x16x32_bf16 v[148:151], v[228:231], v[28:31], 0
    ds_read_b64_tr_b16 v[246:247], v5 offset:17696
    s_waitcnt vmcnt(11) lgkmcnt(6)
    v_mfma_f32_16x16x32_bf16 v[88:91], v[232:235], v[32:35], v[88:91]
    ds_read_b64_tr_b16 v[224:225], v4 offset:16896
    s_waitcnt vmcnt(10)
    v_mfma_f32_16x16x32_bf16 v[92:95], v[232:235], v[36:39], v[92:95]
    s_add_u32 s22, s24, 0x280000
    s_add_u32 m0, s20, 0x24000
    s_nop 0
    buffer_load_dwordx4 v3, s[4:7], s22 offen lds
    ds_read_b64_tr_b16 v[226:227], v4 offset:17920
    s_waitcnt lgkmcnt(6)
    v_mfma_f32_16x16x32_bf16 v[96:99], v[236:239], v[32:35], v[96:99]
    ds_read_b64_tr_b16 v[228:229], v5 offset:16928
    v_mfma_f32_16x16x32_bf16 v[100:103], v[236:239], v[36:39], v[100:103]
    ds_read_b64_tr_b16 v[230:231], v5 offset:17952
    s_waitcnt lgkmcnt(6)
    v_mfma_f32_16x16x32_bf16 v[104:107], v[240:243], v[32:35], v[104:107]
    s_add_u32 s22, s24, 0x282000
    s_add_u32 m0, s20, 0x24400
    s_nop 0
    buffer_load_dwordx4 v3, s[4:7], s22 offen lds
    ds_read_b64_tr_b16 v[232:233], v4 offset:17152
    v_mfma_f32_16x16x32_bf16 v[108:111], v[240:243], v[36:39], v[108:111]
    ds_read_b64_tr_b16 v[234:235], v4 offset:18176
    s_waitcnt lgkmcnt(6)
    v_mfma_f32_16x16x32_bf16 v[112:115], v[244:247], v[32:35], v[112:115]
    ds_read_b64_tr_b16 v[236:237], v5 offset:17184
    v_mfma_f32_16x16x32_bf16 v[116:119], v[244:247], v[36:39], v[116:119]
    ds_read_b64_tr_b16 v[238:239], v5 offset:18208
    s_waitcnt lgkmcnt(6)
    v_mfma_f32_16x16x32_bf16 v[120:123], v[224:227], v[32:35], v[120:123]
    v_mfma_f32_16x16x32_bf16 v[124:127], v[224:227], v[36:39], v[124:127]
    s_barrier
    ds_read_b64_tr_b16 v[240:241], v4 offset:32768
    ds_read_b64_tr_b16 v[242:243], v4 offset:33792
    s_waitcnt lgkmcnt(6)
    v_mfma_f32_16x16x32_bf16 v[128:131], v[228:231], v[32:35], v[128:131]
    ds_read_b64_tr_b16 v[244:245], v5 offset:32800
    s_mov_b32 s23, 0xa000
    buffer_load_dwordx4 v[24:27], v6, s[8:11], s23 offen offset:0 sc1
    v_mfma_f32_16x16x32_bf16 v[132:135], v[228:231], v[36:39], v[132:135]
    ds_read_b64_tr_b16 v[246:247], v5 offset:33824
    s_waitcnt lgkmcnt(6)
    v_mfma_f32_16x16x32_bf16 v[136:139], v[232:235], v[32:35], v[136:139]
    ds_read_b64_tr_b16 v[224:225], v4 offset:33024
    v_mfma_f32_16x16x32_bf16 v[140:143], v[232:235], v[36:39], v[140:143]
    ds_read_b64_tr_b16 v[226:227], v4 offset:34048
    s_mov_b32 s23, 0x2a000
    buffer_load_dwordx4 v[28:31], v6, s[8:11], s23 offen offset:0 sc1
    s_waitcnt lgkmcnt(6)
    v_mfma_f32_16x16x32_bf16 v[144:147], v[236:239], v[32:35], v[144:147]
    s_add_u32 s16, s63, 0x574000
    v_mov_b32 v14, s28
    v_mov_b32 v15, 0
    s_mov_b64 exec, 1
    buffer_store_dword v14, v15, s[8:11], s16 offen sc1
    s_mov_b64 exec, -1
    ds_read_b64_tr_b16 v[228:229], v5 offset:33056
    v_mfma_f32_16x16x32_bf16 v[148:151], v[236:239], v[36:39], v[148:151]
    ds_read_b64_tr_b16 v[230:231], v5 offset:34080
    s_waitcnt vmcnt(14) lgkmcnt(6)
    v_mfma_f32_16x16x32_bf16 v[88:91], v[240:243], v[40:43], v[88:91]
    ds_read_b64_tr_b16 v[232:233], v4 offset:33280
    s_waitcnt vmcnt(13)
    v_mfma_f32_16x16x32_bf16 v[92:95], v[240:243], v[44:47], v[92:95]
    s_add_u32 s22, s24, 0x300000
    s_add_u32 m0, s20, 0x10000
    s_nop 0
    buffer_load_dwordx4 v3, s[4:7], s22 offen lds
    ds_read_b64_tr_b16 v[234:235], v4 offset:34304
    s_waitcnt lgkmcnt(6)
    v_mfma_f32_16x16x32_bf16 v[96:99], v[244:247], v[40:43], v[96:99]
    ds_read_b64_tr_b16 v[236:237], v5 offset:33312
    v_mfma_f32_16x16x32_bf16 v[100:103], v[244:247], v[44:47], v[100:103]
    ds_read_b64_tr_b16 v[238:239], v5 offset:34336
    s_waitcnt lgkmcnt(6)
    v_mfma_f32_16x16x32_bf16 v[104:107], v[224:227], v[40:43], v[104:107]
    s_add_u32 s22, s24, 0x302000
    s_add_u32 m0, s20, 0x10400
    s_nop 0
    buffer_load_dwordx4 v3, s[4:7], s22 offen lds
    ds_read_b64_tr_b16 v[240:241], v4 offset:33536
    v_mfma_f32_16x16x32_bf16 v[108:111], v[224:227], v[44:47], v[108:111]
    ds_read_b64_tr_b16 v[242:243], v4 offset:34560
    s_waitcnt lgkmcnt(6)
    v_mfma_f32_16x16x32_bf16 v[112:115], v[228:231], v[40:43], v[112:115]
    ds_read_b64_tr_b16 v[244:245], v5 offset:33568
    v_mfma_f32_16x16x32_bf16 v[116:119], v[228:231], v[44:47], v[116:119]
    ds_read_b64_tr_b16 v[246:247], v5 offset:34592
    s_waitcnt lgkmcnt(6)
    v_mfma_f32_16x16x32_bf16 v[120:123], v[232:235], v[40:43], v[120:123]
    v_mfma_f32_16x16x32_bf16 v[124:127], v[232:235], v[44:47], v[124:127]
    s_barrier
    ds_read_b64_tr_b16 v[224:225], v4 offset:49152
    ds_read_b64_tr_b16 v[226:227], v4 offset:50176
    s_add_u32 s19, s19, 8192
    buffer_load_dword v12, v13, s[8:11], s19 offen sc1
    s_waitcnt lgkmcnt(6)
    v_mfma_f32_16x16x32_bf16 v[128:131], v[236:239], v[40:43], v[128:131]
    ds_read_b64_tr_b16 v[228:229], v5 offset:49184
    s_mov_b32 s23, 0xc000
    buffer_load_dwordx4 v[32:35], v6, s[8:11], s23 offen offset:0 sc1
    v_mfma_f32_16x16x32_bf16 v[132:135], v[236:239], v[44:47], v[132:135]
    ds_read_b64_tr_b16 v[230:231], v5 offset:50208
    s_waitcnt lgkmcnt(6)
    v_mfma_f32_16x16x32_bf16 v[136:139], v[240:243], v[40:43], v[136:139]
    ds_read_b64_tr_b16 v[232:233], v4 offset:49408
    v_mfma_f32_16x16x32_bf16 v[140:143], v[240:243], v[44:47], v[140:143]
    ds_read_b64_tr_b16 v[234:235], v4 offset:50432
    s_mov_b32 s23, 0x2c000
    buffer_load_dwordx4 v[36:39], v6, s[8:11], s23 offen offset:0 sc1
    s_waitcnt lgkmcnt(6)
    v_mfma_f32_16x16x32_bf16 v[144:147], v[244:247], v[40:43], v[144:147]
    ds_read_b64_tr_b16 v[236:237], v5 offset:49440
    v_mfma_f32_16x16x32_bf16 v[148:151], v[244:247], v[44:47], v[148:151]
    ds_read_b64_tr_b16 v[238:239], v5 offset:50464
    s_waitcnt vmcnt(17) lgkmcnt(6)
    v_mfma_f32_16x16x32_bf16 v[88:91], v[224:227], v[48:51], v[88:91]
    ds_read_b64_tr_b16 v[240:241], v4 offset:49664
    s_waitcnt vmcnt(16)
    v_mfma_f32_16x16x32_bf16 v[92:95], v[224:227], v[52:55], v[92:95]
    s_add_u32 s22, s24, 0x380000
    s_add_u32 m0, s20, 0x14000
    s_nop 0
    buffer_load_dwordx4 v3, s[4:7], s22 offen lds
    ds_read_b64_tr_b16 v[242:243], v4 offset:50688
    s_waitcnt lgkmcnt(6)
    v_mfma_f32_16x16x32_bf16 v[96:99], v[228:231], v[48:51], v[96:99]
    ds_read_b64_tr_b16 v[244:245], v5 offset:49696
    v_mfma_f32_16x16x32_bf16 v[100:103], v[228:231], v[52:55], v[100:103]
    ds_read_b64_tr_b16 v[246:247], v5 offset:50720
    s_waitcnt lgkmcnt(6)
    v_mfma_f32_16x16x32_bf16 v[104:107], v[232:235], v[48:51], v[104:107]
    s_add_u32 s22, s24, 0x382000
    s_add_u32 m0, s20, 0x14400
    s_nop 0
    buffer_load_dwordx4 v3, s[4:7], s22 offen lds
    ds_read_b64_tr_b16 v[224:225], v4 offset:49920
    v_mfma_f32_16x16x32_bf16 v[108:111], v[232:235], v[52:55], v[108:111]
    ds_read_b64_tr_b16 v[226:227], v4 offset:50944
    s_waitcnt lgkmcnt(6)
    v_mfma_f32_16x16x32_bf16 v[112:115], v[236:239], v[48:51], v[112:115]
    ds_read_b64_tr_b16 v[228:229], v5 offset:49952
    v_mfma_f32_16x16x32_bf16 v[116:119], v[236:239], v[52:55], v[116:119]
    ds_read_b64_tr_b16 v[230:231], v5 offset:50976
    s_waitcnt lgkmcnt(6)
    v_mfma_f32_16x16x32_bf16 v[120:123], v[240:243], v[48:51], v[120:123]
    v_mfma_f32_16x16x32_bf16 v[124:127], v[240:243], v[52:55], v[124:127]
    s_waitcnt vmcnt(13)
    s_barrier
    ds_read_b64_tr_b16 v[232:233], v7 offset:0
    ds_read_b64_tr_b16 v[234:235], v7 offset:1024
    s_waitcnt lgkmcnt(6)
    v_mfma_f32_16x16x32_bf16 v[128:131], v[244:247], v[48:51], v[128:131]
    ds_read_b64_tr_b16 v[236:237], v8 offset:32
    s_mov_b32 s23, 0xe000
    buffer_load_dwordx4 v[40:43], v6, s[8:11], s23 offen offset:0 sc1
    v_mfma_f32_16x16x32_bf16 v[132:135], v[244:247], v[52:55], v[132:135]
    ds_read_b64_tr_b16 v[238:239], v8 offset:1056
    s_waitcnt lgkmcnt(6)
    v_mfma_f32_16x16x32_bf16 v[136:139], v[224:227], v[48:51], v[136:139]
    ds_read_b64_tr_b16 v[240:241], v7 offset:256
    v_mfma_f32_16x16x32_bf16 v[140:143], v[224:227], v[52:55], v[140:143]
    ds_read_b64_tr_b16 v[242:243], v7 offset:1280
    s_mov_b32 s23, 0x2e000
    buffer_load_dwordx4 v[44:47], v6, s[8:11], s23 offen offset:0 sc1
    s_waitcnt lgkmcnt(6)
    v_mfma_f32_16x16x32_bf16 v[144:147], v[228:231], v[48:51], v[144:147]
    ds_read_b64_tr_b16 v[244:245], v8 offset:288
    v_mfma_f32_16x16x32_bf16 v[148:151], v[228:231], v[52:55], v[148:151]
    ds_read_b64_tr_b16 v[246:247], v8 offset:1312
    s_waitcnt vmcnt(6)
    v_cmp_ne_u32 vcc, s28, v12
    s_cbranch_vccnz adaLN_cond__sliding_block_cached__moe_arch_mod__prompt_kernel_o218r
adaLN_cond__sliding_block_cached__moe_arch_mod__prompt_kernel_o218b:
    s_waitcnt lgkmcnt(6)
    v_mfma_f32_16x16x32_bf16 v[88:91], v[232:235], v[56:59], v[88:91]
    ds_read_b64_tr_b16 v[224:225], v7 offset:512
    v_mfma_f32_16x16x32_bf16 v[92:95], v[232:235], v[60:63], v[92:95]
    s_add_u32 s22, s24, 0x10000
    s_add_u32 m0, s20, 0x18000
    s_nop 0
    buffer_load_dwordx4 v3, s[4:7], s22 offen lds
    ds_read_b64_tr_b16 v[226:227], v7 offset:1536
    s_waitcnt lgkmcnt(6)
    v_mfma_f32_16x16x32_bf16 v[96:99], v[236:239], v[56:59], v[96:99]
    ds_read_b64_tr_b16 v[228:229], v8 offset:544
    v_mfma_f32_16x16x32_bf16 v[100:103], v[236:239], v[60:63], v[100:103]
    ds_read_b64_tr_b16 v[230:231], v8 offset:1568
    s_waitcnt lgkmcnt(6)
    v_mfma_f32_16x16x32_bf16 v[104:107], v[240:243], v[56:59], v[104:107]
    s_add_u32 s22, s24, 0x12000
    s_add_u32 m0, s20, 0x18400
    s_nop 0
    buffer_load_dwordx4 v3, s[4:7], s22 offen lds
    ds_read_b64_tr_b16 v[232:233], v7 offset:768
    v_mfma_f32_16x16x32_bf16 v[108:111], v[240:243], v[60:63], v[108:111]
    ds_read_b64_tr_b16 v[234:235], v7 offset:1792
    s_waitcnt lgkmcnt(6)
    v_mfma_f32_16x16x32_bf16 v[112:115], v[244:247], v[56:59], v[112:115]
    ds_read_b64_tr_b16 v[236:237], v8 offset:800
    v_mfma_f32_16x16x32_bf16 v[116:119], v[244:247], v[60:63], v[116:119]
    ds_read_b64_tr_b16 v[238:239], v8 offset:1824
    s_waitcnt lgkmcnt(6)
    v_mfma_f32_16x16x32_bf16 v[120:123], v[224:227], v[56:59], v[120:123]
    v_mfma_f32_16x16x32_bf16 v[124:127], v[224:227], v[60:63], v[124:127]
    s_barrier
    ds_read_b64_tr_b16 v[240:241], v7 offset:16384
    ds_read_b64_tr_b16 v[242:243], v7 offset:17408
    s_waitcnt lgkmcnt(6)
    v_mfma_f32_16x16x32_bf16 v[128:131], v[228:231], v[56:59], v[128:131]
    ds_read_b64_tr_b16 v[244:245], v8 offset:16416
    s_mov_b32 s23, 0x0
    buffer_load_dwordx4 v[48:51], v6, s[8:11], s23 offen offset:1024 sc1
    v_mfma_f32_16x16x32_bf16 v[132:135], v[228:231], v[60:63], v[132:135]
    ds_read_b64_tr_b16 v[246:247], v8 offset:17440
    s_waitcnt lgkmcnt(6)
    v_mfma_f32_16x16x32_bf16 v[136:139], v[232:235], v[56:59], v[136:139]
    ds_read_b64_tr_b16 v[224:225], v7 offset:16640
    v_mfma_f32_16x16x32_bf16 v[140:143], v[232:235], v[60:63], v[140:143]
    ds_read_b64_tr_b16 v[226:227], v7 offset:17664
    s_mov_b32 s23, 0x20000
    buffer_load_dwordx4 v[52:55], v6, s[8:11], s23 offen offset:1024 sc1
    s_waitcnt lgkmcnt(6)
    v_mfma_f32_16x16x32_bf16 v[144:147], v[236:239], v[56:59], v[144:147]
    ds_read_b64_tr_b16 v[228:229], v8 offset:16672
    v_mfma_f32_16x16x32_bf16 v[148:151], v[236:239], v[60:63], v[148:151]
    ds_read_b64_tr_b16 v[230:231], v8 offset:17696
    s_waitcnt lgkmcnt(6)
    v_mfma_f32_16x16x32_bf16 v[88:91], v[240:243], v[24:27], v[88:91]
    ds_read_b64_tr_b16 v[232:233], v7 offset:16896
    v_mfma_f32_16x16x32_bf16 v[92:95], v[240:243], v[28:31], v[92:95]
    s_add_u32 s22, s24, 0x90000
    s_add_u32 m0, s20, 0x1c000
    s_nop 0
    buffer_load_dwordx4 v3, s[4:7], s22 offen lds
    ds_read_b64_tr_b16 v[234:235], v7 offset:17920
    s_waitcnt lgkmcnt(6)
    v_mfma_f32_16x16x32_bf16 v[96:99], v[244:247], v[24:27], v[96:99]
    ds_read_b64_tr_b16 v[236:237], v8 offset:16928
    v_mfma_f32_16x16x32_bf16 v[100:103], v[244:247], v[28:31], v[100:103]
    ds_read_b64_tr_b16 v[238:239], v8 offset:17952
    s_waitcnt lgkmcnt(6)
    v_mfma_f32_16x16x32_bf16 v[104:107], v[224:227], v[24:27], v[104:107]
    s_add_u32 s22, s24, 0x92000
    s_add_u32 m0, s20, 0x1c400
    s_nop 0
    buffer_load_dwordx4 v3, s[4:7], s22 offen lds
    ds_read_b64_tr_b16 v[240:241], v7 offset:17152
    v_mfma_f32_16x16x32_bf16 v[108:111], v[224:227], v[28:31], v[108:111]
    ds_read_b64_tr_b16 v[242:243], v7 offset:18176
    s_waitcnt lgkmcnt(6)
    v_mfma_f32_16x16x32_bf16 v[112:115], v[228:231], v[24:27], v[112:115]
    ds_read_b64_tr_b16 v[244:245], v8 offset:17184
    v_mfma_f32_16x16x32_bf16 v[116:119], v[228:231], v[28:31], v[116:119]
    ds_read_b64_tr_b16 v[246:247], v8 offset:18208
    s_waitcnt lgkmcnt(6)
    v_mfma_f32_16x16x32_bf16 v[120:123], v[232:235], v[24:27], v[120:123]
    v_mfma_f32_16x16x32_bf16 v[124:127], v[232:235], v[28:31], v[124:127]
    s_barrier
    ds_read_b64_tr_b16 v[224:225], v4 offset:0
    ds_read_b64_tr_b16 v[226:227], v4 offset:1024
    s_waitcnt lgkmcnt(6)
    v_mfma_f32_16x16x32_bf16 v[128:131], v[236:239], v[24:27], v[128:131]
    s_add_u32 s16, s63, 0x576000
    v_mov_b32 v14, s28
    v_mov_b32 v15, 0
    s_mov_b64 exec, 1
    buffer_store_dword v14, v15, s[8:11], s16 offen sc1
    s_mov_b64 exec, -1
    ds_read_b64_tr_b16 v[228:229], v5 offset:32
    s_mov_b32 s23, 0x2000
    buffer_load_dwordx4 v[56:59], v6, s[8:11], s23 offen offset:1024 sc1
    v_mfma_f32_16x16x32_bf16 v[132:135], v[236:239], v[28:31], v[132:135]
    ds_read_b64_tr_b16 v[230:231], v5 offset:1056
    s_waitcnt lgkmcnt(6)
    v_mfma_f32_16x16x32_bf16 v[136:139], v[240:243], v[24:27], v[136:139]
    ds_read_b64_tr_b16 v[232:233], v4 offset:256
    v_mfma_f32_16x16x32_bf16 v[140:143], v[240:243], v[28:31], v[140:143]
    ds_read_b64_tr_b16 v[234:235], v4 offset:1280
    s_mov_b32 s23, 0x22000
    buffer_load_dwordx4 v[60:63], v6, s[8:11], s23 offen offset:1024 sc1
    s_waitcnt lgkmcnt(6)
    v_mfma_f32_16x16x32_bf16 v[144:147], v[244:247], v[24:27], v[144:147]
    ds_read_b64_tr_b16 v[236:237], v5 offset:288
    v_mfma_f32_16x16x32_bf16 v[148:151], v[244:247], v[28:31], v[148:151]
    ds_read_b64_tr_b16 v[238:239], v5 offset:1312
    s_waitcnt vmcnt(14) lgkmcnt(6)
    v_mfma_f32_16x16x32_bf16 v[88:91], v[224:227], v[32:35], v[88:91]
    ds_read_b64_tr_b16 v[240:241], v4 offset:512
    s_waitcnt vmcnt(13)
    v_mfma_f32_16x16x32_bf16 v[92:95], v[224:227], v[36:39], v[92:95]
    s_add_u32 s22, s24, 0x110000
    s_add_u32 m0, s20, 0x20000
    s_nop 0
    buffer_load_dwordx4 v3, s[4:7], s22 offen lds
    ds_read_b64_tr_b16 v[242:243], v4 offset:1536
    s_waitcnt lgkmcnt(6)
    v_mfma_f32_16x16x32_bf16 v[96:99], v[228:231], v[32:35], v[96:99]
    ds_read_b64_tr_b16 v[244:245], v5 offset:544
    v_mfma_f32_16x16x32_bf16 v[100:103], v[228:231], v[36:39], v[100:103]
    ds_read_b64_tr_b16 v[246:247], v5 offset:1568
    s_waitcnt lgkmcnt(6)
    v_mfma_f32_16x16x32_bf16 v[104:107], v[232:235], v[32:35], v[104:107]
    s_add_u32 s22, s24, 0x112000
    s_add_u32 m0, s20, 0x20400
    s_nop 0
    buffer_load_dwordx4 v3, s[4:7], s22 offen lds
    ds_read_b64_tr_b16 v[224:225], v4 offset:768
    v_mfma_f32_16x16x32_bf16 v[108:111], v[232:235], v[36:39], v[108:111]
    ds_read_b64_tr_b16 v[226:227], v4 offset:1792
    s_waitcnt lgkmcnt(6)
    v_mfma_f32_16x16x32_bf16 v[112:115], v[236:239], v[32:35], v[112:115]
    ds_read_b64_tr_b16 v[228:229], v5 offset:800
    v_mfma_f32_16x16x32_bf16 v[116:119], v[236:239], v[36:39], v[116:119]
    ds_read_b64_tr_b16 v[230:231], v5 offset:1824
    s_waitcnt lgkmcnt(6)
    v_mfma_f32_16x16x32_bf16 v[120:123], v[240:243], v[32:35], v[120:123]
    v_mfma_f32_16x16x32_bf16 v[124:127], v[240:243], v[36:39], v[124:127]
    s_waitcnt vmcnt(13)
    s_barrier
    ds_read_b64_tr_b16 v[232:233], v4 offset:16384
    ds_read_b64_tr_b16 v[234:235], v4 offset:17408
    s_waitcnt lgkmcnt(6)
    v_mfma_f32_16x16x32_bf16 v[128:131], v[244:247], v[32:35], v[128:131]
    ds_read_b64_tr_b16 v[236:237], v5 offset:16416
    s_mov_b32 s23, 0x4000
    buffer_load_dwordx4 v[24:27], v6, s[8:11], s23 offen offset:1024 sc1
    v_mfma_f32_16x16x32_bf16 v[132:135], v[244:247], v[36:39], v[132:135]
    ds_read_b64_tr_b16 v[238:239], v5 offset:17440
    s_waitcnt lgkmcnt(6)
    v_mfma_f32_16x16x32_bf16 v[136:139], v[224:227], v[32:35], v[136:139]
    ds_read_b64_tr_b16 v[240:241], v4 offset:16640
    v_mfma_f32_16x16x32_bf16 v[140:143], v[224:227], v[36:39], v[140:143]
    ds_read_b64_tr_b16 v[242:243], v4 offset:17664
    s_mov_b32 s23, 0x24000
    buffer_load_dwordx4 v[28:31], v6, s[8:11], s23 offen offset:1024 sc1
    s_waitcnt lgkmcnt(6)
    v_mfma_f32_16x16x32_bf16 v[144:147], v[228:231], v[32:35], v[144:147]
    ds_read_b64_tr_b16 v[244:245], v5 offset:16672
    v_mfma_f32_16x16x32_bf16 v[148:151], v[228:231], v[36:39], v[148:151]
    ds_read_b64_tr_b16 v[246:247], v5 offset:17696
    s_waitcnt vmcnt(14) lgkmcnt(6)
    v_mfma_f32_16x16x32_bf16 v[88:91], v[232:235], v[40:43], v[88:91]
    ds_read_b64_tr_b16 v[224:225], v4 offset:16896
    s_waitcnt vmcnt(13)
    v_mfma_f32_16x16x32_bf16 v[92:95], v[232:235], v[44:47], v[92:95]
    s_add_u32 s22, s24, 0x190000
    s_add_u32 m0, s20, 0x24000
    s_nop 0
    buffer_load_dwordx4 v3, s[4:7], s22 offen lds
    ds_read_b64_tr_b16 v[226:227], v4 offset:17920
    s_waitcnt lgkmcnt(6)
    v_mfma_f32_16x16x32_bf16 v[96:99], v[236:239], v[40:43], v[96:99]
    ds_read_b64_tr_b16 v[228:229], v5 offset:16928
    v_mfma_f32_16x16x32_bf16 v[100:103], v[236:239], v[44:47], v[100:103]
    ds_read_b64_tr_b16 v[230:231], v5 offset:17952
    s_waitcnt lgkmcnt(6)
    v_mfma_f32_16x16x32_bf16 v[104:107], v[240:243], v[40:43], v[104:107]
    s_add_u32 s22, s24, 0x192000
    s_add_u32 m0, s20, 0x24400
    s_nop 0
    buffer_load_dwordx4 v3, s[4:7], s22 offen lds
    ds_read_b64_tr_b16 v[232:233], v4 offset:17152
    v_mfma_f32_16x16x32_bf16 v[108:111], v[240:243], v[44:47], v[108:111]
    ds_read_b64_tr_b16 v[234:235], v4 offset:18176
    s_waitcnt lgkmcnt(6)
    v_mfma_f32_16x16x32_bf16 v[112:115], v[244:247], v[40:43], v[112:115]
    ds_read_b64_tr_b16 v[236:237], v5 offset:17184
    v_mfma_f32_16x16x32_bf16 v[116:119], v[244:247], v[44:47], v[116:119]
    ds_read_b64_tr_b16 v[238:239], v5 offset:18208
    s_waitcnt lgkmcnt(6)
    v_mfma_f32_16x16x32_bf16 v[120:123], v[224:227], v[40:43], v[120:123]
    v_mfma_f32_16x16x32_bf16 v[124:127], v[224:227], v[44:47], v[124:127]
    s_waitcnt vmcnt(13)
    s_barrier
    ds_read_b64_tr_b16 v[240:241], v4 offset:32768
    ds_read_b64_tr_b16 v[242:243], v4 offset:33792
    s_waitcnt lgkmcnt(6)
    v_mfma_f32_16x16x32_bf16 v[128:131], v[228:231], v[40:43], v[128:131]
    ds_read_b64_tr_b16 v[244:245], v5 offset:32800
    s_mov_b32 s23, 0x6000
    buffer_load_dwordx4 v[32:35], v6, s[8:11], s23 offen offset:1024 sc1
    v_mfma_f32_16x16x32_bf16 v[132:135], v[228:231], v[44:47], v[132:135]
    ds_read_b64_tr_b16 v[246:247], v5 offset:33824
    s_waitcnt lgkmcnt(6)
    v_mfma_f32_16x16x32_bf16 v[136:139], v[232:235], v[40:43], v[136:139]
    ds_read_b64_tr_b16 v[224:225], v4 offset:33024
    v_mfma_f32_16x16x32_bf16 v[140:143], v[232:235], v[44:47], v[140:143]
    ds_read_b64_tr_b16 v[226:227], v4 offset:34048
    s_mov_b32 s23, 0x26000
    buffer_load_dwordx4 v[36:39], v6, s[8:11], s23 offen offset:1024 sc1
    s_waitcnt lgkmcnt(6)
    v_mfma_f32_16x16x32_bf16 v[144:147], v[236:239], v[40:43], v[144:147]
    ds_read_b64_tr_b16 v[228:229], v5 offset:33056
    v_mfma_f32_16x16x32_bf16 v[148:151], v[236:239], v[44:47], v[148:151]
    ds_read_b64_tr_b16 v[230:231], v5 offset:34080
    s_waitcnt vmcnt(14) lgkmcnt(6)
    v_mfma_f32_16x16x32_bf16 v[88:91], v[240:243], v[48:51], v[88:91]
    ds_read_b64_tr_b16 v[232:233], v4 offset:33280
    s_waitcnt vmcnt(13)
    v_mfma_f32_16x16x32_bf16 v[92:95], v[240:243], v[52:55], v[92:95]
    s_add_u32 s22, s24, 0x210000
    s_add_u32 m0, s20, 0x10000
    s_nop 0
    buffer_load_dwordx4 v3, s[4:7], s22 offen lds
    ds_read_b64_tr_b16 v[234:235], v4 offset:34304
    s_waitcnt lgkmcnt(6)
    v_mfma_f32_16x16x32_bf16 v[96:99], v[244:247], v[48:51], v[96:99]
    ds_read_b64_tr_b16 v[236:237], v5 offset:33312
    v_mfma_f32_16x16x32_bf16 v[100:103], v[244:247], v[52:55], v[100:103]
    ds_read_b64_tr_b16 v[238:239], v5 offset:34336
    s_waitcnt lgkmcnt(6)
    v_mfma_f32_16x16x32_bf16 v[104:107], v[224:227], v[48:51], v[104:107]
    s_add_u32 s22, s24, 0x212000
    s_add_u32 m0, s20, 0x10400
    s_nop 0
    buffer_load_dwordx4 v3, s[4:7], s22 offen lds
    ds_read_b64_tr_b16 v[240:241], v4 offset:33536
    v_mfma_f32_16x16x32_bf16 v[108:111], v[224:227], v[52:55], v[108:111]
    ds_read_b64_tr_b16 v[242:243], v4 offset:34560
    s_waitcnt lgkmcnt(6)
    v_mfma_f32_16x16x32_bf16 v[112:115], v[228:231], v[48:51], v[112:115]
    ds_read_b64_tr_b16 v[244:245], v5 offset:33568
    v_mfma_f32_16x16x32_bf16 v[116:119], v[228:231], v[52:55], v[116:119]
    ds_read_b64_tr_b16 v[246:247], v5 offset:34592
    s_waitcnt lgkmcnt(6)
    v_mfma_f32_16x16x32_bf16 v[120:123], v[232:235], v[48:51], v[120:123]
    v_mfma_f32_16x16x32_bf16 v[124:127], v[232:235], v[52:55], v[124:127]
    s_waitcnt vmcnt(13)
    s_barrier
    ds_read_b64_tr_b16 v[224:225], v4 offset:49152
    ds_read_b64_tr_b16 v[226:227], v4 offset:50176
    s_waitcnt lgkmcnt(6)
    v_mfma_f32_16x16x32_bf16 v[128:131], v[236:239], v[48:51], v[128:131]
    ds_read_b64_tr_b16 v[228:229], v5 offset:49184
    s_mov_b32 s23, 0x8000
    buffer_load_dwordx4 v[40:43], v6, s[8:11], s23 offen offset:1024 sc1
    v_mfma_f32_16x16x32_bf16 v[132:135], v[236:239], v[52:55], v[132:135]
    ds_read_b64_tr_b16 v[230:231], v5 offset:50208
    s_waitcnt lgkmcnt(6)
    v_mfma_f32_16x16x32_bf16 v[136:139], v[240:243], v[48:51], v[136:139]
    ds_read_b64_tr_b16 v[232:233], v4 offset:49408
    v_mfma_f32_16x16x32_bf16 v[140:143], v[240:243], v[52:55], v[140:143]
    ds_read_b64_tr_b16 v[234:235], v4 offset:50432
    s_mov_b32 s23, 0x28000
    buffer_load_dwordx4 v[44:47], v6, s[8:11], s23 offen offset:1024 sc1
    s_waitcnt lgkmcnt(6)
    v_mfma_f32_16x16x32_bf16 v[144:147], v[244:247], v[48:51], v[144:147]
    ds_read_b64_tr_b16 v[236:237], v5 offset:49440
    v_mfma_f32_16x16x32_bf16 v[148:151], v[244:247], v[52:55], v[148:151]
    ds_read_b64_tr_b16 v[238:239], v5 offset:50464
    s_waitcnt vmcnt(13) lgkmcnt(6)
    v_mfma_f32_16x16x32_bf16 v[88:91], v[224:227], v[56:59], v[88:91]
    ds_read_b64_tr_b16 v[240:241], v4 offset:49664
    s_waitcnt vmcnt(12)
    v_mfma_f32_16x16x32_bf16 v[92:95], v[224:227], v[60:63], v[92:95]
    s_add_u32 s22, s24, 0x290000
    s_add_u32 m0, s20, 0x14000
    s_nop 0
    buffer_load_dwordx4 v3, s[4:7], s22 offen lds
    ds_read_b64_tr_b16 v[242:243], v4 offset:50688
    s_waitcnt lgkmcnt(6)
    v_mfma_f32_16x16x32_bf16 v[96:99], v[228:231], v[56:59], v[96:99]
    ds_read_b64_tr_b16 v[244:245], v5 offset:49696
    v_mfma_f32_16x16x32_bf16 v[100:103], v[228:231], v[60:63], v[100:103]
    ds_read_b64_tr_b16 v[246:247], v5 offset:50720
    s_waitcnt lgkmcnt(6)
    v_mfma_f32_16x16x32_bf16 v[104:107], v[232:235], v[56:59], v[104:107]
    s_add_u32 s22, s24, 0x292000
    s_add_u32 m0, s20, 0x14400
    s_nop 0
    buffer_load_dwordx4 v3, s[4:7], s22 offen lds
    ds_read_b64_tr_b16 v[224:225], v4 offset:49920
    v_mfma_f32_16x16x32_bf16 v[108:111], v[232:235], v[60:63], v[108:111]
    ds_read_b64_tr_b16 v[226:227], v4 offset:50944
    s_waitcnt lgkmcnt(6)
    v_mfma_f32_16x16x32_bf16 v[112:115], v[236:239], v[56:59], v[112:115]
    ds_read_b64_tr_b16 v[228:229], v5 offset:49952
    v_mfma_f32_16x16x32_bf16 v[116:119], v[236:239], v[60:63], v[116:119]
    ds_read_b64_tr_b16 v[230:231], v5 offset:50976
    s_waitcnt lgkmcnt(6)
    v_mfma_f32_16x16x32_bf16 v[120:123], v[240:243], v[56:59], v[120:123]
    v_mfma_f32_16x16x32_bf16 v[124:127], v[240:243], v[60:63], v[124:127]
    s_waitcnt vmcnt(12)
    s_barrier
    ds_read_b64_tr_b16 v[232:233], v7 offset:0
    ds_read_b64_tr_b16 v[234:235], v7 offset:1024
    s_waitcnt lgkmcnt(6)
    v_mfma_f32_16x16x32_bf16 v[128:131], v[244:247], v[56:59], v[128:131]
    ds_read_b64_tr_b16 v[236:237], v8 offset:32
    s_mov_b32 s23, 0xa000
    buffer_load_dwordx4 v[48:51], v6, s[8:11], s23 offen offset:1024 sc1
    v_mfma_f32_16x16x32_bf16 v[132:135], v[244:247], v[60:63], v[132:135]
    ds_read_b64_tr_b16 v[238:239], v8 offset:1056
    s_waitcnt lgkmcnt(6)
    v_mfma_f32_16x16x32_bf16 v[136:139], v[224:227], v[56:59], v[136:139]
    ds_read_b64_tr_b16 v[240:241], v7 offset:256
    v_mfma_f32_16x16x32_bf16 v[140:143], v[224:227], v[60:63], v[140:143]
    ds_read_b64_tr_b16 v[242:243], v7 offset:1280
    s_mov_b32 s23, 0x2a000
    buffer_load_dwordx4 v[52:55], v6, s[8:11], s23 offen offset:1024 sc1
    s_waitcnt lgkmcnt(6)
    v_mfma_f32_16x16x32_bf16 v[144:147], v[228:231], v[56:59], v[144:147]
    ds_read_b64_tr_b16 v[244:245], v8 offset:288
    v_mfma_f32_16x16x32_bf16 v[148:151], v[228:231], v[60:63], v[148:151]
    ds_read_b64_tr_b16 v[246:247], v8 offset:1312
    s_waitcnt vmcnt(13) lgkmcnt(6)
    v_mfma_f32_16x16x32_bf16 v[88:91], v[232:235], v[24:27], v[88:91]
    ds_read_b64_tr_b16 v[224:225], v7 offset:512
    s_waitcnt vmcnt(12)
    v_mfma_f32_16x16x32_bf16 v[92:95], v[232:235], v[28:31], v[92:95]
    s_add_u32 s22, s24, 0x310000
    s_add_u32 m0, s20, 0x18000
    s_nop 0
    buffer_load_dwordx4 v3, s[4:7], s22 offen lds
    ds_read_b64_tr_b16 v[226:227], v7 offset:1536
    s_waitcnt lgkmcnt(6)
    v_mfma_f32_16x16x32_bf16 v[96:99], v[236:239], v[24:27], v[96:99]
    ds_read_b64_tr_b16 v[228:229], v8 offset:544
    v_mfma_f32_16x16x32_bf16 v[100:103], v[236:239], v[28:31], v[100:103]
    ds_read_b64_tr_b16 v[230:231], v8 offset:1568
    s_waitcnt lgkmcnt(6)
    v_mfma_f32_16x16x32_bf16 v[104:107], v[240:243], v[24:27], v[104:107]
    s_add_u32 s22, s24, 0x312000
    s_add_u32 m0, s20, 0x18400
    s_nop 0
    buffer_load_dwordx4 v3, s[4:7], s22 offen lds
    ds_read_b64_tr_b16 v[232:233], v7 offset:768
    v_mfma_f32_16x16x32_bf16 v[108:111], v[240:243], v[28:31], v[108:111]
    ds_read_b64_tr_b16 v[234:235], v7 offset:1792
    s_waitcnt lgkmcnt(6)
    v_mfma_f32_16x16x32_bf16 v[112:115], v[244:247], v[24:27], v[112:115]
    ds_read_b64_tr_b16 v[236:237], v8 offset:800
    v_mfma_f32_16x16x32_bf16 v[116:119], v[244:247], v[28:31], v[116:119]
    ds_read_b64_tr_b16 v[238:239], v8 offset:1824
    s_waitcnt lgkmcnt(6)
    v_mfma_f32_16x16x32_bf16 v[120:123], v[224:227], v[24:27], v[120:123]
    v_mfma_f32_16x16x32_bf16 v[124:127], v[224:227], v[28:31], v[124:127]
    s_waitcnt vmcnt(12)
    s_barrier
    ds_read_b64_tr_b16 v[240:241], v7 offset:16384
    ds_read_b64_tr_b16 v[242:243], v7 offset:17408
    s_add_u32 s19, s19, 8192
    buffer_load_dword v12, v13, s[8:11], s19 offen sc1
    s_waitcnt lgkmcnt(6)
    v_mfma_f32_16x16x32_bf16 v[128:131], v[228:231], v[24:27], v[128:131]
    ds_read_b64_tr_b16 v[244:245], v8 offset:16416
    s_mov_b32 s23, 0xc000
    buffer_load_dwordx4 v[56:59], v6, s[8:11], s23 offen offset:1024 sc1
    v_mfma_f32_16x16x32_bf16 v[132:135], v[228:231], v[28:31], v[132:135]
    ds_read_b64_tr_b16 v[246:247], v8 offset:17440
    s_waitcnt lgkmcnt(6)
    v_mfma_f32_16x16x32_bf16 v[136:139], v[232:235], v[24:27], v[136:139]
    ds_read_b64_tr_b16 v[224:225], v7 offset:16640
    v_mfma_f32_16x16x32_bf16 v[140:143], v[232:235], v[28:31], v[140:143]
    ds_read_b64_tr_b16 v[226:227], v7 offset:17664
    s_mov_b32 s23, 0x2c000
    buffer_load_dwordx4 v[60:63], v6, s[8:11], s23 offen offset:1024 sc1
    s_waitcnt lgkmcnt(6)
    v_mfma_f32_16x16x32_bf16 v[144:147], v[236:239], v[24:27], v[144:147]
    ds_read_b64_tr_b16 v[228:229], v8 offset:16672
    v_mfma_f32_16x16x32_bf16 v[148:151], v[236:239], v[28:31], v[148:151]
    ds_read_b64_tr_b16 v[230:231], v8 offset:17696
    s_waitcnt vmcnt(14) lgkmcnt(6)
    v_mfma_f32_16x16x32_bf16 v[88:91], v[240:243], v[32:35], v[88:91]
    ds_read_b64_tr_b16 v[232:233], v7 offset:16896
    s_waitcnt vmcnt(13)
    v_mfma_f32_16x16x32_bf16 v[92:95], v[240:243], v[36:39], v[92:95]
    s_add_u32 s22, s24, 0x390000
    s_add_u32 m0, s20, 0x1c000
    s_nop 0
    buffer_load_dwordx4 v3, s[4:7], s22 offen lds
    ds_read_b64_tr_b16 v[234:235], v7 offset:17920
    s_waitcnt lgkmcnt(6)
    v_mfma_f32_16x16x32_bf16 v[96:99], v[244:247], v[32:35], v[96:99]
    ds_read_b64_tr_b16 v[236:237], v8 offset:16928
    v_mfma_f32_16x16x32_bf16 v[100:103], v[244:247], v[36:39], v[100:103]
    ds_read_b64_tr_b16 v[238:239], v8 offset:17952
    s_waitcnt lgkmcnt(6)
    v_mfma_f32_16x16x32_bf16 v[104:107], v[224:227], v[32:35], v[104:107]
    s_add_u32 s22, s24, 0x392000
    s_add_u32 m0, s20, 0x1c400
    s_nop 0
    buffer_load_dwordx4 v3, s[4:7], s22 offen lds
    ds_read_b64_tr_b16 v[240:241], v7 offset:17152
    v_mfma_f32_16x16x32_bf16 v[108:111], v[224:227], v[36:39], v[108:111]
    ds_read_b64_tr_b16 v[242:243], v7 offset:18176
    s_waitcnt lgkmcnt(6)
    v_mfma_f32_16x16x32_bf16 v[112:115], v[228:231], v[32:35], v[112:115]
    ds_read_b64_tr_b16 v[244:245], v8 offset:17184
    v_mfma_f32_16x16x32_bf16 v[116:119], v[228:231], v[36:39], v[116:119]
    ds_read_b64_tr_b16 v[246:247], v8 offset:18208
    s_waitcnt lgkmcnt(6)
    v_mfma_f32_16x16x32_bf16 v[120:123], v[232:235], v[32:35], v[120:123]
    v_mfma_f32_16x16x32_bf16 v[124:127], v[232:235], v[36:39], v[124:127]
    s_waitcnt vmcnt(13)
    s_barrier
    ds_read_b64_tr_b16 v[224:225], v4 offset:0
    ds_read_b64_tr_b16 v[226:227], v4 offset:1024
    s_waitcnt lgkmcnt(6)
    v_mfma_f32_16x16x32_bf16 v[128:131], v[236:239], v[32:35], v[128:131]
    ds_read_b64_tr_b16 v[228:229], v5 offset:32
    s_mov_b32 s23, 0xe000
    buffer_load_dwordx4 v[24:27], v6, s[8:11], s23 offen offset:1024 sc1
    v_mfma_f32_16x16x32_bf16 v[132:135], v[236:239], v[36:39], v[132:135]
    ds_read_b64_tr_b16 v[230:231], v5 offset:1056
    s_waitcnt lgkmcnt(6)
    v_mfma_f32_16x16x32_bf16 v[136:139], v[240:243], v[32:35], v[136:139]
    ds_read_b64_tr_b16 v[232:233], v4 offset:256
    v_mfma_f32_16x16x32_bf16 v[140:143], v[240:243], v[36:39], v[140:143]
    ds_read_b64_tr_b16 v[234:235], v4 offset:1280
    s_mov_b32 s23, 0x2e000
    buffer_load_dwordx4 v[28:31], v6, s[8:11], s23 offen offset:1024 sc1
    s_waitcnt lgkmcnt(6)
    v_mfma_f32_16x16x32_bf16 v[144:147], v[244:247], v[32:35], v[144:147]
    ds_read_b64_tr_b16 v[236:237], v5 offset:288
    v_mfma_f32_16x16x32_bf16 v[148:151], v[244:247], v[36:39], v[148:151]
    ds_read_b64_tr_b16 v[238:239], v5 offset:1312
    s_waitcnt vmcnt(6)
    v_cmp_ne_u32 vcc, s28, v12
    s_cbranch_vccnz adaLN_cond__sliding_block_cached__moe_arch_mod__prompt_kernel_o219r
adaLN_cond__sliding_block_cached__moe_arch_mod__prompt_kernel_o219b:
    s_waitcnt lgkmcnt(6)
    v_mfma_f32_16x16x32_bf16 v[88:91], v[224:227], v[40:43], v[88:91]
    ds_read_b64_tr_b16 v[240:241], v4 offset:512
    v_mfma_f32_16x16x32_bf16 v[92:95], v[224:227], v[44:47], v[92:95]
    s_add_u32 s22, s24, 0x20000
    s_add_u32 m0, s20, 0x20000
    s_nop 0
    buffer_load_dwordx4 v3, s[4:7], s22 offen lds
    ds_read_b64_tr_b16 v[242:243], v4 offset:1536
    s_waitcnt lgkmcnt(6)
    v_mfma_f32_16x16x32_bf16 v[96:99], v[228:231], v[40:43], v[96:99]
    ds_read_b64_tr_b16 v[244:245], v5 offset:544
    v_mfma_f32_16x16x32_bf16 v[100:103], v[228:231], v[44:47], v[100:103]
    ds_read_b64_tr_b16 v[246:247], v5 offset:1568
    s_waitcnt lgkmcnt(6)
    v_mfma_f32_16x16x32_bf16 v[104:107], v[232:235], v[40:43], v[104:107]
    s_add_u32 s22, s24, 0x22000
    s_add_u32 m0, s20, 0x20400
    s_nop 0
    buffer_load_dwordx4 v3, s[4:7], s22 offen lds
    ds_read_b64_tr_b16 v[224:225], v4 offset:768
    v_mfma_f32_16x16x32_bf16 v[108:111], v[232:235], v[44:47], v[108:111]
    ds_read_b64_tr_b16 v[226:227], v4 offset:1792
    s_waitcnt lgkmcnt(6)
    v_mfma_f32_16x16x32_bf16 v[112:115], v[236:239], v[40:43], v[112:115]
    ds_read_b64_tr_b16 v[228:229], v5 offset:800
    v_mfma_f32_16x16x32_bf16 v[116:119], v[236:239], v[44:47], v[116:119]
    ds_read_b64_tr_b16 v[230:231], v5 offset:1824
    s_waitcnt lgkmcnt(6)
    v_mfma_f32_16x16x32_bf16 v[120:123], v[240:243], v[40:43], v[120:123]
    v_mfma_f32_16x16x32_bf16 v[124:127], v[240:243], v[44:47], v[124:127]
    s_barrier
    ds_read_b64_tr_b16 v[232:233], v4 offset:16384
    ds_read_b64_tr_b16 v[234:235], v4 offset:17408
    s_waitcnt lgkmcnt(6)
    v_mfma_f32_16x16x32_bf16 v[128:131], v[244:247], v[40:43], v[128:131]
    ds_read_b64_tr_b16 v[236:237], v5 offset:16416
    s_mov_b32 s23, 0x0
    buffer_load_dwordx4 v[32:35], v6, s[8:11], s23 offen offset:2048 sc1
    v_mfma_f32_16x16x32_bf16 v[132:135], v[244:247], v[44:47], v[132:135]
    ds_read_b64_tr_b16 v[238:239], v5 offset:17440
    s_waitcnt lgkmcnt(6)
    v_mfma_f32_16x16x32_bf16 v[136:139], v[224:227], v[40:43], v[136:139]
    ds_read_b64_tr_b16 v[240:241], v4 offset:16640
    v_mfma_f32_16x16x32_bf16 v[140:143], v[224:227], v[44:47], v[140:143]
    ds_read_b64_tr_b16 v[242:243], v4 offset:17664
    s_mov_b32 s23, 0x20000
    buffer_load_dwordx4 v[36:39], v6, s[8:11], s23 offen offset:2048 sc1
    s_waitcnt lgkmcnt(6)
    v_mfma_f32_16x16x32_bf16 v[144:147], v[228:231], v[40:43], v[144:147]
    ds_read_b64_tr_b16 v[244:245], v5 offset:16672
    v_mfma_f32_16x16x32_bf16 v[148:151], v[228:231], v[44:47], v[148:151]
    ds_read_b64_tr_b16 v[246:247], v5 offset:17696
    s_waitcnt lgkmcnt(6)
    v_mfma_f32_16x16x32_bf16 v[88:91], v[232:235], v[48:51], v[88:91]
    ds_read_b64_tr_b16 v[224:225], v4 offset:16896
    v_mfma_f32_16x16x32_bf16 v[92:95], v[232:235], v[52:55], v[92:95]
    s_add_u32 s22, s24, 0xa0000
    s_add_u32 m0, s20, 0x24000
    s_nop 0
    buffer_load_dwordx4 v3, s[4:7], s22 offen lds
    ds_read_b64_tr_b16 v[226:227], v4 offset:17920
    s_waitcnt lgkmcnt(6)
    v_mfma_f32_16x16x32_bf16 v[96:99], v[236:239], v[48:51], v[96:99]
    ds_read_b64_tr_b16 v[228:229], v5 offset:16928
    v_mfma_f32_16x16x32_bf16 v[100:103], v[236:239], v[52:55], v[100:103]
    ds_read_b64_tr_b16 v[230:231], v5 offset:17952
    s_waitcnt lgkmcnt(6)
    v_mfma_f32_16x16x32_bf16 v[104:107], v[240:243], v[48:51], v[104:107]
    s_add_u32 s22, s24, 0xa2000
    s_add_u32 m0, s20, 0x24400
    s_nop 0
    buffer_load_dwordx4 v3, s[4:7], s22 offen lds
    ds_read_b64_tr_b16 v[232:233], v4 offset:17152
    v_mfma_f32_16x16x32_bf16 v[108:111], v[240:243], v[52:55], v[108:111]
    ds_read_b64_tr_b16 v[234:235], v4 offset:18176
    s_waitcnt lgkmcnt(6)
    v_mfma_f32_16x16x32_bf16 v[112:115], v[244:247], v[48:51], v[112:115]
    ds_read_b64_tr_b16 v[236:237], v5 offset:17184
    v_mfma_f32_16x16x32_bf16 v[116:119], v[244:247], v[52:55], v[116:119]
    ds_read_b64_tr_b16 v[238:239], v5 offset:18208
    s_waitcnt lgkmcnt(6)
    v_mfma_f32_16x16x32_bf16 v[120:123], v[224:227], v[48:51], v[120:123]
    v_mfma_f32_16x16x32_bf16 v[124:127], v[224:227], v[52:55], v[124:127]
    s_barrier
    ds_read_b64_tr_b16 v[240:241], v4 offset:32768
    ds_read_b64_tr_b16 v[242:243], v4 offset:33792
    s_waitcnt lgkmcnt(6)
    v_mfma_f32_16x16x32_bf16 v[128:131], v[228:231], v[48:51], v[128:131]
    ds_read_b64_tr_b16 v[244:245], v5 offset:32800
    s_mov_b32 s23, 0x2000
    buffer_load_dwordx4 v[40:43], v6, s[8:11], s23 offen offset:2048 sc1
    v_mfma_f32_16x16x32_bf16 v[132:135], v[228:231], v[52:55], v[132:135]
    ds_read_b64_tr_b16 v[246:247], v5 offset:33824
    s_waitcnt lgkmcnt(6)
    v_mfma_f32_16x16x32_bf16 v[136:139], v[232:235], v[48:51], v[136:139]
    ds_read_b64_tr_b16 v[224:225], v4 offset:33024
    v_mfma_f32_16x16x32_bf16 v[140:143], v[232:235], v[52:55], v[140:143]
    ds_read_b64_tr_b16 v[226:227], v4 offset:34048
    s_mov_b32 s23, 0x22000
    buffer_load_dwordx4 v[44:47], v6, s[8:11], s23 offen offset:2048 sc1
    s_waitcnt lgkmcnt(6)
    v_mfma_f32_16x16x32_bf16 v[144:147], v[236:239], v[48:51], v[144:147]
    ds_read_b64_tr_b16 v[228:229], v5 offset:33056
    v_mfma_f32_16x16x32_bf16 v[148:151], v[236:239], v[52:55], v[148:151]
    ds_read_b64_tr_b16 v[230:231], v5 offset:34080
    s_waitcnt vmcnt(13) lgkmcnt(6)
    v_mfma_f32_16x16x32_bf16 v[88:91], v[240:243], v[56:59], v[88:91]
    ds_read_b64_tr_b16 v[232:233], v4 offset:33280
    s_waitcnt vmcnt(12)
    v_mfma_f32_16x16x32_bf16 v[92:95], v[240:243], v[60:63], v[92:95]
    s_add_u32 s22, s24, 0x120000
    s_add_u32 m0, s20, 0x10000
    s_nop 0
    buffer_load_dwordx4 v3, s[4:7], s22 offen lds
    ds_read_b64_tr_b16 v[234:235], v4 offset:34304
    s_waitcnt lgkmcnt(6)
    v_mfma_f32_16x16x32_bf16 v[96:99], v[244:247], v[56:59], v[96:99]
    ds_read_b64_tr_b16 v[236:237], v5 offset:33312
    v_mfma_f32_16x16x32_bf16 v[100:103], v[244:247], v[60:63], v[100:103]
    ds_read_b64_tr_b16 v[238:239], v5 offset:34336
    s_waitcnt lgkmcnt(6)
    v_mfma_f32_16x16x32_bf16 v[104:107], v[224:227], v[56:59], v[104:107]
    s_add_u32 s22, s24, 0x122000
    s_add_u32 m0, s20, 0x10400
    s_nop 0
    buffer_load_dwordx4 v3, s[4:7], s22 offen lds
    ds_read_b64_tr_b16 v[240:241], v4 offset:33536
    v_mfma_f32_16x16x32_bf16 v[108:111], v[224:227], v[60:63], v[108:111]
    ds_read_b64_tr_b16 v[242:243], v4 offset:34560
    s_waitcnt lgkmcnt(6)
    v_mfma_f32_16x16x32_bf16 v[112:115], v[228:231], v[56:59], v[112:115]
    ds_read_b64_tr_b16 v[244:245], v5 offset:33568
    v_mfma_f32_16x16x32_bf16 v[116:119], v[228:231], v[60:63], v[116:119]
    ds_read_b64_tr_b16 v[246:247], v5 offset:34592
    s_waitcnt lgkmcnt(6)
    v_mfma_f32_16x16x32_bf16 v[120:123], v[232:235], v[56:59], v[120:123]
    v_mfma_f32_16x16x32_bf16 v[124:127], v[232:235], v[60:63], v[124:127]
    s_waitcnt vmcnt(12)
    s_barrier
    ds_read_b64_tr_b16 v[224:225], v4 offset:49152
    ds_read_b64_tr_b16 v[226:227], v4 offset:50176
    s_waitcnt lgkmcnt(6)
    v_mfma_f32_16x16x32_bf16 v[128:131], v[236:239], v[56:59], v[128:131]
    ds_read_b64_tr_b16 v[228:229], v5 offset:49184
    s_mov_b32 s23, 0x4000
    buffer_load_dwordx4 v[48:51], v6, s[8:11], s23 offen offset:2048 sc1
    v_mfma_f32_16x16x32_bf16 v[132:135], v[236:239], v[60:63], v[132:135]
    ds_read_b64_tr_b16 v[230:231], v5 offset:50208
    s_waitcnt lgkmcnt(6)
    v_mfma_f32_16x16x32_bf16 v[136:139], v[240:243], v[56:59], v[136:139]
    ds_read_b64_tr_b16 v[232:233], v4 offset:49408
    v_mfma_f32_16x16x32_bf16 v[140:143], v[240:243], v[60:63], v[140:143]
    ds_read_b64_tr_b16 v[234:235], v4 offset:50432
    s_mov_b32 s23, 0x24000
    buffer_load_dwordx4 v[52:55], v6, s[8:11], s23 offen offset:2048 sc1
    s_waitcnt lgkmcnt(6)
    v_mfma_f32_16x16x32_bf16 v[144:147], v[244:247], v[56:59], v[144:147]
    ds_read_b64_tr_b16 v[236:237], v5 offset:49440
    v_mfma_f32_16x16x32_bf16 v[148:151], v[244:247], v[60:63], v[148:151]
    ds_read_b64_tr_b16 v[238:239], v5 offset:50464
    s_waitcnt vmcnt(13) lgkmcnt(6)
    v_mfma_f32_16x16x32_bf16 v[88:91], v[224:227], v[24:27], v[88:91]
    ds_read_b64_tr_b16 v[240:241], v4 offset:49664
    s_waitcnt vmcnt(12)
    v_mfma_f32_16x16x32_bf16 v[92:95], v[224:227], v[28:31], v[92:95]
    s_add_u32 s22, s24, 0x1a0000
    s_add_u32 m0, s20, 0x14000
    s_nop 0
    buffer_load_dwordx4 v3, s[4:7], s22 offen lds
    ds_read_b64_tr_b16 v[242:243], v4 offset:50688
    s_waitcnt lgkmcnt(6)
    v_mfma_f32_16x16x32_bf16 v[96:99], v[228:231], v[24:27], v[96:99]
    ds_read_b64_tr_b16 v[244:245], v5 offset:49696
    v_mfma_f32_16x16x32_bf16 v[100:103], v[228:231], v[28:31], v[100:103]
    ds_read_b64_tr_b16 v[246:247], v5 offset:50720
    s_waitcnt lgkmcnt(6)
    v_mfma_f32_16x16x32_bf16 v[104:107], v[232:235], v[24:27], v[104:107]
    s_add_u32 s22, s24, 0x1a2000
    s_add_u32 m0, s20, 0x14400
    s_nop 0
    buffer_load_dwordx4 v3, s[4:7], s22 offen lds
    ds_read_b64_tr_b16 v[224:225], v4 offset:49920
    v_mfma_f32_16x16x32_bf16 v[108:111], v[232:235], v[28:31], v[108:111]
    ds_read_b64_tr_b16 v[226:227], v4 offset:50944
    s_waitcnt lgkmcnt(6)
    v_mfma_f32_16x16x32_bf16 v[112:115], v[236:239], v[24:27], v[112:115]
    ds_read_b64_tr_b16 v[228:229], v5 offset:49952
    v_mfma_f32_16x16x32_bf16 v[116:119], v[236:239], v[28:31], v[116:119]
    ds_read_b64_tr_b16 v[230:231], v5 offset:50976
    s_waitcnt lgkmcnt(6)
    v_mfma_f32_16x16x32_bf16 v[120:123], v[240:243], v[24:27], v[120:123]
    v_mfma_f32_16x16x32_bf16 v[124:127], v[240:243], v[28:31], v[124:127]
    s_waitcnt vmcnt(12)
    s_barrier
    ds_read_b64_tr_b16 v[232:233], v7 offset:0
    ds_read_b64_tr_b16 v[234:235], v7 offset:1024
    s_waitcnt lgkmcnt(6)
    v_mfma_f32_16x16x32_bf16 v[128:131], v[244:247], v[24:27], v[128:131]
    ds_read_b64_tr_b16 v[236:237], v8 offset:32
    s_mov_b32 s23, 0x6000
    buffer_load_dwordx4 v[56:59], v6, s[8:11], s23 offen offset:2048 sc1
    v_mfma_f32_16x16x32_bf16 v[132:135], v[244:247], v[28:31], v[132:135]
    ds_read_b64_tr_b16 v[238:239], v8 offset:1056
    s_waitcnt lgkmcnt(6)
    v_mfma_f32_16x16x32_bf16 v[136:139], v[224:227], v[24:27], v[136:139]
    ds_read_b64_tr_b16 v[240:241], v7 offset:256
    v_mfma_f32_16x16x32_bf16 v[140:143], v[224:227], v[28:31], v[140:143]
    ds_read_b64_tr_b16 v[242:243], v7 offset:1280
    s_mov_b32 s23, 0x26000
    buffer_load_dwordx4 v[60:63], v6, s[8:11], s23 offen offset:2048 sc1
    s_waitcnt lgkmcnt(6)
    v_mfma_f32_16x16x32_bf16 v[144:147], v[228:231], v[24:27], v[144:147]
    ds_read_b64_tr_b16 v[244:245], v8 offset:288
    v_mfma_f32_16x16x32_bf16 v[148:151], v[228:231], v[28:31], v[148:151]
    ds_read_b64_tr_b16 v[246:247], v8 offset:1312
    s_waitcnt vmcnt(13) lgkmcnt(6)
    v_mfma_f32_16x16x32_bf16 v[88:91], v[232:235], v[32:35], v[88:91]
    ds_read_b64_tr_b16 v[224:225], v7 offset:512
    s_waitcnt vmcnt(12)
    v_mfma_f32_16x16x32_bf16 v[92:95], v[232:235], v[36:39], v[92:95]
    s_add_u32 s22, s24, 0x220000
    s_add_u32 m0, s20, 0x18000
    s_nop 0
    buffer_load_dwordx4 v3, s[4:7], s22 offen lds
    ds_read_b64_tr_b16 v[226:227], v7 offset:1536
    s_waitcnt lgkmcnt(6)
    v_mfma_f32_16x16x32_bf16 v[96:99], v[236:239], v[32:35], v[96:99]
    ds_read_b64_tr_b16 v[228:229], v8 offset:544
    v_mfma_f32_16x16x32_bf16 v[100:103], v[236:239], v[36:39], v[100:103]
    ds_read_b64_tr_b16 v[230:231], v8 offset:1568
    s_waitcnt lgkmcnt(6)
    v_mfma_f32_16x16x32_bf16 v[104:107], v[240:243], v[32:35], v[104:107]
    s_add_u32 s22, s24, 0x222000
    s_add_u32 m0, s20, 0x18400
    s_nop 0
    buffer_load_dwordx4 v3, s[4:7], s22 offen lds
    ds_read_b64_tr_b16 v[232:233], v7 offset:768
    v_mfma_f32_16x16x32_bf16 v[108:111], v[240:243], v[36:39], v[108:111]
    ds_read_b64_tr_b16 v[234:235], v7 offset:1792
    s_mov_b32 s16, 0x544000
    buffer_load_dwordx4 v[184:187], v2, s[8:11], s16 offen sc1
    s_waitcnt lgkmcnt(6)
    v_mfma_f32_16x16x32_bf16 v[112:115], v[244:247], v[32:35], v[112:115]
    ds_read_b64_tr_b16 v[236:237], v8 offset:800
    v_mfma_f32_16x16x32_bf16 v[116:119], v[244:247], v[36:39], v[116:119]
    ds_read_b64_tr_b16 v[238:239], v8 offset:1824
    s_waitcnt lgkmcnt(6)
    v_mfma_f32_16x16x32_bf16 v[120:123], v[224:227], v[32:35], v[120:123]
    v_mfma_f32_16x16x32_bf16 v[124:127], v[224:227], v[36:39], v[124:127]
    s_waitcnt vmcnt(13)
    s_barrier
    ds_read_b64_tr_b16 v[240:241], v7 offset:16384
    ds_read_b64_tr_b16 v[242:243], v7 offset:17408
    s_waitcnt lgkmcnt(6)
    v_mfma_f32_16x16x32_bf16 v[128:131], v[228:231], v[32:35], v[128:131]
    ds_read_b64_tr_b16 v[244:245], v8 offset:16416
    s_mov_b32 s23, 0x8000
    buffer_load_dwordx4 v[24:27], v6, s[8:11], s23 offen offset:2048 sc1
    v_mfma_f32_16x16x32_bf16 v[132:135], v[228:231], v[36:39], v[132:135]
    ds_read_b64_tr_b16 v[246:247], v8 offset:17440
    s_waitcnt lgkmcnt(6)
    v_mfma_f32_16x16x32_bf16 v[136:139], v[232:235], v[32:35], v[136:139]
    ds_read_b64_tr_b16 v[224:225], v7 offset:16640
    v_mfma_f32_16x16x32_bf16 v[140:143], v[232:235], v[36:39], v[140:143]
    ds_read_b64_tr_b16 v[226:227], v7 offset:17664
    s_mov_b32 s23, 0x28000
    buffer_load_dwordx4 v[28:31], v6, s[8:11], s23 offen offset:2048 sc1
    s_waitcnt lgkmcnt(6)
    v_mfma_f32_16x16x32_bf16 v[144:147], v[236:239], v[32:35], v[144:147]
    ds_read_b64_tr_b16 v[228:229], v8 offset:16672
    v_mfma_f32_16x16x32_bf16 v[148:151], v[236:239], v[36:39], v[148:151]
    ds_read_b64_tr_b16 v[230:231], v8 offset:17696
    s_waitcnt vmcnt(14) lgkmcnt(6)
    v_mfma_f32_16x16x32_bf16 v[88:91], v[240:243], v[40:43], v[88:91]
    ds_read_b64_tr_b16 v[232:233], v7 offset:16896
    s_waitcnt vmcnt(13)
    v_mfma_f32_16x16x32_bf16 v[92:95], v[240:243], v[44:47], v[92:95]
    s_add_u32 s22, s24, 0x2a0000
    s_add_u32 m0, s20, 0x1c000
    s_nop 0
    buffer_load_dwordx4 v3, s[4:7], s22 offen lds
    ds_read_b64_tr_b16 v[234:235], v7 offset:17920
    s_waitcnt lgkmcnt(6)
    v_mfma_f32_16x16x32_bf16 v[96:99], v[244:247], v[40:43], v[96:99]
    ds_read_b64_tr_b16 v[236:237], v8 offset:16928
    v_mfma_f32_16x16x32_bf16 v[100:103], v[244:247], v[44:47], v[100:103]
    ds_read_b64_tr_b16 v[238:239], v8 offset:17952
    s_waitcnt lgkmcnt(6)
    v_mfma_f32_16x16x32_bf16 v[104:107], v[224:227], v[40:43], v[104:107]
    s_add_u32 s22, s24, 0x2a2000
    s_add_u32 m0, s20, 0x1c400
    s_nop 0
    buffer_load_dwordx4 v3, s[4:7], s22 offen lds
    ds_read_b64_tr_b16 v[240:241], v7 offset:17152
    v_mfma_f32_16x16x32_bf16 v[108:111], v[224:227], v[44:47], v[108:111]
    ds_read_b64_tr_b16 v[242:243], v7 offset:18176
    s_waitcnt lgkmcnt(6)
    v_mfma_f32_16x16x32_bf16 v[112:115], v[228:231], v[40:43], v[112:115]
    ds_read_b64_tr_b16 v[244:245], v8 offset:17184
    v_mfma_f32_16x16x32_bf16 v[116:119], v[228:231], v[44:47], v[116:119]
    ds_read_b64_tr_b16 v[246:247], v8 offset:18208
    s_waitcnt lgkmcnt(6)
    v_mfma_f32_16x16x32_bf16 v[120:123], v[232:235], v[40:43], v[120:123]
    v_mfma_f32_16x16x32_bf16 v[124:127], v[232:235], v[44:47], v[124:127]
    s_waitcnt vmcnt(13)
    s_barrier
    ds_read_b64_tr_b16 v[224:225], v4 offset:0
    ds_read_b64_tr_b16 v[226:227], v4 offset:1024
    s_waitcnt lgkmcnt(6)
    v_mfma_f32_16x16x32_bf16 v[128:131], v[236:239], v[40:43], v[128:131]
    ds_read_b64_tr_b16 v[228:229], v5 offset:32
    s_mov_b32 s23, 0xa000
    buffer_load_dwordx4 v[32:35], v6, s[8:11], s23 offen offset:2048 sc1
    v_mfma_f32_16x16x32_bf16 v[132:135], v[236:239], v[44:47], v[132:135]
    ds_read_b64_tr_b16 v[230:231], v5 offset:1056
    s_waitcnt lgkmcnt(6)
    v_mfma_f32_16x16x32_bf16 v[136:139], v[240:243], v[40:43], v[136:139]
    ds_read_b64_tr_b16 v[232:233], v4 offset:256
    v_mfma_f32_16x16x32_bf16 v[140:143], v[240:243], v[44:47], v[140:143]
    ds_read_b64_tr_b16 v[234:235], v4 offset:1280
    s_mov_b32 s23, 0x2a000
    buffer_load_dwordx4 v[36:39], v6, s[8:11], s23 offen offset:2048 sc1
    s_waitcnt lgkmcnt(6)
    v_mfma_f32_16x16x32_bf16 v[144:147], v[244:247], v[40:43], v[144:147]
    ds_read_b64_tr_b16 v[236:237], v5 offset:288
    v_mfma_f32_16x16x32_bf16 v[148:151], v[244:247], v[44:47], v[148:151]
    ds_read_b64_tr_b16 v[238:239], v5 offset:1312
    s_waitcnt vmcnt(14) lgkmcnt(6)
    v_mfma_f32_16x16x32_bf16 v[88:91], v[224:227], v[48:51], v[88:91]
    ds_read_b64_tr_b16 v[240:241], v4 offset:512
    s_waitcnt vmcnt(13)
    v_mfma_f32_16x16x32_bf16 v[92:95], v[224:227], v[52:55], v[92:95]
    s_add_u32 s22, s24, 0x320000
    s_add_u32 m0, s20, 0x20000
    s_nop 0
    buffer_load_dwordx4 v3, s[4:7], s22 offen lds
    ds_read_b64_tr_b16 v[242:243], v4 offset:1536
    s_waitcnt lgkmcnt(6)
    v_mfma_f32_16x16x32_bf16 v[96:99], v[228:231], v[48:51], v[96:99]
    ds_read_b64_tr_b16 v[244:245], v5 offset:544
    v_mfma_f32_16x16x32_bf16 v[100:103], v[228:231], v[52:55], v[100:103]
    ds_read_b64_tr_b16 v[246:247], v5 offset:1568
    s_waitcnt lgkmcnt(6)
    v_mfma_f32_16x16x32_bf16 v[104:107], v[232:235], v[48:51], v[104:107]
    s_add_u32 s22, s24, 0x322000
    s_add_u32 m0, s20, 0x20400
    s_nop 0
    buffer_load_dwordx4 v3, s[4:7], s22 offen lds
    ds_read_b64_tr_b16 v[224:225], v4 offset:768
    v_mfma_f32_16x16x32_bf16 v[108:111], v[232:235], v[52:55], v[108:111]
    ds_read_b64_tr_b16 v[226:227], v4 offset:1792
    s_waitcnt lgkmcnt(6)
    v_mfma_f32_16x16x32_bf16 v[112:115], v[236:239], v[48:51], v[112:115]
    ds_read_b64_tr_b16 v[228:229], v5 offset:800
    v_mfma_f32_16x16x32_bf16 v[116:119], v[236:239], v[52:55], v[116:119]
    ds_read_b64_tr_b16 v[230:231], v5 offset:1824
    s_waitcnt lgkmcnt(6)
    v_mfma_f32_16x16x32_bf16 v[120:123], v[240:243], v[48:51], v[120:123]
    v_mfma_f32_16x16x32_bf16 v[124:127], v[240:243], v[52:55], v[124:127]
    s_waitcnt vmcnt(13)
    s_barrier
    ds_read_b64_tr_b16 v[232:233], v4 offset:16384
    ds_read_b64_tr_b16 v[234:235], v4 offset:17408
    s_add_u32 s19, s19, 8192
    buffer_load_dword v12, v13, s[8:11], s19 offen sc1
    s_waitcnt lgkmcnt(6)
    v_mfma_f32_16x16x32_bf16 v[128:131], v[244:247], v[48:51], v[128:131]
    ds_read_b64_tr_b16 v[236:237], v5 offset:16416
    s_mov_b32 s23, 0xc000
    buffer_load_dwordx4 v[40:43], v6, s[8:11], s23 offen offset:2048 sc1
    v_mfma_f32_16x16x32_bf16 v[132:135], v[244:247], v[52:55], v[132:135]
    ds_read_b64_tr_b16 v[238:239], v5 offset:17440
    s_waitcnt lgkmcnt(6)
    v_mfma_f32_16x16x32_bf16 v[136:139], v[224:227], v[48:51], v[136:139]
    ds_read_b64_tr_b16 v[240:241], v4 offset:16640
    v_mfma_f32_16x16x32_bf16 v[140:143], v[224:227], v[52:55], v[140:143]
    ds_read_b64_tr_b16 v[242:243], v4 offset:17664
    s_mov_b32 s23, 0x2c000
    buffer_load_dwordx4 v[44:47], v6, s[8:11], s23 offen offset:2048 sc1
    s_waitcnt lgkmcnt(6)
    v_mfma_f32_16x16x32_bf16 v[144:147], v[228:231], v[48:51], v[144:147]
    ds_read_b64_tr_b16 v[244:245], v5 offset:16672
    v_mfma_f32_16x16x32_bf16 v[148:151], v[228:231], v[52:55], v[148:151]
    ds_read_b64_tr_b16 v[246:247], v5 offset:17696
    s_waitcnt vmcnt(15) lgkmcnt(6)
    v_mfma_f32_16x16x32_bf16 v[88:91], v[232:235], v[56:59], v[88:91]
    ds_read_b64_tr_b16 v[224:225], v4 offset:16896
    s_waitcnt vmcnt(14)
    v_mfma_f32_16x16x32_bf16 v[92:95], v[232:235], v[60:63], v[92:95]
    s_add_u32 s22, s24, 0x3a0000
    s_add_u32 m0, s20, 0x24000
    s_nop 0
    buffer_load_dwordx4 v3, s[4:7], s22 offen lds
    ds_read_b64_tr_b16 v[226:227], v4 offset:17920
    s_waitcnt lgkmcnt(6)
    v_mfma_f32_16x16x32_bf16 v[96:99], v[236:239], v[56:59], v[96:99]
    ds_read_b64_tr_b16 v[228:229], v5 offset:16928
    v_mfma_f32_16x16x32_bf16 v[100:103], v[236:239], v[60:63], v[100:103]
    ds_read_b64_tr_b16 v[230:231], v5 offset:17952
    s_waitcnt lgkmcnt(6)
    v_mfma_f32_16x16x32_bf16 v[104:107], v[240:243], v[56:59], v[104:107]
    s_add_u32 s22, s24, 0x3a2000
    s_add_u32 m0, s20, 0x24400
    s_nop 0
    buffer_load_dwordx4 v3, s[4:7], s22 offen lds
    ds_read_b64_tr_b16 v[232:233], v4 offset:17152
    v_mfma_f32_16x16x32_bf16 v[108:111], v[240:243], v[60:63], v[108:111]
    ds_read_b64_tr_b16 v[234:235], v4 offset:18176
    s_waitcnt lgkmcnt(6)
    v_mfma_f32_16x16x32_bf16 v[112:115], v[244:247], v[56:59], v[112:115]
    ds_read_b64_tr_b16 v[236:237], v5 offset:17184
    v_mfma_f32_16x16x32_bf16 v[116:119], v[244:247], v[60:63], v[116:119]
    ds_read_b64_tr_b16 v[238:239], v5 offset:18208
    s_waitcnt lgkmcnt(6)
    v_mfma_f32_16x16x32_bf16 v[120:123], v[224:227], v[56:59], v[120:123]
    v_mfma_f32_16x16x32_bf16 v[124:127], v[224:227], v[60:63], v[124:127]
    s_waitcnt vmcnt(14)
    s_barrier
    ds_read_b64_tr_b16 v[240:241], v4 offset:32768
    ds_read_b64_tr_b16 v[242:243], v4 offset:33792
    s_waitcnt lgkmcnt(6)
    v_mfma_f32_16x16x32_bf16 v[128:131], v[228:231], v[56:59], v[128:131]
    ds_read_b64_tr_b16 v[244:245], v5 offset:32800
    s_mov_b32 s23, 0xe000
    buffer_load_dwordx4 v[48:51], v6, s[8:11], s23 offen offset:2048 sc1
    v_mfma_f32_16x16x32_bf16 v[132:135], v[228:231], v[60:63], v[132:135]
    ds_read_b64_tr_b16 v[246:247], v5 offset:33824
    s_waitcnt lgkmcnt(6)
    v_mfma_f32_16x16x32_bf16 v[136:139], v[232:235], v[56:59], v[136:139]
    ds_read_b64_tr_b16 v[224:225], v4 offset:33024
    v_mfma_f32_16x16x32_bf16 v[140:143], v[232:235], v[60:63], v[140:143]
    ds_read_b64_tr_b16 v[226:227], v4 offset:34048
    s_mov_b32 s23, 0x2e000
    buffer_load_dwordx4 v[52:55], v6, s[8:11], s23 offen offset:2048 sc1
    s_waitcnt lgkmcnt(6)
    v_mfma_f32_16x16x32_bf16 v[144:147], v[236:239], v[56:59], v[144:147]
    ds_read_b64_tr_b16 v[228:229], v5 offset:33056
    v_mfma_f32_16x16x32_bf16 v[148:151], v[236:239], v[60:63], v[148:151]
    ds_read_b64_tr_b16 v[230:231], v5 offset:34080
    s_waitcnt vmcnt(6)
    v_cmp_ne_u32 vcc, s28, v12
    s_cbranch_vccnz adaLN_cond__sliding_block_cached__moe_arch_mod__prompt_kernel_o220r
adaLN_cond__sliding_block_cached__moe_arch_mod__prompt_kernel_o220b:
    s_waitcnt lgkmcnt(6)
    v_mfma_f32_16x16x32_bf16 v[88:91], v[240:243], v[24:27], v[88:91]
    ds_read_b64_tr_b16 v[232:233], v4 offset:33280
    v_mfma_f32_16x16x32_bf16 v[92:95], v[240:243], v[28:31], v[92:95]
    s_add_u32 s22, s24, 0x30000
    s_add_u32 m0, s20, 0x10000
    s_nop 0
    buffer_load_dwordx4 v3, s[4:7], s22 offen lds
    ds_read_b64_tr_b16 v[234:235], v4 offset:34304
    s_waitcnt lgkmcnt(6)
    v_mfma_f32_16x16x32_bf16 v[96:99], v[244:247], v[24:27], v[96:99]
    ds_read_b64_tr_b16 v[236:237], v5 offset:33312
    v_mfma_f32_16x16x32_bf16 v[100:103], v[244:247], v[28:31], v[100:103]
    ds_read_b64_tr_b16 v[238:239], v5 offset:34336
    s_waitcnt lgkmcnt(6)
    v_mfma_f32_16x16x32_bf16 v[104:107], v[224:227], v[24:27], v[104:107]
    s_add_u32 s22, s24, 0x32000
    s_add_u32 m0, s20, 0x10400
    s_nop 0
    buffer_load_dwordx4 v3, s[4:7], s22 offen lds
    ds_read_b64_tr_b16 v[240:241], v4 offset:33536
    v_mfma_f32_16x16x32_bf16 v[108:111], v[224:227], v[28:31], v[108:111]
    ds_read_b64_tr_b16 v[242:243], v4 offset:34560
    v_xor_b32 v16, s28, v184
    v_xor_b32 v17, s28, v185
    v_xor_b32 v18, s28, v186
    v_xor_b32 v19, s28, v187
    v_or3_b32 v16, v16, v17, v18
    v_or_b32 v16, v16, v19
    v_cmp_ne_u32 vcc, 0, v16
    s_cbranch_vccnz adaLN_cond__sliding_block_cached__moe_arch_mod__prompt_kernel_mf21r
adaLN_cond__sliding_block_cached__moe_arch_mod__prompt_kernel_mf21b:
    s_waitcnt lgkmcnt(6)
    v_mfma_f32_16x16x32_bf16 v[112:115], v[228:231], v[24:27], v[112:115]
    ds_read_b64_tr_b16 v[244:245], v5 offset:33568
    v_mfma_f32_16x16x32_bf16 v[116:119], v[228:231], v[28:31], v[116:119]
    ds_read_b64_tr_b16 v[246:247], v5 offset:34592
    s_waitcnt lgkmcnt(6)
    v_mfma_f32_16x16x32_bf16 v[120:123], v[232:235], v[24:27], v[120:123]
    v_mfma_f32_16x16x32_bf16 v[124:127], v[232:235], v[28:31], v[124:127]
    s_barrier
    ds_read_b64_tr_b16 v[224:225], v4 offset:49152
    ds_read_b64_tr_b16 v[226:227], v4 offset:50176
    s_waitcnt lgkmcnt(6)
    v_mfma_f32_16x16x32_bf16 v[128:131], v[236:239], v[24:27], v[128:131]
    ds_read_b64_tr_b16 v[228:229], v5 offset:49184
    s_mov_b32 s23, 0x0
    buffer_load_dwordx4 v[56:59], v6, s[8:11], s23 offen offset:3072 sc1
    v_mfma_f32_16x16x32_bf16 v[132:135], v[236:239], v[28:31], v[132:135]
    ds_read_b64_tr_b16 v[230:231], v5 offset:50208
    s_waitcnt lgkmcnt(6)
    v_mfma_f32_16x16x32_bf16 v[136:139], v[240:243], v[24:27], v[136:139]
    ds_read_b64_tr_b16 v[232:233], v4 offset:49408
    v_mfma_f32_16x16x32_bf16 v[140:143], v[240:243], v[28:31], v[140:143]
    ds_read_b64_tr_b16 v[234:235], v4 offset:50432
    s_mov_b32 s23, 0x20000
    buffer_load_dwordx4 v[60:63], v6, s[8:11], s23 offen offset:3072 sc1
    s_waitcnt lgkmcnt(6)
    v_mfma_f32_16x16x32_bf16 v[144:147], v[244:247], v[24:27], v[144:147]
    ds_read_b64_tr_b16 v[236:237], v5 offset:49440
    v_mfma_f32_16x16x32_bf16 v[148:151], v[244:247], v[28:31], v[148:151]
    ds_read_b64_tr_b16 v[238:239], v5 offset:50464
    s_waitcnt lgkmcnt(6)
    v_mfma_f32_16x16x32_bf16 v[88:91], v[224:227], v[32:35], v[88:91]
    ds_read_b64_tr_b16 v[240:241], v4 offset:49664
    v_mfma_f32_16x16x32_bf16 v[92:95], v[224:227], v[36:39], v[92:95]
    s_add_u32 s22, s24, 0xb0000
    s_add_u32 m0, s20, 0x14000
    s_nop 0
    buffer_load_dwordx4 v3, s[4:7], s22 offen lds
    ds_read_b64_tr_b16 v[242:243], v4 offset:50688
    s_waitcnt lgkmcnt(6)
    v_mfma_f32_16x16x32_bf16 v[96:99], v[228:231], v[32:35], v[96:99]
    ds_read_b64_tr_b16 v[244:245], v5 offset:49696
    v_mfma_f32_16x16x32_bf16 v[100:103], v[228:231], v[36:39], v[100:103]
    ds_read_b64_tr_b16 v[246:247], v5 offset:50720
    s_waitcnt lgkmcnt(6)
    v_mfma_f32_16x16x32_bf16 v[104:107], v[232:235], v[32:35], v[104:107]
    s_add_u32 s22, s24, 0xb2000
    s_add_u32 m0, s20, 0x14400
    s_nop 0
    buffer_load_dwordx4 v3, s[4:7], s22 offen lds
    ds_read_b64_tr_b16 v[224:225], v4 offset:49920
    v_mfma_f32_16x16x32_bf16 v[108:111], v[232:235], v[36:39], v[108:111]
    ds_read_b64_tr_b16 v[226:227], v4 offset:50944
    s_waitcnt lgkmcnt(6)
    v_mfma_f32_16x16x32_bf16 v[112:115], v[236:239], v[32:35], v[112:115]
    ds_read_b64_tr_b16 v[228:229], v5 offset:49952
    v_mfma_f32_16x16x32_bf16 v[116:119], v[236:239], v[36:39], v[116:119]
    ds_read_b64_tr_b16 v[230:231], v5 offset:50976
    s_waitcnt lgkmcnt(6)
    v_mfma_f32_16x16x32_bf16 v[120:123], v[240:243], v[32:35], v[120:123]
    v_mfma_f32_16x16x32_bf16 v[124:127], v[240:243], v[36:39], v[124:127]
    s_barrier
    ds_read_b64_tr_b16 v[232:233], v7 offset:0
    ds_read_b64_tr_b16 v[234:235], v7 offset:1024
    s_waitcnt lgkmcnt(6)
    v_mfma_f32_16x16x32_bf16 v[128:131], v[244:247], v[32:35], v[128:131]
    ds_read_b64_tr_b16 v[236:237], v8 offset:32
    s_mov_b32 s23, 0x2000
    buffer_load_dwordx4 v[24:27], v6, s[8:11], s23 offen offset:3072 sc1
    v_mfma_f32_16x16x32_bf16 v[132:135], v[244:247], v[36:39], v[132:135]
    ds_read_b64_tr_b16 v[238:239], v8 offset:1056
    s_waitcnt lgkmcnt(6)
    v_mfma_f32_16x16x32_bf16 v[136:139], v[224:227], v[32:35], v[136:139]
    ds_read_b64_tr_b16 v[240:241], v7 offset:256
    v_mfma_f32_16x16x32_bf16 v[140:143], v[224:227], v[36:39], v[140:143]
    ds_read_b64_tr_b16 v[242:243], v7 offset:1280
    s_mov_b32 s23, 0x22000
    buffer_load_dwordx4 v[28:31], v6, s[8:11], s23 offen offset:3072 sc1
    s_waitcnt lgkmcnt(6)
    v_mfma_f32_16x16x32_bf16 v[144:147], v[228:231], v[32:35], v[144:147]
    ds_read_b64_tr_b16 v[244:245], v8 offset:288
    v_mfma_f32_16x16x32_bf16 v[148:151], v[228:231], v[36:39], v[148:151]
    ds_read_b64_tr_b16 v[246:247], v8 offset:1312
    s_waitcnt vmcnt(13) lgkmcnt(6)
    v_mfma_f32_16x16x32_bf16 v[88:91], v[232:235], v[40:43], v[88:91]
    ds_read_b64_tr_b16 v[224:225], v7 offset:512
    s_waitcnt vmcnt(12)
    v_mfma_f32_16x16x32_bf16 v[92:95], v[232:235], v[44:47], v[92:95]
    s_add_u32 s22, s24, 0x130000
    s_add_u32 m0, s20, 0x18000
    s_nop 0
    buffer_load_dwordx4 v3, s[4:7], s22 offen lds
    ds_read_b64_tr_b16 v[226:227], v7 offset:1536
    s_waitcnt lgkmcnt(6)
    v_mfma_f32_16x16x32_bf16 v[96:99], v[236:239], v[40:43], v[96:99]
    ds_read_b64_tr_b16 v[228:229], v8 offset:544
    v_mfma_f32_16x16x32_bf16 v[100:103], v[236:239], v[44:47], v[100:103]
    ds_read_b64_tr_b16 v[230:231], v8 offset:1568
    s_waitcnt lgkmcnt(6)
    v_mfma_f32_16x16x32_bf16 v[104:107], v[240:243], v[40:43], v[104:107]
    s_add_u32 s22, s24, 0x132000
    s_add_u32 m0, s20, 0x18400
    s_nop 0
    buffer_load_dwordx4 v3, s[4:7], s22 offen lds
    ds_read_b64_tr_b16 v[232:233], v7 offset:768
    v_mfma_f32_16x16x32_bf16 v[108:111], v[240:243], v[44:47], v[108:111]
    ds_read_b64_tr_b16 v[234:235], v7 offset:1792
    s_waitcnt lgkmcnt(6)
    v_mfma_f32_16x16x32_bf16 v[112:115], v[244:247], v[40:43], v[112:115]
    ds_read_b64_tr_b16 v[236:237], v8 offset:800
    v_mfma_f32_16x16x32_bf16 v[116:119], v[244:247], v[44:47], v[116:119]
    ds_read_b64_tr_b16 v[238:239], v8 offset:1824
    s_waitcnt lgkmcnt(6)
    v_mfma_f32_16x16x32_bf16 v[120:123], v[224:227], v[40:43], v[120:123]
    v_mfma_f32_16x16x32_bf16 v[124:127], v[224:227], v[44:47], v[124:127]
    s_waitcnt vmcnt(12)
    s_barrier
    ds_read_b64_tr_b16 v[240:241], v7 offset:16384
    ds_read_b64_tr_b16 v[242:243], v7 offset:17408
    s_waitcnt lgkmcnt(6)
    v_mfma_f32_16x16x32_bf16 v[128:131], v[228:231], v[40:43], v[128:131]
    ds_read_b64_tr_b16 v[244:245], v8 offset:16416
    s_mov_b32 s23, 0x4000
    buffer_load_dwordx4 v[32:35], v6, s[8:11], s23 offen offset:3072 sc1
    v_mfma_f32_16x16x32_bf16 v[132:135], v[228:231], v[44:47], v[132:135]
    ds_read_b64_tr_b16 v[246:247], v8 offset:17440
    s_waitcnt lgkmcnt(6)
    v_mfma_f32_16x16x32_bf16 v[136:139], v[232:235], v[40:43], v[136:139]
    ds_read_b64_tr_b16 v[224:225], v7 offset:16640
    v_mfma_f32_16x16x32_bf16 v[140:143], v[232:235], v[44:47], v[140:143]
    ds_read_b64_tr_b16 v[226:227], v7 offset:17664
    s_mov_b32 s23, 0x24000
    buffer_load_dwordx4 v[36:39], v6, s[8:11], s23 offen offset:3072 sc1
    s_waitcnt lgkmcnt(6)
    v_mfma_f32_16x16x32_bf16 v[144:147], v[236:239], v[40:43], v[144:147]
    ds_read_b64_tr_b16 v[228:229], v8 offset:16672
    v_mfma_f32_16x16x32_bf16 v[148:151], v[236:239], v[44:47], v[148:151]
    ds_read_b64_tr_b16 v[230:231], v8 offset:17696
    s_waitcnt vmcnt(13) lgkmcnt(6)
    v_mfma_f32_16x16x32_bf16 v[88:91], v[240:243], v[48:51], v[88:91]
    ds_read_b64_tr_b16 v[232:233], v7 offset:16896
    s_waitcnt vmcnt(12)
    v_mfma_f32_16x16x32_bf16 v[92:95], v[240:243], v[52:55], v[92:95]
    s_add_u32 s22, s24, 0x1b0000
    s_add_u32 m0, s20, 0x1c000
    s_nop 0
    buffer_load_dwordx4 v3, s[4:7], s22 offen lds
    ds_read_b64_tr_b16 v[234:235], v7 offset:17920
    s_waitcnt lgkmcnt(6)
    v_mfma_f32_16x16x32_bf16 v[96:99], v[244:247], v[48:51], v[96:99]
    ds_read_b64_tr_b16 v[236:237], v8 offset:16928
    v_mfma_f32_16x16x32_bf16 v[100:103], v[244:247], v[52:55], v[100:103]
    ds_read_b64_tr_b16 v[238:239], v8 offset:17952
    s_waitcnt lgkmcnt(6)
    v_mfma_f32_16x16x32_bf16 v[104:107], v[224:227], v[48:51], v[104:107]
    s_add_u32 s22, s24, 0x1b2000
    s_add_u32 m0, s20, 0x1c400
    s_nop 0
    buffer_load_dwordx4 v3, s[4:7], s22 offen lds
    ds_read_b64_tr_b16 v[240:241], v7 offset:17152
    v_mfma_f32_16x16x32_bf16 v[108:111], v[224:227], v[52:55], v[108:111]
    ds_read_b64_tr_b16 v[242:243], v7 offset:18176
    s_waitcnt lgkmcnt(6)
    v_mfma_f32_16x16x32_bf16 v[112:115], v[228:231], v[48:51], v[112:115]
    ds_read_b64_tr_b16 v[244:245], v8 offset:17184
    v_mfma_f32_16x16x32_bf16 v[116:119], v[228:231], v[52:55], v[116:119]
    ds_read_b64_tr_b16 v[246:247], v8 offset:18208
    s_waitcnt lgkmcnt(6)
    v_mfma_f32_16x16x32_bf16 v[120:123], v[232:235], v[48:51], v[120:123]
    v_mfma_f32_16x16x32_bf16 v[124:127], v[232:235], v[52:55], v[124:127]
    s_waitcnt vmcnt(12)
    s_barrier
    ds_read_b64_tr_b16 v[224:225], v4 offset:0
    ds_read_b64_tr_b16 v[226:227], v4 offset:1024
    s_waitcnt lgkmcnt(6)
    v_mfma_f32_16x16x32_bf16 v[128:131], v[236:239], v[48:51], v[128:131]
    ds_read_b64_tr_b16 v[228:229], v5 offset:32
    s_mov_b32 s23, 0x6000
    buffer_load_dwordx4 v[40:43], v6, s[8:11], s23 offen offset:3072 sc1
    v_mfma_f32_16x16x32_bf16 v[132:135], v[236:239], v[52:55], v[132:135]
    ds_read_b64_tr_b16 v[230:231], v5 offset:1056
    s_waitcnt lgkmcnt(6)
    v_mfma_f32_16x16x32_bf16 v[136:139], v[240:243], v[48:51], v[136:139]
    ds_read_b64_tr_b16 v[232:233], v4 offset:256
    v_mfma_f32_16x16x32_bf16 v[140:143], v[240:243], v[52:55], v[140:143]
    ds_read_b64_tr_b16 v[234:235], v4 offset:1280
    s_mov_b32 s23, 0x26000
    buffer_load_dwordx4 v[44:47], v6, s[8:11], s23 offen offset:3072 sc1
    s_waitcnt lgkmcnt(6)
    v_mfma_f32_16x16x32_bf16 v[144:147], v[244:247], v[48:51], v[144:147]
    ds_read_b64_tr_b16 v[236:237], v5 offset:288
    v_mfma_f32_16x16x32_bf16 v[148:151], v[244:247], v[52:55], v[148:151]
    ds_read_b64_tr_b16 v[238:239], v5 offset:1312
    s_waitcnt vmcnt(13) lgkmcnt(6)
    v_mfma_f32_16x16x32_bf16 v[88:91], v[224:227], v[56:59], v[88:91]
    ds_read_b64_tr_b16 v[240:241], v4 offset:512
    s_waitcnt vmcnt(12)
    v_mfma_f32_16x16x32_bf16 v[92:95], v[224:227], v[60:63], v[92:95]
    s_add_u32 s22, s24, 0x230000
    s_add_u32 m0, s20, 0x20000
    s_nop 0
    buffer_load_dwordx4 v3, s[4:7], s22 offen lds
    ds_read_b64_tr_b16 v[242:243], v4 offset:1536
    s_waitcnt lgkmcnt(6)
    v_mfma_f32_16x16x32_bf16 v[96:99], v[228:231], v[56:59], v[96:99]
    ds_read_b64_tr_b16 v[244:245], v5 offset:544
    v_mfma_f32_16x16x32_bf16 v[100:103], v[228:231], v[60:63], v[100:103]
    ds_read_b64_tr_b16 v[246:247], v5 offset:1568
    s_waitcnt lgkmcnt(6)
    v_mfma_f32_16x16x32_bf16 v[104:107], v[232:235], v[56:59], v[104:107]
    s_add_u32 s22, s24, 0x232000
    s_add_u32 m0, s20, 0x20400
    s_nop 0
    buffer_load_dwordx4 v3, s[4:7], s22 offen lds
    ds_read_b64_tr_b16 v[224:225], v4 offset:768
    v_mfma_f32_16x16x32_bf16 v[108:111], v[232:235], v[60:63], v[108:111]
    ds_read_b64_tr_b16 v[226:227], v4 offset:1792
    s_waitcnt lgkmcnt(6)
    v_mfma_f32_16x16x32_bf16 v[112:115], v[236:239], v[56:59], v[112:115]
    ds_read_b64_tr_b16 v[228:229], v5 offset:800
    v_mfma_f32_16x16x32_bf16 v[116:119], v[236:239], v[60:63], v[116:119]
    ds_read_b64_tr_b16 v[230:231], v5 offset:1824
    s_waitcnt lgkmcnt(6)
    v_mfma_f32_16x16x32_bf16 v[120:123], v[240:243], v[56:59], v[120:123]
    v_mfma_f32_16x16x32_bf16 v[124:127], v[240:243], v[60:63], v[124:127]
    s_waitcnt vmcnt(12)
    s_barrier
    ds_read_b64_tr_b16 v[232:233], v4 offset:16384
    ds_read_b64_tr_b16 v[234:235], v4 offset:17408
    s_waitcnt lgkmcnt(6)
    v_mfma_f32_16x16x32_bf16 v[128:131], v[244:247], v[56:59], v[128:131]
    ds_read_b64_tr_b16 v[236:237], v5 offset:16416
    s_mov_b32 s23, 0x8000
    buffer_load_dwordx4 v[48:51], v6, s[8:11], s23 offen offset:3072 sc1
    v_mfma_f32_16x16x32_bf16 v[132:135], v[244:247], v[60:63], v[132:135]
    ds_read_b64_tr_b16 v[238:239], v5 offset:17440
    s_waitcnt lgkmcnt(6)
    v_mfma_f32_16x16x32_bf16 v[136:139], v[224:227], v[56:59], v[136:139]
    ds_read_b64_tr_b16 v[240:241], v4 offset:16640
    v_mfma_f32_16x16x32_bf16 v[140:143], v[224:227], v[60:63], v[140:143]
    ds_read_b64_tr_b16 v[242:243], v4 offset:17664
    s_mov_b32 s23, 0x28000
    buffer_load_dwordx4 v[52:55], v6, s[8:11], s23 offen offset:3072 sc1
    s_waitcnt lgkmcnt(6)
    v_mfma_f32_16x16x32_bf16 v[144:147], v[228:231], v[56:59], v[144:147]
    ds_read_b64_tr_b16 v[244:245], v5 offset:16672
    v_mfma_f32_16x16x32_bf16 v[148:151], v[228:231], v[60:63], v[148:151]
    ds_read_b64_tr_b16 v[246:247], v5 offset:17696
    s_waitcnt vmcnt(13) lgkmcnt(6)
    v_mfma_f32_16x16x32_bf16 v[88:91], v[232:235], v[24:27], v[88:91]
    ds_read_b64_tr_b16 v[224:225], v4 offset:16896
    s_waitcnt vmcnt(12)
    v_mfma_f32_16x16x32_bf16 v[92:95], v[232:235], v[28:31], v[92:95]
    s_add_u32 s22, s24, 0x2b0000
    s_add_u32 m0, s20, 0x24000
    s_nop 0
    buffer_load_dwordx4 v3, s[4:7], s22 offen lds
    ds_read_b64_tr_b16 v[226:227], v4 offset:17920
    s_waitcnt lgkmcnt(6)
    v_mfma_f32_16x16x32_bf16 v[96:99], v[236:239], v[24:27], v[96:99]
    ds_read_b64_tr_b16 v[228:229], v5 offset:16928
    v_mfma_f32_16x16x32_bf16 v[100:103], v[236:239], v[28:31], v[100:103]
    ds_read_b64_tr_b16 v[230:231], v5 offset:17952
    s_waitcnt lgkmcnt(6)
    v_mfma_f32_16x16x32_bf16 v[104:107], v[240:243], v[24:27], v[104:107]
    s_add_u32 s22, s24, 0x2b2000
    s_add_u32 m0, s20, 0x24400
    s_nop 0
    buffer_load_dwordx4 v3, s[4:7], s22 offen lds
    ds_read_b64_tr_b16 v[232:233], v4 offset:17152
    v_mfma_f32_16x16x32_bf16 v[108:111], v[240:243], v[28:31], v[108:111]
    ds_read_b64_tr_b16 v[234:235], v4 offset:18176
    s_waitcnt lgkmcnt(6)
    v_mfma_f32_16x16x32_bf16 v[112:115], v[244:247], v[24:27], v[112:115]
    ds_read_b64_tr_b16 v[236:237], v5 offset:17184
    v_mfma_f32_16x16x32_bf16 v[116:119], v[244:247], v[28:31], v[116:119]
    ds_read_b64_tr_b16 v[238:239], v5 offset:18208
    s_waitcnt lgkmcnt(6)
    v_mfma_f32_16x16x32_bf16 v[120:123], v[224:227], v[24:27], v[120:123]
    v_mfma_f32_16x16x32_bf16 v[124:127], v[224:227], v[28:31], v[124:127]
    s_waitcnt vmcnt(12)
    s_barrier
    ds_read_b64_tr_b16 v[240:241], v4 offset:32768
    ds_read_b64_tr_b16 v[242:243], v4 offset:33792
    s_waitcnt lgkmcnt(6)
    v_mfma_f32_16x16x32_bf16 v[128:131], v[228:231], v[24:27], v[128:131]
    ds_read_b64_tr_b16 v[244:245], v5 offset:32800
    s_mov_b32 s23, 0xa000
    buffer_load_dwordx4 v[56:59], v6, s[8:11], s23 offen offset:3072 sc1
    v_mfma_f32_16x16x32_bf16 v[132:135], v[228:231], v[28:31], v[132:135]
    ds_read_b64_tr_b16 v[246:247], v5 offset:33824
    s_waitcnt lgkmcnt(6)
    v_mfma_f32_16x16x32_bf16 v[136:139], v[232:235], v[24:27], v[136:139]
    ds_read_b64_tr_b16 v[224:225], v4 offset:33024
    v_mfma_f32_16x16x32_bf16 v[140:143], v[232:235], v[28:31], v[140:143]
    ds_read_b64_tr_b16 v[226:227], v4 offset:34048
    s_mov_b32 s23, 0x2a000
    buffer_load_dwordx4 v[60:63], v6, s[8:11], s23 offen offset:3072 sc1
    s_waitcnt lgkmcnt(6)
    v_mfma_f32_16x16x32_bf16 v[144:147], v[236:239], v[24:27], v[144:147]
    ds_read_b64_tr_b16 v[228:229], v5 offset:33056
    v_mfma_f32_16x16x32_bf16 v[148:151], v[236:239], v[28:31], v[148:151]
    ds_read_b64_tr_b16 v[230:231], v5 offset:34080
    s_waitcnt vmcnt(13) lgkmcnt(6)
    v_mfma_f32_16x16x32_bf16 v[88:91], v[240:243], v[32:35], v[88:91]
    ds_read_b64_tr_b16 v[232:233], v4 offset:33280
    s_waitcnt vmcnt(12)
    v_mfma_f32_16x16x32_bf16 v[92:95], v[240:243], v[36:39], v[92:95]
    s_add_u32 s22, s24, 0x330000
    s_add_u32 m0, s20, 0x10000
    s_nop 0
    buffer_load_dwordx4 v3, s[4:7], s22 offen lds
    ds_read_b64_tr_b16 v[234:235], v4 offset:34304
    s_waitcnt lgkmcnt(6)
    v_mfma_f32_16x16x32_bf16 v[96:99], v[244:247], v[32:35], v[96:99]
    ds_read_b64_tr_b16 v[236:237], v5 offset:33312
    v_mfma_f32_16x16x32_bf16 v[100:103], v[244:247], v[36:39], v[100:103]
    ds_read_b64_tr_b16 v[238:239], v5 offset:34336
    s_waitcnt lgkmcnt(6)
    v_mfma_f32_16x16x32_bf16 v[104:107], v[224:227], v[32:35], v[104:107]
    s_add_u32 s22, s24, 0x332000
    s_add_u32 m0, s20, 0x10400
    s_nop 0
    buffer_load_dwordx4 v3, s[4:7], s22 offen lds
    ds_read_b64_tr_b16 v[240:241], v4 offset:33536
    v_mfma_f32_16x16x32_bf16 v[108:111], v[224:227], v[36:39], v[108:111]
    ds_read_b64_tr_b16 v[242:243], v4 offset:34560
    v_lshrrev_b32 v16, 4, v1
    v_lshlrev_b32 v16, 3, v16
    s_lshl_b32 s16, s31, 8
    s_add_u32 s16, s16, 0x540080
    buffer_load_dwordx2 v[248:249], v16, s[8:11], s16 offen offset:0 sc1
    buffer_load_dwordx2 v[250:251], v16, s[8:11], s16 offen offset:32 sc1
    buffer_load_dwordx2 v[252:253], v16, s[8:11], s16 offen offset:64 sc1
    buffer_load_dwordx2 v[254:255], v16, s[8:11], s16 offen offset:96 sc1
    s_waitcnt lgkmcnt(6)
    v_mfma_f32_16x16x32_bf16 v[112:115], v[228:231], v[32:35], v[112:115]
    ds_read_b64_tr_b16 v[244:245], v5 offset:33568
    v_mfma_f32_16x16x32_bf16 v[116:119], v[228:231], v[36:39], v[116:119]
    ds_read_b64_tr_b16 v[246:247], v5 offset:34592
    s_waitcnt lgkmcnt(6)
    v_mfma_f32_16x16x32_bf16 v[120:123], v[232:235], v[32:35], v[120:123]
    v_mfma_f32_16x16x32_bf16 v[124:127], v[232:235], v[36:39], v[124:127]
    s_waitcnt vmcnt(16)
    s_barrier
    ds_read_b64_tr_b16 v[224:225], v4 offset:49152
    ds_read_b64_tr_b16 v[226:227], v4 offset:50176
    s_waitcnt lgkmcnt(6)
    v_mfma_f32_16x16x32_bf16 v[128:131], v[236:239], v[32:35], v[128:131]
    ds_read_b64_tr_b16 v[228:229], v5 offset:49184
    s_mov_b32 s23, 0xc000
    buffer_load_dwordx4 v[24:27], v6, s[8:11], s23 offen offset:3072 sc1
    v_mfma_f32_16x16x32_bf16 v[132:135], v[236:239], v[36:39], v[132:135]
    ds_read_b64_tr_b16 v[230:231], v5 offset:50208
    s_waitcnt lgkmcnt(6)
    v_mfma_f32_16x16x32_bf16 v[136:139], v[240:243], v[32:35], v[136:139]
    ds_read_b64_tr_b16 v[232:233], v4 offset:49408
    v_mfma_f32_16x16x32_bf16 v[140:143], v[240:243], v[36:39], v[140:143]
    ds_read_b64_tr_b16 v[234:235], v4 offset:50432
    s_mov_b32 s23, 0x2c000
    buffer_load_dwordx4 v[28:31], v6, s[8:11], s23 offen offset:3072 sc1
    s_waitcnt lgkmcnt(6)
    v_mfma_f32_16x16x32_bf16 v[144:147], v[244:247], v[32:35], v[144:147]
    ds_read_b64_tr_b16 v[236:237], v5 offset:49440
    v_mfma_f32_16x16x32_bf16 v[148:151], v[244:247], v[36:39], v[148:151]
    ds_read_b64_tr_b16 v[238:239], v5 offset:50464
    s_waitcnt vmcnt(17) lgkmcnt(6)
    v_mfma_f32_16x16x32_bf16 v[88:91], v[224:227], v[40:43], v[88:91]
    ds_read_b64_tr_b16 v[240:241], v4 offset:49664
    s_waitcnt vmcnt(16)
    v_mfma_f32_16x16x32_bf16 v[92:95], v[224:227], v[44:47], v[92:95]
    s_add_u32 s22, s24, 0x3b0000
    s_add_u32 m0, s20, 0x14000
    s_nop 0
    buffer_load_dwordx4 v3, s[4:7], s22 offen lds
    ds_read_b64_tr_b16 v[242:243], v4 offset:50688
    s_waitcnt lgkmcnt(6)
    v_mfma_f32_16x16x32_bf16 v[96:99], v[228:231], v[40:43], v[96:99]
    ds_read_b64_tr_b16 v[244:245], v5 offset:49696
    v_mfma_f32_16x16x32_bf16 v[100:103], v[228:231], v[44:47], v[100:103]
    ds_read_b64_tr_b16 v[246:247], v5 offset:50720
    s_waitcnt lgkmcnt(6)
    v_mfma_f32_16x16x32_bf16 v[104:107], v[232:235], v[40:43], v[104:107]
    s_add_u32 s22, s24, 0x3b2000
    s_add_u32 m0, s20, 0x14400
    s_nop 0
    buffer_load_dwordx4 v3, s[4:7], s22 offen lds
    ds_read_b64_tr_b16 v[224:225], v4 offset:49920
    v_mfma_f32_16x16x32_bf16 v[108:111], v[232:235], v[44:47], v[108:111]
    ds_read_b64_tr_b16 v[226:227], v4 offset:50944
    s_waitcnt lgkmcnt(6)
    v_mfma_f32_16x16x32_bf16 v[112:115], v[236:239], v[40:43], v[112:115]
    ds_read_b64_tr_b16 v[228:229], v5 offset:49952
    v_mfma_f32_16x16x32_bf16 v[116:119], v[236:239], v[44:47], v[116:119]
    ds_read_b64_tr_b16 v[230:231], v5 offset:50976
    s_waitcnt lgkmcnt(6)
    v_mfma_f32_16x16x32_bf16 v[120:123], v[240:243], v[40:43], v[120:123]
    v_mfma_f32_16x16x32_bf16 v[124:127], v[240:243], v[44:47], v[124:127]
    s_waitcnt vmcnt(16)
    s_barrier
    ds_read_b64_tr_b16 v[232:233], v7 offset:0
    ds_read_b64_tr_b16 v[234:235], v7 offset:1024
    s_waitcnt lgkmcnt(6)
    v_mfma_f32_16x16x32_bf16 v[128:131], v[244:247], v[40:43], v[128:131]
    ds_read_b64_tr_b16 v[236:237], v8 offset:32
    s_mov_b32 s23, 0xe000
    buffer_load_dwordx4 v[32:35], v6, s[8:11], s23 offen offset:3072 sc1
    v_mfma_f32_16x16x32_bf16 v[132:135], v[244:247], v[44:47], v[132:135]
    ds_read_b64_tr_b16 v[238:239], v8 offset:1056
    s_waitcnt lgkmcnt(6)
    v_mfma_f32_16x16x32_bf16 v[136:139], v[224:227], v[40:43], v[136:139]
    ds_read_b64_tr_b16 v[240:241], v7 offset:256
    v_mfma_f32_16x16x32_bf16 v[140:143], v[224:227], v[44:47], v[140:143]
    ds_read_b64_tr_b16 v[242:243], v7 offset:1280
    s_mov_b32 s23, 0x2e000
    buffer_load_dwordx4 v[36:39], v6, s[8:11], s23 offen offset:3072 sc1
    s_waitcnt lgkmcnt(6)
    v_mfma_f32_16x16x32_bf16 v[144:147], v[228:231], v[40:43], v[144:147]
    ds_read_b64_tr_b16 v[244:245], v8 offset:288
    v_mfma_f32_16x16x32_bf16 v[148:151], v[228:231], v[44:47], v[148:151]
    ds_read_b64_tr_b16 v[246:247], v8 offset:1312
    s_waitcnt vmcnt(17) lgkmcnt(6)
    v_mfma_f32_16x16x32_bf16 v[88:91], v[232:235], v[48:51], v[88:91]
    ds_read_b64_tr_b16 v[224:225], v7 offset:512
    s_waitcnt vmcnt(16)
    v_mfma_f32_16x16x32_bf16 v[92:95], v[232:235], v[52:55], v[92:95]
    ds_read_b64_tr_b16 v[226:227], v7 offset:1536
    s_waitcnt lgkmcnt(6)
    v_mfma_f32_16x16x32_bf16 v[96:99], v[236:239], v[48:51], v[96:99]
    ds_read_b64_tr_b16 v[228:229], v8 offset:544
    v_mfma_f32_16x16x32_bf16 v[100:103], v[236:239], v[52:55], v[100:103]
    ds_read_b64_tr_b16 v[230:231], v8 offset:1568
    s_waitcnt lgkmcnt(6)
    v_mfma_f32_16x16x32_bf16 v[104:107], v[240:243], v[48:51], v[104:107]
    ds_read_b64_tr_b16 v[232:233], v7 offset:768
    v_mfma_f32_16x16x32_bf16 v[108:111], v[240:243], v[52:55], v[108:111]
    ds_read_b64_tr_b16 v[234:235], v7 offset:1792
    s_waitcnt lgkmcnt(6)
    v_mfma_f32_16x16x32_bf16 v[112:115], v[244:247], v[48:51], v[112:115]
    ds_read_b64_tr_b16 v[236:237], v8 offset:800
    v_mfma_f32_16x16x32_bf16 v[116:119], v[244:247], v[52:55], v[116:119]
    ds_read_b64_tr_b16 v[238:239], v8 offset:1824
    s_waitcnt lgkmcnt(6)
    v_mfma_f32_16x16x32_bf16 v[120:123], v[224:227], v[48:51], v[120:123]
    s_mov_b64 s[72:73], s[48:49]
    s_mov_b32 s74, 0x700000
    s_mov_b32 s75, 0x20000
    s_cmp_lt_u32 s2, 224
    s_cselect_b32 s74, 7340032, 0
    s_sub_u32 s16, s3, 4
    v_lshrrev_b32 v20, 3, v1
    v_lshlrev_b32 v20, 3, v20
    s_lshl_b32 s17, s16, 6
    v_add_u32 v20, s17, v20
    s_mov_b32 s17, 7168
    v_mul_lo_u32 v21, s17, v20
    v_and_b32 v20, 7, v1
    v_lshl_add_u32 v21, v20, 4, v21
    s_and_b32 s17, s29, 3
    s_mul_i32 s18, s17, 1835008
    s_lshr_b32 s17, s29, 2
    s_lshl_b32 s17, s17, 7
    s_add_u32 s18, s18, s17
    s_lshl_b32 s16, s16, 13
    s_add_u32 s22, s18, 0
    s_add_u32 m0, s16, 32768
    s_nop 0
    buffer_load_dwordx4 v21, s[72:75], s22 offen lds
    s_add_u32 s22, s18, 7168
    s_add_u32 m0, s16, 33792
    s_nop 0
    buffer_load_dwordx4 v21, s[72:75], s22 offen lds
    s_add_u32 s22, s18, 14336
    s_add_u32 m0, s16, 34816
    s_nop 0
    buffer_load_dwordx4 v21, s[72:75], s22 offen lds
    s_add_u32 s22, s18, 21504
    s_add_u32 m0, s16, 35840
    s_nop 0
    buffer_load_dwordx4 v21, s[72:75], s22 offen lds
    s_add_u32 s22, s18, 28672
    s_add_u32 m0, s16, 36864
    s_nop 0
    buffer_load_dwordx4 v21, s[72:75], s22 offen lds
    s_add_u32 s22, s18, 35840
    s_add_u32 m0, s16, 37888
    s_nop 0
    buffer_load_dwordx4 v21, s[72:75], s22 offen lds
    s_add_u32 s22, s18, 43008
    s_add_u32 m0, s16, 38912
    s_nop 0
    buffer_load_dwordx4 v21, s[72:75], s22 offen lds
    s_add_u32 s22, s18, 50176
    s_add_u32 m0, s16, 39936
    s_nop 0
    buffer_load_dwordx4 v21, s[72:75], s22 offen lds
    v_mfma_f32_16x16x32_bf16 v[124:127], v[224:227], v[52:55], v[124:127]
    s_waitcnt vmcnt(22)
    s_barrier
    ds_read_b64_tr_b16 v[240:241], v7 offset:16384
    ds_read_b64_tr_b16 v[242:243], v7 offset:17408
    s_waitcnt lgkmcnt(6)
    v_mfma_f32_16x16x32_bf16 v[128:131], v[228:231], v[48:51], v[128:131]
    ds_read_b64_tr_b16 v[244:245], v8 offset:16416
    v_mfma_f32_16x16x32_bf16 v[132:135], v[228:231], v[52:55], v[132:135]
    ds_read_b64_tr_b16 v[246:247], v8 offset:17440
    s_waitcnt lgkmcnt(6)
    v_mfma_f32_16x16x32_bf16 v[136:139], v[232:235], v[48:51], v[136:139]
    ds_read_b64_tr_b16 v[224:225], v7 offset:16640
    v_mfma_f32_16x16x32_bf16 v[140:143], v[232:235], v[52:55], v[140:143]
    ds_read_b64_tr_b16 v[226:227], v7 offset:17664
    s_waitcnt lgkmcnt(6)
    v_mfma_f32_16x16x32_bf16 v[144:147], v[236:239], v[48:51], v[144:147]
    ds_read_b64_tr_b16 v[228:229], v8 offset:16672
    v_mfma_f32_16x16x32_bf16 v[148:151], v[236:239], v[52:55], v[148:151]
    ds_read_b64_tr_b16 v[230:231], v8 offset:17696
    s_waitcnt vmcnt(21) lgkmcnt(6)
    v_mfma_f32_16x16x32_bf16 v[88:91], v[240:243], v[56:59], v[88:91]
    ds_read_b64_tr_b16 v[232:233], v7 offset:16896
    s_waitcnt vmcnt(20)
    v_mfma_f32_16x16x32_bf16 v[92:95], v[240:243], v[60:63], v[92:95]
    ds_read_b64_tr_b16 v[234:235], v7 offset:17920
    s_waitcnt lgkmcnt(6)
    v_mfma_f32_16x16x32_bf16 v[96:99], v[244:247], v[56:59], v[96:99]
    ds_read_b64_tr_b16 v[236:237], v8 offset:16928
    v_mfma_f32_16x16x32_bf16 v[100:103], v[244:247], v[60:63], v[100:103]
    ds_read_b64_tr_b16 v[238:239], v8 offset:17952
    s_waitcnt lgkmcnt(6)
    v_mfma_f32_16x16x32_bf16 v[104:107], v[224:227], v[56:59], v[104:107]
    ds_read_b64_tr_b16 v[240:241], v7 offset:17152
    v_mfma_f32_16x16x32_bf16 v[108:111], v[224:227], v[60:63], v[108:111]
    ds_read_b64_tr_b16 v[242:243], v7 offset:18176
    s_waitcnt lgkmcnt(6)
    v_mfma_f32_16x16x32_bf16 v[112:115], v[228:231], v[56:59], v[112:115]
    ds_read_b64_tr_b16 v[244:245], v8 offset:17184
    v_mfma_f32_16x16x32_bf16 v[116:119], v[228:231], v[60:63], v[116:119]
    ds_read_b64_tr_b16 v[246:247], v8 offset:18208
    s_waitcnt lgkmcnt(6)
    v_mfma_f32_16x16x32_bf16 v[120:123], v[232:235], v[56:59], v[120:123]
    v_mfma_f32_16x16x32_bf16 v[124:127], v[232:235], v[60:63], v[124:127]
    s_waitcnt vmcnt(18)
    s_barrier
    ds_read_b64_tr_b16 v[224:225], v4 offset:0
    ds_read_b64_tr_b16 v[226:227], v4 offset:1024
    s_waitcnt lgkmcnt(6)
    v_mfma_f32_16x16x32_bf16 v[128:131], v[236:239], v[56:59], v[128:131]
    ds_read_b64_tr_b16 v[228:229], v5 offset:32
    v_mfma_f32_16x16x32_bf16 v[132:135], v[236:239], v[60:63], v[132:135]
    ds_read_b64_tr_b16 v[230:231], v5 offset:1056
    s_waitcnt lgkmcnt(6)
    v_mfma_f32_16x16x32_bf16 v[136:139], v[240:243], v[56:59], v[136:139]
    ds_read_b64_tr_b16 v[232:233], v4 offset:256
    v_mfma_f32_16x16x32_bf16 v[140:143], v[240:243], v[60:63], v[140:143]
    ds_read_b64_tr_b16 v[234:235], v4 offset:1280
    s_waitcnt lgkmcnt(6)
    v_mfma_f32_16x16x32_bf16 v[144:147], v[244:247], v[56:59], v[144:147]
    ds_read_b64_tr_b16 v[236:237], v5 offset:288
    v_mfma_f32_16x16x32_bf16 v[148:151], v[244:247], v[60:63], v[148:151]
    ds_read_b64_tr_b16 v[238:239], v5 offset:1312
    s_waitcnt vmcnt(13) lgkmcnt(6)
    v_mfma_f32_16x16x32_bf16 v[88:91], v[224:227], v[24:27], v[88:91]
    ds_read_b64_tr_b16 v[240:241], v4 offset:512
    s_waitcnt vmcnt(12)
    v_mfma_f32_16x16x32_bf16 v[92:95], v[224:227], v[28:31], v[92:95]
    ds_read_b64_tr_b16 v[242:243], v4 offset:1536
    s_waitcnt lgkmcnt(6)
    v_mfma_f32_16x16x32_bf16 v[96:99], v[228:231], v[24:27], v[96:99]
    ds_read_b64_tr_b16 v[244:245], v5 offset:544
    v_mfma_f32_16x16x32_bf16 v[100:103], v[228:231], v[28:31], v[100:103]
    ds_read_b64_tr_b16 v[246:247], v5 offset:1568
    s_waitcnt lgkmcnt(6)
    v_mfma_f32_16x16x32_bf16 v[104:107], v[232:235], v[24:27], v[104:107]
    ds_read_b64_tr_b16 v[224:225], v4 offset:768
    v_mfma_f32_16x16x32_bf16 v[108:111], v[232:235], v[28:31], v[108:111]
    ds_read_b64_tr_b16 v[226:227], v4 offset:1792
    s_waitcnt lgkmcnt(6)
    v_mfma_f32_16x16x32_bf16 v[112:115], v[236:239], v[24:27], v[112:115]
    ds_read_b64_tr_b16 v[228:229], v5 offset:800
    v_mfma_f32_16x16x32_bf16 v[116:119], v[236:239], v[28:31], v[116:119]
    ds_read_b64_tr_b16 v[230:231], v5 offset:1824
    s_waitcnt lgkmcnt(6)
    v_mfma_f32_16x16x32_bf16 v[120:123], v[240:243], v[24:27], v[120:123]
    v_mfma_f32_16x16x32_bf16 v[124:127], v[240:243], v[28:31], v[124:127]
    s_waitcnt vmcnt(10)
    s_barrier
    ds_read_b64_tr_b16 v[232:233], v4 offset:16384
    ds_read_b64_tr_b16 v[234:235], v4 offset:17408
    s_waitcnt lgkmcnt(6)
    v_mfma_f32_16x16x32_bf16 v[128:131], v[244:247], v[24:27], v[128:131]
    ds_read_b64_tr_b16 v[236:237], v5 offset:16416
    v_mfma_f32_16x16x32_bf16 v[132:135], v[244:247], v[28:31], v[132:135]
    ds_read_b64_tr_b16 v[238:239], v5 offset:17440
    s_waitcnt lgkmcnt(6)
    v_mfma_f32_16x16x32_bf16 v[136:139], v[224:227], v[24:27], v[136:139]
    ds_read_b64_tr_b16 v[240:241], v4 offset:16640
    v_mfma_f32_16x16x32_bf16 v[140:143], v[224:227], v[28:31], v[140:143]
    ds_read_b64_tr_b16 v[242:243], v4 offset:17664
    s_waitcnt lgkmcnt(6)
    v_mfma_f32_16x16x32_bf16 v[144:147], v[228:231], v[24:27], v[144:147]
    ds_read_b64_tr_b16 v[244:245], v5 offset:16672
    v_mfma_f32_16x16x32_bf16 v[148:151], v[228:231], v[28:31], v[148:151]
    ds_read_b64_tr_b16 v[246:247], v5 offset:17696
    s_waitcnt vmcnt(9) lgkmcnt(6)
    v_mfma_f32_16x16x32_bf16 v[88:91], v[232:235], v[32:35], v[88:91]
    ds_read_b64_tr_b16 v[224:225], v4 offset:16896
    s_waitcnt vmcnt(8)
    v_mfma_f32_16x16x32_bf16 v[92:95], v[232:235], v[36:39], v[92:95]
    ds_read_b64_tr_b16 v[226:227], v4 offset:17920
    s_waitcnt lgkmcnt(6)
    v_mfma_f32_16x16x32_bf16 v[96:99], v[236:239], v[32:35], v[96:99]
    ds_read_b64_tr_b16 v[228:229], v5 offset:16928
    v_mfma_f32_16x16x32_bf16 v[100:103], v[236:239], v[36:39], v[100:103]
    ds_read_b64_tr_b16 v[230:231], v5 offset:17952
    s_waitcnt lgkmcnt(6)
    v_mfma_f32_16x16x32_bf16 v[104:107], v[240:243], v[32:35], v[104:107]
    ds_read_b64_tr_b16 v[232:233], v4 offset:17152
    v_mfma_f32_16x16x32_bf16 v[108:111], v[240:243], v[36:39], v[108:111]
    ds_read_b64_tr_b16 v[234:235], v4 offset:18176
    s_waitcnt lgkmcnt(6)
    v_mfma_f32_16x16x32_bf16 v[112:115], v[244:247], v[32:35], v[112:115]
    ds_read_b64_tr_b16 v[236:237], v5 offset:17184
    v_mfma_f32_16x16x32_bf16 v[116:119], v[244:247], v[36:39], v[116:119]
    ds_read_b64_tr_b16 v[238:239], v5 offset:18208
    s_waitcnt lgkmcnt(6)
    v_mfma_f32_16x16x32_bf16 v[120:123], v[224:227], v[32:35], v[120:123]
    v_mfma_f32_16x16x32_bf16 v[124:127], v[224:227], v[36:39], v[124:127]
    s_waitcnt lgkmcnt(4)
    v_mfma_f32_16x16x32_bf16 v[128:131], v[228:231], v[32:35], v[128:131]
    v_mfma_f32_16x16x32_bf16 v[132:135], v[228:231], v[36:39], v[132:135]
    s_waitcnt lgkmcnt(2)
    v_mfma_f32_16x16x32_bf16 v[136:139], v[232:235], v[32:35], v[136:139]
    v_mfma_f32_16x16x32_bf16 v[140:143], v[232:235], v[36:39], v[140:143]
    s_waitcnt lgkmcnt(0)
    v_mfma_f32_16x16x32_bf16 v[144:147], v[236:239], v[32:35], v[144:147]
    v_mfma_f32_16x16x32_bf16 v[148:151], v[236:239], v[36:39], v[148:151]
    s_lshl_b32 s16, s3, 13
    s_xor_b32 s17, s16, 0x8000
    s_add_u32 s16, s16, 0x18000
    s_add_u32 s17, s17, 0x18000
    v_add_u32 v16, s16, v2
    s_mov_b32 s16, s17
    v_add_u32 v17, s16, v2
    ds_write_b128 v16, v[88:91] offset:0
    ds_write_b128 v16, v[92:95] offset:1024
    ds_write_b128 v16, v[96:99] offset:2048
    ds_write_b128 v16, v[100:103] offset:3072
    ds_write_b128 v16, v[104:107] offset:4096
    ds_write_b128 v16, v[108:111] offset:5120
    ds_write_b128 v16, v[112:115] offset:6144
    ds_write_b128 v16, v[116:119] offset:7168
    v_lshlrev_b32 v24, 16, v248
    v_and_b32 v25, 0xffff0000, v248
    v_lshlrev_b32 v26, 16, v249
    v_and_b32 v27, 0xffff0000, v249
    v_lshlrev_b32 v28, 16, v250
    v_and_b32 v29, 0xffff0000, v250
    v_lshlrev_b32 v30, 16, v251
    v_and_b32 v31, 0xffff0000, v251
    v_lshlrev_b32 v32, 16, v252
    v_and_b32 v33, 0xffff0000, v252
    v_lshlrev_b32 v34, 16, v253
    v_and_b32 v35, 0xffff0000, v253
    v_lshlrev_b32 v36, 16, v254
    v_and_b32 v37, 0xffff0000, v254
    v_lshlrev_b32 v38, 16, v255
    v_and_b32 v39, 0xffff0000, v255
    v_and_b32 v18, 15, v1
    v_lshlrev_b32 v18, 6, v18
    v_lshrrev_b32 v19, 4, v1
    v_and_b32 v20, 1, v19
    v_lshl_add_u32 v18, v20, 5, v18
    v_lshrrev_b32 v19, 1, v19
    v_lshl_add_u32 v18, v19, 4, v18
    s_and_b32 s17, s3, 3
    s_lshl_b32 s18, s30, 2
    s_add_u32 s18, s18, s17
    s_lshl_b32 s18, s18, 16
    s_lshl_b32 s19, s15, 22
    s_add_u32 s18, s18, s19
    s_lshl_b32 s19, s31, 12
    s_add_u32 s18, s18, s19
    s_add_u32 s18, s18, 0x2c00800
    s_add_u32 s19, s18, 32768
    s_waitcnt lgkmcnt(0)
    s_barrier
    ds_read_b128 v[40:43], v17 offset:0
    ds_read_b128 v[44:47], v17 offset:1024
    ds_read_b128 v[48:51], v17 offset:2048
    ds_read_b128 v[52:55], v17 offset:3072
    ds_read_b128 v[56:59], v17 offset:4096
    ds_read_b128 v[60:63], v17 offset:5120
    ds_read_b128 v[64:67], v17 offset:6144
    ds_read_b128 v[68:71], v17 offset:7168
    s_waitcnt lgkmcnt(7)
    v_pk_add_f32 v[120:121], v[120:121], v[40:41]
    v_pk_add_f32 v[122:123], v[122:123], v[42:43]
    v_pk_mul_f32 v[120:121], v[120:121], v[24:25]
    v_pk_mul_f32 v[122:123], v[122:123], v[26:27]
    v_cvt_pk_bf16_f32 v224, v120, v121
    v_cvt_pk_bf16_f32 v225, v122, v123
    s_waitcnt lgkmcnt(5)
    v_pk_add_f32 v[128:129], v[128:129], v[48:49]
    v_pk_add_f32 v[130:131], v[130:131], v[50:51]
    v_pk_mul_f32 v[128:129], v[128:129], v[28:29]
    v_pk_mul_f32 v[130:131], v[130:131], v[30:31]
    v_cvt_pk_bf16_f32 v226, v128, v129
    v_cvt_pk_bf16_f32 v227, v130, v131
    s_nop 0
    v_permlane16_swap_b32 v224, v226
    v_permlane16_swap_b32 v225, v227
    buffer_store_dwordx4 v[224:227], v18, s[8:11], s18 offen offset:0 sc1
    v_pk_add_f32 v[124:125], v[124:125], v[44:45]
    v_pk_add_f32 v[126:127], v[126:127], v[46:47]
    v_pk_mul_f32 v[124:125], v[124:125], v[24:25]
    v_pk_mul_f32 v[126:127], v[126:127], v[26:27]
    v_cvt_pk_bf16_f32 v228, v124, v125
    v_cvt_pk_bf16_f32 v229, v126, v127
    s_waitcnt lgkmcnt(4)
    v_pk_add_f32 v[132:133], v[132:133], v[52:53]
    v_pk_add_f32 v[134:135], v[134:135], v[54:55]
    v_pk_mul_f32 v[132:133], v[132:133], v[28:29]
    v_pk_mul_f32 v[134:135], v[134:135], v[30:31]
    v_cvt_pk_bf16_f32 v230, v132, v133
    v_cvt_pk_bf16_f32 v231, v134, v135
    s_nop 0
    v_permlane16_swap_b32 v228, v230
    v_permlane16_swap_b32 v229, v231
    buffer_store_dwordx4 v[228:231], v18, s[8:11], s19 offen offset:0 sc1
    s_waitcnt lgkmcnt(3)
    v_pk_add_f32 v[136:137], v[136:137], v[56:57]
    v_pk_add_f32 v[138:139], v[138:139], v[58:59]
    v_pk_mul_f32 v[136:137], v[136:137], v[32:33]
    v_pk_mul_f32 v[138:139], v[138:139], v[34:35]
    v_cvt_pk_bf16_f32 v232, v136, v137
    v_cvt_pk_bf16_f32 v233, v138, v139
    s_waitcnt lgkmcnt(1)
    v_pk_add_f32 v[144:145], v[144:145], v[64:65]
    v_pk_add_f32 v[146:147], v[146:147], v[66:67]
    v_pk_mul_f32 v[144:145], v[144:145], v[36:37]
    v_pk_mul_f32 v[146:147], v[146:147], v[38:39]
    v_cvt_pk_bf16_f32 v234, v144, v145
    v_cvt_pk_bf16_f32 v235, v146, v147
    s_nop 0
    v_permlane16_swap_b32 v232, v234
    v_permlane16_swap_b32 v233, v235
    buffer_store_dwordx4 v[232:235], v18, s[8:11], s18 offen offset:1024 sc1
    v_pk_add_f32 v[140:141], v[140:141], v[60:61]
    v_pk_add_f32 v[142:143], v[142:143], v[62:63]
    v_pk_mul_f32 v[140:141], v[140:141], v[32:33]
    v_pk_mul_f32 v[142:143], v[142:143], v[34:35]
    v_cvt_pk_bf16_f32 v236, v140, v141
    v_cvt_pk_bf16_f32 v237, v142, v143
    s_waitcnt lgkmcnt(0)
    v_pk_add_f32 v[148:149], v[148:149], v[68:69]
    v_pk_add_f32 v[150:151], v[150:151], v[70:71]
    v_pk_mul_f32 v[148:149], v[148:149], v[36:37]
    v_pk_mul_f32 v[150:151], v[150:151], v[38:39]
    v_cvt_pk_bf16_f32 v238, v148, v149
    v_cvt_pk_bf16_f32 v239, v150, v151
    s_nop 0
    v_permlane16_swap_b32 v236, v238
    v_permlane16_swap_b32 v237, v239
    buffer_store_dwordx4 v[236:239], v18, s[8:11], s19 offen offset:1024 sc1
    s_mov_b64 s[64:65], s[44:45]
    s_mov_b32 s66, 0x800
    s_mov_b32 s67, 0x20000
    s_mov_b64 s[76:77], s[32:33]
    s_mov_b32 s78, 0x400000
    s_mov_b32 s79, 0x20000
    s_mov_b64 s[68:69], s[56:57]
    s_mov_b32 s70, 0x400000
    s_mov_b32 s71, 0x20000
    s_lshl_b32 s14, s31, 1
    s_add_u32 s14, s14, s15
    s_lshl_b32 s14, s14, 3
    s_add_u32 s14, s14, s3
    s_lshl_b32 s16, s30, 7
    s_add_u32 s14, s14, s16
    s_lshl_b32 s16, s14, 11
    buffer_load_dwordx4 v[216:219], v2, s[76:79], s16 offen offset:0
    buffer_load_dwordx4 v[220:223], v2, s[76:79], s16 offen offset:1024
    s_lshl_b32 s16, s3, 10
    s_add_u32 m0, s16, 81920
    s_add_u32 s17, s16, 0x540800
    s_cmp_lt_u32 s3, 6
    s_cselect_b32 s17, s17, 0x7ffffff0
    s_sub_u32 s23, s16, 6144
    s_cmp_ge_u32 s3, 6
    s_cselect_b32 s23, s23, 0x7ffffff0
    s_cbranch_scc1 adaLN_cond__sliding_block_cached__moe_arch_mod__prompt_kernel_mlw
    buffer_load_dwordx4 v2, s[8:11], s17 offen sc1 lds
    s_branch adaLN_cond__sliding_block_cached__moe_arch_mod__prompt_kernel_mlj
adaLN_cond__sliding_block_cached__moe_arch_mod__prompt_kernel_mlw:
    buffer_load_dwordx4 v2, s[64:67], s23 offen lds
adaLN_cond__sliding_block_cached__moe_arch_mod__prompt_kernel_mlj:
    s_lshl_b32 s16, s30, 5
    s_lshl_b32 s17, s31, 1
    s_add_u32 s16, s16, s17
    s_add_u32 s16, s16, s15
    s_lshl_b32 s16, s16, 2
    s_add_u32 s16, s16, 0x530000
    s_cmp_eq_u32 s3, 0
    s_cselect_b32 s16, s16, 0x7ffffff0
    v_mov_b32 v16, s28
    v_mov_b32 v17, 0
    s_lshr_b32 s18, s14, 4
    s_lshl_b32 s18, s18, 15
    s_and_b32 s19, s14, 15
    s_lshl_b32 s19, s19, 6
    s_add_u32 s18, s18, s19
    s_add_u32 s18, s18, 0x2c00000
    s_add_u32 s19, s18, 16384
    v_lshrrev_b32 v18, 2, v1
    v_lshlrev_b32 v18, 10, v18
    v_and_b32 v19, 3, v1
    v_lshl_add_u32 v18, v19, 4, v18
    v_add_u32 v19, 0x400000, v18
    s_lshl_b32 s25, s30, 7
    s_add_u32 s25, s25, 0x530000
    v_and_b32 v20, 15, v1
    v_lshlrev_b32 v20, 2, v20
    s_waitcnt vmcnt(3)
    s_waitcnt vmcnt(0)
    s_barrier
    s_mov_b64 exec, 1
    buffer_store_dword v16, v17, s[8:11], s16 offen sc1
    s_mov_b64 exec, -1
    v_add_u32 v16, 81920, v2
    ds_read_b128 v[184:187], v16 offset:0
    ds_read_b128 v[188:191], v16 offset:1024
    ds_read_b128 v[192:195], v16 offset:2048
    ds_read_b128 v[196:199], v16 offset:3072
    ds_read_b128 v[200:203], v16 offset:4096
    ds_read_b128 v[204:207], v16 offset:5120
    ds_read_b128 v[208:211], v16 offset:6144
    ds_read_b128 v[212:215], v16 offset:7168
    v_mov_b32 v94, 0
    v_mov_b32 v95, 0
    s_waitcnt lgkmcnt(5)
    v_lshlrev_b32 v76, 16, v192
    v_and_b32 v77, 0xffff0000, v192
    s_waitcnt lgkmcnt(1)
    v_lshlrev_b32 v78, 16, v208
    v_and_b32 v79, 0xffff0000, v208
    v_pk_mul_f32 v[60:61], v[76:77], v[78:79]
    v_lshlrev_b32 v76, 16, v184
    v_and_b32 v77, 0xffff0000, v184
    v_fmac_f32 v94, v76, v78
    v_fmac_f32 v94, v77, v79
    v_add_f32 v95, v95, v60
    v_add_f32 v95, v95, v61
    v_lshlrev_b32 v76, 16, v193
    v_and_b32 v77, 0xffff0000, v193
    v_lshlrev_b32 v78, 16, v209
    v_and_b32 v79, 0xffff0000, v209
    v_pk_mul_f32 v[62:63], v[76:77], v[78:79]
    v_lshlrev_b32 v76, 16, v185
    v_and_b32 v77, 0xffff0000, v185
    v_fmac_f32 v94, v76, v78
    v_fmac_f32 v94, v77, v79
    v_add_f32 v95, v95, v62
    v_add_f32 v95, v95, v63
    v_lshlrev_b32 v76, 16, v194
    v_and_b32 v77, 0xffff0000, v194
    v_lshlrev_b32 v78, 16, v210
    v_and_b32 v79, 0xffff0000, v210
    v_pk_mul_f32 v[64:65], v[76:77], v[78:79]
    v_lshlrev_b32 v76, 16, v186
    v_and_b32 v77, 0xffff0000, v186
    v_fmac_f32 v94, v76, v78
    v_fmac_f32 v94, v77, v79
    v_add_f32 v95, v95, v64
    v_add_f32 v95, v95, v65
    v_lshlrev_b32 v76, 16, v195
    v_and_b32 v77, 0xffff0000, v195
    v_lshlrev_b32 v78, 16, v211
    v_and_b32 v79, 0xffff0000, v211
    v_pk_mul_f32 v[66:67], v[76:77], v[78:79]
    v_lshlrev_b32 v76, 16, v187
    v_and_b32 v77, 0xffff0000, v187
    v_fmac_f32 v94, v76, v78
    v_fmac_f32 v94, v77, v79
    v_add_f32 v95, v95, v66
    v_add_f32 v95, v95, v67
    v_lshlrev_b32 v76, 16, v196
    v_and_b32 v77, 0xffff0000, v196
    s_waitcnt lgkmcnt(0)
    v_lshlrev_b32 v78, 16, v212
    v_and_b32 v79, 0xffff0000, v212
    v_pk_mul_f32 v[68:69], v[76:77], v[78:79]
    v_lshlrev_b32 v76, 16, v188
    v_and_b32 v77, 0xffff0000, v188
    v_fmac_f32 v94, v76, v78
    v_fmac_f32 v94, v77, v79
    v_add_f32 v95, v95, v68
    v_add_f32 v95, v95, v69
    v_lshlrev_b32 v76, 16, v197
    v_and_b32 v77, 0xffff0000, v197
    v_lshlrev_b32 v78, 16, v213
    v_and_b32 v79, 0xffff0000, v213
    v_pk_mul_f32 v[70:71], v[76:77], v[78:79]
    v_lshlrev_b32 v76, 16, v189
    v_and_b32 v77, 0xffff0000, v189
    v_fmac_f32 v94, v76, v78
    v_fmac_f32 v94, v77, v79
    v_add_f32 v95, v95, v70
    v_add_f32 v95, v95, v71
    v_lshlrev_b32 v76, 16, v198
    v_and_b32 v77, 0xffff0000, v198
    v_lshlrev_b32 v78, 16, v214
    v_and_b32 v79, 0xffff0000, v214
    v_pk_mul_f32 v[72:73], v[76:77], v[78:79]
    v_lshlrev_b32 v76, 16, v190
    v_and_b32 v77, 0xffff0000, v190
    v_fmac_f32 v94, v76, v78
    v_fmac_f32 v94, v77, v79
    v_add_f32 v95, v95, v72
    v_add_f32 v95, v95, v73
    v_lshlrev_b32 v76, 16, v199
    v_and_b32 v77, 0xffff0000, v199
    v_lshlrev_b32 v78, 16, v215
    v_and_b32 v79, 0xffff0000, v215
    v_pk_mul_f32 v[74:75], v[76:77], v[78:79]
    v_lshlrev_b32 v76, 16, v191
    v_and_b32 v77, 0xffff0000, v191
    v_fmac_f32 v94, v76, v78
    v_fmac_f32 v94, v77, v79
    v_add_f32 v95, v95, v74
    v_add_f32 v95, v95, v75
    v_add_f32_dpp v94, v94, v94 row_ror:1 row_mask:0xf bank_mask:0xf
    s_nop 0
    v_add_f32_dpp v95, v95, v95 row_ror:1 row_mask:0xf bank_mask:0xf
    v_add_f32_dpp v94, v94, v94 row_ror:2 row_mask:0xf bank_mask:0xf
    s_nop 0
    v_add_f32_dpp v95, v95, v95 row_ror:2 row_mask:0xf bank_mask:0xf
    v_add_f32_dpp v94, v94, v94 row_ror:4 row_mask:0xf bank_mask:0xf
    s_nop 0
    v_add_f32_dpp v95, v95, v95 row_ror:4 row_mask:0xf bank_mask:0xf
    v_add_f32_dpp v94, v94, v94 row_ror:8 row_mask:0xf bank_mask:0xf
    s_nop 0
    v_add_f32_dpp v95, v95, v95 row_ror:8 row_mask:0xf bank_mask:0xf
    v_mov_b32 v76, v94
    s_nop 1
    v_permlane16_swap_b32 v94, v76
    v_add_f32 v94, v94, v76
    v_mov_b32 v77, v95
    s_nop 1
    v_permlane16_swap_b32 v95, v77
    v_add_f32 v95, v95, v77
    v_mov_b32 v76, v94
    s_nop 1
    v_permlane32_swap_b32 v94, v76
    v_add_f32 v94, v94, v76
    v_mov_b32 v77, v95
    s_nop 1
    v_permlane32_swap_b32 v95, v77
    v_add_f32 v95, v95, v77
    v_lshlrev_b32 v28, 16, v216
    v_and_b32 v29, 0xffff0000, v216
    v_lshlrev_b32 v30, 16, v217
    v_and_b32 v31, 0xffff0000, v217
    v_lshlrev_b32 v32, 16, v218
    v_and_b32 v33, 0xffff0000, v218
    v_lshlrev_b32 v34, 16, v219
    v_and_b32 v35, 0xffff0000, v219
    v_lshlrev_b32 v36, 16, v220
    v_and_b32 v37, 0xffff0000, v220
    v_lshlrev_b32 v38, 16, v221
    v_and_b32 v39, 0xffff0000, v221
    v_lshlrev_b32 v40, 16, v222
    v_and_b32 v41, 0xffff0000, v222
    v_lshlrev_b32 v42, 16, v223
    v_and_b32 v43, 0xffff0000, v223
    s_sleep 16
    s_mov_b32 s27, 0
adaLN_cond__sliding_block_cached__moe_arch_mod__prompt_kernel_a22p:
    buffer_load_dword v76, v20, s[8:11], s25 offen sc1
    s_waitcnt vmcnt(0)
    v_cmp_ne_u32 vcc, s28, v76
    s_add_u32 s27, s27, 1
    s_cmp_ge_u32 s27, 262144
    s_cbranch_scc1 adaLN_cond__sliding_block_cached__moe_arch_mod__prompt_kernel_a22g
    s_cbranch_vccnz adaLN_cond__sliding_block_cached__moe_arch_mod__prompt_kernel_a22p
adaLN_cond__sliding_block_cached__moe_arch_mod__prompt_kernel_a22g:
    buffer_load_dwordx4 v[44:47], v18, s[8:11], s18 offen sc1
    buffer_load_dwordx4 v[52:55], v19, s[8:11], s18 offen sc1
    buffer_load_dwordx4 v[48:51], v18, s[8:11], s19 offen sc1
    buffer_load_dwordx4 v[56:59], v19, s[8:11], s19 offen sc1
    v_lshlrev_b32 v21, 2, v0
    s_mov_b32 s16, 0x540800
    buffer_load_dword v106, v21, s[8:11], s16 offen sc1
    buffer_load_dword v104, v21, s[8:11], s16 offen offset:2048 sc1
    s_waitcnt vmcnt(5)
    v_lshlrev_b32 v76, 16, v44
    v_and_b32 v77, 0xffff0000, v44
    s_waitcnt vmcnt(4)
    v_lshlrev_b32 v78, 16, v52
    v_and_b32 v79, 0xffff0000, v52
    v_pk_add_f32 v[76:77], v[76:77], v[78:79]
    v_pk_add_f32 v[28:29], v[28:29], v[76:77]
    v_cvt_pk_bf16_f32 v16, v28, v29
    v_lshlrev_b32 v28, 16, v16
    v_and_b32 v29, 0xffff0000, v16
    v_lshlrev_b32 v80, 16, v45
    v_and_b32 v81, 0xffff0000, v45
    v_lshlrev_b32 v82, 16, v53
    v_and_b32 v83, 0xffff0000, v53
    v_pk_add_f32 v[80:81], v[80:81], v[82:83]
    v_pk_add_f32 v[30:31], v[30:31], v[80:81]
    v_cvt_pk_bf16_f32 v17, v30, v31
    v_lshlrev_b32 v30, 16, v17
    v_and_b32 v31, 0xffff0000, v17
    v_lshlrev_b32 v76, 16, v46
    v_and_b32 v77, 0xffff0000, v46
    v_lshlrev_b32 v78, 16, v54
    v_and_b32 v79, 0xffff0000, v54
    v_pk_add_f32 v[76:77], v[76:77], v[78:79]
    v_pk_add_f32 v[32:33], v[32:33], v[76:77]
    v_cvt_pk_bf16_f32 v16, v32, v33
    v_lshlrev_b32 v32, 16, v16
    v_and_b32 v33, 0xffff0000, v16
    v_lshlrev_b32 v80, 16, v47
    v_and_b32 v81, 0xffff0000, v47
    v_lshlrev_b32 v82, 16, v55
    v_and_b32 v83, 0xffff0000, v55
    v_pk_add_f32 v[80:81], v[80:81], v[82:83]
    v_pk_add_f32 v[34:35], v[34:35], v[80:81]
    v_cvt_pk_bf16_f32 v17, v34, v35
    v_lshlrev_b32 v34, 16, v17
    v_and_b32 v35, 0xffff0000, v17
    s_waitcnt vmcnt(3)
    v_lshlrev_b32 v76, 16, v48
    v_and_b32 v77, 0xffff0000, v48
    s_waitcnt vmcnt(2)
    v_lshlrev_b32 v78, 16, v56
    v_and_b32 v79, 0xffff0000, v56
    v_pk_add_f32 v[76:77], v[76:77], v[78:79]
    v_pk_add_f32 v[36:37], v[36:37], v[76:77]
    v_cvt_pk_bf16_f32 v16, v36, v37
    v_lshlrev_b32 v36, 16, v16
    v_and_b32 v37, 0xffff0000, v16
    v_lshlrev_b32 v80, 16, v49
    v_and_b32 v81, 0xffff0000, v49
    v_lshlrev_b32 v82, 16, v57
    v_and_b32 v83, 0xffff0000, v57
    v_pk_add_f32 v[80:81], v[80:81], v[82:83]
    v_pk_add_f32 v[38:39], v[38:39], v[80:81]
    v_cvt_pk_bf16_f32 v17, v38, v39
    v_lshlrev_b32 v38, 16, v17
    v_and_b32 v39, 0xffff0000, v17
    v_lshlrev_b32 v76, 16, v50
    v_and_b32 v77, 0xffff0000, v50
    v_lshlrev_b32 v78, 16, v58
    v_and_b32 v79, 0xffff0000, v58
    v_pk_add_f32 v[76:77], v[76:77], v[78:79]
    v_pk_add_f32 v[40:41], v[40:41], v[76:77]
    v_cvt_pk_bf16_f32 v16, v40, v41
    v_lshlrev_b32 v40, 16, v16
    v_and_b32 v41, 0xffff0000, v16
    v_lshlrev_b32 v80, 16, v51
    v_and_b32 v81, 0xffff0000, v51
    v_lshlrev_b32 v82, 16, v59
    v_and_b32 v83, 0xffff0000, v59
    v_pk_add_f32 v[80:81], v[80:81], v[82:83]
    v_pk_add_f32 v[42:43], v[42:43], v[80:81]
    v_cvt_pk_bf16_f32 v17, v42, v43
    v_lshlrev_b32 v42, 16, v17
    v_and_b32 v43, 0xffff0000, v17
    v_pk_add_f32 v[76:77], v[28:29], v[30:31]
    v_pk_mul_f32 v[78:79], v[28:29], v[28:29]
    v_pk_mul_f32 v[80:81], v[28:29], v[60:61]
    v_pk_fma_f32 v[78:79], v[30:31], v[30:31], v[78:79]
    v_pk_fma_f32 v[80:81], v[30:31], v[62:63], v[80:81]
    v_pk_add_f32 v[76:77], v[76:77], v[32:33]
    v_pk_fma_f32 v[78:79], v[32:33], v[32:33], v[78:79]
    v_pk_fma_f32 v[80:81], v[32:33], v[64:65], v[80:81]
    v_pk_add_f32 v[76:77], v[76:77], v[34:35]
    v_pk_fma_f32 v[78:79], v[34:35], v[34:35], v[78:79]
    v_pk_fma_f32 v[80:81], v[34:35], v[66:67], v[80:81]
    v_pk_add_f32 v[76:77], v[76:77], v[36:37]
    v_pk_fma_f32 v[78:79], v[36:37], v[36:37], v[78:79]
    v_pk_fma_f32 v[80:81], v[36:37], v[68:69], v[80:81]
    v_pk_add_f32 v[76:77], v[76:77], v[38:39]
    v_pk_fma_f32 v[78:79], v[38:39], v[38:39], v[78:79]
    v_pk_fma_f32 v[80:81], v[38:39], v[70:71], v[80:81]
    v_pk_add_f32 v[76:77], v[76:77], v[40:41]
    v_pk_fma_f32 v[78:79], v[40:41], v[40:41], v[78:79]
    v_pk_fma_f32 v[80:81], v[40:41], v[72:73], v[80:81]
    v_pk_add_f32 v[76:77], v[76:77], v[42:43]
    v_pk_fma_f32 v[78:79], v[42:43], v[42:43], v[78:79]
    v_pk_fma_f32 v[80:81], v[42:43], v[74:75], v[80:81]
    v_add_f32 v96, v76, v77
    v_add_f32 v97, v78, v79
    v_add_f32 v98, v80, v81
    v_add_f32_dpp v96, v96, v96 row_ror:1 row_mask:0xf bank_mask:0xf
    v_add_f32_dpp v97, v97, v97 row_ror:1 row_mask:0xf bank_mask:0xf
    v_add_f32_dpp v98, v98, v98 row_ror:1 row_mask:0xf bank_mask:0xf
    v_add_f32_dpp v96, v96, v96 row_ror:2 row_mask:0xf bank_mask:0xf
    v_add_f32_dpp v97, v97, v97 row_ror:2 row_mask:0xf bank_mask:0xf
    v_add_f32_dpp v98, v98, v98 row_ror:2 row_mask:0xf bank_mask:0xf
    v_add_f32_dpp v96, v96, v96 row_ror:4 row_mask:0xf bank_mask:0xf
    v_add_f32_dpp v97, v97, v97 row_ror:4 row_mask:0xf bank_mask:0xf
    v_add_f32_dpp v98, v98, v98 row_ror:4 row_mask:0xf bank_mask:0xf
    v_add_f32_dpp v96, v96, v96 row_ror:8 row_mask:0xf bank_mask:0xf
    v_add_f32_dpp v97, v97, v97 row_ror:8 row_mask:0xf bank_mask:0xf
    v_add_f32_dpp v98, v98, v98 row_ror:8 row_mask:0xf bank_mask:0xf
    v_mov_b32 v76, v96
    s_nop 1
    v_permlane16_swap_b32 v96, v76
    v_add_f32 v96, v96, v76
    v_mov_b32 v77, v97
    s_nop 1
    v_permlane16_swap_b32 v97, v77
    v_add_f32 v97, v97, v77
    v_mov_b32 v78, v98
    s_nop 1
    v_permlane16_swap_b32 v98, v78
    v_add_f32 v98, v98, v78
    v_mov_b32 v76, v96
    s_nop 1
    v_permlane32_swap_b32 v96, v76
    v_add_f32 v96, v96, v76
    v_mov_b32 v77, v97
    s_nop 1
    v_permlane32_swap_b32 v97, v77
    v_add_f32 v97, v97, v77
    v_mov_b32 v78, v98
    s_nop 1
    v_permlane32_swap_b32 v98, v78
    v_add_f32 v98, v98, v78
    v_mul_f32 v96, 0x3a800000, v96
    v_mul_f32 v97, 0x3a800000, v97
    v_fma_f32 v97, -v96, v96, v97
    v_max_f32 v97, 0, v97
    v_fma_f32 v98, -v96, v95, v98
    v_add_f32 v76, 0x3727c5ac, v97
    v_rsq_f32 v76, v76
    s_nop 0
    v_fma_f32 v27, v98, v76, v94
    v_cvt_pk_bf16_f32 v96, v96, v96
    v_lshlrev_b32 v96, 16, v96
    v_cvt_pk_bf16_f32 v97, v97, v97
    v_lshlrev_b32 v97, 16, v97
    v_add_f32 v97, 0x3727c5ac, v97
    v_cvt_pk_bf16_f32 v97, v97, v97
    v_lshlrev_b32 v97, 16, v97
    v_sqrt_f32 v98, v97
    s_nop 0
    v_cvt_pk_bf16_f32 v98, v98, v98
    v_lshlrev_b32 v98, 16, v98
    v_rcp_f32 v99, v98
    v_mov_b32 v25, v96
    v_mov_b32 v26, v98
    v_ashrrev_i32 v16, 31, v27
    v_or_b32 v16, 0x80000000, v16
    v_xor_b32 v24, v27, v16
    v_and_b32 v24, 0xfffff800, v24
    v_max_u32 v24, 0x800, v24
    s_sub_u32 s16, 2047, s14
    v_or_b32 v24, s16, v24
    s_lshl_b32 s16, s3, 4
    s_add_u32 s16, s16, 65536
    v_mov_b32 v16, s16
    ds_write_b128 v16, v[24:27]
    s_waitcnt lgkmcnt(0)
    s_barrier
    v_and_b32 v16, 7, v1
    v_lshlrev_b32 v16, 4, v16
    v_add_u32 v16, 65536, v16
    ds_read_b32 v76, v16
    s_waitcnt lgkmcnt(0)
    v_mov_b32 v77, v76
    s_nop 1
    v_max_u32_dpp v77, v77, v77 row_ror:1 row_mask:0xf bank_mask:0xf
    s_nop 1
    v_max_u32_dpp v77, v77, v77 row_ror:2 row_mask:0xf bank_mask:0xf
    s_nop 1
    v_max_u32_dpp v77, v77, v77 row_ror:4 row_mask:0xf bank_mask:0xf
    v_cmp_eq_u32 vcc, v76, v77
    s_ff1_i32_b64 s16, vcc
    s_lshl_b32 s16, s16, 4
    s_add_u32 s16, s16, 65536
    v_mov_b32 v16, s16
    ds_read_b128 v[24:27], v16
    s_lshl_b32 s16, s2, 4
    s_add_u32 s16, s16, 0x6e0000
    s_cmp_eq_u32 s3, 0
    s_cselect_b32 s16, s16, 0x7ffffff0
    v_mov_b32 v17, 0
    s_mov_b64 exec, 1
    s_waitcnt lgkmcnt(0)
    buffer_store_dwordx4 v[24:27], v17, s[8:11], s16 offen sc1
    s_mov_b64 exec, -1
    s_mov_b64 s[72:73], s[50:51]
    s_mov_b32 s74, 0x700000
    s_mov_b32 s75, 0x20000
    s_cmp_lt_u32 s2, 224
    s_cselect_b32 s74, 7340032, 0
    s_lshl_b32 s17, s29, 4
    s_sub_u32 s16, s3, 4
    s_lshl_b32 s16, s16, 2
    s_add_u32 s16, s16, s17
    s_lshl_b32 s16, s16, 11
    s_add_u32 s17, s16, 0
    buffer_load_dwordx4 v[152:155], v2, s[72:75], s17 offen offset:0
    buffer_load_dwordx4 v[156:159], v2, s[72:75], s17 offen offset:1024
    s_add_u32 s17, s16, 2048
    buffer_load_dwordx4 v[160:163], v2, s[72:75], s17 offen offset:0
    buffer_load_dwordx4 v[164:167], v2, s[72:75], s17 offen offset:1024
    s_add_u32 s17, s16, 4096
    buffer_load_dwordx4 v[168:171], v2, s[72:75], s17 offen offset:0
    buffer_load_dwordx4 v[172:175], v2, s[72:75], s17 offen offset:1024
    s_add_u32 s17, s16, 6144
    buffer_load_dwordx4 v[176:179], v2, s[72:75], s17 offen offset:0
    buffer_load_dwordx4 v[180:183], v2, s[72:75], s17 offen offset:1024
    v_sub_f32 v44, v28, v96
    v_sub_f32 v45, v29, v96
    v_sub_f32 v46, v30, v96
    v_sub_f32 v47, v31, v96
    v_sub_f32 v48, v32, v96
    v_sub_f32 v49, v33, v96
    v_sub_f32 v50, v34, v96
    v_sub_f32 v51, v35, v96
    v_cvt_pk_bf16_f32 v16, v44, v45
    v_lshlrev_b32 v44, 16, v16
    v_and_b32 v45, 0xffff0000, v16
    v_cvt_pk_bf16_f32 v16, v46, v47
    v_lshlrev_b32 v46, 16, v16
    v_and_b32 v47, 0xffff0000, v16
    v_cvt_pk_bf16_f32 v16, v48, v49
    v_lshlrev_b32 v48, 16, v16
    v_and_b32 v49, 0xffff0000, v16
    v_cvt_pk_bf16_f32 v16, v50, v51
    v_lshlrev_b32 v50, 16, v16
    v_and_b32 v51, 0xffff0000, v16
    v_mul_f32 v52, v44, v99
    v_mul_f32 v53, v45, v99
    v_mul_f32 v54, v46, v99
    v_mul_f32 v55, v47, v99
    v_mul_f32 v56, v48, v99
    v_mul_f32 v57, v49, v99
    v_mul_f32 v58, v50, v99
    v_mul_f32 v59, v51, v99
    v_fma_f32 v44, -v52, v98, v44
    v_fma_f32 v45, -v53, v98, v45
    v_fma_f32 v46, -v54, v98, v46
    v_fma_f32 v47, -v55, v98, v47
    v_fma_f32 v48, -v56, v98, v48
    v_fma_f32 v49, -v57, v98, v49
    v_fma_f32 v50, -v58, v98, v50
    v_fma_f32 v51, -v59, v98, v51
    v_fma_f32 v44, v44, v99, v52
    v_fma_f32 v45, v45, v99, v53
    v_fma_f32 v46, v46, v99, v54
    v_fma_f32 v47, v47, v99, v55
    v_fma_f32 v48, v48, v99, v56
    v_fma_f32 v49, v49, v99, v57
    v_fma_f32 v50, v50, v99, v58
    v_fma_f32 v51, v51, v99, v59
    v_cvt_pk_bf16_f32 v16, v44, v45
    v_lshlrev_b32 v44, 16, v16
    v_and_b32 v45, 0xffff0000, v16
    v_cvt_pk_bf16_f32 v16, v46, v47
    v_lshlrev_b32 v46, 16, v16
    v_and_b32 v47, 0xffff0000, v16
    v_cvt_pk_bf16_f32 v16, v48, v49
    v_lshlrev_b32 v48, 16, v16
    v_and_b32 v49, 0xffff0000, v16
    v_cvt_pk_bf16_f32 v16, v50, v51
    v_lshlrev_b32 v50, 16, v16
    v_and_b32 v51, 0xffff0000, v16
    v_lshlrev_b32 v52, 16, v192
    v_and_b32 v53, 0xffff0000, v192
    v_lshlrev_b32 v54, 16, v193
    v_and_b32 v55, 0xffff0000, v193
    v_lshlrev_b32 v56, 16, v194
    v_and_b32 v57, 0xffff0000, v194
    v_lshlrev_b32 v58, 16, v195
    v_and_b32 v59, 0xffff0000, v195
    v_pk_mul_f32 v[44:45], v[44:45], v[52:53]
    v_pk_mul_f32 v[46:47], v[46:47], v[54:55]
    v_pk_mul_f32 v[48:49], v[48:49], v[56:57]
    v_pk_mul_f32 v[50:51], v[50:51], v[58:59]
    v_cvt_pk_bf16_f32 v16, v44, v45
    v_lshlrev_b32 v44, 16, v16
    v_and_b32 v45, 0xffff0000, v16
    v_cvt_pk_bf16_f32 v16, v46, v47
    v_lshlrev_b32 v46, 16, v16
    v_and_b32 v47, 0xffff0000, v16
    v_cvt_pk_bf16_f32 v16, v48, v49
    v_lshlrev_b32 v48, 16, v16
    v_and_b32 v49, 0xffff0000, v16
    v_cvt_pk_bf16_f32 v16, v50, v51
    v_lshlrev_b32 v50, 16, v16
    v_and_b32 v51, 0xffff0000, v16
    v_lshlrev_b32 v52, 16, v184
    v_and_b32 v53, 0xffff0000, v184
    v_lshlrev_b32 v54, 16, v185
    v_and_b32 v55, 0xffff0000, v185
    v_lshlrev_b32 v56, 16, v186
    v_and_b32 v57, 0xffff0000, v186
    v_lshlrev_b32 v58, 16, v187
    v_and_b32 v59, 0xffff0000, v187
    v_pk_add_f32 v[44:45], v[44:45], v[52:53]
    v_pk_add_f32 v[46:47], v[46:47], v[54:55]
    v_pk_add_f32 v[48:49], v[48:49], v[56:57]
    v_pk_add_f32 v[50:51], v[50:51], v[58:59]
    v_cvt_pk_bf16_f32 v16, v44, v45
    v_lshlrev_b32 v44, 16, v16
    v_and_b32 v45, 0xffff0000, v16
    v_cvt_pk_bf16_f32 v16, v46, v47
    v_lshlrev_b32 v46, 16, v16
    v_and_b32 v47, 0xffff0000, v16
    v_cvt_pk_bf16_f32 v16, v48, v49
    v_lshlrev_b32 v48, 16, v16
    v_and_b32 v49, 0xffff0000, v16
    v_cvt_pk_bf16_f32 v16, v50, v51
    v_lshlrev_b32 v50, 16, v16
    v_and_b32 v51, 0xffff0000, v16
    v_lshlrev_b32 v52, 16, v200
    v_and_b32 v53, 0xffff0000, v200
    v_lshlrev_b32 v54, 16, v201
    v_and_b32 v55, 0xffff0000, v201
    v_lshlrev_b32 v56, 16, v202
    v_and_b32 v57, 0xffff0000, v202
    v_lshlrev_b32 v58, 16, v203
    v_and_b32 v59, 0xffff0000, v203
    v_pk_mul_f32 v[44:45], v[44:45], v[52:53]
    v_pk_mul_f32 v[46:47], v[46:47], v[54:55]
    v_pk_mul_f32 v[48:49], v[48:49], v[56:57]
    v_pk_mul_f32 v[50:51], v[50:51], v[58:59]
    v_cvt_pk_bf16_f32 v16, v44, v45
    v_lshlrev_b32 v44, 16, v16
    v_and_b32 v45, 0xffff0000, v16
    v_cvt_pk_bf16_f32 v16, v46, v47
    v_lshlrev_b32 v46, 16, v16
    v_and_b32 v47, 0xffff0000, v16
    v_cvt_pk_bf16_f32 v16, v48, v49
    v_lshlrev_b32 v48, 16, v16
    v_and_b32 v49, 0xffff0000, v16
    v_cvt_pk_bf16_f32 v16, v50, v51
    v_lshlrev_b32 v50, 16, v16
    v_and_b32 v51, 0xffff0000, v16
    v_pk_add_f32 v[44:45], v[44:45], v[28:29]
    v_pk_add_f32 v[46:47], v[46:47], v[30:31]
    v_pk_add_f32 v[48:49], v[48:49], v[32:33]
    v_pk_add_f32 v[50:51], v[50:51], v[34:35]
    v_cvt_pk_bf16_f32 v28, v44, v45
    v_cvt_pk_bf16_f32 v29, v46, v47
    v_cvt_pk_bf16_f32 v30, v48, v49
    v_cvt_pk_bf16_f32 v31, v50, v51
    v_sub_f32 v44, v36, v96
    v_sub_f32 v45, v37, v96
    v_sub_f32 v46, v38, v96
    v_sub_f32 v47, v39, v96
    v_sub_f32 v48, v40, v96
    v_sub_f32 v49, v41, v96
    v_sub_f32 v50, v42, v96
    v_sub_f32 v51, v43, v96
    v_cvt_pk_bf16_f32 v16, v44, v45
    v_lshlrev_b32 v44, 16, v16
    v_and_b32 v45, 0xffff0000, v16
    v_cvt_pk_bf16_f32 v16, v46, v47
    v_lshlrev_b32 v46, 16, v16
    v_and_b32 v47, 0xffff0000, v16
    v_cvt_pk_bf16_f32 v16, v48, v49
    v_lshlrev_b32 v48, 16, v16
    v_and_b32 v49, 0xffff0000, v16
    v_cvt_pk_bf16_f32 v16, v50, v51
    v_lshlrev_b32 v50, 16, v16
    v_and_b32 v51, 0xffff0000, v16
    v_mul_f32 v52, v44, v99
    v_mul_f32 v53, v45, v99
    v_mul_f32 v54, v46, v99
    v_mul_f32 v55, v47, v99
    v_mul_f32 v56, v48, v99
    v_mul_f32 v57, v49, v99
    v_mul_f32 v58, v50, v99
    v_mul_f32 v59, v51, v99
    v_fma_f32 v44, -v52, v98, v44
    v_fma_f32 v45, -v53, v98, v45
    v_fma_f32 v46, -v54, v98, v46
    v_fma_f32 v47, -v55, v98, v47
    v_fma_f32 v48, -v56, v98, v48
    v_fma_f32 v49, -v57, v98, v49
    v_fma_f32 v50, -v58, v98, v50
    v_fma_f32 v51, -v59, v98, v51
    v_fma_f32 v44, v44, v99, v52
    v_fma_f32 v45, v45, v99, v53
    v_fma_f32 v46, v46, v99, v54
    v_fma_f32 v47, v47, v99, v55
    v_fma_f32 v48, v48, v99, v56
    v_fma_f32 v49, v49, v99, v57
    v_fma_f32 v50, v50, v99, v58
    v_fma_f32 v51, v51, v99, v59
    v_cvt_pk_bf16_f32 v16, v44, v45
    v_lshlrev_b32 v44, 16, v16
    v_and_b32 v45, 0xffff0000, v16
    v_cvt_pk_bf16_f32 v16, v46, v47
    v_lshlrev_b32 v46, 16, v16
    v_and_b32 v47, 0xffff0000, v16
    v_cvt_pk_bf16_f32 v16, v48, v49
    v_lshlrev_b32 v48, 16, v16
    v_and_b32 v49, 0xffff0000, v16
    v_cvt_pk_bf16_f32 v16, v50, v51
    v_lshlrev_b32 v50, 16, v16
    v_and_b32 v51, 0xffff0000, v16
    v_lshlrev_b32 v52, 16, v196
    v_and_b32 v53, 0xffff0000, v196
    v_lshlrev_b32 v54, 16, v197
    v_and_b32 v55, 0xffff0000, v197
    v_lshlrev_b32 v56, 16, v198
    v_and_b32 v57, 0xffff0000, v198
    v_lshlrev_b32 v58, 16, v199
    v_and_b32 v59, 0xffff0000, v199
    v_pk_mul_f32 v[44:45], v[44:45], v[52:53]
    v_pk_mul_f32 v[46:47], v[46:47], v[54:55]
    v_pk_mul_f32 v[48:49], v[48:49], v[56:57]
    v_pk_mul_f32 v[50:51], v[50:51], v[58:59]
    v_cvt_pk_bf16_f32 v16, v44, v45
    v_lshlrev_b32 v44, 16, v16
    v_and_b32 v45, 0xffff0000, v16
    v_cvt_pk_bf16_f32 v16, v46, v47
    v_lshlrev_b32 v46, 16, v16
    v_and_b32 v47, 0xffff0000, v16
    v_cvt_pk_bf16_f32 v16, v48, v49
    v_lshlrev_b32 v48, 16, v16
    v_and_b32 v49, 0xffff0000, v16
    v_cvt_pk_bf16_f32 v16, v50, v51
    v_lshlrev_b32 v50, 16, v16
    v_and_b32 v51, 0xffff0000, v16
    v_lshlrev_b32 v52, 16, v188
    v_and_b32 v53, 0xffff0000, v188
    v_lshlrev_b32 v54, 16, v189
    v_and_b32 v55, 0xffff0000, v189
    v_lshlrev_b32 v56, 16, v190
    v_and_b32 v57, 0xffff0000, v190
    v_lshlrev_b32 v58, 16, v191
    v_and_b32 v59, 0xffff0000, v191
    v_pk_add_f32 v[44:45], v[44:45], v[52:53]
    v_pk_add_f32 v[46:47], v[46:47], v[54:55]
    v_pk_add_f32 v[48:49], v[48:49], v[56:57]
    v_pk_add_f32 v[50:51], v[50:51], v[58:59]
    v_cvt_pk_bf16_f32 v16, v44, v45
    v_lshlrev_b32 v44, 16, v16
    v_and_b32 v45, 0xffff0000, v16
    v_cvt_pk_bf16_f32 v16, v46, v47
    v_lshlrev_b32 v46, 16, v16
    v_and_b32 v47, 0xffff0000, v16
    v_cvt_pk_bf16_f32 v16, v48, v49
    v_lshlrev_b32 v48, 16, v16
    v_and_b32 v49, 0xffff0000, v16
    v_cvt_pk_bf16_f32 v16, v50, v51
    v_lshlrev_b32 v50, 16, v16
    v_and_b32 v51, 0xffff0000, v16
    v_lshlrev_b32 v52, 16, v204
    v_and_b32 v53, 0xffff0000, v204
    v_lshlrev_b32 v54, 16, v205
    v_and_b32 v55, 0xffff0000, v205
    v_lshlrev_b32 v56, 16, v206
    v_and_b32 v57, 0xffff0000, v206
    v_lshlrev_b32 v58, 16, v207
    v_and_b32 v59, 0xffff0000, v207
    v_pk_mul_f32 v[44:45], v[44:45], v[52:53]
    v_pk_mul_f32 v[46:47], v[46:47], v[54:55]
    v_pk_mul_f32 v[48:49], v[48:49], v[56:57]
    v_pk_mul_f32 v[50:51], v[50:51], v[58:59]
    v_cvt_pk_bf16_f32 v16, v44, v45
    v_lshlrev_b32 v44, 16, v16
    v_and_b32 v45, 0xffff0000, v16
    v_cvt_pk_bf16_f32 v16, v46, v47
    v_lshlrev_b32 v46, 16, v16
    v_and_b32 v47, 0xffff0000, v16
    v_cvt_pk_bf16_f32 v16, v48, v49
    v_lshlrev_b32 v48, 16, v16
    v_and_b32 v49, 0xffff0000, v16
    v_cvt_pk_bf16_f32 v16, v50, v51
    v_lshlrev_b32 v50, 16, v16
    v_and_b32 v51, 0xffff0000, v16
    v_pk_add_f32 v[44:45], v[44:45], v[36:37]
    v_pk_add_f32 v[46:47], v[46:47], v[38:39]
    v_pk_add_f32 v[48:49], v[48:49], v[40:41]
    v_pk_add_f32 v[50:51], v[50:51], v[42:43]
    v_cvt_pk_bf16_f32 v36, v44, v45
    v_cvt_pk_bf16_f32 v37, v46, v47
    v_cvt_pk_bf16_f32 v38, v48, v49
    v_cvt_pk_bf16_f32 v39, v50, v51
    s_barrier
    v_and_b32 v16, 3, v1
    v_lshlrev_b32 v16, 4, v16
    v_add_u32 v16, 65792, v16
    ds_read_b32 v76, v16
    s_waitcnt lgkmcnt(0)
    v_mov_b32 v77, v76
    s_nop 1
    v_max_u32_dpp v77, v77, v77 row_ror:1 row_mask:0xf bank_mask:0xf
    s_nop 1
    v_max_u32_dpp v77, v77, v77 row_ror:2 row_mask:0xf bank_mask:0xf
    v_cmp_eq_u32 vcc, v76, v77
    s_ff1_i32_b64 s16, vcc
    s_lshl_b32 s16, s16, 4
    s_add_u32 s16, s16, 65792
    v_mov_b32 v16, s16
    ds_read_b128 v[24:27], v16
    s_waitcnt lgkmcnt(0)
    v_and_b32 v76, 0x7ff, v24
    v_sub_u32 v76, 2047, v76
    s_nop 0
    v_readfirstlane_b32 s12, v76
    v_rcp_f32 v103, v26
    s_lshr_b32 s18, s12, 4
    s_lshl_b32 s18, s18, 15
    s_and_b32 s19, s12, 15
    s_lshl_b32 s19, s19, 6
    s_add_u32 s18, s18, s19
    s_add_u32 s18, s18, 0x2c00000
    s_add_u32 s19, s18, 0x400000
    v_lshrrev_b32 v18, 4, v0
    v_lshlrev_b32 v18, 10, v18
    v_and_b32 v19, 15, v0
    v_lshl_add_u32 v18, v19, 2, v18
    s_lshl_b32 s13, s12, 11
    buffer_load_dword v100, v18, s[8:11], s18 offen sc1
    buffer_load_dword v101, v18, s[8:11], s19 offen sc1
    buffer_load_dword v102, v21, s[76:79], s13 offen
    s_lshl_b32 s16, s14, 11
    s_cmp_lg_u32 s12, s14
    s_cselect_b32 s16, s16, 0x7ffffff0
    buffer_store_dwordx4 v[28:31], v2, s[68:71], s16 offen offset:0 sc1
    buffer_store_dwordx4 v[36:39], v2, s[68:71], s16 offen offset:1024 sc1
    s_lshl_b32 s16, s3, 13
    v_add_u32 v20, s16, v2
    s_waitcnt vmcnt(4)
    v_lshlrev_b32 v76, 16, v100
    v_and_b32 v77, 0xffff0000, v100
    s_waitcnt vmcnt(3)
    v_lshlrev_b32 v78, 16, v101
    v_and_b32 v79, 0xffff0000, v101
    v_pk_add_f32 v[76:77], v[76:77], v[78:79]
    s_waitcnt vmcnt(2)
    v_lshlrev_b32 v78, 16, v102
    v_and_b32 v79, 0xffff0000, v102
    v_pk_add_f32 v[92:93], v[78:79], v[76:77]
    v_cvt_pk_bf16_f32 v76, v92, v93
    v_lshlrev_b32 v92, 16, v76
    v_and_b32 v93, 0xffff0000, v76
    v_cvt_pk_bf16_f32 v100, v92, v93
    v_and_b32 v105, 0xffff0000, v104
    v_lshlrev_b32 v104, 16, v104
    v_and_b32 v107, 0xffff0000, v106
    v_lshlrev_b32 v106, 16, v106
    v_sub_f32 v92, v92, v25
    v_sub_f32 v93, v93, v25
    v_cvt_pk_bf16_f32 v76, v92, v93
    v_lshlrev_b32 v92, 16, v76
    v_and_b32 v93, 0xffff0000, v76
    v_mul_f32 v77, v92, v103
    v_fma_f32 v92, -v77, v26, v92
    v_fma_f32 v92, v92, v103, v77
    v_mul_f32 v77, v93, v103
    v_fma_f32 v93, -v77, v26, v93
    v_fma_f32 v93, v93, v103, v77
    v_cvt_pk_bf16_f32 v76, v92, v93
    v_lshlrev_b32 v92, 16, v76
    v_and_b32 v93, 0xffff0000, v76
    v_mul_f32 v92, v92, v104
    v_mul_f32 v93, v93, v105
    v_cvt_pk_bf16_f32 v76, v92, v93
    v_lshlrev_b32 v92, 16, v76
    v_and_b32 v93, 0xffff0000, v76
    v_add_f32 v92, v92, v106
    v_add_f32 v93, v93, v107
    v_cvt_pk_bf16_f32 v101, v92, v93
    v_add_u32 v16, 66560, v21
    ds_write_b32 v16, v101
    ds_write_b32 v16, v100 offset:2048
    s_waitcnt lgkmcnt(0)
    s_barrier
    ds_read_b128 v[60:63], v20 offset:0
    ds_read_b128 v[64:67], v20 offset:1024
    ds_read_b128 v[68:71], v20 offset:2048
    ds_read_b128 v[72:75], v20 offset:3072
    ds_read_b128 v[108:111], v20 offset:4096
    ds_read_b128 v[112:115], v20 offset:5120
    ds_read_b128 v[116:119], v20 offset:6144
    ds_read_b128 v[120:123], v20 offset:7168
    s_and_b32 s16, s3, 3
    s_lshl_b32 s16, s16, 7
    s_and_b32 s17, s29, 3
    s_lshl_b32 s17, s17, 9
    s_add_u32 s16, s16, s17
    s_add_u32 s16, s16, 66560
    v_lshrrev_b32 v16, 3, v1
    v_lshlrev_b32 v16, 4, v16
    v_add_u32 v16, s16, v16
    ds_read_b128 v[104:107], v16
    s_waitcnt lgkmcnt(0)
    v_lshlrev_b32 v76, 16, v104
    v_and_b32 v77, 0xffff, v104
    v_dot2_f32_bf16 v85, v60, v76, 0
    v_dot2_f32_bf16 v84, v60, v77, 0
    v_dot2_f32_bf16 v87, v61, v76, 0
    v_dot2_f32_bf16 v86, v61, v77, 0
    v_dot2_f32_bf16 v89, v62, v76, 0
    v_dot2_f32_bf16 v88, v62, v77, 0
    v_dot2_f32_bf16 v91, v63, v76, 0
    v_dot2_f32_bf16 v90, v63, v77, 0
    v_and_b32 v78, 0xffff0000, v104
    v_lshrrev_b32 v79, 16, v104
    v_dot2c_f32_bf16 v85, v64, v78
    v_dot2c_f32_bf16 v84, v64, v79
    v_dot2c_f32_bf16 v87, v65, v78
    v_dot2c_f32_bf16 v86, v65, v79
    v_dot2c_f32_bf16 v89, v66, v78
    v_dot2c_f32_bf16 v88, v66, v79
    v_dot2c_f32_bf16 v91, v67, v78
    v_dot2c_f32_bf16 v90, v67, v79
    v_lshlrev_b32 v80, 16, v105
    v_and_b32 v81, 0xffff, v105
    v_dot2c_f32_bf16 v85, v68, v80
    v_dot2c_f32_bf16 v84, v68, v81
    v_dot2c_f32_bf16 v87, v69, v80
    v_dot2c_f32_bf16 v86, v69, v81
    v_dot2c_f32_bf16 v89, v70, v80
    v_dot2c_f32_bf16 v88, v70, v81
    v_dot2c_f32_bf16 v91, v71, v80
    v_dot2c_f32_bf16 v90, v71, v81
    v_and_b32 v82, 0xffff0000, v105
    v_lshrrev_b32 v83, 16, v105
    v_dot2c_f32_bf16 v85, v72, v82
    v_dot2c_f32_bf16 v84, v72, v83
    v_dot2c_f32_bf16 v87, v73, v82
    v_dot2c_f32_bf16 v86, v73, v83
    v_dot2c_f32_bf16 v89, v74, v82
    v_dot2c_f32_bf16 v88, v74, v83
    v_dot2c_f32_bf16 v91, v75, v82
    v_dot2c_f32_bf16 v90, v75, v83
    v_lshlrev_b32 v76, 16, v106
    v_and_b32 v77, 0xffff, v106
    v_dot2c_f32_bf16 v85, v108, v76
    v_dot2c_f32_bf16 v84, v108, v77
    v_dot2c_f32_bf16 v87, v109, v76
    v_dot2c_f32_bf16 v86, v109, v77
    v_dot2c_f32_bf16 v89, v110, v76
    v_dot2c_f32_bf16 v88, v110, v77
    v_dot2c_f32_bf16 v91, v111, v76
    v_dot2c_f32_bf16 v90, v111, v77
    v_and_b32 v78, 0xffff0000, v106
    v_lshrrev_b32 v79, 16, v106
    v_dot2c_f32_bf16 v85, v112, v78
    v_dot2c_f32_bf16 v84, v112, v79
    v_dot2c_f32_bf16 v87, v113, v78
    v_dot2c_f32_bf16 v86, v113, v79
    v_dot2c_f32_bf16 v89, v114, v78
    v_dot2c_f32_bf16 v88, v114, v79
    v_dot2c_f32_bf16 v91, v115, v78
    v_dot2c_f32_bf16 v90, v115, v79
    v_lshlrev_b32 v80, 16, v107
    v_and_b32 v81, 0xffff, v107
    v_dot2c_f32_bf16 v85, v116, v80
    v_dot2c_f32_bf16 v84, v116, v81
    v_dot2c_f32_bf16 v87, v117, v80
    v_dot2c_f32_bf16 v86, v117, v81
    v_dot2c_f32_bf16 v89, v118, v80
    v_dot2c_f32_bf16 v88, v118, v81
    v_dot2c_f32_bf16 v91, v119, v80
    v_dot2c_f32_bf16 v90, v119, v81
    v_and_b32 v82, 0xffff0000, v107
    v_lshrrev_b32 v83, 16, v107
    v_dot2c_f32_bf16 v85, v120, v82
    v_dot2c_f32_bf16 v84, v120, v83
    v_dot2c_f32_bf16 v87, v121, v82
    v_dot2c_f32_bf16 v86, v121, v83
    v_dot2c_f32_bf16 v89, v122, v82
    v_dot2c_f32_bf16 v88, v122, v83
    v_dot2c_f32_bf16 v91, v123, v82
    v_dot2c_f32_bf16 v90, v123, v83
    s_nop 0
    v_permlane32_swap_b32 v84, v88
    v_permlane32_swap_b32 v85, v89
    v_permlane32_swap_b32 v86, v90
    v_permlane32_swap_b32 v87, v91
    v_add_f32 v84, v84, v88
    v_add_f32 v85, v85, v89
    v_add_f32 v86, v86, v90
    v_add_f32 v87, v87, v91
    s_nop 0
    v_permlane16_swap_b32 v84, v86
    v_permlane16_swap_b32 v85, v87
    v_add_f32 v84, v84, v86
    v_add_f32 v85, v85, v87
    s_nop 0
    v_add_f32_dpp v84, v84, v84 row_ror:8 row_mask:0xf bank_mask:0xf
    v_add_f32_dpp v85, v85, v85 row_ror:8 row_mask:0xf bank_mask:0xf
    v_and_b32 v16, 7, v1
    v_lshlrev_b32 v16, 5, v16
    v_lshrrev_b32 v17, 4, v1
    v_lshl_add_u32 v16, v17, 3, v16
    s_lshl_b32 s16, s3, 8
    s_add_u32 s16, s16, 70656
    v_add_u32 v16, s16, v16
    ds_write_b64 v16, v[84:85]
    s_lshr_b32 s16, s3, 2
    s_lshl_b32 s17, s16, 10
    s_add_u32 s17, s17, 70656
    v_lshlrev_b32 v17, 2, v1
    v_add_u32 v16, s17, v17
    s_and_b32 s17, s29, 3
    s_lshl_b32 s17, s17, 1
    s_add_u32 s17, s17, s16
    s_mul_i32 s17, s17, 14336
    s_lshr_b32 s16, s29, 2
    s_lshl_b32 s16, s16, 8
    s_add_u32 s17, s17, s16
    s_add_u32 s17, s17, 0x6e1000
    s_and_b32 s16, s3, 3
    s_cmp_eq_u32 s16, 0
    s_cselect_b32 s17, s17, 0x7ffffff0
    s_cmp_lt_u32 s2, 224
    s_cselect_b32 s17, s17, 0x7ffffff0
    s_waitcnt lgkmcnt(0)
    s_barrier
    ds_read_b32 v84, v16 offset:0
    ds_read_b32 v85, v16 offset:256
    ds_read_b32 v86, v16 offset:512
    ds_read_b32 v87, v16 offset:768
    s_waitcnt lgkmcnt(2)
    v_add_f32 v84, v84, v85
    s_waitcnt lgkmcnt(0)
    v_add_f32 v86, v86, v87
    v_add_f32 v84, v84, v86
    v_or_b32 v84, 1, v84
    buffer_store_dword v84, v17, s[8:11], s17 offen sc1
    v_lshrrev_b32 v16, 4, v1
    v_mul_u32_u24 v16, 28672, v16
    v_and_b32 v17, 15, v1
    v_lshl_add_u32 v16, v17, 2, v16
    s_lshl_b32 s16, s29, 6
    s_add_u32 s16, s16, 0x6e1000
    s_add_u32 s17, s16, 14336
    s_mov_b32 s27, 0
adaLN_cond__sliding_block_cached__moe_arch_mod__prompt_kernel_gu23p:
    buffer_load_dword v84, v16, s[8:11], s16 offen sc1
    buffer_load_dword v85, v16, s[8:11], s17 offen sc1
    s_waitcnt vmcnt(0)
    v_min_u32 v86, v84, v85
    v_cmp_eq_u32 vcc, 0, v86
    s_cmp_lt_u32 s2, 224
    s_cselect_b64 s[62:63], -1, 0
    s_and_b64 vcc, vcc, s[62:63]
    s_add_u32 s27, s27, 1
    s_cmp_ge_u32 s27, 262144
    s_cbranch_scc1 adaLN_cond__sliding_block_cached__moe_arch_mod__prompt_kernel_gu23g
    s_cbranch_vccnz adaLN_cond__sliding_block_cached__moe_arch_mod__prompt_kernel_gu23p
adaLN_cond__sliding_block_cached__moe_arch_mod__prompt_kernel_gu23g:
    v_mov_b32 v86, v84
    s_nop 1
    v_permlane16_swap_b32 v84, v86
    v_add_f32 v84, v84, v86
    v_mov_b32 v87, v85
    s_nop 1
    v_permlane16_swap_b32 v85, v87
    v_add_f32 v85, v85, v87
    v_mov_b32 v86, v84
    s_nop 1
    v_permlane32_swap_b32 v84, v86
    v_add_f32 v84, v84, v86
    v_mov_b32 v87, v85
    s_nop 1
    v_permlane32_swap_b32 v85, v87
    v_add_f32 v85, v85, v87
    v_cvt_pk_bf16_f32 v86, v84, v85
    v_lshlrev_b32 v84, 16, v86
    v_and_b32 v85, 0xffff0000, v86
    v_mul_f32 v86, 0xbfb8aa3b, v84
    v_exp_f32 v86, v86
    s_nop 0
    v_add_f32 v86, 1.0, v86
    v_rcp_f32 v86, v86
    s_nop 0
    v_mul_f32 v84, v84, v86
    v_cvt_pk_bf16_f32 v84, v84, v84
    v_lshlrev_b32 v84, 16, v84
    v_mul_f32 v84, v84, v85
    v_cvt_pk_bf16_f32 v84, v84, v84
    v_lshlrev_b32 v84, 16, v84
    s_sub_u32 s16, s3, 4
    s_lshl_b32 s16, s16, 2
    s_add_u32 s17, s16, 0
    v_readlane_b32 s20, v84, s17
    s_lshr_b32 s4, s20, 16
    s_add_u32 s17, s16, 1
    v_readlane_b32 s21, v84, s17
    s_lshr_b32 s5, s21, 16
    s_add_u32 s17, s16, 2
    v_readlane_b32 s22, v84, s17
    s_lshr_b32 s6, s22, 16
    s_add_u32 s17, s16, 3
    v_readlane_b32 s23, v84, s17
    s_lshr_b32 s7, s23, 16
    v_dot2_f32_bf16 v45, v152, s20, 0
    v_dot2_f32_bf16 v44, v152, s4, 0
    v_dot2_f32_bf16 v47, v153, s20, 0
    v_dot2_f32_bf16 v46, v153, s4, 0
    v_dot2_f32_bf16 v49, v154, s20, 0
    v_dot2_f32_bf16 v48, v154, s4, 0
    v_dot2_f32_bf16 v51, v155, s20, 0
    v_dot2_f32_bf16 v50, v155, s4, 0
    v_dot2_f32_bf16 v53, v156, s20, 0
    v_dot2_f32_bf16 v52, v156, s4, 0
    v_dot2_f32_bf16 v55, v157, s20, 0
    v_dot2_f32_bf16 v54, v157, s4, 0
    v_dot2_f32_bf16 v57, v158, s20, 0
    v_dot2_f32_bf16 v56, v158, s4, 0
    v_dot2_f32_bf16 v59, v159, s20, 0
    v_dot2_f32_bf16 v58, v159, s4, 0
    v_dot2c_f32_bf16 v45, s21, v160
    v_dot2c_f32_bf16 v44, s5, v160
    v_dot2c_f32_bf16 v47, s21, v161
    v_dot2c_f32_bf16 v46, s5, v161
    v_dot2c_f32_bf16 v49, s21, v162
    v_dot2c_f32_bf16 v48, s5, v162
    v_dot2c_f32_bf16 v51, s21, v163
    v_dot2c_f32_bf16 v50, s5, v163
    v_dot2c_f32_bf16 v53, s21, v164
    v_dot2c_f32_bf16 v52, s5, v164
    v_dot2c_f32_bf16 v55, s21, v165
    v_dot2c_f32_bf16 v54, s5, v165
    v_dot2c_f32_bf16 v57, s21, v166
    v_dot2c_f32_bf16 v56, s5, v166
    v_dot2c_f32_bf16 v59, s21, v167
    v_dot2c_f32_bf16 v58, s5, v167
    v_dot2c_f32_bf16 v45, s22, v168
    v_dot2c_f32_bf16 v44, s6, v168
    v_dot2c_f32_bf16 v47, s22, v169
    v_dot2c_f32_bf16 v46, s6, v169
    v_dot2c_f32_bf16 v49, s22, v170
    v_dot2c_f32_bf16 v48, s6, v170
    v_dot2c_f32_bf16 v51, s22, v171
    v_dot2c_f32_bf16 v50, s6, v171
    v_dot2c_f32_bf16 v53, s22, v172
    v_dot2c_f32_bf16 v52, s6, v172
    v_dot2c_f32_bf16 v55, s22, v173
    v_dot2c_f32_bf16 v54, s6, v173
    v_dot2c_f32_bf16 v57, s22, v174
    v_dot2c_f32_bf16 v56, s6, v174
    v_dot2c_f32_bf16 v59, s22, v175
    v_dot2c_f32_bf16 v58, s6, v175
    v_dot2c_f32_bf16 v45, s23, v176
    v_dot2c_f32_bf16 v44, s7, v176
    v_dot2c_f32_bf16 v47, s23, v177
    v_dot2c_f32_bf16 v46, s7, v177
    v_dot2c_f32_bf16 v49, s23, v178
    v_dot2c_f32_bf16 v48, s7, v178
    v_dot2c_f32_bf16 v51, s23, v179
    v_dot2c_f32_bf16 v50, s7, v179
    v_dot2c_f32_bf16 v53, s23, v180
    v_dot2c_f32_bf16 v52, s7, v180
    v_dot2c_f32_bf16 v55, s23, v181
    v_dot2c_f32_bf16 v54, s7, v181
    v_dot2c_f32_bf16 v57, s23, v182
    v_dot2c_f32_bf16 v56, s7, v182
    v_dot2c_f32_bf16 v59, s23, v183
    v_dot2c_f32_bf16 v58, s7, v183
    s_sub_u32 s16, s3, 4
    s_lshl_b32 s16, s16, 12
    s_add_u32 s16, s16, 73728
    v_lshlrev_b32 v16, 5, v1
    v_add_u32 v16, s16, v16
    ds_write_b128 v16, v[44:47] offset:0
    ds_write_b128 v16, v[48:51] offset:16
    ds_write_b128 v16, v[52:55] offset:2048
    ds_write_b128 v16, v[56:59] offset:2064
    s_waitcnt lgkmcnt(0)
    s_barrier
    v_lshlrev_b32 v16, 3, v0
    v_add_u32 v17, 73728, v16
    ds_read_b64 v[84:85], v17 offset:0
    ds_read_b64 v[86:87], v17 offset:4096
    ds_read_b64 v[88:89], v17 offset:8192
    ds_read_b64 v[90:91], v17 offset:12288
    s_waitcnt lgkmcnt(2)
    v_pk_add_f32 v[84:85], v[84:85], v[86:87]
    s_waitcnt lgkmcnt(0)
    v_pk_add_f32 v[88:89], v[88:89], v[90:91]
    v_pk_add_f32 v[84:85], v[84:85], v[88:89]
    v_or_b32 v84, 1, v84
    v_or_b32 v85, 1, v85
    s_lshl_b32 s16, s29, 12
    s_add_u32 s16, s16, 0x600000
    s_cmp_lt_u32 s2, 224
    s_cselect_b32 s16, s16, 0x7ffffff0
    buffer_store_dwordx2 v[84:85], v16, s[8:11], s16 offen sc1
    s_cmp_lt_u32 s2, 224
    s_cbranch_scc1 adaLN_cond__sliding_block_cached__moe_arch_mod__prompt_kernel_end
    s_sub_u32 s16, s2, 224
    s_lshl_b32 s17, s16, 7
    s_add_u32 s17, s17, 0x600000
    v_lshrrev_b32 v16, 3, v0
    v_lshlrev_b32 v16, 12, v16
    v_and_b32 v17, 7, v0
    v_lshl_add_u32 v16, v17, 4, v16
    v_cmp_gt_u32 vcc, 256, v0
    v_bfrev_b32 v17, -2
    s_nop 0
    v_cndmask_b32 v17, v17, v16, vcc
    v_mov_b32 v19, 0
    v_cndmask_b32 v18, 1, v19, vcc
    s_lshl_b32 s18, s16, 6
    v_and_b32 v19, 31, v1
    v_lshlrev_b32 v19, 1, v19
    v_add_u32 v19, s18, v19
    s_mov_b32 s19, 0x541800
    buffer_load_ushort v95, v19, s[8:11], s19 offen sc1
    v_add_u32 v20, 66560, v19
    ds_read_u16 v96, v20
    ds_read_u16 v97, v20 offset:2048
    v_mov_b32 v94, v27
    v_cvt_pk_bf16_f32 v94, v94, v94
    v_lshlrev_b32 v94, 16, v94
    v_mul_f32 v94, 0xbfb8aa3b, v94
    v_exp_f32 v94, v94
    s_nop 0
    v_add_f32 v94, 1.0, v94
    v_rcp_f32 v94, v94
    s_nop 0
    v_cvt_pk_bf16_f32 v94, v94, v94
    v_lshlrev_b32 v94, 16, v94
    s_waitcnt vmcnt(0)
    v_lshlrev_b32 v95, 16, v95
    s_waitcnt lgkmcnt(1)
    v_lshlrev_b32 v96, 16, v96
    s_waitcnt lgkmcnt(0)
    v_lshlrev_b32 v97, 16, v97
    s_mov_b32 s27, 0
adaLN_cond__sliding_block_cached__moe_arch_mod__prompt_kernel_y24p:
    s_add_u32 s19, s17, 0x0
    buffer_load_dwordx4 v[44:47], v16, s[8:11], s19 offen sc1
    s_add_u32 s19, s17, 0x40000
    buffer_load_dwordx4 v[48:51], v16, s[8:11], s19 offen sc1
    s_add_u32 s19, s17, 0x80000
    buffer_load_dwordx4 v[52:55], v16, s[8:11], s19 offen sc1
    s_add_u32 s19, s17, 0xc0000
    buffer_load_dwordx4 v[56:59], v17, s[8:11], s19 offen sc1
    s_waitcnt vmcnt(0)
    v_min3_u32 v98, v56, v57, v58
    v_min_u32 v98, v98, v59
    v_or_b32 v98, v98, v18
    v_min3_u32 v98, v98, v44, v45
    v_min3_u32 v98, v98, v46, v47
    v_min3_u32 v98, v98, v48, v49
    v_min3_u32 v98, v98, v50, v51
    v_min3_u32 v98, v98, v52, v53
    v_min3_u32 v98, v98, v54, v55
    v_cmp_eq_u32 vcc, 0, v98
    s_add_u32 s27, s27, 1
    s_cmp_ge_u32 s27, 262144
    s_cbranch_scc1 adaLN_cond__sliding_block_cached__moe_arch_mod__prompt_kernel_y24g
    s_cbranch_vccnz adaLN_cond__sliding_block_cached__moe_arch_mod__prompt_kernel_y24p
adaLN_cond__sliding_block_cached__moe_arch_mod__prompt_kernel_y24g:
    v_pk_add_f32 v[44:45], v[44:45], v[52:53]
    v_pk_add_f32 v[46:47], v[46:47], v[54:55]
    v_pk_add_f32 v[48:49], v[48:49], v[56:57]
    v_pk_add_f32 v[50:51], v[50:51], v[58:59]
    v_pk_add_f32 v[44:45], v[44:45], v[48:49]
    v_pk_add_f32 v[46:47], v[46:47], v[50:51]
    s_nop 0
    v_add_f32_dpp v44, v44, v44 row_ror:8 row_mask:0xf bank_mask:0xf
    v_add_f32_dpp v45, v45, v45 row_ror:8 row_mask:0xf bank_mask:0xf
    v_add_f32_dpp v46, v46, v46 row_ror:8 row_mask:0xf bank_mask:0xf
    v_add_f32_dpp v47, v47, v47 row_ror:8 row_mask:0xf bank_mask:0xf
    s_nop 0
    v_permlane32_swap_b32 v44, v46
    v_permlane32_swap_b32 v45, v47
    v_add_f32 v44, v44, v46
    v_add_f32 v45, v45, v47
    s_nop 1
    v_permlane16_swap_b32 v44, v45
    v_add_f32 v44, v44, v45
    v_and_b32 v16, 7, v1
    v_lshlrev_b32 v16, 4, v16
    v_lshrrev_b32 v17, 4, v1
    v_lshl_add_u32 v16, v17, 2, v16
    s_lshl_b32 s19, s3, 7
    s_add_u32 s19, s19, 91136
    v_add_u32 v16, s19, v16
    ds_write_b32 v16, v44
    v_and_b32 v16, 31, v1
    v_lshlrev_b32 v16, 2, v16
    v_add_u32 v16, 91136, v16
    s_waitcnt lgkmcnt(0)
    s_barrier
    s_cmp_lg_u32 s3, 0
    s_cbranch_scc1 adaLN_cond__sliding_block_cached__moe_arch_mod__prompt_kernel_end
    ds_read_b32 v44, v16 offset:0
    ds_read_b32 v45, v16 offset:128
    ds_read_b32 v46, v16 offset:256
    ds_read_b32 v47, v16 offset:384
    ds_read_b32 v48, v16 offset:512
    ds_read_b32 v49, v16 offset:640
    ds_read_b32 v50, v16 offset:768
    ds_read_b32 v51, v16 offset:896
    s_waitcnt lgkmcnt(3)
    v_add_f32 v44, v44, v48
    s_waitcnt lgkmcnt(2)
    v_add_f32 v45, v45, v49
    s_waitcnt lgkmcnt(1)
    v_add_f32 v46, v46, v50
    s_waitcnt lgkmcnt(0)
    v_add_f32 v47, v47, v51
    v_add_f32 v44, v44, v46
    v_add_f32 v45, v45, v47
    v_add_f32 v44, v44, v45
    v_cvt_pk_bf16_f32 v44, v44, v44
    v_lshlrev_b32 v44, 16, v44
    v_mul_f32 v44, v44, v94
    v_cvt_pk_bf16_f32 v44, v44, v44
    v_lshlrev_b32 v44, 16, v44
    v_add_f32 v44, v44, v96
    v_cvt_pk_bf16_f32 v44, v44, v44
    v_lshlrev_b32 v44, 16, v44
    v_mul_f32 v44, v44, v95
    v_cvt_pk_bf16_f32 v44, v44, v44
    v_lshlrev_b32 v44, 16, v44
    v_add_f32 v44, v44, v97
    v_cvt_pk_bf16_f32 v44, v44, v44
    s_mov_b64 exec, 0xffffffff
    buffer_store_short v44, v19, s[68:71], s13 offen sc1
adaLN_cond__sliding_block_cached__moe_arch_mod__prompt_kernel_end:
    s_endpgm
adaLN_cond__sliding_block_cached__moe_arch_mod__prompt_kernel_n1r:
    s_mov_b32 s27, 0
adaLN_cond__sliding_block_cached__moe_arch_mod__prompt_kernel_n1p:
    buffer_load_dword v134, v132, s[64:67], 0 offen sc1
    s_waitcnt vmcnt(0)
    v_cmp_eq_u32 vcc, 0, v134
    s_cmp_eq_u32 s3, 0
    s_cselect_b64 s[62:63], -1, 0
    s_and_b64 vcc, vcc, s[62:63]
    s_add_u32 s27, s27, 1
    s_cmp_ge_u32 s27, 262144
    s_cbranch_scc1 adaLN_cond__sliding_block_cached__moe_arch_mod__prompt_kernel_n1g
    s_cbranch_vccnz adaLN_cond__sliding_block_cached__moe_arch_mod__prompt_kernel_n1p
adaLN_cond__sliding_block_cached__moe_arch_mod__prompt_kernel_n1g:
    s_waitcnt vmcnt(0) lgkmcnt(0)
    s_nop 15
    s_nop 3
    s_branch adaLN_cond__sliding_block_cached__moe_arch_mod__prompt_kernel_n1b
adaLN_cond__sliding_block_cached__moe_arch_mod__prompt_kernel_kv4r:
    s_waitcnt vmcnt(0) lgkmcnt(0)
    s_nop 15
    s_nop 3
    s_mov_b32 s27, 0
adaLN_cond__sliding_block_cached__moe_arch_mod__prompt_kernel_kv4p:
    buffer_load_dwordx4 v[12:15], v21, s[8:11], s18 offen sc1
    s_waitcnt vmcnt(0)
    v_xor_b32 v8, s28, v12
    v_xor_b32 v20, s28, v13
    v_or_b32 v8, v8, v20
    v_xor_b32 v20, s28, v14
    v_or_b32 v8, v8, v20
    v_xor_b32 v20, s28, v15
    v_or_b32 v8, v8, v20
    v_cmp_ne_u32 vcc, 0, v8
    s_add_u32 s27, s27, 1
    s_cmp_ge_u32 s27, 262144
    s_cbranch_scc1 adaLN_cond__sliding_block_cached__moe_arch_mod__prompt_kernel_kv4g
    s_cbranch_vccnz adaLN_cond__sliding_block_cached__moe_arch_mod__prompt_kernel_kv4p
adaLN_cond__sliding_block_cached__moe_arch_mod__prompt_kernel_kv4g:
    s_waitcnt vmcnt(0) lgkmcnt(0)
    s_nop 15
    s_nop 3
    s_branch adaLN_cond__sliding_block_cached__moe_arch_mod__prompt_kernel_kv4b
adaLN_cond__sliding_block_cached__moe_arch_mod__prompt_kernel_fixA:
    s_waitcnt vmcnt(0) lgkmcnt(0)
    s_nop 15
    s_nop 3
    s_lshr_b32 s16, s12, 3
    s_lshl_b32 s16, s16, 17
    s_add_u32 s16, s16, 0x400000
    v_add_u32 v8, s16, v2
    v_mov_b32 v16, 0xff7fffff
    v_mov_b32 v17, 0xff7fffff
    s_mov_b32 s16, 0
adaLN_cond__sliding_block_cached__moe_arch_mod__prompt_kernel_fixAm:
    s_add_u32 s17, s16, 0
    buffer_load_dwordx4 v[200:203], v8, s[8:11], s17 offen offset:0
    buffer_load_dwordx4 v[204:207], v8, s[8:11], s17 offen offset:1024
    buffer_load_dwordx4 v[208:211], v8, s[8:11], s17 offen offset:2048
    buffer_load_dwordx4 v[212:215], v8, s[8:11], s17 offen offset:3072
    s_waitcnt vmcnt(3)
    v_mfma_f32_16x16x32_bf16 v[184:187], v[200:203], v[152:155], 0
    v_mfma_f32_16x16x32_bf16 v[188:191], v[200:203], v[168:171], 0
    s_waitcnt vmcnt(2)
    v_mfma_f32_16x16x32_bf16 v[192:195], v[204:207], v[152:155], 0
    v_mfma_f32_16x16x32_bf16 v[196:199], v[204:207], v[168:171], 0
    s_waitcnt vmcnt(1)
    v_mfma_f32_16x16x32_bf16 v[184:187], v[208:211], v[156:159], v[184:187]
    v_mfma_f32_16x16x32_bf16 v[188:191], v[208:211], v[172:175], v[188:191]
    s_waitcnt vmcnt(0)
    v_mfma_f32_16x16x32_bf16 v[192:195], v[212:215], v[156:159], v[192:195]
    v_mfma_f32_16x16x32_bf16 v[196:199], v[212:215], v[172:175], v[196:199]
    s_add_u32 s17, s16, 4096
    buffer_load_dwordx4 v[200:203], v8, s[8:11], s17 offen offset:0
    buffer_load_dwordx4 v[204:207], v8, s[8:11], s17 offen offset:1024
    buffer_load_dwordx4 v[208:211], v8, s[8:11], s17 offen offset:2048
    buffer_load_dwordx4 v[212:215], v8, s[8:11], s17 offen offset:3072
    s_waitcnt vmcnt(3)
    v_mfma_f32_16x16x32_bf16 v[184:187], v[200:203], v[160:163], v[184:187]
    v_mfma_f32_16x16x32_bf16 v[188:191], v[200:203], v[176:179], v[188:191]
    s_waitcnt vmcnt(2)
    v_mfma_f32_16x16x32_bf16 v[192:195], v[204:207], v[160:163], v[192:195]
    v_mfma_f32_16x16x32_bf16 v[196:199], v[204:207], v[176:179], v[196:199]
    s_waitcnt vmcnt(1)
    v_mfma_f32_16x16x32_bf16 v[184:187], v[208:211], v[164:167], v[184:187]
    v_mfma_f32_16x16x32_bf16 v[188:191], v[208:211], v[180:183], v[188:191]
    s_waitcnt vmcnt(0)
    v_mfma_f32_16x16x32_bf16 v[192:195], v[212:215], v[164:167], v[192:195]
    v_mfma_f32_16x16x32_bf16 v[196:199], v[212:215], v[180:183], v[196:199]
    s_nop 3
    v_max3_f32 v16, v16, v184, v185
    v_max3_f32 v16, v16, v186, v187
    v_max3_f32 v17, v17, v188, v189
    v_max3_f32 v17, v17, v190, v191
    v_max3_f32 v16, v16, v192, v193
    v_max3_f32 v16, v16, v194, v195
    v_max3_f32 v17, v17, v196, v197
    v_max3_f32 v17, v17, v198, v199
    s_add_u32 s16, s16, 8192
    s_cmp_lt_u32 s16, 0x20000
    s_cbranch_scc1 adaLN_cond__sliding_block_cached__moe_arch_mod__prompt_kernel_fixAm
    v_mov_b32 v18, v16
    v_mov_b32 v19, v17
    s_nop 0
    v_permlane16_swap_b32 v16, v18
    v_permlane16_swap_b32 v17, v19
    v_max_f32 v16, v16, v18
    v_max_f32 v17, v17, v19
    v_mov_b32 v18, v16
    v_mov_b32 v19, v17
    s_nop 0
    v_permlane32_swap_b32 v16, v18
    v_permlane32_swap_b32 v17, v19
    v_max_f32 v16, v16, v18
    v_max_f32 v17, v17, v19
    v_sub_f32 v216, 0, v16
    v_sub_f32 v217, 0, v16
    v_sub_f32 v218, 0, v16
    v_sub_f32 v219, 0, v16
    v_sub_f32 v220, 0, v17
    v_sub_f32 v221, 0, v17
    v_sub_f32 v222, 0, v17
    v_sub_f32 v223, 0, v17
    s_mov_b32 s17, 0x0
    buffer_load_dwordx4 v[200:203], v8, s[8:11], s17 offen offset:0
    buffer_load_dwordx4 v[204:207], v8, s[8:11], s17 offen offset:1024
    buffer_load_dwordx4 v[208:211], v8, s[8:11], s17 offen offset:2048
    buffer_load_dwordx4 v[212:215], v8, s[8:11], s17 offen offset:3072
    s_waitcnt vmcnt(3)
    v_mfma_f32_16x16x32_bf16 v[184:187], v[200:203], v[152:155], v[216:219]
    v_mfma_f32_16x16x32_bf16 v[188:191], v[200:203], v[168:171], v[220:223]
    s_waitcnt vmcnt(2)
    v_mfma_f32_16x16x32_bf16 v[192:195], v[204:207], v[152:155], v[216:219]
    v_mfma_f32_16x16x32_bf16 v[196:199], v[204:207], v[168:171], v[220:223]
    s_waitcnt vmcnt(1)
    v_mfma_f32_16x16x32_bf16 v[184:187], v[208:211], v[156:159], v[184:187]
    v_mfma_f32_16x16x32_bf16 v[188:191], v[208:211], v[172:175], v[188:191]
    s_waitcnt vmcnt(0)
    v_mfma_f32_16x16x32_bf16 v[192:195], v[212:215], v[156:159], v[192:195]
    v_mfma_f32_16x16x32_bf16 v[196:199], v[212:215], v[172:175], v[196:199]
    s_mov_b32 s17, 0x1000
    buffer_load_dwordx4 v[200:203], v8, s[8:11], s17 offen offset:0
    buffer_load_dwordx4 v[204:207], v8, s[8:11], s17 offen offset:1024
    buffer_load_dwordx4 v[208:211], v8, s[8:11], s17 offen offset:2048
    buffer_load_dwordx4 v[212:215], v8, s[8:11], s17 offen offset:3072
    s_waitcnt vmcnt(3)
    v_mfma_f32_16x16x32_bf16 v[184:187], v[200:203], v[160:163], v[184:187]
    v_mfma_f32_16x16x32_bf16 v[188:191], v[200:203], v[176:179], v[188:191]
    s_waitcnt vmcnt(2)
    v_mfma_f32_16x16x32_bf16 v[192:195], v[204:207], v[160:163], v[192:195]
    v_mfma_f32_16x16x32_bf16 v[196:199], v[204:207], v[176:179], v[196:199]
    s_waitcnt vmcnt(1)
    v_mfma_f32_16x16x32_bf16 v[184:187], v[208:211], v[164:167], v[184:187]
    v_mfma_f32_16x16x32_bf16 v[188:191], v[208:211], v[180:183], v[188:191]
    s_waitcnt vmcnt(0)
    v_mfma_f32_16x16x32_bf16 v[192:195], v[212:215], v[164:167], v[192:195]
    v_mfma_f32_16x16x32_bf16 v[196:199], v[212:215], v[180:183], v[196:199]
    s_nop 3
    v_exp_f32 v184, v184
    v_exp_f32 v185, v185
    s_nop 0
    v_add_f32 v9, v184, v185
    v_cvt_pk_bf16_f32 v24, v184, v185
    v_exp_f32 v186, v186
    v_exp_f32 v187, v187
    v_add_f32 v9, v9, v186
    v_add_f32 v9, v9, v187
    v_cvt_pk_bf16_f32 v25, v186, v187
    v_exp_f32 v188, v188
    v_exp_f32 v189, v189
    s_nop 0
    v_add_f32 v10, v188, v189
    v_cvt_pk_bf16_f32 v28, v188, v189
    v_exp_f32 v190, v190
    v_exp_f32 v191, v191
    v_add_f32 v10, v10, v190
    v_add_f32 v10, v10, v191
    v_cvt_pk_bf16_f32 v29, v190, v191
    v_exp_f32 v192, v192
    v_exp_f32 v193, v193
    v_add_f32 v9, v9, v192
    v_add_f32 v9, v9, v193
    v_cvt_pk_bf16_f32 v26, v192, v193
    v_exp_f32 v194, v194
    v_exp_f32 v195, v195
    v_add_f32 v9, v9, v194
    v_add_f32 v9, v9, v195
    v_cvt_pk_bf16_f32 v27, v194, v195
    v_exp_f32 v196, v196
    v_exp_f32 v197, v197
    v_add_f32 v10, v10, v196
    v_add_f32 v10, v10, v197
    v_cvt_pk_bf16_f32 v30, v196, v197
    v_exp_f32 v198, v198
    v_exp_f32 v199, v199
    v_add_f32 v10, v10, v198
    v_add_f32 v10, v10, v199
    v_cvt_pk_bf16_f32 v31, v198, v199
    s_mov_b32 s17, 0x2000
    buffer_load_dwordx4 v[200:203], v8, s[8:11], s17 offen offset:0
    buffer_load_dwordx4 v[204:207], v8, s[8:11], s17 offen offset:1024
    buffer_load_dwordx4 v[208:211], v8, s[8:11], s17 offen offset:2048
    buffer_load_dwordx4 v[212:215], v8, s[8:11], s17 offen offset:3072
    s_waitcnt vmcnt(3)
    v_mfma_f32_16x16x32_bf16 v[184:187], v[200:203], v[152:155], v[216:219]
    v_mfma_f32_16x16x32_bf16 v[188:191], v[200:203], v[168:171], v[220:223]
    s_waitcnt vmcnt(2)
    v_mfma_f32_16x16x32_bf16 v[192:195], v[204:207], v[152:155], v[216:219]
    v_mfma_f32_16x16x32_bf16 v[196:199], v[204:207], v[168:171], v[220:223]
    s_waitcnt vmcnt(1)
    v_mfma_f32_16x16x32_bf16 v[184:187], v[208:211], v[156:159], v[184:187]
    v_mfma_f32_16x16x32_bf16 v[188:191], v[208:211], v[172:175], v[188:191]
    s_waitcnt vmcnt(0)
    v_mfma_f32_16x16x32_bf16 v[192:195], v[212:215], v[156:159], v[192:195]
    v_mfma_f32_16x16x32_bf16 v[196:199], v[212:215], v[172:175], v[196:199]
    s_mov_b32 s17, 0x3000
    buffer_load_dwordx4 v[200:203], v8, s[8:11], s17 offen offset:0
    buffer_load_dwordx4 v[204:207], v8, s[8:11], s17 offen offset:1024
    buffer_load_dwordx4 v[208:211], v8, s[8:11], s17 offen offset:2048
    buffer_load_dwordx4 v[212:215], v8, s[8:11], s17 offen offset:3072
    s_waitcnt vmcnt(3)
    v_mfma_f32_16x16x32_bf16 v[184:187], v[200:203], v[160:163], v[184:187]
    v_mfma_f32_16x16x32_bf16 v[188:191], v[200:203], v[176:179], v[188:191]
    s_waitcnt vmcnt(2)
    v_mfma_f32_16x16x32_bf16 v[192:195], v[204:207], v[160:163], v[192:195]
    v_mfma_f32_16x16x32_bf16 v[196:199], v[204:207], v[176:179], v[196:199]
    s_waitcnt vmcnt(1)
    v_mfma_f32_16x16x32_bf16 v[184:187], v[208:211], v[164:167], v[184:187]
    v_mfma_f32_16x16x32_bf16 v[188:191], v[208:211], v[180:183], v[188:191]
    s_waitcnt vmcnt(0)
    v_mfma_f32_16x16x32_bf16 v[192:195], v[212:215], v[164:167], v[192:195]
    v_mfma_f32_16x16x32_bf16 v[196:199], v[212:215], v[180:183], v[196:199]
    s_nop 3
    v_exp_f32 v184, v184
    v_exp_f32 v185, v185
    v_add_f32 v9, v9, v184
    v_add_f32 v9, v9, v185
    v_cvt_pk_bf16_f32 v32, v184, v185
    v_exp_f32 v186, v186
    v_exp_f32 v187, v187
    v_add_f32 v9, v9, v186
    v_add_f32 v9, v9, v187
    v_cvt_pk_bf16_f32 v33, v186, v187
    v_exp_f32 v188, v188
    v_exp_f32 v189, v189
    v_add_f32 v10, v10, v188
    v_add_f32 v10, v10, v189
    v_cvt_pk_bf16_f32 v36, v188, v189
    v_exp_f32 v190, v190
    v_exp_f32 v191, v191
    v_add_f32 v10, v10, v190
    v_add_f32 v10, v10, v191
    v_cvt_pk_bf16_f32 v37, v190, v191
    v_exp_f32 v192, v192
    v_exp_f32 v193, v193
    v_add_f32 v9, v9, v192
    v_add_f32 v9, v9, v193
    v_cvt_pk_bf16_f32 v34, v192, v193
    v_exp_f32 v194, v194
    v_exp_f32 v195, v195
    v_add_f32 v9, v9, v194
    v_add_f32 v9, v9, v195
    v_cvt_pk_bf16_f32 v35, v194, v195
    v_exp_f32 v196, v196
    v_exp_f32 v197, v197
    v_add_f32 v10, v10, v196
    v_add_f32 v10, v10, v197
    v_cvt_pk_bf16_f32 v38, v196, v197
    v_exp_f32 v198, v198
    v_exp_f32 v199, v199
    v_add_f32 v10, v10, v198
    v_add_f32 v10, v10, v199
    v_cvt_pk_bf16_f32 v39, v198, v199
    s_mov_b32 s17, 0x4000
    buffer_load_dwordx4 v[200:203], v8, s[8:11], s17 offen offset:0
    buffer_load_dwordx4 v[204:207], v8, s[8:11], s17 offen offset:1024
    buffer_load_dwordx4 v[208:211], v8, s[8:11], s17 offen offset:2048
    buffer_load_dwordx4 v[212:215], v8, s[8:11], s17 offen offset:3072
    s_waitcnt vmcnt(3)
    v_mfma_f32_16x16x32_bf16 v[184:187], v[200:203], v[152:155], v[216:219]
    v_mfma_f32_16x16x32_bf16 v[188:191], v[200:203], v[168:171], v[220:223]
    s_waitcnt vmcnt(2)
    v_mfma_f32_16x16x32_bf16 v[192:195], v[204:207], v[152:155], v[216:219]
    v_mfma_f32_16x16x32_bf16 v[196:199], v[204:207], v[168:171], v[220:223]
    s_waitcnt vmcnt(1)
    v_mfma_f32_16x16x32_bf16 v[184:187], v[208:211], v[156:159], v[184:187]
    v_mfma_f32_16x16x32_bf16 v[188:191], v[208:211], v[172:175], v[188:191]
    s_waitcnt vmcnt(0)
    v_mfma_f32_16x16x32_bf16 v[192:195], v[212:215], v[156:159], v[192:195]
    v_mfma_f32_16x16x32_bf16 v[196:199], v[212:215], v[172:175], v[196:199]
    s_mov_b32 s17, 0x5000
    buffer_load_dwordx4 v[200:203], v8, s[8:11], s17 offen offset:0
    buffer_load_dwordx4 v[204:207], v8, s[8:11], s17 offen offset:1024
    buffer_load_dwordx4 v[208:211], v8, s[8:11], s17 offen offset:2048
    buffer_load_dwordx4 v[212:215], v8, s[8:11], s17 offen offset:3072
    s_waitcnt vmcnt(3)
    v_mfma_f32_16x16x32_bf16 v[184:187], v[200:203], v[160:163], v[184:187]
    v_mfma_f32_16x16x32_bf16 v[188:191], v[200:203], v[176:179], v[188:191]
    s_waitcnt vmcnt(2)
    v_mfma_f32_16x16x32_bf16 v[192:195], v[204:207], v[160:163], v[192:195]
    v_mfma_f32_16x16x32_bf16 v[196:199], v[204:207], v[176:179], v[196:199]
    s_waitcnt vmcnt(1)
    v_mfma_f32_16x16x32_bf16 v[184:187], v[208:211], v[164:167], v[184:187]
    v_mfma_f32_16x16x32_bf16 v[188:191], v[208:211], v[180:183], v[188:191]
    s_waitcnt vmcnt(0)
    v_mfma_f32_16x16x32_bf16 v[192:195], v[212:215], v[164:167], v[192:195]
    v_mfma_f32_16x16x32_bf16 v[196:199], v[212:215], v[180:183], v[196:199]
    s_nop 3
    v_exp_f32 v184, v184
    v_exp_f32 v185, v185
    v_add_f32 v9, v9, v184
    v_add_f32 v9, v9, v185
    v_cvt_pk_bf16_f32 v40, v184, v185
    v_exp_f32 v186, v186
    v_exp_f32 v187, v187
    v_add_f32 v9, v9, v186
    v_add_f32 v9, v9, v187
    v_cvt_pk_bf16_f32 v41, v186, v187
    v_exp_f32 v188, v188
    v_exp_f32 v189, v189
    v_add_f32 v10, v10, v188
    v_add_f32 v10, v10, v189
    v_cvt_pk_bf16_f32 v44, v188, v189
    v_exp_f32 v190, v190
    v_exp_f32 v191, v191
    v_add_f32 v10, v10, v190
    v_add_f32 v10, v10, v191
    v_cvt_pk_bf16_f32 v45, v190, v191
    v_exp_f32 v192, v192
    v_exp_f32 v193, v193
    v_add_f32 v9, v9, v192
    v_add_f32 v9, v9, v193
    v_cvt_pk_bf16_f32 v42, v192, v193
    v_exp_f32 v194, v194
    v_exp_f32 v195, v195
    v_add_f32 v9, v9, v194
    v_add_f32 v9, v9, v195
    v_cvt_pk_bf16_f32 v43, v194, v195
    v_exp_f32 v196, v196
    v_exp_f32 v197, v197
    v_add_f32 v10, v10, v196
    v_add_f32 v10, v10, v197
    v_cvt_pk_bf16_f32 v46, v196, v197
    v_exp_f32 v198, v198
    v_exp_f32 v199, v199
    v_add_f32 v10, v10, v198
    v_add_f32 v10, v10, v199
    v_cvt_pk_bf16_f32 v47, v198, v199
    s_mov_b32 s17, 0x6000
    buffer_load_dwordx4 v[200:203], v8, s[8:11], s17 offen offset:0
    buffer_load_dwordx4 v[204:207], v8, s[8:11], s17 offen offset:1024
    buffer_load_dwordx4 v[208:211], v8, s[8:11], s17 offen offset:2048
    buffer_load_dwordx4 v[212:215], v8, s[8:11], s17 offen offset:3072
    s_waitcnt vmcnt(3)
    v_mfma_f32_16x16x32_bf16 v[184:187], v[200:203], v[152:155], v[216:219]
    v_mfma_f32_16x16x32_bf16 v[188:191], v[200:203], v[168:171], v[220:223]
    s_waitcnt vmcnt(2)
    v_mfma_f32_16x16x32_bf16 v[192:195], v[204:207], v[152:155], v[216:219]
    v_mfma_f32_16x16x32_bf16 v[196:199], v[204:207], v[168:171], v[220:223]
    s_waitcnt vmcnt(1)
    v_mfma_f32_16x16x32_bf16 v[184:187], v[208:211], v[156:159], v[184:187]
    v_mfma_f32_16x16x32_bf16 v[188:191], v[208:211], v[172:175], v[188:191]
    s_waitcnt vmcnt(0)
    v_mfma_f32_16x16x32_bf16 v[192:195], v[212:215], v[156:159], v[192:195]
    v_mfma_f32_16x16x32_bf16 v[196:199], v[212:215], v[172:175], v[196:199]
    s_mov_b32 s17, 0x7000
    buffer_load_dwordx4 v[200:203], v8, s[8:11], s17 offen offset:0
    buffer_load_dwordx4 v[204:207], v8, s[8:11], s17 offen offset:1024
    buffer_load_dwordx4 v[208:211], v8, s[8:11], s17 offen offset:2048
    buffer_load_dwordx4 v[212:215], v8, s[8:11], s17 offen offset:3072
    s_waitcnt vmcnt(3)
    v_mfma_f32_16x16x32_bf16 v[184:187], v[200:203], v[160:163], v[184:187]
    v_mfma_f32_16x16x32_bf16 v[188:191], v[200:203], v[176:179], v[188:191]
    s_waitcnt vmcnt(2)
    v_mfma_f32_16x16x32_bf16 v[192:195], v[204:207], v[160:163], v[192:195]
    v_mfma_f32_16x16x32_bf16 v[196:199], v[204:207], v[176:179], v[196:199]
    s_waitcnt vmcnt(1)
    v_mfma_f32_16x16x32_bf16 v[184:187], v[208:211], v[164:167], v[184:187]
    v_mfma_f32_16x16x32_bf16 v[188:191], v[208:211], v[180:183], v[188:191]
    s_waitcnt vmcnt(0)
    v_mfma_f32_16x16x32_bf16 v[192:195], v[212:215], v[164:167], v[192:195]
    v_mfma_f32_16x16x32_bf16 v[196:199], v[212:215], v[180:183], v[196:199]
    s_nop 3
    v_exp_f32 v184, v184
    v_exp_f32 v185, v185
    v_add_f32 v9, v9, v184
    v_add_f32 v9, v9, v185
    v_cvt_pk_bf16_f32 v48, v184, v185
    v_exp_f32 v186, v186
    v_exp_f32 v187, v187
    v_add_f32 v9, v9, v186
    v_add_f32 v9, v9, v187
    v_cvt_pk_bf16_f32 v49, v186, v187
    v_exp_f32 v188, v188
    v_exp_f32 v189, v189
    v_add_f32 v10, v10, v188
    v_add_f32 v10, v10, v189
    v_cvt_pk_bf16_f32 v52, v188, v189
    v_exp_f32 v190, v190
    v_exp_f32 v191, v191
    v_add_f32 v10, v10, v190
    v_add_f32 v10, v10, v191
    v_cvt_pk_bf16_f32 v53, v190, v191
    v_exp_f32 v192, v192
    v_exp_f32 v193, v193
    v_add_f32 v9, v9, v192
    v_add_f32 v9, v9, v193
    v_cvt_pk_bf16_f32 v50, v192, v193
    v_exp_f32 v194, v194
    v_exp_f32 v195, v195
    v_add_f32 v9, v9, v194
    v_add_f32 v9, v9, v195
    v_cvt_pk_bf16_f32 v51, v194, v195
    v_exp_f32 v196, v196
    v_exp_f32 v197, v197
    v_add_f32 v10, v10, v196
    v_add_f32 v10, v10, v197
    v_cvt_pk_bf16_f32 v54, v196, v197
    v_exp_f32 v198, v198
    v_exp_f32 v199, v199
    v_add_f32 v10, v10, v198
    v_add_f32 v10, v10, v199
    v_cvt_pk_bf16_f32 v55, v198, v199
    s_mov_b32 s17, 0x8000
    buffer_load_dwordx4 v[200:203], v8, s[8:11], s17 offen offset:0
    buffer_load_dwordx4 v[204:207], v8, s[8:11], s17 offen offset:1024
    buffer_load_dwordx4 v[208:211], v8, s[8:11], s17 offen offset:2048
    buffer_load_dwordx4 v[212:215], v8, s[8:11], s17 offen offset:3072
    s_waitcnt vmcnt(3)
    v_mfma_f32_16x16x32_bf16 v[184:187], v[200:203], v[152:155], v[216:219]
    v_mfma_f32_16x16x32_bf16 v[188:191], v[200:203], v[168:171], v[220:223]
    s_waitcnt vmcnt(2)
    v_mfma_f32_16x16x32_bf16 v[192:195], v[204:207], v[152:155], v[216:219]
    v_mfma_f32_16x16x32_bf16 v[196:199], v[204:207], v[168:171], v[220:223]
    s_waitcnt vmcnt(1)
    v_mfma_f32_16x16x32_bf16 v[184:187], v[208:211], v[156:159], v[184:187]
    v_mfma_f32_16x16x32_bf16 v[188:191], v[208:211], v[172:175], v[188:191]
    s_waitcnt vmcnt(0)
    v_mfma_f32_16x16x32_bf16 v[192:195], v[212:215], v[156:159], v[192:195]
    v_mfma_f32_16x16x32_bf16 v[196:199], v[212:215], v[172:175], v[196:199]
    s_mov_b32 s17, 0x9000
    buffer_load_dwordx4 v[200:203], v8, s[8:11], s17 offen offset:0
    buffer_load_dwordx4 v[204:207], v8, s[8:11], s17 offen offset:1024
    buffer_load_dwordx4 v[208:211], v8, s[8:11], s17 offen offset:2048
    buffer_load_dwordx4 v[212:215], v8, s[8:11], s17 offen offset:3072
    s_waitcnt vmcnt(3)
    v_mfma_f32_16x16x32_bf16 v[184:187], v[200:203], v[160:163], v[184:187]
    v_mfma_f32_16x16x32_bf16 v[188:191], v[200:203], v[176:179], v[188:191]
    s_waitcnt vmcnt(2)
    v_mfma_f32_16x16x32_bf16 v[192:195], v[204:207], v[160:163], v[192:195]
    v_mfma_f32_16x16x32_bf16 v[196:199], v[204:207], v[176:179], v[196:199]
    s_waitcnt vmcnt(1)
    v_mfma_f32_16x16x32_bf16 v[184:187], v[208:211], v[164:167], v[184:187]
    v_mfma_f32_16x16x32_bf16 v[188:191], v[208:211], v[180:183], v[188:191]
    s_waitcnt vmcnt(0)
    v_mfma_f32_16x16x32_bf16 v[192:195], v[212:215], v[164:167], v[192:195]
    v_mfma_f32_16x16x32_bf16 v[196:199], v[212:215], v[180:183], v[196:199]
    s_nop 3
    v_exp_f32 v184, v184
    v_exp_f32 v185, v185
    v_add_f32 v9, v9, v184
    v_add_f32 v9, v9, v185
    v_cvt_pk_bf16_f32 v56, v184, v185
    v_exp_f32 v186, v186
    v_exp_f32 v187, v187
    v_add_f32 v9, v9, v186
    v_add_f32 v9, v9, v187
    v_cvt_pk_bf16_f32 v57, v186, v187
    v_exp_f32 v188, v188
    v_exp_f32 v189, v189
    v_add_f32 v10, v10, v188
    v_add_f32 v10, v10, v189
    v_cvt_pk_bf16_f32 v60, v188, v189
    v_exp_f32 v190, v190
    v_exp_f32 v191, v191
    v_add_f32 v10, v10, v190
    v_add_f32 v10, v10, v191
    v_cvt_pk_bf16_f32 v61, v190, v191
    v_exp_f32 v192, v192
    v_exp_f32 v193, v193
    v_add_f32 v9, v9, v192
    v_add_f32 v9, v9, v193
    v_cvt_pk_bf16_f32 v58, v192, v193
    v_exp_f32 v194, v194
    v_exp_f32 v195, v195
    v_add_f32 v9, v9, v194
    v_add_f32 v9, v9, v195
    v_cvt_pk_bf16_f32 v59, v194, v195
    v_exp_f32 v196, v196
    v_exp_f32 v197, v197
    v_add_f32 v10, v10, v196
    v_add_f32 v10, v10, v197
    v_cvt_pk_bf16_f32 v62, v196, v197
    v_exp_f32 v198, v198
    v_exp_f32 v199, v199
    v_add_f32 v10, v10, v198
    v_add_f32 v10, v10, v199
    v_cvt_pk_bf16_f32 v63, v198, v199
    s_mov_b32 s17, 0xa000
    buffer_load_dwordx4 v[200:203], v8, s[8:11], s17 offen offset:0
    buffer_load_dwordx4 v[204:207], v8, s[8:11], s17 offen offset:1024
    buffer_load_dwordx4 v[208:211], v8, s[8:11], s17 offen offset:2048
    buffer_load_dwordx4 v[212:215], v8, s[8:11], s17 offen offset:3072
    s_waitcnt vmcnt(3)
    v_mfma_f32_16x16x32_bf16 v[184:187], v[200:203], v[152:155], v[216:219]
    v_mfma_f32_16x16x32_bf16 v[188:191], v[200:203], v[168:171], v[220:223]
    s_waitcnt vmcnt(2)
    v_mfma_f32_16x16x32_bf16 v[192:195], v[204:207], v[152:155], v[216:219]
    v_mfma_f32_16x16x32_bf16 v[196:199], v[204:207], v[168:171], v[220:223]
    s_waitcnt vmcnt(1)
    v_mfma_f32_16x16x32_bf16 v[184:187], v[208:211], v[156:159], v[184:187]
    v_mfma_f32_16x16x32_bf16 v[188:191], v[208:211], v[172:175], v[188:191]
    s_waitcnt vmcnt(0)
    v_mfma_f32_16x16x32_bf16 v[192:195], v[212:215], v[156:159], v[192:195]
    v_mfma_f32_16x16x32_bf16 v[196:199], v[212:215], v[172:175], v[196:199]
    s_mov_b32 s17, 0xb000
    buffer_load_dwordx4 v[200:203], v8, s[8:11], s17 offen offset:0
    buffer_load_dwordx4 v[204:207], v8, s[8:11], s17 offen offset:1024
    buffer_load_dwordx4 v[208:211], v8, s[8:11], s17 offen offset:2048
    buffer_load_dwordx4 v[212:215], v8, s[8:11], s17 offen offset:3072
    s_waitcnt vmcnt(3)
    v_mfma_f32_16x16x32_bf16 v[184:187], v[200:203], v[160:163], v[184:187]
    v_mfma_f32_16x16x32_bf16 v[188:191], v[200:203], v[176:179], v[188:191]
    s_waitcnt vmcnt(2)
    v_mfma_f32_16x16x32_bf16 v[192:195], v[204:207], v[160:163], v[192:195]
    v_mfma_f32_16x16x32_bf16 v[196:199], v[204:207], v[176:179], v[196:199]
    s_waitcnt vmcnt(1)
    v_mfma_f32_16x16x32_bf16 v[184:187], v[208:211], v[164:167], v[184:187]
    v_mfma_f32_16x16x32_bf16 v[188:191], v[208:211], v[180:183], v[188:191]
    s_waitcnt vmcnt(0)
    v_mfma_f32_16x16x32_bf16 v[192:195], v[212:215], v[164:167], v[192:195]
    v_mfma_f32_16x16x32_bf16 v[196:199], v[212:215], v[180:183], v[196:199]
    s_nop 3
    v_exp_f32 v184, v184
    v_exp_f32 v185, v185
    v_add_f32 v9, v9, v184
    v_add_f32 v9, v9, v185
    v_cvt_pk_bf16_f32 v64, v184, v185
    v_exp_f32 v186, v186
    v_exp_f32 v187, v187
    v_add_f32 v9, v9, v186
    v_add_f32 v9, v9, v187
    v_cvt_pk_bf16_f32 v65, v186, v187
    v_exp_f32 v188, v188
    v_exp_f32 v189, v189
    v_add_f32 v10, v10, v188
    v_add_f32 v10, v10, v189
    v_cvt_pk_bf16_f32 v68, v188, v189
    v_exp_f32 v190, v190
    v_exp_f32 v191, v191
    v_add_f32 v10, v10, v190
    v_add_f32 v10, v10, v191
    v_cvt_pk_bf16_f32 v69, v190, v191
    v_exp_f32 v192, v192
    v_exp_f32 v193, v193
    v_add_f32 v9, v9, v192
    v_add_f32 v9, v9, v193
    v_cvt_pk_bf16_f32 v66, v192, v193
    v_exp_f32 v194, v194
    v_exp_f32 v195, v195
    v_add_f32 v9, v9, v194
    v_add_f32 v9, v9, v195
    v_cvt_pk_bf16_f32 v67, v194, v195
    v_exp_f32 v196, v196
    v_exp_f32 v197, v197
    v_add_f32 v10, v10, v196
    v_add_f32 v10, v10, v197
    v_cvt_pk_bf16_f32 v70, v196, v197
    v_exp_f32 v198, v198
    v_exp_f32 v199, v199
    v_add_f32 v10, v10, v198
    v_add_f32 v10, v10, v199
    v_cvt_pk_bf16_f32 v71, v198, v199
    s_mov_b32 s17, 0xc000
    buffer_load_dwordx4 v[200:203], v8, s[8:11], s17 offen offset:0
    buffer_load_dwordx4 v[204:207], v8, s[8:11], s17 offen offset:1024
    buffer_load_dwordx4 v[208:211], v8, s[8:11], s17 offen offset:2048
    buffer_load_dwordx4 v[212:215], v8, s[8:11], s17 offen offset:3072
    s_waitcnt vmcnt(3)
    v_mfma_f32_16x16x32_bf16 v[184:187], v[200:203], v[152:155], v[216:219]
    v_mfma_f32_16x16x32_bf16 v[188:191], v[200:203], v[168:171], v[220:223]
    s_waitcnt vmcnt(2)
    v_mfma_f32_16x16x32_bf16 v[192:195], v[204:207], v[152:155], v[216:219]
    v_mfma_f32_16x16x32_bf16 v[196:199], v[204:207], v[168:171], v[220:223]
    s_waitcnt vmcnt(1)
    v_mfma_f32_16x16x32_bf16 v[184:187], v[208:211], v[156:159], v[184:187]
    v_mfma_f32_16x16x32_bf16 v[188:191], v[208:211], v[172:175], v[188:191]
    s_waitcnt vmcnt(0)
    v_mfma_f32_16x16x32_bf16 v[192:195], v[212:215], v[156:159], v[192:195]
    v_mfma_f32_16x16x32_bf16 v[196:199], v[212:215], v[172:175], v[196:199]
    s_mov_b32 s17, 0xd000
    buffer_load_dwordx4 v[200:203], v8, s[8:11], s17 offen offset:0
    buffer_load_dwordx4 v[204:207], v8, s[8:11], s17 offen offset:1024
    buffer_load_dwordx4 v[208:211], v8, s[8:11], s17 offen offset:2048
    buffer_load_dwordx4 v[212:215], v8, s[8:11], s17 offen offset:3072
    s_waitcnt vmcnt(3)
    v_mfma_f32_16x16x32_bf16 v[184:187], v[200:203], v[160:163], v[184:187]
    v_mfma_f32_16x16x32_bf16 v[188:191], v[200:203], v[176:179], v[188:191]
    s_waitcnt vmcnt(2)
    v_mfma_f32_16x16x32_bf16 v[192:195], v[204:207], v[160:163], v[192:195]
    v_mfma_f32_16x16x32_bf16 v[196:199], v[204:207], v[176:179], v[196:199]
    s_waitcnt vmcnt(1)
    v_mfma_f32_16x16x32_bf16 v[184:187], v[208:211], v[164:167], v[184:187]
    v_mfma_f32_16x16x32_bf16 v[188:191], v[208:211], v[180:183], v[188:191]
    s_waitcnt vmcnt(0)
    v_mfma_f32_16x16x32_bf16 v[192:195], v[212:215], v[164:167], v[192:195]
    v_mfma_f32_16x16x32_bf16 v[196:199], v[212:215], v[180:183], v[196:199]
    s_nop 3
    v_exp_f32 v184, v184
    v_exp_f32 v185, v185
    v_add_f32 v9, v9, v184
    v_add_f32 v9, v9, v185
    v_cvt_pk_bf16_f32 v72, v184, v185
    v_exp_f32 v186, v186
    v_exp_f32 v187, v187
    v_add_f32 v9, v9, v186
    v_add_f32 v9, v9, v187
    v_cvt_pk_bf16_f32 v73, v186, v187
    v_exp_f32 v188, v188
    v_exp_f32 v189, v189
    v_add_f32 v10, v10, v188
    v_add_f32 v10, v10, v189
    v_cvt_pk_bf16_f32 v76, v188, v189
    v_exp_f32 v190, v190
    v_exp_f32 v191, v191
    v_add_f32 v10, v10, v190
    v_add_f32 v10, v10, v191
    v_cvt_pk_bf16_f32 v77, v190, v191
    v_exp_f32 v192, v192
    v_exp_f32 v193, v193
    v_add_f32 v9, v9, v192
    v_add_f32 v9, v9, v193
    v_cvt_pk_bf16_f32 v74, v192, v193
    v_exp_f32 v194, v194
    v_exp_f32 v195, v195
    v_add_f32 v9, v9, v194
    v_add_f32 v9, v9, v195
    v_cvt_pk_bf16_f32 v75, v194, v195
    v_exp_f32 v196, v196
    v_exp_f32 v197, v197
    v_add_f32 v10, v10, v196
    v_add_f32 v10, v10, v197
    v_cvt_pk_bf16_f32 v78, v196, v197
    v_exp_f32 v198, v198
    v_exp_f32 v199, v199
    v_add_f32 v10, v10, v198
    v_add_f32 v10, v10, v199
    v_cvt_pk_bf16_f32 v79, v198, v199
    s_mov_b32 s17, 0xe000
    buffer_load_dwordx4 v[200:203], v8, s[8:11], s17 offen offset:0
    buffer_load_dwordx4 v[204:207], v8, s[8:11], s17 offen offset:1024
    buffer_load_dwordx4 v[208:211], v8, s[8:11], s17 offen offset:2048
    buffer_load_dwordx4 v[212:215], v8, s[8:11], s17 offen offset:3072
    s_waitcnt vmcnt(3)
    v_mfma_f32_16x16x32_bf16 v[184:187], v[200:203], v[152:155], v[216:219]
    v_mfma_f32_16x16x32_bf16 v[188:191], v[200:203], v[168:171], v[220:223]
    s_waitcnt vmcnt(2)
    v_mfma_f32_16x16x32_bf16 v[192:195], v[204:207], v[152:155], v[216:219]
    v_mfma_f32_16x16x32_bf16 v[196:199], v[204:207], v[168:171], v[220:223]
    s_waitcnt vmcnt(1)
    v_mfma_f32_16x16x32_bf16 v[184:187], v[208:211], v[156:159], v[184:187]
    v_mfma_f32_16x16x32_bf16 v[188:191], v[208:211], v[172:175], v[188:191]
    s_waitcnt vmcnt(0)
    v_mfma_f32_16x16x32_bf16 v[192:195], v[212:215], v[156:159], v[192:195]
    v_mfma_f32_16x16x32_bf16 v[196:199], v[212:215], v[172:175], v[196:199]
    s_mov_b32 s17, 0xf000
    buffer_load_dwordx4 v[200:203], v8, s[8:11], s17 offen offset:0
    buffer_load_dwordx4 v[204:207], v8, s[8:11], s17 offen offset:1024
    buffer_load_dwordx4 v[208:211], v8, s[8:11], s17 offen offset:2048
    buffer_load_dwordx4 v[212:215], v8, s[8:11], s17 offen offset:3072
    s_waitcnt vmcnt(3)
    v_mfma_f32_16x16x32_bf16 v[184:187], v[200:203], v[160:163], v[184:187]
    v_mfma_f32_16x16x32_bf16 v[188:191], v[200:203], v[176:179], v[188:191]
    s_waitcnt vmcnt(2)
    v_mfma_f32_16x16x32_bf16 v[192:195], v[204:207], v[160:163], v[192:195]
    v_mfma_f32_16x16x32_bf16 v[196:199], v[204:207], v[176:179], v[196:199]
    s_waitcnt vmcnt(1)
    v_mfma_f32_16x16x32_bf16 v[184:187], v[208:211], v[164:167], v[184:187]
    v_mfma_f32_16x16x32_bf16 v[188:191], v[208:211], v[180:183], v[188:191]
    s_waitcnt vmcnt(0)
    v_mfma_f32_16x16x32_bf16 v[192:195], v[212:215], v[164:167], v[192:195]
    v_mfma_f32_16x16x32_bf16 v[196:199], v[212:215], v[180:183], v[196:199]
    s_nop 3
    v_exp_f32 v184, v184
    v_exp_f32 v185, v185
    v_add_f32 v9, v9, v184
    v_add_f32 v9, v9, v185
    v_cvt_pk_bf16_f32 v80, v184, v185
    v_exp_f32 v186, v186
    v_exp_f32 v187, v187
    v_add_f32 v9, v9, v186
    v_add_f32 v9, v9, v187
    v_cvt_pk_bf16_f32 v81, v186, v187
    v_exp_f32 v188, v188
    v_exp_f32 v189, v189
    v_add_f32 v10, v10, v188
    v_add_f32 v10, v10, v189
    v_cvt_pk_bf16_f32 v84, v188, v189
    v_exp_f32 v190, v190
    v_exp_f32 v191, v191
    v_add_f32 v10, v10, v190
    v_add_f32 v10, v10, v191
    v_cvt_pk_bf16_f32 v85, v190, v191
    v_exp_f32 v192, v192
    v_exp_f32 v193, v193
    v_add_f32 v9, v9, v192
    v_add_f32 v9, v9, v193
    v_cvt_pk_bf16_f32 v82, v192, v193
    v_exp_f32 v194, v194
    v_exp_f32 v195, v195
    v_add_f32 v9, v9, v194
    v_add_f32 v9, v9, v195
    v_cvt_pk_bf16_f32 v83, v194, v195
    v_exp_f32 v196, v196
    v_exp_f32 v197, v197
    v_add_f32 v10, v10, v196
    v_add_f32 v10, v10, v197
    v_cvt_pk_bf16_f32 v86, v196, v197
    v_exp_f32 v198, v198
    v_exp_f32 v199, v199
    v_add_f32 v10, v10, v198
    v_add_f32 v10, v10, v199
    v_cvt_pk_bf16_f32 v87, v198, v199
    s_mov_b32 s17, 0x10000
    buffer_load_dwordx4 v[200:203], v8, s[8:11], s17 offen offset:0
    buffer_load_dwordx4 v[204:207], v8, s[8:11], s17 offen offset:1024
    buffer_load_dwordx4 v[208:211], v8, s[8:11], s17 offen offset:2048
    buffer_load_dwordx4 v[212:215], v8, s[8:11], s17 offen offset:3072
    s_waitcnt vmcnt(3)
    v_mfma_f32_16x16x32_bf16 v[184:187], v[200:203], v[152:155], v[216:219]
    v_mfma_f32_16x16x32_bf16 v[188:191], v[200:203], v[168:171], v[220:223]
    s_waitcnt vmcnt(2)
    v_mfma_f32_16x16x32_bf16 v[192:195], v[204:207], v[152:155], v[216:219]
    v_mfma_f32_16x16x32_bf16 v[196:199], v[204:207], v[168:171], v[220:223]
    s_waitcnt vmcnt(1)
    v_mfma_f32_16x16x32_bf16 v[184:187], v[208:211], v[156:159], v[184:187]
    v_mfma_f32_16x16x32_bf16 v[188:191], v[208:211], v[172:175], v[188:191]
    s_waitcnt vmcnt(0)
    v_mfma_f32_16x16x32_bf16 v[192:195], v[212:215], v[156:159], v[192:195]
    v_mfma_f32_16x16x32_bf16 v[196:199], v[212:215], v[172:175], v[196:199]
    s_mov_b32 s17, 0x11000
    buffer_load_dwordx4 v[200:203], v8, s[8:11], s17 offen offset:0
    buffer_load_dwordx4 v[204:207], v8, s[8:11], s17 offen offset:1024
    buffer_load_dwordx4 v[208:211], v8, s[8:11], s17 offen offset:2048
    buffer_load_dwordx4 v[212:215], v8, s[8:11], s17 offen offset:3072
    s_waitcnt vmcnt(3)
    v_mfma_f32_16x16x32_bf16 v[184:187], v[200:203], v[160:163], v[184:187]
    v_mfma_f32_16x16x32_bf16 v[188:191], v[200:203], v[176:179], v[188:191]
    s_waitcnt vmcnt(2)
    v_mfma_f32_16x16x32_bf16 v[192:195], v[204:207], v[160:163], v[192:195]
    v_mfma_f32_16x16x32_bf16 v[196:199], v[204:207], v[176:179], v[196:199]
    s_waitcnt vmcnt(1)
    v_mfma_f32_16x16x32_bf16 v[184:187], v[208:211], v[164:167], v[184:187]
    v_mfma_f32_16x16x32_bf16 v[188:191], v[208:211], v[180:183], v[188:191]
    s_waitcnt vmcnt(0)
    v_mfma_f32_16x16x32_bf16 v[192:195], v[212:215], v[164:167], v[192:195]
    v_mfma_f32_16x16x32_bf16 v[196:199], v[212:215], v[180:183], v[196:199]
    s_nop 3
    v_exp_f32 v184, v184
    v_exp_f32 v185, v185
    v_add_f32 v9, v9, v184
    v_add_f32 v9, v9, v185
    v_cvt_pk_bf16_f32 v88, v184, v185
    v_exp_f32 v186, v186
    v_exp_f32 v187, v187
    v_add_f32 v9, v9, v186
    v_add_f32 v9, v9, v187
    v_cvt_pk_bf16_f32 v89, v186, v187
    v_exp_f32 v188, v188
    v_exp_f32 v189, v189
    v_add_f32 v10, v10, v188
    v_add_f32 v10, v10, v189
    v_cvt_pk_bf16_f32 v92, v188, v189
    v_exp_f32 v190, v190
    v_exp_f32 v191, v191
    v_add_f32 v10, v10, v190
    v_add_f32 v10, v10, v191
    v_cvt_pk_bf16_f32 v93, v190, v191
    v_exp_f32 v192, v192
    v_exp_f32 v193, v193
    v_add_f32 v9, v9, v192
    v_add_f32 v9, v9, v193
    v_cvt_pk_bf16_f32 v90, v192, v193
    v_exp_f32 v194, v194
    v_exp_f32 v195, v195
    v_add_f32 v9, v9, v194
    v_add_f32 v9, v9, v195
    v_cvt_pk_bf16_f32 v91, v194, v195
    v_exp_f32 v196, v196
    v_exp_f32 v197, v197
    v_add_f32 v10, v10, v196
    v_add_f32 v10, v10, v197
    v_cvt_pk_bf16_f32 v94, v196, v197
    v_exp_f32 v198, v198
    v_exp_f32 v199, v199
    v_add_f32 v10, v10, v198
    v_add_f32 v10, v10, v199
    v_cvt_pk_bf16_f32 v95, v198, v199
    s_mov_b32 s17, 0x12000
    buffer_load_dwordx4 v[200:203], v8, s[8:11], s17 offen offset:0
    buffer_load_dwordx4 v[204:207], v8, s[8:11], s17 offen offset:1024
    buffer_load_dwordx4 v[208:211], v8, s[8:11], s17 offen offset:2048
    buffer_load_dwordx4 v[212:215], v8, s[8:11], s17 offen offset:3072
    s_waitcnt vmcnt(3)
    v_mfma_f32_16x16x32_bf16 v[184:187], v[200:203], v[152:155], v[216:219]
    v_mfma_f32_16x16x32_bf16 v[188:191], v[200:203], v[168:171], v[220:223]
    s_waitcnt vmcnt(2)
    v_mfma_f32_16x16x32_bf16 v[192:195], v[204:207], v[152:155], v[216:219]
    v_mfma_f32_16x16x32_bf16 v[196:199], v[204:207], v[168:171], v[220:223]
    s_waitcnt vmcnt(1)
    v_mfma_f32_16x16x32_bf16 v[184:187], v[208:211], v[156:159], v[184:187]
    v_mfma_f32_16x16x32_bf16 v[188:191], v[208:211], v[172:175], v[188:191]
    s_waitcnt vmcnt(0)
    v_mfma_f32_16x16x32_bf16 v[192:195], v[212:215], v[156:159], v[192:195]
    v_mfma_f32_16x16x32_bf16 v[196:199], v[212:215], v[172:175], v[196:199]
    s_mov_b32 s17, 0x13000
    buffer_load_dwordx4 v[200:203], v8, s[8:11], s17 offen offset:0
    buffer_load_dwordx4 v[204:207], v8, s[8:11], s17 offen offset:1024
    buffer_load_dwordx4 v[208:211], v8, s[8:11], s17 offen offset:2048
    buffer_load_dwordx4 v[212:215], v8, s[8:11], s17 offen offset:3072
    s_waitcnt vmcnt(3)
    v_mfma_f32_16x16x32_bf16 v[184:187], v[200:203], v[160:163], v[184:187]
    v_mfma_f32_16x16x32_bf16 v[188:191], v[200:203], v[176:179], v[188:191]
    s_waitcnt vmcnt(2)
    v_mfma_f32_16x16x32_bf16 v[192:195], v[204:207], v[160:163], v[192:195]
    v_mfma_f32_16x16x32_bf16 v[196:199], v[204:207], v[176:179], v[196:199]
    s_waitcnt vmcnt(1)
    v_mfma_f32_16x16x32_bf16 v[184:187], v[208:211], v[164:167], v[184:187]
    v_mfma_f32_16x16x32_bf16 v[188:191], v[208:211], v[180:183], v[188:191]
    s_waitcnt vmcnt(0)
    v_mfma_f32_16x16x32_bf16 v[192:195], v[212:215], v[164:167], v[192:195]
    v_mfma_f32_16x16x32_bf16 v[196:199], v[212:215], v[180:183], v[196:199]
    s_nop 3
    v_exp_f32 v184, v184
    v_exp_f32 v185, v185
    v_add_f32 v9, v9, v184
    v_add_f32 v9, v9, v185
    v_cvt_pk_bf16_f32 v96, v184, v185
    v_exp_f32 v186, v186
    v_exp_f32 v187, v187
    v_add_f32 v9, v9, v186
    v_add_f32 v9, v9, v187
    v_cvt_pk_bf16_f32 v97, v186, v187
    v_exp_f32 v188, v188
    v_exp_f32 v189, v189
    v_add_f32 v10, v10, v188
    v_add_f32 v10, v10, v189
    v_cvt_pk_bf16_f32 v100, v188, v189
    v_exp_f32 v190, v190
    v_exp_f32 v191, v191
    v_add_f32 v10, v10, v190
    v_add_f32 v10, v10, v191
    v_cvt_pk_bf16_f32 v101, v190, v191
    v_exp_f32 v192, v192
    v_exp_f32 v193, v193
    v_add_f32 v9, v9, v192
    v_add_f32 v9, v9, v193
    v_cvt_pk_bf16_f32 v98, v192, v193
    v_exp_f32 v194, v194
    v_exp_f32 v195, v195
    v_add_f32 v9, v9, v194
    v_add_f32 v9, v9, v195
    v_cvt_pk_bf16_f32 v99, v194, v195
    v_exp_f32 v196, v196
    v_exp_f32 v197, v197
    v_add_f32 v10, v10, v196
    v_add_f32 v10, v10, v197
    v_cvt_pk_bf16_f32 v102, v196, v197
    v_exp_f32 v198, v198
    v_exp_f32 v199, v199
    v_add_f32 v10, v10, v198
    v_add_f32 v10, v10, v199
    v_cvt_pk_bf16_f32 v103, v198, v199
    s_mov_b32 s17, 0x14000
    buffer_load_dwordx4 v[200:203], v8, s[8:11], s17 offen offset:0
    buffer_load_dwordx4 v[204:207], v8, s[8:11], s17 offen offset:1024
    buffer_load_dwordx4 v[208:211], v8, s[8:11], s17 offen offset:2048
    buffer_load_dwordx4 v[212:215], v8, s[8:11], s17 offen offset:3072
    s_waitcnt vmcnt(3)
    v_mfma_f32_16x16x32_bf16 v[184:187], v[200:203], v[152:155], v[216:219]
    v_mfma_f32_16x16x32_bf16 v[188:191], v[200:203], v[168:171], v[220:223]
    s_waitcnt vmcnt(2)
    v_mfma_f32_16x16x32_bf16 v[192:195], v[204:207], v[152:155], v[216:219]
    v_mfma_f32_16x16x32_bf16 v[196:199], v[204:207], v[168:171], v[220:223]
    s_waitcnt vmcnt(1)
    v_mfma_f32_16x16x32_bf16 v[184:187], v[208:211], v[156:159], v[184:187]
    v_mfma_f32_16x16x32_bf16 v[188:191], v[208:211], v[172:175], v[188:191]
    s_waitcnt vmcnt(0)
    v_mfma_f32_16x16x32_bf16 v[192:195], v[212:215], v[156:159], v[192:195]
    v_mfma_f32_16x16x32_bf16 v[196:199], v[212:215], v[172:175], v[196:199]
    s_mov_b32 s17, 0x15000
    buffer_load_dwordx4 v[200:203], v8, s[8:11], s17 offen offset:0
    buffer_load_dwordx4 v[204:207], v8, s[8:11], s17 offen offset:1024
    buffer_load_dwordx4 v[208:211], v8, s[8:11], s17 offen offset:2048
    buffer_load_dwordx4 v[212:215], v8, s[8:11], s17 offen offset:3072
    s_waitcnt vmcnt(3)
    v_mfma_f32_16x16x32_bf16 v[184:187], v[200:203], v[160:163], v[184:187]
    v_mfma_f32_16x16x32_bf16 v[188:191], v[200:203], v[176:179], v[188:191]
    s_waitcnt vmcnt(2)
    v_mfma_f32_16x16x32_bf16 v[192:195], v[204:207], v[160:163], v[192:195]
    v_mfma_f32_16x16x32_bf16 v[196:199], v[204:207], v[176:179], v[196:199]
    s_waitcnt vmcnt(1)
    v_mfma_f32_16x16x32_bf16 v[184:187], v[208:211], v[164:167], v[184:187]
    v_mfma_f32_16x16x32_bf16 v[188:191], v[208:211], v[180:183], v[188:191]
    s_waitcnt vmcnt(0)
    v_mfma_f32_16x16x32_bf16 v[192:195], v[212:215], v[164:167], v[192:195]
    v_mfma_f32_16x16x32_bf16 v[196:199], v[212:215], v[180:183], v[196:199]
    s_nop 3
    v_exp_f32 v184, v184
    v_exp_f32 v185, v185
    v_add_f32 v9, v9, v184
    v_add_f32 v9, v9, v185
    v_cvt_pk_bf16_f32 v104, v184, v185
    v_exp_f32 v186, v186
    v_exp_f32 v187, v187
    v_add_f32 v9, v9, v186
    v_add_f32 v9, v9, v187
    v_cvt_pk_bf16_f32 v105, v186, v187
    v_exp_f32 v188, v188
    v_exp_f32 v189, v189
    v_add_f32 v10, v10, v188
    v_add_f32 v10, v10, v189
    v_cvt_pk_bf16_f32 v108, v188, v189
    v_exp_f32 v190, v190
    v_exp_f32 v191, v191
    v_add_f32 v10, v10, v190
    v_add_f32 v10, v10, v191
    v_cvt_pk_bf16_f32 v109, v190, v191
    v_exp_f32 v192, v192
    v_exp_f32 v193, v193
    v_add_f32 v9, v9, v192
    v_add_f32 v9, v9, v193
    v_cvt_pk_bf16_f32 v106, v192, v193
    v_exp_f32 v194, v194
    v_exp_f32 v195, v195
    v_add_f32 v9, v9, v194
    v_add_f32 v9, v9, v195
    v_cvt_pk_bf16_f32 v107, v194, v195
    v_exp_f32 v196, v196
    v_exp_f32 v197, v197
    v_add_f32 v10, v10, v196
    v_add_f32 v10, v10, v197
    v_cvt_pk_bf16_f32 v110, v196, v197
    v_exp_f32 v198, v198
    v_exp_f32 v199, v199
    v_add_f32 v10, v10, v198
    v_add_f32 v10, v10, v199
    v_cvt_pk_bf16_f32 v111, v198, v199
    s_mov_b32 s17, 0x16000
    buffer_load_dwordx4 v[200:203], v8, s[8:11], s17 offen offset:0
    buffer_load_dwordx4 v[204:207], v8, s[8:11], s17 offen offset:1024
    buffer_load_dwordx4 v[208:211], v8, s[8:11], s17 offen offset:2048
    buffer_load_dwordx4 v[212:215], v8, s[8:11], s17 offen offset:3072
    s_waitcnt vmcnt(3)
    v_mfma_f32_16x16x32_bf16 v[184:187], v[200:203], v[152:155], v[216:219]
    v_mfma_f32_16x16x32_bf16 v[188:191], v[200:203], v[168:171], v[220:223]
    s_waitcnt vmcnt(2)
    v_mfma_f32_16x16x32_bf16 v[192:195], v[204:207], v[152:155], v[216:219]
    v_mfma_f32_16x16x32_bf16 v[196:199], v[204:207], v[168:171], v[220:223]
    s_waitcnt vmcnt(1)
    v_mfma_f32_16x16x32_bf16 v[184:187], v[208:211], v[156:159], v[184:187]
    v_mfma_f32_16x16x32_bf16 v[188:191], v[208:211], v[172:175], v[188:191]
    s_waitcnt vmcnt(0)
    v_mfma_f32_16x16x32_bf16 v[192:195], v[212:215], v[156:159], v[192:195]
    v_mfma_f32_16x16x32_bf16 v[196:199], v[212:215], v[172:175], v[196:199]
    s_mov_b32 s17, 0x17000
    buffer_load_dwordx4 v[200:203], v8, s[8:11], s17 offen offset:0
    buffer_load_dwordx4 v[204:207], v8, s[8:11], s17 offen offset:1024
    buffer_load_dwordx4 v[208:211], v8, s[8:11], s17 offen offset:2048
    buffer_load_dwordx4 v[212:215], v8, s[8:11], s17 offen offset:3072
    s_waitcnt vmcnt(3)
    v_mfma_f32_16x16x32_bf16 v[184:187], v[200:203], v[160:163], v[184:187]
    v_mfma_f32_16x16x32_bf16 v[188:191], v[200:203], v[176:179], v[188:191]
    s_waitcnt vmcnt(2)
    v_mfma_f32_16x16x32_bf16 v[192:195], v[204:207], v[160:163], v[192:195]
    v_mfma_f32_16x16x32_bf16 v[196:199], v[204:207], v[176:179], v[196:199]
    s_waitcnt vmcnt(1)
    v_mfma_f32_16x16x32_bf16 v[184:187], v[208:211], v[164:167], v[184:187]
    v_mfma_f32_16x16x32_bf16 v[188:191], v[208:211], v[180:183], v[188:191]
    s_waitcnt vmcnt(0)
    v_mfma_f32_16x16x32_bf16 v[192:195], v[212:215], v[164:167], v[192:195]
    v_mfma_f32_16x16x32_bf16 v[196:199], v[212:215], v[180:183], v[196:199]
    s_nop 3
    v_exp_f32 v184, v184
    v_exp_f32 v185, v185
    v_add_f32 v9, v9, v184
    v_add_f32 v9, v9, v185
    v_cvt_pk_bf16_f32 v112, v184, v185
    v_exp_f32 v186, v186
    v_exp_f32 v187, v187
    v_add_f32 v9, v9, v186
    v_add_f32 v9, v9, v187
    v_cvt_pk_bf16_f32 v113, v186, v187
    v_exp_f32 v188, v188
    v_exp_f32 v189, v189
    v_add_f32 v10, v10, v188
    v_add_f32 v10, v10, v189
    v_cvt_pk_bf16_f32 v116, v188, v189
    v_exp_f32 v190, v190
    v_exp_f32 v191, v191
    v_add_f32 v10, v10, v190
    v_add_f32 v10, v10, v191
    v_cvt_pk_bf16_f32 v117, v190, v191
    v_exp_f32 v192, v192
    v_exp_f32 v193, v193
    v_add_f32 v9, v9, v192
    v_add_f32 v9, v9, v193
    v_cvt_pk_bf16_f32 v114, v192, v193
    v_exp_f32 v194, v194
    v_exp_f32 v195, v195
    v_add_f32 v9, v9, v194
    v_add_f32 v9, v9, v195
    v_cvt_pk_bf16_f32 v115, v194, v195
    v_exp_f32 v196, v196
    v_exp_f32 v197, v197
    v_add_f32 v10, v10, v196
    v_add_f32 v10, v10, v197
    v_cvt_pk_bf16_f32 v118, v196, v197
    v_exp_f32 v198, v198
    v_exp_f32 v199, v199
    v_add_f32 v10, v10, v198
    v_add_f32 v10, v10, v199
    v_cvt_pk_bf16_f32 v119, v198, v199
    s_mov_b32 s17, 0x18000
    buffer_load_dwordx4 v[200:203], v8, s[8:11], s17 offen offset:0
    buffer_load_dwordx4 v[204:207], v8, s[8:11], s17 offen offset:1024
    buffer_load_dwordx4 v[208:211], v8, s[8:11], s17 offen offset:2048
    buffer_load_dwordx4 v[212:215], v8, s[8:11], s17 offen offset:3072
    s_waitcnt vmcnt(3)
    v_mfma_f32_16x16x32_bf16 v[184:187], v[200:203], v[152:155], v[216:219]
    v_mfma_f32_16x16x32_bf16 v[188:191], v[200:203], v[168:171], v[220:223]
    s_waitcnt vmcnt(2)
    v_mfma_f32_16x16x32_bf16 v[192:195], v[204:207], v[152:155], v[216:219]
    v_mfma_f32_16x16x32_bf16 v[196:199], v[204:207], v[168:171], v[220:223]
    s_waitcnt vmcnt(1)
    v_mfma_f32_16x16x32_bf16 v[184:187], v[208:211], v[156:159], v[184:187]
    v_mfma_f32_16x16x32_bf16 v[188:191], v[208:211], v[172:175], v[188:191]
    s_waitcnt vmcnt(0)
    v_mfma_f32_16x16x32_bf16 v[192:195], v[212:215], v[156:159], v[192:195]
    v_mfma_f32_16x16x32_bf16 v[196:199], v[212:215], v[172:175], v[196:199]
    s_mov_b32 s17, 0x19000
    buffer_load_dwordx4 v[200:203], v8, s[8:11], s17 offen offset:0
    buffer_load_dwordx4 v[204:207], v8, s[8:11], s17 offen offset:1024
    buffer_load_dwordx4 v[208:211], v8, s[8:11], s17 offen offset:2048
    buffer_load_dwordx4 v[212:215], v8, s[8:11], s17 offen offset:3072
    s_waitcnt vmcnt(3)
    v_mfma_f32_16x16x32_bf16 v[184:187], v[200:203], v[160:163], v[184:187]
    v_mfma_f32_16x16x32_bf16 v[188:191], v[200:203], v[176:179], v[188:191]
    s_waitcnt vmcnt(2)
    v_mfma_f32_16x16x32_bf16 v[192:195], v[204:207], v[160:163], v[192:195]
    v_mfma_f32_16x16x32_bf16 v[196:199], v[204:207], v[176:179], v[196:199]
    s_waitcnt vmcnt(1)
    v_mfma_f32_16x16x32_bf16 v[184:187], v[208:211], v[164:167], v[184:187]
    v_mfma_f32_16x16x32_bf16 v[188:191], v[208:211], v[180:183], v[188:191]
    s_waitcnt vmcnt(0)
    v_mfma_f32_16x16x32_bf16 v[192:195], v[212:215], v[164:167], v[192:195]
    v_mfma_f32_16x16x32_bf16 v[196:199], v[212:215], v[180:183], v[196:199]
    s_nop 3
    v_exp_f32 v184, v184
    v_exp_f32 v185, v185
    v_add_f32 v9, v9, v184
    v_add_f32 v9, v9, v185
    v_cvt_pk_bf16_f32 v120, v184, v185
    v_exp_f32 v186, v186
    v_exp_f32 v187, v187
    v_add_f32 v9, v9, v186
    v_add_f32 v9, v9, v187
    v_cvt_pk_bf16_f32 v121, v186, v187
    v_exp_f32 v188, v188
    v_exp_f32 v189, v189
    v_add_f32 v10, v10, v188
    v_add_f32 v10, v10, v189
    v_cvt_pk_bf16_f32 v124, v188, v189
    v_exp_f32 v190, v190
    v_exp_f32 v191, v191
    v_add_f32 v10, v10, v190
    v_add_f32 v10, v10, v191
    v_cvt_pk_bf16_f32 v125, v190, v191
    v_exp_f32 v192, v192
    v_exp_f32 v193, v193
    v_add_f32 v9, v9, v192
    v_add_f32 v9, v9, v193
    v_cvt_pk_bf16_f32 v122, v192, v193
    v_exp_f32 v194, v194
    v_exp_f32 v195, v195
    v_add_f32 v9, v9, v194
    v_add_f32 v9, v9, v195
    v_cvt_pk_bf16_f32 v123, v194, v195
    v_exp_f32 v196, v196
    v_exp_f32 v197, v197
    v_add_f32 v10, v10, v196
    v_add_f32 v10, v10, v197
    v_cvt_pk_bf16_f32 v126, v196, v197
    v_exp_f32 v198, v198
    v_exp_f32 v199, v199
    v_add_f32 v10, v10, v198
    v_add_f32 v10, v10, v199
    v_cvt_pk_bf16_f32 v127, v198, v199
    s_mov_b32 s17, 0x1a000
    buffer_load_dwordx4 v[200:203], v8, s[8:11], s17 offen offset:0
    buffer_load_dwordx4 v[204:207], v8, s[8:11], s17 offen offset:1024
    buffer_load_dwordx4 v[208:211], v8, s[8:11], s17 offen offset:2048
    buffer_load_dwordx4 v[212:215], v8, s[8:11], s17 offen offset:3072
    s_waitcnt vmcnt(3)
    v_mfma_f32_16x16x32_bf16 v[184:187], v[200:203], v[152:155], v[216:219]
    v_mfma_f32_16x16x32_bf16 v[188:191], v[200:203], v[168:171], v[220:223]
    s_waitcnt vmcnt(2)
    v_mfma_f32_16x16x32_bf16 v[192:195], v[204:207], v[152:155], v[216:219]
    v_mfma_f32_16x16x32_bf16 v[196:199], v[204:207], v[168:171], v[220:223]
    s_waitcnt vmcnt(1)
    v_mfma_f32_16x16x32_bf16 v[184:187], v[208:211], v[156:159], v[184:187]
    v_mfma_f32_16x16x32_bf16 v[188:191], v[208:211], v[172:175], v[188:191]
    s_waitcnt vmcnt(0)
    v_mfma_f32_16x16x32_bf16 v[192:195], v[212:215], v[156:159], v[192:195]
    v_mfma_f32_16x16x32_bf16 v[196:199], v[212:215], v[172:175], v[196:199]
    s_mov_b32 s17, 0x1b000
    buffer_load_dwordx4 v[200:203], v8, s[8:11], s17 offen offset:0
    buffer_load_dwordx4 v[204:207], v8, s[8:11], s17 offen offset:1024
    buffer_load_dwordx4 v[208:211], v8, s[8:11], s17 offen offset:2048
    buffer_load_dwordx4 v[212:215], v8, s[8:11], s17 offen offset:3072
    s_waitcnt vmcnt(3)
    v_mfma_f32_16x16x32_bf16 v[184:187], v[200:203], v[160:163], v[184:187]
    v_mfma_f32_16x16x32_bf16 v[188:191], v[200:203], v[176:179], v[188:191]
    s_waitcnt vmcnt(2)
    v_mfma_f32_16x16x32_bf16 v[192:195], v[204:207], v[160:163], v[192:195]
    v_mfma_f32_16x16x32_bf16 v[196:199], v[204:207], v[176:179], v[196:199]
    s_waitcnt vmcnt(1)
    v_mfma_f32_16x16x32_bf16 v[184:187], v[208:211], v[164:167], v[184:187]
    v_mfma_f32_16x16x32_bf16 v[188:191], v[208:211], v[180:183], v[188:191]
    s_waitcnt vmcnt(0)
    v_mfma_f32_16x16x32_bf16 v[192:195], v[212:215], v[164:167], v[192:195]
    v_mfma_f32_16x16x32_bf16 v[196:199], v[212:215], v[180:183], v[196:199]
    s_nop 3
    v_exp_f32 v184, v184
    v_exp_f32 v185, v185
    v_add_f32 v9, v9, v184
    v_add_f32 v9, v9, v185
    v_cvt_pk_bf16_f32 v128, v184, v185
    v_exp_f32 v186, v186
    v_exp_f32 v187, v187
    v_add_f32 v9, v9, v186
    v_add_f32 v9, v9, v187
    v_cvt_pk_bf16_f32 v129, v186, v187
    v_exp_f32 v188, v188
    v_exp_f32 v189, v189
    v_add_f32 v10, v10, v188
    v_add_f32 v10, v10, v189
    v_cvt_pk_bf16_f32 v132, v188, v189
    v_exp_f32 v190, v190
    v_exp_f32 v191, v191
    v_add_f32 v10, v10, v190
    v_add_f32 v10, v10, v191
    v_cvt_pk_bf16_f32 v133, v190, v191
    v_exp_f32 v192, v192
    v_exp_f32 v193, v193
    v_add_f32 v9, v9, v192
    v_add_f32 v9, v9, v193
    v_cvt_pk_bf16_f32 v130, v192, v193
    v_exp_f32 v194, v194
    v_exp_f32 v195, v195
    v_add_f32 v9, v9, v194
    v_add_f32 v9, v9, v195
    v_cvt_pk_bf16_f32 v131, v194, v195
    v_exp_f32 v196, v196
    v_exp_f32 v197, v197
    v_add_f32 v10, v10, v196
    v_add_f32 v10, v10, v197
    v_cvt_pk_bf16_f32 v134, v196, v197
    v_exp_f32 v198, v198
    v_exp_f32 v199, v199
    v_add_f32 v10, v10, v198
    v_add_f32 v10, v10, v199
    v_cvt_pk_bf16_f32 v135, v198, v199
    s_mov_b32 s17, 0x1c000
    buffer_load_dwordx4 v[200:203], v8, s[8:11], s17 offen offset:0
    buffer_load_dwordx4 v[204:207], v8, s[8:11], s17 offen offset:1024
    buffer_load_dwordx4 v[208:211], v8, s[8:11], s17 offen offset:2048
    buffer_load_dwordx4 v[212:215], v8, s[8:11], s17 offen offset:3072
    s_waitcnt vmcnt(3)
    v_mfma_f32_16x16x32_bf16 v[184:187], v[200:203], v[152:155], v[216:219]
    v_mfma_f32_16x16x32_bf16 v[188:191], v[200:203], v[168:171], v[220:223]
    s_waitcnt vmcnt(2)
    v_mfma_f32_16x16x32_bf16 v[192:195], v[204:207], v[152:155], v[216:219]
    v_mfma_f32_16x16x32_bf16 v[196:199], v[204:207], v[168:171], v[220:223]
    s_waitcnt vmcnt(1)
    v_mfma_f32_16x16x32_bf16 v[184:187], v[208:211], v[156:159], v[184:187]
    v_mfma_f32_16x16x32_bf16 v[188:191], v[208:211], v[172:175], v[188:191]
    s_waitcnt vmcnt(0)
    v_mfma_f32_16x16x32_bf16 v[192:195], v[212:215], v[156:159], v[192:195]
    v_mfma_f32_16x16x32_bf16 v[196:199], v[212:215], v[172:175], v[196:199]
    s_mov_b32 s17, 0x1d000
    buffer_load_dwordx4 v[200:203], v8, s[8:11], s17 offen offset:0
    buffer_load_dwordx4 v[204:207], v8, s[8:11], s17 offen offset:1024
    buffer_load_dwordx4 v[208:211], v8, s[8:11], s17 offen offset:2048
    buffer_load_dwordx4 v[212:215], v8, s[8:11], s17 offen offset:3072
    s_waitcnt vmcnt(3)
    v_mfma_f32_16x16x32_bf16 v[184:187], v[200:203], v[160:163], v[184:187]
    v_mfma_f32_16x16x32_bf16 v[188:191], v[200:203], v[176:179], v[188:191]
    s_waitcnt vmcnt(2)
    v_mfma_f32_16x16x32_bf16 v[192:195], v[204:207], v[160:163], v[192:195]
    v_mfma_f32_16x16x32_bf16 v[196:199], v[204:207], v[176:179], v[196:199]
    s_waitcnt vmcnt(1)
    v_mfma_f32_16x16x32_bf16 v[184:187], v[208:211], v[164:167], v[184:187]
    v_mfma_f32_16x16x32_bf16 v[188:191], v[208:211], v[180:183], v[188:191]
    s_waitcnt vmcnt(0)
    v_mfma_f32_16x16x32_bf16 v[192:195], v[212:215], v[164:167], v[192:195]
    v_mfma_f32_16x16x32_bf16 v[196:199], v[212:215], v[180:183], v[196:199]
    s_nop 3
    v_exp_f32 v184, v184
    v_exp_f32 v185, v185
    v_add_f32 v9, v9, v184
    v_add_f32 v9, v9, v185
    v_cvt_pk_bf16_f32 v136, v184, v185
    v_exp_f32 v186, v186
    v_exp_f32 v187, v187
    v_add_f32 v9, v9, v186
    v_add_f32 v9, v9, v187
    v_cvt_pk_bf16_f32 v137, v186, v187
    v_exp_f32 v188, v188
    v_exp_f32 v189, v189
    v_add_f32 v10, v10, v188
    v_add_f32 v10, v10, v189
    v_cvt_pk_bf16_f32 v140, v188, v189
    v_exp_f32 v190, v190
    v_exp_f32 v191, v191
    v_add_f32 v10, v10, v190
    v_add_f32 v10, v10, v191
    v_cvt_pk_bf16_f32 v141, v190, v191
    v_exp_f32 v192, v192
    v_exp_f32 v193, v193
    v_add_f32 v9, v9, v192
    v_add_f32 v9, v9, v193
    v_cvt_pk_bf16_f32 v138, v192, v193
    v_exp_f32 v194, v194
    v_exp_f32 v195, v195
    v_add_f32 v9, v9, v194
    v_add_f32 v9, v9, v195
    v_cvt_pk_bf16_f32 v139, v194, v195
    v_exp_f32 v196, v196
    v_exp_f32 v197, v197
    v_add_f32 v10, v10, v196
    v_add_f32 v10, v10, v197
    v_cvt_pk_bf16_f32 v142, v196, v197
    v_exp_f32 v198, v198
    v_exp_f32 v199, v199
    v_add_f32 v10, v10, v198
    v_add_f32 v10, v10, v199
    v_cvt_pk_bf16_f32 v143, v198, v199
    s_mov_b32 s17, 0x1e000
    buffer_load_dwordx4 v[200:203], v8, s[8:11], s17 offen offset:0
    buffer_load_dwordx4 v[204:207], v8, s[8:11], s17 offen offset:1024
    buffer_load_dwordx4 v[208:211], v8, s[8:11], s17 offen offset:2048
    buffer_load_dwordx4 v[212:215], v8, s[8:11], s17 offen offset:3072
    s_waitcnt vmcnt(3)
    v_mfma_f32_16x16x32_bf16 v[184:187], v[200:203], v[152:155], v[216:219]
    v_mfma_f32_16x16x32_bf16 v[188:191], v[200:203], v[168:171], v[220:223]
    s_waitcnt vmcnt(2)
    v_mfma_f32_16x16x32_bf16 v[192:195], v[204:207], v[152:155], v[216:219]
    v_mfma_f32_16x16x32_bf16 v[196:199], v[204:207], v[168:171], v[220:223]
    s_waitcnt vmcnt(1)
    v_mfma_f32_16x16x32_bf16 v[184:187], v[208:211], v[156:159], v[184:187]
    v_mfma_f32_16x16x32_bf16 v[188:191], v[208:211], v[172:175], v[188:191]
    s_waitcnt vmcnt(0)
    v_mfma_f32_16x16x32_bf16 v[192:195], v[212:215], v[156:159], v[192:195]
    v_mfma_f32_16x16x32_bf16 v[196:199], v[212:215], v[172:175], v[196:199]
    s_mov_b32 s17, 0x1f000
    buffer_load_dwordx4 v[200:203], v8, s[8:11], s17 offen offset:0
    buffer_load_dwordx4 v[204:207], v8, s[8:11], s17 offen offset:1024
    buffer_load_dwordx4 v[208:211], v8, s[8:11], s17 offen offset:2048
    buffer_load_dwordx4 v[212:215], v8, s[8:11], s17 offen offset:3072
    s_waitcnt vmcnt(3)
    v_mfma_f32_16x16x32_bf16 v[184:187], v[200:203], v[160:163], v[184:187]
    v_mfma_f32_16x16x32_bf16 v[188:191], v[200:203], v[176:179], v[188:191]
    s_waitcnt vmcnt(2)
    v_mfma_f32_16x16x32_bf16 v[192:195], v[204:207], v[160:163], v[192:195]
    v_mfma_f32_16x16x32_bf16 v[196:199], v[204:207], v[176:179], v[196:199]
    s_waitcnt vmcnt(1)
    v_mfma_f32_16x16x32_bf16 v[184:187], v[208:211], v[164:167], v[184:187]
    v_mfma_f32_16x16x32_bf16 v[188:191], v[208:211], v[180:183], v[188:191]
    s_waitcnt vmcnt(0)
    v_mfma_f32_16x16x32_bf16 v[192:195], v[212:215], v[164:167], v[192:195]
    v_mfma_f32_16x16x32_bf16 v[196:199], v[212:215], v[180:183], v[196:199]
    s_nop 3
    v_exp_f32 v184, v184
    v_exp_f32 v185, v185
    v_add_f32 v9, v9, v184
    v_add_f32 v9, v9, v185
    v_cvt_pk_bf16_f32 v144, v184, v185
    v_exp_f32 v186, v186
    v_exp_f32 v187, v187
    v_add_f32 v9, v9, v186
    v_add_f32 v9, v9, v187
    v_cvt_pk_bf16_f32 v145, v186, v187
    v_exp_f32 v188, v188
    v_exp_f32 v189, v189
    v_add_f32 v10, v10, v188
    v_add_f32 v10, v10, v189
    v_cvt_pk_bf16_f32 v148, v188, v189
    v_exp_f32 v190, v190
    v_exp_f32 v191, v191
    v_add_f32 v10, v10, v190
    v_add_f32 v10, v10, v191
    v_cvt_pk_bf16_f32 v149, v190, v191
    v_exp_f32 v192, v192
    v_exp_f32 v193, v193
    v_add_f32 v9, v9, v192
    v_add_f32 v9, v9, v193
    v_cvt_pk_bf16_f32 v146, v192, v193
    v_exp_f32 v194, v194
    v_exp_f32 v195, v195
    v_add_f32 v9, v9, v194
    v_add_f32 v9, v9, v195
    v_cvt_pk_bf16_f32 v147, v194, v195
    v_exp_f32 v196, v196
    v_exp_f32 v197, v197
    v_add_f32 v10, v10, v196
    v_add_f32 v10, v10, v197
    v_cvt_pk_bf16_f32 v150, v196, v197
    v_exp_f32 v198, v198
    v_exp_f32 v199, v199
    v_add_f32 v10, v10, v198
    v_add_f32 v10, v10, v199
    v_cvt_pk_bf16_f32 v151, v198, v199
    v_mov_b32 v16, v9
    v_mov_b32 v18, v10
    s_nop 0
    v_permlane16_swap_b32 v9, v16
    v_permlane16_swap_b32 v10, v18
    v_add_f32 v9, v9, v16
    v_add_f32 v10, v10, v18
    v_mov_b32 v16, v9
    v_mov_b32 v18, v10
    s_nop 0
    v_permlane32_swap_b32 v9, v16
    v_permlane32_swap_b32 v10, v18
    v_add_f32 v9, v9, v16
    v_add_f32 v10, v10, v18
    s_waitcnt vmcnt(0) lgkmcnt(0)
    s_nop 15
    s_nop 3
    s_branch adaLN_cond__sliding_block_cached__moe_arch_mod__prompt_kernel_fixAb
adaLN_cond__sliding_block_cached__moe_arch_mod__prompt_kernel_mp5r:
    s_waitcnt vmcnt(0) lgkmcnt(0)
    s_nop 15
    s_nop 3
    s_mov_b32 s27, 0
adaLN_cond__sliding_block_cached__moe_arch_mod__prompt_kernel_mp5p:
    buffer_load_dword v248, v250, s[8:11], s14 offen sc1
    s_waitcnt vmcnt(0)
    v_cmp_ne_u32 vcc, s28, v248
    s_add_u32 s27, s27, 1
    s_cmp_ge_u32 s27, 262144
    s_cbranch_scc1 adaLN_cond__sliding_block_cached__moe_arch_mod__prompt_kernel_mp5g
    s_cbranch_vccnz adaLN_cond__sliding_block_cached__moe_arch_mod__prompt_kernel_mp5p
adaLN_cond__sliding_block_cached__moe_arch_mod__prompt_kernel_mp5g:
    s_waitcnt vmcnt(0) lgkmcnt(0)
    s_nop 15
    s_nop 3
    s_branch adaLN_cond__sliding_block_cached__moe_arch_mod__prompt_kernel_mp5b
adaLN_cond__sliding_block_cached__moe_arch_mod__prompt_kernel_o6r:
    s_waitcnt vmcnt(0) lgkmcnt(0)
    s_nop 15
    s_nop 3
    s_mov_b32 s27, 0
adaLN_cond__sliding_block_cached__moe_arch_mod__prompt_kernel_o6p:
    buffer_load_dword v12, v13, s[8:11], s19 offen sc1
    s_waitcnt vmcnt(0)
    v_cmp_ne_u32 vcc, s28, v12
    s_add_u32 s27, s27, 1
    s_cmp_ge_u32 s27, 262144
    s_cbranch_scc1 adaLN_cond__sliding_block_cached__moe_arch_mod__prompt_kernel_o6g
    s_cbranch_vccnz adaLN_cond__sliding_block_cached__moe_arch_mod__prompt_kernel_o6p
adaLN_cond__sliding_block_cached__moe_arch_mod__prompt_kernel_o6g:
    s_waitcnt vmcnt(0) lgkmcnt(0)
    s_nop 15
    s_nop 3
    s_branch adaLN_cond__sliding_block_cached__moe_arch_mod__prompt_kernel_o6b
adaLN_cond__sliding_block_cached__moe_arch_mod__prompt_kernel_o27r:
    s_waitcnt vmcnt(0) lgkmcnt(0)
    s_nop 15
    s_nop 3
    s_mov_b32 s27, 0
adaLN_cond__sliding_block_cached__moe_arch_mod__prompt_kernel_o27p:
    buffer_load_dword v12, v13, s[8:11], s19 offen sc1
    s_waitcnt vmcnt(0)
    v_cmp_ne_u32 vcc, s28, v12
    s_add_u32 s27, s27, 1
    s_cmp_ge_u32 s27, 262144
    s_cbranch_scc1 adaLN_cond__sliding_block_cached__moe_arch_mod__prompt_kernel_o27g
    s_cbranch_vccnz adaLN_cond__sliding_block_cached__moe_arch_mod__prompt_kernel_o27p
adaLN_cond__sliding_block_cached__moe_arch_mod__prompt_kernel_o27g:
    s_waitcnt vmcnt(0) lgkmcnt(0)
    s_nop 15
    s_nop 3
    s_branch adaLN_cond__sliding_block_cached__moe_arch_mod__prompt_kernel_o27b
adaLN_cond__sliding_block_cached__moe_arch_mod__prompt_kernel_o28r:
    s_waitcnt vmcnt(0) lgkmcnt(0)
    s_nop 15
    s_nop 3
    s_mov_b32 s27, 0
adaLN_cond__sliding_block_cached__moe_arch_mod__prompt_kernel_o28p:
    buffer_load_dword v12, v13, s[8:11], s19 offen sc1
    s_waitcnt vmcnt(0)
    v_cmp_ne_u32 vcc, s28, v12
    s_add_u32 s27, s27, 1
    s_cmp_ge_u32 s27, 262144
    s_cbranch_scc1 adaLN_cond__sliding_block_cached__moe_arch_mod__prompt_kernel_o28g
    s_cbranch_vccnz adaLN_cond__sliding_block_cached__moe_arch_mod__prompt_kernel_o28p
adaLN_cond__sliding_block_cached__moe_arch_mod__prompt_kernel_o28g:
    s_waitcnt vmcnt(0) lgkmcnt(0)
    s_nop 15
    s_nop 3
    s_branch adaLN_cond__sliding_block_cached__moe_arch_mod__prompt_kernel_o28b
adaLN_cond__sliding_block_cached__moe_arch_mod__prompt_kernel_o29r:
    s_waitcnt vmcnt(0) lgkmcnt(0)
    s_nop 15
    s_nop 3
    s_mov_b32 s27, 0
adaLN_cond__sliding_block_cached__moe_arch_mod__prompt_kernel_o29p:
    buffer_load_dword v12, v13, s[8:11], s19 offen sc1
    s_waitcnt vmcnt(0)
    v_cmp_ne_u32 vcc, s28, v12
    s_add_u32 s27, s27, 1
    s_cmp_ge_u32 s27, 262144
    s_cbranch_scc1 adaLN_cond__sliding_block_cached__moe_arch_mod__prompt_kernel_o29g
    s_cbranch_vccnz adaLN_cond__sliding_block_cached__moe_arch_mod__prompt_kernel_o29p
adaLN_cond__sliding_block_cached__moe_arch_mod__prompt_kernel_o29g:
    s_waitcnt vmcnt(0) lgkmcnt(0)
    s_nop 15
    s_nop 3
    s_branch adaLN_cond__sliding_block_cached__moe_arch_mod__prompt_kernel_o29b
adaLN_cond__sliding_block_cached__moe_arch_mod__prompt_kernel_mf10r:
    s_waitcnt vmcnt(0) lgkmcnt(0)
    s_nop 15
    s_nop 3
    s_mov_b32 s27, 0
adaLN_cond__sliding_block_cached__moe_arch_mod__prompt_kernel_mf10p:
    s_mov_b32 s16, 0x544000
    buffer_load_dwordx4 v[184:187], v2, s[8:11], s16 offen sc1
    s_waitcnt vmcnt(0)
    v_xor_b32 v16, s28, v184
    v_xor_b32 v17, s28, v185
    v_xor_b32 v18, s28, v186
    v_xor_b32 v19, s28, v187
    v_or3_b32 v16, v16, v17, v18
    v_or_b32 v16, v16, v19
    v_cmp_ne_u32 vcc, 0, v16
    s_add_u32 s27, s27, 1
    s_cmp_ge_u32 s27, 262144
    s_cbranch_scc1 adaLN_cond__sliding_block_cached__moe_arch_mod__prompt_kernel_mf10g
    s_cbranch_vccnz adaLN_cond__sliding_block_cached__moe_arch_mod__prompt_kernel_mf10p
adaLN_cond__sliding_block_cached__moe_arch_mod__prompt_kernel_mf10g:
    s_waitcnt vmcnt(0) lgkmcnt(0)
    s_nop 15
    s_nop 3
    s_branch adaLN_cond__sliding_block_cached__moe_arch_mod__prompt_kernel_mf10b
adaLN_cond__sliding_block_cached__moe_arch_mod__prompt_kernel_kv16r:
    s_waitcnt vmcnt(0) lgkmcnt(0)
    s_nop 15
    s_nop 3
    s_mov_b32 s27, 0
adaLN_cond__sliding_block_cached__moe_arch_mod__prompt_kernel_kv16p:
    buffer_load_dwordx4 v[12:15], v21, s[8:11], s18 offen sc1
    s_waitcnt vmcnt(0)
    v_xor_b32 v8, s28, v12
    v_xor_b32 v20, s28, v13
    v_or_b32 v8, v8, v20
    v_xor_b32 v20, s28, v14
    v_or_b32 v8, v8, v20
    v_xor_b32 v20, s28, v15
    v_or_b32 v8, v8, v20
    v_cmp_ne_u32 vcc, 0, v8
    s_add_u32 s27, s27, 1
    s_cmp_ge_u32 s27, 262144
    s_cbranch_scc1 adaLN_cond__sliding_block_cached__moe_arch_mod__prompt_kernel_kv16g
    s_cbranch_vccnz adaLN_cond__sliding_block_cached__moe_arch_mod__prompt_kernel_kv16p
adaLN_cond__sliding_block_cached__moe_arch_mod__prompt_kernel_kv16g:
    s_waitcnt vmcnt(0) lgkmcnt(0)
    s_nop 15
    s_nop 3
    s_branch adaLN_cond__sliding_block_cached__moe_arch_mod__prompt_kernel_kv16b
adaLN_cond__sliding_block_cached__moe_arch_mod__prompt_kernel_fixB:
    s_waitcnt vmcnt(0) lgkmcnt(0)
    s_nop 15
    s_nop 3
    s_lshr_b32 s16, s12, 3
    s_lshl_b32 s16, s16, 17
    s_add_u32 s16, s16, 0x400000
    v_add_u32 v8, s16, v2
    v_mov_b32 v16, 0xff7fffff
    v_mov_b32 v17, 0xff7fffff
    s_mov_b32 s16, 0
adaLN_cond__sliding_block_cached__moe_arch_mod__prompt_kernel_fixBm:
    s_add_u32 s17, s16, 0
    buffer_load_dwordx4 v[200:203], v8, s[8:11], s17 offen offset:0
    buffer_load_dwordx4 v[204:207], v8, s[8:11], s17 offen offset:1024
    buffer_load_dwordx4 v[208:211], v8, s[8:11], s17 offen offset:2048
    buffer_load_dwordx4 v[212:215], v8, s[8:11], s17 offen offset:3072
    s_waitcnt vmcnt(3)
    v_mfma_f32_16x16x32_bf16 v[184:187], v[200:203], v[152:155], 0
    v_mfma_f32_16x16x32_bf16 v[188:191], v[200:203], v[168:171], 0
    s_waitcnt vmcnt(2)
    v_mfma_f32_16x16x32_bf16 v[192:195], v[204:207], v[152:155], 0
    v_mfma_f32_16x16x32_bf16 v[196:199], v[204:207], v[168:171], 0
    s_waitcnt vmcnt(1)
    v_mfma_f32_16x16x32_bf16 v[184:187], v[208:211], v[156:159], v[184:187]
    v_mfma_f32_16x16x32_bf16 v[188:191], v[208:211], v[172:175], v[188:191]
    s_waitcnt vmcnt(0)
    v_mfma_f32_16x16x32_bf16 v[192:195], v[212:215], v[156:159], v[192:195]
    v_mfma_f32_16x16x32_bf16 v[196:199], v[212:215], v[172:175], v[196:199]
    s_add_u32 s17, s16, 4096
    buffer_load_dwordx4 v[200:203], v8, s[8:11], s17 offen offset:0
    buffer_load_dwordx4 v[204:207], v8, s[8:11], s17 offen offset:1024
    buffer_load_dwordx4 v[208:211], v8, s[8:11], s17 offen offset:2048
    buffer_load_dwordx4 v[212:215], v8, s[8:11], s17 offen offset:3072
    s_waitcnt vmcnt(3)
    v_mfma_f32_16x16x32_bf16 v[184:187], v[200:203], v[160:163], v[184:187]
    v_mfma_f32_16x16x32_bf16 v[188:191], v[200:203], v[176:179], v[188:191]
    s_waitcnt vmcnt(2)
    v_mfma_f32_16x16x32_bf16 v[192:195], v[204:207], v[160:163], v[192:195]
    v_mfma_f32_16x16x32_bf16 v[196:199], v[204:207], v[176:179], v[196:199]
    s_waitcnt vmcnt(1)
    v_mfma_f32_16x16x32_bf16 v[184:187], v[208:211], v[164:167], v[184:187]
    v_mfma_f32_16x16x32_bf16 v[188:191], v[208:211], v[180:183], v[188:191]
    s_waitcnt vmcnt(0)
    v_mfma_f32_16x16x32_bf16 v[192:195], v[212:215], v[164:167], v[192:195]
    v_mfma_f32_16x16x32_bf16 v[196:199], v[212:215], v[180:183], v[196:199]
    s_nop 3
    v_max3_f32 v16, v16, v184, v185
    v_max3_f32 v16, v16, v186, v187
    v_max3_f32 v17, v17, v188, v189
    v_max3_f32 v17, v17, v190, v191
    v_max3_f32 v16, v16, v192, v193
    v_max3_f32 v16, v16, v194, v195
    v_max3_f32 v17, v17, v196, v197
    v_max3_f32 v17, v17, v198, v199
    s_add_u32 s16, s16, 8192
    s_cmp_lt_u32 s16, 0x20000
    s_cbranch_scc1 adaLN_cond__sliding_block_cached__moe_arch_mod__prompt_kernel_fixBm
    v_mov_b32 v18, v16
    v_mov_b32 v19, v17
    s_nop 0
    v_permlane16_swap_b32 v16, v18
    v_permlane16_swap_b32 v17, v19
    v_max_f32 v16, v16, v18
    v_max_f32 v17, v17, v19
    v_mov_b32 v18, v16
    v_mov_b32 v19, v17
    s_nop 0
    v_permlane32_swap_b32 v16, v18
    v_permlane32_swap_b32 v17, v19
    v_max_f32 v16, v16, v18
    v_max_f32 v17, v17, v19
    v_sub_f32 v216, 0, v16
    v_sub_f32 v217, 0, v16
    v_sub_f32 v218, 0, v16
    v_sub_f32 v219, 0, v16
    v_sub_f32 v220, 0, v17
    v_sub_f32 v221, 0, v17
    v_sub_f32 v222, 0, v17
    v_sub_f32 v223, 0, v17
    s_mov_b32 s17, 0x0
    buffer_load_dwordx4 v[200:203], v8, s[8:11], s17 offen offset:0
    buffer_load_dwordx4 v[204:207], v8, s[8:11], s17 offen offset:1024
    buffer_load_dwordx4 v[208:211], v8, s[8:11], s17 offen offset:2048
    buffer_load_dwordx4 v[212:215], v8, s[8:11], s17 offen offset:3072
    s_waitcnt vmcnt(3)
    v_mfma_f32_16x16x32_bf16 v[184:187], v[200:203], v[152:155], v[216:219]
    v_mfma_f32_16x16x32_bf16 v[188:191], v[200:203], v[168:171], v[220:223]
    s_waitcnt vmcnt(2)
    v_mfma_f32_16x16x32_bf16 v[192:195], v[204:207], v[152:155], v[216:219]
    v_mfma_f32_16x16x32_bf16 v[196:199], v[204:207], v[168:171], v[220:223]
    s_waitcnt vmcnt(1)
    v_mfma_f32_16x16x32_bf16 v[184:187], v[208:211], v[156:159], v[184:187]
    v_mfma_f32_16x16x32_bf16 v[188:191], v[208:211], v[172:175], v[188:191]
    s_waitcnt vmcnt(0)
    v_mfma_f32_16x16x32_bf16 v[192:195], v[212:215], v[156:159], v[192:195]
    v_mfma_f32_16x16x32_bf16 v[196:199], v[212:215], v[172:175], v[196:199]
    s_mov_b32 s17, 0x1000
    buffer_load_dwordx4 v[200:203], v8, s[8:11], s17 offen offset:0
    buffer_load_dwordx4 v[204:207], v8, s[8:11], s17 offen offset:1024
    buffer_load_dwordx4 v[208:211], v8, s[8:11], s17 offen offset:2048
    buffer_load_dwordx4 v[212:215], v8, s[8:11], s17 offen offset:3072
    s_waitcnt vmcnt(3)
    v_mfma_f32_16x16x32_bf16 v[184:187], v[200:203], v[160:163], v[184:187]
    v_mfma_f32_16x16x32_bf16 v[188:191], v[200:203], v[176:179], v[188:191]
    s_waitcnt vmcnt(2)
    v_mfma_f32_16x16x32_bf16 v[192:195], v[204:207], v[160:163], v[192:195]
    v_mfma_f32_16x16x32_bf16 v[196:199], v[204:207], v[176:179], v[196:199]
    s_waitcnt vmcnt(1)
    v_mfma_f32_16x16x32_bf16 v[184:187], v[208:211], v[164:167], v[184:187]
    v_mfma_f32_16x16x32_bf16 v[188:191], v[208:211], v[180:183], v[188:191]
    s_waitcnt vmcnt(0)
    v_mfma_f32_16x16x32_bf16 v[192:195], v[212:215], v[164:167], v[192:195]
    v_mfma_f32_16x16x32_bf16 v[196:199], v[212:215], v[180:183], v[196:199]
    s_nop 3
    v_exp_f32 v184, v184
    v_exp_f32 v185, v185
    s_nop 0
    v_add_f32 v9, v184, v185
    v_cvt_pk_bf16_f32 v24, v184, v185
    v_exp_f32 v186, v186
    v_exp_f32 v187, v187
    v_add_f32 v9, v9, v186
    v_add_f32 v9, v9, v187
    v_cvt_pk_bf16_f32 v25, v186, v187
    v_exp_f32 v188, v188
    v_exp_f32 v189, v189
    s_nop 0
    v_add_f32 v10, v188, v189
    v_cvt_pk_bf16_f32 v28, v188, v189
    v_exp_f32 v190, v190
    v_exp_f32 v191, v191
    v_add_f32 v10, v10, v190
    v_add_f32 v10, v10, v191
    v_cvt_pk_bf16_f32 v29, v190, v191
    v_exp_f32 v192, v192
    v_exp_f32 v193, v193
    v_add_f32 v9, v9, v192
    v_add_f32 v9, v9, v193
    v_cvt_pk_bf16_f32 v26, v192, v193
    v_exp_f32 v194, v194
    v_exp_f32 v195, v195
    v_add_f32 v9, v9, v194
    v_add_f32 v9, v9, v195
    v_cvt_pk_bf16_f32 v27, v194, v195
    v_exp_f32 v196, v196
    v_exp_f32 v197, v197
    v_add_f32 v10, v10, v196
    v_add_f32 v10, v10, v197
    v_cvt_pk_bf16_f32 v30, v196, v197
    v_exp_f32 v198, v198
    v_exp_f32 v199, v199
    v_add_f32 v10, v10, v198
    v_add_f32 v10, v10, v199
    v_cvt_pk_bf16_f32 v31, v198, v199
    s_mov_b32 s17, 0x2000
    buffer_load_dwordx4 v[200:203], v8, s[8:11], s17 offen offset:0
    buffer_load_dwordx4 v[204:207], v8, s[8:11], s17 offen offset:1024
    buffer_load_dwordx4 v[208:211], v8, s[8:11], s17 offen offset:2048
    buffer_load_dwordx4 v[212:215], v8, s[8:11], s17 offen offset:3072
    s_waitcnt vmcnt(3)
    v_mfma_f32_16x16x32_bf16 v[184:187], v[200:203], v[152:155], v[216:219]
    v_mfma_f32_16x16x32_bf16 v[188:191], v[200:203], v[168:171], v[220:223]
    s_waitcnt vmcnt(2)
    v_mfma_f32_16x16x32_bf16 v[192:195], v[204:207], v[152:155], v[216:219]
    v_mfma_f32_16x16x32_bf16 v[196:199], v[204:207], v[168:171], v[220:223]
    s_waitcnt vmcnt(1)
    v_mfma_f32_16x16x32_bf16 v[184:187], v[208:211], v[156:159], v[184:187]
    v_mfma_f32_16x16x32_bf16 v[188:191], v[208:211], v[172:175], v[188:191]
    s_waitcnt vmcnt(0)
    v_mfma_f32_16x16x32_bf16 v[192:195], v[212:215], v[156:159], v[192:195]
    v_mfma_f32_16x16x32_bf16 v[196:199], v[212:215], v[172:175], v[196:199]
    s_mov_b32 s17, 0x3000
    buffer_load_dwordx4 v[200:203], v8, s[8:11], s17 offen offset:0
    buffer_load_dwordx4 v[204:207], v8, s[8:11], s17 offen offset:1024
    buffer_load_dwordx4 v[208:211], v8, s[8:11], s17 offen offset:2048
    buffer_load_dwordx4 v[212:215], v8, s[8:11], s17 offen offset:3072
    s_waitcnt vmcnt(3)
    v_mfma_f32_16x16x32_bf16 v[184:187], v[200:203], v[160:163], v[184:187]
    v_mfma_f32_16x16x32_bf16 v[188:191], v[200:203], v[176:179], v[188:191]
    s_waitcnt vmcnt(2)
    v_mfma_f32_16x16x32_bf16 v[192:195], v[204:207], v[160:163], v[192:195]
    v_mfma_f32_16x16x32_bf16 v[196:199], v[204:207], v[176:179], v[196:199]
    s_waitcnt vmcnt(1)
    v_mfma_f32_16x16x32_bf16 v[184:187], v[208:211], v[164:167], v[184:187]
    v_mfma_f32_16x16x32_bf16 v[188:191], v[208:211], v[180:183], v[188:191]
    s_waitcnt vmcnt(0)
    v_mfma_f32_16x16x32_bf16 v[192:195], v[212:215], v[164:167], v[192:195]
    v_mfma_f32_16x16x32_bf16 v[196:199], v[212:215], v[180:183], v[196:199]
    s_nop 3
    v_exp_f32 v184, v184
    v_exp_f32 v185, v185
    v_add_f32 v9, v9, v184
    v_add_f32 v9, v9, v185
    v_cvt_pk_bf16_f32 v32, v184, v185
    v_exp_f32 v186, v186
    v_exp_f32 v187, v187
    v_add_f32 v9, v9, v186
    v_add_f32 v9, v9, v187
    v_cvt_pk_bf16_f32 v33, v186, v187
    v_exp_f32 v188, v188
    v_exp_f32 v189, v189
    v_add_f32 v10, v10, v188
    v_add_f32 v10, v10, v189
    v_cvt_pk_bf16_f32 v36, v188, v189
    v_exp_f32 v190, v190
    v_exp_f32 v191, v191
    v_add_f32 v10, v10, v190
    v_add_f32 v10, v10, v191
    v_cvt_pk_bf16_f32 v37, v190, v191
    v_exp_f32 v192, v192
    v_exp_f32 v193, v193
    v_add_f32 v9, v9, v192
    v_add_f32 v9, v9, v193
    v_cvt_pk_bf16_f32 v34, v192, v193
    v_exp_f32 v194, v194
    v_exp_f32 v195, v195
    v_add_f32 v9, v9, v194
    v_add_f32 v9, v9, v195
    v_cvt_pk_bf16_f32 v35, v194, v195
    v_exp_f32 v196, v196
    v_exp_f32 v197, v197
    v_add_f32 v10, v10, v196
    v_add_f32 v10, v10, v197
    v_cvt_pk_bf16_f32 v38, v196, v197
    v_exp_f32 v198, v198
    v_exp_f32 v199, v199
    v_add_f32 v10, v10, v198
    v_add_f32 v10, v10, v199
    v_cvt_pk_bf16_f32 v39, v198, v199
    s_mov_b32 s17, 0x4000
    buffer_load_dwordx4 v[200:203], v8, s[8:11], s17 offen offset:0
    buffer_load_dwordx4 v[204:207], v8, s[8:11], s17 offen offset:1024
    buffer_load_dwordx4 v[208:211], v8, s[8:11], s17 offen offset:2048
    buffer_load_dwordx4 v[212:215], v8, s[8:11], s17 offen offset:3072
    s_waitcnt vmcnt(3)
    v_mfma_f32_16x16x32_bf16 v[184:187], v[200:203], v[152:155], v[216:219]
    v_mfma_f32_16x16x32_bf16 v[188:191], v[200:203], v[168:171], v[220:223]
    s_waitcnt vmcnt(2)
    v_mfma_f32_16x16x32_bf16 v[192:195], v[204:207], v[152:155], v[216:219]
    v_mfma_f32_16x16x32_bf16 v[196:199], v[204:207], v[168:171], v[220:223]
    s_waitcnt vmcnt(1)
    v_mfma_f32_16x16x32_bf16 v[184:187], v[208:211], v[156:159], v[184:187]
    v_mfma_f32_16x16x32_bf16 v[188:191], v[208:211], v[172:175], v[188:191]
    s_waitcnt vmcnt(0)
    v_mfma_f32_16x16x32_bf16 v[192:195], v[212:215], v[156:159], v[192:195]
    v_mfma_f32_16x16x32_bf16 v[196:199], v[212:215], v[172:175], v[196:199]
    s_mov_b32 s17, 0x5000
    buffer_load_dwordx4 v[200:203], v8, s[8:11], s17 offen offset:0
    buffer_load_dwordx4 v[204:207], v8, s[8:11], s17 offen offset:1024
    buffer_load_dwordx4 v[208:211], v8, s[8:11], s17 offen offset:2048
    buffer_load_dwordx4 v[212:215], v8, s[8:11], s17 offen offset:3072
    s_waitcnt vmcnt(3)
    v_mfma_f32_16x16x32_bf16 v[184:187], v[200:203], v[160:163], v[184:187]
    v_mfma_f32_16x16x32_bf16 v[188:191], v[200:203], v[176:179], v[188:191]
    s_waitcnt vmcnt(2)
    v_mfma_f32_16x16x32_bf16 v[192:195], v[204:207], v[160:163], v[192:195]
    v_mfma_f32_16x16x32_bf16 v[196:199], v[204:207], v[176:179], v[196:199]
    s_waitcnt vmcnt(1)
    v_mfma_f32_16x16x32_bf16 v[184:187], v[208:211], v[164:167], v[184:187]
    v_mfma_f32_16x16x32_bf16 v[188:191], v[208:211], v[180:183], v[188:191]
    s_waitcnt vmcnt(0)
    v_mfma_f32_16x16x32_bf16 v[192:195], v[212:215], v[164:167], v[192:195]
    v_mfma_f32_16x16x32_bf16 v[196:199], v[212:215], v[180:183], v[196:199]
    s_nop 3
    v_exp_f32 v184, v184
    v_exp_f32 v185, v185
    v_add_f32 v9, v9, v184
    v_add_f32 v9, v9, v185
    v_cvt_pk_bf16_f32 v40, v184, v185
    v_exp_f32 v186, v186
    v_exp_f32 v187, v187
    v_add_f32 v9, v9, v186
    v_add_f32 v9, v9, v187
    v_cvt_pk_bf16_f32 v41, v186, v187
    v_exp_f32 v188, v188
    v_exp_f32 v189, v189
    v_add_f32 v10, v10, v188
    v_add_f32 v10, v10, v189
    v_cvt_pk_bf16_f32 v44, v188, v189
    v_exp_f32 v190, v190
    v_exp_f32 v191, v191
    v_add_f32 v10, v10, v190
    v_add_f32 v10, v10, v191
    v_cvt_pk_bf16_f32 v45, v190, v191
    v_exp_f32 v192, v192
    v_exp_f32 v193, v193
    v_add_f32 v9, v9, v192
    v_add_f32 v9, v9, v193
    v_cvt_pk_bf16_f32 v42, v192, v193
    v_exp_f32 v194, v194
    v_exp_f32 v195, v195
    v_add_f32 v9, v9, v194
    v_add_f32 v9, v9, v195
    v_cvt_pk_bf16_f32 v43, v194, v195
    v_exp_f32 v196, v196
    v_exp_f32 v197, v197
    v_add_f32 v10, v10, v196
    v_add_f32 v10, v10, v197
    v_cvt_pk_bf16_f32 v46, v196, v197
    v_exp_f32 v198, v198
    v_exp_f32 v199, v199
    v_add_f32 v10, v10, v198
    v_add_f32 v10, v10, v199
    v_cvt_pk_bf16_f32 v47, v198, v199
    s_mov_b32 s17, 0x6000
    buffer_load_dwordx4 v[200:203], v8, s[8:11], s17 offen offset:0
    buffer_load_dwordx4 v[204:207], v8, s[8:11], s17 offen offset:1024
    buffer_load_dwordx4 v[208:211], v8, s[8:11], s17 offen offset:2048
    buffer_load_dwordx4 v[212:215], v8, s[8:11], s17 offen offset:3072
    s_waitcnt vmcnt(3)
    v_mfma_f32_16x16x32_bf16 v[184:187], v[200:203], v[152:155], v[216:219]
    v_mfma_f32_16x16x32_bf16 v[188:191], v[200:203], v[168:171], v[220:223]
    s_waitcnt vmcnt(2)
    v_mfma_f32_16x16x32_bf16 v[192:195], v[204:207], v[152:155], v[216:219]
    v_mfma_f32_16x16x32_bf16 v[196:199], v[204:207], v[168:171], v[220:223]
    s_waitcnt vmcnt(1)
    v_mfma_f32_16x16x32_bf16 v[184:187], v[208:211], v[156:159], v[184:187]
    v_mfma_f32_16x16x32_bf16 v[188:191], v[208:211], v[172:175], v[188:191]
    s_waitcnt vmcnt(0)
    v_mfma_f32_16x16x32_bf16 v[192:195], v[212:215], v[156:159], v[192:195]
    v_mfma_f32_16x16x32_bf16 v[196:199], v[212:215], v[172:175], v[196:199]
    s_mov_b32 s17, 0x7000
    buffer_load_dwordx4 v[200:203], v8, s[8:11], s17 offen offset:0
    buffer_load_dwordx4 v[204:207], v8, s[8:11], s17 offen offset:1024
    buffer_load_dwordx4 v[208:211], v8, s[8:11], s17 offen offset:2048
    buffer_load_dwordx4 v[212:215], v8, s[8:11], s17 offen offset:3072
    s_waitcnt vmcnt(3)
    v_mfma_f32_16x16x32_bf16 v[184:187], v[200:203], v[160:163], v[184:187]
    v_mfma_f32_16x16x32_bf16 v[188:191], v[200:203], v[176:179], v[188:191]
    s_waitcnt vmcnt(2)
    v_mfma_f32_16x16x32_bf16 v[192:195], v[204:207], v[160:163], v[192:195]
    v_mfma_f32_16x16x32_bf16 v[196:199], v[204:207], v[176:179], v[196:199]
    s_waitcnt vmcnt(1)
    v_mfma_f32_16x16x32_bf16 v[184:187], v[208:211], v[164:167], v[184:187]
    v_mfma_f32_16x16x32_bf16 v[188:191], v[208:211], v[180:183], v[188:191]
    s_waitcnt vmcnt(0)
    v_mfma_f32_16x16x32_bf16 v[192:195], v[212:215], v[164:167], v[192:195]
    v_mfma_f32_16x16x32_bf16 v[196:199], v[212:215], v[180:183], v[196:199]
    s_nop 3
    v_exp_f32 v184, v184
    v_exp_f32 v185, v185
    v_add_f32 v9, v9, v184
    v_add_f32 v9, v9, v185
    v_cvt_pk_bf16_f32 v48, v184, v185
    v_exp_f32 v186, v186
    v_exp_f32 v187, v187
    v_add_f32 v9, v9, v186
    v_add_f32 v9, v9, v187
    v_cvt_pk_bf16_f32 v49, v186, v187
    v_exp_f32 v188, v188
    v_exp_f32 v189, v189
    v_add_f32 v10, v10, v188
    v_add_f32 v10, v10, v189
    v_cvt_pk_bf16_f32 v52, v188, v189
    v_exp_f32 v190, v190
    v_exp_f32 v191, v191
    v_add_f32 v10, v10, v190
    v_add_f32 v10, v10, v191
    v_cvt_pk_bf16_f32 v53, v190, v191
    v_exp_f32 v192, v192
    v_exp_f32 v193, v193
    v_add_f32 v9, v9, v192
    v_add_f32 v9, v9, v193
    v_cvt_pk_bf16_f32 v50, v192, v193
    v_exp_f32 v194, v194
    v_exp_f32 v195, v195
    v_add_f32 v9, v9, v194
    v_add_f32 v9, v9, v195
    v_cvt_pk_bf16_f32 v51, v194, v195
    v_exp_f32 v196, v196
    v_exp_f32 v197, v197
    v_add_f32 v10, v10, v196
    v_add_f32 v10, v10, v197
    v_cvt_pk_bf16_f32 v54, v196, v197
    v_exp_f32 v198, v198
    v_exp_f32 v199, v199
    v_add_f32 v10, v10, v198
    v_add_f32 v10, v10, v199
    v_cvt_pk_bf16_f32 v55, v198, v199
    s_mov_b32 s17, 0x8000
    buffer_load_dwordx4 v[200:203], v8, s[8:11], s17 offen offset:0
    buffer_load_dwordx4 v[204:207], v8, s[8:11], s17 offen offset:1024
    buffer_load_dwordx4 v[208:211], v8, s[8:11], s17 offen offset:2048
    buffer_load_dwordx4 v[212:215], v8, s[8:11], s17 offen offset:3072
    s_waitcnt vmcnt(3)
    v_mfma_f32_16x16x32_bf16 v[184:187], v[200:203], v[152:155], v[216:219]
    v_mfma_f32_16x16x32_bf16 v[188:191], v[200:203], v[168:171], v[220:223]
    s_waitcnt vmcnt(2)
    v_mfma_f32_16x16x32_bf16 v[192:195], v[204:207], v[152:155], v[216:219]
    v_mfma_f32_16x16x32_bf16 v[196:199], v[204:207], v[168:171], v[220:223]
    s_waitcnt vmcnt(1)
    v_mfma_f32_16x16x32_bf16 v[184:187], v[208:211], v[156:159], v[184:187]
    v_mfma_f32_16x16x32_bf16 v[188:191], v[208:211], v[172:175], v[188:191]
    s_waitcnt vmcnt(0)
    v_mfma_f32_16x16x32_bf16 v[192:195], v[212:215], v[156:159], v[192:195]
    v_mfma_f32_16x16x32_bf16 v[196:199], v[212:215], v[172:175], v[196:199]
    s_mov_b32 s17, 0x9000
    buffer_load_dwordx4 v[200:203], v8, s[8:11], s17 offen offset:0
    buffer_load_dwordx4 v[204:207], v8, s[8:11], s17 offen offset:1024
    buffer_load_dwordx4 v[208:211], v8, s[8:11], s17 offen offset:2048
    buffer_load_dwordx4 v[212:215], v8, s[8:11], s17 offen offset:3072
    s_waitcnt vmcnt(3)
    v_mfma_f32_16x16x32_bf16 v[184:187], v[200:203], v[160:163], v[184:187]
    v_mfma_f32_16x16x32_bf16 v[188:191], v[200:203], v[176:179], v[188:191]
    s_waitcnt vmcnt(2)
    v_mfma_f32_16x16x32_bf16 v[192:195], v[204:207], v[160:163], v[192:195]
    v_mfma_f32_16x16x32_bf16 v[196:199], v[204:207], v[176:179], v[196:199]
    s_waitcnt vmcnt(1)
    v_mfma_f32_16x16x32_bf16 v[184:187], v[208:211], v[164:167], v[184:187]
    v_mfma_f32_16x16x32_bf16 v[188:191], v[208:211], v[180:183], v[188:191]
    s_waitcnt vmcnt(0)
    v_mfma_f32_16x16x32_bf16 v[192:195], v[212:215], v[164:167], v[192:195]
    v_mfma_f32_16x16x32_bf16 v[196:199], v[212:215], v[180:183], v[196:199]
    s_nop 3
    v_exp_f32 v184, v184
    v_exp_f32 v185, v185
    v_add_f32 v9, v9, v184
    v_add_f32 v9, v9, v185
    v_cvt_pk_bf16_f32 v56, v184, v185
    v_exp_f32 v186, v186
    v_exp_f32 v187, v187
    v_add_f32 v9, v9, v186
    v_add_f32 v9, v9, v187
    v_cvt_pk_bf16_f32 v57, v186, v187
    v_exp_f32 v188, v188
    v_exp_f32 v189, v189
    v_add_f32 v10, v10, v188
    v_add_f32 v10, v10, v189
    v_cvt_pk_bf16_f32 v60, v188, v189
    v_exp_f32 v190, v190
    v_exp_f32 v191, v191
    v_add_f32 v10, v10, v190
    v_add_f32 v10, v10, v191
    v_cvt_pk_bf16_f32 v61, v190, v191
    v_exp_f32 v192, v192
    v_exp_f32 v193, v193
    v_add_f32 v9, v9, v192
    v_add_f32 v9, v9, v193
    v_cvt_pk_bf16_f32 v58, v192, v193
    v_exp_f32 v194, v194
    v_exp_f32 v195, v195
    v_add_f32 v9, v9, v194
    v_add_f32 v9, v9, v195
    v_cvt_pk_bf16_f32 v59, v194, v195
    v_exp_f32 v196, v196
    v_exp_f32 v197, v197
    v_add_f32 v10, v10, v196
    v_add_f32 v10, v10, v197
    v_cvt_pk_bf16_f32 v62, v196, v197
    v_exp_f32 v198, v198
    v_exp_f32 v199, v199
    v_add_f32 v10, v10, v198
    v_add_f32 v10, v10, v199
    v_cvt_pk_bf16_f32 v63, v198, v199
    s_mov_b32 s17, 0xa000
    buffer_load_dwordx4 v[200:203], v8, s[8:11], s17 offen offset:0
    buffer_load_dwordx4 v[204:207], v8, s[8:11], s17 offen offset:1024
    buffer_load_dwordx4 v[208:211], v8, s[8:11], s17 offen offset:2048
    buffer_load_dwordx4 v[212:215], v8, s[8:11], s17 offen offset:3072
    s_waitcnt vmcnt(3)
    v_mfma_f32_16x16x32_bf16 v[184:187], v[200:203], v[152:155], v[216:219]
    v_mfma_f32_16x16x32_bf16 v[188:191], v[200:203], v[168:171], v[220:223]
    s_waitcnt vmcnt(2)
    v_mfma_f32_16x16x32_bf16 v[192:195], v[204:207], v[152:155], v[216:219]
    v_mfma_f32_16x16x32_bf16 v[196:199], v[204:207], v[168:171], v[220:223]
    s_waitcnt vmcnt(1)
    v_mfma_f32_16x16x32_bf16 v[184:187], v[208:211], v[156:159], v[184:187]
    v_mfma_f32_16x16x32_bf16 v[188:191], v[208:211], v[172:175], v[188:191]
    s_waitcnt vmcnt(0)
    v_mfma_f32_16x16x32_bf16 v[192:195], v[212:215], v[156:159], v[192:195]
    v_mfma_f32_16x16x32_bf16 v[196:199], v[212:215], v[172:175], v[196:199]
    s_mov_b32 s17, 0xb000
    buffer_load_dwordx4 v[200:203], v8, s[8:11], s17 offen offset:0
    buffer_load_dwordx4 v[204:207], v8, s[8:11], s17 offen offset:1024
    buffer_load_dwordx4 v[208:211], v8, s[8:11], s17 offen offset:2048
    buffer_load_dwordx4 v[212:215], v8, s[8:11], s17 offen offset:3072
    s_waitcnt vmcnt(3)
    v_mfma_f32_16x16x32_bf16 v[184:187], v[200:203], v[160:163], v[184:187]
    v_mfma_f32_16x16x32_bf16 v[188:191], v[200:203], v[176:179], v[188:191]
    s_waitcnt vmcnt(2)
    v_mfma_f32_16x16x32_bf16 v[192:195], v[204:207], v[160:163], v[192:195]
    v_mfma_f32_16x16x32_bf16 v[196:199], v[204:207], v[176:179], v[196:199]
    s_waitcnt vmcnt(1)
    v_mfma_f32_16x16x32_bf16 v[184:187], v[208:211], v[164:167], v[184:187]
    v_mfma_f32_16x16x32_bf16 v[188:191], v[208:211], v[180:183], v[188:191]
    s_waitcnt vmcnt(0)
    v_mfma_f32_16x16x32_bf16 v[192:195], v[212:215], v[164:167], v[192:195]
    v_mfma_f32_16x16x32_bf16 v[196:199], v[212:215], v[180:183], v[196:199]
    s_nop 3
    v_exp_f32 v184, v184
    v_exp_f32 v185, v185
    v_add_f32 v9, v9, v184
    v_add_f32 v9, v9, v185
    v_cvt_pk_bf16_f32 v64, v184, v185
    v_exp_f32 v186, v186
    v_exp_f32 v187, v187
    v_add_f32 v9, v9, v186
    v_add_f32 v9, v9, v187
    v_cvt_pk_bf16_f32 v65, v186, v187
    v_exp_f32 v188, v188
    v_exp_f32 v189, v189
    v_add_f32 v10, v10, v188
    v_add_f32 v10, v10, v189
    v_cvt_pk_bf16_f32 v68, v188, v189
    v_exp_f32 v190, v190
    v_exp_f32 v191, v191
    v_add_f32 v10, v10, v190
    v_add_f32 v10, v10, v191
    v_cvt_pk_bf16_f32 v69, v190, v191
    v_exp_f32 v192, v192
    v_exp_f32 v193, v193
    v_add_f32 v9, v9, v192
    v_add_f32 v9, v9, v193
    v_cvt_pk_bf16_f32 v66, v192, v193
    v_exp_f32 v194, v194
    v_exp_f32 v195, v195
    v_add_f32 v9, v9, v194
    v_add_f32 v9, v9, v195
    v_cvt_pk_bf16_f32 v67, v194, v195
    v_exp_f32 v196, v196
    v_exp_f32 v197, v197
    v_add_f32 v10, v10, v196
    v_add_f32 v10, v10, v197
    v_cvt_pk_bf16_f32 v70, v196, v197
    v_exp_f32 v198, v198
    v_exp_f32 v199, v199
    v_add_f32 v10, v10, v198
    v_add_f32 v10, v10, v199
    v_cvt_pk_bf16_f32 v71, v198, v199
    s_mov_b32 s17, 0xc000
    buffer_load_dwordx4 v[200:203], v8, s[8:11], s17 offen offset:0
    buffer_load_dwordx4 v[204:207], v8, s[8:11], s17 offen offset:1024
    buffer_load_dwordx4 v[208:211], v8, s[8:11], s17 offen offset:2048
    buffer_load_dwordx4 v[212:215], v8, s[8:11], s17 offen offset:3072
    s_waitcnt vmcnt(3)
    v_mfma_f32_16x16x32_bf16 v[184:187], v[200:203], v[152:155], v[216:219]
    v_mfma_f32_16x16x32_bf16 v[188:191], v[200:203], v[168:171], v[220:223]
    s_waitcnt vmcnt(2)
    v_mfma_f32_16x16x32_bf16 v[192:195], v[204:207], v[152:155], v[216:219]
    v_mfma_f32_16x16x32_bf16 v[196:199], v[204:207], v[168:171], v[220:223]
    s_waitcnt vmcnt(1)
    v_mfma_f32_16x16x32_bf16 v[184:187], v[208:211], v[156:159], v[184:187]
    v_mfma_f32_16x16x32_bf16 v[188:191], v[208:211], v[172:175], v[188:191]
    s_waitcnt vmcnt(0)
    v_mfma_f32_16x16x32_bf16 v[192:195], v[212:215], v[156:159], v[192:195]
    v_mfma_f32_16x16x32_bf16 v[196:199], v[212:215], v[172:175], v[196:199]
    s_mov_b32 s17, 0xd000
    buffer_load_dwordx4 v[200:203], v8, s[8:11], s17 offen offset:0
    buffer_load_dwordx4 v[204:207], v8, s[8:11], s17 offen offset:1024
    buffer_load_dwordx4 v[208:211], v8, s[8:11], s17 offen offset:2048
    buffer_load_dwordx4 v[212:215], v8, s[8:11], s17 offen offset:3072
    s_waitcnt vmcnt(3)
    v_mfma_f32_16x16x32_bf16 v[184:187], v[200:203], v[160:163], v[184:187]
    v_mfma_f32_16x16x32_bf16 v[188:191], v[200:203], v[176:179], v[188:191]
    s_waitcnt vmcnt(2)
    v_mfma_f32_16x16x32_bf16 v[192:195], v[204:207], v[160:163], v[192:195]
    v_mfma_f32_16x16x32_bf16 v[196:199], v[204:207], v[176:179], v[196:199]
    s_waitcnt vmcnt(1)
    v_mfma_f32_16x16x32_bf16 v[184:187], v[208:211], v[164:167], v[184:187]
    v_mfma_f32_16x16x32_bf16 v[188:191], v[208:211], v[180:183], v[188:191]
    s_waitcnt vmcnt(0)
    v_mfma_f32_16x16x32_bf16 v[192:195], v[212:215], v[164:167], v[192:195]
    v_mfma_f32_16x16x32_bf16 v[196:199], v[212:215], v[180:183], v[196:199]
    s_nop 3
    v_exp_f32 v184, v184
    v_exp_f32 v185, v185
    v_add_f32 v9, v9, v184
    v_add_f32 v9, v9, v185
    v_cvt_pk_bf16_f32 v72, v184, v185
    v_exp_f32 v186, v186
    v_exp_f32 v187, v187
    v_add_f32 v9, v9, v186
    v_add_f32 v9, v9, v187
    v_cvt_pk_bf16_f32 v73, v186, v187
    v_exp_f32 v188, v188
    v_exp_f32 v189, v189
    v_add_f32 v10, v10, v188
    v_add_f32 v10, v10, v189
    v_cvt_pk_bf16_f32 v76, v188, v189
    v_exp_f32 v190, v190
    v_exp_f32 v191, v191
    v_add_f32 v10, v10, v190
    v_add_f32 v10, v10, v191
    v_cvt_pk_bf16_f32 v77, v190, v191
    v_exp_f32 v192, v192
    v_exp_f32 v193, v193
    v_add_f32 v9, v9, v192
    v_add_f32 v9, v9, v193
    v_cvt_pk_bf16_f32 v74, v192, v193
    v_exp_f32 v194, v194
    v_exp_f32 v195, v195
    v_add_f32 v9, v9, v194
    v_add_f32 v9, v9, v195
    v_cvt_pk_bf16_f32 v75, v194, v195
    v_exp_f32 v196, v196
    v_exp_f32 v197, v197
    v_add_f32 v10, v10, v196
    v_add_f32 v10, v10, v197
    v_cvt_pk_bf16_f32 v78, v196, v197
    v_exp_f32 v198, v198
    v_exp_f32 v199, v199
    v_add_f32 v10, v10, v198
    v_add_f32 v10, v10, v199
    v_cvt_pk_bf16_f32 v79, v198, v199
    s_mov_b32 s17, 0xe000
    buffer_load_dwordx4 v[200:203], v8, s[8:11], s17 offen offset:0
    buffer_load_dwordx4 v[204:207], v8, s[8:11], s17 offen offset:1024
    buffer_load_dwordx4 v[208:211], v8, s[8:11], s17 offen offset:2048
    buffer_load_dwordx4 v[212:215], v8, s[8:11], s17 offen offset:3072
    s_waitcnt vmcnt(3)
    v_mfma_f32_16x16x32_bf16 v[184:187], v[200:203], v[152:155], v[216:219]
    v_mfma_f32_16x16x32_bf16 v[188:191], v[200:203], v[168:171], v[220:223]
    s_waitcnt vmcnt(2)
    v_mfma_f32_16x16x32_bf16 v[192:195], v[204:207], v[152:155], v[216:219]
    v_mfma_f32_16x16x32_bf16 v[196:199], v[204:207], v[168:171], v[220:223]
    s_waitcnt vmcnt(1)
    v_mfma_f32_16x16x32_bf16 v[184:187], v[208:211], v[156:159], v[184:187]
    v_mfma_f32_16x16x32_bf16 v[188:191], v[208:211], v[172:175], v[188:191]
    s_waitcnt vmcnt(0)
    v_mfma_f32_16x16x32_bf16 v[192:195], v[212:215], v[156:159], v[192:195]
    v_mfma_f32_16x16x32_bf16 v[196:199], v[212:215], v[172:175], v[196:199]
    s_mov_b32 s17, 0xf000
    buffer_load_dwordx4 v[200:203], v8, s[8:11], s17 offen offset:0
    buffer_load_dwordx4 v[204:207], v8, s[8:11], s17 offen offset:1024
    buffer_load_dwordx4 v[208:211], v8, s[8:11], s17 offen offset:2048
    buffer_load_dwordx4 v[212:215], v8, s[8:11], s17 offen offset:3072
    s_waitcnt vmcnt(3)
    v_mfma_f32_16x16x32_bf16 v[184:187], v[200:203], v[160:163], v[184:187]
    v_mfma_f32_16x16x32_bf16 v[188:191], v[200:203], v[176:179], v[188:191]
    s_waitcnt vmcnt(2)
    v_mfma_f32_16x16x32_bf16 v[192:195], v[204:207], v[160:163], v[192:195]
    v_mfma_f32_16x16x32_bf16 v[196:199], v[204:207], v[176:179], v[196:199]
    s_waitcnt vmcnt(1)
    v_mfma_f32_16x16x32_bf16 v[184:187], v[208:211], v[164:167], v[184:187]
    v_mfma_f32_16x16x32_bf16 v[188:191], v[208:211], v[180:183], v[188:191]
    s_waitcnt vmcnt(0)
    v_mfma_f32_16x16x32_bf16 v[192:195], v[212:215], v[164:167], v[192:195]
    v_mfma_f32_16x16x32_bf16 v[196:199], v[212:215], v[180:183], v[196:199]
    s_nop 3
    v_exp_f32 v184, v184
    v_exp_f32 v185, v185
    v_add_f32 v9, v9, v184
    v_add_f32 v9, v9, v185
    v_cvt_pk_bf16_f32 v80, v184, v185
    v_exp_f32 v186, v186
    v_exp_f32 v187, v187
    v_add_f32 v9, v9, v186
    v_add_f32 v9, v9, v187
    v_cvt_pk_bf16_f32 v81, v186, v187
    v_exp_f32 v188, v188
    v_exp_f32 v189, v189
    v_add_f32 v10, v10, v188
    v_add_f32 v10, v10, v189
    v_cvt_pk_bf16_f32 v84, v188, v189
    v_exp_f32 v190, v190
    v_exp_f32 v191, v191
    v_add_f32 v10, v10, v190
    v_add_f32 v10, v10, v191
    v_cvt_pk_bf16_f32 v85, v190, v191
    v_exp_f32 v192, v192
    v_exp_f32 v193, v193
    v_add_f32 v9, v9, v192
    v_add_f32 v9, v9, v193
    v_cvt_pk_bf16_f32 v82, v192, v193
    v_exp_f32 v194, v194
    v_exp_f32 v195, v195
    v_add_f32 v9, v9, v194
    v_add_f32 v9, v9, v195
    v_cvt_pk_bf16_f32 v83, v194, v195
    v_exp_f32 v196, v196
    v_exp_f32 v197, v197
    v_add_f32 v10, v10, v196
    v_add_f32 v10, v10, v197
    v_cvt_pk_bf16_f32 v86, v196, v197
    v_exp_f32 v198, v198
    v_exp_f32 v199, v199
    v_add_f32 v10, v10, v198
    v_add_f32 v10, v10, v199
    v_cvt_pk_bf16_f32 v87, v198, v199
    s_mov_b32 s17, 0x10000
    buffer_load_dwordx4 v[200:203], v8, s[8:11], s17 offen offset:0
    buffer_load_dwordx4 v[204:207], v8, s[8:11], s17 offen offset:1024
    buffer_load_dwordx4 v[208:211], v8, s[8:11], s17 offen offset:2048
    buffer_load_dwordx4 v[212:215], v8, s[8:11], s17 offen offset:3072
    s_waitcnt vmcnt(3)
    v_mfma_f32_16x16x32_bf16 v[184:187], v[200:203], v[152:155], v[216:219]
    v_mfma_f32_16x16x32_bf16 v[188:191], v[200:203], v[168:171], v[220:223]
    s_waitcnt vmcnt(2)
    v_mfma_f32_16x16x32_bf16 v[192:195], v[204:207], v[152:155], v[216:219]
    v_mfma_f32_16x16x32_bf16 v[196:199], v[204:207], v[168:171], v[220:223]
    s_waitcnt vmcnt(1)
    v_mfma_f32_16x16x32_bf16 v[184:187], v[208:211], v[156:159], v[184:187]
    v_mfma_f32_16x16x32_bf16 v[188:191], v[208:211], v[172:175], v[188:191]
    s_waitcnt vmcnt(0)
    v_mfma_f32_16x16x32_bf16 v[192:195], v[212:215], v[156:159], v[192:195]
    v_mfma_f32_16x16x32_bf16 v[196:199], v[212:215], v[172:175], v[196:199]
    s_mov_b32 s17, 0x11000
    buffer_load_dwordx4 v[200:203], v8, s[8:11], s17 offen offset:0
    buffer_load_dwordx4 v[204:207], v8, s[8:11], s17 offen offset:1024
    buffer_load_dwordx4 v[208:211], v8, s[8:11], s17 offen offset:2048
    buffer_load_dwordx4 v[212:215], v8, s[8:11], s17 offen offset:3072
    s_waitcnt vmcnt(3)
    v_mfma_f32_16x16x32_bf16 v[184:187], v[200:203], v[160:163], v[184:187]
    v_mfma_f32_16x16x32_bf16 v[188:191], v[200:203], v[176:179], v[188:191]
    s_waitcnt vmcnt(2)
    v_mfma_f32_16x16x32_bf16 v[192:195], v[204:207], v[160:163], v[192:195]
    v_mfma_f32_16x16x32_bf16 v[196:199], v[204:207], v[176:179], v[196:199]
    s_waitcnt vmcnt(1)
    v_mfma_f32_16x16x32_bf16 v[184:187], v[208:211], v[164:167], v[184:187]
    v_mfma_f32_16x16x32_bf16 v[188:191], v[208:211], v[180:183], v[188:191]
    s_waitcnt vmcnt(0)
    v_mfma_f32_16x16x32_bf16 v[192:195], v[212:215], v[164:167], v[192:195]
    v_mfma_f32_16x16x32_bf16 v[196:199], v[212:215], v[180:183], v[196:199]
    s_nop 3
    v_exp_f32 v184, v184
    v_exp_f32 v185, v185
    v_add_f32 v9, v9, v184
    v_add_f32 v9, v9, v185
    v_cvt_pk_bf16_f32 v88, v184, v185
    v_exp_f32 v186, v186
    v_exp_f32 v187, v187
    v_add_f32 v9, v9, v186
    v_add_f32 v9, v9, v187
    v_cvt_pk_bf16_f32 v89, v186, v187
    v_exp_f32 v188, v188
    v_exp_f32 v189, v189
    v_add_f32 v10, v10, v188
    v_add_f32 v10, v10, v189
    v_cvt_pk_bf16_f32 v92, v188, v189
    v_exp_f32 v190, v190
    v_exp_f32 v191, v191
    v_add_f32 v10, v10, v190
    v_add_f32 v10, v10, v191
    v_cvt_pk_bf16_f32 v93, v190, v191
    v_exp_f32 v192, v192
    v_exp_f32 v193, v193
    v_add_f32 v9, v9, v192
    v_add_f32 v9, v9, v193
    v_cvt_pk_bf16_f32 v90, v192, v193
    v_exp_f32 v194, v194
    v_exp_f32 v195, v195
    v_add_f32 v9, v9, v194
    v_add_f32 v9, v9, v195
    v_cvt_pk_bf16_f32 v91, v194, v195
    v_exp_f32 v196, v196
    v_exp_f32 v197, v197
    v_add_f32 v10, v10, v196
    v_add_f32 v10, v10, v197
    v_cvt_pk_bf16_f32 v94, v196, v197
    v_exp_f32 v198, v198
    v_exp_f32 v199, v199
    v_add_f32 v10, v10, v198
    v_add_f32 v10, v10, v199
    v_cvt_pk_bf16_f32 v95, v198, v199
    s_mov_b32 s17, 0x12000
    buffer_load_dwordx4 v[200:203], v8, s[8:11], s17 offen offset:0
    buffer_load_dwordx4 v[204:207], v8, s[8:11], s17 offen offset:1024
    buffer_load_dwordx4 v[208:211], v8, s[8:11], s17 offen offset:2048
    buffer_load_dwordx4 v[212:215], v8, s[8:11], s17 offen offset:3072
    s_waitcnt vmcnt(3)
    v_mfma_f32_16x16x32_bf16 v[184:187], v[200:203], v[152:155], v[216:219]
    v_mfma_f32_16x16x32_bf16 v[188:191], v[200:203], v[168:171], v[220:223]
    s_waitcnt vmcnt(2)
    v_mfma_f32_16x16x32_bf16 v[192:195], v[204:207], v[152:155], v[216:219]
    v_mfma_f32_16x16x32_bf16 v[196:199], v[204:207], v[168:171], v[220:223]
    s_waitcnt vmcnt(1)
    v_mfma_f32_16x16x32_bf16 v[184:187], v[208:211], v[156:159], v[184:187]
    v_mfma_f32_16x16x32_bf16 v[188:191], v[208:211], v[172:175], v[188:191]
    s_waitcnt vmcnt(0)
    v_mfma_f32_16x16x32_bf16 v[192:195], v[212:215], v[156:159], v[192:195]
    v_mfma_f32_16x16x32_bf16 v[196:199], v[212:215], v[172:175], v[196:199]
    s_mov_b32 s17, 0x13000
    buffer_load_dwordx4 v[200:203], v8, s[8:11], s17 offen offset:0
    buffer_load_dwordx4 v[204:207], v8, s[8:11], s17 offen offset:1024
    buffer_load_dwordx4 v[208:211], v8, s[8:11], s17 offen offset:2048
    buffer_load_dwordx4 v[212:215], v8, s[8:11], s17 offen offset:3072
    s_waitcnt vmcnt(3)
    v_mfma_f32_16x16x32_bf16 v[184:187], v[200:203], v[160:163], v[184:187]
    v_mfma_f32_16x16x32_bf16 v[188:191], v[200:203], v[176:179], v[188:191]
    s_waitcnt vmcnt(2)
    v_mfma_f32_16x16x32_bf16 v[192:195], v[204:207], v[160:163], v[192:195]
    v_mfma_f32_16x16x32_bf16 v[196:199], v[204:207], v[176:179], v[196:199]
    s_waitcnt vmcnt(1)
    v_mfma_f32_16x16x32_bf16 v[184:187], v[208:211], v[164:167], v[184:187]
    v_mfma_f32_16x16x32_bf16 v[188:191], v[208:211], v[180:183], v[188:191]
    s_waitcnt vmcnt(0)
    v_mfma_f32_16x16x32_bf16 v[192:195], v[212:215], v[164:167], v[192:195]
    v_mfma_f32_16x16x32_bf16 v[196:199], v[212:215], v[180:183], v[196:199]
    s_nop 3
    v_exp_f32 v184, v184
    v_exp_f32 v185, v185
    v_add_f32 v9, v9, v184
    v_add_f32 v9, v9, v185
    v_cvt_pk_bf16_f32 v96, v184, v185
    v_exp_f32 v186, v186
    v_exp_f32 v187, v187
    v_add_f32 v9, v9, v186
    v_add_f32 v9, v9, v187
    v_cvt_pk_bf16_f32 v97, v186, v187
    v_exp_f32 v188, v188
    v_exp_f32 v189, v189
    v_add_f32 v10, v10, v188
    v_add_f32 v10, v10, v189
    v_cvt_pk_bf16_f32 v100, v188, v189
    v_exp_f32 v190, v190
    v_exp_f32 v191, v191
    v_add_f32 v10, v10, v190
    v_add_f32 v10, v10, v191
    v_cvt_pk_bf16_f32 v101, v190, v191
    v_exp_f32 v192, v192
    v_exp_f32 v193, v193
    v_add_f32 v9, v9, v192
    v_add_f32 v9, v9, v193
    v_cvt_pk_bf16_f32 v98, v192, v193
    v_exp_f32 v194, v194
    v_exp_f32 v195, v195
    v_add_f32 v9, v9, v194
    v_add_f32 v9, v9, v195
    v_cvt_pk_bf16_f32 v99, v194, v195
    v_exp_f32 v196, v196
    v_exp_f32 v197, v197
    v_add_f32 v10, v10, v196
    v_add_f32 v10, v10, v197
    v_cvt_pk_bf16_f32 v102, v196, v197
    v_exp_f32 v198, v198
    v_exp_f32 v199, v199
    v_add_f32 v10, v10, v198
    v_add_f32 v10, v10, v199
    v_cvt_pk_bf16_f32 v103, v198, v199
    s_mov_b32 s17, 0x14000
    buffer_load_dwordx4 v[200:203], v8, s[8:11], s17 offen offset:0
    buffer_load_dwordx4 v[204:207], v8, s[8:11], s17 offen offset:1024
    buffer_load_dwordx4 v[208:211], v8, s[8:11], s17 offen offset:2048
    buffer_load_dwordx4 v[212:215], v8, s[8:11], s17 offen offset:3072
    s_waitcnt vmcnt(3)
    v_mfma_f32_16x16x32_bf16 v[184:187], v[200:203], v[152:155], v[216:219]
    v_mfma_f32_16x16x32_bf16 v[188:191], v[200:203], v[168:171], v[220:223]
    s_waitcnt vmcnt(2)
    v_mfma_f32_16x16x32_bf16 v[192:195], v[204:207], v[152:155], v[216:219]
    v_mfma_f32_16x16x32_bf16 v[196:199], v[204:207], v[168:171], v[220:223]
    s_waitcnt vmcnt(1)
    v_mfma_f32_16x16x32_bf16 v[184:187], v[208:211], v[156:159], v[184:187]
    v_mfma_f32_16x16x32_bf16 v[188:191], v[208:211], v[172:175], v[188:191]
    s_waitcnt vmcnt(0)
    v_mfma_f32_16x16x32_bf16 v[192:195], v[212:215], v[156:159], v[192:195]
    v_mfma_f32_16x16x32_bf16 v[196:199], v[212:215], v[172:175], v[196:199]
    s_mov_b32 s17, 0x15000
    buffer_load_dwordx4 v[200:203], v8, s[8:11], s17 offen offset:0
    buffer_load_dwordx4 v[204:207], v8, s[8:11], s17 offen offset:1024
    buffer_load_dwordx4 v[208:211], v8, s[8:11], s17 offen offset:2048
    buffer_load_dwordx4 v[212:215], v8, s[8:11], s17 offen offset:3072
    s_waitcnt vmcnt(3)
    v_mfma_f32_16x16x32_bf16 v[184:187], v[200:203], v[160:163], v[184:187]
    v_mfma_f32_16x16x32_bf16 v[188:191], v[200:203], v[176:179], v[188:191]
    s_waitcnt vmcnt(2)
    v_mfma_f32_16x16x32_bf16 v[192:195], v[204:207], v[160:163], v[192:195]
    v_mfma_f32_16x16x32_bf16 v[196:199], v[204:207], v[176:179], v[196:199]
    s_waitcnt vmcnt(1)
    v_mfma_f32_16x16x32_bf16 v[184:187], v[208:211], v[164:167], v[184:187]
    v_mfma_f32_16x16x32_bf16 v[188:191], v[208:211], v[180:183], v[188:191]
    s_waitcnt vmcnt(0)
    v_mfma_f32_16x16x32_bf16 v[192:195], v[212:215], v[164:167], v[192:195]
    v_mfma_f32_16x16x32_bf16 v[196:199], v[212:215], v[180:183], v[196:199]
    s_nop 3
    v_exp_f32 v184, v184
    v_exp_f32 v185, v185
    v_add_f32 v9, v9, v184
    v_add_f32 v9, v9, v185
    v_cvt_pk_bf16_f32 v104, v184, v185
    v_exp_f32 v186, v186
    v_exp_f32 v187, v187
    v_add_f32 v9, v9, v186
    v_add_f32 v9, v9, v187
    v_cvt_pk_bf16_f32 v105, v186, v187
    v_exp_f32 v188, v188
    v_exp_f32 v189, v189
    v_add_f32 v10, v10, v188
    v_add_f32 v10, v10, v189
    v_cvt_pk_bf16_f32 v108, v188, v189
    v_exp_f32 v190, v190
    v_exp_f32 v191, v191
    v_add_f32 v10, v10, v190
    v_add_f32 v10, v10, v191
    v_cvt_pk_bf16_f32 v109, v190, v191
    v_exp_f32 v192, v192
    v_exp_f32 v193, v193
    v_add_f32 v9, v9, v192
    v_add_f32 v9, v9, v193
    v_cvt_pk_bf16_f32 v106, v192, v193
    v_exp_f32 v194, v194
    v_exp_f32 v195, v195
    v_add_f32 v9, v9, v194
    v_add_f32 v9, v9, v195
    v_cvt_pk_bf16_f32 v107, v194, v195
    v_exp_f32 v196, v196
    v_exp_f32 v197, v197
    v_add_f32 v10, v10, v196
    v_add_f32 v10, v10, v197
    v_cvt_pk_bf16_f32 v110, v196, v197
    v_exp_f32 v198, v198
    v_exp_f32 v199, v199
    v_add_f32 v10, v10, v198
    v_add_f32 v10, v10, v199
    v_cvt_pk_bf16_f32 v111, v198, v199
    s_mov_b32 s17, 0x16000
    buffer_load_dwordx4 v[200:203], v8, s[8:11], s17 offen offset:0
    buffer_load_dwordx4 v[204:207], v8, s[8:11], s17 offen offset:1024
    buffer_load_dwordx4 v[208:211], v8, s[8:11], s17 offen offset:2048
    buffer_load_dwordx4 v[212:215], v8, s[8:11], s17 offen offset:3072
    s_waitcnt vmcnt(3)
    v_mfma_f32_16x16x32_bf16 v[184:187], v[200:203], v[152:155], v[216:219]
    v_mfma_f32_16x16x32_bf16 v[188:191], v[200:203], v[168:171], v[220:223]
    s_waitcnt vmcnt(2)
    v_mfma_f32_16x16x32_bf16 v[192:195], v[204:207], v[152:155], v[216:219]
    v_mfma_f32_16x16x32_bf16 v[196:199], v[204:207], v[168:171], v[220:223]
    s_waitcnt vmcnt(1)
    v_mfma_f32_16x16x32_bf16 v[184:187], v[208:211], v[156:159], v[184:187]
    v_mfma_f32_16x16x32_bf16 v[188:191], v[208:211], v[172:175], v[188:191]
    s_waitcnt vmcnt(0)
    v_mfma_f32_16x16x32_bf16 v[192:195], v[212:215], v[156:159], v[192:195]
    v_mfma_f32_16x16x32_bf16 v[196:199], v[212:215], v[172:175], v[196:199]
    s_mov_b32 s17, 0x17000
    buffer_load_dwordx4 v[200:203], v8, s[8:11], s17 offen offset:0
    buffer_load_dwordx4 v[204:207], v8, s[8:11], s17 offen offset:1024
    buffer_load_dwordx4 v[208:211], v8, s[8:11], s17 offen offset:2048
    buffer_load_dwordx4 v[212:215], v8, s[8:11], s17 offen offset:3072
    s_waitcnt vmcnt(3)
    v_mfma_f32_16x16x32_bf16 v[184:187], v[200:203], v[160:163], v[184:187]
    v_mfma_f32_16x16x32_bf16 v[188:191], v[200:203], v[176:179], v[188:191]
    s_waitcnt vmcnt(2)
    v_mfma_f32_16x16x32_bf16 v[192:195], v[204:207], v[160:163], v[192:195]
    v_mfma_f32_16x16x32_bf16 v[196:199], v[204:207], v[176:179], v[196:199]
    s_waitcnt vmcnt(1)
    v_mfma_f32_16x16x32_bf16 v[184:187], v[208:211], v[164:167], v[184:187]
    v_mfma_f32_16x16x32_bf16 v[188:191], v[208:211], v[180:183], v[188:191]
    s_waitcnt vmcnt(0)
    v_mfma_f32_16x16x32_bf16 v[192:195], v[212:215], v[164:167], v[192:195]
    v_mfma_f32_16x16x32_bf16 v[196:199], v[212:215], v[180:183], v[196:199]
    s_nop 3
    v_exp_f32 v184, v184
    v_exp_f32 v185, v185
    v_add_f32 v9, v9, v184
    v_add_f32 v9, v9, v185
    v_cvt_pk_bf16_f32 v112, v184, v185
    v_exp_f32 v186, v186
    v_exp_f32 v187, v187
    v_add_f32 v9, v9, v186
    v_add_f32 v9, v9, v187
    v_cvt_pk_bf16_f32 v113, v186, v187
    v_exp_f32 v188, v188
    v_exp_f32 v189, v189
    v_add_f32 v10, v10, v188
    v_add_f32 v10, v10, v189
    v_cvt_pk_bf16_f32 v116, v188, v189
    v_exp_f32 v190, v190
    v_exp_f32 v191, v191
    v_add_f32 v10, v10, v190
    v_add_f32 v10, v10, v191
    v_cvt_pk_bf16_f32 v117, v190, v191
    v_exp_f32 v192, v192
    v_exp_f32 v193, v193
    v_add_f32 v9, v9, v192
    v_add_f32 v9, v9, v193
    v_cvt_pk_bf16_f32 v114, v192, v193
    v_exp_f32 v194, v194
    v_exp_f32 v195, v195
    v_add_f32 v9, v9, v194
    v_add_f32 v9, v9, v195
    v_cvt_pk_bf16_f32 v115, v194, v195
    v_exp_f32 v196, v196
    v_exp_f32 v197, v197
    v_add_f32 v10, v10, v196
    v_add_f32 v10, v10, v197
    v_cvt_pk_bf16_f32 v118, v196, v197
    v_exp_f32 v198, v198
    v_exp_f32 v199, v199
    v_add_f32 v10, v10, v198
    v_add_f32 v10, v10, v199
    v_cvt_pk_bf16_f32 v119, v198, v199
    s_mov_b32 s17, 0x18000
    buffer_load_dwordx4 v[200:203], v8, s[8:11], s17 offen offset:0
    buffer_load_dwordx4 v[204:207], v8, s[8:11], s17 offen offset:1024
    buffer_load_dwordx4 v[208:211], v8, s[8:11], s17 offen offset:2048
    buffer_load_dwordx4 v[212:215], v8, s[8:11], s17 offen offset:3072
    s_waitcnt vmcnt(3)
    v_mfma_f32_16x16x32_bf16 v[184:187], v[200:203], v[152:155], v[216:219]
    v_mfma_f32_16x16x32_bf16 v[188:191], v[200:203], v[168:171], v[220:223]
    s_waitcnt vmcnt(2)
    v_mfma_f32_16x16x32_bf16 v[192:195], v[204:207], v[152:155], v[216:219]
    v_mfma_f32_16x16x32_bf16 v[196:199], v[204:207], v[168:171], v[220:223]
    s_waitcnt vmcnt(1)
    v_mfma_f32_16x16x32_bf16 v[184:187], v[208:211], v[156:159], v[184:187]
    v_mfma_f32_16x16x32_bf16 v[188:191], v[208:211], v[172:175], v[188:191]
    s_waitcnt vmcnt(0)
    v_mfma_f32_16x16x32_bf16 v[192:195], v[212:215], v[156:159], v[192:195]
    v_mfma_f32_16x16x32_bf16 v[196:199], v[212:215], v[172:175], v[196:199]
    s_mov_b32 s17, 0x19000
    buffer_load_dwordx4 v[200:203], v8, s[8:11], s17 offen offset:0
    buffer_load_dwordx4 v[204:207], v8, s[8:11], s17 offen offset:1024
    buffer_load_dwordx4 v[208:211], v8, s[8:11], s17 offen offset:2048
    buffer_load_dwordx4 v[212:215], v8, s[8:11], s17 offen offset:3072
    s_waitcnt vmcnt(3)
    v_mfma_f32_16x16x32_bf16 v[184:187], v[200:203], v[160:163], v[184:187]
    v_mfma_f32_16x16x32_bf16 v[188:191], v[200:203], v[176:179], v[188:191]
    s_waitcnt vmcnt(2)
    v_mfma_f32_16x16x32_bf16 v[192:195], v[204:207], v[160:163], v[192:195]
    v_mfma_f32_16x16x32_bf16 v[196:199], v[204:207], v[176:179], v[196:199]
    s_waitcnt vmcnt(1)
    v_mfma_f32_16x16x32_bf16 v[184:187], v[208:211], v[164:167], v[184:187]
    v_mfma_f32_16x16x32_bf16 v[188:191], v[208:211], v[180:183], v[188:191]
    s_waitcnt vmcnt(0)
    v_mfma_f32_16x16x32_bf16 v[192:195], v[212:215], v[164:167], v[192:195]
    v_mfma_f32_16x16x32_bf16 v[196:199], v[212:215], v[180:183], v[196:199]
    s_nop 3
    v_exp_f32 v184, v184
    v_exp_f32 v185, v185
    v_add_f32 v9, v9, v184
    v_add_f32 v9, v9, v185
    v_cvt_pk_bf16_f32 v120, v184, v185
    v_exp_f32 v186, v186
    v_exp_f32 v187, v187
    v_add_f32 v9, v9, v186
    v_add_f32 v9, v9, v187
    v_cvt_pk_bf16_f32 v121, v186, v187
    v_exp_f32 v188, v188
    v_exp_f32 v189, v189
    v_add_f32 v10, v10, v188
    v_add_f32 v10, v10, v189
    v_cvt_pk_bf16_f32 v124, v188, v189
    v_exp_f32 v190, v190
    v_exp_f32 v191, v191
    v_add_f32 v10, v10, v190
    v_add_f32 v10, v10, v191
    v_cvt_pk_bf16_f32 v125, v190, v191
    v_exp_f32 v192, v192
    v_exp_f32 v193, v193
    v_add_f32 v9, v9, v192
    v_add_f32 v9, v9, v193
    v_cvt_pk_bf16_f32 v122, v192, v193
    v_exp_f32 v194, v194
    v_exp_f32 v195, v195
    v_add_f32 v9, v9, v194
    v_add_f32 v9, v9, v195
    v_cvt_pk_bf16_f32 v123, v194, v195
    v_exp_f32 v196, v196
    v_exp_f32 v197, v197
    v_add_f32 v10, v10, v196
    v_add_f32 v10, v10, v197
    v_cvt_pk_bf16_f32 v126, v196, v197
    v_exp_f32 v198, v198
    v_exp_f32 v199, v199
    v_add_f32 v10, v10, v198
    v_add_f32 v10, v10, v199
    v_cvt_pk_bf16_f32 v127, v198, v199
    s_mov_b32 s17, 0x1a000
    buffer_load_dwordx4 v[200:203], v8, s[8:11], s17 offen offset:0
    buffer_load_dwordx4 v[204:207], v8, s[8:11], s17 offen offset:1024
    buffer_load_dwordx4 v[208:211], v8, s[8:11], s17 offen offset:2048
    buffer_load_dwordx4 v[212:215], v8, s[8:11], s17 offen offset:3072
    s_waitcnt vmcnt(3)
    v_mfma_f32_16x16x32_bf16 v[184:187], v[200:203], v[152:155], v[216:219]
    v_mfma_f32_16x16x32_bf16 v[188:191], v[200:203], v[168:171], v[220:223]
    s_waitcnt vmcnt(2)
    v_mfma_f32_16x16x32_bf16 v[192:195], v[204:207], v[152:155], v[216:219]
    v_mfma_f32_16x16x32_bf16 v[196:199], v[204:207], v[168:171], v[220:223]
    s_waitcnt vmcnt(1)
    v_mfma_f32_16x16x32_bf16 v[184:187], v[208:211], v[156:159], v[184:187]
    v_mfma_f32_16x16x32_bf16 v[188:191], v[208:211], v[172:175], v[188:191]
    s_waitcnt vmcnt(0)
    v_mfma_f32_16x16x32_bf16 v[192:195], v[212:215], v[156:159], v[192:195]
    v_mfma_f32_16x16x32_bf16 v[196:199], v[212:215], v[172:175], v[196:199]
    s_mov_b32 s17, 0x1b000
    buffer_load_dwordx4 v[200:203], v8, s[8:11], s17 offen offset:0
    buffer_load_dwordx4 v[204:207], v8, s[8:11], s17 offen offset:1024
    buffer_load_dwordx4 v[208:211], v8, s[8:11], s17 offen offset:2048
    buffer_load_dwordx4 v[212:215], v8, s[8:11], s17 offen offset:3072
    s_waitcnt vmcnt(3)
    v_mfma_f32_16x16x32_bf16 v[184:187], v[200:203], v[160:163], v[184:187]
    v_mfma_f32_16x16x32_bf16 v[188:191], v[200:203], v[176:179], v[188:191]
    s_waitcnt vmcnt(2)
    v_mfma_f32_16x16x32_bf16 v[192:195], v[204:207], v[160:163], v[192:195]
    v_mfma_f32_16x16x32_bf16 v[196:199], v[204:207], v[176:179], v[196:199]
    s_waitcnt vmcnt(1)
    v_mfma_f32_16x16x32_bf16 v[184:187], v[208:211], v[164:167], v[184:187]
    v_mfma_f32_16x16x32_bf16 v[188:191], v[208:211], v[180:183], v[188:191]
    s_waitcnt vmcnt(0)
    v_mfma_f32_16x16x32_bf16 v[192:195], v[212:215], v[164:167], v[192:195]
    v_mfma_f32_16x16x32_bf16 v[196:199], v[212:215], v[180:183], v[196:199]
    s_nop 3
    v_exp_f32 v184, v184
    v_exp_f32 v185, v185
    v_add_f32 v9, v9, v184
    v_add_f32 v9, v9, v185
    v_cvt_pk_bf16_f32 v128, v184, v185
    v_exp_f32 v186, v186
    v_exp_f32 v187, v187
    v_add_f32 v9, v9, v186
    v_add_f32 v9, v9, v187
    v_cvt_pk_bf16_f32 v129, v186, v187
    v_exp_f32 v188, v188
    v_exp_f32 v189, v189
    v_add_f32 v10, v10, v188
    v_add_f32 v10, v10, v189
    v_cvt_pk_bf16_f32 v132, v188, v189
    v_exp_f32 v190, v190
    v_exp_f32 v191, v191
    v_add_f32 v10, v10, v190
    v_add_f32 v10, v10, v191
    v_cvt_pk_bf16_f32 v133, v190, v191
    v_exp_f32 v192, v192
    v_exp_f32 v193, v193
    v_add_f32 v9, v9, v192
    v_add_f32 v9, v9, v193
    v_cvt_pk_bf16_f32 v130, v192, v193
    v_exp_f32 v194, v194
    v_exp_f32 v195, v195
    v_add_f32 v9, v9, v194
    v_add_f32 v9, v9, v195
    v_cvt_pk_bf16_f32 v131, v194, v195
    v_exp_f32 v196, v196
    v_exp_f32 v197, v197
    v_add_f32 v10, v10, v196
    v_add_f32 v10, v10, v197
    v_cvt_pk_bf16_f32 v134, v196, v197
    v_exp_f32 v198, v198
    v_exp_f32 v199, v199
    v_add_f32 v10, v10, v198
    v_add_f32 v10, v10, v199
    v_cvt_pk_bf16_f32 v135, v198, v199
    s_mov_b32 s17, 0x1c000
    buffer_load_dwordx4 v[200:203], v8, s[8:11], s17 offen offset:0
    buffer_load_dwordx4 v[204:207], v8, s[8:11], s17 offen offset:1024
    buffer_load_dwordx4 v[208:211], v8, s[8:11], s17 offen offset:2048
    buffer_load_dwordx4 v[212:215], v8, s[8:11], s17 offen offset:3072
    s_waitcnt vmcnt(3)
    v_mfma_f32_16x16x32_bf16 v[184:187], v[200:203], v[152:155], v[216:219]
    v_mfma_f32_16x16x32_bf16 v[188:191], v[200:203], v[168:171], v[220:223]
    s_waitcnt vmcnt(2)
    v_mfma_f32_16x16x32_bf16 v[192:195], v[204:207], v[152:155], v[216:219]
    v_mfma_f32_16x16x32_bf16 v[196:199], v[204:207], v[168:171], v[220:223]
    s_waitcnt vmcnt(1)
    v_mfma_f32_16x16x32_bf16 v[184:187], v[208:211], v[156:159], v[184:187]
    v_mfma_f32_16x16x32_bf16 v[188:191], v[208:211], v[172:175], v[188:191]
    s_waitcnt vmcnt(0)
    v_mfma_f32_16x16x32_bf16 v[192:195], v[212:215], v[156:159], v[192:195]
    v_mfma_f32_16x16x32_bf16 v[196:199], v[212:215], v[172:175], v[196:199]
    s_mov_b32 s17, 0x1d000
    buffer_load_dwordx4 v[200:203], v8, s[8:11], s17 offen offset:0
    buffer_load_dwordx4 v[204:207], v8, s[8:11], s17 offen offset:1024
    buffer_load_dwordx4 v[208:211], v8, s[8:11], s17 offen offset:2048
    buffer_load_dwordx4 v[212:215], v8, s[8:11], s17 offen offset:3072
    s_waitcnt vmcnt(3)
    v_mfma_f32_16x16x32_bf16 v[184:187], v[200:203], v[160:163], v[184:187]
    v_mfma_f32_16x16x32_bf16 v[188:191], v[200:203], v[176:179], v[188:191]
    s_waitcnt vmcnt(2)
    v_mfma_f32_16x16x32_bf16 v[192:195], v[204:207], v[160:163], v[192:195]
    v_mfma_f32_16x16x32_bf16 v[196:199], v[204:207], v[176:179], v[196:199]
    s_waitcnt vmcnt(1)
    v_mfma_f32_16x16x32_bf16 v[184:187], v[208:211], v[164:167], v[184:187]
    v_mfma_f32_16x16x32_bf16 v[188:191], v[208:211], v[180:183], v[188:191]
    s_waitcnt vmcnt(0)
    v_mfma_f32_16x16x32_bf16 v[192:195], v[212:215], v[164:167], v[192:195]
    v_mfma_f32_16x16x32_bf16 v[196:199], v[212:215], v[180:183], v[196:199]
    s_nop 3
    v_exp_f32 v184, v184
    v_exp_f32 v185, v185
    v_add_f32 v9, v9, v184
    v_add_f32 v9, v9, v185
    v_cvt_pk_bf16_f32 v136, v184, v185
    v_exp_f32 v186, v186
    v_exp_f32 v187, v187
    v_add_f32 v9, v9, v186
    v_add_f32 v9, v9, v187
    v_cvt_pk_bf16_f32 v137, v186, v187
    v_exp_f32 v188, v188
    v_exp_f32 v189, v189
    v_add_f32 v10, v10, v188
    v_add_f32 v10, v10, v189
    v_cvt_pk_bf16_f32 v140, v188, v189
    v_exp_f32 v190, v190
    v_exp_f32 v191, v191
    v_add_f32 v10, v10, v190
    v_add_f32 v10, v10, v191
    v_cvt_pk_bf16_f32 v141, v190, v191
    v_exp_f32 v192, v192
    v_exp_f32 v193, v193
    v_add_f32 v9, v9, v192
    v_add_f32 v9, v9, v193
    v_cvt_pk_bf16_f32 v138, v192, v193
    v_exp_f32 v194, v194
    v_exp_f32 v195, v195
    v_add_f32 v9, v9, v194
    v_add_f32 v9, v9, v195
    v_cvt_pk_bf16_f32 v139, v194, v195
    v_exp_f32 v196, v196
    v_exp_f32 v197, v197
    v_add_f32 v10, v10, v196
    v_add_f32 v10, v10, v197
    v_cvt_pk_bf16_f32 v142, v196, v197
    v_exp_f32 v198, v198
    v_exp_f32 v199, v199
    v_add_f32 v10, v10, v198
    v_add_f32 v10, v10, v199
    v_cvt_pk_bf16_f32 v143, v198, v199
    s_mov_b32 s17, 0x1e000
    buffer_load_dwordx4 v[200:203], v8, s[8:11], s17 offen offset:0
    buffer_load_dwordx4 v[204:207], v8, s[8:11], s17 offen offset:1024
    buffer_load_dwordx4 v[208:211], v8, s[8:11], s17 offen offset:2048
    buffer_load_dwordx4 v[212:215], v8, s[8:11], s17 offen offset:3072
    s_waitcnt vmcnt(3)
    v_mfma_f32_16x16x32_bf16 v[184:187], v[200:203], v[152:155], v[216:219]
    v_mfma_f32_16x16x32_bf16 v[188:191], v[200:203], v[168:171], v[220:223]
    s_waitcnt vmcnt(2)
    v_mfma_f32_16x16x32_bf16 v[192:195], v[204:207], v[152:155], v[216:219]
    v_mfma_f32_16x16x32_bf16 v[196:199], v[204:207], v[168:171], v[220:223]
    s_waitcnt vmcnt(1)
    v_mfma_f32_16x16x32_bf16 v[184:187], v[208:211], v[156:159], v[184:187]
    v_mfma_f32_16x16x32_bf16 v[188:191], v[208:211], v[172:175], v[188:191]
    s_waitcnt vmcnt(0)
    v_mfma_f32_16x16x32_bf16 v[192:195], v[212:215], v[156:159], v[192:195]
    v_mfma_f32_16x16x32_bf16 v[196:199], v[212:215], v[172:175], v[196:199]
    s_mov_b32 s17, 0x1f000
    buffer_load_dwordx4 v[200:203], v8, s[8:11], s17 offen offset:0
    buffer_load_dwordx4 v[204:207], v8, s[8:11], s17 offen offset:1024
    buffer_load_dwordx4 v[208:211], v8, s[8:11], s17 offen offset:2048
    buffer_load_dwordx4 v[212:215], v8, s[8:11], s17 offen offset:3072
    s_waitcnt vmcnt(3)
    v_mfma_f32_16x16x32_bf16 v[184:187], v[200:203], v[160:163], v[184:187]
    v_mfma_f32_16x16x32_bf16 v[188:191], v[200:203], v[176:179], v[188:191]
    s_waitcnt vmcnt(2)
    v_mfma_f32_16x16x32_bf16 v[192:195], v[204:207], v[160:163], v[192:195]
    v_mfma_f32_16x16x32_bf16 v[196:199], v[204:207], v[176:179], v[196:199]
    s_waitcnt vmcnt(1)
    v_mfma_f32_16x16x32_bf16 v[184:187], v[208:211], v[164:167], v[184:187]
    v_mfma_f32_16x16x32_bf16 v[188:191], v[208:211], v[180:183], v[188:191]
    s_waitcnt vmcnt(0)
    v_mfma_f32_16x16x32_bf16 v[192:195], v[212:215], v[164:167], v[192:195]
    v_mfma_f32_16x16x32_bf16 v[196:199], v[212:215], v[180:183], v[196:199]
    s_nop 3
    v_exp_f32 v184, v184
    v_exp_f32 v185, v185
    v_add_f32 v9, v9, v184
    v_add_f32 v9, v9, v185
    v_cvt_pk_bf16_f32 v144, v184, v185
    v_exp_f32 v186, v186
    v_exp_f32 v187, v187
    v_add_f32 v9, v9, v186
    v_add_f32 v9, v9, v187
    v_cvt_pk_bf16_f32 v145, v186, v187
    v_exp_f32 v188, v188
    v_exp_f32 v189, v189
    v_add_f32 v10, v10, v188
    v_add_f32 v10, v10, v189
    v_cvt_pk_bf16_f32 v148, v188, v189
    v_exp_f32 v190, v190
    v_exp_f32 v191, v191
    v_add_f32 v10, v10, v190
    v_add_f32 v10, v10, v191
    v_cvt_pk_bf16_f32 v149, v190, v191
    v_exp_f32 v192, v192
    v_exp_f32 v193, v193
    v_add_f32 v9, v9, v192
    v_add_f32 v9, v9, v193
    v_cvt_pk_bf16_f32 v146, v192, v193
    v_exp_f32 v194, v194
    v_exp_f32 v195, v195
    v_add_f32 v9, v9, v194
    v_add_f32 v9, v9, v195
    v_cvt_pk_bf16_f32 v147, v194, v195
    v_exp_f32 v196, v196
    v_exp_f32 v197, v197
    v_add_f32 v10, v10, v196
    v_add_f32 v10, v10, v197
    v_cvt_pk_bf16_f32 v150, v196, v197
    v_exp_f32 v198, v198
    v_exp_f32 v199, v199
    v_add_f32 v10, v10, v198
    v_add_f32 v10, v10, v199
    v_cvt_pk_bf16_f32 v151, v198, v199
    v_mov_b32 v16, v9
    v_mov_b32 v18, v10
    s_nop 0
    v_permlane16_swap_b32 v9, v16
    v_permlane16_swap_b32 v10, v18
    v_add_f32 v9, v9, v16
    v_add_f32 v10, v10, v18
    v_mov_b32 v16, v9
    v_mov_b32 v18, v10
    s_nop 0
    v_permlane32_swap_b32 v9, v16
    v_permlane32_swap_b32 v10, v18
    v_add_f32 v9, v9, v16
    v_add_f32 v10, v10, v18
    s_waitcnt vmcnt(0) lgkmcnt(0)
    s_nop 15
    s_nop 3
    s_branch adaLN_cond__sliding_block_cached__moe_arch_mod__prompt_kernel_fixBb
adaLN_cond__sliding_block_cached__moe_arch_mod__prompt_kernel_o17r:
    s_waitcnt vmcnt(0) lgkmcnt(0)
    s_nop 15
    s_nop 3
    s_mov_b32 s27, 0
adaLN_cond__sliding_block_cached__moe_arch_mod__prompt_kernel_o17p:
    buffer_load_dword v12, v13, s[8:11], s19 offen sc1
    s_waitcnt vmcnt(0)
    v_cmp_ne_u32 vcc, s28, v12
    s_add_u32 s27, s27, 1
    s_cmp_ge_u32 s27, 262144
    s_cbranch_scc1 adaLN_cond__sliding_block_cached__moe_arch_mod__prompt_kernel_o17g
    s_cbranch_vccnz adaLN_cond__sliding_block_cached__moe_arch_mod__prompt_kernel_o17p
adaLN_cond__sliding_block_cached__moe_arch_mod__prompt_kernel_o17g:
    s_waitcnt vmcnt(0) lgkmcnt(0)
    s_nop 15
    s_nop 3
    s_branch adaLN_cond__sliding_block_cached__moe_arch_mod__prompt_kernel_o17b
adaLN_cond__sliding_block_cached__moe_arch_mod__prompt_kernel_o218r:
    s_waitcnt vmcnt(0) lgkmcnt(0)
    s_nop 15
    s_nop 3
    s_mov_b32 s27, 0
adaLN_cond__sliding_block_cached__moe_arch_mod__prompt_kernel_o218p:
    buffer_load_dword v12, v13, s[8:11], s19 offen sc1
    s_waitcnt vmcnt(0)
    v_cmp_ne_u32 vcc, s28, v12
    s_add_u32 s27, s27, 1
    s_cmp_ge_u32 s27, 262144
    s_cbranch_scc1 adaLN_cond__sliding_block_cached__moe_arch_mod__prompt_kernel_o218g
    s_cbranch_vccnz adaLN_cond__sliding_block_cached__moe_arch_mod__prompt_kernel_o218p
adaLN_cond__sliding_block_cached__moe_arch_mod__prompt_kernel_o218g:
    s_waitcnt vmcnt(0) lgkmcnt(0)
    s_nop 15
    s_nop 3
    s_branch adaLN_cond__sliding_block_cached__moe_arch_mod__prompt_kernel_o218b
adaLN_cond__sliding_block_cached__moe_arch_mod__prompt_kernel_o219r:
    s_waitcnt vmcnt(0) lgkmcnt(0)
    s_nop 15
    s_nop 3
    s_mov_b32 s27, 0
adaLN_cond__sliding_block_cached__moe_arch_mod__prompt_kernel_o219p:
    buffer_load_dword v12, v13, s[8:11], s19 offen sc1
    s_waitcnt vmcnt(0)
    v_cmp_ne_u32 vcc, s28, v12
    s_add_u32 s27, s27, 1
    s_cmp_ge_u32 s27, 262144
    s_cbranch_scc1 adaLN_cond__sliding_block_cached__moe_arch_mod__prompt_kernel_o219g
    s_cbranch_vccnz adaLN_cond__sliding_block_cached__moe_arch_mod__prompt_kernel_o219p
adaLN_cond__sliding_block_cached__moe_arch_mod__prompt_kernel_o219g:
    s_waitcnt vmcnt(0) lgkmcnt(0)
    s_nop 15
    s_nop 3
    s_branch adaLN_cond__sliding_block_cached__moe_arch_mod__prompt_kernel_o219b
adaLN_cond__sliding_block_cached__moe_arch_mod__prompt_kernel_o220r:
    s_waitcnt vmcnt(0) lgkmcnt(0)
    s_nop 15
    s_nop 3
    s_mov_b32 s27, 0
adaLN_cond__sliding_block_cached__moe_arch_mod__prompt_kernel_o220p:
    buffer_load_dword v12, v13, s[8:11], s19 offen sc1
    s_waitcnt vmcnt(0)
    v_cmp_ne_u32 vcc, s28, v12
    s_add_u32 s27, s27, 1
    s_cmp_ge_u32 s27, 262144
    s_cbranch_scc1 adaLN_cond__sliding_block_cached__moe_arch_mod__prompt_kernel_o220g
    s_cbranch_vccnz adaLN_cond__sliding_block_cached__moe_arch_mod__prompt_kernel_o220p
adaLN_cond__sliding_block_cached__moe_arch_mod__prompt_kernel_o220g:
    s_waitcnt vmcnt(0) lgkmcnt(0)
    s_nop 15
    s_nop 3
    s_branch adaLN_cond__sliding_block_cached__moe_arch_mod__prompt_kernel_o220b
adaLN_cond__sliding_block_cached__moe_arch_mod__prompt_kernel_mf21r:
    s_waitcnt vmcnt(0) lgkmcnt(0)
    s_nop 15
    s_nop 3
    s_mov_b32 s27, 0
adaLN_cond__sliding_block_cached__moe_arch_mod__prompt_kernel_mf21p:
    s_mov_b32 s16, 0x544000
    buffer_load_dwordx4 v[184:187], v2, s[8:11], s16 offen sc1
    s_waitcnt vmcnt(0)
    v_xor_b32 v16, s28, v184
    v_xor_b32 v17, s28, v185
    v_xor_b32 v18, s28, v186
    v_xor_b32 v19, s28, v187
    v_or3_b32 v16, v16, v17, v18
    v_or_b32 v16, v16, v19
    v_cmp_ne_u32 vcc, 0, v16
    s_add_u32 s27, s27, 1
    s_cmp_ge_u32 s27, 262144
    s_cbranch_scc1 adaLN_cond__sliding_block_cached__moe_arch_mod__prompt_kernel_mf21g
    s_cbranch_vccnz adaLN_cond__sliding_block_cached__moe_arch_mod__prompt_kernel_mf21p
adaLN_cond__sliding_block_cached__moe_arch_mod__prompt_kernel_mf21g:
    s_waitcnt vmcnt(0) lgkmcnt(0)
    s_nop 15
    s_nop 3
    s_branch adaLN_cond__sliding_block_cached__moe_arch_mod__prompt_kernel_mf21b
.section .rodata,"a"
.p2align 6
.amdhsa_kernel adaLN_cond__sliding_block_cached__moe_arch_mod__prompt_kernel
  .amdhsa_next_free_vgpr 256
  .amdhsa_next_free_sgpr 80
  .amdhsa_accum_offset 256
  .amdhsa_group_segment_fixed_size 0
  .amdhsa_kernarg_size 120
  .amdhsa_user_sgpr_count 2
  .amdhsa_user_sgpr_kernarg_segment_ptr 1
  .amdhsa_system_sgpr_workgroup_id_x 1
  .amdhsa_float_denorm_mode_32 3
.end_amdhsa_kernel
```

```asm
; @launch grid=(256,1,1) block=(512,1,1) lds=163840
.amdgcn_target "amdgcn-amd-amdhsa--gfx950"
.text
.globl adaLN_cond__sliding_block_cached__moe_arch_mod__prompt_kernel
.p2align 8
.type adaLN_cond__sliding_block_cached__moe_arch_mod__prompt_kernel,@function
adaLN_cond__sliding_block_cached__moe_arch_mod__prompt_kernel:
    s_cmp_ge_u32 s2, 256
    s_cbranch_scc1 adaLN_cond__sliding_block_cached__moe_arch_mod__prompt_kernel_end
    s_getpc_b64 s[76:77]
adaLN_cond__sliding_block_cached__moe_arch_mod__prompt_kernel_pc0:
    s_sub_u32 s76, s76, adaLN_cond__sliding_block_cached__moe_arch_mod__prompt_kernel_pc0-adaLN_cond__sliding_block_cached__moe_arch_mod__prompt_kernel
    s_subb_u32 s77, s77, 0
    v_and_b32 v16, 63, v0
    v_lshlrev_b32 v16, 7, v16
    v_lshrrev_b32 v17, 6, v0
    s_lshr_b32 s62, s2, 3
    s_lshl_b32 s62, s62, 13
    v_lshlrev_b32 v18, 13, v17
    v_mov_b32 v19, s62
    v_cmp_eq_u32 vcc, 7, v17
    s_nop 1
    v_cndmask_b32 v18, v18, v19, vcc
    v_add_u32 v16, v16, v18
    v_min_u32 v16, adaLN_cond__sliding_block_cached__moe_arch_mod__prompt_kernel_codeend-adaLN_cond__sliding_block_cached__moe_arch_mod__prompt_kernel-4, v16
    v_mov_b32 v25, s77
    v_add_co_u32 v24, vcc, s76, v16
    s_nop 1
    v_addc_co_u32 v25, vcc, 0, v25, vcc
    v_cmp_gt_u32 vcc, 2, v17
    v_cmp_eq_u32 s[62:63], 7, v17
    s_or_b64 vcc, vcc, s[62:63]
    s_and_saveexec_b64 s[62:63], vcc
    s_cbranch_execz adaLN_cond__sliding_block_cached__moe_arch_mod__prompt_kernel_nocp0
    global_load_dword v26, v[24:25], off
adaLN_cond__sliding_block_cached__moe_arch_mod__prompt_kernel_nocp0:
    s_mov_b64 exec, s[62:63]
    s_load_dwordx4 s[56:59], s[0:1], 96
    s_load_dwordx2 s[60:61], s[0:1], 112
    s_load_dwordx8 s[48:55], s[0:1], 64
    s_load_dwordx16 s[32:47], s[0:1], 0
    s_memrealtime s[62:63]
    v_lshrrev_b32 v16, 6, v0
    v_and_b32 v1, 63, v0
    v_readfirstlane_b32 s3, v16
    v_lshlrev_b32 v2, 4, v1
    s_and_b32 s12, s2, 3
    s_lshl_b32 s12, s12, 3
    s_bfe_u32 s13, s2, 0x30003
    s_add_u32 s12, s12, s13
    s_bfe_u32 s13, s2, 0x10002
    s_lshl_b32 s13, s13, 2
    s_lshr_b32 s14, s2, 6
    s_add_u32 s13, s13, s14
    v_bfe_u32 v16, v1, 2, 2
    v_lshrrev_b32 v17, 4, v1
    v_and_b32 v18, 3, v1
    v_lshlrev_b32 v19, 6, v17
    v_lshl_add_u32 v19, v18, 4, v19
    v_lshl_add_u32 v3, v16, 13, v19
    s_and_b32 s14, s3, 1
    s_lshl_b32 s14, s14, 5
    v_xor_b32 v3, s14, v3
    v_lshlrev_b32 v4, 11, v17
    v_lshl_add_u32 v4, v16, 6, v4
    v_lshl_add_u32 v4, v18, 3, v4
    v_and_b32 v20, 1, v17
    v_lshlrev_b32 v20, 5, v20
    v_sub_u32 v5, v4, v20
    v_add_u32 v4, v4, v20
    s_lshl_b32 s14, s13, 3
    s_add_u32 s14, s14, s3
    s_lshl_b32 s14, s14, 16
    v_add_u32 v7, s14, v2
    s_cmp_ge_u32 s3, 4
    s_cbranch_scc1 adaLN_cond__sliding_block_cached__moe_arch_mod__prompt_kernel_roleB
    v_mov_b32 v132, 0
    v_mov_b32 v133, 0
    v_lshrrev_b32 v16, 3, v0
    v_and_b32 v17, 7, v0
    v_mul_u32_u24 v135, 24576, v16
    v_lshl_add_u32 v135, v17, 4, v135
    v_lshlrev_b32 v136, 2, v16
    s_and_b32 s14, s2, 31
    s_lshr_b32 s15, s2, 5
    s_mul_i32 s26, s15, 1572864
    s_lshl_b32 s16, s14, 7
    s_add_u32 s26, s26, s16
    s_lshl_b32 s29, s15, 8
    v_lshlrev_b32 v137, 3, v0
    s_lshl_b32 s18, s2, 3
    s_add_u32 s18, s18, s3
    s_lshl_b32 s18, s18, 11
    v_and_b32 v18, 15, v1
    v_lshrrev_b32 v19, 4, v1
    v_lshlrev_b32 v138, 11, v18
    v_lshl_add_u32 v138, v19, 4, v138
    s_lshr_b32 s30, s2, 4
    s_and_b32 s31, s2, 15
    s_lshl_b32 s19, s30, 3
    s_add_u32 s19, s19, s3
    s_lshl_b32 s22, s19, 15
    s_lshl_b32 s23, s31, 7
    s_add_u32 s22, s22, s23
    s_lshl_b32 s23, s2, 12
    s_add_u32 s23, s23, 0x600000
    s_or_b32 s25, s2, s3
    s_cmp_eq_u32 s25, 0
    s_cselect_b32 s25, 0, 0x7ffffff0
    s_waitcnt lgkmcnt(0)
    s_mov_b64 s[64:65], s[58:59]
    s_mov_b32 s66, 0x100
    s_mov_b32 s67, 0x20000
    s_or_b32 s28, s62, 1
    v_mov_b32 v134, s28
    s_mov_b64 exec, 1
    buffer_store_dword v134, v132, s[64:67], s25 offen sc1
    s_mov_b64 exec, -1
    s_mov_b64 s[68:69], s[52:53]
    s_mov_b32 s70, 0x800
    s_mov_b32 s71, 0x20000
    s_mov_b64 s[72:73], s[54:55]
    s_mov_b32 s74, 0xc00000
    s_mov_b32 s75, 0x20000
    s_mov_b64 s[76:77], s[32:33]
    s_mov_b32 s78, 0x400000
    s_mov_b32 s79, 0x20000
    s_mov_b64 s[8:9], s[60:61]
    s_mov_b32 s10, 0x3400000
    s_mov_b32 s11, 0x20000
    buffer_load_dword v72, v136, s[68:71], s29 offen
    buffer_load_dwordx4 v[24:27], v135, s[72:75], s26 offen
    s_add_u32 s26, s26, 12288
    buffer_load_dwordx4 v[28:31], v135, s[72:75], s26 offen
    buffer_load_dwordx4 v[32:35], v2, s[76:79], s18 offen offset:0
    buffer_load_dwordx4 v[36:39], v2, s[76:79], s18 offen offset:1024
    s_cmp_eq_u32 s3, 0
    s_cselect_b32 s25, 0, 0x7ffffff0
    buffer_load_dword v134, v132, s[64:67], s25 offen sc1
    buffer_store_dwordx2 v[132:133], v137, s[8:11], s23 offen sc1
    s_barrier
    buffer_load_dwordx4 v[40:43], v138, s[76:79], s22 offen offset:0
    buffer_load_dwordx4 v[44:47], v138, s[76:79], s22 offen offset:64
    s_mov_b32 s29, s19
    s_waitcnt vmcnt(8)
    v_and_b32 v73, 0xffff0000, v72
    v_lshlrev_b32 v72, 16, v72
    v_mul_f32 v16, 0xbfb8aa3b, v72
    v_exp_f32 v16, v16
    s_nop 0
    v_add_f32 v16, 1.0, v16
    v_rcp_f32 v16, v16
    s_nop 0
    v_mul_f32 v72, v72, v16
    v_mul_f32 v17, 0xbfb8aa3b, v73
    v_exp_f32 v17, v17
    s_nop 0
    v_add_f32 v17, 1.0, v17
    v_rcp_f32 v17, v17
    s_nop 0
    v_mul_f32 v73, v73, v17
    v_cvt_pk_bf16_f32 v16, v72, v73
    v_lshlrev_b32 v72, 16, v16
    v_and_b32 v73, 0xffff0000, v16
    s_lshl_b32 s16, s2, 8
    s_add_u32 s16, s16, 0x550000
    s_mov_b32 exec_lo, 0x01010101
    s_mov_b32 exec_hi, 0x01010101
    buffer_store_dword v16, v136, s[8:11], s16 offen sc1
    s_mov_b64 exec, -1
    v_lshrrev_b32 v74, 16, v72
    v_lshrrev_b32 v75, 16, v73
    s_waitcnt vmcnt(8)
    v_dot2_f32_bf16 v49, v24, v72, 0
    v_dot2_f32_bf16 v48, v24, v74, 0
    v_dot2_f32_bf16 v51, v25, v72, 0
    v_dot2_f32_bf16 v50, v25, v74, 0
    v_dot2_f32_bf16 v53, v26, v72, 0
    v_dot2_f32_bf16 v52, v26, v74, 0
    v_dot2_f32_bf16 v55, v27, v72, 0
    v_dot2_f32_bf16 v54, v27, v74, 0
    s_waitcnt vmcnt(7)
    v_dot2c_f32_bf16 v49, v28, v73
    v_dot2c_f32_bf16 v48, v28, v75
    v_dot2c_f32_bf16 v51, v29, v73
    v_dot2c_f32_bf16 v50, v29, v75
    v_dot2c_f32_bf16 v53, v30, v73
    v_dot2c_f32_bf16 v52, v30, v75
    v_dot2c_f32_bf16 v55, v31, v73
    v_dot2c_f32_bf16 v54, v31, v75
    s_nop 0
    v_permlane32_swap_b32 v48, v52
    v_permlane32_swap_b32 v49, v53
    v_permlane32_swap_b32 v50, v54
    v_permlane32_swap_b32 v51, v55
    v_add_f32 v48, v48, v52
    v_add_f32 v49, v49, v53
    v_add_f32 v50, v50, v54
    v_add_f32 v51, v51, v55
    s_nop 0
    v_permlane16_swap_b32 v48, v50
    v_permlane16_swap_b32 v49, v51
    v_add_f32 v48, v48, v50
    v_add_f32 v49, v49, v51
    s_nop 0
    v_add_f32_dpp v48, v48, v48 row_ror:8 row_mask:0xf bank_mask:0xf
    v_add_f32_dpp v49, v49, v49 row_ror:8 row_mask:0xf bank_mask:0xf
    v_and_b32 v16, 7, v1
    v_lshlrev_b32 v16, 5, v16
    v_lshrrev_b32 v17, 4, v1
    v_lshl_add_u32 v16, v17, 3, v16
    s_lshl_b32 s16, s3, 8
    s_add_u32 s16, s16, 65536
    v_add_u32 v16, s16, v16
    ds_write_b64 v16, v[48:49]
    s_waitcnt vmcnt(6)
    v_lshlrev_b32 v56, 16, v32
    v_and_b32 v57, 0xffff0000, v32
    v_lshlrev_b32 v58, 16, v33
    v_and_b32 v59, 0xffff0000, v33
    v_lshlrev_b32 v60, 16, v34
    v_and_b32 v61, 0xffff0000, v34
    v_lshlrev_b32 v62, 16, v35
    v_and_b32 v63, 0xffff0000, v35
    s_waitcnt vmcnt(5)
    v_lshlrev_b32 v64, 16, v36
    v_and_b32 v65, 0xffff0000, v36
    v_lshlrev_b32 v66, 16, v37
    v_and_b32 v67, 0xffff0000, v37
    v_lshlrev_b32 v68, 16, v38
    v_and_b32 v69, 0xffff0000, v38
    v_lshlrev_b32 v70, 16, v39
    v_and_b32 v71, 0xffff0000, v39
    v_add_f32 v20, v56, v57
    v_add_f32 v21, v58, v59
    v_add_f32 v20, v20, v60
    v_add_f32 v21, v21, v61
    v_add_f32 v20, v20, v62
    v_add_f32 v21, v21, v63
    v_add_f32 v20, v20, v64
    v_add_f32 v21, v21, v65
    v_add_f32 v20, v20, v66
    v_add_f32 v21, v21, v67
    v_add_f32 v20, v20, v68
    v_add_f32 v21, v21, v69
    v_add_f32 v20, v20, v70
    v_add_f32 v21, v21, v71
    v_add_f32 v128, v20, v21
    s_nop 1
    v_add_f32_dpp v128, v128, v128 row_ror:1 row_mask:0xf bank_mask:0xf
    s_nop 1
    v_add_f32_dpp v128, v128, v128 row_ror:2 row_mask:0xf bank_mask:0xf
    s_nop 1
    v_add_f32_dpp v128, v128, v128 row_ror:4 row_mask:0xf bank_mask:0xf
    s_nop 1
    v_add_f32_dpp v128, v128, v128 row_ror:8 row_mask:0xf bank_mask:0xf
    v_mov_b32 v20, v128
    s_nop 1
    v_permlane16_swap_b32 v128, v20
    v_add_f32 v128, v128, v20
    v_mov_b32 v20, v128
    s_nop 1
    v_permlane32_swap_b32 v128, v20
    v_add_f32 v128, v128, v20
    v_mul_f32 v128, 0x3a800000, v128
    v_sub_f32 v18, v56, v128
    v_mul_f32 v20, v18, v18
    v_sub_f32 v19, v57, v128
    v_mul_f32 v21, v19, v19
    v_sub_f32 v18, v58, v128
    v_sub_f32 v19, v59, v128
    v_fmac_f32 v20, v18, v18
    v_fmac_f32 v21, v19, v19
    v_sub_f32 v18, v60, v128
    v_sub_f32 v19, v61, v128
    v_fmac_f32 v20, v18, v18
    v_fmac_f32 v21, v19, v19
    v_sub_f32 v18, v62, v128
    v_sub_f32 v19, v63, v128
    v_fmac_f32 v20, v18, v18
    v_fmac_f32 v21, v19, v19
    v_sub_f32 v18, v64, v128
    v_sub_f32 v19, v65, v128
    v_fmac_f32 v20, v18, v18
    v_fmac_f32 v21, v19, v19
    v_sub_f32 v18, v66, v128
    v_sub_f32 v19, v67, v128
    v_fmac_f32 v20, v18, v18
    v_fmac_f32 v21, v19, v19
    v_sub_f32 v18, v68, v128
    v_sub_f32 v19, v69, v128
    v_fmac_f32 v20, v18, v18
    v_fmac_f32 v21, v19, v19
    v_sub_f32 v18, v70, v128
    v_sub_f32 v19, v71, v128
    v_fmac_f32 v20, v18, v18
    v_fmac_f32 v21, v19, v19
    v_add_f32 v17, v20, v21
    s_nop 1
    v_add_f32_dpp v17, v17, v17 row_ror:1 row_mask:0xf bank_mask:0xf
    s_nop 1
    v_add_f32_dpp v17, v17, v17 row_ror:2 row_mask:0xf bank_mask:0xf
    s_nop 1
    v_add_f32_dpp v17, v17, v17 row_ror:4 row_mask:0xf bank_mask:0xf
    s_nop 1
    v_add_f32_dpp v17, v17, v17 row_ror:8 row_mask:0xf bank_mask:0xf
    v_mov_b32 v20, v17
    s_nop 1
    v_permlane16_swap_b32 v17, v20
    v_add_f32 v17, v17, v20
    v_mov_b32 v20, v17
    s_nop 1
    v_permlane32_swap_b32 v17, v20
    v_add_f32 v17, v17, v20
    v_mul_f32 v17, 0x3a800000, v17
    v_cvt_pk_bf16_f32 v128, v128, v128
    v_lshlrev_b32 v128, 16, v128
    v_cvt_pk_bf16_f32 v17, v17, v17
    v_lshlrev_b32 v17, 16, v17
    v_add_f32 v17, 0x3727c5ac, v17
    v_cvt_pk_bf16_f32 v17, v17, v17
    v_lshlrev_b32 v17, 16, v17
    v_sqrt_f32 v129, v17
    s_nop 0
    v_cvt_pk_bf16_f32 v129, v129, v129
    v_lshlrev_b32 v129, 16, v129
    v_rcp_f32 v130, v129
    s_lshl_b32 s16, s3, 4
    s_add_u32 s16, s16, 67600
    v_mov_b32 v19, s16
    ds_write_b128 v19, v[128:131]
    s_waitcnt vmcnt(4)
    v_cmp_eq_u32 vcc, 0, v134
    s_cmp_eq_u32 s3, 0
    s_cselect_b64 s[62:63], -1, 0
    s_and_b64 vcc, vcc, s[62:63]
    s_cbranch_vccnz adaLN_cond__sliding_block_cached__moe_arch_mod__prompt_kernel_n1r
adaLN_cond__sliding_block_cached__moe_arch_mod__prompt_kernel_n1b:
    v_mov_b32 v19, 67584
    s_cmp_eq_u32 s3, 0
    s_cselect_b64 exec, 1, 0
    ds_write_b32 v19, v134
    s_mov_b64 exec, -1
    v_mov_b32 v19, 67584
    v_and_b32 v17, 31, v1
    v_lshlrev_b32 v18, 3, v17
    v_add_u32 v18, 65536, v18
    v_lshlrev_b32 v17, 4, v17
    s_waitcnt lgkmcnt(0)
    s_barrier
    ds_read_b32 v134, v19
    ds_read_b64 v[96:97], v18 offset:0
    ds_read_b64 v[100:101], v18 offset:256
    ds_read_b64 v[104:105], v18 offset:512
    ds_read_b64 v[108:109], v18 offset:768
    ds_read_b64 v[112:113], v18 offset:1024
    ds_read_b64 v[116:117], v18 offset:1280
    ds_read_b64 v[120:121], v18 offset:1536
    ds_read_b64 v[124:125], v18 offset:1792
    s_waitcnt lgkmcnt(8)
    v_readfirstlane_b32 s28, v134
    v_and_b32 v20, 7, v1
    v_lshlrev_b32 v20, 4, v20
    v_add_u32 v21, 67600, v20
    ds_read_b128 v[128:131], v21
    s_waitcnt lgkmcnt(0)
    v_mov_b32 v131, s28
    s_lshl_b32 s16, s2, 7
    s_add_u32 s16, s16, 0x520000
    s_cmp_eq_u32 s3, 0
    s_cselect_b32 s16, s16, 0x7ffffff0
    s_mov_b64 exec, 0xff
    buffer_store_dwordx4 v[128:131], v20, s[8:11], s16 offen sc1
    s_mov_b64 exec, -1
    v_pk_add_f32 v[96:97], v[96:97], v[112:113]
    v_pk_add_f32 v[100:101], v[100:101], v[116:117]
    v_pk_add_f32 v[104:105], v[104:105], v[120:121]
    v_pk_add_f32 v[108:109], v[108:109], v[124:125]
    v_pk_add_f32 v[96:97], v[96:97], v[104:105]
    v_pk_add_f32 v[100:101], v[100:101], v[108:109]
    v_pk_add_f32 v[96:97], v[96:97], v[100:101]
    v_mov_b32 v98, s28
    v_mov_b32 v99, s28
    s_lshl_b32 s16, s14, 3
    s_add_u32 s16, s16, s15
    s_lshl_b32 s16, s16, 9
    s_add_u32 s16, s16, 0x500000
    s_cmp_eq_u32 s3, 0
    s_cselect_b32 s16, s16, 0x7ffffff0
    s_mov_b64 exec, 0xffffffff
    buffer_store_dwordx4 v[96:99], v17, s[8:11], s16 offen sc1
    s_mov_b64 exec, -1
    s_lshr_b32 s16, s3, 2
    s_lshl_b32 s16, s16, 4
    s_add_u32 s16, s16, s31
    s_lshl_b32 s16, s16, 12
    s_and_b32 s17, s3, 3
    s_lshl_b32 s17, s17, 7
    s_add_u32 s16, s16, s17
    s_add_u32 s16, s16, 0x500000
    v_lshrrev_b32 v139, 3, v1
    v_lshlrev_b32 v139, 9, v139
    v_and_b32 v16, 7, v1
    v_lshl_add_u32 v139, v16, 4, v139
    v_and_b32 v140, 15, v1
    v_lshlrev_b32 v140, 4, v140
    s_lshl_b32 s17, s29, 8
    s_add_u32 s17, s17, 0x520000
    s_waitcnt vmcnt(4)
    v_lshlrev_b32 v56, 16, v40
    v_and_b32 v57, 0xffff0000, v40
    v_lshlrev_b32 v58, 16, v41
    v_and_b32 v59, 0xffff0000, v41
    v_lshlrev_b32 v60, 16, v42
    v_and_b32 v61, 0xffff0000, v42
    v_lshlrev_b32 v62, 16, v43
    v_and_b32 v63, 0xffff0000, v43
    s_waitcnt vmcnt(3)
    v_lshlrev_b32 v64, 16, v44
    v_and_b32 v65, 0xffff0000, v44
    v_lshlrev_b32 v66, 16, v45
    v_and_b32 v67, 0xffff0000, v45
    v_lshlrev_b32 v68, 16, v46
    v_and_b32 v69, 0xffff0000, v46
    v_lshlrev_b32 v70, 16, v47
    v_and_b32 v71, 0xffff0000, v47
    s_mov_b32 s27, 0
adaLN_cond__sliding_block_cached__moe_arch_mod__prompt_kernel_g2p:
    buffer_load_dwordx4 v[76:79], v139, s[8:11], s16 offen sc1
    buffer_load_dwordx4 v[80:83], v140, s[8:11], s17 offen sc1
    s_waitcnt vmcnt(1)
    v_cmp_ne_u32 vcc, s28, v78
    v_cmp_ne_u32 s[62:63], s28, v79
    s_or_b64 vcc, vcc, s[62:63]
    s_waitcnt vmcnt(0)
    v_cmp_ne_u32 s[62:63], s28, v83
    s_or_b64 vcc, vcc, s[62:63]
    s_add_u32 s27, s27, 1
    s_cmp_ge_u32 s27, 65536
    s_cbranch_scc1 adaLN_cond__sliding_block_cached__moe_arch_mod__prompt_kernel_g2g
    s_cbranch_vccnz adaLN_cond__sliding_block_cached__moe_arch_mod__prompt_kernel_g2p
adaLN_cond__sliding_block_cached__moe_arch_mod__prompt_kernel_g2g:
    v_add_f32_dpp v76, v76, v76 row_ror:8 row_mask:0xf bank_mask:0xf
    v_add_f32_dpp v77, v77, v77 row_ror:8 row_mask:0xf bank_mask:0xf
    v_mov_b32 v17, v76
    s_nop 1
    v_permlane16_swap_b32 v76, v17
    v_add_f32 v76, v76, v17
    v_mov_b32 v18, v77
    s_nop 1
    v_permlane16_swap_b32 v77, v18
    v_add_f32 v77, v77, v18
    v_mov_b32 v17, v76
    s_nop 1
    v_permlane32_swap_b32 v76, v17
    v_add_f32 v76, v76, v17
    v_mov_b32 v18, v77
    s_nop 1
    v_permlane32_swap_b32 v77, v18
    v_add_f32 v77, v77, v18
    v_cvt_pk_bf16_f32 v17, v76, v77
    v_lshlrev_b32 v76, 16, v17
    v_and_b32 v77, 0xffff0000, v17
    v_add_f32 v76, 0, v76
    v_add_f32 v77, 0, v77
    s_lshl_b32 s16, s3, 6
    s_add_u32 s16, s16, 69632
    v_lshl_add_u32 v16, v16, 3, s16
    ds_write_b64 v16, v[76:77]
    v_lshrrev_b32 v17, 4, v1
    v_lshlrev_b32 v17, 5, v17
    v_add_u32 v17, 69632, v17
    v_sub_f32 v56, v56, v80
    v_sub_f32 v57, v57, v80
    v_sub_f32 v58, v58, v80
    v_sub_f32 v59, v59, v80
    v_sub_f32 v60, v60, v80
    v_sub_f32 v61, v61, v80
    v_sub_f32 v62, v62, v80
    v_sub_f32 v63, v63, v80
    v_sub_f32 v64, v64, v80
    v_sub_f32 v65, v65, v80
    v_sub_f32 v66, v66, v80
    v_sub_f32 v67, v67, v80
    v_sub_f32 v68, v68, v80
    v_sub_f32 v69, v69, v80
    v_sub_f32 v70, v70, v80
    v_sub_f32 v71, v71, v80
    v_cvt_pk_bf16_f32 v18, v56, v57
    v_lshlrev_b32 v56, 16, v18
    v_and_b32 v57, 0xffff0000, v18
    v_cvt_pk_bf16_f32 v19, v58, v59
    v_lshlrev_b32 v58, 16, v19
    v_and_b32 v59, 0xffff0000, v19
    v_cvt_pk_bf16_f32 v18, v60, v61
    v_lshlrev_b32 v60, 16, v18
    v_and_b32 v61, 0xffff0000, v18
    v_cvt_pk_bf16_f32 v19, v62, v63
    v_lshlrev_b32 v62, 16, v19
    v_and_b32 v63, 0xffff0000, v19
    v_cvt_pk_bf16_f32 v18, v64, v65
    v_lshlrev_b32 v64, 16, v18
    v_and_b32 v65, 0xffff0000, v18
    v_cvt_pk_bf16_f32 v19, v66, v67
    v_lshlrev_b32 v66, 16, v19
    v_and_b32 v67, 0xffff0000, v19
    v_cvt_pk_bf16_f32 v18, v68, v69
    v_lshlrev_b32 v68, 16, v18
    v_and_b32 v69, 0xffff0000, v18
    v_cvt_pk_bf16_f32 v19, v70, v71
    v_lshlrev_b32 v70, 16, v19
    v_and_b32 v71, 0xffff0000, v19
    v_mul_f32 v56, v56, v82
    v_mul_f32 v57, v57, v82
    v_mul_f32 v58, v58, v82
    v_mul_f32 v59, v59, v82
    v_mul_f32 v60, v60, v82
    v_mul_f32 v61, v61, v82
    v_mul_f32 v62, v62, v82
    v_mul_f32 v63, v63, v82
    v_mul_f32 v64, v64, v82
    v_mul_f32 v65, v65, v82
    v_mul_f32 v66, v66, v82
    v_mul_f32 v67, v67, v82
    v_mul_f32 v68, v68, v82
    v_mul_f32 v69, v69, v82
    v_mul_f32 v70, v70, v82
    v_mul_f32 v71, v71, v82
    v_cvt_pk_bf16_f32 v18, v56, v57
    v_lshlrev_b32 v56, 16, v18
    v_and_b32 v57, 0xffff0000, v18
    v_cvt_pk_bf16_f32 v19, v58, v59
    v_lshlrev_b32 v58, 16, v19
    v_and_b32 v59, 0xffff0000, v19
    v_cvt_pk_bf16_f32 v18, v60, v61
    v_lshlrev_b32 v60, 16, v18
    v_and_b32 v61, 0xffff0000, v18
    v_cvt_pk_bf16_f32 v19, v62, v63
    v_lshlrev_b32 v62, 16, v19
    v_and_b32 v63, 0xffff0000, v19
    v_cvt_pk_bf16_f32 v18, v64, v65
    v_lshlrev_b32 v64, 16, v18
    v_and_b32 v65, 0xffff0000, v18
    v_cvt_pk_bf16_f32 v19, v66, v67
    v_lshlrev_b32 v66, 16, v19
    v_and_b32 v67, 0xffff0000, v19
    v_cvt_pk_bf16_f32 v18, v68, v69
    v_lshlrev_b32 v68, 16, v18
    v_and_b32 v69, 0xffff0000, v18
    v_cvt_pk_bf16_f32 v19, v70, v71
    v_lshlrev_b32 v70, 16, v19
    v_and_b32 v71, 0xffff0000, v19
    s_lshl_b32 s16, s29, 15
    s_lshl_b32 s17, s31, 11
    s_add_u32 s16, s16, s17
    s_waitcnt lgkmcnt(0)
    s_barrier
    ds_read_b128 v[96:99], v17 offset:256
    ds_read_b128 v[104:107], v17 offset:0
    ds_read_b128 v[100:103], v17 offset:272
    ds_read_b128 v[108:111], v17 offset:16
    ds_read_b128 v[112:115], v17 offset:384
    ds_read_b128 v[120:123], v17 offset:128
    ds_read_b128 v[116:119], v17 offset:400
    ds_read_b128 v[124:127], v17 offset:144
    s_waitcnt lgkmcnt(7)
    v_pk_mul_f32 v[56:57], v[56:57], v[96:97]
    v_pk_mul_f32 v[58:59], v[58:59], v[98:99]
    s_waitcnt lgkmcnt(5)
    v_pk_mul_f32 v[60:61], v[60:61], v[100:101]
    v_pk_mul_f32 v[62:63], v[62:63], v[102:103]
    v_cvt_pk_bf16_f32 v18, v56, v57
    v_lshlrev_b32 v56, 16, v18
    v_and_b32 v57, 0xffff0000, v18
    v_cvt_pk_bf16_f32 v19, v58, v59
    v_lshlrev_b32 v58, 16, v19
    v_and_b32 v59, 0xffff0000, v19
    v_cvt_pk_bf16_f32 v18, v60, v61
    v_lshlrev_b32 v60, 16, v18
    v_and_b32 v61, 0xffff0000, v18
    v_cvt_pk_bf16_f32 v19, v62, v63
    v_lshlrev_b32 v62, 16, v19
    v_and_b32 v63, 0xffff0000, v19
    v_pk_add_f32 v[56:57], v[56:57], v[104:105]
    v_pk_add_f32 v[58:59], v[58:59], v[106:107]
    s_waitcnt lgkmcnt(4)
    v_pk_add_f32 v[60:61], v[60:61], v[108:109]
    v_pk_add_f32 v[62:63], v[62:63], v[110:111]
    v_cvt_pk_bf16_f32 v32, v56, v57
    v_cvt_pk_bf16_f32 v33, v58, v59
    v_cvt_pk_bf16_f32 v34, v60, v61
    v_cvt_pk_bf16_f32 v35, v62, v63
    buffer_store_dwordx4 v[32:35], v2, s[8:11], s16 offen offset:0 sc1
    s_waitcnt lgkmcnt(3)
    v_pk_mul_f32 v[64:65], v[64:65], v[112:113]
    v_pk_mul_f32 v[66:67], v[66:67], v[114:115]
    s_waitcnt lgkmcnt(1)
    v_pk_mul_f32 v[68:69], v[68:69], v[116:117]
    v_pk_mul_f32 v[70:71], v[70:71], v[118:119]
    v_cvt_pk_bf16_f32 v18, v64, v65
    v_lshlrev_b32 v64, 16, v18
    v_and_b32 v65, 0xffff0000, v18
    v_cvt_pk_bf16_f32 v19, v66, v67
    v_lshlrev_b32 v66, 16, v19
    v_and_b32 v67, 0xffff0000, v19
    v_cvt_pk_bf16_f32 v18, v68, v69
    v_lshlrev_b32 v68, 16, v18
    v_and_b32 v69, 0xffff0000, v18
    v_cvt_pk_bf16_f32 v19, v70, v71
    v_lshlrev_b32 v70, 16, v19
    v_and_b32 v71, 0xffff0000, v19
    v_pk_add_f32 v[64:65], v[64:65], v[120:121]
    v_pk_add_f32 v[66:67], v[66:67], v[122:123]
    s_waitcnt lgkmcnt(0)
    v_pk_add_f32 v[68:69], v[68:69], v[124:125]
    v_pk_add_f32 v[70:71], v[70:71], v[126:127]
    v_cvt_pk_bf16_f32 v36, v64, v65
    v_cvt_pk_bf16_f32 v37, v66, v67
    v_cvt_pk_bf16_f32 v38, v68, v69
    v_cvt_pk_bf16_f32 v39, v70, v71
    buffer_store_dwordx4 v[36:39], v2, s[8:11], s16 offen offset:1024 sc1
    s_lshl_b32 s19, s3, 16
    s_lshl_b32 s20, s3, 11
    s_lshl_b32 s16, s12, 8
    s_add_u32 s4, s38, s16
    s_addc_u32 s5, s39, 0
    s_sub_u32 s6, 0x800000, s16
    s_mov_b32 s7, 0x20000
    v_mov_b32 v134, s28
    s_lshl_b32 s16, s29, 4
    s_add_u32 s16, s16, s31
    s_lshl_b32 s16, s16, 2
    s_add_u32 s16, s16, 0x528000
    v_and_b32 v16, 31, v1
    v_lshlrev_b32 v16, 2, v16
    s_lshl_b32 s17, s13, 3
    s_add_u32 s17, s17, s3
    s_lshl_b32 s17, s17, 7
    s_add_u32 s17, s17, 0x528000
    s_waitcnt vmcnt(0)
    s_mov_b64 exec, 1
    buffer_store_dword v134, v132, s[8:11], s16 offen sc1
    s_mov_b64 exec, -1
    s_add_u32 s22, s19, 0x0
    s_add_u32 m0, s20, 0x0
    s_nop 0
    buffer_load_dwordx4 v3, s[4:7], s22 offen lds
    s_add_u32 s22, s19, 0x8000
    s_add_u32 m0, s20, 0x400
    s_nop 0
    buffer_load_dwordx4 v3, s[4:7], s22 offen lds
    s_add_u32 s22, s19, 0x80000
    s_add_u32 m0, s20, 0x4000
    s_nop 0
    buffer_load_dwordx4 v3, s[4:7], s22 offen lds
    s_add_u32 s22, s19, 0x88000
    s_add_u32 m0, s20, 0x4400
    s_nop 0
    buffer_load_dwordx4 v3, s[4:7], s22 offen lds
    s_add_u32 s22, s19, 0x100000
    s_add_u32 m0, s20, 0x8000
    s_nop 0
    buffer_load_dwordx4 v3, s[4:7], s22 offen lds
    s_add_u32 s22, s19, 0x108000
    s_add_u32 m0, s20, 0x8400
    s_nop 0
    buffer_load_dwordx4 v3, s[4:7], s22 offen lds
    s_sleep 40
    s_mov_b32 s27, 0
adaLN_cond__sliding_block_cached__moe_arch_mod__prompt_kernel_h3p:
    buffer_load_dword v17, v16, s[8:11], s17 offen sc1
    s_waitcnt vmcnt(0)
    v_cmp_ne_u32 vcc, s28, v17
    s_add_u32 s27, s27, 1
    s_cmp_ge_u32 s27, 65536
    s_cbranch_scc1 adaLN_cond__sliding_block_cached__moe_arch_mod__prompt_kernel_h3g
    s_cbranch_vccnz adaLN_cond__sliding_block_cached__moe_arch_mod__prompt_kernel_h3p
adaLN_cond__sliding_block_cached__moe_arch_mod__prompt_kernel_h3g:
    s_mov_b32 s23, 0x0
    buffer_load_dwordx4 v[88:91], v7, s[8:11], s23 offen offset:0 sc1
    s_mov_b32 s23, 0x8000
    buffer_load_dwordx4 v[92:95], v7, s[8:11], s23 offen offset:0 sc1
    s_mov_b32 s23, 0x0
    buffer_load_dwordx4 v[96:99], v7, s[8:11], s23 offen offset:1024 sc1
    s_mov_b32 s23, 0x8000
    buffer_load_dwordx4 v[100:103], v7, s[8:11], s23 offen offset:1024 sc1
    s_mov_b32 s23, 0x800
    buffer_load_dwordx4 v[104:107], v7, s[8:11], s23 offen offset:0 sc1
    s_mov_b32 s23, 0x8800
    buffer_load_dwordx4 v[108:111], v7, s[8:11], s23 offen offset:0 sc1
    s_mov_b32 s23, 0x800
    buffer_load_dwordx4 v[112:115], v7, s[8:11], s23 offen offset:1024 sc1
    s_mov_b32 s23, 0x8800
    buffer_load_dwordx4 v[116:119], v7, s[8:11], s23 offen offset:1024 sc1
    s_lshr_b32 s21, s12, 3
    s_lshl_b32 s21, s21, 17
    s_add_u32 s21, s21, s20
    s_add_u32 s21, s21, 0x400000
    s_barrier
    ds_read_b64_tr_b16 v[224:225], v4 offset:0
    ds_read_b64_tr_b16 v[226:227], v4 offset:1024
    ds_read_b64_tr_b16 v[228:229], v5 offset:32
    ds_read_b64_tr_b16 v[230:231], v5 offset:1056
    ds_read_b64_tr_b16 v[232:233], v4 offset:256
    ds_read_b64_tr_b16 v[234:235], v4 offset:1280
    ds_read_b64_tr_b16 v[236:237], v5 offset:288
    ds_read_b64_tr_b16 v[238:239], v5 offset:1312
    s_waitcnt vmcnt(7) lgkmcnt(6)
    v_mfma_f32_16x16x32_bf16 v[24:27], v[224:227], v[88:91], 0
    ds_read_b64_tr_b16 v[240:241], v4 offset:512
    s_waitcnt vmcnt(6)
    v_mfma_f32_16x16x32_bf16 v[28:31], v[224:227], v[92:95], 0
    ds_read_b64_tr_b16 v[242:243], v4 offset:1536
    s_waitcnt lgkmcnt(6)
    v_mfma_f32_16x16x32_bf16 v[32:35], v[228:231], v[88:91], 0
    ds_read_b64_tr_b16 v[244:245], v5 offset:544
    v_mfma_f32_16x16x32_bf16 v[36:39], v[228:231], v[92:95], 0
    ds_read_b64_tr_b16 v[246:247], v5 offset:1568
    s_mov_b32 s23, 0x1000
    buffer_load_dwordx4 v[120:123], v7, s[8:11], s23 offen offset:0 sc1
    s_waitcnt lgkmcnt(6)
    v_mfma_f32_16x16x32_bf16 v[40:43], v[232:235], v[88:91], 0
    ds_read_b64_tr_b16 v[224:225], v4 offset:768
    v_mfma_f32_16x16x32_bf16 v[44:47], v[232:235], v[92:95], 0
    ds_read_b64_tr_b16 v[226:227], v4 offset:1792
    s_waitcnt lgkmcnt(6)
    v_mfma_f32_16x16x32_bf16 v[48:51], v[236:239], v[88:91], 0
    ds_read_b64_tr_b16 v[228:229], v5 offset:800
    v_mfma_f32_16x16x32_bf16 v[52:55], v[236:239], v[92:95], 0
    ds_read_b64_tr_b16 v[230:231], v5 offset:1824
    s_waitcnt lgkmcnt(6)
    v_mfma_f32_16x16x32_bf16 v[56:59], v[240:243], v[88:91], 0
    ds_read_b64_tr_b16 v[232:233], v4 offset:8192
    v_mfma_f32_16x16x32_bf16 v[60:63], v[240:243], v[92:95], 0
    ds_read_b64_tr_b16 v[234:235], v4 offset:9216
    s_waitcnt lgkmcnt(6)
    v_mfma_f32_16x16x32_bf16 v[64:67], v[244:247], v[88:91], 0
    ds_read_b64_tr_b16 v[236:237], v5 offset:8224
    v_mfma_f32_16x16x32_bf16 v[68:71], v[244:247], v[92:95], 0
    ds_read_b64_tr_b16 v[238:239], v5 offset:9248
    s_mov_b32 s23, 0x9000
    buffer_load_dwordx4 v[124:127], v7, s[8:11], s23 offen offset:0 sc1
    s_waitcnt lgkmcnt(6)
    v_mfma_f32_16x16x32_bf16 v[72:75], v[224:227], v[88:91], 0
    ds_read_b64_tr_b16 v[240:241], v4 offset:8448
    v_mfma_f32_16x16x32_bf16 v[76:79], v[224:227], v[92:95], 0
    ds_read_b64_tr_b16 v[242:243], v4 offset:9472
    s_waitcnt lgkmcnt(6)
    v_mfma_f32_16x16x32_bf16 v[80:83], v[228:231], v[88:91], 0
    ds_read_b64_tr_b16 v[244:245], v5 offset:8480
    v_mfma_f32_16x16x32_bf16 v[84:87], v[228:231], v[92:95], 0
    ds_read_b64_tr_b16 v[246:247], v5 offset:9504
    s_waitcnt vmcnt(7) lgkmcnt(6)
    v_mfma_f32_16x16x32_bf16 v[24:27], v[232:235], v[96:99], v[24:27]
    ds_read_b64_tr_b16 v[224:225], v4 offset:8704
    s_waitcnt vmcnt(6)
    v_mfma_f32_16x16x32_bf16 v[28:31], v[232:235], v[100:103], v[28:31]
    ds_read_b64_tr_b16 v[226:227], v4 offset:9728
    s_waitcnt lgkmcnt(6)
    v_mfma_f32_16x16x32_bf16 v[32:35], v[236:239], v[96:99], v[32:35]
    ds_read_b64_tr_b16 v[228:229], v5 offset:8736
    v_mfma_f32_16x16x32_bf16 v[36:39], v[236:239], v[100:103], v[36:39]
    ds_read_b64_tr_b16 v[230:231], v5 offset:9760
    s_mov_b32 s23, 0x1000
    buffer_load_dwordx4 v[128:131], v7, s[8:11], s23 offen offset:1024 sc1
    s_waitcnt lgkmcnt(6)
    v_mfma_f32_16x16x32_bf16 v[40:43], v[240:243], v[96:99], v[40:43]
    ds_read_b64_tr_b16 v[232:233], v4 offset:8960
    v_mfma_f32_16x16x32_bf16 v[44:47], v[240:243], v[100:103], v[44:47]
    ds_read_b64_tr_b16 v[234:235], v4 offset:9984
    s_waitcnt lgkmcnt(6)
    v_mfma_f32_16x16x32_bf16 v[48:51], v[244:247], v[96:99], v[48:51]
    ds_read_b64_tr_b16 v[236:237], v5 offset:8992
    v_mfma_f32_16x16x32_bf16 v[52:55], v[244:247], v[100:103], v[52:55]
    ds_read_b64_tr_b16 v[238:239], v5 offset:10016
    s_waitcnt lgkmcnt(6)
    v_mfma_f32_16x16x32_bf16 v[56:59], v[224:227], v[96:99], v[56:59]
    v_mfma_f32_16x16x32_bf16 v[60:63], v[224:227], v[100:103], v[60:63]
    s_barrier
    ds_read_b64_tr_b16 v[240:241], v4 offset:16384
    ds_read_b64_tr_b16 v[242:243], v4 offset:17408
    s_waitcnt lgkmcnt(6)
    v_mfma_f32_16x16x32_bf16 v[64:67], v[228:231], v[96:99], v[64:67]
    ds_read_b64_tr_b16 v[244:245], v5 offset:16416
    v_mfma_f32_16x16x32_bf16 v[68:71], v[228:231], v[100:103], v[68:71]
    s_add_u32 s22, s19, 0x180000
    s_add_u32 m0, s20, 0xc000
    s_nop 0
    buffer_load_dwordx4 v3, s[4:7], s22 offen lds
    ds_read_b64_tr_b16 v[246:247], v5 offset:17440
    s_mov_b32 s23, 0x9000
    buffer_load_dwordx4 v[132:135], v7, s[8:11], s23 offen offset:1024 sc1
    s_waitcnt lgkmcnt(6)
    v_mfma_f32_16x16x32_bf16 v[72:75], v[232:235], v[96:99], v[72:75]
    ds_read_b64_tr_b16 v[224:225], v4 offset:16640
    v_mfma_f32_16x16x32_bf16 v[76:79], v[232:235], v[100:103], v[76:79]
    ds_read_b64_tr_b16 v[226:227], v4 offset:17664
    s_waitcnt lgkmcnt(6)
    v_mfma_f32_16x16x32_bf16 v[80:83], v[236:239], v[96:99], v[80:83]
    ds_read_b64_tr_b16 v[228:229], v5 offset:16672
    v_mfma_f32_16x16x32_bf16 v[84:87], v[236:239], v[100:103], v[84:87]
    ds_read_b64_tr_b16 v[230:231], v5 offset:17696
    s_waitcnt vmcnt(8) lgkmcnt(6)
    v_mfma_f32_16x16x32_bf16 v[24:27], v[240:243], v[104:107], v[24:27]
    ds_read_b64_tr_b16 v[232:233], v4 offset:16896
    s_waitcnt vmcnt(7)
    v_mfma_f32_16x16x32_bf16 v[28:31], v[240:243], v[108:111], v[28:31]
    ds_read_b64_tr_b16 v[234:235], v4 offset:17920
    s_waitcnt lgkmcnt(6)
    v_mfma_f32_16x16x32_bf16 v[32:35], v[244:247], v[104:107], v[32:35]
    ds_read_b64_tr_b16 v[236:237], v5 offset:16928
    v_mfma_f32_16x16x32_bf16 v[36:39], v[244:247], v[108:111], v[36:39]
    s_add_u32 s22, s19, 0x188000
    s_add_u32 m0, s20, 0xc400
    s_nop 0
    buffer_load_dwordx4 v3, s[4:7], s22 offen lds
    ds_read_b64_tr_b16 v[238:239], v5 offset:17952
    s_mov_b32 s23, 0x1800
    buffer_load_dwordx4 v[88:91], v7, s[8:11], s23 offen offset:0 sc1
    s_waitcnt lgkmcnt(6)
    v_mfma_f32_16x16x32_bf16 v[40:43], v[224:227], v[104:107], v[40:43]
    ds_read_b64_tr_b16 v[240:241], v4 offset:17152
    v_mfma_f32_16x16x32_bf16 v[44:47], v[224:227], v[108:111], v[44:47]
    ds_read_b64_tr_b16 v[242:243], v4 offset:18176
    s_waitcnt lgkmcnt(6)
    v_mfma_f32_16x16x32_bf16 v[48:51], v[228:231], v[104:107], v[48:51]
    ds_read_b64_tr_b16 v[244:245], v5 offset:17184
    v_mfma_f32_16x16x32_bf16 v[52:55], v[228:231], v[108:111], v[52:55]
    ds_read_b64_tr_b16 v[246:247], v5 offset:18208
    s_waitcnt lgkmcnt(6)
    v_mfma_f32_16x16x32_bf16 v[56:59], v[232:235], v[104:107], v[56:59]
    ds_read_b64_tr_b16 v[224:225], v4 offset:24576
    v_mfma_f32_16x16x32_bf16 v[60:63], v[232:235], v[108:111], v[60:63]
    ds_read_b64_tr_b16 v[226:227], v4 offset:25600
    s_waitcnt lgkmcnt(6)
    v_mfma_f32_16x16x32_bf16 v[64:67], v[236:239], v[104:107], v[64:67]
    ds_read_b64_tr_b16 v[228:229], v5 offset:24608
    v_mfma_f32_16x16x32_bf16 v[68:71], v[236:239], v[108:111], v[68:71]
    ds_read_b64_tr_b16 v[230:231], v5 offset:25632
    s_mov_b32 s23, 0x9800
    buffer_load_dwordx4 v[92:95], v7, s[8:11], s23 offen offset:0 sc1
    s_waitcnt lgkmcnt(6)
    v_mfma_f32_16x16x32_bf16 v[72:75], v[240:243], v[104:107], v[72:75]
    ds_read_b64_tr_b16 v[232:233], v4 offset:24832
    v_mfma_f32_16x16x32_bf16 v[76:79], v[240:243], v[108:111], v[76:79]
    ds_read_b64_tr_b16 v[234:235], v4 offset:25856
    s_waitcnt lgkmcnt(6)
    v_mfma_f32_16x16x32_bf16 v[80:83], v[244:247], v[104:107], v[80:83]
    ds_read_b64_tr_b16 v[236:237], v5 offset:24864
    v_mfma_f32_16x16x32_bf16 v[84:87], v[244:247], v[108:111], v[84:87]
    ds_read_b64_tr_b16 v[238:239], v5 offset:25888
    s_waitcnt vmcnt(9) lgkmcnt(6)
    v_mfma_f32_16x16x32_bf16 v[24:27], v[224:227], v[112:115], v[24:27]
    ds_read_b64_tr_b16 v[240:241], v4 offset:25088
    s_waitcnt vmcnt(8)
    v_mfma_f32_16x16x32_bf16 v[28:31], v[224:227], v[116:119], v[28:31]
    ds_read_b64_tr_b16 v[242:243], v4 offset:26112
    s_waitcnt lgkmcnt(6)
    v_mfma_f32_16x16x32_bf16 v[32:35], v[228:231], v[112:115], v[32:35]
    ds_read_b64_tr_b16 v[244:245], v5 offset:25120
    v_mfma_f32_16x16x32_bf16 v[36:39], v[228:231], v[116:119], v[36:39]
    ds_read_b64_tr_b16 v[246:247], v5 offset:26144
    s_mov_b32 s23, 0x1800
    buffer_load_dwordx4 v[96:99], v7, s[8:11], s23 offen offset:1024 sc1
    s_waitcnt lgkmcnt(6)
    v_mfma_f32_16x16x32_bf16 v[40:43], v[232:235], v[112:115], v[40:43]
    ds_read_b64_tr_b16 v[224:225], v4 offset:25344
    v_mfma_f32_16x16x32_bf16 v[44:47], v[232:235], v[116:119], v[44:47]
    ds_read_b64_tr_b16 v[226:227], v4 offset:26368
    s_waitcnt lgkmcnt(6)
    v_mfma_f32_16x16x32_bf16 v[48:51], v[236:239], v[112:115], v[48:51]
    ds_read_b64_tr_b16 v[228:229], v5 offset:25376
    v_mfma_f32_16x16x32_bf16 v[52:55], v[236:239], v[116:119], v[52:55]
    ds_read_b64_tr_b16 v[230:231], v5 offset:26400
    s_waitcnt lgkmcnt(6)
    v_mfma_f32_16x16x32_bf16 v[56:59], v[240:243], v[112:115], v[56:59]
    v_mfma_f32_16x16x32_bf16 v[60:63], v[240:243], v[116:119], v[60:63]
    s_barrier
    ds_read_b64_tr_b16 v[232:233], v4 offset:32768
    ds_read_b64_tr_b16 v[234:235], v4 offset:33792
    s_waitcnt lgkmcnt(6)
    v_mfma_f32_16x16x32_bf16 v[64:67], v[244:247], v[112:115], v[64:67]
    ds_read_b64_tr_b16 v[236:237], v5 offset:32800
    v_mfma_f32_16x16x32_bf16 v[68:71], v[244:247], v[116:119], v[68:71]
    s_add_u32 s22, s19, 0x200000
    s_add_u32 m0, s20, 0x0
    s_nop 0
    buffer_load_dwordx4 v3, s[4:7], s22 offen lds
    ds_read_b64_tr_b16 v[238:239], v5 offset:33824
    s_mov_b32 s23, 0x9800
    buffer_load_dwordx4 v[100:103], v7, s[8:11], s23 offen offset:1024 sc1
    s_waitcnt lgkmcnt(6)
    v_mfma_f32_16x16x32_bf16 v[72:75], v[224:227], v[112:115], v[72:75]
    ds_read_b64_tr_b16 v[240:241], v4 offset:33024
    v_mfma_f32_16x16x32_bf16 v[76:79], v[224:227], v[116:119], v[76:79]
    ds_read_b64_tr_b16 v[242:243], v4 offset:34048
    s_waitcnt lgkmcnt(6)
    v_mfma_f32_16x16x32_bf16 v[80:83], v[228:231], v[112:115], v[80:83]
    ds_read_b64_tr_b16 v[244:245], v5 offset:33056
    v_mfma_f32_16x16x32_bf16 v[84:87], v[228:231], v[116:119], v[84:87]
    ds_read_b64_tr_b16 v[246:247], v5 offset:34080
    s_waitcnt vmcnt(10) lgkmcnt(6)
    v_mfma_f32_16x16x32_bf16 v[24:27], v[232:235], v[120:123], v[24:27]
    ds_read_b64_tr_b16 v[224:225], v4 offset:33280
    s_waitcnt vmcnt(9)
    v_mfma_f32_16x16x32_bf16 v[28:31], v[232:235], v[124:127], v[28:31]
    ds_read_b64_tr_b16 v[226:227], v4 offset:34304
    s_waitcnt lgkmcnt(6)
    v_mfma_f32_16x16x32_bf16 v[32:35], v[236:239], v[120:123], v[32:35]
    ds_read_b64_tr_b16 v[228:229], v5 offset:33312
    v_mfma_f32_16x16x32_bf16 v[36:39], v[236:239], v[124:127], v[36:39]
    s_add_u32 s22, s19, 0x208000
    s_add_u32 m0, s20, 0x400
    s_nop 0
    buffer_load_dwordx4 v3, s[4:7], s22 offen lds
    ds_read_b64_tr_b16 v[230:231], v5 offset:34336
    s_mov_b32 s23, 0x2000
    buffer_load_dwordx4 v[104:107], v7, s[8:11], s23 offen offset:0 sc1
    s_waitcnt lgkmcnt(6)
    v_mfma_f32_16x16x32_bf16 v[40:43], v[240:243], v[120:123], v[40:43]
    ds_read_b64_tr_b16 v[232:233], v4 offset:33536
    v_mfma_f32_16x16x32_bf16 v[44:47], v[240:243], v[124:127], v[44:47]
    ds_read_b64_tr_b16 v[234:235], v4 offset:34560
    s_waitcnt lgkmcnt(6)
    v_mfma_f32_16x16x32_bf16 v[48:51], v[244:247], v[120:123], v[48:51]
    ds_read_b64_tr_b16 v[236:237], v5 offset:33568
    v_mfma_f32_16x16x32_bf16 v[52:55], v[244:247], v[124:127], v[52:55]
    ds_read_b64_tr_b16 v[238:239], v5 offset:34592
    s_waitcnt lgkmcnt(6)
    v_mfma_f32_16x16x32_bf16 v[56:59], v[224:227], v[120:123], v[56:59]
    ds_read_b64_tr_b16 v[240:241], v4 offset:40960
    v_mfma_f32_16x16x32_bf16 v[60:63], v[224:227], v[124:127], v[60:63]
    ds_read_b64_tr_b16 v[242:243], v4 offset:41984
    s_waitcnt lgkmcnt(6)
    v_mfma_f32_16x16x32_bf16 v[64:67], v[228:231], v[120:123], v[64:67]
    ds_read_b64_tr_b16 v[244:245], v5 offset:40992
    v_mfma_f32_16x16x32_bf16 v[68:71], v[228:231], v[124:127], v[68:71]
    ds_read_b64_tr_b16 v[246:247], v5 offset:42016
    s_mov_b32 s23, 0xa000
    buffer_load_dwordx4 v[108:111], v7, s[8:11], s23 offen offset:0 sc1
    s_waitcnt lgkmcnt(6)
    v_mfma_f32_16x16x32_bf16 v[72:75], v[232:235], v[120:123], v[72:75]
    ds_read_b64_tr_b16 v[224:225], v4 offset:41216
    v_mfma_f32_16x16x32_bf16 v[76:79], v[232:235], v[124:127], v[76:79]
    ds_read_b64_tr_b16 v[226:227], v4 offset:42240
    s_waitcnt lgkmcnt(6)
    v_mfma_f32_16x16x32_bf16 v[80:83], v[236:239], v[120:123], v[80:83]
    ds_read_b64_tr_b16 v[228:229], v5 offset:41248
    v_mfma_f32_16x16x32_bf16 v[84:87], v[236:239], v[124:127], v[84:87]
    ds_read_b64_tr_b16 v[230:231], v5 offset:42272
    s_waitcnt vmcnt(11) lgkmcnt(6)
    v_mfma_f32_16x16x32_bf16 v[24:27], v[240:243], v[128:131], v[24:27]
    ds_read_b64_tr_b16 v[232:233], v4 offset:41472
    s_waitcnt vmcnt(9)
    v_mfma_f32_16x16x32_bf16 v[28:31], v[240:243], v[132:135], v[28:31]
    ds_read_b64_tr_b16 v[234:235], v4 offset:42496
    s_waitcnt lgkmcnt(6)
    v_mfma_f32_16x16x32_bf16 v[32:35], v[244:247], v[128:131], v[32:35]
    ds_read_b64_tr_b16 v[236:237], v5 offset:41504
    v_mfma_f32_16x16x32_bf16 v[36:39], v[244:247], v[132:135], v[36:39]
    ds_read_b64_tr_b16 v[238:239], v5 offset:42528
    s_mov_b32 s23, 0x2000
    buffer_load_dwordx4 v[112:115], v7, s[8:11], s23 offen offset:1024 sc1
    s_waitcnt lgkmcnt(6)
    v_mfma_f32_16x16x32_bf16 v[40:43], v[224:227], v[128:131], v[40:43]
    ds_read_b64_tr_b16 v[240:241], v4 offset:41728
    v_mfma_f32_16x16x32_bf16 v[44:47], v[224:227], v[132:135], v[44:47]
    ds_read_b64_tr_b16 v[242:243], v4 offset:42752
    s_waitcnt lgkmcnt(6)
    v_mfma_f32_16x16x32_bf16 v[48:51], v[228:231], v[128:131], v[48:51]
    ds_read_b64_tr_b16 v[244:245], v5 offset:41760
    v_mfma_f32_16x16x32_bf16 v[52:55], v[228:231], v[132:135], v[52:55]
    ds_read_b64_tr_b16 v[246:247], v5 offset:42784
    s_waitcnt lgkmcnt(6)
    v_mfma_f32_16x16x32_bf16 v[56:59], v[232:235], v[128:131], v[56:59]
    v_mfma_f32_16x16x32_bf16 v[60:63], v[232:235], v[132:135], v[60:63]
    s_waitcnt vmcnt(9)
    s_barrier
    ds_read_b64_tr_b16 v[224:225], v4 offset:49152
    ds_read_b64_tr_b16 v[226:227], v4 offset:50176
    s_waitcnt lgkmcnt(6)
    v_mfma_f32_16x16x32_bf16 v[64:67], v[236:239], v[128:131], v[64:67]
    ds_read_b64_tr_b16 v[228:229], v5 offset:49184
    v_mfma_f32_16x16x32_bf16 v[68:71], v[236:239], v[132:135], v[68:71]
    s_add_u32 s22, s19, 0x280000
    s_add_u32 m0, s20, 0x4000
    s_nop 0
    buffer_load_dwordx4 v3, s[4:7], s22 offen lds
    ds_read_b64_tr_b16 v[230:231], v5 offset:50208
    s_mov_b32 s23, 0xa000
    buffer_load_dwordx4 v[116:119], v7, s[8:11], s23 offen offset:1024 sc1
    s_waitcnt lgkmcnt(6)
    v_mfma_f32_16x16x32_bf16 v[72:75], v[240:243], v[128:131], v[72:75]
    ds_read_b64_tr_b16 v[232:233], v4 offset:49408
    v_mfma_f32_16x16x32_bf16 v[76:79], v[240:243], v[132:135], v[76:79]
    ds_read_b64_tr_b16 v[234:235], v4 offset:50432
    s_waitcnt lgkmcnt(6)
    v_mfma_f32_16x16x32_bf16 v[80:83], v[244:247], v[128:131], v[80:83]
    ds_read_b64_tr_b16 v[236:237], v5 offset:49440
    v_mfma_f32_16x16x32_bf16 v[84:87], v[244:247], v[132:135], v[84:87]
    ds_read_b64_tr_b16 v[238:239], v5 offset:50464
    s_waitcnt vmcnt(10) lgkmcnt(6)
    v_mfma_f32_16x16x32_bf16 v[24:27], v[224:227], v[88:91], v[24:27]
    ds_read_b64_tr_b16 v[240:241], v4 offset:49664
    s_waitcnt vmcnt(9)
    v_mfma_f32_16x16x32_bf16 v[28:31], v[224:227], v[92:95], v[28:31]
    ds_read_b64_tr_b16 v[242:243], v4 offset:50688
    s_waitcnt lgkmcnt(6)
    v_mfma_f32_16x16x32_bf16 v[32:35], v[228:231], v[88:91], v[32:35]
    ds_read_b64_tr_b16 v[244:245], v5 offset:49696
    v_mfma_f32_16x16x32_bf16 v[36:39], v[228:231], v[92:95], v[36:39]
    s_add_u32 s22, s19, 0x288000
    s_add_u32 m0, s20, 0x4400
    s_nop 0
    buffer_load_dwordx4 v3, s[4:7], s22 offen lds
    ds_read_b64_tr_b16 v[246:247], v5 offset:50720
    s_mov_b32 s23, 0x2800
    buffer_load_dwordx4 v[120:123], v7, s[8:11], s23 offen offset:0 sc1
    s_waitcnt lgkmcnt(6)
    v_mfma_f32_16x16x32_bf16 v[40:43], v[232:235], v[88:91], v[40:43]
    ds_read_b64_tr_b16 v[224:225], v4 offset:49920
    v_mfma_f32_16x16x32_bf16 v[44:47], v[232:235], v[92:95], v[44:47]
    ds_read_b64_tr_b16 v[226:227], v4 offset:50944
    s_waitcnt lgkmcnt(6)
    v_mfma_f32_16x16x32_bf16 v[48:51], v[236:239], v[88:91], v[48:51]
    ds_read_b64_tr_b16 v[228:229], v5 offset:49952
    v_mfma_f32_16x16x32_bf16 v[52:55], v[236:239], v[92:95], v[52:55]
    ds_read_b64_tr_b16 v[230:231], v5 offset:50976
    s_waitcnt lgkmcnt(6)
    v_mfma_f32_16x16x32_bf16 v[56:59], v[240:243], v[88:91], v[56:59]
    ds_read_b64_tr_b16 v[232:233], v4 offset:57344
    v_mfma_f32_16x16x32_bf16 v[60:63], v[240:243], v[92:95], v[60:63]
    ds_read_b64_tr_b16 v[234:235], v4 offset:58368
    s_waitcnt lgkmcnt(6)
    v_mfma_f32_16x16x32_bf16 v[64:67], v[244:247], v[88:91], v[64:67]
    ds_read_b64_tr_b16 v[236:237], v5 offset:57376
    v_mfma_f32_16x16x32_bf16 v[68:71], v[244:247], v[92:95], v[68:71]
    ds_read_b64_tr_b16 v[238:239], v5 offset:58400
    s_mov_b32 s23, 0xa800
    buffer_load_dwordx4 v[124:127], v7, s[8:11], s23 offen offset:0 sc1
    s_waitcnt lgkmcnt(6)
    v_mfma_f32_16x16x32_bf16 v[72:75], v[224:227], v[88:91], v[72:75]
    ds_read_b64_tr_b16 v[240:241], v4 offset:57600
    v_mfma_f32_16x16x32_bf16 v[76:79], v[224:227], v[92:95], v[76:79]
    ds_read_b64_tr_b16 v[242:243], v4 offset:58624
    s_waitcnt lgkmcnt(6)
    v_mfma_f32_16x16x32_bf16 v[80:83], v[228:231], v[88:91], v[80:83]
    ds_read_b64_tr_b16 v[244:245], v5 offset:57632
    v_mfma_f32_16x16x32_bf16 v[84:87], v[228:231], v[92:95], v[84:87]
    ds_read_b64_tr_b16 v[246:247], v5 offset:58656
    s_waitcnt vmcnt(11) lgkmcnt(6)
    v_mfma_f32_16x16x32_bf16 v[24:27], v[232:235], v[96:99], v[24:27]
    ds_read_b64_tr_b16 v[224:225], v4 offset:57856
    s_waitcnt vmcnt(9)
    v_mfma_f32_16x16x32_bf16 v[28:31], v[232:235], v[100:103], v[28:31]
    ds_read_b64_tr_b16 v[226:227], v4 offset:58880
    s_waitcnt lgkmcnt(6)
    v_mfma_f32_16x16x32_bf16 v[32:35], v[236:239], v[96:99], v[32:35]
    ds_read_b64_tr_b16 v[228:229], v5 offset:57888
    v_mfma_f32_16x16x32_bf16 v[36:39], v[236:239], v[100:103], v[36:39]
    ds_read_b64_tr_b16 v[230:231], v5 offset:58912
    s_mov_b32 s23, 0x2800
    buffer_load_dwordx4 v[128:131], v7, s[8:11], s23 offen offset:1024 sc1
    s_waitcnt lgkmcnt(6)
    v_mfma_f32_16x16x32_bf16 v[40:43], v[240:243], v[96:99], v[40:43]
    ds_read_b64_tr_b16 v[232:233], v4 offset:58112
    v_mfma_f32_16x16x32_bf16 v[44:47], v[240:243], v[100:103], v[44:47]
    ds_read_b64_tr_b16 v[234:235], v4 offset:59136
    s_waitcnt lgkmcnt(6)
    v_mfma_f32_16x16x32_bf16 v[48:51], v[244:247], v[96:99], v[48:51]
    ds_read_b64_tr_b16 v[236:237], v5 offset:58144
    v_mfma_f32_16x16x32_bf16 v[52:55], v[244:247], v[100:103], v[52:55]
    ds_read_b64_tr_b16 v[238:239], v5 offset:59168
    s_waitcnt lgkmcnt(6)
    v_mfma_f32_16x16x32_bf16 v[56:59], v[224:227], v[96:99], v[56:59]
    v_mfma_f32_16x16x32_bf16 v[60:63], v[224:227], v[100:103], v[60:63]
    s_waitcnt vmcnt(9)
    s_barrier
    ds_read_b64_tr_b16 v[240:241], v4 offset:0
    ds_read_b64_tr_b16 v[242:243], v4 offset:1024
    s_waitcnt lgkmcnt(6)
    v_mfma_f32_16x16x32_bf16 v[64:67], v[228:231], v[96:99], v[64:67]
    ds_read_b64_tr_b16 v[244:245], v5 offset:32
    v_mfma_f32_16x16x32_bf16 v[68:71], v[228:231], v[100:103], v[68:71]
    s_add_u32 s22, s19, 0x300000
    s_add_u32 m0, s20, 0x8000
    s_nop 0
    buffer_load_dwordx4 v3, s[4:7], s22 offen lds
    ds_read_b64_tr_b16 v[246:247], v5 offset:1056
    s_mov_b32 s23, 0xa800
    buffer_load_dwordx4 v[132:135], v7, s[8:11], s23 offen offset:1024 sc1
    s_waitcnt lgkmcnt(6)
    v_mfma_f32_16x16x32_bf16 v[72:75], v[232:235], v[96:99], v[72:75]
    ds_read_b64_tr_b16 v[224:225], v4 offset:256
    v_mfma_f32_16x16x32_bf16 v[76:79], v[232:235], v[100:103], v[76:79]
    ds_read_b64_tr_b16 v[226:227], v4 offset:1280
    s_waitcnt lgkmcnt(6)
    v_mfma_f32_16x16x32_bf16 v[80:83], v[236:239], v[96:99], v[80:83]
    ds_read_b64_tr_b16 v[228:229], v5 offset:288
    v_mfma_f32_16x16x32_bf16 v[84:87], v[236:239], v[100:103], v[84:87]
    ds_read_b64_tr_b16 v[230:231], v5 offset:1312
    s_waitcnt vmcnt(10) lgkmcnt(6)
    v_mfma_f32_16x16x32_bf16 v[24:27], v[240:243], v[104:107], v[24:27]
    ds_read_b64_tr_b16 v[232:233], v4 offset:512
    s_waitcnt vmcnt(9)
    v_mfma_f32_16x16x32_bf16 v[28:31], v[240:243], v[108:111], v[28:31]
    ds_read_b64_tr_b16 v[234:235], v4 offset:1536
    s_waitcnt lgkmcnt(6)
    v_mfma_f32_16x16x32_bf16 v[32:35], v[244:247], v[104:107], v[32:35]
    ds_read_b64_tr_b16 v[236:237], v5 offset:544
    v_mfma_f32_16x16x32_bf16 v[36:39], v[244:247], v[108:111], v[36:39]
    s_add_u32 s22, s19, 0x308000
    s_add_u32 m0, s20, 0x8400
    s_nop 0
    buffer_load_dwordx4 v3, s[4:7], s22 offen lds
    ds_read_b64_tr_b16 v[238:239], v5 offset:1568
    s_mov_b32 s23, 0x3000
    buffer_load_dwordx4 v[88:91], v7, s[8:11], s23 offen offset:0 sc1
    s_waitcnt lgkmcnt(6)
    v_mfma_f32_16x16x32_bf16 v[40:43], v[224:227], v[104:107], v[40:43]
    ds_read_b64_tr_b16 v[240:241], v4 offset:768
    v_mfma_f32_16x16x32_bf16 v[44:47], v[224:227], v[108:111], v[44:47]
    ds_read_b64_tr_b16 v[242:243], v4 offset:1792
    s_waitcnt lgkmcnt(6)
    v_mfma_f32_16x16x32_bf16 v[48:51], v[228:231], v[104:107], v[48:51]
    ds_read_b64_tr_b16 v[244:245], v5 offset:800
    v_mfma_f32_16x16x32_bf16 v[52:55], v[228:231], v[108:111], v[52:55]
    ds_read_b64_tr_b16 v[246:247], v5 offset:1824
    s_waitcnt lgkmcnt(6)
    v_mfma_f32_16x16x32_bf16 v[56:59], v[232:235], v[104:107], v[56:59]
    ds_read_b64_tr_b16 v[224:225], v4 offset:8192
    v_mfma_f32_16x16x32_bf16 v[60:63], v[232:235], v[108:111], v[60:63]
    ds_read_b64_tr_b16 v[226:227], v4 offset:9216
    s_waitcnt lgkmcnt(6)
    v_mfma_f32_16x16x32_bf16 v[64:67], v[236:239], v[104:107], v[64:67]
    ds_read_b64_tr_b16 v[228:229], v5 offset:8224
    v_mfma_f32_16x16x32_bf16 v[68:71], v[236:239], v[108:111], v[68:71]
    ds_read_b64_tr_b16 v[230:231], v5 offset:9248
    s_mov_b32 s23, 0xb000
    buffer_load_dwordx4 v[92:95], v7, s[8:11], s23 offen offset:0 sc1
    s_waitcnt lgkmcnt(6)
    v_mfma_f32_16x16x32_bf16 v[72:75], v[240:243], v[104:107], v[72:75]
    ds_read_b64_tr_b16 v[232:233], v4 offset:8448
    v_mfma_f32_16x16x32_bf16 v[76:79], v[240:243], v[108:111], v[76:79]
    ds_read_b64_tr_b16 v[234:235], v4 offset:9472
    s_waitcnt lgkmcnt(6)
    v_mfma_f32_16x16x32_bf16 v[80:83], v[244:247], v[104:107], v[80:83]
    ds_read_b64_tr_b16 v[236:237], v5 offset:8480
    v_mfma_f32_16x16x32_bf16 v[84:87], v[244:247], v[108:111], v[84:87]
    ds_read_b64_tr_b16 v[238:239], v5 offset:9504
    s_waitcnt vmcnt(11) lgkmcnt(6)
    v_mfma_f32_16x16x32_bf16 v[24:27], v[224:227], v[112:115], v[24:27]
    ds_read_b64_tr_b16 v[240:241], v4 offset:8704
    s_waitcnt vmcnt(9)
    v_mfma_f32_16x16x32_bf16 v[28:31], v[224:227], v[116:119], v[28:31]
    ds_read_b64_tr_b16 v[242:243], v4 offset:9728
    s_waitcnt lgkmcnt(6)
    v_mfma_f32_16x16x32_bf16 v[32:35], v[228:231], v[112:115], v[32:35]
    ds_read_b64_tr_b16 v[244:245], v5 offset:8736
    v_mfma_f32_16x16x32_bf16 v[36:39], v[228:231], v[116:119], v[36:39]
    ds_read_b64_tr_b16 v[246:247], v5 offset:9760
    s_mov_b32 s23, 0x3000
    buffer_load_dwordx4 v[96:99], v7, s[8:11], s23 offen offset:1024 sc1
    s_waitcnt lgkmcnt(6)
    v_mfma_f32_16x16x32_bf16 v[40:43], v[232:235], v[112:115], v[40:43]
    ds_read_b64_tr_b16 v[224:225], v4 offset:8960
    v_mfma_f32_16x16x32_bf16 v[44:47], v[232:235], v[116:119], v[44:47]
    ds_read_b64_tr_b16 v[226:227], v4 offset:9984
    s_waitcnt lgkmcnt(6)
    v_mfma_f32_16x16x32_bf16 v[48:51], v[236:239], v[112:115], v[48:51]
    ds_read_b64_tr_b16 v[228:229], v5 offset:8992
    v_mfma_f32_16x16x32_bf16 v[52:55], v[236:239], v[116:119], v[52:55]
    ds_read_b64_tr_b16 v[230:231], v5 offset:10016
    s_waitcnt lgkmcnt(6)
    v_mfma_f32_16x16x32_bf16 v[56:59], v[240:243], v[112:115], v[56:59]
    v_mfma_f32_16x16x32_bf16 v[60:63], v[240:243], v[116:119], v[60:63]
    s_waitcnt vmcnt(9)
    s_barrier
    ds_read_b64_tr_b16 v[232:233], v4 offset:16384
    ds_read_b64_tr_b16 v[234:235], v4 offset:17408
    s_waitcnt lgkmcnt(6)
    v_mfma_f32_16x16x32_bf16 v[64:67], v[244:247], v[112:115], v[64:67]
    ds_read_b64_tr_b16 v[236:237], v5 offset:16416
    v_mfma_f32_16x16x32_bf16 v[68:71], v[244:247], v[116:119], v[68:71]
    s_add_u32 s22, s19, 0x380000
    s_add_u32 m0, s20, 0xc000
    s_nop 0
    buffer_load_dwordx4 v3, s[4:7], s22 offen lds
    ds_read_b64_tr_b16 v[238:239], v5 offset:17440
    s_mov_b32 s23, 0xb000
    buffer_load_dwordx4 v[100:103], v7, s[8:11], s23 offen offset:1024 sc1
    s_waitcnt lgkmcnt(6)
    v_mfma_f32_16x16x32_bf16 v[72:75], v[224:227], v[112:115], v[72:75]
    ds_read_b64_tr_b16 v[240:241], v4 offset:16640
    v_mfma_f32_16x16x32_bf16 v[76:79], v[224:227], v[116:119], v[76:79]
    ds_read_b64_tr_b16 v[242:243], v4 offset:17664
    s_waitcnt lgkmcnt(6)
    v_mfma_f32_16x16x32_bf16 v[80:83], v[228:231], v[112:115], v[80:83]
    ds_read_b64_tr_b16 v[244:245], v5 offset:16672
    v_mfma_f32_16x16x32_bf16 v[84:87], v[228:231], v[116:119], v[84:87]
    ds_read_b64_tr_b16 v[246:247], v5 offset:17696
    s_waitcnt vmcnt(10) lgkmcnt(6)
    v_mfma_f32_16x16x32_bf16 v[24:27], v[232:235], v[120:123], v[24:27]
    ds_read_b64_tr_b16 v[224:225], v4 offset:16896
    s_waitcnt vmcnt(9)
    v_mfma_f32_16x16x32_bf16 v[28:31], v[232:235], v[124:127], v[28:31]
    ds_read_b64_tr_b16 v[226:227], v4 offset:17920
    s_waitcnt lgkmcnt(6)
    v_mfma_f32_16x16x32_bf16 v[32:35], v[236:239], v[120:123], v[32:35]
    ds_read_b64_tr_b16 v[228:229], v5 offset:16928
    v_mfma_f32_16x16x32_bf16 v[36:39], v[236:239], v[124:127], v[36:39]
    s_add_u32 s22, s19, 0x388000
    s_add_u32 m0, s20, 0xc400
    s_nop 0
    buffer_load_dwordx4 v3, s[4:7], s22 offen lds
    ds_read_b64_tr_b16 v[230:231], v5 offset:17952
    s_mov_b32 s23, 0x3800
    buffer_load_dwordx4 v[104:107], v7, s[8:11], s23 offen offset:0 sc1
    s_waitcnt lgkmcnt(6)
    v_mfma_f32_16x16x32_bf16 v[40:43], v[240:243], v[120:123], v[40:43]
    ds_read_b64_tr_b16 v[232:233], v4 offset:17152
    v_mfma_f32_16x16x32_bf16 v[44:47], v[240:243], v[124:127], v[44:47]
    ds_read_b64_tr_b16 v[234:235], v4 offset:18176
    s_waitcnt lgkmcnt(6)
    v_mfma_f32_16x16x32_bf16 v[48:51], v[244:247], v[120:123], v[48:51]
    ds_read_b64_tr_b16 v[236:237], v5 offset:17184
    v_mfma_f32_16x16x32_bf16 v[52:55], v[244:247], v[124:127], v[52:55]
    ds_read_b64_tr_b16 v[238:239], v5 offset:18208
    s_waitcnt lgkmcnt(6)
    v_mfma_f32_16x16x32_bf16 v[56:59], v[224:227], v[120:123], v[56:59]
    ds_read_b64_tr_b16 v[240:241], v4 offset:24576
    v_mfma_f32_16x16x32_bf16 v[60:63], v[224:227], v[124:127], v[60:63]
    ds_read_b64_tr_b16 v[242:243], v4 offset:25600
    s_waitcnt lgkmcnt(6)
    v_mfma_f32_16x16x32_bf16 v[64:67], v[228:231], v[120:123], v[64:67]
    ds_read_b64_tr_b16 v[244:245], v5 offset:24608
    v_mfma_f32_16x16x32_bf16 v[68:71], v[228:231], v[124:127], v[68:71]
    ds_read_b64_tr_b16 v[246:247], v5 offset:25632
    s_mov_b32 s23, 0xb800
    buffer_load_dwordx4 v[108:111], v7, s[8:11], s23 offen offset:0 sc1
    s_waitcnt lgkmcnt(6)
    v_mfma_f32_16x16x32_bf16 v[72:75], v[232:235], v[120:123], v[72:75]
    ds_read_b64_tr_b16 v[224:225], v4 offset:24832
    v_mfma_f32_16x16x32_bf16 v[76:79], v[232:235], v[124:127], v[76:79]
    ds_read_b64_tr_b16 v[226:227], v4 offset:25856
    s_waitcnt lgkmcnt(6)
    v_mfma_f32_16x16x32_bf16 v[80:83], v[236:239], v[120:123], v[80:83]
    ds_read_b64_tr_b16 v[228:229], v5 offset:24864
    v_mfma_f32_16x16x32_bf16 v[84:87], v[236:239], v[124:127], v[84:87]
    ds_read_b64_tr_b16 v[230:231], v5 offset:25888
    s_waitcnt vmcnt(11) lgkmcnt(6)
    v_mfma_f32_16x16x32_bf16 v[24:27], v[240:243], v[128:131], v[24:27]
    ds_read_b64_tr_b16 v[232:233], v4 offset:25088
    s_waitcnt vmcnt(9)
    v_mfma_f32_16x16x32_bf16 v[28:31], v[240:243], v[132:135], v[28:31]
    ds_read_b64_tr_b16 v[234:235], v4 offset:26112
    s_waitcnt lgkmcnt(6)
    v_mfma_f32_16x16x32_bf16 v[32:35], v[244:247], v[128:131], v[32:35]
    ds_read_b64_tr_b16 v[236:237], v5 offset:25120
    v_mfma_f32_16x16x32_bf16 v[36:39], v[244:247], v[132:135], v[36:39]
    ds_read_b64_tr_b16 v[238:239], v5 offset:26144
    s_mov_b32 s23, 0x3800
    buffer_load_dwordx4 v[112:115], v7, s[8:11], s23 offen offset:1024 sc1
    s_waitcnt lgkmcnt(6)
    v_mfma_f32_16x16x32_bf16 v[40:43], v[224:227], v[128:131], v[40:43]
    ds_read_b64_tr_b16 v[240:241], v4 offset:25344
    v_mfma_f32_16x16x32_bf16 v[44:47], v[224:227], v[132:135], v[44:47]
    ds_read_b64_tr_b16 v[242:243], v4 offset:26368
    s_waitcnt lgkmcnt(6)
    v_mfma_f32_16x16x32_bf16 v[48:51], v[228:231], v[128:131], v[48:51]
    ds_read_b64_tr_b16 v[244:245], v5 offset:25376
    v_mfma_f32_16x16x32_bf16 v[52:55], v[228:231], v[132:135], v[52:55]
    ds_read_b64_tr_b16 v[246:247], v5 offset:26400
    s_waitcnt lgkmcnt(6)
    v_mfma_f32_16x16x32_bf16 v[56:59], v[232:235], v[128:131], v[56:59]
    v_mfma_f32_16x16x32_bf16 v[60:63], v[232:235], v[132:135], v[60:63]
    s_waitcnt vmcnt(9)
    s_barrier
    ds_read_b64_tr_b16 v[224:225], v4 offset:32768
    ds_read_b64_tr_b16 v[226:227], v4 offset:33792
    s_waitcnt lgkmcnt(6)
    v_mfma_f32_16x16x32_bf16 v[64:67], v[236:239], v[128:131], v[64:67]
    ds_read_b64_tr_b16 v[228:229], v5 offset:32800
    v_mfma_f32_16x16x32_bf16 v[68:71], v[236:239], v[132:135], v[68:71]
    s_add_u32 s22, s19, 0x400000
    s_add_u32 m0, s20, 0x0
    s_nop 0
    buffer_load_dwordx4 v3, s[4:7], s22 offen lds
    ds_read_b64_tr_b16 v[230:231], v5 offset:33824
    s_mov_b32 s23, 0xb800
    buffer_load_dwordx4 v[116:119], v7, s[8:11], s23 offen offset:1024 sc1
    s_waitcnt lgkmcnt(6)
    v_mfma_f32_16x16x32_bf16 v[72:75], v[240:243], v[128:131], v[72:75]
    ds_read_b64_tr_b16 v[232:233], v4 offset:33024
    v_mfma_f32_16x16x32_bf16 v[76:79], v[240:243], v[132:135], v[76:79]
    ds_read_b64_tr_b16 v[234:235], v4 offset:34048
    s_waitcnt lgkmcnt(6)
    v_mfma_f32_16x16x32_bf16 v[80:83], v[244:247], v[128:131], v[80:83]
    ds_read_b64_tr_b16 v[236:237], v5 offset:33056
    v_mfma_f32_16x16x32_bf16 v[84:87], v[244:247], v[132:135], v[84:87]
    ds_read_b64_tr_b16 v[238:239], v5 offset:34080
    s_waitcnt vmcnt(10) lgkmcnt(6)
    v_mfma_f32_16x16x32_bf16 v[24:27], v[224:227], v[88:91], v[24:27]
    ds_read_b64_tr_b16 v[240:241], v4 offset:33280
    s_waitcnt vmcnt(9)
    v_mfma_f32_16x16x32_bf16 v[28:31], v[224:227], v[92:95], v[28:31]
    ds_read_b64_tr_b16 v[242:243], v4 offset:34304
    s_waitcnt lgkmcnt(6)
    v_mfma_f32_16x16x32_bf16 v[32:35], v[228:231], v[88:91], v[32:35]
    ds_read_b64_tr_b16 v[244:245], v5 offset:33312
    v_mfma_f32_16x16x32_bf16 v[36:39], v[228:231], v[92:95], v[36:39]
    s_add_u32 s22, s19, 0x408000
    s_add_u32 m0, s20, 0x400
    s_nop 0
    buffer_load_dwordx4 v3, s[4:7], s22 offen lds
    ds_read_b64_tr_b16 v[246:247], v5 offset:34336
    s_mov_b32 s23, 0x4000
    buffer_load_dwordx4 v[120:123], v7, s[8:11], s23 offen offset:0 sc1
    s_waitcnt lgkmcnt(6)
    v_mfma_f32_16x16x32_bf16 v[40:43], v[232:235], v[88:91], v[40:43]
    ds_read_b64_tr_b16 v[224:225], v4 offset:33536
    v_mfma_f32_16x16x32_bf16 v[44:47], v[232:235], v[92:95], v[44:47]
    ds_read_b64_tr_b16 v[226:227], v4 offset:34560
    s_waitcnt lgkmcnt(6)
    v_mfma_f32_16x16x32_bf16 v[48:51], v[236:239], v[88:91], v[48:51]
    ds_read_b64_tr_b16 v[228:229], v5 offset:33568
    v_mfma_f32_16x16x32_bf16 v[52:55], v[236:239], v[92:95], v[52:55]
    ds_read_b64_tr_b16 v[230:231], v5 offset:34592
    s_waitcnt lgkmcnt(6)
    v_mfma_f32_16x16x32_bf16 v[56:59], v[240:243], v[88:91], v[56:59]
    ds_read_b64_tr_b16 v[232:233], v4 offset:40960
    v_mfma_f32_16x16x32_bf16 v[60:63], v[240:243], v[92:95], v[60:63]
    ds_read_b64_tr_b16 v[234:235], v4 offset:41984
    s_waitcnt lgkmcnt(6)
    v_mfma_f32_16x16x32_bf16 v[64:67], v[244:247], v[88:91], v[64:67]
    ds_read_b64_tr_b16 v[236:237], v5 offset:40992
    v_mfma_f32_16x16x32_bf16 v[68:71], v[244:247], v[92:95], v[68:71]
    ds_read_b64_tr_b16 v[238:239], v5 offset:42016
    s_mov_b32 s23, 0xc000
    buffer_load_dwordx4 v[124:127], v7, s[8:11], s23 offen offset:0 sc1
    s_waitcnt lgkmcnt(6)
    v_mfma_f32_16x16x32_bf16 v[72:75], v[224:227], v[88:91], v[72:75]
    ds_read_b64_tr_b16 v[240:241], v4 offset:41216
    v_lshrrev_b32 v21, 4, v1
    v_lshlrev_b32 v21, 9, v21
    v_and_b32 v20, 15, v1
    v_lshl_add_u32 v21, v20, 4, v21
    s_lshr_b32 s18, s12, 3
    s_lshl_b32 s18, s18, 11
    s_add_u32 s18, s18, 0x528100
    buffer_load_dwordx4 v[12:15], v21, s[8:11], s18 offen sc1
    v_mfma_f32_16x16x32_bf16 v[76:79], v[224:227], v[92:95], v[76:79]
    ds_read_b64_tr_b16 v[242:243], v4 offset:42240
    s_waitcnt lgkmcnt(6)
    v_mfma_f32_16x16x32_bf16 v[80:83], v[228:231], v[88:91], v[80:83]
    ds_read_b64_tr_b16 v[244:245], v5 offset:41248
    v_mfma_f32_16x16x32_bf16 v[84:87], v[228:231], v[92:95], v[84:87]
    ds_read_b64_tr_b16 v[246:247], v5 offset:42272
    s_waitcnt vmcnt(12) lgkmcnt(6)
    v_mfma_f32_16x16x32_bf16 v[24:27], v[232:235], v[96:99], v[24:27]
    ds_read_b64_tr_b16 v[224:225], v4 offset:41472
    s_waitcnt vmcnt(10)
    v_mfma_f32_16x16x32_bf16 v[28:31], v[232:235], v[100:103], v[28:31]
    ds_read_b64_tr_b16 v[226:227], v4 offset:42496
    s_waitcnt lgkmcnt(6)
    v_mfma_f32_16x16x32_bf16 v[32:35], v[236:239], v[96:99], v[32:35]
    ds_read_b64_tr_b16 v[228:229], v5 offset:41504
    v_mfma_f32_16x16x32_bf16 v[36:39], v[236:239], v[100:103], v[36:39]
    ds_read_b64_tr_b16 v[230:231], v5 offset:42528
    s_mov_b32 s23, 0x4000
    buffer_load_dwordx4 v[128:131], v7, s[8:11], s23 offen offset:1024 sc1
    s_waitcnt lgkmcnt(6)
    v_mfma_f32_16x16x32_bf16 v[40:43], v[240:243], v[96:99], v[40:43]
    ds_read_b64_tr_b16 v[232:233], v4 offset:41728
    v_mfma_f32_16x16x32_bf16 v[44:47], v[240:243], v[100:103], v[44:47]
    ds_read_b64_tr_b16 v[234:235], v4 offset:42752
    s_waitcnt lgkmcnt(6)
    v_mfma_f32_16x16x32_bf16 v[48:51], v[244:247], v[96:99], v[48:51]
    ds_read_b64_tr_b16 v[236:237], v5 offset:41760
    v_mfma_f32_16x16x32_bf16 v[52:55], v[244:247], v[100:103], v[52:55]
    ds_read_b64_tr_b16 v[238:239], v5 offset:42784
    s_waitcnt lgkmcnt(6)
    v_mfma_f32_16x16x32_bf16 v[56:59], v[224:227], v[96:99], v[56:59]
    v_mfma_f32_16x16x32_bf16 v[60:63], v[224:227], v[100:103], v[60:63]
    s_waitcnt vmcnt(10)
    s_barrier
    ds_read_b64_tr_b16 v[240:241], v4 offset:49152
    ds_read_b64_tr_b16 v[242:243], v4 offset:50176
    s_waitcnt lgkmcnt(6)
    v_mfma_f32_16x16x32_bf16 v[64:67], v[228:231], v[96:99], v[64:67]
    ds_read_b64_tr_b16 v[244:245], v5 offset:49184
    v_mfma_f32_16x16x32_bf16 v[68:71], v[228:231], v[100:103], v[68:71]
    s_add_u32 s22, s19, 0x480000
    s_add_u32 m0, s20, 0x4000
    s_nop 0
    buffer_load_dwordx4 v3, s[4:7], s22 offen lds
    ds_read_b64_tr_b16 v[246:247], v5 offset:50208
    s_mov_b32 s23, 0xc000
    buffer_load_dwordx4 v[132:135], v7, s[8:11], s23 offen offset:1024 sc1
    s_waitcnt lgkmcnt(6)
    v_mfma_f32_16x16x32_bf16 v[72:75], v[232:235], v[96:99], v[72:75]
    ds_read_b64_tr_b16 v[224:225], v4 offset:49408
    v_mfma_f32_16x16x32_bf16 v[76:79], v[232:235], v[100:103], v[76:79]
    ds_read_b64_tr_b16 v[226:227], v4 offset:50432
    s_waitcnt lgkmcnt(6)
    v_mfma_f32_16x16x32_bf16 v[80:83], v[236:239], v[96:99], v[80:83]
    ds_read_b64_tr_b16 v[228:229], v5 offset:49440
    v_mfma_f32_16x16x32_bf16 v[84:87], v[236:239], v[100:103], v[84:87]
    ds_read_b64_tr_b16 v[230:231], v5 offset:50464
    s_waitcnt vmcnt(11) lgkmcnt(6)
    v_mfma_f32_16x16x32_bf16 v[24:27], v[240:243], v[104:107], v[24:27]
    ds_read_b64_tr_b16 v[232:233], v4 offset:49664
    s_waitcnt vmcnt(10)
    v_mfma_f32_16x16x32_bf16 v[28:31], v[240:243], v[108:111], v[28:31]
    ds_read_b64_tr_b16 v[234:235], v4 offset:50688
    s_waitcnt lgkmcnt(6)
    v_mfma_f32_16x16x32_bf16 v[32:35], v[244:247], v[104:107], v[32:35]
    ds_read_b64_tr_b16 v[236:237], v5 offset:49696
    v_mfma_f32_16x16x32_bf16 v[36:39], v[244:247], v[108:111], v[36:39]
    s_add_u32 s22, s19, 0x488000
    s_add_u32 m0, s20, 0x4400
    s_nop 0
    buffer_load_dwordx4 v3, s[4:7], s22 offen lds
    ds_read_b64_tr_b16 v[238:239], v5 offset:50720
    s_mov_b32 s23, 0x4800
    buffer_load_dwordx4 v[88:91], v7, s[8:11], s23 offen offset:0 sc1
    s_waitcnt lgkmcnt(6)
    v_mfma_f32_16x16x32_bf16 v[40:43], v[224:227], v[104:107], v[40:43]
    ds_read_b64_tr_b16 v[240:241], v4 offset:49920
    v_mfma_f32_16x16x32_bf16 v[44:47], v[224:227], v[108:111], v[44:47]
    ds_read_b64_tr_b16 v[242:243], v4 offset:50944
    s_waitcnt lgkmcnt(6)
    v_mfma_f32_16x16x32_bf16 v[48:51], v[228:231], v[104:107], v[48:51]
    ds_read_b64_tr_b16 v[244:245], v5 offset:49952
    v_mfma_f32_16x16x32_bf16 v[52:55], v[228:231], v[108:111], v[52:55]
    ds_read_b64_tr_b16 v[246:247], v5 offset:50976
    s_waitcnt lgkmcnt(6)
    v_mfma_f32_16x16x32_bf16 v[56:59], v[232:235], v[104:107], v[56:59]
    ds_read_b64_tr_b16 v[224:225], v4 offset:57344
    v_mfma_f32_16x16x32_bf16 v[60:63], v[232:235], v[108:111], v[60:63]
    ds_read_b64_tr_b16 v[226:227], v4 offset:58368
    s_waitcnt lgkmcnt(6)
    v_mfma_f32_16x16x32_bf16 v[64:67], v[236:239], v[104:107], v[64:67]
    ds_read_b64_tr_b16 v[228:229], v5 offset:57376
    v_mfma_f32_16x16x32_bf16 v[68:71], v[236:239], v[108:111], v[68:71]
    ds_read_b64_tr_b16 v[230:231], v5 offset:58400
    s_mov_b32 s23, 0xc800
    buffer_load_dwordx4 v[92:95], v7, s[8:11], s23 offen offset:0 sc1
    s_waitcnt lgkmcnt(6)
    v_mfma_f32_16x16x32_bf16 v[72:75], v[240:243], v[104:107], v[72:75]
    ds_read_b64_tr_b16 v[232:233], v4 offset:57600
    v_mfma_f32_16x16x32_bf16 v[76:79], v[240:243], v[108:111], v[76:79]
    ds_read_b64_tr_b16 v[234:235], v4 offset:58624
    s_waitcnt lgkmcnt(6)
    v_mfma_f32_16x16x32_bf16 v[80:83], v[244:247], v[104:107], v[80:83]
    ds_read_b64_tr_b16 v[236:237], v5 offset:57632
    v_mfma_f32_16x16x32_bf16 v[84:87], v[244:247], v[108:111], v[84:87]
    ds_read_b64_tr_b16 v[238:239], v5 offset:58656
    s_waitcnt vmcnt(12) lgkmcnt(6)
    v_mfma_f32_16x16x32_bf16 v[24:27], v[224:227], v[112:115], v[24:27]
    ds_read_b64_tr_b16 v[240:241], v4 offset:57856
    s_waitcnt vmcnt(10)
    v_mfma_f32_16x16x32_bf16 v[28:31], v[224:227], v[116:119], v[28:31]
    ds_read_b64_tr_b16 v[242:243], v4 offset:58880
    s_waitcnt lgkmcnt(6)
    v_mfma_f32_16x16x32_bf16 v[32:35], v[228:231], v[112:115], v[32:35]
    ds_read_b64_tr_b16 v[244:245], v5 offset:57888
    v_mfma_f32_16x16x32_bf16 v[36:39], v[228:231], v[116:119], v[36:39]
    ds_read_b64_tr_b16 v[246:247], v5 offset:58912
    s_mov_b32 s23, 0x4800
    buffer_load_dwordx4 v[96:99], v7, s[8:11], s23 offen offset:1024 sc1
    s_waitcnt lgkmcnt(6)
    v_mfma_f32_16x16x32_bf16 v[40:43], v[232:235], v[112:115], v[40:43]
    ds_read_b64_tr_b16 v[224:225], v4 offset:58112
    v_mfma_f32_16x16x32_bf16 v[44:47], v[232:235], v[116:119], v[44:47]
    ds_read_b64_tr_b16 v[226:227], v4 offset:59136
    s_waitcnt lgkmcnt(6)
    v_mfma_f32_16x16x32_bf16 v[48:51], v[236:239], v[112:115], v[48:51]
    ds_read_b64_tr_b16 v[228:229], v5 offset:58144
    v_mfma_f32_16x16x32_bf16 v[52:55], v[236:239], v[116:119], v[52:55]
    ds_read_b64_tr_b16 v[230:231], v5 offset:59168
    s_waitcnt lgkmcnt(6)
    v_mfma_f32_16x16x32_bf16 v[56:59], v[240:243], v[112:115], v[56:59]
    v_mfma_f32_16x16x32_bf16 v[60:63], v[240:243], v[116:119], v[60:63]
    s_waitcnt vmcnt(10)
    s_barrier
    ds_read_b64_tr_b16 v[232:233], v4 offset:0
    ds_read_b64_tr_b16 v[234:235], v4 offset:1024
    s_waitcnt lgkmcnt(6)
    v_mfma_f32_16x16x32_bf16 v[64:67], v[244:247], v[112:115], v[64:67]
    ds_read_b64_tr_b16 v[236:237], v5 offset:32
    v_mfma_f32_16x16x32_bf16 v[68:71], v[244:247], v[116:119], v[68:71]
    s_add_u32 s22, s19, 0x500000
    s_add_u32 m0, s20, 0x8000
    s_nop 0
    buffer_load_dwordx4 v3, s[4:7], s22 offen lds
    ds_read_b64_tr_b16 v[238:239], v5 offset:1056
    s_mov_b32 s23, 0xc800
    buffer_load_dwordx4 v[100:103], v7, s[8:11], s23 offen offset:1024 sc1
    s_waitcnt lgkmcnt(6)
    v_mfma_f32_16x16x32_bf16 v[72:75], v[224:227], v[112:115], v[72:75]
    ds_read_b64_tr_b16 v[240:241], v4 offset:256
    v_mfma_f32_16x16x32_bf16 v[76:79], v[224:227], v[116:119], v[76:79]
    ds_read_b64_tr_b16 v[242:243], v4 offset:1280
    s_waitcnt lgkmcnt(6)
    v_mfma_f32_16x16x32_bf16 v[80:83], v[228:231], v[112:115], v[80:83]
    ds_read_b64_tr_b16 v[244:245], v5 offset:288
    v_mfma_f32_16x16x32_bf16 v[84:87], v[228:231], v[116:119], v[84:87]
    ds_read_b64_tr_b16 v[246:247], v5 offset:1312
    s_waitcnt vmcnt(11) lgkmcnt(6)
    v_mfma_f32_16x16x32_bf16 v[24:27], v[232:235], v[120:123], v[24:27]
    ds_read_b64_tr_b16 v[224:225], v4 offset:512
    s_waitcnt vmcnt(10)
    v_mfma_f32_16x16x32_bf16 v[28:31], v[232:235], v[124:127], v[28:31]
    ds_read_b64_tr_b16 v[226:227], v4 offset:1536
    s_waitcnt lgkmcnt(6)
    v_mfma_f32_16x16x32_bf16 v[32:35], v[236:239], v[120:123], v[32:35]
    ds_read_b64_tr_b16 v[228:229], v5 offset:544
    v_mfma_f32_16x16x32_bf16 v[36:39], v[236:239], v[124:127], v[36:39]
    s_add_u32 s22, s19, 0x508000
    s_add_u32 m0, s20, 0x8400
    s_nop 0
    buffer_load_dwordx4 v3, s[4:7], s22 offen lds
    ds_read_b64_tr_b16 v[230:231], v5 offset:1568
    s_mov_b32 s23, 0x5000
    buffer_load_dwordx4 v[104:107], v7, s[8:11], s23 offen offset:0 sc1
    s_waitcnt lgkmcnt(6)
    v_mfma_f32_16x16x32_bf16 v[40:43], v[240:243], v[120:123], v[40:43]
    ds_read_b64_tr_b16 v[232:233], v4 offset:768
    v_mfma_f32_16x16x32_bf16 v[44:47], v[240:243], v[124:127], v[44:47]
    ds_read_b64_tr_b16 v[234:235], v4 offset:1792
    s_waitcnt lgkmcnt(6)
    v_mfma_f32_16x16x32_bf16 v[48:51], v[244:247], v[120:123], v[48:51]
    ds_read_b64_tr_b16 v[236:237], v5 offset:800
    v_mfma_f32_16x16x32_bf16 v[52:55], v[244:247], v[124:127], v[52:55]
    ds_read_b64_tr_b16 v[238:239], v5 offset:1824
    s_waitcnt lgkmcnt(6)
    v_mfma_f32_16x16x32_bf16 v[56:59], v[224:227], v[120:123], v[56:59]
    ds_read_b64_tr_b16 v[240:241], v4 offset:8192
    v_mfma_f32_16x16x32_bf16 v[60:63], v[224:227], v[124:127], v[60:63]
    ds_read_b64_tr_b16 v[242:243], v4 offset:9216
    s_waitcnt lgkmcnt(6)
    v_mfma_f32_16x16x32_bf16 v[64:67], v[228:231], v[120:123], v[64:67]
    ds_read_b64_tr_b16 v[244:245], v5 offset:8224
    v_mfma_f32_16x16x32_bf16 v[68:71], v[228:231], v[124:127], v[68:71]
    ds_read_b64_tr_b16 v[246:247], v5 offset:9248
    s_mov_b32 s23, 0xd000
    buffer_load_dwordx4 v[108:111], v7, s[8:11], s23 offen offset:0 sc1
    s_waitcnt lgkmcnt(6)
    v_mfma_f32_16x16x32_bf16 v[72:75], v[232:235], v[120:123], v[72:75]
    ds_read_b64_tr_b16 v[224:225], v4 offset:8448
    v_mfma_f32_16x16x32_bf16 v[76:79], v[232:235], v[124:127], v[76:79]
    ds_read_b64_tr_b16 v[226:227], v4 offset:9472
    s_waitcnt lgkmcnt(6)
    v_mfma_f32_16x16x32_bf16 v[80:83], v[236:239], v[120:123], v[80:83]
    ds_read_b64_tr_b16 v[228:229], v5 offset:8480
    v_mfma_f32_16x16x32_bf16 v[84:87], v[236:239], v[124:127], v[84:87]
    ds_read_b64_tr_b16 v[230:231], v5 offset:9504
    s_waitcnt vmcnt(11) lgkmcnt(6)
    v_mfma_f32_16x16x32_bf16 v[24:27], v[240:243], v[128:131], v[24:27]
    ds_read_b64_tr_b16 v[232:233], v4 offset:8704
    s_waitcnt vmcnt(9)
    v_mfma_f32_16x16x32_bf16 v[28:31], v[240:243], v[132:135], v[28:31]
    ds_read_b64_tr_b16 v[234:235], v4 offset:9728
    s_waitcnt lgkmcnt(6)
    v_mfma_f32_16x16x32_bf16 v[32:35], v[244:247], v[128:131], v[32:35]
    ds_read_b64_tr_b16 v[236:237], v5 offset:8736
    v_mfma_f32_16x16x32_bf16 v[36:39], v[244:247], v[132:135], v[36:39]
    ds_read_b64_tr_b16 v[238:239], v5 offset:9760
    s_mov_b32 s23, 0x5000
    buffer_load_dwordx4 v[112:115], v7, s[8:11], s23 offen offset:1024 sc1
    s_waitcnt lgkmcnt(6)
    v_mfma_f32_16x16x32_bf16 v[40:43], v[224:227], v[128:131], v[40:43]
    ds_read_b64_tr_b16 v[240:241], v4 offset:8960
    v_mfma_f32_16x16x32_bf16 v[44:47], v[224:227], v[132:135], v[44:47]
    ds_read_b64_tr_b16 v[242:243], v4 offset:9984
    s_waitcnt lgkmcnt(6)
    v_mfma_f32_16x16x32_bf16 v[48:51], v[228:231], v[128:131], v[48:51]
    ds_read_b64_tr_b16 v[244:245], v5 offset:8992
    v_mfma_f32_16x16x32_bf16 v[52:55], v[228:231], v[132:135], v[52:55]
    ds_read_b64_tr_b16 v[246:247], v5 offset:10016
    s_waitcnt lgkmcnt(6)
    v_mfma_f32_16x16x32_bf16 v[56:59], v[232:235], v[128:131], v[56:59]
    v_mfma_f32_16x16x32_bf16 v[60:63], v[232:235], v[132:135], v[60:63]
    s_waitcnt vmcnt(9)
    s_barrier
    ds_read_b64_tr_b16 v[224:225], v4 offset:16384
    ds_read_b64_tr_b16 v[226:227], v4 offset:17408
    s_waitcnt lgkmcnt(6)
    v_mfma_f32_16x16x32_bf16 v[64:67], v[236:239], v[128:131], v[64:67]
    ds_read_b64_tr_b16 v[228:229], v5 offset:16416
    v_mfma_f32_16x16x32_bf16 v[68:71], v[236:239], v[132:135], v[68:71]
    s_add_u32 s22, s19, 0x580000
    s_add_u32 m0, s20, 0xc000
    s_nop 0
    buffer_load_dwordx4 v3, s[4:7], s22 offen lds
    ds_read_b64_tr_b16 v[230:231], v5 offset:17440
    s_mov_b32 s23, 0xd000
    buffer_load_dwordx4 v[116:119], v7, s[8:11], s23 offen offset:1024 sc1
    s_waitcnt lgkmcnt(6)
    v_mfma_f32_16x16x32_bf16 v[72:75], v[240:243], v[128:131], v[72:75]
    ds_read_b64_tr_b16 v[232:233], v4 offset:16640
    v_mfma_f32_16x16x32_bf16 v[76:79], v[240:243], v[132:135], v[76:79]
    ds_read_b64_tr_b16 v[234:235], v4 offset:17664
    s_waitcnt lgkmcnt(6)
    v_mfma_f32_16x16x32_bf16 v[80:83], v[244:247], v[128:131], v[80:83]
    ds_read_b64_tr_b16 v[236:237], v5 offset:16672
    v_mfma_f32_16x16x32_bf16 v[84:87], v[244:247], v[132:135], v[84:87]
    ds_read_b64_tr_b16 v[238:239], v5 offset:17696
    s_waitcnt vmcnt(10) lgkmcnt(6)
    v_mfma_f32_16x16x32_bf16 v[24:27], v[224:227], v[88:91], v[24:27]
    ds_read_b64_tr_b16 v[240:241], v4 offset:16896
    s_waitcnt vmcnt(9)
    v_mfma_f32_16x16x32_bf16 v[28:31], v[224:227], v[92:95], v[28:31]
    ds_read_b64_tr_b16 v[242:243], v4 offset:17920
    s_waitcnt lgkmcnt(6)
    v_mfma_f32_16x16x32_bf16 v[32:35], v[228:231], v[88:91], v[32:35]
    ds_read_b64_tr_b16 v[244:245], v5 offset:16928
    v_mfma_f32_16x16x32_bf16 v[36:39], v[228:231], v[92:95], v[36:39]
    s_add_u32 s22, s19, 0x588000
    s_add_u32 m0, s20, 0xc400
    s_nop 0
    buffer_load_dwordx4 v3, s[4:7], s22 offen lds
    ds_read_b64_tr_b16 v[246:247], v5 offset:17952
    s_mov_b32 s23, 0x5800
    buffer_load_dwordx4 v[120:123], v7, s[8:11], s23 offen offset:0 sc1
    s_waitcnt lgkmcnt(6)
    v_mfma_f32_16x16x32_bf16 v[40:43], v[232:235], v[88:91], v[40:43]
    ds_read_b64_tr_b16 v[224:225], v4 offset:17152
    v_mfma_f32_16x16x32_bf16 v[44:47], v[232:235], v[92:95], v[44:47]
    ds_read_b64_tr_b16 v[226:227], v4 offset:18176
    s_waitcnt lgkmcnt(6)
    v_mfma_f32_16x16x32_bf16 v[48:51], v[236:239], v[88:91], v[48:51]
    ds_read_b64_tr_b16 v[228:229], v5 offset:17184
    v_mfma_f32_16x16x32_bf16 v[52:55], v[236:239], v[92:95], v[52:55]
    ds_read_b64_tr_b16 v[230:231], v5 offset:18208
    s_waitcnt lgkmcnt(6)
    v_mfma_f32_16x16x32_bf16 v[56:59], v[240:243], v[88:91], v[56:59]
    ds_read_b64_tr_b16 v[232:233], v4 offset:24576
    v_mfma_f32_16x16x32_bf16 v[60:63], v[240:243], v[92:95], v[60:63]
    ds_read_b64_tr_b16 v[234:235], v4 offset:25600
    s_waitcnt lgkmcnt(6)
    v_mfma_f32_16x16x32_bf16 v[64:67], v[244:247], v[88:91], v[64:67]
    ds_read_b64_tr_b16 v[236:237], v5 offset:24608
    v_mfma_f32_16x16x32_bf16 v[68:71], v[244:247], v[92:95], v[68:71]
    ds_read_b64_tr_b16 v[238:239], v5 offset:25632
    s_mov_b32 s23, 0xd800
    buffer_load_dwordx4 v[124:127], v7, s[8:11], s23 offen offset:0 sc1
    s_waitcnt lgkmcnt(6)
    v_mfma_f32_16x16x32_bf16 v[72:75], v[224:227], v[88:91], v[72:75]
    ds_read_b64_tr_b16 v[240:241], v4 offset:24832
    v_xor_b32 v8, s28, v12
    v_xor_b32 v20, s28, v13
    v_or_b32 v8, v8, v20
    v_xor_b32 v20, s28, v14
    v_or_b32 v8, v8, v20
    v_xor_b32 v20, s28, v15
    v_or_b32 v8, v8, v20
    v_cmp_ne_u32 vcc, 0, v8
    s_cbranch_vccnz adaLN_cond__sliding_block_cached__moe_arch_mod__prompt_kernel_kv4r
adaLN_cond__sliding_block_cached__moe_arch_mod__prompt_kernel_kv4b:
    v_mfma_f32_16x16x32_bf16 v[76:79], v[224:227], v[92:95], v[76:79]
    ds_read_b64_tr_b16 v[242:243], v4 offset:25856
    v_mov_b32 v20, 0
    s_mov_b32 s16, 0x564000
    buffer_load_dword v8, v20, s[8:11], s16 offen sc1
    s_waitcnt lgkmcnt(6)
    v_mfma_f32_16x16x32_bf16 v[80:83], v[228:231], v[88:91], v[80:83]
    ds_read_b64_tr_b16 v[244:245], v5 offset:24864
    v_mfma_f32_16x16x32_bf16 v[84:87], v[228:231], v[92:95], v[84:87]
    ds_read_b64_tr_b16 v[246:247], v5 offset:25888
    s_waitcnt vmcnt(12) lgkmcnt(6)
    v_mfma_f32_16x16x32_bf16 v[24:27], v[232:235], v[96:99], v[24:27]
    ds_read_b64_tr_b16 v[224:225], v4 offset:25088
    s_waitcnt vmcnt(10)
    v_mfma_f32_16x16x32_bf16 v[28:31], v[232:235], v[100:103], v[28:31]
    ds_read_b64_tr_b16 v[226:227], v4 offset:26112
    s_waitcnt lgkmcnt(6)
    v_mfma_f32_16x16x32_bf16 v[32:35], v[236:239], v[96:99], v[32:35]
    ds_read_b64_tr_b16 v[228:229], v5 offset:25120
    v_mfma_f32_16x16x32_bf16 v[36:39], v[236:239], v[100:103], v[36:39]
    ds_read_b64_tr_b16 v[230:231], v5 offset:26144
    s_mov_b32 s23, 0x5800
    buffer_load_dwordx4 v[128:131], v7, s[8:11], s23 offen offset:1024 sc1
    s_waitcnt lgkmcnt(6)
    v_mfma_f32_16x16x32_bf16 v[40:43], v[240:243], v[96:99], v[40:43]
    ds_read_b64_tr_b16 v[232:233], v4 offset:25344
    s_mov_b64 s[76:77], s[54:55]
    s_mov_b32 s78, 0xc00000
    s_mov_b32 s79, 0x20000
    v_bfe_u32 v20, v1, 2, 2
    v_lshlrev_b32 v20, 12, v20
    v_add_u32 v6, v3, v20
    s_lshr_b32 s16, s2, 5
    s_lshl_b32 s16, s16, 7
    s_lshl_b32 s17, s3, 3
    s_add_u32 s16, s16, s17
    s_mul_i32 s14, s16, 12288
    s_and_b32 s16, s2, 31
    s_lshl_b32 s16, s16, 8
    s_add_u32 s14, s14, s16
    s_add_u32 s14, s14, 4096
    v_mfma_f32_16x16x32_bf16 v[44:47], v[240:243], v[100:103], v[44:47]
    ds_read_b64_tr_b16 v[234:235], v4 offset:26368
    s_waitcnt lgkmcnt(6)
    v_mfma_f32_16x16x32_bf16 v[48:51], v[244:247], v[96:99], v[48:51]
    ds_read_b64_tr_b16 v[236:237], v5 offset:25376
    v_mfma_f32_16x16x32_bf16 v[52:55], v[244:247], v[100:103], v[52:55]
    ds_read_b64_tr_b16 v[238:239], v5 offset:26400
    s_waitcnt lgkmcnt(6)
    v_mfma_f32_16x16x32_bf16 v[56:59], v[224:227], v[96:99], v[56:59]
    v_mfma_f32_16x16x32_bf16 v[60:63], v[224:227], v[100:103], v[60:63]
    s_waitcnt vmcnt(10)
    s_barrier
    ds_read_b64_tr_b16 v[240:241], v4 offset:32768
    ds_read_b64_tr_b16 v[242:243], v4 offset:33792
    s_waitcnt lgkmcnt(6)
    v_mfma_f32_16x16x32_bf16 v[64:67], v[228:231], v[96:99], v[64:67]
    ds_read_b64_tr_b16 v[244:245], v5 offset:32800
    v_mfma_f32_16x16x32_bf16 v[68:71], v[228:231], v[100:103], v[68:71]
    s_add_u32 s22, s19, 0x600000
    s_add_u32 m0, s20, 0x0
    s_nop 0
    buffer_load_dwordx4 v3, s[4:7], s22 offen lds
    ds_read_b64_tr_b16 v[246:247], v5 offset:33824
    s_mov_b32 s23, 0xd800
    buffer_load_dwordx4 v[132:135], v7, s[8:11], s23 offen offset:1024 sc1
    s_waitcnt lgkmcnt(6)
    v_mfma_f32_16x16x32_bf16 v[72:75], v[232:235], v[96:99], v[72:75]
    ds_read_b64_tr_b16 v[224:225], v4 offset:33024
    v_mfma_f32_16x16x32_bf16 v[76:79], v[232:235], v[100:103], v[76:79]
    ds_read_b64_tr_b16 v[226:227], v4 offset:34048
    s_waitcnt lgkmcnt(6)
    v_mfma_f32_16x16x32_bf16 v[80:83], v[236:239], v[96:99], v[80:83]
    ds_read_b64_tr_b16 v[228:229], v5 offset:33056
    v_mfma_f32_16x16x32_bf16 v[84:87], v[236:239], v[100:103], v[84:87]
    ds_read_b64_tr_b16 v[230:231], v5 offset:34080
    s_waitcnt vmcnt(11) lgkmcnt(6)
    v_mfma_f32_16x16x32_bf16 v[24:27], v[240:243], v[104:107], v[24:27]
    ds_read_b64_tr_b16 v[232:233], v4 offset:33280
    s_waitcnt vmcnt(10)
    v_mfma_f32_16x16x32_bf16 v[28:31], v[240:243], v[108:111], v[28:31]
    ds_read_b64_tr_b16 v[234:235], v4 offset:34304
    s_waitcnt lgkmcnt(6)
    v_mfma_f32_16x16x32_bf16 v[32:35], v[244:247], v[104:107], v[32:35]
    ds_read_b64_tr_b16 v[236:237], v5 offset:33312
    v_mfma_f32_16x16x32_bf16 v[36:39], v[244:247], v[108:111], v[36:39]
    s_add_u32 s22, s19, 0x608000
    s_add_u32 m0, s20, 0x400
    s_nop 0
    buffer_load_dwordx4 v3, s[4:7], s22 offen lds
    ds_read_b64_tr_b16 v[238:239], v5 offset:34336
    s_mov_b32 s23, 0x6000
    buffer_load_dwordx4 v[88:91], v7, s[8:11], s23 offen offset:0 sc1
    s_waitcnt lgkmcnt(6)
    v_mfma_f32_16x16x32_bf16 v[40:43], v[224:227], v[104:107], v[40:43]
    ds_read_b64_tr_b16 v[240:241], v4 offset:33536
    v_mfma_f32_16x16x32_bf16 v[44:47], v[224:227], v[108:111], v[44:47]
    ds_read_b64_tr_b16 v[242:243], v4 offset:34560
    s_waitcnt lgkmcnt(6)
    v_mfma_f32_16x16x32_bf16 v[48:51], v[228:231], v[104:107], v[48:51]
    ds_read_b64_tr_b16 v[244:245], v5 offset:33568
    v_mfma_f32_16x16x32_bf16 v[52:55], v[228:231], v[108:111], v[52:55]
    ds_read_b64_tr_b16 v[246:247], v5 offset:34592
    s_waitcnt lgkmcnt(6)
    v_mfma_f32_16x16x32_bf16 v[56:59], v[232:235], v[104:107], v[56:59]
    ds_read_b64_tr_b16 v[224:225], v4 offset:40960
    v_mfma_f32_16x16x32_bf16 v[60:63], v[232:235], v[108:111], v[60:63]
    ds_read_b64_tr_b16 v[226:227], v4 offset:41984
    s_waitcnt lgkmcnt(6)
    v_mfma_f32_16x16x32_bf16 v[64:67], v[236:239], v[104:107], v[64:67]
    ds_read_b64_tr_b16 v[228:229], v5 offset:40992
    v_mfma_f32_16x16x32_bf16 v[68:71], v[236:239], v[108:111], v[68:71]
    ds_read_b64_tr_b16 v[230:231], v5 offset:42016
    s_mov_b32 s23, 0xe000
    buffer_load_dwordx4 v[92:95], v7, s[8:11], s23 offen offset:0 sc1
    s_waitcnt lgkmcnt(6)
    v_mfma_f32_16x16x32_bf16 v[72:75], v[240:243], v[104:107], v[72:75]
    ds_read_b64_tr_b16 v[232:233], v4 offset:41216
    v_mfma_f32_16x16x32_bf16 v[76:79], v[240:243], v[108:111], v[76:79]
    ds_read_b64_tr_b16 v[234:235], v4 offset:42240
    s_waitcnt lgkmcnt(6)
    v_mfma_f32_16x16x32_bf16 v[80:83], v[244:247], v[104:107], v[80:83]
    ds_read_b64_tr_b16 v[236:237], v5 offset:41248
    v_mfma_f32_16x16x32_bf16 v[84:87], v[244:247], v[108:111], v[84:87]
    ds_read_b64_tr_b16 v[238:239], v5 offset:42272
    s_waitcnt vmcnt(12) lgkmcnt(6)
    v_mfma_f32_16x16x32_bf16 v[24:27], v[224:227], v[112:115], v[24:27]
    ds_read_b64_tr_b16 v[240:241], v4 offset:41472
    s_add_u32 s22, s14, 0x0
    s_add_u32 m0, s20, 0x10000
    s_nop 0
    buffer_load_dwordx4 v6, s[76:79], s22 offen lds
    s_waitcnt vmcnt(11)
    v_mfma_f32_16x16x32_bf16 v[28:31], v[224:227], v[116:119], v[28:31]
    ds_read_b64_tr_b16 v[242:243], v4 offset:42496
    s_waitcnt lgkmcnt(6)
    v_mfma_f32_16x16x32_bf16 v[32:35], v[228:231], v[112:115], v[32:35]
    ds_read_b64_tr_b16 v[244:245], v5 offset:41504
    v_mfma_f32_16x16x32_bf16 v[36:39], v[228:231], v[116:119], v[36:39]
    ds_read_b64_tr_b16 v[246:247], v5 offset:42528
    s_mov_b32 s23, 0x6000
    buffer_load_dwordx4 v[96:99], v7, s[8:11], s23 offen offset:1024 sc1
    s_waitcnt lgkmcnt(6)
    v_mfma_f32_16x16x32_bf16 v[40:43], v[232:235], v[112:115], v[40:43]
    ds_read_b64_tr_b16 v[224:225], v4 offset:41728
    s_add_u32 s22, s14, 0xc000
    s_add_u32 m0, s20, 0x10400
    s_nop 0
    buffer_load_dwordx4 v6, s[76:79], s22 offen lds
    v_mfma_f32_16x16x32_bf16 v[44:47], v[232:235], v[116:119], v[44:47]
    ds_read_b64_tr_b16 v[226:227], v4 offset:42752
    s_waitcnt lgkmcnt(6)
    v_mfma_f32_16x16x32_bf16 v[48:51], v[236:239], v[112:115], v[48:51]
    ds_read_b64_tr_b16 v[228:229], v5 offset:41760
    v_mfma_f32_16x16x32_bf16 v[52:55], v[236:239], v[116:119], v[52:55]
    ds_read_b64_tr_b16 v[230:231], v5 offset:42784
    s_waitcnt lgkmcnt(6)
    v_mfma_f32_16x16x32_bf16 v[56:59], v[240:243], v[112:115], v[56:59]
    v_mfma_f32_16x16x32_bf16 v[60:63], v[240:243], v[116:119], v[60:63]
    s_waitcnt vmcnt(12)
    s_barrier
    ds_read_b64_tr_b16 v[232:233], v4 offset:49152
    ds_read_b64_tr_b16 v[234:235], v4 offset:50176
    s_waitcnt lgkmcnt(6)
    v_mfma_f32_16x16x32_bf16 v[64:67], v[244:247], v[112:115], v[64:67]
    ds_read_b64_tr_b16 v[236:237], v5 offset:49184
    v_mfma_f32_16x16x32_bf16 v[68:71], v[244:247], v[116:119], v[68:71]
    s_add_u32 s22, s19, 0x680000
    s_add_u32 m0, s20, 0x4000
    s_nop 0
    buffer_load_dwordx4 v3, s[4:7], s22 offen lds
    ds_read_b64_tr_b16 v[238:239], v5 offset:50208
    s_mov_b32 s23, 0xe000
    buffer_load_dwordx4 v[100:103], v7, s[8:11], s23 offen offset:1024 sc1
    s_waitcnt lgkmcnt(6)
    v_mfma_f32_16x16x32_bf16 v[72:75], v[224:227], v[112:115], v[72:75]
    ds_read_b64_tr_b16 v[240:241], v4 offset:49408
    v_mfma_f32_16x16x32_bf16 v[76:79], v[224:227], v[116:119], v[76:79]
    ds_read_b64_tr_b16 v[242:243], v4 offset:50432
    s_waitcnt lgkmcnt(6)
    v_mfma_f32_16x16x32_bf16 v[80:83], v[228:231], v[112:115], v[80:83]
    ds_read_b64_tr_b16 v[244:245], v5 offset:49440
    v_mfma_f32_16x16x32_bf16 v[84:87], v[228:231], v[116:119], v[84:87]
    ds_read_b64_tr_b16 v[246:247], v5 offset:50464
    s_waitcnt vmcnt(13) lgkmcnt(6)
    v_mfma_f32_16x16x32_bf16 v[24:27], v[232:235], v[120:123], v[24:27]
    ds_read_b64_tr_b16 v[224:225], v4 offset:49664
    s_waitcnt vmcnt(12)
    v_mfma_f32_16x16x32_bf16 v[28:31], v[232:235], v[124:127], v[28:31]
    ds_read_b64_tr_b16 v[226:227], v4 offset:50688
    s_waitcnt lgkmcnt(6)
    v_mfma_f32_16x16x32_bf16 v[32:35], v[236:239], v[120:123], v[32:35]
    ds_read_b64_tr_b16 v[228:229], v5 offset:49696
    v_mfma_f32_16x16x32_bf16 v[36:39], v[236:239], v[124:127], v[36:39]
    s_add_u32 s22, s19, 0x688000
    s_add_u32 m0, s20, 0x4400
    s_nop 0
    buffer_load_dwordx4 v3, s[4:7], s22 offen lds
    ds_read_b64_tr_b16 v[230:231], v5 offset:50720
    s_mov_b32 s23, 0x6800
    buffer_load_dwordx4 v[104:107], v7, s[8:11], s23 offen offset:0 sc1
    s_waitcnt lgkmcnt(6)
    v_mfma_f32_16x16x32_bf16 v[40:43], v[240:243], v[120:123], v[40:43]
    ds_read_b64_tr_b16 v[232:233], v4 offset:49920
    v_mfma_f32_16x16x32_bf16 v[44:47], v[240:243], v[124:127], v[44:47]
    ds_read_b64_tr_b16 v[234:235], v4 offset:50944
    s_waitcnt lgkmcnt(6)
    v_mfma_f32_16x16x32_bf16 v[48:51], v[244:247], v[120:123], v[48:51]
    ds_read_b64_tr_b16 v[236:237], v5 offset:49952
    v_mfma_f32_16x16x32_bf16 v[52:55], v[244:247], v[124:127], v[52:55]
    ds_read_b64_tr_b16 v[238:239], v5 offset:50976
    s_waitcnt lgkmcnt(6)
    v_mfma_f32_16x16x32_bf16 v[56:59], v[224:227], v[120:123], v[56:59]
    ds_read_b64_tr_b16 v[240:241], v4 offset:57344
    v_mfma_f32_16x16x32_bf16 v[60:63], v[224:227], v[124:127], v[60:63]
    ds_read_b64_tr_b16 v[242:243], v4 offset:58368
    s_waitcnt lgkmcnt(6)
    v_mfma_f32_16x16x32_bf16 v[64:67], v[228:231], v[120:123], v[64:67]
    ds_read_b64_tr_b16 v[244:245], v5 offset:57376
    v_mfma_f32_16x16x32_bf16 v[68:71], v[228:231], v[124:127], v[68:71]
    ds_read_b64_tr_b16 v[246:247], v5 offset:58400
    s_mov_b32 s23, 0xe800
    buffer_load_dwordx4 v[108:111], v7, s[8:11], s23 offen offset:0 sc1
    s_waitcnt lgkmcnt(6)
    v_mfma_f32_16x16x32_bf16 v[72:75], v[232:235], v[120:123], v[72:75]
    ds_read_b64_tr_b16 v[224:225], v4 offset:57600
    v_mfma_f32_16x16x32_bf16 v[76:79], v[232:235], v[124:127], v[76:79]
    ds_read_b64_tr_b16 v[226:227], v4 offset:58624
    s_waitcnt lgkmcnt(6)
    v_mfma_f32_16x16x32_bf16 v[80:83], v[236:239], v[120:123], v[80:83]
    ds_read_b64_tr_b16 v[228:229], v5 offset:57632
    v_mfma_f32_16x16x32_bf16 v[84:87], v[236:239], v[124:127], v[84:87]
    ds_read_b64_tr_b16 v[230:231], v5 offset:58656
    s_waitcnt vmcnt(13) lgkmcnt(6)
    v_mfma_f32_16x16x32_bf16 v[24:27], v[240:243], v[128:131], v[24:27]
    ds_read_b64_tr_b16 v[232:233], v4 offset:57856
    s_add_u32 s22, s14, 0xc0000
    s_add_u32 m0, s20, 0x14000
    s_nop 0
    buffer_load_dwordx4 v6, s[76:79], s22 offen lds
    s_waitcnt vmcnt(12)
    v_mfma_f32_16x16x32_bf16 v[28:31], v[240:243], v[132:135], v[28:31]
    ds_read_b64_tr_b16 v[234:235], v4 offset:58880
    s_waitcnt lgkmcnt(6)
    v_mfma_f32_16x16x32_bf16 v[32:35], v[244:247], v[128:131], v[32:35]
    ds_read_b64_tr_b16 v[236:237], v5 offset:57888
    v_mfma_f32_16x16x32_bf16 v[36:39], v[244:247], v[132:135], v[36:39]
    ds_read_b64_tr_b16 v[238:239], v5 offset:58912
    s_mov_b32 s23, 0x6800
    buffer_load_dwordx4 v[112:115], v7, s[8:11], s23 offen offset:1024 sc1
    s_waitcnt lgkmcnt(6)
    v_mfma_f32_16x16x32_bf16 v[40:43], v[224:227], v[128:131], v[40:43]
    ds_read_b64_tr_b16 v[240:241], v4 offset:58112
    s_add_u32 s22, s14, 0xcc000
    s_add_u32 m0, s20, 0x14400
    s_nop 0
    buffer_load_dwordx4 v6, s[76:79], s22 offen lds
    v_mfma_f32_16x16x32_bf16 v[44:47], v[224:227], v[132:135], v[44:47]
    ds_read_b64_tr_b16 v[242:243], v4 offset:59136
    s_waitcnt lgkmcnt(6)
    v_mfma_f32_16x16x32_bf16 v[48:51], v[228:231], v[128:131], v[48:51]
    ds_read_b64_tr_b16 v[244:245], v5 offset:58144
    v_mfma_f32_16x16x32_bf16 v[52:55], v[228:231], v[132:135], v[52:55]
    ds_read_b64_tr_b16 v[246:247], v5 offset:59168
    s_waitcnt lgkmcnt(6)
    v_mfma_f32_16x16x32_bf16 v[56:59], v[232:235], v[128:131], v[56:59]
    v_mfma_f32_16x16x32_bf16 v[60:63], v[232:235], v[132:135], v[60:63]
    s_waitcnt vmcnt(13)
    s_barrier
    ds_read_b64_tr_b16 v[224:225], v4 offset:0
    ds_read_b64_tr_b16 v[226:227], v4 offset:1024
    s_waitcnt lgkmcnt(6)
    v_mfma_f32_16x16x32_bf16 v[64:67], v[236:239], v[128:131], v[64:67]
    ds_read_b64_tr_b16 v[228:229], v5 offset:32
    v_mfma_f32_16x16x32_bf16 v[68:71], v[236:239], v[132:135], v[68:71]
    s_add_u32 s22, s19, 0x700000
    s_add_u32 m0, s20, 0x8000
    s_nop 0
    buffer_load_dwordx4 v3, s[4:7], s22 offen lds
    ds_read_b64_tr_b16 v[230:231], v5 offset:1056
    s_mov_b32 s23, 0xe800
    buffer_load_dwordx4 v[116:119], v7, s[8:11], s23 offen offset:1024 sc1
    s_waitcnt lgkmcnt(6)
    v_mfma_f32_16x16x32_bf16 v[72:75], v[240:243], v[128:131], v[72:75]
    ds_read_b64_tr_b16 v[232:233], v4 offset:256
    v_mfma_f32_16x16x32_bf16 v[76:79], v[240:243], v[132:135], v[76:79]
    ds_read_b64_tr_b16 v[234:235], v4 offset:1280
    s_waitcnt lgkmcnt(6)
    v_mfma_f32_16x16x32_bf16 v[80:83], v[244:247], v[128:131], v[80:83]
    ds_read_b64_tr_b16 v[236:237], v5 offset:288
    v_mfma_f32_16x16x32_bf16 v[84:87], v[244:247], v[132:135], v[84:87]
    ds_read_b64_tr_b16 v[238:239], v5 offset:1312
    s_waitcnt vmcnt(14) lgkmcnt(6)
    v_mfma_f32_16x16x32_bf16 v[24:27], v[224:227], v[88:91], v[24:27]
    ds_read_b64_tr_b16 v[240:241], v4 offset:512
    s_waitcnt vmcnt(13)
    v_mfma_f32_16x16x32_bf16 v[28:31], v[224:227], v[92:95], v[28:31]
    ds_read_b64_tr_b16 v[242:243], v4 offset:1536
    s_waitcnt lgkmcnt(6)
    v_mfma_f32_16x16x32_bf16 v[32:35], v[228:231], v[88:91], v[32:35]
    ds_read_b64_tr_b16 v[244:245], v5 offset:544
    v_mfma_f32_16x16x32_bf16 v[36:39], v[228:231], v[92:95], v[36:39]
    s_add_u32 s22, s19, 0x708000
    s_add_u32 m0, s20, 0x8400
    s_nop 0
    buffer_load_dwordx4 v3, s[4:7], s22 offen lds
    ds_read_b64_tr_b16 v[246:247], v5 offset:1568
    s_mov_b32 s23, 0x7000
    buffer_load_dwordx4 v[120:123], v7, s[8:11], s23 offen offset:0 sc1
    s_waitcnt lgkmcnt(6)
    v_mfma_f32_16x16x32_bf16 v[40:43], v[232:235], v[88:91], v[40:43]
    ds_read_b64_tr_b16 v[224:225], v4 offset:768
    v_mfma_f32_16x16x32_bf16 v[44:47], v[232:235], v[92:95], v[44:47]
    ds_read_b64_tr_b16 v[226:227], v4 offset:1792
    s_waitcnt lgkmcnt(6)
    v_mfma_f32_16x16x32_bf16 v[48:51], v[236:239], v[88:91], v[48:51]
    ds_read_b64_tr_b16 v[228:229], v5 offset:800
    v_mfma_f32_16x16x32_bf16 v[52:55], v[236:239], v[92:95], v[52:55]
    ds_read_b64_tr_b16 v[230:231], v5 offset:1824
    s_waitcnt lgkmcnt(6)
    v_mfma_f32_16x16x32_bf16 v[56:59], v[240:243], v[88:91], v[56:59]
    ds_read_b64_tr_b16 v[232:233], v4 offset:8192
    v_mfma_f32_16x16x32_bf16 v[60:63], v[240:243], v[92:95], v[60:63]
    ds_read_b64_tr_b16 v[234:235], v4 offset:9216
    s_waitcnt lgkmcnt(6)
    v_mfma_f32_16x16x32_bf16 v[64:67], v[244:247], v[88:91], v[64:67]
    ds_read_b64_tr_b16 v[236:237], v5 offset:8224
    v_mfma_f32_16x16x32_bf16 v[68:71], v[244:247], v[92:95], v[68:71]
    ds_read_b64_tr_b16 v[238:239], v5 offset:9248
    s_mov_b32 s23, 0xf000
    buffer_load_dwordx4 v[124:127], v7, s[8:11], s23 offen offset:0 sc1
    s_waitcnt lgkmcnt(6)
    v_mfma_f32_16x16x32_bf16 v[72:75], v[224:227], v[88:91], v[72:75]
    ds_read_b64_tr_b16 v[240:241], v4 offset:8448
    v_mfma_f32_16x16x32_bf16 v[76:79], v[224:227], v[92:95], v[76:79]
    ds_read_b64_tr_b16 v[242:243], v4 offset:9472
    s_waitcnt lgkmcnt(6)
    v_mfma_f32_16x16x32_bf16 v[80:83], v[228:231], v[88:91], v[80:83]
    ds_read_b64_tr_b16 v[244:245], v5 offset:8480
    v_mfma_f32_16x16x32_bf16 v[84:87], v[228:231], v[92:95], v[84:87]
    ds_read_b64_tr_b16 v[246:247], v5 offset:9504
    s_waitcnt vmcnt(14) lgkmcnt(6)
    v_mfma_f32_16x16x32_bf16 v[24:27], v[232:235], v[96:99], v[24:27]
    ds_read_b64_tr_b16 v[224:225], v4 offset:8704
    s_add_u32 s22, s21, 0x0
    s_add_u32 m0, s20, 0x18000
    s_nop 0
    buffer_load_dwordx4 v2, s[8:11], s22 offen sc1 lds
    s_waitcnt vmcnt(12)
    v_mfma_f32_16x16x32_bf16 v[28:31], v[232:235], v[100:103], v[28:31]
    ds_read_b64_tr_b16 v[226:227], v4 offset:9728
    s_waitcnt lgkmcnt(6)
    v_mfma_f32_16x16x32_bf16 v[32:35], v[236:239], v[96:99], v[32:35]
    ds_read_b64_tr_b16 v[228:229], v5 offset:8736
    v_mfma_f32_16x16x32_bf16 v[36:39], v[236:239], v[100:103], v[36:39]
    ds_read_b64_tr_b16 v[230:231], v5 offset:9760
    s_mov_b32 s23, 0x7000
    buffer_load_dwordx4 v[128:131], v7, s[8:11], s23 offen offset:1024 sc1
    s_waitcnt lgkmcnt(6)
    v_mfma_f32_16x16x32_bf16 v[40:43], v[240:243], v[96:99], v[40:43]
    ds_read_b64_tr_b16 v[232:233], v4 offset:8960
    s_add_u32 s22, s21, 0x400
    s_add_u32 m0, s20, 0x18400
    s_nop 0
    buffer_load_dwordx4 v2, s[8:11], s22 offen sc1 lds
    v_mfma_f32_16x16x32_bf16 v[44:47], v[240:243], v[100:103], v[44:47]
    ds_read_b64_tr_b16 v[234:235], v4 offset:9984
    s_waitcnt lgkmcnt(6)
    v_mfma_f32_16x16x32_bf16 v[48:51], v[244:247], v[96:99], v[48:51]
    ds_read_b64_tr_b16 v[236:237], v5 offset:8992
    v_mfma_f32_16x16x32_bf16 v[52:55], v[244:247], v[100:103], v[52:55]
    ds_read_b64_tr_b16 v[238:239], v5 offset:10016
    s_waitcnt lgkmcnt(6)
    v_mfma_f32_16x16x32_bf16 v[56:59], v[224:227], v[96:99], v[56:59]
    v_mfma_f32_16x16x32_bf16 v[60:63], v[224:227], v[100:103], v[60:63]
    s_waitcnt vmcnt(13)
    s_barrier
    ds_read_b64_tr_b16 v[240:241], v4 offset:16384
    ds_read_b64_tr_b16 v[242:243], v4 offset:17408
    s_waitcnt lgkmcnt(6)
    v_mfma_f32_16x16x32_bf16 v[64:67], v[228:231], v[96:99], v[64:67]
    ds_read_b64_tr_b16 v[244:245], v5 offset:16416
    v_mfma_f32_16x16x32_bf16 v[68:71], v[228:231], v[100:103], v[68:71]
    s_add_u32 s22, s19, 0x780000
    s_add_u32 m0, s20, 0xc000
    s_nop 0
    buffer_load_dwordx4 v3, s[4:7], s22 offen lds
    ds_read_b64_tr_b16 v[246:247], v5 offset:17440
    s_mov_b32 s23, 0xf000
    buffer_load_dwordx4 v[132:135], v7, s[8:11], s23 offen offset:1024 sc1
    s_waitcnt lgkmcnt(6)
    v_mfma_f32_16x16x32_bf16 v[72:75], v[232:235], v[96:99], v[72:75]
    ds_read_b64_tr_b16 v[224:225], v4 offset:16640
    v_mfma_f32_16x16x32_bf16 v[76:79], v[232:235], v[100:103], v[76:79]
    ds_read_b64_tr_b16 v[226:227], v4 offset:17664
    s_waitcnt lgkmcnt(6)
    v_mfma_f32_16x16x32_bf16 v[80:83], v[236:239], v[96:99], v[80:83]
    ds_read_b64_tr_b16 v[228:229], v5 offset:16672
    v_mfma_f32_16x16x32_bf16 v[84:87], v[236:239], v[100:103], v[84:87]
    ds_read_b64_tr_b16 v[230:231], v5 offset:17696
    s_waitcnt vmcnt(14) lgkmcnt(6)
    v_mfma_f32_16x16x32_bf16 v[24:27], v[240:243], v[104:107], v[24:27]
    ds_read_b64_tr_b16 v[232:233], v4 offset:16896
    s_waitcnt vmcnt(13)
    v_mfma_f32_16x16x32_bf16 v[28:31], v[240:243], v[108:111], v[28:31]
    ds_read_b64_tr_b16 v[234:235], v4 offset:17920
    s_waitcnt lgkmcnt(6)
    v_mfma_f32_16x16x32_bf16 v[32:35], v[244:247], v[104:107], v[32:35]
    ds_read_b64_tr_b16 v[236:237], v5 offset:16928
    v_mfma_f32_16x16x32_bf16 v[36:39], v[244:247], v[108:111], v[36:39]
    s_add_u32 s22, s19, 0x788000
    s_add_u32 m0, s20, 0xc400
    s_nop 0
    buffer_load_dwordx4 v3, s[4:7], s22 offen lds
    ds_read_b64_tr_b16 v[238:239], v5 offset:17952
    s_mov_b32 s23, 0x7800
    buffer_load_dwordx4 v[88:91], v7, s[8:11], s23 offen offset:0 sc1
    s_waitcnt lgkmcnt(6)
    v_mfma_f32_16x16x32_bf16 v[40:43], v[224:227], v[104:107], v[40:43]
    ds_read_b64_tr_b16 v[240:241], v4 offset:17152
    v_lshrrev_b32 v20, 4, v1
    v_lshlrev_b32 v21, 4, v20
    s_lshl_b32 s16, s2, 8
    s_add_u32 s16, s16, 0x550000
    buffer_load_dwordx4 v[136:139], v21, s[8:11], s16 offen offset:0 sc1
    buffer_load_dwordx4 v[140:143], v21, s[8:11], s16 offen offset:64 sc1
    buffer_load_dwordx4 v[144:147], v21, s[8:11], s16 offen offset:128 sc1
    buffer_load_dwordx4 v[148:151], v21, s[8:11], s16 offen offset:192 sc1
    v_lshlrev_b32 v11, 11, v20
    v_xor_b32 v20, s3, v20
    v_and_b32 v20, 1, v20
    v_lshl_add_u32 v11, v20, 5, v11
    v_bfe_u32 v20, v1, 2, 2
    v_lshl_add_u32 v11, v20, 6, v11
    v_and_b32 v20, 3, v1
    v_lshl_add_u32 v11, v20, 3, v11
    s_lshr_b32 s16, s3, 1
    s_lshl_b32 s16, s16, 8
    s_add_u32 s16, s16, 65536
    v_add_u32 v11, s16, v11
    v_mfma_f32_16x16x32_bf16 v[44:47], v[224:227], v[108:111], v[44:47]
    ds_read_b64_tr_b16 v[242:243], v4 offset:18176
    s_waitcnt lgkmcnt(6)
    v_mfma_f32_16x16x32_bf16 v[48:51], v[228:231], v[104:107], v[48:51]
    ds_read_b64_tr_b16 v[244:245], v5 offset:17184
    v_mfma_f32_16x16x32_bf16 v[52:55], v[228:231], v[108:111], v[52:55]
    ds_read_b64_tr_b16 v[246:247], v5 offset:18208
    s_waitcnt lgkmcnt(6)
    v_mfma_f32_16x16x32_bf16 v[56:59], v[232:235], v[104:107], v[56:59]
    ds_read_b64_tr_b16 v[224:225], v4 offset:24576
    v_mfma_f32_16x16x32_bf16 v[60:63], v[232:235], v[108:111], v[60:63]
    ds_read_b64_tr_b16 v[226:227], v4 offset:25600
    s_waitcnt lgkmcnt(6)
    v_mfma_f32_16x16x32_bf16 v[64:67], v[236:239], v[104:107], v[64:67]
    ds_read_b64_tr_b16 v[228:229], v5 offset:24608
    v_mfma_f32_16x16x32_bf16 v[68:71], v[236:239], v[108:111], v[68:71]
    ds_read_b64_tr_b16 v[230:231], v5 offset:25632
    s_mov_b32 s23, 0xf800
    buffer_load_dwordx4 v[92:95], v7, s[8:11], s23 offen offset:0 sc1
    s_waitcnt lgkmcnt(6)
    v_mfma_f32_16x16x32_bf16 v[72:75], v[240:243], v[104:107], v[72:75]
    ds_read_b64_tr_b16 v[232:233], v4 offset:24832
    v_mfma_f32_16x16x32_bf16 v[76:79], v[240:243], v[108:111], v[76:79]
    ds_read_b64_tr_b16 v[234:235], v4 offset:25856
    s_waitcnt lgkmcnt(6)
    v_mfma_f32_16x16x32_bf16 v[80:83], v[244:247], v[104:107], v[80:83]
    ds_read_b64_tr_b16 v[236:237], v5 offset:24864
    v_mfma_f32_16x16x32_bf16 v[84:87], v[244:247], v[108:111], v[84:87]
    ds_read_b64_tr_b16 v[238:239], v5 offset:25888
    s_waitcnt vmcnt(18) lgkmcnt(6)
    v_mfma_f32_16x16x32_bf16 v[24:27], v[224:227], v[112:115], v[24:27]
    ds_read_b64_tr_b16 v[240:241], v4 offset:25088
    s_add_u32 s22, s21, 0x4000
    s_add_u32 m0, s20, 0x1c000
    s_nop 0
    buffer_load_dwordx4 v2, s[8:11], s22 offen sc1 lds
    s_waitcnt vmcnt(16)
    v_mfma_f32_16x16x32_bf16 v[28:31], v[224:227], v[116:119], v[28:31]
    ds_read_b64_tr_b16 v[242:243], v4 offset:26112
    s_waitcnt lgkmcnt(6)
    v_mfma_f32_16x16x32_bf16 v[32:35], v[228:231], v[112:115], v[32:35]
    ds_read_b64_tr_b16 v[244:245], v5 offset:25120
    v_mfma_f32_16x16x32_bf16 v[36:39], v[228:231], v[116:119], v[36:39]
    ds_read_b64_tr_b16 v[246:247], v5 offset:26144
    s_mov_b32 s23, 0x7800
    buffer_load_dwordx4 v[96:99], v7, s[8:11], s23 offen offset:1024 sc1
    s_waitcnt lgkmcnt(6)
    v_mfma_f32_16x16x32_bf16 v[40:43], v[232:235], v[112:115], v[40:43]
    ds_read_b64_tr_b16 v[224:225], v4 offset:25344
    s_add_u32 s22, s21, 0x4400
    s_add_u32 m0, s20, 0x1c400
    s_nop 0
    buffer_load_dwordx4 v2, s[8:11], s22 offen sc1 lds
    v_mfma_f32_16x16x32_bf16 v[44:47], v[232:235], v[116:119], v[44:47]
    ds_read_b64_tr_b16 v[226:227], v4 offset:26368
    s_waitcnt lgkmcnt(6)
    v_mfma_f32_16x16x32_bf16 v[48:51], v[236:239], v[112:115], v[48:51]
    ds_read_b64_tr_b16 v[228:229], v5 offset:25376
    v_mfma_f32_16x16x32_bf16 v[52:55], v[236:239], v[116:119], v[52:55]
    ds_read_b64_tr_b16 v[230:231], v5 offset:26400
    s_waitcnt lgkmcnt(6)
    v_mfma_f32_16x16x32_bf16 v[56:59], v[240:243], v[112:115], v[56:59]
    v_mfma_f32_16x16x32_bf16 v[60:63], v[240:243], v[116:119], v[60:63]
    s_waitcnt vmcnt(17)
    s_barrier
    ds_read_b64_tr_b16 v[232:233], v4 offset:32768
    ds_read_b64_tr_b16 v[234:235], v4 offset:33792
    s_waitcnt lgkmcnt(6)
    v_mfma_f32_16x16x32_bf16 v[64:67], v[244:247], v[112:115], v[64:67]
    ds_read_b64_tr_b16 v[236:237], v5 offset:32800
    v_mfma_f32_16x16x32_bf16 v[68:71], v[244:247], v[116:119], v[68:71]
    ds_read_b64_tr_b16 v[238:239], v5 offset:33824
    s_mov_b32 s23, 0xf800
    buffer_load_dwordx4 v[100:103], v7, s[8:11], s23 offen offset:1024 sc1
    s_waitcnt lgkmcnt(6)
    v_mfma_f32_16x16x32_bf16 v[72:75], v[224:227], v[112:115], v[72:75]
    ds_read_b64_tr_b16 v[240:241], v4 offset:33024
    v_mfma_f32_16x16x32_bf16 v[76:79], v[224:227], v[116:119], v[76:79]
    ds_read_b64_tr_b16 v[242:243], v4 offset:34048
    s_waitcnt lgkmcnt(6)
    v_mfma_f32_16x16x32_bf16 v[80:83], v[228:231], v[112:115], v[80:83]
    ds_read_b64_tr_b16 v[244:245], v5 offset:33056
    v_mfma_f32_16x16x32_bf16 v[84:87], v[228:231], v[116:119], v[84:87]
    ds_read_b64_tr_b16 v[246:247], v5 offset:34080
    s_waitcnt vmcnt(17) lgkmcnt(6)
    v_mfma_f32_16x16x32_bf16 v[24:27], v[232:235], v[120:123], v[24:27]
    ds_read_b64_tr_b16 v[224:225], v4 offset:33280
    s_waitcnt vmcnt(16)
    v_mfma_f32_16x16x32_bf16 v[28:31], v[232:235], v[124:127], v[28:31]
    ds_read_b64_tr_b16 v[226:227], v4 offset:34304
    s_waitcnt lgkmcnt(6)
    v_mfma_f32_16x16x32_bf16 v[32:35], v[236:239], v[120:123], v[32:35]
    ds_read_b64_tr_b16 v[228:229], v5 offset:33312
    v_mfma_f32_16x16x32_bf16 v[36:39], v[236:239], v[124:127], v[36:39]
    ds_read_b64_tr_b16 v[230:231], v5 offset:34336
    s_waitcnt lgkmcnt(6)
    v_mfma_f32_16x16x32_bf16 v[40:43], v[240:243], v[120:123], v[40:43]
    ds_read_b64_tr_b16 v[232:233], v4 offset:33536
    v_mfma_f32_16x16x32_bf16 v[44:47], v[240:243], v[124:127], v[44:47]
    ds_read_b64_tr_b16 v[234:235], v4 offset:34560
    s_waitcnt lgkmcnt(6)
    v_mfma_f32_16x16x32_bf16 v[48:51], v[244:247], v[120:123], v[48:51]
    ds_read_b64_tr_b16 v[236:237], v5 offset:33568
    v_mfma_f32_16x16x32_bf16 v[52:55], v[244:247], v[124:127], v[52:55]
    ds_read_b64_tr_b16 v[238:239], v5 offset:34592
    s_waitcnt lgkmcnt(6)
    v_mfma_f32_16x16x32_bf16 v[56:59], v[224:227], v[120:123], v[56:59]
    ds_read_b64_tr_b16 v[240:241], v4 offset:40960
    v_mfma_f32_16x16x32_bf16 v[60:63], v[224:227], v[124:127], v[60:63]
    ds_read_b64_tr_b16 v[242:243], v4 offset:41984
    s_waitcnt lgkmcnt(6)
    v_mfma_f32_16x16x32_bf16 v[64:67], v[228:231], v[120:123], v[64:67]
    ds_read_b64_tr_b16 v[244:245], v5 offset:40992
    v_mfma_f32_16x16x32_bf16 v[68:71], v[228:231], v[124:127], v[68:71]
    ds_read_b64_tr_b16 v[246:247], v5 offset:42016
    s_waitcnt lgkmcnt(6)
    v_mfma_f32_16x16x32_bf16 v[72:75], v[232:235], v[120:123], v[72:75]
    ds_read_b64_tr_b16 v[224:225], v4 offset:41216
    v_mfma_f32_16x16x32_bf16 v[76:79], v[232:235], v[124:127], v[76:79]
    ds_read_b64_tr_b16 v[226:227], v4 offset:42240
    s_waitcnt lgkmcnt(6)
    v_mfma_f32_16x16x32_bf16 v[80:83], v[236:239], v[120:123], v[80:83]
    ds_read_b64_tr_b16 v[228:229], v5 offset:41248
    v_mfma_f32_16x16x32_bf16 v[84:87], v[236:239], v[124:127], v[84:87]
    ds_read_b64_tr_b16 v[230:231], v5 offset:42272
    s_waitcnt vmcnt(14) lgkmcnt(6)
    v_mfma_f32_16x16x32_bf16 v[24:27], v[240:243], v[128:131], v[24:27]
    ds_read_b64_tr_b16 v[232:233], v4 offset:41472
    s_waitcnt vmcnt(11)
    v_mfma_f32_16x16x32_bf16 v[28:31], v[240:243], v[132:135], v[28:31]
    ds_read_b64_tr_b16 v[234:235], v4 offset:42496
    s_waitcnt lgkmcnt(6)
    v_mfma_f32_16x16x32_bf16 v[32:35], v[244:247], v[128:131], v[32:35]
    ds_read_b64_tr_b16 v[236:237], v5 offset:41504
    v_mfma_f32_16x16x32_bf16 v[36:39], v[244:247], v[132:135], v[36:39]
    ds_read_b64_tr_b16 v[238:239], v5 offset:42528
    s_waitcnt lgkmcnt(6)
    v_mfma_f32_16x16x32_bf16 v[40:43], v[224:227], v[128:131], v[40:43]
    ds_read_b64_tr_b16 v[240:241], v4 offset:41728
    v_mfma_f32_16x16x32_bf16 v[44:47], v[224:227], v[132:135], v[44:47]
    ds_read_b64_tr_b16 v[242:243], v4 offset:42752
    s_waitcnt lgkmcnt(6)
    v_mfma_f32_16x16x32_bf16 v[48:51], v[228:231], v[128:131], v[48:51]
    ds_read_b64_tr_b16 v[244:245], v5 offset:41760
    v_mfma_f32_16x16x32_bf16 v[52:55], v[228:231], v[132:135], v[52:55]
    ds_read_b64_tr_b16 v[246:247], v5 offset:42784
    s_waitcnt lgkmcnt(6)
    v_mfma_f32_16x16x32_bf16 v[56:59], v[232:235], v[128:131], v[56:59]
    v_mfma_f32_16x16x32_bf16 v[60:63], v[232:235], v[132:135], v[60:63]
    s_waitcnt vmcnt(10)
    s_barrier
    ds_read_b64_tr_b16 v[224:225], v4 offset:49152
    ds_read_b64_tr_b16 v[226:227], v4 offset:50176
    s_waitcnt lgkmcnt(6)
    v_mfma_f32_16x16x32_bf16 v[64:67], v[236:239], v[128:131], v[64:67]
    ds_read_b64_tr_b16 v[228:229], v5 offset:49184
    v_mfma_f32_16x16x32_bf16 v[68:71], v[236:239], v[132:135], v[68:71]
    ds_read_b64_tr_b16 v[230:231], v5 offset:50208
    s_waitcnt lgkmcnt(6)
    v_mfma_f32_16x16x32_bf16 v[72:75], v[240:243], v[128:131], v[72:75]
    ds_read_b64_tr_b16 v[232:233], v4 offset:49408
    v_mfma_f32_16x16x32_bf16 v[76:79], v[240:243], v[132:135], v[76:79]
    ds_read_b64_tr_b16 v[234:235], v4 offset:50432
    s_waitcnt lgkmcnt(6)
    v_mfma_f32_16x16x32_bf16 v[80:83], v[244:247], v[128:131], v[80:83]
    ds_read_b64_tr_b16 v[236:237], v5 offset:49440
    v_mfma_f32_16x16x32_bf16 v[84:87], v[244:247], v[132:135], v[84:87]
    ds_read_b64_tr_b16 v[238:239], v5 offset:50464
    s_waitcnt vmcnt(9) lgkmcnt(6)
    v_mfma_f32_16x16x32_bf16 v[24:27], v[224:227], v[88:91], v[24:27]
    ds_read_b64_tr_b16 v[240:241], v4 offset:49664
    s_waitcnt vmcnt(4)
    v_mfma_f32_16x16x32_bf16 v[28:31], v[224:227], v[92:95], v[28:31]
    ds_read_b64_tr_b16 v[242:243], v4 offset:50688
    s_waitcnt lgkmcnt(6)
    v_mfma_f32_16x16x32_bf16 v[32:35], v[228:231], v[88:91], v[32:35]
    ds_read_b64_tr_b16 v[244:245], v5 offset:49696
    v_mfma_f32_16x16x32_bf16 v[36:39], v[228:231], v[92:95], v[36:39]
    ds_read_b64_tr_b16 v[246:247], v5 offset:50720
    s_waitcnt lgkmcnt(6)
    v_mfma_f32_16x16x32_bf16 v[40:43], v[232:235], v[88:91], v[40:43]
    ds_read_b64_tr_b16 v[224:225], v4 offset:49920
    v_mfma_f32_16x16x32_bf16 v[44:47], v[232:235], v[92:95], v[44:47]
    ds_read_b64_tr_b16 v[226:227], v4 offset:50944
    s_waitcnt lgkmcnt(6)
    v_mfma_f32_16x16x32_bf16 v[48:51], v[236:239], v[88:91], v[48:51]
    ds_read_b64_tr_b16 v[228:229], v5 offset:49952
    v_mfma_f32_16x16x32_bf16 v[52:55], v[236:239], v[92:95], v[52:55]
    ds_read_b64_tr_b16 v[230:231], v5 offset:50976
    s_waitcnt lgkmcnt(6)
    v_mfma_f32_16x16x32_bf16 v[56:59], v[240:243], v[88:91], v[56:59]
    ds_read_b64_tr_b16 v[232:233], v4 offset:57344
    v_mfma_f32_16x16x32_bf16 v[60:63], v[240:243], v[92:95], v[60:63]
    ds_read_b64_tr_b16 v[234:235], v4 offset:58368
    s_waitcnt lgkmcnt(6)
    v_mfma_f32_16x16x32_bf16 v[64:67], v[244:247], v[88:91], v[64:67]
    ds_read_b64_tr_b16 v[236:237], v5 offset:57376
    v_mfma_f32_16x16x32_bf16 v[68:71], v[244:247], v[92:95], v[68:71]
    ds_read_b64_tr_b16 v[238:239], v5 offset:58400
    s_waitcnt lgkmcnt(6)
    v_mfma_f32_16x16x32_bf16 v[72:75], v[224:227], v[88:91], v[72:75]
    ds_read_b64_tr_b16 v[240:241], v4 offset:57600
    v_mfma_f32_16x16x32_bf16 v[76:79], v[224:227], v[92:95], v[76:79]
    ds_read_b64_tr_b16 v[242:243], v4 offset:58624
    s_waitcnt lgkmcnt(6)
    v_mfma_f32_16x16x32_bf16 v[80:83], v[228:231], v[88:91], v[80:83]
    ds_read_b64_tr_b16 v[244:245], v5 offset:57632
    v_mfma_f32_16x16x32_bf16 v[84:87], v[228:231], v[92:95], v[84:87]
    ds_read_b64_tr_b16 v[246:247], v5 offset:58656
    s_waitcnt vmcnt(2) lgkmcnt(6)
    v_mfma_f32_16x16x32_bf16 v[24:27], v[232:235], v[96:99], v[24:27]
    ds_read_b64_tr_b16 v[224:225], v4 offset:57856
    s_waitcnt vmcnt(0)
    v_mfma_f32_16x16x32_bf16 v[28:31], v[232:235], v[100:103], v[28:31]
    ds_read_b64_tr_b16 v[226:227], v4 offset:58880
    s_waitcnt lgkmcnt(6)
    v_mfma_f32_16x16x32_bf16 v[32:35], v[236:239], v[96:99], v[32:35]
    ds_read_b64_tr_b16 v[228:229], v5 offset:57888
    v_mfma_f32_16x16x32_bf16 v[36:39], v[236:239], v[100:103], v[36:39]
    ds_read_b64_tr_b16 v[230:231], v5 offset:58912
    s_waitcnt lgkmcnt(6)
    v_mfma_f32_16x16x32_bf16 v[40:43], v[240:243], v[96:99], v[40:43]
    ds_read_b64_tr_b16 v[232:233], v4 offset:58112
    v_mfma_f32_16x16x32_bf16 v[44:47], v[240:243], v[100:103], v[44:47]
    ds_read_b64_tr_b16 v[234:235], v4 offset:59136
    s_waitcnt lgkmcnt(6)
    v_mfma_f32_16x16x32_bf16 v[48:51], v[244:247], v[96:99], v[48:51]
    ds_read_b64_tr_b16 v[236:237], v5 offset:58144
    v_mfma_f32_16x16x32_bf16 v[52:55], v[244:247], v[100:103], v[52:55]
    ds_read_b64_tr_b16 v[238:239], v5 offset:59168
    s_waitcnt lgkmcnt(6)
    v_mfma_f32_16x16x32_bf16 v[56:59], v[224:227], v[96:99], v[56:59]
    v_mfma_f32_16x16x32_bf16 v[60:63], v[224:227], v[100:103], v[60:63]
    s_waitcnt lgkmcnt(4)
    v_mfma_f32_16x16x32_bf16 v[64:67], v[228:231], v[96:99], v[64:67]
    v_mfma_f32_16x16x32_bf16 v[68:71], v[228:231], v[100:103], v[68:71]
    s_waitcnt lgkmcnt(2)
    v_mfma_f32_16x16x32_bf16 v[72:75], v[232:235], v[96:99], v[72:75]
    v_mfma_f32_16x16x32_bf16 v[76:79], v[232:235], v[100:103], v[76:79]
    s_waitcnt lgkmcnt(0)
    v_mfma_f32_16x16x32_bf16 v[80:83], v[236:239], v[96:99], v[80:83]
    v_mfma_f32_16x16x32_bf16 v[84:87], v[236:239], v[100:103], v[84:87]
    s_barrier
    s_add_u32 s22, s21, 0x8000
    s_add_u32 m0, s20, 0x20000
    s_nop 0
    buffer_load_dwordx4 v2, s[8:11], s22 offen sc1 lds
    s_add_u32 s22, s21, 0x8400
    s_add_u32 m0, s20, 0x20400
    s_nop 0
    buffer_load_dwordx4 v2, s[8:11], s22 offen sc1 lds
    s_add_u32 s22, s21, 0xc000
    s_add_u32 m0, s20, 0x24000
    s_nop 0
    buffer_load_dwordx4 v2, s[8:11], s22 offen sc1 lds
    s_add_u32 s22, s21, 0xc400
    s_add_u32 m0, s20, 0x24400
    s_nop 0
    buffer_load_dwordx4 v2, s[8:11], s22 offen sc1 lds
    ds_read_b64_tr_b16 v[88:89], v11 offset:0
    ds_read_b64_tr_b16 v[90:91], v11 offset:1024
    ds_read_b64_tr_b16 v[92:93], v11 offset:8192
    ds_read_b64_tr_b16 v[94:95], v11 offset:9216
    ds_read_b64_tr_b16 v[96:97], v11 offset:16384
    ds_read_b64_tr_b16 v[98:99], v11 offset:17408
    ds_read_b64_tr_b16 v[100:101], v11 offset:24576
    ds_read_b64_tr_b16 v[102:103], v11 offset:25600
    s_mov_b32 s23, 0x3e0293ee
    v_mul_f32 v24, s23, v24
    v_mul_f32 v25, s23, v25
    v_mul_f32 v26, s23, v26
    v_mul_f32 v27, s23, v27
    v_mul_f32 v28, s23, v28
    v_mul_f32 v29, s23, v29
    v_mul_f32 v30, s23, v30
    v_mul_f32 v31, s23, v31
    v_mul_f32 v32, s23, v32
    v_mul_f32 v33, s23, v33
    v_mul_f32 v34, s23, v34
    v_mul_f32 v35, s23, v35
    v_mul_f32 v36, s23, v36
    v_mul_f32 v37, s23, v37
    v_mul_f32 v38, s23, v38
    v_mul_f32 v39, s23, v39
    v_cvt_pk_bf16_f32 v152, v24, v25
    v_cvt_pk_bf16_f32 v153, v26, v27
    v_cvt_pk_bf16_f32 v168, v28, v29
    v_cvt_pk_bf16_f32 v169, v30, v31
    v_cvt_pk_bf16_f32 v154, v32, v33
    v_cvt_pk_bf16_f32 v155, v34, v35
    v_cvt_pk_bf16_f32 v170, v36, v37
    v_cvt_pk_bf16_f32 v171, v38, v39
    s_waitcnt lgkmcnt(6)
    v_mfma_f32_16x16x32_bf16 v[104:107], v[88:91], v[136:139], 0
    s_waitcnt lgkmcnt(4)
    v_mfma_f32_16x16x32_bf16 v[104:107], v[92:95], v[140:143], v[104:107]
    s_waitcnt lgkmcnt(2)
    v_mfma_f32_16x16x32_bf16 v[104:107], v[96:99], v[144:147], v[104:107]
    s_waitcnt lgkmcnt(0)
    v_mfma_f32_16x16x32_bf16 v[104:107], v[100:103], v[148:151], v[104:107]
    v_add_u32 v4, 0x10000, v2
    v_add_u32 v5, 0x20000, v2
    s_barrier
    ds_read_b128 v[224:227], v4 offset:32768
    ds_read_b128 v[228:231], v4 offset:33792
    ds_read_b128 v[232:235], v4 offset:34816
    ds_read_b128 v[236:239], v4 offset:35840
    v_mov_b32 v12, 0x3f803f80
    v_mov_b32 v13, 0x3f803f80
    v_mov_b32 v14, 0x3f803f80
    v_mov_b32 v15, 0x3f803f80
    s_waitcnt lgkmcnt(3)
    v_mfma_f32_16x16x32_bf16 v[184:187], v[224:227], v[152:155], 0
    v_mul_f32 v40, s23, v40
    v_mul_f32 v41, s23, v41
    v_mul_f32 v42, s23, v42
    v_mul_f32 v43, s23, v43
    v_mul_f32 v44, s23, v44
    v_mul_f32 v45, s23, v45
    v_lshrrev_b32 v20, 4, v1
    v_lshlrev_b32 v20, 4, v20
    s_lshr_b32 s16, s2, 5
    s_lshl_b32 s16, s16, 14
    s_and_b32 s17, s2, 31
    s_lshl_b32 s17, s17, 9
    s_add_u32 s16, s16, s17
    s_lshl_b32 s17, s3, 6
    s_add_u32 s16, s16, s17
    s_add_u32 s16, s16, 0x580000
    s_mov_b32 exec_lo, 0x10001
    s_mov_b32 exec_hi, 0x10001
    buffer_store_dwordx4 v[104:107], v20, s[8:11], s16 offen sc1
    s_mov_b64 exec, -1
    v_mfma_f32_16x16x32_bf16 v[188:191], v[224:227], v[168:171], 0
    ds_read_b128 v[240:243], v4 offset:36864
    v_mul_f32 v46, s23, v46
    v_mul_f32 v47, s23, v47
    v_mul_f32 v48, s23, v48
    v_mul_f32 v49, s23, v49
    v_mul_f32 v50, s23, v50
    v_mul_f32 v51, s23, v51
    s_and_b32 s29, s2, 7
    s_mul_i32 s29, s29, 28
    s_lshr_b32 s16, s2, 3
    s_add_u32 s29, s29, s16
    s_waitcnt lgkmcnt(3)
    v_mfma_f32_16x16x32_bf16 v[192:195], v[228:231], v[152:155], 0
    s_add_u32 s22, s21, 0x10000
    s_add_u32 m0, s20, 0x10000
    s_nop 0
    buffer_load_dwordx4 v2, s[8:11], s22 offen sc1 lds
    v_mul_f32 v52, s23, v52
    v_mul_f32 v53, s23, v53
    v_mul_f32 v54, s23, v54
    v_mul_f32 v55, s23, v55
    v_cvt_pk_bf16_f32 v156, v40, v41
    v_cvt_pk_bf16_f32 v157, v42, v43
    v_mfma_f32_16x16x32_bf16 v[196:199], v[228:231], v[168:171], 0
    ds_read_b128 v[244:247], v4 offset:37888
    v_cvt_pk_bf16_f32 v172, v44, v45
    v_cvt_pk_bf16_f32 v173, v46, v47
    v_cvt_pk_bf16_f32 v158, v48, v49
    v_cvt_pk_bf16_f32 v159, v50, v51
    v_cvt_pk_bf16_f32 v174, v52, v53
    v_cvt_pk_bf16_f32 v175, v54, v55
    s_waitcnt lgkmcnt(3)
    v_mfma_f32_16x16x32_bf16 v[184:187], v[232:235], v[156:159], v[184:187]
    v_mul_f32 v56, s23, v56
    v_mul_f32 v57, s23, v57
    v_mul_f32 v58, s23, v58
    v_mul_f32 v59, s23, v59
    v_mul_f32 v60, s23, v60
    v_mul_f32 v61, s23, v61
    v_mfma_f32_16x16x32_bf16 v[188:191], v[232:235], v[172:175], v[188:191]
    ds_read_b128 v[224:227], v4 offset:38912
    v_mul_f32 v62, s23, v62
    v_mul_f32 v63, s23, v63
    v_mul_f32 v64, s23, v64
    v_mul_f32 v65, s23, v65
    v_mul_f32 v66, s23, v66
    v_mul_f32 v67, s23, v67
    s_waitcnt lgkmcnt(3)
    v_mfma_f32_16x16x32_bf16 v[192:195], v[236:239], v[156:159], v[192:195]
    v_mul_f32 v68, s23, v68
    v_mul_f32 v69, s23, v69
    v_mul_f32 v70, s23, v70
    v_mul_f32 v71, s23, v71
    v_cvt_pk_bf16_f32 v160, v56, v57
    v_cvt_pk_bf16_f32 v161, v58, v59
    v_mfma_f32_16x16x32_bf16 v[196:199], v[236:239], v[172:175], v[196:199]
    ds_read_b128 v[228:231], v4 offset:39936
    v_cvt_pk_bf16_f32 v176, v60, v61
    v_cvt_pk_bf16_f32 v177, v62, v63
    v_cvt_pk_bf16_f32 v162, v64, v65
    v_cvt_pk_bf16_f32 v163, v66, v67
    v_cvt_pk_bf16_f32 v178, v68, v69
    v_cvt_pk_bf16_f32 v179, v70, v71
    s_waitcnt lgkmcnt(3)
    v_mfma_f32_16x16x32_bf16 v[184:187], v[240:243], v[160:163], v[184:187]
    v_mul_f32 v72, s23, v72
    v_mul_f32 v73, s23, v73
    v_mul_f32 v74, s23, v74
    v_mul_f32 v75, s23, v75
    v_mul_f32 v76, s23, v76
    v_mul_f32 v77, s23, v77
    v_mfma_f32_16x16x32_bf16 v[188:191], v[240:243], v[176:179], v[188:191]
    ds_read_b128 v[232:235], v4 offset:40960
    v_mul_f32 v78, s23, v78
    v_mul_f32 v79, s23, v79
    v_mul_f32 v80, s23, v80
    v_mul_f32 v81, s23, v81
    v_mul_f32 v82, s23, v82
    v_mul_f32 v83, s23, v83
    s_waitcnt lgkmcnt(3)
    v_mfma_f32_16x16x32_bf16 v[192:195], v[244:247], v[160:163], v[192:195]
    s_add_u32 s22, s21, 0x10400
    s_add_u32 m0, s20, 0x10400
    s_nop 0
    buffer_load_dwordx4 v2, s[8:11], s22 offen sc1 lds
    v_mul_f32 v84, s23, v84
    v_mul_f32 v85, s23, v85
    v_mul_f32 v86, s23, v86
    v_mul_f32 v87, s23, v87
    v_cvt_pk_bf16_f32 v164, v72, v73
    v_cvt_pk_bf16_f32 v165, v74, v75
    v_mfma_f32_16x16x32_bf16 v[196:199], v[244:247], v[176:179], v[196:199]
    ds_read_b128 v[236:239], v4 offset:41984
    v_cvt_pk_bf16_f32 v180, v76, v77
    v_cvt_pk_bf16_f32 v181, v78, v79
    v_cvt_pk_bf16_f32 v166, v80, v81
    v_cvt_pk_bf16_f32 v167, v82, v83
    v_cvt_pk_bf16_f32 v182, v84, v85
    v_cvt_pk_bf16_f32 v183, v86, v87
    s_waitcnt lgkmcnt(3)
    v_mfma_f32_16x16x32_bf16 v[184:187], v[224:227], v[164:167], v[184:187]
    v_mfma_f32_16x16x32_bf16 v[188:191], v[224:227], v[180:183], v[188:191]
    ds_read_b128 v[240:243], v4 offset:43008
    s_waitcnt lgkmcnt(3)
    v_mfma_f32_16x16x32_bf16 v[192:195], v[228:231], v[164:167], v[192:195]
    v_mfma_f32_16x16x32_bf16 v[196:199], v[228:231], v[180:183], v[196:199]
    ds_read_b128 v[244:247], v4 offset:44032
    s_waitcnt lgkmcnt(3)
    v_mfma_f32_16x16x32_bf16 v[200:203], v[232:235], v[152:155], 0
    v_mfma_f32_16x16x32_bf16 v[204:207], v[232:235], v[168:171], 0
    ds_read_b128 v[224:227], v4 offset:45056
    s_waitcnt lgkmcnt(3)
    v_mfma_f32_16x16x32_bf16 v[208:211], v[236:239], v[152:155], 0
    v_mfma_f32_16x16x32_bf16 v[212:215], v[236:239], v[168:171], 0
    ds_read_b128 v[228:231], v4 offset:46080
    s_waitcnt lgkmcnt(3)
    v_mfma_f32_16x16x32_bf16 v[200:203], v[240:243], v[156:159], v[200:203]
    v_mfma_f32_16x16x32_bf16 v[204:207], v[240:243], v[172:175], v[204:207]
    ds_read_b128 v[232:235], v4 offset:47104
    s_waitcnt lgkmcnt(3)
    v_mfma_f32_16x16x32_bf16 v[208:211], v[244:247], v[156:159], v[208:211]
    v_max3_f32 v16, v184, v185, v186
    v_mfma_f32_16x16x32_bf16 v[212:215], v[244:247], v[172:175], v[212:215]
    ds_read_b128 v[236:239], v4 offset:48128
    v_max3_f32 v16, v16, v187, v192
    s_waitcnt lgkmcnt(3)
    v_mfma_f32_16x16x32_bf16 v[200:203], v[224:227], v[160:163], v[200:203]
    v_max3_f32 v16, v16, v193, v194
    v_mfma_f32_16x16x32_bf16 v[204:207], v[224:227], v[176:179], v[204:207]
    s_barrier
    ds_read_b128 v[240:243], v4 offset:49152
    v_max_f32 v16, v16, v195
    s_waitcnt lgkmcnt(3)
    v_mfma_f32_16x16x32_bf16 v[208:211], v[228:231], v[160:163], v[208:211]
    v_max3_f32 v17, v188, v189, v190
    v_mfma_f32_16x16x32_bf16 v[212:215], v[228:231], v[176:179], v[212:215]
    s_add_u32 s22, s21, 0x14000
    s_add_u32 m0, s20, 0x14000
    s_nop 0
    buffer_load_dwordx4 v2, s[8:11], s22 offen sc1 lds
    ds_read_b128 v[244:247], v4 offset:50176
    v_max3_f32 v17, v17, v191, v196
    s_waitcnt lgkmcnt(3)
    v_mfma_f32_16x16x32_bf16 v[200:203], v[232:235], v[164:167], v[200:203]
    v_max3_f32 v17, v17, v197, v198
    v_mfma_f32_16x16x32_bf16 v[204:207], v[232:235], v[180:183], v[204:207]
    ds_read_b128 v[224:227], v4 offset:51200
    v_max_f32 v17, v17, v199
    s_waitcnt lgkmcnt(3)
    v_mfma_f32_16x16x32_bf16 v[208:211], v[236:239], v[164:167], v[208:211]
    v_mfma_f32_16x16x32_bf16 v[212:215], v[236:239], v[180:183], v[212:215]
    ds_read_b128 v[228:231], v4 offset:52224
    v_max3_f32 v16, v16, v200, v201
    v_max3_f32 v16, v16, v202, v203
    s_nop 3
    v_max3_f32 v16, v16, v208, v209
    v_max3_f32 v16, v16, v210, v211
    v_max3_f32 v17, v17, v204, v205
    v_max3_f32 v17, v17, v206, v207
    v_max3_f32 v17, v17, v212, v213
    v_max3_f32 v17, v17, v214, v215
    v_mov_b32 v18, v16
    v_mov_b32 v19, v17
    s_nop 0
    v_permlane16_swap_b32 v16, v18
    v_permlane16_swap_b32 v17, v19
    v_max_f32 v16, v16, v18
    v_max_f32 v17, v17, v19
    v_mov_b32 v18, v16
    v_mov_b32 v19, v17
    s_nop 0
    v_permlane32_swap_b32 v16, v18
    v_permlane32_swap_b32 v17, v19
    v_max_f32 v16, v16, v18
    v_max_f32 v17, v17, v19
    v_sub_f32 v216, 0, v16
    v_sub_f32 v217, 0, v16
    v_sub_f32 v218, 0, v16
    v_sub_f32 v219, 0, v16
    v_sub_f32 v220, 0, v17
    v_sub_f32 v221, 0, v17
    v_sub_f32 v222, 0, v17
    v_sub_f32 v223, 0, v17
    v_add_f32 v184, v184, v216
    v_add_f32 v185, v185, v216
    v_exp_f32 v184, v184
    v_exp_f32 v185, v185
    s_nop 0
    v_cvt_pk_bf16_f32 v24, v184, v185
    v_add_f32 v186, v186, v216
    v_add_f32 v187, v187, v216
    v_exp_f32 v186, v186
    v_exp_f32 v187, v187
    s_nop 0
    v_cvt_pk_bf16_f32 v25, v186, v187
    v_add_f32 v188, v188, v220
    v_add_f32 v189, v189, v220
    v_exp_f32 v188, v188
    v_exp_f32 v189, v189
    s_nop 0
    v_cvt_pk_bf16_f32 v28, v188, v189
    v_add_f32 v190, v190, v220
    v_add_f32 v191, v191, v220
    v_exp_f32 v190, v190
    v_exp_f32 v191, v191
    s_nop 0
    v_cvt_pk_bf16_f32 v29, v190, v191
    v_add_f32 v192, v192, v216
    v_add_f32 v193, v193, v216
    v_exp_f32 v192, v192
    v_exp_f32 v193, v193
    s_nop 0
    v_cvt_pk_bf16_f32 v26, v192, v193
    v_add_f32 v194, v194, v216
    v_add_f32 v195, v195, v216
    v_exp_f32 v194, v194
    v_exp_f32 v195, v195
    s_nop 0
    v_cvt_pk_bf16_f32 v27, v194, v195
    v_add_f32 v196, v196, v220
    v_add_f32 v197, v197, v220
    v_exp_f32 v196, v196
    v_exp_f32 v197, v197
    s_nop 0
    v_cvt_pk_bf16_f32 v30, v196, v197
    v_add_f32 v198, v198, v220
    v_add_f32 v199, v199, v220
    v_exp_f32 v198, v198
    v_exp_f32 v199, v199
    s_nop 0
    v_cvt_pk_bf16_f32 v31, v198, v199
    s_waitcnt lgkmcnt(3)
    v_mfma_f32_16x16x32_bf16 v[184:187], v[240:243], v[152:155], v[216:219]
    v_mfma_f32_16x16x32_bf16 v[188:191], v[240:243], v[168:171], v[220:223]
    ds_read_b128 v[232:235], v4 offset:53248
    v_add_f32 v200, v200, v216
    v_add_f32 v201, v201, v216
    v_exp_f32 v200, v200
    v_mfma_f32_16x16x32_bf16 v[248:251], v[12:15], v[24:27], 0
    s_waitcnt lgkmcnt(3)
    v_mfma_f32_16x16x32_bf16 v[192:195], v[244:247], v[152:155], v[216:219]
    v_exp_f32 v201, v201
    s_nop 0
    v_cvt_pk_bf16_f32 v32, v200, v201
    v_add_f32 v202, v202, v216
    v_mfma_f32_16x16x32_bf16 v[196:199], v[244:247], v[168:171], v[220:223]
    s_add_u32 s22, s21, 0x14400
    s_add_u32 m0, s20, 0x14400
    s_nop 0
    buffer_load_dwordx4 v2, s[8:11], s22 offen sc1 lds
    ds_read_b128 v[236:239], v4 offset:54272
    v_add_f32 v203, v203, v216
    v_exp_f32 v202, v202
    v_mfma_f32_16x16x32_bf16 v[252:255], v[12:15], v[28:31], 0
    s_waitcnt lgkmcnt(3)
    v_mfma_f32_16x16x32_bf16 v[184:187], v[224:227], v[156:159], v[184:187]
    v_exp_f32 v203, v203
    s_nop 0
    v_cvt_pk_bf16_f32 v33, v202, v203
    v_add_f32 v204, v204, v220
    v_mfma_f32_16x16x32_bf16 v[188:191], v[224:227], v[172:175], v[188:191]
    ds_read_b128 v[240:243], v4 offset:55296
    v_add_f32 v205, v205, v220
    v_exp_f32 v204, v204
    v_exp_f32 v205, v205
    s_mov_b64 s[4:5], s[40:41]
    s_mov_b32 s6, 0x800000
    s_mov_b32 s7, 0x20000
    v_bfe_u32 v20, v1, 2, 2
    v_lshlrev_b32 v21, 13, v20
    v_sub_u32 v3, v3, v21
    v_lshl_add_u32 v3, v20, 11, v3
    s_and_b32 s16, s2, 1
    s_lshl_b32 s24, s16, 22
    s_lshr_b32 s16, s2, 5
    s_lshl_b32 s16, s16, 8
    s_add_u32 s24, s24, s16
    s_lshl_b32 s16, s3, 14
    s_add_u32 s24, s24, s16
    s_waitcnt lgkmcnt(3)
    v_mfma_f32_16x16x32_bf16 v[192:195], v[228:231], v[156:159], v[192:195]
    v_cvt_pk_bf16_f32 v36, v204, v205
    v_add_f32 v206, v206, v220
    v_mfma_f32_16x16x32_bf16 v[196:199], v[228:231], v[172:175], v[196:199]
    ds_read_b128 v[244:247], v4 offset:56320
    v_add_f32 v207, v207, v220
    v_exp_f32 v206, v206
    v_exp_f32 v207, v207
    s_waitcnt lgkmcnt(3)
    v_mfma_f32_16x16x32_bf16 v[184:187], v[232:235], v[160:163], v[184:187]
    v_cvt_pk_bf16_f32 v37, v206, v207
    v_add_f32 v208, v208, v216
    v_add_f32 v209, v209, v216
    v_mfma_f32_16x16x32_bf16 v[188:191], v[232:235], v[176:179], v[188:191]
    ds_read_b128 v[224:227], v4 offset:57344
    v_exp_f32 v208, v208
    v_exp_f32 v209, v209
    s_waitcnt lgkmcnt(3)
    v_mfma_f32_16x16x32_bf16 v[192:195], v[236:239], v[160:163], v[192:195]
    v_cvt_pk_bf16_f32 v34, v208, v209
    v_add_f32 v210, v210, v216
    v_add_f32 v211, v211, v216
    v_mfma_f32_16x16x32_bf16 v[196:199], v[236:239], v[176:179], v[196:199]
    ds_read_b128 v[228:231], v4 offset:58368
    v_exp_f32 v210, v210
    v_exp_f32 v211, v211
    s_nop 0
    v_cvt_pk_bf16_f32 v35, v210, v211
    s_waitcnt lgkmcnt(3)
    v_mfma_f32_16x16x32_bf16 v[184:187], v[240:243], v[164:167], v[184:187]
    v_add_f32 v212, v212, v220
    v_add_f32 v213, v213, v220
    v_mfma_f32_16x16x32_bf16 v[188:191], v[240:243], v[180:183], v[188:191]
    ds_read_b128 v[232:235], v4 offset:59392
    v_exp_f32 v212, v212
    v_exp_f32 v213, v213
    s_nop 0
    v_cvt_pk_bf16_f32 v38, v212, v213
    s_waitcnt lgkmcnt(3)
    v_mfma_f32_16x16x32_bf16 v[192:195], v[244:247], v[164:167], v[192:195]
    v_add_f32 v214, v214, v220
    v_add_f32 v215, v215, v220
    v_exp_f32 v214, v214
    v_mfma_f32_16x16x32_bf16 v[196:199], v[244:247], v[180:183], v[196:199]
    ds_read_b128 v[236:239], v4 offset:60416
    v_exp_f32 v215, v215
    s_nop 0
    v_cvt_pk_bf16_f32 v39, v214, v215
    s_waitcnt lgkmcnt(3)
    v_mfma_f32_16x16x32_bf16 v[200:203], v[224:227], v[152:155], v[216:219]
    v_mfma_f32_16x16x32_bf16 v[204:207], v[224:227], v[168:171], v[220:223]
    ds_read_b128 v[240:243], v4 offset:61440
    v_exp_f32 v184, v184
    v_exp_f32 v185, v185
    v_mfma_f32_16x16x32_bf16 v[248:251], v[12:15], v[32:35], v[248:251]
    s_waitcnt lgkmcnt(3)
    v_mfma_f32_16x16x32_bf16 v[208:211], v[228:231], v[152:155], v[216:219]
    v_cvt_pk_bf16_f32 v40, v184, v185
    v_exp_f32 v186, v186
    v_mfma_f32_16x16x32_bf16 v[212:215], v[228:231], v[168:171], v[220:223]
    ds_read_b128 v[244:247], v4 offset:62464
    v_exp_f32 v187, v187
    v_mfma_f32_16x16x32_bf16 v[252:255], v[12:15], v[36:39], v[252:255]
    s_waitcnt lgkmcnt(3)
    v_mfma_f32_16x16x32_bf16 v[200:203], v[232:235], v[156:159], v[200:203]
    v_cvt_pk_bf16_f32 v41, v186, v187
    v_exp_f32 v188, v188
    v_mfma_f32_16x16x32_bf16 v[204:207], v[232:235], v[172:175], v[204:207]
    ds_read_b128 v[224:227], v4 offset:63488
    v_exp_f32 v189, v189
    s_waitcnt lgkmcnt(3)
    v_mfma_f32_16x16x32_bf16 v[208:211], v[236:239], v[156:159], v[208:211]
    v_cvt_pk_bf16_f32 v44, v188, v189
    v_exp_f32 v190, v190
    v_mfma_f32_16x16x32_bf16 v[212:215], v[236:239], v[172:175], v[212:215]
    ds_read_b128 v[228:231], v4 offset:64512
    v_exp_f32 v191, v191
    s_nop 0
    v_cvt_pk_bf16_f32 v45, v190, v191
    s_waitcnt lgkmcnt(3)
    v_mfma_f32_16x16x32_bf16 v[200:203], v[240:243], v[160:163], v[200:203]
    v_exp_f32 v192, v192
    v_mfma_f32_16x16x32_bf16 v[204:207], v[240:243], v[176:179], v[204:207]
    s_waitcnt vmcnt(7)
    s_barrier
    ds_read_b128 v[232:235], v5 offset:0
    v_exp_f32 v193, v193
    s_nop 0
    v_cvt_pk_bf16_f32 v42, v192, v193
    s_waitcnt lgkmcnt(3)
    v_mfma_f32_16x16x32_bf16 v[208:211], v[244:247], v[160:163], v[208:211]
    v_exp_f32 v194, v194
    v_mfma_f32_16x16x32_bf16 v[212:215], v[244:247], v[176:179], v[212:215]
    s_add_u32 s22, s21, 0x18000
    s_add_u32 m0, s20, 0x18000
    s_nop 0
    buffer_load_dwordx4 v2, s[8:11], s22 offen sc1 lds
    ds_read_b128 v[236:239], v5 offset:1024
    v_exp_f32 v195, v195
    s_nop 0
    v_cvt_pk_bf16_f32 v43, v194, v195
    s_waitcnt lgkmcnt(3)
    v_mfma_f32_16x16x32_bf16 v[200:203], v[224:227], v[164:167], v[200:203]
    v_exp_f32 v196, v196
    v_exp_f32 v197, v197
    v_mfma_f32_16x16x32_bf16 v[204:207], v[224:227], v[180:183], v[204:207]
    ds_read_b128 v[240:243], v5 offset:2048
    v_cvt_pk_bf16_f32 v46, v196, v197
    s_waitcnt lgkmcnt(3)
    v_mfma_f32_16x16x32_bf16 v[208:211], v[228:231], v[164:167], v[208:211]
    v_exp_f32 v198, v198
    v_exp_f32 v199, v199
    v_mfma_f32_16x16x32_bf16 v[212:215], v[228:231], v[180:183], v[212:215]
    ds_read_b128 v[244:247], v5 offset:3072
    v_cvt_pk_bf16_f32 v47, v198, v199
    s_waitcnt lgkmcnt(3)
    v_mfma_f32_16x16x32_bf16 v[184:187], v[232:235], v[152:155], v[216:219]
    v_mfma_f32_16x16x32_bf16 v[188:191], v[232:235], v[168:171], v[220:223]
    ds_read_b128 v[224:227], v5 offset:4096
    v_exp_f32 v200, v200
    v_exp_f32 v201, v201
    v_mfma_f32_16x16x32_bf16 v[248:251], v[12:15], v[40:43], v[248:251]
    s_waitcnt lgkmcnt(3)
    v_mfma_f32_16x16x32_bf16 v[192:195], v[236:239], v[152:155], v[216:219]
    v_cvt_pk_bf16_f32 v48, v200, v201
    v_exp_f32 v202, v202
    v_mfma_f32_16x16x32_bf16 v[196:199], v[236:239], v[168:171], v[220:223]
    s_add_u32 s22, s21, 0x18400
    s_add_u32 m0, s20, 0x18400
    s_nop 0
    buffer_load_dwordx4 v2, s[8:11], s22 offen sc1 lds
    ds_read_b128 v[228:231], v5 offset:5120
    v_exp_f32 v203, v203
    v_mfma_f32_16x16x32_bf16 v[252:255], v[12:15], v[44:47], v[252:255]
    s_waitcnt lgkmcnt(3)
    v_mfma_f32_16x16x32_bf16 v[184:187], v[240:243], v[156:159], v[184:187]
    v_cvt_pk_bf16_f32 v49, v202, v203
    v_exp_f32 v204, v204
    v_mfma_f32_16x16x32_bf16 v[188:191], v[240:243], v[172:175], v[188:191]
    ds_read_b128 v[232:235], v5 offset:6144
    v_exp_f32 v205, v205
    s_waitcnt lgkmcnt(3)
    v_mfma_f32_16x16x32_bf16 v[192:195], v[244:247], v[156:159], v[192:195]
    v_cvt_pk_bf16_f32 v52, v204, v205
    v_exp_f32 v206, v206
    v_mfma_f32_16x16x32_bf16 v[196:199], v[244:247], v[172:175], v[196:199]
    ds_read_b128 v[236:239], v5 offset:7168
    v_exp_f32 v207, v207
    s_nop 0
    v_cvt_pk_bf16_f32 v53, v206, v207
    s_waitcnt lgkmcnt(3)
    v_mfma_f32_16x16x32_bf16 v[184:187], v[224:227], v[160:163], v[184:187]
    v_exp_f32 v208, v208
    v_mfma_f32_16x16x32_bf16 v[188:191], v[224:227], v[176:179], v[188:191]
    ds_read_b128 v[240:243], v5 offset:8192
    v_exp_f32 v209, v209
    s_nop 0
    v_cvt_pk_bf16_f32 v50, v208, v209
    s_waitcnt lgkmcnt(3)
    v_mfma_f32_16x16x32_bf16 v[192:195], v[228:231], v[160:163], v[192:195]
    v_exp_f32 v210, v210
    v_mfma_f32_16x16x32_bf16 v[196:199], v[228:231], v[176:179], v[196:199]
    ds_read_b128 v[244:247], v5 offset:9216
    v_exp_f32 v211, v211
    s_nop 0
    v_cvt_pk_bf16_f32 v51, v210, v211
    s_waitcnt lgkmcnt(3)
    v_mfma_f32_16x16x32_bf16 v[184:187], v[232:235], v[164:167], v[184:187]
    v_exp_f32 v212, v212
    v_exp_f32 v213, v213
    v_mfma_f32_16x16x32_bf16 v[188:191], v[232:235], v[180:183], v[188:191]
    ds_read_b128 v[224:227], v5 offset:10240
    v_cvt_pk_bf16_f32 v54, v212, v213
    s_waitcnt lgkmcnt(3)
    v_mfma_f32_16x16x32_bf16 v[192:195], v[236:239], v[164:167], v[192:195]
    v_exp_f32 v214, v214
    v_exp_f32 v215, v215
    v_mfma_f32_16x16x32_bf16 v[196:199], v[236:239], v[180:183], v[196:199]
    ds_read_b128 v[228:231], v5 offset:11264
    v_cvt_pk_bf16_f32 v55, v214, v215
    s_waitcnt lgkmcnt(3)
    v_mfma_f32_16x16x32_bf16 v[200:203], v[240:243], v[152:155], v[216:219]
    v_mfma_f32_16x16x32_bf16 v[204:207], v[240:243], v[168:171], v[220:223]
    ds_read_b128 v[232:235], v5 offset:12288
    v_exp_f32 v184, v184
    v_exp_f32 v185, v185
    v_mfma_f32_16x16x32_bf16 v[248:251], v[12:15], v[48:51], v[248:251]
    s_waitcnt lgkmcnt(3)
    v_mfma_f32_16x16x32_bf16 v[208:211], v[244:247], v[152:155], v[216:219]
    v_cvt_pk_bf16_f32 v56, v184, v185
    v_exp_f32 v186, v186
    v_mfma_f32_16x16x32_bf16 v[212:215], v[244:247], v[168:171], v[220:223]
    ds_read_b128 v[236:239], v5 offset:13312
    v_exp_f32 v187, v187
    v_mfma_f32_16x16x32_bf16 v[252:255], v[12:15], v[52:55], v[252:255]
    s_waitcnt lgkmcnt(3)
    v_mfma_f32_16x16x32_bf16 v[200:203], v[224:227], v[156:159], v[200:203]
    v_cvt_pk_bf16_f32 v57, v186, v187
    v_exp_f32 v188, v188
    v_mfma_f32_16x16x32_bf16 v[204:207], v[224:227], v[172:175], v[204:207]
    ds_read_b128 v[240:243], v5 offset:14336
    v_exp_f32 v189, v189
    s_waitcnt lgkmcnt(3)
    v_mfma_f32_16x16x32_bf16 v[208:211], v[228:231], v[156:159], v[208:211]
    v_cvt_pk_bf16_f32 v60, v188, v189
    v_exp_f32 v190, v190
    s_waitcnt vmcnt(6)
    v_mfma_f32_16x16x32_bf16 v[212:215], v[228:231], v[172:175], v[212:215]
    ds_read_b128 v[244:247], v5 offset:15360
    v_exp_f32 v191, v191
    s_nop 0
    v_cvt_pk_bf16_f32 v61, v190, v191
    s_waitcnt lgkmcnt(3)
    v_mfma_f32_16x16x32_bf16 v[200:203], v[232:235], v[160:163], v[200:203]
    v_exp_f32 v192, v192
    v_mfma_f32_16x16x32_bf16 v[204:207], v[232:235], v[176:179], v[204:207]
    s_barrier
    ds_read_b128 v[224:227], v5 offset:16384
    v_exp_f32 v193, v193
    s_nop 0
    v_cvt_pk_bf16_f32 v58, v192, v193
    s_waitcnt lgkmcnt(3)
    v_mfma_f32_16x16x32_bf16 v[208:211], v[236:239], v[160:163], v[208:211]
    v_exp_f32 v194, v194
    v_mfma_f32_16x16x32_bf16 v[212:215], v[236:239], v[176:179], v[212:215]
    s_add_u32 s22, s21, 0x1c000
    s_add_u32 m0, s20, 0x1c000
    s_nop 0
    buffer_load_dwordx4 v2, s[8:11], s22 offen sc1 lds
    ds_read_b128 v[228:231], v5 offset:17408
    v_exp_f32 v195, v195
    s_nop 0
    v_cvt_pk_bf16_f32 v59, v194, v195
    s_waitcnt lgkmcnt(3)
    v_mfma_f32_16x16x32_bf16 v[200:203], v[240:243], v[164:167], v[200:203]
    v_exp_f32 v196, v196
    v_exp_f32 v197, v197
    v_mfma_f32_16x16x32_bf16 v[204:207], v[240:243], v[180:183], v[204:207]
    ds_read_b128 v[232:235], v5 offset:18432
    v_cvt_pk_bf16_f32 v62, v196, v197
    s_waitcnt lgkmcnt(3)
    v_mfma_f32_16x16x32_bf16 v[208:211], v[244:247], v[164:167], v[208:211]
    v_exp_f32 v198, v198
    v_exp_f32 v199, v199
    v_mov_b32 v20, s28
    v_mov_b32 v21, 0
    s_lshl_b32 s16, s2, 2
    s_add_u32 s16, s16, 0x560000
    s_cmp_eq_u32 s3, 0
    s_cselect_b32 s16, s16, 0x7ffffff0
    s_mov_b64 exec, 1
    buffer_store_dword v20, v21, s[8:11], s16 offen sc1
    s_mov_b64 exec, -1
    v_mfma_f32_16x16x32_bf16 v[212:215], v[244:247], v[180:183], v[212:215]
    ds_read_b128 v[236:239], v5 offset:19456
    v_cvt_pk_bf16_f32 v63, v198, v199
    s_waitcnt lgkmcnt(3)
    v_mfma_f32_16x16x32_bf16 v[184:187], v[224:227], v[152:155], v[216:219]
    v_mfma_f32_16x16x32_bf16 v[188:191], v[224:227], v[168:171], v[220:223]
    ds_read_b128 v[240:243], v5 offset:20480
    v_exp_f32 v200, v200
    v_exp_f32 v201, v201
    v_mfma_f32_16x16x32_bf16 v[248:251], v[12:15], v[56:59], v[248:251]
    s_waitcnt lgkmcnt(3)
    v_mfma_f32_16x16x32_bf16 v[192:195], v[228:231], v[152:155], v[216:219]
    v_cvt_pk_bf16_f32 v64, v200, v201
    v_exp_f32 v202, v202
    v_mfma_f32_16x16x32_bf16 v[196:199], v[228:231], v[168:171], v[220:223]
    s_add_u32 s22, s21, 0x1c400
    s_add_u32 m0, s20, 0x1c400
    s_nop 0
    buffer_load_dwordx4 v2, s[8:11], s22 offen sc1 lds
    ds_read_b128 v[244:247], v5 offset:21504
    v_exp_f32 v203, v203
    v_mfma_f32_16x16x32_bf16 v[252:255], v[12:15], v[60:63], v[252:255]
    s_waitcnt lgkmcnt(3)
    v_mfma_f32_16x16x32_bf16 v[184:187], v[232:235], v[156:159], v[184:187]
    v_cvt_pk_bf16_f32 v65, v202, v203
    v_exp_f32 v204, v204
    v_mfma_f32_16x16x32_bf16 v[188:191], v[232:235], v[172:175], v[188:191]
    ds_read_b128 v[224:227], v5 offset:22528
    v_exp_f32 v205, v205
    s_waitcnt lgkmcnt(3)
    v_mfma_f32_16x16x32_bf16 v[192:195], v[236:239], v[156:159], v[192:195]
    v_cvt_pk_bf16_f32 v68, v204, v205
    v_exp_f32 v206, v206
    v_mfma_f32_16x16x32_bf16 v[196:199], v[236:239], v[172:175], v[196:199]
    ds_read_b128 v[228:231], v5 offset:23552
    v_exp_f32 v207, v207
    s_nop 0
    v_cvt_pk_bf16_f32 v69, v206, v207
    s_waitcnt lgkmcnt(3)
    v_mfma_f32_16x16x32_bf16 v[184:187], v[240:243], v[160:163], v[184:187]
    v_exp_f32 v208, v208
    v_mfma_f32_16x16x32_bf16 v[188:191], v[240:243], v[176:179], v[188:191]
    ds_read_b128 v[232:235], v5 offset:24576
    v_exp_f32 v209, v209
    s_nop 0
    v_cvt_pk_bf16_f32 v66, v208, v209
    s_waitcnt lgkmcnt(3)
    v_mfma_f32_16x16x32_bf16 v[192:195], v[244:247], v[160:163], v[192:195]
    v_exp_f32 v210, v210
    v_mfma_f32_16x16x32_bf16 v[196:199], v[244:247], v[176:179], v[196:199]
    ds_read_b128 v[236:239], v5 offset:25600
    v_exp_f32 v211, v211
    s_nop 0
    v_cvt_pk_bf16_f32 v67, v210, v211
    s_waitcnt lgkmcnt(3)
    v_mfma_f32_16x16x32_bf16 v[184:187], v[224:227], v[164:167], v[184:187]
    v_exp_f32 v212, v212
    v_exp_f32 v213, v213
    v_mfma_f32_16x16x32_bf16 v[188:191], v[224:227], v[180:183], v[188:191]
    ds_read_b128 v[240:243], v5 offset:26624
    v_cvt_pk_bf16_f32 v70, v212, v213
    s_waitcnt lgkmcnt(3)
    v_mfma_f32_16x16x32_bf16 v[192:195], v[228:231], v[164:167], v[192:195]
    v_exp_f32 v214, v214
    v_exp_f32 v215, v215
    v_mfma_f32_16x16x32_bf16 v[196:199], v[228:231], v[180:183], v[196:199]
    ds_read_b128 v[244:247], v5 offset:27648
    v_cvt_pk_bf16_f32 v71, v214, v215
    s_waitcnt lgkmcnt(3)
    v_mfma_f32_16x16x32_bf16 v[200:203], v[232:235], v[152:155], v[216:219]
    v_mfma_f32_16x16x32_bf16 v[204:207], v[232:235], v[168:171], v[220:223]
    ds_read_b128 v[224:227], v5 offset:28672
    v_exp_f32 v184, v184
    v_exp_f32 v185, v185
    v_mfma_f32_16x16x32_bf16 v[248:251], v[12:15], v[64:67], v[248:251]
    s_waitcnt lgkmcnt(3)
    v_mfma_f32_16x16x32_bf16 v[208:211], v[236:239], v[152:155], v[216:219]
    v_cvt_pk_bf16_f32 v72, v184, v185
    v_exp_f32 v186, v186
    v_mfma_f32_16x16x32_bf16 v[212:215], v[236:239], v[168:171], v[220:223]
    ds_read_b128 v[228:231], v5 offset:29696
    v_exp_f32 v187, v187
    v_mfma_f32_16x16x32_bf16 v[252:255], v[12:15], v[68:71], v[252:255]
    s_waitcnt lgkmcnt(3)
    v_mfma_f32_16x16x32_bf16 v[200:203], v[240:243], v[156:159], v[200:203]
    v_cvt_pk_bf16_f32 v73, v186, v187
    v_exp_f32 v188, v188
    v_mfma_f32_16x16x32_bf16 v[204:207], v[240:243], v[172:175], v[204:207]
    ds_read_b128 v[232:235], v5 offset:30720
    v_exp_f32 v189, v189
    s_waitcnt lgkmcnt(3)
    v_mfma_f32_16x16x32_bf16 v[208:211], v[244:247], v[156:159], v[208:211]
    v_cvt_pk_bf16_f32 v76, v188, v189
    v_exp_f32 v190, v190
    v_mfma_f32_16x16x32_bf16 v[212:215], v[244:247], v[172:175], v[212:215]
    ds_read_b128 v[236:239], v5 offset:31744
    v_exp_f32 v191, v191
    s_nop 0
    v_cvt_pk_bf16_f32 v77, v190, v191
    s_waitcnt lgkmcnt(3)
    v_mfma_f32_16x16x32_bf16 v[200:203], v[224:227], v[160:163], v[200:203]
    v_exp_f32 v192, v192
    v_mfma_f32_16x16x32_bf16 v[204:207], v[224:227], v[176:179], v[204:207]
    s_waitcnt vmcnt(7)
    s_barrier
    ds_read_b128 v[240:243], v4 offset:0
    v_exp_f32 v193, v193
    s_nop 0
    v_cvt_pk_bf16_f32 v74, v192, v193
    s_waitcnt lgkmcnt(3)
    v_mfma_f32_16x16x32_bf16 v[208:211], v[228:231], v[160:163], v[208:211]
    v_exp_f32 v194, v194
    v_mfma_f32_16x16x32_bf16 v[212:215], v[228:231], v[176:179], v[212:215]
    s_add_u32 s22, s21, 0x80000
    s_add_u32 m0, s20, 0x20000
    s_nop 0
    buffer_load_dwordx4 v2, s[8:11], s22 offen sc1 lds
    ds_read_b128 v[244:247], v4 offset:1024
    v_exp_f32 v195, v195
    s_nop 0
    v_cvt_pk_bf16_f32 v75, v194, v195
    s_waitcnt lgkmcnt(3)
    v_mfma_f32_16x16x32_bf16 v[200:203], v[232:235], v[164:167], v[200:203]
    v_exp_f32 v196, v196
    v_exp_f32 v197, v197
    v_mfma_f32_16x16x32_bf16 v[204:207], v[232:235], v[180:183], v[204:207]
    ds_read_b128 v[224:227], v4 offset:2048
    v_cvt_pk_bf16_f32 v78, v196, v197
    s_waitcnt lgkmcnt(3)
    v_mfma_f32_16x16x32_bf16 v[208:211], v[236:239], v[164:167], v[208:211]
    v_exp_f32 v198, v198
    v_exp_f32 v199, v199
    v_mfma_f32_16x16x32_bf16 v[212:215], v[236:239], v[180:183], v[212:215]
    ds_read_b128 v[228:231], v4 offset:3072
    v_cvt_pk_bf16_f32 v79, v198, v199
    s_waitcnt lgkmcnt(3)
    v_mfma_f32_16x16x32_bf16 v[184:187], v[240:243], v[152:155], v[216:219]
    v_mfma_f32_16x16x32_bf16 v[188:191], v[240:243], v[168:171], v[220:223]
    ds_read_b128 v[232:235], v4 offset:4096
    v_exp_f32 v200, v200
    v_exp_f32 v201, v201
    v_mfma_f32_16x16x32_bf16 v[248:251], v[12:15], v[72:75], v[248:251]
    s_waitcnt lgkmcnt(3)
    v_mfma_f32_16x16x32_bf16 v[192:195], v[244:247], v[152:155], v[216:219]
    v_cvt_pk_bf16_f32 v80, v200, v201
    v_exp_f32 v202, v202
    v_mfma_f32_16x16x32_bf16 v[196:199], v[244:247], v[168:171], v[220:223]
    s_add_u32 s22, s21, 0x80400
    s_add_u32 m0, s20, 0x20400
    s_nop 0
    buffer_load_dwordx4 v2, s[8:11], s22 offen sc1 lds
    ds_read_b128 v[236:239], v4 offset:5120
    v_exp_f32 v203, v203
    v_mfma_f32_16x16x32_bf16 v[252:255], v[12:15], v[76:79], v[252:255]
    s_waitcnt lgkmcnt(3)
    v_mfma_f32_16x16x32_bf16 v[184:187], v[224:227], v[156:159], v[184:187]
    v_cvt_pk_bf16_f32 v81, v202, v203
    v_exp_f32 v204, v204
    v_mfma_f32_16x16x32_bf16 v[188:191], v[224:227], v[172:175], v[188:191]
    ds_read_b128 v[240:243], v4 offset:6144
    v_exp_f32 v205, v205
    s_waitcnt lgkmcnt(3)
    v_mfma_f32_16x16x32_bf16 v[192:195], v[228:231], v[156:159], v[192:195]
    v_cvt_pk_bf16_f32 v84, v204, v205
    v_exp_f32 v206, v206
    v_mfma_f32_16x16x32_bf16 v[196:199], v[228:231], v[172:175], v[196:199]
    ds_read_b128 v[244:247], v4 offset:7168
    v_exp_f32 v207, v207
    s_nop 0
    v_cvt_pk_bf16_f32 v85, v206, v207
    s_waitcnt lgkmcnt(3)
    v_mfma_f32_16x16x32_bf16 v[184:187], v[232:235], v[160:163], v[184:187]
    v_exp_f32 v208, v208
    v_mfma_f32_16x16x32_bf16 v[188:191], v[232:235], v[176:179], v[188:191]
    ds_read_b128 v[224:227], v4 offset:8192
    v_exp_f32 v209, v209
    s_nop 0
    v_cvt_pk_bf16_f32 v82, v208, v209
    s_waitcnt lgkmcnt(3)
    v_mfma_f32_16x16x32_bf16 v[192:195], v[236:239], v[160:163], v[192:195]
    v_exp_f32 v210, v210
    v_mfma_f32_16x16x32_bf16 v[196:199], v[236:239], v[176:179], v[196:199]
    ds_read_b128 v[228:231], v4 offset:9216
    v_exp_f32 v211, v211
    s_nop 0
    v_cvt_pk_bf16_f32 v83, v210, v211
    s_waitcnt lgkmcnt(3)
    v_mfma_f32_16x16x32_bf16 v[184:187], v[240:243], v[164:167], v[184:187]
    v_exp_f32 v212, v212
    v_exp_f32 v213, v213
    v_mfma_f32_16x16x32_bf16 v[188:191], v[240:243], v[180:183], v[188:191]
    ds_read_b128 v[232:235], v4 offset:10240
    v_cvt_pk_bf16_f32 v86, v212, v213
    s_waitcnt lgkmcnt(3)
    v_mfma_f32_16x16x32_bf16 v[192:195], v[244:247], v[164:167], v[192:195]
    v_exp_f32 v214, v214
    v_exp_f32 v215, v215
    v_mfma_f32_16x16x32_bf16 v[196:199], v[244:247], v[180:183], v[196:199]
    ds_read_b128 v[236:239], v4 offset:11264
    v_cvt_pk_bf16_f32 v87, v214, v215
    s_waitcnt lgkmcnt(3)
    v_mfma_f32_16x16x32_bf16 v[200:203], v[224:227], v[152:155], v[216:219]
    v_mfma_f32_16x16x32_bf16 v[204:207], v[224:227], v[168:171], v[220:223]
    ds_read_b128 v[240:243], v4 offset:12288
    v_exp_f32 v184, v184
    v_exp_f32 v185, v185
    v_mfma_f32_16x16x32_bf16 v[248:251], v[12:15], v[80:83], v[248:251]
    s_waitcnt lgkmcnt(3)
    v_mfma_f32_16x16x32_bf16 v[208:211], v[228:231], v[152:155], v[216:219]
    v_cvt_pk_bf16_f32 v88, v184, v185
    v_exp_f32 v186, v186
    v_mfma_f32_16x16x32_bf16 v[212:215], v[228:231], v[168:171], v[220:223]
    ds_read_b128 v[244:247], v4 offset:13312
    v_exp_f32 v187, v187
    v_mfma_f32_16x16x32_bf16 v[252:255], v[12:15], v[84:87], v[252:255]
    s_waitcnt lgkmcnt(3)
    v_mfma_f32_16x16x32_bf16 v[200:203], v[232:235], v[156:159], v[200:203]
    v_cvt_pk_bf16_f32 v89, v186, v187
    v_exp_f32 v188, v188
    v_mfma_f32_16x16x32_bf16 v[204:207], v[232:235], v[172:175], v[204:207]
    ds_read_b128 v[224:227], v4 offset:14336
    v_exp_f32 v189, v189
    s_waitcnt lgkmcnt(3)
    v_mfma_f32_16x16x32_bf16 v[208:211], v[236:239], v[156:159], v[208:211]
    v_cvt_pk_bf16_f32 v92, v188, v189
    v_exp_f32 v190, v190
    v_mfma_f32_16x16x32_bf16 v[212:215], v[236:239], v[172:175], v[212:215]
    ds_read_b128 v[228:231], v4 offset:15360
    v_exp_f32 v191, v191
    s_nop 0
    v_cvt_pk_bf16_f32 v93, v190, v191
    s_waitcnt lgkmcnt(3)
    v_mfma_f32_16x16x32_bf16 v[200:203], v[240:243], v[160:163], v[200:203]
    v_exp_f32 v192, v192
    v_mfma_f32_16x16x32_bf16 v[204:207], v[240:243], v[176:179], v[204:207]
    s_waitcnt vmcnt(7)
    s_barrier
    ds_read_b128 v[232:235], v4 offset:16384
    v_exp_f32 v193, v193
    s_nop 0
    v_cvt_pk_bf16_f32 v90, v192, v193
    s_waitcnt lgkmcnt(3)
    v_mfma_f32_16x16x32_bf16 v[208:211], v[244:247], v[160:163], v[208:211]
    v_exp_f32 v194, v194
    v_mfma_f32_16x16x32_bf16 v[212:215], v[244:247], v[176:179], v[212:215]
    s_add_u32 s22, s21, 0x84000
    s_add_u32 m0, s20, 0x24000
    s_nop 0
    buffer_load_dwordx4 v2, s[8:11], s22 offen sc1 lds
    ds_read_b128 v[236:239], v4 offset:17408
    v_exp_f32 v195, v195
    s_nop 0
    v_cvt_pk_bf16_f32 v91, v194, v195
    s_waitcnt lgkmcnt(3)
    v_mfma_f32_16x16x32_bf16 v[200:203], v[224:227], v[164:167], v[200:203]
    v_exp_f32 v196, v196
    v_exp_f32 v197, v197
    v_mfma_f32_16x16x32_bf16 v[204:207], v[224:227], v[180:183], v[204:207]
    ds_read_b128 v[240:243], v4 offset:18432
    v_cvt_pk_bf16_f32 v94, v196, v197
    s_waitcnt lgkmcnt(3)
    v_mfma_f32_16x16x32_bf16 v[208:211], v[228:231], v[164:167], v[208:211]
    v_exp_f32 v198, v198
    v_exp_f32 v199, v199
    v_mfma_f32_16x16x32_bf16 v[212:215], v[228:231], v[180:183], v[212:215]
    ds_read_b128 v[244:247], v4 offset:19456
    v_cvt_pk_bf16_f32 v95, v198, v199
    s_waitcnt lgkmcnt(3)
    v_mfma_f32_16x16x32_bf16 v[184:187], v[232:235], v[152:155], v[216:219]
    v_mfma_f32_16x16x32_bf16 v[188:191], v[232:235], v[168:171], v[220:223]
    ds_read_b128 v[224:227], v4 offset:20480
    v_exp_f32 v200, v200
    v_exp_f32 v201, v201
    v_mfma_f32_16x16x32_bf16 v[248:251], v[12:15], v[88:91], v[248:251]
    s_waitcnt lgkmcnt(3)
    v_mfma_f32_16x16x32_bf16 v[192:195], v[236:239], v[152:155], v[216:219]
    v_cvt_pk_bf16_f32 v96, v200, v201
    v_exp_f32 v202, v202
    v_mfma_f32_16x16x32_bf16 v[196:199], v[236:239], v[168:171], v[220:223]
    s_add_u32 s22, s21, 0x84400
    s_add_u32 m0, s20, 0x24400
    s_nop 0
    buffer_load_dwordx4 v2, s[8:11], s22 offen sc1 lds
    ds_read_b128 v[228:231], v4 offset:21504
    v_exp_f32 v203, v203
    v_mfma_f32_16x16x32_bf16 v[252:255], v[12:15], v[92:95], v[252:255]
    s_waitcnt lgkmcnt(3)
    v_mfma_f32_16x16x32_bf16 v[184:187], v[240:243], v[156:159], v[184:187]
    v_cvt_pk_bf16_f32 v97, v202, v203
    v_exp_f32 v204, v204
    v_mfma_f32_16x16x32_bf16 v[188:191], v[240:243], v[172:175], v[188:191]
    ds_read_b128 v[232:235], v4 offset:22528
    v_exp_f32 v205, v205
    s_waitcnt lgkmcnt(3)
    v_mfma_f32_16x16x32_bf16 v[192:195], v[244:247], v[156:159], v[192:195]
    v_cvt_pk_bf16_f32 v100, v204, v205
    v_exp_f32 v206, v206
    v_mfma_f32_16x16x32_bf16 v[196:199], v[244:247], v[172:175], v[196:199]
    ds_read_b128 v[236:239], v4 offset:23552
    v_exp_f32 v207, v207
    s_nop 0
    v_cvt_pk_bf16_f32 v101, v206, v207
    s_waitcnt lgkmcnt(3)
    v_mfma_f32_16x16x32_bf16 v[184:187], v[224:227], v[160:163], v[184:187]
    v_exp_f32 v208, v208
    v_mfma_f32_16x16x32_bf16 v[188:191], v[224:227], v[176:179], v[188:191]
    ds_read_b128 v[240:243], v4 offset:24576
    v_exp_f32 v209, v209
    s_nop 0
    v_cvt_pk_bf16_f32 v98, v208, v209
    s_waitcnt lgkmcnt(3)
    v_mfma_f32_16x16x32_bf16 v[192:195], v[228:231], v[160:163], v[192:195]
    v_exp_f32 v210, v210
    v_mfma_f32_16x16x32_bf16 v[196:199], v[228:231], v[176:179], v[196:199]
    ds_read_b128 v[244:247], v4 offset:25600
    v_exp_f32 v211, v211
    s_nop 0
    v_cvt_pk_bf16_f32 v99, v210, v211
    s_waitcnt lgkmcnt(3)
    v_mfma_f32_16x16x32_bf16 v[184:187], v[232:235], v[164:167], v[184:187]
    v_exp_f32 v212, v212
    v_exp_f32 v213, v213
    v_mfma_f32_16x16x32_bf16 v[188:191], v[232:235], v[180:183], v[188:191]
    ds_read_b128 v[224:227], v4 offset:26624
    v_cvt_pk_bf16_f32 v102, v212, v213
    s_waitcnt lgkmcnt(3)
    v_mfma_f32_16x16x32_bf16 v[192:195], v[236:239], v[164:167], v[192:195]
    v_exp_f32 v214, v214
    v_exp_f32 v215, v215
    v_mfma_f32_16x16x32_bf16 v[196:199], v[236:239], v[180:183], v[196:199]
    ds_read_b128 v[228:231], v4 offset:27648
    v_cvt_pk_bf16_f32 v103, v214, v215
    s_waitcnt lgkmcnt(3)
    v_mfma_f32_16x16x32_bf16 v[200:203], v[240:243], v[152:155], v[216:219]
    v_mfma_f32_16x16x32_bf16 v[204:207], v[240:243], v[168:171], v[220:223]
    ds_read_b128 v[232:235], v4 offset:28672
    v_exp_f32 v184, v184
    v_exp_f32 v185, v185
    v_mfma_f32_16x16x32_bf16 v[248:251], v[12:15], v[96:99], v[248:251]
    s_waitcnt lgkmcnt(3)
    v_mfma_f32_16x16x32_bf16 v[208:211], v[244:247], v[152:155], v[216:219]
    v_cvt_pk_bf16_f32 v104, v184, v185
    v_exp_f32 v186, v186
    v_mfma_f32_16x16x32_bf16 v[212:215], v[244:247], v[168:171], v[220:223]
    ds_read_b128 v[236:239], v4 offset:29696
    v_exp_f32 v187, v187
    v_mfma_f32_16x16x32_bf16 v[252:255], v[12:15], v[100:103], v[252:255]
    s_waitcnt lgkmcnt(3)
    v_mfma_f32_16x16x32_bf16 v[200:203], v[224:227], v[156:159], v[200:203]
    v_cvt_pk_bf16_f32 v105, v186, v187
    v_exp_f32 v188, v188
    v_mfma_f32_16x16x32_bf16 v[204:207], v[224:227], v[172:175], v[204:207]
    ds_read_b128 v[240:243], v4 offset:30720
    v_exp_f32 v189, v189
    s_waitcnt lgkmcnt(3)
    v_mfma_f32_16x16x32_bf16 v[208:211], v[228:231], v[156:159], v[208:211]
    v_cvt_pk_bf16_f32 v108, v188, v189
    v_exp_f32 v190, v190
    v_mfma_f32_16x16x32_bf16 v[212:215], v[228:231], v[172:175], v[212:215]
    ds_read_b128 v[244:247], v4 offset:31744
    v_exp_f32 v191, v191
    s_nop 0
    v_cvt_pk_bf16_f32 v109, v190, v191
    s_waitcnt lgkmcnt(3)
    v_mfma_f32_16x16x32_bf16 v[200:203], v[232:235], v[160:163], v[200:203]
    v_exp_f32 v192, v192
    v_mfma_f32_16x16x32_bf16 v[204:207], v[232:235], v[176:179], v[204:207]
    s_waitcnt vmcnt(7)
    s_barrier
    ds_read_b128 v[224:227], v4 offset:32768
    v_exp_f32 v193, v193
    s_nop 0
    v_cvt_pk_bf16_f32 v106, v192, v193
    s_waitcnt lgkmcnt(3)
    v_mfma_f32_16x16x32_bf16 v[208:211], v[236:239], v[160:163], v[208:211]
    v_exp_f32 v194, v194
    v_mfma_f32_16x16x32_bf16 v[212:215], v[236:239], v[176:179], v[212:215]
    s_add_u32 s22, s21, 0x88000
    s_add_u32 m0, s20, 0x10000
    s_nop 0
    buffer_load_dwordx4 v2, s[8:11], s22 offen sc1 lds
    ds_read_b128 v[228:231], v4 offset:33792
    v_exp_f32 v195, v195
    s_nop 0
    v_cvt_pk_bf16_f32 v107, v194, v195
    s_waitcnt lgkmcnt(3)
    v_mfma_f32_16x16x32_bf16 v[200:203], v[240:243], v[164:167], v[200:203]
    v_exp_f32 v196, v196
    v_exp_f32 v197, v197
    v_mfma_f32_16x16x32_bf16 v[204:207], v[240:243], v[180:183], v[204:207]
    ds_read_b128 v[232:235], v4 offset:34816
    v_cvt_pk_bf16_f32 v110, v196, v197
    s_waitcnt lgkmcnt(3)
    v_mfma_f32_16x16x32_bf16 v[208:211], v[244:247], v[164:167], v[208:211]
    v_exp_f32 v198, v198
    v_exp_f32 v199, v199
    v_mfma_f32_16x16x32_bf16 v[212:215], v[244:247], v[180:183], v[212:215]
    ds_read_b128 v[236:239], v4 offset:35840
    v_cvt_pk_bf16_f32 v111, v198, v199
    s_waitcnt lgkmcnt(3)
    v_mfma_f32_16x16x32_bf16 v[184:187], v[224:227], v[152:155], v[216:219]
    v_mfma_f32_16x16x32_bf16 v[188:191], v[224:227], v[168:171], v[220:223]
    ds_read_b128 v[240:243], v4 offset:36864
    v_exp_f32 v200, v200
    v_exp_f32 v201, v201
    v_mfma_f32_16x16x32_bf16 v[248:251], v[12:15], v[104:107], v[248:251]
    s_waitcnt lgkmcnt(3)
    v_mfma_f32_16x16x32_bf16 v[192:195], v[228:231], v[152:155], v[216:219]
    v_cvt_pk_bf16_f32 v112, v200, v201
    v_exp_f32 v202, v202
    v_mfma_f32_16x16x32_bf16 v[196:199], v[228:231], v[168:171], v[220:223]
    s_add_u32 s22, s21, 0x88400
    s_add_u32 m0, s20, 0x10400
    s_nop 0
    buffer_load_dwordx4 v2, s[8:11], s22 offen sc1 lds
    ds_read_b128 v[244:247], v4 offset:37888
    v_exp_f32 v203, v203
    v_mfma_f32_16x16x32_bf16 v[252:255], v[12:15], v[108:111], v[252:255]
    s_waitcnt lgkmcnt(3)
    v_mfma_f32_16x16x32_bf16 v[184:187], v[232:235], v[156:159], v[184:187]
    v_cvt_pk_bf16_f32 v113, v202, v203
    v_exp_f32 v204, v204
    v_mfma_f32_16x16x32_bf16 v[188:191], v[232:235], v[172:175], v[188:191]
    ds_read_b128 v[224:227], v4 offset:38912
    v_exp_f32 v205, v205
    s_waitcnt lgkmcnt(3)
    v_mfma_f32_16x16x32_bf16 v[192:195], v[236:239], v[156:159], v[192:195]
    v_cvt_pk_bf16_f32 v116, v204, v205
    v_exp_f32 v206, v206
    v_mfma_f32_16x16x32_bf16 v[196:199], v[236:239], v[172:175], v[196:199]
    ds_read_b128 v[228:231], v4 offset:39936
    v_exp_f32 v207, v207
    s_nop 0
    v_cvt_pk_bf16_f32 v117, v206, v207
    s_waitcnt lgkmcnt(3)
    v_mfma_f32_16x16x32_bf16 v[184:187], v[240:243], v[160:163], v[184:187]
    v_exp_f32 v208, v208
    v_mfma_f32_16x16x32_bf16 v[188:191], v[240:243], v[176:179], v[188:191]
    ds_read_b128 v[232:235], v4 offset:40960
    v_exp_f32 v209, v209
    s_nop 0
    v_cvt_pk_bf16_f32 v114, v208, v209
    s_waitcnt lgkmcnt(3)
    v_mfma_f32_16x16x32_bf16 v[192:195], v[244:247], v[160:163], v[192:195]
    v_exp_f32 v210, v210
    v_mfma_f32_16x16x32_bf16 v[196:199], v[244:247], v[176:179], v[196:199]
    ds_read_b128 v[236:239], v4 offset:41984
    v_exp_f32 v211, v211
    s_nop 0
    v_cvt_pk_bf16_f32 v115, v210, v211
    s_waitcnt lgkmcnt(3)
    v_mfma_f32_16x16x32_bf16 v[184:187], v[224:227], v[164:167], v[184:187]
    v_exp_f32 v212, v212
    v_exp_f32 v213, v213
    v_mfma_f32_16x16x32_bf16 v[188:191], v[224:227], v[180:183], v[188:191]
    ds_read_b128 v[240:243], v4 offset:43008
    v_cvt_pk_bf16_f32 v118, v212, v213
    s_waitcnt lgkmcnt(3)
    v_mfma_f32_16x16x32_bf16 v[192:195], v[228:231], v[164:167], v[192:195]
    v_exp_f32 v214, v214
    v_exp_f32 v215, v215
    v_mfma_f32_16x16x32_bf16 v[196:199], v[228:231], v[180:183], v[196:199]
    ds_read_b128 v[244:247], v4 offset:44032
    v_cvt_pk_bf16_f32 v119, v214, v215
    s_waitcnt lgkmcnt(3)
    v_mfma_f32_16x16x32_bf16 v[200:203], v[232:235], v[152:155], v[216:219]
    v_mfma_f32_16x16x32_bf16 v[204:207], v[232:235], v[168:171], v[220:223]
    ds_read_b128 v[224:227], v4 offset:45056
    v_exp_f32 v184, v184
    v_exp_f32 v185, v185
    v_mfma_f32_16x16x32_bf16 v[248:251], v[12:15], v[112:115], v[248:251]
    s_waitcnt lgkmcnt(3)
    v_mfma_f32_16x16x32_bf16 v[208:211], v[236:239], v[152:155], v[216:219]
    v_cvt_pk_bf16_f32 v120, v184, v185
    v_exp_f32 v186, v186
    v_mfma_f32_16x16x32_bf16 v[212:215], v[236:239], v[168:171], v[220:223]
    ds_read_b128 v[228:231], v4 offset:46080
    v_exp_f32 v187, v187
    v_mfma_f32_16x16x32_bf16 v[252:255], v[12:15], v[116:119], v[252:255]
    s_waitcnt lgkmcnt(3)
    v_mfma_f32_16x16x32_bf16 v[200:203], v[240:243], v[156:159], v[200:203]
    v_cvt_pk_bf16_f32 v121, v186, v187
    v_exp_f32 v188, v188
    v_mfma_f32_16x16x32_bf16 v[204:207], v[240:243], v[172:175], v[204:207]
    ds_read_b128 v[232:235], v4 offset:47104
    v_exp_f32 v189, v189
    s_waitcnt lgkmcnt(3)
    v_mfma_f32_16x16x32_bf16 v[208:211], v[244:247], v[156:159], v[208:211]
    v_cvt_pk_bf16_f32 v124, v188, v189
    v_exp_f32 v190, v190
    v_mfma_f32_16x16x32_bf16 v[212:215], v[244:247], v[172:175], v[212:215]
    ds_read_b128 v[236:239], v4 offset:48128
    v_exp_f32 v191, v191
    s_nop 0
    v_cvt_pk_bf16_f32 v125, v190, v191
    s_waitcnt lgkmcnt(3)
    v_mfma_f32_16x16x32_bf16 v[200:203], v[224:227], v[160:163], v[200:203]
    v_exp_f32 v192, v192
    v_mfma_f32_16x16x32_bf16 v[204:207], v[224:227], v[176:179], v[204:207]
    s_waitcnt vmcnt(6)
    s_barrier
    ds_read_b128 v[240:243], v4 offset:49152
    v_exp_f32 v193, v193
    s_nop 0
    v_cvt_pk_bf16_f32 v122, v192, v193
    s_waitcnt lgkmcnt(3)
    v_mfma_f32_16x16x32_bf16 v[208:211], v[228:231], v[160:163], v[208:211]
    v_exp_f32 v194, v194
    v_mfma_f32_16x16x32_bf16 v[212:215], v[228:231], v[176:179], v[212:215]
    s_add_u32 s22, s21, 0x8c000
    s_add_u32 m0, s20, 0x14000
    s_nop 0
    buffer_load_dwordx4 v2, s[8:11], s22 offen sc1 lds
    ds_read_b128 v[244:247], v4 offset:50176
    v_exp_f32 v195, v195
    s_nop 0
    v_cvt_pk_bf16_f32 v123, v194, v195
    s_waitcnt lgkmcnt(3)
    v_mfma_f32_16x16x32_bf16 v[200:203], v[232:235], v[164:167], v[200:203]
    v_exp_f32 v196, v196
    v_exp_f32 v197, v197
    v_mfma_f32_16x16x32_bf16 v[204:207], v[232:235], v[180:183], v[204:207]
    ds_read_b128 v[224:227], v4 offset:51200
    v_cvt_pk_bf16_f32 v126, v196, v197
    s_waitcnt lgkmcnt(3)
    v_mfma_f32_16x16x32_bf16 v[208:211], v[236:239], v[164:167], v[208:211]
    v_exp_f32 v198, v198
    v_exp_f32 v199, v199
    v_mfma_f32_16x16x32_bf16 v[212:215], v[236:239], v[180:183], v[212:215]
    ds_read_b128 v[228:231], v4 offset:52224
    v_cvt_pk_bf16_f32 v127, v198, v199
    s_waitcnt lgkmcnt(3)
    v_mfma_f32_16x16x32_bf16 v[184:187], v[240:243], v[152:155], v[216:219]
    v_mfma_f32_16x16x32_bf16 v[188:191], v[240:243], v[168:171], v[220:223]
    ds_read_b128 v[232:235], v4 offset:53248
    v_exp_f32 v200, v200
    v_exp_f32 v201, v201
    v_mfma_f32_16x16x32_bf16 v[248:251], v[12:15], v[120:123], v[248:251]
    s_waitcnt lgkmcnt(3)
    v_mfma_f32_16x16x32_bf16 v[192:195], v[244:247], v[152:155], v[216:219]
    v_cvt_pk_bf16_f32 v128, v200, v201
    v_exp_f32 v202, v202
    v_mfma_f32_16x16x32_bf16 v[196:199], v[244:247], v[168:171], v[220:223]
    s_add_u32 s22, s21, 0x8c400
    s_add_u32 m0, s20, 0x14400
    s_nop 0
    buffer_load_dwordx4 v2, s[8:11], s22 offen sc1 lds
    ds_read_b128 v[236:239], v4 offset:54272
    v_exp_f32 v203, v203
    v_mfma_f32_16x16x32_bf16 v[252:255], v[12:15], v[124:127], v[252:255]
    s_waitcnt lgkmcnt(3)
    v_mfma_f32_16x16x32_bf16 v[184:187], v[224:227], v[156:159], v[184:187]
    v_cvt_pk_bf16_f32 v129, v202, v203
    v_exp_f32 v204, v204
    v_mfma_f32_16x16x32_bf16 v[188:191], v[224:227], v[172:175], v[188:191]
    ds_read_b128 v[240:243], v4 offset:55296
    v_exp_f32 v205, v205
    s_waitcnt lgkmcnt(3)
    v_mfma_f32_16x16x32_bf16 v[192:195], v[228:231], v[156:159], v[192:195]
    v_cvt_pk_bf16_f32 v132, v204, v205
    v_exp_f32 v206, v206
    v_mfma_f32_16x16x32_bf16 v[196:199], v[228:231], v[172:175], v[196:199]
    ds_read_b128 v[244:247], v4 offset:56320
    v_exp_f32 v207, v207
    s_nop 0
    v_cvt_pk_bf16_f32 v133, v206, v207
    s_waitcnt lgkmcnt(3)
    v_mfma_f32_16x16x32_bf16 v[184:187], v[232:235], v[160:163], v[184:187]
    v_exp_f32 v208, v208
    v_mfma_f32_16x16x32_bf16 v[188:191], v[232:235], v[176:179], v[188:191]
    ds_read_b128 v[224:227], v4 offset:57344
    v_exp_f32 v209, v209
    s_nop 0
    v_cvt_pk_bf16_f32 v130, v208, v209
    s_waitcnt lgkmcnt(3)
    v_mfma_f32_16x16x32_bf16 v[192:195], v[236:239], v[160:163], v[192:195]
    v_exp_f32 v210, v210
    v_mfma_f32_16x16x32_bf16 v[196:199], v[236:239], v[176:179], v[196:199]
    ds_read_b128 v[228:231], v4 offset:58368
    v_exp_f32 v211, v211
    s_nop 0
    v_cvt_pk_bf16_f32 v131, v210, v211
    s_waitcnt lgkmcnt(3)
    v_mfma_f32_16x16x32_bf16 v[184:187], v[240:243], v[164:167], v[184:187]
    v_exp_f32 v212, v212
    v_exp_f32 v213, v213
    v_mfma_f32_16x16x32_bf16 v[188:191], v[240:243], v[180:183], v[188:191]
    ds_read_b128 v[232:235], v4 offset:59392
    v_cvt_pk_bf16_f32 v134, v212, v213
    s_waitcnt lgkmcnt(3)
    v_mfma_f32_16x16x32_bf16 v[192:195], v[244:247], v[164:167], v[192:195]
    v_exp_f32 v214, v214
    v_exp_f32 v215, v215
    v_mfma_f32_16x16x32_bf16 v[196:199], v[244:247], v[180:183], v[196:199]
    ds_read_b128 v[236:239], v4 offset:60416
    v_cvt_pk_bf16_f32 v135, v214, v215
    s_waitcnt lgkmcnt(3)
    v_mfma_f32_16x16x32_bf16 v[200:203], v[224:227], v[152:155], v[216:219]
    v_mfma_f32_16x16x32_bf16 v[204:207], v[224:227], v[168:171], v[220:223]
    ds_read_b128 v[240:243], v4 offset:61440
    v_exp_f32 v184, v184
    v_exp_f32 v185, v185
    v_mfma_f32_16x16x32_bf16 v[248:251], v[12:15], v[128:131], v[248:251]
    s_waitcnt lgkmcnt(3)
    v_mfma_f32_16x16x32_bf16 v[208:211], v[228:231], v[152:155], v[216:219]
    v_cvt_pk_bf16_f32 v136, v184, v185
    v_exp_f32 v186, v186
    v_mfma_f32_16x16x32_bf16 v[212:215], v[228:231], v[168:171], v[220:223]
    ds_read_b128 v[244:247], v4 offset:62464
    v_exp_f32 v187, v187
    v_mfma_f32_16x16x32_bf16 v[252:255], v[12:15], v[132:135], v[252:255]
    s_waitcnt lgkmcnt(3)
    v_mfma_f32_16x16x32_bf16 v[200:203], v[232:235], v[156:159], v[200:203]
    v_cvt_pk_bf16_f32 v137, v186, v187
    v_exp_f32 v188, v188
    v_mfma_f32_16x16x32_bf16 v[204:207], v[232:235], v[172:175], v[204:207]
    ds_read_b128 v[224:227], v4 offset:63488
    v_exp_f32 v189, v189
    s_waitcnt lgkmcnt(3)
    v_mfma_f32_16x16x32_bf16 v[208:211], v[236:239], v[156:159], v[208:211]
    v_cvt_pk_bf16_f32 v140, v188, v189
    v_exp_f32 v190, v190
    v_mfma_f32_16x16x32_bf16 v[212:215], v[236:239], v[172:175], v[212:215]
    ds_read_b128 v[228:231], v4 offset:64512
    v_exp_f32 v191, v191
    s_nop 0
    v_cvt_pk_bf16_f32 v141, v190, v191
    s_waitcnt lgkmcnt(3)
    v_mfma_f32_16x16x32_bf16 v[200:203], v[240:243], v[160:163], v[200:203]
    v_exp_f32 v192, v192
    v_mfma_f32_16x16x32_bf16 v[204:207], v[240:243], v[176:179], v[204:207]
    v_exp_f32 v193, v193
    s_nop 0
    v_cvt_pk_bf16_f32 v138, v192, v193
    s_waitcnt lgkmcnt(2)
    v_mfma_f32_16x16x32_bf16 v[208:211], v[244:247], v[160:163], v[208:211]
    v_exp_f32 v194, v194
    v_mfma_f32_16x16x32_bf16 v[212:215], v[244:247], v[176:179], v[212:215]
    v_exp_f32 v195, v195
    s_nop 0
    v_cvt_pk_bf16_f32 v139, v194, v195
    s_waitcnt lgkmcnt(1)
    v_mfma_f32_16x16x32_bf16 v[200:203], v[224:227], v[164:167], v[200:203]
    v_exp_f32 v196, v196
    v_exp_f32 v197, v197
    v_mfma_f32_16x16x32_bf16 v[204:207], v[224:227], v[180:183], v[204:207]
    v_cvt_pk_bf16_f32 v142, v196, v197
    s_waitcnt lgkmcnt(0)
    v_mfma_f32_16x16x32_bf16 v[208:211], v[228:231], v[164:167], v[208:211]
    v_exp_f32 v198, v198
    v_exp_f32 v199, v199
    v_mfma_f32_16x16x32_bf16 v[212:215], v[228:231], v[180:183], v[212:215]
    v_cvt_pk_bf16_f32 v143, v198, v199
    s_waitcnt vmcnt(6)
    s_barrier
    ds_read_b128 v[232:235], v5 offset:0
    ds_read_b128 v[236:239], v5 offset:1024
    ds_read_b128 v[240:243], v5 offset:2048
    ds_read_b128 v[244:247], v5 offset:3072
    v_mfma_f32_16x16x32_bf16 v[248:251], v[12:15], v[136:139], v[248:251]
    v_mfma_f32_16x16x32_bf16 v[252:255], v[12:15], v[140:143], v[252:255]
    v_exp_f32 v200, v200
    v_exp_f32 v201, v201
    s_nop 0
    v_cvt_pk_bf16_f32 v144, v200, v201
    v_exp_f32 v202, v202
    v_exp_f32 v203, v203
    s_nop 0
    v_cvt_pk_bf16_f32 v145, v202, v203
    v_exp_f32 v204, v204
    v_exp_f32 v205, v205
    s_nop 0
    v_cvt_pk_bf16_f32 v148, v204, v205
    v_exp_f32 v206, v206
    v_exp_f32 v207, v207
    s_nop 0
    v_cvt_pk_bf16_f32 v149, v206, v207
    v_exp_f32 v208, v208
    v_exp_f32 v209, v209
    s_nop 0
    v_cvt_pk_bf16_f32 v146, v208, v209
    v_exp_f32 v210, v210
    v_exp_f32 v211, v211
    s_nop 0
    v_cvt_pk_bf16_f32 v147, v210, v211
    v_exp_f32 v212, v212
    v_exp_f32 v213, v213
    s_nop 0
    v_cvt_pk_bf16_f32 v150, v212, v213
    v_exp_f32 v214, v214
    v_exp_f32 v215, v215
    s_nop 0
    v_cvt_pk_bf16_f32 v151, v214, v215
    v_mfma_f32_16x16x32_bf16 v[248:251], v[12:15], v[144:147], v[248:251]
    s_nop 0
    v_mfma_f32_16x16x32_bf16 v[252:255], v[12:15], v[148:151], v[252:255]
    s_nop 5
    v_mov_b32 v9, v248
    s_nop 0
    v_mov_b32 v10, v252
    v_max_f32 v17, v9, v10
    v_readfirstlane_b32 s17, v8
    s_cmp_eq_u32 s17, s28
    s_cselect_b32 s16, 0, 0x71800000
    v_cmp_ngt_f32 vcc, s16, v17
    v_cmp_u_f32 s[76:77], v9, v10
    s_or_b64 vcc, vcc, s[76:77]
    s_cbranch_vccnz adaLN_cond__sliding_block_cached__moe_arch_mod__prompt_kernel_fixA
adaLN_cond__sliding_block_cached__moe_arch_mod__prompt_kernel_fixAb:
    v_rcp_f32 v9, v9
    v_rcp_f32 v10, v10
    s_lshl_b32 s25, s13, 3
    s_add_u32 s25, s25, s3
    s_lshl_b32 s25, s25, 18
    s_lshl_b32 s26, s12, 12
    s_add_u32 s25, s25, s26
    s_add_u32 s25, s25, 0x1000000
    s_add_u32 s26, s25, 131072
    s_lshl_b32 s63, s13, 3
    s_add_u32 s63, s63, s3
    s_lshl_b32 s63, s63, 5
    s_add_u32 s63, s63, s12
    s_lshl_b32 s63, s63, 2
    s_waitcnt lgkmcnt(3)
    v_mfma_f32_16x16x32_bf16 v[184:187], v[232:235], v[24:27], 0
    v_mfma_f32_16x16x32_bf16 v[188:191], v[232:235], v[28:31], 0
    ds_read_b128 v[224:227], v5 offset:4096
    s_waitcnt lgkmcnt(3)
    v_mfma_f32_16x16x32_bf16 v[192:195], v[236:239], v[24:27], 0
    s_add_u32 s22, s21, 0x90000
    s_add_u32 m0, s20, 0x18000
    s_nop 0
    buffer_load_dwordx4 v2, s[8:11], s22 offen sc1 lds
    v_mfma_f32_16x16x32_bf16 v[196:199], v[236:239], v[28:31], 0
    ds_read_b128 v[228:231], v5 offset:5120
    s_waitcnt lgkmcnt(3)
    v_mfma_f32_16x16x32_bf16 v[184:187], v[240:243], v[32:35], v[184:187]
    v_mfma_f32_16x16x32_bf16 v[188:191], v[240:243], v[36:39], v[188:191]
    ds_read_b128 v[232:235], v5 offset:6144
    s_waitcnt lgkmcnt(3)
    v_mfma_f32_16x16x32_bf16 v[192:195], v[244:247], v[32:35], v[192:195]
    v_mfma_f32_16x16x32_bf16 v[196:199], v[244:247], v[36:39], v[196:199]
    ds_read_b128 v[236:239], v5 offset:7168
    s_waitcnt lgkmcnt(3)
    v_mfma_f32_16x16x32_bf16 v[184:187], v[224:227], v[40:43], v[184:187]
    v_mfma_f32_16x16x32_bf16 v[188:191], v[224:227], v[44:47], v[188:191]
    ds_read_b128 v[240:243], v5 offset:8192
    s_waitcnt lgkmcnt(3)
    v_mfma_f32_16x16x32_bf16 v[192:195], v[228:231], v[40:43], v[192:195]
    s_add_u32 s22, s21, 0x90400
    s_add_u32 m0, s20, 0x18400
    s_nop 0
    buffer_load_dwordx4 v2, s[8:11], s22 offen sc1 lds
    v_and_b32 v250, 7, v1
    v_lshlrev_b32 v250, 7, v250
    s_lshr_b32 s14, s2, 3
    s_lshl_b32 s14, s14, 2
    s_add_u32 s14, s14, 0x560000
    buffer_load_dword v248, v250, s[8:11], s14 offen sc1
    v_mfma_f32_16x16x32_bf16 v[196:199], v[228:231], v[44:47], v[196:199]
    ds_read_b128 v[244:247], v5 offset:9216
    s_waitcnt lgkmcnt(3)
    v_mfma_f32_16x16x32_bf16 v[184:187], v[232:235], v[48:51], v[184:187]
    v_mfma_f32_16x16x32_bf16 v[188:191], v[232:235], v[52:55], v[188:191]
    ds_read_b128 v[224:227], v5 offset:10240
    s_waitcnt lgkmcnt(3)
    v_mfma_f32_16x16x32_bf16 v[192:195], v[236:239], v[48:51], v[192:195]
    v_mfma_f32_16x16x32_bf16 v[196:199], v[236:239], v[52:55], v[196:199]
    ds_read_b128 v[228:231], v5 offset:11264
    s_waitcnt lgkmcnt(3)
    v_mfma_f32_16x16x32_bf16 v[184:187], v[240:243], v[56:59], v[184:187]
    v_mfma_f32_16x16x32_bf16 v[188:191], v[240:243], v[60:63], v[188:191]
    ds_read_b128 v[232:235], v5 offset:12288
    s_waitcnt lgkmcnt(3)
    v_mfma_f32_16x16x32_bf16 v[192:195], v[244:247], v[56:59], v[192:195]
    v_mfma_f32_16x16x32_bf16 v[196:199], v[244:247], v[60:63], v[196:199]
    ds_read_b128 v[236:239], v5 offset:13312
    s_waitcnt lgkmcnt(3)
    v_mfma_f32_16x16x32_bf16 v[184:187], v[224:227], v[64:67], v[184:187]
    v_mfma_f32_16x16x32_bf16 v[188:191], v[224:227], v[68:71], v[188:191]
    ds_read_b128 v[240:243], v5 offset:14336
    s_waitcnt lgkmcnt(3)
    v_mfma_f32_16x16x32_bf16 v[192:195], v[228:231], v[64:67], v[192:195]
    v_mfma_f32_16x16x32_bf16 v[196:199], v[228:231], v[68:71], v[196:199]
    ds_read_b128 v[244:247], v5 offset:15360
    s_waitcnt lgkmcnt(3)
    v_mfma_f32_16x16x32_bf16 v[184:187], v[232:235], v[72:75], v[184:187]
    v_mfma_f32_16x16x32_bf16 v[188:191], v[232:235], v[76:79], v[188:191]
    s_waitcnt vmcnt(7)
    s_barrier
    ds_read_b128 v[224:227], v5 offset:16384
    s_waitcnt lgkmcnt(3)
    v_mfma_f32_16x16x32_bf16 v[192:195], v[236:239], v[72:75], v[192:195]
    v_mfma_f32_16x16x32_bf16 v[196:199], v[236:239], v[76:79], v[196:199]
    s_add_u32 s22, s21, 0x94000
    s_add_u32 m0, s20, 0x1c000
    s_nop 0
    buffer_load_dwordx4 v2, s[8:11], s22 offen sc1 lds
    ds_read_b128 v[228:231], v5 offset:17408
    s_waitcnt lgkmcnt(3)
    v_mfma_f32_16x16x32_bf16 v[184:187], v[240:243], v[80:83], v[184:187]
    v_mfma_f32_16x16x32_bf16 v[188:191], v[240:243], v[84:87], v[188:191]
    ds_read_b128 v[232:235], v5 offset:18432
    s_waitcnt lgkmcnt(3)
    v_mfma_f32_16x16x32_bf16 v[192:195], v[244:247], v[80:83], v[192:195]
    v_mfma_f32_16x16x32_bf16 v[196:199], v[244:247], v[84:87], v[196:199]
    ds_read_b128 v[236:239], v5 offset:19456
    s_waitcnt lgkmcnt(3)
    v_mfma_f32_16x16x32_bf16 v[184:187], v[224:227], v[88:91], v[184:187]
    v_mfma_f32_16x16x32_bf16 v[188:191], v[224:227], v[92:95], v[188:191]
    ds_read_b128 v[240:243], v5 offset:20480
    s_waitcnt lgkmcnt(3)
    v_mfma_f32_16x16x32_bf16 v[192:195], v[228:231], v[88:91], v[192:195]
    v_mfma_f32_16x16x32_bf16 v[196:199], v[228:231], v[92:95], v[196:199]
    s_add_u32 s22, s21, 0x94400
    s_add_u32 m0, s20, 0x1c400
    s_nop 0
    buffer_load_dwordx4 v2, s[8:11], s22 offen sc1 lds
    ds_read_b128 v[244:247], v5 offset:21504
    s_waitcnt lgkmcnt(3)
    v_mfma_f32_16x16x32_bf16 v[184:187], v[232:235], v[96:99], v[184:187]
    v_mfma_f32_16x16x32_bf16 v[188:191], v[232:235], v[100:103], v[188:191]
    ds_read_b128 v[224:227], v5 offset:22528
    s_waitcnt lgkmcnt(3)
    v_mfma_f32_16x16x32_bf16 v[192:195], v[236:239], v[96:99], v[192:195]
    v_mfma_f32_16x16x32_bf16 v[196:199], v[236:239], v[100:103], v[196:199]
    ds_read_b128 v[228:231], v5 offset:23552
    s_waitcnt lgkmcnt(3)
    v_mfma_f32_16x16x32_bf16 v[184:187], v[240:243], v[104:107], v[184:187]
    v_mfma_f32_16x16x32_bf16 v[188:191], v[240:243], v[108:111], v[188:191]
    ds_read_b128 v[232:235], v5 offset:24576
    s_waitcnt lgkmcnt(3)
    v_mfma_f32_16x16x32_bf16 v[192:195], v[244:247], v[104:107], v[192:195]
    v_mfma_f32_16x16x32_bf16 v[196:199], v[244:247], v[108:111], v[196:199]
    ds_read_b128 v[236:239], v5 offset:25600
    s_waitcnt lgkmcnt(3)
    v_mfma_f32_16x16x32_bf16 v[184:187], v[224:227], v[112:115], v[184:187]
    s_waitcnt vmcnt(2)
    v_cmp_ne_u32 vcc, s28, v248
    s_cbranch_vccnz adaLN_cond__sliding_block_cached__moe_arch_mod__prompt_kernel_mp5r
adaLN_cond__sliding_block_cached__moe_arch_mod__prompt_kernel_mp5b:
    v_mfma_f32_16x16x32_bf16 v[188:191], v[224:227], v[116:119], v[188:191]
    ds_read_b128 v[240:243], v5 offset:26624
    v_lshrrev_b32 v250, 4, v1
    v_lshlrev_b32 v250, 14, v250
    v_and_b32 v253, 15, v1
    v_lshl_add_u32 v250, v253, 2, v250
    s_lshl_b32 s14, s2, 6
    s_add_u32 s14, s14, 0x580000
    buffer_load_dword v249, v250, s[8:11], s14 offen sc1
    s_add_u32 s14, s14, 0x10000
    buffer_load_dword v254, v250, s[8:11], s14 offen sc1
    s_waitcnt lgkmcnt(3)
    v_mfma_f32_16x16x32_bf16 v[192:195], v[228:231], v[112:115], v[192:195]
    v_mfma_f32_16x16x32_bf16 v[196:199], v[228:231], v[116:119], v[196:199]
    ds_read_b128 v[244:247], v5 offset:27648
    s_waitcnt lgkmcnt(3)
    v_mfma_f32_16x16x32_bf16 v[184:187], v[232:235], v[120:123], v[184:187]
    v_mfma_f32_16x16x32_bf16 v[188:191], v[232:235], v[124:127], v[188:191]
    ds_read_b128 v[224:227], v5 offset:28672
    s_waitcnt lgkmcnt(3)
    v_mfma_f32_16x16x32_bf16 v[192:195], v[236:239], v[120:123], v[192:195]
    v_mfma_f32_16x16x32_bf16 v[196:199], v[236:239], v[124:127], v[196:199]
    ds_read_b128 v[228:231], v5 offset:29696
    s_waitcnt lgkmcnt(3)
    v_mfma_f32_16x16x32_bf16 v[184:187], v[240:243], v[128:131], v[184:187]
    v_mfma_f32_16x16x32_bf16 v[188:191], v[240:243], v[132:135], v[188:191]
    ds_read_b128 v[232:235], v5 offset:30720
    s_waitcnt lgkmcnt(3)
    v_mfma_f32_16x16x32_bf16 v[192:195], v[244:247], v[128:131], v[192:195]
    v_mfma_f32_16x16x32_bf16 v[196:199], v[244:247], v[132:135], v[196:199]
    ds_read_b128 v[236:239], v5 offset:31744
    s_waitcnt lgkmcnt(3)
    v_mfma_f32_16x16x32_bf16 v[184:187], v[224:227], v[136:139], v[184:187]
    v_mfma_f32_16x16x32_bf16 v[188:191], v[224:227], v[140:143], v[188:191]
    s_barrier
    ds_read_b128 v[240:243], v4 offset:0
    s_waitcnt lgkmcnt(3)
    v_mfma_f32_16x16x32_bf16 v[192:195], v[228:231], v[136:139], v[192:195]
    v_mfma_f32_16x16x32_bf16 v[196:199], v[228:231], v[140:143], v[196:199]
    s_add_u32 s22, s21, 0x98000
    s_add_u32 m0, s20, 0x20000
    s_nop 0
    buffer_load_dwordx4 v2, s[8:11], s22 offen sc1 lds
    ds_read_b128 v[244:247], v4 offset:1024
    s_waitcnt lgkmcnt(3)
    v_mfma_f32_16x16x32_bf16 v[184:187], v[232:235], v[144:147], v[184:187]
    v_mfma_f32_16x16x32_bf16 v[188:191], v[232:235], v[148:151], v[188:191]
    ds_read_b128 v[224:227], v4 offset:2048
    s_waitcnt lgkmcnt(3)
    v_mfma_f32_16x16x32_bf16 v[192:195], v[236:239], v[144:147], v[192:195]
    v_mfma_f32_16x16x32_bf16 v[196:199], v[236:239], v[148:151], v[196:199]
    ds_read_b128 v[228:231], v4 offset:3072
    s_waitcnt lgkmcnt(3)
    v_mfma_f32_16x16x32_bf16 v[200:203], v[240:243], v[24:27], 0
    v_mfma_f32_16x16x32_bf16 v[204:207], v[240:243], v[28:31], 0
    ds_read_b128 v[232:235], v4 offset:4096
    s_waitcnt lgkmcnt(3)
    v_mfma_f32_16x16x32_bf16 v[208:211], v[244:247], v[24:27], 0
    v_mfma_f32_16x16x32_bf16 v[212:215], v[244:247], v[28:31], 0
    s_add_u32 s22, s21, 0x98400
    s_add_u32 m0, s20, 0x20400
    s_nop 0
    buffer_load_dwordx4 v2, s[8:11], s22 offen sc1 lds
    ds_read_b128 v[236:239], v4 offset:5120
    v_mul_f32 v184, v184, v9
    s_waitcnt lgkmcnt(3)
    v_mfma_f32_16x16x32_bf16 v[200:203], v[224:227], v[32:35], v[200:203]
    v_mul_f32 v185, v185, v9
    s_waitcnt vmcnt(2)
    v_add_f32 v249, v249, v254
    v_mov_b32 v250, v249
    s_nop 1
    v_permlane16_swap_b32 v249, v250
    v_add_f32 v249, v249, v250
    v_mov_b32 v250, v249
    s_nop 1
    v_permlane32_swap_b32 v249, v250
    v_add_f32 v249, v249, v250
    v_cvt_pk_bf16_f32 v249, v249, v249
    v_lshlrev_b32 v249, 16, v249
    s_lshr_b32 s14, s2, 6
    s_cmp_eq_u32 s14, 2
    s_cselect_b32 s14, 1.0, 0
    v_add_f32 v249, s14, v249
    v_cvt_pk_bf16_f32 v249, v249, v249
    v_lshlrev_b32 v253, 1, v253
    s_lshl_b32 s14, s2, 5
    s_add_u32 s14, s14, 0x540000
    s_cmp_eq_u32 s3, 0
    s_cselect_b32 s14, s14, 0x7ffffff0
    s_mov_b64 exec, 0xffff
    buffer_store_short v249, v253, s[8:11], s14 offen sc1
    s_mov_b64 exec, -1
    v_mfma_f32_16x16x32_bf16 v[204:207], v[224:227], v[36:39], v[204:207]
    ds_read_b128 v[240:243], v4 offset:6144
    v_mul_f32 v186, v186, v9
    s_waitcnt lgkmcnt(3)
    v_mfma_f32_16x16x32_bf16 v[208:211], v[228:231], v[32:35], v[208:211]
    v_mul_f32 v187, v187, v9
    v_mfma_f32_16x16x32_bf16 v[212:215], v[228:231], v[36:39], v[212:215]
    ds_read_b128 v[244:247], v4 offset:7168
    v_mul_f32 v192, v192, v9
    s_waitcnt lgkmcnt(3)
    v_mfma_f32_16x16x32_bf16 v[200:203], v[232:235], v[40:43], v[200:203]
    v_mul_f32 v193, v193, v9
    v_mfma_f32_16x16x32_bf16 v[204:207], v[232:235], v[44:47], v[204:207]
    ds_read_b128 v[224:227], v4 offset:8192
    v_mul_f32 v194, v194, v9
    s_waitcnt lgkmcnt(3)
    v_mfma_f32_16x16x32_bf16 v[208:211], v[236:239], v[40:43], v[208:211]
    v_mul_f32 v195, v195, v9
    v_mfma_f32_16x16x32_bf16 v[212:215], v[236:239], v[44:47], v[212:215]
    ds_read_b128 v[228:231], v4 offset:9216
    v_cvt_pk_bf16_f32 v216, v184, v185
    s_waitcnt lgkmcnt(3)
    v_mfma_f32_16x16x32_bf16 v[200:203], v[240:243], v[48:51], v[200:203]
    v_cvt_pk_bf16_f32 v217, v186, v187
    v_mfma_f32_16x16x32_bf16 v[204:207], v[240:243], v[52:55], v[204:207]
    ds_read_b128 v[232:235], v4 offset:10240
    v_cvt_pk_bf16_f32 v218, v192, v193
    s_waitcnt lgkmcnt(3)
    v_mfma_f32_16x16x32_bf16 v[208:211], v[244:247], v[48:51], v[208:211]
    v_cvt_pk_bf16_f32 v219, v194, v195
    v_mfma_f32_16x16x32_bf16 v[212:215], v[244:247], v[52:55], v[212:215]
    ds_read_b128 v[236:239], v4 offset:11264
    buffer_store_dwordx4 v[216:219], v2, s[8:11], s25 offen offset:0 sc1
    s_waitcnt lgkmcnt(3)
    v_mfma_f32_16x16x32_bf16 v[200:203], v[224:227], v[56:59], v[200:203]
    v_mul_f32 v188, v188, v10
    v_mfma_f32_16x16x32_bf16 v[204:207], v[224:227], v[60:63], v[204:207]
    ds_read_b128 v[240:243], v4 offset:12288
    v_mul_f32 v189, v189, v10
    s_waitcnt lgkmcnt(3)
    v_mfma_f32_16x16x32_bf16 v[208:211], v[228:231], v[56:59], v[208:211]
    v_mul_f32 v190, v190, v10
    v_mfma_f32_16x16x32_bf16 v[212:215], v[228:231], v[60:63], v[212:215]
    ds_read_b128 v[244:247], v4 offset:13312
    v_mul_f32 v191, v191, v10
    s_waitcnt lgkmcnt(3)
    v_mfma_f32_16x16x32_bf16 v[200:203], v[232:235], v[64:67], v[200:203]
    v_mul_f32 v196, v196, v10
    v_mfma_f32_16x16x32_bf16 v[204:207], v[232:235], v[68:71], v[204:207]
    ds_read_b128 v[224:227], v4 offset:14336
    v_mul_f32 v197, v197, v10
    s_waitcnt lgkmcnt(3)
    v_mfma_f32_16x16x32_bf16 v[208:211], v[236:239], v[64:67], v[208:211]
    v_mul_f32 v198, v198, v10
    v_mfma_f32_16x16x32_bf16 v[212:215], v[236:239], v[68:71], v[212:215]
    ds_read_b128 v[228:231], v4 offset:15360
    v_mul_f32 v199, v199, v10
    s_waitcnt lgkmcnt(3)
    v_mfma_f32_16x16x32_bf16 v[200:203], v[240:243], v[72:75], v[200:203]
    v_cvt_pk_bf16_f32 v220, v188, v189
    v_mfma_f32_16x16x32_bf16 v[204:207], v[240:243], v[76:79], v[204:207]
    s_barrier
    ds_read_b128 v[232:235], v4 offset:16384
    v_cvt_pk_bf16_f32 v221, v190, v191
    s_waitcnt lgkmcnt(3)
    v_mfma_f32_16x16x32_bf16 v[208:211], v[244:247], v[72:75], v[208:211]
    v_cvt_pk_bf16_f32 v222, v196, v197
    v_mfma_f32_16x16x32_bf16 v[212:215], v[244:247], v[76:79], v[212:215]
    s_add_u32 s22, s21, 0x9c000
    s_add_u32 m0, s20, 0x24000
    s_nop 0
    buffer_load_dwordx4 v2, s[8:11], s22 offen sc1 lds
    ds_read_b128 v[236:239], v4 offset:17408
    v_cvt_pk_bf16_f32 v223, v198, v199
    s_waitcnt lgkmcnt(3)
    v_mfma_f32_16x16x32_bf16 v[200:203], v[224:227], v[80:83], v[200:203]
    buffer_store_dwordx4 v[220:223], v2, s[8:11], s26 offen offset:0 sc1
    v_mfma_f32_16x16x32_bf16 v[204:207], v[224:227], v[84:87], v[204:207]
    ds_read_b128 v[240:243], v4 offset:18432
    s_waitcnt lgkmcnt(3)
    v_mfma_f32_16x16x32_bf16 v[208:211], v[228:231], v[80:83], v[208:211]
    v_mfma_f32_16x16x32_bf16 v[212:215], v[228:231], v[84:87], v[212:215]
    ds_read_b128 v[244:247], v4 offset:19456
    s_waitcnt lgkmcnt(3)
    v_mfma_f32_16x16x32_bf16 v[200:203], v[232:235], v[88:91], v[200:203]
    v_mfma_f32_16x16x32_bf16 v[204:207], v[232:235], v[92:95], v[204:207]
    ds_read_b128 v[224:227], v4 offset:20480
    s_waitcnt lgkmcnt(3)
    v_mfma_f32_16x16x32_bf16 v[208:211], v[236:239], v[88:91], v[208:211]
    v_mfma_f32_16x16x32_bf16 v[212:215], v[236:239], v[92:95], v[212:215]
    s_add_u32 s22, s21, 0x9c400
    s_add_u32 m0, s20, 0x24400
    s_nop 0
    buffer_load_dwordx4 v2, s[8:11], s22 offen sc1 lds
    ds_read_b128 v[228:231], v4 offset:21504
    s_waitcnt lgkmcnt(3)
    v_mfma_f32_16x16x32_bf16 v[200:203], v[240:243], v[96:99], v[200:203]
    v_mfma_f32_16x16x32_bf16 v[204:207], v[240:243], v[100:103], v[204:207]
    ds_read_b128 v[232:235], v4 offset:22528
    s_waitcnt lgkmcnt(3)
    v_mfma_f32_16x16x32_bf16 v[208:211], v[244:247], v[96:99], v[208:211]
    v_mfma_f32_16x16x32_bf16 v[212:215], v[244:247], v[100:103], v[212:215]
    ds_read_b128 v[236:239], v4 offset:23552
    s_waitcnt lgkmcnt(3)
    v_mfma_f32_16x16x32_bf16 v[200:203], v[224:227], v[104:107], v[200:203]
    v_mfma_f32_16x16x32_bf16 v[204:207], v[224:227], v[108:111], v[204:207]
    ds_read_b128 v[240:243], v4 offset:24576
    s_waitcnt lgkmcnt(3)
    v_mfma_f32_16x16x32_bf16 v[208:211], v[228:231], v[104:107], v[208:211]
    v_mfma_f32_16x16x32_bf16 v[212:215], v[228:231], v[108:111], v[212:215]
    ds_read_b128 v[244:247], v4 offset:25600
    s_waitcnt lgkmcnt(3)
    v_mfma_f32_16x16x32_bf16 v[200:203], v[232:235], v[112:115], v[200:203]
    s_waitcnt vmcnt(4)
    v_mov_b32 v248, s28
    v_mov_b32 v249, 0
    s_lshl_b32 s14, s2, 2
    s_add_u32 s14, s14, 0x544000
    s_cmp_eq_u32 s3, 0
    s_cselect_b32 s14, s14, 0x7ffffff0
    s_mov_b64 exec, 1
    buffer_store_dword v248, v249, s[8:11], s14 offen sc1
    s_mov_b64 exec, -1
    v_mfma_f32_16x16x32_bf16 v[204:207], v[232:235], v[116:119], v[204:207]
    ds_read_b128 v[224:227], v4 offset:26624
    s_waitcnt lgkmcnt(3)
    v_mfma_f32_16x16x32_bf16 v[208:211], v[236:239], v[112:115], v[208:211]
    v_mfma_f32_16x16x32_bf16 v[212:215], v[236:239], v[116:119], v[212:215]
    ds_read_b128 v[228:231], v4 offset:27648
    s_waitcnt lgkmcnt(3)
    v_mfma_f32_16x16x32_bf16 v[200:203], v[240:243], v[120:123], v[200:203]
    v_mfma_f32_16x16x32_bf16 v[204:207], v[240:243], v[124:127], v[204:207]
    ds_read_b128 v[232:235], v4 offset:28672
    s_waitcnt lgkmcnt(3)
    v_mfma_f32_16x16x32_bf16 v[208:211], v[244:247], v[120:123], v[208:211]
    v_mfma_f32_16x16x32_bf16 v[212:215], v[244:247], v[124:127], v[212:215]
    ds_read_b128 v[236:239], v4 offset:29696
    s_waitcnt lgkmcnt(3)
    v_mfma_f32_16x16x32_bf16 v[200:203], v[224:227], v[128:131], v[200:203]
    v_mfma_f32_16x16x32_bf16 v[204:207], v[224:227], v[132:135], v[204:207]
    ds_read_b128 v[240:243], v4 offset:30720
    s_waitcnt lgkmcnt(3)
    v_mfma_f32_16x16x32_bf16 v[208:211], v[228:231], v[128:131], v[208:211]
    v_mfma_f32_16x16x32_bf16 v[212:215], v[228:231], v[132:135], v[212:215]
    ds_read_b128 v[244:247], v4 offset:31744
    s_waitcnt lgkmcnt(3)
    v_mfma_f32_16x16x32_bf16 v[200:203], v[232:235], v[136:139], v[200:203]
    v_mfma_f32_16x16x32_bf16 v[204:207], v[232:235], v[140:143], v[204:207]
    s_barrier
    ds_read_b128 v[224:227], v4 offset:32768
    s_waitcnt lgkmcnt(3)
    v_mfma_f32_16x16x32_bf16 v[208:211], v[236:239], v[136:139], v[208:211]
    v_mfma_f32_16x16x32_bf16 v[212:215], v[236:239], v[140:143], v[212:215]
    s_add_u32 s22, s24, 0x0
    s_add_u32 m0, s20, 0x10000
    s_nop 0
    buffer_load_dwordx4 v3, s[4:7], s22 offen lds
    ds_read_b128 v[228:231], v4 offset:33792
    s_waitcnt lgkmcnt(3)
    v_mfma_f32_16x16x32_bf16 v[200:203], v[240:243], v[144:147], v[200:203]
    v_mfma_f32_16x16x32_bf16 v[204:207], v[240:243], v[148:151], v[204:207]
    ds_read_b128 v[232:235], v4 offset:34816
    s_waitcnt lgkmcnt(3)
    v_mfma_f32_16x16x32_bf16 v[208:211], v[244:247], v[144:147], v[208:211]
    v_mfma_f32_16x16x32_bf16 v[212:215], v[244:247], v[148:151], v[212:215]
    ds_read_b128 v[236:239], v4 offset:35840
    s_waitcnt lgkmcnt(3)
    v_mfma_f32_16x16x32_bf16 v[184:187], v[224:227], v[24:27], 0
    v_mfma_f32_16x16x32_bf16 v[188:191], v[224:227], v[28:31], 0
    ds_read_b128 v[240:243], v4 offset:36864
    s_waitcnt lgkmcnt(3)
    v_mfma_f32_16x16x32_bf16 v[192:195], v[228:231], v[24:27], 0
    v_mfma_f32_16x16x32_bf16 v[196:199], v[228:231], v[28:31], 0
    s_add_u32 s22, s24, 0x2000
    s_add_u32 m0, s20, 0x10400
    s_nop 0
    buffer_load_dwordx4 v3, s[4:7], s22 offen lds
    ds_read_b128 v[244:247], v4 offset:37888
    v_mul_f32 v200, v200, v9
    s_waitcnt lgkmcnt(3)
    v_mfma_f32_16x16x32_bf16 v[184:187], v[232:235], v[32:35], v[184:187]
    v_mul_f32 v201, v201, v9
    v_mfma_f32_16x16x32_bf16 v[188:191], v[232:235], v[36:39], v[188:191]
    ds_read_b128 v[224:227], v4 offset:38912
    v_mul_f32 v202, v202, v9
    s_waitcnt lgkmcnt(3)
    v_mfma_f32_16x16x32_bf16 v[192:195], v[236:239], v[32:35], v[192:195]
    v_mul_f32 v203, v203, v9
    v_mfma_f32_16x16x32_bf16 v[196:199], v[236:239], v[36:39], v[196:199]
    ds_read_b128 v[228:231], v4 offset:39936
    v_mul_f32 v208, v208, v9
    s_waitcnt lgkmcnt(3)
    v_mfma_f32_16x16x32_bf16 v[184:187], v[240:243], v[40:43], v[184:187]
    v_mul_f32 v209, v209, v9
    v_mfma_f32_16x16x32_bf16 v[188:191], v[240:243], v[44:47], v[188:191]
    ds_read_b128 v[232:235], v4 offset:40960
    v_mul_f32 v210, v210, v9
    s_waitcnt lgkmcnt(3)
    v_mfma_f32_16x16x32_bf16 v[192:195], v[244:247], v[40:43], v[192:195]
    v_mul_f32 v211, v211, v9
    v_mfma_f32_16x16x32_bf16 v[196:199], v[244:247], v[44:47], v[196:199]
    ds_read_b128 v[236:239], v4 offset:41984
    v_cvt_pk_bf16_f32 v216, v200, v201
    s_waitcnt lgkmcnt(3)
    v_mfma_f32_16x16x32_bf16 v[184:187], v[224:227], v[48:51], v[184:187]
    v_cvt_pk_bf16_f32 v217, v202, v203
    s_waitcnt vmcnt(4)
    s_add_u32 s16, s63, 0x570000
    v_mov_b32 v7, s28
    v_mov_b32 v8, 0
    s_mov_b64 exec, 1
    buffer_store_dword v7, v8, s[8:11], s16 offen sc1
    s_mov_b64 exec, -1
    v_mfma_f32_16x16x32_bf16 v[188:191], v[224:227], v[52:55], v[188:191]
    ds_read_b128 v[240:243], v4 offset:43008
    v_cvt_pk_bf16_f32 v218, v208, v209
    s_waitcnt lgkmcnt(3)
    v_mfma_f32_16x16x32_bf16 v[192:195], v[228:231], v[48:51], v[192:195]
    v_cvt_pk_bf16_f32 v219, v210, v211
    v_mfma_f32_16x16x32_bf16 v[196:199], v[228:231], v[52:55], v[196:199]
    ds_read_b128 v[244:247], v4 offset:44032
    buffer_store_dwordx4 v[216:219], v2, s[8:11], s25 offen offset:1024 sc1
    s_waitcnt lgkmcnt(3)
    v_mfma_f32_16x16x32_bf16 v[184:187], v[232:235], v[56:59], v[184:187]
    v_mul_f32 v204, v204, v10
    v_mfma_f32_16x16x32_bf16 v[188:191], v[232:235], v[60:63], v[188:191]
    ds_read_b128 v[224:227], v4 offset:45056
    v_mul_f32 v205, v205, v10
    s_waitcnt lgkmcnt(3)
    v_mfma_f32_16x16x32_bf16 v[192:195], v[236:239], v[56:59], v[192:195]
    v_mul_f32 v206, v206, v10
    v_mfma_f32_16x16x32_bf16 v[196:199], v[236:239], v[60:63], v[196:199]
    ds_read_b128 v[228:231], v4 offset:46080
    v_mul_f32 v207, v207, v10
    s_waitcnt lgkmcnt(3)
    v_mfma_f32_16x16x32_bf16 v[184:187], v[240:243], v[64:67], v[184:187]
    v_mul_f32 v212, v212, v10
    v_mfma_f32_16x16x32_bf16 v[188:191], v[240:243], v[68:71], v[188:191]
    ds_read_b128 v[232:235], v4 offset:47104
    v_mul_f32 v213, v213, v10
    s_waitcnt lgkmcnt(3)
    v_mfma_f32_16x16x32_bf16 v[192:195], v[244:247], v[64:67], v[192:195]
    v_mul_f32 v214, v214, v10
    v_mfma_f32_16x16x32_bf16 v[196:199], v[244:247], v[68:71], v[196:199]
    ds_read_b128 v[236:239], v4 offset:48128
    v_mul_f32 v215, v215, v10
    s_waitcnt lgkmcnt(3)
    v_mfma_f32_16x16x32_bf16 v[184:187], v[224:227], v[72:75], v[184:187]
    v_cvt_pk_bf16_f32 v220, v204, v205
    v_mfma_f32_16x16x32_bf16 v[188:191], v[224:227], v[76:79], v[188:191]
    s_barrier
    ds_read_b128 v[240:243], v4 offset:49152
    v_cvt_pk_bf16_f32 v221, v206, v207
    s_waitcnt lgkmcnt(3)
    v_mfma_f32_16x16x32_bf16 v[192:195], v[228:231], v[72:75], v[192:195]
    v_cvt_pk_bf16_f32 v222, v212, v213
    v_mfma_f32_16x16x32_bf16 v[196:199], v[228:231], v[76:79], v[196:199]
    s_add_u32 s22, s24, 0x80000
    s_add_u32 m0, s20, 0x14000
    s_nop 0
    buffer_load_dwordx4 v3, s[4:7], s22 offen lds
    ds_read_b128 v[244:247], v4 offset:50176
    v_cvt_pk_bf16_f32 v223, v214, v215
    s_waitcnt lgkmcnt(3)
    v_mfma_f32_16x16x32_bf16 v[184:187], v[232:235], v[80:83], v[184:187]
    buffer_store_dwordx4 v[220:223], v2, s[8:11], s26 offen offset:1024 sc1
    v_mfma_f32_16x16x32_bf16 v[188:191], v[232:235], v[84:87], v[188:191]
    ds_read_b128 v[224:227], v4 offset:51200
    s_waitcnt lgkmcnt(3)
    v_mfma_f32_16x16x32_bf16 v[192:195], v[236:239], v[80:83], v[192:195]
    v_mfma_f32_16x16x32_bf16 v[196:199], v[236:239], v[84:87], v[196:199]
    ds_read_b128 v[228:231], v4 offset:52224
    s_waitcnt lgkmcnt(3)
    v_mfma_f32_16x16x32_bf16 v[184:187], v[240:243], v[88:91], v[184:187]
    v_mfma_f32_16x16x32_bf16 v[188:191], v[240:243], v[92:95], v[188:191]
    ds_read_b128 v[232:235], v4 offset:53248
    s_waitcnt lgkmcnt(3)
    v_mfma_f32_16x16x32_bf16 v[192:195], v[244:247], v[88:91], v[192:195]
    v_mfma_f32_16x16x32_bf16 v[196:199], v[244:247], v[92:95], v[196:199]
    s_add_u32 s22, s24, 0x82000
    s_add_u32 m0, s20, 0x14400
    s_nop 0
    buffer_load_dwordx4 v3, s[4:7], s22 offen lds
    ds_read_b128 v[236:239], v4 offset:54272
    s_waitcnt lgkmcnt(3)
    v_mfma_f32_16x16x32_bf16 v[184:187], v[224:227], v[96:99], v[184:187]
    v_mfma_f32_16x16x32_bf16 v[188:191], v[224:227], v[100:103], v[188:191]
    ds_read_b128 v[240:243], v4 offset:55296
    s_waitcnt lgkmcnt(3)
    v_mfma_f32_16x16x32_bf16 v[192:195], v[228:231], v[96:99], v[192:195]
    v_mfma_f32_16x16x32_bf16 v[196:199], v[228:231], v[100:103], v[196:199]
    ds_read_b128 v[244:247], v4 offset:56320
    s_waitcnt lgkmcnt(3)
    v_mfma_f32_16x16x32_bf16 v[184:187], v[232:235], v[104:107], v[184:187]
    v_mfma_f32_16x16x32_bf16 v[188:191], v[232:235], v[108:111], v[188:191]
    ds_read_b128 v[224:227], v4 offset:57344
    s_waitcnt lgkmcnt(3)
    v_mfma_f32_16x16x32_bf16 v[192:195], v[236:239], v[104:107], v[192:195]
    v_mfma_f32_16x16x32_bf16 v[196:199], v[236:239], v[108:111], v[196:199]
    ds_read_b128 v[228:231], v4 offset:58368
    s_waitcnt lgkmcnt(3)
    v_mfma_f32_16x16x32_bf16 v[184:187], v[240:243], v[112:115], v[184:187]
    v_mfma_f32_16x16x32_bf16 v[188:191], v[240:243], v[116:119], v[188:191]
    ds_read_b128 v[232:235], v4 offset:59392
    s_waitcnt lgkmcnt(3)
    v_mfma_f32_16x16x32_bf16 v[192:195], v[244:247], v[112:115], v[192:195]
    v_mfma_f32_16x16x32_bf16 v[196:199], v[244:247], v[116:119], v[196:199]
    ds_read_b128 v[236:239], v4 offset:60416
    s_waitcnt lgkmcnt(3)
    v_mfma_f32_16x16x32_bf16 v[184:187], v[224:227], v[120:123], v[184:187]
    v_mfma_f32_16x16x32_bf16 v[188:191], v[224:227], v[124:127], v[188:191]
    ds_read_b128 v[240:243], v4 offset:61440
    s_waitcnt lgkmcnt(3)
    v_mfma_f32_16x16x32_bf16 v[192:195], v[228:231], v[120:123], v[192:195]
    v_mfma_f32_16x16x32_bf16 v[196:199], v[228:231], v[124:127], v[196:199]
    ds_read_b128 v[244:247], v4 offset:62464
    s_waitcnt lgkmcnt(3)
    v_mfma_f32_16x16x32_bf16 v[184:187], v[232:235], v[128:131], v[184:187]
    v_mfma_f32_16x16x32_bf16 v[188:191], v[232:235], v[132:135], v[188:191]
    ds_read_b128 v[224:227], v4 offset:63488
    s_waitcnt lgkmcnt(3)
    v_mfma_f32_16x16x32_bf16 v[192:195], v[236:239], v[128:131], v[192:195]
    v_mfma_f32_16x16x32_bf16 v[196:199], v[236:239], v[132:135], v[196:199]
    ds_read_b128 v[228:231], v4 offset:64512
    s_waitcnt lgkmcnt(3)
    v_mfma_f32_16x16x32_bf16 v[184:187], v[240:243], v[136:139], v[184:187]
    v_mfma_f32_16x16x32_bf16 v[188:191], v[240:243], v[140:143], v[188:191]
    s_barrier
    ds_read_b128 v[232:235], v5 offset:0
    s_waitcnt lgkmcnt(3)
    v_mfma_f32_16x16x32_bf16 v[192:195], v[244:247], v[136:139], v[192:195]
    v_mfma_f32_16x16x32_bf16 v[196:199], v[244:247], v[140:143], v[196:199]
    s_add_u32 s22, s24, 0x100000
    s_add_u32 m0, s20, 0x18000
    s_nop 0
    buffer_load_dwordx4 v3, s[4:7], s22 offen lds
    ds_read_b128 v[236:239], v5 offset:1024
    s_waitcnt lgkmcnt(3)
    v_mfma_f32_16x16x32_bf16 v[184:187], v[224:227], v[144:147], v[184:187]
    v_mfma_f32_16x16x32_bf16 v[188:191], v[224:227], v[148:151], v[188:191]
    ds_read_b128 v[240:243], v5 offset:2048
    s_waitcnt lgkmcnt(3)
    v_mfma_f32_16x16x32_bf16 v[192:195], v[228:231], v[144:147], v[192:195]
    v_mfma_f32_16x16x32_bf16 v[196:199], v[228:231], v[148:151], v[196:199]
    ds_read_b128 v[244:247], v5 offset:3072
    s_waitcnt lgkmcnt(3)
    v_mfma_f32_16x16x32_bf16 v[200:203], v[232:235], v[24:27], 0
    v_mfma_f32_16x16x32_bf16 v[204:207], v[232:235], v[28:31], 0
    ds_read_b128 v[224:227], v5 offset:4096
    s_waitcnt lgkmcnt(3)
    v_mfma_f32_16x16x32_bf16 v[208:211], v[236:239], v[24:27], 0
    v_mfma_f32_16x16x32_bf16 v[212:215], v[236:239], v[28:31], 0
    s_add_u32 s22, s24, 0x102000
    s_add_u32 m0, s20, 0x18400
    s_nop 0
    buffer_load_dwordx4 v3, s[4:7], s22 offen lds
    ds_read_b128 v[228:231], v5 offset:5120
    v_mul_f32 v184, v184, v9
    s_waitcnt lgkmcnt(3)
    v_mfma_f32_16x16x32_bf16 v[200:203], v[240:243], v[32:35], v[200:203]
    v_mul_f32 v185, v185, v9
    s_bfe_u32 s30, s2, 0x20001
    s_lshl_b32 s30, s30, 2
    s_bfe_u32 s17, s2, 0x20003
    s_add_u32 s30, s30, s17
    s_lshr_b32 s31, s2, 5
    s_and_b32 s17, s3, 3
    s_lshl_b32 s19, s30, 2
    s_add_u32 s19, s19, s17
    s_and_b32 s16, s2, 1
    s_lshl_b32 s17, s19, 18
    s_lshl_b32 s23, s16, 16
    s_add_u32 s17, s17, s23
    s_add_u32 s17, s17, 0x1000000
    v_add_u32 v6, s17, v2
    s_lshl_b32 s19, s19, 7
    s_lshl_b32 s23, s16, 6
    s_add_u32 s19, s19, s23
    s_add_u32 s19, s19, 0x570000
    v_and_b32 v13, 15, v1
    v_lshlrev_b32 v13, 2, v13
    buffer_load_dword v12, v13, s[8:11], s19 offen sc1
    v_mfma_f32_16x16x32_bf16 v[204:207], v[240:243], v[36:39], v[204:207]
    ds_read_b128 v[232:235], v5 offset:6144
    v_mul_f32 v186, v186, v9
    s_waitcnt lgkmcnt(3)
    v_mfma_f32_16x16x32_bf16 v[208:211], v[244:247], v[32:35], v[208:211]
    v_mul_f32 v187, v187, v9
    v_mfma_f32_16x16x32_bf16 v[212:215], v[244:247], v[36:39], v[212:215]
    ds_read_b128 v[236:239], v5 offset:7168
    v_mul_f32 v192, v192, v9
    s_waitcnt lgkmcnt(3)
    v_mfma_f32_16x16x32_bf16 v[200:203], v[224:227], v[40:43], v[200:203]
    v_mul_f32 v193, v193, v9
    v_mfma_f32_16x16x32_bf16 v[204:207], v[224:227], v[44:47], v[204:207]
    ds_read_b128 v[240:243], v5 offset:8192
    v_mul_f32 v194, v194, v9
    s_waitcnt lgkmcnt(3)
    v_mfma_f32_16x16x32_bf16 v[208:211], v[228:231], v[40:43], v[208:211]
    v_mul_f32 v195, v195, v9
    v_mfma_f32_16x16x32_bf16 v[212:215], v[228:231], v[44:47], v[212:215]
    ds_read_b128 v[244:247], v5 offset:9216
    v_cvt_pk_bf16_f32 v216, v184, v185
    s_waitcnt lgkmcnt(3)
    v_mfma_f32_16x16x32_bf16 v[200:203], v[232:235], v[48:51], v[200:203]
    v_cvt_pk_bf16_f32 v217, v186, v187
    v_mfma_f32_16x16x32_bf16 v[204:207], v[232:235], v[52:55], v[204:207]
    ds_read_b128 v[224:227], v5 offset:10240
    v_cvt_pk_bf16_f32 v218, v192, v193
    s_waitcnt lgkmcnt(3)
    v_mfma_f32_16x16x32_bf16 v[208:211], v[236:239], v[48:51], v[208:211]
    v_cvt_pk_bf16_f32 v219, v194, v195
    v_mfma_f32_16x16x32_bf16 v[212:215], v[236:239], v[52:55], v[212:215]
    ds_read_b128 v[228:231], v5 offset:11264
    buffer_store_dwordx4 v[216:219], v2, s[8:11], s25 offen offset:2048 sc1
    s_waitcnt lgkmcnt(3)
    v_mfma_f32_16x16x32_bf16 v[200:203], v[240:243], v[56:59], v[200:203]
    v_mul_f32 v188, v188, v10
    v_mfma_f32_16x16x32_bf16 v[204:207], v[240:243], v[60:63], v[204:207]
    ds_read_b128 v[232:235], v5 offset:12288
    v_mul_f32 v189, v189, v10
    s_waitcnt lgkmcnt(3)
    v_mfma_f32_16x16x32_bf16 v[208:211], v[244:247], v[56:59], v[208:211]
    v_mul_f32 v190, v190, v10
    v_mfma_f32_16x16x32_bf16 v[212:215], v[244:247], v[60:63], v[212:215]
    ds_read_b128 v[236:239], v5 offset:13312
    v_mul_f32 v191, v191, v10
    s_waitcnt lgkmcnt(3)
    v_mfma_f32_16x16x32_bf16 v[200:203], v[224:227], v[64:67], v[200:203]
    v_mul_f32 v196, v196, v10
    v_mfma_f32_16x16x32_bf16 v[204:207], v[224:227], v[68:71], v[204:207]
    ds_read_b128 v[240:243], v5 offset:14336
    v_mul_f32 v197, v197, v10
    s_waitcnt lgkmcnt(3)
    v_mfma_f32_16x16x32_bf16 v[208:211], v[228:231], v[64:67], v[208:211]
    v_mul_f32 v198, v198, v10
    v_mfma_f32_16x16x32_bf16 v[212:215], v[228:231], v[68:71], v[212:215]
    ds_read_b128 v[244:247], v5 offset:15360
    v_mul_f32 v199, v199, v10
    s_waitcnt lgkmcnt(3)
    v_mfma_f32_16x16x32_bf16 v[200:203], v[232:235], v[72:75], v[200:203]
    v_cvt_pk_bf16_f32 v220, v188, v189
    v_mfma_f32_16x16x32_bf16 v[204:207], v[232:235], v[76:79], v[204:207]
    s_waitcnt vmcnt(12)
    s_barrier
    ds_read_b128 v[224:227], v5 offset:16384
    v_cvt_pk_bf16_f32 v221, v190, v191
    s_waitcnt lgkmcnt(3)
    v_mfma_f32_16x16x32_bf16 v[208:211], v[236:239], v[72:75], v[208:211]
    v_cvt_pk_bf16_f32 v222, v196, v197
    v_mfma_f32_16x16x32_bf16 v[212:215], v[236:239], v[76:79], v[212:215]
    s_add_u32 s22, s24, 0x180000
    s_add_u32 m0, s20, 0x1c000
    s_nop 0
    buffer_load_dwordx4 v3, s[4:7], s22 offen lds
    ds_read_b128 v[228:231], v5 offset:17408
    v_cvt_pk_bf16_f32 v223, v198, v199
    s_waitcnt lgkmcnt(3)
    v_mfma_f32_16x16x32_bf16 v[200:203], v[240:243], v[80:83], v[200:203]
    buffer_store_dwordx4 v[220:223], v2, s[8:11], s26 offen offset:2048 sc1
    v_mfma_f32_16x16x32_bf16 v[204:207], v[240:243], v[84:87], v[204:207]
    ds_read_b128 v[232:235], v5 offset:18432
    s_waitcnt lgkmcnt(3)
    v_mfma_f32_16x16x32_bf16 v[208:211], v[244:247], v[80:83], v[208:211]
    v_mfma_f32_16x16x32_bf16 v[212:215], v[244:247], v[84:87], v[212:215]
    ds_read_b128 v[236:239], v5 offset:19456
    s_waitcnt lgkmcnt(3)
    v_mfma_f32_16x16x32_bf16 v[200:203], v[224:227], v[88:91], v[200:203]
    v_mfma_f32_16x16x32_bf16 v[204:207], v[224:227], v[92:95], v[204:207]
    ds_read_b128 v[240:243], v5 offset:20480
    s_waitcnt vmcnt(3)
    v_cmp_ne_u32 vcc, s28, v12
    s_cbranch_vccnz adaLN_cond__sliding_block_cached__moe_arch_mod__prompt_kernel_o6r
adaLN_cond__sliding_block_cached__moe_arch_mod__prompt_kernel_o6b:
    s_waitcnt lgkmcnt(3)
    v_mfma_f32_16x16x32_bf16 v[208:211], v[228:231], v[88:91], v[208:211]
    s_mov_b32 s23, 0x0
    buffer_load_dwordx4 v[24:27], v6, s[8:11], s23 offen offset:0 sc1
    v_mfma_f32_16x16x32_bf16 v[212:215], v[228:231], v[92:95], v[212:215]
    s_add_u32 s22, s24, 0x182000
    s_add_u32 m0, s20, 0x1c400
    s_nop 0
    buffer_load_dwordx4 v3, s[4:7], s22 offen lds
    ds_read_b128 v[244:247], v5 offset:21504
    s_waitcnt lgkmcnt(3)
    v_mfma_f32_16x16x32_bf16 v[200:203], v[232:235], v[96:99], v[200:203]
    v_mfma_f32_16x16x32_bf16 v[204:207], v[232:235], v[100:103], v[204:207]
    ds_read_b128 v[224:227], v5 offset:22528
    s_mov_b32 s23, 0x20000
    buffer_load_dwordx4 v[28:31], v6, s[8:11], s23 offen offset:0 sc1
    s_waitcnt lgkmcnt(3)
    v_mfma_f32_16x16x32_bf16 v[208:211], v[236:239], v[96:99], v[208:211]
    s_add_u32 s16, s63, 0x572000
    v_mov_b32 v14, s28
    v_mov_b32 v15, 0
    s_mov_b64 exec, 1
    buffer_store_dword v14, v15, s[8:11], s16 offen sc1
    s_mov_b64 exec, -1
    v_mfma_f32_16x16x32_bf16 v[212:215], v[236:239], v[100:103], v[212:215]
    ds_read_b128 v[228:231], v5 offset:23552
    s_waitcnt lgkmcnt(3)
    v_mfma_f32_16x16x32_bf16 v[200:203], v[240:243], v[104:107], v[200:203]
    v_mfma_f32_16x16x32_bf16 v[204:207], v[240:243], v[108:111], v[204:207]
    ds_read_b128 v[232:235], v5 offset:24576
    s_mov_b32 s23, 0x2000
    buffer_load_dwordx4 v[32:35], v6, s[8:11], s23 offen offset:0 sc1
    s_waitcnt lgkmcnt(3)
    v_mfma_f32_16x16x32_bf16 v[208:211], v[244:247], v[104:107], v[208:211]
    v_mfma_f32_16x16x32_bf16 v[212:215], v[244:247], v[108:111], v[212:215]
    ds_read_b128 v[236:239], v5 offset:25600
    s_waitcnt lgkmcnt(3)
    v_mfma_f32_16x16x32_bf16 v[200:203], v[224:227], v[112:115], v[200:203]
    s_mov_b32 s23, 0x22000
    buffer_load_dwordx4 v[36:39], v6, s[8:11], s23 offen offset:0 sc1
    v_mfma_f32_16x16x32_bf16 v[204:207], v[224:227], v[116:119], v[204:207]
    ds_read_b128 v[240:243], v5 offset:26624
    s_waitcnt lgkmcnt(3)
    v_mfma_f32_16x16x32_bf16 v[208:211], v[228:231], v[112:115], v[208:211]
    v_mfma_f32_16x16x32_bf16 v[212:215], v[228:231], v[116:119], v[212:215]
    ds_read_b128 v[244:247], v5 offset:27648
    s_waitcnt lgkmcnt(3)
    v_mfma_f32_16x16x32_bf16 v[200:203], v[232:235], v[120:123], v[200:203]
    s_mov_b32 s23, 0x4000
    buffer_load_dwordx4 v[40:43], v6, s[8:11], s23 offen offset:0 sc1
    v_mfma_f32_16x16x32_bf16 v[204:207], v[232:235], v[124:127], v[204:207]
    ds_read_b128 v[224:227], v5 offset:28672
    s_waitcnt lgkmcnt(3)
    v_mfma_f32_16x16x32_bf16 v[208:211], v[236:239], v[120:123], v[208:211]
    v_mfma_f32_16x16x32_bf16 v[212:215], v[236:239], v[124:127], v[212:215]
    ds_read_b128 v[228:231], v5 offset:29696
    s_waitcnt lgkmcnt(3)
    v_mfma_f32_16x16x32_bf16 v[200:203], v[240:243], v[128:131], v[200:203]
    s_mov_b32 s23, 0x24000
    buffer_load_dwordx4 v[44:47], v6, s[8:11], s23 offen offset:0 sc1
    v_mfma_f32_16x16x32_bf16 v[204:207], v[240:243], v[132:135], v[204:207]
    ds_read_b128 v[232:235], v5 offset:30720
    s_waitcnt lgkmcnt(3)
    v_mfma_f32_16x16x32_bf16 v[208:211], v[244:247], v[128:131], v[208:211]
    v_mfma_f32_16x16x32_bf16 v[212:215], v[244:247], v[132:135], v[212:215]
    ds_read_b128 v[236:239], v5 offset:31744
    s_mov_b32 s23, 0x6000
    buffer_load_dwordx4 v[48:51], v6, s[8:11], s23 offen offset:0 sc1
    s_waitcnt lgkmcnt(3)
    v_mfma_f32_16x16x32_bf16 v[200:203], v[224:227], v[136:139], v[200:203]
    v_bfe_u32 v18, v1, 2, 2
    v_lshrrev_b32 v19, 4, v1
    v_mfma_f32_16x16x32_bf16 v[204:207], v[224:227], v[140:143], v[204:207]
    v_and_b32 v17, 3, v1
    v_lshlrev_b32 v16, 11, v19
    s_waitcnt lgkmcnt(2)
    v_mfma_f32_16x16x32_bf16 v[208:211], v[228:231], v[136:139], v[208:211]
    v_lshl_add_u32 v16, v18, 6, v16
    v_lshl_add_u32 v16, v17, 3, v16
    v_mfma_f32_16x16x32_bf16 v[212:215], v[228:231], v[140:143], v[212:215]
    s_mov_b32 s23, 0x26000
    buffer_load_dwordx4 v[52:55], v6, s[8:11], s23 offen offset:0 sc1
    v_add_u32 v16, 0x10000, v16
    v_and_b32 v19, 1, v19
    s_waitcnt lgkmcnt(1)
    v_mfma_f32_16x16x32_bf16 v[200:203], v[232:235], v[144:147], v[200:203]
    v_lshlrev_b32 v19, 5, v19
    v_sub_u32 v5, v16, v19
    v_mfma_f32_16x16x32_bf16 v[204:207], v[232:235], v[148:151], v[204:207]
    v_add_u32 v4, v16, v19
    v_add_u32 v7, 0x10000, v4
    s_waitcnt lgkmcnt(0)
    v_mfma_f32_16x16x32_bf16 v[208:211], v[236:239], v[144:147], v[208:211]
    v_add_u32 v8, 0x10000, v5
    v_mfma_f32_16x16x32_bf16 v[212:215], v[236:239], v[148:151], v[212:215]
    v_mul_f32 v200, v200, v9
    v_mul_f32 v201, v201, v9
    v_mul_f32 v202, v202, v9
    v_mul_f32 v203, v203, v9
    s_nop 1
    v_mul_f32 v208, v208, v9
    v_mul_f32 v209, v209, v9
    v_mul_f32 v210, v210, v9
    v_mul_f32 v211, v211, v9
    v_cvt_pk_bf16_f32 v216, v200, v201
    v_cvt_pk_bf16_f32 v217, v202, v203
    v_cvt_pk_bf16_f32 v218, v208, v209
    v_cvt_pk_bf16_f32 v219, v210, v211
    buffer_store_dwordx4 v[216:219], v2, s[8:11], s25 offen offset:3072 sc1
    v_mul_f32 v204, v204, v10
    v_mul_f32 v205, v205, v10
    v_mul_f32 v206, v206, v10
    v_mul_f32 v207, v207, v10
    v_mul_f32 v212, v212, v10
    v_mul_f32 v213, v213, v10
    v_mul_f32 v214, v214, v10
    v_mul_f32 v215, v215, v10
    v_cvt_pk_bf16_f32 v220, v204, v205
    v_cvt_pk_bf16_f32 v221, v206, v207
    v_cvt_pk_bf16_f32 v222, v212, v213
    v_cvt_pk_bf16_f32 v223, v214, v215
    buffer_store_dwordx4 v[220:223], v2, s[8:11], s26 offen offset:3072 sc1
    s_and_b32 s15, s2, 1
    s_barrier
    ds_read_b64_tr_b16 v[224:225], v4 offset:0
    ds_read_b64_tr_b16 v[226:227], v4 offset:1024
    ds_read_b64_tr_b16 v[228:229], v5 offset:32
    ds_read_b64_tr_b16 v[230:231], v5 offset:1056
    ds_read_b64_tr_b16 v[232:233], v4 offset:256
    ds_read_b64_tr_b16 v[234:235], v4 offset:1280
    ds_read_b64_tr_b16 v[236:237], v5 offset:288
    ds_read_b64_tr_b16 v[238:239], v5 offset:1312
    s_waitcnt vmcnt(11) lgkmcnt(6)
    v_mfma_f32_16x16x32_bf16 v[88:91], v[224:227], v[24:27], 0
    ds_read_b64_tr_b16 v[240:241], v4 offset:512
    s_waitcnt vmcnt(9)
    v_mfma_f32_16x16x32_bf16 v[92:95], v[224:227], v[28:31], 0
    s_add_u32 s22, s24, 0x200000
    s_add_u32 m0, s20, 0x20000
    s_nop 0
    buffer_load_dwordx4 v3, s[4:7], s22 offen lds
    ds_read_b64_tr_b16 v[242:243], v4 offset:1536
    s_waitcnt lgkmcnt(6)
    v_mfma_f32_16x16x32_bf16 v[96:99], v[228:231], v[24:27], 0
    ds_read_b64_tr_b16 v[244:245], v5 offset:544
    s_mov_b32 s23, 0x8000
    buffer_load_dwordx4 v[56:59], v6, s[8:11], s23 offen offset:0 sc1
    v_mfma_f32_16x16x32_bf16 v[100:103], v[228:231], v[28:31], 0
    ds_read_b64_tr_b16 v[246:247], v5 offset:1568
    s_waitcnt lgkmcnt(6)
    v_mfma_f32_16x16x32_bf16 v[104:107], v[232:235], v[24:27], 0
    s_add_u32 s22, s24, 0x202000
    s_add_u32 m0, s20, 0x20400
    s_nop 0
    buffer_load_dwordx4 v3, s[4:7], s22 offen lds
    ds_read_b64_tr_b16 v[224:225], v4 offset:768
    v_mfma_f32_16x16x32_bf16 v[108:111], v[232:235], v[28:31], 0
    ds_read_b64_tr_b16 v[226:227], v4 offset:1792
    s_mov_b32 s23, 0x28000
    buffer_load_dwordx4 v[60:63], v6, s[8:11], s23 offen offset:0 sc1
    s_waitcnt lgkmcnt(6)
    v_mfma_f32_16x16x32_bf16 v[112:115], v[236:239], v[24:27], 0
    ds_read_b64_tr_b16 v[228:229], v5 offset:800
    v_mfma_f32_16x16x32_bf16 v[116:119], v[236:239], v[28:31], 0
    ds_read_b64_tr_b16 v[230:231], v5 offset:1824
    s_waitcnt lgkmcnt(6)
    v_mfma_f32_16x16x32_bf16 v[120:123], v[240:243], v[24:27], 0
    v_mfma_f32_16x16x32_bf16 v[124:127], v[240:243], v[28:31], 0
    s_barrier
    ds_read_b64_tr_b16 v[232:233], v4 offset:16384
    ds_read_b64_tr_b16 v[234:235], v4 offset:17408
    s_waitcnt lgkmcnt(6)
    v_mfma_f32_16x16x32_bf16 v[128:131], v[244:247], v[24:27], 0
    s_add_u32 s22, s24, 0x280000
    s_add_u32 m0, s20, 0x24000
    s_nop 0
    buffer_load_dwordx4 v3, s[4:7], s22 offen lds
    ds_read_b64_tr_b16 v[236:237], v5 offset:16416
    v_mfma_f32_16x16x32_bf16 v[132:135], v[244:247], v[28:31], 0
    ds_read_b64_tr_b16 v[238:239], v5 offset:17440
    s_waitcnt lgkmcnt(6)
    v_mfma_f32_16x16x32_bf16 v[136:139], v[224:227], v[24:27], 0
    ds_read_b64_tr_b16 v[240:241], v4 offset:16640
    v_mfma_f32_16x16x32_bf16 v[140:143], v[224:227], v[28:31], 0
    s_add_u32 s22, s24, 0x282000
    s_add_u32 m0, s20, 0x24400
    s_nop 0
    buffer_load_dwordx4 v3, s[4:7], s22 offen lds
    ds_read_b64_tr_b16 v[242:243], v4 offset:17664
    s_waitcnt lgkmcnt(6)
    v_mfma_f32_16x16x32_bf16 v[144:147], v[228:231], v[24:27], 0
    ds_read_b64_tr_b16 v[244:245], v5 offset:16672
    v_mfma_f32_16x16x32_bf16 v[148:151], v[228:231], v[28:31], 0
    ds_read_b64_tr_b16 v[246:247], v5 offset:17696
    s_waitcnt vmcnt(13) lgkmcnt(6)
    v_mfma_f32_16x16x32_bf16 v[88:91], v[232:235], v[32:35], v[88:91]
    ds_read_b64_tr_b16 v[224:225], v4 offset:16896
    s_waitcnt vmcnt(12)
    v_mfma_f32_16x16x32_bf16 v[92:95], v[232:235], v[36:39], v[92:95]
    ds_read_b64_tr_b16 v[226:227], v4 offset:17920
    s_waitcnt lgkmcnt(6)
    v_mfma_f32_16x16x32_bf16 v[96:99], v[236:239], v[32:35], v[96:99]
    ds_read_b64_tr_b16 v[228:229], v5 offset:16928
    s_mov_b32 s23, 0xa000
    buffer_load_dwordx4 v[24:27], v6, s[8:11], s23 offen offset:0 sc1
    v_mfma_f32_16x16x32_bf16 v[100:103], v[236:239], v[36:39], v[100:103]
    ds_read_b64_tr_b16 v[230:231], v5 offset:17952
    s_waitcnt lgkmcnt(6)
    v_mfma_f32_16x16x32_bf16 v[104:107], v[240:243], v[32:35], v[104:107]
    ds_read_b64_tr_b16 v[232:233], v4 offset:17152
    v_mfma_f32_16x16x32_bf16 v[108:111], v[240:243], v[36:39], v[108:111]
    ds_read_b64_tr_b16 v[234:235], v4 offset:18176
    s_mov_b32 s23, 0x2a000
    buffer_load_dwordx4 v[28:31], v6, s[8:11], s23 offen offset:0 sc1
    s_waitcnt lgkmcnt(6)
    v_mfma_f32_16x16x32_bf16 v[112:115], v[244:247], v[32:35], v[112:115]
    ds_read_b64_tr_b16 v[236:237], v5 offset:17184
    v_mfma_f32_16x16x32_bf16 v[116:119], v[244:247], v[36:39], v[116:119]
    ds_read_b64_tr_b16 v[238:239], v5 offset:18208
    s_waitcnt lgkmcnt(6)
    v_mfma_f32_16x16x32_bf16 v[120:123], v[224:227], v[32:35], v[120:123]
    v_mfma_f32_16x16x32_bf16 v[124:127], v[224:227], v[36:39], v[124:127]
    s_barrier
    ds_read_b64_tr_b16 v[240:241], v4 offset:32768
    ds_read_b64_tr_b16 v[242:243], v4 offset:33792
    s_waitcnt lgkmcnt(6)
    v_mfma_f32_16x16x32_bf16 v[128:131], v[228:231], v[32:35], v[128:131]
    s_add_u32 s22, s24, 0x300000
    s_add_u32 m0, s20, 0x10000
    s_nop 0
    buffer_load_dwordx4 v3, s[4:7], s22 offen lds
    ds_read_b64_tr_b16 v[244:245], v5 offset:32800
    v_mfma_f32_16x16x32_bf16 v[132:135], v[228:231], v[36:39], v[132:135]
    ds_read_b64_tr_b16 v[246:247], v5 offset:33824
    s_waitcnt lgkmcnt(6)
    v_mfma_f32_16x16x32_bf16 v[136:139], v[232:235], v[32:35], v[136:139]
    ds_read_b64_tr_b16 v[224:225], v4 offset:33024
    v_mfma_f32_16x16x32_bf16 v[140:143], v[232:235], v[36:39], v[140:143]
    s_add_u32 s22, s24, 0x302000
    s_add_u32 m0, s20, 0x10400
    s_nop 0
    buffer_load_dwordx4 v3, s[4:7], s22 offen lds
    ds_read_b64_tr_b16 v[226:227], v4 offset:34048
    s_waitcnt lgkmcnt(6)
    v_mfma_f32_16x16x32_bf16 v[144:147], v[236:239], v[32:35], v[144:147]
    s_add_u32 s16, s63, 0x574000
    v_mov_b32 v14, s28
    v_mov_b32 v15, 0
    s_mov_b64 exec, 1
    buffer_store_dword v14, v15, s[8:11], s16 offen sc1
    s_mov_b64 exec, -1
    ds_read_b64_tr_b16 v[228:229], v5 offset:33056
    v_mfma_f32_16x16x32_bf16 v[148:151], v[236:239], v[36:39], v[148:151]
    ds_read_b64_tr_b16 v[230:231], v5 offset:34080
    s_waitcnt vmcnt(16) lgkmcnt(6)
    v_mfma_f32_16x16x32_bf16 v[88:91], v[240:243], v[40:43], v[88:91]
    ds_read_b64_tr_b16 v[232:233], v4 offset:33280
    s_waitcnt vmcnt(15)
    v_mfma_f32_16x16x32_bf16 v[92:95], v[240:243], v[44:47], v[92:95]
    ds_read_b64_tr_b16 v[234:235], v4 offset:34304
    s_waitcnt lgkmcnt(6)
    v_mfma_f32_16x16x32_bf16 v[96:99], v[244:247], v[40:43], v[96:99]
    ds_read_b64_tr_b16 v[236:237], v5 offset:33312
    s_mov_b32 s23, 0xc000
    buffer_load_dwordx4 v[32:35], v6, s[8:11], s23 offen offset:0 sc1
    v_mfma_f32_16x16x32_bf16 v[100:103], v[244:247], v[44:47], v[100:103]
    ds_read_b64_tr_b16 v[238:239], v5 offset:34336
    s_waitcnt lgkmcnt(6)
    v_mfma_f32_16x16x32_bf16 v[104:107], v[224:227], v[40:43], v[104:107]
    ds_read_b64_tr_b16 v[240:241], v4 offset:33536
    v_mfma_f32_16x16x32_bf16 v[108:111], v[224:227], v[44:47], v[108:111]
    ds_read_b64_tr_b16 v[242:243], v4 offset:34560
    s_mov_b32 s23, 0x2c000
    buffer_load_dwordx4 v[36:39], v6, s[8:11], s23 offen offset:0 sc1
    s_waitcnt lgkmcnt(6)
    v_mfma_f32_16x16x32_bf16 v[112:115], v[228:231], v[40:43], v[112:115]
    ds_read_b64_tr_b16 v[244:245], v5 offset:33568
    v_mfma_f32_16x16x32_bf16 v[116:119], v[228:231], v[44:47], v[116:119]
    ds_read_b64_tr_b16 v[246:247], v5 offset:34592
    s_waitcnt lgkmcnt(6)
    v_mfma_f32_16x16x32_bf16 v[120:123], v[232:235], v[40:43], v[120:123]
    v_mfma_f32_16x16x32_bf16 v[124:127], v[232:235], v[44:47], v[124:127]
    s_barrier
    ds_read_b64_tr_b16 v[224:225], v4 offset:49152
    ds_read_b64_tr_b16 v[226:227], v4 offset:50176
    s_add_u32 s19, s19, 8192
    buffer_load_dword v12, v13, s[8:11], s19 offen sc1
    s_waitcnt lgkmcnt(6)
    v_mfma_f32_16x16x32_bf16 v[128:131], v[236:239], v[40:43], v[128:131]
    s_add_u32 s22, s24, 0x380000
    s_add_u32 m0, s20, 0x14000
    s_nop 0
    buffer_load_dwordx4 v3, s[4:7], s22 offen lds
    ds_read_b64_tr_b16 v[228:229], v5 offset:49184
    v_mfma_f32_16x16x32_bf16 v[132:135], v[236:239], v[44:47], v[132:135]
    ds_read_b64_tr_b16 v[230:231], v5 offset:50208
    s_waitcnt lgkmcnt(6)
    v_mfma_f32_16x16x32_bf16 v[136:139], v[240:243], v[40:43], v[136:139]
    ds_read_b64_tr_b16 v[232:233], v4 offset:49408
    v_mfma_f32_16x16x32_bf16 v[140:143], v[240:243], v[44:47], v[140:143]
    s_add_u32 s22, s24, 0x382000
    s_add_u32 m0, s20, 0x14400
    s_nop 0
    buffer_load_dwordx4 v3, s[4:7], s22 offen lds
    ds_read_b64_tr_b16 v[234:235], v4 offset:50432
    s_waitcnt lgkmcnt(6)
    v_mfma_f32_16x16x32_bf16 v[144:147], v[244:247], v[40:43], v[144:147]
    ds_read_b64_tr_b16 v[236:237], v5 offset:49440
    v_mfma_f32_16x16x32_bf16 v[148:151], v[244:247], v[44:47], v[148:151]
    ds_read_b64_tr_b16 v[238:239], v5 offset:50464
    s_waitcnt vmcnt(19) lgkmcnt(6)
    v_mfma_f32_16x16x32_bf16 v[88:91], v[224:227], v[48:51], v[88:91]
    ds_read_b64_tr_b16 v[240:241], v4 offset:49664
    s_waitcnt vmcnt(18)
    v_mfma_f32_16x16x32_bf16 v[92:95], v[224:227], v[52:55], v[92:95]
    ds_read_b64_tr_b16 v[242:243], v4 offset:50688
    s_waitcnt lgkmcnt(6)
    v_mfma_f32_16x16x32_bf16 v[96:99], v[228:231], v[48:51], v[96:99]
    ds_read_b64_tr_b16 v[244:245], v5 offset:49696
    s_mov_b32 s23, 0xe000
    buffer_load_dwordx4 v[40:43], v6, s[8:11], s23 offen offset:0 sc1
    v_mfma_f32_16x16x32_bf16 v[100:103], v[228:231], v[52:55], v[100:103]
    ds_read_b64_tr_b16 v[246:247], v5 offset:50720
    s_waitcnt lgkmcnt(6)
    v_mfma_f32_16x16x32_bf16 v[104:107], v[232:235], v[48:51], v[104:107]
    ds_read_b64_tr_b16 v[224:225], v4 offset:49920
    v_mfma_f32_16x16x32_bf16 v[108:111], v[232:235], v[52:55], v[108:111]
    ds_read_b64_tr_b16 v[226:227], v4 offset:50944
    s_mov_b32 s23, 0x2e000
    buffer_load_dwordx4 v[44:47], v6, s[8:11], s23 offen offset:0 sc1
    s_waitcnt lgkmcnt(6)
    v_mfma_f32_16x16x32_bf16 v[112:115], v[236:239], v[48:51], v[112:115]
    ds_read_b64_tr_b16 v[228:229], v5 offset:49952
    v_mfma_f32_16x16x32_bf16 v[116:119], v[236:239], v[52:55], v[116:119]
    ds_read_b64_tr_b16 v[230:231], v5 offset:50976
    s_waitcnt lgkmcnt(6)
    v_mfma_f32_16x16x32_bf16 v[120:123], v[240:243], v[48:51], v[120:123]
    v_mfma_f32_16x16x32_bf16 v[124:127], v[240:243], v[52:55], v[124:127]
    s_waitcnt vmcnt(15)
    s_barrier
    ds_read_b64_tr_b16 v[232:233], v7 offset:0
    ds_read_b64_tr_b16 v[234:235], v7 offset:1024
    s_waitcnt lgkmcnt(6)
    v_mfma_f32_16x16x32_bf16 v[128:131], v[244:247], v[48:51], v[128:131]
    s_add_u32 s22, s24, 0x10000
    s_add_u32 m0, s20, 0x18000
    s_nop 0
    buffer_load_dwordx4 v3, s[4:7], s22 offen lds
    ds_read_b64_tr_b16 v[236:237], v8 offset:32
    v_mfma_f32_16x16x32_bf16 v[132:135], v[244:247], v[52:55], v[132:135]
    ds_read_b64_tr_b16 v[238:239], v8 offset:1056
    s_waitcnt lgkmcnt(6)
    v_mfma_f32_16x16x32_bf16 v[136:139], v[224:227], v[48:51], v[136:139]
    ds_read_b64_tr_b16 v[240:241], v7 offset:256
    v_mfma_f32_16x16x32_bf16 v[140:143], v[224:227], v[52:55], v[140:143]
    s_add_u32 s22, s24, 0x12000
    s_add_u32 m0, s20, 0x18400
    s_nop 0
    buffer_load_dwordx4 v3, s[4:7], s22 offen lds
    ds_read_b64_tr_b16 v[242:243], v7 offset:1280
    s_waitcnt lgkmcnt(6)
    v_mfma_f32_16x16x32_bf16 v[144:147], v[228:231], v[48:51], v[144:147]
    ds_read_b64_tr_b16 v[244:245], v8 offset:288
    v_mfma_f32_16x16x32_bf16 v[148:151], v[228:231], v[52:55], v[148:151]
    ds_read_b64_tr_b16 v[246:247], v8 offset:1312
    s_waitcnt vmcnt(6)
    v_cmp_ne_u32 vcc, s28, v12
    s_cbranch_vccnz adaLN_cond__sliding_block_cached__moe_arch_mod__prompt_kernel_o27r
adaLN_cond__sliding_block_cached__moe_arch_mod__prompt_kernel_o27b:
    s_waitcnt lgkmcnt(6)
    v_mfma_f32_16x16x32_bf16 v[88:91], v[232:235], v[56:59], v[88:91]
    ds_read_b64_tr_b16 v[224:225], v7 offset:512
    v_mfma_f32_16x16x32_bf16 v[92:95], v[232:235], v[60:63], v[92:95]
    ds_read_b64_tr_b16 v[226:227], v7 offset:1536
    s_waitcnt lgkmcnt(6)
    v_mfma_f32_16x16x32_bf16 v[96:99], v[236:239], v[56:59], v[96:99]
    ds_read_b64_tr_b16 v[228:229], v8 offset:544
    s_mov_b32 s23, 0x0
    buffer_load_dwordx4 v[48:51], v6, s[8:11], s23 offen offset:1024 sc1
    v_mfma_f32_16x16x32_bf16 v[100:103], v[236:239], v[60:63], v[100:103]
    ds_read_b64_tr_b16 v[230:231], v8 offset:1568
    s_waitcnt lgkmcnt(6)
    v_mfma_f32_16x16x32_bf16 v[104:107], v[240:243], v[56:59], v[104:107]
    ds_read_b64_tr_b16 v[232:233], v7 offset:768
    v_mfma_f32_16x16x32_bf16 v[108:111], v[240:243], v[60:63], v[108:111]
    ds_read_b64_tr_b16 v[234:235], v7 offset:1792
    s_mov_b32 s23, 0x20000
    buffer_load_dwordx4 v[52:55], v6, s[8:11], s23 offen offset:1024 sc1
    s_waitcnt lgkmcnt(6)
    v_mfma_f32_16x16x32_bf16 v[112:115], v[244:247], v[56:59], v[112:115]
    ds_read_b64_tr_b16 v[236:237], v8 offset:800
    v_mfma_f32_16x16x32_bf16 v[116:119], v[244:247], v[60:63], v[116:119]
    ds_read_b64_tr_b16 v[238:239], v8 offset:1824
    s_waitcnt lgkmcnt(6)
    v_mfma_f32_16x16x32_bf16 v[120:123], v[224:227], v[56:59], v[120:123]
    v_mfma_f32_16x16x32_bf16 v[124:127], v[224:227], v[60:63], v[124:127]
    s_barrier
    ds_read_b64_tr_b16 v[240:241], v7 offset:16384
    ds_read_b64_tr_b16 v[242:243], v7 offset:17408
    s_waitcnt lgkmcnt(6)
    v_mfma_f32_16x16x32_bf16 v[128:131], v[228:231], v[56:59], v[128:131]
    s_add_u32 s22, s24, 0x90000
    s_add_u32 m0, s20, 0x1c000
    s_nop 0
    buffer_load_dwordx4 v3, s[4:7], s22 offen lds
    ds_read_b64_tr_b16 v[244:245], v8 offset:16416
    v_mfma_f32_16x16x32_bf16 v[132:135], v[228:231], v[60:63], v[132:135]
    ds_read_b64_tr_b16 v[246:247], v8 offset:17440
    s_waitcnt lgkmcnt(6)
    v_mfma_f32_16x16x32_bf16 v[136:139], v[232:235], v[56:59], v[136:139]
    ds_read_b64_tr_b16 v[224:225], v7 offset:16640
    v_mfma_f32_16x16x32_bf16 v[140:143], v[232:235], v[60:63], v[140:143]
    s_add_u32 s22, s24, 0x92000
    s_add_u32 m0, s20, 0x1c400
    s_nop 0
    buffer_load_dwordx4 v3, s[4:7], s22 offen lds
    ds_read_b64_tr_b16 v[226:227], v7 offset:17664
    s_waitcnt lgkmcnt(6)
    v_mfma_f32_16x16x32_bf16 v[144:147], v[236:239], v[56:59], v[144:147]
    ds_read_b64_tr_b16 v[228:229], v8 offset:16672
    v_mfma_f32_16x16x32_bf16 v[148:151], v[236:239], v[60:63], v[148:151]
    ds_read_b64_tr_b16 v[230:231], v8 offset:17696
    s_waitcnt lgkmcnt(6)
    v_mfma_f32_16x16x32_bf16 v[88:91], v[240:243], v[24:27], v[88:91]
    ds_read_b64_tr_b16 v[232:233], v7 offset:16896
    v_mfma_f32_16x16x32_bf16 v[92:95], v[240:243], v[28:31], v[92:95]
    ds_read_b64_tr_b16 v[234:235], v7 offset:17920
    s_waitcnt lgkmcnt(6)
    v_mfma_f32_16x16x32_bf16 v[96:99], v[244:247], v[24:27], v[96:99]
    ds_read_b64_tr_b16 v[236:237], v8 offset:16928
    s_mov_b32 s23, 0x2000
    buffer_load_dwordx4 v[56:59], v6, s[8:11], s23 offen offset:1024 sc1
    v_mfma_f32_16x16x32_bf16 v[100:103], v[244:247], v[28:31], v[100:103]
    ds_read_b64_tr_b16 v[238:239], v8 offset:17952
    s_waitcnt lgkmcnt(6)
    v_mfma_f32_16x16x32_bf16 v[104:107], v[224:227], v[24:27], v[104:107]
    ds_read_b64_tr_b16 v[240:241], v7 offset:17152
    v_mfma_f32_16x16x32_bf16 v[108:111], v[224:227], v[28:31], v[108:111]
    ds_read_b64_tr_b16 v[242:243], v7 offset:18176
    s_mov_b32 s23, 0x22000
    buffer_load_dwordx4 v[60:63], v6, s[8:11], s23 offen offset:1024 sc1
    s_waitcnt lgkmcnt(6)
    v_mfma_f32_16x16x32_bf16 v[112:115], v[228:231], v[24:27], v[112:115]
    ds_read_b64_tr_b16 v[244:245], v8 offset:17184
    v_mfma_f32_16x16x32_bf16 v[116:119], v[228:231], v[28:31], v[116:119]
    ds_read_b64_tr_b16 v[246:247], v8 offset:18208
    s_waitcnt lgkmcnt(6)
    v_mfma_f32_16x16x32_bf16 v[120:123], v[232:235], v[24:27], v[120:123]
    v_mfma_f32_16x16x32_bf16 v[124:127], v[232:235], v[28:31], v[124:127]
    s_barrier
    ds_read_b64_tr_b16 v[224:225], v4 offset:0
    ds_read_b64_tr_b16 v[226:227], v4 offset:1024
    s_waitcnt lgkmcnt(6)
    v_mfma_f32_16x16x32_bf16 v[128:131], v[236:239], v[24:27], v[128:131]
    s_add_u32 s16, s63, 0x576000
    v_mov_b32 v14, s28
    v_mov_b32 v15, 0
    s_mov_b64 exec, 1
    buffer_store_dword v14, v15, s[8:11], s16 offen sc1
    s_mov_b64 exec, -1
    s_add_u32 s22, s24, 0x110000
    s_add_u32 m0, s20, 0x20000
    s_nop 0
    buffer_load_dwordx4 v3, s[4:7], s22 offen lds
    ds_read_b64_tr_b16 v[228:229], v5 offset:32
    v_mfma_f32_16x16x32_bf16 v[132:135], v[236:239], v[28:31], v[132:135]
    ds_read_b64_tr_b16 v[230:231], v5 offset:1056
    s_waitcnt lgkmcnt(6)
    v_mfma_f32_16x16x32_bf16 v[136:139], v[240:243], v[24:27], v[136:139]
    ds_read_b64_tr_b16 v[232:233], v4 offset:256
    v_mfma_f32_16x16x32_bf16 v[140:143], v[240:243], v[28:31], v[140:143]
    s_add_u32 s22, s24, 0x112000
    s_add_u32 m0, s20, 0x20400
    s_nop 0
    buffer_load_dwordx4 v3, s[4:7], s22 offen lds
    ds_read_b64_tr_b16 v[234:235], v4 offset:1280
    s_waitcnt lgkmcnt(6)
    v_mfma_f32_16x16x32_bf16 v[144:147], v[244:247], v[24:27], v[144:147]
    ds_read_b64_tr_b16 v[236:237], v5 offset:288
    v_mfma_f32_16x16x32_bf16 v[148:151], v[244:247], v[28:31], v[148:151]
    ds_read_b64_tr_b16 v[238:239], v5 offset:1312
    s_waitcnt lgkmcnt(6)
    v_mfma_f32_16x16x32_bf16 v[88:91], v[224:227], v[32:35], v[88:91]
    ds_read_b64_tr_b16 v[240:241], v4 offset:512
    v_mfma_f32_16x16x32_bf16 v[92:95], v[224:227], v[36:39], v[92:95]
    ds_read_b64_tr_b16 v[242:243], v4 offset:1536
    s_waitcnt lgkmcnt(6)
    v_mfma_f32_16x16x32_bf16 v[96:99], v[228:231], v[32:35], v[96:99]
    ds_read_b64_tr_b16 v[244:245], v5 offset:544
    s_mov_b32 s23, 0x4000
    buffer_load_dwordx4 v[24:27], v6, s[8:11], s23 offen offset:1024 sc1
    v_mfma_f32_16x16x32_bf16 v[100:103], v[228:231], v[36:39], v[100:103]
    ds_read_b64_tr_b16 v[246:247], v5 offset:1568
    s_waitcnt lgkmcnt(6)
    v_mfma_f32_16x16x32_bf16 v[104:107], v[232:235], v[32:35], v[104:107]
    ds_read_b64_tr_b16 v[224:225], v4 offset:768
    v_mfma_f32_16x16x32_bf16 v[108:111], v[232:235], v[36:39], v[108:111]
    ds_read_b64_tr_b16 v[226:227], v4 offset:1792
    s_mov_b32 s23, 0x24000
    buffer_load_dwordx4 v[28:31], v6, s[8:11], s23 offen offset:1024 sc1
    s_waitcnt lgkmcnt(6)
    v_mfma_f32_16x16x32_bf16 v[112:115], v[236:239], v[32:35], v[112:115]
    ds_read_b64_tr_b16 v[228:229], v5 offset:800
    v_mfma_f32_16x16x32_bf16 v[116:119], v[236:239], v[36:39], v[116:119]
    ds_read_b64_tr_b16 v[230:231], v5 offset:1824
    s_waitcnt lgkmcnt(6)
    v_mfma_f32_16x16x32_bf16 v[120:123], v[240:243], v[32:35], v[120:123]
    v_mfma_f32_16x16x32_bf16 v[124:127], v[240:243], v[36:39], v[124:127]
    s_waitcnt vmcnt(15)
    s_barrier
    ds_read_b64_tr_b16 v[232:233], v4 offset:16384
    ds_read_b64_tr_b16 v[234:235], v4 offset:17408
    s_waitcnt lgkmcnt(6)
    v_mfma_f32_16x16x32_bf16 v[128:131], v[244:247], v[32:35], v[128:131]
    s_add_u32 s22, s24, 0x190000
    s_add_u32 m0, s20, 0x24000
    s_nop 0
    buffer_load_dwordx4 v3, s[4:7], s22 offen lds
    ds_read_b64_tr_b16 v[236:237], v5 offset:16416
    v_mfma_f32_16x16x32_bf16 v[132:135], v[244:247], v[36:39], v[132:135]
    ds_read_b64_tr_b16 v[238:239], v5 offset:17440
    s_waitcnt lgkmcnt(6)
    v_mfma_f32_16x16x32_bf16 v[136:139], v[224:227], v[32:35], v[136:139]
    ds_read_b64_tr_b16 v[240:241], v4 offset:16640
    v_mfma_f32_16x16x32_bf16 v[140:143], v[224:227], v[36:39], v[140:143]
    s_add_u32 s22, s24, 0x192000
    s_add_u32 m0, s20, 0x24400
    s_nop 0
    buffer_load_dwordx4 v3, s[4:7], s22 offen lds
    ds_read_b64_tr_b16 v[242:243], v4 offset:17664
    s_waitcnt lgkmcnt(6)
    v_mfma_f32_16x16x32_bf16 v[144:147], v[228:231], v[32:35], v[144:147]
    ds_read_b64_tr_b16 v[244:245], v5 offset:16672
    v_mfma_f32_16x16x32_bf16 v[148:151], v[228:231], v[36:39], v[148:151]
    ds_read_b64_tr_b16 v[246:247], v5 offset:17696
    s_waitcnt vmcnt(16) lgkmcnt(6)
    v_mfma_f32_16x16x32_bf16 v[88:91], v[232:235], v[40:43], v[88:91]
    ds_read_b64_tr_b16 v[224:225], v4 offset:16896
    s_waitcnt vmcnt(15)
    v_mfma_f32_16x16x32_bf16 v[92:95], v[232:235], v[44:47], v[92:95]
    ds_read_b64_tr_b16 v[226:227], v4 offset:17920
    s_waitcnt lgkmcnt(6)
    v_mfma_f32_16x16x32_bf16 v[96:99], v[236:239], v[40:43], v[96:99]
    ds_read_b64_tr_b16 v[228:229], v5 offset:16928
    s_mov_b32 s23, 0x6000
    buffer_load_dwordx4 v[32:35], v6, s[8:11], s23 offen offset:1024 sc1
    v_mfma_f32_16x16x32_bf16 v[100:103], v[236:239], v[44:47], v[100:103]
    ds_read_b64_tr_b16 v[230:231], v5 offset:17952
    s_waitcnt lgkmcnt(6)
    v_mfma_f32_16x16x32_bf16 v[104:107], v[240:243], v[40:43], v[104:107]
    ds_read_b64_tr_b16 v[232:233], v4 offset:17152
    v_mfma_f32_16x16x32_bf16 v[108:111], v[240:243], v[44:47], v[108:111]
    ds_read_b64_tr_b16 v[234:235], v4 offset:18176
    s_mov_b32 s23, 0x26000
    buffer_load_dwordx4 v[36:39], v6, s[8:11], s23 offen offset:1024 sc1
    s_waitcnt lgkmcnt(6)
    v_mfma_f32_16x16x32_bf16 v[112:115], v[244:247], v[40:43], v[112:115]
    ds_read_b64_tr_b16 v[236:237], v5 offset:17184
    v_mfma_f32_16x16x32_bf16 v[116:119], v[244:247], v[44:47], v[116:119]
    ds_read_b64_tr_b16 v[238:239], v5 offset:18208
    s_waitcnt lgkmcnt(6)
    v_mfma_f32_16x16x32_bf16 v[120:123], v[224:227], v[40:43], v[120:123]
    v_mfma_f32_16x16x32_bf16 v[124:127], v[224:227], v[44:47], v[124:127]
    s_waitcnt vmcnt(15)
    s_barrier
    ds_read_b64_tr_b16 v[240:241], v4 offset:32768
    ds_read_b64_tr_b16 v[242:243], v4 offset:33792
    s_waitcnt lgkmcnt(6)
    v_mfma_f32_16x16x32_bf16 v[128:131], v[228:231], v[40:43], v[128:131]
    s_add_u32 s22, s24, 0x210000
    s_add_u32 m0, s20, 0x10000
    s_nop 0
    buffer_load_dwordx4 v3, s[4:7], s22 offen lds
    ds_read_b64_tr_b16 v[244:245], v5 offset:32800
    v_mfma_f32_16x16x32_bf16 v[132:135], v[228:231], v[44:47], v[132:135]
    ds_read_b64_tr_b16 v[246:247], v5 offset:33824
    s_waitcnt lgkmcnt(6)
    v_mfma_f32_16x16x32_bf16 v[136:139], v[232:235], v[40:43], v[136:139]
    ds_read_b64_tr_b16 v[224:225], v4 offset:33024
    v_mfma_f32_16x16x32_bf16 v[140:143], v[232:235], v[44:47], v[140:143]
    s_add_u32 s22, s24, 0x212000
    s_add_u32 m0, s20, 0x10400
    s_nop 0
    buffer_load_dwordx4 v3, s[4:7], s22 offen lds
    ds_read_b64_tr_b16 v[226:227], v4 offset:34048
    s_waitcnt lgkmcnt(6)
    v_mfma_f32_16x16x32_bf16 v[144:147], v[236:239], v[40:43], v[144:147]
    ds_read_b64_tr_b16 v[228:229], v5 offset:33056
    v_mfma_f32_16x16x32_bf16 v[148:151], v[236:239], v[44:47], v[148:151]
    ds_read_b64_tr_b16 v[230:231], v5 offset:34080
    s_waitcnt vmcnt(16) lgkmcnt(6)
    v_mfma_f32_16x16x32_bf16 v[88:91], v[240:243], v[48:51], v[88:91]
    ds_read_b64_tr_b16 v[232:233], v4 offset:33280
    s_waitcnt vmcnt(15)
    v_mfma_f32_16x16x32_bf16 v[92:95], v[240:243], v[52:55], v[92:95]
    ds_read_b64_tr_b16 v[234:235], v4 offset:34304
    s_waitcnt lgkmcnt(6)
    v_mfma_f32_16x16x32_bf16 v[96:99], v[244:247], v[48:51], v[96:99]
    ds_read_b64_tr_b16 v[236:237], v5 offset:33312
    s_mov_b32 s23, 0x8000
    buffer_load_dwordx4 v[40:43], v6, s[8:11], s23 offen offset:1024 sc1
    v_mfma_f32_16x16x32_bf16 v[100:103], v[244:247], v[52:55], v[100:103]
    ds_read_b64_tr_b16 v[238:239], v5 offset:34336
    s_waitcnt lgkmcnt(6)
    v_mfma_f32_16x16x32_bf16 v[104:107], v[224:227], v[48:51], v[104:107]
    ds_read_b64_tr_b16 v[240:241], v4 offset:33536
    v_mfma_f32_16x16x32_bf16 v[108:111], v[224:227], v[52:55], v[108:111]
    ds_read_b64_tr_b16 v[242:243], v4 offset:34560
    s_mov_b32 s23, 0x28000
    buffer_load_dwordx4 v[44:47], v6, s[8:11], s23 offen offset:1024 sc1
    s_waitcnt lgkmcnt(6)
    v_mfma_f32_16x16x32_bf16 v[112:115], v[228:231], v[48:51], v[112:115]
    ds_read_b64_tr_b16 v[244:245], v5 offset:33568
    v_mfma_f32_16x16x32_bf16 v[116:119], v[228:231], v[52:55], v[116:119]
    ds_read_b64_tr_b16 v[246:247], v5 offset:34592
    s_waitcnt lgkmcnt(6)
    v_mfma_f32_16x16x32_bf16 v[120:123], v[232:235], v[48:51], v[120:123]
    v_mfma_f32_16x16x32_bf16 v[124:127], v[232:235], v[52:55], v[124:127]
    s_waitcnt vmcnt(15)
    s_barrier
    ds_read_b64_tr_b16 v[224:225], v4 offset:49152
    ds_read_b64_tr_b16 v[226:227], v4 offset:50176
    s_waitcnt lgkmcnt(6)
    v_mfma_f32_16x16x32_bf16 v[128:131], v[236:239], v[48:51], v[128:131]
    s_add_u32 s22, s24, 0x290000
    s_add_u32 m0, s20, 0x14000
    s_nop 0
    buffer_load_dwordx4 v3, s[4:7], s22 offen lds
    ds_read_b64_tr_b16 v[228:229], v5 offset:49184
    v_mfma_f32_16x16x32_bf16 v[132:135], v[236:239], v[52:55], v[132:135]
    ds_read_b64_tr_b16 v[230:231], v5 offset:50208
    s_waitcnt lgkmcnt(6)
    v_mfma_f32_16x16x32_bf16 v[136:139], v[240:243], v[48:51], v[136:139]
    ds_read_b64_tr_b16 v[232:233], v4 offset:49408
    v_mfma_f32_16x16x32_bf16 v[140:143], v[240:243], v[52:55], v[140:143]
    s_add_u32 s22, s24, 0x292000
    s_add_u32 m0, s20, 0x14400
    s_nop 0
    buffer_load_dwordx4 v3, s[4:7], s22 offen lds
    ds_read_b64_tr_b16 v[234:235], v4 offset:50432
    s_waitcnt lgkmcnt(6)
    v_mfma_f32_16x16x32_bf16 v[144:147], v[244:247], v[48:51], v[144:147]
    ds_read_b64_tr_b16 v[236:237], v5 offset:49440
    v_mfma_f32_16x16x32_bf16 v[148:151], v[244:247], v[52:55], v[148:151]
    ds_read_b64_tr_b16 v[238:239], v5 offset:50464
    s_waitcnt vmcnt(16) lgkmcnt(6)
    v_mfma_f32_16x16x32_bf16 v[88:91], v[224:227], v[56:59], v[88:91]
    ds_read_b64_tr_b16 v[240:241], v4 offset:49664
    s_waitcnt vmcnt(15)
    v_mfma_f32_16x16x32_bf16 v[92:95], v[224:227], v[60:63], v[92:95]
    ds_read_b64_tr_b16 v[242:243], v4 offset:50688
    s_waitcnt lgkmcnt(6)
    v_mfma_f32_16x16x32_bf16 v[96:99], v[228:231], v[56:59], v[96:99]
    ds_read_b64_tr_b16 v[244:245], v5 offset:49696
    s_mov_b32 s23, 0xa000
    buffer_load_dwordx4 v[48:51], v6, s[8:11], s23 offen offset:1024 sc1
    v_mfma_f32_16x16x32_bf16 v[100:103], v[228:231], v[60:63], v[100:103]
    ds_read_b64_tr_b16 v[246:247], v5 offset:50720
    s_waitcnt lgkmcnt(6)
    v_mfma_f32_16x16x32_bf16 v[104:107], v[232:235], v[56:59], v[104:107]
    ds_read_b64_tr_b16 v[224:225], v4 offset:49920
    v_mfma_f32_16x16x32_bf16 v[108:111], v[232:235], v[60:63], v[108:111]
    ds_read_b64_tr_b16 v[226:227], v4 offset:50944
    s_mov_b32 s23, 0x2a000
    buffer_load_dwordx4 v[52:55], v6, s[8:11], s23 offen offset:1024 sc1
    s_waitcnt lgkmcnt(6)
    v_mfma_f32_16x16x32_bf16 v[112:115], v[236:239], v[56:59], v[112:115]
    ds_read_b64_tr_b16 v[228:229], v5 offset:49952
    v_mfma_f32_16x16x32_bf16 v[116:119], v[236:239], v[60:63], v[116:119]
    ds_read_b64_tr_b16 v[230:231], v5 offset:50976
    s_waitcnt lgkmcnt(6)
    v_mfma_f32_16x16x32_bf16 v[120:123], v[240:243], v[56:59], v[120:123]
    v_mfma_f32_16x16x32_bf16 v[124:127], v[240:243], v[60:63], v[124:127]
    s_waitcnt vmcnt(14)
    s_barrier
    ds_read_b64_tr_b16 v[232:233], v7 offset:0
    ds_read_b64_tr_b16 v[234:235], v7 offset:1024
    s_waitcnt lgkmcnt(6)
    v_mfma_f32_16x16x32_bf16 v[128:131], v[244:247], v[56:59], v[128:131]
    s_add_u32 s22, s24, 0x310000
    s_add_u32 m0, s20, 0x18000
    s_nop 0
    buffer_load_dwordx4 v3, s[4:7], s22 offen lds
    ds_read_b64_tr_b16 v[236:237], v8 offset:32
    v_mfma_f32_16x16x32_bf16 v[132:135], v[244:247], v[60:63], v[132:135]
    ds_read_b64_tr_b16 v[238:239], v8 offset:1056
    s_waitcnt lgkmcnt(6)
    v_mfma_f32_16x16x32_bf16 v[136:139], v[224:227], v[56:59], v[136:139]
    ds_read_b64_tr_b16 v[240:241], v7 offset:256
    v_mfma_f32_16x16x32_bf16 v[140:143], v[224:227], v[60:63], v[140:143]
    s_add_u32 s22, s24, 0x312000
    s_add_u32 m0, s20, 0x18400
    s_nop 0
    buffer_load_dwordx4 v3, s[4:7], s22 offen lds
    ds_read_b64_tr_b16 v[242:243], v7 offset:1280
    s_waitcnt lgkmcnt(6)
    v_mfma_f32_16x16x32_bf16 v[144:147], v[228:231], v[56:59], v[144:147]
    ds_read_b64_tr_b16 v[244:245], v8 offset:288
    v_mfma_f32_16x16x32_bf16 v[148:151], v[228:231], v[60:63], v[148:151]
    ds_read_b64_tr_b16 v[246:247], v8 offset:1312
    s_waitcnt vmcnt(15) lgkmcnt(6)
    v_mfma_f32_16x16x32_bf16 v[88:91], v[232:235], v[24:27], v[88:91]
    ds_read_b64_tr_b16 v[224:225], v7 offset:512
    s_waitcnt vmcnt(14)
    v_mfma_f32_16x16x32_bf16 v[92:95], v[232:235], v[28:31], v[92:95]
    ds_read_b64_tr_b16 v[226:227], v7 offset:1536
    s_waitcnt lgkmcnt(6)
    v_mfma_f32_16x16x32_bf16 v[96:99], v[236:239], v[24:27], v[96:99]
    ds_read_b64_tr_b16 v[228:229], v8 offset:544
    s_mov_b32 s23, 0xc000
    buffer_load_dwordx4 v[56:59], v6, s[8:11], s23 offen offset:1024 sc1
    v_mfma_f32_16x16x32_bf16 v[100:103], v[236:239], v[28:31], v[100:103]
    ds_read_b64_tr_b16 v[230:231], v8 offset:1568
    s_waitcnt lgkmcnt(6)
    v_mfma_f32_16x16x32_bf16 v[104:107], v[240:243], v[24:27], v[104:107]
    ds_read_b64_tr_b16 v[232:233], v7 offset:768
    v_mfma_f32_16x16x32_bf16 v[108:111], v[240:243], v[28:31], v[108:111]
    ds_read_b64_tr_b16 v[234:235], v7 offset:1792
    s_mov_b32 s23, 0x2c000
    buffer_load_dwordx4 v[60:63], v6, s[8:11], s23 offen offset:1024 sc1
    s_waitcnt lgkmcnt(6)
    v_mfma_f32_16x16x32_bf16 v[112:115], v[244:247], v[24:27], v[112:115]
    ds_read_b64_tr_b16 v[236:237], v8 offset:800
    v_mfma_f32_16x16x32_bf16 v[116:119], v[244:247], v[28:31], v[116:119]
    ds_read_b64_tr_b16 v[238:239], v8 offset:1824
    s_waitcnt lgkmcnt(6)
    v_mfma_f32_16x16x32_bf16 v[120:123], v[224:227], v[24:27], v[120:123]
    v_mfma_f32_16x16x32_bf16 v[124:127], v[224:227], v[28:31], v[124:127]
    s_waitcnt vmcnt(14)
    s_barrier
    ds_read_b64_tr_b16 v[240:241], v7 offset:16384
    ds_read_b64_tr_b16 v[242:243], v7 offset:17408
    s_add_u32 s19, s19, 8192
    buffer_load_dword v12, v13, s[8:11], s19 offen sc1
    s_waitcnt lgkmcnt(6)
    v_mfma_f32_16x16x32_bf16 v[128:131], v[228:231], v[24:27], v[128:131]
    s_add_u32 s22, s24, 0x390000
    s_add_u32 m0, s20, 0x1c000
    s_nop 0
    buffer_load_dwordx4 v3, s[4:7], s22 offen lds
    ds_read_b64_tr_b16 v[244:245], v8 offset:16416
    v_mfma_f32_16x16x32_bf16 v[132:135], v[228:231], v[28:31], v[132:135]
    ds_read_b64_tr_b16 v[246:247], v8 offset:17440
    s_waitcnt lgkmcnt(6)
    v_mfma_f32_16x16x32_bf16 v[136:139], v[232:235], v[24:27], v[136:139]
    ds_read_b64_tr_b16 v[224:225], v7 offset:16640
    v_mfma_f32_16x16x32_bf16 v[140:143], v[232:235], v[28:31], v[140:143]
    s_add_u32 s22, s24, 0x392000
    s_add_u32 m0, s20, 0x1c400
    s_nop 0
    buffer_load_dwordx4 v3, s[4:7], s22 offen lds
    ds_read_b64_tr_b16 v[226:227], v7 offset:17664
    s_waitcnt lgkmcnt(6)
    v_mfma_f32_16x16x32_bf16 v[144:147], v[236:239], v[24:27], v[144:147]
    ds_read_b64_tr_b16 v[228:229], v8 offset:16672
    v_mfma_f32_16x16x32_bf16 v[148:151], v[236:239], v[28:31], v[148:151]
    ds_read_b64_tr_b16 v[230:231], v8 offset:17696
    s_waitcnt vmcnt(16) lgkmcnt(6)
    v_mfma_f32_16x16x32_bf16 v[88:91], v[240:243], v[32:35], v[88:91]
    ds_read_b64_tr_b16 v[232:233], v7 offset:16896
    s_waitcnt vmcnt(15)
    v_mfma_f32_16x16x32_bf16 v[92:95], v[240:243], v[36:39], v[92:95]
    ds_read_b64_tr_b16 v[234:235], v7 offset:17920
    s_waitcnt lgkmcnt(6)
    v_mfma_f32_16x16x32_bf16 v[96:99], v[244:247], v[32:35], v[96:99]
    ds_read_b64_tr_b16 v[236:237], v8 offset:16928
    s_mov_b32 s23, 0xe000
    buffer_load_dwordx4 v[24:27], v6, s[8:11], s23 offen offset:1024 sc1
    v_mfma_f32_16x16x32_bf16 v[100:103], v[244:247], v[36:39], v[100:103]
    ds_read_b64_tr_b16 v[238:239], v8 offset:17952
    s_waitcnt lgkmcnt(6)
    v_mfma_f32_16x16x32_bf16 v[104:107], v[224:227], v[32:35], v[104:107]
    ds_read_b64_tr_b16 v[240:241], v7 offset:17152
    v_mfma_f32_16x16x32_bf16 v[108:111], v[224:227], v[36:39], v[108:111]
    ds_read_b64_tr_b16 v[242:243], v7 offset:18176
    s_mov_b32 s23, 0x2e000
    buffer_load_dwordx4 v[28:31], v6, s[8:11], s23 offen offset:1024 sc1
    s_waitcnt lgkmcnt(6)
    v_mfma_f32_16x16x32_bf16 v[112:115], v[228:231], v[32:35], v[112:115]
    ds_read_b64_tr_b16 v[244:245], v8 offset:17184
    v_mfma_f32_16x16x32_bf16 v[116:119], v[228:231], v[36:39], v[116:119]
    ds_read_b64_tr_b16 v[246:247], v8 offset:18208
    s_waitcnt lgkmcnt(6)
    v_mfma_f32_16x16x32_bf16 v[120:123], v[232:235], v[32:35], v[120:123]
    v_mfma_f32_16x16x32_bf16 v[124:127], v[232:235], v[36:39], v[124:127]
    s_waitcnt vmcnt(15)
    s_barrier
    ds_read_b64_tr_b16 v[224:225], v4 offset:0
    ds_read_b64_tr_b16 v[226:227], v4 offset:1024
    s_waitcnt lgkmcnt(6)
    v_mfma_f32_16x16x32_bf16 v[128:131], v[236:239], v[32:35], v[128:131]
    s_add_u32 s22, s24, 0x20000
    s_add_u32 m0, s20, 0x20000
    s_nop 0
    buffer_load_dwordx4 v3, s[4:7], s22 offen lds
    ds_read_b64_tr_b16 v[228:229], v5 offset:32
    v_mfma_f32_16x16x32_bf16 v[132:135], v[236:239], v[36:39], v[132:135]
    ds_read_b64_tr_b16 v[230:231], v5 offset:1056
    s_waitcnt lgkmcnt(6)
    v_mfma_f32_16x16x32_bf16 v[136:139], v[240:243], v[32:35], v[136:139]
    ds_read_b64_tr_b16 v[232:233], v4 offset:256
    v_mfma_f32_16x16x32_bf16 v[140:143], v[240:243], v[36:39], v[140:143]
    s_add_u32 s22, s24, 0x22000
    s_add_u32 m0, s20, 0x20400
    s_nop 0
    buffer_load_dwordx4 v3, s[4:7], s22 offen lds
    ds_read_b64_tr_b16 v[234:235], v4 offset:1280
    s_waitcnt lgkmcnt(6)
    v_mfma_f32_16x16x32_bf16 v[144:147], v[244:247], v[32:35], v[144:147]
    ds_read_b64_tr_b16 v[236:237], v5 offset:288
    v_mfma_f32_16x16x32_bf16 v[148:151], v[244:247], v[36:39], v[148:151]
    ds_read_b64_tr_b16 v[238:239], v5 offset:1312
    s_waitcnt vmcnt(6)
    v_cmp_ne_u32 vcc, s28, v12
    s_cbranch_vccnz adaLN_cond__sliding_block_cached__moe_arch_mod__prompt_kernel_o28r
adaLN_cond__sliding_block_cached__moe_arch_mod__prompt_kernel_o28b:
    s_waitcnt lgkmcnt(6)
    v_mfma_f32_16x16x32_bf16 v[88:91], v[224:227], v[40:43], v[88:91]
    ds_read_b64_tr_b16 v[240:241], v4 offset:512
    v_mfma_f32_16x16x32_bf16 v[92:95], v[224:227], v[44:47], v[92:95]
    ds_read_b64_tr_b16 v[242:243], v4 offset:1536
    s_waitcnt lgkmcnt(6)
    v_mfma_f32_16x16x32_bf16 v[96:99], v[228:231], v[40:43], v[96:99]
    ds_read_b64_tr_b16 v[244:245], v5 offset:544
    s_mov_b32 s23, 0x0
    buffer_load_dwordx4 v[32:35], v6, s[8:11], s23 offen offset:2048 sc1
    v_mfma_f32_16x16x32_bf16 v[100:103], v[228:231], v[44:47], v[100:103]
    ds_read_b64_tr_b16 v[246:247], v5 offset:1568
    s_waitcnt lgkmcnt(6)
    v_mfma_f32_16x16x32_bf16 v[104:107], v[232:235], v[40:43], v[104:107]
    ds_read_b64_tr_b16 v[224:225], v4 offset:768
    v_mfma_f32_16x16x32_bf16 v[108:111], v[232:235], v[44:47], v[108:111]
    ds_read_b64_tr_b16 v[226:227], v4 offset:1792
    s_mov_b32 s23, 0x20000
    buffer_load_dwordx4 v[36:39], v6, s[8:11], s23 offen offset:2048 sc1
    s_waitcnt lgkmcnt(6)
    v_mfma_f32_16x16x32_bf16 v[112:115], v[236:239], v[40:43], v[112:115]
    ds_read_b64_tr_b16 v[228:229], v5 offset:800
    v_mfma_f32_16x16x32_bf16 v[116:119], v[236:239], v[44:47], v[116:119]
    ds_read_b64_tr_b16 v[230:231], v5 offset:1824
    s_waitcnt lgkmcnt(6)
    v_mfma_f32_16x16x32_bf16 v[120:123], v[240:243], v[40:43], v[120:123]
    v_mfma_f32_16x16x32_bf16 v[124:127], v[240:243], v[44:47], v[124:127]
    s_barrier
    ds_read_b64_tr_b16 v[232:233], v4 offset:16384
    ds_read_b64_tr_b16 v[234:235], v4 offset:17408
    s_waitcnt lgkmcnt(6)
    v_mfma_f32_16x16x32_bf16 v[128:131], v[244:247], v[40:43], v[128:131]
    s_add_u32 s22, s24, 0xa0000
    s_add_u32 m0, s20, 0x24000
    s_nop 0
    buffer_load_dwordx4 v3, s[4:7], s22 offen lds
    ds_read_b64_tr_b16 v[236:237], v5 offset:16416
    v_mfma_f32_16x16x32_bf16 v[132:135], v[244:247], v[44:47], v[132:135]
    ds_read_b64_tr_b16 v[238:239], v5 offset:17440
    s_waitcnt lgkmcnt(6)
    v_mfma_f32_16x16x32_bf16 v[136:139], v[224:227], v[40:43], v[136:139]
    ds_read_b64_tr_b16 v[240:241], v4 offset:16640
    v_mfma_f32_16x16x32_bf16 v[140:143], v[224:227], v[44:47], v[140:143]
    s_add_u32 s22, s24, 0xa2000
    s_add_u32 m0, s20, 0x24400
    s_nop 0
    buffer_load_dwordx4 v3, s[4:7], s22 offen lds
    ds_read_b64_tr_b16 v[242:243], v4 offset:17664
    s_waitcnt lgkmcnt(6)
    v_mfma_f32_16x16x32_bf16 v[144:147], v[228:231], v[40:43], v[144:147]
    ds_read_b64_tr_b16 v[244:245], v5 offset:16672
    v_mfma_f32_16x16x32_bf16 v[148:151], v[228:231], v[44:47], v[148:151]
    ds_read_b64_tr_b16 v[246:247], v5 offset:17696
    s_waitcnt lgkmcnt(6)
    v_mfma_f32_16x16x32_bf16 v[88:91], v[232:235], v[48:51], v[88:91]
    ds_read_b64_tr_b16 v[224:225], v4 offset:16896
    v_mfma_f32_16x16x32_bf16 v[92:95], v[232:235], v[52:55], v[92:95]
    ds_read_b64_tr_b16 v[226:227], v4 offset:17920
    s_waitcnt lgkmcnt(6)
    v_mfma_f32_16x16x32_bf16 v[96:99], v[236:239], v[48:51], v[96:99]
    ds_read_b64_tr_b16 v[228:229], v5 offset:16928
    s_mov_b32 s23, 0x2000
    buffer_load_dwordx4 v[40:43], v6, s[8:11], s23 offen offset:2048 sc1
    v_mfma_f32_16x16x32_bf16 v[100:103], v[236:239], v[52:55], v[100:103]
    ds_read_b64_tr_b16 v[230:231], v5 offset:17952
    s_waitcnt lgkmcnt(6)
    v_mfma_f32_16x16x32_bf16 v[104:107], v[240:243], v[48:51], v[104:107]
    ds_read_b64_tr_b16 v[232:233], v4 offset:17152
    v_mfma_f32_16x16x32_bf16 v[108:111], v[240:243], v[52:55], v[108:111]
    ds_read_b64_tr_b16 v[234:235], v4 offset:18176
    s_mov_b32 s23, 0x22000
    buffer_load_dwordx4 v[44:47], v6, s[8:11], s23 offen offset:2048 sc1
    s_waitcnt lgkmcnt(6)
    v_mfma_f32_16x16x32_bf16 v[112:115], v[244:247], v[48:51], v[112:115]
    ds_read_b64_tr_b16 v[236:237], v5 offset:17184
    v_mfma_f32_16x16x32_bf16 v[116:119], v[244:247], v[52:55], v[116:119]
    ds_read_b64_tr_b16 v[238:239], v5 offset:18208
    s_waitcnt lgkmcnt(6)
    v_mfma_f32_16x16x32_bf16 v[120:123], v[224:227], v[48:51], v[120:123]
    v_mfma_f32_16x16x32_bf16 v[124:127], v[224:227], v[52:55], v[124:127]
    s_barrier
    ds_read_b64_tr_b16 v[240:241], v4 offset:32768
    ds_read_b64_tr_b16 v[242:243], v4 offset:33792
    s_waitcnt lgkmcnt(6)
    v_mfma_f32_16x16x32_bf16 v[128:131], v[228:231], v[48:51], v[128:131]
    s_add_u32 s22, s24, 0x120000
    s_add_u32 m0, s20, 0x10000
    s_nop 0
    buffer_load_dwordx4 v3, s[4:7], s22 offen lds
    ds_read_b64_tr_b16 v[244:245], v5 offset:32800
    v_mfma_f32_16x16x32_bf16 v[132:135], v[228:231], v[52:55], v[132:135]
    ds_read_b64_tr_b16 v[246:247], v5 offset:33824
    s_waitcnt lgkmcnt(6)
    v_mfma_f32_16x16x32_bf16 v[136:139], v[232:235], v[48:51], v[136:139]
    ds_read_b64_tr_b16 v[224:225], v4 offset:33024
    v_mfma_f32_16x16x32_bf16 v[140:143], v[232:235], v[52:55], v[140:143]
    s_add_u32 s22, s24, 0x122000
    s_add_u32 m0, s20, 0x10400
    s_nop 0
    buffer_load_dwordx4 v3, s[4:7], s22 offen lds
    ds_read_b64_tr_b16 v[226:227], v4 offset:34048
    s_waitcnt lgkmcnt(6)
    v_mfma_f32_16x16x32_bf16 v[144:147], v[236:239], v[48:51], v[144:147]
    ds_read_b64_tr_b16 v[228:229], v5 offset:33056
    v_mfma_f32_16x16x32_bf16 v[148:151], v[236:239], v[52:55], v[148:151]
    ds_read_b64_tr_b16 v[230:231], v5 offset:34080
    s_waitcnt lgkmcnt(6)
    v_mfma_f32_16x16x32_bf16 v[88:91], v[240:243], v[56:59], v[88:91]
    ds_read_b64_tr_b16 v[232:233], v4 offset:33280
    v_mfma_f32_16x16x32_bf16 v[92:95], v[240:243], v[60:63], v[92:95]
    ds_read_b64_tr_b16 v[234:235], v4 offset:34304
    s_waitcnt lgkmcnt(6)
    v_mfma_f32_16x16x32_bf16 v[96:99], v[244:247], v[56:59], v[96:99]
    ds_read_b64_tr_b16 v[236:237], v5 offset:33312
    s_mov_b32 s23, 0x4000
    buffer_load_dwordx4 v[48:51], v6, s[8:11], s23 offen offset:2048 sc1
    v_mfma_f32_16x16x32_bf16 v[100:103], v[244:247], v[60:63], v[100:103]
    ds_read_b64_tr_b16 v[238:239], v5 offset:34336
    s_waitcnt lgkmcnt(6)
    v_mfma_f32_16x16x32_bf16 v[104:107], v[224:227], v[56:59], v[104:107]
    ds_read_b64_tr_b16 v[240:241], v4 offset:33536
    v_mfma_f32_16x16x32_bf16 v[108:111], v[224:227], v[60:63], v[108:111]
    ds_read_b64_tr_b16 v[242:243], v4 offset:34560
    s_mov_b32 s23, 0x24000
    buffer_load_dwordx4 v[52:55], v6, s[8:11], s23 offen offset:2048 sc1
    s_waitcnt lgkmcnt(6)
    v_mfma_f32_16x16x32_bf16 v[112:115], v[228:231], v[56:59], v[112:115]
    ds_read_b64_tr_b16 v[244:245], v5 offset:33568
    v_mfma_f32_16x16x32_bf16 v[116:119], v[228:231], v[60:63], v[116:119]
    ds_read_b64_tr_b16 v[246:247], v5 offset:34592
    s_waitcnt lgkmcnt(6)
    v_mfma_f32_16x16x32_bf16 v[120:123], v[232:235], v[56:59], v[120:123]
    v_mfma_f32_16x16x32_bf16 v[124:127], v[232:235], v[60:63], v[124:127]
    s_waitcnt vmcnt(14)
    s_barrier
    ds_read_b64_tr_b16 v[224:225], v4 offset:49152
    ds_read_b64_tr_b16 v[226:227], v4 offset:50176
    s_waitcnt lgkmcnt(6)
    v_mfma_f32_16x16x32_bf16 v[128:131], v[236:239], v[56:59], v[128:131]
    s_add_u32 s22, s24, 0x1a0000
    s_add_u32 m0, s20, 0x14000
    s_nop 0
    buffer_load_dwordx4 v3, s[4:7], s22 offen lds
    ds_read_b64_tr_b16 v[228:229], v5 offset:49184
    v_mfma_f32_16x16x32_bf16 v[132:135], v[236:239], v[60:63], v[132:135]
    ds_read_b64_tr_b16 v[230:231], v5 offset:50208
    s_waitcnt lgkmcnt(6)
    v_mfma_f32_16x16x32_bf16 v[136:139], v[240:243], v[56:59], v[136:139]
    ds_read_b64_tr_b16 v[232:233], v4 offset:49408
    v_mfma_f32_16x16x32_bf16 v[140:143], v[240:243], v[60:63], v[140:143]
    s_add_u32 s22, s24, 0x1a2000
    s_add_u32 m0, s20, 0x14400
    s_nop 0
    buffer_load_dwordx4 v3, s[4:7], s22 offen lds
    ds_read_b64_tr_b16 v[234:235], v4 offset:50432
    s_waitcnt lgkmcnt(6)
    v_mfma_f32_16x16x32_bf16 v[144:147], v[244:247], v[56:59], v[144:147]
    ds_read_b64_tr_b16 v[236:237], v5 offset:49440
    v_mfma_f32_16x16x32_bf16 v[148:151], v[244:247], v[60:63], v[148:151]
    ds_read_b64_tr_b16 v[238:239], v5 offset:50464
    s_waitcnt vmcnt(15) lgkmcnt(6)
    v_mfma_f32_16x16x32_bf16 v[88:91], v[224:227], v[24:27], v[88:91]
    ds_read_b64_tr_b16 v[240:241], v4 offset:49664
    s_waitcnt vmcnt(14)
    v_mfma_f32_16x16x32_bf16 v[92:95], v[224:227], v[28:31], v[92:95]
    ds_read_b64_tr_b16 v[242:243], v4 offset:50688
    s_waitcnt lgkmcnt(6)
    v_mfma_f32_16x16x32_bf16 v[96:99], v[228:231], v[24:27], v[96:99]
    ds_read_b64_tr_b16 v[244:245], v5 offset:49696
    s_mov_b32 s23, 0x6000
    buffer_load_dwordx4 v[56:59], v6, s[8:11], s23 offen offset:2048 sc1
    v_mfma_f32_16x16x32_bf16 v[100:103], v[228:231], v[28:31], v[100:103]
    ds_read_b64_tr_b16 v[246:247], v5 offset:50720
    s_waitcnt lgkmcnt(6)
    v_mfma_f32_16x16x32_bf16 v[104:107], v[232:235], v[24:27], v[104:107]
    ds_read_b64_tr_b16 v[224:225], v4 offset:49920
    v_mfma_f32_16x16x32_bf16 v[108:111], v[232:235], v[28:31], v[108:111]
    ds_read_b64_tr_b16 v[226:227], v4 offset:50944
    s_mov_b32 s23, 0x26000
    buffer_load_dwordx4 v[60:63], v6, s[8:11], s23 offen offset:2048 sc1
    s_waitcnt lgkmcnt(6)
    v_mfma_f32_16x16x32_bf16 v[112:115], v[236:239], v[24:27], v[112:115]
    ds_read_b64_tr_b16 v[228:229], v5 offset:49952
    v_mfma_f32_16x16x32_bf16 v[116:119], v[236:239], v[28:31], v[116:119]
    ds_read_b64_tr_b16 v[230:231], v5 offset:50976
    s_waitcnt lgkmcnt(6)
    v_mfma_f32_16x16x32_bf16 v[120:123], v[240:243], v[24:27], v[120:123]
    v_mfma_f32_16x16x32_bf16 v[124:127], v[240:243], v[28:31], v[124:127]
    s_waitcnt vmcnt(14)
    s_barrier
    ds_read_b64_tr_b16 v[232:233], v7 offset:0
    ds_read_b64_tr_b16 v[234:235], v7 offset:1024
    s_waitcnt lgkmcnt(6)
    v_mfma_f32_16x16x32_bf16 v[128:131], v[244:247], v[24:27], v[128:131]
    s_add_u32 s22, s24, 0x220000
    s_add_u32 m0, s20, 0x18000
    s_nop 0
    buffer_load_dwordx4 v3, s[4:7], s22 offen lds
    ds_read_b64_tr_b16 v[236:237], v8 offset:32
    v_mfma_f32_16x16x32_bf16 v[132:135], v[244:247], v[28:31], v[132:135]
    ds_read_b64_tr_b16 v[238:239], v8 offset:1056
    s_waitcnt lgkmcnt(6)
    v_mfma_f32_16x16x32_bf16 v[136:139], v[224:227], v[24:27], v[136:139]
    ds_read_b64_tr_b16 v[240:241], v7 offset:256
    v_mfma_f32_16x16x32_bf16 v[140:143], v[224:227], v[28:31], v[140:143]
    s_add_u32 s22, s24, 0x222000
    s_add_u32 m0, s20, 0x18400
    s_nop 0
    buffer_load_dwordx4 v3, s[4:7], s22 offen lds
    ds_read_b64_tr_b16 v[242:243], v7 offset:1280
    s_waitcnt lgkmcnt(6)
    v_mfma_f32_16x16x32_bf16 v[144:147], v[228:231], v[24:27], v[144:147]
    ds_read_b64_tr_b16 v[244:245], v8 offset:288
    v_mfma_f32_16x16x32_bf16 v[148:151], v[228:231], v[28:31], v[148:151]
    ds_read_b64_tr_b16 v[246:247], v8 offset:1312
    s_waitcnt vmcnt(15) lgkmcnt(6)
    v_mfma_f32_16x16x32_bf16 v[88:91], v[232:235], v[32:35], v[88:91]
    ds_read_b64_tr_b16 v[224:225], v7 offset:512
    s_waitcnt vmcnt(14)
    v_mfma_f32_16x16x32_bf16 v[92:95], v[232:235], v[36:39], v[92:95]
    ds_read_b64_tr_b16 v[226:227], v7 offset:1536
    s_waitcnt lgkmcnt(6)
    v_mfma_f32_16x16x32_bf16 v[96:99], v[236:239], v[32:35], v[96:99]
    ds_read_b64_tr_b16 v[228:229], v8 offset:544
    s_mov_b32 s23, 0x8000
    buffer_load_dwordx4 v[24:27], v6, s[8:11], s23 offen offset:2048 sc1
    v_mfma_f32_16x16x32_bf16 v[100:103], v[236:239], v[36:39], v[100:103]
    ds_read_b64_tr_b16 v[230:231], v8 offset:1568
    s_waitcnt lgkmcnt(6)
    v_mfma_f32_16x16x32_bf16 v[104:107], v[240:243], v[32:35], v[104:107]
    ds_read_b64_tr_b16 v[232:233], v7 offset:768
    v_mfma_f32_16x16x32_bf16 v[108:111], v[240:243], v[36:39], v[108:111]
    ds_read_b64_tr_b16 v[234:235], v7 offset:1792
    s_mov_b32 s23, 0x28000
    buffer_load_dwordx4 v[28:31], v6, s[8:11], s23 offen offset:2048 sc1
    s_mov_b32 s16, 0x544000
    buffer_load_dwordx4 v[184:187], v2, s[8:11], s16 offen sc1
    s_waitcnt lgkmcnt(6)
    v_mfma_f32_16x16x32_bf16 v[112:115], v[244:247], v[32:35], v[112:115]
    ds_read_b64_tr_b16 v[236:237], v8 offset:800
    v_mfma_f32_16x16x32_bf16 v[116:119], v[244:247], v[36:39], v[116:119]
    ds_read_b64_tr_b16 v[238:239], v8 offset:1824
    s_waitcnt lgkmcnt(6)
    v_mfma_f32_16x16x32_bf16 v[120:123], v[224:227], v[32:35], v[120:123]
    v_mfma_f32_16x16x32_bf16 v[124:127], v[224:227], v[36:39], v[124:127]
    s_waitcnt vmcnt(15)
    s_barrier
    ds_read_b64_tr_b16 v[240:241], v7 offset:16384
    ds_read_b64_tr_b16 v[242:243], v7 offset:17408
    s_waitcnt lgkmcnt(6)
    v_mfma_f32_16x16x32_bf16 v[128:131], v[228:231], v[32:35], v[128:131]
    s_add_u32 s22, s24, 0x2a0000
    s_add_u32 m0, s20, 0x1c000
    s_nop 0
    buffer_load_dwordx4 v3, s[4:7], s22 offen lds
    ds_read_b64_tr_b16 v[244:245], v8 offset:16416
    v_mfma_f32_16x16x32_bf16 v[132:135], v[228:231], v[36:39], v[132:135]
    ds_read_b64_tr_b16 v[246:247], v8 offset:17440
    s_waitcnt lgkmcnt(6)
    v_mfma_f32_16x16x32_bf16 v[136:139], v[232:235], v[32:35], v[136:139]
    ds_read_b64_tr_b16 v[224:225], v7 offset:16640
    v_mfma_f32_16x16x32_bf16 v[140:143], v[232:235], v[36:39], v[140:143]
    s_add_u32 s22, s24, 0x2a2000
    s_add_u32 m0, s20, 0x1c400
    s_nop 0
    buffer_load_dwordx4 v3, s[4:7], s22 offen lds
    ds_read_b64_tr_b16 v[226:227], v7 offset:17664
    s_waitcnt lgkmcnt(6)
    v_mfma_f32_16x16x32_bf16 v[144:147], v[236:239], v[32:35], v[144:147]
    ds_read_b64_tr_b16 v[228:229], v8 offset:16672
    v_mfma_f32_16x16x32_bf16 v[148:151], v[236:239], v[36:39], v[148:151]
    ds_read_b64_tr_b16 v[230:231], v8 offset:17696
    s_waitcnt vmcnt(16) lgkmcnt(6)
    v_mfma_f32_16x16x32_bf16 v[88:91], v[240:243], v[40:43], v[88:91]
    ds_read_b64_tr_b16 v[232:233], v7 offset:16896
    s_waitcnt vmcnt(15)
    v_mfma_f32_16x16x32_bf16 v[92:95], v[240:243], v[44:47], v[92:95]
    ds_read_b64_tr_b16 v[234:235], v7 offset:17920
    s_waitcnt lgkmcnt(6)
    v_mfma_f32_16x16x32_bf16 v[96:99], v[244:247], v[40:43], v[96:99]
    ds_read_b64_tr_b16 v[236:237], v8 offset:16928
    s_mov_b32 s23, 0xa000
    buffer_load_dwordx4 v[32:35], v6, s[8:11], s23 offen offset:2048 sc1
    v_mfma_f32_16x16x32_bf16 v[100:103], v[244:247], v[44:47], v[100:103]
    ds_read_b64_tr_b16 v[238:239], v8 offset:17952
    s_waitcnt lgkmcnt(6)
    v_mfma_f32_16x16x32_bf16 v[104:107], v[224:227], v[40:43], v[104:107]
    ds_read_b64_tr_b16 v[240:241], v7 offset:17152
    v_mfma_f32_16x16x32_bf16 v[108:111], v[224:227], v[44:47], v[108:111]
    ds_read_b64_tr_b16 v[242:243], v7 offset:18176
    s_mov_b32 s23, 0x2a000
    buffer_load_dwordx4 v[36:39], v6, s[8:11], s23 offen offset:2048 sc1
    s_waitcnt lgkmcnt(6)
    v_mfma_f32_16x16x32_bf16 v[112:115], v[228:231], v[40:43], v[112:115]
    ds_read_b64_tr_b16 v[244:245], v8 offset:17184
    v_mfma_f32_16x16x32_bf16 v[116:119], v[228:231], v[44:47], v[116:119]
    ds_read_b64_tr_b16 v[246:247], v8 offset:18208
    s_waitcnt lgkmcnt(6)
    v_mfma_f32_16x16x32_bf16 v[120:123], v[232:235], v[40:43], v[120:123]
    v_mfma_f32_16x16x32_bf16 v[124:127], v[232:235], v[44:47], v[124:127]
    s_waitcnt vmcnt(15)
    s_barrier
    ds_read_b64_tr_b16 v[224:225], v4 offset:0
    ds_read_b64_tr_b16 v[226:227], v4 offset:1024
    s_waitcnt lgkmcnt(6)
    v_mfma_f32_16x16x32_bf16 v[128:131], v[236:239], v[40:43], v[128:131]
    s_add_u32 s22, s24, 0x320000
    s_add_u32 m0, s20, 0x20000
    s_nop 0
    buffer_load_dwordx4 v3, s[4:7], s22 offen lds
    ds_read_b64_tr_b16 v[228:229], v5 offset:32
    v_mfma_f32_16x16x32_bf16 v[132:135], v[236:239], v[44:47], v[132:135]
    ds_read_b64_tr_b16 v[230:231], v5 offset:1056
    s_waitcnt lgkmcnt(6)
    v_mfma_f32_16x16x32_bf16 v[136:139], v[240:243], v[40:43], v[136:139]
    ds_read_b64_tr_b16 v[232:233], v4 offset:256
    v_mfma_f32_16x16x32_bf16 v[140:143], v[240:243], v[44:47], v[140:143]
    s_add_u32 s22, s24, 0x322000
    s_add_u32 m0, s20, 0x20400
    s_nop 0
    buffer_load_dwordx4 v3, s[4:7], s22 offen lds
    ds_read_b64_tr_b16 v[234:235], v4 offset:1280
    s_waitcnt lgkmcnt(6)
    v_mfma_f32_16x16x32_bf16 v[144:147], v[244:247], v[40:43], v[144:147]
    ds_read_b64_tr_b16 v[236:237], v5 offset:288
    v_mfma_f32_16x16x32_bf16 v[148:151], v[244:247], v[44:47], v[148:151]
    ds_read_b64_tr_b16 v[238:239], v5 offset:1312
    s_waitcnt vmcnt(16) lgkmcnt(6)
    v_mfma_f32_16x16x32_bf16 v[88:91], v[224:227], v[48:51], v[88:91]
    ds_read_b64_tr_b16 v[240:241], v4 offset:512
    s_waitcnt vmcnt(15)
    v_mfma_f32_16x16x32_bf16 v[92:95], v[224:227], v[52:55], v[92:95]
    ds_read_b64_tr_b16 v[242:243], v4 offset:1536
    s_waitcnt lgkmcnt(6)
    v_mfma_f32_16x16x32_bf16 v[96:99], v[228:231], v[48:51], v[96:99]
    ds_read_b64_tr_b16 v[244:245], v5 offset:544
    s_mov_b32 s23, 0xc000
    buffer_load_dwordx4 v[40:43], v6, s[8:11], s23 offen offset:2048 sc1
    v_mfma_f32_16x16x32_bf16 v[100:103], v[228:231], v[52:55], v[100:103]
    ds_read_b64_tr_b16 v[246:247], v5 offset:1568
    s_waitcnt lgkmcnt(6)
    v_mfma_f32_16x16x32_bf16 v[104:107], v[232:235], v[48:51], v[104:107]
    ds_read_b64_tr_b16 v[224:225], v4 offset:768
    v_mfma_f32_16x16x32_bf16 v[108:111], v[232:235], v[52:55], v[108:111]
    ds_read_b64_tr_b16 v[226:227], v4 offset:1792
    s_mov_b32 s23, 0x2c000
    buffer_load_dwordx4 v[44:47], v6, s[8:11], s23 offen offset:2048 sc1
    s_waitcnt lgkmcnt(6)
    v_mfma_f32_16x16x32_bf16 v[112:115], v[236:239], v[48:51], v[112:115]
    ds_read_b64_tr_b16 v[228:229], v5 offset:800
    v_mfma_f32_16x16x32_bf16 v[116:119], v[236:239], v[52:55], v[116:119]
    ds_read_b64_tr_b16 v[230:231], v5 offset:1824
    s_waitcnt lgkmcnt(6)
    v_mfma_f32_16x16x32_bf16 v[120:123], v[240:243], v[48:51], v[120:123]
    v_mfma_f32_16x16x32_bf16 v[124:127], v[240:243], v[52:55], v[124:127]
    s_waitcnt vmcnt(15)
    s_barrier
    ds_read_b64_tr_b16 v[232:233], v4 offset:16384
    ds_read_b64_tr_b16 v[234:235], v4 offset:17408
    s_add_u32 s19, s19, 8192
    buffer_load_dword v12, v13, s[8:11], s19 offen sc1
    s_waitcnt lgkmcnt(6)
    v_mfma_f32_16x16x32_bf16 v[128:131], v[244:247], v[48:51], v[128:131]
    s_add_u32 s22, s24, 0x3a0000
    s_add_u32 m0, s20, 0x24000
    s_nop 0
    buffer_load_dwordx4 v3, s[4:7], s22 offen lds
    ds_read_b64_tr_b16 v[236:237], v5 offset:16416
    v_mfma_f32_16x16x32_bf16 v[132:135], v[244:247], v[52:55], v[132:135]
    ds_read_b64_tr_b16 v[238:239], v5 offset:17440
    s_waitcnt lgkmcnt(6)
    v_mfma_f32_16x16x32_bf16 v[136:139], v[224:227], v[48:51], v[136:139]
    ds_read_b64_tr_b16 v[240:241], v4 offset:16640
    v_mfma_f32_16x16x32_bf16 v[140:143], v[224:227], v[52:55], v[140:143]
    s_add_u32 s22, s24, 0x3a2000
    s_add_u32 m0, s20, 0x24400
    s_nop 0
    buffer_load_dwordx4 v3, s[4:7], s22 offen lds
    ds_read_b64_tr_b16 v[242:243], v4 offset:17664
    s_waitcnt lgkmcnt(6)
    v_mfma_f32_16x16x32_bf16 v[144:147], v[228:231], v[48:51], v[144:147]
    ds_read_b64_tr_b16 v[244:245], v5 offset:16672
    v_mfma_f32_16x16x32_bf16 v[148:151], v[228:231], v[52:55], v[148:151]
    ds_read_b64_tr_b16 v[246:247], v5 offset:17696
    s_waitcnt vmcnt(17) lgkmcnt(6)
    v_mfma_f32_16x16x32_bf16 v[88:91], v[232:235], v[56:59], v[88:91]
    ds_read_b64_tr_b16 v[224:225], v4 offset:16896
    s_waitcnt vmcnt(16)
    v_mfma_f32_16x16x32_bf16 v[92:95], v[232:235], v[60:63], v[92:95]
    ds_read_b64_tr_b16 v[226:227], v4 offset:17920
    s_waitcnt lgkmcnt(6)
    v_mfma_f32_16x16x32_bf16 v[96:99], v[236:239], v[56:59], v[96:99]
    ds_read_b64_tr_b16 v[228:229], v5 offset:16928
    s_mov_b32 s23, 0xe000
    buffer_load_dwordx4 v[48:51], v6, s[8:11], s23 offen offset:2048 sc1
    v_mfma_f32_16x16x32_bf16 v[100:103], v[236:239], v[60:63], v[100:103]
    ds_read_b64_tr_b16 v[230:231], v5 offset:17952
    s_waitcnt lgkmcnt(6)
    v_mfma_f32_16x16x32_bf16 v[104:107], v[240:243], v[56:59], v[104:107]
    ds_read_b64_tr_b16 v[232:233], v4 offset:17152
    v_mfma_f32_16x16x32_bf16 v[108:111], v[240:243], v[60:63], v[108:111]
    ds_read_b64_tr_b16 v[234:235], v4 offset:18176
    s_mov_b32 s23, 0x2e000
    buffer_load_dwordx4 v[52:55], v6, s[8:11], s23 offen offset:2048 sc1
    s_waitcnt lgkmcnt(6)
    v_mfma_f32_16x16x32_bf16 v[112:115], v[244:247], v[56:59], v[112:115]
    ds_read_b64_tr_b16 v[236:237], v5 offset:17184
    v_mfma_f32_16x16x32_bf16 v[116:119], v[244:247], v[60:63], v[116:119]
    ds_read_b64_tr_b16 v[238:239], v5 offset:18208
    s_waitcnt lgkmcnt(6)
    v_mfma_f32_16x16x32_bf16 v[120:123], v[224:227], v[56:59], v[120:123]
    v_mfma_f32_16x16x32_bf16 v[124:127], v[224:227], v[60:63], v[124:127]
    s_waitcnt vmcnt(16)
    s_barrier
    ds_read_b64_tr_b16 v[240:241], v4 offset:32768
    ds_read_b64_tr_b16 v[242:243], v4 offset:33792
    s_waitcnt lgkmcnt(6)
    v_mfma_f32_16x16x32_bf16 v[128:131], v[228:231], v[56:59], v[128:131]
    s_add_u32 s22, s24, 0x30000
    s_add_u32 m0, s20, 0x10000
    s_nop 0
    buffer_load_dwordx4 v3, s[4:7], s22 offen lds
    ds_read_b64_tr_b16 v[244:245], v5 offset:32800
    v_mfma_f32_16x16x32_bf16 v[132:135], v[228:231], v[60:63], v[132:135]
    ds_read_b64_tr_b16 v[246:247], v5 offset:33824
    s_waitcnt lgkmcnt(6)
    v_mfma_f32_16x16x32_bf16 v[136:139], v[232:235], v[56:59], v[136:139]
    ds_read_b64_tr_b16 v[224:225], v4 offset:33024
    v_mfma_f32_16x16x32_bf16 v[140:143], v[232:235], v[60:63], v[140:143]
    s_add_u32 s22, s24, 0x32000
    s_add_u32 m0, s20, 0x10400
    s_nop 0
    buffer_load_dwordx4 v3, s[4:7], s22 offen lds
    ds_read_b64_tr_b16 v[226:227], v4 offset:34048
    s_waitcnt lgkmcnt(6)
    v_mfma_f32_16x16x32_bf16 v[144:147], v[236:239], v[56:59], v[144:147]
    ds_read_b64_tr_b16 v[228:229], v5 offset:33056
    v_mfma_f32_16x16x32_bf16 v[148:151], v[236:239], v[60:63], v[148:151]
    ds_read_b64_tr_b16 v[230:231], v5 offset:34080
    s_waitcnt vmcnt(6)
    v_cmp_ne_u32 vcc, s28, v12
    s_cbranch_vccnz adaLN_cond__sliding_block_cached__moe_arch_mod__prompt_kernel_o29r
adaLN_cond__sliding_block_cached__moe_arch_mod__prompt_kernel_o29b:
    s_waitcnt lgkmcnt(6)
    v_mfma_f32_16x16x32_bf16 v[88:91], v[240:243], v[24:27], v[88:91]
    ds_read_b64_tr_b16 v[232:233], v4 offset:33280
    v_mfma_f32_16x16x32_bf16 v[92:95], v[240:243], v[28:31], v[92:95]
    ds_read_b64_tr_b16 v[234:235], v4 offset:34304
    s_waitcnt lgkmcnt(6)
    v_mfma_f32_16x16x32_bf16 v[96:99], v[244:247], v[24:27], v[96:99]
    ds_read_b64_tr_b16 v[236:237], v5 offset:33312
    s_mov_b32 s23, 0x0
    buffer_load_dwordx4 v[56:59], v6, s[8:11], s23 offen offset:3072 sc1
    v_mfma_f32_16x16x32_bf16 v[100:103], v[244:247], v[28:31], v[100:103]
    ds_read_b64_tr_b16 v[238:239], v5 offset:34336
    s_waitcnt lgkmcnt(6)
    v_mfma_f32_16x16x32_bf16 v[104:107], v[224:227], v[24:27], v[104:107]
    ds_read_b64_tr_b16 v[240:241], v4 offset:33536
    v_mfma_f32_16x16x32_bf16 v[108:111], v[224:227], v[28:31], v[108:111]
    ds_read_b64_tr_b16 v[242:243], v4 offset:34560
    s_mov_b32 s23, 0x20000
    buffer_load_dwordx4 v[60:63], v6, s[8:11], s23 offen offset:3072 sc1
    v_xor_b32 v16, s28, v184
    v_xor_b32 v17, s28, v185
    v_xor_b32 v18, s28, v186
    v_xor_b32 v19, s28, v187
    v_or3_b32 v16, v16, v17, v18
    v_or_b32 v16, v16, v19
    v_cmp_ne_u32 vcc, 0, v16
    s_cbranch_vccnz adaLN_cond__sliding_block_cached__moe_arch_mod__prompt_kernel_mf10r
adaLN_cond__sliding_block_cached__moe_arch_mod__prompt_kernel_mf10b:
    s_waitcnt lgkmcnt(6)
    v_mfma_f32_16x16x32_bf16 v[112:115], v[228:231], v[24:27], v[112:115]
    ds_read_b64_tr_b16 v[244:245], v5 offset:33568
    v_mfma_f32_16x16x32_bf16 v[116:119], v[228:231], v[28:31], v[116:119]
    ds_read_b64_tr_b16 v[246:247], v5 offset:34592
    s_waitcnt lgkmcnt(6)
    v_mfma_f32_16x16x32_bf16 v[120:123], v[232:235], v[24:27], v[120:123]
    v_mfma_f32_16x16x32_bf16 v[124:127], v[232:235], v[28:31], v[124:127]
    s_barrier
    ds_read_b64_tr_b16 v[224:225], v4 offset:49152
    ds_read_b64_tr_b16 v[226:227], v4 offset:50176
    s_waitcnt lgkmcnt(6)
    v_mfma_f32_16x16x32_bf16 v[128:131], v[236:239], v[24:27], v[128:131]
    s_add_u32 s22, s24, 0xb0000
    s_add_u32 m0, s20, 0x14000
    s_nop 0
    buffer_load_dwordx4 v3, s[4:7], s22 offen lds
    ds_read_b64_tr_b16 v[228:229], v5 offset:49184
    v_mfma_f32_16x16x32_bf16 v[132:135], v[236:239], v[28:31], v[132:135]
    ds_read_b64_tr_b16 v[230:231], v5 offset:50208
    s_waitcnt lgkmcnt(6)
    v_mfma_f32_16x16x32_bf16 v[136:139], v[240:243], v[24:27], v[136:139]
    ds_read_b64_tr_b16 v[232:233], v4 offset:49408
    v_mfma_f32_16x16x32_bf16 v[140:143], v[240:243], v[28:31], v[140:143]
    s_add_u32 s22, s24, 0xb2000
    s_add_u32 m0, s20, 0x14400
    s_nop 0
    buffer_load_dwordx4 v3, s[4:7], s22 offen lds
    ds_read_b64_tr_b16 v[234:235], v4 offset:50432
    s_waitcnt lgkmcnt(6)
    v_mfma_f32_16x16x32_bf16 v[144:147], v[244:247], v[24:27], v[144:147]
    ds_read_b64_tr_b16 v[236:237], v5 offset:49440
    v_mfma_f32_16x16x32_bf16 v[148:151], v[244:247], v[28:31], v[148:151]
    ds_read_b64_tr_b16 v[238:239], v5 offset:50464
    s_waitcnt lgkmcnt(6)
    v_mfma_f32_16x16x32_bf16 v[88:91], v[224:227], v[32:35], v[88:91]
    ds_read_b64_tr_b16 v[240:241], v4 offset:49664
    v_mfma_f32_16x16x32_bf16 v[92:95], v[224:227], v[36:39], v[92:95]
    ds_read_b64_tr_b16 v[242:243], v4 offset:50688
    s_waitcnt lgkmcnt(6)
    v_mfma_f32_16x16x32_bf16 v[96:99], v[228:231], v[32:35], v[96:99]
    ds_read_b64_tr_b16 v[244:245], v5 offset:49696
    s_mov_b32 s23, 0x2000
    buffer_load_dwordx4 v[24:27], v6, s[8:11], s23 offen offset:3072 sc1
    v_mfma_f32_16x16x32_bf16 v[100:103], v[228:231], v[36:39], v[100:103]
    ds_read_b64_tr_b16 v[246:247], v5 offset:50720
    s_waitcnt lgkmcnt(6)
    v_mfma_f32_16x16x32_bf16 v[104:107], v[232:235], v[32:35], v[104:107]
    ds_read_b64_tr_b16 v[224:225], v4 offset:49920
    v_mfma_f32_16x16x32_bf16 v[108:111], v[232:235], v[36:39], v[108:111]
    ds_read_b64_tr_b16 v[226:227], v4 offset:50944
    s_mov_b32 s23, 0x22000
    buffer_load_dwordx4 v[28:31], v6, s[8:11], s23 offen offset:3072 sc1
    s_waitcnt lgkmcnt(6)
    v_mfma_f32_16x16x32_bf16 v[112:115], v[236:239], v[32:35], v[112:115]
    ds_read_b64_tr_b16 v[228:229], v5 offset:49952
    v_mfma_f32_16x16x32_bf16 v[116:119], v[236:239], v[36:39], v[116:119]
    ds_read_b64_tr_b16 v[230:231], v5 offset:50976
    s_waitcnt lgkmcnt(6)
    v_mfma_f32_16x16x32_bf16 v[120:123], v[240:243], v[32:35], v[120:123]
    v_mfma_f32_16x16x32_bf16 v[124:127], v[240:243], v[36:39], v[124:127]
    s_barrier
    ds_read_b64_tr_b16 v[232:233], v7 offset:0
    ds_read_b64_tr_b16 v[234:235], v7 offset:1024
    s_waitcnt lgkmcnt(6)
    v_mfma_f32_16x16x32_bf16 v[128:131], v[244:247], v[32:35], v[128:131]
    s_add_u32 s22, s24, 0x130000
    s_add_u32 m0, s20, 0x18000
    s_nop 0
    buffer_load_dwordx4 v3, s[4:7], s22 offen lds
    ds_read_b64_tr_b16 v[236:237], v8 offset:32
    v_mfma_f32_16x16x32_bf16 v[132:135], v[244:247], v[36:39], v[132:135]
    ds_read_b64_tr_b16 v[238:239], v8 offset:1056
    s_waitcnt lgkmcnt(6)
    v_mfma_f32_16x16x32_bf16 v[136:139], v[224:227], v[32:35], v[136:139]
    ds_read_b64_tr_b16 v[240:241], v7 offset:256
    v_mfma_f32_16x16x32_bf16 v[140:143], v[224:227], v[36:39], v[140:143]
    s_add_u32 s22, s24, 0x132000
    s_add_u32 m0, s20, 0x18400
    s_nop 0
    buffer_load_dwordx4 v3, s[4:7], s22 offen lds
    ds_read_b64_tr_b16 v[242:243], v7 offset:1280
    s_waitcnt lgkmcnt(6)
    v_mfma_f32_16x16x32_bf16 v[144:147], v[228:231], v[32:35], v[144:147]
    ds_read_b64_tr_b16 v[244:245], v8 offset:288
    v_mfma_f32_16x16x32_bf16 v[148:151], v[228:231], v[36:39], v[148:151]
    ds_read_b64_tr_b16 v[246:247], v8 offset:1312
    s_waitcnt lgkmcnt(6)
    v_mfma_f32_16x16x32_bf16 v[88:91], v[232:235], v[40:43], v[88:91]
    ds_read_b64_tr_b16 v[224:225], v7 offset:512
    v_mfma_f32_16x16x32_bf16 v[92:95], v[232:235], v[44:47], v[92:95]
    ds_read_b64_tr_b16 v[226:227], v7 offset:1536
    s_waitcnt lgkmcnt(6)
    v_mfma_f32_16x16x32_bf16 v[96:99], v[236:239], v[40:43], v[96:99]
    ds_read_b64_tr_b16 v[228:229], v8 offset:544
    s_mov_b32 s23, 0x4000
    buffer_load_dwordx4 v[32:35], v6, s[8:11], s23 offen offset:3072 sc1
    v_mfma_f32_16x16x32_bf16 v[100:103], v[236:239], v[44:47], v[100:103]
    ds_read_b64_tr_b16 v[230:231], v8 offset:1568
    s_waitcnt lgkmcnt(6)
    v_mfma_f32_16x16x32_bf16 v[104:107], v[240:243], v[40:43], v[104:107]
    ds_read_b64_tr_b16 v[232:233], v7 offset:768
    v_mfma_f32_16x16x32_bf16 v[108:111], v[240:243], v[44:47], v[108:111]
    ds_read_b64_tr_b16 v[234:235], v7 offset:1792
    s_mov_b32 s23, 0x24000
    buffer_load_dwordx4 v[36:39], v6, s[8:11], s23 offen offset:3072 sc1
    s_waitcnt lgkmcnt(6)
    v_mfma_f32_16x16x32_bf16 v[112:115], v[244:247], v[40:43], v[112:115]
    ds_read_b64_tr_b16 v[236:237], v8 offset:800
    v_mfma_f32_16x16x32_bf16 v[116:119], v[244:247], v[44:47], v[116:119]
    ds_read_b64_tr_b16 v[238:239], v8 offset:1824
    s_waitcnt lgkmcnt(6)
    v_mfma_f32_16x16x32_bf16 v[120:123], v[224:227], v[40:43], v[120:123]
    v_mfma_f32_16x16x32_bf16 v[124:127], v[224:227], v[44:47], v[124:127]
    s_waitcnt vmcnt(14)
    s_barrier
    ds_read_b64_tr_b16 v[240:241], v7 offset:16384
    ds_read_b64_tr_b16 v[242:243], v7 offset:17408
    s_waitcnt lgkmcnt(6)
    v_mfma_f32_16x16x32_bf16 v[128:131], v[228:231], v[40:43], v[128:131]
    s_add_u32 s22, s24, 0x1b0000
    s_add_u32 m0, s20, 0x1c000
    s_nop 0
    buffer_load_dwordx4 v3, s[4:7], s22 offen lds
    ds_read_b64_tr_b16 v[244:245], v8 offset:16416
    v_mfma_f32_16x16x32_bf16 v[132:135], v[228:231], v[44:47], v[132:135]
    ds_read_b64_tr_b16 v[246:247], v8 offset:17440
    s_waitcnt lgkmcnt(6)
    v_mfma_f32_16x16x32_bf16 v[136:139], v[232:235], v[40:43], v[136:139]
    ds_read_b64_tr_b16 v[224:225], v7 offset:16640
    v_mfma_f32_16x16x32_bf16 v[140:143], v[232:235], v[44:47], v[140:143]
    s_add_u32 s22, s24, 0x1b2000
    s_add_u32 m0, s20, 0x1c400
    s_nop 0
    buffer_load_dwordx4 v3, s[4:7], s22 offen lds
    ds_read_b64_tr_b16 v[226:227], v7 offset:17664
    s_waitcnt lgkmcnt(6)
    v_mfma_f32_16x16x32_bf16 v[144:147], v[236:239], v[40:43], v[144:147]
    ds_read_b64_tr_b16 v[228:229], v8 offset:16672
    v_mfma_f32_16x16x32_bf16 v[148:151], v[236:239], v[44:47], v[148:151]
    ds_read_b64_tr_b16 v[230:231], v8 offset:17696
    s_waitcnt vmcnt(15) lgkmcnt(6)
    v_mfma_f32_16x16x32_bf16 v[88:91], v[240:243], v[48:51], v[88:91]
    ds_read_b64_tr_b16 v[232:233], v7 offset:16896
    s_waitcnt vmcnt(14)
    v_mfma_f32_16x16x32_bf16 v[92:95], v[240:243], v[52:55], v[92:95]
    ds_read_b64_tr_b16 v[234:235], v7 offset:17920
    s_waitcnt lgkmcnt(6)
    v_mfma_f32_16x16x32_bf16 v[96:99], v[244:247], v[48:51], v[96:99]
    ds_read_b64_tr_b16 v[236:237], v8 offset:16928
    s_mov_b32 s23, 0x6000
    buffer_load_dwordx4 v[40:43], v6, s[8:11], s23 offen offset:3072 sc1
    v_mfma_f32_16x16x32_bf16 v[100:103], v[244:247], v[52:55], v[100:103]
    ds_read_b64_tr_b16 v[238:239], v8 offset:17952
    s_waitcnt lgkmcnt(6)
    v_mfma_f32_16x16x32_bf16 v[104:107], v[224:227], v[48:51], v[104:107]
    ds_read_b64_tr_b16 v[240:241], v7 offset:17152
    v_mfma_f32_16x16x32_bf16 v[108:111], v[224:227], v[52:55], v[108:111]
    ds_read_b64_tr_b16 v[242:243], v7 offset:18176
    s_mov_b32 s23, 0x26000
    buffer_load_dwordx4 v[44:47], v6, s[8:11], s23 offen offset:3072 sc1
    s_waitcnt lgkmcnt(6)
    v_mfma_f32_16x16x32_bf16 v[112:115], v[228:231], v[48:51], v[112:115]
    ds_read_b64_tr_b16 v[244:245], v8 offset:17184
    v_mfma_f32_16x16x32_bf16 v[116:119], v[228:231], v[52:55], v[116:119]
    ds_read_b64_tr_b16 v[246:247], v8 offset:18208
    s_waitcnt lgkmcnt(6)
    v_mfma_f32_16x16x32_bf16 v[120:123], v[232:235], v[48:51], v[120:123]
    v_mfma_f32_16x16x32_bf16 v[124:127], v[232:235], v[52:55], v[124:127]
    s_waitcnt vmcnt(14)
    s_barrier
    ds_read_b64_tr_b16 v[224:225], v4 offset:0
    ds_read_b64_tr_b16 v[226:227], v4 offset:1024
    s_waitcnt lgkmcnt(6)
    v_mfma_f32_16x16x32_bf16 v[128:131], v[236:239], v[48:51], v[128:131]
    s_add_u32 s22, s24, 0x230000
    s_add_u32 m0, s20, 0x20000
    s_nop 0
    buffer_load_dwordx4 v3, s[4:7], s22 offen lds
    ds_read_b64_tr_b16 v[228:229], v5 offset:32
    v_mfma_f32_16x16x32_bf16 v[132:135], v[236:239], v[52:55], v[132:135]
    ds_read_b64_tr_b16 v[230:231], v5 offset:1056
    s_waitcnt lgkmcnt(6)
    v_mfma_f32_16x16x32_bf16 v[136:139], v[240:243], v[48:51], v[136:139]
    ds_read_b64_tr_b16 v[232:233], v4 offset:256
    v_mfma_f32_16x16x32_bf16 v[140:143], v[240:243], v[52:55], v[140:143]
    s_add_u32 s22, s24, 0x232000
    s_add_u32 m0, s20, 0x20400
    s_nop 0
    buffer_load_dwordx4 v3, s[4:7], s22 offen lds
    ds_read_b64_tr_b16 v[234:235], v4 offset:1280
    s_waitcnt lgkmcnt(6)
    v_mfma_f32_16x16x32_bf16 v[144:147], v[244:247], v[48:51], v[144:147]
    ds_read_b64_tr_b16 v[236:237], v5 offset:288
    v_mfma_f32_16x16x32_bf16 v[148:151], v[244:247], v[52:55], v[148:151]
    ds_read_b64_tr_b16 v[238:239], v5 offset:1312
    s_waitcnt vmcnt(15) lgkmcnt(6)
    v_mfma_f32_16x16x32_bf16 v[88:91], v[224:227], v[56:59], v[88:91]
    ds_read_b64_tr_b16 v[240:241], v4 offset:512
    s_waitcnt vmcnt(14)
    v_mfma_f32_16x16x32_bf16 v[92:95], v[224:227], v[60:63], v[92:95]
    ds_read_b64_tr_b16 v[242:243], v4 offset:1536
    s_waitcnt lgkmcnt(6)
    v_mfma_f32_16x16x32_bf16 v[96:99], v[228:231], v[56:59], v[96:99]
    ds_read_b64_tr_b16 v[244:245], v5 offset:544
    s_mov_b32 s23, 0x8000
    buffer_load_dwordx4 v[48:51], v6, s[8:11], s23 offen offset:3072 sc1
    v_mfma_f32_16x16x32_bf16 v[100:103], v[228:231], v[60:63], v[100:103]
    ds_read_b64_tr_b16 v[246:247], v5 offset:1568
    s_waitcnt lgkmcnt(6)
    v_mfma_f32_16x16x32_bf16 v[104:107], v[232:235], v[56:59], v[104:107]
    ds_read_b64_tr_b16 v[224:225], v4 offset:768
    v_mfma_f32_16x16x32_bf16 v[108:111], v[232:235], v[60:63], v[108:111]
    ds_read_b64_tr_b16 v[226:227], v4 offset:1792
    s_mov_b32 s23, 0x28000
    buffer_load_dwordx4 v[52:55], v6, s[8:11], s23 offen offset:3072 sc1
    s_waitcnt lgkmcnt(6)
    v_mfma_f32_16x16x32_bf16 v[112:115], v[236:239], v[56:59], v[112:115]
    ds_read_b64_tr_b16 v[228:229], v5 offset:800
    v_mfma_f32_16x16x32_bf16 v[116:119], v[236:239], v[60:63], v[116:119]
    ds_read_b64_tr_b16 v[230:231], v5 offset:1824
    s_waitcnt lgkmcnt(6)
    v_mfma_f32_16x16x32_bf16 v[120:123], v[240:243], v[56:59], v[120:123]
    v_mfma_f32_16x16x32_bf16 v[124:127], v[240:243], v[60:63], v[124:127]
    s_waitcnt vmcnt(14)
    s_barrier
    ds_read_b64_tr_b16 v[232:233], v4 offset:16384
    ds_read_b64_tr_b16 v[234:235], v4 offset:17408
    s_waitcnt lgkmcnt(6)
    v_mfma_f32_16x16x32_bf16 v[128:131], v[244:247], v[56:59], v[128:131]
    s_add_u32 s22, s24, 0x2b0000
    s_add_u32 m0, s20, 0x24000
    s_nop 0
    buffer_load_dwordx4 v3, s[4:7], s22 offen lds
    ds_read_b64_tr_b16 v[236:237], v5 offset:16416
    v_mfma_f32_16x16x32_bf16 v[132:135], v[244:247], v[60:63], v[132:135]
    ds_read_b64_tr_b16 v[238:239], v5 offset:17440
    s_waitcnt lgkmcnt(6)
    v_mfma_f32_16x16x32_bf16 v[136:139], v[224:227], v[56:59], v[136:139]
    ds_read_b64_tr_b16 v[240:241], v4 offset:16640
    v_mfma_f32_16x16x32_bf16 v[140:143], v[224:227], v[60:63], v[140:143]
    s_add_u32 s22, s24, 0x2b2000
    s_add_u32 m0, s20, 0x24400
    s_nop 0
    buffer_load_dwordx4 v3, s[4:7], s22 offen lds
    ds_read_b64_tr_b16 v[242:243], v4 offset:17664
    s_waitcnt lgkmcnt(6)
    v_mfma_f32_16x16x32_bf16 v[144:147], v[228:231], v[56:59], v[144:147]
    ds_read_b64_tr_b16 v[244:245], v5 offset:16672
    v_mfma_f32_16x16x32_bf16 v[148:151], v[228:231], v[60:63], v[148:151]
    ds_read_b64_tr_b16 v[246:247], v5 offset:17696
    s_waitcnt vmcnt(15) lgkmcnt(6)
    v_mfma_f32_16x16x32_bf16 v[88:91], v[232:235], v[24:27], v[88:91]
    ds_read_b64_tr_b16 v[224:225], v4 offset:16896
    s_waitcnt vmcnt(14)
    v_mfma_f32_16x16x32_bf16 v[92:95], v[232:235], v[28:31], v[92:95]
    ds_read_b64_tr_b16 v[226:227], v4 offset:17920
    s_waitcnt lgkmcnt(6)
    v_mfma_f32_16x16x32_bf16 v[96:99], v[236:239], v[24:27], v[96:99]
    ds_read_b64_tr_b16 v[228:229], v5 offset:16928
    s_mov_b32 s23, 0xa000
    buffer_load_dwordx4 v[56:59], v6, s[8:11], s23 offen offset:3072 sc1
    v_mfma_f32_16x16x32_bf16 v[100:103], v[236:239], v[28:31], v[100:103]
    ds_read_b64_tr_b16 v[230:231], v5 offset:17952
    s_waitcnt lgkmcnt(6)
    v_mfma_f32_16x16x32_bf16 v[104:107], v[240:243], v[24:27], v[104:107]
    ds_read_b64_tr_b16 v[232:233], v4 offset:17152
    v_mfma_f32_16x16x32_bf16 v[108:111], v[240:243], v[28:31], v[108:111]
    ds_read_b64_tr_b16 v[234:235], v4 offset:18176
    s_mov_b32 s23, 0x2a000
    buffer_load_dwordx4 v[60:63], v6, s[8:11], s23 offen offset:3072 sc1
    s_waitcnt lgkmcnt(6)
    v_mfma_f32_16x16x32_bf16 v[112:115], v[244:247], v[24:27], v[112:115]
    ds_read_b64_tr_b16 v[236:237], v5 offset:17184
    v_mfma_f32_16x16x32_bf16 v[116:119], v[244:247], v[28:31], v[116:119]
    ds_read_b64_tr_b16 v[238:239], v5 offset:18208
    s_waitcnt lgkmcnt(6)
    v_mfma_f32_16x16x32_bf16 v[120:123], v[224:227], v[24:27], v[120:123]
    v_mfma_f32_16x16x32_bf16 v[124:127], v[224:227], v[28:31], v[124:127]
    s_waitcnt vmcnt(14)
    s_barrier
    ds_read_b64_tr_b16 v[240:241], v4 offset:32768
    ds_read_b64_tr_b16 v[242:243], v4 offset:33792
    s_waitcnt lgkmcnt(6)
    v_mfma_f32_16x16x32_bf16 v[128:131], v[228:231], v[24:27], v[128:131]
    s_add_u32 s22, s24, 0x330000
    s_add_u32 m0, s20, 0x10000
    s_nop 0
    buffer_load_dwordx4 v3, s[4:7], s22 offen lds
    ds_read_b64_tr_b16 v[244:245], v5 offset:32800
    v_mfma_f32_16x16x32_bf16 v[132:135], v[228:231], v[28:31], v[132:135]
    ds_read_b64_tr_b16 v[246:247], v5 offset:33824
    s_waitcnt lgkmcnt(6)
    v_mfma_f32_16x16x32_bf16 v[136:139], v[232:235], v[24:27], v[136:139]
    ds_read_b64_tr_b16 v[224:225], v4 offset:33024
    v_mfma_f32_16x16x32_bf16 v[140:143], v[232:235], v[28:31], v[140:143]
    s_add_u32 s22, s24, 0x332000
    s_add_u32 m0, s20, 0x10400
    s_nop 0
    buffer_load_dwordx4 v3, s[4:7], s22 offen lds
    ds_read_b64_tr_b16 v[226:227], v4 offset:34048
    s_waitcnt lgkmcnt(6)
    v_mfma_f32_16x16x32_bf16 v[144:147], v[236:239], v[24:27], v[144:147]
    ds_read_b64_tr_b16 v[228:229], v5 offset:33056
    v_mfma_f32_16x16x32_bf16 v[148:151], v[236:239], v[28:31], v[148:151]
    ds_read_b64_tr_b16 v[230:231], v5 offset:34080
    s_waitcnt vmcnt(15) lgkmcnt(6)
    v_mfma_f32_16x16x32_bf16 v[88:91], v[240:243], v[32:35], v[88:91]
    ds_read_b64_tr_b16 v[232:233], v4 offset:33280
    s_waitcnt vmcnt(14)
    v_mfma_f32_16x16x32_bf16 v[92:95], v[240:243], v[36:39], v[92:95]
    ds_read_b64_tr_b16 v[234:235], v4 offset:34304
    s_waitcnt lgkmcnt(6)
    v_mfma_f32_16x16x32_bf16 v[96:99], v[244:247], v[32:35], v[96:99]
    ds_read_b64_tr_b16 v[236:237], v5 offset:33312
    s_mov_b32 s23, 0xc000
    buffer_load_dwordx4 v[24:27], v6, s[8:11], s23 offen offset:3072 sc1
    v_mfma_f32_16x16x32_bf16 v[100:103], v[244:247], v[36:39], v[100:103]
    ds_read_b64_tr_b16 v[238:239], v5 offset:34336
    s_waitcnt lgkmcnt(6)
    v_mfma_f32_16x16x32_bf16 v[104:107], v[224:227], v[32:35], v[104:107]
    ds_read_b64_tr_b16 v[240:241], v4 offset:33536
    v_mfma_f32_16x16x32_bf16 v[108:111], v[224:227], v[36:39], v[108:111]
    ds_read_b64_tr_b16 v[242:243], v4 offset:34560
    s_mov_b32 s23, 0x2c000
    buffer_load_dwordx4 v[28:31], v6, s[8:11], s23 offen offset:3072 sc1
    v_lshrrev_b32 v16, 4, v1
    v_lshlrev_b32 v16, 3, v16
    s_lshl_b32 s16, s31, 8
    s_add_u32 s16, s16, 0x540000
    buffer_load_dwordx2 v[248:249], v16, s[8:11], s16 offen offset:0 sc1
    buffer_load_dwordx2 v[250:251], v16, s[8:11], s16 offen offset:32 sc1
    buffer_load_dwordx2 v[252:253], v16, s[8:11], s16 offen offset:64 sc1
    buffer_load_dwordx2 v[254:255], v16, s[8:11], s16 offen offset:96 sc1
    s_waitcnt lgkmcnt(6)
    v_mfma_f32_16x16x32_bf16 v[112:115], v[228:231], v[32:35], v[112:115]
    ds_read_b64_tr_b16 v[244:245], v5 offset:33568
    v_mfma_f32_16x16x32_bf16 v[116:119], v[228:231], v[36:39], v[116:119]
    ds_read_b64_tr_b16 v[246:247], v5 offset:34592
    s_waitcnt lgkmcnt(6)
    v_mfma_f32_16x16x32_bf16 v[120:123], v[232:235], v[32:35], v[120:123]
    v_mfma_f32_16x16x32_bf16 v[124:127], v[232:235], v[36:39], v[124:127]
    s_waitcnt vmcnt(18)
    s_barrier
    ds_read_b64_tr_b16 v[224:225], v4 offset:49152
    ds_read_b64_tr_b16 v[226:227], v4 offset:50176
    s_waitcnt lgkmcnt(6)
    v_mfma_f32_16x16x32_bf16 v[128:131], v[236:239], v[32:35], v[128:131]
    s_add_u32 s22, s24, 0x3b0000
    s_add_u32 m0, s20, 0x14000
    s_nop 0
    buffer_load_dwordx4 v3, s[4:7], s22 offen lds
    ds_read_b64_tr_b16 v[228:229], v5 offset:49184
    v_mfma_f32_16x16x32_bf16 v[132:135], v[236:239], v[36:39], v[132:135]
    ds_read_b64_tr_b16 v[230:231], v5 offset:50208
    s_waitcnt lgkmcnt(6)
    v_mfma_f32_16x16x32_bf16 v[136:139], v[240:243], v[32:35], v[136:139]
    ds_read_b64_tr_b16 v[232:233], v4 offset:49408
    v_mfma_f32_16x16x32_bf16 v[140:143], v[240:243], v[36:39], v[140:143]
    s_add_u32 s22, s24, 0x3b2000
    s_add_u32 m0, s20, 0x14400
    s_nop 0
    buffer_load_dwordx4 v3, s[4:7], s22 offen lds
    ds_read_b64_tr_b16 v[234:235], v4 offset:50432
    s_waitcnt lgkmcnt(6)
    v_mfma_f32_16x16x32_bf16 v[144:147], v[244:247], v[32:35], v[144:147]
    ds_read_b64_tr_b16 v[236:237], v5 offset:49440
    v_mfma_f32_16x16x32_bf16 v[148:151], v[244:247], v[36:39], v[148:151]
    ds_read_b64_tr_b16 v[238:239], v5 offset:50464
    s_waitcnt vmcnt(19) lgkmcnt(6)
    v_mfma_f32_16x16x32_bf16 v[88:91], v[224:227], v[40:43], v[88:91]
    ds_read_b64_tr_b16 v[240:241], v4 offset:49664
    s_waitcnt vmcnt(18)
    v_mfma_f32_16x16x32_bf16 v[92:95], v[224:227], v[44:47], v[92:95]
    ds_read_b64_tr_b16 v[242:243], v4 offset:50688
    s_waitcnt lgkmcnt(6)
    v_mfma_f32_16x16x32_bf16 v[96:99], v[228:231], v[40:43], v[96:99]
    ds_read_b64_tr_b16 v[244:245], v5 offset:49696
    s_mov_b32 s23, 0xe000
    buffer_load_dwordx4 v[32:35], v6, s[8:11], s23 offen offset:3072 sc1
    v_mfma_f32_16x16x32_bf16 v[100:103], v[228:231], v[44:47], v[100:103]
    ds_read_b64_tr_b16 v[246:247], v5 offset:50720
    s_waitcnt lgkmcnt(6)
    v_mfma_f32_16x16x32_bf16 v[104:107], v[232:235], v[40:43], v[104:107]
    ds_read_b64_tr_b16 v[224:225], v4 offset:49920
    v_mfma_f32_16x16x32_bf16 v[108:111], v[232:235], v[44:47], v[108:111]
    ds_read_b64_tr_b16 v[226:227], v4 offset:50944
    s_mov_b32 s23, 0x2e000
    buffer_load_dwordx4 v[36:39], v6, s[8:11], s23 offen offset:3072 sc1
    s_waitcnt lgkmcnt(6)
    v_mfma_f32_16x16x32_bf16 v[112:115], v[236:239], v[40:43], v[112:115]
    ds_read_b64_tr_b16 v[228:229], v5 offset:49952
    v_mfma_f32_16x16x32_bf16 v[116:119], v[236:239], v[44:47], v[116:119]
    ds_read_b64_tr_b16 v[230:231], v5 offset:50976
    s_waitcnt lgkmcnt(6)
    v_mfma_f32_16x16x32_bf16 v[120:123], v[240:243], v[40:43], v[120:123]
    v_mfma_f32_16x16x32_bf16 v[124:127], v[240:243], v[44:47], v[124:127]
    s_waitcnt vmcnt(18)
    s_barrier
    ds_read_b64_tr_b16 v[232:233], v7 offset:0
    ds_read_b64_tr_b16 v[234:235], v7 offset:1024
    s_waitcnt lgkmcnt(6)
    v_mfma_f32_16x16x32_bf16 v[128:131], v[244:247], v[40:43], v[128:131]
    ds_read_b64_tr_b16 v[236:237], v8 offset:32
    v_mfma_f32_16x16x32_bf16 v[132:135], v[244:247], v[44:47], v[132:135]
    ds_read_b64_tr_b16 v[238:239], v8 offset:1056
    s_waitcnt lgkmcnt(6)
    v_mfma_f32_16x16x32_bf16 v[136:139], v[224:227], v[40:43], v[136:139]
    ds_read_b64_tr_b16 v[240:241], v7 offset:256
    v_mfma_f32_16x16x32_bf16 v[140:143], v[224:227], v[44:47], v[140:143]
    ds_read_b64_tr_b16 v[242:243], v7 offset:1280
    s_waitcnt lgkmcnt(6)
    v_mfma_f32_16x16x32_bf16 v[144:147], v[228:231], v[40:43], v[144:147]
    ds_read_b64_tr_b16 v[244:245], v8 offset:288
    v_mfma_f32_16x16x32_bf16 v[148:151], v[228:231], v[44:47], v[148:151]
    ds_read_b64_tr_b16 v[246:247], v8 offset:1312
    s_waitcnt vmcnt(17) lgkmcnt(6)
    v_mfma_f32_16x16x32_bf16 v[88:91], v[232:235], v[48:51], v[88:91]
    ds_read_b64_tr_b16 v[224:225], v7 offset:512
    s_waitcnt vmcnt(16)
    v_mfma_f32_16x16x32_bf16 v[92:95], v[232:235], v[52:55], v[92:95]
    ds_read_b64_tr_b16 v[226:227], v7 offset:1536
    s_waitcnt lgkmcnt(6)
    v_mfma_f32_16x16x32_bf16 v[96:99], v[236:239], v[48:51], v[96:99]
    ds_read_b64_tr_b16 v[228:229], v8 offset:544
    v_mfma_f32_16x16x32_bf16 v[100:103], v[236:239], v[52:55], v[100:103]
    ds_read_b64_tr_b16 v[230:231], v8 offset:1568
    s_waitcnt lgkmcnt(6)
    v_mfma_f32_16x16x32_bf16 v[104:107], v[240:243], v[48:51], v[104:107]
    ds_read_b64_tr_b16 v[232:233], v7 offset:768
    v_mfma_f32_16x16x32_bf16 v[108:111], v[240:243], v[52:55], v[108:111]
    ds_read_b64_tr_b16 v[234:235], v7 offset:1792
    s_waitcnt lgkmcnt(6)
    v_mfma_f32_16x16x32_bf16 v[112:115], v[244:247], v[48:51], v[112:115]
    ds_read_b64_tr_b16 v[236:237], v8 offset:800
    v_mfma_f32_16x16x32_bf16 v[116:119], v[244:247], v[52:55], v[116:119]
    ds_read_b64_tr_b16 v[238:239], v8 offset:1824
    s_waitcnt lgkmcnt(6)
    v_mfma_f32_16x16x32_bf16 v[120:123], v[224:227], v[48:51], v[120:123]
    v_mfma_f32_16x16x32_bf16 v[124:127], v[224:227], v[52:55], v[124:127]
    s_waitcnt vmcnt(14)
    s_barrier
    ds_read_b64_tr_b16 v[240:241], v7 offset:16384
    ds_read_b64_tr_b16 v[242:243], v7 offset:17408
    s_waitcnt lgkmcnt(6)
    v_mfma_f32_16x16x32_bf16 v[128:131], v[228:231], v[48:51], v[128:131]
    ds_read_b64_tr_b16 v[244:245], v8 offset:16416
    v_mfma_f32_16x16x32_bf16 v[132:135], v[228:231], v[52:55], v[132:135]
    ds_read_b64_tr_b16 v[246:247], v8 offset:17440
    s_waitcnt lgkmcnt(6)
    v_mfma_f32_16x16x32_bf16 v[136:139], v[232:235], v[48:51], v[136:139]
    ds_read_b64_tr_b16 v[224:225], v7 offset:16640
    v_mfma_f32_16x16x32_bf16 v[140:143], v[232:235], v[52:55], v[140:143]
    ds_read_b64_tr_b16 v[226:227], v7 offset:17664
    s_waitcnt lgkmcnt(6)
    v_mfma_f32_16x16x32_bf16 v[144:147], v[236:239], v[48:51], v[144:147]
    ds_read_b64_tr_b16 v[228:229], v8 offset:16672
    v_mfma_f32_16x16x32_bf16 v[148:151], v[236:239], v[52:55], v[148:151]
    ds_read_b64_tr_b16 v[230:231], v8 offset:17696
    s_waitcnt vmcnt(13) lgkmcnt(6)
    v_mfma_f32_16x16x32_bf16 v[88:91], v[240:243], v[56:59], v[88:91]
    ds_read_b64_tr_b16 v[232:233], v7 offset:16896
    s_waitcnt vmcnt(12)
    v_mfma_f32_16x16x32_bf16 v[92:95], v[240:243], v[60:63], v[92:95]
    ds_read_b64_tr_b16 v[234:235], v7 offset:17920
    s_waitcnt lgkmcnt(6)
    v_mfma_f32_16x16x32_bf16 v[96:99], v[244:247], v[56:59], v[96:99]
    ds_read_b64_tr_b16 v[236:237], v8 offset:16928
    v_mfma_f32_16x16x32_bf16 v[100:103], v[244:247], v[60:63], v[100:103]
    ds_read_b64_tr_b16 v[238:239], v8 offset:17952
    s_waitcnt lgkmcnt(6)
    v_mfma_f32_16x16x32_bf16 v[104:107], v[224:227], v[56:59], v[104:107]
    ds_read_b64_tr_b16 v[240:241], v7 offset:17152
    v_mfma_f32_16x16x32_bf16 v[108:111], v[224:227], v[60:63], v[108:111]
    ds_read_b64_tr_b16 v[242:243], v7 offset:18176
    s_waitcnt lgkmcnt(6)
    v_mfma_f32_16x16x32_bf16 v[112:115], v[228:231], v[56:59], v[112:115]
    ds_read_b64_tr_b16 v[244:245], v8 offset:17184
    v_mfma_f32_16x16x32_bf16 v[116:119], v[228:231], v[60:63], v[116:119]
    ds_read_b64_tr_b16 v[246:247], v8 offset:18208
    s_waitcnt lgkmcnt(6)
    v_mfma_f32_16x16x32_bf16 v[120:123], v[232:235], v[56:59], v[120:123]
    v_mfma_f32_16x16x32_bf16 v[124:127], v[232:235], v[60:63], v[124:127]
    s_waitcnt vmcnt(10)
    s_barrier
    ds_read_b64_tr_b16 v[224:225], v4 offset:0
    ds_read_b64_tr_b16 v[226:227], v4 offset:1024
    s_waitcnt lgkmcnt(6)
    v_mfma_f32_16x16x32_bf16 v[128:131], v[236:239], v[56:59], v[128:131]
    ds_read_b64_tr_b16 v[228:229], v5 offset:32
    v_mfma_f32_16x16x32_bf16 v[132:135], v[236:239], v[60:63], v[132:135]
    ds_read_b64_tr_b16 v[230:231], v5 offset:1056
    s_waitcnt lgkmcnt(6)
    v_mfma_f32_16x16x32_bf16 v[136:139], v[240:243], v[56:59], v[136:139]
    ds_read_b64_tr_b16 v[232:233], v4 offset:256
    v_mfma_f32_16x16x32_bf16 v[140:143], v[240:243], v[60:63], v[140:143]
    ds_read_b64_tr_b16 v[234:235], v4 offset:1280
    s_waitcnt lgkmcnt(6)
    v_mfma_f32_16x16x32_bf16 v[144:147], v[244:247], v[56:59], v[144:147]
    ds_read_b64_tr_b16 v[236:237], v5 offset:288
    v_mfma_f32_16x16x32_bf16 v[148:151], v[244:247], v[60:63], v[148:151]
    ds_read_b64_tr_b16 v[238:239], v5 offset:1312
    s_waitcnt vmcnt(9) lgkmcnt(6)
    v_mfma_f32_16x16x32_bf16 v[88:91], v[224:227], v[24:27], v[88:91]
    ds_read_b64_tr_b16 v[240:241], v4 offset:512
    s_waitcnt vmcnt(8)
    v_mfma_f32_16x16x32_bf16 v[92:95], v[224:227], v[28:31], v[92:95]
    ds_read_b64_tr_b16 v[242:243], v4 offset:1536
    s_waitcnt lgkmcnt(6)
    v_mfma_f32_16x16x32_bf16 v[96:99], v[228:231], v[24:27], v[96:99]
    ds_read_b64_tr_b16 v[244:245], v5 offset:544
    v_mfma_f32_16x16x32_bf16 v[100:103], v[228:231], v[28:31], v[100:103]
    ds_read_b64_tr_b16 v[246:247], v5 offset:1568
    s_waitcnt lgkmcnt(6)
    v_mfma_f32_16x16x32_bf16 v[104:107], v[232:235], v[24:27], v[104:107]
    ds_read_b64_tr_b16 v[224:225], v4 offset:768
    v_mfma_f32_16x16x32_bf16 v[108:111], v[232:235], v[28:31], v[108:111]
    ds_read_b64_tr_b16 v[226:227], v4 offset:1792
    s_waitcnt lgkmcnt(6)
    v_mfma_f32_16x16x32_bf16 v[112:115], v[236:239], v[24:27], v[112:115]
    ds_read_b64_tr_b16 v[228:229], v5 offset:800
    v_mfma_f32_16x16x32_bf16 v[116:119], v[236:239], v[28:31], v[116:119]
    ds_read_b64_tr_b16 v[230:231], v5 offset:1824
    s_waitcnt lgkmcnt(6)
    v_mfma_f32_16x16x32_bf16 v[120:123], v[240:243], v[24:27], v[120:123]
    v_mfma_f32_16x16x32_bf16 v[124:127], v[240:243], v[28:31], v[124:127]
    s_waitcnt vmcnt(2)
    s_barrier
    ds_read_b64_tr_b16 v[232:233], v4 offset:16384
    ds_read_b64_tr_b16 v[234:235], v4 offset:17408
    s_waitcnt lgkmcnt(6)
    v_mfma_f32_16x16x32_bf16 v[128:131], v[244:247], v[24:27], v[128:131]
    ds_read_b64_tr_b16 v[236:237], v5 offset:16416
    v_mfma_f32_16x16x32_bf16 v[132:135], v[244:247], v[28:31], v[132:135]
    ds_read_b64_tr_b16 v[238:239], v5 offset:17440
    s_waitcnt lgkmcnt(6)
    v_mfma_f32_16x16x32_bf16 v[136:139], v[224:227], v[24:27], v[136:139]
    ds_read_b64_tr_b16 v[240:241], v4 offset:16640
    v_mfma_f32_16x16x32_bf16 v[140:143], v[224:227], v[28:31], v[140:143]
    ds_read_b64_tr_b16 v[242:243], v4 offset:17664
    s_waitcnt lgkmcnt(6)
    v_mfma_f32_16x16x32_bf16 v[144:147], v[228:231], v[24:27], v[144:147]
    ds_read_b64_tr_b16 v[244:245], v5 offset:16672
    v_mfma_f32_16x16x32_bf16 v[148:151], v[228:231], v[28:31], v[148:151]
    ds_read_b64_tr_b16 v[246:247], v5 offset:17696
    s_waitcnt vmcnt(1) lgkmcnt(6)
    v_mfma_f32_16x16x32_bf16 v[88:91], v[232:235], v[32:35], v[88:91]
    ds_read_b64_tr_b16 v[224:225], v4 offset:16896
    s_waitcnt vmcnt(0)
    v_mfma_f32_16x16x32_bf16 v[92:95], v[232:235], v[36:39], v[92:95]
    ds_read_b64_tr_b16 v[226:227], v4 offset:17920
    s_waitcnt lgkmcnt(6)
    v_mfma_f32_16x16x32_bf16 v[96:99], v[236:239], v[32:35], v[96:99]
    ds_read_b64_tr_b16 v[228:229], v5 offset:16928
    v_mfma_f32_16x16x32_bf16 v[100:103], v[236:239], v[36:39], v[100:103]
    ds_read_b64_tr_b16 v[230:231], v5 offset:17952
    s_waitcnt lgkmcnt(6)
    v_mfma_f32_16x16x32_bf16 v[104:107], v[240:243], v[32:35], v[104:107]
    ds_read_b64_tr_b16 v[232:233], v4 offset:17152
    v_mfma_f32_16x16x32_bf16 v[108:111], v[240:243], v[36:39], v[108:111]
    ds_read_b64_tr_b16 v[234:235], v4 offset:18176
    s_waitcnt lgkmcnt(6)
    v_mfma_f32_16x16x32_bf16 v[112:115], v[244:247], v[32:35], v[112:115]
    ds_read_b64_tr_b16 v[236:237], v5 offset:17184
    v_mfma_f32_16x16x32_bf16 v[116:119], v[244:247], v[36:39], v[116:119]
    ds_read_b64_tr_b16 v[238:239], v5 offset:18208
    s_waitcnt lgkmcnt(6)
    v_mfma_f32_16x16x32_bf16 v[120:123], v[224:227], v[32:35], v[120:123]
    v_mfma_f32_16x16x32_bf16 v[124:127], v[224:227], v[36:39], v[124:127]
    s_waitcnt lgkmcnt(4)
    v_mfma_f32_16x16x32_bf16 v[128:131], v[228:231], v[32:35], v[128:131]
    v_mfma_f32_16x16x32_bf16 v[132:135], v[228:231], v[36:39], v[132:135]
    s_waitcnt lgkmcnt(2)
    v_mfma_f32_16x16x32_bf16 v[136:139], v[232:235], v[32:35], v[136:139]
    v_mfma_f32_16x16x32_bf16 v[140:143], v[232:235], v[36:39], v[140:143]
    s_waitcnt lgkmcnt(0)
    v_mfma_f32_16x16x32_bf16 v[144:147], v[236:239], v[32:35], v[144:147]
    v_mfma_f32_16x16x32_bf16 v[148:151], v[236:239], v[36:39], v[148:151]
    s_lshl_b32 s16, s3, 13
    s_xor_b32 s17, s16, 0x8000
    s_add_u32 s16, s16, 0x18000
    s_add_u32 s17, s17, 0x18000
    v_add_u32 v16, s16, v2
    s_mov_b32 s16, s17
    v_add_u32 v17, s16, v2
    ds_write_b128 v16, v[120:123] offset:0
    ds_write_b128 v16, v[124:127] offset:1024
    ds_write_b128 v16, v[128:131] offset:2048
    ds_write_b128 v16, v[132:135] offset:3072
    ds_write_b128 v16, v[136:139] offset:4096
    ds_write_b128 v16, v[140:143] offset:5120
    ds_write_b128 v16, v[144:147] offset:6144
    ds_write_b128 v16, v[148:151] offset:7168
    v_lshlrev_b32 v24, 16, v248
    v_and_b32 v25, 0xffff0000, v248
    v_lshlrev_b32 v26, 16, v249
    v_and_b32 v27, 0xffff0000, v249
    v_lshlrev_b32 v28, 16, v250
    v_and_b32 v29, 0xffff0000, v250
    v_lshlrev_b32 v30, 16, v251
    v_and_b32 v31, 0xffff0000, v251
    v_lshlrev_b32 v32, 16, v252
    v_and_b32 v33, 0xffff0000, v252
    v_lshlrev_b32 v34, 16, v253
    v_and_b32 v35, 0xffff0000, v253
    v_lshlrev_b32 v36, 16, v254
    v_and_b32 v37, 0xffff0000, v254
    v_lshlrev_b32 v38, 16, v255
    v_and_b32 v39, 0xffff0000, v255
    v_and_b32 v18, 15, v1
    v_lshlrev_b32 v18, 6, v18
    v_lshrrev_b32 v19, 4, v1
    v_and_b32 v20, 1, v19
    v_lshl_add_u32 v18, v20, 5, v18
    v_lshrrev_b32 v19, 1, v19
    v_lshl_add_u32 v18, v19, 4, v18
    s_and_b32 s17, s3, 3
    s_lshl_b32 s18, s30, 2
    s_add_u32 s18, s18, s17
    s_lshl_b32 s18, s18, 16
    s_lshl_b32 s19, s15, 22
    s_add_u32 s18, s18, s19
    s_lshl_b32 s19, s31, 12
    s_add_u32 s18, s18, s19
    s_add_u32 s18, s18, 0x2c00000
    s_add_u32 s19, s18, 32768
    s_waitcnt lgkmcnt(0)
    s_barrier
    ds_read_b128 v[40:43], v17 offset:0
    ds_read_b128 v[44:47], v17 offset:1024
    ds_read_b128 v[48:51], v17 offset:2048
    ds_read_b128 v[52:55], v17 offset:3072
    ds_read_b128 v[56:59], v17 offset:4096
    ds_read_b128 v[60:63], v17 offset:5120
    ds_read_b128 v[64:67], v17 offset:6144
    ds_read_b128 v[68:71], v17 offset:7168
    s_waitcnt lgkmcnt(7)
    v_pk_add_f32 v[88:89], v[88:89], v[40:41]
    v_pk_add_f32 v[90:91], v[90:91], v[42:43]
    v_pk_mul_f32 v[88:89], v[88:89], v[24:25]
    v_pk_mul_f32 v[90:91], v[90:91], v[26:27]
    v_cvt_pk_bf16_f32 v224, v88, v89
    v_cvt_pk_bf16_f32 v225, v90, v91
    s_waitcnt lgkmcnt(5)
    v_pk_add_f32 v[96:97], v[96:97], v[48:49]
    v_pk_add_f32 v[98:99], v[98:99], v[50:51]
    v_pk_mul_f32 v[96:97], v[96:97], v[28:29]
    v_pk_mul_f32 v[98:99], v[98:99], v[30:31]
    v_cvt_pk_bf16_f32 v226, v96, v97
    v_cvt_pk_bf16_f32 v227, v98, v99
    s_nop 0
    v_permlane16_swap_b32 v224, v226
    v_permlane16_swap_b32 v225, v227
    buffer_store_dwordx4 v[224:227], v18, s[8:11], s18 offen offset:0 sc1
    v_pk_add_f32 v[92:93], v[92:93], v[44:45]
    v_pk_add_f32 v[94:95], v[94:95], v[46:47]
    v_pk_mul_f32 v[92:93], v[92:93], v[24:25]
    v_pk_mul_f32 v[94:95], v[94:95], v[26:27]
    v_cvt_pk_bf16_f32 v228, v92, v93
    v_cvt_pk_bf16_f32 v229, v94, v95
    s_waitcnt lgkmcnt(4)
    v_pk_add_f32 v[100:101], v[100:101], v[52:53]
    v_pk_add_f32 v[102:103], v[102:103], v[54:55]
    v_pk_mul_f32 v[100:101], v[100:101], v[28:29]
    v_pk_mul_f32 v[102:103], v[102:103], v[30:31]
    v_cvt_pk_bf16_f32 v230, v100, v101
    v_cvt_pk_bf16_f32 v231, v102, v103
    s_nop 0
    v_permlane16_swap_b32 v228, v230
    v_permlane16_swap_b32 v229, v231
    buffer_store_dwordx4 v[228:231], v18, s[8:11], s19 offen offset:0 sc1
    s_waitcnt lgkmcnt(3)
    v_pk_add_f32 v[104:105], v[104:105], v[56:57]
    v_pk_add_f32 v[106:107], v[106:107], v[58:59]
    v_pk_mul_f32 v[104:105], v[104:105], v[32:33]
    v_pk_mul_f32 v[106:107], v[106:107], v[34:35]
    v_cvt_pk_bf16_f32 v232, v104, v105
    v_cvt_pk_bf16_f32 v233, v106, v107
    s_waitcnt lgkmcnt(1)
    v_pk_add_f32 v[112:113], v[112:113], v[64:65]
    v_pk_add_f32 v[114:115], v[114:115], v[66:67]
    v_pk_mul_f32 v[112:113], v[112:113], v[36:37]
    v_pk_mul_f32 v[114:115], v[114:115], v[38:39]
    v_cvt_pk_bf16_f32 v234, v112, v113
    v_cvt_pk_bf16_f32 v235, v114, v115
    s_nop 0
    v_permlane16_swap_b32 v232, v234
    v_permlane16_swap_b32 v233, v235
    buffer_store_dwordx4 v[232:235], v18, s[8:11], s18 offen offset:1024 sc1
    v_pk_add_f32 v[108:109], v[108:109], v[60:61]
    v_pk_add_f32 v[110:111], v[110:111], v[62:63]
    v_pk_mul_f32 v[108:109], v[108:109], v[32:33]
    v_pk_mul_f32 v[110:111], v[110:111], v[34:35]
    v_cvt_pk_bf16_f32 v236, v108, v109
    v_cvt_pk_bf16_f32 v237, v110, v111
    s_waitcnt lgkmcnt(0)
    v_pk_add_f32 v[116:117], v[116:117], v[68:69]
    v_pk_add_f32 v[118:119], v[118:119], v[70:71]
    v_pk_mul_f32 v[116:117], v[116:117], v[36:37]
    v_pk_mul_f32 v[118:119], v[118:119], v[38:39]
    v_cvt_pk_bf16_f32 v238, v116, v117
    v_cvt_pk_bf16_f32 v239, v118, v119
    s_nop 0
    v_permlane16_swap_b32 v236, v238
    v_permlane16_swap_b32 v237, v239
    buffer_store_dwordx4 v[236:239], v18, s[8:11], s19 offen offset:1024 sc1
    s_mov_b64 s[64:65], s[44:45]
    s_mov_b32 s66, 0x800
    s_mov_b32 s67, 0x20000
    s_mov_b64 s[76:77], s[32:33]
    s_mov_b32 s78, 0x400000
    s_mov_b32 s79, 0x20000
    s_mov_b64 s[68:69], s[56:57]
    s_mov_b32 s70, 0x400000
    s_mov_b32 s71, 0x20000
    s_lshl_b32 s14, s31, 1
    s_add_u32 s14, s14, s15
    s_lshl_b32 s14, s14, 3
    s_add_u32 s14, s14, s3
    s_lshl_b32 s16, s30, 7
    s_add_u32 s14, s14, s16
    s_lshl_b32 s16, s14, 11
    buffer_load_dwordx4 v[216:219], v2, s[76:79], s16 offen offset:0
    buffer_load_dwordx4 v[220:223], v2, s[76:79], s16 offen offset:1024
    s_lshl_b32 s16, s3, 10
    s_add_u32 m0, s16, 81920
    s_add_u32 s16, s16, 0x540800
    buffer_load_dwordx4 v2, s[8:11], s16 offen sc1 lds
    s_lshl_b32 s16, s30, 5
    s_lshl_b32 s17, s31, 1
    s_add_u32 s16, s16, s17
    s_add_u32 s16, s16, s15
    s_lshl_b32 s16, s16, 2
    s_add_u32 s16, s16, 0x530000
    s_cmp_eq_u32 s3, 0
    s_cselect_b32 s16, s16, 0x7ffffff0
    v_mov_b32 v16, s28
    v_mov_b32 v17, 0
    s_lshr_b32 s18, s14, 4
    s_lshl_b32 s18, s18, 15
    s_and_b32 s19, s14, 15
    s_lshl_b32 s19, s19, 6
    s_add_u32 s18, s18, s19
    s_add_u32 s18, s18, 0x2c00000
    s_add_u32 s19, s18, 16384
    v_lshrrev_b32 v18, 2, v1
    v_lshlrev_b32 v18, 10, v18
    v_and_b32 v19, 3, v1
    v_lshl_add_u32 v18, v19, 4, v18
    v_add_u32 v19, 0x400000, v18
    s_lshl_b32 s25, s30, 7
    s_add_u32 s25, s25, 0x530000
    v_and_b32 v20, 15, v1
    v_lshlrev_b32 v20, 2, v20
    s_waitcnt vmcnt(3)
    s_waitcnt vmcnt(0)
    s_barrier
    s_mov_b64 exec, 1
    buffer_store_dword v16, v17, s[8:11], s16 offen sc1
    s_mov_b64 exec, -1
    v_add_u32 v16, 81920, v2
    ds_read_b128 v[184:187], v16 offset:0
    ds_read_b128 v[188:191], v16 offset:1024
    ds_read_b128 v[192:195], v16 offset:2048
    ds_read_b128 v[196:199], v16 offset:3072
    ds_read_b128 v[200:203], v16 offset:4096
    ds_read_b128 v[204:207], v16 offset:5120
    ds_read_b128 v[208:211], v16 offset:6144
    ds_read_b128 v[212:215], v16 offset:7168
    v_mov_b32 v94, 0
    v_mov_b32 v95, 0
    s_waitcnt lgkmcnt(5)
    v_lshlrev_b32 v76, 16, v192
    v_and_b32 v77, 0xffff0000, v192
    s_waitcnt lgkmcnt(1)
    v_lshlrev_b32 v78, 16, v208
    v_and_b32 v79, 0xffff0000, v208
    v_pk_mul_f32 v[60:61], v[76:77], v[78:79]
    v_lshlrev_b32 v76, 16, v184
    v_and_b32 v77, 0xffff0000, v184
    v_fmac_f32 v94, v76, v78
    v_fmac_f32 v94, v77, v79
    v_add_f32 v95, v95, v60
    v_add_f32 v95, v95, v61
    v_lshlrev_b32 v76, 16, v193
    v_and_b32 v77, 0xffff0000, v193
    v_lshlrev_b32 v78, 16, v209
    v_and_b32 v79, 0xffff0000, v209
    v_pk_mul_f32 v[62:63], v[76:77], v[78:79]
    v_lshlrev_b32 v76, 16, v185
    v_and_b32 v77, 0xffff0000, v185
    v_fmac_f32 v94, v76, v78
    v_fmac_f32 v94, v77, v79
    v_add_f32 v95, v95, v62
    v_add_f32 v95, v95, v63
    v_lshlrev_b32 v76, 16, v194
    v_and_b32 v77, 0xffff0000, v194
    v_lshlrev_b32 v78, 16, v210
    v_and_b32 v79, 0xffff0000, v210
    v_pk_mul_f32 v[64:65], v[76:77], v[78:79]
    v_lshlrev_b32 v76, 16, v186
    v_and_b32 v77, 0xffff0000, v186
    v_fmac_f32 v94, v76, v78
    v_fmac_f32 v94, v77, v79
    v_add_f32 v95, v95, v64
    v_add_f32 v95, v95, v65
    v_lshlrev_b32 v76, 16, v195
    v_and_b32 v77, 0xffff0000, v195
    v_lshlrev_b32 v78, 16, v211
    v_and_b32 v79, 0xffff0000, v211
    v_pk_mul_f32 v[66:67], v[76:77], v[78:79]
    v_lshlrev_b32 v76, 16, v187
    v_and_b32 v77, 0xffff0000, v187
    v_fmac_f32 v94, v76, v78
    v_fmac_f32 v94, v77, v79
    v_add_f32 v95, v95, v66
    v_add_f32 v95, v95, v67
    v_lshlrev_b32 v76, 16, v196
    v_and_b32 v77, 0xffff0000, v196
    s_waitcnt lgkmcnt(0)
    v_lshlrev_b32 v78, 16, v212
    v_and_b32 v79, 0xffff0000, v212
    v_pk_mul_f32 v[68:69], v[76:77], v[78:79]
    v_lshlrev_b32 v76, 16, v188
    v_and_b32 v77, 0xffff0000, v188
    v_fmac_f32 v94, v76, v78
    v_fmac_f32 v94, v77, v79
    v_add_f32 v95, v95, v68
    v_add_f32 v95, v95, v69
    v_lshlrev_b32 v76, 16, v197
    v_and_b32 v77, 0xffff0000, v197
    v_lshlrev_b32 v78, 16, v213
    v_and_b32 v79, 0xffff0000, v213
    v_pk_mul_f32 v[70:71], v[76:77], v[78:79]
    v_lshlrev_b32 v76, 16, v189
    v_and_b32 v77, 0xffff0000, v189
    v_fmac_f32 v94, v76, v78
    v_fmac_f32 v94, v77, v79
    v_add_f32 v95, v95, v70
    v_add_f32 v95, v95, v71
    v_lshlrev_b32 v76, 16, v198
    v_and_b32 v77, 0xffff0000, v198
    v_lshlrev_b32 v78, 16, v214
    v_and_b32 v79, 0xffff0000, v214
    v_pk_mul_f32 v[72:73], v[76:77], v[78:79]
    v_lshlrev_b32 v76, 16, v190
    v_and_b32 v77, 0xffff0000, v190
    v_fmac_f32 v94, v76, v78
    v_fmac_f32 v94, v77, v79
    v_add_f32 v95, v95, v72
    v_add_f32 v95, v95, v73
    v_lshlrev_b32 v76, 16, v199
    v_and_b32 v77, 0xffff0000, v199
    v_lshlrev_b32 v78, 16, v215
    v_and_b32 v79, 0xffff0000, v215
    v_pk_mul_f32 v[74:75], v[76:77], v[78:79]
    v_lshlrev_b32 v76, 16, v191
    v_and_b32 v77, 0xffff0000, v191
    v_fmac_f32 v94, v76, v78
    v_fmac_f32 v94, v77, v79
    v_add_f32 v95, v95, v74
    v_add_f32 v95, v95, v75
    v_add_f32_dpp v94, v94, v94 row_ror:1 row_mask:0xf bank_mask:0xf
    s_nop 0
    v_add_f32_dpp v95, v95, v95 row_ror:1 row_mask:0xf bank_mask:0xf
    v_add_f32_dpp v94, v94, v94 row_ror:2 row_mask:0xf bank_mask:0xf
    s_nop 0
    v_add_f32_dpp v95, v95, v95 row_ror:2 row_mask:0xf bank_mask:0xf
    v_add_f32_dpp v94, v94, v94 row_ror:4 row_mask:0xf bank_mask:0xf
    s_nop 0
    v_add_f32_dpp v95, v95, v95 row_ror:4 row_mask:0xf bank_mask:0xf
    v_add_f32_dpp v94, v94, v94 row_ror:8 row_mask:0xf bank_mask:0xf
    s_nop 0
    v_add_f32_dpp v95, v95, v95 row_ror:8 row_mask:0xf bank_mask:0xf
    v_mov_b32 v76, v94
    s_nop 1
    v_permlane16_swap_b32 v94, v76
    v_add_f32 v94, v94, v76
    v_mov_b32 v77, v95
    s_nop 1
    v_permlane16_swap_b32 v95, v77
    v_add_f32 v95, v95, v77
    v_mov_b32 v76, v94
    s_nop 1
    v_permlane32_swap_b32 v94, v76
    v_add_f32 v94, v94, v76
    v_mov_b32 v77, v95
    s_nop 1
    v_permlane32_swap_b32 v95, v77
    v_add_f32 v95, v95, v77
    v_lshlrev_b32 v28, 16, v216
    v_and_b32 v29, 0xffff0000, v216
    v_lshlrev_b32 v30, 16, v217
    v_and_b32 v31, 0xffff0000, v217
    v_lshlrev_b32 v32, 16, v218
    v_and_b32 v33, 0xffff0000, v218
    v_lshlrev_b32 v34, 16, v219
    v_and_b32 v35, 0xffff0000, v219
    v_lshlrev_b32 v36, 16, v220
    v_and_b32 v37, 0xffff0000, v220
    v_lshlrev_b32 v38, 16, v221
    v_and_b32 v39, 0xffff0000, v221
    v_lshlrev_b32 v40, 16, v222
    v_and_b32 v41, 0xffff0000, v222
    v_lshlrev_b32 v42, 16, v223
    v_and_b32 v43, 0xffff0000, v223
    s_sleep 16
    s_mov_b32 s27, 0
adaLN_cond__sliding_block_cached__moe_arch_mod__prompt_kernel_a11p:
    buffer_load_dword v76, v20, s[8:11], s25 offen sc1
    s_waitcnt vmcnt(0)
    v_cmp_ne_u32 vcc, s28, v76
    s_add_u32 s27, s27, 1
    s_cmp_ge_u32 s27, 65536
    s_cbranch_scc1 adaLN_cond__sliding_block_cached__moe_arch_mod__prompt_kernel_a11g
    s_cbranch_vccnz adaLN_cond__sliding_block_cached__moe_arch_mod__prompt_kernel_a11p
adaLN_cond__sliding_block_cached__moe_arch_mod__prompt_kernel_a11g:
    buffer_load_dwordx4 v[44:47], v18, s[8:11], s18 offen sc1
    buffer_load_dwordx4 v[52:55], v19, s[8:11], s18 offen sc1
    buffer_load_dwordx4 v[48:51], v18, s[8:11], s19 offen sc1
    buffer_load_dwordx4 v[56:59], v19, s[8:11], s19 offen sc1
    v_lshlrev_b32 v21, 2, v0
    s_mov_b32 s16, 0x540800
    buffer_load_dword v106, v21, s[8:11], s16 offen sc1
    buffer_load_dword v104, v21, s[8:11], s16 offen offset:2048 sc1
    s_waitcnt vmcnt(5)
    v_lshlrev_b32 v76, 16, v44
    v_and_b32 v77, 0xffff0000, v44
    s_waitcnt vmcnt(4)
    v_lshlrev_b32 v78, 16, v52
    v_and_b32 v79, 0xffff0000, v52
    v_pk_add_f32 v[76:77], v[76:77], v[78:79]
    v_pk_add_f32 v[28:29], v[28:29], v[76:77]
    v_cvt_pk_bf16_f32 v16, v28, v29
    v_lshlrev_b32 v28, 16, v16
    v_and_b32 v29, 0xffff0000, v16
    v_lshlrev_b32 v80, 16, v45
    v_and_b32 v81, 0xffff0000, v45
    v_lshlrev_b32 v82, 16, v53
    v_and_b32 v83, 0xffff0000, v53
    v_pk_add_f32 v[80:81], v[80:81], v[82:83]
    v_pk_add_f32 v[30:31], v[30:31], v[80:81]
    v_cvt_pk_bf16_f32 v17, v30, v31
    v_lshlrev_b32 v30, 16, v17
    v_and_b32 v31, 0xffff0000, v17
    v_lshlrev_b32 v76, 16, v46
    v_and_b32 v77, 0xffff0000, v46
    v_lshlrev_b32 v78, 16, v54
    v_and_b32 v79, 0xffff0000, v54
    v_pk_add_f32 v[76:77], v[76:77], v[78:79]
    v_pk_add_f32 v[32:33], v[32:33], v[76:77]
    v_cvt_pk_bf16_f32 v16, v32, v33
    v_lshlrev_b32 v32, 16, v16
    v_and_b32 v33, 0xffff0000, v16
    v_lshlrev_b32 v80, 16, v47
    v_and_b32 v81, 0xffff0000, v47
    v_lshlrev_b32 v82, 16, v55
    v_and_b32 v83, 0xffff0000, v55
    v_pk_add_f32 v[80:81], v[80:81], v[82:83]
    v_pk_add_f32 v[34:35], v[34:35], v[80:81]
    v_cvt_pk_bf16_f32 v17, v34, v35
    v_lshlrev_b32 v34, 16, v17
    v_and_b32 v35, 0xffff0000, v17
    s_waitcnt vmcnt(3)
    v_lshlrev_b32 v76, 16, v48
    v_and_b32 v77, 0xffff0000, v48
    s_waitcnt vmcnt(2)
    v_lshlrev_b32 v78, 16, v56
    v_and_b32 v79, 0xffff0000, v56
    v_pk_add_f32 v[76:77], v[76:77], v[78:79]
    v_pk_add_f32 v[36:37], v[36:37], v[76:77]
    v_cvt_pk_bf16_f32 v16, v36, v37
    v_lshlrev_b32 v36, 16, v16
    v_and_b32 v37, 0xffff0000, v16
    v_lshlrev_b32 v80, 16, v49
    v_and_b32 v81, 0xffff0000, v49
    v_lshlrev_b32 v82, 16, v57
    v_and_b32 v83, 0xffff0000, v57
    v_pk_add_f32 v[80:81], v[80:81], v[82:83]
    v_pk_add_f32 v[38:39], v[38:39], v[80:81]
    v_cvt_pk_bf16_f32 v17, v38, v39
    v_lshlrev_b32 v38, 16, v17
    v_and_b32 v39, 0xffff0000, v17
    v_lshlrev_b32 v76, 16, v50
    v_and_b32 v77, 0xffff0000, v50
    v_lshlrev_b32 v78, 16, v58
    v_and_b32 v79, 0xffff0000, v58
    v_pk_add_f32 v[76:77], v[76:77], v[78:79]
    v_pk_add_f32 v[40:41], v[40:41], v[76:77]
    v_cvt_pk_bf16_f32 v16, v40, v41
    v_lshlrev_b32 v40, 16, v16
    v_and_b32 v41, 0xffff0000, v16
    v_lshlrev_b32 v80, 16, v51
    v_and_b32 v81, 0xffff0000, v51
    v_lshlrev_b32 v82, 16, v59
    v_and_b32 v83, 0xffff0000, v59
    v_pk_add_f32 v[80:81], v[80:81], v[82:83]
    v_pk_add_f32 v[42:43], v[42:43], v[80:81]
    v_cvt_pk_bf16_f32 v17, v42, v43
    v_lshlrev_b32 v42, 16, v17
    v_and_b32 v43, 0xffff0000, v17
    v_pk_add_f32 v[76:77], v[28:29], v[30:31]
    v_pk_mul_f32 v[78:79], v[28:29], v[28:29]
    v_pk_mul_f32 v[80:81], v[28:29], v[60:61]
    v_pk_fma_f32 v[78:79], v[30:31], v[30:31], v[78:79]
    v_pk_fma_f32 v[80:81], v[30:31], v[62:63], v[80:81]
    v_pk_add_f32 v[76:77], v[76:77], v[32:33]
    v_pk_fma_f32 v[78:79], v[32:33], v[32:33], v[78:79]
    v_pk_fma_f32 v[80:81], v[32:33], v[64:65], v[80:81]
    v_pk_add_f32 v[76:77], v[76:77], v[34:35]
    v_pk_fma_f32 v[78:79], v[34:35], v[34:35], v[78:79]
    v_pk_fma_f32 v[80:81], v[34:35], v[66:67], v[80:81]
    v_pk_add_f32 v[76:77], v[76:77], v[36:37]
    v_pk_fma_f32 v[78:79], v[36:37], v[36:37], v[78:79]
    v_pk_fma_f32 v[80:81], v[36:37], v[68:69], v[80:81]
    v_pk_add_f32 v[76:77], v[76:77], v[38:39]
    v_pk_fma_f32 v[78:79], v[38:39], v[38:39], v[78:79]
    v_pk_fma_f32 v[80:81], v[38:39], v[70:71], v[80:81]
    v_pk_add_f32 v[76:77], v[76:77], v[40:41]
    v_pk_fma_f32 v[78:79], v[40:41], v[40:41], v[78:79]
    v_pk_fma_f32 v[80:81], v[40:41], v[72:73], v[80:81]
    v_pk_add_f32 v[76:77], v[76:77], v[42:43]
    v_pk_fma_f32 v[78:79], v[42:43], v[42:43], v[78:79]
    v_pk_fma_f32 v[80:81], v[42:43], v[74:75], v[80:81]
    v_add_f32 v96, v76, v77
    v_add_f32 v97, v78, v79
    v_add_f32 v98, v80, v81
    v_add_f32_dpp v96, v96, v96 row_ror:1 row_mask:0xf bank_mask:0xf
    v_add_f32_dpp v97, v97, v97 row_ror:1 row_mask:0xf bank_mask:0xf
    v_add_f32_dpp v98, v98, v98 row_ror:1 row_mask:0xf bank_mask:0xf
    v_add_f32_dpp v96, v96, v96 row_ror:2 row_mask:0xf bank_mask:0xf
    v_add_f32_dpp v97, v97, v97 row_ror:2 row_mask:0xf bank_mask:0xf
    v_add_f32_dpp v98, v98, v98 row_ror:2 row_mask:0xf bank_mask:0xf
    v_add_f32_dpp v96, v96, v96 row_ror:4 row_mask:0xf bank_mask:0xf
    v_add_f32_dpp v97, v97, v97 row_ror:4 row_mask:0xf bank_mask:0xf
    v_add_f32_dpp v98, v98, v98 row_ror:4 row_mask:0xf bank_mask:0xf
    v_add_f32_dpp v96, v96, v96 row_ror:8 row_mask:0xf bank_mask:0xf
    v_add_f32_dpp v97, v97, v97 row_ror:8 row_mask:0xf bank_mask:0xf
    v_add_f32_dpp v98, v98, v98 row_ror:8 row_mask:0xf bank_mask:0xf
    v_mov_b32 v76, v96
    s_nop 1
    v_permlane16_swap_b32 v96, v76
    v_add_f32 v96, v96, v76
    v_mov_b32 v77, v97
    s_nop 1
    v_permlane16_swap_b32 v97, v77
    v_add_f32 v97, v97, v77
    v_mov_b32 v78, v98
    s_nop 1
    v_permlane16_swap_b32 v98, v78
    v_add_f32 v98, v98, v78
    v_mov_b32 v76, v96
    s_nop 1
    v_permlane32_swap_b32 v96, v76
    v_add_f32 v96, v96, v76
    v_mov_b32 v77, v97
    s_nop 1
    v_permlane32_swap_b32 v97, v77
    v_add_f32 v97, v97, v77
    v_mov_b32 v78, v98
    s_nop 1
    v_permlane32_swap_b32 v98, v78
    v_add_f32 v98, v98, v78
    v_mul_f32 v96, 0x3a800000, v96
    v_mul_f32 v97, 0x3a800000, v97
    v_fma_f32 v97, -v96, v96, v97
    v_max_f32 v97, 0, v97
    v_fma_f32 v98, -v96, v95, v98
    v_add_f32 v76, 0x3727c5ac, v97
    v_rsq_f32 v76, v76
    s_nop 0
    v_fma_f32 v27, v98, v76, v94
    v_cvt_pk_bf16_f32 v96, v96, v96
    v_lshlrev_b32 v96, 16, v96
    v_cvt_pk_bf16_f32 v97, v97, v97
    v_lshlrev_b32 v97, 16, v97
    v_add_f32 v97, 0x3727c5ac, v97
    v_cvt_pk_bf16_f32 v97, v97, v97
    v_lshlrev_b32 v97, 16, v97
    v_sqrt_f32 v98, v97
    s_nop 0
    v_cvt_pk_bf16_f32 v98, v98, v98
    v_lshlrev_b32 v98, 16, v98
    v_rcp_f32 v99, v98
    v_mov_b32 v25, v96
    v_mov_b32 v26, v98
    v_ashrrev_i32 v16, 31, v27
    v_or_b32 v16, 0x80000000, v16
    v_xor_b32 v24, v27, v16
    v_and_b32 v24, 0xfffff800, v24
    v_max_u32 v24, 0x800, v24
    s_sub_u32 s16, 2047, s14
    v_or_b32 v24, s16, v24
    s_lshl_b32 s16, s3, 4
    s_add_u32 s16, s16, 65536
    v_mov_b32 v16, s16
    ds_write_b128 v16, v[24:27]
    s_waitcnt lgkmcnt(0)
    s_barrier
    v_and_b32 v16, 7, v1
    v_lshlrev_b32 v16, 4, v16
    v_add_u32 v16, 65536, v16
    ds_read_b32 v76, v16
    s_waitcnt lgkmcnt(0)
    v_mov_b32 v77, v76
    s_nop 1
    v_max_u32_dpp v77, v77, v77 row_ror:1 row_mask:0xf bank_mask:0xf
    s_nop 1
    v_max_u32_dpp v77, v77, v77 row_ror:2 row_mask:0xf bank_mask:0xf
    s_nop 1
    v_max_u32_dpp v77, v77, v77 row_ror:4 row_mask:0xf bank_mask:0xf
    v_cmp_eq_u32 vcc, v76, v77
    s_ff1_i32_b64 s16, vcc
    s_lshl_b32 s16, s16, 4
    s_add_u32 s16, s16, 65536
    v_mov_b32 v16, s16
    ds_read_b128 v[24:27], v16
    s_lshl_b32 s16, s2, 4
    s_add_u32 s16, s16, 0x6e0000
    s_cmp_eq_u32 s3, 0
    s_cselect_b32 s16, s16, 0x7ffffff0
    v_mov_b32 v17, 0
    s_mov_b64 exec, 1
    s_waitcnt lgkmcnt(0)
    buffer_store_dwordx4 v[24:27], v17, s[8:11], s16 offen sc1
    s_mov_b64 exec, -1
    v_sub_f32 v44, v28, v96
    v_sub_f32 v45, v29, v96
    v_sub_f32 v46, v30, v96
    v_sub_f32 v47, v31, v96
    v_sub_f32 v48, v32, v96
    v_sub_f32 v49, v33, v96
    v_sub_f32 v50, v34, v96
    v_sub_f32 v51, v35, v96
    v_cvt_pk_bf16_f32 v16, v44, v45
    v_lshlrev_b32 v44, 16, v16
    v_and_b32 v45, 0xffff0000, v16
    v_cvt_pk_bf16_f32 v16, v46, v47
    v_lshlrev_b32 v46, 16, v16
    v_and_b32 v47, 0xffff0000, v16
    v_cvt_pk_bf16_f32 v16, v48, v49
    v_lshlrev_b32 v48, 16, v16
    v_and_b32 v49, 0xffff0000, v16
    v_cvt_pk_bf16_f32 v16, v50, v51
    v_lshlrev_b32 v50, 16, v16
    v_and_b32 v51, 0xffff0000, v16
    v_mul_f32 v52, v44, v99
    v_mul_f32 v53, v45, v99
    v_mul_f32 v54, v46, v99
    v_mul_f32 v55, v47, v99
    v_mul_f32 v56, v48, v99
    v_mul_f32 v57, v49, v99
    v_mul_f32 v58, v50, v99
    v_mul_f32 v59, v51, v99
    v_fma_f32 v44, -v52, v98, v44
    v_fma_f32 v45, -v53, v98, v45
    v_fma_f32 v46, -v54, v98, v46
    v_fma_f32 v47, -v55, v98, v47
    v_fma_f32 v48, -v56, v98, v48
    v_fma_f32 v49, -v57, v98, v49
    v_fma_f32 v50, -v58, v98, v50
    v_fma_f32 v51, -v59, v98, v51
    v_fma_f32 v44, v44, v99, v52
    v_fma_f32 v45, v45, v99, v53
    v_fma_f32 v46, v46, v99, v54
    v_fma_f32 v47, v47, v99, v55
    v_fma_f32 v48, v48, v99, v56
    v_fma_f32 v49, v49, v99, v57
    v_fma_f32 v50, v50, v99, v58
    v_fma_f32 v51, v51, v99, v59
    v_cvt_pk_bf16_f32 v16, v44, v45
    v_lshlrev_b32 v44, 16, v16
    v_and_b32 v45, 0xffff0000, v16
    v_cvt_pk_bf16_f32 v16, v46, v47
    v_lshlrev_b32 v46, 16, v16
    v_and_b32 v47, 0xffff0000, v16
    v_cvt_pk_bf16_f32 v16, v48, v49
    v_lshlrev_b32 v48, 16, v16
    v_and_b32 v49, 0xffff0000, v16
    v_cvt_pk_bf16_f32 v16, v50, v51
    v_lshlrev_b32 v50, 16, v16
    v_and_b32 v51, 0xffff0000, v16
    v_lshlrev_b32 v52, 16, v192
    v_and_b32 v53, 0xffff0000, v192
    v_lshlrev_b32 v54, 16, v193
    v_and_b32 v55, 0xffff0000, v193
    v_lshlrev_b32 v56, 16, v194
    v_and_b32 v57, 0xffff0000, v194
    v_lshlrev_b32 v58, 16, v195
    v_and_b32 v59, 0xffff0000, v195
    v_pk_mul_f32 v[44:45], v[44:45], v[52:53]
    v_pk_mul_f32 v[46:47], v[46:47], v[54:55]
    v_pk_mul_f32 v[48:49], v[48:49], v[56:57]
    v_pk_mul_f32 v[50:51], v[50:51], v[58:59]
    v_cvt_pk_bf16_f32 v16, v44, v45
    v_lshlrev_b32 v44, 16, v16
    v_and_b32 v45, 0xffff0000, v16
    v_cvt_pk_bf16_f32 v16, v46, v47
    v_lshlrev_b32 v46, 16, v16
    v_and_b32 v47, 0xffff0000, v16
    v_cvt_pk_bf16_f32 v16, v48, v49
    v_lshlrev_b32 v48, 16, v16
    v_and_b32 v49, 0xffff0000, v16
    v_cvt_pk_bf16_f32 v16, v50, v51
    v_lshlrev_b32 v50, 16, v16
    v_and_b32 v51, 0xffff0000, v16
    v_lshlrev_b32 v52, 16, v184
    v_and_b32 v53, 0xffff0000, v184
    v_lshlrev_b32 v54, 16, v185
    v_and_b32 v55, 0xffff0000, v185
    v_lshlrev_b32 v56, 16, v186
    v_and_b32 v57, 0xffff0000, v186
    v_lshlrev_b32 v58, 16, v187
    v_and_b32 v59, 0xffff0000, v187
    v_pk_add_f32 v[44:45], v[44:45], v[52:53]
    v_pk_add_f32 v[46:47], v[46:47], v[54:55]
    v_pk_add_f32 v[48:49], v[48:49], v[56:57]
    v_pk_add_f32 v[50:51], v[50:51], v[58:59]
    v_cvt_pk_bf16_f32 v16, v44, v45
    v_lshlrev_b32 v44, 16, v16
    v_and_b32 v45, 0xffff0000, v16
    v_cvt_pk_bf16_f32 v16, v46, v47
    v_lshlrev_b32 v46, 16, v16
    v_and_b32 v47, 0xffff0000, v16
    v_cvt_pk_bf16_f32 v16, v48, v49
    v_lshlrev_b32 v48, 16, v16
    v_and_b32 v49, 0xffff0000, v16
    v_cvt_pk_bf16_f32 v16, v50, v51
    v_lshlrev_b32 v50, 16, v16
    v_and_b32 v51, 0xffff0000, v16
    v_lshlrev_b32 v52, 16, v200
    v_and_b32 v53, 0xffff0000, v200
    v_lshlrev_b32 v54, 16, v201
    v_and_b32 v55, 0xffff0000, v201
    v_lshlrev_b32 v56, 16, v202
    v_and_b32 v57, 0xffff0000, v202
    v_lshlrev_b32 v58, 16, v203
    v_and_b32 v59, 0xffff0000, v203
    v_pk_mul_f32 v[44:45], v[44:45], v[52:53]
    v_pk_mul_f32 v[46:47], v[46:47], v[54:55]
    v_pk_mul_f32 v[48:49], v[48:49], v[56:57]
    v_pk_mul_f32 v[50:51], v[50:51], v[58:59]
    v_cvt_pk_bf16_f32 v16, v44, v45
    v_lshlrev_b32 v44, 16, v16
    v_and_b32 v45, 0xffff0000, v16
    v_cvt_pk_bf16_f32 v16, v46, v47
    v_lshlrev_b32 v46, 16, v16
    v_and_b32 v47, 0xffff0000, v16
    v_cvt_pk_bf16_f32 v16, v48, v49
    v_lshlrev_b32 v48, 16, v16
    v_and_b32 v49, 0xffff0000, v16
    v_cvt_pk_bf16_f32 v16, v50, v51
    v_lshlrev_b32 v50, 16, v16
    v_and_b32 v51, 0xffff0000, v16
    v_pk_add_f32 v[44:45], v[44:45], v[28:29]
    v_pk_add_f32 v[46:47], v[46:47], v[30:31]
    v_pk_add_f32 v[48:49], v[48:49], v[32:33]
    v_pk_add_f32 v[50:51], v[50:51], v[34:35]
    v_cvt_pk_bf16_f32 v28, v44, v45
    v_cvt_pk_bf16_f32 v29, v46, v47
    v_cvt_pk_bf16_f32 v30, v48, v49
    v_cvt_pk_bf16_f32 v31, v50, v51
    v_sub_f32 v44, v36, v96
    v_sub_f32 v45, v37, v96
    v_sub_f32 v46, v38, v96
    v_sub_f32 v47, v39, v96
    v_sub_f32 v48, v40, v96
    v_sub_f32 v49, v41, v96
    v_sub_f32 v50, v42, v96
    v_sub_f32 v51, v43, v96
    v_cvt_pk_bf16_f32 v16, v44, v45
    v_lshlrev_b32 v44, 16, v16
    v_and_b32 v45, 0xffff0000, v16
    v_cvt_pk_bf16_f32 v16, v46, v47
    v_lshlrev_b32 v46, 16, v16
    v_and_b32 v47, 0xffff0000, v16
    v_cvt_pk_bf16_f32 v16, v48, v49
    v_lshlrev_b32 v48, 16, v16
    v_and_b32 v49, 0xffff0000, v16
    v_cvt_pk_bf16_f32 v16, v50, v51
    v_lshlrev_b32 v50, 16, v16
    v_and_b32 v51, 0xffff0000, v16
    v_mul_f32 v52, v44, v99
    v_mul_f32 v53, v45, v99
    v_mul_f32 v54, v46, v99
    v_mul_f32 v55, v47, v99
    v_mul_f32 v56, v48, v99
    v_mul_f32 v57, v49, v99
    v_mul_f32 v58, v50, v99
    v_mul_f32 v59, v51, v99
    v_fma_f32 v44, -v52, v98, v44
    v_fma_f32 v45, -v53, v98, v45
    v_fma_f32 v46, -v54, v98, v46
    v_fma_f32 v47, -v55, v98, v47
    v_fma_f32 v48, -v56, v98, v48
    v_fma_f32 v49, -v57, v98, v49
    v_fma_f32 v50, -v58, v98, v50
    v_fma_f32 v51, -v59, v98, v51
    v_fma_f32 v44, v44, v99, v52
    v_fma_f32 v45, v45, v99, v53
    v_fma_f32 v46, v46, v99, v54
    v_fma_f32 v47, v47, v99, v55
    v_fma_f32 v48, v48, v99, v56
    v_fma_f32 v49, v49, v99, v57
    v_fma_f32 v50, v50, v99, v58
    v_fma_f32 v51, v51, v99, v59
    v_cvt_pk_bf16_f32 v16, v44, v45
    v_lshlrev_b32 v44, 16, v16
    v_and_b32 v45, 0xffff0000, v16
    v_cvt_pk_bf16_f32 v16, v46, v47
    v_lshlrev_b32 v46, 16, v16
    v_and_b32 v47, 0xffff0000, v16
    v_cvt_pk_bf16_f32 v16, v48, v49
    v_lshlrev_b32 v48, 16, v16
    v_and_b32 v49, 0xffff0000, v16
    v_cvt_pk_bf16_f32 v16, v50, v51
    v_lshlrev_b32 v50, 16, v16
    v_and_b32 v51, 0xffff0000, v16
    v_lshlrev_b32 v52, 16, v196
    v_and_b32 v53, 0xffff0000, v196
    v_lshlrev_b32 v54, 16, v197
    v_and_b32 v55, 0xffff0000, v197
    v_lshlrev_b32 v56, 16, v198
    v_and_b32 v57, 0xffff0000, v198
    v_lshlrev_b32 v58, 16, v199
    v_and_b32 v59, 0xffff0000, v199
    v_pk_mul_f32 v[44:45], v[44:45], v[52:53]
    v_pk_mul_f32 v[46:47], v[46:47], v[54:55]
    v_pk_mul_f32 v[48:49], v[48:49], v[56:57]
    v_pk_mul_f32 v[50:51], v[50:51], v[58:59]
    v_cvt_pk_bf16_f32 v16, v44, v45
    v_lshlrev_b32 v44, 16, v16
    v_and_b32 v45, 0xffff0000, v16
    v_cvt_pk_bf16_f32 v16, v46, v47
    v_lshlrev_b32 v46, 16, v16
    v_and_b32 v47, 0xffff0000, v16
    v_cvt_pk_bf16_f32 v16, v48, v49
    v_lshlrev_b32 v48, 16, v16
    v_and_b32 v49, 0xffff0000, v16
    v_cvt_pk_bf16_f32 v16, v50, v51
    v_lshlrev_b32 v50, 16, v16
    v_and_b32 v51, 0xffff0000, v16
    v_lshlrev_b32 v52, 16, v188
    v_and_b32 v53, 0xffff0000, v188
    v_lshlrev_b32 v54, 16, v189
    v_and_b32 v55, 0xffff0000, v189
    v_lshlrev_b32 v56, 16, v190
    v_and_b32 v57, 0xffff0000, v190
    v_lshlrev_b32 v58, 16, v191
    v_and_b32 v59, 0xffff0000, v191
    v_pk_add_f32 v[44:45], v[44:45], v[52:53]
    v_pk_add_f32 v[46:47], v[46:47], v[54:55]
    v_pk_add_f32 v[48:49], v[48:49], v[56:57]
    v_pk_add_f32 v[50:51], v[50:51], v[58:59]
    v_cvt_pk_bf16_f32 v16, v44, v45
    v_lshlrev_b32 v44, 16, v16
    v_and_b32 v45, 0xffff0000, v16
    v_cvt_pk_bf16_f32 v16, v46, v47
    v_lshlrev_b32 v46, 16, v16
    v_and_b32 v47, 0xffff0000, v16
    v_cvt_pk_bf16_f32 v16, v48, v49
    v_lshlrev_b32 v48, 16, v16
    v_and_b32 v49, 0xffff0000, v16
    v_cvt_pk_bf16_f32 v16, v50, v51
    v_lshlrev_b32 v50, 16, v16
    v_and_b32 v51, 0xffff0000, v16
    v_lshlrev_b32 v52, 16, v204
    v_and_b32 v53, 0xffff0000, v204
    v_lshlrev_b32 v54, 16, v205
    v_and_b32 v55, 0xffff0000, v205
    v_lshlrev_b32 v56, 16, v206
    v_and_b32 v57, 0xffff0000, v206
    v_lshlrev_b32 v58, 16, v207
    v_and_b32 v59, 0xffff0000, v207
    v_pk_mul_f32 v[44:45], v[44:45], v[52:53]
    v_pk_mul_f32 v[46:47], v[46:47], v[54:55]
    v_pk_mul_f32 v[48:49], v[48:49], v[56:57]
    v_pk_mul_f32 v[50:51], v[50:51], v[58:59]
    v_cvt_pk_bf16_f32 v16, v44, v45
    v_lshlrev_b32 v44, 16, v16
    v_and_b32 v45, 0xffff0000, v16
    v_cvt_pk_bf16_f32 v16, v46, v47
    v_lshlrev_b32 v46, 16, v16
    v_and_b32 v47, 0xffff0000, v16
    v_cvt_pk_bf16_f32 v16, v48, v49
    v_lshlrev_b32 v48, 16, v16
    v_and_b32 v49, 0xffff0000, v16
    v_cvt_pk_bf16_f32 v16, v50, v51
    v_lshlrev_b32 v50, 16, v16
    v_and_b32 v51, 0xffff0000, v16
    v_pk_add_f32 v[44:45], v[44:45], v[36:37]
    v_pk_add_f32 v[46:47], v[46:47], v[38:39]
    v_pk_add_f32 v[48:49], v[48:49], v[40:41]
    v_pk_add_f32 v[50:51], v[50:51], v[42:43]
    v_cvt_pk_bf16_f32 v36, v44, v45
    v_cvt_pk_bf16_f32 v37, v46, v47
    v_cvt_pk_bf16_f32 v38, v48, v49
    v_cvt_pk_bf16_f32 v39, v50, v51
    v_lshlrev_b32 v18, 4, v0
    s_mov_b32 s16, 0x6e0000
    s_mov_b32 s27, 0
adaLN_cond__sliding_block_cached__moe_arch_mod__prompt_kernel_w12p:
    buffer_load_dwordx4 v[24:27], v18, s[8:11], s16 offen sc1
    s_waitcnt vmcnt(0)
    v_cmp_eq_u32 vcc, 0, v24
    s_add_u32 s27, s27, 1
    s_cmp_ge_u32 s27, 65536
    s_cbranch_scc1 adaLN_cond__sliding_block_cached__moe_arch_mod__prompt_kernel_w12g
    s_cbranch_vccnz adaLN_cond__sliding_block_cached__moe_arch_mod__prompt_kernel_w12p
adaLN_cond__sliding_block_cached__moe_arch_mod__prompt_kernel_w12g:
    v_mov_b32 v76, v24
    s_nop 1
    v_max_u32_dpp v76, v76, v76 row_ror:1 row_mask:0xf bank_mask:0xf
    s_nop 1
    v_max_u32_dpp v76, v76, v76 row_ror:2 row_mask:0xf bank_mask:0xf
    s_nop 1
    v_max_u32_dpp v76, v76, v76 row_ror:4 row_mask:0xf bank_mask:0xf
    s_nop 1
    v_max_u32_dpp v76, v76, v76 row_ror:8 row_mask:0xf bank_mask:0xf
    v_mov_b32 v77, v76
    s_nop 1
    v_permlane16_swap_b32 v76, v77
    v_max_u32 v76, v76, v77
    v_mov_b32 v77, v76
    s_nop 1
    v_permlane32_swap_b32 v76, v77
    v_max_u32 v76, v76, v77
    v_cmp_eq_u32 vcc, v76, v24
    s_lshl_b32 s16, s3, 4
    s_add_u32 s16, s16, 65792
    v_mov_b32 v16, s16
    s_and_saveexec_b64 s[62:63], vcc
    ds_write_b128 v16, v[24:27]
    s_mov_b64 exec, s[62:63]
    s_waitcnt lgkmcnt(0)
    s_barrier
    v_and_b32 v16, 3, v1
    v_lshlrev_b32 v16, 4, v16
    v_add_u32 v16, 65792, v16
    ds_read_b32 v76, v16
    s_waitcnt lgkmcnt(0)
    v_mov_b32 v77, v76
    s_nop 1
    v_max_u32_dpp v77, v77, v77 row_ror:1 row_mask:0xf bank_mask:0xf
    s_nop 1
    v_max_u32_dpp v77, v77, v77 row_ror:2 row_mask:0xf bank_mask:0xf
    v_cmp_eq_u32 vcc, v76, v77
    s_ff1_i32_b64 s16, vcc
    s_lshl_b32 s16, s16, 4
    s_add_u32 s16, s16, 65792
    v_mov_b32 v16, s16
    ds_read_b128 v[24:27], v16
    s_waitcnt lgkmcnt(0)
    v_and_b32 v76, 0x7ff, v24
    v_sub_u32 v76, 2047, v76
    s_nop 0
    v_readfirstlane_b32 s12, v76
    v_rcp_f32 v103, v26
    s_lshr_b32 s18, s12, 4
    s_lshl_b32 s18, s18, 15
    s_and_b32 s19, s12, 15
    s_lshl_b32 s19, s19, 6
    s_add_u32 s18, s18, s19
    s_add_u32 s18, s18, 0x2c00000
    s_add_u32 s19, s18, 0x400000
    v_lshrrev_b32 v18, 4, v0
    v_lshlrev_b32 v18, 10, v18
    v_and_b32 v19, 15, v0
    v_lshl_add_u32 v18, v19, 2, v18
    s_lshl_b32 s13, s12, 11
    buffer_load_dword v100, v18, s[8:11], s18 offen sc1
    buffer_load_dword v101, v18, s[8:11], s19 offen sc1
    buffer_load_dword v102, v21, s[76:79], s13 offen
    s_lshl_b32 s16, s14, 11
    s_cmp_lg_u32 s12, s14
    s_cselect_b32 s16, s16, 0x7ffffff0
    buffer_store_dwordx4 v[28:31], v2, s[68:71], s16 offen offset:0 sc1
    buffer_store_dwordx4 v[36:39], v2, s[68:71], s16 offen offset:1024 sc1
    s_lshl_b32 s16, s3, 13
    v_add_u32 v20, s16, v2
    s_waitcnt vmcnt(4)
    v_lshlrev_b32 v76, 16, v100
    v_and_b32 v77, 0xffff0000, v100
    s_waitcnt vmcnt(3)
    v_lshlrev_b32 v78, 16, v101
    v_and_b32 v79, 0xffff0000, v101
    v_pk_add_f32 v[76:77], v[76:77], v[78:79]
    s_waitcnt vmcnt(2)
    v_lshlrev_b32 v78, 16, v102
    v_and_b32 v79, 0xffff0000, v102
    v_pk_add_f32 v[92:93], v[78:79], v[76:77]
    v_cvt_pk_bf16_f32 v76, v92, v93
    v_lshlrev_b32 v92, 16, v76
    v_and_b32 v93, 0xffff0000, v76
    v_cvt_pk_bf16_f32 v100, v92, v93
    v_and_b32 v105, 0xffff0000, v104
    v_lshlrev_b32 v104, 16, v104
    v_and_b32 v107, 0xffff0000, v106
    v_lshlrev_b32 v106, 16, v106
    v_sub_f32 v92, v92, v25
    v_sub_f32 v93, v93, v25
    v_cvt_pk_bf16_f32 v76, v92, v93
    v_lshlrev_b32 v92, 16, v76
    v_and_b32 v93, 0xffff0000, v76
    v_mul_f32 v77, v92, v103
    v_fma_f32 v92, -v77, v26, v92
    v_fma_f32 v92, v92, v103, v77
    v_mul_f32 v77, v93, v103
    v_fma_f32 v93, -v77, v26, v93
    v_fma_f32 v93, v93, v103, v77
    v_cvt_pk_bf16_f32 v76, v92, v93
    v_lshlrev_b32 v92, 16, v76
    v_and_b32 v93, 0xffff0000, v76
    v_mul_f32 v92, v92, v104
    v_mul_f32 v93, v93, v105
    v_cvt_pk_bf16_f32 v76, v92, v93
    v_lshlrev_b32 v92, 16, v76
    v_and_b32 v93, 0xffff0000, v76
    v_add_f32 v92, v92, v106
    v_add_f32 v93, v93, v107
    v_cvt_pk_bf16_f32 v101, v92, v93
    v_add_u32 v16, 66560, v21
    ds_write_b32 v16, v101
    ds_write_b32 v16, v100 offset:2048
    s_waitcnt lgkmcnt(0)
    s_barrier
    ds_read_b128 v[60:63], v20 offset:0
    ds_read_b128 v[64:67], v20 offset:1024
    ds_read_b128 v[68:71], v20 offset:2048
    ds_read_b128 v[72:75], v20 offset:3072
    ds_read_b128 v[108:111], v20 offset:4096
    ds_read_b128 v[112:115], v20 offset:5120
    ds_read_b128 v[116:119], v20 offset:6144
    ds_read_b128 v[120:123], v20 offset:7168
    s_and_b32 s16, s3, 3
    s_lshl_b32 s16, s16, 7
    s_and_b32 s17, s29, 3
    s_lshl_b32 s17, s17, 9
    s_add_u32 s16, s16, s17
    s_add_u32 s16, s16, 66560
    v_lshrrev_b32 v16, 3, v1
    v_lshlrev_b32 v16, 4, v16
    v_add_u32 v16, s16, v16
    ds_read_b128 v[104:107], v16
    s_waitcnt lgkmcnt(0)
    v_lshlrev_b32 v76, 16, v104
    v_and_b32 v77, 0xffff, v104
    v_dot2_f32_bf16 v85, v60, v76, 0
    v_dot2_f32_bf16 v84, v60, v77, 0
    v_dot2_f32_bf16 v87, v61, v76, 0
    v_dot2_f32_bf16 v86, v61, v77, 0
    v_dot2_f32_bf16 v89, v62, v76, 0
    v_dot2_f32_bf16 v88, v62, v77, 0
    v_dot2_f32_bf16 v91, v63, v76, 0
    v_dot2_f32_bf16 v90, v63, v77, 0
    v_and_b32 v78, 0xffff0000, v104
    v_lshrrev_b32 v79, 16, v104
    v_dot2c_f32_bf16 v85, v64, v78
    v_dot2c_f32_bf16 v84, v64, v79
    v_dot2c_f32_bf16 v87, v65, v78
    v_dot2c_f32_bf16 v86, v65, v79
    v_dot2c_f32_bf16 v89, v66, v78
    v_dot2c_f32_bf16 v88, v66, v79
    v_dot2c_f32_bf16 v91, v67, v78
    v_dot2c_f32_bf16 v90, v67, v79
    v_lshlrev_b32 v80, 16, v105
    v_and_b32 v81, 0xffff, v105
    v_dot2c_f32_bf16 v85, v68, v80
    v_dot2c_f32_bf16 v84, v68, v81
    v_dot2c_f32_bf16 v87, v69, v80
    v_dot2c_f32_bf16 v86, v69, v81
    v_dot2c_f32_bf16 v89, v70, v80
    v_dot2c_f32_bf16 v88, v70, v81
    v_dot2c_f32_bf16 v91, v71, v80
    v_dot2c_f32_bf16 v90, v71, v81
    v_and_b32 v82, 0xffff0000, v105
    v_lshrrev_b32 v83, 16, v105
    v_dot2c_f32_bf16 v85, v72, v82
    v_dot2c_f32_bf16 v84, v72, v83
    v_dot2c_f32_bf16 v87, v73, v82
    v_dot2c_f32_bf16 v86, v73, v83
    v_dot2c_f32_bf16 v89, v74, v82
    v_dot2c_f32_bf16 v88, v74, v83
    v_dot2c_f32_bf16 v91, v75, v82
    v_dot2c_f32_bf16 v90, v75, v83
    v_lshlrev_b32 v76, 16, v106
    v_and_b32 v77, 0xffff, v106
    v_dot2c_f32_bf16 v85, v108, v76
    v_dot2c_f32_bf16 v84, v108, v77
    v_dot2c_f32_bf16 v87, v109, v76
    v_dot2c_f32_bf16 v86, v109, v77
    v_dot2c_f32_bf16 v89, v110, v76
    v_dot2c_f32_bf16 v88, v110, v77
    v_dot2c_f32_bf16 v91, v111, v76
    v_dot2c_f32_bf16 v90, v111, v77
    v_and_b32 v78, 0xffff0000, v106
    v_lshrrev_b32 v79, 16, v106
    v_dot2c_f32_bf16 v85, v112, v78
    v_dot2c_f32_bf16 v84, v112, v79
    v_dot2c_f32_bf16 v87, v113, v78
    v_dot2c_f32_bf16 v86, v113, v79
    v_dot2c_f32_bf16 v89, v114, v78
    v_dot2c_f32_bf16 v88, v114, v79
    v_dot2c_f32_bf16 v91, v115, v78
    v_dot2c_f32_bf16 v90, v115, v79
    v_lshlrev_b32 v80, 16, v107
    v_and_b32 v81, 0xffff, v107
    v_dot2c_f32_bf16 v85, v116, v80
    v_dot2c_f32_bf16 v84, v116, v81
    v_dot2c_f32_bf16 v87, v117, v80
    v_dot2c_f32_bf16 v86, v117, v81
    v_dot2c_f32_bf16 v89, v118, v80
    v_dot2c_f32_bf16 v88, v118, v81
    v_dot2c_f32_bf16 v91, v119, v80
    v_dot2c_f32_bf16 v90, v119, v81
    v_and_b32 v82, 0xffff0000, v107
    v_lshrrev_b32 v83, 16, v107
    v_dot2c_f32_bf16 v85, v120, v82
    v_dot2c_f32_bf16 v84, v120, v83
    v_dot2c_f32_bf16 v87, v121, v82
    v_dot2c_f32_bf16 v86, v121, v83
    v_dot2c_f32_bf16 v89, v122, v82
    v_dot2c_f32_bf16 v88, v122, v83
    v_dot2c_f32_bf16 v91, v123, v82
    v_dot2c_f32_bf16 v90, v123, v83
    s_nop 0
    v_permlane32_swap_b32 v84, v88
    v_permlane32_swap_b32 v85, v89
    v_permlane32_swap_b32 v86, v90
    v_permlane32_swap_b32 v87, v91
    v_add_f32 v84, v84, v88
    v_add_f32 v85, v85, v89
    v_add_f32 v86, v86, v90
    v_add_f32 v87, v87, v91
    s_nop 0
    v_permlane16_swap_b32 v84, v86
    v_permlane16_swap_b32 v85, v87
    v_add_f32 v84, v84, v86
    v_add_f32 v85, v85, v87
    s_nop 0
    v_add_f32_dpp v84, v84, v84 row_ror:8 row_mask:0xf bank_mask:0xf
    v_add_f32_dpp v85, v85, v85 row_ror:8 row_mask:0xf bank_mask:0xf
    v_and_b32 v16, 7, v1
    v_lshlrev_b32 v16, 5, v16
    v_lshrrev_b32 v17, 4, v1
    v_lshl_add_u32 v16, v17, 3, v16
    s_lshl_b32 s16, s3, 8
    s_add_u32 s16, s16, 70656
    v_add_u32 v16, s16, v16
    ds_write_b64 v16, v[84:85]
    s_lshr_b32 s16, s3, 2
    s_lshl_b32 s17, s16, 10
    s_add_u32 s17, s17, 70656
    v_lshlrev_b32 v17, 2, v1
    v_add_u32 v16, s17, v17
    s_and_b32 s17, s29, 3
    s_lshl_b32 s17, s17, 1
    s_add_u32 s17, s17, s16
    s_mul_i32 s17, s17, 14336
    s_lshr_b32 s16, s29, 2
    s_lshl_b32 s16, s16, 8
    s_add_u32 s17, s17, s16
    s_add_u32 s17, s17, 0x6e1000
    s_and_b32 s16, s3, 3
    s_cmp_eq_u32 s16, 0
    s_cselect_b32 s17, s17, 0x7ffffff0
    s_cmp_lt_u32 s2, 224
    s_cselect_b32 s17, s17, 0x7ffffff0
    s_waitcnt lgkmcnt(0)
    s_barrier
    ds_read_b32 v84, v16 offset:0
    ds_read_b32 v85, v16 offset:256
    ds_read_b32 v86, v16 offset:512
    ds_read_b32 v87, v16 offset:768
    s_waitcnt lgkmcnt(2)
    v_add_f32 v84, v84, v85
    s_waitcnt lgkmcnt(0)
    v_add_f32 v86, v86, v87
    v_add_f32 v84, v84, v86
    v_or_b32 v84, 1, v84
    buffer_store_dword v84, v17, s[8:11], s17 offen sc1
    s_barrier
    v_lshlrev_b32 v16, 3, v0
    v_add_u32 v17, 73728, v16
    ds_read_b64 v[84:85], v17 offset:0
    ds_read_b64 v[86:87], v17 offset:4096
    ds_read_b64 v[88:89], v17 offset:8192
    ds_read_b64 v[90:91], v17 offset:12288
    s_waitcnt lgkmcnt(2)
    v_pk_add_f32 v[84:85], v[84:85], v[86:87]
    s_waitcnt lgkmcnt(0)
    v_pk_add_f32 v[88:89], v[88:89], v[90:91]
    v_pk_add_f32 v[84:85], v[84:85], v[88:89]
    v_or_b32 v84, 1, v84
    v_or_b32 v85, 1, v85
    s_lshl_b32 s16, s29, 12
    s_add_u32 s16, s16, 0x600000
    s_cmp_lt_u32 s2, 224
    s_cselect_b32 s16, s16, 0x7ffffff0
    buffer_store_dwordx2 v[84:85], v16, s[8:11], s16 offen sc1
    s_cmp_lt_u32 s2, 224
    s_cbranch_scc1 adaLN_cond__sliding_block_cached__moe_arch_mod__prompt_kernel_end
    s_sub_u32 s16, s2, 224
    s_lshl_b32 s17, s16, 7
    s_add_u32 s17, s17, 0x600000
    v_lshrrev_b32 v16, 3, v0
    v_lshlrev_b32 v16, 12, v16
    v_and_b32 v17, 7, v0
    v_lshl_add_u32 v16, v17, 4, v16
    v_cmp_gt_u32 vcc, 256, v0
    v_bfrev_b32 v17, -2
    s_nop 0
    v_cndmask_b32 v17, v17, v16, vcc
    v_mov_b32 v19, 0
    v_cndmask_b32 v18, 1, v19, vcc
    s_lshl_b32 s18, s16, 6
    v_and_b32 v19, 31, v1
    v_lshlrev_b32 v19, 1, v19
    v_add_u32 v19, s18, v19
    s_mov_b32 s19, 0x541800
    buffer_load_ushort v95, v19, s[8:11], s19 offen sc1
    v_add_u32 v20, 66560, v19
    ds_read_u16 v96, v20
    ds_read_u16 v97, v20 offset:2048
    v_mov_b32 v94, v27
    v_cvt_pk_bf16_f32 v94, v94, v94
    v_lshlrev_b32 v94, 16, v94
    v_mul_f32 v94, 0xbfb8aa3b, v94
    v_exp_f32 v94, v94
    s_nop 0
    v_add_f32 v94, 1.0, v94
    v_rcp_f32 v94, v94
    s_nop 0
    v_cvt_pk_bf16_f32 v94, v94, v94
    v_lshlrev_b32 v94, 16, v94
    s_waitcnt vmcnt(0)
    v_lshlrev_b32 v95, 16, v95
    s_waitcnt lgkmcnt(1)
    v_lshlrev_b32 v96, 16, v96
    s_waitcnt lgkmcnt(0)
    v_lshlrev_b32 v97, 16, v97
    s_mov_b32 s27, 0
adaLN_cond__sliding_block_cached__moe_arch_mod__prompt_kernel_y13p:
    s_add_u32 s19, s17, 0x0
    buffer_load_dwordx4 v[44:47], v16, s[8:11], s19 offen sc1
    s_add_u32 s19, s17, 0x40000
    buffer_load_dwordx4 v[48:51], v16, s[8:11], s19 offen sc1
    s_add_u32 s19, s17, 0x80000
    buffer_load_dwordx4 v[52:55], v16, s[8:11], s19 offen sc1
    s_add_u32 s19, s17, 0xc0000
    buffer_load_dwordx4 v[56:59], v17, s[8:11], s19 offen sc1
    s_waitcnt vmcnt(0)
    v_min3_u32 v98, v56, v57, v58
    v_min_u32 v98, v98, v59
    v_or_b32 v98, v98, v18
    v_min3_u32 v98, v98, v44, v45
    v_min3_u32 v98, v98, v46, v47
    v_min3_u32 v98, v98, v48, v49
    v_min3_u32 v98, v98, v50, v51
    v_min3_u32 v98, v98, v52, v53
    v_min3_u32 v98, v98, v54, v55
    v_cmp_eq_u32 vcc, 0, v98
    s_add_u32 s27, s27, 1
    s_cmp_ge_u32 s27, 65536
    s_cbranch_scc1 adaLN_cond__sliding_block_cached__moe_arch_mod__prompt_kernel_y13g
    s_cbranch_vccnz adaLN_cond__sliding_block_cached__moe_arch_mod__prompt_kernel_y13p
adaLN_cond__sliding_block_cached__moe_arch_mod__prompt_kernel_y13g:
    v_pk_add_f32 v[44:45], v[44:45], v[52:53]
    v_pk_add_f32 v[46:47], v[46:47], v[54:55]
    v_pk_add_f32 v[48:49], v[48:49], v[56:57]
    v_pk_add_f32 v[50:51], v[50:51], v[58:59]
    v_pk_add_f32 v[44:45], v[44:45], v[48:49]
    v_pk_add_f32 v[46:47], v[46:47], v[50:51]
    s_nop 0
    v_add_f32_dpp v44, v44, v44 row_ror:8 row_mask:0xf bank_mask:0xf
    v_add_f32_dpp v45, v45, v45 row_ror:8 row_mask:0xf bank_mask:0xf
    v_add_f32_dpp v46, v46, v46 row_ror:8 row_mask:0xf bank_mask:0xf
    v_add_f32_dpp v47, v47, v47 row_ror:8 row_mask:0xf bank_mask:0xf
    s_nop 0
    v_permlane32_swap_b32 v44, v46
    v_permlane32_swap_b32 v45, v47
    v_add_f32 v44, v44, v46
    v_add_f32 v45, v45, v47
    s_nop 1
    v_permlane16_swap_b32 v44, v45
    v_add_f32 v44, v44, v45
    v_and_b32 v16, 7, v1
    v_lshlrev_b32 v16, 4, v16
    v_lshrrev_b32 v17, 4, v1
    v_lshl_add_u32 v16, v17, 2, v16
    s_lshl_b32 s19, s3, 7
    s_add_u32 s19, s19, 91136
    v_add_u32 v16, s19, v16
    ds_write_b32 v16, v44
    v_and_b32 v16, 31, v1
    v_lshlrev_b32 v16, 2, v16
    v_add_u32 v16, 91136, v16
    s_waitcnt lgkmcnt(0)
    s_barrier
    s_cmp_lg_u32 s3, 0
    s_cbranch_scc1 adaLN_cond__sliding_block_cached__moe_arch_mod__prompt_kernel_end
    ds_read_b32 v44, v16 offset:0
    ds_read_b32 v45, v16 offset:128
    ds_read_b32 v46, v16 offset:256
    ds_read_b32 v47, v16 offset:384
    ds_read_b32 v48, v16 offset:512
    ds_read_b32 v49, v16 offset:640
    ds_read_b32 v50, v16 offset:768
    ds_read_b32 v51, v16 offset:896
    s_waitcnt lgkmcnt(3)
    v_add_f32 v44, v44, v48
    s_waitcnt lgkmcnt(2)
    v_add_f32 v45, v45, v49
    s_waitcnt lgkmcnt(1)
    v_add_f32 v46, v46, v50
    s_waitcnt lgkmcnt(0)
    v_add_f32 v47, v47, v51
    v_add_f32 v44, v44, v46
    v_add_f32 v45, v45, v47
    v_add_f32 v44, v44, v45
    v_cvt_pk_bf16_f32 v44, v44, v44
    v_lshlrev_b32 v44, 16, v44
    v_mul_f32 v44, v44, v94
    v_cvt_pk_bf16_f32 v44, v44, v44
    v_lshlrev_b32 v44, 16, v44
    v_add_f32 v44, v44, v96
    v_cvt_pk_bf16_f32 v44, v44, v44
    v_lshlrev_b32 v44, 16, v44
    v_mul_f32 v44, v44, v95
    v_cvt_pk_bf16_f32 v44, v44, v44
    v_lshlrev_b32 v44, 16, v44
    v_add_f32 v44, v44, v97
    v_cvt_pk_bf16_f32 v44, v44, v44
    s_mov_b64 exec, 0xffffffff
    buffer_store_short v44, v19, s[68:71], s13 offen sc1
    s_branch adaLN_cond__sliding_block_cached__moe_arch_mod__prompt_kernel_end
adaLN_cond__sliding_block_cached__moe_arch_mod__prompt_kernel_roleB:
    v_mov_b32 v132, 0
    v_mov_b32 v133, 0
    v_lshrrev_b32 v16, 3, v0
    v_and_b32 v17, 7, v0
    v_mul_u32_u24 v135, 24576, v16
    v_lshl_add_u32 v135, v17, 4, v135
    v_lshlrev_b32 v136, 2, v16
    s_and_b32 s14, s2, 31
    s_lshr_b32 s15, s2, 5
    s_mul_i32 s26, s15, 1572864
    s_lshl_b32 s16, s14, 7
    s_add_u32 s26, s26, s16
    s_lshl_b32 s29, s15, 8
    v_lshlrev_b32 v137, 3, v0
    s_lshl_b32 s18, s2, 3
    s_add_u32 s18, s18, s3
    s_lshl_b32 s18, s18, 11
    v_and_b32 v18, 15, v1
    v_lshrrev_b32 v19, 4, v1
    v_lshlrev_b32 v138, 11, v18
    v_lshl_add_u32 v138, v19, 4, v138
    s_lshr_b32 s30, s2, 4
    s_and_b32 s31, s2, 15
    s_lshl_b32 s19, s30, 3
    s_add_u32 s19, s19, s3
    s_lshl_b32 s22, s19, 15
    s_lshl_b32 s23, s31, 7
    s_add_u32 s22, s22, s23
    s_lshl_b32 s23, s2, 12
    s_add_u32 s23, s23, 0x600000
    s_or_b32 s25, s2, s3
    s_cmp_eq_u32 s25, 0
    s_cselect_b32 s25, 0, 0x7ffffff0
    s_waitcnt lgkmcnt(0)
    s_mov_b64 s[64:65], s[58:59]
    s_mov_b32 s66, 0x100
    s_mov_b32 s67, 0x20000
    s_or_b32 s28, s62, 1
    v_mov_b32 v134, s28
    s_mov_b64 exec, 1
    buffer_store_dword v134, v132, s[64:67], s25 offen sc1
    s_mov_b64 exec, -1
    s_mov_b64 s[68:69], s[52:53]
    s_mov_b32 s70, 0x800
    s_mov_b32 s71, 0x20000
    s_mov_b64 s[72:73], s[54:55]
    s_mov_b32 s74, 0xc00000
    s_mov_b32 s75, 0x20000
    s_mov_b64 s[76:77], s[32:33]
    s_mov_b32 s78, 0x400000
    s_mov_b32 s79, 0x20000
    s_mov_b64 s[8:9], s[60:61]
    s_mov_b32 s10, 0x3400000
    s_mov_b32 s11, 0x20000
    buffer_load_dword v72, v136, s[68:71], s29 offen
    buffer_load_dwordx4 v[24:27], v135, s[72:75], s26 offen
    s_add_u32 s26, s26, 12288
    buffer_load_dwordx4 v[28:31], v135, s[72:75], s26 offen
    buffer_load_dwordx4 v[32:35], v2, s[76:79], s18 offen offset:0
    buffer_load_dwordx4 v[36:39], v2, s[76:79], s18 offen offset:1024
    buffer_store_dwordx2 v[132:133], v137, s[8:11], s23 offen sc1
    s_barrier
    buffer_load_dwordx4 v[40:43], v138, s[76:79], s22 offen offset:0
    buffer_load_dwordx4 v[44:47], v138, s[76:79], s22 offen offset:64
    s_mov_b32 s29, s19
    s_mov_b64 s[64:65], s[34:35]
    s_mov_b32 s66, 0x200000
    s_mov_b32 s67, 0x20000
    s_mov_b64 s[68:69], s[36:37]
    s_mov_b32 s70, 0x200000
    s_mov_b32 s71, 0x20000
    s_lshl_b32 s20, s2, 2
    s_add_u32 s20, s20, s3
    s_sub_u32 s20, s20, 4
    s_lshr_b32 s22, s20, 8
    s_bfe_u32 s23, s20, 0x40004
    s_and_b32 s24, s20, 15
    s_lshl_b32 s25, s22, 19
    s_lshl_b32 s26, s23, 13
    s_add_u32 s25, s25, s26
    s_add_u32 s25, s25, 393216
    v_and_b32 v16, 15, v1
    v_lshrrev_b32 v17, 4, v1
    s_lshl_b32 s21, s22, 17
    s_cmp_ge_u32 s24, 8
    s_cbranch_scc1 adaLN_cond__sliding_block_cached__moe_arch_mod__prompt_kernel_kvV
    v_lshlrev_b32 v18, 8, v16
    v_lshl_add_u32 v18, v17, 3, v18
    s_and_b32 s26, s24, 1
    s_lshl_b32 s26, s26, 12
    s_add_u32 s25, s25, s26
    s_lshr_b32 s26, s24, 1
    s_lshl_b32 s26, s26, 6
    s_add_u32 s25, s25, s26
    buffer_load_dwordx2 v[84:85], v18, s[64:67], s25 offen
    buffer_load_dwordx2 v[86:87], v18, s[64:67], s25 offen offset:32
    s_lshl_b32 s26, s23, 13
    s_add_u32 s21, s21, s26
    s_lshl_b32 s26, s24, 10
    s_add_u32 s21, s21, s26
    s_add_u32 s21, s21, 0x400000
    s_branch adaLN_cond__sliding_block_cached__moe_arch_mod__prompt_kernel_kvJ
adaLN_cond__sliding_block_cached__moe_arch_mod__prompt_kernel_kvV:
    s_bfe_u32 s26, s24, 0x20001
    s_lshl_b32 s26, s26, 6
    s_add_u32 s25, s25, s26
    s_and_b32 s26, s24, 1
    s_lshl_b32 s26, s26, 3
    s_add_u32 s25, s25, s26
    s_add_u32 s26, s25, 4096
    v_lshrrev_b32 v18, 2, v16
    v_lshlrev_b32 v18, 4, v18
    v_and_b32 v19, 3, v16
    v_lshl_add_u32 v18, v19, 1, v18
    v_lshl_add_u32 v18, v17, 10, v18
    buffer_load_ushort v88, v18, s[68:71], s25 offen offset:0
    buffer_load_ushort v89, v18, s[68:71], s25 offen offset:256
    buffer_load_ushort v90, v18, s[68:71], s25 offen offset:512
    buffer_load_ushort v91, v18, s[68:71], s25 offen offset:768
    buffer_load_ushort v92, v18, s[68:71], s26 offen offset:0
    buffer_load_ushort v93, v18, s[68:71], s26 offen offset:256
    buffer_load_ushort v94, v18, s[68:71], s26 offen offset:512
    buffer_load_ushort v95, v18, s[68:71], s26 offen offset:768
    s_bfe_u32 s26, s24, 0x20001
    s_lshl_b32 s26, s26, 15
    s_add_u32 s21, s21, s26
    s_lshl_b32 s26, s23, 11
    s_add_u32 s21, s21, s26
    s_and_b32 s26, s24, 1
    s_lshl_b32 s26, s26, 10
    s_add_u32 s21, s21, s26
    s_add_u32 s21, s21, 0x480000
adaLN_cond__sliding_block_cached__moe_arch_mod__prompt_kernel_kvJ:
    s_waitcnt vmcnt(9)
    v_and_b32 v73, 0xffff0000, v72
    v_lshlrev_b32 v72, 16, v72
    v_mul_f32 v16, 0xbfb8aa3b, v72
    v_exp_f32 v16, v16
    s_nop 0
    v_add_f32 v16, 1.0, v16
    v_rcp_f32 v16, v16
    s_nop 0
    v_mul_f32 v72, v72, v16
    v_mul_f32 v17, 0xbfb8aa3b, v73
    v_exp_f32 v17, v17
    s_nop 0
    v_add_f32 v17, 1.0, v17
    v_rcp_f32 v17, v17
    s_nop 0
    v_mul_f32 v73, v73, v17
    v_cvt_pk_bf16_f32 v16, v72, v73
    v_lshlrev_b32 v72, 16, v16
    v_and_b32 v73, 0xffff0000, v16
    s_lshl_b32 s16, s2, 8
    s_add_u32 s16, s16, 0x550000
    s_mov_b32 exec_lo, 0x01010101
    s_mov_b32 exec_hi, 0x01010101
    buffer_store_dword v16, v136, s[8:11], s16 offen sc1
    s_mov_b64 exec, -1
    v_lshrrev_b32 v74, 16, v72
    v_lshrrev_b32 v75, 16, v73
    s_waitcnt vmcnt(9)
    v_dot2_f32_bf16 v49, v24, v72, 0
    v_dot2_f32_bf16 v48, v24, v74, 0
    v_dot2_f32_bf16 v51, v25, v72, 0
    v_dot2_f32_bf16 v50, v25, v74, 0
    v_dot2_f32_bf16 v53, v26, v72, 0
    v_dot2_f32_bf16 v52, v26, v74, 0
    v_dot2_f32_bf16 v55, v27, v72, 0
    v_dot2_f32_bf16 v54, v27, v74, 0
    s_waitcnt vmcnt(8)
    v_dot2c_f32_bf16 v49, v28, v73
    v_dot2c_f32_bf16 v48, v28, v75
    v_dot2c_f32_bf16 v51, v29, v73
    v_dot2c_f32_bf16 v50, v29, v75
    v_dot2c_f32_bf16 v53, v30, v73
    v_dot2c_f32_bf16 v52, v30, v75
    v_dot2c_f32_bf16 v55, v31, v73
    v_dot2c_f32_bf16 v54, v31, v75
    s_nop 0
    v_permlane32_swap_b32 v48, v52
    v_permlane32_swap_b32 v49, v53
    v_permlane32_swap_b32 v50, v54
    v_permlane32_swap_b32 v51, v55
    v_add_f32 v48, v48, v52
    v_add_f32 v49, v49, v53
    v_add_f32 v50, v50, v54
    v_add_f32 v51, v51, v55
    s_nop 0
    v_permlane16_swap_b32 v48, v50
    v_permlane16_swap_b32 v49, v51
    v_add_f32 v48, v48, v50
    v_add_f32 v49, v49, v51
    s_nop 0
    v_add_f32_dpp v48, v48, v48 row_ror:8 row_mask:0xf bank_mask:0xf
    v_add_f32_dpp v49, v49, v49 row_ror:8 row_mask:0xf bank_mask:0xf
    v_and_b32 v16, 7, v1
    v_lshlrev_b32 v16, 5, v16
    v_lshrrev_b32 v17, 4, v1
    v_lshl_add_u32 v16, v17, 3, v16
    s_lshl_b32 s16, s3, 8
    s_add_u32 s16, s16, 65536
    v_add_u32 v16, s16, v16
    ds_write_b64 v16, v[48:49]
    s_waitcnt vmcnt(7)
    v_lshlrev_b32 v56, 16, v32
    v_and_b32 v57, 0xffff0000, v32
    v_lshlrev_b32 v58, 16, v33
    v_and_b32 v59, 0xffff0000, v33
    v_lshlrev_b32 v60, 16, v34
    v_and_b32 v61, 0xffff0000, v34
    v_lshlrev_b32 v62, 16, v35
    v_and_b32 v63, 0xffff0000, v35
    s_waitcnt vmcnt(6)
    v_lshlrev_b32 v64, 16, v36
    v_and_b32 v65, 0xffff0000, v36
    v_lshlrev_b32 v66, 16, v37
    v_and_b32 v67, 0xffff0000, v37
    v_lshlrev_b32 v68, 16, v38
    v_and_b32 v69, 0xffff0000, v38
    v_lshlrev_b32 v70, 16, v39
    v_and_b32 v71, 0xffff0000, v39
    v_add_f32 v20, v56, v57
    v_add_f32 v21, v58, v59
    v_add_f32 v20, v20, v60
    v_add_f32 v21, v21, v61
    v_add_f32 v20, v20, v62
    v_add_f32 v21, v21, v63
    v_add_f32 v20, v20, v64
    v_add_f32 v21, v21, v65
    v_add_f32 v20, v20, v66
    v_add_f32 v21, v21, v67
    v_add_f32 v20, v20, v68
    v_add_f32 v21, v21, v69
    v_add_f32 v20, v20, v70
    v_add_f32 v21, v21, v71
    v_add_f32 v128, v20, v21
    s_nop 1
    v_add_f32_dpp v128, v128, v128 row_ror:1 row_mask:0xf bank_mask:0xf
    s_nop 1
    v_add_f32_dpp v128, v128, v128 row_ror:2 row_mask:0xf bank_mask:0xf
    s_nop 1
    v_add_f32_dpp v128, v128, v128 row_ror:4 row_mask:0xf bank_mask:0xf
    s_nop 1
    v_add_f32_dpp v128, v128, v128 row_ror:8 row_mask:0xf bank_mask:0xf
    v_mov_b32 v20, v128
    s_nop 1
    v_permlane16_swap_b32 v128, v20
    v_add_f32 v128, v128, v20
    v_mov_b32 v20, v128
    s_nop 1
    v_permlane32_swap_b32 v128, v20
    v_add_f32 v128, v128, v20
    v_mul_f32 v128, 0x3a800000, v128
    v_sub_f32 v18, v56, v128
    v_mul_f32 v20, v18, v18
    v_sub_f32 v19, v57, v128
    v_mul_f32 v21, v19, v19
    v_sub_f32 v18, v58, v128
    v_sub_f32 v19, v59, v128
    v_fmac_f32 v20, v18, v18
    v_fmac_f32 v21, v19, v19
    v_sub_f32 v18, v60, v128
    v_sub_f32 v19, v61, v128
    v_fmac_f32 v20, v18, v18
    v_fmac_f32 v21, v19, v19
    v_sub_f32 v18, v62, v128
    v_sub_f32 v19, v63, v128
    v_fmac_f32 v20, v18, v18
    v_fmac_f32 v21, v19, v19
    v_sub_f32 v18, v64, v128
    v_sub_f32 v19, v65, v128
    v_fmac_f32 v20, v18, v18
    v_fmac_f32 v21, v19, v19
    v_sub_f32 v18, v66, v128
    v_sub_f32 v19, v67, v128
    v_fmac_f32 v20, v18, v18
    v_fmac_f32 v21, v19, v19
    v_sub_f32 v18, v68, v128
    v_sub_f32 v19, v69, v128
    v_fmac_f32 v20, v18, v18
    v_fmac_f32 v21, v19, v19
    v_sub_f32 v18, v70, v128
    v_sub_f32 v19, v71, v128
    v_fmac_f32 v20, v18, v18
    v_fmac_f32 v21, v19, v19
    v_add_f32 v17, v20, v21
    s_nop 1
    v_add_f32_dpp v17, v17, v17 row_ror:1 row_mask:0xf bank_mask:0xf
    s_nop 1
    v_add_f32_dpp v17, v17, v17 row_ror:2 row_mask:0xf bank_mask:0xf
    s_nop 1
    v_add_f32_dpp v17, v17, v17 row_ror:4 row_mask:0xf bank_mask:0xf
    s_nop 1
    v_add_f32_dpp v17, v17, v17 row_ror:8 row_mask:0xf bank_mask:0xf
    v_mov_b32 v20, v17
    s_nop 1
    v_permlane16_swap_b32 v17, v20
    v_add_f32 v17, v17, v20
    v_mov_b32 v20, v17
    s_nop 1
    v_permlane32_swap_b32 v17, v20
    v_add_f32 v17, v17, v20
    v_mul_f32 v17, 0x3a800000, v17
    v_cvt_pk_bf16_f32 v128, v128, v128
    v_lshlrev_b32 v128, 16, v128
    v_cvt_pk_bf16_f32 v17, v17, v17
    v_lshlrev_b32 v17, 16, v17
    v_add_f32 v17, 0x3727c5ac, v17
    v_cvt_pk_bf16_f32 v17, v17, v17
    v_lshlrev_b32 v17, 16, v17
    v_sqrt_f32 v129, v17
    s_nop 0
    v_cvt_pk_bf16_f32 v129, v129, v129
    v_lshlrev_b32 v129, 16, v129
    v_rcp_f32 v130, v129
    s_lshl_b32 s16, s3, 4
    s_add_u32 s16, s16, 67600
    v_mov_b32 v19, s16
    ds_write_b128 v19, v[128:131]
    v_mov_b32 v19, 67584
    v_and_b32 v17, 31, v1
    v_lshlrev_b32 v18, 3, v17
    v_add_u32 v18, 65536, v18
    v_lshlrev_b32 v17, 4, v17
    s_waitcnt lgkmcnt(0)
    s_barrier
    ds_read_b32 v134, v19
    ds_read_b64 v[96:97], v18 offset:0
    ds_read_b64 v[100:101], v18 offset:256
    ds_read_b64 v[104:105], v18 offset:512
    ds_read_b64 v[108:109], v18 offset:768
    ds_read_b64 v[112:113], v18 offset:1024
    ds_read_b64 v[116:117], v18 offset:1280
    ds_read_b64 v[120:121], v18 offset:1536
    ds_read_b64 v[124:125], v18 offset:1792
    s_waitcnt lgkmcnt(8)
    v_readfirstlane_b32 s28, v134
    v_and_b32 v20, 7, v1
    v_lshlrev_b32 v20, 4, v20
    v_add_u32 v21, 67600, v20
    ds_read_b128 v[128:131], v21
    s_waitcnt lgkmcnt(0)
    v_mov_b32 v131, s28
    s_lshl_b32 s16, s2, 7
    s_add_u32 s16, s16, 0x520000
    s_cmp_eq_u32 s3, 0
    s_cselect_b32 s16, s16, 0x7ffffff0
    s_mov_b64 exec, 0xff
    buffer_store_dwordx4 v[128:131], v20, s[8:11], s16 offen sc1
    s_mov_b64 exec, -1
    v_pk_add_f32 v[96:97], v[96:97], v[112:113]
    v_pk_add_f32 v[100:101], v[100:101], v[116:117]
    v_pk_add_f32 v[104:105], v[104:105], v[120:121]
    v_pk_add_f32 v[108:109], v[108:109], v[124:125]
    v_pk_add_f32 v[96:97], v[96:97], v[104:105]
    v_pk_add_f32 v[100:101], v[100:101], v[108:109]
    v_pk_add_f32 v[96:97], v[96:97], v[100:101]
    v_mov_b32 v98, s28
    v_mov_b32 v99, s28
    s_lshl_b32 s16, s14, 3
    s_add_u32 s16, s16, s15
    s_lshl_b32 s16, s16, 9
    s_add_u32 s16, s16, 0x500000
    s_cmp_eq_u32 s3, 0
    s_cselect_b32 s16, s16, 0x7ffffff0
    s_mov_b64 exec, 0xffffffff
    buffer_store_dwordx4 v[96:99], v17, s[8:11], s16 offen sc1
    s_mov_b64 exec, -1
    s_cmp_lt_u32 s24, 8
    s_cbranch_scc1 adaLN_cond__sliding_block_cached__moe_arch_mod__prompt_kernel_kvS
    s_waitcnt vmcnt(4)
    v_lshl_or_b32 v84, v89, 16, v88
    v_lshl_or_b32 v85, v91, 16, v90
    s_waitcnt vmcnt(3)
    v_lshl_or_b32 v86, v93, 16, v92
    v_lshl_or_b32 v87, v95, 16, v94
    v_and_b32 v88, 0x7fff, v88
    v_and_b32 v89, 0x7fff, v89
    v_and_b32 v90, 0x7fff, v90
    v_and_b32 v91, 0x7fff, v91
    v_and_b32 v92, 0x7fff, v92
    v_and_b32 v93, 0x7fff, v93
    v_and_b32 v94, 0x7fff, v94
    v_and_b32 v95, 0x7fff, v95
    v_max3_u32 v88, v88, v89, v90
    v_max3_u32 v91, v91, v92, v93
    v_max3_u32 v88, v88, v94, v95
    v_max_u32 v88, v88, v91
    v_cmp_le_u32 vcc, 0x4980, v88
    v_mov_b32 v89, s28
    s_mov_b32 s16, 0x564000
    s_and_saveexec_b64 s[62:63], vcc
    buffer_store_dword v89, v132, s[8:11], s16 offen sc1
    s_mov_b64 exec, s[62:63]
adaLN_cond__sliding_block_cached__moe_arch_mod__prompt_kernel_kvS:
    s_waitcnt vmcnt(3)
    buffer_store_dwordx4 v[84:87], v2, s[8:11], s21 offen sc1
    s_lshr_b32 s16, s3, 2
    s_lshl_b32 s16, s16, 4
    s_add_u32 s16, s16, s31
    s_lshl_b32 s16, s16, 12
    s_and_b32 s17, s3, 3
    s_lshl_b32 s17, s17, 7
    s_add_u32 s16, s16, s17
    s_add_u32 s16, s16, 0x500000
    v_lshrrev_b32 v139, 3, v1
    v_lshlrev_b32 v139, 9, v139
    v_and_b32 v16, 7, v1
    v_lshl_add_u32 v139, v16, 4, v139
    v_and_b32 v140, 15, v1
    v_lshlrev_b32 v140, 4, v140
    s_lshl_b32 s17, s29, 8
    s_add_u32 s17, s17, 0x520000
    v_lshlrev_b32 v56, 16, v40
    v_and_b32 v57, 0xffff0000, v40
    v_lshlrev_b32 v58, 16, v41
    v_and_b32 v59, 0xffff0000, v41
    v_lshlrev_b32 v60, 16, v42
    v_and_b32 v61, 0xffff0000, v42
    v_lshlrev_b32 v62, 16, v43
    v_and_b32 v63, 0xffff0000, v43
    v_lshlrev_b32 v64, 16, v44
    v_and_b32 v65, 0xffff0000, v44
    v_lshlrev_b32 v66, 16, v45
    v_and_b32 v67, 0xffff0000, v45
    v_lshlrev_b32 v68, 16, v46
    v_and_b32 v69, 0xffff0000, v46
    v_lshlrev_b32 v70, 16, v47
    v_and_b32 v71, 0xffff0000, v47
    v_mov_b32 v135, 2097152
    v_mul_lo_u32 v135, v135, v1
    s_mov_b64 s[76:77], s[40:41]
    s_mov_b32 s78, 0x800000
    s_mov_b32 s79, 0x20000
    s_mov_b32 s62, 0x0
    s_cmp_eq_u32 s3, 4
    s_cselect_b32 s62, s62, 0x7ffffff0
    buffer_load_dword v136, v135, s[76:79], s62 offen
    s_mov_b64 s[76:77], s[46:47]
    s_mov_b32 s78, 0x700000
    s_mov_b32 s79, 0x20000
    s_mov_b32 s62, 0x0
    s_cmp_eq_u32 s3, 4
    s_cselect_b32 s62, s62, 0x7ffffff0
    buffer_load_dword v136, v135, s[76:79], s62 offen
    s_mov_b64 s[76:77], s[48:49]
    s_mov_b32 s78, 0x700000
    s_mov_b32 s79, 0x20000
    s_mov_b32 s62, 0x0
    s_cmp_eq_u32 s3, 5
    s_cselect_b32 s62, s62, 0x7ffffff0
    buffer_load_dword v136, v135, s[76:79], s62 offen
    s_mov_b64 s[76:77], s[50:51]
    s_mov_b32 s78, 0x700000
    s_mov_b32 s79, 0x20000
    s_mov_b32 s62, 0x0
    s_cmp_eq_u32 s3, 5
    s_cselect_b32 s62, s62, 0x7ffffff0
    buffer_load_dword v136, v135, s[76:79], s62 offen
    s_mov_b64 s[76:77], s[38:39]
    s_mov_b32 s78, 0x800000
    s_mov_b32 s79, 0x20000
    s_mov_b32 s62, 0x0
    s_cmp_eq_u32 s3, 6
    s_cselect_b32 s62, s62, 0x7ffffff0
    buffer_load_dword v136, v135, s[76:79], s62 offen
    s_mov_b64 s[76:77], s[56:57]
    s_mov_b32 s78, 0x400000
    s_mov_b32 s79, 0x20000
    s_mov_b32 s62, 0x0
    s_cmp_eq_u32 s3, 6
    s_cselect_b32 s62, s62, 0x7ffffff0
    buffer_load_dword v136, v135, s[76:79], s62 offen
    s_mov_b64 s[76:77], s[54:55]
    s_mov_b32 s78, 0xc00000
    s_mov_b32 s79, 0x20000
    s_mov_b32 s62, 0x0
    s_cmp_eq_u32 s3, 7
    s_cselect_b32 s62, s62, 0x7ffffff0
    buffer_load_dword v136, v135, s[76:79], s62 offen
    s_mov_b64 s[76:77], s[44:45]
    s_mov_b32 s78, 0x800
    s_mov_b32 s79, 0x20000
    s_mov_b32 s62, 0x0
    s_cmp_eq_u32 s3, 7
    s_cselect_b32 s62, s62, 0x7ffffff0
    buffer_load_dword v136, v135, s[76:79], s62 offen
    s_mov_b32 s27, 0
adaLN_cond__sliding_block_cached__moe_arch_mod__prompt_kernel_g14p:
    buffer_load_dwordx4 v[76:79], v139, s[8:11], s16 offen sc1
    buffer_load_dwordx4 v[80:83], v140, s[8:11], s17 offen sc1
    s_waitcnt vmcnt(1)
    v_cmp_ne_u32 vcc, s28, v78
    v_cmp_ne_u32 s[62:63], s28, v79
    s_or_b64 vcc, vcc, s[62:63]
    s_waitcnt vmcnt(0)
    v_cmp_ne_u32 s[62:63], s28, v83
    s_or_b64 vcc, vcc, s[62:63]
    s_add_u32 s27, s27, 1
    s_cmp_ge_u32 s27, 65536
    s_cbranch_scc1 adaLN_cond__sliding_block_cached__moe_arch_mod__prompt_kernel_g14g
    s_cbranch_vccnz adaLN_cond__sliding_block_cached__moe_arch_mod__prompt_kernel_g14p
adaLN_cond__sliding_block_cached__moe_arch_mod__prompt_kernel_g14g:
    v_add_f32_dpp v76, v76, v76 row_ror:8 row_mask:0xf bank_mask:0xf
    v_add_f32_dpp v77, v77, v77 row_ror:8 row_mask:0xf bank_mask:0xf
    v_mov_b32 v17, v76
    s_nop 1
    v_permlane16_swap_b32 v76, v17
    v_add_f32 v76, v76, v17
    v_mov_b32 v18, v77
    s_nop 1
    v_permlane16_swap_b32 v77, v18
    v_add_f32 v77, v77, v18
    v_mov_b32 v17, v76
    s_nop 1
    v_permlane32_swap_b32 v76, v17
    v_add_f32 v76, v76, v17
    v_mov_b32 v18, v77
    s_nop 1
    v_permlane32_swap_b32 v77, v18
    v_add_f32 v77, v77, v18
    v_cvt_pk_bf16_f32 v17, v76, v77
    v_lshlrev_b32 v76, 16, v17
    v_and_b32 v77, 0xffff0000, v17
    v_add_f32 v76, 1.0, v76
    v_add_f32 v77, 1.0, v77
    v_cvt_pk_bf16_f32 v17, v76, v77
    v_lshlrev_b32 v76, 16, v17
    v_and_b32 v77, 0xffff0000, v17
    s_lshl_b32 s16, s3, 6
    s_add_u32 s16, s16, 69632
    v_lshl_add_u32 v16, v16, 3, s16
    ds_write_b64 v16, v[76:77]
    v_lshrrev_b32 v17, 4, v1
    v_lshlrev_b32 v17, 5, v17
    v_add_u32 v17, 69632, v17
    v_sub_f32 v56, v56, v80
    v_sub_f32 v57, v57, v80
    v_sub_f32 v58, v58, v80
    v_sub_f32 v59, v59, v80
    v_sub_f32 v60, v60, v80
    v_sub_f32 v61, v61, v80
    v_sub_f32 v62, v62, v80
    v_sub_f32 v63, v63, v80
    v_sub_f32 v64, v64, v80
    v_sub_f32 v65, v65, v80
    v_sub_f32 v66, v66, v80
    v_sub_f32 v67, v67, v80
    v_sub_f32 v68, v68, v80
    v_sub_f32 v69, v69, v80
    v_sub_f32 v70, v70, v80
    v_sub_f32 v71, v71, v80
    v_cvt_pk_bf16_f32 v18, v56, v57
    v_lshlrev_b32 v56, 16, v18
    v_and_b32 v57, 0xffff0000, v18
    v_cvt_pk_bf16_f32 v19, v58, v59
    v_lshlrev_b32 v58, 16, v19
    v_and_b32 v59, 0xffff0000, v19
    v_cvt_pk_bf16_f32 v18, v60, v61
    v_lshlrev_b32 v60, 16, v18
    v_and_b32 v61, 0xffff0000, v18
    v_cvt_pk_bf16_f32 v19, v62, v63
    v_lshlrev_b32 v62, 16, v19
    v_and_b32 v63, 0xffff0000, v19
    v_cvt_pk_bf16_f32 v18, v64, v65
    v_lshlrev_b32 v64, 16, v18
    v_and_b32 v65, 0xffff0000, v18
    v_cvt_pk_bf16_f32 v19, v66, v67
    v_lshlrev_b32 v66, 16, v19
    v_and_b32 v67, 0xffff0000, v19
    v_cvt_pk_bf16_f32 v18, v68, v69
    v_lshlrev_b32 v68, 16, v18
    v_and_b32 v69, 0xffff0000, v18
    v_cvt_pk_bf16_f32 v19, v70, v71
    v_lshlrev_b32 v70, 16, v19
    v_and_b32 v71, 0xffff0000, v19
    v_mul_f32 v56, v56, v82
    v_mul_f32 v57, v57, v82
    v_mul_f32 v58, v58, v82
    v_mul_f32 v59, v59, v82
    v_mul_f32 v60, v60, v82
    v_mul_f32 v61, v61, v82
    v_mul_f32 v62, v62, v82
    v_mul_f32 v63, v63, v82
    v_mul_f32 v64, v64, v82
    v_mul_f32 v65, v65, v82
    v_mul_f32 v66, v66, v82
    v_mul_f32 v67, v67, v82
    v_mul_f32 v68, v68, v82
    v_mul_f32 v69, v69, v82
    v_mul_f32 v70, v70, v82
    v_mul_f32 v71, v71, v82
    v_cvt_pk_bf16_f32 v18, v56, v57
    v_lshlrev_b32 v56, 16, v18
    v_and_b32 v57, 0xffff0000, v18
    v_cvt_pk_bf16_f32 v19, v58, v59
    v_lshlrev_b32 v58, 16, v19
    v_and_b32 v59, 0xffff0000, v19
    v_cvt_pk_bf16_f32 v18, v60, v61
    v_lshlrev_b32 v60, 16, v18
    v_and_b32 v61, 0xffff0000, v18
    v_cvt_pk_bf16_f32 v19, v62, v63
    v_lshlrev_b32 v62, 16, v19
    v_and_b32 v63, 0xffff0000, v19
    v_cvt_pk_bf16_f32 v18, v64, v65
    v_lshlrev_b32 v64, 16, v18
    v_and_b32 v65, 0xffff0000, v18
    v_cvt_pk_bf16_f32 v19, v66, v67
    v_lshlrev_b32 v66, 16, v19
    v_and_b32 v67, 0xffff0000, v19
    v_cvt_pk_bf16_f32 v18, v68, v69
    v_lshlrev_b32 v68, 16, v18
    v_and_b32 v69, 0xffff0000, v18
    v_cvt_pk_bf16_f32 v19, v70, v71
    v_lshlrev_b32 v70, 16, v19
    v_and_b32 v71, 0xffff0000, v19
    s_lshl_b32 s16, s29, 15
    s_lshl_b32 s17, s31, 11
    s_add_u32 s16, s16, s17
    s_waitcnt lgkmcnt(0)
    s_barrier
    ds_read_b128 v[96:99], v17 offset:256
    ds_read_b128 v[104:107], v17 offset:0
    ds_read_b128 v[100:103], v17 offset:272
    ds_read_b128 v[108:111], v17 offset:16
    ds_read_b128 v[112:115], v17 offset:384
    ds_read_b128 v[120:123], v17 offset:128
    ds_read_b128 v[116:119], v17 offset:400
    ds_read_b128 v[124:127], v17 offset:144
    s_waitcnt lgkmcnt(7)
    v_pk_mul_f32 v[56:57], v[56:57], v[96:97]
    v_pk_mul_f32 v[58:59], v[58:59], v[98:99]
    s_waitcnt lgkmcnt(5)
    v_pk_mul_f32 v[60:61], v[60:61], v[100:101]
    v_pk_mul_f32 v[62:63], v[62:63], v[102:103]
    v_cvt_pk_bf16_f32 v18, v56, v57
    v_lshlrev_b32 v56, 16, v18
    v_and_b32 v57, 0xffff0000, v18
    v_cvt_pk_bf16_f32 v19, v58, v59
    v_lshlrev_b32 v58, 16, v19
    v_and_b32 v59, 0xffff0000, v19
    v_cvt_pk_bf16_f32 v18, v60, v61
    v_lshlrev_b32 v60, 16, v18
    v_and_b32 v61, 0xffff0000, v18
    v_cvt_pk_bf16_f32 v19, v62, v63
    v_lshlrev_b32 v62, 16, v19
    v_and_b32 v63, 0xffff0000, v19
    v_pk_add_f32 v[56:57], v[56:57], v[104:105]
    v_pk_add_f32 v[58:59], v[58:59], v[106:107]
    s_waitcnt lgkmcnt(4)
    v_pk_add_f32 v[60:61], v[60:61], v[108:109]
    v_pk_add_f32 v[62:63], v[62:63], v[110:111]
    v_cvt_pk_bf16_f32 v32, v56, v57
    v_cvt_pk_bf16_f32 v33, v58, v59
    v_cvt_pk_bf16_f32 v34, v60, v61
    v_cvt_pk_bf16_f32 v35, v62, v63
    buffer_store_dwordx4 v[32:35], v2, s[8:11], s16 offen offset:0 sc1
    s_waitcnt lgkmcnt(3)
    v_pk_mul_f32 v[64:65], v[64:65], v[112:113]
    v_pk_mul_f32 v[66:67], v[66:67], v[114:115]
    s_waitcnt lgkmcnt(1)
    v_pk_mul_f32 v[68:69], v[68:69], v[116:117]
    v_pk_mul_f32 v[70:71], v[70:71], v[118:119]
    v_cvt_pk_bf16_f32 v18, v64, v65
    v_lshlrev_b32 v64, 16, v18
    v_and_b32 v65, 0xffff0000, v18
    v_cvt_pk_bf16_f32 v19, v66, v67
    v_lshlrev_b32 v66, 16, v19
    v_and_b32 v67, 0xffff0000, v19
    v_cvt_pk_bf16_f32 v18, v68, v69
    v_lshlrev_b32 v68, 16, v18
    v_and_b32 v69, 0xffff0000, v18
    v_cvt_pk_bf16_f32 v19, v70, v71
    v_lshlrev_b32 v70, 16, v19
    v_and_b32 v71, 0xffff0000, v19
    v_pk_add_f32 v[64:65], v[64:65], v[120:121]
    v_pk_add_f32 v[66:67], v[66:67], v[122:123]
    s_waitcnt lgkmcnt(0)
    v_pk_add_f32 v[68:69], v[68:69], v[124:125]
    v_pk_add_f32 v[70:71], v[70:71], v[126:127]
    v_cvt_pk_bf16_f32 v36, v64, v65
    v_cvt_pk_bf16_f32 v37, v66, v67
    v_cvt_pk_bf16_f32 v38, v68, v69
    v_cvt_pk_bf16_f32 v39, v70, v71
    buffer_store_dwordx4 v[36:39], v2, s[8:11], s16 offen offset:1024 sc1
    s_lshl_b32 s19, s3, 16
    s_lshl_b32 s20, s3, 11
    s_lshl_b32 s16, s12, 8
    s_add_u32 s4, s38, s16
    s_addc_u32 s5, s39, 0
    s_sub_u32 s6, 0x800000, s16
    s_mov_b32 s7, 0x20000
    v_mov_b32 v134, s28
    s_lshl_b32 s16, s29, 4
    s_add_u32 s16, s16, s31
    s_lshl_b32 s16, s16, 2
    s_add_u32 s16, s16, 0x528000
    v_and_b32 v16, 31, v1
    v_lshlrev_b32 v16, 2, v16
    s_lshl_b32 s17, s13, 3
    s_add_u32 s17, s17, s3
    s_lshl_b32 s17, s17, 7
    s_add_u32 s17, s17, 0x528000
    s_waitcnt vmcnt(0)
    s_mov_b64 exec, 1
    buffer_store_dword v134, v132, s[8:11], s16 offen sc1
    s_mov_b64 exec, -1
    s_add_u32 s22, s19, 0x0
    s_add_u32 m0, s20, 0x0
    s_nop 0
    buffer_load_dwordx4 v3, s[4:7], s22 offen lds
    s_add_u32 s22, s19, 0x8000
    s_add_u32 m0, s20, 0x400
    s_nop 0
    buffer_load_dwordx4 v3, s[4:7], s22 offen lds
    s_add_u32 s22, s19, 0x80000
    s_add_u32 m0, s20, 0x4000
    s_nop 0
    buffer_load_dwordx4 v3, s[4:7], s22 offen lds
    s_add_u32 s22, s19, 0x88000
    s_add_u32 m0, s20, 0x4400
    s_nop 0
    buffer_load_dwordx4 v3, s[4:7], s22 offen lds
    s_add_u32 s22, s19, 0x100000
    s_add_u32 m0, s20, 0x8000
    s_nop 0
    buffer_load_dwordx4 v3, s[4:7], s22 offen lds
    s_add_u32 s22, s19, 0x108000
    s_add_u32 m0, s20, 0x8400
    s_nop 0
    buffer_load_dwordx4 v3, s[4:7], s22 offen lds
    s_sleep 40
    s_mov_b32 s27, 0
adaLN_cond__sliding_block_cached__moe_arch_mod__prompt_kernel_h15p:
    buffer_load_dword v17, v16, s[8:11], s17 offen sc1
    s_waitcnt vmcnt(0)
    v_cmp_ne_u32 vcc, s28, v17
    s_add_u32 s27, s27, 1
    s_cmp_ge_u32 s27, 65536
    s_cbranch_scc1 adaLN_cond__sliding_block_cached__moe_arch_mod__prompt_kernel_h15g
    s_cbranch_vccnz adaLN_cond__sliding_block_cached__moe_arch_mod__prompt_kernel_h15p
adaLN_cond__sliding_block_cached__moe_arch_mod__prompt_kernel_h15g:
    s_mov_b32 s23, 0x0
    buffer_load_dwordx4 v[88:91], v7, s[8:11], s23 offen offset:0 sc1
    s_mov_b32 s23, 0x8000
    buffer_load_dwordx4 v[92:95], v7, s[8:11], s23 offen offset:0 sc1
    s_mov_b32 s23, 0x0
    buffer_load_dwordx4 v[96:99], v7, s[8:11], s23 offen offset:1024 sc1
    s_mov_b32 s23, 0x8000
    buffer_load_dwordx4 v[100:103], v7, s[8:11], s23 offen offset:1024 sc1
    s_mov_b32 s23, 0x800
    buffer_load_dwordx4 v[104:107], v7, s[8:11], s23 offen offset:0 sc1
    s_mov_b32 s23, 0x8800
    buffer_load_dwordx4 v[108:111], v7, s[8:11], s23 offen offset:0 sc1
    s_mov_b32 s23, 0x800
    buffer_load_dwordx4 v[112:115], v7, s[8:11], s23 offen offset:1024 sc1
    s_mov_b32 s23, 0x8800
    buffer_load_dwordx4 v[116:119], v7, s[8:11], s23 offen offset:1024 sc1
    s_lshr_b32 s21, s12, 3
    s_lshl_b32 s21, s21, 17
    s_add_u32 s21, s21, s20
    s_add_u32 s21, s21, 0x400000
    s_barrier
    ds_read_b64_tr_b16 v[224:225], v4 offset:0
    ds_read_b64_tr_b16 v[226:227], v4 offset:1024
    ds_read_b64_tr_b16 v[228:229], v5 offset:32
    ds_read_b64_tr_b16 v[230:231], v5 offset:1056
    ds_read_b64_tr_b16 v[232:233], v4 offset:256
    ds_read_b64_tr_b16 v[234:235], v4 offset:1280
    ds_read_b64_tr_b16 v[236:237], v5 offset:288
    ds_read_b64_tr_b16 v[238:239], v5 offset:1312
    s_waitcnt vmcnt(7) lgkmcnt(6)
    v_mfma_f32_16x16x32_bf16 v[24:27], v[224:227], v[88:91], 0
    ds_read_b64_tr_b16 v[240:241], v4 offset:512
    s_waitcnt vmcnt(6)
    v_mfma_f32_16x16x32_bf16 v[28:31], v[224:227], v[92:95], 0
    ds_read_b64_tr_b16 v[242:243], v4 offset:1536
    s_waitcnt lgkmcnt(6)
    v_mfma_f32_16x16x32_bf16 v[32:35], v[228:231], v[88:91], 0
    ds_read_b64_tr_b16 v[244:245], v5 offset:544
    v_mfma_f32_16x16x32_bf16 v[36:39], v[228:231], v[92:95], 0
    ds_read_b64_tr_b16 v[246:247], v5 offset:1568
    s_mov_b32 s23, 0x1000
    buffer_load_dwordx4 v[120:123], v7, s[8:11], s23 offen offset:0 sc1
    s_waitcnt lgkmcnt(6)
    v_mfma_f32_16x16x32_bf16 v[40:43], v[232:235], v[88:91], 0
    ds_read_b64_tr_b16 v[224:225], v4 offset:768
    v_mfma_f32_16x16x32_bf16 v[44:47], v[232:235], v[92:95], 0
    ds_read_b64_tr_b16 v[226:227], v4 offset:1792
    s_waitcnt lgkmcnt(6)
    v_mfma_f32_16x16x32_bf16 v[48:51], v[236:239], v[88:91], 0
    ds_read_b64_tr_b16 v[228:229], v5 offset:800
    v_mfma_f32_16x16x32_bf16 v[52:55], v[236:239], v[92:95], 0
    ds_read_b64_tr_b16 v[230:231], v5 offset:1824
    s_waitcnt lgkmcnt(6)
    v_mfma_f32_16x16x32_bf16 v[56:59], v[240:243], v[88:91], 0
    ds_read_b64_tr_b16 v[232:233], v4 offset:8192
    v_mfma_f32_16x16x32_bf16 v[60:63], v[240:243], v[92:95], 0
    ds_read_b64_tr_b16 v[234:235], v4 offset:9216
    s_waitcnt lgkmcnt(6)
    v_mfma_f32_16x16x32_bf16 v[64:67], v[244:247], v[88:91], 0
    ds_read_b64_tr_b16 v[236:237], v5 offset:8224
    v_mfma_f32_16x16x32_bf16 v[68:71], v[244:247], v[92:95], 0
    ds_read_b64_tr_b16 v[238:239], v5 offset:9248
    s_mov_b32 s23, 0x9000
    buffer_load_dwordx4 v[124:127], v7, s[8:11], s23 offen offset:0 sc1
    s_waitcnt lgkmcnt(6)
    v_mfma_f32_16x16x32_bf16 v[72:75], v[224:227], v[88:91], 0
    ds_read_b64_tr_b16 v[240:241], v4 offset:8448
    v_mfma_f32_16x16x32_bf16 v[76:79], v[224:227], v[92:95], 0
    ds_read_b64_tr_b16 v[242:243], v4 offset:9472
    s_waitcnt lgkmcnt(6)
    v_mfma_f32_16x16x32_bf16 v[80:83], v[228:231], v[88:91], 0
    ds_read_b64_tr_b16 v[244:245], v5 offset:8480
    v_mfma_f32_16x16x32_bf16 v[84:87], v[228:231], v[92:95], 0
    ds_read_b64_tr_b16 v[246:247], v5 offset:9504
    s_waitcnt vmcnt(7) lgkmcnt(6)
    v_mfma_f32_16x16x32_bf16 v[24:27], v[232:235], v[96:99], v[24:27]
    ds_read_b64_tr_b16 v[224:225], v4 offset:8704
    s_waitcnt vmcnt(6)
    v_mfma_f32_16x16x32_bf16 v[28:31], v[232:235], v[100:103], v[28:31]
    ds_read_b64_tr_b16 v[226:227], v4 offset:9728
    s_waitcnt lgkmcnt(6)
    v_mfma_f32_16x16x32_bf16 v[32:35], v[236:239], v[96:99], v[32:35]
    ds_read_b64_tr_b16 v[228:229], v5 offset:8736
    v_mfma_f32_16x16x32_bf16 v[36:39], v[236:239], v[100:103], v[36:39]
    ds_read_b64_tr_b16 v[230:231], v5 offset:9760
    s_mov_b32 s23, 0x1000
    buffer_load_dwordx4 v[128:131], v7, s[8:11], s23 offen offset:1024 sc1
    s_waitcnt lgkmcnt(6)
    v_mfma_f32_16x16x32_bf16 v[40:43], v[240:243], v[96:99], v[40:43]
    ds_read_b64_tr_b16 v[232:233], v4 offset:8960
    v_mfma_f32_16x16x32_bf16 v[44:47], v[240:243], v[100:103], v[44:47]
    ds_read_b64_tr_b16 v[234:235], v4 offset:9984
    s_waitcnt lgkmcnt(6)
    v_mfma_f32_16x16x32_bf16 v[48:51], v[244:247], v[96:99], v[48:51]
    ds_read_b64_tr_b16 v[236:237], v5 offset:8992
    v_mfma_f32_16x16x32_bf16 v[52:55], v[244:247], v[100:103], v[52:55]
    ds_read_b64_tr_b16 v[238:239], v5 offset:10016
    s_waitcnt lgkmcnt(6)
    v_mfma_f32_16x16x32_bf16 v[56:59], v[224:227], v[96:99], v[56:59]
    v_mfma_f32_16x16x32_bf16 v[60:63], v[224:227], v[100:103], v[60:63]
    s_barrier
    ds_read_b64_tr_b16 v[240:241], v4 offset:16384
    ds_read_b64_tr_b16 v[242:243], v4 offset:17408
    s_waitcnt lgkmcnt(6)
    v_mfma_f32_16x16x32_bf16 v[64:67], v[228:231], v[96:99], v[64:67]
    ds_read_b64_tr_b16 v[244:245], v5 offset:16416
    v_mfma_f32_16x16x32_bf16 v[68:71], v[228:231], v[100:103], v[68:71]
    s_add_u32 s22, s19, 0x180000
    s_add_u32 m0, s20, 0xc000
    s_nop 0
    buffer_load_dwordx4 v3, s[4:7], s22 offen lds
    ds_read_b64_tr_b16 v[246:247], v5 offset:17440
    s_mov_b32 s23, 0x9000
    buffer_load_dwordx4 v[132:135], v7, s[8:11], s23 offen offset:1024 sc1
    s_waitcnt lgkmcnt(6)
    v_mfma_f32_16x16x32_bf16 v[72:75], v[232:235], v[96:99], v[72:75]
    ds_read_b64_tr_b16 v[224:225], v4 offset:16640
    v_mfma_f32_16x16x32_bf16 v[76:79], v[232:235], v[100:103], v[76:79]
    ds_read_b64_tr_b16 v[226:227], v4 offset:17664
    s_waitcnt lgkmcnt(6)
    v_mfma_f32_16x16x32_bf16 v[80:83], v[236:239], v[96:99], v[80:83]
    ds_read_b64_tr_b16 v[228:229], v5 offset:16672
    v_mfma_f32_16x16x32_bf16 v[84:87], v[236:239], v[100:103], v[84:87]
    ds_read_b64_tr_b16 v[230:231], v5 offset:17696
    s_waitcnt vmcnt(8) lgkmcnt(6)
    v_mfma_f32_16x16x32_bf16 v[24:27], v[240:243], v[104:107], v[24:27]
    ds_read_b64_tr_b16 v[232:233], v4 offset:16896
    s_waitcnt vmcnt(7)
    v_mfma_f32_16x16x32_bf16 v[28:31], v[240:243], v[108:111], v[28:31]
    ds_read_b64_tr_b16 v[234:235], v4 offset:17920
    s_waitcnt lgkmcnt(6)
    v_mfma_f32_16x16x32_bf16 v[32:35], v[244:247], v[104:107], v[32:35]
    ds_read_b64_tr_b16 v[236:237], v5 offset:16928
    v_mfma_f32_16x16x32_bf16 v[36:39], v[244:247], v[108:111], v[36:39]
    s_add_u32 s22, s19, 0x188000
    s_add_u32 m0, s20, 0xc400
    s_nop 0
    buffer_load_dwordx4 v3, s[4:7], s22 offen lds
    ds_read_b64_tr_b16 v[238:239], v5 offset:17952
    s_mov_b32 s23, 0x1800
    buffer_load_dwordx4 v[88:91], v7, s[8:11], s23 offen offset:0 sc1
    s_waitcnt lgkmcnt(6)
    v_mfma_f32_16x16x32_bf16 v[40:43], v[224:227], v[104:107], v[40:43]
    ds_read_b64_tr_b16 v[240:241], v4 offset:17152
    v_mfma_f32_16x16x32_bf16 v[44:47], v[224:227], v[108:111], v[44:47]
    ds_read_b64_tr_b16 v[242:243], v4 offset:18176
    s_waitcnt lgkmcnt(6)
    v_mfma_f32_16x16x32_bf16 v[48:51], v[228:231], v[104:107], v[48:51]
    ds_read_b64_tr_b16 v[244:245], v5 offset:17184
    v_mfma_f32_16x16x32_bf16 v[52:55], v[228:231], v[108:111], v[52:55]
    ds_read_b64_tr_b16 v[246:247], v5 offset:18208
    s_waitcnt lgkmcnt(6)
    v_mfma_f32_16x16x32_bf16 v[56:59], v[232:235], v[104:107], v[56:59]
    ds_read_b64_tr_b16 v[224:225], v4 offset:24576
    v_mfma_f32_16x16x32_bf16 v[60:63], v[232:235], v[108:111], v[60:63]
    ds_read_b64_tr_b16 v[226:227], v4 offset:25600
    s_waitcnt lgkmcnt(6)
    v_mfma_f32_16x16x32_bf16 v[64:67], v[236:239], v[104:107], v[64:67]
    ds_read_b64_tr_b16 v[228:229], v5 offset:24608
    v_mfma_f32_16x16x32_bf16 v[68:71], v[236:239], v[108:111], v[68:71]
    ds_read_b64_tr_b16 v[230:231], v5 offset:25632
    s_mov_b32 s23, 0x9800
    buffer_load_dwordx4 v[92:95], v7, s[8:11], s23 offen offset:0 sc1
    s_waitcnt lgkmcnt(6)
    v_mfma_f32_16x16x32_bf16 v[72:75], v[240:243], v[104:107], v[72:75]
    ds_read_b64_tr_b16 v[232:233], v4 offset:24832
    v_mfma_f32_16x16x32_bf16 v[76:79], v[240:243], v[108:111], v[76:79]
    ds_read_b64_tr_b16 v[234:235], v4 offset:25856
    s_waitcnt lgkmcnt(6)
    v_mfma_f32_16x16x32_bf16 v[80:83], v[244:247], v[104:107], v[80:83]
    ds_read_b64_tr_b16 v[236:237], v5 offset:24864
    v_mfma_f32_16x16x32_bf16 v[84:87], v[244:247], v[108:111], v[84:87]
    ds_read_b64_tr_b16 v[238:239], v5 offset:25888
    s_waitcnt vmcnt(9) lgkmcnt(6)
    v_mfma_f32_16x16x32_bf16 v[24:27], v[224:227], v[112:115], v[24:27]
    ds_read_b64_tr_b16 v[240:241], v4 offset:25088
    s_waitcnt vmcnt(8)
    v_mfma_f32_16x16x32_bf16 v[28:31], v[224:227], v[116:119], v[28:31]
    ds_read_b64_tr_b16 v[242:243], v4 offset:26112
    s_waitcnt lgkmcnt(6)
    v_mfma_f32_16x16x32_bf16 v[32:35], v[228:231], v[112:115], v[32:35]
    ds_read_b64_tr_b16 v[244:245], v5 offset:25120
    v_mfma_f32_16x16x32_bf16 v[36:39], v[228:231], v[116:119], v[36:39]
    ds_read_b64_tr_b16 v[246:247], v5 offset:26144
    s_mov_b32 s23, 0x1800
    buffer_load_dwordx4 v[96:99], v7, s[8:11], s23 offen offset:1024 sc1
    s_waitcnt lgkmcnt(6)
    v_mfma_f32_16x16x32_bf16 v[40:43], v[232:235], v[112:115], v[40:43]
    ds_read_b64_tr_b16 v[224:225], v4 offset:25344
    v_mfma_f32_16x16x32_bf16 v[44:47], v[232:235], v[116:119], v[44:47]
    ds_read_b64_tr_b16 v[226:227], v4 offset:26368
    s_waitcnt lgkmcnt(6)
    v_mfma_f32_16x16x32_bf16 v[48:51], v[236:239], v[112:115], v[48:51]
    ds_read_b64_tr_b16 v[228:229], v5 offset:25376
    v_mfma_f32_16x16x32_bf16 v[52:55], v[236:239], v[116:119], v[52:55]
    ds_read_b64_tr_b16 v[230:231], v5 offset:26400
    s_waitcnt lgkmcnt(6)
    v_mfma_f32_16x16x32_bf16 v[56:59], v[240:243], v[112:115], v[56:59]
    v_mfma_f32_16x16x32_bf16 v[60:63], v[240:243], v[116:119], v[60:63]
    s_barrier
    ds_read_b64_tr_b16 v[232:233], v4 offset:32768
    ds_read_b64_tr_b16 v[234:235], v4 offset:33792
    s_waitcnt lgkmcnt(6)
    v_mfma_f32_16x16x32_bf16 v[64:67], v[244:247], v[112:115], v[64:67]
    ds_read_b64_tr_b16 v[236:237], v5 offset:32800
    v_mfma_f32_16x16x32_bf16 v[68:71], v[244:247], v[116:119], v[68:71]
    s_add_u32 s22, s19, 0x200000
    s_add_u32 m0, s20, 0x0
    s_nop 0
    buffer_load_dwordx4 v3, s[4:7], s22 offen lds
    ds_read_b64_tr_b16 v[238:239], v5 offset:33824
    s_mov_b32 s23, 0x9800
    buffer_load_dwordx4 v[100:103], v7, s[8:11], s23 offen offset:1024 sc1
    s_waitcnt lgkmcnt(6)
    v_mfma_f32_16x16x32_bf16 v[72:75], v[224:227], v[112:115], v[72:75]
    ds_read_b64_tr_b16 v[240:241], v4 offset:33024
    v_mfma_f32_16x16x32_bf16 v[76:79], v[224:227], v[116:119], v[76:79]
    ds_read_b64_tr_b16 v[242:243], v4 offset:34048
    s_waitcnt lgkmcnt(6)
    v_mfma_f32_16x16x32_bf16 v[80:83], v[228:231], v[112:115], v[80:83]
    ds_read_b64_tr_b16 v[244:245], v5 offset:33056
    v_mfma_f32_16x16x32_bf16 v[84:87], v[228:231], v[116:119], v[84:87]
    ds_read_b64_tr_b16 v[246:247], v5 offset:34080
    s_waitcnt vmcnt(10) lgkmcnt(6)
    v_mfma_f32_16x16x32_bf16 v[24:27], v[232:235], v[120:123], v[24:27]
    ds_read_b64_tr_b16 v[224:225], v4 offset:33280
    s_waitcnt vmcnt(9)
    v_mfma_f32_16x16x32_bf16 v[28:31], v[232:235], v[124:127], v[28:31]
    ds_read_b64_tr_b16 v[226:227], v4 offset:34304
    s_waitcnt lgkmcnt(6)
    v_mfma_f32_16x16x32_bf16 v[32:35], v[236:239], v[120:123], v[32:35]
    ds_read_b64_tr_b16 v[228:229], v5 offset:33312
    v_mfma_f32_16x16x32_bf16 v[36:39], v[236:239], v[124:127], v[36:39]
    s_add_u32 s22, s19, 0x208000
    s_add_u32 m0, s20, 0x400
    s_nop 0
    buffer_load_dwordx4 v3, s[4:7], s22 offen lds
    ds_read_b64_tr_b16 v[230:231], v5 offset:34336
    s_mov_b32 s23, 0x2000
    buffer_load_dwordx4 v[104:107], v7, s[8:11], s23 offen offset:0 sc1
    s_waitcnt lgkmcnt(6)
    v_mfma_f32_16x16x32_bf16 v[40:43], v[240:243], v[120:123], v[40:43]
    ds_read_b64_tr_b16 v[232:233], v4 offset:33536
    v_mfma_f32_16x16x32_bf16 v[44:47], v[240:243], v[124:127], v[44:47]
    ds_read_b64_tr_b16 v[234:235], v4 offset:34560
    s_waitcnt lgkmcnt(6)
    v_mfma_f32_16x16x32_bf16 v[48:51], v[244:247], v[120:123], v[48:51]
    ds_read_b64_tr_b16 v[236:237], v5 offset:33568
    v_mfma_f32_16x16x32_bf16 v[52:55], v[244:247], v[124:127], v[52:55]
    ds_read_b64_tr_b16 v[238:239], v5 offset:34592
    s_waitcnt lgkmcnt(6)
    v_mfma_f32_16x16x32_bf16 v[56:59], v[224:227], v[120:123], v[56:59]
    ds_read_b64_tr_b16 v[240:241], v4 offset:40960
    v_mfma_f32_16x16x32_bf16 v[60:63], v[224:227], v[124:127], v[60:63]
    ds_read_b64_tr_b16 v[242:243], v4 offset:41984
    s_waitcnt lgkmcnt(6)
    v_mfma_f32_16x16x32_bf16 v[64:67], v[228:231], v[120:123], v[64:67]
    ds_read_b64_tr_b16 v[244:245], v5 offset:40992
    v_mfma_f32_16x16x32_bf16 v[68:71], v[228:231], v[124:127], v[68:71]
    ds_read_b64_tr_b16 v[246:247], v5 offset:42016
    s_mov_b32 s23, 0xa000
    buffer_load_dwordx4 v[108:111], v7, s[8:11], s23 offen offset:0 sc1
    s_waitcnt lgkmcnt(6)
    v_mfma_f32_16x16x32_bf16 v[72:75], v[232:235], v[120:123], v[72:75]
    ds_read_b64_tr_b16 v[224:225], v4 offset:41216
    v_mfma_f32_16x16x32_bf16 v[76:79], v[232:235], v[124:127], v[76:79]
    ds_read_b64_tr_b16 v[226:227], v4 offset:42240
    s_waitcnt lgkmcnt(6)
    v_mfma_f32_16x16x32_bf16 v[80:83], v[236:239], v[120:123], v[80:83]
    ds_read_b64_tr_b16 v[228:229], v5 offset:41248
    v_mfma_f32_16x16x32_bf16 v[84:87], v[236:239], v[124:127], v[84:87]
    ds_read_b64_tr_b16 v[230:231], v5 offset:42272
    s_waitcnt vmcnt(11) lgkmcnt(6)
    v_mfma_f32_16x16x32_bf16 v[24:27], v[240:243], v[128:131], v[24:27]
    ds_read_b64_tr_b16 v[232:233], v4 offset:41472
    s_waitcnt vmcnt(9)
    v_mfma_f32_16x16x32_bf16 v[28:31], v[240:243], v[132:135], v[28:31]
    ds_read_b64_tr_b16 v[234:235], v4 offset:42496
    s_waitcnt lgkmcnt(6)
    v_mfma_f32_16x16x32_bf16 v[32:35], v[244:247], v[128:131], v[32:35]
    ds_read_b64_tr_b16 v[236:237], v5 offset:41504
    v_mfma_f32_16x16x32_bf16 v[36:39], v[244:247], v[132:135], v[36:39]
    ds_read_b64_tr_b16 v[238:239], v5 offset:42528
    s_mov_b32 s23, 0x2000
    buffer_load_dwordx4 v[112:115], v7, s[8:11], s23 offen offset:1024 sc1
    s_waitcnt lgkmcnt(6)
    v_mfma_f32_16x16x32_bf16 v[40:43], v[224:227], v[128:131], v[40:43]
    ds_read_b64_tr_b16 v[240:241], v4 offset:41728
    v_mfma_f32_16x16x32_bf16 v[44:47], v[224:227], v[132:135], v[44:47]
    ds_read_b64_tr_b16 v[242:243], v4 offset:42752
    s_waitcnt lgkmcnt(6)
    v_mfma_f32_16x16x32_bf16 v[48:51], v[228:231], v[128:131], v[48:51]
    ds_read_b64_tr_b16 v[244:245], v5 offset:41760
    v_mfma_f32_16x16x32_bf16 v[52:55], v[228:231], v[132:135], v[52:55]
    ds_read_b64_tr_b16 v[246:247], v5 offset:42784
    s_waitcnt lgkmcnt(6)
    v_mfma_f32_16x16x32_bf16 v[56:59], v[232:235], v[128:131], v[56:59]
    v_mfma_f32_16x16x32_bf16 v[60:63], v[232:235], v[132:135], v[60:63]
    s_waitcnt vmcnt(9)
    s_barrier
    ds_read_b64_tr_b16 v[224:225], v4 offset:49152
    ds_read_b64_tr_b16 v[226:227], v4 offset:50176
    s_waitcnt lgkmcnt(6)
    v_mfma_f32_16x16x32_bf16 v[64:67], v[236:239], v[128:131], v[64:67]
    ds_read_b64_tr_b16 v[228:229], v5 offset:49184
    v_mfma_f32_16x16x32_bf16 v[68:71], v[236:239], v[132:135], v[68:71]
    s_add_u32 s22, s19, 0x280000
    s_add_u32 m0, s20, 0x4000
    s_nop 0
    buffer_load_dwordx4 v3, s[4:7], s22 offen lds
    ds_read_b64_tr_b16 v[230:231], v5 offset:50208
    s_mov_b32 s23, 0xa000
    buffer_load_dwordx4 v[116:119], v7, s[8:11], s23 offen offset:1024 sc1
    s_waitcnt lgkmcnt(6)
    v_mfma_f32_16x16x32_bf16 v[72:75], v[240:243], v[128:131], v[72:75]
    ds_read_b64_tr_b16 v[232:233], v4 offset:49408
    v_mfma_f32_16x16x32_bf16 v[76:79], v[240:243], v[132:135], v[76:79]
    ds_read_b64_tr_b16 v[234:235], v4 offset:50432
    s_waitcnt lgkmcnt(6)
    v_mfma_f32_16x16x32_bf16 v[80:83], v[244:247], v[128:131], v[80:83]
    ds_read_b64_tr_b16 v[236:237], v5 offset:49440
    v_mfma_f32_16x16x32_bf16 v[84:87], v[244:247], v[132:135], v[84:87]
    ds_read_b64_tr_b16 v[238:239], v5 offset:50464
    s_waitcnt vmcnt(10) lgkmcnt(6)
    v_mfma_f32_16x16x32_bf16 v[24:27], v[224:227], v[88:91], v[24:27]
    ds_read_b64_tr_b16 v[240:241], v4 offset:49664
    s_waitcnt vmcnt(9)
    v_mfma_f32_16x16x32_bf16 v[28:31], v[224:227], v[92:95], v[28:31]
    ds_read_b64_tr_b16 v[242:243], v4 offset:50688
    s_waitcnt lgkmcnt(6)
    v_mfma_f32_16x16x32_bf16 v[32:35], v[228:231], v[88:91], v[32:35]
    ds_read_b64_tr_b16 v[244:245], v5 offset:49696
    v_mfma_f32_16x16x32_bf16 v[36:39], v[228:231], v[92:95], v[36:39]
    s_add_u32 s22, s19, 0x288000
    s_add_u32 m0, s20, 0x4400
    s_nop 0
    buffer_load_dwordx4 v3, s[4:7], s22 offen lds
    ds_read_b64_tr_b16 v[246:247], v5 offset:50720
    s_mov_b32 s23, 0x2800
    buffer_load_dwordx4 v[120:123], v7, s[8:11], s23 offen offset:0 sc1
    s_waitcnt lgkmcnt(6)
    v_mfma_f32_16x16x32_bf16 v[40:43], v[232:235], v[88:91], v[40:43]
    ds_read_b64_tr_b16 v[224:225], v4 offset:49920
    v_mfma_f32_16x16x32_bf16 v[44:47], v[232:235], v[92:95], v[44:47]
    ds_read_b64_tr_b16 v[226:227], v4 offset:50944
    s_waitcnt lgkmcnt(6)
    v_mfma_f32_16x16x32_bf16 v[48:51], v[236:239], v[88:91], v[48:51]
    ds_read_b64_tr_b16 v[228:229], v5 offset:49952
    v_mfma_f32_16x16x32_bf16 v[52:55], v[236:239], v[92:95], v[52:55]
    ds_read_b64_tr_b16 v[230:231], v5 offset:50976
    s_waitcnt lgkmcnt(6)
    v_mfma_f32_16x16x32_bf16 v[56:59], v[240:243], v[88:91], v[56:59]
    ds_read_b64_tr_b16 v[232:233], v4 offset:57344
    v_mfma_f32_16x16x32_bf16 v[60:63], v[240:243], v[92:95], v[60:63]
    ds_read_b64_tr_b16 v[234:235], v4 offset:58368
    s_waitcnt lgkmcnt(6)
    v_mfma_f32_16x16x32_bf16 v[64:67], v[244:247], v[88:91], v[64:67]
    ds_read_b64_tr_b16 v[236:237], v5 offset:57376
    v_mfma_f32_16x16x32_bf16 v[68:71], v[244:247], v[92:95], v[68:71]
    ds_read_b64_tr_b16 v[238:239], v5 offset:58400
    s_mov_b32 s23, 0xa800
    buffer_load_dwordx4 v[124:127], v7, s[8:11], s23 offen offset:0 sc1
    s_waitcnt lgkmcnt(6)
    v_mfma_f32_16x16x32_bf16 v[72:75], v[224:227], v[88:91], v[72:75]
    ds_read_b64_tr_b16 v[240:241], v4 offset:57600
    v_mfma_f32_16x16x32_bf16 v[76:79], v[224:227], v[92:95], v[76:79]
    ds_read_b64_tr_b16 v[242:243], v4 offset:58624
    s_waitcnt lgkmcnt(6)
    v_mfma_f32_16x16x32_bf16 v[80:83], v[228:231], v[88:91], v[80:83]
    ds_read_b64_tr_b16 v[244:245], v5 offset:57632
    v_mfma_f32_16x16x32_bf16 v[84:87], v[228:231], v[92:95], v[84:87]
    ds_read_b64_tr_b16 v[246:247], v5 offset:58656
    s_waitcnt vmcnt(11) lgkmcnt(6)
    v_mfma_f32_16x16x32_bf16 v[24:27], v[232:235], v[96:99], v[24:27]
    ds_read_b64_tr_b16 v[224:225], v4 offset:57856
    s_waitcnt vmcnt(9)
    v_mfma_f32_16x16x32_bf16 v[28:31], v[232:235], v[100:103], v[28:31]
    ds_read_b64_tr_b16 v[226:227], v4 offset:58880
    s_waitcnt lgkmcnt(6)
    v_mfma_f32_16x16x32_bf16 v[32:35], v[236:239], v[96:99], v[32:35]
    ds_read_b64_tr_b16 v[228:229], v5 offset:57888
    v_mfma_f32_16x16x32_bf16 v[36:39], v[236:239], v[100:103], v[36:39]
    ds_read_b64_tr_b16 v[230:231], v5 offset:58912
    s_mov_b32 s23, 0x2800
    buffer_load_dwordx4 v[128:131], v7, s[8:11], s23 offen offset:1024 sc1
    s_waitcnt lgkmcnt(6)
    v_mfma_f32_16x16x32_bf16 v[40:43], v[240:243], v[96:99], v[40:43]
    ds_read_b64_tr_b16 v[232:233], v4 offset:58112
    v_mfma_f32_16x16x32_bf16 v[44:47], v[240:243], v[100:103], v[44:47]
    ds_read_b64_tr_b16 v[234:235], v4 offset:59136
    s_waitcnt lgkmcnt(6)
    v_mfma_f32_16x16x32_bf16 v[48:51], v[244:247], v[96:99], v[48:51]
    ds_read_b64_tr_b16 v[236:237], v5 offset:58144
    v_mfma_f32_16x16x32_bf16 v[52:55], v[244:247], v[100:103], v[52:55]
    ds_read_b64_tr_b16 v[238:239], v5 offset:59168
    s_waitcnt lgkmcnt(6)
    v_mfma_f32_16x16x32_bf16 v[56:59], v[224:227], v[96:99], v[56:59]
    v_mfma_f32_16x16x32_bf16 v[60:63], v[224:227], v[100:103], v[60:63]
    s_waitcnt vmcnt(9)
    s_barrier
    ds_read_b64_tr_b16 v[240:241], v4 offset:0
    ds_read_b64_tr_b16 v[242:243], v4 offset:1024
    s_waitcnt lgkmcnt(6)
    v_mfma_f32_16x16x32_bf16 v[64:67], v[228:231], v[96:99], v[64:67]
    ds_read_b64_tr_b16 v[244:245], v5 offset:32
    v_mfma_f32_16x16x32_bf16 v[68:71], v[228:231], v[100:103], v[68:71]
    s_add_u32 s22, s19, 0x300000
    s_add_u32 m0, s20, 0x8000
    s_nop 0
    buffer_load_dwordx4 v3, s[4:7], s22 offen lds
    ds_read_b64_tr_b16 v[246:247], v5 offset:1056
    s_mov_b32 s23, 0xa800
    buffer_load_dwordx4 v[132:135], v7, s[8:11], s23 offen offset:1024 sc1
    s_waitcnt lgkmcnt(6)
    v_mfma_f32_16x16x32_bf16 v[72:75], v[232:235], v[96:99], v[72:75]
    ds_read_b64_tr_b16 v[224:225], v4 offset:256
    v_mfma_f32_16x16x32_bf16 v[76:79], v[232:235], v[100:103], v[76:79]
    ds_read_b64_tr_b16 v[226:227], v4 offset:1280
    s_waitcnt lgkmcnt(6)
    v_mfma_f32_16x16x32_bf16 v[80:83], v[236:239], v[96:99], v[80:83]
    ds_read_b64_tr_b16 v[228:229], v5 offset:288
    v_mfma_f32_16x16x32_bf16 v[84:87], v[236:239], v[100:103], v[84:87]
    ds_read_b64_tr_b16 v[230:231], v5 offset:1312
    s_waitcnt vmcnt(10) lgkmcnt(6)
    v_mfma_f32_16x16x32_bf16 v[24:27], v[240:243], v[104:107], v[24:27]
    ds_read_b64_tr_b16 v[232:233], v4 offset:512
    s_waitcnt vmcnt(9)
    v_mfma_f32_16x16x32_bf16 v[28:31], v[240:243], v[108:111], v[28:31]
    ds_read_b64_tr_b16 v[234:235], v4 offset:1536
    s_waitcnt lgkmcnt(6)
    v_mfma_f32_16x16x32_bf16 v[32:35], v[244:247], v[104:107], v[32:35]
    ds_read_b64_tr_b16 v[236:237], v5 offset:544
    v_mfma_f32_16x16x32_bf16 v[36:39], v[244:247], v[108:111], v[36:39]
    s_add_u32 s22, s19, 0x308000
    s_add_u32 m0, s20, 0x8400
    s_nop 0
    buffer_load_dwordx4 v3, s[4:7], s22 offen lds
    ds_read_b64_tr_b16 v[238:239], v5 offset:1568
    s_mov_b32 s23, 0x3000
    buffer_load_dwordx4 v[88:91], v7, s[8:11], s23 offen offset:0 sc1
    s_waitcnt lgkmcnt(6)
    v_mfma_f32_16x16x32_bf16 v[40:43], v[224:227], v[104:107], v[40:43]
    ds_read_b64_tr_b16 v[240:241], v4 offset:768
    v_mfma_f32_16x16x32_bf16 v[44:47], v[224:227], v[108:111], v[44:47]
    ds_read_b64_tr_b16 v[242:243], v4 offset:1792
    s_waitcnt lgkmcnt(6)
    v_mfma_f32_16x16x32_bf16 v[48:51], v[228:231], v[104:107], v[48:51]
    ds_read_b64_tr_b16 v[244:245], v5 offset:800
    v_mfma_f32_16x16x32_bf16 v[52:55], v[228:231], v[108:111], v[52:55]
    ds_read_b64_tr_b16 v[246:247], v5 offset:1824
    s_waitcnt lgkmcnt(6)
    v_mfma_f32_16x16x32_bf16 v[56:59], v[232:235], v[104:107], v[56:59]
    ds_read_b64_tr_b16 v[224:225], v4 offset:8192
    v_mfma_f32_16x16x32_bf16 v[60:63], v[232:235], v[108:111], v[60:63]
    ds_read_b64_tr_b16 v[226:227], v4 offset:9216
    s_waitcnt lgkmcnt(6)
    v_mfma_f32_16x16x32_bf16 v[64:67], v[236:239], v[104:107], v[64:67]
    ds_read_b64_tr_b16 v[228:229], v5 offset:8224
    v_mfma_f32_16x16x32_bf16 v[68:71], v[236:239], v[108:111], v[68:71]
    ds_read_b64_tr_b16 v[230:231], v5 offset:9248
    s_mov_b32 s23, 0xb000
    buffer_load_dwordx4 v[92:95], v7, s[8:11], s23 offen offset:0 sc1
    s_waitcnt lgkmcnt(6)
    v_mfma_f32_16x16x32_bf16 v[72:75], v[240:243], v[104:107], v[72:75]
    ds_read_b64_tr_b16 v[232:233], v4 offset:8448
    v_mfma_f32_16x16x32_bf16 v[76:79], v[240:243], v[108:111], v[76:79]
    ds_read_b64_tr_b16 v[234:235], v4 offset:9472
    s_waitcnt lgkmcnt(6)
    v_mfma_f32_16x16x32_bf16 v[80:83], v[244:247], v[104:107], v[80:83]
    ds_read_b64_tr_b16 v[236:237], v5 offset:8480
    v_mfma_f32_16x16x32_bf16 v[84:87], v[244:247], v[108:111], v[84:87]
    ds_read_b64_tr_b16 v[238:239], v5 offset:9504
    s_waitcnt vmcnt(11) lgkmcnt(6)
    v_mfma_f32_16x16x32_bf16 v[24:27], v[224:227], v[112:115], v[24:27]
    ds_read_b64_tr_b16 v[240:241], v4 offset:8704
    s_waitcnt vmcnt(9)
    v_mfma_f32_16x16x32_bf16 v[28:31], v[224:227], v[116:119], v[28:31]
    ds_read_b64_tr_b16 v[242:243], v4 offset:9728
    s_waitcnt lgkmcnt(6)
    v_mfma_f32_16x16x32_bf16 v[32:35], v[228:231], v[112:115], v[32:35]
    ds_read_b64_tr_b16 v[244:245], v5 offset:8736
    v_mfma_f32_16x16x32_bf16 v[36:39], v[228:231], v[116:119], v[36:39]
    ds_read_b64_tr_b16 v[246:247], v5 offset:9760
    s_mov_b32 s23, 0x3000
    buffer_load_dwordx4 v[96:99], v7, s[8:11], s23 offen offset:1024 sc1
    s_waitcnt lgkmcnt(6)
    v_mfma_f32_16x16x32_bf16 v[40:43], v[232:235], v[112:115], v[40:43]
    ds_read_b64_tr_b16 v[224:225], v4 offset:8960
    v_mfma_f32_16x16x32_bf16 v[44:47], v[232:235], v[116:119], v[44:47]
    ds_read_b64_tr_b16 v[226:227], v4 offset:9984
    s_waitcnt lgkmcnt(6)
    v_mfma_f32_16x16x32_bf16 v[48:51], v[236:239], v[112:115], v[48:51]
    ds_read_b64_tr_b16 v[228:229], v5 offset:8992
    v_mfma_f32_16x16x32_bf16 v[52:55], v[236:239], v[116:119], v[52:55]
    ds_read_b64_tr_b16 v[230:231], v5 offset:10016
    s_waitcnt lgkmcnt(6)
    v_mfma_f32_16x16x32_bf16 v[56:59], v[240:243], v[112:115], v[56:59]
    v_mfma_f32_16x16x32_bf16 v[60:63], v[240:243], v[116:119], v[60:63]
    s_waitcnt vmcnt(9)
    s_barrier
    ds_read_b64_tr_b16 v[232:233], v4 offset:16384
    ds_read_b64_tr_b16 v[234:235], v4 offset:17408
    s_waitcnt lgkmcnt(6)
    v_mfma_f32_16x16x32_bf16 v[64:67], v[244:247], v[112:115], v[64:67]
    ds_read_b64_tr_b16 v[236:237], v5 offset:16416
    v_mfma_f32_16x16x32_bf16 v[68:71], v[244:247], v[116:119], v[68:71]
    s_add_u32 s22, s19, 0x380000
    s_add_u32 m0, s20, 0xc000
    s_nop 0
    buffer_load_dwordx4 v3, s[4:7], s22 offen lds
    ds_read_b64_tr_b16 v[238:239], v5 offset:17440
    s_mov_b32 s23, 0xb000
    buffer_load_dwordx4 v[100:103], v7, s[8:11], s23 offen offset:1024 sc1
    s_waitcnt lgkmcnt(6)
    v_mfma_f32_16x16x32_bf16 v[72:75], v[224:227], v[112:115], v[72:75]
    ds_read_b64_tr_b16 v[240:241], v4 offset:16640
    v_mfma_f32_16x16x32_bf16 v[76:79], v[224:227], v[116:119], v[76:79]
    ds_read_b64_tr_b16 v[242:243], v4 offset:17664
    s_waitcnt lgkmcnt(6)
    v_mfma_f32_16x16x32_bf16 v[80:83], v[228:231], v[112:115], v[80:83]
    ds_read_b64_tr_b16 v[244:245], v5 offset:16672
    v_mfma_f32_16x16x32_bf16 v[84:87], v[228:231], v[116:119], v[84:87]
    ds_read_b64_tr_b16 v[246:247], v5 offset:17696
    s_waitcnt vmcnt(10) lgkmcnt(6)
    v_mfma_f32_16x16x32_bf16 v[24:27], v[232:235], v[120:123], v[24:27]
    ds_read_b64_tr_b16 v[224:225], v4 offset:16896
    s_waitcnt vmcnt(9)
    v_mfma_f32_16x16x32_bf16 v[28:31], v[232:235], v[124:127], v[28:31]
    ds_read_b64_tr_b16 v[226:227], v4 offset:17920
    s_waitcnt lgkmcnt(6)
    v_mfma_f32_16x16x32_bf16 v[32:35], v[236:239], v[120:123], v[32:35]
    ds_read_b64_tr_b16 v[228:229], v5 offset:16928
    v_mfma_f32_16x16x32_bf16 v[36:39], v[236:239], v[124:127], v[36:39]
    s_add_u32 s22, s19, 0x388000
    s_add_u32 m0, s20, 0xc400
    s_nop 0
    buffer_load_dwordx4 v3, s[4:7], s22 offen lds
    ds_read_b64_tr_b16 v[230:231], v5 offset:17952
    s_mov_b32 s23, 0x3800
    buffer_load_dwordx4 v[104:107], v7, s[8:11], s23 offen offset:0 sc1
    s_waitcnt lgkmcnt(6)
    v_mfma_f32_16x16x32_bf16 v[40:43], v[240:243], v[120:123], v[40:43]
    ds_read_b64_tr_b16 v[232:233], v4 offset:17152
    v_mfma_f32_16x16x32_bf16 v[44:47], v[240:243], v[124:127], v[44:47]
    ds_read_b64_tr_b16 v[234:235], v4 offset:18176
    s_waitcnt lgkmcnt(6)
    v_mfma_f32_16x16x32_bf16 v[48:51], v[244:247], v[120:123], v[48:51]
    ds_read_b64_tr_b16 v[236:237], v5 offset:17184
    v_mfma_f32_16x16x32_bf16 v[52:55], v[244:247], v[124:127], v[52:55]
    ds_read_b64_tr_b16 v[238:239], v5 offset:18208
    s_waitcnt lgkmcnt(6)
    v_mfma_f32_16x16x32_bf16 v[56:59], v[224:227], v[120:123], v[56:59]
    ds_read_b64_tr_b16 v[240:241], v4 offset:24576
    v_mfma_f32_16x16x32_bf16 v[60:63], v[224:227], v[124:127], v[60:63]
    ds_read_b64_tr_b16 v[242:243], v4 offset:25600
    s_waitcnt lgkmcnt(6)
    v_mfma_f32_16x16x32_bf16 v[64:67], v[228:231], v[120:123], v[64:67]
    ds_read_b64_tr_b16 v[244:245], v5 offset:24608
    v_mfma_f32_16x16x32_bf16 v[68:71], v[228:231], v[124:127], v[68:71]
    ds_read_b64_tr_b16 v[246:247], v5 offset:25632
    s_mov_b32 s23, 0xb800
    buffer_load_dwordx4 v[108:111], v7, s[8:11], s23 offen offset:0 sc1
    s_waitcnt lgkmcnt(6)
    v_mfma_f32_16x16x32_bf16 v[72:75], v[232:235], v[120:123], v[72:75]
    ds_read_b64_tr_b16 v[224:225], v4 offset:24832
    v_mfma_f32_16x16x32_bf16 v[76:79], v[232:235], v[124:127], v[76:79]
    ds_read_b64_tr_b16 v[226:227], v4 offset:25856
    s_waitcnt lgkmcnt(6)
    v_mfma_f32_16x16x32_bf16 v[80:83], v[236:239], v[120:123], v[80:83]
    ds_read_b64_tr_b16 v[228:229], v5 offset:24864
    v_mfma_f32_16x16x32_bf16 v[84:87], v[236:239], v[124:127], v[84:87]
    ds_read_b64_tr_b16 v[230:231], v5 offset:25888
    s_waitcnt vmcnt(11) lgkmcnt(6)
    v_mfma_f32_16x16x32_bf16 v[24:27], v[240:243], v[128:131], v[24:27]
    ds_read_b64_tr_b16 v[232:233], v4 offset:25088
    s_waitcnt vmcnt(9)
    v_mfma_f32_16x16x32_bf16 v[28:31], v[240:243], v[132:135], v[28:31]
    ds_read_b64_tr_b16 v[234:235], v4 offset:26112
    s_waitcnt lgkmcnt(6)
    v_mfma_f32_16x16x32_bf16 v[32:35], v[244:247], v[128:131], v[32:35]
    ds_read_b64_tr_b16 v[236:237], v5 offset:25120
    v_mfma_f32_16x16x32_bf16 v[36:39], v[244:247], v[132:135], v[36:39]
    ds_read_b64_tr_b16 v[238:239], v5 offset:26144
    s_mov_b32 s23, 0x3800
    buffer_load_dwordx4 v[112:115], v7, s[8:11], s23 offen offset:1024 sc1
    s_waitcnt lgkmcnt(6)
    v_mfma_f32_16x16x32_bf16 v[40:43], v[224:227], v[128:131], v[40:43]
    ds_read_b64_tr_b16 v[240:241], v4 offset:25344
    v_mfma_f32_16x16x32_bf16 v[44:47], v[224:227], v[132:135], v[44:47]
    ds_read_b64_tr_b16 v[242:243], v4 offset:26368
    s_waitcnt lgkmcnt(6)
    v_mfma_f32_16x16x32_bf16 v[48:51], v[228:231], v[128:131], v[48:51]
    ds_read_b64_tr_b16 v[244:245], v5 offset:25376
    v_mfma_f32_16x16x32_bf16 v[52:55], v[228:231], v[132:135], v[52:55]
    ds_read_b64_tr_b16 v[246:247], v5 offset:26400
    s_waitcnt lgkmcnt(6)
    v_mfma_f32_16x16x32_bf16 v[56:59], v[232:235], v[128:131], v[56:59]
    v_mfma_f32_16x16x32_bf16 v[60:63], v[232:235], v[132:135], v[60:63]
    s_waitcnt vmcnt(9)
    s_barrier
    ds_read_b64_tr_b16 v[224:225], v4 offset:32768
    ds_read_b64_tr_b16 v[226:227], v4 offset:33792
    s_waitcnt lgkmcnt(6)
    v_mfma_f32_16x16x32_bf16 v[64:67], v[236:239], v[128:131], v[64:67]
    ds_read_b64_tr_b16 v[228:229], v5 offset:32800
    v_mfma_f32_16x16x32_bf16 v[68:71], v[236:239], v[132:135], v[68:71]
    s_add_u32 s22, s19, 0x400000
    s_add_u32 m0, s20, 0x0
    s_nop 0
    buffer_load_dwordx4 v3, s[4:7], s22 offen lds
    ds_read_b64_tr_b16 v[230:231], v5 offset:33824
    s_mov_b32 s23, 0xb800
    buffer_load_dwordx4 v[116:119], v7, s[8:11], s23 offen offset:1024 sc1
    s_waitcnt lgkmcnt(6)
    v_mfma_f32_16x16x32_bf16 v[72:75], v[240:243], v[128:131], v[72:75]
    ds_read_b64_tr_b16 v[232:233], v4 offset:33024
    v_mfma_f32_16x16x32_bf16 v[76:79], v[240:243], v[132:135], v[76:79]
    ds_read_b64_tr_b16 v[234:235], v4 offset:34048
    s_waitcnt lgkmcnt(6)
    v_mfma_f32_16x16x32_bf16 v[80:83], v[244:247], v[128:131], v[80:83]
    ds_read_b64_tr_b16 v[236:237], v5 offset:33056
    v_mfma_f32_16x16x32_bf16 v[84:87], v[244:247], v[132:135], v[84:87]
    ds_read_b64_tr_b16 v[238:239], v5 offset:34080
    s_waitcnt vmcnt(10) lgkmcnt(6)
    v_mfma_f32_16x16x32_bf16 v[24:27], v[224:227], v[88:91], v[24:27]
    ds_read_b64_tr_b16 v[240:241], v4 offset:33280
    s_waitcnt vmcnt(9)
    v_mfma_f32_16x16x32_bf16 v[28:31], v[224:227], v[92:95], v[28:31]
    ds_read_b64_tr_b16 v[242:243], v4 offset:34304
    s_waitcnt lgkmcnt(6)
    v_mfma_f32_16x16x32_bf16 v[32:35], v[228:231], v[88:91], v[32:35]
    ds_read_b64_tr_b16 v[244:245], v5 offset:33312
    v_mfma_f32_16x16x32_bf16 v[36:39], v[228:231], v[92:95], v[36:39]
    s_add_u32 s22, s19, 0x408000
    s_add_u32 m0, s20, 0x400
    s_nop 0
    buffer_load_dwordx4 v3, s[4:7], s22 offen lds
    ds_read_b64_tr_b16 v[246:247], v5 offset:34336
    s_mov_b32 s23, 0x4000
    buffer_load_dwordx4 v[120:123], v7, s[8:11], s23 offen offset:0 sc1
    s_waitcnt lgkmcnt(6)
    v_mfma_f32_16x16x32_bf16 v[40:43], v[232:235], v[88:91], v[40:43]
    ds_read_b64_tr_b16 v[224:225], v4 offset:33536
    v_mfma_f32_16x16x32_bf16 v[44:47], v[232:235], v[92:95], v[44:47]
    ds_read_b64_tr_b16 v[226:227], v4 offset:34560
    s_waitcnt lgkmcnt(6)
    v_mfma_f32_16x16x32_bf16 v[48:51], v[236:239], v[88:91], v[48:51]
    ds_read_b64_tr_b16 v[228:229], v5 offset:33568
    v_mfma_f32_16x16x32_bf16 v[52:55], v[236:239], v[92:95], v[52:55]
    ds_read_b64_tr_b16 v[230:231], v5 offset:34592
    s_waitcnt lgkmcnt(6)
    v_mfma_f32_16x16x32_bf16 v[56:59], v[240:243], v[88:91], v[56:59]
    ds_read_b64_tr_b16 v[232:233], v4 offset:40960
    v_mfma_f32_16x16x32_bf16 v[60:63], v[240:243], v[92:95], v[60:63]
    ds_read_b64_tr_b16 v[234:235], v4 offset:41984
    s_waitcnt lgkmcnt(6)
    v_mfma_f32_16x16x32_bf16 v[64:67], v[244:247], v[88:91], v[64:67]
    ds_read_b64_tr_b16 v[236:237], v5 offset:40992
    v_mfma_f32_16x16x32_bf16 v[68:71], v[244:247], v[92:95], v[68:71]
    ds_read_b64_tr_b16 v[238:239], v5 offset:42016
    s_mov_b32 s23, 0xc000
    buffer_load_dwordx4 v[124:127], v7, s[8:11], s23 offen offset:0 sc1
    s_waitcnt lgkmcnt(6)
    v_mfma_f32_16x16x32_bf16 v[72:75], v[224:227], v[88:91], v[72:75]
    ds_read_b64_tr_b16 v[240:241], v4 offset:41216
    v_lshrrev_b32 v21, 4, v1
    v_lshlrev_b32 v21, 9, v21
    v_and_b32 v20, 15, v1
    v_lshl_add_u32 v21, v20, 4, v21
    s_lshr_b32 s18, s12, 3
    s_lshl_b32 s18, s18, 11
    s_add_u32 s18, s18, 0x528100
    buffer_load_dwordx4 v[12:15], v21, s[8:11], s18 offen sc1
    v_mfma_f32_16x16x32_bf16 v[76:79], v[224:227], v[92:95], v[76:79]
    ds_read_b64_tr_b16 v[242:243], v4 offset:42240
    s_waitcnt lgkmcnt(6)
    v_mfma_f32_16x16x32_bf16 v[80:83], v[228:231], v[88:91], v[80:83]
    ds_read_b64_tr_b16 v[244:245], v5 offset:41248
    v_mfma_f32_16x16x32_bf16 v[84:87], v[228:231], v[92:95], v[84:87]
    ds_read_b64_tr_b16 v[246:247], v5 offset:42272
    s_waitcnt vmcnt(12) lgkmcnt(6)
    v_mfma_f32_16x16x32_bf16 v[24:27], v[232:235], v[96:99], v[24:27]
    ds_read_b64_tr_b16 v[224:225], v4 offset:41472
    s_waitcnt vmcnt(10)
    v_mfma_f32_16x16x32_bf16 v[28:31], v[232:235], v[100:103], v[28:31]
    ds_read_b64_tr_b16 v[226:227], v4 offset:42496
    s_waitcnt lgkmcnt(6)
    v_mfma_f32_16x16x32_bf16 v[32:35], v[236:239], v[96:99], v[32:35]
    ds_read_b64_tr_b16 v[228:229], v5 offset:41504
    v_mfma_f32_16x16x32_bf16 v[36:39], v[236:239], v[100:103], v[36:39]
    ds_read_b64_tr_b16 v[230:231], v5 offset:42528
    s_mov_b32 s23, 0x4000
    buffer_load_dwordx4 v[128:131], v7, s[8:11], s23 offen offset:1024 sc1
    s_waitcnt lgkmcnt(6)
    v_mfma_f32_16x16x32_bf16 v[40:43], v[240:243], v[96:99], v[40:43]
    ds_read_b64_tr_b16 v[232:233], v4 offset:41728
    v_mfma_f32_16x16x32_bf16 v[44:47], v[240:243], v[100:103], v[44:47]
    ds_read_b64_tr_b16 v[234:235], v4 offset:42752
    s_waitcnt lgkmcnt(6)
    v_mfma_f32_16x16x32_bf16 v[48:51], v[244:247], v[96:99], v[48:51]
    ds_read_b64_tr_b16 v[236:237], v5 offset:41760
    v_mfma_f32_16x16x32_bf16 v[52:55], v[244:247], v[100:103], v[52:55]
    ds_read_b64_tr_b16 v[238:239], v5 offset:42784
    s_waitcnt lgkmcnt(6)
    v_mfma_f32_16x16x32_bf16 v[56:59], v[224:227], v[96:99], v[56:59]
    v_mfma_f32_16x16x32_bf16 v[60:63], v[224:227], v[100:103], v[60:63]
    s_waitcnt vmcnt(10)
    s_barrier
    ds_read_b64_tr_b16 v[240:241], v4 offset:49152
    ds_read_b64_tr_b16 v[242:243], v4 offset:50176
    s_waitcnt lgkmcnt(6)
    v_mfma_f32_16x16x32_bf16 v[64:67], v[228:231], v[96:99], v[64:67]
    ds_read_b64_tr_b16 v[244:245], v5 offset:49184
    v_mfma_f32_16x16x32_bf16 v[68:71], v[228:231], v[100:103], v[68:71]
    s_add_u32 s22, s19, 0x480000
    s_add_u32 m0, s20, 0x4000
    s_nop 0
    buffer_load_dwordx4 v3, s[4:7], s22 offen lds
    ds_read_b64_tr_b16 v[246:247], v5 offset:50208
    s_mov_b32 s23, 0xc000
    buffer_load_dwordx4 v[132:135], v7, s[8:11], s23 offen offset:1024 sc1
    s_waitcnt lgkmcnt(6)
    v_mfma_f32_16x16x32_bf16 v[72:75], v[232:235], v[96:99], v[72:75]
    ds_read_b64_tr_b16 v[224:225], v4 offset:49408
    v_mfma_f32_16x16x32_bf16 v[76:79], v[232:235], v[100:103], v[76:79]
    ds_read_b64_tr_b16 v[226:227], v4 offset:50432
    s_waitcnt lgkmcnt(6)
    v_mfma_f32_16x16x32_bf16 v[80:83], v[236:239], v[96:99], v[80:83]
    ds_read_b64_tr_b16 v[228:229], v5 offset:49440
    v_mfma_f32_16x16x32_bf16 v[84:87], v[236:239], v[100:103], v[84:87]
    ds_read_b64_tr_b16 v[230:231], v5 offset:50464
    s_waitcnt vmcnt(11) lgkmcnt(6)
    v_mfma_f32_16x16x32_bf16 v[24:27], v[240:243], v[104:107], v[24:27]
    ds_read_b64_tr_b16 v[232:233], v4 offset:49664
    s_waitcnt vmcnt(10)
    v_mfma_f32_16x16x32_bf16 v[28:31], v[240:243], v[108:111], v[28:31]
    ds_read_b64_tr_b16 v[234:235], v4 offset:50688
    s_waitcnt lgkmcnt(6)
    v_mfma_f32_16x16x32_bf16 v[32:35], v[244:247], v[104:107], v[32:35]
    ds_read_b64_tr_b16 v[236:237], v5 offset:49696
    v_mfma_f32_16x16x32_bf16 v[36:39], v[244:247], v[108:111], v[36:39]
    s_add_u32 s22, s19, 0x488000
    s_add_u32 m0, s20, 0x4400
    s_nop 0
    buffer_load_dwordx4 v3, s[4:7], s22 offen lds
    ds_read_b64_tr_b16 v[238:239], v5 offset:50720
    s_mov_b32 s23, 0x4800
    buffer_load_dwordx4 v[88:91], v7, s[8:11], s23 offen offset:0 sc1
    s_waitcnt lgkmcnt(6)
    v_mfma_f32_16x16x32_bf16 v[40:43], v[224:227], v[104:107], v[40:43]
    ds_read_b64_tr_b16 v[240:241], v4 offset:49920
    v_mfma_f32_16x16x32_bf16 v[44:47], v[224:227], v[108:111], v[44:47]
    ds_read_b64_tr_b16 v[242:243], v4 offset:50944
    s_waitcnt lgkmcnt(6)
    v_mfma_f32_16x16x32_bf16 v[48:51], v[228:231], v[104:107], v[48:51]
    ds_read_b64_tr_b16 v[244:245], v5 offset:49952
    v_mfma_f32_16x16x32_bf16 v[52:55], v[228:231], v[108:111], v[52:55]
    ds_read_b64_tr_b16 v[246:247], v5 offset:50976
    s_waitcnt lgkmcnt(6)
    v_mfma_f32_16x16x32_bf16 v[56:59], v[232:235], v[104:107], v[56:59]
    ds_read_b64_tr_b16 v[224:225], v4 offset:57344
    v_mfma_f32_16x16x32_bf16 v[60:63], v[232:235], v[108:111], v[60:63]
    ds_read_b64_tr_b16 v[226:227], v4 offset:58368
    s_waitcnt lgkmcnt(6)
    v_mfma_f32_16x16x32_bf16 v[64:67], v[236:239], v[104:107], v[64:67]
    ds_read_b64_tr_b16 v[228:229], v5 offset:57376
    v_mfma_f32_16x16x32_bf16 v[68:71], v[236:239], v[108:111], v[68:71]
    ds_read_b64_tr_b16 v[230:231], v5 offset:58400
    s_mov_b32 s23, 0xc800
    buffer_load_dwordx4 v[92:95], v7, s[8:11], s23 offen offset:0 sc1
    s_waitcnt lgkmcnt(6)
    v_mfma_f32_16x16x32_bf16 v[72:75], v[240:243], v[104:107], v[72:75]
    ds_read_b64_tr_b16 v[232:233], v4 offset:57600
    v_mfma_f32_16x16x32_bf16 v[76:79], v[240:243], v[108:111], v[76:79]
    ds_read_b64_tr_b16 v[234:235], v4 offset:58624
    s_waitcnt lgkmcnt(6)
    v_mfma_f32_16x16x32_bf16 v[80:83], v[244:247], v[104:107], v[80:83]
    ds_read_b64_tr_b16 v[236:237], v5 offset:57632
    v_mfma_f32_16x16x32_bf16 v[84:87], v[244:247], v[108:111], v[84:87]
    ds_read_b64_tr_b16 v[238:239], v5 offset:58656
    s_waitcnt vmcnt(12) lgkmcnt(6)
    v_mfma_f32_16x16x32_bf16 v[24:27], v[224:227], v[112:115], v[24:27]
    ds_read_b64_tr_b16 v[240:241], v4 offset:57856
    s_waitcnt vmcnt(10)
    v_mfma_f32_16x16x32_bf16 v[28:31], v[224:227], v[116:119], v[28:31]
    ds_read_b64_tr_b16 v[242:243], v4 offset:58880
    s_waitcnt lgkmcnt(6)
    v_mfma_f32_16x16x32_bf16 v[32:35], v[228:231], v[112:115], v[32:35]
    ds_read_b64_tr_b16 v[244:245], v5 offset:57888
    v_mfma_f32_16x16x32_bf16 v[36:39], v[228:231], v[116:119], v[36:39]
    ds_read_b64_tr_b16 v[246:247], v5 offset:58912
    s_mov_b32 s23, 0x4800
    buffer_load_dwordx4 v[96:99], v7, s[8:11], s23 offen offset:1024 sc1
    s_waitcnt lgkmcnt(6)
    v_mfma_f32_16x16x32_bf16 v[40:43], v[232:235], v[112:115], v[40:43]
    ds_read_b64_tr_b16 v[224:225], v4 offset:58112
    v_mfma_f32_16x16x32_bf16 v[44:47], v[232:235], v[116:119], v[44:47]
    ds_read_b64_tr_b16 v[226:227], v4 offset:59136
    s_waitcnt lgkmcnt(6)
    v_mfma_f32_16x16x32_bf16 v[48:51], v[236:239], v[112:115], v[48:51]
    ds_read_b64_tr_b16 v[228:229], v5 offset:58144
    v_mfma_f32_16x16x32_bf16 v[52:55], v[236:239], v[116:119], v[52:55]
    ds_read_b64_tr_b16 v[230:231], v5 offset:59168
    s_waitcnt lgkmcnt(6)
    v_mfma_f32_16x16x32_bf16 v[56:59], v[240:243], v[112:115], v[56:59]
    v_mfma_f32_16x16x32_bf16 v[60:63], v[240:243], v[116:119], v[60:63]
    s_waitcnt vmcnt(10)
    s_barrier
    ds_read_b64_tr_b16 v[232:233], v4 offset:0
    ds_read_b64_tr_b16 v[234:235], v4 offset:1024
    s_waitcnt lgkmcnt(6)
    v_mfma_f32_16x16x32_bf16 v[64:67], v[244:247], v[112:115], v[64:67]
    ds_read_b64_tr_b16 v[236:237], v5 offset:32
    v_mfma_f32_16x16x32_bf16 v[68:71], v[244:247], v[116:119], v[68:71]
    s_add_u32 s22, s19, 0x500000
    s_add_u32 m0, s20, 0x8000
    s_nop 0
    buffer_load_dwordx4 v3, s[4:7], s22 offen lds
    ds_read_b64_tr_b16 v[238:239], v5 offset:1056
    s_mov_b32 s23, 0xc800
    buffer_load_dwordx4 v[100:103], v7, s[8:11], s23 offen offset:1024 sc1
    s_waitcnt lgkmcnt(6)
    v_mfma_f32_16x16x32_bf16 v[72:75], v[224:227], v[112:115], v[72:75]
    ds_read_b64_tr_b16 v[240:241], v4 offset:256
    v_mfma_f32_16x16x32_bf16 v[76:79], v[224:227], v[116:119], v[76:79]
    ds_read_b64_tr_b16 v[242:243], v4 offset:1280
    s_waitcnt lgkmcnt(6)
    v_mfma_f32_16x16x32_bf16 v[80:83], v[228:231], v[112:115], v[80:83]
    ds_read_b64_tr_b16 v[244:245], v5 offset:288
    v_mfma_f32_16x16x32_bf16 v[84:87], v[228:231], v[116:119], v[84:87]
    ds_read_b64_tr_b16 v[246:247], v5 offset:1312
    s_waitcnt vmcnt(11) lgkmcnt(6)
    v_mfma_f32_16x16x32_bf16 v[24:27], v[232:235], v[120:123], v[24:27]
    ds_read_b64_tr_b16 v[224:225], v4 offset:512
    s_waitcnt vmcnt(10)
    v_mfma_f32_16x16x32_bf16 v[28:31], v[232:235], v[124:127], v[28:31]
    ds_read_b64_tr_b16 v[226:227], v4 offset:1536
    s_waitcnt lgkmcnt(6)
    v_mfma_f32_16x16x32_bf16 v[32:35], v[236:239], v[120:123], v[32:35]
    ds_read_b64_tr_b16 v[228:229], v5 offset:544
    v_mfma_f32_16x16x32_bf16 v[36:39], v[236:239], v[124:127], v[36:39]
    s_add_u32 s22, s19, 0x508000
    s_add_u32 m0, s20, 0x8400
    s_nop 0
    buffer_load_dwordx4 v3, s[4:7], s22 offen lds
    ds_read_b64_tr_b16 v[230:231], v5 offset:1568
    s_mov_b32 s23, 0x5000
    buffer_load_dwordx4 v[104:107], v7, s[8:11], s23 offen offset:0 sc1
    s_waitcnt lgkmcnt(6)
    v_mfma_f32_16x16x32_bf16 v[40:43], v[240:243], v[120:123], v[40:43]
    ds_read_b64_tr_b16 v[232:233], v4 offset:768
    v_mfma_f32_16x16x32_bf16 v[44:47], v[240:243], v[124:127], v[44:47]
    ds_read_b64_tr_b16 v[234:235], v4 offset:1792
    s_waitcnt lgkmcnt(6)
    v_mfma_f32_16x16x32_bf16 v[48:51], v[244:247], v[120:123], v[48:51]
    ds_read_b64_tr_b16 v[236:237], v5 offset:800
    v_mfma_f32_16x16x32_bf16 v[52:55], v[244:247], v[124:127], v[52:55]
    ds_read_b64_tr_b16 v[238:239], v5 offset:1824
    s_waitcnt lgkmcnt(6)
    v_mfma_f32_16x16x32_bf16 v[56:59], v[224:227], v[120:123], v[56:59]
    ds_read_b64_tr_b16 v[240:241], v4 offset:8192
    v_mfma_f32_16x16x32_bf16 v[60:63], v[224:227], v[124:127], v[60:63]
    ds_read_b64_tr_b16 v[242:243], v4 offset:9216
    s_waitcnt lgkmcnt(6)
    v_mfma_f32_16x16x32_bf16 v[64:67], v[228:231], v[120:123], v[64:67]
    ds_read_b64_tr_b16 v[244:245], v5 offset:8224
    v_mfma_f32_16x16x32_bf16 v[68:71], v[228:231], v[124:127], v[68:71]
    ds_read_b64_tr_b16 v[246:247], v5 offset:9248
    s_mov_b32 s23, 0xd000
    buffer_load_dwordx4 v[108:111], v7, s[8:11], s23 offen offset:0 sc1
    s_waitcnt lgkmcnt(6)
    v_mfma_f32_16x16x32_bf16 v[72:75], v[232:235], v[120:123], v[72:75]
    ds_read_b64_tr_b16 v[224:225], v4 offset:8448
    v_mfma_f32_16x16x32_bf16 v[76:79], v[232:235], v[124:127], v[76:79]
    ds_read_b64_tr_b16 v[226:227], v4 offset:9472
    s_waitcnt lgkmcnt(6)
    v_mfma_f32_16x16x32_bf16 v[80:83], v[236:239], v[120:123], v[80:83]
    ds_read_b64_tr_b16 v[228:229], v5 offset:8480
    v_mfma_f32_16x16x32_bf16 v[84:87], v[236:239], v[124:127], v[84:87]
    ds_read_b64_tr_b16 v[230:231], v5 offset:9504
    s_waitcnt vmcnt(11) lgkmcnt(6)
    v_mfma_f32_16x16x32_bf16 v[24:27], v[240:243], v[128:131], v[24:27]
    ds_read_b64_tr_b16 v[232:233], v4 offset:8704
    s_waitcnt vmcnt(9)
    v_mfma_f32_16x16x32_bf16 v[28:31], v[240:243], v[132:135], v[28:31]
    ds_read_b64_tr_b16 v[234:235], v4 offset:9728
    s_waitcnt lgkmcnt(6)
    v_mfma_f32_16x16x32_bf16 v[32:35], v[244:247], v[128:131], v[32:35]
    ds_read_b64_tr_b16 v[236:237], v5 offset:8736
    v_mfma_f32_16x16x32_bf16 v[36:39], v[244:247], v[132:135], v[36:39]
    ds_read_b64_tr_b16 v[238:239], v5 offset:9760
    s_mov_b32 s23, 0x5000
    buffer_load_dwordx4 v[112:115], v7, s[8:11], s23 offen offset:1024 sc1
    s_waitcnt lgkmcnt(6)
    v_mfma_f32_16x16x32_bf16 v[40:43], v[224:227], v[128:131], v[40:43]
    ds_read_b64_tr_b16 v[240:241], v4 offset:8960
    v_mfma_f32_16x16x32_bf16 v[44:47], v[224:227], v[132:135], v[44:47]
    ds_read_b64_tr_b16 v[242:243], v4 offset:9984
    s_waitcnt lgkmcnt(6)
    v_mfma_f32_16x16x32_bf16 v[48:51], v[228:231], v[128:131], v[48:51]
    ds_read_b64_tr_b16 v[244:245], v5 offset:8992
    v_mfma_f32_16x16x32_bf16 v[52:55], v[228:231], v[132:135], v[52:55]
    ds_read_b64_tr_b16 v[246:247], v5 offset:10016
    s_waitcnt lgkmcnt(6)
    v_mfma_f32_16x16x32_bf16 v[56:59], v[232:235], v[128:131], v[56:59]
    v_mfma_f32_16x16x32_bf16 v[60:63], v[232:235], v[132:135], v[60:63]
    s_waitcnt vmcnt(9)
    s_barrier
    ds_read_b64_tr_b16 v[224:225], v4 offset:16384
    ds_read_b64_tr_b16 v[226:227], v4 offset:17408
    s_waitcnt lgkmcnt(6)
    v_mfma_f32_16x16x32_bf16 v[64:67], v[236:239], v[128:131], v[64:67]
    ds_read_b64_tr_b16 v[228:229], v5 offset:16416
    v_mfma_f32_16x16x32_bf16 v[68:71], v[236:239], v[132:135], v[68:71]
    s_add_u32 s22, s19, 0x580000
    s_add_u32 m0, s20, 0xc000
    s_nop 0
    buffer_load_dwordx4 v3, s[4:7], s22 offen lds
    ds_read_b64_tr_b16 v[230:231], v5 offset:17440
    s_mov_b32 s23, 0xd000
    buffer_load_dwordx4 v[116:119], v7, s[8:11], s23 offen offset:1024 sc1
    s_waitcnt lgkmcnt(6)
    v_mfma_f32_16x16x32_bf16 v[72:75], v[240:243], v[128:131], v[72:75]
    ds_read_b64_tr_b16 v[232:233], v4 offset:16640
    v_mfma_f32_16x16x32_bf16 v[76:79], v[240:243], v[132:135], v[76:79]
    ds_read_b64_tr_b16 v[234:235], v4 offset:17664
    s_waitcnt lgkmcnt(6)
    v_mfma_f32_16x16x32_bf16 v[80:83], v[244:247], v[128:131], v[80:83]
    ds_read_b64_tr_b16 v[236:237], v5 offset:16672
    v_mfma_f32_16x16x32_bf16 v[84:87], v[244:247], v[132:135], v[84:87]
    ds_read_b64_tr_b16 v[238:239], v5 offset:17696
    s_waitcnt vmcnt(10) lgkmcnt(6)
    v_mfma_f32_16x16x32_bf16 v[24:27], v[224:227], v[88:91], v[24:27]
    ds_read_b64_tr_b16 v[240:241], v4 offset:16896
    s_waitcnt vmcnt(9)
    v_mfma_f32_16x16x32_bf16 v[28:31], v[224:227], v[92:95], v[28:31]
    ds_read_b64_tr_b16 v[242:243], v4 offset:17920
    s_waitcnt lgkmcnt(6)
    v_mfma_f32_16x16x32_bf16 v[32:35], v[228:231], v[88:91], v[32:35]
    ds_read_b64_tr_b16 v[244:245], v5 offset:16928
    v_mfma_f32_16x16x32_bf16 v[36:39], v[228:231], v[92:95], v[36:39]
    s_add_u32 s22, s19, 0x588000
    s_add_u32 m0, s20, 0xc400
    s_nop 0
    buffer_load_dwordx4 v3, s[4:7], s22 offen lds
    ds_read_b64_tr_b16 v[246:247], v5 offset:17952
    s_mov_b32 s23, 0x5800
    buffer_load_dwordx4 v[120:123], v7, s[8:11], s23 offen offset:0 sc1
    s_waitcnt lgkmcnt(6)
    v_mfma_f32_16x16x32_bf16 v[40:43], v[232:235], v[88:91], v[40:43]
    ds_read_b64_tr_b16 v[224:225], v4 offset:17152
    v_mfma_f32_16x16x32_bf16 v[44:47], v[232:235], v[92:95], v[44:47]
    ds_read_b64_tr_b16 v[226:227], v4 offset:18176
    s_waitcnt lgkmcnt(6)
    v_mfma_f32_16x16x32_bf16 v[48:51], v[236:239], v[88:91], v[48:51]
    ds_read_b64_tr_b16 v[228:229], v5 offset:17184
    v_mfma_f32_16x16x32_bf16 v[52:55], v[236:239], v[92:95], v[52:55]
    ds_read_b64_tr_b16 v[230:231], v5 offset:18208
    s_waitcnt lgkmcnt(6)
    v_mfma_f32_16x16x32_bf16 v[56:59], v[240:243], v[88:91], v[56:59]
    ds_read_b64_tr_b16 v[232:233], v4 offset:24576
    v_mfma_f32_16x16x32_bf16 v[60:63], v[240:243], v[92:95], v[60:63]
    ds_read_b64_tr_b16 v[234:235], v4 offset:25600
    s_waitcnt lgkmcnt(6)
    v_mfma_f32_16x16x32_bf16 v[64:67], v[244:247], v[88:91], v[64:67]
    ds_read_b64_tr_b16 v[236:237], v5 offset:24608
    v_mfma_f32_16x16x32_bf16 v[68:71], v[244:247], v[92:95], v[68:71]
    ds_read_b64_tr_b16 v[238:239], v5 offset:25632
    s_mov_b32 s23, 0xd800
    buffer_load_dwordx4 v[124:127], v7, s[8:11], s23 offen offset:0 sc1
    s_waitcnt lgkmcnt(6)
    v_mfma_f32_16x16x32_bf16 v[72:75], v[224:227], v[88:91], v[72:75]
    ds_read_b64_tr_b16 v[240:241], v4 offset:24832
    v_xor_b32 v8, s28, v12
    v_xor_b32 v20, s28, v13
    v_or_b32 v8, v8, v20
    v_xor_b32 v20, s28, v14
    v_or_b32 v8, v8, v20
    v_xor_b32 v20, s28, v15
    v_or_b32 v8, v8, v20
    v_cmp_ne_u32 vcc, 0, v8
    s_cbranch_vccnz adaLN_cond__sliding_block_cached__moe_arch_mod__prompt_kernel_kv16r
adaLN_cond__sliding_block_cached__moe_arch_mod__prompt_kernel_kv16b:
    v_mfma_f32_16x16x32_bf16 v[76:79], v[224:227], v[92:95], v[76:79]
    ds_read_b64_tr_b16 v[242:243], v4 offset:25856
    v_mov_b32 v20, 0
    s_mov_b32 s16, 0x564000
    buffer_load_dword v8, v20, s[8:11], s16 offen sc1
    s_waitcnt lgkmcnt(6)
    v_mfma_f32_16x16x32_bf16 v[80:83], v[228:231], v[88:91], v[80:83]
    ds_read_b64_tr_b16 v[244:245], v5 offset:24864
    v_mfma_f32_16x16x32_bf16 v[84:87], v[228:231], v[92:95], v[84:87]
    ds_read_b64_tr_b16 v[246:247], v5 offset:25888
    s_waitcnt vmcnt(12) lgkmcnt(6)
    v_mfma_f32_16x16x32_bf16 v[24:27], v[232:235], v[96:99], v[24:27]
    ds_read_b64_tr_b16 v[224:225], v4 offset:25088
    s_waitcnt vmcnt(10)
    v_mfma_f32_16x16x32_bf16 v[28:31], v[232:235], v[100:103], v[28:31]
    ds_read_b64_tr_b16 v[226:227], v4 offset:26112
    s_waitcnt lgkmcnt(6)
    v_mfma_f32_16x16x32_bf16 v[32:35], v[236:239], v[96:99], v[32:35]
    ds_read_b64_tr_b16 v[228:229], v5 offset:25120
    v_mfma_f32_16x16x32_bf16 v[36:39], v[236:239], v[100:103], v[36:39]
    ds_read_b64_tr_b16 v[230:231], v5 offset:26144
    s_mov_b32 s23, 0x5800
    buffer_load_dwordx4 v[128:131], v7, s[8:11], s23 offen offset:1024 sc1
    s_waitcnt lgkmcnt(6)
    v_mfma_f32_16x16x32_bf16 v[40:43], v[240:243], v[96:99], v[40:43]
    ds_read_b64_tr_b16 v[232:233], v4 offset:25344
    s_mov_b64 s[76:77], s[54:55]
    s_mov_b32 s78, 0xc00000
    s_mov_b32 s79, 0x20000
    v_bfe_u32 v20, v1, 2, 2
    v_lshlrev_b32 v20, 12, v20
    v_add_u32 v6, v3, v20
    s_lshr_b32 s16, s2, 5
    s_lshl_b32 s16, s16, 7
    s_lshl_b32 s17, s3, 3
    s_add_u32 s16, s16, s17
    s_mul_i32 s14, s16, 12288
    s_and_b32 s16, s2, 31
    s_lshl_b32 s16, s16, 8
    s_add_u32 s14, s14, s16
    s_add_u32 s14, s14, 4096
    v_mfma_f32_16x16x32_bf16 v[44:47], v[240:243], v[100:103], v[44:47]
    ds_read_b64_tr_b16 v[234:235], v4 offset:26368
    s_waitcnt lgkmcnt(6)
    v_mfma_f32_16x16x32_bf16 v[48:51], v[244:247], v[96:99], v[48:51]
    ds_read_b64_tr_b16 v[236:237], v5 offset:25376
    v_mfma_f32_16x16x32_bf16 v[52:55], v[244:247], v[100:103], v[52:55]
    ds_read_b64_tr_b16 v[238:239], v5 offset:26400
    s_waitcnt lgkmcnt(6)
    v_mfma_f32_16x16x32_bf16 v[56:59], v[224:227], v[96:99], v[56:59]
    v_mfma_f32_16x16x32_bf16 v[60:63], v[224:227], v[100:103], v[60:63]
    s_waitcnt vmcnt(10)
    s_barrier
    ds_read_b64_tr_b16 v[240:241], v4 offset:32768
    ds_read_b64_tr_b16 v[242:243], v4 offset:33792
    s_waitcnt lgkmcnt(6)
    v_mfma_f32_16x16x32_bf16 v[64:67], v[228:231], v[96:99], v[64:67]
    ds_read_b64_tr_b16 v[244:245], v5 offset:32800
    v_mfma_f32_16x16x32_bf16 v[68:71], v[228:231], v[100:103], v[68:71]
    s_add_u32 s22, s19, 0x600000
    s_add_u32 m0, s20, 0x0
    s_nop 0
    buffer_load_dwordx4 v3, s[4:7], s22 offen lds
    ds_read_b64_tr_b16 v[246:247], v5 offset:33824
    s_mov_b32 s23, 0xd800
    buffer_load_dwordx4 v[132:135], v7, s[8:11], s23 offen offset:1024 sc1
    s_waitcnt lgkmcnt(6)
    v_mfma_f32_16x16x32_bf16 v[72:75], v[232:235], v[96:99], v[72:75]
    ds_read_b64_tr_b16 v[224:225], v4 offset:33024
    v_mfma_f32_16x16x32_bf16 v[76:79], v[232:235], v[100:103], v[76:79]
    ds_read_b64_tr_b16 v[226:227], v4 offset:34048
    s_waitcnt lgkmcnt(6)
    v_mfma_f32_16x16x32_bf16 v[80:83], v[236:239], v[96:99], v[80:83]
    ds_read_b64_tr_b16 v[228:229], v5 offset:33056
    v_mfma_f32_16x16x32_bf16 v[84:87], v[236:239], v[100:103], v[84:87]
    ds_read_b64_tr_b16 v[230:231], v5 offset:34080
    s_waitcnt vmcnt(11) lgkmcnt(6)
    v_mfma_f32_16x16x32_bf16 v[24:27], v[240:243], v[104:107], v[24:27]
    ds_read_b64_tr_b16 v[232:233], v4 offset:33280
    s_waitcnt vmcnt(10)
    v_mfma_f32_16x16x32_bf16 v[28:31], v[240:243], v[108:111], v[28:31]
    ds_read_b64_tr_b16 v[234:235], v4 offset:34304
    s_waitcnt lgkmcnt(6)
    v_mfma_f32_16x16x32_bf16 v[32:35], v[244:247], v[104:107], v[32:35]
    ds_read_b64_tr_b16 v[236:237], v5 offset:33312
    v_mfma_f32_16x16x32_bf16 v[36:39], v[244:247], v[108:111], v[36:39]
    s_add_u32 s22, s19, 0x608000
    s_add_u32 m0, s20, 0x400
    s_nop 0
    buffer_load_dwordx4 v3, s[4:7], s22 offen lds
    ds_read_b64_tr_b16 v[238:239], v5 offset:34336
    s_mov_b32 s23, 0x6000
    buffer_load_dwordx4 v[88:91], v7, s[8:11], s23 offen offset:0 sc1
    s_waitcnt lgkmcnt(6)
    v_mfma_f32_16x16x32_bf16 v[40:43], v[224:227], v[104:107], v[40:43]
    ds_read_b64_tr_b16 v[240:241], v4 offset:33536
    v_mfma_f32_16x16x32_bf16 v[44:47], v[224:227], v[108:111], v[44:47]
    ds_read_b64_tr_b16 v[242:243], v4 offset:34560
    s_waitcnt lgkmcnt(6)
    v_mfma_f32_16x16x32_bf16 v[48:51], v[228:231], v[104:107], v[48:51]
    ds_read_b64_tr_b16 v[244:245], v5 offset:33568
    v_mfma_f32_16x16x32_bf16 v[52:55], v[228:231], v[108:111], v[52:55]
    ds_read_b64_tr_b16 v[246:247], v5 offset:34592
    s_waitcnt lgkmcnt(6)
    v_mfma_f32_16x16x32_bf16 v[56:59], v[232:235], v[104:107], v[56:59]
    ds_read_b64_tr_b16 v[224:225], v4 offset:40960
    v_mfma_f32_16x16x32_bf16 v[60:63], v[232:235], v[108:111], v[60:63]
    ds_read_b64_tr_b16 v[226:227], v4 offset:41984
    s_waitcnt lgkmcnt(6)
    v_mfma_f32_16x16x32_bf16 v[64:67], v[236:239], v[104:107], v[64:67]
    ds_read_b64_tr_b16 v[228:229], v5 offset:40992
    v_mfma_f32_16x16x32_bf16 v[68:71], v[236:239], v[108:111], v[68:71]
    ds_read_b64_tr_b16 v[230:231], v5 offset:42016
    s_mov_b32 s23, 0xe000
    buffer_load_dwordx4 v[92:95], v7, s[8:11], s23 offen offset:0 sc1
    s_waitcnt lgkmcnt(6)
    v_mfma_f32_16x16x32_bf16 v[72:75], v[240:243], v[104:107], v[72:75]
    ds_read_b64_tr_b16 v[232:233], v4 offset:41216
    v_mfma_f32_16x16x32_bf16 v[76:79], v[240:243], v[108:111], v[76:79]
    ds_read_b64_tr_b16 v[234:235], v4 offset:42240
    s_waitcnt lgkmcnt(6)
    v_mfma_f32_16x16x32_bf16 v[80:83], v[244:247], v[104:107], v[80:83]
    ds_read_b64_tr_b16 v[236:237], v5 offset:41248
    v_mfma_f32_16x16x32_bf16 v[84:87], v[244:247], v[108:111], v[84:87]
    ds_read_b64_tr_b16 v[238:239], v5 offset:42272
    s_waitcnt vmcnt(12) lgkmcnt(6)
    v_mfma_f32_16x16x32_bf16 v[24:27], v[224:227], v[112:115], v[24:27]
    ds_read_b64_tr_b16 v[240:241], v4 offset:41472
    s_add_u32 s22, s14, 0x0
    s_add_u32 m0, s20, 0x10000
    s_nop 0
    buffer_load_dwordx4 v6, s[76:79], s22 offen lds
    s_waitcnt vmcnt(11)
    v_mfma_f32_16x16x32_bf16 v[28:31], v[224:227], v[116:119], v[28:31]
    ds_read_b64_tr_b16 v[242:243], v4 offset:42496
    s_waitcnt lgkmcnt(6)
    v_mfma_f32_16x16x32_bf16 v[32:35], v[228:231], v[112:115], v[32:35]
    ds_read_b64_tr_b16 v[244:245], v5 offset:41504
    v_mfma_f32_16x16x32_bf16 v[36:39], v[228:231], v[116:119], v[36:39]
    ds_read_b64_tr_b16 v[246:247], v5 offset:42528
    s_mov_b32 s23, 0x6000
    buffer_load_dwordx4 v[96:99], v7, s[8:11], s23 offen offset:1024 sc1
    s_waitcnt lgkmcnt(6)
    v_mfma_f32_16x16x32_bf16 v[40:43], v[232:235], v[112:115], v[40:43]
    ds_read_b64_tr_b16 v[224:225], v4 offset:41728
    s_add_u32 s22, s14, 0xc000
    s_add_u32 m0, s20, 0x10400
    s_nop 0
    buffer_load_dwordx4 v6, s[76:79], s22 offen lds
    v_mfma_f32_16x16x32_bf16 v[44:47], v[232:235], v[116:119], v[44:47]
    ds_read_b64_tr_b16 v[226:227], v4 offset:42752
    s_waitcnt lgkmcnt(6)
    v_mfma_f32_16x16x32_bf16 v[48:51], v[236:239], v[112:115], v[48:51]
    ds_read_b64_tr_b16 v[228:229], v5 offset:41760
    v_mfma_f32_16x16x32_bf16 v[52:55], v[236:239], v[116:119], v[52:55]
    ds_read_b64_tr_b16 v[230:231], v5 offset:42784
    s_waitcnt lgkmcnt(6)
    v_mfma_f32_16x16x32_bf16 v[56:59], v[240:243], v[112:115], v[56:59]
    v_mfma_f32_16x16x32_bf16 v[60:63], v[240:243], v[116:119], v[60:63]
    s_waitcnt vmcnt(12)
    s_barrier
    ds_read_b64_tr_b16 v[232:233], v4 offset:49152
    ds_read_b64_tr_b16 v[234:235], v4 offset:50176
    s_waitcnt lgkmcnt(6)
    v_mfma_f32_16x16x32_bf16 v[64:67], v[244:247], v[112:115], v[64:67]
    ds_read_b64_tr_b16 v[236:237], v5 offset:49184
    v_mfma_f32_16x16x32_bf16 v[68:71], v[244:247], v[116:119], v[68:71]
    s_add_u32 s22, s19, 0x680000
    s_add_u32 m0, s20, 0x4000
    s_nop 0
    buffer_load_dwordx4 v3, s[4:7], s22 offen lds
    ds_read_b64_tr_b16 v[238:239], v5 offset:50208
    s_mov_b32 s23, 0xe000
    buffer_load_dwordx4 v[100:103], v7, s[8:11], s23 offen offset:1024 sc1
    s_waitcnt lgkmcnt(6)
    v_mfma_f32_16x16x32_bf16 v[72:75], v[224:227], v[112:115], v[72:75]
    ds_read_b64_tr_b16 v[240:241], v4 offset:49408
    v_mfma_f32_16x16x32_bf16 v[76:79], v[224:227], v[116:119], v[76:79]
    ds_read_b64_tr_b16 v[242:243], v4 offset:50432
    s_waitcnt lgkmcnt(6)
    v_mfma_f32_16x16x32_bf16 v[80:83], v[228:231], v[112:115], v[80:83]
    ds_read_b64_tr_b16 v[244:245], v5 offset:49440
    v_mfma_f32_16x16x32_bf16 v[84:87], v[228:231], v[116:119], v[84:87]
    ds_read_b64_tr_b16 v[246:247], v5 offset:50464
    s_waitcnt vmcnt(13) lgkmcnt(6)
    v_mfma_f32_16x16x32_bf16 v[24:27], v[232:235], v[120:123], v[24:27]
    ds_read_b64_tr_b16 v[224:225], v4 offset:49664
    s_waitcnt vmcnt(12)
    v_mfma_f32_16x16x32_bf16 v[28:31], v[232:235], v[124:127], v[28:31]
    ds_read_b64_tr_b16 v[226:227], v4 offset:50688
    s_waitcnt lgkmcnt(6)
    v_mfma_f32_16x16x32_bf16 v[32:35], v[236:239], v[120:123], v[32:35]
    ds_read_b64_tr_b16 v[228:229], v5 offset:49696
    v_mfma_f32_16x16x32_bf16 v[36:39], v[236:239], v[124:127], v[36:39]
    s_add_u32 s22, s19, 0x688000
    s_add_u32 m0, s20, 0x4400
    s_nop 0
    buffer_load_dwordx4 v3, s[4:7], s22 offen lds
    ds_read_b64_tr_b16 v[230:231], v5 offset:50720
    s_mov_b32 s23, 0x6800
    buffer_load_dwordx4 v[104:107], v7, s[8:11], s23 offen offset:0 sc1
    s_waitcnt lgkmcnt(6)
    v_mfma_f32_16x16x32_bf16 v[40:43], v[240:243], v[120:123], v[40:43]
    ds_read_b64_tr_b16 v[232:233], v4 offset:49920
    v_mfma_f32_16x16x32_bf16 v[44:47], v[240:243], v[124:127], v[44:47]
    ds_read_b64_tr_b16 v[234:235], v4 offset:50944
    s_waitcnt lgkmcnt(6)
    v_mfma_f32_16x16x32_bf16 v[48:51], v[244:247], v[120:123], v[48:51]
    ds_read_b64_tr_b16 v[236:237], v5 offset:49952
    v_mfma_f32_16x16x32_bf16 v[52:55], v[244:247], v[124:127], v[52:55]
    ds_read_b64_tr_b16 v[238:239], v5 offset:50976
    s_waitcnt lgkmcnt(6)
    v_mfma_f32_16x16x32_bf16 v[56:59], v[224:227], v[120:123], v[56:59]
    ds_read_b64_tr_b16 v[240:241], v4 offset:57344
    v_mfma_f32_16x16x32_bf16 v[60:63], v[224:227], v[124:127], v[60:63]
    ds_read_b64_tr_b16 v[242:243], v4 offset:58368
    s_waitcnt lgkmcnt(6)
    v_mfma_f32_16x16x32_bf16 v[64:67], v[228:231], v[120:123], v[64:67]
    ds_read_b64_tr_b16 v[244:245], v5 offset:57376
    v_mfma_f32_16x16x32_bf16 v[68:71], v[228:231], v[124:127], v[68:71]
    ds_read_b64_tr_b16 v[246:247], v5 offset:58400
    s_mov_b32 s23, 0xe800
    buffer_load_dwordx4 v[108:111], v7, s[8:11], s23 offen offset:0 sc1
    s_waitcnt lgkmcnt(6)
    v_mfma_f32_16x16x32_bf16 v[72:75], v[232:235], v[120:123], v[72:75]
    ds_read_b64_tr_b16 v[224:225], v4 offset:57600
    v_mfma_f32_16x16x32_bf16 v[76:79], v[232:235], v[124:127], v[76:79]
    ds_read_b64_tr_b16 v[226:227], v4 offset:58624
    s_waitcnt lgkmcnt(6)
    v_mfma_f32_16x16x32_bf16 v[80:83], v[236:239], v[120:123], v[80:83]
    ds_read_b64_tr_b16 v[228:229], v5 offset:57632
    v_mfma_f32_16x16x32_bf16 v[84:87], v[236:239], v[124:127], v[84:87]
    ds_read_b64_tr_b16 v[230:231], v5 offset:58656
    s_waitcnt vmcnt(13) lgkmcnt(6)
    v_mfma_f32_16x16x32_bf16 v[24:27], v[240:243], v[128:131], v[24:27]
    ds_read_b64_tr_b16 v[232:233], v4 offset:57856
    s_add_u32 s22, s14, 0xc0000
    s_add_u32 m0, s20, 0x14000
    s_nop 0
    buffer_load_dwordx4 v6, s[76:79], s22 offen lds
    s_waitcnt vmcnt(12)
    v_mfma_f32_16x16x32_bf16 v[28:31], v[240:243], v[132:135], v[28:31]
    ds_read_b64_tr_b16 v[234:235], v4 offset:58880
    s_waitcnt lgkmcnt(6)
    v_mfma_f32_16x16x32_bf16 v[32:35], v[244:247], v[128:131], v[32:35]
    ds_read_b64_tr_b16 v[236:237], v5 offset:57888
    v_mfma_f32_16x16x32_bf16 v[36:39], v[244:247], v[132:135], v[36:39]
    ds_read_b64_tr_b16 v[238:239], v5 offset:58912
    s_mov_b32 s23, 0x6800
    buffer_load_dwordx4 v[112:115], v7, s[8:11], s23 offen offset:1024 sc1
    s_waitcnt lgkmcnt(6)
    v_mfma_f32_16x16x32_bf16 v[40:43], v[224:227], v[128:131], v[40:43]
    ds_read_b64_tr_b16 v[240:241], v4 offset:58112
    s_add_u32 s22, s14, 0xcc000
    s_add_u32 m0, s20, 0x14400
    s_nop 0
    buffer_load_dwordx4 v6, s[76:79], s22 offen lds
    v_mfma_f32_16x16x32_bf16 v[44:47], v[224:227], v[132:135], v[44:47]
    ds_read_b64_tr_b16 v[242:243], v4 offset:59136
    s_waitcnt lgkmcnt(6)
    v_mfma_f32_16x16x32_bf16 v[48:51], v[228:231], v[128:131], v[48:51]
    ds_read_b64_tr_b16 v[244:245], v5 offset:58144
    v_mfma_f32_16x16x32_bf16 v[52:55], v[228:231], v[132:135], v[52:55]
    ds_read_b64_tr_b16 v[246:247], v5 offset:59168
    s_waitcnt lgkmcnt(6)
    v_mfma_f32_16x16x32_bf16 v[56:59], v[232:235], v[128:131], v[56:59]
    v_mfma_f32_16x16x32_bf16 v[60:63], v[232:235], v[132:135], v[60:63]
    s_waitcnt vmcnt(13)
    s_barrier
    ds_read_b64_tr_b16 v[224:225], v4 offset:0
    ds_read_b64_tr_b16 v[226:227], v4 offset:1024
    s_waitcnt lgkmcnt(6)
    v_mfma_f32_16x16x32_bf16 v[64:67], v[236:239], v[128:131], v[64:67]
    ds_read_b64_tr_b16 v[228:229], v5 offset:32
    v_mfma_f32_16x16x32_bf16 v[68:71], v[236:239], v[132:135], v[68:71]
    s_add_u32 s22, s19, 0x700000
    s_add_u32 m0, s20, 0x8000
    s_nop 0
    buffer_load_dwordx4 v3, s[4:7], s22 offen lds
    ds_read_b64_tr_b16 v[230:231], v5 offset:1056
    s_mov_b32 s23, 0xe800
    buffer_load_dwordx4 v[116:119], v7, s[8:11], s23 offen offset:1024 sc1
    s_waitcnt lgkmcnt(6)
    v_mfma_f32_16x16x32_bf16 v[72:75], v[240:243], v[128:131], v[72:75]
    ds_read_b64_tr_b16 v[232:233], v4 offset:256
    v_mfma_f32_16x16x32_bf16 v[76:79], v[240:243], v[132:135], v[76:79]
    ds_read_b64_tr_b16 v[234:235], v4 offset:1280
    s_waitcnt lgkmcnt(6)
    v_mfma_f32_16x16x32_bf16 v[80:83], v[244:247], v[128:131], v[80:83]
    ds_read_b64_tr_b16 v[236:237], v5 offset:288
    v_mfma_f32_16x16x32_bf16 v[84:87], v[244:247], v[132:135], v[84:87]
    ds_read_b64_tr_b16 v[238:239], v5 offset:1312
    s_waitcnt vmcnt(14) lgkmcnt(6)
    v_mfma_f32_16x16x32_bf16 v[24:27], v[224:227], v[88:91], v[24:27]
    ds_read_b64_tr_b16 v[240:241], v4 offset:512
    s_waitcnt vmcnt(13)
    v_mfma_f32_16x16x32_bf16 v[28:31], v[224:227], v[92:95], v[28:31]
    ds_read_b64_tr_b16 v[242:243], v4 offset:1536
    s_waitcnt lgkmcnt(6)
    v_mfma_f32_16x16x32_bf16 v[32:35], v[228:231], v[88:91], v[32:35]
    ds_read_b64_tr_b16 v[244:245], v5 offset:544
    v_mfma_f32_16x16x32_bf16 v[36:39], v[228:231], v[92:95], v[36:39]
    s_add_u32 s22, s19, 0x708000
    s_add_u32 m0, s20, 0x8400
    s_nop 0
    buffer_load_dwordx4 v3, s[4:7], s22 offen lds
    ds_read_b64_tr_b16 v[246:247], v5 offset:1568
    s_mov_b32 s23, 0x7000
    buffer_load_dwordx4 v[120:123], v7, s[8:11], s23 offen offset:0 sc1
    s_waitcnt lgkmcnt(6)
    v_mfma_f32_16x16x32_bf16 v[40:43], v[232:235], v[88:91], v[40:43]
    ds_read_b64_tr_b16 v[224:225], v4 offset:768
    v_mfma_f32_16x16x32_bf16 v[44:47], v[232:235], v[92:95], v[44:47]
    ds_read_b64_tr_b16 v[226:227], v4 offset:1792
    s_waitcnt lgkmcnt(6)
    v_mfma_f32_16x16x32_bf16 v[48:51], v[236:239], v[88:91], v[48:51]
    ds_read_b64_tr_b16 v[228:229], v5 offset:800
    v_mfma_f32_16x16x32_bf16 v[52:55], v[236:239], v[92:95], v[52:55]
    ds_read_b64_tr_b16 v[230:231], v5 offset:1824
    s_waitcnt lgkmcnt(6)
    v_mfma_f32_16x16x32_bf16 v[56:59], v[240:243], v[88:91], v[56:59]
    ds_read_b64_tr_b16 v[232:233], v4 offset:8192
    v_mfma_f32_16x16x32_bf16 v[60:63], v[240:243], v[92:95], v[60:63]
    ds_read_b64_tr_b16 v[234:235], v4 offset:9216
    s_waitcnt lgkmcnt(6)
    v_mfma_f32_16x16x32_bf16 v[64:67], v[244:247], v[88:91], v[64:67]
    ds_read_b64_tr_b16 v[236:237], v5 offset:8224
    v_mfma_f32_16x16x32_bf16 v[68:71], v[244:247], v[92:95], v[68:71]
    ds_read_b64_tr_b16 v[238:239], v5 offset:9248
    s_mov_b32 s23, 0xf000
    buffer_load_dwordx4 v[124:127], v7, s[8:11], s23 offen offset:0 sc1
    s_waitcnt lgkmcnt(6)
    v_mfma_f32_16x16x32_bf16 v[72:75], v[224:227], v[88:91], v[72:75]
    ds_read_b64_tr_b16 v[240:241], v4 offset:8448
    v_mfma_f32_16x16x32_bf16 v[76:79], v[224:227], v[92:95], v[76:79]
    ds_read_b64_tr_b16 v[242:243], v4 offset:9472
    s_waitcnt lgkmcnt(6)
    v_mfma_f32_16x16x32_bf16 v[80:83], v[228:231], v[88:91], v[80:83]
    ds_read_b64_tr_b16 v[244:245], v5 offset:8480
    v_mfma_f32_16x16x32_bf16 v[84:87], v[228:231], v[92:95], v[84:87]
    ds_read_b64_tr_b16 v[246:247], v5 offset:9504
    s_waitcnt vmcnt(14) lgkmcnt(6)
    v_mfma_f32_16x16x32_bf16 v[24:27], v[232:235], v[96:99], v[24:27]
    ds_read_b64_tr_b16 v[224:225], v4 offset:8704
    s_add_u32 s22, s21, 0x0
    s_add_u32 m0, s20, 0x18000
    s_nop 0
    buffer_load_dwordx4 v2, s[8:11], s22 offen sc1 lds
    s_waitcnt vmcnt(12)
    v_mfma_f32_16x16x32_bf16 v[28:31], v[232:235], v[100:103], v[28:31]
    ds_read_b64_tr_b16 v[226:227], v4 offset:9728
    s_waitcnt lgkmcnt(6)
    v_mfma_f32_16x16x32_bf16 v[32:35], v[236:239], v[96:99], v[32:35]
    ds_read_b64_tr_b16 v[228:229], v5 offset:8736
    v_mfma_f32_16x16x32_bf16 v[36:39], v[236:239], v[100:103], v[36:39]
    ds_read_b64_tr_b16 v[230:231], v5 offset:9760
    s_mov_b32 s23, 0x7000
    buffer_load_dwordx4 v[128:131], v7, s[8:11], s23 offen offset:1024 sc1
    s_waitcnt lgkmcnt(6)
    v_mfma_f32_16x16x32_bf16 v[40:43], v[240:243], v[96:99], v[40:43]
    ds_read_b64_tr_b16 v[232:233], v4 offset:8960
    s_add_u32 s22, s21, 0x400
    s_add_u32 m0, s20, 0x18400
    s_nop 0
    buffer_load_dwordx4 v2, s[8:11], s22 offen sc1 lds
    v_mfma_f32_16x16x32_bf16 v[44:47], v[240:243], v[100:103], v[44:47]
    ds_read_b64_tr_b16 v[234:235], v4 offset:9984
    s_waitcnt lgkmcnt(6)
    v_mfma_f32_16x16x32_bf16 v[48:51], v[244:247], v[96:99], v[48:51]
    ds_read_b64_tr_b16 v[236:237], v5 offset:8992
    v_mfma_f32_16x16x32_bf16 v[52:55], v[244:247], v[100:103], v[52:55]
    ds_read_b64_tr_b16 v[238:239], v5 offset:10016
    s_waitcnt lgkmcnt(6)
    v_mfma_f32_16x16x32_bf16 v[56:59], v[224:227], v[96:99], v[56:59]
    v_mfma_f32_16x16x32_bf16 v[60:63], v[224:227], v[100:103], v[60:63]
    s_waitcnt vmcnt(13)
    s_barrier
    ds_read_b64_tr_b16 v[240:241], v4 offset:16384
    ds_read_b64_tr_b16 v[242:243], v4 offset:17408
    s_waitcnt lgkmcnt(6)
    v_mfma_f32_16x16x32_bf16 v[64:67], v[228:231], v[96:99], v[64:67]
    ds_read_b64_tr_b16 v[244:245], v5 offset:16416
    v_mfma_f32_16x16x32_bf16 v[68:71], v[228:231], v[100:103], v[68:71]
    s_add_u32 s22, s19, 0x780000
    s_add_u32 m0, s20, 0xc000
    s_nop 0
    buffer_load_dwordx4 v3, s[4:7], s22 offen lds
    ds_read_b64_tr_b16 v[246:247], v5 offset:17440
    s_mov_b32 s23, 0xf000
    buffer_load_dwordx4 v[132:135], v7, s[8:11], s23 offen offset:1024 sc1
    s_waitcnt lgkmcnt(6)
    v_mfma_f32_16x16x32_bf16 v[72:75], v[232:235], v[96:99], v[72:75]
    ds_read_b64_tr_b16 v[224:225], v4 offset:16640
    v_mfma_f32_16x16x32_bf16 v[76:79], v[232:235], v[100:103], v[76:79]
    ds_read_b64_tr_b16 v[226:227], v4 offset:17664
    s_waitcnt lgkmcnt(6)
    v_mfma_f32_16x16x32_bf16 v[80:83], v[236:239], v[96:99], v[80:83]
    ds_read_b64_tr_b16 v[228:229], v5 offset:16672
    v_mfma_f32_16x16x32_bf16 v[84:87], v[236:239], v[100:103], v[84:87]
    ds_read_b64_tr_b16 v[230:231], v5 offset:17696
    s_waitcnt vmcnt(14) lgkmcnt(6)
    v_mfma_f32_16x16x32_bf16 v[24:27], v[240:243], v[104:107], v[24:27]
    ds_read_b64_tr_b16 v[232:233], v4 offset:16896
    s_waitcnt vmcnt(13)
    v_mfma_f32_16x16x32_bf16 v[28:31], v[240:243], v[108:111], v[28:31]
    ds_read_b64_tr_b16 v[234:235], v4 offset:17920
    s_waitcnt lgkmcnt(6)
    v_mfma_f32_16x16x32_bf16 v[32:35], v[244:247], v[104:107], v[32:35]
    ds_read_b64_tr_b16 v[236:237], v5 offset:16928
    v_mfma_f32_16x16x32_bf16 v[36:39], v[244:247], v[108:111], v[36:39]
    s_add_u32 s22, s19, 0x788000
    s_add_u32 m0, s20, 0xc400
    s_nop 0
    buffer_load_dwordx4 v3, s[4:7], s22 offen lds
    ds_read_b64_tr_b16 v[238:239], v5 offset:17952
    s_mov_b32 s23, 0x7800
    buffer_load_dwordx4 v[88:91], v7, s[8:11], s23 offen offset:0 sc1
    s_waitcnt lgkmcnt(6)
    v_mfma_f32_16x16x32_bf16 v[40:43], v[224:227], v[104:107], v[40:43]
    ds_read_b64_tr_b16 v[240:241], v4 offset:17152
    v_lshrrev_b32 v20, 4, v1
    v_lshlrev_b32 v21, 4, v20
    s_lshl_b32 s16, s2, 8
    s_add_u32 s16, s16, 0x550000
    buffer_load_dwordx4 v[136:139], v21, s[8:11], s16 offen offset:0 sc1
    buffer_load_dwordx4 v[140:143], v21, s[8:11], s16 offen offset:64 sc1
    buffer_load_dwordx4 v[144:147], v21, s[8:11], s16 offen offset:128 sc1
    buffer_load_dwordx4 v[148:151], v21, s[8:11], s16 offen offset:192 sc1
    v_lshlrev_b32 v11, 11, v20
    v_xor_b32 v20, s3, v20
    v_and_b32 v20, 1, v20
    v_lshl_add_u32 v11, v20, 5, v11
    v_bfe_u32 v20, v1, 2, 2
    v_lshl_add_u32 v11, v20, 6, v11
    v_and_b32 v20, 3, v1
    v_lshl_add_u32 v11, v20, 3, v11
    s_lshr_b32 s16, s3, 1
    s_lshl_b32 s16, s16, 8
    s_add_u32 s16, s16, 65536
    v_add_u32 v11, s16, v11
    v_mfma_f32_16x16x32_bf16 v[44:47], v[224:227], v[108:111], v[44:47]
    ds_read_b64_tr_b16 v[242:243], v4 offset:18176
    s_waitcnt lgkmcnt(6)
    v_mfma_f32_16x16x32_bf16 v[48:51], v[228:231], v[104:107], v[48:51]
    ds_read_b64_tr_b16 v[244:245], v5 offset:17184
    v_mfma_f32_16x16x32_bf16 v[52:55], v[228:231], v[108:111], v[52:55]
    ds_read_b64_tr_b16 v[246:247], v5 offset:18208
    s_waitcnt lgkmcnt(6)
    v_mfma_f32_16x16x32_bf16 v[56:59], v[232:235], v[104:107], v[56:59]
    ds_read_b64_tr_b16 v[224:225], v4 offset:24576
    v_mfma_f32_16x16x32_bf16 v[60:63], v[232:235], v[108:111], v[60:63]
    ds_read_b64_tr_b16 v[226:227], v4 offset:25600
    s_waitcnt lgkmcnt(6)
    v_mfma_f32_16x16x32_bf16 v[64:67], v[236:239], v[104:107], v[64:67]
    ds_read_b64_tr_b16 v[228:229], v5 offset:24608
    v_mfma_f32_16x16x32_bf16 v[68:71], v[236:239], v[108:111], v[68:71]
    ds_read_b64_tr_b16 v[230:231], v5 offset:25632
    s_mov_b32 s23, 0xf800
    buffer_load_dwordx4 v[92:95], v7, s[8:11], s23 offen offset:0 sc1
    s_waitcnt lgkmcnt(6)
    v_mfma_f32_16x16x32_bf16 v[72:75], v[240:243], v[104:107], v[72:75]
    ds_read_b64_tr_b16 v[232:233], v4 offset:24832
    v_mfma_f32_16x16x32_bf16 v[76:79], v[240:243], v[108:111], v[76:79]
    ds_read_b64_tr_b16 v[234:235], v4 offset:25856
    s_waitcnt lgkmcnt(6)
    v_mfma_f32_16x16x32_bf16 v[80:83], v[244:247], v[104:107], v[80:83]
    ds_read_b64_tr_b16 v[236:237], v5 offset:24864
    v_mfma_f32_16x16x32_bf16 v[84:87], v[244:247], v[108:111], v[84:87]
    ds_read_b64_tr_b16 v[238:239], v5 offset:25888
    s_waitcnt vmcnt(18) lgkmcnt(6)
    v_mfma_f32_16x16x32_bf16 v[24:27], v[224:227], v[112:115], v[24:27]
    ds_read_b64_tr_b16 v[240:241], v4 offset:25088
    s_add_u32 s22, s21, 0x4000
    s_add_u32 m0, s20, 0x1c000
    s_nop 0
    buffer_load_dwordx4 v2, s[8:11], s22 offen sc1 lds
    s_waitcnt vmcnt(16)
    v_mfma_f32_16x16x32_bf16 v[28:31], v[224:227], v[116:119], v[28:31]
    ds_read_b64_tr_b16 v[242:243], v4 offset:26112
    s_waitcnt lgkmcnt(6)
    v_mfma_f32_16x16x32_bf16 v[32:35], v[228:231], v[112:115], v[32:35]
    ds_read_b64_tr_b16 v[244:245], v5 offset:25120
    v_mfma_f32_16x16x32_bf16 v[36:39], v[228:231], v[116:119], v[36:39]
    ds_read_b64_tr_b16 v[246:247], v5 offset:26144
    s_mov_b32 s23, 0x7800
    buffer_load_dwordx4 v[96:99], v7, s[8:11], s23 offen offset:1024 sc1
    s_waitcnt lgkmcnt(6)
    v_mfma_f32_16x16x32_bf16 v[40:43], v[232:235], v[112:115], v[40:43]
    ds_read_b64_tr_b16 v[224:225], v4 offset:25344
    s_add_u32 s22, s21, 0x4400
    s_add_u32 m0, s20, 0x1c400
    s_nop 0
    buffer_load_dwordx4 v2, s[8:11], s22 offen sc1 lds
    v_mfma_f32_16x16x32_bf16 v[44:47], v[232:235], v[116:119], v[44:47]
    ds_read_b64_tr_b16 v[226:227], v4 offset:26368
    s_waitcnt lgkmcnt(6)
    v_mfma_f32_16x16x32_bf16 v[48:51], v[236:239], v[112:115], v[48:51]
    ds_read_b64_tr_b16 v[228:229], v5 offset:25376
    v_mfma_f32_16x16x32_bf16 v[52:55], v[236:239], v[116:119], v[52:55]
    ds_read_b64_tr_b16 v[230:231], v5 offset:26400
    s_waitcnt lgkmcnt(6)
    v_mfma_f32_16x16x32_bf16 v[56:59], v[240:243], v[112:115], v[56:59]
    v_mfma_f32_16x16x32_bf16 v[60:63], v[240:243], v[116:119], v[60:63]
    s_waitcnt vmcnt(17)
    s_barrier
    ds_read_b64_tr_b16 v[232:233], v4 offset:32768
    ds_read_b64_tr_b16 v[234:235], v4 offset:33792
    s_waitcnt lgkmcnt(6)
    v_mfma_f32_16x16x32_bf16 v[64:67], v[244:247], v[112:115], v[64:67]
    ds_read_b64_tr_b16 v[236:237], v5 offset:32800
    v_mfma_f32_16x16x32_bf16 v[68:71], v[244:247], v[116:119], v[68:71]
    ds_read_b64_tr_b16 v[238:239], v5 offset:33824
    s_mov_b32 s23, 0xf800
    buffer_load_dwordx4 v[100:103], v7, s[8:11], s23 offen offset:1024 sc1
    s_waitcnt lgkmcnt(6)
    v_mfma_f32_16x16x32_bf16 v[72:75], v[224:227], v[112:115], v[72:75]
    ds_read_b64_tr_b16 v[240:241], v4 offset:33024
    v_mfma_f32_16x16x32_bf16 v[76:79], v[224:227], v[116:119], v[76:79]
    ds_read_b64_tr_b16 v[242:243], v4 offset:34048
    s_waitcnt lgkmcnt(6)
    v_mfma_f32_16x16x32_bf16 v[80:83], v[228:231], v[112:115], v[80:83]
    ds_read_b64_tr_b16 v[244:245], v5 offset:33056
    v_mfma_f32_16x16x32_bf16 v[84:87], v[228:231], v[116:119], v[84:87]
    ds_read_b64_tr_b16 v[246:247], v5 offset:34080
    s_waitcnt vmcnt(17) lgkmcnt(6)
    v_mfma_f32_16x16x32_bf16 v[24:27], v[232:235], v[120:123], v[24:27]
    ds_read_b64_tr_b16 v[224:225], v4 offset:33280
    s_waitcnt vmcnt(16)
    v_mfma_f32_16x16x32_bf16 v[28:31], v[232:235], v[124:127], v[28:31]
    ds_read_b64_tr_b16 v[226:227], v4 offset:34304
    s_waitcnt lgkmcnt(6)
    v_mfma_f32_16x16x32_bf16 v[32:35], v[236:239], v[120:123], v[32:35]
    ds_read_b64_tr_b16 v[228:229], v5 offset:33312
    v_mfma_f32_16x16x32_bf16 v[36:39], v[236:239], v[124:127], v[36:39]
    ds_read_b64_tr_b16 v[230:231], v5 offset:34336
    s_waitcnt lgkmcnt(6)
    v_mfma_f32_16x16x32_bf16 v[40:43], v[240:243], v[120:123], v[40:43]
    ds_read_b64_tr_b16 v[232:233], v4 offset:33536
    v_mfma_f32_16x16x32_bf16 v[44:47], v[240:243], v[124:127], v[44:47]
    ds_read_b64_tr_b16 v[234:235], v4 offset:34560
    s_waitcnt lgkmcnt(6)
    v_mfma_f32_16x16x32_bf16 v[48:51], v[244:247], v[120:123], v[48:51]
    ds_read_b64_tr_b16 v[236:237], v5 offset:33568
    v_mfma_f32_16x16x32_bf16 v[52:55], v[244:247], v[124:127], v[52:55]
    ds_read_b64_tr_b16 v[238:239], v5 offset:34592
    s_waitcnt lgkmcnt(6)
    v_mfma_f32_16x16x32_bf16 v[56:59], v[224:227], v[120:123], v[56:59]
    ds_read_b64_tr_b16 v[240:241], v4 offset:40960
    v_mfma_f32_16x16x32_bf16 v[60:63], v[224:227], v[124:127], v[60:63]
    ds_read_b64_tr_b16 v[242:243], v4 offset:41984
    s_waitcnt lgkmcnt(6)
    v_mfma_f32_16x16x32_bf16 v[64:67], v[228:231], v[120:123], v[64:67]
    ds_read_b64_tr_b16 v[244:245], v5 offset:40992
    v_mfma_f32_16x16x32_bf16 v[68:71], v[228:231], v[124:127], v[68:71]
    ds_read_b64_tr_b16 v[246:247], v5 offset:42016
    s_waitcnt lgkmcnt(6)
    v_mfma_f32_16x16x32_bf16 v[72:75], v[232:235], v[120:123], v[72:75]
    ds_read_b64_tr_b16 v[224:225], v4 offset:41216
    v_mfma_f32_16x16x32_bf16 v[76:79], v[232:235], v[124:127], v[76:79]
    ds_read_b64_tr_b16 v[226:227], v4 offset:42240
    s_waitcnt lgkmcnt(6)
    v_mfma_f32_16x16x32_bf16 v[80:83], v[236:239], v[120:123], v[80:83]
    ds_read_b64_tr_b16 v[228:229], v5 offset:41248
    v_mfma_f32_16x16x32_bf16 v[84:87], v[236:239], v[124:127], v[84:87]
    ds_read_b64_tr_b16 v[230:231], v5 offset:42272
    s_waitcnt vmcnt(14) lgkmcnt(6)
    v_mfma_f32_16x16x32_bf16 v[24:27], v[240:243], v[128:131], v[24:27]
    ds_read_b64_tr_b16 v[232:233], v4 offset:41472
    s_waitcnt vmcnt(11)
    v_mfma_f32_16x16x32_bf16 v[28:31], v[240:243], v[132:135], v[28:31]
    ds_read_b64_tr_b16 v[234:235], v4 offset:42496
    s_waitcnt lgkmcnt(6)
    v_mfma_f32_16x16x32_bf16 v[32:35], v[244:247], v[128:131], v[32:35]
    ds_read_b64_tr_b16 v[236:237], v5 offset:41504
    v_mfma_f32_16x16x32_bf16 v[36:39], v[244:247], v[132:135], v[36:39]
    ds_read_b64_tr_b16 v[238:239], v5 offset:42528
    s_waitcnt lgkmcnt(6)
    v_mfma_f32_16x16x32_bf16 v[40:43], v[224:227], v[128:131], v[40:43]
    ds_read_b64_tr_b16 v[240:241], v4 offset:41728
    v_mfma_f32_16x16x32_bf16 v[44:47], v[224:227], v[132:135], v[44:47]
    ds_read_b64_tr_b16 v[242:243], v4 offset:42752
    s_waitcnt lgkmcnt(6)
    v_mfma_f32_16x16x32_bf16 v[48:51], v[228:231], v[128:131], v[48:51]
    ds_read_b64_tr_b16 v[244:245], v5 offset:41760
    v_mfma_f32_16x16x32_bf16 v[52:55], v[228:231], v[132:135], v[52:55]
    ds_read_b64_tr_b16 v[246:247], v5 offset:42784
    s_waitcnt lgkmcnt(6)
    v_mfma_f32_16x16x32_bf16 v[56:59], v[232:235], v[128:131], v[56:59]
    v_mfma_f32_16x16x32_bf16 v[60:63], v[232:235], v[132:135], v[60:63]
    s_waitcnt vmcnt(10)
    s_barrier
    ds_read_b64_tr_b16 v[224:225], v4 offset:49152
    ds_read_b64_tr_b16 v[226:227], v4 offset:50176
    s_waitcnt lgkmcnt(6)
    v_mfma_f32_16x16x32_bf16 v[64:67], v[236:239], v[128:131], v[64:67]
    ds_read_b64_tr_b16 v[228:229], v5 offset:49184
    v_mfma_f32_16x16x32_bf16 v[68:71], v[236:239], v[132:135], v[68:71]
    ds_read_b64_tr_b16 v[230:231], v5 offset:50208
    s_waitcnt lgkmcnt(6)
    v_mfma_f32_16x16x32_bf16 v[72:75], v[240:243], v[128:131], v[72:75]
    ds_read_b64_tr_b16 v[232:233], v4 offset:49408
    v_mfma_f32_16x16x32_bf16 v[76:79], v[240:243], v[132:135], v[76:79]
    ds_read_b64_tr_b16 v[234:235], v4 offset:50432
    s_waitcnt lgkmcnt(6)
    v_mfma_f32_16x16x32_bf16 v[80:83], v[244:247], v[128:131], v[80:83]
    ds_read_b64_tr_b16 v[236:237], v5 offset:49440
    v_mfma_f32_16x16x32_bf16 v[84:87], v[244:247], v[132:135], v[84:87]
    ds_read_b64_tr_b16 v[238:239], v5 offset:50464
    s_waitcnt vmcnt(9) lgkmcnt(6)
    v_mfma_f32_16x16x32_bf16 v[24:27], v[224:227], v[88:91], v[24:27]
    ds_read_b64_tr_b16 v[240:241], v4 offset:49664
    s_waitcnt vmcnt(4)
    v_mfma_f32_16x16x32_bf16 v[28:31], v[224:227], v[92:95], v[28:31]
    ds_read_b64_tr_b16 v[242:243], v4 offset:50688
    s_waitcnt lgkmcnt(6)
    v_mfma_f32_16x16x32_bf16 v[32:35], v[228:231], v[88:91], v[32:35]
    ds_read_b64_tr_b16 v[244:245], v5 offset:49696
    v_mfma_f32_16x16x32_bf16 v[36:39], v[228:231], v[92:95], v[36:39]
    ds_read_b64_tr_b16 v[246:247], v5 offset:50720
    s_waitcnt lgkmcnt(6)
    v_mfma_f32_16x16x32_bf16 v[40:43], v[232:235], v[88:91], v[40:43]
    ds_read_b64_tr_b16 v[224:225], v4 offset:49920
    v_mfma_f32_16x16x32_bf16 v[44:47], v[232:235], v[92:95], v[44:47]
    ds_read_b64_tr_b16 v[226:227], v4 offset:50944
    s_waitcnt lgkmcnt(6)
    v_mfma_f32_16x16x32_bf16 v[48:51], v[236:239], v[88:91], v[48:51]
    ds_read_b64_tr_b16 v[228:229], v5 offset:49952
    v_mfma_f32_16x16x32_bf16 v[52:55], v[236:239], v[92:95], v[52:55]
    ds_read_b64_tr_b16 v[230:231], v5 offset:50976
    s_waitcnt lgkmcnt(6)
    v_mfma_f32_16x16x32_bf16 v[56:59], v[240:243], v[88:91], v[56:59]
    ds_read_b64_tr_b16 v[232:233], v4 offset:57344
    v_mfma_f32_16x16x32_bf16 v[60:63], v[240:243], v[92:95], v[60:63]
    ds_read_b64_tr_b16 v[234:235], v4 offset:58368
    s_waitcnt lgkmcnt(6)
    v_mfma_f32_16x16x32_bf16 v[64:67], v[244:247], v[88:91], v[64:67]
    ds_read_b64_tr_b16 v[236:237], v5 offset:57376
    v_mfma_f32_16x16x32_bf16 v[68:71], v[244:247], v[92:95], v[68:71]
    ds_read_b64_tr_b16 v[238:239], v5 offset:58400
    s_waitcnt lgkmcnt(6)
    v_mfma_f32_16x16x32_bf16 v[72:75], v[224:227], v[88:91], v[72:75]
    ds_read_b64_tr_b16 v[240:241], v4 offset:57600
    v_mfma_f32_16x16x32_bf16 v[76:79], v[224:227], v[92:95], v[76:79]
    ds_read_b64_tr_b16 v[242:243], v4 offset:58624
    s_waitcnt lgkmcnt(6)
    v_mfma_f32_16x16x32_bf16 v[80:83], v[228:231], v[88:91], v[80:83]
    ds_read_b64_tr_b16 v[244:245], v5 offset:57632
    v_mfma_f32_16x16x32_bf16 v[84:87], v[228:231], v[92:95], v[84:87]
    ds_read_b64_tr_b16 v[246:247], v5 offset:58656
    s_waitcnt vmcnt(2) lgkmcnt(6)
    v_mfma_f32_16x16x32_bf16 v[24:27], v[232:235], v[96:99], v[24:27]
    ds_read_b64_tr_b16 v[224:225], v4 offset:57856
    s_waitcnt vmcnt(0)
    v_mfma_f32_16x16x32_bf16 v[28:31], v[232:235], v[100:103], v[28:31]
    ds_read_b64_tr_b16 v[226:227], v4 offset:58880
    s_waitcnt lgkmcnt(6)
    v_mfma_f32_16x16x32_bf16 v[32:35], v[236:239], v[96:99], v[32:35]
    ds_read_b64_tr_b16 v[228:229], v5 offset:57888
    v_mfma_f32_16x16x32_bf16 v[36:39], v[236:239], v[100:103], v[36:39]
    ds_read_b64_tr_b16 v[230:231], v5 offset:58912
    s_waitcnt lgkmcnt(6)
    v_mfma_f32_16x16x32_bf16 v[40:43], v[240:243], v[96:99], v[40:43]
    ds_read_b64_tr_b16 v[232:233], v4 offset:58112
    v_mfma_f32_16x16x32_bf16 v[44:47], v[240:243], v[100:103], v[44:47]
    ds_read_b64_tr_b16 v[234:235], v4 offset:59136
    s_waitcnt lgkmcnt(6)
    v_mfma_f32_16x16x32_bf16 v[48:51], v[244:247], v[96:99], v[48:51]
    ds_read_b64_tr_b16 v[236:237], v5 offset:58144
    v_mfma_f32_16x16x32_bf16 v[52:55], v[244:247], v[100:103], v[52:55]
    ds_read_b64_tr_b16 v[238:239], v5 offset:59168
    s_waitcnt lgkmcnt(6)
    v_mfma_f32_16x16x32_bf16 v[56:59], v[224:227], v[96:99], v[56:59]
    v_mfma_f32_16x16x32_bf16 v[60:63], v[224:227], v[100:103], v[60:63]
    s_waitcnt lgkmcnt(4)
    v_mfma_f32_16x16x32_bf16 v[64:67], v[228:231], v[96:99], v[64:67]
    v_mfma_f32_16x16x32_bf16 v[68:71], v[228:231], v[100:103], v[68:71]
    s_waitcnt lgkmcnt(2)
    v_mfma_f32_16x16x32_bf16 v[72:75], v[232:235], v[96:99], v[72:75]
    v_mfma_f32_16x16x32_bf16 v[76:79], v[232:235], v[100:103], v[76:79]
    s_waitcnt lgkmcnt(0)
    v_mfma_f32_16x16x32_bf16 v[80:83], v[236:239], v[96:99], v[80:83]
    v_mfma_f32_16x16x32_bf16 v[84:87], v[236:239], v[100:103], v[84:87]
    s_barrier
    s_add_u32 s22, s21, 0x8000
    s_add_u32 m0, s20, 0x20000
    s_nop 0
    buffer_load_dwordx4 v2, s[8:11], s22 offen sc1 lds
    s_add_u32 s22, s21, 0x8400
    s_add_u32 m0, s20, 0x20400
    s_nop 0
    buffer_load_dwordx4 v2, s[8:11], s22 offen sc1 lds
    s_add_u32 s22, s21, 0xc000
    s_add_u32 m0, s20, 0x24000
    s_nop 0
    buffer_load_dwordx4 v2, s[8:11], s22 offen sc1 lds
    s_add_u32 s22, s21, 0xc400
    s_add_u32 m0, s20, 0x24400
    s_nop 0
    buffer_load_dwordx4 v2, s[8:11], s22 offen sc1 lds
    ds_read_b64_tr_b16 v[88:89], v11 offset:0
    ds_read_b64_tr_b16 v[90:91], v11 offset:1024
    ds_read_b64_tr_b16 v[92:93], v11 offset:8192
    ds_read_b64_tr_b16 v[94:95], v11 offset:9216
    ds_read_b64_tr_b16 v[96:97], v11 offset:16384
    ds_read_b64_tr_b16 v[98:99], v11 offset:17408
    ds_read_b64_tr_b16 v[100:101], v11 offset:24576
    ds_read_b64_tr_b16 v[102:103], v11 offset:25600
    s_mov_b32 s23, 0x3e0293ee
    v_mul_f32 v24, s23, v24
    v_mul_f32 v25, s23, v25
    v_mul_f32 v26, s23, v26
    v_mul_f32 v27, s23, v27
    v_mul_f32 v28, s23, v28
    v_mul_f32 v29, s23, v29
    v_mul_f32 v30, s23, v30
    v_mul_f32 v31, s23, v31
    v_mul_f32 v32, s23, v32
    v_mul_f32 v33, s23, v33
    v_mul_f32 v34, s23, v34
    v_mul_f32 v35, s23, v35
    v_mul_f32 v36, s23, v36
    v_mul_f32 v37, s23, v37
    v_mul_f32 v38, s23, v38
    v_mul_f32 v39, s23, v39
    v_cvt_pk_bf16_f32 v152, v24, v25
    v_cvt_pk_bf16_f32 v153, v26, v27
    v_cvt_pk_bf16_f32 v168, v28, v29
    v_cvt_pk_bf16_f32 v169, v30, v31
    v_cvt_pk_bf16_f32 v154, v32, v33
    v_cvt_pk_bf16_f32 v155, v34, v35
    v_cvt_pk_bf16_f32 v170, v36, v37
    v_cvt_pk_bf16_f32 v171, v38, v39
    s_waitcnt lgkmcnt(6)
    v_mfma_f32_16x16x32_bf16 v[104:107], v[88:91], v[136:139], 0
    s_waitcnt lgkmcnt(4)
    v_mfma_f32_16x16x32_bf16 v[104:107], v[92:95], v[140:143], v[104:107]
    s_waitcnt lgkmcnt(2)
    v_mfma_f32_16x16x32_bf16 v[104:107], v[96:99], v[144:147], v[104:107]
    s_waitcnt lgkmcnt(0)
    v_mfma_f32_16x16x32_bf16 v[104:107], v[100:103], v[148:151], v[104:107]
    v_add_u32 v4, 0x10000, v2
    v_add_u32 v5, 0x20000, v2
    s_barrier
    ds_read_b128 v[224:227], v4 offset:32768
    ds_read_b128 v[228:231], v4 offset:33792
    ds_read_b128 v[232:235], v4 offset:34816
    ds_read_b128 v[236:239], v4 offset:35840
    v_mov_b32 v12, 0x3f803f80
    v_mov_b32 v13, 0x3f803f80
    v_mov_b32 v14, 0x3f803f80
    v_mov_b32 v15, 0x3f803f80
    s_waitcnt lgkmcnt(3)
    v_mfma_f32_16x16x32_bf16 v[184:187], v[224:227], v[152:155], 0
    v_mul_f32 v40, s23, v40
    v_mul_f32 v41, s23, v41
    v_mul_f32 v42, s23, v42
    v_mul_f32 v43, s23, v43
    v_mul_f32 v44, s23, v44
    v_mul_f32 v45, s23, v45
    v_lshrrev_b32 v20, 4, v1
    v_lshlrev_b32 v20, 4, v20
    s_lshr_b32 s16, s2, 5
    s_lshl_b32 s16, s16, 14
    s_and_b32 s17, s2, 31
    s_lshl_b32 s17, s17, 9
    s_add_u32 s16, s16, s17
    s_lshl_b32 s17, s3, 6
    s_add_u32 s16, s16, s17
    s_add_u32 s16, s16, 0x580000
    s_mov_b32 exec_lo, 0x10001
    s_mov_b32 exec_hi, 0x10001
    buffer_store_dwordx4 v[104:107], v20, s[8:11], s16 offen sc1
    s_mov_b64 exec, -1
    v_mfma_f32_16x16x32_bf16 v[188:191], v[224:227], v[168:171], 0
    ds_read_b128 v[240:243], v4 offset:36864
    v_mul_f32 v46, s23, v46
    v_mul_f32 v47, s23, v47
    v_mul_f32 v48, s23, v48
    v_mul_f32 v49, s23, v49
    v_mul_f32 v50, s23, v50
    v_mul_f32 v51, s23, v51
    s_mov_b64 s[64:65], s[46:47]
    s_mov_b32 s66, 0x700000
    s_mov_b32 s67, 0x20000
    s_mov_b64 s[68:69], s[48:49]
    s_mov_b32 s70, 0x700000
    s_mov_b32 s71, 0x20000
    s_cmp_lt_u32 s2, 224
    s_cselect_b32 s66, 7340032, 0
    s_cselect_b32 s70, 7340032, 0
    s_and_b32 s29, s2, 7
    s_mul_i32 s29, s29, 28
    s_lshr_b32 s16, s2, 3
    s_add_u32 s29, s29, s16
    s_sub_u32 s16, s3, 4
    v_lshrrev_b32 v20, 3, v1
    v_lshlrev_b32 v20, 3, v20
    s_lshl_b32 s17, s16, 6
    v_add_u32 v20, s17, v20
    s_mov_b32 s17, 7168
    v_mul_lo_u32 v11, s17, v20
    v_and_b32 v20, 7, v1
    v_lshl_add_u32 v11, v20, 4, v11
    s_and_b32 s17, s29, 3
    s_mul_i32 s18, s17, 1835008
    s_lshr_b32 s17, s29, 2
    s_lshl_b32 s17, s17, 7
    s_add_u32 s18, s18, s17
    s_lshl_b32 s15, s16, 13
    s_waitcnt lgkmcnt(3)
    v_mfma_f32_16x16x32_bf16 v[192:195], v[228:231], v[152:155], 0
    s_add_u32 s22, s21, 0x10000
    s_add_u32 m0, s20, 0x10000
    s_nop 0
    buffer_load_dwordx4 v2, s[8:11], s22 offen sc1 lds
    v_mul_f32 v52, s23, v52
    v_mul_f32 v53, s23, v53
    v_mul_f32 v54, s23, v54
    v_mul_f32 v55, s23, v55
    v_cvt_pk_bf16_f32 v156, v40, v41
    v_cvt_pk_bf16_f32 v157, v42, v43
    v_mfma_f32_16x16x32_bf16 v[196:199], v[228:231], v[168:171], 0
    ds_read_b128 v[244:247], v4 offset:37888
    v_cvt_pk_bf16_f32 v172, v44, v45
    v_cvt_pk_bf16_f32 v173, v46, v47
    v_cvt_pk_bf16_f32 v158, v48, v49
    v_cvt_pk_bf16_f32 v159, v50, v51
    v_cvt_pk_bf16_f32 v174, v52, v53
    v_cvt_pk_bf16_f32 v175, v54, v55
    s_waitcnt lgkmcnt(3)
    v_mfma_f32_16x16x32_bf16 v[184:187], v[232:235], v[156:159], v[184:187]
    v_mul_f32 v56, s23, v56
    v_mul_f32 v57, s23, v57
    v_mul_f32 v58, s23, v58
    v_mul_f32 v59, s23, v59
    v_mul_f32 v60, s23, v60
    v_mul_f32 v61, s23, v61
    v_mfma_f32_16x16x32_bf16 v[188:191], v[232:235], v[172:175], v[188:191]
    ds_read_b128 v[224:227], v4 offset:38912
    v_mul_f32 v62, s23, v62
    v_mul_f32 v63, s23, v63
    v_mul_f32 v64, s23, v64
    v_mul_f32 v65, s23, v65
    v_mul_f32 v66, s23, v66
    v_mul_f32 v67, s23, v67
    s_waitcnt lgkmcnt(3)
    v_mfma_f32_16x16x32_bf16 v[192:195], v[236:239], v[156:159], v[192:195]
    v_mul_f32 v68, s23, v68
    v_mul_f32 v69, s23, v69
    v_mul_f32 v70, s23, v70
    v_mul_f32 v71, s23, v71
    v_cvt_pk_bf16_f32 v160, v56, v57
    v_cvt_pk_bf16_f32 v161, v58, v59
    v_mfma_f32_16x16x32_bf16 v[196:199], v[236:239], v[172:175], v[196:199]
    ds_read_b128 v[228:231], v4 offset:39936
    v_cvt_pk_bf16_f32 v176, v60, v61
    v_cvt_pk_bf16_f32 v177, v62, v63
    v_cvt_pk_bf16_f32 v162, v64, v65
    v_cvt_pk_bf16_f32 v163, v66, v67
    v_cvt_pk_bf16_f32 v178, v68, v69
    v_cvt_pk_bf16_f32 v179, v70, v71
    s_waitcnt lgkmcnt(3)
    v_mfma_f32_16x16x32_bf16 v[184:187], v[240:243], v[160:163], v[184:187]
    v_mul_f32 v72, s23, v72
    v_mul_f32 v73, s23, v73
    v_mul_f32 v74, s23, v74
    v_mul_f32 v75, s23, v75
    v_mul_f32 v76, s23, v76
    v_mul_f32 v77, s23, v77
    v_mfma_f32_16x16x32_bf16 v[188:191], v[240:243], v[176:179], v[188:191]
    ds_read_b128 v[232:235], v4 offset:40960
    v_mul_f32 v78, s23, v78
    v_mul_f32 v79, s23, v79
    v_mul_f32 v80, s23, v80
    v_mul_f32 v81, s23, v81
    v_mul_f32 v82, s23, v82
    v_mul_f32 v83, s23, v83
    s_waitcnt lgkmcnt(3)
    v_mfma_f32_16x16x32_bf16 v[192:195], v[244:247], v[160:163], v[192:195]
    s_add_u32 s22, s21, 0x10400
    s_add_u32 m0, s20, 0x10400
    s_nop 0
    buffer_load_dwordx4 v2, s[8:11], s22 offen sc1 lds
    v_mul_f32 v84, s23, v84
    v_mul_f32 v85, s23, v85
    v_mul_f32 v86, s23, v86
    v_mul_f32 v87, s23, v87
    v_cvt_pk_bf16_f32 v164, v72, v73
    v_cvt_pk_bf16_f32 v165, v74, v75
    v_mfma_f32_16x16x32_bf16 v[196:199], v[244:247], v[176:179], v[196:199]
    ds_read_b128 v[236:239], v4 offset:41984
    v_cvt_pk_bf16_f32 v180, v76, v77
    v_cvt_pk_bf16_f32 v181, v78, v79
    v_cvt_pk_bf16_f32 v166, v80, v81
    v_cvt_pk_bf16_f32 v167, v82, v83
    v_cvt_pk_bf16_f32 v182, v84, v85
    v_cvt_pk_bf16_f32 v183, v86, v87
    s_waitcnt lgkmcnt(3)
    v_mfma_f32_16x16x32_bf16 v[184:187], v[224:227], v[164:167], v[184:187]
    v_mfma_f32_16x16x32_bf16 v[188:191], v[224:227], v[180:183], v[188:191]
    ds_read_b128 v[240:243], v4 offset:43008
    s_waitcnt lgkmcnt(3)
    v_mfma_f32_16x16x32_bf16 v[192:195], v[228:231], v[164:167], v[192:195]
    v_mfma_f32_16x16x32_bf16 v[196:199], v[228:231], v[180:183], v[196:199]
    ds_read_b128 v[244:247], v4 offset:44032
    s_waitcnt lgkmcnt(3)
    v_mfma_f32_16x16x32_bf16 v[200:203], v[232:235], v[152:155], 0
    v_mfma_f32_16x16x32_bf16 v[204:207], v[232:235], v[168:171], 0
    ds_read_b128 v[224:227], v4 offset:45056
    s_waitcnt lgkmcnt(3)
    v_mfma_f32_16x16x32_bf16 v[208:211], v[236:239], v[152:155], 0
    v_mfma_f32_16x16x32_bf16 v[212:215], v[236:239], v[168:171], 0
    ds_read_b128 v[228:231], v4 offset:46080
    s_waitcnt lgkmcnt(3)
    v_mfma_f32_16x16x32_bf16 v[200:203], v[240:243], v[156:159], v[200:203]
    v_mfma_f32_16x16x32_bf16 v[204:207], v[240:243], v[172:175], v[204:207]
    ds_read_b128 v[232:235], v4 offset:47104
    s_waitcnt lgkmcnt(3)
    v_mfma_f32_16x16x32_bf16 v[208:211], v[244:247], v[156:159], v[208:211]
    v_max3_f32 v16, v184, v185, v186
    v_mfma_f32_16x16x32_bf16 v[212:215], v[244:247], v[172:175], v[212:215]
    ds_read_b128 v[236:239], v4 offset:48128
    v_max3_f32 v16, v16, v187, v192
    s_waitcnt lgkmcnt(3)
    v_mfma_f32_16x16x32_bf16 v[200:203], v[224:227], v[160:163], v[200:203]
    v_max3_f32 v16, v16, v193, v194
    v_mfma_f32_16x16x32_bf16 v[204:207], v[224:227], v[176:179], v[204:207]
    s_barrier
    ds_read_b128 v[240:243], v4 offset:49152
    v_max_f32 v16, v16, v195
    s_waitcnt lgkmcnt(3)
    v_mfma_f32_16x16x32_bf16 v[208:211], v[228:231], v[160:163], v[208:211]
    v_max3_f32 v17, v188, v189, v190
    v_mfma_f32_16x16x32_bf16 v[212:215], v[228:231], v[176:179], v[212:215]
    s_add_u32 s22, s21, 0x14000
    s_add_u32 m0, s20, 0x14000
    s_nop 0
    buffer_load_dwordx4 v2, s[8:11], s22 offen sc1 lds
    ds_read_b128 v[244:247], v4 offset:50176
    v_max3_f32 v17, v17, v191, v196
    s_waitcnt lgkmcnt(3)
    v_mfma_f32_16x16x32_bf16 v[200:203], v[232:235], v[164:167], v[200:203]
    v_max3_f32 v17, v17, v197, v198
    v_mfma_f32_16x16x32_bf16 v[204:207], v[232:235], v[180:183], v[204:207]
    ds_read_b128 v[224:227], v4 offset:51200
    v_max_f32 v17, v17, v199
    s_waitcnt lgkmcnt(3)
    v_mfma_f32_16x16x32_bf16 v[208:211], v[236:239], v[164:167], v[208:211]
    v_mfma_f32_16x16x32_bf16 v[212:215], v[236:239], v[180:183], v[212:215]
    ds_read_b128 v[228:231], v4 offset:52224
    v_max3_f32 v16, v16, v200, v201
    v_max3_f32 v16, v16, v202, v203
    s_nop 3
    v_max3_f32 v16, v16, v208, v209
    v_max3_f32 v16, v16, v210, v211
    v_max3_f32 v17, v17, v204, v205
    v_max3_f32 v17, v17, v206, v207
    v_max3_f32 v17, v17, v212, v213
    v_max3_f32 v17, v17, v214, v215
    v_mov_b32 v18, v16
    v_mov_b32 v19, v17
    s_nop 0
    v_permlane16_swap_b32 v16, v18
    v_permlane16_swap_b32 v17, v19
    v_max_f32 v16, v16, v18
    v_max_f32 v17, v17, v19
    v_mov_b32 v18, v16
    v_mov_b32 v19, v17
    s_nop 0
    v_permlane32_swap_b32 v16, v18
    v_permlane32_swap_b32 v17, v19
    v_max_f32 v16, v16, v18
    v_max_f32 v17, v17, v19
    v_sub_f32 v216, 0, v16
    v_sub_f32 v217, 0, v16
    v_sub_f32 v218, 0, v16
    v_sub_f32 v219, 0, v16
    v_sub_f32 v220, 0, v17
    v_sub_f32 v221, 0, v17
    v_sub_f32 v222, 0, v17
    v_sub_f32 v223, 0, v17
    v_add_f32 v184, v184, v216
    v_add_f32 v185, v185, v216
    v_exp_f32 v184, v184
    v_exp_f32 v185, v185
    s_nop 0
    v_cvt_pk_bf16_f32 v24, v184, v185
    v_add_f32 v186, v186, v216
    v_add_f32 v187, v187, v216
    v_exp_f32 v186, v186
    v_exp_f32 v187, v187
    s_nop 0
    v_cvt_pk_bf16_f32 v25, v186, v187
    v_add_f32 v188, v188, v220
    v_add_f32 v189, v189, v220
    v_exp_f32 v188, v188
    v_exp_f32 v189, v189
    s_nop 0
    v_cvt_pk_bf16_f32 v28, v188, v189
    v_add_f32 v190, v190, v220
    v_add_f32 v191, v191, v220
    v_exp_f32 v190, v190
    v_exp_f32 v191, v191
    s_nop 0
    v_cvt_pk_bf16_f32 v29, v190, v191
    v_add_f32 v192, v192, v216
    v_add_f32 v193, v193, v216
    v_exp_f32 v192, v192
    v_exp_f32 v193, v193
    s_nop 0
    v_cvt_pk_bf16_f32 v26, v192, v193
    v_add_f32 v194, v194, v216
    v_add_f32 v195, v195, v216
    v_exp_f32 v194, v194
    v_exp_f32 v195, v195
    s_nop 0
    v_cvt_pk_bf16_f32 v27, v194, v195
    v_add_f32 v196, v196, v220
    v_add_f32 v197, v197, v220
    v_exp_f32 v196, v196
    v_exp_f32 v197, v197
    s_nop 0
    v_cvt_pk_bf16_f32 v30, v196, v197
    v_add_f32 v198, v198, v220
    v_add_f32 v199, v199, v220
    v_exp_f32 v198, v198
    v_exp_f32 v199, v199
    s_nop 0
    v_cvt_pk_bf16_f32 v31, v198, v199
    s_waitcnt lgkmcnt(3)
    v_mfma_f32_16x16x32_bf16 v[184:187], v[240:243], v[152:155], v[216:219]
    v_mfma_f32_16x16x32_bf16 v[188:191], v[240:243], v[168:171], v[220:223]
    ds_read_b128 v[232:235], v4 offset:53248
    v_add_f32 v200, v200, v216
    v_add_f32 v201, v201, v216
    v_exp_f32 v200, v200
    v_mfma_f32_16x16x32_bf16 v[248:251], v[12:15], v[24:27], 0
    s_waitcnt lgkmcnt(3)
    v_mfma_f32_16x16x32_bf16 v[192:195], v[244:247], v[152:155], v[216:219]
    v_exp_f32 v201, v201
    s_nop 0
    v_cvt_pk_bf16_f32 v32, v200, v201
    v_add_f32 v202, v202, v216
    v_mfma_f32_16x16x32_bf16 v[196:199], v[244:247], v[168:171], v[220:223]
    s_add_u32 s22, s21, 0x14400
    s_add_u32 m0, s20, 0x14400
    s_nop 0
    buffer_load_dwordx4 v2, s[8:11], s22 offen sc1 lds
    ds_read_b128 v[236:239], v4 offset:54272
    v_add_f32 v203, v203, v216
    v_exp_f32 v202, v202
    v_mfma_f32_16x16x32_bf16 v[252:255], v[12:15], v[28:31], 0
    s_waitcnt lgkmcnt(3)
    v_mfma_f32_16x16x32_bf16 v[184:187], v[224:227], v[156:159], v[184:187]
    v_exp_f32 v203, v203
    s_nop 0
    v_cvt_pk_bf16_f32 v33, v202, v203
    v_add_f32 v204, v204, v220
    s_add_u32 s22, s18, 0
    s_add_u32 m0, s15, 0
    s_nop 0
    buffer_load_dwordx4 v11, s[64:67], s22 offen lds
    v_mfma_f32_16x16x32_bf16 v[188:191], v[224:227], v[172:175], v[188:191]
    ds_read_b128 v[240:243], v4 offset:55296
    v_add_f32 v205, v205, v220
    v_exp_f32 v204, v204
    v_exp_f32 v205, v205
    s_mov_b64 s[4:5], s[40:41]
    s_mov_b32 s6, 0x800000
    s_mov_b32 s7, 0x20000
    v_bfe_u32 v20, v1, 2, 2
    v_lshlrev_b32 v21, 13, v20
    v_sub_u32 v3, v3, v21
    v_lshl_add_u32 v3, v20, 11, v3
    s_and_b32 s16, s2, 1
    s_lshl_b32 s24, s16, 22
    s_lshr_b32 s16, s2, 5
    s_lshl_b32 s16, s16, 8
    s_add_u32 s24, s24, s16
    s_lshl_b32 s16, s3, 14
    s_add_u32 s24, s24, s16
    s_add_u32 s24, s24, 196608
    s_waitcnt lgkmcnt(3)
    v_mfma_f32_16x16x32_bf16 v[192:195], v[228:231], v[156:159], v[192:195]
    v_cvt_pk_bf16_f32 v36, v204, v205
    v_add_f32 v206, v206, v220
    v_mfma_f32_16x16x32_bf16 v[196:199], v[228:231], v[172:175], v[196:199]
    ds_read_b128 v[244:247], v4 offset:56320
    v_add_f32 v207, v207, v220
    v_exp_f32 v206, v206
    v_exp_f32 v207, v207
    s_waitcnt lgkmcnt(3)
    v_mfma_f32_16x16x32_bf16 v[184:187], v[232:235], v[160:163], v[184:187]
    v_cvt_pk_bf16_f32 v37, v206, v207
    v_add_f32 v208, v208, v216
    v_add_f32 v209, v209, v216
    s_mov_b64 s[72:73], s[40:41]
    s_mov_b32 s74, 0x800000
    s_mov_b32 s75, 0x20000
    v_lshlrev_b32 v21, 7, v1
    s_lshl_b32 s16, s2, 2
    s_add_u32 s16, s16, s3
    s_sub_u32 s16, s16, 4
    s_lshl_b32 s16, s16, 13
    buffer_load_dword v7, v21, s[72:75], s16 offen
    v_mfma_f32_16x16x32_bf16 v[188:191], v[232:235], v[176:179], v[188:191]
    ds_read_b128 v[224:227], v4 offset:57344
    v_exp_f32 v208, v208
    v_exp_f32 v209, v209
    s_waitcnt lgkmcnt(3)
    v_mfma_f32_16x16x32_bf16 v[192:195], v[236:239], v[160:163], v[192:195]
    v_cvt_pk_bf16_f32 v34, v208, v209
    v_add_f32 v210, v210, v216
    v_add_f32 v211, v211, v216
    v_mfma_f32_16x16x32_bf16 v[196:199], v[236:239], v[176:179], v[196:199]
    ds_read_b128 v[228:231], v4 offset:58368
    v_exp_f32 v210, v210
    v_exp_f32 v211, v211
    s_nop 0
    v_cvt_pk_bf16_f32 v35, v210, v211
    s_waitcnt lgkmcnt(3)
    v_mfma_f32_16x16x32_bf16 v[184:187], v[240:243], v[164:167], v[184:187]
    v_add_f32 v212, v212, v220
    v_add_f32 v213, v213, v220
    v_mfma_f32_16x16x32_bf16 v[188:191], v[240:243], v[180:183], v[188:191]
    ds_read_b128 v[232:235], v4 offset:59392
    v_exp_f32 v212, v212
    v_exp_f32 v213, v213
    s_nop 0
    v_cvt_pk_bf16_f32 v38, v212, v213
    s_waitcnt lgkmcnt(3)
    v_mfma_f32_16x16x32_bf16 v[192:195], v[244:247], v[164:167], v[192:195]
    v_add_f32 v214, v214, v220
    v_add_f32 v215, v215, v220
    v_exp_f32 v214, v214
    v_mfma_f32_16x16x32_bf16 v[196:199], v[244:247], v[180:183], v[196:199]
    ds_read_b128 v[236:239], v4 offset:60416
    v_exp_f32 v215, v215
    s_nop 0
    v_cvt_pk_bf16_f32 v39, v214, v215
    s_waitcnt lgkmcnt(3)
    v_mfma_f32_16x16x32_bf16 v[200:203], v[224:227], v[152:155], v[216:219]
    v_mfma_f32_16x16x32_bf16 v[204:207], v[224:227], v[168:171], v[220:223]
    ds_read_b128 v[240:243], v4 offset:61440
    v_exp_f32 v184, v184
    v_exp_f32 v185, v185
    v_mfma_f32_16x16x32_bf16 v[248:251], v[12:15], v[32:35], v[248:251]
    s_waitcnt lgkmcnt(3)
    v_mfma_f32_16x16x32_bf16 v[208:211], v[228:231], v[152:155], v[216:219]
    v_cvt_pk_bf16_f32 v40, v184, v185
    v_exp_f32 v186, v186
    v_mfma_f32_16x16x32_bf16 v[212:215], v[228:231], v[168:171], v[220:223]
    ds_read_b128 v[244:247], v4 offset:62464
    v_exp_f32 v187, v187
    v_mfma_f32_16x16x32_bf16 v[252:255], v[12:15], v[36:39], v[252:255]
    s_waitcnt lgkmcnt(3)
    v_mfma_f32_16x16x32_bf16 v[200:203], v[232:235], v[156:159], v[200:203]
    v_cvt_pk_bf16_f32 v41, v186, v187
    v_exp_f32 v188, v188
    v_mfma_f32_16x16x32_bf16 v[204:207], v[232:235], v[172:175], v[204:207]
    ds_read_b128 v[224:227], v4 offset:63488
    v_exp_f32 v189, v189
    s_waitcnt lgkmcnt(3)
    v_mfma_f32_16x16x32_bf16 v[208:211], v[236:239], v[156:159], v[208:211]
    v_cvt_pk_bf16_f32 v44, v188, v189
    v_exp_f32 v190, v190
    v_mfma_f32_16x16x32_bf16 v[212:215], v[236:239], v[172:175], v[212:215]
    ds_read_b128 v[228:231], v4 offset:64512
    v_exp_f32 v191, v191
    s_nop 0
    v_cvt_pk_bf16_f32 v45, v190, v191
    s_waitcnt lgkmcnt(3)
    v_mfma_f32_16x16x32_bf16 v[200:203], v[240:243], v[160:163], v[200:203]
    v_exp_f32 v192, v192
    v_mfma_f32_16x16x32_bf16 v[204:207], v[240:243], v[176:179], v[204:207]
    s_waitcnt vmcnt(9)
    s_barrier
    ds_read_b128 v[232:235], v5 offset:0
    v_exp_f32 v193, v193
    s_nop 0
    v_cvt_pk_bf16_f32 v42, v192, v193
    s_waitcnt lgkmcnt(3)
    v_mfma_f32_16x16x32_bf16 v[208:211], v[244:247], v[160:163], v[208:211]
    v_exp_f32 v194, v194
    v_mfma_f32_16x16x32_bf16 v[212:215], v[244:247], v[176:179], v[212:215]
    s_add_u32 s22, s21, 0x18000
    s_add_u32 m0, s20, 0x18000
    s_nop 0
    buffer_load_dwordx4 v2, s[8:11], s22 offen sc1 lds
    ds_read_b128 v[236:239], v5 offset:1024
    v_exp_f32 v195, v195
    s_nop 0
    v_cvt_pk_bf16_f32 v43, v194, v195
    s_add_u32 s22, s18, 7168
    s_add_u32 m0, s15, 1024
    s_nop 0
    buffer_load_dwordx4 v11, s[64:67], s22 offen lds
    s_waitcnt lgkmcnt(3)
    v_mfma_f32_16x16x32_bf16 v[200:203], v[224:227], v[164:167], v[200:203]
    v_exp_f32 v196, v196
    v_exp_f32 v197, v197
    v_mfma_f32_16x16x32_bf16 v[204:207], v[224:227], v[180:183], v[204:207]
    ds_read_b128 v[240:243], v5 offset:2048
    v_cvt_pk_bf16_f32 v46, v196, v197
    s_waitcnt lgkmcnt(3)
    v_mfma_f32_16x16x32_bf16 v[208:211], v[228:231], v[164:167], v[208:211]
    v_exp_f32 v198, v198
    v_exp_f32 v199, v199
    v_mfma_f32_16x16x32_bf16 v[212:215], v[228:231], v[180:183], v[212:215]
    ds_read_b128 v[244:247], v5 offset:3072
    v_cvt_pk_bf16_f32 v47, v198, v199
    s_waitcnt lgkmcnt(3)
    v_mfma_f32_16x16x32_bf16 v[184:187], v[232:235], v[152:155], v[216:219]
    v_mfma_f32_16x16x32_bf16 v[188:191], v[232:235], v[168:171], v[220:223]
    ds_read_b128 v[224:227], v5 offset:4096
    v_exp_f32 v200, v200
    v_exp_f32 v201, v201
    v_mfma_f32_16x16x32_bf16 v[248:251], v[12:15], v[40:43], v[248:251]
    s_waitcnt lgkmcnt(3)
    v_mfma_f32_16x16x32_bf16 v[192:195], v[236:239], v[152:155], v[216:219]
    v_cvt_pk_bf16_f32 v48, v200, v201
    v_exp_f32 v202, v202
    v_mfma_f32_16x16x32_bf16 v[196:199], v[236:239], v[168:171], v[220:223]
    s_add_u32 s22, s21, 0x18400
    s_add_u32 m0, s20, 0x18400
    s_nop 0
    buffer_load_dwordx4 v2, s[8:11], s22 offen sc1 lds
    ds_read_b128 v[228:231], v5 offset:5120
    v_exp_f32 v203, v203
    v_mfma_f32_16x16x32_bf16 v[252:255], v[12:15], v[44:47], v[252:255]
    s_waitcnt lgkmcnt(3)
    v_mfma_f32_16x16x32_bf16 v[184:187], v[240:243], v[156:159], v[184:187]
    v_cvt_pk_bf16_f32 v49, v202, v203
    v_exp_f32 v204, v204
    v_mfma_f32_16x16x32_bf16 v[188:191], v[240:243], v[172:175], v[188:191]
    ds_read_b128 v[232:235], v5 offset:6144
    v_exp_f32 v205, v205
    s_waitcnt lgkmcnt(3)
    v_mfma_f32_16x16x32_bf16 v[192:195], v[244:247], v[156:159], v[192:195]
    v_cvt_pk_bf16_f32 v52, v204, v205
    v_exp_f32 v206, v206
    v_mfma_f32_16x16x32_bf16 v[196:199], v[244:247], v[172:175], v[196:199]
    ds_read_b128 v[236:239], v5 offset:7168
    v_exp_f32 v207, v207
    s_nop 0
    v_cvt_pk_bf16_f32 v53, v206, v207
    s_waitcnt lgkmcnt(3)
    v_mfma_f32_16x16x32_bf16 v[184:187], v[224:227], v[160:163], v[184:187]
    v_exp_f32 v208, v208
    v_mfma_f32_16x16x32_bf16 v[188:191], v[224:227], v[176:179], v[188:191]
    ds_read_b128 v[240:243], v5 offset:8192
    v_exp_f32 v209, v209
    s_nop 0
    v_cvt_pk_bf16_f32 v50, v208, v209
    s_waitcnt lgkmcnt(3)
    v_mfma_f32_16x16x32_bf16 v[192:195], v[228:231], v[160:163], v[192:195]
    v_exp_f32 v210, v210
    v_mfma_f32_16x16x32_bf16 v[196:199], v[228:231], v[176:179], v[196:199]
    ds_read_b128 v[244:247], v5 offset:9216
    v_exp_f32 v211, v211
    s_nop 0
    v_cvt_pk_bf16_f32 v51, v210, v211
    s_waitcnt lgkmcnt(3)
    v_mfma_f32_16x16x32_bf16 v[184:187], v[232:235], v[164:167], v[184:187]
    v_exp_f32 v212, v212
    v_exp_f32 v213, v213
    v_mfma_f32_16x16x32_bf16 v[188:191], v[232:235], v[180:183], v[188:191]
    ds_read_b128 v[224:227], v5 offset:10240
    v_cvt_pk_bf16_f32 v54, v212, v213
    s_waitcnt lgkmcnt(3)
    v_mfma_f32_16x16x32_bf16 v[192:195], v[236:239], v[164:167], v[192:195]
    v_exp_f32 v214, v214
    v_exp_f32 v215, v215
    v_mfma_f32_16x16x32_bf16 v[196:199], v[236:239], v[180:183], v[196:199]
    ds_read_b128 v[228:231], v5 offset:11264
    v_cvt_pk_bf16_f32 v55, v214, v215
    s_waitcnt lgkmcnt(3)
    v_mfma_f32_16x16x32_bf16 v[200:203], v[240:243], v[152:155], v[216:219]
    v_mfma_f32_16x16x32_bf16 v[204:207], v[240:243], v[168:171], v[220:223]
    ds_read_b128 v[232:235], v5 offset:12288
    v_exp_f32 v184, v184
    v_exp_f32 v185, v185
    v_mfma_f32_16x16x32_bf16 v[248:251], v[12:15], v[48:51], v[248:251]
    s_waitcnt lgkmcnt(3)
    v_mfma_f32_16x16x32_bf16 v[208:211], v[244:247], v[152:155], v[216:219]
    v_cvt_pk_bf16_f32 v56, v184, v185
    v_exp_f32 v186, v186
    v_mfma_f32_16x16x32_bf16 v[212:215], v[244:247], v[168:171], v[220:223]
    ds_read_b128 v[236:239], v5 offset:13312
    v_exp_f32 v187, v187
    s_add_u32 s22, s18, 14336
    s_add_u32 m0, s15, 2048
    s_nop 0
    buffer_load_dwordx4 v11, s[64:67], s22 offen lds
    v_mfma_f32_16x16x32_bf16 v[252:255], v[12:15], v[52:55], v[252:255]
    s_waitcnt lgkmcnt(3)
    v_mfma_f32_16x16x32_bf16 v[200:203], v[224:227], v[156:159], v[200:203]
    v_cvt_pk_bf16_f32 v57, v186, v187
    v_exp_f32 v188, v188
    v_mfma_f32_16x16x32_bf16 v[204:207], v[224:227], v[172:175], v[204:207]
    ds_read_b128 v[240:243], v5 offset:14336
    v_exp_f32 v189, v189
    s_waitcnt lgkmcnt(3)
    v_mfma_f32_16x16x32_bf16 v[208:211], v[228:231], v[156:159], v[208:211]
    v_cvt_pk_bf16_f32 v60, v188, v189
    v_exp_f32 v190, v190
    s_waitcnt vmcnt(10)
    v_mfma_f32_16x16x32_bf16 v[212:215], v[228:231], v[172:175], v[212:215]
    ds_read_b128 v[244:247], v5 offset:15360
    v_exp_f32 v191, v191
    s_nop 0
    v_cvt_pk_bf16_f32 v61, v190, v191
    s_waitcnt lgkmcnt(3)
    v_mfma_f32_16x16x32_bf16 v[200:203], v[232:235], v[160:163], v[200:203]
    v_exp_f32 v192, v192
    v_mfma_f32_16x16x32_bf16 v[204:207], v[232:235], v[176:179], v[204:207]
    s_barrier
    ds_read_b128 v[224:227], v5 offset:16384
    v_exp_f32 v193, v193
    s_nop 0
    v_cvt_pk_bf16_f32 v58, v192, v193
    s_waitcnt lgkmcnt(3)
    v_mfma_f32_16x16x32_bf16 v[208:211], v[236:239], v[160:163], v[208:211]
    v_exp_f32 v194, v194
    v_mfma_f32_16x16x32_bf16 v[212:215], v[236:239], v[176:179], v[212:215]
    s_add_u32 s22, s21, 0x1c000
    s_add_u32 m0, s20, 0x1c000
    s_nop 0
    buffer_load_dwordx4 v2, s[8:11], s22 offen sc1 lds
    ds_read_b128 v[228:231], v5 offset:17408
    v_exp_f32 v195, v195
    s_nop 0
    v_cvt_pk_bf16_f32 v59, v194, v195
    s_waitcnt lgkmcnt(3)
    v_mfma_f32_16x16x32_bf16 v[200:203], v[240:243], v[164:167], v[200:203]
    v_exp_f32 v196, v196
    v_exp_f32 v197, v197
    v_mfma_f32_16x16x32_bf16 v[204:207], v[240:243], v[180:183], v[204:207]
    ds_read_b128 v[232:235], v5 offset:18432
    v_cvt_pk_bf16_f32 v62, v196, v197
    s_waitcnt lgkmcnt(3)
    v_mfma_f32_16x16x32_bf16 v[208:211], v[244:247], v[164:167], v[208:211]
    v_exp_f32 v198, v198
    v_exp_f32 v199, v199
    v_mfma_f32_16x16x32_bf16 v[212:215], v[244:247], v[180:183], v[212:215]
    ds_read_b128 v[236:239], v5 offset:19456
    v_cvt_pk_bf16_f32 v63, v198, v199
    s_waitcnt lgkmcnt(3)
    v_mfma_f32_16x16x32_bf16 v[184:187], v[224:227], v[152:155], v[216:219]
    v_mfma_f32_16x16x32_bf16 v[188:191], v[224:227], v[168:171], v[220:223]
    ds_read_b128 v[240:243], v5 offset:20480
    v_exp_f32 v200, v200
    v_exp_f32 v201, v201
    v_mfma_f32_16x16x32_bf16 v[248:251], v[12:15], v[56:59], v[248:251]
    s_waitcnt lgkmcnt(3)
    v_mfma_f32_16x16x32_bf16 v[192:195], v[228:231], v[152:155], v[216:219]
    v_cvt_pk_bf16_f32 v64, v200, v201
    v_exp_f32 v202, v202
    v_mfma_f32_16x16x32_bf16 v[196:199], v[228:231], v[168:171], v[220:223]
    s_add_u32 s22, s21, 0x1c400
    s_add_u32 m0, s20, 0x1c400
    s_nop 0
    buffer_load_dwordx4 v2, s[8:11], s22 offen sc1 lds
    ds_read_b128 v[244:247], v5 offset:21504
    v_exp_f32 v203, v203
    v_mfma_f32_16x16x32_bf16 v[252:255], v[12:15], v[60:63], v[252:255]
    s_waitcnt lgkmcnt(3)
    v_mfma_f32_16x16x32_bf16 v[184:187], v[232:235], v[156:159], v[184:187]
    v_cvt_pk_bf16_f32 v65, v202, v203
    v_exp_f32 v204, v204
    v_mfma_f32_16x16x32_bf16 v[188:191], v[232:235], v[172:175], v[188:191]
    ds_read_b128 v[224:227], v5 offset:22528
    v_exp_f32 v205, v205
    s_waitcnt lgkmcnt(3)
    v_mfma_f32_16x16x32_bf16 v[192:195], v[236:239], v[156:159], v[192:195]
    v_cvt_pk_bf16_f32 v68, v204, v205
    v_exp_f32 v206, v206
    v_mfma_f32_16x16x32_bf16 v[196:199], v[236:239], v[172:175], v[196:199]
    ds_read_b128 v[228:231], v5 offset:23552
    v_exp_f32 v207, v207
    s_nop 0
    v_cvt_pk_bf16_f32 v69, v206, v207
    s_waitcnt lgkmcnt(3)
    v_mfma_f32_16x16x32_bf16 v[184:187], v[240:243], v[160:163], v[184:187]
    v_exp_f32 v208, v208
    v_mfma_f32_16x16x32_bf16 v[188:191], v[240:243], v[176:179], v[188:191]
    ds_read_b128 v[232:235], v5 offset:24576
    v_exp_f32 v209, v209
    s_nop 0
    v_cvt_pk_bf16_f32 v66, v208, v209
    s_waitcnt lgkmcnt(3)
    v_mfma_f32_16x16x32_bf16 v[192:195], v[244:247], v[160:163], v[192:195]
    v_exp_f32 v210, v210
    s_add_u32 s22, s18, 21504
    s_add_u32 m0, s15, 3072
    s_nop 0
    buffer_load_dwordx4 v11, s[64:67], s22 offen lds
    v_mfma_f32_16x16x32_bf16 v[196:199], v[244:247], v[176:179], v[196:199]
    ds_read_b128 v[236:239], v5 offset:25600
    v_exp_f32 v211, v211
    s_nop 0
    v_cvt_pk_bf16_f32 v67, v210, v211
    s_waitcnt lgkmcnt(3)
    v_mfma_f32_16x16x32_bf16 v[184:187], v[224:227], v[164:167], v[184:187]
    v_exp_f32 v212, v212
    v_exp_f32 v213, v213
    v_mfma_f32_16x16x32_bf16 v[188:191], v[224:227], v[180:183], v[188:191]
    ds_read_b128 v[240:243], v5 offset:26624
    v_cvt_pk_bf16_f32 v70, v212, v213
    s_waitcnt lgkmcnt(3)
    v_mfma_f32_16x16x32_bf16 v[192:195], v[228:231], v[164:167], v[192:195]
    v_exp_f32 v214, v214
    v_exp_f32 v215, v215
    v_mfma_f32_16x16x32_bf16 v[196:199], v[228:231], v[180:183], v[196:199]
    ds_read_b128 v[244:247], v5 offset:27648
    v_cvt_pk_bf16_f32 v71, v214, v215
    s_waitcnt lgkmcnt(3)
    v_mfma_f32_16x16x32_bf16 v[200:203], v[232:235], v[152:155], v[216:219]
    v_mfma_f32_16x16x32_bf16 v[204:207], v[232:235], v[168:171], v[220:223]
    ds_read_b128 v[224:227], v5 offset:28672
    v_exp_f32 v184, v184
    v_exp_f32 v185, v185
    v_mfma_f32_16x16x32_bf16 v[248:251], v[12:15], v[64:67], v[248:251]
    s_waitcnt lgkmcnt(3)
    v_mfma_f32_16x16x32_bf16 v[208:211], v[236:239], v[152:155], v[216:219]
    v_cvt_pk_bf16_f32 v72, v184, v185
    v_exp_f32 v186, v186
    v_mfma_f32_16x16x32_bf16 v[212:215], v[236:239], v[168:171], v[220:223]
    ds_read_b128 v[228:231], v5 offset:29696
    v_exp_f32 v187, v187
    v_mfma_f32_16x16x32_bf16 v[252:255], v[12:15], v[68:71], v[252:255]
    s_waitcnt lgkmcnt(3)
    v_mfma_f32_16x16x32_bf16 v[200:203], v[240:243], v[156:159], v[200:203]
    v_cvt_pk_bf16_f32 v73, v186, v187
    v_exp_f32 v188, v188
    v_mfma_f32_16x16x32_bf16 v[204:207], v[240:243], v[172:175], v[204:207]
    ds_read_b128 v[232:235], v5 offset:30720
    v_exp_f32 v189, v189
    s_waitcnt lgkmcnt(3)
    v_mfma_f32_16x16x32_bf16 v[208:211], v[244:247], v[156:159], v[208:211]
    v_cvt_pk_bf16_f32 v76, v188, v189
    v_exp_f32 v190, v190
    v_mfma_f32_16x16x32_bf16 v[212:215], v[244:247], v[172:175], v[212:215]
    ds_read_b128 v[236:239], v5 offset:31744
    v_exp_f32 v191, v191
    s_nop 0
    v_cvt_pk_bf16_f32 v77, v190, v191
    s_waitcnt lgkmcnt(3)
    v_mfma_f32_16x16x32_bf16 v[200:203], v[224:227], v[160:163], v[200:203]
    v_exp_f32 v192, v192
    v_mfma_f32_16x16x32_bf16 v[204:207], v[224:227], v[176:179], v[204:207]
    s_waitcnt vmcnt(11)
    s_barrier
    ds_read_b128 v[240:243], v4 offset:0
    v_exp_f32 v193, v193
    s_nop 0
    v_cvt_pk_bf16_f32 v74, v192, v193
    s_waitcnt lgkmcnt(3)
    v_mfma_f32_16x16x32_bf16 v[208:211], v[228:231], v[160:163], v[208:211]
    v_exp_f32 v194, v194
    v_mfma_f32_16x16x32_bf16 v[212:215], v[228:231], v[176:179], v[212:215]
    s_add_u32 s22, s21, 0x80000
    s_add_u32 m0, s20, 0x20000
    s_nop 0
    buffer_load_dwordx4 v2, s[8:11], s22 offen sc1 lds
    ds_read_b128 v[244:247], v4 offset:1024
    v_exp_f32 v195, v195
    s_nop 0
    v_cvt_pk_bf16_f32 v75, v194, v195
    s_waitcnt lgkmcnt(3)
    v_mfma_f32_16x16x32_bf16 v[200:203], v[232:235], v[164:167], v[200:203]
    v_exp_f32 v196, v196
    v_exp_f32 v197, v197
    v_mfma_f32_16x16x32_bf16 v[204:207], v[232:235], v[180:183], v[204:207]
    ds_read_b128 v[224:227], v4 offset:2048
    v_cvt_pk_bf16_f32 v78, v196, v197
    s_waitcnt lgkmcnt(3)
    v_mfma_f32_16x16x32_bf16 v[208:211], v[236:239], v[164:167], v[208:211]
    v_exp_f32 v198, v198
    v_exp_f32 v199, v199
    v_mfma_f32_16x16x32_bf16 v[212:215], v[236:239], v[180:183], v[212:215]
    ds_read_b128 v[228:231], v4 offset:3072
    v_cvt_pk_bf16_f32 v79, v198, v199
    s_waitcnt lgkmcnt(3)
    v_mfma_f32_16x16x32_bf16 v[184:187], v[240:243], v[152:155], v[216:219]
    v_mfma_f32_16x16x32_bf16 v[188:191], v[240:243], v[168:171], v[220:223]
    ds_read_b128 v[232:235], v4 offset:4096
    v_exp_f32 v200, v200
    v_exp_f32 v201, v201
    v_mfma_f32_16x16x32_bf16 v[248:251], v[12:15], v[72:75], v[248:251]
    s_waitcnt lgkmcnt(3)
    v_mfma_f32_16x16x32_bf16 v[192:195], v[244:247], v[152:155], v[216:219]
    v_cvt_pk_bf16_f32 v80, v200, v201
    v_exp_f32 v202, v202
    s_add_u32 s22, s18, 28672
    s_add_u32 m0, s15, 4096
    s_nop 0
    buffer_load_dwordx4 v11, s[64:67], s22 offen lds
    v_mfma_f32_16x16x32_bf16 v[196:199], v[244:247], v[168:171], v[220:223]
    s_add_u32 s22, s21, 0x80400
    s_add_u32 m0, s20, 0x20400
    s_nop 0
    buffer_load_dwordx4 v2, s[8:11], s22 offen sc1 lds
    ds_read_b128 v[236:239], v4 offset:5120
    v_exp_f32 v203, v203
    v_mfma_f32_16x16x32_bf16 v[252:255], v[12:15], v[76:79], v[252:255]
    s_waitcnt lgkmcnt(3)
    v_mfma_f32_16x16x32_bf16 v[184:187], v[224:227], v[156:159], v[184:187]
    v_cvt_pk_bf16_f32 v81, v202, v203
    v_exp_f32 v204, v204
    v_mfma_f32_16x16x32_bf16 v[188:191], v[224:227], v[172:175], v[188:191]
    ds_read_b128 v[240:243], v4 offset:6144
    v_exp_f32 v205, v205
    s_waitcnt lgkmcnt(3)
    v_mfma_f32_16x16x32_bf16 v[192:195], v[228:231], v[156:159], v[192:195]
    v_cvt_pk_bf16_f32 v84, v204, v205
    v_exp_f32 v206, v206
    v_mfma_f32_16x16x32_bf16 v[196:199], v[228:231], v[172:175], v[196:199]
    ds_read_b128 v[244:247], v4 offset:7168
    v_exp_f32 v207, v207
    s_nop 0
    v_cvt_pk_bf16_f32 v85, v206, v207
    s_waitcnt lgkmcnt(3)
    v_mfma_f32_16x16x32_bf16 v[184:187], v[232:235], v[160:163], v[184:187]
    v_exp_f32 v208, v208
    v_mfma_f32_16x16x32_bf16 v[188:191], v[232:235], v[176:179], v[188:191]
    ds_read_b128 v[224:227], v4 offset:8192
    v_exp_f32 v209, v209
    s_nop 0
    v_cvt_pk_bf16_f32 v82, v208, v209
    s_waitcnt lgkmcnt(3)
    v_mfma_f32_16x16x32_bf16 v[192:195], v[236:239], v[160:163], v[192:195]
    v_exp_f32 v210, v210
    v_mfma_f32_16x16x32_bf16 v[196:199], v[236:239], v[176:179], v[196:199]
    ds_read_b128 v[228:231], v4 offset:9216
    v_exp_f32 v211, v211
    s_nop 0
    v_cvt_pk_bf16_f32 v83, v210, v211
    s_waitcnt lgkmcnt(3)
    v_mfma_f32_16x16x32_bf16 v[184:187], v[240:243], v[164:167], v[184:187]
    v_exp_f32 v212, v212
    v_exp_f32 v213, v213
    v_mfma_f32_16x16x32_bf16 v[188:191], v[240:243], v[180:183], v[188:191]
    ds_read_b128 v[232:235], v4 offset:10240
    v_cvt_pk_bf16_f32 v86, v212, v213
    s_waitcnt lgkmcnt(3)
    v_mfma_f32_16x16x32_bf16 v[192:195], v[244:247], v[164:167], v[192:195]
    v_exp_f32 v214, v214
    v_exp_f32 v215, v215
    v_mfma_f32_16x16x32_bf16 v[196:199], v[244:247], v[180:183], v[196:199]
    ds_read_b128 v[236:239], v4 offset:11264
    v_cvt_pk_bf16_f32 v87, v214, v215
    s_waitcnt lgkmcnt(3)
    v_mfma_f32_16x16x32_bf16 v[200:203], v[224:227], v[152:155], v[216:219]
    v_mfma_f32_16x16x32_bf16 v[204:207], v[224:227], v[168:171], v[220:223]
    ds_read_b128 v[240:243], v4 offset:12288
    v_exp_f32 v184, v184
    v_exp_f32 v185, v185
    v_mfma_f32_16x16x32_bf16 v[248:251], v[12:15], v[80:83], v[248:251]
    s_waitcnt lgkmcnt(3)
    v_mfma_f32_16x16x32_bf16 v[208:211], v[228:231], v[152:155], v[216:219]
    v_cvt_pk_bf16_f32 v88, v184, v185
    v_exp_f32 v186, v186
    v_mfma_f32_16x16x32_bf16 v[212:215], v[228:231], v[168:171], v[220:223]
    ds_read_b128 v[244:247], v4 offset:13312
    v_exp_f32 v187, v187
    v_mfma_f32_16x16x32_bf16 v[252:255], v[12:15], v[84:87], v[252:255]
    s_waitcnt lgkmcnt(3)
    v_mfma_f32_16x16x32_bf16 v[200:203], v[232:235], v[156:159], v[200:203]
    v_cvt_pk_bf16_f32 v89, v186, v187
    v_exp_f32 v188, v188
    v_mfma_f32_16x16x32_bf16 v[204:207], v[232:235], v[172:175], v[204:207]
    ds_read_b128 v[224:227], v4 offset:14336
    v_exp_f32 v189, v189
    s_waitcnt lgkmcnt(3)
    v_mfma_f32_16x16x32_bf16 v[208:211], v[236:239], v[156:159], v[208:211]
    v_cvt_pk_bf16_f32 v92, v188, v189
    v_exp_f32 v190, v190
    v_mfma_f32_16x16x32_bf16 v[212:215], v[236:239], v[172:175], v[212:215]
    ds_read_b128 v[228:231], v4 offset:15360
    v_exp_f32 v191, v191
    s_nop 0
    v_cvt_pk_bf16_f32 v93, v190, v191
    s_waitcnt lgkmcnt(3)
    v_mfma_f32_16x16x32_bf16 v[200:203], v[240:243], v[160:163], v[200:203]
    v_exp_f32 v192, v192
    v_mfma_f32_16x16x32_bf16 v[204:207], v[240:243], v[176:179], v[204:207]
    s_waitcnt vmcnt(12)
    s_barrier
    ds_read_b128 v[232:235], v4 offset:16384
    v_exp_f32 v193, v193
    s_nop 0
    v_cvt_pk_bf16_f32 v90, v192, v193
    s_add_u32 s22, s18, 35840
    s_add_u32 m0, s15, 5120
    s_nop 0
    buffer_load_dwordx4 v11, s[64:67], s22 offen lds
    s_waitcnt lgkmcnt(3)
    v_mfma_f32_16x16x32_bf16 v[208:211], v[244:247], v[160:163], v[208:211]
    v_exp_f32 v194, v194
    v_mfma_f32_16x16x32_bf16 v[212:215], v[244:247], v[176:179], v[212:215]
    s_add_u32 s22, s21, 0x84000
    s_add_u32 m0, s20, 0x24000
    s_nop 0
    buffer_load_dwordx4 v2, s[8:11], s22 offen sc1 lds
    ds_read_b128 v[236:239], v4 offset:17408
    v_exp_f32 v195, v195
    s_nop 0
    v_cvt_pk_bf16_f32 v91, v194, v195
    s_waitcnt lgkmcnt(3)
    v_mfma_f32_16x16x32_bf16 v[200:203], v[224:227], v[164:167], v[200:203]
    v_exp_f32 v196, v196
    v_exp_f32 v197, v197
    v_mfma_f32_16x16x32_bf16 v[204:207], v[224:227], v[180:183], v[204:207]
    ds_read_b128 v[240:243], v4 offset:18432
    v_cvt_pk_bf16_f32 v94, v196, v197
    s_waitcnt lgkmcnt(3)
    v_mfma_f32_16x16x32_bf16 v[208:211], v[228:231], v[164:167], v[208:211]
    v_exp_f32 v198, v198
    v_exp_f32 v199, v199
    v_mfma_f32_16x16x32_bf16 v[212:215], v[228:231], v[180:183], v[212:215]
    ds_read_b128 v[244:247], v4 offset:19456
    v_cvt_pk_bf16_f32 v95, v198, v199
    s_waitcnt lgkmcnt(3)
    v_mfma_f32_16x16x32_bf16 v[184:187], v[232:235], v[152:155], v[216:219]
    v_mfma_f32_16x16x32_bf16 v[188:191], v[232:235], v[168:171], v[220:223]
    ds_read_b128 v[224:227], v4 offset:20480
    v_exp_f32 v200, v200
    v_exp_f32 v201, v201
    v_mfma_f32_16x16x32_bf16 v[248:251], v[12:15], v[88:91], v[248:251]
    s_waitcnt lgkmcnt(3)
    v_mfma_f32_16x16x32_bf16 v[192:195], v[236:239], v[152:155], v[216:219]
    v_cvt_pk_bf16_f32 v96, v200, v201
    v_exp_f32 v202, v202
    v_mfma_f32_16x16x32_bf16 v[196:199], v[236:239], v[168:171], v[220:223]
    s_add_u32 s22, s21, 0x84400
    s_add_u32 m0, s20, 0x24400
    s_nop 0
    buffer_load_dwordx4 v2, s[8:11], s22 offen sc1 lds
    ds_read_b128 v[228:231], v4 offset:21504
    v_exp_f32 v203, v203
    v_mfma_f32_16x16x32_bf16 v[252:255], v[12:15], v[92:95], v[252:255]
    s_waitcnt lgkmcnt(3)
    v_mfma_f32_16x16x32_bf16 v[184:187], v[240:243], v[156:159], v[184:187]
    v_cvt_pk_bf16_f32 v97, v202, v203
    v_exp_f32 v204, v204
    v_mfma_f32_16x16x32_bf16 v[188:191], v[240:243], v[172:175], v[188:191]
    ds_read_b128 v[232:235], v4 offset:22528
    v_exp_f32 v205, v205
    s_waitcnt lgkmcnt(3)
    v_mfma_f32_16x16x32_bf16 v[192:195], v[244:247], v[156:159], v[192:195]
    v_cvt_pk_bf16_f32 v100, v204, v205
    v_exp_f32 v206, v206
    v_mfma_f32_16x16x32_bf16 v[196:199], v[244:247], v[172:175], v[196:199]
    ds_read_b128 v[236:239], v4 offset:23552
    v_exp_f32 v207, v207
    s_nop 0
    v_cvt_pk_bf16_f32 v101, v206, v207
    s_waitcnt lgkmcnt(3)
    v_mfma_f32_16x16x32_bf16 v[184:187], v[224:227], v[160:163], v[184:187]
    v_exp_f32 v208, v208
    v_mfma_f32_16x16x32_bf16 v[188:191], v[224:227], v[176:179], v[188:191]
    ds_read_b128 v[240:243], v4 offset:24576
    v_exp_f32 v209, v209
    s_nop 0
    v_cvt_pk_bf16_f32 v98, v208, v209
    s_waitcnt lgkmcnt(3)
    v_mfma_f32_16x16x32_bf16 v[192:195], v[228:231], v[160:163], v[192:195]
    v_exp_f32 v210, v210
    v_mfma_f32_16x16x32_bf16 v[196:199], v[228:231], v[176:179], v[196:199]
    ds_read_b128 v[244:247], v4 offset:25600
    v_exp_f32 v211, v211
    s_nop 0
    v_cvt_pk_bf16_f32 v99, v210, v211
    s_waitcnt lgkmcnt(3)
    v_mfma_f32_16x16x32_bf16 v[184:187], v[232:235], v[164:167], v[184:187]
    v_exp_f32 v212, v212
    v_exp_f32 v213, v213
    v_mfma_f32_16x16x32_bf16 v[188:191], v[232:235], v[180:183], v[188:191]
    ds_read_b128 v[224:227], v4 offset:26624
    v_cvt_pk_bf16_f32 v102, v212, v213
    s_waitcnt lgkmcnt(3)
    v_mfma_f32_16x16x32_bf16 v[192:195], v[236:239], v[164:167], v[192:195]
    v_exp_f32 v214, v214
    v_exp_f32 v215, v215
    v_mfma_f32_16x16x32_bf16 v[196:199], v[236:239], v[180:183], v[196:199]
    ds_read_b128 v[228:231], v4 offset:27648
    v_cvt_pk_bf16_f32 v103, v214, v215
    s_waitcnt lgkmcnt(3)
    v_mfma_f32_16x16x32_bf16 v[200:203], v[240:243], v[152:155], v[216:219]
    v_mfma_f32_16x16x32_bf16 v[204:207], v[240:243], v[168:171], v[220:223]
    ds_read_b128 v[232:235], v4 offset:28672
    v_exp_f32 v184, v184
    v_exp_f32 v185, v185
    s_add_u32 s22, s18, 43008
    s_add_u32 m0, s15, 6144
    s_nop 0
    buffer_load_dwordx4 v11, s[64:67], s22 offen lds
    v_mfma_f32_16x16x32_bf16 v[248:251], v[12:15], v[96:99], v[248:251]
    s_waitcnt lgkmcnt(3)
    v_mfma_f32_16x16x32_bf16 v[208:211], v[244:247], v[152:155], v[216:219]
    v_cvt_pk_bf16_f32 v104, v184, v185
    v_exp_f32 v186, v186
    v_mfma_f32_16x16x32_bf16 v[212:215], v[244:247], v[168:171], v[220:223]
    ds_read_b128 v[236:239], v4 offset:29696
    v_exp_f32 v187, v187
    v_mfma_f32_16x16x32_bf16 v[252:255], v[12:15], v[100:103], v[252:255]
    s_waitcnt lgkmcnt(3)
    v_mfma_f32_16x16x32_bf16 v[200:203], v[224:227], v[156:159], v[200:203]
    v_cvt_pk_bf16_f32 v105, v186, v187
    v_exp_f32 v188, v188
    v_mfma_f32_16x16x32_bf16 v[204:207], v[224:227], v[172:175], v[204:207]
    ds_read_b128 v[240:243], v4 offset:30720
    v_exp_f32 v189, v189
    s_waitcnt lgkmcnt(3)
    v_mfma_f32_16x16x32_bf16 v[208:211], v[228:231], v[156:159], v[208:211]
    v_cvt_pk_bf16_f32 v108, v188, v189
    v_exp_f32 v190, v190
    v_mfma_f32_16x16x32_bf16 v[212:215], v[228:231], v[172:175], v[212:215]
    ds_read_b128 v[244:247], v4 offset:31744
    v_exp_f32 v191, v191
    s_nop 0
    v_cvt_pk_bf16_f32 v109, v190, v191
    s_waitcnt lgkmcnt(3)
    v_mfma_f32_16x16x32_bf16 v[200:203], v[232:235], v[160:163], v[200:203]
    v_exp_f32 v192, v192
    v_mfma_f32_16x16x32_bf16 v[204:207], v[232:235], v[176:179], v[204:207]
    s_waitcnt vmcnt(11)
    s_barrier
    ds_read_b128 v[224:227], v4 offset:32768
    v_exp_f32 v193, v193
    s_nop 0
    v_cvt_pk_bf16_f32 v106, v192, v193
    s_waitcnt lgkmcnt(3)
    v_mfma_f32_16x16x32_bf16 v[208:211], v[236:239], v[160:163], v[208:211]
    v_exp_f32 v194, v194
    v_mfma_f32_16x16x32_bf16 v[212:215], v[236:239], v[176:179], v[212:215]
    s_add_u32 s22, s21, 0x88000
    s_add_u32 m0, s20, 0x10000
    s_nop 0
    buffer_load_dwordx4 v2, s[8:11], s22 offen sc1 lds
    ds_read_b128 v[228:231], v4 offset:33792
    v_exp_f32 v195, v195
    s_nop 0
    v_cvt_pk_bf16_f32 v107, v194, v195
    s_waitcnt lgkmcnt(3)
    v_mfma_f32_16x16x32_bf16 v[200:203], v[240:243], v[164:167], v[200:203]
    v_exp_f32 v196, v196
    v_exp_f32 v197, v197
    v_mfma_f32_16x16x32_bf16 v[204:207], v[240:243], v[180:183], v[204:207]
    ds_read_b128 v[232:235], v4 offset:34816
    v_cvt_pk_bf16_f32 v110, v196, v197
    s_waitcnt lgkmcnt(3)
    v_mfma_f32_16x16x32_bf16 v[208:211], v[244:247], v[164:167], v[208:211]
    v_exp_f32 v198, v198
    v_exp_f32 v199, v199
    v_mfma_f32_16x16x32_bf16 v[212:215], v[244:247], v[180:183], v[212:215]
    ds_read_b128 v[236:239], v4 offset:35840
    v_cvt_pk_bf16_f32 v111, v198, v199
    s_waitcnt lgkmcnt(3)
    v_mfma_f32_16x16x32_bf16 v[184:187], v[224:227], v[152:155], v[216:219]
    v_mfma_f32_16x16x32_bf16 v[188:191], v[224:227], v[168:171], v[220:223]
    ds_read_b128 v[240:243], v4 offset:36864
    v_exp_f32 v200, v200
    v_exp_f32 v201, v201
    v_mfma_f32_16x16x32_bf16 v[248:251], v[12:15], v[104:107], v[248:251]
    s_waitcnt lgkmcnt(3)
    v_mfma_f32_16x16x32_bf16 v[192:195], v[228:231], v[152:155], v[216:219]
    v_cvt_pk_bf16_f32 v112, v200, v201
    v_exp_f32 v202, v202
    v_mfma_f32_16x16x32_bf16 v[196:199], v[228:231], v[168:171], v[220:223]
    s_add_u32 s22, s21, 0x88400
    s_add_u32 m0, s20, 0x10400
    s_nop 0
    buffer_load_dwordx4 v2, s[8:11], s22 offen sc1 lds
    ds_read_b128 v[244:247], v4 offset:37888
    v_exp_f32 v203, v203
    v_mfma_f32_16x16x32_bf16 v[252:255], v[12:15], v[108:111], v[252:255]
    s_waitcnt lgkmcnt(3)
    v_mfma_f32_16x16x32_bf16 v[184:187], v[232:235], v[156:159], v[184:187]
    v_cvt_pk_bf16_f32 v113, v202, v203
    v_exp_f32 v204, v204
    v_mfma_f32_16x16x32_bf16 v[188:191], v[232:235], v[172:175], v[188:191]
    ds_read_b128 v[224:227], v4 offset:38912
    v_exp_f32 v205, v205
    s_waitcnt lgkmcnt(3)
    v_mfma_f32_16x16x32_bf16 v[192:195], v[236:239], v[156:159], v[192:195]
    v_cvt_pk_bf16_f32 v116, v204, v205
    v_exp_f32 v206, v206
    v_mfma_f32_16x16x32_bf16 v[196:199], v[236:239], v[172:175], v[196:199]
    ds_read_b128 v[228:231], v4 offset:39936
    v_exp_f32 v207, v207
    s_nop 0
    v_cvt_pk_bf16_f32 v117, v206, v207
    s_waitcnt lgkmcnt(3)
    v_mfma_f32_16x16x32_bf16 v[184:187], v[240:243], v[160:163], v[184:187]
    v_exp_f32 v208, v208
    s_add_u32 s22, s18, 50176
    s_add_u32 m0, s15, 7168
    s_nop 0
    buffer_load_dwordx4 v11, s[64:67], s22 offen lds
    v_mfma_f32_16x16x32_bf16 v[188:191], v[240:243], v[176:179], v[188:191]
    ds_read_b128 v[232:235], v4 offset:40960
    v_exp_f32 v209, v209
    s_nop 0
    v_cvt_pk_bf16_f32 v114, v208, v209
    s_waitcnt lgkmcnt(3)
    v_mfma_f32_16x16x32_bf16 v[192:195], v[244:247], v[160:163], v[192:195]
    v_exp_f32 v210, v210
    v_mfma_f32_16x16x32_bf16 v[196:199], v[244:247], v[176:179], v[196:199]
    ds_read_b128 v[236:239], v4 offset:41984
    v_exp_f32 v211, v211
    s_nop 0
    v_cvt_pk_bf16_f32 v115, v210, v211
    s_waitcnt lgkmcnt(3)
    v_mfma_f32_16x16x32_bf16 v[184:187], v[224:227], v[164:167], v[184:187]
    v_exp_f32 v212, v212
    v_exp_f32 v213, v213
    v_mfma_f32_16x16x32_bf16 v[188:191], v[224:227], v[180:183], v[188:191]
    ds_read_b128 v[240:243], v4 offset:43008
    v_cvt_pk_bf16_f32 v118, v212, v213
    s_waitcnt lgkmcnt(3)
    v_mfma_f32_16x16x32_bf16 v[192:195], v[228:231], v[164:167], v[192:195]
    v_exp_f32 v214, v214
    v_exp_f32 v215, v215
    v_mfma_f32_16x16x32_bf16 v[196:199], v[228:231], v[180:183], v[196:199]
    ds_read_b128 v[244:247], v4 offset:44032
    v_cvt_pk_bf16_f32 v119, v214, v215
    s_waitcnt lgkmcnt(3)
    v_mfma_f32_16x16x32_bf16 v[200:203], v[232:235], v[152:155], v[216:219]
    v_mfma_f32_16x16x32_bf16 v[204:207], v[232:235], v[168:171], v[220:223]
    ds_read_b128 v[224:227], v4 offset:45056
    v_exp_f32 v184, v184
    v_exp_f32 v185, v185
    v_mfma_f32_16x16x32_bf16 v[248:251], v[12:15], v[112:115], v[248:251]
    s_waitcnt lgkmcnt(3)
    v_mfma_f32_16x16x32_bf16 v[208:211], v[236:239], v[152:155], v[216:219]
    v_cvt_pk_bf16_f32 v120, v184, v185
    v_exp_f32 v186, v186
    v_mfma_f32_16x16x32_bf16 v[212:215], v[236:239], v[168:171], v[220:223]
    ds_read_b128 v[228:231], v4 offset:46080
    v_exp_f32 v187, v187
    v_mfma_f32_16x16x32_bf16 v[252:255], v[12:15], v[116:119], v[252:255]
    s_waitcnt lgkmcnt(3)
    v_mfma_f32_16x16x32_bf16 v[200:203], v[240:243], v[156:159], v[200:203]
    v_cvt_pk_bf16_f32 v121, v186, v187
    v_exp_f32 v188, v188
    v_mfma_f32_16x16x32_bf16 v[204:207], v[240:243], v[172:175], v[204:207]
    ds_read_b128 v[232:235], v4 offset:47104
    v_exp_f32 v189, v189
    s_waitcnt lgkmcnt(3)
    v_mfma_f32_16x16x32_bf16 v[208:211], v[244:247], v[156:159], v[208:211]
    v_cvt_pk_bf16_f32 v124, v188, v189
    v_exp_f32 v190, v190
    v_mfma_f32_16x16x32_bf16 v[212:215], v[244:247], v[172:175], v[212:215]
    ds_read_b128 v[236:239], v4 offset:48128
    v_exp_f32 v191, v191
    s_nop 0
    v_cvt_pk_bf16_f32 v125, v190, v191
    s_waitcnt lgkmcnt(3)
    v_mfma_f32_16x16x32_bf16 v[200:203], v[224:227], v[160:163], v[200:203]
    v_exp_f32 v192, v192
    v_mfma_f32_16x16x32_bf16 v[204:207], v[224:227], v[176:179], v[204:207]
    s_waitcnt vmcnt(11)
    s_barrier
    ds_read_b128 v[240:243], v4 offset:49152
    v_exp_f32 v193, v193
    s_nop 0
    v_cvt_pk_bf16_f32 v122, v192, v193
    s_waitcnt lgkmcnt(3)
    v_mfma_f32_16x16x32_bf16 v[208:211], v[228:231], v[160:163], v[208:211]
    v_exp_f32 v194, v194
    v_mfma_f32_16x16x32_bf16 v[212:215], v[228:231], v[176:179], v[212:215]
    s_add_u32 s22, s21, 0x8c000
    s_add_u32 m0, s20, 0x14000
    s_nop 0
    buffer_load_dwordx4 v2, s[8:11], s22 offen sc1 lds
    ds_read_b128 v[244:247], v4 offset:50176
    v_exp_f32 v195, v195
    s_nop 0
    v_cvt_pk_bf16_f32 v123, v194, v195
    s_waitcnt lgkmcnt(3)
    v_mfma_f32_16x16x32_bf16 v[200:203], v[232:235], v[164:167], v[200:203]
    v_exp_f32 v196, v196
    v_exp_f32 v197, v197
    v_mfma_f32_16x16x32_bf16 v[204:207], v[232:235], v[180:183], v[204:207]
    ds_read_b128 v[224:227], v4 offset:51200
    v_cvt_pk_bf16_f32 v126, v196, v197
    s_waitcnt lgkmcnt(3)
    v_mfma_f32_16x16x32_bf16 v[208:211], v[236:239], v[164:167], v[208:211]
    v_exp_f32 v198, v198
    v_exp_f32 v199, v199
    v_mfma_f32_16x16x32_bf16 v[212:215], v[236:239], v[180:183], v[212:215]
    ds_read_b128 v[228:231], v4 offset:52224
    v_cvt_pk_bf16_f32 v127, v198, v199
    s_waitcnt lgkmcnt(3)
    v_mfma_f32_16x16x32_bf16 v[184:187], v[240:243], v[152:155], v[216:219]
    v_mfma_f32_16x16x32_bf16 v[188:191], v[240:243], v[168:171], v[220:223]
    ds_read_b128 v[232:235], v4 offset:53248
    v_exp_f32 v200, v200
    v_exp_f32 v201, v201
    v_mfma_f32_16x16x32_bf16 v[248:251], v[12:15], v[120:123], v[248:251]
    s_waitcnt lgkmcnt(3)
    v_mfma_f32_16x16x32_bf16 v[192:195], v[244:247], v[152:155], v[216:219]
    v_cvt_pk_bf16_f32 v128, v200, v201
    v_exp_f32 v202, v202
    v_mfma_f32_16x16x32_bf16 v[196:199], v[244:247], v[168:171], v[220:223]
    s_add_u32 s22, s21, 0x8c400
    s_add_u32 m0, s20, 0x14400
    s_nop 0
    buffer_load_dwordx4 v2, s[8:11], s22 offen sc1 lds
    ds_read_b128 v[236:239], v4 offset:54272
    v_exp_f32 v203, v203
    v_mfma_f32_16x16x32_bf16 v[252:255], v[12:15], v[124:127], v[252:255]
    s_waitcnt lgkmcnt(3)
    v_mfma_f32_16x16x32_bf16 v[184:187], v[224:227], v[156:159], v[184:187]
    v_cvt_pk_bf16_f32 v129, v202, v203
    v_exp_f32 v204, v204
    v_mfma_f32_16x16x32_bf16 v[188:191], v[224:227], v[172:175], v[188:191]
    ds_read_b128 v[240:243], v4 offset:55296
    v_exp_f32 v205, v205
    s_waitcnt lgkmcnt(3)
    v_mfma_f32_16x16x32_bf16 v[192:195], v[228:231], v[156:159], v[192:195]
    v_cvt_pk_bf16_f32 v132, v204, v205
    v_exp_f32 v206, v206
    v_mfma_f32_16x16x32_bf16 v[196:199], v[228:231], v[172:175], v[196:199]
    ds_read_b128 v[244:247], v4 offset:56320
    v_exp_f32 v207, v207
    s_nop 0
    v_cvt_pk_bf16_f32 v133, v206, v207
    s_waitcnt lgkmcnt(3)
    v_mfma_f32_16x16x32_bf16 v[184:187], v[232:235], v[160:163], v[184:187]
    v_exp_f32 v208, v208
    v_mfma_f32_16x16x32_bf16 v[188:191], v[232:235], v[176:179], v[188:191]
    ds_read_b128 v[224:227], v4 offset:57344
    v_exp_f32 v209, v209
    s_nop 0
    v_cvt_pk_bf16_f32 v130, v208, v209
    s_waitcnt lgkmcnt(3)
    v_mfma_f32_16x16x32_bf16 v[192:195], v[236:239], v[160:163], v[192:195]
    v_exp_f32 v210, v210
    v_mfma_f32_16x16x32_bf16 v[196:199], v[236:239], v[176:179], v[196:199]
    ds_read_b128 v[228:231], v4 offset:58368
    v_exp_f32 v211, v211
    s_nop 0
    v_cvt_pk_bf16_f32 v131, v210, v211
    s_waitcnt lgkmcnt(3)
    v_mfma_f32_16x16x32_bf16 v[184:187], v[240:243], v[164:167], v[184:187]
    v_exp_f32 v212, v212
    v_exp_f32 v213, v213
    v_mfma_f32_16x16x32_bf16 v[188:191], v[240:243], v[180:183], v[188:191]
    ds_read_b128 v[232:235], v4 offset:59392
    v_cvt_pk_bf16_f32 v134, v212, v213
    s_waitcnt lgkmcnt(3)
    v_mfma_f32_16x16x32_bf16 v[192:195], v[244:247], v[164:167], v[192:195]
    v_exp_f32 v214, v214
    v_exp_f32 v215, v215
    v_mfma_f32_16x16x32_bf16 v[196:199], v[244:247], v[180:183], v[196:199]
    ds_read_b128 v[236:239], v4 offset:60416
    v_cvt_pk_bf16_f32 v135, v214, v215
    s_waitcnt lgkmcnt(3)
    v_mfma_f32_16x16x32_bf16 v[200:203], v[224:227], v[152:155], v[216:219]
    v_mfma_f32_16x16x32_bf16 v[204:207], v[224:227], v[168:171], v[220:223]
    ds_read_b128 v[240:243], v4 offset:61440
    v_exp_f32 v184, v184
    v_exp_f32 v185, v185
    v_mfma_f32_16x16x32_bf16 v[248:251], v[12:15], v[128:131], v[248:251]
    s_waitcnt lgkmcnt(3)
    v_mfma_f32_16x16x32_bf16 v[208:211], v[228:231], v[152:155], v[216:219]
    v_cvt_pk_bf16_f32 v136, v184, v185
    v_exp_f32 v186, v186
    v_mfma_f32_16x16x32_bf16 v[212:215], v[228:231], v[168:171], v[220:223]
    ds_read_b128 v[244:247], v4 offset:62464
    v_exp_f32 v187, v187
    v_mfma_f32_16x16x32_bf16 v[252:255], v[12:15], v[132:135], v[252:255]
    s_waitcnt lgkmcnt(3)
    v_mfma_f32_16x16x32_bf16 v[200:203], v[232:235], v[156:159], v[200:203]
    v_cvt_pk_bf16_f32 v137, v186, v187
    v_exp_f32 v188, v188
    v_mfma_f32_16x16x32_bf16 v[204:207], v[232:235], v[172:175], v[204:207]
    ds_read_b128 v[224:227], v4 offset:63488
    v_exp_f32 v189, v189
    s_waitcnt lgkmcnt(3)
    v_mfma_f32_16x16x32_bf16 v[208:211], v[236:239], v[156:159], v[208:211]
    v_cvt_pk_bf16_f32 v140, v188, v189
    v_exp_f32 v190, v190
    v_mfma_f32_16x16x32_bf16 v[212:215], v[236:239], v[172:175], v[212:215]
    ds_read_b128 v[228:231], v4 offset:64512
    v_exp_f32 v191, v191
    s_nop 0
    v_cvt_pk_bf16_f32 v141, v190, v191
    s_waitcnt lgkmcnt(3)
    v_mfma_f32_16x16x32_bf16 v[200:203], v[240:243], v[160:163], v[200:203]
    v_exp_f32 v192, v192
    v_mfma_f32_16x16x32_bf16 v[204:207], v[240:243], v[176:179], v[204:207]
    v_exp_f32 v193, v193
    s_nop 0
    v_cvt_pk_bf16_f32 v138, v192, v193
    s_waitcnt lgkmcnt(2)
    v_mfma_f32_16x16x32_bf16 v[208:211], v[244:247], v[160:163], v[208:211]
    v_exp_f32 v194, v194
    v_mfma_f32_16x16x32_bf16 v[212:215], v[244:247], v[176:179], v[212:215]
    v_exp_f32 v195, v195
    s_nop 0
    v_cvt_pk_bf16_f32 v139, v194, v195
    s_waitcnt lgkmcnt(1)
    v_mfma_f32_16x16x32_bf16 v[200:203], v[224:227], v[164:167], v[200:203]
    v_exp_f32 v196, v196
    v_exp_f32 v197, v197
    v_mfma_f32_16x16x32_bf16 v[204:207], v[224:227], v[180:183], v[204:207]
    v_cvt_pk_bf16_f32 v142, v196, v197
    s_waitcnt lgkmcnt(0)
    v_mfma_f32_16x16x32_bf16 v[208:211], v[228:231], v[164:167], v[208:211]
    v_exp_f32 v198, v198
    v_exp_f32 v199, v199
    v_mfma_f32_16x16x32_bf16 v[212:215], v[228:231], v[180:183], v[212:215]
    v_cvt_pk_bf16_f32 v143, v198, v199
    s_waitcnt vmcnt(9)
    s_barrier
    ds_read_b128 v[232:235], v5 offset:0
    ds_read_b128 v[236:239], v5 offset:1024
    ds_read_b128 v[240:243], v5 offset:2048
    ds_read_b128 v[244:247], v5 offset:3072
    v_mfma_f32_16x16x32_bf16 v[248:251], v[12:15], v[136:139], v[248:251]
    v_mfma_f32_16x16x32_bf16 v[252:255], v[12:15], v[140:143], v[252:255]
    v_exp_f32 v200, v200
    v_exp_f32 v201, v201
    s_nop 0
    v_cvt_pk_bf16_f32 v144, v200, v201
    v_exp_f32 v202, v202
    v_exp_f32 v203, v203
    s_nop 0
    v_cvt_pk_bf16_f32 v145, v202, v203
    v_exp_f32 v204, v204
    v_exp_f32 v205, v205
    s_nop 0
    v_cvt_pk_bf16_f32 v148, v204, v205
    v_exp_f32 v206, v206
    v_exp_f32 v207, v207
    s_nop 0
    v_cvt_pk_bf16_f32 v149, v206, v207
    v_exp_f32 v208, v208
    v_exp_f32 v209, v209
    s_nop 0
    v_cvt_pk_bf16_f32 v146, v208, v209
    v_exp_f32 v210, v210
    v_exp_f32 v211, v211
    s_nop 0
    v_cvt_pk_bf16_f32 v147, v210, v211
    v_exp_f32 v212, v212
    v_exp_f32 v213, v213
    s_nop 0
    v_cvt_pk_bf16_f32 v150, v212, v213
    v_exp_f32 v214, v214
    v_exp_f32 v215, v215
    s_nop 0
    v_cvt_pk_bf16_f32 v151, v214, v215
    v_mfma_f32_16x16x32_bf16 v[248:251], v[12:15], v[144:147], v[248:251]
    s_nop 0
    v_mfma_f32_16x16x32_bf16 v[252:255], v[12:15], v[148:151], v[252:255]
    s_nop 5
    v_mov_b32 v9, v248
    s_nop 0
    v_mov_b32 v10, v252
    v_max_f32 v17, v9, v10
    v_readfirstlane_b32 s17, v8
    s_cmp_eq_u32 s17, s28
    s_cselect_b32 s16, 0, 0x71800000
    v_cmp_ngt_f32 vcc, s16, v17
    v_cmp_u_f32 s[76:77], v9, v10
    s_or_b64 vcc, vcc, s[76:77]
    s_cbranch_vccnz adaLN_cond__sliding_block_cached__moe_arch_mod__prompt_kernel_fixB
adaLN_cond__sliding_block_cached__moe_arch_mod__prompt_kernel_fixBb:
    v_rcp_f32 v9, v9
    v_rcp_f32 v10, v10
    s_lshl_b32 s25, s13, 3
    s_add_u32 s25, s25, s3
    s_lshl_b32 s25, s25, 18
    s_lshl_b32 s26, s12, 12
    s_add_u32 s25, s25, s26
    s_add_u32 s25, s25, 0x1000000
    s_add_u32 s26, s25, 131072
    s_lshl_b32 s63, s13, 3
    s_add_u32 s63, s63, s3
    s_lshl_b32 s63, s63, 5
    s_add_u32 s63, s63, s12
    s_lshl_b32 s63, s63, 2
    s_waitcnt lgkmcnt(3)
    v_mfma_f32_16x16x32_bf16 v[184:187], v[232:235], v[24:27], 0
    v_mfma_f32_16x16x32_bf16 v[188:191], v[232:235], v[28:31], 0
    ds_read_b128 v[224:227], v5 offset:4096
    s_waitcnt lgkmcnt(3)
    v_mfma_f32_16x16x32_bf16 v[192:195], v[236:239], v[24:27], 0
    s_add_u32 s22, s21, 0x90000
    s_add_u32 m0, s20, 0x18000
    s_nop 0
    buffer_load_dwordx4 v2, s[8:11], s22 offen sc1 lds
    v_mfma_f32_16x16x32_bf16 v[196:199], v[236:239], v[28:31], 0
    ds_read_b128 v[228:231], v5 offset:5120
    s_waitcnt lgkmcnt(3)
    v_mfma_f32_16x16x32_bf16 v[184:187], v[240:243], v[32:35], v[184:187]
    v_mfma_f32_16x16x32_bf16 v[188:191], v[240:243], v[36:39], v[188:191]
    ds_read_b128 v[232:235], v5 offset:6144
    s_waitcnt lgkmcnt(3)
    v_mfma_f32_16x16x32_bf16 v[192:195], v[244:247], v[32:35], v[192:195]
    v_mfma_f32_16x16x32_bf16 v[196:199], v[244:247], v[36:39], v[196:199]
    ds_read_b128 v[236:239], v5 offset:7168
    s_waitcnt lgkmcnt(3)
    v_mfma_f32_16x16x32_bf16 v[184:187], v[224:227], v[40:43], v[184:187]
    v_mfma_f32_16x16x32_bf16 v[188:191], v[224:227], v[44:47], v[188:191]
    ds_read_b128 v[240:243], v5 offset:8192
    s_waitcnt lgkmcnt(3)
    v_mfma_f32_16x16x32_bf16 v[192:195], v[228:231], v[40:43], v[192:195]
    s_add_u32 s22, s21, 0x90400
    s_add_u32 m0, s20, 0x18400
    s_nop 0
    buffer_load_dwordx4 v2, s[8:11], s22 offen sc1 lds
    v_mfma_f32_16x16x32_bf16 v[196:199], v[228:231], v[44:47], v[196:199]
    ds_read_b128 v[244:247], v5 offset:9216
    s_waitcnt lgkmcnt(3)
    v_mfma_f32_16x16x32_bf16 v[184:187], v[232:235], v[48:51], v[184:187]
    v_mfma_f32_16x16x32_bf16 v[188:191], v[232:235], v[52:55], v[188:191]
    ds_read_b128 v[224:227], v5 offset:10240
    s_waitcnt lgkmcnt(3)
    v_mfma_f32_16x16x32_bf16 v[192:195], v[236:239], v[48:51], v[192:195]
    v_mfma_f32_16x16x32_bf16 v[196:199], v[236:239], v[52:55], v[196:199]
    ds_read_b128 v[228:231], v5 offset:11264
    s_waitcnt lgkmcnt(3)
    v_mfma_f32_16x16x32_bf16 v[184:187], v[240:243], v[56:59], v[184:187]
    v_mfma_f32_16x16x32_bf16 v[188:191], v[240:243], v[60:63], v[188:191]
    ds_read_b128 v[232:235], v5 offset:12288
    s_waitcnt lgkmcnt(3)
    v_mfma_f32_16x16x32_bf16 v[192:195], v[244:247], v[56:59], v[192:195]
    v_mfma_f32_16x16x32_bf16 v[196:199], v[244:247], v[60:63], v[196:199]
    ds_read_b128 v[236:239], v5 offset:13312
    s_waitcnt lgkmcnt(3)
    v_mfma_f32_16x16x32_bf16 v[184:187], v[224:227], v[64:67], v[184:187]
    v_mfma_f32_16x16x32_bf16 v[188:191], v[224:227], v[68:71], v[188:191]
    ds_read_b128 v[240:243], v5 offset:14336
    s_waitcnt lgkmcnt(3)
    v_mfma_f32_16x16x32_bf16 v[192:195], v[228:231], v[64:67], v[192:195]
    v_mfma_f32_16x16x32_bf16 v[196:199], v[228:231], v[68:71], v[196:199]
    ds_read_b128 v[244:247], v5 offset:15360
    s_waitcnt lgkmcnt(3)
    v_mfma_f32_16x16x32_bf16 v[184:187], v[232:235], v[72:75], v[184:187]
    v_mfma_f32_16x16x32_bf16 v[188:191], v[232:235], v[76:79], v[188:191]
    s_waitcnt vmcnt(8)
    s_barrier
    ds_read_b128 v[224:227], v5 offset:16384
    s_waitcnt lgkmcnt(3)
    v_mfma_f32_16x16x32_bf16 v[192:195], v[236:239], v[72:75], v[192:195]
    v_mfma_f32_16x16x32_bf16 v[196:199], v[236:239], v[76:79], v[196:199]
    s_add_u32 s22, s21, 0x94000
    s_add_u32 m0, s20, 0x1c000
    s_nop 0
    buffer_load_dwordx4 v2, s[8:11], s22 offen sc1 lds
    ds_read_b128 v[228:231], v5 offset:17408
    s_waitcnt lgkmcnt(3)
    v_mfma_f32_16x16x32_bf16 v[184:187], v[240:243], v[80:83], v[184:187]
    v_mfma_f32_16x16x32_bf16 v[188:191], v[240:243], v[84:87], v[188:191]
    ds_read_b128 v[232:235], v5 offset:18432
    s_waitcnt lgkmcnt(3)
    v_mfma_f32_16x16x32_bf16 v[192:195], v[244:247], v[80:83], v[192:195]
    v_mfma_f32_16x16x32_bf16 v[196:199], v[244:247], v[84:87], v[196:199]
    ds_read_b128 v[236:239], v5 offset:19456
    s_waitcnt lgkmcnt(3)
    v_mfma_f32_16x16x32_bf16 v[184:187], v[224:227], v[88:91], v[184:187]
    v_mfma_f32_16x16x32_bf16 v[188:191], v[224:227], v[92:95], v[188:191]
    ds_read_b128 v[240:243], v5 offset:20480
    s_waitcnt lgkmcnt(3)
    v_mfma_f32_16x16x32_bf16 v[192:195], v[228:231], v[88:91], v[192:195]
    v_mfma_f32_16x16x32_bf16 v[196:199], v[228:231], v[92:95], v[196:199]
    s_add_u32 s22, s21, 0x94400
    s_add_u32 m0, s20, 0x1c400
    s_nop 0
    buffer_load_dwordx4 v2, s[8:11], s22 offen sc1 lds
    ds_read_b128 v[244:247], v5 offset:21504
    s_waitcnt lgkmcnt(3)
    v_mfma_f32_16x16x32_bf16 v[184:187], v[232:235], v[96:99], v[184:187]
    v_mfma_f32_16x16x32_bf16 v[188:191], v[232:235], v[100:103], v[188:191]
    ds_read_b128 v[224:227], v5 offset:22528
    s_waitcnt lgkmcnt(3)
    v_mfma_f32_16x16x32_bf16 v[192:195], v[236:239], v[96:99], v[192:195]
    v_mfma_f32_16x16x32_bf16 v[196:199], v[236:239], v[100:103], v[196:199]
    ds_read_b128 v[228:231], v5 offset:23552
    s_waitcnt lgkmcnt(3)
    v_mfma_f32_16x16x32_bf16 v[184:187], v[240:243], v[104:107], v[184:187]
    v_mfma_f32_16x16x32_bf16 v[188:191], v[240:243], v[108:111], v[188:191]
    ds_read_b128 v[232:235], v5 offset:24576
    s_waitcnt lgkmcnt(3)
    v_mfma_f32_16x16x32_bf16 v[192:195], v[244:247], v[104:107], v[192:195]
    v_mfma_f32_16x16x32_bf16 v[196:199], v[244:247], v[108:111], v[196:199]
    ds_read_b128 v[236:239], v5 offset:25600
    s_waitcnt lgkmcnt(3)
    v_mfma_f32_16x16x32_bf16 v[184:187], v[224:227], v[112:115], v[184:187]
    v_mfma_f32_16x16x32_bf16 v[188:191], v[224:227], v[116:119], v[188:191]
    ds_read_b128 v[240:243], v5 offset:26624
    s_waitcnt lgkmcnt(3)
    v_mfma_f32_16x16x32_bf16 v[192:195], v[228:231], v[112:115], v[192:195]
    v_mfma_f32_16x16x32_bf16 v[196:199], v[228:231], v[116:119], v[196:199]
    ds_read_b128 v[244:247], v5 offset:27648
    s_waitcnt lgkmcnt(3)
    v_mfma_f32_16x16x32_bf16 v[184:187], v[232:235], v[120:123], v[184:187]
    v_mfma_f32_16x16x32_bf16 v[188:191], v[232:235], v[124:127], v[188:191]
    ds_read_b128 v[224:227], v5 offset:28672
    s_waitcnt lgkmcnt(3)
    v_mfma_f32_16x16x32_bf16 v[192:195], v[236:239], v[120:123], v[192:195]
    v_mfma_f32_16x16x32_bf16 v[196:199], v[236:239], v[124:127], v[196:199]
    ds_read_b128 v[228:231], v5 offset:29696
    s_waitcnt lgkmcnt(3)
    v_mfma_f32_16x16x32_bf16 v[184:187], v[240:243], v[128:131], v[184:187]
    v_mfma_f32_16x16x32_bf16 v[188:191], v[240:243], v[132:135], v[188:191]
    ds_read_b128 v[232:235], v5 offset:30720
    s_waitcnt lgkmcnt(3)
    v_mfma_f32_16x16x32_bf16 v[192:195], v[244:247], v[128:131], v[192:195]
    v_mfma_f32_16x16x32_bf16 v[196:199], v[244:247], v[132:135], v[196:199]
    ds_read_b128 v[236:239], v5 offset:31744
    s_waitcnt lgkmcnt(3)
    v_mfma_f32_16x16x32_bf16 v[184:187], v[224:227], v[136:139], v[184:187]
    v_mfma_f32_16x16x32_bf16 v[188:191], v[224:227], v[140:143], v[188:191]
    s_waitcnt vmcnt(7)
    s_barrier
    ds_read_b128 v[240:243], v4 offset:0
    s_waitcnt lgkmcnt(3)
    v_mfma_f32_16x16x32_bf16 v[192:195], v[228:231], v[136:139], v[192:195]
    v_mfma_f32_16x16x32_bf16 v[196:199], v[228:231], v[140:143], v[196:199]
    s_add_u32 s22, s21, 0x98000
    s_add_u32 m0, s20, 0x20000
    s_nop 0
    buffer_load_dwordx4 v2, s[8:11], s22 offen sc1 lds
    ds_read_b128 v[244:247], v4 offset:1024
    s_waitcnt lgkmcnt(3)
    v_mfma_f32_16x16x32_bf16 v[184:187], v[232:235], v[144:147], v[184:187]
    v_mfma_f32_16x16x32_bf16 v[188:191], v[232:235], v[148:151], v[188:191]
    ds_read_b128 v[224:227], v4 offset:2048
    s_waitcnt lgkmcnt(3)
    v_mfma_f32_16x16x32_bf16 v[192:195], v[236:239], v[144:147], v[192:195]
    v_mfma_f32_16x16x32_bf16 v[196:199], v[236:239], v[148:151], v[196:199]
    ds_read_b128 v[228:231], v4 offset:3072
    s_waitcnt lgkmcnt(3)
    v_mfma_f32_16x16x32_bf16 v[200:203], v[240:243], v[24:27], 0
    v_mfma_f32_16x16x32_bf16 v[204:207], v[240:243], v[28:31], 0
    ds_read_b128 v[232:235], v4 offset:4096
    s_waitcnt lgkmcnt(3)
    v_mfma_f32_16x16x32_bf16 v[208:211], v[244:247], v[24:27], 0
    v_mfma_f32_16x16x32_bf16 v[212:215], v[244:247], v[28:31], 0
    s_add_u32 s22, s21, 0x98400
    s_add_u32 m0, s20, 0x20400
    s_nop 0
    buffer_load_dwordx4 v2, s[8:11], s22 offen sc1 lds
    ds_read_b128 v[236:239], v4 offset:5120
    v_mul_f32 v184, v184, v9
    s_waitcnt lgkmcnt(3)
    v_mfma_f32_16x16x32_bf16 v[200:203], v[224:227], v[32:35], v[200:203]
    v_mul_f32 v185, v185, v9
    v_mfma_f32_16x16x32_bf16 v[204:207], v[224:227], v[36:39], v[204:207]
    ds_read_b128 v[240:243], v4 offset:6144
    v_mul_f32 v186, v186, v9
    s_waitcnt lgkmcnt(3)
    v_mfma_f32_16x16x32_bf16 v[208:211], v[228:231], v[32:35], v[208:211]
    v_mul_f32 v187, v187, v9
    v_mfma_f32_16x16x32_bf16 v[212:215], v[228:231], v[36:39], v[212:215]
    ds_read_b128 v[244:247], v4 offset:7168
    v_mul_f32 v192, v192, v9
    s_waitcnt lgkmcnt(3)
    v_mfma_f32_16x16x32_bf16 v[200:203], v[232:235], v[40:43], v[200:203]
    v_mul_f32 v193, v193, v9
    v_mfma_f32_16x16x32_bf16 v[204:207], v[232:235], v[44:47], v[204:207]
    ds_read_b128 v[224:227], v4 offset:8192
    v_mul_f32 v194, v194, v9
    s_waitcnt lgkmcnt(3)
    v_mfma_f32_16x16x32_bf16 v[208:211], v[236:239], v[40:43], v[208:211]
    v_mul_f32 v195, v195, v9
    v_mfma_f32_16x16x32_bf16 v[212:215], v[236:239], v[44:47], v[212:215]
    ds_read_b128 v[228:231], v4 offset:9216
    v_cvt_pk_bf16_f32 v216, v184, v185
    s_waitcnt lgkmcnt(3)
    v_mfma_f32_16x16x32_bf16 v[200:203], v[240:243], v[48:51], v[200:203]
    v_cvt_pk_bf16_f32 v217, v186, v187
    v_mfma_f32_16x16x32_bf16 v[204:207], v[240:243], v[52:55], v[204:207]
    ds_read_b128 v[232:235], v4 offset:10240
    v_cvt_pk_bf16_f32 v218, v192, v193
    s_waitcnt lgkmcnt(3)
    v_mfma_f32_16x16x32_bf16 v[208:211], v[244:247], v[48:51], v[208:211]
    v_cvt_pk_bf16_f32 v219, v194, v195
    v_mfma_f32_16x16x32_bf16 v[212:215], v[244:247], v[52:55], v[212:215]
    ds_read_b128 v[236:239], v4 offset:11264
    buffer_store_dwordx4 v[216:219], v2, s[8:11], s25 offen offset:0 sc1
    s_waitcnt lgkmcnt(3)
    v_mfma_f32_16x16x32_bf16 v[200:203], v[224:227], v[56:59], v[200:203]
    v_mul_f32 v188, v188, v10
    v_mfma_f32_16x16x32_bf16 v[204:207], v[224:227], v[60:63], v[204:207]
    ds_read_b128 v[240:243], v4 offset:12288
    v_mul_f32 v189, v189, v10
    s_waitcnt lgkmcnt(3)
    v_mfma_f32_16x16x32_bf16 v[208:211], v[228:231], v[56:59], v[208:211]
    v_mul_f32 v190, v190, v10
    v_mfma_f32_16x16x32_bf16 v[212:215], v[228:231], v[60:63], v[212:215]
    ds_read_b128 v[244:247], v4 offset:13312
    v_mul_f32 v191, v191, v10
    s_waitcnt lgkmcnt(3)
    v_mfma_f32_16x16x32_bf16 v[200:203], v[232:235], v[64:67], v[200:203]
    v_mul_f32 v196, v196, v10
    v_mfma_f32_16x16x32_bf16 v[204:207], v[232:235], v[68:71], v[204:207]
    ds_read_b128 v[224:227], v4 offset:14336
    v_mul_f32 v197, v197, v10
    s_waitcnt lgkmcnt(3)
    v_mfma_f32_16x16x32_bf16 v[208:211], v[236:239], v[64:67], v[208:211]
    v_mul_f32 v198, v198, v10
    v_mfma_f32_16x16x32_bf16 v[212:215], v[236:239], v[68:71], v[212:215]
    ds_read_b128 v[228:231], v4 offset:15360
    v_mul_f32 v199, v199, v10
    s_waitcnt lgkmcnt(3)
    v_mfma_f32_16x16x32_bf16 v[200:203], v[240:243], v[72:75], v[200:203]
    v_cvt_pk_bf16_f32 v220, v188, v189
    v_mfma_f32_16x16x32_bf16 v[204:207], v[240:243], v[76:79], v[204:207]
    s_waitcnt vmcnt(7)
    s_barrier
    ds_read_b128 v[232:235], v4 offset:16384
    v_cvt_pk_bf16_f32 v221, v190, v191
    s_waitcnt lgkmcnt(3)
    v_mfma_f32_16x16x32_bf16 v[208:211], v[244:247], v[72:75], v[208:211]
    v_cvt_pk_bf16_f32 v222, v196, v197
    v_mfma_f32_16x16x32_bf16 v[212:215], v[244:247], v[76:79], v[212:215]
    s_add_u32 s22, s21, 0x9c000
    s_add_u32 m0, s20, 0x24000
    s_nop 0
    buffer_load_dwordx4 v2, s[8:11], s22 offen sc1 lds
    ds_read_b128 v[236:239], v4 offset:17408
    v_cvt_pk_bf16_f32 v223, v198, v199
    s_waitcnt lgkmcnt(3)
    v_mfma_f32_16x16x32_bf16 v[200:203], v[224:227], v[80:83], v[200:203]
    buffer_store_dwordx4 v[220:223], v2, s[8:11], s26 offen offset:0 sc1
    v_mfma_f32_16x16x32_bf16 v[204:207], v[224:227], v[84:87], v[204:207]
    ds_read_b128 v[240:243], v4 offset:18432
    s_waitcnt lgkmcnt(3)
    v_mfma_f32_16x16x32_bf16 v[208:211], v[228:231], v[80:83], v[208:211]
    v_mfma_f32_16x16x32_bf16 v[212:215], v[228:231], v[84:87], v[212:215]
    ds_read_b128 v[244:247], v4 offset:19456
    s_waitcnt lgkmcnt(3)
    v_mfma_f32_16x16x32_bf16 v[200:203], v[232:235], v[88:91], v[200:203]
    v_mfma_f32_16x16x32_bf16 v[204:207], v[232:235], v[92:95], v[204:207]
    ds_read_b128 v[224:227], v4 offset:20480
    s_waitcnt lgkmcnt(3)
    v_mfma_f32_16x16x32_bf16 v[208:211], v[236:239], v[88:91], v[208:211]
    v_mfma_f32_16x16x32_bf16 v[212:215], v[236:239], v[92:95], v[212:215]
    s_add_u32 s22, s21, 0x9c400
    s_add_u32 m0, s20, 0x24400
    s_nop 0
    buffer_load_dwordx4 v2, s[8:11], s22 offen sc1 lds
    ds_read_b128 v[228:231], v4 offset:21504
    s_waitcnt lgkmcnt(3)
    v_mfma_f32_16x16x32_bf16 v[200:203], v[240:243], v[96:99], v[200:203]
    v_mfma_f32_16x16x32_bf16 v[204:207], v[240:243], v[100:103], v[204:207]
    ds_read_b128 v[232:235], v4 offset:22528
    s_waitcnt lgkmcnt(3)
    v_mfma_f32_16x16x32_bf16 v[208:211], v[244:247], v[96:99], v[208:211]
    v_mfma_f32_16x16x32_bf16 v[212:215], v[244:247], v[100:103], v[212:215]
    ds_read_b128 v[236:239], v4 offset:23552
    s_waitcnt lgkmcnt(3)
    v_mfma_f32_16x16x32_bf16 v[200:203], v[224:227], v[104:107], v[200:203]
    v_mfma_f32_16x16x32_bf16 v[204:207], v[224:227], v[108:111], v[204:207]
    ds_read_b128 v[240:243], v4 offset:24576
    s_waitcnt lgkmcnt(3)
    v_mfma_f32_16x16x32_bf16 v[208:211], v[228:231], v[104:107], v[208:211]
    v_mfma_f32_16x16x32_bf16 v[212:215], v[228:231], v[108:111], v[212:215]
    ds_read_b128 v[244:247], v4 offset:25600
    s_waitcnt lgkmcnt(3)
    v_mfma_f32_16x16x32_bf16 v[200:203], v[232:235], v[112:115], v[200:203]
    v_mfma_f32_16x16x32_bf16 v[204:207], v[232:235], v[116:119], v[204:207]
    ds_read_b128 v[224:227], v4 offset:26624
    s_waitcnt lgkmcnt(3)
    v_mfma_f32_16x16x32_bf16 v[208:211], v[236:239], v[112:115], v[208:211]
    v_mfma_f32_16x16x32_bf16 v[212:215], v[236:239], v[116:119], v[212:215]
    ds_read_b128 v[228:231], v4 offset:27648
    s_waitcnt lgkmcnt(3)
    v_mfma_f32_16x16x32_bf16 v[200:203], v[240:243], v[120:123], v[200:203]
    v_mfma_f32_16x16x32_bf16 v[204:207], v[240:243], v[124:127], v[204:207]
    ds_read_b128 v[232:235], v4 offset:28672
    s_waitcnt lgkmcnt(3)
    v_mfma_f32_16x16x32_bf16 v[208:211], v[244:247], v[120:123], v[208:211]
    v_mfma_f32_16x16x32_bf16 v[212:215], v[244:247], v[124:127], v[212:215]
    ds_read_b128 v[236:239], v4 offset:29696
    s_waitcnt lgkmcnt(3)
    v_mfma_f32_16x16x32_bf16 v[200:203], v[224:227], v[128:131], v[200:203]
    v_mfma_f32_16x16x32_bf16 v[204:207], v[224:227], v[132:135], v[204:207]
    ds_read_b128 v[240:243], v4 offset:30720
    s_waitcnt lgkmcnt(3)
    v_mfma_f32_16x16x32_bf16 v[208:211], v[228:231], v[128:131], v[208:211]
    v_mfma_f32_16x16x32_bf16 v[212:215], v[228:231], v[132:135], v[212:215]
    ds_read_b128 v[244:247], v4 offset:31744
    s_waitcnt lgkmcnt(3)
    v_mfma_f32_16x16x32_bf16 v[200:203], v[232:235], v[136:139], v[200:203]
    v_mfma_f32_16x16x32_bf16 v[204:207], v[232:235], v[140:143], v[204:207]
    s_waitcnt vmcnt(8)
    s_barrier
    ds_read_b128 v[224:227], v4 offset:32768
    s_waitcnt lgkmcnt(3)
    v_mfma_f32_16x16x32_bf16 v[208:211], v[236:239], v[136:139], v[208:211]
    v_mfma_f32_16x16x32_bf16 v[212:215], v[236:239], v[140:143], v[212:215]
    s_add_u32 s22, s24, 0x0
    s_add_u32 m0, s20, 0x10000
    s_nop 0
    buffer_load_dwordx4 v3, s[4:7], s22 offen lds
    ds_read_b128 v[228:231], v4 offset:33792
    s_waitcnt lgkmcnt(3)
    v_mfma_f32_16x16x32_bf16 v[200:203], v[240:243], v[144:147], v[200:203]
    v_mfma_f32_16x16x32_bf16 v[204:207], v[240:243], v[148:151], v[204:207]
    ds_read_b128 v[232:235], v4 offset:34816
    s_waitcnt lgkmcnt(3)
    v_mfma_f32_16x16x32_bf16 v[208:211], v[244:247], v[144:147], v[208:211]
    v_mfma_f32_16x16x32_bf16 v[212:215], v[244:247], v[148:151], v[212:215]
    ds_read_b128 v[236:239], v4 offset:35840
    s_waitcnt lgkmcnt(3)
    v_mfma_f32_16x16x32_bf16 v[184:187], v[224:227], v[24:27], 0
    v_mfma_f32_16x16x32_bf16 v[188:191], v[224:227], v[28:31], 0
    ds_read_b128 v[240:243], v4 offset:36864
    s_waitcnt lgkmcnt(3)
    v_mfma_f32_16x16x32_bf16 v[192:195], v[228:231], v[24:27], 0
    v_mfma_f32_16x16x32_bf16 v[196:199], v[228:231], v[28:31], 0
    s_add_u32 s22, s24, 0x2000
    s_add_u32 m0, s20, 0x10400
    s_nop 0
    buffer_load_dwordx4 v3, s[4:7], s22 offen lds
    ds_read_b128 v[244:247], v4 offset:37888
    v_mul_f32 v200, v200, v9
    s_waitcnt lgkmcnt(3)
    v_mfma_f32_16x16x32_bf16 v[184:187], v[232:235], v[32:35], v[184:187]
    v_mul_f32 v201, v201, v9
    v_mfma_f32_16x16x32_bf16 v[188:191], v[232:235], v[36:39], v[188:191]
    ds_read_b128 v[224:227], v4 offset:38912
    v_mul_f32 v202, v202, v9
    s_waitcnt lgkmcnt(3)
    v_mfma_f32_16x16x32_bf16 v[192:195], v[236:239], v[32:35], v[192:195]
    v_mul_f32 v203, v203, v9
    v_mfma_f32_16x16x32_bf16 v[196:199], v[236:239], v[36:39], v[196:199]
    ds_read_b128 v[228:231], v4 offset:39936
    v_mul_f32 v208, v208, v9
    s_waitcnt lgkmcnt(3)
    v_mfma_f32_16x16x32_bf16 v[184:187], v[240:243], v[40:43], v[184:187]
    v_mul_f32 v209, v209, v9
    v_mfma_f32_16x16x32_bf16 v[188:191], v[240:243], v[44:47], v[188:191]
    ds_read_b128 v[232:235], v4 offset:40960
    v_mul_f32 v210, v210, v9
    s_waitcnt lgkmcnt(3)
    v_mfma_f32_16x16x32_bf16 v[192:195], v[244:247], v[40:43], v[192:195]
    v_mul_f32 v211, v211, v9
    v_mfma_f32_16x16x32_bf16 v[196:199], v[244:247], v[44:47], v[196:199]
    ds_read_b128 v[236:239], v4 offset:41984
    v_cvt_pk_bf16_f32 v216, v200, v201
    s_waitcnt lgkmcnt(3)
    v_mfma_f32_16x16x32_bf16 v[184:187], v[224:227], v[48:51], v[184:187]
    v_cvt_pk_bf16_f32 v217, v202, v203
    s_waitcnt vmcnt(3)
    s_add_u32 s16, s63, 0x570000
    v_mov_b32 v7, s28
    v_mov_b32 v8, 0
    s_mov_b64 exec, 1
    buffer_store_dword v7, v8, s[8:11], s16 offen sc1
    s_mov_b64 exec, -1
    v_mfma_f32_16x16x32_bf16 v[188:191], v[224:227], v[52:55], v[188:191]
    ds_read_b128 v[240:243], v4 offset:43008
    v_cvt_pk_bf16_f32 v218, v208, v209
    s_waitcnt lgkmcnt(3)
    v_mfma_f32_16x16x32_bf16 v[192:195], v[228:231], v[48:51], v[192:195]
    v_cvt_pk_bf16_f32 v219, v210, v211
    v_mfma_f32_16x16x32_bf16 v[196:199], v[228:231], v[52:55], v[196:199]
    ds_read_b128 v[244:247], v4 offset:44032
    buffer_store_dwordx4 v[216:219], v2, s[8:11], s25 offen offset:1024 sc1
    s_waitcnt lgkmcnt(3)
    v_mfma_f32_16x16x32_bf16 v[184:187], v[232:235], v[56:59], v[184:187]
    v_mul_f32 v204, v204, v10
    v_mfma_f32_16x16x32_bf16 v[188:191], v[232:235], v[60:63], v[188:191]
    ds_read_b128 v[224:227], v4 offset:45056
    v_mul_f32 v205, v205, v10
    s_waitcnt lgkmcnt(3)
    v_mfma_f32_16x16x32_bf16 v[192:195], v[236:239], v[56:59], v[192:195]
    v_mul_f32 v206, v206, v10
    v_mfma_f32_16x16x32_bf16 v[196:199], v[236:239], v[60:63], v[196:199]
    ds_read_b128 v[228:231], v4 offset:46080
    v_mul_f32 v207, v207, v10
    s_waitcnt lgkmcnt(3)
    v_mfma_f32_16x16x32_bf16 v[184:187], v[240:243], v[64:67], v[184:187]
    v_mul_f32 v212, v212, v10
    v_mfma_f32_16x16x32_bf16 v[188:191], v[240:243], v[68:71], v[188:191]
    ds_read_b128 v[232:235], v4 offset:47104
    v_mul_f32 v213, v213, v10
    s_waitcnt lgkmcnt(3)
    v_mfma_f32_16x16x32_bf16 v[192:195], v[244:247], v[64:67], v[192:195]
    v_mul_f32 v214, v214, v10
    v_mfma_f32_16x16x32_bf16 v[196:199], v[244:247], v[68:71], v[196:199]
    ds_read_b128 v[236:239], v4 offset:48128
    v_mul_f32 v215, v215, v10
    s_waitcnt lgkmcnt(3)
    v_mfma_f32_16x16x32_bf16 v[184:187], v[224:227], v[72:75], v[184:187]
    v_cvt_pk_bf16_f32 v220, v204, v205
    v_mfma_f32_16x16x32_bf16 v[188:191], v[224:227], v[76:79], v[188:191]
    s_barrier
    ds_read_b128 v[240:243], v4 offset:49152
    v_cvt_pk_bf16_f32 v221, v206, v207
    s_waitcnt lgkmcnt(3)
    v_mfma_f32_16x16x32_bf16 v[192:195], v[228:231], v[72:75], v[192:195]
    v_cvt_pk_bf16_f32 v222, v212, v213
    v_mfma_f32_16x16x32_bf16 v[196:199], v[228:231], v[76:79], v[196:199]
    s_add_u32 s22, s24, 0x80000
    s_add_u32 m0, s20, 0x14000
    s_nop 0
    buffer_load_dwordx4 v3, s[4:7], s22 offen lds
    ds_read_b128 v[244:247], v4 offset:50176
    v_cvt_pk_bf16_f32 v223, v214, v215
    s_waitcnt lgkmcnt(3)
    v_mfma_f32_16x16x32_bf16 v[184:187], v[232:235], v[80:83], v[184:187]
    buffer_store_dwordx4 v[220:223], v2, s[8:11], s26 offen offset:1024 sc1
    v_mfma_f32_16x16x32_bf16 v[188:191], v[232:235], v[84:87], v[188:191]
    ds_read_b128 v[224:227], v4 offset:51200
    s_waitcnt lgkmcnt(3)
    v_mfma_f32_16x16x32_bf16 v[192:195], v[236:239], v[80:83], v[192:195]
    v_mfma_f32_16x16x32_bf16 v[196:199], v[236:239], v[84:87], v[196:199]
    ds_read_b128 v[228:231], v4 offset:52224
    s_waitcnt lgkmcnt(3)
    v_mfma_f32_16x16x32_bf16 v[184:187], v[240:243], v[88:91], v[184:187]
    v_mfma_f32_16x16x32_bf16 v[188:191], v[240:243], v[92:95], v[188:191]
    ds_read_b128 v[232:235], v4 offset:53248
    s_waitcnt lgkmcnt(3)
    v_mfma_f32_16x16x32_bf16 v[192:195], v[244:247], v[88:91], v[192:195]
    v_mfma_f32_16x16x32_bf16 v[196:199], v[244:247], v[92:95], v[196:199]
    s_add_u32 s22, s24, 0x82000
    s_add_u32 m0, s20, 0x14400
    s_nop 0
    buffer_load_dwordx4 v3, s[4:7], s22 offen lds
    ds_read_b128 v[236:239], v4 offset:54272
    s_waitcnt lgkmcnt(3)
    v_mfma_f32_16x16x32_bf16 v[184:187], v[224:227], v[96:99], v[184:187]
    v_mfma_f32_16x16x32_bf16 v[188:191], v[224:227], v[100:103], v[188:191]
    ds_read_b128 v[240:243], v4 offset:55296
    s_waitcnt lgkmcnt(3)
    v_mfma_f32_16x16x32_bf16 v[192:195], v[228:231], v[96:99], v[192:195]
    v_mfma_f32_16x16x32_bf16 v[196:199], v[228:231], v[100:103], v[196:199]
    ds_read_b128 v[244:247], v4 offset:56320
    s_waitcnt lgkmcnt(3)
    v_mfma_f32_16x16x32_bf16 v[184:187], v[232:235], v[104:107], v[184:187]
    v_mfma_f32_16x16x32_bf16 v[188:191], v[232:235], v[108:111], v[188:191]
    ds_read_b128 v[224:227], v4 offset:57344
    s_waitcnt lgkmcnt(3)
    v_mfma_f32_16x16x32_bf16 v[192:195], v[236:239], v[104:107], v[192:195]
    v_mfma_f32_16x16x32_bf16 v[196:199], v[236:239], v[108:111], v[196:199]
    ds_read_b128 v[228:231], v4 offset:58368
    s_waitcnt lgkmcnt(3)
    v_mfma_f32_16x16x32_bf16 v[184:187], v[240:243], v[112:115], v[184:187]
    v_mfma_f32_16x16x32_bf16 v[188:191], v[240:243], v[116:119], v[188:191]
    ds_read_b128 v[232:235], v4 offset:59392
    s_waitcnt lgkmcnt(3)
    v_mfma_f32_16x16x32_bf16 v[192:195], v[244:247], v[112:115], v[192:195]
    v_mfma_f32_16x16x32_bf16 v[196:199], v[244:247], v[116:119], v[196:199]
    ds_read_b128 v[236:239], v4 offset:60416
    s_waitcnt lgkmcnt(3)
    v_mfma_f32_16x16x32_bf16 v[184:187], v[224:227], v[120:123], v[184:187]
    v_mfma_f32_16x16x32_bf16 v[188:191], v[224:227], v[124:127], v[188:191]
    ds_read_b128 v[240:243], v4 offset:61440
    s_waitcnt lgkmcnt(3)
    v_mfma_f32_16x16x32_bf16 v[192:195], v[228:231], v[120:123], v[192:195]
    v_mfma_f32_16x16x32_bf16 v[196:199], v[228:231], v[124:127], v[196:199]
    ds_read_b128 v[244:247], v4 offset:62464
    s_waitcnt lgkmcnt(3)
    v_mfma_f32_16x16x32_bf16 v[184:187], v[232:235], v[128:131], v[184:187]
    v_mfma_f32_16x16x32_bf16 v[188:191], v[232:235], v[132:135], v[188:191]
    ds_read_b128 v[224:227], v4 offset:63488
    s_waitcnt lgkmcnt(3)
    v_mfma_f32_16x16x32_bf16 v[192:195], v[236:239], v[128:131], v[192:195]
    v_mfma_f32_16x16x32_bf16 v[196:199], v[236:239], v[132:135], v[196:199]
    ds_read_b128 v[228:231], v4 offset:64512
    s_waitcnt lgkmcnt(3)
    v_mfma_f32_16x16x32_bf16 v[184:187], v[240:243], v[136:139], v[184:187]
    v_mfma_f32_16x16x32_bf16 v[188:191], v[240:243], v[140:143], v[188:191]
    s_barrier
    ds_read_b128 v[232:235], v5 offset:0
    s_waitcnt lgkmcnt(3)
    v_mfma_f32_16x16x32_bf16 v[192:195], v[244:247], v[136:139], v[192:195]
    v_mfma_f32_16x16x32_bf16 v[196:199], v[244:247], v[140:143], v[196:199]
    s_add_u32 s22, s24, 0x100000
    s_add_u32 m0, s20, 0x18000
    s_nop 0
    buffer_load_dwordx4 v3, s[4:7], s22 offen lds
    ds_read_b128 v[236:239], v5 offset:1024
    s_waitcnt lgkmcnt(3)
    v_mfma_f32_16x16x32_bf16 v[184:187], v[224:227], v[144:147], v[184:187]
    v_mfma_f32_16x16x32_bf16 v[188:191], v[224:227], v[148:151], v[188:191]
    ds_read_b128 v[240:243], v5 offset:2048
    s_waitcnt lgkmcnt(3)
    v_mfma_f32_16x16x32_bf16 v[192:195], v[228:231], v[144:147], v[192:195]
    v_mfma_f32_16x16x32_bf16 v[196:199], v[228:231], v[148:151], v[196:199]
    ds_read_b128 v[244:247], v5 offset:3072
    s_waitcnt lgkmcnt(3)
    v_mfma_f32_16x16x32_bf16 v[200:203], v[232:235], v[24:27], 0
    v_mfma_f32_16x16x32_bf16 v[204:207], v[232:235], v[28:31], 0
    ds_read_b128 v[224:227], v5 offset:4096
    s_waitcnt lgkmcnt(3)
    v_mfma_f32_16x16x32_bf16 v[208:211], v[236:239], v[24:27], 0
    v_mfma_f32_16x16x32_bf16 v[212:215], v[236:239], v[28:31], 0
    s_add_u32 s22, s24, 0x102000
    s_add_u32 m0, s20, 0x18400
    s_nop 0
    buffer_load_dwordx4 v3, s[4:7], s22 offen lds
    ds_read_b128 v[228:231], v5 offset:5120
    v_mul_f32 v184, v184, v9
    s_waitcnt lgkmcnt(3)
    v_mfma_f32_16x16x32_bf16 v[200:203], v[240:243], v[32:35], v[200:203]
    v_mul_f32 v185, v185, v9
    s_bfe_u32 s30, s2, 0x20001
    s_lshl_b32 s30, s30, 2
    s_bfe_u32 s17, s2, 0x20003
    s_add_u32 s30, s30, s17
    s_lshr_b32 s31, s2, 5
    s_and_b32 s17, s3, 3
    s_lshl_b32 s19, s30, 2
    s_add_u32 s19, s19, s17
    s_and_b32 s16, s2, 1
    s_lshl_b32 s17, s19, 18
    s_lshl_b32 s23, s16, 16
    s_add_u32 s17, s17, s23
    s_add_u32 s17, s17, 0x1001000
    v_add_u32 v6, s17, v2
    s_lshl_b32 s19, s19, 7
    s_lshl_b32 s23, s16, 6
    s_add_u32 s19, s19, s23
    s_add_u32 s19, s19, 0x570000
    v_and_b32 v13, 15, v1
    v_lshlrev_b32 v13, 2, v13
    buffer_load_dword v12, v13, s[8:11], s19 offen sc1
    v_mfma_f32_16x16x32_bf16 v[204:207], v[240:243], v[36:39], v[204:207]
    ds_read_b128 v[232:235], v5 offset:6144
    v_mul_f32 v186, v186, v9
    s_waitcnt lgkmcnt(3)
    v_mfma_f32_16x16x32_bf16 v[208:211], v[244:247], v[32:35], v[208:211]
    v_mul_f32 v187, v187, v9
    v_mfma_f32_16x16x32_bf16 v[212:215], v[244:247], v[36:39], v[212:215]
    ds_read_b128 v[236:239], v5 offset:7168
    v_mul_f32 v192, v192, v9
    s_waitcnt lgkmcnt(3)
    v_mfma_f32_16x16x32_bf16 v[200:203], v[224:227], v[40:43], v[200:203]
    v_mul_f32 v193, v193, v9
    v_mfma_f32_16x16x32_bf16 v[204:207], v[224:227], v[44:47], v[204:207]
    ds_read_b128 v[240:243], v5 offset:8192
    v_mul_f32 v194, v194, v9
    s_waitcnt lgkmcnt(3)
    v_mfma_f32_16x16x32_bf16 v[208:211], v[228:231], v[40:43], v[208:211]
    v_mul_f32 v195, v195, v9
    v_mfma_f32_16x16x32_bf16 v[212:215], v[228:231], v[44:47], v[212:215]
    ds_read_b128 v[244:247], v5 offset:9216
    v_cvt_pk_bf16_f32 v216, v184, v185
    s_waitcnt lgkmcnt(3)
    v_mfma_f32_16x16x32_bf16 v[200:203], v[232:235], v[48:51], v[200:203]
    v_cvt_pk_bf16_f32 v217, v186, v187
    v_mfma_f32_16x16x32_bf16 v[204:207], v[232:235], v[52:55], v[204:207]
    ds_read_b128 v[224:227], v5 offset:10240
    v_cvt_pk_bf16_f32 v218, v192, v193
    s_waitcnt lgkmcnt(3)
    v_mfma_f32_16x16x32_bf16 v[208:211], v[236:239], v[48:51], v[208:211]
    v_cvt_pk_bf16_f32 v219, v194, v195
    v_mfma_f32_16x16x32_bf16 v[212:215], v[236:239], v[52:55], v[212:215]
    ds_read_b128 v[228:231], v5 offset:11264
    buffer_store_dwordx4 v[216:219], v2, s[8:11], s25 offen offset:2048 sc1
    s_waitcnt lgkmcnt(3)
    v_mfma_f32_16x16x32_bf16 v[200:203], v[240:243], v[56:59], v[200:203]
    v_mul_f32 v188, v188, v10
    v_mfma_f32_16x16x32_bf16 v[204:207], v[240:243], v[60:63], v[204:207]
    ds_read_b128 v[232:235], v5 offset:12288
    v_mul_f32 v189, v189, v10
    s_waitcnt lgkmcnt(3)
    v_mfma_f32_16x16x32_bf16 v[208:211], v[244:247], v[56:59], v[208:211]
    v_mul_f32 v190, v190, v10
    v_mfma_f32_16x16x32_bf16 v[212:215], v[244:247], v[60:63], v[212:215]
    ds_read_b128 v[236:239], v5 offset:13312
    v_mul_f32 v191, v191, v10
    s_waitcnt lgkmcnt(3)
    v_mfma_f32_16x16x32_bf16 v[200:203], v[224:227], v[64:67], v[200:203]
    v_mul_f32 v196, v196, v10
    v_mfma_f32_16x16x32_bf16 v[204:207], v[224:227], v[68:71], v[204:207]
    ds_read_b128 v[240:243], v5 offset:14336
    v_mul_f32 v197, v197, v10
    s_waitcnt lgkmcnt(3)
    v_mfma_f32_16x16x32_bf16 v[208:211], v[228:231], v[64:67], v[208:211]
    v_mul_f32 v198, v198, v10
    v_mfma_f32_16x16x32_bf16 v[212:215], v[228:231], v[68:71], v[212:215]
    ds_read_b128 v[244:247], v5 offset:15360
    v_mul_f32 v199, v199, v10
    s_waitcnt lgkmcnt(3)
    v_mfma_f32_16x16x32_bf16 v[200:203], v[232:235], v[72:75], v[200:203]
    v_cvt_pk_bf16_f32 v220, v188, v189
    v_mfma_f32_16x16x32_bf16 v[204:207], v[232:235], v[76:79], v[204:207]
    s_waitcnt vmcnt(11)
    s_barrier
    ds_read_b128 v[224:227], v5 offset:16384
    v_cvt_pk_bf16_f32 v221, v190, v191
    s_waitcnt lgkmcnt(3)
    v_mfma_f32_16x16x32_bf16 v[208:211], v[236:239], v[72:75], v[208:211]
    v_cvt_pk_bf16_f32 v222, v196, v197
    v_mfma_f32_16x16x32_bf16 v[212:215], v[236:239], v[76:79], v[212:215]
    s_add_u32 s22, s24, 0x180000
    s_add_u32 m0, s20, 0x1c000
    s_nop 0
    buffer_load_dwordx4 v3, s[4:7], s22 offen lds
    ds_read_b128 v[228:231], v5 offset:17408
    v_cvt_pk_bf16_f32 v223, v198, v199
    s_waitcnt lgkmcnt(3)
    v_mfma_f32_16x16x32_bf16 v[200:203], v[240:243], v[80:83], v[200:203]
    buffer_store_dwordx4 v[220:223], v2, s[8:11], s26 offen offset:2048 sc1
    v_mfma_f32_16x16x32_bf16 v[204:207], v[240:243], v[84:87], v[204:207]
    ds_read_b128 v[232:235], v5 offset:18432
    s_waitcnt lgkmcnt(3)
    v_mfma_f32_16x16x32_bf16 v[208:211], v[244:247], v[80:83], v[208:211]
    v_mfma_f32_16x16x32_bf16 v[212:215], v[244:247], v[84:87], v[212:215]
    ds_read_b128 v[236:239], v5 offset:19456
    s_waitcnt lgkmcnt(3)
    v_mfma_f32_16x16x32_bf16 v[200:203], v[224:227], v[88:91], v[200:203]
    v_mfma_f32_16x16x32_bf16 v[204:207], v[224:227], v[92:95], v[204:207]
    ds_read_b128 v[240:243], v5 offset:20480
    s_waitcnt vmcnt(3)
    v_cmp_ne_u32 vcc, s28, v12
    s_cbranch_vccnz adaLN_cond__sliding_block_cached__moe_arch_mod__prompt_kernel_o17r
adaLN_cond__sliding_block_cached__moe_arch_mod__prompt_kernel_o17b:
    s_waitcnt lgkmcnt(3)
    v_mfma_f32_16x16x32_bf16 v[208:211], v[228:231], v[88:91], v[208:211]
    s_mov_b32 s23, 0x0
    buffer_load_dwordx4 v[24:27], v6, s[8:11], s23 offen offset:0 sc1
    v_mfma_f32_16x16x32_bf16 v[212:215], v[228:231], v[92:95], v[212:215]
    s_add_u32 s22, s24, 0x182000
    s_add_u32 m0, s20, 0x1c400
    s_nop 0
    buffer_load_dwordx4 v3, s[4:7], s22 offen lds
    ds_read_b128 v[244:247], v5 offset:21504
    s_waitcnt lgkmcnt(3)
    v_mfma_f32_16x16x32_bf16 v[200:203], v[232:235], v[96:99], v[200:203]
    v_mfma_f32_16x16x32_bf16 v[204:207], v[232:235], v[100:103], v[204:207]
    ds_read_b128 v[224:227], v5 offset:22528
    s_mov_b32 s23, 0x20000
    buffer_load_dwordx4 v[28:31], v6, s[8:11], s23 offen offset:0 sc1
    s_waitcnt lgkmcnt(3)
    v_mfma_f32_16x16x32_bf16 v[208:211], v[236:239], v[96:99], v[208:211]
    s_add_u32 s16, s63, 0x572000
    v_mov_b32 v14, s28
    v_mov_b32 v15, 0
    s_mov_b64 exec, 1
    buffer_store_dword v14, v15, s[8:11], s16 offen sc1
    s_mov_b64 exec, -1
    v_mfma_f32_16x16x32_bf16 v[212:215], v[236:239], v[100:103], v[212:215]
    ds_read_b128 v[228:231], v5 offset:23552
    s_waitcnt lgkmcnt(3)
    v_mfma_f32_16x16x32_bf16 v[200:203], v[240:243], v[104:107], v[200:203]
    v_mfma_f32_16x16x32_bf16 v[204:207], v[240:243], v[108:111], v[204:207]
    ds_read_b128 v[232:235], v5 offset:24576
    s_mov_b32 s23, 0x2000
    buffer_load_dwordx4 v[32:35], v6, s[8:11], s23 offen offset:0 sc1
    s_waitcnt lgkmcnt(3)
    v_mfma_f32_16x16x32_bf16 v[208:211], v[244:247], v[104:107], v[208:211]
    v_mfma_f32_16x16x32_bf16 v[212:215], v[244:247], v[108:111], v[212:215]
    ds_read_b128 v[236:239], v5 offset:25600
    s_waitcnt lgkmcnt(3)
    v_mfma_f32_16x16x32_bf16 v[200:203], v[224:227], v[112:115], v[200:203]
    s_mov_b32 s23, 0x22000
    buffer_load_dwordx4 v[36:39], v6, s[8:11], s23 offen offset:0 sc1
    v_mfma_f32_16x16x32_bf16 v[204:207], v[224:227], v[116:119], v[204:207]
    ds_read_b128 v[240:243], v5 offset:26624
    s_waitcnt lgkmcnt(3)
    v_mfma_f32_16x16x32_bf16 v[208:211], v[228:231], v[112:115], v[208:211]
    v_mfma_f32_16x16x32_bf16 v[212:215], v[228:231], v[116:119], v[212:215]
    ds_read_b128 v[244:247], v5 offset:27648
    s_waitcnt lgkmcnt(3)
    v_mfma_f32_16x16x32_bf16 v[200:203], v[232:235], v[120:123], v[200:203]
    s_mov_b32 s23, 0x4000
    buffer_load_dwordx4 v[40:43], v6, s[8:11], s23 offen offset:0 sc1
    v_mfma_f32_16x16x32_bf16 v[204:207], v[232:235], v[124:127], v[204:207]
    ds_read_b128 v[224:227], v5 offset:28672
    s_waitcnt lgkmcnt(3)
    v_mfma_f32_16x16x32_bf16 v[208:211], v[236:239], v[120:123], v[208:211]
    v_mfma_f32_16x16x32_bf16 v[212:215], v[236:239], v[124:127], v[212:215]
    ds_read_b128 v[228:231], v5 offset:29696
    s_waitcnt lgkmcnt(3)
    v_mfma_f32_16x16x32_bf16 v[200:203], v[240:243], v[128:131], v[200:203]
    s_mov_b32 s23, 0x24000
    buffer_load_dwordx4 v[44:47], v6, s[8:11], s23 offen offset:0 sc1
    v_mfma_f32_16x16x32_bf16 v[204:207], v[240:243], v[132:135], v[204:207]
    ds_read_b128 v[232:235], v5 offset:30720
    s_waitcnt lgkmcnt(3)
    v_mfma_f32_16x16x32_bf16 v[208:211], v[244:247], v[128:131], v[208:211]
    v_mfma_f32_16x16x32_bf16 v[212:215], v[244:247], v[132:135], v[212:215]
    ds_read_b128 v[236:239], v5 offset:31744
    s_mov_b32 s23, 0x6000
    buffer_load_dwordx4 v[48:51], v6, s[8:11], s23 offen offset:0 sc1
    s_waitcnt lgkmcnt(3)
    v_mfma_f32_16x16x32_bf16 v[200:203], v[224:227], v[136:139], v[200:203]
    v_bfe_u32 v18, v1, 2, 2
    v_lshrrev_b32 v19, 4, v1
    v_mfma_f32_16x16x32_bf16 v[204:207], v[224:227], v[140:143], v[204:207]
    v_and_b32 v17, 3, v1
    v_lshlrev_b32 v16, 11, v19
    s_waitcnt lgkmcnt(2)
    v_mfma_f32_16x16x32_bf16 v[208:211], v[228:231], v[136:139], v[208:211]
    v_lshl_add_u32 v16, v18, 6, v16
    v_lshl_add_u32 v16, v17, 3, v16
    v_mfma_f32_16x16x32_bf16 v[212:215], v[228:231], v[140:143], v[212:215]
    s_mov_b32 s23, 0x26000
    buffer_load_dwordx4 v[52:55], v6, s[8:11], s23 offen offset:0 sc1
    v_add_u32 v16, 0x12000, v16
    v_and_b32 v19, 1, v19
    s_waitcnt lgkmcnt(1)
    v_mfma_f32_16x16x32_bf16 v[200:203], v[232:235], v[144:147], v[200:203]
    v_lshlrev_b32 v19, 5, v19
    v_sub_u32 v5, v16, v19
    v_mfma_f32_16x16x32_bf16 v[204:207], v[232:235], v[148:151], v[204:207]
    v_add_u32 v4, v16, v19
    v_add_u32 v7, 0x10000, v4
    s_waitcnt lgkmcnt(0)
    v_mfma_f32_16x16x32_bf16 v[208:211], v[236:239], v[144:147], v[208:211]
    v_add_u32 v8, 0x10000, v5
    v_mfma_f32_16x16x32_bf16 v[212:215], v[236:239], v[148:151], v[212:215]
    v_mul_f32 v200, v200, v9
    v_mul_f32 v201, v201, v9
    v_mul_f32 v202, v202, v9
    v_mul_f32 v203, v203, v9
    s_nop 1
    v_mul_f32 v208, v208, v9
    v_mul_f32 v209, v209, v9
    v_mul_f32 v210, v210, v9
    v_mul_f32 v211, v211, v9
    v_cvt_pk_bf16_f32 v216, v200, v201
    v_cvt_pk_bf16_f32 v217, v202, v203
    v_cvt_pk_bf16_f32 v218, v208, v209
    v_cvt_pk_bf16_f32 v219, v210, v211
    buffer_store_dwordx4 v[216:219], v2, s[8:11], s25 offen offset:3072 sc1
    v_mul_f32 v204, v204, v10
    v_mul_f32 v205, v205, v10
    v_mul_f32 v206, v206, v10
    v_mul_f32 v207, v207, v10
    v_mul_f32 v212, v212, v10
    v_mul_f32 v213, v213, v10
    v_mul_f32 v214, v214, v10
    v_mul_f32 v215, v215, v10
    v_cvt_pk_bf16_f32 v220, v204, v205
    v_cvt_pk_bf16_f32 v221, v206, v207
    v_cvt_pk_bf16_f32 v222, v212, v213
    v_cvt_pk_bf16_f32 v223, v214, v215
    buffer_store_dwordx4 v[220:223], v2, s[8:11], s26 offen offset:3072 sc1
    s_and_b32 s15, s2, 1
    s_barrier
    ds_read_b64_tr_b16 v[224:225], v4 offset:0
    ds_read_b64_tr_b16 v[226:227], v4 offset:1024
    ds_read_b64_tr_b16 v[228:229], v5 offset:32
    ds_read_b64_tr_b16 v[230:231], v5 offset:1056
    ds_read_b64_tr_b16 v[232:233], v4 offset:256
    ds_read_b64_tr_b16 v[234:235], v4 offset:1280
    ds_read_b64_tr_b16 v[236:237], v5 offset:288
    ds_read_b64_tr_b16 v[238:239], v5 offset:1312
    s_waitcnt vmcnt(11) lgkmcnt(6)
    v_mfma_f32_16x16x32_bf16 v[88:91], v[224:227], v[24:27], 0
    ds_read_b64_tr_b16 v[240:241], v4 offset:512
    s_waitcnt vmcnt(9)
    v_mfma_f32_16x16x32_bf16 v[92:95], v[224:227], v[28:31], 0
    ds_read_b64_tr_b16 v[242:243], v4 offset:1536
    s_waitcnt lgkmcnt(6)
    v_mfma_f32_16x16x32_bf16 v[96:99], v[228:231], v[24:27], 0
    ds_read_b64_tr_b16 v[244:245], v5 offset:544
    v_mfma_f32_16x16x32_bf16 v[100:103], v[228:231], v[28:31], 0
    ds_read_b64_tr_b16 v[246:247], v5 offset:1568
    s_waitcnt lgkmcnt(6)
    v_mfma_f32_16x16x32_bf16 v[104:107], v[232:235], v[24:27], 0
    ds_read_b64_tr_b16 v[224:225], v4 offset:768
    v_mfma_f32_16x16x32_bf16 v[108:111], v[232:235], v[28:31], 0
    ds_read_b64_tr_b16 v[226:227], v4 offset:1792
    s_waitcnt lgkmcnt(6)
    v_mfma_f32_16x16x32_bf16 v[112:115], v[236:239], v[24:27], 0
    ds_read_b64_tr_b16 v[228:229], v5 offset:800
    v_mfma_f32_16x16x32_bf16 v[116:119], v[236:239], v[28:31], 0
    ds_read_b64_tr_b16 v[230:231], v5 offset:1824
    s_waitcnt lgkmcnt(6)
    v_mfma_f32_16x16x32_bf16 v[120:123], v[240:243], v[24:27], 0
    s_add_u32 s22, s24, 0x200000
    s_add_u32 m0, s20, 0x20000
    s_nop 0
    buffer_load_dwordx4 v3, s[4:7], s22 offen lds
    v_mfma_f32_16x16x32_bf16 v[124:127], v[240:243], v[28:31], 0
    s_barrier
    ds_read_b64_tr_b16 v[232:233], v4 offset:16384
    ds_read_b64_tr_b16 v[234:235], v4 offset:17408
    s_waitcnt lgkmcnt(6)
    v_mfma_f32_16x16x32_bf16 v[128:131], v[244:247], v[24:27], 0
    ds_read_b64_tr_b16 v[236:237], v5 offset:16416
    s_mov_b32 s23, 0x8000
    buffer_load_dwordx4 v[56:59], v6, s[8:11], s23 offen offset:0 sc1
    v_mfma_f32_16x16x32_bf16 v[132:135], v[244:247], v[28:31], 0
    s_add_u32 s22, s24, 0x202000
    s_add_u32 m0, s20, 0x20400
    s_nop 0
    buffer_load_dwordx4 v3, s[4:7], s22 offen lds
    ds_read_b64_tr_b16 v[238:239], v5 offset:17440
    s_waitcnt lgkmcnt(6)
    v_mfma_f32_16x16x32_bf16 v[136:139], v[224:227], v[24:27], 0
    ds_read_b64_tr_b16 v[240:241], v4 offset:16640
    v_mfma_f32_16x16x32_bf16 v[140:143], v[224:227], v[28:31], 0
    ds_read_b64_tr_b16 v[242:243], v4 offset:17664
    s_mov_b32 s23, 0x28000
    buffer_load_dwordx4 v[60:63], v6, s[8:11], s23 offen offset:0 sc1
    s_waitcnt lgkmcnt(6)
    v_mfma_f32_16x16x32_bf16 v[144:147], v[228:231], v[24:27], 0
    ds_read_b64_tr_b16 v[244:245], v5 offset:16672
    v_mfma_f32_16x16x32_bf16 v[148:151], v[228:231], v[28:31], 0
    ds_read_b64_tr_b16 v[246:247], v5 offset:17696
    s_waitcnt vmcnt(11) lgkmcnt(6)
    v_mfma_f32_16x16x32_bf16 v[88:91], v[232:235], v[32:35], v[88:91]
    ds_read_b64_tr_b16 v[224:225], v4 offset:16896
    s_waitcnt vmcnt(10)
    v_mfma_f32_16x16x32_bf16 v[92:95], v[232:235], v[36:39], v[92:95]
    s_add_u32 s22, s24, 0x280000
    s_add_u32 m0, s20, 0x24000
    s_nop 0
    buffer_load_dwordx4 v3, s[4:7], s22 offen lds
    ds_read_b64_tr_b16 v[226:227], v4 offset:17920
    s_waitcnt lgkmcnt(6)
    v_mfma_f32_16x16x32_bf16 v[96:99], v[236:239], v[32:35], v[96:99]
    ds_read_b64_tr_b16 v[228:229], v5 offset:16928
    v_mfma_f32_16x16x32_bf16 v[100:103], v[236:239], v[36:39], v[100:103]
    ds_read_b64_tr_b16 v[230:231], v5 offset:17952
    s_waitcnt lgkmcnt(6)
    v_mfma_f32_16x16x32_bf16 v[104:107], v[240:243], v[32:35], v[104:107]
    s_add_u32 s22, s24, 0x282000
    s_add_u32 m0, s20, 0x24400
    s_nop 0
    buffer_load_dwordx4 v3, s[4:7], s22 offen lds
    ds_read_b64_tr_b16 v[232:233], v4 offset:17152
    v_mfma_f32_16x16x32_bf16 v[108:111], v[240:243], v[36:39], v[108:111]
    ds_read_b64_tr_b16 v[234:235], v4 offset:18176
    s_waitcnt lgkmcnt(6)
    v_mfma_f32_16x16x32_bf16 v[112:115], v[244:247], v[32:35], v[112:115]
    ds_read_b64_tr_b16 v[236:237], v5 offset:17184
    v_mfma_f32_16x16x32_bf16 v[116:119], v[244:247], v[36:39], v[116:119]
    ds_read_b64_tr_b16 v[238:239], v5 offset:18208
    s_waitcnt lgkmcnt(6)
    v_mfma_f32_16x16x32_bf16 v[120:123], v[224:227], v[32:35], v[120:123]
    v_mfma_f32_16x16x32_bf16 v[124:127], v[224:227], v[36:39], v[124:127]
    s_barrier
    ds_read_b64_tr_b16 v[240:241], v4 offset:32768
    ds_read_b64_tr_b16 v[242:243], v4 offset:33792
    s_waitcnt lgkmcnt(6)
    v_mfma_f32_16x16x32_bf16 v[128:131], v[228:231], v[32:35], v[128:131]
    ds_read_b64_tr_b16 v[244:245], v5 offset:32800
    s_mov_b32 s23, 0xa000
    buffer_load_dwordx4 v[24:27], v6, s[8:11], s23 offen offset:0 sc1
    v_mfma_f32_16x16x32_bf16 v[132:135], v[228:231], v[36:39], v[132:135]
    ds_read_b64_tr_b16 v[246:247], v5 offset:33824
    s_waitcnt lgkmcnt(6)
    v_mfma_f32_16x16x32_bf16 v[136:139], v[232:235], v[32:35], v[136:139]
    ds_read_b64_tr_b16 v[224:225], v4 offset:33024
    v_mfma_f32_16x16x32_bf16 v[140:143], v[232:235], v[36:39], v[140:143]
    ds_read_b64_tr_b16 v[226:227], v4 offset:34048
    s_mov_b32 s23, 0x2a000
    buffer_load_dwordx4 v[28:31], v6, s[8:11], s23 offen offset:0 sc1
    s_waitcnt lgkmcnt(6)
    v_mfma_f32_16x16x32_bf16 v[144:147], v[236:239], v[32:35], v[144:147]
    s_add_u32 s16, s63, 0x574000
    v_mov_b32 v14, s28
    v_mov_b32 v15, 0
    s_mov_b64 exec, 1
    buffer_store_dword v14, v15, s[8:11], s16 offen sc1
    s_mov_b64 exec, -1
    ds_read_b64_tr_b16 v[228:229], v5 offset:33056
    v_mfma_f32_16x16x32_bf16 v[148:151], v[236:239], v[36:39], v[148:151]
    ds_read_b64_tr_b16 v[230:231], v5 offset:34080
    s_waitcnt vmcnt(14) lgkmcnt(6)
    v_mfma_f32_16x16x32_bf16 v[88:91], v[240:243], v[40:43], v[88:91]
    ds_read_b64_tr_b16 v[232:233], v4 offset:33280
    s_waitcnt vmcnt(13)
    v_mfma_f32_16x16x32_bf16 v[92:95], v[240:243], v[44:47], v[92:95]
    s_add_u32 s22, s24, 0x300000
    s_add_u32 m0, s20, 0x10000
    s_nop 0
    buffer_load_dwordx4 v3, s[4:7], s22 offen lds
    ds_read_b64_tr_b16 v[234:235], v4 offset:34304
    s_waitcnt lgkmcnt(6)
    v_mfma_f32_16x16x32_bf16 v[96:99], v[244:247], v[40:43], v[96:99]
    ds_read_b64_tr_b16 v[236:237], v5 offset:33312
    v_mfma_f32_16x16x32_bf16 v[100:103], v[244:247], v[44:47], v[100:103]
    ds_read_b64_tr_b16 v[238:239], v5 offset:34336
    s_waitcnt lgkmcnt(6)
    v_mfma_f32_16x16x32_bf16 v[104:107], v[224:227], v[40:43], v[104:107]
    s_add_u32 s22, s24, 0x302000
    s_add_u32 m0, s20, 0x10400
    s_nop 0
    buffer_load_dwordx4 v3, s[4:7], s22 offen lds
    ds_read_b64_tr_b16 v[240:241], v4 offset:33536
    v_mfma_f32_16x16x32_bf16 v[108:111], v[224:227], v[44:47], v[108:111]
    ds_read_b64_tr_b16 v[242:243], v4 offset:34560
    s_waitcnt lgkmcnt(6)
    v_mfma_f32_16x16x32_bf16 v[112:115], v[228:231], v[40:43], v[112:115]
    ds_read_b64_tr_b16 v[244:245], v5 offset:33568
    v_mfma_f32_16x16x32_bf16 v[116:119], v[228:231], v[44:47], v[116:119]
    ds_read_b64_tr_b16 v[246:247], v5 offset:34592
    s_waitcnt lgkmcnt(6)
    v_mfma_f32_16x16x32_bf16 v[120:123], v[232:235], v[40:43], v[120:123]
    v_mfma_f32_16x16x32_bf16 v[124:127], v[232:235], v[44:47], v[124:127]
    s_barrier
    ds_read_b64_tr_b16 v[224:225], v4 offset:49152
    ds_read_b64_tr_b16 v[226:227], v4 offset:50176
    s_add_u32 s19, s19, 8192
    buffer_load_dword v12, v13, s[8:11], s19 offen sc1
    s_waitcnt lgkmcnt(6)
    v_mfma_f32_16x16x32_bf16 v[128:131], v[236:239], v[40:43], v[128:131]
    ds_read_b64_tr_b16 v[228:229], v5 offset:49184
    s_mov_b32 s23, 0xc000
    buffer_load_dwordx4 v[32:35], v6, s[8:11], s23 offen offset:0 sc1
    v_mfma_f32_16x16x32_bf16 v[132:135], v[236:239], v[44:47], v[132:135]
    ds_read_b64_tr_b16 v[230:231], v5 offset:50208
    s_waitcnt lgkmcnt(6)
    v_mfma_f32_16x16x32_bf16 v[136:139], v[240:243], v[40:43], v[136:139]
    ds_read_b64_tr_b16 v[232:233], v4 offset:49408
    v_mfma_f32_16x16x32_bf16 v[140:143], v[240:243], v[44:47], v[140:143]
    ds_read_b64_tr_b16 v[234:235], v4 offset:50432
    s_mov_b32 s23, 0x2c000
    buffer_load_dwordx4 v[36:39], v6, s[8:11], s23 offen offset:0 sc1
    s_waitcnt lgkmcnt(6)
    v_mfma_f32_16x16x32_bf16 v[144:147], v[244:247], v[40:43], v[144:147]
    ds_read_b64_tr_b16 v[236:237], v5 offset:49440
    v_mfma_f32_16x16x32_bf16 v[148:151], v[244:247], v[44:47], v[148:151]
    ds_read_b64_tr_b16 v[238:239], v5 offset:50464
    s_waitcnt vmcnt(17) lgkmcnt(6)
    v_mfma_f32_16x16x32_bf16 v[88:91], v[224:227], v[48:51], v[88:91]
    ds_read_b64_tr_b16 v[240:241], v4 offset:49664
    s_waitcnt vmcnt(16)
    v_mfma_f32_16x16x32_bf16 v[92:95], v[224:227], v[52:55], v[92:95]
    s_add_u32 s22, s24, 0x380000
    s_add_u32 m0, s20, 0x14000
    s_nop 0
    buffer_load_dwordx4 v3, s[4:7], s22 offen lds
    ds_read_b64_tr_b16 v[242:243], v4 offset:50688
    s_waitcnt lgkmcnt(6)
    v_mfma_f32_16x16x32_bf16 v[96:99], v[228:231], v[48:51], v[96:99]
    ds_read_b64_tr_b16 v[244:245], v5 offset:49696
    v_mfma_f32_16x16x32_bf16 v[100:103], v[228:231], v[52:55], v[100:103]
    ds_read_b64_tr_b16 v[246:247], v5 offset:50720
    s_waitcnt lgkmcnt(6)
    v_mfma_f32_16x16x32_bf16 v[104:107], v[232:235], v[48:51], v[104:107]
    s_add_u32 s22, s24, 0x382000
    s_add_u32 m0, s20, 0x14400
    s_nop 0
    buffer_load_dwordx4 v3, s[4:7], s22 offen lds
    ds_read_b64_tr_b16 v[224:225], v4 offset:49920
    v_mfma_f32_16x16x32_bf16 v[108:111], v[232:235], v[52:55], v[108:111]
    ds_read_b64_tr_b16 v[226:227], v4 offset:50944
    s_waitcnt lgkmcnt(6)
    v_mfma_f32_16x16x32_bf16 v[112:115], v[236:239], v[48:51], v[112:115]
    ds_read_b64_tr_b16 v[228:229], v5 offset:49952
    v_mfma_f32_16x16x32_bf16 v[116:119], v[236:239], v[52:55], v[116:119]
    ds_read_b64_tr_b16 v[230:231], v5 offset:50976
    s_waitcnt lgkmcnt(6)
    v_mfma_f32_16x16x32_bf16 v[120:123], v[240:243], v[48:51], v[120:123]
    v_mfma_f32_16x16x32_bf16 v[124:127], v[240:243], v[52:55], v[124:127]
    s_waitcnt vmcnt(13)
    s_barrier
    ds_read_b64_tr_b16 v[232:233], v7 offset:0
    ds_read_b64_tr_b16 v[234:235], v7 offset:1024
    s_waitcnt lgkmcnt(6)
    v_mfma_f32_16x16x32_bf16 v[128:131], v[244:247], v[48:51], v[128:131]
    ds_read_b64_tr_b16 v[236:237], v8 offset:32
    s_mov_b32 s23, 0xe000
    buffer_load_dwordx4 v[40:43], v6, s[8:11], s23 offen offset:0 sc1
    v_mfma_f32_16x16x32_bf16 v[132:135], v[244:247], v[52:55], v[132:135]
    ds_read_b64_tr_b16 v[238:239], v8 offset:1056
    s_waitcnt lgkmcnt(6)
    v_mfma_f32_16x16x32_bf16 v[136:139], v[224:227], v[48:51], v[136:139]
    ds_read_b64_tr_b16 v[240:241], v7 offset:256
    v_mfma_f32_16x16x32_bf16 v[140:143], v[224:227], v[52:55], v[140:143]
    ds_read_b64_tr_b16 v[242:243], v7 offset:1280
    s_mov_b32 s23, 0x2e000
    buffer_load_dwordx4 v[44:47], v6, s[8:11], s23 offen offset:0 sc1
    s_waitcnt lgkmcnt(6)
    v_mfma_f32_16x16x32_bf16 v[144:147], v[228:231], v[48:51], v[144:147]
    ds_read_b64_tr_b16 v[244:245], v8 offset:288
    v_mfma_f32_16x16x32_bf16 v[148:151], v[228:231], v[52:55], v[148:151]
    ds_read_b64_tr_b16 v[246:247], v8 offset:1312
    s_waitcnt vmcnt(6)
    v_cmp_ne_u32 vcc, s28, v12
    s_cbranch_vccnz adaLN_cond__sliding_block_cached__moe_arch_mod__prompt_kernel_o218r
adaLN_cond__sliding_block_cached__moe_arch_mod__prompt_kernel_o218b:
    s_waitcnt lgkmcnt(6)
    v_mfma_f32_16x16x32_bf16 v[88:91], v[232:235], v[56:59], v[88:91]
    ds_read_b64_tr_b16 v[224:225], v7 offset:512
    v_mfma_f32_16x16x32_bf16 v[92:95], v[232:235], v[60:63], v[92:95]
    s_add_u32 s22, s24, 0x10000
    s_add_u32 m0, s20, 0x18000
    s_nop 0
    buffer_load_dwordx4 v3, s[4:7], s22 offen lds
    ds_read_b64_tr_b16 v[226:227], v7 offset:1536
    s_waitcnt lgkmcnt(6)
    v_mfma_f32_16x16x32_bf16 v[96:99], v[236:239], v[56:59], v[96:99]
    ds_read_b64_tr_b16 v[228:229], v8 offset:544
    v_mfma_f32_16x16x32_bf16 v[100:103], v[236:239], v[60:63], v[100:103]
    ds_read_b64_tr_b16 v[230:231], v8 offset:1568
    s_waitcnt lgkmcnt(6)
    v_mfma_f32_16x16x32_bf16 v[104:107], v[240:243], v[56:59], v[104:107]
    s_add_u32 s22, s24, 0x12000
    s_add_u32 m0, s20, 0x18400
    s_nop 0
    buffer_load_dwordx4 v3, s[4:7], s22 offen lds
    ds_read_b64_tr_b16 v[232:233], v7 offset:768
    v_mfma_f32_16x16x32_bf16 v[108:111], v[240:243], v[60:63], v[108:111]
    ds_read_b64_tr_b16 v[234:235], v7 offset:1792
    s_waitcnt lgkmcnt(6)
    v_mfma_f32_16x16x32_bf16 v[112:115], v[244:247], v[56:59], v[112:115]
    ds_read_b64_tr_b16 v[236:237], v8 offset:800
    v_mfma_f32_16x16x32_bf16 v[116:119], v[244:247], v[60:63], v[116:119]
    ds_read_b64_tr_b16 v[238:239], v8 offset:1824
    s_waitcnt lgkmcnt(6)
    v_mfma_f32_16x16x32_bf16 v[120:123], v[224:227], v[56:59], v[120:123]
    v_mfma_f32_16x16x32_bf16 v[124:127], v[224:227], v[60:63], v[124:127]
    s_barrier
    ds_read_b64_tr_b16 v[240:241], v7 offset:16384
    ds_read_b64_tr_b16 v[242:243], v7 offset:17408
    s_waitcnt lgkmcnt(6)
    v_mfma_f32_16x16x32_bf16 v[128:131], v[228:231], v[56:59], v[128:131]
    ds_read_b64_tr_b16 v[244:245], v8 offset:16416
    s_mov_b32 s23, 0x0
    buffer_load_dwordx4 v[48:51], v6, s[8:11], s23 offen offset:1024 sc1
    v_mfma_f32_16x16x32_bf16 v[132:135], v[228:231], v[60:63], v[132:135]
    ds_read_b64_tr_b16 v[246:247], v8 offset:17440
    s_waitcnt lgkmcnt(6)
    v_mfma_f32_16x16x32_bf16 v[136:139], v[232:235], v[56:59], v[136:139]
    ds_read_b64_tr_b16 v[224:225], v7 offset:16640
    v_mfma_f32_16x16x32_bf16 v[140:143], v[232:235], v[60:63], v[140:143]
    ds_read_b64_tr_b16 v[226:227], v7 offset:17664
    s_mov_b32 s23, 0x20000
    buffer_load_dwordx4 v[52:55], v6, s[8:11], s23 offen offset:1024 sc1
    s_waitcnt lgkmcnt(6)
    v_mfma_f32_16x16x32_bf16 v[144:147], v[236:239], v[56:59], v[144:147]
    ds_read_b64_tr_b16 v[228:229], v8 offset:16672
    v_mfma_f32_16x16x32_bf16 v[148:151], v[236:239], v[60:63], v[148:151]
    ds_read_b64_tr_b16 v[230:231], v8 offset:17696
    s_waitcnt lgkmcnt(6)
    v_mfma_f32_16x16x32_bf16 v[88:91], v[240:243], v[24:27], v[88:91]
    ds_read_b64_tr_b16 v[232:233], v7 offset:16896
    v_mfma_f32_16x16x32_bf16 v[92:95], v[240:243], v[28:31], v[92:95]
    s_add_u32 s22, s24, 0x90000
    s_add_u32 m0, s20, 0x1c000
    s_nop 0
    buffer_load_dwordx4 v3, s[4:7], s22 offen lds
    ds_read_b64_tr_b16 v[234:235], v7 offset:17920
    s_waitcnt lgkmcnt(6)
    v_mfma_f32_16x16x32_bf16 v[96:99], v[244:247], v[24:27], v[96:99]
    ds_read_b64_tr_b16 v[236:237], v8 offset:16928
    v_mfma_f32_16x16x32_bf16 v[100:103], v[244:247], v[28:31], v[100:103]
    ds_read_b64_tr_b16 v[238:239], v8 offset:17952
    s_waitcnt lgkmcnt(6)
    v_mfma_f32_16x16x32_bf16 v[104:107], v[224:227], v[24:27], v[104:107]
    s_add_u32 s22, s24, 0x92000
    s_add_u32 m0, s20, 0x1c400
    s_nop 0
    buffer_load_dwordx4 v3, s[4:7], s22 offen lds
    ds_read_b64_tr_b16 v[240:241], v7 offset:17152
    v_mfma_f32_16x16x32_bf16 v[108:111], v[224:227], v[28:31], v[108:111]
    ds_read_b64_tr_b16 v[242:243], v7 offset:18176
    s_waitcnt lgkmcnt(6)
    v_mfma_f32_16x16x32_bf16 v[112:115], v[228:231], v[24:27], v[112:115]
    ds_read_b64_tr_b16 v[244:245], v8 offset:17184
    v_mfma_f32_16x16x32_bf16 v[116:119], v[228:231], v[28:31], v[116:119]
    ds_read_b64_tr_b16 v[246:247], v8 offset:18208
    s_waitcnt lgkmcnt(6)
    v_mfma_f32_16x16x32_bf16 v[120:123], v[232:235], v[24:27], v[120:123]
    v_mfma_f32_16x16x32_bf16 v[124:127], v[232:235], v[28:31], v[124:127]
    s_barrier
    ds_read_b64_tr_b16 v[224:225], v4 offset:0
    ds_read_b64_tr_b16 v[226:227], v4 offset:1024
    s_waitcnt lgkmcnt(6)
    v_mfma_f32_16x16x32_bf16 v[128:131], v[236:239], v[24:27], v[128:131]
    s_add_u32 s16, s63, 0x576000
    v_mov_b32 v14, s28
    v_mov_b32 v15, 0
    s_mov_b64 exec, 1
    buffer_store_dword v14, v15, s[8:11], s16 offen sc1
    s_mov_b64 exec, -1
    ds_read_b64_tr_b16 v[228:229], v5 offset:32
    s_mov_b32 s23, 0x2000
    buffer_load_dwordx4 v[56:59], v6, s[8:11], s23 offen offset:1024 sc1
    v_mfma_f32_16x16x32_bf16 v[132:135], v[236:239], v[28:31], v[132:135]
    ds_read_b64_tr_b16 v[230:231], v5 offset:1056
    s_waitcnt lgkmcnt(6)
    v_mfma_f32_16x16x32_bf16 v[136:139], v[240:243], v[24:27], v[136:139]
    ds_read_b64_tr_b16 v[232:233], v4 offset:256
    v_mfma_f32_16x16x32_bf16 v[140:143], v[240:243], v[28:31], v[140:143]
    ds_read_b64_tr_b16 v[234:235], v4 offset:1280
    s_mov_b32 s23, 0x22000
    buffer_load_dwordx4 v[60:63], v6, s[8:11], s23 offen offset:1024 sc1
    s_waitcnt lgkmcnt(6)
    v_mfma_f32_16x16x32_bf16 v[144:147], v[244:247], v[24:27], v[144:147]
    ds_read_b64_tr_b16 v[236:237], v5 offset:288
    v_mfma_f32_16x16x32_bf16 v[148:151], v[244:247], v[28:31], v[148:151]
    ds_read_b64_tr_b16 v[238:239], v5 offset:1312
    s_waitcnt vmcnt(14) lgkmcnt(6)
    v_mfma_f32_16x16x32_bf16 v[88:91], v[224:227], v[32:35], v[88:91]
    ds_read_b64_tr_b16 v[240:241], v4 offset:512
    s_waitcnt vmcnt(13)
    v_mfma_f32_16x16x32_bf16 v[92:95], v[224:227], v[36:39], v[92:95]
    s_add_u32 s22, s24, 0x110000
    s_add_u32 m0, s20, 0x20000
    s_nop 0
    buffer_load_dwordx4 v3, s[4:7], s22 offen lds
    ds_read_b64_tr_b16 v[242:243], v4 offset:1536
    s_waitcnt lgkmcnt(6)
    v_mfma_f32_16x16x32_bf16 v[96:99], v[228:231], v[32:35], v[96:99]
    ds_read_b64_tr_b16 v[244:245], v5 offset:544
    v_mfma_f32_16x16x32_bf16 v[100:103], v[228:231], v[36:39], v[100:103]
    ds_read_b64_tr_b16 v[246:247], v5 offset:1568
    s_waitcnt lgkmcnt(6)
    v_mfma_f32_16x16x32_bf16 v[104:107], v[232:235], v[32:35], v[104:107]
    s_add_u32 s22, s24, 0x112000
    s_add_u32 m0, s20, 0x20400
    s_nop 0
    buffer_load_dwordx4 v3, s[4:7], s22 offen lds
    ds_read_b64_tr_b16 v[224:225], v4 offset:768
    v_mfma_f32_16x16x32_bf16 v[108:111], v[232:235], v[36:39], v[108:111]
    ds_read_b64_tr_b16 v[226:227], v4 offset:1792
    s_waitcnt lgkmcnt(6)
    v_mfma_f32_16x16x32_bf16 v[112:115], v[236:239], v[32:35], v[112:115]
    ds_read_b64_tr_b16 v[228:229], v5 offset:800
    v_mfma_f32_16x16x32_bf16 v[116:119], v[236:239], v[36:39], v[116:119]
    ds_read_b64_tr_b16 v[230:231], v5 offset:1824
    s_waitcnt lgkmcnt(6)
    v_mfma_f32_16x16x32_bf16 v[120:123], v[240:243], v[32:35], v[120:123]
    v_mfma_f32_16x16x32_bf16 v[124:127], v[240:243], v[36:39], v[124:127]
    s_waitcnt vmcnt(13)
    s_barrier
    ds_read_b64_tr_b16 v[232:233], v4 offset:16384
    ds_read_b64_tr_b16 v[234:235], v4 offset:17408
    s_waitcnt lgkmcnt(6)
    v_mfma_f32_16x16x32_bf16 v[128:131], v[244:247], v[32:35], v[128:131]
    ds_read_b64_tr_b16 v[236:237], v5 offset:16416
    s_mov_b32 s23, 0x4000
    buffer_load_dwordx4 v[24:27], v6, s[8:11], s23 offen offset:1024 sc1
    v_mfma_f32_16x16x32_bf16 v[132:135], v[244:247], v[36:39], v[132:135]
    ds_read_b64_tr_b16 v[238:239], v5 offset:17440
    s_waitcnt lgkmcnt(6)
    v_mfma_f32_16x16x32_bf16 v[136:139], v[224:227], v[32:35], v[136:139]
    ds_read_b64_tr_b16 v[240:241], v4 offset:16640
    v_mfma_f32_16x16x32_bf16 v[140:143], v[224:227], v[36:39], v[140:143]
    ds_read_b64_tr_b16 v[242:243], v4 offset:17664
    s_mov_b32 s23, 0x24000
    buffer_load_dwordx4 v[28:31], v6, s[8:11], s23 offen offset:1024 sc1
    s_waitcnt lgkmcnt(6)
    v_mfma_f32_16x16x32_bf16 v[144:147], v[228:231], v[32:35], v[144:147]
    ds_read_b64_tr_b16 v[244:245], v5 offset:16672
    v_mfma_f32_16x16x32_bf16 v[148:151], v[228:231], v[36:39], v[148:151]
    ds_read_b64_tr_b16 v[246:247], v5 offset:17696
    s_waitcnt vmcnt(14) lgkmcnt(6)
    v_mfma_f32_16x16x32_bf16 v[88:91], v[232:235], v[40:43], v[88:91]
    ds_read_b64_tr_b16 v[224:225], v4 offset:16896
    s_waitcnt vmcnt(13)
    v_mfma_f32_16x16x32_bf16 v[92:95], v[232:235], v[44:47], v[92:95]
    s_add_u32 s22, s24, 0x190000
    s_add_u32 m0, s20, 0x24000
    s_nop 0
    buffer_load_dwordx4 v3, s[4:7], s22 offen lds
    ds_read_b64_tr_b16 v[226:227], v4 offset:17920
    s_waitcnt lgkmcnt(6)
    v_mfma_f32_16x16x32_bf16 v[96:99], v[236:239], v[40:43], v[96:99]
    ds_read_b64_tr_b16 v[228:229], v5 offset:16928
    v_mfma_f32_16x16x32_bf16 v[100:103], v[236:239], v[44:47], v[100:103]
    ds_read_b64_tr_b16 v[230:231], v5 offset:17952
    s_waitcnt lgkmcnt(6)
    v_mfma_f32_16x16x32_bf16 v[104:107], v[240:243], v[40:43], v[104:107]
    s_add_u32 s22, s24, 0x192000
    s_add_u32 m0, s20, 0x24400
    s_nop 0
    buffer_load_dwordx4 v3, s[4:7], s22 offen lds
    ds_read_b64_tr_b16 v[232:233], v4 offset:17152
    v_mfma_f32_16x16x32_bf16 v[108:111], v[240:243], v[44:47], v[108:111]
    ds_read_b64_tr_b16 v[234:235], v4 offset:18176
    s_waitcnt lgkmcnt(6)
    v_mfma_f32_16x16x32_bf16 v[112:115], v[244:247], v[40:43], v[112:115]
    ds_read_b64_tr_b16 v[236:237], v5 offset:17184
    v_mfma_f32_16x16x32_bf16 v[116:119], v[244:247], v[44:47], v[116:119]
    ds_read_b64_tr_b16 v[238:239], v5 offset:18208
    s_waitcnt lgkmcnt(6)
    v_mfma_f32_16x16x32_bf16 v[120:123], v[224:227], v[40:43], v[120:123]
    v_mfma_f32_16x16x32_bf16 v[124:127], v[224:227], v[44:47], v[124:127]
    s_waitcnt vmcnt(13)
    s_barrier
    ds_read_b64_tr_b16 v[240:241], v4 offset:32768
    ds_read_b64_tr_b16 v[242:243], v4 offset:33792
    s_waitcnt lgkmcnt(6)
    v_mfma_f32_16x16x32_bf16 v[128:131], v[228:231], v[40:43], v[128:131]
    ds_read_b64_tr_b16 v[244:245], v5 offset:32800
    s_mov_b32 s23, 0x6000
    buffer_load_dwordx4 v[32:35], v6, s[8:11], s23 offen offset:1024 sc1
    v_mfma_f32_16x16x32_bf16 v[132:135], v[228:231], v[44:47], v[132:135]
    ds_read_b64_tr_b16 v[246:247], v5 offset:33824
    s_waitcnt lgkmcnt(6)
    v_mfma_f32_16x16x32_bf16 v[136:139], v[232:235], v[40:43], v[136:139]
    ds_read_b64_tr_b16 v[224:225], v4 offset:33024
    v_mfma_f32_16x16x32_bf16 v[140:143], v[232:235], v[44:47], v[140:143]
    ds_read_b64_tr_b16 v[226:227], v4 offset:34048
    s_mov_b32 s23, 0x26000
    buffer_load_dwordx4 v[36:39], v6, s[8:11], s23 offen offset:1024 sc1
    s_waitcnt lgkmcnt(6)
    v_mfma_f32_16x16x32_bf16 v[144:147], v[236:239], v[40:43], v[144:147]
    ds_read_b64_tr_b16 v[228:229], v5 offset:33056
    v_mfma_f32_16x16x32_bf16 v[148:151], v[236:239], v[44:47], v[148:151]
    ds_read_b64_tr_b16 v[230:231], v5 offset:34080
    s_waitcnt vmcnt(14) lgkmcnt(6)
    v_mfma_f32_16x16x32_bf16 v[88:91], v[240:243], v[48:51], v[88:91]
    ds_read_b64_tr_b16 v[232:233], v4 offset:33280
    s_waitcnt vmcnt(13)
    v_mfma_f32_16x16x32_bf16 v[92:95], v[240:243], v[52:55], v[92:95]
    s_add_u32 s22, s24, 0x210000
    s_add_u32 m0, s20, 0x10000
    s_nop 0
    buffer_load_dwordx4 v3, s[4:7], s22 offen lds
    ds_read_b64_tr_b16 v[234:235], v4 offset:34304
    s_waitcnt lgkmcnt(6)
    v_mfma_f32_16x16x32_bf16 v[96:99], v[244:247], v[48:51], v[96:99]
    ds_read_b64_tr_b16 v[236:237], v5 offset:33312
    v_mfma_f32_16x16x32_bf16 v[100:103], v[244:247], v[52:55], v[100:103]
    ds_read_b64_tr_b16 v[238:239], v5 offset:34336
    s_waitcnt lgkmcnt(6)
    v_mfma_f32_16x16x32_bf16 v[104:107], v[224:227], v[48:51], v[104:107]
    s_add_u32 s22, s24, 0x212000
    s_add_u32 m0, s20, 0x10400
    s_nop 0
    buffer_load_dwordx4 v3, s[4:7], s22 offen lds
    ds_read_b64_tr_b16 v[240:241], v4 offset:33536
    v_mfma_f32_16x16x32_bf16 v[108:111], v[224:227], v[52:55], v[108:111]
    ds_read_b64_tr_b16 v[242:243], v4 offset:34560
    s_waitcnt lgkmcnt(6)
    v_mfma_f32_16x16x32_bf16 v[112:115], v[228:231], v[48:51], v[112:115]
    ds_read_b64_tr_b16 v[244:245], v5 offset:33568
    v_mfma_f32_16x16x32_bf16 v[116:119], v[228:231], v[52:55], v[116:119]
    ds_read_b64_tr_b16 v[246:247], v5 offset:34592
    s_waitcnt lgkmcnt(6)
    v_mfma_f32_16x16x32_bf16 v[120:123], v[232:235], v[48:51], v[120:123]
    v_mfma_f32_16x16x32_bf16 v[124:127], v[232:235], v[52:55], v[124:127]
    s_waitcnt vmcnt(13)
    s_barrier
    ds_read_b64_tr_b16 v[224:225], v4 offset:49152
    ds_read_b64_tr_b16 v[226:227], v4 offset:50176
    s_waitcnt lgkmcnt(6)
    v_mfma_f32_16x16x32_bf16 v[128:131], v[236:239], v[48:51], v[128:131]
    ds_read_b64_tr_b16 v[228:229], v5 offset:49184
    s_mov_b32 s23, 0x8000
    buffer_load_dwordx4 v[40:43], v6, s[8:11], s23 offen offset:1024 sc1
    v_mfma_f32_16x16x32_bf16 v[132:135], v[236:239], v[52:55], v[132:135]
    ds_read_b64_tr_b16 v[230:231], v5 offset:50208
    s_waitcnt lgkmcnt(6)
    v_mfma_f32_16x16x32_bf16 v[136:139], v[240:243], v[48:51], v[136:139]
    ds_read_b64_tr_b16 v[232:233], v4 offset:49408
    v_mfma_f32_16x16x32_bf16 v[140:143], v[240:243], v[52:55], v[140:143]
    ds_read_b64_tr_b16 v[234:235], v4 offset:50432
    s_mov_b32 s23, 0x28000
    buffer_load_dwordx4 v[44:47], v6, s[8:11], s23 offen offset:1024 sc1
    s_waitcnt lgkmcnt(6)
    v_mfma_f32_16x16x32_bf16 v[144:147], v[244:247], v[48:51], v[144:147]
    ds_read_b64_tr_b16 v[236:237], v5 offset:49440
    v_mfma_f32_16x16x32_bf16 v[148:151], v[244:247], v[52:55], v[148:151]
    ds_read_b64_tr_b16 v[238:239], v5 offset:50464
    s_waitcnt vmcnt(13) lgkmcnt(6)
    v_mfma_f32_16x16x32_bf16 v[88:91], v[224:227], v[56:59], v[88:91]
    ds_read_b64_tr_b16 v[240:241], v4 offset:49664
    s_waitcnt vmcnt(12)
    v_mfma_f32_16x16x32_bf16 v[92:95], v[224:227], v[60:63], v[92:95]
    s_add_u32 s22, s24, 0x290000
    s_add_u32 m0, s20, 0x14000
    s_nop 0
    buffer_load_dwordx4 v3, s[4:7], s22 offen lds
    ds_read_b64_tr_b16 v[242:243], v4 offset:50688
    s_waitcnt lgkmcnt(6)
    v_mfma_f32_16x16x32_bf16 v[96:99], v[228:231], v[56:59], v[96:99]
    ds_read_b64_tr_b16 v[244:245], v5 offset:49696
    v_mfma_f32_16x16x32_bf16 v[100:103], v[228:231], v[60:63], v[100:103]
    ds_read_b64_tr_b16 v[246:247], v5 offset:50720
    s_waitcnt lgkmcnt(6)
    v_mfma_f32_16x16x32_bf16 v[104:107], v[232:235], v[56:59], v[104:107]
    s_add_u32 s22, s24, 0x292000
    s_add_u32 m0, s20, 0x14400
    s_nop 0
    buffer_load_dwordx4 v3, s[4:7], s22 offen lds
    ds_read_b64_tr_b16 v[224:225], v4 offset:49920
    v_mfma_f32_16x16x32_bf16 v[108:111], v[232:235], v[60:63], v[108:111]
    ds_read_b64_tr_b16 v[226:227], v4 offset:50944
    s_waitcnt lgkmcnt(6)
    v_mfma_f32_16x16x32_bf16 v[112:115], v[236:239], v[56:59], v[112:115]
    ds_read_b64_tr_b16 v[228:229], v5 offset:49952
    v_mfma_f32_16x16x32_bf16 v[116:119], v[236:239], v[60:63], v[116:119]
    ds_read_b64_tr_b16 v[230:231], v5 offset:50976
    s_waitcnt lgkmcnt(6)
    v_mfma_f32_16x16x32_bf16 v[120:123], v[240:243], v[56:59], v[120:123]
    v_mfma_f32_16x16x32_bf16 v[124:127], v[240:243], v[60:63], v[124:127]
    s_waitcnt vmcnt(12)
    s_barrier
    ds_read_b64_tr_b16 v[232:233], v7 offset:0
    ds_read_b64_tr_b16 v[234:235], v7 offset:1024
    s_waitcnt lgkmcnt(6)
    v_mfma_f32_16x16x32_bf16 v[128:131], v[244:247], v[56:59], v[128:131]
    ds_read_b64_tr_b16 v[236:237], v8 offset:32
    s_mov_b32 s23, 0xa000
    buffer_load_dwordx4 v[48:51], v6, s[8:11], s23 offen offset:1024 sc1
    v_mfma_f32_16x16x32_bf16 v[132:135], v[244:247], v[60:63], v[132:135]
    ds_read_b64_tr_b16 v[238:239], v8 offset:1056
    s_waitcnt lgkmcnt(6)
    v_mfma_f32_16x16x32_bf16 v[136:139], v[224:227], v[56:59], v[136:139]
    ds_read_b64_tr_b16 v[240:241], v7 offset:256
    v_mfma_f32_16x16x32_bf16 v[140:143], v[224:227], v[60:63], v[140:143]
    ds_read_b64_tr_b16 v[242:243], v7 offset:1280
    s_mov_b32 s23, 0x2a000
    buffer_load_dwordx4 v[52:55], v6, s[8:11], s23 offen offset:1024 sc1
    s_waitcnt lgkmcnt(6)
    v_mfma_f32_16x16x32_bf16 v[144:147], v[228:231], v[56:59], v[144:147]
    ds_read_b64_tr_b16 v[244:245], v8 offset:288
    v_mfma_f32_16x16x32_bf16 v[148:151], v[228:231], v[60:63], v[148:151]
    ds_read_b64_tr_b16 v[246:247], v8 offset:1312
    s_waitcnt vmcnt(13) lgkmcnt(6)
    v_mfma_f32_16x16x32_bf16 v[88:91], v[232:235], v[24:27], v[88:91]
    ds_read_b64_tr_b16 v[224:225], v7 offset:512
    s_waitcnt vmcnt(12)
    v_mfma_f32_16x16x32_bf16 v[92:95], v[232:235], v[28:31], v[92:95]
    s_add_u32 s22, s24, 0x310000
    s_add_u32 m0, s20, 0x18000
    s_nop 0
    buffer_load_dwordx4 v3, s[4:7], s22 offen lds
    ds_read_b64_tr_b16 v[226:227], v7 offset:1536
    s_waitcnt lgkmcnt(6)
    v_mfma_f32_16x16x32_bf16 v[96:99], v[236:239], v[24:27], v[96:99]
    ds_read_b64_tr_b16 v[228:229], v8 offset:544
    v_mfma_f32_16x16x32_bf16 v[100:103], v[236:239], v[28:31], v[100:103]
    ds_read_b64_tr_b16 v[230:231], v8 offset:1568
    s_waitcnt lgkmcnt(6)
    v_mfma_f32_16x16x32_bf16 v[104:107], v[240:243], v[24:27], v[104:107]
    s_add_u32 s22, s24, 0x312000
    s_add_u32 m0, s20, 0x18400
    s_nop 0
    buffer_load_dwordx4 v3, s[4:7], s22 offen lds
    ds_read_b64_tr_b16 v[232:233], v7 offset:768
    v_mfma_f32_16x16x32_bf16 v[108:111], v[240:243], v[28:31], v[108:111]
    ds_read_b64_tr_b16 v[234:235], v7 offset:1792
    s_waitcnt lgkmcnt(6)
    v_mfma_f32_16x16x32_bf16 v[112:115], v[244:247], v[24:27], v[112:115]
    ds_read_b64_tr_b16 v[236:237], v8 offset:800
    v_mfma_f32_16x16x32_bf16 v[116:119], v[244:247], v[28:31], v[116:119]
    ds_read_b64_tr_b16 v[238:239], v8 offset:1824
    s_waitcnt lgkmcnt(6)
    v_mfma_f32_16x16x32_bf16 v[120:123], v[224:227], v[24:27], v[120:123]
    v_mfma_f32_16x16x32_bf16 v[124:127], v[224:227], v[28:31], v[124:127]
    s_waitcnt vmcnt(12)
    s_barrier
    ds_read_b64_tr_b16 v[240:241], v7 offset:16384
    ds_read_b64_tr_b16 v[242:243], v7 offset:17408
    s_add_u32 s19, s19, 8192
    buffer_load_dword v12, v13, s[8:11], s19 offen sc1
    s_waitcnt lgkmcnt(6)
    v_mfma_f32_16x16x32_bf16 v[128:131], v[228:231], v[24:27], v[128:131]
    ds_read_b64_tr_b16 v[244:245], v8 offset:16416
    s_mov_b32 s23, 0xc000
    buffer_load_dwordx4 v[56:59], v6, s[8:11], s23 offen offset:1024 sc1
    v_mfma_f32_16x16x32_bf16 v[132:135], v[228:231], v[28:31], v[132:135]
    ds_read_b64_tr_b16 v[246:247], v8 offset:17440
    s_waitcnt lgkmcnt(6)
    v_mfma_f32_16x16x32_bf16 v[136:139], v[232:235], v[24:27], v[136:139]
    ds_read_b64_tr_b16 v[224:225], v7 offset:16640
    v_mfma_f32_16x16x32_bf16 v[140:143], v[232:235], v[28:31], v[140:143]
    ds_read_b64_tr_b16 v[226:227], v7 offset:17664
    s_mov_b32 s23, 0x2c000
    buffer_load_dwordx4 v[60:63], v6, s[8:11], s23 offen offset:1024 sc1
    s_waitcnt lgkmcnt(6)
    v_mfma_f32_16x16x32_bf16 v[144:147], v[236:239], v[24:27], v[144:147]
    ds_read_b64_tr_b16 v[228:229], v8 offset:16672
    v_mfma_f32_16x16x32_bf16 v[148:151], v[236:239], v[28:31], v[148:151]
    ds_read_b64_tr_b16 v[230:231], v8 offset:17696
    s_waitcnt vmcnt(14) lgkmcnt(6)
    v_mfma_f32_16x16x32_bf16 v[88:91], v[240:243], v[32:35], v[88:91]
    ds_read_b64_tr_b16 v[232:233], v7 offset:16896
    s_waitcnt vmcnt(13)
    v_mfma_f32_16x16x32_bf16 v[92:95], v[240:243], v[36:39], v[92:95]
    s_add_u32 s22, s24, 0x390000
    s_add_u32 m0, s20, 0x1c000
    s_nop 0
    buffer_load_dwordx4 v3, s[4:7], s22 offen lds
    ds_read_b64_tr_b16 v[234:235], v7 offset:17920
    s_waitcnt lgkmcnt(6)
    v_mfma_f32_16x16x32_bf16 v[96:99], v[244:247], v[32:35], v[96:99]
    ds_read_b64_tr_b16 v[236:237], v8 offset:16928
    v_mfma_f32_16x16x32_bf16 v[100:103], v[244:247], v[36:39], v[100:103]
    ds_read_b64_tr_b16 v[238:239], v8 offset:17952
    s_waitcnt lgkmcnt(6)
    v_mfma_f32_16x16x32_bf16 v[104:107], v[224:227], v[32:35], v[104:107]
    s_add_u32 s22, s24, 0x392000
    s_add_u32 m0, s20, 0x1c400
    s_nop 0
    buffer_load_dwordx4 v3, s[4:7], s22 offen lds
    ds_read_b64_tr_b16 v[240:241], v7 offset:17152
    v_mfma_f32_16x16x32_bf16 v[108:111], v[224:227], v[36:39], v[108:111]
    ds_read_b64_tr_b16 v[242:243], v7 offset:18176
    s_waitcnt lgkmcnt(6)
    v_mfma_f32_16x16x32_bf16 v[112:115], v[228:231], v[32:35], v[112:115]
    ds_read_b64_tr_b16 v[244:245], v8 offset:17184
    v_mfma_f32_16x16x32_bf16 v[116:119], v[228:231], v[36:39], v[116:119]
    ds_read_b64_tr_b16 v[246:247], v8 offset:18208
    s_waitcnt lgkmcnt(6)
    v_mfma_f32_16x16x32_bf16 v[120:123], v[232:235], v[32:35], v[120:123]
    v_mfma_f32_16x16x32_bf16 v[124:127], v[232:235], v[36:39], v[124:127]
    s_waitcnt vmcnt(13)
    s_barrier
    ds_read_b64_tr_b16 v[224:225], v4 offset:0
    ds_read_b64_tr_b16 v[226:227], v4 offset:1024
    s_waitcnt lgkmcnt(6)
    v_mfma_f32_16x16x32_bf16 v[128:131], v[236:239], v[32:35], v[128:131]
    ds_read_b64_tr_b16 v[228:229], v5 offset:32
    s_mov_b32 s23, 0xe000
    buffer_load_dwordx4 v[24:27], v6, s[8:11], s23 offen offset:1024 sc1
    v_mfma_f32_16x16x32_bf16 v[132:135], v[236:239], v[36:39], v[132:135]
    ds_read_b64_tr_b16 v[230:231], v5 offset:1056
    s_waitcnt lgkmcnt(6)
    v_mfma_f32_16x16x32_bf16 v[136:139], v[240:243], v[32:35], v[136:139]
    ds_read_b64_tr_b16 v[232:233], v4 offset:256
    v_mfma_f32_16x16x32_bf16 v[140:143], v[240:243], v[36:39], v[140:143]
    ds_read_b64_tr_b16 v[234:235], v4 offset:1280
    s_mov_b32 s23, 0x2e000
    buffer_load_dwordx4 v[28:31], v6, s[8:11], s23 offen offset:1024 sc1
    s_waitcnt lgkmcnt(6)
    v_mfma_f32_16x16x32_bf16 v[144:147], v[244:247], v[32:35], v[144:147]
    ds_read_b64_tr_b16 v[236:237], v5 offset:288
    v_mfma_f32_16x16x32_bf16 v[148:151], v[244:247], v[36:39], v[148:151]
    ds_read_b64_tr_b16 v[238:239], v5 offset:1312
    s_waitcnt vmcnt(6)
    v_cmp_ne_u32 vcc, s28, v12
    s_cbranch_vccnz adaLN_cond__sliding_block_cached__moe_arch_mod__prompt_kernel_o219r
adaLN_cond__sliding_block_cached__moe_arch_mod__prompt_kernel_o219b:
    s_waitcnt lgkmcnt(6)
    v_mfma_f32_16x16x32_bf16 v[88:91], v[224:227], v[40:43], v[88:91]
    ds_read_b64_tr_b16 v[240:241], v4 offset:512
    v_mfma_f32_16x16x32_bf16 v[92:95], v[224:227], v[44:47], v[92:95]
    s_add_u32 s22, s24, 0x20000
    s_add_u32 m0, s20, 0x20000
    s_nop 0
    buffer_load_dwordx4 v3, s[4:7], s22 offen lds
    ds_read_b64_tr_b16 v[242:243], v4 offset:1536
    s_waitcnt lgkmcnt(6)
    v_mfma_f32_16x16x32_bf16 v[96:99], v[228:231], v[40:43], v[96:99]
    ds_read_b64_tr_b16 v[244:245], v5 offset:544
    v_mfma_f32_16x16x32_bf16 v[100:103], v[228:231], v[44:47], v[100:103]
    ds_read_b64_tr_b16 v[246:247], v5 offset:1568
    s_waitcnt lgkmcnt(6)
    v_mfma_f32_16x16x32_bf16 v[104:107], v[232:235], v[40:43], v[104:107]
    s_add_u32 s22, s24, 0x22000
    s_add_u32 m0, s20, 0x20400
    s_nop 0
    buffer_load_dwordx4 v3, s[4:7], s22 offen lds
    ds_read_b64_tr_b16 v[224:225], v4 offset:768
    v_mfma_f32_16x16x32_bf16 v[108:111], v[232:235], v[44:47], v[108:111]
    ds_read_b64_tr_b16 v[226:227], v4 offset:1792
    s_waitcnt lgkmcnt(6)
    v_mfma_f32_16x16x32_bf16 v[112:115], v[236:239], v[40:43], v[112:115]
    ds_read_b64_tr_b16 v[228:229], v5 offset:800
    v_mfma_f32_16x16x32_bf16 v[116:119], v[236:239], v[44:47], v[116:119]
    ds_read_b64_tr_b16 v[230:231], v5 offset:1824
    s_waitcnt lgkmcnt(6)
    v_mfma_f32_16x16x32_bf16 v[120:123], v[240:243], v[40:43], v[120:123]
    v_mfma_f32_16x16x32_bf16 v[124:127], v[240:243], v[44:47], v[124:127]
    s_barrier
    ds_read_b64_tr_b16 v[232:233], v4 offset:16384
    ds_read_b64_tr_b16 v[234:235], v4 offset:17408
    s_waitcnt lgkmcnt(6)
    v_mfma_f32_16x16x32_bf16 v[128:131], v[244:247], v[40:43], v[128:131]
    ds_read_b64_tr_b16 v[236:237], v5 offset:16416
    s_mov_b32 s23, 0x0
    buffer_load_dwordx4 v[32:35], v6, s[8:11], s23 offen offset:2048 sc1
    v_mfma_f32_16x16x32_bf16 v[132:135], v[244:247], v[44:47], v[132:135]
    ds_read_b64_tr_b16 v[238:239], v5 offset:17440
    s_waitcnt lgkmcnt(6)
    v_mfma_f32_16x16x32_bf16 v[136:139], v[224:227], v[40:43], v[136:139]
    ds_read_b64_tr_b16 v[240:241], v4 offset:16640
    v_mfma_f32_16x16x32_bf16 v[140:143], v[224:227], v[44:47], v[140:143]
    ds_read_b64_tr_b16 v[242:243], v4 offset:17664
    s_mov_b32 s23, 0x20000
    buffer_load_dwordx4 v[36:39], v6, s[8:11], s23 offen offset:2048 sc1
    s_waitcnt lgkmcnt(6)
    v_mfma_f32_16x16x32_bf16 v[144:147], v[228:231], v[40:43], v[144:147]
    ds_read_b64_tr_b16 v[244:245], v5 offset:16672
    v_mfma_f32_16x16x32_bf16 v[148:151], v[228:231], v[44:47], v[148:151]
    ds_read_b64_tr_b16 v[246:247], v5 offset:17696
    s_waitcnt lgkmcnt(6)
    v_mfma_f32_16x16x32_bf16 v[88:91], v[232:235], v[48:51], v[88:91]
    ds_read_b64_tr_b16 v[224:225], v4 offset:16896
    v_mfma_f32_16x16x32_bf16 v[92:95], v[232:235], v[52:55], v[92:95]
    s_add_u32 s22, s24, 0xa0000
    s_add_u32 m0, s20, 0x24000
    s_nop 0
    buffer_load_dwordx4 v3, s[4:7], s22 offen lds
    ds_read_b64_tr_b16 v[226:227], v4 offset:17920
    s_waitcnt lgkmcnt(6)
    v_mfma_f32_16x16x32_bf16 v[96:99], v[236:239], v[48:51], v[96:99]
    ds_read_b64_tr_b16 v[228:229], v5 offset:16928
    v_mfma_f32_16x16x32_bf16 v[100:103], v[236:239], v[52:55], v[100:103]
    ds_read_b64_tr_b16 v[230:231], v5 offset:17952
    s_waitcnt lgkmcnt(6)
    v_mfma_f32_16x16x32_bf16 v[104:107], v[240:243], v[48:51], v[104:107]
    s_add_u32 s22, s24, 0xa2000
    s_add_u32 m0, s20, 0x24400
    s_nop 0
    buffer_load_dwordx4 v3, s[4:7], s22 offen lds
    ds_read_b64_tr_b16 v[232:233], v4 offset:17152
    v_mfma_f32_16x16x32_bf16 v[108:111], v[240:243], v[52:55], v[108:111]
    ds_read_b64_tr_b16 v[234:235], v4 offset:18176
    s_waitcnt lgkmcnt(6)
    v_mfma_f32_16x16x32_bf16 v[112:115], v[244:247], v[48:51], v[112:115]
    ds_read_b64_tr_b16 v[236:237], v5 offset:17184
    v_mfma_f32_16x16x32_bf16 v[116:119], v[244:247], v[52:55], v[116:119]
    ds_read_b64_tr_b16 v[238:239], v5 offset:18208
    s_waitcnt lgkmcnt(6)
    v_mfma_f32_16x16x32_bf16 v[120:123], v[224:227], v[48:51], v[120:123]
    v_mfma_f32_16x16x32_bf16 v[124:127], v[224:227], v[52:55], v[124:127]
    s_barrier
    ds_read_b64_tr_b16 v[240:241], v4 offset:32768
    ds_read_b64_tr_b16 v[242:243], v4 offset:33792
    s_waitcnt lgkmcnt(6)
    v_mfma_f32_16x16x32_bf16 v[128:131], v[228:231], v[48:51], v[128:131]
    ds_read_b64_tr_b16 v[244:245], v5 offset:32800
    s_mov_b32 s23, 0x2000
    buffer_load_dwordx4 v[40:43], v6, s[8:11], s23 offen offset:2048 sc1
    v_mfma_f32_16x16x32_bf16 v[132:135], v[228:231], v[52:55], v[132:135]
    ds_read_b64_tr_b16 v[246:247], v5 offset:33824
    s_waitcnt lgkmcnt(6)
    v_mfma_f32_16x16x32_bf16 v[136:139], v[232:235], v[48:51], v[136:139]
    ds_read_b64_tr_b16 v[224:225], v4 offset:33024
    v_mfma_f32_16x16x32_bf16 v[140:143], v[232:235], v[52:55], v[140:143]
    ds_read_b64_tr_b16 v[226:227], v4 offset:34048
    s_mov_b32 s23, 0x22000
    buffer_load_dwordx4 v[44:47], v6, s[8:11], s23 offen offset:2048 sc1
    s_waitcnt lgkmcnt(6)
    v_mfma_f32_16x16x32_bf16 v[144:147], v[236:239], v[48:51], v[144:147]
    ds_read_b64_tr_b16 v[228:229], v5 offset:33056
    v_mfma_f32_16x16x32_bf16 v[148:151], v[236:239], v[52:55], v[148:151]
    ds_read_b64_tr_b16 v[230:231], v5 offset:34080
    s_waitcnt vmcnt(13) lgkmcnt(6)
    v_mfma_f32_16x16x32_bf16 v[88:91], v[240:243], v[56:59], v[88:91]
    ds_read_b64_tr_b16 v[232:233], v4 offset:33280
    s_waitcnt vmcnt(12)
    v_mfma_f32_16x16x32_bf16 v[92:95], v[240:243], v[60:63], v[92:95]
    s_add_u32 s22, s24, 0x120000
    s_add_u32 m0, s20, 0x10000
    s_nop 0
    buffer_load_dwordx4 v3, s[4:7], s22 offen lds
    ds_read_b64_tr_b16 v[234:235], v4 offset:34304
    s_waitcnt lgkmcnt(6)
    v_mfma_f32_16x16x32_bf16 v[96:99], v[244:247], v[56:59], v[96:99]
    ds_read_b64_tr_b16 v[236:237], v5 offset:33312
    v_mfma_f32_16x16x32_bf16 v[100:103], v[244:247], v[60:63], v[100:103]
    ds_read_b64_tr_b16 v[238:239], v5 offset:34336
    s_waitcnt lgkmcnt(6)
    v_mfma_f32_16x16x32_bf16 v[104:107], v[224:227], v[56:59], v[104:107]
    s_add_u32 s22, s24, 0x122000
    s_add_u32 m0, s20, 0x10400
    s_nop 0
    buffer_load_dwordx4 v3, s[4:7], s22 offen lds
    ds_read_b64_tr_b16 v[240:241], v4 offset:33536
    v_mfma_f32_16x16x32_bf16 v[108:111], v[224:227], v[60:63], v[108:111]
    ds_read_b64_tr_b16 v[242:243], v4 offset:34560
    s_waitcnt lgkmcnt(6)
    v_mfma_f32_16x16x32_bf16 v[112:115], v[228:231], v[56:59], v[112:115]
    ds_read_b64_tr_b16 v[244:245], v5 offset:33568
    v_mfma_f32_16x16x32_bf16 v[116:119], v[228:231], v[60:63], v[116:119]
    ds_read_b64_tr_b16 v[246:247], v5 offset:34592
    s_waitcnt lgkmcnt(6)
    v_mfma_f32_16x16x32_bf16 v[120:123], v[232:235], v[56:59], v[120:123]
    v_mfma_f32_16x16x32_bf16 v[124:127], v[232:235], v[60:63], v[124:127]
    s_waitcnt vmcnt(12)
    s_barrier
    ds_read_b64_tr_b16 v[224:225], v4 offset:49152
    ds_read_b64_tr_b16 v[226:227], v4 offset:50176
    s_waitcnt lgkmcnt(6)
    v_mfma_f32_16x16x32_bf16 v[128:131], v[236:239], v[56:59], v[128:131]
    ds_read_b64_tr_b16 v[228:229], v5 offset:49184
    s_mov_b32 s23, 0x4000
    buffer_load_dwordx4 v[48:51], v6, s[8:11], s23 offen offset:2048 sc1
    v_mfma_f32_16x16x32_bf16 v[132:135], v[236:239], v[60:63], v[132:135]
    ds_read_b64_tr_b16 v[230:231], v5 offset:50208
    s_waitcnt lgkmcnt(6)
    v_mfma_f32_16x16x32_bf16 v[136:139], v[240:243], v[56:59], v[136:139]
    ds_read_b64_tr_b16 v[232:233], v4 offset:49408
    v_mfma_f32_16x16x32_bf16 v[140:143], v[240:243], v[60:63], v[140:143]
    ds_read_b64_tr_b16 v[234:235], v4 offset:50432
    s_mov_b32 s23, 0x24000
    buffer_load_dwordx4 v[52:55], v6, s[8:11], s23 offen offset:2048 sc1
    s_waitcnt lgkmcnt(6)
    v_mfma_f32_16x16x32_bf16 v[144:147], v[244:247], v[56:59], v[144:147]
    ds_read_b64_tr_b16 v[236:237], v5 offset:49440
    v_mfma_f32_16x16x32_bf16 v[148:151], v[244:247], v[60:63], v[148:151]
    ds_read_b64_tr_b16 v[238:239], v5 offset:50464
    s_waitcnt vmcnt(13) lgkmcnt(6)
    v_mfma_f32_16x16x32_bf16 v[88:91], v[224:227], v[24:27], v[88:91]
    ds_read_b64_tr_b16 v[240:241], v4 offset:49664
    s_waitcnt vmcnt(12)
    v_mfma_f32_16x16x32_bf16 v[92:95], v[224:227], v[28:31], v[92:95]
    s_add_u32 s22, s24, 0x1a0000
    s_add_u32 m0, s20, 0x14000
    s_nop 0
    buffer_load_dwordx4 v3, s[4:7], s22 offen lds
    ds_read_b64_tr_b16 v[242:243], v4 offset:50688
    s_waitcnt lgkmcnt(6)
    v_mfma_f32_16x16x32_bf16 v[96:99], v[228:231], v[24:27], v[96:99]
    ds_read_b64_tr_b16 v[244:245], v5 offset:49696
    v_mfma_f32_16x16x32_bf16 v[100:103], v[228:231], v[28:31], v[100:103]
    ds_read_b64_tr_b16 v[246:247], v5 offset:50720
    s_waitcnt lgkmcnt(6)
    v_mfma_f32_16x16x32_bf16 v[104:107], v[232:235], v[24:27], v[104:107]
    s_add_u32 s22, s24, 0x1a2000
    s_add_u32 m0, s20, 0x14400
    s_nop 0
    buffer_load_dwordx4 v3, s[4:7], s22 offen lds
    ds_read_b64_tr_b16 v[224:225], v4 offset:49920
    v_mfma_f32_16x16x32_bf16 v[108:111], v[232:235], v[28:31], v[108:111]
    ds_read_b64_tr_b16 v[226:227], v4 offset:50944
    s_waitcnt lgkmcnt(6)
    v_mfma_f32_16x16x32_bf16 v[112:115], v[236:239], v[24:27], v[112:115]
    ds_read_b64_tr_b16 v[228:229], v5 offset:49952
    v_mfma_f32_16x16x32_bf16 v[116:119], v[236:239], v[28:31], v[116:119]
    ds_read_b64_tr_b16 v[230:231], v5 offset:50976
    s_waitcnt lgkmcnt(6)
    v_mfma_f32_16x16x32_bf16 v[120:123], v[240:243], v[24:27], v[120:123]
    v_mfma_f32_16x16x32_bf16 v[124:127], v[240:243], v[28:31], v[124:127]
    s_waitcnt vmcnt(12)
    s_barrier
    ds_read_b64_tr_b16 v[232:233], v7 offset:0
    ds_read_b64_tr_b16 v[234:235], v7 offset:1024
    s_waitcnt lgkmcnt(6)
    v_mfma_f32_16x16x32_bf16 v[128:131], v[244:247], v[24:27], v[128:131]
    ds_read_b64_tr_b16 v[236:237], v8 offset:32
    s_mov_b32 s23, 0x6000
    buffer_load_dwordx4 v[56:59], v6, s[8:11], s23 offen offset:2048 sc1
    v_mfma_f32_16x16x32_bf16 v[132:135], v[244:247], v[28:31], v[132:135]
    ds_read_b64_tr_b16 v[238:239], v8 offset:1056
    s_waitcnt lgkmcnt(6)
    v_mfma_f32_16x16x32_bf16 v[136:139], v[224:227], v[24:27], v[136:139]
    ds_read_b64_tr_b16 v[240:241], v7 offset:256
    v_mfma_f32_16x16x32_bf16 v[140:143], v[224:227], v[28:31], v[140:143]
    ds_read_b64_tr_b16 v[242:243], v7 offset:1280
    s_mov_b32 s23, 0x26000
    buffer_load_dwordx4 v[60:63], v6, s[8:11], s23 offen offset:2048 sc1
    s_waitcnt lgkmcnt(6)
    v_mfma_f32_16x16x32_bf16 v[144:147], v[228:231], v[24:27], v[144:147]
    ds_read_b64_tr_b16 v[244:245], v8 offset:288
    v_mfma_f32_16x16x32_bf16 v[148:151], v[228:231], v[28:31], v[148:151]
    ds_read_b64_tr_b16 v[246:247], v8 offset:1312
    s_waitcnt vmcnt(13) lgkmcnt(6)
    v_mfma_f32_16x16x32_bf16 v[88:91], v[232:235], v[32:35], v[88:91]
    ds_read_b64_tr_b16 v[224:225], v7 offset:512
    s_waitcnt vmcnt(12)
    v_mfma_f32_16x16x32_bf16 v[92:95], v[232:235], v[36:39], v[92:95]
    s_add_u32 s22, s24, 0x220000
    s_add_u32 m0, s20, 0x18000
    s_nop 0
    buffer_load_dwordx4 v3, s[4:7], s22 offen lds
    ds_read_b64_tr_b16 v[226:227], v7 offset:1536
    s_waitcnt lgkmcnt(6)
    v_mfma_f32_16x16x32_bf16 v[96:99], v[236:239], v[32:35], v[96:99]
    ds_read_b64_tr_b16 v[228:229], v8 offset:544
    v_mfma_f32_16x16x32_bf16 v[100:103], v[236:239], v[36:39], v[100:103]
    ds_read_b64_tr_b16 v[230:231], v8 offset:1568
    s_waitcnt lgkmcnt(6)
    v_mfma_f32_16x16x32_bf16 v[104:107], v[240:243], v[32:35], v[104:107]
    s_add_u32 s22, s24, 0x222000
    s_add_u32 m0, s20, 0x18400
    s_nop 0
    buffer_load_dwordx4 v3, s[4:7], s22 offen lds
    ds_read_b64_tr_b16 v[232:233], v7 offset:768
    v_mfma_f32_16x16x32_bf16 v[108:111], v[240:243], v[36:39], v[108:111]
    ds_read_b64_tr_b16 v[234:235], v7 offset:1792
    s_mov_b32 s16, 0x544000
    buffer_load_dwordx4 v[184:187], v2, s[8:11], s16 offen sc1
    s_waitcnt lgkmcnt(6)
    v_mfma_f32_16x16x32_bf16 v[112:115], v[244:247], v[32:35], v[112:115]
    ds_read_b64_tr_b16 v[236:237], v8 offset:800
    v_mfma_f32_16x16x32_bf16 v[116:119], v[244:247], v[36:39], v[116:119]
    ds_read_b64_tr_b16 v[238:239], v8 offset:1824
    s_waitcnt lgkmcnt(6)
    v_mfma_f32_16x16x32_bf16 v[120:123], v[224:227], v[32:35], v[120:123]
    v_mfma_f32_16x16x32_bf16 v[124:127], v[224:227], v[36:39], v[124:127]
    s_waitcnt vmcnt(13)
    s_barrier
    ds_read_b64_tr_b16 v[240:241], v7 offset:16384
    ds_read_b64_tr_b16 v[242:243], v7 offset:17408
    s_waitcnt lgkmcnt(6)
    v_mfma_f32_16x16x32_bf16 v[128:131], v[228:231], v[32:35], v[128:131]
    ds_read_b64_tr_b16 v[244:245], v8 offset:16416
    s_mov_b32 s23, 0x8000
    buffer_load_dwordx4 v[24:27], v6, s[8:11], s23 offen offset:2048 sc1
    v_mfma_f32_16x16x32_bf16 v[132:135], v[228:231], v[36:39], v[132:135]
    ds_read_b64_tr_b16 v[246:247], v8 offset:17440
    s_waitcnt lgkmcnt(6)
    v_mfma_f32_16x16x32_bf16 v[136:139], v[232:235], v[32:35], v[136:139]
    ds_read_b64_tr_b16 v[224:225], v7 offset:16640
    v_mfma_f32_16x16x32_bf16 v[140:143], v[232:235], v[36:39], v[140:143]
    ds_read_b64_tr_b16 v[226:227], v7 offset:17664
    s_mov_b32 s23, 0x28000
    buffer_load_dwordx4 v[28:31], v6, s[8:11], s23 offen offset:2048 sc1
    s_waitcnt lgkmcnt(6)
    v_mfma_f32_16x16x32_bf16 v[144:147], v[236:239], v[32:35], v[144:147]
    ds_read_b64_tr_b16 v[228:229], v8 offset:16672
    v_mfma_f32_16x16x32_bf16 v[148:151], v[236:239], v[36:39], v[148:151]
    ds_read_b64_tr_b16 v[230:231], v8 offset:17696
    s_waitcnt vmcnt(14) lgkmcnt(6)
    v_mfma_f32_16x16x32_bf16 v[88:91], v[240:243], v[40:43], v[88:91]
    ds_read_b64_tr_b16 v[232:233], v7 offset:16896
    s_waitcnt vmcnt(13)
    v_mfma_f32_16x16x32_bf16 v[92:95], v[240:243], v[44:47], v[92:95]
    s_add_u32 s22, s24, 0x2a0000
    s_add_u32 m0, s20, 0x1c000
    s_nop 0
    buffer_load_dwordx4 v3, s[4:7], s22 offen lds
    ds_read_b64_tr_b16 v[234:235], v7 offset:17920
    s_waitcnt lgkmcnt(6)
    v_mfma_f32_16x16x32_bf16 v[96:99], v[244:247], v[40:43], v[96:99]
    ds_read_b64_tr_b16 v[236:237], v8 offset:16928
    v_mfma_f32_16x16x32_bf16 v[100:103], v[244:247], v[44:47], v[100:103]
    ds_read_b64_tr_b16 v[238:239], v8 offset:17952
    s_waitcnt lgkmcnt(6)
    v_mfma_f32_16x16x32_bf16 v[104:107], v[224:227], v[40:43], v[104:107]
    s_add_u32 s22, s24, 0x2a2000
    s_add_u32 m0, s20, 0x1c400
    s_nop 0
    buffer_load_dwordx4 v3, s[4:7], s22 offen lds
    ds_read_b64_tr_b16 v[240:241], v7 offset:17152
    v_mfma_f32_16x16x32_bf16 v[108:111], v[224:227], v[44:47], v[108:111]
    ds_read_b64_tr_b16 v[242:243], v7 offset:18176
    s_waitcnt lgkmcnt(6)
    v_mfma_f32_16x16x32_bf16 v[112:115], v[228:231], v[40:43], v[112:115]
    ds_read_b64_tr_b16 v[244:245], v8 offset:17184
    v_mfma_f32_16x16x32_bf16 v[116:119], v[228:231], v[44:47], v[116:119]
    ds_read_b64_tr_b16 v[246:247], v8 offset:18208
    s_waitcnt lgkmcnt(6)
    v_mfma_f32_16x16x32_bf16 v[120:123], v[232:235], v[40:43], v[120:123]
    v_mfma_f32_16x16x32_bf16 v[124:127], v[232:235], v[44:47], v[124:127]
    s_waitcnt vmcnt(13)
    s_barrier
    ds_read_b64_tr_b16 v[224:225], v4 offset:0
    ds_read_b64_tr_b16 v[226:227], v4 offset:1024
    s_waitcnt lgkmcnt(6)
    v_mfma_f32_16x16x32_bf16 v[128:131], v[236:239], v[40:43], v[128:131]
    ds_read_b64_tr_b16 v[228:229], v5 offset:32
    s_mov_b32 s23, 0xa000
    buffer_load_dwordx4 v[32:35], v6, s[8:11], s23 offen offset:2048 sc1
    v_mfma_f32_16x16x32_bf16 v[132:135], v[236:239], v[44:47], v[132:135]
    ds_read_b64_tr_b16 v[230:231], v5 offset:1056
    s_waitcnt lgkmcnt(6)
    v_mfma_f32_16x16x32_bf16 v[136:139], v[240:243], v[40:43], v[136:139]
    ds_read_b64_tr_b16 v[232:233], v4 offset:256
    v_mfma_f32_16x16x32_bf16 v[140:143], v[240:243], v[44:47], v[140:143]
    ds_read_b64_tr_b16 v[234:235], v4 offset:1280
    s_mov_b32 s23, 0x2a000
    buffer_load_dwordx4 v[36:39], v6, s[8:11], s23 offen offset:2048 sc1
    s_waitcnt lgkmcnt(6)
    v_mfma_f32_16x16x32_bf16 v[144:147], v[244:247], v[40:43], v[144:147]
    ds_read_b64_tr_b16 v[236:237], v5 offset:288
    v_mfma_f32_16x16x32_bf16 v[148:151], v[244:247], v[44:47], v[148:151]
    ds_read_b64_tr_b16 v[238:239], v5 offset:1312
    s_waitcnt vmcnt(14) lgkmcnt(6)
    v_mfma_f32_16x16x32_bf16 v[88:91], v[224:227], v[48:51], v[88:91]
    ds_read_b64_tr_b16 v[240:241], v4 offset:512
    s_waitcnt vmcnt(13)
    v_mfma_f32_16x16x32_bf16 v[92:95], v[224:227], v[52:55], v[92:95]
    s_add_u32 s22, s24, 0x320000
    s_add_u32 m0, s20, 0x20000
    s_nop 0
    buffer_load_dwordx4 v3, s[4:7], s22 offen lds
    ds_read_b64_tr_b16 v[242:243], v4 offset:1536
    s_waitcnt lgkmcnt(6)
    v_mfma_f32_16x16x32_bf16 v[96:99], v[228:231], v[48:51], v[96:99]
    ds_read_b64_tr_b16 v[244:245], v5 offset:544
    v_mfma_f32_16x16x32_bf16 v[100:103], v[228:231], v[52:55], v[100:103]
    ds_read_b64_tr_b16 v[246:247], v5 offset:1568
    s_waitcnt lgkmcnt(6)
    v_mfma_f32_16x16x32_bf16 v[104:107], v[232:235], v[48:51], v[104:107]
    s_add_u32 s22, s24, 0x322000
    s_add_u32 m0, s20, 0x20400
    s_nop 0
    buffer_load_dwordx4 v3, s[4:7], s22 offen lds
    ds_read_b64_tr_b16 v[224:225], v4 offset:768
    v_mfma_f32_16x16x32_bf16 v[108:111], v[232:235], v[52:55], v[108:111]
    ds_read_b64_tr_b16 v[226:227], v4 offset:1792
    s_waitcnt lgkmcnt(6)
    v_mfma_f32_16x16x32_bf16 v[112:115], v[236:239], v[48:51], v[112:115]
    ds_read_b64_tr_b16 v[228:229], v5 offset:800
    v_mfma_f32_16x16x32_bf16 v[116:119], v[236:239], v[52:55], v[116:119]
    ds_read_b64_tr_b16 v[230:231], v5 offset:1824
    s_waitcnt lgkmcnt(6)
    v_mfma_f32_16x16x32_bf16 v[120:123], v[240:243], v[48:51], v[120:123]
    v_mfma_f32_16x16x32_bf16 v[124:127], v[240:243], v[52:55], v[124:127]
    s_waitcnt vmcnt(13)
    s_barrier
    ds_read_b64_tr_b16 v[232:233], v4 offset:16384
    ds_read_b64_tr_b16 v[234:235], v4 offset:17408
    s_add_u32 s19, s19, 8192
    buffer_load_dword v12, v13, s[8:11], s19 offen sc1
    s_waitcnt lgkmcnt(6)
    v_mfma_f32_16x16x32_bf16 v[128:131], v[244:247], v[48:51], v[128:131]
    ds_read_b64_tr_b16 v[236:237], v5 offset:16416
    s_mov_b32 s23, 0xc000
    buffer_load_dwordx4 v[40:43], v6, s[8:11], s23 offen offset:2048 sc1
    v_mfma_f32_16x16x32_bf16 v[132:135], v[244:247], v[52:55], v[132:135]
    ds_read_b64_tr_b16 v[238:239], v5 offset:17440
    s_waitcnt lgkmcnt(6)
    v_mfma_f32_16x16x32_bf16 v[136:139], v[224:227], v[48:51], v[136:139]
    ds_read_b64_tr_b16 v[240:241], v4 offset:16640
    v_mfma_f32_16x16x32_bf16 v[140:143], v[224:227], v[52:55], v[140:143]
    ds_read_b64_tr_b16 v[242:243], v4 offset:17664
    s_mov_b32 s23, 0x2c000
    buffer_load_dwordx4 v[44:47], v6, s[8:11], s23 offen offset:2048 sc1
    s_waitcnt lgkmcnt(6)
    v_mfma_f32_16x16x32_bf16 v[144:147], v[228:231], v[48:51], v[144:147]
    ds_read_b64_tr_b16 v[244:245], v5 offset:16672
    v_mfma_f32_16x16x32_bf16 v[148:151], v[228:231], v[52:55], v[148:151]
    ds_read_b64_tr_b16 v[246:247], v5 offset:17696
    s_waitcnt vmcnt(15) lgkmcnt(6)
    v_mfma_f32_16x16x32_bf16 v[88:91], v[232:235], v[56:59], v[88:91]
    ds_read_b64_tr_b16 v[224:225], v4 offset:16896
    s_waitcnt vmcnt(14)
    v_mfma_f32_16x16x32_bf16 v[92:95], v[232:235], v[60:63], v[92:95]
    s_add_u32 s22, s24, 0x3a0000
    s_add_u32 m0, s20, 0x24000
    s_nop 0
    buffer_load_dwordx4 v3, s[4:7], s22 offen lds
    ds_read_b64_tr_b16 v[226:227], v4 offset:17920
    s_waitcnt lgkmcnt(6)
    v_mfma_f32_16x16x32_bf16 v[96:99], v[236:239], v[56:59], v[96:99]
    ds_read_b64_tr_b16 v[228:229], v5 offset:16928
    v_mfma_f32_16x16x32_bf16 v[100:103], v[236:239], v[60:63], v[100:103]
    ds_read_b64_tr_b16 v[230:231], v5 offset:17952
    s_waitcnt lgkmcnt(6)
    v_mfma_f32_16x16x32_bf16 v[104:107], v[240:243], v[56:59], v[104:107]
    s_add_u32 s22, s24, 0x3a2000
    s_add_u32 m0, s20, 0x24400
    s_nop 0
    buffer_load_dwordx4 v3, s[4:7], s22 offen lds
    ds_read_b64_tr_b16 v[232:233], v4 offset:17152
    v_mfma_f32_16x16x32_bf16 v[108:111], v[240:243], v[60:63], v[108:111]
    ds_read_b64_tr_b16 v[234:235], v4 offset:18176
    s_waitcnt lgkmcnt(6)
    v_mfma_f32_16x16x32_bf16 v[112:115], v[244:247], v[56:59], v[112:115]
    ds_read_b64_tr_b16 v[236:237], v5 offset:17184
    v_mfma_f32_16x16x32_bf16 v[116:119], v[244:247], v[60:63], v[116:119]
    ds_read_b64_tr_b16 v[238:239], v5 offset:18208
    s_waitcnt lgkmcnt(6)
    v_mfma_f32_16x16x32_bf16 v[120:123], v[224:227], v[56:59], v[120:123]
    v_mfma_f32_16x16x32_bf16 v[124:127], v[224:227], v[60:63], v[124:127]
    s_waitcnt vmcnt(14)
    s_barrier
    ds_read_b64_tr_b16 v[240:241], v4 offset:32768
    ds_read_b64_tr_b16 v[242:243], v4 offset:33792
    s_waitcnt lgkmcnt(6)
    v_mfma_f32_16x16x32_bf16 v[128:131], v[228:231], v[56:59], v[128:131]
    ds_read_b64_tr_b16 v[244:245], v5 offset:32800
    s_mov_b32 s23, 0xe000
    buffer_load_dwordx4 v[48:51], v6, s[8:11], s23 offen offset:2048 sc1
    v_mfma_f32_16x16x32_bf16 v[132:135], v[228:231], v[60:63], v[132:135]
    ds_read_b64_tr_b16 v[246:247], v5 offset:33824
    s_waitcnt lgkmcnt(6)
    v_mfma_f32_16x16x32_bf16 v[136:139], v[232:235], v[56:59], v[136:139]
    ds_read_b64_tr_b16 v[224:225], v4 offset:33024
    v_mfma_f32_16x16x32_bf16 v[140:143], v[232:235], v[60:63], v[140:143]
    ds_read_b64_tr_b16 v[226:227], v4 offset:34048
    s_mov_b32 s23, 0x2e000
    buffer_load_dwordx4 v[52:55], v6, s[8:11], s23 offen offset:2048 sc1
    s_waitcnt lgkmcnt(6)
    v_mfma_f32_16x16x32_bf16 v[144:147], v[236:239], v[56:59], v[144:147]
    ds_read_b64_tr_b16 v[228:229], v5 offset:33056
    v_mfma_f32_16x16x32_bf16 v[148:151], v[236:239], v[60:63], v[148:151]
    ds_read_b64_tr_b16 v[230:231], v5 offset:34080
    s_waitcnt vmcnt(6)
    v_cmp_ne_u32 vcc, s28, v12
    s_cbranch_vccnz adaLN_cond__sliding_block_cached__moe_arch_mod__prompt_kernel_o220r
adaLN_cond__sliding_block_cached__moe_arch_mod__prompt_kernel_o220b:
    s_waitcnt lgkmcnt(6)
    v_mfma_f32_16x16x32_bf16 v[88:91], v[240:243], v[24:27], v[88:91]
    ds_read_b64_tr_b16 v[232:233], v4 offset:33280
    v_mfma_f32_16x16x32_bf16 v[92:95], v[240:243], v[28:31], v[92:95]
    s_add_u32 s22, s24, 0x30000
    s_add_u32 m0, s20, 0x10000
    s_nop 0
    buffer_load_dwordx4 v3, s[4:7], s22 offen lds
    ds_read_b64_tr_b16 v[234:235], v4 offset:34304
    s_waitcnt lgkmcnt(6)
    v_mfma_f32_16x16x32_bf16 v[96:99], v[244:247], v[24:27], v[96:99]
    ds_read_b64_tr_b16 v[236:237], v5 offset:33312
    v_mfma_f32_16x16x32_bf16 v[100:103], v[244:247], v[28:31], v[100:103]
    ds_read_b64_tr_b16 v[238:239], v5 offset:34336
    s_waitcnt lgkmcnt(6)
    v_mfma_f32_16x16x32_bf16 v[104:107], v[224:227], v[24:27], v[104:107]
    s_add_u32 s22, s24, 0x32000
    s_add_u32 m0, s20, 0x10400
    s_nop 0
    buffer_load_dwordx4 v3, s[4:7], s22 offen lds
    ds_read_b64_tr_b16 v[240:241], v4 offset:33536
    v_mfma_f32_16x16x32_bf16 v[108:111], v[224:227], v[28:31], v[108:111]
    ds_read_b64_tr_b16 v[242:243], v4 offset:34560
    v_xor_b32 v16, s28, v184
    v_xor_b32 v17, s28, v185
    v_xor_b32 v18, s28, v186
    v_xor_b32 v19, s28, v187
    v_or3_b32 v16, v16, v17, v18
    v_or_b32 v16, v16, v19
    v_cmp_ne_u32 vcc, 0, v16
    s_cbranch_vccnz adaLN_cond__sliding_block_cached__moe_arch_mod__prompt_kernel_mf21r
adaLN_cond__sliding_block_cached__moe_arch_mod__prompt_kernel_mf21b:
    s_waitcnt lgkmcnt(6)
    v_mfma_f32_16x16x32_bf16 v[112:115], v[228:231], v[24:27], v[112:115]
    ds_read_b64_tr_b16 v[244:245], v5 offset:33568
    v_mfma_f32_16x16x32_bf16 v[116:119], v[228:231], v[28:31], v[116:119]
    ds_read_b64_tr_b16 v[246:247], v5 offset:34592
    s_waitcnt lgkmcnt(6)
    v_mfma_f32_16x16x32_bf16 v[120:123], v[232:235], v[24:27], v[120:123]
    v_mfma_f32_16x16x32_bf16 v[124:127], v[232:235], v[28:31], v[124:127]
    s_barrier
    ds_read_b64_tr_b16 v[224:225], v4 offset:49152
    ds_read_b64_tr_b16 v[226:227], v4 offset:50176
    s_waitcnt lgkmcnt(6)
    v_mfma_f32_16x16x32_bf16 v[128:131], v[236:239], v[24:27], v[128:131]
    ds_read_b64_tr_b16 v[228:229], v5 offset:49184
    s_mov_b32 s23, 0x0
    buffer_load_dwordx4 v[56:59], v6, s[8:11], s23 offen offset:3072 sc1
    v_mfma_f32_16x16x32_bf16 v[132:135], v[236:239], v[28:31], v[132:135]
    ds_read_b64_tr_b16 v[230:231], v5 offset:50208
    s_waitcnt lgkmcnt(6)
    v_mfma_f32_16x16x32_bf16 v[136:139], v[240:243], v[24:27], v[136:139]
    ds_read_b64_tr_b16 v[232:233], v4 offset:49408
    v_mfma_f32_16x16x32_bf16 v[140:143], v[240:243], v[28:31], v[140:143]
    ds_read_b64_tr_b16 v[234:235], v4 offset:50432
    s_mov_b32 s23, 0x20000
    buffer_load_dwordx4 v[60:63], v6, s[8:11], s23 offen offset:3072 sc1
    s_waitcnt lgkmcnt(6)
    v_mfma_f32_16x16x32_bf16 v[144:147], v[244:247], v[24:27], v[144:147]
    ds_read_b64_tr_b16 v[236:237], v5 offset:49440
    v_mfma_f32_16x16x32_bf16 v[148:151], v[244:247], v[28:31], v[148:151]
    ds_read_b64_tr_b16 v[238:239], v5 offset:50464
    s_waitcnt lgkmcnt(6)
    v_mfma_f32_16x16x32_bf16 v[88:91], v[224:227], v[32:35], v[88:91]
    ds_read_b64_tr_b16 v[240:241], v4 offset:49664
    v_mfma_f32_16x16x32_bf16 v[92:95], v[224:227], v[36:39], v[92:95]
    s_add_u32 s22, s24, 0xb0000
    s_add_u32 m0, s20, 0x14000
    s_nop 0
    buffer_load_dwordx4 v3, s[4:7], s22 offen lds
    ds_read_b64_tr_b16 v[242:243], v4 offset:50688
    s_waitcnt lgkmcnt(6)
    v_mfma_f32_16x16x32_bf16 v[96:99], v[228:231], v[32:35], v[96:99]
    ds_read_b64_tr_b16 v[244:245], v5 offset:49696
    v_mfma_f32_16x16x32_bf16 v[100:103], v[228:231], v[36:39], v[100:103]
    ds_read_b64_tr_b16 v[246:247], v5 offset:50720
    s_waitcnt lgkmcnt(6)
    v_mfma_f32_16x16x32_bf16 v[104:107], v[232:235], v[32:35], v[104:107]
    s_add_u32 s22, s24, 0xb2000
    s_add_u32 m0, s20, 0x14400
    s_nop 0
    buffer_load_dwordx4 v3, s[4:7], s22 offen lds
    ds_read_b64_tr_b16 v[224:225], v4 offset:49920
    v_mfma_f32_16x16x32_bf16 v[108:111], v[232:235], v[36:39], v[108:111]
    ds_read_b64_tr_b16 v[226:227], v4 offset:50944
    s_waitcnt lgkmcnt(6)
    v_mfma_f32_16x16x32_bf16 v[112:115], v[236:239], v[32:35], v[112:115]
    ds_read_b64_tr_b16 v[228:229], v5 offset:49952
    v_mfma_f32_16x16x32_bf16 v[116:119], v[236:239], v[36:39], v[116:119]
    ds_read_b64_tr_b16 v[230:231], v5 offset:50976
    s_waitcnt lgkmcnt(6)
    v_mfma_f32_16x16x32_bf16 v[120:123], v[240:243], v[32:35], v[120:123]
    v_mfma_f32_16x16x32_bf16 v[124:127], v[240:243], v[36:39], v[124:127]
    s_barrier
    ds_read_b64_tr_b16 v[232:233], v7 offset:0
    ds_read_b64_tr_b16 v[234:235], v7 offset:1024
    s_waitcnt lgkmcnt(6)
    v_mfma_f32_16x16x32_bf16 v[128:131], v[244:247], v[32:35], v[128:131]
    ds_read_b64_tr_b16 v[236:237], v8 offset:32
    s_mov_b32 s23, 0x2000
    buffer_load_dwordx4 v[24:27], v6, s[8:11], s23 offen offset:3072 sc1
    v_mfma_f32_16x16x32_bf16 v[132:135], v[244:247], v[36:39], v[132:135]
    ds_read_b64_tr_b16 v[238:239], v8 offset:1056
    s_waitcnt lgkmcnt(6)
    v_mfma_f32_16x16x32_bf16 v[136:139], v[224:227], v[32:35], v[136:139]
    ds_read_b64_tr_b16 v[240:241], v7 offset:256
    v_mfma_f32_16x16x32_bf16 v[140:143], v[224:227], v[36:39], v[140:143]
    ds_read_b64_tr_b16 v[242:243], v7 offset:1280
    s_mov_b32 s23, 0x22000
    buffer_load_dwordx4 v[28:31], v6, s[8:11], s23 offen offset:3072 sc1
    s_waitcnt lgkmcnt(6)
    v_mfma_f32_16x16x32_bf16 v[144:147], v[228:231], v[32:35], v[144:147]
    ds_read_b64_tr_b16 v[244:245], v8 offset:288
    v_mfma_f32_16x16x32_bf16 v[148:151], v[228:231], v[36:39], v[148:151]
    ds_read_b64_tr_b16 v[246:247], v8 offset:1312
    s_waitcnt vmcnt(13) lgkmcnt(6)
    v_mfma_f32_16x16x32_bf16 v[88:91], v[232:235], v[40:43], v[88:91]
    ds_read_b64_tr_b16 v[224:225], v7 offset:512
    s_waitcnt vmcnt(12)
    v_mfma_f32_16x16x32_bf16 v[92:95], v[232:235], v[44:47], v[92:95]
    s_add_u32 s22, s24, 0x130000
    s_add_u32 m0, s20, 0x18000
    s_nop 0
    buffer_load_dwordx4 v3, s[4:7], s22 offen lds
    ds_read_b64_tr_b16 v[226:227], v7 offset:1536
    s_waitcnt lgkmcnt(6)
    v_mfma_f32_16x16x32_bf16 v[96:99], v[236:239], v[40:43], v[96:99]
    ds_read_b64_tr_b16 v[228:229], v8 offset:544
    v_mfma_f32_16x16x32_bf16 v[100:103], v[236:239], v[44:47], v[100:103]
    ds_read_b64_tr_b16 v[230:231], v8 offset:1568
    s_waitcnt lgkmcnt(6)
    v_mfma_f32_16x16x32_bf16 v[104:107], v[240:243], v[40:43], v[104:107]
    s_add_u32 s22, s24, 0x132000
    s_add_u32 m0, s20, 0x18400
    s_nop 0
    buffer_load_dwordx4 v3, s[4:7], s22 offen lds
    ds_read_b64_tr_b16 v[232:233], v7 offset:768
    v_mfma_f32_16x16x32_bf16 v[108:111], v[240:243], v[44:47], v[108:111]
    ds_read_b64_tr_b16 v[234:235], v7 offset:1792
    s_waitcnt lgkmcnt(6)
    v_mfma_f32_16x16x32_bf16 v[112:115], v[244:247], v[40:43], v[112:115]
    ds_read_b64_tr_b16 v[236:237], v8 offset:800
    v_mfma_f32_16x16x32_bf16 v[116:119], v[244:247], v[44:47], v[116:119]
    ds_read_b64_tr_b16 v[238:239], v8 offset:1824
    s_waitcnt lgkmcnt(6)
    v_mfma_f32_16x16x32_bf16 v[120:123], v[224:227], v[40:43], v[120:123]
    v_mfma_f32_16x16x32_bf16 v[124:127], v[224:227], v[44:47], v[124:127]
    s_waitcnt vmcnt(12)
    s_barrier
    ds_read_b64_tr_b16 v[240:241], v7 offset:16384
    ds_read_b64_tr_b16 v[242:243], v7 offset:17408
    s_waitcnt lgkmcnt(6)
    v_mfma_f32_16x16x32_bf16 v[128:131], v[228:231], v[40:43], v[128:131]
    ds_read_b64_tr_b16 v[244:245], v8 offset:16416
    s_mov_b32 s23, 0x4000
    buffer_load_dwordx4 v[32:35], v6, s[8:11], s23 offen offset:3072 sc1
    v_mfma_f32_16x16x32_bf16 v[132:135], v[228:231], v[44:47], v[132:135]
    ds_read_b64_tr_b16 v[246:247], v8 offset:17440
    s_waitcnt lgkmcnt(6)
    v_mfma_f32_16x16x32_bf16 v[136:139], v[232:235], v[40:43], v[136:139]
    ds_read_b64_tr_b16 v[224:225], v7 offset:16640
    v_mfma_f32_16x16x32_bf16 v[140:143], v[232:235], v[44:47], v[140:143]
    ds_read_b64_tr_b16 v[226:227], v7 offset:17664
    s_mov_b32 s23, 0x24000
    buffer_load_dwordx4 v[36:39], v6, s[8:11], s23 offen offset:3072 sc1
    s_waitcnt lgkmcnt(6)
    v_mfma_f32_16x16x32_bf16 v[144:147], v[236:239], v[40:43], v[144:147]
    ds_read_b64_tr_b16 v[228:229], v8 offset:16672
    v_mfma_f32_16x16x32_bf16 v[148:151], v[236:239], v[44:47], v[148:151]
    ds_read_b64_tr_b16 v[230:231], v8 offset:17696
    s_waitcnt vmcnt(13) lgkmcnt(6)
    v_mfma_f32_16x16x32_bf16 v[88:91], v[240:243], v[48:51], v[88:91]
    ds_read_b64_tr_b16 v[232:233], v7 offset:16896
    s_waitcnt vmcnt(12)
    v_mfma_f32_16x16x32_bf16 v[92:95], v[240:243], v[52:55], v[92:95]
    s_add_u32 s22, s24, 0x1b0000
    s_add_u32 m0, s20, 0x1c000
    s_nop 0
    buffer_load_dwordx4 v3, s[4:7], s22 offen lds
    ds_read_b64_tr_b16 v[234:235], v7 offset:17920
    s_waitcnt lgkmcnt(6)
    v_mfma_f32_16x16x32_bf16 v[96:99], v[244:247], v[48:51], v[96:99]
    ds_read_b64_tr_b16 v[236:237], v8 offset:16928
    v_mfma_f32_16x16x32_bf16 v[100:103], v[244:247], v[52:55], v[100:103]
    ds_read_b64_tr_b16 v[238:239], v8 offset:17952
    s_waitcnt lgkmcnt(6)
    v_mfma_f32_16x16x32_bf16 v[104:107], v[224:227], v[48:51], v[104:107]
    s_add_u32 s22, s24, 0x1b2000
    s_add_u32 m0, s20, 0x1c400
    s_nop 0
    buffer_load_dwordx4 v3, s[4:7], s22 offen lds
    ds_read_b64_tr_b16 v[240:241], v7 offset:17152
    v_mfma_f32_16x16x32_bf16 v[108:111], v[224:227], v[52:55], v[108:111]
    ds_read_b64_tr_b16 v[242:243], v7 offset:18176
    s_waitcnt lgkmcnt(6)
    v_mfma_f32_16x16x32_bf16 v[112:115], v[228:231], v[48:51], v[112:115]
    ds_read_b64_tr_b16 v[244:245], v8 offset:17184
    v_mfma_f32_16x16x32_bf16 v[116:119], v[228:231], v[52:55], v[116:119]
    ds_read_b64_tr_b16 v[246:247], v8 offset:18208
    s_waitcnt lgkmcnt(6)
    v_mfma_f32_16x16x32_bf16 v[120:123], v[232:235], v[48:51], v[120:123]
    v_mfma_f32_16x16x32_bf16 v[124:127], v[232:235], v[52:55], v[124:127]
    s_waitcnt vmcnt(12)
    s_barrier
    ds_read_b64_tr_b16 v[224:225], v4 offset:0
    ds_read_b64_tr_b16 v[226:227], v4 offset:1024
    s_waitcnt lgkmcnt(6)
    v_mfma_f32_16x16x32_bf16 v[128:131], v[236:239], v[48:51], v[128:131]
    ds_read_b64_tr_b16 v[228:229], v5 offset:32
    s_mov_b32 s23, 0x6000
    buffer_load_dwordx4 v[40:43], v6, s[8:11], s23 offen offset:3072 sc1
    v_mfma_f32_16x16x32_bf16 v[132:135], v[236:239], v[52:55], v[132:135]
    ds_read_b64_tr_b16 v[230:231], v5 offset:1056
    s_waitcnt lgkmcnt(6)
    v_mfma_f32_16x16x32_bf16 v[136:139], v[240:243], v[48:51], v[136:139]
    ds_read_b64_tr_b16 v[232:233], v4 offset:256
    v_mfma_f32_16x16x32_bf16 v[140:143], v[240:243], v[52:55], v[140:143]
    ds_read_b64_tr_b16 v[234:235], v4 offset:1280
    s_mov_b32 s23, 0x26000
    buffer_load_dwordx4 v[44:47], v6, s[8:11], s23 offen offset:3072 sc1
    s_waitcnt lgkmcnt(6)
    v_mfma_f32_16x16x32_bf16 v[144:147], v[244:247], v[48:51], v[144:147]
    ds_read_b64_tr_b16 v[236:237], v5 offset:288
    v_mfma_f32_16x16x32_bf16 v[148:151], v[244:247], v[52:55], v[148:151]
    ds_read_b64_tr_b16 v[238:239], v5 offset:1312
    s_waitcnt vmcnt(13) lgkmcnt(6)
    v_mfma_f32_16x16x32_bf16 v[88:91], v[224:227], v[56:59], v[88:91]
    ds_read_b64_tr_b16 v[240:241], v4 offset:512
    s_waitcnt vmcnt(12)
    v_mfma_f32_16x16x32_bf16 v[92:95], v[224:227], v[60:63], v[92:95]
    s_add_u32 s22, s24, 0x230000
    s_add_u32 m0, s20, 0x20000
    s_nop 0
    buffer_load_dwordx4 v3, s[4:7], s22 offen lds
    ds_read_b64_tr_b16 v[242:243], v4 offset:1536
    s_waitcnt lgkmcnt(6)
    v_mfma_f32_16x16x32_bf16 v[96:99], v[228:231], v[56:59], v[96:99]
    ds_read_b64_tr_b16 v[244:245], v5 offset:544
    v_mfma_f32_16x16x32_bf16 v[100:103], v[228:231], v[60:63], v[100:103]
    ds_read_b64_tr_b16 v[246:247], v5 offset:1568
    s_waitcnt lgkmcnt(6)
    v_mfma_f32_16x16x32_bf16 v[104:107], v[232:235], v[56:59], v[104:107]
    s_add_u32 s22, s24, 0x232000
    s_add_u32 m0, s20, 0x20400
    s_nop 0
    buffer_load_dwordx4 v3, s[4:7], s22 offen lds
    ds_read_b64_tr_b16 v[224:225], v4 offset:768
    v_mfma_f32_16x16x32_bf16 v[108:111], v[232:235], v[60:63], v[108:111]
    ds_read_b64_tr_b16 v[226:227], v4 offset:1792
    s_waitcnt lgkmcnt(6)
    v_mfma_f32_16x16x32_bf16 v[112:115], v[236:239], v[56:59], v[112:115]
    ds_read_b64_tr_b16 v[228:229], v5 offset:800
    v_mfma_f32_16x16x32_bf16 v[116:119], v[236:239], v[60:63], v[116:119]
    ds_read_b64_tr_b16 v[230:231], v5 offset:1824
    s_waitcnt lgkmcnt(6)
    v_mfma_f32_16x16x32_bf16 v[120:123], v[240:243], v[56:59], v[120:123]
    v_mfma_f32_16x16x32_bf16 v[124:127], v[240:243], v[60:63], v[124:127]
    s_waitcnt vmcnt(12)
    s_barrier
    ds_read_b64_tr_b16 v[232:233], v4 offset:16384
    ds_read_b64_tr_b16 v[234:235], v4 offset:17408
    s_waitcnt lgkmcnt(6)
    v_mfma_f32_16x16x32_bf16 v[128:131], v[244:247], v[56:59], v[128:131]
    ds_read_b64_tr_b16 v[236:237], v5 offset:16416
    s_mov_b32 s23, 0x8000
    buffer_load_dwordx4 v[48:51], v6, s[8:11], s23 offen offset:3072 sc1
    v_mfma_f32_16x16x32_bf16 v[132:135], v[244:247], v[60:63], v[132:135]
    ds_read_b64_tr_b16 v[238:239], v5 offset:17440
    s_waitcnt lgkmcnt(6)
    v_mfma_f32_16x16x32_bf16 v[136:139], v[224:227], v[56:59], v[136:139]
    ds_read_b64_tr_b16 v[240:241], v4 offset:16640
    v_mfma_f32_16x16x32_bf16 v[140:143], v[224:227], v[60:63], v[140:143]
    ds_read_b64_tr_b16 v[242:243], v4 offset:17664
    s_mov_b32 s23, 0x28000
    buffer_load_dwordx4 v[52:55], v6, s[8:11], s23 offen offset:3072 sc1
    s_waitcnt lgkmcnt(6)
    v_mfma_f32_16x16x32_bf16 v[144:147], v[228:231], v[56:59], v[144:147]
    ds_read_b64_tr_b16 v[244:245], v5 offset:16672
    v_mfma_f32_16x16x32_bf16 v[148:151], v[228:231], v[60:63], v[148:151]
    ds_read_b64_tr_b16 v[246:247], v5 offset:17696
    s_waitcnt vmcnt(13) lgkmcnt(6)
    v_mfma_f32_16x16x32_bf16 v[88:91], v[232:235], v[24:27], v[88:91]
    ds_read_b64_tr_b16 v[224:225], v4 offset:16896
    s_waitcnt vmcnt(12)
    v_mfma_f32_16x16x32_bf16 v[92:95], v[232:235], v[28:31], v[92:95]
    s_add_u32 s22, s24, 0x2b0000
    s_add_u32 m0, s20, 0x24000
    s_nop 0
    buffer_load_dwordx4 v3, s[4:7], s22 offen lds
    ds_read_b64_tr_b16 v[226:227], v4 offset:17920
    s_waitcnt lgkmcnt(6)
    v_mfma_f32_16x16x32_bf16 v[96:99], v[236:239], v[24:27], v[96:99]
    ds_read_b64_tr_b16 v[228:229], v5 offset:16928
    v_mfma_f32_16x16x32_bf16 v[100:103], v[236:239], v[28:31], v[100:103]
    ds_read_b64_tr_b16 v[230:231], v5 offset:17952
    s_waitcnt lgkmcnt(6)
    v_mfma_f32_16x16x32_bf16 v[104:107], v[240:243], v[24:27], v[104:107]
    s_add_u32 s22, s24, 0x2b2000
    s_add_u32 m0, s20, 0x24400
    s_nop 0
    buffer_load_dwordx4 v3, s[4:7], s22 offen lds
    ds_read_b64_tr_b16 v[232:233], v4 offset:17152
    v_mfma_f32_16x16x32_bf16 v[108:111], v[240:243], v[28:31], v[108:111]
    ds_read_b64_tr_b16 v[234:235], v4 offset:18176
    s_waitcnt lgkmcnt(6)
    v_mfma_f32_16x16x32_bf16 v[112:115], v[244:247], v[24:27], v[112:115]
    ds_read_b64_tr_b16 v[236:237], v5 offset:17184
    v_mfma_f32_16x16x32_bf16 v[116:119], v[244:247], v[28:31], v[116:119]
    ds_read_b64_tr_b16 v[238:239], v5 offset:18208
    s_waitcnt lgkmcnt(6)
    v_mfma_f32_16x16x32_bf16 v[120:123], v[224:227], v[24:27], v[120:123]
    v_mfma_f32_16x16x32_bf16 v[124:127], v[224:227], v[28:31], v[124:127]
    s_waitcnt vmcnt(12)
    s_barrier
    ds_read_b64_tr_b16 v[240:241], v4 offset:32768
    ds_read_b64_tr_b16 v[242:243], v4 offset:33792
    s_waitcnt lgkmcnt(6)
    v_mfma_f32_16x16x32_bf16 v[128:131], v[228:231], v[24:27], v[128:131]
    ds_read_b64_tr_b16 v[244:245], v5 offset:32800
    s_mov_b32 s23, 0xa000
    buffer_load_dwordx4 v[56:59], v6, s[8:11], s23 offen offset:3072 sc1
    v_mfma_f32_16x16x32_bf16 v[132:135], v[228:231], v[28:31], v[132:135]
    ds_read_b64_tr_b16 v[246:247], v5 offset:33824
    s_waitcnt lgkmcnt(6)
    v_mfma_f32_16x16x32_bf16 v[136:139], v[232:235], v[24:27], v[136:139]
    ds_read_b64_tr_b16 v[224:225], v4 offset:33024
    v_mfma_f32_16x16x32_bf16 v[140:143], v[232:235], v[28:31], v[140:143]
    ds_read_b64_tr_b16 v[226:227], v4 offset:34048
    s_mov_b32 s23, 0x2a000
    buffer_load_dwordx4 v[60:63], v6, s[8:11], s23 offen offset:3072 sc1
    s_waitcnt lgkmcnt(6)
    v_mfma_f32_16x16x32_bf16 v[144:147], v[236:239], v[24:27], v[144:147]
    ds_read_b64_tr_b16 v[228:229], v5 offset:33056
    v_mfma_f32_16x16x32_bf16 v[148:151], v[236:239], v[28:31], v[148:151]
    ds_read_b64_tr_b16 v[230:231], v5 offset:34080
    s_waitcnt vmcnt(13) lgkmcnt(6)
    v_mfma_f32_16x16x32_bf16 v[88:91], v[240:243], v[32:35], v[88:91]
    ds_read_b64_tr_b16 v[232:233], v4 offset:33280
    s_waitcnt vmcnt(12)
    v_mfma_f32_16x16x32_bf16 v[92:95], v[240:243], v[36:39], v[92:95]
    s_add_u32 s22, s24, 0x330000
    s_add_u32 m0, s20, 0x10000
    s_nop 0
    buffer_load_dwordx4 v3, s[4:7], s22 offen lds
    ds_read_b64_tr_b16 v[234:235], v4 offset:34304
    s_waitcnt lgkmcnt(6)
    v_mfma_f32_16x16x32_bf16 v[96:99], v[244:247], v[32:35], v[96:99]
    ds_read_b64_tr_b16 v[236:237], v5 offset:33312
    v_mfma_f32_16x16x32_bf16 v[100:103], v[244:247], v[36:39], v[100:103]
    ds_read_b64_tr_b16 v[238:239], v5 offset:34336
    s_waitcnt lgkmcnt(6)
    v_mfma_f32_16x16x32_bf16 v[104:107], v[224:227], v[32:35], v[104:107]
    s_add_u32 s22, s24, 0x332000
    s_add_u32 m0, s20, 0x10400
    s_nop 0
    buffer_load_dwordx4 v3, s[4:7], s22 offen lds
    ds_read_b64_tr_b16 v[240:241], v4 offset:33536
    v_mfma_f32_16x16x32_bf16 v[108:111], v[224:227], v[36:39], v[108:111]
    ds_read_b64_tr_b16 v[242:243], v4 offset:34560
    v_lshrrev_b32 v16, 4, v1
    v_lshlrev_b32 v16, 3, v16
    s_lshl_b32 s16, s31, 8
    s_add_u32 s16, s16, 0x540080
    buffer_load_dwordx2 v[248:249], v16, s[8:11], s16 offen offset:0 sc1
    buffer_load_dwordx2 v[250:251], v16, s[8:11], s16 offen offset:32 sc1
    buffer_load_dwordx2 v[252:253], v16, s[8:11], s16 offen offset:64 sc1
    buffer_load_dwordx2 v[254:255], v16, s[8:11], s16 offen offset:96 sc1
    s_waitcnt lgkmcnt(6)
    v_mfma_f32_16x16x32_bf16 v[112:115], v[228:231], v[32:35], v[112:115]
    ds_read_b64_tr_b16 v[244:245], v5 offset:33568
    v_mfma_f32_16x16x32_bf16 v[116:119], v[228:231], v[36:39], v[116:119]
    ds_read_b64_tr_b16 v[246:247], v5 offset:34592
    s_waitcnt lgkmcnt(6)
    v_mfma_f32_16x16x32_bf16 v[120:123], v[232:235], v[32:35], v[120:123]
    v_mfma_f32_16x16x32_bf16 v[124:127], v[232:235], v[36:39], v[124:127]
    s_waitcnt vmcnt(16)
    s_barrier
    ds_read_b64_tr_b16 v[224:225], v4 offset:49152
    ds_read_b64_tr_b16 v[226:227], v4 offset:50176
    s_waitcnt lgkmcnt(6)
    v_mfma_f32_16x16x32_bf16 v[128:131], v[236:239], v[32:35], v[128:131]
    ds_read_b64_tr_b16 v[228:229], v5 offset:49184
    s_mov_b32 s23, 0xc000
    buffer_load_dwordx4 v[24:27], v6, s[8:11], s23 offen offset:3072 sc1
    v_mfma_f32_16x16x32_bf16 v[132:135], v[236:239], v[36:39], v[132:135]
    ds_read_b64_tr_b16 v[230:231], v5 offset:50208
    s_waitcnt lgkmcnt(6)
    v_mfma_f32_16x16x32_bf16 v[136:139], v[240:243], v[32:35], v[136:139]
    ds_read_b64_tr_b16 v[232:233], v4 offset:49408
    v_mfma_f32_16x16x32_bf16 v[140:143], v[240:243], v[36:39], v[140:143]
    ds_read_b64_tr_b16 v[234:235], v4 offset:50432
    s_mov_b32 s23, 0x2c000
    buffer_load_dwordx4 v[28:31], v6, s[8:11], s23 offen offset:3072 sc1
    s_waitcnt lgkmcnt(6)
    v_mfma_f32_16x16x32_bf16 v[144:147], v[244:247], v[32:35], v[144:147]
    ds_read_b64_tr_b16 v[236:237], v5 offset:49440
    v_mfma_f32_16x16x32_bf16 v[148:151], v[244:247], v[36:39], v[148:151]
    ds_read_b64_tr_b16 v[238:239], v5 offset:50464
    s_waitcnt vmcnt(17) lgkmcnt(6)
    v_mfma_f32_16x16x32_bf16 v[88:91], v[224:227], v[40:43], v[88:91]
    ds_read_b64_tr_b16 v[240:241], v4 offset:49664
    s_waitcnt vmcnt(16)
    v_mfma_f32_16x16x32_bf16 v[92:95], v[224:227], v[44:47], v[92:95]
    s_add_u32 s22, s24, 0x3b0000
    s_add_u32 m0, s20, 0x14000
    s_nop 0
    buffer_load_dwordx4 v3, s[4:7], s22 offen lds
    ds_read_b64_tr_b16 v[242:243], v4 offset:50688
    s_waitcnt lgkmcnt(6)
    v_mfma_f32_16x16x32_bf16 v[96:99], v[228:231], v[40:43], v[96:99]
    ds_read_b64_tr_b16 v[244:245], v5 offset:49696
    v_mfma_f32_16x16x32_bf16 v[100:103], v[228:231], v[44:47], v[100:103]
    ds_read_b64_tr_b16 v[246:247], v5 offset:50720
    s_waitcnt lgkmcnt(6)
    v_mfma_f32_16x16x32_bf16 v[104:107], v[232:235], v[40:43], v[104:107]
    s_add_u32 s22, s24, 0x3b2000
    s_add_u32 m0, s20, 0x14400
    s_nop 0
    buffer_load_dwordx4 v3, s[4:7], s22 offen lds
    ds_read_b64_tr_b16 v[224:225], v4 offset:49920
    v_mfma_f32_16x16x32_bf16 v[108:111], v[232:235], v[44:47], v[108:111]
    ds_read_b64_tr_b16 v[226:227], v4 offset:50944
    s_waitcnt lgkmcnt(6)
    v_mfma_f32_16x16x32_bf16 v[112:115], v[236:239], v[40:43], v[112:115]
    ds_read_b64_tr_b16 v[228:229], v5 offset:49952
    v_mfma_f32_16x16x32_bf16 v[116:119], v[236:239], v[44:47], v[116:119]
    ds_read_b64_tr_b16 v[230:231], v5 offset:50976
    s_waitcnt lgkmcnt(6)
    v_mfma_f32_16x16x32_bf16 v[120:123], v[240:243], v[40:43], v[120:123]
    v_mfma_f32_16x16x32_bf16 v[124:127], v[240:243], v[44:47], v[124:127]
    s_waitcnt vmcnt(16)
    s_barrier
    ds_read_b64_tr_b16 v[232:233], v7 offset:0
    ds_read_b64_tr_b16 v[234:235], v7 offset:1024
    s_waitcnt lgkmcnt(6)
    v_mfma_f32_16x16x32_bf16 v[128:131], v[244:247], v[40:43], v[128:131]
    ds_read_b64_tr_b16 v[236:237], v8 offset:32
    s_mov_b32 s23, 0xe000
    buffer_load_dwordx4 v[32:35], v6, s[8:11], s23 offen offset:3072 sc1
    v_mfma_f32_16x16x32_bf16 v[132:135], v[244:247], v[44:47], v[132:135]
    ds_read_b64_tr_b16 v[238:239], v8 offset:1056
    s_waitcnt lgkmcnt(6)
    v_mfma_f32_16x16x32_bf16 v[136:139], v[224:227], v[40:43], v[136:139]
    ds_read_b64_tr_b16 v[240:241], v7 offset:256
    v_mfma_f32_16x16x32_bf16 v[140:143], v[224:227], v[44:47], v[140:143]
    ds_read_b64_tr_b16 v[242:243], v7 offset:1280
    s_mov_b32 s23, 0x2e000
    buffer_load_dwordx4 v[36:39], v6, s[8:11], s23 offen offset:3072 sc1
    s_waitcnt lgkmcnt(6)
    v_mfma_f32_16x16x32_bf16 v[144:147], v[228:231], v[40:43], v[144:147]
    ds_read_b64_tr_b16 v[244:245], v8 offset:288
    v_mfma_f32_16x16x32_bf16 v[148:151], v[228:231], v[44:47], v[148:151]
    ds_read_b64_tr_b16 v[246:247], v8 offset:1312
    s_waitcnt vmcnt(17) lgkmcnt(6)
    v_mfma_f32_16x16x32_bf16 v[88:91], v[232:235], v[48:51], v[88:91]
    ds_read_b64_tr_b16 v[224:225], v7 offset:512
    s_waitcnt vmcnt(16)
    v_mfma_f32_16x16x32_bf16 v[92:95], v[232:235], v[52:55], v[92:95]
    ds_read_b64_tr_b16 v[226:227], v7 offset:1536
    s_waitcnt lgkmcnt(6)
    v_mfma_f32_16x16x32_bf16 v[96:99], v[236:239], v[48:51], v[96:99]
    ds_read_b64_tr_b16 v[228:229], v8 offset:544
    v_mfma_f32_16x16x32_bf16 v[100:103], v[236:239], v[52:55], v[100:103]
    ds_read_b64_tr_b16 v[230:231], v8 offset:1568
    s_waitcnt lgkmcnt(6)
    v_mfma_f32_16x16x32_bf16 v[104:107], v[240:243], v[48:51], v[104:107]
    ds_read_b64_tr_b16 v[232:233], v7 offset:768
    v_mfma_f32_16x16x32_bf16 v[108:111], v[240:243], v[52:55], v[108:111]
    ds_read_b64_tr_b16 v[234:235], v7 offset:1792
    s_waitcnt lgkmcnt(6)
    v_mfma_f32_16x16x32_bf16 v[112:115], v[244:247], v[48:51], v[112:115]
    ds_read_b64_tr_b16 v[236:237], v8 offset:800
    v_mfma_f32_16x16x32_bf16 v[116:119], v[244:247], v[52:55], v[116:119]
    ds_read_b64_tr_b16 v[238:239], v8 offset:1824
    s_waitcnt lgkmcnt(6)
    v_mfma_f32_16x16x32_bf16 v[120:123], v[224:227], v[48:51], v[120:123]
    s_mov_b64 s[72:73], s[48:49]
    s_mov_b32 s74, 0x700000
    s_mov_b32 s75, 0x20000
    s_cmp_lt_u32 s2, 224
    s_cselect_b32 s74, 7340032, 0
    s_sub_u32 s16, s3, 4
    v_lshrrev_b32 v20, 3, v1
    v_lshlrev_b32 v20, 3, v20
    s_lshl_b32 s17, s16, 6
    v_add_u32 v20, s17, v20
    s_mov_b32 s17, 7168
    v_mul_lo_u32 v21, s17, v20
    v_and_b32 v20, 7, v1
    v_lshl_add_u32 v21, v20, 4, v21
    s_and_b32 s17, s29, 3
    s_mul_i32 s18, s17, 1835008
    s_lshr_b32 s17, s29, 2
    s_lshl_b32 s17, s17, 7
    s_add_u32 s18, s18, s17
    s_lshl_b32 s16, s16, 13
    s_add_u32 s22, s18, 0
    s_add_u32 m0, s16, 32768
    s_nop 0
    buffer_load_dwordx4 v21, s[72:75], s22 offen lds
    s_add_u32 s22, s18, 7168
    s_add_u32 m0, s16, 33792
    s_nop 0
    buffer_load_dwordx4 v21, s[72:75], s22 offen lds
    s_add_u32 s22, s18, 14336
    s_add_u32 m0, s16, 34816
    s_nop 0
    buffer_load_dwordx4 v21, s[72:75], s22 offen lds
    s_add_u32 s22, s18, 21504
    s_add_u32 m0, s16, 35840
    s_nop 0
    buffer_load_dwordx4 v21, s[72:75], s22 offen lds
    s_add_u32 s22, s18, 28672
    s_add_u32 m0, s16, 36864
    s_nop 0
    buffer_load_dwordx4 v21, s[72:75], s22 offen lds
    s_add_u32 s22, s18, 35840
    s_add_u32 m0, s16, 37888
    s_nop 0
    buffer_load_dwordx4 v21, s[72:75], s22 offen lds
    s_add_u32 s22, s18, 43008
    s_add_u32 m0, s16, 38912
    s_nop 0
    buffer_load_dwordx4 v21, s[72:75], s22 offen lds
    s_add_u32 s22, s18, 50176
    s_add_u32 m0, s16, 39936
    s_nop 0
    buffer_load_dwordx4 v21, s[72:75], s22 offen lds
    v_mfma_f32_16x16x32_bf16 v[124:127], v[224:227], v[52:55], v[124:127]
    s_waitcnt vmcnt(22)
    s_barrier
    ds_read_b64_tr_b16 v[240:241], v7 offset:16384
    ds_read_b64_tr_b16 v[242:243], v7 offset:17408
    s_waitcnt lgkmcnt(6)
    v_mfma_f32_16x16x32_bf16 v[128:131], v[228:231], v[48:51], v[128:131]
    ds_read_b64_tr_b16 v[244:245], v8 offset:16416
    v_mfma_f32_16x16x32_bf16 v[132:135], v[228:231], v[52:55], v[132:135]
    ds_read_b64_tr_b16 v[246:247], v8 offset:17440
    s_waitcnt lgkmcnt(6)
    v_mfma_f32_16x16x32_bf16 v[136:139], v[232:235], v[48:51], v[136:139]
    ds_read_b64_tr_b16 v[224:225], v7 offset:16640
    v_mfma_f32_16x16x32_bf16 v[140:143], v[232:235], v[52:55], v[140:143]
    ds_read_b64_tr_b16 v[226:227], v7 offset:17664
    s_waitcnt lgkmcnt(6)
    v_mfma_f32_16x16x32_bf16 v[144:147], v[236:239], v[48:51], v[144:147]
    ds_read_b64_tr_b16 v[228:229], v8 offset:16672
    v_mfma_f32_16x16x32_bf16 v[148:151], v[236:239], v[52:55], v[148:151]
    ds_read_b64_tr_b16 v[230:231], v8 offset:17696
    s_waitcnt vmcnt(21) lgkmcnt(6)
    v_mfma_f32_16x16x32_bf16 v[88:91], v[240:243], v[56:59], v[88:91]
    ds_read_b64_tr_b16 v[232:233], v7 offset:16896
    s_waitcnt vmcnt(20)
    v_mfma_f32_16x16x32_bf16 v[92:95], v[240:243], v[60:63], v[92:95]
    ds_read_b64_tr_b16 v[234:235], v7 offset:17920
    s_waitcnt lgkmcnt(6)
    v_mfma_f32_16x16x32_bf16 v[96:99], v[244:247], v[56:59], v[96:99]
    ds_read_b64_tr_b16 v[236:237], v8 offset:16928
    v_mfma_f32_16x16x32_bf16 v[100:103], v[244:247], v[60:63], v[100:103]
    ds_read_b64_tr_b16 v[238:239], v8 offset:17952
    s_waitcnt lgkmcnt(6)
    v_mfma_f32_16x16x32_bf16 v[104:107], v[224:227], v[56:59], v[104:107]
    ds_read_b64_tr_b16 v[240:241], v7 offset:17152
    v_mfma_f32_16x16x32_bf16 v[108:111], v[224:227], v[60:63], v[108:111]
    ds_read_b64_tr_b16 v[242:243], v7 offset:18176
    s_waitcnt lgkmcnt(6)
    v_mfma_f32_16x16x32_bf16 v[112:115], v[228:231], v[56:59], v[112:115]
    ds_read_b64_tr_b16 v[244:245], v8 offset:17184
    v_mfma_f32_16x16x32_bf16 v[116:119], v[228:231], v[60:63], v[116:119]
    ds_read_b64_tr_b16 v[246:247], v8 offset:18208
    s_waitcnt lgkmcnt(6)
    v_mfma_f32_16x16x32_bf16 v[120:123], v[232:235], v[56:59], v[120:123]
    v_mfma_f32_16x16x32_bf16 v[124:127], v[232:235], v[60:63], v[124:127]
    s_waitcnt vmcnt(18)
    s_barrier
    ds_read_b64_tr_b16 v[224:225], v4 offset:0
    ds_read_b64_tr_b16 v[226:227], v4 offset:1024
    s_waitcnt lgkmcnt(6)
    v_mfma_f32_16x16x32_bf16 v[128:131], v[236:239], v[56:59], v[128:131]
    ds_read_b64_tr_b16 v[228:229], v5 offset:32
    v_mfma_f32_16x16x32_bf16 v[132:135], v[236:239], v[60:63], v[132:135]
    ds_read_b64_tr_b16 v[230:231], v5 offset:1056
    s_waitcnt lgkmcnt(6)
    v_mfma_f32_16x16x32_bf16 v[136:139], v[240:243], v[56:59], v[136:139]
    ds_read_b64_tr_b16 v[232:233], v4 offset:256
    v_mfma_f32_16x16x32_bf16 v[140:143], v[240:243], v[60:63], v[140:143]
    ds_read_b64_tr_b16 v[234:235], v4 offset:1280
    s_waitcnt lgkmcnt(6)
    v_mfma_f32_16x16x32_bf16 v[144:147], v[244:247], v[56:59], v[144:147]
    ds_read_b64_tr_b16 v[236:237], v5 offset:288
    v_mfma_f32_16x16x32_bf16 v[148:151], v[244:247], v[60:63], v[148:151]
    ds_read_b64_tr_b16 v[238:239], v5 offset:1312
    s_waitcnt vmcnt(13) lgkmcnt(6)
    v_mfma_f32_16x16x32_bf16 v[88:91], v[224:227], v[24:27], v[88:91]
    ds_read_b64_tr_b16 v[240:241], v4 offset:512
    s_waitcnt vmcnt(12)
    v_mfma_f32_16x16x32_bf16 v[92:95], v[224:227], v[28:31], v[92:95]
    ds_read_b64_tr_b16 v[242:243], v4 offset:1536
    s_waitcnt lgkmcnt(6)
    v_mfma_f32_16x16x32_bf16 v[96:99], v[228:231], v[24:27], v[96:99]
    ds_read_b64_tr_b16 v[244:245], v5 offset:544
    v_mfma_f32_16x16x32_bf16 v[100:103], v[228:231], v[28:31], v[100:103]
    ds_read_b64_tr_b16 v[246:247], v5 offset:1568
    s_waitcnt lgkmcnt(6)
    v_mfma_f32_16x16x32_bf16 v[104:107], v[232:235], v[24:27], v[104:107]
    ds_read_b64_tr_b16 v[224:225], v4 offset:768
    v_mfma_f32_16x16x32_bf16 v[108:111], v[232:235], v[28:31], v[108:111]
    ds_read_b64_tr_b16 v[226:227], v4 offset:1792
    s_waitcnt lgkmcnt(6)
    v_mfma_f32_16x16x32_bf16 v[112:115], v[236:239], v[24:27], v[112:115]
    ds_read_b64_tr_b16 v[228:229], v5 offset:800
    v_mfma_f32_16x16x32_bf16 v[116:119], v[236:239], v[28:31], v[116:119]
    ds_read_b64_tr_b16 v[230:231], v5 offset:1824
    s_waitcnt lgkmcnt(6)
    v_mfma_f32_16x16x32_bf16 v[120:123], v[240:243], v[24:27], v[120:123]
    v_mfma_f32_16x16x32_bf16 v[124:127], v[240:243], v[28:31], v[124:127]
    s_waitcnt vmcnt(10)
    s_barrier
    ds_read_b64_tr_b16 v[232:233], v4 offset:16384
    ds_read_b64_tr_b16 v[234:235], v4 offset:17408
    s_waitcnt lgkmcnt(6)
    v_mfma_f32_16x16x32_bf16 v[128:131], v[244:247], v[24:27], v[128:131]
    ds_read_b64_tr_b16 v[236:237], v5 offset:16416
    v_mfma_f32_16x16x32_bf16 v[132:135], v[244:247], v[28:31], v[132:135]
    ds_read_b64_tr_b16 v[238:239], v5 offset:17440
    s_waitcnt lgkmcnt(6)
    v_mfma_f32_16x16x32_bf16 v[136:139], v[224:227], v[24:27], v[136:139]
    ds_read_b64_tr_b16 v[240:241], v4 offset:16640
    v_mfma_f32_16x16x32_bf16 v[140:143], v[224:227], v[28:31], v[140:143]
    ds_read_b64_tr_b16 v[242:243], v4 offset:17664
    s_waitcnt lgkmcnt(6)
    v_mfma_f32_16x16x32_bf16 v[144:147], v[228:231], v[24:27], v[144:147]
    ds_read_b64_tr_b16 v[244:245], v5 offset:16672
    v_mfma_f32_16x16x32_bf16 v[148:151], v[228:231], v[28:31], v[148:151]
    ds_read_b64_tr_b16 v[246:247], v5 offset:17696
    s_waitcnt vmcnt(9) lgkmcnt(6)
    v_mfma_f32_16x16x32_bf16 v[88:91], v[232:235], v[32:35], v[88:91]
    ds_read_b64_tr_b16 v[224:225], v4 offset:16896
    s_waitcnt vmcnt(8)
    v_mfma_f32_16x16x32_bf16 v[92:95], v[232:235], v[36:39], v[92:95]
    ds_read_b64_tr_b16 v[226:227], v4 offset:17920
    s_waitcnt lgkmcnt(6)
    v_mfma_f32_16x16x32_bf16 v[96:99], v[236:239], v[32:35], v[96:99]
    ds_read_b64_tr_b16 v[228:229], v5 offset:16928
    v_mfma_f32_16x16x32_bf16 v[100:103], v[236:239], v[36:39], v[100:103]
    ds_read_b64_tr_b16 v[230:231], v5 offset:17952
    s_waitcnt lgkmcnt(6)
    v_mfma_f32_16x16x32_bf16 v[104:107], v[240:243], v[32:35], v[104:107]
    ds_read_b64_tr_b16 v[232:233], v4 offset:17152
    v_mfma_f32_16x16x32_bf16 v[108:111], v[240:243], v[36:39], v[108:111]
    ds_read_b64_tr_b16 v[234:235], v4 offset:18176
    s_waitcnt lgkmcnt(6)
    v_mfma_f32_16x16x32_bf16 v[112:115], v[244:247], v[32:35], v[112:115]
    ds_read_b64_tr_b16 v[236:237], v5 offset:17184
    v_mfma_f32_16x16x32_bf16 v[116:119], v[244:247], v[36:39], v[116:119]
    ds_read_b64_tr_b16 v[238:239], v5 offset:18208
    s_waitcnt lgkmcnt(6)
    v_mfma_f32_16x16x32_bf16 v[120:123], v[224:227], v[32:35], v[120:123]
    v_mfma_f32_16x16x32_bf16 v[124:127], v[224:227], v[36:39], v[124:127]
    s_waitcnt lgkmcnt(4)
    v_mfma_f32_16x16x32_bf16 v[128:131], v[228:231], v[32:35], v[128:131]
    v_mfma_f32_16x16x32_bf16 v[132:135], v[228:231], v[36:39], v[132:135]
    s_waitcnt lgkmcnt(2)
    v_mfma_f32_16x16x32_bf16 v[136:139], v[232:235], v[32:35], v[136:139]
    v_mfma_f32_16x16x32_bf16 v[140:143], v[232:235], v[36:39], v[140:143]
    s_waitcnt lgkmcnt(0)
    v_mfma_f32_16x16x32_bf16 v[144:147], v[236:239], v[32:35], v[144:147]
    v_mfma_f32_16x16x32_bf16 v[148:151], v[236:239], v[36:39], v[148:151]
    s_lshl_b32 s16, s3, 13
    s_xor_b32 s17, s16, 0x8000
    s_add_u32 s16, s16, 0x18000
    s_add_u32 s17, s17, 0x18000
    v_add_u32 v16, s16, v2
    s_mov_b32 s16, s17
    v_add_u32 v17, s16, v2
    ds_write_b128 v16, v[88:91] offset:0
    ds_write_b128 v16, v[92:95] offset:1024
    ds_write_b128 v16, v[96:99] offset:2048
    ds_write_b128 v16, v[100:103] offset:3072
    ds_write_b128 v16, v[104:107] offset:4096
    ds_write_b128 v16, v[108:111] offset:5120
    ds_write_b128 v16, v[112:115] offset:6144
    ds_write_b128 v16, v[116:119] offset:7168
    v_lshlrev_b32 v24, 16, v248
    v_and_b32 v25, 0xffff0000, v248
    v_lshlrev_b32 v26, 16, v249
    v_and_b32 v27, 0xffff0000, v249
    v_lshlrev_b32 v28, 16, v250
    v_and_b32 v29, 0xffff0000, v250
    v_lshlrev_b32 v30, 16, v251
    v_and_b32 v31, 0xffff0000, v251
    v_lshlrev_b32 v32, 16, v252
    v_and_b32 v33, 0xffff0000, v252
    v_lshlrev_b32 v34, 16, v253
    v_and_b32 v35, 0xffff0000, v253
    v_lshlrev_b32 v36, 16, v254
    v_and_b32 v37, 0xffff0000, v254
    v_lshlrev_b32 v38, 16, v255
    v_and_b32 v39, 0xffff0000, v255
    v_and_b32 v18, 15, v1
    v_lshlrev_b32 v18, 6, v18
    v_lshrrev_b32 v19, 4, v1
    v_and_b32 v20, 1, v19
    v_lshl_add_u32 v18, v20, 5, v18
    v_lshrrev_b32 v19, 1, v19
    v_lshl_add_u32 v18, v19, 4, v18
    s_and_b32 s17, s3, 3
    s_lshl_b32 s18, s30, 2
    s_add_u32 s18, s18, s17
    s_lshl_b32 s18, s18, 16
    s_lshl_b32 s19, s15, 22
    s_add_u32 s18, s18, s19
    s_lshl_b32 s19, s31, 12
    s_add_u32 s18, s18, s19
    s_add_u32 s18, s18, 0x2c00800
    s_add_u32 s19, s18, 32768
    s_waitcnt lgkmcnt(0)
    s_barrier
    ds_read_b128 v[40:43], v17 offset:0
    ds_read_b128 v[44:47], v17 offset:1024
    ds_read_b128 v[48:51], v17 offset:2048
    ds_read_b128 v[52:55], v17 offset:3072
    ds_read_b128 v[56:59], v17 offset:4096
    ds_read_b128 v[60:63], v17 offset:5120
    ds_read_b128 v[64:67], v17 offset:6144
    ds_read_b128 v[68:71], v17 offset:7168
    s_waitcnt lgkmcnt(7)
    v_pk_add_f32 v[120:121], v[120:121], v[40:41]
    v_pk_add_f32 v[122:123], v[122:123], v[42:43]
    v_pk_mul_f32 v[120:121], v[120:121], v[24:25]
    v_pk_mul_f32 v[122:123], v[122:123], v[26:27]
    v_cvt_pk_bf16_f32 v224, v120, v121
    v_cvt_pk_bf16_f32 v225, v122, v123
    s_waitcnt lgkmcnt(5)
    v_pk_add_f32 v[128:129], v[128:129], v[48:49]
    v_pk_add_f32 v[130:131], v[130:131], v[50:51]
    v_pk_mul_f32 v[128:129], v[128:129], v[28:29]
    v_pk_mul_f32 v[130:131], v[130:131], v[30:31]
    v_cvt_pk_bf16_f32 v226, v128, v129
    v_cvt_pk_bf16_f32 v227, v130, v131
    s_nop 0
    v_permlane16_swap_b32 v224, v226
    v_permlane16_swap_b32 v225, v227
    buffer_store_dwordx4 v[224:227], v18, s[8:11], s18 offen offset:0 sc1
    v_pk_add_f32 v[124:125], v[124:125], v[44:45]
    v_pk_add_f32 v[126:127], v[126:127], v[46:47]
    v_pk_mul_f32 v[124:125], v[124:125], v[24:25]
    v_pk_mul_f32 v[126:127], v[126:127], v[26:27]
    v_cvt_pk_bf16_f32 v228, v124, v125
    v_cvt_pk_bf16_f32 v229, v126, v127
    s_waitcnt lgkmcnt(4)
    v_pk_add_f32 v[132:133], v[132:133], v[52:53]
    v_pk_add_f32 v[134:135], v[134:135], v[54:55]
    v_pk_mul_f32 v[132:133], v[132:133], v[28:29]
    v_pk_mul_f32 v[134:135], v[134:135], v[30:31]
    v_cvt_pk_bf16_f32 v230, v132, v133
    v_cvt_pk_bf16_f32 v231, v134, v135
    s_nop 0
    v_permlane16_swap_b32 v228, v230
    v_permlane16_swap_b32 v229, v231
    buffer_store_dwordx4 v[228:231], v18, s[8:11], s19 offen offset:0 sc1
    s_waitcnt lgkmcnt(3)
    v_pk_add_f32 v[136:137], v[136:137], v[56:57]
    v_pk_add_f32 v[138:139], v[138:139], v[58:59]
    v_pk_mul_f32 v[136:137], v[136:137], v[32:33]
    v_pk_mul_f32 v[138:139], v[138:139], v[34:35]
    v_cvt_pk_bf16_f32 v232, v136, v137
    v_cvt_pk_bf16_f32 v233, v138, v139
    s_waitcnt lgkmcnt(1)
    v_pk_add_f32 v[144:145], v[144:145], v[64:65]
    v_pk_add_f32 v[146:147], v[146:147], v[66:67]
    v_pk_mul_f32 v[144:145], v[144:145], v[36:37]
    v_pk_mul_f32 v[146:147], v[146:147], v[38:39]
    v_cvt_pk_bf16_f32 v234, v144, v145
    v_cvt_pk_bf16_f32 v235, v146, v147
    s_nop 0
    v_permlane16_swap_b32 v232, v234
    v_permlane16_swap_b32 v233, v235
    buffer_store_dwordx4 v[232:235], v18, s[8:11], s18 offen offset:1024 sc1
    v_pk_add_f32 v[140:141], v[140:141], v[60:61]
    v_pk_add_f32 v[142:143], v[142:143], v[62:63]
    v_pk_mul_f32 v[140:141], v[140:141], v[32:33]
    v_pk_mul_f32 v[142:143], v[142:143], v[34:35]
    v_cvt_pk_bf16_f32 v236, v140, v141
    v_cvt_pk_bf16_f32 v237, v142, v143
    s_waitcnt lgkmcnt(0)
    v_pk_add_f32 v[148:149], v[148:149], v[68:69]
    v_pk_add_f32 v[150:151], v[150:151], v[70:71]
    v_pk_mul_f32 v[148:149], v[148:149], v[36:37]
    v_pk_mul_f32 v[150:151], v[150:151], v[38:39]
    v_cvt_pk_bf16_f32 v238, v148, v149
    v_cvt_pk_bf16_f32 v239, v150, v151
    s_nop 0
    v_permlane16_swap_b32 v236, v238
    v_permlane16_swap_b32 v237, v239
    buffer_store_dwordx4 v[236:239], v18, s[8:11], s19 offen offset:1024 sc1
    s_mov_b64 s[64:65], s[44:45]
    s_mov_b32 s66, 0x800
    s_mov_b32 s67, 0x20000
    s_mov_b64 s[76:77], s[32:33]
    s_mov_b32 s78, 0x400000
    s_mov_b32 s79, 0x20000
    s_mov_b64 s[68:69], s[56:57]
    s_mov_b32 s70, 0x400000
    s_mov_b32 s71, 0x20000
    s_lshl_b32 s14, s31, 1
    s_add_u32 s14, s14, s15
    s_lshl_b32 s14, s14, 3
    s_add_u32 s14, s14, s3
    s_lshl_b32 s16, s30, 7
    s_add_u32 s14, s14, s16
    s_lshl_b32 s16, s14, 11
    buffer_load_dwordx4 v[216:219], v2, s[76:79], s16 offen offset:0
    buffer_load_dwordx4 v[220:223], v2, s[76:79], s16 offen offset:1024
    s_lshl_b32 s16, s3, 10
    s_add_u32 m0, s16, 81920
    s_add_u32 s17, s16, 0x540800
    s_cmp_lt_u32 s3, 6
    s_cselect_b32 s17, s17, 0x7ffffff0
    s_sub_u32 s23, s16, 6144
    s_cmp_ge_u32 s3, 6
    s_cselect_b32 s23, s23, 0x7ffffff0
    s_cbranch_scc1 adaLN_cond__sliding_block_cached__moe_arch_mod__prompt_kernel_mlw
    buffer_load_dwordx4 v2, s[8:11], s17 offen sc1 lds
    s_branch adaLN_cond__sliding_block_cached__moe_arch_mod__prompt_kernel_mlj
adaLN_cond__sliding_block_cached__moe_arch_mod__prompt_kernel_mlw:
    buffer_load_dwordx4 v2, s[64:67], s23 offen lds
adaLN_cond__sliding_block_cached__moe_arch_mod__prompt_kernel_mlj:
    s_lshl_b32 s16, s30, 5
    s_lshl_b32 s17, s31, 1
    s_add_u32 s16, s16, s17
    s_add_u32 s16, s16, s15
    s_lshl_b32 s16, s16, 2
    s_add_u32 s16, s16, 0x530000
    s_cmp_eq_u32 s3, 0
    s_cselect_b32 s16, s16, 0x7ffffff0
    v_mov_b32 v16, s28
    v_mov_b32 v17, 0
    s_lshr_b32 s18, s14, 4
    s_lshl_b32 s18, s18, 15
    s_and_b32 s19, s14, 15
    s_lshl_b32 s19, s19, 6
    s_add_u32 s18, s18, s19
    s_add_u32 s18, s18, 0x2c00000
    s_add_u32 s19, s18, 16384
    v_lshrrev_b32 v18, 2, v1
    v_lshlrev_b32 v18, 10, v18
    v_and_b32 v19, 3, v1
    v_lshl_add_u32 v18, v19, 4, v18
    v_add_u32 v19, 0x400000, v18
    s_lshl_b32 s25, s30, 7
    s_add_u32 s25, s25, 0x530000
    v_and_b32 v20, 15, v1
    v_lshlrev_b32 v20, 2, v20
    s_waitcnt vmcnt(3)
    s_waitcnt vmcnt(0)
    s_barrier
    s_mov_b64 exec, 1
    buffer_store_dword v16, v17, s[8:11], s16 offen sc1
    s_mov_b64 exec, -1
    v_add_u32 v16, 81920, v2
    ds_read_b128 v[184:187], v16 offset:0
    ds_read_b128 v[188:191], v16 offset:1024
    ds_read_b128 v[192:195], v16 offset:2048
    ds_read_b128 v[196:199], v16 offset:3072
    ds_read_b128 v[200:203], v16 offset:4096
    ds_read_b128 v[204:207], v16 offset:5120
    ds_read_b128 v[208:211], v16 offset:6144
    ds_read_b128 v[212:215], v16 offset:7168
    v_mov_b32 v94, 0
    v_mov_b32 v95, 0
    s_waitcnt lgkmcnt(5)
    v_lshlrev_b32 v76, 16, v192
    v_and_b32 v77, 0xffff0000, v192
    s_waitcnt lgkmcnt(1)
    v_lshlrev_b32 v78, 16, v208
    v_and_b32 v79, 0xffff0000, v208
    v_pk_mul_f32 v[60:61], v[76:77], v[78:79]
    v_lshlrev_b32 v76, 16, v184
    v_and_b32 v77, 0xffff0000, v184
    v_fmac_f32 v94, v76, v78
    v_fmac_f32 v94, v77, v79
    v_add_f32 v95, v95, v60
    v_add_f32 v95, v95, v61
    v_lshlrev_b32 v76, 16, v193
    v_and_b32 v77, 0xffff0000, v193
    v_lshlrev_b32 v78, 16, v209
    v_and_b32 v79, 0xffff0000, v209
    v_pk_mul_f32 v[62:63], v[76:77], v[78:79]
    v_lshlrev_b32 v76, 16, v185
    v_and_b32 v77, 0xffff0000, v185
    v_fmac_f32 v94, v76, v78
    v_fmac_f32 v94, v77, v79
    v_add_f32 v95, v95, v62
    v_add_f32 v95, v95, v63
    v_lshlrev_b32 v76, 16, v194
    v_and_b32 v77, 0xffff0000, v194
    v_lshlrev_b32 v78, 16, v210
    v_and_b32 v79, 0xffff0000, v210
    v_pk_mul_f32 v[64:65], v[76:77], v[78:79]
    v_lshlrev_b32 v76, 16, v186
    v_and_b32 v77, 0xffff0000, v186
    v_fmac_f32 v94, v76, v78
    v_fmac_f32 v94, v77, v79
    v_add_f32 v95, v95, v64
    v_add_f32 v95, v95, v65
    v_lshlrev_b32 v76, 16, v195
    v_and_b32 v77, 0xffff0000, v195
    v_lshlrev_b32 v78, 16, v211
    v_and_b32 v79, 0xffff0000, v211
    v_pk_mul_f32 v[66:67], v[76:77], v[78:79]
    v_lshlrev_b32 v76, 16, v187
    v_and_b32 v77, 0xffff0000, v187
    v_fmac_f32 v94, v76, v78
    v_fmac_f32 v94, v77, v79
    v_add_f32 v95, v95, v66
    v_add_f32 v95, v95, v67
    v_lshlrev_b32 v76, 16, v196
    v_and_b32 v77, 0xffff0000, v196
    s_waitcnt lgkmcnt(0)
    v_lshlrev_b32 v78, 16, v212
    v_and_b32 v79, 0xffff0000, v212
    v_pk_mul_f32 v[68:69], v[76:77], v[78:79]
    v_lshlrev_b32 v76, 16, v188
    v_and_b32 v77, 0xffff0000, v188
    v_fmac_f32 v94, v76, v78
    v_fmac_f32 v94, v77, v79
    v_add_f32 v95, v95, v68
    v_add_f32 v95, v95, v69
    v_lshlrev_b32 v76, 16, v197
    v_and_b32 v77, 0xffff0000, v197
    v_lshlrev_b32 v78, 16, v213
    v_and_b32 v79, 0xffff0000, v213
    v_pk_mul_f32 v[70:71], v[76:77], v[78:79]
    v_lshlrev_b32 v76, 16, v189
    v_and_b32 v77, 0xffff0000, v189
    v_fmac_f32 v94, v76, v78
    v_fmac_f32 v94, v77, v79
    v_add_f32 v95, v95, v70
    v_add_f32 v95, v95, v71
    v_lshlrev_b32 v76, 16, v198
    v_and_b32 v77, 0xffff0000, v198
    v_lshlrev_b32 v78, 16, v214
    v_and_b32 v79, 0xffff0000, v214
    v_pk_mul_f32 v[72:73], v[76:77], v[78:79]
    v_lshlrev_b32 v76, 16, v190
    v_and_b32 v77, 0xffff0000, v190
    v_fmac_f32 v94, v76, v78
    v_fmac_f32 v94, v77, v79
    v_add_f32 v95, v95, v72
    v_add_f32 v95, v95, v73
    v_lshlrev_b32 v76, 16, v199
    v_and_b32 v77, 0xffff0000, v199
    v_lshlrev_b32 v78, 16, v215
    v_and_b32 v79, 0xffff0000, v215
    v_pk_mul_f32 v[74:75], v[76:77], v[78:79]
    v_lshlrev_b32 v76, 16, v191
    v_and_b32 v77, 0xffff0000, v191
    v_fmac_f32 v94, v76, v78
    v_fmac_f32 v94, v77, v79
    v_add_f32 v95, v95, v74
    v_add_f32 v95, v95, v75
    v_add_f32_dpp v94, v94, v94 row_ror:1 row_mask:0xf bank_mask:0xf
    s_nop 0
    v_add_f32_dpp v95, v95, v95 row_ror:1 row_mask:0xf bank_mask:0xf
    v_add_f32_dpp v94, v94, v94 row_ror:2 row_mask:0xf bank_mask:0xf
    s_nop 0
    v_add_f32_dpp v95, v95, v95 row_ror:2 row_mask:0xf bank_mask:0xf
    v_add_f32_dpp v94, v94, v94 row_ror:4 row_mask:0xf bank_mask:0xf
    s_nop 0
    v_add_f32_dpp v95, v95, v95 row_ror:4 row_mask:0xf bank_mask:0xf
    v_add_f32_dpp v94, v94, v94 row_ror:8 row_mask:0xf bank_mask:0xf
    s_nop 0
    v_add_f32_dpp v95, v95, v95 row_ror:8 row_mask:0xf bank_mask:0xf
    v_mov_b32 v76, v94
    s_nop 1
    v_permlane16_swap_b32 v94, v76
    v_add_f32 v94, v94, v76
    v_mov_b32 v77, v95
    s_nop 1
    v_permlane16_swap_b32 v95, v77
    v_add_f32 v95, v95, v77
    v_mov_b32 v76, v94
    s_nop 1
    v_permlane32_swap_b32 v94, v76
    v_add_f32 v94, v94, v76
    v_mov_b32 v77, v95
    s_nop 1
    v_permlane32_swap_b32 v95, v77
    v_add_f32 v95, v95, v77
    v_lshlrev_b32 v28, 16, v216
    v_and_b32 v29, 0xffff0000, v216
    v_lshlrev_b32 v30, 16, v217
    v_and_b32 v31, 0xffff0000, v217
    v_lshlrev_b32 v32, 16, v218
    v_and_b32 v33, 0xffff0000, v218
    v_lshlrev_b32 v34, 16, v219
    v_and_b32 v35, 0xffff0000, v219
    v_lshlrev_b32 v36, 16, v220
    v_and_b32 v37, 0xffff0000, v220
    v_lshlrev_b32 v38, 16, v221
    v_and_b32 v39, 0xffff0000, v221
    v_lshlrev_b32 v40, 16, v222
    v_and_b32 v41, 0xffff0000, v222
    v_lshlrev_b32 v42, 16, v223
    v_and_b32 v43, 0xffff0000, v223
    s_sleep 16
    s_mov_b32 s27, 0
adaLN_cond__sliding_block_cached__moe_arch_mod__prompt_kernel_a22p:
    buffer_load_dword v76, v20, s[8:11], s25 offen sc1
    s_waitcnt vmcnt(0)
    v_cmp_ne_u32 vcc, s28, v76
    s_add_u32 s27, s27, 1
    s_cmp_ge_u32 s27, 65536
    s_cbranch_scc1 adaLN_cond__sliding_block_cached__moe_arch_mod__prompt_kernel_a22g
    s_cbranch_vccnz adaLN_cond__sliding_block_cached__moe_arch_mod__prompt_kernel_a22p
adaLN_cond__sliding_block_cached__moe_arch_mod__prompt_kernel_a22g:
    buffer_load_dwordx4 v[44:47], v18, s[8:11], s18 offen sc1
    buffer_load_dwordx4 v[52:55], v19, s[8:11], s18 offen sc1
    buffer_load_dwordx4 v[48:51], v18, s[8:11], s19 offen sc1
    buffer_load_dwordx4 v[56:59], v19, s[8:11], s19 offen sc1
    v_lshlrev_b32 v21, 2, v0
    s_mov_b32 s16, 0x540800
    buffer_load_dword v106, v21, s[8:11], s16 offen sc1
    buffer_load_dword v104, v21, s[8:11], s16 offen offset:2048 sc1
    s_waitcnt vmcnt(5)
    v_lshlrev_b32 v76, 16, v44
    v_and_b32 v77, 0xffff0000, v44
    s_waitcnt vmcnt(4)
    v_lshlrev_b32 v78, 16, v52
    v_and_b32 v79, 0xffff0000, v52
    v_pk_add_f32 v[76:77], v[76:77], v[78:79]
    v_pk_add_f32 v[28:29], v[28:29], v[76:77]
    v_cvt_pk_bf16_f32 v16, v28, v29
    v_lshlrev_b32 v28, 16, v16
    v_and_b32 v29, 0xffff0000, v16
    v_lshlrev_b32 v80, 16, v45
    v_and_b32 v81, 0xffff0000, v45
    v_lshlrev_b32 v82, 16, v53
    v_and_b32 v83, 0xffff0000, v53
    v_pk_add_f32 v[80:81], v[80:81], v[82:83]
    v_pk_add_f32 v[30:31], v[30:31], v[80:81]
    v_cvt_pk_bf16_f32 v17, v30, v31
    v_lshlrev_b32 v30, 16, v17
    v_and_b32 v31, 0xffff0000, v17
    v_lshlrev_b32 v76, 16, v46
    v_and_b32 v77, 0xffff0000, v46
    v_lshlrev_b32 v78, 16, v54
    v_and_b32 v79, 0xffff0000, v54
    v_pk_add_f32 v[76:77], v[76:77], v[78:79]
    v_pk_add_f32 v[32:33], v[32:33], v[76:77]
    v_cvt_pk_bf16_f32 v16, v32, v33
    v_lshlrev_b32 v32, 16, v16
    v_and_b32 v33, 0xffff0000, v16
    v_lshlrev_b32 v80, 16, v47
    v_and_b32 v81, 0xffff0000, v47
    v_lshlrev_b32 v82, 16, v55
    v_and_b32 v83, 0xffff0000, v55
    v_pk_add_f32 v[80:81], v[80:81], v[82:83]
    v_pk_add_f32 v[34:35], v[34:35], v[80:81]
    v_cvt_pk_bf16_f32 v17, v34, v35
    v_lshlrev_b32 v34, 16, v17
    v_and_b32 v35, 0xffff0000, v17
    s_waitcnt vmcnt(3)
    v_lshlrev_b32 v76, 16, v48
    v_and_b32 v77, 0xffff0000, v48
    s_waitcnt vmcnt(2)
    v_lshlrev_b32 v78, 16, v56
    v_and_b32 v79, 0xffff0000, v56
    v_pk_add_f32 v[76:77], v[76:77], v[78:79]
    v_pk_add_f32 v[36:37], v[36:37], v[76:77]
    v_cvt_pk_bf16_f32 v16, v36, v37
    v_lshlrev_b32 v36, 16, v16
    v_and_b32 v37, 0xffff0000, v16
    v_lshlrev_b32 v80, 16, v49
    v_and_b32 v81, 0xffff0000, v49
    v_lshlrev_b32 v82, 16, v57
    v_and_b32 v83, 0xffff0000, v57
    v_pk_add_f32 v[80:81], v[80:81], v[82:83]
    v_pk_add_f32 v[38:39], v[38:39], v[80:81]
    v_cvt_pk_bf16_f32 v17, v38, v39
    v_lshlrev_b32 v38, 16, v17
    v_and_b32 v39, 0xffff0000, v17
    v_lshlrev_b32 v76, 16, v50
    v_and_b32 v77, 0xffff0000, v50
    v_lshlrev_b32 v78, 16, v58
    v_and_b32 v79, 0xffff0000, v58
    v_pk_add_f32 v[76:77], v[76:77], v[78:79]
    v_pk_add_f32 v[40:41], v[40:41], v[76:77]
    v_cvt_pk_bf16_f32 v16, v40, v41
    v_lshlrev_b32 v40, 16, v16
    v_and_b32 v41, 0xffff0000, v16
    v_lshlrev_b32 v80, 16, v51
    v_and_b32 v81, 0xffff0000, v51
    v_lshlrev_b32 v82, 16, v59
    v_and_b32 v83, 0xffff0000, v59
    v_pk_add_f32 v[80:81], v[80:81], v[82:83]
    v_pk_add_f32 v[42:43], v[42:43], v[80:81]
    v_cvt_pk_bf16_f32 v17, v42, v43
    v_lshlrev_b32 v42, 16, v17
    v_and_b32 v43, 0xffff0000, v17
    v_pk_add_f32 v[76:77], v[28:29], v[30:31]
    v_pk_mul_f32 v[78:79], v[28:29], v[28:29]
    v_pk_mul_f32 v[80:81], v[28:29], v[60:61]
    v_pk_fma_f32 v[78:79], v[30:31], v[30:31], v[78:79]
    v_pk_fma_f32 v[80:81], v[30:31], v[62:63], v[80:81]
    v_pk_add_f32 v[76:77], v[76:77], v[32:33]
    v_pk_fma_f32 v[78:79], v[32:33], v[32:33], v[78:79]
    v_pk_fma_f32 v[80:81], v[32:33], v[64:65], v[80:81]
    v_pk_add_f32 v[76:77], v[76:77], v[34:35]
    v_pk_fma_f32 v[78:79], v[34:35], v[34:35], v[78:79]
    v_pk_fma_f32 v[80:81], v[34:35], v[66:67], v[80:81]
    v_pk_add_f32 v[76:77], v[76:77], v[36:37]
    v_pk_fma_f32 v[78:79], v[36:37], v[36:37], v[78:79]
    v_pk_fma_f32 v[80:81], v[36:37], v[68:69], v[80:81]
    v_pk_add_f32 v[76:77], v[76:77], v[38:39]
    v_pk_fma_f32 v[78:79], v[38:39], v[38:39], v[78:79]
    v_pk_fma_f32 v[80:81], v[38:39], v[70:71], v[80:81]
    v_pk_add_f32 v[76:77], v[76:77], v[40:41]
    v_pk_fma_f32 v[78:79], v[40:41], v[40:41], v[78:79]
    v_pk_fma_f32 v[80:81], v[40:41], v[72:73], v[80:81]
    v_pk_add_f32 v[76:77], v[76:77], v[42:43]
    v_pk_fma_f32 v[78:79], v[42:43], v[42:43], v[78:79]
    v_pk_fma_f32 v[80:81], v[42:43], v[74:75], v[80:81]
    v_add_f32 v96, v76, v77
    v_add_f32 v97, v78, v79
    v_add_f32 v98, v80, v81
    v_add_f32_dpp v96, v96, v96 row_ror:1 row_mask:0xf bank_mask:0xf
    v_add_f32_dpp v97, v97, v97 row_ror:1 row_mask:0xf bank_mask:0xf
    v_add_f32_dpp v98, v98, v98 row_ror:1 row_mask:0xf bank_mask:0xf
    v_add_f32_dpp v96, v96, v96 row_ror:2 row_mask:0xf bank_mask:0xf
    v_add_f32_dpp v97, v97, v97 row_ror:2 row_mask:0xf bank_mask:0xf
    v_add_f32_dpp v98, v98, v98 row_ror:2 row_mask:0xf bank_mask:0xf
    v_add_f32_dpp v96, v96, v96 row_ror:4 row_mask:0xf bank_mask:0xf
    v_add_f32_dpp v97, v97, v97 row_ror:4 row_mask:0xf bank_mask:0xf
    v_add_f32_dpp v98, v98, v98 row_ror:4 row_mask:0xf bank_mask:0xf
    v_add_f32_dpp v96, v96, v96 row_ror:8 row_mask:0xf bank_mask:0xf
    v_add_f32_dpp v97, v97, v97 row_ror:8 row_mask:0xf bank_mask:0xf
    v_add_f32_dpp v98, v98, v98 row_ror:8 row_mask:0xf bank_mask:0xf
    v_mov_b32 v76, v96
    s_nop 1
    v_permlane16_swap_b32 v96, v76
    v_add_f32 v96, v96, v76
    v_mov_b32 v77, v97
    s_nop 1
    v_permlane16_swap_b32 v97, v77
    v_add_f32 v97, v97, v77
    v_mov_b32 v78, v98
    s_nop 1
    v_permlane16_swap_b32 v98, v78
    v_add_f32 v98, v98, v78
    v_mov_b32 v76, v96
    s_nop 1
    v_permlane32_swap_b32 v96, v76
    v_add_f32 v96, v96, v76
    v_mov_b32 v77, v97
    s_nop 1
    v_permlane32_swap_b32 v97, v77
    v_add_f32 v97, v97, v77
    v_mov_b32 v78, v98
    s_nop 1
    v_permlane32_swap_b32 v98, v78
    v_add_f32 v98, v98, v78
    v_mul_f32 v96, 0x3a800000, v96
    v_mul_f32 v97, 0x3a800000, v97
    v_fma_f32 v97, -v96, v96, v97
    v_max_f32 v97, 0, v97
    v_fma_f32 v98, -v96, v95, v98
    v_add_f32 v76, 0x3727c5ac, v97
    v_rsq_f32 v76, v76
    s_nop 0
    v_fma_f32 v27, v98, v76, v94
    v_cvt_pk_bf16_f32 v96, v96, v96
    v_lshlrev_b32 v96, 16, v96
    v_cvt_pk_bf16_f32 v97, v97, v97
    v_lshlrev_b32 v97, 16, v97
    v_add_f32 v97, 0x3727c5ac, v97
    v_cvt_pk_bf16_f32 v97, v97, v97
    v_lshlrev_b32 v97, 16, v97
    v_sqrt_f32 v98, v97
    s_nop 0
    v_cvt_pk_bf16_f32 v98, v98, v98
    v_lshlrev_b32 v98, 16, v98
    v_rcp_f32 v99, v98
    v_mov_b32 v25, v96
    v_mov_b32 v26, v98
    v_ashrrev_i32 v16, 31, v27
    v_or_b32 v16, 0x80000000, v16
    v_xor_b32 v24, v27, v16
    v_and_b32 v24, 0xfffff800, v24
    v_max_u32 v24, 0x800, v24
    s_sub_u32 s16, 2047, s14
    v_or_b32 v24, s16, v24
    s_lshl_b32 s16, s3, 4
    s_add_u32 s16, s16, 65536
    v_mov_b32 v16, s16
    ds_write_b128 v16, v[24:27]
    s_waitcnt lgkmcnt(0)
    s_barrier
    v_and_b32 v16, 7, v1
    v_lshlrev_b32 v16, 4, v16
    v_add_u32 v16, 65536, v16
    ds_read_b32 v76, v16
    s_waitcnt lgkmcnt(0)
    v_mov_b32 v77, v76
    s_nop 1
    v_max_u32_dpp v77, v77, v77 row_ror:1 row_mask:0xf bank_mask:0xf
    s_nop 1
    v_max_u32_dpp v77, v77, v77 row_ror:2 row_mask:0xf bank_mask:0xf
    s_nop 1
    v_max_u32_dpp v77, v77, v77 row_ror:4 row_mask:0xf bank_mask:0xf
    v_cmp_eq_u32 vcc, v76, v77
    s_ff1_i32_b64 s16, vcc
    s_lshl_b32 s16, s16, 4
    s_add_u32 s16, s16, 65536
    v_mov_b32 v16, s16
    ds_read_b128 v[24:27], v16
    s_lshl_b32 s16, s2, 4
    s_add_u32 s16, s16, 0x6e0000
    s_cmp_eq_u32 s3, 0
    s_cselect_b32 s16, s16, 0x7ffffff0
    v_mov_b32 v17, 0
    s_mov_b64 exec, 1
    s_waitcnt lgkmcnt(0)
    buffer_store_dwordx4 v[24:27], v17, s[8:11], s16 offen sc1
    s_mov_b64 exec, -1
    s_mov_b64 s[72:73], s[50:51]
    s_mov_b32 s74, 0x700000
    s_mov_b32 s75, 0x20000
    s_cmp_lt_u32 s2, 224
    s_cselect_b32 s74, 7340032, 0
    s_lshl_b32 s17, s29, 4
    s_sub_u32 s16, s3, 4
    s_lshl_b32 s16, s16, 2
    s_add_u32 s16, s16, s17
    s_lshl_b32 s16, s16, 11
    s_add_u32 s17, s16, 0
    buffer_load_dwordx4 v[152:155], v2, s[72:75], s17 offen offset:0
    buffer_load_dwordx4 v[156:159], v2, s[72:75], s17 offen offset:1024
    s_add_u32 s17, s16, 2048
    buffer_load_dwordx4 v[160:163], v2, s[72:75], s17 offen offset:0
    buffer_load_dwordx4 v[164:167], v2, s[72:75], s17 offen offset:1024
    s_add_u32 s17, s16, 4096
    buffer_load_dwordx4 v[168:171], v2, s[72:75], s17 offen offset:0
    buffer_load_dwordx4 v[172:175], v2, s[72:75], s17 offen offset:1024
    s_add_u32 s17, s16, 6144
    buffer_load_dwordx4 v[176:179], v2, s[72:75], s17 offen offset:0
    buffer_load_dwordx4 v[180:183], v2, s[72:75], s17 offen offset:1024
    v_sub_f32 v44, v28, v96
    v_sub_f32 v45, v29, v96
    v_sub_f32 v46, v30, v96
    v_sub_f32 v47, v31, v96
    v_sub_f32 v48, v32, v96
    v_sub_f32 v49, v33, v96
    v_sub_f32 v50, v34, v96
    v_sub_f32 v51, v35, v96
    v_cvt_pk_bf16_f32 v16, v44, v45
    v_lshlrev_b32 v44, 16, v16
    v_and_b32 v45, 0xffff0000, v16
    v_cvt_pk_bf16_f32 v16, v46, v47
    v_lshlrev_b32 v46, 16, v16
    v_and_b32 v47, 0xffff0000, v16
    v_cvt_pk_bf16_f32 v16, v48, v49
    v_lshlrev_b32 v48, 16, v16
    v_and_b32 v49, 0xffff0000, v16
    v_cvt_pk_bf16_f32 v16, v50, v51
    v_lshlrev_b32 v50, 16, v16
    v_and_b32 v51, 0xffff0000, v16
    v_mul_f32 v52, v44, v99
    v_mul_f32 v53, v45, v99
    v_mul_f32 v54, v46, v99
    v_mul_f32 v55, v47, v99
    v_mul_f32 v56, v48, v99
    v_mul_f32 v57, v49, v99
    v_mul_f32 v58, v50, v99
    v_mul_f32 v59, v51, v99
    v_fma_f32 v44, -v52, v98, v44
    v_fma_f32 v45, -v53, v98, v45
    v_fma_f32 v46, -v54, v98, v46
    v_fma_f32 v47, -v55, v98, v47
    v_fma_f32 v48, -v56, v98, v48
    v_fma_f32 v49, -v57, v98, v49
    v_fma_f32 v50, -v58, v98, v50
    v_fma_f32 v51, -v59, v98, v51
    v_fma_f32 v44, v44, v99, v52
    v_fma_f32 v45, v45, v99, v53
    v_fma_f32 v46, v46, v99, v54
    v_fma_f32 v47, v47, v99, v55
    v_fma_f32 v48, v48, v99, v56
    v_fma_f32 v49, v49, v99, v57
    v_fma_f32 v50, v50, v99, v58
    v_fma_f32 v51, v51, v99, v59
    v_cvt_pk_bf16_f32 v16, v44, v45
    v_lshlrev_b32 v44, 16, v16
    v_and_b32 v45, 0xffff0000, v16
    v_cvt_pk_bf16_f32 v16, v46, v47
    v_lshlrev_b32 v46, 16, v16
    v_and_b32 v47, 0xffff0000, v16
    v_cvt_pk_bf16_f32 v16, v48, v49
    v_lshlrev_b32 v48, 16, v16
    v_and_b32 v49, 0xffff0000, v16
    v_cvt_pk_bf16_f32 v16, v50, v51
    v_lshlrev_b32 v50, 16, v16
    v_and_b32 v51, 0xffff0000, v16
    v_lshlrev_b32 v52, 16, v192
    v_and_b32 v53, 0xffff0000, v192
    v_lshlrev_b32 v54, 16, v193
    v_and_b32 v55, 0xffff0000, v193
    v_lshlrev_b32 v56, 16, v194
    v_and_b32 v57, 0xffff0000, v194
    v_lshlrev_b32 v58, 16, v195
    v_and_b32 v59, 0xffff0000, v195
    v_pk_mul_f32 v[44:45], v[44:45], v[52:53]
    v_pk_mul_f32 v[46:47], v[46:47], v[54:55]
    v_pk_mul_f32 v[48:49], v[48:49], v[56:57]
    v_pk_mul_f32 v[50:51], v[50:51], v[58:59]
    v_cvt_pk_bf16_f32 v16, v44, v45
    v_lshlrev_b32 v44, 16, v16
    v_and_b32 v45, 0xffff0000, v16
    v_cvt_pk_bf16_f32 v16, v46, v47
    v_lshlrev_b32 v46, 16, v16
    v_and_b32 v47, 0xffff0000, v16
    v_cvt_pk_bf16_f32 v16, v48, v49
    v_lshlrev_b32 v48, 16, v16
    v_and_b32 v49, 0xffff0000, v16
    v_cvt_pk_bf16_f32 v16, v50, v51
    v_lshlrev_b32 v50, 16, v16
    v_and_b32 v51, 0xffff0000, v16
    v_lshlrev_b32 v52, 16, v184
    v_and_b32 v53, 0xffff0000, v184
    v_lshlrev_b32 v54, 16, v185
    v_and_b32 v55, 0xffff0000, v185
    v_lshlrev_b32 v56, 16, v186
    v_and_b32 v57, 0xffff0000, v186
    v_lshlrev_b32 v58, 16, v187
    v_and_b32 v59, 0xffff0000, v187
    v_pk_add_f32 v[44:45], v[44:45], v[52:53]
    v_pk_add_f32 v[46:47], v[46:47], v[54:55]
    v_pk_add_f32 v[48:49], v[48:49], v[56:57]
    v_pk_add_f32 v[50:51], v[50:51], v[58:59]
    v_cvt_pk_bf16_f32 v16, v44, v45
    v_lshlrev_b32 v44, 16, v16
    v_and_b32 v45, 0xffff0000, v16
    v_cvt_pk_bf16_f32 v16, v46, v47
    v_lshlrev_b32 v46, 16, v16
    v_and_b32 v47, 0xffff0000, v16
    v_cvt_pk_bf16_f32 v16, v48, v49
    v_lshlrev_b32 v48, 16, v16
    v_and_b32 v49, 0xffff0000, v16
    v_cvt_pk_bf16_f32 v16, v50, v51
    v_lshlrev_b32 v50, 16, v16
    v_and_b32 v51, 0xffff0000, v16
    v_lshlrev_b32 v52, 16, v200
    v_and_b32 v53, 0xffff0000, v200
    v_lshlrev_b32 v54, 16, v201
    v_and_b32 v55, 0xffff0000, v201
    v_lshlrev_b32 v56, 16, v202
    v_and_b32 v57, 0xffff0000, v202
    v_lshlrev_b32 v58, 16, v203
    v_and_b32 v59, 0xffff0000, v203
    v_pk_mul_f32 v[44:45], v[44:45], v[52:53]
    v_pk_mul_f32 v[46:47], v[46:47], v[54:55]
    v_pk_mul_f32 v[48:49], v[48:49], v[56:57]
    v_pk_mul_f32 v[50:51], v[50:51], v[58:59]
    v_cvt_pk_bf16_f32 v16, v44, v45
    v_lshlrev_b32 v44, 16, v16
    v_and_b32 v45, 0xffff0000, v16
    v_cvt_pk_bf16_f32 v16, v46, v47
    v_lshlrev_b32 v46, 16, v16
    v_and_b32 v47, 0xffff0000, v16
    v_cvt_pk_bf16_f32 v16, v48, v49
    v_lshlrev_b32 v48, 16, v16
    v_and_b32 v49, 0xffff0000, v16
    v_cvt_pk_bf16_f32 v16, v50, v51
    v_lshlrev_b32 v50, 16, v16
    v_and_b32 v51, 0xffff0000, v16
    v_pk_add_f32 v[44:45], v[44:45], v[28:29]
    v_pk_add_f32 v[46:47], v[46:47], v[30:31]
    v_pk_add_f32 v[48:49], v[48:49], v[32:33]
    v_pk_add_f32 v[50:51], v[50:51], v[34:35]
    v_cvt_pk_bf16_f32 v28, v44, v45
    v_cvt_pk_bf16_f32 v29, v46, v47
    v_cvt_pk_bf16_f32 v30, v48, v49
    v_cvt_pk_bf16_f32 v31, v50, v51
    v_sub_f32 v44, v36, v96
    v_sub_f32 v45, v37, v96
    v_sub_f32 v46, v38, v96
    v_sub_f32 v47, v39, v96
    v_sub_f32 v48, v40, v96
    v_sub_f32 v49, v41, v96
    v_sub_f32 v50, v42, v96
    v_sub_f32 v51, v43, v96
    v_cvt_pk_bf16_f32 v16, v44, v45
    v_lshlrev_b32 v44, 16, v16
    v_and_b32 v45, 0xffff0000, v16
    v_cvt_pk_bf16_f32 v16, v46, v47
    v_lshlrev_b32 v46, 16, v16
    v_and_b32 v47, 0xffff0000, v16
    v_cvt_pk_bf16_f32 v16, v48, v49
    v_lshlrev_b32 v48, 16, v16
    v_and_b32 v49, 0xffff0000, v16
    v_cvt_pk_bf16_f32 v16, v50, v51
    v_lshlrev_b32 v50, 16, v16
    v_and_b32 v51, 0xffff0000, v16
    v_mul_f32 v52, v44, v99
    v_mul_f32 v53, v45, v99
    v_mul_f32 v54, v46, v99
    v_mul_f32 v55, v47, v99
    v_mul_f32 v56, v48, v99
    v_mul_f32 v57, v49, v99
    v_mul_f32 v58, v50, v99
    v_mul_f32 v59, v51, v99
    v_fma_f32 v44, -v52, v98, v44
    v_fma_f32 v45, -v53, v98, v45
    v_fma_f32 v46, -v54, v98, v46
    v_fma_f32 v47, -v55, v98, v47
    v_fma_f32 v48, -v56, v98, v48
    v_fma_f32 v49, -v57, v98, v49
    v_fma_f32 v50, -v58, v98, v50
    v_fma_f32 v51, -v59, v98, v51
    v_fma_f32 v44, v44, v99, v52
    v_fma_f32 v45, v45, v99, v53
    v_fma_f32 v46, v46, v99, v54
    v_fma_f32 v47, v47, v99, v55
    v_fma_f32 v48, v48, v99, v56
    v_fma_f32 v49, v49, v99, v57
    v_fma_f32 v50, v50, v99, v58
    v_fma_f32 v51, v51, v99, v59
    v_cvt_pk_bf16_f32 v16, v44, v45
    v_lshlrev_b32 v44, 16, v16
    v_and_b32 v45, 0xffff0000, v16
    v_cvt_pk_bf16_f32 v16, v46, v47
    v_lshlrev_b32 v46, 16, v16
    v_and_b32 v47, 0xffff0000, v16
    v_cvt_pk_bf16_f32 v16, v48, v49
    v_lshlrev_b32 v48, 16, v16
    v_and_b32 v49, 0xffff0000, v16
    v_cvt_pk_bf16_f32 v16, v50, v51
    v_lshlrev_b32 v50, 16, v16
    v_and_b32 v51, 0xffff0000, v16
    v_lshlrev_b32 v52, 16, v196
    v_and_b32 v53, 0xffff0000, v196
    v_lshlrev_b32 v54, 16, v197
    v_and_b32 v55, 0xffff0000, v197
    v_lshlrev_b32 v56, 16, v198
    v_and_b32 v57, 0xffff0000, v198
    v_lshlrev_b32 v58, 16, v199
    v_and_b32 v59, 0xffff0000, v199
    v_pk_mul_f32 v[44:45], v[44:45], v[52:53]
    v_pk_mul_f32 v[46:47], v[46:47], v[54:55]
    v_pk_mul_f32 v[48:49], v[48:49], v[56:57]
    v_pk_mul_f32 v[50:51], v[50:51], v[58:59]
    v_cvt_pk_bf16_f32 v16, v44, v45
    v_lshlrev_b32 v44, 16, v16
    v_and_b32 v45, 0xffff0000, v16
    v_cvt_pk_bf16_f32 v16, v46, v47
    v_lshlrev_b32 v46, 16, v16
    v_and_b32 v47, 0xffff0000, v16
    v_cvt_pk_bf16_f32 v16, v48, v49
    v_lshlrev_b32 v48, 16, v16
    v_and_b32 v49, 0xffff0000, v16
    v_cvt_pk_bf16_f32 v16, v50, v51
    v_lshlrev_b32 v50, 16, v16
    v_and_b32 v51, 0xffff0000, v16
    v_lshlrev_b32 v52, 16, v188
    v_and_b32 v53, 0xffff0000, v188
    v_lshlrev_b32 v54, 16, v189
    v_and_b32 v55, 0xffff0000, v189
    v_lshlrev_b32 v56, 16, v190
    v_and_b32 v57, 0xffff0000, v190
    v_lshlrev_b32 v58, 16, v191
    v_and_b32 v59, 0xffff0000, v191
    v_pk_add_f32 v[44:45], v[44:45], v[52:53]
    v_pk_add_f32 v[46:47], v[46:47], v[54:55]
    v_pk_add_f32 v[48:49], v[48:49], v[56:57]
    v_pk_add_f32 v[50:51], v[50:51], v[58:59]
    v_cvt_pk_bf16_f32 v16, v44, v45
    v_lshlrev_b32 v44, 16, v16
    v_and_b32 v45, 0xffff0000, v16
    v_cvt_pk_bf16_f32 v16, v46, v47
    v_lshlrev_b32 v46, 16, v16
    v_and_b32 v47, 0xffff0000, v16
    v_cvt_pk_bf16_f32 v16, v48, v49
    v_lshlrev_b32 v48, 16, v16
    v_and_b32 v49, 0xffff0000, v16
    v_cvt_pk_bf16_f32 v16, v50, v51
    v_lshlrev_b32 v50, 16, v16
    v_and_b32 v51, 0xffff0000, v16
    v_lshlrev_b32 v52, 16, v204
    v_and_b32 v53, 0xffff0000, v204
    v_lshlrev_b32 v54, 16, v205
    v_and_b32 v55, 0xffff0000, v205
    v_lshlrev_b32 v56, 16, v206
    v_and_b32 v57, 0xffff0000, v206
    v_lshlrev_b32 v58, 16, v207
    v_and_b32 v59, 0xffff0000, v207
    v_pk_mul_f32 v[44:45], v[44:45], v[52:53]
    v_pk_mul_f32 v[46:47], v[46:47], v[54:55]
    v_pk_mul_f32 v[48:49], v[48:49], v[56:57]
    v_pk_mul_f32 v[50:51], v[50:51], v[58:59]
    v_cvt_pk_bf16_f32 v16, v44, v45
    v_lshlrev_b32 v44, 16, v16
    v_and_b32 v45, 0xffff0000, v16
    v_cvt_pk_bf16_f32 v16, v46, v47
    v_lshlrev_b32 v46, 16, v16
    v_and_b32 v47, 0xffff0000, v16
    v_cvt_pk_bf16_f32 v16, v48, v49
    v_lshlrev_b32 v48, 16, v16
    v_and_b32 v49, 0xffff0000, v16
    v_cvt_pk_bf16_f32 v16, v50, v51
    v_lshlrev_b32 v50, 16, v16
    v_and_b32 v51, 0xffff0000, v16
    v_pk_add_f32 v[44:45], v[44:45], v[36:37]
    v_pk_add_f32 v[46:47], v[46:47], v[38:39]
    v_pk_add_f32 v[48:49], v[48:49], v[40:41]
    v_pk_add_f32 v[50:51], v[50:51], v[42:43]
    v_cvt_pk_bf16_f32 v36, v44, v45
    v_cvt_pk_bf16_f32 v37, v46, v47
    v_cvt_pk_bf16_f32 v38, v48, v49
    v_cvt_pk_bf16_f32 v39, v50, v51
    s_barrier
    v_and_b32 v16, 3, v1
    v_lshlrev_b32 v16, 4, v16
    v_add_u32 v16, 65792, v16
    ds_read_b32 v76, v16
    s_waitcnt lgkmcnt(0)
    v_mov_b32 v77, v76
    s_nop 1
    v_max_u32_dpp v77, v77, v77 row_ror:1 row_mask:0xf bank_mask:0xf
    s_nop 1
    v_max_u32_dpp v77, v77, v77 row_ror:2 row_mask:0xf bank_mask:0xf
    v_cmp_eq_u32 vcc, v76, v77
    s_ff1_i32_b64 s16, vcc
    s_lshl_b32 s16, s16, 4
    s_add_u32 s16, s16, 65792
    v_mov_b32 v16, s16
    ds_read_b128 v[24:27], v16
    s_waitcnt lgkmcnt(0)
    v_and_b32 v76, 0x7ff, v24
    v_sub_u32 v76, 2047, v76
    s_nop 0
    v_readfirstlane_b32 s12, v76
    v_rcp_f32 v103, v26
    s_lshr_b32 s18, s12, 4
    s_lshl_b32 s18, s18, 15
    s_and_b32 s19, s12, 15
    s_lshl_b32 s19, s19, 6
    s_add_u32 s18, s18, s19
    s_add_u32 s18, s18, 0x2c00000
    s_add_u32 s19, s18, 0x400000
    v_lshrrev_b32 v18, 4, v0
    v_lshlrev_b32 v18, 10, v18
    v_and_b32 v19, 15, v0
    v_lshl_add_u32 v18, v19, 2, v18
    s_lshl_b32 s13, s12, 11
    buffer_load_dword v100, v18, s[8:11], s18 offen sc1
    buffer_load_dword v101, v18, s[8:11], s19 offen sc1
    buffer_load_dword v102, v21, s[76:79], s13 offen
    s_lshl_b32 s16, s14, 11
    s_cmp_lg_u32 s12, s14
    s_cselect_b32 s16, s16, 0x7ffffff0
    buffer_store_dwordx4 v[28:31], v2, s[68:71], s16 offen offset:0 sc1
    buffer_store_dwordx4 v[36:39], v2, s[68:71], s16 offen offset:1024 sc1
    s_lshl_b32 s16, s3, 13
    v_add_u32 v20, s16, v2
    s_waitcnt vmcnt(4)
    v_lshlrev_b32 v76, 16, v100
    v_and_b32 v77, 0xffff0000, v100
    s_waitcnt vmcnt(3)
    v_lshlrev_b32 v78, 16, v101
    v_and_b32 v79, 0xffff0000, v101
    v_pk_add_f32 v[76:77], v[76:77], v[78:79]
    s_waitcnt vmcnt(2)
    v_lshlrev_b32 v78, 16, v102
    v_and_b32 v79, 0xffff0000, v102
    v_pk_add_f32 v[92:93], v[78:79], v[76:77]
    v_cvt_pk_bf16_f32 v76, v92, v93
    v_lshlrev_b32 v92, 16, v76
    v_and_b32 v93, 0xffff0000, v76
    v_cvt_pk_bf16_f32 v100, v92, v93
    v_and_b32 v105, 0xffff0000, v104
    v_lshlrev_b32 v104, 16, v104
    v_and_b32 v107, 0xffff0000, v106
    v_lshlrev_b32 v106, 16, v106
    v_sub_f32 v92, v92, v25
    v_sub_f32 v93, v93, v25
    v_cvt_pk_bf16_f32 v76, v92, v93
    v_lshlrev_b32 v92, 16, v76
    v_and_b32 v93, 0xffff0000, v76
    v_mul_f32 v77, v92, v103
    v_fma_f32 v92, -v77, v26, v92
    v_fma_f32 v92, v92, v103, v77
    v_mul_f32 v77, v93, v103
    v_fma_f32 v93, -v77, v26, v93
    v_fma_f32 v93, v93, v103, v77
    v_cvt_pk_bf16_f32 v76, v92, v93
    v_lshlrev_b32 v92, 16, v76
    v_and_b32 v93, 0xffff0000, v76
    v_mul_f32 v92, v92, v104
    v_mul_f32 v93, v93, v105
    v_cvt_pk_bf16_f32 v76, v92, v93
    v_lshlrev_b32 v92, 16, v76
    v_and_b32 v93, 0xffff0000, v76
    v_add_f32 v92, v92, v106
    v_add_f32 v93, v93, v107
    v_cvt_pk_bf16_f32 v101, v92, v93
    v_add_u32 v16, 66560, v21
    ds_write_b32 v16, v101
    ds_write_b32 v16, v100 offset:2048
    s_waitcnt lgkmcnt(0)
    s_barrier
    ds_read_b128 v[60:63], v20 offset:0
    ds_read_b128 v[64:67], v20 offset:1024
    ds_read_b128 v[68:71], v20 offset:2048
    ds_read_b128 v[72:75], v20 offset:3072
    ds_read_b128 v[108:111], v20 offset:4096
    ds_read_b128 v[112:115], v20 offset:5120
    ds_read_b128 v[116:119], v20 offset:6144
    ds_read_b128 v[120:123], v20 offset:7168
    s_and_b32 s16, s3, 3
    s_lshl_b32 s16, s16, 7
    s_and_b32 s17, s29, 3
    s_lshl_b32 s17, s17, 9
    s_add_u32 s16, s16, s17
    s_add_u32 s16, s16, 66560
    v_lshrrev_b32 v16, 3, v1
    v_lshlrev_b32 v16, 4, v16
    v_add_u32 v16, s16, v16
    ds_read_b128 v[104:107], v16
    s_waitcnt lgkmcnt(0)
    v_lshlrev_b32 v76, 16, v104
    v_and_b32 v77, 0xffff, v104
    v_dot2_f32_bf16 v85, v60, v76, 0
    v_dot2_f32_bf16 v84, v60, v77, 0
    v_dot2_f32_bf16 v87, v61, v76, 0
    v_dot2_f32_bf16 v86, v61, v77, 0
    v_dot2_f32_bf16 v89, v62, v76, 0
    v_dot2_f32_bf16 v88, v62, v77, 0
    v_dot2_f32_bf16 v91, v63, v76, 0
    v_dot2_f32_bf16 v90, v63, v77, 0
    v_and_b32 v78, 0xffff0000, v104
    v_lshrrev_b32 v79, 16, v104
    v_dot2c_f32_bf16 v85, v64, v78
    v_dot2c_f32_bf16 v84, v64, v79
    v_dot2c_f32_bf16 v87, v65, v78
    v_dot2c_f32_bf16 v86, v65, v79
    v_dot2c_f32_bf16 v89, v66, v78
    v_dot2c_f32_bf16 v88, v66, v79
    v_dot2c_f32_bf16 v91, v67, v78
    v_dot2c_f32_bf16 v90, v67, v79
    v_lshlrev_b32 v80, 16, v105
    v_and_b32 v81, 0xffff, v105
    v_dot2c_f32_bf16 v85, v68, v80
    v_dot2c_f32_bf16 v84, v68, v81
    v_dot2c_f32_bf16 v87, v69, v80
    v_dot2c_f32_bf16 v86, v69, v81
    v_dot2c_f32_bf16 v89, v70, v80
    v_dot2c_f32_bf16 v88, v70, v81
    v_dot2c_f32_bf16 v91, v71, v80
    v_dot2c_f32_bf16 v90, v71, v81
    v_and_b32 v82, 0xffff0000, v105
    v_lshrrev_b32 v83, 16, v105
    v_dot2c_f32_bf16 v85, v72, v82
    v_dot2c_f32_bf16 v84, v72, v83
    v_dot2c_f32_bf16 v87, v73, v82
    v_dot2c_f32_bf16 v86, v73, v83
    v_dot2c_f32_bf16 v89, v74, v82
    v_dot2c_f32_bf16 v88, v74, v83
    v_dot2c_f32_bf16 v91, v75, v82
    v_dot2c_f32_bf16 v90, v75, v83
    v_lshlrev_b32 v76, 16, v106
    v_and_b32 v77, 0xffff, v106
    v_dot2c_f32_bf16 v85, v108, v76
    v_dot2c_f32_bf16 v84, v108, v77
    v_dot2c_f32_bf16 v87, v109, v76
    v_dot2c_f32_bf16 v86, v109, v77
    v_dot2c_f32_bf16 v89, v110, v76
    v_dot2c_f32_bf16 v88, v110, v77
    v_dot2c_f32_bf16 v91, v111, v76
    v_dot2c_f32_bf16 v90, v111, v77
    v_and_b32 v78, 0xffff0000, v106
    v_lshrrev_b32 v79, 16, v106
    v_dot2c_f32_bf16 v85, v112, v78
    v_dot2c_f32_bf16 v84, v112, v79
    v_dot2c_f32_bf16 v87, v113, v78
    v_dot2c_f32_bf16 v86, v113, v79
    v_dot2c_f32_bf16 v89, v114, v78
    v_dot2c_f32_bf16 v88, v114, v79
    v_dot2c_f32_bf16 v91, v115, v78
    v_dot2c_f32_bf16 v90, v115, v79
    v_lshlrev_b32 v80, 16, v107
    v_and_b32 v81, 0xffff, v107
    v_dot2c_f32_bf16 v85, v116, v80
    v_dot2c_f32_bf16 v84, v116, v81
    v_dot2c_f32_bf16 v87, v117, v80
    v_dot2c_f32_bf16 v86, v117, v81
    v_dot2c_f32_bf16 v89, v118, v80
    v_dot2c_f32_bf16 v88, v118, v81
    v_dot2c_f32_bf16 v91, v119, v80
    v_dot2c_f32_bf16 v90, v119, v81
    v_and_b32 v82, 0xffff0000, v107
    v_lshrrev_b32 v83, 16, v107
    v_dot2c_f32_bf16 v85, v120, v82
    v_dot2c_f32_bf16 v84, v120, v83
    v_dot2c_f32_bf16 v87, v121, v82
    v_dot2c_f32_bf16 v86, v121, v83
    v_dot2c_f32_bf16 v89, v122, v82
    v_dot2c_f32_bf16 v88, v122, v83
    v_dot2c_f32_bf16 v91, v123, v82
    v_dot2c_f32_bf16 v90, v123, v83
    s_nop 0
    v_permlane32_swap_b32 v84, v88
    v_permlane32_swap_b32 v85, v89
    v_permlane32_swap_b32 v86, v90
    v_permlane32_swap_b32 v87, v91
    v_add_f32 v84, v84, v88
    v_add_f32 v85, v85, v89
    v_add_f32 v86, v86, v90
    v_add_f32 v87, v87, v91
    s_nop 0
    v_permlane16_swap_b32 v84, v86
    v_permlane16_swap_b32 v85, v87
    v_add_f32 v84, v84, v86
    v_add_f32 v85, v85, v87
    s_nop 0
    v_add_f32_dpp v84, v84, v84 row_ror:8 row_mask:0xf bank_mask:0xf
    v_add_f32_dpp v85, v85, v85 row_ror:8 row_mask:0xf bank_mask:0xf
    v_and_b32 v16, 7, v1
    v_lshlrev_b32 v16, 5, v16
    v_lshrrev_b32 v17, 4, v1
    v_lshl_add_u32 v16, v17, 3, v16
    s_lshl_b32 s16, s3, 8
    s_add_u32 s16, s16, 70656
    v_add_u32 v16, s16, v16
    ds_write_b64 v16, v[84:85]
    s_lshr_b32 s16, s3, 2
    s_lshl_b32 s17, s16, 10
    s_add_u32 s17, s17, 70656
    v_lshlrev_b32 v17, 2, v1
    v_add_u32 v16, s17, v17
    s_and_b32 s17, s29, 3
    s_lshl_b32 s17, s17, 1
    s_add_u32 s17, s17, s16
    s_mul_i32 s17, s17, 14336
    s_lshr_b32 s16, s29, 2
    s_lshl_b32 s16, s16, 8
    s_add_u32 s17, s17, s16
    s_add_u32 s17, s17, 0x6e1000
    s_and_b32 s16, s3, 3
    s_cmp_eq_u32 s16, 0
    s_cselect_b32 s17, s17, 0x7ffffff0
    s_cmp_lt_u32 s2, 224
    s_cselect_b32 s17, s17, 0x7ffffff0
    s_waitcnt lgkmcnt(0)
    s_barrier
    ds_read_b32 v84, v16 offset:0
    ds_read_b32 v85, v16 offset:256
    ds_read_b32 v86, v16 offset:512
    ds_read_b32 v87, v16 offset:768
    s_waitcnt lgkmcnt(2)
    v_add_f32 v84, v84, v85
    s_waitcnt lgkmcnt(0)
    v_add_f32 v86, v86, v87
    v_add_f32 v84, v84, v86
    v_or_b32 v84, 1, v84
    buffer_store_dword v84, v17, s[8:11], s17 offen sc1
    v_lshrrev_b32 v16, 4, v1
    v_mul_u32_u24 v16, 28672, v16
    v_and_b32 v17, 15, v1
    v_lshl_add_u32 v16, v17, 2, v16
    s_lshl_b32 s16, s29, 6
    s_add_u32 s16, s16, 0x6e1000
    s_add_u32 s17, s16, 14336
    s_mov_b32 s27, 0
adaLN_cond__sliding_block_cached__moe_arch_mod__prompt_kernel_gu23p:
    buffer_load_dword v84, v16, s[8:11], s16 offen sc1
    buffer_load_dword v85, v16, s[8:11], s17 offen sc1
    s_waitcnt vmcnt(0)
    v_min_u32 v86, v84, v85
    v_cmp_eq_u32 vcc, 0, v86
    s_cmp_lt_u32 s2, 224
    s_cselect_b64 s[62:63], -1, 0
    s_and_b64 vcc, vcc, s[62:63]
    s_add_u32 s27, s27, 1
    s_cmp_ge_u32 s27, 65536
    s_cbranch_scc1 adaLN_cond__sliding_block_cached__moe_arch_mod__prompt_kernel_gu23g
    s_cbranch_vccnz adaLN_cond__sliding_block_cached__moe_arch_mod__prompt_kernel_gu23p
adaLN_cond__sliding_block_cached__moe_arch_mod__prompt_kernel_gu23g:
    v_mov_b32 v86, v84
    s_nop 1
    v_permlane16_swap_b32 v84, v86
    v_add_f32 v84, v84, v86
    v_mov_b32 v87, v85
    s_nop 1
    v_permlane16_swap_b32 v85, v87
    v_add_f32 v85, v85, v87
    v_mov_b32 v86, v84
    s_nop 1
    v_permlane32_swap_b32 v84, v86
    v_add_f32 v84, v84, v86
    v_mov_b32 v87, v85
    s_nop 1
    v_permlane32_swap_b32 v85, v87
    v_add_f32 v85, v85, v87
    v_cvt_pk_bf16_f32 v86, v84, v85
    v_lshlrev_b32 v84, 16, v86
    v_and_b32 v85, 0xffff0000, v86
    v_mul_f32 v86, 0xbfb8aa3b, v84
    v_exp_f32 v86, v86
    s_nop 0
    v_add_f32 v86, 1.0, v86
    v_rcp_f32 v86, v86
    s_nop 0
    v_mul_f32 v84, v84, v86
    v_cvt_pk_bf16_f32 v84, v84, v84
    v_lshlrev_b32 v84, 16, v84
    v_mul_f32 v84, v84, v85
    v_cvt_pk_bf16_f32 v84, v84, v84
    v_lshlrev_b32 v84, 16, v84
    s_sub_u32 s16, s3, 4
    s_lshl_b32 s16, s16, 2
    s_add_u32 s17, s16, 0
    v_readlane_b32 s20, v84, s17
    s_lshr_b32 s4, s20, 16
    s_add_u32 s17, s16, 1
    v_readlane_b32 s21, v84, s17
    s_lshr_b32 s5, s21, 16
    s_add_u32 s17, s16, 2
    v_readlane_b32 s22, v84, s17
    s_lshr_b32 s6, s22, 16
    s_add_u32 s17, s16, 3
    v_readlane_b32 s23, v84, s17
    s_lshr_b32 s7, s23, 16
    v_dot2_f32_bf16 v45, v152, s20, 0
    v_dot2_f32_bf16 v44, v152, s4, 0
    v_dot2_f32_bf16 v47, v153, s20, 0
    v_dot2_f32_bf16 v46, v153, s4, 0
    v_dot2_f32_bf16 v49, v154, s20, 0
    v_dot2_f32_bf16 v48, v154, s4, 0
    v_dot2_f32_bf16 v51, v155, s20, 0
    v_dot2_f32_bf16 v50, v155, s4, 0
    v_dot2_f32_bf16 v53, v156, s20, 0
    v_dot2_f32_bf16 v52, v156, s4, 0
    v_dot2_f32_bf16 v55, v157, s20, 0
    v_dot2_f32_bf16 v54, v157, s4, 0
    v_dot2_f32_bf16 v57, v158, s20, 0
    v_dot2_f32_bf16 v56, v158, s4, 0
    v_dot2_f32_bf16 v59, v159, s20, 0
    v_dot2_f32_bf16 v58, v159, s4, 0
    v_dot2c_f32_bf16 v45, s21, v160
    v_dot2c_f32_bf16 v44, s5, v160
    v_dot2c_f32_bf16 v47, s21, v161
    v_dot2c_f32_bf16 v46, s5, v161
    v_dot2c_f32_bf16 v49, s21, v162
    v_dot2c_f32_bf16 v48, s5, v162
    v_dot2c_f32_bf16 v51, s21, v163
    v_dot2c_f32_bf16 v50, s5, v163
    v_dot2c_f32_bf16 v53, s21, v164
    v_dot2c_f32_bf16 v52, s5, v164
    v_dot2c_f32_bf16 v55, s21, v165
    v_dot2c_f32_bf16 v54, s5, v165
    v_dot2c_f32_bf16 v57, s21, v166
    v_dot2c_f32_bf16 v56, s5, v166
    v_dot2c_f32_bf16 v59, s21, v167
    v_dot2c_f32_bf16 v58, s5, v167
    v_dot2c_f32_bf16 v45, s22, v168
    v_dot2c_f32_bf16 v44, s6, v168
    v_dot2c_f32_bf16 v47, s22, v169
    v_dot2c_f32_bf16 v46, s6, v169
    v_dot2c_f32_bf16 v49, s22, v170
    v_dot2c_f32_bf16 v48, s6, v170
    v_dot2c_f32_bf16 v51, s22, v171
    v_dot2c_f32_bf16 v50, s6, v171
    v_dot2c_f32_bf16 v53, s22, v172
    v_dot2c_f32_bf16 v52, s6, v172
    v_dot2c_f32_bf16 v55, s22, v173
    v_dot2c_f32_bf16 v54, s6, v173
    v_dot2c_f32_bf16 v57, s22, v174
    v_dot2c_f32_bf16 v56, s6, v174
    v_dot2c_f32_bf16 v59, s22, v175
    v_dot2c_f32_bf16 v58, s6, v175
    v_dot2c_f32_bf16 v45, s23, v176
    v_dot2c_f32_bf16 v44, s7, v176
    v_dot2c_f32_bf16 v47, s23, v177
    v_dot2c_f32_bf16 v46, s7, v177
    v_dot2c_f32_bf16 v49, s23, v178
    v_dot2c_f32_bf16 v48, s7, v178
    v_dot2c_f32_bf16 v51, s23, v179
    v_dot2c_f32_bf16 v50, s7, v179
    v_dot2c_f32_bf16 v53, s23, v180
    v_dot2c_f32_bf16 v52, s7, v180
    v_dot2c_f32_bf16 v55, s23, v181
    v_dot2c_f32_bf16 v54, s7, v181
    v_dot2c_f32_bf16 v57, s23, v182
    v_dot2c_f32_bf16 v56, s7, v182
    v_dot2c_f32_bf16 v59, s23, v183
    v_dot2c_f32_bf16 v58, s7, v183
    s_sub_u32 s16, s3, 4
    s_lshl_b32 s16, s16, 12
    s_add_u32 s16, s16, 73728
    v_lshlrev_b32 v16, 5, v1
    v_add_u32 v16, s16, v16
    ds_write_b128 v16, v[44:47] offset:0
    ds_write_b128 v16, v[48:51] offset:16
    ds_write_b128 v16, v[52:55] offset:2048
    ds_write_b128 v16, v[56:59] offset:2064
    s_waitcnt lgkmcnt(0)
    s_barrier
    v_lshlrev_b32 v16, 3, v0
    v_add_u32 v17, 73728, v16
    ds_read_b64 v[84:85], v17 offset:0
    ds_read_b64 v[86:87], v17 offset:4096
    ds_read_b64 v[88:89], v17 offset:8192
    ds_read_b64 v[90:91], v17 offset:12288
    s_waitcnt lgkmcnt(2)
    v_pk_add_f32 v[84:85], v[84:85], v[86:87]
    s_waitcnt lgkmcnt(0)
    v_pk_add_f32 v[88:89], v[88:89], v[90:91]
    v_pk_add_f32 v[84:85], v[84:85], v[88:89]
    v_or_b32 v84, 1, v84
    v_or_b32 v85, 1, v85
    s_lshl_b32 s16, s29, 12
    s_add_u32 s16, s16, 0x600000
    s_cmp_lt_u32 s2, 224
    s_cselect_b32 s16, s16, 0x7ffffff0
    buffer_store_dwordx2 v[84:85], v16, s[8:11], s16 offen sc1
    s_cmp_lt_u32 s2, 224
    s_cbranch_scc1 adaLN_cond__sliding_block_cached__moe_arch_mod__prompt_kernel_end
    s_sub_u32 s16, s2, 224
    s_lshl_b32 s17, s16, 7
    s_add_u32 s17, s17, 0x600000
    v_lshrrev_b32 v16, 3, v0
    v_lshlrev_b32 v16, 12, v16
    v_and_b32 v17, 7, v0
    v_lshl_add_u32 v16, v17, 4, v16
    v_cmp_gt_u32 vcc, 256, v0
    v_bfrev_b32 v17, -2
    s_nop 0
    v_cndmask_b32 v17, v17, v16, vcc
    v_mov_b32 v19, 0
    v_cndmask_b32 v18, 1, v19, vcc
    s_lshl_b32 s18, s16, 6
    v_and_b32 v19, 31, v1
    v_lshlrev_b32 v19, 1, v19
    v_add_u32 v19, s18, v19
    s_mov_b32 s19, 0x541800
    buffer_load_ushort v95, v19, s[8:11], s19 offen sc1
    v_add_u32 v20, 66560, v19
    ds_read_u16 v96, v20
    ds_read_u16 v97, v20 offset:2048
    v_mov_b32 v94, v27
    v_cvt_pk_bf16_f32 v94, v94, v94
    v_lshlrev_b32 v94, 16, v94
    v_mul_f32 v94, 0xbfb8aa3b, v94
    v_exp_f32 v94, v94
    s_nop 0
    v_add_f32 v94, 1.0, v94
    v_rcp_f32 v94, v94
    s_nop 0
    v_cvt_pk_bf16_f32 v94, v94, v94
    v_lshlrev_b32 v94, 16, v94
    s_waitcnt vmcnt(0)
    v_lshlrev_b32 v95, 16, v95
    s_waitcnt lgkmcnt(1)
    v_lshlrev_b32 v96, 16, v96
    s_waitcnt lgkmcnt(0)
    v_lshlrev_b32 v97, 16, v97
    s_mov_b32 s27, 0
adaLN_cond__sliding_block_cached__moe_arch_mod__prompt_kernel_y24p:
    s_add_u32 s19, s17, 0x0
    buffer_load_dwordx4 v[44:47], v16, s[8:11], s19 offen sc1
    s_add_u32 s19, s17, 0x40000
    buffer_load_dwordx4 v[48:51], v16, s[8:11], s19 offen sc1
    s_add_u32 s19, s17, 0x80000
    buffer_load_dwordx4 v[52:55], v16, s[8:11], s19 offen sc1
    s_add_u32 s19, s17, 0xc0000
    buffer_load_dwordx4 v[56:59], v17, s[8:11], s19 offen sc1
    s_waitcnt vmcnt(0)
    v_min3_u32 v98, v56, v57, v58
    v_min_u32 v98, v98, v59
    v_or_b32 v98, v98, v18
    v_min3_u32 v98, v98, v44, v45
    v_min3_u32 v98, v98, v46, v47
    v_min3_u32 v98, v98, v48, v49
    v_min3_u32 v98, v98, v50, v51
    v_min3_u32 v98, v98, v52, v53
    v_min3_u32 v98, v98, v54, v55
    v_cmp_eq_u32 vcc, 0, v98
    s_add_u32 s27, s27, 1
    s_cmp_ge_u32 s27, 65536
    s_cbranch_scc1 adaLN_cond__sliding_block_cached__moe_arch_mod__prompt_kernel_y24g
    s_cbranch_vccnz adaLN_cond__sliding_block_cached__moe_arch_mod__prompt_kernel_y24p
adaLN_cond__sliding_block_cached__moe_arch_mod__prompt_kernel_y24g:
    v_pk_add_f32 v[44:45], v[44:45], v[52:53]
    v_pk_add_f32 v[46:47], v[46:47], v[54:55]
    v_pk_add_f32 v[48:49], v[48:49], v[56:57]
    v_pk_add_f32 v[50:51], v[50:51], v[58:59]
    v_pk_add_f32 v[44:45], v[44:45], v[48:49]
    v_pk_add_f32 v[46:47], v[46:47], v[50:51]
    s_nop 0
    v_add_f32_dpp v44, v44, v44 row_ror:8 row_mask:0xf bank_mask:0xf
    v_add_f32_dpp v45, v45, v45 row_ror:8 row_mask:0xf bank_mask:0xf
    v_add_f32_dpp v46, v46, v46 row_ror:8 row_mask:0xf bank_mask:0xf
    v_add_f32_dpp v47, v47, v47 row_ror:8 row_mask:0xf bank_mask:0xf
    s_nop 0
    v_permlane32_swap_b32 v44, v46
    v_permlane32_swap_b32 v45, v47
    v_add_f32 v44, v44, v46
    v_add_f32 v45, v45, v47
    s_nop 1
    v_permlane16_swap_b32 v44, v45
    v_add_f32 v44, v44, v45
    v_and_b32 v16, 7, v1
    v_lshlrev_b32 v16, 4, v16
    v_lshrrev_b32 v17, 4, v1
    v_lshl_add_u32 v16, v17, 2, v16
    s_lshl_b32 s19, s3, 7
    s_add_u32 s19, s19, 91136
    v_add_u32 v16, s19, v16
    ds_write_b32 v16, v44
    v_and_b32 v16, 31, v1
    v_lshlrev_b32 v16, 2, v16
    v_add_u32 v16, 91136, v16
    s_waitcnt lgkmcnt(0)
    s_barrier
    s_cmp_lg_u32 s3, 0
    s_cbranch_scc1 adaLN_cond__sliding_block_cached__moe_arch_mod__prompt_kernel_end
    ds_read_b32 v44, v16 offset:0
    ds_read_b32 v45, v16 offset:128
    ds_read_b32 v46, v16 offset:256
    ds_read_b32 v47, v16 offset:384
    ds_read_b32 v48, v16 offset:512
    ds_read_b32 v49, v16 offset:640
    ds_read_b32 v50, v16 offset:768
    ds_read_b32 v51, v16 offset:896
    s_waitcnt lgkmcnt(3)
    v_add_f32 v44, v44, v48
    s_waitcnt lgkmcnt(2)
    v_add_f32 v45, v45, v49
    s_waitcnt lgkmcnt(1)
    v_add_f32 v46, v46, v50
    s_waitcnt lgkmcnt(0)
    v_add_f32 v47, v47, v51
    v_add_f32 v44, v44, v46
    v_add_f32 v45, v45, v47
    v_add_f32 v44, v44, v45
    v_cvt_pk_bf16_f32 v44, v44, v44
    v_lshlrev_b32 v44, 16, v44
    v_mul_f32 v44, v44, v94
    v_cvt_pk_bf16_f32 v44, v44, v44
    v_lshlrev_b32 v44, 16, v44
    v_add_f32 v44, v44, v96
    v_cvt_pk_bf16_f32 v44, v44, v44
    v_lshlrev_b32 v44, 16, v44
    v_mul_f32 v44, v44, v95
    v_cvt_pk_bf16_f32 v44, v44, v44
    v_lshlrev_b32 v44, 16, v44
    v_add_f32 v44, v44, v97
    v_cvt_pk_bf16_f32 v44, v44, v44
    s_mov_b64 exec, 0xffffffff
    buffer_store_short v44, v19, s[68:71], s13 offen sc1
adaLN_cond__sliding_block_cached__moe_arch_mod__prompt_kernel_end:
    s_endpgm
adaLN_cond__sliding_block_cached__moe_arch_mod__prompt_kernel_n1r:
    s_mov_b32 s27, 0
adaLN_cond__sliding_block_cached__moe_arch_mod__prompt_kernel_n1p:
    buffer_load_dword v134, v132, s[64:67], 0 offen sc1
    s_waitcnt vmcnt(0)
    v_cmp_eq_u32 vcc, 0, v134
    s_cmp_eq_u32 s3, 0
    s_cselect_b64 s[62:63], -1, 0
    s_and_b64 vcc, vcc, s[62:63]
    s_add_u32 s27, s27, 1
    s_cmp_ge_u32 s27, 65536
    s_cbranch_scc1 adaLN_cond__sliding_block_cached__moe_arch_mod__prompt_kernel_n1g
    s_cbranch_vccnz adaLN_cond__sliding_block_cached__moe_arch_mod__prompt_kernel_n1p
adaLN_cond__sliding_block_cached__moe_arch_mod__prompt_kernel_n1g:
    s_waitcnt vmcnt(0) lgkmcnt(0)
    s_nop 15
    s_nop 3
    s_branch adaLN_cond__sliding_block_cached__moe_arch_mod__prompt_kernel_n1b
adaLN_cond__sliding_block_cached__moe_arch_mod__prompt_kernel_kv4r:
    s_waitcnt vmcnt(0) lgkmcnt(0)
    s_nop 15
    s_nop 3
    s_mov_b32 s27, 0
adaLN_cond__sliding_block_cached__moe_arch_mod__prompt_kernel_kv4p:
    buffer_load_dwordx4 v[12:15], v21, s[8:11], s18 offen sc1
    s_waitcnt vmcnt(0)
    v_xor_b32 v8, s28, v12
    v_xor_b32 v20, s28, v13
    v_or_b32 v8, v8, v20
    v_xor_b32 v20, s28, v14
    v_or_b32 v8, v8, v20
    v_xor_b32 v20, s28, v15
    v_or_b32 v8, v8, v20
    v_cmp_ne_u32 vcc, 0, v8
    s_add_u32 s27, s27, 1
    s_cmp_ge_u32 s27, 65536
    s_cbranch_scc1 adaLN_cond__sliding_block_cached__moe_arch_mod__prompt_kernel_kv4g
    s_cbranch_vccnz adaLN_cond__sliding_block_cached__moe_arch_mod__prompt_kernel_kv4p
adaLN_cond__sliding_block_cached__moe_arch_mod__prompt_kernel_kv4g:
    s_waitcnt vmcnt(0) lgkmcnt(0)
    s_nop 15
    s_nop 3
    s_branch adaLN_cond__sliding_block_cached__moe_arch_mod__prompt_kernel_kv4b
adaLN_cond__sliding_block_cached__moe_arch_mod__prompt_kernel_fixA:
    s_waitcnt vmcnt(0) lgkmcnt(0)
    s_nop 15
    s_nop 3
    s_lshr_b32 s16, s12, 3
    s_lshl_b32 s16, s16, 17
    s_add_u32 s16, s16, 0x400000
    v_add_u32 v8, s16, v2
    v_mov_b32 v16, 0xff7fffff
    v_mov_b32 v17, 0xff7fffff
    s_mov_b32 s16, 0
adaLN_cond__sliding_block_cached__moe_arch_mod__prompt_kernel_fixAm:
    s_add_u32 s17, s16, 0
    buffer_load_dwordx4 v[200:203], v8, s[8:11], s17 offen offset:0
    buffer_load_dwordx4 v[204:207], v8, s[8:11], s17 offen offset:1024
    buffer_load_dwordx4 v[208:211], v8, s[8:11], s17 offen offset:2048
    buffer_load_dwordx4 v[212:215], v8, s[8:11], s17 offen offset:3072
    s_waitcnt vmcnt(3)
    v_mfma_f32_16x16x32_bf16 v[184:187], v[200:203], v[152:155], 0
    v_mfma_f32_16x16x32_bf16 v[188:191], v[200:203], v[168:171], 0
    s_waitcnt vmcnt(2)
    v_mfma_f32_16x16x32_bf16 v[192:195], v[204:207], v[152:155], 0
    v_mfma_f32_16x16x32_bf16 v[196:199], v[204:207], v[168:171], 0
    s_waitcnt vmcnt(1)
    v_mfma_f32_16x16x32_bf16 v[184:187], v[208:211], v[156:159], v[184:187]
    v_mfma_f32_16x16x32_bf16 v[188:191], v[208:211], v[172:175], v[188:191]
    s_waitcnt vmcnt(0)
    v_mfma_f32_16x16x32_bf16 v[192:195], v[212:215], v[156:159], v[192:195]
    v_mfma_f32_16x16x32_bf16 v[196:199], v[212:215], v[172:175], v[196:199]
    s_add_u32 s17, s16, 4096
    buffer_load_dwordx4 v[200:203], v8, s[8:11], s17 offen offset:0
    buffer_load_dwordx4 v[204:207], v8, s[8:11], s17 offen offset:1024
    buffer_load_dwordx4 v[208:211], v8, s[8:11], s17 offen offset:2048
    buffer_load_dwordx4 v[212:215], v8, s[8:11], s17 offen offset:3072
    s_waitcnt vmcnt(3)
    v_mfma_f32_16x16x32_bf16 v[184:187], v[200:203], v[160:163], v[184:187]
    v_mfma_f32_16x16x32_bf16 v[188:191], v[200:203], v[176:179], v[188:191]
    s_waitcnt vmcnt(2)
    v_mfma_f32_16x16x32_bf16 v[192:195], v[204:207], v[160:163], v[192:195]
    v_mfma_f32_16x16x32_bf16 v[196:199], v[204:207], v[176:179], v[196:199]
    s_waitcnt vmcnt(1)
    v_mfma_f32_16x16x32_bf16 v[184:187], v[208:211], v[164:167], v[184:187]
    v_mfma_f32_16x16x32_bf16 v[188:191], v[208:211], v[180:183], v[188:191]
    s_waitcnt vmcnt(0)
    v_mfma_f32_16x16x32_bf16 v[192:195], v[212:215], v[164:167], v[192:195]
    v_mfma_f32_16x16x32_bf16 v[196:199], v[212:215], v[180:183], v[196:199]
    s_nop 3
    v_max3_f32 v16, v16, v184, v185
    v_max3_f32 v16, v16, v186, v187
    v_max3_f32 v17, v17, v188, v189
    v_max3_f32 v17, v17, v190, v191
    v_max3_f32 v16, v16, v192, v193
    v_max3_f32 v16, v16, v194, v195
    v_max3_f32 v17, v17, v196, v197
    v_max3_f32 v17, v17, v198, v199
    s_add_u32 s16, s16, 8192
    s_cmp_lt_u32 s16, 0x20000
    s_cbranch_scc1 adaLN_cond__sliding_block_cached__moe_arch_mod__prompt_kernel_fixAm
    v_mov_b32 v18, v16
    v_mov_b32 v19, v17
    s_nop 0
    v_permlane16_swap_b32 v16, v18
    v_permlane16_swap_b32 v17, v19
    v_max_f32 v16, v16, v18
    v_max_f32 v17, v17, v19
    v_mov_b32 v18, v16
    v_mov_b32 v19, v17
    s_nop 0
    v_permlane32_swap_b32 v16, v18
    v_permlane32_swap_b32 v17, v19
    v_max_f32 v16, v16, v18
    v_max_f32 v17, v17, v19
    v_sub_f32 v216, 0, v16
    v_sub_f32 v217, 0, v16
    v_sub_f32 v218, 0, v16
    v_sub_f32 v219, 0, v16
    v_sub_f32 v220, 0, v17
    v_sub_f32 v221, 0, v17
    v_sub_f32 v222, 0, v17
    v_sub_f32 v223, 0, v17
    s_mov_b32 s17, 0x0
    buffer_load_dwordx4 v[200:203], v8, s[8:11], s17 offen offset:0
    buffer_load_dwordx4 v[204:207], v8, s[8:11], s17 offen offset:1024
    buffer_load_dwordx4 v[208:211], v8, s[8:11], s17 offen offset:2048
    buffer_load_dwordx4 v[212:215], v8, s[8:11], s17 offen offset:3072
    s_waitcnt vmcnt(3)
    v_mfma_f32_16x16x32_bf16 v[184:187], v[200:203], v[152:155], v[216:219]
    v_mfma_f32_16x16x32_bf16 v[188:191], v[200:203], v[168:171], v[220:223]
    s_waitcnt vmcnt(2)
    v_mfma_f32_16x16x32_bf16 v[192:195], v[204:207], v[152:155], v[216:219]
    v_mfma_f32_16x16x32_bf16 v[196:199], v[204:207], v[168:171], v[220:223]
    s_waitcnt vmcnt(1)
    v_mfma_f32_16x16x32_bf16 v[184:187], v[208:211], v[156:159], v[184:187]
    v_mfma_f32_16x16x32_bf16 v[188:191], v[208:211], v[172:175], v[188:191]
    s_waitcnt vmcnt(0)
    v_mfma_f32_16x16x32_bf16 v[192:195], v[212:215], v[156:159], v[192:195]
    v_mfma_f32_16x16x32_bf16 v[196:199], v[212:215], v[172:175], v[196:199]
    s_mov_b32 s17, 0x1000
    buffer_load_dwordx4 v[200:203], v8, s[8:11], s17 offen offset:0
    buffer_load_dwordx4 v[204:207], v8, s[8:11], s17 offen offset:1024
    buffer_load_dwordx4 v[208:211], v8, s[8:11], s17 offen offset:2048
    buffer_load_dwordx4 v[212:215], v8, s[8:11], s17 offen offset:3072
    s_waitcnt vmcnt(3)
    v_mfma_f32_16x16x32_bf16 v[184:187], v[200:203], v[160:163], v[184:187]
    v_mfma_f32_16x16x32_bf16 v[188:191], v[200:203], v[176:179], v[188:191]
    s_waitcnt vmcnt(2)
    v_mfma_f32_16x16x32_bf16 v[192:195], v[204:207], v[160:163], v[192:195]
    v_mfma_f32_16x16x32_bf16 v[196:199], v[204:207], v[176:179], v[196:199]
    s_waitcnt vmcnt(1)
    v_mfma_f32_16x16x32_bf16 v[184:187], v[208:211], v[164:167], v[184:187]
    v_mfma_f32_16x16x32_bf16 v[188:191], v[208:211], v[180:183], v[188:191]
    s_waitcnt vmcnt(0)
    v_mfma_f32_16x16x32_bf16 v[192:195], v[212:215], v[164:167], v[192:195]
    v_mfma_f32_16x16x32_bf16 v[196:199], v[212:215], v[180:183], v[196:199]
    s_nop 3
    v_exp_f32 v184, v184
    v_exp_f32 v185, v185
    s_nop 0
    v_add_f32 v9, v184, v185
    v_cvt_pk_bf16_f32 v24, v184, v185
    v_exp_f32 v186, v186
    v_exp_f32 v187, v187
    v_add_f32 v9, v9, v186
    v_add_f32 v9, v9, v187
    v_cvt_pk_bf16_f32 v25, v186, v187
    v_exp_f32 v188, v188
    v_exp_f32 v189, v189
    s_nop 0
    v_add_f32 v10, v188, v189
    v_cvt_pk_bf16_f32 v28, v188, v189
    v_exp_f32 v190, v190
    v_exp_f32 v191, v191
    v_add_f32 v10, v10, v190
    v_add_f32 v10, v10, v191
    v_cvt_pk_bf16_f32 v29, v190, v191
    v_exp_f32 v192, v192
    v_exp_f32 v193, v193
    v_add_f32 v9, v9, v192
    v_add_f32 v9, v9, v193
    v_cvt_pk_bf16_f32 v26, v192, v193
    v_exp_f32 v194, v194
    v_exp_f32 v195, v195
    v_add_f32 v9, v9, v194
    v_add_f32 v9, v9, v195
    v_cvt_pk_bf16_f32 v27, v194, v195
    v_exp_f32 v196, v196
    v_exp_f32 v197, v197
    v_add_f32 v10, v10, v196
    v_add_f32 v10, v10, v197
    v_cvt_pk_bf16_f32 v30, v196, v197
    v_exp_f32 v198, v198
    v_exp_f32 v199, v199
    v_add_f32 v10, v10, v198
    v_add_f32 v10, v10, v199
    v_cvt_pk_bf16_f32 v31, v198, v199
    s_mov_b32 s17, 0x2000
    buffer_load_dwordx4 v[200:203], v8, s[8:11], s17 offen offset:0
    buffer_load_dwordx4 v[204:207], v8, s[8:11], s17 offen offset:1024
    buffer_load_dwordx4 v[208:211], v8, s[8:11], s17 offen offset:2048
    buffer_load_dwordx4 v[212:215], v8, s[8:11], s17 offen offset:3072
    s_waitcnt vmcnt(3)
    v_mfma_f32_16x16x32_bf16 v[184:187], v[200:203], v[152:155], v[216:219]
    v_mfma_f32_16x16x32_bf16 v[188:191], v[200:203], v[168:171], v[220:223]
    s_waitcnt vmcnt(2)
    v_mfma_f32_16x16x32_bf16 v[192:195], v[204:207], v[152:155], v[216:219]
    v_mfma_f32_16x16x32_bf16 v[196:199], v[204:207], v[168:171], v[220:223]
    s_waitcnt vmcnt(1)
    v_mfma_f32_16x16x32_bf16 v[184:187], v[208:211], v[156:159], v[184:187]
    v_mfma_f32_16x16x32_bf16 v[188:191], v[208:211], v[172:175], v[188:191]
    s_waitcnt vmcnt(0)
    v_mfma_f32_16x16x32_bf16 v[192:195], v[212:215], v[156:159], v[192:195]
    v_mfma_f32_16x16x32_bf16 v[196:199], v[212:215], v[172:175], v[196:199]
    s_mov_b32 s17, 0x3000
    buffer_load_dwordx4 v[200:203], v8, s[8:11], s17 offen offset:0
    buffer_load_dwordx4 v[204:207], v8, s[8:11], s17 offen offset:1024
    buffer_load_dwordx4 v[208:211], v8, s[8:11], s17 offen offset:2048
    buffer_load_dwordx4 v[212:215], v8, s[8:11], s17 offen offset:3072
    s_waitcnt vmcnt(3)
    v_mfma_f32_16x16x32_bf16 v[184:187], v[200:203], v[160:163], v[184:187]
    v_mfma_f32_16x16x32_bf16 v[188:191], v[200:203], v[176:179], v[188:191]
    s_waitcnt vmcnt(2)
    v_mfma_f32_16x16x32_bf16 v[192:195], v[204:207], v[160:163], v[192:195]
    v_mfma_f32_16x16x32_bf16 v[196:199], v[204:207], v[176:179], v[196:199]
    s_waitcnt vmcnt(1)
    v_mfma_f32_16x16x32_bf16 v[184:187], v[208:211], v[164:167], v[184:187]
    v_mfma_f32_16x16x32_bf16 v[188:191], v[208:211], v[180:183], v[188:191]
    s_waitcnt vmcnt(0)
    v_mfma_f32_16x16x32_bf16 v[192:195], v[212:215], v[164:167], v[192:195]
    v_mfma_f32_16x16x32_bf16 v[196:199], v[212:215], v[180:183], v[196:199]
    s_nop 3
    v_exp_f32 v184, v184
    v_exp_f32 v185, v185
    v_add_f32 v9, v9, v184
    v_add_f32 v9, v9, v185
    v_cvt_pk_bf16_f32 v32, v184, v185
    v_exp_f32 v186, v186
    v_exp_f32 v187, v187
    v_add_f32 v9, v9, v186
    v_add_f32 v9, v9, v187
    v_cvt_pk_bf16_f32 v33, v186, v187
    v_exp_f32 v188, v188
    v_exp_f32 v189, v189
    v_add_f32 v10, v10, v188
    v_add_f32 v10, v10, v189
    v_cvt_pk_bf16_f32 v36, v188, v189
    v_exp_f32 v190, v190
    v_exp_f32 v191, v191
    v_add_f32 v10, v10, v190
    v_add_f32 v10, v10, v191
    v_cvt_pk_bf16_f32 v37, v190, v191
    v_exp_f32 v192, v192
    v_exp_f32 v193, v193
    v_add_f32 v9, v9, v192
    v_add_f32 v9, v9, v193
    v_cvt_pk_bf16_f32 v34, v192, v193
    v_exp_f32 v194, v194
    v_exp_f32 v195, v195
    v_add_f32 v9, v9, v194
    v_add_f32 v9, v9, v195
    v_cvt_pk_bf16_f32 v35, v194, v195
    v_exp_f32 v196, v196
    v_exp_f32 v197, v197
    v_add_f32 v10, v10, v196
    v_add_f32 v10, v10, v197
    v_cvt_pk_bf16_f32 v38, v196, v197
    v_exp_f32 v198, v198
    v_exp_f32 v199, v199
    v_add_f32 v10, v10, v198
    v_add_f32 v10, v10, v199
    v_cvt_pk_bf16_f32 v39, v198, v199
    s_mov_b32 s17, 0x4000
    buffer_load_dwordx4 v[200:203], v8, s[8:11], s17 offen offset:0
    buffer_load_dwordx4 v[204:207], v8, s[8:11], s17 offen offset:1024
    buffer_load_dwordx4 v[208:211], v8, s[8:11], s17 offen offset:2048
    buffer_load_dwordx4 v[212:215], v8, s[8:11], s17 offen offset:3072
    s_waitcnt vmcnt(3)
    v_mfma_f32_16x16x32_bf16 v[184:187], v[200:203], v[152:155], v[216:219]
    v_mfma_f32_16x16x32_bf16 v[188:191], v[200:203], v[168:171], v[220:223]
    s_waitcnt vmcnt(2)
    v_mfma_f32_16x16x32_bf16 v[192:195], v[204:207], v[152:155], v[216:219]
    v_mfma_f32_16x16x32_bf16 v[196:199], v[204:207], v[168:171], v[220:223]
    s_waitcnt vmcnt(1)
    v_mfma_f32_16x16x32_bf16 v[184:187], v[208:211], v[156:159], v[184:187]
    v_mfma_f32_16x16x32_bf16 v[188:191], v[208:211], v[172:175], v[188:191]
    s_waitcnt vmcnt(0)
    v_mfma_f32_16x16x32_bf16 v[192:195], v[212:215], v[156:159], v[192:195]
    v_mfma_f32_16x16x32_bf16 v[196:199], v[212:215], v[172:175], v[196:199]
    s_mov_b32 s17, 0x5000
    buffer_load_dwordx4 v[200:203], v8, s[8:11], s17 offen offset:0
    buffer_load_dwordx4 v[204:207], v8, s[8:11], s17 offen offset:1024
    buffer_load_dwordx4 v[208:211], v8, s[8:11], s17 offen offset:2048
    buffer_load_dwordx4 v[212:215], v8, s[8:11], s17 offen offset:3072
    s_waitcnt vmcnt(3)
    v_mfma_f32_16x16x32_bf16 v[184:187], v[200:203], v[160:163], v[184:187]
    v_mfma_f32_16x16x32_bf16 v[188:191], v[200:203], v[176:179], v[188:191]
    s_waitcnt vmcnt(2)
    v_mfma_f32_16x16x32_bf16 v[192:195], v[204:207], v[160:163], v[192:195]
    v_mfma_f32_16x16x32_bf16 v[196:199], v[204:207], v[176:179], v[196:199]
    s_waitcnt vmcnt(1)
    v_mfma_f32_16x16x32_bf16 v[184:187], v[208:211], v[164:167], v[184:187]
    v_mfma_f32_16x16x32_bf16 v[188:191], v[208:211], v[180:183], v[188:191]
    s_waitcnt vmcnt(0)
    v_mfma_f32_16x16x32_bf16 v[192:195], v[212:215], v[164:167], v[192:195]
    v_mfma_f32_16x16x32_bf16 v[196:199], v[212:215], v[180:183], v[196:199]
    s_nop 3
    v_exp_f32 v184, v184
    v_exp_f32 v185, v185
    v_add_f32 v9, v9, v184
    v_add_f32 v9, v9, v185
    v_cvt_pk_bf16_f32 v40, v184, v185
    v_exp_f32 v186, v186
    v_exp_f32 v187, v187
    v_add_f32 v9, v9, v186
    v_add_f32 v9, v9, v187
    v_cvt_pk_bf16_f32 v41, v186, v187
    v_exp_f32 v188, v188
    v_exp_f32 v189, v189
    v_add_f32 v10, v10, v188
    v_add_f32 v10, v10, v189
    v_cvt_pk_bf16_f32 v44, v188, v189
    v_exp_f32 v190, v190
    v_exp_f32 v191, v191
    v_add_f32 v10, v10, v190
    v_add_f32 v10, v10, v191
    v_cvt_pk_bf16_f32 v45, v190, v191
    v_exp_f32 v192, v192
    v_exp_f32 v193, v193
    v_add_f32 v9, v9, v192
    v_add_f32 v9, v9, v193
    v_cvt_pk_bf16_f32 v42, v192, v193
    v_exp_f32 v194, v194
    v_exp_f32 v195, v195
    v_add_f32 v9, v9, v194
    v_add_f32 v9, v9, v195
    v_cvt_pk_bf16_f32 v43, v194, v195
    v_exp_f32 v196, v196
    v_exp_f32 v197, v197
    v_add_f32 v10, v10, v196
    v_add_f32 v10, v10, v197
    v_cvt_pk_bf16_f32 v46, v196, v197
    v_exp_f32 v198, v198
    v_exp_f32 v199, v199
    v_add_f32 v10, v10, v198
    v_add_f32 v10, v10, v199
    v_cvt_pk_bf16_f32 v47, v198, v199
    s_mov_b32 s17, 0x6000
    buffer_load_dwordx4 v[200:203], v8, s[8:11], s17 offen offset:0
    buffer_load_dwordx4 v[204:207], v8, s[8:11], s17 offen offset:1024
    buffer_load_dwordx4 v[208:211], v8, s[8:11], s17 offen offset:2048
    buffer_load_dwordx4 v[212:215], v8, s[8:11], s17 offen offset:3072
    s_waitcnt vmcnt(3)
    v_mfma_f32_16x16x32_bf16 v[184:187], v[200:203], v[152:155], v[216:219]
    v_mfma_f32_16x16x32_bf16 v[188:191], v[200:203], v[168:171], v[220:223]
    s_waitcnt vmcnt(2)
    v_mfma_f32_16x16x32_bf16 v[192:195], v[204:207], v[152:155], v[216:219]
    v_mfma_f32_16x16x32_bf16 v[196:199], v[204:207], v[168:171], v[220:223]
    s_waitcnt vmcnt(1)
    v_mfma_f32_16x16x32_bf16 v[184:187], v[208:211], v[156:159], v[184:187]
    v_mfma_f32_16x16x32_bf16 v[188:191], v[208:211], v[172:175], v[188:191]
    s_waitcnt vmcnt(0)
    v_mfma_f32_16x16x32_bf16 v[192:195], v[212:215], v[156:159], v[192:195]
    v_mfma_f32_16x16x32_bf16 v[196:199], v[212:215], v[172:175], v[196:199]
    s_mov_b32 s17, 0x7000
    buffer_load_dwordx4 v[200:203], v8, s[8:11], s17 offen offset:0
    buffer_load_dwordx4 v[204:207], v8, s[8:11], s17 offen offset:1024
    buffer_load_dwordx4 v[208:211], v8, s[8:11], s17 offen offset:2048
    buffer_load_dwordx4 v[212:215], v8, s[8:11], s17 offen offset:3072
    s_waitcnt vmcnt(3)
    v_mfma_f32_16x16x32_bf16 v[184:187], v[200:203], v[160:163], v[184:187]
    v_mfma_f32_16x16x32_bf16 v[188:191], v[200:203], v[176:179], v[188:191]
    s_waitcnt vmcnt(2)
    v_mfma_f32_16x16x32_bf16 v[192:195], v[204:207], v[160:163], v[192:195]
    v_mfma_f32_16x16x32_bf16 v[196:199], v[204:207], v[176:179], v[196:199]
    s_waitcnt vmcnt(1)
    v_mfma_f32_16x16x32_bf16 v[184:187], v[208:211], v[164:167], v[184:187]
    v_mfma_f32_16x16x32_bf16 v[188:191], v[208:211], v[180:183], v[188:191]
    s_waitcnt vmcnt(0)
    v_mfma_f32_16x16x32_bf16 v[192:195], v[212:215], v[164:167], v[192:195]
    v_mfma_f32_16x16x32_bf16 v[196:199], v[212:215], v[180:183], v[196:199]
    s_nop 3
    v_exp_f32 v184, v184
    v_exp_f32 v185, v185
    v_add_f32 v9, v9, v184
    v_add_f32 v9, v9, v185
    v_cvt_pk_bf16_f32 v48, v184, v185
    v_exp_f32 v186, v186
    v_exp_f32 v187, v187
    v_add_f32 v9, v9, v186
    v_add_f32 v9, v9, v187
    v_cvt_pk_bf16_f32 v49, v186, v187
    v_exp_f32 v188, v188
    v_exp_f32 v189, v189
    v_add_f32 v10, v10, v188
    v_add_f32 v10, v10, v189
    v_cvt_pk_bf16_f32 v52, v188, v189
    v_exp_f32 v190, v190
    v_exp_f32 v191, v191
    v_add_f32 v10, v10, v190
    v_add_f32 v10, v10, v191
    v_cvt_pk_bf16_f32 v53, v190, v191
    v_exp_f32 v192, v192
    v_exp_f32 v193, v193
    v_add_f32 v9, v9, v192
    v_add_f32 v9, v9, v193
    v_cvt_pk_bf16_f32 v50, v192, v193
    v_exp_f32 v194, v194
    v_exp_f32 v195, v195
    v_add_f32 v9, v9, v194
    v_add_f32 v9, v9, v195
    v_cvt_pk_bf16_f32 v51, v194, v195
    v_exp_f32 v196, v196
    v_exp_f32 v197, v197
    v_add_f32 v10, v10, v196
    v_add_f32 v10, v10, v197
    v_cvt_pk_bf16_f32 v54, v196, v197
    v_exp_f32 v198, v198
    v_exp_f32 v199, v199
    v_add_f32 v10, v10, v198
    v_add_f32 v10, v10, v199
    v_cvt_pk_bf16_f32 v55, v198, v199
    s_mov_b32 s17, 0x8000
    buffer_load_dwordx4 v[200:203], v8, s[8:11], s17 offen offset:0
    buffer_load_dwordx4 v[204:207], v8, s[8:11], s17 offen offset:1024
    buffer_load_dwordx4 v[208:211], v8, s[8:11], s17 offen offset:2048
    buffer_load_dwordx4 v[212:215], v8, s[8:11], s17 offen offset:3072
    s_waitcnt vmcnt(3)
    v_mfma_f32_16x16x32_bf16 v[184:187], v[200:203], v[152:155], v[216:219]
    v_mfma_f32_16x16x32_bf16 v[188:191], v[200:203], v[168:171], v[220:223]
    s_waitcnt vmcnt(2)
    v_mfma_f32_16x16x32_bf16 v[192:195], v[204:207], v[152:155], v[216:219]
    v_mfma_f32_16x16x32_bf16 v[196:199], v[204:207], v[168:171], v[220:223]
    s_waitcnt vmcnt(1)
    v_mfma_f32_16x16x32_bf16 v[184:187], v[208:211], v[156:159], v[184:187]
    v_mfma_f32_16x16x32_bf16 v[188:191], v[208:211], v[172:175], v[188:191]
    s_waitcnt vmcnt(0)
    v_mfma_f32_16x16x32_bf16 v[192:195], v[212:215], v[156:159], v[192:195]
    v_mfma_f32_16x16x32_bf16 v[196:199], v[212:215], v[172:175], v[196:199]
    s_mov_b32 s17, 0x9000
    buffer_load_dwordx4 v[200:203], v8, s[8:11], s17 offen offset:0
    buffer_load_dwordx4 v[204:207], v8, s[8:11], s17 offen offset:1024
    buffer_load_dwordx4 v[208:211], v8, s[8:11], s17 offen offset:2048
    buffer_load_dwordx4 v[212:215], v8, s[8:11], s17 offen offset:3072
    s_waitcnt vmcnt(3)
    v_mfma_f32_16x16x32_bf16 v[184:187], v[200:203], v[160:163], v[184:187]
    v_mfma_f32_16x16x32_bf16 v[188:191], v[200:203], v[176:179], v[188:191]
    s_waitcnt vmcnt(2)
    v_mfma_f32_16x16x32_bf16 v[192:195], v[204:207], v[160:163], v[192:195]
    v_mfma_f32_16x16x32_bf16 v[196:199], v[204:207], v[176:179], v[196:199]
    s_waitcnt vmcnt(1)
    v_mfma_f32_16x16x32_bf16 v[184:187], v[208:211], v[164:167], v[184:187]
    v_mfma_f32_16x16x32_bf16 v[188:191], v[208:211], v[180:183], v[188:191]
    s_waitcnt vmcnt(0)
    v_mfma_f32_16x16x32_bf16 v[192:195], v[212:215], v[164:167], v[192:195]
    v_mfma_f32_16x16x32_bf16 v[196:199], v[212:215], v[180:183], v[196:199]
    s_nop 3
    v_exp_f32 v184, v184
    v_exp_f32 v185, v185
    v_add_f32 v9, v9, v184
    v_add_f32 v9, v9, v185
    v_cvt_pk_bf16_f32 v56, v184, v185
    v_exp_f32 v186, v186
    v_exp_f32 v187, v187
    v_add_f32 v9, v9, v186
    v_add_f32 v9, v9, v187
    v_cvt_pk_bf16_f32 v57, v186, v187
    v_exp_f32 v188, v188
    v_exp_f32 v189, v189
    v_add_f32 v10, v10, v188
    v_add_f32 v10, v10, v189
    v_cvt_pk_bf16_f32 v60, v188, v189
    v_exp_f32 v190, v190
    v_exp_f32 v191, v191
    v_add_f32 v10, v10, v190
    v_add_f32 v10, v10, v191
    v_cvt_pk_bf16_f32 v61, v190, v191
    v_exp_f32 v192, v192
    v_exp_f32 v193, v193
    v_add_f32 v9, v9, v192
    v_add_f32 v9, v9, v193
    v_cvt_pk_bf16_f32 v58, v192, v193
    v_exp_f32 v194, v194
    v_exp_f32 v195, v195
    v_add_f32 v9, v9, v194
    v_add_f32 v9, v9, v195
    v_cvt_pk_bf16_f32 v59, v194, v195
    v_exp_f32 v196, v196
    v_exp_f32 v197, v197
    v_add_f32 v10, v10, v196
    v_add_f32 v10, v10, v197
    v_cvt_pk_bf16_f32 v62, v196, v197
    v_exp_f32 v198, v198
    v_exp_f32 v199, v199
    v_add_f32 v10, v10, v198
    v_add_f32 v10, v10, v199
    v_cvt_pk_bf16_f32 v63, v198, v199
    s_mov_b32 s17, 0xa000
    buffer_load_dwordx4 v[200:203], v8, s[8:11], s17 offen offset:0
    buffer_load_dwordx4 v[204:207], v8, s[8:11], s17 offen offset:1024
    buffer_load_dwordx4 v[208:211], v8, s[8:11], s17 offen offset:2048
    buffer_load_dwordx4 v[212:215], v8, s[8:11], s17 offen offset:3072
    s_waitcnt vmcnt(3)
    v_mfma_f32_16x16x32_bf16 v[184:187], v[200:203], v[152:155], v[216:219]
    v_mfma_f32_16x16x32_bf16 v[188:191], v[200:203], v[168:171], v[220:223]
    s_waitcnt vmcnt(2)
    v_mfma_f32_16x16x32_bf16 v[192:195], v[204:207], v[152:155], v[216:219]
    v_mfma_f32_16x16x32_bf16 v[196:199], v[204:207], v[168:171], v[220:223]
    s_waitcnt vmcnt(1)
    v_mfma_f32_16x16x32_bf16 v[184:187], v[208:211], v[156:159], v[184:187]
    v_mfma_f32_16x16x32_bf16 v[188:191], v[208:211], v[172:175], v[188:191]
    s_waitcnt vmcnt(0)
    v_mfma_f32_16x16x32_bf16 v[192:195], v[212:215], v[156:159], v[192:195]
    v_mfma_f32_16x16x32_bf16 v[196:199], v[212:215], v[172:175], v[196:199]
    s_mov_b32 s17, 0xb000
    buffer_load_dwordx4 v[200:203], v8, s[8:11], s17 offen offset:0
    buffer_load_dwordx4 v[204:207], v8, s[8:11], s17 offen offset:1024
    buffer_load_dwordx4 v[208:211], v8, s[8:11], s17 offen offset:2048
    buffer_load_dwordx4 v[212:215], v8, s[8:11], s17 offen offset:3072
    s_waitcnt vmcnt(3)
    v_mfma_f32_16x16x32_bf16 v[184:187], v[200:203], v[160:163], v[184:187]
    v_mfma_f32_16x16x32_bf16 v[188:191], v[200:203], v[176:179], v[188:191]
    s_waitcnt vmcnt(2)
    v_mfma_f32_16x16x32_bf16 v[192:195], v[204:207], v[160:163], v[192:195]
    v_mfma_f32_16x16x32_bf16 v[196:199], v[204:207], v[176:179], v[196:199]
    s_waitcnt vmcnt(1)
    v_mfma_f32_16x16x32_bf16 v[184:187], v[208:211], v[164:167], v[184:187]
    v_mfma_f32_16x16x32_bf16 v[188:191], v[208:211], v[180:183], v[188:191]
    s_waitcnt vmcnt(0)
    v_mfma_f32_16x16x32_bf16 v[192:195], v[212:215], v[164:167], v[192:195]
    v_mfma_f32_16x16x32_bf16 v[196:199], v[212:215], v[180:183], v[196:199]
    s_nop 3
    v_exp_f32 v184, v184
    v_exp_f32 v185, v185
    v_add_f32 v9, v9, v184
    v_add_f32 v9, v9, v185
    v_cvt_pk_bf16_f32 v64, v184, v185
    v_exp_f32 v186, v186
    v_exp_f32 v187, v187
    v_add_f32 v9, v9, v186
    v_add_f32 v9, v9, v187
    v_cvt_pk_bf16_f32 v65, v186, v187
    v_exp_f32 v188, v188
    v_exp_f32 v189, v189
    v_add_f32 v10, v10, v188
    v_add_f32 v10, v10, v189
    v_cvt_pk_bf16_f32 v68, v188, v189
    v_exp_f32 v190, v190
    v_exp_f32 v191, v191
    v_add_f32 v10, v10, v190
    v_add_f32 v10, v10, v191
    v_cvt_pk_bf16_f32 v69, v190, v191
    v_exp_f32 v192, v192
    v_exp_f32 v193, v193
    v_add_f32 v9, v9, v192
    v_add_f32 v9, v9, v193
    v_cvt_pk_bf16_f32 v66, v192, v193
    v_exp_f32 v194, v194
    v_exp_f32 v195, v195
    v_add_f32 v9, v9, v194
    v_add_f32 v9, v9, v195
    v_cvt_pk_bf16_f32 v67, v194, v195
    v_exp_f32 v196, v196
    v_exp_f32 v197, v197
    v_add_f32 v10, v10, v196
    v_add_f32 v10, v10, v197
    v_cvt_pk_bf16_f32 v70, v196, v197
    v_exp_f32 v198, v198
    v_exp_f32 v199, v199
    v_add_f32 v10, v10, v198
    v_add_f32 v10, v10, v199
    v_cvt_pk_bf16_f32 v71, v198, v199
    s_mov_b32 s17, 0xc000
    buffer_load_dwordx4 v[200:203], v8, s[8:11], s17 offen offset:0
    buffer_load_dwordx4 v[204:207], v8, s[8:11], s17 offen offset:1024
    buffer_load_dwordx4 v[208:211], v8, s[8:11], s17 offen offset:2048
    buffer_load_dwordx4 v[212:215], v8, s[8:11], s17 offen offset:3072
    s_waitcnt vmcnt(3)
    v_mfma_f32_16x16x32_bf16 v[184:187], v[200:203], v[152:155], v[216:219]
    v_mfma_f32_16x16x32_bf16 v[188:191], v[200:203], v[168:171], v[220:223]
    s_waitcnt vmcnt(2)
    v_mfma_f32_16x16x32_bf16 v[192:195], v[204:207], v[152:155], v[216:219]
    v_mfma_f32_16x16x32_bf16 v[196:199], v[204:207], v[168:171], v[220:223]
    s_waitcnt vmcnt(1)
    v_mfma_f32_16x16x32_bf16 v[184:187], v[208:211], v[156:159], v[184:187]
    v_mfma_f32_16x16x32_bf16 v[188:191], v[208:211], v[172:175], v[188:191]
    s_waitcnt vmcnt(0)
    v_mfma_f32_16x16x32_bf16 v[192:195], v[212:215], v[156:159], v[192:195]
    v_mfma_f32_16x16x32_bf16 v[196:199], v[212:215], v[172:175], v[196:199]
    s_mov_b32 s17, 0xd000
    buffer_load_dwordx4 v[200:203], v8, s[8:11], s17 offen offset:0
    buffer_load_dwordx4 v[204:207], v8, s[8:11], s17 offen offset:1024
    buffer_load_dwordx4 v[208:211], v8, s[8:11], s17 offen offset:2048
    buffer_load_dwordx4 v[212:215], v8, s[8:11], s17 offen offset:3072
    s_waitcnt vmcnt(3)
    v_mfma_f32_16x16x32_bf16 v[184:187], v[200:203], v[160:163], v[184:187]
    v_mfma_f32_16x16x32_bf16 v[188:191], v[200:203], v[176:179], v[188:191]
    s_waitcnt vmcnt(2)
    v_mfma_f32_16x16x32_bf16 v[192:195], v[204:207], v[160:163], v[192:195]
    v_mfma_f32_16x16x32_bf16 v[196:199], v[204:207], v[176:179], v[196:199]
    s_waitcnt vmcnt(1)
    v_mfma_f32_16x16x32_bf16 v[184:187], v[208:211], v[164:167], v[184:187]
    v_mfma_f32_16x16x32_bf16 v[188:191], v[208:211], v[180:183], v[188:191]
    s_waitcnt vmcnt(0)
    v_mfma_f32_16x16x32_bf16 v[192:195], v[212:215], v[164:167], v[192:195]
    v_mfma_f32_16x16x32_bf16 v[196:199], v[212:215], v[180:183], v[196:199]
    s_nop 3
    v_exp_f32 v184, v184
    v_exp_f32 v185, v185
    v_add_f32 v9, v9, v184
    v_add_f32 v9, v9, v185
    v_cvt_pk_bf16_f32 v72, v184, v185
    v_exp_f32 v186, v186
    v_exp_f32 v187, v187
    v_add_f32 v9, v9, v186
    v_add_f32 v9, v9, v187
    v_cvt_pk_bf16_f32 v73, v186, v187
    v_exp_f32 v188, v188
    v_exp_f32 v189, v189
    v_add_f32 v10, v10, v188
    v_add_f32 v10, v10, v189
    v_cvt_pk_bf16_f32 v76, v188, v189
    v_exp_f32 v190, v190
    v_exp_f32 v191, v191
    v_add_f32 v10, v10, v190
    v_add_f32 v10, v10, v191
    v_cvt_pk_bf16_f32 v77, v190, v191
    v_exp_f32 v192, v192
    v_exp_f32 v193, v193
    v_add_f32 v9, v9, v192
    v_add_f32 v9, v9, v193
    v_cvt_pk_bf16_f32 v74, v192, v193
    v_exp_f32 v194, v194
    v_exp_f32 v195, v195
    v_add_f32 v9, v9, v194
    v_add_f32 v9, v9, v195
    v_cvt_pk_bf16_f32 v75, v194, v195
    v_exp_f32 v196, v196
    v_exp_f32 v197, v197
    v_add_f32 v10, v10, v196
    v_add_f32 v10, v10, v197
    v_cvt_pk_bf16_f32 v78, v196, v197
    v_exp_f32 v198, v198
    v_exp_f32 v199, v199
    v_add_f32 v10, v10, v198
    v_add_f32 v10, v10, v199
    v_cvt_pk_bf16_f32 v79, v198, v199
    s_mov_b32 s17, 0xe000
    buffer_load_dwordx4 v[200:203], v8, s[8:11], s17 offen offset:0
    buffer_load_dwordx4 v[204:207], v8, s[8:11], s17 offen offset:1024
    buffer_load_dwordx4 v[208:211], v8, s[8:11], s17 offen offset:2048
    buffer_load_dwordx4 v[212:215], v8, s[8:11], s17 offen offset:3072
    s_waitcnt vmcnt(3)
    v_mfma_f32_16x16x32_bf16 v[184:187], v[200:203], v[152:155], v[216:219]
    v_mfma_f32_16x16x32_bf16 v[188:191], v[200:203], v[168:171], v[220:223]
    s_waitcnt vmcnt(2)
    v_mfma_f32_16x16x32_bf16 v[192:195], v[204:207], v[152:155], v[216:219]
    v_mfma_f32_16x16x32_bf16 v[196:199], v[204:207], v[168:171], v[220:223]
    s_waitcnt vmcnt(1)
    v_mfma_f32_16x16x32_bf16 v[184:187], v[208:211], v[156:159], v[184:187]
    v_mfma_f32_16x16x32_bf16 v[188:191], v[208:211], v[172:175], v[188:191]
    s_waitcnt vmcnt(0)
    v_mfma_f32_16x16x32_bf16 v[192:195], v[212:215], v[156:159], v[192:195]
    v_mfma_f32_16x16x32_bf16 v[196:199], v[212:215], v[172:175], v[196:199]
    s_mov_b32 s17, 0xf000
    buffer_load_dwordx4 v[200:203], v8, s[8:11], s17 offen offset:0
    buffer_load_dwordx4 v[204:207], v8, s[8:11], s17 offen offset:1024
    buffer_load_dwordx4 v[208:211], v8, s[8:11], s17 offen offset:2048
    buffer_load_dwordx4 v[212:215], v8, s[8:11], s17 offen offset:3072
    s_waitcnt vmcnt(3)
    v_mfma_f32_16x16x32_bf16 v[184:187], v[200:203], v[160:163], v[184:187]
    v_mfma_f32_16x16x32_bf16 v[188:191], v[200:203], v[176:179], v[188:191]
    s_waitcnt vmcnt(2)
    v_mfma_f32_16x16x32_bf16 v[192:195], v[204:207], v[160:163], v[192:195]
    v_mfma_f32_16x16x32_bf16 v[196:199], v[204:207], v[176:179], v[196:199]
    s_waitcnt vmcnt(1)
    v_mfma_f32_16x16x32_bf16 v[184:187], v[208:211], v[164:167], v[184:187]
    v_mfma_f32_16x16x32_bf16 v[188:191], v[208:211], v[180:183], v[188:191]
    s_waitcnt vmcnt(0)
    v_mfma_f32_16x16x32_bf16 v[192:195], v[212:215], v[164:167], v[192:195]
    v_mfma_f32_16x16x32_bf16 v[196:199], v[212:215], v[180:183], v[196:199]
    s_nop 3
    v_exp_f32 v184, v184
    v_exp_f32 v185, v185
    v_add_f32 v9, v9, v184
    v_add_f32 v9, v9, v185
    v_cvt_pk_bf16_f32 v80, v184, v185
    v_exp_f32 v186, v186
    v_exp_f32 v187, v187
    v_add_f32 v9, v9, v186
    v_add_f32 v9, v9, v187
    v_cvt_pk_bf16_f32 v81, v186, v187
    v_exp_f32 v188, v188
    v_exp_f32 v189, v189
    v_add_f32 v10, v10, v188
    v_add_f32 v10, v10, v189
    v_cvt_pk_bf16_f32 v84, v188, v189
    v_exp_f32 v190, v190
    v_exp_f32 v191, v191
    v_add_f32 v10, v10, v190
    v_add_f32 v10, v10, v191
    v_cvt_pk_bf16_f32 v85, v190, v191
    v_exp_f32 v192, v192
    v_exp_f32 v193, v193
    v_add_f32 v9, v9, v192
    v_add_f32 v9, v9, v193
    v_cvt_pk_bf16_f32 v82, v192, v193
    v_exp_f32 v194, v194
    v_exp_f32 v195, v195
    v_add_f32 v9, v9, v194
    v_add_f32 v9, v9, v195
    v_cvt_pk_bf16_f32 v83, v194, v195
    v_exp_f32 v196, v196
    v_exp_f32 v197, v197
    v_add_f32 v10, v10, v196
    v_add_f32 v10, v10, v197
    v_cvt_pk_bf16_f32 v86, v196, v197
    v_exp_f32 v198, v198
    v_exp_f32 v199, v199
    v_add_f32 v10, v10, v198
    v_add_f32 v10, v10, v199
    v_cvt_pk_bf16_f32 v87, v198, v199
    s_mov_b32 s17, 0x10000
    buffer_load_dwordx4 v[200:203], v8, s[8:11], s17 offen offset:0
    buffer_load_dwordx4 v[204:207], v8, s[8:11], s17 offen offset:1024
    buffer_load_dwordx4 v[208:211], v8, s[8:11], s17 offen offset:2048
    buffer_load_dwordx4 v[212:215], v8, s[8:11], s17 offen offset:3072
    s_waitcnt vmcnt(3)
    v_mfma_f32_16x16x32_bf16 v[184:187], v[200:203], v[152:155], v[216:219]
    v_mfma_f32_16x16x32_bf16 v[188:191], v[200:203], v[168:171], v[220:223]
    s_waitcnt vmcnt(2)
    v_mfma_f32_16x16x32_bf16 v[192:195], v[204:207], v[152:155], v[216:219]
    v_mfma_f32_16x16x32_bf16 v[196:199], v[204:207], v[168:171], v[220:223]
    s_waitcnt vmcnt(1)
    v_mfma_f32_16x16x32_bf16 v[184:187], v[208:211], v[156:159], v[184:187]
    v_mfma_f32_16x16x32_bf16 v[188:191], v[208:211], v[172:175], v[188:191]
    s_waitcnt vmcnt(0)
    v_mfma_f32_16x16x32_bf16 v[192:195], v[212:215], v[156:159], v[192:195]
    v_mfma_f32_16x16x32_bf16 v[196:199], v[212:215], v[172:175], v[196:199]
    s_mov_b32 s17, 0x11000
    buffer_load_dwordx4 v[200:203], v8, s[8:11], s17 offen offset:0
    buffer_load_dwordx4 v[204:207], v8, s[8:11], s17 offen offset:1024
    buffer_load_dwordx4 v[208:211], v8, s[8:11], s17 offen offset:2048
    buffer_load_dwordx4 v[212:215], v8, s[8:11], s17 offen offset:3072
    s_waitcnt vmcnt(3)
    v_mfma_f32_16x16x32_bf16 v[184:187], v[200:203], v[160:163], v[184:187]
    v_mfma_f32_16x16x32_bf16 v[188:191], v[200:203], v[176:179], v[188:191]
    s_waitcnt vmcnt(2)
    v_mfma_f32_16x16x32_bf16 v[192:195], v[204:207], v[160:163], v[192:195]
    v_mfma_f32_16x16x32_bf16 v[196:199], v[204:207], v[176:179], v[196:199]
    s_waitcnt vmcnt(1)
    v_mfma_f32_16x16x32_bf16 v[184:187], v[208:211], v[164:167], v[184:187]
    v_mfma_f32_16x16x32_bf16 v[188:191], v[208:211], v[180:183], v[188:191]
    s_waitcnt vmcnt(0)
    v_mfma_f32_16x16x32_bf16 v[192:195], v[212:215], v[164:167], v[192:195]
    v_mfma_f32_16x16x32_bf16 v[196:199], v[212:215], v[180:183], v[196:199]
    s_nop 3
    v_exp_f32 v184, v184
    v_exp_f32 v185, v185
    v_add_f32 v9, v9, v184
    v_add_f32 v9, v9, v185
    v_cvt_pk_bf16_f32 v88, v184, v185
    v_exp_f32 v186, v186
    v_exp_f32 v187, v187
    v_add_f32 v9, v9, v186
    v_add_f32 v9, v9, v187
    v_cvt_pk_bf16_f32 v89, v186, v187
    v_exp_f32 v188, v188
    v_exp_f32 v189, v189
    v_add_f32 v10, v10, v188
    v_add_f32 v10, v10, v189
    v_cvt_pk_bf16_f32 v92, v188, v189
    v_exp_f32 v190, v190
    v_exp_f32 v191, v191
    v_add_f32 v10, v10, v190
    v_add_f32 v10, v10, v191
    v_cvt_pk_bf16_f32 v93, v190, v191
    v_exp_f32 v192, v192
    v_exp_f32 v193, v193
    v_add_f32 v9, v9, v192
    v_add_f32 v9, v9, v193
    v_cvt_pk_bf16_f32 v90, v192, v193
    v_exp_f32 v194, v194
    v_exp_f32 v195, v195
    v_add_f32 v9, v9, v194
    v_add_f32 v9, v9, v195
    v_cvt_pk_bf16_f32 v91, v194, v195
    v_exp_f32 v196, v196
    v_exp_f32 v197, v197
    v_add_f32 v10, v10, v196
    v_add_f32 v10, v10, v197
    v_cvt_pk_bf16_f32 v94, v196, v197
    v_exp_f32 v198, v198
    v_exp_f32 v199, v199
    v_add_f32 v10, v10, v198
    v_add_f32 v10, v10, v199
    v_cvt_pk_bf16_f32 v95, v198, v199
    s_mov_b32 s17, 0x12000
    buffer_load_dwordx4 v[200:203], v8, s[8:11], s17 offen offset:0
    buffer_load_dwordx4 v[204:207], v8, s[8:11], s17 offen offset:1024
    buffer_load_dwordx4 v[208:211], v8, s[8:11], s17 offen offset:2048
    buffer_load_dwordx4 v[212:215], v8, s[8:11], s17 offen offset:3072
    s_waitcnt vmcnt(3)
    v_mfma_f32_16x16x32_bf16 v[184:187], v[200:203], v[152:155], v[216:219]
    v_mfma_f32_16x16x32_bf16 v[188:191], v[200:203], v[168:171], v[220:223]
    s_waitcnt vmcnt(2)
    v_mfma_f32_16x16x32_bf16 v[192:195], v[204:207], v[152:155], v[216:219]
    v_mfma_f32_16x16x32_bf16 v[196:199], v[204:207], v[168:171], v[220:223]
    s_waitcnt vmcnt(1)
    v_mfma_f32_16x16x32_bf16 v[184:187], v[208:211], v[156:159], v[184:187]
    v_mfma_f32_16x16x32_bf16 v[188:191], v[208:211], v[172:175], v[188:191]
    s_waitcnt vmcnt(0)
    v_mfma_f32_16x16x32_bf16 v[192:195], v[212:215], v[156:159], v[192:195]
    v_mfma_f32_16x16x32_bf16 v[196:199], v[212:215], v[172:175], v[196:199]
    s_mov_b32 s17, 0x13000
    buffer_load_dwordx4 v[200:203], v8, s[8:11], s17 offen offset:0
    buffer_load_dwordx4 v[204:207], v8, s[8:11], s17 offen offset:1024
    buffer_load_dwordx4 v[208:211], v8, s[8:11], s17 offen offset:2048
    buffer_load_dwordx4 v[212:215], v8, s[8:11], s17 offen offset:3072
    s_waitcnt vmcnt(3)
    v_mfma_f32_16x16x32_bf16 v[184:187], v[200:203], v[160:163], v[184:187]
    v_mfma_f32_16x16x32_bf16 v[188:191], v[200:203], v[176:179], v[188:191]
    s_waitcnt vmcnt(2)
    v_mfma_f32_16x16x32_bf16 v[192:195], v[204:207], v[160:163], v[192:195]
    v_mfma_f32_16x16x32_bf16 v[196:199], v[204:207], v[176:179], v[196:199]
    s_waitcnt vmcnt(1)
    v_mfma_f32_16x16x32_bf16 v[184:187], v[208:211], v[164:167], v[184:187]
    v_mfma_f32_16x16x32_bf16 v[188:191], v[208:211], v[180:183], v[188:191]
    s_waitcnt vmcnt(0)
    v_mfma_f32_16x16x32_bf16 v[192:195], v[212:215], v[164:167], v[192:195]
    v_mfma_f32_16x16x32_bf16 v[196:199], v[212:215], v[180:183], v[196:199]
    s_nop 3
    v_exp_f32 v184, v184
    v_exp_f32 v185, v185
    v_add_f32 v9, v9, v184
    v_add_f32 v9, v9, v185
    v_cvt_pk_bf16_f32 v96, v184, v185
    v_exp_f32 v186, v186
    v_exp_f32 v187, v187
    v_add_f32 v9, v9, v186
    v_add_f32 v9, v9, v187
    v_cvt_pk_bf16_f32 v97, v186, v187
    v_exp_f32 v188, v188
    v_exp_f32 v189, v189
    v_add_f32 v10, v10, v188
    v_add_f32 v10, v10, v189
    v_cvt_pk_bf16_f32 v100, v188, v189
    v_exp_f32 v190, v190
    v_exp_f32 v191, v191
    v_add_f32 v10, v10, v190
    v_add_f32 v10, v10, v191
    v_cvt_pk_bf16_f32 v101, v190, v191
    v_exp_f32 v192, v192
    v_exp_f32 v193, v193
    v_add_f32 v9, v9, v192
    v_add_f32 v9, v9, v193
    v_cvt_pk_bf16_f32 v98, v192, v193
    v_exp_f32 v194, v194
    v_exp_f32 v195, v195
    v_add_f32 v9, v9, v194
    v_add_f32 v9, v9, v195
    v_cvt_pk_bf16_f32 v99, v194, v195
    v_exp_f32 v196, v196
    v_exp_f32 v197, v197
    v_add_f32 v10, v10, v196
    v_add_f32 v10, v10, v197
    v_cvt_pk_bf16_f32 v102, v196, v197
    v_exp_f32 v198, v198
    v_exp_f32 v199, v199
    v_add_f32 v10, v10, v198
    v_add_f32 v10, v10, v199
    v_cvt_pk_bf16_f32 v103, v198, v199
    s_mov_b32 s17, 0x14000
    buffer_load_dwordx4 v[200:203], v8, s[8:11], s17 offen offset:0
    buffer_load_dwordx4 v[204:207], v8, s[8:11], s17 offen offset:1024
    buffer_load_dwordx4 v[208:211], v8, s[8:11], s17 offen offset:2048
    buffer_load_dwordx4 v[212:215], v8, s[8:11], s17 offen offset:3072
    s_waitcnt vmcnt(3)
    v_mfma_f32_16x16x32_bf16 v[184:187], v[200:203], v[152:155], v[216:219]
    v_mfma_f32_16x16x32_bf16 v[188:191], v[200:203], v[168:171], v[220:223]
    s_waitcnt vmcnt(2)
    v_mfma_f32_16x16x32_bf16 v[192:195], v[204:207], v[152:155], v[216:219]
    v_mfma_f32_16x16x32_bf16 v[196:199], v[204:207], v[168:171], v[220:223]
    s_waitcnt vmcnt(1)
    v_mfma_f32_16x16x32_bf16 v[184:187], v[208:211], v[156:159], v[184:187]
    v_mfma_f32_16x16x32_bf16 v[188:191], v[208:211], v[172:175], v[188:191]
    s_waitcnt vmcnt(0)
    v_mfma_f32_16x16x32_bf16 v[192:195], v[212:215], v[156:159], v[192:195]
    v_mfma_f32_16x16x32_bf16 v[196:199], v[212:215], v[172:175], v[196:199]
    s_mov_b32 s17, 0x15000
    buffer_load_dwordx4 v[200:203], v8, s[8:11], s17 offen offset:0
    buffer_load_dwordx4 v[204:207], v8, s[8:11], s17 offen offset:1024
    buffer_load_dwordx4 v[208:211], v8, s[8:11], s17 offen offset:2048
    buffer_load_dwordx4 v[212:215], v8, s[8:11], s17 offen offset:3072
    s_waitcnt vmcnt(3)
    v_mfma_f32_16x16x32_bf16 v[184:187], v[200:203], v[160:163], v[184:187]
    v_mfma_f32_16x16x32_bf16 v[188:191], v[200:203], v[176:179], v[188:191]
    s_waitcnt vmcnt(2)
    v_mfma_f32_16x16x32_bf16 v[192:195], v[204:207], v[160:163], v[192:195]
    v_mfma_f32_16x16x32_bf16 v[196:199], v[204:207], v[176:179], v[196:199]
    s_waitcnt vmcnt(1)
    v_mfma_f32_16x16x32_bf16 v[184:187], v[208:211], v[164:167], v[184:187]
    v_mfma_f32_16x16x32_bf16 v[188:191], v[208:211], v[180:183], v[188:191]
    s_waitcnt vmcnt(0)
    v_mfma_f32_16x16x32_bf16 v[192:195], v[212:215], v[164:167], v[192:195]
    v_mfma_f32_16x16x32_bf16 v[196:199], v[212:215], v[180:183], v[196:199]
    s_nop 3
    v_exp_f32 v184, v184
    v_exp_f32 v185, v185
    v_add_f32 v9, v9, v184
    v_add_f32 v9, v9, v185
    v_cvt_pk_bf16_f32 v104, v184, v185
    v_exp_f32 v186, v186
    v_exp_f32 v187, v187
    v_add_f32 v9, v9, v186
    v_add_f32 v9, v9, v187
    v_cvt_pk_bf16_f32 v105, v186, v187
    v_exp_f32 v188, v188
    v_exp_f32 v189, v189
    v_add_f32 v10, v10, v188
    v_add_f32 v10, v10, v189
    v_cvt_pk_bf16_f32 v108, v188, v189
    v_exp_f32 v190, v190
    v_exp_f32 v191, v191
    v_add_f32 v10, v10, v190
    v_add_f32 v10, v10, v191
    v_cvt_pk_bf16_f32 v109, v190, v191
    v_exp_f32 v192, v192
    v_exp_f32 v193, v193
    v_add_f32 v9, v9, v192
    v_add_f32 v9, v9, v193
    v_cvt_pk_bf16_f32 v106, v192, v193
    v_exp_f32 v194, v194
    v_exp_f32 v195, v195
    v_add_f32 v9, v9, v194
    v_add_f32 v9, v9, v195
    v_cvt_pk_bf16_f32 v107, v194, v195
    v_exp_f32 v196, v196
    v_exp_f32 v197, v197
    v_add_f32 v10, v10, v196
    v_add_f32 v10, v10, v197
    v_cvt_pk_bf16_f32 v110, v196, v197
    v_exp_f32 v198, v198
    v_exp_f32 v199, v199
    v_add_f32 v10, v10, v198
    v_add_f32 v10, v10, v199
    v_cvt_pk_bf16_f32 v111, v198, v199
    s_mov_b32 s17, 0x16000
    buffer_load_dwordx4 v[200:203], v8, s[8:11], s17 offen offset:0
    buffer_load_dwordx4 v[204:207], v8, s[8:11], s17 offen offset:1024
    buffer_load_dwordx4 v[208:211], v8, s[8:11], s17 offen offset:2048
    buffer_load_dwordx4 v[212:215], v8, s[8:11], s17 offen offset:3072
    s_waitcnt vmcnt(3)
    v_mfma_f32_16x16x32_bf16 v[184:187], v[200:203], v[152:155], v[216:219]
    v_mfma_f32_16x16x32_bf16 v[188:191], v[200:203], v[168:171], v[220:223]
    s_waitcnt vmcnt(2)
    v_mfma_f32_16x16x32_bf16 v[192:195], v[204:207], v[152:155], v[216:219]
    v_mfma_f32_16x16x32_bf16 v[196:199], v[204:207], v[168:171], v[220:223]
    s_waitcnt vmcnt(1)
    v_mfma_f32_16x16x32_bf16 v[184:187], v[208:211], v[156:159], v[184:187]
    v_mfma_f32_16x16x32_bf16 v[188:191], v[208:211], v[172:175], v[188:191]
    s_waitcnt vmcnt(0)
    v_mfma_f32_16x16x32_bf16 v[192:195], v[212:215], v[156:159], v[192:195]
    v_mfma_f32_16x16x32_bf16 v[196:199], v[212:215], v[172:175], v[196:199]
    s_mov_b32 s17, 0x17000
    buffer_load_dwordx4 v[200:203], v8, s[8:11], s17 offen offset:0
    buffer_load_dwordx4 v[204:207], v8, s[8:11], s17 offen offset:1024
    buffer_load_dwordx4 v[208:211], v8, s[8:11], s17 offen offset:2048
    buffer_load_dwordx4 v[212:215], v8, s[8:11], s17 offen offset:3072
    s_waitcnt vmcnt(3)
    v_mfma_f32_16x16x32_bf16 v[184:187], v[200:203], v[160:163], v[184:187]
    v_mfma_f32_16x16x32_bf16 v[188:191], v[200:203], v[176:179], v[188:191]
    s_waitcnt vmcnt(2)
    v_mfma_f32_16x16x32_bf16 v[192:195], v[204:207], v[160:163], v[192:195]
    v_mfma_f32_16x16x32_bf16 v[196:199], v[204:207], v[176:179], v[196:199]
    s_waitcnt vmcnt(1)
    v_mfma_f32_16x16x32_bf16 v[184:187], v[208:211], v[164:167], v[184:187]
    v_mfma_f32_16x16x32_bf16 v[188:191], v[208:211], v[180:183], v[188:191]
    s_waitcnt vmcnt(0)
    v_mfma_f32_16x16x32_bf16 v[192:195], v[212:215], v[164:167], v[192:195]
    v_mfma_f32_16x16x32_bf16 v[196:199], v[212:215], v[180:183], v[196:199]
    s_nop 3
    v_exp_f32 v184, v184
    v_exp_f32 v185, v185
    v_add_f32 v9, v9, v184
    v_add_f32 v9, v9, v185
    v_cvt_pk_bf16_f32 v112, v184, v185
    v_exp_f32 v186, v186
    v_exp_f32 v187, v187
    v_add_f32 v9, v9, v186
    v_add_f32 v9, v9, v187
    v_cvt_pk_bf16_f32 v113, v186, v187
    v_exp_f32 v188, v188
    v_exp_f32 v189, v189
    v_add_f32 v10, v10, v188
    v_add_f32 v10, v10, v189
    v_cvt_pk_bf16_f32 v116, v188, v189
    v_exp_f32 v190, v190
    v_exp_f32 v191, v191
    v_add_f32 v10, v10, v190
    v_add_f32 v10, v10, v191
    v_cvt_pk_bf16_f32 v117, v190, v191
    v_exp_f32 v192, v192
    v_exp_f32 v193, v193
    v_add_f32 v9, v9, v192
    v_add_f32 v9, v9, v193
    v_cvt_pk_bf16_f32 v114, v192, v193
    v_exp_f32 v194, v194
    v_exp_f32 v195, v195
    v_add_f32 v9, v9, v194
    v_add_f32 v9, v9, v195
    v_cvt_pk_bf16_f32 v115, v194, v195
    v_exp_f32 v196, v196
    v_exp_f32 v197, v197
    v_add_f32 v10, v10, v196
    v_add_f32 v10, v10, v197
    v_cvt_pk_bf16_f32 v118, v196, v197
    v_exp_f32 v198, v198
    v_exp_f32 v199, v199
    v_add_f32 v10, v10, v198
    v_add_f32 v10, v10, v199
    v_cvt_pk_bf16_f32 v119, v198, v199
    s_mov_b32 s17, 0x18000
    buffer_load_dwordx4 v[200:203], v8, s[8:11], s17 offen offset:0
    buffer_load_dwordx4 v[204:207], v8, s[8:11], s17 offen offset:1024
    buffer_load_dwordx4 v[208:211], v8, s[8:11], s17 offen offset:2048
    buffer_load_dwordx4 v[212:215], v8, s[8:11], s17 offen offset:3072
    s_waitcnt vmcnt(3)
    v_mfma_f32_16x16x32_bf16 v[184:187], v[200:203], v[152:155], v[216:219]
    v_mfma_f32_16x16x32_bf16 v[188:191], v[200:203], v[168:171], v[220:223]
    s_waitcnt vmcnt(2)
    v_mfma_f32_16x16x32_bf16 v[192:195], v[204:207], v[152:155], v[216:219]
    v_mfma_f32_16x16x32_bf16 v[196:199], v[204:207], v[168:171], v[220:223]
    s_waitcnt vmcnt(1)
    v_mfma_f32_16x16x32_bf16 v[184:187], v[208:211], v[156:159], v[184:187]
    v_mfma_f32_16x16x32_bf16 v[188:191], v[208:211], v[172:175], v[188:191]
    s_waitcnt vmcnt(0)
    v_mfma_f32_16x16x32_bf16 v[192:195], v[212:215], v[156:159], v[192:195]
    v_mfma_f32_16x16x32_bf16 v[196:199], v[212:215], v[172:175], v[196:199]
    s_mov_b32 s17, 0x19000
    buffer_load_dwordx4 v[200:203], v8, s[8:11], s17 offen offset:0
    buffer_load_dwordx4 v[204:207], v8, s[8:11], s17 offen offset:1024
    buffer_load_dwordx4 v[208:211], v8, s[8:11], s17 offen offset:2048
    buffer_load_dwordx4 v[212:215], v8, s[8:11], s17 offen offset:3072
    s_waitcnt vmcnt(3)
    v_mfma_f32_16x16x32_bf16 v[184:187], v[200:203], v[160:163], v[184:187]
    v_mfma_f32_16x16x32_bf16 v[188:191], v[200:203], v[176:179], v[188:191]
    s_waitcnt vmcnt(2)
    v_mfma_f32_16x16x32_bf16 v[192:195], v[204:207], v[160:163], v[192:195]
    v_mfma_f32_16x16x32_bf16 v[196:199], v[204:207], v[176:179], v[196:199]
    s_waitcnt vmcnt(1)
    v_mfma_f32_16x16x32_bf16 v[184:187], v[208:211], v[164:167], v[184:187]
    v_mfma_f32_16x16x32_bf16 v[188:191], v[208:211], v[180:183], v[188:191]
    s_waitcnt vmcnt(0)
    v_mfma_f32_16x16x32_bf16 v[192:195], v[212:215], v[164:167], v[192:195]
    v_mfma_f32_16x16x32_bf16 v[196:199], v[212:215], v[180:183], v[196:199]
    s_nop 3
    v_exp_f32 v184, v184
    v_exp_f32 v185, v185
    v_add_f32 v9, v9, v184
    v_add_f32 v9, v9, v185
    v_cvt_pk_bf16_f32 v120, v184, v185
    v_exp_f32 v186, v186
    v_exp_f32 v187, v187
    v_add_f32 v9, v9, v186
    v_add_f32 v9, v9, v187
    v_cvt_pk_bf16_f32 v121, v186, v187
    v_exp_f32 v188, v188
    v_exp_f32 v189, v189
    v_add_f32 v10, v10, v188
    v_add_f32 v10, v10, v189
    v_cvt_pk_bf16_f32 v124, v188, v189
    v_exp_f32 v190, v190
    v_exp_f32 v191, v191
    v_add_f32 v10, v10, v190
    v_add_f32 v10, v10, v191
    v_cvt_pk_bf16_f32 v125, v190, v191
    v_exp_f32 v192, v192
    v_exp_f32 v193, v193
    v_add_f32 v9, v9, v192
    v_add_f32 v9, v9, v193
    v_cvt_pk_bf16_f32 v122, v192, v193
    v_exp_f32 v194, v194
    v_exp_f32 v195, v195
    v_add_f32 v9, v9, v194
    v_add_f32 v9, v9, v195
    v_cvt_pk_bf16_f32 v123, v194, v195
    v_exp_f32 v196, v196
    v_exp_f32 v197, v197
    v_add_f32 v10, v10, v196
    v_add_f32 v10, v10, v197
    v_cvt_pk_bf16_f32 v126, v196, v197
    v_exp_f32 v198, v198
    v_exp_f32 v199, v199
    v_add_f32 v10, v10, v198
    v_add_f32 v10, v10, v199
    v_cvt_pk_bf16_f32 v127, v198, v199
    s_mov_b32 s17, 0x1a000
    buffer_load_dwordx4 v[200:203], v8, s[8:11], s17 offen offset:0
    buffer_load_dwordx4 v[204:207], v8, s[8:11], s17 offen offset:1024
    buffer_load_dwordx4 v[208:211], v8, s[8:11], s17 offen offset:2048
    buffer_load_dwordx4 v[212:215], v8, s[8:11], s17 offen offset:3072
    s_waitcnt vmcnt(3)
    v_mfma_f32_16x16x32_bf16 v[184:187], v[200:203], v[152:155], v[216:219]
    v_mfma_f32_16x16x32_bf16 v[188:191], v[200:203], v[168:171], v[220:223]
    s_waitcnt vmcnt(2)
    v_mfma_f32_16x16x32_bf16 v[192:195], v[204:207], v[152:155], v[216:219]
    v_mfma_f32_16x16x32_bf16 v[196:199], v[204:207], v[168:171], v[220:223]
    s_waitcnt vmcnt(1)
    v_mfma_f32_16x16x32_bf16 v[184:187], v[208:211], v[156:159], v[184:187]
    v_mfma_f32_16x16x32_bf16 v[188:191], v[208:211], v[172:175], v[188:191]
    s_waitcnt vmcnt(0)
    v_mfma_f32_16x16x32_bf16 v[192:195], v[212:215], v[156:159], v[192:195]
    v_mfma_f32_16x16x32_bf16 v[196:199], v[212:215], v[172:175], v[196:199]
    s_mov_b32 s17, 0x1b000
    buffer_load_dwordx4 v[200:203], v8, s[8:11], s17 offen offset:0
    buffer_load_dwordx4 v[204:207], v8, s[8:11], s17 offen offset:1024
    buffer_load_dwordx4 v[208:211], v8, s[8:11], s17 offen offset:2048
    buffer_load_dwordx4 v[212:215], v8, s[8:11], s17 offen offset:3072
    s_waitcnt vmcnt(3)
    v_mfma_f32_16x16x32_bf16 v[184:187], v[200:203], v[160:163], v[184:187]
    v_mfma_f32_16x16x32_bf16 v[188:191], v[200:203], v[176:179], v[188:191]
    s_waitcnt vmcnt(2)
    v_mfma_f32_16x16x32_bf16 v[192:195], v[204:207], v[160:163], v[192:195]
    v_mfma_f32_16x16x32_bf16 v[196:199], v[204:207], v[176:179], v[196:199]
    s_waitcnt vmcnt(1)
    v_mfma_f32_16x16x32_bf16 v[184:187], v[208:211], v[164:167], v[184:187]
    v_mfma_f32_16x16x32_bf16 v[188:191], v[208:211], v[180:183], v[188:191]
    s_waitcnt vmcnt(0)
    v_mfma_f32_16x16x32_bf16 v[192:195], v[212:215], v[164:167], v[192:195]
    v_mfma_f32_16x16x32_bf16 v[196:199], v[212:215], v[180:183], v[196:199]
    s_nop 3
    v_exp_f32 v184, v184
    v_exp_f32 v185, v185
    v_add_f32 v9, v9, v184
    v_add_f32 v9, v9, v185
    v_cvt_pk_bf16_f32 v128, v184, v185
    v_exp_f32 v186, v186
    v_exp_f32 v187, v187
    v_add_f32 v9, v9, v186
    v_add_f32 v9, v9, v187
    v_cvt_pk_bf16_f32 v129, v186, v187
    v_exp_f32 v188, v188
    v_exp_f32 v189, v189
    v_add_f32 v10, v10, v188
    v_add_f32 v10, v10, v189
    v_cvt_pk_bf16_f32 v132, v188, v189
    v_exp_f32 v190, v190
    v_exp_f32 v191, v191
    v_add_f32 v10, v10, v190
    v_add_f32 v10, v10, v191
    v_cvt_pk_bf16_f32 v133, v190, v191
    v_exp_f32 v192, v192
    v_exp_f32 v193, v193
    v_add_f32 v9, v9, v192
    v_add_f32 v9, v9, v193
    v_cvt_pk_bf16_f32 v130, v192, v193
    v_exp_f32 v194, v194
    v_exp_f32 v195, v195
    v_add_f32 v9, v9, v194
    v_add_f32 v9, v9, v195
    v_cvt_pk_bf16_f32 v131, v194, v195
    v_exp_f32 v196, v196
    v_exp_f32 v197, v197
    v_add_f32 v10, v10, v196
    v_add_f32 v10, v10, v197
    v_cvt_pk_bf16_f32 v134, v196, v197
    v_exp_f32 v198, v198
    v_exp_f32 v199, v199
    v_add_f32 v10, v10, v198
    v_add_f32 v10, v10, v199
    v_cvt_pk_bf16_f32 v135, v198, v199
    s_mov_b32 s17, 0x1c000
    buffer_load_dwordx4 v[200:203], v8, s[8:11], s17 offen offset:0
    buffer_load_dwordx4 v[204:207], v8, s[8:11], s17 offen offset:1024
    buffer_load_dwordx4 v[208:211], v8, s[8:11], s17 offen offset:2048
    buffer_load_dwordx4 v[212:215], v8, s[8:11], s17 offen offset:3072
    s_waitcnt vmcnt(3)
    v_mfma_f32_16x16x32_bf16 v[184:187], v[200:203], v[152:155], v[216:219]
    v_mfma_f32_16x16x32_bf16 v[188:191], v[200:203], v[168:171], v[220:223]
    s_waitcnt vmcnt(2)
    v_mfma_f32_16x16x32_bf16 v[192:195], v[204:207], v[152:155], v[216:219]
    v_mfma_f32_16x16x32_bf16 v[196:199], v[204:207], v[168:171], v[220:223]
    s_waitcnt vmcnt(1)
    v_mfma_f32_16x16x32_bf16 v[184:187], v[208:211], v[156:159], v[184:187]
    v_mfma_f32_16x16x32_bf16 v[188:191], v[208:211], v[172:175], v[188:191]
    s_waitcnt vmcnt(0)
    v_mfma_f32_16x16x32_bf16 v[192:195], v[212:215], v[156:159], v[192:195]
    v_mfma_f32_16x16x32_bf16 v[196:199], v[212:215], v[172:175], v[196:199]
    s_mov_b32 s17, 0x1d000
    buffer_load_dwordx4 v[200:203], v8, s[8:11], s17 offen offset:0
    buffer_load_dwordx4 v[204:207], v8, s[8:11], s17 offen offset:1024
    buffer_load_dwordx4 v[208:211], v8, s[8:11], s17 offen offset:2048
    buffer_load_dwordx4 v[212:215], v8, s[8:11], s17 offen offset:3072
    s_waitcnt vmcnt(3)
    v_mfma_f32_16x16x32_bf16 v[184:187], v[200:203], v[160:163], v[184:187]
    v_mfma_f32_16x16x32_bf16 v[188:191], v[200:203], v[176:179], v[188:191]
    s_waitcnt vmcnt(2)
    v_mfma_f32_16x16x32_bf16 v[192:195], v[204:207], v[160:163], v[192:195]
    v_mfma_f32_16x16x32_bf16 v[196:199], v[204:207], v[176:179], v[196:199]
    s_waitcnt vmcnt(1)
    v_mfma_f32_16x16x32_bf16 v[184:187], v[208:211], v[164:167], v[184:187]
    v_mfma_f32_16x16x32_bf16 v[188:191], v[208:211], v[180:183], v[188:191]
    s_waitcnt vmcnt(0)
    v_mfma_f32_16x16x32_bf16 v[192:195], v[212:215], v[164:167], v[192:195]
    v_mfma_f32_16x16x32_bf16 v[196:199], v[212:215], v[180:183], v[196:199]
    s_nop 3
    v_exp_f32 v184, v184
    v_exp_f32 v185, v185
    v_add_f32 v9, v9, v184
    v_add_f32 v9, v9, v185
    v_cvt_pk_bf16_f32 v136, v184, v185
    v_exp_f32 v186, v186
    v_exp_f32 v187, v187
    v_add_f32 v9, v9, v186
    v_add_f32 v9, v9, v187
    v_cvt_pk_bf16_f32 v137, v186, v187
    v_exp_f32 v188, v188
    v_exp_f32 v189, v189
    v_add_f32 v10, v10, v188
    v_add_f32 v10, v10, v189
    v_cvt_pk_bf16_f32 v140, v188, v189
    v_exp_f32 v190, v190
    v_exp_f32 v191, v191
    v_add_f32 v10, v10, v190
    v_add_f32 v10, v10, v191
    v_cvt_pk_bf16_f32 v141, v190, v191
    v_exp_f32 v192, v192
    v_exp_f32 v193, v193
    v_add_f32 v9, v9, v192
    v_add_f32 v9, v9, v193
    v_cvt_pk_bf16_f32 v138, v192, v193
    v_exp_f32 v194, v194
    v_exp_f32 v195, v195
    v_add_f32 v9, v9, v194
    v_add_f32 v9, v9, v195
    v_cvt_pk_bf16_f32 v139, v194, v195
    v_exp_f32 v196, v196
    v_exp_f32 v197, v197
    v_add_f32 v10, v10, v196
    v_add_f32 v10, v10, v197
    v_cvt_pk_bf16_f32 v142, v196, v197
    v_exp_f32 v198, v198
    v_exp_f32 v199, v199
    v_add_f32 v10, v10, v198
    v_add_f32 v10, v10, v199
    v_cvt_pk_bf16_f32 v143, v198, v199
    s_mov_b32 s17, 0x1e000
    buffer_load_dwordx4 v[200:203], v8, s[8:11], s17 offen offset:0
    buffer_load_dwordx4 v[204:207], v8, s[8:11], s17 offen offset:1024
    buffer_load_dwordx4 v[208:211], v8, s[8:11], s17 offen offset:2048
    buffer_load_dwordx4 v[212:215], v8, s[8:11], s17 offen offset:3072
    s_waitcnt vmcnt(3)
    v_mfma_f32_16x16x32_bf16 v[184:187], v[200:203], v[152:155], v[216:219]
    v_mfma_f32_16x16x32_bf16 v[188:191], v[200:203], v[168:171], v[220:223]
    s_waitcnt vmcnt(2)
    v_mfma_f32_16x16x32_bf16 v[192:195], v[204:207], v[152:155], v[216:219]
    v_mfma_f32_16x16x32_bf16 v[196:199], v[204:207], v[168:171], v[220:223]
    s_waitcnt vmcnt(1)
    v_mfma_f32_16x16x32_bf16 v[184:187], v[208:211], v[156:159], v[184:187]
    v_mfma_f32_16x16x32_bf16 v[188:191], v[208:211], v[172:175], v[188:191]
    s_waitcnt vmcnt(0)
    v_mfma_f32_16x16x32_bf16 v[192:195], v[212:215], v[156:159], v[192:195]
    v_mfma_f32_16x16x32_bf16 v[196:199], v[212:215], v[172:175], v[196:199]
    s_mov_b32 s17, 0x1f000
    buffer_load_dwordx4 v[200:203], v8, s[8:11], s17 offen offset:0
    buffer_load_dwordx4 v[204:207], v8, s[8:11], s17 offen offset:1024
    buffer_load_dwordx4 v[208:211], v8, s[8:11], s17 offen offset:2048
    buffer_load_dwordx4 v[212:215], v8, s[8:11], s17 offen offset:3072
    s_waitcnt vmcnt(3)
    v_mfma_f32_16x16x32_bf16 v[184:187], v[200:203], v[160:163], v[184:187]
    v_mfma_f32_16x16x32_bf16 v[188:191], v[200:203], v[176:179], v[188:191]
    s_waitcnt vmcnt(2)
    v_mfma_f32_16x16x32_bf16 v[192:195], v[204:207], v[160:163], v[192:195]
    v_mfma_f32_16x16x32_bf16 v[196:199], v[204:207], v[176:179], v[196:199]
    s_waitcnt vmcnt(1)
    v_mfma_f32_16x16x32_bf16 v[184:187], v[208:211], v[164:167], v[184:187]
    v_mfma_f32_16x16x32_bf16 v[188:191], v[208:211], v[180:183], v[188:191]
    s_waitcnt vmcnt(0)
    v_mfma_f32_16x16x32_bf16 v[192:195], v[212:215], v[164:167], v[192:195]
    v_mfma_f32_16x16x32_bf16 v[196:199], v[212:215], v[180:183], v[196:199]
    s_nop 3
    v_exp_f32 v184, v184
    v_exp_f32 v185, v185
    v_add_f32 v9, v9, v184
    v_add_f32 v9, v9, v185
    v_cvt_pk_bf16_f32 v144, v184, v185
    v_exp_f32 v186, v186
    v_exp_f32 v187, v187
    v_add_f32 v9, v9, v186
    v_add_f32 v9, v9, v187
    v_cvt_pk_bf16_f32 v145, v186, v187
    v_exp_f32 v188, v188
    v_exp_f32 v189, v189
    v_add_f32 v10, v10, v188
    v_add_f32 v10, v10, v189
    v_cvt_pk_bf16_f32 v148, v188, v189
    v_exp_f32 v190, v190
    v_exp_f32 v191, v191
    v_add_f32 v10, v10, v190
    v_add_f32 v10, v10, v191
    v_cvt_pk_bf16_f32 v149, v190, v191
    v_exp_f32 v192, v192
    v_exp_f32 v193, v193
    v_add_f32 v9, v9, v192
    v_add_f32 v9, v9, v193
    v_cvt_pk_bf16_f32 v146, v192, v193
    v_exp_f32 v194, v194
    v_exp_f32 v195, v195
    v_add_f32 v9, v9, v194
    v_add_f32 v9, v9, v195
    v_cvt_pk_bf16_f32 v147, v194, v195
    v_exp_f32 v196, v196
    v_exp_f32 v197, v197
    v_add_f32 v10, v10, v196
    v_add_f32 v10, v10, v197
    v_cvt_pk_bf16_f32 v150, v196, v197
    v_exp_f32 v198, v198
    v_exp_f32 v199, v199
    v_add_f32 v10, v10, v198
    v_add_f32 v10, v10, v199
    v_cvt_pk_bf16_f32 v151, v198, v199
    v_mov_b32 v16, v9
    v_mov_b32 v18, v10
    s_nop 0
    v_permlane16_swap_b32 v9, v16
    v_permlane16_swap_b32 v10, v18
    v_add_f32 v9, v9, v16
    v_add_f32 v10, v10, v18
    v_mov_b32 v16, v9
    v_mov_b32 v18, v10
    s_nop 0
    v_permlane32_swap_b32 v9, v16
    v_permlane32_swap_b32 v10, v18
    v_add_f32 v9, v9, v16
    v_add_f32 v10, v10, v18
    s_waitcnt vmcnt(0) lgkmcnt(0)
    s_nop 15
    s_nop 3
    s_branch adaLN_cond__sliding_block_cached__moe_arch_mod__prompt_kernel_fixAb
adaLN_cond__sliding_block_cached__moe_arch_mod__prompt_kernel_mp5r:
    s_waitcnt vmcnt(0) lgkmcnt(0)
    s_nop 15
    s_nop 3
    s_mov_b32 s27, 0
adaLN_cond__sliding_block_cached__moe_arch_mod__prompt_kernel_mp5p:
    buffer_load_dword v248, v250, s[8:11], s14 offen sc1
    s_waitcnt vmcnt(0)
    v_cmp_ne_u32 vcc, s28, v248
    s_add_u32 s27, s27, 1
    s_cmp_ge_u32 s27, 65536
    s_cbranch_scc1 adaLN_cond__sliding_block_cached__moe_arch_mod__prompt_kernel_mp5g
    s_cbranch_vccnz adaLN_cond__sliding_block_cached__moe_arch_mod__prompt_kernel_mp5p
adaLN_cond__sliding_block_cached__moe_arch_mod__prompt_kernel_mp5g:
    s_waitcnt vmcnt(0) lgkmcnt(0)
    s_nop 15
    s_nop 3
    s_branch adaLN_cond__sliding_block_cached__moe_arch_mod__prompt_kernel_mp5b
adaLN_cond__sliding_block_cached__moe_arch_mod__prompt_kernel_o6r:
    s_waitcnt vmcnt(0) lgkmcnt(0)
    s_nop 15
    s_nop 3
    s_mov_b32 s27, 0
adaLN_cond__sliding_block_cached__moe_arch_mod__prompt_kernel_o6p:
    buffer_load_dword v12, v13, s[8:11], s19 offen sc1
    s_waitcnt vmcnt(0)
    v_cmp_ne_u32 vcc, s28, v12
    s_add_u32 s27, s27, 1
    s_cmp_ge_u32 s27, 65536
    s_cbranch_scc1 adaLN_cond__sliding_block_cached__moe_arch_mod__prompt_kernel_o6g
    s_cbranch_vccnz adaLN_cond__sliding_block_cached__moe_arch_mod__prompt_kernel_o6p
adaLN_cond__sliding_block_cached__moe_arch_mod__prompt_kernel_o6g:
    s_waitcnt vmcnt(0) lgkmcnt(0)
    s_nop 15
    s_nop 3
    s_branch adaLN_cond__sliding_block_cached__moe_arch_mod__prompt_kernel_o6b
adaLN_cond__sliding_block_cached__moe_arch_mod__prompt_kernel_o27r:
    s_waitcnt vmcnt(0) lgkmcnt(0)
    s_nop 15
    s_nop 3
    s_mov_b32 s27, 0
adaLN_cond__sliding_block_cached__moe_arch_mod__prompt_kernel_o27p:
    buffer_load_dword v12, v13, s[8:11], s19 offen sc1
    s_waitcnt vmcnt(0)
    v_cmp_ne_u32 vcc, s28, v12
    s_add_u32 s27, s27, 1
    s_cmp_ge_u32 s27, 65536
    s_cbranch_scc1 adaLN_cond__sliding_block_cached__moe_arch_mod__prompt_kernel_o27g
    s_cbranch_vccnz adaLN_cond__sliding_block_cached__moe_arch_mod__prompt_kernel_o27p
adaLN_cond__sliding_block_cached__moe_arch_mod__prompt_kernel_o27g:
    s_waitcnt vmcnt(0) lgkmcnt(0)
    s_nop 15
    s_nop 3
    s_branch adaLN_cond__sliding_block_cached__moe_arch_mod__prompt_kernel_o27b
adaLN_cond__sliding_block_cached__moe_arch_mod__prompt_kernel_o28r:
    s_waitcnt vmcnt(0) lgkmcnt(0)
    s_nop 15
    s_nop 3
    s_mov_b32 s27, 0
adaLN_cond__sliding_block_cached__moe_arch_mod__prompt_kernel_o28p:
    buffer_load_dword v12, v13, s[8:11], s19 offen sc1
    s_waitcnt vmcnt(0)
    v_cmp_ne_u32 vcc, s28, v12
    s_add_u32 s27, s27, 1
    s_cmp_ge_u32 s27, 65536
    s_cbranch_scc1 adaLN_cond__sliding_block_cached__moe_arch_mod__prompt_kernel_o28g
    s_cbranch_vccnz adaLN_cond__sliding_block_cached__moe_arch_mod__prompt_kernel_o28p
adaLN_cond__sliding_block_cached__moe_arch_mod__prompt_kernel_o28g:
    s_waitcnt vmcnt(0) lgkmcnt(0)
    s_nop 15
    s_nop 3
    s_branch adaLN_cond__sliding_block_cached__moe_arch_mod__prompt_kernel_o28b
adaLN_cond__sliding_block_cached__moe_arch_mod__prompt_kernel_o29r:
    s_waitcnt vmcnt(0) lgkmcnt(0)
    s_nop 15
    s_nop 3
    s_mov_b32 s27, 0
adaLN_cond__sliding_block_cached__moe_arch_mod__prompt_kernel_o29p:
    buffer_load_dword v12, v13, s[8:11], s19 offen sc1
    s_waitcnt vmcnt(0)
    v_cmp_ne_u32 vcc, s28, v12
    s_add_u32 s27, s27, 1
    s_cmp_ge_u32 s27, 65536
    s_cbranch_scc1 adaLN_cond__sliding_block_cached__moe_arch_mod__prompt_kernel_o29g
    s_cbranch_vccnz adaLN_cond__sliding_block_cached__moe_arch_mod__prompt_kernel_o29p
adaLN_cond__sliding_block_cached__moe_arch_mod__prompt_kernel_o29g:
    s_waitcnt vmcnt(0) lgkmcnt(0)
    s_nop 15
    s_nop 3
    s_branch adaLN_cond__sliding_block_cached__moe_arch_mod__prompt_kernel_o29b
adaLN_cond__sliding_block_cached__moe_arch_mod__prompt_kernel_mf10r:
    s_waitcnt vmcnt(0) lgkmcnt(0)
    s_nop 15
    s_nop 3
    s_mov_b32 s27, 0
adaLN_cond__sliding_block_cached__moe_arch_mod__prompt_kernel_mf10p:
    s_mov_b32 s16, 0x544000
    buffer_load_dwordx4 v[184:187], v2, s[8:11], s16 offen sc1
    s_waitcnt vmcnt(0)
    v_xor_b32 v16, s28, v184
    v_xor_b32 v17, s28, v185
    v_xor_b32 v18, s28, v186
    v_xor_b32 v19, s28, v187
    v_or3_b32 v16, v16, v17, v18
    v_or_b32 v16, v16, v19
    v_cmp_ne_u32 vcc, 0, v16
    s_add_u32 s27, s27, 1
    s_cmp_ge_u32 s27, 65536
    s_cbranch_scc1 adaLN_cond__sliding_block_cached__moe_arch_mod__prompt_kernel_mf10g
    s_cbranch_vccnz adaLN_cond__sliding_block_cached__moe_arch_mod__prompt_kernel_mf10p
adaLN_cond__sliding_block_cached__moe_arch_mod__prompt_kernel_mf10g:
    s_waitcnt vmcnt(0) lgkmcnt(0)
    s_nop 15
    s_nop 3
    s_branch adaLN_cond__sliding_block_cached__moe_arch_mod__prompt_kernel_mf10b
adaLN_cond__sliding_block_cached__moe_arch_mod__prompt_kernel_kv16r:
    s_waitcnt vmcnt(0) lgkmcnt(0)
    s_nop 15
    s_nop 3
    s_mov_b32 s27, 0
adaLN_cond__sliding_block_cached__moe_arch_mod__prompt_kernel_kv16p:
    buffer_load_dwordx4 v[12:15], v21, s[8:11], s18 offen sc1
    s_waitcnt vmcnt(0)
    v_xor_b32 v8, s28, v12
    v_xor_b32 v20, s28, v13
    v_or_b32 v8, v8, v20
    v_xor_b32 v20, s28, v14
    v_or_b32 v8, v8, v20
    v_xor_b32 v20, s28, v15
    v_or_b32 v8, v8, v20
    v_cmp_ne_u32 vcc, 0, v8
    s_add_u32 s27, s27, 1
    s_cmp_ge_u32 s27, 65536
    s_cbranch_scc1 adaLN_cond__sliding_block_cached__moe_arch_mod__prompt_kernel_kv16g
    s_cbranch_vccnz adaLN_cond__sliding_block_cached__moe_arch_mod__prompt_kernel_kv16p
adaLN_cond__sliding_block_cached__moe_arch_mod__prompt_kernel_kv16g:
    s_waitcnt vmcnt(0) lgkmcnt(0)
    s_nop 15
    s_nop 3
    s_branch adaLN_cond__sliding_block_cached__moe_arch_mod__prompt_kernel_kv16b
adaLN_cond__sliding_block_cached__moe_arch_mod__prompt_kernel_fixB:
    s_waitcnt vmcnt(0) lgkmcnt(0)
    s_nop 15
    s_nop 3
    s_lshr_b32 s16, s12, 3
    s_lshl_b32 s16, s16, 17
    s_add_u32 s16, s16, 0x400000
    v_add_u32 v8, s16, v2
    v_mov_b32 v16, 0xff7fffff
    v_mov_b32 v17, 0xff7fffff
    s_mov_b32 s16, 0
adaLN_cond__sliding_block_cached__moe_arch_mod__prompt_kernel_fixBm:
    s_add_u32 s17, s16, 0
    buffer_load_dwordx4 v[200:203], v8, s[8:11], s17 offen offset:0
    buffer_load_dwordx4 v[204:207], v8, s[8:11], s17 offen offset:1024
    buffer_load_dwordx4 v[208:211], v8, s[8:11], s17 offen offset:2048
    buffer_load_dwordx4 v[212:215], v8, s[8:11], s17 offen offset:3072
    s_waitcnt vmcnt(3)
    v_mfma_f32_16x16x32_bf16 v[184:187], v[200:203], v[152:155], 0
    v_mfma_f32_16x16x32_bf16 v[188:191], v[200:203], v[168:171], 0
    s_waitcnt vmcnt(2)
    v_mfma_f32_16x16x32_bf16 v[192:195], v[204:207], v[152:155], 0
    v_mfma_f32_16x16x32_bf16 v[196:199], v[204:207], v[168:171], 0
    s_waitcnt vmcnt(1)
    v_mfma_f32_16x16x32_bf16 v[184:187], v[208:211], v[156:159], v[184:187]
    v_mfma_f32_16x16x32_bf16 v[188:191], v[208:211], v[172:175], v[188:191]
    s_waitcnt vmcnt(0)
    v_mfma_f32_16x16x32_bf16 v[192:195], v[212:215], v[156:159], v[192:195]
    v_mfma_f32_16x16x32_bf16 v[196:199], v[212:215], v[172:175], v[196:199]
    s_add_u32 s17, s16, 4096
    buffer_load_dwordx4 v[200:203], v8, s[8:11], s17 offen offset:0
    buffer_load_dwordx4 v[204:207], v8, s[8:11], s17 offen offset:1024
    buffer_load_dwordx4 v[208:211], v8, s[8:11], s17 offen offset:2048
    buffer_load_dwordx4 v[212:215], v8, s[8:11], s17 offen offset:3072
    s_waitcnt vmcnt(3)
    v_mfma_f32_16x16x32_bf16 v[184:187], v[200:203], v[160:163], v[184:187]
    v_mfma_f32_16x16x32_bf16 v[188:191], v[200:203], v[176:179], v[188:191]
    s_waitcnt vmcnt(2)
    v_mfma_f32_16x16x32_bf16 v[192:195], v[204:207], v[160:163], v[192:195]
    v_mfma_f32_16x16x32_bf16 v[196:199], v[204:207], v[176:179], v[196:199]
    s_waitcnt vmcnt(1)
    v_mfma_f32_16x16x32_bf16 v[184:187], v[208:211], v[164:167], v[184:187]
    v_mfma_f32_16x16x32_bf16 v[188:191], v[208:211], v[180:183], v[188:191]
    s_waitcnt vmcnt(0)
    v_mfma_f32_16x16x32_bf16 v[192:195], v[212:215], v[164:167], v[192:195]
    v_mfma_f32_16x16x32_bf16 v[196:199], v[212:215], v[180:183], v[196:199]
    s_nop 3
    v_max3_f32 v16, v16, v184, v185
    v_max3_f32 v16, v16, v186, v187
    v_max3_f32 v17, v17, v188, v189
    v_max3_f32 v17, v17, v190, v191
    v_max3_f32 v16, v16, v192, v193
    v_max3_f32 v16, v16, v194, v195
    v_max3_f32 v17, v17, v196, v197
    v_max3_f32 v17, v17, v198, v199
    s_add_u32 s16, s16, 8192
    s_cmp_lt_u32 s16, 0x20000
    s_cbranch_scc1 adaLN_cond__sliding_block_cached__moe_arch_mod__prompt_kernel_fixBm
    v_mov_b32 v18, v16
    v_mov_b32 v19, v17
    s_nop 0
    v_permlane16_swap_b32 v16, v18
    v_permlane16_swap_b32 v17, v19
    v_max_f32 v16, v16, v18
    v_max_f32 v17, v17, v19
    v_mov_b32 v18, v16
    v_mov_b32 v19, v17
    s_nop 0
    v_permlane32_swap_b32 v16, v18
    v_permlane32_swap_b32 v17, v19
    v_max_f32 v16, v16, v18
    v_max_f32 v17, v17, v19
    v_sub_f32 v216, 0, v16
    v_sub_f32 v217, 0, v16
    v_sub_f32 v218, 0, v16
    v_sub_f32 v219, 0, v16
    v_sub_f32 v220, 0, v17
    v_sub_f32 v221, 0, v17
    v_sub_f32 v222, 0, v17
    v_sub_f32 v223, 0, v17
    s_mov_b32 s17, 0x0
    buffer_load_dwordx4 v[200:203], v8, s[8:11], s17 offen offset:0
    buffer_load_dwordx4 v[204:207], v8, s[8:11], s17 offen offset:1024
    buffer_load_dwordx4 v[208:211], v8, s[8:11], s17 offen offset:2048
    buffer_load_dwordx4 v[212:215], v8, s[8:11], s17 offen offset:3072
    s_waitcnt vmcnt(3)
    v_mfma_f32_16x16x32_bf16 v[184:187], v[200:203], v[152:155], v[216:219]
    v_mfma_f32_16x16x32_bf16 v[188:191], v[200:203], v[168:171], v[220:223]
    s_waitcnt vmcnt(2)
    v_mfma_f32_16x16x32_bf16 v[192:195], v[204:207], v[152:155], v[216:219]
    v_mfma_f32_16x16x32_bf16 v[196:199], v[204:207], v[168:171], v[220:223]
    s_waitcnt vmcnt(1)
    v_mfma_f32_16x16x32_bf16 v[184:187], v[208:211], v[156:159], v[184:187]
    v_mfma_f32_16x16x32_bf16 v[188:191], v[208:211], v[172:175], v[188:191]
    s_waitcnt vmcnt(0)
    v_mfma_f32_16x16x32_bf16 v[192:195], v[212:215], v[156:159], v[192:195]
    v_mfma_f32_16x16x32_bf16 v[196:199], v[212:215], v[172:175], v[196:199]
    s_mov_b32 s17, 0x1000
    buffer_load_dwordx4 v[200:203], v8, s[8:11], s17 offen offset:0
    buffer_load_dwordx4 v[204:207], v8, s[8:11], s17 offen offset:1024
    buffer_load_dwordx4 v[208:211], v8, s[8:11], s17 offen offset:2048
    buffer_load_dwordx4 v[212:215], v8, s[8:11], s17 offen offset:3072
    s_waitcnt vmcnt(3)
    v_mfma_f32_16x16x32_bf16 v[184:187], v[200:203], v[160:163], v[184:187]
    v_mfma_f32_16x16x32_bf16 v[188:191], v[200:203], v[176:179], v[188:191]
    s_waitcnt vmcnt(2)
    v_mfma_f32_16x16x32_bf16 v[192:195], v[204:207], v[160:163], v[192:195]
    v_mfma_f32_16x16x32_bf16 v[196:199], v[204:207], v[176:179], v[196:199]
    s_waitcnt vmcnt(1)
    v_mfma_f32_16x16x32_bf16 v[184:187], v[208:211], v[164:167], v[184:187]
    v_mfma_f32_16x16x32_bf16 v[188:191], v[208:211], v[180:183], v[188:191]
    s_waitcnt vmcnt(0)
    v_mfma_f32_16x16x32_bf16 v[192:195], v[212:215], v[164:167], v[192:195]
    v_mfma_f32_16x16x32_bf16 v[196:199], v[212:215], v[180:183], v[196:199]
    s_nop 3
    v_exp_f32 v184, v184
    v_exp_f32 v185, v185
    s_nop 0
    v_add_f32 v9, v184, v185
    v_cvt_pk_bf16_f32 v24, v184, v185
    v_exp_f32 v186, v186
    v_exp_f32 v187, v187
    v_add_f32 v9, v9, v186
    v_add_f32 v9, v9, v187
    v_cvt_pk_bf16_f32 v25, v186, v187
    v_exp_f32 v188, v188
    v_exp_f32 v189, v189
    s_nop 0
    v_add_f32 v10, v188, v189
    v_cvt_pk_bf16_f32 v28, v188, v189
    v_exp_f32 v190, v190
    v_exp_f32 v191, v191
    v_add_f32 v10, v10, v190
    v_add_f32 v10, v10, v191
    v_cvt_pk_bf16_f32 v29, v190, v191
    v_exp_f32 v192, v192
    v_exp_f32 v193, v193
    v_add_f32 v9, v9, v192
    v_add_f32 v9, v9, v193
    v_cvt_pk_bf16_f32 v26, v192, v193
    v_exp_f32 v194, v194
    v_exp_f32 v195, v195
    v_add_f32 v9, v9, v194
    v_add_f32 v9, v9, v195
    v_cvt_pk_bf16_f32 v27, v194, v195
    v_exp_f32 v196, v196
    v_exp_f32 v197, v197
    v_add_f32 v10, v10, v196
    v_add_f32 v10, v10, v197
    v_cvt_pk_bf16_f32 v30, v196, v197
    v_exp_f32 v198, v198
    v_exp_f32 v199, v199
    v_add_f32 v10, v10, v198
    v_add_f32 v10, v10, v199
    v_cvt_pk_bf16_f32 v31, v198, v199
    s_mov_b32 s17, 0x2000
    buffer_load_dwordx4 v[200:203], v8, s[8:11], s17 offen offset:0
    buffer_load_dwordx4 v[204:207], v8, s[8:11], s17 offen offset:1024
    buffer_load_dwordx4 v[208:211], v8, s[8:11], s17 offen offset:2048
    buffer_load_dwordx4 v[212:215], v8, s[8:11], s17 offen offset:3072
    s_waitcnt vmcnt(3)
    v_mfma_f32_16x16x32_bf16 v[184:187], v[200:203], v[152:155], v[216:219]
    v_mfma_f32_16x16x32_bf16 v[188:191], v[200:203], v[168:171], v[220:223]
    s_waitcnt vmcnt(2)
    v_mfma_f32_16x16x32_bf16 v[192:195], v[204:207], v[152:155], v[216:219]
    v_mfma_f32_16x16x32_bf16 v[196:199], v[204:207], v[168:171], v[220:223]
    s_waitcnt vmcnt(1)
    v_mfma_f32_16x16x32_bf16 v[184:187], v[208:211], v[156:159], v[184:187]
    v_mfma_f32_16x16x32_bf16 v[188:191], v[208:211], v[172:175], v[188:191]
    s_waitcnt vmcnt(0)
    v_mfma_f32_16x16x32_bf16 v[192:195], v[212:215], v[156:159], v[192:195]
    v_mfma_f32_16x16x32_bf16 v[196:199], v[212:215], v[172:175], v[196:199]
    s_mov_b32 s17, 0x3000
    buffer_load_dwordx4 v[200:203], v8, s[8:11], s17 offen offset:0
    buffer_load_dwordx4 v[204:207], v8, s[8:11], s17 offen offset:1024
    buffer_load_dwordx4 v[208:211], v8, s[8:11], s17 offen offset:2048
    buffer_load_dwordx4 v[212:215], v8, s[8:11], s17 offen offset:3072
    s_waitcnt vmcnt(3)
    v_mfma_f32_16x16x32_bf16 v[184:187], v[200:203], v[160:163], v[184:187]
    v_mfma_f32_16x16x32_bf16 v[188:191], v[200:203], v[176:179], v[188:191]
    s_waitcnt vmcnt(2)
    v_mfma_f32_16x16x32_bf16 v[192:195], v[204:207], v[160:163], v[192:195]
    v_mfma_f32_16x16x32_bf16 v[196:199], v[204:207], v[176:179], v[196:199]
    s_waitcnt vmcnt(1)
    v_mfma_f32_16x16x32_bf16 v[184:187], v[208:211], v[164:167], v[184:187]
    v_mfma_f32_16x16x32_bf16 v[188:191], v[208:211], v[180:183], v[188:191]
    s_waitcnt vmcnt(0)
    v_mfma_f32_16x16x32_bf16 v[192:195], v[212:215], v[164:167], v[192:195]
    v_mfma_f32_16x16x32_bf16 v[196:199], v[212:215], v[180:183], v[196:199]
    s_nop 3
    v_exp_f32 v184, v184
    v_exp_f32 v185, v185
    v_add_f32 v9, v9, v184
    v_add_f32 v9, v9, v185
    v_cvt_pk_bf16_f32 v32, v184, v185
    v_exp_f32 v186, v186
    v_exp_f32 v187, v187
    v_add_f32 v9, v9, v186
    v_add_f32 v9, v9, v187
    v_cvt_pk_bf16_f32 v33, v186, v187
    v_exp_f32 v188, v188
    v_exp_f32 v189, v189
    v_add_f32 v10, v10, v188
    v_add_f32 v10, v10, v189
    v_cvt_pk_bf16_f32 v36, v188, v189
    v_exp_f32 v190, v190
    v_exp_f32 v191, v191
    v_add_f32 v10, v10, v190
    v_add_f32 v10, v10, v191
    v_cvt_pk_bf16_f32 v37, v190, v191
    v_exp_f32 v192, v192
    v_exp_f32 v193, v193
    v_add_f32 v9, v9, v192
    v_add_f32 v9, v9, v193
    v_cvt_pk_bf16_f32 v34, v192, v193
    v_exp_f32 v194, v194
    v_exp_f32 v195, v195
    v_add_f32 v9, v9, v194
    v_add_f32 v9, v9, v195
    v_cvt_pk_bf16_f32 v35, v194, v195
    v_exp_f32 v196, v196
    v_exp_f32 v197, v197
    v_add_f32 v10, v10, v196
    v_add_f32 v10, v10, v197
    v_cvt_pk_bf16_f32 v38, v196, v197
    v_exp_f32 v198, v198
    v_exp_f32 v199, v199
    v_add_f32 v10, v10, v198
    v_add_f32 v10, v10, v199
    v_cvt_pk_bf16_f32 v39, v198, v199
    s_mov_b32 s17, 0x4000
    buffer_load_dwordx4 v[200:203], v8, s[8:11], s17 offen offset:0
    buffer_load_dwordx4 v[204:207], v8, s[8:11], s17 offen offset:1024
    buffer_load_dwordx4 v[208:211], v8, s[8:11], s17 offen offset:2048
    buffer_load_dwordx4 v[212:215], v8, s[8:11], s17 offen offset:3072
    s_waitcnt vmcnt(3)
    v_mfma_f32_16x16x32_bf16 v[184:187], v[200:203], v[152:155], v[216:219]
    v_mfma_f32_16x16x32_bf16 v[188:191], v[200:203], v[168:171], v[220:223]
    s_waitcnt vmcnt(2)
    v_mfma_f32_16x16x32_bf16 v[192:195], v[204:207], v[152:155], v[216:219]
    v_mfma_f32_16x16x32_bf16 v[196:199], v[204:207], v[168:171], v[220:223]
    s_waitcnt vmcnt(1)
    v_mfma_f32_16x16x32_bf16 v[184:187], v[208:211], v[156:159], v[184:187]
    v_mfma_f32_16x16x32_bf16 v[188:191], v[208:211], v[172:175], v[188:191]
    s_waitcnt vmcnt(0)
    v_mfma_f32_16x16x32_bf16 v[192:195], v[212:215], v[156:159], v[192:195]
    v_mfma_f32_16x16x32_bf16 v[196:199], v[212:215], v[172:175], v[196:199]
    s_mov_b32 s17, 0x5000
    buffer_load_dwordx4 v[200:203], v8, s[8:11], s17 offen offset:0
    buffer_load_dwordx4 v[204:207], v8, s[8:11], s17 offen offset:1024
    buffer_load_dwordx4 v[208:211], v8, s[8:11], s17 offen offset:2048
    buffer_load_dwordx4 v[212:215], v8, s[8:11], s17 offen offset:3072
    s_waitcnt vmcnt(3)
    v_mfma_f32_16x16x32_bf16 v[184:187], v[200:203], v[160:163], v[184:187]
    v_mfma_f32_16x16x32_bf16 v[188:191], v[200:203], v[176:179], v[188:191]
    s_waitcnt vmcnt(2)
    v_mfma_f32_16x16x32_bf16 v[192:195], v[204:207], v[160:163], v[192:195]
    v_mfma_f32_16x16x32_bf16 v[196:199], v[204:207], v[176:179], v[196:199]
    s_waitcnt vmcnt(1)
    v_mfma_f32_16x16x32_bf16 v[184:187], v[208:211], v[164:167], v[184:187]
    v_mfma_f32_16x16x32_bf16 v[188:191], v[208:211], v[180:183], v[188:191]
    s_waitcnt vmcnt(0)
    v_mfma_f32_16x16x32_bf16 v[192:195], v[212:215], v[164:167], v[192:195]
    v_mfma_f32_16x16x32_bf16 v[196:199], v[212:215], v[180:183], v[196:199]
    s_nop 3
    v_exp_f32 v184, v184
    v_exp_f32 v185, v185
    v_add_f32 v9, v9, v184
    v_add_f32 v9, v9, v185
    v_cvt_pk_bf16_f32 v40, v184, v185
    v_exp_f32 v186, v186
    v_exp_f32 v187, v187
    v_add_f32 v9, v9, v186
    v_add_f32 v9, v9, v187
    v_cvt_pk_bf16_f32 v41, v186, v187
    v_exp_f32 v188, v188
    v_exp_f32 v189, v189
    v_add_f32 v10, v10, v188
    v_add_f32 v10, v10, v189
    v_cvt_pk_bf16_f32 v44, v188, v189
    v_exp_f32 v190, v190
    v_exp_f32 v191, v191
    v_add_f32 v10, v10, v190
    v_add_f32 v10, v10, v191
    v_cvt_pk_bf16_f32 v45, v190, v191
    v_exp_f32 v192, v192
    v_exp_f32 v193, v193
    v_add_f32 v9, v9, v192
    v_add_f32 v9, v9, v193
    v_cvt_pk_bf16_f32 v42, v192, v193
    v_exp_f32 v194, v194
    v_exp_f32 v195, v195
    v_add_f32 v9, v9, v194
    v_add_f32 v9, v9, v195
    v_cvt_pk_bf16_f32 v43, v194, v195
    v_exp_f32 v196, v196
    v_exp_f32 v197, v197
    v_add_f32 v10, v10, v196
    v_add_f32 v10, v10, v197
    v_cvt_pk_bf16_f32 v46, v196, v197
    v_exp_f32 v198, v198
    v_exp_f32 v199, v199
    v_add_f32 v10, v10, v198
    v_add_f32 v10, v10, v199
    v_cvt_pk_bf16_f32 v47, v198, v199
    s_mov_b32 s17, 0x6000
    buffer_load_dwordx4 v[200:203], v8, s[8:11], s17 offen offset:0
    buffer_load_dwordx4 v[204:207], v8, s[8:11], s17 offen offset:1024
    buffer_load_dwordx4 v[208:211], v8, s[8:11], s17 offen offset:2048
    buffer_load_dwordx4 v[212:215], v8, s[8:11], s17 offen offset:3072
    s_waitcnt vmcnt(3)
    v_mfma_f32_16x16x32_bf16 v[184:187], v[200:203], v[152:155], v[216:219]
    v_mfma_f32_16x16x32_bf16 v[188:191], v[200:203], v[168:171], v[220:223]
    s_waitcnt vmcnt(2)
    v_mfma_f32_16x16x32_bf16 v[192:195], v[204:207], v[152:155], v[216:219]
    v_mfma_f32_16x16x32_bf16 v[196:199], v[204:207], v[168:171], v[220:223]
    s_waitcnt vmcnt(1)
    v_mfma_f32_16x16x32_bf16 v[184:187], v[208:211], v[156:159], v[184:187]
    v_mfma_f32_16x16x32_bf16 v[188:191], v[208:211], v[172:175], v[188:191]
    s_waitcnt vmcnt(0)
    v_mfma_f32_16x16x32_bf16 v[192:195], v[212:215], v[156:159], v[192:195]
    v_mfma_f32_16x16x32_bf16 v[196:199], v[212:215], v[172:175], v[196:199]
    s_mov_b32 s17, 0x7000
    buffer_load_dwordx4 v[200:203], v8, s[8:11], s17 offen offset:0
    buffer_load_dwordx4 v[204:207], v8, s[8:11], s17 offen offset:1024
    buffer_load_dwordx4 v[208:211], v8, s[8:11], s17 offen offset:2048
    buffer_load_dwordx4 v[212:215], v8, s[8:11], s17 offen offset:3072
    s_waitcnt vmcnt(3)
    v_mfma_f32_16x16x32_bf16 v[184:187], v[200:203], v[160:163], v[184:187]
    v_mfma_f32_16x16x32_bf16 v[188:191], v[200:203], v[176:179], v[188:191]
    s_waitcnt vmcnt(2)
    v_mfma_f32_16x16x32_bf16 v[192:195], v[204:207], v[160:163], v[192:195]
    v_mfma_f32_16x16x32_bf16 v[196:199], v[204:207], v[176:179], v[196:199]
    s_waitcnt vmcnt(1)
    v_mfma_f32_16x16x32_bf16 v[184:187], v[208:211], v[164:167], v[184:187]
    v_mfma_f32_16x16x32_bf16 v[188:191], v[208:211], v[180:183], v[188:191]
    s_waitcnt vmcnt(0)
    v_mfma_f32_16x16x32_bf16 v[192:195], v[212:215], v[164:167], v[192:195]
    v_mfma_f32_16x16x32_bf16 v[196:199], v[212:215], v[180:183], v[196:199]
    s_nop 3
    v_exp_f32 v184, v184
    v_exp_f32 v185, v185
    v_add_f32 v9, v9, v184
    v_add_f32 v9, v9, v185
    v_cvt_pk_bf16_f32 v48, v184, v185
    v_exp_f32 v186, v186
    v_exp_f32 v187, v187
    v_add_f32 v9, v9, v186
    v_add_f32 v9, v9, v187
    v_cvt_pk_bf16_f32 v49, v186, v187
    v_exp_f32 v188, v188
    v_exp_f32 v189, v189
    v_add_f32 v10, v10, v188
    v_add_f32 v10, v10, v189
    v_cvt_pk_bf16_f32 v52, v188, v189
    v_exp_f32 v190, v190
    v_exp_f32 v191, v191
    v_add_f32 v10, v10, v190
    v_add_f32 v10, v10, v191
    v_cvt_pk_bf16_f32 v53, v190, v191
    v_exp_f32 v192, v192
    v_exp_f32 v193, v193
    v_add_f32 v9, v9, v192
    v_add_f32 v9, v9, v193
    v_cvt_pk_bf16_f32 v50, v192, v193
    v_exp_f32 v194, v194
    v_exp_f32 v195, v195
    v_add_f32 v9, v9, v194
    v_add_f32 v9, v9, v195
    v_cvt_pk_bf16_f32 v51, v194, v195
    v_exp_f32 v196, v196
    v_exp_f32 v197, v197
    v_add_f32 v10, v10, v196
    v_add_f32 v10, v10, v197
    v_cvt_pk_bf16_f32 v54, v196, v197
    v_exp_f32 v198, v198
    v_exp_f32 v199, v199
    v_add_f32 v10, v10, v198
    v_add_f32 v10, v10, v199
    v_cvt_pk_bf16_f32 v55, v198, v199
    s_mov_b32 s17, 0x8000
    buffer_load_dwordx4 v[200:203], v8, s[8:11], s17 offen offset:0
    buffer_load_dwordx4 v[204:207], v8, s[8:11], s17 offen offset:1024
    buffer_load_dwordx4 v[208:211], v8, s[8:11], s17 offen offset:2048
    buffer_load_dwordx4 v[212:215], v8, s[8:11], s17 offen offset:3072
    s_waitcnt vmcnt(3)
    v_mfma_f32_16x16x32_bf16 v[184:187], v[200:203], v[152:155], v[216:219]
    v_mfma_f32_16x16x32_bf16 v[188:191], v[200:203], v[168:171], v[220:223]
    s_waitcnt vmcnt(2)
    v_mfma_f32_16x16x32_bf16 v[192:195], v[204:207], v[152:155], v[216:219]
    v_mfma_f32_16x16x32_bf16 v[196:199], v[204:207], v[168:171], v[220:223]
    s_waitcnt vmcnt(1)
    v_mfma_f32_16x16x32_bf16 v[184:187], v[208:211], v[156:159], v[184:187]
    v_mfma_f32_16x16x32_bf16 v[188:191], v[208:211], v[172:175], v[188:191]
    s_waitcnt vmcnt(0)
    v_mfma_f32_16x16x32_bf16 v[192:195], v[212:215], v[156:159], v[192:195]
    v_mfma_f32_16x16x32_bf16 v[196:199], v[212:215], v[172:175], v[196:199]
    s_mov_b32 s17, 0x9000
    buffer_load_dwordx4 v[200:203], v8, s[8:11], s17 offen offset:0
    buffer_load_dwordx4 v[204:207], v8, s[8:11], s17 offen offset:1024
    buffer_load_dwordx4 v[208:211], v8, s[8:11], s17 offen offset:2048
    buffer_load_dwordx4 v[212:215], v8, s[8:11], s17 offen offset:3072
    s_waitcnt vmcnt(3)
    v_mfma_f32_16x16x32_bf16 v[184:187], v[200:203], v[160:163], v[184:187]
    v_mfma_f32_16x16x32_bf16 v[188:191], v[200:203], v[176:179], v[188:191]
    s_waitcnt vmcnt(2)
    v_mfma_f32_16x16x32_bf16 v[192:195], v[204:207], v[160:163], v[192:195]
    v_mfma_f32_16x16x32_bf16 v[196:199], v[204:207], v[176:179], v[196:199]
    s_waitcnt vmcnt(1)
    v_mfma_f32_16x16x32_bf16 v[184:187], v[208:211], v[164:167], v[184:187]
    v_mfma_f32_16x16x32_bf16 v[188:191], v[208:211], v[180:183], v[188:191]
    s_waitcnt vmcnt(0)
    v_mfma_f32_16x16x32_bf16 v[192:195], v[212:215], v[164:167], v[192:195]
    v_mfma_f32_16x16x32_bf16 v[196:199], v[212:215], v[180:183], v[196:199]
    s_nop 3
    v_exp_f32 v184, v184
    v_exp_f32 v185, v185
    v_add_f32 v9, v9, v184
    v_add_f32 v9, v9, v185
    v_cvt_pk_bf16_f32 v56, v184, v185
    v_exp_f32 v186, v186
    v_exp_f32 v187, v187
    v_add_f32 v9, v9, v186
    v_add_f32 v9, v9, v187
    v_cvt_pk_bf16_f32 v57, v186, v187
    v_exp_f32 v188, v188
    v_exp_f32 v189, v189
    v_add_f32 v10, v10, v188
    v_add_f32 v10, v10, v189
    v_cvt_pk_bf16_f32 v60, v188, v189
    v_exp_f32 v190, v190
    v_exp_f32 v191, v191
    v_add_f32 v10, v10, v190
    v_add_f32 v10, v10, v191
    v_cvt_pk_bf16_f32 v61, v190, v191
    v_exp_f32 v192, v192
    v_exp_f32 v193, v193
    v_add_f32 v9, v9, v192
    v_add_f32 v9, v9, v193
    v_cvt_pk_bf16_f32 v58, v192, v193
    v_exp_f32 v194, v194
    v_exp_f32 v195, v195
    v_add_f32 v9, v9, v194
    v_add_f32 v9, v9, v195
    v_cvt_pk_bf16_f32 v59, v194, v195
    v_exp_f32 v196, v196
    v_exp_f32 v197, v197
    v_add_f32 v10, v10, v196
    v_add_f32 v10, v10, v197
    v_cvt_pk_bf16_f32 v62, v196, v197
    v_exp_f32 v198, v198
    v_exp_f32 v199, v199
    v_add_f32 v10, v10, v198
    v_add_f32 v10, v10, v199
    v_cvt_pk_bf16_f32 v63, v198, v199
    s_mov_b32 s17, 0xa000
    buffer_load_dwordx4 v[200:203], v8, s[8:11], s17 offen offset:0
    buffer_load_dwordx4 v[204:207], v8, s[8:11], s17 offen offset:1024
    buffer_load_dwordx4 v[208:211], v8, s[8:11], s17 offen offset:2048
    buffer_load_dwordx4 v[212:215], v8, s[8:11], s17 offen offset:3072
    s_waitcnt vmcnt(3)
    v_mfma_f32_16x16x32_bf16 v[184:187], v[200:203], v[152:155], v[216:219]
    v_mfma_f32_16x16x32_bf16 v[188:191], v[200:203], v[168:171], v[220:223]
    s_waitcnt vmcnt(2)
    v_mfma_f32_16x16x32_bf16 v[192:195], v[204:207], v[152:155], v[216:219]
    v_mfma_f32_16x16x32_bf16 v[196:199], v[204:207], v[168:171], v[220:223]
    s_waitcnt vmcnt(1)
    v_mfma_f32_16x16x32_bf16 v[184:187], v[208:211], v[156:159], v[184:187]
    v_mfma_f32_16x16x32_bf16 v[188:191], v[208:211], v[172:175], v[188:191]
    s_waitcnt vmcnt(0)
    v_mfma_f32_16x16x32_bf16 v[192:195], v[212:215], v[156:159], v[192:195]
    v_mfma_f32_16x16x32_bf16 v[196:199], v[212:215], v[172:175], v[196:199]
    s_mov_b32 s17, 0xb000
    buffer_load_dwordx4 v[200:203], v8, s[8:11], s17 offen offset:0
    buffer_load_dwordx4 v[204:207], v8, s[8:11], s17 offen offset:1024
    buffer_load_dwordx4 v[208:211], v8, s[8:11], s17 offen offset:2048
    buffer_load_dwordx4 v[212:215], v8, s[8:11], s17 offen offset:3072
    s_waitcnt vmcnt(3)
    v_mfma_f32_16x16x32_bf16 v[184:187], v[200:203], v[160:163], v[184:187]
    v_mfma_f32_16x16x32_bf16 v[188:191], v[200:203], v[176:179], v[188:191]
    s_waitcnt vmcnt(2)
    v_mfma_f32_16x16x32_bf16 v[192:195], v[204:207], v[160:163], v[192:195]
    v_mfma_f32_16x16x32_bf16 v[196:199], v[204:207], v[176:179], v[196:199]
    s_waitcnt vmcnt(1)
    v_mfma_f32_16x16x32_bf16 v[184:187], v[208:211], v[164:167], v[184:187]
    v_mfma_f32_16x16x32_bf16 v[188:191], v[208:211], v[180:183], v[188:191]
    s_waitcnt vmcnt(0)
    v_mfma_f32_16x16x32_bf16 v[192:195], v[212:215], v[164:167], v[192:195]
    v_mfma_f32_16x16x32_bf16 v[196:199], v[212:215], v[180:183], v[196:199]
    s_nop 3
    v_exp_f32 v184, v184
    v_exp_f32 v185, v185
    v_add_f32 v9, v9, v184
    v_add_f32 v9, v9, v185
    v_cvt_pk_bf16_f32 v64, v184, v185
    v_exp_f32 v186, v186
    v_exp_f32 v187, v187
    v_add_f32 v9, v9, v186
    v_add_f32 v9, v9, v187
    v_cvt_pk_bf16_f32 v65, v186, v187
    v_exp_f32 v188, v188
    v_exp_f32 v189, v189
    v_add_f32 v10, v10, v188
    v_add_f32 v10, v10, v189
    v_cvt_pk_bf16_f32 v68, v188, v189
    v_exp_f32 v190, v190
    v_exp_f32 v191, v191
    v_add_f32 v10, v10, v190
    v_add_f32 v10, v10, v191
    v_cvt_pk_bf16_f32 v69, v190, v191
    v_exp_f32 v192, v192
    v_exp_f32 v193, v193
    v_add_f32 v9, v9, v192
    v_add_f32 v9, v9, v193
    v_cvt_pk_bf16_f32 v66, v192, v193
    v_exp_f32 v194, v194
    v_exp_f32 v195, v195
    v_add_f32 v9, v9, v194
    v_add_f32 v9, v9, v195
    v_cvt_pk_bf16_f32 v67, v194, v195
    v_exp_f32 v196, v196
    v_exp_f32 v197, v197
    v_add_f32 v10, v10, v196
    v_add_f32 v10, v10, v197
    v_cvt_pk_bf16_f32 v70, v196, v197
    v_exp_f32 v198, v198
    v_exp_f32 v199, v199
    v_add_f32 v10, v10, v198
    v_add_f32 v10, v10, v199
    v_cvt_pk_bf16_f32 v71, v198, v199
    s_mov_b32 s17, 0xc000
    buffer_load_dwordx4 v[200:203], v8, s[8:11], s17 offen offset:0
    buffer_load_dwordx4 v[204:207], v8, s[8:11], s17 offen offset:1024
    buffer_load_dwordx4 v[208:211], v8, s[8:11], s17 offen offset:2048
    buffer_load_dwordx4 v[212:215], v8, s[8:11], s17 offen offset:3072
    s_waitcnt vmcnt(3)
    v_mfma_f32_16x16x32_bf16 v[184:187], v[200:203], v[152:155], v[216:219]
    v_mfma_f32_16x16x32_bf16 v[188:191], v[200:203], v[168:171], v[220:223]
    s_waitcnt vmcnt(2)
    v_mfma_f32_16x16x32_bf16 v[192:195], v[204:207], v[152:155], v[216:219]
    v_mfma_f32_16x16x32_bf16 v[196:199], v[204:207], v[168:171], v[220:223]
    s_waitcnt vmcnt(1)
    v_mfma_f32_16x16x32_bf16 v[184:187], v[208:211], v[156:159], v[184:187]
    v_mfma_f32_16x16x32_bf16 v[188:191], v[208:211], v[172:175], v[188:191]
    s_waitcnt vmcnt(0)
    v_mfma_f32_16x16x32_bf16 v[192:195], v[212:215], v[156:159], v[192:195]
    v_mfma_f32_16x16x32_bf16 v[196:199], v[212:215], v[172:175], v[196:199]
    s_mov_b32 s17, 0xd000
    buffer_load_dwordx4 v[200:203], v8, s[8:11], s17 offen offset:0
    buffer_load_dwordx4 v[204:207], v8, s[8:11], s17 offen offset:1024
    buffer_load_dwordx4 v[208:211], v8, s[8:11], s17 offen offset:2048
    buffer_load_dwordx4 v[212:215], v8, s[8:11], s17 offen offset:3072
    s_waitcnt vmcnt(3)
    v_mfma_f32_16x16x32_bf16 v[184:187], v[200:203], v[160:163], v[184:187]
    v_mfma_f32_16x16x32_bf16 v[188:191], v[200:203], v[176:179], v[188:191]
    s_waitcnt vmcnt(2)
    v_mfma_f32_16x16x32_bf16 v[192:195], v[204:207], v[160:163], v[192:195]
    v_mfma_f32_16x16x32_bf16 v[196:199], v[204:207], v[176:179], v[196:199]
    s_waitcnt vmcnt(1)
    v_mfma_f32_16x16x32_bf16 v[184:187], v[208:211], v[164:167], v[184:187]
    v_mfma_f32_16x16x32_bf16 v[188:191], v[208:211], v[180:183], v[188:191]
    s_waitcnt vmcnt(0)
    v_mfma_f32_16x16x32_bf16 v[192:195], v[212:215], v[164:167], v[192:195]
    v_mfma_f32_16x16x32_bf16 v[196:199], v[212:215], v[180:183], v[196:199]
    s_nop 3
    v_exp_f32 v184, v184
    v_exp_f32 v185, v185
    v_add_f32 v9, v9, v184
    v_add_f32 v9, v9, v185
    v_cvt_pk_bf16_f32 v72, v184, v185
    v_exp_f32 v186, v186
    v_exp_f32 v187, v187
    v_add_f32 v9, v9, v186
    v_add_f32 v9, v9, v187
    v_cvt_pk_bf16_f32 v73, v186, v187
    v_exp_f32 v188, v188
    v_exp_f32 v189, v189
    v_add_f32 v10, v10, v188
    v_add_f32 v10, v10, v189
    v_cvt_pk_bf16_f32 v76, v188, v189
    v_exp_f32 v190, v190
    v_exp_f32 v191, v191
    v_add_f32 v10, v10, v190
    v_add_f32 v10, v10, v191
    v_cvt_pk_bf16_f32 v77, v190, v191
    v_exp_f32 v192, v192
    v_exp_f32 v193, v193
    v_add_f32 v9, v9, v192
    v_add_f32 v9, v9, v193
    v_cvt_pk_bf16_f32 v74, v192, v193
    v_exp_f32 v194, v194
    v_exp_f32 v195, v195
    v_add_f32 v9, v9, v194
    v_add_f32 v9, v9, v195
    v_cvt_pk_bf16_f32 v75, v194, v195
    v_exp_f32 v196, v196
    v_exp_f32 v197, v197
    v_add_f32 v10, v10, v196
    v_add_f32 v10, v10, v197
    v_cvt_pk_bf16_f32 v78, v196, v197
    v_exp_f32 v198, v198
    v_exp_f32 v199, v199
    v_add_f32 v10, v10, v198
    v_add_f32 v10, v10, v199
    v_cvt_pk_bf16_f32 v79, v198, v199
    s_mov_b32 s17, 0xe000
    buffer_load_dwordx4 v[200:203], v8, s[8:11], s17 offen offset:0
    buffer_load_dwordx4 v[204:207], v8, s[8:11], s17 offen offset:1024
    buffer_load_dwordx4 v[208:211], v8, s[8:11], s17 offen offset:2048
    buffer_load_dwordx4 v[212:215], v8, s[8:11], s17 offen offset:3072
    s_waitcnt vmcnt(3)
    v_mfma_f32_16x16x32_bf16 v[184:187], v[200:203], v[152:155], v[216:219]
    v_mfma_f32_16x16x32_bf16 v[188:191], v[200:203], v[168:171], v[220:223]
    s_waitcnt vmcnt(2)
    v_mfma_f32_16x16x32_bf16 v[192:195], v[204:207], v[152:155], v[216:219]
    v_mfma_f32_16x16x32_bf16 v[196:199], v[204:207], v[168:171], v[220:223]
    s_waitcnt vmcnt(1)
    v_mfma_f32_16x16x32_bf16 v[184:187], v[208:211], v[156:159], v[184:187]
    v_mfma_f32_16x16x32_bf16 v[188:191], v[208:211], v[172:175], v[188:191]
    s_waitcnt vmcnt(0)
    v_mfma_f32_16x16x32_bf16 v[192:195], v[212:215], v[156:159], v[192:195]
    v_mfma_f32_16x16x32_bf16 v[196:199], v[212:215], v[172:175], v[196:199]
    s_mov_b32 s17, 0xf000
    buffer_load_dwordx4 v[200:203], v8, s[8:11], s17 offen offset:0
    buffer_load_dwordx4 v[204:207], v8, s[8:11], s17 offen offset:1024
    buffer_load_dwordx4 v[208:211], v8, s[8:11], s17 offen offset:2048
    buffer_load_dwordx4 v[212:215], v8, s[8:11], s17 offen offset:3072
    s_waitcnt vmcnt(3)
    v_mfma_f32_16x16x32_bf16 v[184:187], v[200:203], v[160:163], v[184:187]
    v_mfma_f32_16x16x32_bf16 v[188:191], v[200:203], v[176:179], v[188:191]
    s_waitcnt vmcnt(2)
    v_mfma_f32_16x16x32_bf16 v[192:195], v[204:207], v[160:163], v[192:195]
    v_mfma_f32_16x16x32_bf16 v[196:199], v[204:207], v[176:179], v[196:199]
    s_waitcnt vmcnt(1)
    v_mfma_f32_16x16x32_bf16 v[184:187], v[208:211], v[164:167], v[184:187]
    v_mfma_f32_16x16x32_bf16 v[188:191], v[208:211], v[180:183], v[188:191]
    s_waitcnt vmcnt(0)
    v_mfma_f32_16x16x32_bf16 v[192:195], v[212:215], v[164:167], v[192:195]
    v_mfma_f32_16x16x32_bf16 v[196:199], v[212:215], v[180:183], v[196:199]
    s_nop 3
    v_exp_f32 v184, v184
    v_exp_f32 v185, v185
    v_add_f32 v9, v9, v184
    v_add_f32 v9, v9, v185
    v_cvt_pk_bf16_f32 v80, v184, v185
    v_exp_f32 v186, v186
    v_exp_f32 v187, v187
    v_add_f32 v9, v9, v186
    v_add_f32 v9, v9, v187
    v_cvt_pk_bf16_f32 v81, v186, v187
    v_exp_f32 v188, v188
    v_exp_f32 v189, v189
    v_add_f32 v10, v10, v188
    v_add_f32 v10, v10, v189
    v_cvt_pk_bf16_f32 v84, v188, v189
    v_exp_f32 v190, v190
    v_exp_f32 v191, v191
    v_add_f32 v10, v10, v190
    v_add_f32 v10, v10, v191
    v_cvt_pk_bf16_f32 v85, v190, v191
    v_exp_f32 v192, v192
    v_exp_f32 v193, v193
    v_add_f32 v9, v9, v192
    v_add_f32 v9, v9, v193
    v_cvt_pk_bf16_f32 v82, v192, v193
    v_exp_f32 v194, v194
    v_exp_f32 v195, v195
    v_add_f32 v9, v9, v194
    v_add_f32 v9, v9, v195
    v_cvt_pk_bf16_f32 v83, v194, v195
    v_exp_f32 v196, v196
    v_exp_f32 v197, v197
    v_add_f32 v10, v10, v196
    v_add_f32 v10, v10, v197
    v_cvt_pk_bf16_f32 v86, v196, v197
    v_exp_f32 v198, v198
    v_exp_f32 v199, v199
    v_add_f32 v10, v10, v198
    v_add_f32 v10, v10, v199
    v_cvt_pk_bf16_f32 v87, v198, v199
    s_mov_b32 s17, 0x10000
    buffer_load_dwordx4 v[200:203], v8, s[8:11], s17 offen offset:0
    buffer_load_dwordx4 v[204:207], v8, s[8:11], s17 offen offset:1024
    buffer_load_dwordx4 v[208:211], v8, s[8:11], s17 offen offset:2048
    buffer_load_dwordx4 v[212:215], v8, s[8:11], s17 offen offset:3072
    s_waitcnt vmcnt(3)
    v_mfma_f32_16x16x32_bf16 v[184:187], v[200:203], v[152:155], v[216:219]
    v_mfma_f32_16x16x32_bf16 v[188:191], v[200:203], v[168:171], v[220:223]
    s_waitcnt vmcnt(2)
    v_mfma_f32_16x16x32_bf16 v[192:195], v[204:207], v[152:155], v[216:219]
    v_mfma_f32_16x16x32_bf16 v[196:199], v[204:207], v[168:171], v[220:223]
    s_waitcnt vmcnt(1)
    v_mfma_f32_16x16x32_bf16 v[184:187], v[208:211], v[156:159], v[184:187]
    v_mfma_f32_16x16x32_bf16 v[188:191], v[208:211], v[172:175], v[188:191]
    s_waitcnt vmcnt(0)
    v_mfma_f32_16x16x32_bf16 v[192:195], v[212:215], v[156:159], v[192:195]
    v_mfma_f32_16x16x32_bf16 v[196:199], v[212:215], v[172:175], v[196:199]
    s_mov_b32 s17, 0x11000
    buffer_load_dwordx4 v[200:203], v8, s[8:11], s17 offen offset:0
    buffer_load_dwordx4 v[204:207], v8, s[8:11], s17 offen offset:1024
    buffer_load_dwordx4 v[208:211], v8, s[8:11], s17 offen offset:2048
    buffer_load_dwordx4 v[212:215], v8, s[8:11], s17 offen offset:3072
    s_waitcnt vmcnt(3)
    v_mfma_f32_16x16x32_bf16 v[184:187], v[200:203], v[160:163], v[184:187]
    v_mfma_f32_16x16x32_bf16 v[188:191], v[200:203], v[176:179], v[188:191]
    s_waitcnt vmcnt(2)
    v_mfma_f32_16x16x32_bf16 v[192:195], v[204:207], v[160:163], v[192:195]
    v_mfma_f32_16x16x32_bf16 v[196:199], v[204:207], v[176:179], v[196:199]
    s_waitcnt vmcnt(1)
    v_mfma_f32_16x16x32_bf16 v[184:187], v[208:211], v[164:167], v[184:187]
    v_mfma_f32_16x16x32_bf16 v[188:191], v[208:211], v[180:183], v[188:191]
    s_waitcnt vmcnt(0)
    v_mfma_f32_16x16x32_bf16 v[192:195], v[212:215], v[164:167], v[192:195]
    v_mfma_f32_16x16x32_bf16 v[196:199], v[212:215], v[180:183], v[196:199]
    s_nop 3
    v_exp_f32 v184, v184
    v_exp_f32 v185, v185
    v_add_f32 v9, v9, v184
    v_add_f32 v9, v9, v185
    v_cvt_pk_bf16_f32 v88, v184, v185
    v_exp_f32 v186, v186
    v_exp_f32 v187, v187
    v_add_f32 v9, v9, v186
    v_add_f32 v9, v9, v187
    v_cvt_pk_bf16_f32 v89, v186, v187
    v_exp_f32 v188, v188
    v_exp_f32 v189, v189
    v_add_f32 v10, v10, v188
    v_add_f32 v10, v10, v189
    v_cvt_pk_bf16_f32 v92, v188, v189
    v_exp_f32 v190, v190
    v_exp_f32 v191, v191
    v_add_f32 v10, v10, v190
    v_add_f32 v10, v10, v191
    v_cvt_pk_bf16_f32 v93, v190, v191
    v_exp_f32 v192, v192
    v_exp_f32 v193, v193
    v_add_f32 v9, v9, v192
    v_add_f32 v9, v9, v193
    v_cvt_pk_bf16_f32 v90, v192, v193
    v_exp_f32 v194, v194
    v_exp_f32 v195, v195
    v_add_f32 v9, v9, v194
    v_add_f32 v9, v9, v195
    v_cvt_pk_bf16_f32 v91, v194, v195
    v_exp_f32 v196, v196
    v_exp_f32 v197, v197
    v_add_f32 v10, v10, v196
    v_add_f32 v10, v10, v197
    v_cvt_pk_bf16_f32 v94, v196, v197
    v_exp_f32 v198, v198
    v_exp_f32 v199, v199
    v_add_f32 v10, v10, v198
    v_add_f32 v10, v10, v199
    v_cvt_pk_bf16_f32 v95, v198, v199
    s_mov_b32 s17, 0x12000
    buffer_load_dwordx4 v[200:203], v8, s[8:11], s17 offen offset:0
    buffer_load_dwordx4 v[204:207], v8, s[8:11], s17 offen offset:1024
    buffer_load_dwordx4 v[208:211], v8, s[8:11], s17 offen offset:2048
    buffer_load_dwordx4 v[212:215], v8, s[8:11], s17 offen offset:3072
    s_waitcnt vmcnt(3)
    v_mfma_f32_16x16x32_bf16 v[184:187], v[200:203], v[152:155], v[216:219]
    v_mfma_f32_16x16x32_bf16 v[188:191], v[200:203], v[168:171], v[220:223]
    s_waitcnt vmcnt(2)
    v_mfma_f32_16x16x32_bf16 v[192:195], v[204:207], v[152:155], v[216:219]
    v_mfma_f32_16x16x32_bf16 v[196:199], v[204:207], v[168:171], v[220:223]
    s_waitcnt vmcnt(1)
    v_mfma_f32_16x16x32_bf16 v[184:187], v[208:211], v[156:159], v[184:187]
    v_mfma_f32_16x16x32_bf16 v[188:191], v[208:211], v[172:175], v[188:191]
    s_waitcnt vmcnt(0)
    v_mfma_f32_16x16x32_bf16 v[192:195], v[212:215], v[156:159], v[192:195]
    v_mfma_f32_16x16x32_bf16 v[196:199], v[212:215], v[172:175], v[196:199]
    s_mov_b32 s17, 0x13000
    buffer_load_dwordx4 v[200:203], v8, s[8:11], s17 offen offset:0
    buffer_load_dwordx4 v[204:207], v8, s[8:11], s17 offen offset:1024
    buffer_load_dwordx4 v[208:211], v8, s[8:11], s17 offen offset:2048
    buffer_load_dwordx4 v[212:215], v8, s[8:11], s17 offen offset:3072
    s_waitcnt vmcnt(3)
    v_mfma_f32_16x16x32_bf16 v[184:187], v[200:203], v[160:163], v[184:187]
    v_mfma_f32_16x16x32_bf16 v[188:191], v[200:203], v[176:179], v[188:191]
    s_waitcnt vmcnt(2)
    v_mfma_f32_16x16x32_bf16 v[192:195], v[204:207], v[160:163], v[192:195]
    v_mfma_f32_16x16x32_bf16 v[196:199], v[204:207], v[176:179], v[196:199]
    s_waitcnt vmcnt(1)
    v_mfma_f32_16x16x32_bf16 v[184:187], v[208:211], v[164:167], v[184:187]
    v_mfma_f32_16x16x32_bf16 v[188:191], v[208:211], v[180:183], v[188:191]
    s_waitcnt vmcnt(0)
    v_mfma_f32_16x16x32_bf16 v[192:195], v[212:215], v[164:167], v[192:195]
    v_mfma_f32_16x16x32_bf16 v[196:199], v[212:215], v[180:183], v[196:199]
    s_nop 3
    v_exp_f32 v184, v184
    v_exp_f32 v185, v185
    v_add_f32 v9, v9, v184
    v_add_f32 v9, v9, v185
    v_cvt_pk_bf16_f32 v96, v184, v185
    v_exp_f32 v186, v186
    v_exp_f32 v187, v187
    v_add_f32 v9, v9, v186
    v_add_f32 v9, v9, v187
    v_cvt_pk_bf16_f32 v97, v186, v187
    v_exp_f32 v188, v188
    v_exp_f32 v189, v189
    v_add_f32 v10, v10, v188
    v_add_f32 v10, v10, v189
    v_cvt_pk_bf16_f32 v100, v188, v189
    v_exp_f32 v190, v190
    v_exp_f32 v191, v191
    v_add_f32 v10, v10, v190
    v_add_f32 v10, v10, v191
    v_cvt_pk_bf16_f32 v101, v190, v191
    v_exp_f32 v192, v192
    v_exp_f32 v193, v193
    v_add_f32 v9, v9, v192
    v_add_f32 v9, v9, v193
    v_cvt_pk_bf16_f32 v98, v192, v193
    v_exp_f32 v194, v194
    v_exp_f32 v195, v195
    v_add_f32 v9, v9, v194
    v_add_f32 v9, v9, v195
    v_cvt_pk_bf16_f32 v99, v194, v195
    v_exp_f32 v196, v196
    v_exp_f32 v197, v197
    v_add_f32 v10, v10, v196
    v_add_f32 v10, v10, v197
    v_cvt_pk_bf16_f32 v102, v196, v197
    v_exp_f32 v198, v198
    v_exp_f32 v199, v199
    v_add_f32 v10, v10, v198
    v_add_f32 v10, v10, v199
    v_cvt_pk_bf16_f32 v103, v198, v199
    s_mov_b32 s17, 0x14000
    buffer_load_dwordx4 v[200:203], v8, s[8:11], s17 offen offset:0
    buffer_load_dwordx4 v[204:207], v8, s[8:11], s17 offen offset:1024
    buffer_load_dwordx4 v[208:211], v8, s[8:11], s17 offen offset:2048
    buffer_load_dwordx4 v[212:215], v8, s[8:11], s17 offen offset:3072
    s_waitcnt vmcnt(3)
    v_mfma_f32_16x16x32_bf16 v[184:187], v[200:203], v[152:155], v[216:219]
    v_mfma_f32_16x16x32_bf16 v[188:191], v[200:203], v[168:171], v[220:223]
    s_waitcnt vmcnt(2)
    v_mfma_f32_16x16x32_bf16 v[192:195], v[204:207], v[152:155], v[216:219]
    v_mfma_f32_16x16x32_bf16 v[196:199], v[204:207], v[168:171], v[220:223]
    s_waitcnt vmcnt(1)
    v_mfma_f32_16x16x32_bf16 v[184:187], v[208:211], v[156:159], v[184:187]
    v_mfma_f32_16x16x32_bf16 v[188:191], v[208:211], v[172:175], v[188:191]
    s_waitcnt vmcnt(0)
    v_mfma_f32_16x16x32_bf16 v[192:195], v[212:215], v[156:159], v[192:195]
    v_mfma_f32_16x16x32_bf16 v[196:199], v[212:215], v[172:175], v[196:199]
    s_mov_b32 s17, 0x15000
    buffer_load_dwordx4 v[200:203], v8, s[8:11], s17 offen offset:0
    buffer_load_dwordx4 v[204:207], v8, s[8:11], s17 offen offset:1024
    buffer_load_dwordx4 v[208:211], v8, s[8:11], s17 offen offset:2048
    buffer_load_dwordx4 v[212:215], v8, s[8:11], s17 offen offset:3072
    s_waitcnt vmcnt(3)
    v_mfma_f32_16x16x32_bf16 v[184:187], v[200:203], v[160:163], v[184:187]
    v_mfma_f32_16x16x32_bf16 v[188:191], v[200:203], v[176:179], v[188:191]
    s_waitcnt vmcnt(2)
    v_mfma_f32_16x16x32_bf16 v[192:195], v[204:207], v[160:163], v[192:195]
    v_mfma_f32_16x16x32_bf16 v[196:199], v[204:207], v[176:179], v[196:199]
    s_waitcnt vmcnt(1)
    v_mfma_f32_16x16x32_bf16 v[184:187], v[208:211], v[164:167], v[184:187]
    v_mfma_f32_16x16x32_bf16 v[188:191], v[208:211], v[180:183], v[188:191]
    s_waitcnt vmcnt(0)
    v_mfma_f32_16x16x32_bf16 v[192:195], v[212:215], v[164:167], v[192:195]
    v_mfma_f32_16x16x32_bf16 v[196:199], v[212:215], v[180:183], v[196:199]
    s_nop 3
    v_exp_f32 v184, v184
    v_exp_f32 v185, v185
    v_add_f32 v9, v9, v184
    v_add_f32 v9, v9, v185
    v_cvt_pk_bf16_f32 v104, v184, v185
    v_exp_f32 v186, v186
    v_exp_f32 v187, v187
    v_add_f32 v9, v9, v186
    v_add_f32 v9, v9, v187
    v_cvt_pk_bf16_f32 v105, v186, v187
    v_exp_f32 v188, v188
    v_exp_f32 v189, v189
    v_add_f32 v10, v10, v188
    v_add_f32 v10, v10, v189
    v_cvt_pk_bf16_f32 v108, v188, v189
    v_exp_f32 v190, v190
    v_exp_f32 v191, v191
    v_add_f32 v10, v10, v190
    v_add_f32 v10, v10, v191
    v_cvt_pk_bf16_f32 v109, v190, v191
    v_exp_f32 v192, v192
    v_exp_f32 v193, v193
    v_add_f32 v9, v9, v192
    v_add_f32 v9, v9, v193
    v_cvt_pk_bf16_f32 v106, v192, v193
    v_exp_f32 v194, v194
    v_exp_f32 v195, v195
    v_add_f32 v9, v9, v194
    v_add_f32 v9, v9, v195
    v_cvt_pk_bf16_f32 v107, v194, v195
    v_exp_f32 v196, v196
    v_exp_f32 v197, v197
    v_add_f32 v10, v10, v196
    v_add_f32 v10, v10, v197
    v_cvt_pk_bf16_f32 v110, v196, v197
    v_exp_f32 v198, v198
    v_exp_f32 v199, v199
    v_add_f32 v10, v10, v198
    v_add_f32 v10, v10, v199
    v_cvt_pk_bf16_f32 v111, v198, v199
    s_mov_b32 s17, 0x16000
    buffer_load_dwordx4 v[200:203], v8, s[8:11], s17 offen offset:0
    buffer_load_dwordx4 v[204:207], v8, s[8:11], s17 offen offset:1024
    buffer_load_dwordx4 v[208:211], v8, s[8:11], s17 offen offset:2048
    buffer_load_dwordx4 v[212:215], v8, s[8:11], s17 offen offset:3072
    s_waitcnt vmcnt(3)
    v_mfma_f32_16x16x32_bf16 v[184:187], v[200:203], v[152:155], v[216:219]
    v_mfma_f32_16x16x32_bf16 v[188:191], v[200:203], v[168:171], v[220:223]
    s_waitcnt vmcnt(2)
    v_mfma_f32_16x16x32_bf16 v[192:195], v[204:207], v[152:155], v[216:219]
    v_mfma_f32_16x16x32_bf16 v[196:199], v[204:207], v[168:171], v[220:223]
    s_waitcnt vmcnt(1)
    v_mfma_f32_16x16x32_bf16 v[184:187], v[208:211], v[156:159], v[184:187]
    v_mfma_f32_16x16x32_bf16 v[188:191], v[208:211], v[172:175], v[188:191]
    s_waitcnt vmcnt(0)
    v_mfma_f32_16x16x32_bf16 v[192:195], v[212:215], v[156:159], v[192:195]
    v_mfma_f32_16x16x32_bf16 v[196:199], v[212:215], v[172:175], v[196:199]
    s_mov_b32 s17, 0x17000
    buffer_load_dwordx4 v[200:203], v8, s[8:11], s17 offen offset:0
    buffer_load_dwordx4 v[204:207], v8, s[8:11], s17 offen offset:1024
    buffer_load_dwordx4 v[208:211], v8, s[8:11], s17 offen offset:2048
    buffer_load_dwordx4 v[212:215], v8, s[8:11], s17 offen offset:3072
    s_waitcnt vmcnt(3)
    v_mfma_f32_16x16x32_bf16 v[184:187], v[200:203], v[160:163], v[184:187]
    v_mfma_f32_16x16x32_bf16 v[188:191], v[200:203], v[176:179], v[188:191]
    s_waitcnt vmcnt(2)
    v_mfma_f32_16x16x32_bf16 v[192:195], v[204:207], v[160:163], v[192:195]
    v_mfma_f32_16x16x32_bf16 v[196:199], v[204:207], v[176:179], v[196:199]
    s_waitcnt vmcnt(1)
    v_mfma_f32_16x16x32_bf16 v[184:187], v[208:211], v[164:167], v[184:187]
    v_mfma_f32_16x16x32_bf16 v[188:191], v[208:211], v[180:183], v[188:191]
    s_waitcnt vmcnt(0)
    v_mfma_f32_16x16x32_bf16 v[192:195], v[212:215], v[164:167], v[192:195]
    v_mfma_f32_16x16x32_bf16 v[196:199], v[212:215], v[180:183], v[196:199]
    s_nop 3
    v_exp_f32 v184, v184
    v_exp_f32 v185, v185
    v_add_f32 v9, v9, v184
    v_add_f32 v9, v9, v185
    v_cvt_pk_bf16_f32 v112, v184, v185
    v_exp_f32 v186, v186
    v_exp_f32 v187, v187
    v_add_f32 v9, v9, v186
    v_add_f32 v9, v9, v187
    v_cvt_pk_bf16_f32 v113, v186, v187
    v_exp_f32 v188, v188
    v_exp_f32 v189, v189
    v_add_f32 v10, v10, v188
    v_add_f32 v10, v10, v189
    v_cvt_pk_bf16_f32 v116, v188, v189
    v_exp_f32 v190, v190
    v_exp_f32 v191, v191
    v_add_f32 v10, v10, v190
    v_add_f32 v10, v10, v191
    v_cvt_pk_bf16_f32 v117, v190, v191
    v_exp_f32 v192, v192
    v_exp_f32 v193, v193
    v_add_f32 v9, v9, v192
    v_add_f32 v9, v9, v193
    v_cvt_pk_bf16_f32 v114, v192, v193
    v_exp_f32 v194, v194
    v_exp_f32 v195, v195
    v_add_f32 v9, v9, v194
    v_add_f32 v9, v9, v195
    v_cvt_pk_bf16_f32 v115, v194, v195
    v_exp_f32 v196, v196
    v_exp_f32 v197, v197
    v_add_f32 v10, v10, v196
    v_add_f32 v10, v10, v197
    v_cvt_pk_bf16_f32 v118, v196, v197
    v_exp_f32 v198, v198
    v_exp_f32 v199, v199
    v_add_f32 v10, v10, v198
    v_add_f32 v10, v10, v199
    v_cvt_pk_bf16_f32 v119, v198, v199
    s_mov_b32 s17, 0x18000
    buffer_load_dwordx4 v[200:203], v8, s[8:11], s17 offen offset:0
    buffer_load_dwordx4 v[204:207], v8, s[8:11], s17 offen offset:1024
    buffer_load_dwordx4 v[208:211], v8, s[8:11], s17 offen offset:2048
    buffer_load_dwordx4 v[212:215], v8, s[8:11], s17 offen offset:3072
    s_waitcnt vmcnt(3)
    v_mfma_f32_16x16x32_bf16 v[184:187], v[200:203], v[152:155], v[216:219]
    v_mfma_f32_16x16x32_bf16 v[188:191], v[200:203], v[168:171], v[220:223]
    s_waitcnt vmcnt(2)
    v_mfma_f32_16x16x32_bf16 v[192:195], v[204:207], v[152:155], v[216:219]
    v_mfma_f32_16x16x32_bf16 v[196:199], v[204:207], v[168:171], v[220:223]
    s_waitcnt vmcnt(1)
    v_mfma_f32_16x16x32_bf16 v[184:187], v[208:211], v[156:159], v[184:187]
    v_mfma_f32_16x16x32_bf16 v[188:191], v[208:211], v[172:175], v[188:191]
    s_waitcnt vmcnt(0)
    v_mfma_f32_16x16x32_bf16 v[192:195], v[212:215], v[156:159], v[192:195]
    v_mfma_f32_16x16x32_bf16 v[196:199], v[212:215], v[172:175], v[196:199]
    s_mov_b32 s17, 0x19000
    buffer_load_dwordx4 v[200:203], v8, s[8:11], s17 offen offset:0
    buffer_load_dwordx4 v[204:207], v8, s[8:11], s17 offen offset:1024
    buffer_load_dwordx4 v[208:211], v8, s[8:11], s17 offen offset:2048
    buffer_load_dwordx4 v[212:215], v8, s[8:11], s17 offen offset:3072
    s_waitcnt vmcnt(3)
    v_mfma_f32_16x16x32_bf16 v[184:187], v[200:203], v[160:163], v[184:187]
    v_mfma_f32_16x16x32_bf16 v[188:191], v[200:203], v[176:179], v[188:191]
    s_waitcnt vmcnt(2)
    v_mfma_f32_16x16x32_bf16 v[192:195], v[204:207], v[160:163], v[192:195]
    v_mfma_f32_16x16x32_bf16 v[196:199], v[204:207], v[176:179], v[196:199]
    s_waitcnt vmcnt(1)
    v_mfma_f32_16x16x32_bf16 v[184:187], v[208:211], v[164:167], v[184:187]
    v_mfma_f32_16x16x32_bf16 v[188:191], v[208:211], v[180:183], v[188:191]
    s_waitcnt vmcnt(0)
    v_mfma_f32_16x16x32_bf16 v[192:195], v[212:215], v[164:167], v[192:195]
    v_mfma_f32_16x16x32_bf16 v[196:199], v[212:215], v[180:183], v[196:199]
    s_nop 3
    v_exp_f32 v184, v184
    v_exp_f32 v185, v185
    v_add_f32 v9, v9, v184
    v_add_f32 v9, v9, v185
    v_cvt_pk_bf16_f32 v120, v184, v185
    v_exp_f32 v186, v186
    v_exp_f32 v187, v187
    v_add_f32 v9, v9, v186
    v_add_f32 v9, v9, v187
    v_cvt_pk_bf16_f32 v121, v186, v187
    v_exp_f32 v188, v188
    v_exp_f32 v189, v189
    v_add_f32 v10, v10, v188
    v_add_f32 v10, v10, v189
    v_cvt_pk_bf16_f32 v124, v188, v189
    v_exp_f32 v190, v190
    v_exp_f32 v191, v191
    v_add_f32 v10, v10, v190
    v_add_f32 v10, v10, v191
    v_cvt_pk_bf16_f32 v125, v190, v191
    v_exp_f32 v192, v192
    v_exp_f32 v193, v193
    v_add_f32 v9, v9, v192
    v_add_f32 v9, v9, v193
    v_cvt_pk_bf16_f32 v122, v192, v193
    v_exp_f32 v194, v194
    v_exp_f32 v195, v195
    v_add_f32 v9, v9, v194
    v_add_f32 v9, v9, v195
    v_cvt_pk_bf16_f32 v123, v194, v195
    v_exp_f32 v196, v196
    v_exp_f32 v197, v197
    v_add_f32 v10, v10, v196
    v_add_f32 v10, v10, v197
    v_cvt_pk_bf16_f32 v126, v196, v197
    v_exp_f32 v198, v198
    v_exp_f32 v199, v199
    v_add_f32 v10, v10, v198
    v_add_f32 v10, v10, v199
    v_cvt_pk_bf16_f32 v127, v198, v199
    s_mov_b32 s17, 0x1a000
    buffer_load_dwordx4 v[200:203], v8, s[8:11], s17 offen offset:0
    buffer_load_dwordx4 v[204:207], v8, s[8:11], s17 offen offset:1024
    buffer_load_dwordx4 v[208:211], v8, s[8:11], s17 offen offset:2048
    buffer_load_dwordx4 v[212:215], v8, s[8:11], s17 offen offset:3072
    s_waitcnt vmcnt(3)
    v_mfma_f32_16x16x32_bf16 v[184:187], v[200:203], v[152:155], v[216:219]
    v_mfma_f32_16x16x32_bf16 v[188:191], v[200:203], v[168:171], v[220:223]
    s_waitcnt vmcnt(2)
    v_mfma_f32_16x16x32_bf16 v[192:195], v[204:207], v[152:155], v[216:219]
    v_mfma_f32_16x16x32_bf16 v[196:199], v[204:207], v[168:171], v[220:223]
    s_waitcnt vmcnt(1)
    v_mfma_f32_16x16x32_bf16 v[184:187], v[208:211], v[156:159], v[184:187]
    v_mfma_f32_16x16x32_bf16 v[188:191], v[208:211], v[172:175], v[188:191]
    s_waitcnt vmcnt(0)
    v_mfma_f32_16x16x32_bf16 v[192:195], v[212:215], v[156:159], v[192:195]
    v_mfma_f32_16x16x32_bf16 v[196:199], v[212:215], v[172:175], v[196:199]
    s_mov_b32 s17, 0x1b000
    buffer_load_dwordx4 v[200:203], v8, s[8:11], s17 offen offset:0
    buffer_load_dwordx4 v[204:207], v8, s[8:11], s17 offen offset:1024
    buffer_load_dwordx4 v[208:211], v8, s[8:11], s17 offen offset:2048
    buffer_load_dwordx4 v[212:215], v8, s[8:11], s17 offen offset:3072
    s_waitcnt vmcnt(3)
    v_mfma_f32_16x16x32_bf16 v[184:187], v[200:203], v[160:163], v[184:187]
    v_mfma_f32_16x16x32_bf16 v[188:191], v[200:203], v[176:179], v[188:191]
    s_waitcnt vmcnt(2)
    v_mfma_f32_16x16x32_bf16 v[192:195], v[204:207], v[160:163], v[192:195]
    v_mfma_f32_16x16x32_bf16 v[196:199], v[204:207], v[176:179], v[196:199]
    s_waitcnt vmcnt(1)
    v_mfma_f32_16x16x32_bf16 v[184:187], v[208:211], v[164:167], v[184:187]
    v_mfma_f32_16x16x32_bf16 v[188:191], v[208:211], v[180:183], v[188:191]
    s_waitcnt vmcnt(0)
    v_mfma_f32_16x16x32_bf16 v[192:195], v[212:215], v[164:167], v[192:195]
    v_mfma_f32_16x16x32_bf16 v[196:199], v[212:215], v[180:183], v[196:199]
    s_nop 3
    v_exp_f32 v184, v184
    v_exp_f32 v185, v185
    v_add_f32 v9, v9, v184
    v_add_f32 v9, v9, v185
    v_cvt_pk_bf16_f32 v128, v184, v185
    v_exp_f32 v186, v186
    v_exp_f32 v187, v187
    v_add_f32 v9, v9, v186
    v_add_f32 v9, v9, v187
    v_cvt_pk_bf16_f32 v129, v186, v187
    v_exp_f32 v188, v188
    v_exp_f32 v189, v189
    v_add_f32 v10, v10, v188
    v_add_f32 v10, v10, v189
    v_cvt_pk_bf16_f32 v132, v188, v189
    v_exp_f32 v190, v190
    v_exp_f32 v191, v191
    v_add_f32 v10, v10, v190
    v_add_f32 v10, v10, v191
    v_cvt_pk_bf16_f32 v133, v190, v191
    v_exp_f32 v192, v192
    v_exp_f32 v193, v193
    v_add_f32 v9, v9, v192
    v_add_f32 v9, v9, v193
    v_cvt_pk_bf16_f32 v130, v192, v193
    v_exp_f32 v194, v194
    v_exp_f32 v195, v195
    v_add_f32 v9, v9, v194
    v_add_f32 v9, v9, v195
    v_cvt_pk_bf16_f32 v131, v194, v195
    v_exp_f32 v196, v196
    v_exp_f32 v197, v197
    v_add_f32 v10, v10, v196
    v_add_f32 v10, v10, v197
    v_cvt_pk_bf16_f32 v134, v196, v197
    v_exp_f32 v198, v198
    v_exp_f32 v199, v199
    v_add_f32 v10, v10, v198
    v_add_f32 v10, v10, v199
    v_cvt_pk_bf16_f32 v135, v198, v199
    s_mov_b32 s17, 0x1c000
    buffer_load_dwordx4 v[200:203], v8, s[8:11], s17 offen offset:0
    buffer_load_dwordx4 v[204:207], v8, s[8:11], s17 offen offset:1024
    buffer_load_dwordx4 v[208:211], v8, s[8:11], s17 offen offset:2048
    buffer_load_dwordx4 v[212:215], v8, s[8:11], s17 offen offset:3072
    s_waitcnt vmcnt(3)
    v_mfma_f32_16x16x32_bf16 v[184:187], v[200:203], v[152:155], v[216:219]
    v_mfma_f32_16x16x32_bf16 v[188:191], v[200:203], v[168:171], v[220:223]
    s_waitcnt vmcnt(2)
    v_mfma_f32_16x16x32_bf16 v[192:195], v[204:207], v[152:155], v[216:219]
    v_mfma_f32_16x16x32_bf16 v[196:199], v[204:207], v[168:171], v[220:223]
    s_waitcnt vmcnt(1)
    v_mfma_f32_16x16x32_bf16 v[184:187], v[208:211], v[156:159], v[184:187]
    v_mfma_f32_16x16x32_bf16 v[188:191], v[208:211], v[172:175], v[188:191]
    s_waitcnt vmcnt(0)
    v_mfma_f32_16x16x32_bf16 v[192:195], v[212:215], v[156:159], v[192:195]
    v_mfma_f32_16x16x32_bf16 v[196:199], v[212:215], v[172:175], v[196:199]
    s_mov_b32 s17, 0x1d000
    buffer_load_dwordx4 v[200:203], v8, s[8:11], s17 offen offset:0
    buffer_load_dwordx4 v[204:207], v8, s[8:11], s17 offen offset:1024
    buffer_load_dwordx4 v[208:211], v8, s[8:11], s17 offen offset:2048
    buffer_load_dwordx4 v[212:215], v8, s[8:11], s17 offen offset:3072
    s_waitcnt vmcnt(3)
    v_mfma_f32_16x16x32_bf16 v[184:187], v[200:203], v[160:163], v[184:187]
    v_mfma_f32_16x16x32_bf16 v[188:191], v[200:203], v[176:179], v[188:191]
    s_waitcnt vmcnt(2)
    v_mfma_f32_16x16x32_bf16 v[192:195], v[204:207], v[160:163], v[192:195]
    v_mfma_f32_16x16x32_bf16 v[196:199], v[204:207], v[176:179], v[196:199]
    s_waitcnt vmcnt(1)
    v_mfma_f32_16x16x32_bf16 v[184:187], v[208:211], v[164:167], v[184:187]
    v_mfma_f32_16x16x32_bf16 v[188:191], v[208:211], v[180:183], v[188:191]
    s_waitcnt vmcnt(0)
    v_mfma_f32_16x16x32_bf16 v[192:195], v[212:215], v[164:167], v[192:195]
    v_mfma_f32_16x16x32_bf16 v[196:199], v[212:215], v[180:183], v[196:199]
    s_nop 3
    v_exp_f32 v184, v184
    v_exp_f32 v185, v185
    v_add_f32 v9, v9, v184
    v_add_f32 v9, v9, v185
    v_cvt_pk_bf16_f32 v136, v184, v185
    v_exp_f32 v186, v186
    v_exp_f32 v187, v187
    v_add_f32 v9, v9, v186
    v_add_f32 v9, v9, v187
    v_cvt_pk_bf16_f32 v137, v186, v187
    v_exp_f32 v188, v188
    v_exp_f32 v189, v189
    v_add_f32 v10, v10, v188
    v_add_f32 v10, v10, v189
    v_cvt_pk_bf16_f32 v140, v188, v189
    v_exp_f32 v190, v190
    v_exp_f32 v191, v191
    v_add_f32 v10, v10, v190
    v_add_f32 v10, v10, v191
    v_cvt_pk_bf16_f32 v141, v190, v191
    v_exp_f32 v192, v192
    v_exp_f32 v193, v193
    v_add_f32 v9, v9, v192
    v_add_f32 v9, v9, v193
    v_cvt_pk_bf16_f32 v138, v192, v193
    v_exp_f32 v194, v194
    v_exp_f32 v195, v195
    v_add_f32 v9, v9, v194
    v_add_f32 v9, v9, v195
    v_cvt_pk_bf16_f32 v139, v194, v195
    v_exp_f32 v196, v196
    v_exp_f32 v197, v197
    v_add_f32 v10, v10, v196
    v_add_f32 v10, v10, v197
    v_cvt_pk_bf16_f32 v142, v196, v197
    v_exp_f32 v198, v198
    v_exp_f32 v199, v199
    v_add_f32 v10, v10, v198
    v_add_f32 v10, v10, v199
    v_cvt_pk_bf16_f32 v143, v198, v199
    s_mov_b32 s17, 0x1e000
    buffer_load_dwordx4 v[200:203], v8, s[8:11], s17 offen offset:0
    buffer_load_dwordx4 v[204:207], v8, s[8:11], s17 offen offset:1024
    buffer_load_dwordx4 v[208:211], v8, s[8:11], s17 offen offset:2048
    buffer_load_dwordx4 v[212:215], v8, s[8:11], s17 offen offset:3072
    s_waitcnt vmcnt(3)
    v_mfma_f32_16x16x32_bf16 v[184:187], v[200:203], v[152:155], v[216:219]
    v_mfma_f32_16x16x32_bf16 v[188:191], v[200:203], v[168:171], v[220:223]
    s_waitcnt vmcnt(2)
    v_mfma_f32_16x16x32_bf16 v[192:195], v[204:207], v[152:155], v[216:219]
    v_mfma_f32_16x16x32_bf16 v[196:199], v[204:207], v[168:171], v[220:223]
    s_waitcnt vmcnt(1)
    v_mfma_f32_16x16x32_bf16 v[184:187], v[208:211], v[156:159], v[184:187]
    v_mfma_f32_16x16x32_bf16 v[188:191], v[208:211], v[172:175], v[188:191]
    s_waitcnt vmcnt(0)
    v_mfma_f32_16x16x32_bf16 v[192:195], v[212:215], v[156:159], v[192:195]
    v_mfma_f32_16x16x32_bf16 v[196:199], v[212:215], v[172:175], v[196:199]
    s_mov_b32 s17, 0x1f000
    buffer_load_dwordx4 v[200:203], v8, s[8:11], s17 offen offset:0
    buffer_load_dwordx4 v[204:207], v8, s[8:11], s17 offen offset:1024
    buffer_load_dwordx4 v[208:211], v8, s[8:11], s17 offen offset:2048
    buffer_load_dwordx4 v[212:215], v8, s[8:11], s17 offen offset:3072
    s_waitcnt vmcnt(3)
    v_mfma_f32_16x16x32_bf16 v[184:187], v[200:203], v[160:163], v[184:187]
    v_mfma_f32_16x16x32_bf16 v[188:191], v[200:203], v[176:179], v[188:191]
    s_waitcnt vmcnt(2)
    v_mfma_f32_16x16x32_bf16 v[192:195], v[204:207], v[160:163], v[192:195]
    v_mfma_f32_16x16x32_bf16 v[196:199], v[204:207], v[176:179], v[196:199]
    s_waitcnt vmcnt(1)
    v_mfma_f32_16x16x32_bf16 v[184:187], v[208:211], v[164:167], v[184:187]
    v_mfma_f32_16x16x32_bf16 v[188:191], v[208:211], v[180:183], v[188:191]
    s_waitcnt vmcnt(0)
    v_mfma_f32_16x16x32_bf16 v[192:195], v[212:215], v[164:167], v[192:195]
    v_mfma_f32_16x16x32_bf16 v[196:199], v[212:215], v[180:183], v[196:199]
    s_nop 3
    v_exp_f32 v184, v184
    v_exp_f32 v185, v185
    v_add_f32 v9, v9, v184
    v_add_f32 v9, v9, v185
    v_cvt_pk_bf16_f32 v144, v184, v185
    v_exp_f32 v186, v186
    v_exp_f32 v187, v187
    v_add_f32 v9, v9, v186
    v_add_f32 v9, v9, v187
    v_cvt_pk_bf16_f32 v145, v186, v187
    v_exp_f32 v188, v188
    v_exp_f32 v189, v189
    v_add_f32 v10, v10, v188
    v_add_f32 v10, v10, v189
    v_cvt_pk_bf16_f32 v148, v188, v189
    v_exp_f32 v190, v190
    v_exp_f32 v191, v191
    v_add_f32 v10, v10, v190
    v_add_f32 v10, v10, v191
    v_cvt_pk_bf16_f32 v149, v190, v191
    v_exp_f32 v192, v192
    v_exp_f32 v193, v193
    v_add_f32 v9, v9, v192
    v_add_f32 v9, v9, v193
    v_cvt_pk_bf16_f32 v146, v192, v193
    v_exp_f32 v194, v194
    v_exp_f32 v195, v195
    v_add_f32 v9, v9, v194
    v_add_f32 v9, v9, v195
    v_cvt_pk_bf16_f32 v147, v194, v195
    v_exp_f32 v196, v196
    v_exp_f32 v197, v197
    v_add_f32 v10, v10, v196
    v_add_f32 v10, v10, v197
    v_cvt_pk_bf16_f32 v150, v196, v197
    v_exp_f32 v198, v198
    v_exp_f32 v199, v199
    v_add_f32 v10, v10, v198
    v_add_f32 v10, v10, v199
    v_cvt_pk_bf16_f32 v151, v198, v199
    v_mov_b32 v16, v9
    v_mov_b32 v18, v10
    s_nop 0
    v_permlane16_swap_b32 v9, v16
    v_permlane16_swap_b32 v10, v18
    v_add_f32 v9, v9, v16
    v_add_f32 v10, v10, v18
    v_mov_b32 v16, v9
    v_mov_b32 v18, v10
    s_nop 0
    v_permlane32_swap_b32 v9, v16
    v_permlane32_swap_b32 v10, v18
    v_add_f32 v9, v9, v16
    v_add_f32 v10, v10, v18
    s_waitcnt vmcnt(0) lgkmcnt(0)
    s_nop 15
    s_nop 3
    s_branch adaLN_cond__sliding_block_cached__moe_arch_mod__prompt_kernel_fixBb
adaLN_cond__sliding_block_cached__moe_arch_mod__prompt_kernel_o17r:
    s_waitcnt vmcnt(0) lgkmcnt(0)
    s_nop 15
    s_nop 3
    s_mov_b32 s27, 0
adaLN_cond__sliding_block_cached__moe_arch_mod__prompt_kernel_o17p:
    buffer_load_dword v12, v13, s[8:11], s19 offen sc1
    s_waitcnt vmcnt(0)
    v_cmp_ne_u32 vcc, s28, v12
    s_add_u32 s27, s27, 1
    s_cmp_ge_u32 s27, 65536
    s_cbranch_scc1 adaLN_cond__sliding_block_cached__moe_arch_mod__prompt_kernel_o17g
    s_cbranch_vccnz adaLN_cond__sliding_block_cached__moe_arch_mod__prompt_kernel_o17p
adaLN_cond__sliding_block_cached__moe_arch_mod__prompt_kernel_o17g:
    s_waitcnt vmcnt(0) lgkmcnt(0)
    s_nop 15
    s_nop 3
    s_branch adaLN_cond__sliding_block_cached__moe_arch_mod__prompt_kernel_o17b
adaLN_cond__sliding_block_cached__moe_arch_mod__prompt_kernel_o218r:
    s_waitcnt vmcnt(0) lgkmcnt(0)
    s_nop 15
    s_nop 3
    s_mov_b32 s27, 0
adaLN_cond__sliding_block_cached__moe_arch_mod__prompt_kernel_o218p:
    buffer_load_dword v12, v13, s[8:11], s19 offen sc1
    s_waitcnt vmcnt(0)
    v_cmp_ne_u32 vcc, s28, v12
    s_add_u32 s27, s27, 1
    s_cmp_ge_u32 s27, 65536
    s_cbranch_scc1 adaLN_cond__sliding_block_cached__moe_arch_mod__prompt_kernel_o218g
    s_cbranch_vccnz adaLN_cond__sliding_block_cached__moe_arch_mod__prompt_kernel_o218p
adaLN_cond__sliding_block_cached__moe_arch_mod__prompt_kernel_o218g:
    s_waitcnt vmcnt(0) lgkmcnt(0)
    s_nop 15
    s_nop 3
    s_branch adaLN_cond__sliding_block_cached__moe_arch_mod__prompt_kernel_o218b
adaLN_cond__sliding_block_cached__moe_arch_mod__prompt_kernel_o219r:
    s_waitcnt vmcnt(0) lgkmcnt(0)
    s_nop 15
    s_nop 3
    s_mov_b32 s27, 0
adaLN_cond__sliding_block_cached__moe_arch_mod__prompt_kernel_o219p:
    buffer_load_dword v12, v13, s[8:11], s19 offen sc1
    s_waitcnt vmcnt(0)
    v_cmp_ne_u32 vcc, s28, v12
    s_add_u32 s27, s27, 1
    s_cmp_ge_u32 s27, 65536
    s_cbranch_scc1 adaLN_cond__sliding_block_cached__moe_arch_mod__prompt_kernel_o219g
    s_cbranch_vccnz adaLN_cond__sliding_block_cached__moe_arch_mod__prompt_kernel_o219p
adaLN_cond__sliding_block_cached__moe_arch_mod__prompt_kernel_o219g:
    s_waitcnt vmcnt(0) lgkmcnt(0)
    s_nop 15
    s_nop 3
    s_branch adaLN_cond__sliding_block_cached__moe_arch_mod__prompt_kernel_o219b
adaLN_cond__sliding_block_cached__moe_arch_mod__prompt_kernel_o220r:
    s_waitcnt vmcnt(0) lgkmcnt(0)
    s_nop 15
    s_nop 3
    s_mov_b32 s27, 0
adaLN_cond__sliding_block_cached__moe_arch_mod__prompt_kernel_o220p:
    buffer_load_dword v12, v13, s[8:11], s19 offen sc1
    s_waitcnt vmcnt(0)
    v_cmp_ne_u32 vcc, s28, v12
    s_add_u32 s27, s27, 1
    s_cmp_ge_u32 s27, 65536
    s_cbranch_scc1 adaLN_cond__sliding_block_cached__moe_arch_mod__prompt_kernel_o220g
    s_cbranch_vccnz adaLN_cond__sliding_block_cached__moe_arch_mod__prompt_kernel_o220p
adaLN_cond__sliding_block_cached__moe_arch_mod__prompt_kernel_o220g:
    s_waitcnt vmcnt(0) lgkmcnt(0)
    s_nop 15
    s_nop 3
    s_branch adaLN_cond__sliding_block_cached__moe_arch_mod__prompt_kernel_o220b
adaLN_cond__sliding_block_cached__moe_arch_mod__prompt_kernel_mf21r:
    s_waitcnt vmcnt(0) lgkmcnt(0)
    s_nop 15
    s_nop 3
    s_mov_b32 s27, 0
adaLN_cond__sliding_block_cached__moe_arch_mod__prompt_kernel_mf21p:
    s_mov_b32 s16, 0x544000
    buffer_load_dwordx4 v[184:187], v2, s[8:11], s16 offen sc1
    s_waitcnt vmcnt(0)
    v_xor_b32 v16, s28, v184
    v_xor_b32 v17, s28, v185
    v_xor_b32 v18, s28, v186
    v_xor_b32 v19, s28, v187
    v_or3_b32 v16, v16, v17, v18
    v_or_b32 v16, v16, v19
    v_cmp_ne_u32 vcc, 0, v16
    s_add_u32 s27, s27, 1
    s_cmp_ge_u32 s27, 65536
    s_cbranch_scc1 adaLN_cond__sliding_block_cached__moe_arch_mod__prompt_kernel_mf21g
    s_cbranch_vccnz adaLN_cond__sliding_block_cached__moe_arch_mod__prompt_kernel_mf21p
adaLN_cond__sliding_block_cached__moe_arch_mod__prompt_kernel_mf21g:
    s_waitcnt vmcnt(0) lgkmcnt(0)
    s_nop 15
    s_nop 3
    s_branch adaLN_cond__sliding_block_cached__moe_arch_mod__prompt_kernel_mf21b
adaLN_cond__sliding_block_cached__moe_arch_mod__prompt_kernel_codeend:
    s_endpgm
.section .rodata,"a"
.p2align 6
.amdhsa_kernel adaLN_cond__sliding_block_cached__moe_arch_mod__prompt_kernel
  .amdhsa_next_free_vgpr 256
  .amdhsa_next_free_sgpr 80
  .amdhsa_accum_offset 256
  .amdhsa_group_segment_fixed_size 0
  .amdhsa_kernarg_size 120
  .amdhsa_user_sgpr_count 2
  .amdhsa_user_sgpr_kernarg_segment_ptr 1
  .amdhsa_system_sgpr_workgroup_id_x 1
  .amdhsa_float_denorm_mode_32 3
.end_amdhsa_kernel
```

```asm
; @launch grid=(256,1,1) block=(512,1,1) lds=163840
.amdgcn_target "amdgcn-amd-amdhsa--gfx950"
.text
.globl adaLN_cond__sliding_block_cached__moe_arch_mod__prompt_kernel
.p2align 8
.type adaLN_cond__sliding_block_cached__moe_arch_mod__prompt_kernel,@function
adaLN_cond__sliding_block_cached__moe_arch_mod__prompt_kernel:
    s_cmp_ge_u32 s2, 256
    s_cbranch_scc1 adaLN_cond__sliding_block_cached__moe_arch_mod__prompt_kernel_end
    s_getpc_b64 s[76:77]
adaLN_cond__sliding_block_cached__moe_arch_mod__prompt_kernel_pc0:
    s_sub_u32 s76, s76, adaLN_cond__sliding_block_cached__moe_arch_mod__prompt_kernel_pc0-adaLN_cond__sliding_block_cached__moe_arch_mod__prompt_kernel
    s_subb_u32 s77, s77, 0
    v_and_b32 v16, 63, v0
    v_lshlrev_b32 v16, 7, v16
    v_lshrrev_b32 v17, 6, v0
    s_lshr_b32 s62, s2, 3
    s_lshl_b32 s62, s62, 13
    v_lshlrev_b32 v18, 13, v17
    v_mov_b32 v19, s62
    v_cmp_eq_u32 vcc, 7, v17
    s_nop 1
    v_cndmask_b32 v18, v18, v19, vcc
    v_add_u32 v16, v16, v18
    v_min_u32 v16, adaLN_cond__sliding_block_cached__moe_arch_mod__prompt_kernel_codeend-adaLN_cond__sliding_block_cached__moe_arch_mod__prompt_kernel-4, v16
    v_mov_b32 v25, s77
    v_add_co_u32 v24, vcc, s76, v16
    s_nop 1
    v_addc_co_u32 v25, vcc, 0, v25, vcc
    v_cmp_gt_u32 vcc, 2, v17
    v_cmp_eq_u32 s[62:63], 7, v17
    s_or_b64 vcc, vcc, s[62:63]
    s_and_saveexec_b64 s[62:63], vcc
    s_cbranch_execz adaLN_cond__sliding_block_cached__moe_arch_mod__prompt_kernel_nocp0
    global_load_dword v26, v[24:25], off
adaLN_cond__sliding_block_cached__moe_arch_mod__prompt_kernel_nocp0:
    s_mov_b64 exec, s[62:63]
    s_load_dwordx4 s[56:59], s[0:1], 96
    s_load_dwordx2 s[60:61], s[0:1], 112
    s_load_dwordx8 s[48:55], s[0:1], 64
    s_load_dwordx16 s[32:47], s[0:1], 0
    s_memrealtime s[62:63]
    v_lshrrev_b32 v16, 6, v0
    v_and_b32 v1, 63, v0
    v_readfirstlane_b32 s3, v16
    v_lshlrev_b32 v2, 4, v1
    s_and_b32 s12, s2, 3
    s_lshl_b32 s12, s12, 3
    s_bfe_u32 s13, s2, 0x30003
    s_add_u32 s12, s12, s13
    s_bfe_u32 s13, s2, 0x10002
    s_lshl_b32 s13, s13, 2
    s_lshr_b32 s14, s2, 6
    s_add_u32 s13, s13, s14
    v_bfe_u32 v16, v1, 2, 2
    v_lshrrev_b32 v17, 4, v1
    v_and_b32 v18, 3, v1
    v_lshlrev_b32 v19, 6, v17
    v_lshl_add_u32 v19, v18, 4, v19
    v_lshl_add_u32 v3, v16, 13, v19
    s_and_b32 s14, s3, 1
    s_lshl_b32 s14, s14, 5
    v_xor_b32 v3, s14, v3
    v_lshlrev_b32 v4, 11, v17
    v_lshl_add_u32 v4, v16, 6, v4
    v_lshl_add_u32 v4, v18, 3, v4
    v_and_b32 v20, 1, v17
    v_lshlrev_b32 v20, 5, v20
    v_sub_u32 v5, v4, v20
    v_add_u32 v4, v4, v20
    s_lshl_b32 s14, s13, 3
    s_add_u32 s14, s14, s3
    s_lshl_b32 s14, s14, 16
    v_add_u32 v7, s14, v2
    s_cmp_ge_u32 s3, 4
    s_cbranch_scc1 adaLN_cond__sliding_block_cached__moe_arch_mod__prompt_kernel_roleB
    v_mov_b32 v132, 0
    v_mov_b32 v133, 0
    v_lshrrev_b32 v16, 3, v0
    v_and_b32 v17, 7, v0
    v_mul_u32_u24 v135, 24576, v16
    v_lshl_add_u32 v135, v17, 4, v135
    v_lshlrev_b32 v136, 2, v16
    s_and_b32 s14, s2, 31
    s_lshr_b32 s15, s2, 5
    s_mul_i32 s26, s15, 1572864
    s_lshl_b32 s16, s14, 7
    s_add_u32 s26, s26, s16
    s_lshl_b32 s29, s15, 8
    v_lshlrev_b32 v137, 3, v0
    s_lshl_b32 s18, s2, 3
    s_add_u32 s18, s18, s3
    s_lshl_b32 s18, s18, 11
    v_and_b32 v18, 15, v1
    v_lshrrev_b32 v19, 4, v1
    v_lshlrev_b32 v138, 11, v18
    v_lshl_add_u32 v138, v19, 4, v138
    s_lshr_b32 s30, s2, 4
    s_and_b32 s31, s2, 15
    s_lshl_b32 s19, s30, 3
    s_add_u32 s19, s19, s3
    s_lshl_b32 s22, s19, 15
    s_lshl_b32 s23, s31, 7
    s_add_u32 s22, s22, s23
    s_lshl_b32 s23, s2, 12
    s_add_u32 s23, s23, 0x600000
    s_or_b32 s25, s2, s3
    s_cmp_eq_u32 s25, 0
    s_cselect_b32 s25, 0, 0x7ffffff0
    s_waitcnt lgkmcnt(0)
    s_mov_b64 s[64:65], s[58:59]
    s_mov_b32 s66, 0x100
    s_mov_b32 s67, 0x20000
    s_or_b32 s28, s62, 1
    v_mov_b32 v134, s28
    s_mov_b64 exec, 1
    buffer_store_dword v134, v132, s[64:67], s25 offen sc1
    s_mov_b64 exec, -1
    s_mov_b64 s[68:69], s[52:53]
    s_mov_b32 s70, 0x800
    s_mov_b32 s71, 0x20000
    s_mov_b64 s[72:73], s[54:55]
    s_mov_b32 s74, 0xc00000
    s_mov_b32 s75, 0x20000
    s_mov_b64 s[76:77], s[32:33]
    s_mov_b32 s78, 0x400000
    s_mov_b32 s79, 0x20000
    s_mov_b64 s[8:9], s[60:61]
    s_mov_b32 s10, 0x3400000
    s_mov_b32 s11, 0x20000
    buffer_load_dword v72, v136, s[68:71], s29 offen
    buffer_load_dwordx4 v[24:27], v135, s[72:75], s26 offen
    s_add_u32 s26, s26, 12288
    buffer_load_dwordx4 v[28:31], v135, s[72:75], s26 offen
    buffer_load_dwordx4 v[32:35], v2, s[76:79], s18 offen offset:0
    buffer_load_dwordx4 v[36:39], v2, s[76:79], s18 offen offset:1024
    s_cmp_eq_u32 s3, 0
    s_cselect_b32 s25, 0, 0x7ffffff0
    buffer_load_dword v134, v132, s[64:67], s25 offen sc1
    buffer_store_dwordx2 v[132:133], v137, s[8:11], s23 offen sc1
    s_barrier
    buffer_load_dwordx4 v[40:43], v138, s[76:79], s22 offen offset:0
    buffer_load_dwordx4 v[44:47], v138, s[76:79], s22 offen offset:64
    s_mov_b32 s29, s19
    s_waitcnt vmcnt(8)
    v_and_b32 v73, 0xffff0000, v72
    v_lshlrev_b32 v72, 16, v72
    v_mul_f32 v16, 0xbfb8aa3b, v72
    v_exp_f32 v16, v16
    s_nop 0
    v_add_f32 v16, 1.0, v16
    v_rcp_f32 v16, v16
    s_nop 0
    v_mul_f32 v72, v72, v16
    v_mul_f32 v17, 0xbfb8aa3b, v73
    v_exp_f32 v17, v17
    s_nop 0
    v_add_f32 v17, 1.0, v17
    v_rcp_f32 v17, v17
    s_nop 0
    v_mul_f32 v73, v73, v17
    v_cvt_pk_bf16_f32 v16, v72, v73
    v_lshlrev_b32 v72, 16, v16
    v_and_b32 v73, 0xffff0000, v16
    s_lshl_b32 s16, s2, 8
    s_add_u32 s16, s16, 0x550000
    s_mov_b32 exec_lo, 0x01010101
    s_mov_b32 exec_hi, 0x01010101
    buffer_store_dword v16, v136, s[8:11], s16 offen sc1
    s_mov_b64 exec, -1
    v_lshrrev_b32 v74, 16, v72
    v_lshrrev_b32 v75, 16, v73
    s_waitcnt vmcnt(8)
    v_dot2_f32_bf16 v49, v24, v72, 0
    v_dot2_f32_bf16 v48, v24, v74, 0
    v_dot2_f32_bf16 v51, v25, v72, 0
    v_dot2_f32_bf16 v50, v25, v74, 0
    v_dot2_f32_bf16 v53, v26, v72, 0
    v_dot2_f32_bf16 v52, v26, v74, 0
    v_dot2_f32_bf16 v55, v27, v72, 0
    v_dot2_f32_bf16 v54, v27, v74, 0
    s_waitcnt vmcnt(7)
    v_dot2c_f32_bf16 v49, v28, v73
    v_dot2c_f32_bf16 v48, v28, v75
    v_dot2c_f32_bf16 v51, v29, v73
    v_dot2c_f32_bf16 v50, v29, v75
    v_dot2c_f32_bf16 v53, v30, v73
    v_dot2c_f32_bf16 v52, v30, v75
    v_dot2c_f32_bf16 v55, v31, v73
    v_dot2c_f32_bf16 v54, v31, v75
    s_nop 0
    v_permlane32_swap_b32 v48, v52
    v_permlane32_swap_b32 v49, v53
    v_permlane32_swap_b32 v50, v54
    v_permlane32_swap_b32 v51, v55
    v_add_f32 v48, v48, v52
    v_add_f32 v49, v49, v53
    v_add_f32 v50, v50, v54
    v_add_f32 v51, v51, v55
    s_nop 0
    v_permlane16_swap_b32 v48, v50
    v_permlane16_swap_b32 v49, v51
    v_add_f32 v48, v48, v50
    v_add_f32 v49, v49, v51
    s_nop 0
    v_add_f32_dpp v48, v48, v48 row_ror:8 row_mask:0xf bank_mask:0xf
    v_add_f32_dpp v49, v49, v49 row_ror:8 row_mask:0xf bank_mask:0xf
    v_and_b32 v16, 7, v1
    v_lshlrev_b32 v16, 5, v16
    v_lshrrev_b32 v17, 4, v1
    v_lshl_add_u32 v16, v17, 3, v16
    s_lshl_b32 s16, s3, 8
    s_add_u32 s16, s16, 65536
    v_add_u32 v16, s16, v16
    ds_write_b64 v16, v[48:49]
    s_waitcnt vmcnt(6)
    v_lshlrev_b32 v56, 16, v32
    v_and_b32 v57, 0xffff0000, v32
    v_lshlrev_b32 v58, 16, v33
    v_and_b32 v59, 0xffff0000, v33
    v_lshlrev_b32 v60, 16, v34
    v_and_b32 v61, 0xffff0000, v34
    v_lshlrev_b32 v62, 16, v35
    v_and_b32 v63, 0xffff0000, v35
    s_waitcnt vmcnt(5)
    v_lshlrev_b32 v64, 16, v36
    v_and_b32 v65, 0xffff0000, v36
    v_lshlrev_b32 v66, 16, v37
    v_and_b32 v67, 0xffff0000, v37
    v_lshlrev_b32 v68, 16, v38
    v_and_b32 v69, 0xffff0000, v38
    v_lshlrev_b32 v70, 16, v39
    v_and_b32 v71, 0xffff0000, v39
    v_add_f32 v20, v56, v57
    v_add_f32 v21, v58, v59
    v_add_f32 v20, v20, v60
    v_add_f32 v21, v21, v61
    v_add_f32 v20, v20, v62
    v_add_f32 v21, v21, v63
    v_add_f32 v20, v20, v64
    v_add_f32 v21, v21, v65
    v_add_f32 v20, v20, v66
    v_add_f32 v21, v21, v67
    v_add_f32 v20, v20, v68
    v_add_f32 v21, v21, v69
    v_add_f32 v20, v20, v70
    v_add_f32 v21, v21, v71
    v_add_f32 v128, v20, v21
    s_nop 1
    v_add_f32_dpp v128, v128, v128 row_ror:1 row_mask:0xf bank_mask:0xf
    s_nop 1
    v_add_f32_dpp v128, v128, v128 row_ror:2 row_mask:0xf bank_mask:0xf
    s_nop 1
    v_add_f32_dpp v128, v128, v128 row_ror:4 row_mask:0xf bank_mask:0xf
    s_nop 1
    v_add_f32_dpp v128, v128, v128 row_ror:8 row_mask:0xf bank_mask:0xf
    v_mov_b32 v20, v128
    s_nop 1
    v_permlane16_swap_b32 v128, v20
    v_add_f32 v128, v128, v20
    v_mov_b32 v20, v128
    s_nop 1
    v_permlane32_swap_b32 v128, v20
    v_add_f32 v128, v128, v20
    v_mul_f32 v128, 0x3a800000, v128
    v_sub_f32 v18, v56, v128
    v_mul_f32 v20, v18, v18
    v_sub_f32 v19, v57, v128
    v_mul_f32 v21, v19, v19
    v_sub_f32 v18, v58, v128
    v_sub_f32 v19, v59, v128
    v_fmac_f32 v20, v18, v18
    v_fmac_f32 v21, v19, v19
    v_sub_f32 v18, v60, v128
    v_sub_f32 v19, v61, v128
    v_fmac_f32 v20, v18, v18
    v_fmac_f32 v21, v19, v19
    v_sub_f32 v18, v62, v128
    v_sub_f32 v19, v63, v128
    v_fmac_f32 v20, v18, v18
    v_fmac_f32 v21, v19, v19
    v_sub_f32 v18, v64, v128
    v_sub_f32 v19, v65, v128
    v_fmac_f32 v20, v18, v18
    v_fmac_f32 v21, v19, v19
    v_sub_f32 v18, v66, v128
    v_sub_f32 v19, v67, v128
    v_fmac_f32 v20, v18, v18
    v_fmac_f32 v21, v19, v19
    v_sub_f32 v18, v68, v128
    v_sub_f32 v19, v69, v128
    v_fmac_f32 v20, v18, v18
    v_fmac_f32 v21, v19, v19
    v_sub_f32 v18, v70, v128
    v_sub_f32 v19, v71, v128
    v_fmac_f32 v20, v18, v18
    v_fmac_f32 v21, v19, v19
    v_add_f32 v17, v20, v21
    s_nop 1
    v_add_f32_dpp v17, v17, v17 row_ror:1 row_mask:0xf bank_mask:0xf
    s_nop 1
    v_add_f32_dpp v17, v17, v17 row_ror:2 row_mask:0xf bank_mask:0xf
    s_nop 1
    v_add_f32_dpp v17, v17, v17 row_ror:4 row_mask:0xf bank_mask:0xf
    s_nop 1
    v_add_f32_dpp v17, v17, v17 row_ror:8 row_mask:0xf bank_mask:0xf
    v_mov_b32 v20, v17
    s_nop 1
    v_permlane16_swap_b32 v17, v20
    v_add_f32 v17, v17, v20
    v_mov_b32 v20, v17
    s_nop 1
    v_permlane32_swap_b32 v17, v20
    v_add_f32 v17, v17, v20
    v_mul_f32 v17, 0x3a800000, v17
    v_cvt_pk_bf16_f32 v128, v128, v128
    v_lshlrev_b32 v128, 16, v128
    v_cvt_pk_bf16_f32 v17, v17, v17
    v_lshlrev_b32 v17, 16, v17
    v_add_f32 v17, 0x3727c5ac, v17
    v_cvt_pk_bf16_f32 v17, v17, v17
    v_lshlrev_b32 v17, 16, v17
    v_sqrt_f32 v129, v17
    s_nop 0
    v_cvt_pk_bf16_f32 v129, v129, v129
    v_lshlrev_b32 v129, 16, v129
    v_rcp_f32 v130, v129
    s_lshl_b32 s16, s3, 4
    s_add_u32 s16, s16, 67600
    v_mov_b32 v19, s16
    ds_write_b128 v19, v[128:131]
    s_waitcnt vmcnt(4)
    v_cmp_eq_u32 vcc, 0, v134
    s_cmp_eq_u32 s3, 0
    s_cselect_b64 s[62:63], -1, 0
    s_and_b64 vcc, vcc, s[62:63]
    s_cbranch_vccnz adaLN_cond__sliding_block_cached__moe_arch_mod__prompt_kernel_n1r
adaLN_cond__sliding_block_cached__moe_arch_mod__prompt_kernel_n1b:
    v_mov_b32 v19, 67584
    s_cmp_eq_u32 s3, 0
    s_cselect_b64 exec, 1, 0
    ds_write_b32 v19, v134
    s_mov_b64 exec, -1
    v_mov_b32 v19, 67584
    v_and_b32 v17, 31, v1
    v_lshlrev_b32 v18, 3, v17
    v_add_u32 v18, 65536, v18
    v_lshlrev_b32 v17, 4, v17
    s_waitcnt lgkmcnt(0)
    s_barrier
    ds_read_b32 v134, v19
    ds_read_b64 v[96:97], v18 offset:0
    ds_read_b64 v[100:101], v18 offset:256
    ds_read_b64 v[104:105], v18 offset:512
    ds_read_b64 v[108:109], v18 offset:768
    ds_read_b64 v[112:113], v18 offset:1024
    ds_read_b64 v[116:117], v18 offset:1280
    ds_read_b64 v[120:121], v18 offset:1536
    ds_read_b64 v[124:125], v18 offset:1792
    s_waitcnt lgkmcnt(8)
    v_readfirstlane_b32 s28, v134
    v_and_b32 v20, 7, v1
    v_lshlrev_b32 v20, 4, v20
    v_add_u32 v21, 67600, v20
    ds_read_b128 v[128:131], v21
    s_waitcnt lgkmcnt(0)
    v_mov_b32 v131, s28
    s_lshl_b32 s16, s2, 7
    s_add_u32 s16, s16, 0x520000
    s_cmp_eq_u32 s3, 0
    s_cselect_b32 s16, s16, 0x7ffffff0
    s_mov_b64 exec, 0xff
    buffer_store_dwordx4 v[128:131], v20, s[8:11], s16 offen sc1
    s_mov_b64 exec, -1
    v_pk_add_f32 v[96:97], v[96:97], v[112:113]
    v_pk_add_f32 v[100:101], v[100:101], v[116:117]
    v_pk_add_f32 v[104:105], v[104:105], v[120:121]
    v_pk_add_f32 v[108:109], v[108:109], v[124:125]
    v_pk_add_f32 v[96:97], v[96:97], v[104:105]
    v_pk_add_f32 v[100:101], v[100:101], v[108:109]
    v_pk_add_f32 v[96:97], v[96:97], v[100:101]
    v_mov_b32 v98, s28
    v_mov_b32 v99, s28
    s_lshl_b32 s16, s14, 3
    s_add_u32 s16, s16, s15
    s_lshl_b32 s16, s16, 9
    s_add_u32 s16, s16, 0x500000
    s_cmp_eq_u32 s3, 0
    s_cselect_b32 s16, s16, 0x7ffffff0
    s_mov_b64 exec, 0xffffffff
    buffer_store_dwordx4 v[96:99], v17, s[8:11], s16 offen sc1
    s_mov_b64 exec, -1
    s_lshr_b32 s16, s3, 2
    s_lshl_b32 s16, s16, 4
    s_add_u32 s16, s16, s31
    s_lshl_b32 s16, s16, 12
    s_and_b32 s17, s3, 3
    s_lshl_b32 s17, s17, 7
    s_add_u32 s16, s16, s17
    s_add_u32 s16, s16, 0x500000
    v_lshrrev_b32 v139, 3, v1
    v_lshlrev_b32 v139, 9, v139
    v_and_b32 v16, 7, v1
    v_lshl_add_u32 v139, v16, 4, v139
    v_and_b32 v140, 15, v1
    v_lshlrev_b32 v140, 4, v140
    s_lshl_b32 s17, s29, 8
    s_add_u32 s17, s17, 0x520000
    s_waitcnt vmcnt(4)
    v_lshlrev_b32 v56, 16, v40
    v_and_b32 v57, 0xffff0000, v40
    v_lshlrev_b32 v58, 16, v41
    v_and_b32 v59, 0xffff0000, v41
    v_lshlrev_b32 v60, 16, v42
    v_and_b32 v61, 0xffff0000, v42
    v_lshlrev_b32 v62, 16, v43
    v_and_b32 v63, 0xffff0000, v43
    s_waitcnt vmcnt(3)
    v_lshlrev_b32 v64, 16, v44
    v_and_b32 v65, 0xffff0000, v44
    v_lshlrev_b32 v66, 16, v45
    v_and_b32 v67, 0xffff0000, v45
    v_lshlrev_b32 v68, 16, v46
    v_and_b32 v69, 0xffff0000, v46
    v_lshlrev_b32 v70, 16, v47
    v_and_b32 v71, 0xffff0000, v47
    s_mov_b32 s27, 0
adaLN_cond__sliding_block_cached__moe_arch_mod__prompt_kernel_g2p:
    buffer_load_dwordx4 v[76:79], v139, s[8:11], s16 offen sc1
    buffer_load_dwordx4 v[80:83], v140, s[8:11], s17 offen sc1
    s_waitcnt vmcnt(1)
    v_cmp_ne_u32 vcc, s28, v78
    v_cmp_ne_u32 s[62:63], s28, v79
    s_or_b64 vcc, vcc, s[62:63]
    s_waitcnt vmcnt(0)
    v_cmp_ne_u32 s[62:63], s28, v83
    s_or_b64 vcc, vcc, s[62:63]
    s_add_u32 s27, s27, 1
    s_cmp_ge_u32 s27, 65536
    s_cbranch_scc1 adaLN_cond__sliding_block_cached__moe_arch_mod__prompt_kernel_g2g
    s_cbranch_vccnz adaLN_cond__sliding_block_cached__moe_arch_mod__prompt_kernel_g2p
adaLN_cond__sliding_block_cached__moe_arch_mod__prompt_kernel_g2g:
    v_add_f32_dpp v76, v76, v76 row_ror:8 row_mask:0xf bank_mask:0xf
    v_add_f32_dpp v77, v77, v77 row_ror:8 row_mask:0xf bank_mask:0xf
    v_mov_b32 v17, v76
    s_nop 1
    v_permlane16_swap_b32 v76, v17
    v_add_f32 v76, v76, v17
    v_mov_b32 v18, v77
    s_nop 1
    v_permlane16_swap_b32 v77, v18
    v_add_f32 v77, v77, v18
    v_mov_b32 v17, v76
    s_nop 1
    v_permlane32_swap_b32 v76, v17
    v_add_f32 v76, v76, v17
    v_mov_b32 v18, v77
    s_nop 1
    v_permlane32_swap_b32 v77, v18
    v_add_f32 v77, v77, v18
    v_cvt_pk_bf16_f32 v17, v76, v77
    v_lshlrev_b32 v76, 16, v17
    v_and_b32 v77, 0xffff0000, v17
    v_add_f32 v76, 0, v76
    v_add_f32 v77, 0, v77
    s_lshl_b32 s16, s3, 6
    s_add_u32 s16, s16, 69632
    v_lshl_add_u32 v16, v16, 3, s16
    ds_write_b64 v16, v[76:77]
    v_lshrrev_b32 v17, 4, v1
    v_lshlrev_b32 v17, 5, v17
    v_add_u32 v17, 69632, v17
    v_sub_f32 v56, v56, v80
    v_sub_f32 v57, v57, v80
    v_sub_f32 v58, v58, v80
    v_sub_f32 v59, v59, v80
    v_sub_f32 v60, v60, v80
    v_sub_f32 v61, v61, v80
    v_sub_f32 v62, v62, v80
    v_sub_f32 v63, v63, v80
    v_sub_f32 v64, v64, v80
    v_sub_f32 v65, v65, v80
    v_sub_f32 v66, v66, v80
    v_sub_f32 v67, v67, v80
    v_sub_f32 v68, v68, v80
    v_sub_f32 v69, v69, v80
    v_sub_f32 v70, v70, v80
    v_sub_f32 v71, v71, v80
    v_cvt_pk_bf16_f32 v18, v56, v57
    v_lshlrev_b32 v56, 16, v18
    v_and_b32 v57, 0xffff0000, v18
    v_cvt_pk_bf16_f32 v19, v58, v59
    v_lshlrev_b32 v58, 16, v19
    v_and_b32 v59, 0xffff0000, v19
    v_cvt_pk_bf16_f32 v18, v60, v61
    v_lshlrev_b32 v60, 16, v18
    v_and_b32 v61, 0xffff0000, v18
    v_cvt_pk_bf16_f32 v19, v62, v63
    v_lshlrev_b32 v62, 16, v19
    v_and_b32 v63, 0xffff0000, v19
    v_cvt_pk_bf16_f32 v18, v64, v65
    v_lshlrev_b32 v64, 16, v18
    v_and_b32 v65, 0xffff0000, v18
    v_cvt_pk_bf16_f32 v19, v66, v67
    v_lshlrev_b32 v66, 16, v19
    v_and_b32 v67, 0xffff0000, v19
    v_cvt_pk_bf16_f32 v18, v68, v69
    v_lshlrev_b32 v68, 16, v18
    v_and_b32 v69, 0xffff0000, v18
    v_cvt_pk_bf16_f32 v19, v70, v71
    v_lshlrev_b32 v70, 16, v19
    v_and_b32 v71, 0xffff0000, v19
    v_mul_f32 v56, v56, v82
    v_mul_f32 v57, v57, v82
    v_mul_f32 v58, v58, v82
    v_mul_f32 v59, v59, v82
    v_mul_f32 v60, v60, v82
    v_mul_f32 v61, v61, v82
    v_mul_f32 v62, v62, v82
    v_mul_f32 v63, v63, v82
    v_mul_f32 v64, v64, v82
    v_mul_f32 v65, v65, v82
    v_mul_f32 v66, v66, v82
    v_mul_f32 v67, v67, v82
    v_mul_f32 v68, v68, v82
    v_mul_f32 v69, v69, v82
    v_mul_f32 v70, v70, v82
    v_mul_f32 v71, v71, v82
    v_cvt_pk_bf16_f32 v18, v56, v57
    v_lshlrev_b32 v56, 16, v18
    v_and_b32 v57, 0xffff0000, v18
    v_cvt_pk_bf16_f32 v19, v58, v59
    v_lshlrev_b32 v58, 16, v19
    v_and_b32 v59, 0xffff0000, v19
    v_cvt_pk_bf16_f32 v18, v60, v61
    v_lshlrev_b32 v60, 16, v18
    v_and_b32 v61, 0xffff0000, v18
    v_cvt_pk_bf16_f32 v19, v62, v63
    v_lshlrev_b32 v62, 16, v19
    v_and_b32 v63, 0xffff0000, v19
    v_cvt_pk_bf16_f32 v18, v64, v65
    v_lshlrev_b32 v64, 16, v18
    v_and_b32 v65, 0xffff0000, v18
    v_cvt_pk_bf16_f32 v19, v66, v67
    v_lshlrev_b32 v66, 16, v19
    v_and_b32 v67, 0xffff0000, v19
    v_cvt_pk_bf16_f32 v18, v68, v69
    v_lshlrev_b32 v68, 16, v18
    v_and_b32 v69, 0xffff0000, v18
    v_cvt_pk_bf16_f32 v19, v70, v71
    v_lshlrev_b32 v70, 16, v19
    v_and_b32 v71, 0xffff0000, v19
    s_lshl_b32 s16, s29, 15
    s_lshl_b32 s17, s31, 11
    s_add_u32 s16, s16, s17
    s_waitcnt lgkmcnt(0)
    s_barrier
    ds_read_b128 v[96:99], v17 offset:256
    ds_read_b128 v[104:107], v17 offset:0
    ds_read_b128 v[100:103], v17 offset:272
    ds_read_b128 v[108:111], v17 offset:16
    ds_read_b128 v[112:115], v17 offset:384
    ds_read_b128 v[120:123], v17 offset:128
    ds_read_b128 v[116:119], v17 offset:400
    ds_read_b128 v[124:127], v17 offset:144
    s_waitcnt lgkmcnt(7)
    v_pk_mul_f32 v[56:57], v[56:57], v[96:97]
    v_pk_mul_f32 v[58:59], v[58:59], v[98:99]
    s_waitcnt lgkmcnt(5)
    v_pk_mul_f32 v[60:61], v[60:61], v[100:101]
    v_pk_mul_f32 v[62:63], v[62:63], v[102:103]
    v_cvt_pk_bf16_f32 v18, v56, v57
    v_lshlrev_b32 v56, 16, v18
    v_and_b32 v57, 0xffff0000, v18
    v_cvt_pk_bf16_f32 v19, v58, v59
    v_lshlrev_b32 v58, 16, v19
    v_and_b32 v59, 0xffff0000, v19
    v_cvt_pk_bf16_f32 v18, v60, v61
    v_lshlrev_b32 v60, 16, v18
    v_and_b32 v61, 0xffff0000, v18
    v_cvt_pk_bf16_f32 v19, v62, v63
    v_lshlrev_b32 v62, 16, v19
    v_and_b32 v63, 0xffff0000, v19
    v_pk_add_f32 v[56:57], v[56:57], v[104:105]
    v_pk_add_f32 v[58:59], v[58:59], v[106:107]
    s_waitcnt lgkmcnt(4)
    v_pk_add_f32 v[60:61], v[60:61], v[108:109]
    v_pk_add_f32 v[62:63], v[62:63], v[110:111]
    v_cvt_pk_bf16_f32 v32, v56, v57
    v_cvt_pk_bf16_f32 v33, v58, v59
    v_cvt_pk_bf16_f32 v34, v60, v61
    v_cvt_pk_bf16_f32 v35, v62, v63
    buffer_store_dwordx4 v[32:35], v2, s[8:11], s16 offen offset:0 sc1
    s_waitcnt lgkmcnt(3)
    v_pk_mul_f32 v[64:65], v[64:65], v[112:113]
    v_pk_mul_f32 v[66:67], v[66:67], v[114:115]
    s_waitcnt lgkmcnt(1)
    v_pk_mul_f32 v[68:69], v[68:69], v[116:117]
    v_pk_mul_f32 v[70:71], v[70:71], v[118:119]
    v_cvt_pk_bf16_f32 v18, v64, v65
    v_lshlrev_b32 v64, 16, v18
    v_and_b32 v65, 0xffff0000, v18
    v_cvt_pk_bf16_f32 v19, v66, v67
    v_lshlrev_b32 v66, 16, v19
    v_and_b32 v67, 0xffff0000, v19
    v_cvt_pk_bf16_f32 v18, v68, v69
    v_lshlrev_b32 v68, 16, v18
    v_and_b32 v69, 0xffff0000, v18
    v_cvt_pk_bf16_f32 v19, v70, v71
    v_lshlrev_b32 v70, 16, v19
    v_and_b32 v71, 0xffff0000, v19
    v_pk_add_f32 v[64:65], v[64:65], v[120:121]
    v_pk_add_f32 v[66:67], v[66:67], v[122:123]
    s_waitcnt lgkmcnt(0)
    v_pk_add_f32 v[68:69], v[68:69], v[124:125]
    v_pk_add_f32 v[70:71], v[70:71], v[126:127]
    v_cvt_pk_bf16_f32 v36, v64, v65
    v_cvt_pk_bf16_f32 v37, v66, v67
    v_cvt_pk_bf16_f32 v38, v68, v69
    v_cvt_pk_bf16_f32 v39, v70, v71
    buffer_store_dwordx4 v[36:39], v2, s[8:11], s16 offen offset:1024 sc1
    s_lshl_b32 s19, s3, 16
    s_lshl_b32 s20, s3, 11
    s_lshl_b32 s16, s12, 8
    s_add_u32 s4, s38, s16
    s_addc_u32 s5, s39, 0
    s_sub_u32 s6, 0x800000, s16
    s_mov_b32 s7, 0x20000
    v_mov_b32 v134, s28
    s_lshl_b32 s16, s29, 4
    s_add_u32 s16, s16, s31
    s_lshl_b32 s16, s16, 2
    s_add_u32 s16, s16, 0x528000
    v_and_b32 v16, 31, v1
    v_lshlrev_b32 v16, 2, v16
    s_lshl_b32 s17, s13, 3
    s_add_u32 s17, s17, s3
    s_lshl_b32 s17, s17, 7
    s_add_u32 s17, s17, 0x528000
    s_waitcnt vmcnt(0)
    s_mov_b64 exec, 1
    buffer_store_dword v134, v132, s[8:11], s16 offen sc1
    s_mov_b64 exec, -1
    s_add_u32 s22, s19, 0x0
    s_add_u32 m0, s20, 0x0
    s_nop 0
    buffer_load_dwordx4 v3, s[4:7], s22 offen lds
    s_add_u32 s22, s19, 0x8000
    s_add_u32 m0, s20, 0x400
    s_nop 0
    buffer_load_dwordx4 v3, s[4:7], s22 offen lds
    s_add_u32 s22, s19, 0x80000
    s_add_u32 m0, s20, 0x4000
    s_nop 0
    buffer_load_dwordx4 v3, s[4:7], s22 offen lds
    s_add_u32 s22, s19, 0x88000
    s_add_u32 m0, s20, 0x4400
    s_nop 0
    buffer_load_dwordx4 v3, s[4:7], s22 offen lds
    s_add_u32 s22, s19, 0x100000
    s_add_u32 m0, s20, 0x8000
    s_nop 0
    buffer_load_dwordx4 v3, s[4:7], s22 offen lds
    s_add_u32 s22, s19, 0x108000
    s_add_u32 m0, s20, 0x8400
    s_nop 0
    buffer_load_dwordx4 v3, s[4:7], s22 offen lds
    s_sleep 40
    s_mov_b32 s27, 0
adaLN_cond__sliding_block_cached__moe_arch_mod__prompt_kernel_h3p:
    buffer_load_dword v17, v16, s[8:11], s17 offen sc1
    s_waitcnt vmcnt(0)
    v_cmp_ne_u32 vcc, s28, v17
    s_add_u32 s27, s27, 1
    s_cmp_ge_u32 s27, 65536
    s_cbranch_scc1 adaLN_cond__sliding_block_cached__moe_arch_mod__prompt_kernel_h3g
    s_cbranch_vccnz adaLN_cond__sliding_block_cached__moe_arch_mod__prompt_kernel_h3p
adaLN_cond__sliding_block_cached__moe_arch_mod__prompt_kernel_h3g:
    s_mov_b32 s23, 0x0
    buffer_load_dwordx4 v[88:91], v7, s[8:11], s23 offen offset:0 sc1
    s_mov_b32 s23, 0x8000
    buffer_load_dwordx4 v[92:95], v7, s[8:11], s23 offen offset:0 sc1
    s_mov_b32 s23, 0x0
    buffer_load_dwordx4 v[96:99], v7, s[8:11], s23 offen offset:1024 sc1
    s_mov_b32 s23, 0x8000
    buffer_load_dwordx4 v[100:103], v7, s[8:11], s23 offen offset:1024 sc1
    s_mov_b32 s23, 0x800
    buffer_load_dwordx4 v[104:107], v7, s[8:11], s23 offen offset:0 sc1
    s_mov_b32 s23, 0x8800
    buffer_load_dwordx4 v[108:111], v7, s[8:11], s23 offen offset:0 sc1
    s_mov_b32 s23, 0x800
    buffer_load_dwordx4 v[112:115], v7, s[8:11], s23 offen offset:1024 sc1
    s_mov_b32 s23, 0x8800
    buffer_load_dwordx4 v[116:119], v7, s[8:11], s23 offen offset:1024 sc1
    s_lshr_b32 s21, s12, 3
    s_lshl_b32 s21, s21, 17
    s_add_u32 s21, s21, s20
    s_add_u32 s21, s21, 0x400000
    s_barrier
    ds_read_b64_tr_b16 v[224:225], v4 offset:0
    ds_read_b64_tr_b16 v[226:227], v4 offset:1024
    ds_read_b64_tr_b16 v[228:229], v5 offset:32
    ds_read_b64_tr_b16 v[230:231], v5 offset:1056
    ds_read_b64_tr_b16 v[232:233], v4 offset:256
    ds_read_b64_tr_b16 v[234:235], v4 offset:1280
    ds_read_b64_tr_b16 v[236:237], v5 offset:288
    ds_read_b64_tr_b16 v[238:239], v5 offset:1312
    s_waitcnt vmcnt(7) lgkmcnt(6)
    v_mfma_f32_16x16x32_bf16 v[24:27], v[224:227], v[88:91], 0
    ds_read_b64_tr_b16 v[240:241], v4 offset:512
    s_waitcnt vmcnt(6)
    v_mfma_f32_16x16x32_bf16 v[28:31], v[224:227], v[92:95], 0
    ds_read_b64_tr_b16 v[242:243], v4 offset:1536
    s_waitcnt lgkmcnt(6)
    v_mfma_f32_16x16x32_bf16 v[32:35], v[228:231], v[88:91], 0
    ds_read_b64_tr_b16 v[244:245], v5 offset:544
    v_mfma_f32_16x16x32_bf16 v[36:39], v[228:231], v[92:95], 0
    ds_read_b64_tr_b16 v[246:247], v5 offset:1568
    s_mov_b32 s23, 0x1000
    buffer_load_dwordx4 v[120:123], v7, s[8:11], s23 offen offset:0 sc1
    s_waitcnt lgkmcnt(6)
    v_mfma_f32_16x16x32_bf16 v[40:43], v[232:235], v[88:91], 0
    ds_read_b64_tr_b16 v[224:225], v4 offset:768
    v_mfma_f32_16x16x32_bf16 v[44:47], v[232:235], v[92:95], 0
    ds_read_b64_tr_b16 v[226:227], v4 offset:1792
    s_waitcnt lgkmcnt(6)
    v_mfma_f32_16x16x32_bf16 v[48:51], v[236:239], v[88:91], 0
    ds_read_b64_tr_b16 v[228:229], v5 offset:800
    v_mfma_f32_16x16x32_bf16 v[52:55], v[236:239], v[92:95], 0
    ds_read_b64_tr_b16 v[230:231], v5 offset:1824
    s_waitcnt lgkmcnt(6)
    v_mfma_f32_16x16x32_bf16 v[56:59], v[240:243], v[88:91], 0
    ds_read_b64_tr_b16 v[232:233], v4 offset:8192
    v_mfma_f32_16x16x32_bf16 v[60:63], v[240:243], v[92:95], 0
    ds_read_b64_tr_b16 v[234:235], v4 offset:9216
    s_waitcnt lgkmcnt(6)
    v_mfma_f32_16x16x32_bf16 v[64:67], v[244:247], v[88:91], 0
    ds_read_b64_tr_b16 v[236:237], v5 offset:8224
    v_mfma_f32_16x16x32_bf16 v[68:71], v[244:247], v[92:95], 0
    ds_read_b64_tr_b16 v[238:239], v5 offset:9248
    s_mov_b32 s23, 0x9000
    buffer_load_dwordx4 v[124:127], v7, s[8:11], s23 offen offset:0 sc1
    s_waitcnt lgkmcnt(6)
    v_mfma_f32_16x16x32_bf16 v[72:75], v[224:227], v[88:91], 0
    ds_read_b64_tr_b16 v[240:241], v4 offset:8448
    v_mfma_f32_16x16x32_bf16 v[76:79], v[224:227], v[92:95], 0
    ds_read_b64_tr_b16 v[242:243], v4 offset:9472
    s_waitcnt lgkmcnt(6)
    v_mfma_f32_16x16x32_bf16 v[80:83], v[228:231], v[88:91], 0
    ds_read_b64_tr_b16 v[244:245], v5 offset:8480
    v_mfma_f32_16x16x32_bf16 v[84:87], v[228:231], v[92:95], 0
    ds_read_b64_tr_b16 v[246:247], v5 offset:9504
    s_waitcnt vmcnt(7) lgkmcnt(6)
    v_mfma_f32_16x16x32_bf16 v[24:27], v[232:235], v[96:99], v[24:27]
    ds_read_b64_tr_b16 v[224:225], v4 offset:8704
    s_waitcnt vmcnt(6)
    v_mfma_f32_16x16x32_bf16 v[28:31], v[232:235], v[100:103], v[28:31]
    ds_read_b64_tr_b16 v[226:227], v4 offset:9728
    s_waitcnt lgkmcnt(6)
    v_mfma_f32_16x16x32_bf16 v[32:35], v[236:239], v[96:99], v[32:35]
    ds_read_b64_tr_b16 v[228:229], v5 offset:8736
    v_mfma_f32_16x16x32_bf16 v[36:39], v[236:239], v[100:103], v[36:39]
    ds_read_b64_tr_b16 v[230:231], v5 offset:9760
    s_mov_b32 s23, 0x1000
    buffer_load_dwordx4 v[128:131], v7, s[8:11], s23 offen offset:1024 sc1
    s_waitcnt lgkmcnt(6)
    v_mfma_f32_16x16x32_bf16 v[40:43], v[240:243], v[96:99], v[40:43]
    ds_read_b64_tr_b16 v[232:233], v4 offset:8960
    v_mfma_f32_16x16x32_bf16 v[44:47], v[240:243], v[100:103], v[44:47]
    ds_read_b64_tr_b16 v[234:235], v4 offset:9984
    s_waitcnt lgkmcnt(6)
    v_mfma_f32_16x16x32_bf16 v[48:51], v[244:247], v[96:99], v[48:51]
    ds_read_b64_tr_b16 v[236:237], v5 offset:8992
    v_mfma_f32_16x16x32_bf16 v[52:55], v[244:247], v[100:103], v[52:55]
    ds_read_b64_tr_b16 v[238:239], v5 offset:10016
    s_waitcnt lgkmcnt(6)
    v_mfma_f32_16x16x32_bf16 v[56:59], v[224:227], v[96:99], v[56:59]
    v_mfma_f32_16x16x32_bf16 v[60:63], v[224:227], v[100:103], v[60:63]
    s_barrier
    ds_read_b64_tr_b16 v[240:241], v4 offset:16384
    ds_read_b64_tr_b16 v[242:243], v4 offset:17408
    s_waitcnt lgkmcnt(6)
    v_mfma_f32_16x16x32_bf16 v[64:67], v[228:231], v[96:99], v[64:67]
    ds_read_b64_tr_b16 v[244:245], v5 offset:16416
    v_mfma_f32_16x16x32_bf16 v[68:71], v[228:231], v[100:103], v[68:71]
    s_add_u32 s22, s19, 0x180000
    s_add_u32 m0, s20, 0xc000
    s_nop 0
    buffer_load_dwordx4 v3, s[4:7], s22 offen lds
    ds_read_b64_tr_b16 v[246:247], v5 offset:17440
    s_mov_b32 s23, 0x9000
    buffer_load_dwordx4 v[132:135], v7, s[8:11], s23 offen offset:1024 sc1
    s_waitcnt lgkmcnt(6)
    v_mfma_f32_16x16x32_bf16 v[72:75], v[232:235], v[96:99], v[72:75]
    ds_read_b64_tr_b16 v[224:225], v4 offset:16640
    v_mfma_f32_16x16x32_bf16 v[76:79], v[232:235], v[100:103], v[76:79]
    ds_read_b64_tr_b16 v[226:227], v4 offset:17664
    s_waitcnt lgkmcnt(6)
    v_mfma_f32_16x16x32_bf16 v[80:83], v[236:239], v[96:99], v[80:83]
    ds_read_b64_tr_b16 v[228:229], v5 offset:16672
    v_mfma_f32_16x16x32_bf16 v[84:87], v[236:239], v[100:103], v[84:87]
    ds_read_b64_tr_b16 v[230:231], v5 offset:17696
    s_waitcnt vmcnt(8) lgkmcnt(6)
    v_mfma_f32_16x16x32_bf16 v[24:27], v[240:243], v[104:107], v[24:27]
    ds_read_b64_tr_b16 v[232:233], v4 offset:16896
    s_waitcnt vmcnt(7)
    v_mfma_f32_16x16x32_bf16 v[28:31], v[240:243], v[108:111], v[28:31]
    ds_read_b64_tr_b16 v[234:235], v4 offset:17920
    s_waitcnt lgkmcnt(6)
    v_mfma_f32_16x16x32_bf16 v[32:35], v[244:247], v[104:107], v[32:35]
    ds_read_b64_tr_b16 v[236:237], v5 offset:16928
    v_mfma_f32_16x16x32_bf16 v[36:39], v[244:247], v[108:111], v[36:39]
    s_add_u32 s22, s19, 0x188000
    s_add_u32 m0, s20, 0xc400
    s_nop 0
    buffer_load_dwordx4 v3, s[4:7], s22 offen lds
    ds_read_b64_tr_b16 v[238:239], v5 offset:17952
    s_mov_b32 s23, 0x1800
    buffer_load_dwordx4 v[88:91], v7, s[8:11], s23 offen offset:0 sc1
    s_waitcnt lgkmcnt(6)
    v_mfma_f32_16x16x32_bf16 v[40:43], v[224:227], v[104:107], v[40:43]
    ds_read_b64_tr_b16 v[240:241], v4 offset:17152
    v_mfma_f32_16x16x32_bf16 v[44:47], v[224:227], v[108:111], v[44:47]
    ds_read_b64_tr_b16 v[242:243], v4 offset:18176
    s_waitcnt lgkmcnt(6)
    v_mfma_f32_16x16x32_bf16 v[48:51], v[228:231], v[104:107], v[48:51]
    ds_read_b64_tr_b16 v[244:245], v5 offset:17184
    v_mfma_f32_16x16x32_bf16 v[52:55], v[228:231], v[108:111], v[52:55]
    ds_read_b64_tr_b16 v[246:247], v5 offset:18208
    s_waitcnt lgkmcnt(6)
    v_mfma_f32_16x16x32_bf16 v[56:59], v[232:235], v[104:107], v[56:59]
    ds_read_b64_tr_b16 v[224:225], v4 offset:24576
    v_mfma_f32_16x16x32_bf16 v[60:63], v[232:235], v[108:111], v[60:63]
    ds_read_b64_tr_b16 v[226:227], v4 offset:25600
    s_waitcnt lgkmcnt(6)
    v_mfma_f32_16x16x32_bf16 v[64:67], v[236:239], v[104:107], v[64:67]
    ds_read_b64_tr_b16 v[228:229], v5 offset:24608
    v_mfma_f32_16x16x32_bf16 v[68:71], v[236:239], v[108:111], v[68:71]
    ds_read_b64_tr_b16 v[230:231], v5 offset:25632
    s_mov_b32 s23, 0x9800
    buffer_load_dwordx4 v[92:95], v7, s[8:11], s23 offen offset:0 sc1
    s_waitcnt lgkmcnt(6)
    v_mfma_f32_16x16x32_bf16 v[72:75], v[240:243], v[104:107], v[72:75]
    ds_read_b64_tr_b16 v[232:233], v4 offset:24832
    v_mfma_f32_16x16x32_bf16 v[76:79], v[240:243], v[108:111], v[76:79]
    ds_read_b64_tr_b16 v[234:235], v4 offset:25856
    s_waitcnt lgkmcnt(6)
    v_mfma_f32_16x16x32_bf16 v[80:83], v[244:247], v[104:107], v[80:83]
    ds_read_b64_tr_b16 v[236:237], v5 offset:24864
    v_mfma_f32_16x16x32_bf16 v[84:87], v[244:247], v[108:111], v[84:87]
    ds_read_b64_tr_b16 v[238:239], v5 offset:25888
    s_waitcnt vmcnt(9) lgkmcnt(6)
    v_mfma_f32_16x16x32_bf16 v[24:27], v[224:227], v[112:115], v[24:27]
    ds_read_b64_tr_b16 v[240:241], v4 offset:25088
    s_waitcnt vmcnt(8)
    v_mfma_f32_16x16x32_bf16 v[28:31], v[224:227], v[116:119], v[28:31]
    ds_read_b64_tr_b16 v[242:243], v4 offset:26112
    s_waitcnt lgkmcnt(6)
    v_mfma_f32_16x16x32_bf16 v[32:35], v[228:231], v[112:115], v[32:35]
    ds_read_b64_tr_b16 v[244:245], v5 offset:25120
    v_mfma_f32_16x16x32_bf16 v[36:39], v[228:231], v[116:119], v[36:39]
    ds_read_b64_tr_b16 v[246:247], v5 offset:26144
    s_mov_b32 s23, 0x1800
    buffer_load_dwordx4 v[96:99], v7, s[8:11], s23 offen offset:1024 sc1
    s_waitcnt lgkmcnt(6)
    v_mfma_f32_16x16x32_bf16 v[40:43], v[232:235], v[112:115], v[40:43]
    ds_read_b64_tr_b16 v[224:225], v4 offset:25344
    v_mfma_f32_16x16x32_bf16 v[44:47], v[232:235], v[116:119], v[44:47]
    ds_read_b64_tr_b16 v[226:227], v4 offset:26368
    s_waitcnt lgkmcnt(6)
    v_mfma_f32_16x16x32_bf16 v[48:51], v[236:239], v[112:115], v[48:51]
    ds_read_b64_tr_b16 v[228:229], v5 offset:25376
    v_mfma_f32_16x16x32_bf16 v[52:55], v[236:239], v[116:119], v[52:55]
    ds_read_b64_tr_b16 v[230:231], v5 offset:26400
    s_waitcnt lgkmcnt(6)
    v_mfma_f32_16x16x32_bf16 v[56:59], v[240:243], v[112:115], v[56:59]
    v_mfma_f32_16x16x32_bf16 v[60:63], v[240:243], v[116:119], v[60:63]
    s_barrier
    ds_read_b64_tr_b16 v[232:233], v4 offset:32768
    ds_read_b64_tr_b16 v[234:235], v4 offset:33792
    s_waitcnt lgkmcnt(6)
    v_mfma_f32_16x16x32_bf16 v[64:67], v[244:247], v[112:115], v[64:67]
    ds_read_b64_tr_b16 v[236:237], v5 offset:32800
    v_mfma_f32_16x16x32_bf16 v[68:71], v[244:247], v[116:119], v[68:71]
    s_add_u32 s22, s19, 0x200000
    s_add_u32 m0, s20, 0x0
    s_nop 0
    buffer_load_dwordx4 v3, s[4:7], s22 offen lds
    ds_read_b64_tr_b16 v[238:239], v5 offset:33824
    s_mov_b32 s23, 0x9800
    buffer_load_dwordx4 v[100:103], v7, s[8:11], s23 offen offset:1024 sc1
    s_waitcnt lgkmcnt(6)
    v_mfma_f32_16x16x32_bf16 v[72:75], v[224:227], v[112:115], v[72:75]
    ds_read_b64_tr_b16 v[240:241], v4 offset:33024
    v_mfma_f32_16x16x32_bf16 v[76:79], v[224:227], v[116:119], v[76:79]
    ds_read_b64_tr_b16 v[242:243], v4 offset:34048
    s_waitcnt lgkmcnt(6)
    v_mfma_f32_16x16x32_bf16 v[80:83], v[228:231], v[112:115], v[80:83]
    ds_read_b64_tr_b16 v[244:245], v5 offset:33056
    v_mfma_f32_16x16x32_bf16 v[84:87], v[228:231], v[116:119], v[84:87]
    ds_read_b64_tr_b16 v[246:247], v5 offset:34080
    s_waitcnt vmcnt(10) lgkmcnt(6)
    v_mfma_f32_16x16x32_bf16 v[24:27], v[232:235], v[120:123], v[24:27]
    ds_read_b64_tr_b16 v[224:225], v4 offset:33280
    s_waitcnt vmcnt(9)
    v_mfma_f32_16x16x32_bf16 v[28:31], v[232:235], v[124:127], v[28:31]
    ds_read_b64_tr_b16 v[226:227], v4 offset:34304
    s_waitcnt lgkmcnt(6)
    v_mfma_f32_16x16x32_bf16 v[32:35], v[236:239], v[120:123], v[32:35]
    ds_read_b64_tr_b16 v[228:229], v5 offset:33312
    v_mfma_f32_16x16x32_bf16 v[36:39], v[236:239], v[124:127], v[36:39]
    s_add_u32 s22, s19, 0x208000
    s_add_u32 m0, s20, 0x400
    s_nop 0
    buffer_load_dwordx4 v3, s[4:7], s22 offen lds
    ds_read_b64_tr_b16 v[230:231], v5 offset:34336
    s_mov_b32 s23, 0x2000
    buffer_load_dwordx4 v[104:107], v7, s[8:11], s23 offen offset:0 sc1
    s_waitcnt lgkmcnt(6)
    v_mfma_f32_16x16x32_bf16 v[40:43], v[240:243], v[120:123], v[40:43]
    ds_read_b64_tr_b16 v[232:233], v4 offset:33536
    v_mfma_f32_16x16x32_bf16 v[44:47], v[240:243], v[124:127], v[44:47]
    ds_read_b64_tr_b16 v[234:235], v4 offset:34560
    s_waitcnt lgkmcnt(6)
    v_mfma_f32_16x16x32_bf16 v[48:51], v[244:247], v[120:123], v[48:51]
    ds_read_b64_tr_b16 v[236:237], v5 offset:33568
    v_mfma_f32_16x16x32_bf16 v[52:55], v[244:247], v[124:127], v[52:55]
    ds_read_b64_tr_b16 v[238:239], v5 offset:34592
    s_waitcnt lgkmcnt(6)
    v_mfma_f32_16x16x32_bf16 v[56:59], v[224:227], v[120:123], v[56:59]
    ds_read_b64_tr_b16 v[240:241], v4 offset:40960
    v_mfma_f32_16x16x32_bf16 v[60:63], v[224:227], v[124:127], v[60:63]
    ds_read_b64_tr_b16 v[242:243], v4 offset:41984
    s_waitcnt lgkmcnt(6)
    v_mfma_f32_16x16x32_bf16 v[64:67], v[228:231], v[120:123], v[64:67]
    ds_read_b64_tr_b16 v[244:245], v5 offset:40992
    v_mfma_f32_16x16x32_bf16 v[68:71], v[228:231], v[124:127], v[68:71]
    ds_read_b64_tr_b16 v[246:247], v5 offset:42016
    s_mov_b32 s23, 0xa000
    buffer_load_dwordx4 v[108:111], v7, s[8:11], s23 offen offset:0 sc1
    s_waitcnt lgkmcnt(6)
    v_mfma_f32_16x16x32_bf16 v[72:75], v[232:235], v[120:123], v[72:75]
    ds_read_b64_tr_b16 v[224:225], v4 offset:41216
    v_mfma_f32_16x16x32_bf16 v[76:79], v[232:235], v[124:127], v[76:79]
    ds_read_b64_tr_b16 v[226:227], v4 offset:42240
    s_waitcnt lgkmcnt(6)
    v_mfma_f32_16x16x32_bf16 v[80:83], v[236:239], v[120:123], v[80:83]
    ds_read_b64_tr_b16 v[228:229], v5 offset:41248
    v_mfma_f32_16x16x32_bf16 v[84:87], v[236:239], v[124:127], v[84:87]
    ds_read_b64_tr_b16 v[230:231], v5 offset:42272
    s_waitcnt vmcnt(11) lgkmcnt(6)
    v_mfma_f32_16x16x32_bf16 v[24:27], v[240:243], v[128:131], v[24:27]
    ds_read_b64_tr_b16 v[232:233], v4 offset:41472
    s_waitcnt vmcnt(9)
    v_mfma_f32_16x16x32_bf16 v[28:31], v[240:243], v[132:135], v[28:31]
    ds_read_b64_tr_b16 v[234:235], v4 offset:42496
    s_waitcnt lgkmcnt(6)
    v_mfma_f32_16x16x32_bf16 v[32:35], v[244:247], v[128:131], v[32:35]
    ds_read_b64_tr_b16 v[236:237], v5 offset:41504
    v_mfma_f32_16x16x32_bf16 v[36:39], v[244:247], v[132:135], v[36:39]
    ds_read_b64_tr_b16 v[238:239], v5 offset:42528
    s_mov_b32 s23, 0x2000
    buffer_load_dwordx4 v[112:115], v7, s[8:11], s23 offen offset:1024 sc1
    s_waitcnt lgkmcnt(6)
    v_mfma_f32_16x16x32_bf16 v[40:43], v[224:227], v[128:131], v[40:43]
    ds_read_b64_tr_b16 v[240:241], v4 offset:41728
    v_mfma_f32_16x16x32_bf16 v[44:47], v[224:227], v[132:135], v[44:47]
    ds_read_b64_tr_b16 v[242:243], v4 offset:42752
    s_waitcnt lgkmcnt(6)
    v_mfma_f32_16x16x32_bf16 v[48:51], v[228:231], v[128:131], v[48:51]
    ds_read_b64_tr_b16 v[244:245], v5 offset:41760
    v_mfma_f32_16x16x32_bf16 v[52:55], v[228:231], v[132:135], v[52:55]
    ds_read_b64_tr_b16 v[246:247], v5 offset:42784
    s_waitcnt lgkmcnt(6)
    v_mfma_f32_16x16x32_bf16 v[56:59], v[232:235], v[128:131], v[56:59]
    v_mfma_f32_16x16x32_bf16 v[60:63], v[232:235], v[132:135], v[60:63]
    s_waitcnt vmcnt(9)
    s_barrier
    ds_read_b64_tr_b16 v[224:225], v4 offset:49152
    ds_read_b64_tr_b16 v[226:227], v4 offset:50176
    s_waitcnt lgkmcnt(6)
    v_mfma_f32_16x16x32_bf16 v[64:67], v[236:239], v[128:131], v[64:67]
    ds_read_b64_tr_b16 v[228:229], v5 offset:49184
    v_mfma_f32_16x16x32_bf16 v[68:71], v[236:239], v[132:135], v[68:71]
    s_add_u32 s22, s19, 0x280000
    s_add_u32 m0, s20, 0x4000
    s_nop 0
    buffer_load_dwordx4 v3, s[4:7], s22 offen lds
    ds_read_b64_tr_b16 v[230:231], v5 offset:50208
    s_mov_b32 s23, 0xa000
    buffer_load_dwordx4 v[116:119], v7, s[8:11], s23 offen offset:1024 sc1
    s_waitcnt lgkmcnt(6)
    v_mfma_f32_16x16x32_bf16 v[72:75], v[240:243], v[128:131], v[72:75]
    ds_read_b64_tr_b16 v[232:233], v4 offset:49408
    v_mfma_f32_16x16x32_bf16 v[76:79], v[240:243], v[132:135], v[76:79]
    ds_read_b64_tr_b16 v[234:235], v4 offset:50432
    s_waitcnt lgkmcnt(6)
    v_mfma_f32_16x16x32_bf16 v[80:83], v[244:247], v[128:131], v[80:83]
    ds_read_b64_tr_b16 v[236:237], v5 offset:49440
    v_mfma_f32_16x16x32_bf16 v[84:87], v[244:247], v[132:135], v[84:87]
    ds_read_b64_tr_b16 v[238:239], v5 offset:50464
    s_waitcnt vmcnt(10) lgkmcnt(6)
    v_mfma_f32_16x16x32_bf16 v[24:27], v[224:227], v[88:91], v[24:27]
    ds_read_b64_tr_b16 v[240:241], v4 offset:49664
    s_waitcnt vmcnt(9)
    v_mfma_f32_16x16x32_bf16 v[28:31], v[224:227], v[92:95], v[28:31]
    ds_read_b64_tr_b16 v[242:243], v4 offset:50688
    s_waitcnt lgkmcnt(6)
    v_mfma_f32_16x16x32_bf16 v[32:35], v[228:231], v[88:91], v[32:35]
    ds_read_b64_tr_b16 v[244:245], v5 offset:49696
    v_mfma_f32_16x16x32_bf16 v[36:39], v[228:231], v[92:95], v[36:39]
    s_add_u32 s22, s19, 0x288000
    s_add_u32 m0, s20, 0x4400
    s_nop 0
    buffer_load_dwordx4 v3, s[4:7], s22 offen lds
    ds_read_b64_tr_b16 v[246:247], v5 offset:50720
    s_mov_b32 s23, 0x2800
    buffer_load_dwordx4 v[120:123], v7, s[8:11], s23 offen offset:0 sc1
    s_waitcnt lgkmcnt(6)
    v_mfma_f32_16x16x32_bf16 v[40:43], v[232:235], v[88:91], v[40:43]
    ds_read_b64_tr_b16 v[224:225], v4 offset:49920
    v_mfma_f32_16x16x32_bf16 v[44:47], v[232:235], v[92:95], v[44:47]
    ds_read_b64_tr_b16 v[226:227], v4 offset:50944
    s_waitcnt lgkmcnt(6)
    v_mfma_f32_16x16x32_bf16 v[48:51], v[236:239], v[88:91], v[48:51]
    ds_read_b64_tr_b16 v[228:229], v5 offset:49952
    v_mfma_f32_16x16x32_bf16 v[52:55], v[236:239], v[92:95], v[52:55]
    ds_read_b64_tr_b16 v[230:231], v5 offset:50976
    s_waitcnt lgkmcnt(6)
    v_mfma_f32_16x16x32_bf16 v[56:59], v[240:243], v[88:91], v[56:59]
    ds_read_b64_tr_b16 v[232:233], v4 offset:57344
    v_mfma_f32_16x16x32_bf16 v[60:63], v[240:243], v[92:95], v[60:63]
    ds_read_b64_tr_b16 v[234:235], v4 offset:58368
    s_waitcnt lgkmcnt(6)
    v_mfma_f32_16x16x32_bf16 v[64:67], v[244:247], v[88:91], v[64:67]
    ds_read_b64_tr_b16 v[236:237], v5 offset:57376
    v_mfma_f32_16x16x32_bf16 v[68:71], v[244:247], v[92:95], v[68:71]
    ds_read_b64_tr_b16 v[238:239], v5 offset:58400
    s_mov_b32 s23, 0xa800
    buffer_load_dwordx4 v[124:127], v7, s[8:11], s23 offen offset:0 sc1
    s_waitcnt lgkmcnt(6)
    v_mfma_f32_16x16x32_bf16 v[72:75], v[224:227], v[88:91], v[72:75]
    ds_read_b64_tr_b16 v[240:241], v4 offset:57600
    v_mfma_f32_16x16x32_bf16 v[76:79], v[224:227], v[92:95], v[76:79]
    ds_read_b64_tr_b16 v[242:243], v4 offset:58624
    s_waitcnt lgkmcnt(6)
    v_mfma_f32_16x16x32_bf16 v[80:83], v[228:231], v[88:91], v[80:83]
    ds_read_b64_tr_b16 v[244:245], v5 offset:57632
    v_mfma_f32_16x16x32_bf16 v[84:87], v[228:231], v[92:95], v[84:87]
    ds_read_b64_tr_b16 v[246:247], v5 offset:58656
    s_waitcnt vmcnt(11) lgkmcnt(6)
    v_mfma_f32_16x16x32_bf16 v[24:27], v[232:235], v[96:99], v[24:27]
    ds_read_b64_tr_b16 v[224:225], v4 offset:57856
    s_waitcnt vmcnt(9)
    v_mfma_f32_16x16x32_bf16 v[28:31], v[232:235], v[100:103], v[28:31]
    ds_read_b64_tr_b16 v[226:227], v4 offset:58880
    s_waitcnt lgkmcnt(6)
    v_mfma_f32_16x16x32_bf16 v[32:35], v[236:239], v[96:99], v[32:35]
    ds_read_b64_tr_b16 v[228:229], v5 offset:57888
    v_mfma_f32_16x16x32_bf16 v[36:39], v[236:239], v[100:103], v[36:39]
    ds_read_b64_tr_b16 v[230:231], v5 offset:58912
    s_mov_b32 s23, 0x2800
    buffer_load_dwordx4 v[128:131], v7, s[8:11], s23 offen offset:1024 sc1
    s_waitcnt lgkmcnt(6)
    v_mfma_f32_16x16x32_bf16 v[40:43], v[240:243], v[96:99], v[40:43]
    ds_read_b64_tr_b16 v[232:233], v4 offset:58112
    v_mfma_f32_16x16x32_bf16 v[44:47], v[240:243], v[100:103], v[44:47]
    ds_read_b64_tr_b16 v[234:235], v4 offset:59136
    s_waitcnt lgkmcnt(6)
    v_mfma_f32_16x16x32_bf16 v[48:51], v[244:247], v[96:99], v[48:51]
    ds_read_b64_tr_b16 v[236:237], v5 offset:58144
    v_mfma_f32_16x16x32_bf16 v[52:55], v[244:247], v[100:103], v[52:55]
    ds_read_b64_tr_b16 v[238:239], v5 offset:59168
    s_waitcnt lgkmcnt(6)
    v_mfma_f32_16x16x32_bf16 v[56:59], v[224:227], v[96:99], v[56:59]
    v_mfma_f32_16x16x32_bf16 v[60:63], v[224:227], v[100:103], v[60:63]
    s_waitcnt vmcnt(9)
    s_barrier
    ds_read_b64_tr_b16 v[240:241], v4 offset:0
    ds_read_b64_tr_b16 v[242:243], v4 offset:1024
    s_waitcnt lgkmcnt(6)
    v_mfma_f32_16x16x32_bf16 v[64:67], v[228:231], v[96:99], v[64:67]
    ds_read_b64_tr_b16 v[244:245], v5 offset:32
    v_mfma_f32_16x16x32_bf16 v[68:71], v[228:231], v[100:103], v[68:71]
    s_add_u32 s22, s19, 0x300000
    s_add_u32 m0, s20, 0x8000
    s_nop 0
    buffer_load_dwordx4 v3, s[4:7], s22 offen lds
    ds_read_b64_tr_b16 v[246:247], v5 offset:1056
    s_mov_b32 s23, 0xa800
    buffer_load_dwordx4 v[132:135], v7, s[8:11], s23 offen offset:1024 sc1
    s_waitcnt lgkmcnt(6)
    v_mfma_f32_16x16x32_bf16 v[72:75], v[232:235], v[96:99], v[72:75]
    ds_read_b64_tr_b16 v[224:225], v4 offset:256
    v_mfma_f32_16x16x32_bf16 v[76:79], v[232:235], v[100:103], v[76:79]
    ds_read_b64_tr_b16 v[226:227], v4 offset:1280
    s_waitcnt lgkmcnt(6)
    v_mfma_f32_16x16x32_bf16 v[80:83], v[236:239], v[96:99], v[80:83]
    ds_read_b64_tr_b16 v[228:229], v5 offset:288
    v_mfma_f32_16x16x32_bf16 v[84:87], v[236:239], v[100:103], v[84:87]
    ds_read_b64_tr_b16 v[230:231], v5 offset:1312
    s_waitcnt vmcnt(10) lgkmcnt(6)
    v_mfma_f32_16x16x32_bf16 v[24:27], v[240:243], v[104:107], v[24:27]
    ds_read_b64_tr_b16 v[232:233], v4 offset:512
    s_waitcnt vmcnt(9)
    v_mfma_f32_16x16x32_bf16 v[28:31], v[240:243], v[108:111], v[28:31]
    ds_read_b64_tr_b16 v[234:235], v4 offset:1536
    s_waitcnt lgkmcnt(6)
    v_mfma_f32_16x16x32_bf16 v[32:35], v[244:247], v[104:107], v[32:35]
    ds_read_b64_tr_b16 v[236:237], v5 offset:544
    v_mfma_f32_16x16x32_bf16 v[36:39], v[244:247], v[108:111], v[36:39]
    s_add_u32 s22, s19, 0x308000
    s_add_u32 m0, s20, 0x8400
    s_nop 0
    buffer_load_dwordx4 v3, s[4:7], s22 offen lds
    ds_read_b64_tr_b16 v[238:239], v5 offset:1568
    s_mov_b32 s23, 0x3000
    buffer_load_dwordx4 v[88:91], v7, s[8:11], s23 offen offset:0 sc1
    s_waitcnt lgkmcnt(6)
    v_mfma_f32_16x16x32_bf16 v[40:43], v[224:227], v[104:107], v[40:43]
    ds_read_b64_tr_b16 v[240:241], v4 offset:768
    v_mfma_f32_16x16x32_bf16 v[44:47], v[224:227], v[108:111], v[44:47]
    ds_read_b64_tr_b16 v[242:243], v4 offset:1792
    s_waitcnt lgkmcnt(6)
    v_mfma_f32_16x16x32_bf16 v[48:51], v[228:231], v[104:107], v[48:51]
    ds_read_b64_tr_b16 v[244:245], v5 offset:800
    v_mfma_f32_16x16x32_bf16 v[52:55], v[228:231], v[108:111], v[52:55]
    ds_read_b64_tr_b16 v[246:247], v5 offset:1824
    s_waitcnt lgkmcnt(6)
    v_mfma_f32_16x16x32_bf16 v[56:59], v[232:235], v[104:107], v[56:59]
    ds_read_b64_tr_b16 v[224:225], v4 offset:8192
    v_mfma_f32_16x16x32_bf16 v[60:63], v[232:235], v[108:111], v[60:63]
    ds_read_b64_tr_b16 v[226:227], v4 offset:9216
    s_waitcnt lgkmcnt(6)
    v_mfma_f32_16x16x32_bf16 v[64:67], v[236:239], v[104:107], v[64:67]
    ds_read_b64_tr_b16 v[228:229], v5 offset:8224
    v_mfma_f32_16x16x32_bf16 v[68:71], v[236:239], v[108:111], v[68:71]
    ds_read_b64_tr_b16 v[230:231], v5 offset:9248
    s_mov_b32 s23, 0xb000
    buffer_load_dwordx4 v[92:95], v7, s[8:11], s23 offen offset:0 sc1
    s_waitcnt lgkmcnt(6)
    v_mfma_f32_16x16x32_bf16 v[72:75], v[240:243], v[104:107], v[72:75]
    ds_read_b64_tr_b16 v[232:233], v4 offset:8448
    v_mfma_f32_16x16x32_bf16 v[76:79], v[240:243], v[108:111], v[76:79]
    ds_read_b64_tr_b16 v[234:235], v4 offset:9472
    s_waitcnt lgkmcnt(6)
    v_mfma_f32_16x16x32_bf16 v[80:83], v[244:247], v[104:107], v[80:83]
    ds_read_b64_tr_b16 v[236:237], v5 offset:8480
    v_mfma_f32_16x16x32_bf16 v[84:87], v[244:247], v[108:111], v[84:87]
    ds_read_b64_tr_b16 v[238:239], v5 offset:9504
    s_waitcnt vmcnt(11) lgkmcnt(6)
    v_mfma_f32_16x16x32_bf16 v[24:27], v[224:227], v[112:115], v[24:27]
    ds_read_b64_tr_b16 v[240:241], v4 offset:8704
    s_waitcnt vmcnt(9)
    v_mfma_f32_16x16x32_bf16 v[28:31], v[224:227], v[116:119], v[28:31]
    ds_read_b64_tr_b16 v[242:243], v4 offset:9728
    s_waitcnt lgkmcnt(6)
    v_mfma_f32_16x16x32_bf16 v[32:35], v[228:231], v[112:115], v[32:35]
    ds_read_b64_tr_b16 v[244:245], v5 offset:8736
    v_mfma_f32_16x16x32_bf16 v[36:39], v[228:231], v[116:119], v[36:39]
    ds_read_b64_tr_b16 v[246:247], v5 offset:9760
    s_mov_b32 s23, 0x3000
    buffer_load_dwordx4 v[96:99], v7, s[8:11], s23 offen offset:1024 sc1
    s_waitcnt lgkmcnt(6)
    v_mfma_f32_16x16x32_bf16 v[40:43], v[232:235], v[112:115], v[40:43]
    ds_read_b64_tr_b16 v[224:225], v4 offset:8960
    v_mfma_f32_16x16x32_bf16 v[44:47], v[232:235], v[116:119], v[44:47]
    ds_read_b64_tr_b16 v[226:227], v4 offset:9984
    s_waitcnt lgkmcnt(6)
    v_mfma_f32_16x16x32_bf16 v[48:51], v[236:239], v[112:115], v[48:51]
    ds_read_b64_tr_b16 v[228:229], v5 offset:8992
    v_mfma_f32_16x16x32_bf16 v[52:55], v[236:239], v[116:119], v[52:55]
    ds_read_b64_tr_b16 v[230:231], v5 offset:10016
    s_waitcnt lgkmcnt(6)
    v_mfma_f32_16x16x32_bf16 v[56:59], v[240:243], v[112:115], v[56:59]
    v_mfma_f32_16x16x32_bf16 v[60:63], v[240:243], v[116:119], v[60:63]
    s_waitcnt vmcnt(9)
    s_barrier
    ds_read_b64_tr_b16 v[232:233], v4 offset:16384
    ds_read_b64_tr_b16 v[234:235], v4 offset:17408
    s_waitcnt lgkmcnt(6)
    v_mfma_f32_16x16x32_bf16 v[64:67], v[244:247], v[112:115], v[64:67]
    ds_read_b64_tr_b16 v[236:237], v5 offset:16416
    v_mfma_f32_16x16x32_bf16 v[68:71], v[244:247], v[116:119], v[68:71]
    s_add_u32 s22, s19, 0x380000
    s_add_u32 m0, s20, 0xc000
    s_nop 0
    buffer_load_dwordx4 v3, s[4:7], s22 offen lds
    ds_read_b64_tr_b16 v[238:239], v5 offset:17440
    s_mov_b32 s23, 0xb000
    buffer_load_dwordx4 v[100:103], v7, s[8:11], s23 offen offset:1024 sc1
    s_waitcnt lgkmcnt(6)
    v_mfma_f32_16x16x32_bf16 v[72:75], v[224:227], v[112:115], v[72:75]
    ds_read_b64_tr_b16 v[240:241], v4 offset:16640
    v_mfma_f32_16x16x32_bf16 v[76:79], v[224:227], v[116:119], v[76:79]
    ds_read_b64_tr_b16 v[242:243], v4 offset:17664
    s_waitcnt lgkmcnt(6)
    v_mfma_f32_16x16x32_bf16 v[80:83], v[228:231], v[112:115], v[80:83]
    ds_read_b64_tr_b16 v[244:245], v5 offset:16672
    v_mfma_f32_16x16x32_bf16 v[84:87], v[228:231], v[116:119], v[84:87]
    ds_read_b64_tr_b16 v[246:247], v5 offset:17696
    s_waitcnt vmcnt(10) lgkmcnt(6)
    v_mfma_f32_16x16x32_bf16 v[24:27], v[232:235], v[120:123], v[24:27]
    ds_read_b64_tr_b16 v[224:225], v4 offset:16896
    s_waitcnt vmcnt(9)
    v_mfma_f32_16x16x32_bf16 v[28:31], v[232:235], v[124:127], v[28:31]
    ds_read_b64_tr_b16 v[226:227], v4 offset:17920
    s_waitcnt lgkmcnt(6)
    v_mfma_f32_16x16x32_bf16 v[32:35], v[236:239], v[120:123], v[32:35]
    ds_read_b64_tr_b16 v[228:229], v5 offset:16928
    v_mfma_f32_16x16x32_bf16 v[36:39], v[236:239], v[124:127], v[36:39]
    s_add_u32 s22, s19, 0x388000
    s_add_u32 m0, s20, 0xc400
    s_nop 0
    buffer_load_dwordx4 v3, s[4:7], s22 offen lds
    ds_read_b64_tr_b16 v[230:231], v5 offset:17952
    s_mov_b32 s23, 0x3800
    buffer_load_dwordx4 v[104:107], v7, s[8:11], s23 offen offset:0 sc1
    s_waitcnt lgkmcnt(6)
    v_mfma_f32_16x16x32_bf16 v[40:43], v[240:243], v[120:123], v[40:43]
    ds_read_b64_tr_b16 v[232:233], v4 offset:17152
    v_mfma_f32_16x16x32_bf16 v[44:47], v[240:243], v[124:127], v[44:47]
    ds_read_b64_tr_b16 v[234:235], v4 offset:18176
    s_waitcnt lgkmcnt(6)
    v_mfma_f32_16x16x32_bf16 v[48:51], v[244:247], v[120:123], v[48:51]
    ds_read_b64_tr_b16 v[236:237], v5 offset:17184
    v_mfma_f32_16x16x32_bf16 v[52:55], v[244:247], v[124:127], v[52:55]
    ds_read_b64_tr_b16 v[238:239], v5 offset:18208
    s_waitcnt lgkmcnt(6)
    v_mfma_f32_16x16x32_bf16 v[56:59], v[224:227], v[120:123], v[56:59]
    ds_read_b64_tr_b16 v[240:241], v4 offset:24576
    v_mfma_f32_16x16x32_bf16 v[60:63], v[224:227], v[124:127], v[60:63]
    ds_read_b64_tr_b16 v[242:243], v4 offset:25600
    s_waitcnt lgkmcnt(6)
    v_mfma_f32_16x16x32_bf16 v[64:67], v[228:231], v[120:123], v[64:67]
    ds_read_b64_tr_b16 v[244:245], v5 offset:24608
    v_mfma_f32_16x16x32_bf16 v[68:71], v[228:231], v[124:127], v[68:71]
    ds_read_b64_tr_b16 v[246:247], v5 offset:25632
    s_mov_b32 s23, 0xb800
    buffer_load_dwordx4 v[108:111], v7, s[8:11], s23 offen offset:0 sc1
    s_waitcnt lgkmcnt(6)
    v_mfma_f32_16x16x32_bf16 v[72:75], v[232:235], v[120:123], v[72:75]
    ds_read_b64_tr_b16 v[224:225], v4 offset:24832
    v_mfma_f32_16x16x32_bf16 v[76:79], v[232:235], v[124:127], v[76:79]
    ds_read_b64_tr_b16 v[226:227], v4 offset:25856
    s_waitcnt lgkmcnt(6)
    v_mfma_f32_16x16x32_bf16 v[80:83], v[236:239], v[120:123], v[80:83]
    ds_read_b64_tr_b16 v[228:229], v5 offset:24864
    v_mfma_f32_16x16x32_bf16 v[84:87], v[236:239], v[124:127], v[84:87]
    ds_read_b64_tr_b16 v[230:231], v5 offset:25888
    s_waitcnt vmcnt(11) lgkmcnt(6)
    v_mfma_f32_16x16x32_bf16 v[24:27], v[240:243], v[128:131], v[24:27]
    ds_read_b64_tr_b16 v[232:233], v4 offset:25088
    s_waitcnt vmcnt(9)
    v_mfma_f32_16x16x32_bf16 v[28:31], v[240:243], v[132:135], v[28:31]
    ds_read_b64_tr_b16 v[234:235], v4 offset:26112
    s_waitcnt lgkmcnt(6)
    v_mfma_f32_16x16x32_bf16 v[32:35], v[244:247], v[128:131], v[32:35]
    ds_read_b64_tr_b16 v[236:237], v5 offset:25120
    v_mfma_f32_16x16x32_bf16 v[36:39], v[244:247], v[132:135], v[36:39]
    ds_read_b64_tr_b16 v[238:239], v5 offset:26144
    s_mov_b32 s23, 0x3800
    buffer_load_dwordx4 v[112:115], v7, s[8:11], s23 offen offset:1024 sc1
    s_waitcnt lgkmcnt(6)
    v_mfma_f32_16x16x32_bf16 v[40:43], v[224:227], v[128:131], v[40:43]
    ds_read_b64_tr_b16 v[240:241], v4 offset:25344
    v_mfma_f32_16x16x32_bf16 v[44:47], v[224:227], v[132:135], v[44:47]
    ds_read_b64_tr_b16 v[242:243], v4 offset:26368
    s_waitcnt lgkmcnt(6)
    v_mfma_f32_16x16x32_bf16 v[48:51], v[228:231], v[128:131], v[48:51]
    ds_read_b64_tr_b16 v[244:245], v5 offset:25376
    v_mfma_f32_16x16x32_bf16 v[52:55], v[228:231], v[132:135], v[52:55]
    ds_read_b64_tr_b16 v[246:247], v5 offset:26400
    s_waitcnt lgkmcnt(6)
    v_mfma_f32_16x16x32_bf16 v[56:59], v[232:235], v[128:131], v[56:59]
    v_mfma_f32_16x16x32_bf16 v[60:63], v[232:235], v[132:135], v[60:63]
    s_waitcnt vmcnt(9)
    s_barrier
    ds_read_b64_tr_b16 v[224:225], v4 offset:32768
    ds_read_b64_tr_b16 v[226:227], v4 offset:33792
    s_waitcnt lgkmcnt(6)
    v_mfma_f32_16x16x32_bf16 v[64:67], v[236:239], v[128:131], v[64:67]
    ds_read_b64_tr_b16 v[228:229], v5 offset:32800
    v_mfma_f32_16x16x32_bf16 v[68:71], v[236:239], v[132:135], v[68:71]
    s_add_u32 s22, s19, 0x400000
    s_add_u32 m0, s20, 0x0
    s_nop 0
    buffer_load_dwordx4 v3, s[4:7], s22 offen lds
    ds_read_b64_tr_b16 v[230:231], v5 offset:33824
    s_mov_b32 s23, 0xb800
    buffer_load_dwordx4 v[116:119], v7, s[8:11], s23 offen offset:1024 sc1
    s_waitcnt lgkmcnt(6)
    v_mfma_f32_16x16x32_bf16 v[72:75], v[240:243], v[128:131], v[72:75]
    ds_read_b64_tr_b16 v[232:233], v4 offset:33024
    v_mfma_f32_16x16x32_bf16 v[76:79], v[240:243], v[132:135], v[76:79]
    ds_read_b64_tr_b16 v[234:235], v4 offset:34048
    s_waitcnt lgkmcnt(6)
    v_mfma_f32_16x16x32_bf16 v[80:83], v[244:247], v[128:131], v[80:83]
    ds_read_b64_tr_b16 v[236:237], v5 offset:33056
    v_mfma_f32_16x16x32_bf16 v[84:87], v[244:247], v[132:135], v[84:87]
    ds_read_b64_tr_b16 v[238:239], v5 offset:34080
    s_waitcnt vmcnt(10) lgkmcnt(6)
    v_mfma_f32_16x16x32_bf16 v[24:27], v[224:227], v[88:91], v[24:27]
    ds_read_b64_tr_b16 v[240:241], v4 offset:33280
    s_waitcnt vmcnt(9)
    v_mfma_f32_16x16x32_bf16 v[28:31], v[224:227], v[92:95], v[28:31]
    ds_read_b64_tr_b16 v[242:243], v4 offset:34304
    s_waitcnt lgkmcnt(6)
    v_mfma_f32_16x16x32_bf16 v[32:35], v[228:231], v[88:91], v[32:35]
    ds_read_b64_tr_b16 v[244:245], v5 offset:33312
    v_mfma_f32_16x16x32_bf16 v[36:39], v[228:231], v[92:95], v[36:39]
    s_add_u32 s22, s19, 0x408000
    s_add_u32 m0, s20, 0x400
    s_nop 0
    buffer_load_dwordx4 v3, s[4:7], s22 offen lds
    ds_read_b64_tr_b16 v[246:247], v5 offset:34336
    s_mov_b32 s23, 0x4000
    buffer_load_dwordx4 v[120:123], v7, s[8:11], s23 offen offset:0 sc1
    s_waitcnt lgkmcnt(6)
    v_mfma_f32_16x16x32_bf16 v[40:43], v[232:235], v[88:91], v[40:43]
    ds_read_b64_tr_b16 v[224:225], v4 offset:33536
    v_mfma_f32_16x16x32_bf16 v[44:47], v[232:235], v[92:95], v[44:47]
    ds_read_b64_tr_b16 v[226:227], v4 offset:34560
    s_waitcnt lgkmcnt(6)
    v_mfma_f32_16x16x32_bf16 v[48:51], v[236:239], v[88:91], v[48:51]
    ds_read_b64_tr_b16 v[228:229], v5 offset:33568
    v_mfma_f32_16x16x32_bf16 v[52:55], v[236:239], v[92:95], v[52:55]
    ds_read_b64_tr_b16 v[230:231], v5 offset:34592
    s_waitcnt lgkmcnt(6)
    v_mfma_f32_16x16x32_bf16 v[56:59], v[240:243], v[88:91], v[56:59]
    ds_read_b64_tr_b16 v[232:233], v4 offset:40960
    v_mfma_f32_16x16x32_bf16 v[60:63], v[240:243], v[92:95], v[60:63]
    ds_read_b64_tr_b16 v[234:235], v4 offset:41984
    s_waitcnt lgkmcnt(6)
    v_mfma_f32_16x16x32_bf16 v[64:67], v[244:247], v[88:91], v[64:67]
    ds_read_b64_tr_b16 v[236:237], v5 offset:40992
    v_mfma_f32_16x16x32_bf16 v[68:71], v[244:247], v[92:95], v[68:71]
    ds_read_b64_tr_b16 v[238:239], v5 offset:42016
    s_mov_b32 s23, 0xc000
    buffer_load_dwordx4 v[124:127], v7, s[8:11], s23 offen offset:0 sc1
    s_waitcnt lgkmcnt(6)
    v_mfma_f32_16x16x32_bf16 v[72:75], v[224:227], v[88:91], v[72:75]
    ds_read_b64_tr_b16 v[240:241], v4 offset:41216
    v_lshrrev_b32 v21, 4, v1
    v_lshlrev_b32 v21, 9, v21
    v_and_b32 v20, 15, v1
    v_lshl_add_u32 v21, v20, 4, v21
    s_lshr_b32 s18, s12, 3
    s_lshl_b32 s18, s18, 11
    s_add_u32 s18, s18, 0x528100
    buffer_load_dwordx4 v[12:15], v21, s[8:11], s18 offen sc1
    v_mfma_f32_16x16x32_bf16 v[76:79], v[224:227], v[92:95], v[76:79]
    ds_read_b64_tr_b16 v[242:243], v4 offset:42240
    s_waitcnt lgkmcnt(6)
    v_mfma_f32_16x16x32_bf16 v[80:83], v[228:231], v[88:91], v[80:83]
    ds_read_b64_tr_b16 v[244:245], v5 offset:41248
    v_mfma_f32_16x16x32_bf16 v[84:87], v[228:231], v[92:95], v[84:87]
    ds_read_b64_tr_b16 v[246:247], v5 offset:42272
    s_waitcnt vmcnt(12) lgkmcnt(6)
    v_mfma_f32_16x16x32_bf16 v[24:27], v[232:235], v[96:99], v[24:27]
    ds_read_b64_tr_b16 v[224:225], v4 offset:41472
    s_waitcnt vmcnt(10)
    v_mfma_f32_16x16x32_bf16 v[28:31], v[232:235], v[100:103], v[28:31]
    ds_read_b64_tr_b16 v[226:227], v4 offset:42496
    s_waitcnt lgkmcnt(6)
    v_mfma_f32_16x16x32_bf16 v[32:35], v[236:239], v[96:99], v[32:35]
    ds_read_b64_tr_b16 v[228:229], v5 offset:41504
    v_mfma_f32_16x16x32_bf16 v[36:39], v[236:239], v[100:103], v[36:39]
    ds_read_b64_tr_b16 v[230:231], v5 offset:42528
    s_mov_b32 s23, 0x4000
    buffer_load_dwordx4 v[128:131], v7, s[8:11], s23 offen offset:1024 sc1
    s_waitcnt lgkmcnt(6)
    v_mfma_f32_16x16x32_bf16 v[40:43], v[240:243], v[96:99], v[40:43]
    ds_read_b64_tr_b16 v[232:233], v4 offset:41728
    v_mfma_f32_16x16x32_bf16 v[44:47], v[240:243], v[100:103], v[44:47]
    ds_read_b64_tr_b16 v[234:235], v4 offset:42752
    s_waitcnt lgkmcnt(6)
    v_mfma_f32_16x16x32_bf16 v[48:51], v[244:247], v[96:99], v[48:51]
    ds_read_b64_tr_b16 v[236:237], v5 offset:41760
    v_mfma_f32_16x16x32_bf16 v[52:55], v[244:247], v[100:103], v[52:55]
    ds_read_b64_tr_b16 v[238:239], v5 offset:42784
    s_waitcnt lgkmcnt(6)
    v_mfma_f32_16x16x32_bf16 v[56:59], v[224:227], v[96:99], v[56:59]
    v_mfma_f32_16x16x32_bf16 v[60:63], v[224:227], v[100:103], v[60:63]
    s_waitcnt vmcnt(10)
    s_barrier
    ds_read_b64_tr_b16 v[240:241], v4 offset:49152
    ds_read_b64_tr_b16 v[242:243], v4 offset:50176
    s_waitcnt lgkmcnt(6)
    v_mfma_f32_16x16x32_bf16 v[64:67], v[228:231], v[96:99], v[64:67]
    ds_read_b64_tr_b16 v[244:245], v5 offset:49184
    v_mfma_f32_16x16x32_bf16 v[68:71], v[228:231], v[100:103], v[68:71]
    s_add_u32 s22, s19, 0x480000
    s_add_u32 m0, s20, 0x4000
    s_nop 0
    buffer_load_dwordx4 v3, s[4:7], s22 offen lds
    ds_read_b64_tr_b16 v[246:247], v5 offset:50208
    s_mov_b32 s23, 0xc000
    buffer_load_dwordx4 v[132:135], v7, s[8:11], s23 offen offset:1024 sc1
    s_waitcnt lgkmcnt(6)
    v_mfma_f32_16x16x32_bf16 v[72:75], v[232:235], v[96:99], v[72:75]
    ds_read_b64_tr_b16 v[224:225], v4 offset:49408
    v_mfma_f32_16x16x32_bf16 v[76:79], v[232:235], v[100:103], v[76:79]
    ds_read_b64_tr_b16 v[226:227], v4 offset:50432
    s_waitcnt lgkmcnt(6)
    v_mfma_f32_16x16x32_bf16 v[80:83], v[236:239], v[96:99], v[80:83]
    ds_read_b64_tr_b16 v[228:229], v5 offset:49440
    v_mfma_f32_16x16x32_bf16 v[84:87], v[236:239], v[100:103], v[84:87]
    ds_read_b64_tr_b16 v[230:231], v5 offset:50464
    s_waitcnt vmcnt(11) lgkmcnt(6)
    v_mfma_f32_16x16x32_bf16 v[24:27], v[240:243], v[104:107], v[24:27]
    ds_read_b64_tr_b16 v[232:233], v4 offset:49664
    s_waitcnt vmcnt(10)
    v_mfma_f32_16x16x32_bf16 v[28:31], v[240:243], v[108:111], v[28:31]
    ds_read_b64_tr_b16 v[234:235], v4 offset:50688
    s_waitcnt lgkmcnt(6)
    v_mfma_f32_16x16x32_bf16 v[32:35], v[244:247], v[104:107], v[32:35]
    ds_read_b64_tr_b16 v[236:237], v5 offset:49696
    v_mfma_f32_16x16x32_bf16 v[36:39], v[244:247], v[108:111], v[36:39]
    s_add_u32 s22, s19, 0x488000
    s_add_u32 m0, s20, 0x4400
    s_nop 0
    buffer_load_dwordx4 v3, s[4:7], s22 offen lds
    ds_read_b64_tr_b16 v[238:239], v5 offset:50720
    s_mov_b32 s23, 0x4800
    buffer_load_dwordx4 v[88:91], v7, s[8:11], s23 offen offset:0 sc1
    s_waitcnt lgkmcnt(6)
    v_mfma_f32_16x16x32_bf16 v[40:43], v[224:227], v[104:107], v[40:43]
    ds_read_b64_tr_b16 v[240:241], v4 offset:49920
    v_mfma_f32_16x16x32_bf16 v[44:47], v[224:227], v[108:111], v[44:47]
    ds_read_b64_tr_b16 v[242:243], v4 offset:50944
    s_waitcnt lgkmcnt(6)
    v_mfma_f32_16x16x32_bf16 v[48:51], v[228:231], v[104:107], v[48:51]
    ds_read_b64_tr_b16 v[244:245], v5 offset:49952
    v_mfma_f32_16x16x32_bf16 v[52:55], v[228:231], v[108:111], v[52:55]
    ds_read_b64_tr_b16 v[246:247], v5 offset:50976
    s_waitcnt lgkmcnt(6)
    v_mfma_f32_16x16x32_bf16 v[56:59], v[232:235], v[104:107], v[56:59]
    ds_read_b64_tr_b16 v[224:225], v4 offset:57344
    v_mfma_f32_16x16x32_bf16 v[60:63], v[232:235], v[108:111], v[60:63]
    ds_read_b64_tr_b16 v[226:227], v4 offset:58368
    s_waitcnt lgkmcnt(6)
    v_mfma_f32_16x16x32_bf16 v[64:67], v[236:239], v[104:107], v[64:67]
    ds_read_b64_tr_b16 v[228:229], v5 offset:57376
    v_mfma_f32_16x16x32_bf16 v[68:71], v[236:239], v[108:111], v[68:71]
    ds_read_b64_tr_b16 v[230:231], v5 offset:58400
    s_mov_b32 s23, 0xc800
    buffer_load_dwordx4 v[92:95], v7, s[8:11], s23 offen offset:0 sc1
    s_waitcnt lgkmcnt(6)
    v_mfma_f32_16x16x32_bf16 v[72:75], v[240:243], v[104:107], v[72:75]
    ds_read_b64_tr_b16 v[232:233], v4 offset:57600
    v_mfma_f32_16x16x32_bf16 v[76:79], v[240:243], v[108:111], v[76:79]
    ds_read_b64_tr_b16 v[234:235], v4 offset:58624
    s_waitcnt lgkmcnt(6)
    v_mfma_f32_16x16x32_bf16 v[80:83], v[244:247], v[104:107], v[80:83]
    ds_read_b64_tr_b16 v[236:237], v5 offset:57632
    v_mfma_f32_16x16x32_bf16 v[84:87], v[244:247], v[108:111], v[84:87]
    ds_read_b64_tr_b16 v[238:239], v5 offset:58656
    s_waitcnt vmcnt(12) lgkmcnt(6)
    v_mfma_f32_16x16x32_bf16 v[24:27], v[224:227], v[112:115], v[24:27]
    ds_read_b64_tr_b16 v[240:241], v4 offset:57856
    s_waitcnt vmcnt(10)
    v_mfma_f32_16x16x32_bf16 v[28:31], v[224:227], v[116:119], v[28:31]
    ds_read_b64_tr_b16 v[242:243], v4 offset:58880
    s_waitcnt lgkmcnt(6)
    v_mfma_f32_16x16x32_bf16 v[32:35], v[228:231], v[112:115], v[32:35]
    ds_read_b64_tr_b16 v[244:245], v5 offset:57888
    v_mfma_f32_16x16x32_bf16 v[36:39], v[228:231], v[116:119], v[36:39]
    ds_read_b64_tr_b16 v[246:247], v5 offset:58912
    s_mov_b32 s23, 0x4800
    buffer_load_dwordx4 v[96:99], v7, s[8:11], s23 offen offset:1024 sc1
    s_waitcnt lgkmcnt(6)
    v_mfma_f32_16x16x32_bf16 v[40:43], v[232:235], v[112:115], v[40:43]
    ds_read_b64_tr_b16 v[224:225], v4 offset:58112
    v_mfma_f32_16x16x32_bf16 v[44:47], v[232:235], v[116:119], v[44:47]
    ds_read_b64_tr_b16 v[226:227], v4 offset:59136
    s_waitcnt lgkmcnt(6)
    v_mfma_f32_16x16x32_bf16 v[48:51], v[236:239], v[112:115], v[48:51]
    ds_read_b64_tr_b16 v[228:229], v5 offset:58144
    v_mfma_f32_16x16x32_bf16 v[52:55], v[236:239], v[116:119], v[52:55]
    ds_read_b64_tr_b16 v[230:231], v5 offset:59168
    s_waitcnt lgkmcnt(6)
    v_mfma_f32_16x16x32_bf16 v[56:59], v[240:243], v[112:115], v[56:59]
    v_mfma_f32_16x16x32_bf16 v[60:63], v[240:243], v[116:119], v[60:63]
    s_waitcnt vmcnt(10)
    s_barrier
    ds_read_b64_tr_b16 v[232:233], v4 offset:0
    ds_read_b64_tr_b16 v[234:235], v4 offset:1024
    s_waitcnt lgkmcnt(6)
    v_mfma_f32_16x16x32_bf16 v[64:67], v[244:247], v[112:115], v[64:67]
    ds_read_b64_tr_b16 v[236:237], v5 offset:32
    v_mfma_f32_16x16x32_bf16 v[68:71], v[244:247], v[116:119], v[68:71]
    s_add_u32 s22, s19, 0x500000
    s_add_u32 m0, s20, 0x8000
    s_nop 0
    buffer_load_dwordx4 v3, s[4:7], s22 offen lds
    ds_read_b64_tr_b16 v[238:239], v5 offset:1056
    s_mov_b32 s23, 0xc800
    buffer_load_dwordx4 v[100:103], v7, s[8:11], s23 offen offset:1024 sc1
    s_waitcnt lgkmcnt(6)
    v_mfma_f32_16x16x32_bf16 v[72:75], v[224:227], v[112:115], v[72:75]
    ds_read_b64_tr_b16 v[240:241], v4 offset:256
    v_mfma_f32_16x16x32_bf16 v[76:79], v[224:227], v[116:119], v[76:79]
    ds_read_b64_tr_b16 v[242:243], v4 offset:1280
    s_waitcnt lgkmcnt(6)
    v_mfma_f32_16x16x32_bf16 v[80:83], v[228:231], v[112:115], v[80:83]
    ds_read_b64_tr_b16 v[244:245], v5 offset:288
    v_mfma_f32_16x16x32_bf16 v[84:87], v[228:231], v[116:119], v[84:87]
    ds_read_b64_tr_b16 v[246:247], v5 offset:1312
    s_waitcnt vmcnt(11) lgkmcnt(6)
    v_mfma_f32_16x16x32_bf16 v[24:27], v[232:235], v[120:123], v[24:27]
    ds_read_b64_tr_b16 v[224:225], v4 offset:512
    s_waitcnt vmcnt(10)
    v_mfma_f32_16x16x32_bf16 v[28:31], v[232:235], v[124:127], v[28:31]
    ds_read_b64_tr_b16 v[226:227], v4 offset:1536
    s_waitcnt lgkmcnt(6)
    v_mfma_f32_16x16x32_bf16 v[32:35], v[236:239], v[120:123], v[32:35]
    ds_read_b64_tr_b16 v[228:229], v5 offset:544
    v_mfma_f32_16x16x32_bf16 v[36:39], v[236:239], v[124:127], v[36:39]
    s_add_u32 s22, s19, 0x508000
    s_add_u32 m0, s20, 0x8400
    s_nop 0
    buffer_load_dwordx4 v3, s[4:7], s22 offen lds
    ds_read_b64_tr_b16 v[230:231], v5 offset:1568
    s_mov_b32 s23, 0x5000
    buffer_load_dwordx4 v[104:107], v7, s[8:11], s23 offen offset:0 sc1
    s_waitcnt lgkmcnt(6)
    v_mfma_f32_16x16x32_bf16 v[40:43], v[240:243], v[120:123], v[40:43]
    ds_read_b64_tr_b16 v[232:233], v4 offset:768
    v_mfma_f32_16x16x32_bf16 v[44:47], v[240:243], v[124:127], v[44:47]
    ds_read_b64_tr_b16 v[234:235], v4 offset:1792
    s_waitcnt lgkmcnt(6)
    v_mfma_f32_16x16x32_bf16 v[48:51], v[244:247], v[120:123], v[48:51]
    ds_read_b64_tr_b16 v[236:237], v5 offset:800
    v_mfma_f32_16x16x32_bf16 v[52:55], v[244:247], v[124:127], v[52:55]
    ds_read_b64_tr_b16 v[238:239], v5 offset:1824
    s_waitcnt lgkmcnt(6)
    v_mfma_f32_16x16x32_bf16 v[56:59], v[224:227], v[120:123], v[56:59]
    ds_read_b64_tr_b16 v[240:241], v4 offset:8192
    v_mfma_f32_16x16x32_bf16 v[60:63], v[224:227], v[124:127], v[60:63]
    ds_read_b64_tr_b16 v[242:243], v4 offset:9216
    s_waitcnt lgkmcnt(6)
    v_mfma_f32_16x16x32_bf16 v[64:67], v[228:231], v[120:123], v[64:67]
    ds_read_b64_tr_b16 v[244:245], v5 offset:8224
    v_mfma_f32_16x16x32_bf16 v[68:71], v[228:231], v[124:127], v[68:71]
    ds_read_b64_tr_b16 v[246:247], v5 offset:9248
    s_mov_b32 s23, 0xd000
    buffer_load_dwordx4 v[108:111], v7, s[8:11], s23 offen offset:0 sc1
    s_waitcnt lgkmcnt(6)
    v_mfma_f32_16x16x32_bf16 v[72:75], v[232:235], v[120:123], v[72:75]
    ds_read_b64_tr_b16 v[224:225], v4 offset:8448
    v_mfma_f32_16x16x32_bf16 v[76:79], v[232:235], v[124:127], v[76:79]
    ds_read_b64_tr_b16 v[226:227], v4 offset:9472
    s_waitcnt lgkmcnt(6)
    v_mfma_f32_16x16x32_bf16 v[80:83], v[236:239], v[120:123], v[80:83]
    ds_read_b64_tr_b16 v[228:229], v5 offset:8480
    v_mfma_f32_16x16x32_bf16 v[84:87], v[236:239], v[124:127], v[84:87]
    ds_read_b64_tr_b16 v[230:231], v5 offset:9504
    s_waitcnt vmcnt(11) lgkmcnt(6)
    v_mfma_f32_16x16x32_bf16 v[24:27], v[240:243], v[128:131], v[24:27]
    ds_read_b64_tr_b16 v[232:233], v4 offset:8704
    s_waitcnt vmcnt(9)
    v_mfma_f32_16x16x32_bf16 v[28:31], v[240:243], v[132:135], v[28:31]
    ds_read_b64_tr_b16 v[234:235], v4 offset:9728
    s_waitcnt lgkmcnt(6)
    v_mfma_f32_16x16x32_bf16 v[32:35], v[244:247], v[128:131], v[32:35]
    ds_read_b64_tr_b16 v[236:237], v5 offset:8736
    v_mfma_f32_16x16x32_bf16 v[36:39], v[244:247], v[132:135], v[36:39]
    ds_read_b64_tr_b16 v[238:239], v5 offset:9760
    s_mov_b32 s23, 0x5000
    buffer_load_dwordx4 v[112:115], v7, s[8:11], s23 offen offset:1024 sc1
    s_waitcnt lgkmcnt(6)
    v_mfma_f32_16x16x32_bf16 v[40:43], v[224:227], v[128:131], v[40:43]
    ds_read_b64_tr_b16 v[240:241], v4 offset:8960
    v_mfma_f32_16x16x32_bf16 v[44:47], v[224:227], v[132:135], v[44:47]
    ds_read_b64_tr_b16 v[242:243], v4 offset:9984
    s_waitcnt lgkmcnt(6)
    v_mfma_f32_16x16x32_bf16 v[48:51], v[228:231], v[128:131], v[48:51]
    ds_read_b64_tr_b16 v[244:245], v5 offset:8992
    v_mfma_f32_16x16x32_bf16 v[52:55], v[228:231], v[132:135], v[52:55]
    ds_read_b64_tr_b16 v[246:247], v5 offset:10016
    s_waitcnt lgkmcnt(6)
    v_mfma_f32_16x16x32_bf16 v[56:59], v[232:235], v[128:131], v[56:59]
    v_mfma_f32_16x16x32_bf16 v[60:63], v[232:235], v[132:135], v[60:63]
    s_waitcnt vmcnt(9)
    s_barrier
    ds_read_b64_tr_b16 v[224:225], v4 offset:16384
    ds_read_b64_tr_b16 v[226:227], v4 offset:17408
    s_waitcnt lgkmcnt(6)
    v_mfma_f32_16x16x32_bf16 v[64:67], v[236:239], v[128:131], v[64:67]
    ds_read_b64_tr_b16 v[228:229], v5 offset:16416
    v_mfma_f32_16x16x32_bf16 v[68:71], v[236:239], v[132:135], v[68:71]
    s_add_u32 s22, s19, 0x580000
    s_add_u32 m0, s20, 0xc000
    s_nop 0
    buffer_load_dwordx4 v3, s[4:7], s22 offen lds
    ds_read_b64_tr_b16 v[230:231], v5 offset:17440
    s_mov_b32 s23, 0xd000
    buffer_load_dwordx4 v[116:119], v7, s[8:11], s23 offen offset:1024 sc1
    s_waitcnt lgkmcnt(6)
    v_mfma_f32_16x16x32_bf16 v[72:75], v[240:243], v[128:131], v[72:75]
    ds_read_b64_tr_b16 v[232:233], v4 offset:16640
    v_mfma_f32_16x16x32_bf16 v[76:79], v[240:243], v[132:135], v[76:79]
    ds_read_b64_tr_b16 v[234:235], v4 offset:17664
    s_waitcnt lgkmcnt(6)
    v_mfma_f32_16x16x32_bf16 v[80:83], v[244:247], v[128:131], v[80:83]
    ds_read_b64_tr_b16 v[236:237], v5 offset:16672
    v_mfma_f32_16x16x32_bf16 v[84:87], v[244:247], v[132:135], v[84:87]
    ds_read_b64_tr_b16 v[238:239], v5 offset:17696
    s_waitcnt vmcnt(10) lgkmcnt(6)
    v_mfma_f32_16x16x32_bf16 v[24:27], v[224:227], v[88:91], v[24:27]
    ds_read_b64_tr_b16 v[240:241], v4 offset:16896
    s_waitcnt vmcnt(9)
    v_mfma_f32_16x16x32_bf16 v[28:31], v[224:227], v[92:95], v[28:31]
    ds_read_b64_tr_b16 v[242:243], v4 offset:17920
    s_waitcnt lgkmcnt(6)
    v_mfma_f32_16x16x32_bf16 v[32:35], v[228:231], v[88:91], v[32:35]
    ds_read_b64_tr_b16 v[244:245], v5 offset:16928
    v_mfma_f32_16x16x32_bf16 v[36:39], v[228:231], v[92:95], v[36:39]
    s_add_u32 s22, s19, 0x588000
    s_add_u32 m0, s20, 0xc400
    s_nop 0
    buffer_load_dwordx4 v3, s[4:7], s22 offen lds
    ds_read_b64_tr_b16 v[246:247], v5 offset:17952
    s_mov_b32 s23, 0x5800
    buffer_load_dwordx4 v[120:123], v7, s[8:11], s23 offen offset:0 sc1
    s_waitcnt lgkmcnt(6)
    v_mfma_f32_16x16x32_bf16 v[40:43], v[232:235], v[88:91], v[40:43]
    ds_read_b64_tr_b16 v[224:225], v4 offset:17152
    v_mfma_f32_16x16x32_bf16 v[44:47], v[232:235], v[92:95], v[44:47]
    ds_read_b64_tr_b16 v[226:227], v4 offset:18176
    s_waitcnt lgkmcnt(6)
    v_mfma_f32_16x16x32_bf16 v[48:51], v[236:239], v[88:91], v[48:51]
    ds_read_b64_tr_b16 v[228:229], v5 offset:17184
    v_mfma_f32_16x16x32_bf16 v[52:55], v[236:239], v[92:95], v[52:55]
    ds_read_b64_tr_b16 v[230:231], v5 offset:18208
    s_waitcnt lgkmcnt(6)
    v_mfma_f32_16x16x32_bf16 v[56:59], v[240:243], v[88:91], v[56:59]
    ds_read_b64_tr_b16 v[232:233], v4 offset:24576
    v_mfma_f32_16x16x32_bf16 v[60:63], v[240:243], v[92:95], v[60:63]
    ds_read_b64_tr_b16 v[234:235], v4 offset:25600
    s_waitcnt lgkmcnt(6)
    v_mfma_f32_16x16x32_bf16 v[64:67], v[244:247], v[88:91], v[64:67]
    ds_read_b64_tr_b16 v[236:237], v5 offset:24608
    v_mfma_f32_16x16x32_bf16 v[68:71], v[244:247], v[92:95], v[68:71]
    ds_read_b64_tr_b16 v[238:239], v5 offset:25632
    s_mov_b32 s23, 0xd800
    buffer_load_dwordx4 v[124:127], v7, s[8:11], s23 offen offset:0 sc1
    s_waitcnt lgkmcnt(6)
    v_mfma_f32_16x16x32_bf16 v[72:75], v[224:227], v[88:91], v[72:75]
    ds_read_b64_tr_b16 v[240:241], v4 offset:24832
    v_xor_b32 v8, s28, v12
    v_xor_b32 v20, s28, v13
    v_or_b32 v8, v8, v20
    v_xor_b32 v20, s28, v14
    v_or_b32 v8, v8, v20
    v_xor_b32 v20, s28, v15
    v_or_b32 v8, v8, v20
    v_cmp_ne_u32 vcc, 0, v8
    s_cbranch_vccnz adaLN_cond__sliding_block_cached__moe_arch_mod__prompt_kernel_kv4r
adaLN_cond__sliding_block_cached__moe_arch_mod__prompt_kernel_kv4b:
    v_mfma_f32_16x16x32_bf16 v[76:79], v[224:227], v[92:95], v[76:79]
    ds_read_b64_tr_b16 v[242:243], v4 offset:25856
    v_mov_b32 v20, 0
    s_mov_b32 s16, 0x564000
    buffer_load_dword v8, v20, s[8:11], s16 offen sc1
    s_waitcnt lgkmcnt(6)
    v_mfma_f32_16x16x32_bf16 v[80:83], v[228:231], v[88:91], v[80:83]
    ds_read_b64_tr_b16 v[244:245], v5 offset:24864
    v_mfma_f32_16x16x32_bf16 v[84:87], v[228:231], v[92:95], v[84:87]
    ds_read_b64_tr_b16 v[246:247], v5 offset:25888
    s_waitcnt vmcnt(12) lgkmcnt(6)
    v_mfma_f32_16x16x32_bf16 v[24:27], v[232:235], v[96:99], v[24:27]
    ds_read_b64_tr_b16 v[224:225], v4 offset:25088
    s_waitcnt vmcnt(10)
    v_mfma_f32_16x16x32_bf16 v[28:31], v[232:235], v[100:103], v[28:31]
    ds_read_b64_tr_b16 v[226:227], v4 offset:26112
    s_waitcnt lgkmcnt(6)
    v_mfma_f32_16x16x32_bf16 v[32:35], v[236:239], v[96:99], v[32:35]
    ds_read_b64_tr_b16 v[228:229], v5 offset:25120
    v_mfma_f32_16x16x32_bf16 v[36:39], v[236:239], v[100:103], v[36:39]
    ds_read_b64_tr_b16 v[230:231], v5 offset:26144
    s_mov_b32 s23, 0x5800
    buffer_load_dwordx4 v[128:131], v7, s[8:11], s23 offen offset:1024 sc1
    s_waitcnt lgkmcnt(6)
    v_mfma_f32_16x16x32_bf16 v[40:43], v[240:243], v[96:99], v[40:43]
    ds_read_b64_tr_b16 v[232:233], v4 offset:25344
    s_mov_b64 s[76:77], s[54:55]
    s_mov_b32 s78, 0xc00000
    s_mov_b32 s79, 0x20000
    v_bfe_u32 v20, v1, 2, 2
    v_lshlrev_b32 v20, 12, v20
    v_add_u32 v6, v3, v20
    s_lshr_b32 s16, s2, 5
    s_lshl_b32 s16, s16, 7
    s_lshl_b32 s17, s3, 3
    s_add_u32 s16, s16, s17
    s_mul_i32 s14, s16, 12288
    s_and_b32 s16, s2, 31
    s_lshl_b32 s16, s16, 8
    s_add_u32 s14, s14, s16
    s_add_u32 s14, s14, 4096
    v_mfma_f32_16x16x32_bf16 v[44:47], v[240:243], v[100:103], v[44:47]
    ds_read_b64_tr_b16 v[234:235], v4 offset:26368
    s_waitcnt lgkmcnt(6)
    v_mfma_f32_16x16x32_bf16 v[48:51], v[244:247], v[96:99], v[48:51]
    ds_read_b64_tr_b16 v[236:237], v5 offset:25376
    v_mfma_f32_16x16x32_bf16 v[52:55], v[244:247], v[100:103], v[52:55]
    ds_read_b64_tr_b16 v[238:239], v5 offset:26400
    s_waitcnt lgkmcnt(6)
    v_mfma_f32_16x16x32_bf16 v[56:59], v[224:227], v[96:99], v[56:59]
    v_mfma_f32_16x16x32_bf16 v[60:63], v[224:227], v[100:103], v[60:63]
    s_waitcnt vmcnt(10)
    s_barrier
    ds_read_b64_tr_b16 v[240:241], v4 offset:32768
    ds_read_b64_tr_b16 v[242:243], v4 offset:33792
    s_waitcnt lgkmcnt(6)
    v_mfma_f32_16x16x32_bf16 v[64:67], v[228:231], v[96:99], v[64:67]
    ds_read_b64_tr_b16 v[244:245], v5 offset:32800
    v_mfma_f32_16x16x32_bf16 v[68:71], v[228:231], v[100:103], v[68:71]
    s_add_u32 s22, s19, 0x600000
    s_add_u32 m0, s20, 0x0
    s_nop 0
    buffer_load_dwordx4 v3, s[4:7], s22 offen lds
    ds_read_b64_tr_b16 v[246:247], v5 offset:33824
    s_mov_b32 s23, 0xd800
    buffer_load_dwordx4 v[132:135], v7, s[8:11], s23 offen offset:1024 sc1
    s_waitcnt lgkmcnt(6)
    v_mfma_f32_16x16x32_bf16 v[72:75], v[232:235], v[96:99], v[72:75]
    ds_read_b64_tr_b16 v[224:225], v4 offset:33024
    v_mfma_f32_16x16x32_bf16 v[76:79], v[232:235], v[100:103], v[76:79]
    ds_read_b64_tr_b16 v[226:227], v4 offset:34048
    s_waitcnt lgkmcnt(6)
    v_mfma_f32_16x16x32_bf16 v[80:83], v[236:239], v[96:99], v[80:83]
    ds_read_b64_tr_b16 v[228:229], v5 offset:33056
    v_mfma_f32_16x16x32_bf16 v[84:87], v[236:239], v[100:103], v[84:87]
    ds_read_b64_tr_b16 v[230:231], v5 offset:34080
    s_waitcnt vmcnt(11) lgkmcnt(6)
    v_mfma_f32_16x16x32_bf16 v[24:27], v[240:243], v[104:107], v[24:27]
    ds_read_b64_tr_b16 v[232:233], v4 offset:33280
    s_waitcnt vmcnt(10)
    v_mfma_f32_16x16x32_bf16 v[28:31], v[240:243], v[108:111], v[28:31]
    ds_read_b64_tr_b16 v[234:235], v4 offset:34304
    s_waitcnt lgkmcnt(6)
    v_mfma_f32_16x16x32_bf16 v[32:35], v[244:247], v[104:107], v[32:35]
    ds_read_b64_tr_b16 v[236:237], v5 offset:33312
    v_mfma_f32_16x16x32_bf16 v[36:39], v[244:247], v[108:111], v[36:39]
    s_add_u32 s22, s19, 0x608000
    s_add_u32 m0, s20, 0x400
    s_nop 0
    buffer_load_dwordx4 v3, s[4:7], s22 offen lds
    ds_read_b64_tr_b16 v[238:239], v5 offset:34336
    s_mov_b32 s23, 0x6000
    buffer_load_dwordx4 v[88:91], v7, s[8:11], s23 offen offset:0 sc1
    s_waitcnt lgkmcnt(6)
    v_mfma_f32_16x16x32_bf16 v[40:43], v[224:227], v[104:107], v[40:43]
    ds_read_b64_tr_b16 v[240:241], v4 offset:33536
    v_mfma_f32_16x16x32_bf16 v[44:47], v[224:227], v[108:111], v[44:47]
    ds_read_b64_tr_b16 v[242:243], v4 offset:34560
    s_waitcnt lgkmcnt(6)
    v_mfma_f32_16x16x32_bf16 v[48:51], v[228:231], v[104:107], v[48:51]
    ds_read_b64_tr_b16 v[244:245], v5 offset:33568
    v_mfma_f32_16x16x32_bf16 v[52:55], v[228:231], v[108:111], v[52:55]
    ds_read_b64_tr_b16 v[246:247], v5 offset:34592
    s_waitcnt lgkmcnt(6)
    v_mfma_f32_16x16x32_bf16 v[56:59], v[232:235], v[104:107], v[56:59]
    ds_read_b64_tr_b16 v[224:225], v4 offset:40960
    v_mfma_f32_16x16x32_bf16 v[60:63], v[232:235], v[108:111], v[60:63]
    ds_read_b64_tr_b16 v[226:227], v4 offset:41984
    s_waitcnt lgkmcnt(6)
    v_mfma_f32_16x16x32_bf16 v[64:67], v[236:239], v[104:107], v[64:67]
    ds_read_b64_tr_b16 v[228:229], v5 offset:40992
    v_mfma_f32_16x16x32_bf16 v[68:71], v[236:239], v[108:111], v[68:71]
    ds_read_b64_tr_b16 v[230:231], v5 offset:42016
    s_mov_b32 s23, 0xe000
    buffer_load_dwordx4 v[92:95], v7, s[8:11], s23 offen offset:0 sc1
    s_waitcnt lgkmcnt(6)
    v_mfma_f32_16x16x32_bf16 v[72:75], v[240:243], v[104:107], v[72:75]
    ds_read_b64_tr_b16 v[232:233], v4 offset:41216
    v_mfma_f32_16x16x32_bf16 v[76:79], v[240:243], v[108:111], v[76:79]
    ds_read_b64_tr_b16 v[234:235], v4 offset:42240
    s_waitcnt lgkmcnt(6)
    v_mfma_f32_16x16x32_bf16 v[80:83], v[244:247], v[104:107], v[80:83]
    ds_read_b64_tr_b16 v[236:237], v5 offset:41248
    v_mfma_f32_16x16x32_bf16 v[84:87], v[244:247], v[108:111], v[84:87]
    ds_read_b64_tr_b16 v[238:239], v5 offset:42272
    s_waitcnt vmcnt(12) lgkmcnt(6)
    v_mfma_f32_16x16x32_bf16 v[24:27], v[224:227], v[112:115], v[24:27]
    ds_read_b64_tr_b16 v[240:241], v4 offset:41472
    s_add_u32 s22, s14, 0x0
    s_add_u32 m0, s20, 0x10000
    s_nop 0
    buffer_load_dwordx4 v6, s[76:79], s22 offen lds
    s_waitcnt vmcnt(11)
    v_mfma_f32_16x16x32_bf16 v[28:31], v[224:227], v[116:119], v[28:31]
    ds_read_b64_tr_b16 v[242:243], v4 offset:42496
    s_waitcnt lgkmcnt(6)
    v_mfma_f32_16x16x32_bf16 v[32:35], v[228:231], v[112:115], v[32:35]
    ds_read_b64_tr_b16 v[244:245], v5 offset:41504
    v_mfma_f32_16x16x32_bf16 v[36:39], v[228:231], v[116:119], v[36:39]
    ds_read_b64_tr_b16 v[246:247], v5 offset:42528
    s_mov_b32 s23, 0x6000
    buffer_load_dwordx4 v[96:99], v7, s[8:11], s23 offen offset:1024 sc1
    s_waitcnt lgkmcnt(6)
    v_mfma_f32_16x16x32_bf16 v[40:43], v[232:235], v[112:115], v[40:43]
    ds_read_b64_tr_b16 v[224:225], v4 offset:41728
    s_add_u32 s22, s14, 0xc000
    s_add_u32 m0, s20, 0x10400
    s_nop 0
    buffer_load_dwordx4 v6, s[76:79], s22 offen lds
    v_mfma_f32_16x16x32_bf16 v[44:47], v[232:235], v[116:119], v[44:47]
    ds_read_b64_tr_b16 v[226:227], v4 offset:42752
    s_waitcnt lgkmcnt(6)
    v_mfma_f32_16x16x32_bf16 v[48:51], v[236:239], v[112:115], v[48:51]
    ds_read_b64_tr_b16 v[228:229], v5 offset:41760
    v_mfma_f32_16x16x32_bf16 v[52:55], v[236:239], v[116:119], v[52:55]
    ds_read_b64_tr_b16 v[230:231], v5 offset:42784
    s_waitcnt lgkmcnt(6)
    v_mfma_f32_16x16x32_bf16 v[56:59], v[240:243], v[112:115], v[56:59]
    v_mfma_f32_16x16x32_bf16 v[60:63], v[240:243], v[116:119], v[60:63]
    s_waitcnt vmcnt(12)
    s_barrier
    ds_read_b64_tr_b16 v[232:233], v4 offset:49152
    ds_read_b64_tr_b16 v[234:235], v4 offset:50176
    s_waitcnt lgkmcnt(6)
    v_mfma_f32_16x16x32_bf16 v[64:67], v[244:247], v[112:115], v[64:67]
    ds_read_b64_tr_b16 v[236:237], v5 offset:49184
    v_mfma_f32_16x16x32_bf16 v[68:71], v[244:247], v[116:119], v[68:71]
    s_add_u32 s22, s19, 0x680000
    s_add_u32 m0, s20, 0x4000
    s_nop 0
    buffer_load_dwordx4 v3, s[4:7], s22 offen lds
    ds_read_b64_tr_b16 v[238:239], v5 offset:50208
    s_mov_b32 s23, 0xe000
    buffer_load_dwordx4 v[100:103], v7, s[8:11], s23 offen offset:1024 sc1
    s_waitcnt lgkmcnt(6)
    v_mfma_f32_16x16x32_bf16 v[72:75], v[224:227], v[112:115], v[72:75]
    ds_read_b64_tr_b16 v[240:241], v4 offset:49408
    v_mfma_f32_16x16x32_bf16 v[76:79], v[224:227], v[116:119], v[76:79]
    ds_read_b64_tr_b16 v[242:243], v4 offset:50432
    s_waitcnt lgkmcnt(6)
    v_mfma_f32_16x16x32_bf16 v[80:83], v[228:231], v[112:115], v[80:83]
    ds_read_b64_tr_b16 v[244:245], v5 offset:49440
    v_mfma_f32_16x16x32_bf16 v[84:87], v[228:231], v[116:119], v[84:87]
    ds_read_b64_tr_b16 v[246:247], v5 offset:50464
    s_waitcnt vmcnt(13) lgkmcnt(6)
    v_mfma_f32_16x16x32_bf16 v[24:27], v[232:235], v[120:123], v[24:27]
    ds_read_b64_tr_b16 v[224:225], v4 offset:49664
    s_waitcnt vmcnt(12)
    v_mfma_f32_16x16x32_bf16 v[28:31], v[232:235], v[124:127], v[28:31]
    ds_read_b64_tr_b16 v[226:227], v4 offset:50688
    s_waitcnt lgkmcnt(6)
    v_mfma_f32_16x16x32_bf16 v[32:35], v[236:239], v[120:123], v[32:35]
    ds_read_b64_tr_b16 v[228:229], v5 offset:49696
    v_mfma_f32_16x16x32_bf16 v[36:39], v[236:239], v[124:127], v[36:39]
    s_add_u32 s22, s19, 0x688000
    s_add_u32 m0, s20, 0x4400
    s_nop 0
    buffer_load_dwordx4 v3, s[4:7], s22 offen lds
    ds_read_b64_tr_b16 v[230:231], v5 offset:50720
    s_mov_b32 s23, 0x6800
    buffer_load_dwordx4 v[104:107], v7, s[8:11], s23 offen offset:0 sc1
    s_waitcnt lgkmcnt(6)
    v_mfma_f32_16x16x32_bf16 v[40:43], v[240:243], v[120:123], v[40:43]
    ds_read_b64_tr_b16 v[232:233], v4 offset:49920
    v_mfma_f32_16x16x32_bf16 v[44:47], v[240:243], v[124:127], v[44:47]
    ds_read_b64_tr_b16 v[234:235], v4 offset:50944
    s_waitcnt lgkmcnt(6)
    v_mfma_f32_16x16x32_bf16 v[48:51], v[244:247], v[120:123], v[48:51]
    ds_read_b64_tr_b16 v[236:237], v5 offset:49952
    v_mfma_f32_16x16x32_bf16 v[52:55], v[244:247], v[124:127], v[52:55]
    ds_read_b64_tr_b16 v[238:239], v5 offset:50976
    s_waitcnt lgkmcnt(6)
    v_mfma_f32_16x16x32_bf16 v[56:59], v[224:227], v[120:123], v[56:59]
    ds_read_b64_tr_b16 v[240:241], v4 offset:57344
    v_mfma_f32_16x16x32_bf16 v[60:63], v[224:227], v[124:127], v[60:63]
    ds_read_b64_tr_b16 v[242:243], v4 offset:58368
    s_waitcnt lgkmcnt(6)
    v_mfma_f32_16x16x32_bf16 v[64:67], v[228:231], v[120:123], v[64:67]
    ds_read_b64_tr_b16 v[244:245], v5 offset:57376
    v_mfma_f32_16x16x32_bf16 v[68:71], v[228:231], v[124:127], v[68:71]
    ds_read_b64_tr_b16 v[246:247], v5 offset:58400
    s_mov_b32 s23, 0xe800
    buffer_load_dwordx4 v[108:111], v7, s[8:11], s23 offen offset:0 sc1
    s_waitcnt lgkmcnt(6)
    v_mfma_f32_16x16x32_bf16 v[72:75], v[232:235], v[120:123], v[72:75]
    ds_read_b64_tr_b16 v[224:225], v4 offset:57600
    v_mfma_f32_16x16x32_bf16 v[76:79], v[232:235], v[124:127], v[76:79]
    ds_read_b64_tr_b16 v[226:227], v4 offset:58624
    s_waitcnt lgkmcnt(6)
    v_mfma_f32_16x16x32_bf16 v[80:83], v[236:239], v[120:123], v[80:83]
    ds_read_b64_tr_b16 v[228:229], v5 offset:57632
    v_mfma_f32_16x16x32_bf16 v[84:87], v[236:239], v[124:127], v[84:87]
    ds_read_b64_tr_b16 v[230:231], v5 offset:58656
    s_waitcnt vmcnt(13) lgkmcnt(6)
    v_mfma_f32_16x16x32_bf16 v[24:27], v[240:243], v[128:131], v[24:27]
    ds_read_b64_tr_b16 v[232:233], v4 offset:57856
    s_add_u32 s22, s14, 0xc0000
    s_add_u32 m0, s20, 0x14000
    s_nop 0
    buffer_load_dwordx4 v6, s[76:79], s22 offen lds
    s_waitcnt vmcnt(12)
    v_mfma_f32_16x16x32_bf16 v[28:31], v[240:243], v[132:135], v[28:31]
    ds_read_b64_tr_b16 v[234:235], v4 offset:58880
    s_waitcnt lgkmcnt(6)
    v_mfma_f32_16x16x32_bf16 v[32:35], v[244:247], v[128:131], v[32:35]
    ds_read_b64_tr_b16 v[236:237], v5 offset:57888
    v_mfma_f32_16x16x32_bf16 v[36:39], v[244:247], v[132:135], v[36:39]
    ds_read_b64_tr_b16 v[238:239], v5 offset:58912
    s_mov_b32 s23, 0x6800
    buffer_load_dwordx4 v[112:115], v7, s[8:11], s23 offen offset:1024 sc1
    s_waitcnt lgkmcnt(6)
    v_mfma_f32_16x16x32_bf16 v[40:43], v[224:227], v[128:131], v[40:43]
    ds_read_b64_tr_b16 v[240:241], v4 offset:58112
    s_add_u32 s22, s14, 0xcc000
    s_add_u32 m0, s20, 0x14400
    s_nop 0
    buffer_load_dwordx4 v6, s[76:79], s22 offen lds
    v_mfma_f32_16x16x32_bf16 v[44:47], v[224:227], v[132:135], v[44:47]
    ds_read_b64_tr_b16 v[242:243], v4 offset:59136
    s_waitcnt lgkmcnt(6)
    v_mfma_f32_16x16x32_bf16 v[48:51], v[228:231], v[128:131], v[48:51]
    ds_read_b64_tr_b16 v[244:245], v5 offset:58144
    v_mfma_f32_16x16x32_bf16 v[52:55], v[228:231], v[132:135], v[52:55]
    ds_read_b64_tr_b16 v[246:247], v5 offset:59168
    s_waitcnt lgkmcnt(6)
    v_mfma_f32_16x16x32_bf16 v[56:59], v[232:235], v[128:131], v[56:59]
    v_mfma_f32_16x16x32_bf16 v[60:63], v[232:235], v[132:135], v[60:63]
    s_waitcnt vmcnt(13)
    s_barrier
    ds_read_b64_tr_b16 v[224:225], v4 offset:0
    ds_read_b64_tr_b16 v[226:227], v4 offset:1024
    s_waitcnt lgkmcnt(6)
    v_mfma_f32_16x16x32_bf16 v[64:67], v[236:239], v[128:131], v[64:67]
    ds_read_b64_tr_b16 v[228:229], v5 offset:32
    v_mfma_f32_16x16x32_bf16 v[68:71], v[236:239], v[132:135], v[68:71]
    s_add_u32 s22, s19, 0x700000
    s_add_u32 m0, s20, 0x8000
    s_nop 0
    buffer_load_dwordx4 v3, s[4:7], s22 offen lds
    ds_read_b64_tr_b16 v[230:231], v5 offset:1056
    s_mov_b32 s23, 0xe800
    buffer_load_dwordx4 v[116:119], v7, s[8:11], s23 offen offset:1024 sc1
    s_waitcnt lgkmcnt(6)
    v_mfma_f32_16x16x32_bf16 v[72:75], v[240:243], v[128:131], v[72:75]
    ds_read_b64_tr_b16 v[232:233], v4 offset:256
    v_mfma_f32_16x16x32_bf16 v[76:79], v[240:243], v[132:135], v[76:79]
    ds_read_b64_tr_b16 v[234:235], v4 offset:1280
    s_waitcnt lgkmcnt(6)
    v_mfma_f32_16x16x32_bf16 v[80:83], v[244:247], v[128:131], v[80:83]
    ds_read_b64_tr_b16 v[236:237], v5 offset:288
    v_mfma_f32_16x16x32_bf16 v[84:87], v[244:247], v[132:135], v[84:87]
    ds_read_b64_tr_b16 v[238:239], v5 offset:1312
    s_waitcnt vmcnt(14) lgkmcnt(6)
    v_mfma_f32_16x16x32_bf16 v[24:27], v[224:227], v[88:91], v[24:27]
    ds_read_b64_tr_b16 v[240:241], v4 offset:512
    s_waitcnt vmcnt(13)
    v_mfma_f32_16x16x32_bf16 v[28:31], v[224:227], v[92:95], v[28:31]
    ds_read_b64_tr_b16 v[242:243], v4 offset:1536
    s_waitcnt lgkmcnt(6)
    v_mfma_f32_16x16x32_bf16 v[32:35], v[228:231], v[88:91], v[32:35]
    ds_read_b64_tr_b16 v[244:245], v5 offset:544
    v_mfma_f32_16x16x32_bf16 v[36:39], v[228:231], v[92:95], v[36:39]
    s_add_u32 s22, s19, 0x708000
    s_add_u32 m0, s20, 0x8400
    s_nop 0
    buffer_load_dwordx4 v3, s[4:7], s22 offen lds
    ds_read_b64_tr_b16 v[246:247], v5 offset:1568
    s_mov_b32 s23, 0x7000
    buffer_load_dwordx4 v[120:123], v7, s[8:11], s23 offen offset:0 sc1
    s_waitcnt lgkmcnt(6)
    v_mfma_f32_16x16x32_bf16 v[40:43], v[232:235], v[88:91], v[40:43]
    ds_read_b64_tr_b16 v[224:225], v4 offset:768
    v_mfma_f32_16x16x32_bf16 v[44:47], v[232:235], v[92:95], v[44:47]
    ds_read_b64_tr_b16 v[226:227], v4 offset:1792
    s_waitcnt lgkmcnt(6)
    v_mfma_f32_16x16x32_bf16 v[48:51], v[236:239], v[88:91], v[48:51]
    ds_read_b64_tr_b16 v[228:229], v5 offset:800
    v_mfma_f32_16x16x32_bf16 v[52:55], v[236:239], v[92:95], v[52:55]
    ds_read_b64_tr_b16 v[230:231], v5 offset:1824
    s_waitcnt lgkmcnt(6)
    v_mfma_f32_16x16x32_bf16 v[56:59], v[240:243], v[88:91], v[56:59]
    ds_read_b64_tr_b16 v[232:233], v4 offset:8192
    v_mfma_f32_16x16x32_bf16 v[60:63], v[240:243], v[92:95], v[60:63]
    ds_read_b64_tr_b16 v[234:235], v4 offset:9216
    s_waitcnt lgkmcnt(6)
    v_mfma_f32_16x16x32_bf16 v[64:67], v[244:247], v[88:91], v[64:67]
    ds_read_b64_tr_b16 v[236:237], v5 offset:8224
    v_mfma_f32_16x16x32_bf16 v[68:71], v[244:247], v[92:95], v[68:71]
    ds_read_b64_tr_b16 v[238:239], v5 offset:9248
    s_mov_b32 s23, 0xf000
    buffer_load_dwordx4 v[124:127], v7, s[8:11], s23 offen offset:0 sc1
    s_waitcnt lgkmcnt(6)
    v_mfma_f32_16x16x32_bf16 v[72:75], v[224:227], v[88:91], v[72:75]
    ds_read_b64_tr_b16 v[240:241], v4 offset:8448
    v_mfma_f32_16x16x32_bf16 v[76:79], v[224:227], v[92:95], v[76:79]
    ds_read_b64_tr_b16 v[242:243], v4 offset:9472
    s_waitcnt lgkmcnt(6)
    v_mfma_f32_16x16x32_bf16 v[80:83], v[228:231], v[88:91], v[80:83]
    ds_read_b64_tr_b16 v[244:245], v5 offset:8480
    v_mfma_f32_16x16x32_bf16 v[84:87], v[228:231], v[92:95], v[84:87]
    ds_read_b64_tr_b16 v[246:247], v5 offset:9504
    s_waitcnt vmcnt(14) lgkmcnt(6)
    v_mfma_f32_16x16x32_bf16 v[24:27], v[232:235], v[96:99], v[24:27]
    ds_read_b64_tr_b16 v[224:225], v4 offset:8704
    s_add_u32 s22, s21, 0x0
    s_add_u32 m0, s20, 0x18000
    s_nop 0
    buffer_load_dwordx4 v2, s[8:11], s22 offen sc1 lds
    s_waitcnt vmcnt(12)
    v_mfma_f32_16x16x32_bf16 v[28:31], v[232:235], v[100:103], v[28:31]
    ds_read_b64_tr_b16 v[226:227], v4 offset:9728
    s_waitcnt lgkmcnt(6)
    v_mfma_f32_16x16x32_bf16 v[32:35], v[236:239], v[96:99], v[32:35]
    ds_read_b64_tr_b16 v[228:229], v5 offset:8736
    v_mfma_f32_16x16x32_bf16 v[36:39], v[236:239], v[100:103], v[36:39]
    ds_read_b64_tr_b16 v[230:231], v5 offset:9760
    s_mov_b32 s23, 0x7000
    buffer_load_dwordx4 v[128:131], v7, s[8:11], s23 offen offset:1024 sc1
    s_waitcnt lgkmcnt(6)
    v_mfma_f32_16x16x32_bf16 v[40:43], v[240:243], v[96:99], v[40:43]
    ds_read_b64_tr_b16 v[232:233], v4 offset:8960
    s_add_u32 s22, s21, 0x400
    s_add_u32 m0, s20, 0x18400
    s_nop 0
    buffer_load_dwordx4 v2, s[8:11], s22 offen sc1 lds
    v_mfma_f32_16x16x32_bf16 v[44:47], v[240:243], v[100:103], v[44:47]
    ds_read_b64_tr_b16 v[234:235], v4 offset:9984
    s_waitcnt lgkmcnt(6)
    v_mfma_f32_16x16x32_bf16 v[48:51], v[244:247], v[96:99], v[48:51]
    ds_read_b64_tr_b16 v[236:237], v5 offset:8992
    v_mfma_f32_16x16x32_bf16 v[52:55], v[244:247], v[100:103], v[52:55]
    ds_read_b64_tr_b16 v[238:239], v5 offset:10016
    s_waitcnt lgkmcnt(6)
    v_mfma_f32_16x16x32_bf16 v[56:59], v[224:227], v[96:99], v[56:59]
    v_mfma_f32_16x16x32_bf16 v[60:63], v[224:227], v[100:103], v[60:63]
    s_waitcnt vmcnt(13)
    s_barrier
    ds_read_b64_tr_b16 v[240:241], v4 offset:16384
    ds_read_b64_tr_b16 v[242:243], v4 offset:17408
    s_waitcnt lgkmcnt(6)
    v_mfma_f32_16x16x32_bf16 v[64:67], v[228:231], v[96:99], v[64:67]
    ds_read_b64_tr_b16 v[244:245], v5 offset:16416
    v_mfma_f32_16x16x32_bf16 v[68:71], v[228:231], v[100:103], v[68:71]
    s_add_u32 s22, s19, 0x780000
    s_add_u32 m0, s20, 0xc000
    s_nop 0
    buffer_load_dwordx4 v3, s[4:7], s22 offen lds
    ds_read_b64_tr_b16 v[246:247], v5 offset:17440
    s_mov_b32 s23, 0xf000
    buffer_load_dwordx4 v[132:135], v7, s[8:11], s23 offen offset:1024 sc1
    s_waitcnt lgkmcnt(6)
    v_mfma_f32_16x16x32_bf16 v[72:75], v[232:235], v[96:99], v[72:75]
    ds_read_b64_tr_b16 v[224:225], v4 offset:16640
    v_mfma_f32_16x16x32_bf16 v[76:79], v[232:235], v[100:103], v[76:79]
    ds_read_b64_tr_b16 v[226:227], v4 offset:17664
    s_waitcnt lgkmcnt(6)
    v_mfma_f32_16x16x32_bf16 v[80:83], v[236:239], v[96:99], v[80:83]
    ds_read_b64_tr_b16 v[228:229], v5 offset:16672
    v_mfma_f32_16x16x32_bf16 v[84:87], v[236:239], v[100:103], v[84:87]
    ds_read_b64_tr_b16 v[230:231], v5 offset:17696
    s_waitcnt vmcnt(14) lgkmcnt(6)
    v_mfma_f32_16x16x32_bf16 v[24:27], v[240:243], v[104:107], v[24:27]
    ds_read_b64_tr_b16 v[232:233], v4 offset:16896
    s_waitcnt vmcnt(13)
    v_mfma_f32_16x16x32_bf16 v[28:31], v[240:243], v[108:111], v[28:31]
    ds_read_b64_tr_b16 v[234:235], v4 offset:17920
    s_waitcnt lgkmcnt(6)
    v_mfma_f32_16x16x32_bf16 v[32:35], v[244:247], v[104:107], v[32:35]
    ds_read_b64_tr_b16 v[236:237], v5 offset:16928
    v_mfma_f32_16x16x32_bf16 v[36:39], v[244:247], v[108:111], v[36:39]
    s_add_u32 s22, s19, 0x788000
    s_add_u32 m0, s20, 0xc400
    s_nop 0
    buffer_load_dwordx4 v3, s[4:7], s22 offen lds
    ds_read_b64_tr_b16 v[238:239], v5 offset:17952
    s_mov_b32 s23, 0x7800
    buffer_load_dwordx4 v[88:91], v7, s[8:11], s23 offen offset:0 sc1
    s_waitcnt lgkmcnt(6)
    v_mfma_f32_16x16x32_bf16 v[40:43], v[224:227], v[104:107], v[40:43]
    ds_read_b64_tr_b16 v[240:241], v4 offset:17152
    v_lshrrev_b32 v20, 4, v1
    v_lshlrev_b32 v21, 4, v20
    s_lshl_b32 s16, s2, 8
    s_add_u32 s16, s16, 0x550000
    buffer_load_dwordx4 v[136:139], v21, s[8:11], s16 offen offset:0 sc1
    buffer_load_dwordx4 v[140:143], v21, s[8:11], s16 offen offset:64 sc1
    buffer_load_dwordx4 v[144:147], v21, s[8:11], s16 offen offset:128 sc1
    buffer_load_dwordx4 v[148:151], v21, s[8:11], s16 offen offset:192 sc1
    v_lshlrev_b32 v11, 11, v20
    v_xor_b32 v20, s3, v20
    v_and_b32 v20, 1, v20
    v_lshl_add_u32 v11, v20, 5, v11
    v_bfe_u32 v20, v1, 2, 2
    v_lshl_add_u32 v11, v20, 6, v11
    v_and_b32 v20, 3, v1
    v_lshl_add_u32 v11, v20, 3, v11
    s_lshr_b32 s16, s3, 1
    s_lshl_b32 s16, s16, 8
    s_add_u32 s16, s16, 65536
    v_add_u32 v11, s16, v11
    v_mfma_f32_16x16x32_bf16 v[44:47], v[224:227], v[108:111], v[44:47]
    ds_read_b64_tr_b16 v[242:243], v4 offset:18176
    s_waitcnt lgkmcnt(6)
    v_mfma_f32_16x16x32_bf16 v[48:51], v[228:231], v[104:107], v[48:51]
    ds_read_b64_tr_b16 v[244:245], v5 offset:17184
    v_mfma_f32_16x16x32_bf16 v[52:55], v[228:231], v[108:111], v[52:55]
    ds_read_b64_tr_b16 v[246:247], v5 offset:18208
    s_waitcnt lgkmcnt(6)
    v_mfma_f32_16x16x32_bf16 v[56:59], v[232:235], v[104:107], v[56:59]
    ds_read_b64_tr_b16 v[224:225], v4 offset:24576
    v_mfma_f32_16x16x32_bf16 v[60:63], v[232:235], v[108:111], v[60:63]
    ds_read_b64_tr_b16 v[226:227], v4 offset:25600
    s_waitcnt lgkmcnt(6)
    v_mfma_f32_16x16x32_bf16 v[64:67], v[236:239], v[104:107], v[64:67]
    ds_read_b64_tr_b16 v[228:229], v5 offset:24608
    v_mfma_f32_16x16x32_bf16 v[68:71], v[236:239], v[108:111], v[68:71]
    ds_read_b64_tr_b16 v[230:231], v5 offset:25632
    s_mov_b32 s23, 0xf800
    buffer_load_dwordx4 v[92:95], v7, s[8:11], s23 offen offset:0 sc1
    s_waitcnt lgkmcnt(6)
    v_mfma_f32_16x16x32_bf16 v[72:75], v[240:243], v[104:107], v[72:75]
    ds_read_b64_tr_b16 v[232:233], v4 offset:24832
    v_mfma_f32_16x16x32_bf16 v[76:79], v[240:243], v[108:111], v[76:79]
    ds_read_b64_tr_b16 v[234:235], v4 offset:25856
    s_waitcnt lgkmcnt(6)
    v_mfma_f32_16x16x32_bf16 v[80:83], v[244:247], v[104:107], v[80:83]
    ds_read_b64_tr_b16 v[236:237], v5 offset:24864
    v_mfma_f32_16x16x32_bf16 v[84:87], v[244:247], v[108:111], v[84:87]
    ds_read_b64_tr_b16 v[238:239], v5 offset:25888
    s_waitcnt vmcnt(18) lgkmcnt(6)
    v_mfma_f32_16x16x32_bf16 v[24:27], v[224:227], v[112:115], v[24:27]
    ds_read_b64_tr_b16 v[240:241], v4 offset:25088
    s_add_u32 s22, s21, 0x4000
    s_add_u32 m0, s20, 0x1c000
    s_nop 0
    buffer_load_dwordx4 v2, s[8:11], s22 offen sc1 lds
    s_waitcnt vmcnt(16)
    v_mfma_f32_16x16x32_bf16 v[28:31], v[224:227], v[116:119], v[28:31]
    ds_read_b64_tr_b16 v[242:243], v4 offset:26112
    s_waitcnt lgkmcnt(6)
    v_mfma_f32_16x16x32_bf16 v[32:35], v[228:231], v[112:115], v[32:35]
    ds_read_b64_tr_b16 v[244:245], v5 offset:25120
    v_mfma_f32_16x16x32_bf16 v[36:39], v[228:231], v[116:119], v[36:39]
    ds_read_b64_tr_b16 v[246:247], v5 offset:26144
    s_mov_b32 s23, 0x7800
    buffer_load_dwordx4 v[96:99], v7, s[8:11], s23 offen offset:1024 sc1
    s_waitcnt lgkmcnt(6)
    v_mfma_f32_16x16x32_bf16 v[40:43], v[232:235], v[112:115], v[40:43]
    ds_read_b64_tr_b16 v[224:225], v4 offset:25344
    s_add_u32 s22, s21, 0x4400
    s_add_u32 m0, s20, 0x1c400
    s_nop 0
    buffer_load_dwordx4 v2, s[8:11], s22 offen sc1 lds
    v_mfma_f32_16x16x32_bf16 v[44:47], v[232:235], v[116:119], v[44:47]
    ds_read_b64_tr_b16 v[226:227], v4 offset:26368
    s_waitcnt lgkmcnt(6)
    v_mfma_f32_16x16x32_bf16 v[48:51], v[236:239], v[112:115], v[48:51]
    ds_read_b64_tr_b16 v[228:229], v5 offset:25376
    v_mfma_f32_16x16x32_bf16 v[52:55], v[236:239], v[116:119], v[52:55]
    ds_read_b64_tr_b16 v[230:231], v5 offset:26400
    s_waitcnt lgkmcnt(6)
    v_mfma_f32_16x16x32_bf16 v[56:59], v[240:243], v[112:115], v[56:59]
    v_mfma_f32_16x16x32_bf16 v[60:63], v[240:243], v[116:119], v[60:63]
    s_waitcnt vmcnt(17)
    s_barrier
    ds_read_b64_tr_b16 v[232:233], v4 offset:32768
    ds_read_b64_tr_b16 v[234:235], v4 offset:33792
    s_waitcnt lgkmcnt(6)
    v_mfma_f32_16x16x32_bf16 v[64:67], v[244:247], v[112:115], v[64:67]
    ds_read_b64_tr_b16 v[236:237], v5 offset:32800
    v_mfma_f32_16x16x32_bf16 v[68:71], v[244:247], v[116:119], v[68:71]
    ds_read_b64_tr_b16 v[238:239], v5 offset:33824
    s_mov_b32 s23, 0xf800
    buffer_load_dwordx4 v[100:103], v7, s[8:11], s23 offen offset:1024 sc1
    s_waitcnt lgkmcnt(6)
    v_mfma_f32_16x16x32_bf16 v[72:75], v[224:227], v[112:115], v[72:75]
    ds_read_b64_tr_b16 v[240:241], v4 offset:33024
    v_mfma_f32_16x16x32_bf16 v[76:79], v[224:227], v[116:119], v[76:79]
    ds_read_b64_tr_b16 v[242:243], v4 offset:34048
    s_waitcnt lgkmcnt(6)
    v_mfma_f32_16x16x32_bf16 v[80:83], v[228:231], v[112:115], v[80:83]
    ds_read_b64_tr_b16 v[244:245], v5 offset:33056
    v_mfma_f32_16x16x32_bf16 v[84:87], v[228:231], v[116:119], v[84:87]
    ds_read_b64_tr_b16 v[246:247], v5 offset:34080
    s_waitcnt vmcnt(17) lgkmcnt(6)
    v_mfma_f32_16x16x32_bf16 v[24:27], v[232:235], v[120:123], v[24:27]
    ds_read_b64_tr_b16 v[224:225], v4 offset:33280
    s_waitcnt vmcnt(16)
    v_mfma_f32_16x16x32_bf16 v[28:31], v[232:235], v[124:127], v[28:31]
    ds_read_b64_tr_b16 v[226:227], v4 offset:34304
    s_waitcnt lgkmcnt(6)
    v_mfma_f32_16x16x32_bf16 v[32:35], v[236:239], v[120:123], v[32:35]
    ds_read_b64_tr_b16 v[228:229], v5 offset:33312
    v_mfma_f32_16x16x32_bf16 v[36:39], v[236:239], v[124:127], v[36:39]
    ds_read_b64_tr_b16 v[230:231], v5 offset:34336
    s_waitcnt lgkmcnt(6)
    v_mfma_f32_16x16x32_bf16 v[40:43], v[240:243], v[120:123], v[40:43]
    ds_read_b64_tr_b16 v[232:233], v4 offset:33536
    v_mfma_f32_16x16x32_bf16 v[44:47], v[240:243], v[124:127], v[44:47]
    ds_read_b64_tr_b16 v[234:235], v4 offset:34560
    s_waitcnt lgkmcnt(6)
    v_mfma_f32_16x16x32_bf16 v[48:51], v[244:247], v[120:123], v[48:51]
    ds_read_b64_tr_b16 v[236:237], v5 offset:33568
    v_mfma_f32_16x16x32_bf16 v[52:55], v[244:247], v[124:127], v[52:55]
    ds_read_b64_tr_b16 v[238:239], v5 offset:34592
    s_waitcnt lgkmcnt(6)
    v_mfma_f32_16x16x32_bf16 v[56:59], v[224:227], v[120:123], v[56:59]
    ds_read_b64_tr_b16 v[240:241], v4 offset:40960
    v_mfma_f32_16x16x32_bf16 v[60:63], v[224:227], v[124:127], v[60:63]
    ds_read_b64_tr_b16 v[242:243], v4 offset:41984
    s_waitcnt lgkmcnt(6)
    v_mfma_f32_16x16x32_bf16 v[64:67], v[228:231], v[120:123], v[64:67]
    ds_read_b64_tr_b16 v[244:245], v5 offset:40992
    v_mfma_f32_16x16x32_bf16 v[68:71], v[228:231], v[124:127], v[68:71]
    ds_read_b64_tr_b16 v[246:247], v5 offset:42016
    s_waitcnt lgkmcnt(6)
    v_mfma_f32_16x16x32_bf16 v[72:75], v[232:235], v[120:123], v[72:75]
    ds_read_b64_tr_b16 v[224:225], v4 offset:41216
    v_mfma_f32_16x16x32_bf16 v[76:79], v[232:235], v[124:127], v[76:79]
    ds_read_b64_tr_b16 v[226:227], v4 offset:42240
    s_waitcnt lgkmcnt(6)
    v_mfma_f32_16x16x32_bf16 v[80:83], v[236:239], v[120:123], v[80:83]
    ds_read_b64_tr_b16 v[228:229], v5 offset:41248
    v_mfma_f32_16x16x32_bf16 v[84:87], v[236:239], v[124:127], v[84:87]
    ds_read_b64_tr_b16 v[230:231], v5 offset:42272
    s_waitcnt vmcnt(14) lgkmcnt(6)
    v_mfma_f32_16x16x32_bf16 v[24:27], v[240:243], v[128:131], v[24:27]
    ds_read_b64_tr_b16 v[232:233], v4 offset:41472
    s_waitcnt vmcnt(11)
    v_mfma_f32_16x16x32_bf16 v[28:31], v[240:243], v[132:135], v[28:31]
    ds_read_b64_tr_b16 v[234:235], v4 offset:42496
    s_waitcnt lgkmcnt(6)
    v_mfma_f32_16x16x32_bf16 v[32:35], v[244:247], v[128:131], v[32:35]
    ds_read_b64_tr_b16 v[236:237], v5 offset:41504
    v_mfma_f32_16x16x32_bf16 v[36:39], v[244:247], v[132:135], v[36:39]
    ds_read_b64_tr_b16 v[238:239], v5 offset:42528
    s_waitcnt lgkmcnt(6)
    v_mfma_f32_16x16x32_bf16 v[40:43], v[224:227], v[128:131], v[40:43]
    ds_read_b64_tr_b16 v[240:241], v4 offset:41728
    v_mfma_f32_16x16x32_bf16 v[44:47], v[224:227], v[132:135], v[44:47]
    ds_read_b64_tr_b16 v[242:243], v4 offset:42752
    s_waitcnt lgkmcnt(6)
    v_mfma_f32_16x16x32_bf16 v[48:51], v[228:231], v[128:131], v[48:51]
    ds_read_b64_tr_b16 v[244:245], v5 offset:41760
    v_mfma_f32_16x16x32_bf16 v[52:55], v[228:231], v[132:135], v[52:55]
    ds_read_b64_tr_b16 v[246:247], v5 offset:42784
    s_waitcnt lgkmcnt(6)
    v_mfma_f32_16x16x32_bf16 v[56:59], v[232:235], v[128:131], v[56:59]
    v_mfma_f32_16x16x32_bf16 v[60:63], v[232:235], v[132:135], v[60:63]
    s_waitcnt vmcnt(10)
    s_barrier
    ds_read_b64_tr_b16 v[224:225], v4 offset:49152
    ds_read_b64_tr_b16 v[226:227], v4 offset:50176
    s_waitcnt lgkmcnt(6)
    v_mfma_f32_16x16x32_bf16 v[64:67], v[236:239], v[128:131], v[64:67]
    ds_read_b64_tr_b16 v[228:229], v5 offset:49184
    v_mfma_f32_16x16x32_bf16 v[68:71], v[236:239], v[132:135], v[68:71]
    ds_read_b64_tr_b16 v[230:231], v5 offset:50208
    s_waitcnt lgkmcnt(6)
    v_mfma_f32_16x16x32_bf16 v[72:75], v[240:243], v[128:131], v[72:75]
    ds_read_b64_tr_b16 v[232:233], v4 offset:49408
    v_mfma_f32_16x16x32_bf16 v[76:79], v[240:243], v[132:135], v[76:79]
    ds_read_b64_tr_b16 v[234:235], v4 offset:50432
    s_waitcnt lgkmcnt(6)
    v_mfma_f32_16x16x32_bf16 v[80:83], v[244:247], v[128:131], v[80:83]
    ds_read_b64_tr_b16 v[236:237], v5 offset:49440
    v_mfma_f32_16x16x32_bf16 v[84:87], v[244:247], v[132:135], v[84:87]
    ds_read_b64_tr_b16 v[238:239], v5 offset:50464
    s_waitcnt vmcnt(9) lgkmcnt(6)
    v_mfma_f32_16x16x32_bf16 v[24:27], v[224:227], v[88:91], v[24:27]
    ds_read_b64_tr_b16 v[240:241], v4 offset:49664
    s_waitcnt vmcnt(4)
    v_mfma_f32_16x16x32_bf16 v[28:31], v[224:227], v[92:95], v[28:31]
    ds_read_b64_tr_b16 v[242:243], v4 offset:50688
    s_waitcnt lgkmcnt(6)
    v_mfma_f32_16x16x32_bf16 v[32:35], v[228:231], v[88:91], v[32:35]
    ds_read_b64_tr_b16 v[244:245], v5 offset:49696
    v_mfma_f32_16x16x32_bf16 v[36:39], v[228:231], v[92:95], v[36:39]
    ds_read_b64_tr_b16 v[246:247], v5 offset:50720
    s_waitcnt lgkmcnt(6)
    v_mfma_f32_16x16x32_bf16 v[40:43], v[232:235], v[88:91], v[40:43]
    ds_read_b64_tr_b16 v[224:225], v4 offset:49920
    v_mfma_f32_16x16x32_bf16 v[44:47], v[232:235], v[92:95], v[44:47]
    ds_read_b64_tr_b16 v[226:227], v4 offset:50944
    s_waitcnt lgkmcnt(6)
    v_mfma_f32_16x16x32_bf16 v[48:51], v[236:239], v[88:91], v[48:51]
    ds_read_b64_tr_b16 v[228:229], v5 offset:49952
    v_mfma_f32_16x16x32_bf16 v[52:55], v[236:239], v[92:95], v[52:55]
    ds_read_b64_tr_b16 v[230:231], v5 offset:50976
    s_waitcnt lgkmcnt(6)
    v_mfma_f32_16x16x32_bf16 v[56:59], v[240:243], v[88:91], v[56:59]
    ds_read_b64_tr_b16 v[232:233], v4 offset:57344
    v_mfma_f32_16x16x32_bf16 v[60:63], v[240:243], v[92:95], v[60:63]
    ds_read_b64_tr_b16 v[234:235], v4 offset:58368
    s_waitcnt lgkmcnt(6)
    v_mfma_f32_16x16x32_bf16 v[64:67], v[244:247], v[88:91], v[64:67]
    ds_read_b64_tr_b16 v[236:237], v5 offset:57376
    v_mfma_f32_16x16x32_bf16 v[68:71], v[244:247], v[92:95], v[68:71]
    ds_read_b64_tr_b16 v[238:239], v5 offset:58400
    s_waitcnt lgkmcnt(6)
    v_mfma_f32_16x16x32_bf16 v[72:75], v[224:227], v[88:91], v[72:75]
    ds_read_b64_tr_b16 v[240:241], v4 offset:57600
    v_mfma_f32_16x16x32_bf16 v[76:79], v[224:227], v[92:95], v[76:79]
    ds_read_b64_tr_b16 v[242:243], v4 offset:58624
    s_waitcnt lgkmcnt(6)
    v_mfma_f32_16x16x32_bf16 v[80:83], v[228:231], v[88:91], v[80:83]
    ds_read_b64_tr_b16 v[244:245], v5 offset:57632
    v_mfma_f32_16x16x32_bf16 v[84:87], v[228:231], v[92:95], v[84:87]
    ds_read_b64_tr_b16 v[246:247], v5 offset:58656
    s_waitcnt vmcnt(2) lgkmcnt(6)
    v_mfma_f32_16x16x32_bf16 v[24:27], v[232:235], v[96:99], v[24:27]
    ds_read_b64_tr_b16 v[224:225], v4 offset:57856
    s_waitcnt vmcnt(0)
    v_mfma_f32_16x16x32_bf16 v[28:31], v[232:235], v[100:103], v[28:31]
    ds_read_b64_tr_b16 v[226:227], v4 offset:58880
    s_waitcnt lgkmcnt(6)
    v_mfma_f32_16x16x32_bf16 v[32:35], v[236:239], v[96:99], v[32:35]
    ds_read_b64_tr_b16 v[228:229], v5 offset:57888
    v_mfma_f32_16x16x32_bf16 v[36:39], v[236:239], v[100:103], v[36:39]
    ds_read_b64_tr_b16 v[230:231], v5 offset:58912
    s_waitcnt lgkmcnt(6)
    v_mfma_f32_16x16x32_bf16 v[40:43], v[240:243], v[96:99], v[40:43]
    ds_read_b64_tr_b16 v[232:233], v4 offset:58112
    v_mfma_f32_16x16x32_bf16 v[44:47], v[240:243], v[100:103], v[44:47]
    ds_read_b64_tr_b16 v[234:235], v4 offset:59136
    s_waitcnt lgkmcnt(6)
    v_mfma_f32_16x16x32_bf16 v[48:51], v[244:247], v[96:99], v[48:51]
    ds_read_b64_tr_b16 v[236:237], v5 offset:58144
    v_mfma_f32_16x16x32_bf16 v[52:55], v[244:247], v[100:103], v[52:55]
    ds_read_b64_tr_b16 v[238:239], v5 offset:59168
    s_waitcnt lgkmcnt(6)
    v_mfma_f32_16x16x32_bf16 v[56:59], v[224:227], v[96:99], v[56:59]
    v_mfma_f32_16x16x32_bf16 v[60:63], v[224:227], v[100:103], v[60:63]
    s_waitcnt lgkmcnt(4)
    v_mfma_f32_16x16x32_bf16 v[64:67], v[228:231], v[96:99], v[64:67]
    v_mfma_f32_16x16x32_bf16 v[68:71], v[228:231], v[100:103], v[68:71]
    s_waitcnt lgkmcnt(2)
    v_mfma_f32_16x16x32_bf16 v[72:75], v[232:235], v[96:99], v[72:75]
    v_mfma_f32_16x16x32_bf16 v[76:79], v[232:235], v[100:103], v[76:79]
    s_waitcnt lgkmcnt(0)
    v_mfma_f32_16x16x32_bf16 v[80:83], v[236:239], v[96:99], v[80:83]
    v_mfma_f32_16x16x32_bf16 v[84:87], v[236:239], v[100:103], v[84:87]
    s_barrier
    s_add_u32 s22, s21, 0x8000
    s_add_u32 m0, s20, 0x20000
    s_nop 0
    buffer_load_dwordx4 v2, s[8:11], s22 offen sc1 lds
    s_add_u32 s22, s21, 0x8400
    s_add_u32 m0, s20, 0x20400
    s_nop 0
    buffer_load_dwordx4 v2, s[8:11], s22 offen sc1 lds
    s_add_u32 s22, s21, 0xc000
    s_add_u32 m0, s20, 0x24000
    s_nop 0
    buffer_load_dwordx4 v2, s[8:11], s22 offen sc1 lds
    s_add_u32 s22, s21, 0xc400
    s_add_u32 m0, s20, 0x24400
    s_nop 0
    buffer_load_dwordx4 v2, s[8:11], s22 offen sc1 lds
    ds_read_b64_tr_b16 v[88:89], v11 offset:0
    ds_read_b64_tr_b16 v[90:91], v11 offset:1024
    ds_read_b64_tr_b16 v[92:93], v11 offset:8192
    ds_read_b64_tr_b16 v[94:95], v11 offset:9216
    ds_read_b64_tr_b16 v[96:97], v11 offset:16384
    ds_read_b64_tr_b16 v[98:99], v11 offset:17408
    ds_read_b64_tr_b16 v[100:101], v11 offset:24576
    ds_read_b64_tr_b16 v[102:103], v11 offset:25600
    s_mov_b32 s23, 0x3e0293ee
    v_mul_f32 v24, s23, v24
    v_mul_f32 v25, s23, v25
    v_mul_f32 v26, s23, v26
    v_mul_f32 v27, s23, v27
    v_mul_f32 v28, s23, v28
    v_mul_f32 v29, s23, v29
    v_mul_f32 v30, s23, v30
    v_mul_f32 v31, s23, v31
    v_mul_f32 v32, s23, v32
    v_mul_f32 v33, s23, v33
    v_mul_f32 v34, s23, v34
    v_mul_f32 v35, s23, v35
    v_mul_f32 v36, s23, v36
    v_mul_f32 v37, s23, v37
    v_mul_f32 v38, s23, v38
    v_mul_f32 v39, s23, v39
    v_cvt_pk_bf16_f32 v152, v24, v25
    v_cvt_pk_bf16_f32 v153, v26, v27
    v_cvt_pk_bf16_f32 v168, v28, v29
    v_cvt_pk_bf16_f32 v169, v30, v31
    v_cvt_pk_bf16_f32 v154, v32, v33
    v_cvt_pk_bf16_f32 v155, v34, v35
    v_cvt_pk_bf16_f32 v170, v36, v37
    v_cvt_pk_bf16_f32 v171, v38, v39
    s_waitcnt lgkmcnt(6)
    v_mfma_f32_16x16x32_bf16 v[104:107], v[88:91], v[136:139], 0
    s_waitcnt lgkmcnt(4)
    v_mfma_f32_16x16x32_bf16 v[104:107], v[92:95], v[140:143], v[104:107]
    s_waitcnt lgkmcnt(2)
    v_mfma_f32_16x16x32_bf16 v[104:107], v[96:99], v[144:147], v[104:107]
    s_waitcnt lgkmcnt(0)
    v_mfma_f32_16x16x32_bf16 v[104:107], v[100:103], v[148:151], v[104:107]
    v_add_u32 v4, 0x10000, v2
    v_add_u32 v5, 0x20000, v2
    s_barrier
    ds_read_b128 v[224:227], v4 offset:32768
    ds_read_b128 v[228:231], v4 offset:33792
    ds_read_b128 v[232:235], v4 offset:34816
    ds_read_b128 v[236:239], v4 offset:35840
    v_mov_b32 v12, 0x3f803f80
    v_mov_b32 v13, 0x3f803f80
    v_mov_b32 v14, 0x3f803f80
    v_mov_b32 v15, 0x3f803f80
    s_waitcnt lgkmcnt(3)
    v_mfma_f32_16x16x32_bf16 v[184:187], v[224:227], v[152:155], 0
    v_mul_f32 v40, s23, v40
    v_mul_f32 v41, s23, v41
    v_mul_f32 v42, s23, v42
    v_mul_f32 v43, s23, v43
    v_mul_f32 v44, s23, v44
    v_mul_f32 v45, s23, v45
    v_lshrrev_b32 v20, 4, v1
    v_lshlrev_b32 v20, 4, v20
    s_lshr_b32 s16, s2, 5
    s_lshl_b32 s16, s16, 14
    s_and_b32 s17, s2, 31
    s_lshl_b32 s17, s17, 9
    s_add_u32 s16, s16, s17
    s_lshl_b32 s17, s3, 6
    s_add_u32 s16, s16, s17
    s_add_u32 s16, s16, 0x580000
    s_mov_b32 exec_lo, 0x10001
    s_mov_b32 exec_hi, 0x10001
    buffer_store_dwordx4 v[104:107], v20, s[8:11], s16 offen sc1
    s_mov_b64 exec, -1
    v_mfma_f32_16x16x32_bf16 v[188:191], v[224:227], v[168:171], 0
    ds_read_b128 v[240:243], v4 offset:36864
    v_mul_f32 v46, s23, v46
    v_mul_f32 v47, s23, v47
    v_mul_f32 v48, s23, v48
    v_mul_f32 v49, s23, v49
    v_mul_f32 v50, s23, v50
    v_mul_f32 v51, s23, v51
    s_and_b32 s29, s2, 7
    s_mul_i32 s29, s29, 28
    s_lshr_b32 s16, s2, 3
    s_add_u32 s29, s29, s16
    s_waitcnt lgkmcnt(3)
    v_mfma_f32_16x16x32_bf16 v[192:195], v[228:231], v[152:155], 0
    s_add_u32 s22, s21, 0x10000
    s_add_u32 m0, s20, 0x10000
    s_nop 0
    buffer_load_dwordx4 v2, s[8:11], s22 offen sc1 lds
    v_mul_f32 v52, s23, v52
    v_mul_f32 v53, s23, v53
    v_mul_f32 v54, s23, v54
    v_mul_f32 v55, s23, v55
    v_cvt_pk_bf16_f32 v156, v40, v41
    v_cvt_pk_bf16_f32 v157, v42, v43
    v_mfma_f32_16x16x32_bf16 v[196:199], v[228:231], v[168:171], 0
    ds_read_b128 v[244:247], v4 offset:37888
    v_cvt_pk_bf16_f32 v172, v44, v45
    v_cvt_pk_bf16_f32 v173, v46, v47
    v_cvt_pk_bf16_f32 v158, v48, v49
    v_cvt_pk_bf16_f32 v159, v50, v51
    v_cvt_pk_bf16_f32 v174, v52, v53
    v_cvt_pk_bf16_f32 v175, v54, v55
    s_waitcnt lgkmcnt(3)
    v_mfma_f32_16x16x32_bf16 v[184:187], v[232:235], v[156:159], v[184:187]
    v_mul_f32 v56, s23, v56
    v_mul_f32 v57, s23, v57
    v_mul_f32 v58, s23, v58
    v_mul_f32 v59, s23, v59
    v_mul_f32 v60, s23, v60
    v_mul_f32 v61, s23, v61
    v_mfma_f32_16x16x32_bf16 v[188:191], v[232:235], v[172:175], v[188:191]
    ds_read_b128 v[224:227], v4 offset:38912
    v_mul_f32 v62, s23, v62
    v_mul_f32 v63, s23, v63
    v_mul_f32 v64, s23, v64
    v_mul_f32 v65, s23, v65
    v_mul_f32 v66, s23, v66
    v_mul_f32 v67, s23, v67
    s_waitcnt lgkmcnt(3)
    v_mfma_f32_16x16x32_bf16 v[192:195], v[236:239], v[156:159], v[192:195]
    v_mul_f32 v68, s23, v68
    v_mul_f32 v69, s23, v69
    v_mul_f32 v70, s23, v70
    v_mul_f32 v71, s23, v71
    v_cvt_pk_bf16_f32 v160, v56, v57
    v_cvt_pk_bf16_f32 v161, v58, v59
    v_mfma_f32_16x16x32_bf16 v[196:199], v[236:239], v[172:175], v[196:199]
    ds_read_b128 v[228:231], v4 offset:39936
    v_cvt_pk_bf16_f32 v176, v60, v61
    v_cvt_pk_bf16_f32 v177, v62, v63
    v_cvt_pk_bf16_f32 v162, v64, v65
    v_cvt_pk_bf16_f32 v163, v66, v67
    v_cvt_pk_bf16_f32 v178, v68, v69
    v_cvt_pk_bf16_f32 v179, v70, v71
    s_waitcnt lgkmcnt(3)
    v_mfma_f32_16x16x32_bf16 v[184:187], v[240:243], v[160:163], v[184:187]
    v_mul_f32 v72, s23, v72
    v_mul_f32 v73, s23, v73
    v_mul_f32 v74, s23, v74
    v_mul_f32 v75, s23, v75
    v_mul_f32 v76, s23, v76
    v_mul_f32 v77, s23, v77
    v_mfma_f32_16x16x32_bf16 v[188:191], v[240:243], v[176:179], v[188:191]
    ds_read_b128 v[232:235], v4 offset:40960
    v_mul_f32 v78, s23, v78
    v_mul_f32 v79, s23, v79
    v_mul_f32 v80, s23, v80
    v_mul_f32 v81, s23, v81
    v_mul_f32 v82, s23, v82
    v_mul_f32 v83, s23, v83
    s_waitcnt lgkmcnt(3)
    v_mfma_f32_16x16x32_bf16 v[192:195], v[244:247], v[160:163], v[192:195]
    s_add_u32 s22, s21, 0x10400
    s_add_u32 m0, s20, 0x10400
    s_nop 0
    buffer_load_dwordx4 v2, s[8:11], s22 offen sc1 lds
    v_mul_f32 v84, s23, v84
    v_mul_f32 v85, s23, v85
    v_mul_f32 v86, s23, v86
    v_mul_f32 v87, s23, v87
    v_cvt_pk_bf16_f32 v164, v72, v73
    v_cvt_pk_bf16_f32 v165, v74, v75
    v_mfma_f32_16x16x32_bf16 v[196:199], v[244:247], v[176:179], v[196:199]
    ds_read_b128 v[236:239], v4 offset:41984
    v_cvt_pk_bf16_f32 v180, v76, v77
    v_cvt_pk_bf16_f32 v181, v78, v79
    v_cvt_pk_bf16_f32 v166, v80, v81
    v_cvt_pk_bf16_f32 v167, v82, v83
    v_cvt_pk_bf16_f32 v182, v84, v85
    v_cvt_pk_bf16_f32 v183, v86, v87
    s_waitcnt lgkmcnt(3)
    v_mfma_f32_16x16x32_bf16 v[184:187], v[224:227], v[164:167], v[184:187]
    v_mfma_f32_16x16x32_bf16 v[188:191], v[224:227], v[180:183], v[188:191]
    ds_read_b128 v[240:243], v4 offset:43008
    s_waitcnt lgkmcnt(3)
    v_mfma_f32_16x16x32_bf16 v[192:195], v[228:231], v[164:167], v[192:195]
    v_mfma_f32_16x16x32_bf16 v[196:199], v[228:231], v[180:183], v[196:199]
    ds_read_b128 v[244:247], v4 offset:44032
    s_waitcnt lgkmcnt(3)
    v_mfma_f32_16x16x32_bf16 v[200:203], v[232:235], v[152:155], 0
    v_mfma_f32_16x16x32_bf16 v[204:207], v[232:235], v[168:171], 0
    ds_read_b128 v[224:227], v4 offset:45056
    s_waitcnt lgkmcnt(3)
    v_mfma_f32_16x16x32_bf16 v[208:211], v[236:239], v[152:155], 0
    v_mfma_f32_16x16x32_bf16 v[212:215], v[236:239], v[168:171], 0
    ds_read_b128 v[228:231], v4 offset:46080
    s_waitcnt lgkmcnt(3)
    v_mfma_f32_16x16x32_bf16 v[200:203], v[240:243], v[156:159], v[200:203]
    v_mfma_f32_16x16x32_bf16 v[204:207], v[240:243], v[172:175], v[204:207]
    ds_read_b128 v[232:235], v4 offset:47104
    s_waitcnt lgkmcnt(3)
    v_mfma_f32_16x16x32_bf16 v[208:211], v[244:247], v[156:159], v[208:211]
    v_max3_f32 v16, v184, v185, v186
    v_mfma_f32_16x16x32_bf16 v[212:215], v[244:247], v[172:175], v[212:215]
    ds_read_b128 v[236:239], v4 offset:48128
    v_max3_f32 v16, v16, v187, v192
    s_waitcnt lgkmcnt(3)
    v_mfma_f32_16x16x32_bf16 v[200:203], v[224:227], v[160:163], v[200:203]
    v_max3_f32 v16, v16, v193, v194
    v_mfma_f32_16x16x32_bf16 v[204:207], v[224:227], v[176:179], v[204:207]
    s_barrier
    ds_read_b128 v[240:243], v4 offset:49152
    v_max_f32 v16, v16, v195
    s_waitcnt lgkmcnt(3)
    v_mfma_f32_16x16x32_bf16 v[208:211], v[228:231], v[160:163], v[208:211]
    v_max3_f32 v17, v188, v189, v190
    v_mfma_f32_16x16x32_bf16 v[212:215], v[228:231], v[176:179], v[212:215]
    s_add_u32 s22, s21, 0x14000
    s_add_u32 m0, s20, 0x14000
    s_nop 0
    buffer_load_dwordx4 v2, s[8:11], s22 offen sc1 lds
    ds_read_b128 v[244:247], v4 offset:50176
    v_max3_f32 v17, v17, v191, v196
    s_waitcnt lgkmcnt(3)
    v_mfma_f32_16x16x32_bf16 v[200:203], v[232:235], v[164:167], v[200:203]
    v_max3_f32 v17, v17, v197, v198
    v_mfma_f32_16x16x32_bf16 v[204:207], v[232:235], v[180:183], v[204:207]
    ds_read_b128 v[224:227], v4 offset:51200
    v_max_f32 v17, v17, v199
    s_waitcnt lgkmcnt(3)
    v_mfma_f32_16x16x32_bf16 v[208:211], v[236:239], v[164:167], v[208:211]
    v_mfma_f32_16x16x32_bf16 v[212:215], v[236:239], v[180:183], v[212:215]
    ds_read_b128 v[228:231], v4 offset:52224
    v_max3_f32 v16, v16, v200, v201
    v_max3_f32 v16, v16, v202, v203
    s_nop 3
    v_max3_f32 v16, v16, v208, v209
    v_max3_f32 v16, v16, v210, v211
    v_max3_f32 v17, v17, v204, v205
    v_max3_f32 v17, v17, v206, v207
    v_max3_f32 v17, v17, v212, v213
    v_max3_f32 v17, v17, v214, v215
    v_mov_b32 v18, v16
    v_mov_b32 v19, v17
    s_nop 0
    v_permlane16_swap_b32 v16, v18
    v_permlane16_swap_b32 v17, v19
    v_max_f32 v16, v16, v18
    v_max_f32 v17, v17, v19
    v_mov_b32 v18, v16
    v_mov_b32 v19, v17
    s_nop 0
    v_permlane32_swap_b32 v16, v18
    v_permlane32_swap_b32 v17, v19
    v_max_f32 v16, v16, v18
    v_max_f32 v17, v17, v19
    v_sub_f32 v216, 0, v16
    v_sub_f32 v217, 0, v16
    v_sub_f32 v218, 0, v16
    v_sub_f32 v219, 0, v16
    v_sub_f32 v220, 0, v17
    v_sub_f32 v221, 0, v17
    v_sub_f32 v222, 0, v17
    v_sub_f32 v223, 0, v17
    v_add_f32 v184, v184, v216
    v_add_f32 v185, v185, v216
    v_exp_f32 v184, v184
    v_exp_f32 v185, v185
    s_nop 0
    v_cvt_pk_bf16_f32 v24, v184, v185
    v_add_f32 v186, v186, v216
    v_add_f32 v187, v187, v216
    v_exp_f32 v186, v186
    v_exp_f32 v187, v187
    s_nop 0
    v_cvt_pk_bf16_f32 v25, v186, v187
    v_add_f32 v188, v188, v220
    v_add_f32 v189, v189, v220
    v_exp_f32 v188, v188
    v_exp_f32 v189, v189
    s_nop 0
    v_cvt_pk_bf16_f32 v28, v188, v189
    v_add_f32 v190, v190, v220
    v_add_f32 v191, v191, v220
    v_exp_f32 v190, v190
    v_exp_f32 v191, v191
    s_nop 0
    v_cvt_pk_bf16_f32 v29, v190, v191
    v_add_f32 v192, v192, v216
    v_add_f32 v193, v193, v216
    v_exp_f32 v192, v192
    v_exp_f32 v193, v193
    s_nop 0
    v_cvt_pk_bf16_f32 v26, v192, v193
    v_add_f32 v194, v194, v216
    v_add_f32 v195, v195, v216
    v_exp_f32 v194, v194
    v_exp_f32 v195, v195
    s_nop 0
    v_cvt_pk_bf16_f32 v27, v194, v195
    v_add_f32 v196, v196, v220
    v_add_f32 v197, v197, v220
    v_exp_f32 v196, v196
    v_exp_f32 v197, v197
    s_nop 0
    v_cvt_pk_bf16_f32 v30, v196, v197
    v_add_f32 v198, v198, v220
    v_add_f32 v199, v199, v220
    v_exp_f32 v198, v198
    v_exp_f32 v199, v199
    s_nop 0
    v_cvt_pk_bf16_f32 v31, v198, v199
    s_waitcnt lgkmcnt(3)
    v_mfma_f32_16x16x32_bf16 v[184:187], v[240:243], v[152:155], v[216:219]
    v_mfma_f32_16x16x32_bf16 v[188:191], v[240:243], v[168:171], v[220:223]
    ds_read_b128 v[232:235], v4 offset:53248
    v_add_f32 v200, v200, v216
    v_add_f32 v201, v201, v216
    v_exp_f32 v200, v200
    v_mfma_f32_16x16x32_bf16 v[248:251], v[12:15], v[24:27], 0
    s_waitcnt lgkmcnt(3)
    v_mfma_f32_16x16x32_bf16 v[192:195], v[244:247], v[152:155], v[216:219]
    v_exp_f32 v201, v201
    s_nop 0
    v_cvt_pk_bf16_f32 v32, v200, v201
    v_add_f32 v202, v202, v216
    v_mfma_f32_16x16x32_bf16 v[196:199], v[244:247], v[168:171], v[220:223]
    s_add_u32 s22, s21, 0x14400
    s_add_u32 m0, s20, 0x14400
    s_nop 0
    buffer_load_dwordx4 v2, s[8:11], s22 offen sc1 lds
    ds_read_b128 v[236:239], v4 offset:54272
    v_add_f32 v203, v203, v216
    v_exp_f32 v202, v202
    v_mfma_f32_16x16x32_bf16 v[252:255], v[12:15], v[28:31], 0
    s_waitcnt lgkmcnt(3)
    v_mfma_f32_16x16x32_bf16 v[184:187], v[224:227], v[156:159], v[184:187]
    v_exp_f32 v203, v203
    s_nop 0
    v_cvt_pk_bf16_f32 v33, v202, v203
    v_add_f32 v204, v204, v220
    v_mfma_f32_16x16x32_bf16 v[188:191], v[224:227], v[172:175], v[188:191]
    ds_read_b128 v[240:243], v4 offset:55296
    v_add_f32 v205, v205, v220
    v_exp_f32 v204, v204
    v_exp_f32 v205, v205
    s_mov_b64 s[4:5], s[40:41]
    s_mov_b32 s6, 0x800000
    s_mov_b32 s7, 0x20000
    v_bfe_u32 v20, v1, 2, 2
    v_lshlrev_b32 v21, 13, v20
    v_sub_u32 v3, v3, v21
    v_lshl_add_u32 v3, v20, 11, v3
    s_and_b32 s16, s2, 1
    s_lshl_b32 s24, s16, 22
    s_lshr_b32 s16, s2, 5
    s_lshl_b32 s16, s16, 8
    s_add_u32 s24, s24, s16
    s_lshl_b32 s16, s3, 14
    s_add_u32 s24, s24, s16
    s_waitcnt lgkmcnt(3)
    v_mfma_f32_16x16x32_bf16 v[192:195], v[228:231], v[156:159], v[192:195]
    v_cvt_pk_bf16_f32 v36, v204, v205
    v_add_f32 v206, v206, v220
    v_mfma_f32_16x16x32_bf16 v[196:199], v[228:231], v[172:175], v[196:199]
    ds_read_b128 v[244:247], v4 offset:56320
    v_add_f32 v207, v207, v220
    v_exp_f32 v206, v206
    v_exp_f32 v207, v207
    s_waitcnt lgkmcnt(3)
    v_mfma_f32_16x16x32_bf16 v[184:187], v[232:235], v[160:163], v[184:187]
    v_cvt_pk_bf16_f32 v37, v206, v207
    v_add_f32 v208, v208, v216
    v_add_f32 v209, v209, v216
    v_mfma_f32_16x16x32_bf16 v[188:191], v[232:235], v[176:179], v[188:191]
    ds_read_b128 v[224:227], v4 offset:57344
    v_exp_f32 v208, v208
    v_exp_f32 v209, v209
    s_waitcnt lgkmcnt(3)
    v_mfma_f32_16x16x32_bf16 v[192:195], v[236:239], v[160:163], v[192:195]
    v_cvt_pk_bf16_f32 v34, v208, v209
    v_add_f32 v210, v210, v216
    v_add_f32 v211, v211, v216
    v_mfma_f32_16x16x32_bf16 v[196:199], v[236:239], v[176:179], v[196:199]
    ds_read_b128 v[228:231], v4 offset:58368
    v_exp_f32 v210, v210
    v_exp_f32 v211, v211
    s_nop 0
    v_cvt_pk_bf16_f32 v35, v210, v211
    s_waitcnt lgkmcnt(3)
    v_mfma_f32_16x16x32_bf16 v[184:187], v[240:243], v[164:167], v[184:187]
    v_add_f32 v212, v212, v220
    v_add_f32 v213, v213, v220
    v_mfma_f32_16x16x32_bf16 v[188:191], v[240:243], v[180:183], v[188:191]
    ds_read_b128 v[232:235], v4 offset:59392
    v_exp_f32 v212, v212
    v_exp_f32 v213, v213
    s_nop 0
    v_cvt_pk_bf16_f32 v38, v212, v213
    s_waitcnt lgkmcnt(3)
    v_mfma_f32_16x16x32_bf16 v[192:195], v[244:247], v[164:167], v[192:195]
    v_add_f32 v214, v214, v220
    v_add_f32 v215, v215, v220
    v_exp_f32 v214, v214
    v_mfma_f32_16x16x32_bf16 v[196:199], v[244:247], v[180:183], v[196:199]
    ds_read_b128 v[236:239], v4 offset:60416
    v_exp_f32 v215, v215
    s_nop 0
    v_cvt_pk_bf16_f32 v39, v214, v215
    s_waitcnt lgkmcnt(3)
    v_mfma_f32_16x16x32_bf16 v[200:203], v[224:227], v[152:155], v[216:219]
    v_mfma_f32_16x16x32_bf16 v[204:207], v[224:227], v[168:171], v[220:223]
    ds_read_b128 v[240:243], v4 offset:61440
    v_exp_f32 v184, v184
    v_exp_f32 v185, v185
    v_mfma_f32_16x16x32_bf16 v[248:251], v[12:15], v[32:35], v[248:251]
    s_waitcnt lgkmcnt(3)
    v_mfma_f32_16x16x32_bf16 v[208:211], v[228:231], v[152:155], v[216:219]
    v_cvt_pk_bf16_f32 v40, v184, v185
    v_exp_f32 v186, v186
    v_mfma_f32_16x16x32_bf16 v[212:215], v[228:231], v[168:171], v[220:223]
    ds_read_b128 v[244:247], v4 offset:62464
    v_exp_f32 v187, v187
    v_mfma_f32_16x16x32_bf16 v[252:255], v[12:15], v[36:39], v[252:255]
    s_waitcnt lgkmcnt(3)
    v_mfma_f32_16x16x32_bf16 v[200:203], v[232:235], v[156:159], v[200:203]
    v_cvt_pk_bf16_f32 v41, v186, v187
    v_exp_f32 v188, v188
    v_mfma_f32_16x16x32_bf16 v[204:207], v[232:235], v[172:175], v[204:207]
    ds_read_b128 v[224:227], v4 offset:63488
    v_exp_f32 v189, v189
    s_waitcnt lgkmcnt(3)
    v_mfma_f32_16x16x32_bf16 v[208:211], v[236:239], v[156:159], v[208:211]
    v_cvt_pk_bf16_f32 v44, v188, v189
    v_exp_f32 v190, v190
    v_mfma_f32_16x16x32_bf16 v[212:215], v[236:239], v[172:175], v[212:215]
    ds_read_b128 v[228:231], v4 offset:64512
    v_exp_f32 v191, v191
    s_nop 0
    v_cvt_pk_bf16_f32 v45, v190, v191
    s_waitcnt lgkmcnt(3)
    v_mfma_f32_16x16x32_bf16 v[200:203], v[240:243], v[160:163], v[200:203]
    v_exp_f32 v192, v192
    v_mfma_f32_16x16x32_bf16 v[204:207], v[240:243], v[176:179], v[204:207]
    s_waitcnt vmcnt(7)
    s_barrier
    ds_read_b128 v[232:235], v5 offset:0
    v_exp_f32 v193, v193
    s_nop 0
    v_cvt_pk_bf16_f32 v42, v192, v193
    s_waitcnt lgkmcnt(3)
    v_mfma_f32_16x16x32_bf16 v[208:211], v[244:247], v[160:163], v[208:211]
    v_exp_f32 v194, v194
    v_mfma_f32_16x16x32_bf16 v[212:215], v[244:247], v[176:179], v[212:215]
    s_add_u32 s22, s21, 0x18000
    s_add_u32 m0, s20, 0x18000
    s_nop 0
    buffer_load_dwordx4 v2, s[8:11], s22 offen sc1 lds
    ds_read_b128 v[236:239], v5 offset:1024
    v_exp_f32 v195, v195
    s_nop 0
    v_cvt_pk_bf16_f32 v43, v194, v195
    s_waitcnt lgkmcnt(3)
    v_mfma_f32_16x16x32_bf16 v[200:203], v[224:227], v[164:167], v[200:203]
    v_exp_f32 v196, v196
    v_exp_f32 v197, v197
    v_mfma_f32_16x16x32_bf16 v[204:207], v[224:227], v[180:183], v[204:207]
    ds_read_b128 v[240:243], v5 offset:2048
    v_cvt_pk_bf16_f32 v46, v196, v197
    s_waitcnt lgkmcnt(3)
    v_mfma_f32_16x16x32_bf16 v[208:211], v[228:231], v[164:167], v[208:211]
    v_exp_f32 v198, v198
    v_exp_f32 v199, v199
    v_mfma_f32_16x16x32_bf16 v[212:215], v[228:231], v[180:183], v[212:215]
    ds_read_b128 v[244:247], v5 offset:3072
    v_cvt_pk_bf16_f32 v47, v198, v199
    s_waitcnt lgkmcnt(3)
    v_mfma_f32_16x16x32_bf16 v[184:187], v[232:235], v[152:155], v[216:219]
    v_mfma_f32_16x16x32_bf16 v[188:191], v[232:235], v[168:171], v[220:223]
    ds_read_b128 v[224:227], v5 offset:4096
    v_exp_f32 v200, v200
    v_exp_f32 v201, v201
    v_mfma_f32_16x16x32_bf16 v[248:251], v[12:15], v[40:43], v[248:251]
    s_waitcnt lgkmcnt(3)
    v_mfma_f32_16x16x32_bf16 v[192:195], v[236:239], v[152:155], v[216:219]
    v_cvt_pk_bf16_f32 v48, v200, v201
    v_exp_f32 v202, v202
    v_mfma_f32_16x16x32_bf16 v[196:199], v[236:239], v[168:171], v[220:223]
    s_add_u32 s22, s21, 0x18400
    s_add_u32 m0, s20, 0x18400
    s_nop 0
    buffer_load_dwordx4 v2, s[8:11], s22 offen sc1 lds
    ds_read_b128 v[228:231], v5 offset:5120
    v_exp_f32 v203, v203
    v_mfma_f32_16x16x32_bf16 v[252:255], v[12:15], v[44:47], v[252:255]
    s_waitcnt lgkmcnt(3)
    v_mfma_f32_16x16x32_bf16 v[184:187], v[240:243], v[156:159], v[184:187]
    v_cvt_pk_bf16_f32 v49, v202, v203
    v_exp_f32 v204, v204
    v_mfma_f32_16x16x32_bf16 v[188:191], v[240:243], v[172:175], v[188:191]
    ds_read_b128 v[232:235], v5 offset:6144
    v_exp_f32 v205, v205
    s_waitcnt lgkmcnt(3)
    v_mfma_f32_16x16x32_bf16 v[192:195], v[244:247], v[156:159], v[192:195]
    v_cvt_pk_bf16_f32 v52, v204, v205
    v_exp_f32 v206, v206
    v_mfma_f32_16x16x32_bf16 v[196:199], v[244:247], v[172:175], v[196:199]
    ds_read_b128 v[236:239], v5 offset:7168
    v_exp_f32 v207, v207
    s_nop 0
    v_cvt_pk_bf16_f32 v53, v206, v207
    s_waitcnt lgkmcnt(3)
    v_mfma_f32_16x16x32_bf16 v[184:187], v[224:227], v[160:163], v[184:187]
    v_exp_f32 v208, v208
    v_mfma_f32_16x16x32_bf16 v[188:191], v[224:227], v[176:179], v[188:191]
    ds_read_b128 v[240:243], v5 offset:8192
    v_exp_f32 v209, v209
    s_nop 0
    v_cvt_pk_bf16_f32 v50, v208, v209
    s_waitcnt lgkmcnt(3)
    v_mfma_f32_16x16x32_bf16 v[192:195], v[228:231], v[160:163], v[192:195]
    v_exp_f32 v210, v210
    v_mfma_f32_16x16x32_bf16 v[196:199], v[228:231], v[176:179], v[196:199]
    ds_read_b128 v[244:247], v5 offset:9216
    v_exp_f32 v211, v211
    s_nop 0
    v_cvt_pk_bf16_f32 v51, v210, v211
    s_waitcnt lgkmcnt(3)
    v_mfma_f32_16x16x32_bf16 v[184:187], v[232:235], v[164:167], v[184:187]
    v_exp_f32 v212, v212
    v_exp_f32 v213, v213
    v_mfma_f32_16x16x32_bf16 v[188:191], v[232:235], v[180:183], v[188:191]
    ds_read_b128 v[224:227], v5 offset:10240
    v_cvt_pk_bf16_f32 v54, v212, v213
    s_waitcnt lgkmcnt(3)
    v_mfma_f32_16x16x32_bf16 v[192:195], v[236:239], v[164:167], v[192:195]
    v_exp_f32 v214, v214
    v_exp_f32 v215, v215
    v_mfma_f32_16x16x32_bf16 v[196:199], v[236:239], v[180:183], v[196:199]
    ds_read_b128 v[228:231], v5 offset:11264
    v_cvt_pk_bf16_f32 v55, v214, v215
    s_waitcnt lgkmcnt(3)
    v_mfma_f32_16x16x32_bf16 v[200:203], v[240:243], v[152:155], v[216:219]
    v_mfma_f32_16x16x32_bf16 v[204:207], v[240:243], v[168:171], v[220:223]
    ds_read_b128 v[232:235], v5 offset:12288
    v_exp_f32 v184, v184
    v_exp_f32 v185, v185
    v_mfma_f32_16x16x32_bf16 v[248:251], v[12:15], v[48:51], v[248:251]
    s_waitcnt lgkmcnt(3)
    v_mfma_f32_16x16x32_bf16 v[208:211], v[244:247], v[152:155], v[216:219]
    v_cvt_pk_bf16_f32 v56, v184, v185
    v_exp_f32 v186, v186
    v_mfma_f32_16x16x32_bf16 v[212:215], v[244:247], v[168:171], v[220:223]
    ds_read_b128 v[236:239], v5 offset:13312
    v_exp_f32 v187, v187
    v_mfma_f32_16x16x32_bf16 v[252:255], v[12:15], v[52:55], v[252:255]
    s_waitcnt lgkmcnt(3)
    v_mfma_f32_16x16x32_bf16 v[200:203], v[224:227], v[156:159], v[200:203]
    v_cvt_pk_bf16_f32 v57, v186, v187
    v_exp_f32 v188, v188
    v_mfma_f32_16x16x32_bf16 v[204:207], v[224:227], v[172:175], v[204:207]
    ds_read_b128 v[240:243], v5 offset:14336
    v_exp_f32 v189, v189
    s_waitcnt lgkmcnt(3)
    v_mfma_f32_16x16x32_bf16 v[208:211], v[228:231], v[156:159], v[208:211]
    v_cvt_pk_bf16_f32 v60, v188, v189
    v_exp_f32 v190, v190
    s_waitcnt vmcnt(6)
    v_mfma_f32_16x16x32_bf16 v[212:215], v[228:231], v[172:175], v[212:215]
    ds_read_b128 v[244:247], v5 offset:15360
    v_exp_f32 v191, v191
    s_nop 0
    v_cvt_pk_bf16_f32 v61, v190, v191
    s_waitcnt lgkmcnt(3)
    v_mfma_f32_16x16x32_bf16 v[200:203], v[232:235], v[160:163], v[200:203]
    v_exp_f32 v192, v192
    v_mfma_f32_16x16x32_bf16 v[204:207], v[232:235], v[176:179], v[204:207]
    s_barrier
    ds_read_b128 v[224:227], v5 offset:16384
    v_exp_f32 v193, v193
    s_nop 0
    v_cvt_pk_bf16_f32 v58, v192, v193
    s_waitcnt lgkmcnt(3)
    v_mfma_f32_16x16x32_bf16 v[208:211], v[236:239], v[160:163], v[208:211]
    v_exp_f32 v194, v194
    v_mfma_f32_16x16x32_bf16 v[212:215], v[236:239], v[176:179], v[212:215]
    s_add_u32 s22, s21, 0x1c000
    s_add_u32 m0, s20, 0x1c000
    s_nop 0
    buffer_load_dwordx4 v2, s[8:11], s22 offen sc1 lds
    ds_read_b128 v[228:231], v5 offset:17408
    v_exp_f32 v195, v195
    s_nop 0
    v_cvt_pk_bf16_f32 v59, v194, v195
    s_waitcnt lgkmcnt(3)
    v_mfma_f32_16x16x32_bf16 v[200:203], v[240:243], v[164:167], v[200:203]
    v_exp_f32 v196, v196
    v_exp_f32 v197, v197
    v_mfma_f32_16x16x32_bf16 v[204:207], v[240:243], v[180:183], v[204:207]
    ds_read_b128 v[232:235], v5 offset:18432
    v_cvt_pk_bf16_f32 v62, v196, v197
    s_waitcnt lgkmcnt(3)
    v_mfma_f32_16x16x32_bf16 v[208:211], v[244:247], v[164:167], v[208:211]
    v_exp_f32 v198, v198
    v_exp_f32 v199, v199
    v_mov_b32 v20, s28
    v_mov_b32 v21, 0
    s_lshl_b32 s16, s2, 2
    s_add_u32 s16, s16, 0x560000
    s_cmp_eq_u32 s3, 0
    s_cselect_b32 s16, s16, 0x7ffffff0
    s_mov_b64 exec, 1
    buffer_store_dword v20, v21, s[8:11], s16 offen sc1
    s_mov_b64 exec, -1
    v_mfma_f32_16x16x32_bf16 v[212:215], v[244:247], v[180:183], v[212:215]
    ds_read_b128 v[236:239], v5 offset:19456
    v_cvt_pk_bf16_f32 v63, v198, v199
    s_waitcnt lgkmcnt(3)
    v_mfma_f32_16x16x32_bf16 v[184:187], v[224:227], v[152:155], v[216:219]
    v_mfma_f32_16x16x32_bf16 v[188:191], v[224:227], v[168:171], v[220:223]
    ds_read_b128 v[240:243], v5 offset:20480
    v_exp_f32 v200, v200
    v_exp_f32 v201, v201
    v_mfma_f32_16x16x32_bf16 v[248:251], v[12:15], v[56:59], v[248:251]
    s_waitcnt lgkmcnt(3)
    v_mfma_f32_16x16x32_bf16 v[192:195], v[228:231], v[152:155], v[216:219]
    v_cvt_pk_bf16_f32 v64, v200, v201
    v_exp_f32 v202, v202
    v_mfma_f32_16x16x32_bf16 v[196:199], v[228:231], v[168:171], v[220:223]
    s_add_u32 s22, s21, 0x1c400
    s_add_u32 m0, s20, 0x1c400
    s_nop 0
    buffer_load_dwordx4 v2, s[8:11], s22 offen sc1 lds
    ds_read_b128 v[244:247], v5 offset:21504
    v_exp_f32 v203, v203
    v_mfma_f32_16x16x32_bf16 v[252:255], v[12:15], v[60:63], v[252:255]
    s_waitcnt lgkmcnt(3)
    v_mfma_f32_16x16x32_bf16 v[184:187], v[232:235], v[156:159], v[184:187]
    v_cvt_pk_bf16_f32 v65, v202, v203
    v_exp_f32 v204, v204
    v_mfma_f32_16x16x32_bf16 v[188:191], v[232:235], v[172:175], v[188:191]
    ds_read_b128 v[224:227], v5 offset:22528
    v_exp_f32 v205, v205
    s_waitcnt lgkmcnt(3)
    v_mfma_f32_16x16x32_bf16 v[192:195], v[236:239], v[156:159], v[192:195]
    v_cvt_pk_bf16_f32 v68, v204, v205
    v_exp_f32 v206, v206
    v_mfma_f32_16x16x32_bf16 v[196:199], v[236:239], v[172:175], v[196:199]
    ds_read_b128 v[228:231], v5 offset:23552
    v_exp_f32 v207, v207
    s_nop 0
    v_cvt_pk_bf16_f32 v69, v206, v207
    s_waitcnt lgkmcnt(3)
    v_mfma_f32_16x16x32_bf16 v[184:187], v[240:243], v[160:163], v[184:187]
    v_exp_f32 v208, v208
    v_mfma_f32_16x16x32_bf16 v[188:191], v[240:243], v[176:179], v[188:191]
    ds_read_b128 v[232:235], v5 offset:24576
    v_exp_f32 v209, v209
    s_nop 0
    v_cvt_pk_bf16_f32 v66, v208, v209
    s_waitcnt lgkmcnt(3)
    v_mfma_f32_16x16x32_bf16 v[192:195], v[244:247], v[160:163], v[192:195]
    v_exp_f32 v210, v210
    v_mfma_f32_16x16x32_bf16 v[196:199], v[244:247], v[176:179], v[196:199]
    ds_read_b128 v[236:239], v5 offset:25600
    v_exp_f32 v211, v211
    s_nop 0
    v_cvt_pk_bf16_f32 v67, v210, v211
    s_waitcnt lgkmcnt(3)
    v_mfma_f32_16x16x32_bf16 v[184:187], v[224:227], v[164:167], v[184:187]
    v_exp_f32 v212, v212
    v_exp_f32 v213, v213
    v_mfma_f32_16x16x32_bf16 v[188:191], v[224:227], v[180:183], v[188:191]
    ds_read_b128 v[240:243], v5 offset:26624
    v_cvt_pk_bf16_f32 v70, v212, v213
    s_waitcnt lgkmcnt(3)
    v_mfma_f32_16x16x32_bf16 v[192:195], v[228:231], v[164:167], v[192:195]
    v_exp_f32 v214, v214
    v_exp_f32 v215, v215
    v_mfma_f32_16x16x32_bf16 v[196:199], v[228:231], v[180:183], v[196:199]
    ds_read_b128 v[244:247], v5 offset:27648
    v_cvt_pk_bf16_f32 v71, v214, v215
    s_waitcnt lgkmcnt(3)
    v_mfma_f32_16x16x32_bf16 v[200:203], v[232:235], v[152:155], v[216:219]
    v_mfma_f32_16x16x32_bf16 v[204:207], v[232:235], v[168:171], v[220:223]
    ds_read_b128 v[224:227], v5 offset:28672
    v_exp_f32 v184, v184
    v_exp_f32 v185, v185
    v_mfma_f32_16x16x32_bf16 v[248:251], v[12:15], v[64:67], v[248:251]
    s_waitcnt lgkmcnt(3)
    v_mfma_f32_16x16x32_bf16 v[208:211], v[236:239], v[152:155], v[216:219]
    v_cvt_pk_bf16_f32 v72, v184, v185
    v_exp_f32 v186, v186
    v_mfma_f32_16x16x32_bf16 v[212:215], v[236:239], v[168:171], v[220:223]
    ds_read_b128 v[228:231], v5 offset:29696
    v_exp_f32 v187, v187
    v_mfma_f32_16x16x32_bf16 v[252:255], v[12:15], v[68:71], v[252:255]
    s_waitcnt lgkmcnt(3)
    v_mfma_f32_16x16x32_bf16 v[200:203], v[240:243], v[156:159], v[200:203]
    v_cvt_pk_bf16_f32 v73, v186, v187
    v_exp_f32 v188, v188
    v_mfma_f32_16x16x32_bf16 v[204:207], v[240:243], v[172:175], v[204:207]
    ds_read_b128 v[232:235], v5 offset:30720
    v_exp_f32 v189, v189
    s_waitcnt lgkmcnt(3)
    v_mfma_f32_16x16x32_bf16 v[208:211], v[244:247], v[156:159], v[208:211]
    v_cvt_pk_bf16_f32 v76, v188, v189
    v_exp_f32 v190, v190
    v_mfma_f32_16x16x32_bf16 v[212:215], v[244:247], v[172:175], v[212:215]
    ds_read_b128 v[236:239], v5 offset:31744
    v_exp_f32 v191, v191
    s_nop 0
    v_cvt_pk_bf16_f32 v77, v190, v191
    s_waitcnt lgkmcnt(3)
    v_mfma_f32_16x16x32_bf16 v[200:203], v[224:227], v[160:163], v[200:203]
    v_exp_f32 v192, v192
    v_mfma_f32_16x16x32_bf16 v[204:207], v[224:227], v[176:179], v[204:207]
    s_waitcnt vmcnt(7)
    s_barrier
    ds_read_b128 v[240:243], v4 offset:0
    v_exp_f32 v193, v193
    s_nop 0
    v_cvt_pk_bf16_f32 v74, v192, v193
    s_waitcnt lgkmcnt(3)
    v_mfma_f32_16x16x32_bf16 v[208:211], v[228:231], v[160:163], v[208:211]
    v_exp_f32 v194, v194
    v_mfma_f32_16x16x32_bf16 v[212:215], v[228:231], v[176:179], v[212:215]
    s_add_u32 s22, s21, 0x80000
    s_add_u32 m0, s20, 0x20000
    s_nop 0
    buffer_load_dwordx4 v2, s[8:11], s22 offen sc1 lds
    ds_read_b128 v[244:247], v4 offset:1024
    v_exp_f32 v195, v195
    s_nop 0
    v_cvt_pk_bf16_f32 v75, v194, v195
    s_waitcnt lgkmcnt(3)
    v_mfma_f32_16x16x32_bf16 v[200:203], v[232:235], v[164:167], v[200:203]
    v_exp_f32 v196, v196
    v_exp_f32 v197, v197
    v_mfma_f32_16x16x32_bf16 v[204:207], v[232:235], v[180:183], v[204:207]
    ds_read_b128 v[224:227], v4 offset:2048
    v_cvt_pk_bf16_f32 v78, v196, v197
    s_waitcnt lgkmcnt(3)
    v_mfma_f32_16x16x32_bf16 v[208:211], v[236:239], v[164:167], v[208:211]
    v_exp_f32 v198, v198
    v_exp_f32 v199, v199
    v_mfma_f32_16x16x32_bf16 v[212:215], v[236:239], v[180:183], v[212:215]
    ds_read_b128 v[228:231], v4 offset:3072
    v_cvt_pk_bf16_f32 v79, v198, v199
    s_waitcnt lgkmcnt(3)
    v_mfma_f32_16x16x32_bf16 v[184:187], v[240:243], v[152:155], v[216:219]
    v_mfma_f32_16x16x32_bf16 v[188:191], v[240:243], v[168:171], v[220:223]
    ds_read_b128 v[232:235], v4 offset:4096
    v_exp_f32 v200, v200
    v_exp_f32 v201, v201
    v_mfma_f32_16x16x32_bf16 v[248:251], v[12:15], v[72:75], v[248:251]
    s_waitcnt lgkmcnt(3)
    v_mfma_f32_16x16x32_bf16 v[192:195], v[244:247], v[152:155], v[216:219]
    v_cvt_pk_bf16_f32 v80, v200, v201
    v_exp_f32 v202, v202
    v_mfma_f32_16x16x32_bf16 v[196:199], v[244:247], v[168:171], v[220:223]
    s_add_u32 s22, s21, 0x80400
    s_add_u32 m0, s20, 0x20400
    s_nop 0
    buffer_load_dwordx4 v2, s[8:11], s22 offen sc1 lds
    ds_read_b128 v[236:239], v4 offset:5120
    v_exp_f32 v203, v203
    v_mfma_f32_16x16x32_bf16 v[252:255], v[12:15], v[76:79], v[252:255]
    s_waitcnt lgkmcnt(3)
    v_mfma_f32_16x16x32_bf16 v[184:187], v[224:227], v[156:159], v[184:187]
    v_cvt_pk_bf16_f32 v81, v202, v203
    v_exp_f32 v204, v204
    v_mfma_f32_16x16x32_bf16 v[188:191], v[224:227], v[172:175], v[188:191]
    ds_read_b128 v[240:243], v4 offset:6144
    v_exp_f32 v205, v205
    s_waitcnt lgkmcnt(3)
    v_mfma_f32_16x16x32_bf16 v[192:195], v[228:231], v[156:159], v[192:195]
    v_cvt_pk_bf16_f32 v84, v204, v205
    v_exp_f32 v206, v206
    v_mfma_f32_16x16x32_bf16 v[196:199], v[228:231], v[172:175], v[196:199]
    ds_read_b128 v[244:247], v4 offset:7168
    v_exp_f32 v207, v207
    s_nop 0
    v_cvt_pk_bf16_f32 v85, v206, v207
    s_waitcnt lgkmcnt(3)
    v_mfma_f32_16x16x32_bf16 v[184:187], v[232:235], v[160:163], v[184:187]
    v_exp_f32 v208, v208
    v_mfma_f32_16x16x32_bf16 v[188:191], v[232:235], v[176:179], v[188:191]
    ds_read_b128 v[224:227], v4 offset:8192
    v_exp_f32 v209, v209
    s_nop 0
    v_cvt_pk_bf16_f32 v82, v208, v209
    s_waitcnt lgkmcnt(3)
    v_mfma_f32_16x16x32_bf16 v[192:195], v[236:239], v[160:163], v[192:195]
    v_exp_f32 v210, v210
    v_mfma_f32_16x16x32_bf16 v[196:199], v[236:239], v[176:179], v[196:199]
    ds_read_b128 v[228:231], v4 offset:9216
    v_exp_f32 v211, v211
    s_nop 0
    v_cvt_pk_bf16_f32 v83, v210, v211
    s_waitcnt lgkmcnt(3)
    v_mfma_f32_16x16x32_bf16 v[184:187], v[240:243], v[164:167], v[184:187]
    v_exp_f32 v212, v212
    v_exp_f32 v213, v213
    v_mfma_f32_16x16x32_bf16 v[188:191], v[240:243], v[180:183], v[188:191]
    ds_read_b128 v[232:235], v4 offset:10240
    v_cvt_pk_bf16_f32 v86, v212, v213
    s_waitcnt lgkmcnt(3)
    v_mfma_f32_16x16x32_bf16 v[192:195], v[244:247], v[164:167], v[192:195]
    v_exp_f32 v214, v214
    v_exp_f32 v215, v215
    v_mfma_f32_16x16x32_bf16 v[196:199], v[244:247], v[180:183], v[196:199]
    ds_read_b128 v[236:239], v4 offset:11264
    v_cvt_pk_bf16_f32 v87, v214, v215
    s_waitcnt lgkmcnt(3)
    v_mfma_f32_16x16x32_bf16 v[200:203], v[224:227], v[152:155], v[216:219]
    v_mfma_f32_16x16x32_bf16 v[204:207], v[224:227], v[168:171], v[220:223]
    ds_read_b128 v[240:243], v4 offset:12288
    v_exp_f32 v184, v184
    v_exp_f32 v185, v185
    v_mfma_f32_16x16x32_bf16 v[248:251], v[12:15], v[80:83], v[248:251]
    s_waitcnt lgkmcnt(3)
    v_mfma_f32_16x16x32_bf16 v[208:211], v[228:231], v[152:155], v[216:219]
    v_cvt_pk_bf16_f32 v88, v184, v185
    v_exp_f32 v186, v186
    v_mfma_f32_16x16x32_bf16 v[212:215], v[228:231], v[168:171], v[220:223]
    ds_read_b128 v[244:247], v4 offset:13312
    v_exp_f32 v187, v187
    v_mfma_f32_16x16x32_bf16 v[252:255], v[12:15], v[84:87], v[252:255]
    s_waitcnt lgkmcnt(3)
    v_mfma_f32_16x16x32_bf16 v[200:203], v[232:235], v[156:159], v[200:203]
    v_cvt_pk_bf16_f32 v89, v186, v187
    v_exp_f32 v188, v188
    v_mfma_f32_16x16x32_bf16 v[204:207], v[232:235], v[172:175], v[204:207]
    ds_read_b128 v[224:227], v4 offset:14336
    v_exp_f32 v189, v189
    s_waitcnt lgkmcnt(3)
    v_mfma_f32_16x16x32_bf16 v[208:211], v[236:239], v[156:159], v[208:211]
    v_cvt_pk_bf16_f32 v92, v188, v189
    v_exp_f32 v190, v190
    v_mfma_f32_16x16x32_bf16 v[212:215], v[236:239], v[172:175], v[212:215]
    ds_read_b128 v[228:231], v4 offset:15360
    v_exp_f32 v191, v191
    s_nop 0
    v_cvt_pk_bf16_f32 v93, v190, v191
    s_waitcnt lgkmcnt(3)
    v_mfma_f32_16x16x32_bf16 v[200:203], v[240:243], v[160:163], v[200:203]
    v_exp_f32 v192, v192
    v_mfma_f32_16x16x32_bf16 v[204:207], v[240:243], v[176:179], v[204:207]
    s_waitcnt vmcnt(7)
    s_barrier
    ds_read_b128 v[232:235], v4 offset:16384
    v_exp_f32 v193, v193
    s_nop 0
    v_cvt_pk_bf16_f32 v90, v192, v193
    s_waitcnt lgkmcnt(3)
    v_mfma_f32_16x16x32_bf16 v[208:211], v[244:247], v[160:163], v[208:211]
    v_exp_f32 v194, v194
    v_mfma_f32_16x16x32_bf16 v[212:215], v[244:247], v[176:179], v[212:215]
    s_add_u32 s22, s21, 0x84000
    s_add_u32 m0, s20, 0x24000
    s_nop 0
    buffer_load_dwordx4 v2, s[8:11], s22 offen sc1 lds
    ds_read_b128 v[236:239], v4 offset:17408
    v_exp_f32 v195, v195
    s_nop 0
    v_cvt_pk_bf16_f32 v91, v194, v195
    s_waitcnt lgkmcnt(3)
    v_mfma_f32_16x16x32_bf16 v[200:203], v[224:227], v[164:167], v[200:203]
    v_exp_f32 v196, v196
    v_exp_f32 v197, v197
    v_mfma_f32_16x16x32_bf16 v[204:207], v[224:227], v[180:183], v[204:207]
    ds_read_b128 v[240:243], v4 offset:18432
    v_cvt_pk_bf16_f32 v94, v196, v197
    s_waitcnt lgkmcnt(3)
    v_mfma_f32_16x16x32_bf16 v[208:211], v[228:231], v[164:167], v[208:211]
    v_exp_f32 v198, v198
    v_exp_f32 v199, v199
    v_mfma_f32_16x16x32_bf16 v[212:215], v[228:231], v[180:183], v[212:215]
    ds_read_b128 v[244:247], v4 offset:19456
    v_cvt_pk_bf16_f32 v95, v198, v199
    s_waitcnt lgkmcnt(3)
    v_mfma_f32_16x16x32_bf16 v[184:187], v[232:235], v[152:155], v[216:219]
    v_mfma_f32_16x16x32_bf16 v[188:191], v[232:235], v[168:171], v[220:223]
    ds_read_b128 v[224:227], v4 offset:20480
    v_exp_f32 v200, v200
    v_exp_f32 v201, v201
    v_mfma_f32_16x16x32_bf16 v[248:251], v[12:15], v[88:91], v[248:251]
    s_waitcnt lgkmcnt(3)
    v_mfma_f32_16x16x32_bf16 v[192:195], v[236:239], v[152:155], v[216:219]
    v_cvt_pk_bf16_f32 v96, v200, v201
    v_exp_f32 v202, v202
    v_mfma_f32_16x16x32_bf16 v[196:199], v[236:239], v[168:171], v[220:223]
    s_add_u32 s22, s21, 0x84400
    s_add_u32 m0, s20, 0x24400
    s_nop 0
    buffer_load_dwordx4 v2, s[8:11], s22 offen sc1 lds
    ds_read_b128 v[228:231], v4 offset:21504
    v_exp_f32 v203, v203
    v_mfma_f32_16x16x32_bf16 v[252:255], v[12:15], v[92:95], v[252:255]
    s_waitcnt lgkmcnt(3)
    v_mfma_f32_16x16x32_bf16 v[184:187], v[240:243], v[156:159], v[184:187]
    v_cvt_pk_bf16_f32 v97, v202, v203
    v_exp_f32 v204, v204
    v_mfma_f32_16x16x32_bf16 v[188:191], v[240:243], v[172:175], v[188:191]
    ds_read_b128 v[232:235], v4 offset:22528
    v_exp_f32 v205, v205
    s_waitcnt lgkmcnt(3)
    v_mfma_f32_16x16x32_bf16 v[192:195], v[244:247], v[156:159], v[192:195]
    v_cvt_pk_bf16_f32 v100, v204, v205
    v_exp_f32 v206, v206
    v_mfma_f32_16x16x32_bf16 v[196:199], v[244:247], v[172:175], v[196:199]
    ds_read_b128 v[236:239], v4 offset:23552
    v_exp_f32 v207, v207
    s_nop 0
    v_cvt_pk_bf16_f32 v101, v206, v207
    s_waitcnt lgkmcnt(3)
    v_mfma_f32_16x16x32_bf16 v[184:187], v[224:227], v[160:163], v[184:187]
    v_exp_f32 v208, v208
    v_mfma_f32_16x16x32_bf16 v[188:191], v[224:227], v[176:179], v[188:191]
    ds_read_b128 v[240:243], v4 offset:24576
    v_exp_f32 v209, v209
    s_nop 0
    v_cvt_pk_bf16_f32 v98, v208, v209
    s_waitcnt lgkmcnt(3)
    v_mfma_f32_16x16x32_bf16 v[192:195], v[228:231], v[160:163], v[192:195]
    v_exp_f32 v210, v210
    v_mfma_f32_16x16x32_bf16 v[196:199], v[228:231], v[176:179], v[196:199]
    ds_read_b128 v[244:247], v4 offset:25600
    v_exp_f32 v211, v211
    s_nop 0
    v_cvt_pk_bf16_f32 v99, v210, v211
    s_waitcnt lgkmcnt(3)
    v_mfma_f32_16x16x32_bf16 v[184:187], v[232:235], v[164:167], v[184:187]
    v_exp_f32 v212, v212
    v_exp_f32 v213, v213
    v_mfma_f32_16x16x32_bf16 v[188:191], v[232:235], v[180:183], v[188:191]
    ds_read_b128 v[224:227], v4 offset:26624
    v_cvt_pk_bf16_f32 v102, v212, v213
    s_waitcnt lgkmcnt(3)
    v_mfma_f32_16x16x32_bf16 v[192:195], v[236:239], v[164:167], v[192:195]
    v_exp_f32 v214, v214
    v_exp_f32 v215, v215
    v_mfma_f32_16x16x32_bf16 v[196:199], v[236:239], v[180:183], v[196:199]
    ds_read_b128 v[228:231], v4 offset:27648
    v_cvt_pk_bf16_f32 v103, v214, v215
    s_waitcnt lgkmcnt(3)
    v_mfma_f32_16x16x32_bf16 v[200:203], v[240:243], v[152:155], v[216:219]
    v_mfma_f32_16x16x32_bf16 v[204:207], v[240:243], v[168:171], v[220:223]
    ds_read_b128 v[232:235], v4 offset:28672
    v_exp_f32 v184, v184
    v_exp_f32 v185, v185
    v_mfma_f32_16x16x32_bf16 v[248:251], v[12:15], v[96:99], v[248:251]
    s_waitcnt lgkmcnt(3)
    v_mfma_f32_16x16x32_bf16 v[208:211], v[244:247], v[152:155], v[216:219]
    v_cvt_pk_bf16_f32 v104, v184, v185
    v_exp_f32 v186, v186
    v_mfma_f32_16x16x32_bf16 v[212:215], v[244:247], v[168:171], v[220:223]
    ds_read_b128 v[236:239], v4 offset:29696
    v_exp_f32 v187, v187
    v_mfma_f32_16x16x32_bf16 v[252:255], v[12:15], v[100:103], v[252:255]
    s_waitcnt lgkmcnt(3)
    v_mfma_f32_16x16x32_bf16 v[200:203], v[224:227], v[156:159], v[200:203]
    v_cvt_pk_bf16_f32 v105, v186, v187
    v_exp_f32 v188, v188
    v_mfma_f32_16x16x32_bf16 v[204:207], v[224:227], v[172:175], v[204:207]
    ds_read_b128 v[240:243], v4 offset:30720
    v_exp_f32 v189, v189
    s_waitcnt lgkmcnt(3)
    v_mfma_f32_16x16x32_bf16 v[208:211], v[228:231], v[156:159], v[208:211]
    v_cvt_pk_bf16_f32 v108, v188, v189
    v_exp_f32 v190, v190
    v_mfma_f32_16x16x32_bf16 v[212:215], v[228:231], v[172:175], v[212:215]
    ds_read_b128 v[244:247], v4 offset:31744
    v_exp_f32 v191, v191
    s_nop 0
    v_cvt_pk_bf16_f32 v109, v190, v191
    s_waitcnt lgkmcnt(3)
    v_mfma_f32_16x16x32_bf16 v[200:203], v[232:235], v[160:163], v[200:203]
    v_exp_f32 v192, v192
    v_mfma_f32_16x16x32_bf16 v[204:207], v[232:235], v[176:179], v[204:207]
    s_waitcnt vmcnt(7)
    s_barrier
    ds_read_b128 v[224:227], v4 offset:32768
    v_exp_f32 v193, v193
    s_nop 0
    v_cvt_pk_bf16_f32 v106, v192, v193
    s_waitcnt lgkmcnt(3)
    v_mfma_f32_16x16x32_bf16 v[208:211], v[236:239], v[160:163], v[208:211]
    v_exp_f32 v194, v194
    v_mfma_f32_16x16x32_bf16 v[212:215], v[236:239], v[176:179], v[212:215]
    s_add_u32 s22, s21, 0x88000
    s_add_u32 m0, s20, 0x10000
    s_nop 0
    buffer_load_dwordx4 v2, s[8:11], s22 offen sc1 lds
    ds_read_b128 v[228:231], v4 offset:33792
    v_exp_f32 v195, v195
    s_nop 0
    v_cvt_pk_bf16_f32 v107, v194, v195
    s_waitcnt lgkmcnt(3)
    v_mfma_f32_16x16x32_bf16 v[200:203], v[240:243], v[164:167], v[200:203]
    v_exp_f32 v196, v196
    v_exp_f32 v197, v197
    v_mfma_f32_16x16x32_bf16 v[204:207], v[240:243], v[180:183], v[204:207]
    ds_read_b128 v[232:235], v4 offset:34816
    v_cvt_pk_bf16_f32 v110, v196, v197
    s_waitcnt lgkmcnt(3)
    v_mfma_f32_16x16x32_bf16 v[208:211], v[244:247], v[164:167], v[208:211]
    v_exp_f32 v198, v198
    v_exp_f32 v199, v199
    v_mfma_f32_16x16x32_bf16 v[212:215], v[244:247], v[180:183], v[212:215]
    ds_read_b128 v[236:239], v4 offset:35840
    v_cvt_pk_bf16_f32 v111, v198, v199
    s_waitcnt lgkmcnt(3)
    v_mfma_f32_16x16x32_bf16 v[184:187], v[224:227], v[152:155], v[216:219]
    v_mfma_f32_16x16x32_bf16 v[188:191], v[224:227], v[168:171], v[220:223]
    ds_read_b128 v[240:243], v4 offset:36864
    v_exp_f32 v200, v200
    v_exp_f32 v201, v201
    v_mfma_f32_16x16x32_bf16 v[248:251], v[12:15], v[104:107], v[248:251]
    s_waitcnt lgkmcnt(3)
    v_mfma_f32_16x16x32_bf16 v[192:195], v[228:231], v[152:155], v[216:219]
    v_cvt_pk_bf16_f32 v112, v200, v201
    v_exp_f32 v202, v202
    v_mfma_f32_16x16x32_bf16 v[196:199], v[228:231], v[168:171], v[220:223]
    s_add_u32 s22, s21, 0x88400
    s_add_u32 m0, s20, 0x10400
    s_nop 0
    buffer_load_dwordx4 v2, s[8:11], s22 offen sc1 lds
    ds_read_b128 v[244:247], v4 offset:37888
    v_exp_f32 v203, v203
    v_mfma_f32_16x16x32_bf16 v[252:255], v[12:15], v[108:111], v[252:255]
    s_waitcnt lgkmcnt(3)
    v_mfma_f32_16x16x32_bf16 v[184:187], v[232:235], v[156:159], v[184:187]
    v_cvt_pk_bf16_f32 v113, v202, v203
    v_exp_f32 v204, v204
    v_mfma_f32_16x16x32_bf16 v[188:191], v[232:235], v[172:175], v[188:191]
    ds_read_b128 v[224:227], v4 offset:38912
    v_exp_f32 v205, v205
    s_waitcnt lgkmcnt(3)
    v_mfma_f32_16x16x32_bf16 v[192:195], v[236:239], v[156:159], v[192:195]
    v_cvt_pk_bf16_f32 v116, v204, v205
    v_exp_f32 v206, v206
    v_mfma_f32_16x16x32_bf16 v[196:199], v[236:239], v[172:175], v[196:199]
    ds_read_b128 v[228:231], v4 offset:39936
    v_exp_f32 v207, v207
    s_nop 0
    v_cvt_pk_bf16_f32 v117, v206, v207
    s_waitcnt lgkmcnt(3)
    v_mfma_f32_16x16x32_bf16 v[184:187], v[240:243], v[160:163], v[184:187]
    v_exp_f32 v208, v208
    v_mfma_f32_16x16x32_bf16 v[188:191], v[240:243], v[176:179], v[188:191]
    ds_read_b128 v[232:235], v4 offset:40960
    v_exp_f32 v209, v209
    s_nop 0
    v_cvt_pk_bf16_f32 v114, v208, v209
    s_waitcnt lgkmcnt(3)
    v_mfma_f32_16x16x32_bf16 v[192:195], v[244:247], v[160:163], v[192:195]
    v_exp_f32 v210, v210
    v_mfma_f32_16x16x32_bf16 v[196:199], v[244:247], v[176:179], v[196:199]
    ds_read_b128 v[236:239], v4 offset:41984
    v_exp_f32 v211, v211
    s_nop 0
    v_cvt_pk_bf16_f32 v115, v210, v211
    s_waitcnt lgkmcnt(3)
    v_mfma_f32_16x16x32_bf16 v[184:187], v[224:227], v[164:167], v[184:187]
    v_exp_f32 v212, v212
    v_exp_f32 v213, v213
    v_mfma_f32_16x16x32_bf16 v[188:191], v[224:227], v[180:183], v[188:191]
    ds_read_b128 v[240:243], v4 offset:43008
    v_cvt_pk_bf16_f32 v118, v212, v213
    s_waitcnt lgkmcnt(3)
    v_mfma_f32_16x16x32_bf16 v[192:195], v[228:231], v[164:167], v[192:195]
    v_exp_f32 v214, v214
    v_exp_f32 v215, v215
    v_mfma_f32_16x16x32_bf16 v[196:199], v[228:231], v[180:183], v[196:199]
    ds_read_b128 v[244:247], v4 offset:44032
    v_cvt_pk_bf16_f32 v119, v214, v215
    s_waitcnt lgkmcnt(3)
    v_mfma_f32_16x16x32_bf16 v[200:203], v[232:235], v[152:155], v[216:219]
    v_mfma_f32_16x16x32_bf16 v[204:207], v[232:235], v[168:171], v[220:223]
    ds_read_b128 v[224:227], v4 offset:45056
    v_exp_f32 v184, v184
    v_exp_f32 v185, v185
    v_mfma_f32_16x16x32_bf16 v[248:251], v[12:15], v[112:115], v[248:251]
    s_waitcnt lgkmcnt(3)
    v_mfma_f32_16x16x32_bf16 v[208:211], v[236:239], v[152:155], v[216:219]
    v_cvt_pk_bf16_f32 v120, v184, v185
    v_exp_f32 v186, v186
    v_mfma_f32_16x16x32_bf16 v[212:215], v[236:239], v[168:171], v[220:223]
    ds_read_b128 v[228:231], v4 offset:46080
    v_exp_f32 v187, v187
    v_mfma_f32_16x16x32_bf16 v[252:255], v[12:15], v[116:119], v[252:255]
    s_waitcnt lgkmcnt(3)
    v_mfma_f32_16x16x32_bf16 v[200:203], v[240:243], v[156:159], v[200:203]
    v_cvt_pk_bf16_f32 v121, v186, v187
    v_exp_f32 v188, v188
    v_mfma_f32_16x16x32_bf16 v[204:207], v[240:243], v[172:175], v[204:207]
    ds_read_b128 v[232:235], v4 offset:47104
    v_exp_f32 v189, v189
    s_waitcnt lgkmcnt(3)
    v_mfma_f32_16x16x32_bf16 v[208:211], v[244:247], v[156:159], v[208:211]
    v_cvt_pk_bf16_f32 v124, v188, v189
    v_exp_f32 v190, v190
    v_mfma_f32_16x16x32_bf16 v[212:215], v[244:247], v[172:175], v[212:215]
    ds_read_b128 v[236:239], v4 offset:48128
    v_exp_f32 v191, v191
    s_nop 0
    v_cvt_pk_bf16_f32 v125, v190, v191
    s_waitcnt lgkmcnt(3)
    v_mfma_f32_16x16x32_bf16 v[200:203], v[224:227], v[160:163], v[200:203]
    v_exp_f32 v192, v192
    v_mfma_f32_16x16x32_bf16 v[204:207], v[224:227], v[176:179], v[204:207]
    s_waitcnt vmcnt(6)
    s_barrier
    ds_read_b128 v[240:243], v4 offset:49152
    v_exp_f32 v193, v193
    s_nop 0
    v_cvt_pk_bf16_f32 v122, v192, v193
    s_waitcnt lgkmcnt(3)
    v_mfma_f32_16x16x32_bf16 v[208:211], v[228:231], v[160:163], v[208:211]
    v_exp_f32 v194, v194
    v_mfma_f32_16x16x32_bf16 v[212:215], v[228:231], v[176:179], v[212:215]
    s_add_u32 s22, s21, 0x8c000
    s_add_u32 m0, s20, 0x14000
    s_nop 0
    buffer_load_dwordx4 v2, s[8:11], s22 offen sc1 lds
    ds_read_b128 v[244:247], v4 offset:50176
    v_exp_f32 v195, v195
    s_nop 0
    v_cvt_pk_bf16_f32 v123, v194, v195
    s_waitcnt lgkmcnt(3)
    v_mfma_f32_16x16x32_bf16 v[200:203], v[232:235], v[164:167], v[200:203]
    v_exp_f32 v196, v196
    v_exp_f32 v197, v197
    v_mfma_f32_16x16x32_bf16 v[204:207], v[232:235], v[180:183], v[204:207]
    ds_read_b128 v[224:227], v4 offset:51200
    v_cvt_pk_bf16_f32 v126, v196, v197
    s_waitcnt lgkmcnt(3)
    v_mfma_f32_16x16x32_bf16 v[208:211], v[236:239], v[164:167], v[208:211]
    v_exp_f32 v198, v198
    v_exp_f32 v199, v199
    v_mfma_f32_16x16x32_bf16 v[212:215], v[236:239], v[180:183], v[212:215]
    ds_read_b128 v[228:231], v4 offset:52224
    v_cvt_pk_bf16_f32 v127, v198, v199
    s_waitcnt lgkmcnt(3)
    v_mfma_f32_16x16x32_bf16 v[184:187], v[240:243], v[152:155], v[216:219]
    v_mfma_f32_16x16x32_bf16 v[188:191], v[240:243], v[168:171], v[220:223]
    ds_read_b128 v[232:235], v4 offset:53248
    v_exp_f32 v200, v200
    v_exp_f32 v201, v201
    v_mfma_f32_16x16x32_bf16 v[248:251], v[12:15], v[120:123], v[248:251]
    s_waitcnt lgkmcnt(3)
    v_mfma_f32_16x16x32_bf16 v[192:195], v[244:247], v[152:155], v[216:219]
    v_cvt_pk_bf16_f32 v128, v200, v201
    v_exp_f32 v202, v202
    v_mfma_f32_16x16x32_bf16 v[196:199], v[244:247], v[168:171], v[220:223]
    s_add_u32 s22, s21, 0x8c400
    s_add_u32 m0, s20, 0x14400
    s_nop 0
    buffer_load_dwordx4 v2, s[8:11], s22 offen sc1 lds
    ds_read_b128 v[236:239], v4 offset:54272
    v_exp_f32 v203, v203
    v_mfma_f32_16x16x32_bf16 v[252:255], v[12:15], v[124:127], v[252:255]
    s_waitcnt lgkmcnt(3)
    v_mfma_f32_16x16x32_bf16 v[184:187], v[224:227], v[156:159], v[184:187]
    v_cvt_pk_bf16_f32 v129, v202, v203
    v_exp_f32 v204, v204
    v_mfma_f32_16x16x32_bf16 v[188:191], v[224:227], v[172:175], v[188:191]
    ds_read_b128 v[240:243], v4 offset:55296
    v_exp_f32 v205, v205
    s_waitcnt lgkmcnt(3)
    v_mfma_f32_16x16x32_bf16 v[192:195], v[228:231], v[156:159], v[192:195]
    v_cvt_pk_bf16_f32 v132, v204, v205
    v_exp_f32 v206, v206
    v_mfma_f32_16x16x32_bf16 v[196:199], v[228:231], v[172:175], v[196:199]
    ds_read_b128 v[244:247], v4 offset:56320
    v_exp_f32 v207, v207
    s_nop 0
    v_cvt_pk_bf16_f32 v133, v206, v207
    s_waitcnt lgkmcnt(3)
    v_mfma_f32_16x16x32_bf16 v[184:187], v[232:235], v[160:163], v[184:187]
    v_exp_f32 v208, v208
    v_mfma_f32_16x16x32_bf16 v[188:191], v[232:235], v[176:179], v[188:191]
    ds_read_b128 v[224:227], v4 offset:57344
    v_exp_f32 v209, v209
    s_nop 0
    v_cvt_pk_bf16_f32 v130, v208, v209
    s_waitcnt lgkmcnt(3)
    v_mfma_f32_16x16x32_bf16 v[192:195], v[236:239], v[160:163], v[192:195]
    v_exp_f32 v210, v210
    v_mfma_f32_16x16x32_bf16 v[196:199], v[236:239], v[176:179], v[196:199]
    ds_read_b128 v[228:231], v4 offset:58368
    v_exp_f32 v211, v211
    s_nop 0
    v_cvt_pk_bf16_f32 v131, v210, v211
    s_waitcnt lgkmcnt(3)
    v_mfma_f32_16x16x32_bf16 v[184:187], v[240:243], v[164:167], v[184:187]
    v_exp_f32 v212, v212
    v_exp_f32 v213, v213
    v_mfma_f32_16x16x32_bf16 v[188:191], v[240:243], v[180:183], v[188:191]
    ds_read_b128 v[232:235], v4 offset:59392
    v_cvt_pk_bf16_f32 v134, v212, v213
    s_waitcnt lgkmcnt(3)
    v_mfma_f32_16x16x32_bf16 v[192:195], v[244:247], v[164:167], v[192:195]
    v_exp_f32 v214, v214
    v_exp_f32 v215, v215
    v_mfma_f32_16x16x32_bf16 v[196:199], v[244:247], v[180:183], v[196:199]
    ds_read_b128 v[236:239], v4 offset:60416
    v_cvt_pk_bf16_f32 v135, v214, v215
    s_waitcnt lgkmcnt(3)
    v_mfma_f32_16x16x32_bf16 v[200:203], v[224:227], v[152:155], v[216:219]
    v_mfma_f32_16x16x32_bf16 v[204:207], v[224:227], v[168:171], v[220:223]
    ds_read_b128 v[240:243], v4 offset:61440
    v_exp_f32 v184, v184
    v_exp_f32 v185, v185
    v_mfma_f32_16x16x32_bf16 v[248:251], v[12:15], v[128:131], v[248:251]
    s_waitcnt lgkmcnt(3)
    v_mfma_f32_16x16x32_bf16 v[208:211], v[228:231], v[152:155], v[216:219]
    v_cvt_pk_bf16_f32 v136, v184, v185
    v_exp_f32 v186, v186
    v_mfma_f32_16x16x32_bf16 v[212:215], v[228:231], v[168:171], v[220:223]
    ds_read_b128 v[244:247], v4 offset:62464
    v_exp_f32 v187, v187
    v_mfma_f32_16x16x32_bf16 v[252:255], v[12:15], v[132:135], v[252:255]
    s_waitcnt lgkmcnt(3)
    v_mfma_f32_16x16x32_bf16 v[200:203], v[232:235], v[156:159], v[200:203]
    v_cvt_pk_bf16_f32 v137, v186, v187
    v_exp_f32 v188, v188
    v_mfma_f32_16x16x32_bf16 v[204:207], v[232:235], v[172:175], v[204:207]
    ds_read_b128 v[224:227], v4 offset:63488
    v_exp_f32 v189, v189
    s_waitcnt lgkmcnt(3)
    v_mfma_f32_16x16x32_bf16 v[208:211], v[236:239], v[156:159], v[208:211]
    v_cvt_pk_bf16_f32 v140, v188, v189
    v_exp_f32 v190, v190
    v_mfma_f32_16x16x32_bf16 v[212:215], v[236:239], v[172:175], v[212:215]
    ds_read_b128 v[228:231], v4 offset:64512
    v_exp_f32 v191, v191
    s_nop 0
    v_cvt_pk_bf16_f32 v141, v190, v191
    s_waitcnt lgkmcnt(3)
    v_mfma_f32_16x16x32_bf16 v[200:203], v[240:243], v[160:163], v[200:203]
    v_exp_f32 v192, v192
    v_mfma_f32_16x16x32_bf16 v[204:207], v[240:243], v[176:179], v[204:207]
    v_exp_f32 v193, v193
    s_nop 0
    v_cvt_pk_bf16_f32 v138, v192, v193
    s_waitcnt lgkmcnt(2)
    v_mfma_f32_16x16x32_bf16 v[208:211], v[244:247], v[160:163], v[208:211]
    v_exp_f32 v194, v194
    v_mfma_f32_16x16x32_bf16 v[212:215], v[244:247], v[176:179], v[212:215]
    v_exp_f32 v195, v195
    s_nop 0
    v_cvt_pk_bf16_f32 v139, v194, v195
    s_waitcnt lgkmcnt(1)
    v_mfma_f32_16x16x32_bf16 v[200:203], v[224:227], v[164:167], v[200:203]
    v_exp_f32 v196, v196
    v_exp_f32 v197, v197
    v_mfma_f32_16x16x32_bf16 v[204:207], v[224:227], v[180:183], v[204:207]
    v_cvt_pk_bf16_f32 v142, v196, v197
    s_waitcnt lgkmcnt(0)
    v_mfma_f32_16x16x32_bf16 v[208:211], v[228:231], v[164:167], v[208:211]
    v_exp_f32 v198, v198
    v_exp_f32 v199, v199
    v_mfma_f32_16x16x32_bf16 v[212:215], v[228:231], v[180:183], v[212:215]
    v_cvt_pk_bf16_f32 v143, v198, v199
    s_waitcnt vmcnt(6)
    s_barrier
    ds_read_b128 v[232:235], v5 offset:0
    ds_read_b128 v[236:239], v5 offset:1024
    ds_read_b128 v[240:243], v5 offset:2048
    ds_read_b128 v[244:247], v5 offset:3072
    v_mfma_f32_16x16x32_bf16 v[248:251], v[12:15], v[136:139], v[248:251]
    v_mfma_f32_16x16x32_bf16 v[252:255], v[12:15], v[140:143], v[252:255]
    v_exp_f32 v200, v200
    v_exp_f32 v201, v201
    s_nop 0
    v_cvt_pk_bf16_f32 v144, v200, v201
    v_exp_f32 v202, v202
    v_exp_f32 v203, v203
    s_nop 0
    v_cvt_pk_bf16_f32 v145, v202, v203
    v_exp_f32 v204, v204
    v_exp_f32 v205, v205
    s_nop 0
    v_cvt_pk_bf16_f32 v148, v204, v205
    v_exp_f32 v206, v206
    v_exp_f32 v207, v207
    s_nop 0
    v_cvt_pk_bf16_f32 v149, v206, v207
    v_exp_f32 v208, v208
    v_exp_f32 v209, v209
    s_nop 0
    v_cvt_pk_bf16_f32 v146, v208, v209
    v_exp_f32 v210, v210
    v_exp_f32 v211, v211
    s_nop 0
    v_cvt_pk_bf16_f32 v147, v210, v211
    v_exp_f32 v212, v212
    v_exp_f32 v213, v213
    s_nop 0
    v_cvt_pk_bf16_f32 v150, v212, v213
    v_exp_f32 v214, v214
    v_exp_f32 v215, v215
    s_nop 0
    v_cvt_pk_bf16_f32 v151, v214, v215
    v_mfma_f32_16x16x32_bf16 v[248:251], v[12:15], v[144:147], v[248:251]
    s_nop 0
    v_mfma_f32_16x16x32_bf16 v[252:255], v[12:15], v[148:151], v[252:255]
    s_nop 5
    v_mov_b32 v9, v248
    s_nop 0
    v_mov_b32 v10, v252
    v_max_f32 v17, v9, v10
    v_readfirstlane_b32 s17, v8
    s_cmp_eq_u32 s17, s28
    s_cselect_b32 s16, 0, 0x71800000
    v_cmp_ngt_f32 vcc, s16, v17
    v_cmp_u_f32 s[76:77], v9, v10
    s_or_b64 vcc, vcc, s[76:77]
    s_cbranch_vccnz adaLN_cond__sliding_block_cached__moe_arch_mod__prompt_kernel_fixA
adaLN_cond__sliding_block_cached__moe_arch_mod__prompt_kernel_fixAb:
    v_rcp_f32 v9, v9
    v_rcp_f32 v10, v10
    s_lshl_b32 s25, s13, 3
    s_add_u32 s25, s25, s3
    s_lshl_b32 s25, s25, 18
    s_lshl_b32 s26, s12, 12
    s_add_u32 s25, s25, s26
    s_add_u32 s25, s25, 0x1000000
    s_add_u32 s26, s25, 131072
    s_lshl_b32 s63, s13, 3
    s_add_u32 s63, s63, s3
    s_lshl_b32 s63, s63, 5
    s_add_u32 s63, s63, s12
    s_lshl_b32 s63, s63, 2
    s_waitcnt lgkmcnt(3)
    v_mfma_f32_16x16x32_bf16 v[184:187], v[232:235], v[24:27], 0
    v_mfma_f32_16x16x32_bf16 v[188:191], v[232:235], v[28:31], 0
    ds_read_b128 v[224:227], v5 offset:4096
    s_waitcnt lgkmcnt(3)
    v_mfma_f32_16x16x32_bf16 v[192:195], v[236:239], v[24:27], 0
    s_add_u32 s22, s21, 0x90000
    s_add_u32 m0, s20, 0x18000
    s_nop 0
    buffer_load_dwordx4 v2, s[8:11], s22 offen sc1 lds
    v_mfma_f32_16x16x32_bf16 v[196:199], v[236:239], v[28:31], 0
    ds_read_b128 v[228:231], v5 offset:5120
    s_waitcnt lgkmcnt(3)
    v_mfma_f32_16x16x32_bf16 v[184:187], v[240:243], v[32:35], v[184:187]
    v_mfma_f32_16x16x32_bf16 v[188:191], v[240:243], v[36:39], v[188:191]
    ds_read_b128 v[232:235], v5 offset:6144
    s_waitcnt lgkmcnt(3)
    v_mfma_f32_16x16x32_bf16 v[192:195], v[244:247], v[32:35], v[192:195]
    v_mfma_f32_16x16x32_bf16 v[196:199], v[244:247], v[36:39], v[196:199]
    ds_read_b128 v[236:239], v5 offset:7168
    s_waitcnt lgkmcnt(3)
    v_mfma_f32_16x16x32_bf16 v[184:187], v[224:227], v[40:43], v[184:187]
    v_mfma_f32_16x16x32_bf16 v[188:191], v[224:227], v[44:47], v[188:191]
    ds_read_b128 v[240:243], v5 offset:8192
    s_waitcnt lgkmcnt(3)
    v_mfma_f32_16x16x32_bf16 v[192:195], v[228:231], v[40:43], v[192:195]
    s_add_u32 s22, s21, 0x90400
    s_add_u32 m0, s20, 0x18400
    s_nop 0
    buffer_load_dwordx4 v2, s[8:11], s22 offen sc1 lds
    v_and_b32 v250, 7, v1
    v_lshlrev_b32 v250, 7, v250
    s_lshr_b32 s14, s2, 3
    s_lshl_b32 s14, s14, 2
    s_add_u32 s14, s14, 0x560000
    buffer_load_dword v248, v250, s[8:11], s14 offen sc1
    v_mfma_f32_16x16x32_bf16 v[196:199], v[228:231], v[44:47], v[196:199]
    ds_read_b128 v[244:247], v5 offset:9216
    s_waitcnt lgkmcnt(3)
    v_mfma_f32_16x16x32_bf16 v[184:187], v[232:235], v[48:51], v[184:187]
    v_mfma_f32_16x16x32_bf16 v[188:191], v[232:235], v[52:55], v[188:191]
    ds_read_b128 v[224:227], v5 offset:10240
    s_waitcnt lgkmcnt(3)
    v_mfma_f32_16x16x32_bf16 v[192:195], v[236:239], v[48:51], v[192:195]
    v_mfma_f32_16x16x32_bf16 v[196:199], v[236:239], v[52:55], v[196:199]
    ds_read_b128 v[228:231], v5 offset:11264
    s_waitcnt lgkmcnt(3)
    v_mfma_f32_16x16x32_bf16 v[184:187], v[240:243], v[56:59], v[184:187]
    v_mfma_f32_16x16x32_bf16 v[188:191], v[240:243], v[60:63], v[188:191]
    ds_read_b128 v[232:235], v5 offset:12288
    s_waitcnt lgkmcnt(3)
    v_mfma_f32_16x16x32_bf16 v[192:195], v[244:247], v[56:59], v[192:195]
    v_mfma_f32_16x16x32_bf16 v[196:199], v[244:247], v[60:63], v[196:199]
    ds_read_b128 v[236:239], v5 offset:13312
    s_waitcnt lgkmcnt(3)
    v_mfma_f32_16x16x32_bf16 v[184:187], v[224:227], v[64:67], v[184:187]
    v_mfma_f32_16x16x32_bf16 v[188:191], v[224:227], v[68:71], v[188:191]
    ds_read_b128 v[240:243], v5 offset:14336
    s_waitcnt lgkmcnt(3)
    v_mfma_f32_16x16x32_bf16 v[192:195], v[228:231], v[64:67], v[192:195]
    v_mfma_f32_16x16x32_bf16 v[196:199], v[228:231], v[68:71], v[196:199]
    ds_read_b128 v[244:247], v5 offset:15360
    s_waitcnt lgkmcnt(3)
    v_mfma_f32_16x16x32_bf16 v[184:187], v[232:235], v[72:75], v[184:187]
    v_mfma_f32_16x16x32_bf16 v[188:191], v[232:235], v[76:79], v[188:191]
    s_waitcnt vmcnt(7)
    s_barrier
    ds_read_b128 v[224:227], v5 offset:16384
    s_waitcnt lgkmcnt(3)
    v_mfma_f32_16x16x32_bf16 v[192:195], v[236:239], v[72:75], v[192:195]
    v_mfma_f32_16x16x32_bf16 v[196:199], v[236:239], v[76:79], v[196:199]
    s_add_u32 s22, s21, 0x94000
    s_add_u32 m0, s20, 0x1c000
    s_nop 0
    buffer_load_dwordx4 v2, s[8:11], s22 offen sc1 lds
    ds_read_b128 v[228:231], v5 offset:17408
    s_waitcnt lgkmcnt(3)
    v_mfma_f32_16x16x32_bf16 v[184:187], v[240:243], v[80:83], v[184:187]
    v_mfma_f32_16x16x32_bf16 v[188:191], v[240:243], v[84:87], v[188:191]
    ds_read_b128 v[232:235], v5 offset:18432
    s_waitcnt lgkmcnt(3)
    v_mfma_f32_16x16x32_bf16 v[192:195], v[244:247], v[80:83], v[192:195]
    v_mfma_f32_16x16x32_bf16 v[196:199], v[244:247], v[84:87], v[196:199]
    ds_read_b128 v[236:239], v5 offset:19456
    s_waitcnt lgkmcnt(3)
    v_mfma_f32_16x16x32_bf16 v[184:187], v[224:227], v[88:91], v[184:187]
    v_mfma_f32_16x16x32_bf16 v[188:191], v[224:227], v[92:95], v[188:191]
    ds_read_b128 v[240:243], v5 offset:20480
    s_waitcnt lgkmcnt(3)
    v_mfma_f32_16x16x32_bf16 v[192:195], v[228:231], v[88:91], v[192:195]
    v_mfma_f32_16x16x32_bf16 v[196:199], v[228:231], v[92:95], v[196:199]
    s_add_u32 s22, s21, 0x94400
    s_add_u32 m0, s20, 0x1c400
    s_nop 0
    buffer_load_dwordx4 v2, s[8:11], s22 offen sc1 lds
    ds_read_b128 v[244:247], v5 offset:21504
    s_waitcnt lgkmcnt(3)
    v_mfma_f32_16x16x32_bf16 v[184:187], v[232:235], v[96:99], v[184:187]
    v_mfma_f32_16x16x32_bf16 v[188:191], v[232:235], v[100:103], v[188:191]
    ds_read_b128 v[224:227], v5 offset:22528
    s_waitcnt lgkmcnt(3)
    v_mfma_f32_16x16x32_bf16 v[192:195], v[236:239], v[96:99], v[192:195]
    v_mfma_f32_16x16x32_bf16 v[196:199], v[236:239], v[100:103], v[196:199]
    ds_read_b128 v[228:231], v5 offset:23552
    s_waitcnt lgkmcnt(3)
    v_mfma_f32_16x16x32_bf16 v[184:187], v[240:243], v[104:107], v[184:187]
    v_mfma_f32_16x16x32_bf16 v[188:191], v[240:243], v[108:111], v[188:191]
    ds_read_b128 v[232:235], v5 offset:24576
    s_waitcnt lgkmcnt(3)
    v_mfma_f32_16x16x32_bf16 v[192:195], v[244:247], v[104:107], v[192:195]
    v_mfma_f32_16x16x32_bf16 v[196:199], v[244:247], v[108:111], v[196:199]
    ds_read_b128 v[236:239], v5 offset:25600
    s_waitcnt lgkmcnt(3)
    v_mfma_f32_16x16x32_bf16 v[184:187], v[224:227], v[112:115], v[184:187]
    s_waitcnt vmcnt(2)
    v_cmp_ne_u32 vcc, s28, v248
    s_cbranch_vccnz adaLN_cond__sliding_block_cached__moe_arch_mod__prompt_kernel_mp5r
adaLN_cond__sliding_block_cached__moe_arch_mod__prompt_kernel_mp5b:
    v_mfma_f32_16x16x32_bf16 v[188:191], v[224:227], v[116:119], v[188:191]
    ds_read_b128 v[240:243], v5 offset:26624
    v_lshrrev_b32 v250, 4, v1
    v_lshlrev_b32 v250, 14, v250
    v_and_b32 v253, 15, v1
    v_lshl_add_u32 v250, v253, 2, v250
    s_lshl_b32 s14, s2, 6
    s_add_u32 s14, s14, 0x580000
    buffer_load_dword v249, v250, s[8:11], s14 offen sc1
    s_add_u32 s14, s14, 0x10000
    buffer_load_dword v254, v250, s[8:11], s14 offen sc1
    s_waitcnt lgkmcnt(3)
    v_mfma_f32_16x16x32_bf16 v[192:195], v[228:231], v[112:115], v[192:195]
    v_mfma_f32_16x16x32_bf16 v[196:199], v[228:231], v[116:119], v[196:199]
    ds_read_b128 v[244:247], v5 offset:27648
    s_waitcnt lgkmcnt(3)
    v_mfma_f32_16x16x32_bf16 v[184:187], v[232:235], v[120:123], v[184:187]
    v_mfma_f32_16x16x32_bf16 v[188:191], v[232:235], v[124:127], v[188:191]
    ds_read_b128 v[224:227], v5 offset:28672
    s_waitcnt lgkmcnt(3)
    v_mfma_f32_16x16x32_bf16 v[192:195], v[236:239], v[120:123], v[192:195]
    v_mfma_f32_16x16x32_bf16 v[196:199], v[236:239], v[124:127], v[196:199]
    ds_read_b128 v[228:231], v5 offset:29696
    s_waitcnt lgkmcnt(3)
    v_mfma_f32_16x16x32_bf16 v[184:187], v[240:243], v[128:131], v[184:187]
    v_mfma_f32_16x16x32_bf16 v[188:191], v[240:243], v[132:135], v[188:191]
    ds_read_b128 v[232:235], v5 offset:30720
    s_waitcnt lgkmcnt(3)
    v_mfma_f32_16x16x32_bf16 v[192:195], v[244:247], v[128:131], v[192:195]
    v_mfma_f32_16x16x32_bf16 v[196:199], v[244:247], v[132:135], v[196:199]
    ds_read_b128 v[236:239], v5 offset:31744
    s_waitcnt lgkmcnt(3)
    v_mfma_f32_16x16x32_bf16 v[184:187], v[224:227], v[136:139], v[184:187]
    v_mfma_f32_16x16x32_bf16 v[188:191], v[224:227], v[140:143], v[188:191]
    s_barrier
    ds_read_b128 v[240:243], v4 offset:0
    s_waitcnt lgkmcnt(3)
    v_mfma_f32_16x16x32_bf16 v[192:195], v[228:231], v[136:139], v[192:195]
    v_mfma_f32_16x16x32_bf16 v[196:199], v[228:231], v[140:143], v[196:199]
    s_add_u32 s22, s21, 0x98000
    s_add_u32 m0, s20, 0x20000
    s_nop 0
    buffer_load_dwordx4 v2, s[8:11], s22 offen sc1 lds
    ds_read_b128 v[244:247], v4 offset:1024
    s_waitcnt lgkmcnt(3)
    v_mfma_f32_16x16x32_bf16 v[184:187], v[232:235], v[144:147], v[184:187]
    v_mfma_f32_16x16x32_bf16 v[188:191], v[232:235], v[148:151], v[188:191]
    ds_read_b128 v[224:227], v4 offset:2048
    s_waitcnt lgkmcnt(3)
    v_mfma_f32_16x16x32_bf16 v[192:195], v[236:239], v[144:147], v[192:195]
    v_mfma_f32_16x16x32_bf16 v[196:199], v[236:239], v[148:151], v[196:199]
    ds_read_b128 v[228:231], v4 offset:3072
    s_waitcnt lgkmcnt(3)
    v_mfma_f32_16x16x32_bf16 v[200:203], v[240:243], v[24:27], 0
    v_mfma_f32_16x16x32_bf16 v[204:207], v[240:243], v[28:31], 0
    ds_read_b128 v[232:235], v4 offset:4096
    s_waitcnt lgkmcnt(3)
    v_mfma_f32_16x16x32_bf16 v[208:211], v[244:247], v[24:27], 0
    v_mfma_f32_16x16x32_bf16 v[212:215], v[244:247], v[28:31], 0
    s_add_u32 s22, s21, 0x98400
    s_add_u32 m0, s20, 0x20400
    s_nop 0
    buffer_load_dwordx4 v2, s[8:11], s22 offen sc1 lds
    ds_read_b128 v[236:239], v4 offset:5120
    v_mul_f32 v184, v184, v9
    s_waitcnt lgkmcnt(3)
    v_mfma_f32_16x16x32_bf16 v[200:203], v[224:227], v[32:35], v[200:203]
    v_mul_f32 v185, v185, v9
    s_waitcnt vmcnt(2)
    v_add_f32 v249, v249, v254
    v_mov_b32 v250, v249
    s_nop 1
    v_permlane16_swap_b32 v249, v250
    v_add_f32 v249, v249, v250
    v_mov_b32 v250, v249
    s_nop 1
    v_permlane32_swap_b32 v249, v250
    v_add_f32 v249, v249, v250
    v_cvt_pk_bf16_f32 v249, v249, v249
    v_lshlrev_b32 v249, 16, v249
    s_lshr_b32 s14, s2, 6
    s_cmp_eq_u32 s14, 2
    s_cselect_b32 s14, 1.0, 0
    v_add_f32 v249, s14, v249
    v_cvt_pk_bf16_f32 v249, v249, v249
    v_lshlrev_b32 v253, 1, v253
    s_lshl_b32 s14, s2, 5
    s_add_u32 s14, s14, 0x540000
    s_cmp_eq_u32 s3, 0
    s_cselect_b32 s14, s14, 0x7ffffff0
    s_mov_b64 exec, 0xffff
    buffer_store_short v249, v253, s[8:11], s14 offen sc1
    s_mov_b64 exec, -1
    v_mfma_f32_16x16x32_bf16 v[204:207], v[224:227], v[36:39], v[204:207]
    ds_read_b128 v[240:243], v4 offset:6144
    v_mul_f32 v186, v186, v9
    s_waitcnt lgkmcnt(3)
    v_mfma_f32_16x16x32_bf16 v[208:211], v[228:231], v[32:35], v[208:211]
    v_mul_f32 v187, v187, v9
    v_mfma_f32_16x16x32_bf16 v[212:215], v[228:231], v[36:39], v[212:215]
    ds_read_b128 v[244:247], v4 offset:7168
    v_mul_f32 v192, v192, v9
    s_waitcnt lgkmcnt(3)
    v_mfma_f32_16x16x32_bf16 v[200:203], v[232:235], v[40:43], v[200:203]
    v_mul_f32 v193, v193, v9
    v_mfma_f32_16x16x32_bf16 v[204:207], v[232:235], v[44:47], v[204:207]
    ds_read_b128 v[224:227], v4 offset:8192
    v_mul_f32 v194, v194, v9
    s_waitcnt lgkmcnt(3)
    v_mfma_f32_16x16x32_bf16 v[208:211], v[236:239], v[40:43], v[208:211]
    v_mul_f32 v195, v195, v9
    v_mfma_f32_16x16x32_bf16 v[212:215], v[236:239], v[44:47], v[212:215]
    ds_read_b128 v[228:231], v4 offset:9216
    v_cvt_pk_bf16_f32 v216, v184, v185
    s_waitcnt lgkmcnt(3)
    v_mfma_f32_16x16x32_bf16 v[200:203], v[240:243], v[48:51], v[200:203]
    v_cvt_pk_bf16_f32 v217, v186, v187
    v_mfma_f32_16x16x32_bf16 v[204:207], v[240:243], v[52:55], v[204:207]
    ds_read_b128 v[232:235], v4 offset:10240
    v_cvt_pk_bf16_f32 v218, v192, v193
    s_waitcnt lgkmcnt(3)
    v_mfma_f32_16x16x32_bf16 v[208:211], v[244:247], v[48:51], v[208:211]
    v_cvt_pk_bf16_f32 v219, v194, v195
    v_mfma_f32_16x16x32_bf16 v[212:215], v[244:247], v[52:55], v[212:215]
    ds_read_b128 v[236:239], v4 offset:11264
    buffer_store_dwordx4 v[216:219], v2, s[8:11], s25 offen offset:0 sc1
    s_waitcnt lgkmcnt(3)
    v_mfma_f32_16x16x32_bf16 v[200:203], v[224:227], v[56:59], v[200:203]
    v_mul_f32 v188, v188, v10
    v_mfma_f32_16x16x32_bf16 v[204:207], v[224:227], v[60:63], v[204:207]
    ds_read_b128 v[240:243], v4 offset:12288
    v_mul_f32 v189, v189, v10
    s_waitcnt lgkmcnt(3)
    v_mfma_f32_16x16x32_bf16 v[208:211], v[228:231], v[56:59], v[208:211]
    v_mul_f32 v190, v190, v10
    v_mfma_f32_16x16x32_bf16 v[212:215], v[228:231], v[60:63], v[212:215]
    ds_read_b128 v[244:247], v4 offset:13312
    v_mul_f32 v191, v191, v10
    s_waitcnt lgkmcnt(3)
    v_mfma_f32_16x16x32_bf16 v[200:203], v[232:235], v[64:67], v[200:203]
    v_mul_f32 v196, v196, v10
    v_mfma_f32_16x16x32_bf16 v[204:207], v[232:235], v[68:71], v[204:207]
    ds_read_b128 v[224:227], v4 offset:14336
    v_mul_f32 v197, v197, v10
    s_waitcnt lgkmcnt(3)
    v_mfma_f32_16x16x32_bf16 v[208:211], v[236:239], v[64:67], v[208:211]
    v_mul_f32 v198, v198, v10
    v_mfma_f32_16x16x32_bf16 v[212:215], v[236:239], v[68:71], v[212:215]
    ds_read_b128 v[228:231], v4 offset:15360
    v_mul_f32 v199, v199, v10
    s_waitcnt lgkmcnt(3)
    v_mfma_f32_16x16x32_bf16 v[200:203], v[240:243], v[72:75], v[200:203]
    v_cvt_pk_bf16_f32 v220, v188, v189
    v_mfma_f32_16x16x32_bf16 v[204:207], v[240:243], v[76:79], v[204:207]
    s_barrier
    ds_read_b128 v[232:235], v4 offset:16384
    v_cvt_pk_bf16_f32 v221, v190, v191
    s_waitcnt lgkmcnt(3)
    v_mfma_f32_16x16x32_bf16 v[208:211], v[244:247], v[72:75], v[208:211]
    v_cvt_pk_bf16_f32 v222, v196, v197
    v_mfma_f32_16x16x32_bf16 v[212:215], v[244:247], v[76:79], v[212:215]
    s_add_u32 s22, s21, 0x9c000
    s_add_u32 m0, s20, 0x24000
    s_nop 0
    buffer_load_dwordx4 v2, s[8:11], s22 offen sc1 lds
    ds_read_b128 v[236:239], v4 offset:17408
    v_cvt_pk_bf16_f32 v223, v198, v199
    s_waitcnt lgkmcnt(3)
    v_mfma_f32_16x16x32_bf16 v[200:203], v[224:227], v[80:83], v[200:203]
    buffer_store_dwordx4 v[220:223], v2, s[8:11], s26 offen offset:0 sc1
    v_mfma_f32_16x16x32_bf16 v[204:207], v[224:227], v[84:87], v[204:207]
    ds_read_b128 v[240:243], v4 offset:18432
    s_waitcnt lgkmcnt(3)
    v_mfma_f32_16x16x32_bf16 v[208:211], v[228:231], v[80:83], v[208:211]
    v_mfma_f32_16x16x32_bf16 v[212:215], v[228:231], v[84:87], v[212:215]
    ds_read_b128 v[244:247], v4 offset:19456
    s_waitcnt lgkmcnt(3)
    v_mfma_f32_16x16x32_bf16 v[200:203], v[232:235], v[88:91], v[200:203]
    v_mfma_f32_16x16x32_bf16 v[204:207], v[232:235], v[92:95], v[204:207]
    ds_read_b128 v[224:227], v4 offset:20480
    s_waitcnt lgkmcnt(3)
    v_mfma_f32_16x16x32_bf16 v[208:211], v[236:239], v[88:91], v[208:211]
    v_mfma_f32_16x16x32_bf16 v[212:215], v[236:239], v[92:95], v[212:215]
    s_add_u32 s22, s21, 0x9c400
    s_add_u32 m0, s20, 0x24400
    s_nop 0
    buffer_load_dwordx4 v2, s[8:11], s22 offen sc1 lds
    ds_read_b128 v[228:231], v4 offset:21504
    s_waitcnt lgkmcnt(3)
    v_mfma_f32_16x16x32_bf16 v[200:203], v[240:243], v[96:99], v[200:203]
    v_mfma_f32_16x16x32_bf16 v[204:207], v[240:243], v[100:103], v[204:207]
    ds_read_b128 v[232:235], v4 offset:22528
    s_waitcnt lgkmcnt(3)
    v_mfma_f32_16x16x32_bf16 v[208:211], v[244:247], v[96:99], v[208:211]
    v_mfma_f32_16x16x32_bf16 v[212:215], v[244:247], v[100:103], v[212:215]
    ds_read_b128 v[236:239], v4 offset:23552
    s_waitcnt lgkmcnt(3)
    v_mfma_f32_16x16x32_bf16 v[200:203], v[224:227], v[104:107], v[200:203]
    v_mfma_f32_16x16x32_bf16 v[204:207], v[224:227], v[108:111], v[204:207]
    ds_read_b128 v[240:243], v4 offset:24576
    s_waitcnt lgkmcnt(3)
    v_mfma_f32_16x16x32_bf16 v[208:211], v[228:231], v[104:107], v[208:211]
    v_mfma_f32_16x16x32_bf16 v[212:215], v[228:231], v[108:111], v[212:215]
    ds_read_b128 v[244:247], v4 offset:25600
    s_waitcnt lgkmcnt(3)
    v_mfma_f32_16x16x32_bf16 v[200:203], v[232:235], v[112:115], v[200:203]
    s_waitcnt vmcnt(4)
    v_mov_b32 v248, s28
    v_mov_b32 v249, 0
    s_lshl_b32 s14, s2, 2
    s_add_u32 s14, s14, 0x544000
    s_cmp_eq_u32 s3, 0
    s_cselect_b32 s14, s14, 0x7ffffff0
    s_mov_b64 exec, 1
    buffer_store_dword v248, v249, s[8:11], s14 offen sc1
    s_mov_b64 exec, -1
    v_mfma_f32_16x16x32_bf16 v[204:207], v[232:235], v[116:119], v[204:207]
    ds_read_b128 v[224:227], v4 offset:26624
    s_waitcnt lgkmcnt(3)
    v_mfma_f32_16x16x32_bf16 v[208:211], v[236:239], v[112:115], v[208:211]
    v_mfma_f32_16x16x32_bf16 v[212:215], v[236:239], v[116:119], v[212:215]
    ds_read_b128 v[228:231], v4 offset:27648
    s_waitcnt lgkmcnt(3)
    v_mfma_f32_16x16x32_bf16 v[200:203], v[240:243], v[120:123], v[200:203]
    v_mfma_f32_16x16x32_bf16 v[204:207], v[240:243], v[124:127], v[204:207]
    ds_read_b128 v[232:235], v4 offset:28672
    s_waitcnt lgkmcnt(3)
    v_mfma_f32_16x16x32_bf16 v[208:211], v[244:247], v[120:123], v[208:211]
    v_mfma_f32_16x16x32_bf16 v[212:215], v[244:247], v[124:127], v[212:215]
    ds_read_b128 v[236:239], v4 offset:29696
    s_waitcnt lgkmcnt(3)
    v_mfma_f32_16x16x32_bf16 v[200:203], v[224:227], v[128:131], v[200:203]
    v_mfma_f32_16x16x32_bf16 v[204:207], v[224:227], v[132:135], v[204:207]
    ds_read_b128 v[240:243], v4 offset:30720
    s_waitcnt lgkmcnt(3)
    v_mfma_f32_16x16x32_bf16 v[208:211], v[228:231], v[128:131], v[208:211]
    v_mfma_f32_16x16x32_bf16 v[212:215], v[228:231], v[132:135], v[212:215]
    ds_read_b128 v[244:247], v4 offset:31744
    s_waitcnt lgkmcnt(3)
    v_mfma_f32_16x16x32_bf16 v[200:203], v[232:235], v[136:139], v[200:203]
    v_mfma_f32_16x16x32_bf16 v[204:207], v[232:235], v[140:143], v[204:207]
    s_barrier
    ds_read_b128 v[224:227], v4 offset:32768
    s_waitcnt lgkmcnt(3)
    v_mfma_f32_16x16x32_bf16 v[208:211], v[236:239], v[136:139], v[208:211]
    v_mfma_f32_16x16x32_bf16 v[212:215], v[236:239], v[140:143], v[212:215]
    s_add_u32 s22, s24, 0x0
    s_add_u32 m0, s20, 0x10000
    s_nop 0
    buffer_load_dwordx4 v3, s[4:7], s22 offen lds
    ds_read_b128 v[228:231], v4 offset:33792
    s_waitcnt lgkmcnt(3)
    v_mfma_f32_16x16x32_bf16 v[200:203], v[240:243], v[144:147], v[200:203]
    v_mfma_f32_16x16x32_bf16 v[204:207], v[240:243], v[148:151], v[204:207]
    ds_read_b128 v[232:235], v4 offset:34816
    s_waitcnt lgkmcnt(3)
    v_mfma_f32_16x16x32_bf16 v[208:211], v[244:247], v[144:147], v[208:211]
    v_mfma_f32_16x16x32_bf16 v[212:215], v[244:247], v[148:151], v[212:215]
    ds_read_b128 v[236:239], v4 offset:35840
    s_waitcnt lgkmcnt(3)
    v_mfma_f32_16x16x32_bf16 v[184:187], v[224:227], v[24:27], 0
    v_mfma_f32_16x16x32_bf16 v[188:191], v[224:227], v[28:31], 0
    ds_read_b128 v[240:243], v4 offset:36864
    s_waitcnt lgkmcnt(3)
    v_mfma_f32_16x16x32_bf16 v[192:195], v[228:231], v[24:27], 0
    v_mfma_f32_16x16x32_bf16 v[196:199], v[228:231], v[28:31], 0
    s_add_u32 s22, s24, 0x2000
    s_add_u32 m0, s20, 0x10400
    s_nop 0
    buffer_load_dwordx4 v3, s[4:7], s22 offen lds
    ds_read_b128 v[244:247], v4 offset:37888
    v_mul_f32 v200, v200, v9
    s_waitcnt lgkmcnt(3)
    v_mfma_f32_16x16x32_bf16 v[184:187], v[232:235], v[32:35], v[184:187]
    v_mul_f32 v201, v201, v9
    v_mfma_f32_16x16x32_bf16 v[188:191], v[232:235], v[36:39], v[188:191]
    ds_read_b128 v[224:227], v4 offset:38912
    v_mul_f32 v202, v202, v9
    s_waitcnt lgkmcnt(3)
    v_mfma_f32_16x16x32_bf16 v[192:195], v[236:239], v[32:35], v[192:195]
    v_mul_f32 v203, v203, v9
    v_mfma_f32_16x16x32_bf16 v[196:199], v[236:239], v[36:39], v[196:199]
    ds_read_b128 v[228:231], v4 offset:39936
    v_mul_f32 v208, v208, v9
    s_waitcnt lgkmcnt(3)
    v_mfma_f32_16x16x32_bf16 v[184:187], v[240:243], v[40:43], v[184:187]
    v_mul_f32 v209, v209, v9
    v_mfma_f32_16x16x32_bf16 v[188:191], v[240:243], v[44:47], v[188:191]
    ds_read_b128 v[232:235], v4 offset:40960
    v_mul_f32 v210, v210, v9
    s_waitcnt lgkmcnt(3)
    v_mfma_f32_16x16x32_bf16 v[192:195], v[244:247], v[40:43], v[192:195]
    v_mul_f32 v211, v211, v9
    v_mfma_f32_16x16x32_bf16 v[196:199], v[244:247], v[44:47], v[196:199]
    ds_read_b128 v[236:239], v4 offset:41984
    v_cvt_pk_bf16_f32 v216, v200, v201
    s_waitcnt lgkmcnt(3)
    v_mfma_f32_16x16x32_bf16 v[184:187], v[224:227], v[48:51], v[184:187]
    v_cvt_pk_bf16_f32 v217, v202, v203
    s_waitcnt vmcnt(4)
    s_add_u32 s16, s63, 0x570000
    v_mov_b32 v7, s28
    v_mov_b32 v8, 0
    s_mov_b64 exec, 1
    buffer_store_dword v7, v8, s[8:11], s16 offen sc1
    s_mov_b64 exec, -1
    v_mfma_f32_16x16x32_bf16 v[188:191], v[224:227], v[52:55], v[188:191]
    ds_read_b128 v[240:243], v4 offset:43008
    v_cvt_pk_bf16_f32 v218, v208, v209
    s_waitcnt lgkmcnt(3)
    v_mfma_f32_16x16x32_bf16 v[192:195], v[228:231], v[48:51], v[192:195]
    v_cvt_pk_bf16_f32 v219, v210, v211
    v_mfma_f32_16x16x32_bf16 v[196:199], v[228:231], v[52:55], v[196:199]
    ds_read_b128 v[244:247], v4 offset:44032
    buffer_store_dwordx4 v[216:219], v2, s[8:11], s25 offen offset:1024 sc1
    s_waitcnt lgkmcnt(3)
    v_mfma_f32_16x16x32_bf16 v[184:187], v[232:235], v[56:59], v[184:187]
    v_mul_f32 v204, v204, v10
    v_mfma_f32_16x16x32_bf16 v[188:191], v[232:235], v[60:63], v[188:191]
    ds_read_b128 v[224:227], v4 offset:45056
    v_mul_f32 v205, v205, v10
    s_waitcnt lgkmcnt(3)
    v_mfma_f32_16x16x32_bf16 v[192:195], v[236:239], v[56:59], v[192:195]
    v_mul_f32 v206, v206, v10
    v_mfma_f32_16x16x32_bf16 v[196:199], v[236:239], v[60:63], v[196:199]
    ds_read_b128 v[228:231], v4 offset:46080
    v_mul_f32 v207, v207, v10
    s_waitcnt lgkmcnt(3)
    v_mfma_f32_16x16x32_bf16 v[184:187], v[240:243], v[64:67], v[184:187]
    v_mul_f32 v212, v212, v10
    v_mfma_f32_16x16x32_bf16 v[188:191], v[240:243], v[68:71], v[188:191]
    ds_read_b128 v[232:235], v4 offset:47104
    v_mul_f32 v213, v213, v10
    s_waitcnt lgkmcnt(3)
    v_mfma_f32_16x16x32_bf16 v[192:195], v[244:247], v[64:67], v[192:195]
    v_mul_f32 v214, v214, v10
    v_mfma_f32_16x16x32_bf16 v[196:199], v[244:247], v[68:71], v[196:199]
    ds_read_b128 v[236:239], v4 offset:48128
    v_mul_f32 v215, v215, v10
    s_waitcnt lgkmcnt(3)
    v_mfma_f32_16x16x32_bf16 v[184:187], v[224:227], v[72:75], v[184:187]
    v_cvt_pk_bf16_f32 v220, v204, v205
    v_mfma_f32_16x16x32_bf16 v[188:191], v[224:227], v[76:79], v[188:191]
    s_barrier
    ds_read_b128 v[240:243], v4 offset:49152
    v_cvt_pk_bf16_f32 v221, v206, v207
    s_waitcnt lgkmcnt(3)
    v_mfma_f32_16x16x32_bf16 v[192:195], v[228:231], v[72:75], v[192:195]
    v_cvt_pk_bf16_f32 v222, v212, v213
    v_mfma_f32_16x16x32_bf16 v[196:199], v[228:231], v[76:79], v[196:199]
    s_add_u32 s22, s24, 0x80000
    s_add_u32 m0, s20, 0x14000
    s_nop 0
    buffer_load_dwordx4 v3, s[4:7], s22 offen lds
    ds_read_b128 v[244:247], v4 offset:50176
    v_cvt_pk_bf16_f32 v223, v214, v215
    s_waitcnt lgkmcnt(3)
    v_mfma_f32_16x16x32_bf16 v[184:187], v[232:235], v[80:83], v[184:187]
    buffer_store_dwordx4 v[220:223], v2, s[8:11], s26 offen offset:1024 sc1
    v_mfma_f32_16x16x32_bf16 v[188:191], v[232:235], v[84:87], v[188:191]
    ds_read_b128 v[224:227], v4 offset:51200
    s_waitcnt lgkmcnt(3)
    v_mfma_f32_16x16x32_bf16 v[192:195], v[236:239], v[80:83], v[192:195]
    v_mfma_f32_16x16x32_bf16 v[196:199], v[236:239], v[84:87], v[196:199]
    ds_read_b128 v[228:231], v4 offset:52224
    s_waitcnt lgkmcnt(3)
    v_mfma_f32_16x16x32_bf16 v[184:187], v[240:243], v[88:91], v[184:187]
    v_mfma_f32_16x16x32_bf16 v[188:191], v[240:243], v[92:95], v[188:191]
    ds_read_b128 v[232:235], v4 offset:53248
    s_waitcnt lgkmcnt(3)
    v_mfma_f32_16x16x32_bf16 v[192:195], v[244:247], v[88:91], v[192:195]
    v_mfma_f32_16x16x32_bf16 v[196:199], v[244:247], v[92:95], v[196:199]
    s_add_u32 s22, s24, 0x82000
    s_add_u32 m0, s20, 0x14400
    s_nop 0
    buffer_load_dwordx4 v3, s[4:7], s22 offen lds
    ds_read_b128 v[236:239], v4 offset:54272
    s_waitcnt lgkmcnt(3)
    v_mfma_f32_16x16x32_bf16 v[184:187], v[224:227], v[96:99], v[184:187]
    v_mfma_f32_16x16x32_bf16 v[188:191], v[224:227], v[100:103], v[188:191]
    ds_read_b128 v[240:243], v4 offset:55296
    s_waitcnt lgkmcnt(3)
    v_mfma_f32_16x16x32_bf16 v[192:195], v[228:231], v[96:99], v[192:195]
    v_mfma_f32_16x16x32_bf16 v[196:199], v[228:231], v[100:103], v[196:199]
    ds_read_b128 v[244:247], v4 offset:56320
    s_waitcnt lgkmcnt(3)
    v_mfma_f32_16x16x32_bf16 v[184:187], v[232:235], v[104:107], v[184:187]
    v_mfma_f32_16x16x32_bf16 v[188:191], v[232:235], v[108:111], v[188:191]
    ds_read_b128 v[224:227], v4 offset:57344
    s_waitcnt lgkmcnt(3)
    v_mfma_f32_16x16x32_bf16 v[192:195], v[236:239], v[104:107], v[192:195]
    v_mfma_f32_16x16x32_bf16 v[196:199], v[236:239], v[108:111], v[196:199]
    ds_read_b128 v[228:231], v4 offset:58368
    s_waitcnt lgkmcnt(3)
    v_mfma_f32_16x16x32_bf16 v[184:187], v[240:243], v[112:115], v[184:187]
    v_mfma_f32_16x16x32_bf16 v[188:191], v[240:243], v[116:119], v[188:191]
    ds_read_b128 v[232:235], v4 offset:59392
    s_waitcnt lgkmcnt(3)
    v_mfma_f32_16x16x32_bf16 v[192:195], v[244:247], v[112:115], v[192:195]
    v_mfma_f32_16x16x32_bf16 v[196:199], v[244:247], v[116:119], v[196:199]
    ds_read_b128 v[236:239], v4 offset:60416
    s_waitcnt lgkmcnt(3)
    v_mfma_f32_16x16x32_bf16 v[184:187], v[224:227], v[120:123], v[184:187]
    v_mfma_f32_16x16x32_bf16 v[188:191], v[224:227], v[124:127], v[188:191]
    ds_read_b128 v[240:243], v4 offset:61440
    s_waitcnt lgkmcnt(3)
    v_mfma_f32_16x16x32_bf16 v[192:195], v[228:231], v[120:123], v[192:195]
    v_mfma_f32_16x16x32_bf16 v[196:199], v[228:231], v[124:127], v[196:199]
    ds_read_b128 v[244:247], v4 offset:62464
    s_waitcnt lgkmcnt(3)
    v_mfma_f32_16x16x32_bf16 v[184:187], v[232:235], v[128:131], v[184:187]
    v_mfma_f32_16x16x32_bf16 v[188:191], v[232:235], v[132:135], v[188:191]
    ds_read_b128 v[224:227], v4 offset:63488
    s_waitcnt lgkmcnt(3)
    v_mfma_f32_16x16x32_bf16 v[192:195], v[236:239], v[128:131], v[192:195]
    v_mfma_f32_16x16x32_bf16 v[196:199], v[236:239], v[132:135], v[196:199]
    ds_read_b128 v[228:231], v4 offset:64512
    s_waitcnt lgkmcnt(3)
    v_mfma_f32_16x16x32_bf16 v[184:187], v[240:243], v[136:139], v[184:187]
    v_mfma_f32_16x16x32_bf16 v[188:191], v[240:243], v[140:143], v[188:191]
    s_barrier
    ds_read_b128 v[232:235], v5 offset:0
    s_waitcnt lgkmcnt(3)
    v_mfma_f32_16x16x32_bf16 v[192:195], v[244:247], v[136:139], v[192:195]
    v_mfma_f32_16x16x32_bf16 v[196:199], v[244:247], v[140:143], v[196:199]
    s_add_u32 s22, s24, 0x100000
    s_add_u32 m0, s20, 0x18000
    s_nop 0
    buffer_load_dwordx4 v3, s[4:7], s22 offen lds
    ds_read_b128 v[236:239], v5 offset:1024
    s_waitcnt lgkmcnt(3)
    v_mfma_f32_16x16x32_bf16 v[184:187], v[224:227], v[144:147], v[184:187]
    v_mfma_f32_16x16x32_bf16 v[188:191], v[224:227], v[148:151], v[188:191]
    ds_read_b128 v[240:243], v5 offset:2048
    s_waitcnt lgkmcnt(3)
    v_mfma_f32_16x16x32_bf16 v[192:195], v[228:231], v[144:147], v[192:195]
    v_mfma_f32_16x16x32_bf16 v[196:199], v[228:231], v[148:151], v[196:199]
    ds_read_b128 v[244:247], v5 offset:3072
    s_waitcnt lgkmcnt(3)
    v_mfma_f32_16x16x32_bf16 v[200:203], v[232:235], v[24:27], 0
    v_mfma_f32_16x16x32_bf16 v[204:207], v[232:235], v[28:31], 0
    ds_read_b128 v[224:227], v5 offset:4096
    s_waitcnt lgkmcnt(3)
    v_mfma_f32_16x16x32_bf16 v[208:211], v[236:239], v[24:27], 0
    v_mfma_f32_16x16x32_bf16 v[212:215], v[236:239], v[28:31], 0
    s_add_u32 s22, s24, 0x102000
    s_add_u32 m0, s20, 0x18400
    s_nop 0
    buffer_load_dwordx4 v3, s[4:7], s22 offen lds
    ds_read_b128 v[228:231], v5 offset:5120
    v_mul_f32 v184, v184, v9
    s_waitcnt lgkmcnt(3)
    v_mfma_f32_16x16x32_bf16 v[200:203], v[240:243], v[32:35], v[200:203]
    v_mul_f32 v185, v185, v9
    s_bfe_u32 s30, s2, 0x20001
    s_lshl_b32 s30, s30, 2
    s_bfe_u32 s17, s2, 0x20003
    s_add_u32 s30, s30, s17
    s_lshr_b32 s31, s2, 5
    s_and_b32 s17, s3, 3
    s_lshl_b32 s19, s30, 2
    s_add_u32 s19, s19, s17
    s_and_b32 s16, s2, 1
    s_lshl_b32 s17, s19, 18
    s_lshl_b32 s23, s16, 16
    s_add_u32 s17, s17, s23
    s_add_u32 s17, s17, 0x1000000
    v_add_u32 v6, s17, v2
    s_lshl_b32 s19, s19, 7
    s_lshl_b32 s23, s16, 6
    s_add_u32 s19, s19, s23
    s_add_u32 s19, s19, 0x570000
    v_and_b32 v13, 15, v1
    v_lshlrev_b32 v13, 2, v13
    buffer_load_dword v12, v13, s[8:11], s19 offen sc1
    v_mfma_f32_16x16x32_bf16 v[204:207], v[240:243], v[36:39], v[204:207]
    ds_read_b128 v[232:235], v5 offset:6144
    v_mul_f32 v186, v186, v9
    s_waitcnt lgkmcnt(3)
    v_mfma_f32_16x16x32_bf16 v[208:211], v[244:247], v[32:35], v[208:211]
    v_mul_f32 v187, v187, v9
    v_mfma_f32_16x16x32_bf16 v[212:215], v[244:247], v[36:39], v[212:215]
    ds_read_b128 v[236:239], v5 offset:7168
    v_mul_f32 v192, v192, v9
    s_waitcnt lgkmcnt(3)
    v_mfma_f32_16x16x32_bf16 v[200:203], v[224:227], v[40:43], v[200:203]
    v_mul_f32 v193, v193, v9
    v_mfma_f32_16x16x32_bf16 v[204:207], v[224:227], v[44:47], v[204:207]
    ds_read_b128 v[240:243], v5 offset:8192
    v_mul_f32 v194, v194, v9
    s_waitcnt lgkmcnt(3)
    v_mfma_f32_16x16x32_bf16 v[208:211], v[228:231], v[40:43], v[208:211]
    v_mul_f32 v195, v195, v9
    v_mfma_f32_16x16x32_bf16 v[212:215], v[228:231], v[44:47], v[212:215]
    ds_read_b128 v[244:247], v5 offset:9216
    v_cvt_pk_bf16_f32 v216, v184, v185
    s_waitcnt lgkmcnt(3)
    v_mfma_f32_16x16x32_bf16 v[200:203], v[232:235], v[48:51], v[200:203]
    v_cvt_pk_bf16_f32 v217, v186, v187
    v_mfma_f32_16x16x32_bf16 v[204:207], v[232:235], v[52:55], v[204:207]
    ds_read_b128 v[224:227], v5 offset:10240
    v_cvt_pk_bf16_f32 v218, v192, v193
    s_waitcnt lgkmcnt(3)
    v_mfma_f32_16x16x32_bf16 v[208:211], v[236:239], v[48:51], v[208:211]
    v_cvt_pk_bf16_f32 v219, v194, v195
    v_mfma_f32_16x16x32_bf16 v[212:215], v[236:239], v[52:55], v[212:215]
    ds_read_b128 v[228:231], v5 offset:11264
    buffer_store_dwordx4 v[216:219], v2, s[8:11], s25 offen offset:2048 sc1
    s_waitcnt lgkmcnt(3)
    v_mfma_f32_16x16x32_bf16 v[200:203], v[240:243], v[56:59], v[200:203]
    v_mul_f32 v188, v188, v10
    v_mfma_f32_16x16x32_bf16 v[204:207], v[240:243], v[60:63], v[204:207]
    ds_read_b128 v[232:235], v5 offset:12288
    v_mul_f32 v189, v189, v10
    s_waitcnt lgkmcnt(3)
    v_mfma_f32_16x16x32_bf16 v[208:211], v[244:247], v[56:59], v[208:211]
    v_mul_f32 v190, v190, v10
    v_mfma_f32_16x16x32_bf16 v[212:215], v[244:247], v[60:63], v[212:215]
    ds_read_b128 v[236:239], v5 offset:13312
    v_mul_f32 v191, v191, v10
    s_waitcnt lgkmcnt(3)
    v_mfma_f32_16x16x32_bf16 v[200:203], v[224:227], v[64:67], v[200:203]
    v_mul_f32 v196, v196, v10
    v_mfma_f32_16x16x32_bf16 v[204:207], v[224:227], v[68:71], v[204:207]
    ds_read_b128 v[240:243], v5 offset:14336
    v_mul_f32 v197, v197, v10
    s_waitcnt lgkmcnt(3)
    v_mfma_f32_16x16x32_bf16 v[208:211], v[228:231], v[64:67], v[208:211]
    v_mul_f32 v198, v198, v10
    v_mfma_f32_16x16x32_bf16 v[212:215], v[228:231], v[68:71], v[212:215]
    ds_read_b128 v[244:247], v5 offset:15360
    v_mul_f32 v199, v199, v10
    s_waitcnt lgkmcnt(3)
    v_mfma_f32_16x16x32_bf16 v[200:203], v[232:235], v[72:75], v[200:203]
    v_cvt_pk_bf16_f32 v220, v188, v189
    v_mfma_f32_16x16x32_bf16 v[204:207], v[232:235], v[76:79], v[204:207]
    s_waitcnt vmcnt(12)
    s_barrier
    ds_read_b128 v[224:227], v5 offset:16384
    v_cvt_pk_bf16_f32 v221, v190, v191
    s_waitcnt lgkmcnt(3)
    v_mfma_f32_16x16x32_bf16 v[208:211], v[236:239], v[72:75], v[208:211]
    v_cvt_pk_bf16_f32 v222, v196, v197
    v_mfma_f32_16x16x32_bf16 v[212:215], v[236:239], v[76:79], v[212:215]
    s_add_u32 s22, s24, 0x180000
    s_add_u32 m0, s20, 0x1c000
    s_nop 0
    buffer_load_dwordx4 v3, s[4:7], s22 offen lds
    ds_read_b128 v[228:231], v5 offset:17408
    v_cvt_pk_bf16_f32 v223, v198, v199
    s_waitcnt lgkmcnt(3)
    v_mfma_f32_16x16x32_bf16 v[200:203], v[240:243], v[80:83], v[200:203]
    buffer_store_dwordx4 v[220:223], v2, s[8:11], s26 offen offset:2048 sc1
    v_mfma_f32_16x16x32_bf16 v[204:207], v[240:243], v[84:87], v[204:207]
    ds_read_b128 v[232:235], v5 offset:18432
    s_waitcnt lgkmcnt(3)
    v_mfma_f32_16x16x32_bf16 v[208:211], v[244:247], v[80:83], v[208:211]
    v_mfma_f32_16x16x32_bf16 v[212:215], v[244:247], v[84:87], v[212:215]
    ds_read_b128 v[236:239], v5 offset:19456
    s_waitcnt lgkmcnt(3)
    v_mfma_f32_16x16x32_bf16 v[200:203], v[224:227], v[88:91], v[200:203]
    v_mfma_f32_16x16x32_bf16 v[204:207], v[224:227], v[92:95], v[204:207]
    ds_read_b128 v[240:243], v5 offset:20480
    s_waitcnt vmcnt(3)
    v_cmp_ne_u32 vcc, s28, v12
    s_cbranch_vccnz adaLN_cond__sliding_block_cached__moe_arch_mod__prompt_kernel_o6r
adaLN_cond__sliding_block_cached__moe_arch_mod__prompt_kernel_o6b:
    s_waitcnt lgkmcnt(3)
    v_mfma_f32_16x16x32_bf16 v[208:211], v[228:231], v[88:91], v[208:211]
    s_mov_b32 s23, 0x0
    buffer_load_dwordx4 v[24:27], v6, s[8:11], s23 offen offset:0 sc1
    v_mfma_f32_16x16x32_bf16 v[212:215], v[228:231], v[92:95], v[212:215]
    s_add_u32 s22, s24, 0x182000
    s_add_u32 m0, s20, 0x1c400
    s_nop 0
    buffer_load_dwordx4 v3, s[4:7], s22 offen lds
    ds_read_b128 v[244:247], v5 offset:21504
    s_waitcnt lgkmcnt(3)
    v_mfma_f32_16x16x32_bf16 v[200:203], v[232:235], v[96:99], v[200:203]
    v_mfma_f32_16x16x32_bf16 v[204:207], v[232:235], v[100:103], v[204:207]
    ds_read_b128 v[224:227], v5 offset:22528
    s_mov_b32 s23, 0x20000
    buffer_load_dwordx4 v[28:31], v6, s[8:11], s23 offen offset:0 sc1
    s_waitcnt lgkmcnt(3)
    v_mfma_f32_16x16x32_bf16 v[208:211], v[236:239], v[96:99], v[208:211]
    s_add_u32 s16, s63, 0x572000
    v_mov_b32 v14, s28
    v_mov_b32 v15, 0
    s_mov_b64 exec, 1
    buffer_store_dword v14, v15, s[8:11], s16 offen sc1
    s_mov_b64 exec, -1
    v_mfma_f32_16x16x32_bf16 v[212:215], v[236:239], v[100:103], v[212:215]
    ds_read_b128 v[228:231], v5 offset:23552
    s_waitcnt lgkmcnt(3)
    v_mfma_f32_16x16x32_bf16 v[200:203], v[240:243], v[104:107], v[200:203]
    v_mfma_f32_16x16x32_bf16 v[204:207], v[240:243], v[108:111], v[204:207]
    ds_read_b128 v[232:235], v5 offset:24576
    s_mov_b32 s23, 0x2000
    buffer_load_dwordx4 v[32:35], v6, s[8:11], s23 offen offset:0 sc1
    s_waitcnt lgkmcnt(3)
    v_mfma_f32_16x16x32_bf16 v[208:211], v[244:247], v[104:107], v[208:211]
    v_mfma_f32_16x16x32_bf16 v[212:215], v[244:247], v[108:111], v[212:215]
    ds_read_b128 v[236:239], v5 offset:25600
    s_waitcnt lgkmcnt(3)
    v_mfma_f32_16x16x32_bf16 v[200:203], v[224:227], v[112:115], v[200:203]
    s_mov_b32 s23, 0x22000
    buffer_load_dwordx4 v[36:39], v6, s[8:11], s23 offen offset:0 sc1
    v_mfma_f32_16x16x32_bf16 v[204:207], v[224:227], v[116:119], v[204:207]
    ds_read_b128 v[240:243], v5 offset:26624
    s_waitcnt lgkmcnt(3)
    v_mfma_f32_16x16x32_bf16 v[208:211], v[228:231], v[112:115], v[208:211]
    v_mfma_f32_16x16x32_bf16 v[212:215], v[228:231], v[116:119], v[212:215]
    ds_read_b128 v[244:247], v5 offset:27648
    s_waitcnt lgkmcnt(3)
    v_mfma_f32_16x16x32_bf16 v[200:203], v[232:235], v[120:123], v[200:203]
    s_mov_b32 s23, 0x4000
    buffer_load_dwordx4 v[40:43], v6, s[8:11], s23 offen offset:0 sc1
    v_mfma_f32_16x16x32_bf16 v[204:207], v[232:235], v[124:127], v[204:207]
    ds_read_b128 v[224:227], v5 offset:28672
    s_waitcnt lgkmcnt(3)
    v_mfma_f32_16x16x32_bf16 v[208:211], v[236:239], v[120:123], v[208:211]
    v_mfma_f32_16x16x32_bf16 v[212:215], v[236:239], v[124:127], v[212:215]
    ds_read_b128 v[228:231], v5 offset:29696
    s_waitcnt lgkmcnt(3)
    v_mfma_f32_16x16x32_bf16 v[200:203], v[240:243], v[128:131], v[200:203]
    s_mov_b32 s23, 0x24000
    buffer_load_dwordx4 v[44:47], v6, s[8:11], s23 offen offset:0 sc1
    v_mfma_f32_16x16x32_bf16 v[204:207], v[240:243], v[132:135], v[204:207]
    ds_read_b128 v[232:235], v5 offset:30720
    s_waitcnt lgkmcnt(3)
    v_mfma_f32_16x16x32_bf16 v[208:211], v[244:247], v[128:131], v[208:211]
    v_mfma_f32_16x16x32_bf16 v[212:215], v[244:247], v[132:135], v[212:215]
    ds_read_b128 v[236:239], v5 offset:31744
    s_mov_b32 s23, 0x6000
    buffer_load_dwordx4 v[48:51], v6, s[8:11], s23 offen offset:0 sc1
    s_waitcnt lgkmcnt(3)
    v_mfma_f32_16x16x32_bf16 v[200:203], v[224:227], v[136:139], v[200:203]
    v_bfe_u32 v18, v1, 2, 2
    v_lshrrev_b32 v19, 4, v1
    v_mfma_f32_16x16x32_bf16 v[204:207], v[224:227], v[140:143], v[204:207]
    v_and_b32 v17, 3, v1
    v_lshlrev_b32 v16, 11, v19
    s_waitcnt lgkmcnt(2)
    v_mfma_f32_16x16x32_bf16 v[208:211], v[228:231], v[136:139], v[208:211]
    v_lshl_add_u32 v16, v18, 6, v16
    v_lshl_add_u32 v16, v17, 3, v16
    v_mfma_f32_16x16x32_bf16 v[212:215], v[228:231], v[140:143], v[212:215]
    s_mov_b32 s23, 0x26000
    buffer_load_dwordx4 v[52:55], v6, s[8:11], s23 offen offset:0 sc1
    v_add_u32 v16, 0x10000, v16
    v_and_b32 v19, 1, v19
    s_waitcnt lgkmcnt(1)
    v_mfma_f32_16x16x32_bf16 v[200:203], v[232:235], v[144:147], v[200:203]
    v_lshlrev_b32 v19, 5, v19
    v_sub_u32 v5, v16, v19
    v_mfma_f32_16x16x32_bf16 v[204:207], v[232:235], v[148:151], v[204:207]
    v_add_u32 v4, v16, v19
    v_add_u32 v7, 0x10000, v4
    s_waitcnt lgkmcnt(0)
    v_mfma_f32_16x16x32_bf16 v[208:211], v[236:239], v[144:147], v[208:211]
    v_add_u32 v8, 0x10000, v5
    v_mfma_f32_16x16x32_bf16 v[212:215], v[236:239], v[148:151], v[212:215]
    v_mul_f32 v200, v200, v9
    v_mul_f32 v201, v201, v9
    v_mul_f32 v202, v202, v9
    v_mul_f32 v203, v203, v9
    s_nop 1
    v_mul_f32 v208, v208, v9
    v_mul_f32 v209, v209, v9
    v_mul_f32 v210, v210, v9
    v_mul_f32 v211, v211, v9
    v_cvt_pk_bf16_f32 v216, v200, v201
    v_cvt_pk_bf16_f32 v217, v202, v203
    v_cvt_pk_bf16_f32 v218, v208, v209
    v_cvt_pk_bf16_f32 v219, v210, v211
    buffer_store_dwordx4 v[216:219], v2, s[8:11], s25 offen offset:3072 sc1
    v_mul_f32 v204, v204, v10
    v_mul_f32 v205, v205, v10
    v_mul_f32 v206, v206, v10
    v_mul_f32 v207, v207, v10
    v_mul_f32 v212, v212, v10
    v_mul_f32 v213, v213, v10
    v_mul_f32 v214, v214, v10
    v_mul_f32 v215, v215, v10
    v_cvt_pk_bf16_f32 v220, v204, v205
    v_cvt_pk_bf16_f32 v221, v206, v207
    v_cvt_pk_bf16_f32 v222, v212, v213
    v_cvt_pk_bf16_f32 v223, v214, v215
    buffer_store_dwordx4 v[220:223], v2, s[8:11], s26 offen offset:3072 sc1
    s_and_b32 s15, s2, 1
    s_barrier
    ds_read_b64_tr_b16 v[224:225], v4 offset:0
    ds_read_b64_tr_b16 v[226:227], v4 offset:1024
    ds_read_b64_tr_b16 v[228:229], v5 offset:32
    ds_read_b64_tr_b16 v[230:231], v5 offset:1056
    ds_read_b64_tr_b16 v[232:233], v4 offset:256
    ds_read_b64_tr_b16 v[234:235], v4 offset:1280
    ds_read_b64_tr_b16 v[236:237], v5 offset:288
    ds_read_b64_tr_b16 v[238:239], v5 offset:1312
    s_waitcnt vmcnt(11) lgkmcnt(6)
    v_mfma_f32_16x16x32_bf16 v[88:91], v[224:227], v[24:27], 0
    ds_read_b64_tr_b16 v[240:241], v4 offset:512
    s_waitcnt vmcnt(9)
    v_mfma_f32_16x16x32_bf16 v[92:95], v[224:227], v[28:31], 0
    s_add_u32 s22, s24, 0x200000
    s_add_u32 m0, s20, 0x20000
    s_nop 0
    buffer_load_dwordx4 v3, s[4:7], s22 offen lds
    ds_read_b64_tr_b16 v[242:243], v4 offset:1536
    s_waitcnt lgkmcnt(6)
    v_mfma_f32_16x16x32_bf16 v[96:99], v[228:231], v[24:27], 0
    ds_read_b64_tr_b16 v[244:245], v5 offset:544
    s_mov_b32 s23, 0x8000
    buffer_load_dwordx4 v[56:59], v6, s[8:11], s23 offen offset:0 sc1
    v_mfma_f32_16x16x32_bf16 v[100:103], v[228:231], v[28:31], 0
    ds_read_b64_tr_b16 v[246:247], v5 offset:1568
    s_waitcnt lgkmcnt(6)
    v_mfma_f32_16x16x32_bf16 v[104:107], v[232:235], v[24:27], 0
    s_add_u32 s22, s24, 0x202000
    s_add_u32 m0, s20, 0x20400
    s_nop 0
    buffer_load_dwordx4 v3, s[4:7], s22 offen lds
    ds_read_b64_tr_b16 v[224:225], v4 offset:768
    v_mfma_f32_16x16x32_bf16 v[108:111], v[232:235], v[28:31], 0
    ds_read_b64_tr_b16 v[226:227], v4 offset:1792
    s_mov_b32 s23, 0x28000
    buffer_load_dwordx4 v[60:63], v6, s[8:11], s23 offen offset:0 sc1
    s_waitcnt lgkmcnt(6)
    v_mfma_f32_16x16x32_bf16 v[112:115], v[236:239], v[24:27], 0
    ds_read_b64_tr_b16 v[228:229], v5 offset:800
    v_mfma_f32_16x16x32_bf16 v[116:119], v[236:239], v[28:31], 0
    ds_read_b64_tr_b16 v[230:231], v5 offset:1824
    s_waitcnt lgkmcnt(6)
    v_mfma_f32_16x16x32_bf16 v[120:123], v[240:243], v[24:27], 0
    v_mfma_f32_16x16x32_bf16 v[124:127], v[240:243], v[28:31], 0
    s_barrier
    ds_read_b64_tr_b16 v[232:233], v4 offset:16384
    ds_read_b64_tr_b16 v[234:235], v4 offset:17408
    s_waitcnt lgkmcnt(6)
    v_mfma_f32_16x16x32_bf16 v[128:131], v[244:247], v[24:27], 0
    s_add_u32 s22, s24, 0x280000
    s_add_u32 m0, s20, 0x24000
    s_nop 0
    buffer_load_dwordx4 v3, s[4:7], s22 offen lds
    ds_read_b64_tr_b16 v[236:237], v5 offset:16416
    v_mfma_f32_16x16x32_bf16 v[132:135], v[244:247], v[28:31], 0
    ds_read_b64_tr_b16 v[238:239], v5 offset:17440
    s_waitcnt lgkmcnt(6)
    v_mfma_f32_16x16x32_bf16 v[136:139], v[224:227], v[24:27], 0
    ds_read_b64_tr_b16 v[240:241], v4 offset:16640
    v_mfma_f32_16x16x32_bf16 v[140:143], v[224:227], v[28:31], 0
    s_add_u32 s22, s24, 0x282000
    s_add_u32 m0, s20, 0x24400
    s_nop 0
    buffer_load_dwordx4 v3, s[4:7], s22 offen lds
    ds_read_b64_tr_b16 v[242:243], v4 offset:17664
    s_waitcnt lgkmcnt(6)
    v_mfma_f32_16x16x32_bf16 v[144:147], v[228:231], v[24:27], 0
    ds_read_b64_tr_b16 v[244:245], v5 offset:16672
    v_mfma_f32_16x16x32_bf16 v[148:151], v[228:231], v[28:31], 0
    ds_read_b64_tr_b16 v[246:247], v5 offset:17696
    s_waitcnt vmcnt(13) lgkmcnt(6)
    v_mfma_f32_16x16x32_bf16 v[88:91], v[232:235], v[32:35], v[88:91]
    ds_read_b64_tr_b16 v[224:225], v4 offset:16896
    s_waitcnt vmcnt(12)
    v_mfma_f32_16x16x32_bf16 v[92:95], v[232:235], v[36:39], v[92:95]
    ds_read_b64_tr_b16 v[226:227], v4 offset:17920
    s_waitcnt lgkmcnt(6)
    v_mfma_f32_16x16x32_bf16 v[96:99], v[236:239], v[32:35], v[96:99]
    ds_read_b64_tr_b16 v[228:229], v5 offset:16928
    s_mov_b32 s23, 0xa000
    buffer_load_dwordx4 v[24:27], v6, s[8:11], s23 offen offset:0 sc1
    v_mfma_f32_16x16x32_bf16 v[100:103], v[236:239], v[36:39], v[100:103]
    ds_read_b64_tr_b16 v[230:231], v5 offset:17952
    s_waitcnt lgkmcnt(6)
    v_mfma_f32_16x16x32_bf16 v[104:107], v[240:243], v[32:35], v[104:107]
    ds_read_b64_tr_b16 v[232:233], v4 offset:17152
    v_mfma_f32_16x16x32_bf16 v[108:111], v[240:243], v[36:39], v[108:111]
    ds_read_b64_tr_b16 v[234:235], v4 offset:18176
    s_mov_b32 s23, 0x2a000
    buffer_load_dwordx4 v[28:31], v6, s[8:11], s23 offen offset:0 sc1
    s_waitcnt lgkmcnt(6)
    v_mfma_f32_16x16x32_bf16 v[112:115], v[244:247], v[32:35], v[112:115]
    ds_read_b64_tr_b16 v[236:237], v5 offset:17184
    v_mfma_f32_16x16x32_bf16 v[116:119], v[244:247], v[36:39], v[116:119]
    ds_read_b64_tr_b16 v[238:239], v5 offset:18208
    s_waitcnt lgkmcnt(6)
    v_mfma_f32_16x16x32_bf16 v[120:123], v[224:227], v[32:35], v[120:123]
    v_mfma_f32_16x16x32_bf16 v[124:127], v[224:227], v[36:39], v[124:127]
    s_barrier
    ds_read_b64_tr_b16 v[240:241], v4 offset:32768
    ds_read_b64_tr_b16 v[242:243], v4 offset:33792
    s_waitcnt lgkmcnt(6)
    v_mfma_f32_16x16x32_bf16 v[128:131], v[228:231], v[32:35], v[128:131]
    s_add_u32 s22, s24, 0x300000
    s_add_u32 m0, s20, 0x10000
    s_nop 0
    buffer_load_dwordx4 v3, s[4:7], s22 offen lds
    ds_read_b64_tr_b16 v[244:245], v5 offset:32800
    v_mfma_f32_16x16x32_bf16 v[132:135], v[228:231], v[36:39], v[132:135]
    ds_read_b64_tr_b16 v[246:247], v5 offset:33824
    s_waitcnt lgkmcnt(6)
    v_mfma_f32_16x16x32_bf16 v[136:139], v[232:235], v[32:35], v[136:139]
    ds_read_b64_tr_b16 v[224:225], v4 offset:33024
    v_mfma_f32_16x16x32_bf16 v[140:143], v[232:235], v[36:39], v[140:143]
    s_add_u32 s22, s24, 0x302000
    s_add_u32 m0, s20, 0x10400
    s_nop 0
    buffer_load_dwordx4 v3, s[4:7], s22 offen lds
    ds_read_b64_tr_b16 v[226:227], v4 offset:34048
    s_waitcnt lgkmcnt(6)
    v_mfma_f32_16x16x32_bf16 v[144:147], v[236:239], v[32:35], v[144:147]
    s_add_u32 s16, s63, 0x574000
    v_mov_b32 v14, s28
    v_mov_b32 v15, 0
    s_mov_b64 exec, 1
    buffer_store_dword v14, v15, s[8:11], s16 offen sc1
    s_mov_b64 exec, -1
    ds_read_b64_tr_b16 v[228:229], v5 offset:33056
    v_mfma_f32_16x16x32_bf16 v[148:151], v[236:239], v[36:39], v[148:151]
    ds_read_b64_tr_b16 v[230:231], v5 offset:34080
    s_waitcnt vmcnt(16) lgkmcnt(6)
    v_mfma_f32_16x16x32_bf16 v[88:91], v[240:243], v[40:43], v[88:91]
    ds_read_b64_tr_b16 v[232:233], v4 offset:33280
    s_waitcnt vmcnt(15)
    v_mfma_f32_16x16x32_bf16 v[92:95], v[240:243], v[44:47], v[92:95]
    ds_read_b64_tr_b16 v[234:235], v4 offset:34304
    s_waitcnt lgkmcnt(6)
    v_mfma_f32_16x16x32_bf16 v[96:99], v[244:247], v[40:43], v[96:99]
    ds_read_b64_tr_b16 v[236:237], v5 offset:33312
    s_mov_b32 s23, 0xc000
    buffer_load_dwordx4 v[32:35], v6, s[8:11], s23 offen offset:0 sc1
    v_mfma_f32_16x16x32_bf16 v[100:103], v[244:247], v[44:47], v[100:103]
    ds_read_b64_tr_b16 v[238:239], v5 offset:34336
    s_waitcnt lgkmcnt(6)
    v_mfma_f32_16x16x32_bf16 v[104:107], v[224:227], v[40:43], v[104:107]
    ds_read_b64_tr_b16 v[240:241], v4 offset:33536
    v_mfma_f32_16x16x32_bf16 v[108:111], v[224:227], v[44:47], v[108:111]
    ds_read_b64_tr_b16 v[242:243], v4 offset:34560
    s_mov_b32 s23, 0x2c000
    buffer_load_dwordx4 v[36:39], v6, s[8:11], s23 offen offset:0 sc1
    s_waitcnt lgkmcnt(6)
    v_mfma_f32_16x16x32_bf16 v[112:115], v[228:231], v[40:43], v[112:115]
    ds_read_b64_tr_b16 v[244:245], v5 offset:33568
    v_mfma_f32_16x16x32_bf16 v[116:119], v[228:231], v[44:47], v[116:119]
    ds_read_b64_tr_b16 v[246:247], v5 offset:34592
    s_waitcnt lgkmcnt(6)
    v_mfma_f32_16x16x32_bf16 v[120:123], v[232:235], v[40:43], v[120:123]
    v_mfma_f32_16x16x32_bf16 v[124:127], v[232:235], v[44:47], v[124:127]
    s_barrier
    ds_read_b64_tr_b16 v[224:225], v4 offset:49152
    ds_read_b64_tr_b16 v[226:227], v4 offset:50176
    s_add_u32 s19, s19, 8192
    buffer_load_dword v12, v13, s[8:11], s19 offen sc1
    s_waitcnt lgkmcnt(6)
    v_mfma_f32_16x16x32_bf16 v[128:131], v[236:239], v[40:43], v[128:131]
    s_add_u32 s22, s24, 0x380000
    s_add_u32 m0, s20, 0x14000
    s_nop 0
    buffer_load_dwordx4 v3, s[4:7], s22 offen lds
    ds_read_b64_tr_b16 v[228:229], v5 offset:49184
    v_mfma_f32_16x16x32_bf16 v[132:135], v[236:239], v[44:47], v[132:135]
    ds_read_b64_tr_b16 v[230:231], v5 offset:50208
    s_waitcnt lgkmcnt(6)
    v_mfma_f32_16x16x32_bf16 v[136:139], v[240:243], v[40:43], v[136:139]
    ds_read_b64_tr_b16 v[232:233], v4 offset:49408
    v_mfma_f32_16x16x32_bf16 v[140:143], v[240:243], v[44:47], v[140:143]
    s_add_u32 s22, s24, 0x382000
    s_add_u32 m0, s20, 0x14400
    s_nop 0
    buffer_load_dwordx4 v3, s[4:7], s22 offen lds
    ds_read_b64_tr_b16 v[234:235], v4 offset:50432
    s_waitcnt lgkmcnt(6)
    v_mfma_f32_16x16x32_bf16 v[144:147], v[244:247], v[40:43], v[144:147]
    ds_read_b64_tr_b16 v[236:237], v5 offset:49440
    v_mfma_f32_16x16x32_bf16 v[148:151], v[244:247], v[44:47], v[148:151]
    ds_read_b64_tr_b16 v[238:239], v5 offset:50464
    s_waitcnt vmcnt(19) lgkmcnt(6)
    v_mfma_f32_16x16x32_bf16 v[88:91], v[224:227], v[48:51], v[88:91]
    ds_read_b64_tr_b16 v[240:241], v4 offset:49664
    s_waitcnt vmcnt(18)
    v_mfma_f32_16x16x32_bf16 v[92:95], v[224:227], v[52:55], v[92:95]
    ds_read_b64_tr_b16 v[242:243], v4 offset:50688
    s_waitcnt lgkmcnt(6)
    v_mfma_f32_16x16x32_bf16 v[96:99], v[228:231], v[48:51], v[96:99]
    ds_read_b64_tr_b16 v[244:245], v5 offset:49696
    s_mov_b32 s23, 0xe000
    buffer_load_dwordx4 v[40:43], v6, s[8:11], s23 offen offset:0 sc1
    v_mfma_f32_16x16x32_bf16 v[100:103], v[228:231], v[52:55], v[100:103]
    ds_read_b64_tr_b16 v[246:247], v5 offset:50720
    s_waitcnt lgkmcnt(6)
    v_mfma_f32_16x16x32_bf16 v[104:107], v[232:235], v[48:51], v[104:107]
    ds_read_b64_tr_b16 v[224:225], v4 offset:49920
    v_mfma_f32_16x16x32_bf16 v[108:111], v[232:235], v[52:55], v[108:111]
    ds_read_b64_tr_b16 v[226:227], v4 offset:50944
    s_mov_b32 s23, 0x2e000
    buffer_load_dwordx4 v[44:47], v6, s[8:11], s23 offen offset:0 sc1
    s_waitcnt lgkmcnt(6)
    v_mfma_f32_16x16x32_bf16 v[112:115], v[236:239], v[48:51], v[112:115]
    ds_read_b64_tr_b16 v[228:229], v5 offset:49952
    v_mfma_f32_16x16x32_bf16 v[116:119], v[236:239], v[52:55], v[116:119]
    ds_read_b64_tr_b16 v[230:231], v5 offset:50976
    s_waitcnt lgkmcnt(6)
    v_mfma_f32_16x16x32_bf16 v[120:123], v[240:243], v[48:51], v[120:123]
    v_mfma_f32_16x16x32_bf16 v[124:127], v[240:243], v[52:55], v[124:127]
    s_waitcnt vmcnt(15)
    s_barrier
    ds_read_b64_tr_b16 v[232:233], v7 offset:0
    ds_read_b64_tr_b16 v[234:235], v7 offset:1024
    s_waitcnt lgkmcnt(6)
    v_mfma_f32_16x16x32_bf16 v[128:131], v[244:247], v[48:51], v[128:131]
    s_add_u32 s22, s24, 0x10000
    s_add_u32 m0, s20, 0x18000
    s_nop 0
    buffer_load_dwordx4 v3, s[4:7], s22 offen lds
    ds_read_b64_tr_b16 v[236:237], v8 offset:32
    v_mfma_f32_16x16x32_bf16 v[132:135], v[244:247], v[52:55], v[132:135]
    ds_read_b64_tr_b16 v[238:239], v8 offset:1056
    s_waitcnt lgkmcnt(6)
    v_mfma_f32_16x16x32_bf16 v[136:139], v[224:227], v[48:51], v[136:139]
    ds_read_b64_tr_b16 v[240:241], v7 offset:256
    v_mfma_f32_16x16x32_bf16 v[140:143], v[224:227], v[52:55], v[140:143]
    s_add_u32 s22, s24, 0x12000
    s_add_u32 m0, s20, 0x18400
    s_nop 0
    buffer_load_dwordx4 v3, s[4:7], s22 offen lds
    ds_read_b64_tr_b16 v[242:243], v7 offset:1280
    s_waitcnt lgkmcnt(6)
    v_mfma_f32_16x16x32_bf16 v[144:147], v[228:231], v[48:51], v[144:147]
    ds_read_b64_tr_b16 v[244:245], v8 offset:288
    v_mfma_f32_16x16x32_bf16 v[148:151], v[228:231], v[52:55], v[148:151]
    ds_read_b64_tr_b16 v[246:247], v8 offset:1312
    s_waitcnt vmcnt(6)
    v_cmp_ne_u32 vcc, s28, v12
    s_cbranch_vccnz adaLN_cond__sliding_block_cached__moe_arch_mod__prompt_kernel_o27r
adaLN_cond__sliding_block_cached__moe_arch_mod__prompt_kernel_o27b:
    s_waitcnt lgkmcnt(6)
    v_mfma_f32_16x16x32_bf16 v[88:91], v[232:235], v[56:59], v[88:91]
    ds_read_b64_tr_b16 v[224:225], v7 offset:512
    v_mfma_f32_16x16x32_bf16 v[92:95], v[232:235], v[60:63], v[92:95]
    ds_read_b64_tr_b16 v[226:227], v7 offset:1536
    s_waitcnt lgkmcnt(6)
    v_mfma_f32_16x16x32_bf16 v[96:99], v[236:239], v[56:59], v[96:99]
    ds_read_b64_tr_b16 v[228:229], v8 offset:544
    s_mov_b32 s23, 0x0
    buffer_load_dwordx4 v[48:51], v6, s[8:11], s23 offen offset:1024 sc1
    v_mfma_f32_16x16x32_bf16 v[100:103], v[236:239], v[60:63], v[100:103]
    ds_read_b64_tr_b16 v[230:231], v8 offset:1568
    s_waitcnt lgkmcnt(6)
    v_mfma_f32_16x16x32_bf16 v[104:107], v[240:243], v[56:59], v[104:107]
    ds_read_b64_tr_b16 v[232:233], v7 offset:768
    v_mfma_f32_16x16x32_bf16 v[108:111], v[240:243], v[60:63], v[108:111]
    ds_read_b64_tr_b16 v[234:235], v7 offset:1792
    s_mov_b32 s23, 0x20000
    buffer_load_dwordx4 v[52:55], v6, s[8:11], s23 offen offset:1024 sc1
    s_waitcnt lgkmcnt(6)
    v_mfma_f32_16x16x32_bf16 v[112:115], v[244:247], v[56:59], v[112:115]
    ds_read_b64_tr_b16 v[236:237], v8 offset:800
    v_mfma_f32_16x16x32_bf16 v[116:119], v[244:247], v[60:63], v[116:119]
    ds_read_b64_tr_b16 v[238:239], v8 offset:1824
    s_waitcnt lgkmcnt(6)
    v_mfma_f32_16x16x32_bf16 v[120:123], v[224:227], v[56:59], v[120:123]
    v_mfma_f32_16x16x32_bf16 v[124:127], v[224:227], v[60:63], v[124:127]
    s_barrier
    ds_read_b64_tr_b16 v[240:241], v7 offset:16384
    ds_read_b64_tr_b16 v[242:243], v7 offset:17408
    s_waitcnt lgkmcnt(6)
    v_mfma_f32_16x16x32_bf16 v[128:131], v[228:231], v[56:59], v[128:131]
    s_add_u32 s22, s24, 0x90000
    s_add_u32 m0, s20, 0x1c000
    s_nop 0
    buffer_load_dwordx4 v3, s[4:7], s22 offen lds
    ds_read_b64_tr_b16 v[244:245], v8 offset:16416
    v_mfma_f32_16x16x32_bf16 v[132:135], v[228:231], v[60:63], v[132:135]
    ds_read_b64_tr_b16 v[246:247], v8 offset:17440
    s_waitcnt lgkmcnt(6)
    v_mfma_f32_16x16x32_bf16 v[136:139], v[232:235], v[56:59], v[136:139]
    ds_read_b64_tr_b16 v[224:225], v7 offset:16640
    v_mfma_f32_16x16x32_bf16 v[140:143], v[232:235], v[60:63], v[140:143]
    s_add_u32 s22, s24, 0x92000
    s_add_u32 m0, s20, 0x1c400
    s_nop 0
    buffer_load_dwordx4 v3, s[4:7], s22 offen lds
    ds_read_b64_tr_b16 v[226:227], v7 offset:17664
    s_waitcnt lgkmcnt(6)
    v_mfma_f32_16x16x32_bf16 v[144:147], v[236:239], v[56:59], v[144:147]
    ds_read_b64_tr_b16 v[228:229], v8 offset:16672
    v_mfma_f32_16x16x32_bf16 v[148:151], v[236:239], v[60:63], v[148:151]
    ds_read_b64_tr_b16 v[230:231], v8 offset:17696
    s_waitcnt lgkmcnt(6)
    v_mfma_f32_16x16x32_bf16 v[88:91], v[240:243], v[24:27], v[88:91]
    ds_read_b64_tr_b16 v[232:233], v7 offset:16896
    v_mfma_f32_16x16x32_bf16 v[92:95], v[240:243], v[28:31], v[92:95]
    ds_read_b64_tr_b16 v[234:235], v7 offset:17920
    s_waitcnt lgkmcnt(6)
    v_mfma_f32_16x16x32_bf16 v[96:99], v[244:247], v[24:27], v[96:99]
    ds_read_b64_tr_b16 v[236:237], v8 offset:16928
    s_mov_b32 s23, 0x2000
    buffer_load_dwordx4 v[56:59], v6, s[8:11], s23 offen offset:1024 sc1
    v_mfma_f32_16x16x32_bf16 v[100:103], v[244:247], v[28:31], v[100:103]
    ds_read_b64_tr_b16 v[238:239], v8 offset:17952
    s_waitcnt lgkmcnt(6)
    v_mfma_f32_16x16x32_bf16 v[104:107], v[224:227], v[24:27], v[104:107]
    ds_read_b64_tr_b16 v[240:241], v7 offset:17152
    v_mfma_f32_16x16x32_bf16 v[108:111], v[224:227], v[28:31], v[108:111]
    ds_read_b64_tr_b16 v[242:243], v7 offset:18176
    s_mov_b32 s23, 0x22000
    buffer_load_dwordx4 v[60:63], v6, s[8:11], s23 offen offset:1024 sc1
    s_waitcnt lgkmcnt(6)
    v_mfma_f32_16x16x32_bf16 v[112:115], v[228:231], v[24:27], v[112:115]
    ds_read_b64_tr_b16 v[244:245], v8 offset:17184
    v_mfma_f32_16x16x32_bf16 v[116:119], v[228:231], v[28:31], v[116:119]
    ds_read_b64_tr_b16 v[246:247], v8 offset:18208
    s_waitcnt lgkmcnt(6)
    v_mfma_f32_16x16x32_bf16 v[120:123], v[232:235], v[24:27], v[120:123]
    v_mfma_f32_16x16x32_bf16 v[124:127], v[232:235], v[28:31], v[124:127]
    s_barrier
    ds_read_b64_tr_b16 v[224:225], v4 offset:0
    ds_read_b64_tr_b16 v[226:227], v4 offset:1024
    s_waitcnt lgkmcnt(6)
    v_mfma_f32_16x16x32_bf16 v[128:131], v[236:239], v[24:27], v[128:131]
    s_add_u32 s16, s63, 0x576000
    v_mov_b32 v14, s28
    v_mov_b32 v15, 0
    s_mov_b64 exec, 1
    buffer_store_dword v14, v15, s[8:11], s16 offen sc1
    s_mov_b64 exec, -1
    s_add_u32 s22, s24, 0x110000
    s_add_u32 m0, s20, 0x20000
    s_nop 0
    buffer_load_dwordx4 v3, s[4:7], s22 offen lds
    ds_read_b64_tr_b16 v[228:229], v5 offset:32
    v_mfma_f32_16x16x32_bf16 v[132:135], v[236:239], v[28:31], v[132:135]
    ds_read_b64_tr_b16 v[230:231], v5 offset:1056
    s_waitcnt lgkmcnt(6)
    v_mfma_f32_16x16x32_bf16 v[136:139], v[240:243], v[24:27], v[136:139]
    ds_read_b64_tr_b16 v[232:233], v4 offset:256
    v_mfma_f32_16x16x32_bf16 v[140:143], v[240:243], v[28:31], v[140:143]
    s_add_u32 s22, s24, 0x112000
    s_add_u32 m0, s20, 0x20400
    s_nop 0
    buffer_load_dwordx4 v3, s[4:7], s22 offen lds
    ds_read_b64_tr_b16 v[234:235], v4 offset:1280
    s_waitcnt lgkmcnt(6)
    v_mfma_f32_16x16x32_bf16 v[144:147], v[244:247], v[24:27], v[144:147]
    ds_read_b64_tr_b16 v[236:237], v5 offset:288
    v_mfma_f32_16x16x32_bf16 v[148:151], v[244:247], v[28:31], v[148:151]
    ds_read_b64_tr_b16 v[238:239], v5 offset:1312
    s_waitcnt lgkmcnt(6)
    v_mfma_f32_16x16x32_bf16 v[88:91], v[224:227], v[32:35], v[88:91]
    ds_read_b64_tr_b16 v[240:241], v4 offset:512
    v_mfma_f32_16x16x32_bf16 v[92:95], v[224:227], v[36:39], v[92:95]
    ds_read_b64_tr_b16 v[242:243], v4 offset:1536
    s_waitcnt lgkmcnt(6)
    v_mfma_f32_16x16x32_bf16 v[96:99], v[228:231], v[32:35], v[96:99]
    ds_read_b64_tr_b16 v[244:245], v5 offset:544
    s_mov_b32 s23, 0x4000
    buffer_load_dwordx4 v[24:27], v6, s[8:11], s23 offen offset:1024 sc1
    v_mfma_f32_16x16x32_bf16 v[100:103], v[228:231], v[36:39], v[100:103]
    ds_read_b64_tr_b16 v[246:247], v5 offset:1568
    s_waitcnt lgkmcnt(6)
    v_mfma_f32_16x16x32_bf16 v[104:107], v[232:235], v[32:35], v[104:107]
    ds_read_b64_tr_b16 v[224:225], v4 offset:768
    v_mfma_f32_16x16x32_bf16 v[108:111], v[232:235], v[36:39], v[108:111]
    ds_read_b64_tr_b16 v[226:227], v4 offset:1792
    s_mov_b32 s23, 0x24000
    buffer_load_dwordx4 v[28:31], v6, s[8:11], s23 offen offset:1024 sc1
    s_waitcnt lgkmcnt(6)
    v_mfma_f32_16x16x32_bf16 v[112:115], v[236:239], v[32:35], v[112:115]
    ds_read_b64_tr_b16 v[228:229], v5 offset:800
    v_mfma_f32_16x16x32_bf16 v[116:119], v[236:239], v[36:39], v[116:119]
    ds_read_b64_tr_b16 v[230:231], v5 offset:1824
    s_waitcnt lgkmcnt(6)
    v_mfma_f32_16x16x32_bf16 v[120:123], v[240:243], v[32:35], v[120:123]
    v_mfma_f32_16x16x32_bf16 v[124:127], v[240:243], v[36:39], v[124:127]
    s_waitcnt vmcnt(15)
    s_barrier
    ds_read_b64_tr_b16 v[232:233], v4 offset:16384
    ds_read_b64_tr_b16 v[234:235], v4 offset:17408
    s_waitcnt lgkmcnt(6)
    v_mfma_f32_16x16x32_bf16 v[128:131], v[244:247], v[32:35], v[128:131]
    s_add_u32 s22, s24, 0x190000
    s_add_u32 m0, s20, 0x24000
    s_nop 0
    buffer_load_dwordx4 v3, s[4:7], s22 offen lds
    ds_read_b64_tr_b16 v[236:237], v5 offset:16416
    v_mfma_f32_16x16x32_bf16 v[132:135], v[244:247], v[36:39], v[132:135]
    ds_read_b64_tr_b16 v[238:239], v5 offset:17440
    s_waitcnt lgkmcnt(6)
    v_mfma_f32_16x16x32_bf16 v[136:139], v[224:227], v[32:35], v[136:139]
    ds_read_b64_tr_b16 v[240:241], v4 offset:16640
    v_mfma_f32_16x16x32_bf16 v[140:143], v[224:227], v[36:39], v[140:143]
    s_add_u32 s22, s24, 0x192000
    s_add_u32 m0, s20, 0x24400
    s_nop 0
    buffer_load_dwordx4 v3, s[4:7], s22 offen lds
    ds_read_b64_tr_b16 v[242:243], v4 offset:17664
    s_waitcnt lgkmcnt(6)
    v_mfma_f32_16x16x32_bf16 v[144:147], v[228:231], v[32:35], v[144:147]
    ds_read_b64_tr_b16 v[244:245], v5 offset:16672
    v_mfma_f32_16x16x32_bf16 v[148:151], v[228:231], v[36:39], v[148:151]
    ds_read_b64_tr_b16 v[246:247], v5 offset:17696
    s_waitcnt vmcnt(16) lgkmcnt(6)
    v_mfma_f32_16x16x32_bf16 v[88:91], v[232:235], v[40:43], v[88:91]
    ds_read_b64_tr_b16 v[224:225], v4 offset:16896
    s_waitcnt vmcnt(15)
    v_mfma_f32_16x16x32_bf16 v[92:95], v[232:235], v[44:47], v[92:95]
    ds_read_b64_tr_b16 v[226:227], v4 offset:17920
    s_waitcnt lgkmcnt(6)
    v_mfma_f32_16x16x32_bf16 v[96:99], v[236:239], v[40:43], v[96:99]
    ds_read_b64_tr_b16 v[228:229], v5 offset:16928
    s_mov_b32 s23, 0x6000
    buffer_load_dwordx4 v[32:35], v6, s[8:11], s23 offen offset:1024 sc1
    v_mfma_f32_16x16x32_bf16 v[100:103], v[236:239], v[44:47], v[100:103]
    ds_read_b64_tr_b16 v[230:231], v5 offset:17952
    s_waitcnt lgkmcnt(6)
    v_mfma_f32_16x16x32_bf16 v[104:107], v[240:243], v[40:43], v[104:107]
    ds_read_b64_tr_b16 v[232:233], v4 offset:17152
    v_mfma_f32_16x16x32_bf16 v[108:111], v[240:243], v[44:47], v[108:111]
    ds_read_b64_tr_b16 v[234:235], v4 offset:18176
    s_mov_b32 s23, 0x26000
    buffer_load_dwordx4 v[36:39], v6, s[8:11], s23 offen offset:1024 sc1
    s_waitcnt lgkmcnt(6)
    v_mfma_f32_16x16x32_bf16 v[112:115], v[244:247], v[40:43], v[112:115]
    ds_read_b64_tr_b16 v[236:237], v5 offset:17184
    v_mfma_f32_16x16x32_bf16 v[116:119], v[244:247], v[44:47], v[116:119]
    ds_read_b64_tr_b16 v[238:239], v5 offset:18208
    s_waitcnt lgkmcnt(6)
    v_mfma_f32_16x16x32_bf16 v[120:123], v[224:227], v[40:43], v[120:123]
    v_mfma_f32_16x16x32_bf16 v[124:127], v[224:227], v[44:47], v[124:127]
    s_waitcnt vmcnt(15)
    s_barrier
    ds_read_b64_tr_b16 v[240:241], v4 offset:32768
    ds_read_b64_tr_b16 v[242:243], v4 offset:33792
    s_waitcnt lgkmcnt(6)
    v_mfma_f32_16x16x32_bf16 v[128:131], v[228:231], v[40:43], v[128:131]
    s_add_u32 s22, s24, 0x210000
    s_add_u32 m0, s20, 0x10000
    s_nop 0
    buffer_load_dwordx4 v3, s[4:7], s22 offen lds
    ds_read_b64_tr_b16 v[244:245], v5 offset:32800
    v_mfma_f32_16x16x32_bf16 v[132:135], v[228:231], v[44:47], v[132:135]
    ds_read_b64_tr_b16 v[246:247], v5 offset:33824
    s_waitcnt lgkmcnt(6)
    v_mfma_f32_16x16x32_bf16 v[136:139], v[232:235], v[40:43], v[136:139]
    ds_read_b64_tr_b16 v[224:225], v4 offset:33024
    v_mfma_f32_16x16x32_bf16 v[140:143], v[232:235], v[44:47], v[140:143]
    s_add_u32 s22, s24, 0x212000
    s_add_u32 m0, s20, 0x10400
    s_nop 0
    buffer_load_dwordx4 v3, s[4:7], s22 offen lds
    ds_read_b64_tr_b16 v[226:227], v4 offset:34048
    s_waitcnt lgkmcnt(6)
    v_mfma_f32_16x16x32_bf16 v[144:147], v[236:239], v[40:43], v[144:147]
    ds_read_b64_tr_b16 v[228:229], v5 offset:33056
    v_mfma_f32_16x16x32_bf16 v[148:151], v[236:239], v[44:47], v[148:151]
    ds_read_b64_tr_b16 v[230:231], v5 offset:34080
    s_waitcnt vmcnt(16) lgkmcnt(6)
    v_mfma_f32_16x16x32_bf16 v[88:91], v[240:243], v[48:51], v[88:91]
    ds_read_b64_tr_b16 v[232:233], v4 offset:33280
    s_waitcnt vmcnt(15)
    v_mfma_f32_16x16x32_bf16 v[92:95], v[240:243], v[52:55], v[92:95]
    ds_read_b64_tr_b16 v[234:235], v4 offset:34304
    s_waitcnt lgkmcnt(6)
    v_mfma_f32_16x16x32_bf16 v[96:99], v[244:247], v[48:51], v[96:99]
    ds_read_b64_tr_b16 v[236:237], v5 offset:33312
    s_mov_b32 s23, 0x8000
    buffer_load_dwordx4 v[40:43], v6, s[8:11], s23 offen offset:1024 sc1
    v_mfma_f32_16x16x32_bf16 v[100:103], v[244:247], v[52:55], v[100:103]
    ds_read_b64_tr_b16 v[238:239], v5 offset:34336
    s_waitcnt lgkmcnt(6)
    v_mfma_f32_16x16x32_bf16 v[104:107], v[224:227], v[48:51], v[104:107]
    ds_read_b64_tr_b16 v[240:241], v4 offset:33536
    v_mfma_f32_16x16x32_bf16 v[108:111], v[224:227], v[52:55], v[108:111]
    ds_read_b64_tr_b16 v[242:243], v4 offset:34560
    s_mov_b32 s23, 0x28000
    buffer_load_dwordx4 v[44:47], v6, s[8:11], s23 offen offset:1024 sc1
    s_waitcnt lgkmcnt(6)
    v_mfma_f32_16x16x32_bf16 v[112:115], v[228:231], v[48:51], v[112:115]
    ds_read_b64_tr_b16 v[244:245], v5 offset:33568
    v_mfma_f32_16x16x32_bf16 v[116:119], v[228:231], v[52:55], v[116:119]
    ds_read_b64_tr_b16 v[246:247], v5 offset:34592
    s_waitcnt lgkmcnt(6)
    v_mfma_f32_16x16x32_bf16 v[120:123], v[232:235], v[48:51], v[120:123]
    v_mfma_f32_16x16x32_bf16 v[124:127], v[232:235], v[52:55], v[124:127]
    s_waitcnt vmcnt(15)
    s_barrier
    ds_read_b64_tr_b16 v[224:225], v4 offset:49152
    ds_read_b64_tr_b16 v[226:227], v4 offset:50176
    s_waitcnt lgkmcnt(6)
    v_mfma_f32_16x16x32_bf16 v[128:131], v[236:239], v[48:51], v[128:131]
    s_add_u32 s22, s24, 0x290000
    s_add_u32 m0, s20, 0x14000
    s_nop 0
    buffer_load_dwordx4 v3, s[4:7], s22 offen lds
    ds_read_b64_tr_b16 v[228:229], v5 offset:49184
    v_mfma_f32_16x16x32_bf16 v[132:135], v[236:239], v[52:55], v[132:135]
    ds_read_b64_tr_b16 v[230:231], v5 offset:50208
    s_waitcnt lgkmcnt(6)
    v_mfma_f32_16x16x32_bf16 v[136:139], v[240:243], v[48:51], v[136:139]
    ds_read_b64_tr_b16 v[232:233], v4 offset:49408
    v_mfma_f32_16x16x32_bf16 v[140:143], v[240:243], v[52:55], v[140:143]
    s_add_u32 s22, s24, 0x292000
    s_add_u32 m0, s20, 0x14400
    s_nop 0
    buffer_load_dwordx4 v3, s[4:7], s22 offen lds
    ds_read_b64_tr_b16 v[234:235], v4 offset:50432
    s_waitcnt lgkmcnt(6)
    v_mfma_f32_16x16x32_bf16 v[144:147], v[244:247], v[48:51], v[144:147]
    ds_read_b64_tr_b16 v[236:237], v5 offset:49440
    v_mfma_f32_16x16x32_bf16 v[148:151], v[244:247], v[52:55], v[148:151]
    ds_read_b64_tr_b16 v[238:239], v5 offset:50464
    s_waitcnt vmcnt(16) lgkmcnt(6)
    v_mfma_f32_16x16x32_bf16 v[88:91], v[224:227], v[56:59], v[88:91]
    ds_read_b64_tr_b16 v[240:241], v4 offset:49664
    s_waitcnt vmcnt(15)
    v_mfma_f32_16x16x32_bf16 v[92:95], v[224:227], v[60:63], v[92:95]
    ds_read_b64_tr_b16 v[242:243], v4 offset:50688
    s_waitcnt lgkmcnt(6)
    v_mfma_f32_16x16x32_bf16 v[96:99], v[228:231], v[56:59], v[96:99]
    ds_read_b64_tr_b16 v[244:245], v5 offset:49696
    s_mov_b32 s23, 0xa000
    buffer_load_dwordx4 v[48:51], v6, s[8:11], s23 offen offset:1024 sc1
    v_mfma_f32_16x16x32_bf16 v[100:103], v[228:231], v[60:63], v[100:103]
    ds_read_b64_tr_b16 v[246:247], v5 offset:50720
    s_waitcnt lgkmcnt(6)
    v_mfma_f32_16x16x32_bf16 v[104:107], v[232:235], v[56:59], v[104:107]
    ds_read_b64_tr_b16 v[224:225], v4 offset:49920
    v_mfma_f32_16x16x32_bf16 v[108:111], v[232:235], v[60:63], v[108:111]
    ds_read_b64_tr_b16 v[226:227], v4 offset:50944
    s_mov_b32 s23, 0x2a000
    buffer_load_dwordx4 v[52:55], v6, s[8:11], s23 offen offset:1024 sc1
    s_waitcnt lgkmcnt(6)
    v_mfma_f32_16x16x32_bf16 v[112:115], v[236:239], v[56:59], v[112:115]
    ds_read_b64_tr_b16 v[228:229], v5 offset:49952
    v_mfma_f32_16x16x32_bf16 v[116:119], v[236:239], v[60:63], v[116:119]
    ds_read_b64_tr_b16 v[230:231], v5 offset:50976
    s_waitcnt lgkmcnt(6)
    v_mfma_f32_16x16x32_bf16 v[120:123], v[240:243], v[56:59], v[120:123]
    v_mfma_f32_16x16x32_bf16 v[124:127], v[240:243], v[60:63], v[124:127]
    s_waitcnt vmcnt(14)
    s_barrier
    ds_read_b64_tr_b16 v[232:233], v7 offset:0
    ds_read_b64_tr_b16 v[234:235], v7 offset:1024
    s_waitcnt lgkmcnt(6)
    v_mfma_f32_16x16x32_bf16 v[128:131], v[244:247], v[56:59], v[128:131]
    s_add_u32 s22, s24, 0x310000
    s_add_u32 m0, s20, 0x18000
    s_nop 0
    buffer_load_dwordx4 v3, s[4:7], s22 offen lds
    ds_read_b64_tr_b16 v[236:237], v8 offset:32
    v_mfma_f32_16x16x32_bf16 v[132:135], v[244:247], v[60:63], v[132:135]
    ds_read_b64_tr_b16 v[238:239], v8 offset:1056
    s_waitcnt lgkmcnt(6)
    v_mfma_f32_16x16x32_bf16 v[136:139], v[224:227], v[56:59], v[136:139]
    ds_read_b64_tr_b16 v[240:241], v7 offset:256
    v_mfma_f32_16x16x32_bf16 v[140:143], v[224:227], v[60:63], v[140:143]
    s_add_u32 s22, s24, 0x312000
    s_add_u32 m0, s20, 0x18400
    s_nop 0
    buffer_load_dwordx4 v3, s[4:7], s22 offen lds
    ds_read_b64_tr_b16 v[242:243], v7 offset:1280
    s_waitcnt lgkmcnt(6)
    v_mfma_f32_16x16x32_bf16 v[144:147], v[228:231], v[56:59], v[144:147]
    ds_read_b64_tr_b16 v[244:245], v8 offset:288
    v_mfma_f32_16x16x32_bf16 v[148:151], v[228:231], v[60:63], v[148:151]
    ds_read_b64_tr_b16 v[246:247], v8 offset:1312
    s_waitcnt vmcnt(15) lgkmcnt(6)
    v_mfma_f32_16x16x32_bf16 v[88:91], v[232:235], v[24:27], v[88:91]
    ds_read_b64_tr_b16 v[224:225], v7 offset:512
    s_waitcnt vmcnt(14)
    v_mfma_f32_16x16x32_bf16 v[92:95], v[232:235], v[28:31], v[92:95]
    ds_read_b64_tr_b16 v[226:227], v7 offset:1536
    s_waitcnt lgkmcnt(6)
    v_mfma_f32_16x16x32_bf16 v[96:99], v[236:239], v[24:27], v[96:99]
    ds_read_b64_tr_b16 v[228:229], v8 offset:544
    s_mov_b32 s23, 0xc000
    buffer_load_dwordx4 v[56:59], v6, s[8:11], s23 offen offset:1024 sc1
    v_mfma_f32_16x16x32_bf16 v[100:103], v[236:239], v[28:31], v[100:103]
    ds_read_b64_tr_b16 v[230:231], v8 offset:1568
    s_waitcnt lgkmcnt(6)
    v_mfma_f32_16x16x32_bf16 v[104:107], v[240:243], v[24:27], v[104:107]
    ds_read_b64_tr_b16 v[232:233], v7 offset:768
    v_mfma_f32_16x16x32_bf16 v[108:111], v[240:243], v[28:31], v[108:111]
    ds_read_b64_tr_b16 v[234:235], v7 offset:1792
    s_mov_b32 s23, 0x2c000
    buffer_load_dwordx4 v[60:63], v6, s[8:11], s23 offen offset:1024 sc1
    s_waitcnt lgkmcnt(6)
    v_mfma_f32_16x16x32_bf16 v[112:115], v[244:247], v[24:27], v[112:115]
    ds_read_b64_tr_b16 v[236:237], v8 offset:800
    v_mfma_f32_16x16x32_bf16 v[116:119], v[244:247], v[28:31], v[116:119]
    ds_read_b64_tr_b16 v[238:239], v8 offset:1824
    s_waitcnt lgkmcnt(6)
    v_mfma_f32_16x16x32_bf16 v[120:123], v[224:227], v[24:27], v[120:123]
    v_mfma_f32_16x16x32_bf16 v[124:127], v[224:227], v[28:31], v[124:127]
    s_waitcnt vmcnt(14)
    s_barrier
    ds_read_b64_tr_b16 v[240:241], v7 offset:16384
    ds_read_b64_tr_b16 v[242:243], v7 offset:17408
    s_add_u32 s19, s19, 8192
    buffer_load_dword v12, v13, s[8:11], s19 offen sc1
    s_waitcnt lgkmcnt(6)
    v_mfma_f32_16x16x32_bf16 v[128:131], v[228:231], v[24:27], v[128:131]
    s_add_u32 s22, s24, 0x390000
    s_add_u32 m0, s20, 0x1c000
    s_nop 0
    buffer_load_dwordx4 v3, s[4:7], s22 offen lds
    ds_read_b64_tr_b16 v[244:245], v8 offset:16416
    v_mfma_f32_16x16x32_bf16 v[132:135], v[228:231], v[28:31], v[132:135]
    ds_read_b64_tr_b16 v[246:247], v8 offset:17440
    s_waitcnt lgkmcnt(6)
    v_mfma_f32_16x16x32_bf16 v[136:139], v[232:235], v[24:27], v[136:139]
    ds_read_b64_tr_b16 v[224:225], v7 offset:16640
    v_mfma_f32_16x16x32_bf16 v[140:143], v[232:235], v[28:31], v[140:143]
    s_add_u32 s22, s24, 0x392000
    s_add_u32 m0, s20, 0x1c400
    s_nop 0
    buffer_load_dwordx4 v3, s[4:7], s22 offen lds
    ds_read_b64_tr_b16 v[226:227], v7 offset:17664
    s_waitcnt lgkmcnt(6)
    v_mfma_f32_16x16x32_bf16 v[144:147], v[236:239], v[24:27], v[144:147]
    ds_read_b64_tr_b16 v[228:229], v8 offset:16672
    v_mfma_f32_16x16x32_bf16 v[148:151], v[236:239], v[28:31], v[148:151]
    ds_read_b64_tr_b16 v[230:231], v8 offset:17696
    s_waitcnt vmcnt(16) lgkmcnt(6)
    v_mfma_f32_16x16x32_bf16 v[88:91], v[240:243], v[32:35], v[88:91]
    ds_read_b64_tr_b16 v[232:233], v7 offset:16896
    s_waitcnt vmcnt(15)
    v_mfma_f32_16x16x32_bf16 v[92:95], v[240:243], v[36:39], v[92:95]
    ds_read_b64_tr_b16 v[234:235], v7 offset:17920
    s_waitcnt lgkmcnt(6)
    v_mfma_f32_16x16x32_bf16 v[96:99], v[244:247], v[32:35], v[96:99]
    ds_read_b64_tr_b16 v[236:237], v8 offset:16928
    s_mov_b32 s23, 0xe000
    buffer_load_dwordx4 v[24:27], v6, s[8:11], s23 offen offset:1024 sc1
    v_mfma_f32_16x16x32_bf16 v[100:103], v[244:247], v[36:39], v[100:103]
    ds_read_b64_tr_b16 v[238:239], v8 offset:17952
    s_waitcnt lgkmcnt(6)
    v_mfma_f32_16x16x32_bf16 v[104:107], v[224:227], v[32:35], v[104:107]
    ds_read_b64_tr_b16 v[240:241], v7 offset:17152
    v_mfma_f32_16x16x32_bf16 v[108:111], v[224:227], v[36:39], v[108:111]
    ds_read_b64_tr_b16 v[242:243], v7 offset:18176
    s_mov_b32 s23, 0x2e000
    buffer_load_dwordx4 v[28:31], v6, s[8:11], s23 offen offset:1024 sc1
    s_waitcnt lgkmcnt(6)
    v_mfma_f32_16x16x32_bf16 v[112:115], v[228:231], v[32:35], v[112:115]
    ds_read_b64_tr_b16 v[244:245], v8 offset:17184
    v_mfma_f32_16x16x32_bf16 v[116:119], v[228:231], v[36:39], v[116:119]
    ds_read_b64_tr_b16 v[246:247], v8 offset:18208
    s_waitcnt lgkmcnt(6)
    v_mfma_f32_16x16x32_bf16 v[120:123], v[232:235], v[32:35], v[120:123]
    v_mfma_f32_16x16x32_bf16 v[124:127], v[232:235], v[36:39], v[124:127]
    s_waitcnt vmcnt(15)
    s_barrier
    ds_read_b64_tr_b16 v[224:225], v4 offset:0
    ds_read_b64_tr_b16 v[226:227], v4 offset:1024
    s_waitcnt lgkmcnt(6)
    v_mfma_f32_16x16x32_bf16 v[128:131], v[236:239], v[32:35], v[128:131]
    s_add_u32 s22, s24, 0x20000
    s_add_u32 m0, s20, 0x20000
    s_nop 0
    buffer_load_dwordx4 v3, s[4:7], s22 offen lds
    ds_read_b64_tr_b16 v[228:229], v5 offset:32
    v_mfma_f32_16x16x32_bf16 v[132:135], v[236:239], v[36:39], v[132:135]
    ds_read_b64_tr_b16 v[230:231], v5 offset:1056
    s_waitcnt lgkmcnt(6)
    v_mfma_f32_16x16x32_bf16 v[136:139], v[240:243], v[32:35], v[136:139]
    ds_read_b64_tr_b16 v[232:233], v4 offset:256
    v_mfma_f32_16x16x32_bf16 v[140:143], v[240:243], v[36:39], v[140:143]
    s_add_u32 s22, s24, 0x22000
    s_add_u32 m0, s20, 0x20400
    s_nop 0
    buffer_load_dwordx4 v3, s[4:7], s22 offen lds
    ds_read_b64_tr_b16 v[234:235], v4 offset:1280
    s_waitcnt lgkmcnt(6)
    v_mfma_f32_16x16x32_bf16 v[144:147], v[244:247], v[32:35], v[144:147]
    ds_read_b64_tr_b16 v[236:237], v5 offset:288
    v_mfma_f32_16x16x32_bf16 v[148:151], v[244:247], v[36:39], v[148:151]
    ds_read_b64_tr_b16 v[238:239], v5 offset:1312
    s_waitcnt vmcnt(6)
    v_cmp_ne_u32 vcc, s28, v12
    s_cbranch_vccnz adaLN_cond__sliding_block_cached__moe_arch_mod__prompt_kernel_o28r
adaLN_cond__sliding_block_cached__moe_arch_mod__prompt_kernel_o28b:
    s_waitcnt lgkmcnt(6)
    v_mfma_f32_16x16x32_bf16 v[88:91], v[224:227], v[40:43], v[88:91]
    ds_read_b64_tr_b16 v[240:241], v4 offset:512
    v_mfma_f32_16x16x32_bf16 v[92:95], v[224:227], v[44:47], v[92:95]
    ds_read_b64_tr_b16 v[242:243], v4 offset:1536
    s_waitcnt lgkmcnt(6)
    v_mfma_f32_16x16x32_bf16 v[96:99], v[228:231], v[40:43], v[96:99]
    ds_read_b64_tr_b16 v[244:245], v5 offset:544
    s_mov_b32 s23, 0x0
    buffer_load_dwordx4 v[32:35], v6, s[8:11], s23 offen offset:2048 sc1
    v_mfma_f32_16x16x32_bf16 v[100:103], v[228:231], v[44:47], v[100:103]
    ds_read_b64_tr_b16 v[246:247], v5 offset:1568
    s_waitcnt lgkmcnt(6)
    v_mfma_f32_16x16x32_bf16 v[104:107], v[232:235], v[40:43], v[104:107]
    ds_read_b64_tr_b16 v[224:225], v4 offset:768
    v_mfma_f32_16x16x32_bf16 v[108:111], v[232:235], v[44:47], v[108:111]
    ds_read_b64_tr_b16 v[226:227], v4 offset:1792
    s_mov_b32 s23, 0x20000
    buffer_load_dwordx4 v[36:39], v6, s[8:11], s23 offen offset:2048 sc1
    s_waitcnt lgkmcnt(6)
    v_mfma_f32_16x16x32_bf16 v[112:115], v[236:239], v[40:43], v[112:115]
    ds_read_b64_tr_b16 v[228:229], v5 offset:800
    v_mfma_f32_16x16x32_bf16 v[116:119], v[236:239], v[44:47], v[116:119]
    ds_read_b64_tr_b16 v[230:231], v5 offset:1824
    s_waitcnt lgkmcnt(6)
    v_mfma_f32_16x16x32_bf16 v[120:123], v[240:243], v[40:43], v[120:123]
    v_mfma_f32_16x16x32_bf16 v[124:127], v[240:243], v[44:47], v[124:127]
    s_barrier
    ds_read_b64_tr_b16 v[232:233], v4 offset:16384
    ds_read_b64_tr_b16 v[234:235], v4 offset:17408
    s_waitcnt lgkmcnt(6)
    v_mfma_f32_16x16x32_bf16 v[128:131], v[244:247], v[40:43], v[128:131]
    s_add_u32 s22, s24, 0xa0000
    s_add_u32 m0, s20, 0x24000
    s_nop 0
    buffer_load_dwordx4 v3, s[4:7], s22 offen lds
    ds_read_b64_tr_b16 v[236:237], v5 offset:16416
    v_mfma_f32_16x16x32_bf16 v[132:135], v[244:247], v[44:47], v[132:135]
    ds_read_b64_tr_b16 v[238:239], v5 offset:17440
    s_waitcnt lgkmcnt(6)
    v_mfma_f32_16x16x32_bf16 v[136:139], v[224:227], v[40:43], v[136:139]
    ds_read_b64_tr_b16 v[240:241], v4 offset:16640
    v_mfma_f32_16x16x32_bf16 v[140:143], v[224:227], v[44:47], v[140:143]
    s_add_u32 s22, s24, 0xa2000
    s_add_u32 m0, s20, 0x24400
    s_nop 0
    buffer_load_dwordx4 v3, s[4:7], s22 offen lds
    ds_read_b64_tr_b16 v[242:243], v4 offset:17664
    s_waitcnt lgkmcnt(6)
    v_mfma_f32_16x16x32_bf16 v[144:147], v[228:231], v[40:43], v[144:147]
    ds_read_b64_tr_b16 v[244:245], v5 offset:16672
    v_mfma_f32_16x16x32_bf16 v[148:151], v[228:231], v[44:47], v[148:151]
    ds_read_b64_tr_b16 v[246:247], v5 offset:17696
    s_waitcnt lgkmcnt(6)
    v_mfma_f32_16x16x32_bf16 v[88:91], v[232:235], v[48:51], v[88:91]
    ds_read_b64_tr_b16 v[224:225], v4 offset:16896
    v_mfma_f32_16x16x32_bf16 v[92:95], v[232:235], v[52:55], v[92:95]
    ds_read_b64_tr_b16 v[226:227], v4 offset:17920
    s_waitcnt lgkmcnt(6)
    v_mfma_f32_16x16x32_bf16 v[96:99], v[236:239], v[48:51], v[96:99]
    ds_read_b64_tr_b16 v[228:229], v5 offset:16928
    s_mov_b32 s23, 0x2000
    buffer_load_dwordx4 v[40:43], v6, s[8:11], s23 offen offset:2048 sc1
    v_mfma_f32_16x16x32_bf16 v[100:103], v[236:239], v[52:55], v[100:103]
    ds_read_b64_tr_b16 v[230:231], v5 offset:17952
    s_waitcnt lgkmcnt(6)
    v_mfma_f32_16x16x32_bf16 v[104:107], v[240:243], v[48:51], v[104:107]
    ds_read_b64_tr_b16 v[232:233], v4 offset:17152
    v_mfma_f32_16x16x32_bf16 v[108:111], v[240:243], v[52:55], v[108:111]
    ds_read_b64_tr_b16 v[234:235], v4 offset:18176
    s_mov_b32 s23, 0x22000
    buffer_load_dwordx4 v[44:47], v6, s[8:11], s23 offen offset:2048 sc1
    s_waitcnt lgkmcnt(6)
    v_mfma_f32_16x16x32_bf16 v[112:115], v[244:247], v[48:51], v[112:115]
    ds_read_b64_tr_b16 v[236:237], v5 offset:17184
    v_mfma_f32_16x16x32_bf16 v[116:119], v[244:247], v[52:55], v[116:119]
    ds_read_b64_tr_b16 v[238:239], v5 offset:18208
    s_waitcnt lgkmcnt(6)
    v_mfma_f32_16x16x32_bf16 v[120:123], v[224:227], v[48:51], v[120:123]
    v_mfma_f32_16x16x32_bf16 v[124:127], v[224:227], v[52:55], v[124:127]
    s_barrier
    ds_read_b64_tr_b16 v[240:241], v4 offset:32768
    ds_read_b64_tr_b16 v[242:243], v4 offset:33792
    s_waitcnt lgkmcnt(6)
    v_mfma_f32_16x16x32_bf16 v[128:131], v[228:231], v[48:51], v[128:131]
    s_add_u32 s22, s24, 0x120000
    s_add_u32 m0, s20, 0x10000
    s_nop 0
    buffer_load_dwordx4 v3, s[4:7], s22 offen lds
    ds_read_b64_tr_b16 v[244:245], v5 offset:32800
    v_mfma_f32_16x16x32_bf16 v[132:135], v[228:231], v[52:55], v[132:135]
    ds_read_b64_tr_b16 v[246:247], v5 offset:33824
    s_waitcnt lgkmcnt(6)
    v_mfma_f32_16x16x32_bf16 v[136:139], v[232:235], v[48:51], v[136:139]
    ds_read_b64_tr_b16 v[224:225], v4 offset:33024
    v_mfma_f32_16x16x32_bf16 v[140:143], v[232:235], v[52:55], v[140:143]
    s_add_u32 s22, s24, 0x122000
    s_add_u32 m0, s20, 0x10400
    s_nop 0
    buffer_load_dwordx4 v3, s[4:7], s22 offen lds
    ds_read_b64_tr_b16 v[226:227], v4 offset:34048
    s_waitcnt lgkmcnt(6)
    v_mfma_f32_16x16x32_bf16 v[144:147], v[236:239], v[48:51], v[144:147]
    ds_read_b64_tr_b16 v[228:229], v5 offset:33056
    v_mfma_f32_16x16x32_bf16 v[148:151], v[236:239], v[52:55], v[148:151]
    ds_read_b64_tr_b16 v[230:231], v5 offset:34080
    s_waitcnt lgkmcnt(6)
    v_mfma_f32_16x16x32_bf16 v[88:91], v[240:243], v[56:59], v[88:91]
    ds_read_b64_tr_b16 v[232:233], v4 offset:33280
    v_mfma_f32_16x16x32_bf16 v[92:95], v[240:243], v[60:63], v[92:95]
    ds_read_b64_tr_b16 v[234:235], v4 offset:34304
    s_waitcnt lgkmcnt(6)
    v_mfma_f32_16x16x32_bf16 v[96:99], v[244:247], v[56:59], v[96:99]
    ds_read_b64_tr_b16 v[236:237], v5 offset:33312
    s_mov_b32 s23, 0x4000
    buffer_load_dwordx4 v[48:51], v6, s[8:11], s23 offen offset:2048 sc1
    v_mfma_f32_16x16x32_bf16 v[100:103], v[244:247], v[60:63], v[100:103]
    ds_read_b64_tr_b16 v[238:239], v5 offset:34336
    s_waitcnt lgkmcnt(6)
    v_mfma_f32_16x16x32_bf16 v[104:107], v[224:227], v[56:59], v[104:107]
    ds_read_b64_tr_b16 v[240:241], v4 offset:33536
    v_mfma_f32_16x16x32_bf16 v[108:111], v[224:227], v[60:63], v[108:111]
    ds_read_b64_tr_b16 v[242:243], v4 offset:34560
    s_mov_b32 s23, 0x24000
    buffer_load_dwordx4 v[52:55], v6, s[8:11], s23 offen offset:2048 sc1
    s_waitcnt lgkmcnt(6)
    v_mfma_f32_16x16x32_bf16 v[112:115], v[228:231], v[56:59], v[112:115]
    ds_read_b64_tr_b16 v[244:245], v5 offset:33568
    v_mfma_f32_16x16x32_bf16 v[116:119], v[228:231], v[60:63], v[116:119]
    ds_read_b64_tr_b16 v[246:247], v5 offset:34592
    s_waitcnt lgkmcnt(6)
    v_mfma_f32_16x16x32_bf16 v[120:123], v[232:235], v[56:59], v[120:123]
    v_mfma_f32_16x16x32_bf16 v[124:127], v[232:235], v[60:63], v[124:127]
    s_waitcnt vmcnt(14)
    s_barrier
    ds_read_b64_tr_b16 v[224:225], v4 offset:49152
    ds_read_b64_tr_b16 v[226:227], v4 offset:50176
    s_waitcnt lgkmcnt(6)
    v_mfma_f32_16x16x32_bf16 v[128:131], v[236:239], v[56:59], v[128:131]
    s_add_u32 s22, s24, 0x1a0000
    s_add_u32 m0, s20, 0x14000
    s_nop 0
    buffer_load_dwordx4 v3, s[4:7], s22 offen lds
    ds_read_b64_tr_b16 v[228:229], v5 offset:49184
    v_mfma_f32_16x16x32_bf16 v[132:135], v[236:239], v[60:63], v[132:135]
    ds_read_b64_tr_b16 v[230:231], v5 offset:50208
    s_waitcnt lgkmcnt(6)
    v_mfma_f32_16x16x32_bf16 v[136:139], v[240:243], v[56:59], v[136:139]
    ds_read_b64_tr_b16 v[232:233], v4 offset:49408
    v_mfma_f32_16x16x32_bf16 v[140:143], v[240:243], v[60:63], v[140:143]
    s_add_u32 s22, s24, 0x1a2000
    s_add_u32 m0, s20, 0x14400
    s_nop 0
    buffer_load_dwordx4 v3, s[4:7], s22 offen lds
    ds_read_b64_tr_b16 v[234:235], v4 offset:50432
    s_waitcnt lgkmcnt(6)
    v_mfma_f32_16x16x32_bf16 v[144:147], v[244:247], v[56:59], v[144:147]
    ds_read_b64_tr_b16 v[236:237], v5 offset:49440
    v_mfma_f32_16x16x32_bf16 v[148:151], v[244:247], v[60:63], v[148:151]
    ds_read_b64_tr_b16 v[238:239], v5 offset:50464
    s_waitcnt vmcnt(15) lgkmcnt(6)
    v_mfma_f32_16x16x32_bf16 v[88:91], v[224:227], v[24:27], v[88:91]
    ds_read_b64_tr_b16 v[240:241], v4 offset:49664
    s_waitcnt vmcnt(14)
    v_mfma_f32_16x16x32_bf16 v[92:95], v[224:227], v[28:31], v[92:95]
    ds_read_b64_tr_b16 v[242:243], v4 offset:50688
    s_waitcnt lgkmcnt(6)
    v_mfma_f32_16x16x32_bf16 v[96:99], v[228:231], v[24:27], v[96:99]
    ds_read_b64_tr_b16 v[244:245], v5 offset:49696
    s_mov_b32 s23, 0x6000
    buffer_load_dwordx4 v[56:59], v6, s[8:11], s23 offen offset:2048 sc1
    v_mfma_f32_16x16x32_bf16 v[100:103], v[228:231], v[28:31], v[100:103]
    ds_read_b64_tr_b16 v[246:247], v5 offset:50720
    s_waitcnt lgkmcnt(6)
    v_mfma_f32_16x16x32_bf16 v[104:107], v[232:235], v[24:27], v[104:107]
    ds_read_b64_tr_b16 v[224:225], v4 offset:49920
    v_mfma_f32_16x16x32_bf16 v[108:111], v[232:235], v[28:31], v[108:111]
    ds_read_b64_tr_b16 v[226:227], v4 offset:50944
    s_mov_b32 s23, 0x26000
    buffer_load_dwordx4 v[60:63], v6, s[8:11], s23 offen offset:2048 sc1
    s_waitcnt lgkmcnt(6)
    v_mfma_f32_16x16x32_bf16 v[112:115], v[236:239], v[24:27], v[112:115]
    ds_read_b64_tr_b16 v[228:229], v5 offset:49952
    v_mfma_f32_16x16x32_bf16 v[116:119], v[236:239], v[28:31], v[116:119]
    ds_read_b64_tr_b16 v[230:231], v5 offset:50976
    s_waitcnt lgkmcnt(6)
    v_mfma_f32_16x16x32_bf16 v[120:123], v[240:243], v[24:27], v[120:123]
    v_mfma_f32_16x16x32_bf16 v[124:127], v[240:243], v[28:31], v[124:127]
    s_waitcnt vmcnt(14)
    s_barrier
    ds_read_b64_tr_b16 v[232:233], v7 offset:0
    ds_read_b64_tr_b16 v[234:235], v7 offset:1024
    s_waitcnt lgkmcnt(6)
    v_mfma_f32_16x16x32_bf16 v[128:131], v[244:247], v[24:27], v[128:131]
    s_add_u32 s22, s24, 0x220000
    s_add_u32 m0, s20, 0x18000
    s_nop 0
    buffer_load_dwordx4 v3, s[4:7], s22 offen lds
    ds_read_b64_tr_b16 v[236:237], v8 offset:32
    v_mfma_f32_16x16x32_bf16 v[132:135], v[244:247], v[28:31], v[132:135]
    ds_read_b64_tr_b16 v[238:239], v8 offset:1056
    s_waitcnt lgkmcnt(6)
    v_mfma_f32_16x16x32_bf16 v[136:139], v[224:227], v[24:27], v[136:139]
    ds_read_b64_tr_b16 v[240:241], v7 offset:256
    v_mfma_f32_16x16x32_bf16 v[140:143], v[224:227], v[28:31], v[140:143]
    s_add_u32 s22, s24, 0x222000
    s_add_u32 m0, s20, 0x18400
    s_nop 0
    buffer_load_dwordx4 v3, s[4:7], s22 offen lds
    ds_read_b64_tr_b16 v[242:243], v7 offset:1280
    s_waitcnt lgkmcnt(6)
    v_mfma_f32_16x16x32_bf16 v[144:147], v[228:231], v[24:27], v[144:147]
    ds_read_b64_tr_b16 v[244:245], v8 offset:288
    v_mfma_f32_16x16x32_bf16 v[148:151], v[228:231], v[28:31], v[148:151]
    ds_read_b64_tr_b16 v[246:247], v8 offset:1312
    s_waitcnt vmcnt(15) lgkmcnt(6)
    v_mfma_f32_16x16x32_bf16 v[88:91], v[232:235], v[32:35], v[88:91]
    ds_read_b64_tr_b16 v[224:225], v7 offset:512
    s_waitcnt vmcnt(14)
    v_mfma_f32_16x16x32_bf16 v[92:95], v[232:235], v[36:39], v[92:95]
    ds_read_b64_tr_b16 v[226:227], v7 offset:1536
    s_waitcnt lgkmcnt(6)
    v_mfma_f32_16x16x32_bf16 v[96:99], v[236:239], v[32:35], v[96:99]
    ds_read_b64_tr_b16 v[228:229], v8 offset:544
    s_mov_b32 s23, 0x8000
    buffer_load_dwordx4 v[24:27], v6, s[8:11], s23 offen offset:2048 sc1
    v_mfma_f32_16x16x32_bf16 v[100:103], v[236:239], v[36:39], v[100:103]
    ds_read_b64_tr_b16 v[230:231], v8 offset:1568
    s_waitcnt lgkmcnt(6)
    v_mfma_f32_16x16x32_bf16 v[104:107], v[240:243], v[32:35], v[104:107]
    ds_read_b64_tr_b16 v[232:233], v7 offset:768
    v_mfma_f32_16x16x32_bf16 v[108:111], v[240:243], v[36:39], v[108:111]
    ds_read_b64_tr_b16 v[234:235], v7 offset:1792
    s_mov_b32 s23, 0x28000
    buffer_load_dwordx4 v[28:31], v6, s[8:11], s23 offen offset:2048 sc1
    s_mov_b32 s16, 0x544000
    buffer_load_dwordx4 v[184:187], v2, s[8:11], s16 offen sc1
    s_waitcnt lgkmcnt(6)
    v_mfma_f32_16x16x32_bf16 v[112:115], v[244:247], v[32:35], v[112:115]
    ds_read_b64_tr_b16 v[236:237], v8 offset:800
    v_mfma_f32_16x16x32_bf16 v[116:119], v[244:247], v[36:39], v[116:119]
    ds_read_b64_tr_b16 v[238:239], v8 offset:1824
    s_waitcnt lgkmcnt(6)
    v_mfma_f32_16x16x32_bf16 v[120:123], v[224:227], v[32:35], v[120:123]
    v_mfma_f32_16x16x32_bf16 v[124:127], v[224:227], v[36:39], v[124:127]
    s_waitcnt vmcnt(15)
    s_barrier
    ds_read_b64_tr_b16 v[240:241], v7 offset:16384
    ds_read_b64_tr_b16 v[242:243], v7 offset:17408
    s_waitcnt lgkmcnt(6)
    v_mfma_f32_16x16x32_bf16 v[128:131], v[228:231], v[32:35], v[128:131]
    s_add_u32 s22, s24, 0x2a0000
    s_add_u32 m0, s20, 0x1c000
    s_nop 0
    buffer_load_dwordx4 v3, s[4:7], s22 offen lds
    ds_read_b64_tr_b16 v[244:245], v8 offset:16416
    v_mfma_f32_16x16x32_bf16 v[132:135], v[228:231], v[36:39], v[132:135]
    ds_read_b64_tr_b16 v[246:247], v8 offset:17440
    s_waitcnt lgkmcnt(6)
    v_mfma_f32_16x16x32_bf16 v[136:139], v[232:235], v[32:35], v[136:139]
    ds_read_b64_tr_b16 v[224:225], v7 offset:16640
    v_mfma_f32_16x16x32_bf16 v[140:143], v[232:235], v[36:39], v[140:143]
    s_add_u32 s22, s24, 0x2a2000
    s_add_u32 m0, s20, 0x1c400
    s_nop 0
    buffer_load_dwordx4 v3, s[4:7], s22 offen lds
    ds_read_b64_tr_b16 v[226:227], v7 offset:17664
    s_waitcnt lgkmcnt(6)
    v_mfma_f32_16x16x32_bf16 v[144:147], v[236:239], v[32:35], v[144:147]
    ds_read_b64_tr_b16 v[228:229], v8 offset:16672
    v_mfma_f32_16x16x32_bf16 v[148:151], v[236:239], v[36:39], v[148:151]
    ds_read_b64_tr_b16 v[230:231], v8 offset:17696
    s_waitcnt vmcnt(16) lgkmcnt(6)
    v_mfma_f32_16x16x32_bf16 v[88:91], v[240:243], v[40:43], v[88:91]
    ds_read_b64_tr_b16 v[232:233], v7 offset:16896
    s_waitcnt vmcnt(15)
    v_mfma_f32_16x16x32_bf16 v[92:95], v[240:243], v[44:47], v[92:95]
    ds_read_b64_tr_b16 v[234:235], v7 offset:17920
    s_waitcnt lgkmcnt(6)
    v_mfma_f32_16x16x32_bf16 v[96:99], v[244:247], v[40:43], v[96:99]
    ds_read_b64_tr_b16 v[236:237], v8 offset:16928
    s_mov_b32 s23, 0xa000
    buffer_load_dwordx4 v[32:35], v6, s[8:11], s23 offen offset:2048 sc1
    v_mfma_f32_16x16x32_bf16 v[100:103], v[244:247], v[44:47], v[100:103]
    ds_read_b64_tr_b16 v[238:239], v8 offset:17952
    s_waitcnt lgkmcnt(6)
    v_mfma_f32_16x16x32_bf16 v[104:107], v[224:227], v[40:43], v[104:107]
    ds_read_b64_tr_b16 v[240:241], v7 offset:17152
    v_mfma_f32_16x16x32_bf16 v[108:111], v[224:227], v[44:47], v[108:111]
    ds_read_b64_tr_b16 v[242:243], v7 offset:18176
    s_mov_b32 s23, 0x2a000
    buffer_load_dwordx4 v[36:39], v6, s[8:11], s23 offen offset:2048 sc1
    s_waitcnt lgkmcnt(6)
    v_mfma_f32_16x16x32_bf16 v[112:115], v[228:231], v[40:43], v[112:115]
    ds_read_b64_tr_b16 v[244:245], v8 offset:17184
    v_mfma_f32_16x16x32_bf16 v[116:119], v[228:231], v[44:47], v[116:119]
    ds_read_b64_tr_b16 v[246:247], v8 offset:18208
    s_waitcnt lgkmcnt(6)
    v_mfma_f32_16x16x32_bf16 v[120:123], v[232:235], v[40:43], v[120:123]
    v_mfma_f32_16x16x32_bf16 v[124:127], v[232:235], v[44:47], v[124:127]
    s_waitcnt vmcnt(15)
    s_barrier
    ds_read_b64_tr_b16 v[224:225], v4 offset:0
    ds_read_b64_tr_b16 v[226:227], v4 offset:1024
    s_waitcnt lgkmcnt(6)
    v_mfma_f32_16x16x32_bf16 v[128:131], v[236:239], v[40:43], v[128:131]
    s_add_u32 s22, s24, 0x320000
    s_add_u32 m0, s20, 0x20000
    s_nop 0
    buffer_load_dwordx4 v3, s[4:7], s22 offen lds
    ds_read_b64_tr_b16 v[228:229], v5 offset:32
    v_mfma_f32_16x16x32_bf16 v[132:135], v[236:239], v[44:47], v[132:135]
    ds_read_b64_tr_b16 v[230:231], v5 offset:1056
    s_waitcnt lgkmcnt(6)
    v_mfma_f32_16x16x32_bf16 v[136:139], v[240:243], v[40:43], v[136:139]
    ds_read_b64_tr_b16 v[232:233], v4 offset:256
    v_mfma_f32_16x16x32_bf16 v[140:143], v[240:243], v[44:47], v[140:143]
    s_add_u32 s22, s24, 0x322000
    s_add_u32 m0, s20, 0x20400
    s_nop 0
    buffer_load_dwordx4 v3, s[4:7], s22 offen lds
    ds_read_b64_tr_b16 v[234:235], v4 offset:1280
    s_waitcnt lgkmcnt(6)
    v_mfma_f32_16x16x32_bf16 v[144:147], v[244:247], v[40:43], v[144:147]
    ds_read_b64_tr_b16 v[236:237], v5 offset:288
    v_mfma_f32_16x16x32_bf16 v[148:151], v[244:247], v[44:47], v[148:151]
    ds_read_b64_tr_b16 v[238:239], v5 offset:1312
    s_waitcnt vmcnt(16) lgkmcnt(6)
    v_mfma_f32_16x16x32_bf16 v[88:91], v[224:227], v[48:51], v[88:91]
    ds_read_b64_tr_b16 v[240:241], v4 offset:512
    s_waitcnt vmcnt(15)
    v_mfma_f32_16x16x32_bf16 v[92:95], v[224:227], v[52:55], v[92:95]
    ds_read_b64_tr_b16 v[242:243], v4 offset:1536
    s_waitcnt lgkmcnt(6)
    v_mfma_f32_16x16x32_bf16 v[96:99], v[228:231], v[48:51], v[96:99]
    ds_read_b64_tr_b16 v[244:245], v5 offset:544
    s_mov_b32 s23, 0xc000
    buffer_load_dwordx4 v[40:43], v6, s[8:11], s23 offen offset:2048 sc1
    v_mfma_f32_16x16x32_bf16 v[100:103], v[228:231], v[52:55], v[100:103]
    ds_read_b64_tr_b16 v[246:247], v5 offset:1568
    s_waitcnt lgkmcnt(6)
    v_mfma_f32_16x16x32_bf16 v[104:107], v[232:235], v[48:51], v[104:107]
    ds_read_b64_tr_b16 v[224:225], v4 offset:768
    v_mfma_f32_16x16x32_bf16 v[108:111], v[232:235], v[52:55], v[108:111]
    ds_read_b64_tr_b16 v[226:227], v4 offset:1792
    s_mov_b32 s23, 0x2c000
    buffer_load_dwordx4 v[44:47], v6, s[8:11], s23 offen offset:2048 sc1
    s_waitcnt lgkmcnt(6)
    v_mfma_f32_16x16x32_bf16 v[112:115], v[236:239], v[48:51], v[112:115]
    ds_read_b64_tr_b16 v[228:229], v5 offset:800
    v_mfma_f32_16x16x32_bf16 v[116:119], v[236:239], v[52:55], v[116:119]
    ds_read_b64_tr_b16 v[230:231], v5 offset:1824
    s_waitcnt lgkmcnt(6)
    v_mfma_f32_16x16x32_bf16 v[120:123], v[240:243], v[48:51], v[120:123]
    v_mfma_f32_16x16x32_bf16 v[124:127], v[240:243], v[52:55], v[124:127]
    s_waitcnt vmcnt(15)
    s_barrier
    ds_read_b64_tr_b16 v[232:233], v4 offset:16384
    ds_read_b64_tr_b16 v[234:235], v4 offset:17408
    s_add_u32 s19, s19, 8192
    buffer_load_dword v12, v13, s[8:11], s19 offen sc1
    s_waitcnt lgkmcnt(6)
    v_mfma_f32_16x16x32_bf16 v[128:131], v[244:247], v[48:51], v[128:131]
    s_add_u32 s22, s24, 0x3a0000
    s_add_u32 m0, s20, 0x24000
    s_nop 0
    buffer_load_dwordx4 v3, s[4:7], s22 offen lds
    ds_read_b64_tr_b16 v[236:237], v5 offset:16416
    v_mfma_f32_16x16x32_bf16 v[132:135], v[244:247], v[52:55], v[132:135]
    ds_read_b64_tr_b16 v[238:239], v5 offset:17440
    s_waitcnt lgkmcnt(6)
    v_mfma_f32_16x16x32_bf16 v[136:139], v[224:227], v[48:51], v[136:139]
    ds_read_b64_tr_b16 v[240:241], v4 offset:16640
    v_mfma_f32_16x16x32_bf16 v[140:143], v[224:227], v[52:55], v[140:143]
    s_add_u32 s22, s24, 0x3a2000
    s_add_u32 m0, s20, 0x24400
    s_nop 0
    buffer_load_dwordx4 v3, s[4:7], s22 offen lds
    ds_read_b64_tr_b16 v[242:243], v4 offset:17664
    s_waitcnt lgkmcnt(6)
    v_mfma_f32_16x16x32_bf16 v[144:147], v[228:231], v[48:51], v[144:147]
    ds_read_b64_tr_b16 v[244:245], v5 offset:16672
    v_mfma_f32_16x16x32_bf16 v[148:151], v[228:231], v[52:55], v[148:151]
    ds_read_b64_tr_b16 v[246:247], v5 offset:17696
    s_waitcnt vmcnt(17) lgkmcnt(6)
    v_mfma_f32_16x16x32_bf16 v[88:91], v[232:235], v[56:59], v[88:91]
    ds_read_b64_tr_b16 v[224:225], v4 offset:16896
    s_waitcnt vmcnt(16)
    v_mfma_f32_16x16x32_bf16 v[92:95], v[232:235], v[60:63], v[92:95]
    ds_read_b64_tr_b16 v[226:227], v4 offset:17920
    s_waitcnt lgkmcnt(6)
    v_mfma_f32_16x16x32_bf16 v[96:99], v[236:239], v[56:59], v[96:99]
    ds_read_b64_tr_b16 v[228:229], v5 offset:16928
    s_mov_b32 s23, 0xe000
    buffer_load_dwordx4 v[48:51], v6, s[8:11], s23 offen offset:2048 sc1
    v_mfma_f32_16x16x32_bf16 v[100:103], v[236:239], v[60:63], v[100:103]
    ds_read_b64_tr_b16 v[230:231], v5 offset:17952
    s_waitcnt lgkmcnt(6)
    v_mfma_f32_16x16x32_bf16 v[104:107], v[240:243], v[56:59], v[104:107]
    ds_read_b64_tr_b16 v[232:233], v4 offset:17152
    v_mfma_f32_16x16x32_bf16 v[108:111], v[240:243], v[60:63], v[108:111]
    ds_read_b64_tr_b16 v[234:235], v4 offset:18176
    s_mov_b32 s23, 0x2e000
    buffer_load_dwordx4 v[52:55], v6, s[8:11], s23 offen offset:2048 sc1
    s_waitcnt lgkmcnt(6)
    v_mfma_f32_16x16x32_bf16 v[112:115], v[244:247], v[56:59], v[112:115]
    ds_read_b64_tr_b16 v[236:237], v5 offset:17184
    v_mfma_f32_16x16x32_bf16 v[116:119], v[244:247], v[60:63], v[116:119]
    ds_read_b64_tr_b16 v[238:239], v5 offset:18208
    s_waitcnt lgkmcnt(6)
    v_mfma_f32_16x16x32_bf16 v[120:123], v[224:227], v[56:59], v[120:123]
    v_mfma_f32_16x16x32_bf16 v[124:127], v[224:227], v[60:63], v[124:127]
    s_waitcnt vmcnt(16)
    s_barrier
    ds_read_b64_tr_b16 v[240:241], v4 offset:32768
    ds_read_b64_tr_b16 v[242:243], v4 offset:33792
    s_waitcnt lgkmcnt(6)
    v_mfma_f32_16x16x32_bf16 v[128:131], v[228:231], v[56:59], v[128:131]
    s_add_u32 s22, s24, 0x30000
    s_add_u32 m0, s20, 0x10000
    s_nop 0
    buffer_load_dwordx4 v3, s[4:7], s22 offen lds
    ds_read_b64_tr_b16 v[244:245], v5 offset:32800
    v_mfma_f32_16x16x32_bf16 v[132:135], v[228:231], v[60:63], v[132:135]
    ds_read_b64_tr_b16 v[246:247], v5 offset:33824
    s_waitcnt lgkmcnt(6)
    v_mfma_f32_16x16x32_bf16 v[136:139], v[232:235], v[56:59], v[136:139]
    ds_read_b64_tr_b16 v[224:225], v4 offset:33024
    v_mfma_f32_16x16x32_bf16 v[140:143], v[232:235], v[60:63], v[140:143]
    s_add_u32 s22, s24, 0x32000
    s_add_u32 m0, s20, 0x10400
    s_nop 0
    buffer_load_dwordx4 v3, s[4:7], s22 offen lds
    ds_read_b64_tr_b16 v[226:227], v4 offset:34048
    s_waitcnt lgkmcnt(6)
    v_mfma_f32_16x16x32_bf16 v[144:147], v[236:239], v[56:59], v[144:147]
    ds_read_b64_tr_b16 v[228:229], v5 offset:33056
    v_mfma_f32_16x16x32_bf16 v[148:151], v[236:239], v[60:63], v[148:151]
    ds_read_b64_tr_b16 v[230:231], v5 offset:34080
    s_waitcnt vmcnt(6)
    v_cmp_ne_u32 vcc, s28, v12
    s_cbranch_vccnz adaLN_cond__sliding_block_cached__moe_arch_mod__prompt_kernel_o29r
adaLN_cond__sliding_block_cached__moe_arch_mod__prompt_kernel_o29b:
    s_waitcnt lgkmcnt(6)
    v_mfma_f32_16x16x32_bf16 v[88:91], v[240:243], v[24:27], v[88:91]
    ds_read_b64_tr_b16 v[232:233], v4 offset:33280
    v_mfma_f32_16x16x32_bf16 v[92:95], v[240:243], v[28:31], v[92:95]
    ds_read_b64_tr_b16 v[234:235], v4 offset:34304
    s_waitcnt lgkmcnt(6)
    v_mfma_f32_16x16x32_bf16 v[96:99], v[244:247], v[24:27], v[96:99]
    ds_read_b64_tr_b16 v[236:237], v5 offset:33312
    s_mov_b32 s23, 0x0
    buffer_load_dwordx4 v[56:59], v6, s[8:11], s23 offen offset:3072 sc1
    v_mfma_f32_16x16x32_bf16 v[100:103], v[244:247], v[28:31], v[100:103]
    ds_read_b64_tr_b16 v[238:239], v5 offset:34336
    s_waitcnt lgkmcnt(6)
    v_mfma_f32_16x16x32_bf16 v[104:107], v[224:227], v[24:27], v[104:107]
    ds_read_b64_tr_b16 v[240:241], v4 offset:33536
    v_mfma_f32_16x16x32_bf16 v[108:111], v[224:227], v[28:31], v[108:111]
    ds_read_b64_tr_b16 v[242:243], v4 offset:34560
    s_mov_b32 s23, 0x20000
    buffer_load_dwordx4 v[60:63], v6, s[8:11], s23 offen offset:3072 sc1
    v_xor_b32 v16, s28, v184
    v_xor_b32 v17, s28, v185
    v_xor_b32 v18, s28, v186
    v_xor_b32 v19, s28, v187
    v_or3_b32 v16, v16, v17, v18
    v_or_b32 v16, v16, v19
    v_cmp_ne_u32 vcc, 0, v16
    s_cbranch_vccnz adaLN_cond__sliding_block_cached__moe_arch_mod__prompt_kernel_mf10r
adaLN_cond__sliding_block_cached__moe_arch_mod__prompt_kernel_mf10b:
    s_waitcnt lgkmcnt(6)
    v_mfma_f32_16x16x32_bf16 v[112:115], v[228:231], v[24:27], v[112:115]
    ds_read_b64_tr_b16 v[244:245], v5 offset:33568
    v_mfma_f32_16x16x32_bf16 v[116:119], v[228:231], v[28:31], v[116:119]
    ds_read_b64_tr_b16 v[246:247], v5 offset:34592
    s_waitcnt lgkmcnt(6)
    v_mfma_f32_16x16x32_bf16 v[120:123], v[232:235], v[24:27], v[120:123]
    v_mfma_f32_16x16x32_bf16 v[124:127], v[232:235], v[28:31], v[124:127]
    s_barrier
    ds_read_b64_tr_b16 v[224:225], v4 offset:49152
    ds_read_b64_tr_b16 v[226:227], v4 offset:50176
    s_waitcnt lgkmcnt(6)
    v_mfma_f32_16x16x32_bf16 v[128:131], v[236:239], v[24:27], v[128:131]
    s_add_u32 s22, s24, 0xb0000
    s_add_u32 m0, s20, 0x14000
    s_nop 0
    buffer_load_dwordx4 v3, s[4:7], s22 offen lds
    ds_read_b64_tr_b16 v[228:229], v5 offset:49184
    v_mfma_f32_16x16x32_bf16 v[132:135], v[236:239], v[28:31], v[132:135]
    ds_read_b64_tr_b16 v[230:231], v5 offset:50208
    s_waitcnt lgkmcnt(6)
    v_mfma_f32_16x16x32_bf16 v[136:139], v[240:243], v[24:27], v[136:139]
    ds_read_b64_tr_b16 v[232:233], v4 offset:49408
    v_mfma_f32_16x16x32_bf16 v[140:143], v[240:243], v[28:31], v[140:143]
    s_add_u32 s22, s24, 0xb2000
    s_add_u32 m0, s20, 0x14400
    s_nop 0
    buffer_load_dwordx4 v3, s[4:7], s22 offen lds
    ds_read_b64_tr_b16 v[234:235], v4 offset:50432
    s_waitcnt lgkmcnt(6)
    v_mfma_f32_16x16x32_bf16 v[144:147], v[244:247], v[24:27], v[144:147]
    ds_read_b64_tr_b16 v[236:237], v5 offset:49440
    v_mfma_f32_16x16x32_bf16 v[148:151], v[244:247], v[28:31], v[148:151]
    ds_read_b64_tr_b16 v[238:239], v5 offset:50464
    s_waitcnt lgkmcnt(6)
    v_mfma_f32_16x16x32_bf16 v[88:91], v[224:227], v[32:35], v[88:91]
    ds_read_b64_tr_b16 v[240:241], v4 offset:49664
    v_mfma_f32_16x16x32_bf16 v[92:95], v[224:227], v[36:39], v[92:95]
    ds_read_b64_tr_b16 v[242:243], v4 offset:50688
    s_waitcnt lgkmcnt(6)
    v_mfma_f32_16x16x32_bf16 v[96:99], v[228:231], v[32:35], v[96:99]
    ds_read_b64_tr_b16 v[244:245], v5 offset:49696
    s_mov_b32 s23, 0x2000
    buffer_load_dwordx4 v[24:27], v6, s[8:11], s23 offen offset:3072 sc1
    v_mfma_f32_16x16x32_bf16 v[100:103], v[228:231], v[36:39], v[100:103]
    ds_read_b64_tr_b16 v[246:247], v5 offset:50720
    s_waitcnt lgkmcnt(6)
    v_mfma_f32_16x16x32_bf16 v[104:107], v[232:235], v[32:35], v[104:107]
    ds_read_b64_tr_b16 v[224:225], v4 offset:49920
    v_mfma_f32_16x16x32_bf16 v[108:111], v[232:235], v[36:39], v[108:111]
    ds_read_b64_tr_b16 v[226:227], v4 offset:50944
    s_mov_b32 s23, 0x22000
    buffer_load_dwordx4 v[28:31], v6, s[8:11], s23 offen offset:3072 sc1
    s_waitcnt lgkmcnt(6)
    v_mfma_f32_16x16x32_bf16 v[112:115], v[236:239], v[32:35], v[112:115]
    ds_read_b64_tr_b16 v[228:229], v5 offset:49952
    v_mfma_f32_16x16x32_bf16 v[116:119], v[236:239], v[36:39], v[116:119]
    ds_read_b64_tr_b16 v[230:231], v5 offset:50976
    s_waitcnt lgkmcnt(6)
    v_mfma_f32_16x16x32_bf16 v[120:123], v[240:243], v[32:35], v[120:123]
    v_mfma_f32_16x16x32_bf16 v[124:127], v[240:243], v[36:39], v[124:127]
    s_barrier
    ds_read_b64_tr_b16 v[232:233], v7 offset:0
    ds_read_b64_tr_b16 v[234:235], v7 offset:1024
    s_waitcnt lgkmcnt(6)
    v_mfma_f32_16x16x32_bf16 v[128:131], v[244:247], v[32:35], v[128:131]
    s_add_u32 s22, s24, 0x130000
    s_add_u32 m0, s20, 0x18000
    s_nop 0
    buffer_load_dwordx4 v3, s[4:7], s22 offen lds
    ds_read_b64_tr_b16 v[236:237], v8 offset:32
    v_mfma_f32_16x16x32_bf16 v[132:135], v[244:247], v[36:39], v[132:135]
    ds_read_b64_tr_b16 v[238:239], v8 offset:1056
    s_waitcnt lgkmcnt(6)
    v_mfma_f32_16x16x32_bf16 v[136:139], v[224:227], v[32:35], v[136:139]
    ds_read_b64_tr_b16 v[240:241], v7 offset:256
    v_mfma_f32_16x16x32_bf16 v[140:143], v[224:227], v[36:39], v[140:143]
    s_add_u32 s22, s24, 0x132000
    s_add_u32 m0, s20, 0x18400
    s_nop 0
    buffer_load_dwordx4 v3, s[4:7], s22 offen lds
    ds_read_b64_tr_b16 v[242:243], v7 offset:1280
    s_waitcnt lgkmcnt(6)
    v_mfma_f32_16x16x32_bf16 v[144:147], v[228:231], v[32:35], v[144:147]
    ds_read_b64_tr_b16 v[244:245], v8 offset:288
    v_mfma_f32_16x16x32_bf16 v[148:151], v[228:231], v[36:39], v[148:151]
    ds_read_b64_tr_b16 v[246:247], v8 offset:1312
    s_waitcnt lgkmcnt(6)
    v_mfma_f32_16x16x32_bf16 v[88:91], v[232:235], v[40:43], v[88:91]
    ds_read_b64_tr_b16 v[224:225], v7 offset:512
    v_mfma_f32_16x16x32_bf16 v[92:95], v[232:235], v[44:47], v[92:95]
    ds_read_b64_tr_b16 v[226:227], v7 offset:1536
    s_waitcnt lgkmcnt(6)
    v_mfma_f32_16x16x32_bf16 v[96:99], v[236:239], v[40:43], v[96:99]
    ds_read_b64_tr_b16 v[228:229], v8 offset:544
    s_mov_b32 s23, 0x4000
    buffer_load_dwordx4 v[32:35], v6, s[8:11], s23 offen offset:3072 sc1
    v_mfma_f32_16x16x32_bf16 v[100:103], v[236:239], v[44:47], v[100:103]
    ds_read_b64_tr_b16 v[230:231], v8 offset:1568
    s_waitcnt lgkmcnt(6)
    v_mfma_f32_16x16x32_bf16 v[104:107], v[240:243], v[40:43], v[104:107]
    ds_read_b64_tr_b16 v[232:233], v7 offset:768
    v_mfma_f32_16x16x32_bf16 v[108:111], v[240:243], v[44:47], v[108:111]
    ds_read_b64_tr_b16 v[234:235], v7 offset:1792
    s_mov_b32 s23, 0x24000
    buffer_load_dwordx4 v[36:39], v6, s[8:11], s23 offen offset:3072 sc1
    s_waitcnt lgkmcnt(6)
    v_mfma_f32_16x16x32_bf16 v[112:115], v[244:247], v[40:43], v[112:115]
    ds_read_b64_tr_b16 v[236:237], v8 offset:800
    v_mfma_f32_16x16x32_bf16 v[116:119], v[244:247], v[44:47], v[116:119]
    ds_read_b64_tr_b16 v[238:239], v8 offset:1824
    s_waitcnt lgkmcnt(6)
    v_mfma_f32_16x16x32_bf16 v[120:123], v[224:227], v[40:43], v[120:123]
    v_mfma_f32_16x16x32_bf16 v[124:127], v[224:227], v[44:47], v[124:127]
    s_waitcnt vmcnt(14)
    s_barrier
    ds_read_b64_tr_b16 v[240:241], v7 offset:16384
    ds_read_b64_tr_b16 v[242:243], v7 offset:17408
    s_waitcnt lgkmcnt(6)
    v_mfma_f32_16x16x32_bf16 v[128:131], v[228:231], v[40:43], v[128:131]
    s_add_u32 s22, s24, 0x1b0000
    s_add_u32 m0, s20, 0x1c000
    s_nop 0
    buffer_load_dwordx4 v3, s[4:7], s22 offen lds
    ds_read_b64_tr_b16 v[244:245], v8 offset:16416
    v_mfma_f32_16x16x32_bf16 v[132:135], v[228:231], v[44:47], v[132:135]
    ds_read_b64_tr_b16 v[246:247], v8 offset:17440
    s_waitcnt lgkmcnt(6)
    v_mfma_f32_16x16x32_bf16 v[136:139], v[232:235], v[40:43], v[136:139]
    ds_read_b64_tr_b16 v[224:225], v7 offset:16640
    v_mfma_f32_16x16x32_bf16 v[140:143], v[232:235], v[44:47], v[140:143]
    s_add_u32 s22, s24, 0x1b2000
    s_add_u32 m0, s20, 0x1c400
    s_nop 0
    buffer_load_dwordx4 v3, s[4:7], s22 offen lds
    ds_read_b64_tr_b16 v[226:227], v7 offset:17664
    s_waitcnt lgkmcnt(6)
    v_mfma_f32_16x16x32_bf16 v[144:147], v[236:239], v[40:43], v[144:147]
    ds_read_b64_tr_b16 v[228:229], v8 offset:16672
    v_mfma_f32_16x16x32_bf16 v[148:151], v[236:239], v[44:47], v[148:151]
    ds_read_b64_tr_b16 v[230:231], v8 offset:17696
    s_waitcnt vmcnt(15) lgkmcnt(6)
    v_mfma_f32_16x16x32_bf16 v[88:91], v[240:243], v[48:51], v[88:91]
    ds_read_b64_tr_b16 v[232:233], v7 offset:16896
    s_waitcnt vmcnt(14)
    v_mfma_f32_16x16x32_bf16 v[92:95], v[240:243], v[52:55], v[92:95]
    ds_read_b64_tr_b16 v[234:235], v7 offset:17920
    s_waitcnt lgkmcnt(6)
    v_mfma_f32_16x16x32_bf16 v[96:99], v[244:247], v[48:51], v[96:99]
    ds_read_b64_tr_b16 v[236:237], v8 offset:16928
    s_mov_b32 s23, 0x6000
    buffer_load_dwordx4 v[40:43], v6, s[8:11], s23 offen offset:3072 sc1
    v_mfma_f32_16x16x32_bf16 v[100:103], v[244:247], v[52:55], v[100:103]
    ds_read_b64_tr_b16 v[238:239], v8 offset:17952
    s_waitcnt lgkmcnt(6)
    v_mfma_f32_16x16x32_bf16 v[104:107], v[224:227], v[48:51], v[104:107]
    ds_read_b64_tr_b16 v[240:241], v7 offset:17152
    v_mfma_f32_16x16x32_bf16 v[108:111], v[224:227], v[52:55], v[108:111]
    ds_read_b64_tr_b16 v[242:243], v7 offset:18176
    s_mov_b32 s23, 0x26000
    buffer_load_dwordx4 v[44:47], v6, s[8:11], s23 offen offset:3072 sc1
    s_waitcnt lgkmcnt(6)
    v_mfma_f32_16x16x32_bf16 v[112:115], v[228:231], v[48:51], v[112:115]
    ds_read_b64_tr_b16 v[244:245], v8 offset:17184
    v_mfma_f32_16x16x32_bf16 v[116:119], v[228:231], v[52:55], v[116:119]
    ds_read_b64_tr_b16 v[246:247], v8 offset:18208
    s_waitcnt lgkmcnt(6)
    v_mfma_f32_16x16x32_bf16 v[120:123], v[232:235], v[48:51], v[120:123]
    v_mfma_f32_16x16x32_bf16 v[124:127], v[232:235], v[52:55], v[124:127]
    s_waitcnt vmcnt(14)
    s_barrier
    ds_read_b64_tr_b16 v[224:225], v4 offset:0
    ds_read_b64_tr_b16 v[226:227], v4 offset:1024
    s_waitcnt lgkmcnt(6)
    v_mfma_f32_16x16x32_bf16 v[128:131], v[236:239], v[48:51], v[128:131]
    s_add_u32 s22, s24, 0x230000
    s_add_u32 m0, s20, 0x20000
    s_nop 0
    buffer_load_dwordx4 v3, s[4:7], s22 offen lds
    ds_read_b64_tr_b16 v[228:229], v5 offset:32
    v_mfma_f32_16x16x32_bf16 v[132:135], v[236:239], v[52:55], v[132:135]
    ds_read_b64_tr_b16 v[230:231], v5 offset:1056
    s_waitcnt lgkmcnt(6)
    v_mfma_f32_16x16x32_bf16 v[136:139], v[240:243], v[48:51], v[136:139]
    ds_read_b64_tr_b16 v[232:233], v4 offset:256
    v_mfma_f32_16x16x32_bf16 v[140:143], v[240:243], v[52:55], v[140:143]
    s_add_u32 s22, s24, 0x232000
    s_add_u32 m0, s20, 0x20400
    s_nop 0
    buffer_load_dwordx4 v3, s[4:7], s22 offen lds
    ds_read_b64_tr_b16 v[234:235], v4 offset:1280
    s_waitcnt lgkmcnt(6)
    v_mfma_f32_16x16x32_bf16 v[144:147], v[244:247], v[48:51], v[144:147]
    ds_read_b64_tr_b16 v[236:237], v5 offset:288
    v_mfma_f32_16x16x32_bf16 v[148:151], v[244:247], v[52:55], v[148:151]
    ds_read_b64_tr_b16 v[238:239], v5 offset:1312
    s_waitcnt vmcnt(15) lgkmcnt(6)
    v_mfma_f32_16x16x32_bf16 v[88:91], v[224:227], v[56:59], v[88:91]
    ds_read_b64_tr_b16 v[240:241], v4 offset:512
    s_waitcnt vmcnt(14)
    v_mfma_f32_16x16x32_bf16 v[92:95], v[224:227], v[60:63], v[92:95]
    ds_read_b64_tr_b16 v[242:243], v4 offset:1536
    s_waitcnt lgkmcnt(6)
    v_mfma_f32_16x16x32_bf16 v[96:99], v[228:231], v[56:59], v[96:99]
    ds_read_b64_tr_b16 v[244:245], v5 offset:544
    s_mov_b32 s23, 0x8000
    buffer_load_dwordx4 v[48:51], v6, s[8:11], s23 offen offset:3072 sc1
    v_mfma_f32_16x16x32_bf16 v[100:103], v[228:231], v[60:63], v[100:103]
    ds_read_b64_tr_b16 v[246:247], v5 offset:1568
    s_waitcnt lgkmcnt(6)
    v_mfma_f32_16x16x32_bf16 v[104:107], v[232:235], v[56:59], v[104:107]
    ds_read_b64_tr_b16 v[224:225], v4 offset:768
    v_mfma_f32_16x16x32_bf16 v[108:111], v[232:235], v[60:63], v[108:111]
    ds_read_b64_tr_b16 v[226:227], v4 offset:1792
    s_mov_b32 s23, 0x28000
    buffer_load_dwordx4 v[52:55], v6, s[8:11], s23 offen offset:3072 sc1
    s_waitcnt lgkmcnt(6)
    v_mfma_f32_16x16x32_bf16 v[112:115], v[236:239], v[56:59], v[112:115]
    ds_read_b64_tr_b16 v[228:229], v5 offset:800
    v_mfma_f32_16x16x32_bf16 v[116:119], v[236:239], v[60:63], v[116:119]
    ds_read_b64_tr_b16 v[230:231], v5 offset:1824
    s_waitcnt lgkmcnt(6)
    v_mfma_f32_16x16x32_bf16 v[120:123], v[240:243], v[56:59], v[120:123]
    v_mfma_f32_16x16x32_bf16 v[124:127], v[240:243], v[60:63], v[124:127]
    s_waitcnt vmcnt(14)
    s_barrier
    ds_read_b64_tr_b16 v[232:233], v4 offset:16384
    ds_read_b64_tr_b16 v[234:235], v4 offset:17408
    s_waitcnt lgkmcnt(6)
    v_mfma_f32_16x16x32_bf16 v[128:131], v[244:247], v[56:59], v[128:131]
    s_add_u32 s22, s24, 0x2b0000
    s_add_u32 m0, s20, 0x24000
    s_nop 0
    buffer_load_dwordx4 v3, s[4:7], s22 offen lds
    ds_read_b64_tr_b16 v[236:237], v5 offset:16416
    v_mfma_f32_16x16x32_bf16 v[132:135], v[244:247], v[60:63], v[132:135]
    ds_read_b64_tr_b16 v[238:239], v5 offset:17440
    s_waitcnt lgkmcnt(6)
    v_mfma_f32_16x16x32_bf16 v[136:139], v[224:227], v[56:59], v[136:139]
    ds_read_b64_tr_b16 v[240:241], v4 offset:16640
    v_mfma_f32_16x16x32_bf16 v[140:143], v[224:227], v[60:63], v[140:143]
    s_add_u32 s22, s24, 0x2b2000
    s_add_u32 m0, s20, 0x24400
    s_nop 0
    buffer_load_dwordx4 v3, s[4:7], s22 offen lds
    ds_read_b64_tr_b16 v[242:243], v4 offset:17664
    s_waitcnt lgkmcnt(6)
    v_mfma_f32_16x16x32_bf16 v[144:147], v[228:231], v[56:59], v[144:147]
    ds_read_b64_tr_b16 v[244:245], v5 offset:16672
    v_mfma_f32_16x16x32_bf16 v[148:151], v[228:231], v[60:63], v[148:151]
    ds_read_b64_tr_b16 v[246:247], v5 offset:17696
    s_waitcnt vmcnt(15) lgkmcnt(6)
    v_mfma_f32_16x16x32_bf16 v[88:91], v[232:235], v[24:27], v[88:91]
    ds_read_b64_tr_b16 v[224:225], v4 offset:16896
    s_waitcnt vmcnt(14)
    v_mfma_f32_16x16x32_bf16 v[92:95], v[232:235], v[28:31], v[92:95]
    ds_read_b64_tr_b16 v[226:227], v4 offset:17920
    s_waitcnt lgkmcnt(6)
    v_mfma_f32_16x16x32_bf16 v[96:99], v[236:239], v[24:27], v[96:99]
    ds_read_b64_tr_b16 v[228:229], v5 offset:16928
    s_mov_b32 s23, 0xa000
    buffer_load_dwordx4 v[56:59], v6, s[8:11], s23 offen offset:3072 sc1
    v_mfma_f32_16x16x32_bf16 v[100:103], v[236:239], v[28:31], v[100:103]
    ds_read_b64_tr_b16 v[230:231], v5 offset:17952
    s_waitcnt lgkmcnt(6)
    v_mfma_f32_16x16x32_bf16 v[104:107], v[240:243], v[24:27], v[104:107]
    ds_read_b64_tr_b16 v[232:233], v4 offset:17152
    v_mfma_f32_16x16x32_bf16 v[108:111], v[240:243], v[28:31], v[108:111]
    ds_read_b64_tr_b16 v[234:235], v4 offset:18176
    s_mov_b32 s23, 0x2a000
    buffer_load_dwordx4 v[60:63], v6, s[8:11], s23 offen offset:3072 sc1
    s_waitcnt lgkmcnt(6)
    v_mfma_f32_16x16x32_bf16 v[112:115], v[244:247], v[24:27], v[112:115]
    ds_read_b64_tr_b16 v[236:237], v5 offset:17184
    v_mfma_f32_16x16x32_bf16 v[116:119], v[244:247], v[28:31], v[116:119]
    ds_read_b64_tr_b16 v[238:239], v5 offset:18208
    s_waitcnt lgkmcnt(6)
    v_mfma_f32_16x16x32_bf16 v[120:123], v[224:227], v[24:27], v[120:123]
    v_mfma_f32_16x16x32_bf16 v[124:127], v[224:227], v[28:31], v[124:127]
    s_waitcnt vmcnt(14)
    s_barrier
    ds_read_b64_tr_b16 v[240:241], v4 offset:32768
    ds_read_b64_tr_b16 v[242:243], v4 offset:33792
    s_waitcnt lgkmcnt(6)
    v_mfma_f32_16x16x32_bf16 v[128:131], v[228:231], v[24:27], v[128:131]
    s_add_u32 s22, s24, 0x330000
    s_add_u32 m0, s20, 0x10000
    s_nop 0
    buffer_load_dwordx4 v3, s[4:7], s22 offen lds
    ds_read_b64_tr_b16 v[244:245], v5 offset:32800
    v_mfma_f32_16x16x32_bf16 v[132:135], v[228:231], v[28:31], v[132:135]
    ds_read_b64_tr_b16 v[246:247], v5 offset:33824
    s_waitcnt lgkmcnt(6)
    v_mfma_f32_16x16x32_bf16 v[136:139], v[232:235], v[24:27], v[136:139]
    ds_read_b64_tr_b16 v[224:225], v4 offset:33024
    v_mfma_f32_16x16x32_bf16 v[140:143], v[232:235], v[28:31], v[140:143]
    s_add_u32 s22, s24, 0x332000
    s_add_u32 m0, s20, 0x10400
    s_nop 0
    buffer_load_dwordx4 v3, s[4:7], s22 offen lds
    ds_read_b64_tr_b16 v[226:227], v4 offset:34048
    s_waitcnt lgkmcnt(6)
    v_mfma_f32_16x16x32_bf16 v[144:147], v[236:239], v[24:27], v[144:147]
    ds_read_b64_tr_b16 v[228:229], v5 offset:33056
    v_mfma_f32_16x16x32_bf16 v[148:151], v[236:239], v[28:31], v[148:151]
    ds_read_b64_tr_b16 v[230:231], v5 offset:34080
    s_waitcnt vmcnt(15) lgkmcnt(6)
    v_mfma_f32_16x16x32_bf16 v[88:91], v[240:243], v[32:35], v[88:91]
    ds_read_b64_tr_b16 v[232:233], v4 offset:33280
    s_waitcnt vmcnt(14)
    v_mfma_f32_16x16x32_bf16 v[92:95], v[240:243], v[36:39], v[92:95]
    ds_read_b64_tr_b16 v[234:235], v4 offset:34304
    s_waitcnt lgkmcnt(6)
    v_mfma_f32_16x16x32_bf16 v[96:99], v[244:247], v[32:35], v[96:99]
    ds_read_b64_tr_b16 v[236:237], v5 offset:33312
    s_mov_b32 s23, 0xc000
    buffer_load_dwordx4 v[24:27], v6, s[8:11], s23 offen offset:3072 sc1
    v_mfma_f32_16x16x32_bf16 v[100:103], v[244:247], v[36:39], v[100:103]
    ds_read_b64_tr_b16 v[238:239], v5 offset:34336
    s_waitcnt lgkmcnt(6)
    v_mfma_f32_16x16x32_bf16 v[104:107], v[224:227], v[32:35], v[104:107]
    ds_read_b64_tr_b16 v[240:241], v4 offset:33536
    v_mfma_f32_16x16x32_bf16 v[108:111], v[224:227], v[36:39], v[108:111]
    ds_read_b64_tr_b16 v[242:243], v4 offset:34560
    s_mov_b32 s23, 0x2c000
    buffer_load_dwordx4 v[28:31], v6, s[8:11], s23 offen offset:3072 sc1
    v_lshrrev_b32 v16, 4, v1
    v_lshlrev_b32 v16, 3, v16
    s_lshl_b32 s16, s31, 8
    s_add_u32 s16, s16, 0x540000
    buffer_load_dwordx2 v[248:249], v16, s[8:11], s16 offen offset:0 sc1
    buffer_load_dwordx2 v[250:251], v16, s[8:11], s16 offen offset:32 sc1
    buffer_load_dwordx2 v[252:253], v16, s[8:11], s16 offen offset:64 sc1
    buffer_load_dwordx2 v[254:255], v16, s[8:11], s16 offen offset:96 sc1
    s_waitcnt lgkmcnt(6)
    v_mfma_f32_16x16x32_bf16 v[112:115], v[228:231], v[32:35], v[112:115]
    ds_read_b64_tr_b16 v[244:245], v5 offset:33568
    v_mfma_f32_16x16x32_bf16 v[116:119], v[228:231], v[36:39], v[116:119]
    ds_read_b64_tr_b16 v[246:247], v5 offset:34592
    s_waitcnt lgkmcnt(6)
    v_mfma_f32_16x16x32_bf16 v[120:123], v[232:235], v[32:35], v[120:123]
    v_mfma_f32_16x16x32_bf16 v[124:127], v[232:235], v[36:39], v[124:127]
    s_waitcnt vmcnt(18)
    s_barrier
    ds_read_b64_tr_b16 v[224:225], v4 offset:49152
    ds_read_b64_tr_b16 v[226:227], v4 offset:50176
    s_waitcnt lgkmcnt(6)
    v_mfma_f32_16x16x32_bf16 v[128:131], v[236:239], v[32:35], v[128:131]
    s_add_u32 s22, s24, 0x3b0000
    s_add_u32 m0, s20, 0x14000
    s_nop 0
    buffer_load_dwordx4 v3, s[4:7], s22 offen lds
    ds_read_b64_tr_b16 v[228:229], v5 offset:49184
    v_mfma_f32_16x16x32_bf16 v[132:135], v[236:239], v[36:39], v[132:135]
    ds_read_b64_tr_b16 v[230:231], v5 offset:50208
    s_waitcnt lgkmcnt(6)
    v_mfma_f32_16x16x32_bf16 v[136:139], v[240:243], v[32:35], v[136:139]
    ds_read_b64_tr_b16 v[232:233], v4 offset:49408
    v_mfma_f32_16x16x32_bf16 v[140:143], v[240:243], v[36:39], v[140:143]
    s_add_u32 s22, s24, 0x3b2000
    s_add_u32 m0, s20, 0x14400
    s_nop 0
    buffer_load_dwordx4 v3, s[4:7], s22 offen lds
    ds_read_b64_tr_b16 v[234:235], v4 offset:50432
    s_waitcnt lgkmcnt(6)
    v_mfma_f32_16x16x32_bf16 v[144:147], v[244:247], v[32:35], v[144:147]
    ds_read_b64_tr_b16 v[236:237], v5 offset:49440
    v_mfma_f32_16x16x32_bf16 v[148:151], v[244:247], v[36:39], v[148:151]
    ds_read_b64_tr_b16 v[238:239], v5 offset:50464
    s_waitcnt vmcnt(19) lgkmcnt(6)
    v_mfma_f32_16x16x32_bf16 v[88:91], v[224:227], v[40:43], v[88:91]
    ds_read_b64_tr_b16 v[240:241], v4 offset:49664
    s_waitcnt vmcnt(18)
    v_mfma_f32_16x16x32_bf16 v[92:95], v[224:227], v[44:47], v[92:95]
    ds_read_b64_tr_b16 v[242:243], v4 offset:50688
    s_waitcnt lgkmcnt(6)
    v_mfma_f32_16x16x32_bf16 v[96:99], v[228:231], v[40:43], v[96:99]
    ds_read_b64_tr_b16 v[244:245], v5 offset:49696
    s_mov_b32 s23, 0xe000
    buffer_load_dwordx4 v[32:35], v6, s[8:11], s23 offen offset:3072 sc1
    v_mfma_f32_16x16x32_bf16 v[100:103], v[228:231], v[44:47], v[100:103]
    ds_read_b64_tr_b16 v[246:247], v5 offset:50720
    s_waitcnt lgkmcnt(6)
    v_mfma_f32_16x16x32_bf16 v[104:107], v[232:235], v[40:43], v[104:107]
    ds_read_b64_tr_b16 v[224:225], v4 offset:49920
    v_mfma_f32_16x16x32_bf16 v[108:111], v[232:235], v[44:47], v[108:111]
    ds_read_b64_tr_b16 v[226:227], v4 offset:50944
    s_mov_b32 s23, 0x2e000
    buffer_load_dwordx4 v[36:39], v6, s[8:11], s23 offen offset:3072 sc1
    s_waitcnt lgkmcnt(6)
    v_mfma_f32_16x16x32_bf16 v[112:115], v[236:239], v[40:43], v[112:115]
    ds_read_b64_tr_b16 v[228:229], v5 offset:49952
    v_mfma_f32_16x16x32_bf16 v[116:119], v[236:239], v[44:47], v[116:119]
    ds_read_b64_tr_b16 v[230:231], v5 offset:50976
    s_waitcnt lgkmcnt(6)
    v_mfma_f32_16x16x32_bf16 v[120:123], v[240:243], v[40:43], v[120:123]
    v_mfma_f32_16x16x32_bf16 v[124:127], v[240:243], v[44:47], v[124:127]
    s_waitcnt vmcnt(18)
    s_barrier
    ds_read_b64_tr_b16 v[232:233], v7 offset:0
    ds_read_b64_tr_b16 v[234:235], v7 offset:1024
    s_waitcnt lgkmcnt(6)
    v_mfma_f32_16x16x32_bf16 v[128:131], v[244:247], v[40:43], v[128:131]
    ds_read_b64_tr_b16 v[236:237], v8 offset:32
    v_mfma_f32_16x16x32_bf16 v[132:135], v[244:247], v[44:47], v[132:135]
    ds_read_b64_tr_b16 v[238:239], v8 offset:1056
    s_waitcnt lgkmcnt(6)
    v_mfma_f32_16x16x32_bf16 v[136:139], v[224:227], v[40:43], v[136:139]
    ds_read_b64_tr_b16 v[240:241], v7 offset:256
    v_mfma_f32_16x16x32_bf16 v[140:143], v[224:227], v[44:47], v[140:143]
    ds_read_b64_tr_b16 v[242:243], v7 offset:1280
    s_waitcnt lgkmcnt(6)
    v_mfma_f32_16x16x32_bf16 v[144:147], v[228:231], v[40:43], v[144:147]
    ds_read_b64_tr_b16 v[244:245], v8 offset:288
    v_mfma_f32_16x16x32_bf16 v[148:151], v[228:231], v[44:47], v[148:151]
    ds_read_b64_tr_b16 v[246:247], v8 offset:1312
    s_waitcnt vmcnt(17) lgkmcnt(6)
    v_mfma_f32_16x16x32_bf16 v[88:91], v[232:235], v[48:51], v[88:91]
    ds_read_b64_tr_b16 v[224:225], v7 offset:512
    s_waitcnt vmcnt(16)
    v_mfma_f32_16x16x32_bf16 v[92:95], v[232:235], v[52:55], v[92:95]
    ds_read_b64_tr_b16 v[226:227], v7 offset:1536
    s_waitcnt lgkmcnt(6)
    v_mfma_f32_16x16x32_bf16 v[96:99], v[236:239], v[48:51], v[96:99]
    ds_read_b64_tr_b16 v[228:229], v8 offset:544
    v_mfma_f32_16x16x32_bf16 v[100:103], v[236:239], v[52:55], v[100:103]
    ds_read_b64_tr_b16 v[230:231], v8 offset:1568
    s_waitcnt lgkmcnt(6)
    v_mfma_f32_16x16x32_bf16 v[104:107], v[240:243], v[48:51], v[104:107]
    ds_read_b64_tr_b16 v[232:233], v7 offset:768
    v_mfma_f32_16x16x32_bf16 v[108:111], v[240:243], v[52:55], v[108:111]
    ds_read_b64_tr_b16 v[234:235], v7 offset:1792
    s_waitcnt lgkmcnt(6)
    v_mfma_f32_16x16x32_bf16 v[112:115], v[244:247], v[48:51], v[112:115]
    ds_read_b64_tr_b16 v[236:237], v8 offset:800
    v_mfma_f32_16x16x32_bf16 v[116:119], v[244:247], v[52:55], v[116:119]
    ds_read_b64_tr_b16 v[238:239], v8 offset:1824
    s_waitcnt lgkmcnt(6)
    v_mfma_f32_16x16x32_bf16 v[120:123], v[224:227], v[48:51], v[120:123]
    v_mfma_f32_16x16x32_bf16 v[124:127], v[224:227], v[52:55], v[124:127]
    s_waitcnt vmcnt(14)
    s_barrier
    ds_read_b64_tr_b16 v[240:241], v7 offset:16384
    ds_read_b64_tr_b16 v[242:243], v7 offset:17408
    s_waitcnt lgkmcnt(6)
    v_mfma_f32_16x16x32_bf16 v[128:131], v[228:231], v[48:51], v[128:131]
    ds_read_b64_tr_b16 v[244:245], v8 offset:16416
    v_mfma_f32_16x16x32_bf16 v[132:135], v[228:231], v[52:55], v[132:135]
    ds_read_b64_tr_b16 v[246:247], v8 offset:17440
    s_waitcnt lgkmcnt(6)
    v_mfma_f32_16x16x32_bf16 v[136:139], v[232:235], v[48:51], v[136:139]
    ds_read_b64_tr_b16 v[224:225], v7 offset:16640
    v_mfma_f32_16x16x32_bf16 v[140:143], v[232:235], v[52:55], v[140:143]
    ds_read_b64_tr_b16 v[226:227], v7 offset:17664
    s_waitcnt lgkmcnt(6)
    v_mfma_f32_16x16x32_bf16 v[144:147], v[236:239], v[48:51], v[144:147]
    ds_read_b64_tr_b16 v[228:229], v8 offset:16672
    v_mfma_f32_16x16x32_bf16 v[148:151], v[236:239], v[52:55], v[148:151]
    ds_read_b64_tr_b16 v[230:231], v8 offset:17696
    s_waitcnt vmcnt(13) lgkmcnt(6)
    v_mfma_f32_16x16x32_bf16 v[88:91], v[240:243], v[56:59], v[88:91]
    ds_read_b64_tr_b16 v[232:233], v7 offset:16896
    s_waitcnt vmcnt(12)
    v_mfma_f32_16x16x32_bf16 v[92:95], v[240:243], v[60:63], v[92:95]
    ds_read_b64_tr_b16 v[234:235], v7 offset:17920
    s_waitcnt lgkmcnt(6)
    v_mfma_f32_16x16x32_bf16 v[96:99], v[244:247], v[56:59], v[96:99]
    ds_read_b64_tr_b16 v[236:237], v8 offset:16928
    v_mfma_f32_16x16x32_bf16 v[100:103], v[244:247], v[60:63], v[100:103]
    ds_read_b64_tr_b16 v[238:239], v8 offset:17952
    s_waitcnt lgkmcnt(6)
    v_mfma_f32_16x16x32_bf16 v[104:107], v[224:227], v[56:59], v[104:107]
    ds_read_b64_tr_b16 v[240:241], v7 offset:17152
    v_mfma_f32_16x16x32_bf16 v[108:111], v[224:227], v[60:63], v[108:111]
    ds_read_b64_tr_b16 v[242:243], v7 offset:18176
    s_waitcnt lgkmcnt(6)
    v_mfma_f32_16x16x32_bf16 v[112:115], v[228:231], v[56:59], v[112:115]
    ds_read_b64_tr_b16 v[244:245], v8 offset:17184
    v_mfma_f32_16x16x32_bf16 v[116:119], v[228:231], v[60:63], v[116:119]
    ds_read_b64_tr_b16 v[246:247], v8 offset:18208
    s_waitcnt lgkmcnt(6)
    v_mfma_f32_16x16x32_bf16 v[120:123], v[232:235], v[56:59], v[120:123]
    v_mfma_f32_16x16x32_bf16 v[124:127], v[232:235], v[60:63], v[124:127]
    s_waitcnt vmcnt(10)
    s_barrier
    ds_read_b64_tr_b16 v[224:225], v4 offset:0
    ds_read_b64_tr_b16 v[226:227], v4 offset:1024
    s_waitcnt lgkmcnt(6)
    v_mfma_f32_16x16x32_bf16 v[128:131], v[236:239], v[56:59], v[128:131]
    ds_read_b64_tr_b16 v[228:229], v5 offset:32
    v_mfma_f32_16x16x32_bf16 v[132:135], v[236:239], v[60:63], v[132:135]
    ds_read_b64_tr_b16 v[230:231], v5 offset:1056
    s_waitcnt lgkmcnt(6)
    v_mfma_f32_16x16x32_bf16 v[136:139], v[240:243], v[56:59], v[136:139]
    ds_read_b64_tr_b16 v[232:233], v4 offset:256
    v_mfma_f32_16x16x32_bf16 v[140:143], v[240:243], v[60:63], v[140:143]
    ds_read_b64_tr_b16 v[234:235], v4 offset:1280
    s_waitcnt lgkmcnt(6)
    v_mfma_f32_16x16x32_bf16 v[144:147], v[244:247], v[56:59], v[144:147]
    ds_read_b64_tr_b16 v[236:237], v5 offset:288
    v_mfma_f32_16x16x32_bf16 v[148:151], v[244:247], v[60:63], v[148:151]
    ds_read_b64_tr_b16 v[238:239], v5 offset:1312
    s_waitcnt vmcnt(9) lgkmcnt(6)
    v_mfma_f32_16x16x32_bf16 v[88:91], v[224:227], v[24:27], v[88:91]
    ds_read_b64_tr_b16 v[240:241], v4 offset:512
    s_waitcnt vmcnt(8)
    v_mfma_f32_16x16x32_bf16 v[92:95], v[224:227], v[28:31], v[92:95]
    ds_read_b64_tr_b16 v[242:243], v4 offset:1536
    s_waitcnt lgkmcnt(6)
    v_mfma_f32_16x16x32_bf16 v[96:99], v[228:231], v[24:27], v[96:99]
    ds_read_b64_tr_b16 v[244:245], v5 offset:544
    v_mfma_f32_16x16x32_bf16 v[100:103], v[228:231], v[28:31], v[100:103]
    ds_read_b64_tr_b16 v[246:247], v5 offset:1568
    s_waitcnt lgkmcnt(6)
    v_mfma_f32_16x16x32_bf16 v[104:107], v[232:235], v[24:27], v[104:107]
    ds_read_b64_tr_b16 v[224:225], v4 offset:768
    v_mfma_f32_16x16x32_bf16 v[108:111], v[232:235], v[28:31], v[108:111]
    ds_read_b64_tr_b16 v[226:227], v4 offset:1792
    s_waitcnt lgkmcnt(6)
    v_mfma_f32_16x16x32_bf16 v[112:115], v[236:239], v[24:27], v[112:115]
    ds_read_b64_tr_b16 v[228:229], v5 offset:800
    v_mfma_f32_16x16x32_bf16 v[116:119], v[236:239], v[28:31], v[116:119]
    ds_read_b64_tr_b16 v[230:231], v5 offset:1824
    s_waitcnt lgkmcnt(6)
    v_mfma_f32_16x16x32_bf16 v[120:123], v[240:243], v[24:27], v[120:123]
    v_mfma_f32_16x16x32_bf16 v[124:127], v[240:243], v[28:31], v[124:127]
    s_waitcnt vmcnt(2)
    s_barrier
    ds_read_b64_tr_b16 v[232:233], v4 offset:16384
    ds_read_b64_tr_b16 v[234:235], v4 offset:17408
    s_waitcnt lgkmcnt(6)
    v_mfma_f32_16x16x32_bf16 v[128:131], v[244:247], v[24:27], v[128:131]
    ds_read_b64_tr_b16 v[236:237], v5 offset:16416
    v_mfma_f32_16x16x32_bf16 v[132:135], v[244:247], v[28:31], v[132:135]
    ds_read_b64_tr_b16 v[238:239], v5 offset:17440
    s_waitcnt lgkmcnt(6)
    v_mfma_f32_16x16x32_bf16 v[136:139], v[224:227], v[24:27], v[136:139]
    ds_read_b64_tr_b16 v[240:241], v4 offset:16640
    v_mfma_f32_16x16x32_bf16 v[140:143], v[224:227], v[28:31], v[140:143]
    ds_read_b64_tr_b16 v[242:243], v4 offset:17664
    s_waitcnt lgkmcnt(6)
    v_mfma_f32_16x16x32_bf16 v[144:147], v[228:231], v[24:27], v[144:147]
    ds_read_b64_tr_b16 v[244:245], v5 offset:16672
    v_mfma_f32_16x16x32_bf16 v[148:151], v[228:231], v[28:31], v[148:151]
    ds_read_b64_tr_b16 v[246:247], v5 offset:17696
    s_waitcnt vmcnt(1) lgkmcnt(6)
    v_mfma_f32_16x16x32_bf16 v[88:91], v[232:235], v[32:35], v[88:91]
    ds_read_b64_tr_b16 v[224:225], v4 offset:16896
    s_waitcnt vmcnt(0)
    v_mfma_f32_16x16x32_bf16 v[92:95], v[232:235], v[36:39], v[92:95]
    ds_read_b64_tr_b16 v[226:227], v4 offset:17920
    s_waitcnt lgkmcnt(6)
    v_mfma_f32_16x16x32_bf16 v[96:99], v[236:239], v[32:35], v[96:99]
    ds_read_b64_tr_b16 v[228:229], v5 offset:16928
    v_mfma_f32_16x16x32_bf16 v[100:103], v[236:239], v[36:39], v[100:103]
    ds_read_b64_tr_b16 v[230:231], v5 offset:17952
    s_waitcnt lgkmcnt(6)
    v_mfma_f32_16x16x32_bf16 v[104:107], v[240:243], v[32:35], v[104:107]
    ds_read_b64_tr_b16 v[232:233], v4 offset:17152
    v_mfma_f32_16x16x32_bf16 v[108:111], v[240:243], v[36:39], v[108:111]
    ds_read_b64_tr_b16 v[234:235], v4 offset:18176
    s_waitcnt lgkmcnt(6)
    v_mfma_f32_16x16x32_bf16 v[112:115], v[244:247], v[32:35], v[112:115]
    ds_read_b64_tr_b16 v[236:237], v5 offset:17184
    v_mfma_f32_16x16x32_bf16 v[116:119], v[244:247], v[36:39], v[116:119]
    ds_read_b64_tr_b16 v[238:239], v5 offset:18208
    s_waitcnt lgkmcnt(6)
    v_mfma_f32_16x16x32_bf16 v[120:123], v[224:227], v[32:35], v[120:123]
    v_mfma_f32_16x16x32_bf16 v[124:127], v[224:227], v[36:39], v[124:127]
    s_waitcnt lgkmcnt(4)
    v_mfma_f32_16x16x32_bf16 v[128:131], v[228:231], v[32:35], v[128:131]
    v_mfma_f32_16x16x32_bf16 v[132:135], v[228:231], v[36:39], v[132:135]
    s_waitcnt lgkmcnt(2)
    v_mfma_f32_16x16x32_bf16 v[136:139], v[232:235], v[32:35], v[136:139]
    v_mfma_f32_16x16x32_bf16 v[140:143], v[232:235], v[36:39], v[140:143]
    s_waitcnt lgkmcnt(0)
    v_mfma_f32_16x16x32_bf16 v[144:147], v[236:239], v[32:35], v[144:147]
    v_mfma_f32_16x16x32_bf16 v[148:151], v[236:239], v[36:39], v[148:151]
    s_lshl_b32 s16, s3, 13
    s_xor_b32 s17, s16, 0x8000
    s_add_u32 s16, s16, 0x18000
    s_add_u32 s17, s17, 0x18000
    v_add_u32 v16, s16, v2
    s_mov_b32 s16, s17
    v_add_u32 v17, s16, v2
    ds_write_b128 v16, v[120:123] offset:0
    ds_write_b128 v16, v[124:127] offset:1024
    ds_write_b128 v16, v[128:131] offset:2048
    ds_write_b128 v16, v[132:135] offset:3072
    ds_write_b128 v16, v[136:139] offset:4096
    ds_write_b128 v16, v[140:143] offset:5120
    ds_write_b128 v16, v[144:147] offset:6144
    ds_write_b128 v16, v[148:151] offset:7168
    v_lshlrev_b32 v24, 16, v248
    v_and_b32 v25, 0xffff0000, v248
    v_lshlrev_b32 v26, 16, v249
    v_and_b32 v27, 0xffff0000, v249
    v_lshlrev_b32 v28, 16, v250
    v_and_b32 v29, 0xffff0000, v250
    v_lshlrev_b32 v30, 16, v251
    v_and_b32 v31, 0xffff0000, v251
    v_lshlrev_b32 v32, 16, v252
    v_and_b32 v33, 0xffff0000, v252
    v_lshlrev_b32 v34, 16, v253
    v_and_b32 v35, 0xffff0000, v253
    v_lshlrev_b32 v36, 16, v254
    v_and_b32 v37, 0xffff0000, v254
    v_lshlrev_b32 v38, 16, v255
    v_and_b32 v39, 0xffff0000, v255
    v_and_b32 v18, 15, v1
    v_lshlrev_b32 v18, 6, v18
    v_lshrrev_b32 v19, 4, v1
    v_and_b32 v20, 1, v19
    v_lshl_add_u32 v18, v20, 5, v18
    v_lshrrev_b32 v19, 1, v19
    v_lshl_add_u32 v18, v19, 4, v18
    s_and_b32 s17, s3, 3
    s_lshl_b32 s18, s30, 2
    s_add_u32 s18, s18, s17
    s_lshl_b32 s18, s18, 16
    s_lshl_b32 s19, s15, 22
    s_add_u32 s18, s18, s19
    s_lshl_b32 s19, s31, 12
    s_add_u32 s18, s18, s19
    s_add_u32 s18, s18, 0x2c00000
    s_add_u32 s19, s18, 32768
    s_waitcnt lgkmcnt(0)
    s_barrier
    ds_read_b128 v[40:43], v17 offset:0
    ds_read_b128 v[44:47], v17 offset:1024
    ds_read_b128 v[48:51], v17 offset:2048
    ds_read_b128 v[52:55], v17 offset:3072
    ds_read_b128 v[56:59], v17 offset:4096
    ds_read_b128 v[60:63], v17 offset:5120
    ds_read_b128 v[64:67], v17 offset:6144
    ds_read_b128 v[68:71], v17 offset:7168
    s_waitcnt lgkmcnt(7)
    v_pk_add_f32 v[88:89], v[88:89], v[40:41]
    v_pk_add_f32 v[90:91], v[90:91], v[42:43]
    v_pk_mul_f32 v[88:89], v[88:89], v[24:25]
    v_pk_mul_f32 v[90:91], v[90:91], v[26:27]
    v_cvt_pk_bf16_f32 v224, v88, v89
    v_cvt_pk_bf16_f32 v225, v90, v91
    s_waitcnt lgkmcnt(5)
    v_pk_add_f32 v[96:97], v[96:97], v[48:49]
    v_pk_add_f32 v[98:99], v[98:99], v[50:51]
    v_pk_mul_f32 v[96:97], v[96:97], v[28:29]
    v_pk_mul_f32 v[98:99], v[98:99], v[30:31]
    v_cvt_pk_bf16_f32 v226, v96, v97
    v_cvt_pk_bf16_f32 v227, v98, v99
    s_nop 0
    v_permlane16_swap_b32 v224, v226
    v_permlane16_swap_b32 v225, v227
    buffer_store_dwordx4 v[224:227], v18, s[8:11], s18 offen offset:0 sc1
    v_pk_add_f32 v[92:93], v[92:93], v[44:45]
    v_pk_add_f32 v[94:95], v[94:95], v[46:47]
    v_pk_mul_f32 v[92:93], v[92:93], v[24:25]
    v_pk_mul_f32 v[94:95], v[94:95], v[26:27]
    v_cvt_pk_bf16_f32 v228, v92, v93
    v_cvt_pk_bf16_f32 v229, v94, v95
    s_waitcnt lgkmcnt(4)
    v_pk_add_f32 v[100:101], v[100:101], v[52:53]
    v_pk_add_f32 v[102:103], v[102:103], v[54:55]
    v_pk_mul_f32 v[100:101], v[100:101], v[28:29]
    v_pk_mul_f32 v[102:103], v[102:103], v[30:31]
    v_cvt_pk_bf16_f32 v230, v100, v101
    v_cvt_pk_bf16_f32 v231, v102, v103
    s_nop 0
    v_permlane16_swap_b32 v228, v230
    v_permlane16_swap_b32 v229, v231
    buffer_store_dwordx4 v[228:231], v18, s[8:11], s19 offen offset:0 sc1
    s_waitcnt lgkmcnt(3)
    v_pk_add_f32 v[104:105], v[104:105], v[56:57]
    v_pk_add_f32 v[106:107], v[106:107], v[58:59]
    v_pk_mul_f32 v[104:105], v[104:105], v[32:33]
    v_pk_mul_f32 v[106:107], v[106:107], v[34:35]
    v_cvt_pk_bf16_f32 v232, v104, v105
    v_cvt_pk_bf16_f32 v233, v106, v107
    s_waitcnt lgkmcnt(1)
    v_pk_add_f32 v[112:113], v[112:113], v[64:65]
    v_pk_add_f32 v[114:115], v[114:115], v[66:67]
    v_pk_mul_f32 v[112:113], v[112:113], v[36:37]
    v_pk_mul_f32 v[114:115], v[114:115], v[38:39]
    v_cvt_pk_bf16_f32 v234, v112, v113
    v_cvt_pk_bf16_f32 v235, v114, v115
    s_nop 0
    v_permlane16_swap_b32 v232, v234
    v_permlane16_swap_b32 v233, v235
    buffer_store_dwordx4 v[232:235], v18, s[8:11], s18 offen offset:1024 sc1
    v_pk_add_f32 v[108:109], v[108:109], v[60:61]
    v_pk_add_f32 v[110:111], v[110:111], v[62:63]
    v_pk_mul_f32 v[108:109], v[108:109], v[32:33]
    v_pk_mul_f32 v[110:111], v[110:111], v[34:35]
    v_cvt_pk_bf16_f32 v236, v108, v109
    v_cvt_pk_bf16_f32 v237, v110, v111
    s_waitcnt lgkmcnt(0)
    v_pk_add_f32 v[116:117], v[116:117], v[68:69]
    v_pk_add_f32 v[118:119], v[118:119], v[70:71]
    v_pk_mul_f32 v[116:117], v[116:117], v[36:37]
    v_pk_mul_f32 v[118:119], v[118:119], v[38:39]
    v_cvt_pk_bf16_f32 v238, v116, v117
    v_cvt_pk_bf16_f32 v239, v118, v119
    s_nop 0
    v_permlane16_swap_b32 v236, v238
    v_permlane16_swap_b32 v237, v239
    buffer_store_dwordx4 v[236:239], v18, s[8:11], s19 offen offset:1024 sc1
    s_mov_b64 s[64:65], s[44:45]
    s_mov_b32 s66, 0x800
    s_mov_b32 s67, 0x20000
    s_mov_b64 s[76:77], s[32:33]
    s_mov_b32 s78, 0x400000
    s_mov_b32 s79, 0x20000
    s_mov_b64 s[68:69], s[56:57]
    s_mov_b32 s70, 0x400000
    s_mov_b32 s71, 0x20000
    s_lshl_b32 s14, s31, 1
    s_add_u32 s14, s14, s15
    s_lshl_b32 s14, s14, 3
    s_add_u32 s14, s14, s3
    s_lshl_b32 s16, s30, 7
    s_add_u32 s14, s14, s16
    s_lshl_b32 s16, s14, 11
    buffer_load_dwordx4 v[216:219], v2, s[76:79], s16 offen offset:0
    buffer_load_dwordx4 v[220:223], v2, s[76:79], s16 offen offset:1024
    s_lshl_b32 s16, s3, 10
    s_add_u32 m0, s16, 81920
    s_add_u32 s16, s16, 0x540800
    buffer_load_dwordx4 v2, s[8:11], s16 offen sc1 lds
    s_lshl_b32 s16, s30, 5
    s_lshl_b32 s17, s31, 1
    s_add_u32 s16, s16, s17
    s_add_u32 s16, s16, s15
    s_lshl_b32 s16, s16, 2
    s_add_u32 s16, s16, 0x530000
    s_cmp_eq_u32 s3, 0
    s_cselect_b32 s16, s16, 0x7ffffff0
    v_mov_b32 v16, s28
    v_mov_b32 v17, 0
    s_lshr_b32 s18, s14, 4
    s_lshl_b32 s18, s18, 15
    s_and_b32 s19, s14, 15
    s_lshl_b32 s19, s19, 6
    s_add_u32 s18, s18, s19
    s_add_u32 s18, s18, 0x2c00000
    s_add_u32 s19, s18, 16384
    v_lshrrev_b32 v18, 2, v1
    v_lshlrev_b32 v18, 10, v18
    v_and_b32 v19, 3, v1
    v_lshl_add_u32 v18, v19, 4, v18
    v_add_u32 v19, 0x400000, v18
    s_lshl_b32 s25, s30, 7
    s_add_u32 s25, s25, 0x530000
    v_and_b32 v20, 15, v1
    v_lshlrev_b32 v20, 2, v20
    s_waitcnt vmcnt(3)
    s_waitcnt vmcnt(0)
    s_barrier
    s_mov_b64 exec, 1
    buffer_store_dword v16, v17, s[8:11], s16 offen sc1
    s_mov_b64 exec, -1
    v_add_u32 v16, 81920, v2
    ds_read_b128 v[184:187], v16 offset:0
    ds_read_b128 v[188:191], v16 offset:1024
    ds_read_b128 v[192:195], v16 offset:2048
    ds_read_b128 v[196:199], v16 offset:3072
    ds_read_b128 v[200:203], v16 offset:4096
    ds_read_b128 v[204:207], v16 offset:5120
    ds_read_b128 v[208:211], v16 offset:6144
    ds_read_b128 v[212:215], v16 offset:7168
    v_mov_b32 v94, 0
    v_mov_b32 v95, 0
    s_waitcnt lgkmcnt(5)
    v_lshlrev_b32 v76, 16, v192
    v_and_b32 v77, 0xffff0000, v192
    s_waitcnt lgkmcnt(1)
    v_lshlrev_b32 v78, 16, v208
    v_and_b32 v79, 0xffff0000, v208
    v_pk_mul_f32 v[60:61], v[76:77], v[78:79]
    v_lshlrev_b32 v76, 16, v184
    v_and_b32 v77, 0xffff0000, v184
    v_fmac_f32 v94, v76, v78
    v_fmac_f32 v94, v77, v79
    v_add_f32 v95, v95, v60
    v_add_f32 v95, v95, v61
    v_lshlrev_b32 v76, 16, v193
    v_and_b32 v77, 0xffff0000, v193
    v_lshlrev_b32 v78, 16, v209
    v_and_b32 v79, 0xffff0000, v209
    v_pk_mul_f32 v[62:63], v[76:77], v[78:79]
    v_lshlrev_b32 v76, 16, v185
    v_and_b32 v77, 0xffff0000, v185
    v_fmac_f32 v94, v76, v78
    v_fmac_f32 v94, v77, v79
    v_add_f32 v95, v95, v62
    v_add_f32 v95, v95, v63
    v_lshlrev_b32 v76, 16, v194
    v_and_b32 v77, 0xffff0000, v194
    v_lshlrev_b32 v78, 16, v210
    v_and_b32 v79, 0xffff0000, v210
    v_pk_mul_f32 v[64:65], v[76:77], v[78:79]
    v_lshlrev_b32 v76, 16, v186
    v_and_b32 v77, 0xffff0000, v186
    v_fmac_f32 v94, v76, v78
    v_fmac_f32 v94, v77, v79
    v_add_f32 v95, v95, v64
    v_add_f32 v95, v95, v65
    v_lshlrev_b32 v76, 16, v195
    v_and_b32 v77, 0xffff0000, v195
    v_lshlrev_b32 v78, 16, v211
    v_and_b32 v79, 0xffff0000, v211
    v_pk_mul_f32 v[66:67], v[76:77], v[78:79]
    v_lshlrev_b32 v76, 16, v187
    v_and_b32 v77, 0xffff0000, v187
    v_fmac_f32 v94, v76, v78
    v_fmac_f32 v94, v77, v79
    v_add_f32 v95, v95, v66
    v_add_f32 v95, v95, v67
    v_lshlrev_b32 v76, 16, v196
    v_and_b32 v77, 0xffff0000, v196
    s_waitcnt lgkmcnt(0)
    v_lshlrev_b32 v78, 16, v212
    v_and_b32 v79, 0xffff0000, v212
    v_pk_mul_f32 v[68:69], v[76:77], v[78:79]
    v_lshlrev_b32 v76, 16, v188
    v_and_b32 v77, 0xffff0000, v188
    v_fmac_f32 v94, v76, v78
    v_fmac_f32 v94, v77, v79
    v_add_f32 v95, v95, v68
    v_add_f32 v95, v95, v69
    v_lshlrev_b32 v76, 16, v197
    v_and_b32 v77, 0xffff0000, v197
    v_lshlrev_b32 v78, 16, v213
    v_and_b32 v79, 0xffff0000, v213
    v_pk_mul_f32 v[70:71], v[76:77], v[78:79]
    v_lshlrev_b32 v76, 16, v189
    v_and_b32 v77, 0xffff0000, v189
    v_fmac_f32 v94, v76, v78
    v_fmac_f32 v94, v77, v79
    v_add_f32 v95, v95, v70
    v_add_f32 v95, v95, v71
    v_lshlrev_b32 v76, 16, v198
    v_and_b32 v77, 0xffff0000, v198
    v_lshlrev_b32 v78, 16, v214
    v_and_b32 v79, 0xffff0000, v214
    v_pk_mul_f32 v[72:73], v[76:77], v[78:79]
    v_lshlrev_b32 v76, 16, v190
    v_and_b32 v77, 0xffff0000, v190
    v_fmac_f32 v94, v76, v78
    v_fmac_f32 v94, v77, v79
    v_add_f32 v95, v95, v72
    v_add_f32 v95, v95, v73
    v_lshlrev_b32 v76, 16, v199
    v_and_b32 v77, 0xffff0000, v199
    v_lshlrev_b32 v78, 16, v215
    v_and_b32 v79, 0xffff0000, v215
    v_pk_mul_f32 v[74:75], v[76:77], v[78:79]
    v_lshlrev_b32 v76, 16, v191
    v_and_b32 v77, 0xffff0000, v191
    v_fmac_f32 v94, v76, v78
    v_fmac_f32 v94, v77, v79
    v_add_f32 v95, v95, v74
    v_add_f32 v95, v95, v75
    v_add_f32_dpp v94, v94, v94 row_ror:1 row_mask:0xf bank_mask:0xf
    s_nop 0
    v_add_f32_dpp v95, v95, v95 row_ror:1 row_mask:0xf bank_mask:0xf
    v_add_f32_dpp v94, v94, v94 row_ror:2 row_mask:0xf bank_mask:0xf
    s_nop 0
    v_add_f32_dpp v95, v95, v95 row_ror:2 row_mask:0xf bank_mask:0xf
    v_add_f32_dpp v94, v94, v94 row_ror:4 row_mask:0xf bank_mask:0xf
    s_nop 0
    v_add_f32_dpp v95, v95, v95 row_ror:4 row_mask:0xf bank_mask:0xf
    v_add_f32_dpp v94, v94, v94 row_ror:8 row_mask:0xf bank_mask:0xf
    s_nop 0
    v_add_f32_dpp v95, v95, v95 row_ror:8 row_mask:0xf bank_mask:0xf
    v_mov_b32 v76, v94
    s_nop 1
    v_permlane16_swap_b32 v94, v76
    v_add_f32 v94, v94, v76
    v_mov_b32 v77, v95
    s_nop 1
    v_permlane16_swap_b32 v95, v77
    v_add_f32 v95, v95, v77
    v_mov_b32 v76, v94
    s_nop 1
    v_permlane32_swap_b32 v94, v76
    v_add_f32 v94, v94, v76
    v_mov_b32 v77, v95
    s_nop 1
    v_permlane32_swap_b32 v95, v77
    v_add_f32 v95, v95, v77
    v_lshlrev_b32 v28, 16, v216
    v_and_b32 v29, 0xffff0000, v216
    v_lshlrev_b32 v30, 16, v217
    v_and_b32 v31, 0xffff0000, v217
    v_lshlrev_b32 v32, 16, v218
    v_and_b32 v33, 0xffff0000, v218
    v_lshlrev_b32 v34, 16, v219
    v_and_b32 v35, 0xffff0000, v219
    v_lshlrev_b32 v36, 16, v220
    v_and_b32 v37, 0xffff0000, v220
    v_lshlrev_b32 v38, 16, v221
    v_and_b32 v39, 0xffff0000, v221
    v_lshlrev_b32 v40, 16, v222
    v_and_b32 v41, 0xffff0000, v222
    v_lshlrev_b32 v42, 16, v223
    v_and_b32 v43, 0xffff0000, v223
    s_sleep 16
    s_mov_b32 s27, 0
adaLN_cond__sliding_block_cached__moe_arch_mod__prompt_kernel_a11p:
    buffer_load_dword v76, v20, s[8:11], s25 offen sc1
    s_waitcnt vmcnt(0)
    v_cmp_ne_u32 vcc, s28, v76
    s_add_u32 s27, s27, 1
    s_cmp_ge_u32 s27, 65536
    s_cbranch_scc1 adaLN_cond__sliding_block_cached__moe_arch_mod__prompt_kernel_a11g
    s_cbranch_vccnz adaLN_cond__sliding_block_cached__moe_arch_mod__prompt_kernel_a11p
adaLN_cond__sliding_block_cached__moe_arch_mod__prompt_kernel_a11g:
    buffer_load_dwordx4 v[44:47], v18, s[8:11], s18 offen sc1
    buffer_load_dwordx4 v[52:55], v19, s[8:11], s18 offen sc1
    buffer_load_dwordx4 v[48:51], v18, s[8:11], s19 offen sc1
    buffer_load_dwordx4 v[56:59], v19, s[8:11], s19 offen sc1
    v_lshlrev_b32 v21, 2, v0
    s_mov_b32 s16, 0x540800
    buffer_load_dword v106, v21, s[8:11], s16 offen sc1
    buffer_load_dword v104, v21, s[8:11], s16 offen offset:2048 sc1
    s_waitcnt vmcnt(5)
    v_lshlrev_b32 v76, 16, v44
    v_and_b32 v77, 0xffff0000, v44
    s_waitcnt vmcnt(4)
    v_lshlrev_b32 v78, 16, v52
    v_and_b32 v79, 0xffff0000, v52
    v_pk_add_f32 v[76:77], v[76:77], v[78:79]
    v_pk_add_f32 v[28:29], v[28:29], v[76:77]
    v_cvt_pk_bf16_f32 v16, v28, v29
    v_lshlrev_b32 v28, 16, v16
    v_and_b32 v29, 0xffff0000, v16
    v_lshlrev_b32 v80, 16, v45
    v_and_b32 v81, 0xffff0000, v45
    v_lshlrev_b32 v82, 16, v53
    v_and_b32 v83, 0xffff0000, v53
    v_pk_add_f32 v[80:81], v[80:81], v[82:83]
    v_pk_add_f32 v[30:31], v[30:31], v[80:81]
    v_cvt_pk_bf16_f32 v17, v30, v31
    v_lshlrev_b32 v30, 16, v17
    v_and_b32 v31, 0xffff0000, v17
    v_lshlrev_b32 v76, 16, v46
    v_and_b32 v77, 0xffff0000, v46
    v_lshlrev_b32 v78, 16, v54
    v_and_b32 v79, 0xffff0000, v54
    v_pk_add_f32 v[76:77], v[76:77], v[78:79]
    v_pk_add_f32 v[32:33], v[32:33], v[76:77]
    v_cvt_pk_bf16_f32 v16, v32, v33
    v_lshlrev_b32 v32, 16, v16
    v_and_b32 v33, 0xffff0000, v16
    v_lshlrev_b32 v80, 16, v47
    v_and_b32 v81, 0xffff0000, v47
    v_lshlrev_b32 v82, 16, v55
    v_and_b32 v83, 0xffff0000, v55
    v_pk_add_f32 v[80:81], v[80:81], v[82:83]
    v_pk_add_f32 v[34:35], v[34:35], v[80:81]
    v_cvt_pk_bf16_f32 v17, v34, v35
    v_lshlrev_b32 v34, 16, v17
    v_and_b32 v35, 0xffff0000, v17
    s_waitcnt vmcnt(3)
    v_lshlrev_b32 v76, 16, v48
    v_and_b32 v77, 0xffff0000, v48
    s_waitcnt vmcnt(2)
    v_lshlrev_b32 v78, 16, v56
    v_and_b32 v79, 0xffff0000, v56
    v_pk_add_f32 v[76:77], v[76:77], v[78:79]
    v_pk_add_f32 v[36:37], v[36:37], v[76:77]
    v_cvt_pk_bf16_f32 v16, v36, v37
    v_lshlrev_b32 v36, 16, v16
    v_and_b32 v37, 0xffff0000, v16
    v_lshlrev_b32 v80, 16, v49
    v_and_b32 v81, 0xffff0000, v49
    v_lshlrev_b32 v82, 16, v57
    v_and_b32 v83, 0xffff0000, v57
    v_pk_add_f32 v[80:81], v[80:81], v[82:83]
    v_pk_add_f32 v[38:39], v[38:39], v[80:81]
    v_cvt_pk_bf16_f32 v17, v38, v39
    v_lshlrev_b32 v38, 16, v17
    v_and_b32 v39, 0xffff0000, v17
    v_lshlrev_b32 v76, 16, v50
    v_and_b32 v77, 0xffff0000, v50
    v_lshlrev_b32 v78, 16, v58
    v_and_b32 v79, 0xffff0000, v58
    v_pk_add_f32 v[76:77], v[76:77], v[78:79]
    v_pk_add_f32 v[40:41], v[40:41], v[76:77]
    v_cvt_pk_bf16_f32 v16, v40, v41
    v_lshlrev_b32 v40, 16, v16
    v_and_b32 v41, 0xffff0000, v16
    v_lshlrev_b32 v80, 16, v51
    v_and_b32 v81, 0xffff0000, v51
    v_lshlrev_b32 v82, 16, v59
    v_and_b32 v83, 0xffff0000, v59
    v_pk_add_f32 v[80:81], v[80:81], v[82:83]
    v_pk_add_f32 v[42:43], v[42:43], v[80:81]
    v_cvt_pk_bf16_f32 v17, v42, v43
    v_lshlrev_b32 v42, 16, v17
    v_and_b32 v43, 0xffff0000, v17
    v_pk_add_f32 v[76:77], v[28:29], v[30:31]
    v_pk_mul_f32 v[78:79], v[28:29], v[28:29]
    v_pk_mul_f32 v[80:81], v[28:29], v[60:61]
    v_pk_fma_f32 v[78:79], v[30:31], v[30:31], v[78:79]
    v_pk_fma_f32 v[80:81], v[30:31], v[62:63], v[80:81]
    v_pk_add_f32 v[76:77], v[76:77], v[32:33]
    v_pk_fma_f32 v[78:79], v[32:33], v[32:33], v[78:79]
    v_pk_fma_f32 v[80:81], v[32:33], v[64:65], v[80:81]
    v_pk_add_f32 v[76:77], v[76:77], v[34:35]
    v_pk_fma_f32 v[78:79], v[34:35], v[34:35], v[78:79]
    v_pk_fma_f32 v[80:81], v[34:35], v[66:67], v[80:81]
    v_pk_add_f32 v[76:77], v[76:77], v[36:37]
    v_pk_fma_f32 v[78:79], v[36:37], v[36:37], v[78:79]
    v_pk_fma_f32 v[80:81], v[36:37], v[68:69], v[80:81]
    v_pk_add_f32 v[76:77], v[76:77], v[38:39]
    v_pk_fma_f32 v[78:79], v[38:39], v[38:39], v[78:79]
    v_pk_fma_f32 v[80:81], v[38:39], v[70:71], v[80:81]
    v_pk_add_f32 v[76:77], v[76:77], v[40:41]
    v_pk_fma_f32 v[78:79], v[40:41], v[40:41], v[78:79]
    v_pk_fma_f32 v[80:81], v[40:41], v[72:73], v[80:81]
    v_pk_add_f32 v[76:77], v[76:77], v[42:43]
    v_pk_fma_f32 v[78:79], v[42:43], v[42:43], v[78:79]
    v_pk_fma_f32 v[80:81], v[42:43], v[74:75], v[80:81]
    v_add_f32 v96, v76, v77
    v_add_f32 v97, v78, v79
    v_add_f32 v98, v80, v81
    v_add_f32_dpp v96, v96, v96 row_ror:1 row_mask:0xf bank_mask:0xf
    v_add_f32_dpp v97, v97, v97 row_ror:1 row_mask:0xf bank_mask:0xf
    v_add_f32_dpp v98, v98, v98 row_ror:1 row_mask:0xf bank_mask:0xf
    v_add_f32_dpp v96, v96, v96 row_ror:2 row_mask:0xf bank_mask:0xf
    v_add_f32_dpp v97, v97, v97 row_ror:2 row_mask:0xf bank_mask:0xf
    v_add_f32_dpp v98, v98, v98 row_ror:2 row_mask:0xf bank_mask:0xf
    v_add_f32_dpp v96, v96, v96 row_ror:4 row_mask:0xf bank_mask:0xf
    v_add_f32_dpp v97, v97, v97 row_ror:4 row_mask:0xf bank_mask:0xf
    v_add_f32_dpp v98, v98, v98 row_ror:4 row_mask:0xf bank_mask:0xf
    v_add_f32_dpp v96, v96, v96 row_ror:8 row_mask:0xf bank_mask:0xf
    v_add_f32_dpp v97, v97, v97 row_ror:8 row_mask:0xf bank_mask:0xf
    v_add_f32_dpp v98, v98, v98 row_ror:8 row_mask:0xf bank_mask:0xf
    v_mov_b32 v76, v96
    s_nop 1
    v_permlane16_swap_b32 v96, v76
    v_add_f32 v96, v96, v76
    v_mov_b32 v77, v97
    s_nop 1
    v_permlane16_swap_b32 v97, v77
    v_add_f32 v97, v97, v77
    v_mov_b32 v78, v98
    s_nop 1
    v_permlane16_swap_b32 v98, v78
    v_add_f32 v98, v98, v78
    v_mov_b32 v76, v96
    s_nop 1
    v_permlane32_swap_b32 v96, v76
    v_add_f32 v96, v96, v76
    v_mov_b32 v77, v97
    s_nop 1
    v_permlane32_swap_b32 v97, v77
    v_add_f32 v97, v97, v77
    v_mov_b32 v78, v98
    s_nop 1
    v_permlane32_swap_b32 v98, v78
    v_add_f32 v98, v98, v78
    v_mul_f32 v96, 0x3a800000, v96
    v_mul_f32 v97, 0x3a800000, v97
    v_fma_f32 v97, -v96, v96, v97
    v_max_f32 v97, 0, v97
    v_fma_f32 v98, -v96, v95, v98
    v_add_f32 v76, 0x3727c5ac, v97
    v_rsq_f32 v76, v76
    s_nop 0
    v_fma_f32 v27, v98, v76, v94
    v_cvt_pk_bf16_f32 v96, v96, v96
    v_lshlrev_b32 v96, 16, v96
    v_cvt_pk_bf16_f32 v97, v97, v97
    v_lshlrev_b32 v97, 16, v97
    v_add_f32 v97, 0x3727c5ac, v97
    v_cvt_pk_bf16_f32 v97, v97, v97
    v_lshlrev_b32 v97, 16, v97
    v_sqrt_f32 v98, v97
    s_nop 0
    v_cvt_pk_bf16_f32 v98, v98, v98
    v_lshlrev_b32 v98, 16, v98
    v_rcp_f32 v99, v98
    v_mov_b32 v25, v96
    v_mov_b32 v26, v98
    v_ashrrev_i32 v16, 31, v27
    v_or_b32 v16, 0x80000000, v16
    v_xor_b32 v24, v27, v16
    v_and_b32 v24, 0xfffff800, v24
    v_max_u32 v24, 0x800, v24
    s_sub_u32 s16, 2047, s14
    v_or_b32 v24, s16, v24
    s_lshl_b32 s16, s3, 4
    s_add_u32 s16, s16, 65536
    v_mov_b32 v16, s16
    ds_write_b128 v16, v[24:27]
    s_waitcnt lgkmcnt(0)
    s_barrier
    v_and_b32 v16, 7, v1
    v_lshlrev_b32 v16, 4, v16
    v_add_u32 v16, 65536, v16
    ds_read_b32 v76, v16
    s_waitcnt lgkmcnt(0)
    v_mov_b32 v77, v76
    s_nop 1
    v_max_u32_dpp v77, v77, v77 row_ror:1 row_mask:0xf bank_mask:0xf
    s_nop 1
    v_max_u32_dpp v77, v77, v77 row_ror:2 row_mask:0xf bank_mask:0xf
    s_nop 1
    v_max_u32_dpp v77, v77, v77 row_ror:4 row_mask:0xf bank_mask:0xf
    v_cmp_eq_u32 vcc, v76, v77
    s_ff1_i32_b64 s16, vcc
    s_lshl_b32 s16, s16, 4
    s_add_u32 s16, s16, 65536
    v_mov_b32 v16, s16
    ds_read_b128 v[24:27], v16
    s_lshl_b32 s16, s2, 4
    s_add_u32 s16, s16, 0x6e0000
    s_cmp_eq_u32 s3, 0
    s_cselect_b32 s16, s16, 0x7ffffff0
    v_mov_b32 v17, 0
    s_mov_b64 exec, 1
    s_waitcnt lgkmcnt(0)
    buffer_store_dwordx4 v[24:27], v17, s[8:11], s16 offen sc1
    s_mov_b64 exec, -1
    v_sub_f32 v44, v28, v96
    v_sub_f32 v45, v29, v96
    v_sub_f32 v46, v30, v96
    v_sub_f32 v47, v31, v96
    v_sub_f32 v48, v32, v96
    v_sub_f32 v49, v33, v96
    v_sub_f32 v50, v34, v96
    v_sub_f32 v51, v35, v96
    v_cvt_pk_bf16_f32 v16, v44, v45
    v_lshlrev_b32 v44, 16, v16
    v_and_b32 v45, 0xffff0000, v16
    v_cvt_pk_bf16_f32 v16, v46, v47
    v_lshlrev_b32 v46, 16, v16
    v_and_b32 v47, 0xffff0000, v16
    v_cvt_pk_bf16_f32 v16, v48, v49
    v_lshlrev_b32 v48, 16, v16
    v_and_b32 v49, 0xffff0000, v16
    v_cvt_pk_bf16_f32 v16, v50, v51
    v_lshlrev_b32 v50, 16, v16
    v_and_b32 v51, 0xffff0000, v16
    v_mul_f32 v52, v44, v99
    v_mul_f32 v53, v45, v99
    v_mul_f32 v54, v46, v99
    v_mul_f32 v55, v47, v99
    v_mul_f32 v56, v48, v99
    v_mul_f32 v57, v49, v99
    v_mul_f32 v58, v50, v99
    v_mul_f32 v59, v51, v99
    v_fma_f32 v44, -v52, v98, v44
    v_fma_f32 v45, -v53, v98, v45
    v_fma_f32 v46, -v54, v98, v46
    v_fma_f32 v47, -v55, v98, v47
    v_fma_f32 v48, -v56, v98, v48
    v_fma_f32 v49, -v57, v98, v49
    v_fma_f32 v50, -v58, v98, v50
    v_fma_f32 v51, -v59, v98, v51
    v_fma_f32 v44, v44, v99, v52
    v_fma_f32 v45, v45, v99, v53
    v_fma_f32 v46, v46, v99, v54
    v_fma_f32 v47, v47, v99, v55
    v_fma_f32 v48, v48, v99, v56
    v_fma_f32 v49, v49, v99, v57
    v_fma_f32 v50, v50, v99, v58
    v_fma_f32 v51, v51, v99, v59
    v_cvt_pk_bf16_f32 v16, v44, v45
    v_lshlrev_b32 v44, 16, v16
    v_and_b32 v45, 0xffff0000, v16
    v_cvt_pk_bf16_f32 v16, v46, v47
    v_lshlrev_b32 v46, 16, v16
    v_and_b32 v47, 0xffff0000, v16
    v_cvt_pk_bf16_f32 v16, v48, v49
    v_lshlrev_b32 v48, 16, v16
    v_and_b32 v49, 0xffff0000, v16
    v_cvt_pk_bf16_f32 v16, v50, v51
    v_lshlrev_b32 v50, 16, v16
    v_and_b32 v51, 0xffff0000, v16
    v_lshlrev_b32 v52, 16, v192
    v_and_b32 v53, 0xffff0000, v192
    v_lshlrev_b32 v54, 16, v193
    v_and_b32 v55, 0xffff0000, v193
    v_lshlrev_b32 v56, 16, v194
    v_and_b32 v57, 0xffff0000, v194
    v_lshlrev_b32 v58, 16, v195
    v_and_b32 v59, 0xffff0000, v195
    v_pk_mul_f32 v[44:45], v[44:45], v[52:53]
    v_pk_mul_f32 v[46:47], v[46:47], v[54:55]
    v_pk_mul_f32 v[48:49], v[48:49], v[56:57]
    v_pk_mul_f32 v[50:51], v[50:51], v[58:59]
    v_cvt_pk_bf16_f32 v16, v44, v45
    v_lshlrev_b32 v44, 16, v16
    v_and_b32 v45, 0xffff0000, v16
    v_cvt_pk_bf16_f32 v16, v46, v47
    v_lshlrev_b32 v46, 16, v16
    v_and_b32 v47, 0xffff0000, v16
    v_cvt_pk_bf16_f32 v16, v48, v49
    v_lshlrev_b32 v48, 16, v16
    v_and_b32 v49, 0xffff0000, v16
    v_cvt_pk_bf16_f32 v16, v50, v51
    v_lshlrev_b32 v50, 16, v16
    v_and_b32 v51, 0xffff0000, v16
    v_lshlrev_b32 v52, 16, v184
    v_and_b32 v53, 0xffff0000, v184
    v_lshlrev_b32 v54, 16, v185
    v_and_b32 v55, 0xffff0000, v185
    v_lshlrev_b32 v56, 16, v186
    v_and_b32 v57, 0xffff0000, v186
    v_lshlrev_b32 v58, 16, v187
    v_and_b32 v59, 0xffff0000, v187
    v_pk_add_f32 v[44:45], v[44:45], v[52:53]
    v_pk_add_f32 v[46:47], v[46:47], v[54:55]
    v_pk_add_f32 v[48:49], v[48:49], v[56:57]
    v_pk_add_f32 v[50:51], v[50:51], v[58:59]
    v_cvt_pk_bf16_f32 v16, v44, v45
    v_lshlrev_b32 v44, 16, v16
    v_and_b32 v45, 0xffff0000, v16
    v_cvt_pk_bf16_f32 v16, v46, v47
    v_lshlrev_b32 v46, 16, v16
    v_and_b32 v47, 0xffff0000, v16
    v_cvt_pk_bf16_f32 v16, v48, v49
    v_lshlrev_b32 v48, 16, v16
    v_and_b32 v49, 0xffff0000, v16
    v_cvt_pk_bf16_f32 v16, v50, v51
    v_lshlrev_b32 v50, 16, v16
    v_and_b32 v51, 0xffff0000, v16
    v_lshlrev_b32 v52, 16, v200
    v_and_b32 v53, 0xffff0000, v200
    v_lshlrev_b32 v54, 16, v201
    v_and_b32 v55, 0xffff0000, v201
    v_lshlrev_b32 v56, 16, v202
    v_and_b32 v57, 0xffff0000, v202
    v_lshlrev_b32 v58, 16, v203
    v_and_b32 v59, 0xffff0000, v203
    v_pk_mul_f32 v[44:45], v[44:45], v[52:53]
    v_pk_mul_f32 v[46:47], v[46:47], v[54:55]
    v_pk_mul_f32 v[48:49], v[48:49], v[56:57]
    v_pk_mul_f32 v[50:51], v[50:51], v[58:59]
    v_cvt_pk_bf16_f32 v16, v44, v45
    v_lshlrev_b32 v44, 16, v16
    v_and_b32 v45, 0xffff0000, v16
    v_cvt_pk_bf16_f32 v16, v46, v47
    v_lshlrev_b32 v46, 16, v16
    v_and_b32 v47, 0xffff0000, v16
    v_cvt_pk_bf16_f32 v16, v48, v49
    v_lshlrev_b32 v48, 16, v16
    v_and_b32 v49, 0xffff0000, v16
    v_cvt_pk_bf16_f32 v16, v50, v51
    v_lshlrev_b32 v50, 16, v16
    v_and_b32 v51, 0xffff0000, v16
    v_pk_add_f32 v[44:45], v[44:45], v[28:29]
    v_pk_add_f32 v[46:47], v[46:47], v[30:31]
    v_pk_add_f32 v[48:49], v[48:49], v[32:33]
    v_pk_add_f32 v[50:51], v[50:51], v[34:35]
    v_cvt_pk_bf16_f32 v28, v44, v45
    v_cvt_pk_bf16_f32 v29, v46, v47
    v_cvt_pk_bf16_f32 v30, v48, v49
    v_cvt_pk_bf16_f32 v31, v50, v51
    v_sub_f32 v44, v36, v96
    v_sub_f32 v45, v37, v96
    v_sub_f32 v46, v38, v96
    v_sub_f32 v47, v39, v96
    v_sub_f32 v48, v40, v96
    v_sub_f32 v49, v41, v96
    v_sub_f32 v50, v42, v96
    v_sub_f32 v51, v43, v96
    v_cvt_pk_bf16_f32 v16, v44, v45
    v_lshlrev_b32 v44, 16, v16
    v_and_b32 v45, 0xffff0000, v16
    v_cvt_pk_bf16_f32 v16, v46, v47
    v_lshlrev_b32 v46, 16, v16
    v_and_b32 v47, 0xffff0000, v16
    v_cvt_pk_bf16_f32 v16, v48, v49
    v_lshlrev_b32 v48, 16, v16
    v_and_b32 v49, 0xffff0000, v16
    v_cvt_pk_bf16_f32 v16, v50, v51
    v_lshlrev_b32 v50, 16, v16
    v_and_b32 v51, 0xffff0000, v16
    v_mul_f32 v52, v44, v99
    v_mul_f32 v53, v45, v99
    v_mul_f32 v54, v46, v99
    v_mul_f32 v55, v47, v99
    v_mul_f32 v56, v48, v99
    v_mul_f32 v57, v49, v99
    v_mul_f32 v58, v50, v99
    v_mul_f32 v59, v51, v99
    v_fma_f32 v44, -v52, v98, v44
    v_fma_f32 v45, -v53, v98, v45
    v_fma_f32 v46, -v54, v98, v46
    v_fma_f32 v47, -v55, v98, v47
    v_fma_f32 v48, -v56, v98, v48
    v_fma_f32 v49, -v57, v98, v49
    v_fma_f32 v50, -v58, v98, v50
    v_fma_f32 v51, -v59, v98, v51
    v_fma_f32 v44, v44, v99, v52
    v_fma_f32 v45, v45, v99, v53
    v_fma_f32 v46, v46, v99, v54
    v_fma_f32 v47, v47, v99, v55
    v_fma_f32 v48, v48, v99, v56
    v_fma_f32 v49, v49, v99, v57
    v_fma_f32 v50, v50, v99, v58
    v_fma_f32 v51, v51, v99, v59
    v_cvt_pk_bf16_f32 v16, v44, v45
    v_lshlrev_b32 v44, 16, v16
    v_and_b32 v45, 0xffff0000, v16
    v_cvt_pk_bf16_f32 v16, v46, v47
    v_lshlrev_b32 v46, 16, v16
    v_and_b32 v47, 0xffff0000, v16
    v_cvt_pk_bf16_f32 v16, v48, v49
    v_lshlrev_b32 v48, 16, v16
    v_and_b32 v49, 0xffff0000, v16
    v_cvt_pk_bf16_f32 v16, v50, v51
    v_lshlrev_b32 v50, 16, v16
    v_and_b32 v51, 0xffff0000, v16
    v_lshlrev_b32 v52, 16, v196
    v_and_b32 v53, 0xffff0000, v196
    v_lshlrev_b32 v54, 16, v197
    v_and_b32 v55, 0xffff0000, v197
    v_lshlrev_b32 v56, 16, v198
    v_and_b32 v57, 0xffff0000, v198
    v_lshlrev_b32 v58, 16, v199
    v_and_b32 v59, 0xffff0000, v199
    v_pk_mul_f32 v[44:45], v[44:45], v[52:53]
    v_pk_mul_f32 v[46:47], v[46:47], v[54:55]
    v_pk_mul_f32 v[48:49], v[48:49], v[56:57]
    v_pk_mul_f32 v[50:51], v[50:51], v[58:59]
    v_cvt_pk_bf16_f32 v16, v44, v45
    v_lshlrev_b32 v44, 16, v16
    v_and_b32 v45, 0xffff0000, v16
    v_cvt_pk_bf16_f32 v16, v46, v47
    v_lshlrev_b32 v46, 16, v16
    v_and_b32 v47, 0xffff0000, v16
    v_cvt_pk_bf16_f32 v16, v48, v49
    v_lshlrev_b32 v48, 16, v16
    v_and_b32 v49, 0xffff0000, v16
    v_cvt_pk_bf16_f32 v16, v50, v51
    v_lshlrev_b32 v50, 16, v16
    v_and_b32 v51, 0xffff0000, v16
    v_lshlrev_b32 v52, 16, v188
    v_and_b32 v53, 0xffff0000, v188
    v_lshlrev_b32 v54, 16, v189
    v_and_b32 v55, 0xffff0000, v189
    v_lshlrev_b32 v56, 16, v190
    v_and_b32 v57, 0xffff0000, v190
    v_lshlrev_b32 v58, 16, v191
    v_and_b32 v59, 0xffff0000, v191
    v_pk_add_f32 v[44:45], v[44:45], v[52:53]
    v_pk_add_f32 v[46:47], v[46:47], v[54:55]
    v_pk_add_f32 v[48:49], v[48:49], v[56:57]
    v_pk_add_f32 v[50:51], v[50:51], v[58:59]
    v_cvt_pk_bf16_f32 v16, v44, v45
    v_lshlrev_b32 v44, 16, v16
    v_and_b32 v45, 0xffff0000, v16
    v_cvt_pk_bf16_f32 v16, v46, v47
    v_lshlrev_b32 v46, 16, v16
    v_and_b32 v47, 0xffff0000, v16
    v_cvt_pk_bf16_f32 v16, v48, v49
    v_lshlrev_b32 v48, 16, v16
    v_and_b32 v49, 0xffff0000, v16
    v_cvt_pk_bf16_f32 v16, v50, v51
    v_lshlrev_b32 v50, 16, v16
    v_and_b32 v51, 0xffff0000, v16
    v_lshlrev_b32 v52, 16, v204
    v_and_b32 v53, 0xffff0000, v204
    v_lshlrev_b32 v54, 16, v205
    v_and_b32 v55, 0xffff0000, v205
    v_lshlrev_b32 v56, 16, v206
    v_and_b32 v57, 0xffff0000, v206
    v_lshlrev_b32 v58, 16, v207
    v_and_b32 v59, 0xffff0000, v207
    v_pk_mul_f32 v[44:45], v[44:45], v[52:53]
    v_pk_mul_f32 v[46:47], v[46:47], v[54:55]
    v_pk_mul_f32 v[48:49], v[48:49], v[56:57]
    v_pk_mul_f32 v[50:51], v[50:51], v[58:59]
    v_cvt_pk_bf16_f32 v16, v44, v45
    v_lshlrev_b32 v44, 16, v16
    v_and_b32 v45, 0xffff0000, v16
    v_cvt_pk_bf16_f32 v16, v46, v47
    v_lshlrev_b32 v46, 16, v16
    v_and_b32 v47, 0xffff0000, v16
    v_cvt_pk_bf16_f32 v16, v48, v49
    v_lshlrev_b32 v48, 16, v16
    v_and_b32 v49, 0xffff0000, v16
    v_cvt_pk_bf16_f32 v16, v50, v51
    v_lshlrev_b32 v50, 16, v16
    v_and_b32 v51, 0xffff0000, v16
    v_pk_add_f32 v[44:45], v[44:45], v[36:37]
    v_pk_add_f32 v[46:47], v[46:47], v[38:39]
    v_pk_add_f32 v[48:49], v[48:49], v[40:41]
    v_pk_add_f32 v[50:51], v[50:51], v[42:43]
    v_cvt_pk_bf16_f32 v36, v44, v45
    v_cvt_pk_bf16_f32 v37, v46, v47
    v_cvt_pk_bf16_f32 v38, v48, v49
    v_cvt_pk_bf16_f32 v39, v50, v51
    v_lshlrev_b32 v18, 4, v0
    s_mov_b32 s16, 0x6e0000
    s_mov_b32 s27, 0
adaLN_cond__sliding_block_cached__moe_arch_mod__prompt_kernel_w12p:
    buffer_load_dwordx4 v[24:27], v18, s[8:11], s16 offen sc1
    s_waitcnt vmcnt(0)
    v_cmp_eq_u32 vcc, 0, v24
    s_add_u32 s27, s27, 1
    s_cmp_ge_u32 s27, 65536
    s_cbranch_scc1 adaLN_cond__sliding_block_cached__moe_arch_mod__prompt_kernel_w12g
    s_cbranch_vccnz adaLN_cond__sliding_block_cached__moe_arch_mod__prompt_kernel_w12p
adaLN_cond__sliding_block_cached__moe_arch_mod__prompt_kernel_w12g:
    v_mov_b32 v76, v24
    s_nop 1
    v_max_u32_dpp v76, v76, v76 row_ror:1 row_mask:0xf bank_mask:0xf
    s_nop 1
    v_max_u32_dpp v76, v76, v76 row_ror:2 row_mask:0xf bank_mask:0xf
    s_nop 1
    v_max_u32_dpp v76, v76, v76 row_ror:4 row_mask:0xf bank_mask:0xf
    s_nop 1
    v_max_u32_dpp v76, v76, v76 row_ror:8 row_mask:0xf bank_mask:0xf
    v_mov_b32 v77, v76
    s_nop 1
    v_permlane16_swap_b32 v76, v77
    v_max_u32 v76, v76, v77
    v_mov_b32 v77, v76
    s_nop 1
    v_permlane32_swap_b32 v76, v77
    v_max_u32 v76, v76, v77
    v_cmp_eq_u32 vcc, v76, v24
    s_lshl_b32 s16, s3, 4
    s_add_u32 s16, s16, 65792
    v_mov_b32 v16, s16
    s_and_saveexec_b64 s[62:63], vcc
    ds_write_b128 v16, v[24:27]
    s_mov_b64 exec, s[62:63]
    s_waitcnt lgkmcnt(0)
    s_barrier
    v_and_b32 v16, 3, v1
    v_lshlrev_b32 v16, 4, v16
    v_add_u32 v16, 65792, v16
    ds_read_b32 v76, v16
    s_waitcnt lgkmcnt(0)
    v_mov_b32 v77, v76
    s_nop 1
    v_max_u32_dpp v77, v77, v77 row_ror:1 row_mask:0xf bank_mask:0xf
    s_nop 1
    v_max_u32_dpp v77, v77, v77 row_ror:2 row_mask:0xf bank_mask:0xf
    v_cmp_eq_u32 vcc, v76, v77
    s_ff1_i32_b64 s16, vcc
    s_lshl_b32 s16, s16, 4
    s_add_u32 s16, s16, 65792
    v_mov_b32 v16, s16
    ds_read_b128 v[24:27], v16
    s_waitcnt lgkmcnt(0)
    v_and_b32 v76, 0x7ff, v24
    v_sub_u32 v76, 2047, v76
    s_nop 0
    v_readfirstlane_b32 s12, v76
    v_rcp_f32 v103, v26
    s_lshr_b32 s18, s12, 4
    s_lshl_b32 s18, s18, 15
    s_and_b32 s19, s12, 15
    s_lshl_b32 s19, s19, 6
    s_add_u32 s18, s18, s19
    s_add_u32 s18, s18, 0x2c00000
    s_add_u32 s19, s18, 0x400000
    v_lshrrev_b32 v18, 4, v0
    v_lshlrev_b32 v18, 10, v18
    v_and_b32 v19, 15, v0
    v_lshl_add_u32 v18, v19, 2, v18
    s_lshl_b32 s13, s12, 11
    buffer_load_dword v100, v18, s[8:11], s18 offen sc1
    buffer_load_dword v101, v18, s[8:11], s19 offen sc1
    buffer_load_dword v102, v21, s[76:79], s13 offen
    s_lshl_b32 s16, s14, 11
    s_cmp_lg_u32 s12, s14
    s_cselect_b32 s16, s16, 0x7ffffff0
    buffer_store_dwordx4 v[28:31], v2, s[68:71], s16 offen offset:0 sc1
    buffer_store_dwordx4 v[36:39], v2, s[68:71], s16 offen offset:1024 sc1
    s_lshl_b32 s16, s3, 13
    v_add_u32 v20, s16, v2
    s_waitcnt vmcnt(4)
    v_lshlrev_b32 v76, 16, v100
    v_and_b32 v77, 0xffff0000, v100
    s_waitcnt vmcnt(3)
    v_lshlrev_b32 v78, 16, v101
    v_and_b32 v79, 0xffff0000, v101
    v_pk_add_f32 v[76:77], v[76:77], v[78:79]
    s_waitcnt vmcnt(2)
    v_lshlrev_b32 v78, 16, v102
    v_and_b32 v79, 0xffff0000, v102
    v_pk_add_f32 v[92:93], v[78:79], v[76:77]
    v_cvt_pk_bf16_f32 v76, v92, v93
    v_lshlrev_b32 v92, 16, v76
    v_and_b32 v93, 0xffff0000, v76
    v_cvt_pk_bf16_f32 v100, v92, v93
    v_and_b32 v105, 0xffff0000, v104
    v_lshlrev_b32 v104, 16, v104
    v_and_b32 v107, 0xffff0000, v106
    v_lshlrev_b32 v106, 16, v106
    v_sub_f32 v92, v92, v25
    v_sub_f32 v93, v93, v25
    v_cvt_pk_bf16_f32 v76, v92, v93
    v_lshlrev_b32 v92, 16, v76
    v_and_b32 v93, 0xffff0000, v76
    v_mul_f32 v77, v92, v103
    v_fma_f32 v92, -v77, v26, v92
    v_fma_f32 v92, v92, v103, v77
    v_mul_f32 v77, v93, v103
    v_fma_f32 v93, -v77, v26, v93
    v_fma_f32 v93, v93, v103, v77
    v_cvt_pk_bf16_f32 v76, v92, v93
    v_lshlrev_b32 v92, 16, v76
    v_and_b32 v93, 0xffff0000, v76
    v_mul_f32 v92, v92, v104
    v_mul_f32 v93, v93, v105
    v_cvt_pk_bf16_f32 v76, v92, v93
    v_lshlrev_b32 v92, 16, v76
    v_and_b32 v93, 0xffff0000, v76
    v_add_f32 v92, v92, v106
    v_add_f32 v93, v93, v107
    v_cvt_pk_bf16_f32 v101, v92, v93
    v_add_u32 v16, 66560, v21
    ds_write_b32 v16, v101
    ds_write_b32 v16, v100 offset:2048
    s_waitcnt lgkmcnt(0)
    s_barrier
    ds_read_b128 v[60:63], v20 offset:0
    ds_read_b128 v[64:67], v20 offset:1024
    ds_read_b128 v[68:71], v20 offset:2048
    ds_read_b128 v[72:75], v20 offset:3072
    ds_read_b128 v[108:111], v20 offset:4096
    ds_read_b128 v[112:115], v20 offset:5120
    ds_read_b128 v[116:119], v20 offset:6144
    ds_read_b128 v[120:123], v20 offset:7168
    s_and_b32 s16, s3, 3
    s_lshl_b32 s16, s16, 7
    s_and_b32 s17, s29, 3
    s_lshl_b32 s17, s17, 9
    s_add_u32 s16, s16, s17
    s_add_u32 s16, s16, 66560
    v_lshrrev_b32 v16, 3, v1
    v_lshlrev_b32 v16, 4, v16
    v_add_u32 v16, s16, v16
    ds_read_b128 v[104:107], v16
    s_waitcnt lgkmcnt(0)
    v_lshlrev_b32 v76, 16, v104
    v_and_b32 v77, 0xffff, v104
    v_dot2_f32_bf16 v85, v60, v76, 0
    v_dot2_f32_bf16 v84, v60, v77, 0
    v_dot2_f32_bf16 v87, v61, v76, 0
    v_dot2_f32_bf16 v86, v61, v77, 0
    v_dot2_f32_bf16 v89, v62, v76, 0
    v_dot2_f32_bf16 v88, v62, v77, 0
    v_dot2_f32_bf16 v91, v63, v76, 0
    v_dot2_f32_bf16 v90, v63, v77, 0
    v_and_b32 v78, 0xffff0000, v104
    v_lshrrev_b32 v79, 16, v104
    v_dot2c_f32_bf16 v85, v64, v78
    v_dot2c_f32_bf16 v84, v64, v79
    v_dot2c_f32_bf16 v87, v65, v78
    v_dot2c_f32_bf16 v86, v65, v79
    v_dot2c_f32_bf16 v89, v66, v78
    v_dot2c_f32_bf16 v88, v66, v79
    v_dot2c_f32_bf16 v91, v67, v78
    v_dot2c_f32_bf16 v90, v67, v79
    v_lshlrev_b32 v80, 16, v105
    v_and_b32 v81, 0xffff, v105
    v_dot2c_f32_bf16 v85, v68, v80
    v_dot2c_f32_bf16 v84, v68, v81
    v_dot2c_f32_bf16 v87, v69, v80
    v_dot2c_f32_bf16 v86, v69, v81
    v_dot2c_f32_bf16 v89, v70, v80
    v_dot2c_f32_bf16 v88, v70, v81
    v_dot2c_f32_bf16 v91, v71, v80
    v_dot2c_f32_bf16 v90, v71, v81
    v_and_b32 v82, 0xffff0000, v105
    v_lshrrev_b32 v83, 16, v105
    v_dot2c_f32_bf16 v85, v72, v82
    v_dot2c_f32_bf16 v84, v72, v83
    v_dot2c_f32_bf16 v87, v73, v82
    v_dot2c_f32_bf16 v86, v73, v83
    v_dot2c_f32_bf16 v89, v74, v82
    v_dot2c_f32_bf16 v88, v74, v83
    v_dot2c_f32_bf16 v91, v75, v82
    v_dot2c_f32_bf16 v90, v75, v83
    v_lshlrev_b32 v76, 16, v106
    v_and_b32 v77, 0xffff, v106
    v_dot2c_f32_bf16 v85, v108, v76
    v_dot2c_f32_bf16 v84, v108, v77
    v_dot2c_f32_bf16 v87, v109, v76
    v_dot2c_f32_bf16 v86, v109, v77
    v_dot2c_f32_bf16 v89, v110, v76
    v_dot2c_f32_bf16 v88, v110, v77
    v_dot2c_f32_bf16 v91, v111, v76
    v_dot2c_f32_bf16 v90, v111, v77
    v_and_b32 v78, 0xffff0000, v106
    v_lshrrev_b32 v79, 16, v106
    v_dot2c_f32_bf16 v85, v112, v78
    v_dot2c_f32_bf16 v84, v112, v79
    v_dot2c_f32_bf16 v87, v113, v78
    v_dot2c_f32_bf16 v86, v113, v79
    v_dot2c_f32_bf16 v89, v114, v78
    v_dot2c_f32_bf16 v88, v114, v79
    v_dot2c_f32_bf16 v91, v115, v78
    v_dot2c_f32_bf16 v90, v115, v79
    v_lshlrev_b32 v80, 16, v107
    v_and_b32 v81, 0xffff, v107
    v_dot2c_f32_bf16 v85, v116, v80
    v_dot2c_f32_bf16 v84, v116, v81
    v_dot2c_f32_bf16 v87, v117, v80
    v_dot2c_f32_bf16 v86, v117, v81
    v_dot2c_f32_bf16 v89, v118, v80
    v_dot2c_f32_bf16 v88, v118, v81
    v_dot2c_f32_bf16 v91, v119, v80
    v_dot2c_f32_bf16 v90, v119, v81
    v_and_b32 v82, 0xffff0000, v107
    v_lshrrev_b32 v83, 16, v107
    v_dot2c_f32_bf16 v85, v120, v82
    v_dot2c_f32_bf16 v84, v120, v83
    v_dot2c_f32_bf16 v87, v121, v82
    v_dot2c_f32_bf16 v86, v121, v83
    v_dot2c_f32_bf16 v89, v122, v82
    v_dot2c_f32_bf16 v88, v122, v83
    v_dot2c_f32_bf16 v91, v123, v82
    v_dot2c_f32_bf16 v90, v123, v83
    s_nop 0
    v_permlane32_swap_b32 v84, v88
    v_permlane32_swap_b32 v85, v89
    v_permlane32_swap_b32 v86, v90
    v_permlane32_swap_b32 v87, v91
    v_add_f32 v84, v84, v88
    v_add_f32 v85, v85, v89
    v_add_f32 v86, v86, v90
    v_add_f32 v87, v87, v91
    s_nop 0
    v_permlane16_swap_b32 v84, v86
    v_permlane16_swap_b32 v85, v87
    v_add_f32 v84, v84, v86
    v_add_f32 v85, v85, v87
    s_nop 0
    v_add_f32_dpp v84, v84, v84 row_ror:8 row_mask:0xf bank_mask:0xf
    v_add_f32_dpp v85, v85, v85 row_ror:8 row_mask:0xf bank_mask:0xf
    v_and_b32 v16, 7, v1
    v_lshlrev_b32 v16, 5, v16
    v_lshrrev_b32 v17, 4, v1
    v_lshl_add_u32 v16, v17, 3, v16
    s_lshl_b32 s16, s3, 8
    s_add_u32 s16, s16, 70656
    v_add_u32 v16, s16, v16
    ds_write_b64 v16, v[84:85]
    s_lshr_b32 s16, s3, 2
    s_lshl_b32 s17, s16, 10
    s_add_u32 s17, s17, 70656
    v_lshlrev_b32 v17, 2, v1
    v_add_u32 v16, s17, v17
    s_and_b32 s17, s29, 3
    s_lshl_b32 s17, s17, 1
    s_add_u32 s17, s17, s16
    s_mul_i32 s17, s17, 14336
    s_lshr_b32 s16, s29, 2
    s_lshl_b32 s16, s16, 8
    s_add_u32 s17, s17, s16
    s_add_u32 s17, s17, 0x6e1000
    s_and_b32 s16, s3, 3
    s_cmp_eq_u32 s16, 0
    s_cselect_b32 s17, s17, 0x7ffffff0
    s_cmp_lt_u32 s2, 224
    s_cselect_b32 s17, s17, 0x7ffffff0
    s_waitcnt lgkmcnt(0)
    s_barrier
    ds_read_b32 v84, v16 offset:0
    ds_read_b32 v85, v16 offset:256
    ds_read_b32 v86, v16 offset:512
    ds_read_b32 v87, v16 offset:768
    s_waitcnt lgkmcnt(2)
    v_add_f32 v84, v84, v85
    s_waitcnt lgkmcnt(0)
    v_add_f32 v86, v86, v87
    v_add_f32 v84, v84, v86
    v_or_b32 v84, 1, v84
    buffer_store_dword v84, v17, s[8:11], s17 offen sc1
    s_barrier
    v_lshlrev_b32 v16, 3, v0
    v_add_u32 v17, 73728, v16
    ds_read_b64 v[84:85], v17 offset:0
    ds_read_b64 v[86:87], v17 offset:4096
    ds_read_b64 v[88:89], v17 offset:8192
    ds_read_b64 v[90:91], v17 offset:12288
    s_waitcnt lgkmcnt(2)
    v_pk_add_f32 v[84:85], v[84:85], v[86:87]
    s_waitcnt lgkmcnt(0)
    v_pk_add_f32 v[88:89], v[88:89], v[90:91]
    v_pk_add_f32 v[84:85], v[84:85], v[88:89]
    v_or_b32 v84, 1, v84
    v_or_b32 v85, 1, v85
    s_lshl_b32 s16, s29, 12
    s_add_u32 s16, s16, 0x600000
    s_cmp_lt_u32 s2, 224
    s_cselect_b32 s16, s16, 0x7ffffff0
    buffer_store_dwordx2 v[84:85], v16, s[8:11], s16 offen sc1
    s_cmp_lt_u32 s2, 224
    s_cbranch_scc1 adaLN_cond__sliding_block_cached__moe_arch_mod__prompt_kernel_end
    s_sub_u32 s16, s2, 224
    s_lshl_b32 s17, s16, 7
    s_add_u32 s17, s17, 0x600000
    v_lshrrev_b32 v16, 3, v0
    v_lshlrev_b32 v16, 12, v16
    v_and_b32 v17, 7, v0
    v_lshl_add_u32 v16, v17, 4, v16
    v_cmp_gt_u32 vcc, 256, v0
    v_bfrev_b32 v17, -2
    s_nop 0
    v_cndmask_b32 v17, v17, v16, vcc
    v_mov_b32 v19, 0
    v_cndmask_b32 v18, 1, v19, vcc
    s_lshl_b32 s18, s16, 6
    v_and_b32 v19, 31, v1
    v_lshlrev_b32 v19, 1, v19
    v_add_u32 v19, s18, v19
    s_mov_b32 s19, 0x541800
    buffer_load_ushort v95, v19, s[8:11], s19 offen sc1
    v_add_u32 v20, 66560, v19
    ds_read_u16 v96, v20
    ds_read_u16 v97, v20 offset:2048
    v_mov_b32 v94, v27
    v_cvt_pk_bf16_f32 v94, v94, v94
    v_lshlrev_b32 v94, 16, v94
    v_mul_f32 v94, 0xbfb8aa3b, v94
    v_exp_f32 v94, v94
    s_nop 0
    v_add_f32 v94, 1.0, v94
    v_rcp_f32 v94, v94
    s_nop 0
    v_cvt_pk_bf16_f32 v94, v94, v94
    v_lshlrev_b32 v94, 16, v94
    s_waitcnt vmcnt(0)
    v_lshlrev_b32 v95, 16, v95
    s_waitcnt lgkmcnt(1)
    v_lshlrev_b32 v96, 16, v96
    s_waitcnt lgkmcnt(0)
    v_lshlrev_b32 v97, 16, v97
    s_mov_b32 s27, 0
adaLN_cond__sliding_block_cached__moe_arch_mod__prompt_kernel_y13p:
    s_add_u32 s19, s17, 0x0
    buffer_load_dwordx4 v[44:47], v16, s[8:11], s19 offen sc1
    s_add_u32 s19, s17, 0x40000
    buffer_load_dwordx4 v[48:51], v16, s[8:11], s19 offen sc1
    s_add_u32 s19, s17, 0x80000
    buffer_load_dwordx4 v[52:55], v16, s[8:11], s19 offen sc1
    s_add_u32 s19, s17, 0xc0000
    buffer_load_dwordx4 v[56:59], v17, s[8:11], s19 offen sc1
    s_waitcnt vmcnt(0)
    v_min3_u32 v98, v56, v57, v58
    v_min_u32 v98, v98, v59
    v_or_b32 v98, v98, v18
    v_min3_u32 v98, v98, v44, v45
    v_min3_u32 v98, v98, v46, v47
    v_min3_u32 v98, v98, v48, v49
    v_min3_u32 v98, v98, v50, v51
    v_min3_u32 v98, v98, v52, v53
    v_min3_u32 v98, v98, v54, v55
    v_cmp_eq_u32 vcc, 0, v98
    s_add_u32 s27, s27, 1
    s_cmp_ge_u32 s27, 65536
    s_cbranch_scc1 adaLN_cond__sliding_block_cached__moe_arch_mod__prompt_kernel_y13g
    s_cbranch_vccnz adaLN_cond__sliding_block_cached__moe_arch_mod__prompt_kernel_y13p
adaLN_cond__sliding_block_cached__moe_arch_mod__prompt_kernel_y13g:
    v_pk_add_f32 v[44:45], v[44:45], v[52:53]
    v_pk_add_f32 v[46:47], v[46:47], v[54:55]
    v_pk_add_f32 v[48:49], v[48:49], v[56:57]
    v_pk_add_f32 v[50:51], v[50:51], v[58:59]
    v_pk_add_f32 v[44:45], v[44:45], v[48:49]
    v_pk_add_f32 v[46:47], v[46:47], v[50:51]
    s_nop 0
    v_add_f32_dpp v44, v44, v44 row_ror:8 row_mask:0xf bank_mask:0xf
    v_add_f32_dpp v45, v45, v45 row_ror:8 row_mask:0xf bank_mask:0xf
    v_add_f32_dpp v46, v46, v46 row_ror:8 row_mask:0xf bank_mask:0xf
    v_add_f32_dpp v47, v47, v47 row_ror:8 row_mask:0xf bank_mask:0xf
    s_nop 0
    v_permlane32_swap_b32 v44, v46
    v_permlane32_swap_b32 v45, v47
    v_add_f32 v44, v44, v46
    v_add_f32 v45, v45, v47
    s_nop 1
    v_permlane16_swap_b32 v44, v45
    v_add_f32 v44, v44, v45
    v_and_b32 v16, 7, v1
    v_lshlrev_b32 v16, 4, v16
    v_lshrrev_b32 v17, 4, v1
    v_lshl_add_u32 v16, v17, 2, v16
    s_lshl_b32 s19, s3, 7
    s_add_u32 s19, s19, 91136
    v_add_u32 v16, s19, v16
    ds_write_b32 v16, v44
    v_and_b32 v16, 31, v1
    v_lshlrev_b32 v16, 2, v16
    v_add_u32 v16, 91136, v16
    s_waitcnt lgkmcnt(0)
    s_barrier
    s_cmp_lg_u32 s3, 0
    s_cbranch_scc1 adaLN_cond__sliding_block_cached__moe_arch_mod__prompt_kernel_end
    ds_read_b32 v44, v16 offset:0
    ds_read_b32 v45, v16 offset:128
    ds_read_b32 v46, v16 offset:256
    ds_read_b32 v47, v16 offset:384
    ds_read_b32 v48, v16 offset:512
    ds_read_b32 v49, v16 offset:640
    ds_read_b32 v50, v16 offset:768
    ds_read_b32 v51, v16 offset:896
    s_waitcnt lgkmcnt(3)
    v_add_f32 v44, v44, v48
    s_waitcnt lgkmcnt(2)
    v_add_f32 v45, v45, v49
    s_waitcnt lgkmcnt(1)
    v_add_f32 v46, v46, v50
    s_waitcnt lgkmcnt(0)
    v_add_f32 v47, v47, v51
    v_add_f32 v44, v44, v46
    v_add_f32 v45, v45, v47
    v_add_f32 v44, v44, v45
    v_cvt_pk_bf16_f32 v44, v44, v44
    v_lshlrev_b32 v44, 16, v44
    v_mul_f32 v44, v44, v94
    v_cvt_pk_bf16_f32 v44, v44, v44
    v_lshlrev_b32 v44, 16, v44
    v_add_f32 v44, v44, v96
    v_cvt_pk_bf16_f32 v44, v44, v44
    v_lshlrev_b32 v44, 16, v44
    v_mul_f32 v44, v44, v95
    v_cvt_pk_bf16_f32 v44, v44, v44
    v_lshlrev_b32 v44, 16, v44
    v_add_f32 v44, v44, v97
    v_cvt_pk_bf16_f32 v44, v44, v44
    s_mov_b64 exec, 0xffffffff
    buffer_store_short v44, v19, s[68:71], s13 offen sc1
    s_branch adaLN_cond__sliding_block_cached__moe_arch_mod__prompt_kernel_end
adaLN_cond__sliding_block_cached__moe_arch_mod__prompt_kernel_roleB:
    v_mov_b32 v132, 0
    v_mov_b32 v133, 0
    v_lshrrev_b32 v16, 3, v0
    v_and_b32 v17, 7, v0
    v_mul_u32_u24 v135, 24576, v16
    v_lshl_add_u32 v135, v17, 4, v135
    v_lshlrev_b32 v136, 2, v16
    s_and_b32 s14, s2, 31
    s_lshr_b32 s15, s2, 5
    s_mul_i32 s26, s15, 1572864
    s_lshl_b32 s16, s14, 7
    s_add_u32 s26, s26, s16
    s_lshl_b32 s29, s15, 8
    v_lshlrev_b32 v137, 3, v0
    s_lshl_b32 s18, s2, 3
    s_add_u32 s18, s18, s3
    s_lshl_b32 s18, s18, 11
    v_and_b32 v18, 15, v1
    v_lshrrev_b32 v19, 4, v1
    v_lshlrev_b32 v138, 11, v18
    v_lshl_add_u32 v138, v19, 4, v138
    s_lshr_b32 s30, s2, 4
    s_and_b32 s31, s2, 15
    s_lshl_b32 s19, s30, 3
    s_add_u32 s19, s19, s3
    s_lshl_b32 s22, s19, 15
    s_lshl_b32 s23, s31, 7
    s_add_u32 s22, s22, s23
    s_lshl_b32 s23, s2, 12
    s_add_u32 s23, s23, 0x600000
    s_or_b32 s25, s2, s3
    s_cmp_eq_u32 s25, 0
    s_cselect_b32 s25, 0, 0x7ffffff0
    s_waitcnt lgkmcnt(0)
    s_mov_b64 s[64:65], s[58:59]
    s_mov_b32 s66, 0x100
    s_mov_b32 s67, 0x20000
    s_or_b32 s28, s62, 1
    v_mov_b32 v134, s28
    s_mov_b64 exec, 1
    buffer_store_dword v134, v132, s[64:67], s25 offen sc1
    s_mov_b64 exec, -1
    s_mov_b64 s[68:69], s[52:53]
    s_mov_b32 s70, 0x800
    s_mov_b32 s71, 0x20000
    s_mov_b64 s[72:73], s[54:55]
    s_mov_b32 s74, 0xc00000
    s_mov_b32 s75, 0x20000
    s_mov_b64 s[76:77], s[32:33]
    s_mov_b32 s78, 0x400000
    s_mov_b32 s79, 0x20000
    s_mov_b64 s[8:9], s[60:61]
    s_mov_b32 s10, 0x3400000
    s_mov_b32 s11, 0x20000
    buffer_load_dword v72, v136, s[68:71], s29 offen
    buffer_load_dwordx4 v[24:27], v135, s[72:75], s26 offen
    s_add_u32 s26, s26, 12288
    buffer_load_dwordx4 v[28:31], v135, s[72:75], s26 offen
    buffer_load_dwordx4 v[32:35], v2, s[76:79], s18 offen offset:0
    buffer_load_dwordx4 v[36:39], v2, s[76:79], s18 offen offset:1024
    buffer_store_dwordx2 v[132:133], v137, s[8:11], s23 offen sc1
    s_barrier
    buffer_load_dwordx4 v[40:43], v138, s[76:79], s22 offen offset:0
    buffer_load_dwordx4 v[44:47], v138, s[76:79], s22 offen offset:64
    s_mov_b32 s29, s19
    s_mov_b64 s[64:65], s[34:35]
    s_mov_b32 s66, 0x200000
    s_mov_b32 s67, 0x20000
    s_mov_b64 s[68:69], s[36:37]
    s_mov_b32 s70, 0x200000
    s_mov_b32 s71, 0x20000
    s_lshl_b32 s20, s2, 2
    s_add_u32 s20, s20, s3
    s_sub_u32 s20, s20, 4
    s_lshr_b32 s22, s20, 8
    s_bfe_u32 s23, s20, 0x40004
    s_and_b32 s24, s20, 15
    s_lshl_b32 s25, s22, 19
    s_lshl_b32 s26, s23, 13
    s_add_u32 s25, s25, s26
    s_add_u32 s25, s25, 393216
    v_and_b32 v16, 15, v1
    v_lshrrev_b32 v17, 4, v1
    s_lshl_b32 s21, s22, 17
    s_cmp_ge_u32 s24, 8
    s_cbranch_scc1 adaLN_cond__sliding_block_cached__moe_arch_mod__prompt_kernel_kvV
    v_lshlrev_b32 v18, 8, v16
    v_lshl_add_u32 v18, v17, 3, v18
    s_and_b32 s26, s24, 1
    s_lshl_b32 s26, s26, 12
    s_add_u32 s25, s25, s26
    s_lshr_b32 s26, s24, 1
    s_lshl_b32 s26, s26, 6
    s_add_u32 s25, s25, s26
    buffer_load_dwordx2 v[84:85], v18, s[64:67], s25 offen
    buffer_load_dwordx2 v[86:87], v18, s[64:67], s25 offen offset:32
    s_lshl_b32 s26, s23, 13
    s_add_u32 s21, s21, s26
    s_lshl_b32 s26, s24, 10
    s_add_u32 s21, s21, s26
    s_add_u32 s21, s21, 0x400000
    s_branch adaLN_cond__sliding_block_cached__moe_arch_mod__prompt_kernel_kvJ
adaLN_cond__sliding_block_cached__moe_arch_mod__prompt_kernel_kvV:
    s_bfe_u32 s26, s24, 0x20001
    s_lshl_b32 s26, s26, 6
    s_add_u32 s25, s25, s26
    s_and_b32 s26, s24, 1
    s_lshl_b32 s26, s26, 3
    s_add_u32 s25, s25, s26
    s_add_u32 s26, s25, 4096
    v_lshrrev_b32 v18, 2, v16
    v_lshlrev_b32 v18, 4, v18
    v_and_b32 v19, 3, v16
    v_lshl_add_u32 v18, v19, 1, v18
    v_lshl_add_u32 v18, v17, 10, v18
    buffer_load_ushort v88, v18, s[68:71], s25 offen offset:0
    buffer_load_ushort v89, v18, s[68:71], s25 offen offset:256
    buffer_load_ushort v90, v18, s[68:71], s25 offen offset:512
    buffer_load_ushort v91, v18, s[68:71], s25 offen offset:768
    buffer_load_ushort v92, v18, s[68:71], s26 offen offset:0
    buffer_load_ushort v93, v18, s[68:71], s26 offen offset:256
    buffer_load_ushort v94, v18, s[68:71], s26 offen offset:512
    buffer_load_ushort v95, v18, s[68:71], s26 offen offset:768
    s_bfe_u32 s26, s24, 0x20001
    s_lshl_b32 s26, s26, 15
    s_add_u32 s21, s21, s26
    s_lshl_b32 s26, s23, 11
    s_add_u32 s21, s21, s26
    s_and_b32 s26, s24, 1
    s_lshl_b32 s26, s26, 10
    s_add_u32 s21, s21, s26
    s_add_u32 s21, s21, 0x480000
adaLN_cond__sliding_block_cached__moe_arch_mod__prompt_kernel_kvJ:
    s_waitcnt vmcnt(9)
    v_and_b32 v73, 0xffff0000, v72
    v_lshlrev_b32 v72, 16, v72
    v_mul_f32 v16, 0xbfb8aa3b, v72
    v_exp_f32 v16, v16
    s_nop 0
    v_add_f32 v16, 1.0, v16
    v_rcp_f32 v16, v16
    s_nop 0
    v_mul_f32 v72, v72, v16
    v_mul_f32 v17, 0xbfb8aa3b, v73
    v_exp_f32 v17, v17
    s_nop 0
    v_add_f32 v17, 1.0, v17
    v_rcp_f32 v17, v17
    s_nop 0
    v_mul_f32 v73, v73, v17
    v_cvt_pk_bf16_f32 v16, v72, v73
    v_lshlrev_b32 v72, 16, v16
    v_and_b32 v73, 0xffff0000, v16
    s_lshl_b32 s16, s2, 8
    s_add_u32 s16, s16, 0x550000
    s_mov_b32 exec_lo, 0x01010101
    s_mov_b32 exec_hi, 0x01010101
    buffer_store_dword v16, v136, s[8:11], s16 offen sc1
    s_mov_b64 exec, -1
    v_lshrrev_b32 v74, 16, v72
    v_lshrrev_b32 v75, 16, v73
    s_waitcnt vmcnt(9)
    v_dot2_f32_bf16 v49, v24, v72, 0
    v_dot2_f32_bf16 v48, v24, v74, 0
    v_dot2_f32_bf16 v51, v25, v72, 0
    v_dot2_f32_bf16 v50, v25, v74, 0
    v_dot2_f32_bf16 v53, v26, v72, 0
    v_dot2_f32_bf16 v52, v26, v74, 0
    v_dot2_f32_bf16 v55, v27, v72, 0
    v_dot2_f32_bf16 v54, v27, v74, 0
    s_waitcnt vmcnt(8)
    v_dot2c_f32_bf16 v49, v28, v73
    v_dot2c_f32_bf16 v48, v28, v75
    v_dot2c_f32_bf16 v51, v29, v73
    v_dot2c_f32_bf16 v50, v29, v75
    v_dot2c_f32_bf16 v53, v30, v73
    v_dot2c_f32_bf16 v52, v30, v75
    v_dot2c_f32_bf16 v55, v31, v73
    v_dot2c_f32_bf16 v54, v31, v75
    s_nop 0
    v_permlane32_swap_b32 v48, v52
    v_permlane32_swap_b32 v49, v53
    v_permlane32_swap_b32 v50, v54
    v_permlane32_swap_b32 v51, v55
    v_add_f32 v48, v48, v52
    v_add_f32 v49, v49, v53
    v_add_f32 v50, v50, v54
    v_add_f32 v51, v51, v55
    s_nop 0
    v_permlane16_swap_b32 v48, v50
    v_permlane16_swap_b32 v49, v51
    v_add_f32 v48, v48, v50
    v_add_f32 v49, v49, v51
    s_nop 0
    v_add_f32_dpp v48, v48, v48 row_ror:8 row_mask:0xf bank_mask:0xf
    v_add_f32_dpp v49, v49, v49 row_ror:8 row_mask:0xf bank_mask:0xf
    v_and_b32 v16, 7, v1
    v_lshlrev_b32 v16, 5, v16
    v_lshrrev_b32 v17, 4, v1
    v_lshl_add_u32 v16, v17, 3, v16
    s_lshl_b32 s16, s3, 8
    s_add_u32 s16, s16, 65536
    v_add_u32 v16, s16, v16
    ds_write_b64 v16, v[48:49]
    s_waitcnt vmcnt(7)
    v_lshlrev_b32 v56, 16, v32
    v_and_b32 v57, 0xffff0000, v32
    v_lshlrev_b32 v58, 16, v33
    v_and_b32 v59, 0xffff0000, v33
    v_lshlrev_b32 v60, 16, v34
    v_and_b32 v61, 0xffff0000, v34
    v_lshlrev_b32 v62, 16, v35
    v_and_b32 v63, 0xffff0000, v35
    s_waitcnt vmcnt(6)
    v_lshlrev_b32 v64, 16, v36
    v_and_b32 v65, 0xffff0000, v36
    v_lshlrev_b32 v66, 16, v37
    v_and_b32 v67, 0xffff0000, v37
    v_lshlrev_b32 v68, 16, v38
    v_and_b32 v69, 0xffff0000, v38
    v_lshlrev_b32 v70, 16, v39
    v_and_b32 v71, 0xffff0000, v39
    v_add_f32 v20, v56, v57
    v_add_f32 v21, v58, v59
    v_add_f32 v20, v20, v60
    v_add_f32 v21, v21, v61
    v_add_f32 v20, v20, v62
    v_add_f32 v21, v21, v63
    v_add_f32 v20, v20, v64
    v_add_f32 v21, v21, v65
    v_add_f32 v20, v20, v66
    v_add_f32 v21, v21, v67
    v_add_f32 v20, v20, v68
    v_add_f32 v21, v21, v69
    v_add_f32 v20, v20, v70
    v_add_f32 v21, v21, v71
    v_add_f32 v128, v20, v21
    s_nop 1
    v_add_f32_dpp v128, v128, v128 row_ror:1 row_mask:0xf bank_mask:0xf
    s_nop 1
    v_add_f32_dpp v128, v128, v128 row_ror:2 row_mask:0xf bank_mask:0xf
    s_nop 1
    v_add_f32_dpp v128, v128, v128 row_ror:4 row_mask:0xf bank_mask:0xf
    s_nop 1
    v_add_f32_dpp v128, v128, v128 row_ror:8 row_mask:0xf bank_mask:0xf
    v_mov_b32 v20, v128
    s_nop 1
    v_permlane16_swap_b32 v128, v20
    v_add_f32 v128, v128, v20
    v_mov_b32 v20, v128
    s_nop 1
    v_permlane32_swap_b32 v128, v20
    v_add_f32 v128, v128, v20
    v_mul_f32 v128, 0x3a800000, v128
    v_sub_f32 v18, v56, v128
    v_mul_f32 v20, v18, v18
    v_sub_f32 v19, v57, v128
    v_mul_f32 v21, v19, v19
    v_sub_f32 v18, v58, v128
    v_sub_f32 v19, v59, v128
    v_fmac_f32 v20, v18, v18
    v_fmac_f32 v21, v19, v19
    v_sub_f32 v18, v60, v128
    v_sub_f32 v19, v61, v128
    v_fmac_f32 v20, v18, v18
    v_fmac_f32 v21, v19, v19
    v_sub_f32 v18, v62, v128
    v_sub_f32 v19, v63, v128
    v_fmac_f32 v20, v18, v18
    v_fmac_f32 v21, v19, v19
    v_sub_f32 v18, v64, v128
    v_sub_f32 v19, v65, v128
    v_fmac_f32 v20, v18, v18
    v_fmac_f32 v21, v19, v19
    v_sub_f32 v18, v66, v128
    v_sub_f32 v19, v67, v128
    v_fmac_f32 v20, v18, v18
    v_fmac_f32 v21, v19, v19
    v_sub_f32 v18, v68, v128
    v_sub_f32 v19, v69, v128
    v_fmac_f32 v20, v18, v18
    v_fmac_f32 v21, v19, v19
    v_sub_f32 v18, v70, v128
    v_sub_f32 v19, v71, v128
    v_fmac_f32 v20, v18, v18
    v_fmac_f32 v21, v19, v19
    v_add_f32 v17, v20, v21
    s_nop 1
    v_add_f32_dpp v17, v17, v17 row_ror:1 row_mask:0xf bank_mask:0xf
    s_nop 1
    v_add_f32_dpp v17, v17, v17 row_ror:2 row_mask:0xf bank_mask:0xf
    s_nop 1
    v_add_f32_dpp v17, v17, v17 row_ror:4 row_mask:0xf bank_mask:0xf
    s_nop 1
    v_add_f32_dpp v17, v17, v17 row_ror:8 row_mask:0xf bank_mask:0xf
    v_mov_b32 v20, v17
    s_nop 1
    v_permlane16_swap_b32 v17, v20
    v_add_f32 v17, v17, v20
    v_mov_b32 v20, v17
    s_nop 1
    v_permlane32_swap_b32 v17, v20
    v_add_f32 v17, v17, v20
    v_mul_f32 v17, 0x3a800000, v17
    v_cvt_pk_bf16_f32 v128, v128, v128
    v_lshlrev_b32 v128, 16, v128
    v_cvt_pk_bf16_f32 v17, v17, v17
    v_lshlrev_b32 v17, 16, v17
    v_add_f32 v17, 0x3727c5ac, v17
    v_cvt_pk_bf16_f32 v17, v17, v17
    v_lshlrev_b32 v17, 16, v17
    v_sqrt_f32 v129, v17
    s_nop 0
    v_cvt_pk_bf16_f32 v129, v129, v129
    v_lshlrev_b32 v129, 16, v129
    v_rcp_f32 v130, v129
    s_lshl_b32 s16, s3, 4
    s_add_u32 s16, s16, 67600
    v_mov_b32 v19, s16
    ds_write_b128 v19, v[128:131]
    v_mov_b32 v19, 67584
    v_and_b32 v17, 31, v1
    v_lshlrev_b32 v18, 3, v17
    v_add_u32 v18, 65536, v18
    v_lshlrev_b32 v17, 4, v17
    s_waitcnt lgkmcnt(0)
    s_barrier
    ds_read_b32 v134, v19
    ds_read_b64 v[96:97], v18 offset:0
    ds_read_b64 v[100:101], v18 offset:256
    ds_read_b64 v[104:105], v18 offset:512
    ds_read_b64 v[108:109], v18 offset:768
    ds_read_b64 v[112:113], v18 offset:1024
    ds_read_b64 v[116:117], v18 offset:1280
    ds_read_b64 v[120:121], v18 offset:1536
    ds_read_b64 v[124:125], v18 offset:1792
    s_waitcnt lgkmcnt(8)
    v_readfirstlane_b32 s28, v134
    v_and_b32 v20, 7, v1
    v_lshlrev_b32 v20, 4, v20
    v_add_u32 v21, 67600, v20
    ds_read_b128 v[128:131], v21
    s_waitcnt lgkmcnt(0)
    v_mov_b32 v131, s28
    s_lshl_b32 s16, s2, 7
    s_add_u32 s16, s16, 0x520000
    s_cmp_eq_u32 s3, 0
    s_cselect_b32 s16, s16, 0x7ffffff0
    s_mov_b64 exec, 0xff
    buffer_store_dwordx4 v[128:131], v20, s[8:11], s16 offen sc1
    s_mov_b64 exec, -1
    v_pk_add_f32 v[96:97], v[96:97], v[112:113]
    v_pk_add_f32 v[100:101], v[100:101], v[116:117]
    v_pk_add_f32 v[104:105], v[104:105], v[120:121]
    v_pk_add_f32 v[108:109], v[108:109], v[124:125]
    v_pk_add_f32 v[96:97], v[96:97], v[104:105]
    v_pk_add_f32 v[100:101], v[100:101], v[108:109]
    v_pk_add_f32 v[96:97], v[96:97], v[100:101]
    v_mov_b32 v98, s28
    v_mov_b32 v99, s28
    s_lshl_b32 s16, s14, 3
    s_add_u32 s16, s16, s15
    s_lshl_b32 s16, s16, 9
    s_add_u32 s16, s16, 0x500000
    s_cmp_eq_u32 s3, 0
    s_cselect_b32 s16, s16, 0x7ffffff0
    s_mov_b64 exec, 0xffffffff
    buffer_store_dwordx4 v[96:99], v17, s[8:11], s16 offen sc1
    s_mov_b64 exec, -1
    s_cmp_lt_u32 s24, 8
    s_cbranch_scc1 adaLN_cond__sliding_block_cached__moe_arch_mod__prompt_kernel_kvS
    s_waitcnt vmcnt(4)
    v_lshl_or_b32 v84, v89, 16, v88
    v_lshl_or_b32 v85, v91, 16, v90
    s_waitcnt vmcnt(3)
    v_lshl_or_b32 v86, v93, 16, v92
    v_lshl_or_b32 v87, v95, 16, v94
    v_and_b32 v88, 0x7fff, v88
    v_and_b32 v89, 0x7fff, v89
    v_and_b32 v90, 0x7fff, v90
    v_and_b32 v91, 0x7fff, v91
    v_and_b32 v92, 0x7fff, v92
    v_and_b32 v93, 0x7fff, v93
    v_and_b32 v94, 0x7fff, v94
    v_and_b32 v95, 0x7fff, v95
    v_max3_u32 v88, v88, v89, v90
    v_max3_u32 v91, v91, v92, v93
    v_max3_u32 v88, v88, v94, v95
    v_max_u32 v88, v88, v91
    v_cmp_le_u32 vcc, 0x4980, v88
    v_mov_b32 v89, s28
    s_mov_b32 s16, 0x564000
    s_and_saveexec_b64 s[62:63], vcc
    buffer_store_dword v89, v132, s[8:11], s16 offen sc1
    s_mov_b64 exec, s[62:63]
adaLN_cond__sliding_block_cached__moe_arch_mod__prompt_kernel_kvS:
    s_waitcnt vmcnt(3)
    buffer_store_dwordx4 v[84:87], v2, s[8:11], s21 offen sc1
    s_lshr_b32 s16, s3, 2
    s_lshl_b32 s16, s16, 4
    s_add_u32 s16, s16, s31
    s_lshl_b32 s16, s16, 12
    s_and_b32 s17, s3, 3
    s_lshl_b32 s17, s17, 7
    s_add_u32 s16, s16, s17
    s_add_u32 s16, s16, 0x500000
    v_lshrrev_b32 v139, 3, v1
    v_lshlrev_b32 v139, 9, v139
    v_and_b32 v16, 7, v1
    v_lshl_add_u32 v139, v16, 4, v139
    v_and_b32 v140, 15, v1
    v_lshlrev_b32 v140, 4, v140
    s_lshl_b32 s17, s29, 8
    s_add_u32 s17, s17, 0x520000
    v_lshlrev_b32 v56, 16, v40
    v_and_b32 v57, 0xffff0000, v40
    v_lshlrev_b32 v58, 16, v41
    v_and_b32 v59, 0xffff0000, v41
    v_lshlrev_b32 v60, 16, v42
    v_and_b32 v61, 0xffff0000, v42
    v_lshlrev_b32 v62, 16, v43
    v_and_b32 v63, 0xffff0000, v43
    v_lshlrev_b32 v64, 16, v44
    v_and_b32 v65, 0xffff0000, v44
    v_lshlrev_b32 v66, 16, v45
    v_and_b32 v67, 0xffff0000, v45
    v_lshlrev_b32 v68, 16, v46
    v_and_b32 v69, 0xffff0000, v46
    v_lshlrev_b32 v70, 16, v47
    v_and_b32 v71, 0xffff0000, v47
    v_mov_b32 v135, 2097152
    v_mul_lo_u32 v135, v135, v1
    s_mov_b64 s[76:77], s[40:41]
    s_mov_b32 s78, 0x800000
    s_mov_b32 s79, 0x20000
    s_mov_b32 s62, 0x0
    s_cmp_eq_u32 s3, 4
    s_cselect_b32 s62, s62, 0x7ffffff0
    buffer_load_dword v136, v135, s[76:79], s62 offen
    s_mov_b64 s[76:77], s[46:47]
    s_mov_b32 s78, 0x700000
    s_mov_b32 s79, 0x20000
    s_mov_b32 s62, 0x0
    s_cmp_eq_u32 s3, 4
    s_cselect_b32 s62, s62, 0x7ffffff0
    buffer_load_dword v136, v135, s[76:79], s62 offen
    s_mov_b64 s[76:77], s[48:49]
    s_mov_b32 s78, 0x700000
    s_mov_b32 s79, 0x20000
    s_mov_b32 s62, 0x0
    s_cmp_eq_u32 s3, 5
    s_cselect_b32 s62, s62, 0x7ffffff0
    buffer_load_dword v136, v135, s[76:79], s62 offen
    s_mov_b64 s[76:77], s[50:51]
    s_mov_b32 s78, 0x700000
    s_mov_b32 s79, 0x20000
    s_mov_b32 s62, 0x0
    s_cmp_eq_u32 s3, 5
    s_cselect_b32 s62, s62, 0x7ffffff0
    buffer_load_dword v136, v135, s[76:79], s62 offen
    s_mov_b64 s[76:77], s[38:39]
    s_mov_b32 s78, 0x800000
    s_mov_b32 s79, 0x20000
    s_mov_b32 s62, 0x0
    s_cmp_eq_u32 s3, 6
    s_cselect_b32 s62, s62, 0x7ffffff0
    buffer_load_dword v136, v135, s[76:79], s62 offen
    s_mov_b64 s[76:77], s[56:57]
    s_mov_b32 s78, 0x400000
    s_mov_b32 s79, 0x20000
    s_mov_b32 s62, 0x0
    s_cmp_eq_u32 s3, 6
    s_cselect_b32 s62, s62, 0x7ffffff0
    buffer_load_dword v136, v135, s[76:79], s62 offen
    s_mov_b64 s[76:77], s[54:55]
    s_mov_b32 s78, 0xc00000
    s_mov_b32 s79, 0x20000
    s_mov_b32 s62, 0x0
    s_cmp_eq_u32 s3, 7
    s_cselect_b32 s62, s62, 0x7ffffff0
    buffer_load_dword v136, v135, s[76:79], s62 offen
    s_mov_b64 s[76:77], s[44:45]
    s_mov_b32 s78, 0x800
    s_mov_b32 s79, 0x20000
    s_mov_b32 s62, 0x0
    s_cmp_eq_u32 s3, 7
    s_cselect_b32 s62, s62, 0x7ffffff0
    buffer_load_dword v136, v135, s[76:79], s62 offen
    s_mov_b32 s27, 0
adaLN_cond__sliding_block_cached__moe_arch_mod__prompt_kernel_g14p:
    buffer_load_dwordx4 v[76:79], v139, s[8:11], s16 offen sc1
    buffer_load_dwordx4 v[80:83], v140, s[8:11], s17 offen sc1
    s_waitcnt vmcnt(1)
    v_cmp_ne_u32 vcc, s28, v78
    v_cmp_ne_u32 s[62:63], s28, v79
    s_or_b64 vcc, vcc, s[62:63]
    s_waitcnt vmcnt(0)
    v_cmp_ne_u32 s[62:63], s28, v83
    s_or_b64 vcc, vcc, s[62:63]
    s_add_u32 s27, s27, 1
    s_cmp_ge_u32 s27, 65536
    s_cbranch_scc1 adaLN_cond__sliding_block_cached__moe_arch_mod__prompt_kernel_g14g
    s_cbranch_vccnz adaLN_cond__sliding_block_cached__moe_arch_mod__prompt_kernel_g14p
adaLN_cond__sliding_block_cached__moe_arch_mod__prompt_kernel_g14g:
    v_add_f32_dpp v76, v76, v76 row_ror:8 row_mask:0xf bank_mask:0xf
    v_add_f32_dpp v77, v77, v77 row_ror:8 row_mask:0xf bank_mask:0xf
    v_mov_b32 v17, v76
    s_nop 1
    v_permlane16_swap_b32 v76, v17
    v_add_f32 v76, v76, v17
    v_mov_b32 v18, v77
    s_nop 1
    v_permlane16_swap_b32 v77, v18
    v_add_f32 v77, v77, v18
    v_mov_b32 v17, v76
    s_nop 1
    v_permlane32_swap_b32 v76, v17
    v_add_f32 v76, v76, v17
    v_mov_b32 v18, v77
    s_nop 1
    v_permlane32_swap_b32 v77, v18
    v_add_f32 v77, v77, v18
    v_cvt_pk_bf16_f32 v17, v76, v77
    v_lshlrev_b32 v76, 16, v17
    v_and_b32 v77, 0xffff0000, v17
    v_add_f32 v76, 1.0, v76
    v_add_f32 v77, 1.0, v77
    v_cvt_pk_bf16_f32 v17, v76, v77
    v_lshlrev_b32 v76, 16, v17
    v_and_b32 v77, 0xffff0000, v17
    s_lshl_b32 s16, s3, 6
    s_add_u32 s16, s16, 69632
    v_lshl_add_u32 v16, v16, 3, s16
    ds_write_b64 v16, v[76:77]
    v_lshrrev_b32 v17, 4, v1
    v_lshlrev_b32 v17, 5, v17
    v_add_u32 v17, 69632, v17
    v_sub_f32 v56, v56, v80
    v_sub_f32 v57, v57, v80
    v_sub_f32 v58, v58, v80
    v_sub_f32 v59, v59, v80
    v_sub_f32 v60, v60, v80
    v_sub_f32 v61, v61, v80
    v_sub_f32 v62, v62, v80
    v_sub_f32 v63, v63, v80
    v_sub_f32 v64, v64, v80
    v_sub_f32 v65, v65, v80
    v_sub_f32 v66, v66, v80
    v_sub_f32 v67, v67, v80
    v_sub_f32 v68, v68, v80
    v_sub_f32 v69, v69, v80
    v_sub_f32 v70, v70, v80
    v_sub_f32 v71, v71, v80
    v_cvt_pk_bf16_f32 v18, v56, v57
    v_lshlrev_b32 v56, 16, v18
    v_and_b32 v57, 0xffff0000, v18
    v_cvt_pk_bf16_f32 v19, v58, v59
    v_lshlrev_b32 v58, 16, v19
    v_and_b32 v59, 0xffff0000, v19
    v_cvt_pk_bf16_f32 v18, v60, v61
    v_lshlrev_b32 v60, 16, v18
    v_and_b32 v61, 0xffff0000, v18
    v_cvt_pk_bf16_f32 v19, v62, v63
    v_lshlrev_b32 v62, 16, v19
    v_and_b32 v63, 0xffff0000, v19
    v_cvt_pk_bf16_f32 v18, v64, v65
    v_lshlrev_b32 v64, 16, v18
    v_and_b32 v65, 0xffff0000, v18
    v_cvt_pk_bf16_f32 v19, v66, v67
    v_lshlrev_b32 v66, 16, v19
    v_and_b32 v67, 0xffff0000, v19
    v_cvt_pk_bf16_f32 v18, v68, v69
    v_lshlrev_b32 v68, 16, v18
    v_and_b32 v69, 0xffff0000, v18
    v_cvt_pk_bf16_f32 v19, v70, v71
    v_lshlrev_b32 v70, 16, v19
    v_and_b32 v71, 0xffff0000, v19
    v_mul_f32 v56, v56, v82
    v_mul_f32 v57, v57, v82
    v_mul_f32 v58, v58, v82
    v_mul_f32 v59, v59, v82
    v_mul_f32 v60, v60, v82
    v_mul_f32 v61, v61, v82
    v_mul_f32 v62, v62, v82
    v_mul_f32 v63, v63, v82
    v_mul_f32 v64, v64, v82
    v_mul_f32 v65, v65, v82
    v_mul_f32 v66, v66, v82
    v_mul_f32 v67, v67, v82
    v_mul_f32 v68, v68, v82
    v_mul_f32 v69, v69, v82
    v_mul_f32 v70, v70, v82
    v_mul_f32 v71, v71, v82
    v_cvt_pk_bf16_f32 v18, v56, v57
    v_lshlrev_b32 v56, 16, v18
    v_and_b32 v57, 0xffff0000, v18
    v_cvt_pk_bf16_f32 v19, v58, v59
    v_lshlrev_b32 v58, 16, v19
    v_and_b32 v59, 0xffff0000, v19
    v_cvt_pk_bf16_f32 v18, v60, v61
    v_lshlrev_b32 v60, 16, v18
    v_and_b32 v61, 0xffff0000, v18
    v_cvt_pk_bf16_f32 v19, v62, v63
    v_lshlrev_b32 v62, 16, v19
    v_and_b32 v63, 0xffff0000, v19
    v_cvt_pk_bf16_f32 v18, v64, v65
    v_lshlrev_b32 v64, 16, v18
    v_and_b32 v65, 0xffff0000, v18
    v_cvt_pk_bf16_f32 v19, v66, v67
    v_lshlrev_b32 v66, 16, v19
    v_and_b32 v67, 0xffff0000, v19
    v_cvt_pk_bf16_f32 v18, v68, v69
    v_lshlrev_b32 v68, 16, v18
    v_and_b32 v69, 0xffff0000, v18
    v_cvt_pk_bf16_f32 v19, v70, v71
    v_lshlrev_b32 v70, 16, v19
    v_and_b32 v71, 0xffff0000, v19
    s_lshl_b32 s16, s29, 15
    s_lshl_b32 s17, s31, 11
    s_add_u32 s16, s16, s17
    s_waitcnt lgkmcnt(0)
    s_barrier
    ds_read_b128 v[96:99], v17 offset:256
    ds_read_b128 v[104:107], v17 offset:0
    ds_read_b128 v[100:103], v17 offset:272
    ds_read_b128 v[108:111], v17 offset:16
    ds_read_b128 v[112:115], v17 offset:384
    ds_read_b128 v[120:123], v17 offset:128
    ds_read_b128 v[116:119], v17 offset:400
    ds_read_b128 v[124:127], v17 offset:144
    s_waitcnt lgkmcnt(7)
    v_pk_mul_f32 v[56:57], v[56:57], v[96:97]
    v_pk_mul_f32 v[58:59], v[58:59], v[98:99]
    s_waitcnt lgkmcnt(5)
    v_pk_mul_f32 v[60:61], v[60:61], v[100:101]
    v_pk_mul_f32 v[62:63], v[62:63], v[102:103]
    v_cvt_pk_bf16_f32 v18, v56, v57
    v_lshlrev_b32 v56, 16, v18
    v_and_b32 v57, 0xffff0000, v18
    v_cvt_pk_bf16_f32 v19, v58, v59
    v_lshlrev_b32 v58, 16, v19
    v_and_b32 v59, 0xffff0000, v19
    v_cvt_pk_bf16_f32 v18, v60, v61
    v_lshlrev_b32 v60, 16, v18
    v_and_b32 v61, 0xffff0000, v18
    v_cvt_pk_bf16_f32 v19, v62, v63
    v_lshlrev_b32 v62, 16, v19
    v_and_b32 v63, 0xffff0000, v19
    v_pk_add_f32 v[56:57], v[56:57], v[104:105]
    v_pk_add_f32 v[58:59], v[58:59], v[106:107]
    s_waitcnt lgkmcnt(4)
    v_pk_add_f32 v[60:61], v[60:61], v[108:109]
    v_pk_add_f32 v[62:63], v[62:63], v[110:111]
    v_cvt_pk_bf16_f32 v32, v56, v57
    v_cvt_pk_bf16_f32 v33, v58, v59
    v_cvt_pk_bf16_f32 v34, v60, v61
    v_cvt_pk_bf16_f32 v35, v62, v63
    buffer_store_dwordx4 v[32:35], v2, s[8:11], s16 offen offset:0 sc1
    s_waitcnt lgkmcnt(3)
    v_pk_mul_f32 v[64:65], v[64:65], v[112:113]
    v_pk_mul_f32 v[66:67], v[66:67], v[114:115]
    s_waitcnt lgkmcnt(1)
    v_pk_mul_f32 v[68:69], v[68:69], v[116:117]
    v_pk_mul_f32 v[70:71], v[70:71], v[118:119]
    v_cvt_pk_bf16_f32 v18, v64, v65
    v_lshlrev_b32 v64, 16, v18
    v_and_b32 v65, 0xffff0000, v18
    v_cvt_pk_bf16_f32 v19, v66, v67
    v_lshlrev_b32 v66, 16, v19
    v_and_b32 v67, 0xffff0000, v19
    v_cvt_pk_bf16_f32 v18, v68, v69
    v_lshlrev_b32 v68, 16, v18
    v_and_b32 v69, 0xffff0000, v18
    v_cvt_pk_bf16_f32 v19, v70, v71
    v_lshlrev_b32 v70, 16, v19
    v_and_b32 v71, 0xffff0000, v19
    v_pk_add_f32 v[64:65], v[64:65], v[120:121]
    v_pk_add_f32 v[66:67], v[66:67], v[122:123]
    s_waitcnt lgkmcnt(0)
    v_pk_add_f32 v[68:69], v[68:69], v[124:125]
    v_pk_add_f32 v[70:71], v[70:71], v[126:127]
    v_cvt_pk_bf16_f32 v36, v64, v65
    v_cvt_pk_bf16_f32 v37, v66, v67
    v_cvt_pk_bf16_f32 v38, v68, v69
    v_cvt_pk_bf16_f32 v39, v70, v71
    buffer_store_dwordx4 v[36:39], v2, s[8:11], s16 offen offset:1024 sc1
    s_lshl_b32 s19, s3, 16
    s_lshl_b32 s20, s3, 11
    s_lshl_b32 s16, s12, 8
    s_add_u32 s4, s38, s16
    s_addc_u32 s5, s39, 0
    s_sub_u32 s6, 0x800000, s16
    s_mov_b32 s7, 0x20000
    v_mov_b32 v134, s28
    s_lshl_b32 s16, s29, 4
    s_add_u32 s16, s16, s31
    s_lshl_b32 s16, s16, 2
    s_add_u32 s16, s16, 0x528000
    v_and_b32 v16, 31, v1
    v_lshlrev_b32 v16, 2, v16
    s_lshl_b32 s17, s13, 3
    s_add_u32 s17, s17, s3
    s_lshl_b32 s17, s17, 7
    s_add_u32 s17, s17, 0x528000
    s_waitcnt vmcnt(0)
    s_mov_b64 exec, 1
    buffer_store_dword v134, v132, s[8:11], s16 offen sc1
    s_mov_b64 exec, -1
    s_add_u32 s22, s19, 0x0
    s_add_u32 m0, s20, 0x0
    s_nop 0
    buffer_load_dwordx4 v3, s[4:7], s22 offen lds
    s_add_u32 s22, s19, 0x8000
    s_add_u32 m0, s20, 0x400
    s_nop 0
    buffer_load_dwordx4 v3, s[4:7], s22 offen lds
    s_add_u32 s22, s19, 0x80000
    s_add_u32 m0, s20, 0x4000
    s_nop 0
    buffer_load_dwordx4 v3, s[4:7], s22 offen lds
    s_add_u32 s22, s19, 0x88000
    s_add_u32 m0, s20, 0x4400
    s_nop 0
    buffer_load_dwordx4 v3, s[4:7], s22 offen lds
    s_add_u32 s22, s19, 0x100000
    s_add_u32 m0, s20, 0x8000
    s_nop 0
    buffer_load_dwordx4 v3, s[4:7], s22 offen lds
    s_add_u32 s22, s19, 0x108000
    s_add_u32 m0, s20, 0x8400
    s_nop 0
    buffer_load_dwordx4 v3, s[4:7], s22 offen lds
    s_sleep 40
    s_mov_b32 s27, 0
adaLN_cond__sliding_block_cached__moe_arch_mod__prompt_kernel_h15p:
    buffer_load_dword v17, v16, s[8:11], s17 offen sc1
    s_waitcnt vmcnt(0)
    v_cmp_ne_u32 vcc, s28, v17
    s_add_u32 s27, s27, 1
    s_cmp_ge_u32 s27, 65536
    s_cbranch_scc1 adaLN_cond__sliding_block_cached__moe_arch_mod__prompt_kernel_h15g
    s_cbranch_vccnz adaLN_cond__sliding_block_cached__moe_arch_mod__prompt_kernel_h15p
adaLN_cond__sliding_block_cached__moe_arch_mod__prompt_kernel_h15g:
    s_mov_b32 s23, 0x0
    buffer_load_dwordx4 v[88:91], v7, s[8:11], s23 offen offset:0 sc1
    s_mov_b32 s23, 0x8000
    buffer_load_dwordx4 v[92:95], v7, s[8:11], s23 offen offset:0 sc1
    s_mov_b32 s23, 0x0
    buffer_load_dwordx4 v[96:99], v7, s[8:11], s23 offen offset:1024 sc1
    s_mov_b32 s23, 0x8000
    buffer_load_dwordx4 v[100:103], v7, s[8:11], s23 offen offset:1024 sc1
    s_mov_b32 s23, 0x800
    buffer_load_dwordx4 v[104:107], v7, s[8:11], s23 offen offset:0 sc1
    s_mov_b32 s23, 0x8800
    buffer_load_dwordx4 v[108:111], v7, s[8:11], s23 offen offset:0 sc1
    s_mov_b32 s23, 0x800
    buffer_load_dwordx4 v[112:115], v7, s[8:11], s23 offen offset:1024 sc1
    s_mov_b32 s23, 0x8800
    buffer_load_dwordx4 v[116:119], v7, s[8:11], s23 offen offset:1024 sc1
    s_lshr_b32 s21, s12, 3
    s_lshl_b32 s21, s21, 17
    s_add_u32 s21, s21, s20
    s_add_u32 s21, s21, 0x400000
    s_barrier
    ds_read_b64_tr_b16 v[224:225], v4 offset:0
    ds_read_b64_tr_b16 v[226:227], v4 offset:1024
    ds_read_b64_tr_b16 v[228:229], v5 offset:32
    ds_read_b64_tr_b16 v[230:231], v5 offset:1056
    ds_read_b64_tr_b16 v[232:233], v4 offset:256
    ds_read_b64_tr_b16 v[234:235], v4 offset:1280
    ds_read_b64_tr_b16 v[236:237], v5 offset:288
    ds_read_b64_tr_b16 v[238:239], v5 offset:1312
    s_waitcnt vmcnt(7) lgkmcnt(6)
    v_mfma_f32_16x16x32_bf16 v[24:27], v[224:227], v[88:91], 0
    ds_read_b64_tr_b16 v[240:241], v4 offset:512
    s_waitcnt vmcnt(6)
    v_mfma_f32_16x16x32_bf16 v[28:31], v[224:227], v[92:95], 0
    ds_read_b64_tr_b16 v[242:243], v4 offset:1536
    s_waitcnt lgkmcnt(6)
    v_mfma_f32_16x16x32_bf16 v[32:35], v[228:231], v[88:91], 0
    ds_read_b64_tr_b16 v[244:245], v5 offset:544
    v_mfma_f32_16x16x32_bf16 v[36:39], v[228:231], v[92:95], 0
    ds_read_b64_tr_b16 v[246:247], v5 offset:1568
    s_mov_b32 s23, 0x1000
    buffer_load_dwordx4 v[120:123], v7, s[8:11], s23 offen offset:0 sc1
    s_waitcnt lgkmcnt(6)
    v_mfma_f32_16x16x32_bf16 v[40:43], v[232:235], v[88:91], 0
    ds_read_b64_tr_b16 v[224:225], v4 offset:768
    v_mfma_f32_16x16x32_bf16 v[44:47], v[232:235], v[92:95], 0
    ds_read_b64_tr_b16 v[226:227], v4 offset:1792
    s_waitcnt lgkmcnt(6)
    v_mfma_f32_16x16x32_bf16 v[48:51], v[236:239], v[88:91], 0
    ds_read_b64_tr_b16 v[228:229], v5 offset:800
    v_mfma_f32_16x16x32_bf16 v[52:55], v[236:239], v[92:95], 0
    ds_read_b64_tr_b16 v[230:231], v5 offset:1824
    s_waitcnt lgkmcnt(6)
    v_mfma_f32_16x16x32_bf16 v[56:59], v[240:243], v[88:91], 0
    ds_read_b64_tr_b16 v[232:233], v4 offset:8192
    v_mfma_f32_16x16x32_bf16 v[60:63], v[240:243], v[92:95], 0
    ds_read_b64_tr_b16 v[234:235], v4 offset:9216
    s_waitcnt lgkmcnt(6)
    v_mfma_f32_16x16x32_bf16 v[64:67], v[244:247], v[88:91], 0
    ds_read_b64_tr_b16 v[236:237], v5 offset:8224
    v_mfma_f32_16x16x32_bf16 v[68:71], v[244:247], v[92:95], 0
    ds_read_b64_tr_b16 v[238:239], v5 offset:9248
    s_mov_b32 s23, 0x9000
    buffer_load_dwordx4 v[124:127], v7, s[8:11], s23 offen offset:0 sc1
    s_waitcnt lgkmcnt(6)
    v_mfma_f32_16x16x32_bf16 v[72:75], v[224:227], v[88:91], 0
    ds_read_b64_tr_b16 v[240:241], v4 offset:8448
    v_mfma_f32_16x16x32_bf16 v[76:79], v[224:227], v[92:95], 0
    ds_read_b64_tr_b16 v[242:243], v4 offset:9472
    s_waitcnt lgkmcnt(6)
    v_mfma_f32_16x16x32_bf16 v[80:83], v[228:231], v[88:91], 0
    ds_read_b64_tr_b16 v[244:245], v5 offset:8480
    v_mfma_f32_16x16x32_bf16 v[84:87], v[228:231], v[92:95], 0
    ds_read_b64_tr_b16 v[246:247], v5 offset:9504
    s_waitcnt vmcnt(7) lgkmcnt(6)
    v_mfma_f32_16x16x32_bf16 v[24:27], v[232:235], v[96:99], v[24:27]
    ds_read_b64_tr_b16 v[224:225], v4 offset:8704
    s_waitcnt vmcnt(6)
    v_mfma_f32_16x16x32_bf16 v[28:31], v[232:235], v[100:103], v[28:31]
    ds_read_b64_tr_b16 v[226:227], v4 offset:9728
    s_waitcnt lgkmcnt(6)
    v_mfma_f32_16x16x32_bf16 v[32:35], v[236:239], v[96:99], v[32:35]
    ds_read_b64_tr_b16 v[228:229], v5 offset:8736
    v_mfma_f32_16x16x32_bf16 v[36:39], v[236:239], v[100:103], v[36:39]
    ds_read_b64_tr_b16 v[230:231], v5 offset:9760
    s_mov_b32 s23, 0x1000
    buffer_load_dwordx4 v[128:131], v7, s[8:11], s23 offen offset:1024 sc1
    s_waitcnt lgkmcnt(6)
    v_mfma_f32_16x16x32_bf16 v[40:43], v[240:243], v[96:99], v[40:43]
    ds_read_b64_tr_b16 v[232:233], v4 offset:8960
    v_mfma_f32_16x16x32_bf16 v[44:47], v[240:243], v[100:103], v[44:47]
    ds_read_b64_tr_b16 v[234:235], v4 offset:9984
    s_waitcnt lgkmcnt(6)
    v_mfma_f32_16x16x32_bf16 v[48:51], v[244:247], v[96:99], v[48:51]
    ds_read_b64_tr_b16 v[236:237], v5 offset:8992
    v_mfma_f32_16x16x32_bf16 v[52:55], v[244:247], v[100:103], v[52:55]
    ds_read_b64_tr_b16 v[238:239], v5 offset:10016
    s_waitcnt lgkmcnt(6)
    v_mfma_f32_16x16x32_bf16 v[56:59], v[224:227], v[96:99], v[56:59]
    v_mfma_f32_16x16x32_bf16 v[60:63], v[224:227], v[100:103], v[60:63]
    s_barrier
    ds_read_b64_tr_b16 v[240:241], v4 offset:16384
    ds_read_b64_tr_b16 v[242:243], v4 offset:17408
    s_waitcnt lgkmcnt(6)
    v_mfma_f32_16x16x32_bf16 v[64:67], v[228:231], v[96:99], v[64:67]
    ds_read_b64_tr_b16 v[244:245], v5 offset:16416
    v_mfma_f32_16x16x32_bf16 v[68:71], v[228:231], v[100:103], v[68:71]
    s_add_u32 s22, s19, 0x180000
    s_add_u32 m0, s20, 0xc000
    s_nop 0
    buffer_load_dwordx4 v3, s[4:7], s22 offen lds
    ds_read_b64_tr_b16 v[246:247], v5 offset:17440
    s_mov_b32 s23, 0x9000
    buffer_load_dwordx4 v[132:135], v7, s[8:11], s23 offen offset:1024 sc1
    s_waitcnt lgkmcnt(6)
    v_mfma_f32_16x16x32_bf16 v[72:75], v[232:235], v[96:99], v[72:75]
    ds_read_b64_tr_b16 v[224:225], v4 offset:16640
    v_mfma_f32_16x16x32_bf16 v[76:79], v[232:235], v[100:103], v[76:79]
    ds_read_b64_tr_b16 v[226:227], v4 offset:17664
    s_waitcnt lgkmcnt(6)
    v_mfma_f32_16x16x32_bf16 v[80:83], v[236:239], v[96:99], v[80:83]
    ds_read_b64_tr_b16 v[228:229], v5 offset:16672
    v_mfma_f32_16x16x32_bf16 v[84:87], v[236:239], v[100:103], v[84:87]
    ds_read_b64_tr_b16 v[230:231], v5 offset:17696
    s_waitcnt vmcnt(8) lgkmcnt(6)
    v_mfma_f32_16x16x32_bf16 v[24:27], v[240:243], v[104:107], v[24:27]
    ds_read_b64_tr_b16 v[232:233], v4 offset:16896
    s_waitcnt vmcnt(7)
    v_mfma_f32_16x16x32_bf16 v[28:31], v[240:243], v[108:111], v[28:31]
    ds_read_b64_tr_b16 v[234:235], v4 offset:17920
    s_waitcnt lgkmcnt(6)
    v_mfma_f32_16x16x32_bf16 v[32:35], v[244:247], v[104:107], v[32:35]
    ds_read_b64_tr_b16 v[236:237], v5 offset:16928
    v_mfma_f32_16x16x32_bf16 v[36:39], v[244:247], v[108:111], v[36:39]
    s_add_u32 s22, s19, 0x188000
    s_add_u32 m0, s20, 0xc400
    s_nop 0
    buffer_load_dwordx4 v3, s[4:7], s22 offen lds
    ds_read_b64_tr_b16 v[238:239], v5 offset:17952
    s_mov_b32 s23, 0x1800
    buffer_load_dwordx4 v[88:91], v7, s[8:11], s23 offen offset:0 sc1
    s_waitcnt lgkmcnt(6)
    v_mfma_f32_16x16x32_bf16 v[40:43], v[224:227], v[104:107], v[40:43]
    ds_read_b64_tr_b16 v[240:241], v4 offset:17152
    v_mfma_f32_16x16x32_bf16 v[44:47], v[224:227], v[108:111], v[44:47]
    ds_read_b64_tr_b16 v[242:243], v4 offset:18176
    s_waitcnt lgkmcnt(6)
    v_mfma_f32_16x16x32_bf16 v[48:51], v[228:231], v[104:107], v[48:51]
    ds_read_b64_tr_b16 v[244:245], v5 offset:17184
    v_mfma_f32_16x16x32_bf16 v[52:55], v[228:231], v[108:111], v[52:55]
    ds_read_b64_tr_b16 v[246:247], v5 offset:18208
    s_waitcnt lgkmcnt(6)
    v_mfma_f32_16x16x32_bf16 v[56:59], v[232:235], v[104:107], v[56:59]
    ds_read_b64_tr_b16 v[224:225], v4 offset:24576
    v_mfma_f32_16x16x32_bf16 v[60:63], v[232:235], v[108:111], v[60:63]
    ds_read_b64_tr_b16 v[226:227], v4 offset:25600
    s_waitcnt lgkmcnt(6)
    v_mfma_f32_16x16x32_bf16 v[64:67], v[236:239], v[104:107], v[64:67]
    ds_read_b64_tr_b16 v[228:229], v5 offset:24608
    v_mfma_f32_16x16x32_bf16 v[68:71], v[236:239], v[108:111], v[68:71]
    ds_read_b64_tr_b16 v[230:231], v5 offset:25632
    s_mov_b32 s23, 0x9800
    buffer_load_dwordx4 v[92:95], v7, s[8:11], s23 offen offset:0 sc1
    s_waitcnt lgkmcnt(6)
    v_mfma_f32_16x16x32_bf16 v[72:75], v[240:243], v[104:107], v[72:75]
    ds_read_b64_tr_b16 v[232:233], v4 offset:24832
    v_mfma_f32_16x16x32_bf16 v[76:79], v[240:243], v[108:111], v[76:79]
    ds_read_b64_tr_b16 v[234:235], v4 offset:25856
    s_waitcnt lgkmcnt(6)
    v_mfma_f32_16x16x32_bf16 v[80:83], v[244:247], v[104:107], v[80:83]
    ds_read_b64_tr_b16 v[236:237], v5 offset:24864
    v_mfma_f32_16x16x32_bf16 v[84:87], v[244:247], v[108:111], v[84:87]
    ds_read_b64_tr_b16 v[238:239], v5 offset:25888
    s_waitcnt vmcnt(9) lgkmcnt(6)
    v_mfma_f32_16x16x32_bf16 v[24:27], v[224:227], v[112:115], v[24:27]
    ds_read_b64_tr_b16 v[240:241], v4 offset:25088
    s_waitcnt vmcnt(8)
    v_mfma_f32_16x16x32_bf16 v[28:31], v[224:227], v[116:119], v[28:31]
    ds_read_b64_tr_b16 v[242:243], v4 offset:26112
    s_waitcnt lgkmcnt(6)
    v_mfma_f32_16x16x32_bf16 v[32:35], v[228:231], v[112:115], v[32:35]
    ds_read_b64_tr_b16 v[244:245], v5 offset:25120
    v_mfma_f32_16x16x32_bf16 v[36:39], v[228:231], v[116:119], v[36:39]
    ds_read_b64_tr_b16 v[246:247], v5 offset:26144
    s_mov_b32 s23, 0x1800
    buffer_load_dwordx4 v[96:99], v7, s[8:11], s23 offen offset:1024 sc1
    s_waitcnt lgkmcnt(6)
    v_mfma_f32_16x16x32_bf16 v[40:43], v[232:235], v[112:115], v[40:43]
    ds_read_b64_tr_b16 v[224:225], v4 offset:25344
    v_mfma_f32_16x16x32_bf16 v[44:47], v[232:235], v[116:119], v[44:47]
    ds_read_b64_tr_b16 v[226:227], v4 offset:26368
    s_waitcnt lgkmcnt(6)
    v_mfma_f32_16x16x32_bf16 v[48:51], v[236:239], v[112:115], v[48:51]
    ds_read_b64_tr_b16 v[228:229], v5 offset:25376
    v_mfma_f32_16x16x32_bf16 v[52:55], v[236:239], v[116:119], v[52:55]
    ds_read_b64_tr_b16 v[230:231], v5 offset:26400
    s_waitcnt lgkmcnt(6)
    v_mfma_f32_16x16x32_bf16 v[56:59], v[240:243], v[112:115], v[56:59]
    v_mfma_f32_16x16x32_bf16 v[60:63], v[240:243], v[116:119], v[60:63]
    s_barrier
    ds_read_b64_tr_b16 v[232:233], v4 offset:32768
    ds_read_b64_tr_b16 v[234:235], v4 offset:33792
    s_waitcnt lgkmcnt(6)
    v_mfma_f32_16x16x32_bf16 v[64:67], v[244:247], v[112:115], v[64:67]
    ds_read_b64_tr_b16 v[236:237], v5 offset:32800
    v_mfma_f32_16x16x32_bf16 v[68:71], v[244:247], v[116:119], v[68:71]
    s_add_u32 s22, s19, 0x200000
    s_add_u32 m0, s20, 0x0
    s_nop 0
    buffer_load_dwordx4 v3, s[4:7], s22 offen lds
    ds_read_b64_tr_b16 v[238:239], v5 offset:33824
    s_mov_b32 s23, 0x9800
    buffer_load_dwordx4 v[100:103], v7, s[8:11], s23 offen offset:1024 sc1
    s_waitcnt lgkmcnt(6)
    v_mfma_f32_16x16x32_bf16 v[72:75], v[224:227], v[112:115], v[72:75]
    ds_read_b64_tr_b16 v[240:241], v4 offset:33024
    v_mfma_f32_16x16x32_bf16 v[76:79], v[224:227], v[116:119], v[76:79]
    ds_read_b64_tr_b16 v[242:243], v4 offset:34048
    s_waitcnt lgkmcnt(6)
    v_mfma_f32_16x16x32_bf16 v[80:83], v[228:231], v[112:115], v[80:83]
    ds_read_b64_tr_b16 v[244:245], v5 offset:33056
    v_mfma_f32_16x16x32_bf16 v[84:87], v[228:231], v[116:119], v[84:87]
    ds_read_b64_tr_b16 v[246:247], v5 offset:34080
    s_waitcnt vmcnt(10) lgkmcnt(6)
    v_mfma_f32_16x16x32_bf16 v[24:27], v[232:235], v[120:123], v[24:27]
    ds_read_b64_tr_b16 v[224:225], v4 offset:33280
    s_waitcnt vmcnt(9)
    v_mfma_f32_16x16x32_bf16 v[28:31], v[232:235], v[124:127], v[28:31]
    ds_read_b64_tr_b16 v[226:227], v4 offset:34304
    s_waitcnt lgkmcnt(6)
    v_mfma_f32_16x16x32_bf16 v[32:35], v[236:239], v[120:123], v[32:35]
    ds_read_b64_tr_b16 v[228:229], v5 offset:33312
    v_mfma_f32_16x16x32_bf16 v[36:39], v[236:239], v[124:127], v[36:39]
    s_add_u32 s22, s19, 0x208000
    s_add_u32 m0, s20, 0x400
    s_nop 0
    buffer_load_dwordx4 v3, s[4:7], s22 offen lds
    ds_read_b64_tr_b16 v[230:231], v5 offset:34336
    s_mov_b32 s23, 0x2000
    buffer_load_dwordx4 v[104:107], v7, s[8:11], s23 offen offset:0 sc1
    s_waitcnt lgkmcnt(6)
    v_mfma_f32_16x16x32_bf16 v[40:43], v[240:243], v[120:123], v[40:43]
    ds_read_b64_tr_b16 v[232:233], v4 offset:33536
    v_mfma_f32_16x16x32_bf16 v[44:47], v[240:243], v[124:127], v[44:47]
    ds_read_b64_tr_b16 v[234:235], v4 offset:34560
    s_waitcnt lgkmcnt(6)
    v_mfma_f32_16x16x32_bf16 v[48:51], v[244:247], v[120:123], v[48:51]
    ds_read_b64_tr_b16 v[236:237], v5 offset:33568
    v_mfma_f32_16x16x32_bf16 v[52:55], v[244:247], v[124:127], v[52:55]
    ds_read_b64_tr_b16 v[238:239], v5 offset:34592
    s_waitcnt lgkmcnt(6)
    v_mfma_f32_16x16x32_bf16 v[56:59], v[224:227], v[120:123], v[56:59]
    ds_read_b64_tr_b16 v[240:241], v4 offset:40960
    v_mfma_f32_16x16x32_bf16 v[60:63], v[224:227], v[124:127], v[60:63]
    ds_read_b64_tr_b16 v[242:243], v4 offset:41984
    s_waitcnt lgkmcnt(6)
    v_mfma_f32_16x16x32_bf16 v[64:67], v[228:231], v[120:123], v[64:67]
    ds_read_b64_tr_b16 v[244:245], v5 offset:40992
    v_mfma_f32_16x16x32_bf16 v[68:71], v[228:231], v[124:127], v[68:71]
    ds_read_b64_tr_b16 v[246:247], v5 offset:42016
    s_mov_b32 s23, 0xa000
    buffer_load_dwordx4 v[108:111], v7, s[8:11], s23 offen offset:0 sc1
    s_waitcnt lgkmcnt(6)
    v_mfma_f32_16x16x32_bf16 v[72:75], v[232:235], v[120:123], v[72:75]
    ds_read_b64_tr_b16 v[224:225], v4 offset:41216
    v_mfma_f32_16x16x32_bf16 v[76:79], v[232:235], v[124:127], v[76:79]
    ds_read_b64_tr_b16 v[226:227], v4 offset:42240
    s_waitcnt lgkmcnt(6)
    v_mfma_f32_16x16x32_bf16 v[80:83], v[236:239], v[120:123], v[80:83]
    ds_read_b64_tr_b16 v[228:229], v5 offset:41248
    v_mfma_f32_16x16x32_bf16 v[84:87], v[236:239], v[124:127], v[84:87]
    ds_read_b64_tr_b16 v[230:231], v5 offset:42272
    s_waitcnt vmcnt(11) lgkmcnt(6)
    v_mfma_f32_16x16x32_bf16 v[24:27], v[240:243], v[128:131], v[24:27]
    ds_read_b64_tr_b16 v[232:233], v4 offset:41472
    s_waitcnt vmcnt(9)
    v_mfma_f32_16x16x32_bf16 v[28:31], v[240:243], v[132:135], v[28:31]
    ds_read_b64_tr_b16 v[234:235], v4 offset:42496
    s_waitcnt lgkmcnt(6)
    v_mfma_f32_16x16x32_bf16 v[32:35], v[244:247], v[128:131], v[32:35]
    ds_read_b64_tr_b16 v[236:237], v5 offset:41504
    v_mfma_f32_16x16x32_bf16 v[36:39], v[244:247], v[132:135], v[36:39]
    ds_read_b64_tr_b16 v[238:239], v5 offset:42528
    s_mov_b32 s23, 0x2000
    buffer_load_dwordx4 v[112:115], v7, s[8:11], s23 offen offset:1024 sc1
    s_waitcnt lgkmcnt(6)
    v_mfma_f32_16x16x32_bf16 v[40:43], v[224:227], v[128:131], v[40:43]
    ds_read_b64_tr_b16 v[240:241], v4 offset:41728
    v_mfma_f32_16x16x32_bf16 v[44:47], v[224:227], v[132:135], v[44:47]
    ds_read_b64_tr_b16 v[242:243], v4 offset:42752
    s_waitcnt lgkmcnt(6)
    v_mfma_f32_16x16x32_bf16 v[48:51], v[228:231], v[128:131], v[48:51]
    ds_read_b64_tr_b16 v[244:245], v5 offset:41760
    v_mfma_f32_16x16x32_bf16 v[52:55], v[228:231], v[132:135], v[52:55]
    ds_read_b64_tr_b16 v[246:247], v5 offset:42784
    s_waitcnt lgkmcnt(6)
    v_mfma_f32_16x16x32_bf16 v[56:59], v[232:235], v[128:131], v[56:59]
    v_mfma_f32_16x16x32_bf16 v[60:63], v[232:235], v[132:135], v[60:63]
    s_waitcnt vmcnt(9)
    s_barrier
    ds_read_b64_tr_b16 v[224:225], v4 offset:49152
    ds_read_b64_tr_b16 v[226:227], v4 offset:50176
    s_waitcnt lgkmcnt(6)
    v_mfma_f32_16x16x32_bf16 v[64:67], v[236:239], v[128:131], v[64:67]
    ds_read_b64_tr_b16 v[228:229], v5 offset:49184
    v_mfma_f32_16x16x32_bf16 v[68:71], v[236:239], v[132:135], v[68:71]
    s_add_u32 s22, s19, 0x280000
    s_add_u32 m0, s20, 0x4000
    s_nop 0
    buffer_load_dwordx4 v3, s[4:7], s22 offen lds
    ds_read_b64_tr_b16 v[230:231], v5 offset:50208
    s_mov_b32 s23, 0xa000
    buffer_load_dwordx4 v[116:119], v7, s[8:11], s23 offen offset:1024 sc1
    s_waitcnt lgkmcnt(6)
    v_mfma_f32_16x16x32_bf16 v[72:75], v[240:243], v[128:131], v[72:75]
    ds_read_b64_tr_b16 v[232:233], v4 offset:49408
    v_mfma_f32_16x16x32_bf16 v[76:79], v[240:243], v[132:135], v[76:79]
    ds_read_b64_tr_b16 v[234:235], v4 offset:50432
    s_waitcnt lgkmcnt(6)
    v_mfma_f32_16x16x32_bf16 v[80:83], v[244:247], v[128:131], v[80:83]
    ds_read_b64_tr_b16 v[236:237], v5 offset:49440
    v_mfma_f32_16x16x32_bf16 v[84:87], v[244:247], v[132:135], v[84:87]
    ds_read_b64_tr_b16 v[238:239], v5 offset:50464
    s_waitcnt vmcnt(10) lgkmcnt(6)
    v_mfma_f32_16x16x32_bf16 v[24:27], v[224:227], v[88:91], v[24:27]
    ds_read_b64_tr_b16 v[240:241], v4 offset:49664
    s_waitcnt vmcnt(9)
    v_mfma_f32_16x16x32_bf16 v[28:31], v[224:227], v[92:95], v[28:31]
    ds_read_b64_tr_b16 v[242:243], v4 offset:50688
    s_waitcnt lgkmcnt(6)
    v_mfma_f32_16x16x32_bf16 v[32:35], v[228:231], v[88:91], v[32:35]
    ds_read_b64_tr_b16 v[244:245], v5 offset:49696
    v_mfma_f32_16x16x32_bf16 v[36:39], v[228:231], v[92:95], v[36:39]
    s_add_u32 s22, s19, 0x288000
    s_add_u32 m0, s20, 0x4400
    s_nop 0
    buffer_load_dwordx4 v3, s[4:7], s22 offen lds
    ds_read_b64_tr_b16 v[246:247], v5 offset:50720
    s_mov_b32 s23, 0x2800
    buffer_load_dwordx4 v[120:123], v7, s[8:11], s23 offen offset:0 sc1
    s_waitcnt lgkmcnt(6)
    v_mfma_f32_16x16x32_bf16 v[40:43], v[232:235], v[88:91], v[40:43]
    ds_read_b64_tr_b16 v[224:225], v4 offset:49920
    v_mfma_f32_16x16x32_bf16 v[44:47], v[232:235], v[92:95], v[44:47]
    ds_read_b64_tr_b16 v[226:227], v4 offset:50944
    s_waitcnt lgkmcnt(6)
    v_mfma_f32_16x16x32_bf16 v[48:51], v[236:239], v[88:91], v[48:51]
    ds_read_b64_tr_b16 v[228:229], v5 offset:49952
    v_mfma_f32_16x16x32_bf16 v[52:55], v[236:239], v[92:95], v[52:55]
    ds_read_b64_tr_b16 v[230:231], v5 offset:50976
    s_waitcnt lgkmcnt(6)
    v_mfma_f32_16x16x32_bf16 v[56:59], v[240:243], v[88:91], v[56:59]
    ds_read_b64_tr_b16 v[232:233], v4 offset:57344
    v_mfma_f32_16x16x32_bf16 v[60:63], v[240:243], v[92:95], v[60:63]
    ds_read_b64_tr_b16 v[234:235], v4 offset:58368
    s_waitcnt lgkmcnt(6)
    v_mfma_f32_16x16x32_bf16 v[64:67], v[244:247], v[88:91], v[64:67]
    ds_read_b64_tr_b16 v[236:237], v5 offset:57376
    v_mfma_f32_16x16x32_bf16 v[68:71], v[244:247], v[92:95], v[68:71]
    ds_read_b64_tr_b16 v[238:239], v5 offset:58400
    s_mov_b32 s23, 0xa800
    buffer_load_dwordx4 v[124:127], v7, s[8:11], s23 offen offset:0 sc1
    s_waitcnt lgkmcnt(6)
    v_mfma_f32_16x16x32_bf16 v[72:75], v[224:227], v[88:91], v[72:75]
    ds_read_b64_tr_b16 v[240:241], v4 offset:57600
    v_mfma_f32_16x16x32_bf16 v[76:79], v[224:227], v[92:95], v[76:79]
    ds_read_b64_tr_b16 v[242:243], v4 offset:58624
    s_waitcnt lgkmcnt(6)
    v_mfma_f32_16x16x32_bf16 v[80:83], v[228:231], v[88:91], v[80:83]
    ds_read_b64_tr_b16 v[244:245], v5 offset:57632
    v_mfma_f32_16x16x32_bf16 v[84:87], v[228:231], v[92:95], v[84:87]
    ds_read_b64_tr_b16 v[246:247], v5 offset:58656
    s_waitcnt vmcnt(11) lgkmcnt(6)
    v_mfma_f32_16x16x32_bf16 v[24:27], v[232:235], v[96:99], v[24:27]
    ds_read_b64_tr_b16 v[224:225], v4 offset:57856
    s_waitcnt vmcnt(9)
    v_mfma_f32_16x16x32_bf16 v[28:31], v[232:235], v[100:103], v[28:31]
    ds_read_b64_tr_b16 v[226:227], v4 offset:58880
    s_waitcnt lgkmcnt(6)
    v_mfma_f32_16x16x32_bf16 v[32:35], v[236:239], v[96:99], v[32:35]
    ds_read_b64_tr_b16 v[228:229], v5 offset:57888
    v_mfma_f32_16x16x32_bf16 v[36:39], v[236:239], v[100:103], v[36:39]
    ds_read_b64_tr_b16 v[230:231], v5 offset:58912
    s_mov_b32 s23, 0x2800
    buffer_load_dwordx4 v[128:131], v7, s[8:11], s23 offen offset:1024 sc1
    s_waitcnt lgkmcnt(6)
    v_mfma_f32_16x16x32_bf16 v[40:43], v[240:243], v[96:99], v[40:43]
    ds_read_b64_tr_b16 v[232:233], v4 offset:58112
    v_mfma_f32_16x16x32_bf16 v[44:47], v[240:243], v[100:103], v[44:47]
    ds_read_b64_tr_b16 v[234:235], v4 offset:59136
    s_waitcnt lgkmcnt(6)
    v_mfma_f32_16x16x32_bf16 v[48:51], v[244:247], v[96:99], v[48:51]
    ds_read_b64_tr_b16 v[236:237], v5 offset:58144
    v_mfma_f32_16x16x32_bf16 v[52:55], v[244:247], v[100:103], v[52:55]
    ds_read_b64_tr_b16 v[238:239], v5 offset:59168
    s_waitcnt lgkmcnt(6)
    v_mfma_f32_16x16x32_bf16 v[56:59], v[224:227], v[96:99], v[56:59]
    v_mfma_f32_16x16x32_bf16 v[60:63], v[224:227], v[100:103], v[60:63]
    s_waitcnt vmcnt(9)
    s_barrier
    ds_read_b64_tr_b16 v[240:241], v4 offset:0
    ds_read_b64_tr_b16 v[242:243], v4 offset:1024
    s_waitcnt lgkmcnt(6)
    v_mfma_f32_16x16x32_bf16 v[64:67], v[228:231], v[96:99], v[64:67]
    ds_read_b64_tr_b16 v[244:245], v5 offset:32
    v_mfma_f32_16x16x32_bf16 v[68:71], v[228:231], v[100:103], v[68:71]
    s_add_u32 s22, s19, 0x300000
    s_add_u32 m0, s20, 0x8000
    s_nop 0
    buffer_load_dwordx4 v3, s[4:7], s22 offen lds
    ds_read_b64_tr_b16 v[246:247], v5 offset:1056
    s_mov_b32 s23, 0xa800
    buffer_load_dwordx4 v[132:135], v7, s[8:11], s23 offen offset:1024 sc1
    s_waitcnt lgkmcnt(6)
    v_mfma_f32_16x16x32_bf16 v[72:75], v[232:235], v[96:99], v[72:75]
    ds_read_b64_tr_b16 v[224:225], v4 offset:256
    v_mfma_f32_16x16x32_bf16 v[76:79], v[232:235], v[100:103], v[76:79]
    ds_read_b64_tr_b16 v[226:227], v4 offset:1280
    s_waitcnt lgkmcnt(6)
    v_mfma_f32_16x16x32_bf16 v[80:83], v[236:239], v[96:99], v[80:83]
    ds_read_b64_tr_b16 v[228:229], v5 offset:288
    v_mfma_f32_16x16x32_bf16 v[84:87], v[236:239], v[100:103], v[84:87]
    ds_read_b64_tr_b16 v[230:231], v5 offset:1312
    s_waitcnt vmcnt(10) lgkmcnt(6)
    v_mfma_f32_16x16x32_bf16 v[24:27], v[240:243], v[104:107], v[24:27]
    ds_read_b64_tr_b16 v[232:233], v4 offset:512
    s_waitcnt vmcnt(9)
    v_mfma_f32_16x16x32_bf16 v[28:31], v[240:243], v[108:111], v[28:31]
    ds_read_b64_tr_b16 v[234:235], v4 offset:1536
    s_waitcnt lgkmcnt(6)
    v_mfma_f32_16x16x32_bf16 v[32:35], v[244:247], v[104:107], v[32:35]
    ds_read_b64_tr_b16 v[236:237], v5 offset:544
    v_mfma_f32_16x16x32_bf16 v[36:39], v[244:247], v[108:111], v[36:39]
    s_add_u32 s22, s19, 0x308000
    s_add_u32 m0, s20, 0x8400
    s_nop 0
    buffer_load_dwordx4 v3, s[4:7], s22 offen lds
    ds_read_b64_tr_b16 v[238:239], v5 offset:1568
    s_mov_b32 s23, 0x3000
    buffer_load_dwordx4 v[88:91], v7, s[8:11], s23 offen offset:0 sc1
    s_waitcnt lgkmcnt(6)
    v_mfma_f32_16x16x32_bf16 v[40:43], v[224:227], v[104:107], v[40:43]
    ds_read_b64_tr_b16 v[240:241], v4 offset:768
    v_mfma_f32_16x16x32_bf16 v[44:47], v[224:227], v[108:111], v[44:47]
    ds_read_b64_tr_b16 v[242:243], v4 offset:1792
    s_waitcnt lgkmcnt(6)
    v_mfma_f32_16x16x32_bf16 v[48:51], v[228:231], v[104:107], v[48:51]
    ds_read_b64_tr_b16 v[244:245], v5 offset:800
    v_mfma_f32_16x16x32_bf16 v[52:55], v[228:231], v[108:111], v[52:55]
    ds_read_b64_tr_b16 v[246:247], v5 offset:1824
    s_waitcnt lgkmcnt(6)
    v_mfma_f32_16x16x32_bf16 v[56:59], v[232:235], v[104:107], v[56:59]
    ds_read_b64_tr_b16 v[224:225], v4 offset:8192
    v_mfma_f32_16x16x32_bf16 v[60:63], v[232:235], v[108:111], v[60:63]
    ds_read_b64_tr_b16 v[226:227], v4 offset:9216
    s_waitcnt lgkmcnt(6)
    v_mfma_f32_16x16x32_bf16 v[64:67], v[236:239], v[104:107], v[64:67]
    ds_read_b64_tr_b16 v[228:229], v5 offset:8224
    v_mfma_f32_16x16x32_bf16 v[68:71], v[236:239], v[108:111], v[68:71]
    ds_read_b64_tr_b16 v[230:231], v5 offset:9248
    s_mov_b32 s23, 0xb000
    buffer_load_dwordx4 v[92:95], v7, s[8:11], s23 offen offset:0 sc1
    s_waitcnt lgkmcnt(6)
    v_mfma_f32_16x16x32_bf16 v[72:75], v[240:243], v[104:107], v[72:75]
    ds_read_b64_tr_b16 v[232:233], v4 offset:8448
    v_mfma_f32_16x16x32_bf16 v[76:79], v[240:243], v[108:111], v[76:79]
    ds_read_b64_tr_b16 v[234:235], v4 offset:9472
    s_waitcnt lgkmcnt(6)
    v_mfma_f32_16x16x32_bf16 v[80:83], v[244:247], v[104:107], v[80:83]
    ds_read_b64_tr_b16 v[236:237], v5 offset:8480
    v_mfma_f32_16x16x32_bf16 v[84:87], v[244:247], v[108:111], v[84:87]
    ds_read_b64_tr_b16 v[238:239], v5 offset:9504
    s_waitcnt vmcnt(11) lgkmcnt(6)
    v_mfma_f32_16x16x32_bf16 v[24:27], v[224:227], v[112:115], v[24:27]
    ds_read_b64_tr_b16 v[240:241], v4 offset:8704
    s_waitcnt vmcnt(9)
    v_mfma_f32_16x16x32_bf16 v[28:31], v[224:227], v[116:119], v[28:31]
    ds_read_b64_tr_b16 v[242:243], v4 offset:9728
    s_waitcnt lgkmcnt(6)
    v_mfma_f32_16x16x32_bf16 v[32:35], v[228:231], v[112:115], v[32:35]
    ds_read_b64_tr_b16 v[244:245], v5 offset:8736
    v_mfma_f32_16x16x32_bf16 v[36:39], v[228:231], v[116:119], v[36:39]
    ds_read_b64_tr_b16 v[246:247], v5 offset:9760
    s_mov_b32 s23, 0x3000
    buffer_load_dwordx4 v[96:99], v7, s[8:11], s23 offen offset:1024 sc1
    s_waitcnt lgkmcnt(6)
    v_mfma_f32_16x16x32_bf16 v[40:43], v[232:235], v[112:115], v[40:43]
    ds_read_b64_tr_b16 v[224:225], v4 offset:8960
    v_mfma_f32_16x16x32_bf16 v[44:47], v[232:235], v[116:119], v[44:47]
    ds_read_b64_tr_b16 v[226:227], v4 offset:9984
    s_waitcnt lgkmcnt(6)
    v_mfma_f32_16x16x32_bf16 v[48:51], v[236:239], v[112:115], v[48:51]
    ds_read_b64_tr_b16 v[228:229], v5 offset:8992
    v_mfma_f32_16x16x32_bf16 v[52:55], v[236:239], v[116:119], v[52:55]
    ds_read_b64_tr_b16 v[230:231], v5 offset:10016
    s_waitcnt lgkmcnt(6)
    v_mfma_f32_16x16x32_bf16 v[56:59], v[240:243], v[112:115], v[56:59]
    v_mfma_f32_16x16x32_bf16 v[60:63], v[240:243], v[116:119], v[60:63]
    s_waitcnt vmcnt(9)
    s_barrier
    ds_read_b64_tr_b16 v[232:233], v4 offset:16384
    ds_read_b64_tr_b16 v[234:235], v4 offset:17408
    s_waitcnt lgkmcnt(6)
    v_mfma_f32_16x16x32_bf16 v[64:67], v[244:247], v[112:115], v[64:67]
    ds_read_b64_tr_b16 v[236:237], v5 offset:16416
    v_mfma_f32_16x16x32_bf16 v[68:71], v[244:247], v[116:119], v[68:71]
    s_add_u32 s22, s19, 0x380000
    s_add_u32 m0, s20, 0xc000
    s_nop 0
    buffer_load_dwordx4 v3, s[4:7], s22 offen lds
    ds_read_b64_tr_b16 v[238:239], v5 offset:17440
    s_mov_b32 s23, 0xb000
    buffer_load_dwordx4 v[100:103], v7, s[8:11], s23 offen offset:1024 sc1
    s_waitcnt lgkmcnt(6)
    v_mfma_f32_16x16x32_bf16 v[72:75], v[224:227], v[112:115], v[72:75]
    ds_read_b64_tr_b16 v[240:241], v4 offset:16640
    v_mfma_f32_16x16x32_bf16 v[76:79], v[224:227], v[116:119], v[76:79]
    ds_read_b64_tr_b16 v[242:243], v4 offset:17664
    s_waitcnt lgkmcnt(6)
    v_mfma_f32_16x16x32_bf16 v[80:83], v[228:231], v[112:115], v[80:83]
    ds_read_b64_tr_b16 v[244:245], v5 offset:16672
    v_mfma_f32_16x16x32_bf16 v[84:87], v[228:231], v[116:119], v[84:87]
    ds_read_b64_tr_b16 v[246:247], v5 offset:17696
    s_waitcnt vmcnt(10) lgkmcnt(6)
    v_mfma_f32_16x16x32_bf16 v[24:27], v[232:235], v[120:123], v[24:27]
    ds_read_b64_tr_b16 v[224:225], v4 offset:16896
    s_waitcnt vmcnt(9)
    v_mfma_f32_16x16x32_bf16 v[28:31], v[232:235], v[124:127], v[28:31]
    ds_read_b64_tr_b16 v[226:227], v4 offset:17920
    s_waitcnt lgkmcnt(6)
    v_mfma_f32_16x16x32_bf16 v[32:35], v[236:239], v[120:123], v[32:35]
    ds_read_b64_tr_b16 v[228:229], v5 offset:16928
    v_mfma_f32_16x16x32_bf16 v[36:39], v[236:239], v[124:127], v[36:39]
    s_add_u32 s22, s19, 0x388000
    s_add_u32 m0, s20, 0xc400
    s_nop 0
    buffer_load_dwordx4 v3, s[4:7], s22 offen lds
    ds_read_b64_tr_b16 v[230:231], v5 offset:17952
    s_mov_b32 s23, 0x3800
    buffer_load_dwordx4 v[104:107], v7, s[8:11], s23 offen offset:0 sc1
    s_waitcnt lgkmcnt(6)
    v_mfma_f32_16x16x32_bf16 v[40:43], v[240:243], v[120:123], v[40:43]
    ds_read_b64_tr_b16 v[232:233], v4 offset:17152
    v_mfma_f32_16x16x32_bf16 v[44:47], v[240:243], v[124:127], v[44:47]
    ds_read_b64_tr_b16 v[234:235], v4 offset:18176
    s_waitcnt lgkmcnt(6)
    v_mfma_f32_16x16x32_bf16 v[48:51], v[244:247], v[120:123], v[48:51]
    ds_read_b64_tr_b16 v[236:237], v5 offset:17184
    v_mfma_f32_16x16x32_bf16 v[52:55], v[244:247], v[124:127], v[52:55]
    ds_read_b64_tr_b16 v[238:239], v5 offset:18208
    s_waitcnt lgkmcnt(6)
    v_mfma_f32_16x16x32_bf16 v[56:59], v[224:227], v[120:123], v[56:59]
    ds_read_b64_tr_b16 v[240:241], v4 offset:24576
    v_mfma_f32_16x16x32_bf16 v[60:63], v[224:227], v[124:127], v[60:63]
    ds_read_b64_tr_b16 v[242:243], v4 offset:25600
    s_waitcnt lgkmcnt(6)
    v_mfma_f32_16x16x32_bf16 v[64:67], v[228:231], v[120:123], v[64:67]
    ds_read_b64_tr_b16 v[244:245], v5 offset:24608
    v_mfma_f32_16x16x32_bf16 v[68:71], v[228:231], v[124:127], v[68:71]
    ds_read_b64_tr_b16 v[246:247], v5 offset:25632
    s_mov_b32 s23, 0xb800
    buffer_load_dwordx4 v[108:111], v7, s[8:11], s23 offen offset:0 sc1
    s_waitcnt lgkmcnt(6)
    v_mfma_f32_16x16x32_bf16 v[72:75], v[232:235], v[120:123], v[72:75]
    ds_read_b64_tr_b16 v[224:225], v4 offset:24832
    v_mfma_f32_16x16x32_bf16 v[76:79], v[232:235], v[124:127], v[76:79]
    ds_read_b64_tr_b16 v[226:227], v4 offset:25856
    s_waitcnt lgkmcnt(6)
    v_mfma_f32_16x16x32_bf16 v[80:83], v[236:239], v[120:123], v[80:83]
    ds_read_b64_tr_b16 v[228:229], v5 offset:24864
    v_mfma_f32_16x16x32_bf16 v[84:87], v[236:239], v[124:127], v[84:87]
    ds_read_b64_tr_b16 v[230:231], v5 offset:25888
    s_waitcnt vmcnt(11) lgkmcnt(6)
    v_mfma_f32_16x16x32_bf16 v[24:27], v[240:243], v[128:131], v[24:27]
    ds_read_b64_tr_b16 v[232:233], v4 offset:25088
    s_waitcnt vmcnt(9)
    v_mfma_f32_16x16x32_bf16 v[28:31], v[240:243], v[132:135], v[28:31]
    ds_read_b64_tr_b16 v[234:235], v4 offset:26112
    s_waitcnt lgkmcnt(6)
    v_mfma_f32_16x16x32_bf16 v[32:35], v[244:247], v[128:131], v[32:35]
    ds_read_b64_tr_b16 v[236:237], v5 offset:25120
    v_mfma_f32_16x16x32_bf16 v[36:39], v[244:247], v[132:135], v[36:39]
    ds_read_b64_tr_b16 v[238:239], v5 offset:26144
    s_mov_b32 s23, 0x3800
    buffer_load_dwordx4 v[112:115], v7, s[8:11], s23 offen offset:1024 sc1
    s_waitcnt lgkmcnt(6)
    v_mfma_f32_16x16x32_bf16 v[40:43], v[224:227], v[128:131], v[40:43]
    ds_read_b64_tr_b16 v[240:241], v4 offset:25344
    v_mfma_f32_16x16x32_bf16 v[44:47], v[224:227], v[132:135], v[44:47]
    ds_read_b64_tr_b16 v[242:243], v4 offset:26368
    s_waitcnt lgkmcnt(6)
    v_mfma_f32_16x16x32_bf16 v[48:51], v[228:231], v[128:131], v[48:51]
    ds_read_b64_tr_b16 v[244:245], v5 offset:25376
    v_mfma_f32_16x16x32_bf16 v[52:55], v[228:231], v[132:135], v[52:55]
    ds_read_b64_tr_b16 v[246:247], v5 offset:26400
    s_waitcnt lgkmcnt(6)
    v_mfma_f32_16x16x32_bf16 v[56:59], v[232:235], v[128:131], v[56:59]
    v_mfma_f32_16x16x32_bf16 v[60:63], v[232:235], v[132:135], v[60:63]
    s_waitcnt vmcnt(9)
    s_barrier
    ds_read_b64_tr_b16 v[224:225], v4 offset:32768
    ds_read_b64_tr_b16 v[226:227], v4 offset:33792
    s_waitcnt lgkmcnt(6)
    v_mfma_f32_16x16x32_bf16 v[64:67], v[236:239], v[128:131], v[64:67]
    ds_read_b64_tr_b16 v[228:229], v5 offset:32800
    v_mfma_f32_16x16x32_bf16 v[68:71], v[236:239], v[132:135], v[68:71]
    s_add_u32 s22, s19, 0x400000
    s_add_u32 m0, s20, 0x0
    s_nop 0
    buffer_load_dwordx4 v3, s[4:7], s22 offen lds
    ds_read_b64_tr_b16 v[230:231], v5 offset:33824
    s_mov_b32 s23, 0xb800
    buffer_load_dwordx4 v[116:119], v7, s[8:11], s23 offen offset:1024 sc1
    s_waitcnt lgkmcnt(6)
    v_mfma_f32_16x16x32_bf16 v[72:75], v[240:243], v[128:131], v[72:75]
    ds_read_b64_tr_b16 v[232:233], v4 offset:33024
    v_mfma_f32_16x16x32_bf16 v[76:79], v[240:243], v[132:135], v[76:79]
    ds_read_b64_tr_b16 v[234:235], v4 offset:34048
    s_waitcnt lgkmcnt(6)
    v_mfma_f32_16x16x32_bf16 v[80:83], v[244:247], v[128:131], v[80:83]
    ds_read_b64_tr_b16 v[236:237], v5 offset:33056
    v_mfma_f32_16x16x32_bf16 v[84:87], v[244:247], v[132:135], v[84:87]
    ds_read_b64_tr_b16 v[238:239], v5 offset:34080
    s_waitcnt vmcnt(10) lgkmcnt(6)
    v_mfma_f32_16x16x32_bf16 v[24:27], v[224:227], v[88:91], v[24:27]
    ds_read_b64_tr_b16 v[240:241], v4 offset:33280
    s_waitcnt vmcnt(9)
    v_mfma_f32_16x16x32_bf16 v[28:31], v[224:227], v[92:95], v[28:31]
    ds_read_b64_tr_b16 v[242:243], v4 offset:34304
    s_waitcnt lgkmcnt(6)
    v_mfma_f32_16x16x32_bf16 v[32:35], v[228:231], v[88:91], v[32:35]
    ds_read_b64_tr_b16 v[244:245], v5 offset:33312
    v_mfma_f32_16x16x32_bf16 v[36:39], v[228:231], v[92:95], v[36:39]
    s_add_u32 s22, s19, 0x408000
    s_add_u32 m0, s20, 0x400
    s_nop 0
    buffer_load_dwordx4 v3, s[4:7], s22 offen lds
    ds_read_b64_tr_b16 v[246:247], v5 offset:34336
    s_mov_b32 s23, 0x4000
    buffer_load_dwordx4 v[120:123], v7, s[8:11], s23 offen offset:0 sc1
    s_waitcnt lgkmcnt(6)
    v_mfma_f32_16x16x32_bf16 v[40:43], v[232:235], v[88:91], v[40:43]
    ds_read_b64_tr_b16 v[224:225], v4 offset:33536
    v_mfma_f32_16x16x32_bf16 v[44:47], v[232:235], v[92:95], v[44:47]
    ds_read_b64_tr_b16 v[226:227], v4 offset:34560
    s_waitcnt lgkmcnt(6)
    v_mfma_f32_16x16x32_bf16 v[48:51], v[236:239], v[88:91], v[48:51]
    ds_read_b64_tr_b16 v[228:229], v5 offset:33568
    v_mfma_f32_16x16x32_bf16 v[52:55], v[236:239], v[92:95], v[52:55]
    ds_read_b64_tr_b16 v[230:231], v5 offset:34592
    s_waitcnt lgkmcnt(6)
    v_mfma_f32_16x16x32_bf16 v[56:59], v[240:243], v[88:91], v[56:59]
    ds_read_b64_tr_b16 v[232:233], v4 offset:40960
    v_mfma_f32_16x16x32_bf16 v[60:63], v[240:243], v[92:95], v[60:63]
    ds_read_b64_tr_b16 v[234:235], v4 offset:41984
    s_waitcnt lgkmcnt(6)
    v_mfma_f32_16x16x32_bf16 v[64:67], v[244:247], v[88:91], v[64:67]
    ds_read_b64_tr_b16 v[236:237], v5 offset:40992
    v_mfma_f32_16x16x32_bf16 v[68:71], v[244:247], v[92:95], v[68:71]
    ds_read_b64_tr_b16 v[238:239], v5 offset:42016
    s_mov_b32 s23, 0xc000
    buffer_load_dwordx4 v[124:127], v7, s[8:11], s23 offen offset:0 sc1
    s_waitcnt lgkmcnt(6)
    v_mfma_f32_16x16x32_bf16 v[72:75], v[224:227], v[88:91], v[72:75]
    ds_read_b64_tr_b16 v[240:241], v4 offset:41216
    v_lshrrev_b32 v21, 4, v1
    v_lshlrev_b32 v21, 9, v21
    v_and_b32 v20, 15, v1
    v_lshl_add_u32 v21, v20, 4, v21
    s_lshr_b32 s18, s12, 3
    s_lshl_b32 s18, s18, 11
    s_add_u32 s18, s18, 0x528100
    buffer_load_dwordx4 v[12:15], v21, s[8:11], s18 offen sc1
    v_mfma_f32_16x16x32_bf16 v[76:79], v[224:227], v[92:95], v[76:79]
    ds_read_b64_tr_b16 v[242:243], v4 offset:42240
    s_waitcnt lgkmcnt(6)
    v_mfma_f32_16x16x32_bf16 v[80:83], v[228:231], v[88:91], v[80:83]
    ds_read_b64_tr_b16 v[244:245], v5 offset:41248
    v_mfma_f32_16x16x32_bf16 v[84:87], v[228:231], v[92:95], v[84:87]
    ds_read_b64_tr_b16 v[246:247], v5 offset:42272
    s_waitcnt vmcnt(12) lgkmcnt(6)
    v_mfma_f32_16x16x32_bf16 v[24:27], v[232:235], v[96:99], v[24:27]
    ds_read_b64_tr_b16 v[224:225], v4 offset:41472
    s_waitcnt vmcnt(10)
    v_mfma_f32_16x16x32_bf16 v[28:31], v[232:235], v[100:103], v[28:31]
    ds_read_b64_tr_b16 v[226:227], v4 offset:42496
    s_waitcnt lgkmcnt(6)
    v_mfma_f32_16x16x32_bf16 v[32:35], v[236:239], v[96:99], v[32:35]
    ds_read_b64_tr_b16 v[228:229], v5 offset:41504
    v_mfma_f32_16x16x32_bf16 v[36:39], v[236:239], v[100:103], v[36:39]
    ds_read_b64_tr_b16 v[230:231], v5 offset:42528
    s_mov_b32 s23, 0x4000
    buffer_load_dwordx4 v[128:131], v7, s[8:11], s23 offen offset:1024 sc1
    s_waitcnt lgkmcnt(6)
    v_mfma_f32_16x16x32_bf16 v[40:43], v[240:243], v[96:99], v[40:43]
    ds_read_b64_tr_b16 v[232:233], v4 offset:41728
    v_mfma_f32_16x16x32_bf16 v[44:47], v[240:243], v[100:103], v[44:47]
    ds_read_b64_tr_b16 v[234:235], v4 offset:42752
    s_waitcnt lgkmcnt(6)
    v_mfma_f32_16x16x32_bf16 v[48:51], v[244:247], v[96:99], v[48:51]
    ds_read_b64_tr_b16 v[236:237], v5 offset:41760
    v_mfma_f32_16x16x32_bf16 v[52:55], v[244:247], v[100:103], v[52:55]
    ds_read_b64_tr_b16 v[238:239], v5 offset:42784
    s_waitcnt lgkmcnt(6)
    v_mfma_f32_16x16x32_bf16 v[56:59], v[224:227], v[96:99], v[56:59]
    v_mfma_f32_16x16x32_bf16 v[60:63], v[224:227], v[100:103], v[60:63]
    s_waitcnt vmcnt(10)
    s_barrier
    ds_read_b64_tr_b16 v[240:241], v4 offset:49152
    ds_read_b64_tr_b16 v[242:243], v4 offset:50176
    s_waitcnt lgkmcnt(6)
    v_mfma_f32_16x16x32_bf16 v[64:67], v[228:231], v[96:99], v[64:67]
    ds_read_b64_tr_b16 v[244:245], v5 offset:49184
    v_mfma_f32_16x16x32_bf16 v[68:71], v[228:231], v[100:103], v[68:71]
    s_add_u32 s22, s19, 0x480000
    s_add_u32 m0, s20, 0x4000
    s_nop 0
    buffer_load_dwordx4 v3, s[4:7], s22 offen lds
    ds_read_b64_tr_b16 v[246:247], v5 offset:50208
    s_mov_b32 s23, 0xc000
    buffer_load_dwordx4 v[132:135], v7, s[8:11], s23 offen offset:1024 sc1
    s_waitcnt lgkmcnt(6)
    v_mfma_f32_16x16x32_bf16 v[72:75], v[232:235], v[96:99], v[72:75]
    ds_read_b64_tr_b16 v[224:225], v4 offset:49408
    v_mfma_f32_16x16x32_bf16 v[76:79], v[232:235], v[100:103], v[76:79]
    ds_read_b64_tr_b16 v[226:227], v4 offset:50432
    s_waitcnt lgkmcnt(6)
    v_mfma_f32_16x16x32_bf16 v[80:83], v[236:239], v[96:99], v[80:83]
    ds_read_b64_tr_b16 v[228:229], v5 offset:49440
    v_mfma_f32_16x16x32_bf16 v[84:87], v[236:239], v[100:103], v[84:87]
    ds_read_b64_tr_b16 v[230:231], v5 offset:50464
    s_waitcnt vmcnt(11) lgkmcnt(6)
    v_mfma_f32_16x16x32_bf16 v[24:27], v[240:243], v[104:107], v[24:27]
    ds_read_b64_tr_b16 v[232:233], v4 offset:49664
    s_waitcnt vmcnt(10)
    v_mfma_f32_16x16x32_bf16 v[28:31], v[240:243], v[108:111], v[28:31]
    ds_read_b64_tr_b16 v[234:235], v4 offset:50688
    s_waitcnt lgkmcnt(6)
    v_mfma_f32_16x16x32_bf16 v[32:35], v[244:247], v[104:107], v[32:35]
    ds_read_b64_tr_b16 v[236:237], v5 offset:49696
    v_mfma_f32_16x16x32_bf16 v[36:39], v[244:247], v[108:111], v[36:39]
    s_add_u32 s22, s19, 0x488000
    s_add_u32 m0, s20, 0x4400
    s_nop 0
    buffer_load_dwordx4 v3, s[4:7], s22 offen lds
    ds_read_b64_tr_b16 v[238:239], v5 offset:50720
    s_mov_b32 s23, 0x4800
    buffer_load_dwordx4 v[88:91], v7, s[8:11], s23 offen offset:0 sc1
    s_waitcnt lgkmcnt(6)
    v_mfma_f32_16x16x32_bf16 v[40:43], v[224:227], v[104:107], v[40:43]
    ds_read_b64_tr_b16 v[240:241], v4 offset:49920
    v_mfma_f32_16x16x32_bf16 v[44:47], v[224:227], v[108:111], v[44:47]
    ds_read_b64_tr_b16 v[242:243], v4 offset:50944
    s_waitcnt lgkmcnt(6)
    v_mfma_f32_16x16x32_bf16 v[48:51], v[228:231], v[104:107], v[48:51]
    ds_read_b64_tr_b16 v[244:245], v5 offset:49952
    v_mfma_f32_16x16x32_bf16 v[52:55], v[228:231], v[108:111], v[52:55]
    ds_read_b64_tr_b16 v[246:247], v5 offset:50976
    s_waitcnt lgkmcnt(6)
    v_mfma_f32_16x16x32_bf16 v[56:59], v[232:235], v[104:107], v[56:59]
    ds_read_b64_tr_b16 v[224:225], v4 offset:57344
    v_mfma_f32_16x16x32_bf16 v[60:63], v[232:235], v[108:111], v[60:63]
    ds_read_b64_tr_b16 v[226:227], v4 offset:58368
    s_waitcnt lgkmcnt(6)
    v_mfma_f32_16x16x32_bf16 v[64:67], v[236:239], v[104:107], v[64:67]
    ds_read_b64_tr_b16 v[228:229], v5 offset:57376
    v_mfma_f32_16x16x32_bf16 v[68:71], v[236:239], v[108:111], v[68:71]
    ds_read_b64_tr_b16 v[230:231], v5 offset:58400
    s_mov_b32 s23, 0xc800
    buffer_load_dwordx4 v[92:95], v7, s[8:11], s23 offen offset:0 sc1
    s_waitcnt lgkmcnt(6)
    v_mfma_f32_16x16x32_bf16 v[72:75], v[240:243], v[104:107], v[72:75]
    ds_read_b64_tr_b16 v[232:233], v4 offset:57600
    v_mfma_f32_16x16x32_bf16 v[76:79], v[240:243], v[108:111], v[76:79]
    ds_read_b64_tr_b16 v[234:235], v4 offset:58624
    s_waitcnt lgkmcnt(6)
    v_mfma_f32_16x16x32_bf16 v[80:83], v[244:247], v[104:107], v[80:83]
    ds_read_b64_tr_b16 v[236:237], v5 offset:57632
    v_mfma_f32_16x16x32_bf16 v[84:87], v[244:247], v[108:111], v[84:87]
    ds_read_b64_tr_b16 v[238:239], v5 offset:58656
    s_waitcnt vmcnt(12) lgkmcnt(6)
    v_mfma_f32_16x16x32_bf16 v[24:27], v[224:227], v[112:115], v[24:27]
    ds_read_b64_tr_b16 v[240:241], v4 offset:57856
    s_waitcnt vmcnt(10)
    v_mfma_f32_16x16x32_bf16 v[28:31], v[224:227], v[116:119], v[28:31]
    ds_read_b64_tr_b16 v[242:243], v4 offset:58880
    s_waitcnt lgkmcnt(6)
    v_mfma_f32_16x16x32_bf16 v[32:35], v[228:231], v[112:115], v[32:35]
    ds_read_b64_tr_b16 v[244:245], v5 offset:57888
    v_mfma_f32_16x16x32_bf16 v[36:39], v[228:231], v[116:119], v[36:39]
    ds_read_b64_tr_b16 v[246:247], v5 offset:58912
    s_mov_b32 s23, 0x4800
    buffer_load_dwordx4 v[96:99], v7, s[8:11], s23 offen offset:1024 sc1
    s_waitcnt lgkmcnt(6)
    v_mfma_f32_16x16x32_bf16 v[40:43], v[232:235], v[112:115], v[40:43]
    ds_read_b64_tr_b16 v[224:225], v4 offset:58112
    v_mfma_f32_16x16x32_bf16 v[44:47], v[232:235], v[116:119], v[44:47]
    ds_read_b64_tr_b16 v[226:227], v4 offset:59136
    s_waitcnt lgkmcnt(6)
    v_mfma_f32_16x16x32_bf16 v[48:51], v[236:239], v[112:115], v[48:51]
    ds_read_b64_tr_b16 v[228:229], v5 offset:58144
    v_mfma_f32_16x16x32_bf16 v[52:55], v[236:239], v[116:119], v[52:55]
    ds_read_b64_tr_b16 v[230:231], v5 offset:59168
    s_waitcnt lgkmcnt(6)
    v_mfma_f32_16x16x32_bf16 v[56:59], v[240:243], v[112:115], v[56:59]
    v_mfma_f32_16x16x32_bf16 v[60:63], v[240:243], v[116:119], v[60:63]
    s_waitcnt vmcnt(10)
    s_barrier
    ds_read_b64_tr_b16 v[232:233], v4 offset:0
    ds_read_b64_tr_b16 v[234:235], v4 offset:1024
    s_waitcnt lgkmcnt(6)
    v_mfma_f32_16x16x32_bf16 v[64:67], v[244:247], v[112:115], v[64:67]
    ds_read_b64_tr_b16 v[236:237], v5 offset:32
    v_mfma_f32_16x16x32_bf16 v[68:71], v[244:247], v[116:119], v[68:71]
    s_add_u32 s22, s19, 0x500000
    s_add_u32 m0, s20, 0x8000
    s_nop 0
    buffer_load_dwordx4 v3, s[4:7], s22 offen lds
    ds_read_b64_tr_b16 v[238:239], v5 offset:1056
    s_mov_b32 s23, 0xc800
    buffer_load_dwordx4 v[100:103], v7, s[8:11], s23 offen offset:1024 sc1
    s_waitcnt lgkmcnt(6)
    v_mfma_f32_16x16x32_bf16 v[72:75], v[224:227], v[112:115], v[72:75]
    ds_read_b64_tr_b16 v[240:241], v4 offset:256
    v_mfma_f32_16x16x32_bf16 v[76:79], v[224:227], v[116:119], v[76:79]
    ds_read_b64_tr_b16 v[242:243], v4 offset:1280
    s_waitcnt lgkmcnt(6)
    v_mfma_f32_16x16x32_bf16 v[80:83], v[228:231], v[112:115], v[80:83]
    ds_read_b64_tr_b16 v[244:245], v5 offset:288
    v_mfma_f32_16x16x32_bf16 v[84:87], v[228:231], v[116:119], v[84:87]
    ds_read_b64_tr_b16 v[246:247], v5 offset:1312
    s_waitcnt vmcnt(11) lgkmcnt(6)
    v_mfma_f32_16x16x32_bf16 v[24:27], v[232:235], v[120:123], v[24:27]
    ds_read_b64_tr_b16 v[224:225], v4 offset:512
    s_waitcnt vmcnt(10)
    v_mfma_f32_16x16x32_bf16 v[28:31], v[232:235], v[124:127], v[28:31]
    ds_read_b64_tr_b16 v[226:227], v4 offset:1536
    s_waitcnt lgkmcnt(6)
    v_mfma_f32_16x16x32_bf16 v[32:35], v[236:239], v[120:123], v[32:35]
    ds_read_b64_tr_b16 v[228:229], v5 offset:544
    v_mfma_f32_16x16x32_bf16 v[36:39], v[236:239], v[124:127], v[36:39]
    s_add_u32 s22, s19, 0x508000
    s_add_u32 m0, s20, 0x8400
    s_nop 0
    buffer_load_dwordx4 v3, s[4:7], s22 offen lds
    ds_read_b64_tr_b16 v[230:231], v5 offset:1568
    s_mov_b32 s23, 0x5000
    buffer_load_dwordx4 v[104:107], v7, s[8:11], s23 offen offset:0 sc1
    s_waitcnt lgkmcnt(6)
    v_mfma_f32_16x16x32_bf16 v[40:43], v[240:243], v[120:123], v[40:43]
    ds_read_b64_tr_b16 v[232:233], v4 offset:768
    v_mfma_f32_16x16x32_bf16 v[44:47], v[240:243], v[124:127], v[44:47]
    ds_read_b64_tr_b16 v[234:235], v4 offset:1792
    s_waitcnt lgkmcnt(6)
    v_mfma_f32_16x16x32_bf16 v[48:51], v[244:247], v[120:123], v[48:51]
    ds_read_b64_tr_b16 v[236:237], v5 offset:800
    v_mfma_f32_16x16x32_bf16 v[52:55], v[244:247], v[124:127], v[52:55]
    ds_read_b64_tr_b16 v[238:239], v5 offset:1824
    s_waitcnt lgkmcnt(6)
    v_mfma_f32_16x16x32_bf16 v[56:59], v[224:227], v[120:123], v[56:59]
    ds_read_b64_tr_b16 v[240:241], v4 offset:8192
    v_mfma_f32_16x16x32_bf16 v[60:63], v[224:227], v[124:127], v[60:63]
    ds_read_b64_tr_b16 v[242:243], v4 offset:9216
    s_waitcnt lgkmcnt(6)
    v_mfma_f32_16x16x32_bf16 v[64:67], v[228:231], v[120:123], v[64:67]
    ds_read_b64_tr_b16 v[244:245], v5 offset:8224
    v_mfma_f32_16x16x32_bf16 v[68:71], v[228:231], v[124:127], v[68:71]
    ds_read_b64_tr_b16 v[246:247], v5 offset:9248
    s_mov_b32 s23, 0xd000
    buffer_load_dwordx4 v[108:111], v7, s[8:11], s23 offen offset:0 sc1
    s_waitcnt lgkmcnt(6)
    v_mfma_f32_16x16x32_bf16 v[72:75], v[232:235], v[120:123], v[72:75]
    ds_read_b64_tr_b16 v[224:225], v4 offset:8448
    v_mfma_f32_16x16x32_bf16 v[76:79], v[232:235], v[124:127], v[76:79]
    ds_read_b64_tr_b16 v[226:227], v4 offset:9472
    s_waitcnt lgkmcnt(6)
    v_mfma_f32_16x16x32_bf16 v[80:83], v[236:239], v[120:123], v[80:83]
    ds_read_b64_tr_b16 v[228:229], v5 offset:8480
    v_mfma_f32_16x16x32_bf16 v[84:87], v[236:239], v[124:127], v[84:87]
    ds_read_b64_tr_b16 v[230:231], v5 offset:9504
    s_waitcnt vmcnt(11) lgkmcnt(6)
    v_mfma_f32_16x16x32_bf16 v[24:27], v[240:243], v[128:131], v[24:27]
    ds_read_b64_tr_b16 v[232:233], v4 offset:8704
    s_waitcnt vmcnt(9)
    v_mfma_f32_16x16x32_bf16 v[28:31], v[240:243], v[132:135], v[28:31]
    ds_read_b64_tr_b16 v[234:235], v4 offset:9728
    s_waitcnt lgkmcnt(6)
    v_mfma_f32_16x16x32_bf16 v[32:35], v[244:247], v[128:131], v[32:35]
    ds_read_b64_tr_b16 v[236:237], v5 offset:8736
    v_mfma_f32_16x16x32_bf16 v[36:39], v[244:247], v[132:135], v[36:39]
    ds_read_b64_tr_b16 v[238:239], v5 offset:9760
    s_mov_b32 s23, 0x5000
    buffer_load_dwordx4 v[112:115], v7, s[8:11], s23 offen offset:1024 sc1
    s_waitcnt lgkmcnt(6)
    v_mfma_f32_16x16x32_bf16 v[40:43], v[224:227], v[128:131], v[40:43]
    ds_read_b64_tr_b16 v[240:241], v4 offset:8960
    v_mfma_f32_16x16x32_bf16 v[44:47], v[224:227], v[132:135], v[44:47]
    ds_read_b64_tr_b16 v[242:243], v4 offset:9984
    s_waitcnt lgkmcnt(6)
    v_mfma_f32_16x16x32_bf16 v[48:51], v[228:231], v[128:131], v[48:51]
    ds_read_b64_tr_b16 v[244:245], v5 offset:8992
    v_mfma_f32_16x16x32_bf16 v[52:55], v[228:231], v[132:135], v[52:55]
    ds_read_b64_tr_b16 v[246:247], v5 offset:10016
    s_waitcnt lgkmcnt(6)
    v_mfma_f32_16x16x32_bf16 v[56:59], v[232:235], v[128:131], v[56:59]
    v_mfma_f32_16x16x32_bf16 v[60:63], v[232:235], v[132:135], v[60:63]
    s_waitcnt vmcnt(9)
    s_barrier
    ds_read_b64_tr_b16 v[224:225], v4 offset:16384
    ds_read_b64_tr_b16 v[226:227], v4 offset:17408
    s_waitcnt lgkmcnt(6)
    v_mfma_f32_16x16x32_bf16 v[64:67], v[236:239], v[128:131], v[64:67]
    ds_read_b64_tr_b16 v[228:229], v5 offset:16416
    v_mfma_f32_16x16x32_bf16 v[68:71], v[236:239], v[132:135], v[68:71]
    s_add_u32 s22, s19, 0x580000
    s_add_u32 m0, s20, 0xc000
    s_nop 0
    buffer_load_dwordx4 v3, s[4:7], s22 offen lds
    ds_read_b64_tr_b16 v[230:231], v5 offset:17440
    s_mov_b32 s23, 0xd000
    buffer_load_dwordx4 v[116:119], v7, s[8:11], s23 offen offset:1024 sc1
    s_waitcnt lgkmcnt(6)
    v_mfma_f32_16x16x32_bf16 v[72:75], v[240:243], v[128:131], v[72:75]
    ds_read_b64_tr_b16 v[232:233], v4 offset:16640
    v_mfma_f32_16x16x32_bf16 v[76:79], v[240:243], v[132:135], v[76:79]
    ds_read_b64_tr_b16 v[234:235], v4 offset:17664
    s_waitcnt lgkmcnt(6)
    v_mfma_f32_16x16x32_bf16 v[80:83], v[244:247], v[128:131], v[80:83]
    ds_read_b64_tr_b16 v[236:237], v5 offset:16672
    v_mfma_f32_16x16x32_bf16 v[84:87], v[244:247], v[132:135], v[84:87]
    ds_read_b64_tr_b16 v[238:239], v5 offset:17696
    s_waitcnt vmcnt(10) lgkmcnt(6)
    v_mfma_f32_16x16x32_bf16 v[24:27], v[224:227], v[88:91], v[24:27]
    ds_read_b64_tr_b16 v[240:241], v4 offset:16896
    s_waitcnt vmcnt(9)
    v_mfma_f32_16x16x32_bf16 v[28:31], v[224:227], v[92:95], v[28:31]
    ds_read_b64_tr_b16 v[242:243], v4 offset:17920
    s_waitcnt lgkmcnt(6)
    v_mfma_f32_16x16x32_bf16 v[32:35], v[228:231], v[88:91], v[32:35]
    ds_read_b64_tr_b16 v[244:245], v5 offset:16928
    v_mfma_f32_16x16x32_bf16 v[36:39], v[228:231], v[92:95], v[36:39]
    s_add_u32 s22, s19, 0x588000
    s_add_u32 m0, s20, 0xc400
    s_nop 0
    buffer_load_dwordx4 v3, s[4:7], s22 offen lds
    ds_read_b64_tr_b16 v[246:247], v5 offset:17952
    s_mov_b32 s23, 0x5800
    buffer_load_dwordx4 v[120:123], v7, s[8:11], s23 offen offset:0 sc1
    s_waitcnt lgkmcnt(6)
    v_mfma_f32_16x16x32_bf16 v[40:43], v[232:235], v[88:91], v[40:43]
    ds_read_b64_tr_b16 v[224:225], v4 offset:17152
    v_mfma_f32_16x16x32_bf16 v[44:47], v[232:235], v[92:95], v[44:47]
    ds_read_b64_tr_b16 v[226:227], v4 offset:18176
    s_waitcnt lgkmcnt(6)
    v_mfma_f32_16x16x32_bf16 v[48:51], v[236:239], v[88:91], v[48:51]
    ds_read_b64_tr_b16 v[228:229], v5 offset:17184
    v_mfma_f32_16x16x32_bf16 v[52:55], v[236:239], v[92:95], v[52:55]
    ds_read_b64_tr_b16 v[230:231], v5 offset:18208
    s_waitcnt lgkmcnt(6)
    v_mfma_f32_16x16x32_bf16 v[56:59], v[240:243], v[88:91], v[56:59]
    ds_read_b64_tr_b16 v[232:233], v4 offset:24576
    v_mfma_f32_16x16x32_bf16 v[60:63], v[240:243], v[92:95], v[60:63]
    ds_read_b64_tr_b16 v[234:235], v4 offset:25600
    s_waitcnt lgkmcnt(6)
    v_mfma_f32_16x16x32_bf16 v[64:67], v[244:247], v[88:91], v[64:67]
    ds_read_b64_tr_b16 v[236:237], v5 offset:24608
    v_mfma_f32_16x16x32_bf16 v[68:71], v[244:247], v[92:95], v[68:71]
    ds_read_b64_tr_b16 v[238:239], v5 offset:25632
    s_mov_b32 s23, 0xd800
    buffer_load_dwordx4 v[124:127], v7, s[8:11], s23 offen offset:0 sc1
    s_waitcnt lgkmcnt(6)
    v_mfma_f32_16x16x32_bf16 v[72:75], v[224:227], v[88:91], v[72:75]
    ds_read_b64_tr_b16 v[240:241], v4 offset:24832
    v_xor_b32 v8, s28, v12
    v_xor_b32 v20, s28, v13
    v_or_b32 v8, v8, v20
    v_xor_b32 v20, s28, v14
    v_or_b32 v8, v8, v20
    v_xor_b32 v20, s28, v15
    v_or_b32 v8, v8, v20
    v_cmp_ne_u32 vcc, 0, v8
    s_cbranch_vccnz adaLN_cond__sliding_block_cached__moe_arch_mod__prompt_kernel_kv16r
adaLN_cond__sliding_block_cached__moe_arch_mod__prompt_kernel_kv16b:
    v_mfma_f32_16x16x32_bf16 v[76:79], v[224:227], v[92:95], v[76:79]
    ds_read_b64_tr_b16 v[242:243], v4 offset:25856
    v_mov_b32 v20, 0
    s_mov_b32 s16, 0x564000
    buffer_load_dword v8, v20, s[8:11], s16 offen sc1
    s_waitcnt lgkmcnt(6)
    v_mfma_f32_16x16x32_bf16 v[80:83], v[228:231], v[88:91], v[80:83]
    ds_read_b64_tr_b16 v[244:245], v5 offset:24864
    v_mfma_f32_16x16x32_bf16 v[84:87], v[228:231], v[92:95], v[84:87]
    ds_read_b64_tr_b16 v[246:247], v5 offset:25888
    s_waitcnt vmcnt(12) lgkmcnt(6)
    v_mfma_f32_16x16x32_bf16 v[24:27], v[232:235], v[96:99], v[24:27]
    ds_read_b64_tr_b16 v[224:225], v4 offset:25088
    s_waitcnt vmcnt(10)
    v_mfma_f32_16x16x32_bf16 v[28:31], v[232:235], v[100:103], v[28:31]
    ds_read_b64_tr_b16 v[226:227], v4 offset:26112
    s_waitcnt lgkmcnt(6)
    v_mfma_f32_16x16x32_bf16 v[32:35], v[236:239], v[96:99], v[32:35]
    ds_read_b64_tr_b16 v[228:229], v5 offset:25120
    v_mfma_f32_16x16x32_bf16 v[36:39], v[236:239], v[100:103], v[36:39]
    ds_read_b64_tr_b16 v[230:231], v5 offset:26144
    s_mov_b32 s23, 0x5800
    buffer_load_dwordx4 v[128:131], v7, s[8:11], s23 offen offset:1024 sc1
    s_waitcnt lgkmcnt(6)
    v_mfma_f32_16x16x32_bf16 v[40:43], v[240:243], v[96:99], v[40:43]
    ds_read_b64_tr_b16 v[232:233], v4 offset:25344
    s_mov_b64 s[76:77], s[54:55]
    s_mov_b32 s78, 0xc00000
    s_mov_b32 s79, 0x20000
    v_bfe_u32 v20, v1, 2, 2
    v_lshlrev_b32 v20, 12, v20
    v_add_u32 v6, v3, v20
    s_lshr_b32 s16, s2, 5
    s_lshl_b32 s16, s16, 7
    s_lshl_b32 s17, s3, 3
    s_add_u32 s16, s16, s17
    s_mul_i32 s14, s16, 12288
    s_and_b32 s16, s2, 31
    s_lshl_b32 s16, s16, 8
    s_add_u32 s14, s14, s16
    s_add_u32 s14, s14, 4096
    v_mfma_f32_16x16x32_bf16 v[44:47], v[240:243], v[100:103], v[44:47]
    ds_read_b64_tr_b16 v[234:235], v4 offset:26368
    s_waitcnt lgkmcnt(6)
    v_mfma_f32_16x16x32_bf16 v[48:51], v[244:247], v[96:99], v[48:51]
    ds_read_b64_tr_b16 v[236:237], v5 offset:25376
    v_mfma_f32_16x16x32_bf16 v[52:55], v[244:247], v[100:103], v[52:55]
    ds_read_b64_tr_b16 v[238:239], v5 offset:26400
    s_waitcnt lgkmcnt(6)
    v_mfma_f32_16x16x32_bf16 v[56:59], v[224:227], v[96:99], v[56:59]
    v_mfma_f32_16x16x32_bf16 v[60:63], v[224:227], v[100:103], v[60:63]
    s_waitcnt vmcnt(10)
    s_barrier
    ds_read_b64_tr_b16 v[240:241], v4 offset:32768
    ds_read_b64_tr_b16 v[242:243], v4 offset:33792
    s_waitcnt lgkmcnt(6)
    v_mfma_f32_16x16x32_bf16 v[64:67], v[228:231], v[96:99], v[64:67]
    ds_read_b64_tr_b16 v[244:245], v5 offset:32800
    v_mfma_f32_16x16x32_bf16 v[68:71], v[228:231], v[100:103], v[68:71]
    s_add_u32 s22, s19, 0x600000
    s_add_u32 m0, s20, 0x0
    s_nop 0
    buffer_load_dwordx4 v3, s[4:7], s22 offen lds
    ds_read_b64_tr_b16 v[246:247], v5 offset:33824
    s_mov_b32 s23, 0xd800
    buffer_load_dwordx4 v[132:135], v7, s[8:11], s23 offen offset:1024 sc1
    s_waitcnt lgkmcnt(6)
    v_mfma_f32_16x16x32_bf16 v[72:75], v[232:235], v[96:99], v[72:75]
    ds_read_b64_tr_b16 v[224:225], v4 offset:33024
    v_mfma_f32_16x16x32_bf16 v[76:79], v[232:235], v[100:103], v[76:79]
    ds_read_b64_tr_b16 v[226:227], v4 offset:34048
    s_waitcnt lgkmcnt(6)
    v_mfma_f32_16x16x32_bf16 v[80:83], v[236:239], v[96:99], v[80:83]
    ds_read_b64_tr_b16 v[228:229], v5 offset:33056
    v_mfma_f32_16x16x32_bf16 v[84:87], v[236:239], v[100:103], v[84:87]
    ds_read_b64_tr_b16 v[230:231], v5 offset:34080
    s_waitcnt vmcnt(11) lgkmcnt(6)
    v_mfma_f32_16x16x32_bf16 v[24:27], v[240:243], v[104:107], v[24:27]
    ds_read_b64_tr_b16 v[232:233], v4 offset:33280
    s_waitcnt vmcnt(10)
    v_mfma_f32_16x16x32_bf16 v[28:31], v[240:243], v[108:111], v[28:31]
    ds_read_b64_tr_b16 v[234:235], v4 offset:34304
    s_waitcnt lgkmcnt(6)
    v_mfma_f32_16x16x32_bf16 v[32:35], v[244:247], v[104:107], v[32:35]
    ds_read_b64_tr_b16 v[236:237], v5 offset:33312
    v_mfma_f32_16x16x32_bf16 v[36:39], v[244:247], v[108:111], v[36:39]
    s_add_u32 s22, s19, 0x608000
    s_add_u32 m0, s20, 0x400
    s_nop 0
    buffer_load_dwordx4 v3, s[4:7], s22 offen lds
    ds_read_b64_tr_b16 v[238:239], v5 offset:34336
    s_mov_b32 s23, 0x6000
    buffer_load_dwordx4 v[88:91], v7, s[8:11], s23 offen offset:0 sc1
    s_waitcnt lgkmcnt(6)
    v_mfma_f32_16x16x32_bf16 v[40:43], v[224:227], v[104:107], v[40:43]
    ds_read_b64_tr_b16 v[240:241], v4 offset:33536
    v_mfma_f32_16x16x32_bf16 v[44:47], v[224:227], v[108:111], v[44:47]
    ds_read_b64_tr_b16 v[242:243], v4 offset:34560
    s_waitcnt lgkmcnt(6)
    v_mfma_f32_16x16x32_bf16 v[48:51], v[228:231], v[104:107], v[48:51]
    ds_read_b64_tr_b16 v[244:245], v5 offset:33568
    v_mfma_f32_16x16x32_bf16 v[52:55], v[228:231], v[108:111], v[52:55]
    ds_read_b64_tr_b16 v[246:247], v5 offset:34592
    s_waitcnt lgkmcnt(6)
    v_mfma_f32_16x16x32_bf16 v[56:59], v[232:235], v[104:107], v[56:59]
    ds_read_b64_tr_b16 v[224:225], v4 offset:40960
    v_mfma_f32_16x16x32_bf16 v[60:63], v[232:235], v[108:111], v[60:63]
    ds_read_b64_tr_b16 v[226:227], v4 offset:41984
    s_waitcnt lgkmcnt(6)
    v_mfma_f32_16x16x32_bf16 v[64:67], v[236:239], v[104:107], v[64:67]
    ds_read_b64_tr_b16 v[228:229], v5 offset:40992
    v_mfma_f32_16x16x32_bf16 v[68:71], v[236:239], v[108:111], v[68:71]
    ds_read_b64_tr_b16 v[230:231], v5 offset:42016
    s_mov_b32 s23, 0xe000
    buffer_load_dwordx4 v[92:95], v7, s[8:11], s23 offen offset:0 sc1
    s_waitcnt lgkmcnt(6)
    v_mfma_f32_16x16x32_bf16 v[72:75], v[240:243], v[104:107], v[72:75]
    ds_read_b64_tr_b16 v[232:233], v4 offset:41216
    v_mfma_f32_16x16x32_bf16 v[76:79], v[240:243], v[108:111], v[76:79]
    ds_read_b64_tr_b16 v[234:235], v4 offset:42240
    s_waitcnt lgkmcnt(6)
    v_mfma_f32_16x16x32_bf16 v[80:83], v[244:247], v[104:107], v[80:83]
    ds_read_b64_tr_b16 v[236:237], v5 offset:41248
    v_mfma_f32_16x16x32_bf16 v[84:87], v[244:247], v[108:111], v[84:87]
    ds_read_b64_tr_b16 v[238:239], v5 offset:42272
    s_waitcnt vmcnt(12) lgkmcnt(6)
    v_mfma_f32_16x16x32_bf16 v[24:27], v[224:227], v[112:115], v[24:27]
    ds_read_b64_tr_b16 v[240:241], v4 offset:41472
    s_add_u32 s22, s14, 0x0
    s_add_u32 m0, s20, 0x10000
    s_nop 0
    buffer_load_dwordx4 v6, s[76:79], s22 offen lds
    s_waitcnt vmcnt(11)
    v_mfma_f32_16x16x32_bf16 v[28:31], v[224:227], v[116:119], v[28:31]
    ds_read_b64_tr_b16 v[242:243], v4 offset:42496
    s_waitcnt lgkmcnt(6)
    v_mfma_f32_16x16x32_bf16 v[32:35], v[228:231], v[112:115], v[32:35]
    ds_read_b64_tr_b16 v[244:245], v5 offset:41504
    v_mfma_f32_16x16x32_bf16 v[36:39], v[228:231], v[116:119], v[36:39]
    ds_read_b64_tr_b16 v[246:247], v5 offset:42528
    s_mov_b32 s23, 0x6000
    buffer_load_dwordx4 v[96:99], v7, s[8:11], s23 offen offset:1024 sc1
    s_waitcnt lgkmcnt(6)
    v_mfma_f32_16x16x32_bf16 v[40:43], v[232:235], v[112:115], v[40:43]
    ds_read_b64_tr_b16 v[224:225], v4 offset:41728
    s_add_u32 s22, s14, 0xc000
    s_add_u32 m0, s20, 0x10400
    s_nop 0
    buffer_load_dwordx4 v6, s[76:79], s22 offen lds
    v_mfma_f32_16x16x32_bf16 v[44:47], v[232:235], v[116:119], v[44:47]
    ds_read_b64_tr_b16 v[226:227], v4 offset:42752
    s_waitcnt lgkmcnt(6)
    v_mfma_f32_16x16x32_bf16 v[48:51], v[236:239], v[112:115], v[48:51]
    ds_read_b64_tr_b16 v[228:229], v5 offset:41760
    v_mfma_f32_16x16x32_bf16 v[52:55], v[236:239], v[116:119], v[52:55]
    ds_read_b64_tr_b16 v[230:231], v5 offset:42784
    s_waitcnt lgkmcnt(6)
    v_mfma_f32_16x16x32_bf16 v[56:59], v[240:243], v[112:115], v[56:59]
    v_mfma_f32_16x16x32_bf16 v[60:63], v[240:243], v[116:119], v[60:63]
    s_waitcnt vmcnt(12)
    s_barrier
    ds_read_b64_tr_b16 v[232:233], v4 offset:49152
    ds_read_b64_tr_b16 v[234:235], v4 offset:50176
    s_waitcnt lgkmcnt(6)
    v_mfma_f32_16x16x32_bf16 v[64:67], v[244:247], v[112:115], v[64:67]
    ds_read_b64_tr_b16 v[236:237], v5 offset:49184
    v_mfma_f32_16x16x32_bf16 v[68:71], v[244:247], v[116:119], v[68:71]
    s_add_u32 s22, s19, 0x680000
    s_add_u32 m0, s20, 0x4000
    s_nop 0
    buffer_load_dwordx4 v3, s[4:7], s22 offen lds
    ds_read_b64_tr_b16 v[238:239], v5 offset:50208
    s_mov_b32 s23, 0xe000
    buffer_load_dwordx4 v[100:103], v7, s[8:11], s23 offen offset:1024 sc1
    s_waitcnt lgkmcnt(6)
    v_mfma_f32_16x16x32_bf16 v[72:75], v[224:227], v[112:115], v[72:75]
    ds_read_b64_tr_b16 v[240:241], v4 offset:49408
    v_mfma_f32_16x16x32_bf16 v[76:79], v[224:227], v[116:119], v[76:79]
    ds_read_b64_tr_b16 v[242:243], v4 offset:50432
    s_waitcnt lgkmcnt(6)
    v_mfma_f32_16x16x32_bf16 v[80:83], v[228:231], v[112:115], v[80:83]
    ds_read_b64_tr_b16 v[244:245], v5 offset:49440
    v_mfma_f32_16x16x32_bf16 v[84:87], v[228:231], v[116:119], v[84:87]
    ds_read_b64_tr_b16 v[246:247], v5 offset:50464
    s_waitcnt vmcnt(13) lgkmcnt(6)
    v_mfma_f32_16x16x32_bf16 v[24:27], v[232:235], v[120:123], v[24:27]
    ds_read_b64_tr_b16 v[224:225], v4 offset:49664
    s_waitcnt vmcnt(12)
    v_mfma_f32_16x16x32_bf16 v[28:31], v[232:235], v[124:127], v[28:31]
    ds_read_b64_tr_b16 v[226:227], v4 offset:50688
    s_waitcnt lgkmcnt(6)
    v_mfma_f32_16x16x32_bf16 v[32:35], v[236:239], v[120:123], v[32:35]
    ds_read_b64_tr_b16 v[228:229], v5 offset:49696
    v_mfma_f32_16x16x32_bf16 v[36:39], v[236:239], v[124:127], v[36:39]
    s_add_u32 s22, s19, 0x688000
    s_add_u32 m0, s20, 0x4400
    s_nop 0
    buffer_load_dwordx4 v3, s[4:7], s22 offen lds
    ds_read_b64_tr_b16 v[230:231], v5 offset:50720
    s_mov_b32 s23, 0x6800
    buffer_load_dwordx4 v[104:107], v7, s[8:11], s23 offen offset:0 sc1
    s_waitcnt lgkmcnt(6)
    v_mfma_f32_16x16x32_bf16 v[40:43], v[240:243], v[120:123], v[40:43]
    ds_read_b64_tr_b16 v[232:233], v4 offset:49920
    v_mfma_f32_16x16x32_bf16 v[44:47], v[240:243], v[124:127], v[44:47]
    ds_read_b64_tr_b16 v[234:235], v4 offset:50944
    s_waitcnt lgkmcnt(6)
    v_mfma_f32_16x16x32_bf16 v[48:51], v[244:247], v[120:123], v[48:51]
    ds_read_b64_tr_b16 v[236:237], v5 offset:49952
    v_mfma_f32_16x16x32_bf16 v[52:55], v[244:247], v[124:127], v[52:55]
    ds_read_b64_tr_b16 v[238:239], v5 offset:50976
    s_waitcnt lgkmcnt(6)
    v_mfma_f32_16x16x32_bf16 v[56:59], v[224:227], v[120:123], v[56:59]
    ds_read_b64_tr_b16 v[240:241], v4 offset:57344
    v_mfma_f32_16x16x32_bf16 v[60:63], v[224:227], v[124:127], v[60:63]
    ds_read_b64_tr_b16 v[242:243], v4 offset:58368
    s_waitcnt lgkmcnt(6)
    v_mfma_f32_16x16x32_bf16 v[64:67], v[228:231], v[120:123], v[64:67]
    ds_read_b64_tr_b16 v[244:245], v5 offset:57376
    v_mfma_f32_16x16x32_bf16 v[68:71], v[228:231], v[124:127], v[68:71]
    ds_read_b64_tr_b16 v[246:247], v5 offset:58400
    s_mov_b32 s23, 0xe800
    buffer_load_dwordx4 v[108:111], v7, s[8:11], s23 offen offset:0 sc1
    s_waitcnt lgkmcnt(6)
    v_mfma_f32_16x16x32_bf16 v[72:75], v[232:235], v[120:123], v[72:75]
    ds_read_b64_tr_b16 v[224:225], v4 offset:57600
    v_mfma_f32_16x16x32_bf16 v[76:79], v[232:235], v[124:127], v[76:79]
    ds_read_b64_tr_b16 v[226:227], v4 offset:58624
    s_waitcnt lgkmcnt(6)
    v_mfma_f32_16x16x32_bf16 v[80:83], v[236:239], v[120:123], v[80:83]
    ds_read_b64_tr_b16 v[228:229], v5 offset:57632
    v_mfma_f32_16x16x32_bf16 v[84:87], v[236:239], v[124:127], v[84:87]
    ds_read_b64_tr_b16 v[230:231], v5 offset:58656
    s_waitcnt vmcnt(13) lgkmcnt(6)
    v_mfma_f32_16x16x32_bf16 v[24:27], v[240:243], v[128:131], v[24:27]
    ds_read_b64_tr_b16 v[232:233], v4 offset:57856
    s_add_u32 s22, s14, 0xc0000
    s_add_u32 m0, s20, 0x14000
    s_nop 0
    buffer_load_dwordx4 v6, s[76:79], s22 offen lds
    s_waitcnt vmcnt(12)
    v_mfma_f32_16x16x32_bf16 v[28:31], v[240:243], v[132:135], v[28:31]
    ds_read_b64_tr_b16 v[234:235], v4 offset:58880
    s_waitcnt lgkmcnt(6)
    v_mfma_f32_16x16x32_bf16 v[32:35], v[244:247], v[128:131], v[32:35]
    ds_read_b64_tr_b16 v[236:237], v5 offset:57888
    v_mfma_f32_16x16x32_bf16 v[36:39], v[244:247], v[132:135], v[36:39]
    ds_read_b64_tr_b16 v[238:239], v5 offset:58912
    s_mov_b32 s23, 0x6800
    buffer_load_dwordx4 v[112:115], v7, s[8:11], s23 offen offset:1024 sc1
    s_waitcnt lgkmcnt(6)
    v_mfma_f32_16x16x32_bf16 v[40:43], v[224:227], v[128:131], v[40:43]
    ds_read_b64_tr_b16 v[240:241], v4 offset:58112
    s_add_u32 s22, s14, 0xcc000
    s_add_u32 m0, s20, 0x14400
    s_nop 0
    buffer_load_dwordx4 v6, s[76:79], s22 offen lds
    v_mfma_f32_16x16x32_bf16 v[44:47], v[224:227], v[132:135], v[44:47]
    ds_read_b64_tr_b16 v[242:243], v4 offset:59136
    s_waitcnt lgkmcnt(6)
    v_mfma_f32_16x16x32_bf16 v[48:51], v[228:231], v[128:131], v[48:51]
    ds_read_b64_tr_b16 v[244:245], v5 offset:58144
    v_mfma_f32_16x16x32_bf16 v[52:55], v[228:231], v[132:135], v[52:55]
    ds_read_b64_tr_b16 v[246:247], v5 offset:59168
    s_waitcnt lgkmcnt(6)
    v_mfma_f32_16x16x32_bf16 v[56:59], v[232:235], v[128:131], v[56:59]
    v_mfma_f32_16x16x32_bf16 v[60:63], v[232:235], v[132:135], v[60:63]
    s_waitcnt vmcnt(13)
    s_barrier
    ds_read_b64_tr_b16 v[224:225], v4 offset:0
    ds_read_b64_tr_b16 v[226:227], v4 offset:1024
    s_waitcnt lgkmcnt(6)
    v_mfma_f32_16x16x32_bf16 v[64:67], v[236:239], v[128:131], v[64:67]
    ds_read_b64_tr_b16 v[228:229], v5 offset:32
    v_mfma_f32_16x16x32_bf16 v[68:71], v[236:239], v[132:135], v[68:71]
    s_add_u32 s22, s19, 0x700000
    s_add_u32 m0, s20, 0x8000
    s_nop 0
    buffer_load_dwordx4 v3, s[4:7], s22 offen lds
    ds_read_b64_tr_b16 v[230:231], v5 offset:1056
    s_mov_b32 s23, 0xe800
    buffer_load_dwordx4 v[116:119], v7, s[8:11], s23 offen offset:1024 sc1
    s_waitcnt lgkmcnt(6)
    v_mfma_f32_16x16x32_bf16 v[72:75], v[240:243], v[128:131], v[72:75]
    ds_read_b64_tr_b16 v[232:233], v4 offset:256
    v_mfma_f32_16x16x32_bf16 v[76:79], v[240:243], v[132:135], v[76:79]
    ds_read_b64_tr_b16 v[234:235], v4 offset:1280
    s_waitcnt lgkmcnt(6)
    v_mfma_f32_16x16x32_bf16 v[80:83], v[244:247], v[128:131], v[80:83]
    ds_read_b64_tr_b16 v[236:237], v5 offset:288
    v_mfma_f32_16x16x32_bf16 v[84:87], v[244:247], v[132:135], v[84:87]
    ds_read_b64_tr_b16 v[238:239], v5 offset:1312
    s_waitcnt vmcnt(14) lgkmcnt(6)
    v_mfma_f32_16x16x32_bf16 v[24:27], v[224:227], v[88:91], v[24:27]
    ds_read_b64_tr_b16 v[240:241], v4 offset:512
    s_waitcnt vmcnt(13)
    v_mfma_f32_16x16x32_bf16 v[28:31], v[224:227], v[92:95], v[28:31]
    ds_read_b64_tr_b16 v[242:243], v4 offset:1536
    s_waitcnt lgkmcnt(6)
    v_mfma_f32_16x16x32_bf16 v[32:35], v[228:231], v[88:91], v[32:35]
    ds_read_b64_tr_b16 v[244:245], v5 offset:544
    v_mfma_f32_16x16x32_bf16 v[36:39], v[228:231], v[92:95], v[36:39]
    s_add_u32 s22, s19, 0x708000
    s_add_u32 m0, s20, 0x8400
    s_nop 0
    buffer_load_dwordx4 v3, s[4:7], s22 offen lds
    ds_read_b64_tr_b16 v[246:247], v5 offset:1568
    s_mov_b32 s23, 0x7000
    buffer_load_dwordx4 v[120:123], v7, s[8:11], s23 offen offset:0 sc1
    s_waitcnt lgkmcnt(6)
    v_mfma_f32_16x16x32_bf16 v[40:43], v[232:235], v[88:91], v[40:43]
    ds_read_b64_tr_b16 v[224:225], v4 offset:768
    v_mfma_f32_16x16x32_bf16 v[44:47], v[232:235], v[92:95], v[44:47]
    ds_read_b64_tr_b16 v[226:227], v4 offset:1792
    s_waitcnt lgkmcnt(6)
    v_mfma_f32_16x16x32_bf16 v[48:51], v[236:239], v[88:91], v[48:51]
    ds_read_b64_tr_b16 v[228:229], v5 offset:800
    v_mfma_f32_16x16x32_bf16 v[52:55], v[236:239], v[92:95], v[52:55]
    ds_read_b64_tr_b16 v[230:231], v5 offset:1824
    s_waitcnt lgkmcnt(6)
    v_mfma_f32_16x16x32_bf16 v[56:59], v[240:243], v[88:91], v[56:59]
    ds_read_b64_tr_b16 v[232:233], v4 offset:8192
    v_mfma_f32_16x16x32_bf16 v[60:63], v[240:243], v[92:95], v[60:63]
    ds_read_b64_tr_b16 v[234:235], v4 offset:9216
    s_waitcnt lgkmcnt(6)
    v_mfma_f32_16x16x32_bf16 v[64:67], v[244:247], v[88:91], v[64:67]
    ds_read_b64_tr_b16 v[236:237], v5 offset:8224
    v_mfma_f32_16x16x32_bf16 v[68:71], v[244:247], v[92:95], v[68:71]
    ds_read_b64_tr_b16 v[238:239], v5 offset:9248
    s_mov_b32 s23, 0xf000
    buffer_load_dwordx4 v[124:127], v7, s[8:11], s23 offen offset:0 sc1
    s_waitcnt lgkmcnt(6)
    v_mfma_f32_16x16x32_bf16 v[72:75], v[224:227], v[88:91], v[72:75]
    ds_read_b64_tr_b16 v[240:241], v4 offset:8448
    v_mfma_f32_16x16x32_bf16 v[76:79], v[224:227], v[92:95], v[76:79]
    ds_read_b64_tr_b16 v[242:243], v4 offset:9472
    s_waitcnt lgkmcnt(6)
    v_mfma_f32_16x16x32_bf16 v[80:83], v[228:231], v[88:91], v[80:83]
    ds_read_b64_tr_b16 v[244:245], v5 offset:8480
    v_mfma_f32_16x16x32_bf16 v[84:87], v[228:231], v[92:95], v[84:87]
    ds_read_b64_tr_b16 v[246:247], v5 offset:9504
    s_waitcnt vmcnt(14) lgkmcnt(6)
    v_mfma_f32_16x16x32_bf16 v[24:27], v[232:235], v[96:99], v[24:27]
    ds_read_b64_tr_b16 v[224:225], v4 offset:8704
    s_add_u32 s22, s21, 0x0
    s_add_u32 m0, s20, 0x18000
    s_nop 0
    buffer_load_dwordx4 v2, s[8:11], s22 offen sc1 lds
    s_waitcnt vmcnt(12)
    v_mfma_f32_16x16x32_bf16 v[28:31], v[232:235], v[100:103], v[28:31]
    ds_read_b64_tr_b16 v[226:227], v4 offset:9728
    s_waitcnt lgkmcnt(6)
    v_mfma_f32_16x16x32_bf16 v[32:35], v[236:239], v[96:99], v[32:35]
    ds_read_b64_tr_b16 v[228:229], v5 offset:8736
    v_mfma_f32_16x16x32_bf16 v[36:39], v[236:239], v[100:103], v[36:39]
    ds_read_b64_tr_b16 v[230:231], v5 offset:9760
    s_mov_b32 s23, 0x7000
    buffer_load_dwordx4 v[128:131], v7, s[8:11], s23 offen offset:1024 sc1
    s_waitcnt lgkmcnt(6)
    v_mfma_f32_16x16x32_bf16 v[40:43], v[240:243], v[96:99], v[40:43]
    ds_read_b64_tr_b16 v[232:233], v4 offset:8960
    s_add_u32 s22, s21, 0x400
    s_add_u32 m0, s20, 0x18400
    s_nop 0
    buffer_load_dwordx4 v2, s[8:11], s22 offen sc1 lds
    v_mfma_f32_16x16x32_bf16 v[44:47], v[240:243], v[100:103], v[44:47]
    ds_read_b64_tr_b16 v[234:235], v4 offset:9984
    s_waitcnt lgkmcnt(6)
    v_mfma_f32_16x16x32_bf16 v[48:51], v[244:247], v[96:99], v[48:51]
    ds_read_b64_tr_b16 v[236:237], v5 offset:8992
    v_mfma_f32_16x16x32_bf16 v[52:55], v[244:247], v[100:103], v[52:55]
    ds_read_b64_tr_b16 v[238:239], v5 offset:10016
    s_waitcnt lgkmcnt(6)
    v_mfma_f32_16x16x32_bf16 v[56:59], v[224:227], v[96:99], v[56:59]
    v_mfma_f32_16x16x32_bf16 v[60:63], v[224:227], v[100:103], v[60:63]
    s_waitcnt vmcnt(13)
    s_barrier
    ds_read_b64_tr_b16 v[240:241], v4 offset:16384
    ds_read_b64_tr_b16 v[242:243], v4 offset:17408
    s_waitcnt lgkmcnt(6)
    v_mfma_f32_16x16x32_bf16 v[64:67], v[228:231], v[96:99], v[64:67]
    ds_read_b64_tr_b16 v[244:245], v5 offset:16416
    v_mfma_f32_16x16x32_bf16 v[68:71], v[228:231], v[100:103], v[68:71]
    s_add_u32 s22, s19, 0x780000
    s_add_u32 m0, s20, 0xc000
    s_nop 0
    buffer_load_dwordx4 v3, s[4:7], s22 offen lds
    ds_read_b64_tr_b16 v[246:247], v5 offset:17440
    s_mov_b32 s23, 0xf000
    buffer_load_dwordx4 v[132:135], v7, s[8:11], s23 offen offset:1024 sc1
    s_waitcnt lgkmcnt(6)
    v_mfma_f32_16x16x32_bf16 v[72:75], v[232:235], v[96:99], v[72:75]
    ds_read_b64_tr_b16 v[224:225], v4 offset:16640
    v_mfma_f32_16x16x32_bf16 v[76:79], v[232:235], v[100:103], v[76:79]
    ds_read_b64_tr_b16 v[226:227], v4 offset:17664
    s_waitcnt lgkmcnt(6)
    v_mfma_f32_16x16x32_bf16 v[80:83], v[236:239], v[96:99], v[80:83]
    ds_read_b64_tr_b16 v[228:229], v5 offset:16672
    v_mfma_f32_16x16x32_bf16 v[84:87], v[236:239], v[100:103], v[84:87]
    ds_read_b64_tr_b16 v[230:231], v5 offset:17696
    s_waitcnt vmcnt(14) lgkmcnt(6)
    v_mfma_f32_16x16x32_bf16 v[24:27], v[240:243], v[104:107], v[24:27]
    ds_read_b64_tr_b16 v[232:233], v4 offset:16896
    s_waitcnt vmcnt(13)
    v_mfma_f32_16x16x32_bf16 v[28:31], v[240:243], v[108:111], v[28:31]
    ds_read_b64_tr_b16 v[234:235], v4 offset:17920
    s_waitcnt lgkmcnt(6)
    v_mfma_f32_16x16x32_bf16 v[32:35], v[244:247], v[104:107], v[32:35]
    ds_read_b64_tr_b16 v[236:237], v5 offset:16928
    v_mfma_f32_16x16x32_bf16 v[36:39], v[244:247], v[108:111], v[36:39]
    s_add_u32 s22, s19, 0x788000
    s_add_u32 m0, s20, 0xc400
    s_nop 0
    buffer_load_dwordx4 v3, s[4:7], s22 offen lds
    ds_read_b64_tr_b16 v[238:239], v5 offset:17952
    s_mov_b32 s23, 0x7800
    buffer_load_dwordx4 v[88:91], v7, s[8:11], s23 offen offset:0 sc1
    s_waitcnt lgkmcnt(6)
    v_mfma_f32_16x16x32_bf16 v[40:43], v[224:227], v[104:107], v[40:43]
    ds_read_b64_tr_b16 v[240:241], v4 offset:17152
    v_lshrrev_b32 v20, 4, v1
    v_lshlrev_b32 v21, 4, v20
    s_lshl_b32 s16, s2, 8
    s_add_u32 s16, s16, 0x550000
    buffer_load_dwordx4 v[136:139], v21, s[8:11], s16 offen offset:0 sc1
    buffer_load_dwordx4 v[140:143], v21, s[8:11], s16 offen offset:64 sc1
    buffer_load_dwordx4 v[144:147], v21, s[8:11], s16 offen offset:128 sc1
    buffer_load_dwordx4 v[148:151], v21, s[8:11], s16 offen offset:192 sc1
    v_lshlrev_b32 v11, 11, v20
    v_xor_b32 v20, s3, v20
    v_and_b32 v20, 1, v20
    v_lshl_add_u32 v11, v20, 5, v11
    v_bfe_u32 v20, v1, 2, 2
    v_lshl_add_u32 v11, v20, 6, v11
    v_and_b32 v20, 3, v1
    v_lshl_add_u32 v11, v20, 3, v11
    s_lshr_b32 s16, s3, 1
    s_lshl_b32 s16, s16, 8
    s_add_u32 s16, s16, 65536
    v_add_u32 v11, s16, v11
    v_mfma_f32_16x16x32_bf16 v[44:47], v[224:227], v[108:111], v[44:47]
    ds_read_b64_tr_b16 v[242:243], v4 offset:18176
    s_waitcnt lgkmcnt(6)
    v_mfma_f32_16x16x32_bf16 v[48:51], v[228:231], v[104:107], v[48:51]
    ds_read_b64_tr_b16 v[244:245], v5 offset:17184
    v_mfma_f32_16x16x32_bf16 v[52:55], v[228:231], v[108:111], v[52:55]
    ds_read_b64_tr_b16 v[246:247], v5 offset:18208
    s_waitcnt lgkmcnt(6)
    v_mfma_f32_16x16x32_bf16 v[56:59], v[232:235], v[104:107], v[56:59]
    ds_read_b64_tr_b16 v[224:225], v4 offset:24576
    v_mfma_f32_16x16x32_bf16 v[60:63], v[232:235], v[108:111], v[60:63]
    ds_read_b64_tr_b16 v[226:227], v4 offset:25600
    s_waitcnt lgkmcnt(6)
    v_mfma_f32_16x16x32_bf16 v[64:67], v[236:239], v[104:107], v[64:67]
    ds_read_b64_tr_b16 v[228:229], v5 offset:24608
    v_mfma_f32_16x16x32_bf16 v[68:71], v[236:239], v[108:111], v[68:71]
    ds_read_b64_tr_b16 v[230:231], v5 offset:25632
    s_mov_b32 s23, 0xf800
    buffer_load_dwordx4 v[92:95], v7, s[8:11], s23 offen offset:0 sc1
    s_waitcnt lgkmcnt(6)
    v_mfma_f32_16x16x32_bf16 v[72:75], v[240:243], v[104:107], v[72:75]
    ds_read_b64_tr_b16 v[232:233], v4 offset:24832
    v_mfma_f32_16x16x32_bf16 v[76:79], v[240:243], v[108:111], v[76:79]
    ds_read_b64_tr_b16 v[234:235], v4 offset:25856
    s_waitcnt lgkmcnt(6)
    v_mfma_f32_16x16x32_bf16 v[80:83], v[244:247], v[104:107], v[80:83]
    ds_read_b64_tr_b16 v[236:237], v5 offset:24864
    v_mfma_f32_16x16x32_bf16 v[84:87], v[244:247], v[108:111], v[84:87]
    ds_read_b64_tr_b16 v[238:239], v5 offset:25888
    s_waitcnt vmcnt(18) lgkmcnt(6)
    v_mfma_f32_16x16x32_bf16 v[24:27], v[224:227], v[112:115], v[24:27]
    ds_read_b64_tr_b16 v[240:241], v4 offset:25088
    s_add_u32 s22, s21, 0x4000
    s_add_u32 m0, s20, 0x1c000
    s_nop 0
    buffer_load_dwordx4 v2, s[8:11], s22 offen sc1 lds
    s_waitcnt vmcnt(16)
    v_mfma_f32_16x16x32_bf16 v[28:31], v[224:227], v[116:119], v[28:31]
    ds_read_b64_tr_b16 v[242:243], v4 offset:26112
    s_waitcnt lgkmcnt(6)
    v_mfma_f32_16x16x32_bf16 v[32:35], v[228:231], v[112:115], v[32:35]
    ds_read_b64_tr_b16 v[244:245], v5 offset:25120
    v_mfma_f32_16x16x32_bf16 v[36:39], v[228:231], v[116:119], v[36:39]
    ds_read_b64_tr_b16 v[246:247], v5 offset:26144
    s_mov_b32 s23, 0x7800
    buffer_load_dwordx4 v[96:99], v7, s[8:11], s23 offen offset:1024 sc1
    s_waitcnt lgkmcnt(6)
    v_mfma_f32_16x16x32_bf16 v[40:43], v[232:235], v[112:115], v[40:43]
    ds_read_b64_tr_b16 v[224:225], v4 offset:25344
    s_add_u32 s22, s21, 0x4400
    s_add_u32 m0, s20, 0x1c400
    s_nop 0
    buffer_load_dwordx4 v2, s[8:11], s22 offen sc1 lds
    v_mfma_f32_16x16x32_bf16 v[44:47], v[232:235], v[116:119], v[44:47]
    ds_read_b64_tr_b16 v[226:227], v4 offset:26368
    s_waitcnt lgkmcnt(6)
    v_mfma_f32_16x16x32_bf16 v[48:51], v[236:239], v[112:115], v[48:51]
    ds_read_b64_tr_b16 v[228:229], v5 offset:25376
    v_mfma_f32_16x16x32_bf16 v[52:55], v[236:239], v[116:119], v[52:55]
    ds_read_b64_tr_b16 v[230:231], v5 offset:26400
    s_waitcnt lgkmcnt(6)
    v_mfma_f32_16x16x32_bf16 v[56:59], v[240:243], v[112:115], v[56:59]
    v_mfma_f32_16x16x32_bf16 v[60:63], v[240:243], v[116:119], v[60:63]
    s_waitcnt vmcnt(17)
    s_barrier
    ds_read_b64_tr_b16 v[232:233], v4 offset:32768
    ds_read_b64_tr_b16 v[234:235], v4 offset:33792
    s_waitcnt lgkmcnt(6)
    v_mfma_f32_16x16x32_bf16 v[64:67], v[244:247], v[112:115], v[64:67]
    ds_read_b64_tr_b16 v[236:237], v5 offset:32800
    v_mfma_f32_16x16x32_bf16 v[68:71], v[244:247], v[116:119], v[68:71]
    ds_read_b64_tr_b16 v[238:239], v5 offset:33824
    s_mov_b32 s23, 0xf800
    buffer_load_dwordx4 v[100:103], v7, s[8:11], s23 offen offset:1024 sc1
    s_waitcnt lgkmcnt(6)
    v_mfma_f32_16x16x32_bf16 v[72:75], v[224:227], v[112:115], v[72:75]
    ds_read_b64_tr_b16 v[240:241], v4 offset:33024
    v_mfma_f32_16x16x32_bf16 v[76:79], v[224:227], v[116:119], v[76:79]
    ds_read_b64_tr_b16 v[242:243], v4 offset:34048
    s_waitcnt lgkmcnt(6)
    v_mfma_f32_16x16x32_bf16 v[80:83], v[228:231], v[112:115], v[80:83]
    ds_read_b64_tr_b16 v[244:245], v5 offset:33056
    v_mfma_f32_16x16x32_bf16 v[84:87], v[228:231], v[116:119], v[84:87]
    ds_read_b64_tr_b16 v[246:247], v5 offset:34080
    s_waitcnt vmcnt(17) lgkmcnt(6)
    v_mfma_f32_16x16x32_bf16 v[24:27], v[232:235], v[120:123], v[24:27]
    ds_read_b64_tr_b16 v[224:225], v4 offset:33280
    s_waitcnt vmcnt(16)
    v_mfma_f32_16x16x32_bf16 v[28:31], v[232:235], v[124:127], v[28:31]
    ds_read_b64_tr_b16 v[226:227], v4 offset:34304
    s_waitcnt lgkmcnt(6)
    v_mfma_f32_16x16x32_bf16 v[32:35], v[236:239], v[120:123], v[32:35]
    ds_read_b64_tr_b16 v[228:229], v5 offset:33312
    v_mfma_f32_16x16x32_bf16 v[36:39], v[236:239], v[124:127], v[36:39]
    ds_read_b64_tr_b16 v[230:231], v5 offset:34336
    s_waitcnt lgkmcnt(6)
    v_mfma_f32_16x16x32_bf16 v[40:43], v[240:243], v[120:123], v[40:43]
    ds_read_b64_tr_b16 v[232:233], v4 offset:33536
    v_mfma_f32_16x16x32_bf16 v[44:47], v[240:243], v[124:127], v[44:47]
    ds_read_b64_tr_b16 v[234:235], v4 offset:34560
    s_waitcnt lgkmcnt(6)
    v_mfma_f32_16x16x32_bf16 v[48:51], v[244:247], v[120:123], v[48:51]
    ds_read_b64_tr_b16 v[236:237], v5 offset:33568
    v_mfma_f32_16x16x32_bf16 v[52:55], v[244:247], v[124:127], v[52:55]
    ds_read_b64_tr_b16 v[238:239], v5 offset:34592
    s_waitcnt lgkmcnt(6)
    v_mfma_f32_16x16x32_bf16 v[56:59], v[224:227], v[120:123], v[56:59]
    ds_read_b64_tr_b16 v[240:241], v4 offset:40960
    v_mfma_f32_16x16x32_bf16 v[60:63], v[224:227], v[124:127], v[60:63]
    ds_read_b64_tr_b16 v[242:243], v4 offset:41984
    s_waitcnt lgkmcnt(6)
    v_mfma_f32_16x16x32_bf16 v[64:67], v[228:231], v[120:123], v[64:67]
    ds_read_b64_tr_b16 v[244:245], v5 offset:40992
    v_mfma_f32_16x16x32_bf16 v[68:71], v[228:231], v[124:127], v[68:71]
    ds_read_b64_tr_b16 v[246:247], v5 offset:42016
    s_waitcnt lgkmcnt(6)
    v_mfma_f32_16x16x32_bf16 v[72:75], v[232:235], v[120:123], v[72:75]
    ds_read_b64_tr_b16 v[224:225], v4 offset:41216
    v_mfma_f32_16x16x32_bf16 v[76:79], v[232:235], v[124:127], v[76:79]
    ds_read_b64_tr_b16 v[226:227], v4 offset:42240
    s_waitcnt lgkmcnt(6)
    v_mfma_f32_16x16x32_bf16 v[80:83], v[236:239], v[120:123], v[80:83]
    ds_read_b64_tr_b16 v[228:229], v5 offset:41248
    v_mfma_f32_16x16x32_bf16 v[84:87], v[236:239], v[124:127], v[84:87]
    ds_read_b64_tr_b16 v[230:231], v5 offset:42272
    s_waitcnt vmcnt(14) lgkmcnt(6)
    v_mfma_f32_16x16x32_bf16 v[24:27], v[240:243], v[128:131], v[24:27]
    ds_read_b64_tr_b16 v[232:233], v4 offset:41472
    s_waitcnt vmcnt(11)
    v_mfma_f32_16x16x32_bf16 v[28:31], v[240:243], v[132:135], v[28:31]
    ds_read_b64_tr_b16 v[234:235], v4 offset:42496
    s_waitcnt lgkmcnt(6)
    v_mfma_f32_16x16x32_bf16 v[32:35], v[244:247], v[128:131], v[32:35]
    ds_read_b64_tr_b16 v[236:237], v5 offset:41504
    v_mfma_f32_16x16x32_bf16 v[36:39], v[244:247], v[132:135], v[36:39]
    ds_read_b64_tr_b16 v[238:239], v5 offset:42528
    s_waitcnt lgkmcnt(6)
    v_mfma_f32_16x16x32_bf16 v[40:43], v[224:227], v[128:131], v[40:43]
    ds_read_b64_tr_b16 v[240:241], v4 offset:41728
    v_mfma_f32_16x16x32_bf16 v[44:47], v[224:227], v[132:135], v[44:47]
    ds_read_b64_tr_b16 v[242:243], v4 offset:42752
    s_waitcnt lgkmcnt(6)
    v_mfma_f32_16x16x32_bf16 v[48:51], v[228:231], v[128:131], v[48:51]
    ds_read_b64_tr_b16 v[244:245], v5 offset:41760
    v_mfma_f32_16x16x32_bf16 v[52:55], v[228:231], v[132:135], v[52:55]
    ds_read_b64_tr_b16 v[246:247], v5 offset:42784
    s_waitcnt lgkmcnt(6)
    v_mfma_f32_16x16x32_bf16 v[56:59], v[232:235], v[128:131], v[56:59]
    v_mfma_f32_16x16x32_bf16 v[60:63], v[232:235], v[132:135], v[60:63]
    s_waitcnt vmcnt(10)
    s_barrier
    ds_read_b64_tr_b16 v[224:225], v4 offset:49152
    ds_read_b64_tr_b16 v[226:227], v4 offset:50176
    s_waitcnt lgkmcnt(6)
    v_mfma_f32_16x16x32_bf16 v[64:67], v[236:239], v[128:131], v[64:67]
    ds_read_b64_tr_b16 v[228:229], v5 offset:49184
    v_mfma_f32_16x16x32_bf16 v[68:71], v[236:239], v[132:135], v[68:71]
    ds_read_b64_tr_b16 v[230:231], v5 offset:50208
    s_waitcnt lgkmcnt(6)
    v_mfma_f32_16x16x32_bf16 v[72:75], v[240:243], v[128:131], v[72:75]
    ds_read_b64_tr_b16 v[232:233], v4 offset:49408
    v_mfma_f32_16x16x32_bf16 v[76:79], v[240:243], v[132:135], v[76:79]
    ds_read_b64_tr_b16 v[234:235], v4 offset:50432
    s_waitcnt lgkmcnt(6)
    v_mfma_f32_16x16x32_bf16 v[80:83], v[244:247], v[128:131], v[80:83]
    ds_read_b64_tr_b16 v[236:237], v5 offset:49440
    v_mfma_f32_16x16x32_bf16 v[84:87], v[244:247], v[132:135], v[84:87]
    ds_read_b64_tr_b16 v[238:239], v5 offset:50464
    s_waitcnt vmcnt(9) lgkmcnt(6)
    v_mfma_f32_16x16x32_bf16 v[24:27], v[224:227], v[88:91], v[24:27]
    ds_read_b64_tr_b16 v[240:241], v4 offset:49664
    s_waitcnt vmcnt(4)
    v_mfma_f32_16x16x32_bf16 v[28:31], v[224:227], v[92:95], v[28:31]
    ds_read_b64_tr_b16 v[242:243], v4 offset:50688
    s_waitcnt lgkmcnt(6)
    v_mfma_f32_16x16x32_bf16 v[32:35], v[228:231], v[88:91], v[32:35]
    ds_read_b64_tr_b16 v[244:245], v5 offset:49696
    v_mfma_f32_16x16x32_bf16 v[36:39], v[228:231], v[92:95], v[36:39]
    ds_read_b64_tr_b16 v[246:247], v5 offset:50720
    s_waitcnt lgkmcnt(6)
    v_mfma_f32_16x16x32_bf16 v[40:43], v[232:235], v[88:91], v[40:43]
    ds_read_b64_tr_b16 v[224:225], v4 offset:49920
    v_mfma_f32_16x16x32_bf16 v[44:47], v[232:235], v[92:95], v[44:47]
    ds_read_b64_tr_b16 v[226:227], v4 offset:50944
    s_waitcnt lgkmcnt(6)
    v_mfma_f32_16x16x32_bf16 v[48:51], v[236:239], v[88:91], v[48:51]
    ds_read_b64_tr_b16 v[228:229], v5 offset:49952
    v_mfma_f32_16x16x32_bf16 v[52:55], v[236:239], v[92:95], v[52:55]
    ds_read_b64_tr_b16 v[230:231], v5 offset:50976
    s_waitcnt lgkmcnt(6)
    v_mfma_f32_16x16x32_bf16 v[56:59], v[240:243], v[88:91], v[56:59]
    ds_read_b64_tr_b16 v[232:233], v4 offset:57344
    v_mfma_f32_16x16x32_bf16 v[60:63], v[240:243], v[92:95], v[60:63]
    ds_read_b64_tr_b16 v[234:235], v4 offset:58368
    s_waitcnt lgkmcnt(6)
    v_mfma_f32_16x16x32_bf16 v[64:67], v[244:247], v[88:91], v[64:67]
    ds_read_b64_tr_b16 v[236:237], v5 offset:57376
    v_mfma_f32_16x16x32_bf16 v[68:71], v[244:247], v[92:95], v[68:71]
    ds_read_b64_tr_b16 v[238:239], v5 offset:58400
    s_waitcnt lgkmcnt(6)
    v_mfma_f32_16x16x32_bf16 v[72:75], v[224:227], v[88:91], v[72:75]
    ds_read_b64_tr_b16 v[240:241], v4 offset:57600
    v_mfma_f32_16x16x32_bf16 v[76:79], v[224:227], v[92:95], v[76:79]
    ds_read_b64_tr_b16 v[242:243], v4 offset:58624
    s_waitcnt lgkmcnt(6)
    v_mfma_f32_16x16x32_bf16 v[80:83], v[228:231], v[88:91], v[80:83]
    ds_read_b64_tr_b16 v[244:245], v5 offset:57632
    v_mfma_f32_16x16x32_bf16 v[84:87], v[228:231], v[92:95], v[84:87]
    ds_read_b64_tr_b16 v[246:247], v5 offset:58656
    s_waitcnt vmcnt(2) lgkmcnt(6)
    v_mfma_f32_16x16x32_bf16 v[24:27], v[232:235], v[96:99], v[24:27]
    ds_read_b64_tr_b16 v[224:225], v4 offset:57856
    s_waitcnt vmcnt(0)
    v_mfma_f32_16x16x32_bf16 v[28:31], v[232:235], v[100:103], v[28:31]
    ds_read_b64_tr_b16 v[226:227], v4 offset:58880
    s_waitcnt lgkmcnt(6)
    v_mfma_f32_16x16x32_bf16 v[32:35], v[236:239], v[96:99], v[32:35]
    ds_read_b64_tr_b16 v[228:229], v5 offset:57888
    v_mfma_f32_16x16x32_bf16 v[36:39], v[236:239], v[100:103], v[36:39]
    ds_read_b64_tr_b16 v[230:231], v5 offset:58912
    s_waitcnt lgkmcnt(6)
    v_mfma_f32_16x16x32_bf16 v[40:43], v[240:243], v[96:99], v[40:43]
    ds_read_b64_tr_b16 v[232:233], v4 offset:58112
    v_mfma_f32_16x16x32_bf16 v[44:47], v[240:243], v[100:103], v[44:47]
    ds_read_b64_tr_b16 v[234:235], v4 offset:59136
    s_waitcnt lgkmcnt(6)
    v_mfma_f32_16x16x32_bf16 v[48:51], v[244:247], v[96:99], v[48:51]
    ds_read_b64_tr_b16 v[236:237], v5 offset:58144
    v_mfma_f32_16x16x32_bf16 v[52:55], v[244:247], v[100:103], v[52:55]
    ds_read_b64_tr_b16 v[238:239], v5 offset:59168
    s_waitcnt lgkmcnt(6)
    v_mfma_f32_16x16x32_bf16 v[56:59], v[224:227], v[96:99], v[56:59]
    v_mfma_f32_16x16x32_bf16 v[60:63], v[224:227], v[100:103], v[60:63]
    s_waitcnt lgkmcnt(4)
    v_mfma_f32_16x16x32_bf16 v[64:67], v[228:231], v[96:99], v[64:67]
    v_mfma_f32_16x16x32_bf16 v[68:71], v[228:231], v[100:103], v[68:71]
    s_waitcnt lgkmcnt(2)
    v_mfma_f32_16x16x32_bf16 v[72:75], v[232:235], v[96:99], v[72:75]
    v_mfma_f32_16x16x32_bf16 v[76:79], v[232:235], v[100:103], v[76:79]
    s_waitcnt lgkmcnt(0)
    v_mfma_f32_16x16x32_bf16 v[80:83], v[236:239], v[96:99], v[80:83]
    v_mfma_f32_16x16x32_bf16 v[84:87], v[236:239], v[100:103], v[84:87]
    s_barrier
    s_add_u32 s22, s21, 0x8000
    s_add_u32 m0, s20, 0x20000
    s_nop 0
    buffer_load_dwordx4 v2, s[8:11], s22 offen sc1 lds
    s_add_u32 s22, s21, 0x8400
    s_add_u32 m0, s20, 0x20400
    s_nop 0
    buffer_load_dwordx4 v2, s[8:11], s22 offen sc1 lds
    s_add_u32 s22, s21, 0xc000
    s_add_u32 m0, s20, 0x24000
    s_nop 0
    buffer_load_dwordx4 v2, s[8:11], s22 offen sc1 lds
    s_add_u32 s22, s21, 0xc400
    s_add_u32 m0, s20, 0x24400
    s_nop 0
    buffer_load_dwordx4 v2, s[8:11], s22 offen sc1 lds
    ds_read_b64_tr_b16 v[88:89], v11 offset:0
    ds_read_b64_tr_b16 v[90:91], v11 offset:1024
    ds_read_b64_tr_b16 v[92:93], v11 offset:8192
    ds_read_b64_tr_b16 v[94:95], v11 offset:9216
    ds_read_b64_tr_b16 v[96:97], v11 offset:16384
    ds_read_b64_tr_b16 v[98:99], v11 offset:17408
    ds_read_b64_tr_b16 v[100:101], v11 offset:24576
    ds_read_b64_tr_b16 v[102:103], v11 offset:25600
    s_mov_b32 s23, 0x3e0293ee
    v_mul_f32 v24, s23, v24
    v_mul_f32 v25, s23, v25
    v_mul_f32 v26, s23, v26
    v_mul_f32 v27, s23, v27
    v_mul_f32 v28, s23, v28
    v_mul_f32 v29, s23, v29
    v_mul_f32 v30, s23, v30
    v_mul_f32 v31, s23, v31
    v_mul_f32 v32, s23, v32
    v_mul_f32 v33, s23, v33
    v_mul_f32 v34, s23, v34
    v_mul_f32 v35, s23, v35
    v_mul_f32 v36, s23, v36
    v_mul_f32 v37, s23, v37
    v_mul_f32 v38, s23, v38
    v_mul_f32 v39, s23, v39
    v_cvt_pk_bf16_f32 v152, v24, v25
    v_cvt_pk_bf16_f32 v153, v26, v27
    v_cvt_pk_bf16_f32 v168, v28, v29
    v_cvt_pk_bf16_f32 v169, v30, v31
    v_cvt_pk_bf16_f32 v154, v32, v33
    v_cvt_pk_bf16_f32 v155, v34, v35
    v_cvt_pk_bf16_f32 v170, v36, v37
    v_cvt_pk_bf16_f32 v171, v38, v39
    s_waitcnt lgkmcnt(6)
    v_mfma_f32_16x16x32_bf16 v[104:107], v[88:91], v[136:139], 0
    s_waitcnt lgkmcnt(4)
    v_mfma_f32_16x16x32_bf16 v[104:107], v[92:95], v[140:143], v[104:107]
    s_waitcnt lgkmcnt(2)
    v_mfma_f32_16x16x32_bf16 v[104:107], v[96:99], v[144:147], v[104:107]
    s_waitcnt lgkmcnt(0)
    v_mfma_f32_16x16x32_bf16 v[104:107], v[100:103], v[148:151], v[104:107]
    v_add_u32 v4, 0x10000, v2
    v_add_u32 v5, 0x20000, v2
    s_barrier
    ds_read_b128 v[224:227], v4 offset:32768
    ds_read_b128 v[228:231], v4 offset:33792
    ds_read_b128 v[232:235], v4 offset:34816
    ds_read_b128 v[236:239], v4 offset:35840
    v_mov_b32 v12, 0x3f803f80
    v_mov_b32 v13, 0x3f803f80
    v_mov_b32 v14, 0x3f803f80
    v_mov_b32 v15, 0x3f803f80
    s_waitcnt lgkmcnt(3)
    v_mfma_f32_16x16x32_bf16 v[184:187], v[224:227], v[152:155], 0
    v_mul_f32 v40, s23, v40
    v_mul_f32 v41, s23, v41
    v_mul_f32 v42, s23, v42
    v_mul_f32 v43, s23, v43
    v_mul_f32 v44, s23, v44
    v_mul_f32 v45, s23, v45
    v_lshrrev_b32 v20, 4, v1
    v_lshlrev_b32 v20, 4, v20
    s_lshr_b32 s16, s2, 5
    s_lshl_b32 s16, s16, 14
    s_and_b32 s17, s2, 31
    s_lshl_b32 s17, s17, 9
    s_add_u32 s16, s16, s17
    s_lshl_b32 s17, s3, 6
    s_add_u32 s16, s16, s17
    s_add_u32 s16, s16, 0x580000
    s_mov_b32 exec_lo, 0x10001
    s_mov_b32 exec_hi, 0x10001
    buffer_store_dwordx4 v[104:107], v20, s[8:11], s16 offen sc1
    s_mov_b64 exec, -1
    v_mfma_f32_16x16x32_bf16 v[188:191], v[224:227], v[168:171], 0
    ds_read_b128 v[240:243], v4 offset:36864
    v_mul_f32 v46, s23, v46
    v_mul_f32 v47, s23, v47
    v_mul_f32 v48, s23, v48
    v_mul_f32 v49, s23, v49
    v_mul_f32 v50, s23, v50
    v_mul_f32 v51, s23, v51
    s_mov_b64 s[64:65], s[46:47]
    s_mov_b32 s66, 0x700000
    s_mov_b32 s67, 0x20000
    s_mov_b64 s[68:69], s[48:49]
    s_mov_b32 s70, 0x700000
    s_mov_b32 s71, 0x20000
    s_cmp_lt_u32 s2, 224
    s_cselect_b32 s66, 7340032, 0
    s_cselect_b32 s70, 7340032, 0
    s_and_b32 s29, s2, 7
    s_mul_i32 s29, s29, 28
    s_lshr_b32 s16, s2, 3
    s_add_u32 s29, s29, s16
    s_sub_u32 s16, s3, 4
    v_lshrrev_b32 v20, 3, v1
    v_lshlrev_b32 v20, 3, v20
    s_lshl_b32 s17, s16, 6
    v_add_u32 v20, s17, v20
    s_mov_b32 s17, 7168
    v_mul_lo_u32 v11, s17, v20
    v_and_b32 v20, 7, v1
    v_lshl_add_u32 v11, v20, 4, v11
    s_and_b32 s17, s29, 3
    s_mul_i32 s18, s17, 1835008
    s_lshr_b32 s17, s29, 2
    s_lshl_b32 s17, s17, 7
    s_add_u32 s18, s18, s17
    s_lshl_b32 s15, s16, 13
    s_waitcnt lgkmcnt(3)
    v_mfma_f32_16x16x32_bf16 v[192:195], v[228:231], v[152:155], 0
    s_add_u32 s22, s21, 0x10000
    s_add_u32 m0, s20, 0x10000
    s_nop 0
    buffer_load_dwordx4 v2, s[8:11], s22 offen sc1 lds
    v_mul_f32 v52, s23, v52
    v_mul_f32 v53, s23, v53
    v_mul_f32 v54, s23, v54
    v_mul_f32 v55, s23, v55
    v_cvt_pk_bf16_f32 v156, v40, v41
    v_cvt_pk_bf16_f32 v157, v42, v43
    v_mfma_f32_16x16x32_bf16 v[196:199], v[228:231], v[168:171], 0
    ds_read_b128 v[244:247], v4 offset:37888
    v_cvt_pk_bf16_f32 v172, v44, v45
    v_cvt_pk_bf16_f32 v173, v46, v47
    v_cvt_pk_bf16_f32 v158, v48, v49
    v_cvt_pk_bf16_f32 v159, v50, v51
    v_cvt_pk_bf16_f32 v174, v52, v53
    v_cvt_pk_bf16_f32 v175, v54, v55
    s_waitcnt lgkmcnt(3)
    v_mfma_f32_16x16x32_bf16 v[184:187], v[232:235], v[156:159], v[184:187]
    v_mul_f32 v56, s23, v56
    v_mul_f32 v57, s23, v57
    v_mul_f32 v58, s23, v58
    v_mul_f32 v59, s23, v59
    v_mul_f32 v60, s23, v60
    v_mul_f32 v61, s23, v61
    v_mfma_f32_16x16x32_bf16 v[188:191], v[232:235], v[172:175], v[188:191]
    ds_read_b128 v[224:227], v4 offset:38912
    v_mul_f32 v62, s23, v62
    v_mul_f32 v63, s23, v63
    v_mul_f32 v64, s23, v64
    v_mul_f32 v65, s23, v65
    v_mul_f32 v66, s23, v66
    v_mul_f32 v67, s23, v67
    s_waitcnt lgkmcnt(3)
    v_mfma_f32_16x16x32_bf16 v[192:195], v[236:239], v[156:159], v[192:195]
    v_mul_f32 v68, s23, v68
    v_mul_f32 v69, s23, v69
    v_mul_f32 v70, s23, v70
    v_mul_f32 v71, s23, v71
    v_cvt_pk_bf16_f32 v160, v56, v57
    v_cvt_pk_bf16_f32 v161, v58, v59
    v_mfma_f32_16x16x32_bf16 v[196:199], v[236:239], v[172:175], v[196:199]
    ds_read_b128 v[228:231], v4 offset:39936
    v_cvt_pk_bf16_f32 v176, v60, v61
    v_cvt_pk_bf16_f32 v177, v62, v63
    v_cvt_pk_bf16_f32 v162, v64, v65
    v_cvt_pk_bf16_f32 v163, v66, v67
    v_cvt_pk_bf16_f32 v178, v68, v69
    v_cvt_pk_bf16_f32 v179, v70, v71
    s_waitcnt lgkmcnt(3)
    v_mfma_f32_16x16x32_bf16 v[184:187], v[240:243], v[160:163], v[184:187]
    v_mul_f32 v72, s23, v72
    v_mul_f32 v73, s23, v73
    v_mul_f32 v74, s23, v74
    v_mul_f32 v75, s23, v75
    v_mul_f32 v76, s23, v76
    v_mul_f32 v77, s23, v77
    v_mfma_f32_16x16x32_bf16 v[188:191], v[240:243], v[176:179], v[188:191]
    ds_read_b128 v[232:235], v4 offset:40960
    v_mul_f32 v78, s23, v78
    v_mul_f32 v79, s23, v79
    v_mul_f32 v80, s23, v80
    v_mul_f32 v81, s23, v81
    v_mul_f32 v82, s23, v82
    v_mul_f32 v83, s23, v83
    s_waitcnt lgkmcnt(3)
    v_mfma_f32_16x16x32_bf16 v[192:195], v[244:247], v[160:163], v[192:195]
    s_add_u32 s22, s21, 0x10400
    s_add_u32 m0, s20, 0x10400
    s_nop 0
    buffer_load_dwordx4 v2, s[8:11], s22 offen sc1 lds
    v_mul_f32 v84, s23, v84
    v_mul_f32 v85, s23, v85
    v_mul_f32 v86, s23, v86
    v_mul_f32 v87, s23, v87
    v_cvt_pk_bf16_f32 v164, v72, v73
    v_cvt_pk_bf16_f32 v165, v74, v75
    v_mfma_f32_16x16x32_bf16 v[196:199], v[244:247], v[176:179], v[196:199]
    ds_read_b128 v[236:239], v4 offset:41984
    v_cvt_pk_bf16_f32 v180, v76, v77
    v_cvt_pk_bf16_f32 v181, v78, v79
    v_cvt_pk_bf16_f32 v166, v80, v81
    v_cvt_pk_bf16_f32 v167, v82, v83
    v_cvt_pk_bf16_f32 v182, v84, v85
    v_cvt_pk_bf16_f32 v183, v86, v87
    s_waitcnt lgkmcnt(3)
    v_mfma_f32_16x16x32_bf16 v[184:187], v[224:227], v[164:167], v[184:187]
    v_mfma_f32_16x16x32_bf16 v[188:191], v[224:227], v[180:183], v[188:191]
    ds_read_b128 v[240:243], v4 offset:43008
    s_waitcnt lgkmcnt(3)
    v_mfma_f32_16x16x32_bf16 v[192:195], v[228:231], v[164:167], v[192:195]
    v_mfma_f32_16x16x32_bf16 v[196:199], v[228:231], v[180:183], v[196:199]
    ds_read_b128 v[244:247], v4 offset:44032
    s_waitcnt lgkmcnt(3)
    v_mfma_f32_16x16x32_bf16 v[200:203], v[232:235], v[152:155], 0
    v_mfma_f32_16x16x32_bf16 v[204:207], v[232:235], v[168:171], 0
    ds_read_b128 v[224:227], v4 offset:45056
    s_waitcnt lgkmcnt(3)
    v_mfma_f32_16x16x32_bf16 v[208:211], v[236:239], v[152:155], 0
    v_mfma_f32_16x16x32_bf16 v[212:215], v[236:239], v[168:171], 0
    ds_read_b128 v[228:231], v4 offset:46080
    s_waitcnt lgkmcnt(3)
    v_mfma_f32_16x16x32_bf16 v[200:203], v[240:243], v[156:159], v[200:203]
    v_mfma_f32_16x16x32_bf16 v[204:207], v[240:243], v[172:175], v[204:207]
    ds_read_b128 v[232:235], v4 offset:47104
    s_waitcnt lgkmcnt(3)
    v_mfma_f32_16x16x32_bf16 v[208:211], v[244:247], v[156:159], v[208:211]
    v_max3_f32 v16, v184, v185, v186
    v_mfma_f32_16x16x32_bf16 v[212:215], v[244:247], v[172:175], v[212:215]
    ds_read_b128 v[236:239], v4 offset:48128
    v_max3_f32 v16, v16, v187, v192
    s_waitcnt lgkmcnt(3)
    v_mfma_f32_16x16x32_bf16 v[200:203], v[224:227], v[160:163], v[200:203]
    v_max3_f32 v16, v16, v193, v194
    v_mfma_f32_16x16x32_bf16 v[204:207], v[224:227], v[176:179], v[204:207]
    s_barrier
    ds_read_b128 v[240:243], v4 offset:49152
    v_max_f32 v16, v16, v195
    s_waitcnt lgkmcnt(3)
    v_mfma_f32_16x16x32_bf16 v[208:211], v[228:231], v[160:163], v[208:211]
    v_max3_f32 v17, v188, v189, v190
    v_mfma_f32_16x16x32_bf16 v[212:215], v[228:231], v[176:179], v[212:215]
    s_add_u32 s22, s21, 0x14000
    s_add_u32 m0, s20, 0x14000
    s_nop 0
    buffer_load_dwordx4 v2, s[8:11], s22 offen sc1 lds
    ds_read_b128 v[244:247], v4 offset:50176
    v_max3_f32 v17, v17, v191, v196
    s_waitcnt lgkmcnt(3)
    v_mfma_f32_16x16x32_bf16 v[200:203], v[232:235], v[164:167], v[200:203]
    v_max3_f32 v17, v17, v197, v198
    v_mfma_f32_16x16x32_bf16 v[204:207], v[232:235], v[180:183], v[204:207]
    ds_read_b128 v[224:227], v4 offset:51200
    v_max_f32 v17, v17, v199
    s_waitcnt lgkmcnt(3)
    v_mfma_f32_16x16x32_bf16 v[208:211], v[236:239], v[164:167], v[208:211]
    s_mov_b64 s[72:73], s[40:41]
    s_mov_b32 s74, 0x800000
    s_mov_b32 s75, 0x20000
    v_lshlrev_b32 v21, 7, v1
    s_lshl_b32 s16, s2, 2
    s_add_u32 s16, s16, s3
    s_sub_u32 s16, s16, 4
    s_lshl_b32 s16, s16, 13
    buffer_load_dword v7, v21, s[72:75], s16 offen
    v_mfma_f32_16x16x32_bf16 v[212:215], v[236:239], v[180:183], v[212:215]
    ds_read_b128 v[228:231], v4 offset:52224
    v_max3_f32 v16, v16, v200, v201
    v_max3_f32 v16, v16, v202, v203
    v_max3_f32 v16, v16, v208, v209
    v_max3_f32 v16, v16, v210, v211
    v_max3_f32 v17, v17, v204, v205
    v_max3_f32 v17, v17, v206, v207
    s_nop 0
    v_max3_f32 v17, v17, v212, v213
    v_max3_f32 v17, v17, v214, v215
    v_mov_b32 v18, v16
    v_mov_b32 v19, v17
    s_nop 0
    v_permlane16_swap_b32 v16, v18
    v_permlane16_swap_b32 v17, v19
    v_max_f32 v16, v16, v18
    v_max_f32 v17, v17, v19
    v_mov_b32 v18, v16
    v_mov_b32 v19, v17
    s_nop 0
    v_permlane32_swap_b32 v16, v18
    v_permlane32_swap_b32 v17, v19
    v_max_f32 v16, v16, v18
    v_max_f32 v17, v17, v19
    v_sub_f32 v216, 0, v16
    v_sub_f32 v217, 0, v16
    v_sub_f32 v218, 0, v16
    v_sub_f32 v219, 0, v16
    v_sub_f32 v220, 0, v17
    v_sub_f32 v221, 0, v17
    v_sub_f32 v222, 0, v17
    v_sub_f32 v223, 0, v17
    v_add_f32 v184, v184, v216
    v_add_f32 v185, v185, v216
    v_exp_f32 v184, v184
    v_exp_f32 v185, v185
    s_nop 0
    v_cvt_pk_bf16_f32 v24, v184, v185
    v_add_f32 v186, v186, v216
    v_add_f32 v187, v187, v216
    v_exp_f32 v186, v186
    v_exp_f32 v187, v187
    s_nop 0
    v_cvt_pk_bf16_f32 v25, v186, v187
    v_add_f32 v188, v188, v220
    v_add_f32 v189, v189, v220
    v_exp_f32 v188, v188
    v_exp_f32 v189, v189
    s_nop 0
    v_cvt_pk_bf16_f32 v28, v188, v189
    v_add_f32 v190, v190, v220
    v_add_f32 v191, v191, v220
    v_exp_f32 v190, v190
    v_exp_f32 v191, v191
    s_nop 0
    v_cvt_pk_bf16_f32 v29, v190, v191
    v_add_f32 v192, v192, v216
    v_add_f32 v193, v193, v216
    v_exp_f32 v192, v192
    v_exp_f32 v193, v193
    s_nop 0
    v_cvt_pk_bf16_f32 v26, v192, v193
    v_add_f32 v194, v194, v216
    v_add_f32 v195, v195, v216
    v_exp_f32 v194, v194
    v_exp_f32 v195, v195
    s_nop 0
    v_cvt_pk_bf16_f32 v27, v194, v195
    v_add_f32 v196, v196, v220
    v_add_f32 v197, v197, v220
    v_exp_f32 v196, v196
    v_exp_f32 v197, v197
    s_nop 0
    v_cvt_pk_bf16_f32 v30, v196, v197
    v_add_f32 v198, v198, v220
    v_add_f32 v199, v199, v220
    v_exp_f32 v198, v198
    v_exp_f32 v199, v199
    s_nop 0
    v_cvt_pk_bf16_f32 v31, v198, v199
    s_waitcnt lgkmcnt(3)
    v_mfma_f32_16x16x32_bf16 v[184:187], v[240:243], v[152:155], v[216:219]
    v_mfma_f32_16x16x32_bf16 v[188:191], v[240:243], v[168:171], v[220:223]
    ds_read_b128 v[232:235], v4 offset:53248
    v_add_f32 v200, v200, v216
    v_add_f32 v201, v201, v216
    v_exp_f32 v200, v200
    v_mfma_f32_16x16x32_bf16 v[248:251], v[12:15], v[24:27], 0
    s_waitcnt lgkmcnt(3)
    v_mfma_f32_16x16x32_bf16 v[192:195], v[244:247], v[152:155], v[216:219]
    v_exp_f32 v201, v201
    s_nop 0
    v_cvt_pk_bf16_f32 v32, v200, v201
    v_add_f32 v202, v202, v216
    v_mfma_f32_16x16x32_bf16 v[196:199], v[244:247], v[168:171], v[220:223]
    s_add_u32 s22, s21, 0x14400
    s_add_u32 m0, s20, 0x14400
    s_nop 0
    buffer_load_dwordx4 v2, s[8:11], s22 offen sc1 lds
    ds_read_b128 v[236:239], v4 offset:54272
    v_add_f32 v203, v203, v216
    v_exp_f32 v202, v202
    v_mfma_f32_16x16x32_bf16 v[252:255], v[12:15], v[28:31], 0
    s_waitcnt lgkmcnt(3)
    v_mfma_f32_16x16x32_bf16 v[184:187], v[224:227], v[156:159], v[184:187]
    v_exp_f32 v203, v203
    s_nop 0
    v_cvt_pk_bf16_f32 v33, v202, v203
    v_add_f32 v204, v204, v220
    v_mfma_f32_16x16x32_bf16 v[188:191], v[224:227], v[172:175], v[188:191]
    ds_read_b128 v[240:243], v4 offset:55296
    v_add_f32 v205, v205, v220
    v_exp_f32 v204, v204
    v_exp_f32 v205, v205
    s_mov_b64 s[4:5], s[40:41]
    s_mov_b32 s6, 0x800000
    s_mov_b32 s7, 0x20000
    v_bfe_u32 v20, v1, 2, 2
    v_lshlrev_b32 v21, 13, v20
    v_sub_u32 v3, v3, v21
    v_lshl_add_u32 v3, v20, 11, v3
    s_and_b32 s16, s2, 1
    s_lshl_b32 s24, s16, 22
    s_lshr_b32 s16, s2, 5
    s_lshl_b32 s16, s16, 8
    s_add_u32 s24, s24, s16
    s_lshl_b32 s16, s3, 14
    s_add_u32 s24, s24, s16
    s_add_u32 s24, s24, 196608
    s_waitcnt lgkmcnt(3)
    v_mfma_f32_16x16x32_bf16 v[192:195], v[228:231], v[156:159], v[192:195]
    v_cvt_pk_bf16_f32 v36, v204, v205
    v_add_f32 v206, v206, v220
    v_mfma_f32_16x16x32_bf16 v[196:199], v[228:231], v[172:175], v[196:199]
    ds_read_b128 v[244:247], v4 offset:56320
    v_add_f32 v207, v207, v220
    v_exp_f32 v206, v206
    v_exp_f32 v207, v207
    s_waitcnt lgkmcnt(3)
    v_mfma_f32_16x16x32_bf16 v[184:187], v[232:235], v[160:163], v[184:187]
    v_cvt_pk_bf16_f32 v37, v206, v207
    v_add_f32 v208, v208, v216
    v_add_f32 v209, v209, v216
    v_mfma_f32_16x16x32_bf16 v[188:191], v[232:235], v[176:179], v[188:191]
    ds_read_b128 v[224:227], v4 offset:57344
    v_exp_f32 v208, v208
    v_exp_f32 v209, v209
    s_waitcnt lgkmcnt(3)
    v_mfma_f32_16x16x32_bf16 v[192:195], v[236:239], v[160:163], v[192:195]
    v_cvt_pk_bf16_f32 v34, v208, v209
    v_add_f32 v210, v210, v216
    v_add_f32 v211, v211, v216
    v_mfma_f32_16x16x32_bf16 v[196:199], v[236:239], v[176:179], v[196:199]
    ds_read_b128 v[228:231], v4 offset:58368
    v_exp_f32 v210, v210
    v_exp_f32 v211, v211
    s_nop 0
    v_cvt_pk_bf16_f32 v35, v210, v211
    s_waitcnt lgkmcnt(3)
    v_mfma_f32_16x16x32_bf16 v[184:187], v[240:243], v[164:167], v[184:187]
    v_add_f32 v212, v212, v220
    v_add_f32 v213, v213, v220
    v_mfma_f32_16x16x32_bf16 v[188:191], v[240:243], v[180:183], v[188:191]
    ds_read_b128 v[232:235], v4 offset:59392
    v_exp_f32 v212, v212
    v_exp_f32 v213, v213
    s_nop 0
    v_cvt_pk_bf16_f32 v38, v212, v213
    s_waitcnt lgkmcnt(3)
    v_mfma_f32_16x16x32_bf16 v[192:195], v[244:247], v[164:167], v[192:195]
    v_add_f32 v214, v214, v220
    v_add_f32 v215, v215, v220
    v_exp_f32 v214, v214
    v_mfma_f32_16x16x32_bf16 v[196:199], v[244:247], v[180:183], v[196:199]
    ds_read_b128 v[236:239], v4 offset:60416
    v_exp_f32 v215, v215
    s_nop 0
    v_cvt_pk_bf16_f32 v39, v214, v215
    s_waitcnt lgkmcnt(3)
    v_mfma_f32_16x16x32_bf16 v[200:203], v[224:227], v[152:155], v[216:219]
    v_mfma_f32_16x16x32_bf16 v[204:207], v[224:227], v[168:171], v[220:223]
    ds_read_b128 v[240:243], v4 offset:61440
    v_exp_f32 v184, v184
    v_exp_f32 v185, v185
    v_mfma_f32_16x16x32_bf16 v[248:251], v[12:15], v[32:35], v[248:251]
    s_waitcnt lgkmcnt(3)
    v_mfma_f32_16x16x32_bf16 v[208:211], v[228:231], v[152:155], v[216:219]
    v_cvt_pk_bf16_f32 v40, v184, v185
    v_exp_f32 v186, v186
    v_mfma_f32_16x16x32_bf16 v[212:215], v[228:231], v[168:171], v[220:223]
    ds_read_b128 v[244:247], v4 offset:62464
    v_exp_f32 v187, v187
    v_mfma_f32_16x16x32_bf16 v[252:255], v[12:15], v[36:39], v[252:255]
    s_waitcnt lgkmcnt(3)
    v_mfma_f32_16x16x32_bf16 v[200:203], v[232:235], v[156:159], v[200:203]
    v_cvt_pk_bf16_f32 v41, v186, v187
    v_exp_f32 v188, v188
    v_mfma_f32_16x16x32_bf16 v[204:207], v[232:235], v[172:175], v[204:207]
    ds_read_b128 v[224:227], v4 offset:63488
    v_exp_f32 v189, v189
    s_waitcnt lgkmcnt(3)
    v_mfma_f32_16x16x32_bf16 v[208:211], v[236:239], v[156:159], v[208:211]
    v_cvt_pk_bf16_f32 v44, v188, v189
    v_exp_f32 v190, v190
    v_mfma_f32_16x16x32_bf16 v[212:215], v[236:239], v[172:175], v[212:215]
    ds_read_b128 v[228:231], v4 offset:64512
    v_exp_f32 v191, v191
    s_nop 0
    v_cvt_pk_bf16_f32 v45, v190, v191
    s_waitcnt lgkmcnt(3)
    v_mfma_f32_16x16x32_bf16 v[200:203], v[240:243], v[160:163], v[200:203]
    v_exp_f32 v192, v192
    v_mfma_f32_16x16x32_bf16 v[204:207], v[240:243], v[176:179], v[204:207]
    s_waitcnt vmcnt(8)
    s_barrier
    ds_read_b128 v[232:235], v5 offset:0
    v_exp_f32 v193, v193
    s_nop 0
    v_cvt_pk_bf16_f32 v42, v192, v193
    s_waitcnt lgkmcnt(3)
    v_mfma_f32_16x16x32_bf16 v[208:211], v[244:247], v[160:163], v[208:211]
    v_exp_f32 v194, v194
    v_mfma_f32_16x16x32_bf16 v[212:215], v[244:247], v[176:179], v[212:215]
    s_add_u32 s22, s21, 0x18000
    s_add_u32 m0, s20, 0x18000
    s_nop 0
    buffer_load_dwordx4 v2, s[8:11], s22 offen sc1 lds
    ds_read_b128 v[236:239], v5 offset:1024
    v_exp_f32 v195, v195
    s_nop 0
    v_cvt_pk_bf16_f32 v43, v194, v195
    s_waitcnt lgkmcnt(3)
    v_mfma_f32_16x16x32_bf16 v[200:203], v[224:227], v[164:167], v[200:203]
    v_exp_f32 v196, v196
    v_exp_f32 v197, v197
    v_mfma_f32_16x16x32_bf16 v[204:207], v[224:227], v[180:183], v[204:207]
    ds_read_b128 v[240:243], v5 offset:2048
    v_cvt_pk_bf16_f32 v46, v196, v197
    s_waitcnt lgkmcnt(3)
    v_mfma_f32_16x16x32_bf16 v[208:211], v[228:231], v[164:167], v[208:211]
    v_exp_f32 v198, v198
    v_exp_f32 v199, v199
    v_mfma_f32_16x16x32_bf16 v[212:215], v[228:231], v[180:183], v[212:215]
    ds_read_b128 v[244:247], v5 offset:3072
    v_cvt_pk_bf16_f32 v47, v198, v199
    s_waitcnt lgkmcnt(3)
    v_mfma_f32_16x16x32_bf16 v[184:187], v[232:235], v[152:155], v[216:219]
    v_mfma_f32_16x16x32_bf16 v[188:191], v[232:235], v[168:171], v[220:223]
    ds_read_b128 v[224:227], v5 offset:4096
    v_exp_f32 v200, v200
    v_exp_f32 v201, v201
    v_mfma_f32_16x16x32_bf16 v[248:251], v[12:15], v[40:43], v[248:251]
    s_waitcnt lgkmcnt(3)
    v_mfma_f32_16x16x32_bf16 v[192:195], v[236:239], v[152:155], v[216:219]
    v_cvt_pk_bf16_f32 v48, v200, v201
    v_exp_f32 v202, v202
    v_mfma_f32_16x16x32_bf16 v[196:199], v[236:239], v[168:171], v[220:223]
    s_add_u32 s22, s21, 0x18400
    s_add_u32 m0, s20, 0x18400
    s_nop 0
    buffer_load_dwordx4 v2, s[8:11], s22 offen sc1 lds
    ds_read_b128 v[228:231], v5 offset:5120
    v_exp_f32 v203, v203
    v_mfma_f32_16x16x32_bf16 v[252:255], v[12:15], v[44:47], v[252:255]
    s_waitcnt lgkmcnt(3)
    v_mfma_f32_16x16x32_bf16 v[184:187], v[240:243], v[156:159], v[184:187]
    v_cvt_pk_bf16_f32 v49, v202, v203
    v_exp_f32 v204, v204
    v_mfma_f32_16x16x32_bf16 v[188:191], v[240:243], v[172:175], v[188:191]
    ds_read_b128 v[232:235], v5 offset:6144
    v_exp_f32 v205, v205
    s_waitcnt lgkmcnt(3)
    v_mfma_f32_16x16x32_bf16 v[192:195], v[244:247], v[156:159], v[192:195]
    v_cvt_pk_bf16_f32 v52, v204, v205
    v_exp_f32 v206, v206
    v_mfma_f32_16x16x32_bf16 v[196:199], v[244:247], v[172:175], v[196:199]
    ds_read_b128 v[236:239], v5 offset:7168
    v_exp_f32 v207, v207
    s_nop 0
    v_cvt_pk_bf16_f32 v53, v206, v207
    s_waitcnt lgkmcnt(3)
    v_mfma_f32_16x16x32_bf16 v[184:187], v[224:227], v[160:163], v[184:187]
    v_exp_f32 v208, v208
    v_mfma_f32_16x16x32_bf16 v[188:191], v[224:227], v[176:179], v[188:191]
    ds_read_b128 v[240:243], v5 offset:8192
    v_exp_f32 v209, v209
    s_nop 0
    v_cvt_pk_bf16_f32 v50, v208, v209
    s_waitcnt lgkmcnt(3)
    v_mfma_f32_16x16x32_bf16 v[192:195], v[228:231], v[160:163], v[192:195]
    v_exp_f32 v210, v210
    v_mfma_f32_16x16x32_bf16 v[196:199], v[228:231], v[176:179], v[196:199]
    ds_read_b128 v[244:247], v5 offset:9216
    v_exp_f32 v211, v211
    s_nop 0
    v_cvt_pk_bf16_f32 v51, v210, v211
    s_waitcnt lgkmcnt(3)
    v_mfma_f32_16x16x32_bf16 v[184:187], v[232:235], v[164:167], v[184:187]
    v_exp_f32 v212, v212
    v_exp_f32 v213, v213
    v_mfma_f32_16x16x32_bf16 v[188:191], v[232:235], v[180:183], v[188:191]
    ds_read_b128 v[224:227], v5 offset:10240
    v_cvt_pk_bf16_f32 v54, v212, v213
    s_waitcnt lgkmcnt(3)
    v_mfma_f32_16x16x32_bf16 v[192:195], v[236:239], v[164:167], v[192:195]
    v_exp_f32 v214, v214
    v_exp_f32 v215, v215
    v_mfma_f32_16x16x32_bf16 v[196:199], v[236:239], v[180:183], v[196:199]
    ds_read_b128 v[228:231], v5 offset:11264
    v_cvt_pk_bf16_f32 v55, v214, v215
    s_waitcnt lgkmcnt(3)
    v_mfma_f32_16x16x32_bf16 v[200:203], v[240:243], v[152:155], v[216:219]
    v_mfma_f32_16x16x32_bf16 v[204:207], v[240:243], v[168:171], v[220:223]
    ds_read_b128 v[232:235], v5 offset:12288
    v_exp_f32 v184, v184
    v_exp_f32 v185, v185
    v_mfma_f32_16x16x32_bf16 v[248:251], v[12:15], v[48:51], v[248:251]
    s_waitcnt lgkmcnt(3)
    v_mfma_f32_16x16x32_bf16 v[208:211], v[244:247], v[152:155], v[216:219]
    v_cvt_pk_bf16_f32 v56, v184, v185
    v_exp_f32 v186, v186
    v_mfma_f32_16x16x32_bf16 v[212:215], v[244:247], v[168:171], v[220:223]
    ds_read_b128 v[236:239], v5 offset:13312
    v_exp_f32 v187, v187
    v_mfma_f32_16x16x32_bf16 v[252:255], v[12:15], v[52:55], v[252:255]
    s_waitcnt lgkmcnt(3)
    v_mfma_f32_16x16x32_bf16 v[200:203], v[224:227], v[156:159], v[200:203]
    v_cvt_pk_bf16_f32 v57, v186, v187
    v_exp_f32 v188, v188
    v_mfma_f32_16x16x32_bf16 v[204:207], v[224:227], v[172:175], v[204:207]
    ds_read_b128 v[240:243], v5 offset:14336
    v_exp_f32 v189, v189
    s_waitcnt lgkmcnt(3)
    v_mfma_f32_16x16x32_bf16 v[208:211], v[228:231], v[156:159], v[208:211]
    v_cvt_pk_bf16_f32 v60, v188, v189
    v_exp_f32 v190, v190
    s_waitcnt vmcnt(7)
    v_mfma_f32_16x16x32_bf16 v[212:215], v[228:231], v[172:175], v[212:215]
    ds_read_b128 v[244:247], v5 offset:15360
    v_exp_f32 v191, v191
    s_nop 0
    v_cvt_pk_bf16_f32 v61, v190, v191
    s_waitcnt lgkmcnt(3)
    v_mfma_f32_16x16x32_bf16 v[200:203], v[232:235], v[160:163], v[200:203]
    v_exp_f32 v192, v192
    v_mfma_f32_16x16x32_bf16 v[204:207], v[232:235], v[176:179], v[204:207]
    s_barrier
    ds_read_b128 v[224:227], v5 offset:16384
    v_exp_f32 v193, v193
    s_nop 0
    v_cvt_pk_bf16_f32 v58, v192, v193
    s_waitcnt lgkmcnt(3)
    v_mfma_f32_16x16x32_bf16 v[208:211], v[236:239], v[160:163], v[208:211]
    v_exp_f32 v194, v194
    v_mfma_f32_16x16x32_bf16 v[212:215], v[236:239], v[176:179], v[212:215]
    s_add_u32 s22, s21, 0x1c000
    s_add_u32 m0, s20, 0x1c000
    s_nop 0
    buffer_load_dwordx4 v2, s[8:11], s22 offen sc1 lds
    ds_read_b128 v[228:231], v5 offset:17408
    v_exp_f32 v195, v195
    s_nop 0
    v_cvt_pk_bf16_f32 v59, v194, v195
    s_waitcnt lgkmcnt(3)
    v_mfma_f32_16x16x32_bf16 v[200:203], v[240:243], v[164:167], v[200:203]
    v_exp_f32 v196, v196
    v_exp_f32 v197, v197
    v_mfma_f32_16x16x32_bf16 v[204:207], v[240:243], v[180:183], v[204:207]
    ds_read_b128 v[232:235], v5 offset:18432
    v_cvt_pk_bf16_f32 v62, v196, v197
    s_waitcnt lgkmcnt(3)
    v_mfma_f32_16x16x32_bf16 v[208:211], v[244:247], v[164:167], v[208:211]
    v_exp_f32 v198, v198
    v_exp_f32 v199, v199
    v_mfma_f32_16x16x32_bf16 v[212:215], v[244:247], v[180:183], v[212:215]
    ds_read_b128 v[236:239], v5 offset:19456
    v_cvt_pk_bf16_f32 v63, v198, v199
    s_waitcnt lgkmcnt(3)
    v_mfma_f32_16x16x32_bf16 v[184:187], v[224:227], v[152:155], v[216:219]
    v_mfma_f32_16x16x32_bf16 v[188:191], v[224:227], v[168:171], v[220:223]
    ds_read_b128 v[240:243], v5 offset:20480
    v_exp_f32 v200, v200
    v_exp_f32 v201, v201
    v_mfma_f32_16x16x32_bf16 v[248:251], v[12:15], v[56:59], v[248:251]
    s_waitcnt lgkmcnt(3)
    v_mfma_f32_16x16x32_bf16 v[192:195], v[228:231], v[152:155], v[216:219]
    v_cvt_pk_bf16_f32 v64, v200, v201
    v_exp_f32 v202, v202
    v_mfma_f32_16x16x32_bf16 v[196:199], v[228:231], v[168:171], v[220:223]
    s_add_u32 s22, s21, 0x1c400
    s_add_u32 m0, s20, 0x1c400
    s_nop 0
    buffer_load_dwordx4 v2, s[8:11], s22 offen sc1 lds
    ds_read_b128 v[244:247], v5 offset:21504
    v_exp_f32 v203, v203
    v_mfma_f32_16x16x32_bf16 v[252:255], v[12:15], v[60:63], v[252:255]
    s_waitcnt lgkmcnt(3)
    v_mfma_f32_16x16x32_bf16 v[184:187], v[232:235], v[156:159], v[184:187]
    v_cvt_pk_bf16_f32 v65, v202, v203
    v_exp_f32 v204, v204
    v_mfma_f32_16x16x32_bf16 v[188:191], v[232:235], v[172:175], v[188:191]
    ds_read_b128 v[224:227], v5 offset:22528
    v_exp_f32 v205, v205
    s_waitcnt lgkmcnt(3)
    v_mfma_f32_16x16x32_bf16 v[192:195], v[236:239], v[156:159], v[192:195]
    v_cvt_pk_bf16_f32 v68, v204, v205
    v_exp_f32 v206, v206
    v_mfma_f32_16x16x32_bf16 v[196:199], v[236:239], v[172:175], v[196:199]
    ds_read_b128 v[228:231], v5 offset:23552
    v_exp_f32 v207, v207
    s_nop 0
    v_cvt_pk_bf16_f32 v69, v206, v207
    s_waitcnt lgkmcnt(3)
    v_mfma_f32_16x16x32_bf16 v[184:187], v[240:243], v[160:163], v[184:187]
    v_exp_f32 v208, v208
    v_mfma_f32_16x16x32_bf16 v[188:191], v[240:243], v[176:179], v[188:191]
    ds_read_b128 v[232:235], v5 offset:24576
    v_exp_f32 v209, v209
    s_nop 0
    v_cvt_pk_bf16_f32 v66, v208, v209
    s_waitcnt lgkmcnt(3)
    v_mfma_f32_16x16x32_bf16 v[192:195], v[244:247], v[160:163], v[192:195]
    v_exp_f32 v210, v210
    v_mfma_f32_16x16x32_bf16 v[196:199], v[244:247], v[176:179], v[196:199]
    ds_read_b128 v[236:239], v5 offset:25600
    v_exp_f32 v211, v211
    s_nop 0
    v_cvt_pk_bf16_f32 v67, v210, v211
    s_waitcnt lgkmcnt(3)
    v_mfma_f32_16x16x32_bf16 v[184:187], v[224:227], v[164:167], v[184:187]
    v_exp_f32 v212, v212
    v_exp_f32 v213, v213
    v_mfma_f32_16x16x32_bf16 v[188:191], v[224:227], v[180:183], v[188:191]
    ds_read_b128 v[240:243], v5 offset:26624
    v_cvt_pk_bf16_f32 v70, v212, v213
    s_waitcnt lgkmcnt(3)
    v_mfma_f32_16x16x32_bf16 v[192:195], v[228:231], v[164:167], v[192:195]
    v_exp_f32 v214, v214
    v_exp_f32 v215, v215
    v_mfma_f32_16x16x32_bf16 v[196:199], v[228:231], v[180:183], v[196:199]
    ds_read_b128 v[244:247], v5 offset:27648
    v_cvt_pk_bf16_f32 v71, v214, v215
    s_waitcnt lgkmcnt(3)
    v_mfma_f32_16x16x32_bf16 v[200:203], v[232:235], v[152:155], v[216:219]
    v_mfma_f32_16x16x32_bf16 v[204:207], v[232:235], v[168:171], v[220:223]
    ds_read_b128 v[224:227], v5 offset:28672
    v_exp_f32 v184, v184
    v_exp_f32 v185, v185
    v_mfma_f32_16x16x32_bf16 v[248:251], v[12:15], v[64:67], v[248:251]
    s_waitcnt lgkmcnt(3)
    v_mfma_f32_16x16x32_bf16 v[208:211], v[236:239], v[152:155], v[216:219]
    v_cvt_pk_bf16_f32 v72, v184, v185
    v_exp_f32 v186, v186
    v_mfma_f32_16x16x32_bf16 v[212:215], v[236:239], v[168:171], v[220:223]
    ds_read_b128 v[228:231], v5 offset:29696
    v_exp_f32 v187, v187
    v_mfma_f32_16x16x32_bf16 v[252:255], v[12:15], v[68:71], v[252:255]
    s_waitcnt lgkmcnt(3)
    v_mfma_f32_16x16x32_bf16 v[200:203], v[240:243], v[156:159], v[200:203]
    v_cvt_pk_bf16_f32 v73, v186, v187
    v_exp_f32 v188, v188
    v_mfma_f32_16x16x32_bf16 v[204:207], v[240:243], v[172:175], v[204:207]
    ds_read_b128 v[232:235], v5 offset:30720
    v_exp_f32 v189, v189
    s_waitcnt lgkmcnt(3)
    v_mfma_f32_16x16x32_bf16 v[208:211], v[244:247], v[156:159], v[208:211]
    v_cvt_pk_bf16_f32 v76, v188, v189
    v_exp_f32 v190, v190
    v_mfma_f32_16x16x32_bf16 v[212:215], v[244:247], v[172:175], v[212:215]
    ds_read_b128 v[236:239], v5 offset:31744
    v_exp_f32 v191, v191
    s_nop 0
    v_cvt_pk_bf16_f32 v77, v190, v191
    s_waitcnt lgkmcnt(3)
    v_mfma_f32_16x16x32_bf16 v[200:203], v[224:227], v[160:163], v[200:203]
    v_exp_f32 v192, v192
    v_mfma_f32_16x16x32_bf16 v[204:207], v[224:227], v[176:179], v[204:207]
    s_waitcnt vmcnt(7)
    s_barrier
    ds_read_b128 v[240:243], v4 offset:0
    v_exp_f32 v193, v193
    s_nop 0
    v_cvt_pk_bf16_f32 v74, v192, v193
    s_waitcnt lgkmcnt(3)
    v_mfma_f32_16x16x32_bf16 v[208:211], v[228:231], v[160:163], v[208:211]
    v_exp_f32 v194, v194
    v_mfma_f32_16x16x32_bf16 v[212:215], v[228:231], v[176:179], v[212:215]
    s_add_u32 s22, s21, 0x80000
    s_add_u32 m0, s20, 0x20000
    s_nop 0
    buffer_load_dwordx4 v2, s[8:11], s22 offen sc1 lds
    ds_read_b128 v[244:247], v4 offset:1024
    v_exp_f32 v195, v195
    s_nop 0
    v_cvt_pk_bf16_f32 v75, v194, v195
    s_waitcnt lgkmcnt(3)
    v_mfma_f32_16x16x32_bf16 v[200:203], v[232:235], v[164:167], v[200:203]
    v_exp_f32 v196, v196
    v_exp_f32 v197, v197
    v_mfma_f32_16x16x32_bf16 v[204:207], v[232:235], v[180:183], v[204:207]
    ds_read_b128 v[224:227], v4 offset:2048
    v_cvt_pk_bf16_f32 v78, v196, v197
    s_waitcnt lgkmcnt(3)
    v_mfma_f32_16x16x32_bf16 v[208:211], v[236:239], v[164:167], v[208:211]
    v_exp_f32 v198, v198
    v_exp_f32 v199, v199
    v_mfma_f32_16x16x32_bf16 v[212:215], v[236:239], v[180:183], v[212:215]
    ds_read_b128 v[228:231], v4 offset:3072
    v_cvt_pk_bf16_f32 v79, v198, v199
    s_waitcnt lgkmcnt(3)
    v_mfma_f32_16x16x32_bf16 v[184:187], v[240:243], v[152:155], v[216:219]
    v_mfma_f32_16x16x32_bf16 v[188:191], v[240:243], v[168:171], v[220:223]
    ds_read_b128 v[232:235], v4 offset:4096
    v_exp_f32 v200, v200
    v_exp_f32 v201, v201
    v_mfma_f32_16x16x32_bf16 v[248:251], v[12:15], v[72:75], v[248:251]
    s_waitcnt lgkmcnt(3)
    v_mfma_f32_16x16x32_bf16 v[192:195], v[244:247], v[152:155], v[216:219]
    v_cvt_pk_bf16_f32 v80, v200, v201
    v_exp_f32 v202, v202
    v_mfma_f32_16x16x32_bf16 v[196:199], v[244:247], v[168:171], v[220:223]
    s_add_u32 s22, s21, 0x80400
    s_add_u32 m0, s20, 0x20400
    s_nop 0
    buffer_load_dwordx4 v2, s[8:11], s22 offen sc1 lds
    ds_read_b128 v[236:239], v4 offset:5120
    v_exp_f32 v203, v203
    v_mfma_f32_16x16x32_bf16 v[252:255], v[12:15], v[76:79], v[252:255]
    s_waitcnt lgkmcnt(3)
    v_mfma_f32_16x16x32_bf16 v[184:187], v[224:227], v[156:159], v[184:187]
    v_cvt_pk_bf16_f32 v81, v202, v203
    v_exp_f32 v204, v204
    s_add_u32 s22, s18, 0
    s_add_u32 m0, s15, 0
    s_nop 0
    buffer_load_dwordx4 v11, s[64:67], s22 offen lds
    v_mfma_f32_16x16x32_bf16 v[188:191], v[224:227], v[172:175], v[188:191]
    ds_read_b128 v[240:243], v4 offset:6144
    v_exp_f32 v205, v205
    s_waitcnt lgkmcnt(3)
    v_mfma_f32_16x16x32_bf16 v[192:195], v[228:231], v[156:159], v[192:195]
    v_cvt_pk_bf16_f32 v84, v204, v205
    v_exp_f32 v206, v206
    v_mfma_f32_16x16x32_bf16 v[196:199], v[228:231], v[172:175], v[196:199]
    ds_read_b128 v[244:247], v4 offset:7168
    v_exp_f32 v207, v207
    s_nop 0
    v_cvt_pk_bf16_f32 v85, v206, v207
    s_waitcnt lgkmcnt(3)
    v_mfma_f32_16x16x32_bf16 v[184:187], v[232:235], v[160:163], v[184:187]
    v_exp_f32 v208, v208
    v_mfma_f32_16x16x32_bf16 v[188:191], v[232:235], v[176:179], v[188:191]
    ds_read_b128 v[224:227], v4 offset:8192
    v_exp_f32 v209, v209
    s_nop 0
    v_cvt_pk_bf16_f32 v82, v208, v209
    s_waitcnt lgkmcnt(3)
    v_mfma_f32_16x16x32_bf16 v[192:195], v[236:239], v[160:163], v[192:195]
    v_exp_f32 v210, v210
    v_mfma_f32_16x16x32_bf16 v[196:199], v[236:239], v[176:179], v[196:199]
    ds_read_b128 v[228:231], v4 offset:9216
    v_exp_f32 v211, v211
    s_nop 0
    v_cvt_pk_bf16_f32 v83, v210, v211
    s_waitcnt lgkmcnt(3)
    v_mfma_f32_16x16x32_bf16 v[184:187], v[240:243], v[164:167], v[184:187]
    v_exp_f32 v212, v212
    v_exp_f32 v213, v213
    v_mfma_f32_16x16x32_bf16 v[188:191], v[240:243], v[180:183], v[188:191]
    ds_read_b128 v[232:235], v4 offset:10240
    v_cvt_pk_bf16_f32 v86, v212, v213
    s_waitcnt lgkmcnt(3)
    v_mfma_f32_16x16x32_bf16 v[192:195], v[244:247], v[164:167], v[192:195]
    v_exp_f32 v214, v214
    v_exp_f32 v215, v215
    v_mfma_f32_16x16x32_bf16 v[196:199], v[244:247], v[180:183], v[196:199]
    ds_read_b128 v[236:239], v4 offset:11264
    v_cvt_pk_bf16_f32 v87, v214, v215
    s_waitcnt lgkmcnt(3)
    v_mfma_f32_16x16x32_bf16 v[200:203], v[224:227], v[152:155], v[216:219]
    v_mfma_f32_16x16x32_bf16 v[204:207], v[224:227], v[168:171], v[220:223]
    ds_read_b128 v[240:243], v4 offset:12288
    v_exp_f32 v184, v184
    v_exp_f32 v185, v185
    v_mfma_f32_16x16x32_bf16 v[248:251], v[12:15], v[80:83], v[248:251]
    s_waitcnt lgkmcnt(3)
    v_mfma_f32_16x16x32_bf16 v[208:211], v[228:231], v[152:155], v[216:219]
    v_cvt_pk_bf16_f32 v88, v184, v185
    v_exp_f32 v186, v186
    v_mfma_f32_16x16x32_bf16 v[212:215], v[228:231], v[168:171], v[220:223]
    ds_read_b128 v[244:247], v4 offset:13312
    v_exp_f32 v187, v187
    s_add_u32 s22, s18, 7168
    s_add_u32 m0, s15, 1024
    s_nop 0
    buffer_load_dwordx4 v11, s[64:67], s22 offen lds
    v_mfma_f32_16x16x32_bf16 v[252:255], v[12:15], v[84:87], v[252:255]
    s_waitcnt lgkmcnt(3)
    v_mfma_f32_16x16x32_bf16 v[200:203], v[232:235], v[156:159], v[200:203]
    v_cvt_pk_bf16_f32 v89, v186, v187
    v_exp_f32 v188, v188
    v_mfma_f32_16x16x32_bf16 v[204:207], v[232:235], v[172:175], v[204:207]
    ds_read_b128 v[224:227], v4 offset:14336
    v_exp_f32 v189, v189
    s_waitcnt lgkmcnt(3)
    v_mfma_f32_16x16x32_bf16 v[208:211], v[236:239], v[156:159], v[208:211]
    v_cvt_pk_bf16_f32 v92, v188, v189
    v_exp_f32 v190, v190
    v_mfma_f32_16x16x32_bf16 v[212:215], v[236:239], v[172:175], v[212:215]
    ds_read_b128 v[228:231], v4 offset:15360
    v_exp_f32 v191, v191
    s_nop 0
    v_cvt_pk_bf16_f32 v93, v190, v191
    s_waitcnt lgkmcnt(3)
    v_mfma_f32_16x16x32_bf16 v[200:203], v[240:243], v[160:163], v[200:203]
    v_exp_f32 v192, v192
    v_mfma_f32_16x16x32_bf16 v[204:207], v[240:243], v[176:179], v[204:207]
    s_waitcnt vmcnt(8)
    s_barrier
    ds_read_b128 v[232:235], v4 offset:16384
    v_exp_f32 v193, v193
    s_nop 0
    v_cvt_pk_bf16_f32 v90, v192, v193
    s_waitcnt lgkmcnt(3)
    v_mfma_f32_16x16x32_bf16 v[208:211], v[244:247], v[160:163], v[208:211]
    v_exp_f32 v194, v194
    v_mfma_f32_16x16x32_bf16 v[212:215], v[244:247], v[176:179], v[212:215]
    s_add_u32 s22, s21, 0x84000
    s_add_u32 m0, s20, 0x24000
    s_nop 0
    buffer_load_dwordx4 v2, s[8:11], s22 offen sc1 lds
    ds_read_b128 v[236:239], v4 offset:17408
    v_exp_f32 v195, v195
    s_nop 0
    v_cvt_pk_bf16_f32 v91, v194, v195
    s_waitcnt lgkmcnt(3)
    v_mfma_f32_16x16x32_bf16 v[200:203], v[224:227], v[164:167], v[200:203]
    v_exp_f32 v196, v196
    v_exp_f32 v197, v197
    v_mfma_f32_16x16x32_bf16 v[204:207], v[224:227], v[180:183], v[204:207]
    ds_read_b128 v[240:243], v4 offset:18432
    v_cvt_pk_bf16_f32 v94, v196, v197
    s_waitcnt lgkmcnt(3)
    v_mfma_f32_16x16x32_bf16 v[208:211], v[228:231], v[164:167], v[208:211]
    v_exp_f32 v198, v198
    v_exp_f32 v199, v199
    v_mfma_f32_16x16x32_bf16 v[212:215], v[228:231], v[180:183], v[212:215]
    ds_read_b128 v[244:247], v4 offset:19456
    v_cvt_pk_bf16_f32 v95, v198, v199
    s_waitcnt lgkmcnt(3)
    v_mfma_f32_16x16x32_bf16 v[184:187], v[232:235], v[152:155], v[216:219]
    v_mfma_f32_16x16x32_bf16 v[188:191], v[232:235], v[168:171], v[220:223]
    ds_read_b128 v[224:227], v4 offset:20480
    v_exp_f32 v200, v200
    v_exp_f32 v201, v201
    v_mfma_f32_16x16x32_bf16 v[248:251], v[12:15], v[88:91], v[248:251]
    s_waitcnt lgkmcnt(3)
    v_mfma_f32_16x16x32_bf16 v[192:195], v[236:239], v[152:155], v[216:219]
    v_cvt_pk_bf16_f32 v96, v200, v201
    v_exp_f32 v202, v202
    v_mfma_f32_16x16x32_bf16 v[196:199], v[236:239], v[168:171], v[220:223]
    s_add_u32 s22, s21, 0x84400
    s_add_u32 m0, s20, 0x24400
    s_nop 0
    buffer_load_dwordx4 v2, s[8:11], s22 offen sc1 lds
    ds_read_b128 v[228:231], v4 offset:21504
    v_exp_f32 v203, v203
    s_add_u32 s22, s18, 14336
    s_add_u32 m0, s15, 2048
    s_nop 0
    buffer_load_dwordx4 v11, s[64:67], s22 offen lds
    v_mfma_f32_16x16x32_bf16 v[252:255], v[12:15], v[92:95], v[252:255]
    s_waitcnt lgkmcnt(3)
    v_mfma_f32_16x16x32_bf16 v[184:187], v[240:243], v[156:159], v[184:187]
    v_cvt_pk_bf16_f32 v97, v202, v203
    v_exp_f32 v204, v204
    v_mfma_f32_16x16x32_bf16 v[188:191], v[240:243], v[172:175], v[188:191]
    ds_read_b128 v[232:235], v4 offset:22528
    v_exp_f32 v205, v205
    s_waitcnt lgkmcnt(3)
    v_mfma_f32_16x16x32_bf16 v[192:195], v[244:247], v[156:159], v[192:195]
    v_cvt_pk_bf16_f32 v100, v204, v205
    v_exp_f32 v206, v206
    v_mfma_f32_16x16x32_bf16 v[196:199], v[244:247], v[172:175], v[196:199]
    ds_read_b128 v[236:239], v4 offset:23552
    v_exp_f32 v207, v207
    s_nop 0
    v_cvt_pk_bf16_f32 v101, v206, v207
    s_waitcnt lgkmcnt(3)
    v_mfma_f32_16x16x32_bf16 v[184:187], v[224:227], v[160:163], v[184:187]
    v_exp_f32 v208, v208
    v_mfma_f32_16x16x32_bf16 v[188:191], v[224:227], v[176:179], v[188:191]
    ds_read_b128 v[240:243], v4 offset:24576
    v_exp_f32 v209, v209
    s_nop 0
    v_cvt_pk_bf16_f32 v98, v208, v209
    s_waitcnt lgkmcnt(3)
    v_mfma_f32_16x16x32_bf16 v[192:195], v[228:231], v[160:163], v[192:195]
    v_exp_f32 v210, v210
    v_mfma_f32_16x16x32_bf16 v[196:199], v[228:231], v[176:179], v[196:199]
    ds_read_b128 v[244:247], v4 offset:25600
    v_exp_f32 v211, v211
    s_nop 0
    v_cvt_pk_bf16_f32 v99, v210, v211
    s_waitcnt lgkmcnt(3)
    v_mfma_f32_16x16x32_bf16 v[184:187], v[232:235], v[164:167], v[184:187]
    v_exp_f32 v212, v212
    v_exp_f32 v213, v213
    v_mfma_f32_16x16x32_bf16 v[188:191], v[232:235], v[180:183], v[188:191]
    ds_read_b128 v[224:227], v4 offset:26624
    v_cvt_pk_bf16_f32 v102, v212, v213
    s_waitcnt lgkmcnt(3)
    v_mfma_f32_16x16x32_bf16 v[192:195], v[236:239], v[164:167], v[192:195]
    v_exp_f32 v214, v214
    v_exp_f32 v215, v215
    v_mfma_f32_16x16x32_bf16 v[196:199], v[236:239], v[180:183], v[196:199]
    ds_read_b128 v[228:231], v4 offset:27648
    v_cvt_pk_bf16_f32 v103, v214, v215
    s_waitcnt lgkmcnt(3)
    v_mfma_f32_16x16x32_bf16 v[200:203], v[240:243], v[152:155], v[216:219]
    v_mfma_f32_16x16x32_bf16 v[204:207], v[240:243], v[168:171], v[220:223]
    ds_read_b128 v[232:235], v4 offset:28672
    v_exp_f32 v184, v184
    v_exp_f32 v185, v185
    v_mfma_f32_16x16x32_bf16 v[248:251], v[12:15], v[96:99], v[248:251]
    s_waitcnt lgkmcnt(3)
    v_mfma_f32_16x16x32_bf16 v[208:211], v[244:247], v[152:155], v[216:219]
    v_cvt_pk_bf16_f32 v104, v184, v185
    v_exp_f32 v186, v186
    s_add_u32 s22, s18, 21504
    s_add_u32 m0, s15, 3072
    s_nop 0
    buffer_load_dwordx4 v11, s[64:67], s22 offen lds
    v_mfma_f32_16x16x32_bf16 v[212:215], v[244:247], v[168:171], v[220:223]
    ds_read_b128 v[236:239], v4 offset:29696
    v_exp_f32 v187, v187
    v_mfma_f32_16x16x32_bf16 v[252:255], v[12:15], v[100:103], v[252:255]
    s_waitcnt lgkmcnt(3)
    v_mfma_f32_16x16x32_bf16 v[200:203], v[224:227], v[156:159], v[200:203]
    v_cvt_pk_bf16_f32 v105, v186, v187
    v_exp_f32 v188, v188
    v_mfma_f32_16x16x32_bf16 v[204:207], v[224:227], v[172:175], v[204:207]
    ds_read_b128 v[240:243], v4 offset:30720
    v_exp_f32 v189, v189
    s_waitcnt lgkmcnt(3)
    v_mfma_f32_16x16x32_bf16 v[208:211], v[228:231], v[156:159], v[208:211]
    v_cvt_pk_bf16_f32 v108, v188, v189
    v_exp_f32 v190, v190
    v_mfma_f32_16x16x32_bf16 v[212:215], v[228:231], v[172:175], v[212:215]
    ds_read_b128 v[244:247], v4 offset:31744
    v_exp_f32 v191, v191
    s_nop 0
    v_cvt_pk_bf16_f32 v109, v190, v191
    s_waitcnt lgkmcnt(3)
    v_mfma_f32_16x16x32_bf16 v[200:203], v[232:235], v[160:163], v[200:203]
    v_exp_f32 v192, v192
    v_mfma_f32_16x16x32_bf16 v[204:207], v[232:235], v[176:179], v[204:207]
    s_waitcnt vmcnt(10)
    s_barrier
    ds_read_b128 v[224:227], v4 offset:32768
    v_exp_f32 v193, v193
    s_nop 0
    v_cvt_pk_bf16_f32 v106, v192, v193
    s_waitcnt lgkmcnt(3)
    v_mfma_f32_16x16x32_bf16 v[208:211], v[236:239], v[160:163], v[208:211]
    v_exp_f32 v194, v194
    v_mfma_f32_16x16x32_bf16 v[212:215], v[236:239], v[176:179], v[212:215]
    s_add_u32 s22, s21, 0x88000
    s_add_u32 m0, s20, 0x10000
    s_nop 0
    buffer_load_dwordx4 v2, s[8:11], s22 offen sc1 lds
    ds_read_b128 v[228:231], v4 offset:33792
    v_exp_f32 v195, v195
    s_nop 0
    v_cvt_pk_bf16_f32 v107, v194, v195
    s_waitcnt lgkmcnt(3)
    v_mfma_f32_16x16x32_bf16 v[200:203], v[240:243], v[164:167], v[200:203]
    v_exp_f32 v196, v196
    v_exp_f32 v197, v197
    v_mfma_f32_16x16x32_bf16 v[204:207], v[240:243], v[180:183], v[204:207]
    ds_read_b128 v[232:235], v4 offset:34816
    v_cvt_pk_bf16_f32 v110, v196, v197
    s_waitcnt lgkmcnt(3)
    v_mfma_f32_16x16x32_bf16 v[208:211], v[244:247], v[164:167], v[208:211]
    v_exp_f32 v198, v198
    v_exp_f32 v199, v199
    v_mfma_f32_16x16x32_bf16 v[212:215], v[244:247], v[180:183], v[212:215]
    ds_read_b128 v[236:239], v4 offset:35840
    v_cvt_pk_bf16_f32 v111, v198, v199
    s_waitcnt lgkmcnt(3)
    v_mfma_f32_16x16x32_bf16 v[184:187], v[224:227], v[152:155], v[216:219]
    v_mfma_f32_16x16x32_bf16 v[188:191], v[224:227], v[168:171], v[220:223]
    ds_read_b128 v[240:243], v4 offset:36864
    v_exp_f32 v200, v200
    v_exp_f32 v201, v201
    v_mfma_f32_16x16x32_bf16 v[248:251], v[12:15], v[104:107], v[248:251]
    s_waitcnt lgkmcnt(3)
    v_mfma_f32_16x16x32_bf16 v[192:195], v[228:231], v[152:155], v[216:219]
    v_cvt_pk_bf16_f32 v112, v200, v201
    v_exp_f32 v202, v202
    s_add_u32 s22, s18, 28672
    s_add_u32 m0, s15, 4096
    s_nop 0
    buffer_load_dwordx4 v11, s[64:67], s22 offen lds
    v_mfma_f32_16x16x32_bf16 v[196:199], v[228:231], v[168:171], v[220:223]
    s_add_u32 s22, s21, 0x88400
    s_add_u32 m0, s20, 0x10400
    s_nop 0
    buffer_load_dwordx4 v2, s[8:11], s22 offen sc1 lds
    ds_read_b128 v[244:247], v4 offset:37888
    v_exp_f32 v203, v203
    v_mfma_f32_16x16x32_bf16 v[252:255], v[12:15], v[108:111], v[252:255]
    s_waitcnt lgkmcnt(3)
    v_mfma_f32_16x16x32_bf16 v[184:187], v[232:235], v[156:159], v[184:187]
    v_cvt_pk_bf16_f32 v113, v202, v203
    v_exp_f32 v204, v204
    v_mfma_f32_16x16x32_bf16 v[188:191], v[232:235], v[172:175], v[188:191]
    ds_read_b128 v[224:227], v4 offset:38912
    v_exp_f32 v205, v205
    s_waitcnt lgkmcnt(3)
    v_mfma_f32_16x16x32_bf16 v[192:195], v[236:239], v[156:159], v[192:195]
    v_cvt_pk_bf16_f32 v116, v204, v205
    v_exp_f32 v206, v206
    v_mfma_f32_16x16x32_bf16 v[196:199], v[236:239], v[172:175], v[196:199]
    ds_read_b128 v[228:231], v4 offset:39936
    v_exp_f32 v207, v207
    s_nop 0
    v_cvt_pk_bf16_f32 v117, v206, v207
    s_waitcnt lgkmcnt(3)
    v_mfma_f32_16x16x32_bf16 v[184:187], v[240:243], v[160:163], v[184:187]
    v_exp_f32 v208, v208
    v_mfma_f32_16x16x32_bf16 v[188:191], v[240:243], v[176:179], v[188:191]
    ds_read_b128 v[232:235], v4 offset:40960
    v_exp_f32 v209, v209
    s_nop 0
    v_cvt_pk_bf16_f32 v114, v208, v209
    s_waitcnt lgkmcnt(3)
    v_mfma_f32_16x16x32_bf16 v[192:195], v[244:247], v[160:163], v[192:195]
    v_exp_f32 v210, v210
    v_mfma_f32_16x16x32_bf16 v[196:199], v[244:247], v[176:179], v[196:199]
    ds_read_b128 v[236:239], v4 offset:41984
    v_exp_f32 v211, v211
    s_nop 0
    v_cvt_pk_bf16_f32 v115, v210, v211
    s_waitcnt lgkmcnt(3)
    v_mfma_f32_16x16x32_bf16 v[184:187], v[224:227], v[164:167], v[184:187]
    v_exp_f32 v212, v212
    v_exp_f32 v213, v213
    v_mfma_f32_16x16x32_bf16 v[188:191], v[224:227], v[180:183], v[188:191]
    ds_read_b128 v[240:243], v4 offset:43008
    v_cvt_pk_bf16_f32 v118, v212, v213
    s_waitcnt lgkmcnt(3)
    v_mfma_f32_16x16x32_bf16 v[192:195], v[228:231], v[164:167], v[192:195]
    v_exp_f32 v214, v214
    v_exp_f32 v215, v215
    v_mfma_f32_16x16x32_bf16 v[196:199], v[228:231], v[180:183], v[196:199]
    ds_read_b128 v[244:247], v4 offset:44032
    v_cvt_pk_bf16_f32 v119, v214, v215
    s_waitcnt lgkmcnt(3)
    v_mfma_f32_16x16x32_bf16 v[200:203], v[232:235], v[152:155], v[216:219]
    v_mfma_f32_16x16x32_bf16 v[204:207], v[232:235], v[168:171], v[220:223]
    ds_read_b128 v[224:227], v4 offset:45056
    v_exp_f32 v184, v184
    v_exp_f32 v185, v185
    s_add_u32 s22, s18, 35840
    s_add_u32 m0, s15, 5120
    s_nop 0
    buffer_load_dwordx4 v11, s[64:67], s22 offen lds
    v_mfma_f32_16x16x32_bf16 v[248:251], v[12:15], v[112:115], v[248:251]
    s_waitcnt lgkmcnt(3)
    v_mfma_f32_16x16x32_bf16 v[208:211], v[236:239], v[152:155], v[216:219]
    v_cvt_pk_bf16_f32 v120, v184, v185
    v_exp_f32 v186, v186
    v_mfma_f32_16x16x32_bf16 v[212:215], v[236:239], v[168:171], v[220:223]
    ds_read_b128 v[228:231], v4 offset:46080
    v_exp_f32 v187, v187
    v_mfma_f32_16x16x32_bf16 v[252:255], v[12:15], v[116:119], v[252:255]
    s_waitcnt lgkmcnt(3)
    v_mfma_f32_16x16x32_bf16 v[200:203], v[240:243], v[156:159], v[200:203]
    v_cvt_pk_bf16_f32 v121, v186, v187
    v_exp_f32 v188, v188
    v_mfma_f32_16x16x32_bf16 v[204:207], v[240:243], v[172:175], v[204:207]
    ds_read_b128 v[232:235], v4 offset:47104
    v_exp_f32 v189, v189
    s_waitcnt lgkmcnt(3)
    v_mfma_f32_16x16x32_bf16 v[208:211], v[244:247], v[156:159], v[208:211]
    v_cvt_pk_bf16_f32 v124, v188, v189
    v_exp_f32 v190, v190
    v_mfma_f32_16x16x32_bf16 v[212:215], v[244:247], v[172:175], v[212:215]
    ds_read_b128 v[236:239], v4 offset:48128
    v_exp_f32 v191, v191
    s_nop 0
    v_cvt_pk_bf16_f32 v125, v190, v191
    s_waitcnt lgkmcnt(3)
    v_mfma_f32_16x16x32_bf16 v[200:203], v[224:227], v[160:163], v[200:203]
    v_exp_f32 v192, v192
    v_mfma_f32_16x16x32_bf16 v[204:207], v[224:227], v[176:179], v[204:207]
    s_waitcnt vmcnt(12)
    s_barrier
    ds_read_b128 v[240:243], v4 offset:49152
    v_exp_f32 v193, v193
    s_nop 0
    v_cvt_pk_bf16_f32 v122, v192, v193
    s_waitcnt lgkmcnt(3)
    v_mfma_f32_16x16x32_bf16 v[208:211], v[228:231], v[160:163], v[208:211]
    v_exp_f32 v194, v194
    v_mfma_f32_16x16x32_bf16 v[212:215], v[228:231], v[176:179], v[212:215]
    s_add_u32 s22, s21, 0x8c000
    s_add_u32 m0, s20, 0x14000
    s_nop 0
    buffer_load_dwordx4 v2, s[8:11], s22 offen sc1 lds
    ds_read_b128 v[244:247], v4 offset:50176
    v_exp_f32 v195, v195
    s_nop 0
    v_cvt_pk_bf16_f32 v123, v194, v195
    s_waitcnt lgkmcnt(3)
    v_mfma_f32_16x16x32_bf16 v[200:203], v[232:235], v[164:167], v[200:203]
    v_exp_f32 v196, v196
    v_exp_f32 v197, v197
    v_mfma_f32_16x16x32_bf16 v[204:207], v[232:235], v[180:183], v[204:207]
    ds_read_b128 v[224:227], v4 offset:51200
    v_cvt_pk_bf16_f32 v126, v196, v197
    s_waitcnt lgkmcnt(3)
    v_mfma_f32_16x16x32_bf16 v[208:211], v[236:239], v[164:167], v[208:211]
    v_exp_f32 v198, v198
    v_exp_f32 v199, v199
    v_mfma_f32_16x16x32_bf16 v[212:215], v[236:239], v[180:183], v[212:215]
    ds_read_b128 v[228:231], v4 offset:52224
    v_cvt_pk_bf16_f32 v127, v198, v199
    s_waitcnt lgkmcnt(3)
    v_mfma_f32_16x16x32_bf16 v[184:187], v[240:243], v[152:155], v[216:219]
    v_mfma_f32_16x16x32_bf16 v[188:191], v[240:243], v[168:171], v[220:223]
    ds_read_b128 v[232:235], v4 offset:53248
    v_exp_f32 v200, v200
    v_exp_f32 v201, v201
    s_add_u32 s22, s18, 43008
    s_add_u32 m0, s15, 6144
    s_nop 0
    buffer_load_dwordx4 v11, s[64:67], s22 offen lds
    v_mfma_f32_16x16x32_bf16 v[248:251], v[12:15], v[120:123], v[248:251]
    s_waitcnt lgkmcnt(3)
    v_mfma_f32_16x16x32_bf16 v[192:195], v[244:247], v[152:155], v[216:219]
    v_cvt_pk_bf16_f32 v128, v200, v201
    v_exp_f32 v202, v202
    v_mfma_f32_16x16x32_bf16 v[196:199], v[244:247], v[168:171], v[220:223]
    s_add_u32 s22, s21, 0x8c400
    s_add_u32 m0, s20, 0x14400
    s_nop 0
    buffer_load_dwordx4 v2, s[8:11], s22 offen sc1 lds
    ds_read_b128 v[236:239], v4 offset:54272
    v_exp_f32 v203, v203
    v_mfma_f32_16x16x32_bf16 v[252:255], v[12:15], v[124:127], v[252:255]
    s_waitcnt lgkmcnt(3)
    v_mfma_f32_16x16x32_bf16 v[184:187], v[224:227], v[156:159], v[184:187]
    v_cvt_pk_bf16_f32 v129, v202, v203
    v_exp_f32 v204, v204
    v_mfma_f32_16x16x32_bf16 v[188:191], v[224:227], v[172:175], v[188:191]
    ds_read_b128 v[240:243], v4 offset:55296
    v_exp_f32 v205, v205
    s_waitcnt lgkmcnt(3)
    v_mfma_f32_16x16x32_bf16 v[192:195], v[228:231], v[156:159], v[192:195]
    v_cvt_pk_bf16_f32 v132, v204, v205
    v_exp_f32 v206, v206
    v_mfma_f32_16x16x32_bf16 v[196:199], v[228:231], v[172:175], v[196:199]
    ds_read_b128 v[244:247], v4 offset:56320
    v_exp_f32 v207, v207
    s_nop 0
    v_cvt_pk_bf16_f32 v133, v206, v207
    s_waitcnt lgkmcnt(3)
    v_mfma_f32_16x16x32_bf16 v[184:187], v[232:235], v[160:163], v[184:187]
    v_exp_f32 v208, v208
    v_mfma_f32_16x16x32_bf16 v[188:191], v[232:235], v[176:179], v[188:191]
    ds_read_b128 v[224:227], v4 offset:57344
    v_exp_f32 v209, v209
    s_nop 0
    v_cvt_pk_bf16_f32 v130, v208, v209
    s_waitcnt lgkmcnt(3)
    v_mfma_f32_16x16x32_bf16 v[192:195], v[236:239], v[160:163], v[192:195]
    v_exp_f32 v210, v210
    v_mfma_f32_16x16x32_bf16 v[196:199], v[236:239], v[176:179], v[196:199]
    ds_read_b128 v[228:231], v4 offset:58368
    v_exp_f32 v211, v211
    s_nop 0
    v_cvt_pk_bf16_f32 v131, v210, v211
    s_waitcnt lgkmcnt(3)
    v_mfma_f32_16x16x32_bf16 v[184:187], v[240:243], v[164:167], v[184:187]
    v_exp_f32 v212, v212
    v_exp_f32 v213, v213
    v_mfma_f32_16x16x32_bf16 v[188:191], v[240:243], v[180:183], v[188:191]
    ds_read_b128 v[232:235], v4 offset:59392
    v_cvt_pk_bf16_f32 v134, v212, v213
    s_waitcnt lgkmcnt(3)
    v_mfma_f32_16x16x32_bf16 v[192:195], v[244:247], v[164:167], v[192:195]
    v_exp_f32 v214, v214
    v_exp_f32 v215, v215
    v_mfma_f32_16x16x32_bf16 v[196:199], v[244:247], v[180:183], v[196:199]
    ds_read_b128 v[236:239], v4 offset:60416
    v_cvt_pk_bf16_f32 v135, v214, v215
    s_waitcnt lgkmcnt(3)
    v_mfma_f32_16x16x32_bf16 v[200:203], v[224:227], v[152:155], v[216:219]
    s_add_u32 s22, s18, 50176
    s_add_u32 m0, s15, 7168
    s_nop 0
    buffer_load_dwordx4 v11, s[64:67], s22 offen lds
    v_mfma_f32_16x16x32_bf16 v[204:207], v[224:227], v[168:171], v[220:223]
    ds_read_b128 v[240:243], v4 offset:61440
    v_exp_f32 v184, v184
    v_exp_f32 v185, v185
    v_mfma_f32_16x16x32_bf16 v[248:251], v[12:15], v[128:131], v[248:251]
    s_waitcnt lgkmcnt(3)
    v_mfma_f32_16x16x32_bf16 v[208:211], v[228:231], v[152:155], v[216:219]
    v_cvt_pk_bf16_f32 v136, v184, v185
    v_exp_f32 v186, v186
    v_mfma_f32_16x16x32_bf16 v[212:215], v[228:231], v[168:171], v[220:223]
    ds_read_b128 v[244:247], v4 offset:62464
    v_exp_f32 v187, v187
    v_mfma_f32_16x16x32_bf16 v[252:255], v[12:15], v[132:135], v[252:255]
    s_waitcnt lgkmcnt(3)
    v_mfma_f32_16x16x32_bf16 v[200:203], v[232:235], v[156:159], v[200:203]
    v_cvt_pk_bf16_f32 v137, v186, v187
    v_exp_f32 v188, v188
    v_mfma_f32_16x16x32_bf16 v[204:207], v[232:235], v[172:175], v[204:207]
    ds_read_b128 v[224:227], v4 offset:63488
    v_exp_f32 v189, v189
    s_waitcnt lgkmcnt(3)
    v_mfma_f32_16x16x32_bf16 v[208:211], v[236:239], v[156:159], v[208:211]
    v_cvt_pk_bf16_f32 v140, v188, v189
    v_exp_f32 v190, v190
    v_mfma_f32_16x16x32_bf16 v[212:215], v[236:239], v[172:175], v[212:215]
    ds_read_b128 v[228:231], v4 offset:64512
    v_exp_f32 v191, v191
    s_nop 0
    v_cvt_pk_bf16_f32 v141, v190, v191
    s_waitcnt lgkmcnt(3)
    v_mfma_f32_16x16x32_bf16 v[200:203], v[240:243], v[160:163], v[200:203]
    v_exp_f32 v192, v192
    v_mfma_f32_16x16x32_bf16 v[204:207], v[240:243], v[176:179], v[204:207]
    v_exp_f32 v193, v193
    s_nop 0
    v_cvt_pk_bf16_f32 v138, v192, v193
    s_waitcnt lgkmcnt(2)
    v_mfma_f32_16x16x32_bf16 v[208:211], v[244:247], v[160:163], v[208:211]
    v_exp_f32 v194, v194
    v_mfma_f32_16x16x32_bf16 v[212:215], v[244:247], v[176:179], v[212:215]
    v_exp_f32 v195, v195
    s_nop 0
    v_cvt_pk_bf16_f32 v139, v194, v195
    s_waitcnt lgkmcnt(1)
    v_mfma_f32_16x16x32_bf16 v[200:203], v[224:227], v[164:167], v[200:203]
    v_exp_f32 v196, v196
    v_exp_f32 v197, v197
    v_mfma_f32_16x16x32_bf16 v[204:207], v[224:227], v[180:183], v[204:207]
    v_cvt_pk_bf16_f32 v142, v196, v197
    s_waitcnt lgkmcnt(0)
    v_mfma_f32_16x16x32_bf16 v[208:211], v[228:231], v[164:167], v[208:211]
    v_exp_f32 v198, v198
    v_exp_f32 v199, v199
    v_mfma_f32_16x16x32_bf16 v[212:215], v[228:231], v[180:183], v[212:215]
    v_cvt_pk_bf16_f32 v143, v198, v199
    s_waitcnt vmcnt(14)
    s_barrier
    ds_read_b128 v[232:235], v5 offset:0
    ds_read_b128 v[236:239], v5 offset:1024
    ds_read_b128 v[240:243], v5 offset:2048
    ds_read_b128 v[244:247], v5 offset:3072
    v_mfma_f32_16x16x32_bf16 v[248:251], v[12:15], v[136:139], v[248:251]
    v_mfma_f32_16x16x32_bf16 v[252:255], v[12:15], v[140:143], v[252:255]
    v_exp_f32 v200, v200
    v_exp_f32 v201, v201
    s_nop 0
    v_cvt_pk_bf16_f32 v144, v200, v201
    v_exp_f32 v202, v202
    v_exp_f32 v203, v203
    s_nop 0
    v_cvt_pk_bf16_f32 v145, v202, v203
    v_exp_f32 v204, v204
    v_exp_f32 v205, v205
    s_nop 0
    v_cvt_pk_bf16_f32 v148, v204, v205
    v_exp_f32 v206, v206
    v_exp_f32 v207, v207
    s_nop 0
    v_cvt_pk_bf16_f32 v149, v206, v207
    v_exp_f32 v208, v208
    v_exp_f32 v209, v209
    s_nop 0
    v_cvt_pk_bf16_f32 v146, v208, v209
    v_exp_f32 v210, v210
    v_exp_f32 v211, v211
    s_nop 0
    v_cvt_pk_bf16_f32 v147, v210, v211
    v_exp_f32 v212, v212
    v_exp_f32 v213, v213
    s_nop 0
    v_cvt_pk_bf16_f32 v150, v212, v213
    v_exp_f32 v214, v214
    v_exp_f32 v215, v215
    s_nop 0
    v_cvt_pk_bf16_f32 v151, v214, v215
    v_mfma_f32_16x16x32_bf16 v[248:251], v[12:15], v[144:147], v[248:251]
    s_nop 0
    v_mfma_f32_16x16x32_bf16 v[252:255], v[12:15], v[148:151], v[252:255]
    s_nop 5
    v_mov_b32 v9, v248
    s_nop 0
    v_mov_b32 v10, v252
    v_max_f32 v17, v9, v10
    v_readfirstlane_b32 s17, v8
    s_cmp_eq_u32 s17, s28
    s_cselect_b32 s16, 0, 0x71800000
    v_cmp_ngt_f32 vcc, s16, v17
    v_cmp_u_f32 s[76:77], v9, v10
    s_or_b64 vcc, vcc, s[76:77]
    s_cbranch_vccnz adaLN_cond__sliding_block_cached__moe_arch_mod__prompt_kernel_fixB
adaLN_cond__sliding_block_cached__moe_arch_mod__prompt_kernel_fixBb:
    v_rcp_f32 v9, v9
    v_rcp_f32 v10, v10
    s_lshl_b32 s25, s13, 3
    s_add_u32 s25, s25, s3
    s_lshl_b32 s25, s25, 18
    s_lshl_b32 s26, s12, 12
    s_add_u32 s25, s25, s26
    s_add_u32 s25, s25, 0x1000000
    s_add_u32 s26, s25, 131072
    s_lshl_b32 s63, s13, 3
    s_add_u32 s63, s63, s3
    s_lshl_b32 s63, s63, 5
    s_add_u32 s63, s63, s12
    s_lshl_b32 s63, s63, 2
    s_waitcnt lgkmcnt(3)
    v_mfma_f32_16x16x32_bf16 v[184:187], v[232:235], v[24:27], 0
    v_mfma_f32_16x16x32_bf16 v[188:191], v[232:235], v[28:31], 0
    ds_read_b128 v[224:227], v5 offset:4096
    s_waitcnt lgkmcnt(3)
    v_mfma_f32_16x16x32_bf16 v[192:195], v[236:239], v[24:27], 0
    s_add_u32 s22, s21, 0x90000
    s_add_u32 m0, s20, 0x18000
    s_nop 0
    buffer_load_dwordx4 v2, s[8:11], s22 offen sc1 lds
    v_mfma_f32_16x16x32_bf16 v[196:199], v[236:239], v[28:31], 0
    ds_read_b128 v[228:231], v5 offset:5120
    s_waitcnt lgkmcnt(3)
    v_mfma_f32_16x16x32_bf16 v[184:187], v[240:243], v[32:35], v[184:187]
    v_mfma_f32_16x16x32_bf16 v[188:191], v[240:243], v[36:39], v[188:191]
    ds_read_b128 v[232:235], v5 offset:6144
    s_waitcnt lgkmcnt(3)
    v_mfma_f32_16x16x32_bf16 v[192:195], v[244:247], v[32:35], v[192:195]
    v_mfma_f32_16x16x32_bf16 v[196:199], v[244:247], v[36:39], v[196:199]
    ds_read_b128 v[236:239], v5 offset:7168
    s_waitcnt lgkmcnt(3)
    v_mfma_f32_16x16x32_bf16 v[184:187], v[224:227], v[40:43], v[184:187]
    v_mfma_f32_16x16x32_bf16 v[188:191], v[224:227], v[44:47], v[188:191]
    ds_read_b128 v[240:243], v5 offset:8192
    s_waitcnt lgkmcnt(3)
    v_mfma_f32_16x16x32_bf16 v[192:195], v[228:231], v[40:43], v[192:195]
    s_add_u32 s22, s21, 0x90400
    s_add_u32 m0, s20, 0x18400
    s_nop 0
    buffer_load_dwordx4 v2, s[8:11], s22 offen sc1 lds
    v_mfma_f32_16x16x32_bf16 v[196:199], v[228:231], v[44:47], v[196:199]
    ds_read_b128 v[244:247], v5 offset:9216
    s_waitcnt lgkmcnt(3)
    v_mfma_f32_16x16x32_bf16 v[184:187], v[232:235], v[48:51], v[184:187]
    v_mfma_f32_16x16x32_bf16 v[188:191], v[232:235], v[52:55], v[188:191]
    ds_read_b128 v[224:227], v5 offset:10240
    s_waitcnt lgkmcnt(3)
    v_mfma_f32_16x16x32_bf16 v[192:195], v[236:239], v[48:51], v[192:195]
    v_mfma_f32_16x16x32_bf16 v[196:199], v[236:239], v[52:55], v[196:199]
    ds_read_b128 v[228:231], v5 offset:11264
    s_waitcnt lgkmcnt(3)
    v_mfma_f32_16x16x32_bf16 v[184:187], v[240:243], v[56:59], v[184:187]
    v_mfma_f32_16x16x32_bf16 v[188:191], v[240:243], v[60:63], v[188:191]
    ds_read_b128 v[232:235], v5 offset:12288
    s_waitcnt lgkmcnt(3)
    v_mfma_f32_16x16x32_bf16 v[192:195], v[244:247], v[56:59], v[192:195]
    v_mfma_f32_16x16x32_bf16 v[196:199], v[244:247], v[60:63], v[196:199]
    ds_read_b128 v[236:239], v5 offset:13312
    s_waitcnt lgkmcnt(3)
    v_mfma_f32_16x16x32_bf16 v[184:187], v[224:227], v[64:67], v[184:187]
    v_mfma_f32_16x16x32_bf16 v[188:191], v[224:227], v[68:71], v[188:191]
    ds_read_b128 v[240:243], v5 offset:14336
    s_waitcnt lgkmcnt(3)
    v_mfma_f32_16x16x32_bf16 v[192:195], v[228:231], v[64:67], v[192:195]
    v_mfma_f32_16x16x32_bf16 v[196:199], v[228:231], v[68:71], v[196:199]
    ds_read_b128 v[244:247], v5 offset:15360
    s_waitcnt lgkmcnt(3)
    v_mfma_f32_16x16x32_bf16 v[184:187], v[232:235], v[72:75], v[184:187]
    v_mfma_f32_16x16x32_bf16 v[188:191], v[232:235], v[76:79], v[188:191]
    s_waitcnt vmcnt(12)
    s_barrier
    ds_read_b128 v[224:227], v5 offset:16384
    s_waitcnt lgkmcnt(3)
    v_mfma_f32_16x16x32_bf16 v[192:195], v[236:239], v[72:75], v[192:195]
    v_mfma_f32_16x16x32_bf16 v[196:199], v[236:239], v[76:79], v[196:199]
    s_add_u32 s22, s21, 0x94000
    s_add_u32 m0, s20, 0x1c000
    s_nop 0
    buffer_load_dwordx4 v2, s[8:11], s22 offen sc1 lds
    ds_read_b128 v[228:231], v5 offset:17408
    s_waitcnt lgkmcnt(3)
    v_mfma_f32_16x16x32_bf16 v[184:187], v[240:243], v[80:83], v[184:187]
    v_mfma_f32_16x16x32_bf16 v[188:191], v[240:243], v[84:87], v[188:191]
    ds_read_b128 v[232:235], v5 offset:18432
    s_waitcnt lgkmcnt(3)
    v_mfma_f32_16x16x32_bf16 v[192:195], v[244:247], v[80:83], v[192:195]
    v_mfma_f32_16x16x32_bf16 v[196:199], v[244:247], v[84:87], v[196:199]
    ds_read_b128 v[236:239], v5 offset:19456
    s_waitcnt lgkmcnt(3)
    v_mfma_f32_16x16x32_bf16 v[184:187], v[224:227], v[88:91], v[184:187]
    v_mfma_f32_16x16x32_bf16 v[188:191], v[224:227], v[92:95], v[188:191]
    ds_read_b128 v[240:243], v5 offset:20480
    s_waitcnt lgkmcnt(3)
    v_mfma_f32_16x16x32_bf16 v[192:195], v[228:231], v[88:91], v[192:195]
    v_mfma_f32_16x16x32_bf16 v[196:199], v[228:231], v[92:95], v[196:199]
    s_add_u32 s22, s21, 0x94400
    s_add_u32 m0, s20, 0x1c400
    s_nop 0
    buffer_load_dwordx4 v2, s[8:11], s22 offen sc1 lds
    ds_read_b128 v[244:247], v5 offset:21504
    s_waitcnt lgkmcnt(3)
    v_mfma_f32_16x16x32_bf16 v[184:187], v[232:235], v[96:99], v[184:187]
    v_mfma_f32_16x16x32_bf16 v[188:191], v[232:235], v[100:103], v[188:191]
    ds_read_b128 v[224:227], v5 offset:22528
    s_waitcnt lgkmcnt(3)
    v_mfma_f32_16x16x32_bf16 v[192:195], v[236:239], v[96:99], v[192:195]
    v_mfma_f32_16x16x32_bf16 v[196:199], v[236:239], v[100:103], v[196:199]
    ds_read_b128 v[228:231], v5 offset:23552
    s_waitcnt lgkmcnt(3)
    v_mfma_f32_16x16x32_bf16 v[184:187], v[240:243], v[104:107], v[184:187]
    v_mfma_f32_16x16x32_bf16 v[188:191], v[240:243], v[108:111], v[188:191]
    ds_read_b128 v[232:235], v5 offset:24576
    s_waitcnt lgkmcnt(3)
    v_mfma_f32_16x16x32_bf16 v[192:195], v[244:247], v[104:107], v[192:195]
    v_mfma_f32_16x16x32_bf16 v[196:199], v[244:247], v[108:111], v[196:199]
    ds_read_b128 v[236:239], v5 offset:25600
    s_waitcnt lgkmcnt(3)
    v_mfma_f32_16x16x32_bf16 v[184:187], v[224:227], v[112:115], v[184:187]
    v_mfma_f32_16x16x32_bf16 v[188:191], v[224:227], v[116:119], v[188:191]
    ds_read_b128 v[240:243], v5 offset:26624
    s_waitcnt lgkmcnt(3)
    v_mfma_f32_16x16x32_bf16 v[192:195], v[228:231], v[112:115], v[192:195]
    v_mfma_f32_16x16x32_bf16 v[196:199], v[228:231], v[116:119], v[196:199]
    ds_read_b128 v[244:247], v5 offset:27648
    s_waitcnt lgkmcnt(3)
    v_mfma_f32_16x16x32_bf16 v[184:187], v[232:235], v[120:123], v[184:187]
    v_mfma_f32_16x16x32_bf16 v[188:191], v[232:235], v[124:127], v[188:191]
    ds_read_b128 v[224:227], v5 offset:28672
    s_waitcnt lgkmcnt(3)
    v_mfma_f32_16x16x32_bf16 v[192:195], v[236:239], v[120:123], v[192:195]
    v_mfma_f32_16x16x32_bf16 v[196:199], v[236:239], v[124:127], v[196:199]
    ds_read_b128 v[228:231], v5 offset:29696
    s_waitcnt lgkmcnt(3)
    v_mfma_f32_16x16x32_bf16 v[184:187], v[240:243], v[128:131], v[184:187]
    v_mfma_f32_16x16x32_bf16 v[188:191], v[240:243], v[132:135], v[188:191]
    ds_read_b128 v[232:235], v5 offset:30720
    s_waitcnt lgkmcnt(3)
    v_mfma_f32_16x16x32_bf16 v[192:195], v[244:247], v[128:131], v[192:195]
    v_mfma_f32_16x16x32_bf16 v[196:199], v[244:247], v[132:135], v[196:199]
    ds_read_b128 v[236:239], v5 offset:31744
    s_waitcnt lgkmcnt(3)
    v_mfma_f32_16x16x32_bf16 v[184:187], v[224:227], v[136:139], v[184:187]
    v_mfma_f32_16x16x32_bf16 v[188:191], v[224:227], v[140:143], v[188:191]
    s_waitcnt vmcnt(9)
    s_barrier
    ds_read_b128 v[240:243], v4 offset:0
    s_waitcnt lgkmcnt(3)
    v_mfma_f32_16x16x32_bf16 v[192:195], v[228:231], v[136:139], v[192:195]
    v_mfma_f32_16x16x32_bf16 v[196:199], v[228:231], v[140:143], v[196:199]
    s_add_u32 s22, s21, 0x98000
    s_add_u32 m0, s20, 0x20000
    s_nop 0
    buffer_load_dwordx4 v2, s[8:11], s22 offen sc1 lds
    ds_read_b128 v[244:247], v4 offset:1024
    s_waitcnt lgkmcnt(3)
    v_mfma_f32_16x16x32_bf16 v[184:187], v[232:235], v[144:147], v[184:187]
    v_mfma_f32_16x16x32_bf16 v[188:191], v[232:235], v[148:151], v[188:191]
    ds_read_b128 v[224:227], v4 offset:2048
    s_waitcnt lgkmcnt(3)
    v_mfma_f32_16x16x32_bf16 v[192:195], v[236:239], v[144:147], v[192:195]
    v_mfma_f32_16x16x32_bf16 v[196:199], v[236:239], v[148:151], v[196:199]
    ds_read_b128 v[228:231], v4 offset:3072
    s_waitcnt lgkmcnt(3)
    v_mfma_f32_16x16x32_bf16 v[200:203], v[240:243], v[24:27], 0
    v_mfma_f32_16x16x32_bf16 v[204:207], v[240:243], v[28:31], 0
    ds_read_b128 v[232:235], v4 offset:4096
    s_waitcnt lgkmcnt(3)
    v_mfma_f32_16x16x32_bf16 v[208:211], v[244:247], v[24:27], 0
    v_mfma_f32_16x16x32_bf16 v[212:215], v[244:247], v[28:31], 0
    s_add_u32 s22, s21, 0x98400
    s_add_u32 m0, s20, 0x20400
    s_nop 0
    buffer_load_dwordx4 v2, s[8:11], s22 offen sc1 lds
    ds_read_b128 v[236:239], v4 offset:5120
    v_mul_f32 v184, v184, v9
    s_waitcnt lgkmcnt(3)
    v_mfma_f32_16x16x32_bf16 v[200:203], v[224:227], v[32:35], v[200:203]
    v_mul_f32 v185, v185, v9
    v_mfma_f32_16x16x32_bf16 v[204:207], v[224:227], v[36:39], v[204:207]
    ds_read_b128 v[240:243], v4 offset:6144
    v_mul_f32 v186, v186, v9
    s_waitcnt lgkmcnt(3)
    v_mfma_f32_16x16x32_bf16 v[208:211], v[228:231], v[32:35], v[208:211]
    v_mul_f32 v187, v187, v9
    v_mfma_f32_16x16x32_bf16 v[212:215], v[228:231], v[36:39], v[212:215]
    ds_read_b128 v[244:247], v4 offset:7168
    v_mul_f32 v192, v192, v9
    s_waitcnt lgkmcnt(3)
    v_mfma_f32_16x16x32_bf16 v[200:203], v[232:235], v[40:43], v[200:203]
    v_mul_f32 v193, v193, v9
    v_mfma_f32_16x16x32_bf16 v[204:207], v[232:235], v[44:47], v[204:207]
    ds_read_b128 v[224:227], v4 offset:8192
    v_mul_f32 v194, v194, v9
    s_waitcnt lgkmcnt(3)
    v_mfma_f32_16x16x32_bf16 v[208:211], v[236:239], v[40:43], v[208:211]
    v_mul_f32 v195, v195, v9
    v_mfma_f32_16x16x32_bf16 v[212:215], v[236:239], v[44:47], v[212:215]
    ds_read_b128 v[228:231], v4 offset:9216
    v_cvt_pk_bf16_f32 v216, v184, v185
    s_waitcnt lgkmcnt(3)
    v_mfma_f32_16x16x32_bf16 v[200:203], v[240:243], v[48:51], v[200:203]
    v_cvt_pk_bf16_f32 v217, v186, v187
    v_mfma_f32_16x16x32_bf16 v[204:207], v[240:243], v[52:55], v[204:207]
    ds_read_b128 v[232:235], v4 offset:10240
    v_cvt_pk_bf16_f32 v218, v192, v193
    s_waitcnt lgkmcnt(3)
    v_mfma_f32_16x16x32_bf16 v[208:211], v[244:247], v[48:51], v[208:211]
    v_cvt_pk_bf16_f32 v219, v194, v195
    v_mfma_f32_16x16x32_bf16 v[212:215], v[244:247], v[52:55], v[212:215]
    ds_read_b128 v[236:239], v4 offset:11264
    buffer_store_dwordx4 v[216:219], v2, s[8:11], s25 offen offset:0 sc1
    s_waitcnt lgkmcnt(3)
    v_mfma_f32_16x16x32_bf16 v[200:203], v[224:227], v[56:59], v[200:203]
    v_mul_f32 v188, v188, v10
    v_mfma_f32_16x16x32_bf16 v[204:207], v[224:227], v[60:63], v[204:207]
    ds_read_b128 v[240:243], v4 offset:12288
    v_mul_f32 v189, v189, v10
    s_waitcnt lgkmcnt(3)
    v_mfma_f32_16x16x32_bf16 v[208:211], v[228:231], v[56:59], v[208:211]
    v_mul_f32 v190, v190, v10
    v_mfma_f32_16x16x32_bf16 v[212:215], v[228:231], v[60:63], v[212:215]
    ds_read_b128 v[244:247], v4 offset:13312
    v_mul_f32 v191, v191, v10
    s_waitcnt lgkmcnt(3)
    v_mfma_f32_16x16x32_bf16 v[200:203], v[232:235], v[64:67], v[200:203]
    v_mul_f32 v196, v196, v10
    v_mfma_f32_16x16x32_bf16 v[204:207], v[232:235], v[68:71], v[204:207]
    ds_read_b128 v[224:227], v4 offset:14336
    v_mul_f32 v197, v197, v10
    s_waitcnt lgkmcnt(3)
    v_mfma_f32_16x16x32_bf16 v[208:211], v[236:239], v[64:67], v[208:211]
    v_mul_f32 v198, v198, v10
    v_mfma_f32_16x16x32_bf16 v[212:215], v[236:239], v[68:71], v[212:215]
    ds_read_b128 v[228:231], v4 offset:15360
    v_mul_f32 v199, v199, v10
    s_waitcnt lgkmcnt(3)
    v_mfma_f32_16x16x32_bf16 v[200:203], v[240:243], v[72:75], v[200:203]
    v_cvt_pk_bf16_f32 v220, v188, v189
    v_mfma_f32_16x16x32_bf16 v[204:207], v[240:243], v[76:79], v[204:207]
    s_waitcnt vmcnt(8)
    s_barrier
    ds_read_b128 v[232:235], v4 offset:16384
    v_cvt_pk_bf16_f32 v221, v190, v191
    s_waitcnt lgkmcnt(3)
    v_mfma_f32_16x16x32_bf16 v[208:211], v[244:247], v[72:75], v[208:211]
    v_cvt_pk_bf16_f32 v222, v196, v197
    v_mfma_f32_16x16x32_bf16 v[212:215], v[244:247], v[76:79], v[212:215]
    s_add_u32 s22, s21, 0x9c000
    s_add_u32 m0, s20, 0x24000
    s_nop 0
    buffer_load_dwordx4 v2, s[8:11], s22 offen sc1 lds
    ds_read_b128 v[236:239], v4 offset:17408
    v_cvt_pk_bf16_f32 v223, v198, v199
    s_waitcnt lgkmcnt(3)
    v_mfma_f32_16x16x32_bf16 v[200:203], v[224:227], v[80:83], v[200:203]
    buffer_store_dwordx4 v[220:223], v2, s[8:11], s26 offen offset:0 sc1
    v_mfma_f32_16x16x32_bf16 v[204:207], v[224:227], v[84:87], v[204:207]
    ds_read_b128 v[240:243], v4 offset:18432
    s_waitcnt lgkmcnt(3)
    v_mfma_f32_16x16x32_bf16 v[208:211], v[228:231], v[80:83], v[208:211]
    v_mfma_f32_16x16x32_bf16 v[212:215], v[228:231], v[84:87], v[212:215]
    ds_read_b128 v[244:247], v4 offset:19456
    s_waitcnt lgkmcnt(3)
    v_mfma_f32_16x16x32_bf16 v[200:203], v[232:235], v[88:91], v[200:203]
    v_mfma_f32_16x16x32_bf16 v[204:207], v[232:235], v[92:95], v[204:207]
    ds_read_b128 v[224:227], v4 offset:20480
    s_waitcnt lgkmcnt(3)
    v_mfma_f32_16x16x32_bf16 v[208:211], v[236:239], v[88:91], v[208:211]
    v_mfma_f32_16x16x32_bf16 v[212:215], v[236:239], v[92:95], v[212:215]
    s_add_u32 s22, s21, 0x9c400
    s_add_u32 m0, s20, 0x24400
    s_nop 0
    buffer_load_dwordx4 v2, s[8:11], s22 offen sc1 lds
    ds_read_b128 v[228:231], v4 offset:21504
    s_waitcnt lgkmcnt(3)
    v_mfma_f32_16x16x32_bf16 v[200:203], v[240:243], v[96:99], v[200:203]
    v_mfma_f32_16x16x32_bf16 v[204:207], v[240:243], v[100:103], v[204:207]
    ds_read_b128 v[232:235], v4 offset:22528
    s_waitcnt lgkmcnt(3)
    v_mfma_f32_16x16x32_bf16 v[208:211], v[244:247], v[96:99], v[208:211]
    v_mfma_f32_16x16x32_bf16 v[212:215], v[244:247], v[100:103], v[212:215]
    ds_read_b128 v[236:239], v4 offset:23552
    s_waitcnt lgkmcnt(3)
    v_mfma_f32_16x16x32_bf16 v[200:203], v[224:227], v[104:107], v[200:203]
    v_mfma_f32_16x16x32_bf16 v[204:207], v[224:227], v[108:111], v[204:207]
    ds_read_b128 v[240:243], v4 offset:24576
    s_waitcnt lgkmcnt(3)
    v_mfma_f32_16x16x32_bf16 v[208:211], v[228:231], v[104:107], v[208:211]
    v_mfma_f32_16x16x32_bf16 v[212:215], v[228:231], v[108:111], v[212:215]
    ds_read_b128 v[244:247], v4 offset:25600
    s_waitcnt lgkmcnt(3)
    v_mfma_f32_16x16x32_bf16 v[200:203], v[232:235], v[112:115], v[200:203]
    v_mfma_f32_16x16x32_bf16 v[204:207], v[232:235], v[116:119], v[204:207]
    ds_read_b128 v[224:227], v4 offset:26624
    s_waitcnt lgkmcnt(3)
    v_mfma_f32_16x16x32_bf16 v[208:211], v[236:239], v[112:115], v[208:211]
    v_mfma_f32_16x16x32_bf16 v[212:215], v[236:239], v[116:119], v[212:215]
    ds_read_b128 v[228:231], v4 offset:27648
    s_waitcnt lgkmcnt(3)
    v_mfma_f32_16x16x32_bf16 v[200:203], v[240:243], v[120:123], v[200:203]
    v_mfma_f32_16x16x32_bf16 v[204:207], v[240:243], v[124:127], v[204:207]
    ds_read_b128 v[232:235], v4 offset:28672
    s_waitcnt lgkmcnt(3)
    v_mfma_f32_16x16x32_bf16 v[208:211], v[244:247], v[120:123], v[208:211]
    v_mfma_f32_16x16x32_bf16 v[212:215], v[244:247], v[124:127], v[212:215]
    ds_read_b128 v[236:239], v4 offset:29696
    s_waitcnt lgkmcnt(3)
    v_mfma_f32_16x16x32_bf16 v[200:203], v[224:227], v[128:131], v[200:203]
    v_mfma_f32_16x16x32_bf16 v[204:207], v[224:227], v[132:135], v[204:207]
    ds_read_b128 v[240:243], v4 offset:30720
    s_waitcnt lgkmcnt(3)
    v_mfma_f32_16x16x32_bf16 v[208:211], v[228:231], v[128:131], v[208:211]
    v_mfma_f32_16x16x32_bf16 v[212:215], v[228:231], v[132:135], v[212:215]
    ds_read_b128 v[244:247], v4 offset:31744
    s_waitcnt lgkmcnt(3)
    v_mfma_f32_16x16x32_bf16 v[200:203], v[232:235], v[136:139], v[200:203]
    v_mfma_f32_16x16x32_bf16 v[204:207], v[232:235], v[140:143], v[204:207]
    s_waitcnt vmcnt(8)
    s_barrier
    ds_read_b128 v[224:227], v4 offset:32768
    s_waitcnt lgkmcnt(3)
    v_mfma_f32_16x16x32_bf16 v[208:211], v[236:239], v[136:139], v[208:211]
    v_mfma_f32_16x16x32_bf16 v[212:215], v[236:239], v[140:143], v[212:215]
    s_add_u32 s22, s24, 0x0
    s_add_u32 m0, s20, 0x10000
    s_nop 0
    buffer_load_dwordx4 v3, s[4:7], s22 offen lds
    ds_read_b128 v[228:231], v4 offset:33792
    s_waitcnt lgkmcnt(3)
    v_mfma_f32_16x16x32_bf16 v[200:203], v[240:243], v[144:147], v[200:203]
    v_mfma_f32_16x16x32_bf16 v[204:207], v[240:243], v[148:151], v[204:207]
    ds_read_b128 v[232:235], v4 offset:34816
    s_waitcnt lgkmcnt(3)
    v_mfma_f32_16x16x32_bf16 v[208:211], v[244:247], v[144:147], v[208:211]
    v_mfma_f32_16x16x32_bf16 v[212:215], v[244:247], v[148:151], v[212:215]
    ds_read_b128 v[236:239], v4 offset:35840
    s_waitcnt lgkmcnt(3)
    v_mfma_f32_16x16x32_bf16 v[184:187], v[224:227], v[24:27], 0
    v_mfma_f32_16x16x32_bf16 v[188:191], v[224:227], v[28:31], 0
    ds_read_b128 v[240:243], v4 offset:36864
    s_waitcnt lgkmcnt(3)
    v_mfma_f32_16x16x32_bf16 v[192:195], v[228:231], v[24:27], 0
    v_mfma_f32_16x16x32_bf16 v[196:199], v[228:231], v[28:31], 0
    s_add_u32 s22, s24, 0x2000
    s_add_u32 m0, s20, 0x10400
    s_nop 0
    buffer_load_dwordx4 v3, s[4:7], s22 offen lds
    ds_read_b128 v[244:247], v4 offset:37888
    v_mul_f32 v200, v200, v9
    s_waitcnt lgkmcnt(3)
    v_mfma_f32_16x16x32_bf16 v[184:187], v[232:235], v[32:35], v[184:187]
    v_mul_f32 v201, v201, v9
    v_mfma_f32_16x16x32_bf16 v[188:191], v[232:235], v[36:39], v[188:191]
    ds_read_b128 v[224:227], v4 offset:38912
    v_mul_f32 v202, v202, v9
    s_waitcnt lgkmcnt(3)
    v_mfma_f32_16x16x32_bf16 v[192:195], v[236:239], v[32:35], v[192:195]
    v_mul_f32 v203, v203, v9
    v_mfma_f32_16x16x32_bf16 v[196:199], v[236:239], v[36:39], v[196:199]
    ds_read_b128 v[228:231], v4 offset:39936
    v_mul_f32 v208, v208, v9
    s_waitcnt lgkmcnt(3)
    v_mfma_f32_16x16x32_bf16 v[184:187], v[240:243], v[40:43], v[184:187]
    v_mul_f32 v209, v209, v9
    v_mfma_f32_16x16x32_bf16 v[188:191], v[240:243], v[44:47], v[188:191]
    ds_read_b128 v[232:235], v4 offset:40960
    v_mul_f32 v210, v210, v9
    s_waitcnt lgkmcnt(3)
    v_mfma_f32_16x16x32_bf16 v[192:195], v[244:247], v[40:43], v[192:195]
    v_mul_f32 v211, v211, v9
    v_mfma_f32_16x16x32_bf16 v[196:199], v[244:247], v[44:47], v[196:199]
    ds_read_b128 v[236:239], v4 offset:41984
    v_cvt_pk_bf16_f32 v216, v200, v201
    s_waitcnt lgkmcnt(3)
    v_mfma_f32_16x16x32_bf16 v[184:187], v[224:227], v[48:51], v[184:187]
    v_cvt_pk_bf16_f32 v217, v202, v203
    s_waitcnt vmcnt(3)
    s_add_u32 s16, s63, 0x570000
    v_mov_b32 v7, s28
    v_mov_b32 v8, 0
    s_mov_b64 exec, 1
    buffer_store_dword v7, v8, s[8:11], s16 offen sc1
    s_mov_b64 exec, -1
    v_mfma_f32_16x16x32_bf16 v[188:191], v[224:227], v[52:55], v[188:191]
    ds_read_b128 v[240:243], v4 offset:43008
    v_cvt_pk_bf16_f32 v218, v208, v209
    s_waitcnt lgkmcnt(3)
    v_mfma_f32_16x16x32_bf16 v[192:195], v[228:231], v[48:51], v[192:195]
    v_cvt_pk_bf16_f32 v219, v210, v211
    v_mfma_f32_16x16x32_bf16 v[196:199], v[228:231], v[52:55], v[196:199]
    ds_read_b128 v[244:247], v4 offset:44032
    buffer_store_dwordx4 v[216:219], v2, s[8:11], s25 offen offset:1024 sc1
    s_waitcnt lgkmcnt(3)
    v_mfma_f32_16x16x32_bf16 v[184:187], v[232:235], v[56:59], v[184:187]
    v_mul_f32 v204, v204, v10
    v_mfma_f32_16x16x32_bf16 v[188:191], v[232:235], v[60:63], v[188:191]
    ds_read_b128 v[224:227], v4 offset:45056
    v_mul_f32 v205, v205, v10
    s_waitcnt lgkmcnt(3)
    v_mfma_f32_16x16x32_bf16 v[192:195], v[236:239], v[56:59], v[192:195]
    v_mul_f32 v206, v206, v10
    v_mfma_f32_16x16x32_bf16 v[196:199], v[236:239], v[60:63], v[196:199]
    ds_read_b128 v[228:231], v4 offset:46080
    v_mul_f32 v207, v207, v10
    s_waitcnt lgkmcnt(3)
    v_mfma_f32_16x16x32_bf16 v[184:187], v[240:243], v[64:67], v[184:187]
    v_mul_f32 v212, v212, v10
    v_mfma_f32_16x16x32_bf16 v[188:191], v[240:243], v[68:71], v[188:191]
    ds_read_b128 v[232:235], v4 offset:47104
    v_mul_f32 v213, v213, v10
    s_waitcnt lgkmcnt(3)
    v_mfma_f32_16x16x32_bf16 v[192:195], v[244:247], v[64:67], v[192:195]
    v_mul_f32 v214, v214, v10
    v_mfma_f32_16x16x32_bf16 v[196:199], v[244:247], v[68:71], v[196:199]
    ds_read_b128 v[236:239], v4 offset:48128
    v_mul_f32 v215, v215, v10
    s_waitcnt lgkmcnt(3)
    v_mfma_f32_16x16x32_bf16 v[184:187], v[224:227], v[72:75], v[184:187]
    v_cvt_pk_bf16_f32 v220, v204, v205
    v_mfma_f32_16x16x32_bf16 v[188:191], v[224:227], v[76:79], v[188:191]
    s_barrier
    ds_read_b128 v[240:243], v4 offset:49152
    v_cvt_pk_bf16_f32 v221, v206, v207
    s_waitcnt lgkmcnt(3)
    v_mfma_f32_16x16x32_bf16 v[192:195], v[228:231], v[72:75], v[192:195]
    v_cvt_pk_bf16_f32 v222, v212, v213
    v_mfma_f32_16x16x32_bf16 v[196:199], v[228:231], v[76:79], v[196:199]
    s_add_u32 s22, s24, 0x80000
    s_add_u32 m0, s20, 0x14000
    s_nop 0
    buffer_load_dwordx4 v3, s[4:7], s22 offen lds
    ds_read_b128 v[244:247], v4 offset:50176
    v_cvt_pk_bf16_f32 v223, v214, v215
    s_waitcnt lgkmcnt(3)
    v_mfma_f32_16x16x32_bf16 v[184:187], v[232:235], v[80:83], v[184:187]
    buffer_store_dwordx4 v[220:223], v2, s[8:11], s26 offen offset:1024 sc1
    v_mfma_f32_16x16x32_bf16 v[188:191], v[232:235], v[84:87], v[188:191]
    ds_read_b128 v[224:227], v4 offset:51200
    s_waitcnt lgkmcnt(3)
    v_mfma_f32_16x16x32_bf16 v[192:195], v[236:239], v[80:83], v[192:195]
    v_mfma_f32_16x16x32_bf16 v[196:199], v[236:239], v[84:87], v[196:199]
    ds_read_b128 v[228:231], v4 offset:52224
    s_waitcnt lgkmcnt(3)
    v_mfma_f32_16x16x32_bf16 v[184:187], v[240:243], v[88:91], v[184:187]
    v_mfma_f32_16x16x32_bf16 v[188:191], v[240:243], v[92:95], v[188:191]
    ds_read_b128 v[232:235], v4 offset:53248
    s_waitcnt lgkmcnt(3)
    v_mfma_f32_16x16x32_bf16 v[192:195], v[244:247], v[88:91], v[192:195]
    v_mfma_f32_16x16x32_bf16 v[196:199], v[244:247], v[92:95], v[196:199]
    s_add_u32 s22, s24, 0x82000
    s_add_u32 m0, s20, 0x14400
    s_nop 0
    buffer_load_dwordx4 v3, s[4:7], s22 offen lds
    ds_read_b128 v[236:239], v4 offset:54272
    s_waitcnt lgkmcnt(3)
    v_mfma_f32_16x16x32_bf16 v[184:187], v[224:227], v[96:99], v[184:187]
    v_mfma_f32_16x16x32_bf16 v[188:191], v[224:227], v[100:103], v[188:191]
    ds_read_b128 v[240:243], v4 offset:55296
    s_waitcnt lgkmcnt(3)
    v_mfma_f32_16x16x32_bf16 v[192:195], v[228:231], v[96:99], v[192:195]
    v_mfma_f32_16x16x32_bf16 v[196:199], v[228:231], v[100:103], v[196:199]
    ds_read_b128 v[244:247], v4 offset:56320
    s_waitcnt lgkmcnt(3)
    v_mfma_f32_16x16x32_bf16 v[184:187], v[232:235], v[104:107], v[184:187]
    v_mfma_f32_16x16x32_bf16 v[188:191], v[232:235], v[108:111], v[188:191]
    ds_read_b128 v[224:227], v4 offset:57344
    s_waitcnt lgkmcnt(3)
    v_mfma_f32_16x16x32_bf16 v[192:195], v[236:239], v[104:107], v[192:195]
    v_mfma_f32_16x16x32_bf16 v[196:199], v[236:239], v[108:111], v[196:199]
    ds_read_b128 v[228:231], v4 offset:58368
    s_waitcnt lgkmcnt(3)
    v_mfma_f32_16x16x32_bf16 v[184:187], v[240:243], v[112:115], v[184:187]
    v_mfma_f32_16x16x32_bf16 v[188:191], v[240:243], v[116:119], v[188:191]
    ds_read_b128 v[232:235], v4 offset:59392
    s_waitcnt lgkmcnt(3)
    v_mfma_f32_16x16x32_bf16 v[192:195], v[244:247], v[112:115], v[192:195]
    v_mfma_f32_16x16x32_bf16 v[196:199], v[244:247], v[116:119], v[196:199]
    ds_read_b128 v[236:239], v4 offset:60416
    s_waitcnt lgkmcnt(3)
    v_mfma_f32_16x16x32_bf16 v[184:187], v[224:227], v[120:123], v[184:187]
    v_mfma_f32_16x16x32_bf16 v[188:191], v[224:227], v[124:127], v[188:191]
    ds_read_b128 v[240:243], v4 offset:61440
    s_waitcnt lgkmcnt(3)
    v_mfma_f32_16x16x32_bf16 v[192:195], v[228:231], v[120:123], v[192:195]
    v_mfma_f32_16x16x32_bf16 v[196:199], v[228:231], v[124:127], v[196:199]
    ds_read_b128 v[244:247], v4 offset:62464
    s_waitcnt lgkmcnt(3)
    v_mfma_f32_16x16x32_bf16 v[184:187], v[232:235], v[128:131], v[184:187]
    v_mfma_f32_16x16x32_bf16 v[188:191], v[232:235], v[132:135], v[188:191]
    ds_read_b128 v[224:227], v4 offset:63488
    s_waitcnt lgkmcnt(3)
    v_mfma_f32_16x16x32_bf16 v[192:195], v[236:239], v[128:131], v[192:195]
    v_mfma_f32_16x16x32_bf16 v[196:199], v[236:239], v[132:135], v[196:199]
    ds_read_b128 v[228:231], v4 offset:64512
    s_waitcnt lgkmcnt(3)
    v_mfma_f32_16x16x32_bf16 v[184:187], v[240:243], v[136:139], v[184:187]
    v_mfma_f32_16x16x32_bf16 v[188:191], v[240:243], v[140:143], v[188:191]
    s_barrier
    ds_read_b128 v[232:235], v5 offset:0
    s_waitcnt lgkmcnt(3)
    v_mfma_f32_16x16x32_bf16 v[192:195], v[244:247], v[136:139], v[192:195]
    v_mfma_f32_16x16x32_bf16 v[196:199], v[244:247], v[140:143], v[196:199]
    s_add_u32 s22, s24, 0x100000
    s_add_u32 m0, s20, 0x18000
    s_nop 0
    buffer_load_dwordx4 v3, s[4:7], s22 offen lds
    ds_read_b128 v[236:239], v5 offset:1024
    s_waitcnt lgkmcnt(3)
    v_mfma_f32_16x16x32_bf16 v[184:187], v[224:227], v[144:147], v[184:187]
    v_mfma_f32_16x16x32_bf16 v[188:191], v[224:227], v[148:151], v[188:191]
    ds_read_b128 v[240:243], v5 offset:2048
    s_waitcnt lgkmcnt(3)
    v_mfma_f32_16x16x32_bf16 v[192:195], v[228:231], v[144:147], v[192:195]
    v_mfma_f32_16x16x32_bf16 v[196:199], v[228:231], v[148:151], v[196:199]
    ds_read_b128 v[244:247], v5 offset:3072
    s_waitcnt lgkmcnt(3)
    v_mfma_f32_16x16x32_bf16 v[200:203], v[232:235], v[24:27], 0
    v_mfma_f32_16x16x32_bf16 v[204:207], v[232:235], v[28:31], 0
    ds_read_b128 v[224:227], v5 offset:4096
    s_waitcnt lgkmcnt(3)
    v_mfma_f32_16x16x32_bf16 v[208:211], v[236:239], v[24:27], 0
    v_mfma_f32_16x16x32_bf16 v[212:215], v[236:239], v[28:31], 0
    s_add_u32 s22, s24, 0x102000
    s_add_u32 m0, s20, 0x18400
    s_nop 0
    buffer_load_dwordx4 v3, s[4:7], s22 offen lds
    ds_read_b128 v[228:231], v5 offset:5120
    v_mul_f32 v184, v184, v9
    s_waitcnt lgkmcnt(3)
    v_mfma_f32_16x16x32_bf16 v[200:203], v[240:243], v[32:35], v[200:203]
    v_mul_f32 v185, v185, v9
    s_bfe_u32 s30, s2, 0x20001
    s_lshl_b32 s30, s30, 2
    s_bfe_u32 s17, s2, 0x20003
    s_add_u32 s30, s30, s17
    s_lshr_b32 s31, s2, 5
    s_and_b32 s17, s3, 3
    s_lshl_b32 s19, s30, 2
    s_add_u32 s19, s19, s17
    s_and_b32 s16, s2, 1
    s_lshl_b32 s17, s19, 18
    s_lshl_b32 s23, s16, 16
    s_add_u32 s17, s17, s23
    s_add_u32 s17, s17, 0x1001000
    v_add_u32 v6, s17, v2
    s_lshl_b32 s19, s19, 7
    s_lshl_b32 s23, s16, 6
    s_add_u32 s19, s19, s23
    s_add_u32 s19, s19, 0x570000
    v_and_b32 v13, 15, v1
    v_lshlrev_b32 v13, 2, v13
    buffer_load_dword v12, v13, s[8:11], s19 offen sc1
    v_mfma_f32_16x16x32_bf16 v[204:207], v[240:243], v[36:39], v[204:207]
    ds_read_b128 v[232:235], v5 offset:6144
    v_mul_f32 v186, v186, v9
    s_waitcnt lgkmcnt(3)
    v_mfma_f32_16x16x32_bf16 v[208:211], v[244:247], v[32:35], v[208:211]
    v_mul_f32 v187, v187, v9
    v_mfma_f32_16x16x32_bf16 v[212:215], v[244:247], v[36:39], v[212:215]
    ds_read_b128 v[236:239], v5 offset:7168
    v_mul_f32 v192, v192, v9
    s_waitcnt lgkmcnt(3)
    v_mfma_f32_16x16x32_bf16 v[200:203], v[224:227], v[40:43], v[200:203]
    v_mul_f32 v193, v193, v9
    v_mfma_f32_16x16x32_bf16 v[204:207], v[224:227], v[44:47], v[204:207]
    ds_read_b128 v[240:243], v5 offset:8192
    v_mul_f32 v194, v194, v9
    s_waitcnt lgkmcnt(3)
    v_mfma_f32_16x16x32_bf16 v[208:211], v[228:231], v[40:43], v[208:211]
    v_mul_f32 v195, v195, v9
    v_mfma_f32_16x16x32_bf16 v[212:215], v[228:231], v[44:47], v[212:215]
    ds_read_b128 v[244:247], v5 offset:9216
    v_cvt_pk_bf16_f32 v216, v184, v185
    s_waitcnt lgkmcnt(3)
    v_mfma_f32_16x16x32_bf16 v[200:203], v[232:235], v[48:51], v[200:203]
    v_cvt_pk_bf16_f32 v217, v186, v187
    v_mfma_f32_16x16x32_bf16 v[204:207], v[232:235], v[52:55], v[204:207]
    ds_read_b128 v[224:227], v5 offset:10240
    v_cvt_pk_bf16_f32 v218, v192, v193
    s_waitcnt lgkmcnt(3)
    v_mfma_f32_16x16x32_bf16 v[208:211], v[236:239], v[48:51], v[208:211]
    v_cvt_pk_bf16_f32 v219, v194, v195
    v_mfma_f32_16x16x32_bf16 v[212:215], v[236:239], v[52:55], v[212:215]
    ds_read_b128 v[228:231], v5 offset:11264
    buffer_store_dwordx4 v[216:219], v2, s[8:11], s25 offen offset:2048 sc1
    s_waitcnt lgkmcnt(3)
    v_mfma_f32_16x16x32_bf16 v[200:203], v[240:243], v[56:59], v[200:203]
    v_mul_f32 v188, v188, v10
    v_mfma_f32_16x16x32_bf16 v[204:207], v[240:243], v[60:63], v[204:207]
    ds_read_b128 v[232:235], v5 offset:12288
    v_mul_f32 v189, v189, v10
    s_waitcnt lgkmcnt(3)
    v_mfma_f32_16x16x32_bf16 v[208:211], v[244:247], v[56:59], v[208:211]
    v_mul_f32 v190, v190, v10
    v_mfma_f32_16x16x32_bf16 v[212:215], v[244:247], v[60:63], v[212:215]
    ds_read_b128 v[236:239], v5 offset:13312
    v_mul_f32 v191, v191, v10
    s_waitcnt lgkmcnt(3)
    v_mfma_f32_16x16x32_bf16 v[200:203], v[224:227], v[64:67], v[200:203]
    v_mul_f32 v196, v196, v10
    v_mfma_f32_16x16x32_bf16 v[204:207], v[224:227], v[68:71], v[204:207]
    ds_read_b128 v[240:243], v5 offset:14336
    v_mul_f32 v197, v197, v10
    s_waitcnt lgkmcnt(3)
    v_mfma_f32_16x16x32_bf16 v[208:211], v[228:231], v[64:67], v[208:211]
    v_mul_f32 v198, v198, v10
    v_mfma_f32_16x16x32_bf16 v[212:215], v[228:231], v[68:71], v[212:215]
    ds_read_b128 v[244:247], v5 offset:15360
    v_mul_f32 v199, v199, v10
    s_waitcnt lgkmcnt(3)
    v_mfma_f32_16x16x32_bf16 v[200:203], v[232:235], v[72:75], v[200:203]
    v_cvt_pk_bf16_f32 v220, v188, v189
    v_mfma_f32_16x16x32_bf16 v[204:207], v[232:235], v[76:79], v[204:207]
    s_waitcnt vmcnt(11)
    s_barrier
    ds_read_b128 v[224:227], v5 offset:16384
    v_cvt_pk_bf16_f32 v221, v190, v191
    s_waitcnt lgkmcnt(3)
    v_mfma_f32_16x16x32_bf16 v[208:211], v[236:239], v[72:75], v[208:211]
    v_cvt_pk_bf16_f32 v222, v196, v197
    v_mfma_f32_16x16x32_bf16 v[212:215], v[236:239], v[76:79], v[212:215]
    s_add_u32 s22, s24, 0x180000
    s_add_u32 m0, s20, 0x1c000
    s_nop 0
    buffer_load_dwordx4 v3, s[4:7], s22 offen lds
    ds_read_b128 v[228:231], v5 offset:17408
    v_cvt_pk_bf16_f32 v223, v198, v199
    s_waitcnt lgkmcnt(3)
    v_mfma_f32_16x16x32_bf16 v[200:203], v[240:243], v[80:83], v[200:203]
    buffer_store_dwordx4 v[220:223], v2, s[8:11], s26 offen offset:2048 sc1
    v_mfma_f32_16x16x32_bf16 v[204:207], v[240:243], v[84:87], v[204:207]
    ds_read_b128 v[232:235], v5 offset:18432
    s_waitcnt lgkmcnt(3)
    v_mfma_f32_16x16x32_bf16 v[208:211], v[244:247], v[80:83], v[208:211]
    v_mfma_f32_16x16x32_bf16 v[212:215], v[244:247], v[84:87], v[212:215]
    ds_read_b128 v[236:239], v5 offset:19456
    s_waitcnt lgkmcnt(3)
    v_mfma_f32_16x16x32_bf16 v[200:203], v[224:227], v[88:91], v[200:203]
    v_mfma_f32_16x16x32_bf16 v[204:207], v[224:227], v[92:95], v[204:207]
    ds_read_b128 v[240:243], v5 offset:20480
    s_waitcnt vmcnt(3)
    v_cmp_ne_u32 vcc, s28, v12
    s_cbranch_vccnz adaLN_cond__sliding_block_cached__moe_arch_mod__prompt_kernel_o17r
adaLN_cond__sliding_block_cached__moe_arch_mod__prompt_kernel_o17b:
    s_waitcnt lgkmcnt(3)
    v_mfma_f32_16x16x32_bf16 v[208:211], v[228:231], v[88:91], v[208:211]
    s_mov_b32 s23, 0x0
    buffer_load_dwordx4 v[24:27], v6, s[8:11], s23 offen offset:0 sc1
    v_mfma_f32_16x16x32_bf16 v[212:215], v[228:231], v[92:95], v[212:215]
    s_add_u32 s22, s24, 0x182000
    s_add_u32 m0, s20, 0x1c400
    s_nop 0
    buffer_load_dwordx4 v3, s[4:7], s22 offen lds
    ds_read_b128 v[244:247], v5 offset:21504
    s_waitcnt lgkmcnt(3)
    v_mfma_f32_16x16x32_bf16 v[200:203], v[232:235], v[96:99], v[200:203]
    v_mfma_f32_16x16x32_bf16 v[204:207], v[232:235], v[100:103], v[204:207]
    ds_read_b128 v[224:227], v5 offset:22528
    s_mov_b32 s23, 0x20000
    buffer_load_dwordx4 v[28:31], v6, s[8:11], s23 offen offset:0 sc1
    s_waitcnt lgkmcnt(3)
    v_mfma_f32_16x16x32_bf16 v[208:211], v[236:239], v[96:99], v[208:211]
    s_add_u32 s16, s63, 0x572000
    v_mov_b32 v14, s28
    v_mov_b32 v15, 0
    s_mov_b64 exec, 1
    buffer_store_dword v14, v15, s[8:11], s16 offen sc1
    s_mov_b64 exec, -1
    v_mfma_f32_16x16x32_bf16 v[212:215], v[236:239], v[100:103], v[212:215]
    ds_read_b128 v[228:231], v5 offset:23552
    s_waitcnt lgkmcnt(3)
    v_mfma_f32_16x16x32_bf16 v[200:203], v[240:243], v[104:107], v[200:203]
    v_mfma_f32_16x16x32_bf16 v[204:207], v[240:243], v[108:111], v[204:207]
    ds_read_b128 v[232:235], v5 offset:24576
    s_mov_b32 s23, 0x2000
    buffer_load_dwordx4 v[32:35], v6, s[8:11], s23 offen offset:0 sc1
    s_waitcnt lgkmcnt(3)
    v_mfma_f32_16x16x32_bf16 v[208:211], v[244:247], v[104:107], v[208:211]
    v_mfma_f32_16x16x32_bf16 v[212:215], v[244:247], v[108:111], v[212:215]
    ds_read_b128 v[236:239], v5 offset:25600
    s_waitcnt lgkmcnt(3)
    v_mfma_f32_16x16x32_bf16 v[200:203], v[224:227], v[112:115], v[200:203]
    s_mov_b32 s23, 0x22000
    buffer_load_dwordx4 v[36:39], v6, s[8:11], s23 offen offset:0 sc1
    v_mfma_f32_16x16x32_bf16 v[204:207], v[224:227], v[116:119], v[204:207]
    ds_read_b128 v[240:243], v5 offset:26624
    s_waitcnt lgkmcnt(3)
    v_mfma_f32_16x16x32_bf16 v[208:211], v[228:231], v[112:115], v[208:211]
    v_mfma_f32_16x16x32_bf16 v[212:215], v[228:231], v[116:119], v[212:215]
    ds_read_b128 v[244:247], v5 offset:27648
    s_waitcnt lgkmcnt(3)
    v_mfma_f32_16x16x32_bf16 v[200:203], v[232:235], v[120:123], v[200:203]
    s_mov_b32 s23, 0x4000
    buffer_load_dwordx4 v[40:43], v6, s[8:11], s23 offen offset:0 sc1
    v_mfma_f32_16x16x32_bf16 v[204:207], v[232:235], v[124:127], v[204:207]
    ds_read_b128 v[224:227], v5 offset:28672
    s_waitcnt lgkmcnt(3)
    v_mfma_f32_16x16x32_bf16 v[208:211], v[236:239], v[120:123], v[208:211]
    v_mfma_f32_16x16x32_bf16 v[212:215], v[236:239], v[124:127], v[212:215]
    ds_read_b128 v[228:231], v5 offset:29696
    s_waitcnt lgkmcnt(3)
    v_mfma_f32_16x16x32_bf16 v[200:203], v[240:243], v[128:131], v[200:203]
    s_mov_b32 s23, 0x24000
    buffer_load_dwordx4 v[44:47], v6, s[8:11], s23 offen offset:0 sc1
    v_mfma_f32_16x16x32_bf16 v[204:207], v[240:243], v[132:135], v[204:207]
    ds_read_b128 v[232:235], v5 offset:30720
    s_waitcnt lgkmcnt(3)
    v_mfma_f32_16x16x32_bf16 v[208:211], v[244:247], v[128:131], v[208:211]
    v_mfma_f32_16x16x32_bf16 v[212:215], v[244:247], v[132:135], v[212:215]
    ds_read_b128 v[236:239], v5 offset:31744
    s_mov_b32 s23, 0x6000
    buffer_load_dwordx4 v[48:51], v6, s[8:11], s23 offen offset:0 sc1
    s_waitcnt lgkmcnt(3)
    v_mfma_f32_16x16x32_bf16 v[200:203], v[224:227], v[136:139], v[200:203]
    v_bfe_u32 v18, v1, 2, 2
    v_lshrrev_b32 v19, 4, v1
    v_mfma_f32_16x16x32_bf16 v[204:207], v[224:227], v[140:143], v[204:207]
    v_and_b32 v17, 3, v1
    v_lshlrev_b32 v16, 11, v19
    s_waitcnt lgkmcnt(2)
    v_mfma_f32_16x16x32_bf16 v[208:211], v[228:231], v[136:139], v[208:211]
    v_lshl_add_u32 v16, v18, 6, v16
    v_lshl_add_u32 v16, v17, 3, v16
    v_mfma_f32_16x16x32_bf16 v[212:215], v[228:231], v[140:143], v[212:215]
    s_mov_b32 s23, 0x26000
    buffer_load_dwordx4 v[52:55], v6, s[8:11], s23 offen offset:0 sc1
    v_add_u32 v16, 0x12000, v16
    v_and_b32 v19, 1, v19
    s_waitcnt lgkmcnt(1)
    v_mfma_f32_16x16x32_bf16 v[200:203], v[232:235], v[144:147], v[200:203]
    v_lshlrev_b32 v19, 5, v19
    v_sub_u32 v5, v16, v19
    v_mfma_f32_16x16x32_bf16 v[204:207], v[232:235], v[148:151], v[204:207]
    v_add_u32 v4, v16, v19
    v_add_u32 v7, 0x10000, v4
    s_waitcnt lgkmcnt(0)
    v_mfma_f32_16x16x32_bf16 v[208:211], v[236:239], v[144:147], v[208:211]
    v_add_u32 v8, 0x10000, v5
    v_mfma_f32_16x16x32_bf16 v[212:215], v[236:239], v[148:151], v[212:215]
    v_mul_f32 v200, v200, v9
    v_mul_f32 v201, v201, v9
    v_mul_f32 v202, v202, v9
    v_mul_f32 v203, v203, v9
    s_nop 1
    v_mul_f32 v208, v208, v9
    v_mul_f32 v209, v209, v9
    v_mul_f32 v210, v210, v9
    v_mul_f32 v211, v211, v9
    v_cvt_pk_bf16_f32 v216, v200, v201
    v_cvt_pk_bf16_f32 v217, v202, v203
    v_cvt_pk_bf16_f32 v218, v208, v209
    v_cvt_pk_bf16_f32 v219, v210, v211
    buffer_store_dwordx4 v[216:219], v2, s[8:11], s25 offen offset:3072 sc1
    v_mul_f32 v204, v204, v10
    v_mul_f32 v205, v205, v10
    v_mul_f32 v206, v206, v10
    v_mul_f32 v207, v207, v10
    v_mul_f32 v212, v212, v10
    v_mul_f32 v213, v213, v10
    v_mul_f32 v214, v214, v10
    v_mul_f32 v215, v215, v10
    v_cvt_pk_bf16_f32 v220, v204, v205
    v_cvt_pk_bf16_f32 v221, v206, v207
    v_cvt_pk_bf16_f32 v222, v212, v213
    v_cvt_pk_bf16_f32 v223, v214, v215
    buffer_store_dwordx4 v[220:223], v2, s[8:11], s26 offen offset:3072 sc1
    s_and_b32 s15, s2, 1
    s_barrier
    ds_read_b64_tr_b16 v[224:225], v4 offset:0
    ds_read_b64_tr_b16 v[226:227], v4 offset:1024
    ds_read_b64_tr_b16 v[228:229], v5 offset:32
    ds_read_b64_tr_b16 v[230:231], v5 offset:1056
    ds_read_b64_tr_b16 v[232:233], v4 offset:256
    ds_read_b64_tr_b16 v[234:235], v4 offset:1280
    ds_read_b64_tr_b16 v[236:237], v5 offset:288
    ds_read_b64_tr_b16 v[238:239], v5 offset:1312
    s_waitcnt vmcnt(11) lgkmcnt(6)
    v_mfma_f32_16x16x32_bf16 v[88:91], v[224:227], v[24:27], 0
    ds_read_b64_tr_b16 v[240:241], v4 offset:512
    s_waitcnt vmcnt(9)
    v_mfma_f32_16x16x32_bf16 v[92:95], v[224:227], v[28:31], 0
    ds_read_b64_tr_b16 v[242:243], v4 offset:1536
    s_waitcnt lgkmcnt(6)
    v_mfma_f32_16x16x32_bf16 v[96:99], v[228:231], v[24:27], 0
    ds_read_b64_tr_b16 v[244:245], v5 offset:544
    v_mfma_f32_16x16x32_bf16 v[100:103], v[228:231], v[28:31], 0
    ds_read_b64_tr_b16 v[246:247], v5 offset:1568
    s_waitcnt lgkmcnt(6)
    v_mfma_f32_16x16x32_bf16 v[104:107], v[232:235], v[24:27], 0
    ds_read_b64_tr_b16 v[224:225], v4 offset:768
    v_mfma_f32_16x16x32_bf16 v[108:111], v[232:235], v[28:31], 0
    ds_read_b64_tr_b16 v[226:227], v4 offset:1792
    s_waitcnt lgkmcnt(6)
    v_mfma_f32_16x16x32_bf16 v[112:115], v[236:239], v[24:27], 0
    ds_read_b64_tr_b16 v[228:229], v5 offset:800
    v_mfma_f32_16x16x32_bf16 v[116:119], v[236:239], v[28:31], 0
    ds_read_b64_tr_b16 v[230:231], v5 offset:1824
    s_waitcnt lgkmcnt(6)
    v_mfma_f32_16x16x32_bf16 v[120:123], v[240:243], v[24:27], 0
    s_add_u32 s22, s24, 0x200000
    s_add_u32 m0, s20, 0x20000
    s_nop 0
    buffer_load_dwordx4 v3, s[4:7], s22 offen lds
    v_mfma_f32_16x16x32_bf16 v[124:127], v[240:243], v[28:31], 0
    s_barrier
    ds_read_b64_tr_b16 v[232:233], v4 offset:16384
    ds_read_b64_tr_b16 v[234:235], v4 offset:17408
    s_waitcnt lgkmcnt(6)
    v_mfma_f32_16x16x32_bf16 v[128:131], v[244:247], v[24:27], 0
    ds_read_b64_tr_b16 v[236:237], v5 offset:16416
    s_mov_b32 s23, 0x8000
    buffer_load_dwordx4 v[56:59], v6, s[8:11], s23 offen offset:0 sc1
    v_mfma_f32_16x16x32_bf16 v[132:135], v[244:247], v[28:31], 0
    s_add_u32 s22, s24, 0x202000
    s_add_u32 m0, s20, 0x20400
    s_nop 0
    buffer_load_dwordx4 v3, s[4:7], s22 offen lds
    ds_read_b64_tr_b16 v[238:239], v5 offset:17440
    s_waitcnt lgkmcnt(6)
    v_mfma_f32_16x16x32_bf16 v[136:139], v[224:227], v[24:27], 0
    ds_read_b64_tr_b16 v[240:241], v4 offset:16640
    v_mfma_f32_16x16x32_bf16 v[140:143], v[224:227], v[28:31], 0
    ds_read_b64_tr_b16 v[242:243], v4 offset:17664
    s_mov_b32 s23, 0x28000
    buffer_load_dwordx4 v[60:63], v6, s[8:11], s23 offen offset:0 sc1
    s_waitcnt lgkmcnt(6)
    v_mfma_f32_16x16x32_bf16 v[144:147], v[228:231], v[24:27], 0
    ds_read_b64_tr_b16 v[244:245], v5 offset:16672
    v_mfma_f32_16x16x32_bf16 v[148:151], v[228:231], v[28:31], 0
    ds_read_b64_tr_b16 v[246:247], v5 offset:17696
    s_waitcnt vmcnt(11) lgkmcnt(6)
    v_mfma_f32_16x16x32_bf16 v[88:91], v[232:235], v[32:35], v[88:91]
    ds_read_b64_tr_b16 v[224:225], v4 offset:16896
    s_waitcnt vmcnt(10)
    v_mfma_f32_16x16x32_bf16 v[92:95], v[232:235], v[36:39], v[92:95]
    s_add_u32 s22, s24, 0x280000
    s_add_u32 m0, s20, 0x24000
    s_nop 0
    buffer_load_dwordx4 v3, s[4:7], s22 offen lds
    ds_read_b64_tr_b16 v[226:227], v4 offset:17920
    s_waitcnt lgkmcnt(6)
    v_mfma_f32_16x16x32_bf16 v[96:99], v[236:239], v[32:35], v[96:99]
    ds_read_b64_tr_b16 v[228:229], v5 offset:16928
    v_mfma_f32_16x16x32_bf16 v[100:103], v[236:239], v[36:39], v[100:103]
    ds_read_b64_tr_b16 v[230:231], v5 offset:17952
    s_waitcnt lgkmcnt(6)
    v_mfma_f32_16x16x32_bf16 v[104:107], v[240:243], v[32:35], v[104:107]
    s_add_u32 s22, s24, 0x282000
    s_add_u32 m0, s20, 0x24400
    s_nop 0
    buffer_load_dwordx4 v3, s[4:7], s22 offen lds
    ds_read_b64_tr_b16 v[232:233], v4 offset:17152
    v_mfma_f32_16x16x32_bf16 v[108:111], v[240:243], v[36:39], v[108:111]
    ds_read_b64_tr_b16 v[234:235], v4 offset:18176
    s_waitcnt lgkmcnt(6)
    v_mfma_f32_16x16x32_bf16 v[112:115], v[244:247], v[32:35], v[112:115]
    ds_read_b64_tr_b16 v[236:237], v5 offset:17184
    v_mfma_f32_16x16x32_bf16 v[116:119], v[244:247], v[36:39], v[116:119]
    ds_read_b64_tr_b16 v[238:239], v5 offset:18208
    s_waitcnt lgkmcnt(6)
    v_mfma_f32_16x16x32_bf16 v[120:123], v[224:227], v[32:35], v[120:123]
    v_mfma_f32_16x16x32_bf16 v[124:127], v[224:227], v[36:39], v[124:127]
    s_barrier
    ds_read_b64_tr_b16 v[240:241], v4 offset:32768
    ds_read_b64_tr_b16 v[242:243], v4 offset:33792
    s_waitcnt lgkmcnt(6)
    v_mfma_f32_16x16x32_bf16 v[128:131], v[228:231], v[32:35], v[128:131]
    ds_read_b64_tr_b16 v[244:245], v5 offset:32800
    s_mov_b32 s23, 0xa000
    buffer_load_dwordx4 v[24:27], v6, s[8:11], s23 offen offset:0 sc1
    v_mfma_f32_16x16x32_bf16 v[132:135], v[228:231], v[36:39], v[132:135]
    ds_read_b64_tr_b16 v[246:247], v5 offset:33824
    s_waitcnt lgkmcnt(6)
    v_mfma_f32_16x16x32_bf16 v[136:139], v[232:235], v[32:35], v[136:139]
    ds_read_b64_tr_b16 v[224:225], v4 offset:33024
    v_mfma_f32_16x16x32_bf16 v[140:143], v[232:235], v[36:39], v[140:143]
    ds_read_b64_tr_b16 v[226:227], v4 offset:34048
    s_mov_b32 s23, 0x2a000
    buffer_load_dwordx4 v[28:31], v6, s[8:11], s23 offen offset:0 sc1
    s_waitcnt lgkmcnt(6)
    v_mfma_f32_16x16x32_bf16 v[144:147], v[236:239], v[32:35], v[144:147]
    s_add_u32 s16, s63, 0x574000
    v_mov_b32 v14, s28
    v_mov_b32 v15, 0
    s_mov_b64 exec, 1
    buffer_store_dword v14, v15, s[8:11], s16 offen sc1
    s_mov_b64 exec, -1
    ds_read_b64_tr_b16 v[228:229], v5 offset:33056
    v_mfma_f32_16x16x32_bf16 v[148:151], v[236:239], v[36:39], v[148:151]
    ds_read_b64_tr_b16 v[230:231], v5 offset:34080
    s_waitcnt vmcnt(14) lgkmcnt(6)
    v_mfma_f32_16x16x32_bf16 v[88:91], v[240:243], v[40:43], v[88:91]
    ds_read_b64_tr_b16 v[232:233], v4 offset:33280
    s_waitcnt vmcnt(13)
    v_mfma_f32_16x16x32_bf16 v[92:95], v[240:243], v[44:47], v[92:95]
    s_add_u32 s22, s24, 0x300000
    s_add_u32 m0, s20, 0x10000
    s_nop 0
    buffer_load_dwordx4 v3, s[4:7], s22 offen lds
    ds_read_b64_tr_b16 v[234:235], v4 offset:34304
    s_waitcnt lgkmcnt(6)
    v_mfma_f32_16x16x32_bf16 v[96:99], v[244:247], v[40:43], v[96:99]
    ds_read_b64_tr_b16 v[236:237], v5 offset:33312
    v_mfma_f32_16x16x32_bf16 v[100:103], v[244:247], v[44:47], v[100:103]
    ds_read_b64_tr_b16 v[238:239], v5 offset:34336
    s_waitcnt lgkmcnt(6)
    v_mfma_f32_16x16x32_bf16 v[104:107], v[224:227], v[40:43], v[104:107]
    s_add_u32 s22, s24, 0x302000
    s_add_u32 m0, s20, 0x10400
    s_nop 0
    buffer_load_dwordx4 v3, s[4:7], s22 offen lds
    ds_read_b64_tr_b16 v[240:241], v4 offset:33536
    v_mfma_f32_16x16x32_bf16 v[108:111], v[224:227], v[44:47], v[108:111]
    ds_read_b64_tr_b16 v[242:243], v4 offset:34560
    s_waitcnt lgkmcnt(6)
    v_mfma_f32_16x16x32_bf16 v[112:115], v[228:231], v[40:43], v[112:115]
    ds_read_b64_tr_b16 v[244:245], v5 offset:33568
    v_mfma_f32_16x16x32_bf16 v[116:119], v[228:231], v[44:47], v[116:119]
    ds_read_b64_tr_b16 v[246:247], v5 offset:34592
    s_waitcnt lgkmcnt(6)
    v_mfma_f32_16x16x32_bf16 v[120:123], v[232:235], v[40:43], v[120:123]
    v_mfma_f32_16x16x32_bf16 v[124:127], v[232:235], v[44:47], v[124:127]
    s_barrier
    ds_read_b64_tr_b16 v[224:225], v4 offset:49152
    ds_read_b64_tr_b16 v[226:227], v4 offset:50176
    s_add_u32 s19, s19, 8192
    buffer_load_dword v12, v13, s[8:11], s19 offen sc1
    s_waitcnt lgkmcnt(6)
    v_mfma_f32_16x16x32_bf16 v[128:131], v[236:239], v[40:43], v[128:131]
    ds_read_b64_tr_b16 v[228:229], v5 offset:49184
    s_mov_b32 s23, 0xc000
    buffer_load_dwordx4 v[32:35], v6, s[8:11], s23 offen offset:0 sc1
    v_mfma_f32_16x16x32_bf16 v[132:135], v[236:239], v[44:47], v[132:135]
    ds_read_b64_tr_b16 v[230:231], v5 offset:50208
    s_waitcnt lgkmcnt(6)
    v_mfma_f32_16x16x32_bf16 v[136:139], v[240:243], v[40:43], v[136:139]
    ds_read_b64_tr_b16 v[232:233], v4 offset:49408
    v_mfma_f32_16x16x32_bf16 v[140:143], v[240:243], v[44:47], v[140:143]
    ds_read_b64_tr_b16 v[234:235], v4 offset:50432
    s_mov_b32 s23, 0x2c000
    buffer_load_dwordx4 v[36:39], v6, s[8:11], s23 offen offset:0 sc1
    s_waitcnt lgkmcnt(6)
    v_mfma_f32_16x16x32_bf16 v[144:147], v[244:247], v[40:43], v[144:147]
    ds_read_b64_tr_b16 v[236:237], v5 offset:49440
    v_mfma_f32_16x16x32_bf16 v[148:151], v[244:247], v[44:47], v[148:151]
    ds_read_b64_tr_b16 v[238:239], v5 offset:50464
    s_waitcnt vmcnt(17) lgkmcnt(6)
    v_mfma_f32_16x16x32_bf16 v[88:91], v[224:227], v[48:51], v[88:91]
    ds_read_b64_tr_b16 v[240:241], v4 offset:49664
    s_waitcnt vmcnt(16)
    v_mfma_f32_16x16x32_bf16 v[92:95], v[224:227], v[52:55], v[92:95]
    s_add_u32 s22, s24, 0x380000
    s_add_u32 m0, s20, 0x14000
    s_nop 0
    buffer_load_dwordx4 v3, s[4:7], s22 offen lds
    ds_read_b64_tr_b16 v[242:243], v4 offset:50688
    s_waitcnt lgkmcnt(6)
    v_mfma_f32_16x16x32_bf16 v[96:99], v[228:231], v[48:51], v[96:99]
    ds_read_b64_tr_b16 v[244:245], v5 offset:49696
    v_mfma_f32_16x16x32_bf16 v[100:103], v[228:231], v[52:55], v[100:103]
    ds_read_b64_tr_b16 v[246:247], v5 offset:50720
    s_waitcnt lgkmcnt(6)
    v_mfma_f32_16x16x32_bf16 v[104:107], v[232:235], v[48:51], v[104:107]
    s_add_u32 s22, s24, 0x382000
    s_add_u32 m0, s20, 0x14400
    s_nop 0
    buffer_load_dwordx4 v3, s[4:7], s22 offen lds
    ds_read_b64_tr_b16 v[224:225], v4 offset:49920
    v_mfma_f32_16x16x32_bf16 v[108:111], v[232:235], v[52:55], v[108:111]
    ds_read_b64_tr_b16 v[226:227], v4 offset:50944
    s_waitcnt lgkmcnt(6)
    v_mfma_f32_16x16x32_bf16 v[112:115], v[236:239], v[48:51], v[112:115]
    ds_read_b64_tr_b16 v[228:229], v5 offset:49952
    v_mfma_f32_16x16x32_bf16 v[116:119], v[236:239], v[52:55], v[116:119]
    ds_read_b64_tr_b16 v[230:231], v5 offset:50976
    s_waitcnt lgkmcnt(6)
    v_mfma_f32_16x16x32_bf16 v[120:123], v[240:243], v[48:51], v[120:123]
    v_mfma_f32_16x16x32_bf16 v[124:127], v[240:243], v[52:55], v[124:127]
    s_waitcnt vmcnt(13)
    s_barrier
    ds_read_b64_tr_b16 v[232:233], v7 offset:0
    ds_read_b64_tr_b16 v[234:235], v7 offset:1024
    s_waitcnt lgkmcnt(6)
    v_mfma_f32_16x16x32_bf16 v[128:131], v[244:247], v[48:51], v[128:131]
    ds_read_b64_tr_b16 v[236:237], v8 offset:32
    s_mov_b32 s23, 0xe000
    buffer_load_dwordx4 v[40:43], v6, s[8:11], s23 offen offset:0 sc1
    v_mfma_f32_16x16x32_bf16 v[132:135], v[244:247], v[52:55], v[132:135]
    ds_read_b64_tr_b16 v[238:239], v8 offset:1056
    s_waitcnt lgkmcnt(6)
    v_mfma_f32_16x16x32_bf16 v[136:139], v[224:227], v[48:51], v[136:139]
    ds_read_b64_tr_b16 v[240:241], v7 offset:256
    v_mfma_f32_16x16x32_bf16 v[140:143], v[224:227], v[52:55], v[140:143]
    ds_read_b64_tr_b16 v[242:243], v7 offset:1280
    s_mov_b32 s23, 0x2e000
    buffer_load_dwordx4 v[44:47], v6, s[8:11], s23 offen offset:0 sc1
    s_waitcnt lgkmcnt(6)
    v_mfma_f32_16x16x32_bf16 v[144:147], v[228:231], v[48:51], v[144:147]
    ds_read_b64_tr_b16 v[244:245], v8 offset:288
    v_mfma_f32_16x16x32_bf16 v[148:151], v[228:231], v[52:55], v[148:151]
    ds_read_b64_tr_b16 v[246:247], v8 offset:1312
    s_waitcnt vmcnt(6)
    v_cmp_ne_u32 vcc, s28, v12
    s_cbranch_vccnz adaLN_cond__sliding_block_cached__moe_arch_mod__prompt_kernel_o218r
adaLN_cond__sliding_block_cached__moe_arch_mod__prompt_kernel_o218b:
    s_waitcnt lgkmcnt(6)
    v_mfma_f32_16x16x32_bf16 v[88:91], v[232:235], v[56:59], v[88:91]
    ds_read_b64_tr_b16 v[224:225], v7 offset:512
    v_mfma_f32_16x16x32_bf16 v[92:95], v[232:235], v[60:63], v[92:95]
    s_add_u32 s22, s24, 0x10000
    s_add_u32 m0, s20, 0x18000
    s_nop 0
    buffer_load_dwordx4 v3, s[4:7], s22 offen lds
    ds_read_b64_tr_b16 v[226:227], v7 offset:1536
    s_waitcnt lgkmcnt(6)
    v_mfma_f32_16x16x32_bf16 v[96:99], v[236:239], v[56:59], v[96:99]
    ds_read_b64_tr_b16 v[228:229], v8 offset:544
    v_mfma_f32_16x16x32_bf16 v[100:103], v[236:239], v[60:63], v[100:103]
    ds_read_b64_tr_b16 v[230:231], v8 offset:1568
    s_waitcnt lgkmcnt(6)
    v_mfma_f32_16x16x32_bf16 v[104:107], v[240:243], v[56:59], v[104:107]
    s_add_u32 s22, s24, 0x12000
    s_add_u32 m0, s20, 0x18400
    s_nop 0
    buffer_load_dwordx4 v3, s[4:7], s22 offen lds
    ds_read_b64_tr_b16 v[232:233], v7 offset:768
    v_mfma_f32_16x16x32_bf16 v[108:111], v[240:243], v[60:63], v[108:111]
    ds_read_b64_tr_b16 v[234:235], v7 offset:1792
    s_waitcnt lgkmcnt(6)
    v_mfma_f32_16x16x32_bf16 v[112:115], v[244:247], v[56:59], v[112:115]
    ds_read_b64_tr_b16 v[236:237], v8 offset:800
    v_mfma_f32_16x16x32_bf16 v[116:119], v[244:247], v[60:63], v[116:119]
    ds_read_b64_tr_b16 v[238:239], v8 offset:1824
    s_waitcnt lgkmcnt(6)
    v_mfma_f32_16x16x32_bf16 v[120:123], v[224:227], v[56:59], v[120:123]
    v_mfma_f32_16x16x32_bf16 v[124:127], v[224:227], v[60:63], v[124:127]
    s_barrier
    ds_read_b64_tr_b16 v[240:241], v7 offset:16384
    ds_read_b64_tr_b16 v[242:243], v7 offset:17408
    s_waitcnt lgkmcnt(6)
    v_mfma_f32_16x16x32_bf16 v[128:131], v[228:231], v[56:59], v[128:131]
    ds_read_b64_tr_b16 v[244:245], v8 offset:16416
    s_mov_b32 s23, 0x0
    buffer_load_dwordx4 v[48:51], v6, s[8:11], s23 offen offset:1024 sc1
    v_mfma_f32_16x16x32_bf16 v[132:135], v[228:231], v[60:63], v[132:135]
    ds_read_b64_tr_b16 v[246:247], v8 offset:17440
    s_waitcnt lgkmcnt(6)
    v_mfma_f32_16x16x32_bf16 v[136:139], v[232:235], v[56:59], v[136:139]
    ds_read_b64_tr_b16 v[224:225], v7 offset:16640
    v_mfma_f32_16x16x32_bf16 v[140:143], v[232:235], v[60:63], v[140:143]
    ds_read_b64_tr_b16 v[226:227], v7 offset:17664
    s_mov_b32 s23, 0x20000
    buffer_load_dwordx4 v[52:55], v6, s[8:11], s23 offen offset:1024 sc1
    s_waitcnt lgkmcnt(6)
    v_mfma_f32_16x16x32_bf16 v[144:147], v[236:239], v[56:59], v[144:147]
    ds_read_b64_tr_b16 v[228:229], v8 offset:16672
    v_mfma_f32_16x16x32_bf16 v[148:151], v[236:239], v[60:63], v[148:151]
    ds_read_b64_tr_b16 v[230:231], v8 offset:17696
    s_waitcnt lgkmcnt(6)
    v_mfma_f32_16x16x32_bf16 v[88:91], v[240:243], v[24:27], v[88:91]
    ds_read_b64_tr_b16 v[232:233], v7 offset:16896
    v_mfma_f32_16x16x32_bf16 v[92:95], v[240:243], v[28:31], v[92:95]
    s_add_u32 s22, s24, 0x90000
    s_add_u32 m0, s20, 0x1c000
    s_nop 0
    buffer_load_dwordx4 v3, s[4:7], s22 offen lds
    ds_read_b64_tr_b16 v[234:235], v7 offset:17920
    s_waitcnt lgkmcnt(6)
    v_mfma_f32_16x16x32_bf16 v[96:99], v[244:247], v[24:27], v[96:99]
    ds_read_b64_tr_b16 v[236:237], v8 offset:16928
    v_mfma_f32_16x16x32_bf16 v[100:103], v[244:247], v[28:31], v[100:103]
    ds_read_b64_tr_b16 v[238:239], v8 offset:17952
    s_waitcnt lgkmcnt(6)
    v_mfma_f32_16x16x32_bf16 v[104:107], v[224:227], v[24:27], v[104:107]
    s_add_u32 s22, s24, 0x92000
    s_add_u32 m0, s20, 0x1c400
    s_nop 0
    buffer_load_dwordx4 v3, s[4:7], s22 offen lds
    ds_read_b64_tr_b16 v[240:241], v7 offset:17152
    v_mfma_f32_16x16x32_bf16 v[108:111], v[224:227], v[28:31], v[108:111]
    ds_read_b64_tr_b16 v[242:243], v7 offset:18176
    s_waitcnt lgkmcnt(6)
    v_mfma_f32_16x16x32_bf16 v[112:115], v[228:231], v[24:27], v[112:115]
    ds_read_b64_tr_b16 v[244:245], v8 offset:17184
    v_mfma_f32_16x16x32_bf16 v[116:119], v[228:231], v[28:31], v[116:119]
    ds_read_b64_tr_b16 v[246:247], v8 offset:18208
    s_waitcnt lgkmcnt(6)
    v_mfma_f32_16x16x32_bf16 v[120:123], v[232:235], v[24:27], v[120:123]
    v_mfma_f32_16x16x32_bf16 v[124:127], v[232:235], v[28:31], v[124:127]
    s_barrier
    ds_read_b64_tr_b16 v[224:225], v4 offset:0
    ds_read_b64_tr_b16 v[226:227], v4 offset:1024
    s_waitcnt lgkmcnt(6)
    v_mfma_f32_16x16x32_bf16 v[128:131], v[236:239], v[24:27], v[128:131]
    s_add_u32 s16, s63, 0x576000
    v_mov_b32 v14, s28
    v_mov_b32 v15, 0
    s_mov_b64 exec, 1
    buffer_store_dword v14, v15, s[8:11], s16 offen sc1
    s_mov_b64 exec, -1
    ds_read_b64_tr_b16 v[228:229], v5 offset:32
    s_mov_b32 s23, 0x2000
    buffer_load_dwordx4 v[56:59], v6, s[8:11], s23 offen offset:1024 sc1
    v_mfma_f32_16x16x32_bf16 v[132:135], v[236:239], v[28:31], v[132:135]
    ds_read_b64_tr_b16 v[230:231], v5 offset:1056
    s_waitcnt lgkmcnt(6)
    v_mfma_f32_16x16x32_bf16 v[136:139], v[240:243], v[24:27], v[136:139]
    ds_read_b64_tr_b16 v[232:233], v4 offset:256
    v_mfma_f32_16x16x32_bf16 v[140:143], v[240:243], v[28:31], v[140:143]
    ds_read_b64_tr_b16 v[234:235], v4 offset:1280
    s_mov_b32 s23, 0x22000
    buffer_load_dwordx4 v[60:63], v6, s[8:11], s23 offen offset:1024 sc1
    s_waitcnt lgkmcnt(6)
    v_mfma_f32_16x16x32_bf16 v[144:147], v[244:247], v[24:27], v[144:147]
    ds_read_b64_tr_b16 v[236:237], v5 offset:288
    v_mfma_f32_16x16x32_bf16 v[148:151], v[244:247], v[28:31], v[148:151]
    ds_read_b64_tr_b16 v[238:239], v5 offset:1312
    s_waitcnt vmcnt(14) lgkmcnt(6)
    v_mfma_f32_16x16x32_bf16 v[88:91], v[224:227], v[32:35], v[88:91]
    ds_read_b64_tr_b16 v[240:241], v4 offset:512
    s_waitcnt vmcnt(13)
    v_mfma_f32_16x16x32_bf16 v[92:95], v[224:227], v[36:39], v[92:95]
    s_add_u32 s22, s24, 0x110000
    s_add_u32 m0, s20, 0x20000
    s_nop 0
    buffer_load_dwordx4 v3, s[4:7], s22 offen lds
    ds_read_b64_tr_b16 v[242:243], v4 offset:1536
    s_waitcnt lgkmcnt(6)
    v_mfma_f32_16x16x32_bf16 v[96:99], v[228:231], v[32:35], v[96:99]
    ds_read_b64_tr_b16 v[244:245], v5 offset:544
    v_mfma_f32_16x16x32_bf16 v[100:103], v[228:231], v[36:39], v[100:103]
    ds_read_b64_tr_b16 v[246:247], v5 offset:1568
    s_waitcnt lgkmcnt(6)
    v_mfma_f32_16x16x32_bf16 v[104:107], v[232:235], v[32:35], v[104:107]
    s_add_u32 s22, s24, 0x112000
    s_add_u32 m0, s20, 0x20400
    s_nop 0
    buffer_load_dwordx4 v3, s[4:7], s22 offen lds
    ds_read_b64_tr_b16 v[224:225], v4 offset:768
    v_mfma_f32_16x16x32_bf16 v[108:111], v[232:235], v[36:39], v[108:111]
    ds_read_b64_tr_b16 v[226:227], v4 offset:1792
    s_waitcnt lgkmcnt(6)
    v_mfma_f32_16x16x32_bf16 v[112:115], v[236:239], v[32:35], v[112:115]
    ds_read_b64_tr_b16 v[228:229], v5 offset:800
    v_mfma_f32_16x16x32_bf16 v[116:119], v[236:239], v[36:39], v[116:119]
    ds_read_b64_tr_b16 v[230:231], v5 offset:1824
    s_waitcnt lgkmcnt(6)
    v_mfma_f32_16x16x32_bf16 v[120:123], v[240:243], v[32:35], v[120:123]
    v_mfma_f32_16x16x32_bf16 v[124:127], v[240:243], v[36:39], v[124:127]
    s_waitcnt vmcnt(13)
    s_barrier
    ds_read_b64_tr_b16 v[232:233], v4 offset:16384
    ds_read_b64_tr_b16 v[234:235], v4 offset:17408
    s_waitcnt lgkmcnt(6)
    v_mfma_f32_16x16x32_bf16 v[128:131], v[244:247], v[32:35], v[128:131]
    ds_read_b64_tr_b16 v[236:237], v5 offset:16416
    s_mov_b32 s23, 0x4000
    buffer_load_dwordx4 v[24:27], v6, s[8:11], s23 offen offset:1024 sc1
    v_mfma_f32_16x16x32_bf16 v[132:135], v[244:247], v[36:39], v[132:135]
    ds_read_b64_tr_b16 v[238:239], v5 offset:17440
    s_waitcnt lgkmcnt(6)
    v_mfma_f32_16x16x32_bf16 v[136:139], v[224:227], v[32:35], v[136:139]
    ds_read_b64_tr_b16 v[240:241], v4 offset:16640
    v_mfma_f32_16x16x32_bf16 v[140:143], v[224:227], v[36:39], v[140:143]
    ds_read_b64_tr_b16 v[242:243], v4 offset:17664
    s_mov_b32 s23, 0x24000
    buffer_load_dwordx4 v[28:31], v6, s[8:11], s23 offen offset:1024 sc1
    s_waitcnt lgkmcnt(6)
    v_mfma_f32_16x16x32_bf16 v[144:147], v[228:231], v[32:35], v[144:147]
    ds_read_b64_tr_b16 v[244:245], v5 offset:16672
    v_mfma_f32_16x16x32_bf16 v[148:151], v[228:231], v[36:39], v[148:151]
    ds_read_b64_tr_b16 v[246:247], v5 offset:17696
    s_waitcnt vmcnt(14) lgkmcnt(6)
    v_mfma_f32_16x16x32_bf16 v[88:91], v[232:235], v[40:43], v[88:91]
    ds_read_b64_tr_b16 v[224:225], v4 offset:16896
    s_waitcnt vmcnt(13)
    v_mfma_f32_16x16x32_bf16 v[92:95], v[232:235], v[44:47], v[92:95]
    s_add_u32 s22, s24, 0x190000
    s_add_u32 m0, s20, 0x24000
    s_nop 0
    buffer_load_dwordx4 v3, s[4:7], s22 offen lds
    ds_read_b64_tr_b16 v[226:227], v4 offset:17920
    s_waitcnt lgkmcnt(6)
    v_mfma_f32_16x16x32_bf16 v[96:99], v[236:239], v[40:43], v[96:99]
    ds_read_b64_tr_b16 v[228:229], v5 offset:16928
    v_mfma_f32_16x16x32_bf16 v[100:103], v[236:239], v[44:47], v[100:103]
    ds_read_b64_tr_b16 v[230:231], v5 offset:17952
    s_waitcnt lgkmcnt(6)
    v_mfma_f32_16x16x32_bf16 v[104:107], v[240:243], v[40:43], v[104:107]
    s_add_u32 s22, s24, 0x192000
    s_add_u32 m0, s20, 0x24400
    s_nop 0
    buffer_load_dwordx4 v3, s[4:7], s22 offen lds
    ds_read_b64_tr_b16 v[232:233], v4 offset:17152
    v_mfma_f32_16x16x32_bf16 v[108:111], v[240:243], v[44:47], v[108:111]
    ds_read_b64_tr_b16 v[234:235], v4 offset:18176
    s_waitcnt lgkmcnt(6)
    v_mfma_f32_16x16x32_bf16 v[112:115], v[244:247], v[40:43], v[112:115]
    ds_read_b64_tr_b16 v[236:237], v5 offset:17184
    v_mfma_f32_16x16x32_bf16 v[116:119], v[244:247], v[44:47], v[116:119]
    ds_read_b64_tr_b16 v[238:239], v5 offset:18208
    s_waitcnt lgkmcnt(6)
    v_mfma_f32_16x16x32_bf16 v[120:123], v[224:227], v[40:43], v[120:123]
    v_mfma_f32_16x16x32_bf16 v[124:127], v[224:227], v[44:47], v[124:127]
    s_waitcnt vmcnt(13)
    s_barrier
    ds_read_b64_tr_b16 v[240:241], v4 offset:32768
    ds_read_b64_tr_b16 v[242:243], v4 offset:33792
    s_waitcnt lgkmcnt(6)
    v_mfma_f32_16x16x32_bf16 v[128:131], v[228:231], v[40:43], v[128:131]
    ds_read_b64_tr_b16 v[244:245], v5 offset:32800
    s_mov_b32 s23, 0x6000
    buffer_load_dwordx4 v[32:35], v6, s[8:11], s23 offen offset:1024 sc1
    v_mfma_f32_16x16x32_bf16 v[132:135], v[228:231], v[44:47], v[132:135]
    ds_read_b64_tr_b16 v[246:247], v5 offset:33824
    s_waitcnt lgkmcnt(6)
    v_mfma_f32_16x16x32_bf16 v[136:139], v[232:235], v[40:43], v[136:139]
    ds_read_b64_tr_b16 v[224:225], v4 offset:33024
    v_mfma_f32_16x16x32_bf16 v[140:143], v[232:235], v[44:47], v[140:143]
    ds_read_b64_tr_b16 v[226:227], v4 offset:34048
    s_mov_b32 s23, 0x26000
    buffer_load_dwordx4 v[36:39], v6, s[8:11], s23 offen offset:1024 sc1
    s_waitcnt lgkmcnt(6)
    v_mfma_f32_16x16x32_bf16 v[144:147], v[236:239], v[40:43], v[144:147]
    ds_read_b64_tr_b16 v[228:229], v5 offset:33056
    v_mfma_f32_16x16x32_bf16 v[148:151], v[236:239], v[44:47], v[148:151]
    ds_read_b64_tr_b16 v[230:231], v5 offset:34080
    s_waitcnt vmcnt(14) lgkmcnt(6)
    v_mfma_f32_16x16x32_bf16 v[88:91], v[240:243], v[48:51], v[88:91]
    ds_read_b64_tr_b16 v[232:233], v4 offset:33280
    s_waitcnt vmcnt(13)
    v_mfma_f32_16x16x32_bf16 v[92:95], v[240:243], v[52:55], v[92:95]
    s_add_u32 s22, s24, 0x210000
    s_add_u32 m0, s20, 0x10000
    s_nop 0
    buffer_load_dwordx4 v3, s[4:7], s22 offen lds
    ds_read_b64_tr_b16 v[234:235], v4 offset:34304
    s_waitcnt lgkmcnt(6)
    v_mfma_f32_16x16x32_bf16 v[96:99], v[244:247], v[48:51], v[96:99]
    ds_read_b64_tr_b16 v[236:237], v5 offset:33312
    v_mfma_f32_16x16x32_bf16 v[100:103], v[244:247], v[52:55], v[100:103]
    ds_read_b64_tr_b16 v[238:239], v5 offset:34336
    s_waitcnt lgkmcnt(6)
    v_mfma_f32_16x16x32_bf16 v[104:107], v[224:227], v[48:51], v[104:107]
    s_add_u32 s22, s24, 0x212000
    s_add_u32 m0, s20, 0x10400
    s_nop 0
    buffer_load_dwordx4 v3, s[4:7], s22 offen lds
    ds_read_b64_tr_b16 v[240:241], v4 offset:33536
    v_mfma_f32_16x16x32_bf16 v[108:111], v[224:227], v[52:55], v[108:111]
    ds_read_b64_tr_b16 v[242:243], v4 offset:34560
    s_waitcnt lgkmcnt(6)
    v_mfma_f32_16x16x32_bf16 v[112:115], v[228:231], v[48:51], v[112:115]
    ds_read_b64_tr_b16 v[244:245], v5 offset:33568
    v_mfma_f32_16x16x32_bf16 v[116:119], v[228:231], v[52:55], v[116:119]
    ds_read_b64_tr_b16 v[246:247], v5 offset:34592
    s_waitcnt lgkmcnt(6)
    v_mfma_f32_16x16x32_bf16 v[120:123], v[232:235], v[48:51], v[120:123]
    v_mfma_f32_16x16x32_bf16 v[124:127], v[232:235], v[52:55], v[124:127]
    s_waitcnt vmcnt(13)
    s_barrier
    ds_read_b64_tr_b16 v[224:225], v4 offset:49152
    ds_read_b64_tr_b16 v[226:227], v4 offset:50176
    s_waitcnt lgkmcnt(6)
    v_mfma_f32_16x16x32_bf16 v[128:131], v[236:239], v[48:51], v[128:131]
    ds_read_b64_tr_b16 v[228:229], v5 offset:49184
    s_mov_b32 s23, 0x8000
    buffer_load_dwordx4 v[40:43], v6, s[8:11], s23 offen offset:1024 sc1
    v_mfma_f32_16x16x32_bf16 v[132:135], v[236:239], v[52:55], v[132:135]
    ds_read_b64_tr_b16 v[230:231], v5 offset:50208
    s_waitcnt lgkmcnt(6)
    v_mfma_f32_16x16x32_bf16 v[136:139], v[240:243], v[48:51], v[136:139]
    ds_read_b64_tr_b16 v[232:233], v4 offset:49408
    v_mfma_f32_16x16x32_bf16 v[140:143], v[240:243], v[52:55], v[140:143]
    ds_read_b64_tr_b16 v[234:235], v4 offset:50432
    s_mov_b32 s23, 0x28000
    buffer_load_dwordx4 v[44:47], v6, s[8:11], s23 offen offset:1024 sc1
    s_waitcnt lgkmcnt(6)
    v_mfma_f32_16x16x32_bf16 v[144:147], v[244:247], v[48:51], v[144:147]
    ds_read_b64_tr_b16 v[236:237], v5 offset:49440
    v_mfma_f32_16x16x32_bf16 v[148:151], v[244:247], v[52:55], v[148:151]
    ds_read_b64_tr_b16 v[238:239], v5 offset:50464
    s_waitcnt vmcnt(13) lgkmcnt(6)
    v_mfma_f32_16x16x32_bf16 v[88:91], v[224:227], v[56:59], v[88:91]
    ds_read_b64_tr_b16 v[240:241], v4 offset:49664
    s_waitcnt vmcnt(12)
    v_mfma_f32_16x16x32_bf16 v[92:95], v[224:227], v[60:63], v[92:95]
    s_add_u32 s22, s24, 0x290000
    s_add_u32 m0, s20, 0x14000
    s_nop 0
    buffer_load_dwordx4 v3, s[4:7], s22 offen lds
    ds_read_b64_tr_b16 v[242:243], v4 offset:50688
    s_waitcnt lgkmcnt(6)
    v_mfma_f32_16x16x32_bf16 v[96:99], v[228:231], v[56:59], v[96:99]
    ds_read_b64_tr_b16 v[244:245], v5 offset:49696
    v_mfma_f32_16x16x32_bf16 v[100:103], v[228:231], v[60:63], v[100:103]
    ds_read_b64_tr_b16 v[246:247], v5 offset:50720
    s_waitcnt lgkmcnt(6)
    v_mfma_f32_16x16x32_bf16 v[104:107], v[232:235], v[56:59], v[104:107]
    s_add_u32 s22, s24, 0x292000
    s_add_u32 m0, s20, 0x14400
    s_nop 0
    buffer_load_dwordx4 v3, s[4:7], s22 offen lds
    ds_read_b64_tr_b16 v[224:225], v4 offset:49920
    v_mfma_f32_16x16x32_bf16 v[108:111], v[232:235], v[60:63], v[108:111]
    ds_read_b64_tr_b16 v[226:227], v4 offset:50944
    s_waitcnt lgkmcnt(6)
    v_mfma_f32_16x16x32_bf16 v[112:115], v[236:239], v[56:59], v[112:115]
    ds_read_b64_tr_b16 v[228:229], v5 offset:49952
    v_mfma_f32_16x16x32_bf16 v[116:119], v[236:239], v[60:63], v[116:119]
    ds_read_b64_tr_b16 v[230:231], v5 offset:50976
    s_waitcnt lgkmcnt(6)
    v_mfma_f32_16x16x32_bf16 v[120:123], v[240:243], v[56:59], v[120:123]
    v_mfma_f32_16x16x32_bf16 v[124:127], v[240:243], v[60:63], v[124:127]
    s_waitcnt vmcnt(12)
    s_barrier
    ds_read_b64_tr_b16 v[232:233], v7 offset:0
    ds_read_b64_tr_b16 v[234:235], v7 offset:1024
    s_waitcnt lgkmcnt(6)
    v_mfma_f32_16x16x32_bf16 v[128:131], v[244:247], v[56:59], v[128:131]
    ds_read_b64_tr_b16 v[236:237], v8 offset:32
    s_mov_b32 s23, 0xa000
    buffer_load_dwordx4 v[48:51], v6, s[8:11], s23 offen offset:1024 sc1
    v_mfma_f32_16x16x32_bf16 v[132:135], v[244:247], v[60:63], v[132:135]
    ds_read_b64_tr_b16 v[238:239], v8 offset:1056
    s_waitcnt lgkmcnt(6)
    v_mfma_f32_16x16x32_bf16 v[136:139], v[224:227], v[56:59], v[136:139]
    ds_read_b64_tr_b16 v[240:241], v7 offset:256
    v_mfma_f32_16x16x32_bf16 v[140:143], v[224:227], v[60:63], v[140:143]
    ds_read_b64_tr_b16 v[242:243], v7 offset:1280
    s_mov_b32 s23, 0x2a000
    buffer_load_dwordx4 v[52:55], v6, s[8:11], s23 offen offset:1024 sc1
    s_waitcnt lgkmcnt(6)
    v_mfma_f32_16x16x32_bf16 v[144:147], v[228:231], v[56:59], v[144:147]
    ds_read_b64_tr_b16 v[244:245], v8 offset:288
    v_mfma_f32_16x16x32_bf16 v[148:151], v[228:231], v[60:63], v[148:151]
    ds_read_b64_tr_b16 v[246:247], v8 offset:1312
    s_waitcnt vmcnt(13) lgkmcnt(6)
    v_mfma_f32_16x16x32_bf16 v[88:91], v[232:235], v[24:27], v[88:91]
    ds_read_b64_tr_b16 v[224:225], v7 offset:512
    s_waitcnt vmcnt(12)
    v_mfma_f32_16x16x32_bf16 v[92:95], v[232:235], v[28:31], v[92:95]
    s_add_u32 s22, s24, 0x310000
    s_add_u32 m0, s20, 0x18000
    s_nop 0
    buffer_load_dwordx4 v3, s[4:7], s22 offen lds
    ds_read_b64_tr_b16 v[226:227], v7 offset:1536
    s_waitcnt lgkmcnt(6)
    v_mfma_f32_16x16x32_bf16 v[96:99], v[236:239], v[24:27], v[96:99]
    ds_read_b64_tr_b16 v[228:229], v8 offset:544
    v_mfma_f32_16x16x32_bf16 v[100:103], v[236:239], v[28:31], v[100:103]
    ds_read_b64_tr_b16 v[230:231], v8 offset:1568
    s_waitcnt lgkmcnt(6)
    v_mfma_f32_16x16x32_bf16 v[104:107], v[240:243], v[24:27], v[104:107]
    s_add_u32 s22, s24, 0x312000
    s_add_u32 m0, s20, 0x18400
    s_nop 0
    buffer_load_dwordx4 v3, s[4:7], s22 offen lds
    ds_read_b64_tr_b16 v[232:233], v7 offset:768
    v_mfma_f32_16x16x32_bf16 v[108:111], v[240:243], v[28:31], v[108:111]
    ds_read_b64_tr_b16 v[234:235], v7 offset:1792
    s_waitcnt lgkmcnt(6)
    v_mfma_f32_16x16x32_bf16 v[112:115], v[244:247], v[24:27], v[112:115]
    ds_read_b64_tr_b16 v[236:237], v8 offset:800
    v_mfma_f32_16x16x32_bf16 v[116:119], v[244:247], v[28:31], v[116:119]
    ds_read_b64_tr_b16 v[238:239], v8 offset:1824
    s_waitcnt lgkmcnt(6)
    v_mfma_f32_16x16x32_bf16 v[120:123], v[224:227], v[24:27], v[120:123]
    v_mfma_f32_16x16x32_bf16 v[124:127], v[224:227], v[28:31], v[124:127]
    s_waitcnt vmcnt(12)
    s_barrier
    ds_read_b64_tr_b16 v[240:241], v7 offset:16384
    ds_read_b64_tr_b16 v[242:243], v7 offset:17408
    s_add_u32 s19, s19, 8192
    buffer_load_dword v12, v13, s[8:11], s19 offen sc1
    s_waitcnt lgkmcnt(6)
    v_mfma_f32_16x16x32_bf16 v[128:131], v[228:231], v[24:27], v[128:131]
    ds_read_b64_tr_b16 v[244:245], v8 offset:16416
    s_mov_b32 s23, 0xc000
    buffer_load_dwordx4 v[56:59], v6, s[8:11], s23 offen offset:1024 sc1
    v_mfma_f32_16x16x32_bf16 v[132:135], v[228:231], v[28:31], v[132:135]
    ds_read_b64_tr_b16 v[246:247], v8 offset:17440
    s_waitcnt lgkmcnt(6)
    v_mfma_f32_16x16x32_bf16 v[136:139], v[232:235], v[24:27], v[136:139]
    ds_read_b64_tr_b16 v[224:225], v7 offset:16640
    v_mfma_f32_16x16x32_bf16 v[140:143], v[232:235], v[28:31], v[140:143]
    ds_read_b64_tr_b16 v[226:227], v7 offset:17664
    s_mov_b32 s23, 0x2c000
    buffer_load_dwordx4 v[60:63], v6, s[8:11], s23 offen offset:1024 sc1
    s_waitcnt lgkmcnt(6)
    v_mfma_f32_16x16x32_bf16 v[144:147], v[236:239], v[24:27], v[144:147]
    ds_read_b64_tr_b16 v[228:229], v8 offset:16672
    v_mfma_f32_16x16x32_bf16 v[148:151], v[236:239], v[28:31], v[148:151]
    ds_read_b64_tr_b16 v[230:231], v8 offset:17696
    s_waitcnt vmcnt(14) lgkmcnt(6)
    v_mfma_f32_16x16x32_bf16 v[88:91], v[240:243], v[32:35], v[88:91]
    ds_read_b64_tr_b16 v[232:233], v7 offset:16896
    s_waitcnt vmcnt(13)
    v_mfma_f32_16x16x32_bf16 v[92:95], v[240:243], v[36:39], v[92:95]
    s_add_u32 s22, s24, 0x390000
    s_add_u32 m0, s20, 0x1c000
    s_nop 0
    buffer_load_dwordx4 v3, s[4:7], s22 offen lds
    ds_read_b64_tr_b16 v[234:235], v7 offset:17920
    s_waitcnt lgkmcnt(6)
    v_mfma_f32_16x16x32_bf16 v[96:99], v[244:247], v[32:35], v[96:99]
    ds_read_b64_tr_b16 v[236:237], v8 offset:16928
    v_mfma_f32_16x16x32_bf16 v[100:103], v[244:247], v[36:39], v[100:103]
    ds_read_b64_tr_b16 v[238:239], v8 offset:17952
    s_waitcnt lgkmcnt(6)
    v_mfma_f32_16x16x32_bf16 v[104:107], v[224:227], v[32:35], v[104:107]
    s_add_u32 s22, s24, 0x392000
    s_add_u32 m0, s20, 0x1c400
    s_nop 0
    buffer_load_dwordx4 v3, s[4:7], s22 offen lds
    ds_read_b64_tr_b16 v[240:241], v7 offset:17152
    v_mfma_f32_16x16x32_bf16 v[108:111], v[224:227], v[36:39], v[108:111]
    ds_read_b64_tr_b16 v[242:243], v7 offset:18176
    s_waitcnt lgkmcnt(6)
    v_mfma_f32_16x16x32_bf16 v[112:115], v[228:231], v[32:35], v[112:115]
    ds_read_b64_tr_b16 v[244:245], v8 offset:17184
    v_mfma_f32_16x16x32_bf16 v[116:119], v[228:231], v[36:39], v[116:119]
    ds_read_b64_tr_b16 v[246:247], v8 offset:18208
    s_waitcnt lgkmcnt(6)
    v_mfma_f32_16x16x32_bf16 v[120:123], v[232:235], v[32:35], v[120:123]
    v_mfma_f32_16x16x32_bf16 v[124:127], v[232:235], v[36:39], v[124:127]
    s_waitcnt vmcnt(13)
    s_barrier
    ds_read_b64_tr_b16 v[224:225], v4 offset:0
    ds_read_b64_tr_b16 v[226:227], v4 offset:1024
    s_waitcnt lgkmcnt(6)
    v_mfma_f32_16x16x32_bf16 v[128:131], v[236:239], v[32:35], v[128:131]
    ds_read_b64_tr_b16 v[228:229], v5 offset:32
    s_mov_b32 s23, 0xe000
    buffer_load_dwordx4 v[24:27], v6, s[8:11], s23 offen offset:1024 sc1
    v_mfma_f32_16x16x32_bf16 v[132:135], v[236:239], v[36:39], v[132:135]
    ds_read_b64_tr_b16 v[230:231], v5 offset:1056
    s_waitcnt lgkmcnt(6)
    v_mfma_f32_16x16x32_bf16 v[136:139], v[240:243], v[32:35], v[136:139]
    ds_read_b64_tr_b16 v[232:233], v4 offset:256
    v_mfma_f32_16x16x32_bf16 v[140:143], v[240:243], v[36:39], v[140:143]
    ds_read_b64_tr_b16 v[234:235], v4 offset:1280
    s_mov_b32 s23, 0x2e000
    buffer_load_dwordx4 v[28:31], v6, s[8:11], s23 offen offset:1024 sc1
    s_waitcnt lgkmcnt(6)
    v_mfma_f32_16x16x32_bf16 v[144:147], v[244:247], v[32:35], v[144:147]
    ds_read_b64_tr_b16 v[236:237], v5 offset:288
    v_mfma_f32_16x16x32_bf16 v[148:151], v[244:247], v[36:39], v[148:151]
    ds_read_b64_tr_b16 v[238:239], v5 offset:1312
    s_waitcnt vmcnt(6)
    v_cmp_ne_u32 vcc, s28, v12
    s_cbranch_vccnz adaLN_cond__sliding_block_cached__moe_arch_mod__prompt_kernel_o219r
adaLN_cond__sliding_block_cached__moe_arch_mod__prompt_kernel_o219b:
    s_waitcnt lgkmcnt(6)
    v_mfma_f32_16x16x32_bf16 v[88:91], v[224:227], v[40:43], v[88:91]
    ds_read_b64_tr_b16 v[240:241], v4 offset:512
    v_mfma_f32_16x16x32_bf16 v[92:95], v[224:227], v[44:47], v[92:95]
    s_add_u32 s22, s24, 0x20000
    s_add_u32 m0, s20, 0x20000
    s_nop 0
    buffer_load_dwordx4 v3, s[4:7], s22 offen lds
    ds_read_b64_tr_b16 v[242:243], v4 offset:1536
    s_waitcnt lgkmcnt(6)
    v_mfma_f32_16x16x32_bf16 v[96:99], v[228:231], v[40:43], v[96:99]
    ds_read_b64_tr_b16 v[244:245], v5 offset:544
    v_mfma_f32_16x16x32_bf16 v[100:103], v[228:231], v[44:47], v[100:103]
    ds_read_b64_tr_b16 v[246:247], v5 offset:1568
    s_waitcnt lgkmcnt(6)
    v_mfma_f32_16x16x32_bf16 v[104:107], v[232:235], v[40:43], v[104:107]
    s_add_u32 s22, s24, 0x22000
    s_add_u32 m0, s20, 0x20400
    s_nop 0
    buffer_load_dwordx4 v3, s[4:7], s22 offen lds
    ds_read_b64_tr_b16 v[224:225], v4 offset:768
    v_mfma_f32_16x16x32_bf16 v[108:111], v[232:235], v[44:47], v[108:111]
    ds_read_b64_tr_b16 v[226:227], v4 offset:1792
    s_waitcnt lgkmcnt(6)
    v_mfma_f32_16x16x32_bf16 v[112:115], v[236:239], v[40:43], v[112:115]
    ds_read_b64_tr_b16 v[228:229], v5 offset:800
    v_mfma_f32_16x16x32_bf16 v[116:119], v[236:239], v[44:47], v[116:119]
    ds_read_b64_tr_b16 v[230:231], v5 offset:1824
    s_waitcnt lgkmcnt(6)
    v_mfma_f32_16x16x32_bf16 v[120:123], v[240:243], v[40:43], v[120:123]
    v_mfma_f32_16x16x32_bf16 v[124:127], v[240:243], v[44:47], v[124:127]
    s_barrier
    ds_read_b64_tr_b16 v[232:233], v4 offset:16384
    ds_read_b64_tr_b16 v[234:235], v4 offset:17408
    s_waitcnt lgkmcnt(6)
    v_mfma_f32_16x16x32_bf16 v[128:131], v[244:247], v[40:43], v[128:131]
    ds_read_b64_tr_b16 v[236:237], v5 offset:16416
    s_mov_b32 s23, 0x0
    buffer_load_dwordx4 v[32:35], v6, s[8:11], s23 offen offset:2048 sc1
    v_mfma_f32_16x16x32_bf16 v[132:135], v[244:247], v[44:47], v[132:135]
    ds_read_b64_tr_b16 v[238:239], v5 offset:17440
    s_waitcnt lgkmcnt(6)
    v_mfma_f32_16x16x32_bf16 v[136:139], v[224:227], v[40:43], v[136:139]
    ds_read_b64_tr_b16 v[240:241], v4 offset:16640
    v_mfma_f32_16x16x32_bf16 v[140:143], v[224:227], v[44:47], v[140:143]
    ds_read_b64_tr_b16 v[242:243], v4 offset:17664
    s_mov_b32 s23, 0x20000
    buffer_load_dwordx4 v[36:39], v6, s[8:11], s23 offen offset:2048 sc1
    s_waitcnt lgkmcnt(6)
    v_mfma_f32_16x16x32_bf16 v[144:147], v[228:231], v[40:43], v[144:147]
    ds_read_b64_tr_b16 v[244:245], v5 offset:16672
    v_mfma_f32_16x16x32_bf16 v[148:151], v[228:231], v[44:47], v[148:151]
    ds_read_b64_tr_b16 v[246:247], v5 offset:17696
    s_waitcnt lgkmcnt(6)
    v_mfma_f32_16x16x32_bf16 v[88:91], v[232:235], v[48:51], v[88:91]
    ds_read_b64_tr_b16 v[224:225], v4 offset:16896
    v_mfma_f32_16x16x32_bf16 v[92:95], v[232:235], v[52:55], v[92:95]
    s_add_u32 s22, s24, 0xa0000
    s_add_u32 m0, s20, 0x24000
    s_nop 0
    buffer_load_dwordx4 v3, s[4:7], s22 offen lds
    ds_read_b64_tr_b16 v[226:227], v4 offset:17920
    s_waitcnt lgkmcnt(6)
    v_mfma_f32_16x16x32_bf16 v[96:99], v[236:239], v[48:51], v[96:99]
    ds_read_b64_tr_b16 v[228:229], v5 offset:16928
    v_mfma_f32_16x16x32_bf16 v[100:103], v[236:239], v[52:55], v[100:103]
    ds_read_b64_tr_b16 v[230:231], v5 offset:17952
    s_waitcnt lgkmcnt(6)
    v_mfma_f32_16x16x32_bf16 v[104:107], v[240:243], v[48:51], v[104:107]
    s_add_u32 s22, s24, 0xa2000
    s_add_u32 m0, s20, 0x24400
    s_nop 0
    buffer_load_dwordx4 v3, s[4:7], s22 offen lds
    ds_read_b64_tr_b16 v[232:233], v4 offset:17152
    v_mfma_f32_16x16x32_bf16 v[108:111], v[240:243], v[52:55], v[108:111]
    ds_read_b64_tr_b16 v[234:235], v4 offset:18176
    s_waitcnt lgkmcnt(6)
    v_mfma_f32_16x16x32_bf16 v[112:115], v[244:247], v[48:51], v[112:115]
    ds_read_b64_tr_b16 v[236:237], v5 offset:17184
    v_mfma_f32_16x16x32_bf16 v[116:119], v[244:247], v[52:55], v[116:119]
    ds_read_b64_tr_b16 v[238:239], v5 offset:18208
    s_waitcnt lgkmcnt(6)
    v_mfma_f32_16x16x32_bf16 v[120:123], v[224:227], v[48:51], v[120:123]
    v_mfma_f32_16x16x32_bf16 v[124:127], v[224:227], v[52:55], v[124:127]
    s_barrier
    ds_read_b64_tr_b16 v[240:241], v4 offset:32768
    ds_read_b64_tr_b16 v[242:243], v4 offset:33792
    s_waitcnt lgkmcnt(6)
    v_mfma_f32_16x16x32_bf16 v[128:131], v[228:231], v[48:51], v[128:131]
    ds_read_b64_tr_b16 v[244:245], v5 offset:32800
    s_mov_b32 s23, 0x2000
    buffer_load_dwordx4 v[40:43], v6, s[8:11], s23 offen offset:2048 sc1
    v_mfma_f32_16x16x32_bf16 v[132:135], v[228:231], v[52:55], v[132:135]
    ds_read_b64_tr_b16 v[246:247], v5 offset:33824
    s_waitcnt lgkmcnt(6)
    v_mfma_f32_16x16x32_bf16 v[136:139], v[232:235], v[48:51], v[136:139]
    ds_read_b64_tr_b16 v[224:225], v4 offset:33024
    v_mfma_f32_16x16x32_bf16 v[140:143], v[232:235], v[52:55], v[140:143]
    ds_read_b64_tr_b16 v[226:227], v4 offset:34048
    s_mov_b32 s23, 0x22000
    buffer_load_dwordx4 v[44:47], v6, s[8:11], s23 offen offset:2048 sc1
    s_waitcnt lgkmcnt(6)
    v_mfma_f32_16x16x32_bf16 v[144:147], v[236:239], v[48:51], v[144:147]
    ds_read_b64_tr_b16 v[228:229], v5 offset:33056
    v_mfma_f32_16x16x32_bf16 v[148:151], v[236:239], v[52:55], v[148:151]
    ds_read_b64_tr_b16 v[230:231], v5 offset:34080
    s_waitcnt vmcnt(13) lgkmcnt(6)
    v_mfma_f32_16x16x32_bf16 v[88:91], v[240:243], v[56:59], v[88:91]
    ds_read_b64_tr_b16 v[232:233], v4 offset:33280
    s_waitcnt vmcnt(12)
    v_mfma_f32_16x16x32_bf16 v[92:95], v[240:243], v[60:63], v[92:95]
    s_add_u32 s22, s24, 0x120000
    s_add_u32 m0, s20, 0x10000
    s_nop 0
    buffer_load_dwordx4 v3, s[4:7], s22 offen lds
    ds_read_b64_tr_b16 v[234:235], v4 offset:34304
    s_waitcnt lgkmcnt(6)
    v_mfma_f32_16x16x32_bf16 v[96:99], v[244:247], v[56:59], v[96:99]
    ds_read_b64_tr_b16 v[236:237], v5 offset:33312
    v_mfma_f32_16x16x32_bf16 v[100:103], v[244:247], v[60:63], v[100:103]
    ds_read_b64_tr_b16 v[238:239], v5 offset:34336
    s_waitcnt lgkmcnt(6)
    v_mfma_f32_16x16x32_bf16 v[104:107], v[224:227], v[56:59], v[104:107]
    s_add_u32 s22, s24, 0x122000
    s_add_u32 m0, s20, 0x10400
    s_nop 0
    buffer_load_dwordx4 v3, s[4:7], s22 offen lds
    ds_read_b64_tr_b16 v[240:241], v4 offset:33536
    v_mfma_f32_16x16x32_bf16 v[108:111], v[224:227], v[60:63], v[108:111]
    ds_read_b64_tr_b16 v[242:243], v4 offset:34560
    s_waitcnt lgkmcnt(6)
    v_mfma_f32_16x16x32_bf16 v[112:115], v[228:231], v[56:59], v[112:115]
    ds_read_b64_tr_b16 v[244:245], v5 offset:33568
    v_mfma_f32_16x16x32_bf16 v[116:119], v[228:231], v[60:63], v[116:119]
    ds_read_b64_tr_b16 v[246:247], v5 offset:34592
    s_waitcnt lgkmcnt(6)
    v_mfma_f32_16x16x32_bf16 v[120:123], v[232:235], v[56:59], v[120:123]
    v_mfma_f32_16x16x32_bf16 v[124:127], v[232:235], v[60:63], v[124:127]
    s_waitcnt vmcnt(12)
    s_barrier
    ds_read_b64_tr_b16 v[224:225], v4 offset:49152
    ds_read_b64_tr_b16 v[226:227], v4 offset:50176
    s_waitcnt lgkmcnt(6)
    v_mfma_f32_16x16x32_bf16 v[128:131], v[236:239], v[56:59], v[128:131]
    ds_read_b64_tr_b16 v[228:229], v5 offset:49184
    s_mov_b32 s23, 0x4000
    buffer_load_dwordx4 v[48:51], v6, s[8:11], s23 offen offset:2048 sc1
    v_mfma_f32_16x16x32_bf16 v[132:135], v[236:239], v[60:63], v[132:135]
    ds_read_b64_tr_b16 v[230:231], v5 offset:50208
    s_waitcnt lgkmcnt(6)
    v_mfma_f32_16x16x32_bf16 v[136:139], v[240:243], v[56:59], v[136:139]
    ds_read_b64_tr_b16 v[232:233], v4 offset:49408
    v_mfma_f32_16x16x32_bf16 v[140:143], v[240:243], v[60:63], v[140:143]
    ds_read_b64_tr_b16 v[234:235], v4 offset:50432
    s_mov_b32 s23, 0x24000
    buffer_load_dwordx4 v[52:55], v6, s[8:11], s23 offen offset:2048 sc1
    s_waitcnt lgkmcnt(6)
    v_mfma_f32_16x16x32_bf16 v[144:147], v[244:247], v[56:59], v[144:147]
    ds_read_b64_tr_b16 v[236:237], v5 offset:49440
    v_mfma_f32_16x16x32_bf16 v[148:151], v[244:247], v[60:63], v[148:151]
    ds_read_b64_tr_b16 v[238:239], v5 offset:50464
    s_waitcnt vmcnt(13) lgkmcnt(6)
    v_mfma_f32_16x16x32_bf16 v[88:91], v[224:227], v[24:27], v[88:91]
    ds_read_b64_tr_b16 v[240:241], v4 offset:49664
    s_waitcnt vmcnt(12)
    v_mfma_f32_16x16x32_bf16 v[92:95], v[224:227], v[28:31], v[92:95]
    s_add_u32 s22, s24, 0x1a0000
    s_add_u32 m0, s20, 0x14000
    s_nop 0
    buffer_load_dwordx4 v3, s[4:7], s22 offen lds
    ds_read_b64_tr_b16 v[242:243], v4 offset:50688
    s_waitcnt lgkmcnt(6)
    v_mfma_f32_16x16x32_bf16 v[96:99], v[228:231], v[24:27], v[96:99]
    ds_read_b64_tr_b16 v[244:245], v5 offset:49696
    v_mfma_f32_16x16x32_bf16 v[100:103], v[228:231], v[28:31], v[100:103]
    ds_read_b64_tr_b16 v[246:247], v5 offset:50720
    s_waitcnt lgkmcnt(6)
    v_mfma_f32_16x16x32_bf16 v[104:107], v[232:235], v[24:27], v[104:107]
    s_add_u32 s22, s24, 0x1a2000
    s_add_u32 m0, s20, 0x14400
    s_nop 0
    buffer_load_dwordx4 v3, s[4:7], s22 offen lds
    ds_read_b64_tr_b16 v[224:225], v4 offset:49920
    v_mfma_f32_16x16x32_bf16 v[108:111], v[232:235], v[28:31], v[108:111]
    ds_read_b64_tr_b16 v[226:227], v4 offset:50944
    s_waitcnt lgkmcnt(6)
    v_mfma_f32_16x16x32_bf16 v[112:115], v[236:239], v[24:27], v[112:115]
    ds_read_b64_tr_b16 v[228:229], v5 offset:49952
    v_mfma_f32_16x16x32_bf16 v[116:119], v[236:239], v[28:31], v[116:119]
    ds_read_b64_tr_b16 v[230:231], v5 offset:50976
    s_waitcnt lgkmcnt(6)
    v_mfma_f32_16x16x32_bf16 v[120:123], v[240:243], v[24:27], v[120:123]
    v_mfma_f32_16x16x32_bf16 v[124:127], v[240:243], v[28:31], v[124:127]
    s_waitcnt vmcnt(12)
    s_barrier
    ds_read_b64_tr_b16 v[232:233], v7 offset:0
    ds_read_b64_tr_b16 v[234:235], v7 offset:1024
    s_waitcnt lgkmcnt(6)
    v_mfma_f32_16x16x32_bf16 v[128:131], v[244:247], v[24:27], v[128:131]
    ds_read_b64_tr_b16 v[236:237], v8 offset:32
    s_mov_b32 s23, 0x6000
    buffer_load_dwordx4 v[56:59], v6, s[8:11], s23 offen offset:2048 sc1
    v_mfma_f32_16x16x32_bf16 v[132:135], v[244:247], v[28:31], v[132:135]
    ds_read_b64_tr_b16 v[238:239], v8 offset:1056
    s_waitcnt lgkmcnt(6)
    v_mfma_f32_16x16x32_bf16 v[136:139], v[224:227], v[24:27], v[136:139]
    ds_read_b64_tr_b16 v[240:241], v7 offset:256
    v_mfma_f32_16x16x32_bf16 v[140:143], v[224:227], v[28:31], v[140:143]
    ds_read_b64_tr_b16 v[242:243], v7 offset:1280
    s_mov_b32 s23, 0x26000
    buffer_load_dwordx4 v[60:63], v6, s[8:11], s23 offen offset:2048 sc1
    s_waitcnt lgkmcnt(6)
    v_mfma_f32_16x16x32_bf16 v[144:147], v[228:231], v[24:27], v[144:147]
    ds_read_b64_tr_b16 v[244:245], v8 offset:288
    v_mfma_f32_16x16x32_bf16 v[148:151], v[228:231], v[28:31], v[148:151]
    ds_read_b64_tr_b16 v[246:247], v8 offset:1312
    s_waitcnt vmcnt(13) lgkmcnt(6)
    v_mfma_f32_16x16x32_bf16 v[88:91], v[232:235], v[32:35], v[88:91]
    ds_read_b64_tr_b16 v[224:225], v7 offset:512
    s_waitcnt vmcnt(12)
    v_mfma_f32_16x16x32_bf16 v[92:95], v[232:235], v[36:39], v[92:95]
    s_add_u32 s22, s24, 0x220000
    s_add_u32 m0, s20, 0x18000
    s_nop 0
    buffer_load_dwordx4 v3, s[4:7], s22 offen lds
    ds_read_b64_tr_b16 v[226:227], v7 offset:1536
    s_waitcnt lgkmcnt(6)
    v_mfma_f32_16x16x32_bf16 v[96:99], v[236:239], v[32:35], v[96:99]
    ds_read_b64_tr_b16 v[228:229], v8 offset:544
    v_mfma_f32_16x16x32_bf16 v[100:103], v[236:239], v[36:39], v[100:103]
    ds_read_b64_tr_b16 v[230:231], v8 offset:1568
    s_waitcnt lgkmcnt(6)
    v_mfma_f32_16x16x32_bf16 v[104:107], v[240:243], v[32:35], v[104:107]
    s_add_u32 s22, s24, 0x222000
    s_add_u32 m0, s20, 0x18400
    s_nop 0
    buffer_load_dwordx4 v3, s[4:7], s22 offen lds
    ds_read_b64_tr_b16 v[232:233], v7 offset:768
    v_mfma_f32_16x16x32_bf16 v[108:111], v[240:243], v[36:39], v[108:111]
    ds_read_b64_tr_b16 v[234:235], v7 offset:1792
    s_mov_b32 s16, 0x544000
    buffer_load_dwordx4 v[184:187], v2, s[8:11], s16 offen sc1
    s_waitcnt lgkmcnt(6)
    v_mfma_f32_16x16x32_bf16 v[112:115], v[244:247], v[32:35], v[112:115]
    ds_read_b64_tr_b16 v[236:237], v8 offset:800
    v_mfma_f32_16x16x32_bf16 v[116:119], v[244:247], v[36:39], v[116:119]
    ds_read_b64_tr_b16 v[238:239], v8 offset:1824
    s_waitcnt lgkmcnt(6)
    v_mfma_f32_16x16x32_bf16 v[120:123], v[224:227], v[32:35], v[120:123]
    v_mfma_f32_16x16x32_bf16 v[124:127], v[224:227], v[36:39], v[124:127]
    s_waitcnt vmcnt(13)
    s_barrier
    ds_read_b64_tr_b16 v[240:241], v7 offset:16384
    ds_read_b64_tr_b16 v[242:243], v7 offset:17408
    s_waitcnt lgkmcnt(6)
    v_mfma_f32_16x16x32_bf16 v[128:131], v[228:231], v[32:35], v[128:131]
    ds_read_b64_tr_b16 v[244:245], v8 offset:16416
    s_mov_b32 s23, 0x8000
    buffer_load_dwordx4 v[24:27], v6, s[8:11], s23 offen offset:2048 sc1
    v_mfma_f32_16x16x32_bf16 v[132:135], v[228:231], v[36:39], v[132:135]
    ds_read_b64_tr_b16 v[246:247], v8 offset:17440
    s_waitcnt lgkmcnt(6)
    v_mfma_f32_16x16x32_bf16 v[136:139], v[232:235], v[32:35], v[136:139]
    ds_read_b64_tr_b16 v[224:225], v7 offset:16640
    v_mfma_f32_16x16x32_bf16 v[140:143], v[232:235], v[36:39], v[140:143]
    ds_read_b64_tr_b16 v[226:227], v7 offset:17664
    s_mov_b32 s23, 0x28000
    buffer_load_dwordx4 v[28:31], v6, s[8:11], s23 offen offset:2048 sc1
    s_waitcnt lgkmcnt(6)
    v_mfma_f32_16x16x32_bf16 v[144:147], v[236:239], v[32:35], v[144:147]
    ds_read_b64_tr_b16 v[228:229], v8 offset:16672
    v_mfma_f32_16x16x32_bf16 v[148:151], v[236:239], v[36:39], v[148:151]
    ds_read_b64_tr_b16 v[230:231], v8 offset:17696
    s_waitcnt vmcnt(14) lgkmcnt(6)
    v_mfma_f32_16x16x32_bf16 v[88:91], v[240:243], v[40:43], v[88:91]
    ds_read_b64_tr_b16 v[232:233], v7 offset:16896
    s_waitcnt vmcnt(13)
    v_mfma_f32_16x16x32_bf16 v[92:95], v[240:243], v[44:47], v[92:95]
    s_add_u32 s22, s24, 0x2a0000
    s_add_u32 m0, s20, 0x1c000
    s_nop 0
    buffer_load_dwordx4 v3, s[4:7], s22 offen lds
    ds_read_b64_tr_b16 v[234:235], v7 offset:17920
    s_waitcnt lgkmcnt(6)
    v_mfma_f32_16x16x32_bf16 v[96:99], v[244:247], v[40:43], v[96:99]
    ds_read_b64_tr_b16 v[236:237], v8 offset:16928
    v_mfma_f32_16x16x32_bf16 v[100:103], v[244:247], v[44:47], v[100:103]
    ds_read_b64_tr_b16 v[238:239], v8 offset:17952
    s_waitcnt lgkmcnt(6)
    v_mfma_f32_16x16x32_bf16 v[104:107], v[224:227], v[40:43], v[104:107]
    s_add_u32 s22, s24, 0x2a2000
    s_add_u32 m0, s20, 0x1c400
    s_nop 0
    buffer_load_dwordx4 v3, s[4:7], s22 offen lds
    ds_read_b64_tr_b16 v[240:241], v7 offset:17152
    v_mfma_f32_16x16x32_bf16 v[108:111], v[224:227], v[44:47], v[108:111]
    ds_read_b64_tr_b16 v[242:243], v7 offset:18176
    s_waitcnt lgkmcnt(6)
    v_mfma_f32_16x16x32_bf16 v[112:115], v[228:231], v[40:43], v[112:115]
    ds_read_b64_tr_b16 v[244:245], v8 offset:17184
    v_mfma_f32_16x16x32_bf16 v[116:119], v[228:231], v[44:47], v[116:119]
    ds_read_b64_tr_b16 v[246:247], v8 offset:18208
    s_waitcnt lgkmcnt(6)
    v_mfma_f32_16x16x32_bf16 v[120:123], v[232:235], v[40:43], v[120:123]
    v_mfma_f32_16x16x32_bf16 v[124:127], v[232:235], v[44:47], v[124:127]
    s_waitcnt vmcnt(13)
    s_barrier
    ds_read_b64_tr_b16 v[224:225], v4 offset:0
    ds_read_b64_tr_b16 v[226:227], v4 offset:1024
    s_waitcnt lgkmcnt(6)
    v_mfma_f32_16x16x32_bf16 v[128:131], v[236:239], v[40:43], v[128:131]
    ds_read_b64_tr_b16 v[228:229], v5 offset:32
    s_mov_b32 s23, 0xa000
    buffer_load_dwordx4 v[32:35], v6, s[8:11], s23 offen offset:2048 sc1
    v_mfma_f32_16x16x32_bf16 v[132:135], v[236:239], v[44:47], v[132:135]
    ds_read_b64_tr_b16 v[230:231], v5 offset:1056
    s_waitcnt lgkmcnt(6)
    v_mfma_f32_16x16x32_bf16 v[136:139], v[240:243], v[40:43], v[136:139]
    ds_read_b64_tr_b16 v[232:233], v4 offset:256
    v_mfma_f32_16x16x32_bf16 v[140:143], v[240:243], v[44:47], v[140:143]
    ds_read_b64_tr_b16 v[234:235], v4 offset:1280
    s_mov_b32 s23, 0x2a000
    buffer_load_dwordx4 v[36:39], v6, s[8:11], s23 offen offset:2048 sc1
    s_waitcnt lgkmcnt(6)
    v_mfma_f32_16x16x32_bf16 v[144:147], v[244:247], v[40:43], v[144:147]
    ds_read_b64_tr_b16 v[236:237], v5 offset:288
    v_mfma_f32_16x16x32_bf16 v[148:151], v[244:247], v[44:47], v[148:151]
    ds_read_b64_tr_b16 v[238:239], v5 offset:1312
    s_waitcnt vmcnt(14) lgkmcnt(6)
    v_mfma_f32_16x16x32_bf16 v[88:91], v[224:227], v[48:51], v[88:91]
    ds_read_b64_tr_b16 v[240:241], v4 offset:512
    s_waitcnt vmcnt(13)
    v_mfma_f32_16x16x32_bf16 v[92:95], v[224:227], v[52:55], v[92:95]
    s_add_u32 s22, s24, 0x320000
    s_add_u32 m0, s20, 0x20000
    s_nop 0
    buffer_load_dwordx4 v3, s[4:7], s22 offen lds
    ds_read_b64_tr_b16 v[242:243], v4 offset:1536
    s_waitcnt lgkmcnt(6)
    v_mfma_f32_16x16x32_bf16 v[96:99], v[228:231], v[48:51], v[96:99]
    ds_read_b64_tr_b16 v[244:245], v5 offset:544
    v_mfma_f32_16x16x32_bf16 v[100:103], v[228:231], v[52:55], v[100:103]
    ds_read_b64_tr_b16 v[246:247], v5 offset:1568
    s_waitcnt lgkmcnt(6)
    v_mfma_f32_16x16x32_bf16 v[104:107], v[232:235], v[48:51], v[104:107]
    s_add_u32 s22, s24, 0x322000
    s_add_u32 m0, s20, 0x20400
    s_nop 0
    buffer_load_dwordx4 v3, s[4:7], s22 offen lds
    ds_read_b64_tr_b16 v[224:225], v4 offset:768
    v_mfma_f32_16x16x32_bf16 v[108:111], v[232:235], v[52:55], v[108:111]
    ds_read_b64_tr_b16 v[226:227], v4 offset:1792
    s_waitcnt lgkmcnt(6)
    v_mfma_f32_16x16x32_bf16 v[112:115], v[236:239], v[48:51], v[112:115]
    ds_read_b64_tr_b16 v[228:229], v5 offset:800
    v_mfma_f32_16x16x32_bf16 v[116:119], v[236:239], v[52:55], v[116:119]
    ds_read_b64_tr_b16 v[230:231], v5 offset:1824
    s_waitcnt lgkmcnt(6)
    v_mfma_f32_16x16x32_bf16 v[120:123], v[240:243], v[48:51], v[120:123]
    v_mfma_f32_16x16x32_bf16 v[124:127], v[240:243], v[52:55], v[124:127]
    s_waitcnt vmcnt(13)
    s_barrier
    ds_read_b64_tr_b16 v[232:233], v4 offset:16384
    ds_read_b64_tr_b16 v[234:235], v4 offset:17408
    s_add_u32 s19, s19, 8192
    buffer_load_dword v12, v13, s[8:11], s19 offen sc1
    s_waitcnt lgkmcnt(6)
    v_mfma_f32_16x16x32_bf16 v[128:131], v[244:247], v[48:51], v[128:131]
    ds_read_b64_tr_b16 v[236:237], v5 offset:16416
    s_mov_b32 s23, 0xc000
    buffer_load_dwordx4 v[40:43], v6, s[8:11], s23 offen offset:2048 sc1
    v_mfma_f32_16x16x32_bf16 v[132:135], v[244:247], v[52:55], v[132:135]
    ds_read_b64_tr_b16 v[238:239], v5 offset:17440
    s_waitcnt lgkmcnt(6)
    v_mfma_f32_16x16x32_bf16 v[136:139], v[224:227], v[48:51], v[136:139]
    ds_read_b64_tr_b16 v[240:241], v4 offset:16640
    v_mfma_f32_16x16x32_bf16 v[140:143], v[224:227], v[52:55], v[140:143]
    ds_read_b64_tr_b16 v[242:243], v4 offset:17664
    s_mov_b32 s23, 0x2c000
    buffer_load_dwordx4 v[44:47], v6, s[8:11], s23 offen offset:2048 sc1
    s_waitcnt lgkmcnt(6)
    v_mfma_f32_16x16x32_bf16 v[144:147], v[228:231], v[48:51], v[144:147]
    ds_read_b64_tr_b16 v[244:245], v5 offset:16672
    v_mfma_f32_16x16x32_bf16 v[148:151], v[228:231], v[52:55], v[148:151]
    ds_read_b64_tr_b16 v[246:247], v5 offset:17696
    s_waitcnt vmcnt(15) lgkmcnt(6)
    v_mfma_f32_16x16x32_bf16 v[88:91], v[232:235], v[56:59], v[88:91]
    ds_read_b64_tr_b16 v[224:225], v4 offset:16896
    s_waitcnt vmcnt(14)
    v_mfma_f32_16x16x32_bf16 v[92:95], v[232:235], v[60:63], v[92:95]
    s_add_u32 s22, s24, 0x3a0000
    s_add_u32 m0, s20, 0x24000
    s_nop 0
    buffer_load_dwordx4 v3, s[4:7], s22 offen lds
    ds_read_b64_tr_b16 v[226:227], v4 offset:17920
    s_waitcnt lgkmcnt(6)
    v_mfma_f32_16x16x32_bf16 v[96:99], v[236:239], v[56:59], v[96:99]
    ds_read_b64_tr_b16 v[228:229], v5 offset:16928
    v_mfma_f32_16x16x32_bf16 v[100:103], v[236:239], v[60:63], v[100:103]
    ds_read_b64_tr_b16 v[230:231], v5 offset:17952
    s_waitcnt lgkmcnt(6)
    v_mfma_f32_16x16x32_bf16 v[104:107], v[240:243], v[56:59], v[104:107]
    s_add_u32 s22, s24, 0x3a2000
    s_add_u32 m0, s20, 0x24400
    s_nop 0
    buffer_load_dwordx4 v3, s[4:7], s22 offen lds
    ds_read_b64_tr_b16 v[232:233], v4 offset:17152
    v_mfma_f32_16x16x32_bf16 v[108:111], v[240:243], v[60:63], v[108:111]
    ds_read_b64_tr_b16 v[234:235], v4 offset:18176
    s_waitcnt lgkmcnt(6)
    v_mfma_f32_16x16x32_bf16 v[112:115], v[244:247], v[56:59], v[112:115]
    ds_read_b64_tr_b16 v[236:237], v5 offset:17184
    v_mfma_f32_16x16x32_bf16 v[116:119], v[244:247], v[60:63], v[116:119]
    ds_read_b64_tr_b16 v[238:239], v5 offset:18208
    s_waitcnt lgkmcnt(6)
    v_mfma_f32_16x16x32_bf16 v[120:123], v[224:227], v[56:59], v[120:123]
    v_mfma_f32_16x16x32_bf16 v[124:127], v[224:227], v[60:63], v[124:127]
    s_waitcnt vmcnt(14)
    s_barrier
    ds_read_b64_tr_b16 v[240:241], v4 offset:32768
    ds_read_b64_tr_b16 v[242:243], v4 offset:33792
    s_waitcnt lgkmcnt(6)
    v_mfma_f32_16x16x32_bf16 v[128:131], v[228:231], v[56:59], v[128:131]
    ds_read_b64_tr_b16 v[244:245], v5 offset:32800
    s_mov_b32 s23, 0xe000
    buffer_load_dwordx4 v[48:51], v6, s[8:11], s23 offen offset:2048 sc1
    v_mfma_f32_16x16x32_bf16 v[132:135], v[228:231], v[60:63], v[132:135]
    ds_read_b64_tr_b16 v[246:247], v5 offset:33824
    s_waitcnt lgkmcnt(6)
    v_mfma_f32_16x16x32_bf16 v[136:139], v[232:235], v[56:59], v[136:139]
    ds_read_b64_tr_b16 v[224:225], v4 offset:33024
    v_mfma_f32_16x16x32_bf16 v[140:143], v[232:235], v[60:63], v[140:143]
    ds_read_b64_tr_b16 v[226:227], v4 offset:34048
    s_mov_b32 s23, 0x2e000
    buffer_load_dwordx4 v[52:55], v6, s[8:11], s23 offen offset:2048 sc1
    s_waitcnt lgkmcnt(6)
    v_mfma_f32_16x16x32_bf16 v[144:147], v[236:239], v[56:59], v[144:147]
    ds_read_b64_tr_b16 v[228:229], v5 offset:33056
    v_mfma_f32_16x16x32_bf16 v[148:151], v[236:239], v[60:63], v[148:151]
    ds_read_b64_tr_b16 v[230:231], v5 offset:34080
    s_waitcnt vmcnt(6)
    v_cmp_ne_u32 vcc, s28, v12
    s_cbranch_vccnz adaLN_cond__sliding_block_cached__moe_arch_mod__prompt_kernel_o220r
adaLN_cond__sliding_block_cached__moe_arch_mod__prompt_kernel_o220b:
    s_waitcnt lgkmcnt(6)
    v_mfma_f32_16x16x32_bf16 v[88:91], v[240:243], v[24:27], v[88:91]
    ds_read_b64_tr_b16 v[232:233], v4 offset:33280
    v_mfma_f32_16x16x32_bf16 v[92:95], v[240:243], v[28:31], v[92:95]
    s_add_u32 s22, s24, 0x30000
    s_add_u32 m0, s20, 0x10000
    s_nop 0
    buffer_load_dwordx4 v3, s[4:7], s22 offen lds
    ds_read_b64_tr_b16 v[234:235], v4 offset:34304
    s_waitcnt lgkmcnt(6)
    v_mfma_f32_16x16x32_bf16 v[96:99], v[244:247], v[24:27], v[96:99]
    ds_read_b64_tr_b16 v[236:237], v5 offset:33312
    v_mfma_f32_16x16x32_bf16 v[100:103], v[244:247], v[28:31], v[100:103]
    ds_read_b64_tr_b16 v[238:239], v5 offset:34336
    s_waitcnt lgkmcnt(6)
    v_mfma_f32_16x16x32_bf16 v[104:107], v[224:227], v[24:27], v[104:107]
    s_add_u32 s22, s24, 0x32000
    s_add_u32 m0, s20, 0x10400
    s_nop 0
    buffer_load_dwordx4 v3, s[4:7], s22 offen lds
    ds_read_b64_tr_b16 v[240:241], v4 offset:33536
    v_mfma_f32_16x16x32_bf16 v[108:111], v[224:227], v[28:31], v[108:111]
    ds_read_b64_tr_b16 v[242:243], v4 offset:34560
    v_xor_b32 v16, s28, v184
    v_xor_b32 v17, s28, v185
    v_xor_b32 v18, s28, v186
    v_xor_b32 v19, s28, v187
    v_or3_b32 v16, v16, v17, v18
    v_or_b32 v16, v16, v19
    v_cmp_ne_u32 vcc, 0, v16
    s_cbranch_vccnz adaLN_cond__sliding_block_cached__moe_arch_mod__prompt_kernel_mf21r
adaLN_cond__sliding_block_cached__moe_arch_mod__prompt_kernel_mf21b:
    s_waitcnt lgkmcnt(6)
    v_mfma_f32_16x16x32_bf16 v[112:115], v[228:231], v[24:27], v[112:115]
    ds_read_b64_tr_b16 v[244:245], v5 offset:33568
    v_mfma_f32_16x16x32_bf16 v[116:119], v[228:231], v[28:31], v[116:119]
    ds_read_b64_tr_b16 v[246:247], v5 offset:34592
    s_waitcnt lgkmcnt(6)
    v_mfma_f32_16x16x32_bf16 v[120:123], v[232:235], v[24:27], v[120:123]
    v_mfma_f32_16x16x32_bf16 v[124:127], v[232:235], v[28:31], v[124:127]
    s_barrier
    ds_read_b64_tr_b16 v[224:225], v4 offset:49152
    ds_read_b64_tr_b16 v[226:227], v4 offset:50176
    s_waitcnt lgkmcnt(6)
    v_mfma_f32_16x16x32_bf16 v[128:131], v[236:239], v[24:27], v[128:131]
    ds_read_b64_tr_b16 v[228:229], v5 offset:49184
    s_mov_b32 s23, 0x0
    buffer_load_dwordx4 v[56:59], v6, s[8:11], s23 offen offset:3072 sc1
    v_mfma_f32_16x16x32_bf16 v[132:135], v[236:239], v[28:31], v[132:135]
    ds_read_b64_tr_b16 v[230:231], v5 offset:50208
    s_waitcnt lgkmcnt(6)
    v_mfma_f32_16x16x32_bf16 v[136:139], v[240:243], v[24:27], v[136:139]
    ds_read_b64_tr_b16 v[232:233], v4 offset:49408
    v_mfma_f32_16x16x32_bf16 v[140:143], v[240:243], v[28:31], v[140:143]
    ds_read_b64_tr_b16 v[234:235], v4 offset:50432
    s_mov_b32 s23, 0x20000
    buffer_load_dwordx4 v[60:63], v6, s[8:11], s23 offen offset:3072 sc1
    s_waitcnt lgkmcnt(6)
    v_mfma_f32_16x16x32_bf16 v[144:147], v[244:247], v[24:27], v[144:147]
    ds_read_b64_tr_b16 v[236:237], v5 offset:49440
    v_mfma_f32_16x16x32_bf16 v[148:151], v[244:247], v[28:31], v[148:151]
    ds_read_b64_tr_b16 v[238:239], v5 offset:50464
    s_waitcnt lgkmcnt(6)
    v_mfma_f32_16x16x32_bf16 v[88:91], v[224:227], v[32:35], v[88:91]
    ds_read_b64_tr_b16 v[240:241], v4 offset:49664
    v_mfma_f32_16x16x32_bf16 v[92:95], v[224:227], v[36:39], v[92:95]
    s_add_u32 s22, s24, 0xb0000
    s_add_u32 m0, s20, 0x14000
    s_nop 0
    buffer_load_dwordx4 v3, s[4:7], s22 offen lds
    ds_read_b64_tr_b16 v[242:243], v4 offset:50688
    s_waitcnt lgkmcnt(6)
    v_mfma_f32_16x16x32_bf16 v[96:99], v[228:231], v[32:35], v[96:99]
    ds_read_b64_tr_b16 v[244:245], v5 offset:49696
    v_mfma_f32_16x16x32_bf16 v[100:103], v[228:231], v[36:39], v[100:103]
    ds_read_b64_tr_b16 v[246:247], v5 offset:50720
    s_waitcnt lgkmcnt(6)
    v_mfma_f32_16x16x32_bf16 v[104:107], v[232:235], v[32:35], v[104:107]
    s_add_u32 s22, s24, 0xb2000
    s_add_u32 m0, s20, 0x14400
    s_nop 0
    buffer_load_dwordx4 v3, s[4:7], s22 offen lds
    ds_read_b64_tr_b16 v[224:225], v4 offset:49920
    v_mfma_f32_16x16x32_bf16 v[108:111], v[232:235], v[36:39], v[108:111]
    ds_read_b64_tr_b16 v[226:227], v4 offset:50944
    s_waitcnt lgkmcnt(6)
    v_mfma_f32_16x16x32_bf16 v[112:115], v[236:239], v[32:35], v[112:115]
    ds_read_b64_tr_b16 v[228:229], v5 offset:49952
    v_mfma_f32_16x16x32_bf16 v[116:119], v[236:239], v[36:39], v[116:119]
    ds_read_b64_tr_b16 v[230:231], v5 offset:50976
    s_waitcnt lgkmcnt(6)
    v_mfma_f32_16x16x32_bf16 v[120:123], v[240:243], v[32:35], v[120:123]
    v_mfma_f32_16x16x32_bf16 v[124:127], v[240:243], v[36:39], v[124:127]
    s_barrier
    ds_read_b64_tr_b16 v[232:233], v7 offset:0
    ds_read_b64_tr_b16 v[234:235], v7 offset:1024
    s_waitcnt lgkmcnt(6)
    v_mfma_f32_16x16x32_bf16 v[128:131], v[244:247], v[32:35], v[128:131]
    ds_read_b64_tr_b16 v[236:237], v8 offset:32
    s_mov_b32 s23, 0x2000
    buffer_load_dwordx4 v[24:27], v6, s[8:11], s23 offen offset:3072 sc1
    v_mfma_f32_16x16x32_bf16 v[132:135], v[244:247], v[36:39], v[132:135]
    ds_read_b64_tr_b16 v[238:239], v8 offset:1056
    s_waitcnt lgkmcnt(6)
    v_mfma_f32_16x16x32_bf16 v[136:139], v[224:227], v[32:35], v[136:139]
    ds_read_b64_tr_b16 v[240:241], v7 offset:256
    v_mfma_f32_16x16x32_bf16 v[140:143], v[224:227], v[36:39], v[140:143]
    ds_read_b64_tr_b16 v[242:243], v7 offset:1280
    s_mov_b32 s23, 0x22000
    buffer_load_dwordx4 v[28:31], v6, s[8:11], s23 offen offset:3072 sc1
    s_waitcnt lgkmcnt(6)
    v_mfma_f32_16x16x32_bf16 v[144:147], v[228:231], v[32:35], v[144:147]
    ds_read_b64_tr_b16 v[244:245], v8 offset:288
    v_mfma_f32_16x16x32_bf16 v[148:151], v[228:231], v[36:39], v[148:151]
    ds_read_b64_tr_b16 v[246:247], v8 offset:1312
    s_waitcnt vmcnt(13) lgkmcnt(6)
    v_mfma_f32_16x16x32_bf16 v[88:91], v[232:235], v[40:43], v[88:91]
    ds_read_b64_tr_b16 v[224:225], v7 offset:512
    s_waitcnt vmcnt(12)
    v_mfma_f32_16x16x32_bf16 v[92:95], v[232:235], v[44:47], v[92:95]
    s_add_u32 s22, s24, 0x130000
    s_add_u32 m0, s20, 0x18000
    s_nop 0
    buffer_load_dwordx4 v3, s[4:7], s22 offen lds
    ds_read_b64_tr_b16 v[226:227], v7 offset:1536
    s_waitcnt lgkmcnt(6)
    v_mfma_f32_16x16x32_bf16 v[96:99], v[236:239], v[40:43], v[96:99]
    ds_read_b64_tr_b16 v[228:229], v8 offset:544
    v_mfma_f32_16x16x32_bf16 v[100:103], v[236:239], v[44:47], v[100:103]
    ds_read_b64_tr_b16 v[230:231], v8 offset:1568
    s_waitcnt lgkmcnt(6)
    v_mfma_f32_16x16x32_bf16 v[104:107], v[240:243], v[40:43], v[104:107]
    s_add_u32 s22, s24, 0x132000
    s_add_u32 m0, s20, 0x18400
    s_nop 0
    buffer_load_dwordx4 v3, s[4:7], s22 offen lds
    ds_read_b64_tr_b16 v[232:233], v7 offset:768
    v_mfma_f32_16x16x32_bf16 v[108:111], v[240:243], v[44:47], v[108:111]
    ds_read_b64_tr_b16 v[234:235], v7 offset:1792
    s_waitcnt lgkmcnt(6)
    v_mfma_f32_16x16x32_bf16 v[112:115], v[244:247], v[40:43], v[112:115]
    ds_read_b64_tr_b16 v[236:237], v8 offset:800
    v_mfma_f32_16x16x32_bf16 v[116:119], v[244:247], v[44:47], v[116:119]
    ds_read_b64_tr_b16 v[238:239], v8 offset:1824
    s_waitcnt lgkmcnt(6)
    v_mfma_f32_16x16x32_bf16 v[120:123], v[224:227], v[40:43], v[120:123]
    v_mfma_f32_16x16x32_bf16 v[124:127], v[224:227], v[44:47], v[124:127]
    s_waitcnt vmcnt(12)
    s_barrier
    ds_read_b64_tr_b16 v[240:241], v7 offset:16384
    ds_read_b64_tr_b16 v[242:243], v7 offset:17408
    s_waitcnt lgkmcnt(6)
    v_mfma_f32_16x16x32_bf16 v[128:131], v[228:231], v[40:43], v[128:131]
    ds_read_b64_tr_b16 v[244:245], v8 offset:16416
    s_mov_b32 s23, 0x4000
    buffer_load_dwordx4 v[32:35], v6, s[8:11], s23 offen offset:3072 sc1
    v_mfma_f32_16x16x32_bf16 v[132:135], v[228:231], v[44:47], v[132:135]
    ds_read_b64_tr_b16 v[246:247], v8 offset:17440
    s_waitcnt lgkmcnt(6)
    v_mfma_f32_16x16x32_bf16 v[136:139], v[232:235], v[40:43], v[136:139]
    ds_read_b64_tr_b16 v[224:225], v7 offset:16640
    v_mfma_f32_16x16x32_bf16 v[140:143], v[232:235], v[44:47], v[140:143]
    ds_read_b64_tr_b16 v[226:227], v7 offset:17664
    s_mov_b32 s23, 0x24000
    buffer_load_dwordx4 v[36:39], v6, s[8:11], s23 offen offset:3072 sc1
    s_waitcnt lgkmcnt(6)
    v_mfma_f32_16x16x32_bf16 v[144:147], v[236:239], v[40:43], v[144:147]
    ds_read_b64_tr_b16 v[228:229], v8 offset:16672
    v_mfma_f32_16x16x32_bf16 v[148:151], v[236:239], v[44:47], v[148:151]
    ds_read_b64_tr_b16 v[230:231], v8 offset:17696
    s_waitcnt vmcnt(13) lgkmcnt(6)
    v_mfma_f32_16x16x32_bf16 v[88:91], v[240:243], v[48:51], v[88:91]
    ds_read_b64_tr_b16 v[232:233], v7 offset:16896
    s_waitcnt vmcnt(12)
    v_mfma_f32_16x16x32_bf16 v[92:95], v[240:243], v[52:55], v[92:95]
    s_add_u32 s22, s24, 0x1b0000
    s_add_u32 m0, s20, 0x1c000
    s_nop 0
    buffer_load_dwordx4 v3, s[4:7], s22 offen lds
    ds_read_b64_tr_b16 v[234:235], v7 offset:17920
    s_waitcnt lgkmcnt(6)
    v_mfma_f32_16x16x32_bf16 v[96:99], v[244:247], v[48:51], v[96:99]
    ds_read_b64_tr_b16 v[236:237], v8 offset:16928
    v_mfma_f32_16x16x32_bf16 v[100:103], v[244:247], v[52:55], v[100:103]
    ds_read_b64_tr_b16 v[238:239], v8 offset:17952
    s_waitcnt lgkmcnt(6)
    v_mfma_f32_16x16x32_bf16 v[104:107], v[224:227], v[48:51], v[104:107]
    s_add_u32 s22, s24, 0x1b2000
    s_add_u32 m0, s20, 0x1c400
    s_nop 0
    buffer_load_dwordx4 v3, s[4:7], s22 offen lds
    ds_read_b64_tr_b16 v[240:241], v7 offset:17152
    v_mfma_f32_16x16x32_bf16 v[108:111], v[224:227], v[52:55], v[108:111]
    ds_read_b64_tr_b16 v[242:243], v7 offset:18176
    s_waitcnt lgkmcnt(6)
    v_mfma_f32_16x16x32_bf16 v[112:115], v[228:231], v[48:51], v[112:115]
    ds_read_b64_tr_b16 v[244:245], v8 offset:17184
    v_mfma_f32_16x16x32_bf16 v[116:119], v[228:231], v[52:55], v[116:119]
    ds_read_b64_tr_b16 v[246:247], v8 offset:18208
    s_waitcnt lgkmcnt(6)
    v_mfma_f32_16x16x32_bf16 v[120:123], v[232:235], v[48:51], v[120:123]
    v_mfma_f32_16x16x32_bf16 v[124:127], v[232:235], v[52:55], v[124:127]
    s_waitcnt vmcnt(12)
    s_barrier
    ds_read_b64_tr_b16 v[224:225], v4 offset:0
    ds_read_b64_tr_b16 v[226:227], v4 offset:1024
    s_waitcnt lgkmcnt(6)
    v_mfma_f32_16x16x32_bf16 v[128:131], v[236:239], v[48:51], v[128:131]
    ds_read_b64_tr_b16 v[228:229], v5 offset:32
    s_mov_b32 s23, 0x6000
    buffer_load_dwordx4 v[40:43], v6, s[8:11], s23 offen offset:3072 sc1
    v_mfma_f32_16x16x32_bf16 v[132:135], v[236:239], v[52:55], v[132:135]
    ds_read_b64_tr_b16 v[230:231], v5 offset:1056
    s_waitcnt lgkmcnt(6)
    v_mfma_f32_16x16x32_bf16 v[136:139], v[240:243], v[48:51], v[136:139]
    ds_read_b64_tr_b16 v[232:233], v4 offset:256
    v_mfma_f32_16x16x32_bf16 v[140:143], v[240:243], v[52:55], v[140:143]
    ds_read_b64_tr_b16 v[234:235], v4 offset:1280
    s_mov_b32 s23, 0x26000
    buffer_load_dwordx4 v[44:47], v6, s[8:11], s23 offen offset:3072 sc1
    s_waitcnt lgkmcnt(6)
    v_mfma_f32_16x16x32_bf16 v[144:147], v[244:247], v[48:51], v[144:147]
    ds_read_b64_tr_b16 v[236:237], v5 offset:288
    v_mfma_f32_16x16x32_bf16 v[148:151], v[244:247], v[52:55], v[148:151]
    ds_read_b64_tr_b16 v[238:239], v5 offset:1312
    s_waitcnt vmcnt(13) lgkmcnt(6)
    v_mfma_f32_16x16x32_bf16 v[88:91], v[224:227], v[56:59], v[88:91]
    ds_read_b64_tr_b16 v[240:241], v4 offset:512
    s_waitcnt vmcnt(12)
    v_mfma_f32_16x16x32_bf16 v[92:95], v[224:227], v[60:63], v[92:95]
    s_add_u32 s22, s24, 0x230000
    s_add_u32 m0, s20, 0x20000
    s_nop 0
    buffer_load_dwordx4 v3, s[4:7], s22 offen lds
    ds_read_b64_tr_b16 v[242:243], v4 offset:1536
    s_waitcnt lgkmcnt(6)
    v_mfma_f32_16x16x32_bf16 v[96:99], v[228:231], v[56:59], v[96:99]
    ds_read_b64_tr_b16 v[244:245], v5 offset:544
    v_mfma_f32_16x16x32_bf16 v[100:103], v[228:231], v[60:63], v[100:103]
    ds_read_b64_tr_b16 v[246:247], v5 offset:1568
    s_waitcnt lgkmcnt(6)
    v_mfma_f32_16x16x32_bf16 v[104:107], v[232:235], v[56:59], v[104:107]
    s_add_u32 s22, s24, 0x232000
    s_add_u32 m0, s20, 0x20400
    s_nop 0
    buffer_load_dwordx4 v3, s[4:7], s22 offen lds
    ds_read_b64_tr_b16 v[224:225], v4 offset:768
    v_mfma_f32_16x16x32_bf16 v[108:111], v[232:235], v[60:63], v[108:111]
    ds_read_b64_tr_b16 v[226:227], v4 offset:1792
    s_waitcnt lgkmcnt(6)
    v_mfma_f32_16x16x32_bf16 v[112:115], v[236:239], v[56:59], v[112:115]
    ds_read_b64_tr_b16 v[228:229], v5 offset:800
    v_mfma_f32_16x16x32_bf16 v[116:119], v[236:239], v[60:63], v[116:119]
    ds_read_b64_tr_b16 v[230:231], v5 offset:1824
    s_waitcnt lgkmcnt(6)
    v_mfma_f32_16x16x32_bf16 v[120:123], v[240:243], v[56:59], v[120:123]
    v_mfma_f32_16x16x32_bf16 v[124:127], v[240:243], v[60:63], v[124:127]
    s_waitcnt vmcnt(12)
    s_barrier
    ds_read_b64_tr_b16 v[232:233], v4 offset:16384
    ds_read_b64_tr_b16 v[234:235], v4 offset:17408
    s_waitcnt lgkmcnt(6)
    v_mfma_f32_16x16x32_bf16 v[128:131], v[244:247], v[56:59], v[128:131]
    ds_read_b64_tr_b16 v[236:237], v5 offset:16416
    s_mov_b32 s23, 0x8000
    buffer_load_dwordx4 v[48:51], v6, s[8:11], s23 offen offset:3072 sc1
    v_mfma_f32_16x16x32_bf16 v[132:135], v[244:247], v[60:63], v[132:135]
    ds_read_b64_tr_b16 v[238:239], v5 offset:17440
    s_waitcnt lgkmcnt(6)
    v_mfma_f32_16x16x32_bf16 v[136:139], v[224:227], v[56:59], v[136:139]
    ds_read_b64_tr_b16 v[240:241], v4 offset:16640
    v_mfma_f32_16x16x32_bf16 v[140:143], v[224:227], v[60:63], v[140:143]
    ds_read_b64_tr_b16 v[242:243], v4 offset:17664
    s_mov_b32 s23, 0x28000
    buffer_load_dwordx4 v[52:55], v6, s[8:11], s23 offen offset:3072 sc1
    s_waitcnt lgkmcnt(6)
    v_mfma_f32_16x16x32_bf16 v[144:147], v[228:231], v[56:59], v[144:147]
    ds_read_b64_tr_b16 v[244:245], v5 offset:16672
    v_mfma_f32_16x16x32_bf16 v[148:151], v[228:231], v[60:63], v[148:151]
    ds_read_b64_tr_b16 v[246:247], v5 offset:17696
    s_waitcnt vmcnt(13) lgkmcnt(6)
    v_mfma_f32_16x16x32_bf16 v[88:91], v[232:235], v[24:27], v[88:91]
    ds_read_b64_tr_b16 v[224:225], v4 offset:16896
    s_waitcnt vmcnt(12)
    v_mfma_f32_16x16x32_bf16 v[92:95], v[232:235], v[28:31], v[92:95]
    s_add_u32 s22, s24, 0x2b0000
    s_add_u32 m0, s20, 0x24000
    s_nop 0
    buffer_load_dwordx4 v3, s[4:7], s22 offen lds
    ds_read_b64_tr_b16 v[226:227], v4 offset:17920
    s_waitcnt lgkmcnt(6)
    v_mfma_f32_16x16x32_bf16 v[96:99], v[236:239], v[24:27], v[96:99]
    ds_read_b64_tr_b16 v[228:229], v5 offset:16928
    v_mfma_f32_16x16x32_bf16 v[100:103], v[236:239], v[28:31], v[100:103]
    ds_read_b64_tr_b16 v[230:231], v5 offset:17952
    s_waitcnt lgkmcnt(6)
    v_mfma_f32_16x16x32_bf16 v[104:107], v[240:243], v[24:27], v[104:107]
    s_add_u32 s22, s24, 0x2b2000
    s_add_u32 m0, s20, 0x24400
    s_nop 0
    buffer_load_dwordx4 v3, s[4:7], s22 offen lds
    ds_read_b64_tr_b16 v[232:233], v4 offset:17152
    v_mfma_f32_16x16x32_bf16 v[108:111], v[240:243], v[28:31], v[108:111]
    ds_read_b64_tr_b16 v[234:235], v4 offset:18176
    s_waitcnt lgkmcnt(6)
    v_mfma_f32_16x16x32_bf16 v[112:115], v[244:247], v[24:27], v[112:115]
    ds_read_b64_tr_b16 v[236:237], v5 offset:17184
    v_mfma_f32_16x16x32_bf16 v[116:119], v[244:247], v[28:31], v[116:119]
    ds_read_b64_tr_b16 v[238:239], v5 offset:18208
    s_waitcnt lgkmcnt(6)
    v_mfma_f32_16x16x32_bf16 v[120:123], v[224:227], v[24:27], v[120:123]
    v_mfma_f32_16x16x32_bf16 v[124:127], v[224:227], v[28:31], v[124:127]
    s_waitcnt vmcnt(12)
    s_barrier
    ds_read_b64_tr_b16 v[240:241], v4 offset:32768
    ds_read_b64_tr_b16 v[242:243], v4 offset:33792
    s_waitcnt lgkmcnt(6)
    v_mfma_f32_16x16x32_bf16 v[128:131], v[228:231], v[24:27], v[128:131]
    ds_read_b64_tr_b16 v[244:245], v5 offset:32800
    s_mov_b32 s23, 0xa000
    buffer_load_dwordx4 v[56:59], v6, s[8:11], s23 offen offset:3072 sc1
    v_mfma_f32_16x16x32_bf16 v[132:135], v[228:231], v[28:31], v[132:135]
    ds_read_b64_tr_b16 v[246:247], v5 offset:33824
    s_waitcnt lgkmcnt(6)
    v_mfma_f32_16x16x32_bf16 v[136:139], v[232:235], v[24:27], v[136:139]
    ds_read_b64_tr_b16 v[224:225], v4 offset:33024
    v_mfma_f32_16x16x32_bf16 v[140:143], v[232:235], v[28:31], v[140:143]
    ds_read_b64_tr_b16 v[226:227], v4 offset:34048
    s_mov_b32 s23, 0x2a000
    buffer_load_dwordx4 v[60:63], v6, s[8:11], s23 offen offset:3072 sc1
    s_waitcnt lgkmcnt(6)
    v_mfma_f32_16x16x32_bf16 v[144:147], v[236:239], v[24:27], v[144:147]
    ds_read_b64_tr_b16 v[228:229], v5 offset:33056
    v_mfma_f32_16x16x32_bf16 v[148:151], v[236:239], v[28:31], v[148:151]
    ds_read_b64_tr_b16 v[230:231], v5 offset:34080
    s_waitcnt vmcnt(13) lgkmcnt(6)
    v_mfma_f32_16x16x32_bf16 v[88:91], v[240:243], v[32:35], v[88:91]
    ds_read_b64_tr_b16 v[232:233], v4 offset:33280
    s_waitcnt vmcnt(12)
    v_mfma_f32_16x16x32_bf16 v[92:95], v[240:243], v[36:39], v[92:95]
    s_add_u32 s22, s24, 0x330000
    s_add_u32 m0, s20, 0x10000
    s_nop 0
    buffer_load_dwordx4 v3, s[4:7], s22 offen lds
    ds_read_b64_tr_b16 v[234:235], v4 offset:34304
    s_waitcnt lgkmcnt(6)
    v_mfma_f32_16x16x32_bf16 v[96:99], v[244:247], v[32:35], v[96:99]
    ds_read_b64_tr_b16 v[236:237], v5 offset:33312
    v_mfma_f32_16x16x32_bf16 v[100:103], v[244:247], v[36:39], v[100:103]
    ds_read_b64_tr_b16 v[238:239], v5 offset:34336
    s_waitcnt lgkmcnt(6)
    v_mfma_f32_16x16x32_bf16 v[104:107], v[224:227], v[32:35], v[104:107]
    s_add_u32 s22, s24, 0x332000
    s_add_u32 m0, s20, 0x10400
    s_nop 0
    buffer_load_dwordx4 v3, s[4:7], s22 offen lds
    ds_read_b64_tr_b16 v[240:241], v4 offset:33536
    v_mfma_f32_16x16x32_bf16 v[108:111], v[224:227], v[36:39], v[108:111]
    ds_read_b64_tr_b16 v[242:243], v4 offset:34560
    v_lshrrev_b32 v16, 4, v1
    v_lshlrev_b32 v16, 3, v16
    s_lshl_b32 s16, s31, 8
    s_add_u32 s16, s16, 0x540080
    buffer_load_dwordx2 v[248:249], v16, s[8:11], s16 offen offset:0 sc1
    buffer_load_dwordx2 v[250:251], v16, s[8:11], s16 offen offset:32 sc1
    buffer_load_dwordx2 v[252:253], v16, s[8:11], s16 offen offset:64 sc1
    buffer_load_dwordx2 v[254:255], v16, s[8:11], s16 offen offset:96 sc1
    s_waitcnt lgkmcnt(6)
    v_mfma_f32_16x16x32_bf16 v[112:115], v[228:231], v[32:35], v[112:115]
    ds_read_b64_tr_b16 v[244:245], v5 offset:33568
    v_mfma_f32_16x16x32_bf16 v[116:119], v[228:231], v[36:39], v[116:119]
    ds_read_b64_tr_b16 v[246:247], v5 offset:34592
    s_waitcnt lgkmcnt(6)
    v_mfma_f32_16x16x32_bf16 v[120:123], v[232:235], v[32:35], v[120:123]
    v_mfma_f32_16x16x32_bf16 v[124:127], v[232:235], v[36:39], v[124:127]
    s_waitcnt vmcnt(16)
    s_barrier
    ds_read_b64_tr_b16 v[224:225], v4 offset:49152
    ds_read_b64_tr_b16 v[226:227], v4 offset:50176
    s_waitcnt lgkmcnt(6)
    v_mfma_f32_16x16x32_bf16 v[128:131], v[236:239], v[32:35], v[128:131]
    ds_read_b64_tr_b16 v[228:229], v5 offset:49184
    s_mov_b32 s23, 0xc000
    buffer_load_dwordx4 v[24:27], v6, s[8:11], s23 offen offset:3072 sc1
    v_mfma_f32_16x16x32_bf16 v[132:135], v[236:239], v[36:39], v[132:135]
    ds_read_b64_tr_b16 v[230:231], v5 offset:50208
    s_waitcnt lgkmcnt(6)
    v_mfma_f32_16x16x32_bf16 v[136:139], v[240:243], v[32:35], v[136:139]
    ds_read_b64_tr_b16 v[232:233], v4 offset:49408
    v_mfma_f32_16x16x32_bf16 v[140:143], v[240:243], v[36:39], v[140:143]
    ds_read_b64_tr_b16 v[234:235], v4 offset:50432
    s_mov_b32 s23, 0x2c000
    buffer_load_dwordx4 v[28:31], v6, s[8:11], s23 offen offset:3072 sc1
    s_waitcnt lgkmcnt(6)
    v_mfma_f32_16x16x32_bf16 v[144:147], v[244:247], v[32:35], v[144:147]
    ds_read_b64_tr_b16 v[236:237], v5 offset:49440
    v_mfma_f32_16x16x32_bf16 v[148:151], v[244:247], v[36:39], v[148:151]
    ds_read_b64_tr_b16 v[238:239], v5 offset:50464
    s_waitcnt vmcnt(17) lgkmcnt(6)
    v_mfma_f32_16x16x32_bf16 v[88:91], v[224:227], v[40:43], v[88:91]
    ds_read_b64_tr_b16 v[240:241], v4 offset:49664
    s_waitcnt vmcnt(16)
    v_mfma_f32_16x16x32_bf16 v[92:95], v[224:227], v[44:47], v[92:95]
    s_add_u32 s22, s24, 0x3b0000
    s_add_u32 m0, s20, 0x14000
    s_nop 0
    buffer_load_dwordx4 v3, s[4:7], s22 offen lds
    ds_read_b64_tr_b16 v[242:243], v4 offset:50688
    s_waitcnt lgkmcnt(6)
    v_mfma_f32_16x16x32_bf16 v[96:99], v[228:231], v[40:43], v[96:99]
    ds_read_b64_tr_b16 v[244:245], v5 offset:49696
    v_mfma_f32_16x16x32_bf16 v[100:103], v[228:231], v[44:47], v[100:103]
    ds_read_b64_tr_b16 v[246:247], v5 offset:50720
    s_waitcnt lgkmcnt(6)
    v_mfma_f32_16x16x32_bf16 v[104:107], v[232:235], v[40:43], v[104:107]
    s_add_u32 s22, s24, 0x3b2000
    s_add_u32 m0, s20, 0x14400
    s_nop 0
    buffer_load_dwordx4 v3, s[4:7], s22 offen lds
    ds_read_b64_tr_b16 v[224:225], v4 offset:49920
    v_mfma_f32_16x16x32_bf16 v[108:111], v[232:235], v[44:47], v[108:111]
    ds_read_b64_tr_b16 v[226:227], v4 offset:50944
    s_waitcnt lgkmcnt(6)
    v_mfma_f32_16x16x32_bf16 v[112:115], v[236:239], v[40:43], v[112:115]
    ds_read_b64_tr_b16 v[228:229], v5 offset:49952
    v_mfma_f32_16x16x32_bf16 v[116:119], v[236:239], v[44:47], v[116:119]
    ds_read_b64_tr_b16 v[230:231], v5 offset:50976
    s_waitcnt lgkmcnt(6)
    v_mfma_f32_16x16x32_bf16 v[120:123], v[240:243], v[40:43], v[120:123]
    v_mfma_f32_16x16x32_bf16 v[124:127], v[240:243], v[44:47], v[124:127]
    s_waitcnt vmcnt(16)
    s_barrier
    ds_read_b64_tr_b16 v[232:233], v7 offset:0
    ds_read_b64_tr_b16 v[234:235], v7 offset:1024
    s_waitcnt lgkmcnt(6)
    v_mfma_f32_16x16x32_bf16 v[128:131], v[244:247], v[40:43], v[128:131]
    ds_read_b64_tr_b16 v[236:237], v8 offset:32
    s_mov_b32 s23, 0xe000
    buffer_load_dwordx4 v[32:35], v6, s[8:11], s23 offen offset:3072 sc1
    v_mfma_f32_16x16x32_bf16 v[132:135], v[244:247], v[44:47], v[132:135]
    ds_read_b64_tr_b16 v[238:239], v8 offset:1056
    s_waitcnt lgkmcnt(6)
    v_mfma_f32_16x16x32_bf16 v[136:139], v[224:227], v[40:43], v[136:139]
    ds_read_b64_tr_b16 v[240:241], v7 offset:256
    v_mfma_f32_16x16x32_bf16 v[140:143], v[224:227], v[44:47], v[140:143]
    ds_read_b64_tr_b16 v[242:243], v7 offset:1280
    s_mov_b32 s23, 0x2e000
    buffer_load_dwordx4 v[36:39], v6, s[8:11], s23 offen offset:3072 sc1
    s_waitcnt lgkmcnt(6)
    v_mfma_f32_16x16x32_bf16 v[144:147], v[228:231], v[40:43], v[144:147]
    ds_read_b64_tr_b16 v[244:245], v8 offset:288
    v_mfma_f32_16x16x32_bf16 v[148:151], v[228:231], v[44:47], v[148:151]
    ds_read_b64_tr_b16 v[246:247], v8 offset:1312
    s_waitcnt vmcnt(17) lgkmcnt(6)
    v_mfma_f32_16x16x32_bf16 v[88:91], v[232:235], v[48:51], v[88:91]
    ds_read_b64_tr_b16 v[224:225], v7 offset:512
    s_waitcnt vmcnt(16)
    v_mfma_f32_16x16x32_bf16 v[92:95], v[232:235], v[52:55], v[92:95]
    ds_read_b64_tr_b16 v[226:227], v7 offset:1536
    s_waitcnt lgkmcnt(6)
    v_mfma_f32_16x16x32_bf16 v[96:99], v[236:239], v[48:51], v[96:99]
    ds_read_b64_tr_b16 v[228:229], v8 offset:544
    v_mfma_f32_16x16x32_bf16 v[100:103], v[236:239], v[52:55], v[100:103]
    ds_read_b64_tr_b16 v[230:231], v8 offset:1568
    s_waitcnt lgkmcnt(6)
    v_mfma_f32_16x16x32_bf16 v[104:107], v[240:243], v[48:51], v[104:107]
    ds_read_b64_tr_b16 v[232:233], v7 offset:768
    v_mfma_f32_16x16x32_bf16 v[108:111], v[240:243], v[52:55], v[108:111]
    ds_read_b64_tr_b16 v[234:235], v7 offset:1792
    s_waitcnt lgkmcnt(6)
    v_mfma_f32_16x16x32_bf16 v[112:115], v[244:247], v[48:51], v[112:115]
    ds_read_b64_tr_b16 v[236:237], v8 offset:800
    v_mfma_f32_16x16x32_bf16 v[116:119], v[244:247], v[52:55], v[116:119]
    ds_read_b64_tr_b16 v[238:239], v8 offset:1824
    s_waitcnt lgkmcnt(6)
    v_mfma_f32_16x16x32_bf16 v[120:123], v[224:227], v[48:51], v[120:123]
    s_mov_b64 s[72:73], s[48:49]
    s_mov_b32 s74, 0x700000
    s_mov_b32 s75, 0x20000
    s_cmp_lt_u32 s2, 224
    s_cselect_b32 s74, 7340032, 0
    s_sub_u32 s16, s3, 4
    v_lshrrev_b32 v20, 3, v1
    v_lshlrev_b32 v20, 3, v20
    s_lshl_b32 s17, s16, 6
    v_add_u32 v20, s17, v20
    s_mov_b32 s17, 7168
    v_mul_lo_u32 v21, s17, v20
    v_and_b32 v20, 7, v1
    v_lshl_add_u32 v21, v20, 4, v21
    s_and_b32 s17, s29, 3
    s_mul_i32 s18, s17, 1835008
    s_lshr_b32 s17, s29, 2
    s_lshl_b32 s17, s17, 7
    s_add_u32 s18, s18, s17
    s_lshl_b32 s16, s16, 13
    s_add_u32 s22, s18, 0
    s_add_u32 m0, s16, 32768
    s_nop 0
    buffer_load_dwordx4 v21, s[72:75], s22 offen lds
    s_add_u32 s22, s18, 7168
    s_add_u32 m0, s16, 33792
    s_nop 0
    buffer_load_dwordx4 v21, s[72:75], s22 offen lds
    s_add_u32 s22, s18, 14336
    s_add_u32 m0, s16, 34816
    s_nop 0
    buffer_load_dwordx4 v21, s[72:75], s22 offen lds
    s_add_u32 s22, s18, 21504
    s_add_u32 m0, s16, 35840
    s_nop 0
    buffer_load_dwordx4 v21, s[72:75], s22 offen lds
    s_add_u32 s22, s18, 28672
    s_add_u32 m0, s16, 36864
    s_nop 0
    buffer_load_dwordx4 v21, s[72:75], s22 offen lds
    s_add_u32 s22, s18, 35840
    s_add_u32 m0, s16, 37888
    s_nop 0
    buffer_load_dwordx4 v21, s[72:75], s22 offen lds
    s_add_u32 s22, s18, 43008
    s_add_u32 m0, s16, 38912
    s_nop 0
    buffer_load_dwordx4 v21, s[72:75], s22 offen lds
    s_add_u32 s22, s18, 50176
    s_add_u32 m0, s16, 39936
    s_nop 0
    buffer_load_dwordx4 v21, s[72:75], s22 offen lds
    v_mfma_f32_16x16x32_bf16 v[124:127], v[224:227], v[52:55], v[124:127]
    s_waitcnt vmcnt(22)
    s_barrier
    ds_read_b64_tr_b16 v[240:241], v7 offset:16384
    ds_read_b64_tr_b16 v[242:243], v7 offset:17408
    s_waitcnt lgkmcnt(6)
    v_mfma_f32_16x16x32_bf16 v[128:131], v[228:231], v[48:51], v[128:131]
    ds_read_b64_tr_b16 v[244:245], v8 offset:16416
    v_mfma_f32_16x16x32_bf16 v[132:135], v[228:231], v[52:55], v[132:135]
    ds_read_b64_tr_b16 v[246:247], v8 offset:17440
    s_waitcnt lgkmcnt(6)
    v_mfma_f32_16x16x32_bf16 v[136:139], v[232:235], v[48:51], v[136:139]
    ds_read_b64_tr_b16 v[224:225], v7 offset:16640
    v_mfma_f32_16x16x32_bf16 v[140:143], v[232:235], v[52:55], v[140:143]
    ds_read_b64_tr_b16 v[226:227], v7 offset:17664
    s_waitcnt lgkmcnt(6)
    v_mfma_f32_16x16x32_bf16 v[144:147], v[236:239], v[48:51], v[144:147]
    ds_read_b64_tr_b16 v[228:229], v8 offset:16672
    v_mfma_f32_16x16x32_bf16 v[148:151], v[236:239], v[52:55], v[148:151]
    ds_read_b64_tr_b16 v[230:231], v8 offset:17696
    s_waitcnt vmcnt(21) lgkmcnt(6)
    v_mfma_f32_16x16x32_bf16 v[88:91], v[240:243], v[56:59], v[88:91]
    ds_read_b64_tr_b16 v[232:233], v7 offset:16896
    s_waitcnt vmcnt(20)
    v_mfma_f32_16x16x32_bf16 v[92:95], v[240:243], v[60:63], v[92:95]
    ds_read_b64_tr_b16 v[234:235], v7 offset:17920
    s_waitcnt lgkmcnt(6)
    v_mfma_f32_16x16x32_bf16 v[96:99], v[244:247], v[56:59], v[96:99]
    ds_read_b64_tr_b16 v[236:237], v8 offset:16928
    v_mfma_f32_16x16x32_bf16 v[100:103], v[244:247], v[60:63], v[100:103]
    ds_read_b64_tr_b16 v[238:239], v8 offset:17952
    s_waitcnt lgkmcnt(6)
    v_mfma_f32_16x16x32_bf16 v[104:107], v[224:227], v[56:59], v[104:107]
    ds_read_b64_tr_b16 v[240:241], v7 offset:17152
    v_mfma_f32_16x16x32_bf16 v[108:111], v[224:227], v[60:63], v[108:111]
    ds_read_b64_tr_b16 v[242:243], v7 offset:18176
    s_waitcnt lgkmcnt(6)
    v_mfma_f32_16x16x32_bf16 v[112:115], v[228:231], v[56:59], v[112:115]
    ds_read_b64_tr_b16 v[244:245], v8 offset:17184
    v_mfma_f32_16x16x32_bf16 v[116:119], v[228:231], v[60:63], v[116:119]
    ds_read_b64_tr_b16 v[246:247], v8 offset:18208
    s_waitcnt lgkmcnt(6)
    v_mfma_f32_16x16x32_bf16 v[120:123], v[232:235], v[56:59], v[120:123]
    v_mfma_f32_16x16x32_bf16 v[124:127], v[232:235], v[60:63], v[124:127]
    s_waitcnt vmcnt(18)
    s_barrier
    ds_read_b64_tr_b16 v[224:225], v4 offset:0
    ds_read_b64_tr_b16 v[226:227], v4 offset:1024
    s_waitcnt lgkmcnt(6)
    v_mfma_f32_16x16x32_bf16 v[128:131], v[236:239], v[56:59], v[128:131]
    ds_read_b64_tr_b16 v[228:229], v5 offset:32
    v_mfma_f32_16x16x32_bf16 v[132:135], v[236:239], v[60:63], v[132:135]
    ds_read_b64_tr_b16 v[230:231], v5 offset:1056
    s_waitcnt lgkmcnt(6)
    v_mfma_f32_16x16x32_bf16 v[136:139], v[240:243], v[56:59], v[136:139]
    ds_read_b64_tr_b16 v[232:233], v4 offset:256
    v_mfma_f32_16x16x32_bf16 v[140:143], v[240:243], v[60:63], v[140:143]
    ds_read_b64_tr_b16 v[234:235], v4 offset:1280
    s_waitcnt lgkmcnt(6)
    v_mfma_f32_16x16x32_bf16 v[144:147], v[244:247], v[56:59], v[144:147]
    ds_read_b64_tr_b16 v[236:237], v5 offset:288
    v_mfma_f32_16x16x32_bf16 v[148:151], v[244:247], v[60:63], v[148:151]
    ds_read_b64_tr_b16 v[238:239], v5 offset:1312
    s_waitcnt vmcnt(13) lgkmcnt(6)
    v_mfma_f32_16x16x32_bf16 v[88:91], v[224:227], v[24:27], v[88:91]
    ds_read_b64_tr_b16 v[240:241], v4 offset:512
    s_waitcnt vmcnt(12)
    v_mfma_f32_16x16x32_bf16 v[92:95], v[224:227], v[28:31], v[92:95]
    ds_read_b64_tr_b16 v[242:243], v4 offset:1536
    s_waitcnt lgkmcnt(6)
    v_mfma_f32_16x16x32_bf16 v[96:99], v[228:231], v[24:27], v[96:99]
    ds_read_b64_tr_b16 v[244:245], v5 offset:544
    v_mfma_f32_16x16x32_bf16 v[100:103], v[228:231], v[28:31], v[100:103]
    ds_read_b64_tr_b16 v[246:247], v5 offset:1568
    s_waitcnt lgkmcnt(6)
    v_mfma_f32_16x16x32_bf16 v[104:107], v[232:235], v[24:27], v[104:107]
    ds_read_b64_tr_b16 v[224:225], v4 offset:768
    v_mfma_f32_16x16x32_bf16 v[108:111], v[232:235], v[28:31], v[108:111]
    ds_read_b64_tr_b16 v[226:227], v4 offset:1792
    s_waitcnt lgkmcnt(6)
    v_mfma_f32_16x16x32_bf16 v[112:115], v[236:239], v[24:27], v[112:115]
    ds_read_b64_tr_b16 v[228:229], v5 offset:800
    v_mfma_f32_16x16x32_bf16 v[116:119], v[236:239], v[28:31], v[116:119]
    ds_read_b64_tr_b16 v[230:231], v5 offset:1824
    s_waitcnt lgkmcnt(6)
    v_mfma_f32_16x16x32_bf16 v[120:123], v[240:243], v[24:27], v[120:123]
    v_mfma_f32_16x16x32_bf16 v[124:127], v[240:243], v[28:31], v[124:127]
    s_waitcnt vmcnt(10)
    s_barrier
    ds_read_b64_tr_b16 v[232:233], v4 offset:16384
    ds_read_b64_tr_b16 v[234:235], v4 offset:17408
    s_waitcnt lgkmcnt(6)
    v_mfma_f32_16x16x32_bf16 v[128:131], v[244:247], v[24:27], v[128:131]
    ds_read_b64_tr_b16 v[236:237], v5 offset:16416
    v_mfma_f32_16x16x32_bf16 v[132:135], v[244:247], v[28:31], v[132:135]
    ds_read_b64_tr_b16 v[238:239], v5 offset:17440
    s_waitcnt lgkmcnt(6)
    v_mfma_f32_16x16x32_bf16 v[136:139], v[224:227], v[24:27], v[136:139]
    ds_read_b64_tr_b16 v[240:241], v4 offset:16640
    v_mfma_f32_16x16x32_bf16 v[140:143], v[224:227], v[28:31], v[140:143]
    ds_read_b64_tr_b16 v[242:243], v4 offset:17664
    s_waitcnt lgkmcnt(6)
    v_mfma_f32_16x16x32_bf16 v[144:147], v[228:231], v[24:27], v[144:147]
    ds_read_b64_tr_b16 v[244:245], v5 offset:16672
    v_mfma_f32_16x16x32_bf16 v[148:151], v[228:231], v[28:31], v[148:151]
    ds_read_b64_tr_b16 v[246:247], v5 offset:17696
    s_waitcnt vmcnt(9) lgkmcnt(6)
    v_mfma_f32_16x16x32_bf16 v[88:91], v[232:235], v[32:35], v[88:91]
    ds_read_b64_tr_b16 v[224:225], v4 offset:16896
    s_waitcnt vmcnt(8)
    v_mfma_f32_16x16x32_bf16 v[92:95], v[232:235], v[36:39], v[92:95]
    ds_read_b64_tr_b16 v[226:227], v4 offset:17920
    s_waitcnt lgkmcnt(6)
    v_mfma_f32_16x16x32_bf16 v[96:99], v[236:239], v[32:35], v[96:99]
    ds_read_b64_tr_b16 v[228:229], v5 offset:16928
    v_mfma_f32_16x16x32_bf16 v[100:103], v[236:239], v[36:39], v[100:103]
    ds_read_b64_tr_b16 v[230:231], v5 offset:17952
    s_waitcnt lgkmcnt(6)
    v_mfma_f32_16x16x32_bf16 v[104:107], v[240:243], v[32:35], v[104:107]
    ds_read_b64_tr_b16 v[232:233], v4 offset:17152
    v_mfma_f32_16x16x32_bf16 v[108:111], v[240:243], v[36:39], v[108:111]
    ds_read_b64_tr_b16 v[234:235], v4 offset:18176
    s_waitcnt lgkmcnt(6)
    v_mfma_f32_16x16x32_bf16 v[112:115], v[244:247], v[32:35], v[112:115]
    ds_read_b64_tr_b16 v[236:237], v5 offset:17184
    v_mfma_f32_16x16x32_bf16 v[116:119], v[244:247], v[36:39], v[116:119]
    ds_read_b64_tr_b16 v[238:239], v5 offset:18208
    s_waitcnt lgkmcnt(6)
    v_mfma_f32_16x16x32_bf16 v[120:123], v[224:227], v[32:35], v[120:123]
    v_mfma_f32_16x16x32_bf16 v[124:127], v[224:227], v[36:39], v[124:127]
    s_waitcnt lgkmcnt(4)
    v_mfma_f32_16x16x32_bf16 v[128:131], v[228:231], v[32:35], v[128:131]
    v_mfma_f32_16x16x32_bf16 v[132:135], v[228:231], v[36:39], v[132:135]
    s_waitcnt lgkmcnt(2)
    v_mfma_f32_16x16x32_bf16 v[136:139], v[232:235], v[32:35], v[136:139]
    v_mfma_f32_16x16x32_bf16 v[140:143], v[232:235], v[36:39], v[140:143]
    s_waitcnt lgkmcnt(0)
    v_mfma_f32_16x16x32_bf16 v[144:147], v[236:239], v[32:35], v[144:147]
    v_mfma_f32_16x16x32_bf16 v[148:151], v[236:239], v[36:39], v[148:151]
    s_lshl_b32 s16, s3, 13
    s_xor_b32 s17, s16, 0x8000
    s_add_u32 s16, s16, 0x18000
    s_add_u32 s17, s17, 0x18000
    v_add_u32 v16, s16, v2
    s_mov_b32 s16, s17
    v_add_u32 v17, s16, v2
    ds_write_b128 v16, v[88:91] offset:0
    ds_write_b128 v16, v[92:95] offset:1024
    ds_write_b128 v16, v[96:99] offset:2048
    ds_write_b128 v16, v[100:103] offset:3072
    ds_write_b128 v16, v[104:107] offset:4096
    ds_write_b128 v16, v[108:111] offset:5120
    ds_write_b128 v16, v[112:115] offset:6144
    ds_write_b128 v16, v[116:119] offset:7168
    v_lshlrev_b32 v24, 16, v248
    v_and_b32 v25, 0xffff0000, v248
    v_lshlrev_b32 v26, 16, v249
    v_and_b32 v27, 0xffff0000, v249
    v_lshlrev_b32 v28, 16, v250
    v_and_b32 v29, 0xffff0000, v250
    v_lshlrev_b32 v30, 16, v251
    v_and_b32 v31, 0xffff0000, v251
    v_lshlrev_b32 v32, 16, v252
    v_and_b32 v33, 0xffff0000, v252
    v_lshlrev_b32 v34, 16, v253
    v_and_b32 v35, 0xffff0000, v253
    v_lshlrev_b32 v36, 16, v254
    v_and_b32 v37, 0xffff0000, v254
    v_lshlrev_b32 v38, 16, v255
    v_and_b32 v39, 0xffff0000, v255
    v_and_b32 v18, 15, v1
    v_lshlrev_b32 v18, 6, v18
    v_lshrrev_b32 v19, 4, v1
    v_and_b32 v20, 1, v19
    v_lshl_add_u32 v18, v20, 5, v18
    v_lshrrev_b32 v19, 1, v19
    v_lshl_add_u32 v18, v19, 4, v18
    s_and_b32 s17, s3, 3
    s_lshl_b32 s18, s30, 2
    s_add_u32 s18, s18, s17
    s_lshl_b32 s18, s18, 16
    s_lshl_b32 s19, s15, 22
    s_add_u32 s18, s18, s19
    s_lshl_b32 s19, s31, 12
    s_add_u32 s18, s18, s19
    s_add_u32 s18, s18, 0x2c00800
    s_add_u32 s19, s18, 32768
    s_waitcnt lgkmcnt(0)
    s_barrier
    ds_read_b128 v[40:43], v17 offset:0
    ds_read_b128 v[44:47], v17 offset:1024
    ds_read_b128 v[48:51], v17 offset:2048
    ds_read_b128 v[52:55], v17 offset:3072
    ds_read_b128 v[56:59], v17 offset:4096
    ds_read_b128 v[60:63], v17 offset:5120
    ds_read_b128 v[64:67], v17 offset:6144
    ds_read_b128 v[68:71], v17 offset:7168
    s_waitcnt lgkmcnt(7)
    v_pk_add_f32 v[120:121], v[120:121], v[40:41]
    v_pk_add_f32 v[122:123], v[122:123], v[42:43]
    v_pk_mul_f32 v[120:121], v[120:121], v[24:25]
    v_pk_mul_f32 v[122:123], v[122:123], v[26:27]
    v_cvt_pk_bf16_f32 v224, v120, v121
    v_cvt_pk_bf16_f32 v225, v122, v123
    s_waitcnt lgkmcnt(5)
    v_pk_add_f32 v[128:129], v[128:129], v[48:49]
    v_pk_add_f32 v[130:131], v[130:131], v[50:51]
    v_pk_mul_f32 v[128:129], v[128:129], v[28:29]
    v_pk_mul_f32 v[130:131], v[130:131], v[30:31]
    v_cvt_pk_bf16_f32 v226, v128, v129
    v_cvt_pk_bf16_f32 v227, v130, v131
    s_nop 0
    v_permlane16_swap_b32 v224, v226
    v_permlane16_swap_b32 v225, v227
    buffer_store_dwordx4 v[224:227], v18, s[8:11], s18 offen offset:0 sc1
    v_pk_add_f32 v[124:125], v[124:125], v[44:45]
    v_pk_add_f32 v[126:127], v[126:127], v[46:47]
    v_pk_mul_f32 v[124:125], v[124:125], v[24:25]
    v_pk_mul_f32 v[126:127], v[126:127], v[26:27]
    v_cvt_pk_bf16_f32 v228, v124, v125
    v_cvt_pk_bf16_f32 v229, v126, v127
    s_waitcnt lgkmcnt(4)
    v_pk_add_f32 v[132:133], v[132:133], v[52:53]
    v_pk_add_f32 v[134:135], v[134:135], v[54:55]
    v_pk_mul_f32 v[132:133], v[132:133], v[28:29]
    v_pk_mul_f32 v[134:135], v[134:135], v[30:31]
    v_cvt_pk_bf16_f32 v230, v132, v133
    v_cvt_pk_bf16_f32 v231, v134, v135
    s_nop 0
    v_permlane16_swap_b32 v228, v230
    v_permlane16_swap_b32 v229, v231
    buffer_store_dwordx4 v[228:231], v18, s[8:11], s19 offen offset:0 sc1
    s_waitcnt lgkmcnt(3)
    v_pk_add_f32 v[136:137], v[136:137], v[56:57]
    v_pk_add_f32 v[138:139], v[138:139], v[58:59]
    v_pk_mul_f32 v[136:137], v[136:137], v[32:33]
    v_pk_mul_f32 v[138:139], v[138:139], v[34:35]
    v_cvt_pk_bf16_f32 v232, v136, v137
    v_cvt_pk_bf16_f32 v233, v138, v139
    s_waitcnt lgkmcnt(1)
    v_pk_add_f32 v[144:145], v[144:145], v[64:65]
    v_pk_add_f32 v[146:147], v[146:147], v[66:67]
    v_pk_mul_f32 v[144:145], v[144:145], v[36:37]
    v_pk_mul_f32 v[146:147], v[146:147], v[38:39]
    v_cvt_pk_bf16_f32 v234, v144, v145
    v_cvt_pk_bf16_f32 v235, v146, v147
    s_nop 0
    v_permlane16_swap_b32 v232, v234
    v_permlane16_swap_b32 v233, v235
    buffer_store_dwordx4 v[232:235], v18, s[8:11], s18 offen offset:1024 sc1
    v_pk_add_f32 v[140:141], v[140:141], v[60:61]
    v_pk_add_f32 v[142:143], v[142:143], v[62:63]
    v_pk_mul_f32 v[140:141], v[140:141], v[32:33]
    v_pk_mul_f32 v[142:143], v[142:143], v[34:35]
    v_cvt_pk_bf16_f32 v236, v140, v141
    v_cvt_pk_bf16_f32 v237, v142, v143
    s_waitcnt lgkmcnt(0)
    v_pk_add_f32 v[148:149], v[148:149], v[68:69]
    v_pk_add_f32 v[150:151], v[150:151], v[70:71]
    v_pk_mul_f32 v[148:149], v[148:149], v[36:37]
    v_pk_mul_f32 v[150:151], v[150:151], v[38:39]
    v_cvt_pk_bf16_f32 v238, v148, v149
    v_cvt_pk_bf16_f32 v239, v150, v151
    s_nop 0
    v_permlane16_swap_b32 v236, v238
    v_permlane16_swap_b32 v237, v239
    buffer_store_dwordx4 v[236:239], v18, s[8:11], s19 offen offset:1024 sc1
    s_mov_b64 s[64:65], s[44:45]
    s_mov_b32 s66, 0x800
    s_mov_b32 s67, 0x20000
    s_mov_b64 s[76:77], s[32:33]
    s_mov_b32 s78, 0x400000
    s_mov_b32 s79, 0x20000
    s_mov_b64 s[68:69], s[56:57]
    s_mov_b32 s70, 0x400000
    s_mov_b32 s71, 0x20000
    s_lshl_b32 s14, s31, 1
    s_add_u32 s14, s14, s15
    s_lshl_b32 s14, s14, 3
    s_add_u32 s14, s14, s3
    s_lshl_b32 s16, s30, 7
    s_add_u32 s14, s14, s16
    s_lshl_b32 s16, s14, 11
    buffer_load_dwordx4 v[216:219], v2, s[76:79], s16 offen offset:0
    buffer_load_dwordx4 v[220:223], v2, s[76:79], s16 offen offset:1024
    s_lshl_b32 s16, s3, 10
    s_add_u32 m0, s16, 81920
    s_add_u32 s17, s16, 0x540800
    s_cmp_lt_u32 s3, 6
    s_cselect_b32 s17, s17, 0x7ffffff0
    s_sub_u32 s23, s16, 6144
    s_cmp_ge_u32 s3, 6
    s_cselect_b32 s23, s23, 0x7ffffff0
    s_cbranch_scc1 adaLN_cond__sliding_block_cached__moe_arch_mod__prompt_kernel_mlw
    buffer_load_dwordx4 v2, s[8:11], s17 offen sc1 lds
    s_branch adaLN_cond__sliding_block_cached__moe_arch_mod__prompt_kernel_mlj
adaLN_cond__sliding_block_cached__moe_arch_mod__prompt_kernel_mlw:
    buffer_load_dwordx4 v2, s[64:67], s23 offen lds
adaLN_cond__sliding_block_cached__moe_arch_mod__prompt_kernel_mlj:
    s_lshl_b32 s16, s30, 5
    s_lshl_b32 s17, s31, 1
    s_add_u32 s16, s16, s17
    s_add_u32 s16, s16, s15
    s_lshl_b32 s16, s16, 2
    s_add_u32 s16, s16, 0x530000
    s_cmp_eq_u32 s3, 0
    s_cselect_b32 s16, s16, 0x7ffffff0
    v_mov_b32 v16, s28
    v_mov_b32 v17, 0
    s_lshr_b32 s18, s14, 4
    s_lshl_b32 s18, s18, 15
    s_and_b32 s19, s14, 15
    s_lshl_b32 s19, s19, 6
    s_add_u32 s18, s18, s19
    s_add_u32 s18, s18, 0x2c00000
    s_add_u32 s19, s18, 16384
    v_lshrrev_b32 v18, 2, v1
    v_lshlrev_b32 v18, 10, v18
    v_and_b32 v19, 3, v1
    v_lshl_add_u32 v18, v19, 4, v18
    v_add_u32 v19, 0x400000, v18
    s_lshl_b32 s25, s30, 7
    s_add_u32 s25, s25, 0x530000
    v_and_b32 v20, 15, v1
    v_lshlrev_b32 v20, 2, v20
    s_waitcnt vmcnt(3)
    s_waitcnt vmcnt(0)
    s_barrier
    s_mov_b64 exec, 1
    buffer_store_dword v16, v17, s[8:11], s16 offen sc1
    s_mov_b64 exec, -1
    v_add_u32 v16, 81920, v2
    ds_read_b128 v[184:187], v16 offset:0
    ds_read_b128 v[188:191], v16 offset:1024
    ds_read_b128 v[192:195], v16 offset:2048
    ds_read_b128 v[196:199], v16 offset:3072
    ds_read_b128 v[200:203], v16 offset:4096
    ds_read_b128 v[204:207], v16 offset:5120
    ds_read_b128 v[208:211], v16 offset:6144
    ds_read_b128 v[212:215], v16 offset:7168
    v_mov_b32 v94, 0
    v_mov_b32 v95, 0
    s_waitcnt lgkmcnt(5)
    v_lshlrev_b32 v76, 16, v192
    v_and_b32 v77, 0xffff0000, v192
    s_waitcnt lgkmcnt(1)
    v_lshlrev_b32 v78, 16, v208
    v_and_b32 v79, 0xffff0000, v208
    v_pk_mul_f32 v[60:61], v[76:77], v[78:79]
    v_lshlrev_b32 v76, 16, v184
    v_and_b32 v77, 0xffff0000, v184
    v_fmac_f32 v94, v76, v78
    v_fmac_f32 v94, v77, v79
    v_add_f32 v95, v95, v60
    v_add_f32 v95, v95, v61
    v_lshlrev_b32 v76, 16, v193
    v_and_b32 v77, 0xffff0000, v193
    v_lshlrev_b32 v78, 16, v209
    v_and_b32 v79, 0xffff0000, v209
    v_pk_mul_f32 v[62:63], v[76:77], v[78:79]
    v_lshlrev_b32 v76, 16, v185
    v_and_b32 v77, 0xffff0000, v185
    v_fmac_f32 v94, v76, v78
    v_fmac_f32 v94, v77, v79
    v_add_f32 v95, v95, v62
    v_add_f32 v95, v95, v63
    v_lshlrev_b32 v76, 16, v194
    v_and_b32 v77, 0xffff0000, v194
    v_lshlrev_b32 v78, 16, v210
    v_and_b32 v79, 0xffff0000, v210
    v_pk_mul_f32 v[64:65], v[76:77], v[78:79]
    v_lshlrev_b32 v76, 16, v186
    v_and_b32 v77, 0xffff0000, v186
    v_fmac_f32 v94, v76, v78
    v_fmac_f32 v94, v77, v79
    v_add_f32 v95, v95, v64
    v_add_f32 v95, v95, v65
    v_lshlrev_b32 v76, 16, v195
    v_and_b32 v77, 0xffff0000, v195
    v_lshlrev_b32 v78, 16, v211
    v_and_b32 v79, 0xffff0000, v211
    v_pk_mul_f32 v[66:67], v[76:77], v[78:79]
    v_lshlrev_b32 v76, 16, v187
    v_and_b32 v77, 0xffff0000, v187
    v_fmac_f32 v94, v76, v78
    v_fmac_f32 v94, v77, v79
    v_add_f32 v95, v95, v66
    v_add_f32 v95, v95, v67
    v_lshlrev_b32 v76, 16, v196
    v_and_b32 v77, 0xffff0000, v196
    s_waitcnt lgkmcnt(0)
    v_lshlrev_b32 v78, 16, v212
    v_and_b32 v79, 0xffff0000, v212
    v_pk_mul_f32 v[68:69], v[76:77], v[78:79]
    v_lshlrev_b32 v76, 16, v188
    v_and_b32 v77, 0xffff0000, v188
    v_fmac_f32 v94, v76, v78
    v_fmac_f32 v94, v77, v79
    v_add_f32 v95, v95, v68
    v_add_f32 v95, v95, v69
    v_lshlrev_b32 v76, 16, v197
    v_and_b32 v77, 0xffff0000, v197
    v_lshlrev_b32 v78, 16, v213
    v_and_b32 v79, 0xffff0000, v213
    v_pk_mul_f32 v[70:71], v[76:77], v[78:79]
    v_lshlrev_b32 v76, 16, v189
    v_and_b32 v77, 0xffff0000, v189
    v_fmac_f32 v94, v76, v78
    v_fmac_f32 v94, v77, v79
    v_add_f32 v95, v95, v70
    v_add_f32 v95, v95, v71
    v_lshlrev_b32 v76, 16, v198
    v_and_b32 v77, 0xffff0000, v198
    v_lshlrev_b32 v78, 16, v214
    v_and_b32 v79, 0xffff0000, v214
    v_pk_mul_f32 v[72:73], v[76:77], v[78:79]
    v_lshlrev_b32 v76, 16, v190
    v_and_b32 v77, 0xffff0000, v190
    v_fmac_f32 v94, v76, v78
    v_fmac_f32 v94, v77, v79
    v_add_f32 v95, v95, v72
    v_add_f32 v95, v95, v73
    v_lshlrev_b32 v76, 16, v199
    v_and_b32 v77, 0xffff0000, v199
    v_lshlrev_b32 v78, 16, v215
    v_and_b32 v79, 0xffff0000, v215
    v_pk_mul_f32 v[74:75], v[76:77], v[78:79]
    v_lshlrev_b32 v76, 16, v191
    v_and_b32 v77, 0xffff0000, v191
    v_fmac_f32 v94, v76, v78
    v_fmac_f32 v94, v77, v79
    v_add_f32 v95, v95, v74
    v_add_f32 v95, v95, v75
    v_add_f32_dpp v94, v94, v94 row_ror:1 row_mask:0xf bank_mask:0xf
    s_nop 0
    v_add_f32_dpp v95, v95, v95 row_ror:1 row_mask:0xf bank_mask:0xf
    v_add_f32_dpp v94, v94, v94 row_ror:2 row_mask:0xf bank_mask:0xf
    s_nop 0
    v_add_f32_dpp v95, v95, v95 row_ror:2 row_mask:0xf bank_mask:0xf
    v_add_f32_dpp v94, v94, v94 row_ror:4 row_mask:0xf bank_mask:0xf
    s_nop 0
    v_add_f32_dpp v95, v95, v95 row_ror:4 row_mask:0xf bank_mask:0xf
    v_add_f32_dpp v94, v94, v94 row_ror:8 row_mask:0xf bank_mask:0xf
    s_nop 0
    v_add_f32_dpp v95, v95, v95 row_ror:8 row_mask:0xf bank_mask:0xf
    v_mov_b32 v76, v94
    s_nop 1
    v_permlane16_swap_b32 v94, v76
    v_add_f32 v94, v94, v76
    v_mov_b32 v77, v95
    s_nop 1
    v_permlane16_swap_b32 v95, v77
    v_add_f32 v95, v95, v77
    v_mov_b32 v76, v94
    s_nop 1
    v_permlane32_swap_b32 v94, v76
    v_add_f32 v94, v94, v76
    v_mov_b32 v77, v95
    s_nop 1
    v_permlane32_swap_b32 v95, v77
    v_add_f32 v95, v95, v77
    v_lshlrev_b32 v28, 16, v216
    v_and_b32 v29, 0xffff0000, v216
    v_lshlrev_b32 v30, 16, v217
    v_and_b32 v31, 0xffff0000, v217
    v_lshlrev_b32 v32, 16, v218
    v_and_b32 v33, 0xffff0000, v218
    v_lshlrev_b32 v34, 16, v219
    v_and_b32 v35, 0xffff0000, v219
    v_lshlrev_b32 v36, 16, v220
    v_and_b32 v37, 0xffff0000, v220
    v_lshlrev_b32 v38, 16, v221
    v_and_b32 v39, 0xffff0000, v221
    v_lshlrev_b32 v40, 16, v222
    v_and_b32 v41, 0xffff0000, v222
    v_lshlrev_b32 v42, 16, v223
    v_and_b32 v43, 0xffff0000, v223
    s_sleep 16
    s_mov_b32 s27, 0
adaLN_cond__sliding_block_cached__moe_arch_mod__prompt_kernel_a22p:
    buffer_load_dword v76, v20, s[8:11], s25 offen sc1
    s_waitcnt vmcnt(0)
    v_cmp_ne_u32 vcc, s28, v76
    s_add_u32 s27, s27, 1
    s_cmp_ge_u32 s27, 65536
    s_cbranch_scc1 adaLN_cond__sliding_block_cached__moe_arch_mod__prompt_kernel_a22g
    s_cbranch_vccnz adaLN_cond__sliding_block_cached__moe_arch_mod__prompt_kernel_a22p
adaLN_cond__sliding_block_cached__moe_arch_mod__prompt_kernel_a22g:
    buffer_load_dwordx4 v[44:47], v18, s[8:11], s18 offen sc1
    buffer_load_dwordx4 v[52:55], v19, s[8:11], s18 offen sc1
    buffer_load_dwordx4 v[48:51], v18, s[8:11], s19 offen sc1
    buffer_load_dwordx4 v[56:59], v19, s[8:11], s19 offen sc1
    v_lshlrev_b32 v21, 2, v0
    s_mov_b32 s16, 0x540800
    buffer_load_dword v106, v21, s[8:11], s16 offen sc1
    buffer_load_dword v104, v21, s[8:11], s16 offen offset:2048 sc1
    s_waitcnt vmcnt(5)
    v_lshlrev_b32 v76, 16, v44
    v_and_b32 v77, 0xffff0000, v44
    s_waitcnt vmcnt(4)
    v_lshlrev_b32 v78, 16, v52
    v_and_b32 v79, 0xffff0000, v52
    v_pk_add_f32 v[76:77], v[76:77], v[78:79]
    v_pk_add_f32 v[28:29], v[28:29], v[76:77]
    v_cvt_pk_bf16_f32 v16, v28, v29
    v_lshlrev_b32 v28, 16, v16
    v_and_b32 v29, 0xffff0000, v16
    v_lshlrev_b32 v80, 16, v45
    v_and_b32 v81, 0xffff0000, v45
    v_lshlrev_b32 v82, 16, v53
    v_and_b32 v83, 0xffff0000, v53
    v_pk_add_f32 v[80:81], v[80:81], v[82:83]
    v_pk_add_f32 v[30:31], v[30:31], v[80:81]
    v_cvt_pk_bf16_f32 v17, v30, v31
    v_lshlrev_b32 v30, 16, v17
    v_and_b32 v31, 0xffff0000, v17
    v_lshlrev_b32 v76, 16, v46
    v_and_b32 v77, 0xffff0000, v46
    v_lshlrev_b32 v78, 16, v54
    v_and_b32 v79, 0xffff0000, v54
    v_pk_add_f32 v[76:77], v[76:77], v[78:79]
    v_pk_add_f32 v[32:33], v[32:33], v[76:77]
    v_cvt_pk_bf16_f32 v16, v32, v33
    v_lshlrev_b32 v32, 16, v16
    v_and_b32 v33, 0xffff0000, v16
    v_lshlrev_b32 v80, 16, v47
    v_and_b32 v81, 0xffff0000, v47
    v_lshlrev_b32 v82, 16, v55
    v_and_b32 v83, 0xffff0000, v55
    v_pk_add_f32 v[80:81], v[80:81], v[82:83]
    v_pk_add_f32 v[34:35], v[34:35], v[80:81]
    v_cvt_pk_bf16_f32 v17, v34, v35
    v_lshlrev_b32 v34, 16, v17
    v_and_b32 v35, 0xffff0000, v17
    s_waitcnt vmcnt(3)
    v_lshlrev_b32 v76, 16, v48
    v_and_b32 v77, 0xffff0000, v48
    s_waitcnt vmcnt(2)
    v_lshlrev_b32 v78, 16, v56
    v_and_b32 v79, 0xffff0000, v56
    v_pk_add_f32 v[76:77], v[76:77], v[78:79]
    v_pk_add_f32 v[36:37], v[36:37], v[76:77]
    v_cvt_pk_bf16_f32 v16, v36, v37
    v_lshlrev_b32 v36, 16, v16
    v_and_b32 v37, 0xffff0000, v16
    v_lshlrev_b32 v80, 16, v49
    v_and_b32 v81, 0xffff0000, v49
    v_lshlrev_b32 v82, 16, v57
    v_and_b32 v83, 0xffff0000, v57
    v_pk_add_f32 v[80:81], v[80:81], v[82:83]
    v_pk_add_f32 v[38:39], v[38:39], v[80:81]
    v_cvt_pk_bf16_f32 v17, v38, v39
    v_lshlrev_b32 v38, 16, v17
    v_and_b32 v39, 0xffff0000, v17
    v_lshlrev_b32 v76, 16, v50
    v_and_b32 v77, 0xffff0000, v50
    v_lshlrev_b32 v78, 16, v58
    v_and_b32 v79, 0xffff0000, v58
    v_pk_add_f32 v[76:77], v[76:77], v[78:79]
    v_pk_add_f32 v[40:41], v[40:41], v[76:77]
    v_cvt_pk_bf16_f32 v16, v40, v41
    v_lshlrev_b32 v40, 16, v16
    v_and_b32 v41, 0xffff0000, v16
    v_lshlrev_b32 v80, 16, v51
    v_and_b32 v81, 0xffff0000, v51
    v_lshlrev_b32 v82, 16, v59
    v_and_b32 v83, 0xffff0000, v59
    v_pk_add_f32 v[80:81], v[80:81], v[82:83]
    v_pk_add_f32 v[42:43], v[42:43], v[80:81]
    v_cvt_pk_bf16_f32 v17, v42, v43
    v_lshlrev_b32 v42, 16, v17
    v_and_b32 v43, 0xffff0000, v17
    v_pk_add_f32 v[76:77], v[28:29], v[30:31]
    v_pk_mul_f32 v[78:79], v[28:29], v[28:29]
    v_pk_mul_f32 v[80:81], v[28:29], v[60:61]
    v_pk_fma_f32 v[78:79], v[30:31], v[30:31], v[78:79]
    v_pk_fma_f32 v[80:81], v[30:31], v[62:63], v[80:81]
    v_pk_add_f32 v[76:77], v[76:77], v[32:33]
    v_pk_fma_f32 v[78:79], v[32:33], v[32:33], v[78:79]
    v_pk_fma_f32 v[80:81], v[32:33], v[64:65], v[80:81]
    v_pk_add_f32 v[76:77], v[76:77], v[34:35]
    v_pk_fma_f32 v[78:79], v[34:35], v[34:35], v[78:79]
    v_pk_fma_f32 v[80:81], v[34:35], v[66:67], v[80:81]
    v_pk_add_f32 v[76:77], v[76:77], v[36:37]
    v_pk_fma_f32 v[78:79], v[36:37], v[36:37], v[78:79]
    v_pk_fma_f32 v[80:81], v[36:37], v[68:69], v[80:81]
    v_pk_add_f32 v[76:77], v[76:77], v[38:39]
    v_pk_fma_f32 v[78:79], v[38:39], v[38:39], v[78:79]
    v_pk_fma_f32 v[80:81], v[38:39], v[70:71], v[80:81]
    v_pk_add_f32 v[76:77], v[76:77], v[40:41]
    v_pk_fma_f32 v[78:79], v[40:41], v[40:41], v[78:79]
    v_pk_fma_f32 v[80:81], v[40:41], v[72:73], v[80:81]
    v_pk_add_f32 v[76:77], v[76:77], v[42:43]
    v_pk_fma_f32 v[78:79], v[42:43], v[42:43], v[78:79]
    v_pk_fma_f32 v[80:81], v[42:43], v[74:75], v[80:81]
    v_add_f32 v96, v76, v77
    v_add_f32 v97, v78, v79
    v_add_f32 v98, v80, v81
    v_add_f32_dpp v96, v96, v96 row_ror:1 row_mask:0xf bank_mask:0xf
    v_add_f32_dpp v97, v97, v97 row_ror:1 row_mask:0xf bank_mask:0xf
    v_add_f32_dpp v98, v98, v98 row_ror:1 row_mask:0xf bank_mask:0xf
    v_add_f32_dpp v96, v96, v96 row_ror:2 row_mask:0xf bank_mask:0xf
    v_add_f32_dpp v97, v97, v97 row_ror:2 row_mask:0xf bank_mask:0xf
    v_add_f32_dpp v98, v98, v98 row_ror:2 row_mask:0xf bank_mask:0xf
    v_add_f32_dpp v96, v96, v96 row_ror:4 row_mask:0xf bank_mask:0xf
    v_add_f32_dpp v97, v97, v97 row_ror:4 row_mask:0xf bank_mask:0xf
    v_add_f32_dpp v98, v98, v98 row_ror:4 row_mask:0xf bank_mask:0xf
    v_add_f32_dpp v96, v96, v96 row_ror:8 row_mask:0xf bank_mask:0xf
    v_add_f32_dpp v97, v97, v97 row_ror:8 row_mask:0xf bank_mask:0xf
    v_add_f32_dpp v98, v98, v98 row_ror:8 row_mask:0xf bank_mask:0xf
    v_mov_b32 v76, v96
    s_nop 1
    v_permlane16_swap_b32 v96, v76
    v_add_f32 v96, v96, v76
    v_mov_b32 v77, v97
    s_nop 1
    v_permlane16_swap_b32 v97, v77
    v_add_f32 v97, v97, v77
    v_mov_b32 v78, v98
    s_nop 1
    v_permlane16_swap_b32 v98, v78
    v_add_f32 v98, v98, v78
    v_mov_b32 v76, v96
    s_nop 1
    v_permlane32_swap_b32 v96, v76
    v_add_f32 v96, v96, v76
    v_mov_b32 v77, v97
    s_nop 1
    v_permlane32_swap_b32 v97, v77
    v_add_f32 v97, v97, v77
    v_mov_b32 v78, v98
    s_nop 1
    v_permlane32_swap_b32 v98, v78
    v_add_f32 v98, v98, v78
    v_mul_f32 v96, 0x3a800000, v96
    v_mul_f32 v97, 0x3a800000, v97
    v_fma_f32 v97, -v96, v96, v97
    v_max_f32 v97, 0, v97
    v_fma_f32 v98, -v96, v95, v98
    v_add_f32 v76, 0x3727c5ac, v97
    v_rsq_f32 v76, v76
    s_nop 0
    v_fma_f32 v27, v98, v76, v94
    v_cvt_pk_bf16_f32 v96, v96, v96
    v_lshlrev_b32 v96, 16, v96
    v_cvt_pk_bf16_f32 v97, v97, v97
    v_lshlrev_b32 v97, 16, v97
    v_add_f32 v97, 0x3727c5ac, v97
    v_cvt_pk_bf16_f32 v97, v97, v97
    v_lshlrev_b32 v97, 16, v97
    v_sqrt_f32 v98, v97
    s_nop 0
    v_cvt_pk_bf16_f32 v98, v98, v98
    v_lshlrev_b32 v98, 16, v98
    v_rcp_f32 v99, v98
    v_mov_b32 v25, v96
    v_mov_b32 v26, v98
    v_ashrrev_i32 v16, 31, v27
    v_or_b32 v16, 0x80000000, v16
    v_xor_b32 v24, v27, v16
    v_and_b32 v24, 0xfffff800, v24
    v_max_u32 v24, 0x800, v24
    s_sub_u32 s16, 2047, s14
    v_or_b32 v24, s16, v24
    s_lshl_b32 s16, s3, 4
    s_add_u32 s16, s16, 65536
    v_mov_b32 v16, s16
    ds_write_b128 v16, v[24:27]
    s_waitcnt lgkmcnt(0)
    s_barrier
    v_and_b32 v16, 7, v1
    v_lshlrev_b32 v16, 4, v16
    v_add_u32 v16, 65536, v16
    ds_read_b32 v76, v16
    s_waitcnt lgkmcnt(0)
    v_mov_b32 v77, v76
    s_nop 1
    v_max_u32_dpp v77, v77, v77 row_ror:1 row_mask:0xf bank_mask:0xf
    s_nop 1
    v_max_u32_dpp v77, v77, v77 row_ror:2 row_mask:0xf bank_mask:0xf
    s_nop 1
    v_max_u32_dpp v77, v77, v77 row_ror:4 row_mask:0xf bank_mask:0xf
    v_cmp_eq_u32 vcc, v76, v77
    s_ff1_i32_b64 s16, vcc
    s_lshl_b32 s16, s16, 4
    s_add_u32 s16, s16, 65536
    v_mov_b32 v16, s16
    ds_read_b128 v[24:27], v16
    s_lshl_b32 s16, s2, 4
    s_add_u32 s16, s16, 0x6e0000
    s_cmp_eq_u32 s3, 0
    s_cselect_b32 s16, s16, 0x7ffffff0
    v_mov_b32 v17, 0
    s_mov_b64 exec, 1
    s_waitcnt lgkmcnt(0)
    buffer_store_dwordx4 v[24:27], v17, s[8:11], s16 offen sc1
    s_mov_b64 exec, -1
    s_mov_b64 s[72:73], s[50:51]
    s_mov_b32 s74, 0x700000
    s_mov_b32 s75, 0x20000
    s_cmp_lt_u32 s2, 224
    s_cselect_b32 s74, 7340032, 0
    s_lshl_b32 s17, s29, 4
    s_sub_u32 s16, s3, 4
    s_lshl_b32 s16, s16, 2
    s_add_u32 s16, s16, s17
    s_lshl_b32 s16, s16, 11
    s_add_u32 s17, s16, 0
    buffer_load_dwordx4 v[152:155], v2, s[72:75], s17 offen offset:0
    buffer_load_dwordx4 v[156:159], v2, s[72:75], s17 offen offset:1024
    s_add_u32 s17, s16, 2048
    buffer_load_dwordx4 v[160:163], v2, s[72:75], s17 offen offset:0
    buffer_load_dwordx4 v[164:167], v2, s[72:75], s17 offen offset:1024
    s_add_u32 s17, s16, 4096
    buffer_load_dwordx4 v[168:171], v2, s[72:75], s17 offen offset:0
    buffer_load_dwordx4 v[172:175], v2, s[72:75], s17 offen offset:1024
    s_add_u32 s17, s16, 6144
    buffer_load_dwordx4 v[176:179], v2, s[72:75], s17 offen offset:0
    buffer_load_dwordx4 v[180:183], v2, s[72:75], s17 offen offset:1024
    v_sub_f32 v44, v28, v96
    v_sub_f32 v45, v29, v96
    v_sub_f32 v46, v30, v96
    v_sub_f32 v47, v31, v96
    v_sub_f32 v48, v32, v96
    v_sub_f32 v49, v33, v96
    v_sub_f32 v50, v34, v96
    v_sub_f32 v51, v35, v96
    v_cvt_pk_bf16_f32 v16, v44, v45
    v_lshlrev_b32 v44, 16, v16
    v_and_b32 v45, 0xffff0000, v16
    v_cvt_pk_bf16_f32 v16, v46, v47
    v_lshlrev_b32 v46, 16, v16
    v_and_b32 v47, 0xffff0000, v16
    v_cvt_pk_bf16_f32 v16, v48, v49
    v_lshlrev_b32 v48, 16, v16
    v_and_b32 v49, 0xffff0000, v16
    v_cvt_pk_bf16_f32 v16, v50, v51
    v_lshlrev_b32 v50, 16, v16
    v_and_b32 v51, 0xffff0000, v16
    v_mul_f32 v52, v44, v99
    v_mul_f32 v53, v45, v99
    v_mul_f32 v54, v46, v99
    v_mul_f32 v55, v47, v99
    v_mul_f32 v56, v48, v99
    v_mul_f32 v57, v49, v99
    v_mul_f32 v58, v50, v99
    v_mul_f32 v59, v51, v99
    v_fma_f32 v44, -v52, v98, v44
    v_fma_f32 v45, -v53, v98, v45
    v_fma_f32 v46, -v54, v98, v46
    v_fma_f32 v47, -v55, v98, v47
    v_fma_f32 v48, -v56, v98, v48
    v_fma_f32 v49, -v57, v98, v49
    v_fma_f32 v50, -v58, v98, v50
    v_fma_f32 v51, -v59, v98, v51
    v_fma_f32 v44, v44, v99, v52
    v_fma_f32 v45, v45, v99, v53
    v_fma_f32 v46, v46, v99, v54
    v_fma_f32 v47, v47, v99, v55
    v_fma_f32 v48, v48, v99, v56
    v_fma_f32 v49, v49, v99, v57
    v_fma_f32 v50, v50, v99, v58
    v_fma_f32 v51, v51, v99, v59
    v_cvt_pk_bf16_f32 v16, v44, v45
    v_lshlrev_b32 v44, 16, v16
    v_and_b32 v45, 0xffff0000, v16
    v_cvt_pk_bf16_f32 v16, v46, v47
    v_lshlrev_b32 v46, 16, v16
    v_and_b32 v47, 0xffff0000, v16
    v_cvt_pk_bf16_f32 v16, v48, v49
    v_lshlrev_b32 v48, 16, v16
    v_and_b32 v49, 0xffff0000, v16
    v_cvt_pk_bf16_f32 v16, v50, v51
    v_lshlrev_b32 v50, 16, v16
    v_and_b32 v51, 0xffff0000, v16
    v_lshlrev_b32 v52, 16, v192
    v_and_b32 v53, 0xffff0000, v192
    v_lshlrev_b32 v54, 16, v193
    v_and_b32 v55, 0xffff0000, v193
    v_lshlrev_b32 v56, 16, v194
    v_and_b32 v57, 0xffff0000, v194
    v_lshlrev_b32 v58, 16, v195
    v_and_b32 v59, 0xffff0000, v195
    v_pk_mul_f32 v[44:45], v[44:45], v[52:53]
    v_pk_mul_f32 v[46:47], v[46:47], v[54:55]
    v_pk_mul_f32 v[48:49], v[48:49], v[56:57]
    v_pk_mul_f32 v[50:51], v[50:51], v[58:59]
    v_cvt_pk_bf16_f32 v16, v44, v45
    v_lshlrev_b32 v44, 16, v16
    v_and_b32 v45, 0xffff0000, v16
    v_cvt_pk_bf16_f32 v16, v46, v47
    v_lshlrev_b32 v46, 16, v16
    v_and_b32 v47, 0xffff0000, v16
    v_cvt_pk_bf16_f32 v16, v48, v49
    v_lshlrev_b32 v48, 16, v16
    v_and_b32 v49, 0xffff0000, v16
    v_cvt_pk_bf16_f32 v16, v50, v51
    v_lshlrev_b32 v50, 16, v16
    v_and_b32 v51, 0xffff0000, v16
    v_lshlrev_b32 v52, 16, v184
    v_and_b32 v53, 0xffff0000, v184
    v_lshlrev_b32 v54, 16, v185
    v_and_b32 v55, 0xffff0000, v185
    v_lshlrev_b32 v56, 16, v186
    v_and_b32 v57, 0xffff0000, v186
    v_lshlrev_b32 v58, 16, v187
    v_and_b32 v59, 0xffff0000, v187
    v_pk_add_f32 v[44:45], v[44:45], v[52:53]
    v_pk_add_f32 v[46:47], v[46:47], v[54:55]
    v_pk_add_f32 v[48:49], v[48:49], v[56:57]
    v_pk_add_f32 v[50:51], v[50:51], v[58:59]
    v_cvt_pk_bf16_f32 v16, v44, v45
    v_lshlrev_b32 v44, 16, v16
    v_and_b32 v45, 0xffff0000, v16
    v_cvt_pk_bf16_f32 v16, v46, v47
    v_lshlrev_b32 v46, 16, v16
    v_and_b32 v47, 0xffff0000, v16
    v_cvt_pk_bf16_f32 v16, v48, v49
    v_lshlrev_b32 v48, 16, v16
    v_and_b32 v49, 0xffff0000, v16
    v_cvt_pk_bf16_f32 v16, v50, v51
    v_lshlrev_b32 v50, 16, v16
    v_and_b32 v51, 0xffff0000, v16
    v_lshlrev_b32 v52, 16, v200
    v_and_b32 v53, 0xffff0000, v200
    v_lshlrev_b32 v54, 16, v201
    v_and_b32 v55, 0xffff0000, v201
    v_lshlrev_b32 v56, 16, v202
    v_and_b32 v57, 0xffff0000, v202
    v_lshlrev_b32 v58, 16, v203
    v_and_b32 v59, 0xffff0000, v203
    v_pk_mul_f32 v[44:45], v[44:45], v[52:53]
    v_pk_mul_f32 v[46:47], v[46:47], v[54:55]
    v_pk_mul_f32 v[48:49], v[48:49], v[56:57]
    v_pk_mul_f32 v[50:51], v[50:51], v[58:59]
    v_cvt_pk_bf16_f32 v16, v44, v45
    v_lshlrev_b32 v44, 16, v16
    v_and_b32 v45, 0xffff0000, v16
    v_cvt_pk_bf16_f32 v16, v46, v47
    v_lshlrev_b32 v46, 16, v16
    v_and_b32 v47, 0xffff0000, v16
    v_cvt_pk_bf16_f32 v16, v48, v49
    v_lshlrev_b32 v48, 16, v16
    v_and_b32 v49, 0xffff0000, v16
    v_cvt_pk_bf16_f32 v16, v50, v51
    v_lshlrev_b32 v50, 16, v16
    v_and_b32 v51, 0xffff0000, v16
    v_pk_add_f32 v[44:45], v[44:45], v[28:29]
    v_pk_add_f32 v[46:47], v[46:47], v[30:31]
    v_pk_add_f32 v[48:49], v[48:49], v[32:33]
    v_pk_add_f32 v[50:51], v[50:51], v[34:35]
    v_cvt_pk_bf16_f32 v28, v44, v45
    v_cvt_pk_bf16_f32 v29, v46, v47
    v_cvt_pk_bf16_f32 v30, v48, v49
    v_cvt_pk_bf16_f32 v31, v50, v51
    v_sub_f32 v44, v36, v96
    v_sub_f32 v45, v37, v96
    v_sub_f32 v46, v38, v96
    v_sub_f32 v47, v39, v96
    v_sub_f32 v48, v40, v96
    v_sub_f32 v49, v41, v96
    v_sub_f32 v50, v42, v96
    v_sub_f32 v51, v43, v96
    v_cvt_pk_bf16_f32 v16, v44, v45
    v_lshlrev_b32 v44, 16, v16
    v_and_b32 v45, 0xffff0000, v16
    v_cvt_pk_bf16_f32 v16, v46, v47
    v_lshlrev_b32 v46, 16, v16
    v_and_b32 v47, 0xffff0000, v16
    v_cvt_pk_bf16_f32 v16, v48, v49
    v_lshlrev_b32 v48, 16, v16
    v_and_b32 v49, 0xffff0000, v16
    v_cvt_pk_bf16_f32 v16, v50, v51
    v_lshlrev_b32 v50, 16, v16
    v_and_b32 v51, 0xffff0000, v16
    v_mul_f32 v52, v44, v99
    v_mul_f32 v53, v45, v99
    v_mul_f32 v54, v46, v99
    v_mul_f32 v55, v47, v99
    v_mul_f32 v56, v48, v99
    v_mul_f32 v57, v49, v99
    v_mul_f32 v58, v50, v99
    v_mul_f32 v59, v51, v99
    v_fma_f32 v44, -v52, v98, v44
    v_fma_f32 v45, -v53, v98, v45
    v_fma_f32 v46, -v54, v98, v46
    v_fma_f32 v47, -v55, v98, v47
    v_fma_f32 v48, -v56, v98, v48
    v_fma_f32 v49, -v57, v98, v49
    v_fma_f32 v50, -v58, v98, v50
    v_fma_f32 v51, -v59, v98, v51
    v_fma_f32 v44, v44, v99, v52
    v_fma_f32 v45, v45, v99, v53
    v_fma_f32 v46, v46, v99, v54
    v_fma_f32 v47, v47, v99, v55
    v_fma_f32 v48, v48, v99, v56
    v_fma_f32 v49, v49, v99, v57
    v_fma_f32 v50, v50, v99, v58
    v_fma_f32 v51, v51, v99, v59
    v_cvt_pk_bf16_f32 v16, v44, v45
    v_lshlrev_b32 v44, 16, v16
    v_and_b32 v45, 0xffff0000, v16
    v_cvt_pk_bf16_f32 v16, v46, v47
    v_lshlrev_b32 v46, 16, v16
    v_and_b32 v47, 0xffff0000, v16
    v_cvt_pk_bf16_f32 v16, v48, v49
    v_lshlrev_b32 v48, 16, v16
    v_and_b32 v49, 0xffff0000, v16
    v_cvt_pk_bf16_f32 v16, v50, v51
    v_lshlrev_b32 v50, 16, v16
    v_and_b32 v51, 0xffff0000, v16
    v_lshlrev_b32 v52, 16, v196
    v_and_b32 v53, 0xffff0000, v196
    v_lshlrev_b32 v54, 16, v197
    v_and_b32 v55, 0xffff0000, v197
    v_lshlrev_b32 v56, 16, v198
    v_and_b32 v57, 0xffff0000, v198
    v_lshlrev_b32 v58, 16, v199
    v_and_b32 v59, 0xffff0000, v199
    v_pk_mul_f32 v[44:45], v[44:45], v[52:53]
    v_pk_mul_f32 v[46:47], v[46:47], v[54:55]
    v_pk_mul_f32 v[48:49], v[48:49], v[56:57]
    v_pk_mul_f32 v[50:51], v[50:51], v[58:59]
    v_cvt_pk_bf16_f32 v16, v44, v45
    v_lshlrev_b32 v44, 16, v16
    v_and_b32 v45, 0xffff0000, v16
    v_cvt_pk_bf16_f32 v16, v46, v47
    v_lshlrev_b32 v46, 16, v16
    v_and_b32 v47, 0xffff0000, v16
    v_cvt_pk_bf16_f32 v16, v48, v49
    v_lshlrev_b32 v48, 16, v16
    v_and_b32 v49, 0xffff0000, v16
    v_cvt_pk_bf16_f32 v16, v50, v51
    v_lshlrev_b32 v50, 16, v16
    v_and_b32 v51, 0xffff0000, v16
    v_lshlrev_b32 v52, 16, v188
    v_and_b32 v53, 0xffff0000, v188
    v_lshlrev_b32 v54, 16, v189
    v_and_b32 v55, 0xffff0000, v189
    v_lshlrev_b32 v56, 16, v190
    v_and_b32 v57, 0xffff0000, v190
    v_lshlrev_b32 v58, 16, v191
    v_and_b32 v59, 0xffff0000, v191
    v_pk_add_f32 v[44:45], v[44:45], v[52:53]
    v_pk_add_f32 v[46:47], v[46:47], v[54:55]
    v_pk_add_f32 v[48:49], v[48:49], v[56:57]
    v_pk_add_f32 v[50:51], v[50:51], v[58:59]
    v_cvt_pk_bf16_f32 v16, v44, v45
    v_lshlrev_b32 v44, 16, v16
    v_and_b32 v45, 0xffff0000, v16
    v_cvt_pk_bf16_f32 v16, v46, v47
    v_lshlrev_b32 v46, 16, v16
    v_and_b32 v47, 0xffff0000, v16
    v_cvt_pk_bf16_f32 v16, v48, v49
    v_lshlrev_b32 v48, 16, v16
    v_and_b32 v49, 0xffff0000, v16
    v_cvt_pk_bf16_f32 v16, v50, v51
    v_lshlrev_b32 v50, 16, v16
    v_and_b32 v51, 0xffff0000, v16
    v_lshlrev_b32 v52, 16, v204
    v_and_b32 v53, 0xffff0000, v204
    v_lshlrev_b32 v54, 16, v205
    v_and_b32 v55, 0xffff0000, v205
    v_lshlrev_b32 v56, 16, v206
    v_and_b32 v57, 0xffff0000, v206
    v_lshlrev_b32 v58, 16, v207
    v_and_b32 v59, 0xffff0000, v207
    v_pk_mul_f32 v[44:45], v[44:45], v[52:53]
    v_pk_mul_f32 v[46:47], v[46:47], v[54:55]
    v_pk_mul_f32 v[48:49], v[48:49], v[56:57]
    v_pk_mul_f32 v[50:51], v[50:51], v[58:59]
    v_cvt_pk_bf16_f32 v16, v44, v45
    v_lshlrev_b32 v44, 16, v16
    v_and_b32 v45, 0xffff0000, v16
    v_cvt_pk_bf16_f32 v16, v46, v47
    v_lshlrev_b32 v46, 16, v16
    v_and_b32 v47, 0xffff0000, v16
    v_cvt_pk_bf16_f32 v16, v48, v49
    v_lshlrev_b32 v48, 16, v16
    v_and_b32 v49, 0xffff0000, v16
    v_cvt_pk_bf16_f32 v16, v50, v51
    v_lshlrev_b32 v50, 16, v16
    v_and_b32 v51, 0xffff0000, v16
    v_pk_add_f32 v[44:45], v[44:45], v[36:37]
    v_pk_add_f32 v[46:47], v[46:47], v[38:39]
    v_pk_add_f32 v[48:49], v[48:49], v[40:41]
    v_pk_add_f32 v[50:51], v[50:51], v[42:43]
    v_cvt_pk_bf16_f32 v36, v44, v45
    v_cvt_pk_bf16_f32 v37, v46, v47
    v_cvt_pk_bf16_f32 v38, v48, v49
    v_cvt_pk_bf16_f32 v39, v50, v51
    s_barrier
    v_and_b32 v16, 3, v1
    v_lshlrev_b32 v16, 4, v16
    v_add_u32 v16, 65792, v16
    ds_read_b32 v76, v16
    s_waitcnt lgkmcnt(0)
    v_mov_b32 v77, v76
    s_nop 1
    v_max_u32_dpp v77, v77, v77 row_ror:1 row_mask:0xf bank_mask:0xf
    s_nop 1
    v_max_u32_dpp v77, v77, v77 row_ror:2 row_mask:0xf bank_mask:0xf
    v_cmp_eq_u32 vcc, v76, v77
    s_ff1_i32_b64 s16, vcc
    s_lshl_b32 s16, s16, 4
    s_add_u32 s16, s16, 65792
    v_mov_b32 v16, s16
    ds_read_b128 v[24:27], v16
    s_waitcnt lgkmcnt(0)
    v_and_b32 v76, 0x7ff, v24
    v_sub_u32 v76, 2047, v76
    s_nop 0
    v_readfirstlane_b32 s12, v76
    v_rcp_f32 v103, v26
    s_lshr_b32 s18, s12, 4
    s_lshl_b32 s18, s18, 15
    s_and_b32 s19, s12, 15
    s_lshl_b32 s19, s19, 6
    s_add_u32 s18, s18, s19
    s_add_u32 s18, s18, 0x2c00000
    s_add_u32 s19, s18, 0x400000
    v_lshrrev_b32 v18, 4, v0
    v_lshlrev_b32 v18, 10, v18
    v_and_b32 v19, 15, v0
    v_lshl_add_u32 v18, v19, 2, v18
    s_lshl_b32 s13, s12, 11
    buffer_load_dword v100, v18, s[8:11], s18 offen sc1
    buffer_load_dword v101, v18, s[8:11], s19 offen sc1
    buffer_load_dword v102, v21, s[76:79], s13 offen
    s_lshl_b32 s16, s14, 11
    s_cmp_lg_u32 s12, s14
    s_cselect_b32 s16, s16, 0x7ffffff0
    buffer_store_dwordx4 v[28:31], v2, s[68:71], s16 offen offset:0 sc1
    buffer_store_dwordx4 v[36:39], v2, s[68:71], s16 offen offset:1024 sc1
    s_lshl_b32 s16, s3, 13
    v_add_u32 v20, s16, v2
    s_waitcnt vmcnt(4)
    v_lshlrev_b32 v76, 16, v100
    v_and_b32 v77, 0xffff0000, v100
    s_waitcnt vmcnt(3)
    v_lshlrev_b32 v78, 16, v101
    v_and_b32 v79, 0xffff0000, v101
    v_pk_add_f32 v[76:77], v[76:77], v[78:79]
    s_waitcnt vmcnt(2)
    v_lshlrev_b32 v78, 16, v102
    v_and_b32 v79, 0xffff0000, v102
    v_pk_add_f32 v[92:93], v[78:79], v[76:77]
    v_cvt_pk_bf16_f32 v76, v92, v93
    v_lshlrev_b32 v92, 16, v76
    v_and_b32 v93, 0xffff0000, v76
    v_cvt_pk_bf16_f32 v100, v92, v93
    v_and_b32 v105, 0xffff0000, v104
    v_lshlrev_b32 v104, 16, v104
    v_and_b32 v107, 0xffff0000, v106
    v_lshlrev_b32 v106, 16, v106
    v_sub_f32 v92, v92, v25
    v_sub_f32 v93, v93, v25
    v_cvt_pk_bf16_f32 v76, v92, v93
    v_lshlrev_b32 v92, 16, v76
    v_and_b32 v93, 0xffff0000, v76
    v_mul_f32 v77, v92, v103
    v_fma_f32 v92, -v77, v26, v92
    v_fma_f32 v92, v92, v103, v77
    v_mul_f32 v77, v93, v103
    v_fma_f32 v93, -v77, v26, v93
    v_fma_f32 v93, v93, v103, v77
    v_cvt_pk_bf16_f32 v76, v92, v93
    v_lshlrev_b32 v92, 16, v76
    v_and_b32 v93, 0xffff0000, v76
    v_mul_f32 v92, v92, v104
    v_mul_f32 v93, v93, v105
    v_cvt_pk_bf16_f32 v76, v92, v93
    v_lshlrev_b32 v92, 16, v76
    v_and_b32 v93, 0xffff0000, v76
    v_add_f32 v92, v92, v106
    v_add_f32 v93, v93, v107
    v_cvt_pk_bf16_f32 v101, v92, v93
    v_add_u32 v16, 66560, v21
    ds_write_b32 v16, v101
    ds_write_b32 v16, v100 offset:2048
    s_waitcnt lgkmcnt(0)
    s_barrier
    ds_read_b128 v[60:63], v20 offset:0
    ds_read_b128 v[64:67], v20 offset:1024
    ds_read_b128 v[68:71], v20 offset:2048
    ds_read_b128 v[72:75], v20 offset:3072
    ds_read_b128 v[108:111], v20 offset:4096
    ds_read_b128 v[112:115], v20 offset:5120
    ds_read_b128 v[116:119], v20 offset:6144
    ds_read_b128 v[120:123], v20 offset:7168
    s_and_b32 s16, s3, 3
    s_lshl_b32 s16, s16, 7
    s_and_b32 s17, s29, 3
    s_lshl_b32 s17, s17, 9
    s_add_u32 s16, s16, s17
    s_add_u32 s16, s16, 66560
    v_lshrrev_b32 v16, 3, v1
    v_lshlrev_b32 v16, 4, v16
    v_add_u32 v16, s16, v16
    ds_read_b128 v[104:107], v16
    s_waitcnt lgkmcnt(0)
    v_lshlrev_b32 v76, 16, v104
    v_and_b32 v77, 0xffff, v104
    v_dot2_f32_bf16 v85, v60, v76, 0
    v_dot2_f32_bf16 v84, v60, v77, 0
    v_dot2_f32_bf16 v87, v61, v76, 0
    v_dot2_f32_bf16 v86, v61, v77, 0
    v_dot2_f32_bf16 v89, v62, v76, 0
    v_dot2_f32_bf16 v88, v62, v77, 0
    v_dot2_f32_bf16 v91, v63, v76, 0
    v_dot2_f32_bf16 v90, v63, v77, 0
    v_and_b32 v78, 0xffff0000, v104
    v_lshrrev_b32 v79, 16, v104
    v_dot2c_f32_bf16 v85, v64, v78
    v_dot2c_f32_bf16 v84, v64, v79
    v_dot2c_f32_bf16 v87, v65, v78
    v_dot2c_f32_bf16 v86, v65, v79
    v_dot2c_f32_bf16 v89, v66, v78
    v_dot2c_f32_bf16 v88, v66, v79
    v_dot2c_f32_bf16 v91, v67, v78
    v_dot2c_f32_bf16 v90, v67, v79
    v_lshlrev_b32 v80, 16, v105
    v_and_b32 v81, 0xffff, v105
    v_dot2c_f32_bf16 v85, v68, v80
    v_dot2c_f32_bf16 v84, v68, v81
    v_dot2c_f32_bf16 v87, v69, v80
    v_dot2c_f32_bf16 v86, v69, v81
    v_dot2c_f32_bf16 v89, v70, v80
    v_dot2c_f32_bf16 v88, v70, v81
    v_dot2c_f32_bf16 v91, v71, v80
    v_dot2c_f32_bf16 v90, v71, v81
    v_and_b32 v82, 0xffff0000, v105
    v_lshrrev_b32 v83, 16, v105
    v_dot2c_f32_bf16 v85, v72, v82
    v_dot2c_f32_bf16 v84, v72, v83
    v_dot2c_f32_bf16 v87, v73, v82
    v_dot2c_f32_bf16 v86, v73, v83
    v_dot2c_f32_bf16 v89, v74, v82
    v_dot2c_f32_bf16 v88, v74, v83
    v_dot2c_f32_bf16 v91, v75, v82
    v_dot2c_f32_bf16 v90, v75, v83
    v_lshlrev_b32 v76, 16, v106
    v_and_b32 v77, 0xffff, v106
    v_dot2c_f32_bf16 v85, v108, v76
    v_dot2c_f32_bf16 v84, v108, v77
    v_dot2c_f32_bf16 v87, v109, v76
    v_dot2c_f32_bf16 v86, v109, v77
    v_dot2c_f32_bf16 v89, v110, v76
    v_dot2c_f32_bf16 v88, v110, v77
    v_dot2c_f32_bf16 v91, v111, v76
    v_dot2c_f32_bf16 v90, v111, v77
    v_and_b32 v78, 0xffff0000, v106
    v_lshrrev_b32 v79, 16, v106
    v_dot2c_f32_bf16 v85, v112, v78
    v_dot2c_f32_bf16 v84, v112, v79
    v_dot2c_f32_bf16 v87, v113, v78
    v_dot2c_f32_bf16 v86, v113, v79
    v_dot2c_f32_bf16 v89, v114, v78
    v_dot2c_f32_bf16 v88, v114, v79
    v_dot2c_f32_bf16 v91, v115, v78
    v_dot2c_f32_bf16 v90, v115, v79
    v_lshlrev_b32 v80, 16, v107
    v_and_b32 v81, 0xffff, v107
    v_dot2c_f32_bf16 v85, v116, v80
    v_dot2c_f32_bf16 v84, v116, v81
    v_dot2c_f32_bf16 v87, v117, v80
    v_dot2c_f32_bf16 v86, v117, v81
    v_dot2c_f32_bf16 v89, v118, v80
    v_dot2c_f32_bf16 v88, v118, v81
    v_dot2c_f32_bf16 v91, v119, v80
    v_dot2c_f32_bf16 v90, v119, v81
    v_and_b32 v82, 0xffff0000, v107
    v_lshrrev_b32 v83, 16, v107
    v_dot2c_f32_bf16 v85, v120, v82
    v_dot2c_f32_bf16 v84, v120, v83
    v_dot2c_f32_bf16 v87, v121, v82
    v_dot2c_f32_bf16 v86, v121, v83
    v_dot2c_f32_bf16 v89, v122, v82
    v_dot2c_f32_bf16 v88, v122, v83
    v_dot2c_f32_bf16 v91, v123, v82
    v_dot2c_f32_bf16 v90, v123, v83
    s_nop 0
    v_permlane32_swap_b32 v84, v88
    v_permlane32_swap_b32 v85, v89
    v_permlane32_swap_b32 v86, v90
    v_permlane32_swap_b32 v87, v91
    v_add_f32 v84, v84, v88
    v_add_f32 v85, v85, v89
    v_add_f32 v86, v86, v90
    v_add_f32 v87, v87, v91
    s_nop 0
    v_permlane16_swap_b32 v84, v86
    v_permlane16_swap_b32 v85, v87
    v_add_f32 v84, v84, v86
    v_add_f32 v85, v85, v87
    s_nop 0
    v_add_f32_dpp v84, v84, v84 row_ror:8 row_mask:0xf bank_mask:0xf
    v_add_f32_dpp v85, v85, v85 row_ror:8 row_mask:0xf bank_mask:0xf
    v_and_b32 v16, 7, v1
    v_lshlrev_b32 v16, 5, v16
    v_lshrrev_b32 v17, 4, v1
    v_lshl_add_u32 v16, v17, 3, v16
    s_lshl_b32 s16, s3, 8
    s_add_u32 s16, s16, 70656
    v_add_u32 v16, s16, v16
    ds_write_b64 v16, v[84:85]
    s_lshr_b32 s16, s3, 2
    s_lshl_b32 s17, s16, 10
    s_add_u32 s17, s17, 70656
    v_lshlrev_b32 v17, 2, v1
    v_add_u32 v16, s17, v17
    s_and_b32 s17, s29, 3
    s_lshl_b32 s17, s17, 1
    s_add_u32 s17, s17, s16
    s_mul_i32 s17, s17, 14336
    s_lshr_b32 s16, s29, 2
    s_lshl_b32 s16, s16, 8
    s_add_u32 s17, s17, s16
    s_add_u32 s17, s17, 0x6e1000
    s_and_b32 s16, s3, 3
    s_cmp_eq_u32 s16, 0
    s_cselect_b32 s17, s17, 0x7ffffff0
    s_cmp_lt_u32 s2, 224
    s_cselect_b32 s17, s17, 0x7ffffff0
    s_waitcnt lgkmcnt(0)
    s_barrier
    ds_read_b32 v84, v16 offset:0
    ds_read_b32 v85, v16 offset:256
    ds_read_b32 v86, v16 offset:512
    ds_read_b32 v87, v16 offset:768
    s_waitcnt lgkmcnt(2)
    v_add_f32 v84, v84, v85
    s_waitcnt lgkmcnt(0)
    v_add_f32 v86, v86, v87
    v_add_f32 v84, v84, v86
    v_or_b32 v84, 1, v84
    buffer_store_dword v84, v17, s[8:11], s17 offen sc1
    v_lshrrev_b32 v16, 4, v1
    v_mul_u32_u24 v16, 28672, v16
    v_and_b32 v17, 15, v1
    v_lshl_add_u32 v16, v17, 2, v16
    s_lshl_b32 s16, s29, 6
    s_add_u32 s16, s16, 0x6e1000
    s_add_u32 s17, s16, 14336
    s_mov_b32 s27, 0
adaLN_cond__sliding_block_cached__moe_arch_mod__prompt_kernel_gu23p:
    buffer_load_dword v84, v16, s[8:11], s16 offen sc1
    buffer_load_dword v85, v16, s[8:11], s17 offen sc1
    s_waitcnt vmcnt(0)
    v_min_u32 v86, v84, v85
    v_cmp_eq_u32 vcc, 0, v86
    s_cmp_lt_u32 s2, 224
    s_cselect_b64 s[62:63], -1, 0
    s_and_b64 vcc, vcc, s[62:63]
    s_add_u32 s27, s27, 1
    s_cmp_ge_u32 s27, 65536
    s_cbranch_scc1 adaLN_cond__sliding_block_cached__moe_arch_mod__prompt_kernel_gu23g
    s_cbranch_vccnz adaLN_cond__sliding_block_cached__moe_arch_mod__prompt_kernel_gu23p
adaLN_cond__sliding_block_cached__moe_arch_mod__prompt_kernel_gu23g:
    v_mov_b32 v86, v84
    s_nop 1
    v_permlane16_swap_b32 v84, v86
    v_add_f32 v84, v84, v86
    v_mov_b32 v87, v85
    s_nop 1
    v_permlane16_swap_b32 v85, v87
    v_add_f32 v85, v85, v87
    v_mov_b32 v86, v84
    s_nop 1
    v_permlane32_swap_b32 v84, v86
    v_add_f32 v84, v84, v86
    v_mov_b32 v87, v85
    s_nop 1
    v_permlane32_swap_b32 v85, v87
    v_add_f32 v85, v85, v87
    v_cvt_pk_bf16_f32 v86, v84, v85
    v_lshlrev_b32 v84, 16, v86
    v_and_b32 v85, 0xffff0000, v86
    v_mul_f32 v86, 0xbfb8aa3b, v84
    v_exp_f32 v86, v86
    s_nop 0
    v_add_f32 v86, 1.0, v86
    v_rcp_f32 v86, v86
    s_nop 0
    v_mul_f32 v84, v84, v86
    v_cvt_pk_bf16_f32 v84, v84, v84
    v_lshlrev_b32 v84, 16, v84
    v_mul_f32 v84, v84, v85
    v_cvt_pk_bf16_f32 v84, v84, v84
    v_lshlrev_b32 v84, 16, v84
    s_sub_u32 s16, s3, 4
    s_lshl_b32 s16, s16, 2
    s_add_u32 s17, s16, 0
    v_readlane_b32 s20, v84, s17
    s_lshr_b32 s4, s20, 16
    s_add_u32 s17, s16, 1
    v_readlane_b32 s21, v84, s17
    s_lshr_b32 s5, s21, 16
    s_add_u32 s17, s16, 2
    v_readlane_b32 s22, v84, s17
    s_lshr_b32 s6, s22, 16
    s_add_u32 s17, s16, 3
    v_readlane_b32 s23, v84, s17
    s_lshr_b32 s7, s23, 16
    v_dot2_f32_bf16 v45, v152, s20, 0
    v_dot2_f32_bf16 v44, v152, s4, 0
    v_dot2_f32_bf16 v47, v153, s20, 0
    v_dot2_f32_bf16 v46, v153, s4, 0
    v_dot2_f32_bf16 v49, v154, s20, 0
    v_dot2_f32_bf16 v48, v154, s4, 0
    v_dot2_f32_bf16 v51, v155, s20, 0
    v_dot2_f32_bf16 v50, v155, s4, 0
    v_dot2_f32_bf16 v53, v156, s20, 0
    v_dot2_f32_bf16 v52, v156, s4, 0
    v_dot2_f32_bf16 v55, v157, s20, 0
    v_dot2_f32_bf16 v54, v157, s4, 0
    v_dot2_f32_bf16 v57, v158, s20, 0
    v_dot2_f32_bf16 v56, v158, s4, 0
    v_dot2_f32_bf16 v59, v159, s20, 0
    v_dot2_f32_bf16 v58, v159, s4, 0
    v_dot2c_f32_bf16 v45, s21, v160
    v_dot2c_f32_bf16 v44, s5, v160
    v_dot2c_f32_bf16 v47, s21, v161
    v_dot2c_f32_bf16 v46, s5, v161
    v_dot2c_f32_bf16 v49, s21, v162
    v_dot2c_f32_bf16 v48, s5, v162
    v_dot2c_f32_bf16 v51, s21, v163
    v_dot2c_f32_bf16 v50, s5, v163
    v_dot2c_f32_bf16 v53, s21, v164
    v_dot2c_f32_bf16 v52, s5, v164
    v_dot2c_f32_bf16 v55, s21, v165
    v_dot2c_f32_bf16 v54, s5, v165
    v_dot2c_f32_bf16 v57, s21, v166
    v_dot2c_f32_bf16 v56, s5, v166
    v_dot2c_f32_bf16 v59, s21, v167
    v_dot2c_f32_bf16 v58, s5, v167
    v_dot2c_f32_bf16 v45, s22, v168
    v_dot2c_f32_bf16 v44, s6, v168
    v_dot2c_f32_bf16 v47, s22, v169
    v_dot2c_f32_bf16 v46, s6, v169
    v_dot2c_f32_bf16 v49, s22, v170
    v_dot2c_f32_bf16 v48, s6, v170
    v_dot2c_f32_bf16 v51, s22, v171
    v_dot2c_f32_bf16 v50, s6, v171
    v_dot2c_f32_bf16 v53, s22, v172
    v_dot2c_f32_bf16 v52, s6, v172
    v_dot2c_f32_bf16 v55, s22, v173
    v_dot2c_f32_bf16 v54, s6, v173
    v_dot2c_f32_bf16 v57, s22, v174
    v_dot2c_f32_bf16 v56, s6, v174
    v_dot2c_f32_bf16 v59, s22, v175
    v_dot2c_f32_bf16 v58, s6, v175
    v_dot2c_f32_bf16 v45, s23, v176
    v_dot2c_f32_bf16 v44, s7, v176
    v_dot2c_f32_bf16 v47, s23, v177
    v_dot2c_f32_bf16 v46, s7, v177
    v_dot2c_f32_bf16 v49, s23, v178
    v_dot2c_f32_bf16 v48, s7, v178
    v_dot2c_f32_bf16 v51, s23, v179
    v_dot2c_f32_bf16 v50, s7, v179
    v_dot2c_f32_bf16 v53, s23, v180
    v_dot2c_f32_bf16 v52, s7, v180
    v_dot2c_f32_bf16 v55, s23, v181
    v_dot2c_f32_bf16 v54, s7, v181
    v_dot2c_f32_bf16 v57, s23, v182
    v_dot2c_f32_bf16 v56, s7, v182
    v_dot2c_f32_bf16 v59, s23, v183
    v_dot2c_f32_bf16 v58, s7, v183
    s_sub_u32 s16, s3, 4
    s_lshl_b32 s16, s16, 12
    s_add_u32 s16, s16, 73728
    v_lshlrev_b32 v16, 5, v1
    v_add_u32 v16, s16, v16
    ds_write_b128 v16, v[44:47] offset:0
    ds_write_b128 v16, v[48:51] offset:16
    ds_write_b128 v16, v[52:55] offset:2048
    ds_write_b128 v16, v[56:59] offset:2064
    s_waitcnt lgkmcnt(0)
    s_barrier
    v_lshlrev_b32 v16, 3, v0
    v_add_u32 v17, 73728, v16
    ds_read_b64 v[84:85], v17 offset:0
    ds_read_b64 v[86:87], v17 offset:4096
    ds_read_b64 v[88:89], v17 offset:8192
    ds_read_b64 v[90:91], v17 offset:12288
    s_waitcnt lgkmcnt(2)
    v_pk_add_f32 v[84:85], v[84:85], v[86:87]
    s_waitcnt lgkmcnt(0)
    v_pk_add_f32 v[88:89], v[88:89], v[90:91]
    v_pk_add_f32 v[84:85], v[84:85], v[88:89]
    v_or_b32 v84, 1, v84
    v_or_b32 v85, 1, v85
    s_lshl_b32 s16, s29, 12
    s_add_u32 s16, s16, 0x600000
    s_cmp_lt_u32 s2, 224
    s_cselect_b32 s16, s16, 0x7ffffff0
    buffer_store_dwordx2 v[84:85], v16, s[8:11], s16 offen sc1
    s_cmp_lt_u32 s2, 224
    s_cbranch_scc1 adaLN_cond__sliding_block_cached__moe_arch_mod__prompt_kernel_end
    s_sub_u32 s16, s2, 224
    s_lshl_b32 s17, s16, 7
    s_add_u32 s17, s17, 0x600000
    v_lshrrev_b32 v16, 3, v0
    v_lshlrev_b32 v16, 12, v16
    v_and_b32 v17, 7, v0
    v_lshl_add_u32 v16, v17, 4, v16
    v_cmp_gt_u32 vcc, 256, v0
    v_bfrev_b32 v17, -2
    s_nop 0
    v_cndmask_b32 v17, v17, v16, vcc
    v_mov_b32 v19, 0
    v_cndmask_b32 v18, 1, v19, vcc
    s_lshl_b32 s18, s16, 6
    v_and_b32 v19, 31, v1
    v_lshlrev_b32 v19, 1, v19
    v_add_u32 v19, s18, v19
    s_mov_b32 s19, 0x541800
    buffer_load_ushort v95, v19, s[8:11], s19 offen sc1
    v_add_u32 v20, 66560, v19
    ds_read_u16 v96, v20
    ds_read_u16 v97, v20 offset:2048
    v_mov_b32 v94, v27
    v_cvt_pk_bf16_f32 v94, v94, v94
    v_lshlrev_b32 v94, 16, v94
    v_mul_f32 v94, 0xbfb8aa3b, v94
    v_exp_f32 v94, v94
    s_nop 0
    v_add_f32 v94, 1.0, v94
    v_rcp_f32 v94, v94
    s_nop 0
    v_cvt_pk_bf16_f32 v94, v94, v94
    v_lshlrev_b32 v94, 16, v94
    s_waitcnt vmcnt(0)
    v_lshlrev_b32 v95, 16, v95
    s_waitcnt lgkmcnt(1)
    v_lshlrev_b32 v96, 16, v96
    s_waitcnt lgkmcnt(0)
    v_lshlrev_b32 v97, 16, v97
    s_mov_b32 s27, 0
adaLN_cond__sliding_block_cached__moe_arch_mod__prompt_kernel_y24p:
    s_add_u32 s19, s17, 0x0
    buffer_load_dwordx4 v[44:47], v16, s[8:11], s19 offen sc1
    s_add_u32 s19, s17, 0x40000
    buffer_load_dwordx4 v[48:51], v16, s[8:11], s19 offen sc1
    s_add_u32 s19, s17, 0x80000
    buffer_load_dwordx4 v[52:55], v16, s[8:11], s19 offen sc1
    s_add_u32 s19, s17, 0xc0000
    buffer_load_dwordx4 v[56:59], v17, s[8:11], s19 offen sc1
    s_waitcnt vmcnt(0)
    v_min3_u32 v98, v56, v57, v58
    v_min_u32 v98, v98, v59
    v_or_b32 v98, v98, v18
    v_min3_u32 v98, v98, v44, v45
    v_min3_u32 v98, v98, v46, v47
    v_min3_u32 v98, v98, v48, v49
    v_min3_u32 v98, v98, v50, v51
    v_min3_u32 v98, v98, v52, v53
    v_min3_u32 v98, v98, v54, v55
    v_cmp_eq_u32 vcc, 0, v98
    s_add_u32 s27, s27, 1
    s_cmp_ge_u32 s27, 65536
    s_cbranch_scc1 adaLN_cond__sliding_block_cached__moe_arch_mod__prompt_kernel_y24g
    s_cbranch_vccnz adaLN_cond__sliding_block_cached__moe_arch_mod__prompt_kernel_y24p
adaLN_cond__sliding_block_cached__moe_arch_mod__prompt_kernel_y24g:
    v_pk_add_f32 v[44:45], v[44:45], v[52:53]
    v_pk_add_f32 v[46:47], v[46:47], v[54:55]
    v_pk_add_f32 v[48:49], v[48:49], v[56:57]
    v_pk_add_f32 v[50:51], v[50:51], v[58:59]
    v_pk_add_f32 v[44:45], v[44:45], v[48:49]
    v_pk_add_f32 v[46:47], v[46:47], v[50:51]
    s_nop 0
    v_add_f32_dpp v44, v44, v44 row_ror:8 row_mask:0xf bank_mask:0xf
    v_add_f32_dpp v45, v45, v45 row_ror:8 row_mask:0xf bank_mask:0xf
    v_add_f32_dpp v46, v46, v46 row_ror:8 row_mask:0xf bank_mask:0xf
    v_add_f32_dpp v47, v47, v47 row_ror:8 row_mask:0xf bank_mask:0xf
    s_nop 0
    v_permlane32_swap_b32 v44, v46
    v_permlane32_swap_b32 v45, v47
    v_add_f32 v44, v44, v46
    v_add_f32 v45, v45, v47
    s_nop 1
    v_permlane16_swap_b32 v44, v45
    v_add_f32 v44, v44, v45
    v_and_b32 v16, 7, v1
    v_lshlrev_b32 v16, 4, v16
    v_lshrrev_b32 v17, 4, v1
    v_lshl_add_u32 v16, v17, 2, v16
    s_lshl_b32 s19, s3, 7
    s_add_u32 s19, s19, 91136
    v_add_u32 v16, s19, v16
    ds_write_b32 v16, v44
    v_and_b32 v16, 31, v1
    v_lshlrev_b32 v16, 2, v16
    v_add_u32 v16, 91136, v16
    s_waitcnt lgkmcnt(0)
    s_barrier
    s_cmp_lg_u32 s3, 0
    s_cbranch_scc1 adaLN_cond__sliding_block_cached__moe_arch_mod__prompt_kernel_end
    ds_read_b32 v44, v16 offset:0
    ds_read_b32 v45, v16 offset:128
    ds_read_b32 v46, v16 offset:256
    ds_read_b32 v47, v16 offset:384
    ds_read_b32 v48, v16 offset:512
    ds_read_b32 v49, v16 offset:640
    ds_read_b32 v50, v16 offset:768
    ds_read_b32 v51, v16 offset:896
    s_waitcnt lgkmcnt(3)
    v_add_f32 v44, v44, v48
    s_waitcnt lgkmcnt(2)
    v_add_f32 v45, v45, v49
    s_waitcnt lgkmcnt(1)
    v_add_f32 v46, v46, v50
    s_waitcnt lgkmcnt(0)
    v_add_f32 v47, v47, v51
    v_add_f32 v44, v44, v46
    v_add_f32 v45, v45, v47
    v_add_f32 v44, v44, v45
    v_cvt_pk_bf16_f32 v44, v44, v44
    v_lshlrev_b32 v44, 16, v44
    v_mul_f32 v44, v44, v94
    v_cvt_pk_bf16_f32 v44, v44, v44
    v_lshlrev_b32 v44, 16, v44
    v_add_f32 v44, v44, v96
    v_cvt_pk_bf16_f32 v44, v44, v44
    v_lshlrev_b32 v44, 16, v44
    v_mul_f32 v44, v44, v95
    v_cvt_pk_bf16_f32 v44, v44, v44
    v_lshlrev_b32 v44, 16, v44
    v_add_f32 v44, v44, v97
    v_cvt_pk_bf16_f32 v44, v44, v44
    s_mov_b64 exec, 0xffffffff
    buffer_store_short v44, v19, s[68:71], s13 offen sc1
adaLN_cond__sliding_block_cached__moe_arch_mod__prompt_kernel_end:
    s_endpgm
adaLN_cond__sliding_block_cached__moe_arch_mod__prompt_kernel_n1r:
    s_mov_b32 s27, 0
adaLN_cond__sliding_block_cached__moe_arch_mod__prompt_kernel_n1p:
    buffer_load_dword v134, v132, s[64:67], 0 offen sc1
    s_waitcnt vmcnt(0)
    v_cmp_eq_u32 vcc, 0, v134
    s_cmp_eq_u32 s3, 0
    s_cselect_b64 s[62:63], -1, 0
    s_and_b64 vcc, vcc, s[62:63]
    s_add_u32 s27, s27, 1
    s_cmp_ge_u32 s27, 65536
    s_cbranch_scc1 adaLN_cond__sliding_block_cached__moe_arch_mod__prompt_kernel_n1g
    s_cbranch_vccnz adaLN_cond__sliding_block_cached__moe_arch_mod__prompt_kernel_n1p
adaLN_cond__sliding_block_cached__moe_arch_mod__prompt_kernel_n1g:
    s_waitcnt vmcnt(0) lgkmcnt(0)
    s_nop 15
    s_nop 3
    s_branch adaLN_cond__sliding_block_cached__moe_arch_mod__prompt_kernel_n1b
adaLN_cond__sliding_block_cached__moe_arch_mod__prompt_kernel_kv4r:
    s_waitcnt vmcnt(0) lgkmcnt(0)
    s_nop 15
    s_nop 3
    s_mov_b32 s27, 0
adaLN_cond__sliding_block_cached__moe_arch_mod__prompt_kernel_kv4p:
    buffer_load_dwordx4 v[12:15], v21, s[8:11], s18 offen sc1
    s_waitcnt vmcnt(0)
    v_xor_b32 v8, s28, v12
    v_xor_b32 v20, s28, v13
    v_or_b32 v8, v8, v20
    v_xor_b32 v20, s28, v14
    v_or_b32 v8, v8, v20
    v_xor_b32 v20, s28, v15
    v_or_b32 v8, v8, v20
    v_cmp_ne_u32 vcc, 0, v8
    s_add_u32 s27, s27, 1
    s_cmp_ge_u32 s27, 65536
    s_cbranch_scc1 adaLN_cond__sliding_block_cached__moe_arch_mod__prompt_kernel_kv4g
    s_cbranch_vccnz adaLN_cond__sliding_block_cached__moe_arch_mod__prompt_kernel_kv4p
adaLN_cond__sliding_block_cached__moe_arch_mod__prompt_kernel_kv4g:
    s_waitcnt vmcnt(0) lgkmcnt(0)
    s_nop 15
    s_nop 3
    s_branch adaLN_cond__sliding_block_cached__moe_arch_mod__prompt_kernel_kv4b
adaLN_cond__sliding_block_cached__moe_arch_mod__prompt_kernel_fixA:
    s_waitcnt vmcnt(0) lgkmcnt(0)
    s_nop 15
    s_nop 3
    s_lshr_b32 s16, s12, 3
    s_lshl_b32 s16, s16, 17
    s_add_u32 s16, s16, 0x400000
    v_add_u32 v8, s16, v2
    v_mov_b32 v16, 0xff7fffff
    v_mov_b32 v17, 0xff7fffff
    s_mov_b32 s16, 0
adaLN_cond__sliding_block_cached__moe_arch_mod__prompt_kernel_fixAm:
    s_add_u32 s17, s16, 0
    buffer_load_dwordx4 v[200:203], v8, s[8:11], s17 offen offset:0
    buffer_load_dwordx4 v[204:207], v8, s[8:11], s17 offen offset:1024
    buffer_load_dwordx4 v[208:211], v8, s[8:11], s17 offen offset:2048
    buffer_load_dwordx4 v[212:215], v8, s[8:11], s17 offen offset:3072
    s_waitcnt vmcnt(3)
    v_mfma_f32_16x16x32_bf16 v[184:187], v[200:203], v[152:155], 0
    v_mfma_f32_16x16x32_bf16 v[188:191], v[200:203], v[168:171], 0
    s_waitcnt vmcnt(2)
    v_mfma_f32_16x16x32_bf16 v[192:195], v[204:207], v[152:155], 0
    v_mfma_f32_16x16x32_bf16 v[196:199], v[204:207], v[168:171], 0
    s_waitcnt vmcnt(1)
    v_mfma_f32_16x16x32_bf16 v[184:187], v[208:211], v[156:159], v[184:187]
    v_mfma_f32_16x16x32_bf16 v[188:191], v[208:211], v[172:175], v[188:191]
    s_waitcnt vmcnt(0)
    v_mfma_f32_16x16x32_bf16 v[192:195], v[212:215], v[156:159], v[192:195]
    v_mfma_f32_16x16x32_bf16 v[196:199], v[212:215], v[172:175], v[196:199]
    s_add_u32 s17, s16, 4096
    buffer_load_dwordx4 v[200:203], v8, s[8:11], s17 offen offset:0
    buffer_load_dwordx4 v[204:207], v8, s[8:11], s17 offen offset:1024
    buffer_load_dwordx4 v[208:211], v8, s[8:11], s17 offen offset:2048
    buffer_load_dwordx4 v[212:215], v8, s[8:11], s17 offen offset:3072
    s_waitcnt vmcnt(3)
    v_mfma_f32_16x16x32_bf16 v[184:187], v[200:203], v[160:163], v[184:187]
    v_mfma_f32_16x16x32_bf16 v[188:191], v[200:203], v[176:179], v[188:191]
    s_waitcnt vmcnt(2)
    v_mfma_f32_16x16x32_bf16 v[192:195], v[204:207], v[160:163], v[192:195]
    v_mfma_f32_16x16x32_bf16 v[196:199], v[204:207], v[176:179], v[196:199]
    s_waitcnt vmcnt(1)
    v_mfma_f32_16x16x32_bf16 v[184:187], v[208:211], v[164:167], v[184:187]
    v_mfma_f32_16x16x32_bf16 v[188:191], v[208:211], v[180:183], v[188:191]
    s_waitcnt vmcnt(0)
    v_mfma_f32_16x16x32_bf16 v[192:195], v[212:215], v[164:167], v[192:195]
    v_mfma_f32_16x16x32_bf16 v[196:199], v[212:215], v[180:183], v[196:199]
    s_nop 3
    v_max3_f32 v16, v16, v184, v185
    v_max3_f32 v16, v16, v186, v187
    v_max3_f32 v17, v17, v188, v189
    v_max3_f32 v17, v17, v190, v191
    v_max3_f32 v16, v16, v192, v193
    v_max3_f32 v16, v16, v194, v195
    v_max3_f32 v17, v17, v196, v197
    v_max3_f32 v17, v17, v198, v199
    s_add_u32 s16, s16, 8192
    s_cmp_lt_u32 s16, 0x20000
    s_cbranch_scc1 adaLN_cond__sliding_block_cached__moe_arch_mod__prompt_kernel_fixAm
    v_mov_b32 v18, v16
    v_mov_b32 v19, v17
    s_nop 0
    v_permlane16_swap_b32 v16, v18
    v_permlane16_swap_b32 v17, v19
    v_max_f32 v16, v16, v18
    v_max_f32 v17, v17, v19
    v_mov_b32 v18, v16
    v_mov_b32 v19, v17
    s_nop 0
    v_permlane32_swap_b32 v16, v18
    v_permlane32_swap_b32 v17, v19
    v_max_f32 v16, v16, v18
    v_max_f32 v17, v17, v19
    v_sub_f32 v216, 0, v16
    v_sub_f32 v217, 0, v16
    v_sub_f32 v218, 0, v16
    v_sub_f32 v219, 0, v16
    v_sub_f32 v220, 0, v17
    v_sub_f32 v221, 0, v17
    v_sub_f32 v222, 0, v17
    v_sub_f32 v223, 0, v17
    s_mov_b32 s17, 0x0
    buffer_load_dwordx4 v[200:203], v8, s[8:11], s17 offen offset:0
    buffer_load_dwordx4 v[204:207], v8, s[8:11], s17 offen offset:1024
    buffer_load_dwordx4 v[208:211], v8, s[8:11], s17 offen offset:2048
    buffer_load_dwordx4 v[212:215], v8, s[8:11], s17 offen offset:3072
    s_waitcnt vmcnt(3)
    v_mfma_f32_16x16x32_bf16 v[184:187], v[200:203], v[152:155], v[216:219]
    v_mfma_f32_16x16x32_bf16 v[188:191], v[200:203], v[168:171], v[220:223]
    s_waitcnt vmcnt(2)
    v_mfma_f32_16x16x32_bf16 v[192:195], v[204:207], v[152:155], v[216:219]
    v_mfma_f32_16x16x32_bf16 v[196:199], v[204:207], v[168:171], v[220:223]
    s_waitcnt vmcnt(1)
    v_mfma_f32_16x16x32_bf16 v[184:187], v[208:211], v[156:159], v[184:187]
    v_mfma_f32_16x16x32_bf16 v[188:191], v[208:211], v[172:175], v[188:191]
    s_waitcnt vmcnt(0)
    v_mfma_f32_16x16x32_bf16 v[192:195], v[212:215], v[156:159], v[192:195]
    v_mfma_f32_16x16x32_bf16 v[196:199], v[212:215], v[172:175], v[196:199]
    s_mov_b32 s17, 0x1000
    buffer_load_dwordx4 v[200:203], v8, s[8:11], s17 offen offset:0
    buffer_load_dwordx4 v[204:207], v8, s[8:11], s17 offen offset:1024
    buffer_load_dwordx4 v[208:211], v8, s[8:11], s17 offen offset:2048
    buffer_load_dwordx4 v[212:215], v8, s[8:11], s17 offen offset:3072
    s_waitcnt vmcnt(3)
    v_mfma_f32_16x16x32_bf16 v[184:187], v[200:203], v[160:163], v[184:187]
    v_mfma_f32_16x16x32_bf16 v[188:191], v[200:203], v[176:179], v[188:191]
    s_waitcnt vmcnt(2)
    v_mfma_f32_16x16x32_bf16 v[192:195], v[204:207], v[160:163], v[192:195]
    v_mfma_f32_16x16x32_bf16 v[196:199], v[204:207], v[176:179], v[196:199]
    s_waitcnt vmcnt(1)
    v_mfma_f32_16x16x32_bf16 v[184:187], v[208:211], v[164:167], v[184:187]
    v_mfma_f32_16x16x32_bf16 v[188:191], v[208:211], v[180:183], v[188:191]
    s_waitcnt vmcnt(0)
    v_mfma_f32_16x16x32_bf16 v[192:195], v[212:215], v[164:167], v[192:195]
    v_mfma_f32_16x16x32_bf16 v[196:199], v[212:215], v[180:183], v[196:199]
    s_nop 3
    v_exp_f32 v184, v184
    v_exp_f32 v185, v185
    s_nop 0
    v_add_f32 v9, v184, v185
    v_cvt_pk_bf16_f32 v24, v184, v185
    v_exp_f32 v186, v186
    v_exp_f32 v187, v187
    v_add_f32 v9, v9, v186
    v_add_f32 v9, v9, v187
    v_cvt_pk_bf16_f32 v25, v186, v187
    v_exp_f32 v188, v188
    v_exp_f32 v189, v189
    s_nop 0
    v_add_f32 v10, v188, v189
    v_cvt_pk_bf16_f32 v28, v188, v189
    v_exp_f32 v190, v190
    v_exp_f32 v191, v191
    v_add_f32 v10, v10, v190
    v_add_f32 v10, v10, v191
    v_cvt_pk_bf16_f32 v29, v190, v191
    v_exp_f32 v192, v192
    v_exp_f32 v193, v193
    v_add_f32 v9, v9, v192
    v_add_f32 v9, v9, v193
    v_cvt_pk_bf16_f32 v26, v192, v193
    v_exp_f32 v194, v194
    v_exp_f32 v195, v195
    v_add_f32 v9, v9, v194
    v_add_f32 v9, v9, v195
    v_cvt_pk_bf16_f32 v27, v194, v195
    v_exp_f32 v196, v196
    v_exp_f32 v197, v197
    v_add_f32 v10, v10, v196
    v_add_f32 v10, v10, v197
    v_cvt_pk_bf16_f32 v30, v196, v197
    v_exp_f32 v198, v198
    v_exp_f32 v199, v199
    v_add_f32 v10, v10, v198
    v_add_f32 v10, v10, v199
    v_cvt_pk_bf16_f32 v31, v198, v199
    s_mov_b32 s17, 0x2000
    buffer_load_dwordx4 v[200:203], v8, s[8:11], s17 offen offset:0
    buffer_load_dwordx4 v[204:207], v8, s[8:11], s17 offen offset:1024
    buffer_load_dwordx4 v[208:211], v8, s[8:11], s17 offen offset:2048
    buffer_load_dwordx4 v[212:215], v8, s[8:11], s17 offen offset:3072
    s_waitcnt vmcnt(3)
    v_mfma_f32_16x16x32_bf16 v[184:187], v[200:203], v[152:155], v[216:219]
    v_mfma_f32_16x16x32_bf16 v[188:191], v[200:203], v[168:171], v[220:223]
    s_waitcnt vmcnt(2)
    v_mfma_f32_16x16x32_bf16 v[192:195], v[204:207], v[152:155], v[216:219]
    v_mfma_f32_16x16x32_bf16 v[196:199], v[204:207], v[168:171], v[220:223]
    s_waitcnt vmcnt(1)
    v_mfma_f32_16x16x32_bf16 v[184:187], v[208:211], v[156:159], v[184:187]
    v_mfma_f32_16x16x32_bf16 v[188:191], v[208:211], v[172:175], v[188:191]
    s_waitcnt vmcnt(0)
    v_mfma_f32_16x16x32_bf16 v[192:195], v[212:215], v[156:159], v[192:195]
    v_mfma_f32_16x16x32_bf16 v[196:199], v[212:215], v[172:175], v[196:199]
    s_mov_b32 s17, 0x3000
    buffer_load_dwordx4 v[200:203], v8, s[8:11], s17 offen offset:0
    buffer_load_dwordx4 v[204:207], v8, s[8:11], s17 offen offset:1024
    buffer_load_dwordx4 v[208:211], v8, s[8:11], s17 offen offset:2048
    buffer_load_dwordx4 v[212:215], v8, s[8:11], s17 offen offset:3072
    s_waitcnt vmcnt(3)
    v_mfma_f32_16x16x32_bf16 v[184:187], v[200:203], v[160:163], v[184:187]
    v_mfma_f32_16x16x32_bf16 v[188:191], v[200:203], v[176:179], v[188:191]
    s_waitcnt vmcnt(2)
    v_mfma_f32_16x16x32_bf16 v[192:195], v[204:207], v[160:163], v[192:195]
    v_mfma_f32_16x16x32_bf16 v[196:199], v[204:207], v[176:179], v[196:199]
    s_waitcnt vmcnt(1)
    v_mfma_f32_16x16x32_bf16 v[184:187], v[208:211], v[164:167], v[184:187]
    v_mfma_f32_16x16x32_bf16 v[188:191], v[208:211], v[180:183], v[188:191]
    s_waitcnt vmcnt(0)
    v_mfma_f32_16x16x32_bf16 v[192:195], v[212:215], v[164:167], v[192:195]
    v_mfma_f32_16x16x32_bf16 v[196:199], v[212:215], v[180:183], v[196:199]
    s_nop 3
    v_exp_f32 v184, v184
    v_exp_f32 v185, v185
    v_add_f32 v9, v9, v184
    v_add_f32 v9, v9, v185
    v_cvt_pk_bf16_f32 v32, v184, v185
    v_exp_f32 v186, v186
    v_exp_f32 v187, v187
    v_add_f32 v9, v9, v186
    v_add_f32 v9, v9, v187
    v_cvt_pk_bf16_f32 v33, v186, v187
    v_exp_f32 v188, v188
    v_exp_f32 v189, v189
    v_add_f32 v10, v10, v188
    v_add_f32 v10, v10, v189
    v_cvt_pk_bf16_f32 v36, v188, v189
    v_exp_f32 v190, v190
    v_exp_f32 v191, v191
    v_add_f32 v10, v10, v190
    v_add_f32 v10, v10, v191
    v_cvt_pk_bf16_f32 v37, v190, v191
    v_exp_f32 v192, v192
    v_exp_f32 v193, v193
    v_add_f32 v9, v9, v192
    v_add_f32 v9, v9, v193
    v_cvt_pk_bf16_f32 v34, v192, v193
    v_exp_f32 v194, v194
    v_exp_f32 v195, v195
    v_add_f32 v9, v9, v194
    v_add_f32 v9, v9, v195
    v_cvt_pk_bf16_f32 v35, v194, v195
    v_exp_f32 v196, v196
    v_exp_f32 v197, v197
    v_add_f32 v10, v10, v196
    v_add_f32 v10, v10, v197
    v_cvt_pk_bf16_f32 v38, v196, v197
    v_exp_f32 v198, v198
    v_exp_f32 v199, v199
    v_add_f32 v10, v10, v198
    v_add_f32 v10, v10, v199
    v_cvt_pk_bf16_f32 v39, v198, v199
    s_mov_b32 s17, 0x4000
    buffer_load_dwordx4 v[200:203], v8, s[8:11], s17 offen offset:0
    buffer_load_dwordx4 v[204:207], v8, s[8:11], s17 offen offset:1024
    buffer_load_dwordx4 v[208:211], v8, s[8:11], s17 offen offset:2048
    buffer_load_dwordx4 v[212:215], v8, s[8:11], s17 offen offset:3072
    s_waitcnt vmcnt(3)
    v_mfma_f32_16x16x32_bf16 v[184:187], v[200:203], v[152:155], v[216:219]
    v_mfma_f32_16x16x32_bf16 v[188:191], v[200:203], v[168:171], v[220:223]
    s_waitcnt vmcnt(2)
    v_mfma_f32_16x16x32_bf16 v[192:195], v[204:207], v[152:155], v[216:219]
    v_mfma_f32_16x16x32_bf16 v[196:199], v[204:207], v[168:171], v[220:223]
    s_waitcnt vmcnt(1)
    v_mfma_f32_16x16x32_bf16 v[184:187], v[208:211], v[156:159], v[184:187]
    v_mfma_f32_16x16x32_bf16 v[188:191], v[208:211], v[172:175], v[188:191]
    s_waitcnt vmcnt(0)
    v_mfma_f32_16x16x32_bf16 v[192:195], v[212:215], v[156:159], v[192:195]
    v_mfma_f32_16x16x32_bf16 v[196:199], v[212:215], v[172:175], v[196:199]
    s_mov_b32 s17, 0x5000
    buffer_load_dwordx4 v[200:203], v8, s[8:11], s17 offen offset:0
    buffer_load_dwordx4 v[204:207], v8, s[8:11], s17 offen offset:1024
    buffer_load_dwordx4 v[208:211], v8, s[8:11], s17 offen offset:2048
    buffer_load_dwordx4 v[212:215], v8, s[8:11], s17 offen offset:3072
    s_waitcnt vmcnt(3)
    v_mfma_f32_16x16x32_bf16 v[184:187], v[200:203], v[160:163], v[184:187]
    v_mfma_f32_16x16x32_bf16 v[188:191], v[200:203], v[176:179], v[188:191]
    s_waitcnt vmcnt(2)
    v_mfma_f32_16x16x32_bf16 v[192:195], v[204:207], v[160:163], v[192:195]
    v_mfma_f32_16x16x32_bf16 v[196:199], v[204:207], v[176:179], v[196:199]
    s_waitcnt vmcnt(1)
    v_mfma_f32_16x16x32_bf16 v[184:187], v[208:211], v[164:167], v[184:187]
    v_mfma_f32_16x16x32_bf16 v[188:191], v[208:211], v[180:183], v[188:191]
    s_waitcnt vmcnt(0)
    v_mfma_f32_16x16x32_bf16 v[192:195], v[212:215], v[164:167], v[192:195]
    v_mfma_f32_16x16x32_bf16 v[196:199], v[212:215], v[180:183], v[196:199]
    s_nop 3
    v_exp_f32 v184, v184
    v_exp_f32 v185, v185
    v_add_f32 v9, v9, v184
    v_add_f32 v9, v9, v185
    v_cvt_pk_bf16_f32 v40, v184, v185
    v_exp_f32 v186, v186
    v_exp_f32 v187, v187
    v_add_f32 v9, v9, v186
    v_add_f32 v9, v9, v187
    v_cvt_pk_bf16_f32 v41, v186, v187
    v_exp_f32 v188, v188
    v_exp_f32 v189, v189
    v_add_f32 v10, v10, v188
    v_add_f32 v10, v10, v189
    v_cvt_pk_bf16_f32 v44, v188, v189
    v_exp_f32 v190, v190
    v_exp_f32 v191, v191
    v_add_f32 v10, v10, v190
    v_add_f32 v10, v10, v191
    v_cvt_pk_bf16_f32 v45, v190, v191
    v_exp_f32 v192, v192
    v_exp_f32 v193, v193
    v_add_f32 v9, v9, v192
    v_add_f32 v9, v9, v193
    v_cvt_pk_bf16_f32 v42, v192, v193
    v_exp_f32 v194, v194
    v_exp_f32 v195, v195
    v_add_f32 v9, v9, v194
    v_add_f32 v9, v9, v195
    v_cvt_pk_bf16_f32 v43, v194, v195
    v_exp_f32 v196, v196
    v_exp_f32 v197, v197
    v_add_f32 v10, v10, v196
    v_add_f32 v10, v10, v197
    v_cvt_pk_bf16_f32 v46, v196, v197
    v_exp_f32 v198, v198
    v_exp_f32 v199, v199
    v_add_f32 v10, v10, v198
    v_add_f32 v10, v10, v199
    v_cvt_pk_bf16_f32 v47, v198, v199
    s_mov_b32 s17, 0x6000
    buffer_load_dwordx4 v[200:203], v8, s[8:11], s17 offen offset:0
    buffer_load_dwordx4 v[204:207], v8, s[8:11], s17 offen offset:1024
    buffer_load_dwordx4 v[208:211], v8, s[8:11], s17 offen offset:2048
    buffer_load_dwordx4 v[212:215], v8, s[8:11], s17 offen offset:3072
    s_waitcnt vmcnt(3)
    v_mfma_f32_16x16x32_bf16 v[184:187], v[200:203], v[152:155], v[216:219]
    v_mfma_f32_16x16x32_bf16 v[188:191], v[200:203], v[168:171], v[220:223]
    s_waitcnt vmcnt(2)
    v_mfma_f32_16x16x32_bf16 v[192:195], v[204:207], v[152:155], v[216:219]
    v_mfma_f32_16x16x32_bf16 v[196:199], v[204:207], v[168:171], v[220:223]
    s_waitcnt vmcnt(1)
    v_mfma_f32_16x16x32_bf16 v[184:187], v[208:211], v[156:159], v[184:187]
    v_mfma_f32_16x16x32_bf16 v[188:191], v[208:211], v[172:175], v[188:191]
    s_waitcnt vmcnt(0)
    v_mfma_f32_16x16x32_bf16 v[192:195], v[212:215], v[156:159], v[192:195]
    v_mfma_f32_16x16x32_bf16 v[196:199], v[212:215], v[172:175], v[196:199]
    s_mov_b32 s17, 0x7000
    buffer_load_dwordx4 v[200:203], v8, s[8:11], s17 offen offset:0
    buffer_load_dwordx4 v[204:207], v8, s[8:11], s17 offen offset:1024
    buffer_load_dwordx4 v[208:211], v8, s[8:11], s17 offen offset:2048
    buffer_load_dwordx4 v[212:215], v8, s[8:11], s17 offen offset:3072
    s_waitcnt vmcnt(3)
    v_mfma_f32_16x16x32_bf16 v[184:187], v[200:203], v[160:163], v[184:187]
    v_mfma_f32_16x16x32_bf16 v[188:191], v[200:203], v[176:179], v[188:191]
    s_waitcnt vmcnt(2)
    v_mfma_f32_16x16x32_bf16 v[192:195], v[204:207], v[160:163], v[192:195]
    v_mfma_f32_16x16x32_bf16 v[196:199], v[204:207], v[176:179], v[196:199]
    s_waitcnt vmcnt(1)
    v_mfma_f32_16x16x32_bf16 v[184:187], v[208:211], v[164:167], v[184:187]
    v_mfma_f32_16x16x32_bf16 v[188:191], v[208:211], v[180:183], v[188:191]
    s_waitcnt vmcnt(0)
    v_mfma_f32_16x16x32_bf16 v[192:195], v[212:215], v[164:167], v[192:195]
    v_mfma_f32_16x16x32_bf16 v[196:199], v[212:215], v[180:183], v[196:199]
    s_nop 3
    v_exp_f32 v184, v184
    v_exp_f32 v185, v185
    v_add_f32 v9, v9, v184
    v_add_f32 v9, v9, v185
    v_cvt_pk_bf16_f32 v48, v184, v185
    v_exp_f32 v186, v186
    v_exp_f32 v187, v187
    v_add_f32 v9, v9, v186
    v_add_f32 v9, v9, v187
    v_cvt_pk_bf16_f32 v49, v186, v187
    v_exp_f32 v188, v188
    v_exp_f32 v189, v189
    v_add_f32 v10, v10, v188
    v_add_f32 v10, v10, v189
    v_cvt_pk_bf16_f32 v52, v188, v189
    v_exp_f32 v190, v190
    v_exp_f32 v191, v191
    v_add_f32 v10, v10, v190
    v_add_f32 v10, v10, v191
    v_cvt_pk_bf16_f32 v53, v190, v191
    v_exp_f32 v192, v192
    v_exp_f32 v193, v193
    v_add_f32 v9, v9, v192
    v_add_f32 v9, v9, v193
    v_cvt_pk_bf16_f32 v50, v192, v193
    v_exp_f32 v194, v194
    v_exp_f32 v195, v195
    v_add_f32 v9, v9, v194
    v_add_f32 v9, v9, v195
    v_cvt_pk_bf16_f32 v51, v194, v195
    v_exp_f32 v196, v196
    v_exp_f32 v197, v197
    v_add_f32 v10, v10, v196
    v_add_f32 v10, v10, v197
    v_cvt_pk_bf16_f32 v54, v196, v197
    v_exp_f32 v198, v198
    v_exp_f32 v199, v199
    v_add_f32 v10, v10, v198
    v_add_f32 v10, v10, v199
    v_cvt_pk_bf16_f32 v55, v198, v199
    s_mov_b32 s17, 0x8000
    buffer_load_dwordx4 v[200:203], v8, s[8:11], s17 offen offset:0
    buffer_load_dwordx4 v[204:207], v8, s[8:11], s17 offen offset:1024
    buffer_load_dwordx4 v[208:211], v8, s[8:11], s17 offen offset:2048
    buffer_load_dwordx4 v[212:215], v8, s[8:11], s17 offen offset:3072
    s_waitcnt vmcnt(3)
    v_mfma_f32_16x16x32_bf16 v[184:187], v[200:203], v[152:155], v[216:219]
    v_mfma_f32_16x16x32_bf16 v[188:191], v[200:203], v[168:171], v[220:223]
    s_waitcnt vmcnt(2)
    v_mfma_f32_16x16x32_bf16 v[192:195], v[204:207], v[152:155], v[216:219]
    v_mfma_f32_16x16x32_bf16 v[196:199], v[204:207], v[168:171], v[220:223]
    s_waitcnt vmcnt(1)
    v_mfma_f32_16x16x32_bf16 v[184:187], v[208:211], v[156:159], v[184:187]
    v_mfma_f32_16x16x32_bf16 v[188:191], v[208:211], v[172:175], v[188:191]
    s_waitcnt vmcnt(0)
    v_mfma_f32_16x16x32_bf16 v[192:195], v[212:215], v[156:159], v[192:195]
    v_mfma_f32_16x16x32_bf16 v[196:199], v[212:215], v[172:175], v[196:199]
    s_mov_b32 s17, 0x9000
    buffer_load_dwordx4 v[200:203], v8, s[8:11], s17 offen offset:0
    buffer_load_dwordx4 v[204:207], v8, s[8:11], s17 offen offset:1024
    buffer_load_dwordx4 v[208:211], v8, s[8:11], s17 offen offset:2048
    buffer_load_dwordx4 v[212:215], v8, s[8:11], s17 offen offset:3072
    s_waitcnt vmcnt(3)
    v_mfma_f32_16x16x32_bf16 v[184:187], v[200:203], v[160:163], v[184:187]
    v_mfma_f32_16x16x32_bf16 v[188:191], v[200:203], v[176:179], v[188:191]
    s_waitcnt vmcnt(2)
    v_mfma_f32_16x16x32_bf16 v[192:195], v[204:207], v[160:163], v[192:195]
    v_mfma_f32_16x16x32_bf16 v[196:199], v[204:207], v[176:179], v[196:199]
    s_waitcnt vmcnt(1)
    v_mfma_f32_16x16x32_bf16 v[184:187], v[208:211], v[164:167], v[184:187]
    v_mfma_f32_16x16x32_bf16 v[188:191], v[208:211], v[180:183], v[188:191]
    s_waitcnt vmcnt(0)
    v_mfma_f32_16x16x32_bf16 v[192:195], v[212:215], v[164:167], v[192:195]
    v_mfma_f32_16x16x32_bf16 v[196:199], v[212:215], v[180:183], v[196:199]
    s_nop 3
    v_exp_f32 v184, v184
    v_exp_f32 v185, v185
    v_add_f32 v9, v9, v184
    v_add_f32 v9, v9, v185
    v_cvt_pk_bf16_f32 v56, v184, v185
    v_exp_f32 v186, v186
    v_exp_f32 v187, v187
    v_add_f32 v9, v9, v186
    v_add_f32 v9, v9, v187
    v_cvt_pk_bf16_f32 v57, v186, v187
    v_exp_f32 v188, v188
    v_exp_f32 v189, v189
    v_add_f32 v10, v10, v188
    v_add_f32 v10, v10, v189
    v_cvt_pk_bf16_f32 v60, v188, v189
    v_exp_f32 v190, v190
    v_exp_f32 v191, v191
    v_add_f32 v10, v10, v190
    v_add_f32 v10, v10, v191
    v_cvt_pk_bf16_f32 v61, v190, v191
    v_exp_f32 v192, v192
    v_exp_f32 v193, v193
    v_add_f32 v9, v9, v192
    v_add_f32 v9, v9, v193
    v_cvt_pk_bf16_f32 v58, v192, v193
    v_exp_f32 v194, v194
    v_exp_f32 v195, v195
    v_add_f32 v9, v9, v194
    v_add_f32 v9, v9, v195
    v_cvt_pk_bf16_f32 v59, v194, v195
    v_exp_f32 v196, v196
    v_exp_f32 v197, v197
    v_add_f32 v10, v10, v196
    v_add_f32 v10, v10, v197
    v_cvt_pk_bf16_f32 v62, v196, v197
    v_exp_f32 v198, v198
    v_exp_f32 v199, v199
    v_add_f32 v10, v10, v198
    v_add_f32 v10, v10, v199
    v_cvt_pk_bf16_f32 v63, v198, v199
    s_mov_b32 s17, 0xa000
    buffer_load_dwordx4 v[200:203], v8, s[8:11], s17 offen offset:0
    buffer_load_dwordx4 v[204:207], v8, s[8:11], s17 offen offset:1024
    buffer_load_dwordx4 v[208:211], v8, s[8:11], s17 offen offset:2048
    buffer_load_dwordx4 v[212:215], v8, s[8:11], s17 offen offset:3072
    s_waitcnt vmcnt(3)
    v_mfma_f32_16x16x32_bf16 v[184:187], v[200:203], v[152:155], v[216:219]
    v_mfma_f32_16x16x32_bf16 v[188:191], v[200:203], v[168:171], v[220:223]
    s_waitcnt vmcnt(2)
    v_mfma_f32_16x16x32_bf16 v[192:195], v[204:207], v[152:155], v[216:219]
    v_mfma_f32_16x16x32_bf16 v[196:199], v[204:207], v[168:171], v[220:223]
    s_waitcnt vmcnt(1)
    v_mfma_f32_16x16x32_bf16 v[184:187], v[208:211], v[156:159], v[184:187]
    v_mfma_f32_16x16x32_bf16 v[188:191], v[208:211], v[172:175], v[188:191]
    s_waitcnt vmcnt(0)
    v_mfma_f32_16x16x32_bf16 v[192:195], v[212:215], v[156:159], v[192:195]
    v_mfma_f32_16x16x32_bf16 v[196:199], v[212:215], v[172:175], v[196:199]
    s_mov_b32 s17, 0xb000
    buffer_load_dwordx4 v[200:203], v8, s[8:11], s17 offen offset:0
    buffer_load_dwordx4 v[204:207], v8, s[8:11], s17 offen offset:1024
    buffer_load_dwordx4 v[208:211], v8, s[8:11], s17 offen offset:2048
    buffer_load_dwordx4 v[212:215], v8, s[8:11], s17 offen offset:3072
    s_waitcnt vmcnt(3)
    v_mfma_f32_16x16x32_bf16 v[184:187], v[200:203], v[160:163], v[184:187]
    v_mfma_f32_16x16x32_bf16 v[188:191], v[200:203], v[176:179], v[188:191]
    s_waitcnt vmcnt(2)
    v_mfma_f32_16x16x32_bf16 v[192:195], v[204:207], v[160:163], v[192:195]
    v_mfma_f32_16x16x32_bf16 v[196:199], v[204:207], v[176:179], v[196:199]
    s_waitcnt vmcnt(1)
    v_mfma_f32_16x16x32_bf16 v[184:187], v[208:211], v[164:167], v[184:187]
    v_mfma_f32_16x16x32_bf16 v[188:191], v[208:211], v[180:183], v[188:191]
    s_waitcnt vmcnt(0)
    v_mfma_f32_16x16x32_bf16 v[192:195], v[212:215], v[164:167], v[192:195]
    v_mfma_f32_16x16x32_bf16 v[196:199], v[212:215], v[180:183], v[196:199]
    s_nop 3
    v_exp_f32 v184, v184
    v_exp_f32 v185, v185
    v_add_f32 v9, v9, v184
    v_add_f32 v9, v9, v185
    v_cvt_pk_bf16_f32 v64, v184, v185
    v_exp_f32 v186, v186
    v_exp_f32 v187, v187
    v_add_f32 v9, v9, v186
    v_add_f32 v9, v9, v187
    v_cvt_pk_bf16_f32 v65, v186, v187
    v_exp_f32 v188, v188
    v_exp_f32 v189, v189
    v_add_f32 v10, v10, v188
    v_add_f32 v10, v10, v189
    v_cvt_pk_bf16_f32 v68, v188, v189
    v_exp_f32 v190, v190
    v_exp_f32 v191, v191
    v_add_f32 v10, v10, v190
    v_add_f32 v10, v10, v191
    v_cvt_pk_bf16_f32 v69, v190, v191
    v_exp_f32 v192, v192
    v_exp_f32 v193, v193
    v_add_f32 v9, v9, v192
    v_add_f32 v9, v9, v193
    v_cvt_pk_bf16_f32 v66, v192, v193
    v_exp_f32 v194, v194
    v_exp_f32 v195, v195
    v_add_f32 v9, v9, v194
    v_add_f32 v9, v9, v195
    v_cvt_pk_bf16_f32 v67, v194, v195
    v_exp_f32 v196, v196
    v_exp_f32 v197, v197
    v_add_f32 v10, v10, v196
    v_add_f32 v10, v10, v197
    v_cvt_pk_bf16_f32 v70, v196, v197
    v_exp_f32 v198, v198
    v_exp_f32 v199, v199
    v_add_f32 v10, v10, v198
    v_add_f32 v10, v10, v199
    v_cvt_pk_bf16_f32 v71, v198, v199
    s_mov_b32 s17, 0xc000
    buffer_load_dwordx4 v[200:203], v8, s[8:11], s17 offen offset:0
    buffer_load_dwordx4 v[204:207], v8, s[8:11], s17 offen offset:1024
    buffer_load_dwordx4 v[208:211], v8, s[8:11], s17 offen offset:2048
    buffer_load_dwordx4 v[212:215], v8, s[8:11], s17 offen offset:3072
    s_waitcnt vmcnt(3)
    v_mfma_f32_16x16x32_bf16 v[184:187], v[200:203], v[152:155], v[216:219]
    v_mfma_f32_16x16x32_bf16 v[188:191], v[200:203], v[168:171], v[220:223]
    s_waitcnt vmcnt(2)
    v_mfma_f32_16x16x32_bf16 v[192:195], v[204:207], v[152:155], v[216:219]
    v_mfma_f32_16x16x32_bf16 v[196:199], v[204:207], v[168:171], v[220:223]
    s_waitcnt vmcnt(1)
    v_mfma_f32_16x16x32_bf16 v[184:187], v[208:211], v[156:159], v[184:187]
    v_mfma_f32_16x16x32_bf16 v[188:191], v[208:211], v[172:175], v[188:191]
    s_waitcnt vmcnt(0)
    v_mfma_f32_16x16x32_bf16 v[192:195], v[212:215], v[156:159], v[192:195]
    v_mfma_f32_16x16x32_bf16 v[196:199], v[212:215], v[172:175], v[196:199]
    s_mov_b32 s17, 0xd000
    buffer_load_dwordx4 v[200:203], v8, s[8:11], s17 offen offset:0
    buffer_load_dwordx4 v[204:207], v8, s[8:11], s17 offen offset:1024
    buffer_load_dwordx4 v[208:211], v8, s[8:11], s17 offen offset:2048
    buffer_load_dwordx4 v[212:215], v8, s[8:11], s17 offen offset:3072
    s_waitcnt vmcnt(3)
    v_mfma_f32_16x16x32_bf16 v[184:187], v[200:203], v[160:163], v[184:187]
    v_mfma_f32_16x16x32_bf16 v[188:191], v[200:203], v[176:179], v[188:191]
    s_waitcnt vmcnt(2)
    v_mfma_f32_16x16x32_bf16 v[192:195], v[204:207], v[160:163], v[192:195]
    v_mfma_f32_16x16x32_bf16 v[196:199], v[204:207], v[176:179], v[196:199]
    s_waitcnt vmcnt(1)
    v_mfma_f32_16x16x32_bf16 v[184:187], v[208:211], v[164:167], v[184:187]
    v_mfma_f32_16x16x32_bf16 v[188:191], v[208:211], v[180:183], v[188:191]
    s_waitcnt vmcnt(0)
    v_mfma_f32_16x16x32_bf16 v[192:195], v[212:215], v[164:167], v[192:195]
    v_mfma_f32_16x16x32_bf16 v[196:199], v[212:215], v[180:183], v[196:199]
    s_nop 3
    v_exp_f32 v184, v184
    v_exp_f32 v185, v185
    v_add_f32 v9, v9, v184
    v_add_f32 v9, v9, v185
    v_cvt_pk_bf16_f32 v72, v184, v185
    v_exp_f32 v186, v186
    v_exp_f32 v187, v187
    v_add_f32 v9, v9, v186
    v_add_f32 v9, v9, v187
    v_cvt_pk_bf16_f32 v73, v186, v187
    v_exp_f32 v188, v188
    v_exp_f32 v189, v189
    v_add_f32 v10, v10, v188
    v_add_f32 v10, v10, v189
    v_cvt_pk_bf16_f32 v76, v188, v189
    v_exp_f32 v190, v190
    v_exp_f32 v191, v191
    v_add_f32 v10, v10, v190
    v_add_f32 v10, v10, v191
    v_cvt_pk_bf16_f32 v77, v190, v191
    v_exp_f32 v192, v192
    v_exp_f32 v193, v193
    v_add_f32 v9, v9, v192
    v_add_f32 v9, v9, v193
    v_cvt_pk_bf16_f32 v74, v192, v193
    v_exp_f32 v194, v194
    v_exp_f32 v195, v195
    v_add_f32 v9, v9, v194
    v_add_f32 v9, v9, v195
    v_cvt_pk_bf16_f32 v75, v194, v195
    v_exp_f32 v196, v196
    v_exp_f32 v197, v197
    v_add_f32 v10, v10, v196
    v_add_f32 v10, v10, v197
    v_cvt_pk_bf16_f32 v78, v196, v197
    v_exp_f32 v198, v198
    v_exp_f32 v199, v199
    v_add_f32 v10, v10, v198
    v_add_f32 v10, v10, v199
    v_cvt_pk_bf16_f32 v79, v198, v199
    s_mov_b32 s17, 0xe000
    buffer_load_dwordx4 v[200:203], v8, s[8:11], s17 offen offset:0
    buffer_load_dwordx4 v[204:207], v8, s[8:11], s17 offen offset:1024
    buffer_load_dwordx4 v[208:211], v8, s[8:11], s17 offen offset:2048
    buffer_load_dwordx4 v[212:215], v8, s[8:11], s17 offen offset:3072
    s_waitcnt vmcnt(3)
    v_mfma_f32_16x16x32_bf16 v[184:187], v[200:203], v[152:155], v[216:219]
    v_mfma_f32_16x16x32_bf16 v[188:191], v[200:203], v[168:171], v[220:223]
    s_waitcnt vmcnt(2)
    v_mfma_f32_16x16x32_bf16 v[192:195], v[204:207], v[152:155], v[216:219]
    v_mfma_f32_16x16x32_bf16 v[196:199], v[204:207], v[168:171], v[220:223]
    s_waitcnt vmcnt(1)
    v_mfma_f32_16x16x32_bf16 v[184:187], v[208:211], v[156:159], v[184:187]
    v_mfma_f32_16x16x32_bf16 v[188:191], v[208:211], v[172:175], v[188:191]
    s_waitcnt vmcnt(0)
    v_mfma_f32_16x16x32_bf16 v[192:195], v[212:215], v[156:159], v[192:195]
    v_mfma_f32_16x16x32_bf16 v[196:199], v[212:215], v[172:175], v[196:199]
    s_mov_b32 s17, 0xf000
    buffer_load_dwordx4 v[200:203], v8, s[8:11], s17 offen offset:0
    buffer_load_dwordx4 v[204:207], v8, s[8:11], s17 offen offset:1024
    buffer_load_dwordx4 v[208:211], v8, s[8:11], s17 offen offset:2048
    buffer_load_dwordx4 v[212:215], v8, s[8:11], s17 offen offset:3072
    s_waitcnt vmcnt(3)
    v_mfma_f32_16x16x32_bf16 v[184:187], v[200:203], v[160:163], v[184:187]
    v_mfma_f32_16x16x32_bf16 v[188:191], v[200:203], v[176:179], v[188:191]
    s_waitcnt vmcnt(2)
    v_mfma_f32_16x16x32_bf16 v[192:195], v[204:207], v[160:163], v[192:195]
    v_mfma_f32_16x16x32_bf16 v[196:199], v[204:207], v[176:179], v[196:199]
    s_waitcnt vmcnt(1)
    v_mfma_f32_16x16x32_bf16 v[184:187], v[208:211], v[164:167], v[184:187]
    v_mfma_f32_16x16x32_bf16 v[188:191], v[208:211], v[180:183], v[188:191]
    s_waitcnt vmcnt(0)
    v_mfma_f32_16x16x32_bf16 v[192:195], v[212:215], v[164:167], v[192:195]
    v_mfma_f32_16x16x32_bf16 v[196:199], v[212:215], v[180:183], v[196:199]
    s_nop 3
    v_exp_f32 v184, v184
    v_exp_f32 v185, v185
    v_add_f32 v9, v9, v184
    v_add_f32 v9, v9, v185
    v_cvt_pk_bf16_f32 v80, v184, v185
    v_exp_f32 v186, v186
    v_exp_f32 v187, v187
    v_add_f32 v9, v9, v186
    v_add_f32 v9, v9, v187
    v_cvt_pk_bf16_f32 v81, v186, v187
    v_exp_f32 v188, v188
    v_exp_f32 v189, v189
    v_add_f32 v10, v10, v188
    v_add_f32 v10, v10, v189
    v_cvt_pk_bf16_f32 v84, v188, v189
    v_exp_f32 v190, v190
    v_exp_f32 v191, v191
    v_add_f32 v10, v10, v190
    v_add_f32 v10, v10, v191
    v_cvt_pk_bf16_f32 v85, v190, v191
    v_exp_f32 v192, v192
    v_exp_f32 v193, v193
    v_add_f32 v9, v9, v192
    v_add_f32 v9, v9, v193
    v_cvt_pk_bf16_f32 v82, v192, v193
    v_exp_f32 v194, v194
    v_exp_f32 v195, v195
    v_add_f32 v9, v9, v194
    v_add_f32 v9, v9, v195
    v_cvt_pk_bf16_f32 v83, v194, v195
    v_exp_f32 v196, v196
    v_exp_f32 v197, v197
    v_add_f32 v10, v10, v196
    v_add_f32 v10, v10, v197
    v_cvt_pk_bf16_f32 v86, v196, v197
    v_exp_f32 v198, v198
    v_exp_f32 v199, v199
    v_add_f32 v10, v10, v198
    v_add_f32 v10, v10, v199
    v_cvt_pk_bf16_f32 v87, v198, v199
    s_mov_b32 s17, 0x10000
    buffer_load_dwordx4 v[200:203], v8, s[8:11], s17 offen offset:0
    buffer_load_dwordx4 v[204:207], v8, s[8:11], s17 offen offset:1024
    buffer_load_dwordx4 v[208:211], v8, s[8:11], s17 offen offset:2048
    buffer_load_dwordx4 v[212:215], v8, s[8:11], s17 offen offset:3072
    s_waitcnt vmcnt(3)
    v_mfma_f32_16x16x32_bf16 v[184:187], v[200:203], v[152:155], v[216:219]
    v_mfma_f32_16x16x32_bf16 v[188:191], v[200:203], v[168:171], v[220:223]
    s_waitcnt vmcnt(2)
    v_mfma_f32_16x16x32_bf16 v[192:195], v[204:207], v[152:155], v[216:219]
    v_mfma_f32_16x16x32_bf16 v[196:199], v[204:207], v[168:171], v[220:223]
    s_waitcnt vmcnt(1)
    v_mfma_f32_16x16x32_bf16 v[184:187], v[208:211], v[156:159], v[184:187]
    v_mfma_f32_16x16x32_bf16 v[188:191], v[208:211], v[172:175], v[188:191]
    s_waitcnt vmcnt(0)
    v_mfma_f32_16x16x32_bf16 v[192:195], v[212:215], v[156:159], v[192:195]
    v_mfma_f32_16x16x32_bf16 v[196:199], v[212:215], v[172:175], v[196:199]
    s_mov_b32 s17, 0x11000
    buffer_load_dwordx4 v[200:203], v8, s[8:11], s17 offen offset:0
    buffer_load_dwordx4 v[204:207], v8, s[8:11], s17 offen offset:1024
    buffer_load_dwordx4 v[208:211], v8, s[8:11], s17 offen offset:2048
    buffer_load_dwordx4 v[212:215], v8, s[8:11], s17 offen offset:3072
    s_waitcnt vmcnt(3)
    v_mfma_f32_16x16x32_bf16 v[184:187], v[200:203], v[160:163], v[184:187]
    v_mfma_f32_16x16x32_bf16 v[188:191], v[200:203], v[176:179], v[188:191]
    s_waitcnt vmcnt(2)
    v_mfma_f32_16x16x32_bf16 v[192:195], v[204:207], v[160:163], v[192:195]
    v_mfma_f32_16x16x32_bf16 v[196:199], v[204:207], v[176:179], v[196:199]
    s_waitcnt vmcnt(1)
    v_mfma_f32_16x16x32_bf16 v[184:187], v[208:211], v[164:167], v[184:187]
    v_mfma_f32_16x16x32_bf16 v[188:191], v[208:211], v[180:183], v[188:191]
    s_waitcnt vmcnt(0)
    v_mfma_f32_16x16x32_bf16 v[192:195], v[212:215], v[164:167], v[192:195]
    v_mfma_f32_16x16x32_bf16 v[196:199], v[212:215], v[180:183], v[196:199]
    s_nop 3
    v_exp_f32 v184, v184
    v_exp_f32 v185, v185
    v_add_f32 v9, v9, v184
    v_add_f32 v9, v9, v185
    v_cvt_pk_bf16_f32 v88, v184, v185
    v_exp_f32 v186, v186
    v_exp_f32 v187, v187
    v_add_f32 v9, v9, v186
    v_add_f32 v9, v9, v187
    v_cvt_pk_bf16_f32 v89, v186, v187
    v_exp_f32 v188, v188
    v_exp_f32 v189, v189
    v_add_f32 v10, v10, v188
    v_add_f32 v10, v10, v189
    v_cvt_pk_bf16_f32 v92, v188, v189
    v_exp_f32 v190, v190
    v_exp_f32 v191, v191
    v_add_f32 v10, v10, v190
    v_add_f32 v10, v10, v191
    v_cvt_pk_bf16_f32 v93, v190, v191
    v_exp_f32 v192, v192
    v_exp_f32 v193, v193
    v_add_f32 v9, v9, v192
    v_add_f32 v9, v9, v193
    v_cvt_pk_bf16_f32 v90, v192, v193
    v_exp_f32 v194, v194
    v_exp_f32 v195, v195
    v_add_f32 v9, v9, v194
    v_add_f32 v9, v9, v195
    v_cvt_pk_bf16_f32 v91, v194, v195
    v_exp_f32 v196, v196
    v_exp_f32 v197, v197
    v_add_f32 v10, v10, v196
    v_add_f32 v10, v10, v197
    v_cvt_pk_bf16_f32 v94, v196, v197
    v_exp_f32 v198, v198
    v_exp_f32 v199, v199
    v_add_f32 v10, v10, v198
    v_add_f32 v10, v10, v199
    v_cvt_pk_bf16_f32 v95, v198, v199
    s_mov_b32 s17, 0x12000
    buffer_load_dwordx4 v[200:203], v8, s[8:11], s17 offen offset:0
    buffer_load_dwordx4 v[204:207], v8, s[8:11], s17 offen offset:1024
    buffer_load_dwordx4 v[208:211], v8, s[8:11], s17 offen offset:2048
    buffer_load_dwordx4 v[212:215], v8, s[8:11], s17 offen offset:3072
    s_waitcnt vmcnt(3)
    v_mfma_f32_16x16x32_bf16 v[184:187], v[200:203], v[152:155], v[216:219]
    v_mfma_f32_16x16x32_bf16 v[188:191], v[200:203], v[168:171], v[220:223]
    s_waitcnt vmcnt(2)
    v_mfma_f32_16x16x32_bf16 v[192:195], v[204:207], v[152:155], v[216:219]
    v_mfma_f32_16x16x32_bf16 v[196:199], v[204:207], v[168:171], v[220:223]
    s_waitcnt vmcnt(1)
    v_mfma_f32_16x16x32_bf16 v[184:187], v[208:211], v[156:159], v[184:187]
    v_mfma_f32_16x16x32_bf16 v[188:191], v[208:211], v[172:175], v[188:191]
    s_waitcnt vmcnt(0)
    v_mfma_f32_16x16x32_bf16 v[192:195], v[212:215], v[156:159], v[192:195]
    v_mfma_f32_16x16x32_bf16 v[196:199], v[212:215], v[172:175], v[196:199]
    s_mov_b32 s17, 0x13000
    buffer_load_dwordx4 v[200:203], v8, s[8:11], s17 offen offset:0
    buffer_load_dwordx4 v[204:207], v8, s[8:11], s17 offen offset:1024
    buffer_load_dwordx4 v[208:211], v8, s[8:11], s17 offen offset:2048
    buffer_load_dwordx4 v[212:215], v8, s[8:11], s17 offen offset:3072
    s_waitcnt vmcnt(3)
    v_mfma_f32_16x16x32_bf16 v[184:187], v[200:203], v[160:163], v[184:187]
    v_mfma_f32_16x16x32_bf16 v[188:191], v[200:203], v[176:179], v[188:191]
    s_waitcnt vmcnt(2)
    v_mfma_f32_16x16x32_bf16 v[192:195], v[204:207], v[160:163], v[192:195]
    v_mfma_f32_16x16x32_bf16 v[196:199], v[204:207], v[176:179], v[196:199]
    s_waitcnt vmcnt(1)
    v_mfma_f32_16x16x32_bf16 v[184:187], v[208:211], v[164:167], v[184:187]
    v_mfma_f32_16x16x32_bf16 v[188:191], v[208:211], v[180:183], v[188:191]
    s_waitcnt vmcnt(0)
    v_mfma_f32_16x16x32_bf16 v[192:195], v[212:215], v[164:167], v[192:195]
    v_mfma_f32_16x16x32_bf16 v[196:199], v[212:215], v[180:183], v[196:199]
    s_nop 3
    v_exp_f32 v184, v184
    v_exp_f32 v185, v185
    v_add_f32 v9, v9, v184
    v_add_f32 v9, v9, v185
    v_cvt_pk_bf16_f32 v96, v184, v185
    v_exp_f32 v186, v186
    v_exp_f32 v187, v187
    v_add_f32 v9, v9, v186
    v_add_f32 v9, v9, v187
    v_cvt_pk_bf16_f32 v97, v186, v187
    v_exp_f32 v188, v188
    v_exp_f32 v189, v189
    v_add_f32 v10, v10, v188
    v_add_f32 v10, v10, v189
    v_cvt_pk_bf16_f32 v100, v188, v189
    v_exp_f32 v190, v190
    v_exp_f32 v191, v191
    v_add_f32 v10, v10, v190
    v_add_f32 v10, v10, v191
    v_cvt_pk_bf16_f32 v101, v190, v191
    v_exp_f32 v192, v192
    v_exp_f32 v193, v193
    v_add_f32 v9, v9, v192
    v_add_f32 v9, v9, v193
    v_cvt_pk_bf16_f32 v98, v192, v193
    v_exp_f32 v194, v194
    v_exp_f32 v195, v195
    v_add_f32 v9, v9, v194
    v_add_f32 v9, v9, v195
    v_cvt_pk_bf16_f32 v99, v194, v195
    v_exp_f32 v196, v196
    v_exp_f32 v197, v197
    v_add_f32 v10, v10, v196
    v_add_f32 v10, v10, v197
    v_cvt_pk_bf16_f32 v102, v196, v197
    v_exp_f32 v198, v198
    v_exp_f32 v199, v199
    v_add_f32 v10, v10, v198
    v_add_f32 v10, v10, v199
    v_cvt_pk_bf16_f32 v103, v198, v199
    s_mov_b32 s17, 0x14000
    buffer_load_dwordx4 v[200:203], v8, s[8:11], s17 offen offset:0
    buffer_load_dwordx4 v[204:207], v8, s[8:11], s17 offen offset:1024
    buffer_load_dwordx4 v[208:211], v8, s[8:11], s17 offen offset:2048
    buffer_load_dwordx4 v[212:215], v8, s[8:11], s17 offen offset:3072
    s_waitcnt vmcnt(3)
    v_mfma_f32_16x16x32_bf16 v[184:187], v[200:203], v[152:155], v[216:219]
    v_mfma_f32_16x16x32_bf16 v[188:191], v[200:203], v[168:171], v[220:223]
    s_waitcnt vmcnt(2)
    v_mfma_f32_16x16x32_bf16 v[192:195], v[204:207], v[152:155], v[216:219]
    v_mfma_f32_16x16x32_bf16 v[196:199], v[204:207], v[168:171], v[220:223]
    s_waitcnt vmcnt(1)
    v_mfma_f32_16x16x32_bf16 v[184:187], v[208:211], v[156:159], v[184:187]
    v_mfma_f32_16x16x32_bf16 v[188:191], v[208:211], v[172:175], v[188:191]
    s_waitcnt vmcnt(0)
    v_mfma_f32_16x16x32_bf16 v[192:195], v[212:215], v[156:159], v[192:195]
    v_mfma_f32_16x16x32_bf16 v[196:199], v[212:215], v[172:175], v[196:199]
    s_mov_b32 s17, 0x15000
    buffer_load_dwordx4 v[200:203], v8, s[8:11], s17 offen offset:0
    buffer_load_dwordx4 v[204:207], v8, s[8:11], s17 offen offset:1024
    buffer_load_dwordx4 v[208:211], v8, s[8:11], s17 offen offset:2048
    buffer_load_dwordx4 v[212:215], v8, s[8:11], s17 offen offset:3072
    s_waitcnt vmcnt(3)
    v_mfma_f32_16x16x32_bf16 v[184:187], v[200:203], v[160:163], v[184:187]
    v_mfma_f32_16x16x32_bf16 v[188:191], v[200:203], v[176:179], v[188:191]
    s_waitcnt vmcnt(2)
    v_mfma_f32_16x16x32_bf16 v[192:195], v[204:207], v[160:163], v[192:195]
    v_mfma_f32_16x16x32_bf16 v[196:199], v[204:207], v[176:179], v[196:199]
    s_waitcnt vmcnt(1)
    v_mfma_f32_16x16x32_bf16 v[184:187], v[208:211], v[164:167], v[184:187]
    v_mfma_f32_16x16x32_bf16 v[188:191], v[208:211], v[180:183], v[188:191]
    s_waitcnt vmcnt(0)
    v_mfma_f32_16x16x32_bf16 v[192:195], v[212:215], v[164:167], v[192:195]
    v_mfma_f32_16x16x32_bf16 v[196:199], v[212:215], v[180:183], v[196:199]
    s_nop 3
    v_exp_f32 v184, v184
    v_exp_f32 v185, v185
    v_add_f32 v9, v9, v184
    v_add_f32 v9, v9, v185
    v_cvt_pk_bf16_f32 v104, v184, v185
    v_exp_f32 v186, v186
    v_exp_f32 v187, v187
    v_add_f32 v9, v9, v186
    v_add_f32 v9, v9, v187
    v_cvt_pk_bf16_f32 v105, v186, v187
    v_exp_f32 v188, v188
    v_exp_f32 v189, v189
    v_add_f32 v10, v10, v188
    v_add_f32 v10, v10, v189
    v_cvt_pk_bf16_f32 v108, v188, v189
    v_exp_f32 v190, v190
    v_exp_f32 v191, v191
    v_add_f32 v10, v10, v190
    v_add_f32 v10, v10, v191
    v_cvt_pk_bf16_f32 v109, v190, v191
    v_exp_f32 v192, v192
    v_exp_f32 v193, v193
    v_add_f32 v9, v9, v192
    v_add_f32 v9, v9, v193
    v_cvt_pk_bf16_f32 v106, v192, v193
    v_exp_f32 v194, v194
    v_exp_f32 v195, v195
    v_add_f32 v9, v9, v194
    v_add_f32 v9, v9, v195
    v_cvt_pk_bf16_f32 v107, v194, v195
    v_exp_f32 v196, v196
    v_exp_f32 v197, v197
    v_add_f32 v10, v10, v196
    v_add_f32 v10, v10, v197
    v_cvt_pk_bf16_f32 v110, v196, v197
    v_exp_f32 v198, v198
    v_exp_f32 v199, v199
    v_add_f32 v10, v10, v198
    v_add_f32 v10, v10, v199
    v_cvt_pk_bf16_f32 v111, v198, v199
    s_mov_b32 s17, 0x16000
    buffer_load_dwordx4 v[200:203], v8, s[8:11], s17 offen offset:0
    buffer_load_dwordx4 v[204:207], v8, s[8:11], s17 offen offset:1024
    buffer_load_dwordx4 v[208:211], v8, s[8:11], s17 offen offset:2048
    buffer_load_dwordx4 v[212:215], v8, s[8:11], s17 offen offset:3072
    s_waitcnt vmcnt(3)
    v_mfma_f32_16x16x32_bf16 v[184:187], v[200:203], v[152:155], v[216:219]
    v_mfma_f32_16x16x32_bf16 v[188:191], v[200:203], v[168:171], v[220:223]
    s_waitcnt vmcnt(2)
    v_mfma_f32_16x16x32_bf16 v[192:195], v[204:207], v[152:155], v[216:219]
    v_mfma_f32_16x16x32_bf16 v[196:199], v[204:207], v[168:171], v[220:223]
    s_waitcnt vmcnt(1)
    v_mfma_f32_16x16x32_bf16 v[184:187], v[208:211], v[156:159], v[184:187]
    v_mfma_f32_16x16x32_bf16 v[188:191], v[208:211], v[172:175], v[188:191]
    s_waitcnt vmcnt(0)
    v_mfma_f32_16x16x32_bf16 v[192:195], v[212:215], v[156:159], v[192:195]
    v_mfma_f32_16x16x32_bf16 v[196:199], v[212:215], v[172:175], v[196:199]
    s_mov_b32 s17, 0x17000
    buffer_load_dwordx4 v[200:203], v8, s[8:11], s17 offen offset:0
    buffer_load_dwordx4 v[204:207], v8, s[8:11], s17 offen offset:1024
    buffer_load_dwordx4 v[208:211], v8, s[8:11], s17 offen offset:2048
    buffer_load_dwordx4 v[212:215], v8, s[8:11], s17 offen offset:3072
    s_waitcnt vmcnt(3)
    v_mfma_f32_16x16x32_bf16 v[184:187], v[200:203], v[160:163], v[184:187]
    v_mfma_f32_16x16x32_bf16 v[188:191], v[200:203], v[176:179], v[188:191]
    s_waitcnt vmcnt(2)
    v_mfma_f32_16x16x32_bf16 v[192:195], v[204:207], v[160:163], v[192:195]
    v_mfma_f32_16x16x32_bf16 v[196:199], v[204:207], v[176:179], v[196:199]
    s_waitcnt vmcnt(1)
    v_mfma_f32_16x16x32_bf16 v[184:187], v[208:211], v[164:167], v[184:187]
    v_mfma_f32_16x16x32_bf16 v[188:191], v[208:211], v[180:183], v[188:191]
    s_waitcnt vmcnt(0)
    v_mfma_f32_16x16x32_bf16 v[192:195], v[212:215], v[164:167], v[192:195]
    v_mfma_f32_16x16x32_bf16 v[196:199], v[212:215], v[180:183], v[196:199]
    s_nop 3
    v_exp_f32 v184, v184
    v_exp_f32 v185, v185
    v_add_f32 v9, v9, v184
    v_add_f32 v9, v9, v185
    v_cvt_pk_bf16_f32 v112, v184, v185
    v_exp_f32 v186, v186
    v_exp_f32 v187, v187
    v_add_f32 v9, v9, v186
    v_add_f32 v9, v9, v187
    v_cvt_pk_bf16_f32 v113, v186, v187
    v_exp_f32 v188, v188
    v_exp_f32 v189, v189
    v_add_f32 v10, v10, v188
    v_add_f32 v10, v10, v189
    v_cvt_pk_bf16_f32 v116, v188, v189
    v_exp_f32 v190, v190
    v_exp_f32 v191, v191
    v_add_f32 v10, v10, v190
    v_add_f32 v10, v10, v191
    v_cvt_pk_bf16_f32 v117, v190, v191
    v_exp_f32 v192, v192
    v_exp_f32 v193, v193
    v_add_f32 v9, v9, v192
    v_add_f32 v9, v9, v193
    v_cvt_pk_bf16_f32 v114, v192, v193
    v_exp_f32 v194, v194
    v_exp_f32 v195, v195
    v_add_f32 v9, v9, v194
    v_add_f32 v9, v9, v195
    v_cvt_pk_bf16_f32 v115, v194, v195
    v_exp_f32 v196, v196
    v_exp_f32 v197, v197
    v_add_f32 v10, v10, v196
    v_add_f32 v10, v10, v197
    v_cvt_pk_bf16_f32 v118, v196, v197
    v_exp_f32 v198, v198
    v_exp_f32 v199, v199
    v_add_f32 v10, v10, v198
    v_add_f32 v10, v10, v199
    v_cvt_pk_bf16_f32 v119, v198, v199
    s_mov_b32 s17, 0x18000
    buffer_load_dwordx4 v[200:203], v8, s[8:11], s17 offen offset:0
    buffer_load_dwordx4 v[204:207], v8, s[8:11], s17 offen offset:1024
    buffer_load_dwordx4 v[208:211], v8, s[8:11], s17 offen offset:2048
    buffer_load_dwordx4 v[212:215], v8, s[8:11], s17 offen offset:3072
    s_waitcnt vmcnt(3)
    v_mfma_f32_16x16x32_bf16 v[184:187], v[200:203], v[152:155], v[216:219]
    v_mfma_f32_16x16x32_bf16 v[188:191], v[200:203], v[168:171], v[220:223]
    s_waitcnt vmcnt(2)
    v_mfma_f32_16x16x32_bf16 v[192:195], v[204:207], v[152:155], v[216:219]
    v_mfma_f32_16x16x32_bf16 v[196:199], v[204:207], v[168:171], v[220:223]
    s_waitcnt vmcnt(1)
    v_mfma_f32_16x16x32_bf16 v[184:187], v[208:211], v[156:159], v[184:187]
    v_mfma_f32_16x16x32_bf16 v[188:191], v[208:211], v[172:175], v[188:191]
    s_waitcnt vmcnt(0)
    v_mfma_f32_16x16x32_bf16 v[192:195], v[212:215], v[156:159], v[192:195]
    v_mfma_f32_16x16x32_bf16 v[196:199], v[212:215], v[172:175], v[196:199]
    s_mov_b32 s17, 0x19000
    buffer_load_dwordx4 v[200:203], v8, s[8:11], s17 offen offset:0
    buffer_load_dwordx4 v[204:207], v8, s[8:11], s17 offen offset:1024
    buffer_load_dwordx4 v[208:211], v8, s[8:11], s17 offen offset:2048
    buffer_load_dwordx4 v[212:215], v8, s[8:11], s17 offen offset:3072
    s_waitcnt vmcnt(3)
    v_mfma_f32_16x16x32_bf16 v[184:187], v[200:203], v[160:163], v[184:187]
    v_mfma_f32_16x16x32_bf16 v[188:191], v[200:203], v[176:179], v[188:191]
    s_waitcnt vmcnt(2)
    v_mfma_f32_16x16x32_bf16 v[192:195], v[204:207], v[160:163], v[192:195]
    v_mfma_f32_16x16x32_bf16 v[196:199], v[204:207], v[176:179], v[196:199]
    s_waitcnt vmcnt(1)
    v_mfma_f32_16x16x32_bf16 v[184:187], v[208:211], v[164:167], v[184:187]
    v_mfma_f32_16x16x32_bf16 v[188:191], v[208:211], v[180:183], v[188:191]
    s_waitcnt vmcnt(0)
    v_mfma_f32_16x16x32_bf16 v[192:195], v[212:215], v[164:167], v[192:195]
    v_mfma_f32_16x16x32_bf16 v[196:199], v[212:215], v[180:183], v[196:199]
    s_nop 3
    v_exp_f32 v184, v184
    v_exp_f32 v185, v185
    v_add_f32 v9, v9, v184
    v_add_f32 v9, v9, v185
    v_cvt_pk_bf16_f32 v120, v184, v185
    v_exp_f32 v186, v186
    v_exp_f32 v187, v187
    v_add_f32 v9, v9, v186
    v_add_f32 v9, v9, v187
    v_cvt_pk_bf16_f32 v121, v186, v187
    v_exp_f32 v188, v188
    v_exp_f32 v189, v189
    v_add_f32 v10, v10, v188
    v_add_f32 v10, v10, v189
    v_cvt_pk_bf16_f32 v124, v188, v189
    v_exp_f32 v190, v190
    v_exp_f32 v191, v191
    v_add_f32 v10, v10, v190
    v_add_f32 v10, v10, v191
    v_cvt_pk_bf16_f32 v125, v190, v191
    v_exp_f32 v192, v192
    v_exp_f32 v193, v193
    v_add_f32 v9, v9, v192
    v_add_f32 v9, v9, v193
    v_cvt_pk_bf16_f32 v122, v192, v193
    v_exp_f32 v194, v194
    v_exp_f32 v195, v195
    v_add_f32 v9, v9, v194
    v_add_f32 v9, v9, v195
    v_cvt_pk_bf16_f32 v123, v194, v195
    v_exp_f32 v196, v196
    v_exp_f32 v197, v197
    v_add_f32 v10, v10, v196
    v_add_f32 v10, v10, v197
    v_cvt_pk_bf16_f32 v126, v196, v197
    v_exp_f32 v198, v198
    v_exp_f32 v199, v199
    v_add_f32 v10, v10, v198
    v_add_f32 v10, v10, v199
    v_cvt_pk_bf16_f32 v127, v198, v199
    s_mov_b32 s17, 0x1a000
    buffer_load_dwordx4 v[200:203], v8, s[8:11], s17 offen offset:0
    buffer_load_dwordx4 v[204:207], v8, s[8:11], s17 offen offset:1024
    buffer_load_dwordx4 v[208:211], v8, s[8:11], s17 offen offset:2048
    buffer_load_dwordx4 v[212:215], v8, s[8:11], s17 offen offset:3072
    s_waitcnt vmcnt(3)
    v_mfma_f32_16x16x32_bf16 v[184:187], v[200:203], v[152:155], v[216:219]
    v_mfma_f32_16x16x32_bf16 v[188:191], v[200:203], v[168:171], v[220:223]
    s_waitcnt vmcnt(2)
    v_mfma_f32_16x16x32_bf16 v[192:195], v[204:207], v[152:155], v[216:219]
    v_mfma_f32_16x16x32_bf16 v[196:199], v[204:207], v[168:171], v[220:223]
    s_waitcnt vmcnt(1)
    v_mfma_f32_16x16x32_bf16 v[184:187], v[208:211], v[156:159], v[184:187]
    v_mfma_f32_16x16x32_bf16 v[188:191], v[208:211], v[172:175], v[188:191]
    s_waitcnt vmcnt(0)
    v_mfma_f32_16x16x32_bf16 v[192:195], v[212:215], v[156:159], v[192:195]
    v_mfma_f32_16x16x32_bf16 v[196:199], v[212:215], v[172:175], v[196:199]
    s_mov_b32 s17, 0x1b000
    buffer_load_dwordx4 v[200:203], v8, s[8:11], s17 offen offset:0
    buffer_load_dwordx4 v[204:207], v8, s[8:11], s17 offen offset:1024
    buffer_load_dwordx4 v[208:211], v8, s[8:11], s17 offen offset:2048
    buffer_load_dwordx4 v[212:215], v8, s[8:11], s17 offen offset:3072
    s_waitcnt vmcnt(3)
    v_mfma_f32_16x16x32_bf16 v[184:187], v[200:203], v[160:163], v[184:187]
    v_mfma_f32_16x16x32_bf16 v[188:191], v[200:203], v[176:179], v[188:191]
    s_waitcnt vmcnt(2)
    v_mfma_f32_16x16x32_bf16 v[192:195], v[204:207], v[160:163], v[192:195]
    v_mfma_f32_16x16x32_bf16 v[196:199], v[204:207], v[176:179], v[196:199]
    s_waitcnt vmcnt(1)
    v_mfma_f32_16x16x32_bf16 v[184:187], v[208:211], v[164:167], v[184:187]
    v_mfma_f32_16x16x32_bf16 v[188:191], v[208:211], v[180:183], v[188:191]
    s_waitcnt vmcnt(0)
    v_mfma_f32_16x16x32_bf16 v[192:195], v[212:215], v[164:167], v[192:195]
    v_mfma_f32_16x16x32_bf16 v[196:199], v[212:215], v[180:183], v[196:199]
    s_nop 3
    v_exp_f32 v184, v184
    v_exp_f32 v185, v185
    v_add_f32 v9, v9, v184
    v_add_f32 v9, v9, v185
    v_cvt_pk_bf16_f32 v128, v184, v185
    v_exp_f32 v186, v186
    v_exp_f32 v187, v187
    v_add_f32 v9, v9, v186
    v_add_f32 v9, v9, v187
    v_cvt_pk_bf16_f32 v129, v186, v187
    v_exp_f32 v188, v188
    v_exp_f32 v189, v189
    v_add_f32 v10, v10, v188
    v_add_f32 v10, v10, v189
    v_cvt_pk_bf16_f32 v132, v188, v189
    v_exp_f32 v190, v190
    v_exp_f32 v191, v191
    v_add_f32 v10, v10, v190
    v_add_f32 v10, v10, v191
    v_cvt_pk_bf16_f32 v133, v190, v191
    v_exp_f32 v192, v192
    v_exp_f32 v193, v193
    v_add_f32 v9, v9, v192
    v_add_f32 v9, v9, v193
    v_cvt_pk_bf16_f32 v130, v192, v193
    v_exp_f32 v194, v194
    v_exp_f32 v195, v195
    v_add_f32 v9, v9, v194
    v_add_f32 v9, v9, v195
    v_cvt_pk_bf16_f32 v131, v194, v195
    v_exp_f32 v196, v196
    v_exp_f32 v197, v197
    v_add_f32 v10, v10, v196
    v_add_f32 v10, v10, v197
    v_cvt_pk_bf16_f32 v134, v196, v197
    v_exp_f32 v198, v198
    v_exp_f32 v199, v199
    v_add_f32 v10, v10, v198
    v_add_f32 v10, v10, v199
    v_cvt_pk_bf16_f32 v135, v198, v199
    s_mov_b32 s17, 0x1c000
    buffer_load_dwordx4 v[200:203], v8, s[8:11], s17 offen offset:0
    buffer_load_dwordx4 v[204:207], v8, s[8:11], s17 offen offset:1024
    buffer_load_dwordx4 v[208:211], v8, s[8:11], s17 offen offset:2048
    buffer_load_dwordx4 v[212:215], v8, s[8:11], s17 offen offset:3072
    s_waitcnt vmcnt(3)
    v_mfma_f32_16x16x32_bf16 v[184:187], v[200:203], v[152:155], v[216:219]
    v_mfma_f32_16x16x32_bf16 v[188:191], v[200:203], v[168:171], v[220:223]
    s_waitcnt vmcnt(2)
    v_mfma_f32_16x16x32_bf16 v[192:195], v[204:207], v[152:155], v[216:219]
    v_mfma_f32_16x16x32_bf16 v[196:199], v[204:207], v[168:171], v[220:223]
    s_waitcnt vmcnt(1)
    v_mfma_f32_16x16x32_bf16 v[184:187], v[208:211], v[156:159], v[184:187]
    v_mfma_f32_16x16x32_bf16 v[188:191], v[208:211], v[172:175], v[188:191]
    s_waitcnt vmcnt(0)
    v_mfma_f32_16x16x32_bf16 v[192:195], v[212:215], v[156:159], v[192:195]
    v_mfma_f32_16x16x32_bf16 v[196:199], v[212:215], v[172:175], v[196:199]
    s_mov_b32 s17, 0x1d000
    buffer_load_dwordx4 v[200:203], v8, s[8:11], s17 offen offset:0
    buffer_load_dwordx4 v[204:207], v8, s[8:11], s17 offen offset:1024
    buffer_load_dwordx4 v[208:211], v8, s[8:11], s17 offen offset:2048
    buffer_load_dwordx4 v[212:215], v8, s[8:11], s17 offen offset:3072
    s_waitcnt vmcnt(3)
    v_mfma_f32_16x16x32_bf16 v[184:187], v[200:203], v[160:163], v[184:187]
    v_mfma_f32_16x16x32_bf16 v[188:191], v[200:203], v[176:179], v[188:191]
    s_waitcnt vmcnt(2)
    v_mfma_f32_16x16x32_bf16 v[192:195], v[204:207], v[160:163], v[192:195]
    v_mfma_f32_16x16x32_bf16 v[196:199], v[204:207], v[176:179], v[196:199]
    s_waitcnt vmcnt(1)
    v_mfma_f32_16x16x32_bf16 v[184:187], v[208:211], v[164:167], v[184:187]
    v_mfma_f32_16x16x32_bf16 v[188:191], v[208:211], v[180:183], v[188:191]
    s_waitcnt vmcnt(0)
    v_mfma_f32_16x16x32_bf16 v[192:195], v[212:215], v[164:167], v[192:195]
    v_mfma_f32_16x16x32_bf16 v[196:199], v[212:215], v[180:183], v[196:199]
    s_nop 3
    v_exp_f32 v184, v184
    v_exp_f32 v185, v185
    v_add_f32 v9, v9, v184
    v_add_f32 v9, v9, v185
    v_cvt_pk_bf16_f32 v136, v184, v185
    v_exp_f32 v186, v186
    v_exp_f32 v187, v187
    v_add_f32 v9, v9, v186
    v_add_f32 v9, v9, v187
    v_cvt_pk_bf16_f32 v137, v186, v187
    v_exp_f32 v188, v188
    v_exp_f32 v189, v189
    v_add_f32 v10, v10, v188
    v_add_f32 v10, v10, v189
    v_cvt_pk_bf16_f32 v140, v188, v189
    v_exp_f32 v190, v190
    v_exp_f32 v191, v191
    v_add_f32 v10, v10, v190
    v_add_f32 v10, v10, v191
    v_cvt_pk_bf16_f32 v141, v190, v191
    v_exp_f32 v192, v192
    v_exp_f32 v193, v193
    v_add_f32 v9, v9, v192
    v_add_f32 v9, v9, v193
    v_cvt_pk_bf16_f32 v138, v192, v193
    v_exp_f32 v194, v194
    v_exp_f32 v195, v195
    v_add_f32 v9, v9, v194
    v_add_f32 v9, v9, v195
    v_cvt_pk_bf16_f32 v139, v194, v195
    v_exp_f32 v196, v196
    v_exp_f32 v197, v197
    v_add_f32 v10, v10, v196
    v_add_f32 v10, v10, v197
    v_cvt_pk_bf16_f32 v142, v196, v197
    v_exp_f32 v198, v198
    v_exp_f32 v199, v199
    v_add_f32 v10, v10, v198
    v_add_f32 v10, v10, v199
    v_cvt_pk_bf16_f32 v143, v198, v199
    s_mov_b32 s17, 0x1e000
    buffer_load_dwordx4 v[200:203], v8, s[8:11], s17 offen offset:0
    buffer_load_dwordx4 v[204:207], v8, s[8:11], s17 offen offset:1024
    buffer_load_dwordx4 v[208:211], v8, s[8:11], s17 offen offset:2048
    buffer_load_dwordx4 v[212:215], v8, s[8:11], s17 offen offset:3072
    s_waitcnt vmcnt(3)
    v_mfma_f32_16x16x32_bf16 v[184:187], v[200:203], v[152:155], v[216:219]
    v_mfma_f32_16x16x32_bf16 v[188:191], v[200:203], v[168:171], v[220:223]
    s_waitcnt vmcnt(2)
    v_mfma_f32_16x16x32_bf16 v[192:195], v[204:207], v[152:155], v[216:219]
    v_mfma_f32_16x16x32_bf16 v[196:199], v[204:207], v[168:171], v[220:223]
    s_waitcnt vmcnt(1)
    v_mfma_f32_16x16x32_bf16 v[184:187], v[208:211], v[156:159], v[184:187]
    v_mfma_f32_16x16x32_bf16 v[188:191], v[208:211], v[172:175], v[188:191]
    s_waitcnt vmcnt(0)
    v_mfma_f32_16x16x32_bf16 v[192:195], v[212:215], v[156:159], v[192:195]
    v_mfma_f32_16x16x32_bf16 v[196:199], v[212:215], v[172:175], v[196:199]
    s_mov_b32 s17, 0x1f000
    buffer_load_dwordx4 v[200:203], v8, s[8:11], s17 offen offset:0
    buffer_load_dwordx4 v[204:207], v8, s[8:11], s17 offen offset:1024
    buffer_load_dwordx4 v[208:211], v8, s[8:11], s17 offen offset:2048
    buffer_load_dwordx4 v[212:215], v8, s[8:11], s17 offen offset:3072
    s_waitcnt vmcnt(3)
    v_mfma_f32_16x16x32_bf16 v[184:187], v[200:203], v[160:163], v[184:187]
    v_mfma_f32_16x16x32_bf16 v[188:191], v[200:203], v[176:179], v[188:191]
    s_waitcnt vmcnt(2)
    v_mfma_f32_16x16x32_bf16 v[192:195], v[204:207], v[160:163], v[192:195]
    v_mfma_f32_16x16x32_bf16 v[196:199], v[204:207], v[176:179], v[196:199]
    s_waitcnt vmcnt(1)
    v_mfma_f32_16x16x32_bf16 v[184:187], v[208:211], v[164:167], v[184:187]
    v_mfma_f32_16x16x32_bf16 v[188:191], v[208:211], v[180:183], v[188:191]
    s_waitcnt vmcnt(0)
    v_mfma_f32_16x16x32_bf16 v[192:195], v[212:215], v[164:167], v[192:195]
    v_mfma_f32_16x16x32_bf16 v[196:199], v[212:215], v[180:183], v[196:199]
    s_nop 3
    v_exp_f32 v184, v184
    v_exp_f32 v185, v185
    v_add_f32 v9, v9, v184
    v_add_f32 v9, v9, v185
    v_cvt_pk_bf16_f32 v144, v184, v185
    v_exp_f32 v186, v186
    v_exp_f32 v187, v187
    v_add_f32 v9, v9, v186
    v_add_f32 v9, v9, v187
    v_cvt_pk_bf16_f32 v145, v186, v187
    v_exp_f32 v188, v188
    v_exp_f32 v189, v189
    v_add_f32 v10, v10, v188
    v_add_f32 v10, v10, v189
    v_cvt_pk_bf16_f32 v148, v188, v189
    v_exp_f32 v190, v190
    v_exp_f32 v191, v191
    v_add_f32 v10, v10, v190
    v_add_f32 v10, v10, v191
    v_cvt_pk_bf16_f32 v149, v190, v191
    v_exp_f32 v192, v192
    v_exp_f32 v193, v193
    v_add_f32 v9, v9, v192
    v_add_f32 v9, v9, v193
    v_cvt_pk_bf16_f32 v146, v192, v193
    v_exp_f32 v194, v194
    v_exp_f32 v195, v195
    v_add_f32 v9, v9, v194
    v_add_f32 v9, v9, v195
    v_cvt_pk_bf16_f32 v147, v194, v195
    v_exp_f32 v196, v196
    v_exp_f32 v197, v197
    v_add_f32 v10, v10, v196
    v_add_f32 v10, v10, v197
    v_cvt_pk_bf16_f32 v150, v196, v197
    v_exp_f32 v198, v198
    v_exp_f32 v199, v199
    v_add_f32 v10, v10, v198
    v_add_f32 v10, v10, v199
    v_cvt_pk_bf16_f32 v151, v198, v199
    v_mov_b32 v16, v9
    v_mov_b32 v18, v10
    s_nop 0
    v_permlane16_swap_b32 v9, v16
    v_permlane16_swap_b32 v10, v18
    v_add_f32 v9, v9, v16
    v_add_f32 v10, v10, v18
    v_mov_b32 v16, v9
    v_mov_b32 v18, v10
    s_nop 0
    v_permlane32_swap_b32 v9, v16
    v_permlane32_swap_b32 v10, v18
    v_add_f32 v9, v9, v16
    v_add_f32 v10, v10, v18
    s_waitcnt vmcnt(0) lgkmcnt(0)
    s_nop 15
    s_nop 3
    s_branch adaLN_cond__sliding_block_cached__moe_arch_mod__prompt_kernel_fixAb
adaLN_cond__sliding_block_cached__moe_arch_mod__prompt_kernel_mp5r:
    s_waitcnt vmcnt(0) lgkmcnt(0)
    s_nop 15
    s_nop 3
    s_mov_b32 s27, 0
adaLN_cond__sliding_block_cached__moe_arch_mod__prompt_kernel_mp5p:
    buffer_load_dword v248, v250, s[8:11], s14 offen sc1
    s_waitcnt vmcnt(0)
    v_cmp_ne_u32 vcc, s28, v248
    s_add_u32 s27, s27, 1
    s_cmp_ge_u32 s27, 65536
    s_cbranch_scc1 adaLN_cond__sliding_block_cached__moe_arch_mod__prompt_kernel_mp5g
    s_cbranch_vccnz adaLN_cond__sliding_block_cached__moe_arch_mod__prompt_kernel_mp5p
adaLN_cond__sliding_block_cached__moe_arch_mod__prompt_kernel_mp5g:
    s_waitcnt vmcnt(0) lgkmcnt(0)
    s_nop 15
    s_nop 3
    s_branch adaLN_cond__sliding_block_cached__moe_arch_mod__prompt_kernel_mp5b
adaLN_cond__sliding_block_cached__moe_arch_mod__prompt_kernel_o6r:
    s_waitcnt vmcnt(0) lgkmcnt(0)
    s_nop 15
    s_nop 3
    s_mov_b32 s27, 0
adaLN_cond__sliding_block_cached__moe_arch_mod__prompt_kernel_o6p:
    buffer_load_dword v12, v13, s[8:11], s19 offen sc1
    s_waitcnt vmcnt(0)
    v_cmp_ne_u32 vcc, s28, v12
    s_add_u32 s27, s27, 1
    s_cmp_ge_u32 s27, 65536
    s_cbranch_scc1 adaLN_cond__sliding_block_cached__moe_arch_mod__prompt_kernel_o6g
    s_cbranch_vccnz adaLN_cond__sliding_block_cached__moe_arch_mod__prompt_kernel_o6p
adaLN_cond__sliding_block_cached__moe_arch_mod__prompt_kernel_o6g:
    s_waitcnt vmcnt(0) lgkmcnt(0)
    s_nop 15
    s_nop 3
    s_branch adaLN_cond__sliding_block_cached__moe_arch_mod__prompt_kernel_o6b
adaLN_cond__sliding_block_cached__moe_arch_mod__prompt_kernel_o27r:
    s_waitcnt vmcnt(0) lgkmcnt(0)
    s_nop 15
    s_nop 3
    s_mov_b32 s27, 0
adaLN_cond__sliding_block_cached__moe_arch_mod__prompt_kernel_o27p:
    buffer_load_dword v12, v13, s[8:11], s19 offen sc1
    s_waitcnt vmcnt(0)
    v_cmp_ne_u32 vcc, s28, v12
    s_add_u32 s27, s27, 1
    s_cmp_ge_u32 s27, 65536
    s_cbranch_scc1 adaLN_cond__sliding_block_cached__moe_arch_mod__prompt_kernel_o27g
    s_cbranch_vccnz adaLN_cond__sliding_block_cached__moe_arch_mod__prompt_kernel_o27p
adaLN_cond__sliding_block_cached__moe_arch_mod__prompt_kernel_o27g:
    s_waitcnt vmcnt(0) lgkmcnt(0)
    s_nop 15
    s_nop 3
    s_branch adaLN_cond__sliding_block_cached__moe_arch_mod__prompt_kernel_o27b
adaLN_cond__sliding_block_cached__moe_arch_mod__prompt_kernel_o28r:
    s_waitcnt vmcnt(0) lgkmcnt(0)
    s_nop 15
    s_nop 3
    s_mov_b32 s27, 0
adaLN_cond__sliding_block_cached__moe_arch_mod__prompt_kernel_o28p:
    buffer_load_dword v12, v13, s[8:11], s19 offen sc1
    s_waitcnt vmcnt(0)
    v_cmp_ne_u32 vcc, s28, v12
    s_add_u32 s27, s27, 1
    s_cmp_ge_u32 s27, 65536
    s_cbranch_scc1 adaLN_cond__sliding_block_cached__moe_arch_mod__prompt_kernel_o28g
    s_cbranch_vccnz adaLN_cond__sliding_block_cached__moe_arch_mod__prompt_kernel_o28p
adaLN_cond__sliding_block_cached__moe_arch_mod__prompt_kernel_o28g:
    s_waitcnt vmcnt(0) lgkmcnt(0)
    s_nop 15
    s_nop 3
    s_branch adaLN_cond__sliding_block_cached__moe_arch_mod__prompt_kernel_o28b
adaLN_cond__sliding_block_cached__moe_arch_mod__prompt_kernel_o29r:
    s_waitcnt vmcnt(0) lgkmcnt(0)
    s_nop 15
    s_nop 3
    s_mov_b32 s27, 0
adaLN_cond__sliding_block_cached__moe_arch_mod__prompt_kernel_o29p:
    buffer_load_dword v12, v13, s[8:11], s19 offen sc1
    s_waitcnt vmcnt(0)
    v_cmp_ne_u32 vcc, s28, v12
    s_add_u32 s27, s27, 1
    s_cmp_ge_u32 s27, 65536
    s_cbranch_scc1 adaLN_cond__sliding_block_cached__moe_arch_mod__prompt_kernel_o29g
    s_cbranch_vccnz adaLN_cond__sliding_block_cached__moe_arch_mod__prompt_kernel_o29p
adaLN_cond__sliding_block_cached__moe_arch_mod__prompt_kernel_o29g:
    s_waitcnt vmcnt(0) lgkmcnt(0)
    s_nop 15
    s_nop 3
    s_branch adaLN_cond__sliding_block_cached__moe_arch_mod__prompt_kernel_o29b
adaLN_cond__sliding_block_cached__moe_arch_mod__prompt_kernel_mf10r:
    s_waitcnt vmcnt(0) lgkmcnt(0)
    s_nop 15
    s_nop 3
    s_mov_b32 s27, 0
adaLN_cond__sliding_block_cached__moe_arch_mod__prompt_kernel_mf10p:
    s_mov_b32 s16, 0x544000
    buffer_load_dwordx4 v[184:187], v2, s[8:11], s16 offen sc1
    s_waitcnt vmcnt(0)
    v_xor_b32 v16, s28, v184
    v_xor_b32 v17, s28, v185
    v_xor_b32 v18, s28, v186
    v_xor_b32 v19, s28, v187
    v_or3_b32 v16, v16, v17, v18
    v_or_b32 v16, v16, v19
    v_cmp_ne_u32 vcc, 0, v16
    s_add_u32 s27, s27, 1
    s_cmp_ge_u32 s27, 65536
    s_cbranch_scc1 adaLN_cond__sliding_block_cached__moe_arch_mod__prompt_kernel_mf10g
    s_cbranch_vccnz adaLN_cond__sliding_block_cached__moe_arch_mod__prompt_kernel_mf10p
adaLN_cond__sliding_block_cached__moe_arch_mod__prompt_kernel_mf10g:
    s_waitcnt vmcnt(0) lgkmcnt(0)
    s_nop 15
    s_nop 3
    s_branch adaLN_cond__sliding_block_cached__moe_arch_mod__prompt_kernel_mf10b
adaLN_cond__sliding_block_cached__moe_arch_mod__prompt_kernel_kv16r:
    s_waitcnt vmcnt(0) lgkmcnt(0)
    s_nop 15
    s_nop 3
    s_mov_b32 s27, 0
adaLN_cond__sliding_block_cached__moe_arch_mod__prompt_kernel_kv16p:
    buffer_load_dwordx4 v[12:15], v21, s[8:11], s18 offen sc1
    s_waitcnt vmcnt(0)
    v_xor_b32 v8, s28, v12
    v_xor_b32 v20, s28, v13
    v_or_b32 v8, v8, v20
    v_xor_b32 v20, s28, v14
    v_or_b32 v8, v8, v20
    v_xor_b32 v20, s28, v15
    v_or_b32 v8, v8, v20
    v_cmp_ne_u32 vcc, 0, v8
    s_add_u32 s27, s27, 1
    s_cmp_ge_u32 s27, 65536
    s_cbranch_scc1 adaLN_cond__sliding_block_cached__moe_arch_mod__prompt_kernel_kv16g
    s_cbranch_vccnz adaLN_cond__sliding_block_cached__moe_arch_mod__prompt_kernel_kv16p
adaLN_cond__sliding_block_cached__moe_arch_mod__prompt_kernel_kv16g:
    s_waitcnt vmcnt(0) lgkmcnt(0)
    s_nop 15
    s_nop 3
    s_branch adaLN_cond__sliding_block_cached__moe_arch_mod__prompt_kernel_kv16b
adaLN_cond__sliding_block_cached__moe_arch_mod__prompt_kernel_fixB:
    s_waitcnt vmcnt(0) lgkmcnt(0)
    s_nop 15
    s_nop 3
    s_lshr_b32 s16, s12, 3
    s_lshl_b32 s16, s16, 17
    s_add_u32 s16, s16, 0x400000
    v_add_u32 v8, s16, v2
    v_mov_b32 v16, 0xff7fffff
    v_mov_b32 v17, 0xff7fffff
    s_mov_b32 s16, 0
adaLN_cond__sliding_block_cached__moe_arch_mod__prompt_kernel_fixBm:
    s_add_u32 s17, s16, 0
    buffer_load_dwordx4 v[200:203], v8, s[8:11], s17 offen offset:0
    buffer_load_dwordx4 v[204:207], v8, s[8:11], s17 offen offset:1024
    buffer_load_dwordx4 v[208:211], v8, s[8:11], s17 offen offset:2048
    buffer_load_dwordx4 v[212:215], v8, s[8:11], s17 offen offset:3072
    s_waitcnt vmcnt(3)
    v_mfma_f32_16x16x32_bf16 v[184:187], v[200:203], v[152:155], 0
    v_mfma_f32_16x16x32_bf16 v[188:191], v[200:203], v[168:171], 0
    s_waitcnt vmcnt(2)
    v_mfma_f32_16x16x32_bf16 v[192:195], v[204:207], v[152:155], 0
    v_mfma_f32_16x16x32_bf16 v[196:199], v[204:207], v[168:171], 0
    s_waitcnt vmcnt(1)
    v_mfma_f32_16x16x32_bf16 v[184:187], v[208:211], v[156:159], v[184:187]
    v_mfma_f32_16x16x32_bf16 v[188:191], v[208:211], v[172:175], v[188:191]
    s_waitcnt vmcnt(0)
    v_mfma_f32_16x16x32_bf16 v[192:195], v[212:215], v[156:159], v[192:195]
    v_mfma_f32_16x16x32_bf16 v[196:199], v[212:215], v[172:175], v[196:199]
    s_add_u32 s17, s16, 4096
    buffer_load_dwordx4 v[200:203], v8, s[8:11], s17 offen offset:0
    buffer_load_dwordx4 v[204:207], v8, s[8:11], s17 offen offset:1024
    buffer_load_dwordx4 v[208:211], v8, s[8:11], s17 offen offset:2048
    buffer_load_dwordx4 v[212:215], v8, s[8:11], s17 offen offset:3072
    s_waitcnt vmcnt(3)
    v_mfma_f32_16x16x32_bf16 v[184:187], v[200:203], v[160:163], v[184:187]
    v_mfma_f32_16x16x32_bf16 v[188:191], v[200:203], v[176:179], v[188:191]
    s_waitcnt vmcnt(2)
    v_mfma_f32_16x16x32_bf16 v[192:195], v[204:207], v[160:163], v[192:195]
    v_mfma_f32_16x16x32_bf16 v[196:199], v[204:207], v[176:179], v[196:199]
    s_waitcnt vmcnt(1)
    v_mfma_f32_16x16x32_bf16 v[184:187], v[208:211], v[164:167], v[184:187]
    v_mfma_f32_16x16x32_bf16 v[188:191], v[208:211], v[180:183], v[188:191]
    s_waitcnt vmcnt(0)
    v_mfma_f32_16x16x32_bf16 v[192:195], v[212:215], v[164:167], v[192:195]
    v_mfma_f32_16x16x32_bf16 v[196:199], v[212:215], v[180:183], v[196:199]
    s_nop 3
    v_max3_f32 v16, v16, v184, v185
    v_max3_f32 v16, v16, v186, v187
    v_max3_f32 v17, v17, v188, v189
    v_max3_f32 v17, v17, v190, v191
    v_max3_f32 v16, v16, v192, v193
    v_max3_f32 v16, v16, v194, v195
    v_max3_f32 v17, v17, v196, v197
    v_max3_f32 v17, v17, v198, v199
    s_add_u32 s16, s16, 8192
    s_cmp_lt_u32 s16, 0x20000
    s_cbranch_scc1 adaLN_cond__sliding_block_cached__moe_arch_mod__prompt_kernel_fixBm
    v_mov_b32 v18, v16
    v_mov_b32 v19, v17
    s_nop 0
    v_permlane16_swap_b32 v16, v18
    v_permlane16_swap_b32 v17, v19
    v_max_f32 v16, v16, v18
    v_max_f32 v17, v17, v19
    v_mov_b32 v18, v16
    v_mov_b32 v19, v17
    s_nop 0
    v_permlane32_swap_b32 v16, v18
    v_permlane32_swap_b32 v17, v19
    v_max_f32 v16, v16, v18
    v_max_f32 v17, v17, v19
    v_sub_f32 v216, 0, v16
    v_sub_f32 v217, 0, v16
    v_sub_f32 v218, 0, v16
    v_sub_f32 v219, 0, v16
    v_sub_f32 v220, 0, v17
    v_sub_f32 v221, 0, v17
    v_sub_f32 v222, 0, v17
    v_sub_f32 v223, 0, v17
    s_mov_b32 s17, 0x0
    buffer_load_dwordx4 v[200:203], v8, s[8:11], s17 offen offset:0
    buffer_load_dwordx4 v[204:207], v8, s[8:11], s17 offen offset:1024
    buffer_load_dwordx4 v[208:211], v8, s[8:11], s17 offen offset:2048
    buffer_load_dwordx4 v[212:215], v8, s[8:11], s17 offen offset:3072
    s_waitcnt vmcnt(3)
    v_mfma_f32_16x16x32_bf16 v[184:187], v[200:203], v[152:155], v[216:219]
    v_mfma_f32_16x16x32_bf16 v[188:191], v[200:203], v[168:171], v[220:223]
    s_waitcnt vmcnt(2)
    v_mfma_f32_16x16x32_bf16 v[192:195], v[204:207], v[152:155], v[216:219]
    v_mfma_f32_16x16x32_bf16 v[196:199], v[204:207], v[168:171], v[220:223]
    s_waitcnt vmcnt(1)
    v_mfma_f32_16x16x32_bf16 v[184:187], v[208:211], v[156:159], v[184:187]
    v_mfma_f32_16x16x32_bf16 v[188:191], v[208:211], v[172:175], v[188:191]
    s_waitcnt vmcnt(0)
    v_mfma_f32_16x16x32_bf16 v[192:195], v[212:215], v[156:159], v[192:195]
    v_mfma_f32_16x16x32_bf16 v[196:199], v[212:215], v[172:175], v[196:199]
    s_mov_b32 s17, 0x1000
    buffer_load_dwordx4 v[200:203], v8, s[8:11], s17 offen offset:0
    buffer_load_dwordx4 v[204:207], v8, s[8:11], s17 offen offset:1024
    buffer_load_dwordx4 v[208:211], v8, s[8:11], s17 offen offset:2048
    buffer_load_dwordx4 v[212:215], v8, s[8:11], s17 offen offset:3072
    s_waitcnt vmcnt(3)
    v_mfma_f32_16x16x32_bf16 v[184:187], v[200:203], v[160:163], v[184:187]
    v_mfma_f32_16x16x32_bf16 v[188:191], v[200:203], v[176:179], v[188:191]
    s_waitcnt vmcnt(2)
    v_mfma_f32_16x16x32_bf16 v[192:195], v[204:207], v[160:163], v[192:195]
    v_mfma_f32_16x16x32_bf16 v[196:199], v[204:207], v[176:179], v[196:199]
    s_waitcnt vmcnt(1)
    v_mfma_f32_16x16x32_bf16 v[184:187], v[208:211], v[164:167], v[184:187]
    v_mfma_f32_16x16x32_bf16 v[188:191], v[208:211], v[180:183], v[188:191]
    s_waitcnt vmcnt(0)
    v_mfma_f32_16x16x32_bf16 v[192:195], v[212:215], v[164:167], v[192:195]
    v_mfma_f32_16x16x32_bf16 v[196:199], v[212:215], v[180:183], v[196:199]
    s_nop 3
    v_exp_f32 v184, v184
    v_exp_f32 v185, v185
    s_nop 0
    v_add_f32 v9, v184, v185
    v_cvt_pk_bf16_f32 v24, v184, v185
    v_exp_f32 v186, v186
    v_exp_f32 v187, v187
    v_add_f32 v9, v9, v186
    v_add_f32 v9, v9, v187
    v_cvt_pk_bf16_f32 v25, v186, v187
    v_exp_f32 v188, v188
    v_exp_f32 v189, v189
    s_nop 0
    v_add_f32 v10, v188, v189
    v_cvt_pk_bf16_f32 v28, v188, v189
    v_exp_f32 v190, v190
    v_exp_f32 v191, v191
    v_add_f32 v10, v10, v190
    v_add_f32 v10, v10, v191
    v_cvt_pk_bf16_f32 v29, v190, v191
    v_exp_f32 v192, v192
    v_exp_f32 v193, v193
    v_add_f32 v9, v9, v192
    v_add_f32 v9, v9, v193
    v_cvt_pk_bf16_f32 v26, v192, v193
    v_exp_f32 v194, v194
    v_exp_f32 v195, v195
    v_add_f32 v9, v9, v194
    v_add_f32 v9, v9, v195
    v_cvt_pk_bf16_f32 v27, v194, v195
    v_exp_f32 v196, v196
    v_exp_f32 v197, v197
    v_add_f32 v10, v10, v196
    v_add_f32 v10, v10, v197
    v_cvt_pk_bf16_f32 v30, v196, v197
    v_exp_f32 v198, v198
    v_exp_f32 v199, v199
    v_add_f32 v10, v10, v198
    v_add_f32 v10, v10, v199
    v_cvt_pk_bf16_f32 v31, v198, v199
    s_mov_b32 s17, 0x2000
    buffer_load_dwordx4 v[200:203], v8, s[8:11], s17 offen offset:0
    buffer_load_dwordx4 v[204:207], v8, s[8:11], s17 offen offset:1024
    buffer_load_dwordx4 v[208:211], v8, s[8:11], s17 offen offset:2048
    buffer_load_dwordx4 v[212:215], v8, s[8:11], s17 offen offset:3072
    s_waitcnt vmcnt(3)
    v_mfma_f32_16x16x32_bf16 v[184:187], v[200:203], v[152:155], v[216:219]
    v_mfma_f32_16x16x32_bf16 v[188:191], v[200:203], v[168:171], v[220:223]
    s_waitcnt vmcnt(2)
    v_mfma_f32_16x16x32_bf16 v[192:195], v[204:207], v[152:155], v[216:219]
    v_mfma_f32_16x16x32_bf16 v[196:199], v[204:207], v[168:171], v[220:223]
    s_waitcnt vmcnt(1)
    v_mfma_f32_16x16x32_bf16 v[184:187], v[208:211], v[156:159], v[184:187]
    v_mfma_f32_16x16x32_bf16 v[188:191], v[208:211], v[172:175], v[188:191]
    s_waitcnt vmcnt(0)
    v_mfma_f32_16x16x32_bf16 v[192:195], v[212:215], v[156:159], v[192:195]
    v_mfma_f32_16x16x32_bf16 v[196:199], v[212:215], v[172:175], v[196:199]
    s_mov_b32 s17, 0x3000
    buffer_load_dwordx4 v[200:203], v8, s[8:11], s17 offen offset:0
    buffer_load_dwordx4 v[204:207], v8, s[8:11], s17 offen offset:1024
    buffer_load_dwordx4 v[208:211], v8, s[8:11], s17 offen offset:2048
    buffer_load_dwordx4 v[212:215], v8, s[8:11], s17 offen offset:3072
    s_waitcnt vmcnt(3)
    v_mfma_f32_16x16x32_bf16 v[184:187], v[200:203], v[160:163], v[184:187]
    v_mfma_f32_16x16x32_bf16 v[188:191], v[200:203], v[176:179], v[188:191]
    s_waitcnt vmcnt(2)
    v_mfma_f32_16x16x32_bf16 v[192:195], v[204:207], v[160:163], v[192:195]
    v_mfma_f32_16x16x32_bf16 v[196:199], v[204:207], v[176:179], v[196:199]
    s_waitcnt vmcnt(1)
    v_mfma_f32_16x16x32_bf16 v[184:187], v[208:211], v[164:167], v[184:187]
    v_mfma_f32_16x16x32_bf16 v[188:191], v[208:211], v[180:183], v[188:191]
    s_waitcnt vmcnt(0)
    v_mfma_f32_16x16x32_bf16 v[192:195], v[212:215], v[164:167], v[192:195]
    v_mfma_f32_16x16x32_bf16 v[196:199], v[212:215], v[180:183], v[196:199]
    s_nop 3
    v_exp_f32 v184, v184
    v_exp_f32 v185, v185
    v_add_f32 v9, v9, v184
    v_add_f32 v9, v9, v185
    v_cvt_pk_bf16_f32 v32, v184, v185
    v_exp_f32 v186, v186
    v_exp_f32 v187, v187
    v_add_f32 v9, v9, v186
    v_add_f32 v9, v9, v187
    v_cvt_pk_bf16_f32 v33, v186, v187
    v_exp_f32 v188, v188
    v_exp_f32 v189, v189
    v_add_f32 v10, v10, v188
    v_add_f32 v10, v10, v189
    v_cvt_pk_bf16_f32 v36, v188, v189
    v_exp_f32 v190, v190
    v_exp_f32 v191, v191
    v_add_f32 v10, v10, v190
    v_add_f32 v10, v10, v191
    v_cvt_pk_bf16_f32 v37, v190, v191
    v_exp_f32 v192, v192
    v_exp_f32 v193, v193
    v_add_f32 v9, v9, v192
    v_add_f32 v9, v9, v193
    v_cvt_pk_bf16_f32 v34, v192, v193
    v_exp_f32 v194, v194
    v_exp_f32 v195, v195
    v_add_f32 v9, v9, v194
    v_add_f32 v9, v9, v195
    v_cvt_pk_bf16_f32 v35, v194, v195
    v_exp_f32 v196, v196
    v_exp_f32 v197, v197
    v_add_f32 v10, v10, v196
    v_add_f32 v10, v10, v197
    v_cvt_pk_bf16_f32 v38, v196, v197
    v_exp_f32 v198, v198
    v_exp_f32 v199, v199
    v_add_f32 v10, v10, v198
    v_add_f32 v10, v10, v199
    v_cvt_pk_bf16_f32 v39, v198, v199
    s_mov_b32 s17, 0x4000
    buffer_load_dwordx4 v[200:203], v8, s[8:11], s17 offen offset:0
    buffer_load_dwordx4 v[204:207], v8, s[8:11], s17 offen offset:1024
    buffer_load_dwordx4 v[208:211], v8, s[8:11], s17 offen offset:2048
    buffer_load_dwordx4 v[212:215], v8, s[8:11], s17 offen offset:3072
    s_waitcnt vmcnt(3)
    v_mfma_f32_16x16x32_bf16 v[184:187], v[200:203], v[152:155], v[216:219]
    v_mfma_f32_16x16x32_bf16 v[188:191], v[200:203], v[168:171], v[220:223]
    s_waitcnt vmcnt(2)
    v_mfma_f32_16x16x32_bf16 v[192:195], v[204:207], v[152:155], v[216:219]
    v_mfma_f32_16x16x32_bf16 v[196:199], v[204:207], v[168:171], v[220:223]
    s_waitcnt vmcnt(1)
    v_mfma_f32_16x16x32_bf16 v[184:187], v[208:211], v[156:159], v[184:187]
    v_mfma_f32_16x16x32_bf16 v[188:191], v[208:211], v[172:175], v[188:191]
    s_waitcnt vmcnt(0)
    v_mfma_f32_16x16x32_bf16 v[192:195], v[212:215], v[156:159], v[192:195]
    v_mfma_f32_16x16x32_bf16 v[196:199], v[212:215], v[172:175], v[196:199]
    s_mov_b32 s17, 0x5000
    buffer_load_dwordx4 v[200:203], v8, s[8:11], s17 offen offset:0
    buffer_load_dwordx4 v[204:207], v8, s[8:11], s17 offen offset:1024
    buffer_load_dwordx4 v[208:211], v8, s[8:11], s17 offen offset:2048
    buffer_load_dwordx4 v[212:215], v8, s[8:11], s17 offen offset:3072
    s_waitcnt vmcnt(3)
    v_mfma_f32_16x16x32_bf16 v[184:187], v[200:203], v[160:163], v[184:187]
    v_mfma_f32_16x16x32_bf16 v[188:191], v[200:203], v[176:179], v[188:191]
    s_waitcnt vmcnt(2)
    v_mfma_f32_16x16x32_bf16 v[192:195], v[204:207], v[160:163], v[192:195]
    v_mfma_f32_16x16x32_bf16 v[196:199], v[204:207], v[176:179], v[196:199]
    s_waitcnt vmcnt(1)
    v_mfma_f32_16x16x32_bf16 v[184:187], v[208:211], v[164:167], v[184:187]
    v_mfma_f32_16x16x32_bf16 v[188:191], v[208:211], v[180:183], v[188:191]
    s_waitcnt vmcnt(0)
    v_mfma_f32_16x16x32_bf16 v[192:195], v[212:215], v[164:167], v[192:195]
    v_mfma_f32_16x16x32_bf16 v[196:199], v[212:215], v[180:183], v[196:199]
    s_nop 3
    v_exp_f32 v184, v184
    v_exp_f32 v185, v185
    v_add_f32 v9, v9, v184
    v_add_f32 v9, v9, v185
    v_cvt_pk_bf16_f32 v40, v184, v185
    v_exp_f32 v186, v186
    v_exp_f32 v187, v187
    v_add_f32 v9, v9, v186
    v_add_f32 v9, v9, v187
    v_cvt_pk_bf16_f32 v41, v186, v187
    v_exp_f32 v188, v188
    v_exp_f32 v189, v189
    v_add_f32 v10, v10, v188
    v_add_f32 v10, v10, v189
    v_cvt_pk_bf16_f32 v44, v188, v189
    v_exp_f32 v190, v190
    v_exp_f32 v191, v191
    v_add_f32 v10, v10, v190
    v_add_f32 v10, v10, v191
    v_cvt_pk_bf16_f32 v45, v190, v191
    v_exp_f32 v192, v192
    v_exp_f32 v193, v193
    v_add_f32 v9, v9, v192
    v_add_f32 v9, v9, v193
    v_cvt_pk_bf16_f32 v42, v192, v193
    v_exp_f32 v194, v194
    v_exp_f32 v195, v195
    v_add_f32 v9, v9, v194
    v_add_f32 v9, v9, v195
    v_cvt_pk_bf16_f32 v43, v194, v195
    v_exp_f32 v196, v196
    v_exp_f32 v197, v197
    v_add_f32 v10, v10, v196
    v_add_f32 v10, v10, v197
    v_cvt_pk_bf16_f32 v46, v196, v197
    v_exp_f32 v198, v198
    v_exp_f32 v199, v199
    v_add_f32 v10, v10, v198
    v_add_f32 v10, v10, v199
    v_cvt_pk_bf16_f32 v47, v198, v199
    s_mov_b32 s17, 0x6000
    buffer_load_dwordx4 v[200:203], v8, s[8:11], s17 offen offset:0
    buffer_load_dwordx4 v[204:207], v8, s[8:11], s17 offen offset:1024
    buffer_load_dwordx4 v[208:211], v8, s[8:11], s17 offen offset:2048
    buffer_load_dwordx4 v[212:215], v8, s[8:11], s17 offen offset:3072
    s_waitcnt vmcnt(3)
    v_mfma_f32_16x16x32_bf16 v[184:187], v[200:203], v[152:155], v[216:219]
    v_mfma_f32_16x16x32_bf16 v[188:191], v[200:203], v[168:171], v[220:223]
    s_waitcnt vmcnt(2)
    v_mfma_f32_16x16x32_bf16 v[192:195], v[204:207], v[152:155], v[216:219]
    v_mfma_f32_16x16x32_bf16 v[196:199], v[204:207], v[168:171], v[220:223]
    s_waitcnt vmcnt(1)
    v_mfma_f32_16x16x32_bf16 v[184:187], v[208:211], v[156:159], v[184:187]
    v_mfma_f32_16x16x32_bf16 v[188:191], v[208:211], v[172:175], v[188:191]
    s_waitcnt vmcnt(0)
    v_mfma_f32_16x16x32_bf16 v[192:195], v[212:215], v[156:159], v[192:195]
    v_mfma_f32_16x16x32_bf16 v[196:199], v[212:215], v[172:175], v[196:199]
    s_mov_b32 s17, 0x7000
    buffer_load_dwordx4 v[200:203], v8, s[8:11], s17 offen offset:0
    buffer_load_dwordx4 v[204:207], v8, s[8:11], s17 offen offset:1024
    buffer_load_dwordx4 v[208:211], v8, s[8:11], s17 offen offset:2048
    buffer_load_dwordx4 v[212:215], v8, s[8:11], s17 offen offset:3072
    s_waitcnt vmcnt(3)
    v_mfma_f32_16x16x32_bf16 v[184:187], v[200:203], v[160:163], v[184:187]
    v_mfma_f32_16x16x32_bf16 v[188:191], v[200:203], v[176:179], v[188:191]
    s_waitcnt vmcnt(2)
    v_mfma_f32_16x16x32_bf16 v[192:195], v[204:207], v[160:163], v[192:195]
    v_mfma_f32_16x16x32_bf16 v[196:199], v[204:207], v[176:179], v[196:199]
    s_waitcnt vmcnt(1)
    v_mfma_f32_16x16x32_bf16 v[184:187], v[208:211], v[164:167], v[184:187]
    v_mfma_f32_16x16x32_bf16 v[188:191], v[208:211], v[180:183], v[188:191]
    s_waitcnt vmcnt(0)
    v_mfma_f32_16x16x32_bf16 v[192:195], v[212:215], v[164:167], v[192:195]
    v_mfma_f32_16x16x32_bf16 v[196:199], v[212:215], v[180:183], v[196:199]
    s_nop 3
    v_exp_f32 v184, v184
    v_exp_f32 v185, v185
    v_add_f32 v9, v9, v184
    v_add_f32 v9, v9, v185
    v_cvt_pk_bf16_f32 v48, v184, v185
    v_exp_f32 v186, v186
    v_exp_f32 v187, v187
    v_add_f32 v9, v9, v186
    v_add_f32 v9, v9, v187
    v_cvt_pk_bf16_f32 v49, v186, v187
    v_exp_f32 v188, v188
    v_exp_f32 v189, v189
    v_add_f32 v10, v10, v188
    v_add_f32 v10, v10, v189
    v_cvt_pk_bf16_f32 v52, v188, v189
    v_exp_f32 v190, v190
    v_exp_f32 v191, v191
    v_add_f32 v10, v10, v190
    v_add_f32 v10, v10, v191
    v_cvt_pk_bf16_f32 v53, v190, v191
    v_exp_f32 v192, v192
    v_exp_f32 v193, v193
    v_add_f32 v9, v9, v192
    v_add_f32 v9, v9, v193
    v_cvt_pk_bf16_f32 v50, v192, v193
    v_exp_f32 v194, v194
    v_exp_f32 v195, v195
    v_add_f32 v9, v9, v194
    v_add_f32 v9, v9, v195
    v_cvt_pk_bf16_f32 v51, v194, v195
    v_exp_f32 v196, v196
    v_exp_f32 v197, v197
    v_add_f32 v10, v10, v196
    v_add_f32 v10, v10, v197
    v_cvt_pk_bf16_f32 v54, v196, v197
    v_exp_f32 v198, v198
    v_exp_f32 v199, v199
    v_add_f32 v10, v10, v198
    v_add_f32 v10, v10, v199
    v_cvt_pk_bf16_f32 v55, v198, v199
    s_mov_b32 s17, 0x8000
    buffer_load_dwordx4 v[200:203], v8, s[8:11], s17 offen offset:0
    buffer_load_dwordx4 v[204:207], v8, s[8:11], s17 offen offset:1024
    buffer_load_dwordx4 v[208:211], v8, s[8:11], s17 offen offset:2048
    buffer_load_dwordx4 v[212:215], v8, s[8:11], s17 offen offset:3072
    s_waitcnt vmcnt(3)
    v_mfma_f32_16x16x32_bf16 v[184:187], v[200:203], v[152:155], v[216:219]
    v_mfma_f32_16x16x32_bf16 v[188:191], v[200:203], v[168:171], v[220:223]
    s_waitcnt vmcnt(2)
    v_mfma_f32_16x16x32_bf16 v[192:195], v[204:207], v[152:155], v[216:219]
    v_mfma_f32_16x16x32_bf16 v[196:199], v[204:207], v[168:171], v[220:223]
    s_waitcnt vmcnt(1)
    v_mfma_f32_16x16x32_bf16 v[184:187], v[208:211], v[156:159], v[184:187]
    v_mfma_f32_16x16x32_bf16 v[188:191], v[208:211], v[172:175], v[188:191]
    s_waitcnt vmcnt(0)
    v_mfma_f32_16x16x32_bf16 v[192:195], v[212:215], v[156:159], v[192:195]
    v_mfma_f32_16x16x32_bf16 v[196:199], v[212:215], v[172:175], v[196:199]
    s_mov_b32 s17, 0x9000
    buffer_load_dwordx4 v[200:203], v8, s[8:11], s17 offen offset:0
    buffer_load_dwordx4 v[204:207], v8, s[8:11], s17 offen offset:1024
    buffer_load_dwordx4 v[208:211], v8, s[8:11], s17 offen offset:2048
    buffer_load_dwordx4 v[212:215], v8, s[8:11], s17 offen offset:3072
    s_waitcnt vmcnt(3)
    v_mfma_f32_16x16x32_bf16 v[184:187], v[200:203], v[160:163], v[184:187]
    v_mfma_f32_16x16x32_bf16 v[188:191], v[200:203], v[176:179], v[188:191]
    s_waitcnt vmcnt(2)
    v_mfma_f32_16x16x32_bf16 v[192:195], v[204:207], v[160:163], v[192:195]
    v_mfma_f32_16x16x32_bf16 v[196:199], v[204:207], v[176:179], v[196:199]
    s_waitcnt vmcnt(1)
    v_mfma_f32_16x16x32_bf16 v[184:187], v[208:211], v[164:167], v[184:187]
    v_mfma_f32_16x16x32_bf16 v[188:191], v[208:211], v[180:183], v[188:191]
    s_waitcnt vmcnt(0)
    v_mfma_f32_16x16x32_bf16 v[192:195], v[212:215], v[164:167], v[192:195]
    v_mfma_f32_16x16x32_bf16 v[196:199], v[212:215], v[180:183], v[196:199]
    s_nop 3
    v_exp_f32 v184, v184
    v_exp_f32 v185, v185
    v_add_f32 v9, v9, v184
    v_add_f32 v9, v9, v185
    v_cvt_pk_bf16_f32 v56, v184, v185
    v_exp_f32 v186, v186
    v_exp_f32 v187, v187
    v_add_f32 v9, v9, v186
    v_add_f32 v9, v9, v187
    v_cvt_pk_bf16_f32 v57, v186, v187
    v_exp_f32 v188, v188
    v_exp_f32 v189, v189
    v_add_f32 v10, v10, v188
    v_add_f32 v10, v10, v189
    v_cvt_pk_bf16_f32 v60, v188, v189
    v_exp_f32 v190, v190
    v_exp_f32 v191, v191
    v_add_f32 v10, v10, v190
    v_add_f32 v10, v10, v191
    v_cvt_pk_bf16_f32 v61, v190, v191
    v_exp_f32 v192, v192
    v_exp_f32 v193, v193
    v_add_f32 v9, v9, v192
    v_add_f32 v9, v9, v193
    v_cvt_pk_bf16_f32 v58, v192, v193
    v_exp_f32 v194, v194
    v_exp_f32 v195, v195
    v_add_f32 v9, v9, v194
    v_add_f32 v9, v9, v195
    v_cvt_pk_bf16_f32 v59, v194, v195
    v_exp_f32 v196, v196
    v_exp_f32 v197, v197
    v_add_f32 v10, v10, v196
    v_add_f32 v10, v10, v197
    v_cvt_pk_bf16_f32 v62, v196, v197
    v_exp_f32 v198, v198
    v_exp_f32 v199, v199
    v_add_f32 v10, v10, v198
    v_add_f32 v10, v10, v199
    v_cvt_pk_bf16_f32 v63, v198, v199
    s_mov_b32 s17, 0xa000
    buffer_load_dwordx4 v[200:203], v8, s[8:11], s17 offen offset:0
    buffer_load_dwordx4 v[204:207], v8, s[8:11], s17 offen offset:1024
    buffer_load_dwordx4 v[208:211], v8, s[8:11], s17 offen offset:2048
    buffer_load_dwordx4 v[212:215], v8, s[8:11], s17 offen offset:3072
    s_waitcnt vmcnt(3)
    v_mfma_f32_16x16x32_bf16 v[184:187], v[200:203], v[152:155], v[216:219]
    v_mfma_f32_16x16x32_bf16 v[188:191], v[200:203], v[168:171], v[220:223]
    s_waitcnt vmcnt(2)
    v_mfma_f32_16x16x32_bf16 v[192:195], v[204:207], v[152:155], v[216:219]
    v_mfma_f32_16x16x32_bf16 v[196:199], v[204:207], v[168:171], v[220:223]
    s_waitcnt vmcnt(1)
    v_mfma_f32_16x16x32_bf16 v[184:187], v[208:211], v[156:159], v[184:187]
    v_mfma_f32_16x16x32_bf16 v[188:191], v[208:211], v[172:175], v[188:191]
    s_waitcnt vmcnt(0)
    v_mfma_f32_16x16x32_bf16 v[192:195], v[212:215], v[156:159], v[192:195]
    v_mfma_f32_16x16x32_bf16 v[196:199], v[212:215], v[172:175], v[196:199]
    s_mov_b32 s17, 0xb000
    buffer_load_dwordx4 v[200:203], v8, s[8:11], s17 offen offset:0
    buffer_load_dwordx4 v[204:207], v8, s[8:11], s17 offen offset:1024
    buffer_load_dwordx4 v[208:211], v8, s[8:11], s17 offen offset:2048
    buffer_load_dwordx4 v[212:215], v8, s[8:11], s17 offen offset:3072
    s_waitcnt vmcnt(3)
    v_mfma_f32_16x16x32_bf16 v[184:187], v[200:203], v[160:163], v[184:187]
    v_mfma_f32_16x16x32_bf16 v[188:191], v[200:203], v[176:179], v[188:191]
    s_waitcnt vmcnt(2)
    v_mfma_f32_16x16x32_bf16 v[192:195], v[204:207], v[160:163], v[192:195]
    v_mfma_f32_16x16x32_bf16 v[196:199], v[204:207], v[176:179], v[196:199]
    s_waitcnt vmcnt(1)
    v_mfma_f32_16x16x32_bf16 v[184:187], v[208:211], v[164:167], v[184:187]
    v_mfma_f32_16x16x32_bf16 v[188:191], v[208:211], v[180:183], v[188:191]
    s_waitcnt vmcnt(0)
    v_mfma_f32_16x16x32_bf16 v[192:195], v[212:215], v[164:167], v[192:195]
    v_mfma_f32_16x16x32_bf16 v[196:199], v[212:215], v[180:183], v[196:199]
    s_nop 3
    v_exp_f32 v184, v184
    v_exp_f32 v185, v185
    v_add_f32 v9, v9, v184
    v_add_f32 v9, v9, v185
    v_cvt_pk_bf16_f32 v64, v184, v185
    v_exp_f32 v186, v186
    v_exp_f32 v187, v187
    v_add_f32 v9, v9, v186
    v_add_f32 v9, v9, v187
    v_cvt_pk_bf16_f32 v65, v186, v187
    v_exp_f32 v188, v188
    v_exp_f32 v189, v189
    v_add_f32 v10, v10, v188
    v_add_f32 v10, v10, v189
    v_cvt_pk_bf16_f32 v68, v188, v189
    v_exp_f32 v190, v190
    v_exp_f32 v191, v191
    v_add_f32 v10, v10, v190
    v_add_f32 v10, v10, v191
    v_cvt_pk_bf16_f32 v69, v190, v191
    v_exp_f32 v192, v192
    v_exp_f32 v193, v193
    v_add_f32 v9, v9, v192
    v_add_f32 v9, v9, v193
    v_cvt_pk_bf16_f32 v66, v192, v193
    v_exp_f32 v194, v194
    v_exp_f32 v195, v195
    v_add_f32 v9, v9, v194
    v_add_f32 v9, v9, v195
    v_cvt_pk_bf16_f32 v67, v194, v195
    v_exp_f32 v196, v196
    v_exp_f32 v197, v197
    v_add_f32 v10, v10, v196
    v_add_f32 v10, v10, v197
    v_cvt_pk_bf16_f32 v70, v196, v197
    v_exp_f32 v198, v198
    v_exp_f32 v199, v199
    v_add_f32 v10, v10, v198
    v_add_f32 v10, v10, v199
    v_cvt_pk_bf16_f32 v71, v198, v199
    s_mov_b32 s17, 0xc000
    buffer_load_dwordx4 v[200:203], v8, s[8:11], s17 offen offset:0
    buffer_load_dwordx4 v[204:207], v8, s[8:11], s17 offen offset:1024
    buffer_load_dwordx4 v[208:211], v8, s[8:11], s17 offen offset:2048
    buffer_load_dwordx4 v[212:215], v8, s[8:11], s17 offen offset:3072
    s_waitcnt vmcnt(3)
    v_mfma_f32_16x16x32_bf16 v[184:187], v[200:203], v[152:155], v[216:219]
    v_mfma_f32_16x16x32_bf16 v[188:191], v[200:203], v[168:171], v[220:223]
    s_waitcnt vmcnt(2)
    v_mfma_f32_16x16x32_bf16 v[192:195], v[204:207], v[152:155], v[216:219]
    v_mfma_f32_16x16x32_bf16 v[196:199], v[204:207], v[168:171], v[220:223]
    s_waitcnt vmcnt(1)
    v_mfma_f32_16x16x32_bf16 v[184:187], v[208:211], v[156:159], v[184:187]
    v_mfma_f32_16x16x32_bf16 v[188:191], v[208:211], v[172:175], v[188:191]
    s_waitcnt vmcnt(0)
    v_mfma_f32_16x16x32_bf16 v[192:195], v[212:215], v[156:159], v[192:195]
    v_mfma_f32_16x16x32_bf16 v[196:199], v[212:215], v[172:175], v[196:199]
    s_mov_b32 s17, 0xd000
    buffer_load_dwordx4 v[200:203], v8, s[8:11], s17 offen offset:0
    buffer_load_dwordx4 v[204:207], v8, s[8:11], s17 offen offset:1024
    buffer_load_dwordx4 v[208:211], v8, s[8:11], s17 offen offset:2048
    buffer_load_dwordx4 v[212:215], v8, s[8:11], s17 offen offset:3072
    s_waitcnt vmcnt(3)
    v_mfma_f32_16x16x32_bf16 v[184:187], v[200:203], v[160:163], v[184:187]
    v_mfma_f32_16x16x32_bf16 v[188:191], v[200:203], v[176:179], v[188:191]
    s_waitcnt vmcnt(2)
    v_mfma_f32_16x16x32_bf16 v[192:195], v[204:207], v[160:163], v[192:195]
    v_mfma_f32_16x16x32_bf16 v[196:199], v[204:207], v[176:179], v[196:199]
    s_waitcnt vmcnt(1)
    v_mfma_f32_16x16x32_bf16 v[184:187], v[208:211], v[164:167], v[184:187]
    v_mfma_f32_16x16x32_bf16 v[188:191], v[208:211], v[180:183], v[188:191]
    s_waitcnt vmcnt(0)
    v_mfma_f32_16x16x32_bf16 v[192:195], v[212:215], v[164:167], v[192:195]
    v_mfma_f32_16x16x32_bf16 v[196:199], v[212:215], v[180:183], v[196:199]
    s_nop 3
    v_exp_f32 v184, v184
    v_exp_f32 v185, v185
    v_add_f32 v9, v9, v184
    v_add_f32 v9, v9, v185
    v_cvt_pk_bf16_f32 v72, v184, v185
    v_exp_f32 v186, v186
    v_exp_f32 v187, v187
    v_add_f32 v9, v9, v186
    v_add_f32 v9, v9, v187
    v_cvt_pk_bf16_f32 v73, v186, v187
    v_exp_f32 v188, v188
    v_exp_f32 v189, v189
    v_add_f32 v10, v10, v188
    v_add_f32 v10, v10, v189
    v_cvt_pk_bf16_f32 v76, v188, v189
    v_exp_f32 v190, v190
    v_exp_f32 v191, v191
    v_add_f32 v10, v10, v190
    v_add_f32 v10, v10, v191
    v_cvt_pk_bf16_f32 v77, v190, v191
    v_exp_f32 v192, v192
    v_exp_f32 v193, v193
    v_add_f32 v9, v9, v192
    v_add_f32 v9, v9, v193
    v_cvt_pk_bf16_f32 v74, v192, v193
    v_exp_f32 v194, v194
    v_exp_f32 v195, v195
    v_add_f32 v9, v9, v194
    v_add_f32 v9, v9, v195
    v_cvt_pk_bf16_f32 v75, v194, v195
    v_exp_f32 v196, v196
    v_exp_f32 v197, v197
    v_add_f32 v10, v10, v196
    v_add_f32 v10, v10, v197
    v_cvt_pk_bf16_f32 v78, v196, v197
    v_exp_f32 v198, v198
    v_exp_f32 v199, v199
    v_add_f32 v10, v10, v198
    v_add_f32 v10, v10, v199
    v_cvt_pk_bf16_f32 v79, v198, v199
    s_mov_b32 s17, 0xe000
    buffer_load_dwordx4 v[200:203], v8, s[8:11], s17 offen offset:0
    buffer_load_dwordx4 v[204:207], v8, s[8:11], s17 offen offset:1024
    buffer_load_dwordx4 v[208:211], v8, s[8:11], s17 offen offset:2048
    buffer_load_dwordx4 v[212:215], v8, s[8:11], s17 offen offset:3072
    s_waitcnt vmcnt(3)
    v_mfma_f32_16x16x32_bf16 v[184:187], v[200:203], v[152:155], v[216:219]
    v_mfma_f32_16x16x32_bf16 v[188:191], v[200:203], v[168:171], v[220:223]
    s_waitcnt vmcnt(2)
    v_mfma_f32_16x16x32_bf16 v[192:195], v[204:207], v[152:155], v[216:219]
    v_mfma_f32_16x16x32_bf16 v[196:199], v[204:207], v[168:171], v[220:223]
    s_waitcnt vmcnt(1)
    v_mfma_f32_16x16x32_bf16 v[184:187], v[208:211], v[156:159], v[184:187]
    v_mfma_f32_16x16x32_bf16 v[188:191], v[208:211], v[172:175], v[188:191]
    s_waitcnt vmcnt(0)
    v_mfma_f32_16x16x32_bf16 v[192:195], v[212:215], v[156:159], v[192:195]
    v_mfma_f32_16x16x32_bf16 v[196:199], v[212:215], v[172:175], v[196:199]
    s_mov_b32 s17, 0xf000
    buffer_load_dwordx4 v[200:203], v8, s[8:11], s17 offen offset:0
    buffer_load_dwordx4 v[204:207], v8, s[8:11], s17 offen offset:1024
    buffer_load_dwordx4 v[208:211], v8, s[8:11], s17 offen offset:2048
    buffer_load_dwordx4 v[212:215], v8, s[8:11], s17 offen offset:3072
    s_waitcnt vmcnt(3)
    v_mfma_f32_16x16x32_bf16 v[184:187], v[200:203], v[160:163], v[184:187]
    v_mfma_f32_16x16x32_bf16 v[188:191], v[200:203], v[176:179], v[188:191]
    s_waitcnt vmcnt(2)
    v_mfma_f32_16x16x32_bf16 v[192:195], v[204:207], v[160:163], v[192:195]
    v_mfma_f32_16x16x32_bf16 v[196:199], v[204:207], v[176:179], v[196:199]
    s_waitcnt vmcnt(1)
    v_mfma_f32_16x16x32_bf16 v[184:187], v[208:211], v[164:167], v[184:187]
    v_mfma_f32_16x16x32_bf16 v[188:191], v[208:211], v[180:183], v[188:191]
    s_waitcnt vmcnt(0)
    v_mfma_f32_16x16x32_bf16 v[192:195], v[212:215], v[164:167], v[192:195]
    v_mfma_f32_16x16x32_bf16 v[196:199], v[212:215], v[180:183], v[196:199]
    s_nop 3
    v_exp_f32 v184, v184
    v_exp_f32 v185, v185
    v_add_f32 v9, v9, v184
    v_add_f32 v9, v9, v185
    v_cvt_pk_bf16_f32 v80, v184, v185
    v_exp_f32 v186, v186
    v_exp_f32 v187, v187
    v_add_f32 v9, v9, v186
    v_add_f32 v9, v9, v187
    v_cvt_pk_bf16_f32 v81, v186, v187
    v_exp_f32 v188, v188
    v_exp_f32 v189, v189
    v_add_f32 v10, v10, v188
    v_add_f32 v10, v10, v189
    v_cvt_pk_bf16_f32 v84, v188, v189
    v_exp_f32 v190, v190
    v_exp_f32 v191, v191
    v_add_f32 v10, v10, v190
    v_add_f32 v10, v10, v191
    v_cvt_pk_bf16_f32 v85, v190, v191
    v_exp_f32 v192, v192
    v_exp_f32 v193, v193
    v_add_f32 v9, v9, v192
    v_add_f32 v9, v9, v193
    v_cvt_pk_bf16_f32 v82, v192, v193
    v_exp_f32 v194, v194
    v_exp_f32 v195, v195
    v_add_f32 v9, v9, v194
    v_add_f32 v9, v9, v195
    v_cvt_pk_bf16_f32 v83, v194, v195
    v_exp_f32 v196, v196
    v_exp_f32 v197, v197
    v_add_f32 v10, v10, v196
    v_add_f32 v10, v10, v197
    v_cvt_pk_bf16_f32 v86, v196, v197
    v_exp_f32 v198, v198
    v_exp_f32 v199, v199
    v_add_f32 v10, v10, v198
    v_add_f32 v10, v10, v199
    v_cvt_pk_bf16_f32 v87, v198, v199
    s_mov_b32 s17, 0x10000
    buffer_load_dwordx4 v[200:203], v8, s[8:11], s17 offen offset:0
    buffer_load_dwordx4 v[204:207], v8, s[8:11], s17 offen offset:1024
    buffer_load_dwordx4 v[208:211], v8, s[8:11], s17 offen offset:2048
    buffer_load_dwordx4 v[212:215], v8, s[8:11], s17 offen offset:3072
    s_waitcnt vmcnt(3)
    v_mfma_f32_16x16x32_bf16 v[184:187], v[200:203], v[152:155], v[216:219]
    v_mfma_f32_16x16x32_bf16 v[188:191], v[200:203], v[168:171], v[220:223]
    s_waitcnt vmcnt(2)
    v_mfma_f32_16x16x32_bf16 v[192:195], v[204:207], v[152:155], v[216:219]
    v_mfma_f32_16x16x32_bf16 v[196:199], v[204:207], v[168:171], v[220:223]
    s_waitcnt vmcnt(1)
    v_mfma_f32_16x16x32_bf16 v[184:187], v[208:211], v[156:159], v[184:187]
    v_mfma_f32_16x16x32_bf16 v[188:191], v[208:211], v[172:175], v[188:191]
    s_waitcnt vmcnt(0)
    v_mfma_f32_16x16x32_bf16 v[192:195], v[212:215], v[156:159], v[192:195]
    v_mfma_f32_16x16x32_bf16 v[196:199], v[212:215], v[172:175], v[196:199]
    s_mov_b32 s17, 0x11000
    buffer_load_dwordx4 v[200:203], v8, s[8:11], s17 offen offset:0
    buffer_load_dwordx4 v[204:207], v8, s[8:11], s17 offen offset:1024
    buffer_load_dwordx4 v[208:211], v8, s[8:11], s17 offen offset:2048
    buffer_load_dwordx4 v[212:215], v8, s[8:11], s17 offen offset:3072
    s_waitcnt vmcnt(3)
    v_mfma_f32_16x16x32_bf16 v[184:187], v[200:203], v[160:163], v[184:187]
    v_mfma_f32_16x16x32_bf16 v[188:191], v[200:203], v[176:179], v[188:191]
    s_waitcnt vmcnt(2)
    v_mfma_f32_16x16x32_bf16 v[192:195], v[204:207], v[160:163], v[192:195]
    v_mfma_f32_16x16x32_bf16 v[196:199], v[204:207], v[176:179], v[196:199]
    s_waitcnt vmcnt(1)
    v_mfma_f32_16x16x32_bf16 v[184:187], v[208:211], v[164:167], v[184:187]
    v_mfma_f32_16x16x32_bf16 v[188:191], v[208:211], v[180:183], v[188:191]
    s_waitcnt vmcnt(0)
    v_mfma_f32_16x16x32_bf16 v[192:195], v[212:215], v[164:167], v[192:195]
    v_mfma_f32_16x16x32_bf16 v[196:199], v[212:215], v[180:183], v[196:199]
    s_nop 3
    v_exp_f32 v184, v184
    v_exp_f32 v185, v185
    v_add_f32 v9, v9, v184
    v_add_f32 v9, v9, v185
    v_cvt_pk_bf16_f32 v88, v184, v185
    v_exp_f32 v186, v186
    v_exp_f32 v187, v187
    v_add_f32 v9, v9, v186
    v_add_f32 v9, v9, v187
    v_cvt_pk_bf16_f32 v89, v186, v187
    v_exp_f32 v188, v188
    v_exp_f32 v189, v189
    v_add_f32 v10, v10, v188
    v_add_f32 v10, v10, v189
    v_cvt_pk_bf16_f32 v92, v188, v189
    v_exp_f32 v190, v190
    v_exp_f32 v191, v191
    v_add_f32 v10, v10, v190
    v_add_f32 v10, v10, v191
    v_cvt_pk_bf16_f32 v93, v190, v191
    v_exp_f32 v192, v192
    v_exp_f32 v193, v193
    v_add_f32 v9, v9, v192
    v_add_f32 v9, v9, v193
    v_cvt_pk_bf16_f32 v90, v192, v193
    v_exp_f32 v194, v194
    v_exp_f32 v195, v195
    v_add_f32 v9, v9, v194
    v_add_f32 v9, v9, v195
    v_cvt_pk_bf16_f32 v91, v194, v195
    v_exp_f32 v196, v196
    v_exp_f32 v197, v197
    v_add_f32 v10, v10, v196
    v_add_f32 v10, v10, v197
    v_cvt_pk_bf16_f32 v94, v196, v197
    v_exp_f32 v198, v198
    v_exp_f32 v199, v199
    v_add_f32 v10, v10, v198
    v_add_f32 v10, v10, v199
    v_cvt_pk_bf16_f32 v95, v198, v199
    s_mov_b32 s17, 0x12000
    buffer_load_dwordx4 v[200:203], v8, s[8:11], s17 offen offset:0
    buffer_load_dwordx4 v[204:207], v8, s[8:11], s17 offen offset:1024
    buffer_load_dwordx4 v[208:211], v8, s[8:11], s17 offen offset:2048
    buffer_load_dwordx4 v[212:215], v8, s[8:11], s17 offen offset:3072
    s_waitcnt vmcnt(3)
    v_mfma_f32_16x16x32_bf16 v[184:187], v[200:203], v[152:155], v[216:219]
    v_mfma_f32_16x16x32_bf16 v[188:191], v[200:203], v[168:171], v[220:223]
    s_waitcnt vmcnt(2)
    v_mfma_f32_16x16x32_bf16 v[192:195], v[204:207], v[152:155], v[216:219]
    v_mfma_f32_16x16x32_bf16 v[196:199], v[204:207], v[168:171], v[220:223]
    s_waitcnt vmcnt(1)
    v_mfma_f32_16x16x32_bf16 v[184:187], v[208:211], v[156:159], v[184:187]
    v_mfma_f32_16x16x32_bf16 v[188:191], v[208:211], v[172:175], v[188:191]
    s_waitcnt vmcnt(0)
    v_mfma_f32_16x16x32_bf16 v[192:195], v[212:215], v[156:159], v[192:195]
    v_mfma_f32_16x16x32_bf16 v[196:199], v[212:215], v[172:175], v[196:199]
    s_mov_b32 s17, 0x13000
    buffer_load_dwordx4 v[200:203], v8, s[8:11], s17 offen offset:0
    buffer_load_dwordx4 v[204:207], v8, s[8:11], s17 offen offset:1024
    buffer_load_dwordx4 v[208:211], v8, s[8:11], s17 offen offset:2048
    buffer_load_dwordx4 v[212:215], v8, s[8:11], s17 offen offset:3072
    s_waitcnt vmcnt(3)
    v_mfma_f32_16x16x32_bf16 v[184:187], v[200:203], v[160:163], v[184:187]
    v_mfma_f32_16x16x32_bf16 v[188:191], v[200:203], v[176:179], v[188:191]
    s_waitcnt vmcnt(2)
    v_mfma_f32_16x16x32_bf16 v[192:195], v[204:207], v[160:163], v[192:195]
    v_mfma_f32_16x16x32_bf16 v[196:199], v[204:207], v[176:179], v[196:199]
    s_waitcnt vmcnt(1)
    v_mfma_f32_16x16x32_bf16 v[184:187], v[208:211], v[164:167], v[184:187]
    v_mfma_f32_16x16x32_bf16 v[188:191], v[208:211], v[180:183], v[188:191]
    s_waitcnt vmcnt(0)
    v_mfma_f32_16x16x32_bf16 v[192:195], v[212:215], v[164:167], v[192:195]
    v_mfma_f32_16x16x32_bf16 v[196:199], v[212:215], v[180:183], v[196:199]
    s_nop 3
    v_exp_f32 v184, v184
    v_exp_f32 v185, v185
    v_add_f32 v9, v9, v184
    v_add_f32 v9, v9, v185
    v_cvt_pk_bf16_f32 v96, v184, v185
    v_exp_f32 v186, v186
    v_exp_f32 v187, v187
    v_add_f32 v9, v9, v186
    v_add_f32 v9, v9, v187
    v_cvt_pk_bf16_f32 v97, v186, v187
    v_exp_f32 v188, v188
    v_exp_f32 v189, v189
    v_add_f32 v10, v10, v188
    v_add_f32 v10, v10, v189
    v_cvt_pk_bf16_f32 v100, v188, v189
    v_exp_f32 v190, v190
    v_exp_f32 v191, v191
    v_add_f32 v10, v10, v190
    v_add_f32 v10, v10, v191
    v_cvt_pk_bf16_f32 v101, v190, v191
    v_exp_f32 v192, v192
    v_exp_f32 v193, v193
    v_add_f32 v9, v9, v192
    v_add_f32 v9, v9, v193
    v_cvt_pk_bf16_f32 v98, v192, v193
    v_exp_f32 v194, v194
    v_exp_f32 v195, v195
    v_add_f32 v9, v9, v194
    v_add_f32 v9, v9, v195
    v_cvt_pk_bf16_f32 v99, v194, v195
    v_exp_f32 v196, v196
    v_exp_f32 v197, v197
    v_add_f32 v10, v10, v196
    v_add_f32 v10, v10, v197
    v_cvt_pk_bf16_f32 v102, v196, v197
    v_exp_f32 v198, v198
    v_exp_f32 v199, v199
    v_add_f32 v10, v10, v198
    v_add_f32 v10, v10, v199
    v_cvt_pk_bf16_f32 v103, v198, v199
    s_mov_b32 s17, 0x14000
    buffer_load_dwordx4 v[200:203], v8, s[8:11], s17 offen offset:0
    buffer_load_dwordx4 v[204:207], v8, s[8:11], s17 offen offset:1024
    buffer_load_dwordx4 v[208:211], v8, s[8:11], s17 offen offset:2048
    buffer_load_dwordx4 v[212:215], v8, s[8:11], s17 offen offset:3072
    s_waitcnt vmcnt(3)
    v_mfma_f32_16x16x32_bf16 v[184:187], v[200:203], v[152:155], v[216:219]
    v_mfma_f32_16x16x32_bf16 v[188:191], v[200:203], v[168:171], v[220:223]
    s_waitcnt vmcnt(2)
    v_mfma_f32_16x16x32_bf16 v[192:195], v[204:207], v[152:155], v[216:219]
    v_mfma_f32_16x16x32_bf16 v[196:199], v[204:207], v[168:171], v[220:223]
    s_waitcnt vmcnt(1)
    v_mfma_f32_16x16x32_bf16 v[184:187], v[208:211], v[156:159], v[184:187]
    v_mfma_f32_16x16x32_bf16 v[188:191], v[208:211], v[172:175], v[188:191]
    s_waitcnt vmcnt(0)
    v_mfma_f32_16x16x32_bf16 v[192:195], v[212:215], v[156:159], v[192:195]
    v_mfma_f32_16x16x32_bf16 v[196:199], v[212:215], v[172:175], v[196:199]
    s_mov_b32 s17, 0x15000
    buffer_load_dwordx4 v[200:203], v8, s[8:11], s17 offen offset:0
    buffer_load_dwordx4 v[204:207], v8, s[8:11], s17 offen offset:1024
    buffer_load_dwordx4 v[208:211], v8, s[8:11], s17 offen offset:2048
    buffer_load_dwordx4 v[212:215], v8, s[8:11], s17 offen offset:3072
    s_waitcnt vmcnt(3)
    v_mfma_f32_16x16x32_bf16 v[184:187], v[200:203], v[160:163], v[184:187]
    v_mfma_f32_16x16x32_bf16 v[188:191], v[200:203], v[176:179], v[188:191]
    s_waitcnt vmcnt(2)
    v_mfma_f32_16x16x32_bf16 v[192:195], v[204:207], v[160:163], v[192:195]
    v_mfma_f32_16x16x32_bf16 v[196:199], v[204:207], v[176:179], v[196:199]
    s_waitcnt vmcnt(1)
    v_mfma_f32_16x16x32_bf16 v[184:187], v[208:211], v[164:167], v[184:187]
    v_mfma_f32_16x16x32_bf16 v[188:191], v[208:211], v[180:183], v[188:191]
    s_waitcnt vmcnt(0)
    v_mfma_f32_16x16x32_bf16 v[192:195], v[212:215], v[164:167], v[192:195]
    v_mfma_f32_16x16x32_bf16 v[196:199], v[212:215], v[180:183], v[196:199]
    s_nop 3
    v_exp_f32 v184, v184
    v_exp_f32 v185, v185
    v_add_f32 v9, v9, v184
    v_add_f32 v9, v9, v185
    v_cvt_pk_bf16_f32 v104, v184, v185
    v_exp_f32 v186, v186
    v_exp_f32 v187, v187
    v_add_f32 v9, v9, v186
    v_add_f32 v9, v9, v187
    v_cvt_pk_bf16_f32 v105, v186, v187
    v_exp_f32 v188, v188
    v_exp_f32 v189, v189
    v_add_f32 v10, v10, v188
    v_add_f32 v10, v10, v189
    v_cvt_pk_bf16_f32 v108, v188, v189
    v_exp_f32 v190, v190
    v_exp_f32 v191, v191
    v_add_f32 v10, v10, v190
    v_add_f32 v10, v10, v191
    v_cvt_pk_bf16_f32 v109, v190, v191
    v_exp_f32 v192, v192
    v_exp_f32 v193, v193
    v_add_f32 v9, v9, v192
    v_add_f32 v9, v9, v193
    v_cvt_pk_bf16_f32 v106, v192, v193
    v_exp_f32 v194, v194
    v_exp_f32 v195, v195
    v_add_f32 v9, v9, v194
    v_add_f32 v9, v9, v195
    v_cvt_pk_bf16_f32 v107, v194, v195
    v_exp_f32 v196, v196
    v_exp_f32 v197, v197
    v_add_f32 v10, v10, v196
    v_add_f32 v10, v10, v197
    v_cvt_pk_bf16_f32 v110, v196, v197
    v_exp_f32 v198, v198
    v_exp_f32 v199, v199
    v_add_f32 v10, v10, v198
    v_add_f32 v10, v10, v199
    v_cvt_pk_bf16_f32 v111, v198, v199
    s_mov_b32 s17, 0x16000
    buffer_load_dwordx4 v[200:203], v8, s[8:11], s17 offen offset:0
    buffer_load_dwordx4 v[204:207], v8, s[8:11], s17 offen offset:1024
    buffer_load_dwordx4 v[208:211], v8, s[8:11], s17 offen offset:2048
    buffer_load_dwordx4 v[212:215], v8, s[8:11], s17 offen offset:3072
    s_waitcnt vmcnt(3)
    v_mfma_f32_16x16x32_bf16 v[184:187], v[200:203], v[152:155], v[216:219]
    v_mfma_f32_16x16x32_bf16 v[188:191], v[200:203], v[168:171], v[220:223]
    s_waitcnt vmcnt(2)
    v_mfma_f32_16x16x32_bf16 v[192:195], v[204:207], v[152:155], v[216:219]
    v_mfma_f32_16x16x32_bf16 v[196:199], v[204:207], v[168:171], v[220:223]
    s_waitcnt vmcnt(1)
    v_mfma_f32_16x16x32_bf16 v[184:187], v[208:211], v[156:159], v[184:187]
    v_mfma_f32_16x16x32_bf16 v[188:191], v[208:211], v[172:175], v[188:191]
    s_waitcnt vmcnt(0)
    v_mfma_f32_16x16x32_bf16 v[192:195], v[212:215], v[156:159], v[192:195]
    v_mfma_f32_16x16x32_bf16 v[196:199], v[212:215], v[172:175], v[196:199]
    s_mov_b32 s17, 0x17000
    buffer_load_dwordx4 v[200:203], v8, s[8:11], s17 offen offset:0
    buffer_load_dwordx4 v[204:207], v8, s[8:11], s17 offen offset:1024
    buffer_load_dwordx4 v[208:211], v8, s[8:11], s17 offen offset:2048
    buffer_load_dwordx4 v[212:215], v8, s[8:11], s17 offen offset:3072
    s_waitcnt vmcnt(3)
    v_mfma_f32_16x16x32_bf16 v[184:187], v[200:203], v[160:163], v[184:187]
    v_mfma_f32_16x16x32_bf16 v[188:191], v[200:203], v[176:179], v[188:191]
    s_waitcnt vmcnt(2)
    v_mfma_f32_16x16x32_bf16 v[192:195], v[204:207], v[160:163], v[192:195]
    v_mfma_f32_16x16x32_bf16 v[196:199], v[204:207], v[176:179], v[196:199]
    s_waitcnt vmcnt(1)
    v_mfma_f32_16x16x32_bf16 v[184:187], v[208:211], v[164:167], v[184:187]
    v_mfma_f32_16x16x32_bf16 v[188:191], v[208:211], v[180:183], v[188:191]
    s_waitcnt vmcnt(0)
    v_mfma_f32_16x16x32_bf16 v[192:195], v[212:215], v[164:167], v[192:195]
    v_mfma_f32_16x16x32_bf16 v[196:199], v[212:215], v[180:183], v[196:199]
    s_nop 3
    v_exp_f32 v184, v184
    v_exp_f32 v185, v185
    v_add_f32 v9, v9, v184
    v_add_f32 v9, v9, v185
    v_cvt_pk_bf16_f32 v112, v184, v185
    v_exp_f32 v186, v186
    v_exp_f32 v187, v187
    v_add_f32 v9, v9, v186
    v_add_f32 v9, v9, v187
    v_cvt_pk_bf16_f32 v113, v186, v187
    v_exp_f32 v188, v188
    v_exp_f32 v189, v189
    v_add_f32 v10, v10, v188
    v_add_f32 v10, v10, v189
    v_cvt_pk_bf16_f32 v116, v188, v189
    v_exp_f32 v190, v190
    v_exp_f32 v191, v191
    v_add_f32 v10, v10, v190
    v_add_f32 v10, v10, v191
    v_cvt_pk_bf16_f32 v117, v190, v191
    v_exp_f32 v192, v192
    v_exp_f32 v193, v193
    v_add_f32 v9, v9, v192
    v_add_f32 v9, v9, v193
    v_cvt_pk_bf16_f32 v114, v192, v193
    v_exp_f32 v194, v194
    v_exp_f32 v195, v195
    v_add_f32 v9, v9, v194
    v_add_f32 v9, v9, v195
    v_cvt_pk_bf16_f32 v115, v194, v195
    v_exp_f32 v196, v196
    v_exp_f32 v197, v197
    v_add_f32 v10, v10, v196
    v_add_f32 v10, v10, v197
    v_cvt_pk_bf16_f32 v118, v196, v197
    v_exp_f32 v198, v198
    v_exp_f32 v199, v199
    v_add_f32 v10, v10, v198
    v_add_f32 v10, v10, v199
    v_cvt_pk_bf16_f32 v119, v198, v199
    s_mov_b32 s17, 0x18000
    buffer_load_dwordx4 v[200:203], v8, s[8:11], s17 offen offset:0
    buffer_load_dwordx4 v[204:207], v8, s[8:11], s17 offen offset:1024
    buffer_load_dwordx4 v[208:211], v8, s[8:11], s17 offen offset:2048
    buffer_load_dwordx4 v[212:215], v8, s[8:11], s17 offen offset:3072
    s_waitcnt vmcnt(3)
    v_mfma_f32_16x16x32_bf16 v[184:187], v[200:203], v[152:155], v[216:219]
    v_mfma_f32_16x16x32_bf16 v[188:191], v[200:203], v[168:171], v[220:223]
    s_waitcnt vmcnt(2)
    v_mfma_f32_16x16x32_bf16 v[192:195], v[204:207], v[152:155], v[216:219]
    v_mfma_f32_16x16x32_bf16 v[196:199], v[204:207], v[168:171], v[220:223]
    s_waitcnt vmcnt(1)
    v_mfma_f32_16x16x32_bf16 v[184:187], v[208:211], v[156:159], v[184:187]
    v_mfma_f32_16x16x32_bf16 v[188:191], v[208:211], v[172:175], v[188:191]
    s_waitcnt vmcnt(0)
    v_mfma_f32_16x16x32_bf16 v[192:195], v[212:215], v[156:159], v[192:195]
    v_mfma_f32_16x16x32_bf16 v[196:199], v[212:215], v[172:175], v[196:199]
    s_mov_b32 s17, 0x19000
    buffer_load_dwordx4 v[200:203], v8, s[8:11], s17 offen offset:0
    buffer_load_dwordx4 v[204:207], v8, s[8:11], s17 offen offset:1024
    buffer_load_dwordx4 v[208:211], v8, s[8:11], s17 offen offset:2048
    buffer_load_dwordx4 v[212:215], v8, s[8:11], s17 offen offset:3072
    s_waitcnt vmcnt(3)
    v_mfma_f32_16x16x32_bf16 v[184:187], v[200:203], v[160:163], v[184:187]
    v_mfma_f32_16x16x32_bf16 v[188:191], v[200:203], v[176:179], v[188:191]
    s_waitcnt vmcnt(2)
    v_mfma_f32_16x16x32_bf16 v[192:195], v[204:207], v[160:163], v[192:195]
    v_mfma_f32_16x16x32_bf16 v[196:199], v[204:207], v[176:179], v[196:199]
    s_waitcnt vmcnt(1)
    v_mfma_f32_16x16x32_bf16 v[184:187], v[208:211], v[164:167], v[184:187]
    v_mfma_f32_16x16x32_bf16 v[188:191], v[208:211], v[180:183], v[188:191]
    s_waitcnt vmcnt(0)
    v_mfma_f32_16x16x32_bf16 v[192:195], v[212:215], v[164:167], v[192:195]
    v_mfma_f32_16x16x32_bf16 v[196:199], v[212:215], v[180:183], v[196:199]
    s_nop 3
    v_exp_f32 v184, v184
    v_exp_f32 v185, v185
    v_add_f32 v9, v9, v184
    v_add_f32 v9, v9, v185
    v_cvt_pk_bf16_f32 v120, v184, v185
    v_exp_f32 v186, v186
    v_exp_f32 v187, v187
    v_add_f32 v9, v9, v186
    v_add_f32 v9, v9, v187
    v_cvt_pk_bf16_f32 v121, v186, v187
    v_exp_f32 v188, v188
    v_exp_f32 v189, v189
    v_add_f32 v10, v10, v188
    v_add_f32 v10, v10, v189
    v_cvt_pk_bf16_f32 v124, v188, v189
    v_exp_f32 v190, v190
    v_exp_f32 v191, v191
    v_add_f32 v10, v10, v190
    v_add_f32 v10, v10, v191
    v_cvt_pk_bf16_f32 v125, v190, v191
    v_exp_f32 v192, v192
    v_exp_f32 v193, v193
    v_add_f32 v9, v9, v192
    v_add_f32 v9, v9, v193
    v_cvt_pk_bf16_f32 v122, v192, v193
    v_exp_f32 v194, v194
    v_exp_f32 v195, v195
    v_add_f32 v9, v9, v194
    v_add_f32 v9, v9, v195
    v_cvt_pk_bf16_f32 v123, v194, v195
    v_exp_f32 v196, v196
    v_exp_f32 v197, v197
    v_add_f32 v10, v10, v196
    v_add_f32 v10, v10, v197
    v_cvt_pk_bf16_f32 v126, v196, v197
    v_exp_f32 v198, v198
    v_exp_f32 v199, v199
    v_add_f32 v10, v10, v198
    v_add_f32 v10, v10, v199
    v_cvt_pk_bf16_f32 v127, v198, v199
    s_mov_b32 s17, 0x1a000
    buffer_load_dwordx4 v[200:203], v8, s[8:11], s17 offen offset:0
    buffer_load_dwordx4 v[204:207], v8, s[8:11], s17 offen offset:1024
    buffer_load_dwordx4 v[208:211], v8, s[8:11], s17 offen offset:2048
    buffer_load_dwordx4 v[212:215], v8, s[8:11], s17 offen offset:3072
    s_waitcnt vmcnt(3)
    v_mfma_f32_16x16x32_bf16 v[184:187], v[200:203], v[152:155], v[216:219]
    v_mfma_f32_16x16x32_bf16 v[188:191], v[200:203], v[168:171], v[220:223]
    s_waitcnt vmcnt(2)
    v_mfma_f32_16x16x32_bf16 v[192:195], v[204:207], v[152:155], v[216:219]
    v_mfma_f32_16x16x32_bf16 v[196:199], v[204:207], v[168:171], v[220:223]
    s_waitcnt vmcnt(1)
    v_mfma_f32_16x16x32_bf16 v[184:187], v[208:211], v[156:159], v[184:187]
    v_mfma_f32_16x16x32_bf16 v[188:191], v[208:211], v[172:175], v[188:191]
    s_waitcnt vmcnt(0)
    v_mfma_f32_16x16x32_bf16 v[192:195], v[212:215], v[156:159], v[192:195]
    v_mfma_f32_16x16x32_bf16 v[196:199], v[212:215], v[172:175], v[196:199]
    s_mov_b32 s17, 0x1b000
    buffer_load_dwordx4 v[200:203], v8, s[8:11], s17 offen offset:0
    buffer_load_dwordx4 v[204:207], v8, s[8:11], s17 offen offset:1024
    buffer_load_dwordx4 v[208:211], v8, s[8:11], s17 offen offset:2048
    buffer_load_dwordx4 v[212:215], v8, s[8:11], s17 offen offset:3072
    s_waitcnt vmcnt(3)
    v_mfma_f32_16x16x32_bf16 v[184:187], v[200:203], v[160:163], v[184:187]
    v_mfma_f32_16x16x32_bf16 v[188:191], v[200:203], v[176:179], v[188:191]
    s_waitcnt vmcnt(2)
    v_mfma_f32_16x16x32_bf16 v[192:195], v[204:207], v[160:163], v[192:195]
    v_mfma_f32_16x16x32_bf16 v[196:199], v[204:207], v[176:179], v[196:199]
    s_waitcnt vmcnt(1)
    v_mfma_f32_16x16x32_bf16 v[184:187], v[208:211], v[164:167], v[184:187]
    v_mfma_f32_16x16x32_bf16 v[188:191], v[208:211], v[180:183], v[188:191]
    s_waitcnt vmcnt(0)
    v_mfma_f32_16x16x32_bf16 v[192:195], v[212:215], v[164:167], v[192:195]
    v_mfma_f32_16x16x32_bf16 v[196:199], v[212:215], v[180:183], v[196:199]
    s_nop 3
    v_exp_f32 v184, v184
    v_exp_f32 v185, v185
    v_add_f32 v9, v9, v184
    v_add_f32 v9, v9, v185
    v_cvt_pk_bf16_f32 v128, v184, v185
    v_exp_f32 v186, v186
    v_exp_f32 v187, v187
    v_add_f32 v9, v9, v186
    v_add_f32 v9, v9, v187
    v_cvt_pk_bf16_f32 v129, v186, v187
    v_exp_f32 v188, v188
    v_exp_f32 v189, v189
    v_add_f32 v10, v10, v188
    v_add_f32 v10, v10, v189
    v_cvt_pk_bf16_f32 v132, v188, v189
    v_exp_f32 v190, v190
    v_exp_f32 v191, v191
    v_add_f32 v10, v10, v190
    v_add_f32 v10, v10, v191
    v_cvt_pk_bf16_f32 v133, v190, v191
    v_exp_f32 v192, v192
    v_exp_f32 v193, v193
    v_add_f32 v9, v9, v192
    v_add_f32 v9, v9, v193
    v_cvt_pk_bf16_f32 v130, v192, v193
    v_exp_f32 v194, v194
    v_exp_f32 v195, v195
    v_add_f32 v9, v9, v194
    v_add_f32 v9, v9, v195
    v_cvt_pk_bf16_f32 v131, v194, v195
    v_exp_f32 v196, v196
    v_exp_f32 v197, v197
    v_add_f32 v10, v10, v196
    v_add_f32 v10, v10, v197
    v_cvt_pk_bf16_f32 v134, v196, v197
    v_exp_f32 v198, v198
    v_exp_f32 v199, v199
    v_add_f32 v10, v10, v198
    v_add_f32 v10, v10, v199
    v_cvt_pk_bf16_f32 v135, v198, v199
    s_mov_b32 s17, 0x1c000
    buffer_load_dwordx4 v[200:203], v8, s[8:11], s17 offen offset:0
    buffer_load_dwordx4 v[204:207], v8, s[8:11], s17 offen offset:1024
    buffer_load_dwordx4 v[208:211], v8, s[8:11], s17 offen offset:2048
    buffer_load_dwordx4 v[212:215], v8, s[8:11], s17 offen offset:3072
    s_waitcnt vmcnt(3)
    v_mfma_f32_16x16x32_bf16 v[184:187], v[200:203], v[152:155], v[216:219]
    v_mfma_f32_16x16x32_bf16 v[188:191], v[200:203], v[168:171], v[220:223]
    s_waitcnt vmcnt(2)
    v_mfma_f32_16x16x32_bf16 v[192:195], v[204:207], v[152:155], v[216:219]
    v_mfma_f32_16x16x32_bf16 v[196:199], v[204:207], v[168:171], v[220:223]
    s_waitcnt vmcnt(1)
    v_mfma_f32_16x16x32_bf16 v[184:187], v[208:211], v[156:159], v[184:187]
    v_mfma_f32_16x16x32_bf16 v[188:191], v[208:211], v[172:175], v[188:191]
    s_waitcnt vmcnt(0)
    v_mfma_f32_16x16x32_bf16 v[192:195], v[212:215], v[156:159], v[192:195]
    v_mfma_f32_16x16x32_bf16 v[196:199], v[212:215], v[172:175], v[196:199]
    s_mov_b32 s17, 0x1d000
    buffer_load_dwordx4 v[200:203], v8, s[8:11], s17 offen offset:0
    buffer_load_dwordx4 v[204:207], v8, s[8:11], s17 offen offset:1024
    buffer_load_dwordx4 v[208:211], v8, s[8:11], s17 offen offset:2048
    buffer_load_dwordx4 v[212:215], v8, s[8:11], s17 offen offset:3072
    s_waitcnt vmcnt(3)
    v_mfma_f32_16x16x32_bf16 v[184:187], v[200:203], v[160:163], v[184:187]
    v_mfma_f32_16x16x32_bf16 v[188:191], v[200:203], v[176:179], v[188:191]
    s_waitcnt vmcnt(2)
    v_mfma_f32_16x16x32_bf16 v[192:195], v[204:207], v[160:163], v[192:195]
    v_mfma_f32_16x16x32_bf16 v[196:199], v[204:207], v[176:179], v[196:199]
    s_waitcnt vmcnt(1)
    v_mfma_f32_16x16x32_bf16 v[184:187], v[208:211], v[164:167], v[184:187]
    v_mfma_f32_16x16x32_bf16 v[188:191], v[208:211], v[180:183], v[188:191]
    s_waitcnt vmcnt(0)
    v_mfma_f32_16x16x32_bf16 v[192:195], v[212:215], v[164:167], v[192:195]
    v_mfma_f32_16x16x32_bf16 v[196:199], v[212:215], v[180:183], v[196:199]
    s_nop 3
    v_exp_f32 v184, v184
    v_exp_f32 v185, v185
    v_add_f32 v9, v9, v184
    v_add_f32 v9, v9, v185
    v_cvt_pk_bf16_f32 v136, v184, v185
    v_exp_f32 v186, v186
    v_exp_f32 v187, v187
    v_add_f32 v9, v9, v186
    v_add_f32 v9, v9, v187
    v_cvt_pk_bf16_f32 v137, v186, v187
    v_exp_f32 v188, v188
    v_exp_f32 v189, v189
    v_add_f32 v10, v10, v188
    v_add_f32 v10, v10, v189
    v_cvt_pk_bf16_f32 v140, v188, v189
    v_exp_f32 v190, v190
    v_exp_f32 v191, v191
    v_add_f32 v10, v10, v190
    v_add_f32 v10, v10, v191
    v_cvt_pk_bf16_f32 v141, v190, v191
    v_exp_f32 v192, v192
    v_exp_f32 v193, v193
    v_add_f32 v9, v9, v192
    v_add_f32 v9, v9, v193
    v_cvt_pk_bf16_f32 v138, v192, v193
    v_exp_f32 v194, v194
    v_exp_f32 v195, v195
    v_add_f32 v9, v9, v194
    v_add_f32 v9, v9, v195
    v_cvt_pk_bf16_f32 v139, v194, v195
    v_exp_f32 v196, v196
    v_exp_f32 v197, v197
    v_add_f32 v10, v10, v196
    v_add_f32 v10, v10, v197
    v_cvt_pk_bf16_f32 v142, v196, v197
    v_exp_f32 v198, v198
    v_exp_f32 v199, v199
    v_add_f32 v10, v10, v198
    v_add_f32 v10, v10, v199
    v_cvt_pk_bf16_f32 v143, v198, v199
    s_mov_b32 s17, 0x1e000
    buffer_load_dwordx4 v[200:203], v8, s[8:11], s17 offen offset:0
    buffer_load_dwordx4 v[204:207], v8, s[8:11], s17 offen offset:1024
    buffer_load_dwordx4 v[208:211], v8, s[8:11], s17 offen offset:2048
    buffer_load_dwordx4 v[212:215], v8, s[8:11], s17 offen offset:3072
    s_waitcnt vmcnt(3)
    v_mfma_f32_16x16x32_bf16 v[184:187], v[200:203], v[152:155], v[216:219]
    v_mfma_f32_16x16x32_bf16 v[188:191], v[200:203], v[168:171], v[220:223]
    s_waitcnt vmcnt(2)
    v_mfma_f32_16x16x32_bf16 v[192:195], v[204:207], v[152:155], v[216:219]
    v_mfma_f32_16x16x32_bf16 v[196:199], v[204:207], v[168:171], v[220:223]
    s_waitcnt vmcnt(1)
    v_mfma_f32_16x16x32_bf16 v[184:187], v[208:211], v[156:159], v[184:187]
    v_mfma_f32_16x16x32_bf16 v[188:191], v[208:211], v[172:175], v[188:191]
    s_waitcnt vmcnt(0)
    v_mfma_f32_16x16x32_bf16 v[192:195], v[212:215], v[156:159], v[192:195]
    v_mfma_f32_16x16x32_bf16 v[196:199], v[212:215], v[172:175], v[196:199]
    s_mov_b32 s17, 0x1f000
    buffer_load_dwordx4 v[200:203], v8, s[8:11], s17 offen offset:0
    buffer_load_dwordx4 v[204:207], v8, s[8:11], s17 offen offset:1024
    buffer_load_dwordx4 v[208:211], v8, s[8:11], s17 offen offset:2048
    buffer_load_dwordx4 v[212:215], v8, s[8:11], s17 offen offset:3072
    s_waitcnt vmcnt(3)
    v_mfma_f32_16x16x32_bf16 v[184:187], v[200:203], v[160:163], v[184:187]
    v_mfma_f32_16x16x32_bf16 v[188:191], v[200:203], v[176:179], v[188:191]
    s_waitcnt vmcnt(2)
    v_mfma_f32_16x16x32_bf16 v[192:195], v[204:207], v[160:163], v[192:195]
    v_mfma_f32_16x16x32_bf16 v[196:199], v[204:207], v[176:179], v[196:199]
    s_waitcnt vmcnt(1)
    v_mfma_f32_16x16x32_bf16 v[184:187], v[208:211], v[164:167], v[184:187]
    v_mfma_f32_16x16x32_bf16 v[188:191], v[208:211], v[180:183], v[188:191]
    s_waitcnt vmcnt(0)
    v_mfma_f32_16x16x32_bf16 v[192:195], v[212:215], v[164:167], v[192:195]
    v_mfma_f32_16x16x32_bf16 v[196:199], v[212:215], v[180:183], v[196:199]
    s_nop 3
    v_exp_f32 v184, v184
    v_exp_f32 v185, v185
    v_add_f32 v9, v9, v184
    v_add_f32 v9, v9, v185
    v_cvt_pk_bf16_f32 v144, v184, v185
    v_exp_f32 v186, v186
    v_exp_f32 v187, v187
    v_add_f32 v9, v9, v186
    v_add_f32 v9, v9, v187
    v_cvt_pk_bf16_f32 v145, v186, v187
    v_exp_f32 v188, v188
    v_exp_f32 v189, v189
    v_add_f32 v10, v10, v188
    v_add_f32 v10, v10, v189
    v_cvt_pk_bf16_f32 v148, v188, v189
    v_exp_f32 v190, v190
    v_exp_f32 v191, v191
    v_add_f32 v10, v10, v190
    v_add_f32 v10, v10, v191
    v_cvt_pk_bf16_f32 v149, v190, v191
    v_exp_f32 v192, v192
    v_exp_f32 v193, v193
    v_add_f32 v9, v9, v192
    v_add_f32 v9, v9, v193
    v_cvt_pk_bf16_f32 v146, v192, v193
    v_exp_f32 v194, v194
    v_exp_f32 v195, v195
    v_add_f32 v9, v9, v194
    v_add_f32 v9, v9, v195
    v_cvt_pk_bf16_f32 v147, v194, v195
    v_exp_f32 v196, v196
    v_exp_f32 v197, v197
    v_add_f32 v10, v10, v196
    v_add_f32 v10, v10, v197
    v_cvt_pk_bf16_f32 v150, v196, v197
    v_exp_f32 v198, v198
    v_exp_f32 v199, v199
    v_add_f32 v10, v10, v198
    v_add_f32 v10, v10, v199
    v_cvt_pk_bf16_f32 v151, v198, v199
    v_mov_b32 v16, v9
    v_mov_b32 v18, v10
    s_nop 0
    v_permlane16_swap_b32 v9, v16
    v_permlane16_swap_b32 v10, v18
    v_add_f32 v9, v9, v16
    v_add_f32 v10, v10, v18
    v_mov_b32 v16, v9
    v_mov_b32 v18, v10
    s_nop 0
    v_permlane32_swap_b32 v9, v16
    v_permlane32_swap_b32 v10, v18
    v_add_f32 v9, v9, v16
    v_add_f32 v10, v10, v18
    s_waitcnt vmcnt(0) lgkmcnt(0)
    s_nop 15
    s_nop 3
    s_branch adaLN_cond__sliding_block_cached__moe_arch_mod__prompt_kernel_fixBb
adaLN_cond__sliding_block_cached__moe_arch_mod__prompt_kernel_o17r:
    s_waitcnt vmcnt(0) lgkmcnt(0)
    s_nop 15
    s_nop 3
    s_mov_b32 s27, 0
adaLN_cond__sliding_block_cached__moe_arch_mod__prompt_kernel_o17p:
    buffer_load_dword v12, v13, s[8:11], s19 offen sc1
    s_waitcnt vmcnt(0)
    v_cmp_ne_u32 vcc, s28, v12
    s_add_u32 s27, s27, 1
    s_cmp_ge_u32 s27, 65536
    s_cbranch_scc1 adaLN_cond__sliding_block_cached__moe_arch_mod__prompt_kernel_o17g
    s_cbranch_vccnz adaLN_cond__sliding_block_cached__moe_arch_mod__prompt_kernel_o17p
adaLN_cond__sliding_block_cached__moe_arch_mod__prompt_kernel_o17g:
    s_waitcnt vmcnt(0) lgkmcnt(0)
    s_nop 15
    s_nop 3
    s_branch adaLN_cond__sliding_block_cached__moe_arch_mod__prompt_kernel_o17b
adaLN_cond__sliding_block_cached__moe_arch_mod__prompt_kernel_o218r:
    s_waitcnt vmcnt(0) lgkmcnt(0)
    s_nop 15
    s_nop 3
    s_mov_b32 s27, 0
adaLN_cond__sliding_block_cached__moe_arch_mod__prompt_kernel_o218p:
    buffer_load_dword v12, v13, s[8:11], s19 offen sc1
    s_waitcnt vmcnt(0)
    v_cmp_ne_u32 vcc, s28, v12
    s_add_u32 s27, s27, 1
    s_cmp_ge_u32 s27, 65536
    s_cbranch_scc1 adaLN_cond__sliding_block_cached__moe_arch_mod__prompt_kernel_o218g
    s_cbranch_vccnz adaLN_cond__sliding_block_cached__moe_arch_mod__prompt_kernel_o218p
adaLN_cond__sliding_block_cached__moe_arch_mod__prompt_kernel_o218g:
    s_waitcnt vmcnt(0) lgkmcnt(0)
    s_nop 15
    s_nop 3
    s_branch adaLN_cond__sliding_block_cached__moe_arch_mod__prompt_kernel_o218b
adaLN_cond__sliding_block_cached__moe_arch_mod__prompt_kernel_o219r:
    s_waitcnt vmcnt(0) lgkmcnt(0)
    s_nop 15
    s_nop 3
    s_mov_b32 s27, 0
adaLN_cond__sliding_block_cached__moe_arch_mod__prompt_kernel_o219p:
    buffer_load_dword v12, v13, s[8:11], s19 offen sc1
    s_waitcnt vmcnt(0)
    v_cmp_ne_u32 vcc, s28, v12
    s_add_u32 s27, s27, 1
    s_cmp_ge_u32 s27, 65536
    s_cbranch_scc1 adaLN_cond__sliding_block_cached__moe_arch_mod__prompt_kernel_o219g
    s_cbranch_vccnz adaLN_cond__sliding_block_cached__moe_arch_mod__prompt_kernel_o219p
adaLN_cond__sliding_block_cached__moe_arch_mod__prompt_kernel_o219g:
    s_waitcnt vmcnt(0) lgkmcnt(0)
    s_nop 15
    s_nop 3
    s_branch adaLN_cond__sliding_block_cached__moe_arch_mod__prompt_kernel_o219b
adaLN_cond__sliding_block_cached__moe_arch_mod__prompt_kernel_o220r:
    s_waitcnt vmcnt(0) lgkmcnt(0)
    s_nop 15
    s_nop 3
    s_mov_b32 s27, 0
adaLN_cond__sliding_block_cached__moe_arch_mod__prompt_kernel_o220p:
    buffer_load_dword v12, v13, s[8:11], s19 offen sc1
    s_waitcnt vmcnt(0)
    v_cmp_ne_u32 vcc, s28, v12
    s_add_u32 s27, s27, 1
    s_cmp_ge_u32 s27, 65536
    s_cbranch_scc1 adaLN_cond__sliding_block_cached__moe_arch_mod__prompt_kernel_o220g
    s_cbranch_vccnz adaLN_cond__sliding_block_cached__moe_arch_mod__prompt_kernel_o220p
adaLN_cond__sliding_block_cached__moe_arch_mod__prompt_kernel_o220g:
    s_waitcnt vmcnt(0) lgkmcnt(0)
    s_nop 15
    s_nop 3
    s_branch adaLN_cond__sliding_block_cached__moe_arch_mod__prompt_kernel_o220b
adaLN_cond__sliding_block_cached__moe_arch_mod__prompt_kernel_mf21r:
    s_waitcnt vmcnt(0) lgkmcnt(0)
    s_nop 15
    s_nop 3
    s_mov_b32 s27, 0
adaLN_cond__sliding_block_cached__moe_arch_mod__prompt_kernel_mf21p:
    s_mov_b32 s16, 0x544000
    buffer_load_dwordx4 v[184:187], v2, s[8:11], s16 offen sc1
    s_waitcnt vmcnt(0)
    v_xor_b32 v16, s28, v184
    v_xor_b32 v17, s28, v185
    v_xor_b32 v18, s28, v186
    v_xor_b32 v19, s28, v187
    v_or3_b32 v16, v16, v17, v18
    v_or_b32 v16, v16, v19
    v_cmp_ne_u32 vcc, 0, v16
    s_add_u32 s27, s27, 1
    s_cmp_ge_u32 s27, 65536
    s_cbranch_scc1 adaLN_cond__sliding_block_cached__moe_arch_mod__prompt_kernel_mf21g
    s_cbranch_vccnz adaLN_cond__sliding_block_cached__moe_arch_mod__prompt_kernel_mf21p
adaLN_cond__sliding_block_cached__moe_arch_mod__prompt_kernel_mf21g:
    s_waitcnt vmcnt(0) lgkmcnt(0)
    s_nop 15
    s_nop 3
    s_branch adaLN_cond__sliding_block_cached__moe_arch_mod__prompt_kernel_mf21b
adaLN_cond__sliding_block_cached__moe_arch_mod__prompt_kernel_codeend:
    s_endpgm
.section .rodata,"a"
.p2align 6
.amdhsa_kernel adaLN_cond__sliding_block_cached__moe_arch_mod__prompt_kernel
  .amdhsa_next_free_vgpr 256
  .amdhsa_next_free_sgpr 80
  .amdhsa_accum_offset 256
  .amdhsa_group_segment_fixed_size 0
  .amdhsa_kernarg_size 120
  .amdhsa_user_sgpr_count 2
  .amdhsa_user_sgpr_kernarg_segment_ptr 1
  .amdhsa_system_sgpr_workgroup_id_x 1
  .amdhsa_float_denorm_mode_32 3
.end_amdhsa_kernel
```

```asm
; @launch grid=(256,1,1) block=(512,1,1) lds=163840
.amdgcn_target "amdgcn-amd-amdhsa--gfx950"
.text
.globl adaLN_cond__sliding_block_cached__moe_arch_mod__prompt_kernel
.p2align 8
.type adaLN_cond__sliding_block_cached__moe_arch_mod__prompt_kernel,@function
adaLN_cond__sliding_block_cached__moe_arch_mod__prompt_kernel:
    s_cmp_ge_u32 s2, 256
    s_cbranch_scc1 adaLN_cond__sliding_block_cached__moe_arch_mod__prompt_kernel_end
    s_getpc_b64 s[76:77]
adaLN_cond__sliding_block_cached__moe_arch_mod__prompt_kernel_pc0:
    s_sub_u32 s76, s76, adaLN_cond__sliding_block_cached__moe_arch_mod__prompt_kernel_pc0-adaLN_cond__sliding_block_cached__moe_arch_mod__prompt_kernel
    s_subb_u32 s77, s77, 0
    v_and_b32 v16, 63, v0
    v_lshlrev_b32 v16, 7, v16
    v_lshrrev_b32 v17, 6, v0
    s_lshr_b32 s62, s2, 3
    s_lshl_b32 s62, s62, 13
    v_lshlrev_b32 v18, 13, v17
    v_mov_b32 v19, s62
    v_cmp_eq_u32 vcc, 7, v17
    s_nop 1
    v_cndmask_b32 v18, v18, v19, vcc
    v_add_u32 v16, v16, v18
    v_min_u32 v16, adaLN_cond__sliding_block_cached__moe_arch_mod__prompt_kernel_codeend-adaLN_cond__sliding_block_cached__moe_arch_mod__prompt_kernel-4, v16
    v_mov_b32 v25, s77
    v_add_co_u32 v24, vcc, s76, v16
    s_nop 1
    v_addc_co_u32 v25, vcc, 0, v25, vcc
    v_cmp_gt_u32 vcc, 2, v17
    v_cmp_eq_u32 s[62:63], 7, v17
    s_or_b64 vcc, vcc, s[62:63]
    s_and_saveexec_b64 s[62:63], vcc
    s_cbranch_execz adaLN_cond__sliding_block_cached__moe_arch_mod__prompt_kernel_nocp0
    global_load_dword v26, v[24:25], off
adaLN_cond__sliding_block_cached__moe_arch_mod__prompt_kernel_nocp0:
    s_mov_b64 exec, s[62:63]
    s_load_dwordx4 s[56:59], s[0:1], 96
    s_load_dwordx2 s[60:61], s[0:1], 112
    s_load_dwordx8 s[48:55], s[0:1], 64
    s_load_dwordx16 s[32:47], s[0:1], 0
    s_memrealtime s[62:63]
    v_lshrrev_b32 v16, 6, v0
    v_and_b32 v1, 63, v0
    v_readfirstlane_b32 s3, v16
    v_lshlrev_b32 v2, 4, v1
    s_and_b32 s12, s2, 3
    s_lshl_b32 s12, s12, 3
    s_bfe_u32 s13, s2, 0x30003
    s_add_u32 s12, s12, s13
    s_bfe_u32 s13, s2, 0x10002
    s_lshl_b32 s13, s13, 2
    s_lshr_b32 s14, s2, 6
    s_add_u32 s13, s13, s14
    v_bfe_u32 v16, v1, 2, 2
    v_lshrrev_b32 v17, 4, v1
    v_and_b32 v18, 3, v1
    v_lshlrev_b32 v19, 6, v17
    v_lshl_add_u32 v19, v18, 4, v19
    v_lshl_add_u32 v3, v16, 13, v19
    s_and_b32 s14, s3, 1
    s_lshl_b32 s14, s14, 5
    v_xor_b32 v3, s14, v3
    v_lshlrev_b32 v4, 11, v17
    v_lshl_add_u32 v4, v16, 6, v4
    v_lshl_add_u32 v4, v18, 3, v4
    v_and_b32 v20, 1, v17
    v_lshlrev_b32 v20, 5, v20
    v_sub_u32 v5, v4, v20
    v_add_u32 v4, v4, v20
    s_lshl_b32 s14, s13, 3
    s_add_u32 s14, s14, s3
    s_lshl_b32 s14, s14, 16
    v_add_u32 v7, s14, v2
    s_cmp_ge_u32 s3, 4
    s_cbranch_scc1 adaLN_cond__sliding_block_cached__moe_arch_mod__prompt_kernel_roleB
    v_mov_b32 v132, 0
    v_mov_b32 v133, 0
    v_lshrrev_b32 v16, 3, v0
    v_and_b32 v17, 7, v0
    v_mul_u32_u24 v135, 24576, v16
    v_lshl_add_u32 v135, v17, 4, v135
    v_lshlrev_b32 v136, 2, v16
    s_and_b32 s14, s2, 31
    s_lshr_b32 s15, s2, 5
    s_mul_i32 s26, s15, 1572864
    s_lshl_b32 s16, s14, 7
    s_add_u32 s26, s26, s16
    s_lshl_b32 s29, s15, 8
    v_lshlrev_b32 v137, 3, v0
    s_lshl_b32 s18, s2, 3
    s_add_u32 s18, s18, s3
    s_lshl_b32 s18, s18, 11
    v_and_b32 v18, 15, v1
    v_lshrrev_b32 v19, 4, v1
    v_lshlrev_b32 v138, 11, v18
    v_lshl_add_u32 v138, v19, 4, v138
    s_lshr_b32 s30, s2, 4
    s_and_b32 s31, s2, 15
    s_lshl_b32 s19, s30, 3
    s_add_u32 s19, s19, s3
    s_lshl_b32 s22, s19, 15
    s_lshl_b32 s23, s31, 7
    s_add_u32 s22, s22, s23
    s_lshl_b32 s23, s2, 12
    s_add_u32 s23, s23, 0x600000
    s_or_b32 s25, s2, s3
    s_cmp_eq_u32 s25, 0
    s_cselect_b32 s25, 0, 0x7ffffff0
    s_waitcnt lgkmcnt(0)
    s_mov_b64 s[64:65], s[58:59]
    s_mov_b32 s66, 0x100
    s_mov_b32 s67, 0x20000
    s_or_b32 s28, s62, 1
    v_mov_b32 v134, s28
    s_mov_b64 exec, 1
    buffer_store_dword v134, v132, s[64:67], s25 offen sc1
    s_mov_b64 exec, -1
    s_mov_b64 s[68:69], s[52:53]
    s_mov_b32 s70, 0x800
    s_mov_b32 s71, 0x20000
    s_mov_b64 s[72:73], s[54:55]
    s_mov_b32 s74, 0xc00000
    s_mov_b32 s75, 0x20000
    s_mov_b64 s[76:77], s[32:33]
    s_mov_b32 s78, 0x400000
    s_mov_b32 s79, 0x20000
    s_mov_b64 s[8:9], s[60:61]
    s_mov_b32 s10, 0x3400000
    s_mov_b32 s11, 0x20000
    buffer_load_dword v72, v136, s[68:71], s29 offen
    buffer_load_dwordx4 v[24:27], v135, s[72:75], s26 offen
    s_add_u32 s26, s26, 12288
    buffer_load_dwordx4 v[28:31], v135, s[72:75], s26 offen
    buffer_load_dwordx4 v[32:35], v2, s[76:79], s18 offen offset:0
    buffer_load_dwordx4 v[36:39], v2, s[76:79], s18 offen offset:1024
    s_cmp_eq_u32 s3, 0
    s_cselect_b32 s25, 0, 0x7ffffff0
    buffer_load_dword v134, v132, s[64:67], s25 offen sc1
    buffer_store_dwordx2 v[132:133], v137, s[8:11], s23 offen sc1
    s_barrier
    buffer_load_dwordx4 v[40:43], v138, s[76:79], s22 offen offset:0
    buffer_load_dwordx4 v[44:47], v138, s[76:79], s22 offen offset:64
    s_mov_b32 s29, s19
    s_waitcnt vmcnt(8)
    v_and_b32 v73, 0xffff0000, v72
    v_lshlrev_b32 v72, 16, v72
    v_mul_f32 v16, 0xbfb8aa3b, v72
    v_exp_f32 v16, v16
    s_nop 0
    v_add_f32 v16, 1.0, v16
    v_rcp_f32 v16, v16
    s_nop 0
    v_mul_f32 v72, v72, v16
    v_mul_f32 v17, 0xbfb8aa3b, v73
    v_exp_f32 v17, v17
    s_nop 0
    v_add_f32 v17, 1.0, v17
    v_rcp_f32 v17, v17
    s_nop 0
    v_mul_f32 v73, v73, v17
    v_cvt_pk_bf16_f32 v16, v72, v73
    v_lshlrev_b32 v72, 16, v16
    v_and_b32 v73, 0xffff0000, v16
    s_lshl_b32 s16, s2, 8
    s_add_u32 s16, s16, 0x550000
    s_mov_b32 exec_lo, 0x01010101
    s_mov_b32 exec_hi, 0x01010101
    buffer_store_dword v16, v136, s[8:11], s16 offen sc1
    s_mov_b64 exec, -1
    v_lshrrev_b32 v74, 16, v72
    v_lshrrev_b32 v75, 16, v73
    s_waitcnt vmcnt(8)
    v_dot2_f32_bf16 v49, v24, v72, 0
    v_dot2_f32_bf16 v48, v24, v74, 0
    v_dot2_f32_bf16 v51, v25, v72, 0
    v_dot2_f32_bf16 v50, v25, v74, 0
    v_dot2_f32_bf16 v53, v26, v72, 0
    v_dot2_f32_bf16 v52, v26, v74, 0
    v_dot2_f32_bf16 v55, v27, v72, 0
    v_dot2_f32_bf16 v54, v27, v74, 0
    s_waitcnt vmcnt(7)
    v_dot2c_f32_bf16 v49, v28, v73
    v_dot2c_f32_bf16 v48, v28, v75
    v_dot2c_f32_bf16 v51, v29, v73
    v_dot2c_f32_bf16 v50, v29, v75
    v_dot2c_f32_bf16 v53, v30, v73
    v_dot2c_f32_bf16 v52, v30, v75
    v_dot2c_f32_bf16 v55, v31, v73
    v_dot2c_f32_bf16 v54, v31, v75
    s_nop 0
    v_permlane32_swap_b32 v48, v52
    v_permlane32_swap_b32 v49, v53
    v_permlane32_swap_b32 v50, v54
    v_permlane32_swap_b32 v51, v55
    v_add_f32 v48, v48, v52
    v_add_f32 v49, v49, v53
    v_add_f32 v50, v50, v54
    v_add_f32 v51, v51, v55
    s_nop 0
    v_permlane16_swap_b32 v48, v50
    v_permlane16_swap_b32 v49, v51
    v_add_f32 v48, v48, v50
    v_add_f32 v49, v49, v51
    s_nop 0
    v_add_f32_dpp v48, v48, v48 row_ror:8 row_mask:0xf bank_mask:0xf
    v_add_f32_dpp v49, v49, v49 row_ror:8 row_mask:0xf bank_mask:0xf
    v_and_b32 v16, 7, v1
    v_lshlrev_b32 v16, 5, v16
    v_lshrrev_b32 v17, 4, v1
    v_lshl_add_u32 v16, v17, 3, v16
    s_lshl_b32 s16, s3, 8
    s_add_u32 s16, s16, 147456
    v_add_u32 v16, s16, v16
    ds_write_b64 v16, v[48:49]
    s_waitcnt vmcnt(6)
    v_lshlrev_b32 v56, 16, v32
    v_and_b32 v57, 0xffff0000, v32
    v_lshlrev_b32 v58, 16, v33
    v_and_b32 v59, 0xffff0000, v33
    v_lshlrev_b32 v60, 16, v34
    v_and_b32 v61, 0xffff0000, v34
    v_lshlrev_b32 v62, 16, v35
    v_and_b32 v63, 0xffff0000, v35
    s_waitcnt vmcnt(5)
    v_lshlrev_b32 v64, 16, v36
    v_and_b32 v65, 0xffff0000, v36
    v_lshlrev_b32 v66, 16, v37
    v_and_b32 v67, 0xffff0000, v37
    v_lshlrev_b32 v68, 16, v38
    v_and_b32 v69, 0xffff0000, v38
    v_lshlrev_b32 v70, 16, v39
    v_and_b32 v71, 0xffff0000, v39
    v_add_f32 v20, v56, v57
    v_add_f32 v21, v58, v59
    v_add_f32 v20, v20, v60
    v_add_f32 v21, v21, v61
    v_add_f32 v20, v20, v62
    v_add_f32 v21, v21, v63
    v_add_f32 v20, v20, v64
    v_add_f32 v21, v21, v65
    v_add_f32 v20, v20, v66
    v_add_f32 v21, v21, v67
    v_add_f32 v20, v20, v68
    v_add_f32 v21, v21, v69
    v_add_f32 v20, v20, v70
    v_add_f32 v21, v21, v71
    v_add_f32 v128, v20, v21
    s_nop 1
    v_add_f32_dpp v128, v128, v128 row_ror:1 row_mask:0xf bank_mask:0xf
    s_nop 1
    v_add_f32_dpp v128, v128, v128 row_ror:2 row_mask:0xf bank_mask:0xf
    s_nop 1
    v_add_f32_dpp v128, v128, v128 row_ror:4 row_mask:0xf bank_mask:0xf
    s_nop 1
    v_add_f32_dpp v128, v128, v128 row_ror:8 row_mask:0xf bank_mask:0xf
    v_mov_b32 v20, v128
    s_nop 1
    v_permlane16_swap_b32 v128, v20
    v_add_f32 v128, v128, v20
    v_mov_b32 v20, v128
    s_nop 1
    v_permlane32_swap_b32 v128, v20
    v_add_f32 v128, v128, v20
    v_mul_f32 v128, 0x3a800000, v128
    v_sub_f32 v18, v56, v128
    v_mul_f32 v20, v18, v18
    v_sub_f32 v19, v57, v128
    v_mul_f32 v21, v19, v19
    v_sub_f32 v18, v58, v128
    v_sub_f32 v19, v59, v128
    v_fmac_f32 v20, v18, v18
    v_fmac_f32 v21, v19, v19
    v_sub_f32 v18, v60, v128
    v_sub_f32 v19, v61, v128
    v_fmac_f32 v20, v18, v18
    v_fmac_f32 v21, v19, v19
    v_sub_f32 v18, v62, v128
    v_sub_f32 v19, v63, v128
    v_fmac_f32 v20, v18, v18
    v_fmac_f32 v21, v19, v19
    v_sub_f32 v18, v64, v128
    v_sub_f32 v19, v65, v128
    v_fmac_f32 v20, v18, v18
    v_fmac_f32 v21, v19, v19
    v_sub_f32 v18, v66, v128
    v_sub_f32 v19, v67, v128
    v_fmac_f32 v20, v18, v18
    v_fmac_f32 v21, v19, v19
    v_sub_f32 v18, v68, v128
    v_sub_f32 v19, v69, v128
    v_fmac_f32 v20, v18, v18
    v_fmac_f32 v21, v19, v19
    v_sub_f32 v18, v70, v128
    v_sub_f32 v19, v71, v128
    v_fmac_f32 v20, v18, v18
    v_fmac_f32 v21, v19, v19
    v_add_f32 v17, v20, v21
    s_nop 1
    v_add_f32_dpp v17, v17, v17 row_ror:1 row_mask:0xf bank_mask:0xf
    s_nop 1
    v_add_f32_dpp v17, v17, v17 row_ror:2 row_mask:0xf bank_mask:0xf
    s_nop 1
    v_add_f32_dpp v17, v17, v17 row_ror:4 row_mask:0xf bank_mask:0xf
    s_nop 1
    v_add_f32_dpp v17, v17, v17 row_ror:8 row_mask:0xf bank_mask:0xf
    v_mov_b32 v20, v17
    s_nop 1
    v_permlane16_swap_b32 v17, v20
    v_add_f32 v17, v17, v20
    v_mov_b32 v20, v17
    s_nop 1
    v_permlane32_swap_b32 v17, v20
    v_add_f32 v17, v17, v20
    v_mul_f32 v17, 0x3a800000, v17
    v_cvt_pk_bf16_f32 v128, v128, v128
    v_lshlrev_b32 v128, 16, v128
    v_cvt_pk_bf16_f32 v17, v17, v17
    v_lshlrev_b32 v17, 16, v17
    v_add_f32 v17, 0x3727c5ac, v17
    v_cvt_pk_bf16_f32 v17, v17, v17
    v_lshlrev_b32 v17, 16, v17
    v_sqrt_f32 v129, v17
    s_nop 0
    v_cvt_pk_bf16_f32 v129, v129, v129
    v_lshlrev_b32 v129, 16, v129
    v_rcp_f32 v130, v129
    s_lshl_b32 s16, s3, 4
    s_add_u32 s16, s16, 149520
    v_mov_b32 v19, s16
    ds_write_b128 v19, v[128:131]
    s_waitcnt vmcnt(4)
    v_cmp_eq_u32 vcc, 0, v134
    s_cmp_eq_u32 s3, 0
    s_cselect_b64 s[62:63], -1, 0
    s_and_b64 vcc, vcc, s[62:63]
    s_cbranch_vccnz adaLN_cond__sliding_block_cached__moe_arch_mod__prompt_kernel_n1r
adaLN_cond__sliding_block_cached__moe_arch_mod__prompt_kernel_n1b:
    v_mov_b32 v19, 149504
    s_cmp_eq_u32 s3, 0
    s_cselect_b64 exec, 1, 0
    ds_write_b32 v19, v134
    s_mov_b64 exec, -1
    v_mov_b32 v19, 149504
    v_and_b32 v17, 31, v1
    v_lshlrev_b32 v18, 3, v17
    v_add_u32 v18, 147456, v18
    v_lshlrev_b32 v17, 4, v17
    s_waitcnt lgkmcnt(0)
    s_barrier
    ds_read_b32 v134, v19
    ds_read_b64 v[96:97], v18 offset:0
    ds_read_b64 v[100:101], v18 offset:256
    ds_read_b64 v[104:105], v18 offset:512
    ds_read_b64 v[108:109], v18 offset:768
    ds_read_b64 v[112:113], v18 offset:1024
    ds_read_b64 v[116:117], v18 offset:1280
    ds_read_b64 v[120:121], v18 offset:1536
    ds_read_b64 v[124:125], v18 offset:1792
    s_waitcnt lgkmcnt(8)
    v_readfirstlane_b32 s28, v134
    v_and_b32 v20, 7, v1
    v_lshlrev_b32 v20, 4, v20
    v_add_u32 v21, 149520, v20
    ds_read_b128 v[128:131], v21
    s_waitcnt lgkmcnt(0)
    v_mov_b32 v131, s28
    s_lshl_b32 s16, s2, 7
    s_add_u32 s16, s16, 0x520000
    s_cmp_eq_u32 s3, 0
    s_cselect_b32 s16, s16, 0x7ffffff0
    s_mov_b64 exec, 0xff
    buffer_store_dwordx4 v[128:131], v20, s[8:11], s16 offen sc1
    s_mov_b64 exec, -1
    v_pk_add_f32 v[96:97], v[96:97], v[112:113]
    v_pk_add_f32 v[100:101], v[100:101], v[116:117]
    v_pk_add_f32 v[104:105], v[104:105], v[120:121]
    v_pk_add_f32 v[108:109], v[108:109], v[124:125]
    v_pk_add_f32 v[96:97], v[96:97], v[104:105]
    v_pk_add_f32 v[100:101], v[100:101], v[108:109]
    v_pk_add_f32 v[96:97], v[96:97], v[100:101]
    v_mov_b32 v98, s28
    v_mov_b32 v99, s28
    s_lshl_b32 s16, s14, 3
    s_add_u32 s16, s16, s15
    s_lshl_b32 s16, s16, 9
    s_add_u32 s16, s16, 0x500000
    s_cmp_eq_u32 s3, 0
    s_cselect_b32 s16, s16, 0x7ffffff0
    s_mov_b64 exec, 0xffffffff
    buffer_store_dwordx4 v[96:99], v17, s[8:11], s16 offen sc1
    s_mov_b64 exec, -1
    s_lshr_b32 s16, s3, 2
    s_lshl_b32 s16, s16, 4
    s_add_u32 s16, s16, s31
    s_lshl_b32 s16, s16, 12
    s_and_b32 s17, s3, 3
    s_lshl_b32 s17, s17, 7
    s_add_u32 s16, s16, s17
    s_add_u32 s16, s16, 0x500000
    v_lshrrev_b32 v139, 3, v1
    v_lshlrev_b32 v139, 9, v139
    v_and_b32 v16, 7, v1
    v_lshl_add_u32 v139, v16, 4, v139
    v_and_b32 v140, 15, v1
    v_lshlrev_b32 v140, 4, v140
    s_lshl_b32 s17, s29, 8
    s_add_u32 s17, s17, 0x520000
    s_waitcnt vmcnt(4)
    v_lshlrev_b32 v56, 16, v40
    v_and_b32 v57, 0xffff0000, v40
    v_lshlrev_b32 v58, 16, v41
    v_and_b32 v59, 0xffff0000, v41
    v_lshlrev_b32 v60, 16, v42
    v_and_b32 v61, 0xffff0000, v42
    v_lshlrev_b32 v62, 16, v43
    v_and_b32 v63, 0xffff0000, v43
    s_waitcnt vmcnt(3)
    v_lshlrev_b32 v64, 16, v44
    v_and_b32 v65, 0xffff0000, v44
    v_lshlrev_b32 v66, 16, v45
    v_and_b32 v67, 0xffff0000, v45
    v_lshlrev_b32 v68, 16, v46
    v_and_b32 v69, 0xffff0000, v46
    v_lshlrev_b32 v70, 16, v47
    v_and_b32 v71, 0xffff0000, v47
    s_mov_b32 s27, 0
adaLN_cond__sliding_block_cached__moe_arch_mod__prompt_kernel_g2p:
    buffer_load_dwordx4 v[76:79], v139, s[8:11], s16 offen sc1
    buffer_load_dwordx4 v[80:83], v140, s[8:11], s17 offen sc1
    s_waitcnt vmcnt(1)
    v_cmp_ne_u32 vcc, s28, v78
    v_cmp_ne_u32 s[62:63], s28, v79
    s_or_b64 vcc, vcc, s[62:63]
    s_waitcnt vmcnt(0)
    v_cmp_ne_u32 s[62:63], s28, v83
    s_or_b64 vcc, vcc, s[62:63]
    s_add_u32 s27, s27, 1
    s_cmp_ge_u32 s27, 65536
    s_cbranch_scc1 adaLN_cond__sliding_block_cached__moe_arch_mod__prompt_kernel_g2g
    s_cbranch_vccnz adaLN_cond__sliding_block_cached__moe_arch_mod__prompt_kernel_g2p
adaLN_cond__sliding_block_cached__moe_arch_mod__prompt_kernel_g2g:
    v_add_f32_dpp v76, v76, v76 row_ror:8 row_mask:0xf bank_mask:0xf
    v_add_f32_dpp v77, v77, v77 row_ror:8 row_mask:0xf bank_mask:0xf
    v_mov_b32 v17, v76
    s_nop 1
    v_permlane16_swap_b32 v76, v17
    v_add_f32 v76, v76, v17
    v_mov_b32 v18, v77
    s_nop 1
    v_permlane16_swap_b32 v77, v18
    v_add_f32 v77, v77, v18
    v_mov_b32 v17, v76
    s_nop 1
    v_permlane32_swap_b32 v76, v17
    v_add_f32 v76, v76, v17
    v_mov_b32 v18, v77
    s_nop 1
    v_permlane32_swap_b32 v77, v18
    v_add_f32 v77, v77, v18
    v_cvt_pk_bf16_f32 v17, v76, v77
    v_lshlrev_b32 v76, 16, v17
    v_and_b32 v77, 0xffff0000, v17
    v_add_f32 v76, 0, v76
    v_add_f32 v77, 0, v77
    s_lshl_b32 s16, s3, 6
    s_add_u32 s16, s16, 151552
    v_lshl_add_u32 v16, v16, 3, s16
    ds_write_b64 v16, v[76:77]
    v_lshrrev_b32 v17, 4, v1
    v_lshlrev_b32 v17, 5, v17
    v_add_u32 v17, 151552, v17
    v_sub_f32 v56, v56, v80
    v_sub_f32 v57, v57, v80
    v_sub_f32 v58, v58, v80
    v_sub_f32 v59, v59, v80
    v_sub_f32 v60, v60, v80
    v_sub_f32 v61, v61, v80
    v_sub_f32 v62, v62, v80
    v_sub_f32 v63, v63, v80
    v_sub_f32 v64, v64, v80
    v_sub_f32 v65, v65, v80
    v_sub_f32 v66, v66, v80
    v_sub_f32 v67, v67, v80
    v_sub_f32 v68, v68, v80
    v_sub_f32 v69, v69, v80
    v_sub_f32 v70, v70, v80
    v_sub_f32 v71, v71, v80
    v_cvt_pk_bf16_f32 v18, v56, v57
    v_lshlrev_b32 v56, 16, v18
    v_and_b32 v57, 0xffff0000, v18
    v_cvt_pk_bf16_f32 v19, v58, v59
    v_lshlrev_b32 v58, 16, v19
    v_and_b32 v59, 0xffff0000, v19
    v_cvt_pk_bf16_f32 v18, v60, v61
    v_lshlrev_b32 v60, 16, v18
    v_and_b32 v61, 0xffff0000, v18
    v_cvt_pk_bf16_f32 v19, v62, v63
    v_lshlrev_b32 v62, 16, v19
    v_and_b32 v63, 0xffff0000, v19
    v_cvt_pk_bf16_f32 v18, v64, v65
    v_lshlrev_b32 v64, 16, v18
    v_and_b32 v65, 0xffff0000, v18
    v_cvt_pk_bf16_f32 v19, v66, v67
    v_lshlrev_b32 v66, 16, v19
    v_and_b32 v67, 0xffff0000, v19
    v_cvt_pk_bf16_f32 v18, v68, v69
    v_lshlrev_b32 v68, 16, v18
    v_and_b32 v69, 0xffff0000, v18
    v_cvt_pk_bf16_f32 v19, v70, v71
    v_lshlrev_b32 v70, 16, v19
    v_and_b32 v71, 0xffff0000, v19
    v_mul_f32 v56, v56, v82
    v_mul_f32 v57, v57, v82
    v_mul_f32 v58, v58, v82
    v_mul_f32 v59, v59, v82
    v_mul_f32 v60, v60, v82
    v_mul_f32 v61, v61, v82
    v_mul_f32 v62, v62, v82
    v_mul_f32 v63, v63, v82
    v_mul_f32 v64, v64, v82
    v_mul_f32 v65, v65, v82
    v_mul_f32 v66, v66, v82
    v_mul_f32 v67, v67, v82
    v_mul_f32 v68, v68, v82
    v_mul_f32 v69, v69, v82
    v_mul_f32 v70, v70, v82
    v_mul_f32 v71, v71, v82
    v_cvt_pk_bf16_f32 v18, v56, v57
    v_lshlrev_b32 v56, 16, v18
    v_and_b32 v57, 0xffff0000, v18
    v_cvt_pk_bf16_f32 v19, v58, v59
    v_lshlrev_b32 v58, 16, v19
    v_and_b32 v59, 0xffff0000, v19
    v_cvt_pk_bf16_f32 v18, v60, v61
    v_lshlrev_b32 v60, 16, v18
    v_and_b32 v61, 0xffff0000, v18
    v_cvt_pk_bf16_f32 v19, v62, v63
    v_lshlrev_b32 v62, 16, v19
    v_and_b32 v63, 0xffff0000, v19
    v_cvt_pk_bf16_f32 v18, v64, v65
    v_lshlrev_b32 v64, 16, v18
    v_and_b32 v65, 0xffff0000, v18
    v_cvt_pk_bf16_f32 v19, v66, v67
    v_lshlrev_b32 v66, 16, v19
    v_and_b32 v67, 0xffff0000, v19
    v_cvt_pk_bf16_f32 v18, v68, v69
    v_lshlrev_b32 v68, 16, v18
    v_and_b32 v69, 0xffff0000, v18
    v_cvt_pk_bf16_f32 v19, v70, v71
    v_lshlrev_b32 v70, 16, v19
    v_and_b32 v71, 0xffff0000, v19
    s_lshl_b32 s16, s29, 15
    s_lshl_b32 s17, s31, 11
    s_add_u32 s16, s16, s17
    s_waitcnt lgkmcnt(0)
    s_barrier
    ds_read_b128 v[96:99], v17 offset:256
    ds_read_b128 v[104:107], v17 offset:0
    ds_read_b128 v[100:103], v17 offset:272
    ds_read_b128 v[108:111], v17 offset:16
    ds_read_b128 v[112:115], v17 offset:384
    ds_read_b128 v[120:123], v17 offset:128
    ds_read_b128 v[116:119], v17 offset:400
    ds_read_b128 v[124:127], v17 offset:144
    s_waitcnt lgkmcnt(7)
    v_pk_mul_f32 v[56:57], v[56:57], v[96:97]
    v_pk_mul_f32 v[58:59], v[58:59], v[98:99]
    s_waitcnt lgkmcnt(5)
    v_pk_mul_f32 v[60:61], v[60:61], v[100:101]
    v_pk_mul_f32 v[62:63], v[62:63], v[102:103]
    v_cvt_pk_bf16_f32 v18, v56, v57
    v_lshlrev_b32 v56, 16, v18
    v_and_b32 v57, 0xffff0000, v18
    v_cvt_pk_bf16_f32 v19, v58, v59
    v_lshlrev_b32 v58, 16, v19
    v_and_b32 v59, 0xffff0000, v19
    v_cvt_pk_bf16_f32 v18, v60, v61
    v_lshlrev_b32 v60, 16, v18
    v_and_b32 v61, 0xffff0000, v18
    v_cvt_pk_bf16_f32 v19, v62, v63
    v_lshlrev_b32 v62, 16, v19
    v_and_b32 v63, 0xffff0000, v19
    v_pk_add_f32 v[56:57], v[56:57], v[104:105]
    v_pk_add_f32 v[58:59], v[58:59], v[106:107]
    s_waitcnt lgkmcnt(4)
    v_pk_add_f32 v[60:61], v[60:61], v[108:109]
    v_pk_add_f32 v[62:63], v[62:63], v[110:111]
    v_cvt_pk_bf16_f32 v32, v56, v57
    v_cvt_pk_bf16_f32 v33, v58, v59
    v_cvt_pk_bf16_f32 v34, v60, v61
    v_cvt_pk_bf16_f32 v35, v62, v63
    buffer_store_dwordx4 v[32:35], v2, s[8:11], s16 offen offset:0 sc1
    s_waitcnt lgkmcnt(3)
    v_pk_mul_f32 v[64:65], v[64:65], v[112:113]
    v_pk_mul_f32 v[66:67], v[66:67], v[114:115]
    s_waitcnt lgkmcnt(1)
    v_pk_mul_f32 v[68:69], v[68:69], v[116:117]
    v_pk_mul_f32 v[70:71], v[70:71], v[118:119]
    v_cvt_pk_bf16_f32 v18, v64, v65
    v_lshlrev_b32 v64, 16, v18
    v_and_b32 v65, 0xffff0000, v18
    v_cvt_pk_bf16_f32 v19, v66, v67
    v_lshlrev_b32 v66, 16, v19
    v_and_b32 v67, 0xffff0000, v19
    v_cvt_pk_bf16_f32 v18, v68, v69
    v_lshlrev_b32 v68, 16, v18
    v_and_b32 v69, 0xffff0000, v18
    v_cvt_pk_bf16_f32 v19, v70, v71
    v_lshlrev_b32 v70, 16, v19
    v_and_b32 v71, 0xffff0000, v19
    v_pk_add_f32 v[64:65], v[64:65], v[120:121]
    v_pk_add_f32 v[66:67], v[66:67], v[122:123]
    s_waitcnt lgkmcnt(0)
    v_pk_add_f32 v[68:69], v[68:69], v[124:125]
    v_pk_add_f32 v[70:71], v[70:71], v[126:127]
    v_cvt_pk_bf16_f32 v36, v64, v65
    v_cvt_pk_bf16_f32 v37, v66, v67
    v_cvt_pk_bf16_f32 v38, v68, v69
    v_cvt_pk_bf16_f32 v39, v70, v71
    buffer_store_dwordx4 v[36:39], v2, s[8:11], s16 offen offset:1024 sc1
    s_lshl_b32 s19, s3, 16
    s_lshl_b32 s20, s3, 11
    s_lshl_b32 s16, s12, 8
    s_add_u32 s4, s38, s16
    s_addc_u32 s5, s39, 0
    s_sub_u32 s6, 0x800000, s16
    s_mov_b32 s7, 0x20000
    v_mov_b32 v134, s28
    s_lshl_b32 s16, s29, 4
    s_add_u32 s16, s16, s31
    s_lshl_b32 s16, s16, 2
    s_add_u32 s16, s16, 0x528000
    v_and_b32 v16, 31, v1
    v_lshlrev_b32 v16, 2, v16
    s_lshl_b32 s17, s13, 3
    s_add_u32 s17, s17, s3
    s_lshl_b32 s17, s17, 7
    s_add_u32 s17, s17, 0x528000
    s_waitcnt vmcnt(0)
    s_mov_b64 exec, 1
    buffer_store_dword v134, v132, s[8:11], s16 offen sc1
    s_mov_b64 exec, -1
    s_add_u32 s22, s19, 0x0
    s_add_u32 m0, s20, 0x0
    s_nop 0
    buffer_load_dwordx4 v3, s[4:7], s22 offen lds
    s_add_u32 s22, s19, 0x8000
    s_add_u32 m0, s20, 0x400
    s_nop 0
    buffer_load_dwordx4 v3, s[4:7], s22 offen lds
    s_add_u32 s22, s19, 0x80000
    s_add_u32 m0, s20, 0x4000
    s_nop 0
    buffer_load_dwordx4 v3, s[4:7], s22 offen lds
    s_add_u32 s22, s19, 0x88000
    s_add_u32 m0, s20, 0x4400
    s_nop 0
    buffer_load_dwordx4 v3, s[4:7], s22 offen lds
    s_add_u32 s22, s19, 0x100000
    s_add_u32 m0, s20, 0x8000
    s_nop 0
    buffer_load_dwordx4 v3, s[4:7], s22 offen lds
    s_add_u32 s22, s19, 0x108000
    s_add_u32 m0, s20, 0x8400
    s_nop 0
    buffer_load_dwordx4 v3, s[4:7], s22 offen lds
    s_sleep 40
    s_mov_b32 s27, 0
adaLN_cond__sliding_block_cached__moe_arch_mod__prompt_kernel_h3p:
    buffer_load_dword v17, v16, s[8:11], s17 offen sc1
    s_waitcnt vmcnt(0)
    v_cmp_ne_u32 vcc, s28, v17
    s_add_u32 s27, s27, 1
    s_cmp_ge_u32 s27, 65536
    s_cbranch_scc1 adaLN_cond__sliding_block_cached__moe_arch_mod__prompt_kernel_h3g
    s_cbranch_vccnz adaLN_cond__sliding_block_cached__moe_arch_mod__prompt_kernel_h3p
adaLN_cond__sliding_block_cached__moe_arch_mod__prompt_kernel_h3g:
    s_mov_b32 s23, 0x0
    buffer_load_dwordx4 v[88:91], v7, s[8:11], s23 offen offset:0 sc1
    s_mov_b32 s23, 0x8000
    buffer_load_dwordx4 v[92:95], v7, s[8:11], s23 offen offset:0 sc1
    s_mov_b32 s23, 0x0
    buffer_load_dwordx4 v[96:99], v7, s[8:11], s23 offen offset:1024 sc1
    s_mov_b32 s23, 0x8000
    buffer_load_dwordx4 v[100:103], v7, s[8:11], s23 offen offset:1024 sc1
    s_mov_b32 s23, 0x800
    buffer_load_dwordx4 v[104:107], v7, s[8:11], s23 offen offset:0 sc1
    s_mov_b32 s23, 0x8800
    buffer_load_dwordx4 v[108:111], v7, s[8:11], s23 offen offset:0 sc1
    s_mov_b32 s23, 0x800
    buffer_load_dwordx4 v[112:115], v7, s[8:11], s23 offen offset:1024 sc1
    s_mov_b32 s23, 0x8800
    buffer_load_dwordx4 v[116:119], v7, s[8:11], s23 offen offset:1024 sc1
    s_lshr_b32 s21, s12, 3
    s_lshl_b32 s21, s21, 17
    s_add_u32 s21, s21, s20
    s_add_u32 s21, s21, 0x400000
    s_barrier
    ds_read_b64_tr_b16 v[224:225], v4 offset:0
    ds_read_b64_tr_b16 v[226:227], v4 offset:1024
    ds_read_b64_tr_b16 v[228:229], v5 offset:32
    ds_read_b64_tr_b16 v[230:231], v5 offset:1056
    ds_read_b64_tr_b16 v[232:233], v4 offset:256
    ds_read_b64_tr_b16 v[234:235], v4 offset:1280
    ds_read_b64_tr_b16 v[236:237], v5 offset:288
    ds_read_b64_tr_b16 v[238:239], v5 offset:1312
    s_waitcnt vmcnt(7) lgkmcnt(6)
    v_mfma_f32_16x16x32_bf16 v[24:27], v[224:227], v[88:91], 0
    ds_read_b64_tr_b16 v[240:241], v4 offset:512
    s_waitcnt vmcnt(6)
    v_mfma_f32_16x16x32_bf16 v[28:31], v[224:227], v[92:95], 0
    ds_read_b64_tr_b16 v[242:243], v4 offset:1536
    s_waitcnt lgkmcnt(6)
    v_mfma_f32_16x16x32_bf16 v[32:35], v[228:231], v[88:91], 0
    ds_read_b64_tr_b16 v[244:245], v5 offset:544
    v_mfma_f32_16x16x32_bf16 v[36:39], v[228:231], v[92:95], 0
    ds_read_b64_tr_b16 v[246:247], v5 offset:1568
    s_mov_b32 s23, 0x1000
    buffer_load_dwordx4 v[120:123], v7, s[8:11], s23 offen offset:0 sc1
    s_waitcnt lgkmcnt(6)
    v_mfma_f32_16x16x32_bf16 v[40:43], v[232:235], v[88:91], 0
    ds_read_b64_tr_b16 v[224:225], v4 offset:768
    v_mfma_f32_16x16x32_bf16 v[44:47], v[232:235], v[92:95], 0
    ds_read_b64_tr_b16 v[226:227], v4 offset:1792
    s_waitcnt lgkmcnt(6)
    v_mfma_f32_16x16x32_bf16 v[48:51], v[236:239], v[88:91], 0
    ds_read_b64_tr_b16 v[228:229], v5 offset:800
    v_mfma_f32_16x16x32_bf16 v[52:55], v[236:239], v[92:95], 0
    ds_read_b64_tr_b16 v[230:231], v5 offset:1824
    s_waitcnt lgkmcnt(6)
    v_mfma_f32_16x16x32_bf16 v[56:59], v[240:243], v[88:91], 0
    ds_read_b64_tr_b16 v[232:233], v4 offset:8192
    v_mfma_f32_16x16x32_bf16 v[60:63], v[240:243], v[92:95], 0
    ds_read_b64_tr_b16 v[234:235], v4 offset:9216
    s_waitcnt lgkmcnt(6)
    v_mfma_f32_16x16x32_bf16 v[64:67], v[244:247], v[88:91], 0
    ds_read_b64_tr_b16 v[236:237], v5 offset:8224
    v_mfma_f32_16x16x32_bf16 v[68:71], v[244:247], v[92:95], 0
    ds_read_b64_tr_b16 v[238:239], v5 offset:9248
    s_mov_b32 s23, 0x9000
    buffer_load_dwordx4 v[124:127], v7, s[8:11], s23 offen offset:0 sc1
    s_waitcnt lgkmcnt(6)
    v_mfma_f32_16x16x32_bf16 v[72:75], v[224:227], v[88:91], 0
    ds_read_b64_tr_b16 v[240:241], v4 offset:8448
    v_mfma_f32_16x16x32_bf16 v[76:79], v[224:227], v[92:95], 0
    ds_read_b64_tr_b16 v[242:243], v4 offset:9472
    s_waitcnt lgkmcnt(6)
    v_mfma_f32_16x16x32_bf16 v[80:83], v[228:231], v[88:91], 0
    ds_read_b64_tr_b16 v[244:245], v5 offset:8480
    v_mfma_f32_16x16x32_bf16 v[84:87], v[228:231], v[92:95], 0
    ds_read_b64_tr_b16 v[246:247], v5 offset:9504
    s_waitcnt vmcnt(7) lgkmcnt(6)
    v_mfma_f32_16x16x32_bf16 v[24:27], v[232:235], v[96:99], v[24:27]
    ds_read_b64_tr_b16 v[224:225], v4 offset:8704
    s_waitcnt vmcnt(6)
    v_mfma_f32_16x16x32_bf16 v[28:31], v[232:235], v[100:103], v[28:31]
    ds_read_b64_tr_b16 v[226:227], v4 offset:9728
    s_waitcnt lgkmcnt(6)
    v_mfma_f32_16x16x32_bf16 v[32:35], v[236:239], v[96:99], v[32:35]
    ds_read_b64_tr_b16 v[228:229], v5 offset:8736
    v_mfma_f32_16x16x32_bf16 v[36:39], v[236:239], v[100:103], v[36:39]
    ds_read_b64_tr_b16 v[230:231], v5 offset:9760
    s_mov_b32 s23, 0x1000
    buffer_load_dwordx4 v[128:131], v7, s[8:11], s23 offen offset:1024 sc1
    s_waitcnt lgkmcnt(6)
    v_mfma_f32_16x16x32_bf16 v[40:43], v[240:243], v[96:99], v[40:43]
    ds_read_b64_tr_b16 v[232:233], v4 offset:8960
    v_mfma_f32_16x16x32_bf16 v[44:47], v[240:243], v[100:103], v[44:47]
    ds_read_b64_tr_b16 v[234:235], v4 offset:9984
    s_waitcnt lgkmcnt(6)
    v_mfma_f32_16x16x32_bf16 v[48:51], v[244:247], v[96:99], v[48:51]
    ds_read_b64_tr_b16 v[236:237], v5 offset:8992
    v_mfma_f32_16x16x32_bf16 v[52:55], v[244:247], v[100:103], v[52:55]
    ds_read_b64_tr_b16 v[238:239], v5 offset:10016
    s_waitcnt lgkmcnt(6)
    v_mfma_f32_16x16x32_bf16 v[56:59], v[224:227], v[96:99], v[56:59]
    v_mfma_f32_16x16x32_bf16 v[60:63], v[224:227], v[100:103], v[60:63]
    s_barrier
    ds_read_b64_tr_b16 v[240:241], v4 offset:16384
    ds_read_b64_tr_b16 v[242:243], v4 offset:17408
    s_waitcnt lgkmcnt(6)
    v_mfma_f32_16x16x32_bf16 v[64:67], v[228:231], v[96:99], v[64:67]
    ds_read_b64_tr_b16 v[244:245], v5 offset:16416
    v_mfma_f32_16x16x32_bf16 v[68:71], v[228:231], v[100:103], v[68:71]
    s_add_u32 s22, s19, 0x180000
    s_add_u32 m0, s20, 0xc000
    s_nop 0
    buffer_load_dwordx4 v3, s[4:7], s22 offen lds
    ds_read_b64_tr_b16 v[246:247], v5 offset:17440
    s_mov_b32 s23, 0x9000
    buffer_load_dwordx4 v[132:135], v7, s[8:11], s23 offen offset:1024 sc1
    s_waitcnt lgkmcnt(6)
    v_mfma_f32_16x16x32_bf16 v[72:75], v[232:235], v[96:99], v[72:75]
    ds_read_b64_tr_b16 v[224:225], v4 offset:16640
    v_mfma_f32_16x16x32_bf16 v[76:79], v[232:235], v[100:103], v[76:79]
    ds_read_b64_tr_b16 v[226:227], v4 offset:17664
    s_waitcnt lgkmcnt(6)
    v_mfma_f32_16x16x32_bf16 v[80:83], v[236:239], v[96:99], v[80:83]
    ds_read_b64_tr_b16 v[228:229], v5 offset:16672
    v_mfma_f32_16x16x32_bf16 v[84:87], v[236:239], v[100:103], v[84:87]
    ds_read_b64_tr_b16 v[230:231], v5 offset:17696
    s_waitcnt vmcnt(8) lgkmcnt(6)
    v_mfma_f32_16x16x32_bf16 v[24:27], v[240:243], v[104:107], v[24:27]
    ds_read_b64_tr_b16 v[232:233], v4 offset:16896
    s_waitcnt vmcnt(7)
    v_mfma_f32_16x16x32_bf16 v[28:31], v[240:243], v[108:111], v[28:31]
    ds_read_b64_tr_b16 v[234:235], v4 offset:17920
    s_waitcnt lgkmcnt(6)
    v_mfma_f32_16x16x32_bf16 v[32:35], v[244:247], v[104:107], v[32:35]
    ds_read_b64_tr_b16 v[236:237], v5 offset:16928
    v_mfma_f32_16x16x32_bf16 v[36:39], v[244:247], v[108:111], v[36:39]
    s_add_u32 s22, s19, 0x188000
    s_add_u32 m0, s20, 0xc400
    s_nop 0
    buffer_load_dwordx4 v3, s[4:7], s22 offen lds
    ds_read_b64_tr_b16 v[238:239], v5 offset:17952
    s_mov_b32 s23, 0x1800
    buffer_load_dwordx4 v[88:91], v7, s[8:11], s23 offen offset:0 sc1
    s_waitcnt lgkmcnt(6)
    v_mfma_f32_16x16x32_bf16 v[40:43], v[224:227], v[104:107], v[40:43]
    ds_read_b64_tr_b16 v[240:241], v4 offset:17152
    v_mfma_f32_16x16x32_bf16 v[44:47], v[224:227], v[108:111], v[44:47]
    ds_read_b64_tr_b16 v[242:243], v4 offset:18176
    s_waitcnt lgkmcnt(6)
    v_mfma_f32_16x16x32_bf16 v[48:51], v[228:231], v[104:107], v[48:51]
    ds_read_b64_tr_b16 v[244:245], v5 offset:17184
    v_mfma_f32_16x16x32_bf16 v[52:55], v[228:231], v[108:111], v[52:55]
    ds_read_b64_tr_b16 v[246:247], v5 offset:18208
    s_waitcnt lgkmcnt(6)
    v_mfma_f32_16x16x32_bf16 v[56:59], v[232:235], v[104:107], v[56:59]
    ds_read_b64_tr_b16 v[224:225], v4 offset:24576
    v_mfma_f32_16x16x32_bf16 v[60:63], v[232:235], v[108:111], v[60:63]
    ds_read_b64_tr_b16 v[226:227], v4 offset:25600
    s_waitcnt lgkmcnt(6)
    v_mfma_f32_16x16x32_bf16 v[64:67], v[236:239], v[104:107], v[64:67]
    ds_read_b64_tr_b16 v[228:229], v5 offset:24608
    v_mfma_f32_16x16x32_bf16 v[68:71], v[236:239], v[108:111], v[68:71]
    ds_read_b64_tr_b16 v[230:231], v5 offset:25632
    s_mov_b32 s23, 0x9800
    buffer_load_dwordx4 v[92:95], v7, s[8:11], s23 offen offset:0 sc1
    s_waitcnt lgkmcnt(6)
    v_mfma_f32_16x16x32_bf16 v[72:75], v[240:243], v[104:107], v[72:75]
    ds_read_b64_tr_b16 v[232:233], v4 offset:24832
    v_mfma_f32_16x16x32_bf16 v[76:79], v[240:243], v[108:111], v[76:79]
    ds_read_b64_tr_b16 v[234:235], v4 offset:25856
    s_waitcnt lgkmcnt(6)
    v_mfma_f32_16x16x32_bf16 v[80:83], v[244:247], v[104:107], v[80:83]
    ds_read_b64_tr_b16 v[236:237], v5 offset:24864
    v_mfma_f32_16x16x32_bf16 v[84:87], v[244:247], v[108:111], v[84:87]
    ds_read_b64_tr_b16 v[238:239], v5 offset:25888
    s_waitcnt vmcnt(9) lgkmcnt(6)
    v_mfma_f32_16x16x32_bf16 v[24:27], v[224:227], v[112:115], v[24:27]
    ds_read_b64_tr_b16 v[240:241], v4 offset:25088
    s_waitcnt vmcnt(8)
    v_mfma_f32_16x16x32_bf16 v[28:31], v[224:227], v[116:119], v[28:31]
    ds_read_b64_tr_b16 v[242:243], v4 offset:26112
    s_waitcnt lgkmcnt(6)
    v_mfma_f32_16x16x32_bf16 v[32:35], v[228:231], v[112:115], v[32:35]
    ds_read_b64_tr_b16 v[244:245], v5 offset:25120
    v_mfma_f32_16x16x32_bf16 v[36:39], v[228:231], v[116:119], v[36:39]
    ds_read_b64_tr_b16 v[246:247], v5 offset:26144
    s_mov_b32 s23, 0x1800
    buffer_load_dwordx4 v[96:99], v7, s[8:11], s23 offen offset:1024 sc1
    s_waitcnt lgkmcnt(6)
    v_mfma_f32_16x16x32_bf16 v[40:43], v[232:235], v[112:115], v[40:43]
    ds_read_b64_tr_b16 v[224:225], v4 offset:25344
    v_mfma_f32_16x16x32_bf16 v[44:47], v[232:235], v[116:119], v[44:47]
    ds_read_b64_tr_b16 v[226:227], v4 offset:26368
    s_waitcnt lgkmcnt(6)
    v_mfma_f32_16x16x32_bf16 v[48:51], v[236:239], v[112:115], v[48:51]
    ds_read_b64_tr_b16 v[228:229], v5 offset:25376
    v_mfma_f32_16x16x32_bf16 v[52:55], v[236:239], v[116:119], v[52:55]
    ds_read_b64_tr_b16 v[230:231], v5 offset:26400
    s_waitcnt lgkmcnt(6)
    v_mfma_f32_16x16x32_bf16 v[56:59], v[240:243], v[112:115], v[56:59]
    v_mfma_f32_16x16x32_bf16 v[60:63], v[240:243], v[116:119], v[60:63]
    s_barrier
    ds_read_b64_tr_b16 v[232:233], v4 offset:32768
    ds_read_b64_tr_b16 v[234:235], v4 offset:33792
    s_waitcnt lgkmcnt(6)
    v_mfma_f32_16x16x32_bf16 v[64:67], v[244:247], v[112:115], v[64:67]
    ds_read_b64_tr_b16 v[236:237], v5 offset:32800
    v_mfma_f32_16x16x32_bf16 v[68:71], v[244:247], v[116:119], v[68:71]
    s_add_u32 s22, s19, 0x200000
    s_add_u32 m0, s20, 0x0
    s_nop 0
    buffer_load_dwordx4 v3, s[4:7], s22 offen lds
    ds_read_b64_tr_b16 v[238:239], v5 offset:33824
    s_mov_b32 s23, 0x9800
    buffer_load_dwordx4 v[100:103], v7, s[8:11], s23 offen offset:1024 sc1
    s_waitcnt lgkmcnt(6)
    v_mfma_f32_16x16x32_bf16 v[72:75], v[224:227], v[112:115], v[72:75]
    ds_read_b64_tr_b16 v[240:241], v4 offset:33024
    v_mfma_f32_16x16x32_bf16 v[76:79], v[224:227], v[116:119], v[76:79]
    ds_read_b64_tr_b16 v[242:243], v4 offset:34048
    s_waitcnt lgkmcnt(6)
    v_mfma_f32_16x16x32_bf16 v[80:83], v[228:231], v[112:115], v[80:83]
    ds_read_b64_tr_b16 v[244:245], v5 offset:33056
    v_mfma_f32_16x16x32_bf16 v[84:87], v[228:231], v[116:119], v[84:87]
    ds_read_b64_tr_b16 v[246:247], v5 offset:34080
    s_waitcnt vmcnt(10) lgkmcnt(6)
    v_mfma_f32_16x16x32_bf16 v[24:27], v[232:235], v[120:123], v[24:27]
    ds_read_b64_tr_b16 v[224:225], v4 offset:33280
    s_waitcnt vmcnt(9)
    v_mfma_f32_16x16x32_bf16 v[28:31], v[232:235], v[124:127], v[28:31]
    ds_read_b64_tr_b16 v[226:227], v4 offset:34304
    s_waitcnt lgkmcnt(6)
    v_mfma_f32_16x16x32_bf16 v[32:35], v[236:239], v[120:123], v[32:35]
    ds_read_b64_tr_b16 v[228:229], v5 offset:33312
    v_mfma_f32_16x16x32_bf16 v[36:39], v[236:239], v[124:127], v[36:39]
    s_add_u32 s22, s19, 0x208000
    s_add_u32 m0, s20, 0x400
    s_nop 0
    buffer_load_dwordx4 v3, s[4:7], s22 offen lds
    ds_read_b64_tr_b16 v[230:231], v5 offset:34336
    s_mov_b32 s23, 0x2000
    buffer_load_dwordx4 v[104:107], v7, s[8:11], s23 offen offset:0 sc1
    s_waitcnt lgkmcnt(6)
    v_mfma_f32_16x16x32_bf16 v[40:43], v[240:243], v[120:123], v[40:43]
    ds_read_b64_tr_b16 v[232:233], v4 offset:33536
    v_mfma_f32_16x16x32_bf16 v[44:47], v[240:243], v[124:127], v[44:47]
    ds_read_b64_tr_b16 v[234:235], v4 offset:34560
    s_waitcnt lgkmcnt(6)
    v_mfma_f32_16x16x32_bf16 v[48:51], v[244:247], v[120:123], v[48:51]
    ds_read_b64_tr_b16 v[236:237], v5 offset:33568
    v_mfma_f32_16x16x32_bf16 v[52:55], v[244:247], v[124:127], v[52:55]
    ds_read_b64_tr_b16 v[238:239], v5 offset:34592
    s_waitcnt lgkmcnt(6)
    v_mfma_f32_16x16x32_bf16 v[56:59], v[224:227], v[120:123], v[56:59]
    ds_read_b64_tr_b16 v[240:241], v4 offset:40960
    v_mfma_f32_16x16x32_bf16 v[60:63], v[224:227], v[124:127], v[60:63]
    ds_read_b64_tr_b16 v[242:243], v4 offset:41984
    s_waitcnt lgkmcnt(6)
    v_mfma_f32_16x16x32_bf16 v[64:67], v[228:231], v[120:123], v[64:67]
    ds_read_b64_tr_b16 v[244:245], v5 offset:40992
    v_mfma_f32_16x16x32_bf16 v[68:71], v[228:231], v[124:127], v[68:71]
    ds_read_b64_tr_b16 v[246:247], v5 offset:42016
    s_mov_b32 s23, 0xa000
    buffer_load_dwordx4 v[108:111], v7, s[8:11], s23 offen offset:0 sc1
    s_waitcnt lgkmcnt(6)
    v_mfma_f32_16x16x32_bf16 v[72:75], v[232:235], v[120:123], v[72:75]
    ds_read_b64_tr_b16 v[224:225], v4 offset:41216
    v_mfma_f32_16x16x32_bf16 v[76:79], v[232:235], v[124:127], v[76:79]
    ds_read_b64_tr_b16 v[226:227], v4 offset:42240
    s_waitcnt lgkmcnt(6)
    v_mfma_f32_16x16x32_bf16 v[80:83], v[236:239], v[120:123], v[80:83]
    ds_read_b64_tr_b16 v[228:229], v5 offset:41248
    v_mfma_f32_16x16x32_bf16 v[84:87], v[236:239], v[124:127], v[84:87]
    ds_read_b64_tr_b16 v[230:231], v5 offset:42272
    s_waitcnt vmcnt(11) lgkmcnt(6)
    v_mfma_f32_16x16x32_bf16 v[24:27], v[240:243], v[128:131], v[24:27]
    ds_read_b64_tr_b16 v[232:233], v4 offset:41472
    s_waitcnt vmcnt(9)
    v_mfma_f32_16x16x32_bf16 v[28:31], v[240:243], v[132:135], v[28:31]
    ds_read_b64_tr_b16 v[234:235], v4 offset:42496
    s_waitcnt lgkmcnt(6)
    v_mfma_f32_16x16x32_bf16 v[32:35], v[244:247], v[128:131], v[32:35]
    ds_read_b64_tr_b16 v[236:237], v5 offset:41504
    v_mfma_f32_16x16x32_bf16 v[36:39], v[244:247], v[132:135], v[36:39]
    ds_read_b64_tr_b16 v[238:239], v5 offset:42528
    s_mov_b32 s23, 0x2000
    buffer_load_dwordx4 v[112:115], v7, s[8:11], s23 offen offset:1024 sc1
    s_waitcnt lgkmcnt(6)
    v_mfma_f32_16x16x32_bf16 v[40:43], v[224:227], v[128:131], v[40:43]
    ds_read_b64_tr_b16 v[240:241], v4 offset:41728
    v_mfma_f32_16x16x32_bf16 v[44:47], v[224:227], v[132:135], v[44:47]
    ds_read_b64_tr_b16 v[242:243], v4 offset:42752
    s_waitcnt lgkmcnt(6)
    v_mfma_f32_16x16x32_bf16 v[48:51], v[228:231], v[128:131], v[48:51]
    ds_read_b64_tr_b16 v[244:245], v5 offset:41760
    v_mfma_f32_16x16x32_bf16 v[52:55], v[228:231], v[132:135], v[52:55]
    ds_read_b64_tr_b16 v[246:247], v5 offset:42784
    s_waitcnt lgkmcnt(6)
    v_mfma_f32_16x16x32_bf16 v[56:59], v[232:235], v[128:131], v[56:59]
    v_mfma_f32_16x16x32_bf16 v[60:63], v[232:235], v[132:135], v[60:63]
    s_waitcnt vmcnt(9)
    s_barrier
    ds_read_b64_tr_b16 v[224:225], v4 offset:49152
    ds_read_b64_tr_b16 v[226:227], v4 offset:50176
    s_waitcnt lgkmcnt(6)
    v_mfma_f32_16x16x32_bf16 v[64:67], v[236:239], v[128:131], v[64:67]
    ds_read_b64_tr_b16 v[228:229], v5 offset:49184
    v_mfma_f32_16x16x32_bf16 v[68:71], v[236:239], v[132:135], v[68:71]
    s_add_u32 s22, s19, 0x280000
    s_add_u32 m0, s20, 0x4000
    s_nop 0
    buffer_load_dwordx4 v3, s[4:7], s22 offen lds
    ds_read_b64_tr_b16 v[230:231], v5 offset:50208
    s_mov_b32 s23, 0xa000
    buffer_load_dwordx4 v[116:119], v7, s[8:11], s23 offen offset:1024 sc1
    s_waitcnt lgkmcnt(6)
    v_mfma_f32_16x16x32_bf16 v[72:75], v[240:243], v[128:131], v[72:75]
    ds_read_b64_tr_b16 v[232:233], v4 offset:49408
    v_mfma_f32_16x16x32_bf16 v[76:79], v[240:243], v[132:135], v[76:79]
    ds_read_b64_tr_b16 v[234:235], v4 offset:50432
    s_waitcnt lgkmcnt(6)
    v_mfma_f32_16x16x32_bf16 v[80:83], v[244:247], v[128:131], v[80:83]
    ds_read_b64_tr_b16 v[236:237], v5 offset:49440
    v_mfma_f32_16x16x32_bf16 v[84:87], v[244:247], v[132:135], v[84:87]
    ds_read_b64_tr_b16 v[238:239], v5 offset:50464
    s_waitcnt vmcnt(10) lgkmcnt(6)
    v_mfma_f32_16x16x32_bf16 v[24:27], v[224:227], v[88:91], v[24:27]
    ds_read_b64_tr_b16 v[240:241], v4 offset:49664
    s_waitcnt vmcnt(9)
    v_mfma_f32_16x16x32_bf16 v[28:31], v[224:227], v[92:95], v[28:31]
    ds_read_b64_tr_b16 v[242:243], v4 offset:50688
    s_waitcnt lgkmcnt(6)
    v_mfma_f32_16x16x32_bf16 v[32:35], v[228:231], v[88:91], v[32:35]
    ds_read_b64_tr_b16 v[244:245], v5 offset:49696
    v_mfma_f32_16x16x32_bf16 v[36:39], v[228:231], v[92:95], v[36:39]
    s_add_u32 s22, s19, 0x288000
    s_add_u32 m0, s20, 0x4400
    s_nop 0
    buffer_load_dwordx4 v3, s[4:7], s22 offen lds
    ds_read_b64_tr_b16 v[246:247], v5 offset:50720
    s_mov_b32 s23, 0x2800
    buffer_load_dwordx4 v[120:123], v7, s[8:11], s23 offen offset:0 sc1
    s_waitcnt lgkmcnt(6)
    v_mfma_f32_16x16x32_bf16 v[40:43], v[232:235], v[88:91], v[40:43]
    ds_read_b64_tr_b16 v[224:225], v4 offset:49920
    v_mfma_f32_16x16x32_bf16 v[44:47], v[232:235], v[92:95], v[44:47]
    ds_read_b64_tr_b16 v[226:227], v4 offset:50944
    s_waitcnt lgkmcnt(6)
    v_mfma_f32_16x16x32_bf16 v[48:51], v[236:239], v[88:91], v[48:51]
    ds_read_b64_tr_b16 v[228:229], v5 offset:49952
    v_mfma_f32_16x16x32_bf16 v[52:55], v[236:239], v[92:95], v[52:55]
    ds_read_b64_tr_b16 v[230:231], v5 offset:50976
    s_waitcnt lgkmcnt(6)
    v_mfma_f32_16x16x32_bf16 v[56:59], v[240:243], v[88:91], v[56:59]
    ds_read_b64_tr_b16 v[232:233], v4 offset:57344
    v_mfma_f32_16x16x32_bf16 v[60:63], v[240:243], v[92:95], v[60:63]
    ds_read_b64_tr_b16 v[234:235], v4 offset:58368
    s_waitcnt lgkmcnt(6)
    v_mfma_f32_16x16x32_bf16 v[64:67], v[244:247], v[88:91], v[64:67]
    ds_read_b64_tr_b16 v[236:237], v5 offset:57376
    v_mfma_f32_16x16x32_bf16 v[68:71], v[244:247], v[92:95], v[68:71]
    ds_read_b64_tr_b16 v[238:239], v5 offset:58400
    s_mov_b32 s23, 0xa800
    buffer_load_dwordx4 v[124:127], v7, s[8:11], s23 offen offset:0 sc1
    s_waitcnt lgkmcnt(6)
    v_mfma_f32_16x16x32_bf16 v[72:75], v[224:227], v[88:91], v[72:75]
    ds_read_b64_tr_b16 v[240:241], v4 offset:57600
    v_mfma_f32_16x16x32_bf16 v[76:79], v[224:227], v[92:95], v[76:79]
    ds_read_b64_tr_b16 v[242:243], v4 offset:58624
    s_waitcnt lgkmcnt(6)
    v_mfma_f32_16x16x32_bf16 v[80:83], v[228:231], v[88:91], v[80:83]
    ds_read_b64_tr_b16 v[244:245], v5 offset:57632
    v_mfma_f32_16x16x32_bf16 v[84:87], v[228:231], v[92:95], v[84:87]
    ds_read_b64_tr_b16 v[246:247], v5 offset:58656
    s_waitcnt vmcnt(11) lgkmcnt(6)
    v_mfma_f32_16x16x32_bf16 v[24:27], v[232:235], v[96:99], v[24:27]
    ds_read_b64_tr_b16 v[224:225], v4 offset:57856
    s_waitcnt vmcnt(9)
    v_mfma_f32_16x16x32_bf16 v[28:31], v[232:235], v[100:103], v[28:31]
    ds_read_b64_tr_b16 v[226:227], v4 offset:58880
    s_waitcnt lgkmcnt(6)
    v_mfma_f32_16x16x32_bf16 v[32:35], v[236:239], v[96:99], v[32:35]
    ds_read_b64_tr_b16 v[228:229], v5 offset:57888
    v_mfma_f32_16x16x32_bf16 v[36:39], v[236:239], v[100:103], v[36:39]
    ds_read_b64_tr_b16 v[230:231], v5 offset:58912
    s_mov_b32 s23, 0x2800
    buffer_load_dwordx4 v[128:131], v7, s[8:11], s23 offen offset:1024 sc1
    s_waitcnt lgkmcnt(6)
    v_mfma_f32_16x16x32_bf16 v[40:43], v[240:243], v[96:99], v[40:43]
    ds_read_b64_tr_b16 v[232:233], v4 offset:58112
    v_mfma_f32_16x16x32_bf16 v[44:47], v[240:243], v[100:103], v[44:47]
    ds_read_b64_tr_b16 v[234:235], v4 offset:59136
    s_waitcnt lgkmcnt(6)
    v_mfma_f32_16x16x32_bf16 v[48:51], v[244:247], v[96:99], v[48:51]
    ds_read_b64_tr_b16 v[236:237], v5 offset:58144
    v_mfma_f32_16x16x32_bf16 v[52:55], v[244:247], v[100:103], v[52:55]
    ds_read_b64_tr_b16 v[238:239], v5 offset:59168
    s_waitcnt lgkmcnt(6)
    v_mfma_f32_16x16x32_bf16 v[56:59], v[224:227], v[96:99], v[56:59]
    v_mfma_f32_16x16x32_bf16 v[60:63], v[224:227], v[100:103], v[60:63]
    s_waitcnt vmcnt(9)
    s_barrier
    ds_read_b64_tr_b16 v[240:241], v4 offset:0
    ds_read_b64_tr_b16 v[242:243], v4 offset:1024
    s_waitcnt lgkmcnt(6)
    v_mfma_f32_16x16x32_bf16 v[64:67], v[228:231], v[96:99], v[64:67]
    ds_read_b64_tr_b16 v[244:245], v5 offset:32
    v_mfma_f32_16x16x32_bf16 v[68:71], v[228:231], v[100:103], v[68:71]
    s_add_u32 s22, s19, 0x300000
    s_add_u32 m0, s20, 0x8000
    s_nop 0
    buffer_load_dwordx4 v3, s[4:7], s22 offen lds
    ds_read_b64_tr_b16 v[246:247], v5 offset:1056
    s_mov_b32 s23, 0xa800
    buffer_load_dwordx4 v[132:135], v7, s[8:11], s23 offen offset:1024 sc1
    s_waitcnt lgkmcnt(6)
    v_mfma_f32_16x16x32_bf16 v[72:75], v[232:235], v[96:99], v[72:75]
    ds_read_b64_tr_b16 v[224:225], v4 offset:256
    v_mfma_f32_16x16x32_bf16 v[76:79], v[232:235], v[100:103], v[76:79]
    ds_read_b64_tr_b16 v[226:227], v4 offset:1280
    s_waitcnt lgkmcnt(6)
    v_mfma_f32_16x16x32_bf16 v[80:83], v[236:239], v[96:99], v[80:83]
    ds_read_b64_tr_b16 v[228:229], v5 offset:288
    v_mfma_f32_16x16x32_bf16 v[84:87], v[236:239], v[100:103], v[84:87]
    ds_read_b64_tr_b16 v[230:231], v5 offset:1312
    s_waitcnt vmcnt(10) lgkmcnt(6)
    v_mfma_f32_16x16x32_bf16 v[24:27], v[240:243], v[104:107], v[24:27]
    ds_read_b64_tr_b16 v[232:233], v4 offset:512
    s_waitcnt vmcnt(9)
    v_mfma_f32_16x16x32_bf16 v[28:31], v[240:243], v[108:111], v[28:31]
    ds_read_b64_tr_b16 v[234:235], v4 offset:1536
    s_waitcnt lgkmcnt(6)
    v_mfma_f32_16x16x32_bf16 v[32:35], v[244:247], v[104:107], v[32:35]
    ds_read_b64_tr_b16 v[236:237], v5 offset:544
    v_mfma_f32_16x16x32_bf16 v[36:39], v[244:247], v[108:111], v[36:39]
    s_add_u32 s22, s19, 0x308000
    s_add_u32 m0, s20, 0x8400
    s_nop 0
    buffer_load_dwordx4 v3, s[4:7], s22 offen lds
    ds_read_b64_tr_b16 v[238:239], v5 offset:1568
    s_mov_b32 s23, 0x3000
    buffer_load_dwordx4 v[88:91], v7, s[8:11], s23 offen offset:0 sc1
    s_waitcnt lgkmcnt(6)
    v_mfma_f32_16x16x32_bf16 v[40:43], v[224:227], v[104:107], v[40:43]
    ds_read_b64_tr_b16 v[240:241], v4 offset:768
    v_mfma_f32_16x16x32_bf16 v[44:47], v[224:227], v[108:111], v[44:47]
    ds_read_b64_tr_b16 v[242:243], v4 offset:1792
    s_waitcnt lgkmcnt(6)
    v_mfma_f32_16x16x32_bf16 v[48:51], v[228:231], v[104:107], v[48:51]
    ds_read_b64_tr_b16 v[244:245], v5 offset:800
    v_mfma_f32_16x16x32_bf16 v[52:55], v[228:231], v[108:111], v[52:55]
    ds_read_b64_tr_b16 v[246:247], v5 offset:1824
    s_waitcnt lgkmcnt(6)
    v_mfma_f32_16x16x32_bf16 v[56:59], v[232:235], v[104:107], v[56:59]
    ds_read_b64_tr_b16 v[224:225], v4 offset:8192
    v_mfma_f32_16x16x32_bf16 v[60:63], v[232:235], v[108:111], v[60:63]
    ds_read_b64_tr_b16 v[226:227], v4 offset:9216
    s_waitcnt lgkmcnt(6)
    v_mfma_f32_16x16x32_bf16 v[64:67], v[236:239], v[104:107], v[64:67]
    ds_read_b64_tr_b16 v[228:229], v5 offset:8224
    v_mfma_f32_16x16x32_bf16 v[68:71], v[236:239], v[108:111], v[68:71]
    ds_read_b64_tr_b16 v[230:231], v5 offset:9248
    s_mov_b32 s23, 0xb000
    buffer_load_dwordx4 v[92:95], v7, s[8:11], s23 offen offset:0 sc1
    s_waitcnt lgkmcnt(6)
    v_mfma_f32_16x16x32_bf16 v[72:75], v[240:243], v[104:107], v[72:75]
    ds_read_b64_tr_b16 v[232:233], v4 offset:8448
    v_mfma_f32_16x16x32_bf16 v[76:79], v[240:243], v[108:111], v[76:79]
    ds_read_b64_tr_b16 v[234:235], v4 offset:9472
    s_waitcnt lgkmcnt(6)
    v_mfma_f32_16x16x32_bf16 v[80:83], v[244:247], v[104:107], v[80:83]
    ds_read_b64_tr_b16 v[236:237], v5 offset:8480
    v_mfma_f32_16x16x32_bf16 v[84:87], v[244:247], v[108:111], v[84:87]
    ds_read_b64_tr_b16 v[238:239], v5 offset:9504
    s_waitcnt vmcnt(11) lgkmcnt(6)
    v_mfma_f32_16x16x32_bf16 v[24:27], v[224:227], v[112:115], v[24:27]
    ds_read_b64_tr_b16 v[240:241], v4 offset:8704
    s_waitcnt vmcnt(9)
    v_mfma_f32_16x16x32_bf16 v[28:31], v[224:227], v[116:119], v[28:31]
    ds_read_b64_tr_b16 v[242:243], v4 offset:9728
    s_waitcnt lgkmcnt(6)
    v_mfma_f32_16x16x32_bf16 v[32:35], v[228:231], v[112:115], v[32:35]
    ds_read_b64_tr_b16 v[244:245], v5 offset:8736
    v_mfma_f32_16x16x32_bf16 v[36:39], v[228:231], v[116:119], v[36:39]
    ds_read_b64_tr_b16 v[246:247], v5 offset:9760
    s_mov_b32 s23, 0x3000
    buffer_load_dwordx4 v[96:99], v7, s[8:11], s23 offen offset:1024 sc1
    s_waitcnt lgkmcnt(6)
    v_mfma_f32_16x16x32_bf16 v[40:43], v[232:235], v[112:115], v[40:43]
    ds_read_b64_tr_b16 v[224:225], v4 offset:8960
    v_mfma_f32_16x16x32_bf16 v[44:47], v[232:235], v[116:119], v[44:47]
    ds_read_b64_tr_b16 v[226:227], v4 offset:9984
    s_waitcnt lgkmcnt(6)
    v_mfma_f32_16x16x32_bf16 v[48:51], v[236:239], v[112:115], v[48:51]
    ds_read_b64_tr_b16 v[228:229], v5 offset:8992
    v_mfma_f32_16x16x32_bf16 v[52:55], v[236:239], v[116:119], v[52:55]
    ds_read_b64_tr_b16 v[230:231], v5 offset:10016
    s_waitcnt lgkmcnt(6)
    v_mfma_f32_16x16x32_bf16 v[56:59], v[240:243], v[112:115], v[56:59]
    v_mfma_f32_16x16x32_bf16 v[60:63], v[240:243], v[116:119], v[60:63]
    s_waitcnt vmcnt(9)
    s_barrier
    ds_read_b64_tr_b16 v[232:233], v4 offset:16384
    ds_read_b64_tr_b16 v[234:235], v4 offset:17408
    s_waitcnt lgkmcnt(6)
    v_mfma_f32_16x16x32_bf16 v[64:67], v[244:247], v[112:115], v[64:67]
    ds_read_b64_tr_b16 v[236:237], v5 offset:16416
    v_mfma_f32_16x16x32_bf16 v[68:71], v[244:247], v[116:119], v[68:71]
    s_add_u32 s22, s19, 0x380000
    s_add_u32 m0, s20, 0xc000
    s_nop 0
    buffer_load_dwordx4 v3, s[4:7], s22 offen lds
    ds_read_b64_tr_b16 v[238:239], v5 offset:17440
    s_mov_b32 s23, 0xb000
    buffer_load_dwordx4 v[100:103], v7, s[8:11], s23 offen offset:1024 sc1
    s_waitcnt lgkmcnt(6)
    v_mfma_f32_16x16x32_bf16 v[72:75], v[224:227], v[112:115], v[72:75]
    ds_read_b64_tr_b16 v[240:241], v4 offset:16640
    v_mfma_f32_16x16x32_bf16 v[76:79], v[224:227], v[116:119], v[76:79]
    ds_read_b64_tr_b16 v[242:243], v4 offset:17664
    s_waitcnt lgkmcnt(6)
    v_mfma_f32_16x16x32_bf16 v[80:83], v[228:231], v[112:115], v[80:83]
    ds_read_b64_tr_b16 v[244:245], v5 offset:16672
    v_mfma_f32_16x16x32_bf16 v[84:87], v[228:231], v[116:119], v[84:87]
    ds_read_b64_tr_b16 v[246:247], v5 offset:17696
    s_waitcnt vmcnt(10) lgkmcnt(6)
    v_mfma_f32_16x16x32_bf16 v[24:27], v[232:235], v[120:123], v[24:27]
    ds_read_b64_tr_b16 v[224:225], v4 offset:16896
    s_waitcnt vmcnt(9)
    v_mfma_f32_16x16x32_bf16 v[28:31], v[232:235], v[124:127], v[28:31]
    ds_read_b64_tr_b16 v[226:227], v4 offset:17920
    s_waitcnt lgkmcnt(6)
    v_mfma_f32_16x16x32_bf16 v[32:35], v[236:239], v[120:123], v[32:35]
    ds_read_b64_tr_b16 v[228:229], v5 offset:16928
    v_mfma_f32_16x16x32_bf16 v[36:39], v[236:239], v[124:127], v[36:39]
    s_add_u32 s22, s19, 0x388000
    s_add_u32 m0, s20, 0xc400
    s_nop 0
    buffer_load_dwordx4 v3, s[4:7], s22 offen lds
    ds_read_b64_tr_b16 v[230:231], v5 offset:17952
    s_mov_b32 s23, 0x3800
    buffer_load_dwordx4 v[104:107], v7, s[8:11], s23 offen offset:0 sc1
    s_waitcnt lgkmcnt(6)
    v_mfma_f32_16x16x32_bf16 v[40:43], v[240:243], v[120:123], v[40:43]
    ds_read_b64_tr_b16 v[232:233], v4 offset:17152
    v_mfma_f32_16x16x32_bf16 v[44:47], v[240:243], v[124:127], v[44:47]
    ds_read_b64_tr_b16 v[234:235], v4 offset:18176
    s_waitcnt lgkmcnt(6)
    v_mfma_f32_16x16x32_bf16 v[48:51], v[244:247], v[120:123], v[48:51]
    ds_read_b64_tr_b16 v[236:237], v5 offset:17184
    v_mfma_f32_16x16x32_bf16 v[52:55], v[244:247], v[124:127], v[52:55]
    ds_read_b64_tr_b16 v[238:239], v5 offset:18208
    s_waitcnt lgkmcnt(6)
    v_mfma_f32_16x16x32_bf16 v[56:59], v[224:227], v[120:123], v[56:59]
    ds_read_b64_tr_b16 v[240:241], v4 offset:24576
    v_mfma_f32_16x16x32_bf16 v[60:63], v[224:227], v[124:127], v[60:63]
    ds_read_b64_tr_b16 v[242:243], v4 offset:25600
    s_waitcnt lgkmcnt(6)
    v_mfma_f32_16x16x32_bf16 v[64:67], v[228:231], v[120:123], v[64:67]
    ds_read_b64_tr_b16 v[244:245], v5 offset:24608
    v_mfma_f32_16x16x32_bf16 v[68:71], v[228:231], v[124:127], v[68:71]
    ds_read_b64_tr_b16 v[246:247], v5 offset:25632
    s_mov_b32 s23, 0xb800
    buffer_load_dwordx4 v[108:111], v7, s[8:11], s23 offen offset:0 sc1
    s_waitcnt lgkmcnt(6)
    v_mfma_f32_16x16x32_bf16 v[72:75], v[232:235], v[120:123], v[72:75]
    ds_read_b64_tr_b16 v[224:225], v4 offset:24832
    v_mfma_f32_16x16x32_bf16 v[76:79], v[232:235], v[124:127], v[76:79]
    ds_read_b64_tr_b16 v[226:227], v4 offset:25856
    s_waitcnt lgkmcnt(6)
    v_mfma_f32_16x16x32_bf16 v[80:83], v[236:239], v[120:123], v[80:83]
    ds_read_b64_tr_b16 v[228:229], v5 offset:24864
    v_mfma_f32_16x16x32_bf16 v[84:87], v[236:239], v[124:127], v[84:87]
    ds_read_b64_tr_b16 v[230:231], v5 offset:25888
    s_waitcnt vmcnt(11) lgkmcnt(6)
    v_mfma_f32_16x16x32_bf16 v[24:27], v[240:243], v[128:131], v[24:27]
    ds_read_b64_tr_b16 v[232:233], v4 offset:25088
    s_waitcnt vmcnt(9)
    v_mfma_f32_16x16x32_bf16 v[28:31], v[240:243], v[132:135], v[28:31]
    ds_read_b64_tr_b16 v[234:235], v4 offset:26112
    s_waitcnt lgkmcnt(6)
    v_mfma_f32_16x16x32_bf16 v[32:35], v[244:247], v[128:131], v[32:35]
    ds_read_b64_tr_b16 v[236:237], v5 offset:25120
    v_mfma_f32_16x16x32_bf16 v[36:39], v[244:247], v[132:135], v[36:39]
    ds_read_b64_tr_b16 v[238:239], v5 offset:26144
    s_mov_b32 s23, 0x3800
    buffer_load_dwordx4 v[112:115], v7, s[8:11], s23 offen offset:1024 sc1
    s_waitcnt lgkmcnt(6)
    v_mfma_f32_16x16x32_bf16 v[40:43], v[224:227], v[128:131], v[40:43]
    ds_read_b64_tr_b16 v[240:241], v4 offset:25344
    v_mfma_f32_16x16x32_bf16 v[44:47], v[224:227], v[132:135], v[44:47]
    ds_read_b64_tr_b16 v[242:243], v4 offset:26368
    s_waitcnt lgkmcnt(6)
    v_mfma_f32_16x16x32_bf16 v[48:51], v[228:231], v[128:131], v[48:51]
    ds_read_b64_tr_b16 v[244:245], v5 offset:25376
    v_mfma_f32_16x16x32_bf16 v[52:55], v[228:231], v[132:135], v[52:55]
    ds_read_b64_tr_b16 v[246:247], v5 offset:26400
    s_waitcnt lgkmcnt(6)
    v_mfma_f32_16x16x32_bf16 v[56:59], v[232:235], v[128:131], v[56:59]
    v_mfma_f32_16x16x32_bf16 v[60:63], v[232:235], v[132:135], v[60:63]
    s_waitcnt vmcnt(9)
    s_barrier
    ds_read_b64_tr_b16 v[224:225], v4 offset:32768
    ds_read_b64_tr_b16 v[226:227], v4 offset:33792
    s_waitcnt lgkmcnt(6)
    v_mfma_f32_16x16x32_bf16 v[64:67], v[236:239], v[128:131], v[64:67]
    ds_read_b64_tr_b16 v[228:229], v5 offset:32800
    v_mfma_f32_16x16x32_bf16 v[68:71], v[236:239], v[132:135], v[68:71]
    s_add_u32 s22, s19, 0x400000
    s_add_u32 m0, s20, 0x0
    s_nop 0
    buffer_load_dwordx4 v3, s[4:7], s22 offen lds
    ds_read_b64_tr_b16 v[230:231], v5 offset:33824
    s_mov_b32 s23, 0xb800
    buffer_load_dwordx4 v[116:119], v7, s[8:11], s23 offen offset:1024 sc1
    s_waitcnt lgkmcnt(6)
    v_mfma_f32_16x16x32_bf16 v[72:75], v[240:243], v[128:131], v[72:75]
    ds_read_b64_tr_b16 v[232:233], v4 offset:33024
    v_mfma_f32_16x16x32_bf16 v[76:79], v[240:243], v[132:135], v[76:79]
    ds_read_b64_tr_b16 v[234:235], v4 offset:34048
    s_waitcnt lgkmcnt(6)
    v_mfma_f32_16x16x32_bf16 v[80:83], v[244:247], v[128:131], v[80:83]
    ds_read_b64_tr_b16 v[236:237], v5 offset:33056
    v_mfma_f32_16x16x32_bf16 v[84:87], v[244:247], v[132:135], v[84:87]
    ds_read_b64_tr_b16 v[238:239], v5 offset:34080
    s_waitcnt vmcnt(10) lgkmcnt(6)
    v_mfma_f32_16x16x32_bf16 v[24:27], v[224:227], v[88:91], v[24:27]
    ds_read_b64_tr_b16 v[240:241], v4 offset:33280
    s_waitcnt vmcnt(9)
    v_mfma_f32_16x16x32_bf16 v[28:31], v[224:227], v[92:95], v[28:31]
    ds_read_b64_tr_b16 v[242:243], v4 offset:34304
    s_waitcnt lgkmcnt(6)
    v_mfma_f32_16x16x32_bf16 v[32:35], v[228:231], v[88:91], v[32:35]
    ds_read_b64_tr_b16 v[244:245], v5 offset:33312
    v_mfma_f32_16x16x32_bf16 v[36:39], v[228:231], v[92:95], v[36:39]
    s_add_u32 s22, s19, 0x408000
    s_add_u32 m0, s20, 0x400
    s_nop 0
    buffer_load_dwordx4 v3, s[4:7], s22 offen lds
    ds_read_b64_tr_b16 v[246:247], v5 offset:34336
    s_mov_b32 s23, 0x4000
    buffer_load_dwordx4 v[120:123], v7, s[8:11], s23 offen offset:0 sc1
    s_waitcnt lgkmcnt(6)
    v_mfma_f32_16x16x32_bf16 v[40:43], v[232:235], v[88:91], v[40:43]
    ds_read_b64_tr_b16 v[224:225], v4 offset:33536
    v_mfma_f32_16x16x32_bf16 v[44:47], v[232:235], v[92:95], v[44:47]
    ds_read_b64_tr_b16 v[226:227], v4 offset:34560
    s_waitcnt lgkmcnt(6)
    v_mfma_f32_16x16x32_bf16 v[48:51], v[236:239], v[88:91], v[48:51]
    ds_read_b64_tr_b16 v[228:229], v5 offset:33568
    v_mfma_f32_16x16x32_bf16 v[52:55], v[236:239], v[92:95], v[52:55]
    ds_read_b64_tr_b16 v[230:231], v5 offset:34592
    s_waitcnt lgkmcnt(6)
    v_mfma_f32_16x16x32_bf16 v[56:59], v[240:243], v[88:91], v[56:59]
    ds_read_b64_tr_b16 v[232:233], v4 offset:40960
    v_mfma_f32_16x16x32_bf16 v[60:63], v[240:243], v[92:95], v[60:63]
    ds_read_b64_tr_b16 v[234:235], v4 offset:41984
    s_waitcnt lgkmcnt(6)
    v_mfma_f32_16x16x32_bf16 v[64:67], v[244:247], v[88:91], v[64:67]
    ds_read_b64_tr_b16 v[236:237], v5 offset:40992
    v_mfma_f32_16x16x32_bf16 v[68:71], v[244:247], v[92:95], v[68:71]
    ds_read_b64_tr_b16 v[238:239], v5 offset:42016
    s_mov_b32 s23, 0xc000
    buffer_load_dwordx4 v[124:127], v7, s[8:11], s23 offen offset:0 sc1
    s_waitcnt lgkmcnt(6)
    v_mfma_f32_16x16x32_bf16 v[72:75], v[224:227], v[88:91], v[72:75]
    ds_read_b64_tr_b16 v[240:241], v4 offset:41216
    v_lshrrev_b32 v21, 4, v1
    v_lshlrev_b32 v21, 9, v21
    v_and_b32 v20, 15, v1
    v_lshl_add_u32 v21, v20, 4, v21
    s_lshr_b32 s18, s12, 3
    s_lshl_b32 s18, s18, 11
    s_add_u32 s18, s18, 0x528100
    buffer_load_dwordx4 v[12:15], v21, s[8:11], s18 offen sc1
    v_mfma_f32_16x16x32_bf16 v[76:79], v[224:227], v[92:95], v[76:79]
    ds_read_b64_tr_b16 v[242:243], v4 offset:42240
    s_waitcnt lgkmcnt(6)
    v_mfma_f32_16x16x32_bf16 v[80:83], v[228:231], v[88:91], v[80:83]
    ds_read_b64_tr_b16 v[244:245], v5 offset:41248
    v_mfma_f32_16x16x32_bf16 v[84:87], v[228:231], v[92:95], v[84:87]
    ds_read_b64_tr_b16 v[246:247], v5 offset:42272
    s_waitcnt vmcnt(12) lgkmcnt(6)
    v_mfma_f32_16x16x32_bf16 v[24:27], v[232:235], v[96:99], v[24:27]
    ds_read_b64_tr_b16 v[224:225], v4 offset:41472
    s_waitcnt vmcnt(10)
    v_mfma_f32_16x16x32_bf16 v[28:31], v[232:235], v[100:103], v[28:31]
    ds_read_b64_tr_b16 v[226:227], v4 offset:42496
    s_waitcnt lgkmcnt(6)
    v_mfma_f32_16x16x32_bf16 v[32:35], v[236:239], v[96:99], v[32:35]
    ds_read_b64_tr_b16 v[228:229], v5 offset:41504
    v_mfma_f32_16x16x32_bf16 v[36:39], v[236:239], v[100:103], v[36:39]
    ds_read_b64_tr_b16 v[230:231], v5 offset:42528
    s_mov_b32 s23, 0x4000
    buffer_load_dwordx4 v[128:131], v7, s[8:11], s23 offen offset:1024 sc1
    s_waitcnt lgkmcnt(6)
    v_mfma_f32_16x16x32_bf16 v[40:43], v[240:243], v[96:99], v[40:43]
    ds_read_b64_tr_b16 v[232:233], v4 offset:41728
    v_mfma_f32_16x16x32_bf16 v[44:47], v[240:243], v[100:103], v[44:47]
    ds_read_b64_tr_b16 v[234:235], v4 offset:42752
    s_waitcnt lgkmcnt(6)
    v_mfma_f32_16x16x32_bf16 v[48:51], v[244:247], v[96:99], v[48:51]
    ds_read_b64_tr_b16 v[236:237], v5 offset:41760
    v_mfma_f32_16x16x32_bf16 v[52:55], v[244:247], v[100:103], v[52:55]
    ds_read_b64_tr_b16 v[238:239], v5 offset:42784
    s_waitcnt lgkmcnt(6)
    v_mfma_f32_16x16x32_bf16 v[56:59], v[224:227], v[96:99], v[56:59]
    v_mfma_f32_16x16x32_bf16 v[60:63], v[224:227], v[100:103], v[60:63]
    s_waitcnt vmcnt(10)
    s_barrier
    ds_read_b64_tr_b16 v[240:241], v4 offset:49152
    ds_read_b64_tr_b16 v[242:243], v4 offset:50176
    s_waitcnt lgkmcnt(6)
    v_mfma_f32_16x16x32_bf16 v[64:67], v[228:231], v[96:99], v[64:67]
    ds_read_b64_tr_b16 v[244:245], v5 offset:49184
    v_mfma_f32_16x16x32_bf16 v[68:71], v[228:231], v[100:103], v[68:71]
    s_add_u32 s22, s19, 0x480000
    s_add_u32 m0, s20, 0x4000
    s_nop 0
    buffer_load_dwordx4 v3, s[4:7], s22 offen lds
    ds_read_b64_tr_b16 v[246:247], v5 offset:50208
    s_mov_b32 s23, 0xc000
    buffer_load_dwordx4 v[132:135], v7, s[8:11], s23 offen offset:1024 sc1
    s_waitcnt lgkmcnt(6)
    v_mfma_f32_16x16x32_bf16 v[72:75], v[232:235], v[96:99], v[72:75]
    ds_read_b64_tr_b16 v[224:225], v4 offset:49408
    v_mfma_f32_16x16x32_bf16 v[76:79], v[232:235], v[100:103], v[76:79]
    ds_read_b64_tr_b16 v[226:227], v4 offset:50432
    s_waitcnt lgkmcnt(6)
    v_mfma_f32_16x16x32_bf16 v[80:83], v[236:239], v[96:99], v[80:83]
    ds_read_b64_tr_b16 v[228:229], v5 offset:49440
    v_mfma_f32_16x16x32_bf16 v[84:87], v[236:239], v[100:103], v[84:87]
    ds_read_b64_tr_b16 v[230:231], v5 offset:50464
    s_waitcnt vmcnt(11) lgkmcnt(6)
    v_mfma_f32_16x16x32_bf16 v[24:27], v[240:243], v[104:107], v[24:27]
    ds_read_b64_tr_b16 v[232:233], v4 offset:49664
    s_waitcnt vmcnt(10)
    v_mfma_f32_16x16x32_bf16 v[28:31], v[240:243], v[108:111], v[28:31]
    ds_read_b64_tr_b16 v[234:235], v4 offset:50688
    s_waitcnt lgkmcnt(6)
    v_mfma_f32_16x16x32_bf16 v[32:35], v[244:247], v[104:107], v[32:35]
    ds_read_b64_tr_b16 v[236:237], v5 offset:49696
    v_mfma_f32_16x16x32_bf16 v[36:39], v[244:247], v[108:111], v[36:39]
    s_add_u32 s22, s19, 0x488000
    s_add_u32 m0, s20, 0x4400
    s_nop 0
    buffer_load_dwordx4 v3, s[4:7], s22 offen lds
    ds_read_b64_tr_b16 v[238:239], v5 offset:50720
    s_mov_b32 s23, 0x4800
    buffer_load_dwordx4 v[88:91], v7, s[8:11], s23 offen offset:0 sc1
    s_waitcnt lgkmcnt(6)
    v_mfma_f32_16x16x32_bf16 v[40:43], v[224:227], v[104:107], v[40:43]
    ds_read_b64_tr_b16 v[240:241], v4 offset:49920
    v_mfma_f32_16x16x32_bf16 v[44:47], v[224:227], v[108:111], v[44:47]
    ds_read_b64_tr_b16 v[242:243], v4 offset:50944
    s_waitcnt lgkmcnt(6)
    v_mfma_f32_16x16x32_bf16 v[48:51], v[228:231], v[104:107], v[48:51]
    ds_read_b64_tr_b16 v[244:245], v5 offset:49952
    v_mfma_f32_16x16x32_bf16 v[52:55], v[228:231], v[108:111], v[52:55]
    ds_read_b64_tr_b16 v[246:247], v5 offset:50976
    s_waitcnt lgkmcnt(6)
    v_mfma_f32_16x16x32_bf16 v[56:59], v[232:235], v[104:107], v[56:59]
    ds_read_b64_tr_b16 v[224:225], v4 offset:57344
    v_mfma_f32_16x16x32_bf16 v[60:63], v[232:235], v[108:111], v[60:63]
    ds_read_b64_tr_b16 v[226:227], v4 offset:58368
    s_waitcnt lgkmcnt(6)
    v_mfma_f32_16x16x32_bf16 v[64:67], v[236:239], v[104:107], v[64:67]
    ds_read_b64_tr_b16 v[228:229], v5 offset:57376
    v_mfma_f32_16x16x32_bf16 v[68:71], v[236:239], v[108:111], v[68:71]
    ds_read_b64_tr_b16 v[230:231], v5 offset:58400
    s_mov_b32 s23, 0xc800
    buffer_load_dwordx4 v[92:95], v7, s[8:11], s23 offen offset:0 sc1
    s_waitcnt lgkmcnt(6)
    v_mfma_f32_16x16x32_bf16 v[72:75], v[240:243], v[104:107], v[72:75]
    ds_read_b64_tr_b16 v[232:233], v4 offset:57600
    v_mfma_f32_16x16x32_bf16 v[76:79], v[240:243], v[108:111], v[76:79]
    ds_read_b64_tr_b16 v[234:235], v4 offset:58624
    s_waitcnt lgkmcnt(6)
    v_mfma_f32_16x16x32_bf16 v[80:83], v[244:247], v[104:107], v[80:83]
    ds_read_b64_tr_b16 v[236:237], v5 offset:57632
    v_mfma_f32_16x16x32_bf16 v[84:87], v[244:247], v[108:111], v[84:87]
    ds_read_b64_tr_b16 v[238:239], v5 offset:58656
    s_waitcnt vmcnt(12) lgkmcnt(6)
    v_mfma_f32_16x16x32_bf16 v[24:27], v[224:227], v[112:115], v[24:27]
    ds_read_b64_tr_b16 v[240:241], v4 offset:57856
    s_waitcnt vmcnt(10)
    v_mfma_f32_16x16x32_bf16 v[28:31], v[224:227], v[116:119], v[28:31]
    ds_read_b64_tr_b16 v[242:243], v4 offset:58880
    s_waitcnt lgkmcnt(6)
    v_mfma_f32_16x16x32_bf16 v[32:35], v[228:231], v[112:115], v[32:35]
    ds_read_b64_tr_b16 v[244:245], v5 offset:57888
    v_mfma_f32_16x16x32_bf16 v[36:39], v[228:231], v[116:119], v[36:39]
    ds_read_b64_tr_b16 v[246:247], v5 offset:58912
    s_mov_b32 s23, 0x4800
    buffer_load_dwordx4 v[96:99], v7, s[8:11], s23 offen offset:1024 sc1
    s_waitcnt lgkmcnt(6)
    v_mfma_f32_16x16x32_bf16 v[40:43], v[232:235], v[112:115], v[40:43]
    ds_read_b64_tr_b16 v[224:225], v4 offset:58112
    v_mfma_f32_16x16x32_bf16 v[44:47], v[232:235], v[116:119], v[44:47]
    ds_read_b64_tr_b16 v[226:227], v4 offset:59136
    s_waitcnt lgkmcnt(6)
    v_mfma_f32_16x16x32_bf16 v[48:51], v[236:239], v[112:115], v[48:51]
    ds_read_b64_tr_b16 v[228:229], v5 offset:58144
    v_mfma_f32_16x16x32_bf16 v[52:55], v[236:239], v[116:119], v[52:55]
    ds_read_b64_tr_b16 v[230:231], v5 offset:59168
    s_waitcnt lgkmcnt(6)
    v_mfma_f32_16x16x32_bf16 v[56:59], v[240:243], v[112:115], v[56:59]
    v_mfma_f32_16x16x32_bf16 v[60:63], v[240:243], v[116:119], v[60:63]
    s_waitcnt vmcnt(10)
    s_barrier
    ds_read_b64_tr_b16 v[232:233], v4 offset:0
    ds_read_b64_tr_b16 v[234:235], v4 offset:1024
    s_waitcnt lgkmcnt(6)
    v_mfma_f32_16x16x32_bf16 v[64:67], v[244:247], v[112:115], v[64:67]
    ds_read_b64_tr_b16 v[236:237], v5 offset:32
    v_mfma_f32_16x16x32_bf16 v[68:71], v[244:247], v[116:119], v[68:71]
    s_add_u32 s22, s19, 0x500000
    s_add_u32 m0, s20, 0x8000
    s_nop 0
    buffer_load_dwordx4 v3, s[4:7], s22 offen lds
    ds_read_b64_tr_b16 v[238:239], v5 offset:1056
    s_mov_b32 s23, 0xc800
    buffer_load_dwordx4 v[100:103], v7, s[8:11], s23 offen offset:1024 sc1
    s_waitcnt lgkmcnt(6)
    v_mfma_f32_16x16x32_bf16 v[72:75], v[224:227], v[112:115], v[72:75]
    ds_read_b64_tr_b16 v[240:241], v4 offset:256
    v_mfma_f32_16x16x32_bf16 v[76:79], v[224:227], v[116:119], v[76:79]
    ds_read_b64_tr_b16 v[242:243], v4 offset:1280
    s_waitcnt lgkmcnt(6)
    v_mfma_f32_16x16x32_bf16 v[80:83], v[228:231], v[112:115], v[80:83]
    ds_read_b64_tr_b16 v[244:245], v5 offset:288
    v_mfma_f32_16x16x32_bf16 v[84:87], v[228:231], v[116:119], v[84:87]
    ds_read_b64_tr_b16 v[246:247], v5 offset:1312
    s_waitcnt vmcnt(11) lgkmcnt(6)
    v_mfma_f32_16x16x32_bf16 v[24:27], v[232:235], v[120:123], v[24:27]
    ds_read_b64_tr_b16 v[224:225], v4 offset:512
    s_waitcnt vmcnt(10)
    v_mfma_f32_16x16x32_bf16 v[28:31], v[232:235], v[124:127], v[28:31]
    ds_read_b64_tr_b16 v[226:227], v4 offset:1536
    s_waitcnt lgkmcnt(6)
    v_mfma_f32_16x16x32_bf16 v[32:35], v[236:239], v[120:123], v[32:35]
    ds_read_b64_tr_b16 v[228:229], v5 offset:544
    v_mfma_f32_16x16x32_bf16 v[36:39], v[236:239], v[124:127], v[36:39]
    s_add_u32 s22, s19, 0x508000
    s_add_u32 m0, s20, 0x8400
    s_nop 0
    buffer_load_dwordx4 v3, s[4:7], s22 offen lds
    ds_read_b64_tr_b16 v[230:231], v5 offset:1568
    s_mov_b32 s23, 0x5000
    buffer_load_dwordx4 v[104:107], v7, s[8:11], s23 offen offset:0 sc1
    s_waitcnt lgkmcnt(6)
    v_mfma_f32_16x16x32_bf16 v[40:43], v[240:243], v[120:123], v[40:43]
    ds_read_b64_tr_b16 v[232:233], v4 offset:768
    v_mfma_f32_16x16x32_bf16 v[44:47], v[240:243], v[124:127], v[44:47]
    ds_read_b64_tr_b16 v[234:235], v4 offset:1792
    s_waitcnt lgkmcnt(6)
    v_mfma_f32_16x16x32_bf16 v[48:51], v[244:247], v[120:123], v[48:51]
    ds_read_b64_tr_b16 v[236:237], v5 offset:800
    v_mfma_f32_16x16x32_bf16 v[52:55], v[244:247], v[124:127], v[52:55]
    ds_read_b64_tr_b16 v[238:239], v5 offset:1824
    s_waitcnt lgkmcnt(6)
    v_mfma_f32_16x16x32_bf16 v[56:59], v[224:227], v[120:123], v[56:59]
    ds_read_b64_tr_b16 v[240:241], v4 offset:8192
    v_mfma_f32_16x16x32_bf16 v[60:63], v[224:227], v[124:127], v[60:63]
    ds_read_b64_tr_b16 v[242:243], v4 offset:9216
    s_waitcnt lgkmcnt(6)
    v_mfma_f32_16x16x32_bf16 v[64:67], v[228:231], v[120:123], v[64:67]
    ds_read_b64_tr_b16 v[244:245], v5 offset:8224
    v_mfma_f32_16x16x32_bf16 v[68:71], v[228:231], v[124:127], v[68:71]
    ds_read_b64_tr_b16 v[246:247], v5 offset:9248
    s_mov_b32 s23, 0xd000
    buffer_load_dwordx4 v[108:111], v7, s[8:11], s23 offen offset:0 sc1
    s_waitcnt lgkmcnt(6)
    v_mfma_f32_16x16x32_bf16 v[72:75], v[232:235], v[120:123], v[72:75]
    ds_read_b64_tr_b16 v[224:225], v4 offset:8448
    v_mfma_f32_16x16x32_bf16 v[76:79], v[232:235], v[124:127], v[76:79]
    ds_read_b64_tr_b16 v[226:227], v4 offset:9472
    s_waitcnt lgkmcnt(6)
    v_mfma_f32_16x16x32_bf16 v[80:83], v[236:239], v[120:123], v[80:83]
    ds_read_b64_tr_b16 v[228:229], v5 offset:8480
    v_mfma_f32_16x16x32_bf16 v[84:87], v[236:239], v[124:127], v[84:87]
    ds_read_b64_tr_b16 v[230:231], v5 offset:9504
    s_waitcnt vmcnt(11) lgkmcnt(6)
    v_mfma_f32_16x16x32_bf16 v[24:27], v[240:243], v[128:131], v[24:27]
    ds_read_b64_tr_b16 v[232:233], v4 offset:8704
    s_waitcnt vmcnt(9)
    v_mfma_f32_16x16x32_bf16 v[28:31], v[240:243], v[132:135], v[28:31]
    ds_read_b64_tr_b16 v[234:235], v4 offset:9728
    s_waitcnt lgkmcnt(6)
    v_mfma_f32_16x16x32_bf16 v[32:35], v[244:247], v[128:131], v[32:35]
    ds_read_b64_tr_b16 v[236:237], v5 offset:8736
    v_mfma_f32_16x16x32_bf16 v[36:39], v[244:247], v[132:135], v[36:39]
    ds_read_b64_tr_b16 v[238:239], v5 offset:9760
    s_mov_b32 s23, 0x5000
    buffer_load_dwordx4 v[112:115], v7, s[8:11], s23 offen offset:1024 sc1
    s_waitcnt lgkmcnt(6)
    v_mfma_f32_16x16x32_bf16 v[40:43], v[224:227], v[128:131], v[40:43]
    ds_read_b64_tr_b16 v[240:241], v4 offset:8960
    v_mfma_f32_16x16x32_bf16 v[44:47], v[224:227], v[132:135], v[44:47]
    ds_read_b64_tr_b16 v[242:243], v4 offset:9984
    s_waitcnt lgkmcnt(6)
    v_mfma_f32_16x16x32_bf16 v[48:51], v[228:231], v[128:131], v[48:51]
    ds_read_b64_tr_b16 v[244:245], v5 offset:8992
    v_mfma_f32_16x16x32_bf16 v[52:55], v[228:231], v[132:135], v[52:55]
    ds_read_b64_tr_b16 v[246:247], v5 offset:10016
    s_waitcnt lgkmcnt(6)
    v_mfma_f32_16x16x32_bf16 v[56:59], v[232:235], v[128:131], v[56:59]
    v_mfma_f32_16x16x32_bf16 v[60:63], v[232:235], v[132:135], v[60:63]
    s_waitcnt vmcnt(9)
    s_barrier
    ds_read_b64_tr_b16 v[224:225], v4 offset:16384
    ds_read_b64_tr_b16 v[226:227], v4 offset:17408
    s_waitcnt lgkmcnt(6)
    v_mfma_f32_16x16x32_bf16 v[64:67], v[236:239], v[128:131], v[64:67]
    ds_read_b64_tr_b16 v[228:229], v5 offset:16416
    v_mfma_f32_16x16x32_bf16 v[68:71], v[236:239], v[132:135], v[68:71]
    s_add_u32 s22, s19, 0x580000
    s_add_u32 m0, s20, 0xc000
    s_nop 0
    buffer_load_dwordx4 v3, s[4:7], s22 offen lds
    ds_read_b64_tr_b16 v[230:231], v5 offset:17440
    s_mov_b32 s23, 0xd000
    buffer_load_dwordx4 v[116:119], v7, s[8:11], s23 offen offset:1024 sc1
    s_waitcnt lgkmcnt(6)
    v_mfma_f32_16x16x32_bf16 v[72:75], v[240:243], v[128:131], v[72:75]
    ds_read_b64_tr_b16 v[232:233], v4 offset:16640
    v_mfma_f32_16x16x32_bf16 v[76:79], v[240:243], v[132:135], v[76:79]
    ds_read_b64_tr_b16 v[234:235], v4 offset:17664
    s_waitcnt lgkmcnt(6)
    v_mfma_f32_16x16x32_bf16 v[80:83], v[244:247], v[128:131], v[80:83]
    ds_read_b64_tr_b16 v[236:237], v5 offset:16672
    v_mfma_f32_16x16x32_bf16 v[84:87], v[244:247], v[132:135], v[84:87]
    ds_read_b64_tr_b16 v[238:239], v5 offset:17696
    s_waitcnt vmcnt(10) lgkmcnt(6)
    v_mfma_f32_16x16x32_bf16 v[24:27], v[224:227], v[88:91], v[24:27]
    ds_read_b64_tr_b16 v[240:241], v4 offset:16896
    s_waitcnt vmcnt(9)
    v_mfma_f32_16x16x32_bf16 v[28:31], v[224:227], v[92:95], v[28:31]
    ds_read_b64_tr_b16 v[242:243], v4 offset:17920
    s_waitcnt lgkmcnt(6)
    v_mfma_f32_16x16x32_bf16 v[32:35], v[228:231], v[88:91], v[32:35]
    ds_read_b64_tr_b16 v[244:245], v5 offset:16928
    v_mfma_f32_16x16x32_bf16 v[36:39], v[228:231], v[92:95], v[36:39]
    s_add_u32 s22, s19, 0x588000
    s_add_u32 m0, s20, 0xc400
    s_nop 0
    buffer_load_dwordx4 v3, s[4:7], s22 offen lds
    ds_read_b64_tr_b16 v[246:247], v5 offset:17952
    s_mov_b32 s23, 0x5800
    buffer_load_dwordx4 v[120:123], v7, s[8:11], s23 offen offset:0 sc1
    s_waitcnt lgkmcnt(6)
    v_mfma_f32_16x16x32_bf16 v[40:43], v[232:235], v[88:91], v[40:43]
    ds_read_b64_tr_b16 v[224:225], v4 offset:17152
    v_mfma_f32_16x16x32_bf16 v[44:47], v[232:235], v[92:95], v[44:47]
    ds_read_b64_tr_b16 v[226:227], v4 offset:18176
    s_waitcnt lgkmcnt(6)
    v_mfma_f32_16x16x32_bf16 v[48:51], v[236:239], v[88:91], v[48:51]
    ds_read_b64_tr_b16 v[228:229], v5 offset:17184
    v_mfma_f32_16x16x32_bf16 v[52:55], v[236:239], v[92:95], v[52:55]
    ds_read_b64_tr_b16 v[230:231], v5 offset:18208
    s_waitcnt lgkmcnt(6)
    v_mfma_f32_16x16x32_bf16 v[56:59], v[240:243], v[88:91], v[56:59]
    ds_read_b64_tr_b16 v[232:233], v4 offset:24576
    v_mfma_f32_16x16x32_bf16 v[60:63], v[240:243], v[92:95], v[60:63]
    ds_read_b64_tr_b16 v[234:235], v4 offset:25600
    s_waitcnt lgkmcnt(6)
    v_mfma_f32_16x16x32_bf16 v[64:67], v[244:247], v[88:91], v[64:67]
    ds_read_b64_tr_b16 v[236:237], v5 offset:24608
    v_mfma_f32_16x16x32_bf16 v[68:71], v[244:247], v[92:95], v[68:71]
    ds_read_b64_tr_b16 v[238:239], v5 offset:25632
    s_mov_b32 s23, 0xd800
    buffer_load_dwordx4 v[124:127], v7, s[8:11], s23 offen offset:0 sc1
    s_waitcnt lgkmcnt(6)
    v_mfma_f32_16x16x32_bf16 v[72:75], v[224:227], v[88:91], v[72:75]
    ds_read_b64_tr_b16 v[240:241], v4 offset:24832
    v_xor_b32 v8, s28, v12
    v_xor_b32 v20, s28, v13
    v_or_b32 v8, v8, v20
    v_xor_b32 v20, s28, v14
    v_or_b32 v8, v8, v20
    v_xor_b32 v20, s28, v15
    v_or_b32 v8, v8, v20
    v_cmp_ne_u32 vcc, 0, v8
    s_cbranch_vccnz adaLN_cond__sliding_block_cached__moe_arch_mod__prompt_kernel_kv4r
adaLN_cond__sliding_block_cached__moe_arch_mod__prompt_kernel_kv4b:
    v_mfma_f32_16x16x32_bf16 v[76:79], v[224:227], v[92:95], v[76:79]
    ds_read_b64_tr_b16 v[242:243], v4 offset:25856
    v_mov_b32 v20, 0
    s_mov_b32 s16, 0x564000
    buffer_load_dword v8, v20, s[8:11], s16 offen sc1
    s_waitcnt lgkmcnt(6)
    v_mfma_f32_16x16x32_bf16 v[80:83], v[228:231], v[88:91], v[80:83]
    ds_read_b64_tr_b16 v[244:245], v5 offset:24864
    v_mfma_f32_16x16x32_bf16 v[84:87], v[228:231], v[92:95], v[84:87]
    ds_read_b64_tr_b16 v[246:247], v5 offset:25888
    s_waitcnt vmcnt(12) lgkmcnt(6)
    v_mfma_f32_16x16x32_bf16 v[24:27], v[232:235], v[96:99], v[24:27]
    ds_read_b64_tr_b16 v[224:225], v4 offset:25088
    s_waitcnt vmcnt(10)
    v_mfma_f32_16x16x32_bf16 v[28:31], v[232:235], v[100:103], v[28:31]
    ds_read_b64_tr_b16 v[226:227], v4 offset:26112
    s_waitcnt lgkmcnt(6)
    v_mfma_f32_16x16x32_bf16 v[32:35], v[236:239], v[96:99], v[32:35]
    ds_read_b64_tr_b16 v[228:229], v5 offset:25120
    v_mfma_f32_16x16x32_bf16 v[36:39], v[236:239], v[100:103], v[36:39]
    ds_read_b64_tr_b16 v[230:231], v5 offset:26144
    s_mov_b32 s23, 0x5800
    buffer_load_dwordx4 v[128:131], v7, s[8:11], s23 offen offset:1024 sc1
    s_waitcnt lgkmcnt(6)
    v_mfma_f32_16x16x32_bf16 v[40:43], v[240:243], v[96:99], v[40:43]
    ds_read_b64_tr_b16 v[232:233], v4 offset:25344
    s_mov_b64 s[76:77], s[54:55]
    s_mov_b32 s78, 0xc00000
    s_mov_b32 s79, 0x20000
    v_bfe_u32 v20, v1, 2, 2
    v_lshlrev_b32 v20, 12, v20
    v_add_u32 v6, v3, v20
    s_lshr_b32 s16, s2, 5
    s_lshl_b32 s16, s16, 7
    s_lshl_b32 s17, s3, 3
    s_add_u32 s16, s16, s17
    s_mul_i32 s14, s16, 12288
    s_and_b32 s16, s2, 31
    s_lshl_b32 s16, s16, 8
    s_add_u32 s14, s14, s16
    s_add_u32 s14, s14, 4096
    v_mfma_f32_16x16x32_bf16 v[44:47], v[240:243], v[100:103], v[44:47]
    ds_read_b64_tr_b16 v[234:235], v4 offset:26368
    s_waitcnt lgkmcnt(6)
    v_mfma_f32_16x16x32_bf16 v[48:51], v[244:247], v[96:99], v[48:51]
    ds_read_b64_tr_b16 v[236:237], v5 offset:25376
    v_mfma_f32_16x16x32_bf16 v[52:55], v[244:247], v[100:103], v[52:55]
    ds_read_b64_tr_b16 v[238:239], v5 offset:26400
    s_waitcnt lgkmcnt(6)
    v_mfma_f32_16x16x32_bf16 v[56:59], v[224:227], v[96:99], v[56:59]
    v_mfma_f32_16x16x32_bf16 v[60:63], v[224:227], v[100:103], v[60:63]
    s_waitcnt vmcnt(10)
    s_barrier
    ds_read_b64_tr_b16 v[240:241], v4 offset:32768
    ds_read_b64_tr_b16 v[242:243], v4 offset:33792
    s_waitcnt lgkmcnt(6)
    v_mfma_f32_16x16x32_bf16 v[64:67], v[228:231], v[96:99], v[64:67]
    ds_read_b64_tr_b16 v[244:245], v5 offset:32800
    v_mfma_f32_16x16x32_bf16 v[68:71], v[228:231], v[100:103], v[68:71]
    s_add_u32 s22, s19, 0x600000
    s_add_u32 m0, s20, 0x0
    s_nop 0
    buffer_load_dwordx4 v3, s[4:7], s22 offen lds
    ds_read_b64_tr_b16 v[246:247], v5 offset:33824
    s_mov_b32 s23, 0xd800
    buffer_load_dwordx4 v[132:135], v7, s[8:11], s23 offen offset:1024 sc1
    s_waitcnt lgkmcnt(6)
    v_mfma_f32_16x16x32_bf16 v[72:75], v[232:235], v[96:99], v[72:75]
    ds_read_b64_tr_b16 v[224:225], v4 offset:33024
    v_mfma_f32_16x16x32_bf16 v[76:79], v[232:235], v[100:103], v[76:79]
    ds_read_b64_tr_b16 v[226:227], v4 offset:34048
    s_waitcnt lgkmcnt(6)
    v_mfma_f32_16x16x32_bf16 v[80:83], v[236:239], v[96:99], v[80:83]
    ds_read_b64_tr_b16 v[228:229], v5 offset:33056
    v_mfma_f32_16x16x32_bf16 v[84:87], v[236:239], v[100:103], v[84:87]
    ds_read_b64_tr_b16 v[230:231], v5 offset:34080
    s_waitcnt vmcnt(11) lgkmcnt(6)
    v_mfma_f32_16x16x32_bf16 v[24:27], v[240:243], v[104:107], v[24:27]
    ds_read_b64_tr_b16 v[232:233], v4 offset:33280
    s_waitcnt vmcnt(10)
    v_mfma_f32_16x16x32_bf16 v[28:31], v[240:243], v[108:111], v[28:31]
    ds_read_b64_tr_b16 v[234:235], v4 offset:34304
    s_waitcnt lgkmcnt(6)
    v_mfma_f32_16x16x32_bf16 v[32:35], v[244:247], v[104:107], v[32:35]
    ds_read_b64_tr_b16 v[236:237], v5 offset:33312
    v_mfma_f32_16x16x32_bf16 v[36:39], v[244:247], v[108:111], v[36:39]
    s_add_u32 s22, s19, 0x608000
    s_add_u32 m0, s20, 0x400
    s_nop 0
    buffer_load_dwordx4 v3, s[4:7], s22 offen lds
    ds_read_b64_tr_b16 v[238:239], v5 offset:34336
    s_mov_b32 s23, 0x6000
    buffer_load_dwordx4 v[88:91], v7, s[8:11], s23 offen offset:0 sc1
    s_waitcnt lgkmcnt(6)
    v_mfma_f32_16x16x32_bf16 v[40:43], v[224:227], v[104:107], v[40:43]
    ds_read_b64_tr_b16 v[240:241], v4 offset:33536
    v_mfma_f32_16x16x32_bf16 v[44:47], v[224:227], v[108:111], v[44:47]
    ds_read_b64_tr_b16 v[242:243], v4 offset:34560
    s_waitcnt lgkmcnt(6)
    v_mfma_f32_16x16x32_bf16 v[48:51], v[228:231], v[104:107], v[48:51]
    ds_read_b64_tr_b16 v[244:245], v5 offset:33568
    v_mfma_f32_16x16x32_bf16 v[52:55], v[228:231], v[108:111], v[52:55]
    ds_read_b64_tr_b16 v[246:247], v5 offset:34592
    s_waitcnt lgkmcnt(6)
    v_mfma_f32_16x16x32_bf16 v[56:59], v[232:235], v[104:107], v[56:59]
    ds_read_b64_tr_b16 v[224:225], v4 offset:40960
    v_mfma_f32_16x16x32_bf16 v[60:63], v[232:235], v[108:111], v[60:63]
    ds_read_b64_tr_b16 v[226:227], v4 offset:41984
    s_waitcnt lgkmcnt(6)
    v_mfma_f32_16x16x32_bf16 v[64:67], v[236:239], v[104:107], v[64:67]
    ds_read_b64_tr_b16 v[228:229], v5 offset:40992
    v_mfma_f32_16x16x32_bf16 v[68:71], v[236:239], v[108:111], v[68:71]
    ds_read_b64_tr_b16 v[230:231], v5 offset:42016
    s_mov_b32 s23, 0xe000
    buffer_load_dwordx4 v[92:95], v7, s[8:11], s23 offen offset:0 sc1
    s_waitcnt lgkmcnt(6)
    v_mfma_f32_16x16x32_bf16 v[72:75], v[240:243], v[104:107], v[72:75]
    ds_read_b64_tr_b16 v[232:233], v4 offset:41216
    v_mfma_f32_16x16x32_bf16 v[76:79], v[240:243], v[108:111], v[76:79]
    ds_read_b64_tr_b16 v[234:235], v4 offset:42240
    s_waitcnt lgkmcnt(6)
    v_mfma_f32_16x16x32_bf16 v[80:83], v[244:247], v[104:107], v[80:83]
    ds_read_b64_tr_b16 v[236:237], v5 offset:41248
    v_mfma_f32_16x16x32_bf16 v[84:87], v[244:247], v[108:111], v[84:87]
    ds_read_b64_tr_b16 v[238:239], v5 offset:42272
    s_waitcnt vmcnt(12) lgkmcnt(6)
    v_mfma_f32_16x16x32_bf16 v[24:27], v[224:227], v[112:115], v[24:27]
    ds_read_b64_tr_b16 v[240:241], v4 offset:41472
    s_add_u32 s22, s14, 0x0
    s_add_u32 m0, s20, 0x10000
    s_nop 0
    buffer_load_dwordx4 v6, s[76:79], s22 offen lds
    s_waitcnt vmcnt(11)
    v_mfma_f32_16x16x32_bf16 v[28:31], v[224:227], v[116:119], v[28:31]
    ds_read_b64_tr_b16 v[242:243], v4 offset:42496
    s_waitcnt lgkmcnt(6)
    v_mfma_f32_16x16x32_bf16 v[32:35], v[228:231], v[112:115], v[32:35]
    ds_read_b64_tr_b16 v[244:245], v5 offset:41504
    v_mfma_f32_16x16x32_bf16 v[36:39], v[228:231], v[116:119], v[36:39]
    ds_read_b64_tr_b16 v[246:247], v5 offset:42528
    s_mov_b32 s23, 0x6000
    buffer_load_dwordx4 v[96:99], v7, s[8:11], s23 offen offset:1024 sc1
    s_waitcnt lgkmcnt(6)
    v_mfma_f32_16x16x32_bf16 v[40:43], v[232:235], v[112:115], v[40:43]
    ds_read_b64_tr_b16 v[224:225], v4 offset:41728
    s_add_u32 s22, s14, 0xc000
    s_add_u32 m0, s20, 0x10400
    s_nop 0
    buffer_load_dwordx4 v6, s[76:79], s22 offen lds
    v_mfma_f32_16x16x32_bf16 v[44:47], v[232:235], v[116:119], v[44:47]
    ds_read_b64_tr_b16 v[226:227], v4 offset:42752
    s_waitcnt lgkmcnt(6)
    v_mfma_f32_16x16x32_bf16 v[48:51], v[236:239], v[112:115], v[48:51]
    ds_read_b64_tr_b16 v[228:229], v5 offset:41760
    v_mfma_f32_16x16x32_bf16 v[52:55], v[236:239], v[116:119], v[52:55]
    ds_read_b64_tr_b16 v[230:231], v5 offset:42784
    s_waitcnt lgkmcnt(6)
    v_mfma_f32_16x16x32_bf16 v[56:59], v[240:243], v[112:115], v[56:59]
    v_mfma_f32_16x16x32_bf16 v[60:63], v[240:243], v[116:119], v[60:63]
    s_waitcnt vmcnt(12)
    s_barrier
    ds_read_b64_tr_b16 v[232:233], v4 offset:49152
    ds_read_b64_tr_b16 v[234:235], v4 offset:50176
    s_waitcnt lgkmcnt(6)
    v_mfma_f32_16x16x32_bf16 v[64:67], v[244:247], v[112:115], v[64:67]
    ds_read_b64_tr_b16 v[236:237], v5 offset:49184
    v_mfma_f32_16x16x32_bf16 v[68:71], v[244:247], v[116:119], v[68:71]
    s_add_u32 s22, s19, 0x680000
    s_add_u32 m0, s20, 0x4000
    s_nop 0
    buffer_load_dwordx4 v3, s[4:7], s22 offen lds
    ds_read_b64_tr_b16 v[238:239], v5 offset:50208
    s_mov_b32 s23, 0xe000
    buffer_load_dwordx4 v[100:103], v7, s[8:11], s23 offen offset:1024 sc1
    s_waitcnt lgkmcnt(6)
    v_mfma_f32_16x16x32_bf16 v[72:75], v[224:227], v[112:115], v[72:75]
    ds_read_b64_tr_b16 v[240:241], v4 offset:49408
    v_mfma_f32_16x16x32_bf16 v[76:79], v[224:227], v[116:119], v[76:79]
    ds_read_b64_tr_b16 v[242:243], v4 offset:50432
    s_waitcnt lgkmcnt(6)
    v_mfma_f32_16x16x32_bf16 v[80:83], v[228:231], v[112:115], v[80:83]
    ds_read_b64_tr_b16 v[244:245], v5 offset:49440
    v_mfma_f32_16x16x32_bf16 v[84:87], v[228:231], v[116:119], v[84:87]
    ds_read_b64_tr_b16 v[246:247], v5 offset:50464
    s_waitcnt vmcnt(13) lgkmcnt(6)
    v_mfma_f32_16x16x32_bf16 v[24:27], v[232:235], v[120:123], v[24:27]
    ds_read_b64_tr_b16 v[224:225], v4 offset:49664
    s_waitcnt vmcnt(12)
    v_mfma_f32_16x16x32_bf16 v[28:31], v[232:235], v[124:127], v[28:31]
    ds_read_b64_tr_b16 v[226:227], v4 offset:50688
    s_waitcnt lgkmcnt(6)
    v_mfma_f32_16x16x32_bf16 v[32:35], v[236:239], v[120:123], v[32:35]
    ds_read_b64_tr_b16 v[228:229], v5 offset:49696
    v_mfma_f32_16x16x32_bf16 v[36:39], v[236:239], v[124:127], v[36:39]
    s_add_u32 s22, s19, 0x688000
    s_add_u32 m0, s20, 0x4400
    s_nop 0
    buffer_load_dwordx4 v3, s[4:7], s22 offen lds
    ds_read_b64_tr_b16 v[230:231], v5 offset:50720
    s_mov_b32 s23, 0x6800
    buffer_load_dwordx4 v[104:107], v7, s[8:11], s23 offen offset:0 sc1
    s_waitcnt lgkmcnt(6)
    v_mfma_f32_16x16x32_bf16 v[40:43], v[240:243], v[120:123], v[40:43]
    ds_read_b64_tr_b16 v[232:233], v4 offset:49920
    v_mfma_f32_16x16x32_bf16 v[44:47], v[240:243], v[124:127], v[44:47]
    ds_read_b64_tr_b16 v[234:235], v4 offset:50944
    s_waitcnt lgkmcnt(6)
    v_mfma_f32_16x16x32_bf16 v[48:51], v[244:247], v[120:123], v[48:51]
    ds_read_b64_tr_b16 v[236:237], v5 offset:49952
    v_mfma_f32_16x16x32_bf16 v[52:55], v[244:247], v[124:127], v[52:55]
    ds_read_b64_tr_b16 v[238:239], v5 offset:50976
    s_waitcnt lgkmcnt(6)
    v_mfma_f32_16x16x32_bf16 v[56:59], v[224:227], v[120:123], v[56:59]
    ds_read_b64_tr_b16 v[240:241], v4 offset:57344
    v_mfma_f32_16x16x32_bf16 v[60:63], v[224:227], v[124:127], v[60:63]
    ds_read_b64_tr_b16 v[242:243], v4 offset:58368
    s_waitcnt lgkmcnt(6)
    v_mfma_f32_16x16x32_bf16 v[64:67], v[228:231], v[120:123], v[64:67]
    ds_read_b64_tr_b16 v[244:245], v5 offset:57376
    v_mfma_f32_16x16x32_bf16 v[68:71], v[228:231], v[124:127], v[68:71]
    ds_read_b64_tr_b16 v[246:247], v5 offset:58400
    s_mov_b32 s23, 0xe800
    buffer_load_dwordx4 v[108:111], v7, s[8:11], s23 offen offset:0 sc1
    s_waitcnt lgkmcnt(6)
    v_mfma_f32_16x16x32_bf16 v[72:75], v[232:235], v[120:123], v[72:75]
    ds_read_b64_tr_b16 v[224:225], v4 offset:57600
    v_mfma_f32_16x16x32_bf16 v[76:79], v[232:235], v[124:127], v[76:79]
    ds_read_b64_tr_b16 v[226:227], v4 offset:58624
    s_waitcnt lgkmcnt(6)
    v_mfma_f32_16x16x32_bf16 v[80:83], v[236:239], v[120:123], v[80:83]
    ds_read_b64_tr_b16 v[228:229], v5 offset:57632
    v_mfma_f32_16x16x32_bf16 v[84:87], v[236:239], v[124:127], v[84:87]
    ds_read_b64_tr_b16 v[230:231], v5 offset:58656
    s_waitcnt vmcnt(13) lgkmcnt(6)
    v_mfma_f32_16x16x32_bf16 v[24:27], v[240:243], v[128:131], v[24:27]
    ds_read_b64_tr_b16 v[232:233], v4 offset:57856
    s_add_u32 s22, s14, 0xc0000
    s_add_u32 m0, s20, 0x14000
    s_nop 0
    buffer_load_dwordx4 v6, s[76:79], s22 offen lds
    s_waitcnt vmcnt(12)
    v_mfma_f32_16x16x32_bf16 v[28:31], v[240:243], v[132:135], v[28:31]
    ds_read_b64_tr_b16 v[234:235], v4 offset:58880
    s_waitcnt lgkmcnt(6)
    v_mfma_f32_16x16x32_bf16 v[32:35], v[244:247], v[128:131], v[32:35]
    ds_read_b64_tr_b16 v[236:237], v5 offset:57888
    v_mfma_f32_16x16x32_bf16 v[36:39], v[244:247], v[132:135], v[36:39]
    ds_read_b64_tr_b16 v[238:239], v5 offset:58912
    s_mov_b32 s23, 0x6800
    buffer_load_dwordx4 v[112:115], v7, s[8:11], s23 offen offset:1024 sc1
    s_waitcnt lgkmcnt(6)
    v_mfma_f32_16x16x32_bf16 v[40:43], v[224:227], v[128:131], v[40:43]
    ds_read_b64_tr_b16 v[240:241], v4 offset:58112
    s_add_u32 s22, s14, 0xcc000
    s_add_u32 m0, s20, 0x14400
    s_nop 0
    buffer_load_dwordx4 v6, s[76:79], s22 offen lds
    v_mfma_f32_16x16x32_bf16 v[44:47], v[224:227], v[132:135], v[44:47]
    ds_read_b64_tr_b16 v[242:243], v4 offset:59136
    s_waitcnt lgkmcnt(6)
    v_mfma_f32_16x16x32_bf16 v[48:51], v[228:231], v[128:131], v[48:51]
    ds_read_b64_tr_b16 v[244:245], v5 offset:58144
    v_mfma_f32_16x16x32_bf16 v[52:55], v[228:231], v[132:135], v[52:55]
    ds_read_b64_tr_b16 v[246:247], v5 offset:59168
    s_waitcnt lgkmcnt(6)
    v_mfma_f32_16x16x32_bf16 v[56:59], v[232:235], v[128:131], v[56:59]
    v_mfma_f32_16x16x32_bf16 v[60:63], v[232:235], v[132:135], v[60:63]
    s_waitcnt vmcnt(13)
    s_barrier
    ds_read_b64_tr_b16 v[224:225], v4 offset:0
    ds_read_b64_tr_b16 v[226:227], v4 offset:1024
    s_waitcnt lgkmcnt(6)
    v_mfma_f32_16x16x32_bf16 v[64:67], v[236:239], v[128:131], v[64:67]
    ds_read_b64_tr_b16 v[228:229], v5 offset:32
    v_mfma_f32_16x16x32_bf16 v[68:71], v[236:239], v[132:135], v[68:71]
    s_add_u32 s22, s19, 0x700000
    s_add_u32 m0, s20, 0x8000
    s_nop 0
    buffer_load_dwordx4 v3, s[4:7], s22 offen lds
    ds_read_b64_tr_b16 v[230:231], v5 offset:1056
    s_mov_b32 s23, 0xe800
    buffer_load_dwordx4 v[116:119], v7, s[8:11], s23 offen offset:1024 sc1
    s_waitcnt lgkmcnt(6)
    v_mfma_f32_16x16x32_bf16 v[72:75], v[240:243], v[128:131], v[72:75]
    ds_read_b64_tr_b16 v[232:233], v4 offset:256
    v_mfma_f32_16x16x32_bf16 v[76:79], v[240:243], v[132:135], v[76:79]
    ds_read_b64_tr_b16 v[234:235], v4 offset:1280
    s_waitcnt lgkmcnt(6)
    v_mfma_f32_16x16x32_bf16 v[80:83], v[244:247], v[128:131], v[80:83]
    ds_read_b64_tr_b16 v[236:237], v5 offset:288
    v_mfma_f32_16x16x32_bf16 v[84:87], v[244:247], v[132:135], v[84:87]
    ds_read_b64_tr_b16 v[238:239], v5 offset:1312
    s_waitcnt vmcnt(14) lgkmcnt(6)
    v_mfma_f32_16x16x32_bf16 v[24:27], v[224:227], v[88:91], v[24:27]
    ds_read_b64_tr_b16 v[240:241], v4 offset:512
    s_waitcnt vmcnt(13)
    v_mfma_f32_16x16x32_bf16 v[28:31], v[224:227], v[92:95], v[28:31]
    ds_read_b64_tr_b16 v[242:243], v4 offset:1536
    s_waitcnt lgkmcnt(6)
    v_mfma_f32_16x16x32_bf16 v[32:35], v[228:231], v[88:91], v[32:35]
    ds_read_b64_tr_b16 v[244:245], v5 offset:544
    v_mfma_f32_16x16x32_bf16 v[36:39], v[228:231], v[92:95], v[36:39]
    s_add_u32 s22, s19, 0x708000
    s_add_u32 m0, s20, 0x8400
    s_nop 0
    buffer_load_dwordx4 v3, s[4:7], s22 offen lds
    ds_read_b64_tr_b16 v[246:247], v5 offset:1568
    s_mov_b32 s23, 0x7000
    buffer_load_dwordx4 v[120:123], v7, s[8:11], s23 offen offset:0 sc1
    s_waitcnt lgkmcnt(6)
    v_mfma_f32_16x16x32_bf16 v[40:43], v[232:235], v[88:91], v[40:43]
    ds_read_b64_tr_b16 v[224:225], v4 offset:768
    v_mfma_f32_16x16x32_bf16 v[44:47], v[232:235], v[92:95], v[44:47]
    ds_read_b64_tr_b16 v[226:227], v4 offset:1792
    s_waitcnt lgkmcnt(6)
    v_mfma_f32_16x16x32_bf16 v[48:51], v[236:239], v[88:91], v[48:51]
    ds_read_b64_tr_b16 v[228:229], v5 offset:800
    v_mfma_f32_16x16x32_bf16 v[52:55], v[236:239], v[92:95], v[52:55]
    ds_read_b64_tr_b16 v[230:231], v5 offset:1824
    s_waitcnt lgkmcnt(6)
    v_mfma_f32_16x16x32_bf16 v[56:59], v[240:243], v[88:91], v[56:59]
    ds_read_b64_tr_b16 v[232:233], v4 offset:8192
    v_mfma_f32_16x16x32_bf16 v[60:63], v[240:243], v[92:95], v[60:63]
    ds_read_b64_tr_b16 v[234:235], v4 offset:9216
    s_waitcnt lgkmcnt(6)
    v_mfma_f32_16x16x32_bf16 v[64:67], v[244:247], v[88:91], v[64:67]
    ds_read_b64_tr_b16 v[236:237], v5 offset:8224
    v_mfma_f32_16x16x32_bf16 v[68:71], v[244:247], v[92:95], v[68:71]
    ds_read_b64_tr_b16 v[238:239], v5 offset:9248
    s_mov_b32 s23, 0xf000
    buffer_load_dwordx4 v[124:127], v7, s[8:11], s23 offen offset:0 sc1
    s_waitcnt lgkmcnt(6)
    v_mfma_f32_16x16x32_bf16 v[72:75], v[224:227], v[88:91], v[72:75]
    ds_read_b64_tr_b16 v[240:241], v4 offset:8448
    v_mfma_f32_16x16x32_bf16 v[76:79], v[224:227], v[92:95], v[76:79]
    ds_read_b64_tr_b16 v[242:243], v4 offset:9472
    s_waitcnt lgkmcnt(6)
    v_mfma_f32_16x16x32_bf16 v[80:83], v[228:231], v[88:91], v[80:83]
    ds_read_b64_tr_b16 v[244:245], v5 offset:8480
    v_mfma_f32_16x16x32_bf16 v[84:87], v[228:231], v[92:95], v[84:87]
    ds_read_b64_tr_b16 v[246:247], v5 offset:9504
    s_waitcnt vmcnt(14) lgkmcnt(6)
    v_mfma_f32_16x16x32_bf16 v[24:27], v[232:235], v[96:99], v[24:27]
    ds_read_b64_tr_b16 v[224:225], v4 offset:8704
    s_add_u32 s22, s21, 0x0
    s_add_u32 m0, s20, 0x18000
    s_nop 0
    buffer_load_dwordx4 v2, s[8:11], s22 offen sc1 lds
    s_waitcnt vmcnt(12)
    v_mfma_f32_16x16x32_bf16 v[28:31], v[232:235], v[100:103], v[28:31]
    ds_read_b64_tr_b16 v[226:227], v4 offset:9728
    s_waitcnt lgkmcnt(6)
    v_mfma_f32_16x16x32_bf16 v[32:35], v[236:239], v[96:99], v[32:35]
    ds_read_b64_tr_b16 v[228:229], v5 offset:8736
    v_mfma_f32_16x16x32_bf16 v[36:39], v[236:239], v[100:103], v[36:39]
    ds_read_b64_tr_b16 v[230:231], v5 offset:9760
    s_mov_b32 s23, 0x7000
    buffer_load_dwordx4 v[128:131], v7, s[8:11], s23 offen offset:1024 sc1
    s_waitcnt lgkmcnt(6)
    v_mfma_f32_16x16x32_bf16 v[40:43], v[240:243], v[96:99], v[40:43]
    ds_read_b64_tr_b16 v[232:233], v4 offset:8960
    s_add_u32 s22, s21, 0x400
    s_add_u32 m0, s20, 0x18400
    s_nop 0
    buffer_load_dwordx4 v2, s[8:11], s22 offen sc1 lds
    v_mfma_f32_16x16x32_bf16 v[44:47], v[240:243], v[100:103], v[44:47]
    ds_read_b64_tr_b16 v[234:235], v4 offset:9984
    s_waitcnt lgkmcnt(6)
    v_mfma_f32_16x16x32_bf16 v[48:51], v[244:247], v[96:99], v[48:51]
    ds_read_b64_tr_b16 v[236:237], v5 offset:8992
    v_mfma_f32_16x16x32_bf16 v[52:55], v[244:247], v[100:103], v[52:55]
    ds_read_b64_tr_b16 v[238:239], v5 offset:10016
    s_waitcnt lgkmcnt(6)
    v_mfma_f32_16x16x32_bf16 v[56:59], v[224:227], v[96:99], v[56:59]
    v_mfma_f32_16x16x32_bf16 v[60:63], v[224:227], v[100:103], v[60:63]
    s_waitcnt vmcnt(13)
    s_barrier
    ds_read_b64_tr_b16 v[240:241], v4 offset:16384
    ds_read_b64_tr_b16 v[242:243], v4 offset:17408
    s_waitcnt lgkmcnt(6)
    v_mfma_f32_16x16x32_bf16 v[64:67], v[228:231], v[96:99], v[64:67]
    ds_read_b64_tr_b16 v[244:245], v5 offset:16416
    v_mfma_f32_16x16x32_bf16 v[68:71], v[228:231], v[100:103], v[68:71]
    s_add_u32 s22, s19, 0x780000
    s_add_u32 m0, s20, 0xc000
    s_nop 0
    buffer_load_dwordx4 v3, s[4:7], s22 offen lds
    ds_read_b64_tr_b16 v[246:247], v5 offset:17440
    s_mov_b32 s23, 0xf000
    buffer_load_dwordx4 v[132:135], v7, s[8:11], s23 offen offset:1024 sc1
    s_waitcnt lgkmcnt(6)
    v_mfma_f32_16x16x32_bf16 v[72:75], v[232:235], v[96:99], v[72:75]
    ds_read_b64_tr_b16 v[224:225], v4 offset:16640
    v_mfma_f32_16x16x32_bf16 v[76:79], v[232:235], v[100:103], v[76:79]
    ds_read_b64_tr_b16 v[226:227], v4 offset:17664
    s_waitcnt lgkmcnt(6)
    v_mfma_f32_16x16x32_bf16 v[80:83], v[236:239], v[96:99], v[80:83]
    ds_read_b64_tr_b16 v[228:229], v5 offset:16672
    v_mfma_f32_16x16x32_bf16 v[84:87], v[236:239], v[100:103], v[84:87]
    ds_read_b64_tr_b16 v[230:231], v5 offset:17696
    s_waitcnt vmcnt(14) lgkmcnt(6)
    v_mfma_f32_16x16x32_bf16 v[24:27], v[240:243], v[104:107], v[24:27]
    ds_read_b64_tr_b16 v[232:233], v4 offset:16896
    s_waitcnt vmcnt(13)
    v_mfma_f32_16x16x32_bf16 v[28:31], v[240:243], v[108:111], v[28:31]
    ds_read_b64_tr_b16 v[234:235], v4 offset:17920
    s_waitcnt lgkmcnt(6)
    v_mfma_f32_16x16x32_bf16 v[32:35], v[244:247], v[104:107], v[32:35]
    ds_read_b64_tr_b16 v[236:237], v5 offset:16928
    v_mfma_f32_16x16x32_bf16 v[36:39], v[244:247], v[108:111], v[36:39]
    s_add_u32 s22, s19, 0x788000
    s_add_u32 m0, s20, 0xc400
    s_nop 0
    buffer_load_dwordx4 v3, s[4:7], s22 offen lds
    ds_read_b64_tr_b16 v[238:239], v5 offset:17952
    s_mov_b32 s23, 0x7800
    buffer_load_dwordx4 v[88:91], v7, s[8:11], s23 offen offset:0 sc1
    s_waitcnt lgkmcnt(6)
    v_mfma_f32_16x16x32_bf16 v[40:43], v[224:227], v[104:107], v[40:43]
    ds_read_b64_tr_b16 v[240:241], v4 offset:17152
    v_lshrrev_b32 v20, 4, v1
    v_lshlrev_b32 v21, 4, v20
    s_lshl_b32 s16, s2, 8
    s_add_u32 s16, s16, 0x550000
    buffer_load_dwordx4 v[136:139], v21, s[8:11], s16 offen offset:0 sc1
    buffer_load_dwordx4 v[140:143], v21, s[8:11], s16 offen offset:64 sc1
    buffer_load_dwordx4 v[144:147], v21, s[8:11], s16 offen offset:128 sc1
    buffer_load_dwordx4 v[148:151], v21, s[8:11], s16 offen offset:192 sc1
    v_lshlrev_b32 v11, 11, v20
    v_xor_b32 v20, s3, v20
    v_and_b32 v20, 1, v20
    v_lshl_add_u32 v11, v20, 5, v11
    v_bfe_u32 v20, v1, 2, 2
    v_lshl_add_u32 v11, v20, 6, v11
    v_and_b32 v20, 3, v1
    v_lshl_add_u32 v11, v20, 3, v11
    s_lshr_b32 s16, s3, 1
    s_lshl_b32 s16, s16, 8
    s_add_u32 s16, s16, 65536
    v_add_u32 v11, s16, v11
    v_mfma_f32_16x16x32_bf16 v[44:47], v[224:227], v[108:111], v[44:47]
    ds_read_b64_tr_b16 v[242:243], v4 offset:18176
    s_waitcnt lgkmcnt(6)
    v_mfma_f32_16x16x32_bf16 v[48:51], v[228:231], v[104:107], v[48:51]
    ds_read_b64_tr_b16 v[244:245], v5 offset:17184
    v_mfma_f32_16x16x32_bf16 v[52:55], v[228:231], v[108:111], v[52:55]
    ds_read_b64_tr_b16 v[246:247], v5 offset:18208
    s_waitcnt lgkmcnt(6)
    v_mfma_f32_16x16x32_bf16 v[56:59], v[232:235], v[104:107], v[56:59]
    ds_read_b64_tr_b16 v[224:225], v4 offset:24576
    v_mfma_f32_16x16x32_bf16 v[60:63], v[232:235], v[108:111], v[60:63]
    ds_read_b64_tr_b16 v[226:227], v4 offset:25600
    s_waitcnt lgkmcnt(6)
    v_mfma_f32_16x16x32_bf16 v[64:67], v[236:239], v[104:107], v[64:67]
    ds_read_b64_tr_b16 v[228:229], v5 offset:24608
    v_mfma_f32_16x16x32_bf16 v[68:71], v[236:239], v[108:111], v[68:71]
    ds_read_b64_tr_b16 v[230:231], v5 offset:25632
    s_mov_b32 s23, 0xf800
    buffer_load_dwordx4 v[92:95], v7, s[8:11], s23 offen offset:0 sc1
    s_waitcnt lgkmcnt(6)
    v_mfma_f32_16x16x32_bf16 v[72:75], v[240:243], v[104:107], v[72:75]
    ds_read_b64_tr_b16 v[232:233], v4 offset:24832
    v_mfma_f32_16x16x32_bf16 v[76:79], v[240:243], v[108:111], v[76:79]
    ds_read_b64_tr_b16 v[234:235], v4 offset:25856
    s_waitcnt lgkmcnt(6)
    v_mfma_f32_16x16x32_bf16 v[80:83], v[244:247], v[104:107], v[80:83]
    ds_read_b64_tr_b16 v[236:237], v5 offset:24864
    v_mfma_f32_16x16x32_bf16 v[84:87], v[244:247], v[108:111], v[84:87]
    ds_read_b64_tr_b16 v[238:239], v5 offset:25888
    s_waitcnt vmcnt(18) lgkmcnt(6)
    v_mfma_f32_16x16x32_bf16 v[24:27], v[224:227], v[112:115], v[24:27]
    ds_read_b64_tr_b16 v[240:241], v4 offset:25088
    s_add_u32 s22, s21, 0x4000
    s_add_u32 m0, s20, 0x1c000
    s_nop 0
    buffer_load_dwordx4 v2, s[8:11], s22 offen sc1 lds
    s_waitcnt vmcnt(16)
    v_mfma_f32_16x16x32_bf16 v[28:31], v[224:227], v[116:119], v[28:31]
    ds_read_b64_tr_b16 v[242:243], v4 offset:26112
    s_waitcnt lgkmcnt(6)
    v_mfma_f32_16x16x32_bf16 v[32:35], v[228:231], v[112:115], v[32:35]
    ds_read_b64_tr_b16 v[244:245], v5 offset:25120
    v_mfma_f32_16x16x32_bf16 v[36:39], v[228:231], v[116:119], v[36:39]
    ds_read_b64_tr_b16 v[246:247], v5 offset:26144
    s_mov_b32 s23, 0x7800
    buffer_load_dwordx4 v[96:99], v7, s[8:11], s23 offen offset:1024 sc1
    s_waitcnt lgkmcnt(6)
    v_mfma_f32_16x16x32_bf16 v[40:43], v[232:235], v[112:115], v[40:43]
    ds_read_b64_tr_b16 v[224:225], v4 offset:25344
    s_add_u32 s22, s21, 0x4400
    s_add_u32 m0, s20, 0x1c400
    s_nop 0
    buffer_load_dwordx4 v2, s[8:11], s22 offen sc1 lds
    v_mfma_f32_16x16x32_bf16 v[44:47], v[232:235], v[116:119], v[44:47]
    ds_read_b64_tr_b16 v[226:227], v4 offset:26368
    s_waitcnt lgkmcnt(6)
    v_mfma_f32_16x16x32_bf16 v[48:51], v[236:239], v[112:115], v[48:51]
    ds_read_b64_tr_b16 v[228:229], v5 offset:25376
    v_mfma_f32_16x16x32_bf16 v[52:55], v[236:239], v[116:119], v[52:55]
    ds_read_b64_tr_b16 v[230:231], v5 offset:26400
    s_waitcnt lgkmcnt(6)
    v_mfma_f32_16x16x32_bf16 v[56:59], v[240:243], v[112:115], v[56:59]
    v_mfma_f32_16x16x32_bf16 v[60:63], v[240:243], v[116:119], v[60:63]
    s_waitcnt vmcnt(17)
    s_barrier
    ds_read_b64_tr_b16 v[232:233], v4 offset:32768
    ds_read_b64_tr_b16 v[234:235], v4 offset:33792
    s_waitcnt lgkmcnt(6)
    v_mfma_f32_16x16x32_bf16 v[64:67], v[244:247], v[112:115], v[64:67]
    ds_read_b64_tr_b16 v[236:237], v5 offset:32800
    v_mfma_f32_16x16x32_bf16 v[68:71], v[244:247], v[116:119], v[68:71]
    ds_read_b64_tr_b16 v[238:239], v5 offset:33824
    s_mov_b32 s23, 0xf800
    buffer_load_dwordx4 v[100:103], v7, s[8:11], s23 offen offset:1024 sc1
    s_waitcnt lgkmcnt(6)
    v_mfma_f32_16x16x32_bf16 v[72:75], v[224:227], v[112:115], v[72:75]
    ds_read_b64_tr_b16 v[240:241], v4 offset:33024
    v_mfma_f32_16x16x32_bf16 v[76:79], v[224:227], v[116:119], v[76:79]
    ds_read_b64_tr_b16 v[242:243], v4 offset:34048
    s_waitcnt lgkmcnt(6)
    v_mfma_f32_16x16x32_bf16 v[80:83], v[228:231], v[112:115], v[80:83]
    ds_read_b64_tr_b16 v[244:245], v5 offset:33056
    v_mfma_f32_16x16x32_bf16 v[84:87], v[228:231], v[116:119], v[84:87]
    ds_read_b64_tr_b16 v[246:247], v5 offset:34080
    s_waitcnt vmcnt(17) lgkmcnt(6)
    v_mfma_f32_16x16x32_bf16 v[24:27], v[232:235], v[120:123], v[24:27]
    ds_read_b64_tr_b16 v[224:225], v4 offset:33280
    s_waitcnt vmcnt(16)
    v_mfma_f32_16x16x32_bf16 v[28:31], v[232:235], v[124:127], v[28:31]
    ds_read_b64_tr_b16 v[226:227], v4 offset:34304
    s_waitcnt lgkmcnt(6)
    v_mfma_f32_16x16x32_bf16 v[32:35], v[236:239], v[120:123], v[32:35]
    ds_read_b64_tr_b16 v[228:229], v5 offset:33312
    v_mfma_f32_16x16x32_bf16 v[36:39], v[236:239], v[124:127], v[36:39]
    ds_read_b64_tr_b16 v[230:231], v5 offset:34336
    s_waitcnt lgkmcnt(6)
    v_mfma_f32_16x16x32_bf16 v[40:43], v[240:243], v[120:123], v[40:43]
    ds_read_b64_tr_b16 v[232:233], v4 offset:33536
    v_mfma_f32_16x16x32_bf16 v[44:47], v[240:243], v[124:127], v[44:47]
    ds_read_b64_tr_b16 v[234:235], v4 offset:34560
    s_waitcnt lgkmcnt(6)
    v_mfma_f32_16x16x32_bf16 v[48:51], v[244:247], v[120:123], v[48:51]
    ds_read_b64_tr_b16 v[236:237], v5 offset:33568
    v_mfma_f32_16x16x32_bf16 v[52:55], v[244:247], v[124:127], v[52:55]
    ds_read_b64_tr_b16 v[238:239], v5 offset:34592
    s_waitcnt lgkmcnt(6)
    v_mfma_f32_16x16x32_bf16 v[56:59], v[224:227], v[120:123], v[56:59]
    ds_read_b64_tr_b16 v[240:241], v4 offset:40960
    v_mfma_f32_16x16x32_bf16 v[60:63], v[224:227], v[124:127], v[60:63]
    ds_read_b64_tr_b16 v[242:243], v4 offset:41984
    s_waitcnt lgkmcnt(6)
    v_mfma_f32_16x16x32_bf16 v[64:67], v[228:231], v[120:123], v[64:67]
    ds_read_b64_tr_b16 v[244:245], v5 offset:40992
    v_mfma_f32_16x16x32_bf16 v[68:71], v[228:231], v[124:127], v[68:71]
    ds_read_b64_tr_b16 v[246:247], v5 offset:42016
    s_waitcnt lgkmcnt(6)
    v_mfma_f32_16x16x32_bf16 v[72:75], v[232:235], v[120:123], v[72:75]
    ds_read_b64_tr_b16 v[224:225], v4 offset:41216
    v_mfma_f32_16x16x32_bf16 v[76:79], v[232:235], v[124:127], v[76:79]
    ds_read_b64_tr_b16 v[226:227], v4 offset:42240
    s_waitcnt lgkmcnt(6)
    v_mfma_f32_16x16x32_bf16 v[80:83], v[236:239], v[120:123], v[80:83]
    ds_read_b64_tr_b16 v[228:229], v5 offset:41248
    v_mfma_f32_16x16x32_bf16 v[84:87], v[236:239], v[124:127], v[84:87]
    ds_read_b64_tr_b16 v[230:231], v5 offset:42272
    s_waitcnt vmcnt(14) lgkmcnt(6)
    v_mfma_f32_16x16x32_bf16 v[24:27], v[240:243], v[128:131], v[24:27]
    ds_read_b64_tr_b16 v[232:233], v4 offset:41472
    s_waitcnt vmcnt(11)
    v_mfma_f32_16x16x32_bf16 v[28:31], v[240:243], v[132:135], v[28:31]
    ds_read_b64_tr_b16 v[234:235], v4 offset:42496
    s_waitcnt lgkmcnt(6)
    v_mfma_f32_16x16x32_bf16 v[32:35], v[244:247], v[128:131], v[32:35]
    ds_read_b64_tr_b16 v[236:237], v5 offset:41504
    v_mfma_f32_16x16x32_bf16 v[36:39], v[244:247], v[132:135], v[36:39]
    ds_read_b64_tr_b16 v[238:239], v5 offset:42528
    s_waitcnt lgkmcnt(6)
    v_mfma_f32_16x16x32_bf16 v[40:43], v[224:227], v[128:131], v[40:43]
    ds_read_b64_tr_b16 v[240:241], v4 offset:41728
    v_mfma_f32_16x16x32_bf16 v[44:47], v[224:227], v[132:135], v[44:47]
    ds_read_b64_tr_b16 v[242:243], v4 offset:42752
    s_waitcnt lgkmcnt(6)
    v_mfma_f32_16x16x32_bf16 v[48:51], v[228:231], v[128:131], v[48:51]
    ds_read_b64_tr_b16 v[244:245], v5 offset:41760
    v_mfma_f32_16x16x32_bf16 v[52:55], v[228:231], v[132:135], v[52:55]
    ds_read_b64_tr_b16 v[246:247], v5 offset:42784
    s_waitcnt lgkmcnt(6)
    v_mfma_f32_16x16x32_bf16 v[56:59], v[232:235], v[128:131], v[56:59]
    v_mfma_f32_16x16x32_bf16 v[60:63], v[232:235], v[132:135], v[60:63]
    s_waitcnt vmcnt(10)
    s_barrier
    ds_read_b64_tr_b16 v[224:225], v4 offset:49152
    ds_read_b64_tr_b16 v[226:227], v4 offset:50176
    s_waitcnt lgkmcnt(6)
    v_mfma_f32_16x16x32_bf16 v[64:67], v[236:239], v[128:131], v[64:67]
    ds_read_b64_tr_b16 v[228:229], v5 offset:49184
    v_mfma_f32_16x16x32_bf16 v[68:71], v[236:239], v[132:135], v[68:71]
    ds_read_b64_tr_b16 v[230:231], v5 offset:50208
    s_waitcnt lgkmcnt(6)
    v_mfma_f32_16x16x32_bf16 v[72:75], v[240:243], v[128:131], v[72:75]
    ds_read_b64_tr_b16 v[232:233], v4 offset:49408
    v_mfma_f32_16x16x32_bf16 v[76:79], v[240:243], v[132:135], v[76:79]
    ds_read_b64_tr_b16 v[234:235], v4 offset:50432
    s_waitcnt lgkmcnt(6)
    v_mfma_f32_16x16x32_bf16 v[80:83], v[244:247], v[128:131], v[80:83]
    ds_read_b64_tr_b16 v[236:237], v5 offset:49440
    v_mfma_f32_16x16x32_bf16 v[84:87], v[244:247], v[132:135], v[84:87]
    ds_read_b64_tr_b16 v[238:239], v5 offset:50464
    s_waitcnt vmcnt(9) lgkmcnt(6)
    v_mfma_f32_16x16x32_bf16 v[24:27], v[224:227], v[88:91], v[24:27]
    ds_read_b64_tr_b16 v[240:241], v4 offset:49664
    s_waitcnt vmcnt(4)
    v_mfma_f32_16x16x32_bf16 v[28:31], v[224:227], v[92:95], v[28:31]
    ds_read_b64_tr_b16 v[242:243], v4 offset:50688
    s_waitcnt lgkmcnt(6)
    v_mfma_f32_16x16x32_bf16 v[32:35], v[228:231], v[88:91], v[32:35]
    ds_read_b64_tr_b16 v[244:245], v5 offset:49696
    v_mfma_f32_16x16x32_bf16 v[36:39], v[228:231], v[92:95], v[36:39]
    ds_read_b64_tr_b16 v[246:247], v5 offset:50720
    s_waitcnt lgkmcnt(6)
    v_mfma_f32_16x16x32_bf16 v[40:43], v[232:235], v[88:91], v[40:43]
    ds_read_b64_tr_b16 v[224:225], v4 offset:49920
    v_mfma_f32_16x16x32_bf16 v[44:47], v[232:235], v[92:95], v[44:47]
    ds_read_b64_tr_b16 v[226:227], v4 offset:50944
    s_waitcnt lgkmcnt(6)
    v_mfma_f32_16x16x32_bf16 v[48:51], v[236:239], v[88:91], v[48:51]
    ds_read_b64_tr_b16 v[228:229], v5 offset:49952
    v_mfma_f32_16x16x32_bf16 v[52:55], v[236:239], v[92:95], v[52:55]
    ds_read_b64_tr_b16 v[230:231], v5 offset:50976
    s_waitcnt lgkmcnt(6)
    v_mfma_f32_16x16x32_bf16 v[56:59], v[240:243], v[88:91], v[56:59]
    ds_read_b64_tr_b16 v[232:233], v4 offset:57344
    v_mfma_f32_16x16x32_bf16 v[60:63], v[240:243], v[92:95], v[60:63]
    ds_read_b64_tr_b16 v[234:235], v4 offset:58368
    s_waitcnt lgkmcnt(6)
    v_mfma_f32_16x16x32_bf16 v[64:67], v[244:247], v[88:91], v[64:67]
    ds_read_b64_tr_b16 v[236:237], v5 offset:57376
    v_mfma_f32_16x16x32_bf16 v[68:71], v[244:247], v[92:95], v[68:71]
    ds_read_b64_tr_b16 v[238:239], v5 offset:58400
    s_waitcnt lgkmcnt(6)
    v_mfma_f32_16x16x32_bf16 v[72:75], v[224:227], v[88:91], v[72:75]
    ds_read_b64_tr_b16 v[240:241], v4 offset:57600
    v_mfma_f32_16x16x32_bf16 v[76:79], v[224:227], v[92:95], v[76:79]
    ds_read_b64_tr_b16 v[242:243], v4 offset:58624
    s_waitcnt lgkmcnt(6)
    v_mfma_f32_16x16x32_bf16 v[80:83], v[228:231], v[88:91], v[80:83]
    ds_read_b64_tr_b16 v[244:245], v5 offset:57632
    v_mfma_f32_16x16x32_bf16 v[84:87], v[228:231], v[92:95], v[84:87]
    ds_read_b64_tr_b16 v[246:247], v5 offset:58656
    s_waitcnt vmcnt(2) lgkmcnt(6)
    v_mfma_f32_16x16x32_bf16 v[24:27], v[232:235], v[96:99], v[24:27]
    ds_read_b64_tr_b16 v[224:225], v4 offset:57856
    s_waitcnt vmcnt(0)
    v_mfma_f32_16x16x32_bf16 v[28:31], v[232:235], v[100:103], v[28:31]
    ds_read_b64_tr_b16 v[226:227], v4 offset:58880
    s_waitcnt lgkmcnt(6)
    v_mfma_f32_16x16x32_bf16 v[32:35], v[236:239], v[96:99], v[32:35]
    ds_read_b64_tr_b16 v[228:229], v5 offset:57888
    v_mfma_f32_16x16x32_bf16 v[36:39], v[236:239], v[100:103], v[36:39]
    ds_read_b64_tr_b16 v[230:231], v5 offset:58912
    s_waitcnt lgkmcnt(6)
    v_mfma_f32_16x16x32_bf16 v[40:43], v[240:243], v[96:99], v[40:43]
    ds_read_b64_tr_b16 v[232:233], v4 offset:58112
    v_mfma_f32_16x16x32_bf16 v[44:47], v[240:243], v[100:103], v[44:47]
    ds_read_b64_tr_b16 v[234:235], v4 offset:59136
    s_waitcnt lgkmcnt(6)
    v_mfma_f32_16x16x32_bf16 v[48:51], v[244:247], v[96:99], v[48:51]
    ds_read_b64_tr_b16 v[236:237], v5 offset:58144
    v_mfma_f32_16x16x32_bf16 v[52:55], v[244:247], v[100:103], v[52:55]
    ds_read_b64_tr_b16 v[238:239], v5 offset:59168
    s_waitcnt lgkmcnt(6)
    v_mfma_f32_16x16x32_bf16 v[56:59], v[224:227], v[96:99], v[56:59]
    v_mfma_f32_16x16x32_bf16 v[60:63], v[224:227], v[100:103], v[60:63]
    s_waitcnt lgkmcnt(4)
    v_mfma_f32_16x16x32_bf16 v[64:67], v[228:231], v[96:99], v[64:67]
    v_mfma_f32_16x16x32_bf16 v[68:71], v[228:231], v[100:103], v[68:71]
    s_waitcnt lgkmcnt(2)
    v_mfma_f32_16x16x32_bf16 v[72:75], v[232:235], v[96:99], v[72:75]
    v_mfma_f32_16x16x32_bf16 v[76:79], v[232:235], v[100:103], v[76:79]
    s_waitcnt lgkmcnt(0)
    v_mfma_f32_16x16x32_bf16 v[80:83], v[236:239], v[96:99], v[80:83]
    v_mfma_f32_16x16x32_bf16 v[84:87], v[236:239], v[100:103], v[84:87]
    s_barrier
    s_add_u32 s22, s21, 0x8000
    s_add_u32 m0, s20, 0x20000
    s_nop 0
    buffer_load_dwordx4 v2, s[8:11], s22 offen sc1 lds
    s_add_u32 s22, s21, 0x8400
    s_add_u32 m0, s20, 0x20400
    s_nop 0
    buffer_load_dwordx4 v2, s[8:11], s22 offen sc1 lds
    s_add_u32 s22, s21, 0xc000
    s_add_u32 m0, s20, 0x24000
    s_nop 0
    buffer_load_dwordx4 v2, s[8:11], s22 offen sc1 lds
    s_add_u32 s22, s21, 0xc400
    s_add_u32 m0, s20, 0x24400
    s_nop 0
    buffer_load_dwordx4 v2, s[8:11], s22 offen sc1 lds
    ds_read_b64_tr_b16 v[88:89], v11 offset:0
    ds_read_b64_tr_b16 v[90:91], v11 offset:1024
    ds_read_b64_tr_b16 v[92:93], v11 offset:8192
    ds_read_b64_tr_b16 v[94:95], v11 offset:9216
    ds_read_b64_tr_b16 v[96:97], v11 offset:16384
    ds_read_b64_tr_b16 v[98:99], v11 offset:17408
    ds_read_b64_tr_b16 v[100:101], v11 offset:24576
    ds_read_b64_tr_b16 v[102:103], v11 offset:25600
    s_mov_b32 s23, 0x3e0293ee
    v_mul_f32 v24, s23, v24
    v_mul_f32 v25, s23, v25
    v_mul_f32 v26, s23, v26
    v_mul_f32 v27, s23, v27
    v_mul_f32 v28, s23, v28
    v_mul_f32 v29, s23, v29
    v_mul_f32 v30, s23, v30
    v_mul_f32 v31, s23, v31
    v_mul_f32 v32, s23, v32
    v_mul_f32 v33, s23, v33
    v_mul_f32 v34, s23, v34
    v_mul_f32 v35, s23, v35
    v_mul_f32 v36, s23, v36
    v_mul_f32 v37, s23, v37
    v_mul_f32 v38, s23, v38
    v_mul_f32 v39, s23, v39
    v_cvt_pk_bf16_f32 v152, v24, v25
    v_cvt_pk_bf16_f32 v153, v26, v27
    v_cvt_pk_bf16_f32 v168, v28, v29
    v_cvt_pk_bf16_f32 v169, v30, v31
    v_cvt_pk_bf16_f32 v154, v32, v33
    v_cvt_pk_bf16_f32 v155, v34, v35
    v_cvt_pk_bf16_f32 v170, v36, v37
    v_cvt_pk_bf16_f32 v171, v38, v39
    s_waitcnt lgkmcnt(6)
    v_mfma_f32_16x16x32_bf16 v[104:107], v[88:91], v[136:139], 0
    s_waitcnt lgkmcnt(4)
    v_mfma_f32_16x16x32_bf16 v[104:107], v[92:95], v[140:143], v[104:107]
    s_waitcnt lgkmcnt(2)
    v_mfma_f32_16x16x32_bf16 v[104:107], v[96:99], v[144:147], v[104:107]
    s_waitcnt lgkmcnt(0)
    v_mfma_f32_16x16x32_bf16 v[104:107], v[100:103], v[148:151], v[104:107]
    v_add_u32 v4, 0x10000, v2
    v_add_u32 v5, 0x20000, v2
    s_barrier
    ds_read_b128 v[224:227], v4 offset:32768
    ds_read_b128 v[228:231], v4 offset:33792
    ds_read_b128 v[232:235], v4 offset:34816
    ds_read_b128 v[236:239], v4 offset:35840
    v_mov_b32 v12, 0x3f803f80
    v_mov_b32 v13, 0x3f803f80
    v_mov_b32 v14, 0x3f803f80
    v_mov_b32 v15, 0x3f803f80
    s_waitcnt lgkmcnt(3)
    v_mfma_f32_16x16x32_bf16 v[184:187], v[224:227], v[152:155], 0
    v_mul_f32 v40, s23, v40
    v_mul_f32 v41, s23, v41
    v_mul_f32 v42, s23, v42
    v_mul_f32 v43, s23, v43
    v_mul_f32 v44, s23, v44
    v_mul_f32 v45, s23, v45
    v_lshrrev_b32 v20, 4, v1
    v_lshlrev_b32 v20, 4, v20
    s_lshr_b32 s16, s2, 5
    s_lshl_b32 s16, s16, 14
    s_and_b32 s17, s2, 31
    s_lshl_b32 s17, s17, 9
    s_add_u32 s16, s16, s17
    s_lshl_b32 s17, s3, 6
    s_add_u32 s16, s16, s17
    s_add_u32 s16, s16, 0x580000
    s_mov_b32 exec_lo, 0x10001
    s_mov_b32 exec_hi, 0x10001
    buffer_store_dwordx4 v[104:107], v20, s[8:11], s16 offen sc1
    s_mov_b64 exec, -1
    v_mfma_f32_16x16x32_bf16 v[188:191], v[224:227], v[168:171], 0
    ds_read_b128 v[240:243], v4 offset:36864
    v_mul_f32 v46, s23, v46
    v_mul_f32 v47, s23, v47
    v_mul_f32 v48, s23, v48
    v_mul_f32 v49, s23, v49
    v_mul_f32 v50, s23, v50
    v_mul_f32 v51, s23, v51
    s_and_b32 s29, s2, 7
    s_mul_i32 s29, s29, 28
    s_lshr_b32 s16, s2, 3
    s_add_u32 s29, s29, s16
    s_waitcnt lgkmcnt(3)
    v_mfma_f32_16x16x32_bf16 v[192:195], v[228:231], v[152:155], 0
    s_add_u32 s22, s21, 0x10000
    s_add_u32 m0, s20, 0x10000
    s_nop 0
    buffer_load_dwordx4 v2, s[8:11], s22 offen sc1 lds
    v_mul_f32 v52, s23, v52
    v_mul_f32 v53, s23, v53
    v_mul_f32 v54, s23, v54
    v_mul_f32 v55, s23, v55
    v_cvt_pk_bf16_f32 v156, v40, v41
    v_cvt_pk_bf16_f32 v157, v42, v43
    v_mfma_f32_16x16x32_bf16 v[196:199], v[228:231], v[168:171], 0
    ds_read_b128 v[244:247], v4 offset:37888
    v_cvt_pk_bf16_f32 v172, v44, v45
    v_cvt_pk_bf16_f32 v173, v46, v47
    v_cvt_pk_bf16_f32 v158, v48, v49
    v_cvt_pk_bf16_f32 v159, v50, v51
    v_cvt_pk_bf16_f32 v174, v52, v53
    v_cvt_pk_bf16_f32 v175, v54, v55
    s_waitcnt lgkmcnt(3)
    v_mfma_f32_16x16x32_bf16 v[184:187], v[232:235], v[156:159], v[184:187]
    v_mul_f32 v56, s23, v56
    v_mul_f32 v57, s23, v57
    v_mul_f32 v58, s23, v58
    v_mul_f32 v59, s23, v59
    v_mul_f32 v60, s23, v60
    v_mul_f32 v61, s23, v61
    v_mfma_f32_16x16x32_bf16 v[188:191], v[232:235], v[172:175], v[188:191]
    ds_read_b128 v[224:227], v4 offset:38912
    v_mul_f32 v62, s23, v62
    v_mul_f32 v63, s23, v63
    v_mul_f32 v64, s23, v64
    v_mul_f32 v65, s23, v65
    v_mul_f32 v66, s23, v66
    v_mul_f32 v67, s23, v67
    s_waitcnt lgkmcnt(3)
    v_mfma_f32_16x16x32_bf16 v[192:195], v[236:239], v[156:159], v[192:195]
    v_mul_f32 v68, s23, v68
    v_mul_f32 v69, s23, v69
    v_mul_f32 v70, s23, v70
    v_mul_f32 v71, s23, v71
    v_cvt_pk_bf16_f32 v160, v56, v57
    v_cvt_pk_bf16_f32 v161, v58, v59
    v_mfma_f32_16x16x32_bf16 v[196:199], v[236:239], v[172:175], v[196:199]
    ds_read_b128 v[228:231], v4 offset:39936
    v_cvt_pk_bf16_f32 v176, v60, v61
    v_cvt_pk_bf16_f32 v177, v62, v63
    v_cvt_pk_bf16_f32 v162, v64, v65
    v_cvt_pk_bf16_f32 v163, v66, v67
    v_cvt_pk_bf16_f32 v178, v68, v69
    v_cvt_pk_bf16_f32 v179, v70, v71
    s_waitcnt lgkmcnt(3)
    v_mfma_f32_16x16x32_bf16 v[184:187], v[240:243], v[160:163], v[184:187]
    v_mul_f32 v72, s23, v72
    v_mul_f32 v73, s23, v73
    v_mul_f32 v74, s23, v74
    v_mul_f32 v75, s23, v75
    v_mul_f32 v76, s23, v76
    v_mul_f32 v77, s23, v77
    v_mfma_f32_16x16x32_bf16 v[188:191], v[240:243], v[176:179], v[188:191]
    ds_read_b128 v[232:235], v4 offset:40960
    v_mul_f32 v78, s23, v78
    v_mul_f32 v79, s23, v79
    v_mul_f32 v80, s23, v80
    v_mul_f32 v81, s23, v81
    v_mul_f32 v82, s23, v82
    v_mul_f32 v83, s23, v83
    s_waitcnt lgkmcnt(3)
    v_mfma_f32_16x16x32_bf16 v[192:195], v[244:247], v[160:163], v[192:195]
    s_add_u32 s22, s21, 0x10400
    s_add_u32 m0, s20, 0x10400
    s_nop 0
    buffer_load_dwordx4 v2, s[8:11], s22 offen sc1 lds
    v_mul_f32 v84, s23, v84
    v_mul_f32 v85, s23, v85
    v_mul_f32 v86, s23, v86
    v_mul_f32 v87, s23, v87
    v_cvt_pk_bf16_f32 v164, v72, v73
    v_cvt_pk_bf16_f32 v165, v74, v75
    v_mfma_f32_16x16x32_bf16 v[196:199], v[244:247], v[176:179], v[196:199]
    ds_read_b128 v[236:239], v4 offset:41984
    v_cvt_pk_bf16_f32 v180, v76, v77
    v_cvt_pk_bf16_f32 v181, v78, v79
    v_cvt_pk_bf16_f32 v166, v80, v81
    v_cvt_pk_bf16_f32 v167, v82, v83
    v_cvt_pk_bf16_f32 v182, v84, v85
    v_cvt_pk_bf16_f32 v183, v86, v87
    s_waitcnt lgkmcnt(3)
    v_mfma_f32_16x16x32_bf16 v[184:187], v[224:227], v[164:167], v[184:187]
    v_mfma_f32_16x16x32_bf16 v[188:191], v[224:227], v[180:183], v[188:191]
    ds_read_b128 v[240:243], v4 offset:43008
    s_waitcnt lgkmcnt(3)
    v_mfma_f32_16x16x32_bf16 v[192:195], v[228:231], v[164:167], v[192:195]
    v_mfma_f32_16x16x32_bf16 v[196:199], v[228:231], v[180:183], v[196:199]
    ds_read_b128 v[244:247], v4 offset:44032
    s_waitcnt lgkmcnt(3)
    v_mfma_f32_16x16x32_bf16 v[200:203], v[232:235], v[152:155], 0
    v_mfma_f32_16x16x32_bf16 v[204:207], v[232:235], v[168:171], 0
    ds_read_b128 v[224:227], v4 offset:45056
    s_waitcnt lgkmcnt(3)
    v_mfma_f32_16x16x32_bf16 v[208:211], v[236:239], v[152:155], 0
    v_mfma_f32_16x16x32_bf16 v[212:215], v[236:239], v[168:171], 0
    ds_read_b128 v[228:231], v4 offset:46080
    s_waitcnt lgkmcnt(3)
    v_mfma_f32_16x16x32_bf16 v[200:203], v[240:243], v[156:159], v[200:203]
    v_mfma_f32_16x16x32_bf16 v[204:207], v[240:243], v[172:175], v[204:207]
    ds_read_b128 v[232:235], v4 offset:47104
    s_waitcnt lgkmcnt(3)
    v_mfma_f32_16x16x32_bf16 v[208:211], v[244:247], v[156:159], v[208:211]
    v_max3_f32 v16, v184, v185, v186
    v_mfma_f32_16x16x32_bf16 v[212:215], v[244:247], v[172:175], v[212:215]
    ds_read_b128 v[236:239], v4 offset:48128
    v_max3_f32 v16, v16, v187, v192
    s_waitcnt lgkmcnt(3)
    v_mfma_f32_16x16x32_bf16 v[200:203], v[224:227], v[160:163], v[200:203]
    v_max3_f32 v16, v16, v193, v194
    v_mfma_f32_16x16x32_bf16 v[204:207], v[224:227], v[176:179], v[204:207]
    s_barrier
    ds_read_b128 v[240:243], v4 offset:49152
    v_max_f32 v16, v16, v195
    s_waitcnt lgkmcnt(3)
    v_mfma_f32_16x16x32_bf16 v[208:211], v[228:231], v[160:163], v[208:211]
    v_max3_f32 v17, v188, v189, v190
    v_mfma_f32_16x16x32_bf16 v[212:215], v[228:231], v[176:179], v[212:215]
    s_add_u32 s22, s21, 0x14000
    s_add_u32 m0, s20, 0x14000
    s_nop 0
    buffer_load_dwordx4 v2, s[8:11], s22 offen sc1 lds
    ds_read_b128 v[244:247], v4 offset:50176
    v_max3_f32 v17, v17, v191, v196
    s_waitcnt lgkmcnt(3)
    v_mfma_f32_16x16x32_bf16 v[200:203], v[232:235], v[164:167], v[200:203]
    v_max3_f32 v17, v17, v197, v198
    v_mfma_f32_16x16x32_bf16 v[204:207], v[232:235], v[180:183], v[204:207]
    ds_read_b128 v[224:227], v4 offset:51200
    v_max_f32 v17, v17, v199
    s_waitcnt lgkmcnt(3)
    v_mfma_f32_16x16x32_bf16 v[208:211], v[236:239], v[164:167], v[208:211]
    v_mfma_f32_16x16x32_bf16 v[212:215], v[236:239], v[180:183], v[212:215]
    ds_read_b128 v[228:231], v4 offset:52224
    v_max3_f32 v16, v16, v200, v201
    v_max3_f32 v16, v16, v202, v203
    s_nop 3
    v_max3_f32 v16, v16, v208, v209
    v_max3_f32 v16, v16, v210, v211
    v_max3_f32 v17, v17, v204, v205
    v_max3_f32 v17, v17, v206, v207
    v_max3_f32 v17, v17, v212, v213
    v_max3_f32 v17, v17, v214, v215
    v_mov_b32 v18, v16
    v_mov_b32 v19, v17
    s_nop 0
    v_permlane16_swap_b32 v16, v18
    v_permlane16_swap_b32 v17, v19
    v_max_f32 v16, v16, v18
    v_max_f32 v17, v17, v19
    v_mov_b32 v18, v16
    v_mov_b32 v19, v17
    s_nop 0
    v_permlane32_swap_b32 v16, v18
    v_permlane32_swap_b32 v17, v19
    v_max_f32 v16, v16, v18
    v_max_f32 v17, v17, v19
    v_sub_f32 v216, 0, v16
    v_sub_f32 v217, 0, v16
    v_sub_f32 v218, 0, v16
    v_sub_f32 v219, 0, v16
    v_sub_f32 v220, 0, v17
    v_sub_f32 v221, 0, v17
    v_sub_f32 v222, 0, v17
    v_sub_f32 v223, 0, v17
    v_add_f32 v184, v184, v216
    v_add_f32 v185, v185, v216
    v_exp_f32 v184, v184
    v_exp_f32 v185, v185
    s_nop 0
    v_cvt_pk_bf16_f32 v24, v184, v185
    v_add_f32 v186, v186, v216
    v_add_f32 v187, v187, v216
    v_exp_f32 v186, v186
    v_exp_f32 v187, v187
    s_nop 0
    v_cvt_pk_bf16_f32 v25, v186, v187
    v_add_f32 v188, v188, v220
    v_add_f32 v189, v189, v220
    v_exp_f32 v188, v188
    v_exp_f32 v189, v189
    s_nop 0
    v_cvt_pk_bf16_f32 v28, v188, v189
    v_add_f32 v190, v190, v220
    v_add_f32 v191, v191, v220
    v_exp_f32 v190, v190
    v_exp_f32 v191, v191
    s_nop 0
    v_cvt_pk_bf16_f32 v29, v190, v191
    v_add_f32 v192, v192, v216
    v_add_f32 v193, v193, v216
    v_exp_f32 v192, v192
    v_exp_f32 v193, v193
    s_nop 0
    v_cvt_pk_bf16_f32 v26, v192, v193
    v_add_f32 v194, v194, v216
    v_add_f32 v195, v195, v216
    v_exp_f32 v194, v194
    v_exp_f32 v195, v195
    s_nop 0
    v_cvt_pk_bf16_f32 v27, v194, v195
    v_add_f32 v196, v196, v220
    v_add_f32 v197, v197, v220
    v_exp_f32 v196, v196
    v_exp_f32 v197, v197
    s_nop 0
    v_cvt_pk_bf16_f32 v30, v196, v197
    v_add_f32 v198, v198, v220
    v_add_f32 v199, v199, v220
    v_exp_f32 v198, v198
    v_exp_f32 v199, v199
    s_nop 0
    v_cvt_pk_bf16_f32 v31, v198, v199
    s_waitcnt lgkmcnt(3)
    v_mfma_f32_16x16x32_bf16 v[184:187], v[240:243], v[152:155], v[216:219]
    v_mfma_f32_16x16x32_bf16 v[188:191], v[240:243], v[168:171], v[220:223]
    ds_read_b128 v[232:235], v4 offset:53248
    v_add_f32 v200, v200, v216
    v_add_f32 v201, v201, v216
    v_exp_f32 v200, v200
    v_mfma_f32_16x16x32_bf16 v[248:251], v[12:15], v[24:27], 0
    s_waitcnt lgkmcnt(3)
    v_mfma_f32_16x16x32_bf16 v[192:195], v[244:247], v[152:155], v[216:219]
    v_exp_f32 v201, v201
    s_nop 0
    v_cvt_pk_bf16_f32 v32, v200, v201
    v_add_f32 v202, v202, v216
    v_mfma_f32_16x16x32_bf16 v[196:199], v[244:247], v[168:171], v[220:223]
    s_add_u32 s22, s21, 0x14400
    s_add_u32 m0, s20, 0x14400
    s_nop 0
    buffer_load_dwordx4 v2, s[8:11], s22 offen sc1 lds
    ds_read_b128 v[236:239], v4 offset:54272
    v_add_f32 v203, v203, v216
    v_exp_f32 v202, v202
    v_mfma_f32_16x16x32_bf16 v[252:255], v[12:15], v[28:31], 0
    s_waitcnt lgkmcnt(3)
    v_mfma_f32_16x16x32_bf16 v[184:187], v[224:227], v[156:159], v[184:187]
    v_exp_f32 v203, v203
    s_nop 0
    v_cvt_pk_bf16_f32 v33, v202, v203
    v_add_f32 v204, v204, v220
    v_mfma_f32_16x16x32_bf16 v[188:191], v[224:227], v[172:175], v[188:191]
    ds_read_b128 v[240:243], v4 offset:55296
    v_add_f32 v205, v205, v220
    v_exp_f32 v204, v204
    v_exp_f32 v205, v205
    s_mov_b64 s[4:5], s[40:41]
    s_mov_b32 s6, 0x800000
    s_mov_b32 s7, 0x20000
    v_bfe_u32 v20, v1, 2, 2
    v_lshlrev_b32 v21, 13, v20
    v_sub_u32 v3, v3, v21
    v_lshl_add_u32 v3, v20, 11, v3
    s_and_b32 s16, s2, 1
    s_lshl_b32 s24, s16, 22
    s_lshr_b32 s16, s2, 5
    s_lshl_b32 s16, s16, 8
    s_add_u32 s24, s24, s16
    s_lshl_b32 s16, s3, 14
    s_add_u32 s24, s24, s16
    s_waitcnt lgkmcnt(3)
    v_mfma_f32_16x16x32_bf16 v[192:195], v[228:231], v[156:159], v[192:195]
    v_cvt_pk_bf16_f32 v36, v204, v205
    v_add_f32 v206, v206, v220
    v_mfma_f32_16x16x32_bf16 v[196:199], v[228:231], v[172:175], v[196:199]
    ds_read_b128 v[244:247], v4 offset:56320
    v_add_f32 v207, v207, v220
    v_exp_f32 v206, v206
    v_exp_f32 v207, v207
    s_waitcnt lgkmcnt(3)
    v_mfma_f32_16x16x32_bf16 v[184:187], v[232:235], v[160:163], v[184:187]
    v_cvt_pk_bf16_f32 v37, v206, v207
    v_add_f32 v208, v208, v216
    v_add_f32 v209, v209, v216
    v_mfma_f32_16x16x32_bf16 v[188:191], v[232:235], v[176:179], v[188:191]
    ds_read_b128 v[224:227], v4 offset:57344
    v_exp_f32 v208, v208
    v_exp_f32 v209, v209
    s_waitcnt lgkmcnt(3)
    v_mfma_f32_16x16x32_bf16 v[192:195], v[236:239], v[160:163], v[192:195]
    v_cvt_pk_bf16_f32 v34, v208, v209
    v_add_f32 v210, v210, v216
    v_add_f32 v211, v211, v216
    v_mfma_f32_16x16x32_bf16 v[196:199], v[236:239], v[176:179], v[196:199]
    ds_read_b128 v[228:231], v4 offset:58368
    v_exp_f32 v210, v210
    v_exp_f32 v211, v211
    s_nop 0
    v_cvt_pk_bf16_f32 v35, v210, v211
    s_waitcnt lgkmcnt(3)
    v_mfma_f32_16x16x32_bf16 v[184:187], v[240:243], v[164:167], v[184:187]
    v_add_f32 v212, v212, v220
    v_add_f32 v213, v213, v220
    v_mfma_f32_16x16x32_bf16 v[188:191], v[240:243], v[180:183], v[188:191]
    ds_read_b128 v[232:235], v4 offset:59392
    v_exp_f32 v212, v212
    v_exp_f32 v213, v213
    s_nop 0
    v_cvt_pk_bf16_f32 v38, v212, v213
    s_waitcnt lgkmcnt(3)
    v_mfma_f32_16x16x32_bf16 v[192:195], v[244:247], v[164:167], v[192:195]
    v_add_f32 v214, v214, v220
    v_add_f32 v215, v215, v220
    v_exp_f32 v214, v214
    v_mfma_f32_16x16x32_bf16 v[196:199], v[244:247], v[180:183], v[196:199]
    ds_read_b128 v[236:239], v4 offset:60416
    v_exp_f32 v215, v215
    s_nop 0
    v_cvt_pk_bf16_f32 v39, v214, v215
    s_waitcnt lgkmcnt(3)
    v_mfma_f32_16x16x32_bf16 v[200:203], v[224:227], v[152:155], v[216:219]
    v_mfma_f32_16x16x32_bf16 v[204:207], v[224:227], v[168:171], v[220:223]
    ds_read_b128 v[240:243], v4 offset:61440
    v_exp_f32 v184, v184
    v_exp_f32 v185, v185
    v_mfma_f32_16x16x32_bf16 v[248:251], v[12:15], v[32:35], v[248:251]
    s_waitcnt lgkmcnt(3)
    v_mfma_f32_16x16x32_bf16 v[208:211], v[228:231], v[152:155], v[216:219]
    v_cvt_pk_bf16_f32 v40, v184, v185
    v_exp_f32 v186, v186
    v_mfma_f32_16x16x32_bf16 v[212:215], v[228:231], v[168:171], v[220:223]
    ds_read_b128 v[244:247], v4 offset:62464
    v_exp_f32 v187, v187
    v_mfma_f32_16x16x32_bf16 v[252:255], v[12:15], v[36:39], v[252:255]
    s_waitcnt lgkmcnt(3)
    v_mfma_f32_16x16x32_bf16 v[200:203], v[232:235], v[156:159], v[200:203]
    v_cvt_pk_bf16_f32 v41, v186, v187
    v_exp_f32 v188, v188
    v_mfma_f32_16x16x32_bf16 v[204:207], v[232:235], v[172:175], v[204:207]
    ds_read_b128 v[224:227], v4 offset:63488
    v_exp_f32 v189, v189
    s_waitcnt lgkmcnt(3)
    v_mfma_f32_16x16x32_bf16 v[208:211], v[236:239], v[156:159], v[208:211]
    v_cvt_pk_bf16_f32 v44, v188, v189
    v_exp_f32 v190, v190
    v_mfma_f32_16x16x32_bf16 v[212:215], v[236:239], v[172:175], v[212:215]
    ds_read_b128 v[228:231], v4 offset:64512
    v_exp_f32 v191, v191
    s_nop 0
    v_cvt_pk_bf16_f32 v45, v190, v191
    s_waitcnt lgkmcnt(3)
    v_mfma_f32_16x16x32_bf16 v[200:203], v[240:243], v[160:163], v[200:203]
    v_exp_f32 v192, v192
    v_mfma_f32_16x16x32_bf16 v[204:207], v[240:243], v[176:179], v[204:207]
    s_waitcnt vmcnt(7)
    s_barrier
    ds_read_b128 v[232:235], v5 offset:0
    v_exp_f32 v193, v193
    s_nop 0
    v_cvt_pk_bf16_f32 v42, v192, v193
    s_waitcnt lgkmcnt(3)
    v_mfma_f32_16x16x32_bf16 v[208:211], v[244:247], v[160:163], v[208:211]
    v_exp_f32 v194, v194
    v_mfma_f32_16x16x32_bf16 v[212:215], v[244:247], v[176:179], v[212:215]
    s_add_u32 s22, s21, 0x18000
    s_add_u32 m0, s20, 0x18000
    s_nop 0
    buffer_load_dwordx4 v2, s[8:11], s22 offen sc1 lds
    ds_read_b128 v[236:239], v5 offset:1024
    v_exp_f32 v195, v195
    s_nop 0
    v_cvt_pk_bf16_f32 v43, v194, v195
    s_waitcnt lgkmcnt(3)
    v_mfma_f32_16x16x32_bf16 v[200:203], v[224:227], v[164:167], v[200:203]
    v_exp_f32 v196, v196
    v_exp_f32 v197, v197
    v_mfma_f32_16x16x32_bf16 v[204:207], v[224:227], v[180:183], v[204:207]
    ds_read_b128 v[240:243], v5 offset:2048
    v_cvt_pk_bf16_f32 v46, v196, v197
    s_waitcnt lgkmcnt(3)
    v_mfma_f32_16x16x32_bf16 v[208:211], v[228:231], v[164:167], v[208:211]
    v_exp_f32 v198, v198
    v_exp_f32 v199, v199
    v_mfma_f32_16x16x32_bf16 v[212:215], v[228:231], v[180:183], v[212:215]
    ds_read_b128 v[244:247], v5 offset:3072
    v_cvt_pk_bf16_f32 v47, v198, v199
    s_waitcnt lgkmcnt(3)
    v_mfma_f32_16x16x32_bf16 v[184:187], v[232:235], v[152:155], v[216:219]
    v_mfma_f32_16x16x32_bf16 v[188:191], v[232:235], v[168:171], v[220:223]
    ds_read_b128 v[224:227], v5 offset:4096
    v_exp_f32 v200, v200
    v_exp_f32 v201, v201
    v_mfma_f32_16x16x32_bf16 v[248:251], v[12:15], v[40:43], v[248:251]
    s_waitcnt lgkmcnt(3)
    v_mfma_f32_16x16x32_bf16 v[192:195], v[236:239], v[152:155], v[216:219]
    v_cvt_pk_bf16_f32 v48, v200, v201
    v_exp_f32 v202, v202
    v_mfma_f32_16x16x32_bf16 v[196:199], v[236:239], v[168:171], v[220:223]
    s_add_u32 s22, s21, 0x18400
    s_add_u32 m0, s20, 0x18400
    s_nop 0
    buffer_load_dwordx4 v2, s[8:11], s22 offen sc1 lds
    ds_read_b128 v[228:231], v5 offset:5120
    v_exp_f32 v203, v203
    v_mfma_f32_16x16x32_bf16 v[252:255], v[12:15], v[44:47], v[252:255]
    s_waitcnt lgkmcnt(3)
    v_mfma_f32_16x16x32_bf16 v[184:187], v[240:243], v[156:159], v[184:187]
    v_cvt_pk_bf16_f32 v49, v202, v203
    v_exp_f32 v204, v204
    v_mfma_f32_16x16x32_bf16 v[188:191], v[240:243], v[172:175], v[188:191]
    ds_read_b128 v[232:235], v5 offset:6144
    v_exp_f32 v205, v205
    s_waitcnt lgkmcnt(3)
    v_mfma_f32_16x16x32_bf16 v[192:195], v[244:247], v[156:159], v[192:195]
    v_cvt_pk_bf16_f32 v52, v204, v205
    v_exp_f32 v206, v206
    v_mfma_f32_16x16x32_bf16 v[196:199], v[244:247], v[172:175], v[196:199]
    ds_read_b128 v[236:239], v5 offset:7168
    v_exp_f32 v207, v207
    s_nop 0
    v_cvt_pk_bf16_f32 v53, v206, v207
    s_waitcnt lgkmcnt(3)
    v_mfma_f32_16x16x32_bf16 v[184:187], v[224:227], v[160:163], v[184:187]
    v_exp_f32 v208, v208
    v_mfma_f32_16x16x32_bf16 v[188:191], v[224:227], v[176:179], v[188:191]
    ds_read_b128 v[240:243], v5 offset:8192
    v_exp_f32 v209, v209
    s_nop 0
    v_cvt_pk_bf16_f32 v50, v208, v209
    s_waitcnt lgkmcnt(3)
    v_mfma_f32_16x16x32_bf16 v[192:195], v[228:231], v[160:163], v[192:195]
    v_exp_f32 v210, v210
    v_mfma_f32_16x16x32_bf16 v[196:199], v[228:231], v[176:179], v[196:199]
    ds_read_b128 v[244:247], v5 offset:9216
    v_exp_f32 v211, v211
    s_nop 0
    v_cvt_pk_bf16_f32 v51, v210, v211
    s_waitcnt lgkmcnt(3)
    v_mfma_f32_16x16x32_bf16 v[184:187], v[232:235], v[164:167], v[184:187]
    v_exp_f32 v212, v212
    v_exp_f32 v213, v213
    v_mfma_f32_16x16x32_bf16 v[188:191], v[232:235], v[180:183], v[188:191]
    ds_read_b128 v[224:227], v5 offset:10240
    v_cvt_pk_bf16_f32 v54, v212, v213
    s_waitcnt lgkmcnt(3)
    v_mfma_f32_16x16x32_bf16 v[192:195], v[236:239], v[164:167], v[192:195]
    v_exp_f32 v214, v214
    v_exp_f32 v215, v215
    v_mfma_f32_16x16x32_bf16 v[196:199], v[236:239], v[180:183], v[196:199]
    ds_read_b128 v[228:231], v5 offset:11264
    v_cvt_pk_bf16_f32 v55, v214, v215
    s_waitcnt lgkmcnt(3)
    v_mfma_f32_16x16x32_bf16 v[200:203], v[240:243], v[152:155], v[216:219]
    v_mfma_f32_16x16x32_bf16 v[204:207], v[240:243], v[168:171], v[220:223]
    ds_read_b128 v[232:235], v5 offset:12288
    v_exp_f32 v184, v184
    v_exp_f32 v185, v185
    v_mfma_f32_16x16x32_bf16 v[248:251], v[12:15], v[48:51], v[248:251]
    s_waitcnt lgkmcnt(3)
    v_mfma_f32_16x16x32_bf16 v[208:211], v[244:247], v[152:155], v[216:219]
    v_cvt_pk_bf16_f32 v56, v184, v185
    v_exp_f32 v186, v186
    v_mfma_f32_16x16x32_bf16 v[212:215], v[244:247], v[168:171], v[220:223]
    ds_read_b128 v[236:239], v5 offset:13312
    v_exp_f32 v187, v187
    v_mfma_f32_16x16x32_bf16 v[252:255], v[12:15], v[52:55], v[252:255]
    s_waitcnt lgkmcnt(3)
    v_mfma_f32_16x16x32_bf16 v[200:203], v[224:227], v[156:159], v[200:203]
    v_cvt_pk_bf16_f32 v57, v186, v187
    v_exp_f32 v188, v188
    v_mfma_f32_16x16x32_bf16 v[204:207], v[224:227], v[172:175], v[204:207]
    ds_read_b128 v[240:243], v5 offset:14336
    v_exp_f32 v189, v189
    s_waitcnt lgkmcnt(3)
    v_mfma_f32_16x16x32_bf16 v[208:211], v[228:231], v[156:159], v[208:211]
    v_cvt_pk_bf16_f32 v60, v188, v189
    v_exp_f32 v190, v190
    s_waitcnt vmcnt(6)
    v_mfma_f32_16x16x32_bf16 v[212:215], v[228:231], v[172:175], v[212:215]
    ds_read_b128 v[244:247], v5 offset:15360
    v_exp_f32 v191, v191
    s_nop 0
    v_cvt_pk_bf16_f32 v61, v190, v191
    s_waitcnt lgkmcnt(3)
    v_mfma_f32_16x16x32_bf16 v[200:203], v[232:235], v[160:163], v[200:203]
    v_exp_f32 v192, v192
    v_mfma_f32_16x16x32_bf16 v[204:207], v[232:235], v[176:179], v[204:207]
    s_barrier
    ds_read_b128 v[224:227], v5 offset:16384
    v_exp_f32 v193, v193
    s_nop 0
    v_cvt_pk_bf16_f32 v58, v192, v193
    s_waitcnt lgkmcnt(3)
    v_mfma_f32_16x16x32_bf16 v[208:211], v[236:239], v[160:163], v[208:211]
    v_exp_f32 v194, v194
    v_mfma_f32_16x16x32_bf16 v[212:215], v[236:239], v[176:179], v[212:215]
    s_add_u32 s22, s21, 0x1c000
    s_add_u32 m0, s20, 0x1c000
    s_nop 0
    buffer_load_dwordx4 v2, s[8:11], s22 offen sc1 lds
    ds_read_b128 v[228:231], v5 offset:17408
    v_exp_f32 v195, v195
    s_nop 0
    v_cvt_pk_bf16_f32 v59, v194, v195
    s_waitcnt lgkmcnt(3)
    v_mfma_f32_16x16x32_bf16 v[200:203], v[240:243], v[164:167], v[200:203]
    v_exp_f32 v196, v196
    v_exp_f32 v197, v197
    v_mfma_f32_16x16x32_bf16 v[204:207], v[240:243], v[180:183], v[204:207]
    ds_read_b128 v[232:235], v5 offset:18432
    v_cvt_pk_bf16_f32 v62, v196, v197
    s_waitcnt lgkmcnt(3)
    v_mfma_f32_16x16x32_bf16 v[208:211], v[244:247], v[164:167], v[208:211]
    v_exp_f32 v198, v198
    v_exp_f32 v199, v199
    v_mov_b32 v20, s28
    v_mov_b32 v21, 0
    s_lshl_b32 s16, s2, 2
    s_add_u32 s16, s16, 0x560000
    s_cmp_eq_u32 s3, 0
    s_cselect_b32 s16, s16, 0x7ffffff0
    s_mov_b64 exec, 1
    buffer_store_dword v20, v21, s[8:11], s16 offen sc1
    s_mov_b64 exec, -1
    v_mfma_f32_16x16x32_bf16 v[212:215], v[244:247], v[180:183], v[212:215]
    ds_read_b128 v[236:239], v5 offset:19456
    v_cvt_pk_bf16_f32 v63, v198, v199
    s_waitcnt lgkmcnt(3)
    v_mfma_f32_16x16x32_bf16 v[184:187], v[224:227], v[152:155], v[216:219]
    v_mfma_f32_16x16x32_bf16 v[188:191], v[224:227], v[168:171], v[220:223]
    ds_read_b128 v[240:243], v5 offset:20480
    v_exp_f32 v200, v200
    v_exp_f32 v201, v201
    v_mfma_f32_16x16x32_bf16 v[248:251], v[12:15], v[56:59], v[248:251]
    s_waitcnt lgkmcnt(3)
    v_mfma_f32_16x16x32_bf16 v[192:195], v[228:231], v[152:155], v[216:219]
    v_cvt_pk_bf16_f32 v64, v200, v201
    v_exp_f32 v202, v202
    v_mfma_f32_16x16x32_bf16 v[196:199], v[228:231], v[168:171], v[220:223]
    s_add_u32 s22, s21, 0x1c400
    s_add_u32 m0, s20, 0x1c400
    s_nop 0
    buffer_load_dwordx4 v2, s[8:11], s22 offen sc1 lds
    ds_read_b128 v[244:247], v5 offset:21504
    v_exp_f32 v203, v203
    v_mfma_f32_16x16x32_bf16 v[252:255], v[12:15], v[60:63], v[252:255]
    s_waitcnt lgkmcnt(3)
    v_mfma_f32_16x16x32_bf16 v[184:187], v[232:235], v[156:159], v[184:187]
    v_cvt_pk_bf16_f32 v65, v202, v203
    v_exp_f32 v204, v204
    v_mfma_f32_16x16x32_bf16 v[188:191], v[232:235], v[172:175], v[188:191]
    ds_read_b128 v[224:227], v5 offset:22528
    v_exp_f32 v205, v205
    s_waitcnt lgkmcnt(3)
    v_mfma_f32_16x16x32_bf16 v[192:195], v[236:239], v[156:159], v[192:195]
    v_cvt_pk_bf16_f32 v68, v204, v205
    v_exp_f32 v206, v206
    v_mfma_f32_16x16x32_bf16 v[196:199], v[236:239], v[172:175], v[196:199]
    ds_read_b128 v[228:231], v5 offset:23552
    v_exp_f32 v207, v207
    s_nop 0
    v_cvt_pk_bf16_f32 v69, v206, v207
    s_waitcnt lgkmcnt(3)
    v_mfma_f32_16x16x32_bf16 v[184:187], v[240:243], v[160:163], v[184:187]
    v_exp_f32 v208, v208
    v_mfma_f32_16x16x32_bf16 v[188:191], v[240:243], v[176:179], v[188:191]
    ds_read_b128 v[232:235], v5 offset:24576
    v_exp_f32 v209, v209
    s_nop 0
    v_cvt_pk_bf16_f32 v66, v208, v209
    s_waitcnt lgkmcnt(3)
    v_mfma_f32_16x16x32_bf16 v[192:195], v[244:247], v[160:163], v[192:195]
    v_exp_f32 v210, v210
    v_mfma_f32_16x16x32_bf16 v[196:199], v[244:247], v[176:179], v[196:199]
    ds_read_b128 v[236:239], v5 offset:25600
    v_exp_f32 v211, v211
    s_nop 0
    v_cvt_pk_bf16_f32 v67, v210, v211
    s_waitcnt lgkmcnt(3)
    v_mfma_f32_16x16x32_bf16 v[184:187], v[224:227], v[164:167], v[184:187]
    v_exp_f32 v212, v212
    v_exp_f32 v213, v213
    v_mfma_f32_16x16x32_bf16 v[188:191], v[224:227], v[180:183], v[188:191]
    ds_read_b128 v[240:243], v5 offset:26624
    v_cvt_pk_bf16_f32 v70, v212, v213
    s_waitcnt lgkmcnt(3)
    v_mfma_f32_16x16x32_bf16 v[192:195], v[228:231], v[164:167], v[192:195]
    v_exp_f32 v214, v214
    v_exp_f32 v215, v215
    v_mfma_f32_16x16x32_bf16 v[196:199], v[228:231], v[180:183], v[196:199]
    ds_read_b128 v[244:247], v5 offset:27648
    v_cvt_pk_bf16_f32 v71, v214, v215
    s_waitcnt lgkmcnt(3)
    v_mfma_f32_16x16x32_bf16 v[200:203], v[232:235], v[152:155], v[216:219]
    v_mfma_f32_16x16x32_bf16 v[204:207], v[232:235], v[168:171], v[220:223]
    ds_read_b128 v[224:227], v5 offset:28672
    v_exp_f32 v184, v184
    v_exp_f32 v185, v185
    v_mfma_f32_16x16x32_bf16 v[248:251], v[12:15], v[64:67], v[248:251]
    s_waitcnt lgkmcnt(3)
    v_mfma_f32_16x16x32_bf16 v[208:211], v[236:239], v[152:155], v[216:219]
    v_cvt_pk_bf16_f32 v72, v184, v185
    v_exp_f32 v186, v186
    v_mfma_f32_16x16x32_bf16 v[212:215], v[236:239], v[168:171], v[220:223]
    ds_read_b128 v[228:231], v5 offset:29696
    v_exp_f32 v187, v187
    v_mfma_f32_16x16x32_bf16 v[252:255], v[12:15], v[68:71], v[252:255]
    s_waitcnt lgkmcnt(3)
    v_mfma_f32_16x16x32_bf16 v[200:203], v[240:243], v[156:159], v[200:203]
    v_cvt_pk_bf16_f32 v73, v186, v187
    v_exp_f32 v188, v188
    v_mfma_f32_16x16x32_bf16 v[204:207], v[240:243], v[172:175], v[204:207]
    ds_read_b128 v[232:235], v5 offset:30720
    v_exp_f32 v189, v189
    s_waitcnt lgkmcnt(3)
    v_mfma_f32_16x16x32_bf16 v[208:211], v[244:247], v[156:159], v[208:211]
    v_cvt_pk_bf16_f32 v76, v188, v189
    v_exp_f32 v190, v190
    v_mfma_f32_16x16x32_bf16 v[212:215], v[244:247], v[172:175], v[212:215]
    ds_read_b128 v[236:239], v5 offset:31744
    v_exp_f32 v191, v191
    s_nop 0
    v_cvt_pk_bf16_f32 v77, v190, v191
    s_waitcnt lgkmcnt(3)
    v_mfma_f32_16x16x32_bf16 v[200:203], v[224:227], v[160:163], v[200:203]
    v_exp_f32 v192, v192
    v_mfma_f32_16x16x32_bf16 v[204:207], v[224:227], v[176:179], v[204:207]
    s_waitcnt vmcnt(7)
    s_barrier
    ds_read_b128 v[240:243], v4 offset:0
    v_exp_f32 v193, v193
    s_nop 0
    v_cvt_pk_bf16_f32 v74, v192, v193
    s_waitcnt lgkmcnt(3)
    v_mfma_f32_16x16x32_bf16 v[208:211], v[228:231], v[160:163], v[208:211]
    v_exp_f32 v194, v194
    v_mfma_f32_16x16x32_bf16 v[212:215], v[228:231], v[176:179], v[212:215]
    s_add_u32 s22, s21, 0x80000
    s_add_u32 m0, s20, 0x20000
    s_nop 0
    buffer_load_dwordx4 v2, s[8:11], s22 offen sc1 lds
    ds_read_b128 v[244:247], v4 offset:1024
    v_exp_f32 v195, v195
    s_nop 0
    v_cvt_pk_bf16_f32 v75, v194, v195
    s_waitcnt lgkmcnt(3)
    v_mfma_f32_16x16x32_bf16 v[200:203], v[232:235], v[164:167], v[200:203]
    v_exp_f32 v196, v196
    v_exp_f32 v197, v197
    v_mfma_f32_16x16x32_bf16 v[204:207], v[232:235], v[180:183], v[204:207]
    ds_read_b128 v[224:227], v4 offset:2048
    v_cvt_pk_bf16_f32 v78, v196, v197
    s_waitcnt lgkmcnt(3)
    v_mfma_f32_16x16x32_bf16 v[208:211], v[236:239], v[164:167], v[208:211]
    v_exp_f32 v198, v198
    v_exp_f32 v199, v199
    v_mfma_f32_16x16x32_bf16 v[212:215], v[236:239], v[180:183], v[212:215]
    ds_read_b128 v[228:231], v4 offset:3072
    v_cvt_pk_bf16_f32 v79, v198, v199
    s_waitcnt lgkmcnt(3)
    v_mfma_f32_16x16x32_bf16 v[184:187], v[240:243], v[152:155], v[216:219]
    v_mfma_f32_16x16x32_bf16 v[188:191], v[240:243], v[168:171], v[220:223]
    ds_read_b128 v[232:235], v4 offset:4096
    v_exp_f32 v200, v200
    v_exp_f32 v201, v201
    v_mfma_f32_16x16x32_bf16 v[248:251], v[12:15], v[72:75], v[248:251]
    s_waitcnt lgkmcnt(3)
    v_mfma_f32_16x16x32_bf16 v[192:195], v[244:247], v[152:155], v[216:219]
    v_cvt_pk_bf16_f32 v80, v200, v201
    v_exp_f32 v202, v202
    v_mfma_f32_16x16x32_bf16 v[196:199], v[244:247], v[168:171], v[220:223]
    s_add_u32 s22, s21, 0x80400
    s_add_u32 m0, s20, 0x20400
    s_nop 0
    buffer_load_dwordx4 v2, s[8:11], s22 offen sc1 lds
    ds_read_b128 v[236:239], v4 offset:5120
    v_exp_f32 v203, v203
    v_mfma_f32_16x16x32_bf16 v[252:255], v[12:15], v[76:79], v[252:255]
    s_waitcnt lgkmcnt(3)
    v_mfma_f32_16x16x32_bf16 v[184:187], v[224:227], v[156:159], v[184:187]
    v_cvt_pk_bf16_f32 v81, v202, v203
    v_exp_f32 v204, v204
    v_mfma_f32_16x16x32_bf16 v[188:191], v[224:227], v[172:175], v[188:191]
    ds_read_b128 v[240:243], v4 offset:6144
    v_exp_f32 v205, v205
    s_waitcnt lgkmcnt(3)
    v_mfma_f32_16x16x32_bf16 v[192:195], v[228:231], v[156:159], v[192:195]
    v_cvt_pk_bf16_f32 v84, v204, v205
    v_exp_f32 v206, v206
    v_mfma_f32_16x16x32_bf16 v[196:199], v[228:231], v[172:175], v[196:199]
    ds_read_b128 v[244:247], v4 offset:7168
    v_exp_f32 v207, v207
    s_nop 0
    v_cvt_pk_bf16_f32 v85, v206, v207
    s_waitcnt lgkmcnt(3)
    v_mfma_f32_16x16x32_bf16 v[184:187], v[232:235], v[160:163], v[184:187]
    v_exp_f32 v208, v208
    v_mfma_f32_16x16x32_bf16 v[188:191], v[232:235], v[176:179], v[188:191]
    ds_read_b128 v[224:227], v4 offset:8192
    v_exp_f32 v209, v209
    s_nop 0
    v_cvt_pk_bf16_f32 v82, v208, v209
    s_waitcnt lgkmcnt(3)
    v_mfma_f32_16x16x32_bf16 v[192:195], v[236:239], v[160:163], v[192:195]
    v_exp_f32 v210, v210
    v_mfma_f32_16x16x32_bf16 v[196:199], v[236:239], v[176:179], v[196:199]
    ds_read_b128 v[228:231], v4 offset:9216
    v_exp_f32 v211, v211
    s_nop 0
    v_cvt_pk_bf16_f32 v83, v210, v211
    s_waitcnt lgkmcnt(3)
    v_mfma_f32_16x16x32_bf16 v[184:187], v[240:243], v[164:167], v[184:187]
    v_exp_f32 v212, v212
    v_exp_f32 v213, v213
    v_mfma_f32_16x16x32_bf16 v[188:191], v[240:243], v[180:183], v[188:191]
    ds_read_b128 v[232:235], v4 offset:10240
    v_cvt_pk_bf16_f32 v86, v212, v213
    s_waitcnt lgkmcnt(3)
    v_mfma_f32_16x16x32_bf16 v[192:195], v[244:247], v[164:167], v[192:195]
    v_exp_f32 v214, v214
    v_exp_f32 v215, v215
    v_mfma_f32_16x16x32_bf16 v[196:199], v[244:247], v[180:183], v[196:199]
    ds_read_b128 v[236:239], v4 offset:11264
    v_cvt_pk_bf16_f32 v87, v214, v215
    s_waitcnt lgkmcnt(3)
    v_mfma_f32_16x16x32_bf16 v[200:203], v[224:227], v[152:155], v[216:219]
    v_mfma_f32_16x16x32_bf16 v[204:207], v[224:227], v[168:171], v[220:223]
    ds_read_b128 v[240:243], v4 offset:12288
    v_exp_f32 v184, v184
    v_exp_f32 v185, v185
    v_mfma_f32_16x16x32_bf16 v[248:251], v[12:15], v[80:83], v[248:251]
    s_waitcnt lgkmcnt(3)
    v_mfma_f32_16x16x32_bf16 v[208:211], v[228:231], v[152:155], v[216:219]
    v_cvt_pk_bf16_f32 v88, v184, v185
    v_exp_f32 v186, v186
    v_mfma_f32_16x16x32_bf16 v[212:215], v[228:231], v[168:171], v[220:223]
    ds_read_b128 v[244:247], v4 offset:13312
    v_exp_f32 v187, v187
    v_mfma_f32_16x16x32_bf16 v[252:255], v[12:15], v[84:87], v[252:255]
    s_waitcnt lgkmcnt(3)
    v_mfma_f32_16x16x32_bf16 v[200:203], v[232:235], v[156:159], v[200:203]
    v_cvt_pk_bf16_f32 v89, v186, v187
    v_exp_f32 v188, v188
    v_mfma_f32_16x16x32_bf16 v[204:207], v[232:235], v[172:175], v[204:207]
    ds_read_b128 v[224:227], v4 offset:14336
    v_exp_f32 v189, v189
    s_waitcnt lgkmcnt(3)
    v_mfma_f32_16x16x32_bf16 v[208:211], v[236:239], v[156:159], v[208:211]
    v_cvt_pk_bf16_f32 v92, v188, v189
    v_exp_f32 v190, v190
    v_mfma_f32_16x16x32_bf16 v[212:215], v[236:239], v[172:175], v[212:215]
    ds_read_b128 v[228:231], v4 offset:15360
    v_exp_f32 v191, v191
    s_nop 0
    v_cvt_pk_bf16_f32 v93, v190, v191
    s_waitcnt lgkmcnt(3)
    v_mfma_f32_16x16x32_bf16 v[200:203], v[240:243], v[160:163], v[200:203]
    v_exp_f32 v192, v192
    v_mfma_f32_16x16x32_bf16 v[204:207], v[240:243], v[176:179], v[204:207]
    s_waitcnt vmcnt(7)
    s_barrier
    ds_read_b128 v[232:235], v4 offset:16384
    v_exp_f32 v193, v193
    s_nop 0
    v_cvt_pk_bf16_f32 v90, v192, v193
    s_waitcnt lgkmcnt(3)
    v_mfma_f32_16x16x32_bf16 v[208:211], v[244:247], v[160:163], v[208:211]
    v_exp_f32 v194, v194
    v_mfma_f32_16x16x32_bf16 v[212:215], v[244:247], v[176:179], v[212:215]
    s_add_u32 s22, s21, 0x84000
    s_add_u32 m0, s20, 0x24000
    s_nop 0
    buffer_load_dwordx4 v2, s[8:11], s22 offen sc1 lds
    ds_read_b128 v[236:239], v4 offset:17408
    v_exp_f32 v195, v195
    s_nop 0
    v_cvt_pk_bf16_f32 v91, v194, v195
    s_waitcnt lgkmcnt(3)
    v_mfma_f32_16x16x32_bf16 v[200:203], v[224:227], v[164:167], v[200:203]
    v_exp_f32 v196, v196
    v_exp_f32 v197, v197
    v_mfma_f32_16x16x32_bf16 v[204:207], v[224:227], v[180:183], v[204:207]
    ds_read_b128 v[240:243], v4 offset:18432
    v_cvt_pk_bf16_f32 v94, v196, v197
    s_waitcnt lgkmcnt(3)
    v_mfma_f32_16x16x32_bf16 v[208:211], v[228:231], v[164:167], v[208:211]
    v_exp_f32 v198, v198
    v_exp_f32 v199, v199
    v_mfma_f32_16x16x32_bf16 v[212:215], v[228:231], v[180:183], v[212:215]
    ds_read_b128 v[244:247], v4 offset:19456
    v_cvt_pk_bf16_f32 v95, v198, v199
    s_waitcnt lgkmcnt(3)
    v_mfma_f32_16x16x32_bf16 v[184:187], v[232:235], v[152:155], v[216:219]
    v_mfma_f32_16x16x32_bf16 v[188:191], v[232:235], v[168:171], v[220:223]
    ds_read_b128 v[224:227], v4 offset:20480
    v_exp_f32 v200, v200
    v_exp_f32 v201, v201
    v_mfma_f32_16x16x32_bf16 v[248:251], v[12:15], v[88:91], v[248:251]
    s_waitcnt lgkmcnt(3)
    v_mfma_f32_16x16x32_bf16 v[192:195], v[236:239], v[152:155], v[216:219]
    v_cvt_pk_bf16_f32 v96, v200, v201
    v_exp_f32 v202, v202
    v_mfma_f32_16x16x32_bf16 v[196:199], v[236:239], v[168:171], v[220:223]
    s_add_u32 s22, s21, 0x84400
    s_add_u32 m0, s20, 0x24400
    s_nop 0
    buffer_load_dwordx4 v2, s[8:11], s22 offen sc1 lds
    ds_read_b128 v[228:231], v4 offset:21504
    v_exp_f32 v203, v203
    v_mfma_f32_16x16x32_bf16 v[252:255], v[12:15], v[92:95], v[252:255]
    s_waitcnt lgkmcnt(3)
    v_mfma_f32_16x16x32_bf16 v[184:187], v[240:243], v[156:159], v[184:187]
    v_cvt_pk_bf16_f32 v97, v202, v203
    v_exp_f32 v204, v204
    v_mfma_f32_16x16x32_bf16 v[188:191], v[240:243], v[172:175], v[188:191]
    ds_read_b128 v[232:235], v4 offset:22528
    v_exp_f32 v205, v205
    s_waitcnt lgkmcnt(3)
    v_mfma_f32_16x16x32_bf16 v[192:195], v[244:247], v[156:159], v[192:195]
    v_cvt_pk_bf16_f32 v100, v204, v205
    v_exp_f32 v206, v206
    v_mfma_f32_16x16x32_bf16 v[196:199], v[244:247], v[172:175], v[196:199]
    ds_read_b128 v[236:239], v4 offset:23552
    v_exp_f32 v207, v207
    s_nop 0
    v_cvt_pk_bf16_f32 v101, v206, v207
    s_waitcnt lgkmcnt(3)
    v_mfma_f32_16x16x32_bf16 v[184:187], v[224:227], v[160:163], v[184:187]
    v_exp_f32 v208, v208
    v_mfma_f32_16x16x32_bf16 v[188:191], v[224:227], v[176:179], v[188:191]
    ds_read_b128 v[240:243], v4 offset:24576
    v_exp_f32 v209, v209
    s_nop 0
    v_cvt_pk_bf16_f32 v98, v208, v209
    s_waitcnt lgkmcnt(3)
    v_mfma_f32_16x16x32_bf16 v[192:195], v[228:231], v[160:163], v[192:195]
    v_exp_f32 v210, v210
    v_mfma_f32_16x16x32_bf16 v[196:199], v[228:231], v[176:179], v[196:199]
    ds_read_b128 v[244:247], v4 offset:25600
    v_exp_f32 v211, v211
    s_nop 0
    v_cvt_pk_bf16_f32 v99, v210, v211
    s_waitcnt lgkmcnt(3)
    v_mfma_f32_16x16x32_bf16 v[184:187], v[232:235], v[164:167], v[184:187]
    v_exp_f32 v212, v212
    v_exp_f32 v213, v213
    v_mfma_f32_16x16x32_bf16 v[188:191], v[232:235], v[180:183], v[188:191]
    ds_read_b128 v[224:227], v4 offset:26624
    v_cvt_pk_bf16_f32 v102, v212, v213
    s_waitcnt lgkmcnt(3)
    v_mfma_f32_16x16x32_bf16 v[192:195], v[236:239], v[164:167], v[192:195]
    v_exp_f32 v214, v214
    v_exp_f32 v215, v215
    v_mfma_f32_16x16x32_bf16 v[196:199], v[236:239], v[180:183], v[196:199]
    ds_read_b128 v[228:231], v4 offset:27648
    v_cvt_pk_bf16_f32 v103, v214, v215
    s_waitcnt lgkmcnt(3)
    v_mfma_f32_16x16x32_bf16 v[200:203], v[240:243], v[152:155], v[216:219]
    v_mfma_f32_16x16x32_bf16 v[204:207], v[240:243], v[168:171], v[220:223]
    ds_read_b128 v[232:235], v4 offset:28672
    v_exp_f32 v184, v184
    v_exp_f32 v185, v185
    v_mfma_f32_16x16x32_bf16 v[248:251], v[12:15], v[96:99], v[248:251]
    s_waitcnt lgkmcnt(3)
    v_mfma_f32_16x16x32_bf16 v[208:211], v[244:247], v[152:155], v[216:219]
    v_cvt_pk_bf16_f32 v104, v184, v185
    v_exp_f32 v186, v186
    v_mfma_f32_16x16x32_bf16 v[212:215], v[244:247], v[168:171], v[220:223]
    ds_read_b128 v[236:239], v4 offset:29696
    v_exp_f32 v187, v187
    v_mfma_f32_16x16x32_bf16 v[252:255], v[12:15], v[100:103], v[252:255]
    s_waitcnt lgkmcnt(3)
    v_mfma_f32_16x16x32_bf16 v[200:203], v[224:227], v[156:159], v[200:203]
    v_cvt_pk_bf16_f32 v105, v186, v187
    v_exp_f32 v188, v188
    v_mfma_f32_16x16x32_bf16 v[204:207], v[224:227], v[172:175], v[204:207]
    ds_read_b128 v[240:243], v4 offset:30720
    v_exp_f32 v189, v189
    s_waitcnt lgkmcnt(3)
    v_mfma_f32_16x16x32_bf16 v[208:211], v[228:231], v[156:159], v[208:211]
    v_cvt_pk_bf16_f32 v108, v188, v189
    v_exp_f32 v190, v190
    v_mfma_f32_16x16x32_bf16 v[212:215], v[228:231], v[172:175], v[212:215]
    ds_read_b128 v[244:247], v4 offset:31744
    v_exp_f32 v191, v191
    s_nop 0
    v_cvt_pk_bf16_f32 v109, v190, v191
    s_waitcnt lgkmcnt(3)
    v_mfma_f32_16x16x32_bf16 v[200:203], v[232:235], v[160:163], v[200:203]
    v_exp_f32 v192, v192
    v_mfma_f32_16x16x32_bf16 v[204:207], v[232:235], v[176:179], v[204:207]
    s_waitcnt vmcnt(7)
    s_barrier
    ds_read_b128 v[224:227], v4 offset:32768
    v_exp_f32 v193, v193
    s_nop 0
    v_cvt_pk_bf16_f32 v106, v192, v193
    s_waitcnt lgkmcnt(3)
    v_mfma_f32_16x16x32_bf16 v[208:211], v[236:239], v[160:163], v[208:211]
    v_exp_f32 v194, v194
    v_mfma_f32_16x16x32_bf16 v[212:215], v[236:239], v[176:179], v[212:215]
    s_add_u32 s22, s21, 0x88000
    s_add_u32 m0, s20, 0x10000
    s_nop 0
    buffer_load_dwordx4 v2, s[8:11], s22 offen sc1 lds
    ds_read_b128 v[228:231], v4 offset:33792
    v_exp_f32 v195, v195
    s_nop 0
    v_cvt_pk_bf16_f32 v107, v194, v195
    s_waitcnt lgkmcnt(3)
    v_mfma_f32_16x16x32_bf16 v[200:203], v[240:243], v[164:167], v[200:203]
    v_exp_f32 v196, v196
    v_exp_f32 v197, v197
    v_mfma_f32_16x16x32_bf16 v[204:207], v[240:243], v[180:183], v[204:207]
    ds_read_b128 v[232:235], v4 offset:34816
    v_cvt_pk_bf16_f32 v110, v196, v197
    s_waitcnt lgkmcnt(3)
    v_mfma_f32_16x16x32_bf16 v[208:211], v[244:247], v[164:167], v[208:211]
    v_exp_f32 v198, v198
    v_exp_f32 v199, v199
    v_mfma_f32_16x16x32_bf16 v[212:215], v[244:247], v[180:183], v[212:215]
    ds_read_b128 v[236:239], v4 offset:35840
    v_cvt_pk_bf16_f32 v111, v198, v199
    s_waitcnt lgkmcnt(3)
    v_mfma_f32_16x16x32_bf16 v[184:187], v[224:227], v[152:155], v[216:219]
    v_mfma_f32_16x16x32_bf16 v[188:191], v[224:227], v[168:171], v[220:223]
    ds_read_b128 v[240:243], v4 offset:36864
    v_exp_f32 v200, v200
    v_exp_f32 v201, v201
    v_mfma_f32_16x16x32_bf16 v[248:251], v[12:15], v[104:107], v[248:251]
    s_waitcnt lgkmcnt(3)
    v_mfma_f32_16x16x32_bf16 v[192:195], v[228:231], v[152:155], v[216:219]
    v_cvt_pk_bf16_f32 v112, v200, v201
    v_exp_f32 v202, v202
    v_mfma_f32_16x16x32_bf16 v[196:199], v[228:231], v[168:171], v[220:223]
    s_add_u32 s22, s21, 0x88400
    s_add_u32 m0, s20, 0x10400
    s_nop 0
    buffer_load_dwordx4 v2, s[8:11], s22 offen sc1 lds
    ds_read_b128 v[244:247], v4 offset:37888
    v_exp_f32 v203, v203
    v_mfma_f32_16x16x32_bf16 v[252:255], v[12:15], v[108:111], v[252:255]
    s_waitcnt lgkmcnt(3)
    v_mfma_f32_16x16x32_bf16 v[184:187], v[232:235], v[156:159], v[184:187]
    v_cvt_pk_bf16_f32 v113, v202, v203
    v_exp_f32 v204, v204
    v_mfma_f32_16x16x32_bf16 v[188:191], v[232:235], v[172:175], v[188:191]
    ds_read_b128 v[224:227], v4 offset:38912
    v_exp_f32 v205, v205
    s_waitcnt lgkmcnt(3)
    v_mfma_f32_16x16x32_bf16 v[192:195], v[236:239], v[156:159], v[192:195]
    v_cvt_pk_bf16_f32 v116, v204, v205
    v_exp_f32 v206, v206
    v_mfma_f32_16x16x32_bf16 v[196:199], v[236:239], v[172:175], v[196:199]
    ds_read_b128 v[228:231], v4 offset:39936
    v_exp_f32 v207, v207
    s_nop 0
    v_cvt_pk_bf16_f32 v117, v206, v207
    s_waitcnt lgkmcnt(3)
    v_mfma_f32_16x16x32_bf16 v[184:187], v[240:243], v[160:163], v[184:187]
    v_exp_f32 v208, v208
    v_mfma_f32_16x16x32_bf16 v[188:191], v[240:243], v[176:179], v[188:191]
    ds_read_b128 v[232:235], v4 offset:40960
    v_exp_f32 v209, v209
    s_nop 0
    v_cvt_pk_bf16_f32 v114, v208, v209
    s_waitcnt lgkmcnt(3)
    v_mfma_f32_16x16x32_bf16 v[192:195], v[244:247], v[160:163], v[192:195]
    v_exp_f32 v210, v210
    v_mfma_f32_16x16x32_bf16 v[196:199], v[244:247], v[176:179], v[196:199]
    ds_read_b128 v[236:239], v4 offset:41984
    v_exp_f32 v211, v211
    s_nop 0
    v_cvt_pk_bf16_f32 v115, v210, v211
    s_waitcnt lgkmcnt(3)
    v_mfma_f32_16x16x32_bf16 v[184:187], v[224:227], v[164:167], v[184:187]
    v_exp_f32 v212, v212
    v_exp_f32 v213, v213
    v_mfma_f32_16x16x32_bf16 v[188:191], v[224:227], v[180:183], v[188:191]
    ds_read_b128 v[240:243], v4 offset:43008
    v_cvt_pk_bf16_f32 v118, v212, v213
    s_waitcnt lgkmcnt(3)
    v_mfma_f32_16x16x32_bf16 v[192:195], v[228:231], v[164:167], v[192:195]
    v_exp_f32 v214, v214
    v_exp_f32 v215, v215
    v_mfma_f32_16x16x32_bf16 v[196:199], v[228:231], v[180:183], v[196:199]
    ds_read_b128 v[244:247], v4 offset:44032
    v_cvt_pk_bf16_f32 v119, v214, v215
    s_waitcnt lgkmcnt(3)
    v_mfma_f32_16x16x32_bf16 v[200:203], v[232:235], v[152:155], v[216:219]
    v_mfma_f32_16x16x32_bf16 v[204:207], v[232:235], v[168:171], v[220:223]
    ds_read_b128 v[224:227], v4 offset:45056
    v_exp_f32 v184, v184
    v_exp_f32 v185, v185
    v_mfma_f32_16x16x32_bf16 v[248:251], v[12:15], v[112:115], v[248:251]
    s_waitcnt lgkmcnt(3)
    v_mfma_f32_16x16x32_bf16 v[208:211], v[236:239], v[152:155], v[216:219]
    v_cvt_pk_bf16_f32 v120, v184, v185
    v_exp_f32 v186, v186
    v_mfma_f32_16x16x32_bf16 v[212:215], v[236:239], v[168:171], v[220:223]
    ds_read_b128 v[228:231], v4 offset:46080
    v_exp_f32 v187, v187
    v_mfma_f32_16x16x32_bf16 v[252:255], v[12:15], v[116:119], v[252:255]
    s_waitcnt lgkmcnt(3)
    v_mfma_f32_16x16x32_bf16 v[200:203], v[240:243], v[156:159], v[200:203]
    v_cvt_pk_bf16_f32 v121, v186, v187
    v_exp_f32 v188, v188
    v_mfma_f32_16x16x32_bf16 v[204:207], v[240:243], v[172:175], v[204:207]
    ds_read_b128 v[232:235], v4 offset:47104
    v_exp_f32 v189, v189
    s_waitcnt lgkmcnt(3)
    v_mfma_f32_16x16x32_bf16 v[208:211], v[244:247], v[156:159], v[208:211]
    v_cvt_pk_bf16_f32 v124, v188, v189
    v_exp_f32 v190, v190
    v_mfma_f32_16x16x32_bf16 v[212:215], v[244:247], v[172:175], v[212:215]
    ds_read_b128 v[236:239], v4 offset:48128
    v_exp_f32 v191, v191
    s_nop 0
    v_cvt_pk_bf16_f32 v125, v190, v191
    s_waitcnt lgkmcnt(3)
    v_mfma_f32_16x16x32_bf16 v[200:203], v[224:227], v[160:163], v[200:203]
    v_exp_f32 v192, v192
    v_mfma_f32_16x16x32_bf16 v[204:207], v[224:227], v[176:179], v[204:207]
    s_waitcnt vmcnt(6)
    s_barrier
    ds_read_b128 v[240:243], v4 offset:49152
    v_exp_f32 v193, v193
    s_nop 0
    v_cvt_pk_bf16_f32 v122, v192, v193
    s_waitcnt lgkmcnt(3)
    v_mfma_f32_16x16x32_bf16 v[208:211], v[228:231], v[160:163], v[208:211]
    v_exp_f32 v194, v194
    v_mfma_f32_16x16x32_bf16 v[212:215], v[228:231], v[176:179], v[212:215]
    s_add_u32 s22, s21, 0x8c000
    s_add_u32 m0, s20, 0x14000
    s_nop 0
    buffer_load_dwordx4 v2, s[8:11], s22 offen sc1 lds
    ds_read_b128 v[244:247], v4 offset:50176
    v_exp_f32 v195, v195
    s_nop 0
    v_cvt_pk_bf16_f32 v123, v194, v195
    s_waitcnt lgkmcnt(3)
    v_mfma_f32_16x16x32_bf16 v[200:203], v[232:235], v[164:167], v[200:203]
    v_exp_f32 v196, v196
    v_exp_f32 v197, v197
    v_mfma_f32_16x16x32_bf16 v[204:207], v[232:235], v[180:183], v[204:207]
    ds_read_b128 v[224:227], v4 offset:51200
    v_cvt_pk_bf16_f32 v126, v196, v197
    s_waitcnt lgkmcnt(3)
    v_mfma_f32_16x16x32_bf16 v[208:211], v[236:239], v[164:167], v[208:211]
    v_exp_f32 v198, v198
    v_exp_f32 v199, v199
    v_mfma_f32_16x16x32_bf16 v[212:215], v[236:239], v[180:183], v[212:215]
    ds_read_b128 v[228:231], v4 offset:52224
    v_cvt_pk_bf16_f32 v127, v198, v199
    s_waitcnt lgkmcnt(3)
    v_mfma_f32_16x16x32_bf16 v[184:187], v[240:243], v[152:155], v[216:219]
    v_mfma_f32_16x16x32_bf16 v[188:191], v[240:243], v[168:171], v[220:223]
    ds_read_b128 v[232:235], v4 offset:53248
    v_exp_f32 v200, v200
    v_exp_f32 v201, v201
    v_mfma_f32_16x16x32_bf16 v[248:251], v[12:15], v[120:123], v[248:251]
    s_waitcnt lgkmcnt(3)
    v_mfma_f32_16x16x32_bf16 v[192:195], v[244:247], v[152:155], v[216:219]
    v_cvt_pk_bf16_f32 v128, v200, v201
    v_exp_f32 v202, v202
    v_mfma_f32_16x16x32_bf16 v[196:199], v[244:247], v[168:171], v[220:223]
    s_add_u32 s22, s21, 0x8c400
    s_add_u32 m0, s20, 0x14400
    s_nop 0
    buffer_load_dwordx4 v2, s[8:11], s22 offen sc1 lds
    ds_read_b128 v[236:239], v4 offset:54272
    v_exp_f32 v203, v203
    v_mfma_f32_16x16x32_bf16 v[252:255], v[12:15], v[124:127], v[252:255]
    s_waitcnt lgkmcnt(3)
    v_mfma_f32_16x16x32_bf16 v[184:187], v[224:227], v[156:159], v[184:187]
    v_cvt_pk_bf16_f32 v129, v202, v203
    v_exp_f32 v204, v204
    v_mfma_f32_16x16x32_bf16 v[188:191], v[224:227], v[172:175], v[188:191]
    ds_read_b128 v[240:243], v4 offset:55296
    v_exp_f32 v205, v205
    s_waitcnt lgkmcnt(3)
    v_mfma_f32_16x16x32_bf16 v[192:195], v[228:231], v[156:159], v[192:195]
    v_cvt_pk_bf16_f32 v132, v204, v205
    v_exp_f32 v206, v206
    v_mfma_f32_16x16x32_bf16 v[196:199], v[228:231], v[172:175], v[196:199]
    ds_read_b128 v[244:247], v4 offset:56320
    v_exp_f32 v207, v207
    s_nop 0
    v_cvt_pk_bf16_f32 v133, v206, v207
    s_waitcnt lgkmcnt(3)
    v_mfma_f32_16x16x32_bf16 v[184:187], v[232:235], v[160:163], v[184:187]
    v_exp_f32 v208, v208
    v_mfma_f32_16x16x32_bf16 v[188:191], v[232:235], v[176:179], v[188:191]
    ds_read_b128 v[224:227], v4 offset:57344
    v_exp_f32 v209, v209
    s_nop 0
    v_cvt_pk_bf16_f32 v130, v208, v209
    s_waitcnt lgkmcnt(3)
    v_mfma_f32_16x16x32_bf16 v[192:195], v[236:239], v[160:163], v[192:195]
    v_exp_f32 v210, v210
    v_mfma_f32_16x16x32_bf16 v[196:199], v[236:239], v[176:179], v[196:199]
    ds_read_b128 v[228:231], v4 offset:58368
    v_exp_f32 v211, v211
    s_nop 0
    v_cvt_pk_bf16_f32 v131, v210, v211
    s_waitcnt lgkmcnt(3)
    v_mfma_f32_16x16x32_bf16 v[184:187], v[240:243], v[164:167], v[184:187]
    v_exp_f32 v212, v212
    v_exp_f32 v213, v213
    v_mfma_f32_16x16x32_bf16 v[188:191], v[240:243], v[180:183], v[188:191]
    ds_read_b128 v[232:235], v4 offset:59392
    v_cvt_pk_bf16_f32 v134, v212, v213
    s_waitcnt lgkmcnt(3)
    v_mfma_f32_16x16x32_bf16 v[192:195], v[244:247], v[164:167], v[192:195]
    v_exp_f32 v214, v214
    v_exp_f32 v215, v215
    v_mfma_f32_16x16x32_bf16 v[196:199], v[244:247], v[180:183], v[196:199]
    ds_read_b128 v[236:239], v4 offset:60416
    v_cvt_pk_bf16_f32 v135, v214, v215
    s_waitcnt lgkmcnt(3)
    v_mfma_f32_16x16x32_bf16 v[200:203], v[224:227], v[152:155], v[216:219]
    v_mfma_f32_16x16x32_bf16 v[204:207], v[224:227], v[168:171], v[220:223]
    ds_read_b128 v[240:243], v4 offset:61440
    v_exp_f32 v184, v184
    v_exp_f32 v185, v185
    v_mfma_f32_16x16x32_bf16 v[248:251], v[12:15], v[128:131], v[248:251]
    s_waitcnt lgkmcnt(3)
    v_mfma_f32_16x16x32_bf16 v[208:211], v[228:231], v[152:155], v[216:219]
    v_cvt_pk_bf16_f32 v136, v184, v185
    v_exp_f32 v186, v186
    v_mfma_f32_16x16x32_bf16 v[212:215], v[228:231], v[168:171], v[220:223]
    ds_read_b128 v[244:247], v4 offset:62464
    v_exp_f32 v187, v187
    v_mfma_f32_16x16x32_bf16 v[252:255], v[12:15], v[132:135], v[252:255]
    s_waitcnt lgkmcnt(3)
    v_mfma_f32_16x16x32_bf16 v[200:203], v[232:235], v[156:159], v[200:203]
    v_cvt_pk_bf16_f32 v137, v186, v187
    v_exp_f32 v188, v188
    v_mfma_f32_16x16x32_bf16 v[204:207], v[232:235], v[172:175], v[204:207]
    ds_read_b128 v[224:227], v4 offset:63488
    v_exp_f32 v189, v189
    s_waitcnt lgkmcnt(3)
    v_mfma_f32_16x16x32_bf16 v[208:211], v[236:239], v[156:159], v[208:211]
    v_cvt_pk_bf16_f32 v140, v188, v189
    v_exp_f32 v190, v190
    v_mfma_f32_16x16x32_bf16 v[212:215], v[236:239], v[172:175], v[212:215]
    ds_read_b128 v[228:231], v4 offset:64512
    v_exp_f32 v191, v191
    s_nop 0
    v_cvt_pk_bf16_f32 v141, v190, v191
    s_waitcnt lgkmcnt(3)
    v_mfma_f32_16x16x32_bf16 v[200:203], v[240:243], v[160:163], v[200:203]
    v_exp_f32 v192, v192
    v_mfma_f32_16x16x32_bf16 v[204:207], v[240:243], v[176:179], v[204:207]
    v_exp_f32 v193, v193
    s_nop 0
    v_cvt_pk_bf16_f32 v138, v192, v193
    s_waitcnt lgkmcnt(2)
    v_mfma_f32_16x16x32_bf16 v[208:211], v[244:247], v[160:163], v[208:211]
    v_exp_f32 v194, v194
    v_mfma_f32_16x16x32_bf16 v[212:215], v[244:247], v[176:179], v[212:215]
    v_exp_f32 v195, v195
    s_nop 0
    v_cvt_pk_bf16_f32 v139, v194, v195
    s_waitcnt lgkmcnt(1)
    v_mfma_f32_16x16x32_bf16 v[200:203], v[224:227], v[164:167], v[200:203]
    v_exp_f32 v196, v196
    v_exp_f32 v197, v197
    v_mfma_f32_16x16x32_bf16 v[204:207], v[224:227], v[180:183], v[204:207]
    v_cvt_pk_bf16_f32 v142, v196, v197
    s_waitcnt lgkmcnt(0)
    v_mfma_f32_16x16x32_bf16 v[208:211], v[228:231], v[164:167], v[208:211]
    v_exp_f32 v198, v198
    v_exp_f32 v199, v199
    v_mfma_f32_16x16x32_bf16 v[212:215], v[228:231], v[180:183], v[212:215]
    v_cvt_pk_bf16_f32 v143, v198, v199
    s_waitcnt vmcnt(6)
    s_barrier
    ds_read_b128 v[232:235], v5 offset:0
    ds_read_b128 v[236:239], v5 offset:1024
    ds_read_b128 v[240:243], v5 offset:2048
    ds_read_b128 v[244:247], v5 offset:3072
    v_mfma_f32_16x16x32_bf16 v[248:251], v[12:15], v[136:139], v[248:251]
    v_mfma_f32_16x16x32_bf16 v[252:255], v[12:15], v[140:143], v[252:255]
    v_exp_f32 v200, v200
    v_exp_f32 v201, v201
    s_nop 0
    v_cvt_pk_bf16_f32 v144, v200, v201
    v_exp_f32 v202, v202
    v_exp_f32 v203, v203
    s_nop 0
    v_cvt_pk_bf16_f32 v145, v202, v203
    v_exp_f32 v204, v204
    v_exp_f32 v205, v205
    s_nop 0
    v_cvt_pk_bf16_f32 v148, v204, v205
    v_exp_f32 v206, v206
    v_exp_f32 v207, v207
    s_nop 0
    v_cvt_pk_bf16_f32 v149, v206, v207
    v_exp_f32 v208, v208
    v_exp_f32 v209, v209
    s_nop 0
    v_cvt_pk_bf16_f32 v146, v208, v209
    v_exp_f32 v210, v210
    v_exp_f32 v211, v211
    s_nop 0
    v_cvt_pk_bf16_f32 v147, v210, v211
    v_exp_f32 v212, v212
    v_exp_f32 v213, v213
    s_nop 0
    v_cvt_pk_bf16_f32 v150, v212, v213
    v_exp_f32 v214, v214
    v_exp_f32 v215, v215
    s_nop 0
    v_cvt_pk_bf16_f32 v151, v214, v215
    v_mfma_f32_16x16x32_bf16 v[248:251], v[12:15], v[144:147], v[248:251]
    s_nop 0
    v_mfma_f32_16x16x32_bf16 v[252:255], v[12:15], v[148:151], v[252:255]
    s_nop 5
    v_mov_b32 v9, v248
    s_nop 0
    v_mov_b32 v10, v252
    v_max_f32 v17, v9, v10
    v_readfirstlane_b32 s17, v8
    s_cmp_eq_u32 s17, s28
    s_cselect_b32 s16, 0, 0x71800000
    v_cmp_ngt_f32 vcc, s16, v17
    v_cmp_u_f32 s[76:77], v9, v10
    s_or_b64 vcc, vcc, s[76:77]
    s_cbranch_vccnz adaLN_cond__sliding_block_cached__moe_arch_mod__prompt_kernel_fixA
adaLN_cond__sliding_block_cached__moe_arch_mod__prompt_kernel_fixAb:
    v_rcp_f32 v9, v9
    v_rcp_f32 v10, v10
    s_lshl_b32 s25, s13, 3
    s_add_u32 s25, s25, s3
    s_lshl_b32 s25, s25, 18
    s_lshl_b32 s26, s12, 12
    s_add_u32 s25, s25, s26
    s_add_u32 s25, s25, 0x1000000
    s_add_u32 s26, s25, 131072
    s_lshl_b32 s63, s13, 3
    s_add_u32 s63, s63, s3
    s_lshl_b32 s63, s63, 5
    s_add_u32 s63, s63, s12
    s_lshl_b32 s63, s63, 2
    s_waitcnt lgkmcnt(3)
    v_mfma_f32_16x16x32_bf16 v[184:187], v[232:235], v[24:27], 0
    v_mfma_f32_16x16x32_bf16 v[188:191], v[232:235], v[28:31], 0
    ds_read_b128 v[224:227], v5 offset:4096
    s_waitcnt lgkmcnt(3)
    v_mfma_f32_16x16x32_bf16 v[192:195], v[236:239], v[24:27], 0
    s_add_u32 s22, s21, 0x90000
    s_add_u32 m0, s20, 0x18000
    s_nop 0
    buffer_load_dwordx4 v2, s[8:11], s22 offen sc1 lds
    v_mfma_f32_16x16x32_bf16 v[196:199], v[236:239], v[28:31], 0
    ds_read_b128 v[228:231], v5 offset:5120
    s_waitcnt lgkmcnt(3)
    v_mfma_f32_16x16x32_bf16 v[184:187], v[240:243], v[32:35], v[184:187]
    v_mfma_f32_16x16x32_bf16 v[188:191], v[240:243], v[36:39], v[188:191]
    ds_read_b128 v[232:235], v5 offset:6144
    s_waitcnt lgkmcnt(3)
    v_mfma_f32_16x16x32_bf16 v[192:195], v[244:247], v[32:35], v[192:195]
    v_mfma_f32_16x16x32_bf16 v[196:199], v[244:247], v[36:39], v[196:199]
    ds_read_b128 v[236:239], v5 offset:7168
    s_waitcnt lgkmcnt(3)
    v_mfma_f32_16x16x32_bf16 v[184:187], v[224:227], v[40:43], v[184:187]
    v_mfma_f32_16x16x32_bf16 v[188:191], v[224:227], v[44:47], v[188:191]
    ds_read_b128 v[240:243], v5 offset:8192
    s_waitcnt lgkmcnt(3)
    v_mfma_f32_16x16x32_bf16 v[192:195], v[228:231], v[40:43], v[192:195]
    s_add_u32 s22, s21, 0x90400
    s_add_u32 m0, s20, 0x18400
    s_nop 0
    buffer_load_dwordx4 v2, s[8:11], s22 offen sc1 lds
    v_and_b32 v250, 7, v1
    v_lshlrev_b32 v250, 7, v250
    s_lshr_b32 s14, s2, 3
    s_lshl_b32 s14, s14, 2
    s_add_u32 s14, s14, 0x560000
    buffer_load_dword v248, v250, s[8:11], s14 offen sc1
    v_mfma_f32_16x16x32_bf16 v[196:199], v[228:231], v[44:47], v[196:199]
    ds_read_b128 v[244:247], v5 offset:9216
    s_waitcnt lgkmcnt(3)
    v_mfma_f32_16x16x32_bf16 v[184:187], v[232:235], v[48:51], v[184:187]
    v_mfma_f32_16x16x32_bf16 v[188:191], v[232:235], v[52:55], v[188:191]
    ds_read_b128 v[224:227], v5 offset:10240
    s_waitcnt lgkmcnt(3)
    v_mfma_f32_16x16x32_bf16 v[192:195], v[236:239], v[48:51], v[192:195]
    v_mfma_f32_16x16x32_bf16 v[196:199], v[236:239], v[52:55], v[196:199]
    ds_read_b128 v[228:231], v5 offset:11264
    s_waitcnt lgkmcnt(3)
    v_mfma_f32_16x16x32_bf16 v[184:187], v[240:243], v[56:59], v[184:187]
    v_mfma_f32_16x16x32_bf16 v[188:191], v[240:243], v[60:63], v[188:191]
    ds_read_b128 v[232:235], v5 offset:12288
    s_waitcnt lgkmcnt(3)
    v_mfma_f32_16x16x32_bf16 v[192:195], v[244:247], v[56:59], v[192:195]
    v_mfma_f32_16x16x32_bf16 v[196:199], v[244:247], v[60:63], v[196:199]
    ds_read_b128 v[236:239], v5 offset:13312
    s_waitcnt lgkmcnt(3)
    v_mfma_f32_16x16x32_bf16 v[184:187], v[224:227], v[64:67], v[184:187]
    v_mfma_f32_16x16x32_bf16 v[188:191], v[224:227], v[68:71], v[188:191]
    ds_read_b128 v[240:243], v5 offset:14336
    s_waitcnt lgkmcnt(3)
    v_mfma_f32_16x16x32_bf16 v[192:195], v[228:231], v[64:67], v[192:195]
    v_mfma_f32_16x16x32_bf16 v[196:199], v[228:231], v[68:71], v[196:199]
    ds_read_b128 v[244:247], v5 offset:15360
    s_waitcnt lgkmcnt(3)
    v_mfma_f32_16x16x32_bf16 v[184:187], v[232:235], v[72:75], v[184:187]
    v_mfma_f32_16x16x32_bf16 v[188:191], v[232:235], v[76:79], v[188:191]
    s_waitcnt vmcnt(7)
    s_barrier
    ds_read_b128 v[224:227], v5 offset:16384
    s_waitcnt lgkmcnt(3)
    v_mfma_f32_16x16x32_bf16 v[192:195], v[236:239], v[72:75], v[192:195]
    v_mfma_f32_16x16x32_bf16 v[196:199], v[236:239], v[76:79], v[196:199]
    s_add_u32 s22, s21, 0x94000
    s_add_u32 m0, s20, 0x1c000
    s_nop 0
    buffer_load_dwordx4 v2, s[8:11], s22 offen sc1 lds
    ds_read_b128 v[228:231], v5 offset:17408
    s_waitcnt lgkmcnt(3)
    v_mfma_f32_16x16x32_bf16 v[184:187], v[240:243], v[80:83], v[184:187]
    v_mfma_f32_16x16x32_bf16 v[188:191], v[240:243], v[84:87], v[188:191]
    ds_read_b128 v[232:235], v5 offset:18432
    s_waitcnt lgkmcnt(3)
    v_mfma_f32_16x16x32_bf16 v[192:195], v[244:247], v[80:83], v[192:195]
    v_mfma_f32_16x16x32_bf16 v[196:199], v[244:247], v[84:87], v[196:199]
    ds_read_b128 v[236:239], v5 offset:19456
    s_waitcnt lgkmcnt(3)
    v_mfma_f32_16x16x32_bf16 v[184:187], v[224:227], v[88:91], v[184:187]
    v_mfma_f32_16x16x32_bf16 v[188:191], v[224:227], v[92:95], v[188:191]
    ds_read_b128 v[240:243], v5 offset:20480
    s_waitcnt lgkmcnt(3)
    v_mfma_f32_16x16x32_bf16 v[192:195], v[228:231], v[88:91], v[192:195]
    v_mfma_f32_16x16x32_bf16 v[196:199], v[228:231], v[92:95], v[196:199]
    s_add_u32 s22, s21, 0x94400
    s_add_u32 m0, s20, 0x1c400
    s_nop 0
    buffer_load_dwordx4 v2, s[8:11], s22 offen sc1 lds
    ds_read_b128 v[244:247], v5 offset:21504
    s_waitcnt lgkmcnt(3)
    v_mfma_f32_16x16x32_bf16 v[184:187], v[232:235], v[96:99], v[184:187]
    v_mfma_f32_16x16x32_bf16 v[188:191], v[232:235], v[100:103], v[188:191]
    ds_read_b128 v[224:227], v5 offset:22528
    s_waitcnt lgkmcnt(3)
    v_mfma_f32_16x16x32_bf16 v[192:195], v[236:239], v[96:99], v[192:195]
    v_mfma_f32_16x16x32_bf16 v[196:199], v[236:239], v[100:103], v[196:199]
    ds_read_b128 v[228:231], v5 offset:23552
    s_waitcnt lgkmcnt(3)
    v_mfma_f32_16x16x32_bf16 v[184:187], v[240:243], v[104:107], v[184:187]
    v_mfma_f32_16x16x32_bf16 v[188:191], v[240:243], v[108:111], v[188:191]
    ds_read_b128 v[232:235], v5 offset:24576
    s_waitcnt lgkmcnt(3)
    v_mfma_f32_16x16x32_bf16 v[192:195], v[244:247], v[104:107], v[192:195]
    v_mfma_f32_16x16x32_bf16 v[196:199], v[244:247], v[108:111], v[196:199]
    ds_read_b128 v[236:239], v5 offset:25600
    s_waitcnt lgkmcnt(3)
    v_mfma_f32_16x16x32_bf16 v[184:187], v[224:227], v[112:115], v[184:187]
    s_waitcnt vmcnt(2)
    v_cmp_ne_u32 vcc, s28, v248
    s_cbranch_vccnz adaLN_cond__sliding_block_cached__moe_arch_mod__prompt_kernel_mp5r
adaLN_cond__sliding_block_cached__moe_arch_mod__prompt_kernel_mp5b:
    v_mfma_f32_16x16x32_bf16 v[188:191], v[224:227], v[116:119], v[188:191]
    ds_read_b128 v[240:243], v5 offset:26624
    v_lshrrev_b32 v250, 4, v1
    v_lshlrev_b32 v250, 14, v250
    v_and_b32 v253, 15, v1
    v_lshl_add_u32 v250, v253, 2, v250
    s_lshl_b32 s14, s2, 6
    s_add_u32 s14, s14, 0x580000
    buffer_load_dword v249, v250, s[8:11], s14 offen sc1
    s_add_u32 s14, s14, 0x10000
    buffer_load_dword v254, v250, s[8:11], s14 offen sc1
    s_waitcnt lgkmcnt(3)
    v_mfma_f32_16x16x32_bf16 v[192:195], v[228:231], v[112:115], v[192:195]
    v_mfma_f32_16x16x32_bf16 v[196:199], v[228:231], v[116:119], v[196:199]
    ds_read_b128 v[244:247], v5 offset:27648
    s_waitcnt lgkmcnt(3)
    v_mfma_f32_16x16x32_bf16 v[184:187], v[232:235], v[120:123], v[184:187]
    v_mfma_f32_16x16x32_bf16 v[188:191], v[232:235], v[124:127], v[188:191]
    ds_read_b128 v[224:227], v5 offset:28672
    s_waitcnt lgkmcnt(3)
    v_mfma_f32_16x16x32_bf16 v[192:195], v[236:239], v[120:123], v[192:195]
    v_mfma_f32_16x16x32_bf16 v[196:199], v[236:239], v[124:127], v[196:199]
    ds_read_b128 v[228:231], v5 offset:29696
    s_waitcnt lgkmcnt(3)
    v_mfma_f32_16x16x32_bf16 v[184:187], v[240:243], v[128:131], v[184:187]
    v_mfma_f32_16x16x32_bf16 v[188:191], v[240:243], v[132:135], v[188:191]
    ds_read_b128 v[232:235], v5 offset:30720
    s_waitcnt lgkmcnt(3)
    v_mfma_f32_16x16x32_bf16 v[192:195], v[244:247], v[128:131], v[192:195]
    v_mfma_f32_16x16x32_bf16 v[196:199], v[244:247], v[132:135], v[196:199]
    ds_read_b128 v[236:239], v5 offset:31744
    s_waitcnt lgkmcnt(3)
    v_mfma_f32_16x16x32_bf16 v[184:187], v[224:227], v[136:139], v[184:187]
    v_mfma_f32_16x16x32_bf16 v[188:191], v[224:227], v[140:143], v[188:191]
    s_barrier
    ds_read_b128 v[240:243], v4 offset:0
    s_waitcnt lgkmcnt(3)
    v_mfma_f32_16x16x32_bf16 v[192:195], v[228:231], v[136:139], v[192:195]
    v_mfma_f32_16x16x32_bf16 v[196:199], v[228:231], v[140:143], v[196:199]
    s_add_u32 s22, s21, 0x98000
    s_add_u32 m0, s20, 0x20000
    s_nop 0
    buffer_load_dwordx4 v2, s[8:11], s22 offen sc1 lds
    ds_read_b128 v[244:247], v4 offset:1024
    s_waitcnt lgkmcnt(3)
    v_mfma_f32_16x16x32_bf16 v[184:187], v[232:235], v[144:147], v[184:187]
    v_mfma_f32_16x16x32_bf16 v[188:191], v[232:235], v[148:151], v[188:191]
    ds_read_b128 v[224:227], v4 offset:2048
    s_waitcnt lgkmcnt(3)
    v_mfma_f32_16x16x32_bf16 v[192:195], v[236:239], v[144:147], v[192:195]
    v_mfma_f32_16x16x32_bf16 v[196:199], v[236:239], v[148:151], v[196:199]
    ds_read_b128 v[228:231], v4 offset:3072
    s_waitcnt lgkmcnt(3)
    v_mfma_f32_16x16x32_bf16 v[200:203], v[240:243], v[24:27], 0
    v_mfma_f32_16x16x32_bf16 v[204:207], v[240:243], v[28:31], 0
    ds_read_b128 v[232:235], v4 offset:4096
    s_waitcnt lgkmcnt(3)
    v_mfma_f32_16x16x32_bf16 v[208:211], v[244:247], v[24:27], 0
    v_mfma_f32_16x16x32_bf16 v[212:215], v[244:247], v[28:31], 0
    s_add_u32 s22, s21, 0x98400
    s_add_u32 m0, s20, 0x20400
    s_nop 0
    buffer_load_dwordx4 v2, s[8:11], s22 offen sc1 lds
    ds_read_b128 v[236:239], v4 offset:5120
    v_mul_f32 v184, v184, v9
    s_waitcnt lgkmcnt(3)
    v_mfma_f32_16x16x32_bf16 v[200:203], v[224:227], v[32:35], v[200:203]
    v_mul_f32 v185, v185, v9
    s_waitcnt vmcnt(2)
    v_add_f32 v249, v249, v254
    v_mov_b32 v250, v249
    s_nop 1
    v_permlane16_swap_b32 v249, v250
    v_add_f32 v249, v249, v250
    v_mov_b32 v250, v249
    s_nop 1
    v_permlane32_swap_b32 v249, v250
    v_add_f32 v249, v249, v250
    v_cvt_pk_bf16_f32 v249, v249, v249
    v_lshlrev_b32 v249, 16, v249
    s_lshr_b32 s14, s2, 6
    s_cmp_eq_u32 s14, 2
    s_cselect_b32 s14, 1.0, 0
    v_add_f32 v249, s14, v249
    v_cvt_pk_bf16_f32 v249, v249, v249
    v_lshlrev_b32 v253, 1, v253
    s_lshl_b32 s14, s2, 5
    s_add_u32 s14, s14, 0x540000
    s_cmp_eq_u32 s3, 0
    s_cselect_b32 s14, s14, 0x7ffffff0
    s_mov_b64 exec, 0xffff
    buffer_store_short v249, v253, s[8:11], s14 offen sc1
    s_mov_b64 exec, -1
    v_mfma_f32_16x16x32_bf16 v[204:207], v[224:227], v[36:39], v[204:207]
    ds_read_b128 v[240:243], v4 offset:6144
    v_mul_f32 v186, v186, v9
    s_waitcnt lgkmcnt(3)
    v_mfma_f32_16x16x32_bf16 v[208:211], v[228:231], v[32:35], v[208:211]
    v_mul_f32 v187, v187, v9
    v_mfma_f32_16x16x32_bf16 v[212:215], v[228:231], v[36:39], v[212:215]
    ds_read_b128 v[244:247], v4 offset:7168
    v_mul_f32 v192, v192, v9
    s_waitcnt lgkmcnt(3)
    v_mfma_f32_16x16x32_bf16 v[200:203], v[232:235], v[40:43], v[200:203]
    v_mul_f32 v193, v193, v9
    v_mfma_f32_16x16x32_bf16 v[204:207], v[232:235], v[44:47], v[204:207]
    ds_read_b128 v[224:227], v4 offset:8192
    v_mul_f32 v194, v194, v9
    s_waitcnt lgkmcnt(3)
    v_mfma_f32_16x16x32_bf16 v[208:211], v[236:239], v[40:43], v[208:211]
    v_mul_f32 v195, v195, v9
    v_mfma_f32_16x16x32_bf16 v[212:215], v[236:239], v[44:47], v[212:215]
    ds_read_b128 v[228:231], v4 offset:9216
    v_cvt_pk_bf16_f32 v216, v184, v185
    s_waitcnt lgkmcnt(3)
    v_mfma_f32_16x16x32_bf16 v[200:203], v[240:243], v[48:51], v[200:203]
    v_cvt_pk_bf16_f32 v217, v186, v187
    v_mfma_f32_16x16x32_bf16 v[204:207], v[240:243], v[52:55], v[204:207]
    ds_read_b128 v[232:235], v4 offset:10240
    v_cvt_pk_bf16_f32 v218, v192, v193
    s_waitcnt lgkmcnt(3)
    v_mfma_f32_16x16x32_bf16 v[208:211], v[244:247], v[48:51], v[208:211]
    v_cvt_pk_bf16_f32 v219, v194, v195
    v_mfma_f32_16x16x32_bf16 v[212:215], v[244:247], v[52:55], v[212:215]
    ds_read_b128 v[236:239], v4 offset:11264
    buffer_store_dwordx4 v[216:219], v2, s[8:11], s25 offen offset:0 sc1
    s_waitcnt lgkmcnt(3)
    v_mfma_f32_16x16x32_bf16 v[200:203], v[224:227], v[56:59], v[200:203]
    v_mul_f32 v188, v188, v10
    v_mfma_f32_16x16x32_bf16 v[204:207], v[224:227], v[60:63], v[204:207]
    ds_read_b128 v[240:243], v4 offset:12288
    v_mul_f32 v189, v189, v10
    s_waitcnt lgkmcnt(3)
    v_mfma_f32_16x16x32_bf16 v[208:211], v[228:231], v[56:59], v[208:211]
    v_mul_f32 v190, v190, v10
    v_mfma_f32_16x16x32_bf16 v[212:215], v[228:231], v[60:63], v[212:215]
    ds_read_b128 v[244:247], v4 offset:13312
    v_mul_f32 v191, v191, v10
    s_waitcnt lgkmcnt(3)
    v_mfma_f32_16x16x32_bf16 v[200:203], v[232:235], v[64:67], v[200:203]
    v_mul_f32 v196, v196, v10
    v_mfma_f32_16x16x32_bf16 v[204:207], v[232:235], v[68:71], v[204:207]
    ds_read_b128 v[224:227], v4 offset:14336
    v_mul_f32 v197, v197, v10
    s_waitcnt lgkmcnt(3)
    v_mfma_f32_16x16x32_bf16 v[208:211], v[236:239], v[64:67], v[208:211]
    v_mul_f32 v198, v198, v10
    v_mfma_f32_16x16x32_bf16 v[212:215], v[236:239], v[68:71], v[212:215]
    ds_read_b128 v[228:231], v4 offset:15360
    v_mul_f32 v199, v199, v10
    s_waitcnt lgkmcnt(3)
    v_mfma_f32_16x16x32_bf16 v[200:203], v[240:243], v[72:75], v[200:203]
    v_cvt_pk_bf16_f32 v220, v188, v189
    v_mfma_f32_16x16x32_bf16 v[204:207], v[240:243], v[76:79], v[204:207]
    s_barrier
    ds_read_b128 v[232:235], v4 offset:16384
    v_cvt_pk_bf16_f32 v221, v190, v191
    s_waitcnt lgkmcnt(3)
    v_mfma_f32_16x16x32_bf16 v[208:211], v[244:247], v[72:75], v[208:211]
    v_cvt_pk_bf16_f32 v222, v196, v197
    v_mfma_f32_16x16x32_bf16 v[212:215], v[244:247], v[76:79], v[212:215]
    s_add_u32 s22, s21, 0x9c000
    s_add_u32 m0, s20, 0x24000
    s_nop 0
    buffer_load_dwordx4 v2, s[8:11], s22 offen sc1 lds
    ds_read_b128 v[236:239], v4 offset:17408
    v_cvt_pk_bf16_f32 v223, v198, v199
    s_waitcnt lgkmcnt(3)
    v_mfma_f32_16x16x32_bf16 v[200:203], v[224:227], v[80:83], v[200:203]
    buffer_store_dwordx4 v[220:223], v2, s[8:11], s26 offen offset:0 sc1
    v_mfma_f32_16x16x32_bf16 v[204:207], v[224:227], v[84:87], v[204:207]
    ds_read_b128 v[240:243], v4 offset:18432
    s_waitcnt lgkmcnt(3)
    v_mfma_f32_16x16x32_bf16 v[208:211], v[228:231], v[80:83], v[208:211]
    v_mfma_f32_16x16x32_bf16 v[212:215], v[228:231], v[84:87], v[212:215]
    ds_read_b128 v[244:247], v4 offset:19456
    s_waitcnt lgkmcnt(3)
    v_mfma_f32_16x16x32_bf16 v[200:203], v[232:235], v[88:91], v[200:203]
    v_mfma_f32_16x16x32_bf16 v[204:207], v[232:235], v[92:95], v[204:207]
    ds_read_b128 v[224:227], v4 offset:20480
    s_waitcnt lgkmcnt(3)
    v_mfma_f32_16x16x32_bf16 v[208:211], v[236:239], v[88:91], v[208:211]
    v_mfma_f32_16x16x32_bf16 v[212:215], v[236:239], v[92:95], v[212:215]
    s_add_u32 s22, s21, 0x9c400
    s_add_u32 m0, s20, 0x24400
    s_nop 0
    buffer_load_dwordx4 v2, s[8:11], s22 offen sc1 lds
    ds_read_b128 v[228:231], v4 offset:21504
    s_waitcnt lgkmcnt(3)
    v_mfma_f32_16x16x32_bf16 v[200:203], v[240:243], v[96:99], v[200:203]
    v_mfma_f32_16x16x32_bf16 v[204:207], v[240:243], v[100:103], v[204:207]
    ds_read_b128 v[232:235], v4 offset:22528
    s_waitcnt lgkmcnt(3)
    v_mfma_f32_16x16x32_bf16 v[208:211], v[244:247], v[96:99], v[208:211]
    v_mfma_f32_16x16x32_bf16 v[212:215], v[244:247], v[100:103], v[212:215]
    ds_read_b128 v[236:239], v4 offset:23552
    s_waitcnt lgkmcnt(3)
    v_mfma_f32_16x16x32_bf16 v[200:203], v[224:227], v[104:107], v[200:203]
    v_mfma_f32_16x16x32_bf16 v[204:207], v[224:227], v[108:111], v[204:207]
    ds_read_b128 v[240:243], v4 offset:24576
    s_waitcnt lgkmcnt(3)
    v_mfma_f32_16x16x32_bf16 v[208:211], v[228:231], v[104:107], v[208:211]
    v_mfma_f32_16x16x32_bf16 v[212:215], v[228:231], v[108:111], v[212:215]
    ds_read_b128 v[244:247], v4 offset:25600
    s_waitcnt lgkmcnt(3)
    v_mfma_f32_16x16x32_bf16 v[200:203], v[232:235], v[112:115], v[200:203]
    s_waitcnt vmcnt(4)
    v_mov_b32 v248, s28
    v_mov_b32 v249, 0
    s_lshl_b32 s14, s2, 2
    s_add_u32 s14, s14, 0x544000
    s_cmp_eq_u32 s3, 0
    s_cselect_b32 s14, s14, 0x7ffffff0
    s_mov_b64 exec, 1
    buffer_store_dword v248, v249, s[8:11], s14 offen sc1
    s_mov_b64 exec, -1
    v_mfma_f32_16x16x32_bf16 v[204:207], v[232:235], v[116:119], v[204:207]
    ds_read_b128 v[224:227], v4 offset:26624
    s_waitcnt lgkmcnt(3)
    v_mfma_f32_16x16x32_bf16 v[208:211], v[236:239], v[112:115], v[208:211]
    v_mfma_f32_16x16x32_bf16 v[212:215], v[236:239], v[116:119], v[212:215]
    ds_read_b128 v[228:231], v4 offset:27648
    s_waitcnt lgkmcnt(3)
    v_mfma_f32_16x16x32_bf16 v[200:203], v[240:243], v[120:123], v[200:203]
    v_mfma_f32_16x16x32_bf16 v[204:207], v[240:243], v[124:127], v[204:207]
    ds_read_b128 v[232:235], v4 offset:28672
    s_waitcnt lgkmcnt(3)
    v_mfma_f32_16x16x32_bf16 v[208:211], v[244:247], v[120:123], v[208:211]
    v_mfma_f32_16x16x32_bf16 v[212:215], v[244:247], v[124:127], v[212:215]
    ds_read_b128 v[236:239], v4 offset:29696
    s_waitcnt lgkmcnt(3)
    v_mfma_f32_16x16x32_bf16 v[200:203], v[224:227], v[128:131], v[200:203]
    v_mfma_f32_16x16x32_bf16 v[204:207], v[224:227], v[132:135], v[204:207]
    ds_read_b128 v[240:243], v4 offset:30720
    s_waitcnt lgkmcnt(3)
    v_mfma_f32_16x16x32_bf16 v[208:211], v[228:231], v[128:131], v[208:211]
    v_mfma_f32_16x16x32_bf16 v[212:215], v[228:231], v[132:135], v[212:215]
    ds_read_b128 v[244:247], v4 offset:31744
    s_waitcnt lgkmcnt(3)
    v_mfma_f32_16x16x32_bf16 v[200:203], v[232:235], v[136:139], v[200:203]
    v_mfma_f32_16x16x32_bf16 v[204:207], v[232:235], v[140:143], v[204:207]
    s_barrier
    ds_read_b128 v[224:227], v4 offset:32768
    s_waitcnt lgkmcnt(3)
    v_mfma_f32_16x16x32_bf16 v[208:211], v[236:239], v[136:139], v[208:211]
    v_mfma_f32_16x16x32_bf16 v[212:215], v[236:239], v[140:143], v[212:215]
    s_add_u32 s22, s24, 0x0
    s_add_u32 m0, s20, 0x10000
    s_nop 0
    buffer_load_dwordx4 v3, s[4:7], s22 offen lds
    ds_read_b128 v[228:231], v4 offset:33792
    s_waitcnt lgkmcnt(3)
    v_mfma_f32_16x16x32_bf16 v[200:203], v[240:243], v[144:147], v[200:203]
    v_mfma_f32_16x16x32_bf16 v[204:207], v[240:243], v[148:151], v[204:207]
    ds_read_b128 v[232:235], v4 offset:34816
    s_waitcnt lgkmcnt(3)
    v_mfma_f32_16x16x32_bf16 v[208:211], v[244:247], v[144:147], v[208:211]
    v_mfma_f32_16x16x32_bf16 v[212:215], v[244:247], v[148:151], v[212:215]
    ds_read_b128 v[236:239], v4 offset:35840
    s_waitcnt lgkmcnt(3)
    v_mfma_f32_16x16x32_bf16 v[184:187], v[224:227], v[24:27], 0
    v_mfma_f32_16x16x32_bf16 v[188:191], v[224:227], v[28:31], 0
    ds_read_b128 v[240:243], v4 offset:36864
    s_waitcnt lgkmcnt(3)
    v_mfma_f32_16x16x32_bf16 v[192:195], v[228:231], v[24:27], 0
    v_mfma_f32_16x16x32_bf16 v[196:199], v[228:231], v[28:31], 0
    s_add_u32 s22, s24, 0x2000
    s_add_u32 m0, s20, 0x10400
    s_nop 0
    buffer_load_dwordx4 v3, s[4:7], s22 offen lds
    ds_read_b128 v[244:247], v4 offset:37888
    v_mul_f32 v200, v200, v9
    s_waitcnt lgkmcnt(3)
    v_mfma_f32_16x16x32_bf16 v[184:187], v[232:235], v[32:35], v[184:187]
    v_mul_f32 v201, v201, v9
    v_mfma_f32_16x16x32_bf16 v[188:191], v[232:235], v[36:39], v[188:191]
    ds_read_b128 v[224:227], v4 offset:38912
    v_mul_f32 v202, v202, v9
    s_waitcnt lgkmcnt(3)
    v_mfma_f32_16x16x32_bf16 v[192:195], v[236:239], v[32:35], v[192:195]
    v_mul_f32 v203, v203, v9
    v_mfma_f32_16x16x32_bf16 v[196:199], v[236:239], v[36:39], v[196:199]
    ds_read_b128 v[228:231], v4 offset:39936
    v_mul_f32 v208, v208, v9
    s_waitcnt lgkmcnt(3)
    v_mfma_f32_16x16x32_bf16 v[184:187], v[240:243], v[40:43], v[184:187]
    v_mul_f32 v209, v209, v9
    v_mfma_f32_16x16x32_bf16 v[188:191], v[240:243], v[44:47], v[188:191]
    ds_read_b128 v[232:235], v4 offset:40960
    v_mul_f32 v210, v210, v9
    s_waitcnt lgkmcnt(3)
    v_mfma_f32_16x16x32_bf16 v[192:195], v[244:247], v[40:43], v[192:195]
    v_mul_f32 v211, v211, v9
    v_mfma_f32_16x16x32_bf16 v[196:199], v[244:247], v[44:47], v[196:199]
    ds_read_b128 v[236:239], v4 offset:41984
    v_cvt_pk_bf16_f32 v216, v200, v201
    s_waitcnt lgkmcnt(3)
    v_mfma_f32_16x16x32_bf16 v[184:187], v[224:227], v[48:51], v[184:187]
    v_cvt_pk_bf16_f32 v217, v202, v203
    s_waitcnt vmcnt(4)
    s_add_u32 s16, s63, 0x570000
    v_mov_b32 v7, s28
    v_mov_b32 v8, 0
    s_mov_b64 exec, 1
    buffer_store_dword v7, v8, s[8:11], s16 offen sc1
    s_mov_b64 exec, -1
    v_mfma_f32_16x16x32_bf16 v[188:191], v[224:227], v[52:55], v[188:191]
    ds_read_b128 v[240:243], v4 offset:43008
    v_cvt_pk_bf16_f32 v218, v208, v209
    s_waitcnt lgkmcnt(3)
    v_mfma_f32_16x16x32_bf16 v[192:195], v[228:231], v[48:51], v[192:195]
    v_cvt_pk_bf16_f32 v219, v210, v211
    v_mfma_f32_16x16x32_bf16 v[196:199], v[228:231], v[52:55], v[196:199]
    ds_read_b128 v[244:247], v4 offset:44032
    buffer_store_dwordx4 v[216:219], v2, s[8:11], s25 offen offset:1024 sc1
    s_waitcnt lgkmcnt(3)
    v_mfma_f32_16x16x32_bf16 v[184:187], v[232:235], v[56:59], v[184:187]
    v_mul_f32 v204, v204, v10
    v_mfma_f32_16x16x32_bf16 v[188:191], v[232:235], v[60:63], v[188:191]
    ds_read_b128 v[224:227], v4 offset:45056
    v_mul_f32 v205, v205, v10
    s_waitcnt lgkmcnt(3)
    v_mfma_f32_16x16x32_bf16 v[192:195], v[236:239], v[56:59], v[192:195]
    v_mul_f32 v206, v206, v10
    v_mfma_f32_16x16x32_bf16 v[196:199], v[236:239], v[60:63], v[196:199]
    ds_read_b128 v[228:231], v4 offset:46080
    v_mul_f32 v207, v207, v10
    s_waitcnt lgkmcnt(3)
    v_mfma_f32_16x16x32_bf16 v[184:187], v[240:243], v[64:67], v[184:187]
    v_mul_f32 v212, v212, v10
    v_mfma_f32_16x16x32_bf16 v[188:191], v[240:243], v[68:71], v[188:191]
    ds_read_b128 v[232:235], v4 offset:47104
    v_mul_f32 v213, v213, v10
    s_waitcnt lgkmcnt(3)
    v_mfma_f32_16x16x32_bf16 v[192:195], v[244:247], v[64:67], v[192:195]
    v_mul_f32 v214, v214, v10
    v_mfma_f32_16x16x32_bf16 v[196:199], v[244:247], v[68:71], v[196:199]
    ds_read_b128 v[236:239], v4 offset:48128
    v_mul_f32 v215, v215, v10
    s_waitcnt lgkmcnt(3)
    v_mfma_f32_16x16x32_bf16 v[184:187], v[224:227], v[72:75], v[184:187]
    v_cvt_pk_bf16_f32 v220, v204, v205
    v_mfma_f32_16x16x32_bf16 v[188:191], v[224:227], v[76:79], v[188:191]
    s_barrier
    ds_read_b128 v[240:243], v4 offset:49152
    v_cvt_pk_bf16_f32 v221, v206, v207
    s_waitcnt lgkmcnt(3)
    v_mfma_f32_16x16x32_bf16 v[192:195], v[228:231], v[72:75], v[192:195]
    v_cvt_pk_bf16_f32 v222, v212, v213
    v_mfma_f32_16x16x32_bf16 v[196:199], v[228:231], v[76:79], v[196:199]
    s_add_u32 s22, s24, 0x80000
    s_add_u32 m0, s20, 0x14000
    s_nop 0
    buffer_load_dwordx4 v3, s[4:7], s22 offen lds
    ds_read_b128 v[244:247], v4 offset:50176
    v_cvt_pk_bf16_f32 v223, v214, v215
    s_waitcnt lgkmcnt(3)
    v_mfma_f32_16x16x32_bf16 v[184:187], v[232:235], v[80:83], v[184:187]
    buffer_store_dwordx4 v[220:223], v2, s[8:11], s26 offen offset:1024 sc1
    v_mfma_f32_16x16x32_bf16 v[188:191], v[232:235], v[84:87], v[188:191]
    ds_read_b128 v[224:227], v4 offset:51200
    s_waitcnt lgkmcnt(3)
    v_mfma_f32_16x16x32_bf16 v[192:195], v[236:239], v[80:83], v[192:195]
    v_mfma_f32_16x16x32_bf16 v[196:199], v[236:239], v[84:87], v[196:199]
    ds_read_b128 v[228:231], v4 offset:52224
    s_waitcnt lgkmcnt(3)
    v_mfma_f32_16x16x32_bf16 v[184:187], v[240:243], v[88:91], v[184:187]
    v_mfma_f32_16x16x32_bf16 v[188:191], v[240:243], v[92:95], v[188:191]
    ds_read_b128 v[232:235], v4 offset:53248
    s_waitcnt lgkmcnt(3)
    v_mfma_f32_16x16x32_bf16 v[192:195], v[244:247], v[88:91], v[192:195]
    v_mfma_f32_16x16x32_bf16 v[196:199], v[244:247], v[92:95], v[196:199]
    s_add_u32 s22, s24, 0x82000
    s_add_u32 m0, s20, 0x14400
    s_nop 0
    buffer_load_dwordx4 v3, s[4:7], s22 offen lds
    ds_read_b128 v[236:239], v4 offset:54272
    s_waitcnt lgkmcnt(3)
    v_mfma_f32_16x16x32_bf16 v[184:187], v[224:227], v[96:99], v[184:187]
    v_mfma_f32_16x16x32_bf16 v[188:191], v[224:227], v[100:103], v[188:191]
    ds_read_b128 v[240:243], v4 offset:55296
    s_waitcnt lgkmcnt(3)
    v_mfma_f32_16x16x32_bf16 v[192:195], v[228:231], v[96:99], v[192:195]
    v_mfma_f32_16x16x32_bf16 v[196:199], v[228:231], v[100:103], v[196:199]
    ds_read_b128 v[244:247], v4 offset:56320
    s_waitcnt lgkmcnt(3)
    v_mfma_f32_16x16x32_bf16 v[184:187], v[232:235], v[104:107], v[184:187]
    v_mfma_f32_16x16x32_bf16 v[188:191], v[232:235], v[108:111], v[188:191]
    ds_read_b128 v[224:227], v4 offset:57344
    s_waitcnt lgkmcnt(3)
    v_mfma_f32_16x16x32_bf16 v[192:195], v[236:239], v[104:107], v[192:195]
    v_mfma_f32_16x16x32_bf16 v[196:199], v[236:239], v[108:111], v[196:199]
    ds_read_b128 v[228:231], v4 offset:58368
    s_waitcnt lgkmcnt(3)
    v_mfma_f32_16x16x32_bf16 v[184:187], v[240:243], v[112:115], v[184:187]
    v_mfma_f32_16x16x32_bf16 v[188:191], v[240:243], v[116:119], v[188:191]
    ds_read_b128 v[232:235], v4 offset:59392
    s_waitcnt lgkmcnt(3)
    v_mfma_f32_16x16x32_bf16 v[192:195], v[244:247], v[112:115], v[192:195]
    v_mfma_f32_16x16x32_bf16 v[196:199], v[244:247], v[116:119], v[196:199]
    ds_read_b128 v[236:239], v4 offset:60416
    s_waitcnt lgkmcnt(3)
    v_mfma_f32_16x16x32_bf16 v[184:187], v[224:227], v[120:123], v[184:187]
    v_mfma_f32_16x16x32_bf16 v[188:191], v[224:227], v[124:127], v[188:191]
    ds_read_b128 v[240:243], v4 offset:61440
    s_waitcnt lgkmcnt(3)
    v_mfma_f32_16x16x32_bf16 v[192:195], v[228:231], v[120:123], v[192:195]
    v_mfma_f32_16x16x32_bf16 v[196:199], v[228:231], v[124:127], v[196:199]
    ds_read_b128 v[244:247], v4 offset:62464
    s_waitcnt lgkmcnt(3)
    v_mfma_f32_16x16x32_bf16 v[184:187], v[232:235], v[128:131], v[184:187]
    v_mfma_f32_16x16x32_bf16 v[188:191], v[232:235], v[132:135], v[188:191]
    ds_read_b128 v[224:227], v4 offset:63488
    s_waitcnt lgkmcnt(3)
    v_mfma_f32_16x16x32_bf16 v[192:195], v[236:239], v[128:131], v[192:195]
    v_mfma_f32_16x16x32_bf16 v[196:199], v[236:239], v[132:135], v[196:199]
    ds_read_b128 v[228:231], v4 offset:64512
    s_waitcnt lgkmcnt(3)
    v_mfma_f32_16x16x32_bf16 v[184:187], v[240:243], v[136:139], v[184:187]
    v_mfma_f32_16x16x32_bf16 v[188:191], v[240:243], v[140:143], v[188:191]
    s_barrier
    ds_read_b128 v[232:235], v5 offset:0
    s_waitcnt lgkmcnt(3)
    v_mfma_f32_16x16x32_bf16 v[192:195], v[244:247], v[136:139], v[192:195]
    v_mfma_f32_16x16x32_bf16 v[196:199], v[244:247], v[140:143], v[196:199]
    s_add_u32 s22, s24, 0x100000
    s_add_u32 m0, s20, 0x18000
    s_nop 0
    buffer_load_dwordx4 v3, s[4:7], s22 offen lds
    ds_read_b128 v[236:239], v5 offset:1024
    s_waitcnt lgkmcnt(3)
    v_mfma_f32_16x16x32_bf16 v[184:187], v[224:227], v[144:147], v[184:187]
    v_mfma_f32_16x16x32_bf16 v[188:191], v[224:227], v[148:151], v[188:191]
    ds_read_b128 v[240:243], v5 offset:2048
    s_waitcnt lgkmcnt(3)
    v_mfma_f32_16x16x32_bf16 v[192:195], v[228:231], v[144:147], v[192:195]
    v_mfma_f32_16x16x32_bf16 v[196:199], v[228:231], v[148:151], v[196:199]
    ds_read_b128 v[244:247], v5 offset:3072
    s_waitcnt lgkmcnt(3)
    v_mfma_f32_16x16x32_bf16 v[200:203], v[232:235], v[24:27], 0
    v_mfma_f32_16x16x32_bf16 v[204:207], v[232:235], v[28:31], 0
    ds_read_b128 v[224:227], v5 offset:4096
    s_waitcnt lgkmcnt(3)
    v_mfma_f32_16x16x32_bf16 v[208:211], v[236:239], v[24:27], 0
    v_mfma_f32_16x16x32_bf16 v[212:215], v[236:239], v[28:31], 0
    s_add_u32 s22, s24, 0x102000
    s_add_u32 m0, s20, 0x18400
    s_nop 0
    buffer_load_dwordx4 v3, s[4:7], s22 offen lds
    ds_read_b128 v[228:231], v5 offset:5120
    v_mul_f32 v184, v184, v9
    s_waitcnt lgkmcnt(3)
    v_mfma_f32_16x16x32_bf16 v[200:203], v[240:243], v[32:35], v[200:203]
    v_mul_f32 v185, v185, v9
    s_bfe_u32 s30, s2, 0x20001
    s_lshl_b32 s30, s30, 2
    s_bfe_u32 s17, s2, 0x20003
    s_add_u32 s30, s30, s17
    s_lshr_b32 s31, s2, 5
    s_and_b32 s17, s3, 3
    s_lshl_b32 s19, s30, 2
    s_add_u32 s19, s19, s17
    s_and_b32 s16, s2, 1
    s_lshl_b32 s17, s19, 18
    s_lshl_b32 s23, s16, 16
    s_add_u32 s17, s17, s23
    s_add_u32 s17, s17, 0x1000000
    v_add_u32 v6, s17, v2
    s_lshl_b32 s19, s19, 7
    s_lshl_b32 s23, s16, 6
    s_add_u32 s19, s19, s23
    s_add_u32 s19, s19, 0x570000
    v_and_b32 v13, 15, v1
    v_lshlrev_b32 v13, 2, v13
    buffer_load_dword v12, v13, s[8:11], s19 offen sc1
    v_mfma_f32_16x16x32_bf16 v[204:207], v[240:243], v[36:39], v[204:207]
    ds_read_b128 v[232:235], v5 offset:6144
    v_mul_f32 v186, v186, v9
    s_waitcnt lgkmcnt(3)
    v_mfma_f32_16x16x32_bf16 v[208:211], v[244:247], v[32:35], v[208:211]
    v_mul_f32 v187, v187, v9
    v_mfma_f32_16x16x32_bf16 v[212:215], v[244:247], v[36:39], v[212:215]
    ds_read_b128 v[236:239], v5 offset:7168
    v_mul_f32 v192, v192, v9
    s_waitcnt lgkmcnt(3)
    v_mfma_f32_16x16x32_bf16 v[200:203], v[224:227], v[40:43], v[200:203]
    v_mul_f32 v193, v193, v9
    v_mfma_f32_16x16x32_bf16 v[204:207], v[224:227], v[44:47], v[204:207]
    ds_read_b128 v[240:243], v5 offset:8192
    v_mul_f32 v194, v194, v9
    s_waitcnt lgkmcnt(3)
    v_mfma_f32_16x16x32_bf16 v[208:211], v[228:231], v[40:43], v[208:211]
    v_mul_f32 v195, v195, v9
    v_mfma_f32_16x16x32_bf16 v[212:215], v[228:231], v[44:47], v[212:215]
    ds_read_b128 v[244:247], v5 offset:9216
    v_cvt_pk_bf16_f32 v216, v184, v185
    s_waitcnt lgkmcnt(3)
    v_mfma_f32_16x16x32_bf16 v[200:203], v[232:235], v[48:51], v[200:203]
    v_cvt_pk_bf16_f32 v217, v186, v187
    v_mfma_f32_16x16x32_bf16 v[204:207], v[232:235], v[52:55], v[204:207]
    ds_read_b128 v[224:227], v5 offset:10240
    v_cvt_pk_bf16_f32 v218, v192, v193
    s_waitcnt lgkmcnt(3)
    v_mfma_f32_16x16x32_bf16 v[208:211], v[236:239], v[48:51], v[208:211]
    v_cvt_pk_bf16_f32 v219, v194, v195
    v_mfma_f32_16x16x32_bf16 v[212:215], v[236:239], v[52:55], v[212:215]
    ds_read_b128 v[228:231], v5 offset:11264
    buffer_store_dwordx4 v[216:219], v2, s[8:11], s25 offen offset:2048 sc1
    s_waitcnt lgkmcnt(3)
    v_mfma_f32_16x16x32_bf16 v[200:203], v[240:243], v[56:59], v[200:203]
    v_mul_f32 v188, v188, v10
    v_mfma_f32_16x16x32_bf16 v[204:207], v[240:243], v[60:63], v[204:207]
    ds_read_b128 v[232:235], v5 offset:12288
    v_mul_f32 v189, v189, v10
    s_waitcnt lgkmcnt(3)
    v_mfma_f32_16x16x32_bf16 v[208:211], v[244:247], v[56:59], v[208:211]
    v_mul_f32 v190, v190, v10
    v_mfma_f32_16x16x32_bf16 v[212:215], v[244:247], v[60:63], v[212:215]
    ds_read_b128 v[236:239], v5 offset:13312
    v_mul_f32 v191, v191, v10
    s_waitcnt lgkmcnt(3)
    v_mfma_f32_16x16x32_bf16 v[200:203], v[224:227], v[64:67], v[200:203]
    v_mul_f32 v196, v196, v10
    v_mfma_f32_16x16x32_bf16 v[204:207], v[224:227], v[68:71], v[204:207]
    ds_read_b128 v[240:243], v5 offset:14336
    v_mul_f32 v197, v197, v10
    s_waitcnt lgkmcnt(3)
    v_mfma_f32_16x16x32_bf16 v[208:211], v[228:231], v[64:67], v[208:211]
    v_mul_f32 v198, v198, v10
    v_mfma_f32_16x16x32_bf16 v[212:215], v[228:231], v[68:71], v[212:215]
    ds_read_b128 v[244:247], v5 offset:15360
    v_mul_f32 v199, v199, v10
    s_waitcnt lgkmcnt(3)
    v_mfma_f32_16x16x32_bf16 v[200:203], v[232:235], v[72:75], v[200:203]
    v_cvt_pk_bf16_f32 v220, v188, v189
    v_mfma_f32_16x16x32_bf16 v[204:207], v[232:235], v[76:79], v[204:207]
    s_waitcnt vmcnt(12)
    s_barrier
    ds_read_b128 v[224:227], v5 offset:16384
    v_cvt_pk_bf16_f32 v221, v190, v191
    s_waitcnt lgkmcnt(3)
    v_mfma_f32_16x16x32_bf16 v[208:211], v[236:239], v[72:75], v[208:211]
    v_cvt_pk_bf16_f32 v222, v196, v197
    v_mfma_f32_16x16x32_bf16 v[212:215], v[236:239], v[76:79], v[212:215]
    s_add_u32 s22, s24, 0x180000
    s_add_u32 m0, s20, 0x1c000
    s_nop 0
    buffer_load_dwordx4 v3, s[4:7], s22 offen lds
    ds_read_b128 v[228:231], v5 offset:17408
    v_cvt_pk_bf16_f32 v223, v198, v199
    s_waitcnt lgkmcnt(3)
    v_mfma_f32_16x16x32_bf16 v[200:203], v[240:243], v[80:83], v[200:203]
    buffer_store_dwordx4 v[220:223], v2, s[8:11], s26 offen offset:2048 sc1
    v_mfma_f32_16x16x32_bf16 v[204:207], v[240:243], v[84:87], v[204:207]
    ds_read_b128 v[232:235], v5 offset:18432
    s_waitcnt lgkmcnt(3)
    v_mfma_f32_16x16x32_bf16 v[208:211], v[244:247], v[80:83], v[208:211]
    v_mfma_f32_16x16x32_bf16 v[212:215], v[244:247], v[84:87], v[212:215]
    ds_read_b128 v[236:239], v5 offset:19456
    s_waitcnt lgkmcnt(3)
    v_mfma_f32_16x16x32_bf16 v[200:203], v[224:227], v[88:91], v[200:203]
    v_mfma_f32_16x16x32_bf16 v[204:207], v[224:227], v[92:95], v[204:207]
    ds_read_b128 v[240:243], v5 offset:20480
    s_waitcnt vmcnt(3)
    v_cmp_ne_u32 vcc, s28, v12
    s_cbranch_vccnz adaLN_cond__sliding_block_cached__moe_arch_mod__prompt_kernel_o6r
adaLN_cond__sliding_block_cached__moe_arch_mod__prompt_kernel_o6b:
    s_waitcnt lgkmcnt(3)
    v_mfma_f32_16x16x32_bf16 v[208:211], v[228:231], v[88:91], v[208:211]
    s_mov_b32 s23, 0x0
    buffer_load_dwordx4 v[24:27], v6, s[8:11], s23 offen offset:0 sc1
    v_mfma_f32_16x16x32_bf16 v[212:215], v[228:231], v[92:95], v[212:215]
    s_add_u32 s22, s24, 0x182000
    s_add_u32 m0, s20, 0x1c400
    s_nop 0
    buffer_load_dwordx4 v3, s[4:7], s22 offen lds
    ds_read_b128 v[244:247], v5 offset:21504
    s_waitcnt lgkmcnt(3)
    v_mfma_f32_16x16x32_bf16 v[200:203], v[232:235], v[96:99], v[200:203]
    v_mfma_f32_16x16x32_bf16 v[204:207], v[232:235], v[100:103], v[204:207]
    ds_read_b128 v[224:227], v5 offset:22528
    s_mov_b32 s23, 0x20000
    buffer_load_dwordx4 v[28:31], v6, s[8:11], s23 offen offset:0 sc1
    s_waitcnt lgkmcnt(3)
    v_mfma_f32_16x16x32_bf16 v[208:211], v[236:239], v[96:99], v[208:211]
    s_add_u32 s16, s63, 0x572000
    v_mov_b32 v14, s28
    v_mov_b32 v15, 0
    s_mov_b64 exec, 1
    buffer_store_dword v14, v15, s[8:11], s16 offen sc1
    s_mov_b64 exec, -1
    v_mfma_f32_16x16x32_bf16 v[212:215], v[236:239], v[100:103], v[212:215]
    ds_read_b128 v[228:231], v5 offset:23552
    s_waitcnt lgkmcnt(3)
    v_mfma_f32_16x16x32_bf16 v[200:203], v[240:243], v[104:107], v[200:203]
    v_mfma_f32_16x16x32_bf16 v[204:207], v[240:243], v[108:111], v[204:207]
    ds_read_b128 v[232:235], v5 offset:24576
    s_mov_b32 s23, 0x2000
    buffer_load_dwordx4 v[32:35], v6, s[8:11], s23 offen offset:0 sc1
    s_waitcnt lgkmcnt(3)
    v_mfma_f32_16x16x32_bf16 v[208:211], v[244:247], v[104:107], v[208:211]
    v_mfma_f32_16x16x32_bf16 v[212:215], v[244:247], v[108:111], v[212:215]
    ds_read_b128 v[236:239], v5 offset:25600
    s_waitcnt lgkmcnt(3)
    v_mfma_f32_16x16x32_bf16 v[200:203], v[224:227], v[112:115], v[200:203]
    s_mov_b32 s23, 0x22000
    buffer_load_dwordx4 v[36:39], v6, s[8:11], s23 offen offset:0 sc1
    v_mfma_f32_16x16x32_bf16 v[204:207], v[224:227], v[116:119], v[204:207]
    ds_read_b128 v[240:243], v5 offset:26624
    s_waitcnt lgkmcnt(3)
    v_mfma_f32_16x16x32_bf16 v[208:211], v[228:231], v[112:115], v[208:211]
    v_mfma_f32_16x16x32_bf16 v[212:215], v[228:231], v[116:119], v[212:215]
    ds_read_b128 v[244:247], v5 offset:27648
    s_waitcnt lgkmcnt(3)
    v_mfma_f32_16x16x32_bf16 v[200:203], v[232:235], v[120:123], v[200:203]
    s_mov_b32 s23, 0x4000
    buffer_load_dwordx4 v[40:43], v6, s[8:11], s23 offen offset:0 sc1
    v_mfma_f32_16x16x32_bf16 v[204:207], v[232:235], v[124:127], v[204:207]
    ds_read_b128 v[224:227], v5 offset:28672
    s_waitcnt lgkmcnt(3)
    v_mfma_f32_16x16x32_bf16 v[208:211], v[236:239], v[120:123], v[208:211]
    v_mfma_f32_16x16x32_bf16 v[212:215], v[236:239], v[124:127], v[212:215]
    ds_read_b128 v[228:231], v5 offset:29696
    s_waitcnt lgkmcnt(3)
    v_mfma_f32_16x16x32_bf16 v[200:203], v[240:243], v[128:131], v[200:203]
    s_mov_b32 s23, 0x24000
    buffer_load_dwordx4 v[44:47], v6, s[8:11], s23 offen offset:0 sc1
    v_mfma_f32_16x16x32_bf16 v[204:207], v[240:243], v[132:135], v[204:207]
    ds_read_b128 v[232:235], v5 offset:30720
    s_waitcnt lgkmcnt(3)
    v_mfma_f32_16x16x32_bf16 v[208:211], v[244:247], v[128:131], v[208:211]
    v_mfma_f32_16x16x32_bf16 v[212:215], v[244:247], v[132:135], v[212:215]
    ds_read_b128 v[236:239], v5 offset:31744
    s_mov_b32 s23, 0x6000
    buffer_load_dwordx4 v[48:51], v6, s[8:11], s23 offen offset:0 sc1
    s_waitcnt lgkmcnt(3)
    v_mfma_f32_16x16x32_bf16 v[200:203], v[224:227], v[136:139], v[200:203]
    v_bfe_u32 v18, v1, 2, 2
    v_lshrrev_b32 v19, 4, v1
    v_mfma_f32_16x16x32_bf16 v[204:207], v[224:227], v[140:143], v[204:207]
    v_and_b32 v17, 3, v1
    v_lshlrev_b32 v16, 11, v19
    s_waitcnt lgkmcnt(2)
    v_mfma_f32_16x16x32_bf16 v[208:211], v[228:231], v[136:139], v[208:211]
    v_lshl_add_u32 v16, v18, 6, v16
    v_lshl_add_u32 v16, v17, 3, v16
    v_mfma_f32_16x16x32_bf16 v[212:215], v[228:231], v[140:143], v[212:215]
    s_mov_b32 s23, 0x26000
    buffer_load_dwordx4 v[52:55], v6, s[8:11], s23 offen offset:0 sc1
    v_add_u32 v16, 0x10000, v16
    v_and_b32 v19, 1, v19
    s_waitcnt lgkmcnt(1)
    v_mfma_f32_16x16x32_bf16 v[200:203], v[232:235], v[144:147], v[200:203]
    v_lshlrev_b32 v19, 5, v19
    v_sub_u32 v5, v16, v19
    v_mfma_f32_16x16x32_bf16 v[204:207], v[232:235], v[148:151], v[204:207]
    v_add_u32 v4, v16, v19
    v_add_u32 v7, 0x10000, v4
    s_waitcnt lgkmcnt(0)
    v_mfma_f32_16x16x32_bf16 v[208:211], v[236:239], v[144:147], v[208:211]
    v_add_u32 v8, 0x10000, v5
    v_mfma_f32_16x16x32_bf16 v[212:215], v[236:239], v[148:151], v[212:215]
    v_mul_f32 v200, v200, v9
    v_mul_f32 v201, v201, v9
    v_mul_f32 v202, v202, v9
    v_mul_f32 v203, v203, v9
    s_nop 1
    v_mul_f32 v208, v208, v9
    v_mul_f32 v209, v209, v9
    v_mul_f32 v210, v210, v9
    v_mul_f32 v211, v211, v9
    v_cvt_pk_bf16_f32 v216, v200, v201
    v_cvt_pk_bf16_f32 v217, v202, v203
    v_cvt_pk_bf16_f32 v218, v208, v209
    v_cvt_pk_bf16_f32 v219, v210, v211
    buffer_store_dwordx4 v[216:219], v2, s[8:11], s25 offen offset:3072 sc1
    v_mul_f32 v204, v204, v10
    v_mul_f32 v205, v205, v10
    v_mul_f32 v206, v206, v10
    v_mul_f32 v207, v207, v10
    v_mul_f32 v212, v212, v10
    v_mul_f32 v213, v213, v10
    v_mul_f32 v214, v214, v10
    v_mul_f32 v215, v215, v10
    v_cvt_pk_bf16_f32 v220, v204, v205
    v_cvt_pk_bf16_f32 v221, v206, v207
    v_cvt_pk_bf16_f32 v222, v212, v213
    v_cvt_pk_bf16_f32 v223, v214, v215
    buffer_store_dwordx4 v[220:223], v2, s[8:11], s26 offen offset:3072 sc1
    s_and_b32 s15, s2, 1
    s_barrier
    ds_read_b64_tr_b16 v[224:225], v4 offset:0
    ds_read_b64_tr_b16 v[226:227], v4 offset:1024
    ds_read_b64_tr_b16 v[228:229], v5 offset:32
    ds_read_b64_tr_b16 v[230:231], v5 offset:1056
    ds_read_b64_tr_b16 v[232:233], v4 offset:256
    ds_read_b64_tr_b16 v[234:235], v4 offset:1280
    ds_read_b64_tr_b16 v[236:237], v5 offset:288
    ds_read_b64_tr_b16 v[238:239], v5 offset:1312
    s_waitcnt vmcnt(11) lgkmcnt(6)
    v_mfma_f32_16x16x32_bf16 v[88:91], v[224:227], v[24:27], 0
    ds_read_b64_tr_b16 v[240:241], v4 offset:512
    s_waitcnt vmcnt(9)
    v_mfma_f32_16x16x32_bf16 v[92:95], v[224:227], v[28:31], 0
    s_add_u32 s22, s24, 0x200000
    s_add_u32 m0, s20, 0x20000
    s_nop 0
    buffer_load_dwordx4 v3, s[4:7], s22 offen lds
    ds_read_b64_tr_b16 v[242:243], v4 offset:1536
    s_waitcnt lgkmcnt(6)
    v_mfma_f32_16x16x32_bf16 v[96:99], v[228:231], v[24:27], 0
    ds_read_b64_tr_b16 v[244:245], v5 offset:544
    s_mov_b32 s23, 0x8000
    buffer_load_dwordx4 v[56:59], v6, s[8:11], s23 offen offset:0 sc1
    v_mfma_f32_16x16x32_bf16 v[100:103], v[228:231], v[28:31], 0
    ds_read_b64_tr_b16 v[246:247], v5 offset:1568
    s_waitcnt lgkmcnt(6)
    v_mfma_f32_16x16x32_bf16 v[104:107], v[232:235], v[24:27], 0
    s_add_u32 s22, s24, 0x202000
    s_add_u32 m0, s20, 0x20400
    s_nop 0
    buffer_load_dwordx4 v3, s[4:7], s22 offen lds
    ds_read_b64_tr_b16 v[224:225], v4 offset:768
    v_mfma_f32_16x16x32_bf16 v[108:111], v[232:235], v[28:31], 0
    ds_read_b64_tr_b16 v[226:227], v4 offset:1792
    s_mov_b32 s23, 0x28000
    buffer_load_dwordx4 v[60:63], v6, s[8:11], s23 offen offset:0 sc1
    s_waitcnt lgkmcnt(6)
    v_mfma_f32_16x16x32_bf16 v[112:115], v[236:239], v[24:27], 0
    ds_read_b64_tr_b16 v[228:229], v5 offset:800
    v_mfma_f32_16x16x32_bf16 v[116:119], v[236:239], v[28:31], 0
    ds_read_b64_tr_b16 v[230:231], v5 offset:1824
    s_waitcnt lgkmcnt(6)
    v_mfma_f32_16x16x32_bf16 v[120:123], v[240:243], v[24:27], 0
    v_mfma_f32_16x16x32_bf16 v[124:127], v[240:243], v[28:31], 0
    s_barrier
    ds_read_b64_tr_b16 v[232:233], v4 offset:16384
    ds_read_b64_tr_b16 v[234:235], v4 offset:17408
    s_waitcnt lgkmcnt(6)
    v_mfma_f32_16x16x32_bf16 v[128:131], v[244:247], v[24:27], 0
    s_add_u32 s22, s24, 0x280000
    s_add_u32 m0, s20, 0x24000
    s_nop 0
    buffer_load_dwordx4 v3, s[4:7], s22 offen lds
    ds_read_b64_tr_b16 v[236:237], v5 offset:16416
    v_mfma_f32_16x16x32_bf16 v[132:135], v[244:247], v[28:31], 0
    ds_read_b64_tr_b16 v[238:239], v5 offset:17440
    s_waitcnt lgkmcnt(6)
    v_mfma_f32_16x16x32_bf16 v[136:139], v[224:227], v[24:27], 0
    ds_read_b64_tr_b16 v[240:241], v4 offset:16640
    v_mfma_f32_16x16x32_bf16 v[140:143], v[224:227], v[28:31], 0
    s_add_u32 s22, s24, 0x282000
    s_add_u32 m0, s20, 0x24400
    s_nop 0
    buffer_load_dwordx4 v3, s[4:7], s22 offen lds
    ds_read_b64_tr_b16 v[242:243], v4 offset:17664
    s_waitcnt lgkmcnt(6)
    v_mfma_f32_16x16x32_bf16 v[144:147], v[228:231], v[24:27], 0
    ds_read_b64_tr_b16 v[244:245], v5 offset:16672
    v_mfma_f32_16x16x32_bf16 v[148:151], v[228:231], v[28:31], 0
    ds_read_b64_tr_b16 v[246:247], v5 offset:17696
    s_waitcnt vmcnt(13) lgkmcnt(6)
    v_mfma_f32_16x16x32_bf16 v[88:91], v[232:235], v[32:35], v[88:91]
    ds_read_b64_tr_b16 v[224:225], v4 offset:16896
    s_waitcnt vmcnt(12)
    v_mfma_f32_16x16x32_bf16 v[92:95], v[232:235], v[36:39], v[92:95]
    ds_read_b64_tr_b16 v[226:227], v4 offset:17920
    s_waitcnt lgkmcnt(6)
    v_mfma_f32_16x16x32_bf16 v[96:99], v[236:239], v[32:35], v[96:99]
    ds_read_b64_tr_b16 v[228:229], v5 offset:16928
    s_mov_b32 s23, 0xa000
    buffer_load_dwordx4 v[24:27], v6, s[8:11], s23 offen offset:0 sc1
    v_mfma_f32_16x16x32_bf16 v[100:103], v[236:239], v[36:39], v[100:103]
    ds_read_b64_tr_b16 v[230:231], v5 offset:17952
    s_waitcnt lgkmcnt(6)
    v_mfma_f32_16x16x32_bf16 v[104:107], v[240:243], v[32:35], v[104:107]
    ds_read_b64_tr_b16 v[232:233], v4 offset:17152
    v_mfma_f32_16x16x32_bf16 v[108:111], v[240:243], v[36:39], v[108:111]
    ds_read_b64_tr_b16 v[234:235], v4 offset:18176
    s_mov_b32 s23, 0x2a000
    buffer_load_dwordx4 v[28:31], v6, s[8:11], s23 offen offset:0 sc1
    s_waitcnt lgkmcnt(6)
    v_mfma_f32_16x16x32_bf16 v[112:115], v[244:247], v[32:35], v[112:115]
    ds_read_b64_tr_b16 v[236:237], v5 offset:17184
    v_mfma_f32_16x16x32_bf16 v[116:119], v[244:247], v[36:39], v[116:119]
    ds_read_b64_tr_b16 v[238:239], v5 offset:18208
    s_waitcnt lgkmcnt(6)
    v_mfma_f32_16x16x32_bf16 v[120:123], v[224:227], v[32:35], v[120:123]
    v_mfma_f32_16x16x32_bf16 v[124:127], v[224:227], v[36:39], v[124:127]
    s_barrier
    ds_read_b64_tr_b16 v[240:241], v4 offset:32768
    ds_read_b64_tr_b16 v[242:243], v4 offset:33792
    s_waitcnt lgkmcnt(6)
    v_mfma_f32_16x16x32_bf16 v[128:131], v[228:231], v[32:35], v[128:131]
    s_add_u32 s22, s24, 0x300000
    s_add_u32 m0, s20, 0x10000
    s_nop 0
    buffer_load_dwordx4 v3, s[4:7], s22 offen lds
    ds_read_b64_tr_b16 v[244:245], v5 offset:32800
    v_mfma_f32_16x16x32_bf16 v[132:135], v[228:231], v[36:39], v[132:135]
    ds_read_b64_tr_b16 v[246:247], v5 offset:33824
    s_waitcnt lgkmcnt(6)
    v_mfma_f32_16x16x32_bf16 v[136:139], v[232:235], v[32:35], v[136:139]
    ds_read_b64_tr_b16 v[224:225], v4 offset:33024
    v_mfma_f32_16x16x32_bf16 v[140:143], v[232:235], v[36:39], v[140:143]
    s_add_u32 s22, s24, 0x302000
    s_add_u32 m0, s20, 0x10400
    s_nop 0
    buffer_load_dwordx4 v3, s[4:7], s22 offen lds
    ds_read_b64_tr_b16 v[226:227], v4 offset:34048
    s_waitcnt lgkmcnt(6)
    v_mfma_f32_16x16x32_bf16 v[144:147], v[236:239], v[32:35], v[144:147]
    s_add_u32 s16, s63, 0x574000
    v_mov_b32 v14, s28
    v_mov_b32 v15, 0
    s_mov_b64 exec, 1
    buffer_store_dword v14, v15, s[8:11], s16 offen sc1
    s_mov_b64 exec, -1
    ds_read_b64_tr_b16 v[228:229], v5 offset:33056
    v_mfma_f32_16x16x32_bf16 v[148:151], v[236:239], v[36:39], v[148:151]
    ds_read_b64_tr_b16 v[230:231], v5 offset:34080
    s_waitcnt vmcnt(16) lgkmcnt(6)
    v_mfma_f32_16x16x32_bf16 v[88:91], v[240:243], v[40:43], v[88:91]
    ds_read_b64_tr_b16 v[232:233], v4 offset:33280
    s_waitcnt vmcnt(15)
    v_mfma_f32_16x16x32_bf16 v[92:95], v[240:243], v[44:47], v[92:95]
    ds_read_b64_tr_b16 v[234:235], v4 offset:34304
    s_waitcnt lgkmcnt(6)
    v_mfma_f32_16x16x32_bf16 v[96:99], v[244:247], v[40:43], v[96:99]
    ds_read_b64_tr_b16 v[236:237], v5 offset:33312
    s_mov_b32 s23, 0xc000
    buffer_load_dwordx4 v[32:35], v6, s[8:11], s23 offen offset:0 sc1
    v_mfma_f32_16x16x32_bf16 v[100:103], v[244:247], v[44:47], v[100:103]
    ds_read_b64_tr_b16 v[238:239], v5 offset:34336
    s_waitcnt lgkmcnt(6)
    v_mfma_f32_16x16x32_bf16 v[104:107], v[224:227], v[40:43], v[104:107]
    ds_read_b64_tr_b16 v[240:241], v4 offset:33536
    v_mfma_f32_16x16x32_bf16 v[108:111], v[224:227], v[44:47], v[108:111]
    ds_read_b64_tr_b16 v[242:243], v4 offset:34560
    s_mov_b32 s23, 0x2c000
    buffer_load_dwordx4 v[36:39], v6, s[8:11], s23 offen offset:0 sc1
    s_waitcnt lgkmcnt(6)
    v_mfma_f32_16x16x32_bf16 v[112:115], v[228:231], v[40:43], v[112:115]
    ds_read_b64_tr_b16 v[244:245], v5 offset:33568
    v_mfma_f32_16x16x32_bf16 v[116:119], v[228:231], v[44:47], v[116:119]
    ds_read_b64_tr_b16 v[246:247], v5 offset:34592
    s_waitcnt lgkmcnt(6)
    v_mfma_f32_16x16x32_bf16 v[120:123], v[232:235], v[40:43], v[120:123]
    v_mfma_f32_16x16x32_bf16 v[124:127], v[232:235], v[44:47], v[124:127]
    s_barrier
    ds_read_b64_tr_b16 v[224:225], v4 offset:49152
    ds_read_b64_tr_b16 v[226:227], v4 offset:50176
    s_add_u32 s19, s19, 8192
    buffer_load_dword v12, v13, s[8:11], s19 offen sc1
    s_waitcnt lgkmcnt(6)
    v_mfma_f32_16x16x32_bf16 v[128:131], v[236:239], v[40:43], v[128:131]
    s_add_u32 s22, s24, 0x380000
    s_add_u32 m0, s20, 0x14000
    s_nop 0
    buffer_load_dwordx4 v3, s[4:7], s22 offen lds
    ds_read_b64_tr_b16 v[228:229], v5 offset:49184
    v_mfma_f32_16x16x32_bf16 v[132:135], v[236:239], v[44:47], v[132:135]
    ds_read_b64_tr_b16 v[230:231], v5 offset:50208
    s_waitcnt lgkmcnt(6)
    v_mfma_f32_16x16x32_bf16 v[136:139], v[240:243], v[40:43], v[136:139]
    ds_read_b64_tr_b16 v[232:233], v4 offset:49408
    v_mfma_f32_16x16x32_bf16 v[140:143], v[240:243], v[44:47], v[140:143]
    s_add_u32 s22, s24, 0x382000
    s_add_u32 m0, s20, 0x14400
    s_nop 0
    buffer_load_dwordx4 v3, s[4:7], s22 offen lds
    ds_read_b64_tr_b16 v[234:235], v4 offset:50432
    s_waitcnt lgkmcnt(6)
    v_mfma_f32_16x16x32_bf16 v[144:147], v[244:247], v[40:43], v[144:147]
    ds_read_b64_tr_b16 v[236:237], v5 offset:49440
    v_mfma_f32_16x16x32_bf16 v[148:151], v[244:247], v[44:47], v[148:151]
    ds_read_b64_tr_b16 v[238:239], v5 offset:50464
    s_waitcnt vmcnt(19) lgkmcnt(6)
    v_mfma_f32_16x16x32_bf16 v[88:91], v[224:227], v[48:51], v[88:91]
    ds_read_b64_tr_b16 v[240:241], v4 offset:49664
    s_waitcnt vmcnt(18)
    v_mfma_f32_16x16x32_bf16 v[92:95], v[224:227], v[52:55], v[92:95]
    ds_read_b64_tr_b16 v[242:243], v4 offset:50688
    s_waitcnt lgkmcnt(6)
    v_mfma_f32_16x16x32_bf16 v[96:99], v[228:231], v[48:51], v[96:99]
    ds_read_b64_tr_b16 v[244:245], v5 offset:49696
    s_mov_b32 s23, 0xe000
    buffer_load_dwordx4 v[40:43], v6, s[8:11], s23 offen offset:0 sc1
    v_mfma_f32_16x16x32_bf16 v[100:103], v[228:231], v[52:55], v[100:103]
    ds_read_b64_tr_b16 v[246:247], v5 offset:50720
    s_waitcnt lgkmcnt(6)
    v_mfma_f32_16x16x32_bf16 v[104:107], v[232:235], v[48:51], v[104:107]
    ds_read_b64_tr_b16 v[224:225], v4 offset:49920
    v_mfma_f32_16x16x32_bf16 v[108:111], v[232:235], v[52:55], v[108:111]
    ds_read_b64_tr_b16 v[226:227], v4 offset:50944
    s_mov_b32 s23, 0x2e000
    buffer_load_dwordx4 v[44:47], v6, s[8:11], s23 offen offset:0 sc1
    s_waitcnt lgkmcnt(6)
    v_mfma_f32_16x16x32_bf16 v[112:115], v[236:239], v[48:51], v[112:115]
    ds_read_b64_tr_b16 v[228:229], v5 offset:49952
    v_mfma_f32_16x16x32_bf16 v[116:119], v[236:239], v[52:55], v[116:119]
    ds_read_b64_tr_b16 v[230:231], v5 offset:50976
    s_waitcnt lgkmcnt(6)
    v_mfma_f32_16x16x32_bf16 v[120:123], v[240:243], v[48:51], v[120:123]
    v_mfma_f32_16x16x32_bf16 v[124:127], v[240:243], v[52:55], v[124:127]
    s_waitcnt vmcnt(15)
    s_barrier
    ds_read_b64_tr_b16 v[232:233], v7 offset:0
    ds_read_b64_tr_b16 v[234:235], v7 offset:1024
    s_waitcnt lgkmcnt(6)
    v_mfma_f32_16x16x32_bf16 v[128:131], v[244:247], v[48:51], v[128:131]
    s_add_u32 s22, s24, 0x10000
    s_add_u32 m0, s20, 0x18000
    s_nop 0
    buffer_load_dwordx4 v3, s[4:7], s22 offen lds
    ds_read_b64_tr_b16 v[236:237], v8 offset:32
    v_mfma_f32_16x16x32_bf16 v[132:135], v[244:247], v[52:55], v[132:135]
    ds_read_b64_tr_b16 v[238:239], v8 offset:1056
    s_waitcnt lgkmcnt(6)
    v_mfma_f32_16x16x32_bf16 v[136:139], v[224:227], v[48:51], v[136:139]
    ds_read_b64_tr_b16 v[240:241], v7 offset:256
    v_mfma_f32_16x16x32_bf16 v[140:143], v[224:227], v[52:55], v[140:143]
    s_add_u32 s22, s24, 0x12000
    s_add_u32 m0, s20, 0x18400
    s_nop 0
    buffer_load_dwordx4 v3, s[4:7], s22 offen lds
    ds_read_b64_tr_b16 v[242:243], v7 offset:1280
    s_waitcnt lgkmcnt(6)
    v_mfma_f32_16x16x32_bf16 v[144:147], v[228:231], v[48:51], v[144:147]
    ds_read_b64_tr_b16 v[244:245], v8 offset:288
    v_mfma_f32_16x16x32_bf16 v[148:151], v[228:231], v[52:55], v[148:151]
    ds_read_b64_tr_b16 v[246:247], v8 offset:1312
    s_waitcnt vmcnt(6)
    v_cmp_ne_u32 vcc, s28, v12
    s_cbranch_vccnz adaLN_cond__sliding_block_cached__moe_arch_mod__prompt_kernel_o27r
adaLN_cond__sliding_block_cached__moe_arch_mod__prompt_kernel_o27b:
    s_waitcnt lgkmcnt(6)
    v_mfma_f32_16x16x32_bf16 v[88:91], v[232:235], v[56:59], v[88:91]
    ds_read_b64_tr_b16 v[224:225], v7 offset:512
    v_mfma_f32_16x16x32_bf16 v[92:95], v[232:235], v[60:63], v[92:95]
    ds_read_b64_tr_b16 v[226:227], v7 offset:1536
    s_waitcnt lgkmcnt(6)
    v_mfma_f32_16x16x32_bf16 v[96:99], v[236:239], v[56:59], v[96:99]
    ds_read_b64_tr_b16 v[228:229], v8 offset:544
    s_mov_b32 s23, 0x0
    buffer_load_dwordx4 v[48:51], v6, s[8:11], s23 offen offset:1024 sc1
    v_mfma_f32_16x16x32_bf16 v[100:103], v[236:239], v[60:63], v[100:103]
    ds_read_b64_tr_b16 v[230:231], v8 offset:1568
    s_waitcnt lgkmcnt(6)
    v_mfma_f32_16x16x32_bf16 v[104:107], v[240:243], v[56:59], v[104:107]
    ds_read_b64_tr_b16 v[232:233], v7 offset:768
    v_mfma_f32_16x16x32_bf16 v[108:111], v[240:243], v[60:63], v[108:111]
    ds_read_b64_tr_b16 v[234:235], v7 offset:1792
    s_mov_b32 s23, 0x20000
    buffer_load_dwordx4 v[52:55], v6, s[8:11], s23 offen offset:1024 sc1
    s_waitcnt lgkmcnt(6)
    v_mfma_f32_16x16x32_bf16 v[112:115], v[244:247], v[56:59], v[112:115]
    ds_read_b64_tr_b16 v[236:237], v8 offset:800
    v_mfma_f32_16x16x32_bf16 v[116:119], v[244:247], v[60:63], v[116:119]
    ds_read_b64_tr_b16 v[238:239], v8 offset:1824
    s_waitcnt lgkmcnt(6)
    v_mfma_f32_16x16x32_bf16 v[120:123], v[224:227], v[56:59], v[120:123]
    v_mfma_f32_16x16x32_bf16 v[124:127], v[224:227], v[60:63], v[124:127]
    s_barrier
    ds_read_b64_tr_b16 v[240:241], v7 offset:16384
    ds_read_b64_tr_b16 v[242:243], v7 offset:17408
    s_waitcnt lgkmcnt(6)
    v_mfma_f32_16x16x32_bf16 v[128:131], v[228:231], v[56:59], v[128:131]
    s_add_u32 s22, s24, 0x90000
    s_add_u32 m0, s20, 0x1c000
    s_nop 0
    buffer_load_dwordx4 v3, s[4:7], s22 offen lds
    ds_read_b64_tr_b16 v[244:245], v8 offset:16416
    v_mfma_f32_16x16x32_bf16 v[132:135], v[228:231], v[60:63], v[132:135]
    ds_read_b64_tr_b16 v[246:247], v8 offset:17440
    s_waitcnt lgkmcnt(6)
    v_mfma_f32_16x16x32_bf16 v[136:139], v[232:235], v[56:59], v[136:139]
    ds_read_b64_tr_b16 v[224:225], v7 offset:16640
    v_mfma_f32_16x16x32_bf16 v[140:143], v[232:235], v[60:63], v[140:143]
    s_add_u32 s22, s24, 0x92000
    s_add_u32 m0, s20, 0x1c400
    s_nop 0
    buffer_load_dwordx4 v3, s[4:7], s22 offen lds
    ds_read_b64_tr_b16 v[226:227], v7 offset:17664
    s_waitcnt lgkmcnt(6)
    v_mfma_f32_16x16x32_bf16 v[144:147], v[236:239], v[56:59], v[144:147]
    ds_read_b64_tr_b16 v[228:229], v8 offset:16672
    v_mfma_f32_16x16x32_bf16 v[148:151], v[236:239], v[60:63], v[148:151]
    ds_read_b64_tr_b16 v[230:231], v8 offset:17696
    s_waitcnt lgkmcnt(6)
    v_mfma_f32_16x16x32_bf16 v[88:91], v[240:243], v[24:27], v[88:91]
    ds_read_b64_tr_b16 v[232:233], v7 offset:16896
    v_mfma_f32_16x16x32_bf16 v[92:95], v[240:243], v[28:31], v[92:95]
    ds_read_b64_tr_b16 v[234:235], v7 offset:17920
    s_waitcnt lgkmcnt(6)
    v_mfma_f32_16x16x32_bf16 v[96:99], v[244:247], v[24:27], v[96:99]
    ds_read_b64_tr_b16 v[236:237], v8 offset:16928
    s_mov_b32 s23, 0x2000
    buffer_load_dwordx4 v[56:59], v6, s[8:11], s23 offen offset:1024 sc1
    v_mfma_f32_16x16x32_bf16 v[100:103], v[244:247], v[28:31], v[100:103]
    ds_read_b64_tr_b16 v[238:239], v8 offset:17952
    s_waitcnt lgkmcnt(6)
    v_mfma_f32_16x16x32_bf16 v[104:107], v[224:227], v[24:27], v[104:107]
    ds_read_b64_tr_b16 v[240:241], v7 offset:17152
    v_mfma_f32_16x16x32_bf16 v[108:111], v[224:227], v[28:31], v[108:111]
    ds_read_b64_tr_b16 v[242:243], v7 offset:18176
    s_mov_b32 s23, 0x22000
    buffer_load_dwordx4 v[60:63], v6, s[8:11], s23 offen offset:1024 sc1
    s_waitcnt lgkmcnt(6)
    v_mfma_f32_16x16x32_bf16 v[112:115], v[228:231], v[24:27], v[112:115]
    ds_read_b64_tr_b16 v[244:245], v8 offset:17184
    v_mfma_f32_16x16x32_bf16 v[116:119], v[228:231], v[28:31], v[116:119]
    ds_read_b64_tr_b16 v[246:247], v8 offset:18208
    s_waitcnt lgkmcnt(6)
    v_mfma_f32_16x16x32_bf16 v[120:123], v[232:235], v[24:27], v[120:123]
    v_mfma_f32_16x16x32_bf16 v[124:127], v[232:235], v[28:31], v[124:127]
    s_barrier
    ds_read_b64_tr_b16 v[224:225], v4 offset:0
    ds_read_b64_tr_b16 v[226:227], v4 offset:1024
    s_waitcnt lgkmcnt(6)
    v_mfma_f32_16x16x32_bf16 v[128:131], v[236:239], v[24:27], v[128:131]
    s_add_u32 s16, s63, 0x576000
    v_mov_b32 v14, s28
    v_mov_b32 v15, 0
    s_mov_b64 exec, 1
    buffer_store_dword v14, v15, s[8:11], s16 offen sc1
    s_mov_b64 exec, -1
    s_add_u32 s22, s24, 0x110000
    s_add_u32 m0, s20, 0x20000
    s_nop 0
    buffer_load_dwordx4 v3, s[4:7], s22 offen lds
    ds_read_b64_tr_b16 v[228:229], v5 offset:32
    v_mfma_f32_16x16x32_bf16 v[132:135], v[236:239], v[28:31], v[132:135]
    ds_read_b64_tr_b16 v[230:231], v5 offset:1056
    s_waitcnt lgkmcnt(6)
    v_mfma_f32_16x16x32_bf16 v[136:139], v[240:243], v[24:27], v[136:139]
    ds_read_b64_tr_b16 v[232:233], v4 offset:256
    v_mfma_f32_16x16x32_bf16 v[140:143], v[240:243], v[28:31], v[140:143]
    s_add_u32 s22, s24, 0x112000
    s_add_u32 m0, s20, 0x20400
    s_nop 0
    buffer_load_dwordx4 v3, s[4:7], s22 offen lds
    ds_read_b64_tr_b16 v[234:235], v4 offset:1280
    s_waitcnt lgkmcnt(6)
    v_mfma_f32_16x16x32_bf16 v[144:147], v[244:247], v[24:27], v[144:147]
    ds_read_b64_tr_b16 v[236:237], v5 offset:288
    v_mfma_f32_16x16x32_bf16 v[148:151], v[244:247], v[28:31], v[148:151]
    ds_read_b64_tr_b16 v[238:239], v5 offset:1312
    s_waitcnt lgkmcnt(6)
    v_mfma_f32_16x16x32_bf16 v[88:91], v[224:227], v[32:35], v[88:91]
    ds_read_b64_tr_b16 v[240:241], v4 offset:512
    v_mfma_f32_16x16x32_bf16 v[92:95], v[224:227], v[36:39], v[92:95]
    ds_read_b64_tr_b16 v[242:243], v4 offset:1536
    s_waitcnt lgkmcnt(6)
    v_mfma_f32_16x16x32_bf16 v[96:99], v[228:231], v[32:35], v[96:99]
    ds_read_b64_tr_b16 v[244:245], v5 offset:544
    s_mov_b32 s23, 0x4000
    buffer_load_dwordx4 v[24:27], v6, s[8:11], s23 offen offset:1024 sc1
    v_mfma_f32_16x16x32_bf16 v[100:103], v[228:231], v[36:39], v[100:103]
    ds_read_b64_tr_b16 v[246:247], v5 offset:1568
    s_waitcnt lgkmcnt(6)
    v_mfma_f32_16x16x32_bf16 v[104:107], v[232:235], v[32:35], v[104:107]
    ds_read_b64_tr_b16 v[224:225], v4 offset:768
    v_mfma_f32_16x16x32_bf16 v[108:111], v[232:235], v[36:39], v[108:111]
    ds_read_b64_tr_b16 v[226:227], v4 offset:1792
    s_mov_b32 s23, 0x24000
    buffer_load_dwordx4 v[28:31], v6, s[8:11], s23 offen offset:1024 sc1
    s_waitcnt lgkmcnt(6)
    v_mfma_f32_16x16x32_bf16 v[112:115], v[236:239], v[32:35], v[112:115]
    ds_read_b64_tr_b16 v[228:229], v5 offset:800
    v_mfma_f32_16x16x32_bf16 v[116:119], v[236:239], v[36:39], v[116:119]
    ds_read_b64_tr_b16 v[230:231], v5 offset:1824
    s_waitcnt lgkmcnt(6)
    v_mfma_f32_16x16x32_bf16 v[120:123], v[240:243], v[32:35], v[120:123]
    v_mfma_f32_16x16x32_bf16 v[124:127], v[240:243], v[36:39], v[124:127]
    s_waitcnt vmcnt(15)
    s_barrier
    ds_read_b64_tr_b16 v[232:233], v4 offset:16384
    ds_read_b64_tr_b16 v[234:235], v4 offset:17408
    s_waitcnt lgkmcnt(6)
    v_mfma_f32_16x16x32_bf16 v[128:131], v[244:247], v[32:35], v[128:131]
    s_add_u32 s22, s24, 0x190000
    s_add_u32 m0, s20, 0x24000
    s_nop 0
    buffer_load_dwordx4 v3, s[4:7], s22 offen lds
    ds_read_b64_tr_b16 v[236:237], v5 offset:16416
    v_mfma_f32_16x16x32_bf16 v[132:135], v[244:247], v[36:39], v[132:135]
    ds_read_b64_tr_b16 v[238:239], v5 offset:17440
    s_waitcnt lgkmcnt(6)
    v_mfma_f32_16x16x32_bf16 v[136:139], v[224:227], v[32:35], v[136:139]
    ds_read_b64_tr_b16 v[240:241], v4 offset:16640
    v_mfma_f32_16x16x32_bf16 v[140:143], v[224:227], v[36:39], v[140:143]
    s_add_u32 s22, s24, 0x192000
    s_add_u32 m0, s20, 0x24400
    s_nop 0
    buffer_load_dwordx4 v3, s[4:7], s22 offen lds
    ds_read_b64_tr_b16 v[242:243], v4 offset:17664
    s_waitcnt lgkmcnt(6)
    v_mfma_f32_16x16x32_bf16 v[144:147], v[228:231], v[32:35], v[144:147]
    ds_read_b64_tr_b16 v[244:245], v5 offset:16672
    v_mfma_f32_16x16x32_bf16 v[148:151], v[228:231], v[36:39], v[148:151]
    ds_read_b64_tr_b16 v[246:247], v5 offset:17696
    s_waitcnt vmcnt(16) lgkmcnt(6)
    v_mfma_f32_16x16x32_bf16 v[88:91], v[232:235], v[40:43], v[88:91]
    ds_read_b64_tr_b16 v[224:225], v4 offset:16896
    s_waitcnt vmcnt(15)
    v_mfma_f32_16x16x32_bf16 v[92:95], v[232:235], v[44:47], v[92:95]
    ds_read_b64_tr_b16 v[226:227], v4 offset:17920
    s_waitcnt lgkmcnt(6)
    v_mfma_f32_16x16x32_bf16 v[96:99], v[236:239], v[40:43], v[96:99]
    ds_read_b64_tr_b16 v[228:229], v5 offset:16928
    s_mov_b32 s23, 0x6000
    buffer_load_dwordx4 v[32:35], v6, s[8:11], s23 offen offset:1024 sc1
    v_mfma_f32_16x16x32_bf16 v[100:103], v[236:239], v[44:47], v[100:103]
    ds_read_b64_tr_b16 v[230:231], v5 offset:17952
    s_waitcnt lgkmcnt(6)
    v_mfma_f32_16x16x32_bf16 v[104:107], v[240:243], v[40:43], v[104:107]
    ds_read_b64_tr_b16 v[232:233], v4 offset:17152
    v_mfma_f32_16x16x32_bf16 v[108:111], v[240:243], v[44:47], v[108:111]
    ds_read_b64_tr_b16 v[234:235], v4 offset:18176
    s_mov_b32 s23, 0x26000
    buffer_load_dwordx4 v[36:39], v6, s[8:11], s23 offen offset:1024 sc1
    s_waitcnt lgkmcnt(6)
    v_mfma_f32_16x16x32_bf16 v[112:115], v[244:247], v[40:43], v[112:115]
    ds_read_b64_tr_b16 v[236:237], v5 offset:17184
    v_mfma_f32_16x16x32_bf16 v[116:119], v[244:247], v[44:47], v[116:119]
    ds_read_b64_tr_b16 v[238:239], v5 offset:18208
    s_waitcnt lgkmcnt(6)
    v_mfma_f32_16x16x32_bf16 v[120:123], v[224:227], v[40:43], v[120:123]
    v_mfma_f32_16x16x32_bf16 v[124:127], v[224:227], v[44:47], v[124:127]
    s_waitcnt vmcnt(15)
    s_barrier
    ds_read_b64_tr_b16 v[240:241], v4 offset:32768
    ds_read_b64_tr_b16 v[242:243], v4 offset:33792
    s_waitcnt lgkmcnt(6)
    v_mfma_f32_16x16x32_bf16 v[128:131], v[228:231], v[40:43], v[128:131]
    s_add_u32 s22, s24, 0x210000
    s_add_u32 m0, s20, 0x10000
    s_nop 0
    buffer_load_dwordx4 v3, s[4:7], s22 offen lds
    ds_read_b64_tr_b16 v[244:245], v5 offset:32800
    v_mfma_f32_16x16x32_bf16 v[132:135], v[228:231], v[44:47], v[132:135]
    ds_read_b64_tr_b16 v[246:247], v5 offset:33824
    s_waitcnt lgkmcnt(6)
    v_mfma_f32_16x16x32_bf16 v[136:139], v[232:235], v[40:43], v[136:139]
    ds_read_b64_tr_b16 v[224:225], v4 offset:33024
    v_mfma_f32_16x16x32_bf16 v[140:143], v[232:235], v[44:47], v[140:143]
    s_add_u32 s22, s24, 0x212000
    s_add_u32 m0, s20, 0x10400
    s_nop 0
    buffer_load_dwordx4 v3, s[4:7], s22 offen lds
    ds_read_b64_tr_b16 v[226:227], v4 offset:34048
    s_waitcnt lgkmcnt(6)
    v_mfma_f32_16x16x32_bf16 v[144:147], v[236:239], v[40:43], v[144:147]
    ds_read_b64_tr_b16 v[228:229], v5 offset:33056
    v_mfma_f32_16x16x32_bf16 v[148:151], v[236:239], v[44:47], v[148:151]
    ds_read_b64_tr_b16 v[230:231], v5 offset:34080
    s_waitcnt vmcnt(16) lgkmcnt(6)
    v_mfma_f32_16x16x32_bf16 v[88:91], v[240:243], v[48:51], v[88:91]
    ds_read_b64_tr_b16 v[232:233], v4 offset:33280
    s_waitcnt vmcnt(15)
    v_mfma_f32_16x16x32_bf16 v[92:95], v[240:243], v[52:55], v[92:95]
    ds_read_b64_tr_b16 v[234:235], v4 offset:34304
    s_waitcnt lgkmcnt(6)
    v_mfma_f32_16x16x32_bf16 v[96:99], v[244:247], v[48:51], v[96:99]
    ds_read_b64_tr_b16 v[236:237], v5 offset:33312
    s_mov_b32 s23, 0x8000
    buffer_load_dwordx4 v[40:43], v6, s[8:11], s23 offen offset:1024 sc1
    v_mfma_f32_16x16x32_bf16 v[100:103], v[244:247], v[52:55], v[100:103]
    ds_read_b64_tr_b16 v[238:239], v5 offset:34336
    s_waitcnt lgkmcnt(6)
    v_mfma_f32_16x16x32_bf16 v[104:107], v[224:227], v[48:51], v[104:107]
    ds_read_b64_tr_b16 v[240:241], v4 offset:33536
    v_mfma_f32_16x16x32_bf16 v[108:111], v[224:227], v[52:55], v[108:111]
    ds_read_b64_tr_b16 v[242:243], v4 offset:34560
    s_mov_b32 s23, 0x28000
    buffer_load_dwordx4 v[44:47], v6, s[8:11], s23 offen offset:1024 sc1
    s_waitcnt lgkmcnt(6)
    v_mfma_f32_16x16x32_bf16 v[112:115], v[228:231], v[48:51], v[112:115]
    ds_read_b64_tr_b16 v[244:245], v5 offset:33568
    v_mfma_f32_16x16x32_bf16 v[116:119], v[228:231], v[52:55], v[116:119]
    ds_read_b64_tr_b16 v[246:247], v5 offset:34592
    s_waitcnt lgkmcnt(6)
    v_mfma_f32_16x16x32_bf16 v[120:123], v[232:235], v[48:51], v[120:123]
    v_mfma_f32_16x16x32_bf16 v[124:127], v[232:235], v[52:55], v[124:127]
    s_waitcnt vmcnt(15)
    s_barrier
    ds_read_b64_tr_b16 v[224:225], v4 offset:49152
    ds_read_b64_tr_b16 v[226:227], v4 offset:50176
    s_waitcnt lgkmcnt(6)
    v_mfma_f32_16x16x32_bf16 v[128:131], v[236:239], v[48:51], v[128:131]
    s_add_u32 s22, s24, 0x290000
    s_add_u32 m0, s20, 0x14000
    s_nop 0
    buffer_load_dwordx4 v3, s[4:7], s22 offen lds
    ds_read_b64_tr_b16 v[228:229], v5 offset:49184
    v_mfma_f32_16x16x32_bf16 v[132:135], v[236:239], v[52:55], v[132:135]
    ds_read_b64_tr_b16 v[230:231], v5 offset:50208
    s_waitcnt lgkmcnt(6)
    v_mfma_f32_16x16x32_bf16 v[136:139], v[240:243], v[48:51], v[136:139]
    ds_read_b64_tr_b16 v[232:233], v4 offset:49408
    v_mfma_f32_16x16x32_bf16 v[140:143], v[240:243], v[52:55], v[140:143]
    s_add_u32 s22, s24, 0x292000
    s_add_u32 m0, s20, 0x14400
    s_nop 0
    buffer_load_dwordx4 v3, s[4:7], s22 offen lds
    ds_read_b64_tr_b16 v[234:235], v4 offset:50432
    s_waitcnt lgkmcnt(6)
    v_mfma_f32_16x16x32_bf16 v[144:147], v[244:247], v[48:51], v[144:147]
    ds_read_b64_tr_b16 v[236:237], v5 offset:49440
    v_mfma_f32_16x16x32_bf16 v[148:151], v[244:247], v[52:55], v[148:151]
    ds_read_b64_tr_b16 v[238:239], v5 offset:50464
    s_waitcnt vmcnt(16) lgkmcnt(6)
    v_mfma_f32_16x16x32_bf16 v[88:91], v[224:227], v[56:59], v[88:91]
    ds_read_b64_tr_b16 v[240:241], v4 offset:49664
    s_waitcnt vmcnt(15)
    v_mfma_f32_16x16x32_bf16 v[92:95], v[224:227], v[60:63], v[92:95]
    ds_read_b64_tr_b16 v[242:243], v4 offset:50688
    s_waitcnt lgkmcnt(6)
    v_mfma_f32_16x16x32_bf16 v[96:99], v[228:231], v[56:59], v[96:99]
    ds_read_b64_tr_b16 v[244:245], v5 offset:49696
    s_mov_b32 s23, 0xa000
    buffer_load_dwordx4 v[48:51], v6, s[8:11], s23 offen offset:1024 sc1
    v_mfma_f32_16x16x32_bf16 v[100:103], v[228:231], v[60:63], v[100:103]
    ds_read_b64_tr_b16 v[246:247], v5 offset:50720
    s_waitcnt lgkmcnt(6)
    v_mfma_f32_16x16x32_bf16 v[104:107], v[232:235], v[56:59], v[104:107]
    ds_read_b64_tr_b16 v[224:225], v4 offset:49920
    v_mfma_f32_16x16x32_bf16 v[108:111], v[232:235], v[60:63], v[108:111]
    ds_read_b64_tr_b16 v[226:227], v4 offset:50944
    s_mov_b32 s23, 0x2a000
    buffer_load_dwordx4 v[52:55], v6, s[8:11], s23 offen offset:1024 sc1
    s_waitcnt lgkmcnt(6)
    v_mfma_f32_16x16x32_bf16 v[112:115], v[236:239], v[56:59], v[112:115]
    ds_read_b64_tr_b16 v[228:229], v5 offset:49952
    v_mfma_f32_16x16x32_bf16 v[116:119], v[236:239], v[60:63], v[116:119]
    ds_read_b64_tr_b16 v[230:231], v5 offset:50976
    s_waitcnt lgkmcnt(6)
    v_mfma_f32_16x16x32_bf16 v[120:123], v[240:243], v[56:59], v[120:123]
    v_mfma_f32_16x16x32_bf16 v[124:127], v[240:243], v[60:63], v[124:127]
    s_waitcnt vmcnt(14)
    s_barrier
    ds_read_b64_tr_b16 v[232:233], v7 offset:0
    ds_read_b64_tr_b16 v[234:235], v7 offset:1024
    s_waitcnt lgkmcnt(6)
    v_mfma_f32_16x16x32_bf16 v[128:131], v[244:247], v[56:59], v[128:131]
    s_add_u32 s22, s24, 0x310000
    s_add_u32 m0, s20, 0x18000
    s_nop 0
    buffer_load_dwordx4 v3, s[4:7], s22 offen lds
    ds_read_b64_tr_b16 v[236:237], v8 offset:32
    v_mfma_f32_16x16x32_bf16 v[132:135], v[244:247], v[60:63], v[132:135]
    ds_read_b64_tr_b16 v[238:239], v8 offset:1056
    s_waitcnt lgkmcnt(6)
    v_mfma_f32_16x16x32_bf16 v[136:139], v[224:227], v[56:59], v[136:139]
    ds_read_b64_tr_b16 v[240:241], v7 offset:256
    v_mfma_f32_16x16x32_bf16 v[140:143], v[224:227], v[60:63], v[140:143]
    s_add_u32 s22, s24, 0x312000
    s_add_u32 m0, s20, 0x18400
    s_nop 0
    buffer_load_dwordx4 v3, s[4:7], s22 offen lds
    ds_read_b64_tr_b16 v[242:243], v7 offset:1280
    s_waitcnt lgkmcnt(6)
    v_mfma_f32_16x16x32_bf16 v[144:147], v[228:231], v[56:59], v[144:147]
    ds_read_b64_tr_b16 v[244:245], v8 offset:288
    v_mfma_f32_16x16x32_bf16 v[148:151], v[228:231], v[60:63], v[148:151]
    ds_read_b64_tr_b16 v[246:247], v8 offset:1312
    s_waitcnt vmcnt(15) lgkmcnt(6)
    v_mfma_f32_16x16x32_bf16 v[88:91], v[232:235], v[24:27], v[88:91]
    ds_read_b64_tr_b16 v[224:225], v7 offset:512
    s_waitcnt vmcnt(14)
    v_mfma_f32_16x16x32_bf16 v[92:95], v[232:235], v[28:31], v[92:95]
    ds_read_b64_tr_b16 v[226:227], v7 offset:1536
    s_waitcnt lgkmcnt(6)
    v_mfma_f32_16x16x32_bf16 v[96:99], v[236:239], v[24:27], v[96:99]
    ds_read_b64_tr_b16 v[228:229], v8 offset:544
    s_mov_b32 s23, 0xc000
    buffer_load_dwordx4 v[56:59], v6, s[8:11], s23 offen offset:1024 sc1
    v_mfma_f32_16x16x32_bf16 v[100:103], v[236:239], v[28:31], v[100:103]
    ds_read_b64_tr_b16 v[230:231], v8 offset:1568
    s_waitcnt lgkmcnt(6)
    v_mfma_f32_16x16x32_bf16 v[104:107], v[240:243], v[24:27], v[104:107]
    ds_read_b64_tr_b16 v[232:233], v7 offset:768
    v_mfma_f32_16x16x32_bf16 v[108:111], v[240:243], v[28:31], v[108:111]
    ds_read_b64_tr_b16 v[234:235], v7 offset:1792
    s_mov_b32 s23, 0x2c000
    buffer_load_dwordx4 v[60:63], v6, s[8:11], s23 offen offset:1024 sc1
    s_waitcnt lgkmcnt(6)
    v_mfma_f32_16x16x32_bf16 v[112:115], v[244:247], v[24:27], v[112:115]
    ds_read_b64_tr_b16 v[236:237], v8 offset:800
    v_mfma_f32_16x16x32_bf16 v[116:119], v[244:247], v[28:31], v[116:119]
    ds_read_b64_tr_b16 v[238:239], v8 offset:1824
    s_waitcnt lgkmcnt(6)
    v_mfma_f32_16x16x32_bf16 v[120:123], v[224:227], v[24:27], v[120:123]
    v_mfma_f32_16x16x32_bf16 v[124:127], v[224:227], v[28:31], v[124:127]
    s_waitcnt vmcnt(14)
    s_barrier
    ds_read_b64_tr_b16 v[240:241], v7 offset:16384
    ds_read_b64_tr_b16 v[242:243], v7 offset:17408
    s_add_u32 s19, s19, 8192
    buffer_load_dword v12, v13, s[8:11], s19 offen sc1
    s_waitcnt lgkmcnt(6)
    v_mfma_f32_16x16x32_bf16 v[128:131], v[228:231], v[24:27], v[128:131]
    s_add_u32 s22, s24, 0x390000
    s_add_u32 m0, s20, 0x1c000
    s_nop 0
    buffer_load_dwordx4 v3, s[4:7], s22 offen lds
    ds_read_b64_tr_b16 v[244:245], v8 offset:16416
    v_mfma_f32_16x16x32_bf16 v[132:135], v[228:231], v[28:31], v[132:135]
    ds_read_b64_tr_b16 v[246:247], v8 offset:17440
    s_waitcnt lgkmcnt(6)
    v_mfma_f32_16x16x32_bf16 v[136:139], v[232:235], v[24:27], v[136:139]
    ds_read_b64_tr_b16 v[224:225], v7 offset:16640
    v_mfma_f32_16x16x32_bf16 v[140:143], v[232:235], v[28:31], v[140:143]
    s_add_u32 s22, s24, 0x392000
    s_add_u32 m0, s20, 0x1c400
    s_nop 0
    buffer_load_dwordx4 v3, s[4:7], s22 offen lds
    ds_read_b64_tr_b16 v[226:227], v7 offset:17664
    s_waitcnt lgkmcnt(6)
    v_mfma_f32_16x16x32_bf16 v[144:147], v[236:239], v[24:27], v[144:147]
    ds_read_b64_tr_b16 v[228:229], v8 offset:16672
    v_mfma_f32_16x16x32_bf16 v[148:151], v[236:239], v[28:31], v[148:151]
    ds_read_b64_tr_b16 v[230:231], v8 offset:17696
    s_waitcnt vmcnt(16) lgkmcnt(6)
    v_mfma_f32_16x16x32_bf16 v[88:91], v[240:243], v[32:35], v[88:91]
    ds_read_b64_tr_b16 v[232:233], v7 offset:16896
    s_waitcnt vmcnt(15)
    v_mfma_f32_16x16x32_bf16 v[92:95], v[240:243], v[36:39], v[92:95]
    ds_read_b64_tr_b16 v[234:235], v7 offset:17920
    s_waitcnt lgkmcnt(6)
    v_mfma_f32_16x16x32_bf16 v[96:99], v[244:247], v[32:35], v[96:99]
    ds_read_b64_tr_b16 v[236:237], v8 offset:16928
    s_mov_b32 s23, 0xe000
    buffer_load_dwordx4 v[24:27], v6, s[8:11], s23 offen offset:1024 sc1
    v_mfma_f32_16x16x32_bf16 v[100:103], v[244:247], v[36:39], v[100:103]
    ds_read_b64_tr_b16 v[238:239], v8 offset:17952
    s_waitcnt lgkmcnt(6)
    v_mfma_f32_16x16x32_bf16 v[104:107], v[224:227], v[32:35], v[104:107]
    ds_read_b64_tr_b16 v[240:241], v7 offset:17152
    v_mfma_f32_16x16x32_bf16 v[108:111], v[224:227], v[36:39], v[108:111]
    ds_read_b64_tr_b16 v[242:243], v7 offset:18176
    s_mov_b32 s23, 0x2e000
    buffer_load_dwordx4 v[28:31], v6, s[8:11], s23 offen offset:1024 sc1
    s_waitcnt lgkmcnt(6)
    v_mfma_f32_16x16x32_bf16 v[112:115], v[228:231], v[32:35], v[112:115]
    ds_read_b64_tr_b16 v[244:245], v8 offset:17184
    v_mfma_f32_16x16x32_bf16 v[116:119], v[228:231], v[36:39], v[116:119]
    ds_read_b64_tr_b16 v[246:247], v8 offset:18208
    s_waitcnt lgkmcnt(6)
    v_mfma_f32_16x16x32_bf16 v[120:123], v[232:235], v[32:35], v[120:123]
    v_mfma_f32_16x16x32_bf16 v[124:127], v[232:235], v[36:39], v[124:127]
    s_waitcnt vmcnt(15)
    s_barrier
    ds_read_b64_tr_b16 v[224:225], v4 offset:0
    ds_read_b64_tr_b16 v[226:227], v4 offset:1024
    s_waitcnt lgkmcnt(6)
    v_mfma_f32_16x16x32_bf16 v[128:131], v[236:239], v[32:35], v[128:131]
    s_add_u32 s22, s24, 0x20000
    s_add_u32 m0, s20, 0x20000
    s_nop 0
    buffer_load_dwordx4 v3, s[4:7], s22 offen lds
    ds_read_b64_tr_b16 v[228:229], v5 offset:32
    v_mfma_f32_16x16x32_bf16 v[132:135], v[236:239], v[36:39], v[132:135]
    ds_read_b64_tr_b16 v[230:231], v5 offset:1056
    s_waitcnt lgkmcnt(6)
    v_mfma_f32_16x16x32_bf16 v[136:139], v[240:243], v[32:35], v[136:139]
    ds_read_b64_tr_b16 v[232:233], v4 offset:256
    v_mfma_f32_16x16x32_bf16 v[140:143], v[240:243], v[36:39], v[140:143]
    s_add_u32 s22, s24, 0x22000
    s_add_u32 m0, s20, 0x20400
    s_nop 0
    buffer_load_dwordx4 v3, s[4:7], s22 offen lds
    ds_read_b64_tr_b16 v[234:235], v4 offset:1280
    s_waitcnt lgkmcnt(6)
    v_mfma_f32_16x16x32_bf16 v[144:147], v[244:247], v[32:35], v[144:147]
    ds_read_b64_tr_b16 v[236:237], v5 offset:288
    v_mfma_f32_16x16x32_bf16 v[148:151], v[244:247], v[36:39], v[148:151]
    ds_read_b64_tr_b16 v[238:239], v5 offset:1312
    s_waitcnt vmcnt(6)
    v_cmp_ne_u32 vcc, s28, v12
    s_cbranch_vccnz adaLN_cond__sliding_block_cached__moe_arch_mod__prompt_kernel_o28r
adaLN_cond__sliding_block_cached__moe_arch_mod__prompt_kernel_o28b:
    s_waitcnt lgkmcnt(6)
    v_mfma_f32_16x16x32_bf16 v[88:91], v[224:227], v[40:43], v[88:91]
    ds_read_b64_tr_b16 v[240:241], v4 offset:512
    v_mfma_f32_16x16x32_bf16 v[92:95], v[224:227], v[44:47], v[92:95]
    ds_read_b64_tr_b16 v[242:243], v4 offset:1536
    s_waitcnt lgkmcnt(6)
    v_mfma_f32_16x16x32_bf16 v[96:99], v[228:231], v[40:43], v[96:99]
    ds_read_b64_tr_b16 v[244:245], v5 offset:544
    s_mov_b32 s23, 0x0
    buffer_load_dwordx4 v[32:35], v6, s[8:11], s23 offen offset:2048 sc1
    v_mfma_f32_16x16x32_bf16 v[100:103], v[228:231], v[44:47], v[100:103]
    ds_read_b64_tr_b16 v[246:247], v5 offset:1568
    s_waitcnt lgkmcnt(6)
    v_mfma_f32_16x16x32_bf16 v[104:107], v[232:235], v[40:43], v[104:107]
    ds_read_b64_tr_b16 v[224:225], v4 offset:768
    v_mfma_f32_16x16x32_bf16 v[108:111], v[232:235], v[44:47], v[108:111]
    ds_read_b64_tr_b16 v[226:227], v4 offset:1792
    s_mov_b32 s23, 0x20000
    buffer_load_dwordx4 v[36:39], v6, s[8:11], s23 offen offset:2048 sc1
    s_waitcnt lgkmcnt(6)
    v_mfma_f32_16x16x32_bf16 v[112:115], v[236:239], v[40:43], v[112:115]
    ds_read_b64_tr_b16 v[228:229], v5 offset:800
    v_mfma_f32_16x16x32_bf16 v[116:119], v[236:239], v[44:47], v[116:119]
    ds_read_b64_tr_b16 v[230:231], v5 offset:1824
    s_waitcnt lgkmcnt(6)
    v_mfma_f32_16x16x32_bf16 v[120:123], v[240:243], v[40:43], v[120:123]
    v_mfma_f32_16x16x32_bf16 v[124:127], v[240:243], v[44:47], v[124:127]
    s_barrier
    ds_read_b64_tr_b16 v[232:233], v4 offset:16384
    ds_read_b64_tr_b16 v[234:235], v4 offset:17408
    s_waitcnt lgkmcnt(6)
    v_mfma_f32_16x16x32_bf16 v[128:131], v[244:247], v[40:43], v[128:131]
    s_add_u32 s22, s24, 0xa0000
    s_add_u32 m0, s20, 0x24000
    s_nop 0
    buffer_load_dwordx4 v3, s[4:7], s22 offen lds
    ds_read_b64_tr_b16 v[236:237], v5 offset:16416
    v_mfma_f32_16x16x32_bf16 v[132:135], v[244:247], v[44:47], v[132:135]
    ds_read_b64_tr_b16 v[238:239], v5 offset:17440
    s_waitcnt lgkmcnt(6)
    v_mfma_f32_16x16x32_bf16 v[136:139], v[224:227], v[40:43], v[136:139]
    ds_read_b64_tr_b16 v[240:241], v4 offset:16640
    v_mfma_f32_16x16x32_bf16 v[140:143], v[224:227], v[44:47], v[140:143]
    s_add_u32 s22, s24, 0xa2000
    s_add_u32 m0, s20, 0x24400
    s_nop 0
    buffer_load_dwordx4 v3, s[4:7], s22 offen lds
    ds_read_b64_tr_b16 v[242:243], v4 offset:17664
    s_waitcnt lgkmcnt(6)
    v_mfma_f32_16x16x32_bf16 v[144:147], v[228:231], v[40:43], v[144:147]
    ds_read_b64_tr_b16 v[244:245], v5 offset:16672
    v_mfma_f32_16x16x32_bf16 v[148:151], v[228:231], v[44:47], v[148:151]
    ds_read_b64_tr_b16 v[246:247], v5 offset:17696
    s_waitcnt lgkmcnt(6)
    v_mfma_f32_16x16x32_bf16 v[88:91], v[232:235], v[48:51], v[88:91]
    ds_read_b64_tr_b16 v[224:225], v4 offset:16896
    v_mfma_f32_16x16x32_bf16 v[92:95], v[232:235], v[52:55], v[92:95]
    ds_read_b64_tr_b16 v[226:227], v4 offset:17920
    s_waitcnt lgkmcnt(6)
    v_mfma_f32_16x16x32_bf16 v[96:99], v[236:239], v[48:51], v[96:99]
    ds_read_b64_tr_b16 v[228:229], v5 offset:16928
    s_mov_b32 s23, 0x2000
    buffer_load_dwordx4 v[40:43], v6, s[8:11], s23 offen offset:2048 sc1
    v_mfma_f32_16x16x32_bf16 v[100:103], v[236:239], v[52:55], v[100:103]
    ds_read_b64_tr_b16 v[230:231], v5 offset:17952
    s_waitcnt lgkmcnt(6)
    v_mfma_f32_16x16x32_bf16 v[104:107], v[240:243], v[48:51], v[104:107]
    ds_read_b64_tr_b16 v[232:233], v4 offset:17152
    v_mfma_f32_16x16x32_bf16 v[108:111], v[240:243], v[52:55], v[108:111]
    ds_read_b64_tr_b16 v[234:235], v4 offset:18176
    s_mov_b32 s23, 0x22000
    buffer_load_dwordx4 v[44:47], v6, s[8:11], s23 offen offset:2048 sc1
    s_waitcnt lgkmcnt(6)
    v_mfma_f32_16x16x32_bf16 v[112:115], v[244:247], v[48:51], v[112:115]
    ds_read_b64_tr_b16 v[236:237], v5 offset:17184
    v_mfma_f32_16x16x32_bf16 v[116:119], v[244:247], v[52:55], v[116:119]
    ds_read_b64_tr_b16 v[238:239], v5 offset:18208
    s_waitcnt lgkmcnt(6)
    v_mfma_f32_16x16x32_bf16 v[120:123], v[224:227], v[48:51], v[120:123]
    v_mfma_f32_16x16x32_bf16 v[124:127], v[224:227], v[52:55], v[124:127]
    s_barrier
    ds_read_b64_tr_b16 v[240:241], v4 offset:32768
    ds_read_b64_tr_b16 v[242:243], v4 offset:33792
    s_waitcnt lgkmcnt(6)
    v_mfma_f32_16x16x32_bf16 v[128:131], v[228:231], v[48:51], v[128:131]
    s_add_u32 s22, s24, 0x120000
    s_add_u32 m0, s20, 0x10000
    s_nop 0
    buffer_load_dwordx4 v3, s[4:7], s22 offen lds
    ds_read_b64_tr_b16 v[244:245], v5 offset:32800
    v_mfma_f32_16x16x32_bf16 v[132:135], v[228:231], v[52:55], v[132:135]
    ds_read_b64_tr_b16 v[246:247], v5 offset:33824
    s_waitcnt lgkmcnt(6)
    v_mfma_f32_16x16x32_bf16 v[136:139], v[232:235], v[48:51], v[136:139]
    ds_read_b64_tr_b16 v[224:225], v4 offset:33024
    v_mfma_f32_16x16x32_bf16 v[140:143], v[232:235], v[52:55], v[140:143]
    s_add_u32 s22, s24, 0x122000
    s_add_u32 m0, s20, 0x10400
    s_nop 0
    buffer_load_dwordx4 v3, s[4:7], s22 offen lds
    ds_read_b64_tr_b16 v[226:227], v4 offset:34048
    s_waitcnt lgkmcnt(6)
    v_mfma_f32_16x16x32_bf16 v[144:147], v[236:239], v[48:51], v[144:147]
    ds_read_b64_tr_b16 v[228:229], v5 offset:33056
    v_mfma_f32_16x16x32_bf16 v[148:151], v[236:239], v[52:55], v[148:151]
    ds_read_b64_tr_b16 v[230:231], v5 offset:34080
    s_waitcnt lgkmcnt(6)
    v_mfma_f32_16x16x32_bf16 v[88:91], v[240:243], v[56:59], v[88:91]
    ds_read_b64_tr_b16 v[232:233], v4 offset:33280
    v_mfma_f32_16x16x32_bf16 v[92:95], v[240:243], v[60:63], v[92:95]
    ds_read_b64_tr_b16 v[234:235], v4 offset:34304
    s_waitcnt lgkmcnt(6)
    v_mfma_f32_16x16x32_bf16 v[96:99], v[244:247], v[56:59], v[96:99]
    ds_read_b64_tr_b16 v[236:237], v5 offset:33312
    s_mov_b32 s23, 0x4000
    buffer_load_dwordx4 v[48:51], v6, s[8:11], s23 offen offset:2048 sc1
    v_mfma_f32_16x16x32_bf16 v[100:103], v[244:247], v[60:63], v[100:103]
    ds_read_b64_tr_b16 v[238:239], v5 offset:34336
    s_waitcnt lgkmcnt(6)
    v_mfma_f32_16x16x32_bf16 v[104:107], v[224:227], v[56:59], v[104:107]
    ds_read_b64_tr_b16 v[240:241], v4 offset:33536
    v_mfma_f32_16x16x32_bf16 v[108:111], v[224:227], v[60:63], v[108:111]
    ds_read_b64_tr_b16 v[242:243], v4 offset:34560
    s_mov_b32 s23, 0x24000
    buffer_load_dwordx4 v[52:55], v6, s[8:11], s23 offen offset:2048 sc1
    s_waitcnt lgkmcnt(6)
    v_mfma_f32_16x16x32_bf16 v[112:115], v[228:231], v[56:59], v[112:115]
    ds_read_b64_tr_b16 v[244:245], v5 offset:33568
    v_mfma_f32_16x16x32_bf16 v[116:119], v[228:231], v[60:63], v[116:119]
    ds_read_b64_tr_b16 v[246:247], v5 offset:34592
    s_waitcnt lgkmcnt(6)
    v_mfma_f32_16x16x32_bf16 v[120:123], v[232:235], v[56:59], v[120:123]
    v_mfma_f32_16x16x32_bf16 v[124:127], v[232:235], v[60:63], v[124:127]
    s_waitcnt vmcnt(14)
    s_barrier
    ds_read_b64_tr_b16 v[224:225], v4 offset:49152
    ds_read_b64_tr_b16 v[226:227], v4 offset:50176
    s_waitcnt lgkmcnt(6)
    v_mfma_f32_16x16x32_bf16 v[128:131], v[236:239], v[56:59], v[128:131]
    s_add_u32 s22, s24, 0x1a0000
    s_add_u32 m0, s20, 0x14000
    s_nop 0
    buffer_load_dwordx4 v3, s[4:7], s22 offen lds
    ds_read_b64_tr_b16 v[228:229], v5 offset:49184
    v_mfma_f32_16x16x32_bf16 v[132:135], v[236:239], v[60:63], v[132:135]
    ds_read_b64_tr_b16 v[230:231], v5 offset:50208
    s_waitcnt lgkmcnt(6)
    v_mfma_f32_16x16x32_bf16 v[136:139], v[240:243], v[56:59], v[136:139]
    ds_read_b64_tr_b16 v[232:233], v4 offset:49408
    v_mfma_f32_16x16x32_bf16 v[140:143], v[240:243], v[60:63], v[140:143]
    s_add_u32 s22, s24, 0x1a2000
    s_add_u32 m0, s20, 0x14400
    s_nop 0
    buffer_load_dwordx4 v3, s[4:7], s22 offen lds
    ds_read_b64_tr_b16 v[234:235], v4 offset:50432
    s_waitcnt lgkmcnt(6)
    v_mfma_f32_16x16x32_bf16 v[144:147], v[244:247], v[56:59], v[144:147]
    ds_read_b64_tr_b16 v[236:237], v5 offset:49440
    v_mfma_f32_16x16x32_bf16 v[148:151], v[244:247], v[60:63], v[148:151]
    ds_read_b64_tr_b16 v[238:239], v5 offset:50464
    s_waitcnt vmcnt(15) lgkmcnt(6)
    v_mfma_f32_16x16x32_bf16 v[88:91], v[224:227], v[24:27], v[88:91]
    ds_read_b64_tr_b16 v[240:241], v4 offset:49664
    s_waitcnt vmcnt(14)
    v_mfma_f32_16x16x32_bf16 v[92:95], v[224:227], v[28:31], v[92:95]
    ds_read_b64_tr_b16 v[242:243], v4 offset:50688
    s_waitcnt lgkmcnt(6)
    v_mfma_f32_16x16x32_bf16 v[96:99], v[228:231], v[24:27], v[96:99]
    ds_read_b64_tr_b16 v[244:245], v5 offset:49696
    s_mov_b32 s23, 0x6000
    buffer_load_dwordx4 v[56:59], v6, s[8:11], s23 offen offset:2048 sc1
    v_mfma_f32_16x16x32_bf16 v[100:103], v[228:231], v[28:31], v[100:103]
    ds_read_b64_tr_b16 v[246:247], v5 offset:50720
    s_waitcnt lgkmcnt(6)
    v_mfma_f32_16x16x32_bf16 v[104:107], v[232:235], v[24:27], v[104:107]
    ds_read_b64_tr_b16 v[224:225], v4 offset:49920
    v_mfma_f32_16x16x32_bf16 v[108:111], v[232:235], v[28:31], v[108:111]
    ds_read_b64_tr_b16 v[226:227], v4 offset:50944
    s_mov_b32 s23, 0x26000
    buffer_load_dwordx4 v[60:63], v6, s[8:11], s23 offen offset:2048 sc1
    s_waitcnt lgkmcnt(6)
    v_mfma_f32_16x16x32_bf16 v[112:115], v[236:239], v[24:27], v[112:115]
    ds_read_b64_tr_b16 v[228:229], v5 offset:49952
    v_mfma_f32_16x16x32_bf16 v[116:119], v[236:239], v[28:31], v[116:119]
    ds_read_b64_tr_b16 v[230:231], v5 offset:50976
    s_waitcnt lgkmcnt(6)
    v_mfma_f32_16x16x32_bf16 v[120:123], v[240:243], v[24:27], v[120:123]
    v_mfma_f32_16x16x32_bf16 v[124:127], v[240:243], v[28:31], v[124:127]
    s_waitcnt vmcnt(14)
    s_barrier
    ds_read_b64_tr_b16 v[232:233], v7 offset:0
    ds_read_b64_tr_b16 v[234:235], v7 offset:1024
    s_waitcnt lgkmcnt(6)
    v_mfma_f32_16x16x32_bf16 v[128:131], v[244:247], v[24:27], v[128:131]
    s_add_u32 s22, s24, 0x220000
    s_add_u32 m0, s20, 0x18000
    s_nop 0
    buffer_load_dwordx4 v3, s[4:7], s22 offen lds
    ds_read_b64_tr_b16 v[236:237], v8 offset:32
    v_mfma_f32_16x16x32_bf16 v[132:135], v[244:247], v[28:31], v[132:135]
    ds_read_b64_tr_b16 v[238:239], v8 offset:1056
    s_waitcnt lgkmcnt(6)
    v_mfma_f32_16x16x32_bf16 v[136:139], v[224:227], v[24:27], v[136:139]
    ds_read_b64_tr_b16 v[240:241], v7 offset:256
    v_mfma_f32_16x16x32_bf16 v[140:143], v[224:227], v[28:31], v[140:143]
    s_add_u32 s22, s24, 0x222000
    s_add_u32 m0, s20, 0x18400
    s_nop 0
    buffer_load_dwordx4 v3, s[4:7], s22 offen lds
    ds_read_b64_tr_b16 v[242:243], v7 offset:1280
    s_waitcnt lgkmcnt(6)
    v_mfma_f32_16x16x32_bf16 v[144:147], v[228:231], v[24:27], v[144:147]
    ds_read_b64_tr_b16 v[244:245], v8 offset:288
    v_mfma_f32_16x16x32_bf16 v[148:151], v[228:231], v[28:31], v[148:151]
    ds_read_b64_tr_b16 v[246:247], v8 offset:1312
    s_waitcnt vmcnt(15) lgkmcnt(6)
    v_mfma_f32_16x16x32_bf16 v[88:91], v[232:235], v[32:35], v[88:91]
    ds_read_b64_tr_b16 v[224:225], v7 offset:512
    s_waitcnt vmcnt(14)
    v_mfma_f32_16x16x32_bf16 v[92:95], v[232:235], v[36:39], v[92:95]
    ds_read_b64_tr_b16 v[226:227], v7 offset:1536
    s_waitcnt lgkmcnt(6)
    v_mfma_f32_16x16x32_bf16 v[96:99], v[236:239], v[32:35], v[96:99]
    ds_read_b64_tr_b16 v[228:229], v8 offset:544
    s_mov_b32 s23, 0x8000
    buffer_load_dwordx4 v[24:27], v6, s[8:11], s23 offen offset:2048 sc1
    v_mfma_f32_16x16x32_bf16 v[100:103], v[236:239], v[36:39], v[100:103]
    ds_read_b64_tr_b16 v[230:231], v8 offset:1568
    s_waitcnt lgkmcnt(6)
    v_mfma_f32_16x16x32_bf16 v[104:107], v[240:243], v[32:35], v[104:107]
    ds_read_b64_tr_b16 v[232:233], v7 offset:768
    v_mfma_f32_16x16x32_bf16 v[108:111], v[240:243], v[36:39], v[108:111]
    ds_read_b64_tr_b16 v[234:235], v7 offset:1792
    s_mov_b32 s23, 0x28000
    buffer_load_dwordx4 v[28:31], v6, s[8:11], s23 offen offset:2048 sc1
    s_mov_b32 s16, 0x544000
    buffer_load_dwordx4 v[184:187], v2, s[8:11], s16 offen sc1
    s_waitcnt lgkmcnt(6)
    v_mfma_f32_16x16x32_bf16 v[112:115], v[244:247], v[32:35], v[112:115]
    ds_read_b64_tr_b16 v[236:237], v8 offset:800
    v_mfma_f32_16x16x32_bf16 v[116:119], v[244:247], v[36:39], v[116:119]
    ds_read_b64_tr_b16 v[238:239], v8 offset:1824
    s_waitcnt lgkmcnt(6)
    v_mfma_f32_16x16x32_bf16 v[120:123], v[224:227], v[32:35], v[120:123]
    v_mfma_f32_16x16x32_bf16 v[124:127], v[224:227], v[36:39], v[124:127]
    s_waitcnt vmcnt(15)
    s_barrier
    ds_read_b64_tr_b16 v[240:241], v7 offset:16384
    ds_read_b64_tr_b16 v[242:243], v7 offset:17408
    s_waitcnt lgkmcnt(6)
    v_mfma_f32_16x16x32_bf16 v[128:131], v[228:231], v[32:35], v[128:131]
    s_add_u32 s22, s24, 0x2a0000
    s_add_u32 m0, s20, 0x1c000
    s_nop 0
    buffer_load_dwordx4 v3, s[4:7], s22 offen lds
    ds_read_b64_tr_b16 v[244:245], v8 offset:16416
    v_mfma_f32_16x16x32_bf16 v[132:135], v[228:231], v[36:39], v[132:135]
    ds_read_b64_tr_b16 v[246:247], v8 offset:17440
    s_waitcnt lgkmcnt(6)
    v_mfma_f32_16x16x32_bf16 v[136:139], v[232:235], v[32:35], v[136:139]
    ds_read_b64_tr_b16 v[224:225], v7 offset:16640
    v_mfma_f32_16x16x32_bf16 v[140:143], v[232:235], v[36:39], v[140:143]
    s_add_u32 s22, s24, 0x2a2000
    s_add_u32 m0, s20, 0x1c400
    s_nop 0
    buffer_load_dwordx4 v3, s[4:7], s22 offen lds
    ds_read_b64_tr_b16 v[226:227], v7 offset:17664
    s_waitcnt lgkmcnt(6)
    v_mfma_f32_16x16x32_bf16 v[144:147], v[236:239], v[32:35], v[144:147]
    ds_read_b64_tr_b16 v[228:229], v8 offset:16672
    v_mfma_f32_16x16x32_bf16 v[148:151], v[236:239], v[36:39], v[148:151]
    ds_read_b64_tr_b16 v[230:231], v8 offset:17696
    s_waitcnt vmcnt(16) lgkmcnt(6)
    v_mfma_f32_16x16x32_bf16 v[88:91], v[240:243], v[40:43], v[88:91]
    ds_read_b64_tr_b16 v[232:233], v7 offset:16896
    s_waitcnt vmcnt(15)
    v_mfma_f32_16x16x32_bf16 v[92:95], v[240:243], v[44:47], v[92:95]
    ds_read_b64_tr_b16 v[234:235], v7 offset:17920
    s_waitcnt lgkmcnt(6)
    v_mfma_f32_16x16x32_bf16 v[96:99], v[244:247], v[40:43], v[96:99]
    ds_read_b64_tr_b16 v[236:237], v8 offset:16928
    s_mov_b32 s23, 0xa000
    buffer_load_dwordx4 v[32:35], v6, s[8:11], s23 offen offset:2048 sc1
    v_mfma_f32_16x16x32_bf16 v[100:103], v[244:247], v[44:47], v[100:103]
    ds_read_b64_tr_b16 v[238:239], v8 offset:17952
    s_waitcnt lgkmcnt(6)
    v_mfma_f32_16x16x32_bf16 v[104:107], v[224:227], v[40:43], v[104:107]
    ds_read_b64_tr_b16 v[240:241], v7 offset:17152
    v_mfma_f32_16x16x32_bf16 v[108:111], v[224:227], v[44:47], v[108:111]
    ds_read_b64_tr_b16 v[242:243], v7 offset:18176
    s_mov_b32 s23, 0x2a000
    buffer_load_dwordx4 v[36:39], v6, s[8:11], s23 offen offset:2048 sc1
    s_waitcnt lgkmcnt(6)
    v_mfma_f32_16x16x32_bf16 v[112:115], v[228:231], v[40:43], v[112:115]
    ds_read_b64_tr_b16 v[244:245], v8 offset:17184
    v_mfma_f32_16x16x32_bf16 v[116:119], v[228:231], v[44:47], v[116:119]
    ds_read_b64_tr_b16 v[246:247], v8 offset:18208
    s_waitcnt lgkmcnt(6)
    v_mfma_f32_16x16x32_bf16 v[120:123], v[232:235], v[40:43], v[120:123]
    v_mfma_f32_16x16x32_bf16 v[124:127], v[232:235], v[44:47], v[124:127]
    s_waitcnt vmcnt(15)
    s_barrier
    ds_read_b64_tr_b16 v[224:225], v4 offset:0
    ds_read_b64_tr_b16 v[226:227], v4 offset:1024
    s_waitcnt lgkmcnt(6)
    v_mfma_f32_16x16x32_bf16 v[128:131], v[236:239], v[40:43], v[128:131]
    s_add_u32 s22, s24, 0x320000
    s_add_u32 m0, s20, 0x20000
    s_nop 0
    buffer_load_dwordx4 v3, s[4:7], s22 offen lds
    ds_read_b64_tr_b16 v[228:229], v5 offset:32
    v_mfma_f32_16x16x32_bf16 v[132:135], v[236:239], v[44:47], v[132:135]
    ds_read_b64_tr_b16 v[230:231], v5 offset:1056
    s_waitcnt lgkmcnt(6)
    v_mfma_f32_16x16x32_bf16 v[136:139], v[240:243], v[40:43], v[136:139]
    ds_read_b64_tr_b16 v[232:233], v4 offset:256
    v_mfma_f32_16x16x32_bf16 v[140:143], v[240:243], v[44:47], v[140:143]
    s_add_u32 s22, s24, 0x322000
    s_add_u32 m0, s20, 0x20400
    s_nop 0
    buffer_load_dwordx4 v3, s[4:7], s22 offen lds
    ds_read_b64_tr_b16 v[234:235], v4 offset:1280
    s_waitcnt lgkmcnt(6)
    v_mfma_f32_16x16x32_bf16 v[144:147], v[244:247], v[40:43], v[144:147]
    ds_read_b64_tr_b16 v[236:237], v5 offset:288
    v_mfma_f32_16x16x32_bf16 v[148:151], v[244:247], v[44:47], v[148:151]
    ds_read_b64_tr_b16 v[238:239], v5 offset:1312
    s_waitcnt vmcnt(16) lgkmcnt(6)
    v_mfma_f32_16x16x32_bf16 v[88:91], v[224:227], v[48:51], v[88:91]
    ds_read_b64_tr_b16 v[240:241], v4 offset:512
    s_waitcnt vmcnt(15)
    v_mfma_f32_16x16x32_bf16 v[92:95], v[224:227], v[52:55], v[92:95]
    ds_read_b64_tr_b16 v[242:243], v4 offset:1536
    s_waitcnt lgkmcnt(6)
    v_mfma_f32_16x16x32_bf16 v[96:99], v[228:231], v[48:51], v[96:99]
    ds_read_b64_tr_b16 v[244:245], v5 offset:544
    s_mov_b32 s23, 0xc000
    buffer_load_dwordx4 v[40:43], v6, s[8:11], s23 offen offset:2048 sc1
    v_mfma_f32_16x16x32_bf16 v[100:103], v[228:231], v[52:55], v[100:103]
    ds_read_b64_tr_b16 v[246:247], v5 offset:1568
    s_waitcnt lgkmcnt(6)
    v_mfma_f32_16x16x32_bf16 v[104:107], v[232:235], v[48:51], v[104:107]
    ds_read_b64_tr_b16 v[224:225], v4 offset:768
    v_mfma_f32_16x16x32_bf16 v[108:111], v[232:235], v[52:55], v[108:111]
    ds_read_b64_tr_b16 v[226:227], v4 offset:1792
    s_mov_b32 s23, 0x2c000
    buffer_load_dwordx4 v[44:47], v6, s[8:11], s23 offen offset:2048 sc1
    s_waitcnt lgkmcnt(6)
    v_mfma_f32_16x16x32_bf16 v[112:115], v[236:239], v[48:51], v[112:115]
    ds_read_b64_tr_b16 v[228:229], v5 offset:800
    v_mfma_f32_16x16x32_bf16 v[116:119], v[236:239], v[52:55], v[116:119]
    ds_read_b64_tr_b16 v[230:231], v5 offset:1824
    s_waitcnt lgkmcnt(6)
    v_mfma_f32_16x16x32_bf16 v[120:123], v[240:243], v[48:51], v[120:123]
    v_mfma_f32_16x16x32_bf16 v[124:127], v[240:243], v[52:55], v[124:127]
    s_waitcnt vmcnt(15)
    s_barrier
    ds_read_b64_tr_b16 v[232:233], v4 offset:16384
    ds_read_b64_tr_b16 v[234:235], v4 offset:17408
    s_add_u32 s19, s19, 8192
    buffer_load_dword v12, v13, s[8:11], s19 offen sc1
    s_waitcnt lgkmcnt(6)
    v_mfma_f32_16x16x32_bf16 v[128:131], v[244:247], v[48:51], v[128:131]
    s_add_u32 s22, s24, 0x3a0000
    s_add_u32 m0, s20, 0x24000
    s_nop 0
    buffer_load_dwordx4 v3, s[4:7], s22 offen lds
    ds_read_b64_tr_b16 v[236:237], v5 offset:16416
    v_mfma_f32_16x16x32_bf16 v[132:135], v[244:247], v[52:55], v[132:135]
    ds_read_b64_tr_b16 v[238:239], v5 offset:17440
    s_waitcnt lgkmcnt(6)
    v_mfma_f32_16x16x32_bf16 v[136:139], v[224:227], v[48:51], v[136:139]
    ds_read_b64_tr_b16 v[240:241], v4 offset:16640
    v_mfma_f32_16x16x32_bf16 v[140:143], v[224:227], v[52:55], v[140:143]
    s_add_u32 s22, s24, 0x3a2000
    s_add_u32 m0, s20, 0x24400
    s_nop 0
    buffer_load_dwordx4 v3, s[4:7], s22 offen lds
    ds_read_b64_tr_b16 v[242:243], v4 offset:17664
    s_waitcnt lgkmcnt(6)
    v_mfma_f32_16x16x32_bf16 v[144:147], v[228:231], v[48:51], v[144:147]
    ds_read_b64_tr_b16 v[244:245], v5 offset:16672
    v_mfma_f32_16x16x32_bf16 v[148:151], v[228:231], v[52:55], v[148:151]
    ds_read_b64_tr_b16 v[246:247], v5 offset:17696
    s_waitcnt vmcnt(17) lgkmcnt(6)
    v_mfma_f32_16x16x32_bf16 v[88:91], v[232:235], v[56:59], v[88:91]
    ds_read_b64_tr_b16 v[224:225], v4 offset:16896
    s_waitcnt vmcnt(16)
    v_mfma_f32_16x16x32_bf16 v[92:95], v[232:235], v[60:63], v[92:95]
    ds_read_b64_tr_b16 v[226:227], v4 offset:17920
    s_waitcnt lgkmcnt(6)
    v_mfma_f32_16x16x32_bf16 v[96:99], v[236:239], v[56:59], v[96:99]
    ds_read_b64_tr_b16 v[228:229], v5 offset:16928
    s_mov_b32 s23, 0xe000
    buffer_load_dwordx4 v[48:51], v6, s[8:11], s23 offen offset:2048 sc1
    v_mfma_f32_16x16x32_bf16 v[100:103], v[236:239], v[60:63], v[100:103]
    ds_read_b64_tr_b16 v[230:231], v5 offset:17952
    s_waitcnt lgkmcnt(6)
    v_mfma_f32_16x16x32_bf16 v[104:107], v[240:243], v[56:59], v[104:107]
    ds_read_b64_tr_b16 v[232:233], v4 offset:17152
    v_mfma_f32_16x16x32_bf16 v[108:111], v[240:243], v[60:63], v[108:111]
    ds_read_b64_tr_b16 v[234:235], v4 offset:18176
    s_mov_b32 s23, 0x2e000
    buffer_load_dwordx4 v[52:55], v6, s[8:11], s23 offen offset:2048 sc1
    s_waitcnt lgkmcnt(6)
    v_mfma_f32_16x16x32_bf16 v[112:115], v[244:247], v[56:59], v[112:115]
    ds_read_b64_tr_b16 v[236:237], v5 offset:17184
    v_mfma_f32_16x16x32_bf16 v[116:119], v[244:247], v[60:63], v[116:119]
    ds_read_b64_tr_b16 v[238:239], v5 offset:18208
    s_waitcnt lgkmcnt(6)
    v_mfma_f32_16x16x32_bf16 v[120:123], v[224:227], v[56:59], v[120:123]
    v_mfma_f32_16x16x32_bf16 v[124:127], v[224:227], v[60:63], v[124:127]
    s_waitcnt vmcnt(16)
    s_barrier
    ds_read_b64_tr_b16 v[240:241], v4 offset:32768
    ds_read_b64_tr_b16 v[242:243], v4 offset:33792
    s_waitcnt lgkmcnt(6)
    v_mfma_f32_16x16x32_bf16 v[128:131], v[228:231], v[56:59], v[128:131]
    s_add_u32 s22, s24, 0x30000
    s_add_u32 m0, s20, 0x10000
    s_nop 0
    buffer_load_dwordx4 v3, s[4:7], s22 offen lds
    ds_read_b64_tr_b16 v[244:245], v5 offset:32800
    v_mfma_f32_16x16x32_bf16 v[132:135], v[228:231], v[60:63], v[132:135]
    ds_read_b64_tr_b16 v[246:247], v5 offset:33824
    s_waitcnt lgkmcnt(6)
    v_mfma_f32_16x16x32_bf16 v[136:139], v[232:235], v[56:59], v[136:139]
    ds_read_b64_tr_b16 v[224:225], v4 offset:33024
    v_mfma_f32_16x16x32_bf16 v[140:143], v[232:235], v[60:63], v[140:143]
    s_add_u32 s22, s24, 0x32000
    s_add_u32 m0, s20, 0x10400
    s_nop 0
    buffer_load_dwordx4 v3, s[4:7], s22 offen lds
    ds_read_b64_tr_b16 v[226:227], v4 offset:34048
    s_waitcnt lgkmcnt(6)
    v_mfma_f32_16x16x32_bf16 v[144:147], v[236:239], v[56:59], v[144:147]
    ds_read_b64_tr_b16 v[228:229], v5 offset:33056
    v_mfma_f32_16x16x32_bf16 v[148:151], v[236:239], v[60:63], v[148:151]
    ds_read_b64_tr_b16 v[230:231], v5 offset:34080
    s_waitcnt vmcnt(6)
    v_cmp_ne_u32 vcc, s28, v12
    s_cbranch_vccnz adaLN_cond__sliding_block_cached__moe_arch_mod__prompt_kernel_o29r
adaLN_cond__sliding_block_cached__moe_arch_mod__prompt_kernel_o29b:
    s_waitcnt lgkmcnt(6)
    v_mfma_f32_16x16x32_bf16 v[88:91], v[240:243], v[24:27], v[88:91]
    ds_read_b64_tr_b16 v[232:233], v4 offset:33280
    v_mfma_f32_16x16x32_bf16 v[92:95], v[240:243], v[28:31], v[92:95]
    ds_read_b64_tr_b16 v[234:235], v4 offset:34304
    s_waitcnt lgkmcnt(6)
    v_mfma_f32_16x16x32_bf16 v[96:99], v[244:247], v[24:27], v[96:99]
    ds_read_b64_tr_b16 v[236:237], v5 offset:33312
    s_mov_b32 s23, 0x0
    buffer_load_dwordx4 v[56:59], v6, s[8:11], s23 offen offset:3072 sc1
    v_mfma_f32_16x16x32_bf16 v[100:103], v[244:247], v[28:31], v[100:103]
    ds_read_b64_tr_b16 v[238:239], v5 offset:34336
    s_waitcnt lgkmcnt(6)
    v_mfma_f32_16x16x32_bf16 v[104:107], v[224:227], v[24:27], v[104:107]
    ds_read_b64_tr_b16 v[240:241], v4 offset:33536
    v_mfma_f32_16x16x32_bf16 v[108:111], v[224:227], v[28:31], v[108:111]
    ds_read_b64_tr_b16 v[242:243], v4 offset:34560
    s_mov_b32 s23, 0x20000
    buffer_load_dwordx4 v[60:63], v6, s[8:11], s23 offen offset:3072 sc1
    v_xor_b32 v16, s28, v184
    v_xor_b32 v17, s28, v185
    v_xor_b32 v18, s28, v186
    v_xor_b32 v19, s28, v187
    v_or3_b32 v16, v16, v17, v18
    v_or_b32 v16, v16, v19
    v_cmp_ne_u32 vcc, 0, v16
    s_cbranch_vccnz adaLN_cond__sliding_block_cached__moe_arch_mod__prompt_kernel_mf10r
adaLN_cond__sliding_block_cached__moe_arch_mod__prompt_kernel_mf10b:
    s_waitcnt lgkmcnt(6)
    v_mfma_f32_16x16x32_bf16 v[112:115], v[228:231], v[24:27], v[112:115]
    ds_read_b64_tr_b16 v[244:245], v5 offset:33568
    v_mfma_f32_16x16x32_bf16 v[116:119], v[228:231], v[28:31], v[116:119]
    ds_read_b64_tr_b16 v[246:247], v5 offset:34592
    s_waitcnt lgkmcnt(6)
    v_mfma_f32_16x16x32_bf16 v[120:123], v[232:235], v[24:27], v[120:123]
    v_mfma_f32_16x16x32_bf16 v[124:127], v[232:235], v[28:31], v[124:127]
    s_barrier
    ds_read_b64_tr_b16 v[224:225], v4 offset:49152
    ds_read_b64_tr_b16 v[226:227], v4 offset:50176
    s_waitcnt lgkmcnt(6)
    v_mfma_f32_16x16x32_bf16 v[128:131], v[236:239], v[24:27], v[128:131]
    s_add_u32 s22, s24, 0xb0000
    s_add_u32 m0, s20, 0x14000
    s_nop 0
    buffer_load_dwordx4 v3, s[4:7], s22 offen lds
    ds_read_b64_tr_b16 v[228:229], v5 offset:49184
    v_mfma_f32_16x16x32_bf16 v[132:135], v[236:239], v[28:31], v[132:135]
    ds_read_b64_tr_b16 v[230:231], v5 offset:50208
    s_waitcnt lgkmcnt(6)
    v_mfma_f32_16x16x32_bf16 v[136:139], v[240:243], v[24:27], v[136:139]
    ds_read_b64_tr_b16 v[232:233], v4 offset:49408
    v_mfma_f32_16x16x32_bf16 v[140:143], v[240:243], v[28:31], v[140:143]
    s_add_u32 s22, s24, 0xb2000
    s_add_u32 m0, s20, 0x14400
    s_nop 0
    buffer_load_dwordx4 v3, s[4:7], s22 offen lds
    ds_read_b64_tr_b16 v[234:235], v4 offset:50432
    s_waitcnt lgkmcnt(6)
    v_mfma_f32_16x16x32_bf16 v[144:147], v[244:247], v[24:27], v[144:147]
    ds_read_b64_tr_b16 v[236:237], v5 offset:49440
    v_mfma_f32_16x16x32_bf16 v[148:151], v[244:247], v[28:31], v[148:151]
    ds_read_b64_tr_b16 v[238:239], v5 offset:50464
    s_waitcnt lgkmcnt(6)
    v_mfma_f32_16x16x32_bf16 v[88:91], v[224:227], v[32:35], v[88:91]
    ds_read_b64_tr_b16 v[240:241], v4 offset:49664
    v_mfma_f32_16x16x32_bf16 v[92:95], v[224:227], v[36:39], v[92:95]
    ds_read_b64_tr_b16 v[242:243], v4 offset:50688
    s_waitcnt lgkmcnt(6)
    v_mfma_f32_16x16x32_bf16 v[96:99], v[228:231], v[32:35], v[96:99]
    ds_read_b64_tr_b16 v[244:245], v5 offset:49696
    s_mov_b32 s23, 0x2000
    buffer_load_dwordx4 v[24:27], v6, s[8:11], s23 offen offset:3072 sc1
    v_mfma_f32_16x16x32_bf16 v[100:103], v[228:231], v[36:39], v[100:103]
    ds_read_b64_tr_b16 v[246:247], v5 offset:50720
    s_waitcnt lgkmcnt(6)
    v_mfma_f32_16x16x32_bf16 v[104:107], v[232:235], v[32:35], v[104:107]
    ds_read_b64_tr_b16 v[224:225], v4 offset:49920
    v_mfma_f32_16x16x32_bf16 v[108:111], v[232:235], v[36:39], v[108:111]
    ds_read_b64_tr_b16 v[226:227], v4 offset:50944
    s_mov_b32 s23, 0x22000
    buffer_load_dwordx4 v[28:31], v6, s[8:11], s23 offen offset:3072 sc1
    s_waitcnt lgkmcnt(6)
    v_mfma_f32_16x16x32_bf16 v[112:115], v[236:239], v[32:35], v[112:115]
    ds_read_b64_tr_b16 v[228:229], v5 offset:49952
    v_mfma_f32_16x16x32_bf16 v[116:119], v[236:239], v[36:39], v[116:119]
    ds_read_b64_tr_b16 v[230:231], v5 offset:50976
    s_waitcnt lgkmcnt(6)
    v_mfma_f32_16x16x32_bf16 v[120:123], v[240:243], v[32:35], v[120:123]
    v_mfma_f32_16x16x32_bf16 v[124:127], v[240:243], v[36:39], v[124:127]
    s_barrier
    ds_read_b64_tr_b16 v[232:233], v7 offset:0
    ds_read_b64_tr_b16 v[234:235], v7 offset:1024
    s_waitcnt lgkmcnt(6)
    v_mfma_f32_16x16x32_bf16 v[128:131], v[244:247], v[32:35], v[128:131]
    s_add_u32 s22, s24, 0x130000
    s_add_u32 m0, s20, 0x18000
    s_nop 0
    buffer_load_dwordx4 v3, s[4:7], s22 offen lds
    ds_read_b64_tr_b16 v[236:237], v8 offset:32
    v_mfma_f32_16x16x32_bf16 v[132:135], v[244:247], v[36:39], v[132:135]
    ds_read_b64_tr_b16 v[238:239], v8 offset:1056
    s_waitcnt lgkmcnt(6)
    v_mfma_f32_16x16x32_bf16 v[136:139], v[224:227], v[32:35], v[136:139]
    ds_read_b64_tr_b16 v[240:241], v7 offset:256
    v_mfma_f32_16x16x32_bf16 v[140:143], v[224:227], v[36:39], v[140:143]
    s_add_u32 s22, s24, 0x132000
    s_add_u32 m0, s20, 0x18400
    s_nop 0
    buffer_load_dwordx4 v3, s[4:7], s22 offen lds
    ds_read_b64_tr_b16 v[242:243], v7 offset:1280
    s_waitcnt lgkmcnt(6)
    v_mfma_f32_16x16x32_bf16 v[144:147], v[228:231], v[32:35], v[144:147]
    ds_read_b64_tr_b16 v[244:245], v8 offset:288
    v_mfma_f32_16x16x32_bf16 v[148:151], v[228:231], v[36:39], v[148:151]
    ds_read_b64_tr_b16 v[246:247], v8 offset:1312
    s_waitcnt lgkmcnt(6)
    v_mfma_f32_16x16x32_bf16 v[88:91], v[232:235], v[40:43], v[88:91]
    ds_read_b64_tr_b16 v[224:225], v7 offset:512
    v_mfma_f32_16x16x32_bf16 v[92:95], v[232:235], v[44:47], v[92:95]
    ds_read_b64_tr_b16 v[226:227], v7 offset:1536
    s_waitcnt lgkmcnt(6)
    v_mfma_f32_16x16x32_bf16 v[96:99], v[236:239], v[40:43], v[96:99]
    ds_read_b64_tr_b16 v[228:229], v8 offset:544
    s_mov_b32 s23, 0x4000
    buffer_load_dwordx4 v[32:35], v6, s[8:11], s23 offen offset:3072 sc1
    v_mfma_f32_16x16x32_bf16 v[100:103], v[236:239], v[44:47], v[100:103]
    ds_read_b64_tr_b16 v[230:231], v8 offset:1568
    s_waitcnt lgkmcnt(6)
    v_mfma_f32_16x16x32_bf16 v[104:107], v[240:243], v[40:43], v[104:107]
    ds_read_b64_tr_b16 v[232:233], v7 offset:768
    v_mfma_f32_16x16x32_bf16 v[108:111], v[240:243], v[44:47], v[108:111]
    ds_read_b64_tr_b16 v[234:235], v7 offset:1792
    s_mov_b32 s23, 0x24000
    buffer_load_dwordx4 v[36:39], v6, s[8:11], s23 offen offset:3072 sc1
    s_waitcnt lgkmcnt(6)
    v_mfma_f32_16x16x32_bf16 v[112:115], v[244:247], v[40:43], v[112:115]
    ds_read_b64_tr_b16 v[236:237], v8 offset:800
    v_mfma_f32_16x16x32_bf16 v[116:119], v[244:247], v[44:47], v[116:119]
    ds_read_b64_tr_b16 v[238:239], v8 offset:1824
    s_waitcnt lgkmcnt(6)
    v_mfma_f32_16x16x32_bf16 v[120:123], v[224:227], v[40:43], v[120:123]
    v_mfma_f32_16x16x32_bf16 v[124:127], v[224:227], v[44:47], v[124:127]
    s_waitcnt vmcnt(14)
    s_barrier
    ds_read_b64_tr_b16 v[240:241], v7 offset:16384
    ds_read_b64_tr_b16 v[242:243], v7 offset:17408
    s_waitcnt lgkmcnt(6)
    v_mfma_f32_16x16x32_bf16 v[128:131], v[228:231], v[40:43], v[128:131]
    s_add_u32 s22, s24, 0x1b0000
    s_add_u32 m0, s20, 0x1c000
    s_nop 0
    buffer_load_dwordx4 v3, s[4:7], s22 offen lds
    ds_read_b64_tr_b16 v[244:245], v8 offset:16416
    v_mfma_f32_16x16x32_bf16 v[132:135], v[228:231], v[44:47], v[132:135]
    ds_read_b64_tr_b16 v[246:247], v8 offset:17440
    s_waitcnt lgkmcnt(6)
    v_mfma_f32_16x16x32_bf16 v[136:139], v[232:235], v[40:43], v[136:139]
    ds_read_b64_tr_b16 v[224:225], v7 offset:16640
    v_mfma_f32_16x16x32_bf16 v[140:143], v[232:235], v[44:47], v[140:143]
    s_add_u32 s22, s24, 0x1b2000
    s_add_u32 m0, s20, 0x1c400
    s_nop 0
    buffer_load_dwordx4 v3, s[4:7], s22 offen lds
    ds_read_b64_tr_b16 v[226:227], v7 offset:17664
    s_waitcnt lgkmcnt(6)
    v_mfma_f32_16x16x32_bf16 v[144:147], v[236:239], v[40:43], v[144:147]
    ds_read_b64_tr_b16 v[228:229], v8 offset:16672
    v_mfma_f32_16x16x32_bf16 v[148:151], v[236:239], v[44:47], v[148:151]
    ds_read_b64_tr_b16 v[230:231], v8 offset:17696
    s_waitcnt vmcnt(15) lgkmcnt(6)
    v_mfma_f32_16x16x32_bf16 v[88:91], v[240:243], v[48:51], v[88:91]
    ds_read_b64_tr_b16 v[232:233], v7 offset:16896
    s_waitcnt vmcnt(14)
    v_mfma_f32_16x16x32_bf16 v[92:95], v[240:243], v[52:55], v[92:95]
    ds_read_b64_tr_b16 v[234:235], v7 offset:17920
    s_waitcnt lgkmcnt(6)
    v_mfma_f32_16x16x32_bf16 v[96:99], v[244:247], v[48:51], v[96:99]
    ds_read_b64_tr_b16 v[236:237], v8 offset:16928
    s_mov_b32 s23, 0x6000
    buffer_load_dwordx4 v[40:43], v6, s[8:11], s23 offen offset:3072 sc1
    v_mfma_f32_16x16x32_bf16 v[100:103], v[244:247], v[52:55], v[100:103]
    ds_read_b64_tr_b16 v[238:239], v8 offset:17952
    s_waitcnt lgkmcnt(6)
    v_mfma_f32_16x16x32_bf16 v[104:107], v[224:227], v[48:51], v[104:107]
    ds_read_b64_tr_b16 v[240:241], v7 offset:17152
    v_mfma_f32_16x16x32_bf16 v[108:111], v[224:227], v[52:55], v[108:111]
    ds_read_b64_tr_b16 v[242:243], v7 offset:18176
    s_mov_b32 s23, 0x26000
    buffer_load_dwordx4 v[44:47], v6, s[8:11], s23 offen offset:3072 sc1
    s_waitcnt lgkmcnt(6)
    v_mfma_f32_16x16x32_bf16 v[112:115], v[228:231], v[48:51], v[112:115]
    ds_read_b64_tr_b16 v[244:245], v8 offset:17184
    v_mfma_f32_16x16x32_bf16 v[116:119], v[228:231], v[52:55], v[116:119]
    ds_read_b64_tr_b16 v[246:247], v8 offset:18208
    s_waitcnt lgkmcnt(6)
    v_mfma_f32_16x16x32_bf16 v[120:123], v[232:235], v[48:51], v[120:123]
    v_mfma_f32_16x16x32_bf16 v[124:127], v[232:235], v[52:55], v[124:127]
    s_waitcnt vmcnt(14)
    s_barrier
    ds_read_b64_tr_b16 v[224:225], v4 offset:0
    ds_read_b64_tr_b16 v[226:227], v4 offset:1024
    s_waitcnt lgkmcnt(6)
    v_mfma_f32_16x16x32_bf16 v[128:131], v[236:239], v[48:51], v[128:131]
    s_add_u32 s22, s24, 0x230000
    s_add_u32 m0, s20, 0x20000
    s_nop 0
    buffer_load_dwordx4 v3, s[4:7], s22 offen lds
    ds_read_b64_tr_b16 v[228:229], v5 offset:32
    v_mfma_f32_16x16x32_bf16 v[132:135], v[236:239], v[52:55], v[132:135]
    ds_read_b64_tr_b16 v[230:231], v5 offset:1056
    s_waitcnt lgkmcnt(6)
    v_mfma_f32_16x16x32_bf16 v[136:139], v[240:243], v[48:51], v[136:139]
    ds_read_b64_tr_b16 v[232:233], v4 offset:256
    v_mfma_f32_16x16x32_bf16 v[140:143], v[240:243], v[52:55], v[140:143]
    s_add_u32 s22, s24, 0x232000
    s_add_u32 m0, s20, 0x20400
    s_nop 0
    buffer_load_dwordx4 v3, s[4:7], s22 offen lds
    ds_read_b64_tr_b16 v[234:235], v4 offset:1280
    s_waitcnt lgkmcnt(6)
    v_mfma_f32_16x16x32_bf16 v[144:147], v[244:247], v[48:51], v[144:147]
    ds_read_b64_tr_b16 v[236:237], v5 offset:288
    v_mfma_f32_16x16x32_bf16 v[148:151], v[244:247], v[52:55], v[148:151]
    ds_read_b64_tr_b16 v[238:239], v5 offset:1312
    s_waitcnt vmcnt(15) lgkmcnt(6)
    v_mfma_f32_16x16x32_bf16 v[88:91], v[224:227], v[56:59], v[88:91]
    ds_read_b64_tr_b16 v[240:241], v4 offset:512
    s_waitcnt vmcnt(14)
    v_mfma_f32_16x16x32_bf16 v[92:95], v[224:227], v[60:63], v[92:95]
    ds_read_b64_tr_b16 v[242:243], v4 offset:1536
    s_waitcnt lgkmcnt(6)
    v_mfma_f32_16x16x32_bf16 v[96:99], v[228:231], v[56:59], v[96:99]
    ds_read_b64_tr_b16 v[244:245], v5 offset:544
    s_mov_b32 s23, 0x8000
    buffer_load_dwordx4 v[48:51], v6, s[8:11], s23 offen offset:3072 sc1
    v_mfma_f32_16x16x32_bf16 v[100:103], v[228:231], v[60:63], v[100:103]
    ds_read_b64_tr_b16 v[246:247], v5 offset:1568
    s_waitcnt lgkmcnt(6)
    v_mfma_f32_16x16x32_bf16 v[104:107], v[232:235], v[56:59], v[104:107]
    ds_read_b64_tr_b16 v[224:225], v4 offset:768
    v_mfma_f32_16x16x32_bf16 v[108:111], v[232:235], v[60:63], v[108:111]
    ds_read_b64_tr_b16 v[226:227], v4 offset:1792
    s_mov_b32 s23, 0x28000
    buffer_load_dwordx4 v[52:55], v6, s[8:11], s23 offen offset:3072 sc1
    s_waitcnt lgkmcnt(6)
    v_mfma_f32_16x16x32_bf16 v[112:115], v[236:239], v[56:59], v[112:115]
    ds_read_b64_tr_b16 v[228:229], v5 offset:800
    v_mfma_f32_16x16x32_bf16 v[116:119], v[236:239], v[60:63], v[116:119]
    ds_read_b64_tr_b16 v[230:231], v5 offset:1824
    s_waitcnt lgkmcnt(6)
    v_mfma_f32_16x16x32_bf16 v[120:123], v[240:243], v[56:59], v[120:123]
    v_mfma_f32_16x16x32_bf16 v[124:127], v[240:243], v[60:63], v[124:127]
    s_waitcnt vmcnt(14)
    s_barrier
    ds_read_b64_tr_b16 v[232:233], v4 offset:16384
    ds_read_b64_tr_b16 v[234:235], v4 offset:17408
    s_waitcnt lgkmcnt(6)
    v_mfma_f32_16x16x32_bf16 v[128:131], v[244:247], v[56:59], v[128:131]
    s_add_u32 s22, s24, 0x2b0000
    s_add_u32 m0, s20, 0x24000
    s_nop 0
    buffer_load_dwordx4 v3, s[4:7], s22 offen lds
    ds_read_b64_tr_b16 v[236:237], v5 offset:16416
    v_mfma_f32_16x16x32_bf16 v[132:135], v[244:247], v[60:63], v[132:135]
    ds_read_b64_tr_b16 v[238:239], v5 offset:17440
    s_waitcnt lgkmcnt(6)
    v_mfma_f32_16x16x32_bf16 v[136:139], v[224:227], v[56:59], v[136:139]
    ds_read_b64_tr_b16 v[240:241], v4 offset:16640
    v_mfma_f32_16x16x32_bf16 v[140:143], v[224:227], v[60:63], v[140:143]
    s_add_u32 s22, s24, 0x2b2000
    s_add_u32 m0, s20, 0x24400
    s_nop 0
    buffer_load_dwordx4 v3, s[4:7], s22 offen lds
    ds_read_b64_tr_b16 v[242:243], v4 offset:17664
    s_waitcnt lgkmcnt(6)
    v_mfma_f32_16x16x32_bf16 v[144:147], v[228:231], v[56:59], v[144:147]
    ds_read_b64_tr_b16 v[244:245], v5 offset:16672
    v_mfma_f32_16x16x32_bf16 v[148:151], v[228:231], v[60:63], v[148:151]
    ds_read_b64_tr_b16 v[246:247], v5 offset:17696
    s_waitcnt vmcnt(15) lgkmcnt(6)
    v_mfma_f32_16x16x32_bf16 v[88:91], v[232:235], v[24:27], v[88:91]
    ds_read_b64_tr_b16 v[224:225], v4 offset:16896
    s_waitcnt vmcnt(14)
    v_mfma_f32_16x16x32_bf16 v[92:95], v[232:235], v[28:31], v[92:95]
    ds_read_b64_tr_b16 v[226:227], v4 offset:17920
    s_waitcnt lgkmcnt(6)
    v_mfma_f32_16x16x32_bf16 v[96:99], v[236:239], v[24:27], v[96:99]
    ds_read_b64_tr_b16 v[228:229], v5 offset:16928
    s_mov_b32 s23, 0xa000
    buffer_load_dwordx4 v[56:59], v6, s[8:11], s23 offen offset:3072 sc1
    v_mfma_f32_16x16x32_bf16 v[100:103], v[236:239], v[28:31], v[100:103]
    ds_read_b64_tr_b16 v[230:231], v5 offset:17952
    s_waitcnt lgkmcnt(6)
    v_mfma_f32_16x16x32_bf16 v[104:107], v[240:243], v[24:27], v[104:107]
    ds_read_b64_tr_b16 v[232:233], v4 offset:17152
    v_mfma_f32_16x16x32_bf16 v[108:111], v[240:243], v[28:31], v[108:111]
    ds_read_b64_tr_b16 v[234:235], v4 offset:18176
    s_mov_b32 s23, 0x2a000
    buffer_load_dwordx4 v[60:63], v6, s[8:11], s23 offen offset:3072 sc1
    s_waitcnt lgkmcnt(6)
    v_mfma_f32_16x16x32_bf16 v[112:115], v[244:247], v[24:27], v[112:115]
    ds_read_b64_tr_b16 v[236:237], v5 offset:17184
    v_mfma_f32_16x16x32_bf16 v[116:119], v[244:247], v[28:31], v[116:119]
    ds_read_b64_tr_b16 v[238:239], v5 offset:18208
    s_waitcnt lgkmcnt(6)
    v_mfma_f32_16x16x32_bf16 v[120:123], v[224:227], v[24:27], v[120:123]
    v_mfma_f32_16x16x32_bf16 v[124:127], v[224:227], v[28:31], v[124:127]
    s_waitcnt vmcnt(14)
    s_barrier
    ds_read_b64_tr_b16 v[240:241], v4 offset:32768
    ds_read_b64_tr_b16 v[242:243], v4 offset:33792
    s_waitcnt lgkmcnt(6)
    v_mfma_f32_16x16x32_bf16 v[128:131], v[228:231], v[24:27], v[128:131]
    s_add_u32 s22, s24, 0x330000
    s_add_u32 m0, s20, 0x10000
    s_nop 0
    buffer_load_dwordx4 v3, s[4:7], s22 offen lds
    ds_read_b64_tr_b16 v[244:245], v5 offset:32800
    v_mfma_f32_16x16x32_bf16 v[132:135], v[228:231], v[28:31], v[132:135]
    ds_read_b64_tr_b16 v[246:247], v5 offset:33824
    s_waitcnt lgkmcnt(6)
    v_mfma_f32_16x16x32_bf16 v[136:139], v[232:235], v[24:27], v[136:139]
    ds_read_b64_tr_b16 v[224:225], v4 offset:33024
    v_mfma_f32_16x16x32_bf16 v[140:143], v[232:235], v[28:31], v[140:143]
    s_add_u32 s22, s24, 0x332000
    s_add_u32 m0, s20, 0x10400
    s_nop 0
    buffer_load_dwordx4 v3, s[4:7], s22 offen lds
    ds_read_b64_tr_b16 v[226:227], v4 offset:34048
    s_waitcnt lgkmcnt(6)
    v_mfma_f32_16x16x32_bf16 v[144:147], v[236:239], v[24:27], v[144:147]
    ds_read_b64_tr_b16 v[228:229], v5 offset:33056
    v_mfma_f32_16x16x32_bf16 v[148:151], v[236:239], v[28:31], v[148:151]
    ds_read_b64_tr_b16 v[230:231], v5 offset:34080
    s_waitcnt vmcnt(15) lgkmcnt(6)
    v_mfma_f32_16x16x32_bf16 v[88:91], v[240:243], v[32:35], v[88:91]
    ds_read_b64_tr_b16 v[232:233], v4 offset:33280
    s_waitcnt vmcnt(14)
    v_mfma_f32_16x16x32_bf16 v[92:95], v[240:243], v[36:39], v[92:95]
    ds_read_b64_tr_b16 v[234:235], v4 offset:34304
    s_waitcnt lgkmcnt(6)
    v_mfma_f32_16x16x32_bf16 v[96:99], v[244:247], v[32:35], v[96:99]
    ds_read_b64_tr_b16 v[236:237], v5 offset:33312
    s_mov_b32 s23, 0xc000
    buffer_load_dwordx4 v[24:27], v6, s[8:11], s23 offen offset:3072 sc1
    v_mfma_f32_16x16x32_bf16 v[100:103], v[244:247], v[36:39], v[100:103]
    ds_read_b64_tr_b16 v[238:239], v5 offset:34336
    s_waitcnt lgkmcnt(6)
    v_mfma_f32_16x16x32_bf16 v[104:107], v[224:227], v[32:35], v[104:107]
    ds_read_b64_tr_b16 v[240:241], v4 offset:33536
    v_mfma_f32_16x16x32_bf16 v[108:111], v[224:227], v[36:39], v[108:111]
    ds_read_b64_tr_b16 v[242:243], v4 offset:34560
    s_mov_b32 s23, 0x2c000
    buffer_load_dwordx4 v[28:31], v6, s[8:11], s23 offen offset:3072 sc1
    v_lshrrev_b32 v16, 4, v1
    v_lshlrev_b32 v16, 3, v16
    s_lshl_b32 s16, s31, 8
    s_add_u32 s16, s16, 0x540000
    buffer_load_dwordx2 v[248:249], v16, s[8:11], s16 offen offset:0 sc1
    buffer_load_dwordx2 v[250:251], v16, s[8:11], s16 offen offset:32 sc1
    buffer_load_dwordx2 v[252:253], v16, s[8:11], s16 offen offset:64 sc1
    buffer_load_dwordx2 v[254:255], v16, s[8:11], s16 offen offset:96 sc1
    s_waitcnt lgkmcnt(6)
    v_mfma_f32_16x16x32_bf16 v[112:115], v[228:231], v[32:35], v[112:115]
    ds_read_b64_tr_b16 v[244:245], v5 offset:33568
    v_mfma_f32_16x16x32_bf16 v[116:119], v[228:231], v[36:39], v[116:119]
    ds_read_b64_tr_b16 v[246:247], v5 offset:34592
    s_waitcnt lgkmcnt(6)
    v_mfma_f32_16x16x32_bf16 v[120:123], v[232:235], v[32:35], v[120:123]
    v_mfma_f32_16x16x32_bf16 v[124:127], v[232:235], v[36:39], v[124:127]
    s_waitcnt vmcnt(18)
    s_barrier
    ds_read_b64_tr_b16 v[224:225], v4 offset:49152
    ds_read_b64_tr_b16 v[226:227], v4 offset:50176
    s_waitcnt lgkmcnt(6)
    v_mfma_f32_16x16x32_bf16 v[128:131], v[236:239], v[32:35], v[128:131]
    s_add_u32 s22, s24, 0x3b0000
    s_add_u32 m0, s20, 0x14000
    s_nop 0
    buffer_load_dwordx4 v3, s[4:7], s22 offen lds
    ds_read_b64_tr_b16 v[228:229], v5 offset:49184
    v_mfma_f32_16x16x32_bf16 v[132:135], v[236:239], v[36:39], v[132:135]
    ds_read_b64_tr_b16 v[230:231], v5 offset:50208
    s_waitcnt lgkmcnt(6)
    v_mfma_f32_16x16x32_bf16 v[136:139], v[240:243], v[32:35], v[136:139]
    ds_read_b64_tr_b16 v[232:233], v4 offset:49408
    v_mfma_f32_16x16x32_bf16 v[140:143], v[240:243], v[36:39], v[140:143]
    s_add_u32 s22, s24, 0x3b2000
    s_add_u32 m0, s20, 0x14400
    s_nop 0
    buffer_load_dwordx4 v3, s[4:7], s22 offen lds
    ds_read_b64_tr_b16 v[234:235], v4 offset:50432
    s_waitcnt lgkmcnt(6)
    v_mfma_f32_16x16x32_bf16 v[144:147], v[244:247], v[32:35], v[144:147]
    ds_read_b64_tr_b16 v[236:237], v5 offset:49440
    v_mfma_f32_16x16x32_bf16 v[148:151], v[244:247], v[36:39], v[148:151]
    ds_read_b64_tr_b16 v[238:239], v5 offset:50464
    s_waitcnt vmcnt(19) lgkmcnt(6)
    v_mfma_f32_16x16x32_bf16 v[88:91], v[224:227], v[40:43], v[88:91]
    ds_read_b64_tr_b16 v[240:241], v4 offset:49664
    s_waitcnt vmcnt(18)
    v_mfma_f32_16x16x32_bf16 v[92:95], v[224:227], v[44:47], v[92:95]
    ds_read_b64_tr_b16 v[242:243], v4 offset:50688
    s_waitcnt lgkmcnt(6)
    v_mfma_f32_16x16x32_bf16 v[96:99], v[228:231], v[40:43], v[96:99]
    ds_read_b64_tr_b16 v[244:245], v5 offset:49696
    s_mov_b32 s23, 0xe000
    buffer_load_dwordx4 v[32:35], v6, s[8:11], s23 offen offset:3072 sc1
    v_mfma_f32_16x16x32_bf16 v[100:103], v[228:231], v[44:47], v[100:103]
    ds_read_b64_tr_b16 v[246:247], v5 offset:50720
    s_waitcnt lgkmcnt(6)
    v_mfma_f32_16x16x32_bf16 v[104:107], v[232:235], v[40:43], v[104:107]
    ds_read_b64_tr_b16 v[224:225], v4 offset:49920
    v_mfma_f32_16x16x32_bf16 v[108:111], v[232:235], v[44:47], v[108:111]
    ds_read_b64_tr_b16 v[226:227], v4 offset:50944
    s_mov_b32 s23, 0x2e000
    buffer_load_dwordx4 v[36:39], v6, s[8:11], s23 offen offset:3072 sc1
    s_waitcnt lgkmcnt(6)
    v_mfma_f32_16x16x32_bf16 v[112:115], v[236:239], v[40:43], v[112:115]
    ds_read_b64_tr_b16 v[228:229], v5 offset:49952
    v_mfma_f32_16x16x32_bf16 v[116:119], v[236:239], v[44:47], v[116:119]
    ds_read_b64_tr_b16 v[230:231], v5 offset:50976
    s_waitcnt lgkmcnt(6)
    v_mfma_f32_16x16x32_bf16 v[120:123], v[240:243], v[40:43], v[120:123]
    v_mfma_f32_16x16x32_bf16 v[124:127], v[240:243], v[44:47], v[124:127]
    s_waitcnt vmcnt(18)
    s_barrier
    ds_read_b64_tr_b16 v[232:233], v7 offset:0
    ds_read_b64_tr_b16 v[234:235], v7 offset:1024
    s_waitcnt lgkmcnt(6)
    v_mfma_f32_16x16x32_bf16 v[128:131], v[244:247], v[40:43], v[128:131]
    ds_read_b64_tr_b16 v[236:237], v8 offset:32
    v_mfma_f32_16x16x32_bf16 v[132:135], v[244:247], v[44:47], v[132:135]
    ds_read_b64_tr_b16 v[238:239], v8 offset:1056
    s_waitcnt lgkmcnt(6)
    v_mfma_f32_16x16x32_bf16 v[136:139], v[224:227], v[40:43], v[136:139]
    ds_read_b64_tr_b16 v[240:241], v7 offset:256
    v_mfma_f32_16x16x32_bf16 v[140:143], v[224:227], v[44:47], v[140:143]
    ds_read_b64_tr_b16 v[242:243], v7 offset:1280
    s_waitcnt lgkmcnt(6)
    v_mfma_f32_16x16x32_bf16 v[144:147], v[228:231], v[40:43], v[144:147]
    ds_read_b64_tr_b16 v[244:245], v8 offset:288
    v_mfma_f32_16x16x32_bf16 v[148:151], v[228:231], v[44:47], v[148:151]
    ds_read_b64_tr_b16 v[246:247], v8 offset:1312
    s_waitcnt vmcnt(17) lgkmcnt(6)
    v_mfma_f32_16x16x32_bf16 v[88:91], v[232:235], v[48:51], v[88:91]
    ds_read_b64_tr_b16 v[224:225], v7 offset:512
    s_waitcnt vmcnt(16)
    v_mfma_f32_16x16x32_bf16 v[92:95], v[232:235], v[52:55], v[92:95]
    ds_read_b64_tr_b16 v[226:227], v7 offset:1536
    s_waitcnt lgkmcnt(6)
    v_mfma_f32_16x16x32_bf16 v[96:99], v[236:239], v[48:51], v[96:99]
    ds_read_b64_tr_b16 v[228:229], v8 offset:544
    v_mfma_f32_16x16x32_bf16 v[100:103], v[236:239], v[52:55], v[100:103]
    ds_read_b64_tr_b16 v[230:231], v8 offset:1568
    s_waitcnt lgkmcnt(6)
    v_mfma_f32_16x16x32_bf16 v[104:107], v[240:243], v[48:51], v[104:107]
    ds_read_b64_tr_b16 v[232:233], v7 offset:768
    v_mfma_f32_16x16x32_bf16 v[108:111], v[240:243], v[52:55], v[108:111]
    ds_read_b64_tr_b16 v[234:235], v7 offset:1792
    s_waitcnt lgkmcnt(6)
    v_mfma_f32_16x16x32_bf16 v[112:115], v[244:247], v[48:51], v[112:115]
    ds_read_b64_tr_b16 v[236:237], v8 offset:800
    v_mfma_f32_16x16x32_bf16 v[116:119], v[244:247], v[52:55], v[116:119]
    ds_read_b64_tr_b16 v[238:239], v8 offset:1824
    s_waitcnt lgkmcnt(6)
    v_mfma_f32_16x16x32_bf16 v[120:123], v[224:227], v[48:51], v[120:123]
    v_mfma_f32_16x16x32_bf16 v[124:127], v[224:227], v[52:55], v[124:127]
    s_waitcnt vmcnt(14)
    s_barrier
    ds_read_b64_tr_b16 v[240:241], v7 offset:16384
    ds_read_b64_tr_b16 v[242:243], v7 offset:17408
    s_waitcnt lgkmcnt(6)
    v_mfma_f32_16x16x32_bf16 v[128:131], v[228:231], v[48:51], v[128:131]
    ds_read_b64_tr_b16 v[244:245], v8 offset:16416
    v_mfma_f32_16x16x32_bf16 v[132:135], v[228:231], v[52:55], v[132:135]
    ds_read_b64_tr_b16 v[246:247], v8 offset:17440
    s_waitcnt lgkmcnt(6)
    v_mfma_f32_16x16x32_bf16 v[136:139], v[232:235], v[48:51], v[136:139]
    ds_read_b64_tr_b16 v[224:225], v7 offset:16640
    v_mfma_f32_16x16x32_bf16 v[140:143], v[232:235], v[52:55], v[140:143]
    ds_read_b64_tr_b16 v[226:227], v7 offset:17664
    s_waitcnt lgkmcnt(6)
    v_mfma_f32_16x16x32_bf16 v[144:147], v[236:239], v[48:51], v[144:147]
    ds_read_b64_tr_b16 v[228:229], v8 offset:16672
    v_mfma_f32_16x16x32_bf16 v[148:151], v[236:239], v[52:55], v[148:151]
    ds_read_b64_tr_b16 v[230:231], v8 offset:17696
    s_waitcnt vmcnt(13) lgkmcnt(6)
    v_mfma_f32_16x16x32_bf16 v[88:91], v[240:243], v[56:59], v[88:91]
    ds_read_b64_tr_b16 v[232:233], v7 offset:16896
    s_waitcnt vmcnt(12)
    v_mfma_f32_16x16x32_bf16 v[92:95], v[240:243], v[60:63], v[92:95]
    ds_read_b64_tr_b16 v[234:235], v7 offset:17920
    s_waitcnt lgkmcnt(6)
    v_mfma_f32_16x16x32_bf16 v[96:99], v[244:247], v[56:59], v[96:99]
    ds_read_b64_tr_b16 v[236:237], v8 offset:16928
    v_mfma_f32_16x16x32_bf16 v[100:103], v[244:247], v[60:63], v[100:103]
    ds_read_b64_tr_b16 v[238:239], v8 offset:17952
    s_waitcnt lgkmcnt(6)
    v_mfma_f32_16x16x32_bf16 v[104:107], v[224:227], v[56:59], v[104:107]
    ds_read_b64_tr_b16 v[240:241], v7 offset:17152
    v_mfma_f32_16x16x32_bf16 v[108:111], v[224:227], v[60:63], v[108:111]
    ds_read_b64_tr_b16 v[242:243], v7 offset:18176
    s_waitcnt lgkmcnt(6)
    v_mfma_f32_16x16x32_bf16 v[112:115], v[228:231], v[56:59], v[112:115]
    ds_read_b64_tr_b16 v[244:245], v8 offset:17184
    v_mfma_f32_16x16x32_bf16 v[116:119], v[228:231], v[60:63], v[116:119]
    ds_read_b64_tr_b16 v[246:247], v8 offset:18208
    s_waitcnt lgkmcnt(6)
    v_mfma_f32_16x16x32_bf16 v[120:123], v[232:235], v[56:59], v[120:123]
    v_mfma_f32_16x16x32_bf16 v[124:127], v[232:235], v[60:63], v[124:127]
    s_waitcnt vmcnt(10)
    s_barrier
    ds_read_b64_tr_b16 v[224:225], v4 offset:0
    ds_read_b64_tr_b16 v[226:227], v4 offset:1024
    s_waitcnt lgkmcnt(6)
    v_mfma_f32_16x16x32_bf16 v[128:131], v[236:239], v[56:59], v[128:131]
    ds_read_b64_tr_b16 v[228:229], v5 offset:32
    v_mfma_f32_16x16x32_bf16 v[132:135], v[236:239], v[60:63], v[132:135]
    ds_read_b64_tr_b16 v[230:231], v5 offset:1056
    s_waitcnt lgkmcnt(6)
    v_mfma_f32_16x16x32_bf16 v[136:139], v[240:243], v[56:59], v[136:139]
    ds_read_b64_tr_b16 v[232:233], v4 offset:256
    v_mfma_f32_16x16x32_bf16 v[140:143], v[240:243], v[60:63], v[140:143]
    ds_read_b64_tr_b16 v[234:235], v4 offset:1280
    s_waitcnt lgkmcnt(6)
    v_mfma_f32_16x16x32_bf16 v[144:147], v[244:247], v[56:59], v[144:147]
    ds_read_b64_tr_b16 v[236:237], v5 offset:288
    v_mfma_f32_16x16x32_bf16 v[148:151], v[244:247], v[60:63], v[148:151]
    ds_read_b64_tr_b16 v[238:239], v5 offset:1312
    s_waitcnt vmcnt(9) lgkmcnt(6)
    v_mfma_f32_16x16x32_bf16 v[88:91], v[224:227], v[24:27], v[88:91]
    ds_read_b64_tr_b16 v[240:241], v4 offset:512
    s_waitcnt vmcnt(8)
    v_mfma_f32_16x16x32_bf16 v[92:95], v[224:227], v[28:31], v[92:95]
    ds_read_b64_tr_b16 v[242:243], v4 offset:1536
    s_waitcnt lgkmcnt(6)
    v_mfma_f32_16x16x32_bf16 v[96:99], v[228:231], v[24:27], v[96:99]
    ds_read_b64_tr_b16 v[244:245], v5 offset:544
    v_mfma_f32_16x16x32_bf16 v[100:103], v[228:231], v[28:31], v[100:103]
    ds_read_b64_tr_b16 v[246:247], v5 offset:1568
    s_waitcnt lgkmcnt(6)
    v_mfma_f32_16x16x32_bf16 v[104:107], v[232:235], v[24:27], v[104:107]
    ds_read_b64_tr_b16 v[224:225], v4 offset:768
    v_mfma_f32_16x16x32_bf16 v[108:111], v[232:235], v[28:31], v[108:111]
    ds_read_b64_tr_b16 v[226:227], v4 offset:1792
    s_waitcnt lgkmcnt(6)
    v_mfma_f32_16x16x32_bf16 v[112:115], v[236:239], v[24:27], v[112:115]
    ds_read_b64_tr_b16 v[228:229], v5 offset:800
    v_mfma_f32_16x16x32_bf16 v[116:119], v[236:239], v[28:31], v[116:119]
    ds_read_b64_tr_b16 v[230:231], v5 offset:1824
    s_waitcnt lgkmcnt(6)
    v_mfma_f32_16x16x32_bf16 v[120:123], v[240:243], v[24:27], v[120:123]
    v_mfma_f32_16x16x32_bf16 v[124:127], v[240:243], v[28:31], v[124:127]
    s_waitcnt vmcnt(2)
    s_barrier
    ds_read_b64_tr_b16 v[232:233], v4 offset:16384
    ds_read_b64_tr_b16 v[234:235], v4 offset:17408
    s_waitcnt lgkmcnt(6)
    v_mfma_f32_16x16x32_bf16 v[128:131], v[244:247], v[24:27], v[128:131]
    ds_read_b64_tr_b16 v[236:237], v5 offset:16416
    v_mfma_f32_16x16x32_bf16 v[132:135], v[244:247], v[28:31], v[132:135]
    ds_read_b64_tr_b16 v[238:239], v5 offset:17440
    s_waitcnt lgkmcnt(6)
    v_mfma_f32_16x16x32_bf16 v[136:139], v[224:227], v[24:27], v[136:139]
    ds_read_b64_tr_b16 v[240:241], v4 offset:16640
    v_mfma_f32_16x16x32_bf16 v[140:143], v[224:227], v[28:31], v[140:143]
    ds_read_b64_tr_b16 v[242:243], v4 offset:17664
    s_waitcnt lgkmcnt(6)
    v_mfma_f32_16x16x32_bf16 v[144:147], v[228:231], v[24:27], v[144:147]
    ds_read_b64_tr_b16 v[244:245], v5 offset:16672
    v_mfma_f32_16x16x32_bf16 v[148:151], v[228:231], v[28:31], v[148:151]
    ds_read_b64_tr_b16 v[246:247], v5 offset:17696
    s_waitcnt vmcnt(1) lgkmcnt(6)
    v_mfma_f32_16x16x32_bf16 v[88:91], v[232:235], v[32:35], v[88:91]
    ds_read_b64_tr_b16 v[224:225], v4 offset:16896
    s_waitcnt vmcnt(0)
    v_mfma_f32_16x16x32_bf16 v[92:95], v[232:235], v[36:39], v[92:95]
    ds_read_b64_tr_b16 v[226:227], v4 offset:17920
    s_waitcnt lgkmcnt(6)
    v_mfma_f32_16x16x32_bf16 v[96:99], v[236:239], v[32:35], v[96:99]
    ds_read_b64_tr_b16 v[228:229], v5 offset:16928
    v_mfma_f32_16x16x32_bf16 v[100:103], v[236:239], v[36:39], v[100:103]
    ds_read_b64_tr_b16 v[230:231], v5 offset:17952
    s_waitcnt lgkmcnt(6)
    v_mfma_f32_16x16x32_bf16 v[104:107], v[240:243], v[32:35], v[104:107]
    ds_read_b64_tr_b16 v[232:233], v4 offset:17152
    v_mfma_f32_16x16x32_bf16 v[108:111], v[240:243], v[36:39], v[108:111]
    ds_read_b64_tr_b16 v[234:235], v4 offset:18176
    s_waitcnt lgkmcnt(6)
    v_mfma_f32_16x16x32_bf16 v[112:115], v[244:247], v[32:35], v[112:115]
    ds_read_b64_tr_b16 v[236:237], v5 offset:17184
    v_mfma_f32_16x16x32_bf16 v[116:119], v[244:247], v[36:39], v[116:119]
    ds_read_b64_tr_b16 v[238:239], v5 offset:18208
    s_waitcnt lgkmcnt(6)
    v_mfma_f32_16x16x32_bf16 v[120:123], v[224:227], v[32:35], v[120:123]
    v_mfma_f32_16x16x32_bf16 v[124:127], v[224:227], v[36:39], v[124:127]
    s_waitcnt lgkmcnt(4)
    v_mfma_f32_16x16x32_bf16 v[128:131], v[228:231], v[32:35], v[128:131]
    v_mfma_f32_16x16x32_bf16 v[132:135], v[228:231], v[36:39], v[132:135]
    s_waitcnt lgkmcnt(2)
    v_mfma_f32_16x16x32_bf16 v[136:139], v[232:235], v[32:35], v[136:139]
    v_mfma_f32_16x16x32_bf16 v[140:143], v[232:235], v[36:39], v[140:143]
    s_waitcnt lgkmcnt(0)
    v_mfma_f32_16x16x32_bf16 v[144:147], v[236:239], v[32:35], v[144:147]
    v_mfma_f32_16x16x32_bf16 v[148:151], v[236:239], v[36:39], v[148:151]
    s_lshl_b32 s16, s3, 13
    s_xor_b32 s17, s16, 0x8000
    s_add_u32 s16, s16, 0x18000
    s_add_u32 s17, s17, 0x18000
    v_add_u32 v16, s16, v2
    s_mov_b32 s16, s17
    v_add_u32 v17, s16, v2
    ds_write_b128 v16, v[120:123] offset:0
    ds_write_b128 v16, v[124:127] offset:1024
    ds_write_b128 v16, v[128:131] offset:2048
    ds_write_b128 v16, v[132:135] offset:3072
    ds_write_b128 v16, v[136:139] offset:4096
    ds_write_b128 v16, v[140:143] offset:5120
    ds_write_b128 v16, v[144:147] offset:6144
    ds_write_b128 v16, v[148:151] offset:7168
    v_lshlrev_b32 v24, 16, v248
    v_and_b32 v25, 0xffff0000, v248
    v_lshlrev_b32 v26, 16, v249
    v_and_b32 v27, 0xffff0000, v249
    v_lshlrev_b32 v28, 16, v250
    v_and_b32 v29, 0xffff0000, v250
    v_lshlrev_b32 v30, 16, v251
    v_and_b32 v31, 0xffff0000, v251
    v_lshlrev_b32 v32, 16, v252
    v_and_b32 v33, 0xffff0000, v252
    v_lshlrev_b32 v34, 16, v253
    v_and_b32 v35, 0xffff0000, v253
    v_lshlrev_b32 v36, 16, v254
    v_and_b32 v37, 0xffff0000, v254
    v_lshlrev_b32 v38, 16, v255
    v_and_b32 v39, 0xffff0000, v255
    v_and_b32 v18, 15, v1
    v_lshlrev_b32 v18, 6, v18
    v_lshrrev_b32 v19, 4, v1
    v_and_b32 v20, 1, v19
    v_lshl_add_u32 v18, v20, 5, v18
    v_lshrrev_b32 v19, 1, v19
    v_lshl_add_u32 v18, v19, 4, v18
    s_and_b32 s17, s3, 3
    s_lshl_b32 s18, s30, 2
    s_add_u32 s18, s18, s17
    s_lshl_b32 s18, s18, 16
    s_lshl_b32 s19, s15, 22
    s_add_u32 s18, s18, s19
    s_lshl_b32 s19, s31, 12
    s_add_u32 s18, s18, s19
    s_add_u32 s18, s18, 0x2000000
    s_add_u32 s19, s18, 32768
    s_waitcnt lgkmcnt(0)
    s_barrier
    ds_read_b128 v[40:43], v17 offset:0
    ds_read_b128 v[44:47], v17 offset:1024
    ds_read_b128 v[48:51], v17 offset:2048
    ds_read_b128 v[52:55], v17 offset:3072
    ds_read_b128 v[56:59], v17 offset:4096
    ds_read_b128 v[60:63], v17 offset:5120
    ds_read_b128 v[64:67], v17 offset:6144
    ds_read_b128 v[68:71], v17 offset:7168
    s_waitcnt lgkmcnt(7)
    v_pk_add_f32 v[88:89], v[88:89], v[40:41]
    v_pk_add_f32 v[90:91], v[90:91], v[42:43]
    v_pk_mul_f32 v[88:89], v[88:89], v[24:25]
    v_pk_mul_f32 v[90:91], v[90:91], v[26:27]
    v_cvt_pk_bf16_f32 v224, v88, v89
    v_cvt_pk_bf16_f32 v225, v90, v91
    s_waitcnt lgkmcnt(5)
    v_pk_add_f32 v[96:97], v[96:97], v[48:49]
    v_pk_add_f32 v[98:99], v[98:99], v[50:51]
    v_pk_mul_f32 v[96:97], v[96:97], v[28:29]
    v_pk_mul_f32 v[98:99], v[98:99], v[30:31]
    v_cvt_pk_bf16_f32 v226, v96, v97
    v_cvt_pk_bf16_f32 v227, v98, v99
    s_nop 0
    v_permlane16_swap_b32 v224, v226
    v_permlane16_swap_b32 v225, v227
    buffer_store_dwordx4 v[224:227], v18, s[8:11], s18 offen offset:0 sc1
    v_pk_add_f32 v[92:93], v[92:93], v[44:45]
    v_pk_add_f32 v[94:95], v[94:95], v[46:47]
    v_pk_mul_f32 v[92:93], v[92:93], v[24:25]
    v_pk_mul_f32 v[94:95], v[94:95], v[26:27]
    v_cvt_pk_bf16_f32 v228, v92, v93
    v_cvt_pk_bf16_f32 v229, v94, v95
    s_waitcnt lgkmcnt(4)
    v_pk_add_f32 v[100:101], v[100:101], v[52:53]
    v_pk_add_f32 v[102:103], v[102:103], v[54:55]
    v_pk_mul_f32 v[100:101], v[100:101], v[28:29]
    v_pk_mul_f32 v[102:103], v[102:103], v[30:31]
    v_cvt_pk_bf16_f32 v230, v100, v101
    v_cvt_pk_bf16_f32 v231, v102, v103
    s_nop 0
    v_permlane16_swap_b32 v228, v230
    v_permlane16_swap_b32 v229, v231
    buffer_store_dwordx4 v[228:231], v18, s[8:11], s19 offen offset:0 sc1
    s_waitcnt lgkmcnt(3)
    v_pk_add_f32 v[104:105], v[104:105], v[56:57]
    v_pk_add_f32 v[106:107], v[106:107], v[58:59]
    v_pk_mul_f32 v[104:105], v[104:105], v[32:33]
    v_pk_mul_f32 v[106:107], v[106:107], v[34:35]
    v_cvt_pk_bf16_f32 v232, v104, v105
    v_cvt_pk_bf16_f32 v233, v106, v107
    s_waitcnt lgkmcnt(1)
    v_pk_add_f32 v[112:113], v[112:113], v[64:65]
    v_pk_add_f32 v[114:115], v[114:115], v[66:67]
    v_pk_mul_f32 v[112:113], v[112:113], v[36:37]
    v_pk_mul_f32 v[114:115], v[114:115], v[38:39]
    v_cvt_pk_bf16_f32 v234, v112, v113
    v_cvt_pk_bf16_f32 v235, v114, v115
    s_nop 0
    v_permlane16_swap_b32 v232, v234
    v_permlane16_swap_b32 v233, v235
    buffer_store_dwordx4 v[232:235], v18, s[8:11], s18 offen offset:1024 sc1
    v_pk_add_f32 v[108:109], v[108:109], v[60:61]
    v_pk_add_f32 v[110:111], v[110:111], v[62:63]
    v_pk_mul_f32 v[108:109], v[108:109], v[32:33]
    v_pk_mul_f32 v[110:111], v[110:111], v[34:35]
    v_cvt_pk_bf16_f32 v236, v108, v109
    v_cvt_pk_bf16_f32 v237, v110, v111
    s_waitcnt lgkmcnt(0)
    v_pk_add_f32 v[116:117], v[116:117], v[68:69]
    v_pk_add_f32 v[118:119], v[118:119], v[70:71]
    v_pk_mul_f32 v[116:117], v[116:117], v[36:37]
    v_pk_mul_f32 v[118:119], v[118:119], v[38:39]
    v_cvt_pk_bf16_f32 v238, v116, v117
    v_cvt_pk_bf16_f32 v239, v118, v119
    s_nop 0
    v_permlane16_swap_b32 v236, v238
    v_permlane16_swap_b32 v237, v239
    buffer_store_dwordx4 v[236:239], v18, s[8:11], s19 offen offset:1024 sc1
    s_mov_b64 s[64:65], s[44:45]
    s_mov_b32 s66, 0x800
    s_mov_b32 s67, 0x20000
    s_mov_b64 s[76:77], s[32:33]
    s_mov_b32 s78, 0x400000
    s_mov_b32 s79, 0x20000
    s_mov_b64 s[68:69], s[56:57]
    s_mov_b32 s70, 0x400000
    s_mov_b32 s71, 0x20000
    s_lshl_b32 s14, s31, 1
    s_add_u32 s14, s14, s15
    s_lshl_b32 s14, s14, 3
    s_add_u32 s14, s14, s3
    s_lshl_b32 s16, s30, 7
    s_add_u32 s14, s14, s16
    s_lshl_b32 s16, s14, 11
    buffer_load_dwordx4 v[216:219], v2, s[76:79], s16 offen offset:0
    buffer_load_dwordx4 v[220:223], v2, s[76:79], s16 offen offset:1024
    s_lshl_b32 s16, s3, 10
    s_add_u32 m0, s16, 81920
    s_add_u32 s16, s16, 0x540800
    buffer_load_dwordx4 v2, s[8:11], s16 offen sc1 lds
    s_lshl_b32 s16, s30, 5
    s_lshl_b32 s17, s31, 1
    s_add_u32 s16, s16, s17
    s_add_u32 s16, s16, s15
    s_lshl_b32 s16, s16, 2
    s_add_u32 s16, s16, 0x530000
    s_cmp_eq_u32 s3, 0
    s_cselect_b32 s16, s16, 0x7ffffff0
    v_mov_b32 v16, s28
    v_mov_b32 v17, 0
    s_lshr_b32 s18, s14, 4
    s_lshl_b32 s18, s18, 15
    s_and_b32 s19, s14, 15
    s_lshl_b32 s19, s19, 6
    s_add_u32 s18, s18, s19
    s_add_u32 s18, s18, 0x2000000
    s_add_u32 s19, s18, 16384
    v_lshrrev_b32 v18, 2, v1
    v_lshlrev_b32 v18, 10, v18
    v_and_b32 v19, 3, v1
    v_lshl_add_u32 v18, v19, 4, v18
    v_add_u32 v19, 0x400000, v18
    s_lshl_b32 s25, s30, 7
    s_add_u32 s25, s25, 0x530000
    v_and_b32 v20, 15, v1
    v_lshlrev_b32 v20, 2, v20
    s_waitcnt vmcnt(3)
    s_waitcnt vmcnt(0)
    s_barrier
    s_mov_b64 exec, 1
    buffer_store_dword v16, v17, s[8:11], s16 offen sc1
    s_mov_b64 exec, -1
    v_add_u32 v16, 81920, v2
    ds_read_b128 v[184:187], v16 offset:0
    ds_read_b128 v[188:191], v16 offset:1024
    ds_read_b128 v[192:195], v16 offset:2048
    ds_read_b128 v[196:199], v16 offset:3072
    ds_read_b128 v[200:203], v16 offset:4096
    ds_read_b128 v[204:207], v16 offset:5120
    ds_read_b128 v[208:211], v16 offset:6144
    ds_read_b128 v[212:215], v16 offset:7168
    v_mov_b32 v94, 0
    v_mov_b32 v95, 0
    s_waitcnt lgkmcnt(5)
    v_lshlrev_b32 v76, 16, v192
    v_and_b32 v77, 0xffff0000, v192
    s_waitcnt lgkmcnt(1)
    v_lshlrev_b32 v78, 16, v208
    v_and_b32 v79, 0xffff0000, v208
    v_pk_mul_f32 v[60:61], v[76:77], v[78:79]
    v_lshlrev_b32 v76, 16, v184
    v_and_b32 v77, 0xffff0000, v184
    v_fmac_f32 v94, v76, v78
    v_fmac_f32 v94, v77, v79
    v_add_f32 v95, v95, v60
    v_add_f32 v95, v95, v61
    v_lshlrev_b32 v76, 16, v193
    v_and_b32 v77, 0xffff0000, v193
    v_lshlrev_b32 v78, 16, v209
    v_and_b32 v79, 0xffff0000, v209
    v_pk_mul_f32 v[62:63], v[76:77], v[78:79]
    v_lshlrev_b32 v76, 16, v185
    v_and_b32 v77, 0xffff0000, v185
    v_fmac_f32 v94, v76, v78
    v_fmac_f32 v94, v77, v79
    v_add_f32 v95, v95, v62
    v_add_f32 v95, v95, v63
    v_lshlrev_b32 v76, 16, v194
    v_and_b32 v77, 0xffff0000, v194
    v_lshlrev_b32 v78, 16, v210
    v_and_b32 v79, 0xffff0000, v210
    v_pk_mul_f32 v[64:65], v[76:77], v[78:79]
    v_lshlrev_b32 v76, 16, v186
    v_and_b32 v77, 0xffff0000, v186
    v_fmac_f32 v94, v76, v78
    v_fmac_f32 v94, v77, v79
    v_add_f32 v95, v95, v64
    v_add_f32 v95, v95, v65
    v_lshlrev_b32 v76, 16, v195
    v_and_b32 v77, 0xffff0000, v195
    v_lshlrev_b32 v78, 16, v211
    v_and_b32 v79, 0xffff0000, v211
    v_pk_mul_f32 v[66:67], v[76:77], v[78:79]
    v_lshlrev_b32 v76, 16, v187
    v_and_b32 v77, 0xffff0000, v187
    v_fmac_f32 v94, v76, v78
    v_fmac_f32 v94, v77, v79
    v_add_f32 v95, v95, v66
    v_add_f32 v95, v95, v67
    v_lshlrev_b32 v76, 16, v196
    v_and_b32 v77, 0xffff0000, v196
    s_waitcnt lgkmcnt(0)
    v_lshlrev_b32 v78, 16, v212
    v_and_b32 v79, 0xffff0000, v212
    v_pk_mul_f32 v[68:69], v[76:77], v[78:79]
    v_lshlrev_b32 v76, 16, v188
    v_and_b32 v77, 0xffff0000, v188
    v_fmac_f32 v94, v76, v78
    v_fmac_f32 v94, v77, v79
    v_add_f32 v95, v95, v68
    v_add_f32 v95, v95, v69
    v_lshlrev_b32 v76, 16, v197
    v_and_b32 v77, 0xffff0000, v197
    v_lshlrev_b32 v78, 16, v213
    v_and_b32 v79, 0xffff0000, v213
    v_pk_mul_f32 v[70:71], v[76:77], v[78:79]
    v_lshlrev_b32 v76, 16, v189
    v_and_b32 v77, 0xffff0000, v189
    v_fmac_f32 v94, v76, v78
    v_fmac_f32 v94, v77, v79
    v_add_f32 v95, v95, v70
    v_add_f32 v95, v95, v71
    v_lshlrev_b32 v76, 16, v198
    v_and_b32 v77, 0xffff0000, v198
    v_lshlrev_b32 v78, 16, v214
    v_and_b32 v79, 0xffff0000, v214
    v_pk_mul_f32 v[72:73], v[76:77], v[78:79]
    v_lshlrev_b32 v76, 16, v190
    v_and_b32 v77, 0xffff0000, v190
    v_fmac_f32 v94, v76, v78
    v_fmac_f32 v94, v77, v79
    v_add_f32 v95, v95, v72
    v_add_f32 v95, v95, v73
    v_lshlrev_b32 v76, 16, v199
    v_and_b32 v77, 0xffff0000, v199
    v_lshlrev_b32 v78, 16, v215
    v_and_b32 v79, 0xffff0000, v215
    v_pk_mul_f32 v[74:75], v[76:77], v[78:79]
    v_lshlrev_b32 v76, 16, v191
    v_and_b32 v77, 0xffff0000, v191
    v_fmac_f32 v94, v76, v78
    v_fmac_f32 v94, v77, v79
    v_add_f32 v95, v95, v74
    v_add_f32 v95, v95, v75
    v_add_f32_dpp v94, v94, v94 row_ror:1 row_mask:0xf bank_mask:0xf
    s_nop 0
    v_add_f32_dpp v95, v95, v95 row_ror:1 row_mask:0xf bank_mask:0xf
    v_add_f32_dpp v94, v94, v94 row_ror:2 row_mask:0xf bank_mask:0xf
    s_nop 0
    v_add_f32_dpp v95, v95, v95 row_ror:2 row_mask:0xf bank_mask:0xf
    v_add_f32_dpp v94, v94, v94 row_ror:4 row_mask:0xf bank_mask:0xf
    s_nop 0
    v_add_f32_dpp v95, v95, v95 row_ror:4 row_mask:0xf bank_mask:0xf
    v_add_f32_dpp v94, v94, v94 row_ror:8 row_mask:0xf bank_mask:0xf
    s_nop 0
    v_add_f32_dpp v95, v95, v95 row_ror:8 row_mask:0xf bank_mask:0xf
    v_mov_b32 v76, v94
    s_nop 1
    v_permlane16_swap_b32 v94, v76
    v_add_f32 v94, v94, v76
    v_mov_b32 v77, v95
    s_nop 1
    v_permlane16_swap_b32 v95, v77
    v_add_f32 v95, v95, v77
    v_mov_b32 v76, v94
    s_nop 1
    v_permlane32_swap_b32 v94, v76
    v_add_f32 v94, v94, v76
    v_mov_b32 v77, v95
    s_nop 1
    v_permlane32_swap_b32 v95, v77
    v_add_f32 v95, v95, v77
    v_lshlrev_b32 v28, 16, v216
    v_and_b32 v29, 0xffff0000, v216
    v_lshlrev_b32 v30, 16, v217
    v_and_b32 v31, 0xffff0000, v217
    v_lshlrev_b32 v32, 16, v218
    v_and_b32 v33, 0xffff0000, v218
    v_lshlrev_b32 v34, 16, v219
    v_and_b32 v35, 0xffff0000, v219
    v_lshlrev_b32 v36, 16, v220
    v_and_b32 v37, 0xffff0000, v220
    v_lshlrev_b32 v38, 16, v221
    v_and_b32 v39, 0xffff0000, v221
    v_lshlrev_b32 v40, 16, v222
    v_and_b32 v41, 0xffff0000, v222
    v_lshlrev_b32 v42, 16, v223
    v_and_b32 v43, 0xffff0000, v223
    s_sleep 16
    s_mov_b32 s27, 0
adaLN_cond__sliding_block_cached__moe_arch_mod__prompt_kernel_a11p:
    buffer_load_dword v76, v20, s[8:11], s25 offen sc1
    s_waitcnt vmcnt(0)
    v_cmp_ne_u32 vcc, s28, v76
    s_add_u32 s27, s27, 1
    s_cmp_ge_u32 s27, 65536
    s_cbranch_scc1 adaLN_cond__sliding_block_cached__moe_arch_mod__prompt_kernel_a11g
    s_cbranch_vccnz adaLN_cond__sliding_block_cached__moe_arch_mod__prompt_kernel_a11p
adaLN_cond__sliding_block_cached__moe_arch_mod__prompt_kernel_a11g:
    buffer_load_dwordx4 v[44:47], v18, s[8:11], s18 offen sc1
    buffer_load_dwordx4 v[52:55], v19, s[8:11], s18 offen sc1
    buffer_load_dwordx4 v[48:51], v18, s[8:11], s19 offen sc1
    buffer_load_dwordx4 v[56:59], v19, s[8:11], s19 offen sc1
    v_lshlrev_b32 v21, 2, v0
    s_mov_b32 s16, 0x540800
    buffer_load_dword v106, v21, s[8:11], s16 offen sc1
    buffer_load_dword v104, v21, s[8:11], s16 offen offset:2048 sc1
    s_waitcnt vmcnt(5)
    v_lshlrev_b32 v76, 16, v44
    v_and_b32 v77, 0xffff0000, v44
    s_waitcnt vmcnt(4)
    v_lshlrev_b32 v78, 16, v52
    v_and_b32 v79, 0xffff0000, v52
    v_pk_add_f32 v[76:77], v[76:77], v[78:79]
    v_pk_add_f32 v[28:29], v[28:29], v[76:77]
    v_cvt_pk_bf16_f32 v16, v28, v29
    v_lshlrev_b32 v28, 16, v16
    v_and_b32 v29, 0xffff0000, v16
    v_lshlrev_b32 v80, 16, v45
    v_and_b32 v81, 0xffff0000, v45
    v_lshlrev_b32 v82, 16, v53
    v_and_b32 v83, 0xffff0000, v53
    v_pk_add_f32 v[80:81], v[80:81], v[82:83]
    v_pk_add_f32 v[30:31], v[30:31], v[80:81]
    v_cvt_pk_bf16_f32 v17, v30, v31
    v_lshlrev_b32 v30, 16, v17
    v_and_b32 v31, 0xffff0000, v17
    v_lshlrev_b32 v76, 16, v46
    v_and_b32 v77, 0xffff0000, v46
    v_lshlrev_b32 v78, 16, v54
    v_and_b32 v79, 0xffff0000, v54
    v_pk_add_f32 v[76:77], v[76:77], v[78:79]
    v_pk_add_f32 v[32:33], v[32:33], v[76:77]
    v_cvt_pk_bf16_f32 v16, v32, v33
    v_lshlrev_b32 v32, 16, v16
    v_and_b32 v33, 0xffff0000, v16
    v_lshlrev_b32 v80, 16, v47
    v_and_b32 v81, 0xffff0000, v47
    v_lshlrev_b32 v82, 16, v55
    v_and_b32 v83, 0xffff0000, v55
    v_pk_add_f32 v[80:81], v[80:81], v[82:83]
    v_pk_add_f32 v[34:35], v[34:35], v[80:81]
    v_cvt_pk_bf16_f32 v17, v34, v35
    v_lshlrev_b32 v34, 16, v17
    v_and_b32 v35, 0xffff0000, v17
    s_waitcnt vmcnt(3)
    v_lshlrev_b32 v76, 16, v48
    v_and_b32 v77, 0xffff0000, v48
    s_waitcnt vmcnt(2)
    v_lshlrev_b32 v78, 16, v56
    v_and_b32 v79, 0xffff0000, v56
    v_pk_add_f32 v[76:77], v[76:77], v[78:79]
    v_pk_add_f32 v[36:37], v[36:37], v[76:77]
    v_cvt_pk_bf16_f32 v16, v36, v37
    v_lshlrev_b32 v36, 16, v16
    v_and_b32 v37, 0xffff0000, v16
    v_lshlrev_b32 v80, 16, v49
    v_and_b32 v81, 0xffff0000, v49
    v_lshlrev_b32 v82, 16, v57
    v_and_b32 v83, 0xffff0000, v57
    v_pk_add_f32 v[80:81], v[80:81], v[82:83]
    v_pk_add_f32 v[38:39], v[38:39], v[80:81]
    v_cvt_pk_bf16_f32 v17, v38, v39
    v_lshlrev_b32 v38, 16, v17
    v_and_b32 v39, 0xffff0000, v17
    v_lshlrev_b32 v76, 16, v50
    v_and_b32 v77, 0xffff0000, v50
    v_lshlrev_b32 v78, 16, v58
    v_and_b32 v79, 0xffff0000, v58
    v_pk_add_f32 v[76:77], v[76:77], v[78:79]
    v_pk_add_f32 v[40:41], v[40:41], v[76:77]
    v_cvt_pk_bf16_f32 v16, v40, v41
    v_lshlrev_b32 v40, 16, v16
    v_and_b32 v41, 0xffff0000, v16
    v_lshlrev_b32 v80, 16, v51
    v_and_b32 v81, 0xffff0000, v51
    v_lshlrev_b32 v82, 16, v59
    v_and_b32 v83, 0xffff0000, v59
    v_pk_add_f32 v[80:81], v[80:81], v[82:83]
    v_pk_add_f32 v[42:43], v[42:43], v[80:81]
    v_cvt_pk_bf16_f32 v17, v42, v43
    v_lshlrev_b32 v42, 16, v17
    v_and_b32 v43, 0xffff0000, v17
    v_pk_add_f32 v[76:77], v[28:29], v[30:31]
    v_pk_mul_f32 v[78:79], v[28:29], v[28:29]
    v_pk_mul_f32 v[80:81], v[28:29], v[60:61]
    v_pk_fma_f32 v[78:79], v[30:31], v[30:31], v[78:79]
    v_pk_fma_f32 v[80:81], v[30:31], v[62:63], v[80:81]
    v_pk_add_f32 v[76:77], v[76:77], v[32:33]
    v_pk_fma_f32 v[78:79], v[32:33], v[32:33], v[78:79]
    v_pk_fma_f32 v[80:81], v[32:33], v[64:65], v[80:81]
    v_pk_add_f32 v[76:77], v[76:77], v[34:35]
    v_pk_fma_f32 v[78:79], v[34:35], v[34:35], v[78:79]
    v_pk_fma_f32 v[80:81], v[34:35], v[66:67], v[80:81]
    v_pk_add_f32 v[76:77], v[76:77], v[36:37]
    v_pk_fma_f32 v[78:79], v[36:37], v[36:37], v[78:79]
    v_pk_fma_f32 v[80:81], v[36:37], v[68:69], v[80:81]
    v_pk_add_f32 v[76:77], v[76:77], v[38:39]
    v_pk_fma_f32 v[78:79], v[38:39], v[38:39], v[78:79]
    v_pk_fma_f32 v[80:81], v[38:39], v[70:71], v[80:81]
    v_pk_add_f32 v[76:77], v[76:77], v[40:41]
    v_pk_fma_f32 v[78:79], v[40:41], v[40:41], v[78:79]
    v_pk_fma_f32 v[80:81], v[40:41], v[72:73], v[80:81]
    v_pk_add_f32 v[76:77], v[76:77], v[42:43]
    v_pk_fma_f32 v[78:79], v[42:43], v[42:43], v[78:79]
    v_pk_fma_f32 v[80:81], v[42:43], v[74:75], v[80:81]
    v_add_f32 v96, v76, v77
    v_add_f32 v97, v78, v79
    v_add_f32 v98, v80, v81
    v_add_f32_dpp v96, v96, v96 row_ror:1 row_mask:0xf bank_mask:0xf
    v_add_f32_dpp v97, v97, v97 row_ror:1 row_mask:0xf bank_mask:0xf
    v_add_f32_dpp v98, v98, v98 row_ror:1 row_mask:0xf bank_mask:0xf
    v_add_f32_dpp v96, v96, v96 row_ror:2 row_mask:0xf bank_mask:0xf
    v_add_f32_dpp v97, v97, v97 row_ror:2 row_mask:0xf bank_mask:0xf
    v_add_f32_dpp v98, v98, v98 row_ror:2 row_mask:0xf bank_mask:0xf
    v_add_f32_dpp v96, v96, v96 row_ror:4 row_mask:0xf bank_mask:0xf
    v_add_f32_dpp v97, v97, v97 row_ror:4 row_mask:0xf bank_mask:0xf
    v_add_f32_dpp v98, v98, v98 row_ror:4 row_mask:0xf bank_mask:0xf
    v_add_f32_dpp v96, v96, v96 row_ror:8 row_mask:0xf bank_mask:0xf
    v_add_f32_dpp v97, v97, v97 row_ror:8 row_mask:0xf bank_mask:0xf
    v_add_f32_dpp v98, v98, v98 row_ror:8 row_mask:0xf bank_mask:0xf
    v_mov_b32 v76, v96
    s_nop 1
    v_permlane16_swap_b32 v96, v76
    v_add_f32 v96, v96, v76
    v_mov_b32 v77, v97
    s_nop 1
    v_permlane16_swap_b32 v97, v77
    v_add_f32 v97, v97, v77
    v_mov_b32 v78, v98
    s_nop 1
    v_permlane16_swap_b32 v98, v78
    v_add_f32 v98, v98, v78
    v_mov_b32 v76, v96
    s_nop 1
    v_permlane32_swap_b32 v96, v76
    v_add_f32 v96, v96, v76
    v_mov_b32 v77, v97
    s_nop 1
    v_permlane32_swap_b32 v97, v77
    v_add_f32 v97, v97, v77
    v_mov_b32 v78, v98
    s_nop 1
    v_permlane32_swap_b32 v98, v78
    v_add_f32 v98, v98, v78
    v_mul_f32 v96, 0x3a800000, v96
    v_mul_f32 v97, 0x3a800000, v97
    v_fma_f32 v97, -v96, v96, v97
    v_max_f32 v97, 0, v97
    v_fma_f32 v98, -v96, v95, v98
    v_add_f32 v76, 0x3727c5ac, v97
    v_rsq_f32 v76, v76
    s_nop 0
    v_fma_f32 v27, v98, v76, v94
    v_cvt_pk_bf16_f32 v96, v96, v96
    v_lshlrev_b32 v96, 16, v96
    v_cvt_pk_bf16_f32 v97, v97, v97
    v_lshlrev_b32 v97, 16, v97
    v_add_f32 v97, 0x3727c5ac, v97
    v_cvt_pk_bf16_f32 v97, v97, v97
    v_lshlrev_b32 v97, 16, v97
    v_sqrt_f32 v98, v97
    s_nop 0
    v_cvt_pk_bf16_f32 v98, v98, v98
    v_lshlrev_b32 v98, 16, v98
    v_rcp_f32 v99, v98
    v_mov_b32 v25, v96
    v_mov_b32 v26, v98
    v_ashrrev_i32 v16, 31, v27
    v_or_b32 v16, 0x80000000, v16
    v_xor_b32 v24, v27, v16
    v_and_b32 v24, 0xfffff800, v24
    v_max_u32 v24, 0x800, v24
    s_sub_u32 s16, 2047, s14
    v_or_b32 v24, s16, v24
    s_lshl_b32 s16, s3, 4
    s_add_u32 s16, s16, 65536
    v_mov_b32 v16, s16
    ds_write_b128 v16, v[24:27]
    s_waitcnt lgkmcnt(0)
    s_barrier
    v_and_b32 v16, 7, v1
    v_lshlrev_b32 v16, 4, v16
    v_add_u32 v16, 65536, v16
    ds_read_b32 v76, v16
    s_waitcnt lgkmcnt(0)
    v_mov_b32 v77, v76
    s_nop 1
    v_max_u32_dpp v77, v77, v77 row_ror:1 row_mask:0xf bank_mask:0xf
    s_nop 1
    v_max_u32_dpp v77, v77, v77 row_ror:2 row_mask:0xf bank_mask:0xf
    s_nop 1
    v_max_u32_dpp v77, v77, v77 row_ror:4 row_mask:0xf bank_mask:0xf
    v_cmp_eq_u32 vcc, v76, v77
    s_ff1_i32_b64 s16, vcc
    s_lshl_b32 s16, s16, 4
    s_add_u32 s16, s16, 65536
    v_mov_b32 v16, s16
    ds_read_b128 v[24:27], v16
    s_lshl_b32 s16, s2, 4
    s_add_u32 s16, s16, 0x6e0000
    s_cmp_eq_u32 s3, 0
    s_cselect_b32 s16, s16, 0x7ffffff0
    v_mov_b32 v17, 0
    s_mov_b64 exec, 1
    s_waitcnt lgkmcnt(0)
    buffer_store_dwordx4 v[24:27], v17, s[8:11], s16 offen sc1
    s_mov_b64 exec, -1
    v_sub_f32 v44, v28, v96
    v_sub_f32 v45, v29, v96
    v_sub_f32 v46, v30, v96
    v_sub_f32 v47, v31, v96
    v_sub_f32 v48, v32, v96
    v_sub_f32 v49, v33, v96
    v_sub_f32 v50, v34, v96
    v_sub_f32 v51, v35, v96
    v_cvt_pk_bf16_f32 v16, v44, v45
    v_lshlrev_b32 v44, 16, v16
    v_and_b32 v45, 0xffff0000, v16
    v_cvt_pk_bf16_f32 v16, v46, v47
    v_lshlrev_b32 v46, 16, v16
    v_and_b32 v47, 0xffff0000, v16
    v_cvt_pk_bf16_f32 v16, v48, v49
    v_lshlrev_b32 v48, 16, v16
    v_and_b32 v49, 0xffff0000, v16
    v_cvt_pk_bf16_f32 v16, v50, v51
    v_lshlrev_b32 v50, 16, v16
    v_and_b32 v51, 0xffff0000, v16
    v_mul_f32 v52, v44, v99
    v_mul_f32 v53, v45, v99
    v_mul_f32 v54, v46, v99
    v_mul_f32 v55, v47, v99
    v_mul_f32 v56, v48, v99
    v_mul_f32 v57, v49, v99
    v_mul_f32 v58, v50, v99
    v_mul_f32 v59, v51, v99
    v_fma_f32 v44, -v52, v98, v44
    v_fma_f32 v45, -v53, v98, v45
    v_fma_f32 v46, -v54, v98, v46
    v_fma_f32 v47, -v55, v98, v47
    v_fma_f32 v48, -v56, v98, v48
    v_fma_f32 v49, -v57, v98, v49
    v_fma_f32 v50, -v58, v98, v50
    v_fma_f32 v51, -v59, v98, v51
    v_fma_f32 v44, v44, v99, v52
    v_fma_f32 v45, v45, v99, v53
    v_fma_f32 v46, v46, v99, v54
    v_fma_f32 v47, v47, v99, v55
    v_fma_f32 v48, v48, v99, v56
    v_fma_f32 v49, v49, v99, v57
    v_fma_f32 v50, v50, v99, v58
    v_fma_f32 v51, v51, v99, v59
    v_cvt_pk_bf16_f32 v16, v44, v45
    v_lshlrev_b32 v44, 16, v16
    v_and_b32 v45, 0xffff0000, v16
    v_cvt_pk_bf16_f32 v16, v46, v47
    v_lshlrev_b32 v46, 16, v16
    v_and_b32 v47, 0xffff0000, v16
    v_cvt_pk_bf16_f32 v16, v48, v49
    v_lshlrev_b32 v48, 16, v16
    v_and_b32 v49, 0xffff0000, v16
    v_cvt_pk_bf16_f32 v16, v50, v51
    v_lshlrev_b32 v50, 16, v16
    v_and_b32 v51, 0xffff0000, v16
    v_lshlrev_b32 v52, 16, v192
    v_and_b32 v53, 0xffff0000, v192
    v_lshlrev_b32 v54, 16, v193
    v_and_b32 v55, 0xffff0000, v193
    v_lshlrev_b32 v56, 16, v194
    v_and_b32 v57, 0xffff0000, v194
    v_lshlrev_b32 v58, 16, v195
    v_and_b32 v59, 0xffff0000, v195
    v_pk_mul_f32 v[44:45], v[44:45], v[52:53]
    v_pk_mul_f32 v[46:47], v[46:47], v[54:55]
    v_pk_mul_f32 v[48:49], v[48:49], v[56:57]
    v_pk_mul_f32 v[50:51], v[50:51], v[58:59]
    v_cvt_pk_bf16_f32 v16, v44, v45
    v_lshlrev_b32 v44, 16, v16
    v_and_b32 v45, 0xffff0000, v16
    v_cvt_pk_bf16_f32 v16, v46, v47
    v_lshlrev_b32 v46, 16, v16
    v_and_b32 v47, 0xffff0000, v16
    v_cvt_pk_bf16_f32 v16, v48, v49
    v_lshlrev_b32 v48, 16, v16
    v_and_b32 v49, 0xffff0000, v16
    v_cvt_pk_bf16_f32 v16, v50, v51
    v_lshlrev_b32 v50, 16, v16
    v_and_b32 v51, 0xffff0000, v16
    v_lshlrev_b32 v52, 16, v184
    v_and_b32 v53, 0xffff0000, v184
    v_lshlrev_b32 v54, 16, v185
    v_and_b32 v55, 0xffff0000, v185
    v_lshlrev_b32 v56, 16, v186
    v_and_b32 v57, 0xffff0000, v186
    v_lshlrev_b32 v58, 16, v187
    v_and_b32 v59, 0xffff0000, v187
    v_pk_add_f32 v[44:45], v[44:45], v[52:53]
    v_pk_add_f32 v[46:47], v[46:47], v[54:55]
    v_pk_add_f32 v[48:49], v[48:49], v[56:57]
    v_pk_add_f32 v[50:51], v[50:51], v[58:59]
    v_cvt_pk_bf16_f32 v16, v44, v45
    v_lshlrev_b32 v44, 16, v16
    v_and_b32 v45, 0xffff0000, v16
    v_cvt_pk_bf16_f32 v16, v46, v47
    v_lshlrev_b32 v46, 16, v16
    v_and_b32 v47, 0xffff0000, v16
    v_cvt_pk_bf16_f32 v16, v48, v49
    v_lshlrev_b32 v48, 16, v16
    v_and_b32 v49, 0xffff0000, v16
    v_cvt_pk_bf16_f32 v16, v50, v51
    v_lshlrev_b32 v50, 16, v16
    v_and_b32 v51, 0xffff0000, v16
    v_lshlrev_b32 v52, 16, v200
    v_and_b32 v53, 0xffff0000, v200
    v_lshlrev_b32 v54, 16, v201
    v_and_b32 v55, 0xffff0000, v201
    v_lshlrev_b32 v56, 16, v202
    v_and_b32 v57, 0xffff0000, v202
    v_lshlrev_b32 v58, 16, v203
    v_and_b32 v59, 0xffff0000, v203
    v_pk_mul_f32 v[44:45], v[44:45], v[52:53]
    v_pk_mul_f32 v[46:47], v[46:47], v[54:55]
    v_pk_mul_f32 v[48:49], v[48:49], v[56:57]
    v_pk_mul_f32 v[50:51], v[50:51], v[58:59]
    v_cvt_pk_bf16_f32 v16, v44, v45
    v_lshlrev_b32 v44, 16, v16
    v_and_b32 v45, 0xffff0000, v16
    v_cvt_pk_bf16_f32 v16, v46, v47
    v_lshlrev_b32 v46, 16, v16
    v_and_b32 v47, 0xffff0000, v16
    v_cvt_pk_bf16_f32 v16, v48, v49
    v_lshlrev_b32 v48, 16, v16
    v_and_b32 v49, 0xffff0000, v16
    v_cvt_pk_bf16_f32 v16, v50, v51
    v_lshlrev_b32 v50, 16, v16
    v_and_b32 v51, 0xffff0000, v16
    v_pk_add_f32 v[44:45], v[44:45], v[28:29]
    v_pk_add_f32 v[46:47], v[46:47], v[30:31]
    v_pk_add_f32 v[48:49], v[48:49], v[32:33]
    v_pk_add_f32 v[50:51], v[50:51], v[34:35]
    v_cvt_pk_bf16_f32 v28, v44, v45
    v_cvt_pk_bf16_f32 v29, v46, v47
    v_cvt_pk_bf16_f32 v30, v48, v49
    v_cvt_pk_bf16_f32 v31, v50, v51
    v_sub_f32 v44, v36, v96
    v_sub_f32 v45, v37, v96
    v_sub_f32 v46, v38, v96
    v_sub_f32 v47, v39, v96
    v_sub_f32 v48, v40, v96
    v_sub_f32 v49, v41, v96
    v_sub_f32 v50, v42, v96
    v_sub_f32 v51, v43, v96
    v_cvt_pk_bf16_f32 v16, v44, v45
    v_lshlrev_b32 v44, 16, v16
    v_and_b32 v45, 0xffff0000, v16
    v_cvt_pk_bf16_f32 v16, v46, v47
    v_lshlrev_b32 v46, 16, v16
    v_and_b32 v47, 0xffff0000, v16
    v_cvt_pk_bf16_f32 v16, v48, v49
    v_lshlrev_b32 v48, 16, v16
    v_and_b32 v49, 0xffff0000, v16
    v_cvt_pk_bf16_f32 v16, v50, v51
    v_lshlrev_b32 v50, 16, v16
    v_and_b32 v51, 0xffff0000, v16
    v_mul_f32 v52, v44, v99
    v_mul_f32 v53, v45, v99
    v_mul_f32 v54, v46, v99
    v_mul_f32 v55, v47, v99
    v_mul_f32 v56, v48, v99
    v_mul_f32 v57, v49, v99
    v_mul_f32 v58, v50, v99
    v_mul_f32 v59, v51, v99
    v_fma_f32 v44, -v52, v98, v44
    v_fma_f32 v45, -v53, v98, v45
    v_fma_f32 v46, -v54, v98, v46
    v_fma_f32 v47, -v55, v98, v47
    v_fma_f32 v48, -v56, v98, v48
    v_fma_f32 v49, -v57, v98, v49
    v_fma_f32 v50, -v58, v98, v50
    v_fma_f32 v51, -v59, v98, v51
    v_fma_f32 v44, v44, v99, v52
    v_fma_f32 v45, v45, v99, v53
    v_fma_f32 v46, v46, v99, v54
    v_fma_f32 v47, v47, v99, v55
    v_fma_f32 v48, v48, v99, v56
    v_fma_f32 v49, v49, v99, v57
    v_fma_f32 v50, v50, v99, v58
    v_fma_f32 v51, v51, v99, v59
    v_cvt_pk_bf16_f32 v16, v44, v45
    v_lshlrev_b32 v44, 16, v16
    v_and_b32 v45, 0xffff0000, v16
    v_cvt_pk_bf16_f32 v16, v46, v47
    v_lshlrev_b32 v46, 16, v16
    v_and_b32 v47, 0xffff0000, v16
    v_cvt_pk_bf16_f32 v16, v48, v49
    v_lshlrev_b32 v48, 16, v16
    v_and_b32 v49, 0xffff0000, v16
    v_cvt_pk_bf16_f32 v16, v50, v51
    v_lshlrev_b32 v50, 16, v16
    v_and_b32 v51, 0xffff0000, v16
    v_lshlrev_b32 v52, 16, v196
    v_and_b32 v53, 0xffff0000, v196
    v_lshlrev_b32 v54, 16, v197
    v_and_b32 v55, 0xffff0000, v197
    v_lshlrev_b32 v56, 16, v198
    v_and_b32 v57, 0xffff0000, v198
    v_lshlrev_b32 v58, 16, v199
    v_and_b32 v59, 0xffff0000, v199
    v_pk_mul_f32 v[44:45], v[44:45], v[52:53]
    v_pk_mul_f32 v[46:47], v[46:47], v[54:55]
    v_pk_mul_f32 v[48:49], v[48:49], v[56:57]
    v_pk_mul_f32 v[50:51], v[50:51], v[58:59]
    v_cvt_pk_bf16_f32 v16, v44, v45
    v_lshlrev_b32 v44, 16, v16
    v_and_b32 v45, 0xffff0000, v16
    v_cvt_pk_bf16_f32 v16, v46, v47
    v_lshlrev_b32 v46, 16, v16
    v_and_b32 v47, 0xffff0000, v16
    v_cvt_pk_bf16_f32 v16, v48, v49
    v_lshlrev_b32 v48, 16, v16
    v_and_b32 v49, 0xffff0000, v16
    v_cvt_pk_bf16_f32 v16, v50, v51
    v_lshlrev_b32 v50, 16, v16
    v_and_b32 v51, 0xffff0000, v16
    v_lshlrev_b32 v52, 16, v188
    v_and_b32 v53, 0xffff0000, v188
    v_lshlrev_b32 v54, 16, v189
    v_and_b32 v55, 0xffff0000, v189
    v_lshlrev_b32 v56, 16, v190
    v_and_b32 v57, 0xffff0000, v190
    v_lshlrev_b32 v58, 16, v191
    v_and_b32 v59, 0xffff0000, v191
    v_pk_add_f32 v[44:45], v[44:45], v[52:53]
    v_pk_add_f32 v[46:47], v[46:47], v[54:55]
    v_pk_add_f32 v[48:49], v[48:49], v[56:57]
    v_pk_add_f32 v[50:51], v[50:51], v[58:59]
    v_cvt_pk_bf16_f32 v16, v44, v45
    v_lshlrev_b32 v44, 16, v16
    v_and_b32 v45, 0xffff0000, v16
    v_cvt_pk_bf16_f32 v16, v46, v47
    v_lshlrev_b32 v46, 16, v16
    v_and_b32 v47, 0xffff0000, v16
    v_cvt_pk_bf16_f32 v16, v48, v49
    v_lshlrev_b32 v48, 16, v16
    v_and_b32 v49, 0xffff0000, v16
    v_cvt_pk_bf16_f32 v16, v50, v51
    v_lshlrev_b32 v50, 16, v16
    v_and_b32 v51, 0xffff0000, v16
    v_lshlrev_b32 v52, 16, v204
    v_and_b32 v53, 0xffff0000, v204
    v_lshlrev_b32 v54, 16, v205
    v_and_b32 v55, 0xffff0000, v205
    v_lshlrev_b32 v56, 16, v206
    v_and_b32 v57, 0xffff0000, v206
    v_lshlrev_b32 v58, 16, v207
    v_and_b32 v59, 0xffff0000, v207
    v_pk_mul_f32 v[44:45], v[44:45], v[52:53]
    v_pk_mul_f32 v[46:47], v[46:47], v[54:55]
    v_pk_mul_f32 v[48:49], v[48:49], v[56:57]
    v_pk_mul_f32 v[50:51], v[50:51], v[58:59]
    v_cvt_pk_bf16_f32 v16, v44, v45
    v_lshlrev_b32 v44, 16, v16
    v_and_b32 v45, 0xffff0000, v16
    v_cvt_pk_bf16_f32 v16, v46, v47
    v_lshlrev_b32 v46, 16, v16
    v_and_b32 v47, 0xffff0000, v16
    v_cvt_pk_bf16_f32 v16, v48, v49
    v_lshlrev_b32 v48, 16, v16
    v_and_b32 v49, 0xffff0000, v16
    v_cvt_pk_bf16_f32 v16, v50, v51
    v_lshlrev_b32 v50, 16, v16
    v_and_b32 v51, 0xffff0000, v16
    v_pk_add_f32 v[44:45], v[44:45], v[36:37]
    v_pk_add_f32 v[46:47], v[46:47], v[38:39]
    v_pk_add_f32 v[48:49], v[48:49], v[40:41]
    v_pk_add_f32 v[50:51], v[50:51], v[42:43]
    v_cvt_pk_bf16_f32 v36, v44, v45
    v_cvt_pk_bf16_f32 v37, v46, v47
    v_cvt_pk_bf16_f32 v38, v48, v49
    v_cvt_pk_bf16_f32 v39, v50, v51
    v_lshlrev_b32 v18, 4, v0
    s_mov_b32 s16, 0x6e0000
    s_mov_b32 s27, 0
adaLN_cond__sliding_block_cached__moe_arch_mod__prompt_kernel_w12p:
    buffer_load_dwordx4 v[24:27], v18, s[8:11], s16 offen sc1
    s_waitcnt vmcnt(0)
    v_cmp_eq_u32 vcc, 0, v24
    s_add_u32 s27, s27, 1
    s_cmp_ge_u32 s27, 65536
    s_cbranch_scc1 adaLN_cond__sliding_block_cached__moe_arch_mod__prompt_kernel_w12g
    s_cbranch_vccnz adaLN_cond__sliding_block_cached__moe_arch_mod__prompt_kernel_w12p
adaLN_cond__sliding_block_cached__moe_arch_mod__prompt_kernel_w12g:
    v_mov_b32 v76, v24
    s_nop 1
    v_max_u32_dpp v76, v76, v76 row_ror:1 row_mask:0xf bank_mask:0xf
    s_nop 1
    v_max_u32_dpp v76, v76, v76 row_ror:2 row_mask:0xf bank_mask:0xf
    s_nop 1
    v_max_u32_dpp v76, v76, v76 row_ror:4 row_mask:0xf bank_mask:0xf
    s_nop 1
    v_max_u32_dpp v76, v76, v76 row_ror:8 row_mask:0xf bank_mask:0xf
    v_mov_b32 v77, v76
    s_nop 1
    v_permlane16_swap_b32 v76, v77
    v_max_u32 v76, v76, v77
    v_mov_b32 v77, v76
    s_nop 1
    v_permlane32_swap_b32 v76, v77
    v_max_u32 v76, v76, v77
    v_cmp_eq_u32 vcc, v76, v24
    s_lshl_b32 s16, s3, 4
    s_add_u32 s16, s16, 65792
    v_mov_b32 v16, s16
    s_and_saveexec_b64 s[62:63], vcc
    ds_write_b128 v16, v[24:27]
    s_mov_b64 exec, s[62:63]
    s_waitcnt lgkmcnt(0)
    s_barrier
    v_and_b32 v16, 3, v1
    v_lshlrev_b32 v16, 4, v16
    v_add_u32 v16, 65792, v16
    ds_read_b32 v76, v16
    s_waitcnt lgkmcnt(0)
    v_mov_b32 v77, v76
    s_nop 1
    v_max_u32_dpp v77, v77, v77 row_ror:1 row_mask:0xf bank_mask:0xf
    s_nop 1
    v_max_u32_dpp v77, v77, v77 row_ror:2 row_mask:0xf bank_mask:0xf
    v_cmp_eq_u32 vcc, v76, v77
    s_ff1_i32_b64 s16, vcc
    s_lshl_b32 s16, s16, 4
    s_add_u32 s16, s16, 65792
    v_mov_b32 v16, s16
    ds_read_b128 v[24:27], v16
    s_waitcnt lgkmcnt(0)
    v_and_b32 v76, 0x7ff, v24
    v_sub_u32 v76, 2047, v76
    s_nop 0
    v_readfirstlane_b32 s12, v76
    v_rcp_f32 v103, v26
    s_lshr_b32 s18, s12, 4
    s_lshl_b32 s18, s18, 15
    s_and_b32 s19, s12, 15
    s_lshl_b32 s19, s19, 6
    s_add_u32 s18, s18, s19
    s_add_u32 s18, s18, 0x2000000
    s_add_u32 s19, s18, 0x400000
    v_lshrrev_b32 v18, 4, v0
    v_lshlrev_b32 v18, 10, v18
    v_and_b32 v19, 15, v0
    v_lshl_add_u32 v18, v19, 2, v18
    s_lshl_b32 s13, s12, 11
    buffer_load_dword v100, v18, s[8:11], s18 offen sc1
    buffer_load_dword v101, v18, s[8:11], s19 offen sc1
    buffer_load_dword v102, v21, s[76:79], s13 offen
    s_lshl_b32 s16, s14, 11
    s_cmp_lg_u32 s12, s14
    s_cselect_b32 s16, s16, 0x7ffffff0
    buffer_store_dwordx4 v[28:31], v2, s[68:71], s16 offen offset:0 sc1
    buffer_store_dwordx4 v[36:39], v2, s[68:71], s16 offen offset:1024 sc1
    s_lshl_b32 s16, s3, 13
    v_add_u32 v20, s16, v2
    s_waitcnt vmcnt(4)
    v_lshlrev_b32 v76, 16, v100
    v_and_b32 v77, 0xffff0000, v100
    s_waitcnt vmcnt(3)
    v_lshlrev_b32 v78, 16, v101
    v_and_b32 v79, 0xffff0000, v101
    v_pk_add_f32 v[76:77], v[76:77], v[78:79]
    s_waitcnt vmcnt(2)
    v_lshlrev_b32 v78, 16, v102
    v_and_b32 v79, 0xffff0000, v102
    v_pk_add_f32 v[92:93], v[78:79], v[76:77]
    v_cvt_pk_bf16_f32 v76, v92, v93
    v_lshlrev_b32 v92, 16, v76
    v_and_b32 v93, 0xffff0000, v76
    v_cvt_pk_bf16_f32 v100, v92, v93
    v_and_b32 v105, 0xffff0000, v104
    v_lshlrev_b32 v104, 16, v104
    v_and_b32 v107, 0xffff0000, v106
    v_lshlrev_b32 v106, 16, v106
    v_sub_f32 v92, v92, v25
    v_sub_f32 v93, v93, v25
    v_cvt_pk_bf16_f32 v76, v92, v93
    v_lshlrev_b32 v92, 16, v76
    v_and_b32 v93, 0xffff0000, v76
    v_mul_f32 v77, v92, v103
    v_fma_f32 v92, -v77, v26, v92
    v_fma_f32 v92, v92, v103, v77
    v_mul_f32 v77, v93, v103
    v_fma_f32 v93, -v77, v26, v93
    v_fma_f32 v93, v93, v103, v77
    v_cvt_pk_bf16_f32 v76, v92, v93
    v_lshlrev_b32 v92, 16, v76
    v_and_b32 v93, 0xffff0000, v76
    v_mul_f32 v92, v92, v104
    v_mul_f32 v93, v93, v105
    v_cvt_pk_bf16_f32 v76, v92, v93
    v_lshlrev_b32 v92, 16, v76
    v_and_b32 v93, 0xffff0000, v76
    v_add_f32 v92, v92, v106
    v_add_f32 v93, v93, v107
    v_cvt_pk_bf16_f32 v101, v92, v93
    v_add_u32 v16, 66560, v21
    ds_write_b32 v16, v101
    ds_write_b32 v16, v100 offset:2048
    s_waitcnt lgkmcnt(0)
    s_barrier
    ds_read_b128 v[60:63], v20 offset:0
    ds_read_b128 v[64:67], v20 offset:1024
    ds_read_b128 v[68:71], v20 offset:2048
    ds_read_b128 v[72:75], v20 offset:3072
    ds_read_b128 v[108:111], v20 offset:4096
    ds_read_b128 v[112:115], v20 offset:5120
    ds_read_b128 v[116:119], v20 offset:6144
    ds_read_b128 v[120:123], v20 offset:7168
    s_and_b32 s16, s3, 3
    s_lshl_b32 s16, s16, 7
    s_and_b32 s17, s29, 3
    s_lshl_b32 s17, s17, 9
    s_add_u32 s16, s16, s17
    s_add_u32 s16, s16, 66560
    v_lshrrev_b32 v16, 3, v1
    v_lshlrev_b32 v16, 4, v16
    v_add_u32 v16, s16, v16
    ds_read_b128 v[104:107], v16
    s_waitcnt lgkmcnt(0)
    v_lshlrev_b32 v76, 16, v104
    v_and_b32 v77, 0xffff, v104
    v_dot2_f32_bf16 v85, v60, v76, 0
    v_dot2_f32_bf16 v84, v60, v77, 0
    v_dot2_f32_bf16 v87, v61, v76, 0
    v_dot2_f32_bf16 v86, v61, v77, 0
    v_dot2_f32_bf16 v89, v62, v76, 0
    v_dot2_f32_bf16 v88, v62, v77, 0
    v_dot2_f32_bf16 v91, v63, v76, 0
    v_dot2_f32_bf16 v90, v63, v77, 0
    v_and_b32 v78, 0xffff0000, v104
    v_lshrrev_b32 v79, 16, v104
    v_dot2c_f32_bf16 v85, v64, v78
    v_dot2c_f32_bf16 v84, v64, v79
    v_dot2c_f32_bf16 v87, v65, v78
    v_dot2c_f32_bf16 v86, v65, v79
    v_dot2c_f32_bf16 v89, v66, v78
    v_dot2c_f32_bf16 v88, v66, v79
    v_dot2c_f32_bf16 v91, v67, v78
    v_dot2c_f32_bf16 v90, v67, v79
    v_lshlrev_b32 v80, 16, v105
    v_and_b32 v81, 0xffff, v105
    v_dot2c_f32_bf16 v85, v68, v80
    v_dot2c_f32_bf16 v84, v68, v81
    v_dot2c_f32_bf16 v87, v69, v80
    v_dot2c_f32_bf16 v86, v69, v81
    v_dot2c_f32_bf16 v89, v70, v80
    v_dot2c_f32_bf16 v88, v70, v81
    v_dot2c_f32_bf16 v91, v71, v80
    v_dot2c_f32_bf16 v90, v71, v81
    v_and_b32 v82, 0xffff0000, v105
    v_lshrrev_b32 v83, 16, v105
    v_dot2c_f32_bf16 v85, v72, v82
    v_dot2c_f32_bf16 v84, v72, v83
    v_dot2c_f32_bf16 v87, v73, v82
    v_dot2c_f32_bf16 v86, v73, v83
    v_dot2c_f32_bf16 v89, v74, v82
    v_dot2c_f32_bf16 v88, v74, v83
    v_dot2c_f32_bf16 v91, v75, v82
    v_dot2c_f32_bf16 v90, v75, v83
    v_lshlrev_b32 v76, 16, v106
    v_and_b32 v77, 0xffff, v106
    v_dot2c_f32_bf16 v85, v108, v76
    v_dot2c_f32_bf16 v84, v108, v77
    v_dot2c_f32_bf16 v87, v109, v76
    v_dot2c_f32_bf16 v86, v109, v77
    v_dot2c_f32_bf16 v89, v110, v76
    v_dot2c_f32_bf16 v88, v110, v77
    v_dot2c_f32_bf16 v91, v111, v76
    v_dot2c_f32_bf16 v90, v111, v77
    v_and_b32 v78, 0xffff0000, v106
    v_lshrrev_b32 v79, 16, v106
    v_dot2c_f32_bf16 v85, v112, v78
    v_dot2c_f32_bf16 v84, v112, v79
    v_dot2c_f32_bf16 v87, v113, v78
    v_dot2c_f32_bf16 v86, v113, v79
    v_dot2c_f32_bf16 v89, v114, v78
    v_dot2c_f32_bf16 v88, v114, v79
    v_dot2c_f32_bf16 v91, v115, v78
    v_dot2c_f32_bf16 v90, v115, v79
    v_lshlrev_b32 v80, 16, v107
    v_and_b32 v81, 0xffff, v107
    v_dot2c_f32_bf16 v85, v116, v80
    v_dot2c_f32_bf16 v84, v116, v81
    v_dot2c_f32_bf16 v87, v117, v80
    v_dot2c_f32_bf16 v86, v117, v81
    v_dot2c_f32_bf16 v89, v118, v80
    v_dot2c_f32_bf16 v88, v118, v81
    v_dot2c_f32_bf16 v91, v119, v80
    v_dot2c_f32_bf16 v90, v119, v81
    v_and_b32 v82, 0xffff0000, v107
    v_lshrrev_b32 v83, 16, v107
    v_dot2c_f32_bf16 v85, v120, v82
    v_dot2c_f32_bf16 v84, v120, v83
    v_dot2c_f32_bf16 v87, v121, v82
    v_dot2c_f32_bf16 v86, v121, v83
    v_dot2c_f32_bf16 v89, v122, v82
    v_dot2c_f32_bf16 v88, v122, v83
    v_dot2c_f32_bf16 v91, v123, v82
    v_dot2c_f32_bf16 v90, v123, v83
    s_nop 0
    v_permlane32_swap_b32 v84, v88
    v_permlane32_swap_b32 v85, v89
    v_permlane32_swap_b32 v86, v90
    v_permlane32_swap_b32 v87, v91
    v_add_f32 v84, v84, v88
    v_add_f32 v85, v85, v89
    v_add_f32 v86, v86, v90
    v_add_f32 v87, v87, v91
    s_nop 0
    v_permlane16_swap_b32 v84, v86
    v_permlane16_swap_b32 v85, v87
    v_add_f32 v84, v84, v86
    v_add_f32 v85, v85, v87
    s_nop 0
    v_add_f32_dpp v84, v84, v84 row_ror:8 row_mask:0xf bank_mask:0xf
    v_add_f32_dpp v85, v85, v85 row_ror:8 row_mask:0xf bank_mask:0xf
    v_and_b32 v16, 7, v1
    v_lshlrev_b32 v16, 5, v16
    v_lshrrev_b32 v17, 4, v1
    v_lshl_add_u32 v16, v17, 3, v16
    s_lshl_b32 s16, s3, 8
    s_add_u32 s16, s16, 70656
    v_add_u32 v16, s16, v16
    ds_write_b64 v16, v[84:85]
    s_lshr_b32 s16, s3, 2
    s_lshl_b32 s17, s16, 10
    s_add_u32 s17, s17, 70656
    v_lshlrev_b32 v17, 2, v1
    v_add_u32 v16, s17, v17
    s_and_b32 s17, s29, 3
    s_lshl_b32 s17, s17, 1
    s_add_u32 s17, s17, s16
    s_mul_i32 s17, s17, 14336
    s_lshr_b32 s16, s29, 2
    s_lshl_b32 s16, s16, 8
    s_add_u32 s17, s17, s16
    s_add_u32 s17, s17, 0x6e1000
    s_and_b32 s16, s3, 3
    s_cmp_eq_u32 s16, 0
    s_cselect_b32 s17, s17, 0x7ffffff0
    s_cmp_lt_u32 s2, 224
    s_cselect_b32 s17, s17, 0x7ffffff0
    s_waitcnt lgkmcnt(0)
    s_barrier
    ds_read_b32 v84, v16 offset:0
    ds_read_b32 v85, v16 offset:256
    ds_read_b32 v86, v16 offset:512
    ds_read_b32 v87, v16 offset:768
    s_waitcnt lgkmcnt(2)
    v_add_f32 v84, v84, v85
    s_waitcnt lgkmcnt(0)
    v_add_f32 v86, v86, v87
    v_add_f32 v84, v84, v86
    v_or_b32 v84, 1, v84
    buffer_store_dword v84, v17, s[8:11], s17 offen sc1
    s_barrier
    v_lshlrev_b32 v16, 3, v0
    v_add_u32 v17, 73728, v16
    ds_read_b64 v[84:85], v17 offset:0
    ds_read_b64 v[86:87], v17 offset:4096
    ds_read_b64 v[88:89], v17 offset:8192
    ds_read_b64 v[90:91], v17 offset:12288
    s_waitcnt lgkmcnt(2)
    v_pk_add_f32 v[84:85], v[84:85], v[86:87]
    s_waitcnt lgkmcnt(0)
    v_pk_add_f32 v[88:89], v[88:89], v[90:91]
    v_pk_add_f32 v[84:85], v[84:85], v[88:89]
    v_or_b32 v84, 1, v84
    v_or_b32 v85, 1, v85
    s_lshl_b32 s16, s29, 12
    s_add_u32 s16, s16, 0x600000
    s_cmp_lt_u32 s2, 224
    s_cselect_b32 s16, s16, 0x7ffffff0
    buffer_store_dwordx2 v[84:85], v16, s[8:11], s16 offen sc1
    s_cmp_lt_u32 s2, 224
    s_cbranch_scc1 adaLN_cond__sliding_block_cached__moe_arch_mod__prompt_kernel_end
    s_sub_u32 s16, s2, 224
    s_lshl_b32 s17, s16, 7
    s_add_u32 s17, s17, 0x600000
    v_lshrrev_b32 v16, 3, v0
    v_lshlrev_b32 v16, 12, v16
    v_and_b32 v17, 7, v0
    v_lshl_add_u32 v16, v17, 4, v16
    v_cmp_gt_u32 vcc, 256, v0
    v_bfrev_b32 v17, -2
    s_nop 0
    v_cndmask_b32 v17, v17, v16, vcc
    v_mov_b32 v19, 0
    v_cndmask_b32 v18, 1, v19, vcc
    s_lshl_b32 s18, s16, 6
    v_and_b32 v19, 31, v1
    v_lshlrev_b32 v19, 1, v19
    v_add_u32 v19, s18, v19
    s_mov_b32 s19, 0x541800
    buffer_load_ushort v95, v19, s[8:11], s19 offen sc1
    v_add_u32 v20, 66560, v19
    ds_read_u16 v96, v20
    ds_read_u16 v97, v20 offset:2048
    v_mov_b32 v94, v27
    v_cvt_pk_bf16_f32 v94, v94, v94
    v_lshlrev_b32 v94, 16, v94
    v_mul_f32 v94, 0xbfb8aa3b, v94
    v_exp_f32 v94, v94
    s_nop 0
    v_add_f32 v94, 1.0, v94
    v_rcp_f32 v94, v94
    s_nop 0
    v_cvt_pk_bf16_f32 v94, v94, v94
    v_lshlrev_b32 v94, 16, v94
    s_waitcnt vmcnt(0)
    v_lshlrev_b32 v95, 16, v95
    s_waitcnt lgkmcnt(1)
    v_lshlrev_b32 v96, 16, v96
    s_waitcnt lgkmcnt(0)
    v_lshlrev_b32 v97, 16, v97
    s_mov_b32 s27, 0
adaLN_cond__sliding_block_cached__moe_arch_mod__prompt_kernel_y13p:
    s_add_u32 s19, s17, 0x0
    buffer_load_dwordx4 v[44:47], v16, s[8:11], s19 offen sc1
    s_add_u32 s19, s17, 0x40000
    buffer_load_dwordx4 v[48:51], v16, s[8:11], s19 offen sc1
    s_add_u32 s19, s17, 0x80000
    buffer_load_dwordx4 v[52:55], v16, s[8:11], s19 offen sc1
    s_add_u32 s19, s17, 0xc0000
    buffer_load_dwordx4 v[56:59], v17, s[8:11], s19 offen sc1
    s_waitcnt vmcnt(0)
    v_min3_u32 v98, v56, v57, v58
    v_min_u32 v98, v98, v59
    v_or_b32 v98, v98, v18
    v_min3_u32 v98, v98, v44, v45
    v_min3_u32 v98, v98, v46, v47
    v_min3_u32 v98, v98, v48, v49
    v_min3_u32 v98, v98, v50, v51
    v_min3_u32 v98, v98, v52, v53
    v_min3_u32 v98, v98, v54, v55
    v_cmp_eq_u32 vcc, 0, v98
    s_add_u32 s27, s27, 1
    s_cmp_ge_u32 s27, 65536
    s_cbranch_scc1 adaLN_cond__sliding_block_cached__moe_arch_mod__prompt_kernel_y13g
    s_cbranch_vccnz adaLN_cond__sliding_block_cached__moe_arch_mod__prompt_kernel_y13p
adaLN_cond__sliding_block_cached__moe_arch_mod__prompt_kernel_y13g:
    v_pk_add_f32 v[44:45], v[44:45], v[52:53]
    v_pk_add_f32 v[46:47], v[46:47], v[54:55]
    v_pk_add_f32 v[48:49], v[48:49], v[56:57]
    v_pk_add_f32 v[50:51], v[50:51], v[58:59]
    v_pk_add_f32 v[44:45], v[44:45], v[48:49]
    v_pk_add_f32 v[46:47], v[46:47], v[50:51]
    s_nop 0
    v_add_f32_dpp v44, v44, v44 row_ror:8 row_mask:0xf bank_mask:0xf
    v_add_f32_dpp v45, v45, v45 row_ror:8 row_mask:0xf bank_mask:0xf
    v_add_f32_dpp v46, v46, v46 row_ror:8 row_mask:0xf bank_mask:0xf
    v_add_f32_dpp v47, v47, v47 row_ror:8 row_mask:0xf bank_mask:0xf
    s_nop 0
    v_permlane32_swap_b32 v44, v46
    v_permlane32_swap_b32 v45, v47
    v_add_f32 v44, v44, v46
    v_add_f32 v45, v45, v47
    s_nop 1
    v_permlane16_swap_b32 v44, v45
    v_add_f32 v44, v44, v45
    v_and_b32 v16, 7, v1
    v_lshlrev_b32 v16, 4, v16
    v_lshrrev_b32 v17, 4, v1
    v_lshl_add_u32 v16, v17, 2, v16
    s_lshl_b32 s19, s3, 7
    s_add_u32 s19, s19, 91136
    v_add_u32 v16, s19, v16
    ds_write_b32 v16, v44
    v_and_b32 v16, 31, v1
    v_lshlrev_b32 v16, 2, v16
    v_add_u32 v16, 91136, v16
    s_waitcnt lgkmcnt(0)
    s_barrier
    s_cmp_lg_u32 s3, 0
    s_cbranch_scc1 adaLN_cond__sliding_block_cached__moe_arch_mod__prompt_kernel_end
    ds_read_b32 v44, v16 offset:0
    ds_read_b32 v45, v16 offset:128
    ds_read_b32 v46, v16 offset:256
    ds_read_b32 v47, v16 offset:384
    ds_read_b32 v48, v16 offset:512
    ds_read_b32 v49, v16 offset:640
    ds_read_b32 v50, v16 offset:768
    ds_read_b32 v51, v16 offset:896
    s_waitcnt lgkmcnt(3)
    v_add_f32 v44, v44, v48
    s_waitcnt lgkmcnt(2)
    v_add_f32 v45, v45, v49
    s_waitcnt lgkmcnt(1)
    v_add_f32 v46, v46, v50
    s_waitcnt lgkmcnt(0)
    v_add_f32 v47, v47, v51
    v_add_f32 v44, v44, v46
    v_add_f32 v45, v45, v47
    v_add_f32 v44, v44, v45
    v_cvt_pk_bf16_f32 v44, v44, v44
    v_lshlrev_b32 v44, 16, v44
    v_mul_f32 v44, v44, v94
    v_cvt_pk_bf16_f32 v44, v44, v44
    v_lshlrev_b32 v44, 16, v44
    v_add_f32 v44, v44, v96
    v_cvt_pk_bf16_f32 v44, v44, v44
    v_lshlrev_b32 v44, 16, v44
    v_mul_f32 v44, v44, v95
    v_cvt_pk_bf16_f32 v44, v44, v44
    v_lshlrev_b32 v44, 16, v44
    v_add_f32 v44, v44, v97
    v_cvt_pk_bf16_f32 v44, v44, v44
    s_mov_b64 exec, 0xffffffff
    buffer_store_short v44, v19, s[68:71], s13 offen sc1
    s_branch adaLN_cond__sliding_block_cached__moe_arch_mod__prompt_kernel_end
adaLN_cond__sliding_block_cached__moe_arch_mod__prompt_kernel_roleB:
    v_mov_b32 v132, 0
    v_mov_b32 v133, 0
    v_lshrrev_b32 v16, 3, v0
    v_and_b32 v17, 7, v0
    v_mul_u32_u24 v135, 24576, v16
    v_lshl_add_u32 v135, v17, 4, v135
    v_lshlrev_b32 v136, 2, v16
    s_and_b32 s14, s2, 31
    s_lshr_b32 s15, s2, 5
    s_mul_i32 s26, s15, 1572864
    s_lshl_b32 s16, s14, 7
    s_add_u32 s26, s26, s16
    s_lshl_b32 s29, s15, 8
    v_lshlrev_b32 v137, 3, v0
    s_lshl_b32 s18, s2, 3
    s_add_u32 s18, s18, s3
    s_lshl_b32 s18, s18, 11
    v_and_b32 v18, 15, v1
    v_lshrrev_b32 v19, 4, v1
    v_lshlrev_b32 v138, 11, v18
    v_lshl_add_u32 v138, v19, 4, v138
    s_lshr_b32 s30, s2, 4
    s_and_b32 s31, s2, 15
    s_lshl_b32 s19, s30, 3
    s_add_u32 s19, s19, s3
    s_lshl_b32 s22, s19, 15
    s_lshl_b32 s23, s31, 7
    s_add_u32 s22, s22, s23
    s_lshl_b32 s23, s2, 12
    s_add_u32 s23, s23, 0x600000
    s_or_b32 s25, s2, s3
    s_cmp_eq_u32 s25, 0
    s_cselect_b32 s25, 0, 0x7ffffff0
    s_waitcnt lgkmcnt(0)
    s_mov_b64 s[64:65], s[58:59]
    s_mov_b32 s66, 0x100
    s_mov_b32 s67, 0x20000
    s_or_b32 s28, s62, 1
    v_mov_b32 v134, s28
    s_mov_b64 exec, 1
    buffer_store_dword v134, v132, s[64:67], s25 offen sc1
    s_mov_b64 exec, -1
    s_mov_b64 s[68:69], s[52:53]
    s_mov_b32 s70, 0x800
    s_mov_b32 s71, 0x20000
    s_mov_b64 s[72:73], s[54:55]
    s_mov_b32 s74, 0xc00000
    s_mov_b32 s75, 0x20000
    s_mov_b64 s[76:77], s[32:33]
    s_mov_b32 s78, 0x400000
    s_mov_b32 s79, 0x20000
    s_mov_b64 s[8:9], s[60:61]
    s_mov_b32 s10, 0x3400000
    s_mov_b32 s11, 0x20000
    buffer_load_dword v72, v136, s[68:71], s29 offen
    buffer_load_dwordx4 v[24:27], v135, s[72:75], s26 offen
    s_add_u32 s26, s26, 12288
    buffer_load_dwordx4 v[28:31], v135, s[72:75], s26 offen
    buffer_load_dwordx4 v[32:35], v2, s[76:79], s18 offen offset:0
    buffer_load_dwordx4 v[36:39], v2, s[76:79], s18 offen offset:1024
    buffer_store_dwordx2 v[132:133], v137, s[8:11], s23 offen sc1
    s_barrier
    buffer_load_dwordx4 v[40:43], v138, s[76:79], s22 offen offset:0
    buffer_load_dwordx4 v[44:47], v138, s[76:79], s22 offen offset:64
    s_mov_b32 s29, s19
    s_mov_b64 s[64:65], s[34:35]
    s_mov_b32 s66, 0x200000
    s_mov_b32 s67, 0x20000
    s_mov_b64 s[68:69], s[36:37]
    s_mov_b32 s70, 0x200000
    s_mov_b32 s71, 0x20000
    s_lshl_b32 s20, s2, 2
    s_add_u32 s20, s20, s3
    s_sub_u32 s20, s20, 4
    s_lshr_b32 s22, s20, 8
    s_bfe_u32 s23, s20, 0x40004
    s_and_b32 s24, s20, 15
    s_lshl_b32 s25, s22, 19
    s_lshl_b32 s26, s23, 13
    s_add_u32 s25, s25, s26
    s_add_u32 s25, s25, 393216
    v_and_b32 v16, 15, v1
    v_lshrrev_b32 v17, 4, v1
    s_lshl_b32 s21, s22, 17
    s_cmp_ge_u32 s24, 8
    s_cbranch_scc1 adaLN_cond__sliding_block_cached__moe_arch_mod__prompt_kernel_kvV
    v_lshlrev_b32 v18, 8, v16
    v_lshl_add_u32 v18, v17, 3, v18
    s_and_b32 s26, s24, 1
    s_lshl_b32 s26, s26, 12
    s_add_u32 s25, s25, s26
    s_lshr_b32 s26, s24, 1
    s_lshl_b32 s26, s26, 6
    s_add_u32 s25, s25, s26
    buffer_load_dwordx2 v[84:85], v18, s[64:67], s25 offen
    buffer_load_dwordx2 v[86:87], v18, s[64:67], s25 offen offset:32
    s_lshl_b32 s26, s23, 13
    s_add_u32 s21, s21, s26
    s_lshl_b32 s26, s24, 10
    s_add_u32 s21, s21, s26
    s_add_u32 s21, s21, 0x400000
    s_branch adaLN_cond__sliding_block_cached__moe_arch_mod__prompt_kernel_kvJ
adaLN_cond__sliding_block_cached__moe_arch_mod__prompt_kernel_kvV:
    s_bfe_u32 s26, s24, 0x20001
    s_lshl_b32 s26, s26, 6
    s_add_u32 s25, s25, s26
    s_and_b32 s26, s24, 1
    s_lshl_b32 s26, s26, 3
    s_add_u32 s25, s25, s26
    s_add_u32 s26, s25, 4096
    v_lshrrev_b32 v18, 2, v16
    v_lshlrev_b32 v18, 4, v18
    v_and_b32 v19, 3, v16
    v_lshl_add_u32 v18, v19, 1, v18
    v_lshl_add_u32 v18, v17, 10, v18
    buffer_load_ushort v88, v18, s[68:71], s25 offen offset:0
    buffer_load_ushort v89, v18, s[68:71], s25 offen offset:256
    buffer_load_ushort v90, v18, s[68:71], s25 offen offset:512
    buffer_load_ushort v91, v18, s[68:71], s25 offen offset:768
    buffer_load_ushort v92, v18, s[68:71], s26 offen offset:0
    buffer_load_ushort v93, v18, s[68:71], s26 offen offset:256
    buffer_load_ushort v94, v18, s[68:71], s26 offen offset:512
    buffer_load_ushort v95, v18, s[68:71], s26 offen offset:768
    s_bfe_u32 s26, s24, 0x20001
    s_lshl_b32 s26, s26, 15
    s_add_u32 s21, s21, s26
    s_lshl_b32 s26, s23, 11
    s_add_u32 s21, s21, s26
    s_and_b32 s26, s24, 1
    s_lshl_b32 s26, s26, 10
    s_add_u32 s21, s21, s26
    s_add_u32 s21, s21, 0x480000
adaLN_cond__sliding_block_cached__moe_arch_mod__prompt_kernel_kvJ:
    s_waitcnt vmcnt(9)
    v_and_b32 v73, 0xffff0000, v72
    v_lshlrev_b32 v72, 16, v72
    v_mul_f32 v16, 0xbfb8aa3b, v72
    v_exp_f32 v16, v16
    s_nop 0
    v_add_f32 v16, 1.0, v16
    v_rcp_f32 v16, v16
    s_nop 0
    v_mul_f32 v72, v72, v16
    v_mul_f32 v17, 0xbfb8aa3b, v73
    v_exp_f32 v17, v17
    s_nop 0
    v_add_f32 v17, 1.0, v17
    v_rcp_f32 v17, v17
    s_nop 0
    v_mul_f32 v73, v73, v17
    v_cvt_pk_bf16_f32 v16, v72, v73
    v_lshlrev_b32 v72, 16, v16
    v_and_b32 v73, 0xffff0000, v16
    s_lshl_b32 s16, s2, 8
    s_add_u32 s16, s16, 0x550000
    s_mov_b32 exec_lo, 0x01010101
    s_mov_b32 exec_hi, 0x01010101
    buffer_store_dword v16, v136, s[8:11], s16 offen sc1
    s_mov_b64 exec, -1
    v_lshrrev_b32 v74, 16, v72
    v_lshrrev_b32 v75, 16, v73
    s_waitcnt vmcnt(9)
    v_dot2_f32_bf16 v49, v24, v72, 0
    v_dot2_f32_bf16 v48, v24, v74, 0
    v_dot2_f32_bf16 v51, v25, v72, 0
    v_dot2_f32_bf16 v50, v25, v74, 0
    v_dot2_f32_bf16 v53, v26, v72, 0
    v_dot2_f32_bf16 v52, v26, v74, 0
    v_dot2_f32_bf16 v55, v27, v72, 0
    v_dot2_f32_bf16 v54, v27, v74, 0
    s_waitcnt vmcnt(8)
    v_dot2c_f32_bf16 v49, v28, v73
    v_dot2c_f32_bf16 v48, v28, v75
    v_dot2c_f32_bf16 v51, v29, v73
    v_dot2c_f32_bf16 v50, v29, v75
    v_dot2c_f32_bf16 v53, v30, v73
    v_dot2c_f32_bf16 v52, v30, v75
    v_dot2c_f32_bf16 v55, v31, v73
    v_dot2c_f32_bf16 v54, v31, v75
    s_nop 0
    v_permlane32_swap_b32 v48, v52
    v_permlane32_swap_b32 v49, v53
    v_permlane32_swap_b32 v50, v54
    v_permlane32_swap_b32 v51, v55
    v_add_f32 v48, v48, v52
    v_add_f32 v49, v49, v53
    v_add_f32 v50, v50, v54
    v_add_f32 v51, v51, v55
    s_nop 0
    v_permlane16_swap_b32 v48, v50
    v_permlane16_swap_b32 v49, v51
    v_add_f32 v48, v48, v50
    v_add_f32 v49, v49, v51
    s_nop 0
    v_add_f32_dpp v48, v48, v48 row_ror:8 row_mask:0xf bank_mask:0xf
    v_add_f32_dpp v49, v49, v49 row_ror:8 row_mask:0xf bank_mask:0xf
    v_and_b32 v16, 7, v1
    v_lshlrev_b32 v16, 5, v16
    v_lshrrev_b32 v17, 4, v1
    v_lshl_add_u32 v16, v17, 3, v16
    s_lshl_b32 s16, s3, 8
    s_add_u32 s16, s16, 147456
    v_add_u32 v16, s16, v16
    ds_write_b64 v16, v[48:49]
    s_waitcnt vmcnt(7)
    v_lshlrev_b32 v56, 16, v32
    v_and_b32 v57, 0xffff0000, v32
    v_lshlrev_b32 v58, 16, v33
    v_and_b32 v59, 0xffff0000, v33
    v_lshlrev_b32 v60, 16, v34
    v_and_b32 v61, 0xffff0000, v34
    v_lshlrev_b32 v62, 16, v35
    v_and_b32 v63, 0xffff0000, v35
    s_waitcnt vmcnt(6)
    v_lshlrev_b32 v64, 16, v36
    v_and_b32 v65, 0xffff0000, v36
    v_lshlrev_b32 v66, 16, v37
    v_and_b32 v67, 0xffff0000, v37
    v_lshlrev_b32 v68, 16, v38
    v_and_b32 v69, 0xffff0000, v38
    v_lshlrev_b32 v70, 16, v39
    v_and_b32 v71, 0xffff0000, v39
    v_add_f32 v20, v56, v57
    v_add_f32 v21, v58, v59
    v_add_f32 v20, v20, v60
    v_add_f32 v21, v21, v61
    v_add_f32 v20, v20, v62
    v_add_f32 v21, v21, v63
    v_add_f32 v20, v20, v64
    v_add_f32 v21, v21, v65
    v_add_f32 v20, v20, v66
    v_add_f32 v21, v21, v67
    v_add_f32 v20, v20, v68
    v_add_f32 v21, v21, v69
    v_add_f32 v20, v20, v70
    v_add_f32 v21, v21, v71
    v_add_f32 v128, v20, v21
    s_nop 1
    v_add_f32_dpp v128, v128, v128 row_ror:1 row_mask:0xf bank_mask:0xf
    s_nop 1
    v_add_f32_dpp v128, v128, v128 row_ror:2 row_mask:0xf bank_mask:0xf
    s_nop 1
    v_add_f32_dpp v128, v128, v128 row_ror:4 row_mask:0xf bank_mask:0xf
    s_nop 1
    v_add_f32_dpp v128, v128, v128 row_ror:8 row_mask:0xf bank_mask:0xf
    v_mov_b32 v20, v128
    s_nop 1
    v_permlane16_swap_b32 v128, v20
    v_add_f32 v128, v128, v20
    v_mov_b32 v20, v128
    s_nop 1
    v_permlane32_swap_b32 v128, v20
    v_add_f32 v128, v128, v20
    v_mul_f32 v128, 0x3a800000, v128
    v_sub_f32 v18, v56, v128
    v_mul_f32 v20, v18, v18
    v_sub_f32 v19, v57, v128
    v_mul_f32 v21, v19, v19
    v_sub_f32 v18, v58, v128
    v_sub_f32 v19, v59, v128
    v_fmac_f32 v20, v18, v18
    v_fmac_f32 v21, v19, v19
    v_sub_f32 v18, v60, v128
    v_sub_f32 v19, v61, v128
    v_fmac_f32 v20, v18, v18
    v_fmac_f32 v21, v19, v19
    v_sub_f32 v18, v62, v128
    v_sub_f32 v19, v63, v128
    v_fmac_f32 v20, v18, v18
    v_fmac_f32 v21, v19, v19
    v_sub_f32 v18, v64, v128
    v_sub_f32 v19, v65, v128
    v_fmac_f32 v20, v18, v18
    v_fmac_f32 v21, v19, v19
    v_sub_f32 v18, v66, v128
    v_sub_f32 v19, v67, v128
    v_fmac_f32 v20, v18, v18
    v_fmac_f32 v21, v19, v19
    v_sub_f32 v18, v68, v128
    v_sub_f32 v19, v69, v128
    v_fmac_f32 v20, v18, v18
    v_fmac_f32 v21, v19, v19
    v_sub_f32 v18, v70, v128
    v_sub_f32 v19, v71, v128
    v_fmac_f32 v20, v18, v18
    v_fmac_f32 v21, v19, v19
    v_add_f32 v17, v20, v21
    s_nop 1
    v_add_f32_dpp v17, v17, v17 row_ror:1 row_mask:0xf bank_mask:0xf
    s_nop 1
    v_add_f32_dpp v17, v17, v17 row_ror:2 row_mask:0xf bank_mask:0xf
    s_nop 1
    v_add_f32_dpp v17, v17, v17 row_ror:4 row_mask:0xf bank_mask:0xf
    s_nop 1
    v_add_f32_dpp v17, v17, v17 row_ror:8 row_mask:0xf bank_mask:0xf
    v_mov_b32 v20, v17
    s_nop 1
    v_permlane16_swap_b32 v17, v20
    v_add_f32 v17, v17, v20
    v_mov_b32 v20, v17
    s_nop 1
    v_permlane32_swap_b32 v17, v20
    v_add_f32 v17, v17, v20
    v_mul_f32 v17, 0x3a800000, v17
    v_cvt_pk_bf16_f32 v128, v128, v128
    v_lshlrev_b32 v128, 16, v128
    v_cvt_pk_bf16_f32 v17, v17, v17
    v_lshlrev_b32 v17, 16, v17
    v_add_f32 v17, 0x3727c5ac, v17
    v_cvt_pk_bf16_f32 v17, v17, v17
    v_lshlrev_b32 v17, 16, v17
    v_sqrt_f32 v129, v17
    s_nop 0
    v_cvt_pk_bf16_f32 v129, v129, v129
    v_lshlrev_b32 v129, 16, v129
    v_rcp_f32 v130, v129
    s_lshl_b32 s16, s3, 4
    s_add_u32 s16, s16, 149520
    v_mov_b32 v19, s16
    ds_write_b128 v19, v[128:131]
    v_mov_b32 v19, 149504
    v_and_b32 v17, 31, v1
    v_lshlrev_b32 v18, 3, v17
    v_add_u32 v18, 147456, v18
    v_lshlrev_b32 v17, 4, v17
    s_waitcnt lgkmcnt(0)
    s_barrier
    ds_read_b32 v134, v19
    ds_read_b64 v[96:97], v18 offset:0
    ds_read_b64 v[100:101], v18 offset:256
    ds_read_b64 v[104:105], v18 offset:512
    ds_read_b64 v[108:109], v18 offset:768
    ds_read_b64 v[112:113], v18 offset:1024
    ds_read_b64 v[116:117], v18 offset:1280
    ds_read_b64 v[120:121], v18 offset:1536
    ds_read_b64 v[124:125], v18 offset:1792
    s_waitcnt lgkmcnt(8)
    v_readfirstlane_b32 s28, v134
    v_and_b32 v20, 7, v1
    v_lshlrev_b32 v20, 4, v20
    v_add_u32 v21, 149520, v20
    ds_read_b128 v[128:131], v21
    s_waitcnt lgkmcnt(0)
    v_mov_b32 v131, s28
    s_lshl_b32 s16, s2, 7
    s_add_u32 s16, s16, 0x520000
    s_cmp_eq_u32 s3, 0
    s_cselect_b32 s16, s16, 0x7ffffff0
    s_mov_b64 exec, 0xff
    buffer_store_dwordx4 v[128:131], v20, s[8:11], s16 offen sc1
    s_mov_b64 exec, -1
    v_pk_add_f32 v[96:97], v[96:97], v[112:113]
    v_pk_add_f32 v[100:101], v[100:101], v[116:117]
    v_pk_add_f32 v[104:105], v[104:105], v[120:121]
    v_pk_add_f32 v[108:109], v[108:109], v[124:125]
    v_pk_add_f32 v[96:97], v[96:97], v[104:105]
    v_pk_add_f32 v[100:101], v[100:101], v[108:109]
    v_pk_add_f32 v[96:97], v[96:97], v[100:101]
    v_mov_b32 v98, s28
    v_mov_b32 v99, s28
    s_lshl_b32 s16, s14, 3
    s_add_u32 s16, s16, s15
    s_lshl_b32 s16, s16, 9
    s_add_u32 s16, s16, 0x500000
    s_cmp_eq_u32 s3, 0
    s_cselect_b32 s16, s16, 0x7ffffff0
    s_mov_b64 exec, 0xffffffff
    buffer_store_dwordx4 v[96:99], v17, s[8:11], s16 offen sc1
    s_mov_b64 exec, -1
    s_cmp_lt_u32 s24, 8
    s_cbranch_scc1 adaLN_cond__sliding_block_cached__moe_arch_mod__prompt_kernel_kvS
    s_waitcnt vmcnt(4)
    v_lshl_or_b32 v84, v89, 16, v88
    v_lshl_or_b32 v85, v91, 16, v90
    s_waitcnt vmcnt(3)
    v_lshl_or_b32 v86, v93, 16, v92
    v_lshl_or_b32 v87, v95, 16, v94
    v_and_b32 v88, 0x7fff, v88
    v_and_b32 v89, 0x7fff, v89
    v_and_b32 v90, 0x7fff, v90
    v_and_b32 v91, 0x7fff, v91
    v_and_b32 v92, 0x7fff, v92
    v_and_b32 v93, 0x7fff, v93
    v_and_b32 v94, 0x7fff, v94
    v_and_b32 v95, 0x7fff, v95
    v_max3_u32 v88, v88, v89, v90
    v_max3_u32 v91, v91, v92, v93
    v_max3_u32 v88, v88, v94, v95
    v_max_u32 v88, v88, v91
    v_cmp_le_u32 vcc, 0x4980, v88
    v_mov_b32 v89, s28
    s_mov_b32 s16, 0x564000
    s_and_saveexec_b64 s[62:63], vcc
    buffer_store_dword v89, v132, s[8:11], s16 offen sc1
    s_mov_b64 exec, s[62:63]
adaLN_cond__sliding_block_cached__moe_arch_mod__prompt_kernel_kvS:
    s_waitcnt vmcnt(3)
    buffer_store_dwordx4 v[84:87], v2, s[8:11], s21 offen sc1
    s_lshr_b32 s16, s3, 2
    s_lshl_b32 s16, s16, 4
    s_add_u32 s16, s16, s31
    s_lshl_b32 s16, s16, 12
    s_and_b32 s17, s3, 3
    s_lshl_b32 s17, s17, 7
    s_add_u32 s16, s16, s17
    s_add_u32 s16, s16, 0x500000
    v_lshrrev_b32 v139, 3, v1
    v_lshlrev_b32 v139, 9, v139
    v_and_b32 v16, 7, v1
    v_lshl_add_u32 v139, v16, 4, v139
    v_and_b32 v140, 15, v1
    v_lshlrev_b32 v140, 4, v140
    s_lshl_b32 s17, s29, 8
    s_add_u32 s17, s17, 0x520000
    v_lshlrev_b32 v56, 16, v40
    v_and_b32 v57, 0xffff0000, v40
    v_lshlrev_b32 v58, 16, v41
    v_and_b32 v59, 0xffff0000, v41
    v_lshlrev_b32 v60, 16, v42
    v_and_b32 v61, 0xffff0000, v42
    v_lshlrev_b32 v62, 16, v43
    v_and_b32 v63, 0xffff0000, v43
    v_lshlrev_b32 v64, 16, v44
    v_and_b32 v65, 0xffff0000, v44
    v_lshlrev_b32 v66, 16, v45
    v_and_b32 v67, 0xffff0000, v45
    v_lshlrev_b32 v68, 16, v46
    v_and_b32 v69, 0xffff0000, v46
    v_lshlrev_b32 v70, 16, v47
    v_and_b32 v71, 0xffff0000, v47
    v_mov_b32 v135, 2097152
    v_mul_lo_u32 v135, v135, v1
    s_mov_b64 s[76:77], s[40:41]
    s_mov_b32 s78, 0x800000
    s_mov_b32 s79, 0x20000
    s_mov_b32 s62, 0x0
    s_cmp_eq_u32 s3, 4
    s_cselect_b32 s62, s62, 0x7ffffff0
    buffer_load_dword v136, v135, s[76:79], s62 offen
    s_mov_b64 s[76:77], s[46:47]
    s_mov_b32 s78, 0x700000
    s_mov_b32 s79, 0x20000
    s_mov_b32 s62, 0x0
    s_cmp_eq_u32 s3, 4
    s_cselect_b32 s62, s62, 0x7ffffff0
    buffer_load_dword v136, v135, s[76:79], s62 offen
    s_mov_b64 s[76:77], s[48:49]
    s_mov_b32 s78, 0x700000
    s_mov_b32 s79, 0x20000
    s_mov_b32 s62, 0x0
    s_cmp_eq_u32 s3, 5
    s_cselect_b32 s62, s62, 0x7ffffff0
    buffer_load_dword v136, v135, s[76:79], s62 offen
    s_mov_b64 s[76:77], s[50:51]
    s_mov_b32 s78, 0x700000
    s_mov_b32 s79, 0x20000
    s_mov_b32 s62, 0x0
    s_cmp_eq_u32 s3, 5
    s_cselect_b32 s62, s62, 0x7ffffff0
    buffer_load_dword v136, v135, s[76:79], s62 offen
    s_mov_b64 s[76:77], s[38:39]
    s_mov_b32 s78, 0x800000
    s_mov_b32 s79, 0x20000
    s_mov_b32 s62, 0x0
    s_cmp_eq_u32 s3, 6
    s_cselect_b32 s62, s62, 0x7ffffff0
    buffer_load_dword v136, v135, s[76:79], s62 offen
    s_mov_b64 s[76:77], s[56:57]
    s_mov_b32 s78, 0x400000
    s_mov_b32 s79, 0x20000
    s_mov_b32 s62, 0x0
    s_cmp_eq_u32 s3, 6
    s_cselect_b32 s62, s62, 0x7ffffff0
    buffer_load_dword v136, v135, s[76:79], s62 offen
    s_mov_b64 s[76:77], s[54:55]
    s_mov_b32 s78, 0xc00000
    s_mov_b32 s79, 0x20000
    s_mov_b32 s62, 0x0
    s_cmp_eq_u32 s3, 7
    s_cselect_b32 s62, s62, 0x7ffffff0
    buffer_load_dword v136, v135, s[76:79], s62 offen
    s_mov_b64 s[76:77], s[44:45]
    s_mov_b32 s78, 0x800
    s_mov_b32 s79, 0x20000
    s_mov_b32 s62, 0x0
    s_cmp_eq_u32 s3, 7
    s_cselect_b32 s62, s62, 0x7ffffff0
    buffer_load_dword v136, v135, s[76:79], s62 offen
    s_mov_b32 s27, 0
adaLN_cond__sliding_block_cached__moe_arch_mod__prompt_kernel_g14p:
    buffer_load_dwordx4 v[76:79], v139, s[8:11], s16 offen sc1
    buffer_load_dwordx4 v[80:83], v140, s[8:11], s17 offen sc1
    s_waitcnt vmcnt(1)
    v_cmp_ne_u32 vcc, s28, v78
    v_cmp_ne_u32 s[62:63], s28, v79
    s_or_b64 vcc, vcc, s[62:63]
    s_waitcnt vmcnt(0)
    v_cmp_ne_u32 s[62:63], s28, v83
    s_or_b64 vcc, vcc, s[62:63]
    s_add_u32 s27, s27, 1
    s_cmp_ge_u32 s27, 65536
    s_cbranch_scc1 adaLN_cond__sliding_block_cached__moe_arch_mod__prompt_kernel_g14g
    s_cbranch_vccnz adaLN_cond__sliding_block_cached__moe_arch_mod__prompt_kernel_g14p
adaLN_cond__sliding_block_cached__moe_arch_mod__prompt_kernel_g14g:
    v_add_f32_dpp v76, v76, v76 row_ror:8 row_mask:0xf bank_mask:0xf
    v_add_f32_dpp v77, v77, v77 row_ror:8 row_mask:0xf bank_mask:0xf
    v_mov_b32 v17, v76
    s_nop 1
    v_permlane16_swap_b32 v76, v17
    v_add_f32 v76, v76, v17
    v_mov_b32 v18, v77
    s_nop 1
    v_permlane16_swap_b32 v77, v18
    v_add_f32 v77, v77, v18
    v_mov_b32 v17, v76
    s_nop 1
    v_permlane32_swap_b32 v76, v17
    v_add_f32 v76, v76, v17
    v_mov_b32 v18, v77
    s_nop 1
    v_permlane32_swap_b32 v77, v18
    v_add_f32 v77, v77, v18
    v_cvt_pk_bf16_f32 v17, v76, v77
    v_lshlrev_b32 v76, 16, v17
    v_and_b32 v77, 0xffff0000, v17
    v_add_f32 v76, 1.0, v76
    v_add_f32 v77, 1.0, v77
    v_cvt_pk_bf16_f32 v17, v76, v77
    v_lshlrev_b32 v76, 16, v17
    v_and_b32 v77, 0xffff0000, v17
    s_lshl_b32 s16, s3, 6
    s_add_u32 s16, s16, 151552
    v_lshl_add_u32 v16, v16, 3, s16
    ds_write_b64 v16, v[76:77]
    v_lshrrev_b32 v17, 4, v1
    v_lshlrev_b32 v17, 5, v17
    v_add_u32 v17, 151552, v17
    v_sub_f32 v56, v56, v80
    v_sub_f32 v57, v57, v80
    v_sub_f32 v58, v58, v80
    v_sub_f32 v59, v59, v80
    v_sub_f32 v60, v60, v80
    v_sub_f32 v61, v61, v80
    v_sub_f32 v62, v62, v80
    v_sub_f32 v63, v63, v80
    v_sub_f32 v64, v64, v80
    v_sub_f32 v65, v65, v80
    v_sub_f32 v66, v66, v80
    v_sub_f32 v67, v67, v80
    v_sub_f32 v68, v68, v80
    v_sub_f32 v69, v69, v80
    v_sub_f32 v70, v70, v80
    v_sub_f32 v71, v71, v80
    v_cvt_pk_bf16_f32 v18, v56, v57
    v_lshlrev_b32 v56, 16, v18
    v_and_b32 v57, 0xffff0000, v18
    v_cvt_pk_bf16_f32 v19, v58, v59
    v_lshlrev_b32 v58, 16, v19
    v_and_b32 v59, 0xffff0000, v19
    v_cvt_pk_bf16_f32 v18, v60, v61
    v_lshlrev_b32 v60, 16, v18
    v_and_b32 v61, 0xffff0000, v18
    v_cvt_pk_bf16_f32 v19, v62, v63
    v_lshlrev_b32 v62, 16, v19
    v_and_b32 v63, 0xffff0000, v19
    v_cvt_pk_bf16_f32 v18, v64, v65
    v_lshlrev_b32 v64, 16, v18
    v_and_b32 v65, 0xffff0000, v18
    v_cvt_pk_bf16_f32 v19, v66, v67
    v_lshlrev_b32 v66, 16, v19
    v_and_b32 v67, 0xffff0000, v19
    v_cvt_pk_bf16_f32 v18, v68, v69
    v_lshlrev_b32 v68, 16, v18
    v_and_b32 v69, 0xffff0000, v18
    v_cvt_pk_bf16_f32 v19, v70, v71
    v_lshlrev_b32 v70, 16, v19
    v_and_b32 v71, 0xffff0000, v19
    v_mul_f32 v56, v56, v82
    v_mul_f32 v57, v57, v82
    v_mul_f32 v58, v58, v82
    v_mul_f32 v59, v59, v82
    v_mul_f32 v60, v60, v82
    v_mul_f32 v61, v61, v82
    v_mul_f32 v62, v62, v82
    v_mul_f32 v63, v63, v82
    v_mul_f32 v64, v64, v82
    v_mul_f32 v65, v65, v82
    v_mul_f32 v66, v66, v82
    v_mul_f32 v67, v67, v82
    v_mul_f32 v68, v68, v82
    v_mul_f32 v69, v69, v82
    v_mul_f32 v70, v70, v82
    v_mul_f32 v71, v71, v82
    v_cvt_pk_bf16_f32 v18, v56, v57
    v_lshlrev_b32 v56, 16, v18
    v_and_b32 v57, 0xffff0000, v18
    v_cvt_pk_bf16_f32 v19, v58, v59
    v_lshlrev_b32 v58, 16, v19
    v_and_b32 v59, 0xffff0000, v19
    v_cvt_pk_bf16_f32 v18, v60, v61
    v_lshlrev_b32 v60, 16, v18
    v_and_b32 v61, 0xffff0000, v18
    v_cvt_pk_bf16_f32 v19, v62, v63
    v_lshlrev_b32 v62, 16, v19
    v_and_b32 v63, 0xffff0000, v19
    v_cvt_pk_bf16_f32 v18, v64, v65
    v_lshlrev_b32 v64, 16, v18
    v_and_b32 v65, 0xffff0000, v18
    v_cvt_pk_bf16_f32 v19, v66, v67
    v_lshlrev_b32 v66, 16, v19
    v_and_b32 v67, 0xffff0000, v19
    v_cvt_pk_bf16_f32 v18, v68, v69
    v_lshlrev_b32 v68, 16, v18
    v_and_b32 v69, 0xffff0000, v18
    v_cvt_pk_bf16_f32 v19, v70, v71
    v_lshlrev_b32 v70, 16, v19
    v_and_b32 v71, 0xffff0000, v19
    s_lshl_b32 s16, s29, 15
    s_lshl_b32 s17, s31, 11
    s_add_u32 s16, s16, s17
    s_waitcnt lgkmcnt(0)
    s_barrier
    ds_read_b128 v[96:99], v17 offset:256
    ds_read_b128 v[104:107], v17 offset:0
    ds_read_b128 v[100:103], v17 offset:272
    ds_read_b128 v[108:111], v17 offset:16
    ds_read_b128 v[112:115], v17 offset:384
    ds_read_b128 v[120:123], v17 offset:128
    ds_read_b128 v[116:119], v17 offset:400
    ds_read_b128 v[124:127], v17 offset:144
    s_waitcnt lgkmcnt(7)
    v_pk_mul_f32 v[56:57], v[56:57], v[96:97]
    v_pk_mul_f32 v[58:59], v[58:59], v[98:99]
    s_waitcnt lgkmcnt(5)
    v_pk_mul_f32 v[60:61], v[60:61], v[100:101]
    v_pk_mul_f32 v[62:63], v[62:63], v[102:103]
    v_cvt_pk_bf16_f32 v18, v56, v57
    v_lshlrev_b32 v56, 16, v18
    v_and_b32 v57, 0xffff0000, v18
    v_cvt_pk_bf16_f32 v19, v58, v59
    v_lshlrev_b32 v58, 16, v19
    v_and_b32 v59, 0xffff0000, v19
    v_cvt_pk_bf16_f32 v18, v60, v61
    v_lshlrev_b32 v60, 16, v18
    v_and_b32 v61, 0xffff0000, v18
    v_cvt_pk_bf16_f32 v19, v62, v63
    v_lshlrev_b32 v62, 16, v19
    v_and_b32 v63, 0xffff0000, v19
    v_pk_add_f32 v[56:57], v[56:57], v[104:105]
    v_pk_add_f32 v[58:59], v[58:59], v[106:107]
    s_waitcnt lgkmcnt(4)
    v_pk_add_f32 v[60:61], v[60:61], v[108:109]
    v_pk_add_f32 v[62:63], v[62:63], v[110:111]
    v_cvt_pk_bf16_f32 v32, v56, v57
    v_cvt_pk_bf16_f32 v33, v58, v59
    v_cvt_pk_bf16_f32 v34, v60, v61
    v_cvt_pk_bf16_f32 v35, v62, v63
    buffer_store_dwordx4 v[32:35], v2, s[8:11], s16 offen offset:0 sc1
    s_waitcnt lgkmcnt(3)
    v_pk_mul_f32 v[64:65], v[64:65], v[112:113]
    v_pk_mul_f32 v[66:67], v[66:67], v[114:115]
    s_waitcnt lgkmcnt(1)
    v_pk_mul_f32 v[68:69], v[68:69], v[116:117]
    v_pk_mul_f32 v[70:71], v[70:71], v[118:119]
    v_cvt_pk_bf16_f32 v18, v64, v65
    v_lshlrev_b32 v64, 16, v18
    v_and_b32 v65, 0xffff0000, v18
    v_cvt_pk_bf16_f32 v19, v66, v67
    v_lshlrev_b32 v66, 16, v19
    v_and_b32 v67, 0xffff0000, v19
    v_cvt_pk_bf16_f32 v18, v68, v69
    v_lshlrev_b32 v68, 16, v18
    v_and_b32 v69, 0xffff0000, v18
    v_cvt_pk_bf16_f32 v19, v70, v71
    v_lshlrev_b32 v70, 16, v19
    v_and_b32 v71, 0xffff0000, v19
    v_pk_add_f32 v[64:65], v[64:65], v[120:121]
    v_pk_add_f32 v[66:67], v[66:67], v[122:123]
    s_waitcnt lgkmcnt(0)
    v_pk_add_f32 v[68:69], v[68:69], v[124:125]
    v_pk_add_f32 v[70:71], v[70:71], v[126:127]
    v_cvt_pk_bf16_f32 v36, v64, v65
    v_cvt_pk_bf16_f32 v37, v66, v67
    v_cvt_pk_bf16_f32 v38, v68, v69
    v_cvt_pk_bf16_f32 v39, v70, v71
    buffer_store_dwordx4 v[36:39], v2, s[8:11], s16 offen offset:1024 sc1
    s_lshl_b32 s19, s3, 16
    s_lshl_b32 s20, s3, 11
    s_lshl_b32 s16, s12, 8
    s_add_u32 s4, s38, s16
    s_addc_u32 s5, s39, 0
    s_sub_u32 s6, 0x800000, s16
    s_mov_b32 s7, 0x20000
    v_mov_b32 v134, s28
    s_lshl_b32 s16, s29, 4
    s_add_u32 s16, s16, s31
    s_lshl_b32 s16, s16, 2
    s_add_u32 s16, s16, 0x528000
    v_and_b32 v16, 31, v1
    v_lshlrev_b32 v16, 2, v16
    s_lshl_b32 s17, s13, 3
    s_add_u32 s17, s17, s3
    s_lshl_b32 s17, s17, 7
    s_add_u32 s17, s17, 0x528000
    s_waitcnt vmcnt(0)
    s_mov_b64 exec, 1
    buffer_store_dword v134, v132, s[8:11], s16 offen sc1
    s_mov_b64 exec, -1
    s_add_u32 s22, s19, 0x0
    s_add_u32 m0, s20, 0x0
    s_nop 0
    buffer_load_dwordx4 v3, s[4:7], s22 offen lds
    s_add_u32 s22, s19, 0x8000
    s_add_u32 m0, s20, 0x400
    s_nop 0
    buffer_load_dwordx4 v3, s[4:7], s22 offen lds
    s_add_u32 s22, s19, 0x80000
    s_add_u32 m0, s20, 0x4000
    s_nop 0
    buffer_load_dwordx4 v3, s[4:7], s22 offen lds
    s_add_u32 s22, s19, 0x88000
    s_add_u32 m0, s20, 0x4400
    s_nop 0
    buffer_load_dwordx4 v3, s[4:7], s22 offen lds
    s_add_u32 s22, s19, 0x100000
    s_add_u32 m0, s20, 0x8000
    s_nop 0
    buffer_load_dwordx4 v3, s[4:7], s22 offen lds
    s_add_u32 s22, s19, 0x108000
    s_add_u32 m0, s20, 0x8400
    s_nop 0
    buffer_load_dwordx4 v3, s[4:7], s22 offen lds
    s_sleep 40
    s_mov_b32 s27, 0
adaLN_cond__sliding_block_cached__moe_arch_mod__prompt_kernel_h15p:
    buffer_load_dword v17, v16, s[8:11], s17 offen sc1
    s_waitcnt vmcnt(0)
    v_cmp_ne_u32 vcc, s28, v17
    s_add_u32 s27, s27, 1
    s_cmp_ge_u32 s27, 65536
    s_cbranch_scc1 adaLN_cond__sliding_block_cached__moe_arch_mod__prompt_kernel_h15g
    s_cbranch_vccnz adaLN_cond__sliding_block_cached__moe_arch_mod__prompt_kernel_h15p
adaLN_cond__sliding_block_cached__moe_arch_mod__prompt_kernel_h15g:
    s_mov_b32 s23, 0x0
    buffer_load_dwordx4 v[88:91], v7, s[8:11], s23 offen offset:0 sc1
    s_mov_b32 s23, 0x8000
    buffer_load_dwordx4 v[92:95], v7, s[8:11], s23 offen offset:0 sc1
    s_mov_b32 s23, 0x0
    buffer_load_dwordx4 v[96:99], v7, s[8:11], s23 offen offset:1024 sc1
    s_mov_b32 s23, 0x8000
    buffer_load_dwordx4 v[100:103], v7, s[8:11], s23 offen offset:1024 sc1
    s_mov_b32 s23, 0x800
    buffer_load_dwordx4 v[104:107], v7, s[8:11], s23 offen offset:0 sc1
    s_mov_b32 s23, 0x8800
    buffer_load_dwordx4 v[108:111], v7, s[8:11], s23 offen offset:0 sc1
    s_mov_b32 s23, 0x800
    buffer_load_dwordx4 v[112:115], v7, s[8:11], s23 offen offset:1024 sc1
    s_mov_b32 s23, 0x8800
    buffer_load_dwordx4 v[116:119], v7, s[8:11], s23 offen offset:1024 sc1
    s_lshr_b32 s21, s12, 3
    s_lshl_b32 s21, s21, 17
    s_add_u32 s21, s21, s20
    s_add_u32 s21, s21, 0x400000
    s_barrier
    ds_read_b64_tr_b16 v[224:225], v4 offset:0
    ds_read_b64_tr_b16 v[226:227], v4 offset:1024
    ds_read_b64_tr_b16 v[228:229], v5 offset:32
    ds_read_b64_tr_b16 v[230:231], v5 offset:1056
    ds_read_b64_tr_b16 v[232:233], v4 offset:256
    ds_read_b64_tr_b16 v[234:235], v4 offset:1280
    ds_read_b64_tr_b16 v[236:237], v5 offset:288
    ds_read_b64_tr_b16 v[238:239], v5 offset:1312
    s_waitcnt vmcnt(7) lgkmcnt(6)
    v_mfma_f32_16x16x32_bf16 v[24:27], v[224:227], v[88:91], 0
    ds_read_b64_tr_b16 v[240:241], v4 offset:512
    s_waitcnt vmcnt(6)
    v_mfma_f32_16x16x32_bf16 v[28:31], v[224:227], v[92:95], 0
    ds_read_b64_tr_b16 v[242:243], v4 offset:1536
    s_waitcnt lgkmcnt(6)
    v_mfma_f32_16x16x32_bf16 v[32:35], v[228:231], v[88:91], 0
    ds_read_b64_tr_b16 v[244:245], v5 offset:544
    v_mfma_f32_16x16x32_bf16 v[36:39], v[228:231], v[92:95], 0
    ds_read_b64_tr_b16 v[246:247], v5 offset:1568
    s_mov_b32 s23, 0x1000
    buffer_load_dwordx4 v[120:123], v7, s[8:11], s23 offen offset:0 sc1
    s_waitcnt lgkmcnt(6)
    v_mfma_f32_16x16x32_bf16 v[40:43], v[232:235], v[88:91], 0
    ds_read_b64_tr_b16 v[224:225], v4 offset:768
    v_mfma_f32_16x16x32_bf16 v[44:47], v[232:235], v[92:95], 0
    ds_read_b64_tr_b16 v[226:227], v4 offset:1792
    s_waitcnt lgkmcnt(6)
    v_mfma_f32_16x16x32_bf16 v[48:51], v[236:239], v[88:91], 0
    ds_read_b64_tr_b16 v[228:229], v5 offset:800
    v_mfma_f32_16x16x32_bf16 v[52:55], v[236:239], v[92:95], 0
    ds_read_b64_tr_b16 v[230:231], v5 offset:1824
    s_waitcnt lgkmcnt(6)
    v_mfma_f32_16x16x32_bf16 v[56:59], v[240:243], v[88:91], 0
    ds_read_b64_tr_b16 v[232:233], v4 offset:8192
    v_mfma_f32_16x16x32_bf16 v[60:63], v[240:243], v[92:95], 0
    ds_read_b64_tr_b16 v[234:235], v4 offset:9216
    s_waitcnt lgkmcnt(6)
    v_mfma_f32_16x16x32_bf16 v[64:67], v[244:247], v[88:91], 0
    ds_read_b64_tr_b16 v[236:237], v5 offset:8224
    v_mfma_f32_16x16x32_bf16 v[68:71], v[244:247], v[92:95], 0
    ds_read_b64_tr_b16 v[238:239], v5 offset:9248
    s_mov_b32 s23, 0x9000
    buffer_load_dwordx4 v[124:127], v7, s[8:11], s23 offen offset:0 sc1
    s_waitcnt lgkmcnt(6)
    v_mfma_f32_16x16x32_bf16 v[72:75], v[224:227], v[88:91], 0
    ds_read_b64_tr_b16 v[240:241], v4 offset:8448
    v_mfma_f32_16x16x32_bf16 v[76:79], v[224:227], v[92:95], 0
    ds_read_b64_tr_b16 v[242:243], v4 offset:9472
    s_waitcnt lgkmcnt(6)
    v_mfma_f32_16x16x32_bf16 v[80:83], v[228:231], v[88:91], 0
    ds_read_b64_tr_b16 v[244:245], v5 offset:8480
    v_mfma_f32_16x16x32_bf16 v[84:87], v[228:231], v[92:95], 0
    ds_read_b64_tr_b16 v[246:247], v5 offset:9504
    s_waitcnt vmcnt(7) lgkmcnt(6)
    v_mfma_f32_16x16x32_bf16 v[24:27], v[232:235], v[96:99], v[24:27]
    ds_read_b64_tr_b16 v[224:225], v4 offset:8704
    s_waitcnt vmcnt(6)
    v_mfma_f32_16x16x32_bf16 v[28:31], v[232:235], v[100:103], v[28:31]
    ds_read_b64_tr_b16 v[226:227], v4 offset:9728
    s_waitcnt lgkmcnt(6)
    v_mfma_f32_16x16x32_bf16 v[32:35], v[236:239], v[96:99], v[32:35]
    ds_read_b64_tr_b16 v[228:229], v5 offset:8736
    v_mfma_f32_16x16x32_bf16 v[36:39], v[236:239], v[100:103], v[36:39]
    ds_read_b64_tr_b16 v[230:231], v5 offset:9760
    s_mov_b32 s23, 0x1000
    buffer_load_dwordx4 v[128:131], v7, s[8:11], s23 offen offset:1024 sc1
    s_waitcnt lgkmcnt(6)
    v_mfma_f32_16x16x32_bf16 v[40:43], v[240:243], v[96:99], v[40:43]
    ds_read_b64_tr_b16 v[232:233], v4 offset:8960
    v_mfma_f32_16x16x32_bf16 v[44:47], v[240:243], v[100:103], v[44:47]
    ds_read_b64_tr_b16 v[234:235], v4 offset:9984
    s_waitcnt lgkmcnt(6)
    v_mfma_f32_16x16x32_bf16 v[48:51], v[244:247], v[96:99], v[48:51]
    ds_read_b64_tr_b16 v[236:237], v5 offset:8992
    v_mfma_f32_16x16x32_bf16 v[52:55], v[244:247], v[100:103], v[52:55]
    ds_read_b64_tr_b16 v[238:239], v5 offset:10016
    s_waitcnt lgkmcnt(6)
    v_mfma_f32_16x16x32_bf16 v[56:59], v[224:227], v[96:99], v[56:59]
    v_mfma_f32_16x16x32_bf16 v[60:63], v[224:227], v[100:103], v[60:63]
    s_barrier
    ds_read_b64_tr_b16 v[240:241], v4 offset:16384
    ds_read_b64_tr_b16 v[242:243], v4 offset:17408
    s_waitcnt lgkmcnt(6)
    v_mfma_f32_16x16x32_bf16 v[64:67], v[228:231], v[96:99], v[64:67]
    ds_read_b64_tr_b16 v[244:245], v5 offset:16416
    v_mfma_f32_16x16x32_bf16 v[68:71], v[228:231], v[100:103], v[68:71]
    s_add_u32 s22, s19, 0x180000
    s_add_u32 m0, s20, 0xc000
    s_nop 0
    buffer_load_dwordx4 v3, s[4:7], s22 offen lds
    ds_read_b64_tr_b16 v[246:247], v5 offset:17440
    s_mov_b32 s23, 0x9000
    buffer_load_dwordx4 v[132:135], v7, s[8:11], s23 offen offset:1024 sc1
    s_waitcnt lgkmcnt(6)
    v_mfma_f32_16x16x32_bf16 v[72:75], v[232:235], v[96:99], v[72:75]
    ds_read_b64_tr_b16 v[224:225], v4 offset:16640
    v_mfma_f32_16x16x32_bf16 v[76:79], v[232:235], v[100:103], v[76:79]
    ds_read_b64_tr_b16 v[226:227], v4 offset:17664
    s_waitcnt lgkmcnt(6)
    v_mfma_f32_16x16x32_bf16 v[80:83], v[236:239], v[96:99], v[80:83]
    ds_read_b64_tr_b16 v[228:229], v5 offset:16672
    v_mfma_f32_16x16x32_bf16 v[84:87], v[236:239], v[100:103], v[84:87]
    ds_read_b64_tr_b16 v[230:231], v5 offset:17696
    s_waitcnt vmcnt(8) lgkmcnt(6)
    v_mfma_f32_16x16x32_bf16 v[24:27], v[240:243], v[104:107], v[24:27]
    ds_read_b64_tr_b16 v[232:233], v4 offset:16896
    s_waitcnt vmcnt(7)
    v_mfma_f32_16x16x32_bf16 v[28:31], v[240:243], v[108:111], v[28:31]
    ds_read_b64_tr_b16 v[234:235], v4 offset:17920
    s_waitcnt lgkmcnt(6)
    v_mfma_f32_16x16x32_bf16 v[32:35], v[244:247], v[104:107], v[32:35]
    ds_read_b64_tr_b16 v[236:237], v5 offset:16928
    v_mfma_f32_16x16x32_bf16 v[36:39], v[244:247], v[108:111], v[36:39]
    s_add_u32 s22, s19, 0x188000
    s_add_u32 m0, s20, 0xc400
    s_nop 0
    buffer_load_dwordx4 v3, s[4:7], s22 offen lds
    ds_read_b64_tr_b16 v[238:239], v5 offset:17952
    s_mov_b32 s23, 0x1800
    buffer_load_dwordx4 v[88:91], v7, s[8:11], s23 offen offset:0 sc1
    s_waitcnt lgkmcnt(6)
    v_mfma_f32_16x16x32_bf16 v[40:43], v[224:227], v[104:107], v[40:43]
    ds_read_b64_tr_b16 v[240:241], v4 offset:17152
    v_mfma_f32_16x16x32_bf16 v[44:47], v[224:227], v[108:111], v[44:47]
    ds_read_b64_tr_b16 v[242:243], v4 offset:18176
    s_waitcnt lgkmcnt(6)
    v_mfma_f32_16x16x32_bf16 v[48:51], v[228:231], v[104:107], v[48:51]
    ds_read_b64_tr_b16 v[244:245], v5 offset:17184
    v_mfma_f32_16x16x32_bf16 v[52:55], v[228:231], v[108:111], v[52:55]
    ds_read_b64_tr_b16 v[246:247], v5 offset:18208
    s_waitcnt lgkmcnt(6)
    v_mfma_f32_16x16x32_bf16 v[56:59], v[232:235], v[104:107], v[56:59]
    ds_read_b64_tr_b16 v[224:225], v4 offset:24576
    v_mfma_f32_16x16x32_bf16 v[60:63], v[232:235], v[108:111], v[60:63]
    ds_read_b64_tr_b16 v[226:227], v4 offset:25600
    s_waitcnt lgkmcnt(6)
    v_mfma_f32_16x16x32_bf16 v[64:67], v[236:239], v[104:107], v[64:67]
    ds_read_b64_tr_b16 v[228:229], v5 offset:24608
    v_mfma_f32_16x16x32_bf16 v[68:71], v[236:239], v[108:111], v[68:71]
    ds_read_b64_tr_b16 v[230:231], v5 offset:25632
    s_mov_b32 s23, 0x9800
    buffer_load_dwordx4 v[92:95], v7, s[8:11], s23 offen offset:0 sc1
    s_waitcnt lgkmcnt(6)
    v_mfma_f32_16x16x32_bf16 v[72:75], v[240:243], v[104:107], v[72:75]
    ds_read_b64_tr_b16 v[232:233], v4 offset:24832
    v_mfma_f32_16x16x32_bf16 v[76:79], v[240:243], v[108:111], v[76:79]
    ds_read_b64_tr_b16 v[234:235], v4 offset:25856
    s_waitcnt lgkmcnt(6)
    v_mfma_f32_16x16x32_bf16 v[80:83], v[244:247], v[104:107], v[80:83]
    ds_read_b64_tr_b16 v[236:237], v5 offset:24864
    v_mfma_f32_16x16x32_bf16 v[84:87], v[244:247], v[108:111], v[84:87]
    ds_read_b64_tr_b16 v[238:239], v5 offset:25888
    s_waitcnt vmcnt(9) lgkmcnt(6)
    v_mfma_f32_16x16x32_bf16 v[24:27], v[224:227], v[112:115], v[24:27]
    ds_read_b64_tr_b16 v[240:241], v4 offset:25088
    s_waitcnt vmcnt(8)
    v_mfma_f32_16x16x32_bf16 v[28:31], v[224:227], v[116:119], v[28:31]
    ds_read_b64_tr_b16 v[242:243], v4 offset:26112
    s_waitcnt lgkmcnt(6)
    v_mfma_f32_16x16x32_bf16 v[32:35], v[228:231], v[112:115], v[32:35]
    ds_read_b64_tr_b16 v[244:245], v5 offset:25120
    v_mfma_f32_16x16x32_bf16 v[36:39], v[228:231], v[116:119], v[36:39]
    ds_read_b64_tr_b16 v[246:247], v5 offset:26144
    s_mov_b32 s23, 0x1800
    buffer_load_dwordx4 v[96:99], v7, s[8:11], s23 offen offset:1024 sc1
    s_waitcnt lgkmcnt(6)
    v_mfma_f32_16x16x32_bf16 v[40:43], v[232:235], v[112:115], v[40:43]
    ds_read_b64_tr_b16 v[224:225], v4 offset:25344
    v_mfma_f32_16x16x32_bf16 v[44:47], v[232:235], v[116:119], v[44:47]
    ds_read_b64_tr_b16 v[226:227], v4 offset:26368
    s_waitcnt lgkmcnt(6)
    v_mfma_f32_16x16x32_bf16 v[48:51], v[236:239], v[112:115], v[48:51]
    ds_read_b64_tr_b16 v[228:229], v5 offset:25376
    v_mfma_f32_16x16x32_bf16 v[52:55], v[236:239], v[116:119], v[52:55]
    ds_read_b64_tr_b16 v[230:231], v5 offset:26400
    s_waitcnt lgkmcnt(6)
    v_mfma_f32_16x16x32_bf16 v[56:59], v[240:243], v[112:115], v[56:59]
    v_mfma_f32_16x16x32_bf16 v[60:63], v[240:243], v[116:119], v[60:63]
    s_barrier
    ds_read_b64_tr_b16 v[232:233], v4 offset:32768
    ds_read_b64_tr_b16 v[234:235], v4 offset:33792
    s_waitcnt lgkmcnt(6)
    v_mfma_f32_16x16x32_bf16 v[64:67], v[244:247], v[112:115], v[64:67]
    ds_read_b64_tr_b16 v[236:237], v5 offset:32800
    v_mfma_f32_16x16x32_bf16 v[68:71], v[244:247], v[116:119], v[68:71]
    s_add_u32 s22, s19, 0x200000
    s_add_u32 m0, s20, 0x0
    s_nop 0
    buffer_load_dwordx4 v3, s[4:7], s22 offen lds
    ds_read_b64_tr_b16 v[238:239], v5 offset:33824
    s_mov_b32 s23, 0x9800
    buffer_load_dwordx4 v[100:103], v7, s[8:11], s23 offen offset:1024 sc1
    s_waitcnt lgkmcnt(6)
    v_mfma_f32_16x16x32_bf16 v[72:75], v[224:227], v[112:115], v[72:75]
    ds_read_b64_tr_b16 v[240:241], v4 offset:33024
    v_mfma_f32_16x16x32_bf16 v[76:79], v[224:227], v[116:119], v[76:79]
    ds_read_b64_tr_b16 v[242:243], v4 offset:34048
    s_waitcnt lgkmcnt(6)
    v_mfma_f32_16x16x32_bf16 v[80:83], v[228:231], v[112:115], v[80:83]
    ds_read_b64_tr_b16 v[244:245], v5 offset:33056
    v_mfma_f32_16x16x32_bf16 v[84:87], v[228:231], v[116:119], v[84:87]
    ds_read_b64_tr_b16 v[246:247], v5 offset:34080
    s_waitcnt vmcnt(10) lgkmcnt(6)
    v_mfma_f32_16x16x32_bf16 v[24:27], v[232:235], v[120:123], v[24:27]
    ds_read_b64_tr_b16 v[224:225], v4 offset:33280
    s_waitcnt vmcnt(9)
    v_mfma_f32_16x16x32_bf16 v[28:31], v[232:235], v[124:127], v[28:31]
    ds_read_b64_tr_b16 v[226:227], v4 offset:34304
    s_waitcnt lgkmcnt(6)
    v_mfma_f32_16x16x32_bf16 v[32:35], v[236:239], v[120:123], v[32:35]
    ds_read_b64_tr_b16 v[228:229], v5 offset:33312
    v_mfma_f32_16x16x32_bf16 v[36:39], v[236:239], v[124:127], v[36:39]
    s_add_u32 s22, s19, 0x208000
    s_add_u32 m0, s20, 0x400
    s_nop 0
    buffer_load_dwordx4 v3, s[4:7], s22 offen lds
    ds_read_b64_tr_b16 v[230:231], v5 offset:34336
    s_mov_b32 s23, 0x2000
    buffer_load_dwordx4 v[104:107], v7, s[8:11], s23 offen offset:0 sc1
    s_waitcnt lgkmcnt(6)
    v_mfma_f32_16x16x32_bf16 v[40:43], v[240:243], v[120:123], v[40:43]
    ds_read_b64_tr_b16 v[232:233], v4 offset:33536
    v_mfma_f32_16x16x32_bf16 v[44:47], v[240:243], v[124:127], v[44:47]
    ds_read_b64_tr_b16 v[234:235], v4 offset:34560
    s_waitcnt lgkmcnt(6)
    v_mfma_f32_16x16x32_bf16 v[48:51], v[244:247], v[120:123], v[48:51]
    ds_read_b64_tr_b16 v[236:237], v5 offset:33568
    v_mfma_f32_16x16x32_bf16 v[52:55], v[244:247], v[124:127], v[52:55]
    ds_read_b64_tr_b16 v[238:239], v5 offset:34592
    s_waitcnt lgkmcnt(6)
    v_mfma_f32_16x16x32_bf16 v[56:59], v[224:227], v[120:123], v[56:59]
    ds_read_b64_tr_b16 v[240:241], v4 offset:40960
    v_mfma_f32_16x16x32_bf16 v[60:63], v[224:227], v[124:127], v[60:63]
    ds_read_b64_tr_b16 v[242:243], v4 offset:41984
    s_waitcnt lgkmcnt(6)
    v_mfma_f32_16x16x32_bf16 v[64:67], v[228:231], v[120:123], v[64:67]
    ds_read_b64_tr_b16 v[244:245], v5 offset:40992
    v_mfma_f32_16x16x32_bf16 v[68:71], v[228:231], v[124:127], v[68:71]
    ds_read_b64_tr_b16 v[246:247], v5 offset:42016
    s_mov_b32 s23, 0xa000
    buffer_load_dwordx4 v[108:111], v7, s[8:11], s23 offen offset:0 sc1
    s_waitcnt lgkmcnt(6)
    v_mfma_f32_16x16x32_bf16 v[72:75], v[232:235], v[120:123], v[72:75]
    ds_read_b64_tr_b16 v[224:225], v4 offset:41216
    v_mfma_f32_16x16x32_bf16 v[76:79], v[232:235], v[124:127], v[76:79]
    ds_read_b64_tr_b16 v[226:227], v4 offset:42240
    s_waitcnt lgkmcnt(6)
    v_mfma_f32_16x16x32_bf16 v[80:83], v[236:239], v[120:123], v[80:83]
    ds_read_b64_tr_b16 v[228:229], v5 offset:41248
    v_mfma_f32_16x16x32_bf16 v[84:87], v[236:239], v[124:127], v[84:87]
    ds_read_b64_tr_b16 v[230:231], v5 offset:42272
    s_waitcnt vmcnt(11) lgkmcnt(6)
    v_mfma_f32_16x16x32_bf16 v[24:27], v[240:243], v[128:131], v[24:27]
    ds_read_b64_tr_b16 v[232:233], v4 offset:41472
    s_waitcnt vmcnt(9)
    v_mfma_f32_16x16x32_bf16 v[28:31], v[240:243], v[132:135], v[28:31]
    ds_read_b64_tr_b16 v[234:235], v4 offset:42496
    s_waitcnt lgkmcnt(6)
    v_mfma_f32_16x16x32_bf16 v[32:35], v[244:247], v[128:131], v[32:35]
    ds_read_b64_tr_b16 v[236:237], v5 offset:41504
    v_mfma_f32_16x16x32_bf16 v[36:39], v[244:247], v[132:135], v[36:39]
    ds_read_b64_tr_b16 v[238:239], v5 offset:42528
    s_mov_b32 s23, 0x2000
    buffer_load_dwordx4 v[112:115], v7, s[8:11], s23 offen offset:1024 sc1
    s_waitcnt lgkmcnt(6)
    v_mfma_f32_16x16x32_bf16 v[40:43], v[224:227], v[128:131], v[40:43]
    ds_read_b64_tr_b16 v[240:241], v4 offset:41728
    v_mfma_f32_16x16x32_bf16 v[44:47], v[224:227], v[132:135], v[44:47]
    ds_read_b64_tr_b16 v[242:243], v4 offset:42752
    s_waitcnt lgkmcnt(6)
    v_mfma_f32_16x16x32_bf16 v[48:51], v[228:231], v[128:131], v[48:51]
    ds_read_b64_tr_b16 v[244:245], v5 offset:41760
    v_mfma_f32_16x16x32_bf16 v[52:55], v[228:231], v[132:135], v[52:55]
    ds_read_b64_tr_b16 v[246:247], v5 offset:42784
    s_waitcnt lgkmcnt(6)
    v_mfma_f32_16x16x32_bf16 v[56:59], v[232:235], v[128:131], v[56:59]
    v_mfma_f32_16x16x32_bf16 v[60:63], v[232:235], v[132:135], v[60:63]
    s_waitcnt vmcnt(9)
    s_barrier
    ds_read_b64_tr_b16 v[224:225], v4 offset:49152
    ds_read_b64_tr_b16 v[226:227], v4 offset:50176
    s_waitcnt lgkmcnt(6)
    v_mfma_f32_16x16x32_bf16 v[64:67], v[236:239], v[128:131], v[64:67]
    ds_read_b64_tr_b16 v[228:229], v5 offset:49184
    v_mfma_f32_16x16x32_bf16 v[68:71], v[236:239], v[132:135], v[68:71]
    s_add_u32 s22, s19, 0x280000
    s_add_u32 m0, s20, 0x4000
    s_nop 0
    buffer_load_dwordx4 v3, s[4:7], s22 offen lds
    ds_read_b64_tr_b16 v[230:231], v5 offset:50208
    s_mov_b32 s23, 0xa000
    buffer_load_dwordx4 v[116:119], v7, s[8:11], s23 offen offset:1024 sc1
    s_waitcnt lgkmcnt(6)
    v_mfma_f32_16x16x32_bf16 v[72:75], v[240:243], v[128:131], v[72:75]
    ds_read_b64_tr_b16 v[232:233], v4 offset:49408
    v_mfma_f32_16x16x32_bf16 v[76:79], v[240:243], v[132:135], v[76:79]
    ds_read_b64_tr_b16 v[234:235], v4 offset:50432
    s_waitcnt lgkmcnt(6)
    v_mfma_f32_16x16x32_bf16 v[80:83], v[244:247], v[128:131], v[80:83]
    ds_read_b64_tr_b16 v[236:237], v5 offset:49440
    v_mfma_f32_16x16x32_bf16 v[84:87], v[244:247], v[132:135], v[84:87]
    ds_read_b64_tr_b16 v[238:239], v5 offset:50464
    s_waitcnt vmcnt(10) lgkmcnt(6)
    v_mfma_f32_16x16x32_bf16 v[24:27], v[224:227], v[88:91], v[24:27]
    ds_read_b64_tr_b16 v[240:241], v4 offset:49664
    s_waitcnt vmcnt(9)
    v_mfma_f32_16x16x32_bf16 v[28:31], v[224:227], v[92:95], v[28:31]
    ds_read_b64_tr_b16 v[242:243], v4 offset:50688
    s_waitcnt lgkmcnt(6)
    v_mfma_f32_16x16x32_bf16 v[32:35], v[228:231], v[88:91], v[32:35]
    ds_read_b64_tr_b16 v[244:245], v5 offset:49696
    v_mfma_f32_16x16x32_bf16 v[36:39], v[228:231], v[92:95], v[36:39]
    s_add_u32 s22, s19, 0x288000
    s_add_u32 m0, s20, 0x4400
    s_nop 0
    buffer_load_dwordx4 v3, s[4:7], s22 offen lds
    ds_read_b64_tr_b16 v[246:247], v5 offset:50720
    s_mov_b32 s23, 0x2800
    buffer_load_dwordx4 v[120:123], v7, s[8:11], s23 offen offset:0 sc1
    s_waitcnt lgkmcnt(6)
    v_mfma_f32_16x16x32_bf16 v[40:43], v[232:235], v[88:91], v[40:43]
    ds_read_b64_tr_b16 v[224:225], v4 offset:49920
    v_mfma_f32_16x16x32_bf16 v[44:47], v[232:235], v[92:95], v[44:47]
    ds_read_b64_tr_b16 v[226:227], v4 offset:50944
    s_waitcnt lgkmcnt(6)
    v_mfma_f32_16x16x32_bf16 v[48:51], v[236:239], v[88:91], v[48:51]
    ds_read_b64_tr_b16 v[228:229], v5 offset:49952
    v_mfma_f32_16x16x32_bf16 v[52:55], v[236:239], v[92:95], v[52:55]
    ds_read_b64_tr_b16 v[230:231], v5 offset:50976
    s_waitcnt lgkmcnt(6)
    v_mfma_f32_16x16x32_bf16 v[56:59], v[240:243], v[88:91], v[56:59]
    ds_read_b64_tr_b16 v[232:233], v4 offset:57344
    v_mfma_f32_16x16x32_bf16 v[60:63], v[240:243], v[92:95], v[60:63]
    ds_read_b64_tr_b16 v[234:235], v4 offset:58368
    s_waitcnt lgkmcnt(6)
    v_mfma_f32_16x16x32_bf16 v[64:67], v[244:247], v[88:91], v[64:67]
    ds_read_b64_tr_b16 v[236:237], v5 offset:57376
    v_mfma_f32_16x16x32_bf16 v[68:71], v[244:247], v[92:95], v[68:71]
    ds_read_b64_tr_b16 v[238:239], v5 offset:58400
    s_mov_b32 s23, 0xa800
    buffer_load_dwordx4 v[124:127], v7, s[8:11], s23 offen offset:0 sc1
    s_waitcnt lgkmcnt(6)
    v_mfma_f32_16x16x32_bf16 v[72:75], v[224:227], v[88:91], v[72:75]
    ds_read_b64_tr_b16 v[240:241], v4 offset:57600
    v_mfma_f32_16x16x32_bf16 v[76:79], v[224:227], v[92:95], v[76:79]
    ds_read_b64_tr_b16 v[242:243], v4 offset:58624
    s_waitcnt lgkmcnt(6)
    v_mfma_f32_16x16x32_bf16 v[80:83], v[228:231], v[88:91], v[80:83]
    ds_read_b64_tr_b16 v[244:245], v5 offset:57632
    v_mfma_f32_16x16x32_bf16 v[84:87], v[228:231], v[92:95], v[84:87]
    ds_read_b64_tr_b16 v[246:247], v5 offset:58656
    s_waitcnt vmcnt(11) lgkmcnt(6)
    v_mfma_f32_16x16x32_bf16 v[24:27], v[232:235], v[96:99], v[24:27]
    ds_read_b64_tr_b16 v[224:225], v4 offset:57856
    s_waitcnt vmcnt(9)
    v_mfma_f32_16x16x32_bf16 v[28:31], v[232:235], v[100:103], v[28:31]
    ds_read_b64_tr_b16 v[226:227], v4 offset:58880
    s_waitcnt lgkmcnt(6)
    v_mfma_f32_16x16x32_bf16 v[32:35], v[236:239], v[96:99], v[32:35]
    ds_read_b64_tr_b16 v[228:229], v5 offset:57888
    v_mfma_f32_16x16x32_bf16 v[36:39], v[236:239], v[100:103], v[36:39]
    ds_read_b64_tr_b16 v[230:231], v5 offset:58912
    s_mov_b32 s23, 0x2800
    buffer_load_dwordx4 v[128:131], v7, s[8:11], s23 offen offset:1024 sc1
    s_waitcnt lgkmcnt(6)
    v_mfma_f32_16x16x32_bf16 v[40:43], v[240:243], v[96:99], v[40:43]
    ds_read_b64_tr_b16 v[232:233], v4 offset:58112
    v_mfma_f32_16x16x32_bf16 v[44:47], v[240:243], v[100:103], v[44:47]
    ds_read_b64_tr_b16 v[234:235], v4 offset:59136
    s_waitcnt lgkmcnt(6)
    v_mfma_f32_16x16x32_bf16 v[48:51], v[244:247], v[96:99], v[48:51]
    ds_read_b64_tr_b16 v[236:237], v5 offset:58144
    v_mfma_f32_16x16x32_bf16 v[52:55], v[244:247], v[100:103], v[52:55]
    ds_read_b64_tr_b16 v[238:239], v5 offset:59168
    s_waitcnt lgkmcnt(6)
    v_mfma_f32_16x16x32_bf16 v[56:59], v[224:227], v[96:99], v[56:59]
    v_mfma_f32_16x16x32_bf16 v[60:63], v[224:227], v[100:103], v[60:63]
    s_waitcnt vmcnt(9)
    s_barrier
    ds_read_b64_tr_b16 v[240:241], v4 offset:0
    ds_read_b64_tr_b16 v[242:243], v4 offset:1024
    s_waitcnt lgkmcnt(6)
    v_mfma_f32_16x16x32_bf16 v[64:67], v[228:231], v[96:99], v[64:67]
    ds_read_b64_tr_b16 v[244:245], v5 offset:32
    v_mfma_f32_16x16x32_bf16 v[68:71], v[228:231], v[100:103], v[68:71]
    s_add_u32 s22, s19, 0x300000
    s_add_u32 m0, s20, 0x8000
    s_nop 0
    buffer_load_dwordx4 v3, s[4:7], s22 offen lds
    ds_read_b64_tr_b16 v[246:247], v5 offset:1056
    s_mov_b32 s23, 0xa800
    buffer_load_dwordx4 v[132:135], v7, s[8:11], s23 offen offset:1024 sc1
    s_waitcnt lgkmcnt(6)
    v_mfma_f32_16x16x32_bf16 v[72:75], v[232:235], v[96:99], v[72:75]
    ds_read_b64_tr_b16 v[224:225], v4 offset:256
    v_mfma_f32_16x16x32_bf16 v[76:79], v[232:235], v[100:103], v[76:79]
    ds_read_b64_tr_b16 v[226:227], v4 offset:1280
    s_waitcnt lgkmcnt(6)
    v_mfma_f32_16x16x32_bf16 v[80:83], v[236:239], v[96:99], v[80:83]
    ds_read_b64_tr_b16 v[228:229], v5 offset:288
    v_mfma_f32_16x16x32_bf16 v[84:87], v[236:239], v[100:103], v[84:87]
    ds_read_b64_tr_b16 v[230:231], v5 offset:1312
    s_waitcnt vmcnt(10) lgkmcnt(6)
    v_mfma_f32_16x16x32_bf16 v[24:27], v[240:243], v[104:107], v[24:27]
    ds_read_b64_tr_b16 v[232:233], v4 offset:512
    s_waitcnt vmcnt(9)
    v_mfma_f32_16x16x32_bf16 v[28:31], v[240:243], v[108:111], v[28:31]
    ds_read_b64_tr_b16 v[234:235], v4 offset:1536
    s_waitcnt lgkmcnt(6)
    v_mfma_f32_16x16x32_bf16 v[32:35], v[244:247], v[104:107], v[32:35]
    ds_read_b64_tr_b16 v[236:237], v5 offset:544
    v_mfma_f32_16x16x32_bf16 v[36:39], v[244:247], v[108:111], v[36:39]
    s_add_u32 s22, s19, 0x308000
    s_add_u32 m0, s20, 0x8400
    s_nop 0
    buffer_load_dwordx4 v3, s[4:7], s22 offen lds
    ds_read_b64_tr_b16 v[238:239], v5 offset:1568
    s_mov_b32 s23, 0x3000
    buffer_load_dwordx4 v[88:91], v7, s[8:11], s23 offen offset:0 sc1
    s_waitcnt lgkmcnt(6)
    v_mfma_f32_16x16x32_bf16 v[40:43], v[224:227], v[104:107], v[40:43]
    ds_read_b64_tr_b16 v[240:241], v4 offset:768
    v_mfma_f32_16x16x32_bf16 v[44:47], v[224:227], v[108:111], v[44:47]
    ds_read_b64_tr_b16 v[242:243], v4 offset:1792
    s_waitcnt lgkmcnt(6)
    v_mfma_f32_16x16x32_bf16 v[48:51], v[228:231], v[104:107], v[48:51]
    ds_read_b64_tr_b16 v[244:245], v5 offset:800
    v_mfma_f32_16x16x32_bf16 v[52:55], v[228:231], v[108:111], v[52:55]
    ds_read_b64_tr_b16 v[246:247], v5 offset:1824
    s_waitcnt lgkmcnt(6)
    v_mfma_f32_16x16x32_bf16 v[56:59], v[232:235], v[104:107], v[56:59]
    ds_read_b64_tr_b16 v[224:225], v4 offset:8192
    v_mfma_f32_16x16x32_bf16 v[60:63], v[232:235], v[108:111], v[60:63]
    ds_read_b64_tr_b16 v[226:227], v4 offset:9216
    s_waitcnt lgkmcnt(6)
    v_mfma_f32_16x16x32_bf16 v[64:67], v[236:239], v[104:107], v[64:67]
    ds_read_b64_tr_b16 v[228:229], v5 offset:8224
    v_mfma_f32_16x16x32_bf16 v[68:71], v[236:239], v[108:111], v[68:71]
    ds_read_b64_tr_b16 v[230:231], v5 offset:9248
    s_mov_b32 s23, 0xb000
    buffer_load_dwordx4 v[92:95], v7, s[8:11], s23 offen offset:0 sc1
    s_waitcnt lgkmcnt(6)
    v_mfma_f32_16x16x32_bf16 v[72:75], v[240:243], v[104:107], v[72:75]
    ds_read_b64_tr_b16 v[232:233], v4 offset:8448
    v_mfma_f32_16x16x32_bf16 v[76:79], v[240:243], v[108:111], v[76:79]
    ds_read_b64_tr_b16 v[234:235], v4 offset:9472
    s_waitcnt lgkmcnt(6)
    v_mfma_f32_16x16x32_bf16 v[80:83], v[244:247], v[104:107], v[80:83]
    ds_read_b64_tr_b16 v[236:237], v5 offset:8480
    v_mfma_f32_16x16x32_bf16 v[84:87], v[244:247], v[108:111], v[84:87]
    ds_read_b64_tr_b16 v[238:239], v5 offset:9504
    s_waitcnt vmcnt(11) lgkmcnt(6)
    v_mfma_f32_16x16x32_bf16 v[24:27], v[224:227], v[112:115], v[24:27]
    ds_read_b64_tr_b16 v[240:241], v4 offset:8704
    s_waitcnt vmcnt(9)
    v_mfma_f32_16x16x32_bf16 v[28:31], v[224:227], v[116:119], v[28:31]
    ds_read_b64_tr_b16 v[242:243], v4 offset:9728
    s_waitcnt lgkmcnt(6)
    v_mfma_f32_16x16x32_bf16 v[32:35], v[228:231], v[112:115], v[32:35]
    ds_read_b64_tr_b16 v[244:245], v5 offset:8736
    v_mfma_f32_16x16x32_bf16 v[36:39], v[228:231], v[116:119], v[36:39]
    ds_read_b64_tr_b16 v[246:247], v5 offset:9760
    s_mov_b32 s23, 0x3000
    buffer_load_dwordx4 v[96:99], v7, s[8:11], s23 offen offset:1024 sc1
    s_waitcnt lgkmcnt(6)
    v_mfma_f32_16x16x32_bf16 v[40:43], v[232:235], v[112:115], v[40:43]
    ds_read_b64_tr_b16 v[224:225], v4 offset:8960
    v_mfma_f32_16x16x32_bf16 v[44:47], v[232:235], v[116:119], v[44:47]
    ds_read_b64_tr_b16 v[226:227], v4 offset:9984
    s_waitcnt lgkmcnt(6)
    v_mfma_f32_16x16x32_bf16 v[48:51], v[236:239], v[112:115], v[48:51]
    ds_read_b64_tr_b16 v[228:229], v5 offset:8992
    v_mfma_f32_16x16x32_bf16 v[52:55], v[236:239], v[116:119], v[52:55]
    ds_read_b64_tr_b16 v[230:231], v5 offset:10016
    s_waitcnt lgkmcnt(6)
    v_mfma_f32_16x16x32_bf16 v[56:59], v[240:243], v[112:115], v[56:59]
    v_mfma_f32_16x16x32_bf16 v[60:63], v[240:243], v[116:119], v[60:63]
    s_waitcnt vmcnt(9)
    s_barrier
    ds_read_b64_tr_b16 v[232:233], v4 offset:16384
    ds_read_b64_tr_b16 v[234:235], v4 offset:17408
    s_waitcnt lgkmcnt(6)
    v_mfma_f32_16x16x32_bf16 v[64:67], v[244:247], v[112:115], v[64:67]
    ds_read_b64_tr_b16 v[236:237], v5 offset:16416
    v_mfma_f32_16x16x32_bf16 v[68:71], v[244:247], v[116:119], v[68:71]
    s_add_u32 s22, s19, 0x380000
    s_add_u32 m0, s20, 0xc000
    s_nop 0
    buffer_load_dwordx4 v3, s[4:7], s22 offen lds
    ds_read_b64_tr_b16 v[238:239], v5 offset:17440
    s_mov_b32 s23, 0xb000
    buffer_load_dwordx4 v[100:103], v7, s[8:11], s23 offen offset:1024 sc1
    s_waitcnt lgkmcnt(6)
    v_mfma_f32_16x16x32_bf16 v[72:75], v[224:227], v[112:115], v[72:75]
    ds_read_b64_tr_b16 v[240:241], v4 offset:16640
    v_mfma_f32_16x16x32_bf16 v[76:79], v[224:227], v[116:119], v[76:79]
    ds_read_b64_tr_b16 v[242:243], v4 offset:17664
    s_waitcnt lgkmcnt(6)
    v_mfma_f32_16x16x32_bf16 v[80:83], v[228:231], v[112:115], v[80:83]
    ds_read_b64_tr_b16 v[244:245], v5 offset:16672
    v_mfma_f32_16x16x32_bf16 v[84:87], v[228:231], v[116:119], v[84:87]
    ds_read_b64_tr_b16 v[246:247], v5 offset:17696
    s_waitcnt vmcnt(10) lgkmcnt(6)
    v_mfma_f32_16x16x32_bf16 v[24:27], v[232:235], v[120:123], v[24:27]
    ds_read_b64_tr_b16 v[224:225], v4 offset:16896
    s_waitcnt vmcnt(9)
    v_mfma_f32_16x16x32_bf16 v[28:31], v[232:235], v[124:127], v[28:31]
    ds_read_b64_tr_b16 v[226:227], v4 offset:17920
    s_waitcnt lgkmcnt(6)
    v_mfma_f32_16x16x32_bf16 v[32:35], v[236:239], v[120:123], v[32:35]
    ds_read_b64_tr_b16 v[228:229], v5 offset:16928
    v_mfma_f32_16x16x32_bf16 v[36:39], v[236:239], v[124:127], v[36:39]
    s_add_u32 s22, s19, 0x388000
    s_add_u32 m0, s20, 0xc400
    s_nop 0
    buffer_load_dwordx4 v3, s[4:7], s22 offen lds
    ds_read_b64_tr_b16 v[230:231], v5 offset:17952
    s_mov_b32 s23, 0x3800
    buffer_load_dwordx4 v[104:107], v7, s[8:11], s23 offen offset:0 sc1
    s_waitcnt lgkmcnt(6)
    v_mfma_f32_16x16x32_bf16 v[40:43], v[240:243], v[120:123], v[40:43]
    ds_read_b64_tr_b16 v[232:233], v4 offset:17152
    v_mfma_f32_16x16x32_bf16 v[44:47], v[240:243], v[124:127], v[44:47]
    ds_read_b64_tr_b16 v[234:235], v4 offset:18176
    s_waitcnt lgkmcnt(6)
    v_mfma_f32_16x16x32_bf16 v[48:51], v[244:247], v[120:123], v[48:51]
    ds_read_b64_tr_b16 v[236:237], v5 offset:17184
    v_mfma_f32_16x16x32_bf16 v[52:55], v[244:247], v[124:127], v[52:55]
    ds_read_b64_tr_b16 v[238:239], v5 offset:18208
    s_waitcnt lgkmcnt(6)
    v_mfma_f32_16x16x32_bf16 v[56:59], v[224:227], v[120:123], v[56:59]
    ds_read_b64_tr_b16 v[240:241], v4 offset:24576
    v_mfma_f32_16x16x32_bf16 v[60:63], v[224:227], v[124:127], v[60:63]
    ds_read_b64_tr_b16 v[242:243], v4 offset:25600
    s_waitcnt lgkmcnt(6)
    v_mfma_f32_16x16x32_bf16 v[64:67], v[228:231], v[120:123], v[64:67]
    ds_read_b64_tr_b16 v[244:245], v5 offset:24608
    v_mfma_f32_16x16x32_bf16 v[68:71], v[228:231], v[124:127], v[68:71]
    ds_read_b64_tr_b16 v[246:247], v5 offset:25632
    s_mov_b32 s23, 0xb800
    buffer_load_dwordx4 v[108:111], v7, s[8:11], s23 offen offset:0 sc1
    s_waitcnt lgkmcnt(6)
    v_mfma_f32_16x16x32_bf16 v[72:75], v[232:235], v[120:123], v[72:75]
    ds_read_b64_tr_b16 v[224:225], v4 offset:24832
    v_mfma_f32_16x16x32_bf16 v[76:79], v[232:235], v[124:127], v[76:79]
    ds_read_b64_tr_b16 v[226:227], v4 offset:25856
    s_waitcnt lgkmcnt(6)
    v_mfma_f32_16x16x32_bf16 v[80:83], v[236:239], v[120:123], v[80:83]
    ds_read_b64_tr_b16 v[228:229], v5 offset:24864
    v_mfma_f32_16x16x32_bf16 v[84:87], v[236:239], v[124:127], v[84:87]
    ds_read_b64_tr_b16 v[230:231], v5 offset:25888
    s_waitcnt vmcnt(11) lgkmcnt(6)
    v_mfma_f32_16x16x32_bf16 v[24:27], v[240:243], v[128:131], v[24:27]
    ds_read_b64_tr_b16 v[232:233], v4 offset:25088
    s_waitcnt vmcnt(9)
    v_mfma_f32_16x16x32_bf16 v[28:31], v[240:243], v[132:135], v[28:31]
    ds_read_b64_tr_b16 v[234:235], v4 offset:26112
    s_waitcnt lgkmcnt(6)
    v_mfma_f32_16x16x32_bf16 v[32:35], v[244:247], v[128:131], v[32:35]
    ds_read_b64_tr_b16 v[236:237], v5 offset:25120
    v_mfma_f32_16x16x32_bf16 v[36:39], v[244:247], v[132:135], v[36:39]
    ds_read_b64_tr_b16 v[238:239], v5 offset:26144
    s_mov_b32 s23, 0x3800
    buffer_load_dwordx4 v[112:115], v7, s[8:11], s23 offen offset:1024 sc1
    s_waitcnt lgkmcnt(6)
    v_mfma_f32_16x16x32_bf16 v[40:43], v[224:227], v[128:131], v[40:43]
    ds_read_b64_tr_b16 v[240:241], v4 offset:25344
    v_mfma_f32_16x16x32_bf16 v[44:47], v[224:227], v[132:135], v[44:47]
    ds_read_b64_tr_b16 v[242:243], v4 offset:26368
    s_waitcnt lgkmcnt(6)
    v_mfma_f32_16x16x32_bf16 v[48:51], v[228:231], v[128:131], v[48:51]
    ds_read_b64_tr_b16 v[244:245], v5 offset:25376
    v_mfma_f32_16x16x32_bf16 v[52:55], v[228:231], v[132:135], v[52:55]
    ds_read_b64_tr_b16 v[246:247], v5 offset:26400
    s_waitcnt lgkmcnt(6)
    v_mfma_f32_16x16x32_bf16 v[56:59], v[232:235], v[128:131], v[56:59]
    v_mfma_f32_16x16x32_bf16 v[60:63], v[232:235], v[132:135], v[60:63]
    s_waitcnt vmcnt(9)
    s_barrier
    ds_read_b64_tr_b16 v[224:225], v4 offset:32768
    ds_read_b64_tr_b16 v[226:227], v4 offset:33792
    s_waitcnt lgkmcnt(6)
    v_mfma_f32_16x16x32_bf16 v[64:67], v[236:239], v[128:131], v[64:67]
    ds_read_b64_tr_b16 v[228:229], v5 offset:32800
    v_mfma_f32_16x16x32_bf16 v[68:71], v[236:239], v[132:135], v[68:71]
    s_add_u32 s22, s19, 0x400000
    s_add_u32 m0, s20, 0x0
    s_nop 0
    buffer_load_dwordx4 v3, s[4:7], s22 offen lds
    ds_read_b64_tr_b16 v[230:231], v5 offset:33824
    s_mov_b32 s23, 0xb800
    buffer_load_dwordx4 v[116:119], v7, s[8:11], s23 offen offset:1024 sc1
    s_waitcnt lgkmcnt(6)
    v_mfma_f32_16x16x32_bf16 v[72:75], v[240:243], v[128:131], v[72:75]
    ds_read_b64_tr_b16 v[232:233], v4 offset:33024
    v_mfma_f32_16x16x32_bf16 v[76:79], v[240:243], v[132:135], v[76:79]
    ds_read_b64_tr_b16 v[234:235], v4 offset:34048
    s_waitcnt lgkmcnt(6)
    v_mfma_f32_16x16x32_bf16 v[80:83], v[244:247], v[128:131], v[80:83]
    ds_read_b64_tr_b16 v[236:237], v5 offset:33056
    v_mfma_f32_16x16x32_bf16 v[84:87], v[244:247], v[132:135], v[84:87]
    ds_read_b64_tr_b16 v[238:239], v5 offset:34080
    s_waitcnt vmcnt(10) lgkmcnt(6)
    v_mfma_f32_16x16x32_bf16 v[24:27], v[224:227], v[88:91], v[24:27]
    ds_read_b64_tr_b16 v[240:241], v4 offset:33280
    s_waitcnt vmcnt(9)
    v_mfma_f32_16x16x32_bf16 v[28:31], v[224:227], v[92:95], v[28:31]
    ds_read_b64_tr_b16 v[242:243], v4 offset:34304
    s_waitcnt lgkmcnt(6)
    v_mfma_f32_16x16x32_bf16 v[32:35], v[228:231], v[88:91], v[32:35]
    ds_read_b64_tr_b16 v[244:245], v5 offset:33312
    v_mfma_f32_16x16x32_bf16 v[36:39], v[228:231], v[92:95], v[36:39]
    s_add_u32 s22, s19, 0x408000
    s_add_u32 m0, s20, 0x400
    s_nop 0
    buffer_load_dwordx4 v3, s[4:7], s22 offen lds
    ds_read_b64_tr_b16 v[246:247], v5 offset:34336
    s_mov_b32 s23, 0x4000
    buffer_load_dwordx4 v[120:123], v7, s[8:11], s23 offen offset:0 sc1
    s_waitcnt lgkmcnt(6)
    v_mfma_f32_16x16x32_bf16 v[40:43], v[232:235], v[88:91], v[40:43]
    ds_read_b64_tr_b16 v[224:225], v4 offset:33536
    v_mfma_f32_16x16x32_bf16 v[44:47], v[232:235], v[92:95], v[44:47]
    ds_read_b64_tr_b16 v[226:227], v4 offset:34560
    s_waitcnt lgkmcnt(6)
    v_mfma_f32_16x16x32_bf16 v[48:51], v[236:239], v[88:91], v[48:51]
    ds_read_b64_tr_b16 v[228:229], v5 offset:33568
    v_mfma_f32_16x16x32_bf16 v[52:55], v[236:239], v[92:95], v[52:55]
    ds_read_b64_tr_b16 v[230:231], v5 offset:34592
    s_waitcnt lgkmcnt(6)
    v_mfma_f32_16x16x32_bf16 v[56:59], v[240:243], v[88:91], v[56:59]
    ds_read_b64_tr_b16 v[232:233], v4 offset:40960
    v_mfma_f32_16x16x32_bf16 v[60:63], v[240:243], v[92:95], v[60:63]
    ds_read_b64_tr_b16 v[234:235], v4 offset:41984
    s_waitcnt lgkmcnt(6)
    v_mfma_f32_16x16x32_bf16 v[64:67], v[244:247], v[88:91], v[64:67]
    ds_read_b64_tr_b16 v[236:237], v5 offset:40992
    v_mfma_f32_16x16x32_bf16 v[68:71], v[244:247], v[92:95], v[68:71]
    ds_read_b64_tr_b16 v[238:239], v5 offset:42016
    s_mov_b32 s23, 0xc000
    buffer_load_dwordx4 v[124:127], v7, s[8:11], s23 offen offset:0 sc1
    s_waitcnt lgkmcnt(6)
    v_mfma_f32_16x16x32_bf16 v[72:75], v[224:227], v[88:91], v[72:75]
    ds_read_b64_tr_b16 v[240:241], v4 offset:41216
    v_lshrrev_b32 v21, 4, v1
    v_lshlrev_b32 v21, 9, v21
    v_and_b32 v20, 15, v1
    v_lshl_add_u32 v21, v20, 4, v21
    s_lshr_b32 s18, s12, 3
    s_lshl_b32 s18, s18, 11
    s_add_u32 s18, s18, 0x528100
    buffer_load_dwordx4 v[12:15], v21, s[8:11], s18 offen sc1
    v_mfma_f32_16x16x32_bf16 v[76:79], v[224:227], v[92:95], v[76:79]
    ds_read_b64_tr_b16 v[242:243], v4 offset:42240
    s_waitcnt lgkmcnt(6)
    v_mfma_f32_16x16x32_bf16 v[80:83], v[228:231], v[88:91], v[80:83]
    ds_read_b64_tr_b16 v[244:245], v5 offset:41248
    v_mfma_f32_16x16x32_bf16 v[84:87], v[228:231], v[92:95], v[84:87]
    ds_read_b64_tr_b16 v[246:247], v5 offset:42272
    s_waitcnt vmcnt(12) lgkmcnt(6)
    v_mfma_f32_16x16x32_bf16 v[24:27], v[232:235], v[96:99], v[24:27]
    ds_read_b64_tr_b16 v[224:225], v4 offset:41472
    s_waitcnt vmcnt(10)
    v_mfma_f32_16x16x32_bf16 v[28:31], v[232:235], v[100:103], v[28:31]
    ds_read_b64_tr_b16 v[226:227], v4 offset:42496
    s_waitcnt lgkmcnt(6)
    v_mfma_f32_16x16x32_bf16 v[32:35], v[236:239], v[96:99], v[32:35]
    ds_read_b64_tr_b16 v[228:229], v5 offset:41504
    v_mfma_f32_16x16x32_bf16 v[36:39], v[236:239], v[100:103], v[36:39]
    ds_read_b64_tr_b16 v[230:231], v5 offset:42528
    s_mov_b32 s23, 0x4000
    buffer_load_dwordx4 v[128:131], v7, s[8:11], s23 offen offset:1024 sc1
    s_waitcnt lgkmcnt(6)
    v_mfma_f32_16x16x32_bf16 v[40:43], v[240:243], v[96:99], v[40:43]
    ds_read_b64_tr_b16 v[232:233], v4 offset:41728
    v_mfma_f32_16x16x32_bf16 v[44:47], v[240:243], v[100:103], v[44:47]
    ds_read_b64_tr_b16 v[234:235], v4 offset:42752
    s_waitcnt lgkmcnt(6)
    v_mfma_f32_16x16x32_bf16 v[48:51], v[244:247], v[96:99], v[48:51]
    ds_read_b64_tr_b16 v[236:237], v5 offset:41760
    v_mfma_f32_16x16x32_bf16 v[52:55], v[244:247], v[100:103], v[52:55]
    ds_read_b64_tr_b16 v[238:239], v5 offset:42784
    s_waitcnt lgkmcnt(6)
    v_mfma_f32_16x16x32_bf16 v[56:59], v[224:227], v[96:99], v[56:59]
    v_mfma_f32_16x16x32_bf16 v[60:63], v[224:227], v[100:103], v[60:63]
    s_waitcnt vmcnt(10)
    s_barrier
    ds_read_b64_tr_b16 v[240:241], v4 offset:49152
    ds_read_b64_tr_b16 v[242:243], v4 offset:50176
    s_waitcnt lgkmcnt(6)
    v_mfma_f32_16x16x32_bf16 v[64:67], v[228:231], v[96:99], v[64:67]
    ds_read_b64_tr_b16 v[244:245], v5 offset:49184
    v_mfma_f32_16x16x32_bf16 v[68:71], v[228:231], v[100:103], v[68:71]
    s_add_u32 s22, s19, 0x480000
    s_add_u32 m0, s20, 0x4000
    s_nop 0
    buffer_load_dwordx4 v3, s[4:7], s22 offen lds
    ds_read_b64_tr_b16 v[246:247], v5 offset:50208
    s_mov_b32 s23, 0xc000
    buffer_load_dwordx4 v[132:135], v7, s[8:11], s23 offen offset:1024 sc1
    s_waitcnt lgkmcnt(6)
    v_mfma_f32_16x16x32_bf16 v[72:75], v[232:235], v[96:99], v[72:75]
    ds_read_b64_tr_b16 v[224:225], v4 offset:49408
    v_mfma_f32_16x16x32_bf16 v[76:79], v[232:235], v[100:103], v[76:79]
    ds_read_b64_tr_b16 v[226:227], v4 offset:50432
    s_waitcnt lgkmcnt(6)
    v_mfma_f32_16x16x32_bf16 v[80:83], v[236:239], v[96:99], v[80:83]
    ds_read_b64_tr_b16 v[228:229], v5 offset:49440
    v_mfma_f32_16x16x32_bf16 v[84:87], v[236:239], v[100:103], v[84:87]
    ds_read_b64_tr_b16 v[230:231], v5 offset:50464
    s_waitcnt vmcnt(11) lgkmcnt(6)
    v_mfma_f32_16x16x32_bf16 v[24:27], v[240:243], v[104:107], v[24:27]
    ds_read_b64_tr_b16 v[232:233], v4 offset:49664
    s_waitcnt vmcnt(10)
    v_mfma_f32_16x16x32_bf16 v[28:31], v[240:243], v[108:111], v[28:31]
    ds_read_b64_tr_b16 v[234:235], v4 offset:50688
    s_waitcnt lgkmcnt(6)
    v_mfma_f32_16x16x32_bf16 v[32:35], v[244:247], v[104:107], v[32:35]
    ds_read_b64_tr_b16 v[236:237], v5 offset:49696
    v_mfma_f32_16x16x32_bf16 v[36:39], v[244:247], v[108:111], v[36:39]
    s_add_u32 s22, s19, 0x488000
    s_add_u32 m0, s20, 0x4400
    s_nop 0
    buffer_load_dwordx4 v3, s[4:7], s22 offen lds
    ds_read_b64_tr_b16 v[238:239], v5 offset:50720
    s_mov_b32 s23, 0x4800
    buffer_load_dwordx4 v[88:91], v7, s[8:11], s23 offen offset:0 sc1
    s_waitcnt lgkmcnt(6)
    v_mfma_f32_16x16x32_bf16 v[40:43], v[224:227], v[104:107], v[40:43]
    ds_read_b64_tr_b16 v[240:241], v4 offset:49920
    v_mfma_f32_16x16x32_bf16 v[44:47], v[224:227], v[108:111], v[44:47]
    ds_read_b64_tr_b16 v[242:243], v4 offset:50944
    s_waitcnt lgkmcnt(6)
    v_mfma_f32_16x16x32_bf16 v[48:51], v[228:231], v[104:107], v[48:51]
    ds_read_b64_tr_b16 v[244:245], v5 offset:49952
    v_mfma_f32_16x16x32_bf16 v[52:55], v[228:231], v[108:111], v[52:55]
    ds_read_b64_tr_b16 v[246:247], v5 offset:50976
    s_waitcnt lgkmcnt(6)
    v_mfma_f32_16x16x32_bf16 v[56:59], v[232:235], v[104:107], v[56:59]
    ds_read_b64_tr_b16 v[224:225], v4 offset:57344
    v_mfma_f32_16x16x32_bf16 v[60:63], v[232:235], v[108:111], v[60:63]
    ds_read_b64_tr_b16 v[226:227], v4 offset:58368
    s_waitcnt lgkmcnt(6)
    v_mfma_f32_16x16x32_bf16 v[64:67], v[236:239], v[104:107], v[64:67]
    ds_read_b64_tr_b16 v[228:229], v5 offset:57376
    v_mfma_f32_16x16x32_bf16 v[68:71], v[236:239], v[108:111], v[68:71]
    ds_read_b64_tr_b16 v[230:231], v5 offset:58400
    s_mov_b32 s23, 0xc800
    buffer_load_dwordx4 v[92:95], v7, s[8:11], s23 offen offset:0 sc1
    s_waitcnt lgkmcnt(6)
    v_mfma_f32_16x16x32_bf16 v[72:75], v[240:243], v[104:107], v[72:75]
    ds_read_b64_tr_b16 v[232:233], v4 offset:57600
    v_mfma_f32_16x16x32_bf16 v[76:79], v[240:243], v[108:111], v[76:79]
    ds_read_b64_tr_b16 v[234:235], v4 offset:58624
    s_waitcnt lgkmcnt(6)
    v_mfma_f32_16x16x32_bf16 v[80:83], v[244:247], v[104:107], v[80:83]
    ds_read_b64_tr_b16 v[236:237], v5 offset:57632
    v_mfma_f32_16x16x32_bf16 v[84:87], v[244:247], v[108:111], v[84:87]
    ds_read_b64_tr_b16 v[238:239], v5 offset:58656
    s_waitcnt vmcnt(12) lgkmcnt(6)
    v_mfma_f32_16x16x32_bf16 v[24:27], v[224:227], v[112:115], v[24:27]
    ds_read_b64_tr_b16 v[240:241], v4 offset:57856
    s_waitcnt vmcnt(10)
    v_mfma_f32_16x16x32_bf16 v[28:31], v[224:227], v[116:119], v[28:31]
    ds_read_b64_tr_b16 v[242:243], v4 offset:58880
    s_waitcnt lgkmcnt(6)
    v_mfma_f32_16x16x32_bf16 v[32:35], v[228:231], v[112:115], v[32:35]
    ds_read_b64_tr_b16 v[244:245], v5 offset:57888
    v_mfma_f32_16x16x32_bf16 v[36:39], v[228:231], v[116:119], v[36:39]
    ds_read_b64_tr_b16 v[246:247], v5 offset:58912
    s_mov_b32 s23, 0x4800
    buffer_load_dwordx4 v[96:99], v7, s[8:11], s23 offen offset:1024 sc1
    s_waitcnt lgkmcnt(6)
    v_mfma_f32_16x16x32_bf16 v[40:43], v[232:235], v[112:115], v[40:43]
    ds_read_b64_tr_b16 v[224:225], v4 offset:58112
    v_mfma_f32_16x16x32_bf16 v[44:47], v[232:235], v[116:119], v[44:47]
    ds_read_b64_tr_b16 v[226:227], v4 offset:59136
    s_waitcnt lgkmcnt(6)
    v_mfma_f32_16x16x32_bf16 v[48:51], v[236:239], v[112:115], v[48:51]
    ds_read_b64_tr_b16 v[228:229], v5 offset:58144
    v_mfma_f32_16x16x32_bf16 v[52:55], v[236:239], v[116:119], v[52:55]
    ds_read_b64_tr_b16 v[230:231], v5 offset:59168
    s_waitcnt lgkmcnt(6)
    v_mfma_f32_16x16x32_bf16 v[56:59], v[240:243], v[112:115], v[56:59]
    v_mfma_f32_16x16x32_bf16 v[60:63], v[240:243], v[116:119], v[60:63]
    s_waitcnt vmcnt(10)
    s_barrier
    ds_read_b64_tr_b16 v[232:233], v4 offset:0
    ds_read_b64_tr_b16 v[234:235], v4 offset:1024
    s_waitcnt lgkmcnt(6)
    v_mfma_f32_16x16x32_bf16 v[64:67], v[244:247], v[112:115], v[64:67]
    ds_read_b64_tr_b16 v[236:237], v5 offset:32
    v_mfma_f32_16x16x32_bf16 v[68:71], v[244:247], v[116:119], v[68:71]
    s_add_u32 s22, s19, 0x500000
    s_add_u32 m0, s20, 0x8000
    s_nop 0
    buffer_load_dwordx4 v3, s[4:7], s22 offen lds
    ds_read_b64_tr_b16 v[238:239], v5 offset:1056
    s_mov_b32 s23, 0xc800
    buffer_load_dwordx4 v[100:103], v7, s[8:11], s23 offen offset:1024 sc1
    s_waitcnt lgkmcnt(6)
    v_mfma_f32_16x16x32_bf16 v[72:75], v[224:227], v[112:115], v[72:75]
    ds_read_b64_tr_b16 v[240:241], v4 offset:256
    v_mfma_f32_16x16x32_bf16 v[76:79], v[224:227], v[116:119], v[76:79]
    ds_read_b64_tr_b16 v[242:243], v4 offset:1280
    s_waitcnt lgkmcnt(6)
    v_mfma_f32_16x16x32_bf16 v[80:83], v[228:231], v[112:115], v[80:83]
    ds_read_b64_tr_b16 v[244:245], v5 offset:288
    v_mfma_f32_16x16x32_bf16 v[84:87], v[228:231], v[116:119], v[84:87]
    ds_read_b64_tr_b16 v[246:247], v5 offset:1312
    s_waitcnt vmcnt(11) lgkmcnt(6)
    v_mfma_f32_16x16x32_bf16 v[24:27], v[232:235], v[120:123], v[24:27]
    ds_read_b64_tr_b16 v[224:225], v4 offset:512
    s_waitcnt vmcnt(10)
    v_mfma_f32_16x16x32_bf16 v[28:31], v[232:235], v[124:127], v[28:31]
    ds_read_b64_tr_b16 v[226:227], v4 offset:1536
    s_waitcnt lgkmcnt(6)
    v_mfma_f32_16x16x32_bf16 v[32:35], v[236:239], v[120:123], v[32:35]
    ds_read_b64_tr_b16 v[228:229], v5 offset:544
    v_mfma_f32_16x16x32_bf16 v[36:39], v[236:239], v[124:127], v[36:39]
    s_add_u32 s22, s19, 0x508000
    s_add_u32 m0, s20, 0x8400
    s_nop 0
    buffer_load_dwordx4 v3, s[4:7], s22 offen lds
    ds_read_b64_tr_b16 v[230:231], v5 offset:1568
    s_mov_b32 s23, 0x5000
    buffer_load_dwordx4 v[104:107], v7, s[8:11], s23 offen offset:0 sc1
    s_waitcnt lgkmcnt(6)
    v_mfma_f32_16x16x32_bf16 v[40:43], v[240:243], v[120:123], v[40:43]
    ds_read_b64_tr_b16 v[232:233], v4 offset:768
    v_mfma_f32_16x16x32_bf16 v[44:47], v[240:243], v[124:127], v[44:47]
    ds_read_b64_tr_b16 v[234:235], v4 offset:1792
    s_waitcnt lgkmcnt(6)
    v_mfma_f32_16x16x32_bf16 v[48:51], v[244:247], v[120:123], v[48:51]
    ds_read_b64_tr_b16 v[236:237], v5 offset:800
    v_mfma_f32_16x16x32_bf16 v[52:55], v[244:247], v[124:127], v[52:55]
    ds_read_b64_tr_b16 v[238:239], v5 offset:1824
    s_waitcnt lgkmcnt(6)
    v_mfma_f32_16x16x32_bf16 v[56:59], v[224:227], v[120:123], v[56:59]
    ds_read_b64_tr_b16 v[240:241], v4 offset:8192
    v_mfma_f32_16x16x32_bf16 v[60:63], v[224:227], v[124:127], v[60:63]
    ds_read_b64_tr_b16 v[242:243], v4 offset:9216
    s_waitcnt lgkmcnt(6)
    v_mfma_f32_16x16x32_bf16 v[64:67], v[228:231], v[120:123], v[64:67]
    ds_read_b64_tr_b16 v[244:245], v5 offset:8224
    v_mfma_f32_16x16x32_bf16 v[68:71], v[228:231], v[124:127], v[68:71]
    ds_read_b64_tr_b16 v[246:247], v5 offset:9248
    s_mov_b32 s23, 0xd000
    buffer_load_dwordx4 v[108:111], v7, s[8:11], s23 offen offset:0 sc1
    s_waitcnt lgkmcnt(6)
    v_mfma_f32_16x16x32_bf16 v[72:75], v[232:235], v[120:123], v[72:75]
    ds_read_b64_tr_b16 v[224:225], v4 offset:8448
    v_mfma_f32_16x16x32_bf16 v[76:79], v[232:235], v[124:127], v[76:79]
    ds_read_b64_tr_b16 v[226:227], v4 offset:9472
    s_waitcnt lgkmcnt(6)
    v_mfma_f32_16x16x32_bf16 v[80:83], v[236:239], v[120:123], v[80:83]
    ds_read_b64_tr_b16 v[228:229], v5 offset:8480
    v_mfma_f32_16x16x32_bf16 v[84:87], v[236:239], v[124:127], v[84:87]
    ds_read_b64_tr_b16 v[230:231], v5 offset:9504
    s_waitcnt vmcnt(11) lgkmcnt(6)
    v_mfma_f32_16x16x32_bf16 v[24:27], v[240:243], v[128:131], v[24:27]
    ds_read_b64_tr_b16 v[232:233], v4 offset:8704
    s_waitcnt vmcnt(9)
    v_mfma_f32_16x16x32_bf16 v[28:31], v[240:243], v[132:135], v[28:31]
    ds_read_b64_tr_b16 v[234:235], v4 offset:9728
    s_waitcnt lgkmcnt(6)
    v_mfma_f32_16x16x32_bf16 v[32:35], v[244:247], v[128:131], v[32:35]
    ds_read_b64_tr_b16 v[236:237], v5 offset:8736
    v_mfma_f32_16x16x32_bf16 v[36:39], v[244:247], v[132:135], v[36:39]
    ds_read_b64_tr_b16 v[238:239], v5 offset:9760
    s_mov_b32 s23, 0x5000
    buffer_load_dwordx4 v[112:115], v7, s[8:11], s23 offen offset:1024 sc1
    s_waitcnt lgkmcnt(6)
    v_mfma_f32_16x16x32_bf16 v[40:43], v[224:227], v[128:131], v[40:43]
    ds_read_b64_tr_b16 v[240:241], v4 offset:8960
    v_mfma_f32_16x16x32_bf16 v[44:47], v[224:227], v[132:135], v[44:47]
    ds_read_b64_tr_b16 v[242:243], v4 offset:9984
    s_waitcnt lgkmcnt(6)
    v_mfma_f32_16x16x32_bf16 v[48:51], v[228:231], v[128:131], v[48:51]
    ds_read_b64_tr_b16 v[244:245], v5 offset:8992
    v_mfma_f32_16x16x32_bf16 v[52:55], v[228:231], v[132:135], v[52:55]
    ds_read_b64_tr_b16 v[246:247], v5 offset:10016
    s_waitcnt lgkmcnt(6)
    v_mfma_f32_16x16x32_bf16 v[56:59], v[232:235], v[128:131], v[56:59]
    v_mfma_f32_16x16x32_bf16 v[60:63], v[232:235], v[132:135], v[60:63]
    s_waitcnt vmcnt(9)
    s_barrier
    ds_read_b64_tr_b16 v[224:225], v4 offset:16384
    ds_read_b64_tr_b16 v[226:227], v4 offset:17408
    s_waitcnt lgkmcnt(6)
    v_mfma_f32_16x16x32_bf16 v[64:67], v[236:239], v[128:131], v[64:67]
    ds_read_b64_tr_b16 v[228:229], v5 offset:16416
    v_mfma_f32_16x16x32_bf16 v[68:71], v[236:239], v[132:135], v[68:71]
    s_add_u32 s22, s19, 0x580000
    s_add_u32 m0, s20, 0xc000
    s_nop 0
    buffer_load_dwordx4 v3, s[4:7], s22 offen lds
    ds_read_b64_tr_b16 v[230:231], v5 offset:17440
    s_mov_b32 s23, 0xd000
    buffer_load_dwordx4 v[116:119], v7, s[8:11], s23 offen offset:1024 sc1
    s_waitcnt lgkmcnt(6)
    v_mfma_f32_16x16x32_bf16 v[72:75], v[240:243], v[128:131], v[72:75]
    ds_read_b64_tr_b16 v[232:233], v4 offset:16640
    v_mfma_f32_16x16x32_bf16 v[76:79], v[240:243], v[132:135], v[76:79]
    ds_read_b64_tr_b16 v[234:235], v4 offset:17664
    s_waitcnt lgkmcnt(6)
    v_mfma_f32_16x16x32_bf16 v[80:83], v[244:247], v[128:131], v[80:83]
    ds_read_b64_tr_b16 v[236:237], v5 offset:16672
    v_mfma_f32_16x16x32_bf16 v[84:87], v[244:247], v[132:135], v[84:87]
    ds_read_b64_tr_b16 v[238:239], v5 offset:17696
    s_waitcnt vmcnt(10) lgkmcnt(6)
    v_mfma_f32_16x16x32_bf16 v[24:27], v[224:227], v[88:91], v[24:27]
    ds_read_b64_tr_b16 v[240:241], v4 offset:16896
    s_waitcnt vmcnt(9)
    v_mfma_f32_16x16x32_bf16 v[28:31], v[224:227], v[92:95], v[28:31]
    ds_read_b64_tr_b16 v[242:243], v4 offset:17920
    s_waitcnt lgkmcnt(6)
    v_mfma_f32_16x16x32_bf16 v[32:35], v[228:231], v[88:91], v[32:35]
    ds_read_b64_tr_b16 v[244:245], v5 offset:16928
    v_mfma_f32_16x16x32_bf16 v[36:39], v[228:231], v[92:95], v[36:39]
    s_add_u32 s22, s19, 0x588000
    s_add_u32 m0, s20, 0xc400
    s_nop 0
    buffer_load_dwordx4 v3, s[4:7], s22 offen lds
    ds_read_b64_tr_b16 v[246:247], v5 offset:17952
    s_mov_b32 s23, 0x5800
    buffer_load_dwordx4 v[120:123], v7, s[8:11], s23 offen offset:0 sc1
    s_waitcnt lgkmcnt(6)
    v_mfma_f32_16x16x32_bf16 v[40:43], v[232:235], v[88:91], v[40:43]
    ds_read_b64_tr_b16 v[224:225], v4 offset:17152
    v_mfma_f32_16x16x32_bf16 v[44:47], v[232:235], v[92:95], v[44:47]
    ds_read_b64_tr_b16 v[226:227], v4 offset:18176
    s_waitcnt lgkmcnt(6)
    v_mfma_f32_16x16x32_bf16 v[48:51], v[236:239], v[88:91], v[48:51]
    ds_read_b64_tr_b16 v[228:229], v5 offset:17184
    v_mfma_f32_16x16x32_bf16 v[52:55], v[236:239], v[92:95], v[52:55]
    ds_read_b64_tr_b16 v[230:231], v5 offset:18208
    s_waitcnt lgkmcnt(6)
    v_mfma_f32_16x16x32_bf16 v[56:59], v[240:243], v[88:91], v[56:59]
    ds_read_b64_tr_b16 v[232:233], v4 offset:24576
    v_mfma_f32_16x16x32_bf16 v[60:63], v[240:243], v[92:95], v[60:63]
    ds_read_b64_tr_b16 v[234:235], v4 offset:25600
    s_waitcnt lgkmcnt(6)
    v_mfma_f32_16x16x32_bf16 v[64:67], v[244:247], v[88:91], v[64:67]
    ds_read_b64_tr_b16 v[236:237], v5 offset:24608
    v_mfma_f32_16x16x32_bf16 v[68:71], v[244:247], v[92:95], v[68:71]
    ds_read_b64_tr_b16 v[238:239], v5 offset:25632
    s_mov_b32 s23, 0xd800
    buffer_load_dwordx4 v[124:127], v7, s[8:11], s23 offen offset:0 sc1
    s_waitcnt lgkmcnt(6)
    v_mfma_f32_16x16x32_bf16 v[72:75], v[224:227], v[88:91], v[72:75]
    ds_read_b64_tr_b16 v[240:241], v4 offset:24832
    v_xor_b32 v8, s28, v12
    v_xor_b32 v20, s28, v13
    v_or_b32 v8, v8, v20
    v_xor_b32 v20, s28, v14
    v_or_b32 v8, v8, v20
    v_xor_b32 v20, s28, v15
    v_or_b32 v8, v8, v20
    v_cmp_ne_u32 vcc, 0, v8
    s_cbranch_vccnz adaLN_cond__sliding_block_cached__moe_arch_mod__prompt_kernel_kv16r
adaLN_cond__sliding_block_cached__moe_arch_mod__prompt_kernel_kv16b:
    v_mfma_f32_16x16x32_bf16 v[76:79], v[224:227], v[92:95], v[76:79]
    ds_read_b64_tr_b16 v[242:243], v4 offset:25856
    v_mov_b32 v20, 0
    s_mov_b32 s16, 0x564000
    buffer_load_dword v8, v20, s[8:11], s16 offen sc1
    s_waitcnt lgkmcnt(6)
    v_mfma_f32_16x16x32_bf16 v[80:83], v[228:231], v[88:91], v[80:83]
    ds_read_b64_tr_b16 v[244:245], v5 offset:24864
    v_mfma_f32_16x16x32_bf16 v[84:87], v[228:231], v[92:95], v[84:87]
    ds_read_b64_tr_b16 v[246:247], v5 offset:25888
    s_waitcnt vmcnt(12) lgkmcnt(6)
    v_mfma_f32_16x16x32_bf16 v[24:27], v[232:235], v[96:99], v[24:27]
    ds_read_b64_tr_b16 v[224:225], v4 offset:25088
    s_waitcnt vmcnt(10)
    v_mfma_f32_16x16x32_bf16 v[28:31], v[232:235], v[100:103], v[28:31]
    ds_read_b64_tr_b16 v[226:227], v4 offset:26112
    s_waitcnt lgkmcnt(6)
    v_mfma_f32_16x16x32_bf16 v[32:35], v[236:239], v[96:99], v[32:35]
    ds_read_b64_tr_b16 v[228:229], v5 offset:25120
    v_mfma_f32_16x16x32_bf16 v[36:39], v[236:239], v[100:103], v[36:39]
    ds_read_b64_tr_b16 v[230:231], v5 offset:26144
    s_mov_b32 s23, 0x5800
    buffer_load_dwordx4 v[128:131], v7, s[8:11], s23 offen offset:1024 sc1
    s_waitcnt lgkmcnt(6)
    v_mfma_f32_16x16x32_bf16 v[40:43], v[240:243], v[96:99], v[40:43]
    ds_read_b64_tr_b16 v[232:233], v4 offset:25344
    s_mov_b64 s[76:77], s[54:55]
    s_mov_b32 s78, 0xc00000
    s_mov_b32 s79, 0x20000
    v_bfe_u32 v20, v1, 2, 2
    v_lshlrev_b32 v20, 12, v20
    v_add_u32 v6, v3, v20
    s_lshr_b32 s16, s2, 5
    s_lshl_b32 s16, s16, 7
    s_lshl_b32 s17, s3, 3
    s_add_u32 s16, s16, s17
    s_mul_i32 s14, s16, 12288
    s_and_b32 s16, s2, 31
    s_lshl_b32 s16, s16, 8
    s_add_u32 s14, s14, s16
    s_add_u32 s14, s14, 4096
    v_mfma_f32_16x16x32_bf16 v[44:47], v[240:243], v[100:103], v[44:47]
    ds_read_b64_tr_b16 v[234:235], v4 offset:26368
    s_waitcnt lgkmcnt(6)
    v_mfma_f32_16x16x32_bf16 v[48:51], v[244:247], v[96:99], v[48:51]
    ds_read_b64_tr_b16 v[236:237], v5 offset:25376
    v_mfma_f32_16x16x32_bf16 v[52:55], v[244:247], v[100:103], v[52:55]
    ds_read_b64_tr_b16 v[238:239], v5 offset:26400
    s_waitcnt lgkmcnt(6)
    v_mfma_f32_16x16x32_bf16 v[56:59], v[224:227], v[96:99], v[56:59]
    v_mfma_f32_16x16x32_bf16 v[60:63], v[224:227], v[100:103], v[60:63]
    s_waitcnt vmcnt(10)
    s_barrier
    ds_read_b64_tr_b16 v[240:241], v4 offset:32768
    ds_read_b64_tr_b16 v[242:243], v4 offset:33792
    s_waitcnt lgkmcnt(6)
    v_mfma_f32_16x16x32_bf16 v[64:67], v[228:231], v[96:99], v[64:67]
    ds_read_b64_tr_b16 v[244:245], v5 offset:32800
    v_mfma_f32_16x16x32_bf16 v[68:71], v[228:231], v[100:103], v[68:71]
    s_add_u32 s22, s19, 0x600000
    s_add_u32 m0, s20, 0x0
    s_nop 0
    buffer_load_dwordx4 v3, s[4:7], s22 offen lds
    ds_read_b64_tr_b16 v[246:247], v5 offset:33824
    s_mov_b32 s23, 0xd800
    buffer_load_dwordx4 v[132:135], v7, s[8:11], s23 offen offset:1024 sc1
    s_waitcnt lgkmcnt(6)
    v_mfma_f32_16x16x32_bf16 v[72:75], v[232:235], v[96:99], v[72:75]
    ds_read_b64_tr_b16 v[224:225], v4 offset:33024
    v_mfma_f32_16x16x32_bf16 v[76:79], v[232:235], v[100:103], v[76:79]
    ds_read_b64_tr_b16 v[226:227], v4 offset:34048
    s_waitcnt lgkmcnt(6)
    v_mfma_f32_16x16x32_bf16 v[80:83], v[236:239], v[96:99], v[80:83]
    ds_read_b64_tr_b16 v[228:229], v5 offset:33056
    v_mfma_f32_16x16x32_bf16 v[84:87], v[236:239], v[100:103], v[84:87]
    ds_read_b64_tr_b16 v[230:231], v5 offset:34080
    s_waitcnt vmcnt(11) lgkmcnt(6)
    v_mfma_f32_16x16x32_bf16 v[24:27], v[240:243], v[104:107], v[24:27]
    ds_read_b64_tr_b16 v[232:233], v4 offset:33280
    s_waitcnt vmcnt(10)
    v_mfma_f32_16x16x32_bf16 v[28:31], v[240:243], v[108:111], v[28:31]
    ds_read_b64_tr_b16 v[234:235], v4 offset:34304
    s_waitcnt lgkmcnt(6)
    v_mfma_f32_16x16x32_bf16 v[32:35], v[244:247], v[104:107], v[32:35]
    ds_read_b64_tr_b16 v[236:237], v5 offset:33312
    v_mfma_f32_16x16x32_bf16 v[36:39], v[244:247], v[108:111], v[36:39]
    s_add_u32 s22, s19, 0x608000
    s_add_u32 m0, s20, 0x400
    s_nop 0
    buffer_load_dwordx4 v3, s[4:7], s22 offen lds
    ds_read_b64_tr_b16 v[238:239], v5 offset:34336
    s_mov_b32 s23, 0x6000
    buffer_load_dwordx4 v[88:91], v7, s[8:11], s23 offen offset:0 sc1
    s_waitcnt lgkmcnt(6)
    v_mfma_f32_16x16x32_bf16 v[40:43], v[224:227], v[104:107], v[40:43]
    ds_read_b64_tr_b16 v[240:241], v4 offset:33536
    v_mfma_f32_16x16x32_bf16 v[44:47], v[224:227], v[108:111], v[44:47]
    ds_read_b64_tr_b16 v[242:243], v4 offset:34560
    s_waitcnt lgkmcnt(6)
    v_mfma_f32_16x16x32_bf16 v[48:51], v[228:231], v[104:107], v[48:51]
    ds_read_b64_tr_b16 v[244:245], v5 offset:33568
    v_mfma_f32_16x16x32_bf16 v[52:55], v[228:231], v[108:111], v[52:55]
    ds_read_b64_tr_b16 v[246:247], v5 offset:34592
    s_waitcnt lgkmcnt(6)
    v_mfma_f32_16x16x32_bf16 v[56:59], v[232:235], v[104:107], v[56:59]
    ds_read_b64_tr_b16 v[224:225], v4 offset:40960
    v_mfma_f32_16x16x32_bf16 v[60:63], v[232:235], v[108:111], v[60:63]
    ds_read_b64_tr_b16 v[226:227], v4 offset:41984
    s_waitcnt lgkmcnt(6)
    v_mfma_f32_16x16x32_bf16 v[64:67], v[236:239], v[104:107], v[64:67]
    ds_read_b64_tr_b16 v[228:229], v5 offset:40992
    v_mfma_f32_16x16x32_bf16 v[68:71], v[236:239], v[108:111], v[68:71]
    ds_read_b64_tr_b16 v[230:231], v5 offset:42016
    s_mov_b32 s23, 0xe000
    buffer_load_dwordx4 v[92:95], v7, s[8:11], s23 offen offset:0 sc1
    s_waitcnt lgkmcnt(6)
    v_mfma_f32_16x16x32_bf16 v[72:75], v[240:243], v[104:107], v[72:75]
    ds_read_b64_tr_b16 v[232:233], v4 offset:41216
    v_mfma_f32_16x16x32_bf16 v[76:79], v[240:243], v[108:111], v[76:79]
    ds_read_b64_tr_b16 v[234:235], v4 offset:42240
    s_waitcnt lgkmcnt(6)
    v_mfma_f32_16x16x32_bf16 v[80:83], v[244:247], v[104:107], v[80:83]
    ds_read_b64_tr_b16 v[236:237], v5 offset:41248
    v_mfma_f32_16x16x32_bf16 v[84:87], v[244:247], v[108:111], v[84:87]
    ds_read_b64_tr_b16 v[238:239], v5 offset:42272
    s_waitcnt vmcnt(12) lgkmcnt(6)
    v_mfma_f32_16x16x32_bf16 v[24:27], v[224:227], v[112:115], v[24:27]
    ds_read_b64_tr_b16 v[240:241], v4 offset:41472
    s_add_u32 s22, s14, 0x0
    s_add_u32 m0, s20, 0x10000
    s_nop 0
    buffer_load_dwordx4 v6, s[76:79], s22 offen lds
    s_waitcnt vmcnt(11)
    v_mfma_f32_16x16x32_bf16 v[28:31], v[224:227], v[116:119], v[28:31]
    ds_read_b64_tr_b16 v[242:243], v4 offset:42496
    s_waitcnt lgkmcnt(6)
    v_mfma_f32_16x16x32_bf16 v[32:35], v[228:231], v[112:115], v[32:35]
    ds_read_b64_tr_b16 v[244:245], v5 offset:41504
    v_mfma_f32_16x16x32_bf16 v[36:39], v[228:231], v[116:119], v[36:39]
    ds_read_b64_tr_b16 v[246:247], v5 offset:42528
    s_mov_b32 s23, 0x6000
    buffer_load_dwordx4 v[96:99], v7, s[8:11], s23 offen offset:1024 sc1
    s_waitcnt lgkmcnt(6)
    v_mfma_f32_16x16x32_bf16 v[40:43], v[232:235], v[112:115], v[40:43]
    ds_read_b64_tr_b16 v[224:225], v4 offset:41728
    s_add_u32 s22, s14, 0xc000
    s_add_u32 m0, s20, 0x10400
    s_nop 0
    buffer_load_dwordx4 v6, s[76:79], s22 offen lds
    v_mfma_f32_16x16x32_bf16 v[44:47], v[232:235], v[116:119], v[44:47]
    ds_read_b64_tr_b16 v[226:227], v4 offset:42752
    s_waitcnt lgkmcnt(6)
    v_mfma_f32_16x16x32_bf16 v[48:51], v[236:239], v[112:115], v[48:51]
    ds_read_b64_tr_b16 v[228:229], v5 offset:41760
    v_mfma_f32_16x16x32_bf16 v[52:55], v[236:239], v[116:119], v[52:55]
    ds_read_b64_tr_b16 v[230:231], v5 offset:42784
    s_waitcnt lgkmcnt(6)
    v_mfma_f32_16x16x32_bf16 v[56:59], v[240:243], v[112:115], v[56:59]
    v_mfma_f32_16x16x32_bf16 v[60:63], v[240:243], v[116:119], v[60:63]
    s_waitcnt vmcnt(12)
    s_barrier
    ds_read_b64_tr_b16 v[232:233], v4 offset:49152
    ds_read_b64_tr_b16 v[234:235], v4 offset:50176
    s_waitcnt lgkmcnt(6)
    v_mfma_f32_16x16x32_bf16 v[64:67], v[244:247], v[112:115], v[64:67]
    ds_read_b64_tr_b16 v[236:237], v5 offset:49184
    v_mfma_f32_16x16x32_bf16 v[68:71], v[244:247], v[116:119], v[68:71]
    s_add_u32 s22, s19, 0x680000
    s_add_u32 m0, s20, 0x4000
    s_nop 0
    buffer_load_dwordx4 v3, s[4:7], s22 offen lds
    ds_read_b64_tr_b16 v[238:239], v5 offset:50208
    s_mov_b32 s23, 0xe000
    buffer_load_dwordx4 v[100:103], v7, s[8:11], s23 offen offset:1024 sc1
    s_waitcnt lgkmcnt(6)
    v_mfma_f32_16x16x32_bf16 v[72:75], v[224:227], v[112:115], v[72:75]
    ds_read_b64_tr_b16 v[240:241], v4 offset:49408
    v_mfma_f32_16x16x32_bf16 v[76:79], v[224:227], v[116:119], v[76:79]
    ds_read_b64_tr_b16 v[242:243], v4 offset:50432
    s_waitcnt lgkmcnt(6)
    v_mfma_f32_16x16x32_bf16 v[80:83], v[228:231], v[112:115], v[80:83]
    ds_read_b64_tr_b16 v[244:245], v5 offset:49440
    v_mfma_f32_16x16x32_bf16 v[84:87], v[228:231], v[116:119], v[84:87]
    ds_read_b64_tr_b16 v[246:247], v5 offset:50464
    s_waitcnt vmcnt(13) lgkmcnt(6)
    v_mfma_f32_16x16x32_bf16 v[24:27], v[232:235], v[120:123], v[24:27]
    ds_read_b64_tr_b16 v[224:225], v4 offset:49664
    s_waitcnt vmcnt(12)
    v_mfma_f32_16x16x32_bf16 v[28:31], v[232:235], v[124:127], v[28:31]
    ds_read_b64_tr_b16 v[226:227], v4 offset:50688
    s_waitcnt lgkmcnt(6)
    v_mfma_f32_16x16x32_bf16 v[32:35], v[236:239], v[120:123], v[32:35]
    ds_read_b64_tr_b16 v[228:229], v5 offset:49696
    v_mfma_f32_16x16x32_bf16 v[36:39], v[236:239], v[124:127], v[36:39]
    s_add_u32 s22, s19, 0x688000
    s_add_u32 m0, s20, 0x4400
    s_nop 0
    buffer_load_dwordx4 v3, s[4:7], s22 offen lds
    ds_read_b64_tr_b16 v[230:231], v5 offset:50720
    s_mov_b32 s23, 0x6800
    buffer_load_dwordx4 v[104:107], v7, s[8:11], s23 offen offset:0 sc1
    s_waitcnt lgkmcnt(6)
    v_mfma_f32_16x16x32_bf16 v[40:43], v[240:243], v[120:123], v[40:43]
    ds_read_b64_tr_b16 v[232:233], v4 offset:49920
    v_mfma_f32_16x16x32_bf16 v[44:47], v[240:243], v[124:127], v[44:47]
    ds_read_b64_tr_b16 v[234:235], v4 offset:50944
    s_waitcnt lgkmcnt(6)
    v_mfma_f32_16x16x32_bf16 v[48:51], v[244:247], v[120:123], v[48:51]
    ds_read_b64_tr_b16 v[236:237], v5 offset:49952
    v_mfma_f32_16x16x32_bf16 v[52:55], v[244:247], v[124:127], v[52:55]
    ds_read_b64_tr_b16 v[238:239], v5 offset:50976
    s_waitcnt lgkmcnt(6)
    v_mfma_f32_16x16x32_bf16 v[56:59], v[224:227], v[120:123], v[56:59]
    ds_read_b64_tr_b16 v[240:241], v4 offset:57344
    v_mfma_f32_16x16x32_bf16 v[60:63], v[224:227], v[124:127], v[60:63]
    ds_read_b64_tr_b16 v[242:243], v4 offset:58368
    s_waitcnt lgkmcnt(6)
    v_mfma_f32_16x16x32_bf16 v[64:67], v[228:231], v[120:123], v[64:67]
    ds_read_b64_tr_b16 v[244:245], v5 offset:57376
    v_mfma_f32_16x16x32_bf16 v[68:71], v[228:231], v[124:127], v[68:71]
    ds_read_b64_tr_b16 v[246:247], v5 offset:58400
    s_mov_b32 s23, 0xe800
    buffer_load_dwordx4 v[108:111], v7, s[8:11], s23 offen offset:0 sc1
    s_waitcnt lgkmcnt(6)
    v_mfma_f32_16x16x32_bf16 v[72:75], v[232:235], v[120:123], v[72:75]
    ds_read_b64_tr_b16 v[224:225], v4 offset:57600
    v_mfma_f32_16x16x32_bf16 v[76:79], v[232:235], v[124:127], v[76:79]
    ds_read_b64_tr_b16 v[226:227], v4 offset:58624
    s_waitcnt lgkmcnt(6)
    v_mfma_f32_16x16x32_bf16 v[80:83], v[236:239], v[120:123], v[80:83]
    ds_read_b64_tr_b16 v[228:229], v5 offset:57632
    v_mfma_f32_16x16x32_bf16 v[84:87], v[236:239], v[124:127], v[84:87]
    ds_read_b64_tr_b16 v[230:231], v5 offset:58656
    s_waitcnt vmcnt(13) lgkmcnt(6)
    v_mfma_f32_16x16x32_bf16 v[24:27], v[240:243], v[128:131], v[24:27]
    ds_read_b64_tr_b16 v[232:233], v4 offset:57856
    s_add_u32 s22, s14, 0xc0000
    s_add_u32 m0, s20, 0x14000
    s_nop 0
    buffer_load_dwordx4 v6, s[76:79], s22 offen lds
    s_waitcnt vmcnt(12)
    v_mfma_f32_16x16x32_bf16 v[28:31], v[240:243], v[132:135], v[28:31]
    ds_read_b64_tr_b16 v[234:235], v4 offset:58880
    s_waitcnt lgkmcnt(6)
    v_mfma_f32_16x16x32_bf16 v[32:35], v[244:247], v[128:131], v[32:35]
    ds_read_b64_tr_b16 v[236:237], v5 offset:57888
    v_mfma_f32_16x16x32_bf16 v[36:39], v[244:247], v[132:135], v[36:39]
    ds_read_b64_tr_b16 v[238:239], v5 offset:58912
    s_mov_b32 s23, 0x6800
    buffer_load_dwordx4 v[112:115], v7, s[8:11], s23 offen offset:1024 sc1
    s_waitcnt lgkmcnt(6)
    v_mfma_f32_16x16x32_bf16 v[40:43], v[224:227], v[128:131], v[40:43]
    ds_read_b64_tr_b16 v[240:241], v4 offset:58112
    s_add_u32 s22, s14, 0xcc000
    s_add_u32 m0, s20, 0x14400
    s_nop 0
    buffer_load_dwordx4 v6, s[76:79], s22 offen lds
    v_mfma_f32_16x16x32_bf16 v[44:47], v[224:227], v[132:135], v[44:47]
    ds_read_b64_tr_b16 v[242:243], v4 offset:59136
    s_waitcnt lgkmcnt(6)
    v_mfma_f32_16x16x32_bf16 v[48:51], v[228:231], v[128:131], v[48:51]
    ds_read_b64_tr_b16 v[244:245], v5 offset:58144
    v_mfma_f32_16x16x32_bf16 v[52:55], v[228:231], v[132:135], v[52:55]
    ds_read_b64_tr_b16 v[246:247], v5 offset:59168
    s_waitcnt lgkmcnt(6)
    v_mfma_f32_16x16x32_bf16 v[56:59], v[232:235], v[128:131], v[56:59]
    v_mfma_f32_16x16x32_bf16 v[60:63], v[232:235], v[132:135], v[60:63]
    s_waitcnt vmcnt(13)
    s_barrier
    ds_read_b64_tr_b16 v[224:225], v4 offset:0
    ds_read_b64_tr_b16 v[226:227], v4 offset:1024
    s_waitcnt lgkmcnt(6)
    v_mfma_f32_16x16x32_bf16 v[64:67], v[236:239], v[128:131], v[64:67]
    ds_read_b64_tr_b16 v[228:229], v5 offset:32
    v_mfma_f32_16x16x32_bf16 v[68:71], v[236:239], v[132:135], v[68:71]
    s_add_u32 s22, s19, 0x700000
    s_add_u32 m0, s20, 0x8000
    s_nop 0
    buffer_load_dwordx4 v3, s[4:7], s22 offen lds
    ds_read_b64_tr_b16 v[230:231], v5 offset:1056
    s_mov_b32 s23, 0xe800
    buffer_load_dwordx4 v[116:119], v7, s[8:11], s23 offen offset:1024 sc1
    s_waitcnt lgkmcnt(6)
    v_mfma_f32_16x16x32_bf16 v[72:75], v[240:243], v[128:131], v[72:75]
    ds_read_b64_tr_b16 v[232:233], v4 offset:256
    v_mfma_f32_16x16x32_bf16 v[76:79], v[240:243], v[132:135], v[76:79]
    ds_read_b64_tr_b16 v[234:235], v4 offset:1280
    s_waitcnt lgkmcnt(6)
    v_mfma_f32_16x16x32_bf16 v[80:83], v[244:247], v[128:131], v[80:83]
    ds_read_b64_tr_b16 v[236:237], v5 offset:288
    v_mfma_f32_16x16x32_bf16 v[84:87], v[244:247], v[132:135], v[84:87]
    ds_read_b64_tr_b16 v[238:239], v5 offset:1312
    s_waitcnt vmcnt(14) lgkmcnt(6)
    v_mfma_f32_16x16x32_bf16 v[24:27], v[224:227], v[88:91], v[24:27]
    ds_read_b64_tr_b16 v[240:241], v4 offset:512
    s_waitcnt vmcnt(13)
    v_mfma_f32_16x16x32_bf16 v[28:31], v[224:227], v[92:95], v[28:31]
    ds_read_b64_tr_b16 v[242:243], v4 offset:1536
    s_waitcnt lgkmcnt(6)
    v_mfma_f32_16x16x32_bf16 v[32:35], v[228:231], v[88:91], v[32:35]
    ds_read_b64_tr_b16 v[244:245], v5 offset:544
    v_mfma_f32_16x16x32_bf16 v[36:39], v[228:231], v[92:95], v[36:39]
    s_add_u32 s22, s19, 0x708000
    s_add_u32 m0, s20, 0x8400
    s_nop 0
    buffer_load_dwordx4 v3, s[4:7], s22 offen lds
    ds_read_b64_tr_b16 v[246:247], v5 offset:1568
    s_mov_b32 s23, 0x7000
    buffer_load_dwordx4 v[120:123], v7, s[8:11], s23 offen offset:0 sc1
    s_waitcnt lgkmcnt(6)
    v_mfma_f32_16x16x32_bf16 v[40:43], v[232:235], v[88:91], v[40:43]
    ds_read_b64_tr_b16 v[224:225], v4 offset:768
    v_mfma_f32_16x16x32_bf16 v[44:47], v[232:235], v[92:95], v[44:47]
    ds_read_b64_tr_b16 v[226:227], v4 offset:1792
    s_waitcnt lgkmcnt(6)
    v_mfma_f32_16x16x32_bf16 v[48:51], v[236:239], v[88:91], v[48:51]
    ds_read_b64_tr_b16 v[228:229], v5 offset:800
    v_mfma_f32_16x16x32_bf16 v[52:55], v[236:239], v[92:95], v[52:55]
    ds_read_b64_tr_b16 v[230:231], v5 offset:1824
    s_waitcnt lgkmcnt(6)
    v_mfma_f32_16x16x32_bf16 v[56:59], v[240:243], v[88:91], v[56:59]
    ds_read_b64_tr_b16 v[232:233], v4 offset:8192
    v_mfma_f32_16x16x32_bf16 v[60:63], v[240:243], v[92:95], v[60:63]
    ds_read_b64_tr_b16 v[234:235], v4 offset:9216
    s_waitcnt lgkmcnt(6)
    v_mfma_f32_16x16x32_bf16 v[64:67], v[244:247], v[88:91], v[64:67]
    ds_read_b64_tr_b16 v[236:237], v5 offset:8224
    v_mfma_f32_16x16x32_bf16 v[68:71], v[244:247], v[92:95], v[68:71]
    ds_read_b64_tr_b16 v[238:239], v5 offset:9248
    s_mov_b32 s23, 0xf000
    buffer_load_dwordx4 v[124:127], v7, s[8:11], s23 offen offset:0 sc1
    s_waitcnt lgkmcnt(6)
    v_mfma_f32_16x16x32_bf16 v[72:75], v[224:227], v[88:91], v[72:75]
    ds_read_b64_tr_b16 v[240:241], v4 offset:8448
    v_mfma_f32_16x16x32_bf16 v[76:79], v[224:227], v[92:95], v[76:79]
    ds_read_b64_tr_b16 v[242:243], v4 offset:9472
    s_waitcnt lgkmcnt(6)
    v_mfma_f32_16x16x32_bf16 v[80:83], v[228:231], v[88:91], v[80:83]
    ds_read_b64_tr_b16 v[244:245], v5 offset:8480
    v_mfma_f32_16x16x32_bf16 v[84:87], v[228:231], v[92:95], v[84:87]
    ds_read_b64_tr_b16 v[246:247], v5 offset:9504
    s_waitcnt vmcnt(14) lgkmcnt(6)
    v_mfma_f32_16x16x32_bf16 v[24:27], v[232:235], v[96:99], v[24:27]
    ds_read_b64_tr_b16 v[224:225], v4 offset:8704
    s_add_u32 s22, s21, 0x0
    s_add_u32 m0, s20, 0x18000
    s_nop 0
    buffer_load_dwordx4 v2, s[8:11], s22 offen sc1 lds
    s_waitcnt vmcnt(12)
    v_mfma_f32_16x16x32_bf16 v[28:31], v[232:235], v[100:103], v[28:31]
    ds_read_b64_tr_b16 v[226:227], v4 offset:9728
    s_waitcnt lgkmcnt(6)
    v_mfma_f32_16x16x32_bf16 v[32:35], v[236:239], v[96:99], v[32:35]
    ds_read_b64_tr_b16 v[228:229], v5 offset:8736
    v_mfma_f32_16x16x32_bf16 v[36:39], v[236:239], v[100:103], v[36:39]
    ds_read_b64_tr_b16 v[230:231], v5 offset:9760
    s_mov_b32 s23, 0x7000
    buffer_load_dwordx4 v[128:131], v7, s[8:11], s23 offen offset:1024 sc1
    s_waitcnt lgkmcnt(6)
    v_mfma_f32_16x16x32_bf16 v[40:43], v[240:243], v[96:99], v[40:43]
    ds_read_b64_tr_b16 v[232:233], v4 offset:8960
    s_add_u32 s22, s21, 0x400
    s_add_u32 m0, s20, 0x18400
    s_nop 0
    buffer_load_dwordx4 v2, s[8:11], s22 offen sc1 lds
    v_mfma_f32_16x16x32_bf16 v[44:47], v[240:243], v[100:103], v[44:47]
    ds_read_b64_tr_b16 v[234:235], v4 offset:9984
    s_waitcnt lgkmcnt(6)
    v_mfma_f32_16x16x32_bf16 v[48:51], v[244:247], v[96:99], v[48:51]
    ds_read_b64_tr_b16 v[236:237], v5 offset:8992
    v_mfma_f32_16x16x32_bf16 v[52:55], v[244:247], v[100:103], v[52:55]
    ds_read_b64_tr_b16 v[238:239], v5 offset:10016
    s_waitcnt lgkmcnt(6)
    v_mfma_f32_16x16x32_bf16 v[56:59], v[224:227], v[96:99], v[56:59]
    v_mfma_f32_16x16x32_bf16 v[60:63], v[224:227], v[100:103], v[60:63]
    s_waitcnt vmcnt(13)
    s_barrier
    ds_read_b64_tr_b16 v[240:241], v4 offset:16384
    ds_read_b64_tr_b16 v[242:243], v4 offset:17408
    s_waitcnt lgkmcnt(6)
    v_mfma_f32_16x16x32_bf16 v[64:67], v[228:231], v[96:99], v[64:67]
    ds_read_b64_tr_b16 v[244:245], v5 offset:16416
    v_mfma_f32_16x16x32_bf16 v[68:71], v[228:231], v[100:103], v[68:71]
    s_add_u32 s22, s19, 0x780000
    s_add_u32 m0, s20, 0xc000
    s_nop 0
    buffer_load_dwordx4 v3, s[4:7], s22 offen lds
    ds_read_b64_tr_b16 v[246:247], v5 offset:17440
    s_mov_b32 s23, 0xf000
    buffer_load_dwordx4 v[132:135], v7, s[8:11], s23 offen offset:1024 sc1
    s_waitcnt lgkmcnt(6)
    v_mfma_f32_16x16x32_bf16 v[72:75], v[232:235], v[96:99], v[72:75]
    ds_read_b64_tr_b16 v[224:225], v4 offset:16640
    v_mfma_f32_16x16x32_bf16 v[76:79], v[232:235], v[100:103], v[76:79]
    ds_read_b64_tr_b16 v[226:227], v4 offset:17664
    s_waitcnt lgkmcnt(6)
    v_mfma_f32_16x16x32_bf16 v[80:83], v[236:239], v[96:99], v[80:83]
    ds_read_b64_tr_b16 v[228:229], v5 offset:16672
    v_mfma_f32_16x16x32_bf16 v[84:87], v[236:239], v[100:103], v[84:87]
    ds_read_b64_tr_b16 v[230:231], v5 offset:17696
    s_waitcnt vmcnt(14) lgkmcnt(6)
    v_mfma_f32_16x16x32_bf16 v[24:27], v[240:243], v[104:107], v[24:27]
    ds_read_b64_tr_b16 v[232:233], v4 offset:16896
    s_waitcnt vmcnt(13)
    v_mfma_f32_16x16x32_bf16 v[28:31], v[240:243], v[108:111], v[28:31]
    ds_read_b64_tr_b16 v[234:235], v4 offset:17920
    s_waitcnt lgkmcnt(6)
    v_mfma_f32_16x16x32_bf16 v[32:35], v[244:247], v[104:107], v[32:35]
    ds_read_b64_tr_b16 v[236:237], v5 offset:16928
    v_mfma_f32_16x16x32_bf16 v[36:39], v[244:247], v[108:111], v[36:39]
    s_add_u32 s22, s19, 0x788000
    s_add_u32 m0, s20, 0xc400
    s_nop 0
    buffer_load_dwordx4 v3, s[4:7], s22 offen lds
    ds_read_b64_tr_b16 v[238:239], v5 offset:17952
    s_mov_b32 s23, 0x7800
    buffer_load_dwordx4 v[88:91], v7, s[8:11], s23 offen offset:0 sc1
    s_waitcnt lgkmcnt(6)
    v_mfma_f32_16x16x32_bf16 v[40:43], v[224:227], v[104:107], v[40:43]
    ds_read_b64_tr_b16 v[240:241], v4 offset:17152
    v_lshrrev_b32 v20, 4, v1
    v_lshlrev_b32 v21, 4, v20
    s_lshl_b32 s16, s2, 8
    s_add_u32 s16, s16, 0x550000
    buffer_load_dwordx4 v[136:139], v21, s[8:11], s16 offen offset:0 sc1
    buffer_load_dwordx4 v[140:143], v21, s[8:11], s16 offen offset:64 sc1
    buffer_load_dwordx4 v[144:147], v21, s[8:11], s16 offen offset:128 sc1
    buffer_load_dwordx4 v[148:151], v21, s[8:11], s16 offen offset:192 sc1
    v_lshlrev_b32 v11, 11, v20
    v_xor_b32 v20, s3, v20
    v_and_b32 v20, 1, v20
    v_lshl_add_u32 v11, v20, 5, v11
    v_bfe_u32 v20, v1, 2, 2
    v_lshl_add_u32 v11, v20, 6, v11
    v_and_b32 v20, 3, v1
    v_lshl_add_u32 v11, v20, 3, v11
    s_lshr_b32 s16, s3, 1
    s_lshl_b32 s16, s16, 8
    s_add_u32 s16, s16, 65536
    v_add_u32 v11, s16, v11
    v_mfma_f32_16x16x32_bf16 v[44:47], v[224:227], v[108:111], v[44:47]
    ds_read_b64_tr_b16 v[242:243], v4 offset:18176
    s_waitcnt lgkmcnt(6)
    v_mfma_f32_16x16x32_bf16 v[48:51], v[228:231], v[104:107], v[48:51]
    ds_read_b64_tr_b16 v[244:245], v5 offset:17184
    v_mfma_f32_16x16x32_bf16 v[52:55], v[228:231], v[108:111], v[52:55]
    ds_read_b64_tr_b16 v[246:247], v5 offset:18208
    s_waitcnt lgkmcnt(6)
    v_mfma_f32_16x16x32_bf16 v[56:59], v[232:235], v[104:107], v[56:59]
    ds_read_b64_tr_b16 v[224:225], v4 offset:24576
    v_mfma_f32_16x16x32_bf16 v[60:63], v[232:235], v[108:111], v[60:63]
    ds_read_b64_tr_b16 v[226:227], v4 offset:25600
    s_waitcnt lgkmcnt(6)
    v_mfma_f32_16x16x32_bf16 v[64:67], v[236:239], v[104:107], v[64:67]
    ds_read_b64_tr_b16 v[228:229], v5 offset:24608
    v_mfma_f32_16x16x32_bf16 v[68:71], v[236:239], v[108:111], v[68:71]
    ds_read_b64_tr_b16 v[230:231], v5 offset:25632
    s_mov_b32 s23, 0xf800
    buffer_load_dwordx4 v[92:95], v7, s[8:11], s23 offen offset:0 sc1
    s_waitcnt lgkmcnt(6)
    v_mfma_f32_16x16x32_bf16 v[72:75], v[240:243], v[104:107], v[72:75]
    ds_read_b64_tr_b16 v[232:233], v4 offset:24832
    v_mfma_f32_16x16x32_bf16 v[76:79], v[240:243], v[108:111], v[76:79]
    ds_read_b64_tr_b16 v[234:235], v4 offset:25856
    s_waitcnt lgkmcnt(6)
    v_mfma_f32_16x16x32_bf16 v[80:83], v[244:247], v[104:107], v[80:83]
    ds_read_b64_tr_b16 v[236:237], v5 offset:24864
    v_mfma_f32_16x16x32_bf16 v[84:87], v[244:247], v[108:111], v[84:87]
    ds_read_b64_tr_b16 v[238:239], v5 offset:25888
    s_waitcnt vmcnt(18) lgkmcnt(6)
    v_mfma_f32_16x16x32_bf16 v[24:27], v[224:227], v[112:115], v[24:27]
    ds_read_b64_tr_b16 v[240:241], v4 offset:25088
    s_add_u32 s22, s21, 0x4000
    s_add_u32 m0, s20, 0x1c000
    s_nop 0
    buffer_load_dwordx4 v2, s[8:11], s22 offen sc1 lds
    s_waitcnt vmcnt(16)
    v_mfma_f32_16x16x32_bf16 v[28:31], v[224:227], v[116:119], v[28:31]
    ds_read_b64_tr_b16 v[242:243], v4 offset:26112
    s_waitcnt lgkmcnt(6)
    v_mfma_f32_16x16x32_bf16 v[32:35], v[228:231], v[112:115], v[32:35]
    ds_read_b64_tr_b16 v[244:245], v5 offset:25120
    v_mfma_f32_16x16x32_bf16 v[36:39], v[228:231], v[116:119], v[36:39]
    ds_read_b64_tr_b16 v[246:247], v5 offset:26144
    s_mov_b32 s23, 0x7800
    buffer_load_dwordx4 v[96:99], v7, s[8:11], s23 offen offset:1024 sc1
    s_waitcnt lgkmcnt(6)
    v_mfma_f32_16x16x32_bf16 v[40:43], v[232:235], v[112:115], v[40:43]
    ds_read_b64_tr_b16 v[224:225], v4 offset:25344
    s_add_u32 s22, s21, 0x4400
    s_add_u32 m0, s20, 0x1c400
    s_nop 0
    buffer_load_dwordx4 v2, s[8:11], s22 offen sc1 lds
    v_mfma_f32_16x16x32_bf16 v[44:47], v[232:235], v[116:119], v[44:47]
    ds_read_b64_tr_b16 v[226:227], v4 offset:26368
    s_waitcnt lgkmcnt(6)
    v_mfma_f32_16x16x32_bf16 v[48:51], v[236:239], v[112:115], v[48:51]
    ds_read_b64_tr_b16 v[228:229], v5 offset:25376
    v_mfma_f32_16x16x32_bf16 v[52:55], v[236:239], v[116:119], v[52:55]
    ds_read_b64_tr_b16 v[230:231], v5 offset:26400
    s_waitcnt lgkmcnt(6)
    v_mfma_f32_16x16x32_bf16 v[56:59], v[240:243], v[112:115], v[56:59]
    v_mfma_f32_16x16x32_bf16 v[60:63], v[240:243], v[116:119], v[60:63]
    s_waitcnt vmcnt(17)
    s_barrier
    ds_read_b64_tr_b16 v[232:233], v4 offset:32768
    ds_read_b64_tr_b16 v[234:235], v4 offset:33792
    s_waitcnt lgkmcnt(6)
    v_mfma_f32_16x16x32_bf16 v[64:67], v[244:247], v[112:115], v[64:67]
    ds_read_b64_tr_b16 v[236:237], v5 offset:32800
    v_mfma_f32_16x16x32_bf16 v[68:71], v[244:247], v[116:119], v[68:71]
    ds_read_b64_tr_b16 v[238:239], v5 offset:33824
    s_mov_b32 s23, 0xf800
    buffer_load_dwordx4 v[100:103], v7, s[8:11], s23 offen offset:1024 sc1
    s_waitcnt lgkmcnt(6)
    v_mfma_f32_16x16x32_bf16 v[72:75], v[224:227], v[112:115], v[72:75]
    ds_read_b64_tr_b16 v[240:241], v4 offset:33024
    v_mfma_f32_16x16x32_bf16 v[76:79], v[224:227], v[116:119], v[76:79]
    ds_read_b64_tr_b16 v[242:243], v4 offset:34048
    s_waitcnt lgkmcnt(6)
    v_mfma_f32_16x16x32_bf16 v[80:83], v[228:231], v[112:115], v[80:83]
    ds_read_b64_tr_b16 v[244:245], v5 offset:33056
    v_mfma_f32_16x16x32_bf16 v[84:87], v[228:231], v[116:119], v[84:87]
    ds_read_b64_tr_b16 v[246:247], v5 offset:34080
    s_waitcnt vmcnt(17) lgkmcnt(6)
    v_mfma_f32_16x16x32_bf16 v[24:27], v[232:235], v[120:123], v[24:27]
    ds_read_b64_tr_b16 v[224:225], v4 offset:33280
    s_waitcnt vmcnt(16)
    v_mfma_f32_16x16x32_bf16 v[28:31], v[232:235], v[124:127], v[28:31]
    ds_read_b64_tr_b16 v[226:227], v4 offset:34304
    s_waitcnt lgkmcnt(6)
    v_mfma_f32_16x16x32_bf16 v[32:35], v[236:239], v[120:123], v[32:35]
    ds_read_b64_tr_b16 v[228:229], v5 offset:33312
    v_mfma_f32_16x16x32_bf16 v[36:39], v[236:239], v[124:127], v[36:39]
    ds_read_b64_tr_b16 v[230:231], v5 offset:34336
    s_waitcnt lgkmcnt(6)
    v_mfma_f32_16x16x32_bf16 v[40:43], v[240:243], v[120:123], v[40:43]
    ds_read_b64_tr_b16 v[232:233], v4 offset:33536
    v_mfma_f32_16x16x32_bf16 v[44:47], v[240:243], v[124:127], v[44:47]
    ds_read_b64_tr_b16 v[234:235], v4 offset:34560
    s_waitcnt lgkmcnt(6)
    v_mfma_f32_16x16x32_bf16 v[48:51], v[244:247], v[120:123], v[48:51]
    ds_read_b64_tr_b16 v[236:237], v5 offset:33568
    v_mfma_f32_16x16x32_bf16 v[52:55], v[244:247], v[124:127], v[52:55]
    ds_read_b64_tr_b16 v[238:239], v5 offset:34592
    s_waitcnt lgkmcnt(6)
    v_mfma_f32_16x16x32_bf16 v[56:59], v[224:227], v[120:123], v[56:59]
    ds_read_b64_tr_b16 v[240:241], v4 offset:40960
    v_mfma_f32_16x16x32_bf16 v[60:63], v[224:227], v[124:127], v[60:63]
    ds_read_b64_tr_b16 v[242:243], v4 offset:41984
    s_waitcnt lgkmcnt(6)
    v_mfma_f32_16x16x32_bf16 v[64:67], v[228:231], v[120:123], v[64:67]
    ds_read_b64_tr_b16 v[244:245], v5 offset:40992
    v_mfma_f32_16x16x32_bf16 v[68:71], v[228:231], v[124:127], v[68:71]
    ds_read_b64_tr_b16 v[246:247], v5 offset:42016
    s_waitcnt lgkmcnt(6)
    v_mfma_f32_16x16x32_bf16 v[72:75], v[232:235], v[120:123], v[72:75]
    ds_read_b64_tr_b16 v[224:225], v4 offset:41216
    v_mfma_f32_16x16x32_bf16 v[76:79], v[232:235], v[124:127], v[76:79]
    ds_read_b64_tr_b16 v[226:227], v4 offset:42240
    s_waitcnt lgkmcnt(6)
    v_mfma_f32_16x16x32_bf16 v[80:83], v[236:239], v[120:123], v[80:83]
    ds_read_b64_tr_b16 v[228:229], v5 offset:41248
    v_mfma_f32_16x16x32_bf16 v[84:87], v[236:239], v[124:127], v[84:87]
    ds_read_b64_tr_b16 v[230:231], v5 offset:42272
    s_waitcnt vmcnt(14) lgkmcnt(6)
    v_mfma_f32_16x16x32_bf16 v[24:27], v[240:243], v[128:131], v[24:27]
    ds_read_b64_tr_b16 v[232:233], v4 offset:41472
    s_waitcnt vmcnt(11)
    v_mfma_f32_16x16x32_bf16 v[28:31], v[240:243], v[132:135], v[28:31]
    ds_read_b64_tr_b16 v[234:235], v4 offset:42496
    s_waitcnt lgkmcnt(6)
    v_mfma_f32_16x16x32_bf16 v[32:35], v[244:247], v[128:131], v[32:35]
    ds_read_b64_tr_b16 v[236:237], v5 offset:41504
    v_mfma_f32_16x16x32_bf16 v[36:39], v[244:247], v[132:135], v[36:39]
    ds_read_b64_tr_b16 v[238:239], v5 offset:42528
    s_waitcnt lgkmcnt(6)
    v_mfma_f32_16x16x32_bf16 v[40:43], v[224:227], v[128:131], v[40:43]
    ds_read_b64_tr_b16 v[240:241], v4 offset:41728
    v_mfma_f32_16x16x32_bf16 v[44:47], v[224:227], v[132:135], v[44:47]
    ds_read_b64_tr_b16 v[242:243], v4 offset:42752
    s_waitcnt lgkmcnt(6)
    v_mfma_f32_16x16x32_bf16 v[48:51], v[228:231], v[128:131], v[48:51]
    ds_read_b64_tr_b16 v[244:245], v5 offset:41760
    v_mfma_f32_16x16x32_bf16 v[52:55], v[228:231], v[132:135], v[52:55]
    ds_read_b64_tr_b16 v[246:247], v5 offset:42784
    s_waitcnt lgkmcnt(6)
    v_mfma_f32_16x16x32_bf16 v[56:59], v[232:235], v[128:131], v[56:59]
    v_mfma_f32_16x16x32_bf16 v[60:63], v[232:235], v[132:135], v[60:63]
    s_waitcnt vmcnt(10)
    s_barrier
    ds_read_b64_tr_b16 v[224:225], v4 offset:49152
    ds_read_b64_tr_b16 v[226:227], v4 offset:50176
    s_waitcnt lgkmcnt(6)
    v_mfma_f32_16x16x32_bf16 v[64:67], v[236:239], v[128:131], v[64:67]
    ds_read_b64_tr_b16 v[228:229], v5 offset:49184
    v_mfma_f32_16x16x32_bf16 v[68:71], v[236:239], v[132:135], v[68:71]
    ds_read_b64_tr_b16 v[230:231], v5 offset:50208
    s_waitcnt lgkmcnt(6)
    v_mfma_f32_16x16x32_bf16 v[72:75], v[240:243], v[128:131], v[72:75]
    ds_read_b64_tr_b16 v[232:233], v4 offset:49408
    v_mfma_f32_16x16x32_bf16 v[76:79], v[240:243], v[132:135], v[76:79]
    ds_read_b64_tr_b16 v[234:235], v4 offset:50432
    s_waitcnt lgkmcnt(6)
    v_mfma_f32_16x16x32_bf16 v[80:83], v[244:247], v[128:131], v[80:83]
    ds_read_b64_tr_b16 v[236:237], v5 offset:49440
    v_mfma_f32_16x16x32_bf16 v[84:87], v[244:247], v[132:135], v[84:87]
    ds_read_b64_tr_b16 v[238:239], v5 offset:50464
    s_waitcnt vmcnt(9) lgkmcnt(6)
    v_mfma_f32_16x16x32_bf16 v[24:27], v[224:227], v[88:91], v[24:27]
    ds_read_b64_tr_b16 v[240:241], v4 offset:49664
    s_waitcnt vmcnt(4)
    v_mfma_f32_16x16x32_bf16 v[28:31], v[224:227], v[92:95], v[28:31]
    ds_read_b64_tr_b16 v[242:243], v4 offset:50688
    s_waitcnt lgkmcnt(6)
    v_mfma_f32_16x16x32_bf16 v[32:35], v[228:231], v[88:91], v[32:35]
    ds_read_b64_tr_b16 v[244:245], v5 offset:49696
    v_mfma_f32_16x16x32_bf16 v[36:39], v[228:231], v[92:95], v[36:39]
    ds_read_b64_tr_b16 v[246:247], v5 offset:50720
    s_waitcnt lgkmcnt(6)
    v_mfma_f32_16x16x32_bf16 v[40:43], v[232:235], v[88:91], v[40:43]
    ds_read_b64_tr_b16 v[224:225], v4 offset:49920
    v_mfma_f32_16x16x32_bf16 v[44:47], v[232:235], v[92:95], v[44:47]
    ds_read_b64_tr_b16 v[226:227], v4 offset:50944
    s_waitcnt lgkmcnt(6)
    v_mfma_f32_16x16x32_bf16 v[48:51], v[236:239], v[88:91], v[48:51]
    ds_read_b64_tr_b16 v[228:229], v5 offset:49952
    v_mfma_f32_16x16x32_bf16 v[52:55], v[236:239], v[92:95], v[52:55]
    ds_read_b64_tr_b16 v[230:231], v5 offset:50976
    s_waitcnt lgkmcnt(6)
    v_mfma_f32_16x16x32_bf16 v[56:59], v[240:243], v[88:91], v[56:59]
    ds_read_b64_tr_b16 v[232:233], v4 offset:57344
    v_mfma_f32_16x16x32_bf16 v[60:63], v[240:243], v[92:95], v[60:63]
    ds_read_b64_tr_b16 v[234:235], v4 offset:58368
    s_waitcnt lgkmcnt(6)
    v_mfma_f32_16x16x32_bf16 v[64:67], v[244:247], v[88:91], v[64:67]
    ds_read_b64_tr_b16 v[236:237], v5 offset:57376
    v_mfma_f32_16x16x32_bf16 v[68:71], v[244:247], v[92:95], v[68:71]
    ds_read_b64_tr_b16 v[238:239], v5 offset:58400
    s_waitcnt lgkmcnt(6)
    v_mfma_f32_16x16x32_bf16 v[72:75], v[224:227], v[88:91], v[72:75]
    ds_read_b64_tr_b16 v[240:241], v4 offset:57600
    v_mfma_f32_16x16x32_bf16 v[76:79], v[224:227], v[92:95], v[76:79]
    ds_read_b64_tr_b16 v[242:243], v4 offset:58624
    s_waitcnt lgkmcnt(6)
    v_mfma_f32_16x16x32_bf16 v[80:83], v[228:231], v[88:91], v[80:83]
    ds_read_b64_tr_b16 v[244:245], v5 offset:57632
    v_mfma_f32_16x16x32_bf16 v[84:87], v[228:231], v[92:95], v[84:87]
    ds_read_b64_tr_b16 v[246:247], v5 offset:58656
    s_waitcnt vmcnt(2) lgkmcnt(6)
    v_mfma_f32_16x16x32_bf16 v[24:27], v[232:235], v[96:99], v[24:27]
    ds_read_b64_tr_b16 v[224:225], v4 offset:57856
    s_waitcnt vmcnt(0)
    v_mfma_f32_16x16x32_bf16 v[28:31], v[232:235], v[100:103], v[28:31]
    ds_read_b64_tr_b16 v[226:227], v4 offset:58880
    s_waitcnt lgkmcnt(6)
    v_mfma_f32_16x16x32_bf16 v[32:35], v[236:239], v[96:99], v[32:35]
    ds_read_b64_tr_b16 v[228:229], v5 offset:57888
    v_mfma_f32_16x16x32_bf16 v[36:39], v[236:239], v[100:103], v[36:39]
    ds_read_b64_tr_b16 v[230:231], v5 offset:58912
    s_waitcnt lgkmcnt(6)
    v_mfma_f32_16x16x32_bf16 v[40:43], v[240:243], v[96:99], v[40:43]
    ds_read_b64_tr_b16 v[232:233], v4 offset:58112
    v_mfma_f32_16x16x32_bf16 v[44:47], v[240:243], v[100:103], v[44:47]
    ds_read_b64_tr_b16 v[234:235], v4 offset:59136
    s_waitcnt lgkmcnt(6)
    v_mfma_f32_16x16x32_bf16 v[48:51], v[244:247], v[96:99], v[48:51]
    ds_read_b64_tr_b16 v[236:237], v5 offset:58144
    v_mfma_f32_16x16x32_bf16 v[52:55], v[244:247], v[100:103], v[52:55]
    ds_read_b64_tr_b16 v[238:239], v5 offset:59168
    s_waitcnt lgkmcnt(6)
    v_mfma_f32_16x16x32_bf16 v[56:59], v[224:227], v[96:99], v[56:59]
    v_mfma_f32_16x16x32_bf16 v[60:63], v[224:227], v[100:103], v[60:63]
    s_waitcnt lgkmcnt(4)
    v_mfma_f32_16x16x32_bf16 v[64:67], v[228:231], v[96:99], v[64:67]
    v_mfma_f32_16x16x32_bf16 v[68:71], v[228:231], v[100:103], v[68:71]
    s_waitcnt lgkmcnt(2)
    v_mfma_f32_16x16x32_bf16 v[72:75], v[232:235], v[96:99], v[72:75]
    v_mfma_f32_16x16x32_bf16 v[76:79], v[232:235], v[100:103], v[76:79]
    s_waitcnt lgkmcnt(0)
    v_mfma_f32_16x16x32_bf16 v[80:83], v[236:239], v[96:99], v[80:83]
    v_mfma_f32_16x16x32_bf16 v[84:87], v[236:239], v[100:103], v[84:87]
    s_barrier
    s_add_u32 s22, s21, 0x8000
    s_add_u32 m0, s20, 0x20000
    s_nop 0
    buffer_load_dwordx4 v2, s[8:11], s22 offen sc1 lds
    s_add_u32 s22, s21, 0x8400
    s_add_u32 m0, s20, 0x20400
    s_nop 0
    buffer_load_dwordx4 v2, s[8:11], s22 offen sc1 lds
    s_add_u32 s22, s21, 0xc000
    s_add_u32 m0, s20, 0x24000
    s_nop 0
    buffer_load_dwordx4 v2, s[8:11], s22 offen sc1 lds
    s_add_u32 s22, s21, 0xc400
    s_add_u32 m0, s20, 0x24400
    s_nop 0
    buffer_load_dwordx4 v2, s[8:11], s22 offen sc1 lds
    ds_read_b64_tr_b16 v[88:89], v11 offset:0
    ds_read_b64_tr_b16 v[90:91], v11 offset:1024
    ds_read_b64_tr_b16 v[92:93], v11 offset:8192
    ds_read_b64_tr_b16 v[94:95], v11 offset:9216
    ds_read_b64_tr_b16 v[96:97], v11 offset:16384
    ds_read_b64_tr_b16 v[98:99], v11 offset:17408
    ds_read_b64_tr_b16 v[100:101], v11 offset:24576
    ds_read_b64_tr_b16 v[102:103], v11 offset:25600
    s_mov_b32 s23, 0x3e0293ee
    v_mul_f32 v24, s23, v24
    v_mul_f32 v25, s23, v25
    v_mul_f32 v26, s23, v26
    v_mul_f32 v27, s23, v27
    v_mul_f32 v28, s23, v28
    v_mul_f32 v29, s23, v29
    v_mul_f32 v30, s23, v30
    v_mul_f32 v31, s23, v31
    v_mul_f32 v32, s23, v32
    v_mul_f32 v33, s23, v33
    v_mul_f32 v34, s23, v34
    v_mul_f32 v35, s23, v35
    v_mul_f32 v36, s23, v36
    v_mul_f32 v37, s23, v37
    v_mul_f32 v38, s23, v38
    v_mul_f32 v39, s23, v39
    v_cvt_pk_bf16_f32 v152, v24, v25
    v_cvt_pk_bf16_f32 v153, v26, v27
    v_cvt_pk_bf16_f32 v168, v28, v29
    v_cvt_pk_bf16_f32 v169, v30, v31
    v_cvt_pk_bf16_f32 v154, v32, v33
    v_cvt_pk_bf16_f32 v155, v34, v35
    v_cvt_pk_bf16_f32 v170, v36, v37
    v_cvt_pk_bf16_f32 v171, v38, v39
    s_waitcnt lgkmcnt(6)
    v_mfma_f32_16x16x32_bf16 v[104:107], v[88:91], v[136:139], 0
    s_waitcnt lgkmcnt(4)
    v_mfma_f32_16x16x32_bf16 v[104:107], v[92:95], v[140:143], v[104:107]
    s_waitcnt lgkmcnt(2)
    v_mfma_f32_16x16x32_bf16 v[104:107], v[96:99], v[144:147], v[104:107]
    s_waitcnt lgkmcnt(0)
    v_mfma_f32_16x16x32_bf16 v[104:107], v[100:103], v[148:151], v[104:107]
    v_add_u32 v4, 0x10000, v2
    v_add_u32 v5, 0x20000, v2
    s_barrier
    ds_read_b128 v[224:227], v4 offset:32768
    ds_read_b128 v[228:231], v4 offset:33792
    ds_read_b128 v[232:235], v4 offset:34816
    ds_read_b128 v[236:239], v4 offset:35840
    v_mov_b32 v12, 0x3f803f80
    v_mov_b32 v13, 0x3f803f80
    v_mov_b32 v14, 0x3f803f80
    v_mov_b32 v15, 0x3f803f80
    s_waitcnt lgkmcnt(3)
    v_mfma_f32_16x16x32_bf16 v[184:187], v[224:227], v[152:155], 0
    v_mul_f32 v40, s23, v40
    v_mul_f32 v41, s23, v41
    v_mul_f32 v42, s23, v42
    v_mul_f32 v43, s23, v43
    v_mul_f32 v44, s23, v44
    v_mul_f32 v45, s23, v45
    v_lshrrev_b32 v20, 4, v1
    v_lshlrev_b32 v20, 4, v20
    s_lshr_b32 s16, s2, 5
    s_lshl_b32 s16, s16, 14
    s_and_b32 s17, s2, 31
    s_lshl_b32 s17, s17, 9
    s_add_u32 s16, s16, s17
    s_lshl_b32 s17, s3, 6
    s_add_u32 s16, s16, s17
    s_add_u32 s16, s16, 0x580000
    s_mov_b32 exec_lo, 0x10001
    s_mov_b32 exec_hi, 0x10001
    buffer_store_dwordx4 v[104:107], v20, s[8:11], s16 offen sc1
    s_mov_b64 exec, -1
    v_mfma_f32_16x16x32_bf16 v[188:191], v[224:227], v[168:171], 0
    ds_read_b128 v[240:243], v4 offset:36864
    v_mul_f32 v46, s23, v46
    v_mul_f32 v47, s23, v47
    v_mul_f32 v48, s23, v48
    v_mul_f32 v49, s23, v49
    v_mul_f32 v50, s23, v50
    v_mul_f32 v51, s23, v51
    s_mov_b64 s[64:65], s[46:47]
    s_mov_b32 s66, 0x700000
    s_mov_b32 s67, 0x20000
    s_mov_b64 s[68:69], s[48:49]
    s_mov_b32 s70, 0x700000
    s_mov_b32 s71, 0x20000
    s_cmp_lt_u32 s2, 224
    s_cselect_b32 s66, 7340032, 0
    s_cselect_b32 s70, 7340032, 0
    s_and_b32 s29, s2, 7
    s_mul_i32 s29, s29, 28
    s_lshr_b32 s16, s2, 3
    s_add_u32 s29, s29, s16
    s_sub_u32 s16, s3, 4
    v_lshrrev_b32 v20, 3, v1
    v_lshlrev_b32 v20, 3, v20
    s_lshl_b32 s17, s16, 6
    v_add_u32 v20, s17, v20
    s_mov_b32 s17, 7168
    v_mul_lo_u32 v11, s17, v20
    v_and_b32 v20, 7, v1
    v_lshl_add_u32 v11, v20, 4, v11
    s_and_b32 s17, s29, 3
    s_mul_i32 s18, s17, 1835008
    s_lshr_b32 s17, s29, 2
    s_lshl_b32 s17, s17, 7
    s_add_u32 s18, s18, s17
    s_lshl_b32 s15, s16, 13
    s_waitcnt lgkmcnt(3)
    v_mfma_f32_16x16x32_bf16 v[192:195], v[228:231], v[152:155], 0
    s_add_u32 s22, s21, 0x10000
    s_add_u32 m0, s20, 0x10000
    s_nop 0
    buffer_load_dwordx4 v2, s[8:11], s22 offen sc1 lds
    v_mul_f32 v52, s23, v52
    v_mul_f32 v53, s23, v53
    v_mul_f32 v54, s23, v54
    v_mul_f32 v55, s23, v55
    v_cvt_pk_bf16_f32 v156, v40, v41
    v_cvt_pk_bf16_f32 v157, v42, v43
    v_mfma_f32_16x16x32_bf16 v[196:199], v[228:231], v[168:171], 0
    ds_read_b128 v[244:247], v4 offset:37888
    v_cvt_pk_bf16_f32 v172, v44, v45
    v_cvt_pk_bf16_f32 v173, v46, v47
    v_cvt_pk_bf16_f32 v158, v48, v49
    v_cvt_pk_bf16_f32 v159, v50, v51
    v_cvt_pk_bf16_f32 v174, v52, v53
    v_cvt_pk_bf16_f32 v175, v54, v55
    s_waitcnt lgkmcnt(3)
    v_mfma_f32_16x16x32_bf16 v[184:187], v[232:235], v[156:159], v[184:187]
    v_mul_f32 v56, s23, v56
    v_mul_f32 v57, s23, v57
    v_mul_f32 v58, s23, v58
    v_mul_f32 v59, s23, v59
    v_mul_f32 v60, s23, v60
    v_mul_f32 v61, s23, v61
    v_mfma_f32_16x16x32_bf16 v[188:191], v[232:235], v[172:175], v[188:191]
    ds_read_b128 v[224:227], v4 offset:38912
    v_mul_f32 v62, s23, v62
    v_mul_f32 v63, s23, v63
    v_mul_f32 v64, s23, v64
    v_mul_f32 v65, s23, v65
    v_mul_f32 v66, s23, v66
    v_mul_f32 v67, s23, v67
    s_waitcnt lgkmcnt(3)
    v_mfma_f32_16x16x32_bf16 v[192:195], v[236:239], v[156:159], v[192:195]
    v_mul_f32 v68, s23, v68
    v_mul_f32 v69, s23, v69
    v_mul_f32 v70, s23, v70
    v_mul_f32 v71, s23, v71
    v_cvt_pk_bf16_f32 v160, v56, v57
    v_cvt_pk_bf16_f32 v161, v58, v59
    v_mfma_f32_16x16x32_bf16 v[196:199], v[236:239], v[172:175], v[196:199]
    ds_read_b128 v[228:231], v4 offset:39936
    v_cvt_pk_bf16_f32 v176, v60, v61
    v_cvt_pk_bf16_f32 v177, v62, v63
    v_cvt_pk_bf16_f32 v162, v64, v65
    v_cvt_pk_bf16_f32 v163, v66, v67
    v_cvt_pk_bf16_f32 v178, v68, v69
    v_cvt_pk_bf16_f32 v179, v70, v71
    s_waitcnt lgkmcnt(3)
    v_mfma_f32_16x16x32_bf16 v[184:187], v[240:243], v[160:163], v[184:187]
    v_mul_f32 v72, s23, v72
    v_mul_f32 v73, s23, v73
    v_mul_f32 v74, s23, v74
    v_mul_f32 v75, s23, v75
    v_mul_f32 v76, s23, v76
    v_mul_f32 v77, s23, v77
    v_mfma_f32_16x16x32_bf16 v[188:191], v[240:243], v[176:179], v[188:191]
    ds_read_b128 v[232:235], v4 offset:40960
    v_mul_f32 v78, s23, v78
    v_mul_f32 v79, s23, v79
    v_mul_f32 v80, s23, v80
    v_mul_f32 v81, s23, v81
    v_mul_f32 v82, s23, v82
    v_mul_f32 v83, s23, v83
    s_waitcnt lgkmcnt(3)
    v_mfma_f32_16x16x32_bf16 v[192:195], v[244:247], v[160:163], v[192:195]
    s_add_u32 s22, s21, 0x10400
    s_add_u32 m0, s20, 0x10400
    s_nop 0
    buffer_load_dwordx4 v2, s[8:11], s22 offen sc1 lds
    v_mul_f32 v84, s23, v84
    v_mul_f32 v85, s23, v85
    v_mul_f32 v86, s23, v86
    v_mul_f32 v87, s23, v87
    v_cvt_pk_bf16_f32 v164, v72, v73
    v_cvt_pk_bf16_f32 v165, v74, v75
    v_mfma_f32_16x16x32_bf16 v[196:199], v[244:247], v[176:179], v[196:199]
    ds_read_b128 v[236:239], v4 offset:41984
    v_cvt_pk_bf16_f32 v180, v76, v77
    v_cvt_pk_bf16_f32 v181, v78, v79
    v_cvt_pk_bf16_f32 v166, v80, v81
    v_cvt_pk_bf16_f32 v167, v82, v83
    v_cvt_pk_bf16_f32 v182, v84, v85
    v_cvt_pk_bf16_f32 v183, v86, v87
    s_waitcnt lgkmcnt(3)
    v_mfma_f32_16x16x32_bf16 v[184:187], v[224:227], v[164:167], v[184:187]
    v_mfma_f32_16x16x32_bf16 v[188:191], v[224:227], v[180:183], v[188:191]
    ds_read_b128 v[240:243], v4 offset:43008
    s_waitcnt lgkmcnt(3)
    v_mfma_f32_16x16x32_bf16 v[192:195], v[228:231], v[164:167], v[192:195]
    v_mfma_f32_16x16x32_bf16 v[196:199], v[228:231], v[180:183], v[196:199]
    ds_read_b128 v[244:247], v4 offset:44032
    s_waitcnt lgkmcnt(3)
    v_mfma_f32_16x16x32_bf16 v[200:203], v[232:235], v[152:155], 0
    v_mfma_f32_16x16x32_bf16 v[204:207], v[232:235], v[168:171], 0
    ds_read_b128 v[224:227], v4 offset:45056
    s_waitcnt lgkmcnt(3)
    v_mfma_f32_16x16x32_bf16 v[208:211], v[236:239], v[152:155], 0
    v_mfma_f32_16x16x32_bf16 v[212:215], v[236:239], v[168:171], 0
    ds_read_b128 v[228:231], v4 offset:46080
    s_waitcnt lgkmcnt(3)
    v_mfma_f32_16x16x32_bf16 v[200:203], v[240:243], v[156:159], v[200:203]
    v_mfma_f32_16x16x32_bf16 v[204:207], v[240:243], v[172:175], v[204:207]
    ds_read_b128 v[232:235], v4 offset:47104
    s_waitcnt lgkmcnt(3)
    v_mfma_f32_16x16x32_bf16 v[208:211], v[244:247], v[156:159], v[208:211]
    v_max3_f32 v16, v184, v185, v186
    v_mfma_f32_16x16x32_bf16 v[212:215], v[244:247], v[172:175], v[212:215]
    ds_read_b128 v[236:239], v4 offset:48128
    v_max3_f32 v16, v16, v187, v192
    s_waitcnt lgkmcnt(3)
    v_mfma_f32_16x16x32_bf16 v[200:203], v[224:227], v[160:163], v[200:203]
    v_max3_f32 v16, v16, v193, v194
    v_mfma_f32_16x16x32_bf16 v[204:207], v[224:227], v[176:179], v[204:207]
    s_barrier
    ds_read_b128 v[240:243], v4 offset:49152
    v_max_f32 v16, v16, v195
    s_waitcnt lgkmcnt(3)
    v_mfma_f32_16x16x32_bf16 v[208:211], v[228:231], v[160:163], v[208:211]
    v_max3_f32 v17, v188, v189, v190
    v_mfma_f32_16x16x32_bf16 v[212:215], v[228:231], v[176:179], v[212:215]
    s_add_u32 s22, s21, 0x14000
    s_add_u32 m0, s20, 0x14000
    s_nop 0
    buffer_load_dwordx4 v2, s[8:11], s22 offen sc1 lds
    ds_read_b128 v[244:247], v4 offset:50176
    v_max3_f32 v17, v17, v191, v196
    s_waitcnt lgkmcnt(3)
    v_mfma_f32_16x16x32_bf16 v[200:203], v[232:235], v[164:167], v[200:203]
    v_max3_f32 v17, v17, v197, v198
    v_mfma_f32_16x16x32_bf16 v[204:207], v[232:235], v[180:183], v[204:207]
    ds_read_b128 v[224:227], v4 offset:51200
    v_max_f32 v17, v17, v199
    s_waitcnt lgkmcnt(3)
    v_mfma_f32_16x16x32_bf16 v[208:211], v[236:239], v[164:167], v[208:211]
    s_mov_b64 s[72:73], s[40:41]
    s_mov_b32 s74, 0x800000
    s_mov_b32 s75, 0x20000
    v_lshlrev_b32 v21, 7, v1
    s_lshl_b32 s16, s2, 2
    s_add_u32 s16, s16, s3
    s_sub_u32 s16, s16, 4
    s_lshl_b32 s16, s16, 13
    buffer_load_dword v7, v21, s[72:75], s16 offen
    v_mfma_f32_16x16x32_bf16 v[212:215], v[236:239], v[180:183], v[212:215]
    ds_read_b128 v[228:231], v4 offset:52224
    v_max3_f32 v16, v16, v200, v201
    v_max3_f32 v16, v16, v202, v203
    v_max3_f32 v16, v16, v208, v209
    v_max3_f32 v16, v16, v210, v211
    v_max3_f32 v17, v17, v204, v205
    v_max3_f32 v17, v17, v206, v207
    s_nop 0
    v_max3_f32 v17, v17, v212, v213
    v_max3_f32 v17, v17, v214, v215
    v_mov_b32 v18, v16
    v_mov_b32 v19, v17
    s_nop 0
    v_permlane16_swap_b32 v16, v18
    v_permlane16_swap_b32 v17, v19
    v_max_f32 v16, v16, v18
    v_max_f32 v17, v17, v19
    v_mov_b32 v18, v16
    v_mov_b32 v19, v17
    s_nop 0
    v_permlane32_swap_b32 v16, v18
    v_permlane32_swap_b32 v17, v19
    v_max_f32 v16, v16, v18
    v_max_f32 v17, v17, v19
    v_sub_f32 v216, 0, v16
    v_sub_f32 v217, 0, v16
    v_sub_f32 v218, 0, v16
    v_sub_f32 v219, 0, v16
    v_sub_f32 v220, 0, v17
    v_sub_f32 v221, 0, v17
    v_sub_f32 v222, 0, v17
    v_sub_f32 v223, 0, v17
    v_add_f32 v184, v184, v216
    v_add_f32 v185, v185, v216
    v_exp_f32 v184, v184
    v_exp_f32 v185, v185
    s_nop 0
    v_cvt_pk_bf16_f32 v24, v184, v185
    v_add_f32 v186, v186, v216
    v_add_f32 v187, v187, v216
    v_exp_f32 v186, v186
    v_exp_f32 v187, v187
    s_nop 0
    v_cvt_pk_bf16_f32 v25, v186, v187
    v_add_f32 v188, v188, v220
    v_add_f32 v189, v189, v220
    v_exp_f32 v188, v188
    v_exp_f32 v189, v189
    s_nop 0
    v_cvt_pk_bf16_f32 v28, v188, v189
    v_add_f32 v190, v190, v220
    v_add_f32 v191, v191, v220
    v_exp_f32 v190, v190
    v_exp_f32 v191, v191
    s_nop 0
    v_cvt_pk_bf16_f32 v29, v190, v191
    v_add_f32 v192, v192, v216
    v_add_f32 v193, v193, v216
    v_exp_f32 v192, v192
    v_exp_f32 v193, v193
    s_nop 0
    v_cvt_pk_bf16_f32 v26, v192, v193
    v_add_f32 v194, v194, v216
    v_add_f32 v195, v195, v216
    v_exp_f32 v194, v194
    v_exp_f32 v195, v195
    s_nop 0
    v_cvt_pk_bf16_f32 v27, v194, v195
    v_add_f32 v196, v196, v220
    v_add_f32 v197, v197, v220
    v_exp_f32 v196, v196
    v_exp_f32 v197, v197
    s_nop 0
    v_cvt_pk_bf16_f32 v30, v196, v197
    v_add_f32 v198, v198, v220
    v_add_f32 v199, v199, v220
    v_exp_f32 v198, v198
    v_exp_f32 v199, v199
    s_nop 0
    v_cvt_pk_bf16_f32 v31, v198, v199
    s_waitcnt lgkmcnt(3)
    v_mfma_f32_16x16x32_bf16 v[184:187], v[240:243], v[152:155], v[216:219]
    v_mfma_f32_16x16x32_bf16 v[188:191], v[240:243], v[168:171], v[220:223]
    ds_read_b128 v[232:235], v4 offset:53248
    v_add_f32 v200, v200, v216
    v_add_f32 v201, v201, v216
    v_exp_f32 v200, v200
    v_mfma_f32_16x16x32_bf16 v[248:251], v[12:15], v[24:27], 0
    s_waitcnt lgkmcnt(3)
    v_mfma_f32_16x16x32_bf16 v[192:195], v[244:247], v[152:155], v[216:219]
    v_exp_f32 v201, v201
    s_nop 0
    v_cvt_pk_bf16_f32 v32, v200, v201
    v_add_f32 v202, v202, v216
    v_mfma_f32_16x16x32_bf16 v[196:199], v[244:247], v[168:171], v[220:223]
    s_add_u32 s22, s21, 0x14400
    s_add_u32 m0, s20, 0x14400
    s_nop 0
    buffer_load_dwordx4 v2, s[8:11], s22 offen sc1 lds
    ds_read_b128 v[236:239], v4 offset:54272
    v_add_f32 v203, v203, v216
    v_exp_f32 v202, v202
    v_mfma_f32_16x16x32_bf16 v[252:255], v[12:15], v[28:31], 0
    s_waitcnt lgkmcnt(3)
    v_mfma_f32_16x16x32_bf16 v[184:187], v[224:227], v[156:159], v[184:187]
    v_exp_f32 v203, v203
    s_nop 0
    v_cvt_pk_bf16_f32 v33, v202, v203
    v_add_f32 v204, v204, v220
    v_mfma_f32_16x16x32_bf16 v[188:191], v[224:227], v[172:175], v[188:191]
    ds_read_b128 v[240:243], v4 offset:55296
    v_add_f32 v205, v205, v220
    v_exp_f32 v204, v204
    v_exp_f32 v205, v205
    s_mov_b64 s[4:5], s[40:41]
    s_mov_b32 s6, 0x800000
    s_mov_b32 s7, 0x20000
    v_bfe_u32 v20, v1, 2, 2
    v_lshlrev_b32 v21, 13, v20
    v_sub_u32 v3, v3, v21
    v_lshl_add_u32 v3, v20, 11, v3
    s_and_b32 s16, s2, 1
    s_lshl_b32 s24, s16, 22
    s_lshr_b32 s16, s2, 5
    s_lshl_b32 s16, s16, 8
    s_add_u32 s24, s24, s16
    s_lshl_b32 s16, s3, 14
    s_add_u32 s24, s24, s16
    s_add_u32 s24, s24, 196608
    s_waitcnt lgkmcnt(3)
    v_mfma_f32_16x16x32_bf16 v[192:195], v[228:231], v[156:159], v[192:195]
    v_cvt_pk_bf16_f32 v36, v204, v205
    v_add_f32 v206, v206, v220
    v_mfma_f32_16x16x32_bf16 v[196:199], v[228:231], v[172:175], v[196:199]
    ds_read_b128 v[244:247], v4 offset:56320
    v_add_f32 v207, v207, v220
    v_exp_f32 v206, v206
    v_exp_f32 v207, v207
    s_waitcnt lgkmcnt(3)
    v_mfma_f32_16x16x32_bf16 v[184:187], v[232:235], v[160:163], v[184:187]
    v_cvt_pk_bf16_f32 v37, v206, v207
    v_add_f32 v208, v208, v216
    v_add_f32 v209, v209, v216
    v_mfma_f32_16x16x32_bf16 v[188:191], v[232:235], v[176:179], v[188:191]
    ds_read_b128 v[224:227], v4 offset:57344
    v_exp_f32 v208, v208
    v_exp_f32 v209, v209
    s_waitcnt lgkmcnt(3)
    v_mfma_f32_16x16x32_bf16 v[192:195], v[236:239], v[160:163], v[192:195]
    v_cvt_pk_bf16_f32 v34, v208, v209
    v_add_f32 v210, v210, v216
    v_add_f32 v211, v211, v216
    v_mfma_f32_16x16x32_bf16 v[196:199], v[236:239], v[176:179], v[196:199]
    ds_read_b128 v[228:231], v4 offset:58368
    v_exp_f32 v210, v210
    v_exp_f32 v211, v211
    s_nop 0
    v_cvt_pk_bf16_f32 v35, v210, v211
    s_waitcnt lgkmcnt(3)
    v_mfma_f32_16x16x32_bf16 v[184:187], v[240:243], v[164:167], v[184:187]
    v_add_f32 v212, v212, v220
    v_add_f32 v213, v213, v220
    v_mfma_f32_16x16x32_bf16 v[188:191], v[240:243], v[180:183], v[188:191]
    ds_read_b128 v[232:235], v4 offset:59392
    v_exp_f32 v212, v212
    v_exp_f32 v213, v213
    s_nop 0
    v_cvt_pk_bf16_f32 v38, v212, v213
    s_waitcnt lgkmcnt(3)
    v_mfma_f32_16x16x32_bf16 v[192:195], v[244:247], v[164:167], v[192:195]
    v_add_f32 v214, v214, v220
    v_add_f32 v215, v215, v220
    v_exp_f32 v214, v214
    v_mfma_f32_16x16x32_bf16 v[196:199], v[244:247], v[180:183], v[196:199]
    ds_read_b128 v[236:239], v4 offset:60416
    v_exp_f32 v215, v215
    s_nop 0
    v_cvt_pk_bf16_f32 v39, v214, v215
    s_waitcnt lgkmcnt(3)
    v_mfma_f32_16x16x32_bf16 v[200:203], v[224:227], v[152:155], v[216:219]
    v_mfma_f32_16x16x32_bf16 v[204:207], v[224:227], v[168:171], v[220:223]
    ds_read_b128 v[240:243], v4 offset:61440
    v_exp_f32 v184, v184
    v_exp_f32 v185, v185
    v_mfma_f32_16x16x32_bf16 v[248:251], v[12:15], v[32:35], v[248:251]
    s_waitcnt lgkmcnt(3)
    v_mfma_f32_16x16x32_bf16 v[208:211], v[228:231], v[152:155], v[216:219]
    v_cvt_pk_bf16_f32 v40, v184, v185
    v_exp_f32 v186, v186
    v_mfma_f32_16x16x32_bf16 v[212:215], v[228:231], v[168:171], v[220:223]
    ds_read_b128 v[244:247], v4 offset:62464
    v_exp_f32 v187, v187
    v_mfma_f32_16x16x32_bf16 v[252:255], v[12:15], v[36:39], v[252:255]
    s_waitcnt lgkmcnt(3)
    v_mfma_f32_16x16x32_bf16 v[200:203], v[232:235], v[156:159], v[200:203]
    v_cvt_pk_bf16_f32 v41, v186, v187
    v_exp_f32 v188, v188
    v_mfma_f32_16x16x32_bf16 v[204:207], v[232:235], v[172:175], v[204:207]
    ds_read_b128 v[224:227], v4 offset:63488
    v_exp_f32 v189, v189
    s_waitcnt lgkmcnt(3)
    v_mfma_f32_16x16x32_bf16 v[208:211], v[236:239], v[156:159], v[208:211]
    v_cvt_pk_bf16_f32 v44, v188, v189
    v_exp_f32 v190, v190
    v_mfma_f32_16x16x32_bf16 v[212:215], v[236:239], v[172:175], v[212:215]
    ds_read_b128 v[228:231], v4 offset:64512
    v_exp_f32 v191, v191
    s_nop 0
    v_cvt_pk_bf16_f32 v45, v190, v191
    s_waitcnt lgkmcnt(3)
    v_mfma_f32_16x16x32_bf16 v[200:203], v[240:243], v[160:163], v[200:203]
    v_exp_f32 v192, v192
    v_mfma_f32_16x16x32_bf16 v[204:207], v[240:243], v[176:179], v[204:207]
    s_waitcnt vmcnt(8)
    s_barrier
    ds_read_b128 v[232:235], v5 offset:0
    v_exp_f32 v193, v193
    s_nop 0
    v_cvt_pk_bf16_f32 v42, v192, v193
    s_waitcnt lgkmcnt(3)
    v_mfma_f32_16x16x32_bf16 v[208:211], v[244:247], v[160:163], v[208:211]
    v_exp_f32 v194, v194
    v_mfma_f32_16x16x32_bf16 v[212:215], v[244:247], v[176:179], v[212:215]
    s_add_u32 s22, s21, 0x18000
    s_add_u32 m0, s20, 0x18000
    s_nop 0
    buffer_load_dwordx4 v2, s[8:11], s22 offen sc1 lds
    ds_read_b128 v[236:239], v5 offset:1024
    v_exp_f32 v195, v195
    s_nop 0
    v_cvt_pk_bf16_f32 v43, v194, v195
    s_waitcnt lgkmcnt(3)
    v_mfma_f32_16x16x32_bf16 v[200:203], v[224:227], v[164:167], v[200:203]
    v_exp_f32 v196, v196
    v_exp_f32 v197, v197
    v_mfma_f32_16x16x32_bf16 v[204:207], v[224:227], v[180:183], v[204:207]
    ds_read_b128 v[240:243], v5 offset:2048
    v_cvt_pk_bf16_f32 v46, v196, v197
    s_waitcnt lgkmcnt(3)
    v_mfma_f32_16x16x32_bf16 v[208:211], v[228:231], v[164:167], v[208:211]
    v_exp_f32 v198, v198
    v_exp_f32 v199, v199
    v_mfma_f32_16x16x32_bf16 v[212:215], v[228:231], v[180:183], v[212:215]
    ds_read_b128 v[244:247], v5 offset:3072
    v_cvt_pk_bf16_f32 v47, v198, v199
    s_waitcnt lgkmcnt(3)
    v_mfma_f32_16x16x32_bf16 v[184:187], v[232:235], v[152:155], v[216:219]
    v_mfma_f32_16x16x32_bf16 v[188:191], v[232:235], v[168:171], v[220:223]
    ds_read_b128 v[224:227], v5 offset:4096
    v_exp_f32 v200, v200
    v_exp_f32 v201, v201
    v_mfma_f32_16x16x32_bf16 v[248:251], v[12:15], v[40:43], v[248:251]
    s_waitcnt lgkmcnt(3)
    v_mfma_f32_16x16x32_bf16 v[192:195], v[236:239], v[152:155], v[216:219]
    v_cvt_pk_bf16_f32 v48, v200, v201
    v_exp_f32 v202, v202
    v_mfma_f32_16x16x32_bf16 v[196:199], v[236:239], v[168:171], v[220:223]
    s_add_u32 s22, s21, 0x18400
    s_add_u32 m0, s20, 0x18400
    s_nop 0
    buffer_load_dwordx4 v2, s[8:11], s22 offen sc1 lds
    ds_read_b128 v[228:231], v5 offset:5120
    v_exp_f32 v203, v203
    v_mfma_f32_16x16x32_bf16 v[252:255], v[12:15], v[44:47], v[252:255]
    s_waitcnt lgkmcnt(3)
    v_mfma_f32_16x16x32_bf16 v[184:187], v[240:243], v[156:159], v[184:187]
    v_cvt_pk_bf16_f32 v49, v202, v203
    v_exp_f32 v204, v204
    v_mfma_f32_16x16x32_bf16 v[188:191], v[240:243], v[172:175], v[188:191]
    ds_read_b128 v[232:235], v5 offset:6144
    v_exp_f32 v205, v205
    s_waitcnt lgkmcnt(3)
    v_mfma_f32_16x16x32_bf16 v[192:195], v[244:247], v[156:159], v[192:195]
    v_cvt_pk_bf16_f32 v52, v204, v205
    v_exp_f32 v206, v206
    v_mfma_f32_16x16x32_bf16 v[196:199], v[244:247], v[172:175], v[196:199]
    ds_read_b128 v[236:239], v5 offset:7168
    v_exp_f32 v207, v207
    s_nop 0
    v_cvt_pk_bf16_f32 v53, v206, v207
    s_waitcnt lgkmcnt(3)
    v_mfma_f32_16x16x32_bf16 v[184:187], v[224:227], v[160:163], v[184:187]
    v_exp_f32 v208, v208
    v_mfma_f32_16x16x32_bf16 v[188:191], v[224:227], v[176:179], v[188:191]
    ds_read_b128 v[240:243], v5 offset:8192
    v_exp_f32 v209, v209
    s_nop 0
    v_cvt_pk_bf16_f32 v50, v208, v209
    s_waitcnt lgkmcnt(3)
    v_mfma_f32_16x16x32_bf16 v[192:195], v[228:231], v[160:163], v[192:195]
    v_exp_f32 v210, v210
    v_mfma_f32_16x16x32_bf16 v[196:199], v[228:231], v[176:179], v[196:199]
    ds_read_b128 v[244:247], v5 offset:9216
    v_exp_f32 v211, v211
    s_nop 0
    v_cvt_pk_bf16_f32 v51, v210, v211
    s_waitcnt lgkmcnt(3)
    v_mfma_f32_16x16x32_bf16 v[184:187], v[232:235], v[164:167], v[184:187]
    v_exp_f32 v212, v212
    v_exp_f32 v213, v213
    v_mfma_f32_16x16x32_bf16 v[188:191], v[232:235], v[180:183], v[188:191]
    ds_read_b128 v[224:227], v5 offset:10240
    v_cvt_pk_bf16_f32 v54, v212, v213
    s_waitcnt lgkmcnt(3)
    v_mfma_f32_16x16x32_bf16 v[192:195], v[236:239], v[164:167], v[192:195]
    v_exp_f32 v214, v214
    v_exp_f32 v215, v215
    v_mfma_f32_16x16x32_bf16 v[196:199], v[236:239], v[180:183], v[196:199]
    ds_read_b128 v[228:231], v5 offset:11264
    v_cvt_pk_bf16_f32 v55, v214, v215
    s_waitcnt lgkmcnt(3)
    v_mfma_f32_16x16x32_bf16 v[200:203], v[240:243], v[152:155], v[216:219]
    v_mfma_f32_16x16x32_bf16 v[204:207], v[240:243], v[168:171], v[220:223]
    ds_read_b128 v[232:235], v5 offset:12288
    v_exp_f32 v184, v184
    v_exp_f32 v185, v185
    v_mfma_f32_16x16x32_bf16 v[248:251], v[12:15], v[48:51], v[248:251]
    s_waitcnt lgkmcnt(3)
    v_mfma_f32_16x16x32_bf16 v[208:211], v[244:247], v[152:155], v[216:219]
    v_cvt_pk_bf16_f32 v56, v184, v185
    v_exp_f32 v186, v186
    v_mfma_f32_16x16x32_bf16 v[212:215], v[244:247], v[168:171], v[220:223]
    ds_read_b128 v[236:239], v5 offset:13312
    v_exp_f32 v187, v187
    v_mfma_f32_16x16x32_bf16 v[252:255], v[12:15], v[52:55], v[252:255]
    s_waitcnt lgkmcnt(3)
    v_mfma_f32_16x16x32_bf16 v[200:203], v[224:227], v[156:159], v[200:203]
    v_cvt_pk_bf16_f32 v57, v186, v187
    v_exp_f32 v188, v188
    v_mfma_f32_16x16x32_bf16 v[204:207], v[224:227], v[172:175], v[204:207]
    ds_read_b128 v[240:243], v5 offset:14336
    v_exp_f32 v189, v189
    s_waitcnt lgkmcnt(3)
    v_mfma_f32_16x16x32_bf16 v[208:211], v[228:231], v[156:159], v[208:211]
    v_cvt_pk_bf16_f32 v60, v188, v189
    v_exp_f32 v190, v190
    s_waitcnt vmcnt(7)
    v_mfma_f32_16x16x32_bf16 v[212:215], v[228:231], v[172:175], v[212:215]
    ds_read_b128 v[244:247], v5 offset:15360
    v_exp_f32 v191, v191
    s_nop 0
    v_cvt_pk_bf16_f32 v61, v190, v191
    s_waitcnt lgkmcnt(3)
    v_mfma_f32_16x16x32_bf16 v[200:203], v[232:235], v[160:163], v[200:203]
    v_exp_f32 v192, v192
    v_mfma_f32_16x16x32_bf16 v[204:207], v[232:235], v[176:179], v[204:207]
    s_barrier
    ds_read_b128 v[224:227], v5 offset:16384
    v_exp_f32 v193, v193
    s_nop 0
    v_cvt_pk_bf16_f32 v58, v192, v193
    s_waitcnt lgkmcnt(3)
    v_mfma_f32_16x16x32_bf16 v[208:211], v[236:239], v[160:163], v[208:211]
    v_exp_f32 v194, v194
    v_mfma_f32_16x16x32_bf16 v[212:215], v[236:239], v[176:179], v[212:215]
    s_add_u32 s22, s21, 0x1c000
    s_add_u32 m0, s20, 0x1c000
    s_nop 0
    buffer_load_dwordx4 v2, s[8:11], s22 offen sc1 lds
    ds_read_b128 v[228:231], v5 offset:17408
    v_exp_f32 v195, v195
    s_nop 0
    v_cvt_pk_bf16_f32 v59, v194, v195
    s_waitcnt lgkmcnt(3)
    v_mfma_f32_16x16x32_bf16 v[200:203], v[240:243], v[164:167], v[200:203]
    v_exp_f32 v196, v196
    v_exp_f32 v197, v197
    v_mfma_f32_16x16x32_bf16 v[204:207], v[240:243], v[180:183], v[204:207]
    ds_read_b128 v[232:235], v5 offset:18432
    v_cvt_pk_bf16_f32 v62, v196, v197
    s_waitcnt lgkmcnt(3)
    v_mfma_f32_16x16x32_bf16 v[208:211], v[244:247], v[164:167], v[208:211]
    v_exp_f32 v198, v198
    v_exp_f32 v199, v199
    v_mfma_f32_16x16x32_bf16 v[212:215], v[244:247], v[180:183], v[212:215]
    ds_read_b128 v[236:239], v5 offset:19456
    v_cvt_pk_bf16_f32 v63, v198, v199
    s_waitcnt lgkmcnt(3)
    v_mfma_f32_16x16x32_bf16 v[184:187], v[224:227], v[152:155], v[216:219]
    v_mfma_f32_16x16x32_bf16 v[188:191], v[224:227], v[168:171], v[220:223]
    ds_read_b128 v[240:243], v5 offset:20480
    v_exp_f32 v200, v200
    v_exp_f32 v201, v201
    v_mfma_f32_16x16x32_bf16 v[248:251], v[12:15], v[56:59], v[248:251]
    s_waitcnt lgkmcnt(3)
    v_mfma_f32_16x16x32_bf16 v[192:195], v[228:231], v[152:155], v[216:219]
    v_cvt_pk_bf16_f32 v64, v200, v201
    v_exp_f32 v202, v202
    v_mfma_f32_16x16x32_bf16 v[196:199], v[228:231], v[168:171], v[220:223]
    s_add_u32 s22, s21, 0x1c400
    s_add_u32 m0, s20, 0x1c400
    s_nop 0
    buffer_load_dwordx4 v2, s[8:11], s22 offen sc1 lds
    ds_read_b128 v[244:247], v5 offset:21504
    v_exp_f32 v203, v203
    v_mfma_f32_16x16x32_bf16 v[252:255], v[12:15], v[60:63], v[252:255]
    s_waitcnt lgkmcnt(3)
    v_mfma_f32_16x16x32_bf16 v[184:187], v[232:235], v[156:159], v[184:187]
    v_cvt_pk_bf16_f32 v65, v202, v203
    v_exp_f32 v204, v204
    v_mfma_f32_16x16x32_bf16 v[188:191], v[232:235], v[172:175], v[188:191]
    ds_read_b128 v[224:227], v5 offset:22528
    v_exp_f32 v205, v205
    s_waitcnt lgkmcnt(3)
    v_mfma_f32_16x16x32_bf16 v[192:195], v[236:239], v[156:159], v[192:195]
    v_cvt_pk_bf16_f32 v68, v204, v205
    v_exp_f32 v206, v206
    v_mfma_f32_16x16x32_bf16 v[196:199], v[236:239], v[172:175], v[196:199]
    ds_read_b128 v[228:231], v5 offset:23552
    v_exp_f32 v207, v207
    s_nop 0
    v_cvt_pk_bf16_f32 v69, v206, v207
    s_waitcnt lgkmcnt(3)
    v_mfma_f32_16x16x32_bf16 v[184:187], v[240:243], v[160:163], v[184:187]
    v_exp_f32 v208, v208
    v_mfma_f32_16x16x32_bf16 v[188:191], v[240:243], v[176:179], v[188:191]
    ds_read_b128 v[232:235], v5 offset:24576
    v_exp_f32 v209, v209
    s_nop 0
    v_cvt_pk_bf16_f32 v66, v208, v209
    s_waitcnt lgkmcnt(3)
    v_mfma_f32_16x16x32_bf16 v[192:195], v[244:247], v[160:163], v[192:195]
    v_exp_f32 v210, v210
    v_mfma_f32_16x16x32_bf16 v[196:199], v[244:247], v[176:179], v[196:199]
    ds_read_b128 v[236:239], v5 offset:25600
    v_exp_f32 v211, v211
    s_nop 0
    v_cvt_pk_bf16_f32 v67, v210, v211
    s_waitcnt lgkmcnt(3)
    v_mfma_f32_16x16x32_bf16 v[184:187], v[224:227], v[164:167], v[184:187]
    v_exp_f32 v212, v212
    v_exp_f32 v213, v213
    v_mfma_f32_16x16x32_bf16 v[188:191], v[224:227], v[180:183], v[188:191]
    ds_read_b128 v[240:243], v5 offset:26624
    v_cvt_pk_bf16_f32 v70, v212, v213
    s_waitcnt lgkmcnt(3)
    v_mfma_f32_16x16x32_bf16 v[192:195], v[228:231], v[164:167], v[192:195]
    v_exp_f32 v214, v214
    v_exp_f32 v215, v215
    v_mfma_f32_16x16x32_bf16 v[196:199], v[228:231], v[180:183], v[196:199]
    ds_read_b128 v[244:247], v5 offset:27648
    v_cvt_pk_bf16_f32 v71, v214, v215
    s_waitcnt lgkmcnt(3)
    v_mfma_f32_16x16x32_bf16 v[200:203], v[232:235], v[152:155], v[216:219]
    v_mfma_f32_16x16x32_bf16 v[204:207], v[232:235], v[168:171], v[220:223]
    ds_read_b128 v[224:227], v5 offset:28672
    v_exp_f32 v184, v184
    v_exp_f32 v185, v185
    v_mfma_f32_16x16x32_bf16 v[248:251], v[12:15], v[64:67], v[248:251]
    s_waitcnt lgkmcnt(3)
    v_mfma_f32_16x16x32_bf16 v[208:211], v[236:239], v[152:155], v[216:219]
    v_cvt_pk_bf16_f32 v72, v184, v185
    v_exp_f32 v186, v186
    v_mfma_f32_16x16x32_bf16 v[212:215], v[236:239], v[168:171], v[220:223]
    ds_read_b128 v[228:231], v5 offset:29696
    v_exp_f32 v187, v187
    v_mfma_f32_16x16x32_bf16 v[252:255], v[12:15], v[68:71], v[252:255]
    s_waitcnt lgkmcnt(3)
    v_mfma_f32_16x16x32_bf16 v[200:203], v[240:243], v[156:159], v[200:203]
    v_cvt_pk_bf16_f32 v73, v186, v187
    v_exp_f32 v188, v188
    v_mfma_f32_16x16x32_bf16 v[204:207], v[240:243], v[172:175], v[204:207]
    ds_read_b128 v[232:235], v5 offset:30720
    v_exp_f32 v189, v189
    s_waitcnt lgkmcnt(3)
    v_mfma_f32_16x16x32_bf16 v[208:211], v[244:247], v[156:159], v[208:211]
    v_cvt_pk_bf16_f32 v76, v188, v189
    v_exp_f32 v190, v190
    v_mfma_f32_16x16x32_bf16 v[212:215], v[244:247], v[172:175], v[212:215]
    ds_read_b128 v[236:239], v5 offset:31744
    v_exp_f32 v191, v191
    s_nop 0
    v_cvt_pk_bf16_f32 v77, v190, v191
    s_waitcnt lgkmcnt(3)
    v_mfma_f32_16x16x32_bf16 v[200:203], v[224:227], v[160:163], v[200:203]
    v_exp_f32 v192, v192
    v_mfma_f32_16x16x32_bf16 v[204:207], v[224:227], v[176:179], v[204:207]
    s_waitcnt vmcnt(7)
    s_barrier
    ds_read_b128 v[240:243], v4 offset:0
    v_exp_f32 v193, v193
    s_nop 0
    v_cvt_pk_bf16_f32 v74, v192, v193
    s_waitcnt lgkmcnt(3)
    v_mfma_f32_16x16x32_bf16 v[208:211], v[228:231], v[160:163], v[208:211]
    v_exp_f32 v194, v194
    v_mfma_f32_16x16x32_bf16 v[212:215], v[228:231], v[176:179], v[212:215]
    s_add_u32 s22, s21, 0x80000
    s_add_u32 m0, s20, 0x20000
    s_nop 0
    buffer_load_dwordx4 v2, s[8:11], s22 offen sc1 lds
    ds_read_b128 v[244:247], v4 offset:1024
    v_exp_f32 v195, v195
    s_nop 0
    v_cvt_pk_bf16_f32 v75, v194, v195
    s_waitcnt lgkmcnt(3)
    v_mfma_f32_16x16x32_bf16 v[200:203], v[232:235], v[164:167], v[200:203]
    v_exp_f32 v196, v196
    v_exp_f32 v197, v197
    v_mfma_f32_16x16x32_bf16 v[204:207], v[232:235], v[180:183], v[204:207]
    ds_read_b128 v[224:227], v4 offset:2048
    v_cvt_pk_bf16_f32 v78, v196, v197
    s_waitcnt lgkmcnt(3)
    v_mfma_f32_16x16x32_bf16 v[208:211], v[236:239], v[164:167], v[208:211]
    v_exp_f32 v198, v198
    v_exp_f32 v199, v199
    v_mfma_f32_16x16x32_bf16 v[212:215], v[236:239], v[180:183], v[212:215]
    ds_read_b128 v[228:231], v4 offset:3072
    v_cvt_pk_bf16_f32 v79, v198, v199
    s_waitcnt lgkmcnt(3)
    v_mfma_f32_16x16x32_bf16 v[184:187], v[240:243], v[152:155], v[216:219]
    v_mfma_f32_16x16x32_bf16 v[188:191], v[240:243], v[168:171], v[220:223]
    ds_read_b128 v[232:235], v4 offset:4096
    v_exp_f32 v200, v200
    v_exp_f32 v201, v201
    v_mfma_f32_16x16x32_bf16 v[248:251], v[12:15], v[72:75], v[248:251]
    s_waitcnt lgkmcnt(3)
    v_mfma_f32_16x16x32_bf16 v[192:195], v[244:247], v[152:155], v[216:219]
    v_cvt_pk_bf16_f32 v80, v200, v201
    v_exp_f32 v202, v202
    v_mfma_f32_16x16x32_bf16 v[196:199], v[244:247], v[168:171], v[220:223]
    s_add_u32 s22, s21, 0x80400
    s_add_u32 m0, s20, 0x20400
    s_nop 0
    buffer_load_dwordx4 v2, s[8:11], s22 offen sc1 lds
    ds_read_b128 v[236:239], v4 offset:5120
    v_exp_f32 v203, v203
    v_mfma_f32_16x16x32_bf16 v[252:255], v[12:15], v[76:79], v[252:255]
    s_waitcnt lgkmcnt(3)
    v_mfma_f32_16x16x32_bf16 v[184:187], v[224:227], v[156:159], v[184:187]
    v_cvt_pk_bf16_f32 v81, v202, v203
    v_exp_f32 v204, v204
    s_add_u32 s22, s18, 0
    s_add_u32 m0, s15, 0
    s_nop 0
    buffer_load_dwordx4 v11, s[64:67], s22 offen lds
    v_mfma_f32_16x16x32_bf16 v[188:191], v[224:227], v[172:175], v[188:191]
    ds_read_b128 v[240:243], v4 offset:6144
    v_exp_f32 v205, v205
    s_waitcnt lgkmcnt(3)
    v_mfma_f32_16x16x32_bf16 v[192:195], v[228:231], v[156:159], v[192:195]
    v_cvt_pk_bf16_f32 v84, v204, v205
    v_exp_f32 v206, v206
    v_mfma_f32_16x16x32_bf16 v[196:199], v[228:231], v[172:175], v[196:199]
    ds_read_b128 v[244:247], v4 offset:7168
    v_exp_f32 v207, v207
    s_nop 0
    v_cvt_pk_bf16_f32 v85, v206, v207
    s_waitcnt lgkmcnt(3)
    v_mfma_f32_16x16x32_bf16 v[184:187], v[232:235], v[160:163], v[184:187]
    v_exp_f32 v208, v208
    v_mfma_f32_16x16x32_bf16 v[188:191], v[232:235], v[176:179], v[188:191]
    ds_read_b128 v[224:227], v4 offset:8192
    v_exp_f32 v209, v209
    s_nop 0
    v_cvt_pk_bf16_f32 v82, v208, v209
    s_waitcnt lgkmcnt(3)
    v_mfma_f32_16x16x32_bf16 v[192:195], v[236:239], v[160:163], v[192:195]
    v_exp_f32 v210, v210
    v_mfma_f32_16x16x32_bf16 v[196:199], v[236:239], v[176:179], v[196:199]
    ds_read_b128 v[228:231], v4 offset:9216
    v_exp_f32 v211, v211
    s_nop 0
    v_cvt_pk_bf16_f32 v83, v210, v211
    s_waitcnt lgkmcnt(3)
    v_mfma_f32_16x16x32_bf16 v[184:187], v[240:243], v[164:167], v[184:187]
    v_exp_f32 v212, v212
    v_exp_f32 v213, v213
    v_mfma_f32_16x16x32_bf16 v[188:191], v[240:243], v[180:183], v[188:191]
    ds_read_b128 v[232:235], v4 offset:10240
    v_cvt_pk_bf16_f32 v86, v212, v213
    s_waitcnt lgkmcnt(3)
    v_mfma_f32_16x16x32_bf16 v[192:195], v[244:247], v[164:167], v[192:195]
    v_exp_f32 v214, v214
    v_exp_f32 v215, v215
    v_mfma_f32_16x16x32_bf16 v[196:199], v[244:247], v[180:183], v[196:199]
    ds_read_b128 v[236:239], v4 offset:11264
    v_cvt_pk_bf16_f32 v87, v214, v215
    s_waitcnt lgkmcnt(3)
    v_mfma_f32_16x16x32_bf16 v[200:203], v[224:227], v[152:155], v[216:219]
    v_mfma_f32_16x16x32_bf16 v[204:207], v[224:227], v[168:171], v[220:223]
    ds_read_b128 v[240:243], v4 offset:12288
    v_exp_f32 v184, v184
    v_exp_f32 v185, v185
    v_mfma_f32_16x16x32_bf16 v[248:251], v[12:15], v[80:83], v[248:251]
    s_waitcnt lgkmcnt(3)
    v_mfma_f32_16x16x32_bf16 v[208:211], v[228:231], v[152:155], v[216:219]
    v_cvt_pk_bf16_f32 v88, v184, v185
    v_exp_f32 v186, v186
    v_mfma_f32_16x16x32_bf16 v[212:215], v[228:231], v[168:171], v[220:223]
    ds_read_b128 v[244:247], v4 offset:13312
    v_exp_f32 v187, v187
    s_add_u32 s22, s18, 7168
    s_add_u32 m0, s15, 1024
    s_nop 0
    buffer_load_dwordx4 v11, s[64:67], s22 offen lds
    v_mfma_f32_16x16x32_bf16 v[252:255], v[12:15], v[84:87], v[252:255]
    s_waitcnt lgkmcnt(3)
    v_mfma_f32_16x16x32_bf16 v[200:203], v[232:235], v[156:159], v[200:203]
    v_cvt_pk_bf16_f32 v89, v186, v187
    v_exp_f32 v188, v188
    v_mfma_f32_16x16x32_bf16 v[204:207], v[232:235], v[172:175], v[204:207]
    ds_read_b128 v[224:227], v4 offset:14336
    v_exp_f32 v189, v189
    s_waitcnt lgkmcnt(3)
    v_mfma_f32_16x16x32_bf16 v[208:211], v[236:239], v[156:159], v[208:211]
    v_cvt_pk_bf16_f32 v92, v188, v189
    v_exp_f32 v190, v190
    v_mfma_f32_16x16x32_bf16 v[212:215], v[236:239], v[172:175], v[212:215]
    ds_read_b128 v[228:231], v4 offset:15360
    v_exp_f32 v191, v191
    s_nop 0
    v_cvt_pk_bf16_f32 v93, v190, v191
    s_waitcnt lgkmcnt(3)
    v_mfma_f32_16x16x32_bf16 v[200:203], v[240:243], v[160:163], v[200:203]
    v_exp_f32 v192, v192
    v_mfma_f32_16x16x32_bf16 v[204:207], v[240:243], v[176:179], v[204:207]
    s_waitcnt vmcnt(8)
    s_barrier
    ds_read_b128 v[232:235], v4 offset:16384
    v_exp_f32 v193, v193
    s_nop 0
    v_cvt_pk_bf16_f32 v90, v192, v193
    s_waitcnt lgkmcnt(3)
    v_mfma_f32_16x16x32_bf16 v[208:211], v[244:247], v[160:163], v[208:211]
    v_exp_f32 v194, v194
    v_mfma_f32_16x16x32_bf16 v[212:215], v[244:247], v[176:179], v[212:215]
    s_add_u32 s22, s21, 0x84000
    s_add_u32 m0, s20, 0x24000
    s_nop 0
    buffer_load_dwordx4 v2, s[8:11], s22 offen sc1 lds
    ds_read_b128 v[236:239], v4 offset:17408
    v_exp_f32 v195, v195
    s_nop 0
    v_cvt_pk_bf16_f32 v91, v194, v195
    s_waitcnt lgkmcnt(3)
    v_mfma_f32_16x16x32_bf16 v[200:203], v[224:227], v[164:167], v[200:203]
    v_exp_f32 v196, v196
    v_exp_f32 v197, v197
    v_mfma_f32_16x16x32_bf16 v[204:207], v[224:227], v[180:183], v[204:207]
    ds_read_b128 v[240:243], v4 offset:18432
    v_cvt_pk_bf16_f32 v94, v196, v197
    s_waitcnt lgkmcnt(3)
    v_mfma_f32_16x16x32_bf16 v[208:211], v[228:231], v[164:167], v[208:211]
    v_exp_f32 v198, v198
    v_exp_f32 v199, v199
    v_mfma_f32_16x16x32_bf16 v[212:215], v[228:231], v[180:183], v[212:215]
    ds_read_b128 v[244:247], v4 offset:19456
    v_cvt_pk_bf16_f32 v95, v198, v199
    s_waitcnt lgkmcnt(3)
    v_mfma_f32_16x16x32_bf16 v[184:187], v[232:235], v[152:155], v[216:219]
    v_mfma_f32_16x16x32_bf16 v[188:191], v[232:235], v[168:171], v[220:223]
    ds_read_b128 v[224:227], v4 offset:20480
    v_exp_f32 v200, v200
    v_exp_f32 v201, v201
    v_mfma_f32_16x16x32_bf16 v[248:251], v[12:15], v[88:91], v[248:251]
    s_waitcnt lgkmcnt(3)
    v_mfma_f32_16x16x32_bf16 v[192:195], v[236:239], v[152:155], v[216:219]
    v_cvt_pk_bf16_f32 v96, v200, v201
    v_exp_f32 v202, v202
    v_mfma_f32_16x16x32_bf16 v[196:199], v[236:239], v[168:171], v[220:223]
    s_add_u32 s22, s21, 0x84400
    s_add_u32 m0, s20, 0x24400
    s_nop 0
    buffer_load_dwordx4 v2, s[8:11], s22 offen sc1 lds
    ds_read_b128 v[228:231], v4 offset:21504
    v_exp_f32 v203, v203
    s_add_u32 s22, s18, 14336
    s_add_u32 m0, s15, 2048
    s_nop 0
    buffer_load_dwordx4 v11, s[64:67], s22 offen lds
    v_mfma_f32_16x16x32_bf16 v[252:255], v[12:15], v[92:95], v[252:255]
    s_waitcnt lgkmcnt(3)
    v_mfma_f32_16x16x32_bf16 v[184:187], v[240:243], v[156:159], v[184:187]
    v_cvt_pk_bf16_f32 v97, v202, v203
    v_exp_f32 v204, v204
    v_mfma_f32_16x16x32_bf16 v[188:191], v[240:243], v[172:175], v[188:191]
    ds_read_b128 v[232:235], v4 offset:22528
    v_exp_f32 v205, v205
    s_waitcnt lgkmcnt(3)
    v_mfma_f32_16x16x32_bf16 v[192:195], v[244:247], v[156:159], v[192:195]
    v_cvt_pk_bf16_f32 v100, v204, v205
    v_exp_f32 v206, v206
    v_mfma_f32_16x16x32_bf16 v[196:199], v[244:247], v[172:175], v[196:199]
    ds_read_b128 v[236:239], v4 offset:23552
    v_exp_f32 v207, v207
    s_nop 0
    v_cvt_pk_bf16_f32 v101, v206, v207
    s_waitcnt lgkmcnt(3)
    v_mfma_f32_16x16x32_bf16 v[184:187], v[224:227], v[160:163], v[184:187]
    v_exp_f32 v208, v208
    v_mfma_f32_16x16x32_bf16 v[188:191], v[224:227], v[176:179], v[188:191]
    ds_read_b128 v[240:243], v4 offset:24576
    v_exp_f32 v209, v209
    s_nop 0
    v_cvt_pk_bf16_f32 v98, v208, v209
    s_waitcnt lgkmcnt(3)
    v_mfma_f32_16x16x32_bf16 v[192:195], v[228:231], v[160:163], v[192:195]
    v_exp_f32 v210, v210
    v_mfma_f32_16x16x32_bf16 v[196:199], v[228:231], v[176:179], v[196:199]
    ds_read_b128 v[244:247], v4 offset:25600
    v_exp_f32 v211, v211
    s_nop 0
    v_cvt_pk_bf16_f32 v99, v210, v211
    s_waitcnt lgkmcnt(3)
    v_mfma_f32_16x16x32_bf16 v[184:187], v[232:235], v[164:167], v[184:187]
    v_exp_f32 v212, v212
    v_exp_f32 v213, v213
    v_mfma_f32_16x16x32_bf16 v[188:191], v[232:235], v[180:183], v[188:191]
    ds_read_b128 v[224:227], v4 offset:26624
    v_cvt_pk_bf16_f32 v102, v212, v213
    s_waitcnt lgkmcnt(3)
    v_mfma_f32_16x16x32_bf16 v[192:195], v[236:239], v[164:167], v[192:195]
    v_exp_f32 v214, v214
    v_exp_f32 v215, v215
    v_mfma_f32_16x16x32_bf16 v[196:199], v[236:239], v[180:183], v[196:199]
    ds_read_b128 v[228:231], v4 offset:27648
    v_cvt_pk_bf16_f32 v103, v214, v215
    s_waitcnt lgkmcnt(3)
    v_mfma_f32_16x16x32_bf16 v[200:203], v[240:243], v[152:155], v[216:219]
    v_mfma_f32_16x16x32_bf16 v[204:207], v[240:243], v[168:171], v[220:223]
    ds_read_b128 v[232:235], v4 offset:28672
    v_exp_f32 v184, v184
    v_exp_f32 v185, v185
    v_mfma_f32_16x16x32_bf16 v[248:251], v[12:15], v[96:99], v[248:251]
    s_waitcnt lgkmcnt(3)
    v_mfma_f32_16x16x32_bf16 v[208:211], v[244:247], v[152:155], v[216:219]
    v_cvt_pk_bf16_f32 v104, v184, v185
    v_exp_f32 v186, v186
    s_add_u32 s22, s18, 21504
    s_add_u32 m0, s15, 3072
    s_nop 0
    buffer_load_dwordx4 v11, s[64:67], s22 offen lds
    v_mfma_f32_16x16x32_bf16 v[212:215], v[244:247], v[168:171], v[220:223]
    ds_read_b128 v[236:239], v4 offset:29696
    v_exp_f32 v187, v187
    v_mfma_f32_16x16x32_bf16 v[252:255], v[12:15], v[100:103], v[252:255]
    s_waitcnt lgkmcnt(3)
    v_mfma_f32_16x16x32_bf16 v[200:203], v[224:227], v[156:159], v[200:203]
    v_cvt_pk_bf16_f32 v105, v186, v187
    v_exp_f32 v188, v188
    v_mfma_f32_16x16x32_bf16 v[204:207], v[224:227], v[172:175], v[204:207]
    ds_read_b128 v[240:243], v4 offset:30720
    v_exp_f32 v189, v189
    s_waitcnt lgkmcnt(3)
    v_mfma_f32_16x16x32_bf16 v[208:211], v[228:231], v[156:159], v[208:211]
    v_cvt_pk_bf16_f32 v108, v188, v189
    v_exp_f32 v190, v190
    v_mfma_f32_16x16x32_bf16 v[212:215], v[228:231], v[172:175], v[212:215]
    ds_read_b128 v[244:247], v4 offset:31744
    v_exp_f32 v191, v191
    s_nop 0
    v_cvt_pk_bf16_f32 v109, v190, v191
    s_waitcnt lgkmcnt(3)
    v_mfma_f32_16x16x32_bf16 v[200:203], v[232:235], v[160:163], v[200:203]
    v_exp_f32 v192, v192
    v_mfma_f32_16x16x32_bf16 v[204:207], v[232:235], v[176:179], v[204:207]
    s_waitcnt vmcnt(10)
    s_barrier
    ds_read_b128 v[224:227], v4 offset:32768
    v_exp_f32 v193, v193
    s_nop 0
    v_cvt_pk_bf16_f32 v106, v192, v193
    s_waitcnt lgkmcnt(3)
    v_mfma_f32_16x16x32_bf16 v[208:211], v[236:239], v[160:163], v[208:211]
    v_exp_f32 v194, v194
    v_mfma_f32_16x16x32_bf16 v[212:215], v[236:239], v[176:179], v[212:215]
    s_add_u32 s22, s21, 0x88000
    s_add_u32 m0, s20, 0x10000
    s_nop 0
    buffer_load_dwordx4 v2, s[8:11], s22 offen sc1 lds
    ds_read_b128 v[228:231], v4 offset:33792
    v_exp_f32 v195, v195
    s_nop 0
    v_cvt_pk_bf16_f32 v107, v194, v195
    s_waitcnt lgkmcnt(3)
    v_mfma_f32_16x16x32_bf16 v[200:203], v[240:243], v[164:167], v[200:203]
    v_exp_f32 v196, v196
    v_exp_f32 v197, v197
    v_mfma_f32_16x16x32_bf16 v[204:207], v[240:243], v[180:183], v[204:207]
    ds_read_b128 v[232:235], v4 offset:34816
    v_cvt_pk_bf16_f32 v110, v196, v197
    s_waitcnt lgkmcnt(3)
    v_mfma_f32_16x16x32_bf16 v[208:211], v[244:247], v[164:167], v[208:211]
    v_exp_f32 v198, v198
    v_exp_f32 v199, v199
    v_mfma_f32_16x16x32_bf16 v[212:215], v[244:247], v[180:183], v[212:215]
    ds_read_b128 v[236:239], v4 offset:35840
    v_cvt_pk_bf16_f32 v111, v198, v199
    s_waitcnt lgkmcnt(3)
    v_mfma_f32_16x16x32_bf16 v[184:187], v[224:227], v[152:155], v[216:219]
    v_mfma_f32_16x16x32_bf16 v[188:191], v[224:227], v[168:171], v[220:223]
    ds_read_b128 v[240:243], v4 offset:36864
    v_exp_f32 v200, v200
    v_exp_f32 v201, v201
    v_mfma_f32_16x16x32_bf16 v[248:251], v[12:15], v[104:107], v[248:251]
    s_waitcnt lgkmcnt(3)
    v_mfma_f32_16x16x32_bf16 v[192:195], v[228:231], v[152:155], v[216:219]
    v_cvt_pk_bf16_f32 v112, v200, v201
    v_exp_f32 v202, v202
    s_add_u32 s22, s18, 28672
    s_add_u32 m0, s15, 4096
    s_nop 0
    buffer_load_dwordx4 v11, s[64:67], s22 offen lds
    v_mfma_f32_16x16x32_bf16 v[196:199], v[228:231], v[168:171], v[220:223]
    s_add_u32 s22, s21, 0x88400
    s_add_u32 m0, s20, 0x10400
    s_nop 0
    buffer_load_dwordx4 v2, s[8:11], s22 offen sc1 lds
    ds_read_b128 v[244:247], v4 offset:37888
    v_exp_f32 v203, v203
    v_mfma_f32_16x16x32_bf16 v[252:255], v[12:15], v[108:111], v[252:255]
    s_waitcnt lgkmcnt(3)
    v_mfma_f32_16x16x32_bf16 v[184:187], v[232:235], v[156:159], v[184:187]
    v_cvt_pk_bf16_f32 v113, v202, v203
    v_exp_f32 v204, v204
    v_mfma_f32_16x16x32_bf16 v[188:191], v[232:235], v[172:175], v[188:191]
    ds_read_b128 v[224:227], v4 offset:38912
    v_exp_f32 v205, v205
    s_waitcnt lgkmcnt(3)
    v_mfma_f32_16x16x32_bf16 v[192:195], v[236:239], v[156:159], v[192:195]
    v_cvt_pk_bf16_f32 v116, v204, v205
    v_exp_f32 v206, v206
    v_mfma_f32_16x16x32_bf16 v[196:199], v[236:239], v[172:175], v[196:199]
    ds_read_b128 v[228:231], v4 offset:39936
    v_exp_f32 v207, v207
    s_nop 0
    v_cvt_pk_bf16_f32 v117, v206, v207
    s_waitcnt lgkmcnt(3)
    v_mfma_f32_16x16x32_bf16 v[184:187], v[240:243], v[160:163], v[184:187]
    v_exp_f32 v208, v208
    v_mfma_f32_16x16x32_bf16 v[188:191], v[240:243], v[176:179], v[188:191]
    ds_read_b128 v[232:235], v4 offset:40960
    v_exp_f32 v209, v209
    s_nop 0
    v_cvt_pk_bf16_f32 v114, v208, v209
    s_waitcnt lgkmcnt(3)
    v_mfma_f32_16x16x32_bf16 v[192:195], v[244:247], v[160:163], v[192:195]
    v_exp_f32 v210, v210
    v_mfma_f32_16x16x32_bf16 v[196:199], v[244:247], v[176:179], v[196:199]
    ds_read_b128 v[236:239], v4 offset:41984
    v_exp_f32 v211, v211
    s_nop 0
    v_cvt_pk_bf16_f32 v115, v210, v211
    s_waitcnt lgkmcnt(3)
    v_mfma_f32_16x16x32_bf16 v[184:187], v[224:227], v[164:167], v[184:187]
    v_exp_f32 v212, v212
    v_exp_f32 v213, v213
    v_mfma_f32_16x16x32_bf16 v[188:191], v[224:227], v[180:183], v[188:191]
    ds_read_b128 v[240:243], v4 offset:43008
    v_cvt_pk_bf16_f32 v118, v212, v213
    s_waitcnt lgkmcnt(3)
    v_mfma_f32_16x16x32_bf16 v[192:195], v[228:231], v[164:167], v[192:195]
    v_exp_f32 v214, v214
    v_exp_f32 v215, v215
    v_mfma_f32_16x16x32_bf16 v[196:199], v[228:231], v[180:183], v[196:199]
    ds_read_b128 v[244:247], v4 offset:44032
    v_cvt_pk_bf16_f32 v119, v214, v215
    s_waitcnt lgkmcnt(3)
    v_mfma_f32_16x16x32_bf16 v[200:203], v[232:235], v[152:155], v[216:219]
    v_mfma_f32_16x16x32_bf16 v[204:207], v[232:235], v[168:171], v[220:223]
    ds_read_b128 v[224:227], v4 offset:45056
    v_exp_f32 v184, v184
    v_exp_f32 v185, v185
    s_add_u32 s22, s18, 35840
    s_add_u32 m0, s15, 5120
    s_nop 0
    buffer_load_dwordx4 v11, s[64:67], s22 offen lds
    v_mfma_f32_16x16x32_bf16 v[248:251], v[12:15], v[112:115], v[248:251]
    s_waitcnt lgkmcnt(3)
    v_mfma_f32_16x16x32_bf16 v[208:211], v[236:239], v[152:155], v[216:219]
    v_cvt_pk_bf16_f32 v120, v184, v185
    v_exp_f32 v186, v186
    v_mfma_f32_16x16x32_bf16 v[212:215], v[236:239], v[168:171], v[220:223]
    ds_read_b128 v[228:231], v4 offset:46080
    v_exp_f32 v187, v187
    v_mfma_f32_16x16x32_bf16 v[252:255], v[12:15], v[116:119], v[252:255]
    s_waitcnt lgkmcnt(3)
    v_mfma_f32_16x16x32_bf16 v[200:203], v[240:243], v[156:159], v[200:203]
    v_cvt_pk_bf16_f32 v121, v186, v187
    v_exp_f32 v188, v188
    v_mfma_f32_16x16x32_bf16 v[204:207], v[240:243], v[172:175], v[204:207]
    ds_read_b128 v[232:235], v4 offset:47104
    v_exp_f32 v189, v189
    s_waitcnt lgkmcnt(3)
    v_mfma_f32_16x16x32_bf16 v[208:211], v[244:247], v[156:159], v[208:211]
    v_cvt_pk_bf16_f32 v124, v188, v189
    v_exp_f32 v190, v190
    v_mfma_f32_16x16x32_bf16 v[212:215], v[244:247], v[172:175], v[212:215]
    ds_read_b128 v[236:239], v4 offset:48128
    v_exp_f32 v191, v191
    s_nop 0
    v_cvt_pk_bf16_f32 v125, v190, v191
    s_waitcnt lgkmcnt(3)
    v_mfma_f32_16x16x32_bf16 v[200:203], v[224:227], v[160:163], v[200:203]
    v_exp_f32 v192, v192
    v_mfma_f32_16x16x32_bf16 v[204:207], v[224:227], v[176:179], v[204:207]
    s_waitcnt vmcnt(12)
    s_barrier
    ds_read_b128 v[240:243], v4 offset:49152
    v_exp_f32 v193, v193
    s_nop 0
    v_cvt_pk_bf16_f32 v122, v192, v193
    s_waitcnt lgkmcnt(3)
    v_mfma_f32_16x16x32_bf16 v[208:211], v[228:231], v[160:163], v[208:211]
    v_exp_f32 v194, v194
    v_mfma_f32_16x16x32_bf16 v[212:215], v[228:231], v[176:179], v[212:215]
    s_add_u32 s22, s21, 0x8c000
    s_add_u32 m0, s20, 0x14000
    s_nop 0
    buffer_load_dwordx4 v2, s[8:11], s22 offen sc1 lds
    ds_read_b128 v[244:247], v4 offset:50176
    v_exp_f32 v195, v195
    s_nop 0
    v_cvt_pk_bf16_f32 v123, v194, v195
    s_waitcnt lgkmcnt(3)
    v_mfma_f32_16x16x32_bf16 v[200:203], v[232:235], v[164:167], v[200:203]
    v_exp_f32 v196, v196
    v_exp_f32 v197, v197
    v_mfma_f32_16x16x32_bf16 v[204:207], v[232:235], v[180:183], v[204:207]
    ds_read_b128 v[224:227], v4 offset:51200
    v_cvt_pk_bf16_f32 v126, v196, v197
    s_waitcnt lgkmcnt(3)
    v_mfma_f32_16x16x32_bf16 v[208:211], v[236:239], v[164:167], v[208:211]
    v_exp_f32 v198, v198
    v_exp_f32 v199, v199
    v_mfma_f32_16x16x32_bf16 v[212:215], v[236:239], v[180:183], v[212:215]
    ds_read_b128 v[228:231], v4 offset:52224
    v_cvt_pk_bf16_f32 v127, v198, v199
    s_waitcnt lgkmcnt(3)
    v_mfma_f32_16x16x32_bf16 v[184:187], v[240:243], v[152:155], v[216:219]
    v_mfma_f32_16x16x32_bf16 v[188:191], v[240:243], v[168:171], v[220:223]
    ds_read_b128 v[232:235], v4 offset:53248
    v_exp_f32 v200, v200
    v_exp_f32 v201, v201
    s_add_u32 s22, s18, 43008
    s_add_u32 m0, s15, 6144
    s_nop 0
    buffer_load_dwordx4 v11, s[64:67], s22 offen lds
    v_mfma_f32_16x16x32_bf16 v[248:251], v[12:15], v[120:123], v[248:251]
    s_waitcnt lgkmcnt(3)
    v_mfma_f32_16x16x32_bf16 v[192:195], v[244:247], v[152:155], v[216:219]
    v_cvt_pk_bf16_f32 v128, v200, v201
    v_exp_f32 v202, v202
    v_mfma_f32_16x16x32_bf16 v[196:199], v[244:247], v[168:171], v[220:223]
    s_add_u32 s22, s21, 0x8c400
    s_add_u32 m0, s20, 0x14400
    s_nop 0
    buffer_load_dwordx4 v2, s[8:11], s22 offen sc1 lds
    ds_read_b128 v[236:239], v4 offset:54272
    v_exp_f32 v203, v203
    v_mfma_f32_16x16x32_bf16 v[252:255], v[12:15], v[124:127], v[252:255]
    s_waitcnt lgkmcnt(3)
    v_mfma_f32_16x16x32_bf16 v[184:187], v[224:227], v[156:159], v[184:187]
    v_cvt_pk_bf16_f32 v129, v202, v203
    v_exp_f32 v204, v204
    v_mfma_f32_16x16x32_bf16 v[188:191], v[224:227], v[172:175], v[188:191]
    ds_read_b128 v[240:243], v4 offset:55296
    v_exp_f32 v205, v205
    s_waitcnt lgkmcnt(3)
    v_mfma_f32_16x16x32_bf16 v[192:195], v[228:231], v[156:159], v[192:195]
    v_cvt_pk_bf16_f32 v132, v204, v205
    v_exp_f32 v206, v206
    v_mfma_f32_16x16x32_bf16 v[196:199], v[228:231], v[172:175], v[196:199]
    ds_read_b128 v[244:247], v4 offset:56320
    v_exp_f32 v207, v207
    s_nop 0
    v_cvt_pk_bf16_f32 v133, v206, v207
    s_waitcnt lgkmcnt(3)
    v_mfma_f32_16x16x32_bf16 v[184:187], v[232:235], v[160:163], v[184:187]
    v_exp_f32 v208, v208
    v_mfma_f32_16x16x32_bf16 v[188:191], v[232:235], v[176:179], v[188:191]
    ds_read_b128 v[224:227], v4 offset:57344
    v_exp_f32 v209, v209
    s_nop 0
    v_cvt_pk_bf16_f32 v130, v208, v209
    s_waitcnt lgkmcnt(3)
    v_mfma_f32_16x16x32_bf16 v[192:195], v[236:239], v[160:163], v[192:195]
    v_exp_f32 v210, v210
    v_mfma_f32_16x16x32_bf16 v[196:199], v[236:239], v[176:179], v[196:199]
    ds_read_b128 v[228:231], v4 offset:58368
    v_exp_f32 v211, v211
    s_nop 0
    v_cvt_pk_bf16_f32 v131, v210, v211
    s_waitcnt lgkmcnt(3)
    v_mfma_f32_16x16x32_bf16 v[184:187], v[240:243], v[164:167], v[184:187]
    v_exp_f32 v212, v212
    v_exp_f32 v213, v213
    v_mfma_f32_16x16x32_bf16 v[188:191], v[240:243], v[180:183], v[188:191]
    ds_read_b128 v[232:235], v4 offset:59392
    v_cvt_pk_bf16_f32 v134, v212, v213
    s_waitcnt lgkmcnt(3)
    v_mfma_f32_16x16x32_bf16 v[192:195], v[244:247], v[164:167], v[192:195]
    v_exp_f32 v214, v214
    v_exp_f32 v215, v215
    v_mfma_f32_16x16x32_bf16 v[196:199], v[244:247], v[180:183], v[196:199]
    ds_read_b128 v[236:239], v4 offset:60416
    v_cvt_pk_bf16_f32 v135, v214, v215
    s_waitcnt lgkmcnt(3)
    v_mfma_f32_16x16x32_bf16 v[200:203], v[224:227], v[152:155], v[216:219]
    s_add_u32 s22, s18, 50176
    s_add_u32 m0, s15, 7168
    s_nop 0
    buffer_load_dwordx4 v11, s[64:67], s22 offen lds
    v_mfma_f32_16x16x32_bf16 v[204:207], v[224:227], v[168:171], v[220:223]
    ds_read_b128 v[240:243], v4 offset:61440
    v_exp_f32 v184, v184
    v_exp_f32 v185, v185
    v_mfma_f32_16x16x32_bf16 v[248:251], v[12:15], v[128:131], v[248:251]
    s_waitcnt lgkmcnt(3)
    v_mfma_f32_16x16x32_bf16 v[208:211], v[228:231], v[152:155], v[216:219]
    v_cvt_pk_bf16_f32 v136, v184, v185
    v_exp_f32 v186, v186
    v_mfma_f32_16x16x32_bf16 v[212:215], v[228:231], v[168:171], v[220:223]
    ds_read_b128 v[244:247], v4 offset:62464
    v_exp_f32 v187, v187
    v_mfma_f32_16x16x32_bf16 v[252:255], v[12:15], v[132:135], v[252:255]
    s_waitcnt lgkmcnt(3)
    v_mfma_f32_16x16x32_bf16 v[200:203], v[232:235], v[156:159], v[200:203]
    v_cvt_pk_bf16_f32 v137, v186, v187
    v_exp_f32 v188, v188
    v_mfma_f32_16x16x32_bf16 v[204:207], v[232:235], v[172:175], v[204:207]
    ds_read_b128 v[224:227], v4 offset:63488
    v_exp_f32 v189, v189
    s_waitcnt lgkmcnt(3)
    v_mfma_f32_16x16x32_bf16 v[208:211], v[236:239], v[156:159], v[208:211]
    v_cvt_pk_bf16_f32 v140, v188, v189
    v_exp_f32 v190, v190
    v_mfma_f32_16x16x32_bf16 v[212:215], v[236:239], v[172:175], v[212:215]
    ds_read_b128 v[228:231], v4 offset:64512
    v_exp_f32 v191, v191
    s_nop 0
    v_cvt_pk_bf16_f32 v141, v190, v191
    s_waitcnt lgkmcnt(3)
    v_mfma_f32_16x16x32_bf16 v[200:203], v[240:243], v[160:163], v[200:203]
    v_exp_f32 v192, v192
    v_mfma_f32_16x16x32_bf16 v[204:207], v[240:243], v[176:179], v[204:207]
    v_exp_f32 v193, v193
    s_nop 0
    v_cvt_pk_bf16_f32 v138, v192, v193
    s_waitcnt lgkmcnt(2)
    v_mfma_f32_16x16x32_bf16 v[208:211], v[244:247], v[160:163], v[208:211]
    v_exp_f32 v194, v194
    v_mfma_f32_16x16x32_bf16 v[212:215], v[244:247], v[176:179], v[212:215]
    v_exp_f32 v195, v195
    s_nop 0
    v_cvt_pk_bf16_f32 v139, v194, v195
    s_waitcnt lgkmcnt(1)
    v_mfma_f32_16x16x32_bf16 v[200:203], v[224:227], v[164:167], v[200:203]
    v_exp_f32 v196, v196
    v_exp_f32 v197, v197
    v_mfma_f32_16x16x32_bf16 v[204:207], v[224:227], v[180:183], v[204:207]
    v_cvt_pk_bf16_f32 v142, v196, v197
    s_waitcnt lgkmcnt(0)
    v_mfma_f32_16x16x32_bf16 v[208:211], v[228:231], v[164:167], v[208:211]
    v_exp_f32 v198, v198
    v_exp_f32 v199, v199
    v_mfma_f32_16x16x32_bf16 v[212:215], v[228:231], v[180:183], v[212:215]
    v_cvt_pk_bf16_f32 v143, v198, v199
    s_waitcnt vmcnt(14)
    s_barrier
    ds_read_b128 v[232:235], v5 offset:0
    ds_read_b128 v[236:239], v5 offset:1024
    ds_read_b128 v[240:243], v5 offset:2048
    ds_read_b128 v[244:247], v5 offset:3072
    v_mfma_f32_16x16x32_bf16 v[248:251], v[12:15], v[136:139], v[248:251]
    v_mfma_f32_16x16x32_bf16 v[252:255], v[12:15], v[140:143], v[252:255]
    v_exp_f32 v200, v200
    v_exp_f32 v201, v201
    s_nop 0
    v_cvt_pk_bf16_f32 v144, v200, v201
    v_exp_f32 v202, v202
    v_exp_f32 v203, v203
    s_nop 0
    v_cvt_pk_bf16_f32 v145, v202, v203
    v_exp_f32 v204, v204
    v_exp_f32 v205, v205
    s_nop 0
    v_cvt_pk_bf16_f32 v148, v204, v205
    v_exp_f32 v206, v206
    v_exp_f32 v207, v207
    s_nop 0
    v_cvt_pk_bf16_f32 v149, v206, v207
    v_exp_f32 v208, v208
    v_exp_f32 v209, v209
    s_nop 0
    v_cvt_pk_bf16_f32 v146, v208, v209
    v_exp_f32 v210, v210
    v_exp_f32 v211, v211
    s_nop 0
    v_cvt_pk_bf16_f32 v147, v210, v211
    v_exp_f32 v212, v212
    v_exp_f32 v213, v213
    s_nop 0
    v_cvt_pk_bf16_f32 v150, v212, v213
    v_exp_f32 v214, v214
    v_exp_f32 v215, v215
    s_nop 0
    v_cvt_pk_bf16_f32 v151, v214, v215
    v_mfma_f32_16x16x32_bf16 v[248:251], v[12:15], v[144:147], v[248:251]
    s_nop 0
    v_mfma_f32_16x16x32_bf16 v[252:255], v[12:15], v[148:151], v[252:255]
    s_nop 5
    v_mov_b32 v9, v248
    s_nop 0
    v_mov_b32 v10, v252
    v_max_f32 v17, v9, v10
    v_readfirstlane_b32 s17, v8
    s_cmp_eq_u32 s17, s28
    s_cselect_b32 s16, 0, 0x71800000
    v_cmp_ngt_f32 vcc, s16, v17
    v_cmp_u_f32 s[76:77], v9, v10
    s_or_b64 vcc, vcc, s[76:77]
    s_cbranch_vccnz adaLN_cond__sliding_block_cached__moe_arch_mod__prompt_kernel_fixB
adaLN_cond__sliding_block_cached__moe_arch_mod__prompt_kernel_fixBb:
    v_rcp_f32 v9, v9
    v_rcp_f32 v10, v10
    s_lshl_b32 s25, s13, 3
    s_add_u32 s25, s25, s3
    s_lshl_b32 s25, s25, 18
    s_lshl_b32 s26, s12, 12
    s_add_u32 s25, s25, s26
    s_add_u32 s25, s25, 0x1000000
    s_add_u32 s26, s25, 131072
    s_lshl_b32 s63, s13, 3
    s_add_u32 s63, s63, s3
    s_lshl_b32 s63, s63, 5
    s_add_u32 s63, s63, s12
    s_lshl_b32 s63, s63, 2
    s_waitcnt lgkmcnt(3)
    v_mfma_f32_16x16x32_bf16 v[184:187], v[232:235], v[24:27], 0
    v_mfma_f32_16x16x32_bf16 v[188:191], v[232:235], v[28:31], 0
    ds_read_b128 v[224:227], v5 offset:4096
    s_waitcnt lgkmcnt(3)
    v_mfma_f32_16x16x32_bf16 v[192:195], v[236:239], v[24:27], 0
    s_add_u32 s22, s21, 0x90000
    s_add_u32 m0, s20, 0x18000
    s_nop 0
    buffer_load_dwordx4 v2, s[8:11], s22 offen sc1 lds
    v_mfma_f32_16x16x32_bf16 v[196:199], v[236:239], v[28:31], 0
    ds_read_b128 v[228:231], v5 offset:5120
    s_waitcnt lgkmcnt(3)
    v_mfma_f32_16x16x32_bf16 v[184:187], v[240:243], v[32:35], v[184:187]
    v_mfma_f32_16x16x32_bf16 v[188:191], v[240:243], v[36:39], v[188:191]
    ds_read_b128 v[232:235], v5 offset:6144
    s_waitcnt lgkmcnt(3)
    v_mfma_f32_16x16x32_bf16 v[192:195], v[244:247], v[32:35], v[192:195]
    v_mfma_f32_16x16x32_bf16 v[196:199], v[244:247], v[36:39], v[196:199]
    ds_read_b128 v[236:239], v5 offset:7168
    s_waitcnt lgkmcnt(3)
    v_mfma_f32_16x16x32_bf16 v[184:187], v[224:227], v[40:43], v[184:187]
    v_mfma_f32_16x16x32_bf16 v[188:191], v[224:227], v[44:47], v[188:191]
    ds_read_b128 v[240:243], v5 offset:8192
    s_waitcnt lgkmcnt(3)
    v_mfma_f32_16x16x32_bf16 v[192:195], v[228:231], v[40:43], v[192:195]
    s_add_u32 s22, s21, 0x90400
    s_add_u32 m0, s20, 0x18400
    s_nop 0
    buffer_load_dwordx4 v2, s[8:11], s22 offen sc1 lds
    v_mfma_f32_16x16x32_bf16 v[196:199], v[228:231], v[44:47], v[196:199]
    ds_read_b128 v[244:247], v5 offset:9216
    s_waitcnt lgkmcnt(3)
    v_mfma_f32_16x16x32_bf16 v[184:187], v[232:235], v[48:51], v[184:187]
    v_mfma_f32_16x16x32_bf16 v[188:191], v[232:235], v[52:55], v[188:191]
    ds_read_b128 v[224:227], v5 offset:10240
    s_waitcnt lgkmcnt(3)
    v_mfma_f32_16x16x32_bf16 v[192:195], v[236:239], v[48:51], v[192:195]
    v_mfma_f32_16x16x32_bf16 v[196:199], v[236:239], v[52:55], v[196:199]
    ds_read_b128 v[228:231], v5 offset:11264
    s_waitcnt lgkmcnt(3)
    v_mfma_f32_16x16x32_bf16 v[184:187], v[240:243], v[56:59], v[184:187]
    v_mfma_f32_16x16x32_bf16 v[188:191], v[240:243], v[60:63], v[188:191]
    ds_read_b128 v[232:235], v5 offset:12288
    s_waitcnt lgkmcnt(3)
    v_mfma_f32_16x16x32_bf16 v[192:195], v[244:247], v[56:59], v[192:195]
    v_mfma_f32_16x16x32_bf16 v[196:199], v[244:247], v[60:63], v[196:199]
    ds_read_b128 v[236:239], v5 offset:13312
    s_waitcnt lgkmcnt(3)
    v_mfma_f32_16x16x32_bf16 v[184:187], v[224:227], v[64:67], v[184:187]
    v_mfma_f32_16x16x32_bf16 v[188:191], v[224:227], v[68:71], v[188:191]
    ds_read_b128 v[240:243], v5 offset:14336
    s_waitcnt lgkmcnt(3)
    v_mfma_f32_16x16x32_bf16 v[192:195], v[228:231], v[64:67], v[192:195]
    v_mfma_f32_16x16x32_bf16 v[196:199], v[228:231], v[68:71], v[196:199]
    ds_read_b128 v[244:247], v5 offset:15360
    s_waitcnt lgkmcnt(3)
    v_mfma_f32_16x16x32_bf16 v[184:187], v[232:235], v[72:75], v[184:187]
    v_mfma_f32_16x16x32_bf16 v[188:191], v[232:235], v[76:79], v[188:191]
    s_waitcnt vmcnt(12)
    s_barrier
    ds_read_b128 v[224:227], v5 offset:16384
    s_waitcnt lgkmcnt(3)
    v_mfma_f32_16x16x32_bf16 v[192:195], v[236:239], v[72:75], v[192:195]
    v_mfma_f32_16x16x32_bf16 v[196:199], v[236:239], v[76:79], v[196:199]
    s_add_u32 s22, s21, 0x94000
    s_add_u32 m0, s20, 0x1c000
    s_nop 0
    buffer_load_dwordx4 v2, s[8:11], s22 offen sc1 lds
    ds_read_b128 v[228:231], v5 offset:17408
    s_waitcnt lgkmcnt(3)
    v_mfma_f32_16x16x32_bf16 v[184:187], v[240:243], v[80:83], v[184:187]
    v_mfma_f32_16x16x32_bf16 v[188:191], v[240:243], v[84:87], v[188:191]
    ds_read_b128 v[232:235], v5 offset:18432
    s_waitcnt lgkmcnt(3)
    v_mfma_f32_16x16x32_bf16 v[192:195], v[244:247], v[80:83], v[192:195]
    v_mfma_f32_16x16x32_bf16 v[196:199], v[244:247], v[84:87], v[196:199]
    ds_read_b128 v[236:239], v5 offset:19456
    s_waitcnt lgkmcnt(3)
    v_mfma_f32_16x16x32_bf16 v[184:187], v[224:227], v[88:91], v[184:187]
    v_mfma_f32_16x16x32_bf16 v[188:191], v[224:227], v[92:95], v[188:191]
    ds_read_b128 v[240:243], v5 offset:20480
    s_waitcnt lgkmcnt(3)
    v_mfma_f32_16x16x32_bf16 v[192:195], v[228:231], v[88:91], v[192:195]
    v_mfma_f32_16x16x32_bf16 v[196:199], v[228:231], v[92:95], v[196:199]
    s_add_u32 s22, s21, 0x94400
    s_add_u32 m0, s20, 0x1c400
    s_nop 0
    buffer_load_dwordx4 v2, s[8:11], s22 offen sc1 lds
    ds_read_b128 v[244:247], v5 offset:21504
    s_waitcnt lgkmcnt(3)
    v_mfma_f32_16x16x32_bf16 v[184:187], v[232:235], v[96:99], v[184:187]
    v_mfma_f32_16x16x32_bf16 v[188:191], v[232:235], v[100:103], v[188:191]
    ds_read_b128 v[224:227], v5 offset:22528
    s_waitcnt lgkmcnt(3)
    v_mfma_f32_16x16x32_bf16 v[192:195], v[236:239], v[96:99], v[192:195]
    v_mfma_f32_16x16x32_bf16 v[196:199], v[236:239], v[100:103], v[196:199]
    ds_read_b128 v[228:231], v5 offset:23552
    s_waitcnt lgkmcnt(3)
    v_mfma_f32_16x16x32_bf16 v[184:187], v[240:243], v[104:107], v[184:187]
    v_mfma_f32_16x16x32_bf16 v[188:191], v[240:243], v[108:111], v[188:191]
    ds_read_b128 v[232:235], v5 offset:24576
    s_waitcnt lgkmcnt(3)
    v_mfma_f32_16x16x32_bf16 v[192:195], v[244:247], v[104:107], v[192:195]
    v_mfma_f32_16x16x32_bf16 v[196:199], v[244:247], v[108:111], v[196:199]
    ds_read_b128 v[236:239], v5 offset:25600
    s_waitcnt lgkmcnt(3)
    v_mfma_f32_16x16x32_bf16 v[184:187], v[224:227], v[112:115], v[184:187]
    v_mfma_f32_16x16x32_bf16 v[188:191], v[224:227], v[116:119], v[188:191]
    ds_read_b128 v[240:243], v5 offset:26624
    s_waitcnt lgkmcnt(3)
    v_mfma_f32_16x16x32_bf16 v[192:195], v[228:231], v[112:115], v[192:195]
    v_mfma_f32_16x16x32_bf16 v[196:199], v[228:231], v[116:119], v[196:199]
    ds_read_b128 v[244:247], v5 offset:27648
    s_waitcnt lgkmcnt(3)
    v_mfma_f32_16x16x32_bf16 v[184:187], v[232:235], v[120:123], v[184:187]
    v_mfma_f32_16x16x32_bf16 v[188:191], v[232:235], v[124:127], v[188:191]
    ds_read_b128 v[224:227], v5 offset:28672
    s_waitcnt lgkmcnt(3)
    v_mfma_f32_16x16x32_bf16 v[192:195], v[236:239], v[120:123], v[192:195]
    v_mfma_f32_16x16x32_bf16 v[196:199], v[236:239], v[124:127], v[196:199]
    ds_read_b128 v[228:231], v5 offset:29696
    s_waitcnt lgkmcnt(3)
    v_mfma_f32_16x16x32_bf16 v[184:187], v[240:243], v[128:131], v[184:187]
    v_mfma_f32_16x16x32_bf16 v[188:191], v[240:243], v[132:135], v[188:191]
    ds_read_b128 v[232:235], v5 offset:30720
    s_waitcnt lgkmcnt(3)
    v_mfma_f32_16x16x32_bf16 v[192:195], v[244:247], v[128:131], v[192:195]
    v_mfma_f32_16x16x32_bf16 v[196:199], v[244:247], v[132:135], v[196:199]
    ds_read_b128 v[236:239], v5 offset:31744
    s_waitcnt lgkmcnt(3)
    v_mfma_f32_16x16x32_bf16 v[184:187], v[224:227], v[136:139], v[184:187]
    v_mfma_f32_16x16x32_bf16 v[188:191], v[224:227], v[140:143], v[188:191]
    s_waitcnt vmcnt(9)
    s_barrier
    ds_read_b128 v[240:243], v4 offset:0
    s_waitcnt lgkmcnt(3)
    v_mfma_f32_16x16x32_bf16 v[192:195], v[228:231], v[136:139], v[192:195]
    v_mfma_f32_16x16x32_bf16 v[196:199], v[228:231], v[140:143], v[196:199]
    s_add_u32 s22, s21, 0x98000
    s_add_u32 m0, s20, 0x20000
    s_nop 0
    buffer_load_dwordx4 v2, s[8:11], s22 offen sc1 lds
    ds_read_b128 v[244:247], v4 offset:1024
    s_waitcnt lgkmcnt(3)
    v_mfma_f32_16x16x32_bf16 v[184:187], v[232:235], v[144:147], v[184:187]
    v_mfma_f32_16x16x32_bf16 v[188:191], v[232:235], v[148:151], v[188:191]
    ds_read_b128 v[224:227], v4 offset:2048
    s_waitcnt lgkmcnt(3)
    v_mfma_f32_16x16x32_bf16 v[192:195], v[236:239], v[144:147], v[192:195]
    v_mfma_f32_16x16x32_bf16 v[196:199], v[236:239], v[148:151], v[196:199]
    ds_read_b128 v[228:231], v4 offset:3072
    s_waitcnt lgkmcnt(3)
    v_mfma_f32_16x16x32_bf16 v[200:203], v[240:243], v[24:27], 0
    v_mfma_f32_16x16x32_bf16 v[204:207], v[240:243], v[28:31], 0
    ds_read_b128 v[232:235], v4 offset:4096
    s_waitcnt lgkmcnt(3)
    v_mfma_f32_16x16x32_bf16 v[208:211], v[244:247], v[24:27], 0
    v_mfma_f32_16x16x32_bf16 v[212:215], v[244:247], v[28:31], 0
    s_add_u32 s22, s21, 0x98400
    s_add_u32 m0, s20, 0x20400
    s_nop 0
    buffer_load_dwordx4 v2, s[8:11], s22 offen sc1 lds
    ds_read_b128 v[236:239], v4 offset:5120
    v_mul_f32 v184, v184, v9
    s_waitcnt lgkmcnt(3)
    v_mfma_f32_16x16x32_bf16 v[200:203], v[224:227], v[32:35], v[200:203]
    v_mul_f32 v185, v185, v9
    v_mfma_f32_16x16x32_bf16 v[204:207], v[224:227], v[36:39], v[204:207]
    ds_read_b128 v[240:243], v4 offset:6144
    v_mul_f32 v186, v186, v9
    s_waitcnt lgkmcnt(3)
    v_mfma_f32_16x16x32_bf16 v[208:211], v[228:231], v[32:35], v[208:211]
    v_mul_f32 v187, v187, v9
    v_mfma_f32_16x16x32_bf16 v[212:215], v[228:231], v[36:39], v[212:215]
    ds_read_b128 v[244:247], v4 offset:7168
    v_mul_f32 v192, v192, v9
    s_waitcnt lgkmcnt(3)
    v_mfma_f32_16x16x32_bf16 v[200:203], v[232:235], v[40:43], v[200:203]
    v_mul_f32 v193, v193, v9
    v_mfma_f32_16x16x32_bf16 v[204:207], v[232:235], v[44:47], v[204:207]
    ds_read_b128 v[224:227], v4 offset:8192
    v_mul_f32 v194, v194, v9
    s_waitcnt lgkmcnt(3)
    v_mfma_f32_16x16x32_bf16 v[208:211], v[236:239], v[40:43], v[208:211]
    v_mul_f32 v195, v195, v9
    v_mfma_f32_16x16x32_bf16 v[212:215], v[236:239], v[44:47], v[212:215]
    ds_read_b128 v[228:231], v4 offset:9216
    v_cvt_pk_bf16_f32 v216, v184, v185
    s_waitcnt lgkmcnt(3)
    v_mfma_f32_16x16x32_bf16 v[200:203], v[240:243], v[48:51], v[200:203]
    v_cvt_pk_bf16_f32 v217, v186, v187
    v_mfma_f32_16x16x32_bf16 v[204:207], v[240:243], v[52:55], v[204:207]
    ds_read_b128 v[232:235], v4 offset:10240
    v_cvt_pk_bf16_f32 v218, v192, v193
    s_waitcnt lgkmcnt(3)
    v_mfma_f32_16x16x32_bf16 v[208:211], v[244:247], v[48:51], v[208:211]
    v_cvt_pk_bf16_f32 v219, v194, v195
    v_mfma_f32_16x16x32_bf16 v[212:215], v[244:247], v[52:55], v[212:215]
    ds_read_b128 v[236:239], v4 offset:11264
    buffer_store_dwordx4 v[216:219], v2, s[8:11], s25 offen offset:0 sc1
    s_waitcnt lgkmcnt(3)
    v_mfma_f32_16x16x32_bf16 v[200:203], v[224:227], v[56:59], v[200:203]
    v_mul_f32 v188, v188, v10
    v_mfma_f32_16x16x32_bf16 v[204:207], v[224:227], v[60:63], v[204:207]
    ds_read_b128 v[240:243], v4 offset:12288
    v_mul_f32 v189, v189, v10
    s_waitcnt lgkmcnt(3)
    v_mfma_f32_16x16x32_bf16 v[208:211], v[228:231], v[56:59], v[208:211]
    v_mul_f32 v190, v190, v10
    v_mfma_f32_16x16x32_bf16 v[212:215], v[228:231], v[60:63], v[212:215]
    ds_read_b128 v[244:247], v4 offset:13312
    v_mul_f32 v191, v191, v10
    s_waitcnt lgkmcnt(3)
    v_mfma_f32_16x16x32_bf16 v[200:203], v[232:235], v[64:67], v[200:203]
    v_mul_f32 v196, v196, v10
    v_mfma_f32_16x16x32_bf16 v[204:207], v[232:235], v[68:71], v[204:207]
    ds_read_b128 v[224:227], v4 offset:14336
    v_mul_f32 v197, v197, v10
    s_waitcnt lgkmcnt(3)
    v_mfma_f32_16x16x32_bf16 v[208:211], v[236:239], v[64:67], v[208:211]
    v_mul_f32 v198, v198, v10
    v_mfma_f32_16x16x32_bf16 v[212:215], v[236:239], v[68:71], v[212:215]
    ds_read_b128 v[228:231], v4 offset:15360
    v_mul_f32 v199, v199, v10
    s_waitcnt lgkmcnt(3)
    v_mfma_f32_16x16x32_bf16 v[200:203], v[240:243], v[72:75], v[200:203]
    v_cvt_pk_bf16_f32 v220, v188, v189
    v_mfma_f32_16x16x32_bf16 v[204:207], v[240:243], v[76:79], v[204:207]
    s_waitcnt vmcnt(8)
    s_barrier
    ds_read_b128 v[232:235], v4 offset:16384
    v_cvt_pk_bf16_f32 v221, v190, v191
    s_waitcnt lgkmcnt(3)
    v_mfma_f32_16x16x32_bf16 v[208:211], v[244:247], v[72:75], v[208:211]
    v_cvt_pk_bf16_f32 v222, v196, v197
    v_mfma_f32_16x16x32_bf16 v[212:215], v[244:247], v[76:79], v[212:215]
    s_add_u32 s22, s21, 0x9c000
    s_add_u32 m0, s20, 0x24000
    s_nop 0
    buffer_load_dwordx4 v2, s[8:11], s22 offen sc1 lds
    ds_read_b128 v[236:239], v4 offset:17408
    v_cvt_pk_bf16_f32 v223, v198, v199
    s_waitcnt lgkmcnt(3)
    v_mfma_f32_16x16x32_bf16 v[200:203], v[224:227], v[80:83], v[200:203]
    buffer_store_dwordx4 v[220:223], v2, s[8:11], s26 offen offset:0 sc1
    v_mfma_f32_16x16x32_bf16 v[204:207], v[224:227], v[84:87], v[204:207]
    ds_read_b128 v[240:243], v4 offset:18432
    s_waitcnt lgkmcnt(3)
    v_mfma_f32_16x16x32_bf16 v[208:211], v[228:231], v[80:83], v[208:211]
    v_mfma_f32_16x16x32_bf16 v[212:215], v[228:231], v[84:87], v[212:215]
    ds_read_b128 v[244:247], v4 offset:19456
    s_waitcnt lgkmcnt(3)
    v_mfma_f32_16x16x32_bf16 v[200:203], v[232:235], v[88:91], v[200:203]
    v_mfma_f32_16x16x32_bf16 v[204:207], v[232:235], v[92:95], v[204:207]
    ds_read_b128 v[224:227], v4 offset:20480
    s_waitcnt lgkmcnt(3)
    v_mfma_f32_16x16x32_bf16 v[208:211], v[236:239], v[88:91], v[208:211]
    v_mfma_f32_16x16x32_bf16 v[212:215], v[236:239], v[92:95], v[212:215]
    s_add_u32 s22, s21, 0x9c400
    s_add_u32 m0, s20, 0x24400
    s_nop 0
    buffer_load_dwordx4 v2, s[8:11], s22 offen sc1 lds
    ds_read_b128 v[228:231], v4 offset:21504
    s_waitcnt lgkmcnt(3)
    v_mfma_f32_16x16x32_bf16 v[200:203], v[240:243], v[96:99], v[200:203]
    v_mfma_f32_16x16x32_bf16 v[204:207], v[240:243], v[100:103], v[204:207]
    ds_read_b128 v[232:235], v4 offset:22528
    s_waitcnt lgkmcnt(3)
    v_mfma_f32_16x16x32_bf16 v[208:211], v[244:247], v[96:99], v[208:211]
    v_mfma_f32_16x16x32_bf16 v[212:215], v[244:247], v[100:103], v[212:215]
    ds_read_b128 v[236:239], v4 offset:23552
    s_waitcnt lgkmcnt(3)
    v_mfma_f32_16x16x32_bf16 v[200:203], v[224:227], v[104:107], v[200:203]
    v_mfma_f32_16x16x32_bf16 v[204:207], v[224:227], v[108:111], v[204:207]
    ds_read_b128 v[240:243], v4 offset:24576
    s_waitcnt lgkmcnt(3)
    v_mfma_f32_16x16x32_bf16 v[208:211], v[228:231], v[104:107], v[208:211]
    v_mfma_f32_16x16x32_bf16 v[212:215], v[228:231], v[108:111], v[212:215]
    ds_read_b128 v[244:247], v4 offset:25600
    s_waitcnt lgkmcnt(3)
    v_mfma_f32_16x16x32_bf16 v[200:203], v[232:235], v[112:115], v[200:203]
    v_mfma_f32_16x16x32_bf16 v[204:207], v[232:235], v[116:119], v[204:207]
    ds_read_b128 v[224:227], v4 offset:26624
    s_waitcnt lgkmcnt(3)
    v_mfma_f32_16x16x32_bf16 v[208:211], v[236:239], v[112:115], v[208:211]
    v_mfma_f32_16x16x32_bf16 v[212:215], v[236:239], v[116:119], v[212:215]
    ds_read_b128 v[228:231], v4 offset:27648
    s_waitcnt lgkmcnt(3)
    v_mfma_f32_16x16x32_bf16 v[200:203], v[240:243], v[120:123], v[200:203]
    v_mfma_f32_16x16x32_bf16 v[204:207], v[240:243], v[124:127], v[204:207]
    ds_read_b128 v[232:235], v4 offset:28672
    s_waitcnt lgkmcnt(3)
    v_mfma_f32_16x16x32_bf16 v[208:211], v[244:247], v[120:123], v[208:211]
    v_mfma_f32_16x16x32_bf16 v[212:215], v[244:247], v[124:127], v[212:215]
    ds_read_b128 v[236:239], v4 offset:29696
    s_waitcnt lgkmcnt(3)
    v_mfma_f32_16x16x32_bf16 v[200:203], v[224:227], v[128:131], v[200:203]
    v_mfma_f32_16x16x32_bf16 v[204:207], v[224:227], v[132:135], v[204:207]
    ds_read_b128 v[240:243], v4 offset:30720
    s_waitcnt lgkmcnt(3)
    v_mfma_f32_16x16x32_bf16 v[208:211], v[228:231], v[128:131], v[208:211]
    v_mfma_f32_16x16x32_bf16 v[212:215], v[228:231], v[132:135], v[212:215]
    ds_read_b128 v[244:247], v4 offset:31744
    s_waitcnt lgkmcnt(3)
    v_mfma_f32_16x16x32_bf16 v[200:203], v[232:235], v[136:139], v[200:203]
    v_mfma_f32_16x16x32_bf16 v[204:207], v[232:235], v[140:143], v[204:207]
    s_waitcnt vmcnt(8)
    s_barrier
    ds_read_b128 v[224:227], v4 offset:32768
    s_waitcnt lgkmcnt(3)
    v_mfma_f32_16x16x32_bf16 v[208:211], v[236:239], v[136:139], v[208:211]
    v_mfma_f32_16x16x32_bf16 v[212:215], v[236:239], v[140:143], v[212:215]
    s_add_u32 s22, s24, 0x0
    s_add_u32 m0, s20, 0x10000
    s_nop 0
    buffer_load_dwordx4 v3, s[4:7], s22 offen lds
    ds_read_b128 v[228:231], v4 offset:33792
    s_waitcnt lgkmcnt(3)
    v_mfma_f32_16x16x32_bf16 v[200:203], v[240:243], v[144:147], v[200:203]
    v_mfma_f32_16x16x32_bf16 v[204:207], v[240:243], v[148:151], v[204:207]
    ds_read_b128 v[232:235], v4 offset:34816
    s_waitcnt lgkmcnt(3)
    v_mfma_f32_16x16x32_bf16 v[208:211], v[244:247], v[144:147], v[208:211]
    v_mfma_f32_16x16x32_bf16 v[212:215], v[244:247], v[148:151], v[212:215]
    ds_read_b128 v[236:239], v4 offset:35840
    s_waitcnt lgkmcnt(3)
    v_mfma_f32_16x16x32_bf16 v[184:187], v[224:227], v[24:27], 0
    v_mfma_f32_16x16x32_bf16 v[188:191], v[224:227], v[28:31], 0
    ds_read_b128 v[240:243], v4 offset:36864
    s_waitcnt lgkmcnt(3)
    v_mfma_f32_16x16x32_bf16 v[192:195], v[228:231], v[24:27], 0
    v_mfma_f32_16x16x32_bf16 v[196:199], v[228:231], v[28:31], 0
    s_add_u32 s22, s24, 0x2000
    s_add_u32 m0, s20, 0x10400
    s_nop 0
    buffer_load_dwordx4 v3, s[4:7], s22 offen lds
    ds_read_b128 v[244:247], v4 offset:37888
    v_mul_f32 v200, v200, v9
    s_waitcnt lgkmcnt(3)
    v_mfma_f32_16x16x32_bf16 v[184:187], v[232:235], v[32:35], v[184:187]
    v_mul_f32 v201, v201, v9
    v_mfma_f32_16x16x32_bf16 v[188:191], v[232:235], v[36:39], v[188:191]
    ds_read_b128 v[224:227], v4 offset:38912
    v_mul_f32 v202, v202, v9
    s_waitcnt lgkmcnt(3)
    v_mfma_f32_16x16x32_bf16 v[192:195], v[236:239], v[32:35], v[192:195]
    v_mul_f32 v203, v203, v9
    v_mfma_f32_16x16x32_bf16 v[196:199], v[236:239], v[36:39], v[196:199]
    ds_read_b128 v[228:231], v4 offset:39936
    v_mul_f32 v208, v208, v9
    s_waitcnt lgkmcnt(3)
    v_mfma_f32_16x16x32_bf16 v[184:187], v[240:243], v[40:43], v[184:187]
    v_mul_f32 v209, v209, v9
    v_mfma_f32_16x16x32_bf16 v[188:191], v[240:243], v[44:47], v[188:191]
    ds_read_b128 v[232:235], v4 offset:40960
    v_mul_f32 v210, v210, v9
    s_waitcnt lgkmcnt(3)
    v_mfma_f32_16x16x32_bf16 v[192:195], v[244:247], v[40:43], v[192:195]
    v_mul_f32 v211, v211, v9
    v_mfma_f32_16x16x32_bf16 v[196:199], v[244:247], v[44:47], v[196:199]
    ds_read_b128 v[236:239], v4 offset:41984
    v_cvt_pk_bf16_f32 v216, v200, v201
    s_waitcnt lgkmcnt(3)
    v_mfma_f32_16x16x32_bf16 v[184:187], v[224:227], v[48:51], v[184:187]
    v_cvt_pk_bf16_f32 v217, v202, v203
    s_waitcnt vmcnt(3)
    s_add_u32 s16, s63, 0x570000
    v_mov_b32 v7, s28
    v_mov_b32 v8, 0
    s_mov_b64 exec, 1
    buffer_store_dword v7, v8, s[8:11], s16 offen sc1
    s_mov_b64 exec, -1
    v_mfma_f32_16x16x32_bf16 v[188:191], v[224:227], v[52:55], v[188:191]
    ds_read_b128 v[240:243], v4 offset:43008
    v_cvt_pk_bf16_f32 v218, v208, v209
    s_waitcnt lgkmcnt(3)
    v_mfma_f32_16x16x32_bf16 v[192:195], v[228:231], v[48:51], v[192:195]
    v_cvt_pk_bf16_f32 v219, v210, v211
    v_mfma_f32_16x16x32_bf16 v[196:199], v[228:231], v[52:55], v[196:199]
    ds_read_b128 v[244:247], v4 offset:44032
    buffer_store_dwordx4 v[216:219], v2, s[8:11], s25 offen offset:1024 sc1
    s_waitcnt lgkmcnt(3)
    v_mfma_f32_16x16x32_bf16 v[184:187], v[232:235], v[56:59], v[184:187]
    v_mul_f32 v204, v204, v10
    v_mfma_f32_16x16x32_bf16 v[188:191], v[232:235], v[60:63], v[188:191]
    ds_read_b128 v[224:227], v4 offset:45056
    v_mul_f32 v205, v205, v10
    s_waitcnt lgkmcnt(3)
    v_mfma_f32_16x16x32_bf16 v[192:195], v[236:239], v[56:59], v[192:195]
    v_mul_f32 v206, v206, v10
    v_mfma_f32_16x16x32_bf16 v[196:199], v[236:239], v[60:63], v[196:199]
    ds_read_b128 v[228:231], v4 offset:46080
    v_mul_f32 v207, v207, v10
    s_waitcnt lgkmcnt(3)
    v_mfma_f32_16x16x32_bf16 v[184:187], v[240:243], v[64:67], v[184:187]
    v_mul_f32 v212, v212, v10
    v_mfma_f32_16x16x32_bf16 v[188:191], v[240:243], v[68:71], v[188:191]
    ds_read_b128 v[232:235], v4 offset:47104
    v_mul_f32 v213, v213, v10
    s_waitcnt lgkmcnt(3)
    v_mfma_f32_16x16x32_bf16 v[192:195], v[244:247], v[64:67], v[192:195]
    v_mul_f32 v214, v214, v10
    v_mfma_f32_16x16x32_bf16 v[196:199], v[244:247], v[68:71], v[196:199]
    ds_read_b128 v[236:239], v4 offset:48128
    v_mul_f32 v215, v215, v10
    s_waitcnt lgkmcnt(3)
    v_mfma_f32_16x16x32_bf16 v[184:187], v[224:227], v[72:75], v[184:187]
    v_cvt_pk_bf16_f32 v220, v204, v205
    v_mfma_f32_16x16x32_bf16 v[188:191], v[224:227], v[76:79], v[188:191]
    s_barrier
    ds_read_b128 v[240:243], v4 offset:49152
    v_cvt_pk_bf16_f32 v221, v206, v207
    s_waitcnt lgkmcnt(3)
    v_mfma_f32_16x16x32_bf16 v[192:195], v[228:231], v[72:75], v[192:195]
    v_cvt_pk_bf16_f32 v222, v212, v213
    v_mfma_f32_16x16x32_bf16 v[196:199], v[228:231], v[76:79], v[196:199]
    s_add_u32 s22, s24, 0x80000
    s_add_u32 m0, s20, 0x14000
    s_nop 0
    buffer_load_dwordx4 v3, s[4:7], s22 offen lds
    ds_read_b128 v[244:247], v4 offset:50176
    v_cvt_pk_bf16_f32 v223, v214, v215
    s_waitcnt lgkmcnt(3)
    v_mfma_f32_16x16x32_bf16 v[184:187], v[232:235], v[80:83], v[184:187]
    buffer_store_dwordx4 v[220:223], v2, s[8:11], s26 offen offset:1024 sc1
    v_mfma_f32_16x16x32_bf16 v[188:191], v[232:235], v[84:87], v[188:191]
    ds_read_b128 v[224:227], v4 offset:51200
    s_waitcnt lgkmcnt(3)
    v_mfma_f32_16x16x32_bf16 v[192:195], v[236:239], v[80:83], v[192:195]
    v_mfma_f32_16x16x32_bf16 v[196:199], v[236:239], v[84:87], v[196:199]
    ds_read_b128 v[228:231], v4 offset:52224
    s_waitcnt lgkmcnt(3)
    v_mfma_f32_16x16x32_bf16 v[184:187], v[240:243], v[88:91], v[184:187]
    v_mfma_f32_16x16x32_bf16 v[188:191], v[240:243], v[92:95], v[188:191]
    ds_read_b128 v[232:235], v4 offset:53248
    s_waitcnt lgkmcnt(3)
    v_mfma_f32_16x16x32_bf16 v[192:195], v[244:247], v[88:91], v[192:195]
    v_mfma_f32_16x16x32_bf16 v[196:199], v[244:247], v[92:95], v[196:199]
    s_add_u32 s22, s24, 0x82000
    s_add_u32 m0, s20, 0x14400
    s_nop 0
    buffer_load_dwordx4 v3, s[4:7], s22 offen lds
    ds_read_b128 v[236:239], v4 offset:54272
    s_waitcnt lgkmcnt(3)
    v_mfma_f32_16x16x32_bf16 v[184:187], v[224:227], v[96:99], v[184:187]
    v_mfma_f32_16x16x32_bf16 v[188:191], v[224:227], v[100:103], v[188:191]
    ds_read_b128 v[240:243], v4 offset:55296
    s_waitcnt lgkmcnt(3)
    v_mfma_f32_16x16x32_bf16 v[192:195], v[228:231], v[96:99], v[192:195]
    v_mfma_f32_16x16x32_bf16 v[196:199], v[228:231], v[100:103], v[196:199]
    ds_read_b128 v[244:247], v4 offset:56320
    s_waitcnt lgkmcnt(3)
    v_mfma_f32_16x16x32_bf16 v[184:187], v[232:235], v[104:107], v[184:187]
    v_mfma_f32_16x16x32_bf16 v[188:191], v[232:235], v[108:111], v[188:191]
    ds_read_b128 v[224:227], v4 offset:57344
    s_waitcnt lgkmcnt(3)
    v_mfma_f32_16x16x32_bf16 v[192:195], v[236:239], v[104:107], v[192:195]
    v_mfma_f32_16x16x32_bf16 v[196:199], v[236:239], v[108:111], v[196:199]
    ds_read_b128 v[228:231], v4 offset:58368
    s_waitcnt lgkmcnt(3)
    v_mfma_f32_16x16x32_bf16 v[184:187], v[240:243], v[112:115], v[184:187]
    v_mfma_f32_16x16x32_bf16 v[188:191], v[240:243], v[116:119], v[188:191]
    ds_read_b128 v[232:235], v4 offset:59392
    s_waitcnt lgkmcnt(3)
    v_mfma_f32_16x16x32_bf16 v[192:195], v[244:247], v[112:115], v[192:195]
    v_mfma_f32_16x16x32_bf16 v[196:199], v[244:247], v[116:119], v[196:199]
    ds_read_b128 v[236:239], v4 offset:60416
    s_waitcnt lgkmcnt(3)
    v_mfma_f32_16x16x32_bf16 v[184:187], v[224:227], v[120:123], v[184:187]
    v_mfma_f32_16x16x32_bf16 v[188:191], v[224:227], v[124:127], v[188:191]
    ds_read_b128 v[240:243], v4 offset:61440
    s_waitcnt lgkmcnt(3)
    v_mfma_f32_16x16x32_bf16 v[192:195], v[228:231], v[120:123], v[192:195]
    v_mfma_f32_16x16x32_bf16 v[196:199], v[228:231], v[124:127], v[196:199]
    ds_read_b128 v[244:247], v4 offset:62464
    s_waitcnt lgkmcnt(3)
    v_mfma_f32_16x16x32_bf16 v[184:187], v[232:235], v[128:131], v[184:187]
    v_mfma_f32_16x16x32_bf16 v[188:191], v[232:235], v[132:135], v[188:191]
    ds_read_b128 v[224:227], v4 offset:63488
    s_waitcnt lgkmcnt(3)
    v_mfma_f32_16x16x32_bf16 v[192:195], v[236:239], v[128:131], v[192:195]
    v_mfma_f32_16x16x32_bf16 v[196:199], v[236:239], v[132:135], v[196:199]
    ds_read_b128 v[228:231], v4 offset:64512
    s_waitcnt lgkmcnt(3)
    v_mfma_f32_16x16x32_bf16 v[184:187], v[240:243], v[136:139], v[184:187]
    v_mfma_f32_16x16x32_bf16 v[188:191], v[240:243], v[140:143], v[188:191]
    s_barrier
    ds_read_b128 v[232:235], v5 offset:0
    s_waitcnt lgkmcnt(3)
    v_mfma_f32_16x16x32_bf16 v[192:195], v[244:247], v[136:139], v[192:195]
    v_mfma_f32_16x16x32_bf16 v[196:199], v[244:247], v[140:143], v[196:199]
    s_add_u32 s22, s24, 0x100000
    s_add_u32 m0, s20, 0x18000
    s_nop 0
    buffer_load_dwordx4 v3, s[4:7], s22 offen lds
    ds_read_b128 v[236:239], v5 offset:1024
    s_waitcnt lgkmcnt(3)
    v_mfma_f32_16x16x32_bf16 v[184:187], v[224:227], v[144:147], v[184:187]
    v_mfma_f32_16x16x32_bf16 v[188:191], v[224:227], v[148:151], v[188:191]
    ds_read_b128 v[240:243], v5 offset:2048
    s_waitcnt lgkmcnt(3)
    v_mfma_f32_16x16x32_bf16 v[192:195], v[228:231], v[144:147], v[192:195]
    v_mfma_f32_16x16x32_bf16 v[196:199], v[228:231], v[148:151], v[196:199]
    ds_read_b128 v[244:247], v5 offset:3072
    s_waitcnt lgkmcnt(3)
    v_mfma_f32_16x16x32_bf16 v[200:203], v[232:235], v[24:27], 0
    v_mfma_f32_16x16x32_bf16 v[204:207], v[232:235], v[28:31], 0
    ds_read_b128 v[224:227], v5 offset:4096
    s_waitcnt lgkmcnt(3)
    v_mfma_f32_16x16x32_bf16 v[208:211], v[236:239], v[24:27], 0
    v_mfma_f32_16x16x32_bf16 v[212:215], v[236:239], v[28:31], 0
    s_add_u32 s22, s24, 0x102000
    s_add_u32 m0, s20, 0x18400
    s_nop 0
    buffer_load_dwordx4 v3, s[4:7], s22 offen lds
    ds_read_b128 v[228:231], v5 offset:5120
    v_mul_f32 v184, v184, v9
    s_waitcnt lgkmcnt(3)
    v_mfma_f32_16x16x32_bf16 v[200:203], v[240:243], v[32:35], v[200:203]
    v_mul_f32 v185, v185, v9
    s_bfe_u32 s30, s2, 0x20001
    s_lshl_b32 s30, s30, 2
    s_bfe_u32 s17, s2, 0x20003
    s_add_u32 s30, s30, s17
    s_lshr_b32 s31, s2, 5
    s_and_b32 s17, s3, 3
    s_lshl_b32 s19, s30, 2
    s_add_u32 s19, s19, s17
    s_and_b32 s16, s2, 1
    s_lshl_b32 s17, s19, 18
    s_lshl_b32 s23, s16, 16
    s_add_u32 s17, s17, s23
    s_add_u32 s17, s17, 0x1001000
    v_add_u32 v6, s17, v2
    s_lshl_b32 s19, s19, 7
    s_lshl_b32 s23, s16, 6
    s_add_u32 s19, s19, s23
    s_add_u32 s19, s19, 0x570000
    v_and_b32 v13, 15, v1
    v_lshlrev_b32 v13, 2, v13
    buffer_load_dword v12, v13, s[8:11], s19 offen sc1
    v_mfma_f32_16x16x32_bf16 v[204:207], v[240:243], v[36:39], v[204:207]
    ds_read_b128 v[232:235], v5 offset:6144
    v_mul_f32 v186, v186, v9
    s_waitcnt lgkmcnt(3)
    v_mfma_f32_16x16x32_bf16 v[208:211], v[244:247], v[32:35], v[208:211]
    v_mul_f32 v187, v187, v9
    v_mfma_f32_16x16x32_bf16 v[212:215], v[244:247], v[36:39], v[212:215]
    ds_read_b128 v[236:239], v5 offset:7168
    v_mul_f32 v192, v192, v9
    s_waitcnt lgkmcnt(3)
    v_mfma_f32_16x16x32_bf16 v[200:203], v[224:227], v[40:43], v[200:203]
    v_mul_f32 v193, v193, v9
    v_mfma_f32_16x16x32_bf16 v[204:207], v[224:227], v[44:47], v[204:207]
    ds_read_b128 v[240:243], v5 offset:8192
    v_mul_f32 v194, v194, v9
    s_waitcnt lgkmcnt(3)
    v_mfma_f32_16x16x32_bf16 v[208:211], v[228:231], v[40:43], v[208:211]
    v_mul_f32 v195, v195, v9
    v_mfma_f32_16x16x32_bf16 v[212:215], v[228:231], v[44:47], v[212:215]
    ds_read_b128 v[244:247], v5 offset:9216
    v_cvt_pk_bf16_f32 v216, v184, v185
    s_waitcnt lgkmcnt(3)
    v_mfma_f32_16x16x32_bf16 v[200:203], v[232:235], v[48:51], v[200:203]
    v_cvt_pk_bf16_f32 v217, v186, v187
    v_mfma_f32_16x16x32_bf16 v[204:207], v[232:235], v[52:55], v[204:207]
    ds_read_b128 v[224:227], v5 offset:10240
    v_cvt_pk_bf16_f32 v218, v192, v193
    s_waitcnt lgkmcnt(3)
    v_mfma_f32_16x16x32_bf16 v[208:211], v[236:239], v[48:51], v[208:211]
    v_cvt_pk_bf16_f32 v219, v194, v195
    v_mfma_f32_16x16x32_bf16 v[212:215], v[236:239], v[52:55], v[212:215]
    ds_read_b128 v[228:231], v5 offset:11264
    buffer_store_dwordx4 v[216:219], v2, s[8:11], s25 offen offset:2048 sc1
    s_waitcnt lgkmcnt(3)
    v_mfma_f32_16x16x32_bf16 v[200:203], v[240:243], v[56:59], v[200:203]
    v_mul_f32 v188, v188, v10
    v_mfma_f32_16x16x32_bf16 v[204:207], v[240:243], v[60:63], v[204:207]
    ds_read_b128 v[232:235], v5 offset:12288
    v_mul_f32 v189, v189, v10
    s_waitcnt lgkmcnt(3)
    v_mfma_f32_16x16x32_bf16 v[208:211], v[244:247], v[56:59], v[208:211]
    v_mul_f32 v190, v190, v10
    v_mfma_f32_16x16x32_bf16 v[212:215], v[244:247], v[60:63], v[212:215]
    ds_read_b128 v[236:239], v5 offset:13312
    v_mul_f32 v191, v191, v10
    s_waitcnt lgkmcnt(3)
    v_mfma_f32_16x16x32_bf16 v[200:203], v[224:227], v[64:67], v[200:203]
    v_mul_f32 v196, v196, v10
    v_mfma_f32_16x16x32_bf16 v[204:207], v[224:227], v[68:71], v[204:207]
    ds_read_b128 v[240:243], v5 offset:14336
    v_mul_f32 v197, v197, v10
    s_waitcnt lgkmcnt(3)
    v_mfma_f32_16x16x32_bf16 v[208:211], v[228:231], v[64:67], v[208:211]
    v_mul_f32 v198, v198, v10
    v_mfma_f32_16x16x32_bf16 v[212:215], v[228:231], v[68:71], v[212:215]
    ds_read_b128 v[244:247], v5 offset:15360
    v_mul_f32 v199, v199, v10
    s_waitcnt lgkmcnt(3)
    v_mfma_f32_16x16x32_bf16 v[200:203], v[232:235], v[72:75], v[200:203]
    v_cvt_pk_bf16_f32 v220, v188, v189
    v_mfma_f32_16x16x32_bf16 v[204:207], v[232:235], v[76:79], v[204:207]
    s_waitcnt vmcnt(11)
    s_barrier
    ds_read_b128 v[224:227], v5 offset:16384
    v_cvt_pk_bf16_f32 v221, v190, v191
    s_waitcnt lgkmcnt(3)
    v_mfma_f32_16x16x32_bf16 v[208:211], v[236:239], v[72:75], v[208:211]
    v_cvt_pk_bf16_f32 v222, v196, v197
    v_mfma_f32_16x16x32_bf16 v[212:215], v[236:239], v[76:79], v[212:215]
    s_add_u32 s22, s24, 0x180000
    s_add_u32 m0, s20, 0x1c000
    s_nop 0
    buffer_load_dwordx4 v3, s[4:7], s22 offen lds
    ds_read_b128 v[228:231], v5 offset:17408
    v_cvt_pk_bf16_f32 v223, v198, v199
    s_waitcnt lgkmcnt(3)
    v_mfma_f32_16x16x32_bf16 v[200:203], v[240:243], v[80:83], v[200:203]
    buffer_store_dwordx4 v[220:223], v2, s[8:11], s26 offen offset:2048 sc1
    v_mfma_f32_16x16x32_bf16 v[204:207], v[240:243], v[84:87], v[204:207]
    ds_read_b128 v[232:235], v5 offset:18432
    s_waitcnt lgkmcnt(3)
    v_mfma_f32_16x16x32_bf16 v[208:211], v[244:247], v[80:83], v[208:211]
    v_mfma_f32_16x16x32_bf16 v[212:215], v[244:247], v[84:87], v[212:215]
    ds_read_b128 v[236:239], v5 offset:19456
    s_waitcnt lgkmcnt(3)
    v_mfma_f32_16x16x32_bf16 v[200:203], v[224:227], v[88:91], v[200:203]
    v_mfma_f32_16x16x32_bf16 v[204:207], v[224:227], v[92:95], v[204:207]
    ds_read_b128 v[240:243], v5 offset:20480
    s_waitcnt vmcnt(3)
    v_cmp_ne_u32 vcc, s28, v12
    s_cbranch_vccnz adaLN_cond__sliding_block_cached__moe_arch_mod__prompt_kernel_o17r
adaLN_cond__sliding_block_cached__moe_arch_mod__prompt_kernel_o17b:
    s_waitcnt lgkmcnt(3)
    v_mfma_f32_16x16x32_bf16 v[208:211], v[228:231], v[88:91], v[208:211]
    s_mov_b32 s23, 0x0
    buffer_load_dwordx4 v[24:27], v6, s[8:11], s23 offen offset:0 sc1
    v_mfma_f32_16x16x32_bf16 v[212:215], v[228:231], v[92:95], v[212:215]
    s_add_u32 s22, s24, 0x182000
    s_add_u32 m0, s20, 0x1c400
    s_nop 0
    buffer_load_dwordx4 v3, s[4:7], s22 offen lds
    ds_read_b128 v[244:247], v5 offset:21504
    s_waitcnt lgkmcnt(3)
    v_mfma_f32_16x16x32_bf16 v[200:203], v[232:235], v[96:99], v[200:203]
    v_mfma_f32_16x16x32_bf16 v[204:207], v[232:235], v[100:103], v[204:207]
    ds_read_b128 v[224:227], v5 offset:22528
    s_mov_b32 s23, 0x20000
    buffer_load_dwordx4 v[28:31], v6, s[8:11], s23 offen offset:0 sc1
    s_waitcnt lgkmcnt(3)
    v_mfma_f32_16x16x32_bf16 v[208:211], v[236:239], v[96:99], v[208:211]
    s_add_u32 s16, s63, 0x572000
    v_mov_b32 v14, s28
    v_mov_b32 v15, 0
    s_mov_b64 exec, 1
    buffer_store_dword v14, v15, s[8:11], s16 offen sc1
    s_mov_b64 exec, -1
    v_mfma_f32_16x16x32_bf16 v[212:215], v[236:239], v[100:103], v[212:215]
    ds_read_b128 v[228:231], v5 offset:23552
    s_waitcnt lgkmcnt(3)
    v_mfma_f32_16x16x32_bf16 v[200:203], v[240:243], v[104:107], v[200:203]
    v_mfma_f32_16x16x32_bf16 v[204:207], v[240:243], v[108:111], v[204:207]
    ds_read_b128 v[232:235], v5 offset:24576
    s_mov_b32 s23, 0x2000
    buffer_load_dwordx4 v[32:35], v6, s[8:11], s23 offen offset:0 sc1
    s_waitcnt lgkmcnt(3)
    v_mfma_f32_16x16x32_bf16 v[208:211], v[244:247], v[104:107], v[208:211]
    v_mfma_f32_16x16x32_bf16 v[212:215], v[244:247], v[108:111], v[212:215]
    ds_read_b128 v[236:239], v5 offset:25600
    s_waitcnt lgkmcnt(3)
    v_mfma_f32_16x16x32_bf16 v[200:203], v[224:227], v[112:115], v[200:203]
    s_mov_b32 s23, 0x22000
    buffer_load_dwordx4 v[36:39], v6, s[8:11], s23 offen offset:0 sc1
    v_mfma_f32_16x16x32_bf16 v[204:207], v[224:227], v[116:119], v[204:207]
    ds_read_b128 v[240:243], v5 offset:26624
    s_waitcnt lgkmcnt(3)
    v_mfma_f32_16x16x32_bf16 v[208:211], v[228:231], v[112:115], v[208:211]
    v_mfma_f32_16x16x32_bf16 v[212:215], v[228:231], v[116:119], v[212:215]
    ds_read_b128 v[244:247], v5 offset:27648
    s_waitcnt lgkmcnt(3)
    v_mfma_f32_16x16x32_bf16 v[200:203], v[232:235], v[120:123], v[200:203]
    s_mov_b32 s23, 0x4000
    buffer_load_dwordx4 v[40:43], v6, s[8:11], s23 offen offset:0 sc1
    v_mfma_f32_16x16x32_bf16 v[204:207], v[232:235], v[124:127], v[204:207]
    ds_read_b128 v[224:227], v5 offset:28672
    s_waitcnt lgkmcnt(3)
    v_mfma_f32_16x16x32_bf16 v[208:211], v[236:239], v[120:123], v[208:211]
    v_mfma_f32_16x16x32_bf16 v[212:215], v[236:239], v[124:127], v[212:215]
    ds_read_b128 v[228:231], v5 offset:29696
    s_waitcnt lgkmcnt(3)
    v_mfma_f32_16x16x32_bf16 v[200:203], v[240:243], v[128:131], v[200:203]
    s_mov_b32 s23, 0x24000
    buffer_load_dwordx4 v[44:47], v6, s[8:11], s23 offen offset:0 sc1
    v_mfma_f32_16x16x32_bf16 v[204:207], v[240:243], v[132:135], v[204:207]
    ds_read_b128 v[232:235], v5 offset:30720
    s_waitcnt lgkmcnt(3)
    v_mfma_f32_16x16x32_bf16 v[208:211], v[244:247], v[128:131], v[208:211]
    v_mfma_f32_16x16x32_bf16 v[212:215], v[244:247], v[132:135], v[212:215]
    ds_read_b128 v[236:239], v5 offset:31744
    s_mov_b32 s23, 0x6000
    buffer_load_dwordx4 v[48:51], v6, s[8:11], s23 offen offset:0 sc1
    s_waitcnt lgkmcnt(3)
    v_mfma_f32_16x16x32_bf16 v[200:203], v[224:227], v[136:139], v[200:203]
    v_bfe_u32 v18, v1, 2, 2
    v_lshrrev_b32 v19, 4, v1
    v_mfma_f32_16x16x32_bf16 v[204:207], v[224:227], v[140:143], v[204:207]
    v_and_b32 v17, 3, v1
    v_lshlrev_b32 v16, 11, v19
    s_waitcnt lgkmcnt(2)
    v_mfma_f32_16x16x32_bf16 v[208:211], v[228:231], v[136:139], v[208:211]
    v_lshl_add_u32 v16, v18, 6, v16
    v_lshl_add_u32 v16, v17, 3, v16
    v_mfma_f32_16x16x32_bf16 v[212:215], v[228:231], v[140:143], v[212:215]
    s_mov_b32 s23, 0x26000
    buffer_load_dwordx4 v[52:55], v6, s[8:11], s23 offen offset:0 sc1
    v_add_u32 v16, 0x12000, v16
    v_and_b32 v19, 1, v19
    s_waitcnt lgkmcnt(1)
    v_mfma_f32_16x16x32_bf16 v[200:203], v[232:235], v[144:147], v[200:203]
    v_lshlrev_b32 v19, 5, v19
    v_sub_u32 v5, v16, v19
    v_mfma_f32_16x16x32_bf16 v[204:207], v[232:235], v[148:151], v[204:207]
    v_add_u32 v4, v16, v19
    v_add_u32 v7, 0x10000, v4
    s_waitcnt lgkmcnt(0)
    v_mfma_f32_16x16x32_bf16 v[208:211], v[236:239], v[144:147], v[208:211]
    v_add_u32 v8, 0x10000, v5
    v_mfma_f32_16x16x32_bf16 v[212:215], v[236:239], v[148:151], v[212:215]
    v_mul_f32 v200, v200, v9
    v_mul_f32 v201, v201, v9
    v_mul_f32 v202, v202, v9
    v_mul_f32 v203, v203, v9
    s_nop 1
    v_mul_f32 v208, v208, v9
    v_mul_f32 v209, v209, v9
    v_mul_f32 v210, v210, v9
    v_mul_f32 v211, v211, v9
    v_cvt_pk_bf16_f32 v216, v200, v201
    v_cvt_pk_bf16_f32 v217, v202, v203
    v_cvt_pk_bf16_f32 v218, v208, v209
    v_cvt_pk_bf16_f32 v219, v210, v211
    buffer_store_dwordx4 v[216:219], v2, s[8:11], s25 offen offset:3072 sc1
    v_mul_f32 v204, v204, v10
    v_mul_f32 v205, v205, v10
    v_mul_f32 v206, v206, v10
    v_mul_f32 v207, v207, v10
    v_mul_f32 v212, v212, v10
    v_mul_f32 v213, v213, v10
    v_mul_f32 v214, v214, v10
    v_mul_f32 v215, v215, v10
    v_cvt_pk_bf16_f32 v220, v204, v205
    v_cvt_pk_bf16_f32 v221, v206, v207
    v_cvt_pk_bf16_f32 v222, v212, v213
    v_cvt_pk_bf16_f32 v223, v214, v215
    buffer_store_dwordx4 v[220:223], v2, s[8:11], s26 offen offset:3072 sc1
    s_and_b32 s15, s2, 1
    s_barrier
    ds_read_b64_tr_b16 v[224:225], v4 offset:0
    ds_read_b64_tr_b16 v[226:227], v4 offset:1024
    ds_read_b64_tr_b16 v[228:229], v5 offset:32
    ds_read_b64_tr_b16 v[230:231], v5 offset:1056
    ds_read_b64_tr_b16 v[232:233], v4 offset:256
    ds_read_b64_tr_b16 v[234:235], v4 offset:1280
    ds_read_b64_tr_b16 v[236:237], v5 offset:288
    ds_read_b64_tr_b16 v[238:239], v5 offset:1312
    s_waitcnt vmcnt(11) lgkmcnt(6)
    v_mfma_f32_16x16x32_bf16 v[88:91], v[224:227], v[24:27], 0
    ds_read_b64_tr_b16 v[240:241], v4 offset:512
    s_waitcnt vmcnt(9)
    v_mfma_f32_16x16x32_bf16 v[92:95], v[224:227], v[28:31], 0
    ds_read_b64_tr_b16 v[242:243], v4 offset:1536
    s_waitcnt lgkmcnt(6)
    v_mfma_f32_16x16x32_bf16 v[96:99], v[228:231], v[24:27], 0
    ds_read_b64_tr_b16 v[244:245], v5 offset:544
    v_mfma_f32_16x16x32_bf16 v[100:103], v[228:231], v[28:31], 0
    ds_read_b64_tr_b16 v[246:247], v5 offset:1568
    s_waitcnt lgkmcnt(6)
    v_mfma_f32_16x16x32_bf16 v[104:107], v[232:235], v[24:27], 0
    ds_read_b64_tr_b16 v[224:225], v4 offset:768
    v_mfma_f32_16x16x32_bf16 v[108:111], v[232:235], v[28:31], 0
    ds_read_b64_tr_b16 v[226:227], v4 offset:1792
    s_waitcnt lgkmcnt(6)
    v_mfma_f32_16x16x32_bf16 v[112:115], v[236:239], v[24:27], 0
    ds_read_b64_tr_b16 v[228:229], v5 offset:800
    v_mfma_f32_16x16x32_bf16 v[116:119], v[236:239], v[28:31], 0
    ds_read_b64_tr_b16 v[230:231], v5 offset:1824
    s_waitcnt lgkmcnt(6)
    v_mfma_f32_16x16x32_bf16 v[120:123], v[240:243], v[24:27], 0
    s_add_u32 s22, s24, 0x200000
    s_add_u32 m0, s20, 0x20000
    s_nop 0
    buffer_load_dwordx4 v3, s[4:7], s22 offen lds
    v_mfma_f32_16x16x32_bf16 v[124:127], v[240:243], v[28:31], 0
    s_barrier
    ds_read_b64_tr_b16 v[232:233], v4 offset:16384
    ds_read_b64_tr_b16 v[234:235], v4 offset:17408
    s_waitcnt lgkmcnt(6)
    v_mfma_f32_16x16x32_bf16 v[128:131], v[244:247], v[24:27], 0
    ds_read_b64_tr_b16 v[236:237], v5 offset:16416
    s_mov_b32 s23, 0x8000
    buffer_load_dwordx4 v[56:59], v6, s[8:11], s23 offen offset:0 sc1
    v_mfma_f32_16x16x32_bf16 v[132:135], v[244:247], v[28:31], 0
    s_add_u32 s22, s24, 0x202000
    s_add_u32 m0, s20, 0x20400
    s_nop 0
    buffer_load_dwordx4 v3, s[4:7], s22 offen lds
    ds_read_b64_tr_b16 v[238:239], v5 offset:17440
    s_waitcnt lgkmcnt(6)
    v_mfma_f32_16x16x32_bf16 v[136:139], v[224:227], v[24:27], 0
    ds_read_b64_tr_b16 v[240:241], v4 offset:16640
    v_mfma_f32_16x16x32_bf16 v[140:143], v[224:227], v[28:31], 0
    ds_read_b64_tr_b16 v[242:243], v4 offset:17664
    s_mov_b32 s23, 0x28000
    buffer_load_dwordx4 v[60:63], v6, s[8:11], s23 offen offset:0 sc1
    s_waitcnt lgkmcnt(6)
    v_mfma_f32_16x16x32_bf16 v[144:147], v[228:231], v[24:27], 0
    ds_read_b64_tr_b16 v[244:245], v5 offset:16672
    v_mfma_f32_16x16x32_bf16 v[148:151], v[228:231], v[28:31], 0
    ds_read_b64_tr_b16 v[246:247], v5 offset:17696
    s_waitcnt vmcnt(11) lgkmcnt(6)
    v_mfma_f32_16x16x32_bf16 v[88:91], v[232:235], v[32:35], v[88:91]
    ds_read_b64_tr_b16 v[224:225], v4 offset:16896
    s_waitcnt vmcnt(10)
    v_mfma_f32_16x16x32_bf16 v[92:95], v[232:235], v[36:39], v[92:95]
    s_add_u32 s22, s24, 0x280000
    s_add_u32 m0, s20, 0x24000
    s_nop 0
    buffer_load_dwordx4 v3, s[4:7], s22 offen lds
    ds_read_b64_tr_b16 v[226:227], v4 offset:17920
    s_waitcnt lgkmcnt(6)
    v_mfma_f32_16x16x32_bf16 v[96:99], v[236:239], v[32:35], v[96:99]
    ds_read_b64_tr_b16 v[228:229], v5 offset:16928
    v_mfma_f32_16x16x32_bf16 v[100:103], v[236:239], v[36:39], v[100:103]
    ds_read_b64_tr_b16 v[230:231], v5 offset:17952
    s_waitcnt lgkmcnt(6)
    v_mfma_f32_16x16x32_bf16 v[104:107], v[240:243], v[32:35], v[104:107]
    s_add_u32 s22, s24, 0x282000
    s_add_u32 m0, s20, 0x24400
    s_nop 0
    buffer_load_dwordx4 v3, s[4:7], s22 offen lds
    ds_read_b64_tr_b16 v[232:233], v4 offset:17152
    v_mfma_f32_16x16x32_bf16 v[108:111], v[240:243], v[36:39], v[108:111]
    ds_read_b64_tr_b16 v[234:235], v4 offset:18176
    s_waitcnt lgkmcnt(6)
    v_mfma_f32_16x16x32_bf16 v[112:115], v[244:247], v[32:35], v[112:115]
    ds_read_b64_tr_b16 v[236:237], v5 offset:17184
    v_mfma_f32_16x16x32_bf16 v[116:119], v[244:247], v[36:39], v[116:119]
    ds_read_b64_tr_b16 v[238:239], v5 offset:18208
    s_waitcnt lgkmcnt(6)
    v_mfma_f32_16x16x32_bf16 v[120:123], v[224:227], v[32:35], v[120:123]
    v_mfma_f32_16x16x32_bf16 v[124:127], v[224:227], v[36:39], v[124:127]
    s_barrier
    ds_read_b64_tr_b16 v[240:241], v4 offset:32768
    ds_read_b64_tr_b16 v[242:243], v4 offset:33792
    s_waitcnt lgkmcnt(6)
    v_mfma_f32_16x16x32_bf16 v[128:131], v[228:231], v[32:35], v[128:131]
    ds_read_b64_tr_b16 v[244:245], v5 offset:32800
    s_mov_b32 s23, 0xa000
    buffer_load_dwordx4 v[24:27], v6, s[8:11], s23 offen offset:0 sc1
    v_mfma_f32_16x16x32_bf16 v[132:135], v[228:231], v[36:39], v[132:135]
    ds_read_b64_tr_b16 v[246:247], v5 offset:33824
    s_waitcnt lgkmcnt(6)
    v_mfma_f32_16x16x32_bf16 v[136:139], v[232:235], v[32:35], v[136:139]
    ds_read_b64_tr_b16 v[224:225], v4 offset:33024
    v_mfma_f32_16x16x32_bf16 v[140:143], v[232:235], v[36:39], v[140:143]
    ds_read_b64_tr_b16 v[226:227], v4 offset:34048
    s_mov_b32 s23, 0x2a000
    buffer_load_dwordx4 v[28:31], v6, s[8:11], s23 offen offset:0 sc1
    s_waitcnt lgkmcnt(6)
    v_mfma_f32_16x16x32_bf16 v[144:147], v[236:239], v[32:35], v[144:147]
    s_add_u32 s16, s63, 0x574000
    v_mov_b32 v14, s28
    v_mov_b32 v15, 0
    s_mov_b64 exec, 1
    buffer_store_dword v14, v15, s[8:11], s16 offen sc1
    s_mov_b64 exec, -1
    ds_read_b64_tr_b16 v[228:229], v5 offset:33056
    v_mfma_f32_16x16x32_bf16 v[148:151], v[236:239], v[36:39], v[148:151]
    ds_read_b64_tr_b16 v[230:231], v5 offset:34080
    s_waitcnt vmcnt(14) lgkmcnt(6)
    v_mfma_f32_16x16x32_bf16 v[88:91], v[240:243], v[40:43], v[88:91]
    ds_read_b64_tr_b16 v[232:233], v4 offset:33280
    s_waitcnt vmcnt(13)
    v_mfma_f32_16x16x32_bf16 v[92:95], v[240:243], v[44:47], v[92:95]
    s_add_u32 s22, s24, 0x300000
    s_add_u32 m0, s20, 0x10000
    s_nop 0
    buffer_load_dwordx4 v3, s[4:7], s22 offen lds
    ds_read_b64_tr_b16 v[234:235], v4 offset:34304
    s_waitcnt lgkmcnt(6)
    v_mfma_f32_16x16x32_bf16 v[96:99], v[244:247], v[40:43], v[96:99]
    ds_read_b64_tr_b16 v[236:237], v5 offset:33312
    v_mfma_f32_16x16x32_bf16 v[100:103], v[244:247], v[44:47], v[100:103]
    ds_read_b64_tr_b16 v[238:239], v5 offset:34336
    s_waitcnt lgkmcnt(6)
    v_mfma_f32_16x16x32_bf16 v[104:107], v[224:227], v[40:43], v[104:107]
    s_add_u32 s22, s24, 0x302000
    s_add_u32 m0, s20, 0x10400
    s_nop 0
    buffer_load_dwordx4 v3, s[4:7], s22 offen lds
    ds_read_b64_tr_b16 v[240:241], v4 offset:33536
    v_mfma_f32_16x16x32_bf16 v[108:111], v[224:227], v[44:47], v[108:111]
    ds_read_b64_tr_b16 v[242:243], v4 offset:34560
    s_waitcnt lgkmcnt(6)
    v_mfma_f32_16x16x32_bf16 v[112:115], v[228:231], v[40:43], v[112:115]
    ds_read_b64_tr_b16 v[244:245], v5 offset:33568
    v_mfma_f32_16x16x32_bf16 v[116:119], v[228:231], v[44:47], v[116:119]
    ds_read_b64_tr_b16 v[246:247], v5 offset:34592
    s_waitcnt lgkmcnt(6)
    v_mfma_f32_16x16x32_bf16 v[120:123], v[232:235], v[40:43], v[120:123]
    v_mfma_f32_16x16x32_bf16 v[124:127], v[232:235], v[44:47], v[124:127]
    s_barrier
    ds_read_b64_tr_b16 v[224:225], v4 offset:49152
    ds_read_b64_tr_b16 v[226:227], v4 offset:50176
    s_add_u32 s19, s19, 8192
    buffer_load_dword v12, v13, s[8:11], s19 offen sc1
    s_waitcnt lgkmcnt(6)
    v_mfma_f32_16x16x32_bf16 v[128:131], v[236:239], v[40:43], v[128:131]
    ds_read_b64_tr_b16 v[228:229], v5 offset:49184
    s_mov_b32 s23, 0xc000
    buffer_load_dwordx4 v[32:35], v6, s[8:11], s23 offen offset:0 sc1
    v_mfma_f32_16x16x32_bf16 v[132:135], v[236:239], v[44:47], v[132:135]
    ds_read_b64_tr_b16 v[230:231], v5 offset:50208
    s_waitcnt lgkmcnt(6)
    v_mfma_f32_16x16x32_bf16 v[136:139], v[240:243], v[40:43], v[136:139]
    ds_read_b64_tr_b16 v[232:233], v4 offset:49408
    v_mfma_f32_16x16x32_bf16 v[140:143], v[240:243], v[44:47], v[140:143]
    ds_read_b64_tr_b16 v[234:235], v4 offset:50432
    s_mov_b32 s23, 0x2c000
    buffer_load_dwordx4 v[36:39], v6, s[8:11], s23 offen offset:0 sc1
    s_waitcnt lgkmcnt(6)
    v_mfma_f32_16x16x32_bf16 v[144:147], v[244:247], v[40:43], v[144:147]
    ds_read_b64_tr_b16 v[236:237], v5 offset:49440
    v_mfma_f32_16x16x32_bf16 v[148:151], v[244:247], v[44:47], v[148:151]
    ds_read_b64_tr_b16 v[238:239], v5 offset:50464
    s_waitcnt vmcnt(17) lgkmcnt(6)
    v_mfma_f32_16x16x32_bf16 v[88:91], v[224:227], v[48:51], v[88:91]
    ds_read_b64_tr_b16 v[240:241], v4 offset:49664
    s_waitcnt vmcnt(16)
    v_mfma_f32_16x16x32_bf16 v[92:95], v[224:227], v[52:55], v[92:95]
    s_add_u32 s22, s24, 0x380000
    s_add_u32 m0, s20, 0x14000
    s_nop 0
    buffer_load_dwordx4 v3, s[4:7], s22 offen lds
    ds_read_b64_tr_b16 v[242:243], v4 offset:50688
    s_waitcnt lgkmcnt(6)
    v_mfma_f32_16x16x32_bf16 v[96:99], v[228:231], v[48:51], v[96:99]
    ds_read_b64_tr_b16 v[244:245], v5 offset:49696
    v_mfma_f32_16x16x32_bf16 v[100:103], v[228:231], v[52:55], v[100:103]
    ds_read_b64_tr_b16 v[246:247], v5 offset:50720
    s_waitcnt lgkmcnt(6)
    v_mfma_f32_16x16x32_bf16 v[104:107], v[232:235], v[48:51], v[104:107]
    s_add_u32 s22, s24, 0x382000
    s_add_u32 m0, s20, 0x14400
    s_nop 0
    buffer_load_dwordx4 v3, s[4:7], s22 offen lds
    ds_read_b64_tr_b16 v[224:225], v4 offset:49920
    v_mfma_f32_16x16x32_bf16 v[108:111], v[232:235], v[52:55], v[108:111]
    ds_read_b64_tr_b16 v[226:227], v4 offset:50944
    s_waitcnt lgkmcnt(6)
    v_mfma_f32_16x16x32_bf16 v[112:115], v[236:239], v[48:51], v[112:115]
    ds_read_b64_tr_b16 v[228:229], v5 offset:49952
    v_mfma_f32_16x16x32_bf16 v[116:119], v[236:239], v[52:55], v[116:119]
    ds_read_b64_tr_b16 v[230:231], v5 offset:50976
    s_waitcnt lgkmcnt(6)
    v_mfma_f32_16x16x32_bf16 v[120:123], v[240:243], v[48:51], v[120:123]
    v_mfma_f32_16x16x32_bf16 v[124:127], v[240:243], v[52:55], v[124:127]
    s_waitcnt vmcnt(13)
    s_barrier
    ds_read_b64_tr_b16 v[232:233], v7 offset:0
    ds_read_b64_tr_b16 v[234:235], v7 offset:1024
    s_waitcnt lgkmcnt(6)
    v_mfma_f32_16x16x32_bf16 v[128:131], v[244:247], v[48:51], v[128:131]
    ds_read_b64_tr_b16 v[236:237], v8 offset:32
    s_mov_b32 s23, 0xe000
    buffer_load_dwordx4 v[40:43], v6, s[8:11], s23 offen offset:0 sc1
    v_mfma_f32_16x16x32_bf16 v[132:135], v[244:247], v[52:55], v[132:135]
    ds_read_b64_tr_b16 v[238:239], v8 offset:1056
    s_waitcnt lgkmcnt(6)
    v_mfma_f32_16x16x32_bf16 v[136:139], v[224:227], v[48:51], v[136:139]
    ds_read_b64_tr_b16 v[240:241], v7 offset:256
    v_mfma_f32_16x16x32_bf16 v[140:143], v[224:227], v[52:55], v[140:143]
    ds_read_b64_tr_b16 v[242:243], v7 offset:1280
    s_mov_b32 s23, 0x2e000
    buffer_load_dwordx4 v[44:47], v6, s[8:11], s23 offen offset:0 sc1
    s_waitcnt lgkmcnt(6)
    v_mfma_f32_16x16x32_bf16 v[144:147], v[228:231], v[48:51], v[144:147]
    ds_read_b64_tr_b16 v[244:245], v8 offset:288
    v_mfma_f32_16x16x32_bf16 v[148:151], v[228:231], v[52:55], v[148:151]
    ds_read_b64_tr_b16 v[246:247], v8 offset:1312
    s_waitcnt vmcnt(6)
    v_cmp_ne_u32 vcc, s28, v12
    s_cbranch_vccnz adaLN_cond__sliding_block_cached__moe_arch_mod__prompt_kernel_o218r
adaLN_cond__sliding_block_cached__moe_arch_mod__prompt_kernel_o218b:
    s_waitcnt lgkmcnt(6)
    v_mfma_f32_16x16x32_bf16 v[88:91], v[232:235], v[56:59], v[88:91]
    ds_read_b64_tr_b16 v[224:225], v7 offset:512
    v_mfma_f32_16x16x32_bf16 v[92:95], v[232:235], v[60:63], v[92:95]
    s_add_u32 s22, s24, 0x10000
    s_add_u32 m0, s20, 0x18000
    s_nop 0
    buffer_load_dwordx4 v3, s[4:7], s22 offen lds
    ds_read_b64_tr_b16 v[226:227], v7 offset:1536
    s_waitcnt lgkmcnt(6)
    v_mfma_f32_16x16x32_bf16 v[96:99], v[236:239], v[56:59], v[96:99]
    ds_read_b64_tr_b16 v[228:229], v8 offset:544
    v_mfma_f32_16x16x32_bf16 v[100:103], v[236:239], v[60:63], v[100:103]
    ds_read_b64_tr_b16 v[230:231], v8 offset:1568
    s_waitcnt lgkmcnt(6)
    v_mfma_f32_16x16x32_bf16 v[104:107], v[240:243], v[56:59], v[104:107]
    s_add_u32 s22, s24, 0x12000
    s_add_u32 m0, s20, 0x18400
    s_nop 0
    buffer_load_dwordx4 v3, s[4:7], s22 offen lds
    ds_read_b64_tr_b16 v[232:233], v7 offset:768
    v_mfma_f32_16x16x32_bf16 v[108:111], v[240:243], v[60:63], v[108:111]
    ds_read_b64_tr_b16 v[234:235], v7 offset:1792
    s_waitcnt lgkmcnt(6)
    v_mfma_f32_16x16x32_bf16 v[112:115], v[244:247], v[56:59], v[112:115]
    ds_read_b64_tr_b16 v[236:237], v8 offset:800
    v_mfma_f32_16x16x32_bf16 v[116:119], v[244:247], v[60:63], v[116:119]
    ds_read_b64_tr_b16 v[238:239], v8 offset:1824
    s_waitcnt lgkmcnt(6)
    v_mfma_f32_16x16x32_bf16 v[120:123], v[224:227], v[56:59], v[120:123]
    v_mfma_f32_16x16x32_bf16 v[124:127], v[224:227], v[60:63], v[124:127]
    s_barrier
    ds_read_b64_tr_b16 v[240:241], v7 offset:16384
    ds_read_b64_tr_b16 v[242:243], v7 offset:17408
    s_waitcnt lgkmcnt(6)
    v_mfma_f32_16x16x32_bf16 v[128:131], v[228:231], v[56:59], v[128:131]
    ds_read_b64_tr_b16 v[244:245], v8 offset:16416
    s_mov_b32 s23, 0x0
    buffer_load_dwordx4 v[48:51], v6, s[8:11], s23 offen offset:1024 sc1
    v_mfma_f32_16x16x32_bf16 v[132:135], v[228:231], v[60:63], v[132:135]
    ds_read_b64_tr_b16 v[246:247], v8 offset:17440
    s_waitcnt lgkmcnt(6)
    v_mfma_f32_16x16x32_bf16 v[136:139], v[232:235], v[56:59], v[136:139]
    ds_read_b64_tr_b16 v[224:225], v7 offset:16640
    v_mfma_f32_16x16x32_bf16 v[140:143], v[232:235], v[60:63], v[140:143]
    ds_read_b64_tr_b16 v[226:227], v7 offset:17664
    s_mov_b32 s23, 0x20000
    buffer_load_dwordx4 v[52:55], v6, s[8:11], s23 offen offset:1024 sc1
    s_waitcnt lgkmcnt(6)
    v_mfma_f32_16x16x32_bf16 v[144:147], v[236:239], v[56:59], v[144:147]
    ds_read_b64_tr_b16 v[228:229], v8 offset:16672
    v_mfma_f32_16x16x32_bf16 v[148:151], v[236:239], v[60:63], v[148:151]
    ds_read_b64_tr_b16 v[230:231], v8 offset:17696
    s_waitcnt lgkmcnt(6)
    v_mfma_f32_16x16x32_bf16 v[88:91], v[240:243], v[24:27], v[88:91]
    ds_read_b64_tr_b16 v[232:233], v7 offset:16896
    v_mfma_f32_16x16x32_bf16 v[92:95], v[240:243], v[28:31], v[92:95]
    s_add_u32 s22, s24, 0x90000
    s_add_u32 m0, s20, 0x1c000
    s_nop 0
    buffer_load_dwordx4 v3, s[4:7], s22 offen lds
    ds_read_b64_tr_b16 v[234:235], v7 offset:17920
    s_waitcnt lgkmcnt(6)
    v_mfma_f32_16x16x32_bf16 v[96:99], v[244:247], v[24:27], v[96:99]
    ds_read_b64_tr_b16 v[236:237], v8 offset:16928
    v_mfma_f32_16x16x32_bf16 v[100:103], v[244:247], v[28:31], v[100:103]
    ds_read_b64_tr_b16 v[238:239], v8 offset:17952
    s_waitcnt lgkmcnt(6)
    v_mfma_f32_16x16x32_bf16 v[104:107], v[224:227], v[24:27], v[104:107]
    s_add_u32 s22, s24, 0x92000
    s_add_u32 m0, s20, 0x1c400
    s_nop 0
    buffer_load_dwordx4 v3, s[4:7], s22 offen lds
    ds_read_b64_tr_b16 v[240:241], v7 offset:17152
    v_mfma_f32_16x16x32_bf16 v[108:111], v[224:227], v[28:31], v[108:111]
    ds_read_b64_tr_b16 v[242:243], v7 offset:18176
    s_waitcnt lgkmcnt(6)
    v_mfma_f32_16x16x32_bf16 v[112:115], v[228:231], v[24:27], v[112:115]
    ds_read_b64_tr_b16 v[244:245], v8 offset:17184
    v_mfma_f32_16x16x32_bf16 v[116:119], v[228:231], v[28:31], v[116:119]
    ds_read_b64_tr_b16 v[246:247], v8 offset:18208
    s_waitcnt lgkmcnt(6)
    v_mfma_f32_16x16x32_bf16 v[120:123], v[232:235], v[24:27], v[120:123]
    v_mfma_f32_16x16x32_bf16 v[124:127], v[232:235], v[28:31], v[124:127]
    s_barrier
    ds_read_b64_tr_b16 v[224:225], v4 offset:0
    ds_read_b64_tr_b16 v[226:227], v4 offset:1024
    s_waitcnt lgkmcnt(6)
    v_mfma_f32_16x16x32_bf16 v[128:131], v[236:239], v[24:27], v[128:131]
    s_add_u32 s16, s63, 0x576000
    v_mov_b32 v14, s28
    v_mov_b32 v15, 0
    s_mov_b64 exec, 1
    buffer_store_dword v14, v15, s[8:11], s16 offen sc1
    s_mov_b64 exec, -1
    ds_read_b64_tr_b16 v[228:229], v5 offset:32
    s_mov_b32 s23, 0x2000
    buffer_load_dwordx4 v[56:59], v6, s[8:11], s23 offen offset:1024 sc1
    v_mfma_f32_16x16x32_bf16 v[132:135], v[236:239], v[28:31], v[132:135]
    ds_read_b64_tr_b16 v[230:231], v5 offset:1056
    s_waitcnt lgkmcnt(6)
    v_mfma_f32_16x16x32_bf16 v[136:139], v[240:243], v[24:27], v[136:139]
    ds_read_b64_tr_b16 v[232:233], v4 offset:256
    v_mfma_f32_16x16x32_bf16 v[140:143], v[240:243], v[28:31], v[140:143]
    ds_read_b64_tr_b16 v[234:235], v4 offset:1280
    s_mov_b32 s23, 0x22000
    buffer_load_dwordx4 v[60:63], v6, s[8:11], s23 offen offset:1024 sc1
    s_waitcnt lgkmcnt(6)
    v_mfma_f32_16x16x32_bf16 v[144:147], v[244:247], v[24:27], v[144:147]
    ds_read_b64_tr_b16 v[236:237], v5 offset:288
    v_mfma_f32_16x16x32_bf16 v[148:151], v[244:247], v[28:31], v[148:151]
    ds_read_b64_tr_b16 v[238:239], v5 offset:1312
    s_waitcnt vmcnt(14) lgkmcnt(6)
    v_mfma_f32_16x16x32_bf16 v[88:91], v[224:227], v[32:35], v[88:91]
    ds_read_b64_tr_b16 v[240:241], v4 offset:512
    s_waitcnt vmcnt(13)
    v_mfma_f32_16x16x32_bf16 v[92:95], v[224:227], v[36:39], v[92:95]
    s_add_u32 s22, s24, 0x110000
    s_add_u32 m0, s20, 0x20000
    s_nop 0
    buffer_load_dwordx4 v3, s[4:7], s22 offen lds
    ds_read_b64_tr_b16 v[242:243], v4 offset:1536
    s_waitcnt lgkmcnt(6)
    v_mfma_f32_16x16x32_bf16 v[96:99], v[228:231], v[32:35], v[96:99]
    ds_read_b64_tr_b16 v[244:245], v5 offset:544
    v_mfma_f32_16x16x32_bf16 v[100:103], v[228:231], v[36:39], v[100:103]
    ds_read_b64_tr_b16 v[246:247], v5 offset:1568
    s_waitcnt lgkmcnt(6)
    v_mfma_f32_16x16x32_bf16 v[104:107], v[232:235], v[32:35], v[104:107]
    s_add_u32 s22, s24, 0x112000
    s_add_u32 m0, s20, 0x20400
    s_nop 0
    buffer_load_dwordx4 v3, s[4:7], s22 offen lds
    ds_read_b64_tr_b16 v[224:225], v4 offset:768
    v_mfma_f32_16x16x32_bf16 v[108:111], v[232:235], v[36:39], v[108:111]
    ds_read_b64_tr_b16 v[226:227], v4 offset:1792
    s_waitcnt lgkmcnt(6)
    v_mfma_f32_16x16x32_bf16 v[112:115], v[236:239], v[32:35], v[112:115]
    ds_read_b64_tr_b16 v[228:229], v5 offset:800
    v_mfma_f32_16x16x32_bf16 v[116:119], v[236:239], v[36:39], v[116:119]
    ds_read_b64_tr_b16 v[230:231], v5 offset:1824
    s_waitcnt lgkmcnt(6)
    v_mfma_f32_16x16x32_bf16 v[120:123], v[240:243], v[32:35], v[120:123]
    v_mfma_f32_16x16x32_bf16 v[124:127], v[240:243], v[36:39], v[124:127]
    s_waitcnt vmcnt(13)
    s_barrier
    ds_read_b64_tr_b16 v[232:233], v4 offset:16384
    ds_read_b64_tr_b16 v[234:235], v4 offset:17408
    s_waitcnt lgkmcnt(6)
    v_mfma_f32_16x16x32_bf16 v[128:131], v[244:247], v[32:35], v[128:131]
    ds_read_b64_tr_b16 v[236:237], v5 offset:16416
    s_mov_b32 s23, 0x4000
    buffer_load_dwordx4 v[24:27], v6, s[8:11], s23 offen offset:1024 sc1
    v_mfma_f32_16x16x32_bf16 v[132:135], v[244:247], v[36:39], v[132:135]
    ds_read_b64_tr_b16 v[238:239], v5 offset:17440
    s_waitcnt lgkmcnt(6)
    v_mfma_f32_16x16x32_bf16 v[136:139], v[224:227], v[32:35], v[136:139]
    ds_read_b64_tr_b16 v[240:241], v4 offset:16640
    v_mfma_f32_16x16x32_bf16 v[140:143], v[224:227], v[36:39], v[140:143]
    ds_read_b64_tr_b16 v[242:243], v4 offset:17664
    s_mov_b32 s23, 0x24000
    buffer_load_dwordx4 v[28:31], v6, s[8:11], s23 offen offset:1024 sc1
    s_waitcnt lgkmcnt(6)
    v_mfma_f32_16x16x32_bf16 v[144:147], v[228:231], v[32:35], v[144:147]
    ds_read_b64_tr_b16 v[244:245], v5 offset:16672
    v_mfma_f32_16x16x32_bf16 v[148:151], v[228:231], v[36:39], v[148:151]
    ds_read_b64_tr_b16 v[246:247], v5 offset:17696
    s_waitcnt vmcnt(14) lgkmcnt(6)
    v_mfma_f32_16x16x32_bf16 v[88:91], v[232:235], v[40:43], v[88:91]
    ds_read_b64_tr_b16 v[224:225], v4 offset:16896
    s_waitcnt vmcnt(13)
    v_mfma_f32_16x16x32_bf16 v[92:95], v[232:235], v[44:47], v[92:95]
    s_add_u32 s22, s24, 0x190000
    s_add_u32 m0, s20, 0x24000
    s_nop 0
    buffer_load_dwordx4 v3, s[4:7], s22 offen lds
    ds_read_b64_tr_b16 v[226:227], v4 offset:17920
    s_waitcnt lgkmcnt(6)
    v_mfma_f32_16x16x32_bf16 v[96:99], v[236:239], v[40:43], v[96:99]
    ds_read_b64_tr_b16 v[228:229], v5 offset:16928
    v_mfma_f32_16x16x32_bf16 v[100:103], v[236:239], v[44:47], v[100:103]
    ds_read_b64_tr_b16 v[230:231], v5 offset:17952
    s_waitcnt lgkmcnt(6)
    v_mfma_f32_16x16x32_bf16 v[104:107], v[240:243], v[40:43], v[104:107]
    s_add_u32 s22, s24, 0x192000
    s_add_u32 m0, s20, 0x24400
    s_nop 0
    buffer_load_dwordx4 v3, s[4:7], s22 offen lds
    ds_read_b64_tr_b16 v[232:233], v4 offset:17152
    v_mfma_f32_16x16x32_bf16 v[108:111], v[240:243], v[44:47], v[108:111]
    ds_read_b64_tr_b16 v[234:235], v4 offset:18176
    s_waitcnt lgkmcnt(6)
    v_mfma_f32_16x16x32_bf16 v[112:115], v[244:247], v[40:43], v[112:115]
    ds_read_b64_tr_b16 v[236:237], v5 offset:17184
    v_mfma_f32_16x16x32_bf16 v[116:119], v[244:247], v[44:47], v[116:119]
    ds_read_b64_tr_b16 v[238:239], v5 offset:18208
    s_waitcnt lgkmcnt(6)
    v_mfma_f32_16x16x32_bf16 v[120:123], v[224:227], v[40:43], v[120:123]
    v_mfma_f32_16x16x32_bf16 v[124:127], v[224:227], v[44:47], v[124:127]
    s_waitcnt vmcnt(13)
    s_barrier
    ds_read_b64_tr_b16 v[240:241], v4 offset:32768
    ds_read_b64_tr_b16 v[242:243], v4 offset:33792
    s_waitcnt lgkmcnt(6)
    v_mfma_f32_16x16x32_bf16 v[128:131], v[228:231], v[40:43], v[128:131]
    ds_read_b64_tr_b16 v[244:245], v5 offset:32800
    s_mov_b32 s23, 0x6000
    buffer_load_dwordx4 v[32:35], v6, s[8:11], s23 offen offset:1024 sc1
    v_mfma_f32_16x16x32_bf16 v[132:135], v[228:231], v[44:47], v[132:135]
    ds_read_b64_tr_b16 v[246:247], v5 offset:33824
    s_waitcnt lgkmcnt(6)
    v_mfma_f32_16x16x32_bf16 v[136:139], v[232:235], v[40:43], v[136:139]
    ds_read_b64_tr_b16 v[224:225], v4 offset:33024
    v_mfma_f32_16x16x32_bf16 v[140:143], v[232:235], v[44:47], v[140:143]
    ds_read_b64_tr_b16 v[226:227], v4 offset:34048
    s_mov_b32 s23, 0x26000
    buffer_load_dwordx4 v[36:39], v6, s[8:11], s23 offen offset:1024 sc1
    s_waitcnt lgkmcnt(6)
    v_mfma_f32_16x16x32_bf16 v[144:147], v[236:239], v[40:43], v[144:147]
    ds_read_b64_tr_b16 v[228:229], v5 offset:33056
    v_mfma_f32_16x16x32_bf16 v[148:151], v[236:239], v[44:47], v[148:151]
    ds_read_b64_tr_b16 v[230:231], v5 offset:34080
    s_waitcnt vmcnt(14) lgkmcnt(6)
    v_mfma_f32_16x16x32_bf16 v[88:91], v[240:243], v[48:51], v[88:91]
    ds_read_b64_tr_b16 v[232:233], v4 offset:33280
    s_waitcnt vmcnt(13)
    v_mfma_f32_16x16x32_bf16 v[92:95], v[240:243], v[52:55], v[92:95]
    s_add_u32 s22, s24, 0x210000
    s_add_u32 m0, s20, 0x10000
    s_nop 0
    buffer_load_dwordx4 v3, s[4:7], s22 offen lds
    ds_read_b64_tr_b16 v[234:235], v4 offset:34304
    s_waitcnt lgkmcnt(6)
    v_mfma_f32_16x16x32_bf16 v[96:99], v[244:247], v[48:51], v[96:99]
    ds_read_b64_tr_b16 v[236:237], v5 offset:33312
    v_mfma_f32_16x16x32_bf16 v[100:103], v[244:247], v[52:55], v[100:103]
    ds_read_b64_tr_b16 v[238:239], v5 offset:34336
    s_waitcnt lgkmcnt(6)
    v_mfma_f32_16x16x32_bf16 v[104:107], v[224:227], v[48:51], v[104:107]
    s_add_u32 s22, s24, 0x212000
    s_add_u32 m0, s20, 0x10400
    s_nop 0
    buffer_load_dwordx4 v3, s[4:7], s22 offen lds
    ds_read_b64_tr_b16 v[240:241], v4 offset:33536
    v_mfma_f32_16x16x32_bf16 v[108:111], v[224:227], v[52:55], v[108:111]
    ds_read_b64_tr_b16 v[242:243], v4 offset:34560
    s_waitcnt lgkmcnt(6)
    v_mfma_f32_16x16x32_bf16 v[112:115], v[228:231], v[48:51], v[112:115]
    ds_read_b64_tr_b16 v[244:245], v5 offset:33568
    v_mfma_f32_16x16x32_bf16 v[116:119], v[228:231], v[52:55], v[116:119]
    ds_read_b64_tr_b16 v[246:247], v5 offset:34592
    s_waitcnt lgkmcnt(6)
    v_mfma_f32_16x16x32_bf16 v[120:123], v[232:235], v[48:51], v[120:123]
    v_mfma_f32_16x16x32_bf16 v[124:127], v[232:235], v[52:55], v[124:127]
    s_waitcnt vmcnt(13)
    s_barrier
    ds_read_b64_tr_b16 v[224:225], v4 offset:49152
    ds_read_b64_tr_b16 v[226:227], v4 offset:50176
    s_waitcnt lgkmcnt(6)
    v_mfma_f32_16x16x32_bf16 v[128:131], v[236:239], v[48:51], v[128:131]
    ds_read_b64_tr_b16 v[228:229], v5 offset:49184
    s_mov_b32 s23, 0x8000
    buffer_load_dwordx4 v[40:43], v6, s[8:11], s23 offen offset:1024 sc1
    v_mfma_f32_16x16x32_bf16 v[132:135], v[236:239], v[52:55], v[132:135]
    ds_read_b64_tr_b16 v[230:231], v5 offset:50208
    s_waitcnt lgkmcnt(6)
    v_mfma_f32_16x16x32_bf16 v[136:139], v[240:243], v[48:51], v[136:139]
    ds_read_b64_tr_b16 v[232:233], v4 offset:49408
    v_mfma_f32_16x16x32_bf16 v[140:143], v[240:243], v[52:55], v[140:143]
    ds_read_b64_tr_b16 v[234:235], v4 offset:50432
    s_mov_b32 s23, 0x28000
    buffer_load_dwordx4 v[44:47], v6, s[8:11], s23 offen offset:1024 sc1
    s_waitcnt lgkmcnt(6)
    v_mfma_f32_16x16x32_bf16 v[144:147], v[244:247], v[48:51], v[144:147]
    ds_read_b64_tr_b16 v[236:237], v5 offset:49440
    v_mfma_f32_16x16x32_bf16 v[148:151], v[244:247], v[52:55], v[148:151]
    ds_read_b64_tr_b16 v[238:239], v5 offset:50464
    s_waitcnt vmcnt(13) lgkmcnt(6)
    v_mfma_f32_16x16x32_bf16 v[88:91], v[224:227], v[56:59], v[88:91]
    ds_read_b64_tr_b16 v[240:241], v4 offset:49664
    s_waitcnt vmcnt(12)
    v_mfma_f32_16x16x32_bf16 v[92:95], v[224:227], v[60:63], v[92:95]
    s_add_u32 s22, s24, 0x290000
    s_add_u32 m0, s20, 0x14000
    s_nop 0
    buffer_load_dwordx4 v3, s[4:7], s22 offen lds
    ds_read_b64_tr_b16 v[242:243], v4 offset:50688
    s_waitcnt lgkmcnt(6)
    v_mfma_f32_16x16x32_bf16 v[96:99], v[228:231], v[56:59], v[96:99]
    ds_read_b64_tr_b16 v[244:245], v5 offset:49696
    v_mfma_f32_16x16x32_bf16 v[100:103], v[228:231], v[60:63], v[100:103]
    ds_read_b64_tr_b16 v[246:247], v5 offset:50720
    s_waitcnt lgkmcnt(6)
    v_mfma_f32_16x16x32_bf16 v[104:107], v[232:235], v[56:59], v[104:107]
    s_add_u32 s22, s24, 0x292000
    s_add_u32 m0, s20, 0x14400
    s_nop 0
    buffer_load_dwordx4 v3, s[4:7], s22 offen lds
    ds_read_b64_tr_b16 v[224:225], v4 offset:49920
    v_mfma_f32_16x16x32_bf16 v[108:111], v[232:235], v[60:63], v[108:111]
    ds_read_b64_tr_b16 v[226:227], v4 offset:50944
    s_waitcnt lgkmcnt(6)
    v_mfma_f32_16x16x32_bf16 v[112:115], v[236:239], v[56:59], v[112:115]
    ds_read_b64_tr_b16 v[228:229], v5 offset:49952
    v_mfma_f32_16x16x32_bf16 v[116:119], v[236:239], v[60:63], v[116:119]
    ds_read_b64_tr_b16 v[230:231], v5 offset:50976
    s_waitcnt lgkmcnt(6)
    v_mfma_f32_16x16x32_bf16 v[120:123], v[240:243], v[56:59], v[120:123]
    v_mfma_f32_16x16x32_bf16 v[124:127], v[240:243], v[60:63], v[124:127]
    s_waitcnt vmcnt(12)
    s_barrier
    ds_read_b64_tr_b16 v[232:233], v7 offset:0
    ds_read_b64_tr_b16 v[234:235], v7 offset:1024
    s_waitcnt lgkmcnt(6)
    v_mfma_f32_16x16x32_bf16 v[128:131], v[244:247], v[56:59], v[128:131]
    ds_read_b64_tr_b16 v[236:237], v8 offset:32
    s_mov_b32 s23, 0xa000
    buffer_load_dwordx4 v[48:51], v6, s[8:11], s23 offen offset:1024 sc1
    v_mfma_f32_16x16x32_bf16 v[132:135], v[244:247], v[60:63], v[132:135]
    ds_read_b64_tr_b16 v[238:239], v8 offset:1056
    s_waitcnt lgkmcnt(6)
    v_mfma_f32_16x16x32_bf16 v[136:139], v[224:227], v[56:59], v[136:139]
    ds_read_b64_tr_b16 v[240:241], v7 offset:256
    v_mfma_f32_16x16x32_bf16 v[140:143], v[224:227], v[60:63], v[140:143]
    ds_read_b64_tr_b16 v[242:243], v7 offset:1280
    s_mov_b32 s23, 0x2a000
    buffer_load_dwordx4 v[52:55], v6, s[8:11], s23 offen offset:1024 sc1
    s_waitcnt lgkmcnt(6)
    v_mfma_f32_16x16x32_bf16 v[144:147], v[228:231], v[56:59], v[144:147]
    ds_read_b64_tr_b16 v[244:245], v8 offset:288
    v_mfma_f32_16x16x32_bf16 v[148:151], v[228:231], v[60:63], v[148:151]
    ds_read_b64_tr_b16 v[246:247], v8 offset:1312
    s_waitcnt vmcnt(13) lgkmcnt(6)
    v_mfma_f32_16x16x32_bf16 v[88:91], v[232:235], v[24:27], v[88:91]
    ds_read_b64_tr_b16 v[224:225], v7 offset:512
    s_waitcnt vmcnt(12)
    v_mfma_f32_16x16x32_bf16 v[92:95], v[232:235], v[28:31], v[92:95]
    s_add_u32 s22, s24, 0x310000
    s_add_u32 m0, s20, 0x18000
    s_nop 0
    buffer_load_dwordx4 v3, s[4:7], s22 offen lds
    ds_read_b64_tr_b16 v[226:227], v7 offset:1536
    s_waitcnt lgkmcnt(6)
    v_mfma_f32_16x16x32_bf16 v[96:99], v[236:239], v[24:27], v[96:99]
    ds_read_b64_tr_b16 v[228:229], v8 offset:544
    v_mfma_f32_16x16x32_bf16 v[100:103], v[236:239], v[28:31], v[100:103]
    ds_read_b64_tr_b16 v[230:231], v8 offset:1568
    s_waitcnt lgkmcnt(6)
    v_mfma_f32_16x16x32_bf16 v[104:107], v[240:243], v[24:27], v[104:107]
    s_add_u32 s22, s24, 0x312000
    s_add_u32 m0, s20, 0x18400
    s_nop 0
    buffer_load_dwordx4 v3, s[4:7], s22 offen lds
    ds_read_b64_tr_b16 v[232:233], v7 offset:768
    v_mfma_f32_16x16x32_bf16 v[108:111], v[240:243], v[28:31], v[108:111]
    ds_read_b64_tr_b16 v[234:235], v7 offset:1792
    s_waitcnt lgkmcnt(6)
    v_mfma_f32_16x16x32_bf16 v[112:115], v[244:247], v[24:27], v[112:115]
    ds_read_b64_tr_b16 v[236:237], v8 offset:800
    v_mfma_f32_16x16x32_bf16 v[116:119], v[244:247], v[28:31], v[116:119]
    ds_read_b64_tr_b16 v[238:239], v8 offset:1824
    s_waitcnt lgkmcnt(6)
    v_mfma_f32_16x16x32_bf16 v[120:123], v[224:227], v[24:27], v[120:123]
    v_mfma_f32_16x16x32_bf16 v[124:127], v[224:227], v[28:31], v[124:127]
    s_waitcnt vmcnt(12)
    s_barrier
    ds_read_b64_tr_b16 v[240:241], v7 offset:16384
    ds_read_b64_tr_b16 v[242:243], v7 offset:17408
    s_add_u32 s19, s19, 8192
    buffer_load_dword v12, v13, s[8:11], s19 offen sc1
    s_waitcnt lgkmcnt(6)
    v_mfma_f32_16x16x32_bf16 v[128:131], v[228:231], v[24:27], v[128:131]
    ds_read_b64_tr_b16 v[244:245], v8 offset:16416
    s_mov_b32 s23, 0xc000
    buffer_load_dwordx4 v[56:59], v6, s[8:11], s23 offen offset:1024 sc1
    v_mfma_f32_16x16x32_bf16 v[132:135], v[228:231], v[28:31], v[132:135]
    ds_read_b64_tr_b16 v[246:247], v8 offset:17440
    s_waitcnt lgkmcnt(6)
    v_mfma_f32_16x16x32_bf16 v[136:139], v[232:235], v[24:27], v[136:139]
    ds_read_b64_tr_b16 v[224:225], v7 offset:16640
    v_mfma_f32_16x16x32_bf16 v[140:143], v[232:235], v[28:31], v[140:143]
    ds_read_b64_tr_b16 v[226:227], v7 offset:17664
    s_mov_b32 s23, 0x2c000
    buffer_load_dwordx4 v[60:63], v6, s[8:11], s23 offen offset:1024 sc1
    s_waitcnt lgkmcnt(6)
    v_mfma_f32_16x16x32_bf16 v[144:147], v[236:239], v[24:27], v[144:147]
    ds_read_b64_tr_b16 v[228:229], v8 offset:16672
    v_mfma_f32_16x16x32_bf16 v[148:151], v[236:239], v[28:31], v[148:151]
    ds_read_b64_tr_b16 v[230:231], v8 offset:17696
    s_waitcnt vmcnt(14) lgkmcnt(6)
    v_mfma_f32_16x16x32_bf16 v[88:91], v[240:243], v[32:35], v[88:91]
    ds_read_b64_tr_b16 v[232:233], v7 offset:16896
    s_waitcnt vmcnt(13)
    v_mfma_f32_16x16x32_bf16 v[92:95], v[240:243], v[36:39], v[92:95]
    s_add_u32 s22, s24, 0x390000
    s_add_u32 m0, s20, 0x1c000
    s_nop 0
    buffer_load_dwordx4 v3, s[4:7], s22 offen lds
    ds_read_b64_tr_b16 v[234:235], v7 offset:17920
    s_waitcnt lgkmcnt(6)
    v_mfma_f32_16x16x32_bf16 v[96:99], v[244:247], v[32:35], v[96:99]
    ds_read_b64_tr_b16 v[236:237], v8 offset:16928
    v_mfma_f32_16x16x32_bf16 v[100:103], v[244:247], v[36:39], v[100:103]
    ds_read_b64_tr_b16 v[238:239], v8 offset:17952
    s_waitcnt lgkmcnt(6)
    v_mfma_f32_16x16x32_bf16 v[104:107], v[224:227], v[32:35], v[104:107]
    s_add_u32 s22, s24, 0x392000
    s_add_u32 m0, s20, 0x1c400
    s_nop 0
    buffer_load_dwordx4 v3, s[4:7], s22 offen lds
    ds_read_b64_tr_b16 v[240:241], v7 offset:17152
    v_mfma_f32_16x16x32_bf16 v[108:111], v[224:227], v[36:39], v[108:111]
    ds_read_b64_tr_b16 v[242:243], v7 offset:18176
    s_waitcnt lgkmcnt(6)
    v_mfma_f32_16x16x32_bf16 v[112:115], v[228:231], v[32:35], v[112:115]
    ds_read_b64_tr_b16 v[244:245], v8 offset:17184
    v_mfma_f32_16x16x32_bf16 v[116:119], v[228:231], v[36:39], v[116:119]
    ds_read_b64_tr_b16 v[246:247], v8 offset:18208
    s_waitcnt lgkmcnt(6)
    v_mfma_f32_16x16x32_bf16 v[120:123], v[232:235], v[32:35], v[120:123]
    v_mfma_f32_16x16x32_bf16 v[124:127], v[232:235], v[36:39], v[124:127]
    s_waitcnt vmcnt(13)
    s_barrier
    ds_read_b64_tr_b16 v[224:225], v4 offset:0
    ds_read_b64_tr_b16 v[226:227], v4 offset:1024
    s_waitcnt lgkmcnt(6)
    v_mfma_f32_16x16x32_bf16 v[128:131], v[236:239], v[32:35], v[128:131]
    ds_read_b64_tr_b16 v[228:229], v5 offset:32
    s_mov_b32 s23, 0xe000
    buffer_load_dwordx4 v[24:27], v6, s[8:11], s23 offen offset:1024 sc1
    v_mfma_f32_16x16x32_bf16 v[132:135], v[236:239], v[36:39], v[132:135]
    ds_read_b64_tr_b16 v[230:231], v5 offset:1056
    s_waitcnt lgkmcnt(6)
    v_mfma_f32_16x16x32_bf16 v[136:139], v[240:243], v[32:35], v[136:139]
    ds_read_b64_tr_b16 v[232:233], v4 offset:256
    v_mfma_f32_16x16x32_bf16 v[140:143], v[240:243], v[36:39], v[140:143]
    ds_read_b64_tr_b16 v[234:235], v4 offset:1280
    s_mov_b32 s23, 0x2e000
    buffer_load_dwordx4 v[28:31], v6, s[8:11], s23 offen offset:1024 sc1
    s_waitcnt lgkmcnt(6)
    v_mfma_f32_16x16x32_bf16 v[144:147], v[244:247], v[32:35], v[144:147]
    ds_read_b64_tr_b16 v[236:237], v5 offset:288
    v_mfma_f32_16x16x32_bf16 v[148:151], v[244:247], v[36:39], v[148:151]
    ds_read_b64_tr_b16 v[238:239], v5 offset:1312
    s_waitcnt vmcnt(6)
    v_cmp_ne_u32 vcc, s28, v12
    s_cbranch_vccnz adaLN_cond__sliding_block_cached__moe_arch_mod__prompt_kernel_o219r
adaLN_cond__sliding_block_cached__moe_arch_mod__prompt_kernel_o219b:
    s_waitcnt lgkmcnt(6)
    v_mfma_f32_16x16x32_bf16 v[88:91], v[224:227], v[40:43], v[88:91]
    ds_read_b64_tr_b16 v[240:241], v4 offset:512
    v_mfma_f32_16x16x32_bf16 v[92:95], v[224:227], v[44:47], v[92:95]
    s_add_u32 s22, s24, 0x20000
    s_add_u32 m0, s20, 0x20000
    s_nop 0
    buffer_load_dwordx4 v3, s[4:7], s22 offen lds
    ds_read_b64_tr_b16 v[242:243], v4 offset:1536
    s_waitcnt lgkmcnt(6)
    v_mfma_f32_16x16x32_bf16 v[96:99], v[228:231], v[40:43], v[96:99]
    ds_read_b64_tr_b16 v[244:245], v5 offset:544
    v_mfma_f32_16x16x32_bf16 v[100:103], v[228:231], v[44:47], v[100:103]
    ds_read_b64_tr_b16 v[246:247], v5 offset:1568
    s_waitcnt lgkmcnt(6)
    v_mfma_f32_16x16x32_bf16 v[104:107], v[232:235], v[40:43], v[104:107]
    s_add_u32 s22, s24, 0x22000
    s_add_u32 m0, s20, 0x20400
    s_nop 0
    buffer_load_dwordx4 v3, s[4:7], s22 offen lds
    ds_read_b64_tr_b16 v[224:225], v4 offset:768
    v_mfma_f32_16x16x32_bf16 v[108:111], v[232:235], v[44:47], v[108:111]
    ds_read_b64_tr_b16 v[226:227], v4 offset:1792
    s_waitcnt lgkmcnt(6)
    v_mfma_f32_16x16x32_bf16 v[112:115], v[236:239], v[40:43], v[112:115]
    ds_read_b64_tr_b16 v[228:229], v5 offset:800
    v_mfma_f32_16x16x32_bf16 v[116:119], v[236:239], v[44:47], v[116:119]
    ds_read_b64_tr_b16 v[230:231], v5 offset:1824
    s_waitcnt lgkmcnt(6)
    v_mfma_f32_16x16x32_bf16 v[120:123], v[240:243], v[40:43], v[120:123]
    v_mfma_f32_16x16x32_bf16 v[124:127], v[240:243], v[44:47], v[124:127]
    s_barrier
    ds_read_b64_tr_b16 v[232:233], v4 offset:16384
    ds_read_b64_tr_b16 v[234:235], v4 offset:17408
    s_waitcnt lgkmcnt(6)
    v_mfma_f32_16x16x32_bf16 v[128:131], v[244:247], v[40:43], v[128:131]
    ds_read_b64_tr_b16 v[236:237], v5 offset:16416
    s_mov_b32 s23, 0x0
    buffer_load_dwordx4 v[32:35], v6, s[8:11], s23 offen offset:2048 sc1
    v_mfma_f32_16x16x32_bf16 v[132:135], v[244:247], v[44:47], v[132:135]
    ds_read_b64_tr_b16 v[238:239], v5 offset:17440
    s_waitcnt lgkmcnt(6)
    v_mfma_f32_16x16x32_bf16 v[136:139], v[224:227], v[40:43], v[136:139]
    ds_read_b64_tr_b16 v[240:241], v4 offset:16640
    v_mfma_f32_16x16x32_bf16 v[140:143], v[224:227], v[44:47], v[140:143]
    ds_read_b64_tr_b16 v[242:243], v4 offset:17664
    s_mov_b32 s23, 0x20000
    buffer_load_dwordx4 v[36:39], v6, s[8:11], s23 offen offset:2048 sc1
    s_waitcnt lgkmcnt(6)
    v_mfma_f32_16x16x32_bf16 v[144:147], v[228:231], v[40:43], v[144:147]
    ds_read_b64_tr_b16 v[244:245], v5 offset:16672
    v_mfma_f32_16x16x32_bf16 v[148:151], v[228:231], v[44:47], v[148:151]
    ds_read_b64_tr_b16 v[246:247], v5 offset:17696
    s_waitcnt lgkmcnt(6)
    v_mfma_f32_16x16x32_bf16 v[88:91], v[232:235], v[48:51], v[88:91]
    ds_read_b64_tr_b16 v[224:225], v4 offset:16896
    v_mfma_f32_16x16x32_bf16 v[92:95], v[232:235], v[52:55], v[92:95]
    s_add_u32 s22, s24, 0xa0000
    s_add_u32 m0, s20, 0x24000
    s_nop 0
    buffer_load_dwordx4 v3, s[4:7], s22 offen lds
    ds_read_b64_tr_b16 v[226:227], v4 offset:17920
    s_waitcnt lgkmcnt(6)
    v_mfma_f32_16x16x32_bf16 v[96:99], v[236:239], v[48:51], v[96:99]
    ds_read_b64_tr_b16 v[228:229], v5 offset:16928
    v_mfma_f32_16x16x32_bf16 v[100:103], v[236:239], v[52:55], v[100:103]
    ds_read_b64_tr_b16 v[230:231], v5 offset:17952
    s_waitcnt lgkmcnt(6)
    v_mfma_f32_16x16x32_bf16 v[104:107], v[240:243], v[48:51], v[104:107]
    s_add_u32 s22, s24, 0xa2000
    s_add_u32 m0, s20, 0x24400
    s_nop 0
    buffer_load_dwordx4 v3, s[4:7], s22 offen lds
    ds_read_b64_tr_b16 v[232:233], v4 offset:17152
    v_mfma_f32_16x16x32_bf16 v[108:111], v[240:243], v[52:55], v[108:111]
    ds_read_b64_tr_b16 v[234:235], v4 offset:18176
    s_waitcnt lgkmcnt(6)
    v_mfma_f32_16x16x32_bf16 v[112:115], v[244:247], v[48:51], v[112:115]
    ds_read_b64_tr_b16 v[236:237], v5 offset:17184
    v_mfma_f32_16x16x32_bf16 v[116:119], v[244:247], v[52:55], v[116:119]
    ds_read_b64_tr_b16 v[238:239], v5 offset:18208
    s_waitcnt lgkmcnt(6)
    v_mfma_f32_16x16x32_bf16 v[120:123], v[224:227], v[48:51], v[120:123]
    v_mfma_f32_16x16x32_bf16 v[124:127], v[224:227], v[52:55], v[124:127]
    s_barrier
    ds_read_b64_tr_b16 v[240:241], v4 offset:32768
    ds_read_b64_tr_b16 v[242:243], v4 offset:33792
    s_waitcnt lgkmcnt(6)
    v_mfma_f32_16x16x32_bf16 v[128:131], v[228:231], v[48:51], v[128:131]
    ds_read_b64_tr_b16 v[244:245], v5 offset:32800
    s_mov_b32 s23, 0x2000
    buffer_load_dwordx4 v[40:43], v6, s[8:11], s23 offen offset:2048 sc1
    v_mfma_f32_16x16x32_bf16 v[132:135], v[228:231], v[52:55], v[132:135]
    ds_read_b64_tr_b16 v[246:247], v5 offset:33824
    s_waitcnt lgkmcnt(6)
    v_mfma_f32_16x16x32_bf16 v[136:139], v[232:235], v[48:51], v[136:139]
    ds_read_b64_tr_b16 v[224:225], v4 offset:33024
    v_mfma_f32_16x16x32_bf16 v[140:143], v[232:235], v[52:55], v[140:143]
    ds_read_b64_tr_b16 v[226:227], v4 offset:34048
    s_mov_b32 s23, 0x22000
    buffer_load_dwordx4 v[44:47], v6, s[8:11], s23 offen offset:2048 sc1
    s_waitcnt lgkmcnt(6)
    v_mfma_f32_16x16x32_bf16 v[144:147], v[236:239], v[48:51], v[144:147]
    ds_read_b64_tr_b16 v[228:229], v5 offset:33056
    v_mfma_f32_16x16x32_bf16 v[148:151], v[236:239], v[52:55], v[148:151]
    ds_read_b64_tr_b16 v[230:231], v5 offset:34080
    s_waitcnt vmcnt(13) lgkmcnt(6)
    v_mfma_f32_16x16x32_bf16 v[88:91], v[240:243], v[56:59], v[88:91]
    ds_read_b64_tr_b16 v[232:233], v4 offset:33280
    s_waitcnt vmcnt(12)
    v_mfma_f32_16x16x32_bf16 v[92:95], v[240:243], v[60:63], v[92:95]
    s_add_u32 s22, s24, 0x120000
    s_add_u32 m0, s20, 0x10000
    s_nop 0
    buffer_load_dwordx4 v3, s[4:7], s22 offen lds
    ds_read_b64_tr_b16 v[234:235], v4 offset:34304
    s_waitcnt lgkmcnt(6)
    v_mfma_f32_16x16x32_bf16 v[96:99], v[244:247], v[56:59], v[96:99]
    ds_read_b64_tr_b16 v[236:237], v5 offset:33312
    v_mfma_f32_16x16x32_bf16 v[100:103], v[244:247], v[60:63], v[100:103]
    ds_read_b64_tr_b16 v[238:239], v5 offset:34336
    s_waitcnt lgkmcnt(6)
    v_mfma_f32_16x16x32_bf16 v[104:107], v[224:227], v[56:59], v[104:107]
    s_add_u32 s22, s24, 0x122000
    s_add_u32 m0, s20, 0x10400
    s_nop 0
    buffer_load_dwordx4 v3, s[4:7], s22 offen lds
    ds_read_b64_tr_b16 v[240:241], v4 offset:33536
    v_mfma_f32_16x16x32_bf16 v[108:111], v[224:227], v[60:63], v[108:111]
    ds_read_b64_tr_b16 v[242:243], v4 offset:34560
    s_waitcnt lgkmcnt(6)
    v_mfma_f32_16x16x32_bf16 v[112:115], v[228:231], v[56:59], v[112:115]
    ds_read_b64_tr_b16 v[244:245], v5 offset:33568
    v_mfma_f32_16x16x32_bf16 v[116:119], v[228:231], v[60:63], v[116:119]
    ds_read_b64_tr_b16 v[246:247], v5 offset:34592
    s_waitcnt lgkmcnt(6)
    v_mfma_f32_16x16x32_bf16 v[120:123], v[232:235], v[56:59], v[120:123]
    v_mfma_f32_16x16x32_bf16 v[124:127], v[232:235], v[60:63], v[124:127]
    s_waitcnt vmcnt(12)
    s_barrier
    ds_read_b64_tr_b16 v[224:225], v4 offset:49152
    ds_read_b64_tr_b16 v[226:227], v4 offset:50176
    s_waitcnt lgkmcnt(6)
    v_mfma_f32_16x16x32_bf16 v[128:131], v[236:239], v[56:59], v[128:131]
    ds_read_b64_tr_b16 v[228:229], v5 offset:49184
    s_mov_b32 s23, 0x4000
    buffer_load_dwordx4 v[48:51], v6, s[8:11], s23 offen offset:2048 sc1
    v_mfma_f32_16x16x32_bf16 v[132:135], v[236:239], v[60:63], v[132:135]
    ds_read_b64_tr_b16 v[230:231], v5 offset:50208
    s_waitcnt lgkmcnt(6)
    v_mfma_f32_16x16x32_bf16 v[136:139], v[240:243], v[56:59], v[136:139]
    ds_read_b64_tr_b16 v[232:233], v4 offset:49408
    v_mfma_f32_16x16x32_bf16 v[140:143], v[240:243], v[60:63], v[140:143]
    ds_read_b64_tr_b16 v[234:235], v4 offset:50432
    s_mov_b32 s23, 0x24000
    buffer_load_dwordx4 v[52:55], v6, s[8:11], s23 offen offset:2048 sc1
    s_waitcnt lgkmcnt(6)
    v_mfma_f32_16x16x32_bf16 v[144:147], v[244:247], v[56:59], v[144:147]
    ds_read_b64_tr_b16 v[236:237], v5 offset:49440
    v_mfma_f32_16x16x32_bf16 v[148:151], v[244:247], v[60:63], v[148:151]
    ds_read_b64_tr_b16 v[238:239], v5 offset:50464
    s_waitcnt vmcnt(13) lgkmcnt(6)
    v_mfma_f32_16x16x32_bf16 v[88:91], v[224:227], v[24:27], v[88:91]
    ds_read_b64_tr_b16 v[240:241], v4 offset:49664
    s_waitcnt vmcnt(12)
    v_mfma_f32_16x16x32_bf16 v[92:95], v[224:227], v[28:31], v[92:95]
    s_add_u32 s22, s24, 0x1a0000
    s_add_u32 m0, s20, 0x14000
    s_nop 0
    buffer_load_dwordx4 v3, s[4:7], s22 offen lds
    ds_read_b64_tr_b16 v[242:243], v4 offset:50688
    s_waitcnt lgkmcnt(6)
    v_mfma_f32_16x16x32_bf16 v[96:99], v[228:231], v[24:27], v[96:99]
    ds_read_b64_tr_b16 v[244:245], v5 offset:49696
    v_mfma_f32_16x16x32_bf16 v[100:103], v[228:231], v[28:31], v[100:103]
    ds_read_b64_tr_b16 v[246:247], v5 offset:50720
    s_waitcnt lgkmcnt(6)
    v_mfma_f32_16x16x32_bf16 v[104:107], v[232:235], v[24:27], v[104:107]
    s_add_u32 s22, s24, 0x1a2000
    s_add_u32 m0, s20, 0x14400
    s_nop 0
    buffer_load_dwordx4 v3, s[4:7], s22 offen lds
    ds_read_b64_tr_b16 v[224:225], v4 offset:49920
    v_mfma_f32_16x16x32_bf16 v[108:111], v[232:235], v[28:31], v[108:111]
    ds_read_b64_tr_b16 v[226:227], v4 offset:50944
    s_waitcnt lgkmcnt(6)
    v_mfma_f32_16x16x32_bf16 v[112:115], v[236:239], v[24:27], v[112:115]
    ds_read_b64_tr_b16 v[228:229], v5 offset:49952
    v_mfma_f32_16x16x32_bf16 v[116:119], v[236:239], v[28:31], v[116:119]
    ds_read_b64_tr_b16 v[230:231], v5 offset:50976
    s_waitcnt lgkmcnt(6)
    v_mfma_f32_16x16x32_bf16 v[120:123], v[240:243], v[24:27], v[120:123]
    v_mfma_f32_16x16x32_bf16 v[124:127], v[240:243], v[28:31], v[124:127]
    s_waitcnt vmcnt(12)
    s_barrier
    ds_read_b64_tr_b16 v[232:233], v7 offset:0
    ds_read_b64_tr_b16 v[234:235], v7 offset:1024
    s_waitcnt lgkmcnt(6)
    v_mfma_f32_16x16x32_bf16 v[128:131], v[244:247], v[24:27], v[128:131]
    ds_read_b64_tr_b16 v[236:237], v8 offset:32
    s_mov_b32 s23, 0x6000
    buffer_load_dwordx4 v[56:59], v6, s[8:11], s23 offen offset:2048 sc1
    v_mfma_f32_16x16x32_bf16 v[132:135], v[244:247], v[28:31], v[132:135]
    ds_read_b64_tr_b16 v[238:239], v8 offset:1056
    s_waitcnt lgkmcnt(6)
    v_mfma_f32_16x16x32_bf16 v[136:139], v[224:227], v[24:27], v[136:139]
    ds_read_b64_tr_b16 v[240:241], v7 offset:256
    v_mfma_f32_16x16x32_bf16 v[140:143], v[224:227], v[28:31], v[140:143]
    ds_read_b64_tr_b16 v[242:243], v7 offset:1280
    s_mov_b32 s23, 0x26000
    buffer_load_dwordx4 v[60:63], v6, s[8:11], s23 offen offset:2048 sc1
    s_waitcnt lgkmcnt(6)
    v_mfma_f32_16x16x32_bf16 v[144:147], v[228:231], v[24:27], v[144:147]
    ds_read_b64_tr_b16 v[244:245], v8 offset:288
    v_mfma_f32_16x16x32_bf16 v[148:151], v[228:231], v[28:31], v[148:151]
    ds_read_b64_tr_b16 v[246:247], v8 offset:1312
    s_waitcnt vmcnt(13) lgkmcnt(6)
    v_mfma_f32_16x16x32_bf16 v[88:91], v[232:235], v[32:35], v[88:91]
    ds_read_b64_tr_b16 v[224:225], v7 offset:512
    s_waitcnt vmcnt(12)
    v_mfma_f32_16x16x32_bf16 v[92:95], v[232:235], v[36:39], v[92:95]
    s_add_u32 s22, s24, 0x220000
    s_add_u32 m0, s20, 0x18000
    s_nop 0
    buffer_load_dwordx4 v3, s[4:7], s22 offen lds
    ds_read_b64_tr_b16 v[226:227], v7 offset:1536
    s_waitcnt lgkmcnt(6)
    v_mfma_f32_16x16x32_bf16 v[96:99], v[236:239], v[32:35], v[96:99]
    ds_read_b64_tr_b16 v[228:229], v8 offset:544
    v_mfma_f32_16x16x32_bf16 v[100:103], v[236:239], v[36:39], v[100:103]
    ds_read_b64_tr_b16 v[230:231], v8 offset:1568
    s_waitcnt lgkmcnt(6)
    v_mfma_f32_16x16x32_bf16 v[104:107], v[240:243], v[32:35], v[104:107]
    s_add_u32 s22, s24, 0x222000
    s_add_u32 m0, s20, 0x18400
    s_nop 0
    buffer_load_dwordx4 v3, s[4:7], s22 offen lds
    ds_read_b64_tr_b16 v[232:233], v7 offset:768
    v_mfma_f32_16x16x32_bf16 v[108:111], v[240:243], v[36:39], v[108:111]
    ds_read_b64_tr_b16 v[234:235], v7 offset:1792
    s_mov_b32 s16, 0x544000
    buffer_load_dwordx4 v[184:187], v2, s[8:11], s16 offen sc1
    s_waitcnt lgkmcnt(6)
    v_mfma_f32_16x16x32_bf16 v[112:115], v[244:247], v[32:35], v[112:115]
    ds_read_b64_tr_b16 v[236:237], v8 offset:800
    v_mfma_f32_16x16x32_bf16 v[116:119], v[244:247], v[36:39], v[116:119]
    ds_read_b64_tr_b16 v[238:239], v8 offset:1824
    s_waitcnt lgkmcnt(6)
    v_mfma_f32_16x16x32_bf16 v[120:123], v[224:227], v[32:35], v[120:123]
    v_mfma_f32_16x16x32_bf16 v[124:127], v[224:227], v[36:39], v[124:127]
    s_waitcnt vmcnt(13)
    s_barrier
    ds_read_b64_tr_b16 v[240:241], v7 offset:16384
    ds_read_b64_tr_b16 v[242:243], v7 offset:17408
    s_waitcnt lgkmcnt(6)
    v_mfma_f32_16x16x32_bf16 v[128:131], v[228:231], v[32:35], v[128:131]
    ds_read_b64_tr_b16 v[244:245], v8 offset:16416
    s_mov_b32 s23, 0x8000
    buffer_load_dwordx4 v[24:27], v6, s[8:11], s23 offen offset:2048 sc1
    v_mfma_f32_16x16x32_bf16 v[132:135], v[228:231], v[36:39], v[132:135]
    ds_read_b64_tr_b16 v[246:247], v8 offset:17440
    s_waitcnt lgkmcnt(6)
    v_mfma_f32_16x16x32_bf16 v[136:139], v[232:235], v[32:35], v[136:139]
    ds_read_b64_tr_b16 v[224:225], v7 offset:16640
    v_mfma_f32_16x16x32_bf16 v[140:143], v[232:235], v[36:39], v[140:143]
    ds_read_b64_tr_b16 v[226:227], v7 offset:17664
    s_mov_b32 s23, 0x28000
    buffer_load_dwordx4 v[28:31], v6, s[8:11], s23 offen offset:2048 sc1
    s_waitcnt lgkmcnt(6)
    v_mfma_f32_16x16x32_bf16 v[144:147], v[236:239], v[32:35], v[144:147]
    ds_read_b64_tr_b16 v[228:229], v8 offset:16672
    v_mfma_f32_16x16x32_bf16 v[148:151], v[236:239], v[36:39], v[148:151]
    ds_read_b64_tr_b16 v[230:231], v8 offset:17696
    s_waitcnt vmcnt(14) lgkmcnt(6)
    v_mfma_f32_16x16x32_bf16 v[88:91], v[240:243], v[40:43], v[88:91]
    ds_read_b64_tr_b16 v[232:233], v7 offset:16896
    s_waitcnt vmcnt(13)
    v_mfma_f32_16x16x32_bf16 v[92:95], v[240:243], v[44:47], v[92:95]
    s_add_u32 s22, s24, 0x2a0000
    s_add_u32 m0, s20, 0x1c000
    s_nop 0
    buffer_load_dwordx4 v3, s[4:7], s22 offen lds
    ds_read_b64_tr_b16 v[234:235], v7 offset:17920
    s_waitcnt lgkmcnt(6)
    v_mfma_f32_16x16x32_bf16 v[96:99], v[244:247], v[40:43], v[96:99]
    ds_read_b64_tr_b16 v[236:237], v8 offset:16928
    v_mfma_f32_16x16x32_bf16 v[100:103], v[244:247], v[44:47], v[100:103]
    ds_read_b64_tr_b16 v[238:239], v8 offset:17952
    s_waitcnt lgkmcnt(6)
    v_mfma_f32_16x16x32_bf16 v[104:107], v[224:227], v[40:43], v[104:107]
    s_add_u32 s22, s24, 0x2a2000
    s_add_u32 m0, s20, 0x1c400
    s_nop 0
    buffer_load_dwordx4 v3, s[4:7], s22 offen lds
    ds_read_b64_tr_b16 v[240:241], v7 offset:17152
    v_mfma_f32_16x16x32_bf16 v[108:111], v[224:227], v[44:47], v[108:111]
    ds_read_b64_tr_b16 v[242:243], v7 offset:18176
    s_waitcnt lgkmcnt(6)
    v_mfma_f32_16x16x32_bf16 v[112:115], v[228:231], v[40:43], v[112:115]
    ds_read_b64_tr_b16 v[244:245], v8 offset:17184
    v_mfma_f32_16x16x32_bf16 v[116:119], v[228:231], v[44:47], v[116:119]
    ds_read_b64_tr_b16 v[246:247], v8 offset:18208
    s_waitcnt lgkmcnt(6)
    v_mfma_f32_16x16x32_bf16 v[120:123], v[232:235], v[40:43], v[120:123]
    v_mfma_f32_16x16x32_bf16 v[124:127], v[232:235], v[44:47], v[124:127]
    s_waitcnt vmcnt(13)
    s_barrier
    ds_read_b64_tr_b16 v[224:225], v4 offset:0
    ds_read_b64_tr_b16 v[226:227], v4 offset:1024
    s_waitcnt lgkmcnt(6)
    v_mfma_f32_16x16x32_bf16 v[128:131], v[236:239], v[40:43], v[128:131]
    ds_read_b64_tr_b16 v[228:229], v5 offset:32
    s_mov_b32 s23, 0xa000
    buffer_load_dwordx4 v[32:35], v6, s[8:11], s23 offen offset:2048 sc1
    v_mfma_f32_16x16x32_bf16 v[132:135], v[236:239], v[44:47], v[132:135]
    ds_read_b64_tr_b16 v[230:231], v5 offset:1056
    s_waitcnt lgkmcnt(6)
    v_mfma_f32_16x16x32_bf16 v[136:139], v[240:243], v[40:43], v[136:139]
    ds_read_b64_tr_b16 v[232:233], v4 offset:256
    v_mfma_f32_16x16x32_bf16 v[140:143], v[240:243], v[44:47], v[140:143]
    ds_read_b64_tr_b16 v[234:235], v4 offset:1280
    s_mov_b32 s23, 0x2a000
    buffer_load_dwordx4 v[36:39], v6, s[8:11], s23 offen offset:2048 sc1
    s_waitcnt lgkmcnt(6)
    v_mfma_f32_16x16x32_bf16 v[144:147], v[244:247], v[40:43], v[144:147]
    ds_read_b64_tr_b16 v[236:237], v5 offset:288
    v_mfma_f32_16x16x32_bf16 v[148:151], v[244:247], v[44:47], v[148:151]
    ds_read_b64_tr_b16 v[238:239], v5 offset:1312
    s_waitcnt vmcnt(14) lgkmcnt(6)
    v_mfma_f32_16x16x32_bf16 v[88:91], v[224:227], v[48:51], v[88:91]
    ds_read_b64_tr_b16 v[240:241], v4 offset:512
    s_waitcnt vmcnt(13)
    v_mfma_f32_16x16x32_bf16 v[92:95], v[224:227], v[52:55], v[92:95]
    s_add_u32 s22, s24, 0x320000
    s_add_u32 m0, s20, 0x20000
    s_nop 0
    buffer_load_dwordx4 v3, s[4:7], s22 offen lds
    ds_read_b64_tr_b16 v[242:243], v4 offset:1536
    s_waitcnt lgkmcnt(6)
    v_mfma_f32_16x16x32_bf16 v[96:99], v[228:231], v[48:51], v[96:99]
    ds_read_b64_tr_b16 v[244:245], v5 offset:544
    v_mfma_f32_16x16x32_bf16 v[100:103], v[228:231], v[52:55], v[100:103]
    ds_read_b64_tr_b16 v[246:247], v5 offset:1568
    s_waitcnt lgkmcnt(6)
    v_mfma_f32_16x16x32_bf16 v[104:107], v[232:235], v[48:51], v[104:107]
    s_add_u32 s22, s24, 0x322000
    s_add_u32 m0, s20, 0x20400
    s_nop 0
    buffer_load_dwordx4 v3, s[4:7], s22 offen lds
    ds_read_b64_tr_b16 v[224:225], v4 offset:768
    v_mfma_f32_16x16x32_bf16 v[108:111], v[232:235], v[52:55], v[108:111]
    ds_read_b64_tr_b16 v[226:227], v4 offset:1792
    s_waitcnt lgkmcnt(6)
    v_mfma_f32_16x16x32_bf16 v[112:115], v[236:239], v[48:51], v[112:115]
    ds_read_b64_tr_b16 v[228:229], v5 offset:800
    v_mfma_f32_16x16x32_bf16 v[116:119], v[236:239], v[52:55], v[116:119]
    ds_read_b64_tr_b16 v[230:231], v5 offset:1824
    s_waitcnt lgkmcnt(6)
    v_mfma_f32_16x16x32_bf16 v[120:123], v[240:243], v[48:51], v[120:123]
    v_mfma_f32_16x16x32_bf16 v[124:127], v[240:243], v[52:55], v[124:127]
    s_waitcnt vmcnt(13)
    s_barrier
    ds_read_b64_tr_b16 v[232:233], v4 offset:16384
    ds_read_b64_tr_b16 v[234:235], v4 offset:17408
    s_add_u32 s19, s19, 8192
    buffer_load_dword v12, v13, s[8:11], s19 offen sc1
    s_waitcnt lgkmcnt(6)
    v_mfma_f32_16x16x32_bf16 v[128:131], v[244:247], v[48:51], v[128:131]
    ds_read_b64_tr_b16 v[236:237], v5 offset:16416
    s_mov_b32 s23, 0xc000
    buffer_load_dwordx4 v[40:43], v6, s[8:11], s23 offen offset:2048 sc1
    v_mfma_f32_16x16x32_bf16 v[132:135], v[244:247], v[52:55], v[132:135]
    ds_read_b64_tr_b16 v[238:239], v5 offset:17440
    s_waitcnt lgkmcnt(6)
    v_mfma_f32_16x16x32_bf16 v[136:139], v[224:227], v[48:51], v[136:139]
    ds_read_b64_tr_b16 v[240:241], v4 offset:16640
    v_mfma_f32_16x16x32_bf16 v[140:143], v[224:227], v[52:55], v[140:143]
    ds_read_b64_tr_b16 v[242:243], v4 offset:17664
    s_mov_b32 s23, 0x2c000
    buffer_load_dwordx4 v[44:47], v6, s[8:11], s23 offen offset:2048 sc1
    s_waitcnt lgkmcnt(6)
    v_mfma_f32_16x16x32_bf16 v[144:147], v[228:231], v[48:51], v[144:147]
    ds_read_b64_tr_b16 v[244:245], v5 offset:16672
    v_mfma_f32_16x16x32_bf16 v[148:151], v[228:231], v[52:55], v[148:151]
    ds_read_b64_tr_b16 v[246:247], v5 offset:17696
    s_waitcnt vmcnt(15) lgkmcnt(6)
    v_mfma_f32_16x16x32_bf16 v[88:91], v[232:235], v[56:59], v[88:91]
    ds_read_b64_tr_b16 v[224:225], v4 offset:16896
    s_waitcnt vmcnt(14)
    v_mfma_f32_16x16x32_bf16 v[92:95], v[232:235], v[60:63], v[92:95]
    s_add_u32 s22, s24, 0x3a0000
    s_add_u32 m0, s20, 0x24000
    s_nop 0
    buffer_load_dwordx4 v3, s[4:7], s22 offen lds
    ds_read_b64_tr_b16 v[226:227], v4 offset:17920
    s_waitcnt lgkmcnt(6)
    v_mfma_f32_16x16x32_bf16 v[96:99], v[236:239], v[56:59], v[96:99]
    ds_read_b64_tr_b16 v[228:229], v5 offset:16928
    v_mfma_f32_16x16x32_bf16 v[100:103], v[236:239], v[60:63], v[100:103]
    ds_read_b64_tr_b16 v[230:231], v5 offset:17952
    s_waitcnt lgkmcnt(6)
    v_mfma_f32_16x16x32_bf16 v[104:107], v[240:243], v[56:59], v[104:107]
    s_add_u32 s22, s24, 0x3a2000
    s_add_u32 m0, s20, 0x24400
    s_nop 0
    buffer_load_dwordx4 v3, s[4:7], s22 offen lds
    ds_read_b64_tr_b16 v[232:233], v4 offset:17152
    v_mfma_f32_16x16x32_bf16 v[108:111], v[240:243], v[60:63], v[108:111]
    ds_read_b64_tr_b16 v[234:235], v4 offset:18176
    s_waitcnt lgkmcnt(6)
    v_mfma_f32_16x16x32_bf16 v[112:115], v[244:247], v[56:59], v[112:115]
    ds_read_b64_tr_b16 v[236:237], v5 offset:17184
    v_mfma_f32_16x16x32_bf16 v[116:119], v[244:247], v[60:63], v[116:119]
    ds_read_b64_tr_b16 v[238:239], v5 offset:18208
    s_waitcnt lgkmcnt(6)
    v_mfma_f32_16x16x32_bf16 v[120:123], v[224:227], v[56:59], v[120:123]
    v_mfma_f32_16x16x32_bf16 v[124:127], v[224:227], v[60:63], v[124:127]
    s_waitcnt vmcnt(14)
    s_barrier
    ds_read_b64_tr_b16 v[240:241], v4 offset:32768
    ds_read_b64_tr_b16 v[242:243], v4 offset:33792
    s_waitcnt lgkmcnt(6)
    v_mfma_f32_16x16x32_bf16 v[128:131], v[228:231], v[56:59], v[128:131]
    ds_read_b64_tr_b16 v[244:245], v5 offset:32800
    s_mov_b32 s23, 0xe000
    buffer_load_dwordx4 v[48:51], v6, s[8:11], s23 offen offset:2048 sc1
    v_mfma_f32_16x16x32_bf16 v[132:135], v[228:231], v[60:63], v[132:135]
    ds_read_b64_tr_b16 v[246:247], v5 offset:33824
    s_waitcnt lgkmcnt(6)
    v_mfma_f32_16x16x32_bf16 v[136:139], v[232:235], v[56:59], v[136:139]
    ds_read_b64_tr_b16 v[224:225], v4 offset:33024
    v_mfma_f32_16x16x32_bf16 v[140:143], v[232:235], v[60:63], v[140:143]
    ds_read_b64_tr_b16 v[226:227], v4 offset:34048
    s_mov_b32 s23, 0x2e000
    buffer_load_dwordx4 v[52:55], v6, s[8:11], s23 offen offset:2048 sc1
    s_waitcnt lgkmcnt(6)
    v_mfma_f32_16x16x32_bf16 v[144:147], v[236:239], v[56:59], v[144:147]
    ds_read_b64_tr_b16 v[228:229], v5 offset:33056
    v_mfma_f32_16x16x32_bf16 v[148:151], v[236:239], v[60:63], v[148:151]
    ds_read_b64_tr_b16 v[230:231], v5 offset:34080
    s_waitcnt vmcnt(6)
    v_cmp_ne_u32 vcc, s28, v12
    s_cbranch_vccnz adaLN_cond__sliding_block_cached__moe_arch_mod__prompt_kernel_o220r
adaLN_cond__sliding_block_cached__moe_arch_mod__prompt_kernel_o220b:
    s_waitcnt lgkmcnt(6)
    v_mfma_f32_16x16x32_bf16 v[88:91], v[240:243], v[24:27], v[88:91]
    ds_read_b64_tr_b16 v[232:233], v4 offset:33280
    v_mfma_f32_16x16x32_bf16 v[92:95], v[240:243], v[28:31], v[92:95]
    s_add_u32 s22, s24, 0x30000
    s_add_u32 m0, s20, 0x10000
    s_nop 0
    buffer_load_dwordx4 v3, s[4:7], s22 offen lds
    ds_read_b64_tr_b16 v[234:235], v4 offset:34304
    s_waitcnt lgkmcnt(6)
    v_mfma_f32_16x16x32_bf16 v[96:99], v[244:247], v[24:27], v[96:99]
    ds_read_b64_tr_b16 v[236:237], v5 offset:33312
    v_mfma_f32_16x16x32_bf16 v[100:103], v[244:247], v[28:31], v[100:103]
    ds_read_b64_tr_b16 v[238:239], v5 offset:34336
    s_waitcnt lgkmcnt(6)
    v_mfma_f32_16x16x32_bf16 v[104:107], v[224:227], v[24:27], v[104:107]
    s_add_u32 s22, s24, 0x32000
    s_add_u32 m0, s20, 0x10400
    s_nop 0
    buffer_load_dwordx4 v3, s[4:7], s22 offen lds
    ds_read_b64_tr_b16 v[240:241], v4 offset:33536
    v_mfma_f32_16x16x32_bf16 v[108:111], v[224:227], v[28:31], v[108:111]
    ds_read_b64_tr_b16 v[242:243], v4 offset:34560
    v_xor_b32 v16, s28, v184
    v_xor_b32 v17, s28, v185
    v_xor_b32 v18, s28, v186
    v_xor_b32 v19, s28, v187
    v_or3_b32 v16, v16, v17, v18
    v_or_b32 v16, v16, v19
    v_cmp_ne_u32 vcc, 0, v16
    s_cbranch_vccnz adaLN_cond__sliding_block_cached__moe_arch_mod__prompt_kernel_mf21r
adaLN_cond__sliding_block_cached__moe_arch_mod__prompt_kernel_mf21b:
    s_waitcnt lgkmcnt(6)
    v_mfma_f32_16x16x32_bf16 v[112:115], v[228:231], v[24:27], v[112:115]
    ds_read_b64_tr_b16 v[244:245], v5 offset:33568
    v_mfma_f32_16x16x32_bf16 v[116:119], v[228:231], v[28:31], v[116:119]
    ds_read_b64_tr_b16 v[246:247], v5 offset:34592
    s_waitcnt lgkmcnt(6)
    v_mfma_f32_16x16x32_bf16 v[120:123], v[232:235], v[24:27], v[120:123]
    v_mfma_f32_16x16x32_bf16 v[124:127], v[232:235], v[28:31], v[124:127]
    s_barrier
    ds_read_b64_tr_b16 v[224:225], v4 offset:49152
    ds_read_b64_tr_b16 v[226:227], v4 offset:50176
    s_waitcnt lgkmcnt(6)
    v_mfma_f32_16x16x32_bf16 v[128:131], v[236:239], v[24:27], v[128:131]
    ds_read_b64_tr_b16 v[228:229], v5 offset:49184
    s_mov_b32 s23, 0x0
    buffer_load_dwordx4 v[56:59], v6, s[8:11], s23 offen offset:3072 sc1
    v_mfma_f32_16x16x32_bf16 v[132:135], v[236:239], v[28:31], v[132:135]
    ds_read_b64_tr_b16 v[230:231], v5 offset:50208
    s_waitcnt lgkmcnt(6)
    v_mfma_f32_16x16x32_bf16 v[136:139], v[240:243], v[24:27], v[136:139]
    ds_read_b64_tr_b16 v[232:233], v4 offset:49408
    v_mfma_f32_16x16x32_bf16 v[140:143], v[240:243], v[28:31], v[140:143]
    ds_read_b64_tr_b16 v[234:235], v4 offset:50432
    s_mov_b32 s23, 0x20000
    buffer_load_dwordx4 v[60:63], v6, s[8:11], s23 offen offset:3072 sc1
    s_waitcnt lgkmcnt(6)
    v_mfma_f32_16x16x32_bf16 v[144:147], v[244:247], v[24:27], v[144:147]
    ds_read_b64_tr_b16 v[236:237], v5 offset:49440
    v_mfma_f32_16x16x32_bf16 v[148:151], v[244:247], v[28:31], v[148:151]
    ds_read_b64_tr_b16 v[238:239], v5 offset:50464
    s_waitcnt lgkmcnt(6)
    v_mfma_f32_16x16x32_bf16 v[88:91], v[224:227], v[32:35], v[88:91]
    ds_read_b64_tr_b16 v[240:241], v4 offset:49664
    v_mfma_f32_16x16x32_bf16 v[92:95], v[224:227], v[36:39], v[92:95]
    s_add_u32 s22, s24, 0xb0000
    s_add_u32 m0, s20, 0x14000
    s_nop 0
    buffer_load_dwordx4 v3, s[4:7], s22 offen lds
    ds_read_b64_tr_b16 v[242:243], v4 offset:50688
    s_waitcnt lgkmcnt(6)
    v_mfma_f32_16x16x32_bf16 v[96:99], v[228:231], v[32:35], v[96:99]
    ds_read_b64_tr_b16 v[244:245], v5 offset:49696
    v_mfma_f32_16x16x32_bf16 v[100:103], v[228:231], v[36:39], v[100:103]
    ds_read_b64_tr_b16 v[246:247], v5 offset:50720
    s_waitcnt lgkmcnt(6)
    v_mfma_f32_16x16x32_bf16 v[104:107], v[232:235], v[32:35], v[104:107]
    s_add_u32 s22, s24, 0xb2000
    s_add_u32 m0, s20, 0x14400
    s_nop 0
    buffer_load_dwordx4 v3, s[4:7], s22 offen lds
    ds_read_b64_tr_b16 v[224:225], v4 offset:49920
    v_mfma_f32_16x16x32_bf16 v[108:111], v[232:235], v[36:39], v[108:111]
    ds_read_b64_tr_b16 v[226:227], v4 offset:50944
    s_waitcnt lgkmcnt(6)
    v_mfma_f32_16x16x32_bf16 v[112:115], v[236:239], v[32:35], v[112:115]
    ds_read_b64_tr_b16 v[228:229], v5 offset:49952
    v_mfma_f32_16x16x32_bf16 v[116:119], v[236:239], v[36:39], v[116:119]
    ds_read_b64_tr_b16 v[230:231], v5 offset:50976
    s_waitcnt lgkmcnt(6)
    v_mfma_f32_16x16x32_bf16 v[120:123], v[240:243], v[32:35], v[120:123]
    v_mfma_f32_16x16x32_bf16 v[124:127], v[240:243], v[36:39], v[124:127]
    s_barrier
    ds_read_b64_tr_b16 v[232:233], v7 offset:0
    ds_read_b64_tr_b16 v[234:235], v7 offset:1024
    s_waitcnt lgkmcnt(6)
    v_mfma_f32_16x16x32_bf16 v[128:131], v[244:247], v[32:35], v[128:131]
    ds_read_b64_tr_b16 v[236:237], v8 offset:32
    s_mov_b32 s23, 0x2000
    buffer_load_dwordx4 v[24:27], v6, s[8:11], s23 offen offset:3072 sc1
    v_mfma_f32_16x16x32_bf16 v[132:135], v[244:247], v[36:39], v[132:135]
    ds_read_b64_tr_b16 v[238:239], v8 offset:1056
    s_waitcnt lgkmcnt(6)
    v_mfma_f32_16x16x32_bf16 v[136:139], v[224:227], v[32:35], v[136:139]
    ds_read_b64_tr_b16 v[240:241], v7 offset:256
    v_mfma_f32_16x16x32_bf16 v[140:143], v[224:227], v[36:39], v[140:143]
    ds_read_b64_tr_b16 v[242:243], v7 offset:1280
    s_mov_b32 s23, 0x22000
    buffer_load_dwordx4 v[28:31], v6, s[8:11], s23 offen offset:3072 sc1
    s_waitcnt lgkmcnt(6)
    v_mfma_f32_16x16x32_bf16 v[144:147], v[228:231], v[32:35], v[144:147]
    ds_read_b64_tr_b16 v[244:245], v8 offset:288
    v_mfma_f32_16x16x32_bf16 v[148:151], v[228:231], v[36:39], v[148:151]
    ds_read_b64_tr_b16 v[246:247], v8 offset:1312
    s_waitcnt vmcnt(13) lgkmcnt(6)
    v_mfma_f32_16x16x32_bf16 v[88:91], v[232:235], v[40:43], v[88:91]
    ds_read_b64_tr_b16 v[224:225], v7 offset:512
    s_waitcnt vmcnt(12)
    v_mfma_f32_16x16x32_bf16 v[92:95], v[232:235], v[44:47], v[92:95]
    s_add_u32 s22, s24, 0x130000
    s_add_u32 m0, s20, 0x18000
    s_nop 0
    buffer_load_dwordx4 v3, s[4:7], s22 offen lds
    ds_read_b64_tr_b16 v[226:227], v7 offset:1536
    s_waitcnt lgkmcnt(6)
    v_mfma_f32_16x16x32_bf16 v[96:99], v[236:239], v[40:43], v[96:99]
    ds_read_b64_tr_b16 v[228:229], v8 offset:544
    v_mfma_f32_16x16x32_bf16 v[100:103], v[236:239], v[44:47], v[100:103]
    ds_read_b64_tr_b16 v[230:231], v8 offset:1568
    s_waitcnt lgkmcnt(6)
    v_mfma_f32_16x16x32_bf16 v[104:107], v[240:243], v[40:43], v[104:107]
    s_add_u32 s22, s24, 0x132000
    s_add_u32 m0, s20, 0x18400
    s_nop 0
    buffer_load_dwordx4 v3, s[4:7], s22 offen lds
    ds_read_b64_tr_b16 v[232:233], v7 offset:768
    v_mfma_f32_16x16x32_bf16 v[108:111], v[240:243], v[44:47], v[108:111]
    ds_read_b64_tr_b16 v[234:235], v7 offset:1792
    s_waitcnt lgkmcnt(6)
    v_mfma_f32_16x16x32_bf16 v[112:115], v[244:247], v[40:43], v[112:115]
    ds_read_b64_tr_b16 v[236:237], v8 offset:800
    v_mfma_f32_16x16x32_bf16 v[116:119], v[244:247], v[44:47], v[116:119]
    ds_read_b64_tr_b16 v[238:239], v8 offset:1824
    s_waitcnt lgkmcnt(6)
    v_mfma_f32_16x16x32_bf16 v[120:123], v[224:227], v[40:43], v[120:123]
    v_mfma_f32_16x16x32_bf16 v[124:127], v[224:227], v[44:47], v[124:127]
    s_waitcnt vmcnt(12)
    s_barrier
    ds_read_b64_tr_b16 v[240:241], v7 offset:16384
    ds_read_b64_tr_b16 v[242:243], v7 offset:17408
    s_waitcnt lgkmcnt(6)
    v_mfma_f32_16x16x32_bf16 v[128:131], v[228:231], v[40:43], v[128:131]
    ds_read_b64_tr_b16 v[244:245], v8 offset:16416
    s_mov_b32 s23, 0x4000
    buffer_load_dwordx4 v[32:35], v6, s[8:11], s23 offen offset:3072 sc1
    v_mfma_f32_16x16x32_bf16 v[132:135], v[228:231], v[44:47], v[132:135]
    ds_read_b64_tr_b16 v[246:247], v8 offset:17440
    s_waitcnt lgkmcnt(6)
    v_mfma_f32_16x16x32_bf16 v[136:139], v[232:235], v[40:43], v[136:139]
    ds_read_b64_tr_b16 v[224:225], v7 offset:16640
    v_mfma_f32_16x16x32_bf16 v[140:143], v[232:235], v[44:47], v[140:143]
    ds_read_b64_tr_b16 v[226:227], v7 offset:17664
    s_mov_b32 s23, 0x24000
    buffer_load_dwordx4 v[36:39], v6, s[8:11], s23 offen offset:3072 sc1
    s_waitcnt lgkmcnt(6)
    v_mfma_f32_16x16x32_bf16 v[144:147], v[236:239], v[40:43], v[144:147]
    ds_read_b64_tr_b16 v[228:229], v8 offset:16672
    v_mfma_f32_16x16x32_bf16 v[148:151], v[236:239], v[44:47], v[148:151]
    ds_read_b64_tr_b16 v[230:231], v8 offset:17696
    s_waitcnt vmcnt(13) lgkmcnt(6)
    v_mfma_f32_16x16x32_bf16 v[88:91], v[240:243], v[48:51], v[88:91]
    ds_read_b64_tr_b16 v[232:233], v7 offset:16896
    s_waitcnt vmcnt(12)
    v_mfma_f32_16x16x32_bf16 v[92:95], v[240:243], v[52:55], v[92:95]
    s_add_u32 s22, s24, 0x1b0000
    s_add_u32 m0, s20, 0x1c000
    s_nop 0
    buffer_load_dwordx4 v3, s[4:7], s22 offen lds
    ds_read_b64_tr_b16 v[234:235], v7 offset:17920
    s_waitcnt lgkmcnt(6)
    v_mfma_f32_16x16x32_bf16 v[96:99], v[244:247], v[48:51], v[96:99]
    ds_read_b64_tr_b16 v[236:237], v8 offset:16928
    v_mfma_f32_16x16x32_bf16 v[100:103], v[244:247], v[52:55], v[100:103]
    ds_read_b64_tr_b16 v[238:239], v8 offset:17952
    s_waitcnt lgkmcnt(6)
    v_mfma_f32_16x16x32_bf16 v[104:107], v[224:227], v[48:51], v[104:107]
    s_add_u32 s22, s24, 0x1b2000
    s_add_u32 m0, s20, 0x1c400
    s_nop 0
    buffer_load_dwordx4 v3, s[4:7], s22 offen lds
    ds_read_b64_tr_b16 v[240:241], v7 offset:17152
    v_mfma_f32_16x16x32_bf16 v[108:111], v[224:227], v[52:55], v[108:111]
    ds_read_b64_tr_b16 v[242:243], v7 offset:18176
    s_waitcnt lgkmcnt(6)
    v_mfma_f32_16x16x32_bf16 v[112:115], v[228:231], v[48:51], v[112:115]
    ds_read_b64_tr_b16 v[244:245], v8 offset:17184
    v_mfma_f32_16x16x32_bf16 v[116:119], v[228:231], v[52:55], v[116:119]
    ds_read_b64_tr_b16 v[246:247], v8 offset:18208
    s_waitcnt lgkmcnt(6)
    v_mfma_f32_16x16x32_bf16 v[120:123], v[232:235], v[48:51], v[120:123]
    v_mfma_f32_16x16x32_bf16 v[124:127], v[232:235], v[52:55], v[124:127]
    s_waitcnt vmcnt(12)
    s_barrier
    ds_read_b64_tr_b16 v[224:225], v4 offset:0
    ds_read_b64_tr_b16 v[226:227], v4 offset:1024
    s_waitcnt lgkmcnt(6)
    v_mfma_f32_16x16x32_bf16 v[128:131], v[236:239], v[48:51], v[128:131]
    ds_read_b64_tr_b16 v[228:229], v5 offset:32
    s_mov_b32 s23, 0x6000
    buffer_load_dwordx4 v[40:43], v6, s[8:11], s23 offen offset:3072 sc1
    v_mfma_f32_16x16x32_bf16 v[132:135], v[236:239], v[52:55], v[132:135]
    ds_read_b64_tr_b16 v[230:231], v5 offset:1056
    s_waitcnt lgkmcnt(6)
    v_mfma_f32_16x16x32_bf16 v[136:139], v[240:243], v[48:51], v[136:139]
    ds_read_b64_tr_b16 v[232:233], v4 offset:256
    v_mfma_f32_16x16x32_bf16 v[140:143], v[240:243], v[52:55], v[140:143]
    ds_read_b64_tr_b16 v[234:235], v4 offset:1280
    s_mov_b32 s23, 0x26000
    buffer_load_dwordx4 v[44:47], v6, s[8:11], s23 offen offset:3072 sc1
    s_waitcnt lgkmcnt(6)
    v_mfma_f32_16x16x32_bf16 v[144:147], v[244:247], v[48:51], v[144:147]
    ds_read_b64_tr_b16 v[236:237], v5 offset:288
    v_mfma_f32_16x16x32_bf16 v[148:151], v[244:247], v[52:55], v[148:151]
    ds_read_b64_tr_b16 v[238:239], v5 offset:1312
    s_waitcnt vmcnt(13) lgkmcnt(6)
    v_mfma_f32_16x16x32_bf16 v[88:91], v[224:227], v[56:59], v[88:91]
    ds_read_b64_tr_b16 v[240:241], v4 offset:512
    s_waitcnt vmcnt(12)
    v_mfma_f32_16x16x32_bf16 v[92:95], v[224:227], v[60:63], v[92:95]
    s_add_u32 s22, s24, 0x230000
    s_add_u32 m0, s20, 0x20000
    s_nop 0
    buffer_load_dwordx4 v3, s[4:7], s22 offen lds
    ds_read_b64_tr_b16 v[242:243], v4 offset:1536
    s_waitcnt lgkmcnt(6)
    v_mfma_f32_16x16x32_bf16 v[96:99], v[228:231], v[56:59], v[96:99]
    ds_read_b64_tr_b16 v[244:245], v5 offset:544
    v_mfma_f32_16x16x32_bf16 v[100:103], v[228:231], v[60:63], v[100:103]
    ds_read_b64_tr_b16 v[246:247], v5 offset:1568
    s_waitcnt lgkmcnt(6)
    v_mfma_f32_16x16x32_bf16 v[104:107], v[232:235], v[56:59], v[104:107]
    s_add_u32 s22, s24, 0x232000
    s_add_u32 m0, s20, 0x20400
    s_nop 0
    buffer_load_dwordx4 v3, s[4:7], s22 offen lds
    ds_read_b64_tr_b16 v[224:225], v4 offset:768
    v_mfma_f32_16x16x32_bf16 v[108:111], v[232:235], v[60:63], v[108:111]
    ds_read_b64_tr_b16 v[226:227], v4 offset:1792
    s_waitcnt lgkmcnt(6)
    v_mfma_f32_16x16x32_bf16 v[112:115], v[236:239], v[56:59], v[112:115]
    ds_read_b64_tr_b16 v[228:229], v5 offset:800
    v_mfma_f32_16x16x32_bf16 v[116:119], v[236:239], v[60:63], v[116:119]
    ds_read_b64_tr_b16 v[230:231], v5 offset:1824
    s_waitcnt lgkmcnt(6)
    v_mfma_f32_16x16x32_bf16 v[120:123], v[240:243], v[56:59], v[120:123]
    v_mfma_f32_16x16x32_bf16 v[124:127], v[240:243], v[60:63], v[124:127]
    s_waitcnt vmcnt(12)
    s_barrier
    ds_read_b64_tr_b16 v[232:233], v4 offset:16384
    ds_read_b64_tr_b16 v[234:235], v4 offset:17408
    s_waitcnt lgkmcnt(6)
    v_mfma_f32_16x16x32_bf16 v[128:131], v[244:247], v[56:59], v[128:131]
    ds_read_b64_tr_b16 v[236:237], v5 offset:16416
    s_mov_b32 s23, 0x8000
    buffer_load_dwordx4 v[48:51], v6, s[8:11], s23 offen offset:3072 sc1
    v_mfma_f32_16x16x32_bf16 v[132:135], v[244:247], v[60:63], v[132:135]
    ds_read_b64_tr_b16 v[238:239], v5 offset:17440
    s_waitcnt lgkmcnt(6)
    v_mfma_f32_16x16x32_bf16 v[136:139], v[224:227], v[56:59], v[136:139]
    ds_read_b64_tr_b16 v[240:241], v4 offset:16640
    v_mfma_f32_16x16x32_bf16 v[140:143], v[224:227], v[60:63], v[140:143]
    ds_read_b64_tr_b16 v[242:243], v4 offset:17664
    s_mov_b32 s23, 0x28000
    buffer_load_dwordx4 v[52:55], v6, s[8:11], s23 offen offset:3072 sc1
    s_waitcnt lgkmcnt(6)
    v_mfma_f32_16x16x32_bf16 v[144:147], v[228:231], v[56:59], v[144:147]
    ds_read_b64_tr_b16 v[244:245], v5 offset:16672
    v_mfma_f32_16x16x32_bf16 v[148:151], v[228:231], v[60:63], v[148:151]
    ds_read_b64_tr_b16 v[246:247], v5 offset:17696
    s_waitcnt vmcnt(13) lgkmcnt(6)
    v_mfma_f32_16x16x32_bf16 v[88:91], v[232:235], v[24:27], v[88:91]
    ds_read_b64_tr_b16 v[224:225], v4 offset:16896
    s_waitcnt vmcnt(12)
    v_mfma_f32_16x16x32_bf16 v[92:95], v[232:235], v[28:31], v[92:95]
    s_add_u32 s22, s24, 0x2b0000
    s_add_u32 m0, s20, 0x24000
    s_nop 0
    buffer_load_dwordx4 v3, s[4:7], s22 offen lds
    ds_read_b64_tr_b16 v[226:227], v4 offset:17920
    s_waitcnt lgkmcnt(6)
    v_mfma_f32_16x16x32_bf16 v[96:99], v[236:239], v[24:27], v[96:99]
    ds_read_b64_tr_b16 v[228:229], v5 offset:16928
    v_mfma_f32_16x16x32_bf16 v[100:103], v[236:239], v[28:31], v[100:103]
    ds_read_b64_tr_b16 v[230:231], v5 offset:17952
    s_waitcnt lgkmcnt(6)
    v_mfma_f32_16x16x32_bf16 v[104:107], v[240:243], v[24:27], v[104:107]
    s_add_u32 s22, s24, 0x2b2000
    s_add_u32 m0, s20, 0x24400
    s_nop 0
    buffer_load_dwordx4 v3, s[4:7], s22 offen lds
    ds_read_b64_tr_b16 v[232:233], v4 offset:17152
    v_mfma_f32_16x16x32_bf16 v[108:111], v[240:243], v[28:31], v[108:111]
    ds_read_b64_tr_b16 v[234:235], v4 offset:18176
    s_waitcnt lgkmcnt(6)
    v_mfma_f32_16x16x32_bf16 v[112:115], v[244:247], v[24:27], v[112:115]
    ds_read_b64_tr_b16 v[236:237], v5 offset:17184
    v_mfma_f32_16x16x32_bf16 v[116:119], v[244:247], v[28:31], v[116:119]
    ds_read_b64_tr_b16 v[238:239], v5 offset:18208
    s_waitcnt lgkmcnt(6)
    v_mfma_f32_16x16x32_bf16 v[120:123], v[224:227], v[24:27], v[120:123]
    v_mfma_f32_16x16x32_bf16 v[124:127], v[224:227], v[28:31], v[124:127]
    s_waitcnt vmcnt(12)
    s_barrier
    ds_read_b64_tr_b16 v[240:241], v4 offset:32768
    ds_read_b64_tr_b16 v[242:243], v4 offset:33792
    s_waitcnt lgkmcnt(6)
    v_mfma_f32_16x16x32_bf16 v[128:131], v[228:231], v[24:27], v[128:131]
    ds_read_b64_tr_b16 v[244:245], v5 offset:32800
    s_mov_b32 s23, 0xa000
    buffer_load_dwordx4 v[56:59], v6, s[8:11], s23 offen offset:3072 sc1
    v_mfma_f32_16x16x32_bf16 v[132:135], v[228:231], v[28:31], v[132:135]
    ds_read_b64_tr_b16 v[246:247], v5 offset:33824
    s_waitcnt lgkmcnt(6)
    v_mfma_f32_16x16x32_bf16 v[136:139], v[232:235], v[24:27], v[136:139]
    ds_read_b64_tr_b16 v[224:225], v4 offset:33024
    v_mfma_f32_16x16x32_bf16 v[140:143], v[232:235], v[28:31], v[140:143]
    ds_read_b64_tr_b16 v[226:227], v4 offset:34048
    s_mov_b32 s23, 0x2a000
    buffer_load_dwordx4 v[60:63], v6, s[8:11], s23 offen offset:3072 sc1
    s_waitcnt lgkmcnt(6)
    v_mfma_f32_16x16x32_bf16 v[144:147], v[236:239], v[24:27], v[144:147]
    ds_read_b64_tr_b16 v[228:229], v5 offset:33056
    v_mfma_f32_16x16x32_bf16 v[148:151], v[236:239], v[28:31], v[148:151]
    ds_read_b64_tr_b16 v[230:231], v5 offset:34080
    s_waitcnt vmcnt(13) lgkmcnt(6)
    v_mfma_f32_16x16x32_bf16 v[88:91], v[240:243], v[32:35], v[88:91]
    ds_read_b64_tr_b16 v[232:233], v4 offset:33280
    s_waitcnt vmcnt(12)
    v_mfma_f32_16x16x32_bf16 v[92:95], v[240:243], v[36:39], v[92:95]
    s_add_u32 s22, s24, 0x330000
    s_add_u32 m0, s20, 0x10000
    s_nop 0
    buffer_load_dwordx4 v3, s[4:7], s22 offen lds
    ds_read_b64_tr_b16 v[234:235], v4 offset:34304
    s_waitcnt lgkmcnt(6)
    v_mfma_f32_16x16x32_bf16 v[96:99], v[244:247], v[32:35], v[96:99]
    ds_read_b64_tr_b16 v[236:237], v5 offset:33312
    v_mfma_f32_16x16x32_bf16 v[100:103], v[244:247], v[36:39], v[100:103]
    ds_read_b64_tr_b16 v[238:239], v5 offset:34336
    s_waitcnt lgkmcnt(6)
    v_mfma_f32_16x16x32_bf16 v[104:107], v[224:227], v[32:35], v[104:107]
    s_add_u32 s22, s24, 0x332000
    s_add_u32 m0, s20, 0x10400
    s_nop 0
    buffer_load_dwordx4 v3, s[4:7], s22 offen lds
    ds_read_b64_tr_b16 v[240:241], v4 offset:33536
    v_mfma_f32_16x16x32_bf16 v[108:111], v[224:227], v[36:39], v[108:111]
    ds_read_b64_tr_b16 v[242:243], v4 offset:34560
    v_lshrrev_b32 v16, 4, v1
    v_lshlrev_b32 v16, 3, v16
    s_lshl_b32 s16, s31, 8
    s_add_u32 s16, s16, 0x540080
    buffer_load_dwordx2 v[248:249], v16, s[8:11], s16 offen offset:0 sc1
    buffer_load_dwordx2 v[250:251], v16, s[8:11], s16 offen offset:32 sc1
    buffer_load_dwordx2 v[252:253], v16, s[8:11], s16 offen offset:64 sc1
    buffer_load_dwordx2 v[254:255], v16, s[8:11], s16 offen offset:96 sc1
    s_waitcnt lgkmcnt(6)
    v_mfma_f32_16x16x32_bf16 v[112:115], v[228:231], v[32:35], v[112:115]
    ds_read_b64_tr_b16 v[244:245], v5 offset:33568
    v_mfma_f32_16x16x32_bf16 v[116:119], v[228:231], v[36:39], v[116:119]
    ds_read_b64_tr_b16 v[246:247], v5 offset:34592
    s_waitcnt lgkmcnt(6)
    v_mfma_f32_16x16x32_bf16 v[120:123], v[232:235], v[32:35], v[120:123]
    v_mfma_f32_16x16x32_bf16 v[124:127], v[232:235], v[36:39], v[124:127]
    s_waitcnt vmcnt(16)
    s_barrier
    ds_read_b64_tr_b16 v[224:225], v4 offset:49152
    ds_read_b64_tr_b16 v[226:227], v4 offset:50176
    s_waitcnt lgkmcnt(6)
    v_mfma_f32_16x16x32_bf16 v[128:131], v[236:239], v[32:35], v[128:131]
    ds_read_b64_tr_b16 v[228:229], v5 offset:49184
    s_mov_b32 s23, 0xc000
    buffer_load_dwordx4 v[24:27], v6, s[8:11], s23 offen offset:3072 sc1
    v_mfma_f32_16x16x32_bf16 v[132:135], v[236:239], v[36:39], v[132:135]
    ds_read_b64_tr_b16 v[230:231], v5 offset:50208
    s_waitcnt lgkmcnt(6)
    v_mfma_f32_16x16x32_bf16 v[136:139], v[240:243], v[32:35], v[136:139]
    ds_read_b64_tr_b16 v[232:233], v4 offset:49408
    v_mfma_f32_16x16x32_bf16 v[140:143], v[240:243], v[36:39], v[140:143]
    ds_read_b64_tr_b16 v[234:235], v4 offset:50432
    s_mov_b32 s23, 0x2c000
    buffer_load_dwordx4 v[28:31], v6, s[8:11], s23 offen offset:3072 sc1
    s_waitcnt lgkmcnt(6)
    v_mfma_f32_16x16x32_bf16 v[144:147], v[244:247], v[32:35], v[144:147]
    ds_read_b64_tr_b16 v[236:237], v5 offset:49440
    v_mfma_f32_16x16x32_bf16 v[148:151], v[244:247], v[36:39], v[148:151]
    ds_read_b64_tr_b16 v[238:239], v5 offset:50464
    s_waitcnt vmcnt(17) lgkmcnt(6)
    v_mfma_f32_16x16x32_bf16 v[88:91], v[224:227], v[40:43], v[88:91]
    ds_read_b64_tr_b16 v[240:241], v4 offset:49664
    s_waitcnt vmcnt(16)
    v_mfma_f32_16x16x32_bf16 v[92:95], v[224:227], v[44:47], v[92:95]
    s_add_u32 s22, s24, 0x3b0000
    s_add_u32 m0, s20, 0x14000
    s_nop 0
    buffer_load_dwordx4 v3, s[4:7], s22 offen lds
    ds_read_b64_tr_b16 v[242:243], v4 offset:50688
    s_waitcnt lgkmcnt(6)
    v_mfma_f32_16x16x32_bf16 v[96:99], v[228:231], v[40:43], v[96:99]
    ds_read_b64_tr_b16 v[244:245], v5 offset:49696
    v_mfma_f32_16x16x32_bf16 v[100:103], v[228:231], v[44:47], v[100:103]
    ds_read_b64_tr_b16 v[246:247], v5 offset:50720
    s_waitcnt lgkmcnt(6)
    v_mfma_f32_16x16x32_bf16 v[104:107], v[232:235], v[40:43], v[104:107]
    s_add_u32 s22, s24, 0x3b2000
    s_add_u32 m0, s20, 0x14400
    s_nop 0
    buffer_load_dwordx4 v3, s[4:7], s22 offen lds
    ds_read_b64_tr_b16 v[224:225], v4 offset:49920
    v_mfma_f32_16x16x32_bf16 v[108:111], v[232:235], v[44:47], v[108:111]
    ds_read_b64_tr_b16 v[226:227], v4 offset:50944
    s_waitcnt lgkmcnt(6)
    v_mfma_f32_16x16x32_bf16 v[112:115], v[236:239], v[40:43], v[112:115]
    ds_read_b64_tr_b16 v[228:229], v5 offset:49952
    v_mfma_f32_16x16x32_bf16 v[116:119], v[236:239], v[44:47], v[116:119]
    ds_read_b64_tr_b16 v[230:231], v5 offset:50976
    s_waitcnt lgkmcnt(6)
    v_mfma_f32_16x16x32_bf16 v[120:123], v[240:243], v[40:43], v[120:123]
    v_mfma_f32_16x16x32_bf16 v[124:127], v[240:243], v[44:47], v[124:127]
    s_waitcnt vmcnt(16)
    s_barrier
    ds_read_b64_tr_b16 v[232:233], v7 offset:0
    ds_read_b64_tr_b16 v[234:235], v7 offset:1024
    s_waitcnt lgkmcnt(6)
    v_mfma_f32_16x16x32_bf16 v[128:131], v[244:247], v[40:43], v[128:131]
    ds_read_b64_tr_b16 v[236:237], v8 offset:32
    s_mov_b32 s23, 0xe000
    buffer_load_dwordx4 v[32:35], v6, s[8:11], s23 offen offset:3072 sc1
    v_mfma_f32_16x16x32_bf16 v[132:135], v[244:247], v[44:47], v[132:135]
    ds_read_b64_tr_b16 v[238:239], v8 offset:1056
    s_waitcnt lgkmcnt(6)
    v_mfma_f32_16x16x32_bf16 v[136:139], v[224:227], v[40:43], v[136:139]
    ds_read_b64_tr_b16 v[240:241], v7 offset:256
    v_mfma_f32_16x16x32_bf16 v[140:143], v[224:227], v[44:47], v[140:143]
    ds_read_b64_tr_b16 v[242:243], v7 offset:1280
    s_mov_b32 s23, 0x2e000
    buffer_load_dwordx4 v[36:39], v6, s[8:11], s23 offen offset:3072 sc1
    s_waitcnt lgkmcnt(6)
    v_mfma_f32_16x16x32_bf16 v[144:147], v[228:231], v[40:43], v[144:147]
    ds_read_b64_tr_b16 v[244:245], v8 offset:288
    v_mfma_f32_16x16x32_bf16 v[148:151], v[228:231], v[44:47], v[148:151]
    ds_read_b64_tr_b16 v[246:247], v8 offset:1312
    s_waitcnt vmcnt(17) lgkmcnt(6)
    v_mfma_f32_16x16x32_bf16 v[88:91], v[232:235], v[48:51], v[88:91]
    ds_read_b64_tr_b16 v[224:225], v7 offset:512
    s_waitcnt vmcnt(16)
    v_mfma_f32_16x16x32_bf16 v[92:95], v[232:235], v[52:55], v[92:95]
    ds_read_b64_tr_b16 v[226:227], v7 offset:1536
    s_waitcnt lgkmcnt(6)
    v_mfma_f32_16x16x32_bf16 v[96:99], v[236:239], v[48:51], v[96:99]
    ds_read_b64_tr_b16 v[228:229], v8 offset:544
    v_mfma_f32_16x16x32_bf16 v[100:103], v[236:239], v[52:55], v[100:103]
    ds_read_b64_tr_b16 v[230:231], v8 offset:1568
    s_waitcnt lgkmcnt(6)
    v_mfma_f32_16x16x32_bf16 v[104:107], v[240:243], v[48:51], v[104:107]
    ds_read_b64_tr_b16 v[232:233], v7 offset:768
    v_mfma_f32_16x16x32_bf16 v[108:111], v[240:243], v[52:55], v[108:111]
    ds_read_b64_tr_b16 v[234:235], v7 offset:1792
    s_waitcnt lgkmcnt(6)
    v_mfma_f32_16x16x32_bf16 v[112:115], v[244:247], v[48:51], v[112:115]
    ds_read_b64_tr_b16 v[236:237], v8 offset:800
    v_mfma_f32_16x16x32_bf16 v[116:119], v[244:247], v[52:55], v[116:119]
    ds_read_b64_tr_b16 v[238:239], v8 offset:1824
    s_waitcnt lgkmcnt(6)
    v_mfma_f32_16x16x32_bf16 v[120:123], v[224:227], v[48:51], v[120:123]
    s_mov_b64 s[72:73], s[48:49]
    s_mov_b32 s74, 0x700000
    s_mov_b32 s75, 0x20000
    s_cmp_lt_u32 s2, 224
    s_cselect_b32 s74, 7340032, 0
    s_and_b32 s16, s3, 3
    v_lshrrev_b32 v20, 3, v1
    v_lshlrev_b32 v20, 3, v20
    s_lshl_b32 s17, s16, 6
    v_add_u32 v20, s17, v20
    s_mov_b32 s17, 7168
    v_mul_lo_u32 v21, s17, v20
    v_and_b32 v20, 7, v1
    v_lshl_add_u32 v21, v20, 4, v21
    s_and_b32 s17, s29, 3
    s_mul_i32 s18, s17, 1835008
    s_lshr_b32 s17, s29, 2
    s_lshl_b32 s17, s17, 7
    s_add_u32 s18, s18, s17
    s_lshl_b32 s16, s16, 13
    s_add_u32 s22, s18, 0
    s_add_u32 m0, s16, 32768
    s_nop 0
    buffer_load_dwordx4 v21, s[72:75], s22 offen lds
    s_add_u32 s22, s18, 7168
    s_add_u32 m0, s16, 33792
    s_nop 0
    buffer_load_dwordx4 v21, s[72:75], s22 offen lds
    s_add_u32 s22, s18, 14336
    s_add_u32 m0, s16, 34816
    s_nop 0
    buffer_load_dwordx4 v21, s[72:75], s22 offen lds
    s_add_u32 s22, s18, 21504
    s_add_u32 m0, s16, 35840
    s_nop 0
    buffer_load_dwordx4 v21, s[72:75], s22 offen lds
    s_add_u32 s22, s18, 28672
    s_add_u32 m0, s16, 36864
    s_nop 0
    buffer_load_dwordx4 v21, s[72:75], s22 offen lds
    s_add_u32 s22, s18, 35840
    s_add_u32 m0, s16, 37888
    s_nop 0
    buffer_load_dwordx4 v21, s[72:75], s22 offen lds
    s_add_u32 s22, s18, 43008
    s_add_u32 m0, s16, 38912
    s_nop 0
    buffer_load_dwordx4 v21, s[72:75], s22 offen lds
    s_add_u32 s22, s18, 50176
    s_add_u32 m0, s16, 39936
    s_nop 0
    buffer_load_dwordx4 v21, s[72:75], s22 offen lds
    v_mfma_f32_16x16x32_bf16 v[124:127], v[224:227], v[52:55], v[124:127]
    s_waitcnt vmcnt(22)
    s_barrier
    ds_read_b64_tr_b16 v[240:241], v7 offset:16384
    ds_read_b64_tr_b16 v[242:243], v7 offset:17408
    s_waitcnt lgkmcnt(6)
    v_mfma_f32_16x16x32_bf16 v[128:131], v[228:231], v[48:51], v[128:131]
    ds_read_b64_tr_b16 v[244:245], v8 offset:16416
    v_mfma_f32_16x16x32_bf16 v[132:135], v[228:231], v[52:55], v[132:135]
    ds_read_b64_tr_b16 v[246:247], v8 offset:17440
    s_waitcnt lgkmcnt(6)
    v_mfma_f32_16x16x32_bf16 v[136:139], v[232:235], v[48:51], v[136:139]
    ds_read_b64_tr_b16 v[224:225], v7 offset:16640
    v_mfma_f32_16x16x32_bf16 v[140:143], v[232:235], v[52:55], v[140:143]
    ds_read_b64_tr_b16 v[226:227], v7 offset:17664
    s_waitcnt lgkmcnt(6)
    v_mfma_f32_16x16x32_bf16 v[144:147], v[236:239], v[48:51], v[144:147]
    ds_read_b64_tr_b16 v[228:229], v8 offset:16672
    v_mfma_f32_16x16x32_bf16 v[148:151], v[236:239], v[52:55], v[148:151]
    ds_read_b64_tr_b16 v[230:231], v8 offset:17696
    s_waitcnt vmcnt(21) lgkmcnt(6)
    v_mfma_f32_16x16x32_bf16 v[88:91], v[240:243], v[56:59], v[88:91]
    ds_read_b64_tr_b16 v[232:233], v7 offset:16896
    s_waitcnt vmcnt(20)
    v_mfma_f32_16x16x32_bf16 v[92:95], v[240:243], v[60:63], v[92:95]
    ds_read_b64_tr_b16 v[234:235], v7 offset:17920
    s_waitcnt lgkmcnt(6)
    v_mfma_f32_16x16x32_bf16 v[96:99], v[244:247], v[56:59], v[96:99]
    ds_read_b64_tr_b16 v[236:237], v8 offset:16928
    v_mfma_f32_16x16x32_bf16 v[100:103], v[244:247], v[60:63], v[100:103]
    ds_read_b64_tr_b16 v[238:239], v8 offset:17952
    s_waitcnt lgkmcnt(6)
    v_mfma_f32_16x16x32_bf16 v[104:107], v[224:227], v[56:59], v[104:107]
    ds_read_b64_tr_b16 v[240:241], v7 offset:17152
    v_mfma_f32_16x16x32_bf16 v[108:111], v[224:227], v[60:63], v[108:111]
    ds_read_b64_tr_b16 v[242:243], v7 offset:18176
    s_waitcnt lgkmcnt(6)
    v_mfma_f32_16x16x32_bf16 v[112:115], v[228:231], v[56:59], v[112:115]
    ds_read_b64_tr_b16 v[244:245], v8 offset:17184
    v_mfma_f32_16x16x32_bf16 v[116:119], v[228:231], v[60:63], v[116:119]
    ds_read_b64_tr_b16 v[246:247], v8 offset:18208
    s_waitcnt lgkmcnt(6)
    v_mfma_f32_16x16x32_bf16 v[120:123], v[232:235], v[56:59], v[120:123]
    v_mfma_f32_16x16x32_bf16 v[124:127], v[232:235], v[60:63], v[124:127]
    s_waitcnt vmcnt(18)
    s_barrier
    ds_read_b64_tr_b16 v[224:225], v4 offset:0
    ds_read_b64_tr_b16 v[226:227], v4 offset:1024
    s_waitcnt lgkmcnt(6)
    v_mfma_f32_16x16x32_bf16 v[128:131], v[236:239], v[56:59], v[128:131]
    ds_read_b64_tr_b16 v[228:229], v5 offset:32
    v_mfma_f32_16x16x32_bf16 v[132:135], v[236:239], v[60:63], v[132:135]
    ds_read_b64_tr_b16 v[230:231], v5 offset:1056
    s_waitcnt lgkmcnt(6)
    v_mfma_f32_16x16x32_bf16 v[136:139], v[240:243], v[56:59], v[136:139]
    ds_read_b64_tr_b16 v[232:233], v4 offset:256
    v_mfma_f32_16x16x32_bf16 v[140:143], v[240:243], v[60:63], v[140:143]
    ds_read_b64_tr_b16 v[234:235], v4 offset:1280
    s_waitcnt lgkmcnt(6)
    v_mfma_f32_16x16x32_bf16 v[144:147], v[244:247], v[56:59], v[144:147]
    ds_read_b64_tr_b16 v[236:237], v5 offset:288
    v_mfma_f32_16x16x32_bf16 v[148:151], v[244:247], v[60:63], v[148:151]
    ds_read_b64_tr_b16 v[238:239], v5 offset:1312
    s_waitcnt vmcnt(13) lgkmcnt(6)
    v_mfma_f32_16x16x32_bf16 v[88:91], v[224:227], v[24:27], v[88:91]
    ds_read_b64_tr_b16 v[240:241], v4 offset:512
    s_waitcnt vmcnt(12)
    v_mfma_f32_16x16x32_bf16 v[92:95], v[224:227], v[28:31], v[92:95]
    ds_read_b64_tr_b16 v[242:243], v4 offset:1536
    s_waitcnt lgkmcnt(6)
    v_mfma_f32_16x16x32_bf16 v[96:99], v[228:231], v[24:27], v[96:99]
    ds_read_b64_tr_b16 v[244:245], v5 offset:544
    v_mfma_f32_16x16x32_bf16 v[100:103], v[228:231], v[28:31], v[100:103]
    ds_read_b64_tr_b16 v[246:247], v5 offset:1568
    s_waitcnt lgkmcnt(6)
    v_mfma_f32_16x16x32_bf16 v[104:107], v[232:235], v[24:27], v[104:107]
    ds_read_b64_tr_b16 v[224:225], v4 offset:768
    v_mfma_f32_16x16x32_bf16 v[108:111], v[232:235], v[28:31], v[108:111]
    ds_read_b64_tr_b16 v[226:227], v4 offset:1792
    s_waitcnt lgkmcnt(6)
    v_mfma_f32_16x16x32_bf16 v[112:115], v[236:239], v[24:27], v[112:115]
    ds_read_b64_tr_b16 v[228:229], v5 offset:800
    v_mfma_f32_16x16x32_bf16 v[116:119], v[236:239], v[28:31], v[116:119]
    ds_read_b64_tr_b16 v[230:231], v5 offset:1824
    s_waitcnt lgkmcnt(6)
    v_mfma_f32_16x16x32_bf16 v[120:123], v[240:243], v[24:27], v[120:123]
    v_mfma_f32_16x16x32_bf16 v[124:127], v[240:243], v[28:31], v[124:127]
    s_waitcnt vmcnt(10)
    s_barrier
    ds_read_b64_tr_b16 v[232:233], v4 offset:16384
    ds_read_b64_tr_b16 v[234:235], v4 offset:17408
    s_waitcnt lgkmcnt(6)
    v_mfma_f32_16x16x32_bf16 v[128:131], v[244:247], v[24:27], v[128:131]
    ds_read_b64_tr_b16 v[236:237], v5 offset:16416
    v_mfma_f32_16x16x32_bf16 v[132:135], v[244:247], v[28:31], v[132:135]
    ds_read_b64_tr_b16 v[238:239], v5 offset:17440
    s_waitcnt lgkmcnt(6)
    v_mfma_f32_16x16x32_bf16 v[136:139], v[224:227], v[24:27], v[136:139]
    ds_read_b64_tr_b16 v[240:241], v4 offset:16640
    v_mfma_f32_16x16x32_bf16 v[140:143], v[224:227], v[28:31], v[140:143]
    ds_read_b64_tr_b16 v[242:243], v4 offset:17664
    s_waitcnt lgkmcnt(6)
    v_mfma_f32_16x16x32_bf16 v[144:147], v[228:231], v[24:27], v[144:147]
    ds_read_b64_tr_b16 v[244:245], v5 offset:16672
    v_mfma_f32_16x16x32_bf16 v[148:151], v[228:231], v[28:31], v[148:151]
    ds_read_b64_tr_b16 v[246:247], v5 offset:17696
    s_waitcnt vmcnt(9) lgkmcnt(6)
    v_mfma_f32_16x16x32_bf16 v[88:91], v[232:235], v[32:35], v[88:91]
    ds_read_b64_tr_b16 v[224:225], v4 offset:16896
    s_waitcnt vmcnt(8)
    v_mfma_f32_16x16x32_bf16 v[92:95], v[232:235], v[36:39], v[92:95]
    ds_read_b64_tr_b16 v[226:227], v4 offset:17920
    s_waitcnt lgkmcnt(6)
    v_mfma_f32_16x16x32_bf16 v[96:99], v[236:239], v[32:35], v[96:99]
    ds_read_b64_tr_b16 v[228:229], v5 offset:16928
    v_mfma_f32_16x16x32_bf16 v[100:103], v[236:239], v[36:39], v[100:103]
    ds_read_b64_tr_b16 v[230:231], v5 offset:17952
    s_waitcnt lgkmcnt(6)
    v_mfma_f32_16x16x32_bf16 v[104:107], v[240:243], v[32:35], v[104:107]
    ds_read_b64_tr_b16 v[232:233], v4 offset:17152
    v_mfma_f32_16x16x32_bf16 v[108:111], v[240:243], v[36:39], v[108:111]
    ds_read_b64_tr_b16 v[234:235], v4 offset:18176
    s_waitcnt lgkmcnt(6)
    v_mfma_f32_16x16x32_bf16 v[112:115], v[244:247], v[32:35], v[112:115]
    ds_read_b64_tr_b16 v[236:237], v5 offset:17184
    v_mfma_f32_16x16x32_bf16 v[116:119], v[244:247], v[36:39], v[116:119]
    ds_read_b64_tr_b16 v[238:239], v5 offset:18208
    s_waitcnt lgkmcnt(6)
    v_mfma_f32_16x16x32_bf16 v[120:123], v[224:227], v[32:35], v[120:123]
    v_mfma_f32_16x16x32_bf16 v[124:127], v[224:227], v[36:39], v[124:127]
    s_waitcnt lgkmcnt(4)
    v_mfma_f32_16x16x32_bf16 v[128:131], v[228:231], v[32:35], v[128:131]
    v_mfma_f32_16x16x32_bf16 v[132:135], v[228:231], v[36:39], v[132:135]
    s_waitcnt lgkmcnt(2)
    v_mfma_f32_16x16x32_bf16 v[136:139], v[232:235], v[32:35], v[136:139]
    v_mfma_f32_16x16x32_bf16 v[140:143], v[232:235], v[36:39], v[140:143]
    s_waitcnt lgkmcnt(0)
    v_mfma_f32_16x16x32_bf16 v[144:147], v[236:239], v[32:35], v[144:147]
    v_mfma_f32_16x16x32_bf16 v[148:151], v[236:239], v[36:39], v[148:151]
    s_lshl_b32 s16, s3, 13
    s_xor_b32 s17, s16, 0x8000
    s_add_u32 s16, s16, 0x18000
    s_add_u32 s17, s17, 0x18000
    v_add_u32 v16, s16, v2
    s_mov_b32 s16, s17
    v_add_u32 v17, s16, v2
    ds_write_b128 v16, v[88:91] offset:0
    ds_write_b128 v16, v[92:95] offset:1024
    ds_write_b128 v16, v[96:99] offset:2048
    ds_write_b128 v16, v[100:103] offset:3072
    ds_write_b128 v16, v[104:107] offset:4096
    ds_write_b128 v16, v[108:111] offset:5120
    ds_write_b128 v16, v[112:115] offset:6144
    ds_write_b128 v16, v[116:119] offset:7168
    v_lshlrev_b32 v24, 16, v248
    v_and_b32 v25, 0xffff0000, v248
    v_lshlrev_b32 v26, 16, v249
    v_and_b32 v27, 0xffff0000, v249
    v_lshlrev_b32 v28, 16, v250
    v_and_b32 v29, 0xffff0000, v250
    v_lshlrev_b32 v30, 16, v251
    v_and_b32 v31, 0xffff0000, v251
    v_lshlrev_b32 v32, 16, v252
    v_and_b32 v33, 0xffff0000, v252
    v_lshlrev_b32 v34, 16, v253
    v_and_b32 v35, 0xffff0000, v253
    v_lshlrev_b32 v36, 16, v254
    v_and_b32 v37, 0xffff0000, v254
    v_lshlrev_b32 v38, 16, v255
    v_and_b32 v39, 0xffff0000, v255
    v_and_b32 v18, 15, v1
    v_lshlrev_b32 v18, 6, v18
    v_lshrrev_b32 v19, 4, v1
    v_and_b32 v20, 1, v19
    v_lshl_add_u32 v18, v20, 5, v18
    v_lshrrev_b32 v19, 1, v19
    v_lshl_add_u32 v18, v19, 4, v18
    s_and_b32 s17, s3, 3
    s_lshl_b32 s18, s30, 2
    s_add_u32 s18, s18, s17
    s_lshl_b32 s18, s18, 16
    s_lshl_b32 s19, s15, 22
    s_add_u32 s18, s18, s19
    s_lshl_b32 s19, s31, 12
    s_add_u32 s18, s18, s19
    s_add_u32 s18, s18, 0x2000800
    s_add_u32 s19, s18, 32768
    s_waitcnt lgkmcnt(0)
    s_barrier
    ds_read_b128 v[40:43], v17 offset:0
    ds_read_b128 v[44:47], v17 offset:1024
    ds_read_b128 v[48:51], v17 offset:2048
    ds_read_b128 v[52:55], v17 offset:3072
    ds_read_b128 v[56:59], v17 offset:4096
    ds_read_b128 v[60:63], v17 offset:5120
    ds_read_b128 v[64:67], v17 offset:6144
    ds_read_b128 v[68:71], v17 offset:7168
    s_waitcnt lgkmcnt(7)
    v_pk_add_f32 v[120:121], v[120:121], v[40:41]
    v_pk_add_f32 v[122:123], v[122:123], v[42:43]
    v_pk_mul_f32 v[120:121], v[120:121], v[24:25]
    v_pk_mul_f32 v[122:123], v[122:123], v[26:27]
    v_cvt_pk_bf16_f32 v224, v120, v121
    v_cvt_pk_bf16_f32 v225, v122, v123
    s_waitcnt lgkmcnt(5)
    v_pk_add_f32 v[128:129], v[128:129], v[48:49]
    v_pk_add_f32 v[130:131], v[130:131], v[50:51]
    v_pk_mul_f32 v[128:129], v[128:129], v[28:29]
    v_pk_mul_f32 v[130:131], v[130:131], v[30:31]
    v_cvt_pk_bf16_f32 v226, v128, v129
    v_cvt_pk_bf16_f32 v227, v130, v131
    s_nop 0
    v_permlane16_swap_b32 v224, v226
    v_permlane16_swap_b32 v225, v227
    buffer_store_dwordx4 v[224:227], v18, s[8:11], s18 offen offset:0 sc1
    v_pk_add_f32 v[124:125], v[124:125], v[44:45]
    v_pk_add_f32 v[126:127], v[126:127], v[46:47]
    v_pk_mul_f32 v[124:125], v[124:125], v[24:25]
    v_pk_mul_f32 v[126:127], v[126:127], v[26:27]
    v_cvt_pk_bf16_f32 v228, v124, v125
    v_cvt_pk_bf16_f32 v229, v126, v127
    s_waitcnt lgkmcnt(4)
    v_pk_add_f32 v[132:133], v[132:133], v[52:53]
    v_pk_add_f32 v[134:135], v[134:135], v[54:55]
    v_pk_mul_f32 v[132:133], v[132:133], v[28:29]
    v_pk_mul_f32 v[134:135], v[134:135], v[30:31]
    v_cvt_pk_bf16_f32 v230, v132, v133
    v_cvt_pk_bf16_f32 v231, v134, v135
    s_nop 0
    v_permlane16_swap_b32 v228, v230
    v_permlane16_swap_b32 v229, v231
    buffer_store_dwordx4 v[228:231], v18, s[8:11], s19 offen offset:0 sc1
    s_waitcnt lgkmcnt(3)
    v_pk_add_f32 v[136:137], v[136:137], v[56:57]
    v_pk_add_f32 v[138:139], v[138:139], v[58:59]
    v_pk_mul_f32 v[136:137], v[136:137], v[32:33]
    v_pk_mul_f32 v[138:139], v[138:139], v[34:35]
    v_cvt_pk_bf16_f32 v232, v136, v137
    v_cvt_pk_bf16_f32 v233, v138, v139
    s_waitcnt lgkmcnt(1)
    v_pk_add_f32 v[144:145], v[144:145], v[64:65]
    v_pk_add_f32 v[146:147], v[146:147], v[66:67]
    v_pk_mul_f32 v[144:145], v[144:145], v[36:37]
    v_pk_mul_f32 v[146:147], v[146:147], v[38:39]
    v_cvt_pk_bf16_f32 v234, v144, v145
    v_cvt_pk_bf16_f32 v235, v146, v147
    s_nop 0
    v_permlane16_swap_b32 v232, v234
    v_permlane16_swap_b32 v233, v235
    buffer_store_dwordx4 v[232:235], v18, s[8:11], s18 offen offset:1024 sc1
    v_pk_add_f32 v[140:141], v[140:141], v[60:61]
    v_pk_add_f32 v[142:143], v[142:143], v[62:63]
    v_pk_mul_f32 v[140:141], v[140:141], v[32:33]
    v_pk_mul_f32 v[142:143], v[142:143], v[34:35]
    v_cvt_pk_bf16_f32 v236, v140, v141
    v_cvt_pk_bf16_f32 v237, v142, v143
    s_waitcnt lgkmcnt(0)
    v_pk_add_f32 v[148:149], v[148:149], v[68:69]
    v_pk_add_f32 v[150:151], v[150:151], v[70:71]
    v_pk_mul_f32 v[148:149], v[148:149], v[36:37]
    v_pk_mul_f32 v[150:151], v[150:151], v[38:39]
    v_cvt_pk_bf16_f32 v238, v148, v149
    v_cvt_pk_bf16_f32 v239, v150, v151
    s_nop 0
    v_permlane16_swap_b32 v236, v238
    v_permlane16_swap_b32 v237, v239
    buffer_store_dwordx4 v[236:239], v18, s[8:11], s19 offen offset:1024 sc1
    s_mov_b64 s[64:65], s[44:45]
    s_mov_b32 s66, 0x800
    s_mov_b32 s67, 0x20000
    s_mov_b64 s[76:77], s[32:33]
    s_mov_b32 s78, 0x400000
    s_mov_b32 s79, 0x20000
    s_mov_b64 s[68:69], s[56:57]
    s_mov_b32 s70, 0x400000
    s_mov_b32 s71, 0x20000
    s_lshl_b32 s14, s31, 1
    s_add_u32 s14, s14, s15
    s_lshl_b32 s14, s14, 3
    s_add_u32 s14, s14, s3
    s_lshl_b32 s16, s30, 7
    s_add_u32 s14, s14, s16
    s_lshl_b32 s16, s14, 11
    buffer_load_dwordx4 v[216:219], v2, s[76:79], s16 offen offset:0
    buffer_load_dwordx4 v[220:223], v2, s[76:79], s16 offen offset:1024
    s_lshl_b32 s16, s3, 10
    s_add_u32 m0, s16, 81920
    s_add_u32 s17, s16, 0x540800
    s_cmp_lt_u32 s3, 6
    s_cselect_b32 s17, s17, 0x7ffffff0
    s_sub_u32 s23, s16, 6144
    s_cmp_ge_u32 s3, 6
    s_cselect_b32 s23, s23, 0x7ffffff0
    s_cbranch_scc1 adaLN_cond__sliding_block_cached__moe_arch_mod__prompt_kernel_mlw
    buffer_load_dwordx4 v2, s[8:11], s17 offen sc1 lds
    s_branch adaLN_cond__sliding_block_cached__moe_arch_mod__prompt_kernel_mlj
adaLN_cond__sliding_block_cached__moe_arch_mod__prompt_kernel_mlw:
    buffer_load_dwordx4 v2, s[64:67], s23 offen lds
adaLN_cond__sliding_block_cached__moe_arch_mod__prompt_kernel_mlj:
    s_lshl_b32 s16, s30, 5
    s_lshl_b32 s17, s31, 1
    s_add_u32 s16, s16, s17
    s_add_u32 s16, s16, s15
    s_lshl_b32 s16, s16, 2
    s_add_u32 s16, s16, 0x530000
    s_cmp_eq_u32 s3, 0
    s_cselect_b32 s16, s16, 0x7ffffff0
    v_mov_b32 v16, s28
    v_mov_b32 v17, 0
    s_lshr_b32 s18, s14, 4
    s_lshl_b32 s18, s18, 15
    s_and_b32 s19, s14, 15
    s_lshl_b32 s19, s19, 6
    s_add_u32 s18, s18, s19
    s_add_u32 s18, s18, 0x2000000
    s_add_u32 s19, s18, 16384
    v_lshrrev_b32 v18, 2, v1
    v_lshlrev_b32 v18, 10, v18
    v_and_b32 v19, 3, v1
    v_lshl_add_u32 v18, v19, 4, v18
    v_add_u32 v19, 0x400000, v18
    s_lshl_b32 s25, s30, 7
    s_add_u32 s25, s25, 0x530000
    v_and_b32 v20, 15, v1
    v_lshlrev_b32 v20, 2, v20
    s_waitcnt vmcnt(3)
    s_waitcnt vmcnt(0)
    s_barrier
    s_mov_b64 exec, 1
    buffer_store_dword v16, v17, s[8:11], s16 offen sc1
    s_mov_b64 exec, -1
    v_add_u32 v16, 81920, v2
    ds_read_b128 v[184:187], v16 offset:0
    ds_read_b128 v[188:191], v16 offset:1024
    ds_read_b128 v[192:195], v16 offset:2048
    ds_read_b128 v[196:199], v16 offset:3072
    ds_read_b128 v[200:203], v16 offset:4096
    ds_read_b128 v[204:207], v16 offset:5120
    ds_read_b128 v[208:211], v16 offset:6144
    ds_read_b128 v[212:215], v16 offset:7168
    v_mov_b32 v94, 0
    v_mov_b32 v95, 0
    s_waitcnt lgkmcnt(5)
    v_lshlrev_b32 v76, 16, v192
    v_and_b32 v77, 0xffff0000, v192
    s_waitcnt lgkmcnt(1)
    v_lshlrev_b32 v78, 16, v208
    v_and_b32 v79, 0xffff0000, v208
    v_pk_mul_f32 v[60:61], v[76:77], v[78:79]
    v_lshlrev_b32 v76, 16, v184
    v_and_b32 v77, 0xffff0000, v184
    v_fmac_f32 v94, v76, v78
    v_fmac_f32 v94, v77, v79
    v_add_f32 v95, v95, v60
    v_add_f32 v95, v95, v61
    v_lshlrev_b32 v76, 16, v193
    v_and_b32 v77, 0xffff0000, v193
    v_lshlrev_b32 v78, 16, v209
    v_and_b32 v79, 0xffff0000, v209
    v_pk_mul_f32 v[62:63], v[76:77], v[78:79]
    v_lshlrev_b32 v76, 16, v185
    v_and_b32 v77, 0xffff0000, v185
    v_fmac_f32 v94, v76, v78
    v_fmac_f32 v94, v77, v79
    v_add_f32 v95, v95, v62
    v_add_f32 v95, v95, v63
    v_lshlrev_b32 v76, 16, v194
    v_and_b32 v77, 0xffff0000, v194
    v_lshlrev_b32 v78, 16, v210
    v_and_b32 v79, 0xffff0000, v210
    v_pk_mul_f32 v[64:65], v[76:77], v[78:79]
    v_lshlrev_b32 v76, 16, v186
    v_and_b32 v77, 0xffff0000, v186
    v_fmac_f32 v94, v76, v78
    v_fmac_f32 v94, v77, v79
    v_add_f32 v95, v95, v64
    v_add_f32 v95, v95, v65
    v_lshlrev_b32 v76, 16, v195
    v_and_b32 v77, 0xffff0000, v195
    v_lshlrev_b32 v78, 16, v211
    v_and_b32 v79, 0xffff0000, v211
    v_pk_mul_f32 v[66:67], v[76:77], v[78:79]
    v_lshlrev_b32 v76, 16, v187
    v_and_b32 v77, 0xffff0000, v187
    v_fmac_f32 v94, v76, v78
    v_fmac_f32 v94, v77, v79
    v_add_f32 v95, v95, v66
    v_add_f32 v95, v95, v67
    v_lshlrev_b32 v76, 16, v196
    v_and_b32 v77, 0xffff0000, v196
    s_waitcnt lgkmcnt(0)
    v_lshlrev_b32 v78, 16, v212
    v_and_b32 v79, 0xffff0000, v212
    v_pk_mul_f32 v[68:69], v[76:77], v[78:79]
    v_lshlrev_b32 v76, 16, v188
    v_and_b32 v77, 0xffff0000, v188
    v_fmac_f32 v94, v76, v78
    v_fmac_f32 v94, v77, v79
    v_add_f32 v95, v95, v68
    v_add_f32 v95, v95, v69
    v_lshlrev_b32 v76, 16, v197
    v_and_b32 v77, 0xffff0000, v197
    v_lshlrev_b32 v78, 16, v213
    v_and_b32 v79, 0xffff0000, v213
    v_pk_mul_f32 v[70:71], v[76:77], v[78:79]
    v_lshlrev_b32 v76, 16, v189
    v_and_b32 v77, 0xffff0000, v189
    v_fmac_f32 v94, v76, v78
    v_fmac_f32 v94, v77, v79
    v_add_f32 v95, v95, v70
    v_add_f32 v95, v95, v71
    v_lshlrev_b32 v76, 16, v198
    v_and_b32 v77, 0xffff0000, v198
    v_lshlrev_b32 v78, 16, v214
    v_and_b32 v79, 0xffff0000, v214
    v_pk_mul_f32 v[72:73], v[76:77], v[78:79]
    v_lshlrev_b32 v76, 16, v190
    v_and_b32 v77, 0xffff0000, v190
    v_fmac_f32 v94, v76, v78
    v_fmac_f32 v94, v77, v79
    v_add_f32 v95, v95, v72
    v_add_f32 v95, v95, v73
    v_lshlrev_b32 v76, 16, v199
    v_and_b32 v77, 0xffff0000, v199
    v_lshlrev_b32 v78, 16, v215
    v_and_b32 v79, 0xffff0000, v215
    v_pk_mul_f32 v[74:75], v[76:77], v[78:79]
    v_lshlrev_b32 v76, 16, v191
    v_and_b32 v77, 0xffff0000, v191
    v_fmac_f32 v94, v76, v78
    v_fmac_f32 v94, v77, v79
    v_add_f32 v95, v95, v74
    v_add_f32 v95, v95, v75
    v_add_f32_dpp v94, v94, v94 row_ror:1 row_mask:0xf bank_mask:0xf
    s_nop 0
    v_add_f32_dpp v95, v95, v95 row_ror:1 row_mask:0xf bank_mask:0xf
    v_add_f32_dpp v94, v94, v94 row_ror:2 row_mask:0xf bank_mask:0xf
    s_nop 0
    v_add_f32_dpp v95, v95, v95 row_ror:2 row_mask:0xf bank_mask:0xf
    v_add_f32_dpp v94, v94, v94 row_ror:4 row_mask:0xf bank_mask:0xf
    s_nop 0
    v_add_f32_dpp v95, v95, v95 row_ror:4 row_mask:0xf bank_mask:0xf
    v_add_f32_dpp v94, v94, v94 row_ror:8 row_mask:0xf bank_mask:0xf
    s_nop 0
    v_add_f32_dpp v95, v95, v95 row_ror:8 row_mask:0xf bank_mask:0xf
    v_mov_b32 v76, v94
    s_nop 1
    v_permlane16_swap_b32 v94, v76
    v_add_f32 v94, v94, v76
    v_mov_b32 v77, v95
    s_nop 1
    v_permlane16_swap_b32 v95, v77
    v_add_f32 v95, v95, v77
    v_mov_b32 v76, v94
    s_nop 1
    v_permlane32_swap_b32 v94, v76
    v_add_f32 v94, v94, v76
    v_mov_b32 v77, v95
    s_nop 1
    v_permlane32_swap_b32 v95, v77
    v_add_f32 v95, v95, v77
    v_lshlrev_b32 v28, 16, v216
    v_and_b32 v29, 0xffff0000, v216
    v_lshlrev_b32 v30, 16, v217
    v_and_b32 v31, 0xffff0000, v217
    v_lshlrev_b32 v32, 16, v218
    v_and_b32 v33, 0xffff0000, v218
    v_lshlrev_b32 v34, 16, v219
    v_and_b32 v35, 0xffff0000, v219
    v_lshlrev_b32 v36, 16, v220
    v_and_b32 v37, 0xffff0000, v220
    v_lshlrev_b32 v38, 16, v221
    v_and_b32 v39, 0xffff0000, v221
    v_lshlrev_b32 v40, 16, v222
    v_and_b32 v41, 0xffff0000, v222
    v_lshlrev_b32 v42, 16, v223
    v_and_b32 v43, 0xffff0000, v223
    s_sleep 16
    s_mov_b32 s27, 0
adaLN_cond__sliding_block_cached__moe_arch_mod__prompt_kernel_a22p:
    buffer_load_dword v76, v20, s[8:11], s25 offen sc1
    s_waitcnt vmcnt(0)
    v_cmp_ne_u32 vcc, s28, v76
    s_add_u32 s27, s27, 1
    s_cmp_ge_u32 s27, 65536
    s_cbranch_scc1 adaLN_cond__sliding_block_cached__moe_arch_mod__prompt_kernel_a22g
    s_cbranch_vccnz adaLN_cond__sliding_block_cached__moe_arch_mod__prompt_kernel_a22p
adaLN_cond__sliding_block_cached__moe_arch_mod__prompt_kernel_a22g:
    buffer_load_dwordx4 v[44:47], v18, s[8:11], s18 offen sc1
    buffer_load_dwordx4 v[52:55], v19, s[8:11], s18 offen sc1
    buffer_load_dwordx4 v[48:51], v18, s[8:11], s19 offen sc1
    buffer_load_dwordx4 v[56:59], v19, s[8:11], s19 offen sc1
    v_lshlrev_b32 v21, 2, v0
    s_mov_b32 s16, 0x540800
    buffer_load_dword v106, v21, s[8:11], s16 offen sc1
    buffer_load_dword v104, v21, s[8:11], s16 offen offset:2048 sc1
    s_waitcnt vmcnt(5)
    v_lshlrev_b32 v76, 16, v44
    v_and_b32 v77, 0xffff0000, v44
    s_waitcnt vmcnt(4)
    v_lshlrev_b32 v78, 16, v52
    v_and_b32 v79, 0xffff0000, v52
    v_pk_add_f32 v[76:77], v[76:77], v[78:79]
    v_pk_add_f32 v[28:29], v[28:29], v[76:77]
    v_cvt_pk_bf16_f32 v16, v28, v29
    v_lshlrev_b32 v28, 16, v16
    v_and_b32 v29, 0xffff0000, v16
    v_lshlrev_b32 v80, 16, v45
    v_and_b32 v81, 0xffff0000, v45
    v_lshlrev_b32 v82, 16, v53
    v_and_b32 v83, 0xffff0000, v53
    v_pk_add_f32 v[80:81], v[80:81], v[82:83]
    v_pk_add_f32 v[30:31], v[30:31], v[80:81]
    v_cvt_pk_bf16_f32 v17, v30, v31
    v_lshlrev_b32 v30, 16, v17
    v_and_b32 v31, 0xffff0000, v17
    v_lshlrev_b32 v76, 16, v46
    v_and_b32 v77, 0xffff0000, v46
    v_lshlrev_b32 v78, 16, v54
    v_and_b32 v79, 0xffff0000, v54
    v_pk_add_f32 v[76:77], v[76:77], v[78:79]
    v_pk_add_f32 v[32:33], v[32:33], v[76:77]
    v_cvt_pk_bf16_f32 v16, v32, v33
    v_lshlrev_b32 v32, 16, v16
    v_and_b32 v33, 0xffff0000, v16
    v_lshlrev_b32 v80, 16, v47
    v_and_b32 v81, 0xffff0000, v47
    v_lshlrev_b32 v82, 16, v55
    v_and_b32 v83, 0xffff0000, v55
    v_pk_add_f32 v[80:81], v[80:81], v[82:83]
    v_pk_add_f32 v[34:35], v[34:35], v[80:81]
    v_cvt_pk_bf16_f32 v17, v34, v35
    v_lshlrev_b32 v34, 16, v17
    v_and_b32 v35, 0xffff0000, v17
    s_waitcnt vmcnt(3)
    v_lshlrev_b32 v76, 16, v48
    v_and_b32 v77, 0xffff0000, v48
    s_waitcnt vmcnt(2)
    v_lshlrev_b32 v78, 16, v56
    v_and_b32 v79, 0xffff0000, v56
    v_pk_add_f32 v[76:77], v[76:77], v[78:79]
    v_pk_add_f32 v[36:37], v[36:37], v[76:77]
    v_cvt_pk_bf16_f32 v16, v36, v37
    v_lshlrev_b32 v36, 16, v16
    v_and_b32 v37, 0xffff0000, v16
    v_lshlrev_b32 v80, 16, v49
    v_and_b32 v81, 0xffff0000, v49
    v_lshlrev_b32 v82, 16, v57
    v_and_b32 v83, 0xffff0000, v57
    v_pk_add_f32 v[80:81], v[80:81], v[82:83]
    v_pk_add_f32 v[38:39], v[38:39], v[80:81]
    v_cvt_pk_bf16_f32 v17, v38, v39
    v_lshlrev_b32 v38, 16, v17
    v_and_b32 v39, 0xffff0000, v17
    v_lshlrev_b32 v76, 16, v50
    v_and_b32 v77, 0xffff0000, v50
    v_lshlrev_b32 v78, 16, v58
    v_and_b32 v79, 0xffff0000, v58
    v_pk_add_f32 v[76:77], v[76:77], v[78:79]
    v_pk_add_f32 v[40:41], v[40:41], v[76:77]
    v_cvt_pk_bf16_f32 v16, v40, v41
    v_lshlrev_b32 v40, 16, v16
    v_and_b32 v41, 0xffff0000, v16
    v_lshlrev_b32 v80, 16, v51
    v_and_b32 v81, 0xffff0000, v51
    v_lshlrev_b32 v82, 16, v59
    v_and_b32 v83, 0xffff0000, v59
    v_pk_add_f32 v[80:81], v[80:81], v[82:83]
    v_pk_add_f32 v[42:43], v[42:43], v[80:81]
    v_cvt_pk_bf16_f32 v17, v42, v43
    v_lshlrev_b32 v42, 16, v17
    v_and_b32 v43, 0xffff0000, v17
    v_pk_add_f32 v[76:77], v[28:29], v[30:31]
    v_pk_mul_f32 v[78:79], v[28:29], v[28:29]
    v_pk_mul_f32 v[80:81], v[28:29], v[60:61]
    v_pk_fma_f32 v[78:79], v[30:31], v[30:31], v[78:79]
    v_pk_fma_f32 v[80:81], v[30:31], v[62:63], v[80:81]
    v_pk_add_f32 v[76:77], v[76:77], v[32:33]
    v_pk_fma_f32 v[78:79], v[32:33], v[32:33], v[78:79]
    v_pk_fma_f32 v[80:81], v[32:33], v[64:65], v[80:81]
    v_pk_add_f32 v[76:77], v[76:77], v[34:35]
    v_pk_fma_f32 v[78:79], v[34:35], v[34:35], v[78:79]
    v_pk_fma_f32 v[80:81], v[34:35], v[66:67], v[80:81]
    v_pk_add_f32 v[76:77], v[76:77], v[36:37]
    v_pk_fma_f32 v[78:79], v[36:37], v[36:37], v[78:79]
    v_pk_fma_f32 v[80:81], v[36:37], v[68:69], v[80:81]
    v_pk_add_f32 v[76:77], v[76:77], v[38:39]
    v_pk_fma_f32 v[78:79], v[38:39], v[38:39], v[78:79]
    v_pk_fma_f32 v[80:81], v[38:39], v[70:71], v[80:81]
    v_pk_add_f32 v[76:77], v[76:77], v[40:41]
    v_pk_fma_f32 v[78:79], v[40:41], v[40:41], v[78:79]
    v_pk_fma_f32 v[80:81], v[40:41], v[72:73], v[80:81]
    v_pk_add_f32 v[76:77], v[76:77], v[42:43]
    v_pk_fma_f32 v[78:79], v[42:43], v[42:43], v[78:79]
    v_pk_fma_f32 v[80:81], v[42:43], v[74:75], v[80:81]
    v_add_f32 v96, v76, v77
    v_add_f32 v97, v78, v79
    v_add_f32 v98, v80, v81
    v_add_f32_dpp v96, v96, v96 row_ror:1 row_mask:0xf bank_mask:0xf
    v_add_f32_dpp v97, v97, v97 row_ror:1 row_mask:0xf bank_mask:0xf
    v_add_f32_dpp v98, v98, v98 row_ror:1 row_mask:0xf bank_mask:0xf
    v_add_f32_dpp v96, v96, v96 row_ror:2 row_mask:0xf bank_mask:0xf
    v_add_f32_dpp v97, v97, v97 row_ror:2 row_mask:0xf bank_mask:0xf
    v_add_f32_dpp v98, v98, v98 row_ror:2 row_mask:0xf bank_mask:0xf
    v_add_f32_dpp v96, v96, v96 row_ror:4 row_mask:0xf bank_mask:0xf
    v_add_f32_dpp v97, v97, v97 row_ror:4 row_mask:0xf bank_mask:0xf
    v_add_f32_dpp v98, v98, v98 row_ror:4 row_mask:0xf bank_mask:0xf
    v_add_f32_dpp v96, v96, v96 row_ror:8 row_mask:0xf bank_mask:0xf
    v_add_f32_dpp v97, v97, v97 row_ror:8 row_mask:0xf bank_mask:0xf
    v_add_f32_dpp v98, v98, v98 row_ror:8 row_mask:0xf bank_mask:0xf
    v_mov_b32 v76, v96
    s_nop 1
    v_permlane16_swap_b32 v96, v76
    v_add_f32 v96, v96, v76
    v_mov_b32 v77, v97
    s_nop 1
    v_permlane16_swap_b32 v97, v77
    v_add_f32 v97, v97, v77
    v_mov_b32 v78, v98
    s_nop 1
    v_permlane16_swap_b32 v98, v78
    v_add_f32 v98, v98, v78
    v_mov_b32 v76, v96
    s_nop 1
    v_permlane32_swap_b32 v96, v76
    v_add_f32 v96, v96, v76
    v_mov_b32 v77, v97
    s_nop 1
    v_permlane32_swap_b32 v97, v77
    v_add_f32 v97, v97, v77
    v_mov_b32 v78, v98
    s_nop 1
    v_permlane32_swap_b32 v98, v78
    v_add_f32 v98, v98, v78
    v_mul_f32 v96, 0x3a800000, v96
    v_mul_f32 v97, 0x3a800000, v97
    v_fma_f32 v97, -v96, v96, v97
    v_max_f32 v97, 0, v97
    v_fma_f32 v98, -v96, v95, v98
    v_add_f32 v76, 0x3727c5ac, v97
    v_rsq_f32 v76, v76
    s_nop 0
    v_fma_f32 v27, v98, v76, v94
    v_cvt_pk_bf16_f32 v96, v96, v96
    v_lshlrev_b32 v96, 16, v96
    v_cvt_pk_bf16_f32 v97, v97, v97
    v_lshlrev_b32 v97, 16, v97
    v_add_f32 v97, 0x3727c5ac, v97
    v_cvt_pk_bf16_f32 v97, v97, v97
    v_lshlrev_b32 v97, 16, v97
    v_sqrt_f32 v98, v97
    s_nop 0
    v_cvt_pk_bf16_f32 v98, v98, v98
    v_lshlrev_b32 v98, 16, v98
    v_rcp_f32 v99, v98
    v_mov_b32 v25, v96
    v_mov_b32 v26, v98
    v_ashrrev_i32 v16, 31, v27
    v_or_b32 v16, 0x80000000, v16
    v_xor_b32 v24, v27, v16
    v_and_b32 v24, 0xfffff800, v24
    v_max_u32 v24, 0x800, v24
    s_sub_u32 s16, 2047, s14
    v_or_b32 v24, s16, v24
    s_lshl_b32 s16, s3, 4
    s_add_u32 s16, s16, 65536
    v_mov_b32 v16, s16
    ds_write_b128 v16, v[24:27]
    s_waitcnt lgkmcnt(0)
    s_barrier
    v_and_b32 v16, 7, v1
    v_lshlrev_b32 v16, 4, v16
    v_add_u32 v16, 65536, v16
    ds_read_b32 v76, v16
    s_waitcnt lgkmcnt(0)
    v_mov_b32 v77, v76
    s_nop 1
    v_max_u32_dpp v77, v77, v77 row_ror:1 row_mask:0xf bank_mask:0xf
    s_nop 1
    v_max_u32_dpp v77, v77, v77 row_ror:2 row_mask:0xf bank_mask:0xf
    s_nop 1
    v_max_u32_dpp v77, v77, v77 row_ror:4 row_mask:0xf bank_mask:0xf
    v_cmp_eq_u32 vcc, v76, v77
    s_ff1_i32_b64 s16, vcc
    s_lshl_b32 s16, s16, 4
    s_add_u32 s16, s16, 65536
    v_mov_b32 v16, s16
    ds_read_b128 v[24:27], v16
    s_lshl_b32 s16, s2, 4
    s_add_u32 s16, s16, 0x6e0000
    s_cmp_eq_u32 s3, 0
    s_cselect_b32 s16, s16, 0x7ffffff0
    v_mov_b32 v17, 0
    s_mov_b64 exec, 1
    s_waitcnt lgkmcnt(0)
    buffer_store_dwordx4 v[24:27], v17, s[8:11], s16 offen sc1
    s_mov_b64 exec, -1
    s_mov_b64 s[72:73], s[50:51]
    s_mov_b32 s74, 0x700000
    s_mov_b32 s75, 0x20000
    s_cmp_lt_u32 s2, 224
    s_cselect_b32 s74, 7340032, 0
    s_lshl_b32 s17, s29, 4
    s_sub_u32 s16, s3, 4
    s_lshl_b32 s16, s16, 2
    s_add_u32 s16, s16, s17
    s_lshl_b32 s16, s16, 11
    s_add_u32 s17, s16, 0
    buffer_load_dwordx4 v[152:155], v2, s[72:75], s17 offen offset:0
    buffer_load_dwordx4 v[156:159], v2, s[72:75], s17 offen offset:1024
    s_add_u32 s17, s16, 2048
    buffer_load_dwordx4 v[160:163], v2, s[72:75], s17 offen offset:0
    buffer_load_dwordx4 v[164:167], v2, s[72:75], s17 offen offset:1024
    s_add_u32 s17, s16, 4096
    buffer_load_dwordx4 v[168:171], v2, s[72:75], s17 offen offset:0
    buffer_load_dwordx4 v[172:175], v2, s[72:75], s17 offen offset:1024
    s_add_u32 s17, s16, 6144
    buffer_load_dwordx4 v[176:179], v2, s[72:75], s17 offen offset:0
    buffer_load_dwordx4 v[180:183], v2, s[72:75], s17 offen offset:1024
    v_sub_f32 v44, v28, v96
    v_sub_f32 v45, v29, v96
    v_sub_f32 v46, v30, v96
    v_sub_f32 v47, v31, v96
    v_sub_f32 v48, v32, v96
    v_sub_f32 v49, v33, v96
    v_sub_f32 v50, v34, v96
    v_sub_f32 v51, v35, v96
    v_cvt_pk_bf16_f32 v16, v44, v45
    v_lshlrev_b32 v44, 16, v16
    v_and_b32 v45, 0xffff0000, v16
    v_cvt_pk_bf16_f32 v16, v46, v47
    v_lshlrev_b32 v46, 16, v16
    v_and_b32 v47, 0xffff0000, v16
    v_cvt_pk_bf16_f32 v16, v48, v49
    v_lshlrev_b32 v48, 16, v16
    v_and_b32 v49, 0xffff0000, v16
    v_cvt_pk_bf16_f32 v16, v50, v51
    v_lshlrev_b32 v50, 16, v16
    v_and_b32 v51, 0xffff0000, v16
    v_mul_f32 v52, v44, v99
    v_mul_f32 v53, v45, v99
    v_mul_f32 v54, v46, v99
    v_mul_f32 v55, v47, v99
    v_mul_f32 v56, v48, v99
    v_mul_f32 v57, v49, v99
    v_mul_f32 v58, v50, v99
    v_mul_f32 v59, v51, v99
    v_fma_f32 v44, -v52, v98, v44
    v_fma_f32 v45, -v53, v98, v45
    v_fma_f32 v46, -v54, v98, v46
    v_fma_f32 v47, -v55, v98, v47
    v_fma_f32 v48, -v56, v98, v48
    v_fma_f32 v49, -v57, v98, v49
    v_fma_f32 v50, -v58, v98, v50
    v_fma_f32 v51, -v59, v98, v51
    v_fma_f32 v44, v44, v99, v52
    v_fma_f32 v45, v45, v99, v53
    v_fma_f32 v46, v46, v99, v54
    v_fma_f32 v47, v47, v99, v55
    v_fma_f32 v48, v48, v99, v56
    v_fma_f32 v49, v49, v99, v57
    v_fma_f32 v50, v50, v99, v58
    v_fma_f32 v51, v51, v99, v59
    v_cvt_pk_bf16_f32 v16, v44, v45
    v_lshlrev_b32 v44, 16, v16
    v_and_b32 v45, 0xffff0000, v16
    v_cvt_pk_bf16_f32 v16, v46, v47
    v_lshlrev_b32 v46, 16, v16
    v_and_b32 v47, 0xffff0000, v16
    v_cvt_pk_bf16_f32 v16, v48, v49
    v_lshlrev_b32 v48, 16, v16
    v_and_b32 v49, 0xffff0000, v16
    v_cvt_pk_bf16_f32 v16, v50, v51
    v_lshlrev_b32 v50, 16, v16
    v_and_b32 v51, 0xffff0000, v16
    v_lshlrev_b32 v52, 16, v192
    v_and_b32 v53, 0xffff0000, v192
    v_lshlrev_b32 v54, 16, v193
    v_and_b32 v55, 0xffff0000, v193
    v_lshlrev_b32 v56, 16, v194
    v_and_b32 v57, 0xffff0000, v194
    v_lshlrev_b32 v58, 16, v195
    v_and_b32 v59, 0xffff0000, v195
    v_pk_mul_f32 v[44:45], v[44:45], v[52:53]
    v_pk_mul_f32 v[46:47], v[46:47], v[54:55]
    v_pk_mul_f32 v[48:49], v[48:49], v[56:57]
    v_pk_mul_f32 v[50:51], v[50:51], v[58:59]
    v_cvt_pk_bf16_f32 v16, v44, v45
    v_lshlrev_b32 v44, 16, v16
    v_and_b32 v45, 0xffff0000, v16
    v_cvt_pk_bf16_f32 v16, v46, v47
    v_lshlrev_b32 v46, 16, v16
    v_and_b32 v47, 0xffff0000, v16
    v_cvt_pk_bf16_f32 v16, v48, v49
    v_lshlrev_b32 v48, 16, v16
    v_and_b32 v49, 0xffff0000, v16
    v_cvt_pk_bf16_f32 v16, v50, v51
    v_lshlrev_b32 v50, 16, v16
    v_and_b32 v51, 0xffff0000, v16
    v_lshlrev_b32 v52, 16, v184
    v_and_b32 v53, 0xffff0000, v184
    v_lshlrev_b32 v54, 16, v185
    v_and_b32 v55, 0xffff0000, v185
    v_lshlrev_b32 v56, 16, v186
    v_and_b32 v57, 0xffff0000, v186
    v_lshlrev_b32 v58, 16, v187
    v_and_b32 v59, 0xffff0000, v187
    v_pk_add_f32 v[44:45], v[44:45], v[52:53]
    v_pk_add_f32 v[46:47], v[46:47], v[54:55]
    v_pk_add_f32 v[48:49], v[48:49], v[56:57]
    v_pk_add_f32 v[50:51], v[50:51], v[58:59]
    v_cvt_pk_bf16_f32 v16, v44, v45
    v_lshlrev_b32 v44, 16, v16
    v_and_b32 v45, 0xffff0000, v16
    v_cvt_pk_bf16_f32 v16, v46, v47
    v_lshlrev_b32 v46, 16, v16
    v_and_b32 v47, 0xffff0000, v16
    v_cvt_pk_bf16_f32 v16, v48, v49
    v_lshlrev_b32 v48, 16, v16
    v_and_b32 v49, 0xffff0000, v16
    v_cvt_pk_bf16_f32 v16, v50, v51
    v_lshlrev_b32 v50, 16, v16
    v_and_b32 v51, 0xffff0000, v16
    v_lshlrev_b32 v52, 16, v200
    v_and_b32 v53, 0xffff0000, v200
    v_lshlrev_b32 v54, 16, v201
    v_and_b32 v55, 0xffff0000, v201
    v_lshlrev_b32 v56, 16, v202
    v_and_b32 v57, 0xffff0000, v202
    v_lshlrev_b32 v58, 16, v203
    v_and_b32 v59, 0xffff0000, v203
    v_pk_mul_f32 v[44:45], v[44:45], v[52:53]
    v_pk_mul_f32 v[46:47], v[46:47], v[54:55]
    v_pk_mul_f32 v[48:49], v[48:49], v[56:57]
    v_pk_mul_f32 v[50:51], v[50:51], v[58:59]
    v_cvt_pk_bf16_f32 v16, v44, v45
    v_lshlrev_b32 v44, 16, v16
    v_and_b32 v45, 0xffff0000, v16
    v_cvt_pk_bf16_f32 v16, v46, v47
    v_lshlrev_b32 v46, 16, v16
    v_and_b32 v47, 0xffff0000, v16
    v_cvt_pk_bf16_f32 v16, v48, v49
    v_lshlrev_b32 v48, 16, v16
    v_and_b32 v49, 0xffff0000, v16
    v_cvt_pk_bf16_f32 v16, v50, v51
    v_lshlrev_b32 v50, 16, v16
    v_and_b32 v51, 0xffff0000, v16
    v_pk_add_f32 v[44:45], v[44:45], v[28:29]
    v_pk_add_f32 v[46:47], v[46:47], v[30:31]
    v_pk_add_f32 v[48:49], v[48:49], v[32:33]
    v_pk_add_f32 v[50:51], v[50:51], v[34:35]
    v_cvt_pk_bf16_f32 v28, v44, v45
    v_cvt_pk_bf16_f32 v29, v46, v47
    v_cvt_pk_bf16_f32 v30, v48, v49
    v_cvt_pk_bf16_f32 v31, v50, v51
    v_sub_f32 v44, v36, v96
    v_sub_f32 v45, v37, v96
    v_sub_f32 v46, v38, v96
    v_sub_f32 v47, v39, v96
    v_sub_f32 v48, v40, v96
    v_sub_f32 v49, v41, v96
    v_sub_f32 v50, v42, v96
    v_sub_f32 v51, v43, v96
    v_cvt_pk_bf16_f32 v16, v44, v45
    v_lshlrev_b32 v44, 16, v16
    v_and_b32 v45, 0xffff0000, v16
    v_cvt_pk_bf16_f32 v16, v46, v47
    v_lshlrev_b32 v46, 16, v16
    v_and_b32 v47, 0xffff0000, v16
    v_cvt_pk_bf16_f32 v16, v48, v49
    v_lshlrev_b32 v48, 16, v16
    v_and_b32 v49, 0xffff0000, v16
    v_cvt_pk_bf16_f32 v16, v50, v51
    v_lshlrev_b32 v50, 16, v16
    v_and_b32 v51, 0xffff0000, v16
    v_mul_f32 v52, v44, v99
    v_mul_f32 v53, v45, v99
    v_mul_f32 v54, v46, v99
    v_mul_f32 v55, v47, v99
    v_mul_f32 v56, v48, v99
    v_mul_f32 v57, v49, v99
    v_mul_f32 v58, v50, v99
    v_mul_f32 v59, v51, v99
    v_fma_f32 v44, -v52, v98, v44
    v_fma_f32 v45, -v53, v98, v45
    v_fma_f32 v46, -v54, v98, v46
    v_fma_f32 v47, -v55, v98, v47
    v_fma_f32 v48, -v56, v98, v48
    v_fma_f32 v49, -v57, v98, v49
    v_fma_f32 v50, -v58, v98, v50
    v_fma_f32 v51, -v59, v98, v51
    v_fma_f32 v44, v44, v99, v52
    v_fma_f32 v45, v45, v99, v53
    v_fma_f32 v46, v46, v99, v54
    v_fma_f32 v47, v47, v99, v55
    v_fma_f32 v48, v48, v99, v56
    v_fma_f32 v49, v49, v99, v57
    v_fma_f32 v50, v50, v99, v58
    v_fma_f32 v51, v51, v99, v59
    v_cvt_pk_bf16_f32 v16, v44, v45
    v_lshlrev_b32 v44, 16, v16
    v_and_b32 v45, 0xffff0000, v16
    v_cvt_pk_bf16_f32 v16, v46, v47
    v_lshlrev_b32 v46, 16, v16
    v_and_b32 v47, 0xffff0000, v16
    v_cvt_pk_bf16_f32 v16, v48, v49
    v_lshlrev_b32 v48, 16, v16
    v_and_b32 v49, 0xffff0000, v16
    v_cvt_pk_bf16_f32 v16, v50, v51
    v_lshlrev_b32 v50, 16, v16
    v_and_b32 v51, 0xffff0000, v16
    v_lshlrev_b32 v52, 16, v196
    v_and_b32 v53, 0xffff0000, v196
    v_lshlrev_b32 v54, 16, v197
    v_and_b32 v55, 0xffff0000, v197
    v_lshlrev_b32 v56, 16, v198
    v_and_b32 v57, 0xffff0000, v198
    v_lshlrev_b32 v58, 16, v199
    v_and_b32 v59, 0xffff0000, v199
    v_pk_mul_f32 v[44:45], v[44:45], v[52:53]
    v_pk_mul_f32 v[46:47], v[46:47], v[54:55]
    v_pk_mul_f32 v[48:49], v[48:49], v[56:57]
    v_pk_mul_f32 v[50:51], v[50:51], v[58:59]
    v_cvt_pk_bf16_f32 v16, v44, v45
    v_lshlrev_b32 v44, 16, v16
    v_and_b32 v45, 0xffff0000, v16
    v_cvt_pk_bf16_f32 v16, v46, v47
    v_lshlrev_b32 v46, 16, v16
    v_and_b32 v47, 0xffff0000, v16
    v_cvt_pk_bf16_f32 v16, v48, v49
    v_lshlrev_b32 v48, 16, v16
    v_and_b32 v49, 0xffff0000, v16
    v_cvt_pk_bf16_f32 v16, v50, v51
    v_lshlrev_b32 v50, 16, v16
    v_and_b32 v51, 0xffff0000, v16
    v_lshlrev_b32 v52, 16, v188
    v_and_b32 v53, 0xffff0000, v188
    v_lshlrev_b32 v54, 16, v189
    v_and_b32 v55, 0xffff0000, v189
    v_lshlrev_b32 v56, 16, v190
    v_and_b32 v57, 0xffff0000, v190
    v_lshlrev_b32 v58, 16, v191
    v_and_b32 v59, 0xffff0000, v191
    v_pk_add_f32 v[44:45], v[44:45], v[52:53]
    v_pk_add_f32 v[46:47], v[46:47], v[54:55]
    v_pk_add_f32 v[48:49], v[48:49], v[56:57]
    v_pk_add_f32 v[50:51], v[50:51], v[58:59]
    v_cvt_pk_bf16_f32 v16, v44, v45
    v_lshlrev_b32 v44, 16, v16
    v_and_b32 v45, 0xffff0000, v16
    v_cvt_pk_bf16_f32 v16, v46, v47
    v_lshlrev_b32 v46, 16, v16
    v_and_b32 v47, 0xffff0000, v16
    v_cvt_pk_bf16_f32 v16, v48, v49
    v_lshlrev_b32 v48, 16, v16
    v_and_b32 v49, 0xffff0000, v16
    v_cvt_pk_bf16_f32 v16, v50, v51
    v_lshlrev_b32 v50, 16, v16
    v_and_b32 v51, 0xffff0000, v16
    v_lshlrev_b32 v52, 16, v204
    v_and_b32 v53, 0xffff0000, v204
    v_lshlrev_b32 v54, 16, v205
    v_and_b32 v55, 0xffff0000, v205
    v_lshlrev_b32 v56, 16, v206
    v_and_b32 v57, 0xffff0000, v206
    v_lshlrev_b32 v58, 16, v207
    v_and_b32 v59, 0xffff0000, v207
    v_pk_mul_f32 v[44:45], v[44:45], v[52:53]
    v_pk_mul_f32 v[46:47], v[46:47], v[54:55]
    v_pk_mul_f32 v[48:49], v[48:49], v[56:57]
    v_pk_mul_f32 v[50:51], v[50:51], v[58:59]
    v_cvt_pk_bf16_f32 v16, v44, v45
    v_lshlrev_b32 v44, 16, v16
    v_and_b32 v45, 0xffff0000, v16
    v_cvt_pk_bf16_f32 v16, v46, v47
    v_lshlrev_b32 v46, 16, v16
    v_and_b32 v47, 0xffff0000, v16
    v_cvt_pk_bf16_f32 v16, v48, v49
    v_lshlrev_b32 v48, 16, v16
    v_and_b32 v49, 0xffff0000, v16
    v_cvt_pk_bf16_f32 v16, v50, v51
    v_lshlrev_b32 v50, 16, v16
    v_and_b32 v51, 0xffff0000, v16
    v_pk_add_f32 v[44:45], v[44:45], v[36:37]
    v_pk_add_f32 v[46:47], v[46:47], v[38:39]
    v_pk_add_f32 v[48:49], v[48:49], v[40:41]
    v_pk_add_f32 v[50:51], v[50:51], v[42:43]
    v_cvt_pk_bf16_f32 v36, v44, v45
    v_cvt_pk_bf16_f32 v37, v46, v47
    v_cvt_pk_bf16_f32 v38, v48, v49
    v_cvt_pk_bf16_f32 v39, v50, v51
    s_barrier
    v_and_b32 v16, 3, v1
    v_lshlrev_b32 v16, 4, v16
    v_add_u32 v16, 65792, v16
    ds_read_b32 v76, v16
    s_waitcnt lgkmcnt(0)
    v_mov_b32 v77, v76
    s_nop 1
    v_max_u32_dpp v77, v77, v77 row_ror:1 row_mask:0xf bank_mask:0xf
    s_nop 1
    v_max_u32_dpp v77, v77, v77 row_ror:2 row_mask:0xf bank_mask:0xf
    v_cmp_eq_u32 vcc, v76, v77
    s_ff1_i32_b64 s16, vcc
    s_lshl_b32 s16, s16, 4
    s_add_u32 s16, s16, 65792
    v_mov_b32 v16, s16
    ds_read_b128 v[24:27], v16
    s_waitcnt lgkmcnt(0)
    v_and_b32 v76, 0x7ff, v24
    v_sub_u32 v76, 2047, v76
    s_nop 0
    v_readfirstlane_b32 s12, v76
    v_rcp_f32 v103, v26
    s_lshr_b32 s18, s12, 4
    s_lshl_b32 s18, s18, 15
    s_and_b32 s19, s12, 15
    s_lshl_b32 s19, s19, 6
    s_add_u32 s18, s18, s19
    s_add_u32 s18, s18, 0x2000000
    s_add_u32 s19, s18, 0x400000
    v_lshrrev_b32 v18, 4, v0
    v_lshlrev_b32 v18, 10, v18
    v_and_b32 v19, 15, v0
    v_lshl_add_u32 v18, v19, 2, v18
    s_lshl_b32 s13, s12, 11
    buffer_load_dword v100, v18, s[8:11], s18 offen sc1
    buffer_load_dword v101, v18, s[8:11], s19 offen sc1
    buffer_load_dword v102, v21, s[76:79], s13 offen
    s_lshl_b32 s16, s14, 11
    s_cmp_lg_u32 s12, s14
    s_cselect_b32 s16, s16, 0x7ffffff0
    buffer_store_dwordx4 v[28:31], v2, s[68:71], s16 offen offset:0 sc1
    buffer_store_dwordx4 v[36:39], v2, s[68:71], s16 offen offset:1024 sc1
    s_lshl_b32 s16, s3, 13
    v_add_u32 v20, s16, v2
    s_waitcnt vmcnt(4)
    v_lshlrev_b32 v76, 16, v100
    v_and_b32 v77, 0xffff0000, v100
    s_waitcnt vmcnt(3)
    v_lshlrev_b32 v78, 16, v101
    v_and_b32 v79, 0xffff0000, v101
    v_pk_add_f32 v[76:77], v[76:77], v[78:79]
    s_waitcnt vmcnt(2)
    v_lshlrev_b32 v78, 16, v102
    v_and_b32 v79, 0xffff0000, v102
    v_pk_add_f32 v[92:93], v[78:79], v[76:77]
    v_cvt_pk_bf16_f32 v76, v92, v93
    v_lshlrev_b32 v92, 16, v76
    v_and_b32 v93, 0xffff0000, v76
    v_cvt_pk_bf16_f32 v100, v92, v93
    v_and_b32 v105, 0xffff0000, v104
    v_lshlrev_b32 v104, 16, v104
    v_and_b32 v107, 0xffff0000, v106
    v_lshlrev_b32 v106, 16, v106
    v_sub_f32 v92, v92, v25
    v_sub_f32 v93, v93, v25
    v_cvt_pk_bf16_f32 v76, v92, v93
    v_lshlrev_b32 v92, 16, v76
    v_and_b32 v93, 0xffff0000, v76
    v_mul_f32 v77, v92, v103
    v_fma_f32 v92, -v77, v26, v92
    v_fma_f32 v92, v92, v103, v77
    v_mul_f32 v77, v93, v103
    v_fma_f32 v93, -v77, v26, v93
    v_fma_f32 v93, v93, v103, v77
    v_cvt_pk_bf16_f32 v76, v92, v93
    v_lshlrev_b32 v92, 16, v76
    v_and_b32 v93, 0xffff0000, v76
    v_mul_f32 v92, v92, v104
    v_mul_f32 v93, v93, v105
    v_cvt_pk_bf16_f32 v76, v92, v93
    v_lshlrev_b32 v92, 16, v76
    v_and_b32 v93, 0xffff0000, v76
    v_add_f32 v92, v92, v106
    v_add_f32 v93, v93, v107
    v_cvt_pk_bf16_f32 v101, v92, v93
    v_add_u32 v16, 66560, v21
    ds_write_b32 v16, v101
    ds_write_b32 v16, v100 offset:2048
    s_waitcnt lgkmcnt(0)
    s_barrier
    ds_read_b128 v[60:63], v20 offset:0
    ds_read_b128 v[64:67], v20 offset:1024
    ds_read_b128 v[68:71], v20 offset:2048
    ds_read_b128 v[72:75], v20 offset:3072
    ds_read_b128 v[108:111], v20 offset:4096
    ds_read_b128 v[112:115], v20 offset:5120
    ds_read_b128 v[116:119], v20 offset:6144
    ds_read_b128 v[120:123], v20 offset:7168
    s_and_b32 s16, s3, 3
    s_lshl_b32 s16, s16, 7
    s_and_b32 s17, s29, 3
    s_lshl_b32 s17, s17, 9
    s_add_u32 s16, s16, s17
    s_add_u32 s16, s16, 66560
    v_lshrrev_b32 v16, 3, v1
    v_lshlrev_b32 v16, 4, v16
    v_add_u32 v16, s16, v16
    ds_read_b128 v[104:107], v16
    s_waitcnt lgkmcnt(0)
    v_lshlrev_b32 v76, 16, v104
    v_and_b32 v77, 0xffff, v104
    v_dot2_f32_bf16 v85, v60, v76, 0
    v_dot2_f32_bf16 v84, v60, v77, 0
    v_dot2_f32_bf16 v87, v61, v76, 0
    v_dot2_f32_bf16 v86, v61, v77, 0
    v_dot2_f32_bf16 v89, v62, v76, 0
    v_dot2_f32_bf16 v88, v62, v77, 0
    v_dot2_f32_bf16 v91, v63, v76, 0
    v_dot2_f32_bf16 v90, v63, v77, 0
    v_and_b32 v78, 0xffff0000, v104
    v_lshrrev_b32 v79, 16, v104
    v_dot2c_f32_bf16 v85, v64, v78
    v_dot2c_f32_bf16 v84, v64, v79
    v_dot2c_f32_bf16 v87, v65, v78
    v_dot2c_f32_bf16 v86, v65, v79
    v_dot2c_f32_bf16 v89, v66, v78
    v_dot2c_f32_bf16 v88, v66, v79
    v_dot2c_f32_bf16 v91, v67, v78
    v_dot2c_f32_bf16 v90, v67, v79
    v_lshlrev_b32 v80, 16, v105
    v_and_b32 v81, 0xffff, v105
    v_dot2c_f32_bf16 v85, v68, v80
    v_dot2c_f32_bf16 v84, v68, v81
    v_dot2c_f32_bf16 v87, v69, v80
    v_dot2c_f32_bf16 v86, v69, v81
    v_dot2c_f32_bf16 v89, v70, v80
    v_dot2c_f32_bf16 v88, v70, v81
    v_dot2c_f32_bf16 v91, v71, v80
    v_dot2c_f32_bf16 v90, v71, v81
    v_and_b32 v82, 0xffff0000, v105
    v_lshrrev_b32 v83, 16, v105
    v_dot2c_f32_bf16 v85, v72, v82
    v_dot2c_f32_bf16 v84, v72, v83
    v_dot2c_f32_bf16 v87, v73, v82
    v_dot2c_f32_bf16 v86, v73, v83
    v_dot2c_f32_bf16 v89, v74, v82
    v_dot2c_f32_bf16 v88, v74, v83
    v_dot2c_f32_bf16 v91, v75, v82
    v_dot2c_f32_bf16 v90, v75, v83
    v_lshlrev_b32 v76, 16, v106
    v_and_b32 v77, 0xffff, v106
    v_dot2c_f32_bf16 v85, v108, v76
    v_dot2c_f32_bf16 v84, v108, v77
    v_dot2c_f32_bf16 v87, v109, v76
    v_dot2c_f32_bf16 v86, v109, v77
    v_dot2c_f32_bf16 v89, v110, v76
    v_dot2c_f32_bf16 v88, v110, v77
    v_dot2c_f32_bf16 v91, v111, v76
    v_dot2c_f32_bf16 v90, v111, v77
    v_and_b32 v78, 0xffff0000, v106
    v_lshrrev_b32 v79, 16, v106
    v_dot2c_f32_bf16 v85, v112, v78
    v_dot2c_f32_bf16 v84, v112, v79
    v_dot2c_f32_bf16 v87, v113, v78
    v_dot2c_f32_bf16 v86, v113, v79
    v_dot2c_f32_bf16 v89, v114, v78
    v_dot2c_f32_bf16 v88, v114, v79
    v_dot2c_f32_bf16 v91, v115, v78
    v_dot2c_f32_bf16 v90, v115, v79
    v_lshlrev_b32 v80, 16, v107
    v_and_b32 v81, 0xffff, v107
    v_dot2c_f32_bf16 v85, v116, v80
    v_dot2c_f32_bf16 v84, v116, v81
    v_dot2c_f32_bf16 v87, v117, v80
    v_dot2c_f32_bf16 v86, v117, v81
    v_dot2c_f32_bf16 v89, v118, v80
    v_dot2c_f32_bf16 v88, v118, v81
    v_dot2c_f32_bf16 v91, v119, v80
    v_dot2c_f32_bf16 v90, v119, v81
    v_and_b32 v82, 0xffff0000, v107
    v_lshrrev_b32 v83, 16, v107
    v_dot2c_f32_bf16 v85, v120, v82
    v_dot2c_f32_bf16 v84, v120, v83
    v_dot2c_f32_bf16 v87, v121, v82
    v_dot2c_f32_bf16 v86, v121, v83
    v_dot2c_f32_bf16 v89, v122, v82
    v_dot2c_f32_bf16 v88, v122, v83
    v_dot2c_f32_bf16 v91, v123, v82
    v_dot2c_f32_bf16 v90, v123, v83
    s_nop 0
    v_permlane32_swap_b32 v84, v88
    v_permlane32_swap_b32 v85, v89
    v_permlane32_swap_b32 v86, v90
    v_permlane32_swap_b32 v87, v91
    v_add_f32 v84, v84, v88
    v_add_f32 v85, v85, v89
    v_add_f32 v86, v86, v90
    v_add_f32 v87, v87, v91
    s_nop 0
    v_permlane16_swap_b32 v84, v86
    v_permlane16_swap_b32 v85, v87
    v_add_f32 v84, v84, v86
    v_add_f32 v85, v85, v87
    s_nop 0
    v_add_f32_dpp v84, v84, v84 row_ror:8 row_mask:0xf bank_mask:0xf
    v_add_f32_dpp v85, v85, v85 row_ror:8 row_mask:0xf bank_mask:0xf
    v_and_b32 v16, 7, v1
    v_lshlrev_b32 v16, 5, v16
    v_lshrrev_b32 v17, 4, v1
    v_lshl_add_u32 v16, v17, 3, v16
    s_lshl_b32 s16, s3, 8
    s_add_u32 s16, s16, 70656
    v_add_u32 v16, s16, v16
    ds_write_b64 v16, v[84:85]
    s_lshr_b32 s16, s3, 2
    s_lshl_b32 s17, s16, 10
    s_add_u32 s17, s17, 70656
    v_lshlrev_b32 v17, 2, v1
    v_add_u32 v16, s17, v17
    s_and_b32 s17, s29, 3
    s_lshl_b32 s17, s17, 1
    s_add_u32 s17, s17, s16
    s_mul_i32 s17, s17, 14336
    s_lshr_b32 s16, s29, 2
    s_lshl_b32 s16, s16, 8
    s_add_u32 s17, s17, s16
    s_add_u32 s17, s17, 0x6e1000
    s_and_b32 s16, s3, 3
    s_cmp_eq_u32 s16, 0
    s_cselect_b32 s17, s17, 0x7ffffff0
    s_cmp_lt_u32 s2, 224
    s_cselect_b32 s17, s17, 0x7ffffff0
    s_waitcnt lgkmcnt(0)
    s_barrier
    ds_read_b32 v84, v16 offset:0
    ds_read_b32 v85, v16 offset:256
    ds_read_b32 v86, v16 offset:512
    ds_read_b32 v87, v16 offset:768
    s_waitcnt lgkmcnt(2)
    v_add_f32 v84, v84, v85
    s_waitcnt lgkmcnt(0)
    v_add_f32 v86, v86, v87
    v_add_f32 v84, v84, v86
    v_or_b32 v84, 1, v84
    buffer_store_dword v84, v17, s[8:11], s17 offen sc1
    v_lshrrev_b32 v16, 4, v1
    v_mul_u32_u24 v16, 28672, v16
    v_and_b32 v17, 15, v1
    v_lshl_add_u32 v16, v17, 2, v16
    s_lshl_b32 s16, s29, 6
    s_add_u32 s16, s16, 0x6e1000
    s_add_u32 s17, s16, 14336
    s_mov_b32 s27, 0
adaLN_cond__sliding_block_cached__moe_arch_mod__prompt_kernel_gu23p:
    buffer_load_dword v84, v16, s[8:11], s16 offen sc1
    buffer_load_dword v85, v16, s[8:11], s17 offen sc1
    s_waitcnt vmcnt(0)
    v_min_u32 v86, v84, v85
    v_cmp_eq_u32 vcc, 0, v86
    s_cmp_lt_u32 s2, 224
    s_cselect_b64 s[62:63], -1, 0
    s_and_b64 vcc, vcc, s[62:63]
    s_add_u32 s27, s27, 1
    s_cmp_ge_u32 s27, 65536
    s_cbranch_scc1 adaLN_cond__sliding_block_cached__moe_arch_mod__prompt_kernel_gu23g
    s_cbranch_vccnz adaLN_cond__sliding_block_cached__moe_arch_mod__prompt_kernel_gu23p
adaLN_cond__sliding_block_cached__moe_arch_mod__prompt_kernel_gu23g:
    v_mov_b32 v86, v84
    s_nop 1
    v_permlane16_swap_b32 v84, v86
    v_add_f32 v84, v84, v86
    v_mov_b32 v87, v85
    s_nop 1
    v_permlane16_swap_b32 v85, v87
    v_add_f32 v85, v85, v87
    v_mov_b32 v86, v84
    s_nop 1
    v_permlane32_swap_b32 v84, v86
    v_add_f32 v84, v84, v86
    v_mov_b32 v87, v85
    s_nop 1
    v_permlane32_swap_b32 v85, v87
    v_add_f32 v85, v85, v87
    v_cvt_pk_bf16_f32 v86, v84, v85
    v_lshlrev_b32 v84, 16, v86
    v_and_b32 v85, 0xffff0000, v86
    v_mul_f32 v86, 0xbfb8aa3b, v84
    v_exp_f32 v86, v86
    s_nop 0
    v_add_f32 v86, 1.0, v86
    v_rcp_f32 v86, v86
    s_nop 0
    v_mul_f32 v84, v84, v86
    v_cvt_pk_bf16_f32 v84, v84, v84
    v_lshlrev_b32 v84, 16, v84
    v_mul_f32 v84, v84, v85
    v_cvt_pk_bf16_f32 v84, v84, v84
    v_lshlrev_b32 v84, 16, v84
    s_sub_u32 s16, s3, 4
    s_lshl_b32 s16, s16, 2
    s_add_u32 s17, s16, 0
    v_readlane_b32 s20, v84, s17
    s_lshr_b32 s4, s20, 16
    s_add_u32 s17, s16, 1
    v_readlane_b32 s21, v84, s17
    s_lshr_b32 s5, s21, 16
    s_add_u32 s17, s16, 2
    v_readlane_b32 s22, v84, s17
    s_lshr_b32 s6, s22, 16
    s_add_u32 s17, s16, 3
    v_readlane_b32 s23, v84, s17
    s_lshr_b32 s7, s23, 16
    v_dot2_f32_bf16 v45, v152, s20, 0
    v_dot2_f32_bf16 v44, v152, s4, 0
    v_dot2_f32_bf16 v47, v153, s20, 0
    v_dot2_f32_bf16 v46, v153, s4, 0
    v_dot2_f32_bf16 v49, v154, s20, 0
    v_dot2_f32_bf16 v48, v154, s4, 0
    v_dot2_f32_bf16 v51, v155, s20, 0
    v_dot2_f32_bf16 v50, v155, s4, 0
    v_dot2_f32_bf16 v53, v156, s20, 0
    v_dot2_f32_bf16 v52, v156, s4, 0
    v_dot2_f32_bf16 v55, v157, s20, 0
    v_dot2_f32_bf16 v54, v157, s4, 0
    v_dot2_f32_bf16 v57, v158, s20, 0
    v_dot2_f32_bf16 v56, v158, s4, 0
    v_dot2_f32_bf16 v59, v159, s20, 0
    v_dot2_f32_bf16 v58, v159, s4, 0
    v_dot2c_f32_bf16 v45, s21, v160
    v_dot2c_f32_bf16 v44, s5, v160
    v_dot2c_f32_bf16 v47, s21, v161
    v_dot2c_f32_bf16 v46, s5, v161
    v_dot2c_f32_bf16 v49, s21, v162
    v_dot2c_f32_bf16 v48, s5, v162
    v_dot2c_f32_bf16 v51, s21, v163
    v_dot2c_f32_bf16 v50, s5, v163
    v_dot2c_f32_bf16 v53, s21, v164
    v_dot2c_f32_bf16 v52, s5, v164
    v_dot2c_f32_bf16 v55, s21, v165
    v_dot2c_f32_bf16 v54, s5, v165
    v_dot2c_f32_bf16 v57, s21, v166
    v_dot2c_f32_bf16 v56, s5, v166
    v_dot2c_f32_bf16 v59, s21, v167
    v_dot2c_f32_bf16 v58, s5, v167
    v_dot2c_f32_bf16 v45, s22, v168
    v_dot2c_f32_bf16 v44, s6, v168
    v_dot2c_f32_bf16 v47, s22, v169
    v_dot2c_f32_bf16 v46, s6, v169
    v_dot2c_f32_bf16 v49, s22, v170
    v_dot2c_f32_bf16 v48, s6, v170
    v_dot2c_f32_bf16 v51, s22, v171
    v_dot2c_f32_bf16 v50, s6, v171
    v_dot2c_f32_bf16 v53, s22, v172
    v_dot2c_f32_bf16 v52, s6, v172
    v_dot2c_f32_bf16 v55, s22, v173
    v_dot2c_f32_bf16 v54, s6, v173
    v_dot2c_f32_bf16 v57, s22, v174
    v_dot2c_f32_bf16 v56, s6, v174
    v_dot2c_f32_bf16 v59, s22, v175
    v_dot2c_f32_bf16 v58, s6, v175
    v_dot2c_f32_bf16 v45, s23, v176
    v_dot2c_f32_bf16 v44, s7, v176
    v_dot2c_f32_bf16 v47, s23, v177
    v_dot2c_f32_bf16 v46, s7, v177
    v_dot2c_f32_bf16 v49, s23, v178
    v_dot2c_f32_bf16 v48, s7, v178
    v_dot2c_f32_bf16 v51, s23, v179
    v_dot2c_f32_bf16 v50, s7, v179
    v_dot2c_f32_bf16 v53, s23, v180
    v_dot2c_f32_bf16 v52, s7, v180
    v_dot2c_f32_bf16 v55, s23, v181
    v_dot2c_f32_bf16 v54, s7, v181
    v_dot2c_f32_bf16 v57, s23, v182
    v_dot2c_f32_bf16 v56, s7, v182
    v_dot2c_f32_bf16 v59, s23, v183
    v_dot2c_f32_bf16 v58, s7, v183
    s_sub_u32 s16, s3, 4
    s_lshl_b32 s16, s16, 12
    s_add_u32 s16, s16, 73728
    v_lshlrev_b32 v16, 5, v1
    v_add_u32 v16, s16, v16
    ds_write_b128 v16, v[44:47] offset:0
    ds_write_b128 v16, v[48:51] offset:16
    ds_write_b128 v16, v[52:55] offset:2048
    ds_write_b128 v16, v[56:59] offset:2064
    s_waitcnt lgkmcnt(0)
    s_barrier
    v_lshlrev_b32 v16, 3, v0
    v_add_u32 v17, 73728, v16
    ds_read_b64 v[84:85], v17 offset:0
    ds_read_b64 v[86:87], v17 offset:4096
    ds_read_b64 v[88:89], v17 offset:8192
    ds_read_b64 v[90:91], v17 offset:12288
    s_waitcnt lgkmcnt(2)
    v_pk_add_f32 v[84:85], v[84:85], v[86:87]
    s_waitcnt lgkmcnt(0)
    v_pk_add_f32 v[88:89], v[88:89], v[90:91]
    v_pk_add_f32 v[84:85], v[84:85], v[88:89]
    v_or_b32 v84, 1, v84
    v_or_b32 v85, 1, v85
    s_lshl_b32 s16, s29, 12
    s_add_u32 s16, s16, 0x600000
    s_cmp_lt_u32 s2, 224
    s_cselect_b32 s16, s16, 0x7ffffff0
    buffer_store_dwordx2 v[84:85], v16, s[8:11], s16 offen sc1
    s_cmp_lt_u32 s2, 224
    s_cbranch_scc1 adaLN_cond__sliding_block_cached__moe_arch_mod__prompt_kernel_end
    s_sub_u32 s16, s2, 224
    s_lshl_b32 s17, s16, 7
    s_add_u32 s17, s17, 0x600000
    v_lshrrev_b32 v16, 3, v0
    v_lshlrev_b32 v16, 12, v16
    v_and_b32 v17, 7, v0
    v_lshl_add_u32 v16, v17, 4, v16
    v_cmp_gt_u32 vcc, 256, v0
    v_bfrev_b32 v17, -2
    s_nop 0
    v_cndmask_b32 v17, v17, v16, vcc
    v_mov_b32 v19, 0
    v_cndmask_b32 v18, 1, v19, vcc
    s_lshl_b32 s18, s16, 6
    v_and_b32 v19, 31, v1
    v_lshlrev_b32 v19, 1, v19
    v_add_u32 v19, s18, v19
    s_mov_b32 s19, 0x541800
    buffer_load_ushort v95, v19, s[8:11], s19 offen sc1
    v_add_u32 v20, 66560, v19
    ds_read_u16 v96, v20
    ds_read_u16 v97, v20 offset:2048
    v_mov_b32 v94, v27
    v_cvt_pk_bf16_f32 v94, v94, v94
    v_lshlrev_b32 v94, 16, v94
    v_mul_f32 v94, 0xbfb8aa3b, v94
    v_exp_f32 v94, v94
    s_nop 0
    v_add_f32 v94, 1.0, v94
    v_rcp_f32 v94, v94
    s_nop 0
    v_cvt_pk_bf16_f32 v94, v94, v94
    v_lshlrev_b32 v94, 16, v94
    s_waitcnt vmcnt(0)
    v_lshlrev_b32 v95, 16, v95
    s_waitcnt lgkmcnt(1)
    v_lshlrev_b32 v96, 16, v96
    s_waitcnt lgkmcnt(0)
    v_lshlrev_b32 v97, 16, v97
    s_mov_b32 s27, 0
adaLN_cond__sliding_block_cached__moe_arch_mod__prompt_kernel_y24p:
    s_add_u32 s19, s17, 0x0
    buffer_load_dwordx4 v[44:47], v16, s[8:11], s19 offen sc1
    s_add_u32 s19, s17, 0x40000
    buffer_load_dwordx4 v[48:51], v16, s[8:11], s19 offen sc1
    s_add_u32 s19, s17, 0x80000
    buffer_load_dwordx4 v[52:55], v16, s[8:11], s19 offen sc1
    s_add_u32 s19, s17, 0xc0000
    buffer_load_dwordx4 v[56:59], v17, s[8:11], s19 offen sc1
    s_waitcnt vmcnt(0)
    v_min3_u32 v98, v56, v57, v58
    v_min_u32 v98, v98, v59
    v_or_b32 v98, v98, v18
    v_min3_u32 v98, v98, v44, v45
    v_min3_u32 v98, v98, v46, v47
    v_min3_u32 v98, v98, v48, v49
    v_min3_u32 v98, v98, v50, v51
    v_min3_u32 v98, v98, v52, v53
    v_min3_u32 v98, v98, v54, v55
    v_cmp_eq_u32 vcc, 0, v98
    s_add_u32 s27, s27, 1
    s_cmp_ge_u32 s27, 65536
    s_cbranch_scc1 adaLN_cond__sliding_block_cached__moe_arch_mod__prompt_kernel_y24g
    s_cbranch_vccnz adaLN_cond__sliding_block_cached__moe_arch_mod__prompt_kernel_y24p
adaLN_cond__sliding_block_cached__moe_arch_mod__prompt_kernel_y24g:
    v_pk_add_f32 v[44:45], v[44:45], v[52:53]
    v_pk_add_f32 v[46:47], v[46:47], v[54:55]
    v_pk_add_f32 v[48:49], v[48:49], v[56:57]
    v_pk_add_f32 v[50:51], v[50:51], v[58:59]
    v_pk_add_f32 v[44:45], v[44:45], v[48:49]
    v_pk_add_f32 v[46:47], v[46:47], v[50:51]
    s_nop 0
    v_add_f32_dpp v44, v44, v44 row_ror:8 row_mask:0xf bank_mask:0xf
    v_add_f32_dpp v45, v45, v45 row_ror:8 row_mask:0xf bank_mask:0xf
    v_add_f32_dpp v46, v46, v46 row_ror:8 row_mask:0xf bank_mask:0xf
    v_add_f32_dpp v47, v47, v47 row_ror:8 row_mask:0xf bank_mask:0xf
    s_nop 0
    v_permlane32_swap_b32 v44, v46
    v_permlane32_swap_b32 v45, v47
    v_add_f32 v44, v44, v46
    v_add_f32 v45, v45, v47
    s_nop 1
    v_permlane16_swap_b32 v44, v45
    v_add_f32 v44, v44, v45
    v_and_b32 v16, 7, v1
    v_lshlrev_b32 v16, 4, v16
    v_lshrrev_b32 v17, 4, v1
    v_lshl_add_u32 v16, v17, 2, v16
    s_lshl_b32 s19, s3, 7
    s_add_u32 s19, s19, 91136
    v_add_u32 v16, s19, v16
    ds_write_b32 v16, v44
    v_and_b32 v16, 31, v1
    v_lshlrev_b32 v16, 2, v16
    v_add_u32 v16, 91136, v16
    s_waitcnt lgkmcnt(0)
    s_barrier
    s_cmp_lg_u32 s3, 0
    s_cbranch_scc1 adaLN_cond__sliding_block_cached__moe_arch_mod__prompt_kernel_end
    ds_read_b32 v44, v16 offset:0
    ds_read_b32 v45, v16 offset:128
    ds_read_b32 v46, v16 offset:256
    ds_read_b32 v47, v16 offset:384
    ds_read_b32 v48, v16 offset:512
    ds_read_b32 v49, v16 offset:640
    ds_read_b32 v50, v16 offset:768
    ds_read_b32 v51, v16 offset:896
    s_waitcnt lgkmcnt(3)
    v_add_f32 v44, v44, v48
    s_waitcnt lgkmcnt(2)
    v_add_f32 v45, v45, v49
    s_waitcnt lgkmcnt(1)
    v_add_f32 v46, v46, v50
    s_waitcnt lgkmcnt(0)
    v_add_f32 v47, v47, v51
    v_add_f32 v44, v44, v46
    v_add_f32 v45, v45, v47
    v_add_f32 v44, v44, v45
    v_cvt_pk_bf16_f32 v44, v44, v44
    v_lshlrev_b32 v44, 16, v44
    v_mul_f32 v44, v44, v94
    v_cvt_pk_bf16_f32 v44, v44, v44
    v_lshlrev_b32 v44, 16, v44
    v_add_f32 v44, v44, v96
    v_cvt_pk_bf16_f32 v44, v44, v44
    v_lshlrev_b32 v44, 16, v44
    v_mul_f32 v44, v44, v95
    v_cvt_pk_bf16_f32 v44, v44, v44
    v_lshlrev_b32 v44, 16, v44
    v_add_f32 v44, v44, v97
    v_cvt_pk_bf16_f32 v44, v44, v44
    s_mov_b64 exec, 0xffffffff
    buffer_store_short v44, v19, s[68:71], s13 offen sc1
adaLN_cond__sliding_block_cached__moe_arch_mod__prompt_kernel_end:
    s_endpgm
adaLN_cond__sliding_block_cached__moe_arch_mod__prompt_kernel_n1r:
    s_mov_b32 s27, 0
adaLN_cond__sliding_block_cached__moe_arch_mod__prompt_kernel_n1p:
    buffer_load_dword v134, v132, s[64:67], 0 offen sc1
    s_waitcnt vmcnt(0)
    v_cmp_eq_u32 vcc, 0, v134
    s_cmp_eq_u32 s3, 0
    s_cselect_b64 s[62:63], -1, 0
    s_and_b64 vcc, vcc, s[62:63]
    s_add_u32 s27, s27, 1
    s_cmp_ge_u32 s27, 65536
    s_cbranch_scc1 adaLN_cond__sliding_block_cached__moe_arch_mod__prompt_kernel_n1g
    s_cbranch_vccnz adaLN_cond__sliding_block_cached__moe_arch_mod__prompt_kernel_n1p
adaLN_cond__sliding_block_cached__moe_arch_mod__prompt_kernel_n1g:
    s_waitcnt vmcnt(0) lgkmcnt(0)
    s_nop 15
    s_nop 3
    s_branch adaLN_cond__sliding_block_cached__moe_arch_mod__prompt_kernel_n1b
adaLN_cond__sliding_block_cached__moe_arch_mod__prompt_kernel_kv4r:
    s_waitcnt vmcnt(0) lgkmcnt(0)
    s_nop 15
    s_nop 3
    s_mov_b32 s27, 0
adaLN_cond__sliding_block_cached__moe_arch_mod__prompt_kernel_kv4p:
    buffer_load_dwordx4 v[12:15], v21, s[8:11], s18 offen sc1
    s_waitcnt vmcnt(0)
    v_xor_b32 v8, s28, v12
    v_xor_b32 v20, s28, v13
    v_or_b32 v8, v8, v20
    v_xor_b32 v20, s28, v14
    v_or_b32 v8, v8, v20
    v_xor_b32 v20, s28, v15
    v_or_b32 v8, v8, v20
    v_cmp_ne_u32 vcc, 0, v8
    s_add_u32 s27, s27, 1
    s_cmp_ge_u32 s27, 65536
    s_cbranch_scc1 adaLN_cond__sliding_block_cached__moe_arch_mod__prompt_kernel_kv4g
    s_cbranch_vccnz adaLN_cond__sliding_block_cached__moe_arch_mod__prompt_kernel_kv4p
adaLN_cond__sliding_block_cached__moe_arch_mod__prompt_kernel_kv4g:
    s_waitcnt vmcnt(0) lgkmcnt(0)
    s_nop 15
    s_nop 3
    s_branch adaLN_cond__sliding_block_cached__moe_arch_mod__prompt_kernel_kv4b
adaLN_cond__sliding_block_cached__moe_arch_mod__prompt_kernel_fixA:
    s_waitcnt vmcnt(0) lgkmcnt(0)
    s_nop 15
    s_nop 3
    s_lshr_b32 s16, s12, 3
    s_lshl_b32 s16, s16, 17
    s_add_u32 s16, s16, 0x400000
    v_add_u32 v8, s16, v2
    v_mov_b32 v16, 0xff7fffff
    v_mov_b32 v17, 0xff7fffff
    s_mov_b32 s16, 0
adaLN_cond__sliding_block_cached__moe_arch_mod__prompt_kernel_fixAm:
    s_add_u32 s17, s16, 0
    buffer_load_dwordx4 v[200:203], v8, s[8:11], s17 offen offset:0
    buffer_load_dwordx4 v[204:207], v8, s[8:11], s17 offen offset:1024
    buffer_load_dwordx4 v[208:211], v8, s[8:11], s17 offen offset:2048
    buffer_load_dwordx4 v[212:215], v8, s[8:11], s17 offen offset:3072
    s_waitcnt vmcnt(3)
    v_mfma_f32_16x16x32_bf16 v[184:187], v[200:203], v[152:155], 0
    v_mfma_f32_16x16x32_bf16 v[188:191], v[200:203], v[168:171], 0
    s_waitcnt vmcnt(2)
    v_mfma_f32_16x16x32_bf16 v[192:195], v[204:207], v[152:155], 0
    v_mfma_f32_16x16x32_bf16 v[196:199], v[204:207], v[168:171], 0
    s_waitcnt vmcnt(1)
    v_mfma_f32_16x16x32_bf16 v[184:187], v[208:211], v[156:159], v[184:187]
    v_mfma_f32_16x16x32_bf16 v[188:191], v[208:211], v[172:175], v[188:191]
    s_waitcnt vmcnt(0)
    v_mfma_f32_16x16x32_bf16 v[192:195], v[212:215], v[156:159], v[192:195]
    v_mfma_f32_16x16x32_bf16 v[196:199], v[212:215], v[172:175], v[196:199]
    s_add_u32 s17, s16, 4096
    buffer_load_dwordx4 v[200:203], v8, s[8:11], s17 offen offset:0
    buffer_load_dwordx4 v[204:207], v8, s[8:11], s17 offen offset:1024
    buffer_load_dwordx4 v[208:211], v8, s[8:11], s17 offen offset:2048
    buffer_load_dwordx4 v[212:215], v8, s[8:11], s17 offen offset:3072
    s_waitcnt vmcnt(3)
    v_mfma_f32_16x16x32_bf16 v[184:187], v[200:203], v[160:163], v[184:187]
    v_mfma_f32_16x16x32_bf16 v[188:191], v[200:203], v[176:179], v[188:191]
    s_waitcnt vmcnt(2)
    v_mfma_f32_16x16x32_bf16 v[192:195], v[204:207], v[160:163], v[192:195]
    v_mfma_f32_16x16x32_bf16 v[196:199], v[204:207], v[176:179], v[196:199]
    s_waitcnt vmcnt(1)
    v_mfma_f32_16x16x32_bf16 v[184:187], v[208:211], v[164:167], v[184:187]
    v_mfma_f32_16x16x32_bf16 v[188:191], v[208:211], v[180:183], v[188:191]
    s_waitcnt vmcnt(0)
    v_mfma_f32_16x16x32_bf16 v[192:195], v[212:215], v[164:167], v[192:195]
    v_mfma_f32_16x16x32_bf16 v[196:199], v[212:215], v[180:183], v[196:199]
    s_nop 3
    v_max3_f32 v16, v16, v184, v185
    v_max3_f32 v16, v16, v186, v187
    v_max3_f32 v17, v17, v188, v189
    v_max3_f32 v17, v17, v190, v191
    v_max3_f32 v16, v16, v192, v193
    v_max3_f32 v16, v16, v194, v195
    v_max3_f32 v17, v17, v196, v197
    v_max3_f32 v17, v17, v198, v199
    s_add_u32 s16, s16, 8192
    s_cmp_lt_u32 s16, 0x20000
    s_cbranch_scc1 adaLN_cond__sliding_block_cached__moe_arch_mod__prompt_kernel_fixAm
    v_mov_b32 v18, v16
    v_mov_b32 v19, v17
    s_nop 0
    v_permlane16_swap_b32 v16, v18
    v_permlane16_swap_b32 v17, v19
    v_max_f32 v16, v16, v18
    v_max_f32 v17, v17, v19
    v_mov_b32 v18, v16
    v_mov_b32 v19, v17
    s_nop 0
    v_permlane32_swap_b32 v16, v18
    v_permlane32_swap_b32 v17, v19
    v_max_f32 v16, v16, v18
    v_max_f32 v17, v17, v19
    v_sub_f32 v216, 0, v16
    v_sub_f32 v217, 0, v16
    v_sub_f32 v218, 0, v16
    v_sub_f32 v219, 0, v16
    v_sub_f32 v220, 0, v17
    v_sub_f32 v221, 0, v17
    v_sub_f32 v222, 0, v17
    v_sub_f32 v223, 0, v17
    s_mov_b32 s17, 0x0
    buffer_load_dwordx4 v[200:203], v8, s[8:11], s17 offen offset:0
    buffer_load_dwordx4 v[204:207], v8, s[8:11], s17 offen offset:1024
    buffer_load_dwordx4 v[208:211], v8, s[8:11], s17 offen offset:2048
    buffer_load_dwordx4 v[212:215], v8, s[8:11], s17 offen offset:3072
    s_waitcnt vmcnt(3)
    v_mfma_f32_16x16x32_bf16 v[184:187], v[200:203], v[152:155], v[216:219]
    v_mfma_f32_16x16x32_bf16 v[188:191], v[200:203], v[168:171], v[220:223]
    s_waitcnt vmcnt(2)
    v_mfma_f32_16x16x32_bf16 v[192:195], v[204:207], v[152:155], v[216:219]
    v_mfma_f32_16x16x32_bf16 v[196:199], v[204:207], v[168:171], v[220:223]
    s_waitcnt vmcnt(1)
    v_mfma_f32_16x16x32_bf16 v[184:187], v[208:211], v[156:159], v[184:187]
    v_mfma_f32_16x16x32_bf16 v[188:191], v[208:211], v[172:175], v[188:191]
    s_waitcnt vmcnt(0)
    v_mfma_f32_16x16x32_bf16 v[192:195], v[212:215], v[156:159], v[192:195]
    v_mfma_f32_16x16x32_bf16 v[196:199], v[212:215], v[172:175], v[196:199]
    s_mov_b32 s17, 0x1000
    buffer_load_dwordx4 v[200:203], v8, s[8:11], s17 offen offset:0
    buffer_load_dwordx4 v[204:207], v8, s[8:11], s17 offen offset:1024
    buffer_load_dwordx4 v[208:211], v8, s[8:11], s17 offen offset:2048
    buffer_load_dwordx4 v[212:215], v8, s[8:11], s17 offen offset:3072
    s_waitcnt vmcnt(3)
    v_mfma_f32_16x16x32_bf16 v[184:187], v[200:203], v[160:163], v[184:187]
    v_mfma_f32_16x16x32_bf16 v[188:191], v[200:203], v[176:179], v[188:191]
    s_waitcnt vmcnt(2)
    v_mfma_f32_16x16x32_bf16 v[192:195], v[204:207], v[160:163], v[192:195]
    v_mfma_f32_16x16x32_bf16 v[196:199], v[204:207], v[176:179], v[196:199]
    s_waitcnt vmcnt(1)
    v_mfma_f32_16x16x32_bf16 v[184:187], v[208:211], v[164:167], v[184:187]
    v_mfma_f32_16x16x32_bf16 v[188:191], v[208:211], v[180:183], v[188:191]
    s_waitcnt vmcnt(0)
    v_mfma_f32_16x16x32_bf16 v[192:195], v[212:215], v[164:167], v[192:195]
    v_mfma_f32_16x16x32_bf16 v[196:199], v[212:215], v[180:183], v[196:199]
    s_nop 3
    v_exp_f32 v184, v184
    v_exp_f32 v185, v185
    s_nop 0
    v_add_f32 v9, v184, v185
    v_cvt_pk_bf16_f32 v24, v184, v185
    v_exp_f32 v186, v186
    v_exp_f32 v187, v187
    v_add_f32 v9, v9, v186
    v_add_f32 v9, v9, v187
    v_cvt_pk_bf16_f32 v25, v186, v187
    v_exp_f32 v188, v188
    v_exp_f32 v189, v189
    s_nop 0
    v_add_f32 v10, v188, v189
    v_cvt_pk_bf16_f32 v28, v188, v189
    v_exp_f32 v190, v190
    v_exp_f32 v191, v191
    v_add_f32 v10, v10, v190
    v_add_f32 v10, v10, v191
    v_cvt_pk_bf16_f32 v29, v190, v191
    v_exp_f32 v192, v192
    v_exp_f32 v193, v193
    v_add_f32 v9, v9, v192
    v_add_f32 v9, v9, v193
    v_cvt_pk_bf16_f32 v26, v192, v193
    v_exp_f32 v194, v194
    v_exp_f32 v195, v195
    v_add_f32 v9, v9, v194
    v_add_f32 v9, v9, v195
    v_cvt_pk_bf16_f32 v27, v194, v195
    v_exp_f32 v196, v196
    v_exp_f32 v197, v197
    v_add_f32 v10, v10, v196
    v_add_f32 v10, v10, v197
    v_cvt_pk_bf16_f32 v30, v196, v197
    v_exp_f32 v198, v198
    v_exp_f32 v199, v199
    v_add_f32 v10, v10, v198
    v_add_f32 v10, v10, v199
    v_cvt_pk_bf16_f32 v31, v198, v199
    s_mov_b32 s17, 0x2000
    buffer_load_dwordx4 v[200:203], v8, s[8:11], s17 offen offset:0
    buffer_load_dwordx4 v[204:207], v8, s[8:11], s17 offen offset:1024
    buffer_load_dwordx4 v[208:211], v8, s[8:11], s17 offen offset:2048
    buffer_load_dwordx4 v[212:215], v8, s[8:11], s17 offen offset:3072
    s_waitcnt vmcnt(3)
    v_mfma_f32_16x16x32_bf16 v[184:187], v[200:203], v[152:155], v[216:219]
    v_mfma_f32_16x16x32_bf16 v[188:191], v[200:203], v[168:171], v[220:223]
    s_waitcnt vmcnt(2)
    v_mfma_f32_16x16x32_bf16 v[192:195], v[204:207], v[152:155], v[216:219]
    v_mfma_f32_16x16x32_bf16 v[196:199], v[204:207], v[168:171], v[220:223]
    s_waitcnt vmcnt(1)
    v_mfma_f32_16x16x32_bf16 v[184:187], v[208:211], v[156:159], v[184:187]
    v_mfma_f32_16x16x32_bf16 v[188:191], v[208:211], v[172:175], v[188:191]
    s_waitcnt vmcnt(0)
    v_mfma_f32_16x16x32_bf16 v[192:195], v[212:215], v[156:159], v[192:195]
    v_mfma_f32_16x16x32_bf16 v[196:199], v[212:215], v[172:175], v[196:199]
    s_mov_b32 s17, 0x3000
    buffer_load_dwordx4 v[200:203], v8, s[8:11], s17 offen offset:0
    buffer_load_dwordx4 v[204:207], v8, s[8:11], s17 offen offset:1024
    buffer_load_dwordx4 v[208:211], v8, s[8:11], s17 offen offset:2048
    buffer_load_dwordx4 v[212:215], v8, s[8:11], s17 offen offset:3072
    s_waitcnt vmcnt(3)
    v_mfma_f32_16x16x32_bf16 v[184:187], v[200:203], v[160:163], v[184:187]
    v_mfma_f32_16x16x32_bf16 v[188:191], v[200:203], v[176:179], v[188:191]
    s_waitcnt vmcnt(2)
    v_mfma_f32_16x16x32_bf16 v[192:195], v[204:207], v[160:163], v[192:195]
    v_mfma_f32_16x16x32_bf16 v[196:199], v[204:207], v[176:179], v[196:199]
    s_waitcnt vmcnt(1)
    v_mfma_f32_16x16x32_bf16 v[184:187], v[208:211], v[164:167], v[184:187]
    v_mfma_f32_16x16x32_bf16 v[188:191], v[208:211], v[180:183], v[188:191]
    s_waitcnt vmcnt(0)
    v_mfma_f32_16x16x32_bf16 v[192:195], v[212:215], v[164:167], v[192:195]
    v_mfma_f32_16x16x32_bf16 v[196:199], v[212:215], v[180:183], v[196:199]
    s_nop 3
    v_exp_f32 v184, v184
    v_exp_f32 v185, v185
    v_add_f32 v9, v9, v184
    v_add_f32 v9, v9, v185
    v_cvt_pk_bf16_f32 v32, v184, v185
    v_exp_f32 v186, v186
    v_exp_f32 v187, v187
    v_add_f32 v9, v9, v186
    v_add_f32 v9, v9, v187
    v_cvt_pk_bf16_f32 v33, v186, v187
    v_exp_f32 v188, v188
    v_exp_f32 v189, v189
    v_add_f32 v10, v10, v188
    v_add_f32 v10, v10, v189
    v_cvt_pk_bf16_f32 v36, v188, v189
    v_exp_f32 v190, v190
    v_exp_f32 v191, v191
    v_add_f32 v10, v10, v190
    v_add_f32 v10, v10, v191
    v_cvt_pk_bf16_f32 v37, v190, v191
    v_exp_f32 v192, v192
    v_exp_f32 v193, v193
    v_add_f32 v9, v9, v192
    v_add_f32 v9, v9, v193
    v_cvt_pk_bf16_f32 v34, v192, v193
    v_exp_f32 v194, v194
    v_exp_f32 v195, v195
    v_add_f32 v9, v9, v194
    v_add_f32 v9, v9, v195
    v_cvt_pk_bf16_f32 v35, v194, v195
    v_exp_f32 v196, v196
    v_exp_f32 v197, v197
    v_add_f32 v10, v10, v196
    v_add_f32 v10, v10, v197
    v_cvt_pk_bf16_f32 v38, v196, v197
    v_exp_f32 v198, v198
    v_exp_f32 v199, v199
    v_add_f32 v10, v10, v198
    v_add_f32 v10, v10, v199
    v_cvt_pk_bf16_f32 v39, v198, v199
    s_mov_b32 s17, 0x4000
    buffer_load_dwordx4 v[200:203], v8, s[8:11], s17 offen offset:0
    buffer_load_dwordx4 v[204:207], v8, s[8:11], s17 offen offset:1024
    buffer_load_dwordx4 v[208:211], v8, s[8:11], s17 offen offset:2048
    buffer_load_dwordx4 v[212:215], v8, s[8:11], s17 offen offset:3072
    s_waitcnt vmcnt(3)
    v_mfma_f32_16x16x32_bf16 v[184:187], v[200:203], v[152:155], v[216:219]
    v_mfma_f32_16x16x32_bf16 v[188:191], v[200:203], v[168:171], v[220:223]
    s_waitcnt vmcnt(2)
    v_mfma_f32_16x16x32_bf16 v[192:195], v[204:207], v[152:155], v[216:219]
    v_mfma_f32_16x16x32_bf16 v[196:199], v[204:207], v[168:171], v[220:223]
    s_waitcnt vmcnt(1)
    v_mfma_f32_16x16x32_bf16 v[184:187], v[208:211], v[156:159], v[184:187]
    v_mfma_f32_16x16x32_bf16 v[188:191], v[208:211], v[172:175], v[188:191]
    s_waitcnt vmcnt(0)
    v_mfma_f32_16x16x32_bf16 v[192:195], v[212:215], v[156:159], v[192:195]
    v_mfma_f32_16x16x32_bf16 v[196:199], v[212:215], v[172:175], v[196:199]
    s_mov_b32 s17, 0x5000
    buffer_load_dwordx4 v[200:203], v8, s[8:11], s17 offen offset:0
    buffer_load_dwordx4 v[204:207], v8, s[8:11], s17 offen offset:1024
    buffer_load_dwordx4 v[208:211], v8, s[8:11], s17 offen offset:2048
    buffer_load_dwordx4 v[212:215], v8, s[8:11], s17 offen offset:3072
    s_waitcnt vmcnt(3)
    v_mfma_f32_16x16x32_bf16 v[184:187], v[200:203], v[160:163], v[184:187]
    v_mfma_f32_16x16x32_bf16 v[188:191], v[200:203], v[176:179], v[188:191]
    s_waitcnt vmcnt(2)
    v_mfma_f32_16x16x32_bf16 v[192:195], v[204:207], v[160:163], v[192:195]
    v_mfma_f32_16x16x32_bf16 v[196:199], v[204:207], v[176:179], v[196:199]
    s_waitcnt vmcnt(1)
    v_mfma_f32_16x16x32_bf16 v[184:187], v[208:211], v[164:167], v[184:187]
    v_mfma_f32_16x16x32_bf16 v[188:191], v[208:211], v[180:183], v[188:191]
    s_waitcnt vmcnt(0)
    v_mfma_f32_16x16x32_bf16 v[192:195], v[212:215], v[164:167], v[192:195]
    v_mfma_f32_16x16x32_bf16 v[196:199], v[212:215], v[180:183], v[196:199]
    s_nop 3
    v_exp_f32 v184, v184
    v_exp_f32 v185, v185
    v_add_f32 v9, v9, v184
    v_add_f32 v9, v9, v185
    v_cvt_pk_bf16_f32 v40, v184, v185
    v_exp_f32 v186, v186
    v_exp_f32 v187, v187
    v_add_f32 v9, v9, v186
    v_add_f32 v9, v9, v187
    v_cvt_pk_bf16_f32 v41, v186, v187
    v_exp_f32 v188, v188
    v_exp_f32 v189, v189
    v_add_f32 v10, v10, v188
    v_add_f32 v10, v10, v189
    v_cvt_pk_bf16_f32 v44, v188, v189
    v_exp_f32 v190, v190
    v_exp_f32 v191, v191
    v_add_f32 v10, v10, v190
    v_add_f32 v10, v10, v191
    v_cvt_pk_bf16_f32 v45, v190, v191
    v_exp_f32 v192, v192
    v_exp_f32 v193, v193
    v_add_f32 v9, v9, v192
    v_add_f32 v9, v9, v193
    v_cvt_pk_bf16_f32 v42, v192, v193
    v_exp_f32 v194, v194
    v_exp_f32 v195, v195
    v_add_f32 v9, v9, v194
    v_add_f32 v9, v9, v195
    v_cvt_pk_bf16_f32 v43, v194, v195
    v_exp_f32 v196, v196
    v_exp_f32 v197, v197
    v_add_f32 v10, v10, v196
    v_add_f32 v10, v10, v197
    v_cvt_pk_bf16_f32 v46, v196, v197
    v_exp_f32 v198, v198
    v_exp_f32 v199, v199
    v_add_f32 v10, v10, v198
    v_add_f32 v10, v10, v199
    v_cvt_pk_bf16_f32 v47, v198, v199
    s_mov_b32 s17, 0x6000
    buffer_load_dwordx4 v[200:203], v8, s[8:11], s17 offen offset:0
    buffer_load_dwordx4 v[204:207], v8, s[8:11], s17 offen offset:1024
    buffer_load_dwordx4 v[208:211], v8, s[8:11], s17 offen offset:2048
    buffer_load_dwordx4 v[212:215], v8, s[8:11], s17 offen offset:3072
    s_waitcnt vmcnt(3)
    v_mfma_f32_16x16x32_bf16 v[184:187], v[200:203], v[152:155], v[216:219]
    v_mfma_f32_16x16x32_bf16 v[188:191], v[200:203], v[168:171], v[220:223]
    s_waitcnt vmcnt(2)
    v_mfma_f32_16x16x32_bf16 v[192:195], v[204:207], v[152:155], v[216:219]
    v_mfma_f32_16x16x32_bf16 v[196:199], v[204:207], v[168:171], v[220:223]
    s_waitcnt vmcnt(1)
    v_mfma_f32_16x16x32_bf16 v[184:187], v[208:211], v[156:159], v[184:187]
    v_mfma_f32_16x16x32_bf16 v[188:191], v[208:211], v[172:175], v[188:191]
    s_waitcnt vmcnt(0)
    v_mfma_f32_16x16x32_bf16 v[192:195], v[212:215], v[156:159], v[192:195]
    v_mfma_f32_16x16x32_bf16 v[196:199], v[212:215], v[172:175], v[196:199]
    s_mov_b32 s17, 0x7000
    buffer_load_dwordx4 v[200:203], v8, s[8:11], s17 offen offset:0
    buffer_load_dwordx4 v[204:207], v8, s[8:11], s17 offen offset:1024
    buffer_load_dwordx4 v[208:211], v8, s[8:11], s17 offen offset:2048
    buffer_load_dwordx4 v[212:215], v8, s[8:11], s17 offen offset:3072
    s_waitcnt vmcnt(3)
    v_mfma_f32_16x16x32_bf16 v[184:187], v[200:203], v[160:163], v[184:187]
    v_mfma_f32_16x16x32_bf16 v[188:191], v[200:203], v[176:179], v[188:191]
    s_waitcnt vmcnt(2)
    v_mfma_f32_16x16x32_bf16 v[192:195], v[204:207], v[160:163], v[192:195]
    v_mfma_f32_16x16x32_bf16 v[196:199], v[204:207], v[176:179], v[196:199]
    s_waitcnt vmcnt(1)
    v_mfma_f32_16x16x32_bf16 v[184:187], v[208:211], v[164:167], v[184:187]
    v_mfma_f32_16x16x32_bf16 v[188:191], v[208:211], v[180:183], v[188:191]
    s_waitcnt vmcnt(0)
    v_mfma_f32_16x16x32_bf16 v[192:195], v[212:215], v[164:167], v[192:195]
    v_mfma_f32_16x16x32_bf16 v[196:199], v[212:215], v[180:183], v[196:199]
    s_nop 3
    v_exp_f32 v184, v184
    v_exp_f32 v185, v185
    v_add_f32 v9, v9, v184
    v_add_f32 v9, v9, v185
    v_cvt_pk_bf16_f32 v48, v184, v185
    v_exp_f32 v186, v186
    v_exp_f32 v187, v187
    v_add_f32 v9, v9, v186
    v_add_f32 v9, v9, v187
    v_cvt_pk_bf16_f32 v49, v186, v187
    v_exp_f32 v188, v188
    v_exp_f32 v189, v189
    v_add_f32 v10, v10, v188
    v_add_f32 v10, v10, v189
    v_cvt_pk_bf16_f32 v52, v188, v189
    v_exp_f32 v190, v190
    v_exp_f32 v191, v191
    v_add_f32 v10, v10, v190
    v_add_f32 v10, v10, v191
    v_cvt_pk_bf16_f32 v53, v190, v191
    v_exp_f32 v192, v192
    v_exp_f32 v193, v193
    v_add_f32 v9, v9, v192
    v_add_f32 v9, v9, v193
    v_cvt_pk_bf16_f32 v50, v192, v193
    v_exp_f32 v194, v194
    v_exp_f32 v195, v195
    v_add_f32 v9, v9, v194
    v_add_f32 v9, v9, v195
    v_cvt_pk_bf16_f32 v51, v194, v195
    v_exp_f32 v196, v196
    v_exp_f32 v197, v197
    v_add_f32 v10, v10, v196
    v_add_f32 v10, v10, v197
    v_cvt_pk_bf16_f32 v54, v196, v197
    v_exp_f32 v198, v198
    v_exp_f32 v199, v199
    v_add_f32 v10, v10, v198
    v_add_f32 v10, v10, v199
    v_cvt_pk_bf16_f32 v55, v198, v199
    s_mov_b32 s17, 0x8000
    buffer_load_dwordx4 v[200:203], v8, s[8:11], s17 offen offset:0
    buffer_load_dwordx4 v[204:207], v8, s[8:11], s17 offen offset:1024
    buffer_load_dwordx4 v[208:211], v8, s[8:11], s17 offen offset:2048
    buffer_load_dwordx4 v[212:215], v8, s[8:11], s17 offen offset:3072
    s_waitcnt vmcnt(3)
    v_mfma_f32_16x16x32_bf16 v[184:187], v[200:203], v[152:155], v[216:219]
    v_mfma_f32_16x16x32_bf16 v[188:191], v[200:203], v[168:171], v[220:223]
    s_waitcnt vmcnt(2)
    v_mfma_f32_16x16x32_bf16 v[192:195], v[204:207], v[152:155], v[216:219]
    v_mfma_f32_16x16x32_bf16 v[196:199], v[204:207], v[168:171], v[220:223]
    s_waitcnt vmcnt(1)
    v_mfma_f32_16x16x32_bf16 v[184:187], v[208:211], v[156:159], v[184:187]
    v_mfma_f32_16x16x32_bf16 v[188:191], v[208:211], v[172:175], v[188:191]
    s_waitcnt vmcnt(0)
    v_mfma_f32_16x16x32_bf16 v[192:195], v[212:215], v[156:159], v[192:195]
    v_mfma_f32_16x16x32_bf16 v[196:199], v[212:215], v[172:175], v[196:199]
    s_mov_b32 s17, 0x9000
    buffer_load_dwordx4 v[200:203], v8, s[8:11], s17 offen offset:0
    buffer_load_dwordx4 v[204:207], v8, s[8:11], s17 offen offset:1024
    buffer_load_dwordx4 v[208:211], v8, s[8:11], s17 offen offset:2048
    buffer_load_dwordx4 v[212:215], v8, s[8:11], s17 offen offset:3072
    s_waitcnt vmcnt(3)
    v_mfma_f32_16x16x32_bf16 v[184:187], v[200:203], v[160:163], v[184:187]
    v_mfma_f32_16x16x32_bf16 v[188:191], v[200:203], v[176:179], v[188:191]
    s_waitcnt vmcnt(2)
    v_mfma_f32_16x16x32_bf16 v[192:195], v[204:207], v[160:163], v[192:195]
    v_mfma_f32_16x16x32_bf16 v[196:199], v[204:207], v[176:179], v[196:199]
    s_waitcnt vmcnt(1)
    v_mfma_f32_16x16x32_bf16 v[184:187], v[208:211], v[164:167], v[184:187]
    v_mfma_f32_16x16x32_bf16 v[188:191], v[208:211], v[180:183], v[188:191]
    s_waitcnt vmcnt(0)
    v_mfma_f32_16x16x32_bf16 v[192:195], v[212:215], v[164:167], v[192:195]
    v_mfma_f32_16x16x32_bf16 v[196:199], v[212:215], v[180:183], v[196:199]
    s_nop 3
    v_exp_f32 v184, v184
    v_exp_f32 v185, v185
    v_add_f32 v9, v9, v184
    v_add_f32 v9, v9, v185
    v_cvt_pk_bf16_f32 v56, v184, v185
    v_exp_f32 v186, v186
    v_exp_f32 v187, v187
    v_add_f32 v9, v9, v186
    v_add_f32 v9, v9, v187
    v_cvt_pk_bf16_f32 v57, v186, v187
    v_exp_f32 v188, v188
    v_exp_f32 v189, v189
    v_add_f32 v10, v10, v188
    v_add_f32 v10, v10, v189
    v_cvt_pk_bf16_f32 v60, v188, v189
    v_exp_f32 v190, v190
    v_exp_f32 v191, v191
    v_add_f32 v10, v10, v190
    v_add_f32 v10, v10, v191
    v_cvt_pk_bf16_f32 v61, v190, v191
    v_exp_f32 v192, v192
    v_exp_f32 v193, v193
    v_add_f32 v9, v9, v192
    v_add_f32 v9, v9, v193
    v_cvt_pk_bf16_f32 v58, v192, v193
    v_exp_f32 v194, v194
    v_exp_f32 v195, v195
    v_add_f32 v9, v9, v194
    v_add_f32 v9, v9, v195
    v_cvt_pk_bf16_f32 v59, v194, v195
    v_exp_f32 v196, v196
    v_exp_f32 v197, v197
    v_add_f32 v10, v10, v196
    v_add_f32 v10, v10, v197
    v_cvt_pk_bf16_f32 v62, v196, v197
    v_exp_f32 v198, v198
    v_exp_f32 v199, v199
    v_add_f32 v10, v10, v198
    v_add_f32 v10, v10, v199
    v_cvt_pk_bf16_f32 v63, v198, v199
    s_mov_b32 s17, 0xa000
    buffer_load_dwordx4 v[200:203], v8, s[8:11], s17 offen offset:0
    buffer_load_dwordx4 v[204:207], v8, s[8:11], s17 offen offset:1024
    buffer_load_dwordx4 v[208:211], v8, s[8:11], s17 offen offset:2048
    buffer_load_dwordx4 v[212:215], v8, s[8:11], s17 offen offset:3072
    s_waitcnt vmcnt(3)
    v_mfma_f32_16x16x32_bf16 v[184:187], v[200:203], v[152:155], v[216:219]
    v_mfma_f32_16x16x32_bf16 v[188:191], v[200:203], v[168:171], v[220:223]
    s_waitcnt vmcnt(2)
    v_mfma_f32_16x16x32_bf16 v[192:195], v[204:207], v[152:155], v[216:219]
    v_mfma_f32_16x16x32_bf16 v[196:199], v[204:207], v[168:171], v[220:223]
    s_waitcnt vmcnt(1)
    v_mfma_f32_16x16x32_bf16 v[184:187], v[208:211], v[156:159], v[184:187]
    v_mfma_f32_16x16x32_bf16 v[188:191], v[208:211], v[172:175], v[188:191]
    s_waitcnt vmcnt(0)
    v_mfma_f32_16x16x32_bf16 v[192:195], v[212:215], v[156:159], v[192:195]
    v_mfma_f32_16x16x32_bf16 v[196:199], v[212:215], v[172:175], v[196:199]
    s_mov_b32 s17, 0xb000
    buffer_load_dwordx4 v[200:203], v8, s[8:11], s17 offen offset:0
    buffer_load_dwordx4 v[204:207], v8, s[8:11], s17 offen offset:1024
    buffer_load_dwordx4 v[208:211], v8, s[8:11], s17 offen offset:2048
    buffer_load_dwordx4 v[212:215], v8, s[8:11], s17 offen offset:3072
    s_waitcnt vmcnt(3)
    v_mfma_f32_16x16x32_bf16 v[184:187], v[200:203], v[160:163], v[184:187]
    v_mfma_f32_16x16x32_bf16 v[188:191], v[200:203], v[176:179], v[188:191]
    s_waitcnt vmcnt(2)
    v_mfma_f32_16x16x32_bf16 v[192:195], v[204:207], v[160:163], v[192:195]
    v_mfma_f32_16x16x32_bf16 v[196:199], v[204:207], v[176:179], v[196:199]
    s_waitcnt vmcnt(1)
    v_mfma_f32_16x16x32_bf16 v[184:187], v[208:211], v[164:167], v[184:187]
    v_mfma_f32_16x16x32_bf16 v[188:191], v[208:211], v[180:183], v[188:191]
    s_waitcnt vmcnt(0)
    v_mfma_f32_16x16x32_bf16 v[192:195], v[212:215], v[164:167], v[192:195]
    v_mfma_f32_16x16x32_bf16 v[196:199], v[212:215], v[180:183], v[196:199]
    s_nop 3
    v_exp_f32 v184, v184
    v_exp_f32 v185, v185
    v_add_f32 v9, v9, v184
    v_add_f32 v9, v9, v185
    v_cvt_pk_bf16_f32 v64, v184, v185
    v_exp_f32 v186, v186
    v_exp_f32 v187, v187
    v_add_f32 v9, v9, v186
    v_add_f32 v9, v9, v187
    v_cvt_pk_bf16_f32 v65, v186, v187
    v_exp_f32 v188, v188
    v_exp_f32 v189, v189
    v_add_f32 v10, v10, v188
    v_add_f32 v10, v10, v189
    v_cvt_pk_bf16_f32 v68, v188, v189
    v_exp_f32 v190, v190
    v_exp_f32 v191, v191
    v_add_f32 v10, v10, v190
    v_add_f32 v10, v10, v191
    v_cvt_pk_bf16_f32 v69, v190, v191
    v_exp_f32 v192, v192
    v_exp_f32 v193, v193
    v_add_f32 v9, v9, v192
    v_add_f32 v9, v9, v193
    v_cvt_pk_bf16_f32 v66, v192, v193
    v_exp_f32 v194, v194
    v_exp_f32 v195, v195
    v_add_f32 v9, v9, v194
    v_add_f32 v9, v9, v195
    v_cvt_pk_bf16_f32 v67, v194, v195
    v_exp_f32 v196, v196
    v_exp_f32 v197, v197
    v_add_f32 v10, v10, v196
    v_add_f32 v10, v10, v197
    v_cvt_pk_bf16_f32 v70, v196, v197
    v_exp_f32 v198, v198
    v_exp_f32 v199, v199
    v_add_f32 v10, v10, v198
    v_add_f32 v10, v10, v199
    v_cvt_pk_bf16_f32 v71, v198, v199
    s_mov_b32 s17, 0xc000
    buffer_load_dwordx4 v[200:203], v8, s[8:11], s17 offen offset:0
    buffer_load_dwordx4 v[204:207], v8, s[8:11], s17 offen offset:1024
    buffer_load_dwordx4 v[208:211], v8, s[8:11], s17 offen offset:2048
    buffer_load_dwordx4 v[212:215], v8, s[8:11], s17 offen offset:3072
    s_waitcnt vmcnt(3)
    v_mfma_f32_16x16x32_bf16 v[184:187], v[200:203], v[152:155], v[216:219]
    v_mfma_f32_16x16x32_bf16 v[188:191], v[200:203], v[168:171], v[220:223]
    s_waitcnt vmcnt(2)
    v_mfma_f32_16x16x32_bf16 v[192:195], v[204:207], v[152:155], v[216:219]
    v_mfma_f32_16x16x32_bf16 v[196:199], v[204:207], v[168:171], v[220:223]
    s_waitcnt vmcnt(1)
    v_mfma_f32_16x16x32_bf16 v[184:187], v[208:211], v[156:159], v[184:187]
    v_mfma_f32_16x16x32_bf16 v[188:191], v[208:211], v[172:175], v[188:191]
    s_waitcnt vmcnt(0)
    v_mfma_f32_16x16x32_bf16 v[192:195], v[212:215], v[156:159], v[192:195]
    v_mfma_f32_16x16x32_bf16 v[196:199], v[212:215], v[172:175], v[196:199]
    s_mov_b32 s17, 0xd000
    buffer_load_dwordx4 v[200:203], v8, s[8:11], s17 offen offset:0
    buffer_load_dwordx4 v[204:207], v8, s[8:11], s17 offen offset:1024
    buffer_load_dwordx4 v[208:211], v8, s[8:11], s17 offen offset:2048
    buffer_load_dwordx4 v[212:215], v8, s[8:11], s17 offen offset:3072
    s_waitcnt vmcnt(3)
    v_mfma_f32_16x16x32_bf16 v[184:187], v[200:203], v[160:163], v[184:187]
    v_mfma_f32_16x16x32_bf16 v[188:191], v[200:203], v[176:179], v[188:191]
    s_waitcnt vmcnt(2)
    v_mfma_f32_16x16x32_bf16 v[192:195], v[204:207], v[160:163], v[192:195]
    v_mfma_f32_16x16x32_bf16 v[196:199], v[204:207], v[176:179], v[196:199]
    s_waitcnt vmcnt(1)
    v_mfma_f32_16x16x32_bf16 v[184:187], v[208:211], v[164:167], v[184:187]
    v_mfma_f32_16x16x32_bf16 v[188:191], v[208:211], v[180:183], v[188:191]
    s_waitcnt vmcnt(0)
    v_mfma_f32_16x16x32_bf16 v[192:195], v[212:215], v[164:167], v[192:195]
    v_mfma_f32_16x16x32_bf16 v[196:199], v[212:215], v[180:183], v[196:199]
    s_nop 3
    v_exp_f32 v184, v184
    v_exp_f32 v185, v185
    v_add_f32 v9, v9, v184
    v_add_f32 v9, v9, v185
    v_cvt_pk_bf16_f32 v72, v184, v185
    v_exp_f32 v186, v186
    v_exp_f32 v187, v187
    v_add_f32 v9, v9, v186
    v_add_f32 v9, v9, v187
    v_cvt_pk_bf16_f32 v73, v186, v187
    v_exp_f32 v188, v188
    v_exp_f32 v189, v189
    v_add_f32 v10, v10, v188
    v_add_f32 v10, v10, v189
    v_cvt_pk_bf16_f32 v76, v188, v189
    v_exp_f32 v190, v190
    v_exp_f32 v191, v191
    v_add_f32 v10, v10, v190
    v_add_f32 v10, v10, v191
    v_cvt_pk_bf16_f32 v77, v190, v191
    v_exp_f32 v192, v192
    v_exp_f32 v193, v193
    v_add_f32 v9, v9, v192
    v_add_f32 v9, v9, v193
    v_cvt_pk_bf16_f32 v74, v192, v193
    v_exp_f32 v194, v194
    v_exp_f32 v195, v195
    v_add_f32 v9, v9, v194
    v_add_f32 v9, v9, v195
    v_cvt_pk_bf16_f32 v75, v194, v195
    v_exp_f32 v196, v196
    v_exp_f32 v197, v197
    v_add_f32 v10, v10, v196
    v_add_f32 v10, v10, v197
    v_cvt_pk_bf16_f32 v78, v196, v197
    v_exp_f32 v198, v198
    v_exp_f32 v199, v199
    v_add_f32 v10, v10, v198
    v_add_f32 v10, v10, v199
    v_cvt_pk_bf16_f32 v79, v198, v199
    s_mov_b32 s17, 0xe000
    buffer_load_dwordx4 v[200:203], v8, s[8:11], s17 offen offset:0
    buffer_load_dwordx4 v[204:207], v8, s[8:11], s17 offen offset:1024
    buffer_load_dwordx4 v[208:211], v8, s[8:11], s17 offen offset:2048
    buffer_load_dwordx4 v[212:215], v8, s[8:11], s17 offen offset:3072
    s_waitcnt vmcnt(3)
    v_mfma_f32_16x16x32_bf16 v[184:187], v[200:203], v[152:155], v[216:219]
    v_mfma_f32_16x16x32_bf16 v[188:191], v[200:203], v[168:171], v[220:223]
    s_waitcnt vmcnt(2)
    v_mfma_f32_16x16x32_bf16 v[192:195], v[204:207], v[152:155], v[216:219]
    v_mfma_f32_16x16x32_bf16 v[196:199], v[204:207], v[168:171], v[220:223]
    s_waitcnt vmcnt(1)
    v_mfma_f32_16x16x32_bf16 v[184:187], v[208:211], v[156:159], v[184:187]
    v_mfma_f32_16x16x32_bf16 v[188:191], v[208:211], v[172:175], v[188:191]
    s_waitcnt vmcnt(0)
    v_mfma_f32_16x16x32_bf16 v[192:195], v[212:215], v[156:159], v[192:195]
    v_mfma_f32_16x16x32_bf16 v[196:199], v[212:215], v[172:175], v[196:199]
    s_mov_b32 s17, 0xf000
    buffer_load_dwordx4 v[200:203], v8, s[8:11], s17 offen offset:0
    buffer_load_dwordx4 v[204:207], v8, s[8:11], s17 offen offset:1024
    buffer_load_dwordx4 v[208:211], v8, s[8:11], s17 offen offset:2048
    buffer_load_dwordx4 v[212:215], v8, s[8:11], s17 offen offset:3072
    s_waitcnt vmcnt(3)
    v_mfma_f32_16x16x32_bf16 v[184:187], v[200:203], v[160:163], v[184:187]
    v_mfma_f32_16x16x32_bf16 v[188:191], v[200:203], v[176:179], v[188:191]
    s_waitcnt vmcnt(2)
    v_mfma_f32_16x16x32_bf16 v[192:195], v[204:207], v[160:163], v[192:195]
    v_mfma_f32_16x16x32_bf16 v[196:199], v[204:207], v[176:179], v[196:199]
    s_waitcnt vmcnt(1)
    v_mfma_f32_16x16x32_bf16 v[184:187], v[208:211], v[164:167], v[184:187]
    v_mfma_f32_16x16x32_bf16 v[188:191], v[208:211], v[180:183], v[188:191]
    s_waitcnt vmcnt(0)
    v_mfma_f32_16x16x32_bf16 v[192:195], v[212:215], v[164:167], v[192:195]
    v_mfma_f32_16x16x32_bf16 v[196:199], v[212:215], v[180:183], v[196:199]
    s_nop 3
    v_exp_f32 v184, v184
    v_exp_f32 v185, v185
    v_add_f32 v9, v9, v184
    v_add_f32 v9, v9, v185
    v_cvt_pk_bf16_f32 v80, v184, v185
    v_exp_f32 v186, v186
    v_exp_f32 v187, v187
    v_add_f32 v9, v9, v186
    v_add_f32 v9, v9, v187
    v_cvt_pk_bf16_f32 v81, v186, v187
    v_exp_f32 v188, v188
    v_exp_f32 v189, v189
    v_add_f32 v10, v10, v188
    v_add_f32 v10, v10, v189
    v_cvt_pk_bf16_f32 v84, v188, v189
    v_exp_f32 v190, v190
    v_exp_f32 v191, v191
    v_add_f32 v10, v10, v190
    v_add_f32 v10, v10, v191
    v_cvt_pk_bf16_f32 v85, v190, v191
    v_exp_f32 v192, v192
    v_exp_f32 v193, v193
    v_add_f32 v9, v9, v192
    v_add_f32 v9, v9, v193
    v_cvt_pk_bf16_f32 v82, v192, v193
    v_exp_f32 v194, v194
    v_exp_f32 v195, v195
    v_add_f32 v9, v9, v194
    v_add_f32 v9, v9, v195
    v_cvt_pk_bf16_f32 v83, v194, v195
    v_exp_f32 v196, v196
    v_exp_f32 v197, v197
    v_add_f32 v10, v10, v196
    v_add_f32 v10, v10, v197
    v_cvt_pk_bf16_f32 v86, v196, v197
    v_exp_f32 v198, v198
    v_exp_f32 v199, v199
    v_add_f32 v10, v10, v198
    v_add_f32 v10, v10, v199
    v_cvt_pk_bf16_f32 v87, v198, v199
    s_mov_b32 s17, 0x10000
    buffer_load_dwordx4 v[200:203], v8, s[8:11], s17 offen offset:0
    buffer_load_dwordx4 v[204:207], v8, s[8:11], s17 offen offset:1024
    buffer_load_dwordx4 v[208:211], v8, s[8:11], s17 offen offset:2048
    buffer_load_dwordx4 v[212:215], v8, s[8:11], s17 offen offset:3072
    s_waitcnt vmcnt(3)
    v_mfma_f32_16x16x32_bf16 v[184:187], v[200:203], v[152:155], v[216:219]
    v_mfma_f32_16x16x32_bf16 v[188:191], v[200:203], v[168:171], v[220:223]
    s_waitcnt vmcnt(2)
    v_mfma_f32_16x16x32_bf16 v[192:195], v[204:207], v[152:155], v[216:219]
    v_mfma_f32_16x16x32_bf16 v[196:199], v[204:207], v[168:171], v[220:223]
    s_waitcnt vmcnt(1)
    v_mfma_f32_16x16x32_bf16 v[184:187], v[208:211], v[156:159], v[184:187]
    v_mfma_f32_16x16x32_bf16 v[188:191], v[208:211], v[172:175], v[188:191]
    s_waitcnt vmcnt(0)
    v_mfma_f32_16x16x32_bf16 v[192:195], v[212:215], v[156:159], v[192:195]
    v_mfma_f32_16x16x32_bf16 v[196:199], v[212:215], v[172:175], v[196:199]
    s_mov_b32 s17, 0x11000
    buffer_load_dwordx4 v[200:203], v8, s[8:11], s17 offen offset:0
    buffer_load_dwordx4 v[204:207], v8, s[8:11], s17 offen offset:1024
    buffer_load_dwordx4 v[208:211], v8, s[8:11], s17 offen offset:2048
    buffer_load_dwordx4 v[212:215], v8, s[8:11], s17 offen offset:3072
    s_waitcnt vmcnt(3)
    v_mfma_f32_16x16x32_bf16 v[184:187], v[200:203], v[160:163], v[184:187]
    v_mfma_f32_16x16x32_bf16 v[188:191], v[200:203], v[176:179], v[188:191]
    s_waitcnt vmcnt(2)
    v_mfma_f32_16x16x32_bf16 v[192:195], v[204:207], v[160:163], v[192:195]
    v_mfma_f32_16x16x32_bf16 v[196:199], v[204:207], v[176:179], v[196:199]
    s_waitcnt vmcnt(1)
    v_mfma_f32_16x16x32_bf16 v[184:187], v[208:211], v[164:167], v[184:187]
    v_mfma_f32_16x16x32_bf16 v[188:191], v[208:211], v[180:183], v[188:191]
    s_waitcnt vmcnt(0)
    v_mfma_f32_16x16x32_bf16 v[192:195], v[212:215], v[164:167], v[192:195]
    v_mfma_f32_16x16x32_bf16 v[196:199], v[212:215], v[180:183], v[196:199]
    s_nop 3
    v_exp_f32 v184, v184
    v_exp_f32 v185, v185
    v_add_f32 v9, v9, v184
    v_add_f32 v9, v9, v185
    v_cvt_pk_bf16_f32 v88, v184, v185
    v_exp_f32 v186, v186
    v_exp_f32 v187, v187
    v_add_f32 v9, v9, v186
    v_add_f32 v9, v9, v187
    v_cvt_pk_bf16_f32 v89, v186, v187
    v_exp_f32 v188, v188
    v_exp_f32 v189, v189
    v_add_f32 v10, v10, v188
    v_add_f32 v10, v10, v189
    v_cvt_pk_bf16_f32 v92, v188, v189
    v_exp_f32 v190, v190
    v_exp_f32 v191, v191
    v_add_f32 v10, v10, v190
    v_add_f32 v10, v10, v191
    v_cvt_pk_bf16_f32 v93, v190, v191
    v_exp_f32 v192, v192
    v_exp_f32 v193, v193
    v_add_f32 v9, v9, v192
    v_add_f32 v9, v9, v193
    v_cvt_pk_bf16_f32 v90, v192, v193
    v_exp_f32 v194, v194
    v_exp_f32 v195, v195
    v_add_f32 v9, v9, v194
    v_add_f32 v9, v9, v195
    v_cvt_pk_bf16_f32 v91, v194, v195
    v_exp_f32 v196, v196
    v_exp_f32 v197, v197
    v_add_f32 v10, v10, v196
    v_add_f32 v10, v10, v197
    v_cvt_pk_bf16_f32 v94, v196, v197
    v_exp_f32 v198, v198
    v_exp_f32 v199, v199
    v_add_f32 v10, v10, v198
    v_add_f32 v10, v10, v199
    v_cvt_pk_bf16_f32 v95, v198, v199
    s_mov_b32 s17, 0x12000
    buffer_load_dwordx4 v[200:203], v8, s[8:11], s17 offen offset:0
    buffer_load_dwordx4 v[204:207], v8, s[8:11], s17 offen offset:1024
    buffer_load_dwordx4 v[208:211], v8, s[8:11], s17 offen offset:2048
    buffer_load_dwordx4 v[212:215], v8, s[8:11], s17 offen offset:3072
    s_waitcnt vmcnt(3)
    v_mfma_f32_16x16x32_bf16 v[184:187], v[200:203], v[152:155], v[216:219]
    v_mfma_f32_16x16x32_bf16 v[188:191], v[200:203], v[168:171], v[220:223]
    s_waitcnt vmcnt(2)
    v_mfma_f32_16x16x32_bf16 v[192:195], v[204:207], v[152:155], v[216:219]
    v_mfma_f32_16x16x32_bf16 v[196:199], v[204:207], v[168:171], v[220:223]
    s_waitcnt vmcnt(1)
    v_mfma_f32_16x16x32_bf16 v[184:187], v[208:211], v[156:159], v[184:187]
    v_mfma_f32_16x16x32_bf16 v[188:191], v[208:211], v[172:175], v[188:191]
    s_waitcnt vmcnt(0)
    v_mfma_f32_16x16x32_bf16 v[192:195], v[212:215], v[156:159], v[192:195]
    v_mfma_f32_16x16x32_bf16 v[196:199], v[212:215], v[172:175], v[196:199]
    s_mov_b32 s17, 0x13000
    buffer_load_dwordx4 v[200:203], v8, s[8:11], s17 offen offset:0
    buffer_load_dwordx4 v[204:207], v8, s[8:11], s17 offen offset:1024
    buffer_load_dwordx4 v[208:211], v8, s[8:11], s17 offen offset:2048
    buffer_load_dwordx4 v[212:215], v8, s[8:11], s17 offen offset:3072
    s_waitcnt vmcnt(3)
    v_mfma_f32_16x16x32_bf16 v[184:187], v[200:203], v[160:163], v[184:187]
    v_mfma_f32_16x16x32_bf16 v[188:191], v[200:203], v[176:179], v[188:191]
    s_waitcnt vmcnt(2)
    v_mfma_f32_16x16x32_bf16 v[192:195], v[204:207], v[160:163], v[192:195]
    v_mfma_f32_16x16x32_bf16 v[196:199], v[204:207], v[176:179], v[196:199]
    s_waitcnt vmcnt(1)
    v_mfma_f32_16x16x32_bf16 v[184:187], v[208:211], v[164:167], v[184:187]
    v_mfma_f32_16x16x32_bf16 v[188:191], v[208:211], v[180:183], v[188:191]
    s_waitcnt vmcnt(0)
    v_mfma_f32_16x16x32_bf16 v[192:195], v[212:215], v[164:167], v[192:195]
    v_mfma_f32_16x16x32_bf16 v[196:199], v[212:215], v[180:183], v[196:199]
    s_nop 3
    v_exp_f32 v184, v184
    v_exp_f32 v185, v185
    v_add_f32 v9, v9, v184
    v_add_f32 v9, v9, v185
    v_cvt_pk_bf16_f32 v96, v184, v185
    v_exp_f32 v186, v186
    v_exp_f32 v187, v187
    v_add_f32 v9, v9, v186
    v_add_f32 v9, v9, v187
    v_cvt_pk_bf16_f32 v97, v186, v187
    v_exp_f32 v188, v188
    v_exp_f32 v189, v189
    v_add_f32 v10, v10, v188
    v_add_f32 v10, v10, v189
    v_cvt_pk_bf16_f32 v100, v188, v189
    v_exp_f32 v190, v190
    v_exp_f32 v191, v191
    v_add_f32 v10, v10, v190
    v_add_f32 v10, v10, v191
    v_cvt_pk_bf16_f32 v101, v190, v191
    v_exp_f32 v192, v192
    v_exp_f32 v193, v193
    v_add_f32 v9, v9, v192
    v_add_f32 v9, v9, v193
    v_cvt_pk_bf16_f32 v98, v192, v193
    v_exp_f32 v194, v194
    v_exp_f32 v195, v195
    v_add_f32 v9, v9, v194
    v_add_f32 v9, v9, v195
    v_cvt_pk_bf16_f32 v99, v194, v195
    v_exp_f32 v196, v196
    v_exp_f32 v197, v197
    v_add_f32 v10, v10, v196
    v_add_f32 v10, v10, v197
    v_cvt_pk_bf16_f32 v102, v196, v197
    v_exp_f32 v198, v198
    v_exp_f32 v199, v199
    v_add_f32 v10, v10, v198
    v_add_f32 v10, v10, v199
    v_cvt_pk_bf16_f32 v103, v198, v199
    s_mov_b32 s17, 0x14000
    buffer_load_dwordx4 v[200:203], v8, s[8:11], s17 offen offset:0
    buffer_load_dwordx4 v[204:207], v8, s[8:11], s17 offen offset:1024
    buffer_load_dwordx4 v[208:211], v8, s[8:11], s17 offen offset:2048
    buffer_load_dwordx4 v[212:215], v8, s[8:11], s17 offen offset:3072
    s_waitcnt vmcnt(3)
    v_mfma_f32_16x16x32_bf16 v[184:187], v[200:203], v[152:155], v[216:219]
    v_mfma_f32_16x16x32_bf16 v[188:191], v[200:203], v[168:171], v[220:223]
    s_waitcnt vmcnt(2)
    v_mfma_f32_16x16x32_bf16 v[192:195], v[204:207], v[152:155], v[216:219]
    v_mfma_f32_16x16x32_bf16 v[196:199], v[204:207], v[168:171], v[220:223]
    s_waitcnt vmcnt(1)
    v_mfma_f32_16x16x32_bf16 v[184:187], v[208:211], v[156:159], v[184:187]
    v_mfma_f32_16x16x32_bf16 v[188:191], v[208:211], v[172:175], v[188:191]
    s_waitcnt vmcnt(0)
    v_mfma_f32_16x16x32_bf16 v[192:195], v[212:215], v[156:159], v[192:195]
    v_mfma_f32_16x16x32_bf16 v[196:199], v[212:215], v[172:175], v[196:199]
    s_mov_b32 s17, 0x15000
    buffer_load_dwordx4 v[200:203], v8, s[8:11], s17 offen offset:0
    buffer_load_dwordx4 v[204:207], v8, s[8:11], s17 offen offset:1024
    buffer_load_dwordx4 v[208:211], v8, s[8:11], s17 offen offset:2048
    buffer_load_dwordx4 v[212:215], v8, s[8:11], s17 offen offset:3072
    s_waitcnt vmcnt(3)
    v_mfma_f32_16x16x32_bf16 v[184:187], v[200:203], v[160:163], v[184:187]
    v_mfma_f32_16x16x32_bf16 v[188:191], v[200:203], v[176:179], v[188:191]
    s_waitcnt vmcnt(2)
    v_mfma_f32_16x16x32_bf16 v[192:195], v[204:207], v[160:163], v[192:195]
    v_mfma_f32_16x16x32_bf16 v[196:199], v[204:207], v[176:179], v[196:199]
    s_waitcnt vmcnt(1)
    v_mfma_f32_16x16x32_bf16 v[184:187], v[208:211], v[164:167], v[184:187]
    v_mfma_f32_16x16x32_bf16 v[188:191], v[208:211], v[180:183], v[188:191]
    s_waitcnt vmcnt(0)
    v_mfma_f32_16x16x32_bf16 v[192:195], v[212:215], v[164:167], v[192:195]
    v_mfma_f32_16x16x32_bf16 v[196:199], v[212:215], v[180:183], v[196:199]
    s_nop 3
    v_exp_f32 v184, v184
    v_exp_f32 v185, v185
    v_add_f32 v9, v9, v184
    v_add_f32 v9, v9, v185
    v_cvt_pk_bf16_f32 v104, v184, v185
    v_exp_f32 v186, v186
    v_exp_f32 v187, v187
    v_add_f32 v9, v9, v186
    v_add_f32 v9, v9, v187
    v_cvt_pk_bf16_f32 v105, v186, v187
    v_exp_f32 v188, v188
    v_exp_f32 v189, v189
    v_add_f32 v10, v10, v188
    v_add_f32 v10, v10, v189
    v_cvt_pk_bf16_f32 v108, v188, v189
    v_exp_f32 v190, v190
    v_exp_f32 v191, v191
    v_add_f32 v10, v10, v190
    v_add_f32 v10, v10, v191
    v_cvt_pk_bf16_f32 v109, v190, v191
    v_exp_f32 v192, v192
    v_exp_f32 v193, v193
    v_add_f32 v9, v9, v192
    v_add_f32 v9, v9, v193
    v_cvt_pk_bf16_f32 v106, v192, v193
    v_exp_f32 v194, v194
    v_exp_f32 v195, v195
    v_add_f32 v9, v9, v194
    v_add_f32 v9, v9, v195
    v_cvt_pk_bf16_f32 v107, v194, v195
    v_exp_f32 v196, v196
    v_exp_f32 v197, v197
    v_add_f32 v10, v10, v196
    v_add_f32 v10, v10, v197
    v_cvt_pk_bf16_f32 v110, v196, v197
    v_exp_f32 v198, v198
    v_exp_f32 v199, v199
    v_add_f32 v10, v10, v198
    v_add_f32 v10, v10, v199
    v_cvt_pk_bf16_f32 v111, v198, v199
    s_mov_b32 s17, 0x16000
    buffer_load_dwordx4 v[200:203], v8, s[8:11], s17 offen offset:0
    buffer_load_dwordx4 v[204:207], v8, s[8:11], s17 offen offset:1024
    buffer_load_dwordx4 v[208:211], v8, s[8:11], s17 offen offset:2048
    buffer_load_dwordx4 v[212:215], v8, s[8:11], s17 offen offset:3072
    s_waitcnt vmcnt(3)
    v_mfma_f32_16x16x32_bf16 v[184:187], v[200:203], v[152:155], v[216:219]
    v_mfma_f32_16x16x32_bf16 v[188:191], v[200:203], v[168:171], v[220:223]
    s_waitcnt vmcnt(2)
    v_mfma_f32_16x16x32_bf16 v[192:195], v[204:207], v[152:155], v[216:219]
    v_mfma_f32_16x16x32_bf16 v[196:199], v[204:207], v[168:171], v[220:223]
    s_waitcnt vmcnt(1)
    v_mfma_f32_16x16x32_bf16 v[184:187], v[208:211], v[156:159], v[184:187]
    v_mfma_f32_16x16x32_bf16 v[188:191], v[208:211], v[172:175], v[188:191]
    s_waitcnt vmcnt(0)
    v_mfma_f32_16x16x32_bf16 v[192:195], v[212:215], v[156:159], v[192:195]
    v_mfma_f32_16x16x32_bf16 v[196:199], v[212:215], v[172:175], v[196:199]
    s_mov_b32 s17, 0x17000
    buffer_load_dwordx4 v[200:203], v8, s[8:11], s17 offen offset:0
    buffer_load_dwordx4 v[204:207], v8, s[8:11], s17 offen offset:1024
    buffer_load_dwordx4 v[208:211], v8, s[8:11], s17 offen offset:2048
    buffer_load_dwordx4 v[212:215], v8, s[8:11], s17 offen offset:3072
    s_waitcnt vmcnt(3)
    v_mfma_f32_16x16x32_bf16 v[184:187], v[200:203], v[160:163], v[184:187]
    v_mfma_f32_16x16x32_bf16 v[188:191], v[200:203], v[176:179], v[188:191]
    s_waitcnt vmcnt(2)
    v_mfma_f32_16x16x32_bf16 v[192:195], v[204:207], v[160:163], v[192:195]
    v_mfma_f32_16x16x32_bf16 v[196:199], v[204:207], v[176:179], v[196:199]
    s_waitcnt vmcnt(1)
    v_mfma_f32_16x16x32_bf16 v[184:187], v[208:211], v[164:167], v[184:187]
    v_mfma_f32_16x16x32_bf16 v[188:191], v[208:211], v[180:183], v[188:191]
    s_waitcnt vmcnt(0)
    v_mfma_f32_16x16x32_bf16 v[192:195], v[212:215], v[164:167], v[192:195]
    v_mfma_f32_16x16x32_bf16 v[196:199], v[212:215], v[180:183], v[196:199]
    s_nop 3
    v_exp_f32 v184, v184
    v_exp_f32 v185, v185
    v_add_f32 v9, v9, v184
    v_add_f32 v9, v9, v185
    v_cvt_pk_bf16_f32 v112, v184, v185
    v_exp_f32 v186, v186
    v_exp_f32 v187, v187
    v_add_f32 v9, v9, v186
    v_add_f32 v9, v9, v187
    v_cvt_pk_bf16_f32 v113, v186, v187
    v_exp_f32 v188, v188
    v_exp_f32 v189, v189
    v_add_f32 v10, v10, v188
    v_add_f32 v10, v10, v189
    v_cvt_pk_bf16_f32 v116, v188, v189
    v_exp_f32 v190, v190
    v_exp_f32 v191, v191
    v_add_f32 v10, v10, v190
    v_add_f32 v10, v10, v191
    v_cvt_pk_bf16_f32 v117, v190, v191
    v_exp_f32 v192, v192
    v_exp_f32 v193, v193
    v_add_f32 v9, v9, v192
    v_add_f32 v9, v9, v193
    v_cvt_pk_bf16_f32 v114, v192, v193
    v_exp_f32 v194, v194
    v_exp_f32 v195, v195
    v_add_f32 v9, v9, v194
    v_add_f32 v9, v9, v195
    v_cvt_pk_bf16_f32 v115, v194, v195
    v_exp_f32 v196, v196
    v_exp_f32 v197, v197
    v_add_f32 v10, v10, v196
    v_add_f32 v10, v10, v197
    v_cvt_pk_bf16_f32 v118, v196, v197
    v_exp_f32 v198, v198
    v_exp_f32 v199, v199
    v_add_f32 v10, v10, v198
    v_add_f32 v10, v10, v199
    v_cvt_pk_bf16_f32 v119, v198, v199
    s_mov_b32 s17, 0x18000
    buffer_load_dwordx4 v[200:203], v8, s[8:11], s17 offen offset:0
    buffer_load_dwordx4 v[204:207], v8, s[8:11], s17 offen offset:1024
    buffer_load_dwordx4 v[208:211], v8, s[8:11], s17 offen offset:2048
    buffer_load_dwordx4 v[212:215], v8, s[8:11], s17 offen offset:3072
    s_waitcnt vmcnt(3)
    v_mfma_f32_16x16x32_bf16 v[184:187], v[200:203], v[152:155], v[216:219]
    v_mfma_f32_16x16x32_bf16 v[188:191], v[200:203], v[168:171], v[220:223]
    s_waitcnt vmcnt(2)
    v_mfma_f32_16x16x32_bf16 v[192:195], v[204:207], v[152:155], v[216:219]
    v_mfma_f32_16x16x32_bf16 v[196:199], v[204:207], v[168:171], v[220:223]
    s_waitcnt vmcnt(1)
    v_mfma_f32_16x16x32_bf16 v[184:187], v[208:211], v[156:159], v[184:187]
    v_mfma_f32_16x16x32_bf16 v[188:191], v[208:211], v[172:175], v[188:191]
    s_waitcnt vmcnt(0)
    v_mfma_f32_16x16x32_bf16 v[192:195], v[212:215], v[156:159], v[192:195]
    v_mfma_f32_16x16x32_bf16 v[196:199], v[212:215], v[172:175], v[196:199]
    s_mov_b32 s17, 0x19000
    buffer_load_dwordx4 v[200:203], v8, s[8:11], s17 offen offset:0
    buffer_load_dwordx4 v[204:207], v8, s[8:11], s17 offen offset:1024
    buffer_load_dwordx4 v[208:211], v8, s[8:11], s17 offen offset:2048
    buffer_load_dwordx4 v[212:215], v8, s[8:11], s17 offen offset:3072
    s_waitcnt vmcnt(3)
    v_mfma_f32_16x16x32_bf16 v[184:187], v[200:203], v[160:163], v[184:187]
    v_mfma_f32_16x16x32_bf16 v[188:191], v[200:203], v[176:179], v[188:191]
    s_waitcnt vmcnt(2)
    v_mfma_f32_16x16x32_bf16 v[192:195], v[204:207], v[160:163], v[192:195]
    v_mfma_f32_16x16x32_bf16 v[196:199], v[204:207], v[176:179], v[196:199]
    s_waitcnt vmcnt(1)
    v_mfma_f32_16x16x32_bf16 v[184:187], v[208:211], v[164:167], v[184:187]
    v_mfma_f32_16x16x32_bf16 v[188:191], v[208:211], v[180:183], v[188:191]
    s_waitcnt vmcnt(0)
    v_mfma_f32_16x16x32_bf16 v[192:195], v[212:215], v[164:167], v[192:195]
    v_mfma_f32_16x16x32_bf16 v[196:199], v[212:215], v[180:183], v[196:199]
    s_nop 3
    v_exp_f32 v184, v184
    v_exp_f32 v185, v185
    v_add_f32 v9, v9, v184
    v_add_f32 v9, v9, v185
    v_cvt_pk_bf16_f32 v120, v184, v185
    v_exp_f32 v186, v186
    v_exp_f32 v187, v187
    v_add_f32 v9, v9, v186
    v_add_f32 v9, v9, v187
    v_cvt_pk_bf16_f32 v121, v186, v187
    v_exp_f32 v188, v188
    v_exp_f32 v189, v189
    v_add_f32 v10, v10, v188
    v_add_f32 v10, v10, v189
    v_cvt_pk_bf16_f32 v124, v188, v189
    v_exp_f32 v190, v190
    v_exp_f32 v191, v191
    v_add_f32 v10, v10, v190
    v_add_f32 v10, v10, v191
    v_cvt_pk_bf16_f32 v125, v190, v191
    v_exp_f32 v192, v192
    v_exp_f32 v193, v193
    v_add_f32 v9, v9, v192
    v_add_f32 v9, v9, v193
    v_cvt_pk_bf16_f32 v122, v192, v193
    v_exp_f32 v194, v194
    v_exp_f32 v195, v195
    v_add_f32 v9, v9, v194
    v_add_f32 v9, v9, v195
    v_cvt_pk_bf16_f32 v123, v194, v195
    v_exp_f32 v196, v196
    v_exp_f32 v197, v197
    v_add_f32 v10, v10, v196
    v_add_f32 v10, v10, v197
    v_cvt_pk_bf16_f32 v126, v196, v197
    v_exp_f32 v198, v198
    v_exp_f32 v199, v199
    v_add_f32 v10, v10, v198
    v_add_f32 v10, v10, v199
    v_cvt_pk_bf16_f32 v127, v198, v199
    s_mov_b32 s17, 0x1a000
    buffer_load_dwordx4 v[200:203], v8, s[8:11], s17 offen offset:0
    buffer_load_dwordx4 v[204:207], v8, s[8:11], s17 offen offset:1024
    buffer_load_dwordx4 v[208:211], v8, s[8:11], s17 offen offset:2048
    buffer_load_dwordx4 v[212:215], v8, s[8:11], s17 offen offset:3072
    s_waitcnt vmcnt(3)
    v_mfma_f32_16x16x32_bf16 v[184:187], v[200:203], v[152:155], v[216:219]
    v_mfma_f32_16x16x32_bf16 v[188:191], v[200:203], v[168:171], v[220:223]
    s_waitcnt vmcnt(2)
    v_mfma_f32_16x16x32_bf16 v[192:195], v[204:207], v[152:155], v[216:219]
    v_mfma_f32_16x16x32_bf16 v[196:199], v[204:207], v[168:171], v[220:223]
    s_waitcnt vmcnt(1)
    v_mfma_f32_16x16x32_bf16 v[184:187], v[208:211], v[156:159], v[184:187]
    v_mfma_f32_16x16x32_bf16 v[188:191], v[208:211], v[172:175], v[188:191]
    s_waitcnt vmcnt(0)
    v_mfma_f32_16x16x32_bf16 v[192:195], v[212:215], v[156:159], v[192:195]
    v_mfma_f32_16x16x32_bf16 v[196:199], v[212:215], v[172:175], v[196:199]
    s_mov_b32 s17, 0x1b000
    buffer_load_dwordx4 v[200:203], v8, s[8:11], s17 offen offset:0
    buffer_load_dwordx4 v[204:207], v8, s[8:11], s17 offen offset:1024
    buffer_load_dwordx4 v[208:211], v8, s[8:11], s17 offen offset:2048
    buffer_load_dwordx4 v[212:215], v8, s[8:11], s17 offen offset:3072
    s_waitcnt vmcnt(3)
    v_mfma_f32_16x16x32_bf16 v[184:187], v[200:203], v[160:163], v[184:187]
    v_mfma_f32_16x16x32_bf16 v[188:191], v[200:203], v[176:179], v[188:191]
    s_waitcnt vmcnt(2)
    v_mfma_f32_16x16x32_bf16 v[192:195], v[204:207], v[160:163], v[192:195]
    v_mfma_f32_16x16x32_bf16 v[196:199], v[204:207], v[176:179], v[196:199]
    s_waitcnt vmcnt(1)
    v_mfma_f32_16x16x32_bf16 v[184:187], v[208:211], v[164:167], v[184:187]
    v_mfma_f32_16x16x32_bf16 v[188:191], v[208:211], v[180:183], v[188:191]
    s_waitcnt vmcnt(0)
    v_mfma_f32_16x16x32_bf16 v[192:195], v[212:215], v[164:167], v[192:195]
    v_mfma_f32_16x16x32_bf16 v[196:199], v[212:215], v[180:183], v[196:199]
    s_nop 3
    v_exp_f32 v184, v184
    v_exp_f32 v185, v185
    v_add_f32 v9, v9, v184
    v_add_f32 v9, v9, v185
    v_cvt_pk_bf16_f32 v128, v184, v185
    v_exp_f32 v186, v186
    v_exp_f32 v187, v187
    v_add_f32 v9, v9, v186
    v_add_f32 v9, v9, v187
    v_cvt_pk_bf16_f32 v129, v186, v187
    v_exp_f32 v188, v188
    v_exp_f32 v189, v189
    v_add_f32 v10, v10, v188
    v_add_f32 v10, v10, v189
    v_cvt_pk_bf16_f32 v132, v188, v189
    v_exp_f32 v190, v190
    v_exp_f32 v191, v191
    v_add_f32 v10, v10, v190
    v_add_f32 v10, v10, v191
    v_cvt_pk_bf16_f32 v133, v190, v191
    v_exp_f32 v192, v192
    v_exp_f32 v193, v193
    v_add_f32 v9, v9, v192
    v_add_f32 v9, v9, v193
    v_cvt_pk_bf16_f32 v130, v192, v193
    v_exp_f32 v194, v194
    v_exp_f32 v195, v195
    v_add_f32 v9, v9, v194
    v_add_f32 v9, v9, v195
    v_cvt_pk_bf16_f32 v131, v194, v195
    v_exp_f32 v196, v196
    v_exp_f32 v197, v197
    v_add_f32 v10, v10, v196
    v_add_f32 v10, v10, v197
    v_cvt_pk_bf16_f32 v134, v196, v197
    v_exp_f32 v198, v198
    v_exp_f32 v199, v199
    v_add_f32 v10, v10, v198
    v_add_f32 v10, v10, v199
    v_cvt_pk_bf16_f32 v135, v198, v199
    s_mov_b32 s17, 0x1c000
    buffer_load_dwordx4 v[200:203], v8, s[8:11], s17 offen offset:0
    buffer_load_dwordx4 v[204:207], v8, s[8:11], s17 offen offset:1024
    buffer_load_dwordx4 v[208:211], v8, s[8:11], s17 offen offset:2048
    buffer_load_dwordx4 v[212:215], v8, s[8:11], s17 offen offset:3072
    s_waitcnt vmcnt(3)
    v_mfma_f32_16x16x32_bf16 v[184:187], v[200:203], v[152:155], v[216:219]
    v_mfma_f32_16x16x32_bf16 v[188:191], v[200:203], v[168:171], v[220:223]
    s_waitcnt vmcnt(2)
    v_mfma_f32_16x16x32_bf16 v[192:195], v[204:207], v[152:155], v[216:219]
    v_mfma_f32_16x16x32_bf16 v[196:199], v[204:207], v[168:171], v[220:223]
    s_waitcnt vmcnt(1)
    v_mfma_f32_16x16x32_bf16 v[184:187], v[208:211], v[156:159], v[184:187]
    v_mfma_f32_16x16x32_bf16 v[188:191], v[208:211], v[172:175], v[188:191]
    s_waitcnt vmcnt(0)
    v_mfma_f32_16x16x32_bf16 v[192:195], v[212:215], v[156:159], v[192:195]
    v_mfma_f32_16x16x32_bf16 v[196:199], v[212:215], v[172:175], v[196:199]
    s_mov_b32 s17, 0x1d000
    buffer_load_dwordx4 v[200:203], v8, s[8:11], s17 offen offset:0
    buffer_load_dwordx4 v[204:207], v8, s[8:11], s17 offen offset:1024
    buffer_load_dwordx4 v[208:211], v8, s[8:11], s17 offen offset:2048
    buffer_load_dwordx4 v[212:215], v8, s[8:11], s17 offen offset:3072
    s_waitcnt vmcnt(3)
    v_mfma_f32_16x16x32_bf16 v[184:187], v[200:203], v[160:163], v[184:187]
    v_mfma_f32_16x16x32_bf16 v[188:191], v[200:203], v[176:179], v[188:191]
    s_waitcnt vmcnt(2)
    v_mfma_f32_16x16x32_bf16 v[192:195], v[204:207], v[160:163], v[192:195]
    v_mfma_f32_16x16x32_bf16 v[196:199], v[204:207], v[176:179], v[196:199]
    s_waitcnt vmcnt(1)
    v_mfma_f32_16x16x32_bf16 v[184:187], v[208:211], v[164:167], v[184:187]
    v_mfma_f32_16x16x32_bf16 v[188:191], v[208:211], v[180:183], v[188:191]
    s_waitcnt vmcnt(0)
    v_mfma_f32_16x16x32_bf16 v[192:195], v[212:215], v[164:167], v[192:195]
    v_mfma_f32_16x16x32_bf16 v[196:199], v[212:215], v[180:183], v[196:199]
    s_nop 3
    v_exp_f32 v184, v184
    v_exp_f32 v185, v185
    v_add_f32 v9, v9, v184
    v_add_f32 v9, v9, v185
    v_cvt_pk_bf16_f32 v136, v184, v185
    v_exp_f32 v186, v186
    v_exp_f32 v187, v187
    v_add_f32 v9, v9, v186
    v_add_f32 v9, v9, v187
    v_cvt_pk_bf16_f32 v137, v186, v187
    v_exp_f32 v188, v188
    v_exp_f32 v189, v189
    v_add_f32 v10, v10, v188
    v_add_f32 v10, v10, v189
    v_cvt_pk_bf16_f32 v140, v188, v189
    v_exp_f32 v190, v190
    v_exp_f32 v191, v191
    v_add_f32 v10, v10, v190
    v_add_f32 v10, v10, v191
    v_cvt_pk_bf16_f32 v141, v190, v191
    v_exp_f32 v192, v192
    v_exp_f32 v193, v193
    v_add_f32 v9, v9, v192
    v_add_f32 v9, v9, v193
    v_cvt_pk_bf16_f32 v138, v192, v193
    v_exp_f32 v194, v194
    v_exp_f32 v195, v195
    v_add_f32 v9, v9, v194
    v_add_f32 v9, v9, v195
    v_cvt_pk_bf16_f32 v139, v194, v195
    v_exp_f32 v196, v196
    v_exp_f32 v197, v197
    v_add_f32 v10, v10, v196
    v_add_f32 v10, v10, v197
    v_cvt_pk_bf16_f32 v142, v196, v197
    v_exp_f32 v198, v198
    v_exp_f32 v199, v199
    v_add_f32 v10, v10, v198
    v_add_f32 v10, v10, v199
    v_cvt_pk_bf16_f32 v143, v198, v199
    s_mov_b32 s17, 0x1e000
    buffer_load_dwordx4 v[200:203], v8, s[8:11], s17 offen offset:0
    buffer_load_dwordx4 v[204:207], v8, s[8:11], s17 offen offset:1024
    buffer_load_dwordx4 v[208:211], v8, s[8:11], s17 offen offset:2048
    buffer_load_dwordx4 v[212:215], v8, s[8:11], s17 offen offset:3072
    s_waitcnt vmcnt(3)
    v_mfma_f32_16x16x32_bf16 v[184:187], v[200:203], v[152:155], v[216:219]
    v_mfma_f32_16x16x32_bf16 v[188:191], v[200:203], v[168:171], v[220:223]
    s_waitcnt vmcnt(2)
    v_mfma_f32_16x16x32_bf16 v[192:195], v[204:207], v[152:155], v[216:219]
    v_mfma_f32_16x16x32_bf16 v[196:199], v[204:207], v[168:171], v[220:223]
    s_waitcnt vmcnt(1)
    v_mfma_f32_16x16x32_bf16 v[184:187], v[208:211], v[156:159], v[184:187]
    v_mfma_f32_16x16x32_bf16 v[188:191], v[208:211], v[172:175], v[188:191]
    s_waitcnt vmcnt(0)
    v_mfma_f32_16x16x32_bf16 v[192:195], v[212:215], v[156:159], v[192:195]
    v_mfma_f32_16x16x32_bf16 v[196:199], v[212:215], v[172:175], v[196:199]
    s_mov_b32 s17, 0x1f000
    buffer_load_dwordx4 v[200:203], v8, s[8:11], s17 offen offset:0
    buffer_load_dwordx4 v[204:207], v8, s[8:11], s17 offen offset:1024
    buffer_load_dwordx4 v[208:211], v8, s[8:11], s17 offen offset:2048
    buffer_load_dwordx4 v[212:215], v8, s[8:11], s17 offen offset:3072
    s_waitcnt vmcnt(3)
    v_mfma_f32_16x16x32_bf16 v[184:187], v[200:203], v[160:163], v[184:187]
    v_mfma_f32_16x16x32_bf16 v[188:191], v[200:203], v[176:179], v[188:191]
    s_waitcnt vmcnt(2)
    v_mfma_f32_16x16x32_bf16 v[192:195], v[204:207], v[160:163], v[192:195]
    v_mfma_f32_16x16x32_bf16 v[196:199], v[204:207], v[176:179], v[196:199]
    s_waitcnt vmcnt(1)
    v_mfma_f32_16x16x32_bf16 v[184:187], v[208:211], v[164:167], v[184:187]
    v_mfma_f32_16x16x32_bf16 v[188:191], v[208:211], v[180:183], v[188:191]
    s_waitcnt vmcnt(0)
    v_mfma_f32_16x16x32_bf16 v[192:195], v[212:215], v[164:167], v[192:195]
    v_mfma_f32_16x16x32_bf16 v[196:199], v[212:215], v[180:183], v[196:199]
    s_nop 3
    v_exp_f32 v184, v184
    v_exp_f32 v185, v185
    v_add_f32 v9, v9, v184
    v_add_f32 v9, v9, v185
    v_cvt_pk_bf16_f32 v144, v184, v185
    v_exp_f32 v186, v186
    v_exp_f32 v187, v187
    v_add_f32 v9, v9, v186
    v_add_f32 v9, v9, v187
    v_cvt_pk_bf16_f32 v145, v186, v187
    v_exp_f32 v188, v188
    v_exp_f32 v189, v189
    v_add_f32 v10, v10, v188
    v_add_f32 v10, v10, v189
    v_cvt_pk_bf16_f32 v148, v188, v189
    v_exp_f32 v190, v190
    v_exp_f32 v191, v191
    v_add_f32 v10, v10, v190
    v_add_f32 v10, v10, v191
    v_cvt_pk_bf16_f32 v149, v190, v191
    v_exp_f32 v192, v192
    v_exp_f32 v193, v193
    v_add_f32 v9, v9, v192
    v_add_f32 v9, v9, v193
    v_cvt_pk_bf16_f32 v146, v192, v193
    v_exp_f32 v194, v194
    v_exp_f32 v195, v195
    v_add_f32 v9, v9, v194
    v_add_f32 v9, v9, v195
    v_cvt_pk_bf16_f32 v147, v194, v195
    v_exp_f32 v196, v196
    v_exp_f32 v197, v197
    v_add_f32 v10, v10, v196
    v_add_f32 v10, v10, v197
    v_cvt_pk_bf16_f32 v150, v196, v197
    v_exp_f32 v198, v198
    v_exp_f32 v199, v199
    v_add_f32 v10, v10, v198
    v_add_f32 v10, v10, v199
    v_cvt_pk_bf16_f32 v151, v198, v199
    v_mov_b32 v16, v9
    v_mov_b32 v18, v10
    s_nop 0
    v_permlane16_swap_b32 v9, v16
    v_permlane16_swap_b32 v10, v18
    v_add_f32 v9, v9, v16
    v_add_f32 v10, v10, v18
    v_mov_b32 v16, v9
    v_mov_b32 v18, v10
    s_nop 0
    v_permlane32_swap_b32 v9, v16
    v_permlane32_swap_b32 v10, v18
    v_add_f32 v9, v9, v16
    v_add_f32 v10, v10, v18
    s_waitcnt vmcnt(0) lgkmcnt(0)
    s_nop 15
    s_nop 3
    s_branch adaLN_cond__sliding_block_cached__moe_arch_mod__prompt_kernel_fixAb
adaLN_cond__sliding_block_cached__moe_arch_mod__prompt_kernel_mp5r:
    s_waitcnt vmcnt(0) lgkmcnt(0)
    s_nop 15
    s_nop 3
    s_mov_b32 s27, 0
adaLN_cond__sliding_block_cached__moe_arch_mod__prompt_kernel_mp5p:
    buffer_load_dword v248, v250, s[8:11], s14 offen sc1
    s_waitcnt vmcnt(0)
    v_cmp_ne_u32 vcc, s28, v248
    s_add_u32 s27, s27, 1
    s_cmp_ge_u32 s27, 65536
    s_cbranch_scc1 adaLN_cond__sliding_block_cached__moe_arch_mod__prompt_kernel_mp5g
    s_cbranch_vccnz adaLN_cond__sliding_block_cached__moe_arch_mod__prompt_kernel_mp5p
adaLN_cond__sliding_block_cached__moe_arch_mod__prompt_kernel_mp5g:
    s_waitcnt vmcnt(0) lgkmcnt(0)
    s_nop 15
    s_nop 3
    s_branch adaLN_cond__sliding_block_cached__moe_arch_mod__prompt_kernel_mp5b
adaLN_cond__sliding_block_cached__moe_arch_mod__prompt_kernel_o6r:
    s_waitcnt vmcnt(0) lgkmcnt(0)
    s_nop 15
    s_nop 3
    s_mov_b32 s27, 0
adaLN_cond__sliding_block_cached__moe_arch_mod__prompt_kernel_o6p:
    buffer_load_dword v12, v13, s[8:11], s19 offen sc1
    s_waitcnt vmcnt(0)
    v_cmp_ne_u32 vcc, s28, v12
    s_add_u32 s27, s27, 1
    s_cmp_ge_u32 s27, 65536
    s_cbranch_scc1 adaLN_cond__sliding_block_cached__moe_arch_mod__prompt_kernel_o6g
    s_cbranch_vccnz adaLN_cond__sliding_block_cached__moe_arch_mod__prompt_kernel_o6p
adaLN_cond__sliding_block_cached__moe_arch_mod__prompt_kernel_o6g:
    s_waitcnt vmcnt(0) lgkmcnt(0)
    s_nop 15
    s_nop 3
    s_branch adaLN_cond__sliding_block_cached__moe_arch_mod__prompt_kernel_o6b
adaLN_cond__sliding_block_cached__moe_arch_mod__prompt_kernel_o27r:
    s_waitcnt vmcnt(0) lgkmcnt(0)
    s_nop 15
    s_nop 3
    s_mov_b32 s27, 0
adaLN_cond__sliding_block_cached__moe_arch_mod__prompt_kernel_o27p:
    buffer_load_dword v12, v13, s[8:11], s19 offen sc1
    s_waitcnt vmcnt(0)
    v_cmp_ne_u32 vcc, s28, v12
    s_add_u32 s27, s27, 1
    s_cmp_ge_u32 s27, 65536
    s_cbranch_scc1 adaLN_cond__sliding_block_cached__moe_arch_mod__prompt_kernel_o27g
    s_cbranch_vccnz adaLN_cond__sliding_block_cached__moe_arch_mod__prompt_kernel_o27p
adaLN_cond__sliding_block_cached__moe_arch_mod__prompt_kernel_o27g:
    s_waitcnt vmcnt(0) lgkmcnt(0)
    s_nop 15
    s_nop 3
    s_branch adaLN_cond__sliding_block_cached__moe_arch_mod__prompt_kernel_o27b
adaLN_cond__sliding_block_cached__moe_arch_mod__prompt_kernel_o28r:
    s_waitcnt vmcnt(0) lgkmcnt(0)
    s_nop 15
    s_nop 3
    s_mov_b32 s27, 0
adaLN_cond__sliding_block_cached__moe_arch_mod__prompt_kernel_o28p:
    buffer_load_dword v12, v13, s[8:11], s19 offen sc1
    s_waitcnt vmcnt(0)
    v_cmp_ne_u32 vcc, s28, v12
    s_add_u32 s27, s27, 1
    s_cmp_ge_u32 s27, 65536
    s_cbranch_scc1 adaLN_cond__sliding_block_cached__moe_arch_mod__prompt_kernel_o28g
    s_cbranch_vccnz adaLN_cond__sliding_block_cached__moe_arch_mod__prompt_kernel_o28p
adaLN_cond__sliding_block_cached__moe_arch_mod__prompt_kernel_o28g:
    s_waitcnt vmcnt(0) lgkmcnt(0)
    s_nop 15
    s_nop 3
    s_branch adaLN_cond__sliding_block_cached__moe_arch_mod__prompt_kernel_o28b
adaLN_cond__sliding_block_cached__moe_arch_mod__prompt_kernel_o29r:
    s_waitcnt vmcnt(0) lgkmcnt(0)
    s_nop 15
    s_nop 3
    s_mov_b32 s27, 0
adaLN_cond__sliding_block_cached__moe_arch_mod__prompt_kernel_o29p:
    buffer_load_dword v12, v13, s[8:11], s19 offen sc1
    s_waitcnt vmcnt(0)
    v_cmp_ne_u32 vcc, s28, v12
    s_add_u32 s27, s27, 1
    s_cmp_ge_u32 s27, 65536
    s_cbranch_scc1 adaLN_cond__sliding_block_cached__moe_arch_mod__prompt_kernel_o29g
    s_cbranch_vccnz adaLN_cond__sliding_block_cached__moe_arch_mod__prompt_kernel_o29p
adaLN_cond__sliding_block_cached__moe_arch_mod__prompt_kernel_o29g:
    s_waitcnt vmcnt(0) lgkmcnt(0)
    s_nop 15
    s_nop 3
    s_branch adaLN_cond__sliding_block_cached__moe_arch_mod__prompt_kernel_o29b
adaLN_cond__sliding_block_cached__moe_arch_mod__prompt_kernel_mf10r:
    s_waitcnt vmcnt(0) lgkmcnt(0)
    s_nop 15
    s_nop 3
    s_mov_b32 s27, 0
adaLN_cond__sliding_block_cached__moe_arch_mod__prompt_kernel_mf10p:
    s_mov_b32 s16, 0x544000
    buffer_load_dwordx4 v[184:187], v2, s[8:11], s16 offen sc1
    s_waitcnt vmcnt(0)
    v_xor_b32 v16, s28, v184
    v_xor_b32 v17, s28, v185
    v_xor_b32 v18, s28, v186
    v_xor_b32 v19, s28, v187
    v_or3_b32 v16, v16, v17, v18
    v_or_b32 v16, v16, v19
    v_cmp_ne_u32 vcc, 0, v16
    s_add_u32 s27, s27, 1
    s_cmp_ge_u32 s27, 65536
    s_cbranch_scc1 adaLN_cond__sliding_block_cached__moe_arch_mod__prompt_kernel_mf10g
    s_cbranch_vccnz adaLN_cond__sliding_block_cached__moe_arch_mod__prompt_kernel_mf10p
adaLN_cond__sliding_block_cached__moe_arch_mod__prompt_kernel_mf10g:
    s_waitcnt vmcnt(0) lgkmcnt(0)
    s_nop 15
    s_nop 3
    s_branch adaLN_cond__sliding_block_cached__moe_arch_mod__prompt_kernel_mf10b
adaLN_cond__sliding_block_cached__moe_arch_mod__prompt_kernel_kv16r:
    s_waitcnt vmcnt(0) lgkmcnt(0)
    s_nop 15
    s_nop 3
    s_mov_b32 s27, 0
adaLN_cond__sliding_block_cached__moe_arch_mod__prompt_kernel_kv16p:
    buffer_load_dwordx4 v[12:15], v21, s[8:11], s18 offen sc1
    s_waitcnt vmcnt(0)
    v_xor_b32 v8, s28, v12
    v_xor_b32 v20, s28, v13
    v_or_b32 v8, v8, v20
    v_xor_b32 v20, s28, v14
    v_or_b32 v8, v8, v20
    v_xor_b32 v20, s28, v15
    v_or_b32 v8, v8, v20
    v_cmp_ne_u32 vcc, 0, v8
    s_add_u32 s27, s27, 1
    s_cmp_ge_u32 s27, 65536
    s_cbranch_scc1 adaLN_cond__sliding_block_cached__moe_arch_mod__prompt_kernel_kv16g
    s_cbranch_vccnz adaLN_cond__sliding_block_cached__moe_arch_mod__prompt_kernel_kv16p
adaLN_cond__sliding_block_cached__moe_arch_mod__prompt_kernel_kv16g:
    s_waitcnt vmcnt(0) lgkmcnt(0)
    s_nop 15
    s_nop 3
    s_branch adaLN_cond__sliding_block_cached__moe_arch_mod__prompt_kernel_kv16b
adaLN_cond__sliding_block_cached__moe_arch_mod__prompt_kernel_fixB:
    s_waitcnt vmcnt(0) lgkmcnt(0)
    s_nop 15
    s_nop 3
    s_lshr_b32 s16, s12, 3
    s_lshl_b32 s16, s16, 17
    s_add_u32 s16, s16, 0x400000
    v_add_u32 v8, s16, v2
    v_mov_b32 v16, 0xff7fffff
    v_mov_b32 v17, 0xff7fffff
    s_mov_b32 s16, 0
adaLN_cond__sliding_block_cached__moe_arch_mod__prompt_kernel_fixBm:
    s_add_u32 s17, s16, 0
    buffer_load_dwordx4 v[200:203], v8, s[8:11], s17 offen offset:0
    buffer_load_dwordx4 v[204:207], v8, s[8:11], s17 offen offset:1024
    buffer_load_dwordx4 v[208:211], v8, s[8:11], s17 offen offset:2048
    buffer_load_dwordx4 v[212:215], v8, s[8:11], s17 offen offset:3072
    s_waitcnt vmcnt(3)
    v_mfma_f32_16x16x32_bf16 v[184:187], v[200:203], v[152:155], 0
    v_mfma_f32_16x16x32_bf16 v[188:191], v[200:203], v[168:171], 0
    s_waitcnt vmcnt(2)
    v_mfma_f32_16x16x32_bf16 v[192:195], v[204:207], v[152:155], 0
    v_mfma_f32_16x16x32_bf16 v[196:199], v[204:207], v[168:171], 0
    s_waitcnt vmcnt(1)
    v_mfma_f32_16x16x32_bf16 v[184:187], v[208:211], v[156:159], v[184:187]
    v_mfma_f32_16x16x32_bf16 v[188:191], v[208:211], v[172:175], v[188:191]
    s_waitcnt vmcnt(0)
    v_mfma_f32_16x16x32_bf16 v[192:195], v[212:215], v[156:159], v[192:195]
    v_mfma_f32_16x16x32_bf16 v[196:199], v[212:215], v[172:175], v[196:199]
    s_add_u32 s17, s16, 4096
    buffer_load_dwordx4 v[200:203], v8, s[8:11], s17 offen offset:0
    buffer_load_dwordx4 v[204:207], v8, s[8:11], s17 offen offset:1024
    buffer_load_dwordx4 v[208:211], v8, s[8:11], s17 offen offset:2048
    buffer_load_dwordx4 v[212:215], v8, s[8:11], s17 offen offset:3072
    s_waitcnt vmcnt(3)
    v_mfma_f32_16x16x32_bf16 v[184:187], v[200:203], v[160:163], v[184:187]
    v_mfma_f32_16x16x32_bf16 v[188:191], v[200:203], v[176:179], v[188:191]
    s_waitcnt vmcnt(2)
    v_mfma_f32_16x16x32_bf16 v[192:195], v[204:207], v[160:163], v[192:195]
    v_mfma_f32_16x16x32_bf16 v[196:199], v[204:207], v[176:179], v[196:199]
    s_waitcnt vmcnt(1)
    v_mfma_f32_16x16x32_bf16 v[184:187], v[208:211], v[164:167], v[184:187]
    v_mfma_f32_16x16x32_bf16 v[188:191], v[208:211], v[180:183], v[188:191]
    s_waitcnt vmcnt(0)
    v_mfma_f32_16x16x32_bf16 v[192:195], v[212:215], v[164:167], v[192:195]
    v_mfma_f32_16x16x32_bf16 v[196:199], v[212:215], v[180:183], v[196:199]
    s_nop 3
    v_max3_f32 v16, v16, v184, v185
    v_max3_f32 v16, v16, v186, v187
    v_max3_f32 v17, v17, v188, v189
    v_max3_f32 v17, v17, v190, v191
    v_max3_f32 v16, v16, v192, v193
    v_max3_f32 v16, v16, v194, v195
    v_max3_f32 v17, v17, v196, v197
    v_max3_f32 v17, v17, v198, v199
    s_add_u32 s16, s16, 8192
    s_cmp_lt_u32 s16, 0x20000
    s_cbranch_scc1 adaLN_cond__sliding_block_cached__moe_arch_mod__prompt_kernel_fixBm
    v_mov_b32 v18, v16
    v_mov_b32 v19, v17
    s_nop 0
    v_permlane16_swap_b32 v16, v18
    v_permlane16_swap_b32 v17, v19
    v_max_f32 v16, v16, v18
    v_max_f32 v17, v17, v19
    v_mov_b32 v18, v16
    v_mov_b32 v19, v17
    s_nop 0
    v_permlane32_swap_b32 v16, v18
    v_permlane32_swap_b32 v17, v19
    v_max_f32 v16, v16, v18
    v_max_f32 v17, v17, v19
    v_sub_f32 v216, 0, v16
    v_sub_f32 v217, 0, v16
    v_sub_f32 v218, 0, v16
    v_sub_f32 v219, 0, v16
    v_sub_f32 v220, 0, v17
    v_sub_f32 v221, 0, v17
    v_sub_f32 v222, 0, v17
    v_sub_f32 v223, 0, v17
    s_mov_b32 s17, 0x0
    buffer_load_dwordx4 v[200:203], v8, s[8:11], s17 offen offset:0
    buffer_load_dwordx4 v[204:207], v8, s[8:11], s17 offen offset:1024
    buffer_load_dwordx4 v[208:211], v8, s[8:11], s17 offen offset:2048
    buffer_load_dwordx4 v[212:215], v8, s[8:11], s17 offen offset:3072
    s_waitcnt vmcnt(3)
    v_mfma_f32_16x16x32_bf16 v[184:187], v[200:203], v[152:155], v[216:219]
    v_mfma_f32_16x16x32_bf16 v[188:191], v[200:203], v[168:171], v[220:223]
    s_waitcnt vmcnt(2)
    v_mfma_f32_16x16x32_bf16 v[192:195], v[204:207], v[152:155], v[216:219]
    v_mfma_f32_16x16x32_bf16 v[196:199], v[204:207], v[168:171], v[220:223]
    s_waitcnt vmcnt(1)
    v_mfma_f32_16x16x32_bf16 v[184:187], v[208:211], v[156:159], v[184:187]
    v_mfma_f32_16x16x32_bf16 v[188:191], v[208:211], v[172:175], v[188:191]
    s_waitcnt vmcnt(0)
    v_mfma_f32_16x16x32_bf16 v[192:195], v[212:215], v[156:159], v[192:195]
    v_mfma_f32_16x16x32_bf16 v[196:199], v[212:215], v[172:175], v[196:199]
    s_mov_b32 s17, 0x1000
    buffer_load_dwordx4 v[200:203], v8, s[8:11], s17 offen offset:0
    buffer_load_dwordx4 v[204:207], v8, s[8:11], s17 offen offset:1024
    buffer_load_dwordx4 v[208:211], v8, s[8:11], s17 offen offset:2048
    buffer_load_dwordx4 v[212:215], v8, s[8:11], s17 offen offset:3072
    s_waitcnt vmcnt(3)
    v_mfma_f32_16x16x32_bf16 v[184:187], v[200:203], v[160:163], v[184:187]
    v_mfma_f32_16x16x32_bf16 v[188:191], v[200:203], v[176:179], v[188:191]
    s_waitcnt vmcnt(2)
    v_mfma_f32_16x16x32_bf16 v[192:195], v[204:207], v[160:163], v[192:195]
    v_mfma_f32_16x16x32_bf16 v[196:199], v[204:207], v[176:179], v[196:199]
    s_waitcnt vmcnt(1)
    v_mfma_f32_16x16x32_bf16 v[184:187], v[208:211], v[164:167], v[184:187]
    v_mfma_f32_16x16x32_bf16 v[188:191], v[208:211], v[180:183], v[188:191]
    s_waitcnt vmcnt(0)
    v_mfma_f32_16x16x32_bf16 v[192:195], v[212:215], v[164:167], v[192:195]
    v_mfma_f32_16x16x32_bf16 v[196:199], v[212:215], v[180:183], v[196:199]
    s_nop 3
    v_exp_f32 v184, v184
    v_exp_f32 v185, v185
    s_nop 0
    v_add_f32 v9, v184, v185
    v_cvt_pk_bf16_f32 v24, v184, v185
    v_exp_f32 v186, v186
    v_exp_f32 v187, v187
    v_add_f32 v9, v9, v186
    v_add_f32 v9, v9, v187
    v_cvt_pk_bf16_f32 v25, v186, v187
    v_exp_f32 v188, v188
    v_exp_f32 v189, v189
    s_nop 0
    v_add_f32 v10, v188, v189
    v_cvt_pk_bf16_f32 v28, v188, v189
    v_exp_f32 v190, v190
    v_exp_f32 v191, v191
    v_add_f32 v10, v10, v190
    v_add_f32 v10, v10, v191
    v_cvt_pk_bf16_f32 v29, v190, v191
    v_exp_f32 v192, v192
    v_exp_f32 v193, v193
    v_add_f32 v9, v9, v192
    v_add_f32 v9, v9, v193
    v_cvt_pk_bf16_f32 v26, v192, v193
    v_exp_f32 v194, v194
    v_exp_f32 v195, v195
    v_add_f32 v9, v9, v194
    v_add_f32 v9, v9, v195
    v_cvt_pk_bf16_f32 v27, v194, v195
    v_exp_f32 v196, v196
    v_exp_f32 v197, v197
    v_add_f32 v10, v10, v196
    v_add_f32 v10, v10, v197
    v_cvt_pk_bf16_f32 v30, v196, v197
    v_exp_f32 v198, v198
    v_exp_f32 v199, v199
    v_add_f32 v10, v10, v198
    v_add_f32 v10, v10, v199
    v_cvt_pk_bf16_f32 v31, v198, v199
    s_mov_b32 s17, 0x2000
    buffer_load_dwordx4 v[200:203], v8, s[8:11], s17 offen offset:0
    buffer_load_dwordx4 v[204:207], v8, s[8:11], s17 offen offset:1024
    buffer_load_dwordx4 v[208:211], v8, s[8:11], s17 offen offset:2048
    buffer_load_dwordx4 v[212:215], v8, s[8:11], s17 offen offset:3072
    s_waitcnt vmcnt(3)
    v_mfma_f32_16x16x32_bf16 v[184:187], v[200:203], v[152:155], v[216:219]
    v_mfma_f32_16x16x32_bf16 v[188:191], v[200:203], v[168:171], v[220:223]
    s_waitcnt vmcnt(2)
    v_mfma_f32_16x16x32_bf16 v[192:195], v[204:207], v[152:155], v[216:219]
    v_mfma_f32_16x16x32_bf16 v[196:199], v[204:207], v[168:171], v[220:223]
    s_waitcnt vmcnt(1)
    v_mfma_f32_16x16x32_bf16 v[184:187], v[208:211], v[156:159], v[184:187]
    v_mfma_f32_16x16x32_bf16 v[188:191], v[208:211], v[172:175], v[188:191]
    s_waitcnt vmcnt(0)
    v_mfma_f32_16x16x32_bf16 v[192:195], v[212:215], v[156:159], v[192:195]
    v_mfma_f32_16x16x32_bf16 v[196:199], v[212:215], v[172:175], v[196:199]
    s_mov_b32 s17, 0x3000
    buffer_load_dwordx4 v[200:203], v8, s[8:11], s17 offen offset:0
    buffer_load_dwordx4 v[204:207], v8, s[8:11], s17 offen offset:1024
    buffer_load_dwordx4 v[208:211], v8, s[8:11], s17 offen offset:2048
    buffer_load_dwordx4 v[212:215], v8, s[8:11], s17 offen offset:3072
    s_waitcnt vmcnt(3)
    v_mfma_f32_16x16x32_bf16 v[184:187], v[200:203], v[160:163], v[184:187]
    v_mfma_f32_16x16x32_bf16 v[188:191], v[200:203], v[176:179], v[188:191]
    s_waitcnt vmcnt(2)
    v_mfma_f32_16x16x32_bf16 v[192:195], v[204:207], v[160:163], v[192:195]
    v_mfma_f32_16x16x32_bf16 v[196:199], v[204:207], v[176:179], v[196:199]
    s_waitcnt vmcnt(1)
    v_mfma_f32_16x16x32_bf16 v[184:187], v[208:211], v[164:167], v[184:187]
    v_mfma_f32_16x16x32_bf16 v[188:191], v[208:211], v[180:183], v[188:191]
    s_waitcnt vmcnt(0)
    v_mfma_f32_16x16x32_bf16 v[192:195], v[212:215], v[164:167], v[192:195]
    v_mfma_f32_16x16x32_bf16 v[196:199], v[212:215], v[180:183], v[196:199]
    s_nop 3
    v_exp_f32 v184, v184
    v_exp_f32 v185, v185
    v_add_f32 v9, v9, v184
    v_add_f32 v9, v9, v185
    v_cvt_pk_bf16_f32 v32, v184, v185
    v_exp_f32 v186, v186
    v_exp_f32 v187, v187
    v_add_f32 v9, v9, v186
    v_add_f32 v9, v9, v187
    v_cvt_pk_bf16_f32 v33, v186, v187
    v_exp_f32 v188, v188
    v_exp_f32 v189, v189
    v_add_f32 v10, v10, v188
    v_add_f32 v10, v10, v189
    v_cvt_pk_bf16_f32 v36, v188, v189
    v_exp_f32 v190, v190
    v_exp_f32 v191, v191
    v_add_f32 v10, v10, v190
    v_add_f32 v10, v10, v191
    v_cvt_pk_bf16_f32 v37, v190, v191
    v_exp_f32 v192, v192
    v_exp_f32 v193, v193
    v_add_f32 v9, v9, v192
    v_add_f32 v9, v9, v193
    v_cvt_pk_bf16_f32 v34, v192, v193
    v_exp_f32 v194, v194
    v_exp_f32 v195, v195
    v_add_f32 v9, v9, v194
    v_add_f32 v9, v9, v195
    v_cvt_pk_bf16_f32 v35, v194, v195
    v_exp_f32 v196, v196
    v_exp_f32 v197, v197
    v_add_f32 v10, v10, v196
    v_add_f32 v10, v10, v197
    v_cvt_pk_bf16_f32 v38, v196, v197
    v_exp_f32 v198, v198
    v_exp_f32 v199, v199
    v_add_f32 v10, v10, v198
    v_add_f32 v10, v10, v199
    v_cvt_pk_bf16_f32 v39, v198, v199
    s_mov_b32 s17, 0x4000
    buffer_load_dwordx4 v[200:203], v8, s[8:11], s17 offen offset:0
    buffer_load_dwordx4 v[204:207], v8, s[8:11], s17 offen offset:1024
    buffer_load_dwordx4 v[208:211], v8, s[8:11], s17 offen offset:2048
    buffer_load_dwordx4 v[212:215], v8, s[8:11], s17 offen offset:3072
    s_waitcnt vmcnt(3)
    v_mfma_f32_16x16x32_bf16 v[184:187], v[200:203], v[152:155], v[216:219]
    v_mfma_f32_16x16x32_bf16 v[188:191], v[200:203], v[168:171], v[220:223]
    s_waitcnt vmcnt(2)
    v_mfma_f32_16x16x32_bf16 v[192:195], v[204:207], v[152:155], v[216:219]
    v_mfma_f32_16x16x32_bf16 v[196:199], v[204:207], v[168:171], v[220:223]
    s_waitcnt vmcnt(1)
    v_mfma_f32_16x16x32_bf16 v[184:187], v[208:211], v[156:159], v[184:187]
    v_mfma_f32_16x16x32_bf16 v[188:191], v[208:211], v[172:175], v[188:191]
    s_waitcnt vmcnt(0)
    v_mfma_f32_16x16x32_bf16 v[192:195], v[212:215], v[156:159], v[192:195]
    v_mfma_f32_16x16x32_bf16 v[196:199], v[212:215], v[172:175], v[196:199]
    s_mov_b32 s17, 0x5000
    buffer_load_dwordx4 v[200:203], v8, s[8:11], s17 offen offset:0
    buffer_load_dwordx4 v[204:207], v8, s[8:11], s17 offen offset:1024
    buffer_load_dwordx4 v[208:211], v8, s[8:11], s17 offen offset:2048
    buffer_load_dwordx4 v[212:215], v8, s[8:11], s17 offen offset:3072
    s_waitcnt vmcnt(3)
    v_mfma_f32_16x16x32_bf16 v[184:187], v[200:203], v[160:163], v[184:187]
    v_mfma_f32_16x16x32_bf16 v[188:191], v[200:203], v[176:179], v[188:191]
    s_waitcnt vmcnt(2)
    v_mfma_f32_16x16x32_bf16 v[192:195], v[204:207], v[160:163], v[192:195]
    v_mfma_f32_16x16x32_bf16 v[196:199], v[204:207], v[176:179], v[196:199]
    s_waitcnt vmcnt(1)
    v_mfma_f32_16x16x32_bf16 v[184:187], v[208:211], v[164:167], v[184:187]
    v_mfma_f32_16x16x32_bf16 v[188:191], v[208:211], v[180:183], v[188:191]
    s_waitcnt vmcnt(0)
    v_mfma_f32_16x16x32_bf16 v[192:195], v[212:215], v[164:167], v[192:195]
    v_mfma_f32_16x16x32_bf16 v[196:199], v[212:215], v[180:183], v[196:199]
    s_nop 3
    v_exp_f32 v184, v184
    v_exp_f32 v185, v185
    v_add_f32 v9, v9, v184
    v_add_f32 v9, v9, v185
    v_cvt_pk_bf16_f32 v40, v184, v185
    v_exp_f32 v186, v186
    v_exp_f32 v187, v187
    v_add_f32 v9, v9, v186
    v_add_f32 v9, v9, v187
    v_cvt_pk_bf16_f32 v41, v186, v187
    v_exp_f32 v188, v188
    v_exp_f32 v189, v189
    v_add_f32 v10, v10, v188
    v_add_f32 v10, v10, v189
    v_cvt_pk_bf16_f32 v44, v188, v189
    v_exp_f32 v190, v190
    v_exp_f32 v191, v191
    v_add_f32 v10, v10, v190
    v_add_f32 v10, v10, v191
    v_cvt_pk_bf16_f32 v45, v190, v191
    v_exp_f32 v192, v192
    v_exp_f32 v193, v193
    v_add_f32 v9, v9, v192
    v_add_f32 v9, v9, v193
    v_cvt_pk_bf16_f32 v42, v192, v193
    v_exp_f32 v194, v194
    v_exp_f32 v195, v195
    v_add_f32 v9, v9, v194
    v_add_f32 v9, v9, v195
    v_cvt_pk_bf16_f32 v43, v194, v195
    v_exp_f32 v196, v196
    v_exp_f32 v197, v197
    v_add_f32 v10, v10, v196
    v_add_f32 v10, v10, v197
    v_cvt_pk_bf16_f32 v46, v196, v197
    v_exp_f32 v198, v198
    v_exp_f32 v199, v199
    v_add_f32 v10, v10, v198
    v_add_f32 v10, v10, v199
    v_cvt_pk_bf16_f32 v47, v198, v199
    s_mov_b32 s17, 0x6000
    buffer_load_dwordx4 v[200:203], v8, s[8:11], s17 offen offset:0
    buffer_load_dwordx4 v[204:207], v8, s[8:11], s17 offen offset:1024
    buffer_load_dwordx4 v[208:211], v8, s[8:11], s17 offen offset:2048
    buffer_load_dwordx4 v[212:215], v8, s[8:11], s17 offen offset:3072
    s_waitcnt vmcnt(3)
    v_mfma_f32_16x16x32_bf16 v[184:187], v[200:203], v[152:155], v[216:219]
    v_mfma_f32_16x16x32_bf16 v[188:191], v[200:203], v[168:171], v[220:223]
    s_waitcnt vmcnt(2)
    v_mfma_f32_16x16x32_bf16 v[192:195], v[204:207], v[152:155], v[216:219]
    v_mfma_f32_16x16x32_bf16 v[196:199], v[204:207], v[168:171], v[220:223]
    s_waitcnt vmcnt(1)
    v_mfma_f32_16x16x32_bf16 v[184:187], v[208:211], v[156:159], v[184:187]
    v_mfma_f32_16x16x32_bf16 v[188:191], v[208:211], v[172:175], v[188:191]
    s_waitcnt vmcnt(0)
    v_mfma_f32_16x16x32_bf16 v[192:195], v[212:215], v[156:159], v[192:195]
    v_mfma_f32_16x16x32_bf16 v[196:199], v[212:215], v[172:175], v[196:199]
    s_mov_b32 s17, 0x7000
    buffer_load_dwordx4 v[200:203], v8, s[8:11], s17 offen offset:0
    buffer_load_dwordx4 v[204:207], v8, s[8:11], s17 offen offset:1024
    buffer_load_dwordx4 v[208:211], v8, s[8:11], s17 offen offset:2048
    buffer_load_dwordx4 v[212:215], v8, s[8:11], s17 offen offset:3072
    s_waitcnt vmcnt(3)
    v_mfma_f32_16x16x32_bf16 v[184:187], v[200:203], v[160:163], v[184:187]
    v_mfma_f32_16x16x32_bf16 v[188:191], v[200:203], v[176:179], v[188:191]
    s_waitcnt vmcnt(2)
    v_mfma_f32_16x16x32_bf16 v[192:195], v[204:207], v[160:163], v[192:195]
    v_mfma_f32_16x16x32_bf16 v[196:199], v[204:207], v[176:179], v[196:199]
    s_waitcnt vmcnt(1)
    v_mfma_f32_16x16x32_bf16 v[184:187], v[208:211], v[164:167], v[184:187]
    v_mfma_f32_16x16x32_bf16 v[188:191], v[208:211], v[180:183], v[188:191]
    s_waitcnt vmcnt(0)
    v_mfma_f32_16x16x32_bf16 v[192:195], v[212:215], v[164:167], v[192:195]
    v_mfma_f32_16x16x32_bf16 v[196:199], v[212:215], v[180:183], v[196:199]
    s_nop 3
    v_exp_f32 v184, v184
    v_exp_f32 v185, v185
    v_add_f32 v9, v9, v184
    v_add_f32 v9, v9, v185
    v_cvt_pk_bf16_f32 v48, v184, v185
    v_exp_f32 v186, v186
    v_exp_f32 v187, v187
    v_add_f32 v9, v9, v186
    v_add_f32 v9, v9, v187
    v_cvt_pk_bf16_f32 v49, v186, v187
    v_exp_f32 v188, v188
    v_exp_f32 v189, v189
    v_add_f32 v10, v10, v188
    v_add_f32 v10, v10, v189
    v_cvt_pk_bf16_f32 v52, v188, v189
    v_exp_f32 v190, v190
    v_exp_f32 v191, v191
    v_add_f32 v10, v10, v190
    v_add_f32 v10, v10, v191
    v_cvt_pk_bf16_f32 v53, v190, v191
    v_exp_f32 v192, v192
    v_exp_f32 v193, v193
    v_add_f32 v9, v9, v192
    v_add_f32 v9, v9, v193
    v_cvt_pk_bf16_f32 v50, v192, v193
    v_exp_f32 v194, v194
    v_exp_f32 v195, v195
    v_add_f32 v9, v9, v194
    v_add_f32 v9, v9, v195
    v_cvt_pk_bf16_f32 v51, v194, v195
    v_exp_f32 v196, v196
    v_exp_f32 v197, v197
    v_add_f32 v10, v10, v196
    v_add_f32 v10, v10, v197
    v_cvt_pk_bf16_f32 v54, v196, v197
    v_exp_f32 v198, v198
    v_exp_f32 v199, v199
    v_add_f32 v10, v10, v198
    v_add_f32 v10, v10, v199
    v_cvt_pk_bf16_f32 v55, v198, v199
    s_mov_b32 s17, 0x8000
    buffer_load_dwordx4 v[200:203], v8, s[8:11], s17 offen offset:0
    buffer_load_dwordx4 v[204:207], v8, s[8:11], s17 offen offset:1024
    buffer_load_dwordx4 v[208:211], v8, s[8:11], s17 offen offset:2048
    buffer_load_dwordx4 v[212:215], v8, s[8:11], s17 offen offset:3072
    s_waitcnt vmcnt(3)
    v_mfma_f32_16x16x32_bf16 v[184:187], v[200:203], v[152:155], v[216:219]
    v_mfma_f32_16x16x32_bf16 v[188:191], v[200:203], v[168:171], v[220:223]
    s_waitcnt vmcnt(2)
    v_mfma_f32_16x16x32_bf16 v[192:195], v[204:207], v[152:155], v[216:219]
    v_mfma_f32_16x16x32_bf16 v[196:199], v[204:207], v[168:171], v[220:223]
    s_waitcnt vmcnt(1)
    v_mfma_f32_16x16x32_bf16 v[184:187], v[208:211], v[156:159], v[184:187]
    v_mfma_f32_16x16x32_bf16 v[188:191], v[208:211], v[172:175], v[188:191]
    s_waitcnt vmcnt(0)
    v_mfma_f32_16x16x32_bf16 v[192:195], v[212:215], v[156:159], v[192:195]
    v_mfma_f32_16x16x32_bf16 v[196:199], v[212:215], v[172:175], v[196:199]
    s_mov_b32 s17, 0x9000
    buffer_load_dwordx4 v[200:203], v8, s[8:11], s17 offen offset:0
    buffer_load_dwordx4 v[204:207], v8, s[8:11], s17 offen offset:1024
    buffer_load_dwordx4 v[208:211], v8, s[8:11], s17 offen offset:2048
    buffer_load_dwordx4 v[212:215], v8, s[8:11], s17 offen offset:3072
    s_waitcnt vmcnt(3)
    v_mfma_f32_16x16x32_bf16 v[184:187], v[200:203], v[160:163], v[184:187]
    v_mfma_f32_16x16x32_bf16 v[188:191], v[200:203], v[176:179], v[188:191]
    s_waitcnt vmcnt(2)
    v_mfma_f32_16x16x32_bf16 v[192:195], v[204:207], v[160:163], v[192:195]
    v_mfma_f32_16x16x32_bf16 v[196:199], v[204:207], v[176:179], v[196:199]
    s_waitcnt vmcnt(1)
    v_mfma_f32_16x16x32_bf16 v[184:187], v[208:211], v[164:167], v[184:187]
    v_mfma_f32_16x16x32_bf16 v[188:191], v[208:211], v[180:183], v[188:191]
    s_waitcnt vmcnt(0)
    v_mfma_f32_16x16x32_bf16 v[192:195], v[212:215], v[164:167], v[192:195]
    v_mfma_f32_16x16x32_bf16 v[196:199], v[212:215], v[180:183], v[196:199]
    s_nop 3
    v_exp_f32 v184, v184
    v_exp_f32 v185, v185
    v_add_f32 v9, v9, v184
    v_add_f32 v9, v9, v185
    v_cvt_pk_bf16_f32 v56, v184, v185
    v_exp_f32 v186, v186
    v_exp_f32 v187, v187
    v_add_f32 v9, v9, v186
    v_add_f32 v9, v9, v187
    v_cvt_pk_bf16_f32 v57, v186, v187
    v_exp_f32 v188, v188
    v_exp_f32 v189, v189
    v_add_f32 v10, v10, v188
    v_add_f32 v10, v10, v189
    v_cvt_pk_bf16_f32 v60, v188, v189
    v_exp_f32 v190, v190
    v_exp_f32 v191, v191
    v_add_f32 v10, v10, v190
    v_add_f32 v10, v10, v191
    v_cvt_pk_bf16_f32 v61, v190, v191
    v_exp_f32 v192, v192
    v_exp_f32 v193, v193
    v_add_f32 v9, v9, v192
    v_add_f32 v9, v9, v193
    v_cvt_pk_bf16_f32 v58, v192, v193
    v_exp_f32 v194, v194
    v_exp_f32 v195, v195
    v_add_f32 v9, v9, v194
    v_add_f32 v9, v9, v195
    v_cvt_pk_bf16_f32 v59, v194, v195
    v_exp_f32 v196, v196
    v_exp_f32 v197, v197
    v_add_f32 v10, v10, v196
    v_add_f32 v10, v10, v197
    v_cvt_pk_bf16_f32 v62, v196, v197
    v_exp_f32 v198, v198
    v_exp_f32 v199, v199
    v_add_f32 v10, v10, v198
    v_add_f32 v10, v10, v199
    v_cvt_pk_bf16_f32 v63, v198, v199
    s_mov_b32 s17, 0xa000
    buffer_load_dwordx4 v[200:203], v8, s[8:11], s17 offen offset:0
    buffer_load_dwordx4 v[204:207], v8, s[8:11], s17 offen offset:1024
    buffer_load_dwordx4 v[208:211], v8, s[8:11], s17 offen offset:2048
    buffer_load_dwordx4 v[212:215], v8, s[8:11], s17 offen offset:3072
    s_waitcnt vmcnt(3)
    v_mfma_f32_16x16x32_bf16 v[184:187], v[200:203], v[152:155], v[216:219]
    v_mfma_f32_16x16x32_bf16 v[188:191], v[200:203], v[168:171], v[220:223]
    s_waitcnt vmcnt(2)
    v_mfma_f32_16x16x32_bf16 v[192:195], v[204:207], v[152:155], v[216:219]
    v_mfma_f32_16x16x32_bf16 v[196:199], v[204:207], v[168:171], v[220:223]
    s_waitcnt vmcnt(1)
    v_mfma_f32_16x16x32_bf16 v[184:187], v[208:211], v[156:159], v[184:187]
    v_mfma_f32_16x16x32_bf16 v[188:191], v[208:211], v[172:175], v[188:191]
    s_waitcnt vmcnt(0)
    v_mfma_f32_16x16x32_bf16 v[192:195], v[212:215], v[156:159], v[192:195]
    v_mfma_f32_16x16x32_bf16 v[196:199], v[212:215], v[172:175], v[196:199]
    s_mov_b32 s17, 0xb000
    buffer_load_dwordx4 v[200:203], v8, s[8:11], s17 offen offset:0
    buffer_load_dwordx4 v[204:207], v8, s[8:11], s17 offen offset:1024
    buffer_load_dwordx4 v[208:211], v8, s[8:11], s17 offen offset:2048
    buffer_load_dwordx4 v[212:215], v8, s[8:11], s17 offen offset:3072
    s_waitcnt vmcnt(3)
    v_mfma_f32_16x16x32_bf16 v[184:187], v[200:203], v[160:163], v[184:187]
    v_mfma_f32_16x16x32_bf16 v[188:191], v[200:203], v[176:179], v[188:191]
    s_waitcnt vmcnt(2)
    v_mfma_f32_16x16x32_bf16 v[192:195], v[204:207], v[160:163], v[192:195]
    v_mfma_f32_16x16x32_bf16 v[196:199], v[204:207], v[176:179], v[196:199]
    s_waitcnt vmcnt(1)
    v_mfma_f32_16x16x32_bf16 v[184:187], v[208:211], v[164:167], v[184:187]
    v_mfma_f32_16x16x32_bf16 v[188:191], v[208:211], v[180:183], v[188:191]
    s_waitcnt vmcnt(0)
    v_mfma_f32_16x16x32_bf16 v[192:195], v[212:215], v[164:167], v[192:195]
    v_mfma_f32_16x16x32_bf16 v[196:199], v[212:215], v[180:183], v[196:199]
    s_nop 3
    v_exp_f32 v184, v184
    v_exp_f32 v185, v185
    v_add_f32 v9, v9, v184
    v_add_f32 v9, v9, v185
    v_cvt_pk_bf16_f32 v64, v184, v185
    v_exp_f32 v186, v186
    v_exp_f32 v187, v187
    v_add_f32 v9, v9, v186
    v_add_f32 v9, v9, v187
    v_cvt_pk_bf16_f32 v65, v186, v187
    v_exp_f32 v188, v188
    v_exp_f32 v189, v189
    v_add_f32 v10, v10, v188
    v_add_f32 v10, v10, v189
    v_cvt_pk_bf16_f32 v68, v188, v189
    v_exp_f32 v190, v190
    v_exp_f32 v191, v191
    v_add_f32 v10, v10, v190
    v_add_f32 v10, v10, v191
    v_cvt_pk_bf16_f32 v69, v190, v191
    v_exp_f32 v192, v192
    v_exp_f32 v193, v193
    v_add_f32 v9, v9, v192
    v_add_f32 v9, v9, v193
    v_cvt_pk_bf16_f32 v66, v192, v193
    v_exp_f32 v194, v194
    v_exp_f32 v195, v195
    v_add_f32 v9, v9, v194
    v_add_f32 v9, v9, v195
    v_cvt_pk_bf16_f32 v67, v194, v195
    v_exp_f32 v196, v196
    v_exp_f32 v197, v197
    v_add_f32 v10, v10, v196
    v_add_f32 v10, v10, v197
    v_cvt_pk_bf16_f32 v70, v196, v197
    v_exp_f32 v198, v198
    v_exp_f32 v199, v199
    v_add_f32 v10, v10, v198
    v_add_f32 v10, v10, v199
    v_cvt_pk_bf16_f32 v71, v198, v199
    s_mov_b32 s17, 0xc000
    buffer_load_dwordx4 v[200:203], v8, s[8:11], s17 offen offset:0
    buffer_load_dwordx4 v[204:207], v8, s[8:11], s17 offen offset:1024
    buffer_load_dwordx4 v[208:211], v8, s[8:11], s17 offen offset:2048
    buffer_load_dwordx4 v[212:215], v8, s[8:11], s17 offen offset:3072
    s_waitcnt vmcnt(3)
    v_mfma_f32_16x16x32_bf16 v[184:187], v[200:203], v[152:155], v[216:219]
    v_mfma_f32_16x16x32_bf16 v[188:191], v[200:203], v[168:171], v[220:223]
    s_waitcnt vmcnt(2)
    v_mfma_f32_16x16x32_bf16 v[192:195], v[204:207], v[152:155], v[216:219]
    v_mfma_f32_16x16x32_bf16 v[196:199], v[204:207], v[168:171], v[220:223]
    s_waitcnt vmcnt(1)
    v_mfma_f32_16x16x32_bf16 v[184:187], v[208:211], v[156:159], v[184:187]
    v_mfma_f32_16x16x32_bf16 v[188:191], v[208:211], v[172:175], v[188:191]
    s_waitcnt vmcnt(0)
    v_mfma_f32_16x16x32_bf16 v[192:195], v[212:215], v[156:159], v[192:195]
    v_mfma_f32_16x16x32_bf16 v[196:199], v[212:215], v[172:175], v[196:199]
    s_mov_b32 s17, 0xd000
    buffer_load_dwordx4 v[200:203], v8, s[8:11], s17 offen offset:0
    buffer_load_dwordx4 v[204:207], v8, s[8:11], s17 offen offset:1024
    buffer_load_dwordx4 v[208:211], v8, s[8:11], s17 offen offset:2048
    buffer_load_dwordx4 v[212:215], v8, s[8:11], s17 offen offset:3072
    s_waitcnt vmcnt(3)
    v_mfma_f32_16x16x32_bf16 v[184:187], v[200:203], v[160:163], v[184:187]
    v_mfma_f32_16x16x32_bf16 v[188:191], v[200:203], v[176:179], v[188:191]
    s_waitcnt vmcnt(2)
    v_mfma_f32_16x16x32_bf16 v[192:195], v[204:207], v[160:163], v[192:195]
    v_mfma_f32_16x16x32_bf16 v[196:199], v[204:207], v[176:179], v[196:199]
    s_waitcnt vmcnt(1)
    v_mfma_f32_16x16x32_bf16 v[184:187], v[208:211], v[164:167], v[184:187]
    v_mfma_f32_16x16x32_bf16 v[188:191], v[208:211], v[180:183], v[188:191]
    s_waitcnt vmcnt(0)
    v_mfma_f32_16x16x32_bf16 v[192:195], v[212:215], v[164:167], v[192:195]
    v_mfma_f32_16x16x32_bf16 v[196:199], v[212:215], v[180:183], v[196:199]
    s_nop 3
    v_exp_f32 v184, v184
    v_exp_f32 v185, v185
    v_add_f32 v9, v9, v184
    v_add_f32 v9, v9, v185
    v_cvt_pk_bf16_f32 v72, v184, v185
    v_exp_f32 v186, v186
    v_exp_f32 v187, v187
    v_add_f32 v9, v9, v186
    v_add_f32 v9, v9, v187
    v_cvt_pk_bf16_f32 v73, v186, v187
    v_exp_f32 v188, v188
    v_exp_f32 v189, v189
    v_add_f32 v10, v10, v188
    v_add_f32 v10, v10, v189
    v_cvt_pk_bf16_f32 v76, v188, v189
    v_exp_f32 v190, v190
    v_exp_f32 v191, v191
    v_add_f32 v10, v10, v190
    v_add_f32 v10, v10, v191
    v_cvt_pk_bf16_f32 v77, v190, v191
    v_exp_f32 v192, v192
    v_exp_f32 v193, v193
    v_add_f32 v9, v9, v192
    v_add_f32 v9, v9, v193
    v_cvt_pk_bf16_f32 v74, v192, v193
    v_exp_f32 v194, v194
    v_exp_f32 v195, v195
    v_add_f32 v9, v9, v194
    v_add_f32 v9, v9, v195
    v_cvt_pk_bf16_f32 v75, v194, v195
    v_exp_f32 v196, v196
    v_exp_f32 v197, v197
    v_add_f32 v10, v10, v196
    v_add_f32 v10, v10, v197
    v_cvt_pk_bf16_f32 v78, v196, v197
    v_exp_f32 v198, v198
    v_exp_f32 v199, v199
    v_add_f32 v10, v10, v198
    v_add_f32 v10, v10, v199
    v_cvt_pk_bf16_f32 v79, v198, v199
    s_mov_b32 s17, 0xe000
    buffer_load_dwordx4 v[200:203], v8, s[8:11], s17 offen offset:0
    buffer_load_dwordx4 v[204:207], v8, s[8:11], s17 offen offset:1024
    buffer_load_dwordx4 v[208:211], v8, s[8:11], s17 offen offset:2048
    buffer_load_dwordx4 v[212:215], v8, s[8:11], s17 offen offset:3072
    s_waitcnt vmcnt(3)
    v_mfma_f32_16x16x32_bf16 v[184:187], v[200:203], v[152:155], v[216:219]
    v_mfma_f32_16x16x32_bf16 v[188:191], v[200:203], v[168:171], v[220:223]
    s_waitcnt vmcnt(2)
    v_mfma_f32_16x16x32_bf16 v[192:195], v[204:207], v[152:155], v[216:219]
    v_mfma_f32_16x16x32_bf16 v[196:199], v[204:207], v[168:171], v[220:223]
    s_waitcnt vmcnt(1)
    v_mfma_f32_16x16x32_bf16 v[184:187], v[208:211], v[156:159], v[184:187]
    v_mfma_f32_16x16x32_bf16 v[188:191], v[208:211], v[172:175], v[188:191]
    s_waitcnt vmcnt(0)
    v_mfma_f32_16x16x32_bf16 v[192:195], v[212:215], v[156:159], v[192:195]
    v_mfma_f32_16x16x32_bf16 v[196:199], v[212:215], v[172:175], v[196:199]
    s_mov_b32 s17, 0xf000
    buffer_load_dwordx4 v[200:203], v8, s[8:11], s17 offen offset:0
    buffer_load_dwordx4 v[204:207], v8, s[8:11], s17 offen offset:1024
    buffer_load_dwordx4 v[208:211], v8, s[8:11], s17 offen offset:2048
    buffer_load_dwordx4 v[212:215], v8, s[8:11], s17 offen offset:3072
    s_waitcnt vmcnt(3)
    v_mfma_f32_16x16x32_bf16 v[184:187], v[200:203], v[160:163], v[184:187]
    v_mfma_f32_16x16x32_bf16 v[188:191], v[200:203], v[176:179], v[188:191]
    s_waitcnt vmcnt(2)
    v_mfma_f32_16x16x32_bf16 v[192:195], v[204:207], v[160:163], v[192:195]
    v_mfma_f32_16x16x32_bf16 v[196:199], v[204:207], v[176:179], v[196:199]
    s_waitcnt vmcnt(1)
    v_mfma_f32_16x16x32_bf16 v[184:187], v[208:211], v[164:167], v[184:187]
    v_mfma_f32_16x16x32_bf16 v[188:191], v[208:211], v[180:183], v[188:191]
    s_waitcnt vmcnt(0)
    v_mfma_f32_16x16x32_bf16 v[192:195], v[212:215], v[164:167], v[192:195]
    v_mfma_f32_16x16x32_bf16 v[196:199], v[212:215], v[180:183], v[196:199]
    s_nop 3
    v_exp_f32 v184, v184
    v_exp_f32 v185, v185
    v_add_f32 v9, v9, v184
    v_add_f32 v9, v9, v185
    v_cvt_pk_bf16_f32 v80, v184, v185
    v_exp_f32 v186, v186
    v_exp_f32 v187, v187
    v_add_f32 v9, v9, v186
    v_add_f32 v9, v9, v187
    v_cvt_pk_bf16_f32 v81, v186, v187
    v_exp_f32 v188, v188
    v_exp_f32 v189, v189
    v_add_f32 v10, v10, v188
    v_add_f32 v10, v10, v189
    v_cvt_pk_bf16_f32 v84, v188, v189
    v_exp_f32 v190, v190
    v_exp_f32 v191, v191
    v_add_f32 v10, v10, v190
    v_add_f32 v10, v10, v191
    v_cvt_pk_bf16_f32 v85, v190, v191
    v_exp_f32 v192, v192
    v_exp_f32 v193, v193
    v_add_f32 v9, v9, v192
    v_add_f32 v9, v9, v193
    v_cvt_pk_bf16_f32 v82, v192, v193
    v_exp_f32 v194, v194
    v_exp_f32 v195, v195
    v_add_f32 v9, v9, v194
    v_add_f32 v9, v9, v195
    v_cvt_pk_bf16_f32 v83, v194, v195
    v_exp_f32 v196, v196
    v_exp_f32 v197, v197
    v_add_f32 v10, v10, v196
    v_add_f32 v10, v10, v197
    v_cvt_pk_bf16_f32 v86, v196, v197
    v_exp_f32 v198, v198
    v_exp_f32 v199, v199
    v_add_f32 v10, v10, v198
    v_add_f32 v10, v10, v199
    v_cvt_pk_bf16_f32 v87, v198, v199
    s_mov_b32 s17, 0x10000
    buffer_load_dwordx4 v[200:203], v8, s[8:11], s17 offen offset:0
    buffer_load_dwordx4 v[204:207], v8, s[8:11], s17 offen offset:1024
    buffer_load_dwordx4 v[208:211], v8, s[8:11], s17 offen offset:2048
    buffer_load_dwordx4 v[212:215], v8, s[8:11], s17 offen offset:3072
    s_waitcnt vmcnt(3)
    v_mfma_f32_16x16x32_bf16 v[184:187], v[200:203], v[152:155], v[216:219]
    v_mfma_f32_16x16x32_bf16 v[188:191], v[200:203], v[168:171], v[220:223]
    s_waitcnt vmcnt(2)
    v_mfma_f32_16x16x32_bf16 v[192:195], v[204:207], v[152:155], v[216:219]
    v_mfma_f32_16x16x32_bf16 v[196:199], v[204:207], v[168:171], v[220:223]
    s_waitcnt vmcnt(1)
    v_mfma_f32_16x16x32_bf16 v[184:187], v[208:211], v[156:159], v[184:187]
    v_mfma_f32_16x16x32_bf16 v[188:191], v[208:211], v[172:175], v[188:191]
    s_waitcnt vmcnt(0)
    v_mfma_f32_16x16x32_bf16 v[192:195], v[212:215], v[156:159], v[192:195]
    v_mfma_f32_16x16x32_bf16 v[196:199], v[212:215], v[172:175], v[196:199]
    s_mov_b32 s17, 0x11000
    buffer_load_dwordx4 v[200:203], v8, s[8:11], s17 offen offset:0
    buffer_load_dwordx4 v[204:207], v8, s[8:11], s17 offen offset:1024
    buffer_load_dwordx4 v[208:211], v8, s[8:11], s17 offen offset:2048
    buffer_load_dwordx4 v[212:215], v8, s[8:11], s17 offen offset:3072
    s_waitcnt vmcnt(3)
    v_mfma_f32_16x16x32_bf16 v[184:187], v[200:203], v[160:163], v[184:187]
    v_mfma_f32_16x16x32_bf16 v[188:191], v[200:203], v[176:179], v[188:191]
    s_waitcnt vmcnt(2)
    v_mfma_f32_16x16x32_bf16 v[192:195], v[204:207], v[160:163], v[192:195]
    v_mfma_f32_16x16x32_bf16 v[196:199], v[204:207], v[176:179], v[196:199]
    s_waitcnt vmcnt(1)
    v_mfma_f32_16x16x32_bf16 v[184:187], v[208:211], v[164:167], v[184:187]
    v_mfma_f32_16x16x32_bf16 v[188:191], v[208:211], v[180:183], v[188:191]
    s_waitcnt vmcnt(0)
    v_mfma_f32_16x16x32_bf16 v[192:195], v[212:215], v[164:167], v[192:195]
    v_mfma_f32_16x16x32_bf16 v[196:199], v[212:215], v[180:183], v[196:199]
    s_nop 3
    v_exp_f32 v184, v184
    v_exp_f32 v185, v185
    v_add_f32 v9, v9, v184
    v_add_f32 v9, v9, v185
    v_cvt_pk_bf16_f32 v88, v184, v185
    v_exp_f32 v186, v186
    v_exp_f32 v187, v187
    v_add_f32 v9, v9, v186
    v_add_f32 v9, v9, v187
    v_cvt_pk_bf16_f32 v89, v186, v187
    v_exp_f32 v188, v188
    v_exp_f32 v189, v189
    v_add_f32 v10, v10, v188
    v_add_f32 v10, v10, v189
    v_cvt_pk_bf16_f32 v92, v188, v189
    v_exp_f32 v190, v190
    v_exp_f32 v191, v191
    v_add_f32 v10, v10, v190
    v_add_f32 v10, v10, v191
    v_cvt_pk_bf16_f32 v93, v190, v191
    v_exp_f32 v192, v192
    v_exp_f32 v193, v193
    v_add_f32 v9, v9, v192
    v_add_f32 v9, v9, v193
    v_cvt_pk_bf16_f32 v90, v192, v193
    v_exp_f32 v194, v194
    v_exp_f32 v195, v195
    v_add_f32 v9, v9, v194
    v_add_f32 v9, v9, v195
    v_cvt_pk_bf16_f32 v91, v194, v195
    v_exp_f32 v196, v196
    v_exp_f32 v197, v197
    v_add_f32 v10, v10, v196
    v_add_f32 v10, v10, v197
    v_cvt_pk_bf16_f32 v94, v196, v197
    v_exp_f32 v198, v198
    v_exp_f32 v199, v199
    v_add_f32 v10, v10, v198
    v_add_f32 v10, v10, v199
    v_cvt_pk_bf16_f32 v95, v198, v199
    s_mov_b32 s17, 0x12000
    buffer_load_dwordx4 v[200:203], v8, s[8:11], s17 offen offset:0
    buffer_load_dwordx4 v[204:207], v8, s[8:11], s17 offen offset:1024
    buffer_load_dwordx4 v[208:211], v8, s[8:11], s17 offen offset:2048
    buffer_load_dwordx4 v[212:215], v8, s[8:11], s17 offen offset:3072
    s_waitcnt vmcnt(3)
    v_mfma_f32_16x16x32_bf16 v[184:187], v[200:203], v[152:155], v[216:219]
    v_mfma_f32_16x16x32_bf16 v[188:191], v[200:203], v[168:171], v[220:223]
    s_waitcnt vmcnt(2)
    v_mfma_f32_16x16x32_bf16 v[192:195], v[204:207], v[152:155], v[216:219]
    v_mfma_f32_16x16x32_bf16 v[196:199], v[204:207], v[168:171], v[220:223]
    s_waitcnt vmcnt(1)
    v_mfma_f32_16x16x32_bf16 v[184:187], v[208:211], v[156:159], v[184:187]
    v_mfma_f32_16x16x32_bf16 v[188:191], v[208:211], v[172:175], v[188:191]
    s_waitcnt vmcnt(0)
    v_mfma_f32_16x16x32_bf16 v[192:195], v[212:215], v[156:159], v[192:195]
    v_mfma_f32_16x16x32_bf16 v[196:199], v[212:215], v[172:175], v[196:199]
    s_mov_b32 s17, 0x13000
    buffer_load_dwordx4 v[200:203], v8, s[8:11], s17 offen offset:0
    buffer_load_dwordx4 v[204:207], v8, s[8:11], s17 offen offset:1024
    buffer_load_dwordx4 v[208:211], v8, s[8:11], s17 offen offset:2048
    buffer_load_dwordx4 v[212:215], v8, s[8:11], s17 offen offset:3072
    s_waitcnt vmcnt(3)
    v_mfma_f32_16x16x32_bf16 v[184:187], v[200:203], v[160:163], v[184:187]
    v_mfma_f32_16x16x32_bf16 v[188:191], v[200:203], v[176:179], v[188:191]
    s_waitcnt vmcnt(2)
    v_mfma_f32_16x16x32_bf16 v[192:195], v[204:207], v[160:163], v[192:195]
    v_mfma_f32_16x16x32_bf16 v[196:199], v[204:207], v[176:179], v[196:199]
    s_waitcnt vmcnt(1)
    v_mfma_f32_16x16x32_bf16 v[184:187], v[208:211], v[164:167], v[184:187]
    v_mfma_f32_16x16x32_bf16 v[188:191], v[208:211], v[180:183], v[188:191]
    s_waitcnt vmcnt(0)
    v_mfma_f32_16x16x32_bf16 v[192:195], v[212:215], v[164:167], v[192:195]
    v_mfma_f32_16x16x32_bf16 v[196:199], v[212:215], v[180:183], v[196:199]
    s_nop 3
    v_exp_f32 v184, v184
    v_exp_f32 v185, v185
    v_add_f32 v9, v9, v184
    v_add_f32 v9, v9, v185
    v_cvt_pk_bf16_f32 v96, v184, v185
    v_exp_f32 v186, v186
    v_exp_f32 v187, v187
    v_add_f32 v9, v9, v186
    v_add_f32 v9, v9, v187
    v_cvt_pk_bf16_f32 v97, v186, v187
    v_exp_f32 v188, v188
    v_exp_f32 v189, v189
    v_add_f32 v10, v10, v188
    v_add_f32 v10, v10, v189
    v_cvt_pk_bf16_f32 v100, v188, v189
    v_exp_f32 v190, v190
    v_exp_f32 v191, v191
    v_add_f32 v10, v10, v190
    v_add_f32 v10, v10, v191
    v_cvt_pk_bf16_f32 v101, v190, v191
    v_exp_f32 v192, v192
    v_exp_f32 v193, v193
    v_add_f32 v9, v9, v192
    v_add_f32 v9, v9, v193
    v_cvt_pk_bf16_f32 v98, v192, v193
    v_exp_f32 v194, v194
    v_exp_f32 v195, v195
    v_add_f32 v9, v9, v194
    v_add_f32 v9, v9, v195
    v_cvt_pk_bf16_f32 v99, v194, v195
    v_exp_f32 v196, v196
    v_exp_f32 v197, v197
    v_add_f32 v10, v10, v196
    v_add_f32 v10, v10, v197
    v_cvt_pk_bf16_f32 v102, v196, v197
    v_exp_f32 v198, v198
    v_exp_f32 v199, v199
    v_add_f32 v10, v10, v198
    v_add_f32 v10, v10, v199
    v_cvt_pk_bf16_f32 v103, v198, v199
    s_mov_b32 s17, 0x14000
    buffer_load_dwordx4 v[200:203], v8, s[8:11], s17 offen offset:0
    buffer_load_dwordx4 v[204:207], v8, s[8:11], s17 offen offset:1024
    buffer_load_dwordx4 v[208:211], v8, s[8:11], s17 offen offset:2048
    buffer_load_dwordx4 v[212:215], v8, s[8:11], s17 offen offset:3072
    s_waitcnt vmcnt(3)
    v_mfma_f32_16x16x32_bf16 v[184:187], v[200:203], v[152:155], v[216:219]
    v_mfma_f32_16x16x32_bf16 v[188:191], v[200:203], v[168:171], v[220:223]
    s_waitcnt vmcnt(2)
    v_mfma_f32_16x16x32_bf16 v[192:195], v[204:207], v[152:155], v[216:219]
    v_mfma_f32_16x16x32_bf16 v[196:199], v[204:207], v[168:171], v[220:223]
    s_waitcnt vmcnt(1)
    v_mfma_f32_16x16x32_bf16 v[184:187], v[208:211], v[156:159], v[184:187]
    v_mfma_f32_16x16x32_bf16 v[188:191], v[208:211], v[172:175], v[188:191]
    s_waitcnt vmcnt(0)
    v_mfma_f32_16x16x32_bf16 v[192:195], v[212:215], v[156:159], v[192:195]
    v_mfma_f32_16x16x32_bf16 v[196:199], v[212:215], v[172:175], v[196:199]
    s_mov_b32 s17, 0x15000
    buffer_load_dwordx4 v[200:203], v8, s[8:11], s17 offen offset:0
    buffer_load_dwordx4 v[204:207], v8, s[8:11], s17 offen offset:1024
    buffer_load_dwordx4 v[208:211], v8, s[8:11], s17 offen offset:2048
    buffer_load_dwordx4 v[212:215], v8, s[8:11], s17 offen offset:3072
    s_waitcnt vmcnt(3)
    v_mfma_f32_16x16x32_bf16 v[184:187], v[200:203], v[160:163], v[184:187]
    v_mfma_f32_16x16x32_bf16 v[188:191], v[200:203], v[176:179], v[188:191]
    s_waitcnt vmcnt(2)
    v_mfma_f32_16x16x32_bf16 v[192:195], v[204:207], v[160:163], v[192:195]
    v_mfma_f32_16x16x32_bf16 v[196:199], v[204:207], v[176:179], v[196:199]
    s_waitcnt vmcnt(1)
    v_mfma_f32_16x16x32_bf16 v[184:187], v[208:211], v[164:167], v[184:187]
    v_mfma_f32_16x16x32_bf16 v[188:191], v[208:211], v[180:183], v[188:191]
    s_waitcnt vmcnt(0)
    v_mfma_f32_16x16x32_bf16 v[192:195], v[212:215], v[164:167], v[192:195]
    v_mfma_f32_16x16x32_bf16 v[196:199], v[212:215], v[180:183], v[196:199]
    s_nop 3
    v_exp_f32 v184, v184
    v_exp_f32 v185, v185
    v_add_f32 v9, v9, v184
    v_add_f32 v9, v9, v185
    v_cvt_pk_bf16_f32 v104, v184, v185
    v_exp_f32 v186, v186
    v_exp_f32 v187, v187
    v_add_f32 v9, v9, v186
    v_add_f32 v9, v9, v187
    v_cvt_pk_bf16_f32 v105, v186, v187
    v_exp_f32 v188, v188
    v_exp_f32 v189, v189
    v_add_f32 v10, v10, v188
    v_add_f32 v10, v10, v189
    v_cvt_pk_bf16_f32 v108, v188, v189
    v_exp_f32 v190, v190
    v_exp_f32 v191, v191
    v_add_f32 v10, v10, v190
    v_add_f32 v10, v10, v191
    v_cvt_pk_bf16_f32 v109, v190, v191
    v_exp_f32 v192, v192
    v_exp_f32 v193, v193
    v_add_f32 v9, v9, v192
    v_add_f32 v9, v9, v193
    v_cvt_pk_bf16_f32 v106, v192, v193
    v_exp_f32 v194, v194
    v_exp_f32 v195, v195
    v_add_f32 v9, v9, v194
    v_add_f32 v9, v9, v195
    v_cvt_pk_bf16_f32 v107, v194, v195
    v_exp_f32 v196, v196
    v_exp_f32 v197, v197
    v_add_f32 v10, v10, v196
    v_add_f32 v10, v10, v197
    v_cvt_pk_bf16_f32 v110, v196, v197
    v_exp_f32 v198, v198
    v_exp_f32 v199, v199
    v_add_f32 v10, v10, v198
    v_add_f32 v10, v10, v199
    v_cvt_pk_bf16_f32 v111, v198, v199
    s_mov_b32 s17, 0x16000
    buffer_load_dwordx4 v[200:203], v8, s[8:11], s17 offen offset:0
    buffer_load_dwordx4 v[204:207], v8, s[8:11], s17 offen offset:1024
    buffer_load_dwordx4 v[208:211], v8, s[8:11], s17 offen offset:2048
    buffer_load_dwordx4 v[212:215], v8, s[8:11], s17 offen offset:3072
    s_waitcnt vmcnt(3)
    v_mfma_f32_16x16x32_bf16 v[184:187], v[200:203], v[152:155], v[216:219]
    v_mfma_f32_16x16x32_bf16 v[188:191], v[200:203], v[168:171], v[220:223]
    s_waitcnt vmcnt(2)
    v_mfma_f32_16x16x32_bf16 v[192:195], v[204:207], v[152:155], v[216:219]
    v_mfma_f32_16x16x32_bf16 v[196:199], v[204:207], v[168:171], v[220:223]
    s_waitcnt vmcnt(1)
    v_mfma_f32_16x16x32_bf16 v[184:187], v[208:211], v[156:159], v[184:187]
    v_mfma_f32_16x16x32_bf16 v[188:191], v[208:211], v[172:175], v[188:191]
    s_waitcnt vmcnt(0)
    v_mfma_f32_16x16x32_bf16 v[192:195], v[212:215], v[156:159], v[192:195]
    v_mfma_f32_16x16x32_bf16 v[196:199], v[212:215], v[172:175], v[196:199]
    s_mov_b32 s17, 0x17000
    buffer_load_dwordx4 v[200:203], v8, s[8:11], s17 offen offset:0
    buffer_load_dwordx4 v[204:207], v8, s[8:11], s17 offen offset:1024
    buffer_load_dwordx4 v[208:211], v8, s[8:11], s17 offen offset:2048
    buffer_load_dwordx4 v[212:215], v8, s[8:11], s17 offen offset:3072
    s_waitcnt vmcnt(3)
    v_mfma_f32_16x16x32_bf16 v[184:187], v[200:203], v[160:163], v[184:187]
    v_mfma_f32_16x16x32_bf16 v[188:191], v[200:203], v[176:179], v[188:191]
    s_waitcnt vmcnt(2)
    v_mfma_f32_16x16x32_bf16 v[192:195], v[204:207], v[160:163], v[192:195]
    v_mfma_f32_16x16x32_bf16 v[196:199], v[204:207], v[176:179], v[196:199]
    s_waitcnt vmcnt(1)
    v_mfma_f32_16x16x32_bf16 v[184:187], v[208:211], v[164:167], v[184:187]
    v_mfma_f32_16x16x32_bf16 v[188:191], v[208:211], v[180:183], v[188:191]
    s_waitcnt vmcnt(0)
    v_mfma_f32_16x16x32_bf16 v[192:195], v[212:215], v[164:167], v[192:195]
    v_mfma_f32_16x16x32_bf16 v[196:199], v[212:215], v[180:183], v[196:199]
    s_nop 3
    v_exp_f32 v184, v184
    v_exp_f32 v185, v185
    v_add_f32 v9, v9, v184
    v_add_f32 v9, v9, v185
    v_cvt_pk_bf16_f32 v112, v184, v185
    v_exp_f32 v186, v186
    v_exp_f32 v187, v187
    v_add_f32 v9, v9, v186
    v_add_f32 v9, v9, v187
    v_cvt_pk_bf16_f32 v113, v186, v187
    v_exp_f32 v188, v188
    v_exp_f32 v189, v189
    v_add_f32 v10, v10, v188
    v_add_f32 v10, v10, v189
    v_cvt_pk_bf16_f32 v116, v188, v189
    v_exp_f32 v190, v190
    v_exp_f32 v191, v191
    v_add_f32 v10, v10, v190
    v_add_f32 v10, v10, v191
    v_cvt_pk_bf16_f32 v117, v190, v191
    v_exp_f32 v192, v192
    v_exp_f32 v193, v193
    v_add_f32 v9, v9, v192
    v_add_f32 v9, v9, v193
    v_cvt_pk_bf16_f32 v114, v192, v193
    v_exp_f32 v194, v194
    v_exp_f32 v195, v195
    v_add_f32 v9, v9, v194
    v_add_f32 v9, v9, v195
    v_cvt_pk_bf16_f32 v115, v194, v195
    v_exp_f32 v196, v196
    v_exp_f32 v197, v197
    v_add_f32 v10, v10, v196
    v_add_f32 v10, v10, v197
    v_cvt_pk_bf16_f32 v118, v196, v197
    v_exp_f32 v198, v198
    v_exp_f32 v199, v199
    v_add_f32 v10, v10, v198
    v_add_f32 v10, v10, v199
    v_cvt_pk_bf16_f32 v119, v198, v199
    s_mov_b32 s17, 0x18000
    buffer_load_dwordx4 v[200:203], v8, s[8:11], s17 offen offset:0
    buffer_load_dwordx4 v[204:207], v8, s[8:11], s17 offen offset:1024
    buffer_load_dwordx4 v[208:211], v8, s[8:11], s17 offen offset:2048
    buffer_load_dwordx4 v[212:215], v8, s[8:11], s17 offen offset:3072
    s_waitcnt vmcnt(3)
    v_mfma_f32_16x16x32_bf16 v[184:187], v[200:203], v[152:155], v[216:219]
    v_mfma_f32_16x16x32_bf16 v[188:191], v[200:203], v[168:171], v[220:223]
    s_waitcnt vmcnt(2)
    v_mfma_f32_16x16x32_bf16 v[192:195], v[204:207], v[152:155], v[216:219]
    v_mfma_f32_16x16x32_bf16 v[196:199], v[204:207], v[168:171], v[220:223]
    s_waitcnt vmcnt(1)
    v_mfma_f32_16x16x32_bf16 v[184:187], v[208:211], v[156:159], v[184:187]
    v_mfma_f32_16x16x32_bf16 v[188:191], v[208:211], v[172:175], v[188:191]
    s_waitcnt vmcnt(0)
    v_mfma_f32_16x16x32_bf16 v[192:195], v[212:215], v[156:159], v[192:195]
    v_mfma_f32_16x16x32_bf16 v[196:199], v[212:215], v[172:175], v[196:199]
    s_mov_b32 s17, 0x19000
    buffer_load_dwordx4 v[200:203], v8, s[8:11], s17 offen offset:0
    buffer_load_dwordx4 v[204:207], v8, s[8:11], s17 offen offset:1024
    buffer_load_dwordx4 v[208:211], v8, s[8:11], s17 offen offset:2048
    buffer_load_dwordx4 v[212:215], v8, s[8:11], s17 offen offset:3072
    s_waitcnt vmcnt(3)
    v_mfma_f32_16x16x32_bf16 v[184:187], v[200:203], v[160:163], v[184:187]
    v_mfma_f32_16x16x32_bf16 v[188:191], v[200:203], v[176:179], v[188:191]
    s_waitcnt vmcnt(2)
    v_mfma_f32_16x16x32_bf16 v[192:195], v[204:207], v[160:163], v[192:195]
    v_mfma_f32_16x16x32_bf16 v[196:199], v[204:207], v[176:179], v[196:199]
    s_waitcnt vmcnt(1)
    v_mfma_f32_16x16x32_bf16 v[184:187], v[208:211], v[164:167], v[184:187]
    v_mfma_f32_16x16x32_bf16 v[188:191], v[208:211], v[180:183], v[188:191]
    s_waitcnt vmcnt(0)
    v_mfma_f32_16x16x32_bf16 v[192:195], v[212:215], v[164:167], v[192:195]
    v_mfma_f32_16x16x32_bf16 v[196:199], v[212:215], v[180:183], v[196:199]
    s_nop 3
    v_exp_f32 v184, v184
    v_exp_f32 v185, v185
    v_add_f32 v9, v9, v184
    v_add_f32 v9, v9, v185
    v_cvt_pk_bf16_f32 v120, v184, v185
    v_exp_f32 v186, v186
    v_exp_f32 v187, v187
    v_add_f32 v9, v9, v186
    v_add_f32 v9, v9, v187
    v_cvt_pk_bf16_f32 v121, v186, v187
    v_exp_f32 v188, v188
    v_exp_f32 v189, v189
    v_add_f32 v10, v10, v188
    v_add_f32 v10, v10, v189
    v_cvt_pk_bf16_f32 v124, v188, v189
    v_exp_f32 v190, v190
    v_exp_f32 v191, v191
    v_add_f32 v10, v10, v190
    v_add_f32 v10, v10, v191
    v_cvt_pk_bf16_f32 v125, v190, v191
    v_exp_f32 v192, v192
    v_exp_f32 v193, v193
    v_add_f32 v9, v9, v192
    v_add_f32 v9, v9, v193
    v_cvt_pk_bf16_f32 v122, v192, v193
    v_exp_f32 v194, v194
    v_exp_f32 v195, v195
    v_add_f32 v9, v9, v194
    v_add_f32 v9, v9, v195
    v_cvt_pk_bf16_f32 v123, v194, v195
    v_exp_f32 v196, v196
    v_exp_f32 v197, v197
    v_add_f32 v10, v10, v196
    v_add_f32 v10, v10, v197
    v_cvt_pk_bf16_f32 v126, v196, v197
    v_exp_f32 v198, v198
    v_exp_f32 v199, v199
    v_add_f32 v10, v10, v198
    v_add_f32 v10, v10, v199
    v_cvt_pk_bf16_f32 v127, v198, v199
    s_mov_b32 s17, 0x1a000
    buffer_load_dwordx4 v[200:203], v8, s[8:11], s17 offen offset:0
    buffer_load_dwordx4 v[204:207], v8, s[8:11], s17 offen offset:1024
    buffer_load_dwordx4 v[208:211], v8, s[8:11], s17 offen offset:2048
    buffer_load_dwordx4 v[212:215], v8, s[8:11], s17 offen offset:3072
    s_waitcnt vmcnt(3)
    v_mfma_f32_16x16x32_bf16 v[184:187], v[200:203], v[152:155], v[216:219]
    v_mfma_f32_16x16x32_bf16 v[188:191], v[200:203], v[168:171], v[220:223]
    s_waitcnt vmcnt(2)
    v_mfma_f32_16x16x32_bf16 v[192:195], v[204:207], v[152:155], v[216:219]
    v_mfma_f32_16x16x32_bf16 v[196:199], v[204:207], v[168:171], v[220:223]
    s_waitcnt vmcnt(1)
    v_mfma_f32_16x16x32_bf16 v[184:187], v[208:211], v[156:159], v[184:187]
    v_mfma_f32_16x16x32_bf16 v[188:191], v[208:211], v[172:175], v[188:191]
    s_waitcnt vmcnt(0)
    v_mfma_f32_16x16x32_bf16 v[192:195], v[212:215], v[156:159], v[192:195]
    v_mfma_f32_16x16x32_bf16 v[196:199], v[212:215], v[172:175], v[196:199]
    s_mov_b32 s17, 0x1b000
    buffer_load_dwordx4 v[200:203], v8, s[8:11], s17 offen offset:0
    buffer_load_dwordx4 v[204:207], v8, s[8:11], s17 offen offset:1024
    buffer_load_dwordx4 v[208:211], v8, s[8:11], s17 offen offset:2048
    buffer_load_dwordx4 v[212:215], v8, s[8:11], s17 offen offset:3072
    s_waitcnt vmcnt(3)
    v_mfma_f32_16x16x32_bf16 v[184:187], v[200:203], v[160:163], v[184:187]
    v_mfma_f32_16x16x32_bf16 v[188:191], v[200:203], v[176:179], v[188:191]
    s_waitcnt vmcnt(2)
    v_mfma_f32_16x16x32_bf16 v[192:195], v[204:207], v[160:163], v[192:195]
    v_mfma_f32_16x16x32_bf16 v[196:199], v[204:207], v[176:179], v[196:199]
    s_waitcnt vmcnt(1)
    v_mfma_f32_16x16x32_bf16 v[184:187], v[208:211], v[164:167], v[184:187]
    v_mfma_f32_16x16x32_bf16 v[188:191], v[208:211], v[180:183], v[188:191]
    s_waitcnt vmcnt(0)
    v_mfma_f32_16x16x32_bf16 v[192:195], v[212:215], v[164:167], v[192:195]
    v_mfma_f32_16x16x32_bf16 v[196:199], v[212:215], v[180:183], v[196:199]
    s_nop 3
    v_exp_f32 v184, v184
    v_exp_f32 v185, v185
    v_add_f32 v9, v9, v184
    v_add_f32 v9, v9, v185
    v_cvt_pk_bf16_f32 v128, v184, v185
    v_exp_f32 v186, v186
    v_exp_f32 v187, v187
    v_add_f32 v9, v9, v186
    v_add_f32 v9, v9, v187
    v_cvt_pk_bf16_f32 v129, v186, v187
    v_exp_f32 v188, v188
    v_exp_f32 v189, v189
    v_add_f32 v10, v10, v188
    v_add_f32 v10, v10, v189
    v_cvt_pk_bf16_f32 v132, v188, v189
    v_exp_f32 v190, v190
    v_exp_f32 v191, v191
    v_add_f32 v10, v10, v190
    v_add_f32 v10, v10, v191
    v_cvt_pk_bf16_f32 v133, v190, v191
    v_exp_f32 v192, v192
    v_exp_f32 v193, v193
    v_add_f32 v9, v9, v192
    v_add_f32 v9, v9, v193
    v_cvt_pk_bf16_f32 v130, v192, v193
    v_exp_f32 v194, v194
    v_exp_f32 v195, v195
    v_add_f32 v9, v9, v194
    v_add_f32 v9, v9, v195
    v_cvt_pk_bf16_f32 v131, v194, v195
    v_exp_f32 v196, v196
    v_exp_f32 v197, v197
    v_add_f32 v10, v10, v196
    v_add_f32 v10, v10, v197
    v_cvt_pk_bf16_f32 v134, v196, v197
    v_exp_f32 v198, v198
    v_exp_f32 v199, v199
    v_add_f32 v10, v10, v198
    v_add_f32 v10, v10, v199
    v_cvt_pk_bf16_f32 v135, v198, v199
    s_mov_b32 s17, 0x1c000
    buffer_load_dwordx4 v[200:203], v8, s[8:11], s17 offen offset:0
    buffer_load_dwordx4 v[204:207], v8, s[8:11], s17 offen offset:1024
    buffer_load_dwordx4 v[208:211], v8, s[8:11], s17 offen offset:2048
    buffer_load_dwordx4 v[212:215], v8, s[8:11], s17 offen offset:3072
    s_waitcnt vmcnt(3)
    v_mfma_f32_16x16x32_bf16 v[184:187], v[200:203], v[152:155], v[216:219]
    v_mfma_f32_16x16x32_bf16 v[188:191], v[200:203], v[168:171], v[220:223]
    s_waitcnt vmcnt(2)
    v_mfma_f32_16x16x32_bf16 v[192:195], v[204:207], v[152:155], v[216:219]
    v_mfma_f32_16x16x32_bf16 v[196:199], v[204:207], v[168:171], v[220:223]
    s_waitcnt vmcnt(1)
    v_mfma_f32_16x16x32_bf16 v[184:187], v[208:211], v[156:159], v[184:187]
    v_mfma_f32_16x16x32_bf16 v[188:191], v[208:211], v[172:175], v[188:191]
    s_waitcnt vmcnt(0)
    v_mfma_f32_16x16x32_bf16 v[192:195], v[212:215], v[156:159], v[192:195]
    v_mfma_f32_16x16x32_bf16 v[196:199], v[212:215], v[172:175], v[196:199]
    s_mov_b32 s17, 0x1d000
    buffer_load_dwordx4 v[200:203], v8, s[8:11], s17 offen offset:0
    buffer_load_dwordx4 v[204:207], v8, s[8:11], s17 offen offset:1024
    buffer_load_dwordx4 v[208:211], v8, s[8:11], s17 offen offset:2048
    buffer_load_dwordx4 v[212:215], v8, s[8:11], s17 offen offset:3072
    s_waitcnt vmcnt(3)
    v_mfma_f32_16x16x32_bf16 v[184:187], v[200:203], v[160:163], v[184:187]
    v_mfma_f32_16x16x32_bf16 v[188:191], v[200:203], v[176:179], v[188:191]
    s_waitcnt vmcnt(2)
    v_mfma_f32_16x16x32_bf16 v[192:195], v[204:207], v[160:163], v[192:195]
    v_mfma_f32_16x16x32_bf16 v[196:199], v[204:207], v[176:179], v[196:199]
    s_waitcnt vmcnt(1)
    v_mfma_f32_16x16x32_bf16 v[184:187], v[208:211], v[164:167], v[184:187]
    v_mfma_f32_16x16x32_bf16 v[188:191], v[208:211], v[180:183], v[188:191]
    s_waitcnt vmcnt(0)
    v_mfma_f32_16x16x32_bf16 v[192:195], v[212:215], v[164:167], v[192:195]
    v_mfma_f32_16x16x32_bf16 v[196:199], v[212:215], v[180:183], v[196:199]
    s_nop 3
    v_exp_f32 v184, v184
    v_exp_f32 v185, v185
    v_add_f32 v9, v9, v184
    v_add_f32 v9, v9, v185
    v_cvt_pk_bf16_f32 v136, v184, v185
    v_exp_f32 v186, v186
    v_exp_f32 v187, v187
    v_add_f32 v9, v9, v186
    v_add_f32 v9, v9, v187
    v_cvt_pk_bf16_f32 v137, v186, v187
    v_exp_f32 v188, v188
    v_exp_f32 v189, v189
    v_add_f32 v10, v10, v188
    v_add_f32 v10, v10, v189
    v_cvt_pk_bf16_f32 v140, v188, v189
    v_exp_f32 v190, v190
    v_exp_f32 v191, v191
    v_add_f32 v10, v10, v190
    v_add_f32 v10, v10, v191
    v_cvt_pk_bf16_f32 v141, v190, v191
    v_exp_f32 v192, v192
    v_exp_f32 v193, v193
    v_add_f32 v9, v9, v192
    v_add_f32 v9, v9, v193
    v_cvt_pk_bf16_f32 v138, v192, v193
    v_exp_f32 v194, v194
    v_exp_f32 v195, v195
    v_add_f32 v9, v9, v194
    v_add_f32 v9, v9, v195
    v_cvt_pk_bf16_f32 v139, v194, v195
    v_exp_f32 v196, v196
    v_exp_f32 v197, v197
    v_add_f32 v10, v10, v196
    v_add_f32 v10, v10, v197
    v_cvt_pk_bf16_f32 v142, v196, v197
    v_exp_f32 v198, v198
    v_exp_f32 v199, v199
    v_add_f32 v10, v10, v198
    v_add_f32 v10, v10, v199
    v_cvt_pk_bf16_f32 v143, v198, v199
    s_mov_b32 s17, 0x1e000
    buffer_load_dwordx4 v[200:203], v8, s[8:11], s17 offen offset:0
    buffer_load_dwordx4 v[204:207], v8, s[8:11], s17 offen offset:1024
    buffer_load_dwordx4 v[208:211], v8, s[8:11], s17 offen offset:2048
    buffer_load_dwordx4 v[212:215], v8, s[8:11], s17 offen offset:3072
    s_waitcnt vmcnt(3)
    v_mfma_f32_16x16x32_bf16 v[184:187], v[200:203], v[152:155], v[216:219]
    v_mfma_f32_16x16x32_bf16 v[188:191], v[200:203], v[168:171], v[220:223]
    s_waitcnt vmcnt(2)
    v_mfma_f32_16x16x32_bf16 v[192:195], v[204:207], v[152:155], v[216:219]
    v_mfma_f32_16x16x32_bf16 v[196:199], v[204:207], v[168:171], v[220:223]
    s_waitcnt vmcnt(1)
    v_mfma_f32_16x16x32_bf16 v[184:187], v[208:211], v[156:159], v[184:187]
    v_mfma_f32_16x16x32_bf16 v[188:191], v[208:211], v[172:175], v[188:191]
    s_waitcnt vmcnt(0)
    v_mfma_f32_16x16x32_bf16 v[192:195], v[212:215], v[156:159], v[192:195]
    v_mfma_f32_16x16x32_bf16 v[196:199], v[212:215], v[172:175], v[196:199]
    s_mov_b32 s17, 0x1f000
    buffer_load_dwordx4 v[200:203], v8, s[8:11], s17 offen offset:0
    buffer_load_dwordx4 v[204:207], v8, s[8:11], s17 offen offset:1024
    buffer_load_dwordx4 v[208:211], v8, s[8:11], s17 offen offset:2048
    buffer_load_dwordx4 v[212:215], v8, s[8:11], s17 offen offset:3072
    s_waitcnt vmcnt(3)
    v_mfma_f32_16x16x32_bf16 v[184:187], v[200:203], v[160:163], v[184:187]
    v_mfma_f32_16x16x32_bf16 v[188:191], v[200:203], v[176:179], v[188:191]
    s_waitcnt vmcnt(2)
    v_mfma_f32_16x16x32_bf16 v[192:195], v[204:207], v[160:163], v[192:195]
    v_mfma_f32_16x16x32_bf16 v[196:199], v[204:207], v[176:179], v[196:199]
    s_waitcnt vmcnt(1)
    v_mfma_f32_16x16x32_bf16 v[184:187], v[208:211], v[164:167], v[184:187]
    v_mfma_f32_16x16x32_bf16 v[188:191], v[208:211], v[180:183], v[188:191]
    s_waitcnt vmcnt(0)
    v_mfma_f32_16x16x32_bf16 v[192:195], v[212:215], v[164:167], v[192:195]
    v_mfma_f32_16x16x32_bf16 v[196:199], v[212:215], v[180:183], v[196:199]
    s_nop 3
    v_exp_f32 v184, v184
    v_exp_f32 v185, v185
    v_add_f32 v9, v9, v184
    v_add_f32 v9, v9, v185
    v_cvt_pk_bf16_f32 v144, v184, v185
    v_exp_f32 v186, v186
    v_exp_f32 v187, v187
    v_add_f32 v9, v9, v186
    v_add_f32 v9, v9, v187
    v_cvt_pk_bf16_f32 v145, v186, v187
    v_exp_f32 v188, v188
    v_exp_f32 v189, v189
    v_add_f32 v10, v10, v188
    v_add_f32 v10, v10, v189
    v_cvt_pk_bf16_f32 v148, v188, v189
    v_exp_f32 v190, v190
    v_exp_f32 v191, v191
    v_add_f32 v10, v10, v190
    v_add_f32 v10, v10, v191
    v_cvt_pk_bf16_f32 v149, v190, v191
    v_exp_f32 v192, v192
    v_exp_f32 v193, v193
    v_add_f32 v9, v9, v192
    v_add_f32 v9, v9, v193
    v_cvt_pk_bf16_f32 v146, v192, v193
    v_exp_f32 v194, v194
    v_exp_f32 v195, v195
    v_add_f32 v9, v9, v194
    v_add_f32 v9, v9, v195
    v_cvt_pk_bf16_f32 v147, v194, v195
    v_exp_f32 v196, v196
    v_exp_f32 v197, v197
    v_add_f32 v10, v10, v196
    v_add_f32 v10, v10, v197
    v_cvt_pk_bf16_f32 v150, v196, v197
    v_exp_f32 v198, v198
    v_exp_f32 v199, v199
    v_add_f32 v10, v10, v198
    v_add_f32 v10, v10, v199
    v_cvt_pk_bf16_f32 v151, v198, v199
    v_mov_b32 v16, v9
    v_mov_b32 v18, v10
    s_nop 0
    v_permlane16_swap_b32 v9, v16
    v_permlane16_swap_b32 v10, v18
    v_add_f32 v9, v9, v16
    v_add_f32 v10, v10, v18
    v_mov_b32 v16, v9
    v_mov_b32 v18, v10
    s_nop 0
    v_permlane32_swap_b32 v9, v16
    v_permlane32_swap_b32 v10, v18
    v_add_f32 v9, v9, v16
    v_add_f32 v10, v10, v18
    s_waitcnt vmcnt(0) lgkmcnt(0)
    s_nop 15
    s_nop 3
    s_branch adaLN_cond__sliding_block_cached__moe_arch_mod__prompt_kernel_fixBb
adaLN_cond__sliding_block_cached__moe_arch_mod__prompt_kernel_o17r:
    s_waitcnt vmcnt(0) lgkmcnt(0)
    s_nop 15
    s_nop 3
    s_mov_b32 s27, 0
adaLN_cond__sliding_block_cached__moe_arch_mod__prompt_kernel_o17p:
    buffer_load_dword v12, v13, s[8:11], s19 offen sc1
    s_waitcnt vmcnt(0)
    v_cmp_ne_u32 vcc, s28, v12
    s_add_u32 s27, s27, 1
    s_cmp_ge_u32 s27, 65536
    s_cbranch_scc1 adaLN_cond__sliding_block_cached__moe_arch_mod__prompt_kernel_o17g
    s_cbranch_vccnz adaLN_cond__sliding_block_cached__moe_arch_mod__prompt_kernel_o17p
adaLN_cond__sliding_block_cached__moe_arch_mod__prompt_kernel_o17g:
    s_waitcnt vmcnt(0) lgkmcnt(0)
    s_nop 15
    s_nop 3
    s_branch adaLN_cond__sliding_block_cached__moe_arch_mod__prompt_kernel_o17b
adaLN_cond__sliding_block_cached__moe_arch_mod__prompt_kernel_o218r:
    s_waitcnt vmcnt(0) lgkmcnt(0)
    s_nop 15
    s_nop 3
    s_mov_b32 s27, 0
adaLN_cond__sliding_block_cached__moe_arch_mod__prompt_kernel_o218p:
    buffer_load_dword v12, v13, s[8:11], s19 offen sc1
    s_waitcnt vmcnt(0)
    v_cmp_ne_u32 vcc, s28, v12
    s_add_u32 s27, s27, 1
    s_cmp_ge_u32 s27, 65536
    s_cbranch_scc1 adaLN_cond__sliding_block_cached__moe_arch_mod__prompt_kernel_o218g
    s_cbranch_vccnz adaLN_cond__sliding_block_cached__moe_arch_mod__prompt_kernel_o218p
adaLN_cond__sliding_block_cached__moe_arch_mod__prompt_kernel_o218g:
    s_waitcnt vmcnt(0) lgkmcnt(0)
    s_nop 15
    s_nop 3
    s_branch adaLN_cond__sliding_block_cached__moe_arch_mod__prompt_kernel_o218b
adaLN_cond__sliding_block_cached__moe_arch_mod__prompt_kernel_o219r:
    s_waitcnt vmcnt(0) lgkmcnt(0)
    s_nop 15
    s_nop 3
    s_mov_b32 s27, 0
adaLN_cond__sliding_block_cached__moe_arch_mod__prompt_kernel_o219p:
    buffer_load_dword v12, v13, s[8:11], s19 offen sc1
    s_waitcnt vmcnt(0)
    v_cmp_ne_u32 vcc, s28, v12
    s_add_u32 s27, s27, 1
    s_cmp_ge_u32 s27, 65536
    s_cbranch_scc1 adaLN_cond__sliding_block_cached__moe_arch_mod__prompt_kernel_o219g
    s_cbranch_vccnz adaLN_cond__sliding_block_cached__moe_arch_mod__prompt_kernel_o219p
adaLN_cond__sliding_block_cached__moe_arch_mod__prompt_kernel_o219g:
    s_waitcnt vmcnt(0) lgkmcnt(0)
    s_nop 15
    s_nop 3
    s_branch adaLN_cond__sliding_block_cached__moe_arch_mod__prompt_kernel_o219b
adaLN_cond__sliding_block_cached__moe_arch_mod__prompt_kernel_o220r:
    s_waitcnt vmcnt(0) lgkmcnt(0)
    s_nop 15
    s_nop 3
    s_mov_b32 s27, 0
adaLN_cond__sliding_block_cached__moe_arch_mod__prompt_kernel_o220p:
    buffer_load_dword v12, v13, s[8:11], s19 offen sc1
    s_waitcnt vmcnt(0)
    v_cmp_ne_u32 vcc, s28, v12
    s_add_u32 s27, s27, 1
    s_cmp_ge_u32 s27, 65536
    s_cbranch_scc1 adaLN_cond__sliding_block_cached__moe_arch_mod__prompt_kernel_o220g
    s_cbranch_vccnz adaLN_cond__sliding_block_cached__moe_arch_mod__prompt_kernel_o220p
adaLN_cond__sliding_block_cached__moe_arch_mod__prompt_kernel_o220g:
    s_waitcnt vmcnt(0) lgkmcnt(0)
    s_nop 15
    s_nop 3
    s_branch adaLN_cond__sliding_block_cached__moe_arch_mod__prompt_kernel_o220b
adaLN_cond__sliding_block_cached__moe_arch_mod__prompt_kernel_mf21r:
    s_waitcnt vmcnt(0) lgkmcnt(0)
    s_nop 15
    s_nop 3
    s_mov_b32 s27, 0
adaLN_cond__sliding_block_cached__moe_arch_mod__prompt_kernel_mf21p:
    s_mov_b32 s16, 0x544000
    buffer_load_dwordx4 v[184:187], v2, s[8:11], s16 offen sc1
    s_waitcnt vmcnt(0)
    v_xor_b32 v16, s28, v184
    v_xor_b32 v17, s28, v185
    v_xor_b32 v18, s28, v186
    v_xor_b32 v19, s28, v187
    v_or3_b32 v16, v16, v17, v18
    v_or_b32 v16, v16, v19
    v_cmp_ne_u32 vcc, 0, v16
    s_add_u32 s27, s27, 1
    s_cmp_ge_u32 s27, 65536
    s_cbranch_scc1 adaLN_cond__sliding_block_cached__moe_arch_mod__prompt_kernel_mf21g
    s_cbranch_vccnz adaLN_cond__sliding_block_cached__moe_arch_mod__prompt_kernel_mf21p
adaLN_cond__sliding_block_cached__moe_arch_mod__prompt_kernel_mf21g:
    s_waitcnt vmcnt(0) lgkmcnt(0)
    s_nop 15
    s_nop 3
    s_branch adaLN_cond__sliding_block_cached__moe_arch_mod__prompt_kernel_mf21b
adaLN_cond__sliding_block_cached__moe_arch_mod__prompt_kernel_codeend:
    s_endpgm
.section .rodata,"a"
.p2align 6
.amdhsa_kernel adaLN_cond__sliding_block_cached__moe_arch_mod__prompt_kernel
  .amdhsa_next_free_vgpr 256
  .amdhsa_next_free_sgpr 80
  .amdhsa_accum_offset 256
  .amdhsa_group_segment_fixed_size 0
  .amdhsa_kernarg_size 120
  .amdhsa_user_sgpr_count 2
  .amdhsa_user_sgpr_kernarg_segment_ptr 1
  .amdhsa_system_sgpr_workgroup_id_x 1
  .amdhsa_float_denorm_mode_32 3
.end_amdhsa_kernel
```

```asm
; @launch grid=(256,1,1) block=(512,1,1) lds=163840
.amdgcn_target "amdgcn-amd-amdhsa--gfx950"
.text
.globl adaLN_cond__sliding_block_cached__moe_arch_mod__prompt_kernel
.p2align 8
.type adaLN_cond__sliding_block_cached__moe_arch_mod__prompt_kernel,@function
adaLN_cond__sliding_block_cached__moe_arch_mod__prompt_kernel:
    s_cmp_ge_u32 s2, 256
    s_cbranch_scc1 adaLN_cond__sliding_block_cached__moe_arch_mod__prompt_kernel_end
    s_getpc_b64 s[76:77]
adaLN_cond__sliding_block_cached__moe_arch_mod__prompt_kernel_pc0:
    s_sub_u32 s76, s76, adaLN_cond__sliding_block_cached__moe_arch_mod__prompt_kernel_pc0-adaLN_cond__sliding_block_cached__moe_arch_mod__prompt_kernel
    s_subb_u32 s77, s77, 0
    v_and_b32 v16, 63, v0
    v_lshlrev_b32 v16, 7, v16
    v_lshrrev_b32 v17, 6, v0
    s_lshr_b32 s62, s2, 3
    s_lshl_b32 s62, s62, 13
    v_lshlrev_b32 v18, 13, v17
    v_mov_b32 v19, s62
    v_cmp_eq_u32 vcc, 7, v17
    s_nop 1
    v_cndmask_b32 v18, v18, v19, vcc
    v_add_u32 v16, v16, v18
    v_min_u32 v16, adaLN_cond__sliding_block_cached__moe_arch_mod__prompt_kernel_codeend-adaLN_cond__sliding_block_cached__moe_arch_mod__prompt_kernel-4, v16
    v_mov_b32 v25, s77
    v_add_co_u32 v24, vcc, s76, v16
    s_nop 1
    v_addc_co_u32 v25, vcc, 0, v25, vcc
    v_cmp_gt_u32 vcc, 2, v17
    v_cmp_eq_u32 s[62:63], 7, v17
    s_or_b64 vcc, vcc, s[62:63]
    s_and_saveexec_b64 s[62:63], vcc
    s_cbranch_execz adaLN_cond__sliding_block_cached__moe_arch_mod__prompt_kernel_nocp0
    global_load_dword v26, v[24:25], off
adaLN_cond__sliding_block_cached__moe_arch_mod__prompt_kernel_nocp0:
    s_mov_b64 exec, s[62:63]
    s_load_dwordx4 s[56:59], s[0:1], 96
    s_load_dwordx2 s[60:61], s[0:1], 112
    s_load_dwordx8 s[48:55], s[0:1], 64
    s_load_dwordx16 s[32:47], s[0:1], 0
    s_memrealtime s[62:63]
    v_lshrrev_b32 v16, 6, v0
    v_and_b32 v1, 63, v0
    v_readfirstlane_b32 s3, v16
    v_lshlrev_b32 v2, 4, v1
    s_and_b32 s12, s2, 3
    s_lshl_b32 s12, s12, 3
    s_bfe_u32 s13, s2, 0x30003
    s_add_u32 s12, s12, s13
    s_bfe_u32 s13, s2, 0x10002
    s_lshl_b32 s13, s13, 2
    s_lshr_b32 s14, s2, 6
    s_add_u32 s13, s13, s14
    v_bfe_u32 v16, v1, 2, 2
    v_lshrrev_b32 v17, 4, v1
    v_and_b32 v18, 3, v1
    v_lshlrev_b32 v19, 6, v17
    v_lshl_add_u32 v19, v18, 4, v19
    v_lshl_add_u32 v3, v16, 13, v19
    s_and_b32 s14, s3, 1
    s_lshl_b32 s14, s14, 5
    v_xor_b32 v3, s14, v3
    v_lshlrev_b32 v4, 11, v17
    v_lshl_add_u32 v4, v16, 6, v4
    v_lshl_add_u32 v4, v18, 3, v4
    v_and_b32 v20, 1, v17
    v_lshlrev_b32 v20, 5, v20
    v_sub_u32 v5, v4, v20
    v_add_u32 v4, v4, v20
    s_lshl_b32 s14, s13, 3
    s_add_u32 s14, s14, s3
    s_lshl_b32 s14, s14, 16
    v_add_u32 v7, s14, v2
    s_cmp_ge_u32 s3, 4
    s_cbranch_scc1 adaLN_cond__sliding_block_cached__moe_arch_mod__prompt_kernel_roleB
    v_mov_b32 v132, 0
    v_mov_b32 v133, 0
    v_lshrrev_b32 v16, 3, v0
    v_and_b32 v17, 7, v0
    v_mul_u32_u24 v135, 24576, v16
    v_lshl_add_u32 v135, v17, 4, v135
    v_lshlrev_b32 v136, 2, v16
    s_and_b32 s14, s2, 31
    s_lshr_b32 s15, s2, 5
    s_mul_i32 s26, s15, 1572864
    s_lshl_b32 s16, s14, 7
    s_add_u32 s26, s26, s16
    s_lshl_b32 s29, s15, 8
    v_lshlrev_b32 v137, 3, v0
    s_lshl_b32 s18, s2, 3
    s_add_u32 s18, s18, s3
    s_lshl_b32 s18, s18, 11
    v_and_b32 v18, 15, v1
    v_lshrrev_b32 v19, 4, v1
    v_lshlrev_b32 v138, 11, v18
    v_lshl_add_u32 v138, v19, 4, v138
    s_lshr_b32 s30, s2, 4
    s_and_b32 s31, s2, 15
    s_lshl_b32 s19, s30, 3
    s_add_u32 s19, s19, s3
    s_lshl_b32 s22, s19, 15
    s_lshl_b32 s23, s31, 7
    s_add_u32 s22, s22, s23
    s_lshl_b32 s23, s2, 12
    s_add_u32 s23, s23, 0x600000
    s_or_b32 s25, s2, s3
    s_cmp_eq_u32 s25, 0
    s_cselect_b32 s25, 0, 0x7ffffff0
    s_waitcnt lgkmcnt(0)
    s_mov_b64 s[64:65], s[58:59]
    s_mov_b32 s66, 0x100
    s_mov_b32 s67, 0x20000
    s_or_b32 s28, s62, 1
    v_mov_b32 v134, s28
    s_mov_b64 exec, 1
    buffer_store_dword v134, v132, s[64:67], s25 offen sc1
    s_mov_b64 exec, -1
    s_mov_b64 s[68:69], s[52:53]
    s_mov_b32 s70, 0x800
    s_mov_b32 s71, 0x20000
    s_mov_b64 s[72:73], s[54:55]
    s_mov_b32 s74, 0xc00000
    s_mov_b32 s75, 0x20000
    s_mov_b64 s[76:77], s[32:33]
    s_mov_b32 s78, 0x400000
    s_mov_b32 s79, 0x20000
    s_mov_b64 s[8:9], s[60:61]
    s_mov_b32 s10, 0x3400000
    s_mov_b32 s11, 0x20000
    buffer_load_dword v72, v136, s[68:71], s29 offen
    buffer_load_dwordx4 v[24:27], v135, s[72:75], s26 offen
    s_add_u32 s26, s26, 12288
    buffer_load_dwordx4 v[28:31], v135, s[72:75], s26 offen
    buffer_load_dwordx4 v[32:35], v2, s[76:79], s18 offen offset:0
    buffer_load_dwordx4 v[36:39], v2, s[76:79], s18 offen offset:1024
    s_cmp_eq_u32 s3, 0
    s_cselect_b32 s25, 0, 0x7ffffff0
    buffer_load_dword v134, v132, s[64:67], s25 offen sc1
    buffer_store_dwordx2 v[132:133], v137, s[8:11], s23 offen sc1
    s_barrier
    buffer_load_dwordx4 v[40:43], v138, s[76:79], s22 offen offset:0
    buffer_load_dwordx4 v[44:47], v138, s[76:79], s22 offen offset:64
    s_mov_b32 s29, s19
    s_waitcnt vmcnt(8)
    v_and_b32 v73, 0xffff0000, v72
    v_lshlrev_b32 v72, 16, v72
    v_mul_f32 v16, 0xbfb8aa3b, v72
    v_exp_f32 v16, v16
    s_nop 0
    v_add_f32 v16, 1.0, v16
    v_rcp_f32 v16, v16
    s_nop 0
    v_mul_f32 v72, v72, v16
    v_mul_f32 v17, 0xbfb8aa3b, v73
    v_exp_f32 v17, v17
    s_nop 0
    v_add_f32 v17, 1.0, v17
    v_rcp_f32 v17, v17
    s_nop 0
    v_mul_f32 v73, v73, v17
    v_cvt_pk_bf16_f32 v16, v72, v73
    v_lshlrev_b32 v72, 16, v16
    v_and_b32 v73, 0xffff0000, v16
    s_lshl_b32 s16, s2, 8
    s_add_u32 s16, s16, 0x550000
    s_mov_b32 exec_lo, 0x01010101
    s_mov_b32 exec_hi, 0x01010101
    buffer_store_dword v16, v136, s[8:11], s16 offen sc1
    s_mov_b64 exec, -1
    v_lshrrev_b32 v74, 16, v72
    v_lshrrev_b32 v75, 16, v73
    s_waitcnt vmcnt(8)
    v_dot2_f32_bf16 v49, v24, v72, 0
    v_dot2_f32_bf16 v48, v24, v74, 0
    v_dot2_f32_bf16 v51, v25, v72, 0
    v_dot2_f32_bf16 v50, v25, v74, 0
    v_dot2_f32_bf16 v53, v26, v72, 0
    v_dot2_f32_bf16 v52, v26, v74, 0
    v_dot2_f32_bf16 v55, v27, v72, 0
    v_dot2_f32_bf16 v54, v27, v74, 0
    s_waitcnt vmcnt(7)
    v_dot2c_f32_bf16 v49, v28, v73
    v_dot2c_f32_bf16 v48, v28, v75
    v_dot2c_f32_bf16 v51, v29, v73
    v_dot2c_f32_bf16 v50, v29, v75
    v_dot2c_f32_bf16 v53, v30, v73
    v_dot2c_f32_bf16 v52, v30, v75
    v_dot2c_f32_bf16 v55, v31, v73
    v_dot2c_f32_bf16 v54, v31, v75
    s_nop 0
    v_permlane32_swap_b32 v48, v52
    v_permlane32_swap_b32 v49, v53
    v_permlane32_swap_b32 v50, v54
    v_permlane32_swap_b32 v51, v55
    v_add_f32 v48, v48, v52
    v_add_f32 v49, v49, v53
    v_add_f32 v50, v50, v54
    v_add_f32 v51, v51, v55
    s_nop 0
    v_permlane16_swap_b32 v48, v50
    v_permlane16_swap_b32 v49, v51
    v_add_f32 v48, v48, v50
    v_add_f32 v49, v49, v51
    s_nop 0
    v_add_f32_dpp v48, v48, v48 row_ror:8 row_mask:0xf bank_mask:0xf
    v_add_f32_dpp v49, v49, v49 row_ror:8 row_mask:0xf bank_mask:0xf
    v_and_b32 v16, 7, v1
    v_lshlrev_b32 v16, 5, v16
    v_lshrrev_b32 v17, 4, v1
    v_lshl_add_u32 v16, v17, 3, v16
    s_lshl_b32 s16, s3, 8
    s_add_u32 s16, s16, 147456
    v_add_u32 v16, s16, v16
    ds_write_b64 v16, v[48:49]
    s_waitcnt vmcnt(6)
    v_lshlrev_b32 v56, 16, v32
    v_and_b32 v57, 0xffff0000, v32
    v_lshlrev_b32 v58, 16, v33
    v_and_b32 v59, 0xffff0000, v33
    v_lshlrev_b32 v60, 16, v34
    v_and_b32 v61, 0xffff0000, v34
    v_lshlrev_b32 v62, 16, v35
    v_and_b32 v63, 0xffff0000, v35
    s_waitcnt vmcnt(5)
    v_lshlrev_b32 v64, 16, v36
    v_and_b32 v65, 0xffff0000, v36
    v_lshlrev_b32 v66, 16, v37
    v_and_b32 v67, 0xffff0000, v37
    v_lshlrev_b32 v68, 16, v38
    v_and_b32 v69, 0xffff0000, v38
    v_lshlrev_b32 v70, 16, v39
    v_and_b32 v71, 0xffff0000, v39
    v_add_f32 v20, v56, v57
    v_add_f32 v21, v58, v59
    v_add_f32 v20, v20, v60
    v_add_f32 v21, v21, v61
    v_add_f32 v20, v20, v62
    v_add_f32 v21, v21, v63
    v_add_f32 v20, v20, v64
    v_add_f32 v21, v21, v65
    v_add_f32 v20, v20, v66
    v_add_f32 v21, v21, v67
    v_add_f32 v20, v20, v68
    v_add_f32 v21, v21, v69
    v_add_f32 v20, v20, v70
    v_add_f32 v21, v21, v71
    v_add_f32 v128, v20, v21
    s_nop 1
    v_add_f32_dpp v128, v128, v128 row_ror:1 row_mask:0xf bank_mask:0xf
    s_nop 1
    v_add_f32_dpp v128, v128, v128 row_ror:2 row_mask:0xf bank_mask:0xf
    s_nop 1
    v_add_f32_dpp v128, v128, v128 row_ror:4 row_mask:0xf bank_mask:0xf
    s_nop 1
    v_add_f32_dpp v128, v128, v128 row_ror:8 row_mask:0xf bank_mask:0xf
    v_mov_b32 v20, v128
    s_nop 1
    v_permlane16_swap_b32 v128, v20
    v_add_f32 v128, v128, v20
    v_mov_b32 v20, v128
    s_nop 1
    v_permlane32_swap_b32 v128, v20
    v_add_f32 v128, v128, v20
    v_mul_f32 v128, 0x3a800000, v128
    v_sub_f32 v18, v56, v128
    v_mul_f32 v20, v18, v18
    v_sub_f32 v19, v57, v128
    v_mul_f32 v21, v19, v19
    v_sub_f32 v18, v58, v128
    v_sub_f32 v19, v59, v128
    v_fmac_f32 v20, v18, v18
    v_fmac_f32 v21, v19, v19
    v_sub_f32 v18, v60, v128
    v_sub_f32 v19, v61, v128
    v_fmac_f32 v20, v18, v18
    v_fmac_f32 v21, v19, v19
    v_sub_f32 v18, v62, v128
    v_sub_f32 v19, v63, v128
    v_fmac_f32 v20, v18, v18
    v_fmac_f32 v21, v19, v19
    v_sub_f32 v18, v64, v128
    v_sub_f32 v19, v65, v128
    v_fmac_f32 v20, v18, v18
    v_fmac_f32 v21, v19, v19
    v_sub_f32 v18, v66, v128
    v_sub_f32 v19, v67, v128
    v_fmac_f32 v20, v18, v18
    v_fmac_f32 v21, v19, v19
    v_sub_f32 v18, v68, v128
    v_sub_f32 v19, v69, v128
    v_fmac_f32 v20, v18, v18
    v_fmac_f32 v21, v19, v19
    v_sub_f32 v18, v70, v128
    v_sub_f32 v19, v71, v128
    v_fmac_f32 v20, v18, v18
    v_fmac_f32 v21, v19, v19
    v_add_f32 v17, v20, v21
    s_nop 1
    v_add_f32_dpp v17, v17, v17 row_ror:1 row_mask:0xf bank_mask:0xf
    s_nop 1
    v_add_f32_dpp v17, v17, v17 row_ror:2 row_mask:0xf bank_mask:0xf
    s_nop 1
    v_add_f32_dpp v17, v17, v17 row_ror:4 row_mask:0xf bank_mask:0xf
    s_nop 1
    v_add_f32_dpp v17, v17, v17 row_ror:8 row_mask:0xf bank_mask:0xf
    v_mov_b32 v20, v17
    s_nop 1
    v_permlane16_swap_b32 v17, v20
    v_add_f32 v17, v17, v20
    v_mov_b32 v20, v17
    s_nop 1
    v_permlane32_swap_b32 v17, v20
    v_add_f32 v17, v17, v20
    v_mul_f32 v17, 0x3a800000, v17
    v_cvt_pk_bf16_f32 v128, v128, v128
    v_lshlrev_b32 v128, 16, v128
    v_cvt_pk_bf16_f32 v17, v17, v17
    v_lshlrev_b32 v17, 16, v17
    v_add_f32 v17, 0x3727c5ac, v17
    v_cvt_pk_bf16_f32 v17, v17, v17
    v_lshlrev_b32 v17, 16, v17
    v_sqrt_f32 v129, v17
    s_nop 0
    v_cvt_pk_bf16_f32 v129, v129, v129
    v_lshlrev_b32 v129, 16, v129
    v_rcp_f32 v130, v129
    s_lshl_b32 s16, s3, 4
    s_add_u32 s16, s16, 149520
    v_mov_b32 v19, s16
    ds_write_b128 v19, v[128:131]
    s_waitcnt vmcnt(4)
    v_cmp_eq_u32 vcc, 0, v134
    s_cmp_eq_u32 s3, 0
    s_cselect_b64 s[62:63], -1, 0
    s_and_b64 vcc, vcc, s[62:63]
    s_cbranch_vccnz adaLN_cond__sliding_block_cached__moe_arch_mod__prompt_kernel_n1r
adaLN_cond__sliding_block_cached__moe_arch_mod__prompt_kernel_n1b:
    v_mov_b32 v19, 149504
    s_cmp_eq_u32 s3, 0
    s_cselect_b64 exec, 1, 0
    ds_write_b32 v19, v134
    s_mov_b64 exec, -1
    v_mov_b32 v19, 149504
    v_and_b32 v17, 31, v1
    v_lshlrev_b32 v18, 3, v17
    v_add_u32 v18, 147456, v18
    v_lshlrev_b32 v17, 4, v17
    s_waitcnt lgkmcnt(0)
    s_barrier
    ds_read_b32 v134, v19
    ds_read_b64 v[96:97], v18 offset:0
    ds_read_b64 v[100:101], v18 offset:256
    ds_read_b64 v[104:105], v18 offset:512
    ds_read_b64 v[108:109], v18 offset:768
    ds_read_b64 v[112:113], v18 offset:1024
    ds_read_b64 v[116:117], v18 offset:1280
    ds_read_b64 v[120:121], v18 offset:1536
    ds_read_b64 v[124:125], v18 offset:1792
    s_waitcnt lgkmcnt(8)
    v_readfirstlane_b32 s28, v134
    v_and_b32 v20, 7, v1
    v_lshlrev_b32 v20, 4, v20
    v_add_u32 v21, 149520, v20
    ds_read_b128 v[128:131], v21
    s_waitcnt lgkmcnt(0)
    v_mov_b32 v131, s28
    s_lshl_b32 s16, s2, 7
    s_add_u32 s16, s16, 0x520000
    s_cmp_eq_u32 s3, 0
    s_cselect_b32 s16, s16, 0x7ffffff0
    s_mov_b64 exec, 0xff
    buffer_store_dwordx4 v[128:131], v20, s[8:11], s16 offen sc1
    s_mov_b64 exec, -1
    v_pk_add_f32 v[96:97], v[96:97], v[112:113]
    v_pk_add_f32 v[100:101], v[100:101], v[116:117]
    v_pk_add_f32 v[104:105], v[104:105], v[120:121]
    v_pk_add_f32 v[108:109], v[108:109], v[124:125]
    v_pk_add_f32 v[96:97], v[96:97], v[104:105]
    v_pk_add_f32 v[100:101], v[100:101], v[108:109]
    v_pk_add_f32 v[96:97], v[96:97], v[100:101]
    v_mov_b32 v98, s28
    v_mov_b32 v99, s28
    s_lshl_b32 s16, s14, 3
    s_add_u32 s16, s16, s15
    s_lshl_b32 s16, s16, 9
    s_add_u32 s16, s16, 0x500000
    s_cmp_eq_u32 s3, 0
    s_cselect_b32 s16, s16, 0x7ffffff0
    s_mov_b64 exec, 0xffffffff
    buffer_store_dwordx4 v[96:99], v17, s[8:11], s16 offen sc1
    s_mov_b64 exec, -1
    s_lshr_b32 s16, s3, 2
    s_lshl_b32 s16, s16, 4
    s_add_u32 s16, s16, s31
    s_lshl_b32 s16, s16, 12
    s_and_b32 s17, s3, 3
    s_lshl_b32 s17, s17, 7
    s_add_u32 s16, s16, s17
    s_add_u32 s16, s16, 0x500000
    v_lshrrev_b32 v139, 3, v1
    v_lshlrev_b32 v139, 9, v139
    v_and_b32 v16, 7, v1
    v_lshl_add_u32 v139, v16, 4, v139
    v_and_b32 v140, 15, v1
    v_lshlrev_b32 v140, 4, v140
    s_lshl_b32 s17, s29, 8
    s_add_u32 s17, s17, 0x520000
    s_waitcnt vmcnt(4)
    v_lshlrev_b32 v56, 16, v40
    v_and_b32 v57, 0xffff0000, v40
    v_lshlrev_b32 v58, 16, v41
    v_and_b32 v59, 0xffff0000, v41
    v_lshlrev_b32 v60, 16, v42
    v_and_b32 v61, 0xffff0000, v42
    v_lshlrev_b32 v62, 16, v43
    v_and_b32 v63, 0xffff0000, v43
    s_waitcnt vmcnt(3)
    v_lshlrev_b32 v64, 16, v44
    v_and_b32 v65, 0xffff0000, v44
    v_lshlrev_b32 v66, 16, v45
    v_and_b32 v67, 0xffff0000, v45
    v_lshlrev_b32 v68, 16, v46
    v_and_b32 v69, 0xffff0000, v46
    v_lshlrev_b32 v70, 16, v47
    v_and_b32 v71, 0xffff0000, v47
    s_mov_b32 s27, 0
adaLN_cond__sliding_block_cached__moe_arch_mod__prompt_kernel_g2p:
    buffer_load_dwordx4 v[76:79], v139, s[8:11], s16 offen sc1
    buffer_load_dwordx4 v[80:83], v140, s[8:11], s17 offen sc1
    s_waitcnt vmcnt(1)
    v_cmp_ne_u32 vcc, s28, v78
    v_cmp_ne_u32 s[62:63], s28, v79
    s_or_b64 vcc, vcc, s[62:63]
    s_waitcnt vmcnt(0)
    v_cmp_ne_u32 s[62:63], s28, v83
    s_or_b64 vcc, vcc, s[62:63]
    s_add_u32 s27, s27, 1
    s_cmp_ge_u32 s27, 65536
    s_cbranch_scc1 adaLN_cond__sliding_block_cached__moe_arch_mod__prompt_kernel_g2g
    s_cbranch_vccnz adaLN_cond__sliding_block_cached__moe_arch_mod__prompt_kernel_g2p
adaLN_cond__sliding_block_cached__moe_arch_mod__prompt_kernel_g2g:
    v_add_f32_dpp v76, v76, v76 row_ror:8 row_mask:0xf bank_mask:0xf
    v_add_f32_dpp v77, v77, v77 row_ror:8 row_mask:0xf bank_mask:0xf
    v_mov_b32 v17, v76
    s_nop 1
    v_permlane16_swap_b32 v76, v17
    v_add_f32 v76, v76, v17
    v_mov_b32 v18, v77
    s_nop 1
    v_permlane16_swap_b32 v77, v18
    v_add_f32 v77, v77, v18
    v_mov_b32 v17, v76
    s_nop 1
    v_permlane32_swap_b32 v76, v17
    v_add_f32 v76, v76, v17
    v_mov_b32 v18, v77
    s_nop 1
    v_permlane32_swap_b32 v77, v18
    v_add_f32 v77, v77, v18
    v_cvt_pk_bf16_f32 v17, v76, v77
    v_lshlrev_b32 v76, 16, v17
    v_and_b32 v77, 0xffff0000, v17
    v_add_f32 v76, 0, v76
    v_add_f32 v77, 0, v77
    s_lshl_b32 s16, s3, 6
    s_add_u32 s16, s16, 151552
    v_lshl_add_u32 v16, v16, 3, s16
    ds_write_b64 v16, v[76:77]
    v_lshrrev_b32 v17, 4, v1
    v_lshlrev_b32 v17, 5, v17
    v_add_u32 v17, 151552, v17
    v_sub_f32 v56, v56, v80
    v_sub_f32 v57, v57, v80
    v_sub_f32 v58, v58, v80
    v_sub_f32 v59, v59, v80
    v_sub_f32 v60, v60, v80
    v_sub_f32 v61, v61, v80
    v_sub_f32 v62, v62, v80
    v_sub_f32 v63, v63, v80
    v_sub_f32 v64, v64, v80
    v_sub_f32 v65, v65, v80
    v_sub_f32 v66, v66, v80
    v_sub_f32 v67, v67, v80
    v_sub_f32 v68, v68, v80
    v_sub_f32 v69, v69, v80
    v_sub_f32 v70, v70, v80
    v_sub_f32 v71, v71, v80
    v_cvt_pk_bf16_f32 v18, v56, v57
    v_lshlrev_b32 v56, 16, v18
    v_and_b32 v57, 0xffff0000, v18
    v_cvt_pk_bf16_f32 v19, v58, v59
    v_lshlrev_b32 v58, 16, v19
    v_and_b32 v59, 0xffff0000, v19
    v_cvt_pk_bf16_f32 v18, v60, v61
    v_lshlrev_b32 v60, 16, v18
    v_and_b32 v61, 0xffff0000, v18
    v_cvt_pk_bf16_f32 v19, v62, v63
    v_lshlrev_b32 v62, 16, v19
    v_and_b32 v63, 0xffff0000, v19
    v_cvt_pk_bf16_f32 v18, v64, v65
    v_lshlrev_b32 v64, 16, v18
    v_and_b32 v65, 0xffff0000, v18
    v_cvt_pk_bf16_f32 v19, v66, v67
    v_lshlrev_b32 v66, 16, v19
    v_and_b32 v67, 0xffff0000, v19
    v_cvt_pk_bf16_f32 v18, v68, v69
    v_lshlrev_b32 v68, 16, v18
    v_and_b32 v69, 0xffff0000, v18
    v_cvt_pk_bf16_f32 v19, v70, v71
    v_lshlrev_b32 v70, 16, v19
    v_and_b32 v71, 0xffff0000, v19
    v_mul_f32 v56, v56, v82
    v_mul_f32 v57, v57, v82
    v_mul_f32 v58, v58, v82
    v_mul_f32 v59, v59, v82
    v_mul_f32 v60, v60, v82
    v_mul_f32 v61, v61, v82
    v_mul_f32 v62, v62, v82
    v_mul_f32 v63, v63, v82
    v_mul_f32 v64, v64, v82
    v_mul_f32 v65, v65, v82
    v_mul_f32 v66, v66, v82
    v_mul_f32 v67, v67, v82
    v_mul_f32 v68, v68, v82
    v_mul_f32 v69, v69, v82
    v_mul_f32 v70, v70, v82
    v_mul_f32 v71, v71, v82
    v_cvt_pk_bf16_f32 v18, v56, v57
    v_lshlrev_b32 v56, 16, v18
    v_and_b32 v57, 0xffff0000, v18
    v_cvt_pk_bf16_f32 v19, v58, v59
    v_lshlrev_b32 v58, 16, v19
    v_and_b32 v59, 0xffff0000, v19
    v_cvt_pk_bf16_f32 v18, v60, v61
    v_lshlrev_b32 v60, 16, v18
    v_and_b32 v61, 0xffff0000, v18
    v_cvt_pk_bf16_f32 v19, v62, v63
    v_lshlrev_b32 v62, 16, v19
    v_and_b32 v63, 0xffff0000, v19
    v_cvt_pk_bf16_f32 v18, v64, v65
    v_lshlrev_b32 v64, 16, v18
    v_and_b32 v65, 0xffff0000, v18
    v_cvt_pk_bf16_f32 v19, v66, v67
    v_lshlrev_b32 v66, 16, v19
    v_and_b32 v67, 0xffff0000, v19
    v_cvt_pk_bf16_f32 v18, v68, v69
    v_lshlrev_b32 v68, 16, v18
    v_and_b32 v69, 0xffff0000, v18
    v_cvt_pk_bf16_f32 v19, v70, v71
    v_lshlrev_b32 v70, 16, v19
    v_and_b32 v71, 0xffff0000, v19
    s_lshl_b32 s16, s29, 15
    s_lshl_b32 s17, s31, 11
    s_add_u32 s16, s16, s17
    s_waitcnt lgkmcnt(0)
    s_barrier
    ds_read_b128 v[96:99], v17 offset:256
    ds_read_b128 v[104:107], v17 offset:0
    ds_read_b128 v[100:103], v17 offset:272
    ds_read_b128 v[108:111], v17 offset:16
    ds_read_b128 v[112:115], v17 offset:384
    ds_read_b128 v[120:123], v17 offset:128
    ds_read_b128 v[116:119], v17 offset:400
    ds_read_b128 v[124:127], v17 offset:144
    s_waitcnt lgkmcnt(7)
    v_pk_mul_f32 v[56:57], v[56:57], v[96:97]
    v_pk_mul_f32 v[58:59], v[58:59], v[98:99]
    s_waitcnt lgkmcnt(5)
    v_pk_mul_f32 v[60:61], v[60:61], v[100:101]
    v_pk_mul_f32 v[62:63], v[62:63], v[102:103]
    v_cvt_pk_bf16_f32 v18, v56, v57
    v_lshlrev_b32 v56, 16, v18
    v_and_b32 v57, 0xffff0000, v18
    v_cvt_pk_bf16_f32 v19, v58, v59
    v_lshlrev_b32 v58, 16, v19
    v_and_b32 v59, 0xffff0000, v19
    v_cvt_pk_bf16_f32 v18, v60, v61
    v_lshlrev_b32 v60, 16, v18
    v_and_b32 v61, 0xffff0000, v18
    v_cvt_pk_bf16_f32 v19, v62, v63
    v_lshlrev_b32 v62, 16, v19
    v_and_b32 v63, 0xffff0000, v19
    v_pk_add_f32 v[56:57], v[56:57], v[104:105]
    v_pk_add_f32 v[58:59], v[58:59], v[106:107]
    s_waitcnt lgkmcnt(4)
    v_pk_add_f32 v[60:61], v[60:61], v[108:109]
    v_pk_add_f32 v[62:63], v[62:63], v[110:111]
    v_cvt_pk_bf16_f32 v32, v56, v57
    v_cvt_pk_bf16_f32 v33, v58, v59
    v_cvt_pk_bf16_f32 v34, v60, v61
    v_cvt_pk_bf16_f32 v35, v62, v63
    buffer_store_dwordx4 v[32:35], v2, s[8:11], s16 offen offset:0 sc1
    s_waitcnt lgkmcnt(3)
    v_pk_mul_f32 v[64:65], v[64:65], v[112:113]
    v_pk_mul_f32 v[66:67], v[66:67], v[114:115]
    s_waitcnt lgkmcnt(1)
    v_pk_mul_f32 v[68:69], v[68:69], v[116:117]
    v_pk_mul_f32 v[70:71], v[70:71], v[118:119]
    v_cvt_pk_bf16_f32 v18, v64, v65
    v_lshlrev_b32 v64, 16, v18
    v_and_b32 v65, 0xffff0000, v18
    v_cvt_pk_bf16_f32 v19, v66, v67
    v_lshlrev_b32 v66, 16, v19
    v_and_b32 v67, 0xffff0000, v19
    v_cvt_pk_bf16_f32 v18, v68, v69
    v_lshlrev_b32 v68, 16, v18
    v_and_b32 v69, 0xffff0000, v18
    v_cvt_pk_bf16_f32 v19, v70, v71
    v_lshlrev_b32 v70, 16, v19
    v_and_b32 v71, 0xffff0000, v19
    v_pk_add_f32 v[64:65], v[64:65], v[120:121]
    v_pk_add_f32 v[66:67], v[66:67], v[122:123]
    s_waitcnt lgkmcnt(0)
    v_pk_add_f32 v[68:69], v[68:69], v[124:125]
    v_pk_add_f32 v[70:71], v[70:71], v[126:127]
    v_cvt_pk_bf16_f32 v36, v64, v65
    v_cvt_pk_bf16_f32 v37, v66, v67
    v_cvt_pk_bf16_f32 v38, v68, v69
    v_cvt_pk_bf16_f32 v39, v70, v71
    buffer_store_dwordx4 v[36:39], v2, s[8:11], s16 offen offset:1024 sc1
    s_lshl_b32 s19, s3, 16
    s_lshl_b32 s20, s3, 11
    s_lshl_b32 s16, s12, 8
    s_add_u32 s4, s38, s16
    s_addc_u32 s5, s39, 0
    s_sub_u32 s6, 0x800000, s16
    s_mov_b32 s7, 0x20000
    v_mov_b32 v134, s28
    s_lshl_b32 s16, s29, 4
    s_add_u32 s16, s16, s31
    s_lshl_b32 s16, s16, 2
    s_add_u32 s16, s16, 0x528000
    v_and_b32 v16, 31, v1
    v_lshlrev_b32 v16, 2, v16
    s_lshl_b32 s17, s13, 3
    s_add_u32 s17, s17, s3
    s_lshl_b32 s17, s17, 7
    s_add_u32 s17, s17, 0x528000
    s_waitcnt vmcnt(0)
    s_mov_b64 exec, 1
    buffer_store_dword v134, v132, s[8:11], s16 offen sc1
    s_mov_b64 exec, -1
    s_add_u32 s22, s19, 0x0
    s_add_u32 m0, s20, 0x0
    s_nop 0
    buffer_load_dwordx4 v3, s[4:7], s22 offen lds
    s_add_u32 s22, s19, 0x8000
    s_add_u32 m0, s20, 0x400
    s_nop 0
    buffer_load_dwordx4 v3, s[4:7], s22 offen lds
    s_add_u32 s22, s19, 0x80000
    s_add_u32 m0, s20, 0x4000
    s_nop 0
    buffer_load_dwordx4 v3, s[4:7], s22 offen lds
    s_add_u32 s22, s19, 0x88000
    s_add_u32 m0, s20, 0x4400
    s_nop 0
    buffer_load_dwordx4 v3, s[4:7], s22 offen lds
    s_add_u32 s22, s19, 0x100000
    s_add_u32 m0, s20, 0x8000
    s_nop 0
    buffer_load_dwordx4 v3, s[4:7], s22 offen lds
    s_add_u32 s22, s19, 0x108000
    s_add_u32 m0, s20, 0x8400
    s_nop 0
    buffer_load_dwordx4 v3, s[4:7], s22 offen lds
    s_waitcnt vmcnt(0)
    s_mov_b32 s27, 0
adaLN_cond__sliding_block_cached__moe_arch_mod__prompt_kernel_h3p:
    buffer_load_dword v17, v16, s[8:11], s17 offen sc1
    s_waitcnt vmcnt(0)
    v_cmp_ne_u32 vcc, s28, v17
    s_add_u32 s27, s27, 1
    s_cmp_ge_u32 s27, 65536
    s_cbranch_scc1 adaLN_cond__sliding_block_cached__moe_arch_mod__prompt_kernel_h3g
    s_cbranch_vccnz adaLN_cond__sliding_block_cached__moe_arch_mod__prompt_kernel_h3p
adaLN_cond__sliding_block_cached__moe_arch_mod__prompt_kernel_h3g:
    s_mov_b32 s23, 0x0
    buffer_load_dwordx4 v[88:91], v7, s[8:11], s23 offen offset:0 sc1
    s_mov_b32 s23, 0x8000
    buffer_load_dwordx4 v[92:95], v7, s[8:11], s23 offen offset:0 sc1
    s_mov_b32 s23, 0x0
    buffer_load_dwordx4 v[96:99], v7, s[8:11], s23 offen offset:1024 sc1
    s_mov_b32 s23, 0x8000
    buffer_load_dwordx4 v[100:103], v7, s[8:11], s23 offen offset:1024 sc1
    s_mov_b32 s23, 0x800
    buffer_load_dwordx4 v[104:107], v7, s[8:11], s23 offen offset:0 sc1
    s_mov_b32 s23, 0x8800
    buffer_load_dwordx4 v[108:111], v7, s[8:11], s23 offen offset:0 sc1
    s_mov_b32 s23, 0x800
    buffer_load_dwordx4 v[112:115], v7, s[8:11], s23 offen offset:1024 sc1
    s_mov_b32 s23, 0x8800
    buffer_load_dwordx4 v[116:119], v7, s[8:11], s23 offen offset:1024 sc1
    s_lshr_b32 s21, s12, 3
    s_lshl_b32 s21, s21, 17
    s_add_u32 s21, s21, s20
    s_add_u32 s21, s21, 0x400000
    s_barrier
    ds_read_b64_tr_b16 v[224:225], v4 offset:0
    ds_read_b64_tr_b16 v[226:227], v4 offset:1024
    ds_read_b64_tr_b16 v[228:229], v5 offset:32
    ds_read_b64_tr_b16 v[230:231], v5 offset:1056
    ds_read_b64_tr_b16 v[232:233], v4 offset:256
    ds_read_b64_tr_b16 v[234:235], v4 offset:1280
    ds_read_b64_tr_b16 v[236:237], v5 offset:288
    ds_read_b64_tr_b16 v[238:239], v5 offset:1312
    s_waitcnt vmcnt(7) lgkmcnt(6)
    v_mfma_f32_16x16x32_bf16 v[24:27], v[224:227], v[88:91], 0
    ds_read_b64_tr_b16 v[240:241], v4 offset:512
    s_waitcnt vmcnt(6)
    v_mfma_f32_16x16x32_bf16 v[28:31], v[224:227], v[92:95], 0
    ds_read_b64_tr_b16 v[242:243], v4 offset:1536
    s_waitcnt lgkmcnt(6)
    v_mfma_f32_16x16x32_bf16 v[32:35], v[228:231], v[88:91], 0
    ds_read_b64_tr_b16 v[244:245], v5 offset:544
    v_mfma_f32_16x16x32_bf16 v[36:39], v[228:231], v[92:95], 0
    ds_read_b64_tr_b16 v[246:247], v5 offset:1568
    s_mov_b32 s23, 0x1000
    buffer_load_dwordx4 v[120:123], v7, s[8:11], s23 offen offset:0 sc1
    s_waitcnt lgkmcnt(6)
    v_mfma_f32_16x16x32_bf16 v[40:43], v[232:235], v[88:91], 0
    ds_read_b64_tr_b16 v[224:225], v4 offset:768
    v_mfma_f32_16x16x32_bf16 v[44:47], v[232:235], v[92:95], 0
    ds_read_b64_tr_b16 v[226:227], v4 offset:1792
    s_waitcnt lgkmcnt(6)
    v_mfma_f32_16x16x32_bf16 v[48:51], v[236:239], v[88:91], 0
    ds_read_b64_tr_b16 v[228:229], v5 offset:800
    v_mfma_f32_16x16x32_bf16 v[52:55], v[236:239], v[92:95], 0
    ds_read_b64_tr_b16 v[230:231], v5 offset:1824
    s_waitcnt lgkmcnt(6)
    v_mfma_f32_16x16x32_bf16 v[56:59], v[240:243], v[88:91], 0
    ds_read_b64_tr_b16 v[232:233], v4 offset:8192
    v_mfma_f32_16x16x32_bf16 v[60:63], v[240:243], v[92:95], 0
    ds_read_b64_tr_b16 v[234:235], v4 offset:9216
    s_waitcnt lgkmcnt(6)
    v_mfma_f32_16x16x32_bf16 v[64:67], v[244:247], v[88:91], 0
    ds_read_b64_tr_b16 v[236:237], v5 offset:8224
    v_mfma_f32_16x16x32_bf16 v[68:71], v[244:247], v[92:95], 0
    ds_read_b64_tr_b16 v[238:239], v5 offset:9248
    s_mov_b32 s23, 0x9000
    buffer_load_dwordx4 v[124:127], v7, s[8:11], s23 offen offset:0 sc1
    s_waitcnt lgkmcnt(6)
    v_mfma_f32_16x16x32_bf16 v[72:75], v[224:227], v[88:91], 0
    ds_read_b64_tr_b16 v[240:241], v4 offset:8448
    v_mfma_f32_16x16x32_bf16 v[76:79], v[224:227], v[92:95], 0
    ds_read_b64_tr_b16 v[242:243], v4 offset:9472
    s_waitcnt lgkmcnt(6)
    v_mfma_f32_16x16x32_bf16 v[80:83], v[228:231], v[88:91], 0
    ds_read_b64_tr_b16 v[244:245], v5 offset:8480
    v_mfma_f32_16x16x32_bf16 v[84:87], v[228:231], v[92:95], 0
    ds_read_b64_tr_b16 v[246:247], v5 offset:9504
    s_waitcnt vmcnt(7) lgkmcnt(6)
    v_mfma_f32_16x16x32_bf16 v[24:27], v[232:235], v[96:99], v[24:27]
    ds_read_b64_tr_b16 v[224:225], v4 offset:8704
    s_waitcnt vmcnt(6)
    v_mfma_f32_16x16x32_bf16 v[28:31], v[232:235], v[100:103], v[28:31]
    ds_read_b64_tr_b16 v[226:227], v4 offset:9728
    s_waitcnt lgkmcnt(6)
    v_mfma_f32_16x16x32_bf16 v[32:35], v[236:239], v[96:99], v[32:35]
    ds_read_b64_tr_b16 v[228:229], v5 offset:8736
    v_mfma_f32_16x16x32_bf16 v[36:39], v[236:239], v[100:103], v[36:39]
    ds_read_b64_tr_b16 v[230:231], v5 offset:9760
    s_mov_b32 s23, 0x1000
    buffer_load_dwordx4 v[128:131], v7, s[8:11], s23 offen offset:1024 sc1
    s_waitcnt lgkmcnt(6)
    v_mfma_f32_16x16x32_bf16 v[40:43], v[240:243], v[96:99], v[40:43]
    ds_read_b64_tr_b16 v[232:233], v4 offset:8960
    v_mfma_f32_16x16x32_bf16 v[44:47], v[240:243], v[100:103], v[44:47]
    ds_read_b64_tr_b16 v[234:235], v4 offset:9984
    s_waitcnt lgkmcnt(6)
    v_mfma_f32_16x16x32_bf16 v[48:51], v[244:247], v[96:99], v[48:51]
    ds_read_b64_tr_b16 v[236:237], v5 offset:8992
    v_mfma_f32_16x16x32_bf16 v[52:55], v[244:247], v[100:103], v[52:55]
    ds_read_b64_tr_b16 v[238:239], v5 offset:10016
    s_waitcnt lgkmcnt(6)
    v_mfma_f32_16x16x32_bf16 v[56:59], v[224:227], v[96:99], v[56:59]
    v_mfma_f32_16x16x32_bf16 v[60:63], v[224:227], v[100:103], v[60:63]
    s_barrier
    ds_read_b64_tr_b16 v[240:241], v4 offset:16384
    ds_read_b64_tr_b16 v[242:243], v4 offset:17408
    s_waitcnt lgkmcnt(6)
    v_mfma_f32_16x16x32_bf16 v[64:67], v[228:231], v[96:99], v[64:67]
    ds_read_b64_tr_b16 v[244:245], v5 offset:16416
    v_mfma_f32_16x16x32_bf16 v[68:71], v[228:231], v[100:103], v[68:71]
    s_add_u32 s22, s19, 0x180000
    s_add_u32 m0, s20, 0xc000
    s_nop 0
    buffer_load_dwordx4 v3, s[4:7], s22 offen lds
    ds_read_b64_tr_b16 v[246:247], v5 offset:17440
    s_mov_b32 s23, 0x9000
    buffer_load_dwordx4 v[132:135], v7, s[8:11], s23 offen offset:1024 sc1
    s_waitcnt lgkmcnt(6)
    v_mfma_f32_16x16x32_bf16 v[72:75], v[232:235], v[96:99], v[72:75]
    ds_read_b64_tr_b16 v[224:225], v4 offset:16640
    v_mfma_f32_16x16x32_bf16 v[76:79], v[232:235], v[100:103], v[76:79]
    ds_read_b64_tr_b16 v[226:227], v4 offset:17664
    s_waitcnt lgkmcnt(6)
    v_mfma_f32_16x16x32_bf16 v[80:83], v[236:239], v[96:99], v[80:83]
    ds_read_b64_tr_b16 v[228:229], v5 offset:16672
    v_mfma_f32_16x16x32_bf16 v[84:87], v[236:239], v[100:103], v[84:87]
    ds_read_b64_tr_b16 v[230:231], v5 offset:17696
    s_waitcnt vmcnt(8) lgkmcnt(6)
    v_mfma_f32_16x16x32_bf16 v[24:27], v[240:243], v[104:107], v[24:27]
    ds_read_b64_tr_b16 v[232:233], v4 offset:16896
    s_waitcnt vmcnt(7)
    v_mfma_f32_16x16x32_bf16 v[28:31], v[240:243], v[108:111], v[28:31]
    ds_read_b64_tr_b16 v[234:235], v4 offset:17920
    s_waitcnt lgkmcnt(6)
    v_mfma_f32_16x16x32_bf16 v[32:35], v[244:247], v[104:107], v[32:35]
    ds_read_b64_tr_b16 v[236:237], v5 offset:16928
    v_mfma_f32_16x16x32_bf16 v[36:39], v[244:247], v[108:111], v[36:39]
    s_add_u32 s22, s19, 0x188000
    s_add_u32 m0, s20, 0xc400
    s_nop 0
    buffer_load_dwordx4 v3, s[4:7], s22 offen lds
    ds_read_b64_tr_b16 v[238:239], v5 offset:17952
    s_mov_b32 s23, 0x1800
    buffer_load_dwordx4 v[88:91], v7, s[8:11], s23 offen offset:0 sc1
    s_waitcnt lgkmcnt(6)
    v_mfma_f32_16x16x32_bf16 v[40:43], v[224:227], v[104:107], v[40:43]
    ds_read_b64_tr_b16 v[240:241], v4 offset:17152
    v_mfma_f32_16x16x32_bf16 v[44:47], v[224:227], v[108:111], v[44:47]
    ds_read_b64_tr_b16 v[242:243], v4 offset:18176
    s_waitcnt lgkmcnt(6)
    v_mfma_f32_16x16x32_bf16 v[48:51], v[228:231], v[104:107], v[48:51]
    ds_read_b64_tr_b16 v[244:245], v5 offset:17184
    v_mfma_f32_16x16x32_bf16 v[52:55], v[228:231], v[108:111], v[52:55]
    ds_read_b64_tr_b16 v[246:247], v5 offset:18208
    s_waitcnt lgkmcnt(6)
    v_mfma_f32_16x16x32_bf16 v[56:59], v[232:235], v[104:107], v[56:59]
    ds_read_b64_tr_b16 v[224:225], v4 offset:24576
    v_mfma_f32_16x16x32_bf16 v[60:63], v[232:235], v[108:111], v[60:63]
    ds_read_b64_tr_b16 v[226:227], v4 offset:25600
    s_waitcnt lgkmcnt(6)
    v_mfma_f32_16x16x32_bf16 v[64:67], v[236:239], v[104:107], v[64:67]
    ds_read_b64_tr_b16 v[228:229], v5 offset:24608
    v_mfma_f32_16x16x32_bf16 v[68:71], v[236:239], v[108:111], v[68:71]
    ds_read_b64_tr_b16 v[230:231], v5 offset:25632
    s_mov_b32 s23, 0x9800
    buffer_load_dwordx4 v[92:95], v7, s[8:11], s23 offen offset:0 sc1
    s_waitcnt lgkmcnt(6)
    v_mfma_f32_16x16x32_bf16 v[72:75], v[240:243], v[104:107], v[72:75]
    ds_read_b64_tr_b16 v[232:233], v4 offset:24832
    v_mfma_f32_16x16x32_bf16 v[76:79], v[240:243], v[108:111], v[76:79]
    ds_read_b64_tr_b16 v[234:235], v4 offset:25856
    s_waitcnt lgkmcnt(6)
    v_mfma_f32_16x16x32_bf16 v[80:83], v[244:247], v[104:107], v[80:83]
    ds_read_b64_tr_b16 v[236:237], v5 offset:24864
    v_mfma_f32_16x16x32_bf16 v[84:87], v[244:247], v[108:111], v[84:87]
    ds_read_b64_tr_b16 v[238:239], v5 offset:25888
    s_waitcnt vmcnt(9) lgkmcnt(6)
    v_mfma_f32_16x16x32_bf16 v[24:27], v[224:227], v[112:115], v[24:27]
    ds_read_b64_tr_b16 v[240:241], v4 offset:25088
    s_waitcnt vmcnt(8)
    v_mfma_f32_16x16x32_bf16 v[28:31], v[224:227], v[116:119], v[28:31]
    ds_read_b64_tr_b16 v[242:243], v4 offset:26112
    s_waitcnt lgkmcnt(6)
    v_mfma_f32_16x16x32_bf16 v[32:35], v[228:231], v[112:115], v[32:35]
    ds_read_b64_tr_b16 v[244:245], v5 offset:25120
    v_mfma_f32_16x16x32_bf16 v[36:39], v[228:231], v[116:119], v[36:39]
    ds_read_b64_tr_b16 v[246:247], v5 offset:26144
    s_mov_b32 s23, 0x1800
    buffer_load_dwordx4 v[96:99], v7, s[8:11], s23 offen offset:1024 sc1
    s_waitcnt lgkmcnt(6)
    v_mfma_f32_16x16x32_bf16 v[40:43], v[232:235], v[112:115], v[40:43]
    ds_read_b64_tr_b16 v[224:225], v4 offset:25344
    v_mfma_f32_16x16x32_bf16 v[44:47], v[232:235], v[116:119], v[44:47]
    ds_read_b64_tr_b16 v[226:227], v4 offset:26368
    s_waitcnt lgkmcnt(6)
    v_mfma_f32_16x16x32_bf16 v[48:51], v[236:239], v[112:115], v[48:51]
    ds_read_b64_tr_b16 v[228:229], v5 offset:25376
    v_mfma_f32_16x16x32_bf16 v[52:55], v[236:239], v[116:119], v[52:55]
    ds_read_b64_tr_b16 v[230:231], v5 offset:26400
    s_waitcnt lgkmcnt(6)
    v_mfma_f32_16x16x32_bf16 v[56:59], v[240:243], v[112:115], v[56:59]
    v_mfma_f32_16x16x32_bf16 v[60:63], v[240:243], v[116:119], v[60:63]
    s_barrier
    ds_read_b64_tr_b16 v[232:233], v4 offset:32768
    ds_read_b64_tr_b16 v[234:235], v4 offset:33792
    s_waitcnt lgkmcnt(6)
    v_mfma_f32_16x16x32_bf16 v[64:67], v[244:247], v[112:115], v[64:67]
    ds_read_b64_tr_b16 v[236:237], v5 offset:32800
    v_mfma_f32_16x16x32_bf16 v[68:71], v[244:247], v[116:119], v[68:71]
    s_add_u32 s22, s19, 0x200000
    s_add_u32 m0, s20, 0x0
    s_nop 0
    buffer_load_dwordx4 v3, s[4:7], s22 offen lds
    ds_read_b64_tr_b16 v[238:239], v5 offset:33824
    s_mov_b32 s23, 0x9800
    buffer_load_dwordx4 v[100:103], v7, s[8:11], s23 offen offset:1024 sc1
    s_waitcnt lgkmcnt(6)
    v_mfma_f32_16x16x32_bf16 v[72:75], v[224:227], v[112:115], v[72:75]
    ds_read_b64_tr_b16 v[240:241], v4 offset:33024
    v_mfma_f32_16x16x32_bf16 v[76:79], v[224:227], v[116:119], v[76:79]
    ds_read_b64_tr_b16 v[242:243], v4 offset:34048
    s_waitcnt lgkmcnt(6)
    v_mfma_f32_16x16x32_bf16 v[80:83], v[228:231], v[112:115], v[80:83]
    ds_read_b64_tr_b16 v[244:245], v5 offset:33056
    v_mfma_f32_16x16x32_bf16 v[84:87], v[228:231], v[116:119], v[84:87]
    ds_read_b64_tr_b16 v[246:247], v5 offset:34080
    s_waitcnt vmcnt(10) lgkmcnt(6)
    v_mfma_f32_16x16x32_bf16 v[24:27], v[232:235], v[120:123], v[24:27]
    ds_read_b64_tr_b16 v[224:225], v4 offset:33280
    s_waitcnt vmcnt(9)
    v_mfma_f32_16x16x32_bf16 v[28:31], v[232:235], v[124:127], v[28:31]
    ds_read_b64_tr_b16 v[226:227], v4 offset:34304
    s_waitcnt lgkmcnt(6)
    v_mfma_f32_16x16x32_bf16 v[32:35], v[236:239], v[120:123], v[32:35]
    ds_read_b64_tr_b16 v[228:229], v5 offset:33312
    v_mfma_f32_16x16x32_bf16 v[36:39], v[236:239], v[124:127], v[36:39]
    s_add_u32 s22, s19, 0x208000
    s_add_u32 m0, s20, 0x400
    s_nop 0
    buffer_load_dwordx4 v3, s[4:7], s22 offen lds
    ds_read_b64_tr_b16 v[230:231], v5 offset:34336
    s_mov_b32 s23, 0x2000
    buffer_load_dwordx4 v[104:107], v7, s[8:11], s23 offen offset:0 sc1
    s_waitcnt lgkmcnt(6)
    v_mfma_f32_16x16x32_bf16 v[40:43], v[240:243], v[120:123], v[40:43]
    ds_read_b64_tr_b16 v[232:233], v4 offset:33536
    v_mfma_f32_16x16x32_bf16 v[44:47], v[240:243], v[124:127], v[44:47]
    ds_read_b64_tr_b16 v[234:235], v4 offset:34560
    s_waitcnt lgkmcnt(6)
    v_mfma_f32_16x16x32_bf16 v[48:51], v[244:247], v[120:123], v[48:51]
    ds_read_b64_tr_b16 v[236:237], v5 offset:33568
    v_mfma_f32_16x16x32_bf16 v[52:55], v[244:247], v[124:127], v[52:55]
    ds_read_b64_tr_b16 v[238:239], v5 offset:34592
    s_waitcnt lgkmcnt(6)
    v_mfma_f32_16x16x32_bf16 v[56:59], v[224:227], v[120:123], v[56:59]
    ds_read_b64_tr_b16 v[240:241], v4 offset:40960
    v_mfma_f32_16x16x32_bf16 v[60:63], v[224:227], v[124:127], v[60:63]
    ds_read_b64_tr_b16 v[242:243], v4 offset:41984
    s_waitcnt lgkmcnt(6)
    v_mfma_f32_16x16x32_bf16 v[64:67], v[228:231], v[120:123], v[64:67]
    ds_read_b64_tr_b16 v[244:245], v5 offset:40992
    v_mfma_f32_16x16x32_bf16 v[68:71], v[228:231], v[124:127], v[68:71]
    ds_read_b64_tr_b16 v[246:247], v5 offset:42016
    s_mov_b32 s23, 0xa000
    buffer_load_dwordx4 v[108:111], v7, s[8:11], s23 offen offset:0 sc1
    s_waitcnt lgkmcnt(6)
    v_mfma_f32_16x16x32_bf16 v[72:75], v[232:235], v[120:123], v[72:75]
    ds_read_b64_tr_b16 v[224:225], v4 offset:41216
    v_mfma_f32_16x16x32_bf16 v[76:79], v[232:235], v[124:127], v[76:79]
    ds_read_b64_tr_b16 v[226:227], v4 offset:42240
    s_waitcnt lgkmcnt(6)
    v_mfma_f32_16x16x32_bf16 v[80:83], v[236:239], v[120:123], v[80:83]
    ds_read_b64_tr_b16 v[228:229], v5 offset:41248
    v_mfma_f32_16x16x32_bf16 v[84:87], v[236:239], v[124:127], v[84:87]
    ds_read_b64_tr_b16 v[230:231], v5 offset:42272
    s_waitcnt vmcnt(11) lgkmcnt(6)
    v_mfma_f32_16x16x32_bf16 v[24:27], v[240:243], v[128:131], v[24:27]
    ds_read_b64_tr_b16 v[232:233], v4 offset:41472
    s_waitcnt vmcnt(9)
    v_mfma_f32_16x16x32_bf16 v[28:31], v[240:243], v[132:135], v[28:31]
    ds_read_b64_tr_b16 v[234:235], v4 offset:42496
    s_waitcnt lgkmcnt(6)
    v_mfma_f32_16x16x32_bf16 v[32:35], v[244:247], v[128:131], v[32:35]
    ds_read_b64_tr_b16 v[236:237], v5 offset:41504
    v_mfma_f32_16x16x32_bf16 v[36:39], v[244:247], v[132:135], v[36:39]
    ds_read_b64_tr_b16 v[238:239], v5 offset:42528
    s_mov_b32 s23, 0x2000
    buffer_load_dwordx4 v[112:115], v7, s[8:11], s23 offen offset:1024 sc1
    s_waitcnt lgkmcnt(6)
    v_mfma_f32_16x16x32_bf16 v[40:43], v[224:227], v[128:131], v[40:43]
    ds_read_b64_tr_b16 v[240:241], v4 offset:41728
    v_mfma_f32_16x16x32_bf16 v[44:47], v[224:227], v[132:135], v[44:47]
    ds_read_b64_tr_b16 v[242:243], v4 offset:42752
    s_waitcnt lgkmcnt(6)
    v_mfma_f32_16x16x32_bf16 v[48:51], v[228:231], v[128:131], v[48:51]
    ds_read_b64_tr_b16 v[244:245], v5 offset:41760
    v_mfma_f32_16x16x32_bf16 v[52:55], v[228:231], v[132:135], v[52:55]
    ds_read_b64_tr_b16 v[246:247], v5 offset:42784
    s_waitcnt lgkmcnt(6)
    v_mfma_f32_16x16x32_bf16 v[56:59], v[232:235], v[128:131], v[56:59]
    v_mfma_f32_16x16x32_bf16 v[60:63], v[232:235], v[132:135], v[60:63]
    s_waitcnt vmcnt(9)
    s_barrier
    ds_read_b64_tr_b16 v[224:225], v4 offset:49152
    ds_read_b64_tr_b16 v[226:227], v4 offset:50176
    s_waitcnt lgkmcnt(6)
    v_mfma_f32_16x16x32_bf16 v[64:67], v[236:239], v[128:131], v[64:67]
    ds_read_b64_tr_b16 v[228:229], v5 offset:49184
    v_mfma_f32_16x16x32_bf16 v[68:71], v[236:239], v[132:135], v[68:71]
    s_add_u32 s22, s19, 0x280000
    s_add_u32 m0, s20, 0x4000
    s_nop 0
    buffer_load_dwordx4 v3, s[4:7], s22 offen lds
    ds_read_b64_tr_b16 v[230:231], v5 offset:50208
    s_mov_b32 s23, 0xa000
    buffer_load_dwordx4 v[116:119], v7, s[8:11], s23 offen offset:1024 sc1
    s_waitcnt lgkmcnt(6)
    v_mfma_f32_16x16x32_bf16 v[72:75], v[240:243], v[128:131], v[72:75]
    ds_read_b64_tr_b16 v[232:233], v4 offset:49408
    v_mfma_f32_16x16x32_bf16 v[76:79], v[240:243], v[132:135], v[76:79]
    ds_read_b64_tr_b16 v[234:235], v4 offset:50432
    s_waitcnt lgkmcnt(6)
    v_mfma_f32_16x16x32_bf16 v[80:83], v[244:247], v[128:131], v[80:83]
    ds_read_b64_tr_b16 v[236:237], v5 offset:49440
    v_mfma_f32_16x16x32_bf16 v[84:87], v[244:247], v[132:135], v[84:87]
    ds_read_b64_tr_b16 v[238:239], v5 offset:50464
    s_waitcnt vmcnt(10) lgkmcnt(6)
    v_mfma_f32_16x16x32_bf16 v[24:27], v[224:227], v[88:91], v[24:27]
    ds_read_b64_tr_b16 v[240:241], v4 offset:49664
    s_waitcnt vmcnt(9)
    v_mfma_f32_16x16x32_bf16 v[28:31], v[224:227], v[92:95], v[28:31]
    ds_read_b64_tr_b16 v[242:243], v4 offset:50688
    s_waitcnt lgkmcnt(6)
    v_mfma_f32_16x16x32_bf16 v[32:35], v[228:231], v[88:91], v[32:35]
    ds_read_b64_tr_b16 v[244:245], v5 offset:49696
    v_mfma_f32_16x16x32_bf16 v[36:39], v[228:231], v[92:95], v[36:39]
    s_add_u32 s22, s19, 0x288000
    s_add_u32 m0, s20, 0x4400
    s_nop 0
    buffer_load_dwordx4 v3, s[4:7], s22 offen lds
    ds_read_b64_tr_b16 v[246:247], v5 offset:50720
    s_mov_b32 s23, 0x2800
    buffer_load_dwordx4 v[120:123], v7, s[8:11], s23 offen offset:0 sc1
    s_waitcnt lgkmcnt(6)
    v_mfma_f32_16x16x32_bf16 v[40:43], v[232:235], v[88:91], v[40:43]
    ds_read_b64_tr_b16 v[224:225], v4 offset:49920
    v_mfma_f32_16x16x32_bf16 v[44:47], v[232:235], v[92:95], v[44:47]
    ds_read_b64_tr_b16 v[226:227], v4 offset:50944
    s_waitcnt lgkmcnt(6)
    v_mfma_f32_16x16x32_bf16 v[48:51], v[236:239], v[88:91], v[48:51]
    ds_read_b64_tr_b16 v[228:229], v5 offset:49952
    v_mfma_f32_16x16x32_bf16 v[52:55], v[236:239], v[92:95], v[52:55]
    ds_read_b64_tr_b16 v[230:231], v5 offset:50976
    s_waitcnt lgkmcnt(6)
    v_mfma_f32_16x16x32_bf16 v[56:59], v[240:243], v[88:91], v[56:59]
    ds_read_b64_tr_b16 v[232:233], v4 offset:57344
    v_mfma_f32_16x16x32_bf16 v[60:63], v[240:243], v[92:95], v[60:63]
    ds_read_b64_tr_b16 v[234:235], v4 offset:58368
    s_waitcnt lgkmcnt(6)
    v_mfma_f32_16x16x32_bf16 v[64:67], v[244:247], v[88:91], v[64:67]
    ds_read_b64_tr_b16 v[236:237], v5 offset:57376
    v_mfma_f32_16x16x32_bf16 v[68:71], v[244:247], v[92:95], v[68:71]
    ds_read_b64_tr_b16 v[238:239], v5 offset:58400
    s_mov_b32 s23, 0xa800
    buffer_load_dwordx4 v[124:127], v7, s[8:11], s23 offen offset:0 sc1
    s_waitcnt lgkmcnt(6)
    v_mfma_f32_16x16x32_bf16 v[72:75], v[224:227], v[88:91], v[72:75]
    ds_read_b64_tr_b16 v[240:241], v4 offset:57600
    v_mfma_f32_16x16x32_bf16 v[76:79], v[224:227], v[92:95], v[76:79]
    ds_read_b64_tr_b16 v[242:243], v4 offset:58624
    s_waitcnt lgkmcnt(6)
    v_mfma_f32_16x16x32_bf16 v[80:83], v[228:231], v[88:91], v[80:83]
    ds_read_b64_tr_b16 v[244:245], v5 offset:57632
    v_mfma_f32_16x16x32_bf16 v[84:87], v[228:231], v[92:95], v[84:87]
    ds_read_b64_tr_b16 v[246:247], v5 offset:58656
    s_waitcnt vmcnt(11) lgkmcnt(6)
    v_mfma_f32_16x16x32_bf16 v[24:27], v[232:235], v[96:99], v[24:27]
    ds_read_b64_tr_b16 v[224:225], v4 offset:57856
    s_waitcnt vmcnt(9)
    v_mfma_f32_16x16x32_bf16 v[28:31], v[232:235], v[100:103], v[28:31]
    ds_read_b64_tr_b16 v[226:227], v4 offset:58880
    s_waitcnt lgkmcnt(6)
    v_mfma_f32_16x16x32_bf16 v[32:35], v[236:239], v[96:99], v[32:35]
    ds_read_b64_tr_b16 v[228:229], v5 offset:57888
    v_mfma_f32_16x16x32_bf16 v[36:39], v[236:239], v[100:103], v[36:39]
    ds_read_b64_tr_b16 v[230:231], v5 offset:58912
    s_mov_b32 s23, 0x2800
    buffer_load_dwordx4 v[128:131], v7, s[8:11], s23 offen offset:1024 sc1
    s_waitcnt lgkmcnt(6)
    v_mfma_f32_16x16x32_bf16 v[40:43], v[240:243], v[96:99], v[40:43]
    ds_read_b64_tr_b16 v[232:233], v4 offset:58112
    v_mfma_f32_16x16x32_bf16 v[44:47], v[240:243], v[100:103], v[44:47]
    ds_read_b64_tr_b16 v[234:235], v4 offset:59136
    s_waitcnt lgkmcnt(6)
    v_mfma_f32_16x16x32_bf16 v[48:51], v[244:247], v[96:99], v[48:51]
    ds_read_b64_tr_b16 v[236:237], v5 offset:58144
    v_mfma_f32_16x16x32_bf16 v[52:55], v[244:247], v[100:103], v[52:55]
    ds_read_b64_tr_b16 v[238:239], v5 offset:59168
    s_waitcnt lgkmcnt(6)
    v_mfma_f32_16x16x32_bf16 v[56:59], v[224:227], v[96:99], v[56:59]
    v_mfma_f32_16x16x32_bf16 v[60:63], v[224:227], v[100:103], v[60:63]
    s_waitcnt vmcnt(9)
    s_barrier
    ds_read_b64_tr_b16 v[240:241], v4 offset:0
    ds_read_b64_tr_b16 v[242:243], v4 offset:1024
    s_waitcnt lgkmcnt(6)
    v_mfma_f32_16x16x32_bf16 v[64:67], v[228:231], v[96:99], v[64:67]
    ds_read_b64_tr_b16 v[244:245], v5 offset:32
    v_mfma_f32_16x16x32_bf16 v[68:71], v[228:231], v[100:103], v[68:71]
    s_add_u32 s22, s19, 0x300000
    s_add_u32 m0, s20, 0x8000
    s_nop 0
    buffer_load_dwordx4 v3, s[4:7], s22 offen lds
    ds_read_b64_tr_b16 v[246:247], v5 offset:1056
    s_mov_b32 s23, 0xa800
    buffer_load_dwordx4 v[132:135], v7, s[8:11], s23 offen offset:1024 sc1
    s_waitcnt lgkmcnt(6)
    v_mfma_f32_16x16x32_bf16 v[72:75], v[232:235], v[96:99], v[72:75]
    ds_read_b64_tr_b16 v[224:225], v4 offset:256
    v_mfma_f32_16x16x32_bf16 v[76:79], v[232:235], v[100:103], v[76:79]
    ds_read_b64_tr_b16 v[226:227], v4 offset:1280
    s_waitcnt lgkmcnt(6)
    v_mfma_f32_16x16x32_bf16 v[80:83], v[236:239], v[96:99], v[80:83]
    ds_read_b64_tr_b16 v[228:229], v5 offset:288
    v_mfma_f32_16x16x32_bf16 v[84:87], v[236:239], v[100:103], v[84:87]
    ds_read_b64_tr_b16 v[230:231], v5 offset:1312
    s_waitcnt vmcnt(10) lgkmcnt(6)
    v_mfma_f32_16x16x32_bf16 v[24:27], v[240:243], v[104:107], v[24:27]
    ds_read_b64_tr_b16 v[232:233], v4 offset:512
    s_waitcnt vmcnt(9)
    v_mfma_f32_16x16x32_bf16 v[28:31], v[240:243], v[108:111], v[28:31]
    ds_read_b64_tr_b16 v[234:235], v4 offset:1536
    s_waitcnt lgkmcnt(6)
    v_mfma_f32_16x16x32_bf16 v[32:35], v[244:247], v[104:107], v[32:35]
    ds_read_b64_tr_b16 v[236:237], v5 offset:544
    v_mfma_f32_16x16x32_bf16 v[36:39], v[244:247], v[108:111], v[36:39]
    s_add_u32 s22, s19, 0x308000
    s_add_u32 m0, s20, 0x8400
    s_nop 0
    buffer_load_dwordx4 v3, s[4:7], s22 offen lds
    ds_read_b64_tr_b16 v[238:239], v5 offset:1568
    s_mov_b32 s23, 0x3000
    buffer_load_dwordx4 v[88:91], v7, s[8:11], s23 offen offset:0 sc1
    s_waitcnt lgkmcnt(6)
    v_mfma_f32_16x16x32_bf16 v[40:43], v[224:227], v[104:107], v[40:43]
    ds_read_b64_tr_b16 v[240:241], v4 offset:768
    v_mfma_f32_16x16x32_bf16 v[44:47], v[224:227], v[108:111], v[44:47]
    ds_read_b64_tr_b16 v[242:243], v4 offset:1792
    s_waitcnt lgkmcnt(6)
    v_mfma_f32_16x16x32_bf16 v[48:51], v[228:231], v[104:107], v[48:51]
    ds_read_b64_tr_b16 v[244:245], v5 offset:800
    v_mfma_f32_16x16x32_bf16 v[52:55], v[228:231], v[108:111], v[52:55]
    ds_read_b64_tr_b16 v[246:247], v5 offset:1824
    s_waitcnt lgkmcnt(6)
    v_mfma_f32_16x16x32_bf16 v[56:59], v[232:235], v[104:107], v[56:59]
    ds_read_b64_tr_b16 v[224:225], v4 offset:8192
    v_mfma_f32_16x16x32_bf16 v[60:63], v[232:235], v[108:111], v[60:63]
    ds_read_b64_tr_b16 v[226:227], v4 offset:9216
    s_waitcnt lgkmcnt(6)
    v_mfma_f32_16x16x32_bf16 v[64:67], v[236:239], v[104:107], v[64:67]
    ds_read_b64_tr_b16 v[228:229], v5 offset:8224
    v_mfma_f32_16x16x32_bf16 v[68:71], v[236:239], v[108:111], v[68:71]
    ds_read_b64_tr_b16 v[230:231], v5 offset:9248
    s_mov_b32 s23, 0xb000
    buffer_load_dwordx4 v[92:95], v7, s[8:11], s23 offen offset:0 sc1
    s_waitcnt lgkmcnt(6)
    v_mfma_f32_16x16x32_bf16 v[72:75], v[240:243], v[104:107], v[72:75]
    ds_read_b64_tr_b16 v[232:233], v4 offset:8448
    v_mfma_f32_16x16x32_bf16 v[76:79], v[240:243], v[108:111], v[76:79]
    ds_read_b64_tr_b16 v[234:235], v4 offset:9472
    s_waitcnt lgkmcnt(6)
    v_mfma_f32_16x16x32_bf16 v[80:83], v[244:247], v[104:107], v[80:83]
    ds_read_b64_tr_b16 v[236:237], v5 offset:8480
    v_mfma_f32_16x16x32_bf16 v[84:87], v[244:247], v[108:111], v[84:87]
    ds_read_b64_tr_b16 v[238:239], v5 offset:9504
    s_waitcnt vmcnt(11) lgkmcnt(6)
    v_mfma_f32_16x16x32_bf16 v[24:27], v[224:227], v[112:115], v[24:27]
    ds_read_b64_tr_b16 v[240:241], v4 offset:8704
    s_waitcnt vmcnt(9)
    v_mfma_f32_16x16x32_bf16 v[28:31], v[224:227], v[116:119], v[28:31]
    ds_read_b64_tr_b16 v[242:243], v4 offset:9728
    s_waitcnt lgkmcnt(6)
    v_mfma_f32_16x16x32_bf16 v[32:35], v[228:231], v[112:115], v[32:35]
    ds_read_b64_tr_b16 v[244:245], v5 offset:8736
    v_mfma_f32_16x16x32_bf16 v[36:39], v[228:231], v[116:119], v[36:39]
    ds_read_b64_tr_b16 v[246:247], v5 offset:9760
    s_mov_b32 s23, 0x3000
    buffer_load_dwordx4 v[96:99], v7, s[8:11], s23 offen offset:1024 sc1
    s_waitcnt lgkmcnt(6)
    v_mfma_f32_16x16x32_bf16 v[40:43], v[232:235], v[112:115], v[40:43]
    ds_read_b64_tr_b16 v[224:225], v4 offset:8960
    v_mfma_f32_16x16x32_bf16 v[44:47], v[232:235], v[116:119], v[44:47]
    ds_read_b64_tr_b16 v[226:227], v4 offset:9984
    s_waitcnt lgkmcnt(6)
    v_mfma_f32_16x16x32_bf16 v[48:51], v[236:239], v[112:115], v[48:51]
    ds_read_b64_tr_b16 v[228:229], v5 offset:8992
    v_mfma_f32_16x16x32_bf16 v[52:55], v[236:239], v[116:119], v[52:55]
    ds_read_b64_tr_b16 v[230:231], v5 offset:10016
    s_waitcnt lgkmcnt(6)
    v_mfma_f32_16x16x32_bf16 v[56:59], v[240:243], v[112:115], v[56:59]
    v_mfma_f32_16x16x32_bf16 v[60:63], v[240:243], v[116:119], v[60:63]
    s_waitcnt vmcnt(9)
    s_barrier
    ds_read_b64_tr_b16 v[232:233], v4 offset:16384
    ds_read_b64_tr_b16 v[234:235], v4 offset:17408
    s_waitcnt lgkmcnt(6)
    v_mfma_f32_16x16x32_bf16 v[64:67], v[244:247], v[112:115], v[64:67]
    ds_read_b64_tr_b16 v[236:237], v5 offset:16416
    v_mfma_f32_16x16x32_bf16 v[68:71], v[244:247], v[116:119], v[68:71]
    s_add_u32 s22, s19, 0x380000
    s_add_u32 m0, s20, 0xc000
    s_nop 0
    buffer_load_dwordx4 v3, s[4:7], s22 offen lds
    ds_read_b64_tr_b16 v[238:239], v5 offset:17440
    s_mov_b32 s23, 0xb000
    buffer_load_dwordx4 v[100:103], v7, s[8:11], s23 offen offset:1024 sc1
    s_waitcnt lgkmcnt(6)
    v_mfma_f32_16x16x32_bf16 v[72:75], v[224:227], v[112:115], v[72:75]
    ds_read_b64_tr_b16 v[240:241], v4 offset:16640
    v_mfma_f32_16x16x32_bf16 v[76:79], v[224:227], v[116:119], v[76:79]
    ds_read_b64_tr_b16 v[242:243], v4 offset:17664
    s_waitcnt lgkmcnt(6)
    v_mfma_f32_16x16x32_bf16 v[80:83], v[228:231], v[112:115], v[80:83]
    ds_read_b64_tr_b16 v[244:245], v5 offset:16672
    v_mfma_f32_16x16x32_bf16 v[84:87], v[228:231], v[116:119], v[84:87]
    ds_read_b64_tr_b16 v[246:247], v5 offset:17696
    s_waitcnt vmcnt(10) lgkmcnt(6)
    v_mfma_f32_16x16x32_bf16 v[24:27], v[232:235], v[120:123], v[24:27]
    ds_read_b64_tr_b16 v[224:225], v4 offset:16896
    s_waitcnt vmcnt(9)
    v_mfma_f32_16x16x32_bf16 v[28:31], v[232:235], v[124:127], v[28:31]
    ds_read_b64_tr_b16 v[226:227], v4 offset:17920
    s_waitcnt lgkmcnt(6)
    v_mfma_f32_16x16x32_bf16 v[32:35], v[236:239], v[120:123], v[32:35]
    ds_read_b64_tr_b16 v[228:229], v5 offset:16928
    v_mfma_f32_16x16x32_bf16 v[36:39], v[236:239], v[124:127], v[36:39]
    s_add_u32 s22, s19, 0x388000
    s_add_u32 m0, s20, 0xc400
    s_nop 0
    buffer_load_dwordx4 v3, s[4:7], s22 offen lds
    ds_read_b64_tr_b16 v[230:231], v5 offset:17952
    s_mov_b32 s23, 0x3800
    buffer_load_dwordx4 v[104:107], v7, s[8:11], s23 offen offset:0 sc1
    s_waitcnt lgkmcnt(6)
    v_mfma_f32_16x16x32_bf16 v[40:43], v[240:243], v[120:123], v[40:43]
    ds_read_b64_tr_b16 v[232:233], v4 offset:17152
    v_mfma_f32_16x16x32_bf16 v[44:47], v[240:243], v[124:127], v[44:47]
    ds_read_b64_tr_b16 v[234:235], v4 offset:18176
    s_waitcnt lgkmcnt(6)
    v_mfma_f32_16x16x32_bf16 v[48:51], v[244:247], v[120:123], v[48:51]
    ds_read_b64_tr_b16 v[236:237], v5 offset:17184
    v_mfma_f32_16x16x32_bf16 v[52:55], v[244:247], v[124:127], v[52:55]
    ds_read_b64_tr_b16 v[238:239], v5 offset:18208
    s_waitcnt lgkmcnt(6)
    v_mfma_f32_16x16x32_bf16 v[56:59], v[224:227], v[120:123], v[56:59]
    ds_read_b64_tr_b16 v[240:241], v4 offset:24576
    v_mfma_f32_16x16x32_bf16 v[60:63], v[224:227], v[124:127], v[60:63]
    ds_read_b64_tr_b16 v[242:243], v4 offset:25600
    s_waitcnt lgkmcnt(6)
    v_mfma_f32_16x16x32_bf16 v[64:67], v[228:231], v[120:123], v[64:67]
    ds_read_b64_tr_b16 v[244:245], v5 offset:24608
    v_mfma_f32_16x16x32_bf16 v[68:71], v[228:231], v[124:127], v[68:71]
    ds_read_b64_tr_b16 v[246:247], v5 offset:25632
    s_mov_b32 s23, 0xb800
    buffer_load_dwordx4 v[108:111], v7, s[8:11], s23 offen offset:0 sc1
    s_waitcnt lgkmcnt(6)
    v_mfma_f32_16x16x32_bf16 v[72:75], v[232:235], v[120:123], v[72:75]
    ds_read_b64_tr_b16 v[224:225], v4 offset:24832
    v_mfma_f32_16x16x32_bf16 v[76:79], v[232:235], v[124:127], v[76:79]
    ds_read_b64_tr_b16 v[226:227], v4 offset:25856
    s_waitcnt lgkmcnt(6)
    v_mfma_f32_16x16x32_bf16 v[80:83], v[236:239], v[120:123], v[80:83]
    ds_read_b64_tr_b16 v[228:229], v5 offset:24864
    v_mfma_f32_16x16x32_bf16 v[84:87], v[236:239], v[124:127], v[84:87]
    ds_read_b64_tr_b16 v[230:231], v5 offset:25888
    s_waitcnt vmcnt(11) lgkmcnt(6)
    v_mfma_f32_16x16x32_bf16 v[24:27], v[240:243], v[128:131], v[24:27]
    ds_read_b64_tr_b16 v[232:233], v4 offset:25088
    s_waitcnt vmcnt(9)
    v_mfma_f32_16x16x32_bf16 v[28:31], v[240:243], v[132:135], v[28:31]
    ds_read_b64_tr_b16 v[234:235], v4 offset:26112
    s_waitcnt lgkmcnt(6)
    v_mfma_f32_16x16x32_bf16 v[32:35], v[244:247], v[128:131], v[32:35]
    ds_read_b64_tr_b16 v[236:237], v5 offset:25120
    v_mfma_f32_16x16x32_bf16 v[36:39], v[244:247], v[132:135], v[36:39]
    ds_read_b64_tr_b16 v[238:239], v5 offset:26144
    s_mov_b32 s23, 0x3800
    buffer_load_dwordx4 v[112:115], v7, s[8:11], s23 offen offset:1024 sc1
    s_waitcnt lgkmcnt(6)
    v_mfma_f32_16x16x32_bf16 v[40:43], v[224:227], v[128:131], v[40:43]
    ds_read_b64_tr_b16 v[240:241], v4 offset:25344
    v_mfma_f32_16x16x32_bf16 v[44:47], v[224:227], v[132:135], v[44:47]
    ds_read_b64_tr_b16 v[242:243], v4 offset:26368
    s_waitcnt lgkmcnt(6)
    v_mfma_f32_16x16x32_bf16 v[48:51], v[228:231], v[128:131], v[48:51]
    ds_read_b64_tr_b16 v[244:245], v5 offset:25376
    v_mfma_f32_16x16x32_bf16 v[52:55], v[228:231], v[132:135], v[52:55]
    ds_read_b64_tr_b16 v[246:247], v5 offset:26400
    s_waitcnt lgkmcnt(6)
    v_mfma_f32_16x16x32_bf16 v[56:59], v[232:235], v[128:131], v[56:59]
    v_mfma_f32_16x16x32_bf16 v[60:63], v[232:235], v[132:135], v[60:63]
    s_waitcnt vmcnt(9)
    s_barrier
    ds_read_b64_tr_b16 v[224:225], v4 offset:32768
    ds_read_b64_tr_b16 v[226:227], v4 offset:33792
    s_waitcnt lgkmcnt(6)
    v_mfma_f32_16x16x32_bf16 v[64:67], v[236:239], v[128:131], v[64:67]
    ds_read_b64_tr_b16 v[228:229], v5 offset:32800
    v_mfma_f32_16x16x32_bf16 v[68:71], v[236:239], v[132:135], v[68:71]
    s_add_u32 s22, s19, 0x400000
    s_add_u32 m0, s20, 0x0
    s_nop 0
    buffer_load_dwordx4 v3, s[4:7], s22 offen lds
    ds_read_b64_tr_b16 v[230:231], v5 offset:33824
    s_mov_b32 s23, 0xb800
    buffer_load_dwordx4 v[116:119], v7, s[8:11], s23 offen offset:1024 sc1
    s_waitcnt lgkmcnt(6)
    v_mfma_f32_16x16x32_bf16 v[72:75], v[240:243], v[128:131], v[72:75]
    ds_read_b64_tr_b16 v[232:233], v4 offset:33024
    v_mfma_f32_16x16x32_bf16 v[76:79], v[240:243], v[132:135], v[76:79]
    ds_read_b64_tr_b16 v[234:235], v4 offset:34048
    s_waitcnt lgkmcnt(6)
    v_mfma_f32_16x16x32_bf16 v[80:83], v[244:247], v[128:131], v[80:83]
    ds_read_b64_tr_b16 v[236:237], v5 offset:33056
    v_mfma_f32_16x16x32_bf16 v[84:87], v[244:247], v[132:135], v[84:87]
    ds_read_b64_tr_b16 v[238:239], v5 offset:34080
    s_waitcnt vmcnt(10) lgkmcnt(6)
    v_mfma_f32_16x16x32_bf16 v[24:27], v[224:227], v[88:91], v[24:27]
    ds_read_b64_tr_b16 v[240:241], v4 offset:33280
    s_waitcnt vmcnt(9)
    v_mfma_f32_16x16x32_bf16 v[28:31], v[224:227], v[92:95], v[28:31]
    ds_read_b64_tr_b16 v[242:243], v4 offset:34304
    s_waitcnt lgkmcnt(6)
    v_mfma_f32_16x16x32_bf16 v[32:35], v[228:231], v[88:91], v[32:35]
    ds_read_b64_tr_b16 v[244:245], v5 offset:33312
    v_mfma_f32_16x16x32_bf16 v[36:39], v[228:231], v[92:95], v[36:39]
    s_add_u32 s22, s19, 0x408000
    s_add_u32 m0, s20, 0x400
    s_nop 0
    buffer_load_dwordx4 v3, s[4:7], s22 offen lds
    ds_read_b64_tr_b16 v[246:247], v5 offset:34336
    s_mov_b32 s23, 0x4000
    buffer_load_dwordx4 v[120:123], v7, s[8:11], s23 offen offset:0 sc1
    s_waitcnt lgkmcnt(6)
    v_mfma_f32_16x16x32_bf16 v[40:43], v[232:235], v[88:91], v[40:43]
    ds_read_b64_tr_b16 v[224:225], v4 offset:33536
    v_mfma_f32_16x16x32_bf16 v[44:47], v[232:235], v[92:95], v[44:47]
    ds_read_b64_tr_b16 v[226:227], v4 offset:34560
    s_waitcnt lgkmcnt(6)
    v_mfma_f32_16x16x32_bf16 v[48:51], v[236:239], v[88:91], v[48:51]
    ds_read_b64_tr_b16 v[228:229], v5 offset:33568
    v_mfma_f32_16x16x32_bf16 v[52:55], v[236:239], v[92:95], v[52:55]
    ds_read_b64_tr_b16 v[230:231], v5 offset:34592
    s_waitcnt lgkmcnt(6)
    v_mfma_f32_16x16x32_bf16 v[56:59], v[240:243], v[88:91], v[56:59]
    ds_read_b64_tr_b16 v[232:233], v4 offset:40960
    v_mfma_f32_16x16x32_bf16 v[60:63], v[240:243], v[92:95], v[60:63]
    ds_read_b64_tr_b16 v[234:235], v4 offset:41984
    s_waitcnt lgkmcnt(6)
    v_mfma_f32_16x16x32_bf16 v[64:67], v[244:247], v[88:91], v[64:67]
    ds_read_b64_tr_b16 v[236:237], v5 offset:40992
    v_mfma_f32_16x16x32_bf16 v[68:71], v[244:247], v[92:95], v[68:71]
    ds_read_b64_tr_b16 v[238:239], v5 offset:42016
    s_mov_b32 s23, 0xc000
    buffer_load_dwordx4 v[124:127], v7, s[8:11], s23 offen offset:0 sc1
    s_waitcnt lgkmcnt(6)
    v_mfma_f32_16x16x32_bf16 v[72:75], v[224:227], v[88:91], v[72:75]
    ds_read_b64_tr_b16 v[240:241], v4 offset:41216
    v_lshrrev_b32 v21, 4, v1
    v_lshlrev_b32 v21, 9, v21
    v_and_b32 v20, 15, v1
    v_lshl_add_u32 v21, v20, 4, v21
    s_lshr_b32 s18, s12, 3
    s_lshl_b32 s18, s18, 11
    s_add_u32 s18, s18, 0x528100
    buffer_load_dwordx4 v[12:15], v21, s[8:11], s18 offen sc1
    v_mfma_f32_16x16x32_bf16 v[76:79], v[224:227], v[92:95], v[76:79]
    ds_read_b64_tr_b16 v[242:243], v4 offset:42240
    s_waitcnt lgkmcnt(6)
    v_mfma_f32_16x16x32_bf16 v[80:83], v[228:231], v[88:91], v[80:83]
    ds_read_b64_tr_b16 v[244:245], v5 offset:41248
    v_mfma_f32_16x16x32_bf16 v[84:87], v[228:231], v[92:95], v[84:87]
    ds_read_b64_tr_b16 v[246:247], v5 offset:42272
    s_waitcnt vmcnt(12) lgkmcnt(6)
    v_mfma_f32_16x16x32_bf16 v[24:27], v[232:235], v[96:99], v[24:27]
    ds_read_b64_tr_b16 v[224:225], v4 offset:41472
    s_waitcnt vmcnt(10)
    v_mfma_f32_16x16x32_bf16 v[28:31], v[232:235], v[100:103], v[28:31]
    ds_read_b64_tr_b16 v[226:227], v4 offset:42496
    s_waitcnt lgkmcnt(6)
    v_mfma_f32_16x16x32_bf16 v[32:35], v[236:239], v[96:99], v[32:35]
    ds_read_b64_tr_b16 v[228:229], v5 offset:41504
    v_mfma_f32_16x16x32_bf16 v[36:39], v[236:239], v[100:103], v[36:39]
    ds_read_b64_tr_b16 v[230:231], v5 offset:42528
    s_mov_b32 s23, 0x4000
    buffer_load_dwordx4 v[128:131], v7, s[8:11], s23 offen offset:1024 sc1
    s_waitcnt lgkmcnt(6)
    v_mfma_f32_16x16x32_bf16 v[40:43], v[240:243], v[96:99], v[40:43]
    ds_read_b64_tr_b16 v[232:233], v4 offset:41728
    v_mfma_f32_16x16x32_bf16 v[44:47], v[240:243], v[100:103], v[44:47]
    ds_read_b64_tr_b16 v[234:235], v4 offset:42752
    s_waitcnt lgkmcnt(6)
    v_mfma_f32_16x16x32_bf16 v[48:51], v[244:247], v[96:99], v[48:51]
    ds_read_b64_tr_b16 v[236:237], v5 offset:41760
    v_mfma_f32_16x16x32_bf16 v[52:55], v[244:247], v[100:103], v[52:55]
    ds_read_b64_tr_b16 v[238:239], v5 offset:42784
    s_waitcnt lgkmcnt(6)
    v_mfma_f32_16x16x32_bf16 v[56:59], v[224:227], v[96:99], v[56:59]
    v_mfma_f32_16x16x32_bf16 v[60:63], v[224:227], v[100:103], v[60:63]
    s_waitcnt vmcnt(10)
    s_barrier
    ds_read_b64_tr_b16 v[240:241], v4 offset:49152
    ds_read_b64_tr_b16 v[242:243], v4 offset:50176
    s_waitcnt lgkmcnt(6)
    v_mfma_f32_16x16x32_bf16 v[64:67], v[228:231], v[96:99], v[64:67]
    ds_read_b64_tr_b16 v[244:245], v5 offset:49184
    v_mfma_f32_16x16x32_bf16 v[68:71], v[228:231], v[100:103], v[68:71]
    s_add_u32 s22, s19, 0x480000
    s_add_u32 m0, s20, 0x4000
    s_nop 0
    buffer_load_dwordx4 v3, s[4:7], s22 offen lds
    ds_read_b64_tr_b16 v[246:247], v5 offset:50208
    s_mov_b32 s23, 0xc000
    buffer_load_dwordx4 v[132:135], v7, s[8:11], s23 offen offset:1024 sc1
    s_waitcnt lgkmcnt(6)
    v_mfma_f32_16x16x32_bf16 v[72:75], v[232:235], v[96:99], v[72:75]
    ds_read_b64_tr_b16 v[224:225], v4 offset:49408
    v_mfma_f32_16x16x32_bf16 v[76:79], v[232:235], v[100:103], v[76:79]
    ds_read_b64_tr_b16 v[226:227], v4 offset:50432
    s_waitcnt lgkmcnt(6)
    v_mfma_f32_16x16x32_bf16 v[80:83], v[236:239], v[96:99], v[80:83]
    ds_read_b64_tr_b16 v[228:229], v5 offset:49440
    v_mfma_f32_16x16x32_bf16 v[84:87], v[236:239], v[100:103], v[84:87]
    ds_read_b64_tr_b16 v[230:231], v5 offset:50464
    s_waitcnt vmcnt(11) lgkmcnt(6)
    v_mfma_f32_16x16x32_bf16 v[24:27], v[240:243], v[104:107], v[24:27]
    ds_read_b64_tr_b16 v[232:233], v4 offset:49664
    s_waitcnt vmcnt(10)
    v_mfma_f32_16x16x32_bf16 v[28:31], v[240:243], v[108:111], v[28:31]
    ds_read_b64_tr_b16 v[234:235], v4 offset:50688
    s_waitcnt lgkmcnt(6)
    v_mfma_f32_16x16x32_bf16 v[32:35], v[244:247], v[104:107], v[32:35]
    ds_read_b64_tr_b16 v[236:237], v5 offset:49696
    v_mfma_f32_16x16x32_bf16 v[36:39], v[244:247], v[108:111], v[36:39]
    s_add_u32 s22, s19, 0x488000
    s_add_u32 m0, s20, 0x4400
    s_nop 0
    buffer_load_dwordx4 v3, s[4:7], s22 offen lds
    ds_read_b64_tr_b16 v[238:239], v5 offset:50720
    s_mov_b32 s23, 0x4800
    buffer_load_dwordx4 v[88:91], v7, s[8:11], s23 offen offset:0 sc1
    s_waitcnt lgkmcnt(6)
    v_mfma_f32_16x16x32_bf16 v[40:43], v[224:227], v[104:107], v[40:43]
    ds_read_b64_tr_b16 v[240:241], v4 offset:49920
    v_mfma_f32_16x16x32_bf16 v[44:47], v[224:227], v[108:111], v[44:47]
    ds_read_b64_tr_b16 v[242:243], v4 offset:50944
    s_waitcnt lgkmcnt(6)
    v_mfma_f32_16x16x32_bf16 v[48:51], v[228:231], v[104:107], v[48:51]
    ds_read_b64_tr_b16 v[244:245], v5 offset:49952
    v_mfma_f32_16x16x32_bf16 v[52:55], v[228:231], v[108:111], v[52:55]
    ds_read_b64_tr_b16 v[246:247], v5 offset:50976
    s_waitcnt lgkmcnt(6)
    v_mfma_f32_16x16x32_bf16 v[56:59], v[232:235], v[104:107], v[56:59]
    ds_read_b64_tr_b16 v[224:225], v4 offset:57344
    v_mfma_f32_16x16x32_bf16 v[60:63], v[232:235], v[108:111], v[60:63]
    ds_read_b64_tr_b16 v[226:227], v4 offset:58368
    s_waitcnt lgkmcnt(6)
    v_mfma_f32_16x16x32_bf16 v[64:67], v[236:239], v[104:107], v[64:67]
    ds_read_b64_tr_b16 v[228:229], v5 offset:57376
    v_mfma_f32_16x16x32_bf16 v[68:71], v[236:239], v[108:111], v[68:71]
    ds_read_b64_tr_b16 v[230:231], v5 offset:58400
    s_mov_b32 s23, 0xc800
    buffer_load_dwordx4 v[92:95], v7, s[8:11], s23 offen offset:0 sc1
    s_waitcnt lgkmcnt(6)
    v_mfma_f32_16x16x32_bf16 v[72:75], v[240:243], v[104:107], v[72:75]
    ds_read_b64_tr_b16 v[232:233], v4 offset:57600
    v_mfma_f32_16x16x32_bf16 v[76:79], v[240:243], v[108:111], v[76:79]
    ds_read_b64_tr_b16 v[234:235], v4 offset:58624
    s_waitcnt lgkmcnt(6)
    v_mfma_f32_16x16x32_bf16 v[80:83], v[244:247], v[104:107], v[80:83]
    ds_read_b64_tr_b16 v[236:237], v5 offset:57632
    v_mfma_f32_16x16x32_bf16 v[84:87], v[244:247], v[108:111], v[84:87]
    ds_read_b64_tr_b16 v[238:239], v5 offset:58656
    s_waitcnt vmcnt(12) lgkmcnt(6)
    v_mfma_f32_16x16x32_bf16 v[24:27], v[224:227], v[112:115], v[24:27]
    ds_read_b64_tr_b16 v[240:241], v4 offset:57856
    s_waitcnt vmcnt(10)
    v_mfma_f32_16x16x32_bf16 v[28:31], v[224:227], v[116:119], v[28:31]
    ds_read_b64_tr_b16 v[242:243], v4 offset:58880
    s_waitcnt lgkmcnt(6)
    v_mfma_f32_16x16x32_bf16 v[32:35], v[228:231], v[112:115], v[32:35]
    ds_read_b64_tr_b16 v[244:245], v5 offset:57888
    v_mfma_f32_16x16x32_bf16 v[36:39], v[228:231], v[116:119], v[36:39]
    ds_read_b64_tr_b16 v[246:247], v5 offset:58912
    s_mov_b32 s23, 0x4800
    buffer_load_dwordx4 v[96:99], v7, s[8:11], s23 offen offset:1024 sc1
    s_waitcnt lgkmcnt(6)
    v_mfma_f32_16x16x32_bf16 v[40:43], v[232:235], v[112:115], v[40:43]
    ds_read_b64_tr_b16 v[224:225], v4 offset:58112
    v_mfma_f32_16x16x32_bf16 v[44:47], v[232:235], v[116:119], v[44:47]
    ds_read_b64_tr_b16 v[226:227], v4 offset:59136
    s_waitcnt lgkmcnt(6)
    v_mfma_f32_16x16x32_bf16 v[48:51], v[236:239], v[112:115], v[48:51]
    ds_read_b64_tr_b16 v[228:229], v5 offset:58144
    v_mfma_f32_16x16x32_bf16 v[52:55], v[236:239], v[116:119], v[52:55]
    ds_read_b64_tr_b16 v[230:231], v5 offset:59168
    s_waitcnt lgkmcnt(6)
    v_mfma_f32_16x16x32_bf16 v[56:59], v[240:243], v[112:115], v[56:59]
    v_mfma_f32_16x16x32_bf16 v[60:63], v[240:243], v[116:119], v[60:63]
    s_waitcnt vmcnt(10)
    s_barrier
    ds_read_b64_tr_b16 v[232:233], v4 offset:0
    ds_read_b64_tr_b16 v[234:235], v4 offset:1024
    s_waitcnt lgkmcnt(6)
    v_mfma_f32_16x16x32_bf16 v[64:67], v[244:247], v[112:115], v[64:67]
    ds_read_b64_tr_b16 v[236:237], v5 offset:32
    v_mfma_f32_16x16x32_bf16 v[68:71], v[244:247], v[116:119], v[68:71]
    s_add_u32 s22, s19, 0x500000
    s_add_u32 m0, s20, 0x8000
    s_nop 0
    buffer_load_dwordx4 v3, s[4:7], s22 offen lds
    ds_read_b64_tr_b16 v[238:239], v5 offset:1056
    s_mov_b32 s23, 0xc800
    buffer_load_dwordx4 v[100:103], v7, s[8:11], s23 offen offset:1024 sc1
    s_waitcnt lgkmcnt(6)
    v_mfma_f32_16x16x32_bf16 v[72:75], v[224:227], v[112:115], v[72:75]
    ds_read_b64_tr_b16 v[240:241], v4 offset:256
    v_mfma_f32_16x16x32_bf16 v[76:79], v[224:227], v[116:119], v[76:79]
    ds_read_b64_tr_b16 v[242:243], v4 offset:1280
    s_waitcnt lgkmcnt(6)
    v_mfma_f32_16x16x32_bf16 v[80:83], v[228:231], v[112:115], v[80:83]
    ds_read_b64_tr_b16 v[244:245], v5 offset:288
    v_mfma_f32_16x16x32_bf16 v[84:87], v[228:231], v[116:119], v[84:87]
    ds_read_b64_tr_b16 v[246:247], v5 offset:1312
    s_waitcnt vmcnt(11) lgkmcnt(6)
    v_mfma_f32_16x16x32_bf16 v[24:27], v[232:235], v[120:123], v[24:27]
    ds_read_b64_tr_b16 v[224:225], v4 offset:512
    s_waitcnt vmcnt(10)
    v_mfma_f32_16x16x32_bf16 v[28:31], v[232:235], v[124:127], v[28:31]
    ds_read_b64_tr_b16 v[226:227], v4 offset:1536
    s_waitcnt lgkmcnt(6)
    v_mfma_f32_16x16x32_bf16 v[32:35], v[236:239], v[120:123], v[32:35]
    ds_read_b64_tr_b16 v[228:229], v5 offset:544
    v_mfma_f32_16x16x32_bf16 v[36:39], v[236:239], v[124:127], v[36:39]
    s_add_u32 s22, s19, 0x508000
    s_add_u32 m0, s20, 0x8400
    s_nop 0
    buffer_load_dwordx4 v3, s[4:7], s22 offen lds
    ds_read_b64_tr_b16 v[230:231], v5 offset:1568
    s_mov_b32 s23, 0x5000
    buffer_load_dwordx4 v[104:107], v7, s[8:11], s23 offen offset:0 sc1
    s_waitcnt lgkmcnt(6)
    v_mfma_f32_16x16x32_bf16 v[40:43], v[240:243], v[120:123], v[40:43]
    ds_read_b64_tr_b16 v[232:233], v4 offset:768
    v_mfma_f32_16x16x32_bf16 v[44:47], v[240:243], v[124:127], v[44:47]
    ds_read_b64_tr_b16 v[234:235], v4 offset:1792
    s_waitcnt lgkmcnt(6)
    v_mfma_f32_16x16x32_bf16 v[48:51], v[244:247], v[120:123], v[48:51]
    ds_read_b64_tr_b16 v[236:237], v5 offset:800
    v_mfma_f32_16x16x32_bf16 v[52:55], v[244:247], v[124:127], v[52:55]
    ds_read_b64_tr_b16 v[238:239], v5 offset:1824
    s_waitcnt lgkmcnt(6)
    v_mfma_f32_16x16x32_bf16 v[56:59], v[224:227], v[120:123], v[56:59]
    ds_read_b64_tr_b16 v[240:241], v4 offset:8192
    v_mfma_f32_16x16x32_bf16 v[60:63], v[224:227], v[124:127], v[60:63]
    ds_read_b64_tr_b16 v[242:243], v4 offset:9216
    s_waitcnt lgkmcnt(6)
    v_mfma_f32_16x16x32_bf16 v[64:67], v[228:231], v[120:123], v[64:67]
    ds_read_b64_tr_b16 v[244:245], v5 offset:8224
    v_mfma_f32_16x16x32_bf16 v[68:71], v[228:231], v[124:127], v[68:71]
    ds_read_b64_tr_b16 v[246:247], v5 offset:9248
    s_mov_b32 s23, 0xd000
    buffer_load_dwordx4 v[108:111], v7, s[8:11], s23 offen offset:0 sc1
    s_waitcnt lgkmcnt(6)
    v_mfma_f32_16x16x32_bf16 v[72:75], v[232:235], v[120:123], v[72:75]
    ds_read_b64_tr_b16 v[224:225], v4 offset:8448
    v_mfma_f32_16x16x32_bf16 v[76:79], v[232:235], v[124:127], v[76:79]
    ds_read_b64_tr_b16 v[226:227], v4 offset:9472
    s_waitcnt lgkmcnt(6)
    v_mfma_f32_16x16x32_bf16 v[80:83], v[236:239], v[120:123], v[80:83]
    ds_read_b64_tr_b16 v[228:229], v5 offset:8480
    v_mfma_f32_16x16x32_bf16 v[84:87], v[236:239], v[124:127], v[84:87]
    ds_read_b64_tr_b16 v[230:231], v5 offset:9504
    s_waitcnt vmcnt(11) lgkmcnt(6)
    v_mfma_f32_16x16x32_bf16 v[24:27], v[240:243], v[128:131], v[24:27]
    ds_read_b64_tr_b16 v[232:233], v4 offset:8704
    s_waitcnt vmcnt(9)
    v_mfma_f32_16x16x32_bf16 v[28:31], v[240:243], v[132:135], v[28:31]
    ds_read_b64_tr_b16 v[234:235], v4 offset:9728
    s_waitcnt lgkmcnt(6)
    v_mfma_f32_16x16x32_bf16 v[32:35], v[244:247], v[128:131], v[32:35]
    ds_read_b64_tr_b16 v[236:237], v5 offset:8736
    v_mfma_f32_16x16x32_bf16 v[36:39], v[244:247], v[132:135], v[36:39]
    ds_read_b64_tr_b16 v[238:239], v5 offset:9760
    s_mov_b32 s23, 0x5000
    buffer_load_dwordx4 v[112:115], v7, s[8:11], s23 offen offset:1024 sc1
    s_waitcnt lgkmcnt(6)
    v_mfma_f32_16x16x32_bf16 v[40:43], v[224:227], v[128:131], v[40:43]
    ds_read_b64_tr_b16 v[240:241], v4 offset:8960
    v_mfma_f32_16x16x32_bf16 v[44:47], v[224:227], v[132:135], v[44:47]
    ds_read_b64_tr_b16 v[242:243], v4 offset:9984
    s_waitcnt lgkmcnt(6)
    v_mfma_f32_16x16x32_bf16 v[48:51], v[228:231], v[128:131], v[48:51]
    ds_read_b64_tr_b16 v[244:245], v5 offset:8992
    v_mfma_f32_16x16x32_bf16 v[52:55], v[228:231], v[132:135], v[52:55]
    ds_read_b64_tr_b16 v[246:247], v5 offset:10016
    s_waitcnt lgkmcnt(6)
    v_mfma_f32_16x16x32_bf16 v[56:59], v[232:235], v[128:131], v[56:59]
    v_mfma_f32_16x16x32_bf16 v[60:63], v[232:235], v[132:135], v[60:63]
    s_waitcnt vmcnt(9)
    s_barrier
    ds_read_b64_tr_b16 v[224:225], v4 offset:16384
    ds_read_b64_tr_b16 v[226:227], v4 offset:17408
    s_waitcnt lgkmcnt(6)
    v_mfma_f32_16x16x32_bf16 v[64:67], v[236:239], v[128:131], v[64:67]
    ds_read_b64_tr_b16 v[228:229], v5 offset:16416
    v_mfma_f32_16x16x32_bf16 v[68:71], v[236:239], v[132:135], v[68:71]
    s_add_u32 s22, s19, 0x580000
    s_add_u32 m0, s20, 0xc000
    s_nop 0
    buffer_load_dwordx4 v3, s[4:7], s22 offen lds
    ds_read_b64_tr_b16 v[230:231], v5 offset:17440
    s_mov_b32 s23, 0xd000
    buffer_load_dwordx4 v[116:119], v7, s[8:11], s23 offen offset:1024 sc1
    s_waitcnt lgkmcnt(6)
    v_mfma_f32_16x16x32_bf16 v[72:75], v[240:243], v[128:131], v[72:75]
    ds_read_b64_tr_b16 v[232:233], v4 offset:16640
    v_mfma_f32_16x16x32_bf16 v[76:79], v[240:243], v[132:135], v[76:79]
    ds_read_b64_tr_b16 v[234:235], v4 offset:17664
    s_waitcnt lgkmcnt(6)
    v_mfma_f32_16x16x32_bf16 v[80:83], v[244:247], v[128:131], v[80:83]
    ds_read_b64_tr_b16 v[236:237], v5 offset:16672
    v_mfma_f32_16x16x32_bf16 v[84:87], v[244:247], v[132:135], v[84:87]
    ds_read_b64_tr_b16 v[238:239], v5 offset:17696
    s_waitcnt vmcnt(10) lgkmcnt(6)
    v_mfma_f32_16x16x32_bf16 v[24:27], v[224:227], v[88:91], v[24:27]
    ds_read_b64_tr_b16 v[240:241], v4 offset:16896
    s_waitcnt vmcnt(9)
    v_mfma_f32_16x16x32_bf16 v[28:31], v[224:227], v[92:95], v[28:31]
    ds_read_b64_tr_b16 v[242:243], v4 offset:17920
    s_waitcnt lgkmcnt(6)
    v_mfma_f32_16x16x32_bf16 v[32:35], v[228:231], v[88:91], v[32:35]
    ds_read_b64_tr_b16 v[244:245], v5 offset:16928
    v_mfma_f32_16x16x32_bf16 v[36:39], v[228:231], v[92:95], v[36:39]
    s_add_u32 s22, s19, 0x588000
    s_add_u32 m0, s20, 0xc400
    s_nop 0
    buffer_load_dwordx4 v3, s[4:7], s22 offen lds
    ds_read_b64_tr_b16 v[246:247], v5 offset:17952
    s_mov_b32 s23, 0x5800
    buffer_load_dwordx4 v[120:123], v7, s[8:11], s23 offen offset:0 sc1
    s_waitcnt lgkmcnt(6)
    v_mfma_f32_16x16x32_bf16 v[40:43], v[232:235], v[88:91], v[40:43]
    ds_read_b64_tr_b16 v[224:225], v4 offset:17152
    v_mfma_f32_16x16x32_bf16 v[44:47], v[232:235], v[92:95], v[44:47]
    ds_read_b64_tr_b16 v[226:227], v4 offset:18176
    s_waitcnt lgkmcnt(6)
    v_mfma_f32_16x16x32_bf16 v[48:51], v[236:239], v[88:91], v[48:51]
    ds_read_b64_tr_b16 v[228:229], v5 offset:17184
    v_mfma_f32_16x16x32_bf16 v[52:55], v[236:239], v[92:95], v[52:55]
    ds_read_b64_tr_b16 v[230:231], v5 offset:18208
    s_waitcnt lgkmcnt(6)
    v_mfma_f32_16x16x32_bf16 v[56:59], v[240:243], v[88:91], v[56:59]
    ds_read_b64_tr_b16 v[232:233], v4 offset:24576
    v_mfma_f32_16x16x32_bf16 v[60:63], v[240:243], v[92:95], v[60:63]
    ds_read_b64_tr_b16 v[234:235], v4 offset:25600
    s_waitcnt lgkmcnt(6)
    v_mfma_f32_16x16x32_bf16 v[64:67], v[244:247], v[88:91], v[64:67]
    ds_read_b64_tr_b16 v[236:237], v5 offset:24608
    v_mfma_f32_16x16x32_bf16 v[68:71], v[244:247], v[92:95], v[68:71]
    ds_read_b64_tr_b16 v[238:239], v5 offset:25632
    s_mov_b32 s23, 0xd800
    buffer_load_dwordx4 v[124:127], v7, s[8:11], s23 offen offset:0 sc1
    s_waitcnt lgkmcnt(6)
    v_mfma_f32_16x16x32_bf16 v[72:75], v[224:227], v[88:91], v[72:75]
    ds_read_b64_tr_b16 v[240:241], v4 offset:24832
    v_xor_b32 v8, s28, v12
    v_xor_b32 v20, s28, v13
    v_or_b32 v8, v8, v20
    v_xor_b32 v20, s28, v14
    v_or_b32 v8, v8, v20
    v_xor_b32 v20, s28, v15
    v_or_b32 v8, v8, v20
    v_cmp_ne_u32 vcc, 0, v8
    s_cbranch_vccnz adaLN_cond__sliding_block_cached__moe_arch_mod__prompt_kernel_kv4r
adaLN_cond__sliding_block_cached__moe_arch_mod__prompt_kernel_kv4b:
    v_mfma_f32_16x16x32_bf16 v[76:79], v[224:227], v[92:95], v[76:79]
    ds_read_b64_tr_b16 v[242:243], v4 offset:25856
    v_mov_b32 v20, 0
    s_mov_b32 s16, 0x564000
    buffer_load_dword v8, v20, s[8:11], s16 offen sc1
    s_waitcnt lgkmcnt(6)
    v_mfma_f32_16x16x32_bf16 v[80:83], v[228:231], v[88:91], v[80:83]
    ds_read_b64_tr_b16 v[244:245], v5 offset:24864
    v_mfma_f32_16x16x32_bf16 v[84:87], v[228:231], v[92:95], v[84:87]
    ds_read_b64_tr_b16 v[246:247], v5 offset:25888
    s_waitcnt vmcnt(12) lgkmcnt(6)
    v_mfma_f32_16x16x32_bf16 v[24:27], v[232:235], v[96:99], v[24:27]
    ds_read_b64_tr_b16 v[224:225], v4 offset:25088
    s_waitcnt vmcnt(10)
    v_mfma_f32_16x16x32_bf16 v[28:31], v[232:235], v[100:103], v[28:31]
    ds_read_b64_tr_b16 v[226:227], v4 offset:26112
    s_waitcnt lgkmcnt(6)
    v_mfma_f32_16x16x32_bf16 v[32:35], v[236:239], v[96:99], v[32:35]
    ds_read_b64_tr_b16 v[228:229], v5 offset:25120
    v_mfma_f32_16x16x32_bf16 v[36:39], v[236:239], v[100:103], v[36:39]
    ds_read_b64_tr_b16 v[230:231], v5 offset:26144
    s_mov_b32 s23, 0x5800
    buffer_load_dwordx4 v[128:131], v7, s[8:11], s23 offen offset:1024 sc1
    s_waitcnt lgkmcnt(6)
    v_mfma_f32_16x16x32_bf16 v[40:43], v[240:243], v[96:99], v[40:43]
    ds_read_b64_tr_b16 v[232:233], v4 offset:25344
    s_mov_b64 s[76:77], s[54:55]
    s_mov_b32 s78, 0xc00000
    s_mov_b32 s79, 0x20000
    v_bfe_u32 v20, v1, 2, 2
    v_lshlrev_b32 v20, 12, v20
    v_add_u32 v6, v3, v20
    s_lshr_b32 s16, s2, 5
    s_lshl_b32 s16, s16, 7
    s_lshl_b32 s17, s3, 3
    s_add_u32 s16, s16, s17
    s_mul_i32 s14, s16, 12288
    s_and_b32 s16, s2, 31
    s_lshl_b32 s16, s16, 8
    s_add_u32 s14, s14, s16
    s_add_u32 s14, s14, 4096
    v_mfma_f32_16x16x32_bf16 v[44:47], v[240:243], v[100:103], v[44:47]
    ds_read_b64_tr_b16 v[234:235], v4 offset:26368
    s_waitcnt lgkmcnt(6)
    v_mfma_f32_16x16x32_bf16 v[48:51], v[244:247], v[96:99], v[48:51]
    ds_read_b64_tr_b16 v[236:237], v5 offset:25376
    v_mfma_f32_16x16x32_bf16 v[52:55], v[244:247], v[100:103], v[52:55]
    ds_read_b64_tr_b16 v[238:239], v5 offset:26400
    s_waitcnt lgkmcnt(6)
    v_mfma_f32_16x16x32_bf16 v[56:59], v[224:227], v[96:99], v[56:59]
    v_mfma_f32_16x16x32_bf16 v[60:63], v[224:227], v[100:103], v[60:63]
    s_waitcnt vmcnt(10)
    s_barrier
    ds_read_b64_tr_b16 v[240:241], v4 offset:32768
    ds_read_b64_tr_b16 v[242:243], v4 offset:33792
    s_waitcnt lgkmcnt(6)
    v_mfma_f32_16x16x32_bf16 v[64:67], v[228:231], v[96:99], v[64:67]
    ds_read_b64_tr_b16 v[244:245], v5 offset:32800
    v_mfma_f32_16x16x32_bf16 v[68:71], v[228:231], v[100:103], v[68:71]
    s_add_u32 s22, s19, 0x600000
    s_add_u32 m0, s20, 0x0
    s_nop 0
    buffer_load_dwordx4 v3, s[4:7], s22 offen lds
    ds_read_b64_tr_b16 v[246:247], v5 offset:33824
    s_mov_b32 s23, 0xd800
    buffer_load_dwordx4 v[132:135], v7, s[8:11], s23 offen offset:1024 sc1
    s_waitcnt lgkmcnt(6)
    v_mfma_f32_16x16x32_bf16 v[72:75], v[232:235], v[96:99], v[72:75]
    ds_read_b64_tr_b16 v[224:225], v4 offset:33024
    v_mfma_f32_16x16x32_bf16 v[76:79], v[232:235], v[100:103], v[76:79]
    ds_read_b64_tr_b16 v[226:227], v4 offset:34048
    s_waitcnt lgkmcnt(6)
    v_mfma_f32_16x16x32_bf16 v[80:83], v[236:239], v[96:99], v[80:83]
    ds_read_b64_tr_b16 v[228:229], v5 offset:33056
    v_mfma_f32_16x16x32_bf16 v[84:87], v[236:239], v[100:103], v[84:87]
    ds_read_b64_tr_b16 v[230:231], v5 offset:34080
    s_waitcnt vmcnt(11) lgkmcnt(6)
    v_mfma_f32_16x16x32_bf16 v[24:27], v[240:243], v[104:107], v[24:27]
    ds_read_b64_tr_b16 v[232:233], v4 offset:33280
    s_waitcnt vmcnt(10)
    v_mfma_f32_16x16x32_bf16 v[28:31], v[240:243], v[108:111], v[28:31]
    ds_read_b64_tr_b16 v[234:235], v4 offset:34304
    s_waitcnt lgkmcnt(6)
    v_mfma_f32_16x16x32_bf16 v[32:35], v[244:247], v[104:107], v[32:35]
    ds_read_b64_tr_b16 v[236:237], v5 offset:33312
    v_mfma_f32_16x16x32_bf16 v[36:39], v[244:247], v[108:111], v[36:39]
    s_add_u32 s22, s19, 0x608000
    s_add_u32 m0, s20, 0x400
    s_nop 0
    buffer_load_dwordx4 v3, s[4:7], s22 offen lds
    ds_read_b64_tr_b16 v[238:239], v5 offset:34336
    s_mov_b32 s23, 0x6000
    buffer_load_dwordx4 v[88:91], v7, s[8:11], s23 offen offset:0 sc1
    s_waitcnt lgkmcnt(6)
    v_mfma_f32_16x16x32_bf16 v[40:43], v[224:227], v[104:107], v[40:43]
    ds_read_b64_tr_b16 v[240:241], v4 offset:33536
    v_mfma_f32_16x16x32_bf16 v[44:47], v[224:227], v[108:111], v[44:47]
    ds_read_b64_tr_b16 v[242:243], v4 offset:34560
    s_waitcnt lgkmcnt(6)
    v_mfma_f32_16x16x32_bf16 v[48:51], v[228:231], v[104:107], v[48:51]
    ds_read_b64_tr_b16 v[244:245], v5 offset:33568
    v_mfma_f32_16x16x32_bf16 v[52:55], v[228:231], v[108:111], v[52:55]
    ds_read_b64_tr_b16 v[246:247], v5 offset:34592
    s_waitcnt lgkmcnt(6)
    v_mfma_f32_16x16x32_bf16 v[56:59], v[232:235], v[104:107], v[56:59]
    ds_read_b64_tr_b16 v[224:225], v4 offset:40960
    v_mfma_f32_16x16x32_bf16 v[60:63], v[232:235], v[108:111], v[60:63]
    ds_read_b64_tr_b16 v[226:227], v4 offset:41984
    s_waitcnt lgkmcnt(6)
    v_mfma_f32_16x16x32_bf16 v[64:67], v[236:239], v[104:107], v[64:67]
    ds_read_b64_tr_b16 v[228:229], v5 offset:40992
    v_mfma_f32_16x16x32_bf16 v[68:71], v[236:239], v[108:111], v[68:71]
    ds_read_b64_tr_b16 v[230:231], v5 offset:42016
    s_mov_b32 s23, 0xe000
    buffer_load_dwordx4 v[92:95], v7, s[8:11], s23 offen offset:0 sc1
    s_waitcnt lgkmcnt(6)
    v_mfma_f32_16x16x32_bf16 v[72:75], v[240:243], v[104:107], v[72:75]
    ds_read_b64_tr_b16 v[232:233], v4 offset:41216
    v_mfma_f32_16x16x32_bf16 v[76:79], v[240:243], v[108:111], v[76:79]
    ds_read_b64_tr_b16 v[234:235], v4 offset:42240
    s_waitcnt lgkmcnt(6)
    v_mfma_f32_16x16x32_bf16 v[80:83], v[244:247], v[104:107], v[80:83]
    ds_read_b64_tr_b16 v[236:237], v5 offset:41248
    v_mfma_f32_16x16x32_bf16 v[84:87], v[244:247], v[108:111], v[84:87]
    ds_read_b64_tr_b16 v[238:239], v5 offset:42272
    s_waitcnt vmcnt(12) lgkmcnt(6)
    v_mfma_f32_16x16x32_bf16 v[24:27], v[224:227], v[112:115], v[24:27]
    ds_read_b64_tr_b16 v[240:241], v4 offset:41472
    s_add_u32 s22, s14, 0x0
    s_add_u32 m0, s20, 0x10000
    s_nop 0
    buffer_load_dwordx4 v6, s[76:79], s22 offen lds
    s_waitcnt vmcnt(11)
    v_mfma_f32_16x16x32_bf16 v[28:31], v[224:227], v[116:119], v[28:31]
    ds_read_b64_tr_b16 v[242:243], v4 offset:42496
    s_waitcnt lgkmcnt(6)
    v_mfma_f32_16x16x32_bf16 v[32:35], v[228:231], v[112:115], v[32:35]
    ds_read_b64_tr_b16 v[244:245], v5 offset:41504
    v_mfma_f32_16x16x32_bf16 v[36:39], v[228:231], v[116:119], v[36:39]
    ds_read_b64_tr_b16 v[246:247], v5 offset:42528
    s_mov_b32 s23, 0x6000
    buffer_load_dwordx4 v[96:99], v7, s[8:11], s23 offen offset:1024 sc1
    s_waitcnt lgkmcnt(6)
    v_mfma_f32_16x16x32_bf16 v[40:43], v[232:235], v[112:115], v[40:43]
    ds_read_b64_tr_b16 v[224:225], v4 offset:41728
    s_add_u32 s22, s14, 0xc000
    s_add_u32 m0, s20, 0x10400
    s_nop 0
    buffer_load_dwordx4 v6, s[76:79], s22 offen lds
    v_mfma_f32_16x16x32_bf16 v[44:47], v[232:235], v[116:119], v[44:47]
    ds_read_b64_tr_b16 v[226:227], v4 offset:42752
    s_waitcnt lgkmcnt(6)
    v_mfma_f32_16x16x32_bf16 v[48:51], v[236:239], v[112:115], v[48:51]
    ds_read_b64_tr_b16 v[228:229], v5 offset:41760
    v_mfma_f32_16x16x32_bf16 v[52:55], v[236:239], v[116:119], v[52:55]
    ds_read_b64_tr_b16 v[230:231], v5 offset:42784
    s_waitcnt lgkmcnt(6)
    v_mfma_f32_16x16x32_bf16 v[56:59], v[240:243], v[112:115], v[56:59]
    v_mfma_f32_16x16x32_bf16 v[60:63], v[240:243], v[116:119], v[60:63]
    s_waitcnt vmcnt(12)
    s_barrier
    ds_read_b64_tr_b16 v[232:233], v4 offset:49152
    ds_read_b64_tr_b16 v[234:235], v4 offset:50176
    s_waitcnt lgkmcnt(6)
    v_mfma_f32_16x16x32_bf16 v[64:67], v[244:247], v[112:115], v[64:67]
    ds_read_b64_tr_b16 v[236:237], v5 offset:49184
    v_mfma_f32_16x16x32_bf16 v[68:71], v[244:247], v[116:119], v[68:71]
    s_add_u32 s22, s19, 0x680000
    s_add_u32 m0, s20, 0x4000
    s_nop 0
    buffer_load_dwordx4 v3, s[4:7], s22 offen lds
    ds_read_b64_tr_b16 v[238:239], v5 offset:50208
    s_mov_b32 s23, 0xe000
    buffer_load_dwordx4 v[100:103], v7, s[8:11], s23 offen offset:1024 sc1
    s_waitcnt lgkmcnt(6)
    v_mfma_f32_16x16x32_bf16 v[72:75], v[224:227], v[112:115], v[72:75]
    ds_read_b64_tr_b16 v[240:241], v4 offset:49408
    v_mfma_f32_16x16x32_bf16 v[76:79], v[224:227], v[116:119], v[76:79]
    ds_read_b64_tr_b16 v[242:243], v4 offset:50432
    s_waitcnt lgkmcnt(6)
    v_mfma_f32_16x16x32_bf16 v[80:83], v[228:231], v[112:115], v[80:83]
    ds_read_b64_tr_b16 v[244:245], v5 offset:49440
    v_mfma_f32_16x16x32_bf16 v[84:87], v[228:231], v[116:119], v[84:87]
    ds_read_b64_tr_b16 v[246:247], v5 offset:50464
    s_waitcnt vmcnt(13) lgkmcnt(6)
    v_mfma_f32_16x16x32_bf16 v[24:27], v[232:235], v[120:123], v[24:27]
    ds_read_b64_tr_b16 v[224:225], v4 offset:49664
    s_waitcnt vmcnt(12)
    v_mfma_f32_16x16x32_bf16 v[28:31], v[232:235], v[124:127], v[28:31]
    ds_read_b64_tr_b16 v[226:227], v4 offset:50688
    s_waitcnt lgkmcnt(6)
    v_mfma_f32_16x16x32_bf16 v[32:35], v[236:239], v[120:123], v[32:35]
    ds_read_b64_tr_b16 v[228:229], v5 offset:49696
    v_mfma_f32_16x16x32_bf16 v[36:39], v[236:239], v[124:127], v[36:39]
    s_add_u32 s22, s19, 0x688000
    s_add_u32 m0, s20, 0x4400
    s_nop 0
    buffer_load_dwordx4 v3, s[4:7], s22 offen lds
    ds_read_b64_tr_b16 v[230:231], v5 offset:50720
    s_mov_b32 s23, 0x6800
    buffer_load_dwordx4 v[104:107], v7, s[8:11], s23 offen offset:0 sc1
    s_waitcnt lgkmcnt(6)
    v_mfma_f32_16x16x32_bf16 v[40:43], v[240:243], v[120:123], v[40:43]
    ds_read_b64_tr_b16 v[232:233], v4 offset:49920
    v_mfma_f32_16x16x32_bf16 v[44:47], v[240:243], v[124:127], v[44:47]
    ds_read_b64_tr_b16 v[234:235], v4 offset:50944
    s_waitcnt lgkmcnt(6)
    v_mfma_f32_16x16x32_bf16 v[48:51], v[244:247], v[120:123], v[48:51]
    ds_read_b64_tr_b16 v[236:237], v5 offset:49952
    v_mfma_f32_16x16x32_bf16 v[52:55], v[244:247], v[124:127], v[52:55]
    ds_read_b64_tr_b16 v[238:239], v5 offset:50976
    s_waitcnt lgkmcnt(6)
    v_mfma_f32_16x16x32_bf16 v[56:59], v[224:227], v[120:123], v[56:59]
    ds_read_b64_tr_b16 v[240:241], v4 offset:57344
    v_mfma_f32_16x16x32_bf16 v[60:63], v[224:227], v[124:127], v[60:63]
    ds_read_b64_tr_b16 v[242:243], v4 offset:58368
    s_waitcnt lgkmcnt(6)
    v_mfma_f32_16x16x32_bf16 v[64:67], v[228:231], v[120:123], v[64:67]
    ds_read_b64_tr_b16 v[244:245], v5 offset:57376
    v_mfma_f32_16x16x32_bf16 v[68:71], v[228:231], v[124:127], v[68:71]
    ds_read_b64_tr_b16 v[246:247], v5 offset:58400
    s_mov_b32 s23, 0xe800
    buffer_load_dwordx4 v[108:111], v7, s[8:11], s23 offen offset:0 sc1
    s_waitcnt lgkmcnt(6)
    v_mfma_f32_16x16x32_bf16 v[72:75], v[232:235], v[120:123], v[72:75]
    ds_read_b64_tr_b16 v[224:225], v4 offset:57600
    v_mfma_f32_16x16x32_bf16 v[76:79], v[232:235], v[124:127], v[76:79]
    ds_read_b64_tr_b16 v[226:227], v4 offset:58624
    s_waitcnt lgkmcnt(6)
    v_mfma_f32_16x16x32_bf16 v[80:83], v[236:239], v[120:123], v[80:83]
    ds_read_b64_tr_b16 v[228:229], v5 offset:57632
    v_mfma_f32_16x16x32_bf16 v[84:87], v[236:239], v[124:127], v[84:87]
    ds_read_b64_tr_b16 v[230:231], v5 offset:58656
    s_waitcnt vmcnt(13) lgkmcnt(6)
    v_mfma_f32_16x16x32_bf16 v[24:27], v[240:243], v[128:131], v[24:27]
    ds_read_b64_tr_b16 v[232:233], v4 offset:57856
    s_add_u32 s22, s14, 0xc0000
    s_add_u32 m0, s20, 0x14000
    s_nop 0
    buffer_load_dwordx4 v6, s[76:79], s22 offen lds
    s_waitcnt vmcnt(12)
    v_mfma_f32_16x16x32_bf16 v[28:31], v[240:243], v[132:135], v[28:31]
    ds_read_b64_tr_b16 v[234:235], v4 offset:58880
    s_waitcnt lgkmcnt(6)
    v_mfma_f32_16x16x32_bf16 v[32:35], v[244:247], v[128:131], v[32:35]
    ds_read_b64_tr_b16 v[236:237], v5 offset:57888
    v_mfma_f32_16x16x32_bf16 v[36:39], v[244:247], v[132:135], v[36:39]
    ds_read_b64_tr_b16 v[238:239], v5 offset:58912
    s_mov_b32 s23, 0x6800
    buffer_load_dwordx4 v[112:115], v7, s[8:11], s23 offen offset:1024 sc1
    s_waitcnt lgkmcnt(6)
    v_mfma_f32_16x16x32_bf16 v[40:43], v[224:227], v[128:131], v[40:43]
    ds_read_b64_tr_b16 v[240:241], v4 offset:58112
    s_add_u32 s22, s14, 0xcc000
    s_add_u32 m0, s20, 0x14400
    s_nop 0
    buffer_load_dwordx4 v6, s[76:79], s22 offen lds
    v_mfma_f32_16x16x32_bf16 v[44:47], v[224:227], v[132:135], v[44:47]
    ds_read_b64_tr_b16 v[242:243], v4 offset:59136
    s_waitcnt lgkmcnt(6)
    v_mfma_f32_16x16x32_bf16 v[48:51], v[228:231], v[128:131], v[48:51]
    ds_read_b64_tr_b16 v[244:245], v5 offset:58144
    v_mfma_f32_16x16x32_bf16 v[52:55], v[228:231], v[132:135], v[52:55]
    ds_read_b64_tr_b16 v[246:247], v5 offset:59168
    s_waitcnt lgkmcnt(6)
    v_mfma_f32_16x16x32_bf16 v[56:59], v[232:235], v[128:131], v[56:59]
    v_mfma_f32_16x16x32_bf16 v[60:63], v[232:235], v[132:135], v[60:63]
    s_waitcnt vmcnt(13)
    s_barrier
    ds_read_b64_tr_b16 v[224:225], v4 offset:0
    ds_read_b64_tr_b16 v[226:227], v4 offset:1024
    s_waitcnt lgkmcnt(6)
    v_mfma_f32_16x16x32_bf16 v[64:67], v[236:239], v[128:131], v[64:67]
    ds_read_b64_tr_b16 v[228:229], v5 offset:32
    v_mfma_f32_16x16x32_bf16 v[68:71], v[236:239], v[132:135], v[68:71]
    s_add_u32 s22, s19, 0x700000
    s_add_u32 m0, s20, 0x8000
    s_nop 0
    buffer_load_dwordx4 v3, s[4:7], s22 offen lds
    ds_read_b64_tr_b16 v[230:231], v5 offset:1056
    s_mov_b32 s23, 0xe800
    buffer_load_dwordx4 v[116:119], v7, s[8:11], s23 offen offset:1024 sc1
    s_waitcnt lgkmcnt(6)
    v_mfma_f32_16x16x32_bf16 v[72:75], v[240:243], v[128:131], v[72:75]
    ds_read_b64_tr_b16 v[232:233], v4 offset:256
    v_mfma_f32_16x16x32_bf16 v[76:79], v[240:243], v[132:135], v[76:79]
    ds_read_b64_tr_b16 v[234:235], v4 offset:1280
    s_waitcnt lgkmcnt(6)
    v_mfma_f32_16x16x32_bf16 v[80:83], v[244:247], v[128:131], v[80:83]
    ds_read_b64_tr_b16 v[236:237], v5 offset:288
    v_mfma_f32_16x16x32_bf16 v[84:87], v[244:247], v[132:135], v[84:87]
    ds_read_b64_tr_b16 v[238:239], v5 offset:1312
    s_waitcnt vmcnt(14) lgkmcnt(6)
    v_mfma_f32_16x16x32_bf16 v[24:27], v[224:227], v[88:91], v[24:27]
    ds_read_b64_tr_b16 v[240:241], v4 offset:512
    s_waitcnt vmcnt(13)
    v_mfma_f32_16x16x32_bf16 v[28:31], v[224:227], v[92:95], v[28:31]
    ds_read_b64_tr_b16 v[242:243], v4 offset:1536
    s_waitcnt lgkmcnt(6)
    v_mfma_f32_16x16x32_bf16 v[32:35], v[228:231], v[88:91], v[32:35]
    ds_read_b64_tr_b16 v[244:245], v5 offset:544
    v_mfma_f32_16x16x32_bf16 v[36:39], v[228:231], v[92:95], v[36:39]
    s_add_u32 s22, s19, 0x708000
    s_add_u32 m0, s20, 0x8400
    s_nop 0
    buffer_load_dwordx4 v3, s[4:7], s22 offen lds
    ds_read_b64_tr_b16 v[246:247], v5 offset:1568
    s_mov_b32 s23, 0x7000
    buffer_load_dwordx4 v[120:123], v7, s[8:11], s23 offen offset:0 sc1
    s_waitcnt lgkmcnt(6)
    v_mfma_f32_16x16x32_bf16 v[40:43], v[232:235], v[88:91], v[40:43]
    ds_read_b64_tr_b16 v[224:225], v4 offset:768
    v_mfma_f32_16x16x32_bf16 v[44:47], v[232:235], v[92:95], v[44:47]
    ds_read_b64_tr_b16 v[226:227], v4 offset:1792
    s_waitcnt lgkmcnt(6)
    v_mfma_f32_16x16x32_bf16 v[48:51], v[236:239], v[88:91], v[48:51]
    ds_read_b64_tr_b16 v[228:229], v5 offset:800
    v_mfma_f32_16x16x32_bf16 v[52:55], v[236:239], v[92:95], v[52:55]
    ds_read_b64_tr_b16 v[230:231], v5 offset:1824
    s_waitcnt lgkmcnt(6)
    v_mfma_f32_16x16x32_bf16 v[56:59], v[240:243], v[88:91], v[56:59]
    ds_read_b64_tr_b16 v[232:233], v4 offset:8192
    v_mfma_f32_16x16x32_bf16 v[60:63], v[240:243], v[92:95], v[60:63]
    ds_read_b64_tr_b16 v[234:235], v4 offset:9216
    s_waitcnt lgkmcnt(6)
    v_mfma_f32_16x16x32_bf16 v[64:67], v[244:247], v[88:91], v[64:67]
    ds_read_b64_tr_b16 v[236:237], v5 offset:8224
    v_mfma_f32_16x16x32_bf16 v[68:71], v[244:247], v[92:95], v[68:71]
    ds_read_b64_tr_b16 v[238:239], v5 offset:9248
    s_mov_b32 s23, 0xf000
    buffer_load_dwordx4 v[124:127], v7, s[8:11], s23 offen offset:0 sc1
    s_waitcnt lgkmcnt(6)
    v_mfma_f32_16x16x32_bf16 v[72:75], v[224:227], v[88:91], v[72:75]
    ds_read_b64_tr_b16 v[240:241], v4 offset:8448
    v_mfma_f32_16x16x32_bf16 v[76:79], v[224:227], v[92:95], v[76:79]
    ds_read_b64_tr_b16 v[242:243], v4 offset:9472
    s_waitcnt lgkmcnt(6)
    v_mfma_f32_16x16x32_bf16 v[80:83], v[228:231], v[88:91], v[80:83]
    ds_read_b64_tr_b16 v[244:245], v5 offset:8480
    v_mfma_f32_16x16x32_bf16 v[84:87], v[228:231], v[92:95], v[84:87]
    ds_read_b64_tr_b16 v[246:247], v5 offset:9504
    s_waitcnt vmcnt(14) lgkmcnt(6)
    v_mfma_f32_16x16x32_bf16 v[24:27], v[232:235], v[96:99], v[24:27]
    ds_read_b64_tr_b16 v[224:225], v4 offset:8704
    s_add_u32 s22, s21, 0x0
    s_add_u32 m0, s20, 0x18000
    s_nop 0
    buffer_load_dwordx4 v2, s[8:11], s22 offen sc1 lds
    s_waitcnt vmcnt(12)
    v_mfma_f32_16x16x32_bf16 v[28:31], v[232:235], v[100:103], v[28:31]
    ds_read_b64_tr_b16 v[226:227], v4 offset:9728
    s_waitcnt lgkmcnt(6)
    v_mfma_f32_16x16x32_bf16 v[32:35], v[236:239], v[96:99], v[32:35]
    ds_read_b64_tr_b16 v[228:229], v5 offset:8736
    v_mfma_f32_16x16x32_bf16 v[36:39], v[236:239], v[100:103], v[36:39]
    ds_read_b64_tr_b16 v[230:231], v5 offset:9760
    s_mov_b32 s23, 0x7000
    buffer_load_dwordx4 v[128:131], v7, s[8:11], s23 offen offset:1024 sc1
    s_waitcnt lgkmcnt(6)
    v_mfma_f32_16x16x32_bf16 v[40:43], v[240:243], v[96:99], v[40:43]
    ds_read_b64_tr_b16 v[232:233], v4 offset:8960
    s_add_u32 s22, s21, 0x400
    s_add_u32 m0, s20, 0x18400
    s_nop 0
    buffer_load_dwordx4 v2, s[8:11], s22 offen sc1 lds
    v_mfma_f32_16x16x32_bf16 v[44:47], v[240:243], v[100:103], v[44:47]
    ds_read_b64_tr_b16 v[234:235], v4 offset:9984
    s_waitcnt lgkmcnt(6)
    v_mfma_f32_16x16x32_bf16 v[48:51], v[244:247], v[96:99], v[48:51]
    ds_read_b64_tr_b16 v[236:237], v5 offset:8992
    v_mfma_f32_16x16x32_bf16 v[52:55], v[244:247], v[100:103], v[52:55]
    ds_read_b64_tr_b16 v[238:239], v5 offset:10016
    s_waitcnt lgkmcnt(6)
    v_mfma_f32_16x16x32_bf16 v[56:59], v[224:227], v[96:99], v[56:59]
    v_mfma_f32_16x16x32_bf16 v[60:63], v[224:227], v[100:103], v[60:63]
    s_waitcnt vmcnt(13)
    s_barrier
    ds_read_b64_tr_b16 v[240:241], v4 offset:16384
    ds_read_b64_tr_b16 v[242:243], v4 offset:17408
    s_waitcnt lgkmcnt(6)
    v_mfma_f32_16x16x32_bf16 v[64:67], v[228:231], v[96:99], v[64:67]
    ds_read_b64_tr_b16 v[244:245], v5 offset:16416
    v_mfma_f32_16x16x32_bf16 v[68:71], v[228:231], v[100:103], v[68:71]
    s_add_u32 s22, s19, 0x780000
    s_add_u32 m0, s20, 0xc000
    s_nop 0
    buffer_load_dwordx4 v3, s[4:7], s22 offen lds
    ds_read_b64_tr_b16 v[246:247], v5 offset:17440
    s_mov_b32 s23, 0xf000
    buffer_load_dwordx4 v[132:135], v7, s[8:11], s23 offen offset:1024 sc1
    s_waitcnt lgkmcnt(6)
    v_mfma_f32_16x16x32_bf16 v[72:75], v[232:235], v[96:99], v[72:75]
    ds_read_b64_tr_b16 v[224:225], v4 offset:16640
    v_mfma_f32_16x16x32_bf16 v[76:79], v[232:235], v[100:103], v[76:79]
    ds_read_b64_tr_b16 v[226:227], v4 offset:17664
    s_waitcnt lgkmcnt(6)
    v_mfma_f32_16x16x32_bf16 v[80:83], v[236:239], v[96:99], v[80:83]
    ds_read_b64_tr_b16 v[228:229], v5 offset:16672
    v_mfma_f32_16x16x32_bf16 v[84:87], v[236:239], v[100:103], v[84:87]
    ds_read_b64_tr_b16 v[230:231], v5 offset:17696
    s_waitcnt vmcnt(14) lgkmcnt(6)
    v_mfma_f32_16x16x32_bf16 v[24:27], v[240:243], v[104:107], v[24:27]
    ds_read_b64_tr_b16 v[232:233], v4 offset:16896
    s_waitcnt vmcnt(13)
    v_mfma_f32_16x16x32_bf16 v[28:31], v[240:243], v[108:111], v[28:31]
    ds_read_b64_tr_b16 v[234:235], v4 offset:17920
    s_waitcnt lgkmcnt(6)
    v_mfma_f32_16x16x32_bf16 v[32:35], v[244:247], v[104:107], v[32:35]
    ds_read_b64_tr_b16 v[236:237], v5 offset:16928
    v_mfma_f32_16x16x32_bf16 v[36:39], v[244:247], v[108:111], v[36:39]
    s_add_u32 s22, s19, 0x788000
    s_add_u32 m0, s20, 0xc400
    s_nop 0
    buffer_load_dwordx4 v3, s[4:7], s22 offen lds
    ds_read_b64_tr_b16 v[238:239], v5 offset:17952
    s_mov_b32 s23, 0x7800
    buffer_load_dwordx4 v[88:91], v7, s[8:11], s23 offen offset:0 sc1
    s_waitcnt lgkmcnt(6)
    v_mfma_f32_16x16x32_bf16 v[40:43], v[224:227], v[104:107], v[40:43]
    ds_read_b64_tr_b16 v[240:241], v4 offset:17152
    v_lshrrev_b32 v20, 4, v1
    v_lshlrev_b32 v21, 4, v20
    s_lshl_b32 s16, s2, 8
    s_add_u32 s16, s16, 0x550000
    buffer_load_dwordx4 v[136:139], v21, s[8:11], s16 offen offset:0 sc1
    buffer_load_dwordx4 v[140:143], v21, s[8:11], s16 offen offset:64 sc1
    buffer_load_dwordx4 v[144:147], v21, s[8:11], s16 offen offset:128 sc1
    buffer_load_dwordx4 v[148:151], v21, s[8:11], s16 offen offset:192 sc1
    v_lshlrev_b32 v11, 11, v20
    v_xor_b32 v20, s3, v20
    v_and_b32 v20, 1, v20
    v_lshl_add_u32 v11, v20, 5, v11
    v_bfe_u32 v20, v1, 2, 2
    v_lshl_add_u32 v11, v20, 6, v11
    v_and_b32 v20, 3, v1
    v_lshl_add_u32 v11, v20, 3, v11
    s_lshr_b32 s16, s3, 1
    s_lshl_b32 s16, s16, 8
    s_add_u32 s16, s16, 65536
    v_add_u32 v11, s16, v11
    v_mfma_f32_16x16x32_bf16 v[44:47], v[224:227], v[108:111], v[44:47]
    ds_read_b64_tr_b16 v[242:243], v4 offset:18176
    s_waitcnt lgkmcnt(6)
    v_mfma_f32_16x16x32_bf16 v[48:51], v[228:231], v[104:107], v[48:51]
    ds_read_b64_tr_b16 v[244:245], v5 offset:17184
    v_mfma_f32_16x16x32_bf16 v[52:55], v[228:231], v[108:111], v[52:55]
    ds_read_b64_tr_b16 v[246:247], v5 offset:18208
    s_waitcnt lgkmcnt(6)
    v_mfma_f32_16x16x32_bf16 v[56:59], v[232:235], v[104:107], v[56:59]
    ds_read_b64_tr_b16 v[224:225], v4 offset:24576
    v_mfma_f32_16x16x32_bf16 v[60:63], v[232:235], v[108:111], v[60:63]
    ds_read_b64_tr_b16 v[226:227], v4 offset:25600
    s_waitcnt lgkmcnt(6)
    v_mfma_f32_16x16x32_bf16 v[64:67], v[236:239], v[104:107], v[64:67]
    ds_read_b64_tr_b16 v[228:229], v5 offset:24608
    v_mfma_f32_16x16x32_bf16 v[68:71], v[236:239], v[108:111], v[68:71]
    ds_read_b64_tr_b16 v[230:231], v5 offset:25632
    s_mov_b32 s23, 0xf800
    buffer_load_dwordx4 v[92:95], v7, s[8:11], s23 offen offset:0 sc1
    s_waitcnt lgkmcnt(6)
    v_mfma_f32_16x16x32_bf16 v[72:75], v[240:243], v[104:107], v[72:75]
    ds_read_b64_tr_b16 v[232:233], v4 offset:24832
    v_mfma_f32_16x16x32_bf16 v[76:79], v[240:243], v[108:111], v[76:79]
    ds_read_b64_tr_b16 v[234:235], v4 offset:25856
    s_waitcnt lgkmcnt(6)
    v_mfma_f32_16x16x32_bf16 v[80:83], v[244:247], v[104:107], v[80:83]
    ds_read_b64_tr_b16 v[236:237], v5 offset:24864
    v_mfma_f32_16x16x32_bf16 v[84:87], v[244:247], v[108:111], v[84:87]
    ds_read_b64_tr_b16 v[238:239], v5 offset:25888
    s_waitcnt vmcnt(18) lgkmcnt(6)
    v_mfma_f32_16x16x32_bf16 v[24:27], v[224:227], v[112:115], v[24:27]
    ds_read_b64_tr_b16 v[240:241], v4 offset:25088
    s_add_u32 s22, s21, 0x4000
    s_add_u32 m0, s20, 0x1c000
    s_nop 0
    buffer_load_dwordx4 v2, s[8:11], s22 offen sc1 lds
    s_waitcnt vmcnt(16)
    v_mfma_f32_16x16x32_bf16 v[28:31], v[224:227], v[116:119], v[28:31]
    ds_read_b64_tr_b16 v[242:243], v4 offset:26112
    s_waitcnt lgkmcnt(6)
    v_mfma_f32_16x16x32_bf16 v[32:35], v[228:231], v[112:115], v[32:35]
    ds_read_b64_tr_b16 v[244:245], v5 offset:25120
    v_mfma_f32_16x16x32_bf16 v[36:39], v[228:231], v[116:119], v[36:39]
    ds_read_b64_tr_b16 v[246:247], v5 offset:26144
    s_mov_b32 s23, 0x7800
    buffer_load_dwordx4 v[96:99], v7, s[8:11], s23 offen offset:1024 sc1
    s_waitcnt lgkmcnt(6)
    v_mfma_f32_16x16x32_bf16 v[40:43], v[232:235], v[112:115], v[40:43]
    ds_read_b64_tr_b16 v[224:225], v4 offset:25344
    s_add_u32 s22, s21, 0x4400
    s_add_u32 m0, s20, 0x1c400
    s_nop 0
    buffer_load_dwordx4 v2, s[8:11], s22 offen sc1 lds
    v_mfma_f32_16x16x32_bf16 v[44:47], v[232:235], v[116:119], v[44:47]
    ds_read_b64_tr_b16 v[226:227], v4 offset:26368
    s_waitcnt lgkmcnt(6)
    v_mfma_f32_16x16x32_bf16 v[48:51], v[236:239], v[112:115], v[48:51]
    ds_read_b64_tr_b16 v[228:229], v5 offset:25376
    v_mfma_f32_16x16x32_bf16 v[52:55], v[236:239], v[116:119], v[52:55]
    ds_read_b64_tr_b16 v[230:231], v5 offset:26400
    s_waitcnt lgkmcnt(6)
    v_mfma_f32_16x16x32_bf16 v[56:59], v[240:243], v[112:115], v[56:59]
    v_mfma_f32_16x16x32_bf16 v[60:63], v[240:243], v[116:119], v[60:63]
    s_waitcnt vmcnt(17)
    s_barrier
    ds_read_b64_tr_b16 v[232:233], v4 offset:32768
    ds_read_b64_tr_b16 v[234:235], v4 offset:33792
    s_waitcnt lgkmcnt(6)
    v_mfma_f32_16x16x32_bf16 v[64:67], v[244:247], v[112:115], v[64:67]
    ds_read_b64_tr_b16 v[236:237], v5 offset:32800
    v_mfma_f32_16x16x32_bf16 v[68:71], v[244:247], v[116:119], v[68:71]
    ds_read_b64_tr_b16 v[238:239], v5 offset:33824
    s_mov_b32 s23, 0xf800
    buffer_load_dwordx4 v[100:103], v7, s[8:11], s23 offen offset:1024 sc1
    s_waitcnt lgkmcnt(6)
    v_mfma_f32_16x16x32_bf16 v[72:75], v[224:227], v[112:115], v[72:75]
    ds_read_b64_tr_b16 v[240:241], v4 offset:33024
    v_mfma_f32_16x16x32_bf16 v[76:79], v[224:227], v[116:119], v[76:79]
    ds_read_b64_tr_b16 v[242:243], v4 offset:34048
    s_waitcnt lgkmcnt(6)
    v_mfma_f32_16x16x32_bf16 v[80:83], v[228:231], v[112:115], v[80:83]
    ds_read_b64_tr_b16 v[244:245], v5 offset:33056
    v_mfma_f32_16x16x32_bf16 v[84:87], v[228:231], v[116:119], v[84:87]
    ds_read_b64_tr_b16 v[246:247], v5 offset:34080
    s_waitcnt vmcnt(17) lgkmcnt(6)
    v_mfma_f32_16x16x32_bf16 v[24:27], v[232:235], v[120:123], v[24:27]
    ds_read_b64_tr_b16 v[224:225], v4 offset:33280
    s_waitcnt vmcnt(16)
    v_mfma_f32_16x16x32_bf16 v[28:31], v[232:235], v[124:127], v[28:31]
    ds_read_b64_tr_b16 v[226:227], v4 offset:34304
    s_waitcnt lgkmcnt(6)
    v_mfma_f32_16x16x32_bf16 v[32:35], v[236:239], v[120:123], v[32:35]
    ds_read_b64_tr_b16 v[228:229], v5 offset:33312
    v_mfma_f32_16x16x32_bf16 v[36:39], v[236:239], v[124:127], v[36:39]
    ds_read_b64_tr_b16 v[230:231], v5 offset:34336
    s_waitcnt lgkmcnt(6)
    v_mfma_f32_16x16x32_bf16 v[40:43], v[240:243], v[120:123], v[40:43]
    ds_read_b64_tr_b16 v[232:233], v4 offset:33536
    v_mfma_f32_16x16x32_bf16 v[44:47], v[240:243], v[124:127], v[44:47]
    ds_read_b64_tr_b16 v[234:235], v4 offset:34560
    s_waitcnt lgkmcnt(6)
    v_mfma_f32_16x16x32_bf16 v[48:51], v[244:247], v[120:123], v[48:51]
    ds_read_b64_tr_b16 v[236:237], v5 offset:33568
    v_mfma_f32_16x16x32_bf16 v[52:55], v[244:247], v[124:127], v[52:55]
    ds_read_b64_tr_b16 v[238:239], v5 offset:34592
    s_waitcnt lgkmcnt(6)
    v_mfma_f32_16x16x32_bf16 v[56:59], v[224:227], v[120:123], v[56:59]
    ds_read_b64_tr_b16 v[240:241], v4 offset:40960
    v_mfma_f32_16x16x32_bf16 v[60:63], v[224:227], v[124:127], v[60:63]
    ds_read_b64_tr_b16 v[242:243], v4 offset:41984
    s_waitcnt lgkmcnt(6)
    v_mfma_f32_16x16x32_bf16 v[64:67], v[228:231], v[120:123], v[64:67]
    ds_read_b64_tr_b16 v[244:245], v5 offset:40992
    v_mfma_f32_16x16x32_bf16 v[68:71], v[228:231], v[124:127], v[68:71]
    ds_read_b64_tr_b16 v[246:247], v5 offset:42016
    s_waitcnt lgkmcnt(6)
    v_mfma_f32_16x16x32_bf16 v[72:75], v[232:235], v[120:123], v[72:75]
    ds_read_b64_tr_b16 v[224:225], v4 offset:41216
    v_mfma_f32_16x16x32_bf16 v[76:79], v[232:235], v[124:127], v[76:79]
    ds_read_b64_tr_b16 v[226:227], v4 offset:42240
    s_waitcnt lgkmcnt(6)
    v_mfma_f32_16x16x32_bf16 v[80:83], v[236:239], v[120:123], v[80:83]
    ds_read_b64_tr_b16 v[228:229], v5 offset:41248
    v_mfma_f32_16x16x32_bf16 v[84:87], v[236:239], v[124:127], v[84:87]
    ds_read_b64_tr_b16 v[230:231], v5 offset:42272
    s_waitcnt vmcnt(14) lgkmcnt(6)
    v_mfma_f32_16x16x32_bf16 v[24:27], v[240:243], v[128:131], v[24:27]
    ds_read_b64_tr_b16 v[232:233], v4 offset:41472
    s_waitcnt vmcnt(11)
    v_mfma_f32_16x16x32_bf16 v[28:31], v[240:243], v[132:135], v[28:31]
    ds_read_b64_tr_b16 v[234:235], v4 offset:42496
    s_waitcnt lgkmcnt(6)
    v_mfma_f32_16x16x32_bf16 v[32:35], v[244:247], v[128:131], v[32:35]
    ds_read_b64_tr_b16 v[236:237], v5 offset:41504
    v_mfma_f32_16x16x32_bf16 v[36:39], v[244:247], v[132:135], v[36:39]
    ds_read_b64_tr_b16 v[238:239], v5 offset:42528
    s_waitcnt lgkmcnt(6)
    v_mfma_f32_16x16x32_bf16 v[40:43], v[224:227], v[128:131], v[40:43]
    ds_read_b64_tr_b16 v[240:241], v4 offset:41728
    v_mfma_f32_16x16x32_bf16 v[44:47], v[224:227], v[132:135], v[44:47]
    ds_read_b64_tr_b16 v[242:243], v4 offset:42752
    s_waitcnt lgkmcnt(6)
    v_mfma_f32_16x16x32_bf16 v[48:51], v[228:231], v[128:131], v[48:51]
    ds_read_b64_tr_b16 v[244:245], v5 offset:41760
    v_mfma_f32_16x16x32_bf16 v[52:55], v[228:231], v[132:135], v[52:55]
    ds_read_b64_tr_b16 v[246:247], v5 offset:42784
    s_waitcnt lgkmcnt(6)
    v_mfma_f32_16x16x32_bf16 v[56:59], v[232:235], v[128:131], v[56:59]
    v_mfma_f32_16x16x32_bf16 v[60:63], v[232:235], v[132:135], v[60:63]
    s_waitcnt vmcnt(10)
    s_barrier
    ds_read_b64_tr_b16 v[224:225], v4 offset:49152
    ds_read_b64_tr_b16 v[226:227], v4 offset:50176
    s_waitcnt lgkmcnt(6)
    v_mfma_f32_16x16x32_bf16 v[64:67], v[236:239], v[128:131], v[64:67]
    ds_read_b64_tr_b16 v[228:229], v5 offset:49184
    v_mfma_f32_16x16x32_bf16 v[68:71], v[236:239], v[132:135], v[68:71]
    ds_read_b64_tr_b16 v[230:231], v5 offset:50208
    s_waitcnt lgkmcnt(6)
    v_mfma_f32_16x16x32_bf16 v[72:75], v[240:243], v[128:131], v[72:75]
    ds_read_b64_tr_b16 v[232:233], v4 offset:49408
    v_mfma_f32_16x16x32_bf16 v[76:79], v[240:243], v[132:135], v[76:79]
    ds_read_b64_tr_b16 v[234:235], v4 offset:50432
    s_waitcnt lgkmcnt(6)
    v_mfma_f32_16x16x32_bf16 v[80:83], v[244:247], v[128:131], v[80:83]
    ds_read_b64_tr_b16 v[236:237], v5 offset:49440
    v_mfma_f32_16x16x32_bf16 v[84:87], v[244:247], v[132:135], v[84:87]
    ds_read_b64_tr_b16 v[238:239], v5 offset:50464
    s_waitcnt vmcnt(9) lgkmcnt(6)
    v_mfma_f32_16x16x32_bf16 v[24:27], v[224:227], v[88:91], v[24:27]
    ds_read_b64_tr_b16 v[240:241], v4 offset:49664
    s_waitcnt vmcnt(4)
    v_mfma_f32_16x16x32_bf16 v[28:31], v[224:227], v[92:95], v[28:31]
    ds_read_b64_tr_b16 v[242:243], v4 offset:50688
    s_waitcnt lgkmcnt(6)
    v_mfma_f32_16x16x32_bf16 v[32:35], v[228:231], v[88:91], v[32:35]
    ds_read_b64_tr_b16 v[244:245], v5 offset:49696
    v_mfma_f32_16x16x32_bf16 v[36:39], v[228:231], v[92:95], v[36:39]
    ds_read_b64_tr_b16 v[246:247], v5 offset:50720
    s_waitcnt lgkmcnt(6)
    v_mfma_f32_16x16x32_bf16 v[40:43], v[232:235], v[88:91], v[40:43]
    ds_read_b64_tr_b16 v[224:225], v4 offset:49920
    v_mfma_f32_16x16x32_bf16 v[44:47], v[232:235], v[92:95], v[44:47]
    ds_read_b64_tr_b16 v[226:227], v4 offset:50944
    s_waitcnt lgkmcnt(6)
    v_mfma_f32_16x16x32_bf16 v[48:51], v[236:239], v[88:91], v[48:51]
    ds_read_b64_tr_b16 v[228:229], v5 offset:49952
    v_mfma_f32_16x16x32_bf16 v[52:55], v[236:239], v[92:95], v[52:55]
    ds_read_b64_tr_b16 v[230:231], v5 offset:50976
    s_waitcnt lgkmcnt(6)
    v_mfma_f32_16x16x32_bf16 v[56:59], v[240:243], v[88:91], v[56:59]
    ds_read_b64_tr_b16 v[232:233], v4 offset:57344
    v_mfma_f32_16x16x32_bf16 v[60:63], v[240:243], v[92:95], v[60:63]
    ds_read_b64_tr_b16 v[234:235], v4 offset:58368
    s_waitcnt lgkmcnt(6)
    v_mfma_f32_16x16x32_bf16 v[64:67], v[244:247], v[88:91], v[64:67]
    ds_read_b64_tr_b16 v[236:237], v5 offset:57376
    v_mfma_f32_16x16x32_bf16 v[68:71], v[244:247], v[92:95], v[68:71]
    ds_read_b64_tr_b16 v[238:239], v5 offset:58400
    s_waitcnt lgkmcnt(6)
    v_mfma_f32_16x16x32_bf16 v[72:75], v[224:227], v[88:91], v[72:75]
    ds_read_b64_tr_b16 v[240:241], v4 offset:57600
    v_mfma_f32_16x16x32_bf16 v[76:79], v[224:227], v[92:95], v[76:79]
    ds_read_b64_tr_b16 v[242:243], v4 offset:58624
    s_waitcnt lgkmcnt(6)
    v_mfma_f32_16x16x32_bf16 v[80:83], v[228:231], v[88:91], v[80:83]
    ds_read_b64_tr_b16 v[244:245], v5 offset:57632
    v_mfma_f32_16x16x32_bf16 v[84:87], v[228:231], v[92:95], v[84:87]
    ds_read_b64_tr_b16 v[246:247], v5 offset:58656
    s_waitcnt vmcnt(2) lgkmcnt(6)
    v_mfma_f32_16x16x32_bf16 v[24:27], v[232:235], v[96:99], v[24:27]
    ds_read_b64_tr_b16 v[224:225], v4 offset:57856
    s_waitcnt vmcnt(0)
    v_mfma_f32_16x16x32_bf16 v[28:31], v[232:235], v[100:103], v[28:31]
    ds_read_b64_tr_b16 v[226:227], v4 offset:58880
    s_waitcnt lgkmcnt(6)
    v_mfma_f32_16x16x32_bf16 v[32:35], v[236:239], v[96:99], v[32:35]
    ds_read_b64_tr_b16 v[228:229], v5 offset:57888
    v_mfma_f32_16x16x32_bf16 v[36:39], v[236:239], v[100:103], v[36:39]
    ds_read_b64_tr_b16 v[230:231], v5 offset:58912
    s_waitcnt lgkmcnt(6)
    v_mfma_f32_16x16x32_bf16 v[40:43], v[240:243], v[96:99], v[40:43]
    ds_read_b64_tr_b16 v[232:233], v4 offset:58112
    v_mfma_f32_16x16x32_bf16 v[44:47], v[240:243], v[100:103], v[44:47]
    ds_read_b64_tr_b16 v[234:235], v4 offset:59136
    s_waitcnt lgkmcnt(6)
    v_mfma_f32_16x16x32_bf16 v[48:51], v[244:247], v[96:99], v[48:51]
    ds_read_b64_tr_b16 v[236:237], v5 offset:58144
    v_mfma_f32_16x16x32_bf16 v[52:55], v[244:247], v[100:103], v[52:55]
    ds_read_b64_tr_b16 v[238:239], v5 offset:59168
    s_waitcnt lgkmcnt(6)
    v_mfma_f32_16x16x32_bf16 v[56:59], v[224:227], v[96:99], v[56:59]
    v_mfma_f32_16x16x32_bf16 v[60:63], v[224:227], v[100:103], v[60:63]
    s_waitcnt lgkmcnt(4)
    v_mfma_f32_16x16x32_bf16 v[64:67], v[228:231], v[96:99], v[64:67]
    v_mfma_f32_16x16x32_bf16 v[68:71], v[228:231], v[100:103], v[68:71]
    s_waitcnt lgkmcnt(2)
    v_mfma_f32_16x16x32_bf16 v[72:75], v[232:235], v[96:99], v[72:75]
    v_mfma_f32_16x16x32_bf16 v[76:79], v[232:235], v[100:103], v[76:79]
    s_waitcnt lgkmcnt(0)
    v_mfma_f32_16x16x32_bf16 v[80:83], v[236:239], v[96:99], v[80:83]
    v_mfma_f32_16x16x32_bf16 v[84:87], v[236:239], v[100:103], v[84:87]
    s_barrier
    s_add_u32 s22, s21, 0x8000
    s_add_u32 m0, s20, 0x20000
    s_nop 0
    buffer_load_dwordx4 v2, s[8:11], s22 offen sc1 lds
    s_add_u32 s22, s21, 0x8400
    s_add_u32 m0, s20, 0x20400
    s_nop 0
    buffer_load_dwordx4 v2, s[8:11], s22 offen sc1 lds
    s_add_u32 s22, s21, 0xc000
    s_add_u32 m0, s20, 0x24000
    s_nop 0
    buffer_load_dwordx4 v2, s[8:11], s22 offen sc1 lds
    s_add_u32 s22, s21, 0xc400
    s_add_u32 m0, s20, 0x24400
    s_nop 0
    buffer_load_dwordx4 v2, s[8:11], s22 offen sc1 lds
    ds_read_b64_tr_b16 v[88:89], v11 offset:0
    ds_read_b64_tr_b16 v[90:91], v11 offset:1024
    ds_read_b64_tr_b16 v[92:93], v11 offset:8192
    ds_read_b64_tr_b16 v[94:95], v11 offset:9216
    ds_read_b64_tr_b16 v[96:97], v11 offset:16384
    ds_read_b64_tr_b16 v[98:99], v11 offset:17408
    ds_read_b64_tr_b16 v[100:101], v11 offset:24576
    ds_read_b64_tr_b16 v[102:103], v11 offset:25600
    s_mov_b32 s23, 0x3e0293ee
    v_mul_f32 v24, s23, v24
    v_mul_f32 v25, s23, v25
    v_mul_f32 v26, s23, v26
    v_mul_f32 v27, s23, v27
    v_mul_f32 v28, s23, v28
    v_mul_f32 v29, s23, v29
    v_mul_f32 v30, s23, v30
    v_mul_f32 v31, s23, v31
    v_mul_f32 v32, s23, v32
    v_mul_f32 v33, s23, v33
    v_mul_f32 v34, s23, v34
    v_mul_f32 v35, s23, v35
    v_mul_f32 v36, s23, v36
    v_mul_f32 v37, s23, v37
    v_mul_f32 v38, s23, v38
    v_mul_f32 v39, s23, v39
    v_cvt_pk_bf16_f32 v152, v24, v25
    v_cvt_pk_bf16_f32 v153, v26, v27
    v_cvt_pk_bf16_f32 v168, v28, v29
    v_cvt_pk_bf16_f32 v169, v30, v31
    v_cvt_pk_bf16_f32 v154, v32, v33
    v_cvt_pk_bf16_f32 v155, v34, v35
    v_cvt_pk_bf16_f32 v170, v36, v37
    v_cvt_pk_bf16_f32 v171, v38, v39
    s_waitcnt lgkmcnt(6)
    v_mfma_f32_16x16x32_bf16 v[104:107], v[88:91], v[136:139], 0
    s_waitcnt lgkmcnt(4)
    v_mfma_f32_16x16x32_bf16 v[104:107], v[92:95], v[140:143], v[104:107]
    s_waitcnt lgkmcnt(2)
    v_mfma_f32_16x16x32_bf16 v[104:107], v[96:99], v[144:147], v[104:107]
    s_waitcnt lgkmcnt(0)
    v_mfma_f32_16x16x32_bf16 v[104:107], v[100:103], v[148:151], v[104:107]
    v_add_u32 v4, 0x10000, v2
    v_add_u32 v5, 0x20000, v2
    s_barrier
    ds_read_b128 v[224:227], v4 offset:32768
    ds_read_b128 v[228:231], v4 offset:33792
    ds_read_b128 v[232:235], v4 offset:34816
    ds_read_b128 v[236:239], v4 offset:35840
    v_mov_b32 v12, 0x3f803f80
    v_mov_b32 v13, 0x3f803f80
    v_mov_b32 v14, 0x3f803f80
    v_mov_b32 v15, 0x3f803f80
    s_waitcnt lgkmcnt(3)
    v_mfma_f32_16x16x32_bf16 v[184:187], v[224:227], v[152:155], 0
    v_mul_f32 v40, s23, v40
    v_mul_f32 v41, s23, v41
    v_mul_f32 v42, s23, v42
    v_mul_f32 v43, s23, v43
    v_mul_f32 v44, s23, v44
    v_mul_f32 v45, s23, v45
    v_lshrrev_b32 v20, 4, v1
    v_lshlrev_b32 v20, 4, v20
    s_lshr_b32 s16, s2, 5
    s_lshl_b32 s16, s16, 14
    s_and_b32 s17, s2, 31
    s_lshl_b32 s17, s17, 9
    s_add_u32 s16, s16, s17
    s_lshl_b32 s17, s3, 6
    s_add_u32 s16, s16, s17
    s_add_u32 s16, s16, 0x580000
    s_mov_b32 exec_lo, 0x10001
    s_mov_b32 exec_hi, 0x10001
    buffer_store_dwordx4 v[104:107], v20, s[8:11], s16 offen sc1
    s_mov_b64 exec, -1
    v_mfma_f32_16x16x32_bf16 v[188:191], v[224:227], v[168:171], 0
    ds_read_b128 v[240:243], v4 offset:36864
    v_mul_f32 v46, s23, v46
    v_mul_f32 v47, s23, v47
    v_mul_f32 v48, s23, v48
    v_mul_f32 v49, s23, v49
    v_mul_f32 v50, s23, v50
    v_mul_f32 v51, s23, v51
    s_and_b32 s29, s2, 7
    s_mul_i32 s29, s29, 28
    s_lshr_b32 s16, s2, 3
    s_add_u32 s29, s29, s16
    s_waitcnt lgkmcnt(3)
    v_mfma_f32_16x16x32_bf16 v[192:195], v[228:231], v[152:155], 0
    s_add_u32 s22, s21, 0x10000
    s_add_u32 m0, s20, 0x10000
    s_nop 0
    buffer_load_dwordx4 v2, s[8:11], s22 offen sc1 lds
    v_mul_f32 v52, s23, v52
    v_mul_f32 v53, s23, v53
    v_mul_f32 v54, s23, v54
    v_mul_f32 v55, s23, v55
    v_cvt_pk_bf16_f32 v156, v40, v41
    v_cvt_pk_bf16_f32 v157, v42, v43
    v_mfma_f32_16x16x32_bf16 v[196:199], v[228:231], v[168:171], 0
    ds_read_b128 v[244:247], v4 offset:37888
    v_cvt_pk_bf16_f32 v172, v44, v45
    v_cvt_pk_bf16_f32 v173, v46, v47
    v_cvt_pk_bf16_f32 v158, v48, v49
    v_cvt_pk_bf16_f32 v159, v50, v51
    v_cvt_pk_bf16_f32 v174, v52, v53
    v_cvt_pk_bf16_f32 v175, v54, v55
    s_waitcnt lgkmcnt(3)
    v_mfma_f32_16x16x32_bf16 v[184:187], v[232:235], v[156:159], v[184:187]
    v_mul_f32 v56, s23, v56
    v_mul_f32 v57, s23, v57
    v_mul_f32 v58, s23, v58
    v_mul_f32 v59, s23, v59
    v_mul_f32 v60, s23, v60
    v_mul_f32 v61, s23, v61
    v_mfma_f32_16x16x32_bf16 v[188:191], v[232:235], v[172:175], v[188:191]
    ds_read_b128 v[224:227], v4 offset:38912
    v_mul_f32 v62, s23, v62
    v_mul_f32 v63, s23, v63
    v_mul_f32 v64, s23, v64
    v_mul_f32 v65, s23, v65
    v_mul_f32 v66, s23, v66
    v_mul_f32 v67, s23, v67
    s_waitcnt lgkmcnt(3)
    v_mfma_f32_16x16x32_bf16 v[192:195], v[236:239], v[156:159], v[192:195]
    v_mul_f32 v68, s23, v68
    v_mul_f32 v69, s23, v69
    v_mul_f32 v70, s23, v70
    v_mul_f32 v71, s23, v71
    v_cvt_pk_bf16_f32 v160, v56, v57
    v_cvt_pk_bf16_f32 v161, v58, v59
    v_mfma_f32_16x16x32_bf16 v[196:199], v[236:239], v[172:175], v[196:199]
    ds_read_b128 v[228:231], v4 offset:39936
    v_cvt_pk_bf16_f32 v176, v60, v61
    v_cvt_pk_bf16_f32 v177, v62, v63
    v_cvt_pk_bf16_f32 v162, v64, v65
    v_cvt_pk_bf16_f32 v163, v66, v67
    v_cvt_pk_bf16_f32 v178, v68, v69
    v_cvt_pk_bf16_f32 v179, v70, v71
    s_waitcnt lgkmcnt(3)
    v_mfma_f32_16x16x32_bf16 v[184:187], v[240:243], v[160:163], v[184:187]
    v_mul_f32 v72, s23, v72
    v_mul_f32 v73, s23, v73
    v_mul_f32 v74, s23, v74
    v_mul_f32 v75, s23, v75
    v_mul_f32 v76, s23, v76
    v_mul_f32 v77, s23, v77
    v_mfma_f32_16x16x32_bf16 v[188:191], v[240:243], v[176:179], v[188:191]
    ds_read_b128 v[232:235], v4 offset:40960
    v_mul_f32 v78, s23, v78
    v_mul_f32 v79, s23, v79
    v_mul_f32 v80, s23, v80
    v_mul_f32 v81, s23, v81
    v_mul_f32 v82, s23, v82
    v_mul_f32 v83, s23, v83
    s_waitcnt lgkmcnt(3)
    v_mfma_f32_16x16x32_bf16 v[192:195], v[244:247], v[160:163], v[192:195]
    s_add_u32 s22, s21, 0x10400
    s_add_u32 m0, s20, 0x10400
    s_nop 0
    buffer_load_dwordx4 v2, s[8:11], s22 offen sc1 lds
    v_mul_f32 v84, s23, v84
    v_mul_f32 v85, s23, v85
    v_mul_f32 v86, s23, v86
    v_mul_f32 v87, s23, v87
    v_cvt_pk_bf16_f32 v164, v72, v73
    v_cvt_pk_bf16_f32 v165, v74, v75
    v_mfma_f32_16x16x32_bf16 v[196:199], v[244:247], v[176:179], v[196:199]
    ds_read_b128 v[236:239], v4 offset:41984
    v_cvt_pk_bf16_f32 v180, v76, v77
    v_cvt_pk_bf16_f32 v181, v78, v79
    v_cvt_pk_bf16_f32 v166, v80, v81
    v_cvt_pk_bf16_f32 v167, v82, v83
    v_cvt_pk_bf16_f32 v182, v84, v85
    v_cvt_pk_bf16_f32 v183, v86, v87
    s_waitcnt lgkmcnt(3)
    v_mfma_f32_16x16x32_bf16 v[184:187], v[224:227], v[164:167], v[184:187]
    v_mfma_f32_16x16x32_bf16 v[188:191], v[224:227], v[180:183], v[188:191]
    ds_read_b128 v[240:243], v4 offset:43008
    s_waitcnt lgkmcnt(3)
    v_mfma_f32_16x16x32_bf16 v[192:195], v[228:231], v[164:167], v[192:195]
    v_mfma_f32_16x16x32_bf16 v[196:199], v[228:231], v[180:183], v[196:199]
    ds_read_b128 v[244:247], v4 offset:44032
    s_waitcnt lgkmcnt(3)
    v_mfma_f32_16x16x32_bf16 v[200:203], v[232:235], v[152:155], 0
    v_mfma_f32_16x16x32_bf16 v[204:207], v[232:235], v[168:171], 0
    ds_read_b128 v[224:227], v4 offset:45056
    s_waitcnt lgkmcnt(3)
    v_mfma_f32_16x16x32_bf16 v[208:211], v[236:239], v[152:155], 0
    v_mfma_f32_16x16x32_bf16 v[212:215], v[236:239], v[168:171], 0
    ds_read_b128 v[228:231], v4 offset:46080
    s_waitcnt lgkmcnt(3)
    v_mfma_f32_16x16x32_bf16 v[200:203], v[240:243], v[156:159], v[200:203]
    v_mfma_f32_16x16x32_bf16 v[204:207], v[240:243], v[172:175], v[204:207]
    ds_read_b128 v[232:235], v4 offset:47104
    s_waitcnt lgkmcnt(3)
    v_mfma_f32_16x16x32_bf16 v[208:211], v[244:247], v[156:159], v[208:211]
    v_max3_f32 v16, v184, v185, v186
    v_mfma_f32_16x16x32_bf16 v[212:215], v[244:247], v[172:175], v[212:215]
    ds_read_b128 v[236:239], v4 offset:48128
    v_max3_f32 v16, v16, v187, v192
    s_waitcnt lgkmcnt(3)
    v_mfma_f32_16x16x32_bf16 v[200:203], v[224:227], v[160:163], v[200:203]
    v_max3_f32 v16, v16, v193, v194
    v_mfma_f32_16x16x32_bf16 v[204:207], v[224:227], v[176:179], v[204:207]
    s_barrier
    ds_read_b128 v[240:243], v4 offset:49152
    v_max_f32 v16, v16, v195
    s_waitcnt lgkmcnt(3)
    v_mfma_f32_16x16x32_bf16 v[208:211], v[228:231], v[160:163], v[208:211]
    v_max3_f32 v17, v188, v189, v190
    v_mfma_f32_16x16x32_bf16 v[212:215], v[228:231], v[176:179], v[212:215]
    s_add_u32 s22, s21, 0x14000
    s_add_u32 m0, s20, 0x14000
    s_nop 0
    buffer_load_dwordx4 v2, s[8:11], s22 offen sc1 lds
    ds_read_b128 v[244:247], v4 offset:50176
    v_max3_f32 v17, v17, v191, v196
    s_waitcnt lgkmcnt(3)
    v_mfma_f32_16x16x32_bf16 v[200:203], v[232:235], v[164:167], v[200:203]
    v_max3_f32 v17, v17, v197, v198
    v_mfma_f32_16x16x32_bf16 v[204:207], v[232:235], v[180:183], v[204:207]
    ds_read_b128 v[224:227], v4 offset:51200
    v_max_f32 v17, v17, v199
    s_waitcnt lgkmcnt(3)
    v_mfma_f32_16x16x32_bf16 v[208:211], v[236:239], v[164:167], v[208:211]
    v_mfma_f32_16x16x32_bf16 v[212:215], v[236:239], v[180:183], v[212:215]
    ds_read_b128 v[228:231], v4 offset:52224
    v_max3_f32 v16, v16, v200, v201
    v_max3_f32 v16, v16, v202, v203
    s_nop 3
    v_max3_f32 v16, v16, v208, v209
    v_max3_f32 v16, v16, v210, v211
    v_max3_f32 v17, v17, v204, v205
    v_max3_f32 v17, v17, v206, v207
    v_max3_f32 v17, v17, v212, v213
    v_max3_f32 v17, v17, v214, v215
    v_mov_b32 v18, v16
    v_mov_b32 v19, v17
    s_nop 0
    v_permlane16_swap_b32 v16, v18
    v_permlane16_swap_b32 v17, v19
    v_max_f32 v16, v16, v18
    v_max_f32 v17, v17, v19
    v_mov_b32 v18, v16
    v_mov_b32 v19, v17
    s_nop 0
    v_permlane32_swap_b32 v16, v18
    v_permlane32_swap_b32 v17, v19
    v_max_f32 v16, v16, v18
    v_max_f32 v17, v17, v19
    v_sub_f32 v216, 0, v16
    v_sub_f32 v217, 0, v16
    v_sub_f32 v218, 0, v16
    v_sub_f32 v219, 0, v16
    v_sub_f32 v220, 0, v17
    v_sub_f32 v221, 0, v17
    v_sub_f32 v222, 0, v17
    v_sub_f32 v223, 0, v17
    v_add_f32 v184, v184, v216
    v_add_f32 v185, v185, v216
    v_exp_f32 v184, v184
    v_exp_f32 v185, v185
    s_nop 0
    v_cvt_pk_bf16_f32 v24, v184, v185
    v_add_f32 v186, v186, v216
    v_add_f32 v187, v187, v216
    v_exp_f32 v186, v186
    v_exp_f32 v187, v187
    s_nop 0
    v_cvt_pk_bf16_f32 v25, v186, v187
    v_add_f32 v188, v188, v220
    v_add_f32 v189, v189, v220
    v_exp_f32 v188, v188
    v_exp_f32 v189, v189
    s_nop 0
    v_cvt_pk_bf16_f32 v28, v188, v189
    v_add_f32 v190, v190, v220
    v_add_f32 v191, v191, v220
    v_exp_f32 v190, v190
    v_exp_f32 v191, v191
    s_nop 0
    v_cvt_pk_bf16_f32 v29, v190, v191
    v_add_f32 v192, v192, v216
    v_add_f32 v193, v193, v216
    v_exp_f32 v192, v192
    v_exp_f32 v193, v193
    s_nop 0
    v_cvt_pk_bf16_f32 v26, v192, v193
    v_add_f32 v194, v194, v216
    v_add_f32 v195, v195, v216
    v_exp_f32 v194, v194
    v_exp_f32 v195, v195
    s_nop 0
    v_cvt_pk_bf16_f32 v27, v194, v195
    v_add_f32 v196, v196, v220
    v_add_f32 v197, v197, v220
    v_exp_f32 v196, v196
    v_exp_f32 v197, v197
    s_nop 0
    v_cvt_pk_bf16_f32 v30, v196, v197
    v_add_f32 v198, v198, v220
    v_add_f32 v199, v199, v220
    v_exp_f32 v198, v198
    v_exp_f32 v199, v199
    s_nop 0
    v_cvt_pk_bf16_f32 v31, v198, v199
    s_waitcnt lgkmcnt(3)
    v_mfma_f32_16x16x32_bf16 v[184:187], v[240:243], v[152:155], v[216:219]
    v_mfma_f32_16x16x32_bf16 v[188:191], v[240:243], v[168:171], v[220:223]
    ds_read_b128 v[232:235], v4 offset:53248
    v_add_f32 v200, v200, v216
    v_add_f32 v201, v201, v216
    v_exp_f32 v200, v200
    v_mfma_f32_16x16x32_bf16 v[248:251], v[12:15], v[24:27], 0
    s_waitcnt lgkmcnt(3)
    v_mfma_f32_16x16x32_bf16 v[192:195], v[244:247], v[152:155], v[216:219]
    v_exp_f32 v201, v201
    s_nop 0
    v_cvt_pk_bf16_f32 v32, v200, v201
    v_add_f32 v202, v202, v216
    v_mfma_f32_16x16x32_bf16 v[196:199], v[244:247], v[168:171], v[220:223]
    s_add_u32 s22, s21, 0x14400
    s_add_u32 m0, s20, 0x14400
    s_nop 0
    buffer_load_dwordx4 v2, s[8:11], s22 offen sc1 lds
    ds_read_b128 v[236:239], v4 offset:54272
    v_add_f32 v203, v203, v216
    v_exp_f32 v202, v202
    v_mfma_f32_16x16x32_bf16 v[252:255], v[12:15], v[28:31], 0
    s_waitcnt lgkmcnt(3)
    v_mfma_f32_16x16x32_bf16 v[184:187], v[224:227], v[156:159], v[184:187]
    v_exp_f32 v203, v203
    s_nop 0
    v_cvt_pk_bf16_f32 v33, v202, v203
    v_add_f32 v204, v204, v220
    v_mfma_f32_16x16x32_bf16 v[188:191], v[224:227], v[172:175], v[188:191]
    ds_read_b128 v[240:243], v4 offset:55296
    v_add_f32 v205, v205, v220
    v_exp_f32 v204, v204
    v_exp_f32 v205, v205
    s_mov_b64 s[4:5], s[40:41]
    s_mov_b32 s6, 0x800000
    s_mov_b32 s7, 0x20000
    v_bfe_u32 v20, v1, 2, 2
    v_lshlrev_b32 v21, 13, v20
    v_sub_u32 v3, v3, v21
    v_lshl_add_u32 v3, v20, 11, v3
    s_and_b32 s16, s2, 1
    s_lshl_b32 s24, s16, 22
    s_lshr_b32 s16, s2, 5
    s_lshl_b32 s16, s16, 8
    s_add_u32 s24, s24, s16
    s_lshl_b32 s16, s3, 14
    s_add_u32 s24, s24, s16
    s_waitcnt lgkmcnt(3)
    v_mfma_f32_16x16x32_bf16 v[192:195], v[228:231], v[156:159], v[192:195]
    v_cvt_pk_bf16_f32 v36, v204, v205
    v_add_f32 v206, v206, v220
    v_mfma_f32_16x16x32_bf16 v[196:199], v[228:231], v[172:175], v[196:199]
    ds_read_b128 v[244:247], v4 offset:56320
    v_add_f32 v207, v207, v220
    v_exp_f32 v206, v206
    v_exp_f32 v207, v207
    s_waitcnt lgkmcnt(3)
    v_mfma_f32_16x16x32_bf16 v[184:187], v[232:235], v[160:163], v[184:187]
    v_cvt_pk_bf16_f32 v37, v206, v207
    v_add_f32 v208, v208, v216
    v_add_f32 v209, v209, v216
    v_mfma_f32_16x16x32_bf16 v[188:191], v[232:235], v[176:179], v[188:191]
    ds_read_b128 v[224:227], v4 offset:57344
    v_exp_f32 v208, v208
    v_exp_f32 v209, v209
    s_waitcnt lgkmcnt(3)
    v_mfma_f32_16x16x32_bf16 v[192:195], v[236:239], v[160:163], v[192:195]
    v_cvt_pk_bf16_f32 v34, v208, v209
    v_add_f32 v210, v210, v216
    v_add_f32 v211, v211, v216
    v_mfma_f32_16x16x32_bf16 v[196:199], v[236:239], v[176:179], v[196:199]
    ds_read_b128 v[228:231], v4 offset:58368
    v_exp_f32 v210, v210
    v_exp_f32 v211, v211
    s_nop 0
    v_cvt_pk_bf16_f32 v35, v210, v211
    s_waitcnt lgkmcnt(3)
    v_mfma_f32_16x16x32_bf16 v[184:187], v[240:243], v[164:167], v[184:187]
    v_add_f32 v212, v212, v220
    v_add_f32 v213, v213, v220
    v_mfma_f32_16x16x32_bf16 v[188:191], v[240:243], v[180:183], v[188:191]
    ds_read_b128 v[232:235], v4 offset:59392
    v_exp_f32 v212, v212
    v_exp_f32 v213, v213
    s_nop 0
    v_cvt_pk_bf16_f32 v38, v212, v213
    s_waitcnt lgkmcnt(3)
    v_mfma_f32_16x16x32_bf16 v[192:195], v[244:247], v[164:167], v[192:195]
    v_add_f32 v214, v214, v220
    v_add_f32 v215, v215, v220
    v_exp_f32 v214, v214
    v_mfma_f32_16x16x32_bf16 v[196:199], v[244:247], v[180:183], v[196:199]
    ds_read_b128 v[236:239], v4 offset:60416
    v_exp_f32 v215, v215
    s_nop 0
    v_cvt_pk_bf16_f32 v39, v214, v215
    s_waitcnt lgkmcnt(3)
    v_mfma_f32_16x16x32_bf16 v[200:203], v[224:227], v[152:155], v[216:219]
    v_mfma_f32_16x16x32_bf16 v[204:207], v[224:227], v[168:171], v[220:223]
    ds_read_b128 v[240:243], v4 offset:61440
    v_exp_f32 v184, v184
    v_exp_f32 v185, v185
    v_mfma_f32_16x16x32_bf16 v[248:251], v[12:15], v[32:35], v[248:251]
    s_waitcnt lgkmcnt(3)
    v_mfma_f32_16x16x32_bf16 v[208:211], v[228:231], v[152:155], v[216:219]
    v_cvt_pk_bf16_f32 v40, v184, v185
    v_exp_f32 v186, v186
    v_mfma_f32_16x16x32_bf16 v[212:215], v[228:231], v[168:171], v[220:223]
    ds_read_b128 v[244:247], v4 offset:62464
    v_exp_f32 v187, v187
    v_mfma_f32_16x16x32_bf16 v[252:255], v[12:15], v[36:39], v[252:255]
    s_waitcnt lgkmcnt(3)
    v_mfma_f32_16x16x32_bf16 v[200:203], v[232:235], v[156:159], v[200:203]
    v_cvt_pk_bf16_f32 v41, v186, v187
    v_exp_f32 v188, v188
    v_mfma_f32_16x16x32_bf16 v[204:207], v[232:235], v[172:175], v[204:207]
    ds_read_b128 v[224:227], v4 offset:63488
    v_exp_f32 v189, v189
    s_waitcnt lgkmcnt(3)
    v_mfma_f32_16x16x32_bf16 v[208:211], v[236:239], v[156:159], v[208:211]
    v_cvt_pk_bf16_f32 v44, v188, v189
    v_exp_f32 v190, v190
    v_mfma_f32_16x16x32_bf16 v[212:215], v[236:239], v[172:175], v[212:215]
    ds_read_b128 v[228:231], v4 offset:64512
    v_exp_f32 v191, v191
    s_nop 0
    v_cvt_pk_bf16_f32 v45, v190, v191
    s_waitcnt lgkmcnt(3)
    v_mfma_f32_16x16x32_bf16 v[200:203], v[240:243], v[160:163], v[200:203]
    v_exp_f32 v192, v192
    v_mfma_f32_16x16x32_bf16 v[204:207], v[240:243], v[176:179], v[204:207]
    s_waitcnt vmcnt(7)
    s_barrier
    ds_read_b128 v[232:235], v5 offset:0
    v_exp_f32 v193, v193
    s_nop 0
    v_cvt_pk_bf16_f32 v42, v192, v193
    s_waitcnt lgkmcnt(3)
    v_mfma_f32_16x16x32_bf16 v[208:211], v[244:247], v[160:163], v[208:211]
    v_exp_f32 v194, v194
    v_mfma_f32_16x16x32_bf16 v[212:215], v[244:247], v[176:179], v[212:215]
    s_add_u32 s22, s21, 0x18000
    s_add_u32 m0, s20, 0x18000
    s_nop 0
    buffer_load_dwordx4 v2, s[8:11], s22 offen sc1 lds
    ds_read_b128 v[236:239], v5 offset:1024
    v_exp_f32 v195, v195
    s_nop 0
    v_cvt_pk_bf16_f32 v43, v194, v195
    s_waitcnt lgkmcnt(3)
    v_mfma_f32_16x16x32_bf16 v[200:203], v[224:227], v[164:167], v[200:203]
    v_exp_f32 v196, v196
    v_exp_f32 v197, v197
    v_mfma_f32_16x16x32_bf16 v[204:207], v[224:227], v[180:183], v[204:207]
    ds_read_b128 v[240:243], v5 offset:2048
    v_cvt_pk_bf16_f32 v46, v196, v197
    s_waitcnt lgkmcnt(3)
    v_mfma_f32_16x16x32_bf16 v[208:211], v[228:231], v[164:167], v[208:211]
    v_exp_f32 v198, v198
    v_exp_f32 v199, v199
    v_mfma_f32_16x16x32_bf16 v[212:215], v[228:231], v[180:183], v[212:215]
    ds_read_b128 v[244:247], v5 offset:3072
    v_cvt_pk_bf16_f32 v47, v198, v199
    s_waitcnt lgkmcnt(3)
    v_mfma_f32_16x16x32_bf16 v[184:187], v[232:235], v[152:155], v[216:219]
    v_mfma_f32_16x16x32_bf16 v[188:191], v[232:235], v[168:171], v[220:223]
    ds_read_b128 v[224:227], v5 offset:4096
    v_exp_f32 v200, v200
    v_exp_f32 v201, v201
    v_mfma_f32_16x16x32_bf16 v[248:251], v[12:15], v[40:43], v[248:251]
    s_waitcnt lgkmcnt(3)
    v_mfma_f32_16x16x32_bf16 v[192:195], v[236:239], v[152:155], v[216:219]
    v_cvt_pk_bf16_f32 v48, v200, v201
    v_exp_f32 v202, v202
    v_mfma_f32_16x16x32_bf16 v[196:199], v[236:239], v[168:171], v[220:223]
    s_add_u32 s22, s21, 0x18400
    s_add_u32 m0, s20, 0x18400
    s_nop 0
    buffer_load_dwordx4 v2, s[8:11], s22 offen sc1 lds
    ds_read_b128 v[228:231], v5 offset:5120
    v_exp_f32 v203, v203
    v_mfma_f32_16x16x32_bf16 v[252:255], v[12:15], v[44:47], v[252:255]
    s_waitcnt lgkmcnt(3)
    v_mfma_f32_16x16x32_bf16 v[184:187], v[240:243], v[156:159], v[184:187]
    v_cvt_pk_bf16_f32 v49, v202, v203
    v_exp_f32 v204, v204
    v_mfma_f32_16x16x32_bf16 v[188:191], v[240:243], v[172:175], v[188:191]
    ds_read_b128 v[232:235], v5 offset:6144
    v_exp_f32 v205, v205
    s_waitcnt lgkmcnt(3)
    v_mfma_f32_16x16x32_bf16 v[192:195], v[244:247], v[156:159], v[192:195]
    v_cvt_pk_bf16_f32 v52, v204, v205
    v_exp_f32 v206, v206
    v_mfma_f32_16x16x32_bf16 v[196:199], v[244:247], v[172:175], v[196:199]
    ds_read_b128 v[236:239], v5 offset:7168
    v_exp_f32 v207, v207
    s_nop 0
    v_cvt_pk_bf16_f32 v53, v206, v207
    s_waitcnt lgkmcnt(3)
    v_mfma_f32_16x16x32_bf16 v[184:187], v[224:227], v[160:163], v[184:187]
    v_exp_f32 v208, v208
    v_mfma_f32_16x16x32_bf16 v[188:191], v[224:227], v[176:179], v[188:191]
    ds_read_b128 v[240:243], v5 offset:8192
    v_exp_f32 v209, v209
    s_nop 0
    v_cvt_pk_bf16_f32 v50, v208, v209
    s_waitcnt lgkmcnt(3)
    v_mfma_f32_16x16x32_bf16 v[192:195], v[228:231], v[160:163], v[192:195]
    v_exp_f32 v210, v210
    v_mfma_f32_16x16x32_bf16 v[196:199], v[228:231], v[176:179], v[196:199]
    ds_read_b128 v[244:247], v5 offset:9216
    v_exp_f32 v211, v211
    s_nop 0
    v_cvt_pk_bf16_f32 v51, v210, v211
    s_waitcnt lgkmcnt(3)
    v_mfma_f32_16x16x32_bf16 v[184:187], v[232:235], v[164:167], v[184:187]
    v_exp_f32 v212, v212
    v_exp_f32 v213, v213
    v_mfma_f32_16x16x32_bf16 v[188:191], v[232:235], v[180:183], v[188:191]
    ds_read_b128 v[224:227], v5 offset:10240
    v_cvt_pk_bf16_f32 v54, v212, v213
    s_waitcnt lgkmcnt(3)
    v_mfma_f32_16x16x32_bf16 v[192:195], v[236:239], v[164:167], v[192:195]
    v_exp_f32 v214, v214
    v_exp_f32 v215, v215
    v_mfma_f32_16x16x32_bf16 v[196:199], v[236:239], v[180:183], v[196:199]
    ds_read_b128 v[228:231], v5 offset:11264
    v_cvt_pk_bf16_f32 v55, v214, v215
    s_waitcnt lgkmcnt(3)
    v_mfma_f32_16x16x32_bf16 v[200:203], v[240:243], v[152:155], v[216:219]
    v_mfma_f32_16x16x32_bf16 v[204:207], v[240:243], v[168:171], v[220:223]
    ds_read_b128 v[232:235], v5 offset:12288
    v_exp_f32 v184, v184
    v_exp_f32 v185, v185
    v_mfma_f32_16x16x32_bf16 v[248:251], v[12:15], v[48:51], v[248:251]
    s_waitcnt lgkmcnt(3)
    v_mfma_f32_16x16x32_bf16 v[208:211], v[244:247], v[152:155], v[216:219]
    v_cvt_pk_bf16_f32 v56, v184, v185
    v_exp_f32 v186, v186
    v_mfma_f32_16x16x32_bf16 v[212:215], v[244:247], v[168:171], v[220:223]
    ds_read_b128 v[236:239], v5 offset:13312
    v_exp_f32 v187, v187
    v_mfma_f32_16x16x32_bf16 v[252:255], v[12:15], v[52:55], v[252:255]
    s_waitcnt lgkmcnt(3)
    v_mfma_f32_16x16x32_bf16 v[200:203], v[224:227], v[156:159], v[200:203]
    v_cvt_pk_bf16_f32 v57, v186, v187
    v_exp_f32 v188, v188
    v_mfma_f32_16x16x32_bf16 v[204:207], v[224:227], v[172:175], v[204:207]
    ds_read_b128 v[240:243], v5 offset:14336
    v_exp_f32 v189, v189
    s_waitcnt lgkmcnt(3)
    v_mfma_f32_16x16x32_bf16 v[208:211], v[228:231], v[156:159], v[208:211]
    v_cvt_pk_bf16_f32 v60, v188, v189
    v_exp_f32 v190, v190
    s_waitcnt vmcnt(6)
    v_mfma_f32_16x16x32_bf16 v[212:215], v[228:231], v[172:175], v[212:215]
    ds_read_b128 v[244:247], v5 offset:15360
    v_exp_f32 v191, v191
    s_nop 0
    v_cvt_pk_bf16_f32 v61, v190, v191
    s_waitcnt lgkmcnt(3)
    v_mfma_f32_16x16x32_bf16 v[200:203], v[232:235], v[160:163], v[200:203]
    v_exp_f32 v192, v192
    v_mfma_f32_16x16x32_bf16 v[204:207], v[232:235], v[176:179], v[204:207]
    s_barrier
    ds_read_b128 v[224:227], v5 offset:16384
    v_exp_f32 v193, v193
    s_nop 0
    v_cvt_pk_bf16_f32 v58, v192, v193
    s_waitcnt lgkmcnt(3)
    v_mfma_f32_16x16x32_bf16 v[208:211], v[236:239], v[160:163], v[208:211]
    v_exp_f32 v194, v194
    v_mfma_f32_16x16x32_bf16 v[212:215], v[236:239], v[176:179], v[212:215]
    s_add_u32 s22, s21, 0x1c000
    s_add_u32 m0, s20, 0x1c000
    s_nop 0
    buffer_load_dwordx4 v2, s[8:11], s22 offen sc1 lds
    ds_read_b128 v[228:231], v5 offset:17408
    v_exp_f32 v195, v195
    s_nop 0
    v_cvt_pk_bf16_f32 v59, v194, v195
    s_waitcnt lgkmcnt(3)
    v_mfma_f32_16x16x32_bf16 v[200:203], v[240:243], v[164:167], v[200:203]
    v_exp_f32 v196, v196
    v_exp_f32 v197, v197
    v_mfma_f32_16x16x32_bf16 v[204:207], v[240:243], v[180:183], v[204:207]
    ds_read_b128 v[232:235], v5 offset:18432
    v_cvt_pk_bf16_f32 v62, v196, v197
    s_waitcnt lgkmcnt(3)
    v_mfma_f32_16x16x32_bf16 v[208:211], v[244:247], v[164:167], v[208:211]
    v_exp_f32 v198, v198
    v_exp_f32 v199, v199
    v_mov_b32 v20, s28
    v_mov_b32 v21, 0
    s_lshl_b32 s16, s2, 2
    s_add_u32 s16, s16, 0x560000
    s_cmp_eq_u32 s3, 0
    s_cselect_b32 s16, s16, 0x7ffffff0
    s_mov_b64 exec, 1
    buffer_store_dword v20, v21, s[8:11], s16 offen sc1
    s_mov_b64 exec, -1
    v_mfma_f32_16x16x32_bf16 v[212:215], v[244:247], v[180:183], v[212:215]
    ds_read_b128 v[236:239], v5 offset:19456
    v_cvt_pk_bf16_f32 v63, v198, v199
    s_waitcnt lgkmcnt(3)
    v_mfma_f32_16x16x32_bf16 v[184:187], v[224:227], v[152:155], v[216:219]
    v_mfma_f32_16x16x32_bf16 v[188:191], v[224:227], v[168:171], v[220:223]
    ds_read_b128 v[240:243], v5 offset:20480
    v_exp_f32 v200, v200
    v_exp_f32 v201, v201
    v_mfma_f32_16x16x32_bf16 v[248:251], v[12:15], v[56:59], v[248:251]
    s_waitcnt lgkmcnt(3)
    v_mfma_f32_16x16x32_bf16 v[192:195], v[228:231], v[152:155], v[216:219]
    v_cvt_pk_bf16_f32 v64, v200, v201
    v_exp_f32 v202, v202
    v_mfma_f32_16x16x32_bf16 v[196:199], v[228:231], v[168:171], v[220:223]
    s_add_u32 s22, s21, 0x1c400
    s_add_u32 m0, s20, 0x1c400
    s_nop 0
    buffer_load_dwordx4 v2, s[8:11], s22 offen sc1 lds
    ds_read_b128 v[244:247], v5 offset:21504
    v_exp_f32 v203, v203
    v_mfma_f32_16x16x32_bf16 v[252:255], v[12:15], v[60:63], v[252:255]
    s_waitcnt lgkmcnt(3)
    v_mfma_f32_16x16x32_bf16 v[184:187], v[232:235], v[156:159], v[184:187]
    v_cvt_pk_bf16_f32 v65, v202, v203
    v_exp_f32 v204, v204
    v_mfma_f32_16x16x32_bf16 v[188:191], v[232:235], v[172:175], v[188:191]
    ds_read_b128 v[224:227], v5 offset:22528
    v_exp_f32 v205, v205
    s_waitcnt lgkmcnt(3)
    v_mfma_f32_16x16x32_bf16 v[192:195], v[236:239], v[156:159], v[192:195]
    v_cvt_pk_bf16_f32 v68, v204, v205
    v_exp_f32 v206, v206
    v_mfma_f32_16x16x32_bf16 v[196:199], v[236:239], v[172:175], v[196:199]
    ds_read_b128 v[228:231], v5 offset:23552
    v_exp_f32 v207, v207
    s_nop 0
    v_cvt_pk_bf16_f32 v69, v206, v207
    s_waitcnt lgkmcnt(3)
    v_mfma_f32_16x16x32_bf16 v[184:187], v[240:243], v[160:163], v[184:187]
    v_exp_f32 v208, v208
    v_mfma_f32_16x16x32_bf16 v[188:191], v[240:243], v[176:179], v[188:191]
    ds_read_b128 v[232:235], v5 offset:24576
    v_exp_f32 v209, v209
    s_nop 0
    v_cvt_pk_bf16_f32 v66, v208, v209
    s_waitcnt lgkmcnt(3)
    v_mfma_f32_16x16x32_bf16 v[192:195], v[244:247], v[160:163], v[192:195]
    v_exp_f32 v210, v210
    v_mfma_f32_16x16x32_bf16 v[196:199], v[244:247], v[176:179], v[196:199]
    ds_read_b128 v[236:239], v5 offset:25600
    v_exp_f32 v211, v211
    s_nop 0
    v_cvt_pk_bf16_f32 v67, v210, v211
    s_waitcnt lgkmcnt(3)
    v_mfma_f32_16x16x32_bf16 v[184:187], v[224:227], v[164:167], v[184:187]
    v_exp_f32 v212, v212
    v_exp_f32 v213, v213
    v_mfma_f32_16x16x32_bf16 v[188:191], v[224:227], v[180:183], v[188:191]
    ds_read_b128 v[240:243], v5 offset:26624
    v_cvt_pk_bf16_f32 v70, v212, v213
    s_waitcnt lgkmcnt(3)
    v_mfma_f32_16x16x32_bf16 v[192:195], v[228:231], v[164:167], v[192:195]
    v_exp_f32 v214, v214
    v_exp_f32 v215, v215
    v_mfma_f32_16x16x32_bf16 v[196:199], v[228:231], v[180:183], v[196:199]
    ds_read_b128 v[244:247], v5 offset:27648
    v_cvt_pk_bf16_f32 v71, v214, v215
    s_waitcnt lgkmcnt(3)
    v_mfma_f32_16x16x32_bf16 v[200:203], v[232:235], v[152:155], v[216:219]
    v_mfma_f32_16x16x32_bf16 v[204:207], v[232:235], v[168:171], v[220:223]
    ds_read_b128 v[224:227], v5 offset:28672
    v_exp_f32 v184, v184
    v_exp_f32 v185, v185
    v_mfma_f32_16x16x32_bf16 v[248:251], v[12:15], v[64:67], v[248:251]
    s_waitcnt lgkmcnt(3)
    v_mfma_f32_16x16x32_bf16 v[208:211], v[236:239], v[152:155], v[216:219]
    v_cvt_pk_bf16_f32 v72, v184, v185
    v_exp_f32 v186, v186
    v_mfma_f32_16x16x32_bf16 v[212:215], v[236:239], v[168:171], v[220:223]
    ds_read_b128 v[228:231], v5 offset:29696
    v_exp_f32 v187, v187
    v_mfma_f32_16x16x32_bf16 v[252:255], v[12:15], v[68:71], v[252:255]
    s_waitcnt lgkmcnt(3)
    v_mfma_f32_16x16x32_bf16 v[200:203], v[240:243], v[156:159], v[200:203]
    v_cvt_pk_bf16_f32 v73, v186, v187
    v_exp_f32 v188, v188
    v_mfma_f32_16x16x32_bf16 v[204:207], v[240:243], v[172:175], v[204:207]
    ds_read_b128 v[232:235], v5 offset:30720
    v_exp_f32 v189, v189
    s_waitcnt lgkmcnt(3)
    v_mfma_f32_16x16x32_bf16 v[208:211], v[244:247], v[156:159], v[208:211]
    v_cvt_pk_bf16_f32 v76, v188, v189
    v_exp_f32 v190, v190
    v_mfma_f32_16x16x32_bf16 v[212:215], v[244:247], v[172:175], v[212:215]
    ds_read_b128 v[236:239], v5 offset:31744
    v_exp_f32 v191, v191
    s_nop 0
    v_cvt_pk_bf16_f32 v77, v190, v191
    s_waitcnt lgkmcnt(3)
    v_mfma_f32_16x16x32_bf16 v[200:203], v[224:227], v[160:163], v[200:203]
    v_exp_f32 v192, v192
    v_mfma_f32_16x16x32_bf16 v[204:207], v[224:227], v[176:179], v[204:207]
    s_waitcnt vmcnt(7)
    s_barrier
    ds_read_b128 v[240:243], v4 offset:0
    v_exp_f32 v193, v193
    s_nop 0
    v_cvt_pk_bf16_f32 v74, v192, v193
    s_waitcnt lgkmcnt(3)
    v_mfma_f32_16x16x32_bf16 v[208:211], v[228:231], v[160:163], v[208:211]
    v_exp_f32 v194, v194
    v_mfma_f32_16x16x32_bf16 v[212:215], v[228:231], v[176:179], v[212:215]
    s_add_u32 s22, s21, 0x80000
    s_add_u32 m0, s20, 0x20000
    s_nop 0
    buffer_load_dwordx4 v2, s[8:11], s22 offen sc1 lds
    ds_read_b128 v[244:247], v4 offset:1024
    v_exp_f32 v195, v195
    s_nop 0
    v_cvt_pk_bf16_f32 v75, v194, v195
    s_waitcnt lgkmcnt(3)
    v_mfma_f32_16x16x32_bf16 v[200:203], v[232:235], v[164:167], v[200:203]
    v_exp_f32 v196, v196
    v_exp_f32 v197, v197
    v_mfma_f32_16x16x32_bf16 v[204:207], v[232:235], v[180:183], v[204:207]
    ds_read_b128 v[224:227], v4 offset:2048
    v_cvt_pk_bf16_f32 v78, v196, v197
    s_waitcnt lgkmcnt(3)
    v_mfma_f32_16x16x32_bf16 v[208:211], v[236:239], v[164:167], v[208:211]
    v_exp_f32 v198, v198
    v_exp_f32 v199, v199
    v_mfma_f32_16x16x32_bf16 v[212:215], v[236:239], v[180:183], v[212:215]
    ds_read_b128 v[228:231], v4 offset:3072
    v_cvt_pk_bf16_f32 v79, v198, v199
    s_waitcnt lgkmcnt(3)
    v_mfma_f32_16x16x32_bf16 v[184:187], v[240:243], v[152:155], v[216:219]
    v_mfma_f32_16x16x32_bf16 v[188:191], v[240:243], v[168:171], v[220:223]
    ds_read_b128 v[232:235], v4 offset:4096
    v_exp_f32 v200, v200
    v_exp_f32 v201, v201
    v_mfma_f32_16x16x32_bf16 v[248:251], v[12:15], v[72:75], v[248:251]
    s_waitcnt lgkmcnt(3)
    v_mfma_f32_16x16x32_bf16 v[192:195], v[244:247], v[152:155], v[216:219]
    v_cvt_pk_bf16_f32 v80, v200, v201
    v_exp_f32 v202, v202
    v_mfma_f32_16x16x32_bf16 v[196:199], v[244:247], v[168:171], v[220:223]
    s_add_u32 s22, s21, 0x80400
    s_add_u32 m0, s20, 0x20400
    s_nop 0
    buffer_load_dwordx4 v2, s[8:11], s22 offen sc1 lds
    ds_read_b128 v[236:239], v4 offset:5120
    v_exp_f32 v203, v203
    v_mfma_f32_16x16x32_bf16 v[252:255], v[12:15], v[76:79], v[252:255]
    s_waitcnt lgkmcnt(3)
    v_mfma_f32_16x16x32_bf16 v[184:187], v[224:227], v[156:159], v[184:187]
    v_cvt_pk_bf16_f32 v81, v202, v203
    v_exp_f32 v204, v204
    v_mfma_f32_16x16x32_bf16 v[188:191], v[224:227], v[172:175], v[188:191]
    ds_read_b128 v[240:243], v4 offset:6144
    v_exp_f32 v205, v205
    s_waitcnt lgkmcnt(3)
    v_mfma_f32_16x16x32_bf16 v[192:195], v[228:231], v[156:159], v[192:195]
    v_cvt_pk_bf16_f32 v84, v204, v205
    v_exp_f32 v206, v206
    v_mfma_f32_16x16x32_bf16 v[196:199], v[228:231], v[172:175], v[196:199]
    ds_read_b128 v[244:247], v4 offset:7168
    v_exp_f32 v207, v207
    s_nop 0
    v_cvt_pk_bf16_f32 v85, v206, v207
    s_waitcnt lgkmcnt(3)
    v_mfma_f32_16x16x32_bf16 v[184:187], v[232:235], v[160:163], v[184:187]
    v_exp_f32 v208, v208
    v_mfma_f32_16x16x32_bf16 v[188:191], v[232:235], v[176:179], v[188:191]
    ds_read_b128 v[224:227], v4 offset:8192
    v_exp_f32 v209, v209
    s_nop 0
    v_cvt_pk_bf16_f32 v82, v208, v209
    s_waitcnt lgkmcnt(3)
    v_mfma_f32_16x16x32_bf16 v[192:195], v[236:239], v[160:163], v[192:195]
    v_exp_f32 v210, v210
    v_mfma_f32_16x16x32_bf16 v[196:199], v[236:239], v[176:179], v[196:199]
    ds_read_b128 v[228:231], v4 offset:9216
    v_exp_f32 v211, v211
    s_nop 0
    v_cvt_pk_bf16_f32 v83, v210, v211
    s_waitcnt lgkmcnt(3)
    v_mfma_f32_16x16x32_bf16 v[184:187], v[240:243], v[164:167], v[184:187]
    v_exp_f32 v212, v212
    v_exp_f32 v213, v213
    v_mfma_f32_16x16x32_bf16 v[188:191], v[240:243], v[180:183], v[188:191]
    ds_read_b128 v[232:235], v4 offset:10240
    v_cvt_pk_bf16_f32 v86, v212, v213
    s_waitcnt lgkmcnt(3)
    v_mfma_f32_16x16x32_bf16 v[192:195], v[244:247], v[164:167], v[192:195]
    v_exp_f32 v214, v214
    v_exp_f32 v215, v215
    v_mfma_f32_16x16x32_bf16 v[196:199], v[244:247], v[180:183], v[196:199]
    ds_read_b128 v[236:239], v4 offset:11264
    v_cvt_pk_bf16_f32 v87, v214, v215
    s_waitcnt lgkmcnt(3)
    v_mfma_f32_16x16x32_bf16 v[200:203], v[224:227], v[152:155], v[216:219]
    v_mfma_f32_16x16x32_bf16 v[204:207], v[224:227], v[168:171], v[220:223]
    ds_read_b128 v[240:243], v4 offset:12288
    v_exp_f32 v184, v184
    v_exp_f32 v185, v185
    v_mfma_f32_16x16x32_bf16 v[248:251], v[12:15], v[80:83], v[248:251]
    s_waitcnt lgkmcnt(3)
    v_mfma_f32_16x16x32_bf16 v[208:211], v[228:231], v[152:155], v[216:219]
    v_cvt_pk_bf16_f32 v88, v184, v185
    v_exp_f32 v186, v186
    v_mfma_f32_16x16x32_bf16 v[212:215], v[228:231], v[168:171], v[220:223]
    ds_read_b128 v[244:247], v4 offset:13312
    v_exp_f32 v187, v187
    v_mfma_f32_16x16x32_bf16 v[252:255], v[12:15], v[84:87], v[252:255]
    s_waitcnt lgkmcnt(3)
    v_mfma_f32_16x16x32_bf16 v[200:203], v[232:235], v[156:159], v[200:203]
    v_cvt_pk_bf16_f32 v89, v186, v187
    v_exp_f32 v188, v188
    v_mfma_f32_16x16x32_bf16 v[204:207], v[232:235], v[172:175], v[204:207]
    ds_read_b128 v[224:227], v4 offset:14336
    v_exp_f32 v189, v189
    s_waitcnt lgkmcnt(3)
    v_mfma_f32_16x16x32_bf16 v[208:211], v[236:239], v[156:159], v[208:211]
    v_cvt_pk_bf16_f32 v92, v188, v189
    v_exp_f32 v190, v190
    v_mfma_f32_16x16x32_bf16 v[212:215], v[236:239], v[172:175], v[212:215]
    ds_read_b128 v[228:231], v4 offset:15360
    v_exp_f32 v191, v191
    s_nop 0
    v_cvt_pk_bf16_f32 v93, v190, v191
    s_waitcnt lgkmcnt(3)
    v_mfma_f32_16x16x32_bf16 v[200:203], v[240:243], v[160:163], v[200:203]
    v_exp_f32 v192, v192
    v_mfma_f32_16x16x32_bf16 v[204:207], v[240:243], v[176:179], v[204:207]
    s_waitcnt vmcnt(7)
    s_barrier
    ds_read_b128 v[232:235], v4 offset:16384
    v_exp_f32 v193, v193
    s_nop 0
    v_cvt_pk_bf16_f32 v90, v192, v193
    s_waitcnt lgkmcnt(3)
    v_mfma_f32_16x16x32_bf16 v[208:211], v[244:247], v[160:163], v[208:211]
    v_exp_f32 v194, v194
    v_mfma_f32_16x16x32_bf16 v[212:215], v[244:247], v[176:179], v[212:215]
    s_add_u32 s22, s21, 0x84000
    s_add_u32 m0, s20, 0x24000
    s_nop 0
    buffer_load_dwordx4 v2, s[8:11], s22 offen sc1 lds
    ds_read_b128 v[236:239], v4 offset:17408
    v_exp_f32 v195, v195
    s_nop 0
    v_cvt_pk_bf16_f32 v91, v194, v195
    s_waitcnt lgkmcnt(3)
    v_mfma_f32_16x16x32_bf16 v[200:203], v[224:227], v[164:167], v[200:203]
    v_exp_f32 v196, v196
    v_exp_f32 v197, v197
    v_mfma_f32_16x16x32_bf16 v[204:207], v[224:227], v[180:183], v[204:207]
    ds_read_b128 v[240:243], v4 offset:18432
    v_cvt_pk_bf16_f32 v94, v196, v197
    s_waitcnt lgkmcnt(3)
    v_mfma_f32_16x16x32_bf16 v[208:211], v[228:231], v[164:167], v[208:211]
    v_exp_f32 v198, v198
    v_exp_f32 v199, v199
    v_mfma_f32_16x16x32_bf16 v[212:215], v[228:231], v[180:183], v[212:215]
    ds_read_b128 v[244:247], v4 offset:19456
    v_cvt_pk_bf16_f32 v95, v198, v199
    s_waitcnt lgkmcnt(3)
    v_mfma_f32_16x16x32_bf16 v[184:187], v[232:235], v[152:155], v[216:219]
    v_mfma_f32_16x16x32_bf16 v[188:191], v[232:235], v[168:171], v[220:223]
    ds_read_b128 v[224:227], v4 offset:20480
    v_exp_f32 v200, v200
    v_exp_f32 v201, v201
    v_mfma_f32_16x16x32_bf16 v[248:251], v[12:15], v[88:91], v[248:251]
    s_waitcnt lgkmcnt(3)
    v_mfma_f32_16x16x32_bf16 v[192:195], v[236:239], v[152:155], v[216:219]
    v_cvt_pk_bf16_f32 v96, v200, v201
    v_exp_f32 v202, v202
    v_mfma_f32_16x16x32_bf16 v[196:199], v[236:239], v[168:171], v[220:223]
    s_add_u32 s22, s21, 0x84400
    s_add_u32 m0, s20, 0x24400
    s_nop 0
    buffer_load_dwordx4 v2, s[8:11], s22 offen sc1 lds
    ds_read_b128 v[228:231], v4 offset:21504
    v_exp_f32 v203, v203
    v_mfma_f32_16x16x32_bf16 v[252:255], v[12:15], v[92:95], v[252:255]
    s_waitcnt lgkmcnt(3)
    v_mfma_f32_16x16x32_bf16 v[184:187], v[240:243], v[156:159], v[184:187]
    v_cvt_pk_bf16_f32 v97, v202, v203
    v_exp_f32 v204, v204
    v_mfma_f32_16x16x32_bf16 v[188:191], v[240:243], v[172:175], v[188:191]
    ds_read_b128 v[232:235], v4 offset:22528
    v_exp_f32 v205, v205
    s_waitcnt lgkmcnt(3)
    v_mfma_f32_16x16x32_bf16 v[192:195], v[244:247], v[156:159], v[192:195]
    v_cvt_pk_bf16_f32 v100, v204, v205
    v_exp_f32 v206, v206
    v_mfma_f32_16x16x32_bf16 v[196:199], v[244:247], v[172:175], v[196:199]
    ds_read_b128 v[236:239], v4 offset:23552
    v_exp_f32 v207, v207
    s_nop 0
    v_cvt_pk_bf16_f32 v101, v206, v207
    s_waitcnt lgkmcnt(3)
    v_mfma_f32_16x16x32_bf16 v[184:187], v[224:227], v[160:163], v[184:187]
    v_exp_f32 v208, v208
    v_mfma_f32_16x16x32_bf16 v[188:191], v[224:227], v[176:179], v[188:191]
    ds_read_b128 v[240:243], v4 offset:24576
    v_exp_f32 v209, v209
    s_nop 0
    v_cvt_pk_bf16_f32 v98, v208, v209
    s_waitcnt lgkmcnt(3)
    v_mfma_f32_16x16x32_bf16 v[192:195], v[228:231], v[160:163], v[192:195]
    v_exp_f32 v210, v210
    v_mfma_f32_16x16x32_bf16 v[196:199], v[228:231], v[176:179], v[196:199]
    ds_read_b128 v[244:247], v4 offset:25600
    v_exp_f32 v211, v211
    s_nop 0
    v_cvt_pk_bf16_f32 v99, v210, v211
    s_waitcnt lgkmcnt(3)
    v_mfma_f32_16x16x32_bf16 v[184:187], v[232:235], v[164:167], v[184:187]
    v_exp_f32 v212, v212
    v_exp_f32 v213, v213
    v_mfma_f32_16x16x32_bf16 v[188:191], v[232:235], v[180:183], v[188:191]
    ds_read_b128 v[224:227], v4 offset:26624
    v_cvt_pk_bf16_f32 v102, v212, v213
    s_waitcnt lgkmcnt(3)
    v_mfma_f32_16x16x32_bf16 v[192:195], v[236:239], v[164:167], v[192:195]
    v_exp_f32 v214, v214
    v_exp_f32 v215, v215
    v_mfma_f32_16x16x32_bf16 v[196:199], v[236:239], v[180:183], v[196:199]
    ds_read_b128 v[228:231], v4 offset:27648
    v_cvt_pk_bf16_f32 v103, v214, v215
    s_waitcnt lgkmcnt(3)
    v_mfma_f32_16x16x32_bf16 v[200:203], v[240:243], v[152:155], v[216:219]
    v_mfma_f32_16x16x32_bf16 v[204:207], v[240:243], v[168:171], v[220:223]
    ds_read_b128 v[232:235], v4 offset:28672
    v_exp_f32 v184, v184
    v_exp_f32 v185, v185
    v_mfma_f32_16x16x32_bf16 v[248:251], v[12:15], v[96:99], v[248:251]
    s_waitcnt lgkmcnt(3)
    v_mfma_f32_16x16x32_bf16 v[208:211], v[244:247], v[152:155], v[216:219]
    v_cvt_pk_bf16_f32 v104, v184, v185
    v_exp_f32 v186, v186
    v_mfma_f32_16x16x32_bf16 v[212:215], v[244:247], v[168:171], v[220:223]
    ds_read_b128 v[236:239], v4 offset:29696
    v_exp_f32 v187, v187
    v_mfma_f32_16x16x32_bf16 v[252:255], v[12:15], v[100:103], v[252:255]
    s_waitcnt lgkmcnt(3)
    v_mfma_f32_16x16x32_bf16 v[200:203], v[224:227], v[156:159], v[200:203]
    v_cvt_pk_bf16_f32 v105, v186, v187
    v_exp_f32 v188, v188
    v_mfma_f32_16x16x32_bf16 v[204:207], v[224:227], v[172:175], v[204:207]
    ds_read_b128 v[240:243], v4 offset:30720
    v_exp_f32 v189, v189
    s_waitcnt lgkmcnt(3)
    v_mfma_f32_16x16x32_bf16 v[208:211], v[228:231], v[156:159], v[208:211]
    v_cvt_pk_bf16_f32 v108, v188, v189
    v_exp_f32 v190, v190
    v_mfma_f32_16x16x32_bf16 v[212:215], v[228:231], v[172:175], v[212:215]
    ds_read_b128 v[244:247], v4 offset:31744
    v_exp_f32 v191, v191
    s_nop 0
    v_cvt_pk_bf16_f32 v109, v190, v191
    s_waitcnt lgkmcnt(3)
    v_mfma_f32_16x16x32_bf16 v[200:203], v[232:235], v[160:163], v[200:203]
    v_exp_f32 v192, v192
    v_mfma_f32_16x16x32_bf16 v[204:207], v[232:235], v[176:179], v[204:207]
    s_waitcnt vmcnt(7)
    s_barrier
    ds_read_b128 v[224:227], v4 offset:32768
    v_exp_f32 v193, v193
    s_nop 0
    v_cvt_pk_bf16_f32 v106, v192, v193
    s_waitcnt lgkmcnt(3)
    v_mfma_f32_16x16x32_bf16 v[208:211], v[236:239], v[160:163], v[208:211]
    v_exp_f32 v194, v194
    v_mfma_f32_16x16x32_bf16 v[212:215], v[236:239], v[176:179], v[212:215]
    s_add_u32 s22, s21, 0x88000
    s_add_u32 m0, s20, 0x10000
    s_nop 0
    buffer_load_dwordx4 v2, s[8:11], s22 offen sc1 lds
    ds_read_b128 v[228:231], v4 offset:33792
    v_exp_f32 v195, v195
    s_nop 0
    v_cvt_pk_bf16_f32 v107, v194, v195
    s_waitcnt lgkmcnt(3)
    v_mfma_f32_16x16x32_bf16 v[200:203], v[240:243], v[164:167], v[200:203]
    v_exp_f32 v196, v196
    v_exp_f32 v197, v197
    v_mfma_f32_16x16x32_bf16 v[204:207], v[240:243], v[180:183], v[204:207]
    ds_read_b128 v[232:235], v4 offset:34816
    v_cvt_pk_bf16_f32 v110, v196, v197
    s_waitcnt lgkmcnt(3)
    v_mfma_f32_16x16x32_bf16 v[208:211], v[244:247], v[164:167], v[208:211]
    v_exp_f32 v198, v198
    v_exp_f32 v199, v199
    v_mfma_f32_16x16x32_bf16 v[212:215], v[244:247], v[180:183], v[212:215]
    ds_read_b128 v[236:239], v4 offset:35840
    v_cvt_pk_bf16_f32 v111, v198, v199
    s_waitcnt lgkmcnt(3)
    v_mfma_f32_16x16x32_bf16 v[184:187], v[224:227], v[152:155], v[216:219]
    v_mfma_f32_16x16x32_bf16 v[188:191], v[224:227], v[168:171], v[220:223]
    ds_read_b128 v[240:243], v4 offset:36864
    v_exp_f32 v200, v200
    v_exp_f32 v201, v201
    v_mfma_f32_16x16x32_bf16 v[248:251], v[12:15], v[104:107], v[248:251]
    s_waitcnt lgkmcnt(3)
    v_mfma_f32_16x16x32_bf16 v[192:195], v[228:231], v[152:155], v[216:219]
    v_cvt_pk_bf16_f32 v112, v200, v201
    v_exp_f32 v202, v202
    v_mfma_f32_16x16x32_bf16 v[196:199], v[228:231], v[168:171], v[220:223]
    s_add_u32 s22, s21, 0x88400
    s_add_u32 m0, s20, 0x10400
    s_nop 0
    buffer_load_dwordx4 v2, s[8:11], s22 offen sc1 lds
    ds_read_b128 v[244:247], v4 offset:37888
    v_exp_f32 v203, v203
    v_mfma_f32_16x16x32_bf16 v[252:255], v[12:15], v[108:111], v[252:255]
    s_waitcnt lgkmcnt(3)
    v_mfma_f32_16x16x32_bf16 v[184:187], v[232:235], v[156:159], v[184:187]
    v_cvt_pk_bf16_f32 v113, v202, v203
    v_exp_f32 v204, v204
    v_mfma_f32_16x16x32_bf16 v[188:191], v[232:235], v[172:175], v[188:191]
    ds_read_b128 v[224:227], v4 offset:38912
    v_exp_f32 v205, v205
    s_waitcnt lgkmcnt(3)
    v_mfma_f32_16x16x32_bf16 v[192:195], v[236:239], v[156:159], v[192:195]
    v_cvt_pk_bf16_f32 v116, v204, v205
    v_exp_f32 v206, v206
    v_mfma_f32_16x16x32_bf16 v[196:199], v[236:239], v[172:175], v[196:199]
    ds_read_b128 v[228:231], v4 offset:39936
    v_exp_f32 v207, v207
    s_nop 0
    v_cvt_pk_bf16_f32 v117, v206, v207
    s_waitcnt lgkmcnt(3)
    v_mfma_f32_16x16x32_bf16 v[184:187], v[240:243], v[160:163], v[184:187]
    v_exp_f32 v208, v208
    v_mfma_f32_16x16x32_bf16 v[188:191], v[240:243], v[176:179], v[188:191]
    ds_read_b128 v[232:235], v4 offset:40960
    v_exp_f32 v209, v209
    s_nop 0
    v_cvt_pk_bf16_f32 v114, v208, v209
    s_waitcnt lgkmcnt(3)
    v_mfma_f32_16x16x32_bf16 v[192:195], v[244:247], v[160:163], v[192:195]
    v_exp_f32 v210, v210
    v_mfma_f32_16x16x32_bf16 v[196:199], v[244:247], v[176:179], v[196:199]
    ds_read_b128 v[236:239], v4 offset:41984
    v_exp_f32 v211, v211
    s_nop 0
    v_cvt_pk_bf16_f32 v115, v210, v211
    s_waitcnt lgkmcnt(3)
    v_mfma_f32_16x16x32_bf16 v[184:187], v[224:227], v[164:167], v[184:187]
    v_exp_f32 v212, v212
    v_exp_f32 v213, v213
    v_mfma_f32_16x16x32_bf16 v[188:191], v[224:227], v[180:183], v[188:191]
    ds_read_b128 v[240:243], v4 offset:43008
    v_cvt_pk_bf16_f32 v118, v212, v213
    s_waitcnt lgkmcnt(3)
    v_mfma_f32_16x16x32_bf16 v[192:195], v[228:231], v[164:167], v[192:195]
    v_exp_f32 v214, v214
    v_exp_f32 v215, v215
    v_mfma_f32_16x16x32_bf16 v[196:199], v[228:231], v[180:183], v[196:199]
    ds_read_b128 v[244:247], v4 offset:44032
    v_cvt_pk_bf16_f32 v119, v214, v215
    s_waitcnt lgkmcnt(3)
    v_mfma_f32_16x16x32_bf16 v[200:203], v[232:235], v[152:155], v[216:219]
    v_mfma_f32_16x16x32_bf16 v[204:207], v[232:235], v[168:171], v[220:223]
    ds_read_b128 v[224:227], v4 offset:45056
    v_exp_f32 v184, v184
    v_exp_f32 v185, v185
    v_mfma_f32_16x16x32_bf16 v[248:251], v[12:15], v[112:115], v[248:251]
    s_waitcnt lgkmcnt(3)
    v_mfma_f32_16x16x32_bf16 v[208:211], v[236:239], v[152:155], v[216:219]
    v_cvt_pk_bf16_f32 v120, v184, v185
    v_exp_f32 v186, v186
    v_mfma_f32_16x16x32_bf16 v[212:215], v[236:239], v[168:171], v[220:223]
    ds_read_b128 v[228:231], v4 offset:46080
    v_exp_f32 v187, v187
    v_mfma_f32_16x16x32_bf16 v[252:255], v[12:15], v[116:119], v[252:255]
    s_waitcnt lgkmcnt(3)
    v_mfma_f32_16x16x32_bf16 v[200:203], v[240:243], v[156:159], v[200:203]
    v_cvt_pk_bf16_f32 v121, v186, v187
    v_exp_f32 v188, v188
    v_mfma_f32_16x16x32_bf16 v[204:207], v[240:243], v[172:175], v[204:207]
    ds_read_b128 v[232:235], v4 offset:47104
    v_exp_f32 v189, v189
    s_waitcnt lgkmcnt(3)
    v_mfma_f32_16x16x32_bf16 v[208:211], v[244:247], v[156:159], v[208:211]
    v_cvt_pk_bf16_f32 v124, v188, v189
    v_exp_f32 v190, v190
    v_mfma_f32_16x16x32_bf16 v[212:215], v[244:247], v[172:175], v[212:215]
    ds_read_b128 v[236:239], v4 offset:48128
    v_exp_f32 v191, v191
    s_nop 0
    v_cvt_pk_bf16_f32 v125, v190, v191
    s_waitcnt lgkmcnt(3)
    v_mfma_f32_16x16x32_bf16 v[200:203], v[224:227], v[160:163], v[200:203]
    v_exp_f32 v192, v192
    v_mfma_f32_16x16x32_bf16 v[204:207], v[224:227], v[176:179], v[204:207]
    s_waitcnt vmcnt(6)
    s_barrier
    ds_read_b128 v[240:243], v4 offset:49152
    v_exp_f32 v193, v193
    s_nop 0
    v_cvt_pk_bf16_f32 v122, v192, v193
    s_waitcnt lgkmcnt(3)
    v_mfma_f32_16x16x32_bf16 v[208:211], v[228:231], v[160:163], v[208:211]
    v_exp_f32 v194, v194
    v_mfma_f32_16x16x32_bf16 v[212:215], v[228:231], v[176:179], v[212:215]
    s_add_u32 s22, s21, 0x8c000
    s_add_u32 m0, s20, 0x14000
    s_nop 0
    buffer_load_dwordx4 v2, s[8:11], s22 offen sc1 lds
    ds_read_b128 v[244:247], v4 offset:50176
    v_exp_f32 v195, v195
    s_nop 0
    v_cvt_pk_bf16_f32 v123, v194, v195
    s_waitcnt lgkmcnt(3)
    v_mfma_f32_16x16x32_bf16 v[200:203], v[232:235], v[164:167], v[200:203]
    v_exp_f32 v196, v196
    v_exp_f32 v197, v197
    v_mfma_f32_16x16x32_bf16 v[204:207], v[232:235], v[180:183], v[204:207]
    ds_read_b128 v[224:227], v4 offset:51200
    v_cvt_pk_bf16_f32 v126, v196, v197
    s_waitcnt lgkmcnt(3)
    v_mfma_f32_16x16x32_bf16 v[208:211], v[236:239], v[164:167], v[208:211]
    v_exp_f32 v198, v198
    v_exp_f32 v199, v199
    v_mfma_f32_16x16x32_bf16 v[212:215], v[236:239], v[180:183], v[212:215]
    ds_read_b128 v[228:231], v4 offset:52224
    v_cvt_pk_bf16_f32 v127, v198, v199
    s_waitcnt lgkmcnt(3)
    v_mfma_f32_16x16x32_bf16 v[184:187], v[240:243], v[152:155], v[216:219]
    v_mfma_f32_16x16x32_bf16 v[188:191], v[240:243], v[168:171], v[220:223]
    ds_read_b128 v[232:235], v4 offset:53248
    v_exp_f32 v200, v200
    v_exp_f32 v201, v201
    v_mfma_f32_16x16x32_bf16 v[248:251], v[12:15], v[120:123], v[248:251]
    s_waitcnt lgkmcnt(3)
    v_mfma_f32_16x16x32_bf16 v[192:195], v[244:247], v[152:155], v[216:219]
    v_cvt_pk_bf16_f32 v128, v200, v201
    v_exp_f32 v202, v202
    v_mfma_f32_16x16x32_bf16 v[196:199], v[244:247], v[168:171], v[220:223]
    s_add_u32 s22, s21, 0x8c400
    s_add_u32 m0, s20, 0x14400
    s_nop 0
    buffer_load_dwordx4 v2, s[8:11], s22 offen sc1 lds
    ds_read_b128 v[236:239], v4 offset:54272
    v_exp_f32 v203, v203
    v_mfma_f32_16x16x32_bf16 v[252:255], v[12:15], v[124:127], v[252:255]
    s_waitcnt lgkmcnt(3)
    v_mfma_f32_16x16x32_bf16 v[184:187], v[224:227], v[156:159], v[184:187]
    v_cvt_pk_bf16_f32 v129, v202, v203
    v_exp_f32 v204, v204
    v_mfma_f32_16x16x32_bf16 v[188:191], v[224:227], v[172:175], v[188:191]
    ds_read_b128 v[240:243], v4 offset:55296
    v_exp_f32 v205, v205
    s_waitcnt lgkmcnt(3)
    v_mfma_f32_16x16x32_bf16 v[192:195], v[228:231], v[156:159], v[192:195]
    v_cvt_pk_bf16_f32 v132, v204, v205
    v_exp_f32 v206, v206
    v_mfma_f32_16x16x32_bf16 v[196:199], v[228:231], v[172:175], v[196:199]
    ds_read_b128 v[244:247], v4 offset:56320
    v_exp_f32 v207, v207
    s_nop 0
    v_cvt_pk_bf16_f32 v133, v206, v207
    s_waitcnt lgkmcnt(3)
    v_mfma_f32_16x16x32_bf16 v[184:187], v[232:235], v[160:163], v[184:187]
    v_exp_f32 v208, v208
    v_mfma_f32_16x16x32_bf16 v[188:191], v[232:235], v[176:179], v[188:191]
    ds_read_b128 v[224:227], v4 offset:57344
    v_exp_f32 v209, v209
    s_nop 0
    v_cvt_pk_bf16_f32 v130, v208, v209
    s_waitcnt lgkmcnt(3)
    v_mfma_f32_16x16x32_bf16 v[192:195], v[236:239], v[160:163], v[192:195]
    v_exp_f32 v210, v210
    v_mfma_f32_16x16x32_bf16 v[196:199], v[236:239], v[176:179], v[196:199]
    ds_read_b128 v[228:231], v4 offset:58368
    v_exp_f32 v211, v211
    s_nop 0
    v_cvt_pk_bf16_f32 v131, v210, v211
    s_waitcnt lgkmcnt(3)
    v_mfma_f32_16x16x32_bf16 v[184:187], v[240:243], v[164:167], v[184:187]
    v_exp_f32 v212, v212
    v_exp_f32 v213, v213
    v_mfma_f32_16x16x32_bf16 v[188:191], v[240:243], v[180:183], v[188:191]
    ds_read_b128 v[232:235], v4 offset:59392
    v_cvt_pk_bf16_f32 v134, v212, v213
    s_waitcnt lgkmcnt(3)
    v_mfma_f32_16x16x32_bf16 v[192:195], v[244:247], v[164:167], v[192:195]
    v_exp_f32 v214, v214
    v_exp_f32 v215, v215
    v_mfma_f32_16x16x32_bf16 v[196:199], v[244:247], v[180:183], v[196:199]
    ds_read_b128 v[236:239], v4 offset:60416
    v_cvt_pk_bf16_f32 v135, v214, v215
    s_waitcnt lgkmcnt(3)
    v_mfma_f32_16x16x32_bf16 v[200:203], v[224:227], v[152:155], v[216:219]
    v_mfma_f32_16x16x32_bf16 v[204:207], v[224:227], v[168:171], v[220:223]
    ds_read_b128 v[240:243], v4 offset:61440
    v_exp_f32 v184, v184
    v_exp_f32 v185, v185
    v_mfma_f32_16x16x32_bf16 v[248:251], v[12:15], v[128:131], v[248:251]
    s_waitcnt lgkmcnt(3)
    v_mfma_f32_16x16x32_bf16 v[208:211], v[228:231], v[152:155], v[216:219]
    v_cvt_pk_bf16_f32 v136, v184, v185
    v_exp_f32 v186, v186
    v_mfma_f32_16x16x32_bf16 v[212:215], v[228:231], v[168:171], v[220:223]
    ds_read_b128 v[244:247], v4 offset:62464
    v_exp_f32 v187, v187
    v_mfma_f32_16x16x32_bf16 v[252:255], v[12:15], v[132:135], v[252:255]
    s_waitcnt lgkmcnt(3)
    v_mfma_f32_16x16x32_bf16 v[200:203], v[232:235], v[156:159], v[200:203]
    v_cvt_pk_bf16_f32 v137, v186, v187
    v_exp_f32 v188, v188
    v_mfma_f32_16x16x32_bf16 v[204:207], v[232:235], v[172:175], v[204:207]
    ds_read_b128 v[224:227], v4 offset:63488
    v_exp_f32 v189, v189
    s_waitcnt lgkmcnt(3)
    v_mfma_f32_16x16x32_bf16 v[208:211], v[236:239], v[156:159], v[208:211]
    v_cvt_pk_bf16_f32 v140, v188, v189
    v_exp_f32 v190, v190
    v_mfma_f32_16x16x32_bf16 v[212:215], v[236:239], v[172:175], v[212:215]
    ds_read_b128 v[228:231], v4 offset:64512
    v_exp_f32 v191, v191
    s_nop 0
    v_cvt_pk_bf16_f32 v141, v190, v191
    s_waitcnt lgkmcnt(3)
    v_mfma_f32_16x16x32_bf16 v[200:203], v[240:243], v[160:163], v[200:203]
    v_exp_f32 v192, v192
    v_mfma_f32_16x16x32_bf16 v[204:207], v[240:243], v[176:179], v[204:207]
    v_exp_f32 v193, v193
    s_nop 0
    v_cvt_pk_bf16_f32 v138, v192, v193
    s_waitcnt lgkmcnt(2)
    v_mfma_f32_16x16x32_bf16 v[208:211], v[244:247], v[160:163], v[208:211]
    v_exp_f32 v194, v194
    v_mfma_f32_16x16x32_bf16 v[212:215], v[244:247], v[176:179], v[212:215]
    v_exp_f32 v195, v195
    s_nop 0
    v_cvt_pk_bf16_f32 v139, v194, v195
    s_waitcnt lgkmcnt(1)
    v_mfma_f32_16x16x32_bf16 v[200:203], v[224:227], v[164:167], v[200:203]
    v_exp_f32 v196, v196
    v_exp_f32 v197, v197
    v_mfma_f32_16x16x32_bf16 v[204:207], v[224:227], v[180:183], v[204:207]
    v_cvt_pk_bf16_f32 v142, v196, v197
    s_waitcnt lgkmcnt(0)
    v_mfma_f32_16x16x32_bf16 v[208:211], v[228:231], v[164:167], v[208:211]
    v_exp_f32 v198, v198
    v_exp_f32 v199, v199
    v_mfma_f32_16x16x32_bf16 v[212:215], v[228:231], v[180:183], v[212:215]
    v_cvt_pk_bf16_f32 v143, v198, v199
    s_waitcnt vmcnt(6)
    s_barrier
    ds_read_b128 v[232:235], v5 offset:0
    ds_read_b128 v[236:239], v5 offset:1024
    ds_read_b128 v[240:243], v5 offset:2048
    ds_read_b128 v[244:247], v5 offset:3072
    v_mfma_f32_16x16x32_bf16 v[248:251], v[12:15], v[136:139], v[248:251]
    v_mfma_f32_16x16x32_bf16 v[252:255], v[12:15], v[140:143], v[252:255]
    v_exp_f32 v200, v200
    v_exp_f32 v201, v201
    s_nop 0
    v_cvt_pk_bf16_f32 v144, v200, v201
    v_exp_f32 v202, v202
    v_exp_f32 v203, v203
    s_nop 0
    v_cvt_pk_bf16_f32 v145, v202, v203
    v_exp_f32 v204, v204
    v_exp_f32 v205, v205
    s_nop 0
    v_cvt_pk_bf16_f32 v148, v204, v205
    v_exp_f32 v206, v206
    v_exp_f32 v207, v207
    s_nop 0
    v_cvt_pk_bf16_f32 v149, v206, v207
    v_exp_f32 v208, v208
    v_exp_f32 v209, v209
    s_nop 0
    v_cvt_pk_bf16_f32 v146, v208, v209
    v_exp_f32 v210, v210
    v_exp_f32 v211, v211
    s_nop 0
    v_cvt_pk_bf16_f32 v147, v210, v211
    v_exp_f32 v212, v212
    v_exp_f32 v213, v213
    s_nop 0
    v_cvt_pk_bf16_f32 v150, v212, v213
    v_exp_f32 v214, v214
    v_exp_f32 v215, v215
    s_nop 0
    v_cvt_pk_bf16_f32 v151, v214, v215
    v_mfma_f32_16x16x32_bf16 v[248:251], v[12:15], v[144:147], v[248:251]
    s_nop 0
    v_mfma_f32_16x16x32_bf16 v[252:255], v[12:15], v[148:151], v[252:255]
    s_nop 5
    v_mov_b32 v9, v248
    s_nop 0
    v_mov_b32 v10, v252
    v_max_f32 v17, v9, v10
    v_readfirstlane_b32 s17, v8
    s_cmp_eq_u32 s17, s28
    s_cselect_b32 s16, 0, 0x71800000
    v_cmp_ngt_f32 vcc, s16, v17
    v_cmp_u_f32 s[76:77], v9, v10
    s_or_b64 vcc, vcc, s[76:77]
    s_cbranch_vccnz adaLN_cond__sliding_block_cached__moe_arch_mod__prompt_kernel_fixA
adaLN_cond__sliding_block_cached__moe_arch_mod__prompt_kernel_fixAb:
    v_rcp_f32 v9, v9
    v_rcp_f32 v10, v10
    s_lshl_b32 s25, s13, 3
    s_add_u32 s25, s25, s3
    s_lshl_b32 s25, s25, 18
    s_lshl_b32 s26, s12, 12
    s_add_u32 s25, s25, s26
    s_add_u32 s25, s25, 0x1000000
    s_add_u32 s26, s25, 131072
    s_lshl_b32 s63, s13, 3
    s_add_u32 s63, s63, s3
    s_lshl_b32 s63, s63, 5
    s_add_u32 s63, s63, s12
    s_lshl_b32 s63, s63, 2
    s_waitcnt lgkmcnt(3)
    v_mfma_f32_16x16x32_bf16 v[184:187], v[232:235], v[24:27], 0
    v_mfma_f32_16x16x32_bf16 v[188:191], v[232:235], v[28:31], 0
    ds_read_b128 v[224:227], v5 offset:4096
    s_waitcnt lgkmcnt(3)
    v_mfma_f32_16x16x32_bf16 v[192:195], v[236:239], v[24:27], 0
    s_add_u32 s22, s21, 0x90000
    s_add_u32 m0, s20, 0x18000
    s_nop 0
    buffer_load_dwordx4 v2, s[8:11], s22 offen sc1 lds
    v_mfma_f32_16x16x32_bf16 v[196:199], v[236:239], v[28:31], 0
    ds_read_b128 v[228:231], v5 offset:5120
    s_waitcnt lgkmcnt(3)
    v_mfma_f32_16x16x32_bf16 v[184:187], v[240:243], v[32:35], v[184:187]
    v_mfma_f32_16x16x32_bf16 v[188:191], v[240:243], v[36:39], v[188:191]
    ds_read_b128 v[232:235], v5 offset:6144
    s_waitcnt lgkmcnt(3)
    v_mfma_f32_16x16x32_bf16 v[192:195], v[244:247], v[32:35], v[192:195]
    v_mfma_f32_16x16x32_bf16 v[196:199], v[244:247], v[36:39], v[196:199]
    ds_read_b128 v[236:239], v5 offset:7168
    s_waitcnt lgkmcnt(3)
    v_mfma_f32_16x16x32_bf16 v[184:187], v[224:227], v[40:43], v[184:187]
    v_mfma_f32_16x16x32_bf16 v[188:191], v[224:227], v[44:47], v[188:191]
    ds_read_b128 v[240:243], v5 offset:8192
    s_waitcnt lgkmcnt(3)
    v_mfma_f32_16x16x32_bf16 v[192:195], v[228:231], v[40:43], v[192:195]
    s_add_u32 s22, s21, 0x90400
    s_add_u32 m0, s20, 0x18400
    s_nop 0
    buffer_load_dwordx4 v2, s[8:11], s22 offen sc1 lds
    v_and_b32 v250, 7, v1
    v_lshlrev_b32 v250, 7, v250
    s_lshr_b32 s14, s2, 3
    s_lshl_b32 s14, s14, 2
    s_add_u32 s14, s14, 0x560000
    buffer_load_dword v248, v250, s[8:11], s14 offen sc1
    v_mfma_f32_16x16x32_bf16 v[196:199], v[228:231], v[44:47], v[196:199]
    ds_read_b128 v[244:247], v5 offset:9216
    s_waitcnt lgkmcnt(3)
    v_mfma_f32_16x16x32_bf16 v[184:187], v[232:235], v[48:51], v[184:187]
    v_mfma_f32_16x16x32_bf16 v[188:191], v[232:235], v[52:55], v[188:191]
    ds_read_b128 v[224:227], v5 offset:10240
    s_waitcnt lgkmcnt(3)
    v_mfma_f32_16x16x32_bf16 v[192:195], v[236:239], v[48:51], v[192:195]
    v_mfma_f32_16x16x32_bf16 v[196:199], v[236:239], v[52:55], v[196:199]
    ds_read_b128 v[228:231], v5 offset:11264
    s_waitcnt lgkmcnt(3)
    v_mfma_f32_16x16x32_bf16 v[184:187], v[240:243], v[56:59], v[184:187]
    v_mfma_f32_16x16x32_bf16 v[188:191], v[240:243], v[60:63], v[188:191]
    ds_read_b128 v[232:235], v5 offset:12288
    s_waitcnt lgkmcnt(3)
    v_mfma_f32_16x16x32_bf16 v[192:195], v[244:247], v[56:59], v[192:195]
    v_mfma_f32_16x16x32_bf16 v[196:199], v[244:247], v[60:63], v[196:199]
    ds_read_b128 v[236:239], v5 offset:13312
    s_waitcnt lgkmcnt(3)
    v_mfma_f32_16x16x32_bf16 v[184:187], v[224:227], v[64:67], v[184:187]
    v_mfma_f32_16x16x32_bf16 v[188:191], v[224:227], v[68:71], v[188:191]
    ds_read_b128 v[240:243], v5 offset:14336
    s_waitcnt lgkmcnt(3)
    v_mfma_f32_16x16x32_bf16 v[192:195], v[228:231], v[64:67], v[192:195]
    v_mfma_f32_16x16x32_bf16 v[196:199], v[228:231], v[68:71], v[196:199]
    ds_read_b128 v[244:247], v5 offset:15360
    s_waitcnt lgkmcnt(3)
    v_mfma_f32_16x16x32_bf16 v[184:187], v[232:235], v[72:75], v[184:187]
    v_mfma_f32_16x16x32_bf16 v[188:191], v[232:235], v[76:79], v[188:191]
    s_waitcnt vmcnt(7)
    s_barrier
    ds_read_b128 v[224:227], v5 offset:16384
    s_waitcnt lgkmcnt(3)
    v_mfma_f32_16x16x32_bf16 v[192:195], v[236:239], v[72:75], v[192:195]
    v_mfma_f32_16x16x32_bf16 v[196:199], v[236:239], v[76:79], v[196:199]
    s_add_u32 s22, s21, 0x94000
    s_add_u32 m0, s20, 0x1c000
    s_nop 0
    buffer_load_dwordx4 v2, s[8:11], s22 offen sc1 lds
    ds_read_b128 v[228:231], v5 offset:17408
    s_waitcnt lgkmcnt(3)
    v_mfma_f32_16x16x32_bf16 v[184:187], v[240:243], v[80:83], v[184:187]
    v_mfma_f32_16x16x32_bf16 v[188:191], v[240:243], v[84:87], v[188:191]
    ds_read_b128 v[232:235], v5 offset:18432
    s_waitcnt lgkmcnt(3)
    v_mfma_f32_16x16x32_bf16 v[192:195], v[244:247], v[80:83], v[192:195]
    v_mfma_f32_16x16x32_bf16 v[196:199], v[244:247], v[84:87], v[196:199]
    ds_read_b128 v[236:239], v5 offset:19456
    s_waitcnt lgkmcnt(3)
    v_mfma_f32_16x16x32_bf16 v[184:187], v[224:227], v[88:91], v[184:187]
    v_mfma_f32_16x16x32_bf16 v[188:191], v[224:227], v[92:95], v[188:191]
    ds_read_b128 v[240:243], v5 offset:20480
    s_waitcnt lgkmcnt(3)
    v_mfma_f32_16x16x32_bf16 v[192:195], v[228:231], v[88:91], v[192:195]
    v_mfma_f32_16x16x32_bf16 v[196:199], v[228:231], v[92:95], v[196:199]
    s_add_u32 s22, s21, 0x94400
    s_add_u32 m0, s20, 0x1c400
    s_nop 0
    buffer_load_dwordx4 v2, s[8:11], s22 offen sc1 lds
    ds_read_b128 v[244:247], v5 offset:21504
    s_waitcnt lgkmcnt(3)
    v_mfma_f32_16x16x32_bf16 v[184:187], v[232:235], v[96:99], v[184:187]
    v_mfma_f32_16x16x32_bf16 v[188:191], v[232:235], v[100:103], v[188:191]
    ds_read_b128 v[224:227], v5 offset:22528
    s_waitcnt lgkmcnt(3)
    v_mfma_f32_16x16x32_bf16 v[192:195], v[236:239], v[96:99], v[192:195]
    v_mfma_f32_16x16x32_bf16 v[196:199], v[236:239], v[100:103], v[196:199]
    ds_read_b128 v[228:231], v5 offset:23552
    s_waitcnt lgkmcnt(3)
    v_mfma_f32_16x16x32_bf16 v[184:187], v[240:243], v[104:107], v[184:187]
    v_mfma_f32_16x16x32_bf16 v[188:191], v[240:243], v[108:111], v[188:191]
    ds_read_b128 v[232:235], v5 offset:24576
    s_waitcnt lgkmcnt(3)
    v_mfma_f32_16x16x32_bf16 v[192:195], v[244:247], v[104:107], v[192:195]
    v_mfma_f32_16x16x32_bf16 v[196:199], v[244:247], v[108:111], v[196:199]
    ds_read_b128 v[236:239], v5 offset:25600
    s_waitcnt lgkmcnt(3)
    v_mfma_f32_16x16x32_bf16 v[184:187], v[224:227], v[112:115], v[184:187]
    s_waitcnt vmcnt(2)
    v_cmp_ne_u32 vcc, s28, v248
    s_cbranch_vccnz adaLN_cond__sliding_block_cached__moe_arch_mod__prompt_kernel_mp5r
adaLN_cond__sliding_block_cached__moe_arch_mod__prompt_kernel_mp5b:
    v_mfma_f32_16x16x32_bf16 v[188:191], v[224:227], v[116:119], v[188:191]
    ds_read_b128 v[240:243], v5 offset:26624
    v_lshrrev_b32 v250, 4, v1
    v_lshlrev_b32 v250, 14, v250
    v_and_b32 v253, 15, v1
    v_lshl_add_u32 v250, v253, 2, v250
    s_lshl_b32 s14, s2, 6
    s_add_u32 s14, s14, 0x580000
    buffer_load_dword v249, v250, s[8:11], s14 offen sc1
    s_add_u32 s14, s14, 0x10000
    buffer_load_dword v254, v250, s[8:11], s14 offen sc1
    s_waitcnt lgkmcnt(3)
    v_mfma_f32_16x16x32_bf16 v[192:195], v[228:231], v[112:115], v[192:195]
    v_mfma_f32_16x16x32_bf16 v[196:199], v[228:231], v[116:119], v[196:199]
    ds_read_b128 v[244:247], v5 offset:27648
    s_waitcnt lgkmcnt(3)
    v_mfma_f32_16x16x32_bf16 v[184:187], v[232:235], v[120:123], v[184:187]
    v_mfma_f32_16x16x32_bf16 v[188:191], v[232:235], v[124:127], v[188:191]
    ds_read_b128 v[224:227], v5 offset:28672
    s_waitcnt lgkmcnt(3)
    v_mfma_f32_16x16x32_bf16 v[192:195], v[236:239], v[120:123], v[192:195]
    v_mfma_f32_16x16x32_bf16 v[196:199], v[236:239], v[124:127], v[196:199]
    ds_read_b128 v[228:231], v5 offset:29696
    s_waitcnt lgkmcnt(3)
    v_mfma_f32_16x16x32_bf16 v[184:187], v[240:243], v[128:131], v[184:187]
    v_mfma_f32_16x16x32_bf16 v[188:191], v[240:243], v[132:135], v[188:191]
    ds_read_b128 v[232:235], v5 offset:30720
    s_waitcnt lgkmcnt(3)
    v_mfma_f32_16x16x32_bf16 v[192:195], v[244:247], v[128:131], v[192:195]
    v_mfma_f32_16x16x32_bf16 v[196:199], v[244:247], v[132:135], v[196:199]
    ds_read_b128 v[236:239], v5 offset:31744
    s_waitcnt lgkmcnt(3)
    v_mfma_f32_16x16x32_bf16 v[184:187], v[224:227], v[136:139], v[184:187]
    v_mfma_f32_16x16x32_bf16 v[188:191], v[224:227], v[140:143], v[188:191]
    s_barrier
    ds_read_b128 v[240:243], v4 offset:0
    s_waitcnt lgkmcnt(3)
    v_mfma_f32_16x16x32_bf16 v[192:195], v[228:231], v[136:139], v[192:195]
    v_mfma_f32_16x16x32_bf16 v[196:199], v[228:231], v[140:143], v[196:199]
    s_add_u32 s22, s21, 0x98000
    s_add_u32 m0, s20, 0x20000
    s_nop 0
    buffer_load_dwordx4 v2, s[8:11], s22 offen sc1 lds
    ds_read_b128 v[244:247], v4 offset:1024
    s_waitcnt lgkmcnt(3)
    v_mfma_f32_16x16x32_bf16 v[184:187], v[232:235], v[144:147], v[184:187]
    v_mfma_f32_16x16x32_bf16 v[188:191], v[232:235], v[148:151], v[188:191]
    ds_read_b128 v[224:227], v4 offset:2048
    s_waitcnt lgkmcnt(3)
    v_mfma_f32_16x16x32_bf16 v[192:195], v[236:239], v[144:147], v[192:195]
    v_mfma_f32_16x16x32_bf16 v[196:199], v[236:239], v[148:151], v[196:199]
    ds_read_b128 v[228:231], v4 offset:3072
    s_waitcnt lgkmcnt(3)
    v_mfma_f32_16x16x32_bf16 v[200:203], v[240:243], v[24:27], 0
    v_mfma_f32_16x16x32_bf16 v[204:207], v[240:243], v[28:31], 0
    ds_read_b128 v[232:235], v4 offset:4096
    s_waitcnt lgkmcnt(3)
    v_mfma_f32_16x16x32_bf16 v[208:211], v[244:247], v[24:27], 0
    v_mfma_f32_16x16x32_bf16 v[212:215], v[244:247], v[28:31], 0
    s_add_u32 s22, s21, 0x98400
    s_add_u32 m0, s20, 0x20400
    s_nop 0
    buffer_load_dwordx4 v2, s[8:11], s22 offen sc1 lds
    ds_read_b128 v[236:239], v4 offset:5120
    v_mul_f32 v184, v184, v9
    s_waitcnt lgkmcnt(3)
    v_mfma_f32_16x16x32_bf16 v[200:203], v[224:227], v[32:35], v[200:203]
    v_mul_f32 v185, v185, v9
    s_waitcnt vmcnt(2)
    v_add_f32 v249, v249, v254
    v_mov_b32 v250, v249
    s_nop 1
    v_permlane16_swap_b32 v249, v250
    v_add_f32 v249, v249, v250
    v_mov_b32 v250, v249
    s_nop 1
    v_permlane32_swap_b32 v249, v250
    v_add_f32 v249, v249, v250
    v_cvt_pk_bf16_f32 v249, v249, v249
    v_lshlrev_b32 v249, 16, v249
    s_lshr_b32 s14, s2, 6
    s_cmp_eq_u32 s14, 2
    s_cselect_b32 s14, 1.0, 0
    v_add_f32 v249, s14, v249
    v_cvt_pk_bf16_f32 v249, v249, v249
    v_lshlrev_b32 v253, 1, v253
    s_lshl_b32 s14, s2, 5
    s_add_u32 s14, s14, 0x540000
    s_cmp_eq_u32 s3, 0
    s_cselect_b32 s14, s14, 0x7ffffff0
    s_mov_b64 exec, 0xffff
    buffer_store_short v249, v253, s[8:11], s14 offen sc1
    s_mov_b64 exec, -1
    v_mfma_f32_16x16x32_bf16 v[204:207], v[224:227], v[36:39], v[204:207]
    ds_read_b128 v[240:243], v4 offset:6144
    v_mul_f32 v186, v186, v9
    s_waitcnt lgkmcnt(3)
    v_mfma_f32_16x16x32_bf16 v[208:211], v[228:231], v[32:35], v[208:211]
    v_mul_f32 v187, v187, v9
    v_mfma_f32_16x16x32_bf16 v[212:215], v[228:231], v[36:39], v[212:215]
    ds_read_b128 v[244:247], v4 offset:7168
    v_mul_f32 v192, v192, v9
    s_waitcnt lgkmcnt(3)
    v_mfma_f32_16x16x32_bf16 v[200:203], v[232:235], v[40:43], v[200:203]
    v_mul_f32 v193, v193, v9
    v_mfma_f32_16x16x32_bf16 v[204:207], v[232:235], v[44:47], v[204:207]
    ds_read_b128 v[224:227], v4 offset:8192
    v_mul_f32 v194, v194, v9
    s_waitcnt lgkmcnt(3)
    v_mfma_f32_16x16x32_bf16 v[208:211], v[236:239], v[40:43], v[208:211]
    v_mul_f32 v195, v195, v9
    v_mfma_f32_16x16x32_bf16 v[212:215], v[236:239], v[44:47], v[212:215]
    ds_read_b128 v[228:231], v4 offset:9216
    v_cvt_pk_bf16_f32 v216, v184, v185
    s_waitcnt lgkmcnt(3)
    v_mfma_f32_16x16x32_bf16 v[200:203], v[240:243], v[48:51], v[200:203]
    v_cvt_pk_bf16_f32 v217, v186, v187
    v_mfma_f32_16x16x32_bf16 v[204:207], v[240:243], v[52:55], v[204:207]
    ds_read_b128 v[232:235], v4 offset:10240
    v_cvt_pk_bf16_f32 v218, v192, v193
    s_waitcnt lgkmcnt(3)
    v_mfma_f32_16x16x32_bf16 v[208:211], v[244:247], v[48:51], v[208:211]
    v_cvt_pk_bf16_f32 v219, v194, v195
    v_mfma_f32_16x16x32_bf16 v[212:215], v[244:247], v[52:55], v[212:215]
    ds_read_b128 v[236:239], v4 offset:11264
    buffer_store_dwordx4 v[216:219], v2, s[8:11], s25 offen offset:0 sc1
    s_waitcnt lgkmcnt(3)
    v_mfma_f32_16x16x32_bf16 v[200:203], v[224:227], v[56:59], v[200:203]
    v_mul_f32 v188, v188, v10
    v_mfma_f32_16x16x32_bf16 v[204:207], v[224:227], v[60:63], v[204:207]
    ds_read_b128 v[240:243], v4 offset:12288
    v_mul_f32 v189, v189, v10
    s_waitcnt lgkmcnt(3)
    v_mfma_f32_16x16x32_bf16 v[208:211], v[228:231], v[56:59], v[208:211]
    v_mul_f32 v190, v190, v10
    v_mfma_f32_16x16x32_bf16 v[212:215], v[228:231], v[60:63], v[212:215]
    ds_read_b128 v[244:247], v4 offset:13312
    v_mul_f32 v191, v191, v10
    s_waitcnt lgkmcnt(3)
    v_mfma_f32_16x16x32_bf16 v[200:203], v[232:235], v[64:67], v[200:203]
    v_mul_f32 v196, v196, v10
    v_mfma_f32_16x16x32_bf16 v[204:207], v[232:235], v[68:71], v[204:207]
    ds_read_b128 v[224:227], v4 offset:14336
    v_mul_f32 v197, v197, v10
    s_waitcnt lgkmcnt(3)
    v_mfma_f32_16x16x32_bf16 v[208:211], v[236:239], v[64:67], v[208:211]
    v_mul_f32 v198, v198, v10
    v_mfma_f32_16x16x32_bf16 v[212:215], v[236:239], v[68:71], v[212:215]
    ds_read_b128 v[228:231], v4 offset:15360
    v_mul_f32 v199, v199, v10
    s_waitcnt lgkmcnt(3)
    v_mfma_f32_16x16x32_bf16 v[200:203], v[240:243], v[72:75], v[200:203]
    v_cvt_pk_bf16_f32 v220, v188, v189
    v_mfma_f32_16x16x32_bf16 v[204:207], v[240:243], v[76:79], v[204:207]
    s_barrier
    ds_read_b128 v[232:235], v4 offset:16384
    v_cvt_pk_bf16_f32 v221, v190, v191
    s_waitcnt lgkmcnt(3)
    v_mfma_f32_16x16x32_bf16 v[208:211], v[244:247], v[72:75], v[208:211]
    v_cvt_pk_bf16_f32 v222, v196, v197
    v_mfma_f32_16x16x32_bf16 v[212:215], v[244:247], v[76:79], v[212:215]
    s_add_u32 s22, s21, 0x9c000
    s_add_u32 m0, s20, 0x24000
    s_nop 0
    buffer_load_dwordx4 v2, s[8:11], s22 offen sc1 lds
    ds_read_b128 v[236:239], v4 offset:17408
    v_cvt_pk_bf16_f32 v223, v198, v199
    s_waitcnt lgkmcnt(3)
    v_mfma_f32_16x16x32_bf16 v[200:203], v[224:227], v[80:83], v[200:203]
    buffer_store_dwordx4 v[220:223], v2, s[8:11], s26 offen offset:0 sc1
    v_mfma_f32_16x16x32_bf16 v[204:207], v[224:227], v[84:87], v[204:207]
    ds_read_b128 v[240:243], v4 offset:18432
    s_waitcnt lgkmcnt(3)
    v_mfma_f32_16x16x32_bf16 v[208:211], v[228:231], v[80:83], v[208:211]
    v_mfma_f32_16x16x32_bf16 v[212:215], v[228:231], v[84:87], v[212:215]
    ds_read_b128 v[244:247], v4 offset:19456
    s_waitcnt lgkmcnt(3)
    v_mfma_f32_16x16x32_bf16 v[200:203], v[232:235], v[88:91], v[200:203]
    v_mfma_f32_16x16x32_bf16 v[204:207], v[232:235], v[92:95], v[204:207]
    ds_read_b128 v[224:227], v4 offset:20480
    s_waitcnt lgkmcnt(3)
    v_mfma_f32_16x16x32_bf16 v[208:211], v[236:239], v[88:91], v[208:211]
    v_mfma_f32_16x16x32_bf16 v[212:215], v[236:239], v[92:95], v[212:215]
    s_add_u32 s22, s21, 0x9c400
    s_add_u32 m0, s20, 0x24400
    s_nop 0
    buffer_load_dwordx4 v2, s[8:11], s22 offen sc1 lds
    ds_read_b128 v[228:231], v4 offset:21504
    s_waitcnt lgkmcnt(3)
    v_mfma_f32_16x16x32_bf16 v[200:203], v[240:243], v[96:99], v[200:203]
    v_mfma_f32_16x16x32_bf16 v[204:207], v[240:243], v[100:103], v[204:207]
    ds_read_b128 v[232:235], v4 offset:22528
    s_waitcnt lgkmcnt(3)
    v_mfma_f32_16x16x32_bf16 v[208:211], v[244:247], v[96:99], v[208:211]
    v_mfma_f32_16x16x32_bf16 v[212:215], v[244:247], v[100:103], v[212:215]
    ds_read_b128 v[236:239], v4 offset:23552
    s_waitcnt lgkmcnt(3)
    v_mfma_f32_16x16x32_bf16 v[200:203], v[224:227], v[104:107], v[200:203]
    v_mfma_f32_16x16x32_bf16 v[204:207], v[224:227], v[108:111], v[204:207]
    ds_read_b128 v[240:243], v4 offset:24576
    s_waitcnt lgkmcnt(3)
    v_mfma_f32_16x16x32_bf16 v[208:211], v[228:231], v[104:107], v[208:211]
    v_mfma_f32_16x16x32_bf16 v[212:215], v[228:231], v[108:111], v[212:215]
    ds_read_b128 v[244:247], v4 offset:25600
    s_waitcnt lgkmcnt(3)
    v_mfma_f32_16x16x32_bf16 v[200:203], v[232:235], v[112:115], v[200:203]
    s_waitcnt vmcnt(4)
    v_mov_b32 v248, s28
    v_mov_b32 v249, 0
    s_lshl_b32 s14, s2, 2
    s_add_u32 s14, s14, 0x544000
    s_cmp_eq_u32 s3, 0
    s_cselect_b32 s14, s14, 0x7ffffff0
    s_mov_b64 exec, 1
    buffer_store_dword v248, v249, s[8:11], s14 offen sc1
    s_mov_b64 exec, -1
    v_mfma_f32_16x16x32_bf16 v[204:207], v[232:235], v[116:119], v[204:207]
    ds_read_b128 v[224:227], v4 offset:26624
    s_waitcnt lgkmcnt(3)
    v_mfma_f32_16x16x32_bf16 v[208:211], v[236:239], v[112:115], v[208:211]
    v_mfma_f32_16x16x32_bf16 v[212:215], v[236:239], v[116:119], v[212:215]
    ds_read_b128 v[228:231], v4 offset:27648
    s_waitcnt lgkmcnt(3)
    v_mfma_f32_16x16x32_bf16 v[200:203], v[240:243], v[120:123], v[200:203]
    v_mfma_f32_16x16x32_bf16 v[204:207], v[240:243], v[124:127], v[204:207]
    ds_read_b128 v[232:235], v4 offset:28672
    s_waitcnt lgkmcnt(3)
    v_mfma_f32_16x16x32_bf16 v[208:211], v[244:247], v[120:123], v[208:211]
    v_mfma_f32_16x16x32_bf16 v[212:215], v[244:247], v[124:127], v[212:215]
    ds_read_b128 v[236:239], v4 offset:29696
    s_waitcnt lgkmcnt(3)
    v_mfma_f32_16x16x32_bf16 v[200:203], v[224:227], v[128:131], v[200:203]
    v_mfma_f32_16x16x32_bf16 v[204:207], v[224:227], v[132:135], v[204:207]
    ds_read_b128 v[240:243], v4 offset:30720
    s_waitcnt lgkmcnt(3)
    v_mfma_f32_16x16x32_bf16 v[208:211], v[228:231], v[128:131], v[208:211]
    v_mfma_f32_16x16x32_bf16 v[212:215], v[228:231], v[132:135], v[212:215]
    ds_read_b128 v[244:247], v4 offset:31744
    s_waitcnt lgkmcnt(3)
    v_mfma_f32_16x16x32_bf16 v[200:203], v[232:235], v[136:139], v[200:203]
    v_mfma_f32_16x16x32_bf16 v[204:207], v[232:235], v[140:143], v[204:207]
    s_barrier
    ds_read_b128 v[224:227], v4 offset:32768
    s_waitcnt lgkmcnt(3)
    v_mfma_f32_16x16x32_bf16 v[208:211], v[236:239], v[136:139], v[208:211]
    v_mfma_f32_16x16x32_bf16 v[212:215], v[236:239], v[140:143], v[212:215]
    s_add_u32 s22, s24, 0x0
    s_add_u32 m0, s20, 0x10000
    s_nop 0
    buffer_load_dwordx4 v3, s[4:7], s22 offen lds
    ds_read_b128 v[228:231], v4 offset:33792
    s_waitcnt lgkmcnt(3)
    v_mfma_f32_16x16x32_bf16 v[200:203], v[240:243], v[144:147], v[200:203]
    v_mfma_f32_16x16x32_bf16 v[204:207], v[240:243], v[148:151], v[204:207]
    ds_read_b128 v[232:235], v4 offset:34816
    s_waitcnt lgkmcnt(3)
    v_mfma_f32_16x16x32_bf16 v[208:211], v[244:247], v[144:147], v[208:211]
    v_mfma_f32_16x16x32_bf16 v[212:215], v[244:247], v[148:151], v[212:215]
    ds_read_b128 v[236:239], v4 offset:35840
    s_waitcnt lgkmcnt(3)
    v_mfma_f32_16x16x32_bf16 v[184:187], v[224:227], v[24:27], 0
    v_mfma_f32_16x16x32_bf16 v[188:191], v[224:227], v[28:31], 0
    ds_read_b128 v[240:243], v4 offset:36864
    s_waitcnt lgkmcnt(3)
    v_mfma_f32_16x16x32_bf16 v[192:195], v[228:231], v[24:27], 0
    v_mfma_f32_16x16x32_bf16 v[196:199], v[228:231], v[28:31], 0
    s_add_u32 s22, s24, 0x2000
    s_add_u32 m0, s20, 0x10400
    s_nop 0
    buffer_load_dwordx4 v3, s[4:7], s22 offen lds
    ds_read_b128 v[244:247], v4 offset:37888
    v_mul_f32 v200, v200, v9
    s_waitcnt lgkmcnt(3)
    v_mfma_f32_16x16x32_bf16 v[184:187], v[232:235], v[32:35], v[184:187]
    v_mul_f32 v201, v201, v9
    v_mfma_f32_16x16x32_bf16 v[188:191], v[232:235], v[36:39], v[188:191]
    ds_read_b128 v[224:227], v4 offset:38912
    v_mul_f32 v202, v202, v9
    s_waitcnt lgkmcnt(3)
    v_mfma_f32_16x16x32_bf16 v[192:195], v[236:239], v[32:35], v[192:195]
    v_mul_f32 v203, v203, v9
    v_mfma_f32_16x16x32_bf16 v[196:199], v[236:239], v[36:39], v[196:199]
    ds_read_b128 v[228:231], v4 offset:39936
    v_mul_f32 v208, v208, v9
    s_waitcnt lgkmcnt(3)
    v_mfma_f32_16x16x32_bf16 v[184:187], v[240:243], v[40:43], v[184:187]
    v_mul_f32 v209, v209, v9
    v_mfma_f32_16x16x32_bf16 v[188:191], v[240:243], v[44:47], v[188:191]
    ds_read_b128 v[232:235], v4 offset:40960
    v_mul_f32 v210, v210, v9
    s_waitcnt lgkmcnt(3)
    v_mfma_f32_16x16x32_bf16 v[192:195], v[244:247], v[40:43], v[192:195]
    v_mul_f32 v211, v211, v9
    v_mfma_f32_16x16x32_bf16 v[196:199], v[244:247], v[44:47], v[196:199]
    ds_read_b128 v[236:239], v4 offset:41984
    v_cvt_pk_bf16_f32 v216, v200, v201
    s_waitcnt lgkmcnt(3)
    v_mfma_f32_16x16x32_bf16 v[184:187], v[224:227], v[48:51], v[184:187]
    v_cvt_pk_bf16_f32 v217, v202, v203
    s_waitcnt vmcnt(4)
    s_add_u32 s16, s63, 0x570000
    v_mov_b32 v7, s28
    v_mov_b32 v8, 0
    s_mov_b64 exec, 1
    buffer_store_dword v7, v8, s[8:11], s16 offen sc1
    s_mov_b64 exec, -1
    v_mfma_f32_16x16x32_bf16 v[188:191], v[224:227], v[52:55], v[188:191]
    ds_read_b128 v[240:243], v4 offset:43008
    v_cvt_pk_bf16_f32 v218, v208, v209
    s_waitcnt lgkmcnt(3)
    v_mfma_f32_16x16x32_bf16 v[192:195], v[228:231], v[48:51], v[192:195]
    v_cvt_pk_bf16_f32 v219, v210, v211
    v_mfma_f32_16x16x32_bf16 v[196:199], v[228:231], v[52:55], v[196:199]
    ds_read_b128 v[244:247], v4 offset:44032
    buffer_store_dwordx4 v[216:219], v2, s[8:11], s25 offen offset:1024 sc1
    s_waitcnt lgkmcnt(3)
    v_mfma_f32_16x16x32_bf16 v[184:187], v[232:235], v[56:59], v[184:187]
    v_mul_f32 v204, v204, v10
    v_mfma_f32_16x16x32_bf16 v[188:191], v[232:235], v[60:63], v[188:191]
    ds_read_b128 v[224:227], v4 offset:45056
    v_mul_f32 v205, v205, v10
    s_waitcnt lgkmcnt(3)
    v_mfma_f32_16x16x32_bf16 v[192:195], v[236:239], v[56:59], v[192:195]
    v_mul_f32 v206, v206, v10
    v_mfma_f32_16x16x32_bf16 v[196:199], v[236:239], v[60:63], v[196:199]
    ds_read_b128 v[228:231], v4 offset:46080
    v_mul_f32 v207, v207, v10
    s_waitcnt lgkmcnt(3)
    v_mfma_f32_16x16x32_bf16 v[184:187], v[240:243], v[64:67], v[184:187]
    v_mul_f32 v212, v212, v10
    v_mfma_f32_16x16x32_bf16 v[188:191], v[240:243], v[68:71], v[188:191]
    ds_read_b128 v[232:235], v4 offset:47104
    v_mul_f32 v213, v213, v10
    s_waitcnt lgkmcnt(3)
    v_mfma_f32_16x16x32_bf16 v[192:195], v[244:247], v[64:67], v[192:195]
    v_mul_f32 v214, v214, v10
    v_mfma_f32_16x16x32_bf16 v[196:199], v[244:247], v[68:71], v[196:199]
    ds_read_b128 v[236:239], v4 offset:48128
    v_mul_f32 v215, v215, v10
    s_waitcnt lgkmcnt(3)
    v_mfma_f32_16x16x32_bf16 v[184:187], v[224:227], v[72:75], v[184:187]
    v_cvt_pk_bf16_f32 v220, v204, v205
    v_mfma_f32_16x16x32_bf16 v[188:191], v[224:227], v[76:79], v[188:191]
    s_barrier
    ds_read_b128 v[240:243], v4 offset:49152
    v_cvt_pk_bf16_f32 v221, v206, v207
    s_waitcnt lgkmcnt(3)
    v_mfma_f32_16x16x32_bf16 v[192:195], v[228:231], v[72:75], v[192:195]
    v_cvt_pk_bf16_f32 v222, v212, v213
    v_mfma_f32_16x16x32_bf16 v[196:199], v[228:231], v[76:79], v[196:199]
    s_add_u32 s22, s24, 0x80000
    s_add_u32 m0, s20, 0x14000
    s_nop 0
    buffer_load_dwordx4 v3, s[4:7], s22 offen lds
    ds_read_b128 v[244:247], v4 offset:50176
    v_cvt_pk_bf16_f32 v223, v214, v215
    s_waitcnt lgkmcnt(3)
    v_mfma_f32_16x16x32_bf16 v[184:187], v[232:235], v[80:83], v[184:187]
    buffer_store_dwordx4 v[220:223], v2, s[8:11], s26 offen offset:1024 sc1
    v_mfma_f32_16x16x32_bf16 v[188:191], v[232:235], v[84:87], v[188:191]
    ds_read_b128 v[224:227], v4 offset:51200
    s_waitcnt lgkmcnt(3)
    v_mfma_f32_16x16x32_bf16 v[192:195], v[236:239], v[80:83], v[192:195]
    v_mfma_f32_16x16x32_bf16 v[196:199], v[236:239], v[84:87], v[196:199]
    ds_read_b128 v[228:231], v4 offset:52224
    s_waitcnt lgkmcnt(3)
    v_mfma_f32_16x16x32_bf16 v[184:187], v[240:243], v[88:91], v[184:187]
    v_mfma_f32_16x16x32_bf16 v[188:191], v[240:243], v[92:95], v[188:191]
    ds_read_b128 v[232:235], v4 offset:53248
    s_waitcnt lgkmcnt(3)
    v_mfma_f32_16x16x32_bf16 v[192:195], v[244:247], v[88:91], v[192:195]
    v_mfma_f32_16x16x32_bf16 v[196:199], v[244:247], v[92:95], v[196:199]
    s_add_u32 s22, s24, 0x82000
    s_add_u32 m0, s20, 0x14400
    s_nop 0
    buffer_load_dwordx4 v3, s[4:7], s22 offen lds
    ds_read_b128 v[236:239], v4 offset:54272
    s_waitcnt lgkmcnt(3)
    v_mfma_f32_16x16x32_bf16 v[184:187], v[224:227], v[96:99], v[184:187]
    v_mfma_f32_16x16x32_bf16 v[188:191], v[224:227], v[100:103], v[188:191]
    ds_read_b128 v[240:243], v4 offset:55296
    s_waitcnt lgkmcnt(3)
    v_mfma_f32_16x16x32_bf16 v[192:195], v[228:231], v[96:99], v[192:195]
    v_mfma_f32_16x16x32_bf16 v[196:199], v[228:231], v[100:103], v[196:199]
    ds_read_b128 v[244:247], v4 offset:56320
    s_waitcnt lgkmcnt(3)
    v_mfma_f32_16x16x32_bf16 v[184:187], v[232:235], v[104:107], v[184:187]
    v_mfma_f32_16x16x32_bf16 v[188:191], v[232:235], v[108:111], v[188:191]
    ds_read_b128 v[224:227], v4 offset:57344
    s_waitcnt lgkmcnt(3)
    v_mfma_f32_16x16x32_bf16 v[192:195], v[236:239], v[104:107], v[192:195]
    v_mfma_f32_16x16x32_bf16 v[196:199], v[236:239], v[108:111], v[196:199]
    ds_read_b128 v[228:231], v4 offset:58368
    s_waitcnt lgkmcnt(3)
    v_mfma_f32_16x16x32_bf16 v[184:187], v[240:243], v[112:115], v[184:187]
    v_mfma_f32_16x16x32_bf16 v[188:191], v[240:243], v[116:119], v[188:191]
    ds_read_b128 v[232:235], v4 offset:59392
    s_waitcnt lgkmcnt(3)
    v_mfma_f32_16x16x32_bf16 v[192:195], v[244:247], v[112:115], v[192:195]
    v_mfma_f32_16x16x32_bf16 v[196:199], v[244:247], v[116:119], v[196:199]
    ds_read_b128 v[236:239], v4 offset:60416
    s_waitcnt lgkmcnt(3)
    v_mfma_f32_16x16x32_bf16 v[184:187], v[224:227], v[120:123], v[184:187]
    v_mfma_f32_16x16x32_bf16 v[188:191], v[224:227], v[124:127], v[188:191]
    ds_read_b128 v[240:243], v4 offset:61440
    s_waitcnt lgkmcnt(3)
    v_mfma_f32_16x16x32_bf16 v[192:195], v[228:231], v[120:123], v[192:195]
    v_mfma_f32_16x16x32_bf16 v[196:199], v[228:231], v[124:127], v[196:199]
    ds_read_b128 v[244:247], v4 offset:62464
    s_waitcnt lgkmcnt(3)
    v_mfma_f32_16x16x32_bf16 v[184:187], v[232:235], v[128:131], v[184:187]
    v_mfma_f32_16x16x32_bf16 v[188:191], v[232:235], v[132:135], v[188:191]
    ds_read_b128 v[224:227], v4 offset:63488
    s_waitcnt lgkmcnt(3)
    v_mfma_f32_16x16x32_bf16 v[192:195], v[236:239], v[128:131], v[192:195]
    v_mfma_f32_16x16x32_bf16 v[196:199], v[236:239], v[132:135], v[196:199]
    ds_read_b128 v[228:231], v4 offset:64512
    s_waitcnt lgkmcnt(3)
    v_mfma_f32_16x16x32_bf16 v[184:187], v[240:243], v[136:139], v[184:187]
    v_mfma_f32_16x16x32_bf16 v[188:191], v[240:243], v[140:143], v[188:191]
    s_barrier
    ds_read_b128 v[232:235], v5 offset:0
    s_waitcnt lgkmcnt(3)
    v_mfma_f32_16x16x32_bf16 v[192:195], v[244:247], v[136:139], v[192:195]
    v_mfma_f32_16x16x32_bf16 v[196:199], v[244:247], v[140:143], v[196:199]
    s_add_u32 s22, s24, 0x100000
    s_add_u32 m0, s20, 0x18000
    s_nop 0
    buffer_load_dwordx4 v3, s[4:7], s22 offen lds
    ds_read_b128 v[236:239], v5 offset:1024
    s_waitcnt lgkmcnt(3)
    v_mfma_f32_16x16x32_bf16 v[184:187], v[224:227], v[144:147], v[184:187]
    v_mfma_f32_16x16x32_bf16 v[188:191], v[224:227], v[148:151], v[188:191]
    ds_read_b128 v[240:243], v5 offset:2048
    s_waitcnt lgkmcnt(3)
    v_mfma_f32_16x16x32_bf16 v[192:195], v[228:231], v[144:147], v[192:195]
    v_mfma_f32_16x16x32_bf16 v[196:199], v[228:231], v[148:151], v[196:199]
    ds_read_b128 v[244:247], v5 offset:3072
    s_waitcnt lgkmcnt(3)
    v_mfma_f32_16x16x32_bf16 v[200:203], v[232:235], v[24:27], 0
    v_mfma_f32_16x16x32_bf16 v[204:207], v[232:235], v[28:31], 0
    ds_read_b128 v[224:227], v5 offset:4096
    s_waitcnt lgkmcnt(3)
    v_mfma_f32_16x16x32_bf16 v[208:211], v[236:239], v[24:27], 0
    v_mfma_f32_16x16x32_bf16 v[212:215], v[236:239], v[28:31], 0
    s_add_u32 s22, s24, 0x102000
    s_add_u32 m0, s20, 0x18400
    s_nop 0
    buffer_load_dwordx4 v3, s[4:7], s22 offen lds
    ds_read_b128 v[228:231], v5 offset:5120
    v_mul_f32 v184, v184, v9
    s_waitcnt lgkmcnt(3)
    v_mfma_f32_16x16x32_bf16 v[200:203], v[240:243], v[32:35], v[200:203]
    v_mul_f32 v185, v185, v9
    s_bfe_u32 s30, s2, 0x20001
    s_lshl_b32 s30, s30, 2
    s_bfe_u32 s17, s2, 0x20003
    s_add_u32 s30, s30, s17
    s_lshr_b32 s31, s2, 5
    s_and_b32 s17, s3, 3
    s_lshl_b32 s19, s30, 2
    s_add_u32 s19, s19, s17
    s_and_b32 s16, s2, 1
    s_lshl_b32 s17, s19, 18
    s_lshl_b32 s23, s16, 16
    s_add_u32 s17, s17, s23
    s_add_u32 s17, s17, 0x1000000
    v_add_u32 v6, s17, v2
    s_lshl_b32 s19, s19, 7
    s_lshl_b32 s23, s16, 6
    s_add_u32 s19, s19, s23
    s_add_u32 s19, s19, 0x570000
    v_and_b32 v13, 15, v1
    v_lshlrev_b32 v13, 2, v13
    buffer_load_dword v12, v13, s[8:11], s19 offen sc1
    v_mfma_f32_16x16x32_bf16 v[204:207], v[240:243], v[36:39], v[204:207]
    ds_read_b128 v[232:235], v5 offset:6144
    v_mul_f32 v186, v186, v9
    s_waitcnt lgkmcnt(3)
    v_mfma_f32_16x16x32_bf16 v[208:211], v[244:247], v[32:35], v[208:211]
    v_mul_f32 v187, v187, v9
    v_mfma_f32_16x16x32_bf16 v[212:215], v[244:247], v[36:39], v[212:215]
    ds_read_b128 v[236:239], v5 offset:7168
    v_mul_f32 v192, v192, v9
    s_waitcnt lgkmcnt(3)
    v_mfma_f32_16x16x32_bf16 v[200:203], v[224:227], v[40:43], v[200:203]
    v_mul_f32 v193, v193, v9
    v_mfma_f32_16x16x32_bf16 v[204:207], v[224:227], v[44:47], v[204:207]
    ds_read_b128 v[240:243], v5 offset:8192
    v_mul_f32 v194, v194, v9
    s_waitcnt lgkmcnt(3)
    v_mfma_f32_16x16x32_bf16 v[208:211], v[228:231], v[40:43], v[208:211]
    v_mul_f32 v195, v195, v9
    v_mfma_f32_16x16x32_bf16 v[212:215], v[228:231], v[44:47], v[212:215]
    ds_read_b128 v[244:247], v5 offset:9216
    v_cvt_pk_bf16_f32 v216, v184, v185
    s_waitcnt lgkmcnt(3)
    v_mfma_f32_16x16x32_bf16 v[200:203], v[232:235], v[48:51], v[200:203]
    v_cvt_pk_bf16_f32 v217, v186, v187
    v_mfma_f32_16x16x32_bf16 v[204:207], v[232:235], v[52:55], v[204:207]
    ds_read_b128 v[224:227], v5 offset:10240
    v_cvt_pk_bf16_f32 v218, v192, v193
    s_waitcnt lgkmcnt(3)
    v_mfma_f32_16x16x32_bf16 v[208:211], v[236:239], v[48:51], v[208:211]
    v_cvt_pk_bf16_f32 v219, v194, v195
    v_mfma_f32_16x16x32_bf16 v[212:215], v[236:239], v[52:55], v[212:215]
    ds_read_b128 v[228:231], v5 offset:11264
    buffer_store_dwordx4 v[216:219], v2, s[8:11], s25 offen offset:2048 sc1
    s_waitcnt lgkmcnt(3)
    v_mfma_f32_16x16x32_bf16 v[200:203], v[240:243], v[56:59], v[200:203]
    v_mul_f32 v188, v188, v10
    v_mfma_f32_16x16x32_bf16 v[204:207], v[240:243], v[60:63], v[204:207]
    ds_read_b128 v[232:235], v5 offset:12288
    v_mul_f32 v189, v189, v10
    s_waitcnt lgkmcnt(3)
    v_mfma_f32_16x16x32_bf16 v[208:211], v[244:247], v[56:59], v[208:211]
    v_mul_f32 v190, v190, v10
    v_mfma_f32_16x16x32_bf16 v[212:215], v[244:247], v[60:63], v[212:215]
    ds_read_b128 v[236:239], v5 offset:13312
    v_mul_f32 v191, v191, v10
    s_waitcnt lgkmcnt(3)
    v_mfma_f32_16x16x32_bf16 v[200:203], v[224:227], v[64:67], v[200:203]
    v_mul_f32 v196, v196, v10
    v_mfma_f32_16x16x32_bf16 v[204:207], v[224:227], v[68:71], v[204:207]
    ds_read_b128 v[240:243], v5 offset:14336
    v_mul_f32 v197, v197, v10
    s_waitcnt lgkmcnt(3)
    v_mfma_f32_16x16x32_bf16 v[208:211], v[228:231], v[64:67], v[208:211]
    v_mul_f32 v198, v198, v10
    v_mfma_f32_16x16x32_bf16 v[212:215], v[228:231], v[68:71], v[212:215]
    ds_read_b128 v[244:247], v5 offset:15360
    v_mul_f32 v199, v199, v10
    s_waitcnt lgkmcnt(3)
    v_mfma_f32_16x16x32_bf16 v[200:203], v[232:235], v[72:75], v[200:203]
    v_cvt_pk_bf16_f32 v220, v188, v189
    v_mfma_f32_16x16x32_bf16 v[204:207], v[232:235], v[76:79], v[204:207]
    s_waitcnt vmcnt(12)
    s_barrier
    ds_read_b128 v[224:227], v5 offset:16384
    v_cvt_pk_bf16_f32 v221, v190, v191
    s_waitcnt lgkmcnt(3)
    v_mfma_f32_16x16x32_bf16 v[208:211], v[236:239], v[72:75], v[208:211]
    v_cvt_pk_bf16_f32 v222, v196, v197
    v_mfma_f32_16x16x32_bf16 v[212:215], v[236:239], v[76:79], v[212:215]
    s_add_u32 s22, s24, 0x180000
    s_add_u32 m0, s20, 0x1c000
    s_nop 0
    buffer_load_dwordx4 v3, s[4:7], s22 offen lds
    ds_read_b128 v[228:231], v5 offset:17408
    v_cvt_pk_bf16_f32 v223, v198, v199
    s_waitcnt lgkmcnt(3)
    v_mfma_f32_16x16x32_bf16 v[200:203], v[240:243], v[80:83], v[200:203]
    buffer_store_dwordx4 v[220:223], v2, s[8:11], s26 offen offset:2048 sc1
    v_mfma_f32_16x16x32_bf16 v[204:207], v[240:243], v[84:87], v[204:207]
    ds_read_b128 v[232:235], v5 offset:18432
    s_waitcnt lgkmcnt(3)
    v_mfma_f32_16x16x32_bf16 v[208:211], v[244:247], v[80:83], v[208:211]
    v_mfma_f32_16x16x32_bf16 v[212:215], v[244:247], v[84:87], v[212:215]
    ds_read_b128 v[236:239], v5 offset:19456
    s_waitcnt lgkmcnt(3)
    v_mfma_f32_16x16x32_bf16 v[200:203], v[224:227], v[88:91], v[200:203]
    v_mfma_f32_16x16x32_bf16 v[204:207], v[224:227], v[92:95], v[204:207]
    ds_read_b128 v[240:243], v5 offset:20480
    s_waitcnt vmcnt(3)
    v_cmp_ne_u32 vcc, s28, v12
    s_cbranch_vccnz adaLN_cond__sliding_block_cached__moe_arch_mod__prompt_kernel_o6r
adaLN_cond__sliding_block_cached__moe_arch_mod__prompt_kernel_o6b:
    s_waitcnt lgkmcnt(3)
    v_mfma_f32_16x16x32_bf16 v[208:211], v[228:231], v[88:91], v[208:211]
    s_mov_b32 s23, 0x0
    buffer_load_dwordx4 v[24:27], v6, s[8:11], s23 offen offset:0 sc1
    v_mfma_f32_16x16x32_bf16 v[212:215], v[228:231], v[92:95], v[212:215]
    s_add_u32 s22, s24, 0x182000
    s_add_u32 m0, s20, 0x1c400
    s_nop 0
    buffer_load_dwordx4 v3, s[4:7], s22 offen lds
    ds_read_b128 v[244:247], v5 offset:21504
    s_waitcnt lgkmcnt(3)
    v_mfma_f32_16x16x32_bf16 v[200:203], v[232:235], v[96:99], v[200:203]
    v_mfma_f32_16x16x32_bf16 v[204:207], v[232:235], v[100:103], v[204:207]
    ds_read_b128 v[224:227], v5 offset:22528
    s_mov_b32 s23, 0x20000
    buffer_load_dwordx4 v[28:31], v6, s[8:11], s23 offen offset:0 sc1
    s_waitcnt lgkmcnt(3)
    v_mfma_f32_16x16x32_bf16 v[208:211], v[236:239], v[96:99], v[208:211]
    s_add_u32 s16, s63, 0x572000
    v_mov_b32 v14, s28
    v_mov_b32 v15, 0
    s_mov_b64 exec, 1
    buffer_store_dword v14, v15, s[8:11], s16 offen sc1
    s_mov_b64 exec, -1
    v_mfma_f32_16x16x32_bf16 v[212:215], v[236:239], v[100:103], v[212:215]
    ds_read_b128 v[228:231], v5 offset:23552
    s_waitcnt lgkmcnt(3)
    v_mfma_f32_16x16x32_bf16 v[200:203], v[240:243], v[104:107], v[200:203]
    v_mfma_f32_16x16x32_bf16 v[204:207], v[240:243], v[108:111], v[204:207]
    ds_read_b128 v[232:235], v5 offset:24576
    s_mov_b32 s23, 0x2000
    buffer_load_dwordx4 v[32:35], v6, s[8:11], s23 offen offset:0 sc1
    s_waitcnt lgkmcnt(3)
    v_mfma_f32_16x16x32_bf16 v[208:211], v[244:247], v[104:107], v[208:211]
    v_mfma_f32_16x16x32_bf16 v[212:215], v[244:247], v[108:111], v[212:215]
    ds_read_b128 v[236:239], v5 offset:25600
    s_waitcnt lgkmcnt(3)
    v_mfma_f32_16x16x32_bf16 v[200:203], v[224:227], v[112:115], v[200:203]
    s_mov_b32 s23, 0x22000
    buffer_load_dwordx4 v[36:39], v6, s[8:11], s23 offen offset:0 sc1
    v_mfma_f32_16x16x32_bf16 v[204:207], v[224:227], v[116:119], v[204:207]
    ds_read_b128 v[240:243], v5 offset:26624
    s_waitcnt lgkmcnt(3)
    v_mfma_f32_16x16x32_bf16 v[208:211], v[228:231], v[112:115], v[208:211]
    v_mfma_f32_16x16x32_bf16 v[212:215], v[228:231], v[116:119], v[212:215]
    ds_read_b128 v[244:247], v5 offset:27648
    s_waitcnt lgkmcnt(3)
    v_mfma_f32_16x16x32_bf16 v[200:203], v[232:235], v[120:123], v[200:203]
    s_mov_b32 s23, 0x4000
    buffer_load_dwordx4 v[40:43], v6, s[8:11], s23 offen offset:0 sc1
    v_mfma_f32_16x16x32_bf16 v[204:207], v[232:235], v[124:127], v[204:207]
    ds_read_b128 v[224:227], v5 offset:28672
    s_waitcnt lgkmcnt(3)
    v_mfma_f32_16x16x32_bf16 v[208:211], v[236:239], v[120:123], v[208:211]
    v_mfma_f32_16x16x32_bf16 v[212:215], v[236:239], v[124:127], v[212:215]
    ds_read_b128 v[228:231], v5 offset:29696
    s_waitcnt lgkmcnt(3)
    v_mfma_f32_16x16x32_bf16 v[200:203], v[240:243], v[128:131], v[200:203]
    s_mov_b32 s23, 0x24000
    buffer_load_dwordx4 v[44:47], v6, s[8:11], s23 offen offset:0 sc1
    v_mfma_f32_16x16x32_bf16 v[204:207], v[240:243], v[132:135], v[204:207]
    ds_read_b128 v[232:235], v5 offset:30720
    s_waitcnt lgkmcnt(3)
    v_mfma_f32_16x16x32_bf16 v[208:211], v[244:247], v[128:131], v[208:211]
    v_mfma_f32_16x16x32_bf16 v[212:215], v[244:247], v[132:135], v[212:215]
    ds_read_b128 v[236:239], v5 offset:31744
    s_mov_b32 s23, 0x6000
    buffer_load_dwordx4 v[48:51], v6, s[8:11], s23 offen offset:0 sc1
    s_waitcnt lgkmcnt(3)
    v_mfma_f32_16x16x32_bf16 v[200:203], v[224:227], v[136:139], v[200:203]
    v_bfe_u32 v18, v1, 2, 2
    v_lshrrev_b32 v19, 4, v1
    v_mfma_f32_16x16x32_bf16 v[204:207], v[224:227], v[140:143], v[204:207]
    v_and_b32 v17, 3, v1
    v_lshlrev_b32 v16, 11, v19
    s_waitcnt lgkmcnt(2)
    v_mfma_f32_16x16x32_bf16 v[208:211], v[228:231], v[136:139], v[208:211]
    v_lshl_add_u32 v16, v18, 6, v16
    v_lshl_add_u32 v16, v17, 3, v16
    v_mfma_f32_16x16x32_bf16 v[212:215], v[228:231], v[140:143], v[212:215]
    s_mov_b32 s23, 0x26000
    buffer_load_dwordx4 v[52:55], v6, s[8:11], s23 offen offset:0 sc1
    v_add_u32 v16, 0x10000, v16
    v_and_b32 v19, 1, v19
    s_waitcnt lgkmcnt(1)
    v_mfma_f32_16x16x32_bf16 v[200:203], v[232:235], v[144:147], v[200:203]
    v_lshlrev_b32 v19, 5, v19
    v_sub_u32 v5, v16, v19
    v_mfma_f32_16x16x32_bf16 v[204:207], v[232:235], v[148:151], v[204:207]
    v_add_u32 v4, v16, v19
    v_add_u32 v7, 0x10000, v4
    s_waitcnt lgkmcnt(0)
    v_mfma_f32_16x16x32_bf16 v[208:211], v[236:239], v[144:147], v[208:211]
    v_add_u32 v8, 0x10000, v5
    v_mfma_f32_16x16x32_bf16 v[212:215], v[236:239], v[148:151], v[212:215]
    v_mul_f32 v200, v200, v9
    v_mul_f32 v201, v201, v9
    v_mul_f32 v202, v202, v9
    v_mul_f32 v203, v203, v9
    s_nop 1
    v_mul_f32 v208, v208, v9
    v_mul_f32 v209, v209, v9
    v_mul_f32 v210, v210, v9
    v_mul_f32 v211, v211, v9
    v_cvt_pk_bf16_f32 v216, v200, v201
    v_cvt_pk_bf16_f32 v217, v202, v203
    v_cvt_pk_bf16_f32 v218, v208, v209
    v_cvt_pk_bf16_f32 v219, v210, v211
    buffer_store_dwordx4 v[216:219], v2, s[8:11], s25 offen offset:3072 sc1
    v_mul_f32 v204, v204, v10
    v_mul_f32 v205, v205, v10
    v_mul_f32 v206, v206, v10
    v_mul_f32 v207, v207, v10
    v_mul_f32 v212, v212, v10
    v_mul_f32 v213, v213, v10
    v_mul_f32 v214, v214, v10
    v_mul_f32 v215, v215, v10
    v_cvt_pk_bf16_f32 v220, v204, v205
    v_cvt_pk_bf16_f32 v221, v206, v207
    v_cvt_pk_bf16_f32 v222, v212, v213
    v_cvt_pk_bf16_f32 v223, v214, v215
    buffer_store_dwordx4 v[220:223], v2, s[8:11], s26 offen offset:3072 sc1
    s_and_b32 s15, s2, 1
    s_barrier
    ds_read_b64_tr_b16 v[224:225], v4 offset:0
    ds_read_b64_tr_b16 v[226:227], v4 offset:1024
    ds_read_b64_tr_b16 v[228:229], v5 offset:32
    ds_read_b64_tr_b16 v[230:231], v5 offset:1056
    ds_read_b64_tr_b16 v[232:233], v4 offset:256
    ds_read_b64_tr_b16 v[234:235], v4 offset:1280
    ds_read_b64_tr_b16 v[236:237], v5 offset:288
    ds_read_b64_tr_b16 v[238:239], v5 offset:1312
    s_waitcnt vmcnt(11) lgkmcnt(6)
    v_mfma_f32_16x16x32_bf16 v[88:91], v[224:227], v[24:27], 0
    ds_read_b64_tr_b16 v[240:241], v4 offset:512
    s_waitcnt vmcnt(9)
    v_mfma_f32_16x16x32_bf16 v[92:95], v[224:227], v[28:31], 0
    s_add_u32 s22, s24, 0x200000
    s_add_u32 m0, s20, 0x20000
    s_nop 0
    buffer_load_dwordx4 v3, s[4:7], s22 offen lds
    ds_read_b64_tr_b16 v[242:243], v4 offset:1536
    s_waitcnt lgkmcnt(6)
    v_mfma_f32_16x16x32_bf16 v[96:99], v[228:231], v[24:27], 0
    ds_read_b64_tr_b16 v[244:245], v5 offset:544
    s_mov_b32 s23, 0x8000
    buffer_load_dwordx4 v[56:59], v6, s[8:11], s23 offen offset:0 sc1
    v_mfma_f32_16x16x32_bf16 v[100:103], v[228:231], v[28:31], 0
    ds_read_b64_tr_b16 v[246:247], v5 offset:1568
    s_waitcnt lgkmcnt(6)
    v_mfma_f32_16x16x32_bf16 v[104:107], v[232:235], v[24:27], 0
    s_add_u32 s22, s24, 0x202000
    s_add_u32 m0, s20, 0x20400
    s_nop 0
    buffer_load_dwordx4 v3, s[4:7], s22 offen lds
    ds_read_b64_tr_b16 v[224:225], v4 offset:768
    v_mfma_f32_16x16x32_bf16 v[108:111], v[232:235], v[28:31], 0
    ds_read_b64_tr_b16 v[226:227], v4 offset:1792
    s_mov_b32 s23, 0x28000
    buffer_load_dwordx4 v[60:63], v6, s[8:11], s23 offen offset:0 sc1
    s_waitcnt lgkmcnt(6)
    v_mfma_f32_16x16x32_bf16 v[112:115], v[236:239], v[24:27], 0
    ds_read_b64_tr_b16 v[228:229], v5 offset:800
    v_mfma_f32_16x16x32_bf16 v[116:119], v[236:239], v[28:31], 0
    ds_read_b64_tr_b16 v[230:231], v5 offset:1824
    s_waitcnt lgkmcnt(6)
    v_mfma_f32_16x16x32_bf16 v[120:123], v[240:243], v[24:27], 0
    v_mfma_f32_16x16x32_bf16 v[124:127], v[240:243], v[28:31], 0
    s_barrier
    ds_read_b64_tr_b16 v[232:233], v4 offset:16384
    ds_read_b64_tr_b16 v[234:235], v4 offset:17408
    s_waitcnt lgkmcnt(6)
    v_mfma_f32_16x16x32_bf16 v[128:131], v[244:247], v[24:27], 0
    s_add_u32 s22, s24, 0x280000
    s_add_u32 m0, s20, 0x24000
    s_nop 0
    buffer_load_dwordx4 v3, s[4:7], s22 offen lds
    ds_read_b64_tr_b16 v[236:237], v5 offset:16416
    v_mfma_f32_16x16x32_bf16 v[132:135], v[244:247], v[28:31], 0
    ds_read_b64_tr_b16 v[238:239], v5 offset:17440
    s_waitcnt lgkmcnt(6)
    v_mfma_f32_16x16x32_bf16 v[136:139], v[224:227], v[24:27], 0
    ds_read_b64_tr_b16 v[240:241], v4 offset:16640
    v_mfma_f32_16x16x32_bf16 v[140:143], v[224:227], v[28:31], 0
    s_add_u32 s22, s24, 0x282000
    s_add_u32 m0, s20, 0x24400
    s_nop 0
    buffer_load_dwordx4 v3, s[4:7], s22 offen lds
    ds_read_b64_tr_b16 v[242:243], v4 offset:17664
    s_waitcnt lgkmcnt(6)
    v_mfma_f32_16x16x32_bf16 v[144:147], v[228:231], v[24:27], 0
    ds_read_b64_tr_b16 v[244:245], v5 offset:16672
    v_mfma_f32_16x16x32_bf16 v[148:151], v[228:231], v[28:31], 0
    ds_read_b64_tr_b16 v[246:247], v5 offset:17696
    s_waitcnt vmcnt(13) lgkmcnt(6)
    v_mfma_f32_16x16x32_bf16 v[88:91], v[232:235], v[32:35], v[88:91]
    ds_read_b64_tr_b16 v[224:225], v4 offset:16896
    s_waitcnt vmcnt(12)
    v_mfma_f32_16x16x32_bf16 v[92:95], v[232:235], v[36:39], v[92:95]
    ds_read_b64_tr_b16 v[226:227], v4 offset:17920
    s_waitcnt lgkmcnt(6)
    v_mfma_f32_16x16x32_bf16 v[96:99], v[236:239], v[32:35], v[96:99]
    ds_read_b64_tr_b16 v[228:229], v5 offset:16928
    s_mov_b32 s23, 0xa000
    buffer_load_dwordx4 v[24:27], v6, s[8:11], s23 offen offset:0 sc1
    v_mfma_f32_16x16x32_bf16 v[100:103], v[236:239], v[36:39], v[100:103]
    ds_read_b64_tr_b16 v[230:231], v5 offset:17952
    s_waitcnt lgkmcnt(6)
    v_mfma_f32_16x16x32_bf16 v[104:107], v[240:243], v[32:35], v[104:107]
    ds_read_b64_tr_b16 v[232:233], v4 offset:17152
    v_mfma_f32_16x16x32_bf16 v[108:111], v[240:243], v[36:39], v[108:111]
    ds_read_b64_tr_b16 v[234:235], v4 offset:18176
    s_mov_b32 s23, 0x2a000
    buffer_load_dwordx4 v[28:31], v6, s[8:11], s23 offen offset:0 sc1
    s_waitcnt lgkmcnt(6)
    v_mfma_f32_16x16x32_bf16 v[112:115], v[244:247], v[32:35], v[112:115]
    ds_read_b64_tr_b16 v[236:237], v5 offset:17184
    v_mfma_f32_16x16x32_bf16 v[116:119], v[244:247], v[36:39], v[116:119]
    ds_read_b64_tr_b16 v[238:239], v5 offset:18208
    s_waitcnt lgkmcnt(6)
    v_mfma_f32_16x16x32_bf16 v[120:123], v[224:227], v[32:35], v[120:123]
    v_mfma_f32_16x16x32_bf16 v[124:127], v[224:227], v[36:39], v[124:127]
    s_barrier
    ds_read_b64_tr_b16 v[240:241], v4 offset:32768
    ds_read_b64_tr_b16 v[242:243], v4 offset:33792
    s_waitcnt lgkmcnt(6)
    v_mfma_f32_16x16x32_bf16 v[128:131], v[228:231], v[32:35], v[128:131]
    s_add_u32 s22, s24, 0x300000
    s_add_u32 m0, s20, 0x10000
    s_nop 0
    buffer_load_dwordx4 v3, s[4:7], s22 offen lds
    ds_read_b64_tr_b16 v[244:245], v5 offset:32800
    v_mfma_f32_16x16x32_bf16 v[132:135], v[228:231], v[36:39], v[132:135]
    ds_read_b64_tr_b16 v[246:247], v5 offset:33824
    s_waitcnt lgkmcnt(6)
    v_mfma_f32_16x16x32_bf16 v[136:139], v[232:235], v[32:35], v[136:139]
    ds_read_b64_tr_b16 v[224:225], v4 offset:33024
    v_mfma_f32_16x16x32_bf16 v[140:143], v[232:235], v[36:39], v[140:143]
    s_add_u32 s22, s24, 0x302000
    s_add_u32 m0, s20, 0x10400
    s_nop 0
    buffer_load_dwordx4 v3, s[4:7], s22 offen lds
    ds_read_b64_tr_b16 v[226:227], v4 offset:34048
    s_waitcnt lgkmcnt(6)
    v_mfma_f32_16x16x32_bf16 v[144:147], v[236:239], v[32:35], v[144:147]
    s_add_u32 s16, s63, 0x574000
    v_mov_b32 v14, s28
    v_mov_b32 v15, 0
    s_mov_b64 exec, 1
    buffer_store_dword v14, v15, s[8:11], s16 offen sc1
    s_mov_b64 exec, -1
    ds_read_b64_tr_b16 v[228:229], v5 offset:33056
    v_mfma_f32_16x16x32_bf16 v[148:151], v[236:239], v[36:39], v[148:151]
    ds_read_b64_tr_b16 v[230:231], v5 offset:34080
    s_waitcnt vmcnt(16) lgkmcnt(6)
    v_mfma_f32_16x16x32_bf16 v[88:91], v[240:243], v[40:43], v[88:91]
    ds_read_b64_tr_b16 v[232:233], v4 offset:33280
    s_waitcnt vmcnt(15)
    v_mfma_f32_16x16x32_bf16 v[92:95], v[240:243], v[44:47], v[92:95]
    ds_read_b64_tr_b16 v[234:235], v4 offset:34304
    s_waitcnt lgkmcnt(6)
    v_mfma_f32_16x16x32_bf16 v[96:99], v[244:247], v[40:43], v[96:99]
    ds_read_b64_tr_b16 v[236:237], v5 offset:33312
    s_mov_b32 s23, 0xc000
    buffer_load_dwordx4 v[32:35], v6, s[8:11], s23 offen offset:0 sc1
    v_mfma_f32_16x16x32_bf16 v[100:103], v[244:247], v[44:47], v[100:103]
    ds_read_b64_tr_b16 v[238:239], v5 offset:34336
    s_waitcnt lgkmcnt(6)
    v_mfma_f32_16x16x32_bf16 v[104:107], v[224:227], v[40:43], v[104:107]
    ds_read_b64_tr_b16 v[240:241], v4 offset:33536
    v_mfma_f32_16x16x32_bf16 v[108:111], v[224:227], v[44:47], v[108:111]
    ds_read_b64_tr_b16 v[242:243], v4 offset:34560
    s_mov_b32 s23, 0x2c000
    buffer_load_dwordx4 v[36:39], v6, s[8:11], s23 offen offset:0 sc1
    s_waitcnt lgkmcnt(6)
    v_mfma_f32_16x16x32_bf16 v[112:115], v[228:231], v[40:43], v[112:115]
    ds_read_b64_tr_b16 v[244:245], v5 offset:33568
    v_mfma_f32_16x16x32_bf16 v[116:119], v[228:231], v[44:47], v[116:119]
    ds_read_b64_tr_b16 v[246:247], v5 offset:34592
    s_waitcnt lgkmcnt(6)
    v_mfma_f32_16x16x32_bf16 v[120:123], v[232:235], v[40:43], v[120:123]
    v_mfma_f32_16x16x32_bf16 v[124:127], v[232:235], v[44:47], v[124:127]
    s_barrier
    ds_read_b64_tr_b16 v[224:225], v4 offset:49152
    ds_read_b64_tr_b16 v[226:227], v4 offset:50176
    s_add_u32 s19, s19, 8192
    buffer_load_dword v12, v13, s[8:11], s19 offen sc1
    s_waitcnt lgkmcnt(6)
    v_mfma_f32_16x16x32_bf16 v[128:131], v[236:239], v[40:43], v[128:131]
    s_add_u32 s22, s24, 0x380000
    s_add_u32 m0, s20, 0x14000
    s_nop 0
    buffer_load_dwordx4 v3, s[4:7], s22 offen lds
    ds_read_b64_tr_b16 v[228:229], v5 offset:49184
    v_mfma_f32_16x16x32_bf16 v[132:135], v[236:239], v[44:47], v[132:135]
    ds_read_b64_tr_b16 v[230:231], v5 offset:50208
    s_waitcnt lgkmcnt(6)
    v_mfma_f32_16x16x32_bf16 v[136:139], v[240:243], v[40:43], v[136:139]
    ds_read_b64_tr_b16 v[232:233], v4 offset:49408
    v_mfma_f32_16x16x32_bf16 v[140:143], v[240:243], v[44:47], v[140:143]
    s_add_u32 s22, s24, 0x382000
    s_add_u32 m0, s20, 0x14400
    s_nop 0
    buffer_load_dwordx4 v3, s[4:7], s22 offen lds
    ds_read_b64_tr_b16 v[234:235], v4 offset:50432
    s_waitcnt lgkmcnt(6)
    v_mfma_f32_16x16x32_bf16 v[144:147], v[244:247], v[40:43], v[144:147]
    ds_read_b64_tr_b16 v[236:237], v5 offset:49440
    v_mfma_f32_16x16x32_bf16 v[148:151], v[244:247], v[44:47], v[148:151]
    ds_read_b64_tr_b16 v[238:239], v5 offset:50464
    s_waitcnt vmcnt(19) lgkmcnt(6)
    v_mfma_f32_16x16x32_bf16 v[88:91], v[224:227], v[48:51], v[88:91]
    ds_read_b64_tr_b16 v[240:241], v4 offset:49664
    s_waitcnt vmcnt(18)
    v_mfma_f32_16x16x32_bf16 v[92:95], v[224:227], v[52:55], v[92:95]
    ds_read_b64_tr_b16 v[242:243], v4 offset:50688
    s_waitcnt lgkmcnt(6)
    v_mfma_f32_16x16x32_bf16 v[96:99], v[228:231], v[48:51], v[96:99]
    ds_read_b64_tr_b16 v[244:245], v5 offset:49696
    s_mov_b32 s23, 0xe000
    buffer_load_dwordx4 v[40:43], v6, s[8:11], s23 offen offset:0 sc1
    v_mfma_f32_16x16x32_bf16 v[100:103], v[228:231], v[52:55], v[100:103]
    ds_read_b64_tr_b16 v[246:247], v5 offset:50720
    s_waitcnt lgkmcnt(6)
    v_mfma_f32_16x16x32_bf16 v[104:107], v[232:235], v[48:51], v[104:107]
    ds_read_b64_tr_b16 v[224:225], v4 offset:49920
    v_mfma_f32_16x16x32_bf16 v[108:111], v[232:235], v[52:55], v[108:111]
    ds_read_b64_tr_b16 v[226:227], v4 offset:50944
    s_mov_b32 s23, 0x2e000
    buffer_load_dwordx4 v[44:47], v6, s[8:11], s23 offen offset:0 sc1
    s_waitcnt lgkmcnt(6)
    v_mfma_f32_16x16x32_bf16 v[112:115], v[236:239], v[48:51], v[112:115]
    ds_read_b64_tr_b16 v[228:229], v5 offset:49952
    v_mfma_f32_16x16x32_bf16 v[116:119], v[236:239], v[52:55], v[116:119]
    ds_read_b64_tr_b16 v[230:231], v5 offset:50976
    s_waitcnt lgkmcnt(6)
    v_mfma_f32_16x16x32_bf16 v[120:123], v[240:243], v[48:51], v[120:123]
    v_mfma_f32_16x16x32_bf16 v[124:127], v[240:243], v[52:55], v[124:127]
    s_waitcnt vmcnt(15)
    s_barrier
    ds_read_b64_tr_b16 v[232:233], v7 offset:0
    ds_read_b64_tr_b16 v[234:235], v7 offset:1024
    s_waitcnt lgkmcnt(6)
    v_mfma_f32_16x16x32_bf16 v[128:131], v[244:247], v[48:51], v[128:131]
    s_add_u32 s22, s24, 0x10000
    s_add_u32 m0, s20, 0x18000
    s_nop 0
    buffer_load_dwordx4 v3, s[4:7], s22 offen lds
    ds_read_b64_tr_b16 v[236:237], v8 offset:32
    v_mfma_f32_16x16x32_bf16 v[132:135], v[244:247], v[52:55], v[132:135]
    ds_read_b64_tr_b16 v[238:239], v8 offset:1056
    s_waitcnt lgkmcnt(6)
    v_mfma_f32_16x16x32_bf16 v[136:139], v[224:227], v[48:51], v[136:139]
    ds_read_b64_tr_b16 v[240:241], v7 offset:256
    v_mfma_f32_16x16x32_bf16 v[140:143], v[224:227], v[52:55], v[140:143]
    s_add_u32 s22, s24, 0x12000
    s_add_u32 m0, s20, 0x18400
    s_nop 0
    buffer_load_dwordx4 v3, s[4:7], s22 offen lds
    ds_read_b64_tr_b16 v[242:243], v7 offset:1280
    s_waitcnt lgkmcnt(6)
    v_mfma_f32_16x16x32_bf16 v[144:147], v[228:231], v[48:51], v[144:147]
    ds_read_b64_tr_b16 v[244:245], v8 offset:288
    v_mfma_f32_16x16x32_bf16 v[148:151], v[228:231], v[52:55], v[148:151]
    ds_read_b64_tr_b16 v[246:247], v8 offset:1312
    s_waitcnt vmcnt(6)
    v_cmp_ne_u32 vcc, s28, v12
    s_cbranch_vccnz adaLN_cond__sliding_block_cached__moe_arch_mod__prompt_kernel_o27r
adaLN_cond__sliding_block_cached__moe_arch_mod__prompt_kernel_o27b:
    s_waitcnt lgkmcnt(6)
    v_mfma_f32_16x16x32_bf16 v[88:91], v[232:235], v[56:59], v[88:91]
    ds_read_b64_tr_b16 v[224:225], v7 offset:512
    v_mfma_f32_16x16x32_bf16 v[92:95], v[232:235], v[60:63], v[92:95]
    ds_read_b64_tr_b16 v[226:227], v7 offset:1536
    s_waitcnt lgkmcnt(6)
    v_mfma_f32_16x16x32_bf16 v[96:99], v[236:239], v[56:59], v[96:99]
    ds_read_b64_tr_b16 v[228:229], v8 offset:544
    s_mov_b32 s23, 0x0
    buffer_load_dwordx4 v[48:51], v6, s[8:11], s23 offen offset:1024 sc1
    v_mfma_f32_16x16x32_bf16 v[100:103], v[236:239], v[60:63], v[100:103]
    ds_read_b64_tr_b16 v[230:231], v8 offset:1568
    s_waitcnt lgkmcnt(6)
    v_mfma_f32_16x16x32_bf16 v[104:107], v[240:243], v[56:59], v[104:107]
    ds_read_b64_tr_b16 v[232:233], v7 offset:768
    v_mfma_f32_16x16x32_bf16 v[108:111], v[240:243], v[60:63], v[108:111]
    ds_read_b64_tr_b16 v[234:235], v7 offset:1792
    s_mov_b32 s23, 0x20000
    buffer_load_dwordx4 v[52:55], v6, s[8:11], s23 offen offset:1024 sc1
    s_waitcnt lgkmcnt(6)
    v_mfma_f32_16x16x32_bf16 v[112:115], v[244:247], v[56:59], v[112:115]
    ds_read_b64_tr_b16 v[236:237], v8 offset:800
    v_mfma_f32_16x16x32_bf16 v[116:119], v[244:247], v[60:63], v[116:119]
    ds_read_b64_tr_b16 v[238:239], v8 offset:1824
    s_waitcnt lgkmcnt(6)
    v_mfma_f32_16x16x32_bf16 v[120:123], v[224:227], v[56:59], v[120:123]
    v_mfma_f32_16x16x32_bf16 v[124:127], v[224:227], v[60:63], v[124:127]
    s_barrier
    ds_read_b64_tr_b16 v[240:241], v7 offset:16384
    ds_read_b64_tr_b16 v[242:243], v7 offset:17408
    s_waitcnt lgkmcnt(6)
    v_mfma_f32_16x16x32_bf16 v[128:131], v[228:231], v[56:59], v[128:131]
    s_add_u32 s22, s24, 0x90000
    s_add_u32 m0, s20, 0x1c000
    s_nop 0
    buffer_load_dwordx4 v3, s[4:7], s22 offen lds
    ds_read_b64_tr_b16 v[244:245], v8 offset:16416
    v_mfma_f32_16x16x32_bf16 v[132:135], v[228:231], v[60:63], v[132:135]
    ds_read_b64_tr_b16 v[246:247], v8 offset:17440
    s_waitcnt lgkmcnt(6)
    v_mfma_f32_16x16x32_bf16 v[136:139], v[232:235], v[56:59], v[136:139]
    ds_read_b64_tr_b16 v[224:225], v7 offset:16640
    v_mfma_f32_16x16x32_bf16 v[140:143], v[232:235], v[60:63], v[140:143]
    s_add_u32 s22, s24, 0x92000
    s_add_u32 m0, s20, 0x1c400
    s_nop 0
    buffer_load_dwordx4 v3, s[4:7], s22 offen lds
    ds_read_b64_tr_b16 v[226:227], v7 offset:17664
    s_waitcnt lgkmcnt(6)
    v_mfma_f32_16x16x32_bf16 v[144:147], v[236:239], v[56:59], v[144:147]
    ds_read_b64_tr_b16 v[228:229], v8 offset:16672
    v_mfma_f32_16x16x32_bf16 v[148:151], v[236:239], v[60:63], v[148:151]
    ds_read_b64_tr_b16 v[230:231], v8 offset:17696
    s_waitcnt lgkmcnt(6)
    v_mfma_f32_16x16x32_bf16 v[88:91], v[240:243], v[24:27], v[88:91]
    ds_read_b64_tr_b16 v[232:233], v7 offset:16896
    v_mfma_f32_16x16x32_bf16 v[92:95], v[240:243], v[28:31], v[92:95]
    ds_read_b64_tr_b16 v[234:235], v7 offset:17920
    s_waitcnt lgkmcnt(6)
    v_mfma_f32_16x16x32_bf16 v[96:99], v[244:247], v[24:27], v[96:99]
    ds_read_b64_tr_b16 v[236:237], v8 offset:16928
    s_mov_b32 s23, 0x2000
    buffer_load_dwordx4 v[56:59], v6, s[8:11], s23 offen offset:1024 sc1
    v_mfma_f32_16x16x32_bf16 v[100:103], v[244:247], v[28:31], v[100:103]
    ds_read_b64_tr_b16 v[238:239], v8 offset:17952
    s_waitcnt lgkmcnt(6)
    v_mfma_f32_16x16x32_bf16 v[104:107], v[224:227], v[24:27], v[104:107]
    ds_read_b64_tr_b16 v[240:241], v7 offset:17152
    v_mfma_f32_16x16x32_bf16 v[108:111], v[224:227], v[28:31], v[108:111]
    ds_read_b64_tr_b16 v[242:243], v7 offset:18176
    s_mov_b32 s23, 0x22000
    buffer_load_dwordx4 v[60:63], v6, s[8:11], s23 offen offset:1024 sc1
    s_waitcnt lgkmcnt(6)
    v_mfma_f32_16x16x32_bf16 v[112:115], v[228:231], v[24:27], v[112:115]
    ds_read_b64_tr_b16 v[244:245], v8 offset:17184
    v_mfma_f32_16x16x32_bf16 v[116:119], v[228:231], v[28:31], v[116:119]
    ds_read_b64_tr_b16 v[246:247], v8 offset:18208
    s_waitcnt lgkmcnt(6)
    v_mfma_f32_16x16x32_bf16 v[120:123], v[232:235], v[24:27], v[120:123]
    v_mfma_f32_16x16x32_bf16 v[124:127], v[232:235], v[28:31], v[124:127]
    s_barrier
    ds_read_b64_tr_b16 v[224:225], v4 offset:0
    ds_read_b64_tr_b16 v[226:227], v4 offset:1024
    s_waitcnt lgkmcnt(6)
    v_mfma_f32_16x16x32_bf16 v[128:131], v[236:239], v[24:27], v[128:131]
    s_add_u32 s16, s63, 0x576000
    v_mov_b32 v14, s28
    v_mov_b32 v15, 0
    s_mov_b64 exec, 1
    buffer_store_dword v14, v15, s[8:11], s16 offen sc1
    s_mov_b64 exec, -1
    s_add_u32 s22, s24, 0x110000
    s_add_u32 m0, s20, 0x20000
    s_nop 0
    buffer_load_dwordx4 v3, s[4:7], s22 offen lds
    ds_read_b64_tr_b16 v[228:229], v5 offset:32
    v_mfma_f32_16x16x32_bf16 v[132:135], v[236:239], v[28:31], v[132:135]
    ds_read_b64_tr_b16 v[230:231], v5 offset:1056
    s_waitcnt lgkmcnt(6)
    v_mfma_f32_16x16x32_bf16 v[136:139], v[240:243], v[24:27], v[136:139]
    ds_read_b64_tr_b16 v[232:233], v4 offset:256
    v_mfma_f32_16x16x32_bf16 v[140:143], v[240:243], v[28:31], v[140:143]
    s_add_u32 s22, s24, 0x112000
    s_add_u32 m0, s20, 0x20400
    s_nop 0
    buffer_load_dwordx4 v3, s[4:7], s22 offen lds
    ds_read_b64_tr_b16 v[234:235], v4 offset:1280
    s_waitcnt lgkmcnt(6)
    v_mfma_f32_16x16x32_bf16 v[144:147], v[244:247], v[24:27], v[144:147]
    ds_read_b64_tr_b16 v[236:237], v5 offset:288
    v_mfma_f32_16x16x32_bf16 v[148:151], v[244:247], v[28:31], v[148:151]
    ds_read_b64_tr_b16 v[238:239], v5 offset:1312
    s_waitcnt lgkmcnt(6)
    v_mfma_f32_16x16x32_bf16 v[88:91], v[224:227], v[32:35], v[88:91]
    ds_read_b64_tr_b16 v[240:241], v4 offset:512
    v_mfma_f32_16x16x32_bf16 v[92:95], v[224:227], v[36:39], v[92:95]
    ds_read_b64_tr_b16 v[242:243], v4 offset:1536
    s_waitcnt lgkmcnt(6)
    v_mfma_f32_16x16x32_bf16 v[96:99], v[228:231], v[32:35], v[96:99]
    ds_read_b64_tr_b16 v[244:245], v5 offset:544
    s_mov_b32 s23, 0x4000
    buffer_load_dwordx4 v[24:27], v6, s[8:11], s23 offen offset:1024 sc1
    v_mfma_f32_16x16x32_bf16 v[100:103], v[228:231], v[36:39], v[100:103]
    ds_read_b64_tr_b16 v[246:247], v5 offset:1568
    s_waitcnt lgkmcnt(6)
    v_mfma_f32_16x16x32_bf16 v[104:107], v[232:235], v[32:35], v[104:107]
    ds_read_b64_tr_b16 v[224:225], v4 offset:768
    v_mfma_f32_16x16x32_bf16 v[108:111], v[232:235], v[36:39], v[108:111]
    ds_read_b64_tr_b16 v[226:227], v4 offset:1792
    s_mov_b32 s23, 0x24000
    buffer_load_dwordx4 v[28:31], v6, s[8:11], s23 offen offset:1024 sc1
    s_waitcnt lgkmcnt(6)
    v_mfma_f32_16x16x32_bf16 v[112:115], v[236:239], v[32:35], v[112:115]
    ds_read_b64_tr_b16 v[228:229], v5 offset:800
    v_mfma_f32_16x16x32_bf16 v[116:119], v[236:239], v[36:39], v[116:119]
    ds_read_b64_tr_b16 v[230:231], v5 offset:1824
    s_waitcnt lgkmcnt(6)
    v_mfma_f32_16x16x32_bf16 v[120:123], v[240:243], v[32:35], v[120:123]
    v_mfma_f32_16x16x32_bf16 v[124:127], v[240:243], v[36:39], v[124:127]
    s_waitcnt vmcnt(15)
    s_barrier
    ds_read_b64_tr_b16 v[232:233], v4 offset:16384
    ds_read_b64_tr_b16 v[234:235], v4 offset:17408
    s_waitcnt lgkmcnt(6)
    v_mfma_f32_16x16x32_bf16 v[128:131], v[244:247], v[32:35], v[128:131]
    s_add_u32 s22, s24, 0x190000
    s_add_u32 m0, s20, 0x24000
    s_nop 0
    buffer_load_dwordx4 v3, s[4:7], s22 offen lds
    ds_read_b64_tr_b16 v[236:237], v5 offset:16416
    v_mfma_f32_16x16x32_bf16 v[132:135], v[244:247], v[36:39], v[132:135]
    ds_read_b64_tr_b16 v[238:239], v5 offset:17440
    s_waitcnt lgkmcnt(6)
    v_mfma_f32_16x16x32_bf16 v[136:139], v[224:227], v[32:35], v[136:139]
    ds_read_b64_tr_b16 v[240:241], v4 offset:16640
    v_mfma_f32_16x16x32_bf16 v[140:143], v[224:227], v[36:39], v[140:143]
    s_add_u32 s22, s24, 0x192000
    s_add_u32 m0, s20, 0x24400
    s_nop 0
    buffer_load_dwordx4 v3, s[4:7], s22 offen lds
    ds_read_b64_tr_b16 v[242:243], v4 offset:17664
    s_waitcnt lgkmcnt(6)
    v_mfma_f32_16x16x32_bf16 v[144:147], v[228:231], v[32:35], v[144:147]
    ds_read_b64_tr_b16 v[244:245], v5 offset:16672
    v_mfma_f32_16x16x32_bf16 v[148:151], v[228:231], v[36:39], v[148:151]
    ds_read_b64_tr_b16 v[246:247], v5 offset:17696
    s_waitcnt vmcnt(16) lgkmcnt(6)
    v_mfma_f32_16x16x32_bf16 v[88:91], v[232:235], v[40:43], v[88:91]
    ds_read_b64_tr_b16 v[224:225], v4 offset:16896
    s_waitcnt vmcnt(15)
    v_mfma_f32_16x16x32_bf16 v[92:95], v[232:235], v[44:47], v[92:95]
    ds_read_b64_tr_b16 v[226:227], v4 offset:17920
    s_waitcnt lgkmcnt(6)
    v_mfma_f32_16x16x32_bf16 v[96:99], v[236:239], v[40:43], v[96:99]
    ds_read_b64_tr_b16 v[228:229], v5 offset:16928
    s_mov_b32 s23, 0x6000
    buffer_load_dwordx4 v[32:35], v6, s[8:11], s23 offen offset:1024 sc1
    v_mfma_f32_16x16x32_bf16 v[100:103], v[236:239], v[44:47], v[100:103]
    ds_read_b64_tr_b16 v[230:231], v5 offset:17952
    s_waitcnt lgkmcnt(6)
    v_mfma_f32_16x16x32_bf16 v[104:107], v[240:243], v[40:43], v[104:107]
    ds_read_b64_tr_b16 v[232:233], v4 offset:17152
    v_mfma_f32_16x16x32_bf16 v[108:111], v[240:243], v[44:47], v[108:111]
    ds_read_b64_tr_b16 v[234:235], v4 offset:18176
    s_mov_b32 s23, 0x26000
    buffer_load_dwordx4 v[36:39], v6, s[8:11], s23 offen offset:1024 sc1
    s_waitcnt lgkmcnt(6)
    v_mfma_f32_16x16x32_bf16 v[112:115], v[244:247], v[40:43], v[112:115]
    ds_read_b64_tr_b16 v[236:237], v5 offset:17184
    v_mfma_f32_16x16x32_bf16 v[116:119], v[244:247], v[44:47], v[116:119]
    ds_read_b64_tr_b16 v[238:239], v5 offset:18208
    s_waitcnt lgkmcnt(6)
    v_mfma_f32_16x16x32_bf16 v[120:123], v[224:227], v[40:43], v[120:123]
    v_mfma_f32_16x16x32_bf16 v[124:127], v[224:227], v[44:47], v[124:127]
    s_waitcnt vmcnt(15)
    s_barrier
    ds_read_b64_tr_b16 v[240:241], v4 offset:32768
    ds_read_b64_tr_b16 v[242:243], v4 offset:33792
    s_waitcnt lgkmcnt(6)
    v_mfma_f32_16x16x32_bf16 v[128:131], v[228:231], v[40:43], v[128:131]
    s_add_u32 s22, s24, 0x210000
    s_add_u32 m0, s20, 0x10000
    s_nop 0
    buffer_load_dwordx4 v3, s[4:7], s22 offen lds
    ds_read_b64_tr_b16 v[244:245], v5 offset:32800
    v_mfma_f32_16x16x32_bf16 v[132:135], v[228:231], v[44:47], v[132:135]
    ds_read_b64_tr_b16 v[246:247], v5 offset:33824
    s_waitcnt lgkmcnt(6)
    v_mfma_f32_16x16x32_bf16 v[136:139], v[232:235], v[40:43], v[136:139]
    ds_read_b64_tr_b16 v[224:225], v4 offset:33024
    v_mfma_f32_16x16x32_bf16 v[140:143], v[232:235], v[44:47], v[140:143]
    s_add_u32 s22, s24, 0x212000
    s_add_u32 m0, s20, 0x10400
    s_nop 0
    buffer_load_dwordx4 v3, s[4:7], s22 offen lds
    ds_read_b64_tr_b16 v[226:227], v4 offset:34048
    s_waitcnt lgkmcnt(6)
    v_mfma_f32_16x16x32_bf16 v[144:147], v[236:239], v[40:43], v[144:147]
    ds_read_b64_tr_b16 v[228:229], v5 offset:33056
    v_mfma_f32_16x16x32_bf16 v[148:151], v[236:239], v[44:47], v[148:151]
    ds_read_b64_tr_b16 v[230:231], v5 offset:34080
    s_waitcnt vmcnt(16) lgkmcnt(6)
    v_mfma_f32_16x16x32_bf16 v[88:91], v[240:243], v[48:51], v[88:91]
    ds_read_b64_tr_b16 v[232:233], v4 offset:33280
    s_waitcnt vmcnt(15)
    v_mfma_f32_16x16x32_bf16 v[92:95], v[240:243], v[52:55], v[92:95]
    ds_read_b64_tr_b16 v[234:235], v4 offset:34304
    s_waitcnt lgkmcnt(6)
    v_mfma_f32_16x16x32_bf16 v[96:99], v[244:247], v[48:51], v[96:99]
    ds_read_b64_tr_b16 v[236:237], v5 offset:33312
    s_mov_b32 s23, 0x8000
    buffer_load_dwordx4 v[40:43], v6, s[8:11], s23 offen offset:1024 sc1
    v_mfma_f32_16x16x32_bf16 v[100:103], v[244:247], v[52:55], v[100:103]
    ds_read_b64_tr_b16 v[238:239], v5 offset:34336
    s_waitcnt lgkmcnt(6)
    v_mfma_f32_16x16x32_bf16 v[104:107], v[224:227], v[48:51], v[104:107]
    ds_read_b64_tr_b16 v[240:241], v4 offset:33536
    v_mfma_f32_16x16x32_bf16 v[108:111], v[224:227], v[52:55], v[108:111]
    ds_read_b64_tr_b16 v[242:243], v4 offset:34560
    s_mov_b32 s23, 0x28000
    buffer_load_dwordx4 v[44:47], v6, s[8:11], s23 offen offset:1024 sc1
    s_waitcnt lgkmcnt(6)
    v_mfma_f32_16x16x32_bf16 v[112:115], v[228:231], v[48:51], v[112:115]
    ds_read_b64_tr_b16 v[244:245], v5 offset:33568
    v_mfma_f32_16x16x32_bf16 v[116:119], v[228:231], v[52:55], v[116:119]
    ds_read_b64_tr_b16 v[246:247], v5 offset:34592
    s_waitcnt lgkmcnt(6)
    v_mfma_f32_16x16x32_bf16 v[120:123], v[232:235], v[48:51], v[120:123]
    v_mfma_f32_16x16x32_bf16 v[124:127], v[232:235], v[52:55], v[124:127]
    s_waitcnt vmcnt(15)
    s_barrier
    ds_read_b64_tr_b16 v[224:225], v4 offset:49152
    ds_read_b64_tr_b16 v[226:227], v4 offset:50176
    s_waitcnt lgkmcnt(6)
    v_mfma_f32_16x16x32_bf16 v[128:131], v[236:239], v[48:51], v[128:131]
    s_add_u32 s22, s24, 0x290000
    s_add_u32 m0, s20, 0x14000
    s_nop 0
    buffer_load_dwordx4 v3, s[4:7], s22 offen lds
    ds_read_b64_tr_b16 v[228:229], v5 offset:49184
    v_mfma_f32_16x16x32_bf16 v[132:135], v[236:239], v[52:55], v[132:135]
    ds_read_b64_tr_b16 v[230:231], v5 offset:50208
    s_waitcnt lgkmcnt(6)
    v_mfma_f32_16x16x32_bf16 v[136:139], v[240:243], v[48:51], v[136:139]
    ds_read_b64_tr_b16 v[232:233], v4 offset:49408
    v_mfma_f32_16x16x32_bf16 v[140:143], v[240:243], v[52:55], v[140:143]
    s_add_u32 s22, s24, 0x292000
    s_add_u32 m0, s20, 0x14400
    s_nop 0
    buffer_load_dwordx4 v3, s[4:7], s22 offen lds
    ds_read_b64_tr_b16 v[234:235], v4 offset:50432
    s_waitcnt lgkmcnt(6)
    v_mfma_f32_16x16x32_bf16 v[144:147], v[244:247], v[48:51], v[144:147]
    ds_read_b64_tr_b16 v[236:237], v5 offset:49440
    v_mfma_f32_16x16x32_bf16 v[148:151], v[244:247], v[52:55], v[148:151]
    ds_read_b64_tr_b16 v[238:239], v5 offset:50464
    s_waitcnt vmcnt(16) lgkmcnt(6)
    v_mfma_f32_16x16x32_bf16 v[88:91], v[224:227], v[56:59], v[88:91]
    ds_read_b64_tr_b16 v[240:241], v4 offset:49664
    s_waitcnt vmcnt(15)
    v_mfma_f32_16x16x32_bf16 v[92:95], v[224:227], v[60:63], v[92:95]
    ds_read_b64_tr_b16 v[242:243], v4 offset:50688
    s_waitcnt lgkmcnt(6)
    v_mfma_f32_16x16x32_bf16 v[96:99], v[228:231], v[56:59], v[96:99]
    ds_read_b64_tr_b16 v[244:245], v5 offset:49696
    s_mov_b32 s23, 0xa000
    buffer_load_dwordx4 v[48:51], v6, s[8:11], s23 offen offset:1024 sc1
    v_mfma_f32_16x16x32_bf16 v[100:103], v[228:231], v[60:63], v[100:103]
    ds_read_b64_tr_b16 v[246:247], v5 offset:50720
    s_waitcnt lgkmcnt(6)
    v_mfma_f32_16x16x32_bf16 v[104:107], v[232:235], v[56:59], v[104:107]
    ds_read_b64_tr_b16 v[224:225], v4 offset:49920
    v_mfma_f32_16x16x32_bf16 v[108:111], v[232:235], v[60:63], v[108:111]
    ds_read_b64_tr_b16 v[226:227], v4 offset:50944
    s_mov_b32 s23, 0x2a000
    buffer_load_dwordx4 v[52:55], v6, s[8:11], s23 offen offset:1024 sc1
    s_waitcnt lgkmcnt(6)
    v_mfma_f32_16x16x32_bf16 v[112:115], v[236:239], v[56:59], v[112:115]
    ds_read_b64_tr_b16 v[228:229], v5 offset:49952
    v_mfma_f32_16x16x32_bf16 v[116:119], v[236:239], v[60:63], v[116:119]
    ds_read_b64_tr_b16 v[230:231], v5 offset:50976
    s_waitcnt lgkmcnt(6)
    v_mfma_f32_16x16x32_bf16 v[120:123], v[240:243], v[56:59], v[120:123]
    v_mfma_f32_16x16x32_bf16 v[124:127], v[240:243], v[60:63], v[124:127]
    s_waitcnt vmcnt(14)
    s_barrier
    ds_read_b64_tr_b16 v[232:233], v7 offset:0
    ds_read_b64_tr_b16 v[234:235], v7 offset:1024
    s_waitcnt lgkmcnt(6)
    v_mfma_f32_16x16x32_bf16 v[128:131], v[244:247], v[56:59], v[128:131]
    s_add_u32 s22, s24, 0x310000
    s_add_u32 m0, s20, 0x18000
    s_nop 0
    buffer_load_dwordx4 v3, s[4:7], s22 offen lds
    ds_read_b64_tr_b16 v[236:237], v8 offset:32
    v_mfma_f32_16x16x32_bf16 v[132:135], v[244:247], v[60:63], v[132:135]
    ds_read_b64_tr_b16 v[238:239], v8 offset:1056
    s_waitcnt lgkmcnt(6)
    v_mfma_f32_16x16x32_bf16 v[136:139], v[224:227], v[56:59], v[136:139]
    ds_read_b64_tr_b16 v[240:241], v7 offset:256
    v_mfma_f32_16x16x32_bf16 v[140:143], v[224:227], v[60:63], v[140:143]
    s_add_u32 s22, s24, 0x312000
    s_add_u32 m0, s20, 0x18400
    s_nop 0
    buffer_load_dwordx4 v3, s[4:7], s22 offen lds
    ds_read_b64_tr_b16 v[242:243], v7 offset:1280
    s_waitcnt lgkmcnt(6)
    v_mfma_f32_16x16x32_bf16 v[144:147], v[228:231], v[56:59], v[144:147]
    ds_read_b64_tr_b16 v[244:245], v8 offset:288
    v_mfma_f32_16x16x32_bf16 v[148:151], v[228:231], v[60:63], v[148:151]
    ds_read_b64_tr_b16 v[246:247], v8 offset:1312
    s_waitcnt vmcnt(15) lgkmcnt(6)
    v_mfma_f32_16x16x32_bf16 v[88:91], v[232:235], v[24:27], v[88:91]
    ds_read_b64_tr_b16 v[224:225], v7 offset:512
    s_waitcnt vmcnt(14)
    v_mfma_f32_16x16x32_bf16 v[92:95], v[232:235], v[28:31], v[92:95]
    ds_read_b64_tr_b16 v[226:227], v7 offset:1536
    s_waitcnt lgkmcnt(6)
    v_mfma_f32_16x16x32_bf16 v[96:99], v[236:239], v[24:27], v[96:99]
    ds_read_b64_tr_b16 v[228:229], v8 offset:544
    s_mov_b32 s23, 0xc000
    buffer_load_dwordx4 v[56:59], v6, s[8:11], s23 offen offset:1024 sc1
    v_mfma_f32_16x16x32_bf16 v[100:103], v[236:239], v[28:31], v[100:103]
    ds_read_b64_tr_b16 v[230:231], v8 offset:1568
    s_waitcnt lgkmcnt(6)
    v_mfma_f32_16x16x32_bf16 v[104:107], v[240:243], v[24:27], v[104:107]
    ds_read_b64_tr_b16 v[232:233], v7 offset:768
    v_mfma_f32_16x16x32_bf16 v[108:111], v[240:243], v[28:31], v[108:111]
    ds_read_b64_tr_b16 v[234:235], v7 offset:1792
    s_mov_b32 s23, 0x2c000
    buffer_load_dwordx4 v[60:63], v6, s[8:11], s23 offen offset:1024 sc1
    s_waitcnt lgkmcnt(6)
    v_mfma_f32_16x16x32_bf16 v[112:115], v[244:247], v[24:27], v[112:115]
    ds_read_b64_tr_b16 v[236:237], v8 offset:800
    v_mfma_f32_16x16x32_bf16 v[116:119], v[244:247], v[28:31], v[116:119]
    ds_read_b64_tr_b16 v[238:239], v8 offset:1824
    s_waitcnt lgkmcnt(6)
    v_mfma_f32_16x16x32_bf16 v[120:123], v[224:227], v[24:27], v[120:123]
    v_mfma_f32_16x16x32_bf16 v[124:127], v[224:227], v[28:31], v[124:127]
    s_waitcnt vmcnt(14)
    s_barrier
    ds_read_b64_tr_b16 v[240:241], v7 offset:16384
    ds_read_b64_tr_b16 v[242:243], v7 offset:17408
    s_add_u32 s19, s19, 8192
    buffer_load_dword v12, v13, s[8:11], s19 offen sc1
    s_waitcnt lgkmcnt(6)
    v_mfma_f32_16x16x32_bf16 v[128:131], v[228:231], v[24:27], v[128:131]
    s_add_u32 s22, s24, 0x390000
    s_add_u32 m0, s20, 0x1c000
    s_nop 0
    buffer_load_dwordx4 v3, s[4:7], s22 offen lds
    ds_read_b64_tr_b16 v[244:245], v8 offset:16416
    v_mfma_f32_16x16x32_bf16 v[132:135], v[228:231], v[28:31], v[132:135]
    ds_read_b64_tr_b16 v[246:247], v8 offset:17440
    s_waitcnt lgkmcnt(6)
    v_mfma_f32_16x16x32_bf16 v[136:139], v[232:235], v[24:27], v[136:139]
    ds_read_b64_tr_b16 v[224:225], v7 offset:16640
    v_mfma_f32_16x16x32_bf16 v[140:143], v[232:235], v[28:31], v[140:143]
    s_add_u32 s22, s24, 0x392000
    s_add_u32 m0, s20, 0x1c400
    s_nop 0
    buffer_load_dwordx4 v3, s[4:7], s22 offen lds
    ds_read_b64_tr_b16 v[226:227], v7 offset:17664
    s_waitcnt lgkmcnt(6)
    v_mfma_f32_16x16x32_bf16 v[144:147], v[236:239], v[24:27], v[144:147]
    ds_read_b64_tr_b16 v[228:229], v8 offset:16672
    v_mfma_f32_16x16x32_bf16 v[148:151], v[236:239], v[28:31], v[148:151]
    ds_read_b64_tr_b16 v[230:231], v8 offset:17696
    s_waitcnt vmcnt(16) lgkmcnt(6)
    v_mfma_f32_16x16x32_bf16 v[88:91], v[240:243], v[32:35], v[88:91]
    ds_read_b64_tr_b16 v[232:233], v7 offset:16896
    s_waitcnt vmcnt(15)
    v_mfma_f32_16x16x32_bf16 v[92:95], v[240:243], v[36:39], v[92:95]
    ds_read_b64_tr_b16 v[234:235], v7 offset:17920
    s_waitcnt lgkmcnt(6)
    v_mfma_f32_16x16x32_bf16 v[96:99], v[244:247], v[32:35], v[96:99]
    ds_read_b64_tr_b16 v[236:237], v8 offset:16928
    s_mov_b32 s23, 0xe000
    buffer_load_dwordx4 v[24:27], v6, s[8:11], s23 offen offset:1024 sc1
    v_mfma_f32_16x16x32_bf16 v[100:103], v[244:247], v[36:39], v[100:103]
    ds_read_b64_tr_b16 v[238:239], v8 offset:17952
    s_waitcnt lgkmcnt(6)
    v_mfma_f32_16x16x32_bf16 v[104:107], v[224:227], v[32:35], v[104:107]
    ds_read_b64_tr_b16 v[240:241], v7 offset:17152
    v_mfma_f32_16x16x32_bf16 v[108:111], v[224:227], v[36:39], v[108:111]
    ds_read_b64_tr_b16 v[242:243], v7 offset:18176
    s_mov_b32 s23, 0x2e000
    buffer_load_dwordx4 v[28:31], v6, s[8:11], s23 offen offset:1024 sc1
    s_waitcnt lgkmcnt(6)
    v_mfma_f32_16x16x32_bf16 v[112:115], v[228:231], v[32:35], v[112:115]
    ds_read_b64_tr_b16 v[244:245], v8 offset:17184
    v_mfma_f32_16x16x32_bf16 v[116:119], v[228:231], v[36:39], v[116:119]
    ds_read_b64_tr_b16 v[246:247], v8 offset:18208
    s_waitcnt lgkmcnt(6)
    v_mfma_f32_16x16x32_bf16 v[120:123], v[232:235], v[32:35], v[120:123]
    v_mfma_f32_16x16x32_bf16 v[124:127], v[232:235], v[36:39], v[124:127]
    s_waitcnt vmcnt(15)
    s_barrier
    ds_read_b64_tr_b16 v[224:225], v4 offset:0
    ds_read_b64_tr_b16 v[226:227], v4 offset:1024
    s_waitcnt lgkmcnt(6)
    v_mfma_f32_16x16x32_bf16 v[128:131], v[236:239], v[32:35], v[128:131]
    s_add_u32 s22, s24, 0x20000
    s_add_u32 m0, s20, 0x20000
    s_nop 0
    buffer_load_dwordx4 v3, s[4:7], s22 offen lds
    ds_read_b64_tr_b16 v[228:229], v5 offset:32
    v_mfma_f32_16x16x32_bf16 v[132:135], v[236:239], v[36:39], v[132:135]
    ds_read_b64_tr_b16 v[230:231], v5 offset:1056
    s_waitcnt lgkmcnt(6)
    v_mfma_f32_16x16x32_bf16 v[136:139], v[240:243], v[32:35], v[136:139]
    ds_read_b64_tr_b16 v[232:233], v4 offset:256
    v_mfma_f32_16x16x32_bf16 v[140:143], v[240:243], v[36:39], v[140:143]
    s_add_u32 s22, s24, 0x22000
    s_add_u32 m0, s20, 0x20400
    s_nop 0
    buffer_load_dwordx4 v3, s[4:7], s22 offen lds
    ds_read_b64_tr_b16 v[234:235], v4 offset:1280
    s_waitcnt lgkmcnt(6)
    v_mfma_f32_16x16x32_bf16 v[144:147], v[244:247], v[32:35], v[144:147]
    ds_read_b64_tr_b16 v[236:237], v5 offset:288
    v_mfma_f32_16x16x32_bf16 v[148:151], v[244:247], v[36:39], v[148:151]
    ds_read_b64_tr_b16 v[238:239], v5 offset:1312
    s_waitcnt vmcnt(6)
    v_cmp_ne_u32 vcc, s28, v12
    s_cbranch_vccnz adaLN_cond__sliding_block_cached__moe_arch_mod__prompt_kernel_o28r
adaLN_cond__sliding_block_cached__moe_arch_mod__prompt_kernel_o28b:
    s_waitcnt lgkmcnt(6)
    v_mfma_f32_16x16x32_bf16 v[88:91], v[224:227], v[40:43], v[88:91]
    ds_read_b64_tr_b16 v[240:241], v4 offset:512
    v_mfma_f32_16x16x32_bf16 v[92:95], v[224:227], v[44:47], v[92:95]
    ds_read_b64_tr_b16 v[242:243], v4 offset:1536
    s_waitcnt lgkmcnt(6)
    v_mfma_f32_16x16x32_bf16 v[96:99], v[228:231], v[40:43], v[96:99]
    ds_read_b64_tr_b16 v[244:245], v5 offset:544
    s_mov_b32 s23, 0x0
    buffer_load_dwordx4 v[32:35], v6, s[8:11], s23 offen offset:2048 sc1
    v_mfma_f32_16x16x32_bf16 v[100:103], v[228:231], v[44:47], v[100:103]
    ds_read_b64_tr_b16 v[246:247], v5 offset:1568
    s_waitcnt lgkmcnt(6)
    v_mfma_f32_16x16x32_bf16 v[104:107], v[232:235], v[40:43], v[104:107]
    ds_read_b64_tr_b16 v[224:225], v4 offset:768
    v_mfma_f32_16x16x32_bf16 v[108:111], v[232:235], v[44:47], v[108:111]
    ds_read_b64_tr_b16 v[226:227], v4 offset:1792
    s_mov_b32 s23, 0x20000
    buffer_load_dwordx4 v[36:39], v6, s[8:11], s23 offen offset:2048 sc1
    s_waitcnt lgkmcnt(6)
    v_mfma_f32_16x16x32_bf16 v[112:115], v[236:239], v[40:43], v[112:115]
    ds_read_b64_tr_b16 v[228:229], v5 offset:800
    v_mfma_f32_16x16x32_bf16 v[116:119], v[236:239], v[44:47], v[116:119]
    ds_read_b64_tr_b16 v[230:231], v5 offset:1824
    s_waitcnt lgkmcnt(6)
    v_mfma_f32_16x16x32_bf16 v[120:123], v[240:243], v[40:43], v[120:123]
    v_mfma_f32_16x16x32_bf16 v[124:127], v[240:243], v[44:47], v[124:127]
    s_barrier
    ds_read_b64_tr_b16 v[232:233], v4 offset:16384
    ds_read_b64_tr_b16 v[234:235], v4 offset:17408
    s_waitcnt lgkmcnt(6)
    v_mfma_f32_16x16x32_bf16 v[128:131], v[244:247], v[40:43], v[128:131]
    s_add_u32 s22, s24, 0xa0000
    s_add_u32 m0, s20, 0x24000
    s_nop 0
    buffer_load_dwordx4 v3, s[4:7], s22 offen lds
    ds_read_b64_tr_b16 v[236:237], v5 offset:16416
    v_mfma_f32_16x16x32_bf16 v[132:135], v[244:247], v[44:47], v[132:135]
    ds_read_b64_tr_b16 v[238:239], v5 offset:17440
    s_waitcnt lgkmcnt(6)
    v_mfma_f32_16x16x32_bf16 v[136:139], v[224:227], v[40:43], v[136:139]
    ds_read_b64_tr_b16 v[240:241], v4 offset:16640
    v_mfma_f32_16x16x32_bf16 v[140:143], v[224:227], v[44:47], v[140:143]
    s_add_u32 s22, s24, 0xa2000
    s_add_u32 m0, s20, 0x24400
    s_nop 0
    buffer_load_dwordx4 v3, s[4:7], s22 offen lds
    ds_read_b64_tr_b16 v[242:243], v4 offset:17664
    s_waitcnt lgkmcnt(6)
    v_mfma_f32_16x16x32_bf16 v[144:147], v[228:231], v[40:43], v[144:147]
    ds_read_b64_tr_b16 v[244:245], v5 offset:16672
    v_mfma_f32_16x16x32_bf16 v[148:151], v[228:231], v[44:47], v[148:151]
    ds_read_b64_tr_b16 v[246:247], v5 offset:17696
    s_waitcnt lgkmcnt(6)
    v_mfma_f32_16x16x32_bf16 v[88:91], v[232:235], v[48:51], v[88:91]
    ds_read_b64_tr_b16 v[224:225], v4 offset:16896
    v_mfma_f32_16x16x32_bf16 v[92:95], v[232:235], v[52:55], v[92:95]
    ds_read_b64_tr_b16 v[226:227], v4 offset:17920
    s_waitcnt lgkmcnt(6)
    v_mfma_f32_16x16x32_bf16 v[96:99], v[236:239], v[48:51], v[96:99]
    ds_read_b64_tr_b16 v[228:229], v5 offset:16928
    s_mov_b32 s23, 0x2000
    buffer_load_dwordx4 v[40:43], v6, s[8:11], s23 offen offset:2048 sc1
    v_mfma_f32_16x16x32_bf16 v[100:103], v[236:239], v[52:55], v[100:103]
    ds_read_b64_tr_b16 v[230:231], v5 offset:17952
    s_waitcnt lgkmcnt(6)
    v_mfma_f32_16x16x32_bf16 v[104:107], v[240:243], v[48:51], v[104:107]
    ds_read_b64_tr_b16 v[232:233], v4 offset:17152
    v_mfma_f32_16x16x32_bf16 v[108:111], v[240:243], v[52:55], v[108:111]
    ds_read_b64_tr_b16 v[234:235], v4 offset:18176
    s_mov_b32 s23, 0x22000
    buffer_load_dwordx4 v[44:47], v6, s[8:11], s23 offen offset:2048 sc1
    s_waitcnt lgkmcnt(6)
    v_mfma_f32_16x16x32_bf16 v[112:115], v[244:247], v[48:51], v[112:115]
    ds_read_b64_tr_b16 v[236:237], v5 offset:17184
    v_mfma_f32_16x16x32_bf16 v[116:119], v[244:247], v[52:55], v[116:119]
    ds_read_b64_tr_b16 v[238:239], v5 offset:18208
    s_waitcnt lgkmcnt(6)
    v_mfma_f32_16x16x32_bf16 v[120:123], v[224:227], v[48:51], v[120:123]
    v_mfma_f32_16x16x32_bf16 v[124:127], v[224:227], v[52:55], v[124:127]
    s_barrier
    ds_read_b64_tr_b16 v[240:241], v4 offset:32768
    ds_read_b64_tr_b16 v[242:243], v4 offset:33792
    s_waitcnt lgkmcnt(6)
    v_mfma_f32_16x16x32_bf16 v[128:131], v[228:231], v[48:51], v[128:131]
    s_add_u32 s22, s24, 0x120000
    s_add_u32 m0, s20, 0x10000
    s_nop 0
    buffer_load_dwordx4 v3, s[4:7], s22 offen lds
    ds_read_b64_tr_b16 v[244:245], v5 offset:32800
    v_mfma_f32_16x16x32_bf16 v[132:135], v[228:231], v[52:55], v[132:135]
    ds_read_b64_tr_b16 v[246:247], v5 offset:33824
    s_waitcnt lgkmcnt(6)
    v_mfma_f32_16x16x32_bf16 v[136:139], v[232:235], v[48:51], v[136:139]
    ds_read_b64_tr_b16 v[224:225], v4 offset:33024
    v_mfma_f32_16x16x32_bf16 v[140:143], v[232:235], v[52:55], v[140:143]
    s_add_u32 s22, s24, 0x122000
    s_add_u32 m0, s20, 0x10400
    s_nop 0
    buffer_load_dwordx4 v3, s[4:7], s22 offen lds
    ds_read_b64_tr_b16 v[226:227], v4 offset:34048
    s_waitcnt lgkmcnt(6)
    v_mfma_f32_16x16x32_bf16 v[144:147], v[236:239], v[48:51], v[144:147]
    ds_read_b64_tr_b16 v[228:229], v5 offset:33056
    v_mfma_f32_16x16x32_bf16 v[148:151], v[236:239], v[52:55], v[148:151]
    ds_read_b64_tr_b16 v[230:231], v5 offset:34080
    s_waitcnt lgkmcnt(6)
    v_mfma_f32_16x16x32_bf16 v[88:91], v[240:243], v[56:59], v[88:91]
    ds_read_b64_tr_b16 v[232:233], v4 offset:33280
    v_mfma_f32_16x16x32_bf16 v[92:95], v[240:243], v[60:63], v[92:95]
    ds_read_b64_tr_b16 v[234:235], v4 offset:34304
    s_waitcnt lgkmcnt(6)
    v_mfma_f32_16x16x32_bf16 v[96:99], v[244:247], v[56:59], v[96:99]
    ds_read_b64_tr_b16 v[236:237], v5 offset:33312
    s_mov_b32 s23, 0x4000
    buffer_load_dwordx4 v[48:51], v6, s[8:11], s23 offen offset:2048 sc1
    v_mfma_f32_16x16x32_bf16 v[100:103], v[244:247], v[60:63], v[100:103]
    ds_read_b64_tr_b16 v[238:239], v5 offset:34336
    s_waitcnt lgkmcnt(6)
    v_mfma_f32_16x16x32_bf16 v[104:107], v[224:227], v[56:59], v[104:107]
    ds_read_b64_tr_b16 v[240:241], v4 offset:33536
    v_mfma_f32_16x16x32_bf16 v[108:111], v[224:227], v[60:63], v[108:111]
    ds_read_b64_tr_b16 v[242:243], v4 offset:34560
    s_mov_b32 s23, 0x24000
    buffer_load_dwordx4 v[52:55], v6, s[8:11], s23 offen offset:2048 sc1
    s_waitcnt lgkmcnt(6)
    v_mfma_f32_16x16x32_bf16 v[112:115], v[228:231], v[56:59], v[112:115]
    ds_read_b64_tr_b16 v[244:245], v5 offset:33568
    v_mfma_f32_16x16x32_bf16 v[116:119], v[228:231], v[60:63], v[116:119]
    ds_read_b64_tr_b16 v[246:247], v5 offset:34592
    s_waitcnt lgkmcnt(6)
    v_mfma_f32_16x16x32_bf16 v[120:123], v[232:235], v[56:59], v[120:123]
    v_mfma_f32_16x16x32_bf16 v[124:127], v[232:235], v[60:63], v[124:127]
    s_waitcnt vmcnt(14)
    s_barrier
    ds_read_b64_tr_b16 v[224:225], v4 offset:49152
    ds_read_b64_tr_b16 v[226:227], v4 offset:50176
    s_waitcnt lgkmcnt(6)
    v_mfma_f32_16x16x32_bf16 v[128:131], v[236:239], v[56:59], v[128:131]
    s_add_u32 s22, s24, 0x1a0000
    s_add_u32 m0, s20, 0x14000
    s_nop 0
    buffer_load_dwordx4 v3, s[4:7], s22 offen lds
    ds_read_b64_tr_b16 v[228:229], v5 offset:49184
    v_mfma_f32_16x16x32_bf16 v[132:135], v[236:239], v[60:63], v[132:135]
    ds_read_b64_tr_b16 v[230:231], v5 offset:50208
    s_waitcnt lgkmcnt(6)
    v_mfma_f32_16x16x32_bf16 v[136:139], v[240:243], v[56:59], v[136:139]
    ds_read_b64_tr_b16 v[232:233], v4 offset:49408
    v_mfma_f32_16x16x32_bf16 v[140:143], v[240:243], v[60:63], v[140:143]
    s_add_u32 s22, s24, 0x1a2000
    s_add_u32 m0, s20, 0x14400
    s_nop 0
    buffer_load_dwordx4 v3, s[4:7], s22 offen lds
    ds_read_b64_tr_b16 v[234:235], v4 offset:50432
    s_waitcnt lgkmcnt(6)
    v_mfma_f32_16x16x32_bf16 v[144:147], v[244:247], v[56:59], v[144:147]
    ds_read_b64_tr_b16 v[236:237], v5 offset:49440
    v_mfma_f32_16x16x32_bf16 v[148:151], v[244:247], v[60:63], v[148:151]
    ds_read_b64_tr_b16 v[238:239], v5 offset:50464
    s_waitcnt vmcnt(15) lgkmcnt(6)
    v_mfma_f32_16x16x32_bf16 v[88:91], v[224:227], v[24:27], v[88:91]
    ds_read_b64_tr_b16 v[240:241], v4 offset:49664
    s_waitcnt vmcnt(14)
    v_mfma_f32_16x16x32_bf16 v[92:95], v[224:227], v[28:31], v[92:95]
    ds_read_b64_tr_b16 v[242:243], v4 offset:50688
    s_waitcnt lgkmcnt(6)
    v_mfma_f32_16x16x32_bf16 v[96:99], v[228:231], v[24:27], v[96:99]
    ds_read_b64_tr_b16 v[244:245], v5 offset:49696
    s_mov_b32 s23, 0x6000
    buffer_load_dwordx4 v[56:59], v6, s[8:11], s23 offen offset:2048 sc1
    v_mfma_f32_16x16x32_bf16 v[100:103], v[228:231], v[28:31], v[100:103]
    ds_read_b64_tr_b16 v[246:247], v5 offset:50720
    s_waitcnt lgkmcnt(6)
    v_mfma_f32_16x16x32_bf16 v[104:107], v[232:235], v[24:27], v[104:107]
    ds_read_b64_tr_b16 v[224:225], v4 offset:49920
    v_mfma_f32_16x16x32_bf16 v[108:111], v[232:235], v[28:31], v[108:111]
    ds_read_b64_tr_b16 v[226:227], v4 offset:50944
    s_mov_b32 s23, 0x26000
    buffer_load_dwordx4 v[60:63], v6, s[8:11], s23 offen offset:2048 sc1
    s_waitcnt lgkmcnt(6)
    v_mfma_f32_16x16x32_bf16 v[112:115], v[236:239], v[24:27], v[112:115]
    ds_read_b64_tr_b16 v[228:229], v5 offset:49952
    v_mfma_f32_16x16x32_bf16 v[116:119], v[236:239], v[28:31], v[116:119]
    ds_read_b64_tr_b16 v[230:231], v5 offset:50976
    s_waitcnt lgkmcnt(6)
    v_mfma_f32_16x16x32_bf16 v[120:123], v[240:243], v[24:27], v[120:123]
    v_mfma_f32_16x16x32_bf16 v[124:127], v[240:243], v[28:31], v[124:127]
    s_waitcnt vmcnt(14)
    s_barrier
    ds_read_b64_tr_b16 v[232:233], v7 offset:0
    ds_read_b64_tr_b16 v[234:235], v7 offset:1024
    s_waitcnt lgkmcnt(6)
    v_mfma_f32_16x16x32_bf16 v[128:131], v[244:247], v[24:27], v[128:131]
    s_add_u32 s22, s24, 0x220000
    s_add_u32 m0, s20, 0x18000
    s_nop 0
    buffer_load_dwordx4 v3, s[4:7], s22 offen lds
    ds_read_b64_tr_b16 v[236:237], v8 offset:32
    v_mfma_f32_16x16x32_bf16 v[132:135], v[244:247], v[28:31], v[132:135]
    ds_read_b64_tr_b16 v[238:239], v8 offset:1056
    s_waitcnt lgkmcnt(6)
    v_mfma_f32_16x16x32_bf16 v[136:139], v[224:227], v[24:27], v[136:139]
    ds_read_b64_tr_b16 v[240:241], v7 offset:256
    v_mfma_f32_16x16x32_bf16 v[140:143], v[224:227], v[28:31], v[140:143]
    s_add_u32 s22, s24, 0x222000
    s_add_u32 m0, s20, 0x18400
    s_nop 0
    buffer_load_dwordx4 v3, s[4:7], s22 offen lds
    ds_read_b64_tr_b16 v[242:243], v7 offset:1280
    s_waitcnt lgkmcnt(6)
    v_mfma_f32_16x16x32_bf16 v[144:147], v[228:231], v[24:27], v[144:147]
    ds_read_b64_tr_b16 v[244:245], v8 offset:288
    v_mfma_f32_16x16x32_bf16 v[148:151], v[228:231], v[28:31], v[148:151]
    ds_read_b64_tr_b16 v[246:247], v8 offset:1312
    s_waitcnt vmcnt(15) lgkmcnt(6)
    v_mfma_f32_16x16x32_bf16 v[88:91], v[232:235], v[32:35], v[88:91]
    ds_read_b64_tr_b16 v[224:225], v7 offset:512
    s_waitcnt vmcnt(14)
    v_mfma_f32_16x16x32_bf16 v[92:95], v[232:235], v[36:39], v[92:95]
    ds_read_b64_tr_b16 v[226:227], v7 offset:1536
    s_waitcnt lgkmcnt(6)
    v_mfma_f32_16x16x32_bf16 v[96:99], v[236:239], v[32:35], v[96:99]
    ds_read_b64_tr_b16 v[228:229], v8 offset:544
    s_mov_b32 s23, 0x8000
    buffer_load_dwordx4 v[24:27], v6, s[8:11], s23 offen offset:2048 sc1
    v_mfma_f32_16x16x32_bf16 v[100:103], v[236:239], v[36:39], v[100:103]
    ds_read_b64_tr_b16 v[230:231], v8 offset:1568
    s_waitcnt lgkmcnt(6)
    v_mfma_f32_16x16x32_bf16 v[104:107], v[240:243], v[32:35], v[104:107]
    ds_read_b64_tr_b16 v[232:233], v7 offset:768
    v_mfma_f32_16x16x32_bf16 v[108:111], v[240:243], v[36:39], v[108:111]
    ds_read_b64_tr_b16 v[234:235], v7 offset:1792
    s_mov_b32 s23, 0x28000
    buffer_load_dwordx4 v[28:31], v6, s[8:11], s23 offen offset:2048 sc1
    s_mov_b32 s16, 0x544000
    buffer_load_dwordx4 v[184:187], v2, s[8:11], s16 offen sc1
    s_waitcnt lgkmcnt(6)
    v_mfma_f32_16x16x32_bf16 v[112:115], v[244:247], v[32:35], v[112:115]
    ds_read_b64_tr_b16 v[236:237], v8 offset:800
    v_mfma_f32_16x16x32_bf16 v[116:119], v[244:247], v[36:39], v[116:119]
    ds_read_b64_tr_b16 v[238:239], v8 offset:1824
    s_waitcnt lgkmcnt(6)
    v_mfma_f32_16x16x32_bf16 v[120:123], v[224:227], v[32:35], v[120:123]
    v_mfma_f32_16x16x32_bf16 v[124:127], v[224:227], v[36:39], v[124:127]
    s_waitcnt vmcnt(15)
    s_barrier
    ds_read_b64_tr_b16 v[240:241], v7 offset:16384
    ds_read_b64_tr_b16 v[242:243], v7 offset:17408
    s_waitcnt lgkmcnt(6)
    v_mfma_f32_16x16x32_bf16 v[128:131], v[228:231], v[32:35], v[128:131]
    s_add_u32 s22, s24, 0x2a0000
    s_add_u32 m0, s20, 0x1c000
    s_nop 0
    buffer_load_dwordx4 v3, s[4:7], s22 offen lds
    ds_read_b64_tr_b16 v[244:245], v8 offset:16416
    v_mfma_f32_16x16x32_bf16 v[132:135], v[228:231], v[36:39], v[132:135]
    ds_read_b64_tr_b16 v[246:247], v8 offset:17440
    s_waitcnt lgkmcnt(6)
    v_mfma_f32_16x16x32_bf16 v[136:139], v[232:235], v[32:35], v[136:139]
    ds_read_b64_tr_b16 v[224:225], v7 offset:16640
    v_mfma_f32_16x16x32_bf16 v[140:143], v[232:235], v[36:39], v[140:143]
    s_add_u32 s22, s24, 0x2a2000
    s_add_u32 m0, s20, 0x1c400
    s_nop 0
    buffer_load_dwordx4 v3, s[4:7], s22 offen lds
    ds_read_b64_tr_b16 v[226:227], v7 offset:17664
    s_waitcnt lgkmcnt(6)
    v_mfma_f32_16x16x32_bf16 v[144:147], v[236:239], v[32:35], v[144:147]
    ds_read_b64_tr_b16 v[228:229], v8 offset:16672
    v_mfma_f32_16x16x32_bf16 v[148:151], v[236:239], v[36:39], v[148:151]
    ds_read_b64_tr_b16 v[230:231], v8 offset:17696
    s_waitcnt vmcnt(16) lgkmcnt(6)
    v_mfma_f32_16x16x32_bf16 v[88:91], v[240:243], v[40:43], v[88:91]
    ds_read_b64_tr_b16 v[232:233], v7 offset:16896
    s_waitcnt vmcnt(15)
    v_mfma_f32_16x16x32_bf16 v[92:95], v[240:243], v[44:47], v[92:95]
    ds_read_b64_tr_b16 v[234:235], v7 offset:17920
    s_waitcnt lgkmcnt(6)
    v_mfma_f32_16x16x32_bf16 v[96:99], v[244:247], v[40:43], v[96:99]
    ds_read_b64_tr_b16 v[236:237], v8 offset:16928
    s_mov_b32 s23, 0xa000
    buffer_load_dwordx4 v[32:35], v6, s[8:11], s23 offen offset:2048 sc1
    v_mfma_f32_16x16x32_bf16 v[100:103], v[244:247], v[44:47], v[100:103]
    ds_read_b64_tr_b16 v[238:239], v8 offset:17952
    s_waitcnt lgkmcnt(6)
    v_mfma_f32_16x16x32_bf16 v[104:107], v[224:227], v[40:43], v[104:107]
    ds_read_b64_tr_b16 v[240:241], v7 offset:17152
    v_mfma_f32_16x16x32_bf16 v[108:111], v[224:227], v[44:47], v[108:111]
    ds_read_b64_tr_b16 v[242:243], v7 offset:18176
    s_mov_b32 s23, 0x2a000
    buffer_load_dwordx4 v[36:39], v6, s[8:11], s23 offen offset:2048 sc1
    s_waitcnt lgkmcnt(6)
    v_mfma_f32_16x16x32_bf16 v[112:115], v[228:231], v[40:43], v[112:115]
    ds_read_b64_tr_b16 v[244:245], v8 offset:17184
    v_mfma_f32_16x16x32_bf16 v[116:119], v[228:231], v[44:47], v[116:119]
    ds_read_b64_tr_b16 v[246:247], v8 offset:18208
    s_waitcnt lgkmcnt(6)
    v_mfma_f32_16x16x32_bf16 v[120:123], v[232:235], v[40:43], v[120:123]
    v_mfma_f32_16x16x32_bf16 v[124:127], v[232:235], v[44:47], v[124:127]
    s_waitcnt vmcnt(15)
    s_barrier
    ds_read_b64_tr_b16 v[224:225], v4 offset:0
    ds_read_b64_tr_b16 v[226:227], v4 offset:1024
    s_waitcnt lgkmcnt(6)
    v_mfma_f32_16x16x32_bf16 v[128:131], v[236:239], v[40:43], v[128:131]
    s_add_u32 s22, s24, 0x320000
    s_add_u32 m0, s20, 0x20000
    s_nop 0
    buffer_load_dwordx4 v3, s[4:7], s22 offen lds
    ds_read_b64_tr_b16 v[228:229], v5 offset:32
    v_mfma_f32_16x16x32_bf16 v[132:135], v[236:239], v[44:47], v[132:135]
    ds_read_b64_tr_b16 v[230:231], v5 offset:1056
    s_waitcnt lgkmcnt(6)
    v_mfma_f32_16x16x32_bf16 v[136:139], v[240:243], v[40:43], v[136:139]
    ds_read_b64_tr_b16 v[232:233], v4 offset:256
    v_mfma_f32_16x16x32_bf16 v[140:143], v[240:243], v[44:47], v[140:143]
    s_add_u32 s22, s24, 0x322000
    s_add_u32 m0, s20, 0x20400
    s_nop 0
    buffer_load_dwordx4 v3, s[4:7], s22 offen lds
    ds_read_b64_tr_b16 v[234:235], v4 offset:1280
    s_waitcnt lgkmcnt(6)
    v_mfma_f32_16x16x32_bf16 v[144:147], v[244:247], v[40:43], v[144:147]
    ds_read_b64_tr_b16 v[236:237], v5 offset:288
    v_mfma_f32_16x16x32_bf16 v[148:151], v[244:247], v[44:47], v[148:151]
    ds_read_b64_tr_b16 v[238:239], v5 offset:1312
    s_waitcnt vmcnt(16) lgkmcnt(6)
    v_mfma_f32_16x16x32_bf16 v[88:91], v[224:227], v[48:51], v[88:91]
    ds_read_b64_tr_b16 v[240:241], v4 offset:512
    s_waitcnt vmcnt(15)
    v_mfma_f32_16x16x32_bf16 v[92:95], v[224:227], v[52:55], v[92:95]
    ds_read_b64_tr_b16 v[242:243], v4 offset:1536
    s_waitcnt lgkmcnt(6)
    v_mfma_f32_16x16x32_bf16 v[96:99], v[228:231], v[48:51], v[96:99]
    ds_read_b64_tr_b16 v[244:245], v5 offset:544
    s_mov_b32 s23, 0xc000
    buffer_load_dwordx4 v[40:43], v6, s[8:11], s23 offen offset:2048 sc1
    v_mfma_f32_16x16x32_bf16 v[100:103], v[228:231], v[52:55], v[100:103]
    ds_read_b64_tr_b16 v[246:247], v5 offset:1568
    s_waitcnt lgkmcnt(6)
    v_mfma_f32_16x16x32_bf16 v[104:107], v[232:235], v[48:51], v[104:107]
    ds_read_b64_tr_b16 v[224:225], v4 offset:768
    v_mfma_f32_16x16x32_bf16 v[108:111], v[232:235], v[52:55], v[108:111]
    ds_read_b64_tr_b16 v[226:227], v4 offset:1792
    s_mov_b32 s23, 0x2c000
    buffer_load_dwordx4 v[44:47], v6, s[8:11], s23 offen offset:2048 sc1
    s_waitcnt lgkmcnt(6)
    v_mfma_f32_16x16x32_bf16 v[112:115], v[236:239], v[48:51], v[112:115]
    ds_read_b64_tr_b16 v[228:229], v5 offset:800
    v_mfma_f32_16x16x32_bf16 v[116:119], v[236:239], v[52:55], v[116:119]
    ds_read_b64_tr_b16 v[230:231], v5 offset:1824
    s_waitcnt lgkmcnt(6)
    v_mfma_f32_16x16x32_bf16 v[120:123], v[240:243], v[48:51], v[120:123]
    v_mfma_f32_16x16x32_bf16 v[124:127], v[240:243], v[52:55], v[124:127]
    s_waitcnt vmcnt(15)
    s_barrier
    ds_read_b64_tr_b16 v[232:233], v4 offset:16384
    ds_read_b64_tr_b16 v[234:235], v4 offset:17408
    s_add_u32 s19, s19, 8192
    buffer_load_dword v12, v13, s[8:11], s19 offen sc1
    s_waitcnt lgkmcnt(6)
    v_mfma_f32_16x16x32_bf16 v[128:131], v[244:247], v[48:51], v[128:131]
    s_add_u32 s22, s24, 0x3a0000
    s_add_u32 m0, s20, 0x24000
    s_nop 0
    buffer_load_dwordx4 v3, s[4:7], s22 offen lds
    ds_read_b64_tr_b16 v[236:237], v5 offset:16416
    v_mfma_f32_16x16x32_bf16 v[132:135], v[244:247], v[52:55], v[132:135]
    ds_read_b64_tr_b16 v[238:239], v5 offset:17440
    s_waitcnt lgkmcnt(6)
    v_mfma_f32_16x16x32_bf16 v[136:139], v[224:227], v[48:51], v[136:139]
    ds_read_b64_tr_b16 v[240:241], v4 offset:16640
    v_mfma_f32_16x16x32_bf16 v[140:143], v[224:227], v[52:55], v[140:143]
    s_add_u32 s22, s24, 0x3a2000
    s_add_u32 m0, s20, 0x24400
    s_nop 0
    buffer_load_dwordx4 v3, s[4:7], s22 offen lds
    ds_read_b64_tr_b16 v[242:243], v4 offset:17664
    s_waitcnt lgkmcnt(6)
    v_mfma_f32_16x16x32_bf16 v[144:147], v[228:231], v[48:51], v[144:147]
    ds_read_b64_tr_b16 v[244:245], v5 offset:16672
    v_mfma_f32_16x16x32_bf16 v[148:151], v[228:231], v[52:55], v[148:151]
    ds_read_b64_tr_b16 v[246:247], v5 offset:17696
    s_waitcnt vmcnt(17) lgkmcnt(6)
    v_mfma_f32_16x16x32_bf16 v[88:91], v[232:235], v[56:59], v[88:91]
    ds_read_b64_tr_b16 v[224:225], v4 offset:16896
    s_waitcnt vmcnt(16)
    v_mfma_f32_16x16x32_bf16 v[92:95], v[232:235], v[60:63], v[92:95]
    ds_read_b64_tr_b16 v[226:227], v4 offset:17920
    s_waitcnt lgkmcnt(6)
    v_mfma_f32_16x16x32_bf16 v[96:99], v[236:239], v[56:59], v[96:99]
    ds_read_b64_tr_b16 v[228:229], v5 offset:16928
    s_mov_b32 s23, 0xe000
    buffer_load_dwordx4 v[48:51], v6, s[8:11], s23 offen offset:2048 sc1
    v_mfma_f32_16x16x32_bf16 v[100:103], v[236:239], v[60:63], v[100:103]
    ds_read_b64_tr_b16 v[230:231], v5 offset:17952
    s_waitcnt lgkmcnt(6)
    v_mfma_f32_16x16x32_bf16 v[104:107], v[240:243], v[56:59], v[104:107]
    ds_read_b64_tr_b16 v[232:233], v4 offset:17152
    v_mfma_f32_16x16x32_bf16 v[108:111], v[240:243], v[60:63], v[108:111]
    ds_read_b64_tr_b16 v[234:235], v4 offset:18176
    s_mov_b32 s23, 0x2e000
    buffer_load_dwordx4 v[52:55], v6, s[8:11], s23 offen offset:2048 sc1
    s_waitcnt lgkmcnt(6)
    v_mfma_f32_16x16x32_bf16 v[112:115], v[244:247], v[56:59], v[112:115]
    ds_read_b64_tr_b16 v[236:237], v5 offset:17184
    v_mfma_f32_16x16x32_bf16 v[116:119], v[244:247], v[60:63], v[116:119]
    ds_read_b64_tr_b16 v[238:239], v5 offset:18208
    s_waitcnt lgkmcnt(6)
    v_mfma_f32_16x16x32_bf16 v[120:123], v[224:227], v[56:59], v[120:123]
    v_mfma_f32_16x16x32_bf16 v[124:127], v[224:227], v[60:63], v[124:127]
    s_waitcnt vmcnt(16)
    s_barrier
    ds_read_b64_tr_b16 v[240:241], v4 offset:32768
    ds_read_b64_tr_b16 v[242:243], v4 offset:33792
    s_waitcnt lgkmcnt(6)
    v_mfma_f32_16x16x32_bf16 v[128:131], v[228:231], v[56:59], v[128:131]
    s_add_u32 s22, s24, 0x30000
    s_add_u32 m0, s20, 0x10000
    s_nop 0
    buffer_load_dwordx4 v3, s[4:7], s22 offen lds
    ds_read_b64_tr_b16 v[244:245], v5 offset:32800
    v_mfma_f32_16x16x32_bf16 v[132:135], v[228:231], v[60:63], v[132:135]
    ds_read_b64_tr_b16 v[246:247], v5 offset:33824
    s_waitcnt lgkmcnt(6)
    v_mfma_f32_16x16x32_bf16 v[136:139], v[232:235], v[56:59], v[136:139]
    ds_read_b64_tr_b16 v[224:225], v4 offset:33024
    v_mfma_f32_16x16x32_bf16 v[140:143], v[232:235], v[60:63], v[140:143]
    s_add_u32 s22, s24, 0x32000
    s_add_u32 m0, s20, 0x10400
    s_nop 0
    buffer_load_dwordx4 v3, s[4:7], s22 offen lds
    ds_read_b64_tr_b16 v[226:227], v4 offset:34048
    s_waitcnt lgkmcnt(6)
    v_mfma_f32_16x16x32_bf16 v[144:147], v[236:239], v[56:59], v[144:147]
    ds_read_b64_tr_b16 v[228:229], v5 offset:33056
    v_mfma_f32_16x16x32_bf16 v[148:151], v[236:239], v[60:63], v[148:151]
    ds_read_b64_tr_b16 v[230:231], v5 offset:34080
    s_waitcnt vmcnt(6)
    v_cmp_ne_u32 vcc, s28, v12
    s_cbranch_vccnz adaLN_cond__sliding_block_cached__moe_arch_mod__prompt_kernel_o29r
adaLN_cond__sliding_block_cached__moe_arch_mod__prompt_kernel_o29b:
    s_waitcnt lgkmcnt(6)
    v_mfma_f32_16x16x32_bf16 v[88:91], v[240:243], v[24:27], v[88:91]
    ds_read_b64_tr_b16 v[232:233], v4 offset:33280
    v_mfma_f32_16x16x32_bf16 v[92:95], v[240:243], v[28:31], v[92:95]
    ds_read_b64_tr_b16 v[234:235], v4 offset:34304
    s_waitcnt lgkmcnt(6)
    v_mfma_f32_16x16x32_bf16 v[96:99], v[244:247], v[24:27], v[96:99]
    ds_read_b64_tr_b16 v[236:237], v5 offset:33312
    s_mov_b32 s23, 0x0
    buffer_load_dwordx4 v[56:59], v6, s[8:11], s23 offen offset:3072 sc1
    v_mfma_f32_16x16x32_bf16 v[100:103], v[244:247], v[28:31], v[100:103]
    ds_read_b64_tr_b16 v[238:239], v5 offset:34336
    s_waitcnt lgkmcnt(6)
    v_mfma_f32_16x16x32_bf16 v[104:107], v[224:227], v[24:27], v[104:107]
    ds_read_b64_tr_b16 v[240:241], v4 offset:33536
    v_mfma_f32_16x16x32_bf16 v[108:111], v[224:227], v[28:31], v[108:111]
    ds_read_b64_tr_b16 v[242:243], v4 offset:34560
    s_mov_b32 s23, 0x20000
    buffer_load_dwordx4 v[60:63], v6, s[8:11], s23 offen offset:3072 sc1
    v_xor_b32 v16, s28, v184
    v_xor_b32 v17, s28, v185
    v_xor_b32 v18, s28, v186
    v_xor_b32 v19, s28, v187
    v_or3_b32 v16, v16, v17, v18
    v_or_b32 v16, v16, v19
    v_cmp_ne_u32 vcc, 0, v16
    s_cbranch_vccnz adaLN_cond__sliding_block_cached__moe_arch_mod__prompt_kernel_mf10r
adaLN_cond__sliding_block_cached__moe_arch_mod__prompt_kernel_mf10b:
    s_waitcnt lgkmcnt(6)
    v_mfma_f32_16x16x32_bf16 v[112:115], v[228:231], v[24:27], v[112:115]
    ds_read_b64_tr_b16 v[244:245], v5 offset:33568
    v_mfma_f32_16x16x32_bf16 v[116:119], v[228:231], v[28:31], v[116:119]
    ds_read_b64_tr_b16 v[246:247], v5 offset:34592
    s_waitcnt lgkmcnt(6)
    v_mfma_f32_16x16x32_bf16 v[120:123], v[232:235], v[24:27], v[120:123]
    v_mfma_f32_16x16x32_bf16 v[124:127], v[232:235], v[28:31], v[124:127]
    s_barrier
    ds_read_b64_tr_b16 v[224:225], v4 offset:49152
    ds_read_b64_tr_b16 v[226:227], v4 offset:50176
    s_waitcnt lgkmcnt(6)
    v_mfma_f32_16x16x32_bf16 v[128:131], v[236:239], v[24:27], v[128:131]
    s_add_u32 s22, s24, 0xb0000
    s_add_u32 m0, s20, 0x14000
    s_nop 0
    buffer_load_dwordx4 v3, s[4:7], s22 offen lds
    ds_read_b64_tr_b16 v[228:229], v5 offset:49184
    v_mfma_f32_16x16x32_bf16 v[132:135], v[236:239], v[28:31], v[132:135]
    ds_read_b64_tr_b16 v[230:231], v5 offset:50208
    s_waitcnt lgkmcnt(6)
    v_mfma_f32_16x16x32_bf16 v[136:139], v[240:243], v[24:27], v[136:139]
    ds_read_b64_tr_b16 v[232:233], v4 offset:49408
    v_mfma_f32_16x16x32_bf16 v[140:143], v[240:243], v[28:31], v[140:143]
    s_add_u32 s22, s24, 0xb2000
    s_add_u32 m0, s20, 0x14400
    s_nop 0
    buffer_load_dwordx4 v3, s[4:7], s22 offen lds
    ds_read_b64_tr_b16 v[234:235], v4 offset:50432
    s_waitcnt lgkmcnt(6)
    v_mfma_f32_16x16x32_bf16 v[144:147], v[244:247], v[24:27], v[144:147]
    ds_read_b64_tr_b16 v[236:237], v5 offset:49440
    v_mfma_f32_16x16x32_bf16 v[148:151], v[244:247], v[28:31], v[148:151]
    ds_read_b64_tr_b16 v[238:239], v5 offset:50464
    s_waitcnt lgkmcnt(6)
    v_mfma_f32_16x16x32_bf16 v[88:91], v[224:227], v[32:35], v[88:91]
    ds_read_b64_tr_b16 v[240:241], v4 offset:49664
    v_mfma_f32_16x16x32_bf16 v[92:95], v[224:227], v[36:39], v[92:95]
    ds_read_b64_tr_b16 v[242:243], v4 offset:50688
    s_waitcnt lgkmcnt(6)
    v_mfma_f32_16x16x32_bf16 v[96:99], v[228:231], v[32:35], v[96:99]
    ds_read_b64_tr_b16 v[244:245], v5 offset:49696
    s_mov_b32 s23, 0x2000
    buffer_load_dwordx4 v[24:27], v6, s[8:11], s23 offen offset:3072 sc1
    v_mfma_f32_16x16x32_bf16 v[100:103], v[228:231], v[36:39], v[100:103]
    ds_read_b64_tr_b16 v[246:247], v5 offset:50720
    s_waitcnt lgkmcnt(6)
    v_mfma_f32_16x16x32_bf16 v[104:107], v[232:235], v[32:35], v[104:107]
    ds_read_b64_tr_b16 v[224:225], v4 offset:49920
    v_mfma_f32_16x16x32_bf16 v[108:111], v[232:235], v[36:39], v[108:111]
    ds_read_b64_tr_b16 v[226:227], v4 offset:50944
    s_mov_b32 s23, 0x22000
    buffer_load_dwordx4 v[28:31], v6, s[8:11], s23 offen offset:3072 sc1
    s_waitcnt lgkmcnt(6)
    v_mfma_f32_16x16x32_bf16 v[112:115], v[236:239], v[32:35], v[112:115]
    ds_read_b64_tr_b16 v[228:229], v5 offset:49952
    v_mfma_f32_16x16x32_bf16 v[116:119], v[236:239], v[36:39], v[116:119]
    ds_read_b64_tr_b16 v[230:231], v5 offset:50976
    s_waitcnt lgkmcnt(6)
    v_mfma_f32_16x16x32_bf16 v[120:123], v[240:243], v[32:35], v[120:123]
    v_mfma_f32_16x16x32_bf16 v[124:127], v[240:243], v[36:39], v[124:127]
    s_barrier
    ds_read_b64_tr_b16 v[232:233], v7 offset:0
    ds_read_b64_tr_b16 v[234:235], v7 offset:1024
    s_waitcnt lgkmcnt(6)
    v_mfma_f32_16x16x32_bf16 v[128:131], v[244:247], v[32:35], v[128:131]
    s_add_u32 s22, s24, 0x130000
    s_add_u32 m0, s20, 0x18000
    s_nop 0
    buffer_load_dwordx4 v3, s[4:7], s22 offen lds
    ds_read_b64_tr_b16 v[236:237], v8 offset:32
    v_mfma_f32_16x16x32_bf16 v[132:135], v[244:247], v[36:39], v[132:135]
    ds_read_b64_tr_b16 v[238:239], v8 offset:1056
    s_waitcnt lgkmcnt(6)
    v_mfma_f32_16x16x32_bf16 v[136:139], v[224:227], v[32:35], v[136:139]
    ds_read_b64_tr_b16 v[240:241], v7 offset:256
    v_mfma_f32_16x16x32_bf16 v[140:143], v[224:227], v[36:39], v[140:143]
    s_add_u32 s22, s24, 0x132000
    s_add_u32 m0, s20, 0x18400
    s_nop 0
    buffer_load_dwordx4 v3, s[4:7], s22 offen lds
    ds_read_b64_tr_b16 v[242:243], v7 offset:1280
    s_waitcnt lgkmcnt(6)
    v_mfma_f32_16x16x32_bf16 v[144:147], v[228:231], v[32:35], v[144:147]
    ds_read_b64_tr_b16 v[244:245], v8 offset:288
    v_mfma_f32_16x16x32_bf16 v[148:151], v[228:231], v[36:39], v[148:151]
    ds_read_b64_tr_b16 v[246:247], v8 offset:1312
    s_waitcnt lgkmcnt(6)
    v_mfma_f32_16x16x32_bf16 v[88:91], v[232:235], v[40:43], v[88:91]
    ds_read_b64_tr_b16 v[224:225], v7 offset:512
    v_mfma_f32_16x16x32_bf16 v[92:95], v[232:235], v[44:47], v[92:95]
    ds_read_b64_tr_b16 v[226:227], v7 offset:1536
    s_waitcnt lgkmcnt(6)
    v_mfma_f32_16x16x32_bf16 v[96:99], v[236:239], v[40:43], v[96:99]
    ds_read_b64_tr_b16 v[228:229], v8 offset:544
    s_mov_b32 s23, 0x4000
    buffer_load_dwordx4 v[32:35], v6, s[8:11], s23 offen offset:3072 sc1
    v_mfma_f32_16x16x32_bf16 v[100:103], v[236:239], v[44:47], v[100:103]
    ds_read_b64_tr_b16 v[230:231], v8 offset:1568
    s_waitcnt lgkmcnt(6)
    v_mfma_f32_16x16x32_bf16 v[104:107], v[240:243], v[40:43], v[104:107]
    ds_read_b64_tr_b16 v[232:233], v7 offset:768
    v_mfma_f32_16x16x32_bf16 v[108:111], v[240:243], v[44:47], v[108:111]
    ds_read_b64_tr_b16 v[234:235], v7 offset:1792
    s_mov_b32 s23, 0x24000
    buffer_load_dwordx4 v[36:39], v6, s[8:11], s23 offen offset:3072 sc1
    s_waitcnt lgkmcnt(6)
    v_mfma_f32_16x16x32_bf16 v[112:115], v[244:247], v[40:43], v[112:115]
    ds_read_b64_tr_b16 v[236:237], v8 offset:800
    v_mfma_f32_16x16x32_bf16 v[116:119], v[244:247], v[44:47], v[116:119]
    ds_read_b64_tr_b16 v[238:239], v8 offset:1824
    s_waitcnt lgkmcnt(6)
    v_mfma_f32_16x16x32_bf16 v[120:123], v[224:227], v[40:43], v[120:123]
    v_mfma_f32_16x16x32_bf16 v[124:127], v[224:227], v[44:47], v[124:127]
    s_waitcnt vmcnt(14)
    s_barrier
    ds_read_b64_tr_b16 v[240:241], v7 offset:16384
    ds_read_b64_tr_b16 v[242:243], v7 offset:17408
    s_waitcnt lgkmcnt(6)
    v_mfma_f32_16x16x32_bf16 v[128:131], v[228:231], v[40:43], v[128:131]
    s_add_u32 s22, s24, 0x1b0000
    s_add_u32 m0, s20, 0x1c000
    s_nop 0
    buffer_load_dwordx4 v3, s[4:7], s22 offen lds
    ds_read_b64_tr_b16 v[244:245], v8 offset:16416
    v_mfma_f32_16x16x32_bf16 v[132:135], v[228:231], v[44:47], v[132:135]
    ds_read_b64_tr_b16 v[246:247], v8 offset:17440
    s_waitcnt lgkmcnt(6)
    v_mfma_f32_16x16x32_bf16 v[136:139], v[232:235], v[40:43], v[136:139]
    ds_read_b64_tr_b16 v[224:225], v7 offset:16640
    v_mfma_f32_16x16x32_bf16 v[140:143], v[232:235], v[44:47], v[140:143]
    s_add_u32 s22, s24, 0x1b2000
    s_add_u32 m0, s20, 0x1c400
    s_nop 0
    buffer_load_dwordx4 v3, s[4:7], s22 offen lds
    ds_read_b64_tr_b16 v[226:227], v7 offset:17664
    s_waitcnt lgkmcnt(6)
    v_mfma_f32_16x16x32_bf16 v[144:147], v[236:239], v[40:43], v[144:147]
    ds_read_b64_tr_b16 v[228:229], v8 offset:16672
    v_mfma_f32_16x16x32_bf16 v[148:151], v[236:239], v[44:47], v[148:151]
    ds_read_b64_tr_b16 v[230:231], v8 offset:17696
    s_waitcnt vmcnt(15) lgkmcnt(6)
    v_mfma_f32_16x16x32_bf16 v[88:91], v[240:243], v[48:51], v[88:91]
    ds_read_b64_tr_b16 v[232:233], v7 offset:16896
    s_waitcnt vmcnt(14)
    v_mfma_f32_16x16x32_bf16 v[92:95], v[240:243], v[52:55], v[92:95]
    ds_read_b64_tr_b16 v[234:235], v7 offset:17920
    s_waitcnt lgkmcnt(6)
    v_mfma_f32_16x16x32_bf16 v[96:99], v[244:247], v[48:51], v[96:99]
    ds_read_b64_tr_b16 v[236:237], v8 offset:16928
    s_mov_b32 s23, 0x6000
    buffer_load_dwordx4 v[40:43], v6, s[8:11], s23 offen offset:3072 sc1
    v_mfma_f32_16x16x32_bf16 v[100:103], v[244:247], v[52:55], v[100:103]
    ds_read_b64_tr_b16 v[238:239], v8 offset:17952
    s_waitcnt lgkmcnt(6)
    v_mfma_f32_16x16x32_bf16 v[104:107], v[224:227], v[48:51], v[104:107]
    ds_read_b64_tr_b16 v[240:241], v7 offset:17152
    v_mfma_f32_16x16x32_bf16 v[108:111], v[224:227], v[52:55], v[108:111]
    ds_read_b64_tr_b16 v[242:243], v7 offset:18176
    s_mov_b32 s23, 0x26000
    buffer_load_dwordx4 v[44:47], v6, s[8:11], s23 offen offset:3072 sc1
    s_waitcnt lgkmcnt(6)
    v_mfma_f32_16x16x32_bf16 v[112:115], v[228:231], v[48:51], v[112:115]
    ds_read_b64_tr_b16 v[244:245], v8 offset:17184
    v_mfma_f32_16x16x32_bf16 v[116:119], v[228:231], v[52:55], v[116:119]
    ds_read_b64_tr_b16 v[246:247], v8 offset:18208
    s_waitcnt lgkmcnt(6)
    v_mfma_f32_16x16x32_bf16 v[120:123], v[232:235], v[48:51], v[120:123]
    v_mfma_f32_16x16x32_bf16 v[124:127], v[232:235], v[52:55], v[124:127]
    s_waitcnt vmcnt(14)
    s_barrier
    ds_read_b64_tr_b16 v[224:225], v4 offset:0
    ds_read_b64_tr_b16 v[226:227], v4 offset:1024
    s_waitcnt lgkmcnt(6)
    v_mfma_f32_16x16x32_bf16 v[128:131], v[236:239], v[48:51], v[128:131]
    s_add_u32 s22, s24, 0x230000
    s_add_u32 m0, s20, 0x20000
    s_nop 0
    buffer_load_dwordx4 v3, s[4:7], s22 offen lds
    ds_read_b64_tr_b16 v[228:229], v5 offset:32
    v_mfma_f32_16x16x32_bf16 v[132:135], v[236:239], v[52:55], v[132:135]
    ds_read_b64_tr_b16 v[230:231], v5 offset:1056
    s_waitcnt lgkmcnt(6)
    v_mfma_f32_16x16x32_bf16 v[136:139], v[240:243], v[48:51], v[136:139]
    ds_read_b64_tr_b16 v[232:233], v4 offset:256
    v_mfma_f32_16x16x32_bf16 v[140:143], v[240:243], v[52:55], v[140:143]
    s_add_u32 s22, s24, 0x232000
    s_add_u32 m0, s20, 0x20400
    s_nop 0
    buffer_load_dwordx4 v3, s[4:7], s22 offen lds
    ds_read_b64_tr_b16 v[234:235], v4 offset:1280
    s_waitcnt lgkmcnt(6)
    v_mfma_f32_16x16x32_bf16 v[144:147], v[244:247], v[48:51], v[144:147]
    ds_read_b64_tr_b16 v[236:237], v5 offset:288
    v_mfma_f32_16x16x32_bf16 v[148:151], v[244:247], v[52:55], v[148:151]
    ds_read_b64_tr_b16 v[238:239], v5 offset:1312
    s_waitcnt vmcnt(15) lgkmcnt(6)
    v_mfma_f32_16x16x32_bf16 v[88:91], v[224:227], v[56:59], v[88:91]
    ds_read_b64_tr_b16 v[240:241], v4 offset:512
    s_waitcnt vmcnt(14)
    v_mfma_f32_16x16x32_bf16 v[92:95], v[224:227], v[60:63], v[92:95]
    ds_read_b64_tr_b16 v[242:243], v4 offset:1536
    s_waitcnt lgkmcnt(6)
    v_mfma_f32_16x16x32_bf16 v[96:99], v[228:231], v[56:59], v[96:99]
    ds_read_b64_tr_b16 v[244:245], v5 offset:544
    s_mov_b32 s23, 0x8000
    buffer_load_dwordx4 v[48:51], v6, s[8:11], s23 offen offset:3072 sc1
    v_mfma_f32_16x16x32_bf16 v[100:103], v[228:231], v[60:63], v[100:103]
    ds_read_b64_tr_b16 v[246:247], v5 offset:1568
    s_waitcnt lgkmcnt(6)
    v_mfma_f32_16x16x32_bf16 v[104:107], v[232:235], v[56:59], v[104:107]
    ds_read_b64_tr_b16 v[224:225], v4 offset:768
    v_mfma_f32_16x16x32_bf16 v[108:111], v[232:235], v[60:63], v[108:111]
    ds_read_b64_tr_b16 v[226:227], v4 offset:1792
    s_mov_b32 s23, 0x28000
    buffer_load_dwordx4 v[52:55], v6, s[8:11], s23 offen offset:3072 sc1
    s_waitcnt lgkmcnt(6)
    v_mfma_f32_16x16x32_bf16 v[112:115], v[236:239], v[56:59], v[112:115]
    ds_read_b64_tr_b16 v[228:229], v5 offset:800
    v_mfma_f32_16x16x32_bf16 v[116:119], v[236:239], v[60:63], v[116:119]
    ds_read_b64_tr_b16 v[230:231], v5 offset:1824
    s_waitcnt lgkmcnt(6)
    v_mfma_f32_16x16x32_bf16 v[120:123], v[240:243], v[56:59], v[120:123]
    v_mfma_f32_16x16x32_bf16 v[124:127], v[240:243], v[60:63], v[124:127]
    s_waitcnt vmcnt(14)
    s_barrier
    ds_read_b64_tr_b16 v[232:233], v4 offset:16384
    ds_read_b64_tr_b16 v[234:235], v4 offset:17408
    s_waitcnt lgkmcnt(6)
    v_mfma_f32_16x16x32_bf16 v[128:131], v[244:247], v[56:59], v[128:131]
    s_add_u32 s22, s24, 0x2b0000
    s_add_u32 m0, s20, 0x24000
    s_nop 0
    buffer_load_dwordx4 v3, s[4:7], s22 offen lds
    ds_read_b64_tr_b16 v[236:237], v5 offset:16416
    v_mfma_f32_16x16x32_bf16 v[132:135], v[244:247], v[60:63], v[132:135]
    ds_read_b64_tr_b16 v[238:239], v5 offset:17440
    s_waitcnt lgkmcnt(6)
    v_mfma_f32_16x16x32_bf16 v[136:139], v[224:227], v[56:59], v[136:139]
    ds_read_b64_tr_b16 v[240:241], v4 offset:16640
    v_mfma_f32_16x16x32_bf16 v[140:143], v[224:227], v[60:63], v[140:143]
    s_add_u32 s22, s24, 0x2b2000
    s_add_u32 m0, s20, 0x24400
    s_nop 0
    buffer_load_dwordx4 v3, s[4:7], s22 offen lds
    ds_read_b64_tr_b16 v[242:243], v4 offset:17664
    s_waitcnt lgkmcnt(6)
    v_mfma_f32_16x16x32_bf16 v[144:147], v[228:231], v[56:59], v[144:147]
    ds_read_b64_tr_b16 v[244:245], v5 offset:16672
    v_mfma_f32_16x16x32_bf16 v[148:151], v[228:231], v[60:63], v[148:151]
    ds_read_b64_tr_b16 v[246:247], v5 offset:17696
    s_waitcnt vmcnt(15) lgkmcnt(6)
    v_mfma_f32_16x16x32_bf16 v[88:91], v[232:235], v[24:27], v[88:91]
    ds_read_b64_tr_b16 v[224:225], v4 offset:16896
    s_waitcnt vmcnt(14)
    v_mfma_f32_16x16x32_bf16 v[92:95], v[232:235], v[28:31], v[92:95]
    ds_read_b64_tr_b16 v[226:227], v4 offset:17920
    s_waitcnt lgkmcnt(6)
    v_mfma_f32_16x16x32_bf16 v[96:99], v[236:239], v[24:27], v[96:99]
    ds_read_b64_tr_b16 v[228:229], v5 offset:16928
    s_mov_b32 s23, 0xa000
    buffer_load_dwordx4 v[56:59], v6, s[8:11], s23 offen offset:3072 sc1
    v_mfma_f32_16x16x32_bf16 v[100:103], v[236:239], v[28:31], v[100:103]
    ds_read_b64_tr_b16 v[230:231], v5 offset:17952
    s_waitcnt lgkmcnt(6)
    v_mfma_f32_16x16x32_bf16 v[104:107], v[240:243], v[24:27], v[104:107]
    ds_read_b64_tr_b16 v[232:233], v4 offset:17152
    v_mfma_f32_16x16x32_bf16 v[108:111], v[240:243], v[28:31], v[108:111]
    ds_read_b64_tr_b16 v[234:235], v4 offset:18176
    s_mov_b32 s23, 0x2a000
    buffer_load_dwordx4 v[60:63], v6, s[8:11], s23 offen offset:3072 sc1
    s_waitcnt lgkmcnt(6)
    v_mfma_f32_16x16x32_bf16 v[112:115], v[244:247], v[24:27], v[112:115]
    ds_read_b64_tr_b16 v[236:237], v5 offset:17184
    v_mfma_f32_16x16x32_bf16 v[116:119], v[244:247], v[28:31], v[116:119]
    ds_read_b64_tr_b16 v[238:239], v5 offset:18208
    s_waitcnt lgkmcnt(6)
    v_mfma_f32_16x16x32_bf16 v[120:123], v[224:227], v[24:27], v[120:123]
    v_mfma_f32_16x16x32_bf16 v[124:127], v[224:227], v[28:31], v[124:127]
    s_waitcnt vmcnt(14)
    s_barrier
    ds_read_b64_tr_b16 v[240:241], v4 offset:32768
    ds_read_b64_tr_b16 v[242:243], v4 offset:33792
    s_waitcnt lgkmcnt(6)
    v_mfma_f32_16x16x32_bf16 v[128:131], v[228:231], v[24:27], v[128:131]
    s_add_u32 s22, s24, 0x330000
    s_add_u32 m0, s20, 0x10000
    s_nop 0
    buffer_load_dwordx4 v3, s[4:7], s22 offen lds
    ds_read_b64_tr_b16 v[244:245], v5 offset:32800
    v_mfma_f32_16x16x32_bf16 v[132:135], v[228:231], v[28:31], v[132:135]
    ds_read_b64_tr_b16 v[246:247], v5 offset:33824
    s_waitcnt lgkmcnt(6)
    v_mfma_f32_16x16x32_bf16 v[136:139], v[232:235], v[24:27], v[136:139]
    ds_read_b64_tr_b16 v[224:225], v4 offset:33024
    v_mfma_f32_16x16x32_bf16 v[140:143], v[232:235], v[28:31], v[140:143]
    s_add_u32 s22, s24, 0x332000
    s_add_u32 m0, s20, 0x10400
    s_nop 0
    buffer_load_dwordx4 v3, s[4:7], s22 offen lds
    ds_read_b64_tr_b16 v[226:227], v4 offset:34048
    s_waitcnt lgkmcnt(6)
    v_mfma_f32_16x16x32_bf16 v[144:147], v[236:239], v[24:27], v[144:147]
    ds_read_b64_tr_b16 v[228:229], v5 offset:33056
    v_mfma_f32_16x16x32_bf16 v[148:151], v[236:239], v[28:31], v[148:151]
    ds_read_b64_tr_b16 v[230:231], v5 offset:34080
    s_waitcnt vmcnt(15) lgkmcnt(6)
    v_mfma_f32_16x16x32_bf16 v[88:91], v[240:243], v[32:35], v[88:91]
    ds_read_b64_tr_b16 v[232:233], v4 offset:33280
    s_waitcnt vmcnt(14)
    v_mfma_f32_16x16x32_bf16 v[92:95], v[240:243], v[36:39], v[92:95]
    ds_read_b64_tr_b16 v[234:235], v4 offset:34304
    s_waitcnt lgkmcnt(6)
    v_mfma_f32_16x16x32_bf16 v[96:99], v[244:247], v[32:35], v[96:99]
    ds_read_b64_tr_b16 v[236:237], v5 offset:33312
    s_mov_b32 s23, 0xc000
    buffer_load_dwordx4 v[24:27], v6, s[8:11], s23 offen offset:3072 sc1
    v_mfma_f32_16x16x32_bf16 v[100:103], v[244:247], v[36:39], v[100:103]
    ds_read_b64_tr_b16 v[238:239], v5 offset:34336
    s_waitcnt lgkmcnt(6)
    v_mfma_f32_16x16x32_bf16 v[104:107], v[224:227], v[32:35], v[104:107]
    ds_read_b64_tr_b16 v[240:241], v4 offset:33536
    v_mfma_f32_16x16x32_bf16 v[108:111], v[224:227], v[36:39], v[108:111]
    ds_read_b64_tr_b16 v[242:243], v4 offset:34560
    s_mov_b32 s23, 0x2c000
    buffer_load_dwordx4 v[28:31], v6, s[8:11], s23 offen offset:3072 sc1
    v_lshrrev_b32 v16, 4, v1
    v_lshlrev_b32 v16, 3, v16
    s_lshl_b32 s16, s31, 8
    s_add_u32 s16, s16, 0x540000
    buffer_load_dwordx2 v[248:249], v16, s[8:11], s16 offen offset:0 sc1
    buffer_load_dwordx2 v[250:251], v16, s[8:11], s16 offen offset:32 sc1
    buffer_load_dwordx2 v[252:253], v16, s[8:11], s16 offen offset:64 sc1
    buffer_load_dwordx2 v[254:255], v16, s[8:11], s16 offen offset:96 sc1
    s_waitcnt lgkmcnt(6)
    v_mfma_f32_16x16x32_bf16 v[112:115], v[228:231], v[32:35], v[112:115]
    ds_read_b64_tr_b16 v[244:245], v5 offset:33568
    v_mfma_f32_16x16x32_bf16 v[116:119], v[228:231], v[36:39], v[116:119]
    ds_read_b64_tr_b16 v[246:247], v5 offset:34592
    s_waitcnt lgkmcnt(6)
    v_mfma_f32_16x16x32_bf16 v[120:123], v[232:235], v[32:35], v[120:123]
    v_mfma_f32_16x16x32_bf16 v[124:127], v[232:235], v[36:39], v[124:127]
    s_waitcnt vmcnt(18)
    s_barrier
    ds_read_b64_tr_b16 v[224:225], v4 offset:49152
    ds_read_b64_tr_b16 v[226:227], v4 offset:50176
    s_waitcnt lgkmcnt(6)
    v_mfma_f32_16x16x32_bf16 v[128:131], v[236:239], v[32:35], v[128:131]
    s_add_u32 s22, s24, 0x3b0000
    s_add_u32 m0, s20, 0x14000
    s_nop 0
    buffer_load_dwordx4 v3, s[4:7], s22 offen lds
    ds_read_b64_tr_b16 v[228:229], v5 offset:49184
    v_mfma_f32_16x16x32_bf16 v[132:135], v[236:239], v[36:39], v[132:135]
    ds_read_b64_tr_b16 v[230:231], v5 offset:50208
    s_waitcnt lgkmcnt(6)
    v_mfma_f32_16x16x32_bf16 v[136:139], v[240:243], v[32:35], v[136:139]
    ds_read_b64_tr_b16 v[232:233], v4 offset:49408
    v_mfma_f32_16x16x32_bf16 v[140:143], v[240:243], v[36:39], v[140:143]
    s_add_u32 s22, s24, 0x3b2000
    s_add_u32 m0, s20, 0x14400
    s_nop 0
    buffer_load_dwordx4 v3, s[4:7], s22 offen lds
    ds_read_b64_tr_b16 v[234:235], v4 offset:50432
    s_waitcnt lgkmcnt(6)
    v_mfma_f32_16x16x32_bf16 v[144:147], v[244:247], v[32:35], v[144:147]
    ds_read_b64_tr_b16 v[236:237], v5 offset:49440
    v_mfma_f32_16x16x32_bf16 v[148:151], v[244:247], v[36:39], v[148:151]
    ds_read_b64_tr_b16 v[238:239], v5 offset:50464
    s_waitcnt vmcnt(19) lgkmcnt(6)
    v_mfma_f32_16x16x32_bf16 v[88:91], v[224:227], v[40:43], v[88:91]
    ds_read_b64_tr_b16 v[240:241], v4 offset:49664
    s_waitcnt vmcnt(18)
    v_mfma_f32_16x16x32_bf16 v[92:95], v[224:227], v[44:47], v[92:95]
    ds_read_b64_tr_b16 v[242:243], v4 offset:50688
    s_waitcnt lgkmcnt(6)
    v_mfma_f32_16x16x32_bf16 v[96:99], v[228:231], v[40:43], v[96:99]
    ds_read_b64_tr_b16 v[244:245], v5 offset:49696
    s_mov_b32 s23, 0xe000
    buffer_load_dwordx4 v[32:35], v6, s[8:11], s23 offen offset:3072 sc1
    v_mfma_f32_16x16x32_bf16 v[100:103], v[228:231], v[44:47], v[100:103]
    ds_read_b64_tr_b16 v[246:247], v5 offset:50720
    s_waitcnt lgkmcnt(6)
    v_mfma_f32_16x16x32_bf16 v[104:107], v[232:235], v[40:43], v[104:107]
    ds_read_b64_tr_b16 v[224:225], v4 offset:49920
    v_mfma_f32_16x16x32_bf16 v[108:111], v[232:235], v[44:47], v[108:111]
    ds_read_b64_tr_b16 v[226:227], v4 offset:50944
    s_mov_b32 s23, 0x2e000
    buffer_load_dwordx4 v[36:39], v6, s[8:11], s23 offen offset:3072 sc1
    s_waitcnt lgkmcnt(6)
    v_mfma_f32_16x16x32_bf16 v[112:115], v[236:239], v[40:43], v[112:115]
    ds_read_b64_tr_b16 v[228:229], v5 offset:49952
    v_mfma_f32_16x16x32_bf16 v[116:119], v[236:239], v[44:47], v[116:119]
    ds_read_b64_tr_b16 v[230:231], v5 offset:50976
    s_waitcnt lgkmcnt(6)
    v_mfma_f32_16x16x32_bf16 v[120:123], v[240:243], v[40:43], v[120:123]
    v_mfma_f32_16x16x32_bf16 v[124:127], v[240:243], v[44:47], v[124:127]
    s_waitcnt vmcnt(18)
    s_barrier
    ds_read_b64_tr_b16 v[232:233], v7 offset:0
    ds_read_b64_tr_b16 v[234:235], v7 offset:1024
    s_waitcnt lgkmcnt(6)
    v_mfma_f32_16x16x32_bf16 v[128:131], v[244:247], v[40:43], v[128:131]
    ds_read_b64_tr_b16 v[236:237], v8 offset:32
    v_mfma_f32_16x16x32_bf16 v[132:135], v[244:247], v[44:47], v[132:135]
    ds_read_b64_tr_b16 v[238:239], v8 offset:1056
    s_waitcnt lgkmcnt(6)
    v_mfma_f32_16x16x32_bf16 v[136:139], v[224:227], v[40:43], v[136:139]
    ds_read_b64_tr_b16 v[240:241], v7 offset:256
    v_mfma_f32_16x16x32_bf16 v[140:143], v[224:227], v[44:47], v[140:143]
    ds_read_b64_tr_b16 v[242:243], v7 offset:1280
    s_waitcnt lgkmcnt(6)
    v_mfma_f32_16x16x32_bf16 v[144:147], v[228:231], v[40:43], v[144:147]
    ds_read_b64_tr_b16 v[244:245], v8 offset:288
    v_mfma_f32_16x16x32_bf16 v[148:151], v[228:231], v[44:47], v[148:151]
    ds_read_b64_tr_b16 v[246:247], v8 offset:1312
    s_waitcnt vmcnt(17) lgkmcnt(6)
    v_mfma_f32_16x16x32_bf16 v[88:91], v[232:235], v[48:51], v[88:91]
    ds_read_b64_tr_b16 v[224:225], v7 offset:512
    s_waitcnt vmcnt(16)
    v_mfma_f32_16x16x32_bf16 v[92:95], v[232:235], v[52:55], v[92:95]
    ds_read_b64_tr_b16 v[226:227], v7 offset:1536
    s_waitcnt lgkmcnt(6)
    v_mfma_f32_16x16x32_bf16 v[96:99], v[236:239], v[48:51], v[96:99]
    ds_read_b64_tr_b16 v[228:229], v8 offset:544
    v_mfma_f32_16x16x32_bf16 v[100:103], v[236:239], v[52:55], v[100:103]
    ds_read_b64_tr_b16 v[230:231], v8 offset:1568
    s_waitcnt lgkmcnt(6)
    v_mfma_f32_16x16x32_bf16 v[104:107], v[240:243], v[48:51], v[104:107]
    ds_read_b64_tr_b16 v[232:233], v7 offset:768
    v_mfma_f32_16x16x32_bf16 v[108:111], v[240:243], v[52:55], v[108:111]
    ds_read_b64_tr_b16 v[234:235], v7 offset:1792
    s_waitcnt lgkmcnt(6)
    v_mfma_f32_16x16x32_bf16 v[112:115], v[244:247], v[48:51], v[112:115]
    ds_read_b64_tr_b16 v[236:237], v8 offset:800
    v_mfma_f32_16x16x32_bf16 v[116:119], v[244:247], v[52:55], v[116:119]
    ds_read_b64_tr_b16 v[238:239], v8 offset:1824
    s_waitcnt lgkmcnt(6)
    v_mfma_f32_16x16x32_bf16 v[120:123], v[224:227], v[48:51], v[120:123]
    v_mfma_f32_16x16x32_bf16 v[124:127], v[224:227], v[52:55], v[124:127]
    s_waitcnt vmcnt(14)
    s_barrier
    ds_read_b64_tr_b16 v[240:241], v7 offset:16384
    ds_read_b64_tr_b16 v[242:243], v7 offset:17408
    s_waitcnt lgkmcnt(6)
    v_mfma_f32_16x16x32_bf16 v[128:131], v[228:231], v[48:51], v[128:131]
    ds_read_b64_tr_b16 v[244:245], v8 offset:16416
    v_mfma_f32_16x16x32_bf16 v[132:135], v[228:231], v[52:55], v[132:135]
    ds_read_b64_tr_b16 v[246:247], v8 offset:17440
    s_waitcnt lgkmcnt(6)
    v_mfma_f32_16x16x32_bf16 v[136:139], v[232:235], v[48:51], v[136:139]
    ds_read_b64_tr_b16 v[224:225], v7 offset:16640
    v_mfma_f32_16x16x32_bf16 v[140:143], v[232:235], v[52:55], v[140:143]
    ds_read_b64_tr_b16 v[226:227], v7 offset:17664
    s_waitcnt lgkmcnt(6)
    v_mfma_f32_16x16x32_bf16 v[144:147], v[236:239], v[48:51], v[144:147]
    ds_read_b64_tr_b16 v[228:229], v8 offset:16672
    v_mfma_f32_16x16x32_bf16 v[148:151], v[236:239], v[52:55], v[148:151]
    ds_read_b64_tr_b16 v[230:231], v8 offset:17696
    s_waitcnt vmcnt(13) lgkmcnt(6)
    v_mfma_f32_16x16x32_bf16 v[88:91], v[240:243], v[56:59], v[88:91]
    ds_read_b64_tr_b16 v[232:233], v7 offset:16896
    s_waitcnt vmcnt(12)
    v_mfma_f32_16x16x32_bf16 v[92:95], v[240:243], v[60:63], v[92:95]
    ds_read_b64_tr_b16 v[234:235], v7 offset:17920
    s_waitcnt lgkmcnt(6)
    v_mfma_f32_16x16x32_bf16 v[96:99], v[244:247], v[56:59], v[96:99]
    ds_read_b64_tr_b16 v[236:237], v8 offset:16928
    v_mfma_f32_16x16x32_bf16 v[100:103], v[244:247], v[60:63], v[100:103]
    ds_read_b64_tr_b16 v[238:239], v8 offset:17952
    s_waitcnt lgkmcnt(6)
    v_mfma_f32_16x16x32_bf16 v[104:107], v[224:227], v[56:59], v[104:107]
    ds_read_b64_tr_b16 v[240:241], v7 offset:17152
    v_mfma_f32_16x16x32_bf16 v[108:111], v[224:227], v[60:63], v[108:111]
    ds_read_b64_tr_b16 v[242:243], v7 offset:18176
    s_waitcnt lgkmcnt(6)
    v_mfma_f32_16x16x32_bf16 v[112:115], v[228:231], v[56:59], v[112:115]
    ds_read_b64_tr_b16 v[244:245], v8 offset:17184
    v_mfma_f32_16x16x32_bf16 v[116:119], v[228:231], v[60:63], v[116:119]
    ds_read_b64_tr_b16 v[246:247], v8 offset:18208
    s_waitcnt lgkmcnt(6)
    v_mfma_f32_16x16x32_bf16 v[120:123], v[232:235], v[56:59], v[120:123]
    v_mfma_f32_16x16x32_bf16 v[124:127], v[232:235], v[60:63], v[124:127]
    s_waitcnt vmcnt(10)
    s_barrier
    ds_read_b64_tr_b16 v[224:225], v4 offset:0
    ds_read_b64_tr_b16 v[226:227], v4 offset:1024
    s_waitcnt lgkmcnt(6)
    v_mfma_f32_16x16x32_bf16 v[128:131], v[236:239], v[56:59], v[128:131]
    ds_read_b64_tr_b16 v[228:229], v5 offset:32
    v_mfma_f32_16x16x32_bf16 v[132:135], v[236:239], v[60:63], v[132:135]
    ds_read_b64_tr_b16 v[230:231], v5 offset:1056
    s_waitcnt lgkmcnt(6)
    v_mfma_f32_16x16x32_bf16 v[136:139], v[240:243], v[56:59], v[136:139]
    ds_read_b64_tr_b16 v[232:233], v4 offset:256
    v_mfma_f32_16x16x32_bf16 v[140:143], v[240:243], v[60:63], v[140:143]
    ds_read_b64_tr_b16 v[234:235], v4 offset:1280
    s_waitcnt lgkmcnt(6)
    v_mfma_f32_16x16x32_bf16 v[144:147], v[244:247], v[56:59], v[144:147]
    ds_read_b64_tr_b16 v[236:237], v5 offset:288
    v_mfma_f32_16x16x32_bf16 v[148:151], v[244:247], v[60:63], v[148:151]
    ds_read_b64_tr_b16 v[238:239], v5 offset:1312
    s_waitcnt vmcnt(9) lgkmcnt(6)
    v_mfma_f32_16x16x32_bf16 v[88:91], v[224:227], v[24:27], v[88:91]
    ds_read_b64_tr_b16 v[240:241], v4 offset:512
    s_waitcnt vmcnt(8)
    v_mfma_f32_16x16x32_bf16 v[92:95], v[224:227], v[28:31], v[92:95]
    ds_read_b64_tr_b16 v[242:243], v4 offset:1536
    s_waitcnt lgkmcnt(6)
    v_mfma_f32_16x16x32_bf16 v[96:99], v[228:231], v[24:27], v[96:99]
    ds_read_b64_tr_b16 v[244:245], v5 offset:544
    v_mfma_f32_16x16x32_bf16 v[100:103], v[228:231], v[28:31], v[100:103]
    ds_read_b64_tr_b16 v[246:247], v5 offset:1568
    s_waitcnt lgkmcnt(6)
    v_mfma_f32_16x16x32_bf16 v[104:107], v[232:235], v[24:27], v[104:107]
    ds_read_b64_tr_b16 v[224:225], v4 offset:768
    v_mfma_f32_16x16x32_bf16 v[108:111], v[232:235], v[28:31], v[108:111]
    ds_read_b64_tr_b16 v[226:227], v4 offset:1792
    s_waitcnt lgkmcnt(6)
    v_mfma_f32_16x16x32_bf16 v[112:115], v[236:239], v[24:27], v[112:115]
    ds_read_b64_tr_b16 v[228:229], v5 offset:800
    v_mfma_f32_16x16x32_bf16 v[116:119], v[236:239], v[28:31], v[116:119]
    ds_read_b64_tr_b16 v[230:231], v5 offset:1824
    s_waitcnt lgkmcnt(6)
    v_mfma_f32_16x16x32_bf16 v[120:123], v[240:243], v[24:27], v[120:123]
    v_mfma_f32_16x16x32_bf16 v[124:127], v[240:243], v[28:31], v[124:127]
    s_waitcnt vmcnt(2)
    s_barrier
    ds_read_b64_tr_b16 v[232:233], v4 offset:16384
    ds_read_b64_tr_b16 v[234:235], v4 offset:17408
    s_waitcnt lgkmcnt(6)
    v_mfma_f32_16x16x32_bf16 v[128:131], v[244:247], v[24:27], v[128:131]
    ds_read_b64_tr_b16 v[236:237], v5 offset:16416
    v_mfma_f32_16x16x32_bf16 v[132:135], v[244:247], v[28:31], v[132:135]
    ds_read_b64_tr_b16 v[238:239], v5 offset:17440
    s_waitcnt lgkmcnt(6)
    v_mfma_f32_16x16x32_bf16 v[136:139], v[224:227], v[24:27], v[136:139]
    ds_read_b64_tr_b16 v[240:241], v4 offset:16640
    v_mfma_f32_16x16x32_bf16 v[140:143], v[224:227], v[28:31], v[140:143]
    ds_read_b64_tr_b16 v[242:243], v4 offset:17664
    s_waitcnt lgkmcnt(6)
    v_mfma_f32_16x16x32_bf16 v[144:147], v[228:231], v[24:27], v[144:147]
    ds_read_b64_tr_b16 v[244:245], v5 offset:16672
    v_mfma_f32_16x16x32_bf16 v[148:151], v[228:231], v[28:31], v[148:151]
    ds_read_b64_tr_b16 v[246:247], v5 offset:17696
    s_waitcnt vmcnt(1) lgkmcnt(6)
    v_mfma_f32_16x16x32_bf16 v[88:91], v[232:235], v[32:35], v[88:91]
    ds_read_b64_tr_b16 v[224:225], v4 offset:16896
    s_waitcnt vmcnt(0)
    v_mfma_f32_16x16x32_bf16 v[92:95], v[232:235], v[36:39], v[92:95]
    ds_read_b64_tr_b16 v[226:227], v4 offset:17920
    s_waitcnt lgkmcnt(6)
    v_mfma_f32_16x16x32_bf16 v[96:99], v[236:239], v[32:35], v[96:99]
    ds_read_b64_tr_b16 v[228:229], v5 offset:16928
    v_mfma_f32_16x16x32_bf16 v[100:103], v[236:239], v[36:39], v[100:103]
    ds_read_b64_tr_b16 v[230:231], v5 offset:17952
    s_waitcnt lgkmcnt(6)
    v_mfma_f32_16x16x32_bf16 v[104:107], v[240:243], v[32:35], v[104:107]
    ds_read_b64_tr_b16 v[232:233], v4 offset:17152
    v_mfma_f32_16x16x32_bf16 v[108:111], v[240:243], v[36:39], v[108:111]
    ds_read_b64_tr_b16 v[234:235], v4 offset:18176
    s_waitcnt lgkmcnt(6)
    v_mfma_f32_16x16x32_bf16 v[112:115], v[244:247], v[32:35], v[112:115]
    ds_read_b64_tr_b16 v[236:237], v5 offset:17184
    v_mfma_f32_16x16x32_bf16 v[116:119], v[244:247], v[36:39], v[116:119]
    ds_read_b64_tr_b16 v[238:239], v5 offset:18208
    s_waitcnt lgkmcnt(6)
    v_mfma_f32_16x16x32_bf16 v[120:123], v[224:227], v[32:35], v[120:123]
    v_mfma_f32_16x16x32_bf16 v[124:127], v[224:227], v[36:39], v[124:127]
    s_waitcnt lgkmcnt(4)
    v_mfma_f32_16x16x32_bf16 v[128:131], v[228:231], v[32:35], v[128:131]
    v_mfma_f32_16x16x32_bf16 v[132:135], v[228:231], v[36:39], v[132:135]
    s_waitcnt lgkmcnt(2)
    v_mfma_f32_16x16x32_bf16 v[136:139], v[232:235], v[32:35], v[136:139]
    v_mfma_f32_16x16x32_bf16 v[140:143], v[232:235], v[36:39], v[140:143]
    s_waitcnt lgkmcnt(0)
    v_mfma_f32_16x16x32_bf16 v[144:147], v[236:239], v[32:35], v[144:147]
    v_mfma_f32_16x16x32_bf16 v[148:151], v[236:239], v[36:39], v[148:151]
    s_lshl_b32 s16, s3, 13
    s_xor_b32 s17, s16, 0x8000
    s_add_u32 s16, s16, 0x18000
    s_add_u32 s17, s17, 0x18000
    v_add_u32 v16, s16, v2
    s_mov_b32 s16, s17
    v_add_u32 v17, s16, v2
    ds_write_b128 v16, v[120:123] offset:0
    ds_write_b128 v16, v[124:127] offset:1024
    ds_write_b128 v16, v[128:131] offset:2048
    ds_write_b128 v16, v[132:135] offset:3072
    ds_write_b128 v16, v[136:139] offset:4096
    ds_write_b128 v16, v[140:143] offset:5120
    ds_write_b128 v16, v[144:147] offset:6144
    ds_write_b128 v16, v[148:151] offset:7168
    v_lshlrev_b32 v24, 16, v248
    v_and_b32 v25, 0xffff0000, v248
    v_lshlrev_b32 v26, 16, v249
    v_and_b32 v27, 0xffff0000, v249
    v_lshlrev_b32 v28, 16, v250
    v_and_b32 v29, 0xffff0000, v250
    v_lshlrev_b32 v30, 16, v251
    v_and_b32 v31, 0xffff0000, v251
    v_lshlrev_b32 v32, 16, v252
    v_and_b32 v33, 0xffff0000, v252
    v_lshlrev_b32 v34, 16, v253
    v_and_b32 v35, 0xffff0000, v253
    v_lshlrev_b32 v36, 16, v254
    v_and_b32 v37, 0xffff0000, v254
    v_lshlrev_b32 v38, 16, v255
    v_and_b32 v39, 0xffff0000, v255
    v_and_b32 v18, 15, v1
    v_lshlrev_b32 v18, 6, v18
    v_lshrrev_b32 v19, 4, v1
    v_and_b32 v20, 1, v19
    v_lshl_add_u32 v18, v20, 5, v18
    v_lshrrev_b32 v19, 1, v19
    v_lshl_add_u32 v18, v19, 4, v18
    s_and_b32 s17, s3, 3
    s_lshl_b32 s18, s30, 2
    s_add_u32 s18, s18, s17
    s_lshl_b32 s18, s18, 16
    s_lshl_b32 s19, s15, 22
    s_add_u32 s18, s18, s19
    s_lshl_b32 s19, s31, 12
    s_add_u32 s18, s18, s19
    s_add_u32 s18, s18, 0x2000000
    s_add_u32 s19, s18, 32768
    s_waitcnt lgkmcnt(0)
    s_barrier
    ds_read_b128 v[40:43], v17 offset:0
    ds_read_b128 v[44:47], v17 offset:1024
    ds_read_b128 v[48:51], v17 offset:2048
    ds_read_b128 v[52:55], v17 offset:3072
    ds_read_b128 v[56:59], v17 offset:4096
    ds_read_b128 v[60:63], v17 offset:5120
    ds_read_b128 v[64:67], v17 offset:6144
    ds_read_b128 v[68:71], v17 offset:7168
    s_waitcnt lgkmcnt(7)
    v_pk_add_f32 v[88:89], v[88:89], v[40:41]
    v_pk_add_f32 v[90:91], v[90:91], v[42:43]
    v_pk_mul_f32 v[88:89], v[88:89], v[24:25]
    v_pk_mul_f32 v[90:91], v[90:91], v[26:27]
    v_cvt_pk_bf16_f32 v224, v88, v89
    v_cvt_pk_bf16_f32 v225, v90, v91
    s_waitcnt lgkmcnt(5)
    v_pk_add_f32 v[96:97], v[96:97], v[48:49]
    v_pk_add_f32 v[98:99], v[98:99], v[50:51]
    v_pk_mul_f32 v[96:97], v[96:97], v[28:29]
    v_pk_mul_f32 v[98:99], v[98:99], v[30:31]
    v_cvt_pk_bf16_f32 v226, v96, v97
    v_cvt_pk_bf16_f32 v227, v98, v99
    s_nop 0
    v_permlane16_swap_b32 v224, v226
    v_permlane16_swap_b32 v225, v227
    buffer_store_dwordx4 v[224:227], v18, s[8:11], s18 offen offset:0 sc1
    v_pk_add_f32 v[92:93], v[92:93], v[44:45]
    v_pk_add_f32 v[94:95], v[94:95], v[46:47]
    v_pk_mul_f32 v[92:93], v[92:93], v[24:25]
    v_pk_mul_f32 v[94:95], v[94:95], v[26:27]
    v_cvt_pk_bf16_f32 v228, v92, v93
    v_cvt_pk_bf16_f32 v229, v94, v95
    s_waitcnt lgkmcnt(4)
    v_pk_add_f32 v[100:101], v[100:101], v[52:53]
    v_pk_add_f32 v[102:103], v[102:103], v[54:55]
    v_pk_mul_f32 v[100:101], v[100:101], v[28:29]
    v_pk_mul_f32 v[102:103], v[102:103], v[30:31]
    v_cvt_pk_bf16_f32 v230, v100, v101
    v_cvt_pk_bf16_f32 v231, v102, v103
    s_nop 0
    v_permlane16_swap_b32 v228, v230
    v_permlane16_swap_b32 v229, v231
    buffer_store_dwordx4 v[228:231], v18, s[8:11], s19 offen offset:0 sc1
    s_waitcnt lgkmcnt(3)
    v_pk_add_f32 v[104:105], v[104:105], v[56:57]
    v_pk_add_f32 v[106:107], v[106:107], v[58:59]
    v_pk_mul_f32 v[104:105], v[104:105], v[32:33]
    v_pk_mul_f32 v[106:107], v[106:107], v[34:35]
    v_cvt_pk_bf16_f32 v232, v104, v105
    v_cvt_pk_bf16_f32 v233, v106, v107
    s_waitcnt lgkmcnt(1)
    v_pk_add_f32 v[112:113], v[112:113], v[64:65]
    v_pk_add_f32 v[114:115], v[114:115], v[66:67]
    v_pk_mul_f32 v[112:113], v[112:113], v[36:37]
    v_pk_mul_f32 v[114:115], v[114:115], v[38:39]
    v_cvt_pk_bf16_f32 v234, v112, v113
    v_cvt_pk_bf16_f32 v235, v114, v115
    s_nop 0
    v_permlane16_swap_b32 v232, v234
    v_permlane16_swap_b32 v233, v235
    buffer_store_dwordx4 v[232:235], v18, s[8:11], s18 offen offset:1024 sc1
    v_pk_add_f32 v[108:109], v[108:109], v[60:61]
    v_pk_add_f32 v[110:111], v[110:111], v[62:63]
    v_pk_mul_f32 v[108:109], v[108:109], v[32:33]
    v_pk_mul_f32 v[110:111], v[110:111], v[34:35]
    v_cvt_pk_bf16_f32 v236, v108, v109
    v_cvt_pk_bf16_f32 v237, v110, v111
    s_waitcnt lgkmcnt(0)
    v_pk_add_f32 v[116:117], v[116:117], v[68:69]
    v_pk_add_f32 v[118:119], v[118:119], v[70:71]
    v_pk_mul_f32 v[116:117], v[116:117], v[36:37]
    v_pk_mul_f32 v[118:119], v[118:119], v[38:39]
    v_cvt_pk_bf16_f32 v238, v116, v117
    v_cvt_pk_bf16_f32 v239, v118, v119
    s_nop 0
    v_permlane16_swap_b32 v236, v238
    v_permlane16_swap_b32 v237, v239
    buffer_store_dwordx4 v[236:239], v18, s[8:11], s19 offen offset:1024 sc1
    s_mov_b64 s[64:65], s[44:45]
    s_mov_b32 s66, 0x800
    s_mov_b32 s67, 0x20000
    s_mov_b64 s[76:77], s[32:33]
    s_mov_b32 s78, 0x400000
    s_mov_b32 s79, 0x20000
    s_mov_b64 s[68:69], s[56:57]
    s_mov_b32 s70, 0x400000
    s_mov_b32 s71, 0x20000
    s_lshl_b32 s14, s31, 1
    s_add_u32 s14, s14, s15
    s_lshl_b32 s14, s14, 3
    s_add_u32 s14, s14, s3
    s_lshl_b32 s16, s30, 7
    s_add_u32 s14, s14, s16
    s_lshl_b32 s16, s14, 11
    buffer_load_dwordx4 v[216:219], v2, s[76:79], s16 offen offset:0
    buffer_load_dwordx4 v[220:223], v2, s[76:79], s16 offen offset:1024
    s_lshl_b32 s16, s3, 10
    s_add_u32 m0, s16, 81920
    s_add_u32 s16, s16, 0x540800
    buffer_load_dwordx4 v2, s[8:11], s16 offen sc1 lds
    s_lshl_b32 s16, s30, 5
    s_lshl_b32 s17, s31, 1
    s_add_u32 s16, s16, s17
    s_add_u32 s16, s16, s15
    s_lshl_b32 s16, s16, 2
    s_add_u32 s16, s16, 0x530000
    s_cmp_eq_u32 s3, 0
    s_cselect_b32 s16, s16, 0x7ffffff0
    v_mov_b32 v16, s28
    v_mov_b32 v17, 0
    s_lshr_b32 s18, s14, 4
    s_lshl_b32 s18, s18, 15
    s_and_b32 s19, s14, 15
    s_lshl_b32 s19, s19, 6
    s_add_u32 s18, s18, s19
    s_add_u32 s18, s18, 0x2000000
    s_add_u32 s19, s18, 16384
    v_lshrrev_b32 v18, 2, v1
    v_lshlrev_b32 v18, 10, v18
    v_and_b32 v19, 3, v1
    v_lshl_add_u32 v18, v19, 4, v18
    v_add_u32 v19, 0x400000, v18
    s_lshl_b32 s25, s30, 7
    s_add_u32 s25, s25, 0x530000
    v_and_b32 v20, 15, v1
    v_lshlrev_b32 v20, 2, v20
    s_waitcnt vmcnt(3)
    s_waitcnt vmcnt(0)
    s_barrier
    s_mov_b64 exec, 1
    buffer_store_dword v16, v17, s[8:11], s16 offen sc1
    s_mov_b64 exec, -1
    v_add_u32 v16, 81920, v2
    ds_read_b128 v[184:187], v16 offset:0
    ds_read_b128 v[188:191], v16 offset:1024
    ds_read_b128 v[192:195], v16 offset:2048
    ds_read_b128 v[196:199], v16 offset:3072
    ds_read_b128 v[200:203], v16 offset:4096
    ds_read_b128 v[204:207], v16 offset:5120
    ds_read_b128 v[208:211], v16 offset:6144
    ds_read_b128 v[212:215], v16 offset:7168
    v_mov_b32 v94, 0
    v_mov_b32 v95, 0
    s_waitcnt lgkmcnt(5)
    v_lshlrev_b32 v76, 16, v192
    v_and_b32 v77, 0xffff0000, v192
    s_waitcnt lgkmcnt(1)
    v_lshlrev_b32 v78, 16, v208
    v_and_b32 v79, 0xffff0000, v208
    v_pk_mul_f32 v[60:61], v[76:77], v[78:79]
    v_lshlrev_b32 v76, 16, v184
    v_and_b32 v77, 0xffff0000, v184
    v_fmac_f32 v94, v76, v78
    v_fmac_f32 v94, v77, v79
    v_add_f32 v95, v95, v60
    v_add_f32 v95, v95, v61
    v_lshlrev_b32 v76, 16, v193
    v_and_b32 v77, 0xffff0000, v193
    v_lshlrev_b32 v78, 16, v209
    v_and_b32 v79, 0xffff0000, v209
    v_pk_mul_f32 v[62:63], v[76:77], v[78:79]
    v_lshlrev_b32 v76, 16, v185
    v_and_b32 v77, 0xffff0000, v185
    v_fmac_f32 v94, v76, v78
    v_fmac_f32 v94, v77, v79
    v_add_f32 v95, v95, v62
    v_add_f32 v95, v95, v63
    v_lshlrev_b32 v76, 16, v194
    v_and_b32 v77, 0xffff0000, v194
    v_lshlrev_b32 v78, 16, v210
    v_and_b32 v79, 0xffff0000, v210
    v_pk_mul_f32 v[64:65], v[76:77], v[78:79]
    v_lshlrev_b32 v76, 16, v186
    v_and_b32 v77, 0xffff0000, v186
    v_fmac_f32 v94, v76, v78
    v_fmac_f32 v94, v77, v79
    v_add_f32 v95, v95, v64
    v_add_f32 v95, v95, v65
    v_lshlrev_b32 v76, 16, v195
    v_and_b32 v77, 0xffff0000, v195
    v_lshlrev_b32 v78, 16, v211
    v_and_b32 v79, 0xffff0000, v211
    v_pk_mul_f32 v[66:67], v[76:77], v[78:79]
    v_lshlrev_b32 v76, 16, v187
    v_and_b32 v77, 0xffff0000, v187
    v_fmac_f32 v94, v76, v78
    v_fmac_f32 v94, v77, v79
    v_add_f32 v95, v95, v66
    v_add_f32 v95, v95, v67
    v_lshlrev_b32 v76, 16, v196
    v_and_b32 v77, 0xffff0000, v196
    s_waitcnt lgkmcnt(0)
    v_lshlrev_b32 v78, 16, v212
    v_and_b32 v79, 0xffff0000, v212
    v_pk_mul_f32 v[68:69], v[76:77], v[78:79]
    v_lshlrev_b32 v76, 16, v188
    v_and_b32 v77, 0xffff0000, v188
    v_fmac_f32 v94, v76, v78
    v_fmac_f32 v94, v77, v79
    v_add_f32 v95, v95, v68
    v_add_f32 v95, v95, v69
    v_lshlrev_b32 v76, 16, v197
    v_and_b32 v77, 0xffff0000, v197
    v_lshlrev_b32 v78, 16, v213
    v_and_b32 v79, 0xffff0000, v213
    v_pk_mul_f32 v[70:71], v[76:77], v[78:79]
    v_lshlrev_b32 v76, 16, v189
    v_and_b32 v77, 0xffff0000, v189
    v_fmac_f32 v94, v76, v78
    v_fmac_f32 v94, v77, v79
    v_add_f32 v95, v95, v70
    v_add_f32 v95, v95, v71
    v_lshlrev_b32 v76, 16, v198
    v_and_b32 v77, 0xffff0000, v198
    v_lshlrev_b32 v78, 16, v214
    v_and_b32 v79, 0xffff0000, v214
    v_pk_mul_f32 v[72:73], v[76:77], v[78:79]
    v_lshlrev_b32 v76, 16, v190
    v_and_b32 v77, 0xffff0000, v190
    v_fmac_f32 v94, v76, v78
    v_fmac_f32 v94, v77, v79
    v_add_f32 v95, v95, v72
    v_add_f32 v95, v95, v73
    v_lshlrev_b32 v76, 16, v199
    v_and_b32 v77, 0xffff0000, v199
    v_lshlrev_b32 v78, 16, v215
    v_and_b32 v79, 0xffff0000, v215
    v_pk_mul_f32 v[74:75], v[76:77], v[78:79]
    v_lshlrev_b32 v76, 16, v191
    v_and_b32 v77, 0xffff0000, v191
    v_fmac_f32 v94, v76, v78
    v_fmac_f32 v94, v77, v79
    v_add_f32 v95, v95, v74
    v_add_f32 v95, v95, v75
    v_add_f32_dpp v94, v94, v94 row_ror:1 row_mask:0xf bank_mask:0xf
    s_nop 0
    v_add_f32_dpp v95, v95, v95 row_ror:1 row_mask:0xf bank_mask:0xf
    v_add_f32_dpp v94, v94, v94 row_ror:2 row_mask:0xf bank_mask:0xf
    s_nop 0
    v_add_f32_dpp v95, v95, v95 row_ror:2 row_mask:0xf bank_mask:0xf
    v_add_f32_dpp v94, v94, v94 row_ror:4 row_mask:0xf bank_mask:0xf
    s_nop 0
    v_add_f32_dpp v95, v95, v95 row_ror:4 row_mask:0xf bank_mask:0xf
    v_add_f32_dpp v94, v94, v94 row_ror:8 row_mask:0xf bank_mask:0xf
    s_nop 0
    v_add_f32_dpp v95, v95, v95 row_ror:8 row_mask:0xf bank_mask:0xf
    v_mov_b32 v76, v94
    s_nop 1
    v_permlane16_swap_b32 v94, v76
    v_add_f32 v94, v94, v76
    v_mov_b32 v77, v95
    s_nop 1
    v_permlane16_swap_b32 v95, v77
    v_add_f32 v95, v95, v77
    v_mov_b32 v76, v94
    s_nop 1
    v_permlane32_swap_b32 v94, v76
    v_add_f32 v94, v94, v76
    v_mov_b32 v77, v95
    s_nop 1
    v_permlane32_swap_b32 v95, v77
    v_add_f32 v95, v95, v77
    v_lshlrev_b32 v28, 16, v216
    v_and_b32 v29, 0xffff0000, v216
    v_lshlrev_b32 v30, 16, v217
    v_and_b32 v31, 0xffff0000, v217
    v_lshlrev_b32 v32, 16, v218
    v_and_b32 v33, 0xffff0000, v218
    v_lshlrev_b32 v34, 16, v219
    v_and_b32 v35, 0xffff0000, v219
    v_lshlrev_b32 v36, 16, v220
    v_and_b32 v37, 0xffff0000, v220
    v_lshlrev_b32 v38, 16, v221
    v_and_b32 v39, 0xffff0000, v221
    v_lshlrev_b32 v40, 16, v222
    v_and_b32 v41, 0xffff0000, v222
    v_lshlrev_b32 v42, 16, v223
    v_and_b32 v43, 0xffff0000, v223
    s_mov_b32 s27, 0
adaLN_cond__sliding_block_cached__moe_arch_mod__prompt_kernel_a11p:
    buffer_load_dword v76, v20, s[8:11], s25 offen sc1
    s_waitcnt vmcnt(0)
    v_cmp_ne_u32 vcc, s28, v76
    s_add_u32 s27, s27, 1
    s_cmp_ge_u32 s27, 65536
    s_cbranch_scc1 adaLN_cond__sliding_block_cached__moe_arch_mod__prompt_kernel_a11g
    s_cbranch_vccnz adaLN_cond__sliding_block_cached__moe_arch_mod__prompt_kernel_a11p
adaLN_cond__sliding_block_cached__moe_arch_mod__prompt_kernel_a11g:
    buffer_load_dwordx4 v[44:47], v18, s[8:11], s18 offen sc1
    buffer_load_dwordx4 v[52:55], v19, s[8:11], s18 offen sc1
    buffer_load_dwordx4 v[48:51], v18, s[8:11], s19 offen sc1
    buffer_load_dwordx4 v[56:59], v19, s[8:11], s19 offen sc1
    v_lshlrev_b32 v21, 2, v0
    s_mov_b32 s16, 0x540800
    buffer_load_dword v106, v21, s[8:11], s16 offen sc1
    buffer_load_dword v104, v21, s[8:11], s16 offen offset:2048 sc1
    s_waitcnt vmcnt(5)
    v_lshlrev_b32 v76, 16, v44
    v_and_b32 v77, 0xffff0000, v44
    s_waitcnt vmcnt(4)
    v_lshlrev_b32 v78, 16, v52
    v_and_b32 v79, 0xffff0000, v52
    v_pk_add_f32 v[76:77], v[76:77], v[78:79]
    v_pk_add_f32 v[28:29], v[28:29], v[76:77]
    v_cvt_pk_bf16_f32 v16, v28, v29
    v_lshlrev_b32 v28, 16, v16
    v_and_b32 v29, 0xffff0000, v16
    v_lshlrev_b32 v80, 16, v45
    v_and_b32 v81, 0xffff0000, v45
    v_lshlrev_b32 v82, 16, v53
    v_and_b32 v83, 0xffff0000, v53
    v_pk_add_f32 v[80:81], v[80:81], v[82:83]
    v_pk_add_f32 v[30:31], v[30:31], v[80:81]
    v_cvt_pk_bf16_f32 v17, v30, v31
    v_lshlrev_b32 v30, 16, v17
    v_and_b32 v31, 0xffff0000, v17
    v_lshlrev_b32 v76, 16, v46
    v_and_b32 v77, 0xffff0000, v46
    v_lshlrev_b32 v78, 16, v54
    v_and_b32 v79, 0xffff0000, v54
    v_pk_add_f32 v[76:77], v[76:77], v[78:79]
    v_pk_add_f32 v[32:33], v[32:33], v[76:77]
    v_cvt_pk_bf16_f32 v16, v32, v33
    v_lshlrev_b32 v32, 16, v16
    v_and_b32 v33, 0xffff0000, v16
    v_lshlrev_b32 v80, 16, v47
    v_and_b32 v81, 0xffff0000, v47
    v_lshlrev_b32 v82, 16, v55
    v_and_b32 v83, 0xffff0000, v55
    v_pk_add_f32 v[80:81], v[80:81], v[82:83]
    v_pk_add_f32 v[34:35], v[34:35], v[80:81]
    v_cvt_pk_bf16_f32 v17, v34, v35
    v_lshlrev_b32 v34, 16, v17
    v_and_b32 v35, 0xffff0000, v17
    s_waitcnt vmcnt(3)
    v_lshlrev_b32 v76, 16, v48
    v_and_b32 v77, 0xffff0000, v48
    s_waitcnt vmcnt(2)
    v_lshlrev_b32 v78, 16, v56
    v_and_b32 v79, 0xffff0000, v56
    v_pk_add_f32 v[76:77], v[76:77], v[78:79]
    v_pk_add_f32 v[36:37], v[36:37], v[76:77]
    v_cvt_pk_bf16_f32 v16, v36, v37
    v_lshlrev_b32 v36, 16, v16
    v_and_b32 v37, 0xffff0000, v16
    v_lshlrev_b32 v80, 16, v49
    v_and_b32 v81, 0xffff0000, v49
    v_lshlrev_b32 v82, 16, v57
    v_and_b32 v83, 0xffff0000, v57
    v_pk_add_f32 v[80:81], v[80:81], v[82:83]
    v_pk_add_f32 v[38:39], v[38:39], v[80:81]
    v_cvt_pk_bf16_f32 v17, v38, v39
    v_lshlrev_b32 v38, 16, v17
    v_and_b32 v39, 0xffff0000, v17
    v_lshlrev_b32 v76, 16, v50
    v_and_b32 v77, 0xffff0000, v50
    v_lshlrev_b32 v78, 16, v58
    v_and_b32 v79, 0xffff0000, v58
    v_pk_add_f32 v[76:77], v[76:77], v[78:79]
    v_pk_add_f32 v[40:41], v[40:41], v[76:77]
    v_cvt_pk_bf16_f32 v16, v40, v41
    v_lshlrev_b32 v40, 16, v16
    v_and_b32 v41, 0xffff0000, v16
    v_lshlrev_b32 v80, 16, v51
    v_and_b32 v81, 0xffff0000, v51
    v_lshlrev_b32 v82, 16, v59
    v_and_b32 v83, 0xffff0000, v59
    v_pk_add_f32 v[80:81], v[80:81], v[82:83]
    v_pk_add_f32 v[42:43], v[42:43], v[80:81]
    v_cvt_pk_bf16_f32 v17, v42, v43
    v_lshlrev_b32 v42, 16, v17
    v_and_b32 v43, 0xffff0000, v17
    v_pk_add_f32 v[76:77], v[28:29], v[30:31]
    v_pk_mul_f32 v[78:79], v[28:29], v[28:29]
    v_pk_mul_f32 v[80:81], v[28:29], v[60:61]
    v_pk_fma_f32 v[78:79], v[30:31], v[30:31], v[78:79]
    v_pk_fma_f32 v[80:81], v[30:31], v[62:63], v[80:81]
    v_pk_add_f32 v[76:77], v[76:77], v[32:33]
    v_pk_fma_f32 v[78:79], v[32:33], v[32:33], v[78:79]
    v_pk_fma_f32 v[80:81], v[32:33], v[64:65], v[80:81]
    v_pk_add_f32 v[76:77], v[76:77], v[34:35]
    v_pk_fma_f32 v[78:79], v[34:35], v[34:35], v[78:79]
    v_pk_fma_f32 v[80:81], v[34:35], v[66:67], v[80:81]
    v_pk_add_f32 v[76:77], v[76:77], v[36:37]
    v_pk_fma_f32 v[78:79], v[36:37], v[36:37], v[78:79]
    v_pk_fma_f32 v[80:81], v[36:37], v[68:69], v[80:81]
    v_pk_add_f32 v[76:77], v[76:77], v[38:39]
    v_pk_fma_f32 v[78:79], v[38:39], v[38:39], v[78:79]
    v_pk_fma_f32 v[80:81], v[38:39], v[70:71], v[80:81]
    v_pk_add_f32 v[76:77], v[76:77], v[40:41]
    v_pk_fma_f32 v[78:79], v[40:41], v[40:41], v[78:79]
    v_pk_fma_f32 v[80:81], v[40:41], v[72:73], v[80:81]
    v_pk_add_f32 v[76:77], v[76:77], v[42:43]
    v_pk_fma_f32 v[78:79], v[42:43], v[42:43], v[78:79]
    v_pk_fma_f32 v[80:81], v[42:43], v[74:75], v[80:81]
    v_add_f32 v96, v76, v77
    v_add_f32 v97, v78, v79
    v_add_f32 v98, v80, v81
    v_add_f32_dpp v96, v96, v96 row_ror:1 row_mask:0xf bank_mask:0xf
    v_add_f32_dpp v97, v97, v97 row_ror:1 row_mask:0xf bank_mask:0xf
    v_add_f32_dpp v98, v98, v98 row_ror:1 row_mask:0xf bank_mask:0xf
    v_add_f32_dpp v96, v96, v96 row_ror:2 row_mask:0xf bank_mask:0xf
    v_add_f32_dpp v97, v97, v97 row_ror:2 row_mask:0xf bank_mask:0xf
    v_add_f32_dpp v98, v98, v98 row_ror:2 row_mask:0xf bank_mask:0xf
    v_add_f32_dpp v96, v96, v96 row_ror:4 row_mask:0xf bank_mask:0xf
    v_add_f32_dpp v97, v97, v97 row_ror:4 row_mask:0xf bank_mask:0xf
    v_add_f32_dpp v98, v98, v98 row_ror:4 row_mask:0xf bank_mask:0xf
    v_add_f32_dpp v96, v96, v96 row_ror:8 row_mask:0xf bank_mask:0xf
    v_add_f32_dpp v97, v97, v97 row_ror:8 row_mask:0xf bank_mask:0xf
    v_add_f32_dpp v98, v98, v98 row_ror:8 row_mask:0xf bank_mask:0xf
    v_mov_b32 v76, v96
    s_nop 1
    v_permlane16_swap_b32 v96, v76
    v_add_f32 v96, v96, v76
    v_mov_b32 v77, v97
    s_nop 1
    v_permlane16_swap_b32 v97, v77
    v_add_f32 v97, v97, v77
    v_mov_b32 v78, v98
    s_nop 1
    v_permlane16_swap_b32 v98, v78
    v_add_f32 v98, v98, v78
    v_mov_b32 v76, v96
    s_nop 1
    v_permlane32_swap_b32 v96, v76
    v_add_f32 v96, v96, v76
    v_mov_b32 v77, v97
    s_nop 1
    v_permlane32_swap_b32 v97, v77
    v_add_f32 v97, v97, v77
    v_mov_b32 v78, v98
    s_nop 1
    v_permlane32_swap_b32 v98, v78
    v_add_f32 v98, v98, v78
    v_mul_f32 v96, 0x3a800000, v96
    v_mul_f32 v97, 0x3a800000, v97
    v_fma_f32 v97, -v96, v96, v97
    v_max_f32 v97, 0, v97
    v_fma_f32 v98, -v96, v95, v98
    v_add_f32 v76, 0x3727c5ac, v97
    v_rsq_f32 v76, v76
    s_nop 0
    v_fma_f32 v27, v98, v76, v94
    v_cvt_pk_bf16_f32 v96, v96, v96
    v_lshlrev_b32 v96, 16, v96
    v_cvt_pk_bf16_f32 v97, v97, v97
    v_lshlrev_b32 v97, 16, v97
    v_add_f32 v97, 0x3727c5ac, v97
    v_cvt_pk_bf16_f32 v97, v97, v97
    v_lshlrev_b32 v97, 16, v97
    v_sqrt_f32 v98, v97
    s_nop 0
    v_cvt_pk_bf16_f32 v98, v98, v98
    v_lshlrev_b32 v98, 16, v98
    v_rcp_f32 v99, v98
    v_mov_b32 v25, v96
    v_mov_b32 v26, v98
    v_ashrrev_i32 v16, 31, v27
    v_or_b32 v16, 0x80000000, v16
    v_xor_b32 v24, v27, v16
    v_and_b32 v24, 0xfffff800, v24
    v_max_u32 v24, 0x800, v24
    s_sub_u32 s16, 2047, s14
    v_or_b32 v24, s16, v24
    s_lshl_b32 s16, s3, 4
    s_add_u32 s16, s16, 65536
    v_mov_b32 v16, s16
    ds_write_b128 v16, v[24:27]
    s_waitcnt lgkmcnt(0)
    s_barrier
    v_and_b32 v16, 7, v1
    v_lshlrev_b32 v16, 4, v16
    v_add_u32 v16, 65536, v16
    ds_read_b32 v76, v16
    s_waitcnt lgkmcnt(0)
    v_mov_b32 v77, v76
    s_nop 1
    v_max_u32_dpp v77, v77, v77 row_ror:1 row_mask:0xf bank_mask:0xf
    s_nop 1
    v_max_u32_dpp v77, v77, v77 row_ror:2 row_mask:0xf bank_mask:0xf
    s_nop 1
    v_max_u32_dpp v77, v77, v77 row_ror:4 row_mask:0xf bank_mask:0xf
    v_cmp_eq_u32 vcc, v76, v77
    s_ff1_i32_b64 s16, vcc
    s_lshl_b32 s16, s16, 4
    s_add_u32 s16, s16, 65536
    v_mov_b32 v16, s16
    ds_read_b128 v[24:27], v16
    s_lshl_b32 s16, s2, 4
    s_add_u32 s16, s16, 0x6e0000
    s_cmp_eq_u32 s3, 0
    s_cselect_b32 s16, s16, 0x7ffffff0
    v_mov_b32 v17, 0
    s_mov_b64 exec, 1
    s_waitcnt lgkmcnt(0)
    buffer_store_dwordx4 v[24:27], v17, s[8:11], s16 offen sc1
    s_mov_b64 exec, -1
    v_sub_f32 v44, v28, v96
    v_sub_f32 v45, v29, v96
    v_sub_f32 v46, v30, v96
    v_sub_f32 v47, v31, v96
    v_sub_f32 v48, v32, v96
    v_sub_f32 v49, v33, v96
    v_sub_f32 v50, v34, v96
    v_sub_f32 v51, v35, v96
    v_cvt_pk_bf16_f32 v16, v44, v45
    v_lshlrev_b32 v44, 16, v16
    v_and_b32 v45, 0xffff0000, v16
    v_cvt_pk_bf16_f32 v16, v46, v47
    v_lshlrev_b32 v46, 16, v16
    v_and_b32 v47, 0xffff0000, v16
    v_cvt_pk_bf16_f32 v16, v48, v49
    v_lshlrev_b32 v48, 16, v16
    v_and_b32 v49, 0xffff0000, v16
    v_cvt_pk_bf16_f32 v16, v50, v51
    v_lshlrev_b32 v50, 16, v16
    v_and_b32 v51, 0xffff0000, v16
    v_mul_f32 v52, v44, v99
    v_mul_f32 v53, v45, v99
    v_mul_f32 v54, v46, v99
    v_mul_f32 v55, v47, v99
    v_mul_f32 v56, v48, v99
    v_mul_f32 v57, v49, v99
    v_mul_f32 v58, v50, v99
    v_mul_f32 v59, v51, v99
    v_fma_f32 v44, -v52, v98, v44
    v_fma_f32 v45, -v53, v98, v45
    v_fma_f32 v46, -v54, v98, v46
    v_fma_f32 v47, -v55, v98, v47
    v_fma_f32 v48, -v56, v98, v48
    v_fma_f32 v49, -v57, v98, v49
    v_fma_f32 v50, -v58, v98, v50
    v_fma_f32 v51, -v59, v98, v51
    v_fma_f32 v44, v44, v99, v52
    v_fma_f32 v45, v45, v99, v53
    v_fma_f32 v46, v46, v99, v54
    v_fma_f32 v47, v47, v99, v55
    v_fma_f32 v48, v48, v99, v56
    v_fma_f32 v49, v49, v99, v57
    v_fma_f32 v50, v50, v99, v58
    v_fma_f32 v51, v51, v99, v59
    v_cvt_pk_bf16_f32 v16, v44, v45
    v_lshlrev_b32 v44, 16, v16
    v_and_b32 v45, 0xffff0000, v16
    v_cvt_pk_bf16_f32 v16, v46, v47
    v_lshlrev_b32 v46, 16, v16
    v_and_b32 v47, 0xffff0000, v16
    v_cvt_pk_bf16_f32 v16, v48, v49
    v_lshlrev_b32 v48, 16, v16
    v_and_b32 v49, 0xffff0000, v16
    v_cvt_pk_bf16_f32 v16, v50, v51
    v_lshlrev_b32 v50, 16, v16
    v_and_b32 v51, 0xffff0000, v16
    v_lshlrev_b32 v52, 16, v192
    v_and_b32 v53, 0xffff0000, v192
    v_lshlrev_b32 v54, 16, v193
    v_and_b32 v55, 0xffff0000, v193
    v_lshlrev_b32 v56, 16, v194
    v_and_b32 v57, 0xffff0000, v194
    v_lshlrev_b32 v58, 16, v195
    v_and_b32 v59, 0xffff0000, v195
    v_pk_mul_f32 v[44:45], v[44:45], v[52:53]
    v_pk_mul_f32 v[46:47], v[46:47], v[54:55]
    v_pk_mul_f32 v[48:49], v[48:49], v[56:57]
    v_pk_mul_f32 v[50:51], v[50:51], v[58:59]
    v_cvt_pk_bf16_f32 v16, v44, v45
    v_lshlrev_b32 v44, 16, v16
    v_and_b32 v45, 0xffff0000, v16
    v_cvt_pk_bf16_f32 v16, v46, v47
    v_lshlrev_b32 v46, 16, v16
    v_and_b32 v47, 0xffff0000, v16
    v_cvt_pk_bf16_f32 v16, v48, v49
    v_lshlrev_b32 v48, 16, v16
    v_and_b32 v49, 0xffff0000, v16
    v_cvt_pk_bf16_f32 v16, v50, v51
    v_lshlrev_b32 v50, 16, v16
    v_and_b32 v51, 0xffff0000, v16
    v_lshlrev_b32 v52, 16, v184
    v_and_b32 v53, 0xffff0000, v184
    v_lshlrev_b32 v54, 16, v185
    v_and_b32 v55, 0xffff0000, v185
    v_lshlrev_b32 v56, 16, v186
    v_and_b32 v57, 0xffff0000, v186
    v_lshlrev_b32 v58, 16, v187
    v_and_b32 v59, 0xffff0000, v187
    v_pk_add_f32 v[44:45], v[44:45], v[52:53]
    v_pk_add_f32 v[46:47], v[46:47], v[54:55]
    v_pk_add_f32 v[48:49], v[48:49], v[56:57]
    v_pk_add_f32 v[50:51], v[50:51], v[58:59]
    v_cvt_pk_bf16_f32 v16, v44, v45
    v_lshlrev_b32 v44, 16, v16
    v_and_b32 v45, 0xffff0000, v16
    v_cvt_pk_bf16_f32 v16, v46, v47
    v_lshlrev_b32 v46, 16, v16
    v_and_b32 v47, 0xffff0000, v16
    v_cvt_pk_bf16_f32 v16, v48, v49
    v_lshlrev_b32 v48, 16, v16
    v_and_b32 v49, 0xffff0000, v16
    v_cvt_pk_bf16_f32 v16, v50, v51
    v_lshlrev_b32 v50, 16, v16
    v_and_b32 v51, 0xffff0000, v16
    v_lshlrev_b32 v52, 16, v200
    v_and_b32 v53, 0xffff0000, v200
    v_lshlrev_b32 v54, 16, v201
    v_and_b32 v55, 0xffff0000, v201
    v_lshlrev_b32 v56, 16, v202
    v_and_b32 v57, 0xffff0000, v202
    v_lshlrev_b32 v58, 16, v203
    v_and_b32 v59, 0xffff0000, v203
    v_pk_mul_f32 v[44:45], v[44:45], v[52:53]
    v_pk_mul_f32 v[46:47], v[46:47], v[54:55]
    v_pk_mul_f32 v[48:49], v[48:49], v[56:57]
    v_pk_mul_f32 v[50:51], v[50:51], v[58:59]
    v_cvt_pk_bf16_f32 v16, v44, v45
    v_lshlrev_b32 v44, 16, v16
    v_and_b32 v45, 0xffff0000, v16
    v_cvt_pk_bf16_f32 v16, v46, v47
    v_lshlrev_b32 v46, 16, v16
    v_and_b32 v47, 0xffff0000, v16
    v_cvt_pk_bf16_f32 v16, v48, v49
    v_lshlrev_b32 v48, 16, v16
    v_and_b32 v49, 0xffff0000, v16
    v_cvt_pk_bf16_f32 v16, v50, v51
    v_lshlrev_b32 v50, 16, v16
    v_and_b32 v51, 0xffff0000, v16
    v_pk_add_f32 v[44:45], v[44:45], v[28:29]
    v_pk_add_f32 v[46:47], v[46:47], v[30:31]
    v_pk_add_f32 v[48:49], v[48:49], v[32:33]
    v_pk_add_f32 v[50:51], v[50:51], v[34:35]
    v_cvt_pk_bf16_f32 v28, v44, v45
    v_cvt_pk_bf16_f32 v29, v46, v47
    v_cvt_pk_bf16_f32 v30, v48, v49
    v_cvt_pk_bf16_f32 v31, v50, v51
    v_sub_f32 v44, v36, v96
    v_sub_f32 v45, v37, v96
    v_sub_f32 v46, v38, v96
    v_sub_f32 v47, v39, v96
    v_sub_f32 v48, v40, v96
    v_sub_f32 v49, v41, v96
    v_sub_f32 v50, v42, v96
    v_sub_f32 v51, v43, v96
    v_cvt_pk_bf16_f32 v16, v44, v45
    v_lshlrev_b32 v44, 16, v16
    v_and_b32 v45, 0xffff0000, v16
    v_cvt_pk_bf16_f32 v16, v46, v47
    v_lshlrev_b32 v46, 16, v16
    v_and_b32 v47, 0xffff0000, v16
    v_cvt_pk_bf16_f32 v16, v48, v49
    v_lshlrev_b32 v48, 16, v16
    v_and_b32 v49, 0xffff0000, v16
    v_cvt_pk_bf16_f32 v16, v50, v51
    v_lshlrev_b32 v50, 16, v16
    v_and_b32 v51, 0xffff0000, v16
    v_mul_f32 v52, v44, v99
    v_mul_f32 v53, v45, v99
    v_mul_f32 v54, v46, v99
    v_mul_f32 v55, v47, v99
    v_mul_f32 v56, v48, v99
    v_mul_f32 v57, v49, v99
    v_mul_f32 v58, v50, v99
    v_mul_f32 v59, v51, v99
    v_fma_f32 v44, -v52, v98, v44
    v_fma_f32 v45, -v53, v98, v45
    v_fma_f32 v46, -v54, v98, v46
    v_fma_f32 v47, -v55, v98, v47
    v_fma_f32 v48, -v56, v98, v48
    v_fma_f32 v49, -v57, v98, v49
    v_fma_f32 v50, -v58, v98, v50
    v_fma_f32 v51, -v59, v98, v51
    v_fma_f32 v44, v44, v99, v52
    v_fma_f32 v45, v45, v99, v53
    v_fma_f32 v46, v46, v99, v54
    v_fma_f32 v47, v47, v99, v55
    v_fma_f32 v48, v48, v99, v56
    v_fma_f32 v49, v49, v99, v57
    v_fma_f32 v50, v50, v99, v58
    v_fma_f32 v51, v51, v99, v59
    v_cvt_pk_bf16_f32 v16, v44, v45
    v_lshlrev_b32 v44, 16, v16
    v_and_b32 v45, 0xffff0000, v16
    v_cvt_pk_bf16_f32 v16, v46, v47
    v_lshlrev_b32 v46, 16, v16
    v_and_b32 v47, 0xffff0000, v16
    v_cvt_pk_bf16_f32 v16, v48, v49
    v_lshlrev_b32 v48, 16, v16
    v_and_b32 v49, 0xffff0000, v16
    v_cvt_pk_bf16_f32 v16, v50, v51
    v_lshlrev_b32 v50, 16, v16
    v_and_b32 v51, 0xffff0000, v16
    v_lshlrev_b32 v52, 16, v196
    v_and_b32 v53, 0xffff0000, v196
    v_lshlrev_b32 v54, 16, v197
    v_and_b32 v55, 0xffff0000, v197
    v_lshlrev_b32 v56, 16, v198
    v_and_b32 v57, 0xffff0000, v198
    v_lshlrev_b32 v58, 16, v199
    v_and_b32 v59, 0xffff0000, v199
    v_pk_mul_f32 v[44:45], v[44:45], v[52:53]
    v_pk_mul_f32 v[46:47], v[46:47], v[54:55]
    v_pk_mul_f32 v[48:49], v[48:49], v[56:57]
    v_pk_mul_f32 v[50:51], v[50:51], v[58:59]
    v_cvt_pk_bf16_f32 v16, v44, v45
    v_lshlrev_b32 v44, 16, v16
    v_and_b32 v45, 0xffff0000, v16
    v_cvt_pk_bf16_f32 v16, v46, v47
    v_lshlrev_b32 v46, 16, v16
    v_and_b32 v47, 0xffff0000, v16
    v_cvt_pk_bf16_f32 v16, v48, v49
    v_lshlrev_b32 v48, 16, v16
    v_and_b32 v49, 0xffff0000, v16
    v_cvt_pk_bf16_f32 v16, v50, v51
    v_lshlrev_b32 v50, 16, v16
    v_and_b32 v51, 0xffff0000, v16
    v_lshlrev_b32 v52, 16, v188
    v_and_b32 v53, 0xffff0000, v188
    v_lshlrev_b32 v54, 16, v189
    v_and_b32 v55, 0xffff0000, v189
    v_lshlrev_b32 v56, 16, v190
    v_and_b32 v57, 0xffff0000, v190
    v_lshlrev_b32 v58, 16, v191
    v_and_b32 v59, 0xffff0000, v191
    v_pk_add_f32 v[44:45], v[44:45], v[52:53]
    v_pk_add_f32 v[46:47], v[46:47], v[54:55]
    v_pk_add_f32 v[48:49], v[48:49], v[56:57]
    v_pk_add_f32 v[50:51], v[50:51], v[58:59]
    v_cvt_pk_bf16_f32 v16, v44, v45
    v_lshlrev_b32 v44, 16, v16
    v_and_b32 v45, 0xffff0000, v16
    v_cvt_pk_bf16_f32 v16, v46, v47
    v_lshlrev_b32 v46, 16, v16
    v_and_b32 v47, 0xffff0000, v16
    v_cvt_pk_bf16_f32 v16, v48, v49
    v_lshlrev_b32 v48, 16, v16
    v_and_b32 v49, 0xffff0000, v16
    v_cvt_pk_bf16_f32 v16, v50, v51
    v_lshlrev_b32 v50, 16, v16
    v_and_b32 v51, 0xffff0000, v16
    v_lshlrev_b32 v52, 16, v204
    v_and_b32 v53, 0xffff0000, v204
    v_lshlrev_b32 v54, 16, v205
    v_and_b32 v55, 0xffff0000, v205
    v_lshlrev_b32 v56, 16, v206
    v_and_b32 v57, 0xffff0000, v206
    v_lshlrev_b32 v58, 16, v207
    v_and_b32 v59, 0xffff0000, v207
    v_pk_mul_f32 v[44:45], v[44:45], v[52:53]
    v_pk_mul_f32 v[46:47], v[46:47], v[54:55]
    v_pk_mul_f32 v[48:49], v[48:49], v[56:57]
    v_pk_mul_f32 v[50:51], v[50:51], v[58:59]
    v_cvt_pk_bf16_f32 v16, v44, v45
    v_lshlrev_b32 v44, 16, v16
    v_and_b32 v45, 0xffff0000, v16
    v_cvt_pk_bf16_f32 v16, v46, v47
    v_lshlrev_b32 v46, 16, v16
    v_and_b32 v47, 0xffff0000, v16
    v_cvt_pk_bf16_f32 v16, v48, v49
    v_lshlrev_b32 v48, 16, v16
    v_and_b32 v49, 0xffff0000, v16
    v_cvt_pk_bf16_f32 v16, v50, v51
    v_lshlrev_b32 v50, 16, v16
    v_and_b32 v51, 0xffff0000, v16
    v_pk_add_f32 v[44:45], v[44:45], v[36:37]
    v_pk_add_f32 v[46:47], v[46:47], v[38:39]
    v_pk_add_f32 v[48:49], v[48:49], v[40:41]
    v_pk_add_f32 v[50:51], v[50:51], v[42:43]
    v_cvt_pk_bf16_f32 v36, v44, v45
    v_cvt_pk_bf16_f32 v37, v46, v47
    v_cvt_pk_bf16_f32 v38, v48, v49
    v_cvt_pk_bf16_f32 v39, v50, v51
    v_lshlrev_b32 v18, 4, v0
    s_mov_b32 s16, 0x6e0000
    s_mov_b32 s27, 0
adaLN_cond__sliding_block_cached__moe_arch_mod__prompt_kernel_w12p:
    buffer_load_dwordx4 v[24:27], v18, s[8:11], s16 offen sc1
    s_waitcnt vmcnt(0)
    v_cmp_eq_u32 vcc, 0, v24
    s_add_u32 s27, s27, 1
    s_cmp_ge_u32 s27, 65536
    s_cbranch_scc1 adaLN_cond__sliding_block_cached__moe_arch_mod__prompt_kernel_w12g
    s_cbranch_vccnz adaLN_cond__sliding_block_cached__moe_arch_mod__prompt_kernel_w12p
adaLN_cond__sliding_block_cached__moe_arch_mod__prompt_kernel_w12g:
    v_mov_b32 v76, v24
    s_nop 1
    v_max_u32_dpp v76, v76, v76 row_ror:1 row_mask:0xf bank_mask:0xf
    s_nop 1
    v_max_u32_dpp v76, v76, v76 row_ror:2 row_mask:0xf bank_mask:0xf
    s_nop 1
    v_max_u32_dpp v76, v76, v76 row_ror:4 row_mask:0xf bank_mask:0xf
    s_nop 1
    v_max_u32_dpp v76, v76, v76 row_ror:8 row_mask:0xf bank_mask:0xf
    v_mov_b32 v77, v76
    s_nop 1
    v_permlane16_swap_b32 v76, v77
    v_max_u32 v76, v76, v77
    v_mov_b32 v77, v76
    s_nop 1
    v_permlane32_swap_b32 v76, v77
    v_max_u32 v76, v76, v77
    v_cmp_eq_u32 vcc, v76, v24
    s_lshl_b32 s16, s3, 4
    s_add_u32 s16, s16, 65792
    v_mov_b32 v16, s16
    s_and_saveexec_b64 s[62:63], vcc
    ds_write_b128 v16, v[24:27]
    s_mov_b64 exec, s[62:63]
    s_waitcnt lgkmcnt(0)
    s_barrier
    v_and_b32 v16, 3, v1
    v_lshlrev_b32 v16, 4, v16
    v_add_u32 v16, 65792, v16
    ds_read_b32 v76, v16
    s_waitcnt lgkmcnt(0)
    v_mov_b32 v77, v76
    s_nop 1
    v_max_u32_dpp v77, v77, v77 row_ror:1 row_mask:0xf bank_mask:0xf
    s_nop 1
    v_max_u32_dpp v77, v77, v77 row_ror:2 row_mask:0xf bank_mask:0xf
    v_cmp_eq_u32 vcc, v76, v77
    s_ff1_i32_b64 s16, vcc
    s_lshl_b32 s16, s16, 4
    s_add_u32 s16, s16, 65792
    v_mov_b32 v16, s16
    ds_read_b128 v[24:27], v16
    s_waitcnt lgkmcnt(0)
    v_and_b32 v76, 0x7ff, v24
    v_sub_u32 v76, 2047, v76
    s_nop 0
    v_readfirstlane_b32 s12, v76
    v_rcp_f32 v103, v26
    s_lshr_b32 s18, s12, 4
    s_lshl_b32 s18, s18, 15
    s_and_b32 s19, s12, 15
    s_lshl_b32 s19, s19, 6
    s_add_u32 s18, s18, s19
    s_add_u32 s18, s18, 0x2000000
    s_add_u32 s19, s18, 0x400000
    v_lshrrev_b32 v18, 4, v0
    v_lshlrev_b32 v18, 10, v18
    v_and_b32 v19, 15, v0
    v_lshl_add_u32 v18, v19, 2, v18
    s_lshl_b32 s13, s12, 11
    buffer_load_dword v100, v18, s[8:11], s18 offen sc1
    buffer_load_dword v101, v18, s[8:11], s19 offen sc1
    buffer_load_dword v102, v21, s[76:79], s13 offen
    s_lshl_b32 s16, s14, 11
    s_cmp_lg_u32 s12, s14
    s_cselect_b32 s16, s16, 0x7ffffff0
    buffer_store_dwordx4 v[28:31], v2, s[68:71], s16 offen offset:0 sc1
    buffer_store_dwordx4 v[36:39], v2, s[68:71], s16 offen offset:1024 sc1
    s_lshl_b32 s16, s3, 13
    v_add_u32 v20, s16, v2
    s_waitcnt vmcnt(4)
    v_lshlrev_b32 v76, 16, v100
    v_and_b32 v77, 0xffff0000, v100
    s_waitcnt vmcnt(3)
    v_lshlrev_b32 v78, 16, v101
    v_and_b32 v79, 0xffff0000, v101
    v_pk_add_f32 v[76:77], v[76:77], v[78:79]
    s_waitcnt vmcnt(2)
    v_lshlrev_b32 v78, 16, v102
    v_and_b32 v79, 0xffff0000, v102
    v_pk_add_f32 v[92:93], v[78:79], v[76:77]
    v_cvt_pk_bf16_f32 v76, v92, v93
    v_lshlrev_b32 v92, 16, v76
    v_and_b32 v93, 0xffff0000, v76
    v_cvt_pk_bf16_f32 v100, v92, v93
    v_and_b32 v105, 0xffff0000, v104
    v_lshlrev_b32 v104, 16, v104
    v_and_b32 v107, 0xffff0000, v106
    v_lshlrev_b32 v106, 16, v106
    v_sub_f32 v92, v92, v25
    v_sub_f32 v93, v93, v25
    v_cvt_pk_bf16_f32 v76, v92, v93
    v_lshlrev_b32 v92, 16, v76
    v_and_b32 v93, 0xffff0000, v76
    v_mul_f32 v77, v92, v103
    v_fma_f32 v92, -v77, v26, v92
    v_fma_f32 v92, v92, v103, v77
    v_mul_f32 v77, v93, v103
    v_fma_f32 v93, -v77, v26, v93
    v_fma_f32 v93, v93, v103, v77
    v_cvt_pk_bf16_f32 v76, v92, v93
    v_lshlrev_b32 v92, 16, v76
    v_and_b32 v93, 0xffff0000, v76
    v_mul_f32 v92, v92, v104
    v_mul_f32 v93, v93, v105
    v_cvt_pk_bf16_f32 v76, v92, v93
    v_lshlrev_b32 v92, 16, v76
    v_and_b32 v93, 0xffff0000, v76
    v_add_f32 v92, v92, v106
    v_add_f32 v93, v93, v107
    v_cvt_pk_bf16_f32 v101, v92, v93
    v_add_u32 v16, 66560, v21
    ds_write_b32 v16, v101
    ds_write_b32 v16, v100 offset:2048
    s_waitcnt lgkmcnt(0)
    s_barrier
    ds_read_b128 v[60:63], v20 offset:0
    ds_read_b128 v[64:67], v20 offset:1024
    ds_read_b128 v[68:71], v20 offset:2048
    ds_read_b128 v[72:75], v20 offset:3072
    ds_read_b128 v[108:111], v20 offset:4096
    ds_read_b128 v[112:115], v20 offset:5120
    ds_read_b128 v[116:119], v20 offset:6144
    ds_read_b128 v[120:123], v20 offset:7168
    s_and_b32 s16, s3, 3
    s_lshl_b32 s16, s16, 7
    s_and_b32 s17, s29, 3
    s_lshl_b32 s17, s17, 9
    s_add_u32 s16, s16, s17
    s_add_u32 s16, s16, 66560
    v_lshrrev_b32 v16, 3, v1
    v_lshlrev_b32 v16, 4, v16
    v_add_u32 v16, s16, v16
    ds_read_b128 v[104:107], v16
    s_waitcnt lgkmcnt(0)
    v_lshlrev_b32 v76, 16, v104
    v_and_b32 v77, 0xffff, v104
    v_dot2_f32_bf16 v85, v60, v76, 0
    v_dot2_f32_bf16 v84, v60, v77, 0
    v_dot2_f32_bf16 v87, v61, v76, 0
    v_dot2_f32_bf16 v86, v61, v77, 0
    v_dot2_f32_bf16 v89, v62, v76, 0
    v_dot2_f32_bf16 v88, v62, v77, 0
    v_dot2_f32_bf16 v91, v63, v76, 0
    v_dot2_f32_bf16 v90, v63, v77, 0
    v_and_b32 v78, 0xffff0000, v104
    v_lshrrev_b32 v79, 16, v104
    v_dot2c_f32_bf16 v85, v64, v78
    v_dot2c_f32_bf16 v84, v64, v79
    v_dot2c_f32_bf16 v87, v65, v78
    v_dot2c_f32_bf16 v86, v65, v79
    v_dot2c_f32_bf16 v89, v66, v78
    v_dot2c_f32_bf16 v88, v66, v79
    v_dot2c_f32_bf16 v91, v67, v78
    v_dot2c_f32_bf16 v90, v67, v79
    v_lshlrev_b32 v80, 16, v105
    v_and_b32 v81, 0xffff, v105
    v_dot2c_f32_bf16 v85, v68, v80
    v_dot2c_f32_bf16 v84, v68, v81
    v_dot2c_f32_bf16 v87, v69, v80
    v_dot2c_f32_bf16 v86, v69, v81
    v_dot2c_f32_bf16 v89, v70, v80
    v_dot2c_f32_bf16 v88, v70, v81
    v_dot2c_f32_bf16 v91, v71, v80
    v_dot2c_f32_bf16 v90, v71, v81
    v_and_b32 v82, 0xffff0000, v105
    v_lshrrev_b32 v83, 16, v105
    v_dot2c_f32_bf16 v85, v72, v82
    v_dot2c_f32_bf16 v84, v72, v83
    v_dot2c_f32_bf16 v87, v73, v82
    v_dot2c_f32_bf16 v86, v73, v83
    v_dot2c_f32_bf16 v89, v74, v82
    v_dot2c_f32_bf16 v88, v74, v83
    v_dot2c_f32_bf16 v91, v75, v82
    v_dot2c_f32_bf16 v90, v75, v83
    v_lshlrev_b32 v76, 16, v106
    v_and_b32 v77, 0xffff, v106
    v_dot2c_f32_bf16 v85, v108, v76
    v_dot2c_f32_bf16 v84, v108, v77
    v_dot2c_f32_bf16 v87, v109, v76
    v_dot2c_f32_bf16 v86, v109, v77
    v_dot2c_f32_bf16 v89, v110, v76
    v_dot2c_f32_bf16 v88, v110, v77
    v_dot2c_f32_bf16 v91, v111, v76
    v_dot2c_f32_bf16 v90, v111, v77
    v_and_b32 v78, 0xffff0000, v106
    v_lshrrev_b32 v79, 16, v106
    v_dot2c_f32_bf16 v85, v112, v78
    v_dot2c_f32_bf16 v84, v112, v79
    v_dot2c_f32_bf16 v87, v113, v78
    v_dot2c_f32_bf16 v86, v113, v79
    v_dot2c_f32_bf16 v89, v114, v78
    v_dot2c_f32_bf16 v88, v114, v79
    v_dot2c_f32_bf16 v91, v115, v78
    v_dot2c_f32_bf16 v90, v115, v79
    v_lshlrev_b32 v80, 16, v107
    v_and_b32 v81, 0xffff, v107
    v_dot2c_f32_bf16 v85, v116, v80
    v_dot2c_f32_bf16 v84, v116, v81
    v_dot2c_f32_bf16 v87, v117, v80
    v_dot2c_f32_bf16 v86, v117, v81
    v_dot2c_f32_bf16 v89, v118, v80
    v_dot2c_f32_bf16 v88, v118, v81
    v_dot2c_f32_bf16 v91, v119, v80
    v_dot2c_f32_bf16 v90, v119, v81
    v_and_b32 v82, 0xffff0000, v107
    v_lshrrev_b32 v83, 16, v107
    v_dot2c_f32_bf16 v85, v120, v82
    v_dot2c_f32_bf16 v84, v120, v83
    v_dot2c_f32_bf16 v87, v121, v82
    v_dot2c_f32_bf16 v86, v121, v83
    v_dot2c_f32_bf16 v89, v122, v82
    v_dot2c_f32_bf16 v88, v122, v83
    v_dot2c_f32_bf16 v91, v123, v82
    v_dot2c_f32_bf16 v90, v123, v83
    s_nop 0
    v_permlane32_swap_b32 v84, v88
    v_permlane32_swap_b32 v85, v89
    v_permlane32_swap_b32 v86, v90
    v_permlane32_swap_b32 v87, v91
    v_add_f32 v84, v84, v88
    v_add_f32 v85, v85, v89
    v_add_f32 v86, v86, v90
    v_add_f32 v87, v87, v91
    s_nop 0
    v_permlane16_swap_b32 v84, v86
    v_permlane16_swap_b32 v85, v87
    v_add_f32 v84, v84, v86
    v_add_f32 v85, v85, v87
    s_nop 0
    v_add_f32_dpp v84, v84, v84 row_ror:8 row_mask:0xf bank_mask:0xf
    v_add_f32_dpp v85, v85, v85 row_ror:8 row_mask:0xf bank_mask:0xf
    v_and_b32 v16, 7, v1
    v_lshlrev_b32 v16, 5, v16
    v_lshrrev_b32 v17, 4, v1
    v_lshl_add_u32 v16, v17, 3, v16
    s_lshl_b32 s16, s3, 8
    s_add_u32 s16, s16, 70656
    v_add_u32 v16, s16, v16
    ds_write_b64 v16, v[84:85]
    s_lshr_b32 s16, s3, 2
    s_lshl_b32 s17, s16, 10
    s_add_u32 s17, s17, 70656
    v_lshlrev_b32 v17, 2, v1
    v_add_u32 v16, s17, v17
    s_and_b32 s17, s29, 3
    s_lshl_b32 s17, s17, 1
    s_add_u32 s17, s17, s16
    s_mul_i32 s17, s17, 14336
    s_lshr_b32 s16, s29, 2
    s_lshl_b32 s16, s16, 8
    s_add_u32 s17, s17, s16
    s_add_u32 s17, s17, 0x6e1000
    s_and_b32 s16, s3, 3
    s_cmp_eq_u32 s16, 0
    s_cselect_b32 s17, s17, 0x7ffffff0
    s_cmp_lt_u32 s2, 224
    s_cselect_b32 s17, s17, 0x7ffffff0
    s_waitcnt lgkmcnt(0)
    s_barrier
    ds_read_b32 v84, v16 offset:0
    ds_read_b32 v85, v16 offset:256
    ds_read_b32 v86, v16 offset:512
    ds_read_b32 v87, v16 offset:768
    s_waitcnt lgkmcnt(2)
    v_add_f32 v84, v84, v85
    s_waitcnt lgkmcnt(0)
    v_add_f32 v86, v86, v87
    v_add_f32 v84, v84, v86
    v_or_b32 v84, 1, v84
    buffer_store_dword v84, v17, s[8:11], s17 offen sc1
    s_barrier
    v_lshlrev_b32 v16, 3, v0
    v_add_u32 v17, 73728, v16
    ds_read_b64 v[84:85], v17 offset:0
    ds_read_b64 v[86:87], v17 offset:4096
    ds_read_b64 v[88:89], v17 offset:8192
    ds_read_b64 v[90:91], v17 offset:12288
    s_waitcnt lgkmcnt(2)
    v_pk_add_f32 v[84:85], v[84:85], v[86:87]
    s_waitcnt lgkmcnt(0)
    v_pk_add_f32 v[88:89], v[88:89], v[90:91]
    v_pk_add_f32 v[84:85], v[84:85], v[88:89]
    v_or_b32 v84, 1, v84
    v_or_b32 v85, 1, v85
    s_lshl_b32 s16, s29, 12
    s_add_u32 s16, s16, 0x600000
    s_cmp_lt_u32 s2, 224
    s_cselect_b32 s16, s16, 0x7ffffff0
    buffer_store_dwordx2 v[84:85], v16, s[8:11], s16 offen sc1
    s_cmp_lt_u32 s2, 224
    s_cbranch_scc1 adaLN_cond__sliding_block_cached__moe_arch_mod__prompt_kernel_end
    s_sub_u32 s16, s2, 224
    s_lshl_b32 s17, s16, 7
    s_add_u32 s17, s17, 0x600000
    v_lshrrev_b32 v16, 3, v0
    v_lshlrev_b32 v16, 12, v16
    v_and_b32 v17, 7, v0
    v_lshl_add_u32 v16, v17, 4, v16
    v_cmp_gt_u32 vcc, 256, v0
    v_bfrev_b32 v17, -2
    s_nop 0
    v_cndmask_b32 v17, v17, v16, vcc
    v_mov_b32 v19, 0
    v_cndmask_b32 v18, 1, v19, vcc
    s_lshl_b32 s18, s16, 6
    v_and_b32 v19, 31, v1
    v_lshlrev_b32 v19, 1, v19
    v_add_u32 v19, s18, v19
    s_mov_b32 s19, 0x541800
    buffer_load_ushort v95, v19, s[8:11], s19 offen sc1
    v_add_u32 v20, 66560, v19
    ds_read_u16 v96, v20
    ds_read_u16 v97, v20 offset:2048
    v_mov_b32 v94, v27
    v_cvt_pk_bf16_f32 v94, v94, v94
    v_lshlrev_b32 v94, 16, v94
    v_mul_f32 v94, 0xbfb8aa3b, v94
    v_exp_f32 v94, v94
    s_nop 0
    v_add_f32 v94, 1.0, v94
    v_rcp_f32 v94, v94
    s_nop 0
    v_cvt_pk_bf16_f32 v94, v94, v94
    v_lshlrev_b32 v94, 16, v94
    s_waitcnt vmcnt(0)
    v_lshlrev_b32 v95, 16, v95
    s_waitcnt lgkmcnt(1)
    v_lshlrev_b32 v96, 16, v96
    s_waitcnt lgkmcnt(0)
    v_lshlrev_b32 v97, 16, v97
    s_mov_b32 s27, 0
adaLN_cond__sliding_block_cached__moe_arch_mod__prompt_kernel_y13p:
    s_add_u32 s19, s17, 0x0
    buffer_load_dwordx4 v[44:47], v16, s[8:11], s19 offen sc1
    s_add_u32 s19, s17, 0x40000
    buffer_load_dwordx4 v[48:51], v16, s[8:11], s19 offen sc1
    s_add_u32 s19, s17, 0x80000
    buffer_load_dwordx4 v[52:55], v16, s[8:11], s19 offen sc1
    s_add_u32 s19, s17, 0xc0000
    buffer_load_dwordx4 v[56:59], v17, s[8:11], s19 offen sc1
    s_waitcnt vmcnt(0)
    v_min3_u32 v98, v56, v57, v58
    v_min_u32 v98, v98, v59
    v_or_b32 v98, v98, v18
    v_min3_u32 v98, v98, v44, v45
    v_min3_u32 v98, v98, v46, v47
    v_min3_u32 v98, v98, v48, v49
    v_min3_u32 v98, v98, v50, v51
    v_min3_u32 v98, v98, v52, v53
    v_min3_u32 v98, v98, v54, v55
    v_cmp_eq_u32 vcc, 0, v98
    s_add_u32 s27, s27, 1
    s_cmp_ge_u32 s27, 65536
    s_cbranch_scc1 adaLN_cond__sliding_block_cached__moe_arch_mod__prompt_kernel_y13g
    s_cbranch_vccnz adaLN_cond__sliding_block_cached__moe_arch_mod__prompt_kernel_y13p
adaLN_cond__sliding_block_cached__moe_arch_mod__prompt_kernel_y13g:
    v_pk_add_f32 v[44:45], v[44:45], v[52:53]
    v_pk_add_f32 v[46:47], v[46:47], v[54:55]
    v_pk_add_f32 v[48:49], v[48:49], v[56:57]
    v_pk_add_f32 v[50:51], v[50:51], v[58:59]
    v_pk_add_f32 v[44:45], v[44:45], v[48:49]
    v_pk_add_f32 v[46:47], v[46:47], v[50:51]
    s_nop 0
    v_add_f32_dpp v44, v44, v44 row_ror:8 row_mask:0xf bank_mask:0xf
    v_add_f32_dpp v45, v45, v45 row_ror:8 row_mask:0xf bank_mask:0xf
    v_add_f32_dpp v46, v46, v46 row_ror:8 row_mask:0xf bank_mask:0xf
    v_add_f32_dpp v47, v47, v47 row_ror:8 row_mask:0xf bank_mask:0xf
    s_nop 0
    v_permlane32_swap_b32 v44, v46
    v_permlane32_swap_b32 v45, v47
    v_add_f32 v44, v44, v46
    v_add_f32 v45, v45, v47
    s_nop 1
    v_permlane16_swap_b32 v44, v45
    v_add_f32 v44, v44, v45
    v_and_b32 v16, 7, v1
    v_lshlrev_b32 v16, 4, v16
    v_lshrrev_b32 v17, 4, v1
    v_lshl_add_u32 v16, v17, 2, v16
    s_lshl_b32 s19, s3, 7
    s_add_u32 s19, s19, 91136
    v_add_u32 v16, s19, v16
    ds_write_b32 v16, v44
    v_and_b32 v16, 31, v1
    v_lshlrev_b32 v16, 2, v16
    v_add_u32 v16, 91136, v16
    s_waitcnt lgkmcnt(0)
    s_barrier
    s_cmp_lg_u32 s3, 0
    s_cbranch_scc1 adaLN_cond__sliding_block_cached__moe_arch_mod__prompt_kernel_end
    ds_read_b32 v44, v16 offset:0
    ds_read_b32 v45, v16 offset:128
    ds_read_b32 v46, v16 offset:256
    ds_read_b32 v47, v16 offset:384
    ds_read_b32 v48, v16 offset:512
    ds_read_b32 v49, v16 offset:640
    ds_read_b32 v50, v16 offset:768
    ds_read_b32 v51, v16 offset:896
    s_waitcnt lgkmcnt(3)
    v_add_f32 v44, v44, v48
    s_waitcnt lgkmcnt(2)
    v_add_f32 v45, v45, v49
    s_waitcnt lgkmcnt(1)
    v_add_f32 v46, v46, v50
    s_waitcnt lgkmcnt(0)
    v_add_f32 v47, v47, v51
    v_add_f32 v44, v44, v46
    v_add_f32 v45, v45, v47
    v_add_f32 v44, v44, v45
    v_cvt_pk_bf16_f32 v44, v44, v44
    v_lshlrev_b32 v44, 16, v44
    v_mul_f32 v44, v44, v94
    v_cvt_pk_bf16_f32 v44, v44, v44
    v_lshlrev_b32 v44, 16, v44
    v_add_f32 v44, v44, v96
    v_cvt_pk_bf16_f32 v44, v44, v44
    v_lshlrev_b32 v44, 16, v44
    v_mul_f32 v44, v44, v95
    v_cvt_pk_bf16_f32 v44, v44, v44
    v_lshlrev_b32 v44, 16, v44
    v_add_f32 v44, v44, v97
    v_cvt_pk_bf16_f32 v44, v44, v44
    s_mov_b64 exec, 0xffffffff
    buffer_store_short v44, v19, s[68:71], s13 offen sc1
    s_branch adaLN_cond__sliding_block_cached__moe_arch_mod__prompt_kernel_end
adaLN_cond__sliding_block_cached__moe_arch_mod__prompt_kernel_roleB:
    v_mov_b32 v132, 0
    v_mov_b32 v133, 0
    v_lshrrev_b32 v16, 3, v0
    v_and_b32 v17, 7, v0
    v_mul_u32_u24 v135, 24576, v16
    v_lshl_add_u32 v135, v17, 4, v135
    v_lshlrev_b32 v136, 2, v16
    s_and_b32 s14, s2, 31
    s_lshr_b32 s15, s2, 5
    s_mul_i32 s26, s15, 1572864
    s_lshl_b32 s16, s14, 7
    s_add_u32 s26, s26, s16
    s_lshl_b32 s29, s15, 8
    v_lshlrev_b32 v137, 3, v0
    s_lshl_b32 s18, s2, 3
    s_add_u32 s18, s18, s3
    s_lshl_b32 s18, s18, 11
    v_and_b32 v18, 15, v1
    v_lshrrev_b32 v19, 4, v1
    v_lshlrev_b32 v138, 11, v18
    v_lshl_add_u32 v138, v19, 4, v138
    s_lshr_b32 s30, s2, 4
    s_and_b32 s31, s2, 15
    s_lshl_b32 s19, s30, 3
    s_add_u32 s19, s19, s3
    s_lshl_b32 s22, s19, 15
    s_lshl_b32 s23, s31, 7
    s_add_u32 s22, s22, s23
    s_lshl_b32 s23, s2, 12
    s_add_u32 s23, s23, 0x600000
    s_or_b32 s25, s2, s3
    s_cmp_eq_u32 s25, 0
    s_cselect_b32 s25, 0, 0x7ffffff0
    s_waitcnt lgkmcnt(0)
    s_mov_b64 s[64:65], s[58:59]
    s_mov_b32 s66, 0x100
    s_mov_b32 s67, 0x20000
    s_or_b32 s28, s62, 1
    v_mov_b32 v134, s28
    s_mov_b64 exec, 1
    buffer_store_dword v134, v132, s[64:67], s25 offen sc1
    s_mov_b64 exec, -1
    s_mov_b64 s[68:69], s[52:53]
    s_mov_b32 s70, 0x800
    s_mov_b32 s71, 0x20000
    s_mov_b64 s[72:73], s[54:55]
    s_mov_b32 s74, 0xc00000
    s_mov_b32 s75, 0x20000
    s_mov_b64 s[76:77], s[32:33]
    s_mov_b32 s78, 0x400000
    s_mov_b32 s79, 0x20000
    s_mov_b64 s[8:9], s[60:61]
    s_mov_b32 s10, 0x3400000
    s_mov_b32 s11, 0x20000
    buffer_load_dword v72, v136, s[68:71], s29 offen
    buffer_load_dwordx4 v[24:27], v135, s[72:75], s26 offen
    s_add_u32 s26, s26, 12288
    buffer_load_dwordx4 v[28:31], v135, s[72:75], s26 offen
    buffer_load_dwordx4 v[32:35], v2, s[76:79], s18 offen offset:0
    buffer_load_dwordx4 v[36:39], v2, s[76:79], s18 offen offset:1024
    buffer_store_dwordx2 v[132:133], v137, s[8:11], s23 offen sc1
    s_barrier
    buffer_load_dwordx4 v[40:43], v138, s[76:79], s22 offen offset:0
    buffer_load_dwordx4 v[44:47], v138, s[76:79], s22 offen offset:64
    s_mov_b32 s29, s19
    s_mov_b64 s[64:65], s[34:35]
    s_mov_b32 s66, 0x200000
    s_mov_b32 s67, 0x20000
    s_mov_b64 s[68:69], s[36:37]
    s_mov_b32 s70, 0x200000
    s_mov_b32 s71, 0x20000
    s_lshl_b32 s20, s2, 2
    s_add_u32 s20, s20, s3
    s_sub_u32 s20, s20, 4
    s_lshr_b32 s22, s20, 8
    s_bfe_u32 s23, s20, 0x40004
    s_and_b32 s24, s20, 15
    s_lshl_b32 s25, s22, 19
    s_lshl_b32 s26, s23, 13
    s_add_u32 s25, s25, s26
    s_add_u32 s25, s25, 393216
    v_and_b32 v16, 15, v1
    v_lshrrev_b32 v17, 4, v1
    s_lshl_b32 s21, s22, 17
    s_cmp_ge_u32 s24, 8
    s_cbranch_scc1 adaLN_cond__sliding_block_cached__moe_arch_mod__prompt_kernel_kvV
    v_lshlrev_b32 v18, 8, v16
    v_lshl_add_u32 v18, v17, 3, v18
    s_and_b32 s26, s24, 1
    s_lshl_b32 s26, s26, 12
    s_add_u32 s25, s25, s26
    s_lshr_b32 s26, s24, 1
    s_lshl_b32 s26, s26, 6
    s_add_u32 s25, s25, s26
    buffer_load_dwordx2 v[84:85], v18, s[64:67], s25 offen
    buffer_load_dwordx2 v[86:87], v18, s[64:67], s25 offen offset:32
    s_lshl_b32 s26, s23, 13
    s_add_u32 s21, s21, s26
    s_lshl_b32 s26, s24, 10
    s_add_u32 s21, s21, s26
    s_add_u32 s21, s21, 0x400000
    s_branch adaLN_cond__sliding_block_cached__moe_arch_mod__prompt_kernel_kvJ
adaLN_cond__sliding_block_cached__moe_arch_mod__prompt_kernel_kvV:
    s_bfe_u32 s26, s24, 0x20001
    s_lshl_b32 s26, s26, 6
    s_add_u32 s25, s25, s26
    s_and_b32 s26, s24, 1
    s_lshl_b32 s26, s26, 3
    s_add_u32 s25, s25, s26
    s_add_u32 s26, s25, 4096
    v_lshrrev_b32 v18, 2, v16
    v_lshlrev_b32 v18, 4, v18
    v_and_b32 v19, 3, v16
    v_lshl_add_u32 v18, v19, 1, v18
    v_lshl_add_u32 v18, v17, 10, v18
    buffer_load_ushort v88, v18, s[68:71], s25 offen offset:0
    buffer_load_ushort v89, v18, s[68:71], s25 offen offset:256
    buffer_load_ushort v90, v18, s[68:71], s25 offen offset:512
    buffer_load_ushort v91, v18, s[68:71], s25 offen offset:768
    buffer_load_ushort v92, v18, s[68:71], s26 offen offset:0
    buffer_load_ushort v93, v18, s[68:71], s26 offen offset:256
    buffer_load_ushort v94, v18, s[68:71], s26 offen offset:512
    buffer_load_ushort v95, v18, s[68:71], s26 offen offset:768
    s_bfe_u32 s26, s24, 0x20001
    s_lshl_b32 s26, s26, 15
    s_add_u32 s21, s21, s26
    s_lshl_b32 s26, s23, 11
    s_add_u32 s21, s21, s26
    s_and_b32 s26, s24, 1
    s_lshl_b32 s26, s26, 10
    s_add_u32 s21, s21, s26
    s_add_u32 s21, s21, 0x480000
adaLN_cond__sliding_block_cached__moe_arch_mod__prompt_kernel_kvJ:
    s_waitcnt vmcnt(9)
    v_and_b32 v73, 0xffff0000, v72
    v_lshlrev_b32 v72, 16, v72
    v_mul_f32 v16, 0xbfb8aa3b, v72
    v_exp_f32 v16, v16
    s_nop 0
    v_add_f32 v16, 1.0, v16
    v_rcp_f32 v16, v16
    s_nop 0
    v_mul_f32 v72, v72, v16
    v_mul_f32 v17, 0xbfb8aa3b, v73
    v_exp_f32 v17, v17
    s_nop 0
    v_add_f32 v17, 1.0, v17
    v_rcp_f32 v17, v17
    s_nop 0
    v_mul_f32 v73, v73, v17
    v_cvt_pk_bf16_f32 v16, v72, v73
    v_lshlrev_b32 v72, 16, v16
    v_and_b32 v73, 0xffff0000, v16
    s_lshl_b32 s16, s2, 8
    s_add_u32 s16, s16, 0x550000
    s_mov_b32 exec_lo, 0x01010101
    s_mov_b32 exec_hi, 0x01010101
    buffer_store_dword v16, v136, s[8:11], s16 offen sc1
    s_mov_b64 exec, -1
    v_lshrrev_b32 v74, 16, v72
    v_lshrrev_b32 v75, 16, v73
    s_waitcnt vmcnt(9)
    v_dot2_f32_bf16 v49, v24, v72, 0
    v_dot2_f32_bf16 v48, v24, v74, 0
    v_dot2_f32_bf16 v51, v25, v72, 0
    v_dot2_f32_bf16 v50, v25, v74, 0
    v_dot2_f32_bf16 v53, v26, v72, 0
    v_dot2_f32_bf16 v52, v26, v74, 0
    v_dot2_f32_bf16 v55, v27, v72, 0
    v_dot2_f32_bf16 v54, v27, v74, 0
    s_waitcnt vmcnt(8)
    v_dot2c_f32_bf16 v49, v28, v73
    v_dot2c_f32_bf16 v48, v28, v75
    v_dot2c_f32_bf16 v51, v29, v73
    v_dot2c_f32_bf16 v50, v29, v75
    v_dot2c_f32_bf16 v53, v30, v73
    v_dot2c_f32_bf16 v52, v30, v75
    v_dot2c_f32_bf16 v55, v31, v73
    v_dot2c_f32_bf16 v54, v31, v75
    s_nop 0
    v_permlane32_swap_b32 v48, v52
    v_permlane32_swap_b32 v49, v53
    v_permlane32_swap_b32 v50, v54
    v_permlane32_swap_b32 v51, v55
    v_add_f32 v48, v48, v52
    v_add_f32 v49, v49, v53
    v_add_f32 v50, v50, v54
    v_add_f32 v51, v51, v55
    s_nop 0
    v_permlane16_swap_b32 v48, v50
    v_permlane16_swap_b32 v49, v51
    v_add_f32 v48, v48, v50
    v_add_f32 v49, v49, v51
    s_nop 0
    v_add_f32_dpp v48, v48, v48 row_ror:8 row_mask:0xf bank_mask:0xf
    v_add_f32_dpp v49, v49, v49 row_ror:8 row_mask:0xf bank_mask:0xf
    v_and_b32 v16, 7, v1
    v_lshlrev_b32 v16, 5, v16
    v_lshrrev_b32 v17, 4, v1
    v_lshl_add_u32 v16, v17, 3, v16
    s_lshl_b32 s16, s3, 8
    s_add_u32 s16, s16, 147456
    v_add_u32 v16, s16, v16
    ds_write_b64 v16, v[48:49]
    s_waitcnt vmcnt(7)
    v_lshlrev_b32 v56, 16, v32
    v_and_b32 v57, 0xffff0000, v32
    v_lshlrev_b32 v58, 16, v33
    v_and_b32 v59, 0xffff0000, v33
    v_lshlrev_b32 v60, 16, v34
    v_and_b32 v61, 0xffff0000, v34
    v_lshlrev_b32 v62, 16, v35
    v_and_b32 v63, 0xffff0000, v35
    s_waitcnt vmcnt(6)
    v_lshlrev_b32 v64, 16, v36
    v_and_b32 v65, 0xffff0000, v36
    v_lshlrev_b32 v66, 16, v37
    v_and_b32 v67, 0xffff0000, v37
    v_lshlrev_b32 v68, 16, v38
    v_and_b32 v69, 0xffff0000, v38
    v_lshlrev_b32 v70, 16, v39
    v_and_b32 v71, 0xffff0000, v39
    v_add_f32 v20, v56, v57
    v_add_f32 v21, v58, v59
    v_add_f32 v20, v20, v60
    v_add_f32 v21, v21, v61
    v_add_f32 v20, v20, v62
    v_add_f32 v21, v21, v63
    v_add_f32 v20, v20, v64
    v_add_f32 v21, v21, v65
    v_add_f32 v20, v20, v66
    v_add_f32 v21, v21, v67
    v_add_f32 v20, v20, v68
    v_add_f32 v21, v21, v69
    v_add_f32 v20, v20, v70
    v_add_f32 v21, v21, v71
    v_add_f32 v128, v20, v21
    s_nop 1
    v_add_f32_dpp v128, v128, v128 row_ror:1 row_mask:0xf bank_mask:0xf
    s_nop 1
    v_add_f32_dpp v128, v128, v128 row_ror:2 row_mask:0xf bank_mask:0xf
    s_nop 1
    v_add_f32_dpp v128, v128, v128 row_ror:4 row_mask:0xf bank_mask:0xf
    s_nop 1
    v_add_f32_dpp v128, v128, v128 row_ror:8 row_mask:0xf bank_mask:0xf
    v_mov_b32 v20, v128
    s_nop 1
    v_permlane16_swap_b32 v128, v20
    v_add_f32 v128, v128, v20
    v_mov_b32 v20, v128
    s_nop 1
    v_permlane32_swap_b32 v128, v20
    v_add_f32 v128, v128, v20
    v_mul_f32 v128, 0x3a800000, v128
    v_sub_f32 v18, v56, v128
    v_mul_f32 v20, v18, v18
    v_sub_f32 v19, v57, v128
    v_mul_f32 v21, v19, v19
    v_sub_f32 v18, v58, v128
    v_sub_f32 v19, v59, v128
    v_fmac_f32 v20, v18, v18
    v_fmac_f32 v21, v19, v19
    v_sub_f32 v18, v60, v128
    v_sub_f32 v19, v61, v128
    v_fmac_f32 v20, v18, v18
    v_fmac_f32 v21, v19, v19
    v_sub_f32 v18, v62, v128
    v_sub_f32 v19, v63, v128
    v_fmac_f32 v20, v18, v18
    v_fmac_f32 v21, v19, v19
    v_sub_f32 v18, v64, v128
    v_sub_f32 v19, v65, v128
    v_fmac_f32 v20, v18, v18
    v_fmac_f32 v21, v19, v19
    v_sub_f32 v18, v66, v128
    v_sub_f32 v19, v67, v128
    v_fmac_f32 v20, v18, v18
    v_fmac_f32 v21, v19, v19
    v_sub_f32 v18, v68, v128
    v_sub_f32 v19, v69, v128
    v_fmac_f32 v20, v18, v18
    v_fmac_f32 v21, v19, v19
    v_sub_f32 v18, v70, v128
    v_sub_f32 v19, v71, v128
    v_fmac_f32 v20, v18, v18
    v_fmac_f32 v21, v19, v19
    v_add_f32 v17, v20, v21
    s_nop 1
    v_add_f32_dpp v17, v17, v17 row_ror:1 row_mask:0xf bank_mask:0xf
    s_nop 1
    v_add_f32_dpp v17, v17, v17 row_ror:2 row_mask:0xf bank_mask:0xf
    s_nop 1
    v_add_f32_dpp v17, v17, v17 row_ror:4 row_mask:0xf bank_mask:0xf
    s_nop 1
    v_add_f32_dpp v17, v17, v17 row_ror:8 row_mask:0xf bank_mask:0xf
    v_mov_b32 v20, v17
    s_nop 1
    v_permlane16_swap_b32 v17, v20
    v_add_f32 v17, v17, v20
    v_mov_b32 v20, v17
    s_nop 1
    v_permlane32_swap_b32 v17, v20
    v_add_f32 v17, v17, v20
    v_mul_f32 v17, 0x3a800000, v17
    v_cvt_pk_bf16_f32 v128, v128, v128
    v_lshlrev_b32 v128, 16, v128
    v_cvt_pk_bf16_f32 v17, v17, v17
    v_lshlrev_b32 v17, 16, v17
    v_add_f32 v17, 0x3727c5ac, v17
    v_cvt_pk_bf16_f32 v17, v17, v17
    v_lshlrev_b32 v17, 16, v17
    v_sqrt_f32 v129, v17
    s_nop 0
    v_cvt_pk_bf16_f32 v129, v129, v129
    v_lshlrev_b32 v129, 16, v129
    v_rcp_f32 v130, v129
    s_lshl_b32 s16, s3, 4
    s_add_u32 s16, s16, 149520
    v_mov_b32 v19, s16
    ds_write_b128 v19, v[128:131]
    v_mov_b32 v19, 149504
    v_and_b32 v17, 31, v1
    v_lshlrev_b32 v18, 3, v17
    v_add_u32 v18, 147456, v18
    v_lshlrev_b32 v17, 4, v17
    s_waitcnt lgkmcnt(0)
    s_barrier
    ds_read_b32 v134, v19
    ds_read_b64 v[96:97], v18 offset:0
    ds_read_b64 v[100:101], v18 offset:256
    ds_read_b64 v[104:105], v18 offset:512
    ds_read_b64 v[108:109], v18 offset:768
    ds_read_b64 v[112:113], v18 offset:1024
    ds_read_b64 v[116:117], v18 offset:1280
    ds_read_b64 v[120:121], v18 offset:1536
    ds_read_b64 v[124:125], v18 offset:1792
    s_waitcnt lgkmcnt(8)
    v_readfirstlane_b32 s28, v134
    v_and_b32 v20, 7, v1
    v_lshlrev_b32 v20, 4, v20
    v_add_u32 v21, 149520, v20
    ds_read_b128 v[128:131], v21
    s_waitcnt lgkmcnt(0)
    v_mov_b32 v131, s28
    s_lshl_b32 s16, s2, 7
    s_add_u32 s16, s16, 0x520000
    s_cmp_eq_u32 s3, 0
    s_cselect_b32 s16, s16, 0x7ffffff0
    s_mov_b64 exec, 0xff
    buffer_store_dwordx4 v[128:131], v20, s[8:11], s16 offen sc1
    s_mov_b64 exec, -1
    v_pk_add_f32 v[96:97], v[96:97], v[112:113]
    v_pk_add_f32 v[100:101], v[100:101], v[116:117]
    v_pk_add_f32 v[104:105], v[104:105], v[120:121]
    v_pk_add_f32 v[108:109], v[108:109], v[124:125]
    v_pk_add_f32 v[96:97], v[96:97], v[104:105]
    v_pk_add_f32 v[100:101], v[100:101], v[108:109]
    v_pk_add_f32 v[96:97], v[96:97], v[100:101]
    v_mov_b32 v98, s28
    v_mov_b32 v99, s28
    s_lshl_b32 s16, s14, 3
    s_add_u32 s16, s16, s15
    s_lshl_b32 s16, s16, 9
    s_add_u32 s16, s16, 0x500000
    s_cmp_eq_u32 s3, 0
    s_cselect_b32 s16, s16, 0x7ffffff0
    s_mov_b64 exec, 0xffffffff
    buffer_store_dwordx4 v[96:99], v17, s[8:11], s16 offen sc1
    s_mov_b64 exec, -1
    s_cmp_lt_u32 s24, 8
    s_cbranch_scc1 adaLN_cond__sliding_block_cached__moe_arch_mod__prompt_kernel_kvS
    s_waitcnt vmcnt(4)
    v_lshl_or_b32 v84, v89, 16, v88
    v_lshl_or_b32 v85, v91, 16, v90
    s_waitcnt vmcnt(3)
    v_lshl_or_b32 v86, v93, 16, v92
    v_lshl_or_b32 v87, v95, 16, v94
    v_and_b32 v88, 0x7fff, v88
    v_and_b32 v89, 0x7fff, v89
    v_and_b32 v90, 0x7fff, v90
    v_and_b32 v91, 0x7fff, v91
    v_and_b32 v92, 0x7fff, v92
    v_and_b32 v93, 0x7fff, v93
    v_and_b32 v94, 0x7fff, v94
    v_and_b32 v95, 0x7fff, v95
    v_max3_u32 v88, v88, v89, v90
    v_max3_u32 v91, v91, v92, v93
    v_max3_u32 v88, v88, v94, v95
    v_max_u32 v88, v88, v91
    v_cmp_le_u32 vcc, 0x4980, v88
    v_mov_b32 v89, s28
    s_mov_b32 s16, 0x564000
    s_and_saveexec_b64 s[62:63], vcc
    buffer_store_dword v89, v132, s[8:11], s16 offen sc1
    s_mov_b64 exec, s[62:63]
adaLN_cond__sliding_block_cached__moe_arch_mod__prompt_kernel_kvS:
    s_waitcnt vmcnt(3)
    buffer_store_dwordx4 v[84:87], v2, s[8:11], s21 offen sc1
    s_lshr_b32 s16, s3, 2
    s_lshl_b32 s16, s16, 4
    s_add_u32 s16, s16, s31
    s_lshl_b32 s16, s16, 12
    s_and_b32 s17, s3, 3
    s_lshl_b32 s17, s17, 7
    s_add_u32 s16, s16, s17
    s_add_u32 s16, s16, 0x500000
    v_lshrrev_b32 v139, 3, v1
    v_lshlrev_b32 v139, 9, v139
    v_and_b32 v16, 7, v1
    v_lshl_add_u32 v139, v16, 4, v139
    v_and_b32 v140, 15, v1
    v_lshlrev_b32 v140, 4, v140
    s_lshl_b32 s17, s29, 8
    s_add_u32 s17, s17, 0x520000
    v_lshlrev_b32 v56, 16, v40
    v_and_b32 v57, 0xffff0000, v40
    v_lshlrev_b32 v58, 16, v41
    v_and_b32 v59, 0xffff0000, v41
    v_lshlrev_b32 v60, 16, v42
    v_and_b32 v61, 0xffff0000, v42
    v_lshlrev_b32 v62, 16, v43
    v_and_b32 v63, 0xffff0000, v43
    v_lshlrev_b32 v64, 16, v44
    v_and_b32 v65, 0xffff0000, v44
    v_lshlrev_b32 v66, 16, v45
    v_and_b32 v67, 0xffff0000, v45
    v_lshlrev_b32 v68, 16, v46
    v_and_b32 v69, 0xffff0000, v46
    v_lshlrev_b32 v70, 16, v47
    v_and_b32 v71, 0xffff0000, v47
    v_mov_b32 v135, 2097152
    v_mul_lo_u32 v135, v135, v1
    s_mov_b64 s[76:77], s[40:41]
    s_mov_b32 s78, 0x800000
    s_mov_b32 s79, 0x20000
    s_mov_b32 s62, 0x0
    s_cmp_eq_u32 s3, 4
    s_cselect_b32 s62, s62, 0x7ffffff0
    buffer_load_dword v136, v135, s[76:79], s62 offen
    s_mov_b64 s[76:77], s[46:47]
    s_mov_b32 s78, 0x700000
    s_mov_b32 s79, 0x20000
    s_mov_b32 s62, 0x0
    s_cmp_eq_u32 s3, 4
    s_cselect_b32 s62, s62, 0x7ffffff0
    buffer_load_dword v136, v135, s[76:79], s62 offen
    s_mov_b64 s[76:77], s[48:49]
    s_mov_b32 s78, 0x700000
    s_mov_b32 s79, 0x20000
    s_mov_b32 s62, 0x0
    s_cmp_eq_u32 s3, 5
    s_cselect_b32 s62, s62, 0x7ffffff0
    buffer_load_dword v136, v135, s[76:79], s62 offen
    s_mov_b64 s[76:77], s[50:51]
    s_mov_b32 s78, 0x700000
    s_mov_b32 s79, 0x20000
    s_mov_b32 s62, 0x0
    s_cmp_eq_u32 s3, 5
    s_cselect_b32 s62, s62, 0x7ffffff0
    buffer_load_dword v136, v135, s[76:79], s62 offen
    s_mov_b64 s[76:77], s[38:39]
    s_mov_b32 s78, 0x800000
    s_mov_b32 s79, 0x20000
    s_mov_b32 s62, 0x0
    s_cmp_eq_u32 s3, 6
    s_cselect_b32 s62, s62, 0x7ffffff0
    buffer_load_dword v136, v135, s[76:79], s62 offen
    s_mov_b64 s[76:77], s[56:57]
    s_mov_b32 s78, 0x400000
    s_mov_b32 s79, 0x20000
    s_mov_b32 s62, 0x0
    s_cmp_eq_u32 s3, 6
    s_cselect_b32 s62, s62, 0x7ffffff0
    buffer_load_dword v136, v135, s[76:79], s62 offen
    s_mov_b64 s[76:77], s[54:55]
    s_mov_b32 s78, 0xc00000
    s_mov_b32 s79, 0x20000
    s_mov_b32 s62, 0x0
    s_cmp_eq_u32 s3, 7
    s_cselect_b32 s62, s62, 0x7ffffff0
    buffer_load_dword v136, v135, s[76:79], s62 offen
    s_mov_b64 s[76:77], s[44:45]
    s_mov_b32 s78, 0x800
    s_mov_b32 s79, 0x20000
    s_mov_b32 s62, 0x0
    s_cmp_eq_u32 s3, 7
    s_cselect_b32 s62, s62, 0x7ffffff0
    buffer_load_dword v136, v135, s[76:79], s62 offen
    s_mov_b32 s27, 0
adaLN_cond__sliding_block_cached__moe_arch_mod__prompt_kernel_g14p:
    buffer_load_dwordx4 v[76:79], v139, s[8:11], s16 offen sc1
    buffer_load_dwordx4 v[80:83], v140, s[8:11], s17 offen sc1
    s_waitcnt vmcnt(1)
    v_cmp_ne_u32 vcc, s28, v78
    v_cmp_ne_u32 s[62:63], s28, v79
    s_or_b64 vcc, vcc, s[62:63]
    s_waitcnt vmcnt(0)
    v_cmp_ne_u32 s[62:63], s28, v83
    s_or_b64 vcc, vcc, s[62:63]
    s_add_u32 s27, s27, 1
    s_cmp_ge_u32 s27, 65536
    s_cbranch_scc1 adaLN_cond__sliding_block_cached__moe_arch_mod__prompt_kernel_g14g
    s_cbranch_vccnz adaLN_cond__sliding_block_cached__moe_arch_mod__prompt_kernel_g14p
adaLN_cond__sliding_block_cached__moe_arch_mod__prompt_kernel_g14g:
    v_add_f32_dpp v76, v76, v76 row_ror:8 row_mask:0xf bank_mask:0xf
    v_add_f32_dpp v77, v77, v77 row_ror:8 row_mask:0xf bank_mask:0xf
    v_mov_b32 v17, v76
    s_nop 1
    v_permlane16_swap_b32 v76, v17
    v_add_f32 v76, v76, v17
    v_mov_b32 v18, v77
    s_nop 1
    v_permlane16_swap_b32 v77, v18
    v_add_f32 v77, v77, v18
    v_mov_b32 v17, v76
    s_nop 1
    v_permlane32_swap_b32 v76, v17
    v_add_f32 v76, v76, v17
    v_mov_b32 v18, v77
    s_nop 1
    v_permlane32_swap_b32 v77, v18
    v_add_f32 v77, v77, v18
    v_cvt_pk_bf16_f32 v17, v76, v77
    v_lshlrev_b32 v76, 16, v17
    v_and_b32 v77, 0xffff0000, v17
    v_add_f32 v76, 1.0, v76
    v_add_f32 v77, 1.0, v77
    v_cvt_pk_bf16_f32 v17, v76, v77
    v_lshlrev_b32 v76, 16, v17
    v_and_b32 v77, 0xffff0000, v17
    s_lshl_b32 s16, s3, 6
    s_add_u32 s16, s16, 151552
    v_lshl_add_u32 v16, v16, 3, s16
    ds_write_b64 v16, v[76:77]
    v_lshrrev_b32 v17, 4, v1
    v_lshlrev_b32 v17, 5, v17
    v_add_u32 v17, 151552, v17
    v_sub_f32 v56, v56, v80
    v_sub_f32 v57, v57, v80
    v_sub_f32 v58, v58, v80
    v_sub_f32 v59, v59, v80
    v_sub_f32 v60, v60, v80
    v_sub_f32 v61, v61, v80
    v_sub_f32 v62, v62, v80
    v_sub_f32 v63, v63, v80
    v_sub_f32 v64, v64, v80
    v_sub_f32 v65, v65, v80
    v_sub_f32 v66, v66, v80
    v_sub_f32 v67, v67, v80
    v_sub_f32 v68, v68, v80
    v_sub_f32 v69, v69, v80
    v_sub_f32 v70, v70, v80
    v_sub_f32 v71, v71, v80
    v_cvt_pk_bf16_f32 v18, v56, v57
    v_lshlrev_b32 v56, 16, v18
    v_and_b32 v57, 0xffff0000, v18
    v_cvt_pk_bf16_f32 v19, v58, v59
    v_lshlrev_b32 v58, 16, v19
    v_and_b32 v59, 0xffff0000, v19
    v_cvt_pk_bf16_f32 v18, v60, v61
    v_lshlrev_b32 v60, 16, v18
    v_and_b32 v61, 0xffff0000, v18
    v_cvt_pk_bf16_f32 v19, v62, v63
    v_lshlrev_b32 v62, 16, v19
    v_and_b32 v63, 0xffff0000, v19
    v_cvt_pk_bf16_f32 v18, v64, v65
    v_lshlrev_b32 v64, 16, v18
    v_and_b32 v65, 0xffff0000, v18
    v_cvt_pk_bf16_f32 v19, v66, v67
    v_lshlrev_b32 v66, 16, v19
    v_and_b32 v67, 0xffff0000, v19
    v_cvt_pk_bf16_f32 v18, v68, v69
    v_lshlrev_b32 v68, 16, v18
    v_and_b32 v69, 0xffff0000, v18
    v_cvt_pk_bf16_f32 v19, v70, v71
    v_lshlrev_b32 v70, 16, v19
    v_and_b32 v71, 0xffff0000, v19
    v_mul_f32 v56, v56, v82
    v_mul_f32 v57, v57, v82
    v_mul_f32 v58, v58, v82
    v_mul_f32 v59, v59, v82
    v_mul_f32 v60, v60, v82
    v_mul_f32 v61, v61, v82
    v_mul_f32 v62, v62, v82
    v_mul_f32 v63, v63, v82
    v_mul_f32 v64, v64, v82
    v_mul_f32 v65, v65, v82
    v_mul_f32 v66, v66, v82
    v_mul_f32 v67, v67, v82
    v_mul_f32 v68, v68, v82
    v_mul_f32 v69, v69, v82
    v_mul_f32 v70, v70, v82
    v_mul_f32 v71, v71, v82
    v_cvt_pk_bf16_f32 v18, v56, v57
    v_lshlrev_b32 v56, 16, v18
    v_and_b32 v57, 0xffff0000, v18
    v_cvt_pk_bf16_f32 v19, v58, v59
    v_lshlrev_b32 v58, 16, v19
    v_and_b32 v59, 0xffff0000, v19
    v_cvt_pk_bf16_f32 v18, v60, v61
    v_lshlrev_b32 v60, 16, v18
    v_and_b32 v61, 0xffff0000, v18
    v_cvt_pk_bf16_f32 v19, v62, v63
    v_lshlrev_b32 v62, 16, v19
    v_and_b32 v63, 0xffff0000, v19
    v_cvt_pk_bf16_f32 v18, v64, v65
    v_lshlrev_b32 v64, 16, v18
    v_and_b32 v65, 0xffff0000, v18
    v_cvt_pk_bf16_f32 v19, v66, v67
    v_lshlrev_b32 v66, 16, v19
    v_and_b32 v67, 0xffff0000, v19
    v_cvt_pk_bf16_f32 v18, v68, v69
    v_lshlrev_b32 v68, 16, v18
    v_and_b32 v69, 0xffff0000, v18
    v_cvt_pk_bf16_f32 v19, v70, v71
    v_lshlrev_b32 v70, 16, v19
    v_and_b32 v71, 0xffff0000, v19
    s_lshl_b32 s16, s29, 15
    s_lshl_b32 s17, s31, 11
    s_add_u32 s16, s16, s17
    s_waitcnt lgkmcnt(0)
    s_barrier
    ds_read_b128 v[96:99], v17 offset:256
    ds_read_b128 v[104:107], v17 offset:0
    ds_read_b128 v[100:103], v17 offset:272
    ds_read_b128 v[108:111], v17 offset:16
    ds_read_b128 v[112:115], v17 offset:384
    ds_read_b128 v[120:123], v17 offset:128
    ds_read_b128 v[116:119], v17 offset:400
    ds_read_b128 v[124:127], v17 offset:144
    s_waitcnt lgkmcnt(7)
    v_pk_mul_f32 v[56:57], v[56:57], v[96:97]
    v_pk_mul_f32 v[58:59], v[58:59], v[98:99]
    s_waitcnt lgkmcnt(5)
    v_pk_mul_f32 v[60:61], v[60:61], v[100:101]
    v_pk_mul_f32 v[62:63], v[62:63], v[102:103]
    v_cvt_pk_bf16_f32 v18, v56, v57
    v_lshlrev_b32 v56, 16, v18
    v_and_b32 v57, 0xffff0000, v18
    v_cvt_pk_bf16_f32 v19, v58, v59
    v_lshlrev_b32 v58, 16, v19
    v_and_b32 v59, 0xffff0000, v19
    v_cvt_pk_bf16_f32 v18, v60, v61
    v_lshlrev_b32 v60, 16, v18
    v_and_b32 v61, 0xffff0000, v18
    v_cvt_pk_bf16_f32 v19, v62, v63
    v_lshlrev_b32 v62, 16, v19
    v_and_b32 v63, 0xffff0000, v19
    v_pk_add_f32 v[56:57], v[56:57], v[104:105]
    v_pk_add_f32 v[58:59], v[58:59], v[106:107]
    s_waitcnt lgkmcnt(4)
    v_pk_add_f32 v[60:61], v[60:61], v[108:109]
    v_pk_add_f32 v[62:63], v[62:63], v[110:111]
    v_cvt_pk_bf16_f32 v32, v56, v57
    v_cvt_pk_bf16_f32 v33, v58, v59
    v_cvt_pk_bf16_f32 v34, v60, v61
    v_cvt_pk_bf16_f32 v35, v62, v63
    buffer_store_dwordx4 v[32:35], v2, s[8:11], s16 offen offset:0 sc1
    s_waitcnt lgkmcnt(3)
    v_pk_mul_f32 v[64:65], v[64:65], v[112:113]
    v_pk_mul_f32 v[66:67], v[66:67], v[114:115]
    s_waitcnt lgkmcnt(1)
    v_pk_mul_f32 v[68:69], v[68:69], v[116:117]
    v_pk_mul_f32 v[70:71], v[70:71], v[118:119]
    v_cvt_pk_bf16_f32 v18, v64, v65
    v_lshlrev_b32 v64, 16, v18
    v_and_b32 v65, 0xffff0000, v18
    v_cvt_pk_bf16_f32 v19, v66, v67
    v_lshlrev_b32 v66, 16, v19
    v_and_b32 v67, 0xffff0000, v19
    v_cvt_pk_bf16_f32 v18, v68, v69
    v_lshlrev_b32 v68, 16, v18
    v_and_b32 v69, 0xffff0000, v18
    v_cvt_pk_bf16_f32 v19, v70, v71
    v_lshlrev_b32 v70, 16, v19
    v_and_b32 v71, 0xffff0000, v19
    v_pk_add_f32 v[64:65], v[64:65], v[120:121]
    v_pk_add_f32 v[66:67], v[66:67], v[122:123]
    s_waitcnt lgkmcnt(0)
    v_pk_add_f32 v[68:69], v[68:69], v[124:125]
    v_pk_add_f32 v[70:71], v[70:71], v[126:127]
    v_cvt_pk_bf16_f32 v36, v64, v65
    v_cvt_pk_bf16_f32 v37, v66, v67
    v_cvt_pk_bf16_f32 v38, v68, v69
    v_cvt_pk_bf16_f32 v39, v70, v71
    buffer_store_dwordx4 v[36:39], v2, s[8:11], s16 offen offset:1024 sc1
    s_lshl_b32 s19, s3, 16
    s_lshl_b32 s20, s3, 11
    s_lshl_b32 s16, s12, 8
    s_add_u32 s4, s38, s16
    s_addc_u32 s5, s39, 0
    s_sub_u32 s6, 0x800000, s16
    s_mov_b32 s7, 0x20000
    v_mov_b32 v134, s28
    s_lshl_b32 s16, s29, 4
    s_add_u32 s16, s16, s31
    s_lshl_b32 s16, s16, 2
    s_add_u32 s16, s16, 0x528000
    v_and_b32 v16, 31, v1
    v_lshlrev_b32 v16, 2, v16
    s_lshl_b32 s17, s13, 3
    s_add_u32 s17, s17, s3
    s_lshl_b32 s17, s17, 7
    s_add_u32 s17, s17, 0x528000
    s_waitcnt vmcnt(0)
    s_mov_b64 exec, 1
    buffer_store_dword v134, v132, s[8:11], s16 offen sc1
    s_mov_b64 exec, -1
    s_add_u32 s22, s19, 0x0
    s_add_u32 m0, s20, 0x0
    s_nop 0
    buffer_load_dwordx4 v3, s[4:7], s22 offen lds
    s_add_u32 s22, s19, 0x8000
    s_add_u32 m0, s20, 0x400
    s_nop 0
    buffer_load_dwordx4 v3, s[4:7], s22 offen lds
    s_add_u32 s22, s19, 0x80000
    s_add_u32 m0, s20, 0x4000
    s_nop 0
    buffer_load_dwordx4 v3, s[4:7], s22 offen lds
    s_add_u32 s22, s19, 0x88000
    s_add_u32 m0, s20, 0x4400
    s_nop 0
    buffer_load_dwordx4 v3, s[4:7], s22 offen lds
    s_add_u32 s22, s19, 0x100000
    s_add_u32 m0, s20, 0x8000
    s_nop 0
    buffer_load_dwordx4 v3, s[4:7], s22 offen lds
    s_add_u32 s22, s19, 0x108000
    s_add_u32 m0, s20, 0x8400
    s_nop 0
    buffer_load_dwordx4 v3, s[4:7], s22 offen lds
    s_waitcnt vmcnt(0)
    s_mov_b32 s27, 0
adaLN_cond__sliding_block_cached__moe_arch_mod__prompt_kernel_h15p:
    buffer_load_dword v17, v16, s[8:11], s17 offen sc1
    s_waitcnt vmcnt(0)
    v_cmp_ne_u32 vcc, s28, v17
    s_add_u32 s27, s27, 1
    s_cmp_ge_u32 s27, 65536
    s_cbranch_scc1 adaLN_cond__sliding_block_cached__moe_arch_mod__prompt_kernel_h15g
    s_cbranch_vccnz adaLN_cond__sliding_block_cached__moe_arch_mod__prompt_kernel_h15p
adaLN_cond__sliding_block_cached__moe_arch_mod__prompt_kernel_h15g:
    s_mov_b32 s23, 0x0
    buffer_load_dwordx4 v[88:91], v7, s[8:11], s23 offen offset:0 sc1
    s_mov_b32 s23, 0x8000
    buffer_load_dwordx4 v[92:95], v7, s[8:11], s23 offen offset:0 sc1
    s_mov_b32 s23, 0x0
    buffer_load_dwordx4 v[96:99], v7, s[8:11], s23 offen offset:1024 sc1
    s_mov_b32 s23, 0x8000
    buffer_load_dwordx4 v[100:103], v7, s[8:11], s23 offen offset:1024 sc1
    s_mov_b32 s23, 0x800
    buffer_load_dwordx4 v[104:107], v7, s[8:11], s23 offen offset:0 sc1
    s_mov_b32 s23, 0x8800
    buffer_load_dwordx4 v[108:111], v7, s[8:11], s23 offen offset:0 sc1
    s_mov_b32 s23, 0x800
    buffer_load_dwordx4 v[112:115], v7, s[8:11], s23 offen offset:1024 sc1
    s_mov_b32 s23, 0x8800
    buffer_load_dwordx4 v[116:119], v7, s[8:11], s23 offen offset:1024 sc1
    s_lshr_b32 s21, s12, 3
    s_lshl_b32 s21, s21, 17
    s_add_u32 s21, s21, s20
    s_add_u32 s21, s21, 0x400000
    s_barrier
    ds_read_b64_tr_b16 v[224:225], v4 offset:0
    ds_read_b64_tr_b16 v[226:227], v4 offset:1024
    ds_read_b64_tr_b16 v[228:229], v5 offset:32
    ds_read_b64_tr_b16 v[230:231], v5 offset:1056
    ds_read_b64_tr_b16 v[232:233], v4 offset:256
    ds_read_b64_tr_b16 v[234:235], v4 offset:1280
    ds_read_b64_tr_b16 v[236:237], v5 offset:288
    ds_read_b64_tr_b16 v[238:239], v5 offset:1312
    s_waitcnt vmcnt(7) lgkmcnt(6)
    v_mfma_f32_16x16x32_bf16 v[24:27], v[224:227], v[88:91], 0
    ds_read_b64_tr_b16 v[240:241], v4 offset:512
    s_waitcnt vmcnt(6)
    v_mfma_f32_16x16x32_bf16 v[28:31], v[224:227], v[92:95], 0
    ds_read_b64_tr_b16 v[242:243], v4 offset:1536
    s_waitcnt lgkmcnt(6)
    v_mfma_f32_16x16x32_bf16 v[32:35], v[228:231], v[88:91], 0
    ds_read_b64_tr_b16 v[244:245], v5 offset:544
    v_mfma_f32_16x16x32_bf16 v[36:39], v[228:231], v[92:95], 0
    ds_read_b64_tr_b16 v[246:247], v5 offset:1568
    s_mov_b32 s23, 0x1000
    buffer_load_dwordx4 v[120:123], v7, s[8:11], s23 offen offset:0 sc1
    s_waitcnt lgkmcnt(6)
    v_mfma_f32_16x16x32_bf16 v[40:43], v[232:235], v[88:91], 0
    ds_read_b64_tr_b16 v[224:225], v4 offset:768
    v_mfma_f32_16x16x32_bf16 v[44:47], v[232:235], v[92:95], 0
    ds_read_b64_tr_b16 v[226:227], v4 offset:1792
    s_waitcnt lgkmcnt(6)
    v_mfma_f32_16x16x32_bf16 v[48:51], v[236:239], v[88:91], 0
    ds_read_b64_tr_b16 v[228:229], v5 offset:800
    v_mfma_f32_16x16x32_bf16 v[52:55], v[236:239], v[92:95], 0
    ds_read_b64_tr_b16 v[230:231], v5 offset:1824
    s_waitcnt lgkmcnt(6)
    v_mfma_f32_16x16x32_bf16 v[56:59], v[240:243], v[88:91], 0
    ds_read_b64_tr_b16 v[232:233], v4 offset:8192
    v_mfma_f32_16x16x32_bf16 v[60:63], v[240:243], v[92:95], 0
    ds_read_b64_tr_b16 v[234:235], v4 offset:9216
    s_waitcnt lgkmcnt(6)
    v_mfma_f32_16x16x32_bf16 v[64:67], v[244:247], v[88:91], 0
    ds_read_b64_tr_b16 v[236:237], v5 offset:8224
    v_mfma_f32_16x16x32_bf16 v[68:71], v[244:247], v[92:95], 0
    ds_read_b64_tr_b16 v[238:239], v5 offset:9248
    s_mov_b32 s23, 0x9000
    buffer_load_dwordx4 v[124:127], v7, s[8:11], s23 offen offset:0 sc1
    s_waitcnt lgkmcnt(6)
    v_mfma_f32_16x16x32_bf16 v[72:75], v[224:227], v[88:91], 0
    ds_read_b64_tr_b16 v[240:241], v4 offset:8448
    v_mfma_f32_16x16x32_bf16 v[76:79], v[224:227], v[92:95], 0
    ds_read_b64_tr_b16 v[242:243], v4 offset:9472
    s_waitcnt lgkmcnt(6)
    v_mfma_f32_16x16x32_bf16 v[80:83], v[228:231], v[88:91], 0
    ds_read_b64_tr_b16 v[244:245], v5 offset:8480
    v_mfma_f32_16x16x32_bf16 v[84:87], v[228:231], v[92:95], 0
    ds_read_b64_tr_b16 v[246:247], v5 offset:9504
    s_waitcnt vmcnt(7) lgkmcnt(6)
    v_mfma_f32_16x16x32_bf16 v[24:27], v[232:235], v[96:99], v[24:27]
    ds_read_b64_tr_b16 v[224:225], v4 offset:8704
    s_waitcnt vmcnt(6)
    v_mfma_f32_16x16x32_bf16 v[28:31], v[232:235], v[100:103], v[28:31]
    ds_read_b64_tr_b16 v[226:227], v4 offset:9728
    s_waitcnt lgkmcnt(6)
    v_mfma_f32_16x16x32_bf16 v[32:35], v[236:239], v[96:99], v[32:35]
    ds_read_b64_tr_b16 v[228:229], v5 offset:8736
    v_mfma_f32_16x16x32_bf16 v[36:39], v[236:239], v[100:103], v[36:39]
    ds_read_b64_tr_b16 v[230:231], v5 offset:9760
    s_mov_b32 s23, 0x1000
    buffer_load_dwordx4 v[128:131], v7, s[8:11], s23 offen offset:1024 sc1
    s_waitcnt lgkmcnt(6)
    v_mfma_f32_16x16x32_bf16 v[40:43], v[240:243], v[96:99], v[40:43]
    ds_read_b64_tr_b16 v[232:233], v4 offset:8960
    v_mfma_f32_16x16x32_bf16 v[44:47], v[240:243], v[100:103], v[44:47]
    ds_read_b64_tr_b16 v[234:235], v4 offset:9984
    s_waitcnt lgkmcnt(6)
    v_mfma_f32_16x16x32_bf16 v[48:51], v[244:247], v[96:99], v[48:51]
    ds_read_b64_tr_b16 v[236:237], v5 offset:8992
    v_mfma_f32_16x16x32_bf16 v[52:55], v[244:247], v[100:103], v[52:55]
    ds_read_b64_tr_b16 v[238:239], v5 offset:10016
    s_waitcnt lgkmcnt(6)
    v_mfma_f32_16x16x32_bf16 v[56:59], v[224:227], v[96:99], v[56:59]
    v_mfma_f32_16x16x32_bf16 v[60:63], v[224:227], v[100:103], v[60:63]
    s_barrier
    ds_read_b64_tr_b16 v[240:241], v4 offset:16384
    ds_read_b64_tr_b16 v[242:243], v4 offset:17408
    s_waitcnt lgkmcnt(6)
    v_mfma_f32_16x16x32_bf16 v[64:67], v[228:231], v[96:99], v[64:67]
    ds_read_b64_tr_b16 v[244:245], v5 offset:16416
    v_mfma_f32_16x16x32_bf16 v[68:71], v[228:231], v[100:103], v[68:71]
    s_add_u32 s22, s19, 0x180000
    s_add_u32 m0, s20, 0xc000
    s_nop 0
    buffer_load_dwordx4 v3, s[4:7], s22 offen lds
    ds_read_b64_tr_b16 v[246:247], v5 offset:17440
    s_mov_b32 s23, 0x9000
    buffer_load_dwordx4 v[132:135], v7, s[8:11], s23 offen offset:1024 sc1
    s_waitcnt lgkmcnt(6)
    v_mfma_f32_16x16x32_bf16 v[72:75], v[232:235], v[96:99], v[72:75]
    ds_read_b64_tr_b16 v[224:225], v4 offset:16640
    v_mfma_f32_16x16x32_bf16 v[76:79], v[232:235], v[100:103], v[76:79]
    ds_read_b64_tr_b16 v[226:227], v4 offset:17664
    s_waitcnt lgkmcnt(6)
    v_mfma_f32_16x16x32_bf16 v[80:83], v[236:239], v[96:99], v[80:83]
    ds_read_b64_tr_b16 v[228:229], v5 offset:16672
    v_mfma_f32_16x16x32_bf16 v[84:87], v[236:239], v[100:103], v[84:87]
    ds_read_b64_tr_b16 v[230:231], v5 offset:17696
    s_waitcnt vmcnt(8) lgkmcnt(6)
    v_mfma_f32_16x16x32_bf16 v[24:27], v[240:243], v[104:107], v[24:27]
    ds_read_b64_tr_b16 v[232:233], v4 offset:16896
    s_waitcnt vmcnt(7)
    v_mfma_f32_16x16x32_bf16 v[28:31], v[240:243], v[108:111], v[28:31]
    ds_read_b64_tr_b16 v[234:235], v4 offset:17920
    s_waitcnt lgkmcnt(6)
    v_mfma_f32_16x16x32_bf16 v[32:35], v[244:247], v[104:107], v[32:35]
    ds_read_b64_tr_b16 v[236:237], v5 offset:16928
    v_mfma_f32_16x16x32_bf16 v[36:39], v[244:247], v[108:111], v[36:39]
    s_add_u32 s22, s19, 0x188000
    s_add_u32 m0, s20, 0xc400
    s_nop 0
    buffer_load_dwordx4 v3, s[4:7], s22 offen lds
    ds_read_b64_tr_b16 v[238:239], v5 offset:17952
    s_mov_b32 s23, 0x1800
    buffer_load_dwordx4 v[88:91], v7, s[8:11], s23 offen offset:0 sc1
    s_waitcnt lgkmcnt(6)
    v_mfma_f32_16x16x32_bf16 v[40:43], v[224:227], v[104:107], v[40:43]
    ds_read_b64_tr_b16 v[240:241], v4 offset:17152
    v_mfma_f32_16x16x32_bf16 v[44:47], v[224:227], v[108:111], v[44:47]
    ds_read_b64_tr_b16 v[242:243], v4 offset:18176
    s_waitcnt lgkmcnt(6)
    v_mfma_f32_16x16x32_bf16 v[48:51], v[228:231], v[104:107], v[48:51]
    ds_read_b64_tr_b16 v[244:245], v5 offset:17184
    v_mfma_f32_16x16x32_bf16 v[52:55], v[228:231], v[108:111], v[52:55]
    ds_read_b64_tr_b16 v[246:247], v5 offset:18208
    s_waitcnt lgkmcnt(6)
    v_mfma_f32_16x16x32_bf16 v[56:59], v[232:235], v[104:107], v[56:59]
    ds_read_b64_tr_b16 v[224:225], v4 offset:24576
    v_mfma_f32_16x16x32_bf16 v[60:63], v[232:235], v[108:111], v[60:63]
    ds_read_b64_tr_b16 v[226:227], v4 offset:25600
    s_waitcnt lgkmcnt(6)
    v_mfma_f32_16x16x32_bf16 v[64:67], v[236:239], v[104:107], v[64:67]
    ds_read_b64_tr_b16 v[228:229], v5 offset:24608
    v_mfma_f32_16x16x32_bf16 v[68:71], v[236:239], v[108:111], v[68:71]
    ds_read_b64_tr_b16 v[230:231], v5 offset:25632
    s_mov_b32 s23, 0x9800
    buffer_load_dwordx4 v[92:95], v7, s[8:11], s23 offen offset:0 sc1
    s_waitcnt lgkmcnt(6)
    v_mfma_f32_16x16x32_bf16 v[72:75], v[240:243], v[104:107], v[72:75]
    ds_read_b64_tr_b16 v[232:233], v4 offset:24832
    v_mfma_f32_16x16x32_bf16 v[76:79], v[240:243], v[108:111], v[76:79]
    ds_read_b64_tr_b16 v[234:235], v4 offset:25856
    s_waitcnt lgkmcnt(6)
    v_mfma_f32_16x16x32_bf16 v[80:83], v[244:247], v[104:107], v[80:83]
    ds_read_b64_tr_b16 v[236:237], v5 offset:24864
    v_mfma_f32_16x16x32_bf16 v[84:87], v[244:247], v[108:111], v[84:87]
    ds_read_b64_tr_b16 v[238:239], v5 offset:25888
    s_waitcnt vmcnt(9) lgkmcnt(6)
    v_mfma_f32_16x16x32_bf16 v[24:27], v[224:227], v[112:115], v[24:27]
    ds_read_b64_tr_b16 v[240:241], v4 offset:25088
    s_waitcnt vmcnt(8)
    v_mfma_f32_16x16x32_bf16 v[28:31], v[224:227], v[116:119], v[28:31]
    ds_read_b64_tr_b16 v[242:243], v4 offset:26112
    s_waitcnt lgkmcnt(6)
    v_mfma_f32_16x16x32_bf16 v[32:35], v[228:231], v[112:115], v[32:35]
    ds_read_b64_tr_b16 v[244:245], v5 offset:25120
    v_mfma_f32_16x16x32_bf16 v[36:39], v[228:231], v[116:119], v[36:39]
    ds_read_b64_tr_b16 v[246:247], v5 offset:26144
    s_mov_b32 s23, 0x1800
    buffer_load_dwordx4 v[96:99], v7, s[8:11], s23 offen offset:1024 sc1
    s_waitcnt lgkmcnt(6)
    v_mfma_f32_16x16x32_bf16 v[40:43], v[232:235], v[112:115], v[40:43]
    ds_read_b64_tr_b16 v[224:225], v4 offset:25344
    v_mfma_f32_16x16x32_bf16 v[44:47], v[232:235], v[116:119], v[44:47]
    ds_read_b64_tr_b16 v[226:227], v4 offset:26368
    s_waitcnt lgkmcnt(6)
    v_mfma_f32_16x16x32_bf16 v[48:51], v[236:239], v[112:115], v[48:51]
    ds_read_b64_tr_b16 v[228:229], v5 offset:25376
    v_mfma_f32_16x16x32_bf16 v[52:55], v[236:239], v[116:119], v[52:55]
    ds_read_b64_tr_b16 v[230:231], v5 offset:26400
    s_waitcnt lgkmcnt(6)
    v_mfma_f32_16x16x32_bf16 v[56:59], v[240:243], v[112:115], v[56:59]
    v_mfma_f32_16x16x32_bf16 v[60:63], v[240:243], v[116:119], v[60:63]
    s_barrier
    ds_read_b64_tr_b16 v[232:233], v4 offset:32768
    ds_read_b64_tr_b16 v[234:235], v4 offset:33792
    s_waitcnt lgkmcnt(6)
    v_mfma_f32_16x16x32_bf16 v[64:67], v[244:247], v[112:115], v[64:67]
    ds_read_b64_tr_b16 v[236:237], v5 offset:32800
    v_mfma_f32_16x16x32_bf16 v[68:71], v[244:247], v[116:119], v[68:71]
    s_add_u32 s22, s19, 0x200000
    s_add_u32 m0, s20, 0x0
    s_nop 0
    buffer_load_dwordx4 v3, s[4:7], s22 offen lds
    ds_read_b64_tr_b16 v[238:239], v5 offset:33824
    s_mov_b32 s23, 0x9800
    buffer_load_dwordx4 v[100:103], v7, s[8:11], s23 offen offset:1024 sc1
    s_waitcnt lgkmcnt(6)
    v_mfma_f32_16x16x32_bf16 v[72:75], v[224:227], v[112:115], v[72:75]
    ds_read_b64_tr_b16 v[240:241], v4 offset:33024
    v_mfma_f32_16x16x32_bf16 v[76:79], v[224:227], v[116:119], v[76:79]
    ds_read_b64_tr_b16 v[242:243], v4 offset:34048
    s_waitcnt lgkmcnt(6)
    v_mfma_f32_16x16x32_bf16 v[80:83], v[228:231], v[112:115], v[80:83]
    ds_read_b64_tr_b16 v[244:245], v5 offset:33056
    v_mfma_f32_16x16x32_bf16 v[84:87], v[228:231], v[116:119], v[84:87]
    ds_read_b64_tr_b16 v[246:247], v5 offset:34080
    s_waitcnt vmcnt(10) lgkmcnt(6)
    v_mfma_f32_16x16x32_bf16 v[24:27], v[232:235], v[120:123], v[24:27]
    ds_read_b64_tr_b16 v[224:225], v4 offset:33280
    s_waitcnt vmcnt(9)
    v_mfma_f32_16x16x32_bf16 v[28:31], v[232:235], v[124:127], v[28:31]
    ds_read_b64_tr_b16 v[226:227], v4 offset:34304
    s_waitcnt lgkmcnt(6)
    v_mfma_f32_16x16x32_bf16 v[32:35], v[236:239], v[120:123], v[32:35]
    ds_read_b64_tr_b16 v[228:229], v5 offset:33312
    v_mfma_f32_16x16x32_bf16 v[36:39], v[236:239], v[124:127], v[36:39]
    s_add_u32 s22, s19, 0x208000
    s_add_u32 m0, s20, 0x400
    s_nop 0
    buffer_load_dwordx4 v3, s[4:7], s22 offen lds
    ds_read_b64_tr_b16 v[230:231], v5 offset:34336
    s_mov_b32 s23, 0x2000
    buffer_load_dwordx4 v[104:107], v7, s[8:11], s23 offen offset:0 sc1
    s_waitcnt lgkmcnt(6)
    v_mfma_f32_16x16x32_bf16 v[40:43], v[240:243], v[120:123], v[40:43]
    ds_read_b64_tr_b16 v[232:233], v4 offset:33536
    v_mfma_f32_16x16x32_bf16 v[44:47], v[240:243], v[124:127], v[44:47]
    ds_read_b64_tr_b16 v[234:235], v4 offset:34560
    s_waitcnt lgkmcnt(6)
    v_mfma_f32_16x16x32_bf16 v[48:51], v[244:247], v[120:123], v[48:51]
    ds_read_b64_tr_b16 v[236:237], v5 offset:33568
    v_mfma_f32_16x16x32_bf16 v[52:55], v[244:247], v[124:127], v[52:55]
    ds_read_b64_tr_b16 v[238:239], v5 offset:34592
    s_waitcnt lgkmcnt(6)
    v_mfma_f32_16x16x32_bf16 v[56:59], v[224:227], v[120:123], v[56:59]
    ds_read_b64_tr_b16 v[240:241], v4 offset:40960
    v_mfma_f32_16x16x32_bf16 v[60:63], v[224:227], v[124:127], v[60:63]
    ds_read_b64_tr_b16 v[242:243], v4 offset:41984
    s_waitcnt lgkmcnt(6)
    v_mfma_f32_16x16x32_bf16 v[64:67], v[228:231], v[120:123], v[64:67]
    ds_read_b64_tr_b16 v[244:245], v5 offset:40992
    v_mfma_f32_16x16x32_bf16 v[68:71], v[228:231], v[124:127], v[68:71]
    ds_read_b64_tr_b16 v[246:247], v5 offset:42016
    s_mov_b32 s23, 0xa000
    buffer_load_dwordx4 v[108:111], v7, s[8:11], s23 offen offset:0 sc1
    s_waitcnt lgkmcnt(6)
    v_mfma_f32_16x16x32_bf16 v[72:75], v[232:235], v[120:123], v[72:75]
    ds_read_b64_tr_b16 v[224:225], v4 offset:41216
    v_mfma_f32_16x16x32_bf16 v[76:79], v[232:235], v[124:127], v[76:79]
    ds_read_b64_tr_b16 v[226:227], v4 offset:42240
    s_waitcnt lgkmcnt(6)
    v_mfma_f32_16x16x32_bf16 v[80:83], v[236:239], v[120:123], v[80:83]
    ds_read_b64_tr_b16 v[228:229], v5 offset:41248
    v_mfma_f32_16x16x32_bf16 v[84:87], v[236:239], v[124:127], v[84:87]
    ds_read_b64_tr_b16 v[230:231], v5 offset:42272
    s_waitcnt vmcnt(11) lgkmcnt(6)
    v_mfma_f32_16x16x32_bf16 v[24:27], v[240:243], v[128:131], v[24:27]
    ds_read_b64_tr_b16 v[232:233], v4 offset:41472
    s_waitcnt vmcnt(9)
    v_mfma_f32_16x16x32_bf16 v[28:31], v[240:243], v[132:135], v[28:31]
    ds_read_b64_tr_b16 v[234:235], v4 offset:42496
    s_waitcnt lgkmcnt(6)
    v_mfma_f32_16x16x32_bf16 v[32:35], v[244:247], v[128:131], v[32:35]
    ds_read_b64_tr_b16 v[236:237], v5 offset:41504
    v_mfma_f32_16x16x32_bf16 v[36:39], v[244:247], v[132:135], v[36:39]
    ds_read_b64_tr_b16 v[238:239], v5 offset:42528
    s_mov_b32 s23, 0x2000
    buffer_load_dwordx4 v[112:115], v7, s[8:11], s23 offen offset:1024 sc1
    s_waitcnt lgkmcnt(6)
    v_mfma_f32_16x16x32_bf16 v[40:43], v[224:227], v[128:131], v[40:43]
    ds_read_b64_tr_b16 v[240:241], v4 offset:41728
    v_mfma_f32_16x16x32_bf16 v[44:47], v[224:227], v[132:135], v[44:47]
    ds_read_b64_tr_b16 v[242:243], v4 offset:42752
    s_waitcnt lgkmcnt(6)
    v_mfma_f32_16x16x32_bf16 v[48:51], v[228:231], v[128:131], v[48:51]
    ds_read_b64_tr_b16 v[244:245], v5 offset:41760
    v_mfma_f32_16x16x32_bf16 v[52:55], v[228:231], v[132:135], v[52:55]
    ds_read_b64_tr_b16 v[246:247], v5 offset:42784
    s_waitcnt lgkmcnt(6)
    v_mfma_f32_16x16x32_bf16 v[56:59], v[232:235], v[128:131], v[56:59]
    v_mfma_f32_16x16x32_bf16 v[60:63], v[232:235], v[132:135], v[60:63]
    s_waitcnt vmcnt(9)
    s_barrier
    ds_read_b64_tr_b16 v[224:225], v4 offset:49152
    ds_read_b64_tr_b16 v[226:227], v4 offset:50176
    s_waitcnt lgkmcnt(6)
    v_mfma_f32_16x16x32_bf16 v[64:67], v[236:239], v[128:131], v[64:67]
    ds_read_b64_tr_b16 v[228:229], v5 offset:49184
    v_mfma_f32_16x16x32_bf16 v[68:71], v[236:239], v[132:135], v[68:71]
    s_add_u32 s22, s19, 0x280000
    s_add_u32 m0, s20, 0x4000
    s_nop 0
    buffer_load_dwordx4 v3, s[4:7], s22 offen lds
    ds_read_b64_tr_b16 v[230:231], v5 offset:50208
    s_mov_b32 s23, 0xa000
    buffer_load_dwordx4 v[116:119], v7, s[8:11], s23 offen offset:1024 sc1
    s_waitcnt lgkmcnt(6)
    v_mfma_f32_16x16x32_bf16 v[72:75], v[240:243], v[128:131], v[72:75]
    ds_read_b64_tr_b16 v[232:233], v4 offset:49408
    v_mfma_f32_16x16x32_bf16 v[76:79], v[240:243], v[132:135], v[76:79]
    ds_read_b64_tr_b16 v[234:235], v4 offset:50432
    s_waitcnt lgkmcnt(6)
    v_mfma_f32_16x16x32_bf16 v[80:83], v[244:247], v[128:131], v[80:83]
    ds_read_b64_tr_b16 v[236:237], v5 offset:49440
    v_mfma_f32_16x16x32_bf16 v[84:87], v[244:247], v[132:135], v[84:87]
    ds_read_b64_tr_b16 v[238:239], v5 offset:50464
    s_waitcnt vmcnt(10) lgkmcnt(6)
    v_mfma_f32_16x16x32_bf16 v[24:27], v[224:227], v[88:91], v[24:27]
    ds_read_b64_tr_b16 v[240:241], v4 offset:49664
    s_waitcnt vmcnt(9)
    v_mfma_f32_16x16x32_bf16 v[28:31], v[224:227], v[92:95], v[28:31]
    ds_read_b64_tr_b16 v[242:243], v4 offset:50688
    s_waitcnt lgkmcnt(6)
    v_mfma_f32_16x16x32_bf16 v[32:35], v[228:231], v[88:91], v[32:35]
    ds_read_b64_tr_b16 v[244:245], v5 offset:49696
    v_mfma_f32_16x16x32_bf16 v[36:39], v[228:231], v[92:95], v[36:39]
    s_add_u32 s22, s19, 0x288000
    s_add_u32 m0, s20, 0x4400
    s_nop 0
    buffer_load_dwordx4 v3, s[4:7], s22 offen lds
    ds_read_b64_tr_b16 v[246:247], v5 offset:50720
    s_mov_b32 s23, 0x2800
    buffer_load_dwordx4 v[120:123], v7, s[8:11], s23 offen offset:0 sc1
    s_waitcnt lgkmcnt(6)
    v_mfma_f32_16x16x32_bf16 v[40:43], v[232:235], v[88:91], v[40:43]
    ds_read_b64_tr_b16 v[224:225], v4 offset:49920
    v_mfma_f32_16x16x32_bf16 v[44:47], v[232:235], v[92:95], v[44:47]
    ds_read_b64_tr_b16 v[226:227], v4 offset:50944
    s_waitcnt lgkmcnt(6)
    v_mfma_f32_16x16x32_bf16 v[48:51], v[236:239], v[88:91], v[48:51]
    ds_read_b64_tr_b16 v[228:229], v5 offset:49952
    v_mfma_f32_16x16x32_bf16 v[52:55], v[236:239], v[92:95], v[52:55]
    ds_read_b64_tr_b16 v[230:231], v5 offset:50976
    s_waitcnt lgkmcnt(6)
    v_mfma_f32_16x16x32_bf16 v[56:59], v[240:243], v[88:91], v[56:59]
    ds_read_b64_tr_b16 v[232:233], v4 offset:57344
    v_mfma_f32_16x16x32_bf16 v[60:63], v[240:243], v[92:95], v[60:63]
    ds_read_b64_tr_b16 v[234:235], v4 offset:58368
    s_waitcnt lgkmcnt(6)
    v_mfma_f32_16x16x32_bf16 v[64:67], v[244:247], v[88:91], v[64:67]
    ds_read_b64_tr_b16 v[236:237], v5 offset:57376
    v_mfma_f32_16x16x32_bf16 v[68:71], v[244:247], v[92:95], v[68:71]
    ds_read_b64_tr_b16 v[238:239], v5 offset:58400
    s_mov_b32 s23, 0xa800
    buffer_load_dwordx4 v[124:127], v7, s[8:11], s23 offen offset:0 sc1
    s_waitcnt lgkmcnt(6)
    v_mfma_f32_16x16x32_bf16 v[72:75], v[224:227], v[88:91], v[72:75]
    ds_read_b64_tr_b16 v[240:241], v4 offset:57600
    v_mfma_f32_16x16x32_bf16 v[76:79], v[224:227], v[92:95], v[76:79]
    ds_read_b64_tr_b16 v[242:243], v4 offset:58624
    s_waitcnt lgkmcnt(6)
    v_mfma_f32_16x16x32_bf16 v[80:83], v[228:231], v[88:91], v[80:83]
    ds_read_b64_tr_b16 v[244:245], v5 offset:57632
    v_mfma_f32_16x16x32_bf16 v[84:87], v[228:231], v[92:95], v[84:87]
    ds_read_b64_tr_b16 v[246:247], v5 offset:58656
    s_waitcnt vmcnt(11) lgkmcnt(6)
    v_mfma_f32_16x16x32_bf16 v[24:27], v[232:235], v[96:99], v[24:27]
    ds_read_b64_tr_b16 v[224:225], v4 offset:57856
    s_waitcnt vmcnt(9)
    v_mfma_f32_16x16x32_bf16 v[28:31], v[232:235], v[100:103], v[28:31]
    ds_read_b64_tr_b16 v[226:227], v4 offset:58880
    s_waitcnt lgkmcnt(6)
    v_mfma_f32_16x16x32_bf16 v[32:35], v[236:239], v[96:99], v[32:35]
    ds_read_b64_tr_b16 v[228:229], v5 offset:57888
    v_mfma_f32_16x16x32_bf16 v[36:39], v[236:239], v[100:103], v[36:39]
    ds_read_b64_tr_b16 v[230:231], v5 offset:58912
    s_mov_b32 s23, 0x2800
    buffer_load_dwordx4 v[128:131], v7, s[8:11], s23 offen offset:1024 sc1
    s_waitcnt lgkmcnt(6)
    v_mfma_f32_16x16x32_bf16 v[40:43], v[240:243], v[96:99], v[40:43]
    ds_read_b64_tr_b16 v[232:233], v4 offset:58112
    v_mfma_f32_16x16x32_bf16 v[44:47], v[240:243], v[100:103], v[44:47]
    ds_read_b64_tr_b16 v[234:235], v4 offset:59136
    s_waitcnt lgkmcnt(6)
    v_mfma_f32_16x16x32_bf16 v[48:51], v[244:247], v[96:99], v[48:51]
    ds_read_b64_tr_b16 v[236:237], v5 offset:58144
    v_mfma_f32_16x16x32_bf16 v[52:55], v[244:247], v[100:103], v[52:55]
    ds_read_b64_tr_b16 v[238:239], v5 offset:59168
    s_waitcnt lgkmcnt(6)
    v_mfma_f32_16x16x32_bf16 v[56:59], v[224:227], v[96:99], v[56:59]
    v_mfma_f32_16x16x32_bf16 v[60:63], v[224:227], v[100:103], v[60:63]
    s_waitcnt vmcnt(9)
    s_barrier
    ds_read_b64_tr_b16 v[240:241], v4 offset:0
    ds_read_b64_tr_b16 v[242:243], v4 offset:1024
    s_waitcnt lgkmcnt(6)
    v_mfma_f32_16x16x32_bf16 v[64:67], v[228:231], v[96:99], v[64:67]
    ds_read_b64_tr_b16 v[244:245], v5 offset:32
    v_mfma_f32_16x16x32_bf16 v[68:71], v[228:231], v[100:103], v[68:71]
    s_add_u32 s22, s19, 0x300000
    s_add_u32 m0, s20, 0x8000
    s_nop 0
    buffer_load_dwordx4 v3, s[4:7], s22 offen lds
    ds_read_b64_tr_b16 v[246:247], v5 offset:1056
    s_mov_b32 s23, 0xa800
    buffer_load_dwordx4 v[132:135], v7, s[8:11], s23 offen offset:1024 sc1
    s_waitcnt lgkmcnt(6)
    v_mfma_f32_16x16x32_bf16 v[72:75], v[232:235], v[96:99], v[72:75]
    ds_read_b64_tr_b16 v[224:225], v4 offset:256
    v_mfma_f32_16x16x32_bf16 v[76:79], v[232:235], v[100:103], v[76:79]
    ds_read_b64_tr_b16 v[226:227], v4 offset:1280
    s_waitcnt lgkmcnt(6)
    v_mfma_f32_16x16x32_bf16 v[80:83], v[236:239], v[96:99], v[80:83]
    ds_read_b64_tr_b16 v[228:229], v5 offset:288
    v_mfma_f32_16x16x32_bf16 v[84:87], v[236:239], v[100:103], v[84:87]
    ds_read_b64_tr_b16 v[230:231], v5 offset:1312
    s_waitcnt vmcnt(10) lgkmcnt(6)
    v_mfma_f32_16x16x32_bf16 v[24:27], v[240:243], v[104:107], v[24:27]
    ds_read_b64_tr_b16 v[232:233], v4 offset:512
    s_waitcnt vmcnt(9)
    v_mfma_f32_16x16x32_bf16 v[28:31], v[240:243], v[108:111], v[28:31]
    ds_read_b64_tr_b16 v[234:235], v4 offset:1536
    s_waitcnt lgkmcnt(6)
    v_mfma_f32_16x16x32_bf16 v[32:35], v[244:247], v[104:107], v[32:35]
    ds_read_b64_tr_b16 v[236:237], v5 offset:544
    v_mfma_f32_16x16x32_bf16 v[36:39], v[244:247], v[108:111], v[36:39]
    s_add_u32 s22, s19, 0x308000
    s_add_u32 m0, s20, 0x8400
    s_nop 0
    buffer_load_dwordx4 v3, s[4:7], s22 offen lds
    ds_read_b64_tr_b16 v[238:239], v5 offset:1568
    s_mov_b32 s23, 0x3000
    buffer_load_dwordx4 v[88:91], v7, s[8:11], s23 offen offset:0 sc1
    s_waitcnt lgkmcnt(6)
    v_mfma_f32_16x16x32_bf16 v[40:43], v[224:227], v[104:107], v[40:43]
    ds_read_b64_tr_b16 v[240:241], v4 offset:768
    v_mfma_f32_16x16x32_bf16 v[44:47], v[224:227], v[108:111], v[44:47]
    ds_read_b64_tr_b16 v[242:243], v4 offset:1792
    s_waitcnt lgkmcnt(6)
    v_mfma_f32_16x16x32_bf16 v[48:51], v[228:231], v[104:107], v[48:51]
    ds_read_b64_tr_b16 v[244:245], v5 offset:800
    v_mfma_f32_16x16x32_bf16 v[52:55], v[228:231], v[108:111], v[52:55]
    ds_read_b64_tr_b16 v[246:247], v5 offset:1824
    s_waitcnt lgkmcnt(6)
    v_mfma_f32_16x16x32_bf16 v[56:59], v[232:235], v[104:107], v[56:59]
    ds_read_b64_tr_b16 v[224:225], v4 offset:8192
    v_mfma_f32_16x16x32_bf16 v[60:63], v[232:235], v[108:111], v[60:63]
    ds_read_b64_tr_b16 v[226:227], v4 offset:9216
    s_waitcnt lgkmcnt(6)
    v_mfma_f32_16x16x32_bf16 v[64:67], v[236:239], v[104:107], v[64:67]
    ds_read_b64_tr_b16 v[228:229], v5 offset:8224
    v_mfma_f32_16x16x32_bf16 v[68:71], v[236:239], v[108:111], v[68:71]
    ds_read_b64_tr_b16 v[230:231], v5 offset:9248
    s_mov_b32 s23, 0xb000
    buffer_load_dwordx4 v[92:95], v7, s[8:11], s23 offen offset:0 sc1
    s_waitcnt lgkmcnt(6)
    v_mfma_f32_16x16x32_bf16 v[72:75], v[240:243], v[104:107], v[72:75]
    ds_read_b64_tr_b16 v[232:233], v4 offset:8448
    v_mfma_f32_16x16x32_bf16 v[76:79], v[240:243], v[108:111], v[76:79]
    ds_read_b64_tr_b16 v[234:235], v4 offset:9472
    s_waitcnt lgkmcnt(6)
    v_mfma_f32_16x16x32_bf16 v[80:83], v[244:247], v[104:107], v[80:83]
    ds_read_b64_tr_b16 v[236:237], v5 offset:8480
    v_mfma_f32_16x16x32_bf16 v[84:87], v[244:247], v[108:111], v[84:87]
    ds_read_b64_tr_b16 v[238:239], v5 offset:9504
    s_waitcnt vmcnt(11) lgkmcnt(6)
    v_mfma_f32_16x16x32_bf16 v[24:27], v[224:227], v[112:115], v[24:27]
    ds_read_b64_tr_b16 v[240:241], v4 offset:8704
    s_waitcnt vmcnt(9)
    v_mfma_f32_16x16x32_bf16 v[28:31], v[224:227], v[116:119], v[28:31]
    ds_read_b64_tr_b16 v[242:243], v4 offset:9728
    s_waitcnt lgkmcnt(6)
    v_mfma_f32_16x16x32_bf16 v[32:35], v[228:231], v[112:115], v[32:35]
    ds_read_b64_tr_b16 v[244:245], v5 offset:8736
    v_mfma_f32_16x16x32_bf16 v[36:39], v[228:231], v[116:119], v[36:39]
    ds_read_b64_tr_b16 v[246:247], v5 offset:9760
    s_mov_b32 s23, 0x3000
    buffer_load_dwordx4 v[96:99], v7, s[8:11], s23 offen offset:1024 sc1
    s_waitcnt lgkmcnt(6)
    v_mfma_f32_16x16x32_bf16 v[40:43], v[232:235], v[112:115], v[40:43]
    ds_read_b64_tr_b16 v[224:225], v4 offset:8960
    v_mfma_f32_16x16x32_bf16 v[44:47], v[232:235], v[116:119], v[44:47]
    ds_read_b64_tr_b16 v[226:227], v4 offset:9984
    s_waitcnt lgkmcnt(6)
    v_mfma_f32_16x16x32_bf16 v[48:51], v[236:239], v[112:115], v[48:51]
    ds_read_b64_tr_b16 v[228:229], v5 offset:8992
    v_mfma_f32_16x16x32_bf16 v[52:55], v[236:239], v[116:119], v[52:55]
    ds_read_b64_tr_b16 v[230:231], v5 offset:10016
    s_waitcnt lgkmcnt(6)
    v_mfma_f32_16x16x32_bf16 v[56:59], v[240:243], v[112:115], v[56:59]
    v_mfma_f32_16x16x32_bf16 v[60:63], v[240:243], v[116:119], v[60:63]
    s_waitcnt vmcnt(9)
    s_barrier
    ds_read_b64_tr_b16 v[232:233], v4 offset:16384
    ds_read_b64_tr_b16 v[234:235], v4 offset:17408
    s_waitcnt lgkmcnt(6)
    v_mfma_f32_16x16x32_bf16 v[64:67], v[244:247], v[112:115], v[64:67]
    ds_read_b64_tr_b16 v[236:237], v5 offset:16416
    v_mfma_f32_16x16x32_bf16 v[68:71], v[244:247], v[116:119], v[68:71]
    s_add_u32 s22, s19, 0x380000
    s_add_u32 m0, s20, 0xc000
    s_nop 0
    buffer_load_dwordx4 v3, s[4:7], s22 offen lds
    ds_read_b64_tr_b16 v[238:239], v5 offset:17440
    s_mov_b32 s23, 0xb000
    buffer_load_dwordx4 v[100:103], v7, s[8:11], s23 offen offset:1024 sc1
    s_waitcnt lgkmcnt(6)
    v_mfma_f32_16x16x32_bf16 v[72:75], v[224:227], v[112:115], v[72:75]
    ds_read_b64_tr_b16 v[240:241], v4 offset:16640
    v_mfma_f32_16x16x32_bf16 v[76:79], v[224:227], v[116:119], v[76:79]
    ds_read_b64_tr_b16 v[242:243], v4 offset:17664
    s_waitcnt lgkmcnt(6)
    v_mfma_f32_16x16x32_bf16 v[80:83], v[228:231], v[112:115], v[80:83]
    ds_read_b64_tr_b16 v[244:245], v5 offset:16672
    v_mfma_f32_16x16x32_bf16 v[84:87], v[228:231], v[116:119], v[84:87]
    ds_read_b64_tr_b16 v[246:247], v5 offset:17696
    s_waitcnt vmcnt(10) lgkmcnt(6)
    v_mfma_f32_16x16x32_bf16 v[24:27], v[232:235], v[120:123], v[24:27]
    ds_read_b64_tr_b16 v[224:225], v4 offset:16896
    s_waitcnt vmcnt(9)
    v_mfma_f32_16x16x32_bf16 v[28:31], v[232:235], v[124:127], v[28:31]
    ds_read_b64_tr_b16 v[226:227], v4 offset:17920
    s_waitcnt lgkmcnt(6)
    v_mfma_f32_16x16x32_bf16 v[32:35], v[236:239], v[120:123], v[32:35]
    ds_read_b64_tr_b16 v[228:229], v5 offset:16928
    v_mfma_f32_16x16x32_bf16 v[36:39], v[236:239], v[124:127], v[36:39]
    s_add_u32 s22, s19, 0x388000
    s_add_u32 m0, s20, 0xc400
    s_nop 0
    buffer_load_dwordx4 v3, s[4:7], s22 offen lds
    ds_read_b64_tr_b16 v[230:231], v5 offset:17952
    s_mov_b32 s23, 0x3800
    buffer_load_dwordx4 v[104:107], v7, s[8:11], s23 offen offset:0 sc1
    s_waitcnt lgkmcnt(6)
    v_mfma_f32_16x16x32_bf16 v[40:43], v[240:243], v[120:123], v[40:43]
    ds_read_b64_tr_b16 v[232:233], v4 offset:17152
    v_mfma_f32_16x16x32_bf16 v[44:47], v[240:243], v[124:127], v[44:47]
    ds_read_b64_tr_b16 v[234:235], v4 offset:18176
    s_waitcnt lgkmcnt(6)
    v_mfma_f32_16x16x32_bf16 v[48:51], v[244:247], v[120:123], v[48:51]
    ds_read_b64_tr_b16 v[236:237], v5 offset:17184
    v_mfma_f32_16x16x32_bf16 v[52:55], v[244:247], v[124:127], v[52:55]
    ds_read_b64_tr_b16 v[238:239], v5 offset:18208
    s_waitcnt lgkmcnt(6)
    v_mfma_f32_16x16x32_bf16 v[56:59], v[224:227], v[120:123], v[56:59]
    ds_read_b64_tr_b16 v[240:241], v4 offset:24576
    v_mfma_f32_16x16x32_bf16 v[60:63], v[224:227], v[124:127], v[60:63]
    ds_read_b64_tr_b16 v[242:243], v4 offset:25600
    s_waitcnt lgkmcnt(6)
    v_mfma_f32_16x16x32_bf16 v[64:67], v[228:231], v[120:123], v[64:67]
    ds_read_b64_tr_b16 v[244:245], v5 offset:24608
    v_mfma_f32_16x16x32_bf16 v[68:71], v[228:231], v[124:127], v[68:71]
    ds_read_b64_tr_b16 v[246:247], v5 offset:25632
    s_mov_b32 s23, 0xb800
    buffer_load_dwordx4 v[108:111], v7, s[8:11], s23 offen offset:0 sc1
    s_waitcnt lgkmcnt(6)
    v_mfma_f32_16x16x32_bf16 v[72:75], v[232:235], v[120:123], v[72:75]
    ds_read_b64_tr_b16 v[224:225], v4 offset:24832
    v_mfma_f32_16x16x32_bf16 v[76:79], v[232:235], v[124:127], v[76:79]
    ds_read_b64_tr_b16 v[226:227], v4 offset:25856
    s_waitcnt lgkmcnt(6)
    v_mfma_f32_16x16x32_bf16 v[80:83], v[236:239], v[120:123], v[80:83]
    ds_read_b64_tr_b16 v[228:229], v5 offset:24864
    v_mfma_f32_16x16x32_bf16 v[84:87], v[236:239], v[124:127], v[84:87]
    ds_read_b64_tr_b16 v[230:231], v5 offset:25888
    s_waitcnt vmcnt(11) lgkmcnt(6)
    v_mfma_f32_16x16x32_bf16 v[24:27], v[240:243], v[128:131], v[24:27]
    ds_read_b64_tr_b16 v[232:233], v4 offset:25088
    s_waitcnt vmcnt(9)
    v_mfma_f32_16x16x32_bf16 v[28:31], v[240:243], v[132:135], v[28:31]
    ds_read_b64_tr_b16 v[234:235], v4 offset:26112
    s_waitcnt lgkmcnt(6)
    v_mfma_f32_16x16x32_bf16 v[32:35], v[244:247], v[128:131], v[32:35]
    ds_read_b64_tr_b16 v[236:237], v5 offset:25120
    v_mfma_f32_16x16x32_bf16 v[36:39], v[244:247], v[132:135], v[36:39]
    ds_read_b64_tr_b16 v[238:239], v5 offset:26144
    s_mov_b32 s23, 0x3800
    buffer_load_dwordx4 v[112:115], v7, s[8:11], s23 offen offset:1024 sc1
    s_waitcnt lgkmcnt(6)
    v_mfma_f32_16x16x32_bf16 v[40:43], v[224:227], v[128:131], v[40:43]
    ds_read_b64_tr_b16 v[240:241], v4 offset:25344
    v_mfma_f32_16x16x32_bf16 v[44:47], v[224:227], v[132:135], v[44:47]
    ds_read_b64_tr_b16 v[242:243], v4 offset:26368
    s_waitcnt lgkmcnt(6)
    v_mfma_f32_16x16x32_bf16 v[48:51], v[228:231], v[128:131], v[48:51]
    ds_read_b64_tr_b16 v[244:245], v5 offset:25376
    v_mfma_f32_16x16x32_bf16 v[52:55], v[228:231], v[132:135], v[52:55]
    ds_read_b64_tr_b16 v[246:247], v5 offset:26400
    s_waitcnt lgkmcnt(6)
    v_mfma_f32_16x16x32_bf16 v[56:59], v[232:235], v[128:131], v[56:59]
    v_mfma_f32_16x16x32_bf16 v[60:63], v[232:235], v[132:135], v[60:63]
    s_waitcnt vmcnt(9)
    s_barrier
    ds_read_b64_tr_b16 v[224:225], v4 offset:32768
    ds_read_b64_tr_b16 v[226:227], v4 offset:33792
    s_waitcnt lgkmcnt(6)
    v_mfma_f32_16x16x32_bf16 v[64:67], v[236:239], v[128:131], v[64:67]
    ds_read_b64_tr_b16 v[228:229], v5 offset:32800
    v_mfma_f32_16x16x32_bf16 v[68:71], v[236:239], v[132:135], v[68:71]
    s_add_u32 s22, s19, 0x400000
    s_add_u32 m0, s20, 0x0
    s_nop 0
    buffer_load_dwordx4 v3, s[4:7], s22 offen lds
    ds_read_b64_tr_b16 v[230:231], v5 offset:33824
    s_mov_b32 s23, 0xb800
    buffer_load_dwordx4 v[116:119], v7, s[8:11], s23 offen offset:1024 sc1
    s_waitcnt lgkmcnt(6)
    v_mfma_f32_16x16x32_bf16 v[72:75], v[240:243], v[128:131], v[72:75]
    ds_read_b64_tr_b16 v[232:233], v4 offset:33024
    v_mfma_f32_16x16x32_bf16 v[76:79], v[240:243], v[132:135], v[76:79]
    ds_read_b64_tr_b16 v[234:235], v4 offset:34048
    s_waitcnt lgkmcnt(6)
    v_mfma_f32_16x16x32_bf16 v[80:83], v[244:247], v[128:131], v[80:83]
    ds_read_b64_tr_b16 v[236:237], v5 offset:33056
    v_mfma_f32_16x16x32_bf16 v[84:87], v[244:247], v[132:135], v[84:87]
    ds_read_b64_tr_b16 v[238:239], v5 offset:34080
    s_waitcnt vmcnt(10) lgkmcnt(6)
    v_mfma_f32_16x16x32_bf16 v[24:27], v[224:227], v[88:91], v[24:27]
    ds_read_b64_tr_b16 v[240:241], v4 offset:33280
    s_waitcnt vmcnt(9)
    v_mfma_f32_16x16x32_bf16 v[28:31], v[224:227], v[92:95], v[28:31]
    ds_read_b64_tr_b16 v[242:243], v4 offset:34304
    s_waitcnt lgkmcnt(6)
    v_mfma_f32_16x16x32_bf16 v[32:35], v[228:231], v[88:91], v[32:35]
    ds_read_b64_tr_b16 v[244:245], v5 offset:33312
    v_mfma_f32_16x16x32_bf16 v[36:39], v[228:231], v[92:95], v[36:39]
    s_add_u32 s22, s19, 0x408000
    s_add_u32 m0, s20, 0x400
    s_nop 0
    buffer_load_dwordx4 v3, s[4:7], s22 offen lds
    ds_read_b64_tr_b16 v[246:247], v5 offset:34336
    s_mov_b32 s23, 0x4000
    buffer_load_dwordx4 v[120:123], v7, s[8:11], s23 offen offset:0 sc1
    s_waitcnt lgkmcnt(6)
    v_mfma_f32_16x16x32_bf16 v[40:43], v[232:235], v[88:91], v[40:43]
    ds_read_b64_tr_b16 v[224:225], v4 offset:33536
    v_mfma_f32_16x16x32_bf16 v[44:47], v[232:235], v[92:95], v[44:47]
    ds_read_b64_tr_b16 v[226:227], v4 offset:34560
    s_waitcnt lgkmcnt(6)
    v_mfma_f32_16x16x32_bf16 v[48:51], v[236:239], v[88:91], v[48:51]
    ds_read_b64_tr_b16 v[228:229], v5 offset:33568
    v_mfma_f32_16x16x32_bf16 v[52:55], v[236:239], v[92:95], v[52:55]
    ds_read_b64_tr_b16 v[230:231], v5 offset:34592
    s_waitcnt lgkmcnt(6)
    v_mfma_f32_16x16x32_bf16 v[56:59], v[240:243], v[88:91], v[56:59]
    ds_read_b64_tr_b16 v[232:233], v4 offset:40960
    v_mfma_f32_16x16x32_bf16 v[60:63], v[240:243], v[92:95], v[60:63]
    ds_read_b64_tr_b16 v[234:235], v4 offset:41984
    s_waitcnt lgkmcnt(6)
    v_mfma_f32_16x16x32_bf16 v[64:67], v[244:247], v[88:91], v[64:67]
    ds_read_b64_tr_b16 v[236:237], v5 offset:40992
    v_mfma_f32_16x16x32_bf16 v[68:71], v[244:247], v[92:95], v[68:71]
    ds_read_b64_tr_b16 v[238:239], v5 offset:42016
    s_mov_b32 s23, 0xc000
    buffer_load_dwordx4 v[124:127], v7, s[8:11], s23 offen offset:0 sc1
    s_waitcnt lgkmcnt(6)
    v_mfma_f32_16x16x32_bf16 v[72:75], v[224:227], v[88:91], v[72:75]
    ds_read_b64_tr_b16 v[240:241], v4 offset:41216
    v_lshrrev_b32 v21, 4, v1
    v_lshlrev_b32 v21, 9, v21
    v_and_b32 v20, 15, v1
    v_lshl_add_u32 v21, v20, 4, v21
    s_lshr_b32 s18, s12, 3
    s_lshl_b32 s18, s18, 11
    s_add_u32 s18, s18, 0x528100
    buffer_load_dwordx4 v[12:15], v21, s[8:11], s18 offen sc1
    v_mfma_f32_16x16x32_bf16 v[76:79], v[224:227], v[92:95], v[76:79]
    ds_read_b64_tr_b16 v[242:243], v4 offset:42240
    s_waitcnt lgkmcnt(6)
    v_mfma_f32_16x16x32_bf16 v[80:83], v[228:231], v[88:91], v[80:83]
    ds_read_b64_tr_b16 v[244:245], v5 offset:41248
    v_mfma_f32_16x16x32_bf16 v[84:87], v[228:231], v[92:95], v[84:87]
    ds_read_b64_tr_b16 v[246:247], v5 offset:42272
    s_waitcnt vmcnt(12) lgkmcnt(6)
    v_mfma_f32_16x16x32_bf16 v[24:27], v[232:235], v[96:99], v[24:27]
    ds_read_b64_tr_b16 v[224:225], v4 offset:41472
    s_waitcnt vmcnt(10)
    v_mfma_f32_16x16x32_bf16 v[28:31], v[232:235], v[100:103], v[28:31]
    ds_read_b64_tr_b16 v[226:227], v4 offset:42496
    s_waitcnt lgkmcnt(6)
    v_mfma_f32_16x16x32_bf16 v[32:35], v[236:239], v[96:99], v[32:35]
    ds_read_b64_tr_b16 v[228:229], v5 offset:41504
    v_mfma_f32_16x16x32_bf16 v[36:39], v[236:239], v[100:103], v[36:39]
    ds_read_b64_tr_b16 v[230:231], v5 offset:42528
    s_mov_b32 s23, 0x4000
    buffer_load_dwordx4 v[128:131], v7, s[8:11], s23 offen offset:1024 sc1
    s_waitcnt lgkmcnt(6)
    v_mfma_f32_16x16x32_bf16 v[40:43], v[240:243], v[96:99], v[40:43]
    ds_read_b64_tr_b16 v[232:233], v4 offset:41728
    v_mfma_f32_16x16x32_bf16 v[44:47], v[240:243], v[100:103], v[44:47]
    ds_read_b64_tr_b16 v[234:235], v4 offset:42752
    s_waitcnt lgkmcnt(6)
    v_mfma_f32_16x16x32_bf16 v[48:51], v[244:247], v[96:99], v[48:51]
    ds_read_b64_tr_b16 v[236:237], v5 offset:41760
    v_mfma_f32_16x16x32_bf16 v[52:55], v[244:247], v[100:103], v[52:55]
    ds_read_b64_tr_b16 v[238:239], v5 offset:42784
    s_waitcnt lgkmcnt(6)
    v_mfma_f32_16x16x32_bf16 v[56:59], v[224:227], v[96:99], v[56:59]
    v_mfma_f32_16x16x32_bf16 v[60:63], v[224:227], v[100:103], v[60:63]
    s_waitcnt vmcnt(10)
    s_barrier
    ds_read_b64_tr_b16 v[240:241], v4 offset:49152
    ds_read_b64_tr_b16 v[242:243], v4 offset:50176
    s_waitcnt lgkmcnt(6)
    v_mfma_f32_16x16x32_bf16 v[64:67], v[228:231], v[96:99], v[64:67]
    ds_read_b64_tr_b16 v[244:245], v5 offset:49184
    v_mfma_f32_16x16x32_bf16 v[68:71], v[228:231], v[100:103], v[68:71]
    s_add_u32 s22, s19, 0x480000
    s_add_u32 m0, s20, 0x4000
    s_nop 0
    buffer_load_dwordx4 v3, s[4:7], s22 offen lds
    ds_read_b64_tr_b16 v[246:247], v5 offset:50208
    s_mov_b32 s23, 0xc000
    buffer_load_dwordx4 v[132:135], v7, s[8:11], s23 offen offset:1024 sc1
    s_waitcnt lgkmcnt(6)
    v_mfma_f32_16x16x32_bf16 v[72:75], v[232:235], v[96:99], v[72:75]
    ds_read_b64_tr_b16 v[224:225], v4 offset:49408
    v_mfma_f32_16x16x32_bf16 v[76:79], v[232:235], v[100:103], v[76:79]
    ds_read_b64_tr_b16 v[226:227], v4 offset:50432
    s_waitcnt lgkmcnt(6)
    v_mfma_f32_16x16x32_bf16 v[80:83], v[236:239], v[96:99], v[80:83]
    ds_read_b64_tr_b16 v[228:229], v5 offset:49440
    v_mfma_f32_16x16x32_bf16 v[84:87], v[236:239], v[100:103], v[84:87]
    ds_read_b64_tr_b16 v[230:231], v5 offset:50464
    s_waitcnt vmcnt(11) lgkmcnt(6)
    v_mfma_f32_16x16x32_bf16 v[24:27], v[240:243], v[104:107], v[24:27]
    ds_read_b64_tr_b16 v[232:233], v4 offset:49664
    s_waitcnt vmcnt(10)
    v_mfma_f32_16x16x32_bf16 v[28:31], v[240:243], v[108:111], v[28:31]
    ds_read_b64_tr_b16 v[234:235], v4 offset:50688
    s_waitcnt lgkmcnt(6)
    v_mfma_f32_16x16x32_bf16 v[32:35], v[244:247], v[104:107], v[32:35]
    ds_read_b64_tr_b16 v[236:237], v5 offset:49696
    v_mfma_f32_16x16x32_bf16 v[36:39], v[244:247], v[108:111], v[36:39]
    s_add_u32 s22, s19, 0x488000
    s_add_u32 m0, s20, 0x4400
    s_nop 0
    buffer_load_dwordx4 v3, s[4:7], s22 offen lds
    ds_read_b64_tr_b16 v[238:239], v5 offset:50720
    s_mov_b32 s23, 0x4800
    buffer_load_dwordx4 v[88:91], v7, s[8:11], s23 offen offset:0 sc1
    s_waitcnt lgkmcnt(6)
    v_mfma_f32_16x16x32_bf16 v[40:43], v[224:227], v[104:107], v[40:43]
    ds_read_b64_tr_b16 v[240:241], v4 offset:49920
    v_mfma_f32_16x16x32_bf16 v[44:47], v[224:227], v[108:111], v[44:47]
    ds_read_b64_tr_b16 v[242:243], v4 offset:50944
    s_waitcnt lgkmcnt(6)
    v_mfma_f32_16x16x32_bf16 v[48:51], v[228:231], v[104:107], v[48:51]
    ds_read_b64_tr_b16 v[244:245], v5 offset:49952
    v_mfma_f32_16x16x32_bf16 v[52:55], v[228:231], v[108:111], v[52:55]
    ds_read_b64_tr_b16 v[246:247], v5 offset:50976
    s_waitcnt lgkmcnt(6)
    v_mfma_f32_16x16x32_bf16 v[56:59], v[232:235], v[104:107], v[56:59]
    ds_read_b64_tr_b16 v[224:225], v4 offset:57344
    v_mfma_f32_16x16x32_bf16 v[60:63], v[232:235], v[108:111], v[60:63]
    ds_read_b64_tr_b16 v[226:227], v4 offset:58368
    s_waitcnt lgkmcnt(6)
    v_mfma_f32_16x16x32_bf16 v[64:67], v[236:239], v[104:107], v[64:67]
    ds_read_b64_tr_b16 v[228:229], v5 offset:57376
    v_mfma_f32_16x16x32_bf16 v[68:71], v[236:239], v[108:111], v[68:71]
    ds_read_b64_tr_b16 v[230:231], v5 offset:58400
    s_mov_b32 s23, 0xc800
    buffer_load_dwordx4 v[92:95], v7, s[8:11], s23 offen offset:0 sc1
    s_waitcnt lgkmcnt(6)
    v_mfma_f32_16x16x32_bf16 v[72:75], v[240:243], v[104:107], v[72:75]
    ds_read_b64_tr_b16 v[232:233], v4 offset:57600
    v_mfma_f32_16x16x32_bf16 v[76:79], v[240:243], v[108:111], v[76:79]
    ds_read_b64_tr_b16 v[234:235], v4 offset:58624
    s_waitcnt lgkmcnt(6)
    v_mfma_f32_16x16x32_bf16 v[80:83], v[244:247], v[104:107], v[80:83]
    ds_read_b64_tr_b16 v[236:237], v5 offset:57632
    v_mfma_f32_16x16x32_bf16 v[84:87], v[244:247], v[108:111], v[84:87]
    ds_read_b64_tr_b16 v[238:239], v5 offset:58656
    s_waitcnt vmcnt(12) lgkmcnt(6)
    v_mfma_f32_16x16x32_bf16 v[24:27], v[224:227], v[112:115], v[24:27]
    ds_read_b64_tr_b16 v[240:241], v4 offset:57856
    s_waitcnt vmcnt(10)
    v_mfma_f32_16x16x32_bf16 v[28:31], v[224:227], v[116:119], v[28:31]
    ds_read_b64_tr_b16 v[242:243], v4 offset:58880
    s_waitcnt lgkmcnt(6)
    v_mfma_f32_16x16x32_bf16 v[32:35], v[228:231], v[112:115], v[32:35]
    ds_read_b64_tr_b16 v[244:245], v5 offset:57888
    v_mfma_f32_16x16x32_bf16 v[36:39], v[228:231], v[116:119], v[36:39]
    ds_read_b64_tr_b16 v[246:247], v5 offset:58912
    s_mov_b32 s23, 0x4800
    buffer_load_dwordx4 v[96:99], v7, s[8:11], s23 offen offset:1024 sc1
    s_waitcnt lgkmcnt(6)
    v_mfma_f32_16x16x32_bf16 v[40:43], v[232:235], v[112:115], v[40:43]
    ds_read_b64_tr_b16 v[224:225], v4 offset:58112
    v_mfma_f32_16x16x32_bf16 v[44:47], v[232:235], v[116:119], v[44:47]
    ds_read_b64_tr_b16 v[226:227], v4 offset:59136
    s_waitcnt lgkmcnt(6)
    v_mfma_f32_16x16x32_bf16 v[48:51], v[236:239], v[112:115], v[48:51]
    ds_read_b64_tr_b16 v[228:229], v5 offset:58144
    v_mfma_f32_16x16x32_bf16 v[52:55], v[236:239], v[116:119], v[52:55]
    ds_read_b64_tr_b16 v[230:231], v5 offset:59168
    s_waitcnt lgkmcnt(6)
    v_mfma_f32_16x16x32_bf16 v[56:59], v[240:243], v[112:115], v[56:59]
    v_mfma_f32_16x16x32_bf16 v[60:63], v[240:243], v[116:119], v[60:63]
    s_waitcnt vmcnt(10)
    s_barrier
    ds_read_b64_tr_b16 v[232:233], v4 offset:0
    ds_read_b64_tr_b16 v[234:235], v4 offset:1024
    s_waitcnt lgkmcnt(6)
    v_mfma_f32_16x16x32_bf16 v[64:67], v[244:247], v[112:115], v[64:67]
    ds_read_b64_tr_b16 v[236:237], v5 offset:32
    v_mfma_f32_16x16x32_bf16 v[68:71], v[244:247], v[116:119], v[68:71]
    s_add_u32 s22, s19, 0x500000
    s_add_u32 m0, s20, 0x8000
    s_nop 0
    buffer_load_dwordx4 v3, s[4:7], s22 offen lds
    ds_read_b64_tr_b16 v[238:239], v5 offset:1056
    s_mov_b32 s23, 0xc800
    buffer_load_dwordx4 v[100:103], v7, s[8:11], s23 offen offset:1024 sc1
    s_waitcnt lgkmcnt(6)
    v_mfma_f32_16x16x32_bf16 v[72:75], v[224:227], v[112:115], v[72:75]
    ds_read_b64_tr_b16 v[240:241], v4 offset:256
    v_mfma_f32_16x16x32_bf16 v[76:79], v[224:227], v[116:119], v[76:79]
    ds_read_b64_tr_b16 v[242:243], v4 offset:1280
    s_waitcnt lgkmcnt(6)
    v_mfma_f32_16x16x32_bf16 v[80:83], v[228:231], v[112:115], v[80:83]
    ds_read_b64_tr_b16 v[244:245], v5 offset:288
    v_mfma_f32_16x16x32_bf16 v[84:87], v[228:231], v[116:119], v[84:87]
    ds_read_b64_tr_b16 v[246:247], v5 offset:1312
    s_waitcnt vmcnt(11) lgkmcnt(6)
    v_mfma_f32_16x16x32_bf16 v[24:27], v[232:235], v[120:123], v[24:27]
    ds_read_b64_tr_b16 v[224:225], v4 offset:512
    s_waitcnt vmcnt(10)
    v_mfma_f32_16x16x32_bf16 v[28:31], v[232:235], v[124:127], v[28:31]
    ds_read_b64_tr_b16 v[226:227], v4 offset:1536
    s_waitcnt lgkmcnt(6)
    v_mfma_f32_16x16x32_bf16 v[32:35], v[236:239], v[120:123], v[32:35]
    ds_read_b64_tr_b16 v[228:229], v5 offset:544
    v_mfma_f32_16x16x32_bf16 v[36:39], v[236:239], v[124:127], v[36:39]
    s_add_u32 s22, s19, 0x508000
    s_add_u32 m0, s20, 0x8400
    s_nop 0
    buffer_load_dwordx4 v3, s[4:7], s22 offen lds
    ds_read_b64_tr_b16 v[230:231], v5 offset:1568
    s_mov_b32 s23, 0x5000
    buffer_load_dwordx4 v[104:107], v7, s[8:11], s23 offen offset:0 sc1
    s_waitcnt lgkmcnt(6)
    v_mfma_f32_16x16x32_bf16 v[40:43], v[240:243], v[120:123], v[40:43]
    ds_read_b64_tr_b16 v[232:233], v4 offset:768
    v_mfma_f32_16x16x32_bf16 v[44:47], v[240:243], v[124:127], v[44:47]
    ds_read_b64_tr_b16 v[234:235], v4 offset:1792
    s_waitcnt lgkmcnt(6)
    v_mfma_f32_16x16x32_bf16 v[48:51], v[244:247], v[120:123], v[48:51]
    ds_read_b64_tr_b16 v[236:237], v5 offset:800
    v_mfma_f32_16x16x32_bf16 v[52:55], v[244:247], v[124:127], v[52:55]
    ds_read_b64_tr_b16 v[238:239], v5 offset:1824
    s_waitcnt lgkmcnt(6)
    v_mfma_f32_16x16x32_bf16 v[56:59], v[224:227], v[120:123], v[56:59]
    ds_read_b64_tr_b16 v[240:241], v4 offset:8192
    v_mfma_f32_16x16x32_bf16 v[60:63], v[224:227], v[124:127], v[60:63]
    ds_read_b64_tr_b16 v[242:243], v4 offset:9216
    s_waitcnt lgkmcnt(6)
    v_mfma_f32_16x16x32_bf16 v[64:67], v[228:231], v[120:123], v[64:67]
    ds_read_b64_tr_b16 v[244:245], v5 offset:8224
    v_mfma_f32_16x16x32_bf16 v[68:71], v[228:231], v[124:127], v[68:71]
    ds_read_b64_tr_b16 v[246:247], v5 offset:9248
    s_mov_b32 s23, 0xd000
    buffer_load_dwordx4 v[108:111], v7, s[8:11], s23 offen offset:0 sc1
    s_waitcnt lgkmcnt(6)
    v_mfma_f32_16x16x32_bf16 v[72:75], v[232:235], v[120:123], v[72:75]
    ds_read_b64_tr_b16 v[224:225], v4 offset:8448
    v_mfma_f32_16x16x32_bf16 v[76:79], v[232:235], v[124:127], v[76:79]
    ds_read_b64_tr_b16 v[226:227], v4 offset:9472
    s_waitcnt lgkmcnt(6)
    v_mfma_f32_16x16x32_bf16 v[80:83], v[236:239], v[120:123], v[80:83]
    ds_read_b64_tr_b16 v[228:229], v5 offset:8480
    v_mfma_f32_16x16x32_bf16 v[84:87], v[236:239], v[124:127], v[84:87]
    ds_read_b64_tr_b16 v[230:231], v5 offset:9504
    s_waitcnt vmcnt(11) lgkmcnt(6)
    v_mfma_f32_16x16x32_bf16 v[24:27], v[240:243], v[128:131], v[24:27]
    ds_read_b64_tr_b16 v[232:233], v4 offset:8704
    s_waitcnt vmcnt(9)
    v_mfma_f32_16x16x32_bf16 v[28:31], v[240:243], v[132:135], v[28:31]
    ds_read_b64_tr_b16 v[234:235], v4 offset:9728
    s_waitcnt lgkmcnt(6)
    v_mfma_f32_16x16x32_bf16 v[32:35], v[244:247], v[128:131], v[32:35]
    ds_read_b64_tr_b16 v[236:237], v5 offset:8736
    v_mfma_f32_16x16x32_bf16 v[36:39], v[244:247], v[132:135], v[36:39]
    ds_read_b64_tr_b16 v[238:239], v5 offset:9760
    s_mov_b32 s23, 0x5000
    buffer_load_dwordx4 v[112:115], v7, s[8:11], s23 offen offset:1024 sc1
    s_waitcnt lgkmcnt(6)
    v_mfma_f32_16x16x32_bf16 v[40:43], v[224:227], v[128:131], v[40:43]
    ds_read_b64_tr_b16 v[240:241], v4 offset:8960
    v_mfma_f32_16x16x32_bf16 v[44:47], v[224:227], v[132:135], v[44:47]
    ds_read_b64_tr_b16 v[242:243], v4 offset:9984
    s_waitcnt lgkmcnt(6)
    v_mfma_f32_16x16x32_bf16 v[48:51], v[228:231], v[128:131], v[48:51]
    ds_read_b64_tr_b16 v[244:245], v5 offset:8992
    v_mfma_f32_16x16x32_bf16 v[52:55], v[228:231], v[132:135], v[52:55]
    ds_read_b64_tr_b16 v[246:247], v5 offset:10016
    s_waitcnt lgkmcnt(6)
    v_mfma_f32_16x16x32_bf16 v[56:59], v[232:235], v[128:131], v[56:59]
    v_mfma_f32_16x16x32_bf16 v[60:63], v[232:235], v[132:135], v[60:63]
    s_waitcnt vmcnt(9)
    s_barrier
    ds_read_b64_tr_b16 v[224:225], v4 offset:16384
    ds_read_b64_tr_b16 v[226:227], v4 offset:17408
    s_waitcnt lgkmcnt(6)
    v_mfma_f32_16x16x32_bf16 v[64:67], v[236:239], v[128:131], v[64:67]
    ds_read_b64_tr_b16 v[228:229], v5 offset:16416
    v_mfma_f32_16x16x32_bf16 v[68:71], v[236:239], v[132:135], v[68:71]
    s_add_u32 s22, s19, 0x580000
    s_add_u32 m0, s20, 0xc000
    s_nop 0
    buffer_load_dwordx4 v3, s[4:7], s22 offen lds
    ds_read_b64_tr_b16 v[230:231], v5 offset:17440
    s_mov_b32 s23, 0xd000
    buffer_load_dwordx4 v[116:119], v7, s[8:11], s23 offen offset:1024 sc1
    s_waitcnt lgkmcnt(6)
    v_mfma_f32_16x16x32_bf16 v[72:75], v[240:243], v[128:131], v[72:75]
    ds_read_b64_tr_b16 v[232:233], v4 offset:16640
    v_mfma_f32_16x16x32_bf16 v[76:79], v[240:243], v[132:135], v[76:79]
    ds_read_b64_tr_b16 v[234:235], v4 offset:17664
    s_waitcnt lgkmcnt(6)
    v_mfma_f32_16x16x32_bf16 v[80:83], v[244:247], v[128:131], v[80:83]
    ds_read_b64_tr_b16 v[236:237], v5 offset:16672
    v_mfma_f32_16x16x32_bf16 v[84:87], v[244:247], v[132:135], v[84:87]
    ds_read_b64_tr_b16 v[238:239], v5 offset:17696
    s_waitcnt vmcnt(10) lgkmcnt(6)
    v_mfma_f32_16x16x32_bf16 v[24:27], v[224:227], v[88:91], v[24:27]
    ds_read_b64_tr_b16 v[240:241], v4 offset:16896
    s_waitcnt vmcnt(9)
    v_mfma_f32_16x16x32_bf16 v[28:31], v[224:227], v[92:95], v[28:31]
    ds_read_b64_tr_b16 v[242:243], v4 offset:17920
    s_waitcnt lgkmcnt(6)
    v_mfma_f32_16x16x32_bf16 v[32:35], v[228:231], v[88:91], v[32:35]
    ds_read_b64_tr_b16 v[244:245], v5 offset:16928
    v_mfma_f32_16x16x32_bf16 v[36:39], v[228:231], v[92:95], v[36:39]
    s_add_u32 s22, s19, 0x588000
    s_add_u32 m0, s20, 0xc400
    s_nop 0
    buffer_load_dwordx4 v3, s[4:7], s22 offen lds
    ds_read_b64_tr_b16 v[246:247], v5 offset:17952
    s_mov_b32 s23, 0x5800
    buffer_load_dwordx4 v[120:123], v7, s[8:11], s23 offen offset:0 sc1
    s_waitcnt lgkmcnt(6)
    v_mfma_f32_16x16x32_bf16 v[40:43], v[232:235], v[88:91], v[40:43]
    ds_read_b64_tr_b16 v[224:225], v4 offset:17152
    v_mfma_f32_16x16x32_bf16 v[44:47], v[232:235], v[92:95], v[44:47]
    ds_read_b64_tr_b16 v[226:227], v4 offset:18176
    s_waitcnt lgkmcnt(6)
    v_mfma_f32_16x16x32_bf16 v[48:51], v[236:239], v[88:91], v[48:51]
    ds_read_b64_tr_b16 v[228:229], v5 offset:17184
    v_mfma_f32_16x16x32_bf16 v[52:55], v[236:239], v[92:95], v[52:55]
    ds_read_b64_tr_b16 v[230:231], v5 offset:18208
    s_waitcnt lgkmcnt(6)
    v_mfma_f32_16x16x32_bf16 v[56:59], v[240:243], v[88:91], v[56:59]
    ds_read_b64_tr_b16 v[232:233], v4 offset:24576
    v_mfma_f32_16x16x32_bf16 v[60:63], v[240:243], v[92:95], v[60:63]
    ds_read_b64_tr_b16 v[234:235], v4 offset:25600
    s_waitcnt lgkmcnt(6)
    v_mfma_f32_16x16x32_bf16 v[64:67], v[244:247], v[88:91], v[64:67]
    ds_read_b64_tr_b16 v[236:237], v5 offset:24608
    v_mfma_f32_16x16x32_bf16 v[68:71], v[244:247], v[92:95], v[68:71]
    ds_read_b64_tr_b16 v[238:239], v5 offset:25632
    s_mov_b32 s23, 0xd800
    buffer_load_dwordx4 v[124:127], v7, s[8:11], s23 offen offset:0 sc1
    s_waitcnt lgkmcnt(6)
    v_mfma_f32_16x16x32_bf16 v[72:75], v[224:227], v[88:91], v[72:75]
    ds_read_b64_tr_b16 v[240:241], v4 offset:24832
    v_xor_b32 v8, s28, v12
    v_xor_b32 v20, s28, v13
    v_or_b32 v8, v8, v20
    v_xor_b32 v20, s28, v14
    v_or_b32 v8, v8, v20
    v_xor_b32 v20, s28, v15
    v_or_b32 v8, v8, v20
    v_cmp_ne_u32 vcc, 0, v8
    s_cbranch_vccnz adaLN_cond__sliding_block_cached__moe_arch_mod__prompt_kernel_kv16r
adaLN_cond__sliding_block_cached__moe_arch_mod__prompt_kernel_kv16b:
    v_mfma_f32_16x16x32_bf16 v[76:79], v[224:227], v[92:95], v[76:79]
    ds_read_b64_tr_b16 v[242:243], v4 offset:25856
    v_mov_b32 v20, 0
    s_mov_b32 s16, 0x564000
    buffer_load_dword v8, v20, s[8:11], s16 offen sc1
    s_waitcnt lgkmcnt(6)
    v_mfma_f32_16x16x32_bf16 v[80:83], v[228:231], v[88:91], v[80:83]
    ds_read_b64_tr_b16 v[244:245], v5 offset:24864
    v_mfma_f32_16x16x32_bf16 v[84:87], v[228:231], v[92:95], v[84:87]
    ds_read_b64_tr_b16 v[246:247], v5 offset:25888
    s_waitcnt vmcnt(12) lgkmcnt(6)
    v_mfma_f32_16x16x32_bf16 v[24:27], v[232:235], v[96:99], v[24:27]
    ds_read_b64_tr_b16 v[224:225], v4 offset:25088
    s_waitcnt vmcnt(10)
    v_mfma_f32_16x16x32_bf16 v[28:31], v[232:235], v[100:103], v[28:31]
    ds_read_b64_tr_b16 v[226:227], v4 offset:26112
    s_waitcnt lgkmcnt(6)
    v_mfma_f32_16x16x32_bf16 v[32:35], v[236:239], v[96:99], v[32:35]
    ds_read_b64_tr_b16 v[228:229], v5 offset:25120
    v_mfma_f32_16x16x32_bf16 v[36:39], v[236:239], v[100:103], v[36:39]
    ds_read_b64_tr_b16 v[230:231], v5 offset:26144
    s_mov_b32 s23, 0x5800
    buffer_load_dwordx4 v[128:131], v7, s[8:11], s23 offen offset:1024 sc1
    s_waitcnt lgkmcnt(6)
    v_mfma_f32_16x16x32_bf16 v[40:43], v[240:243], v[96:99], v[40:43]
    ds_read_b64_tr_b16 v[232:233], v4 offset:25344
    s_mov_b64 s[76:77], s[54:55]
    s_mov_b32 s78, 0xc00000
    s_mov_b32 s79, 0x20000
    v_bfe_u32 v20, v1, 2, 2
    v_lshlrev_b32 v20, 12, v20
    v_add_u32 v6, v3, v20
    s_lshr_b32 s16, s2, 5
    s_lshl_b32 s16, s16, 7
    s_lshl_b32 s17, s3, 3
    s_add_u32 s16, s16, s17
    s_mul_i32 s14, s16, 12288
    s_and_b32 s16, s2, 31
    s_lshl_b32 s16, s16, 8
    s_add_u32 s14, s14, s16
    s_add_u32 s14, s14, 4096
    v_mfma_f32_16x16x32_bf16 v[44:47], v[240:243], v[100:103], v[44:47]
    ds_read_b64_tr_b16 v[234:235], v4 offset:26368
    s_waitcnt lgkmcnt(6)
    v_mfma_f32_16x16x32_bf16 v[48:51], v[244:247], v[96:99], v[48:51]
    ds_read_b64_tr_b16 v[236:237], v5 offset:25376
    v_mfma_f32_16x16x32_bf16 v[52:55], v[244:247], v[100:103], v[52:55]
    ds_read_b64_tr_b16 v[238:239], v5 offset:26400
    s_waitcnt lgkmcnt(6)
    v_mfma_f32_16x16x32_bf16 v[56:59], v[224:227], v[96:99], v[56:59]
    v_mfma_f32_16x16x32_bf16 v[60:63], v[224:227], v[100:103], v[60:63]
    s_waitcnt vmcnt(10)
    s_barrier
    ds_read_b64_tr_b16 v[240:241], v4 offset:32768
    ds_read_b64_tr_b16 v[242:243], v4 offset:33792
    s_waitcnt lgkmcnt(6)
    v_mfma_f32_16x16x32_bf16 v[64:67], v[228:231], v[96:99], v[64:67]
    ds_read_b64_tr_b16 v[244:245], v5 offset:32800
    v_mfma_f32_16x16x32_bf16 v[68:71], v[228:231], v[100:103], v[68:71]
    s_add_u32 s22, s19, 0x600000
    s_add_u32 m0, s20, 0x0
    s_nop 0
    buffer_load_dwordx4 v3, s[4:7], s22 offen lds
    ds_read_b64_tr_b16 v[246:247], v5 offset:33824
    s_mov_b32 s23, 0xd800
    buffer_load_dwordx4 v[132:135], v7, s[8:11], s23 offen offset:1024 sc1
    s_waitcnt lgkmcnt(6)
    v_mfma_f32_16x16x32_bf16 v[72:75], v[232:235], v[96:99], v[72:75]
    ds_read_b64_tr_b16 v[224:225], v4 offset:33024
    v_mfma_f32_16x16x32_bf16 v[76:79], v[232:235], v[100:103], v[76:79]
    ds_read_b64_tr_b16 v[226:227], v4 offset:34048
    s_waitcnt lgkmcnt(6)
    v_mfma_f32_16x16x32_bf16 v[80:83], v[236:239], v[96:99], v[80:83]
    ds_read_b64_tr_b16 v[228:229], v5 offset:33056
    v_mfma_f32_16x16x32_bf16 v[84:87], v[236:239], v[100:103], v[84:87]
    ds_read_b64_tr_b16 v[230:231], v5 offset:34080
    s_waitcnt vmcnt(11) lgkmcnt(6)
    v_mfma_f32_16x16x32_bf16 v[24:27], v[240:243], v[104:107], v[24:27]
    ds_read_b64_tr_b16 v[232:233], v4 offset:33280
    s_waitcnt vmcnt(10)
    v_mfma_f32_16x16x32_bf16 v[28:31], v[240:243], v[108:111], v[28:31]
    ds_read_b64_tr_b16 v[234:235], v4 offset:34304
    s_waitcnt lgkmcnt(6)
    v_mfma_f32_16x16x32_bf16 v[32:35], v[244:247], v[104:107], v[32:35]
    ds_read_b64_tr_b16 v[236:237], v5 offset:33312
    v_mfma_f32_16x16x32_bf16 v[36:39], v[244:247], v[108:111], v[36:39]
    s_add_u32 s22, s19, 0x608000
    s_add_u32 m0, s20, 0x400
    s_nop 0
    buffer_load_dwordx4 v3, s[4:7], s22 offen lds
    ds_read_b64_tr_b16 v[238:239], v5 offset:34336
    s_mov_b32 s23, 0x6000
    buffer_load_dwordx4 v[88:91], v7, s[8:11], s23 offen offset:0 sc1
    s_waitcnt lgkmcnt(6)
    v_mfma_f32_16x16x32_bf16 v[40:43], v[224:227], v[104:107], v[40:43]
    ds_read_b64_tr_b16 v[240:241], v4 offset:33536
    v_mfma_f32_16x16x32_bf16 v[44:47], v[224:227], v[108:111], v[44:47]
    ds_read_b64_tr_b16 v[242:243], v4 offset:34560
    s_waitcnt lgkmcnt(6)
    v_mfma_f32_16x16x32_bf16 v[48:51], v[228:231], v[104:107], v[48:51]
    ds_read_b64_tr_b16 v[244:245], v5 offset:33568
    v_mfma_f32_16x16x32_bf16 v[52:55], v[228:231], v[108:111], v[52:55]
    ds_read_b64_tr_b16 v[246:247], v5 offset:34592
    s_waitcnt lgkmcnt(6)
    v_mfma_f32_16x16x32_bf16 v[56:59], v[232:235], v[104:107], v[56:59]
    ds_read_b64_tr_b16 v[224:225], v4 offset:40960
    v_mfma_f32_16x16x32_bf16 v[60:63], v[232:235], v[108:111], v[60:63]
    ds_read_b64_tr_b16 v[226:227], v4 offset:41984
    s_waitcnt lgkmcnt(6)
    v_mfma_f32_16x16x32_bf16 v[64:67], v[236:239], v[104:107], v[64:67]
    ds_read_b64_tr_b16 v[228:229], v5 offset:40992
    v_mfma_f32_16x16x32_bf16 v[68:71], v[236:239], v[108:111], v[68:71]
    ds_read_b64_tr_b16 v[230:231], v5 offset:42016
    s_mov_b32 s23, 0xe000
    buffer_load_dwordx4 v[92:95], v7, s[8:11], s23 offen offset:0 sc1
    s_waitcnt lgkmcnt(6)
    v_mfma_f32_16x16x32_bf16 v[72:75], v[240:243], v[104:107], v[72:75]
    ds_read_b64_tr_b16 v[232:233], v4 offset:41216
    v_mfma_f32_16x16x32_bf16 v[76:79], v[240:243], v[108:111], v[76:79]
    ds_read_b64_tr_b16 v[234:235], v4 offset:42240
    s_waitcnt lgkmcnt(6)
    v_mfma_f32_16x16x32_bf16 v[80:83], v[244:247], v[104:107], v[80:83]
    ds_read_b64_tr_b16 v[236:237], v5 offset:41248
    v_mfma_f32_16x16x32_bf16 v[84:87], v[244:247], v[108:111], v[84:87]
    ds_read_b64_tr_b16 v[238:239], v5 offset:42272
    s_waitcnt vmcnt(12) lgkmcnt(6)
    v_mfma_f32_16x16x32_bf16 v[24:27], v[224:227], v[112:115], v[24:27]
    ds_read_b64_tr_b16 v[240:241], v4 offset:41472
    s_add_u32 s22, s14, 0x0
    s_add_u32 m0, s20, 0x10000
    s_nop 0
    buffer_load_dwordx4 v6, s[76:79], s22 offen lds
    s_waitcnt vmcnt(11)
    v_mfma_f32_16x16x32_bf16 v[28:31], v[224:227], v[116:119], v[28:31]
    ds_read_b64_tr_b16 v[242:243], v4 offset:42496
    s_waitcnt lgkmcnt(6)
    v_mfma_f32_16x16x32_bf16 v[32:35], v[228:231], v[112:115], v[32:35]
    ds_read_b64_tr_b16 v[244:245], v5 offset:41504
    v_mfma_f32_16x16x32_bf16 v[36:39], v[228:231], v[116:119], v[36:39]
    ds_read_b64_tr_b16 v[246:247], v5 offset:42528
    s_mov_b32 s23, 0x6000
    buffer_load_dwordx4 v[96:99], v7, s[8:11], s23 offen offset:1024 sc1
    s_waitcnt lgkmcnt(6)
    v_mfma_f32_16x16x32_bf16 v[40:43], v[232:235], v[112:115], v[40:43]
    ds_read_b64_tr_b16 v[224:225], v4 offset:41728
    s_add_u32 s22, s14, 0xc000
    s_add_u32 m0, s20, 0x10400
    s_nop 0
    buffer_load_dwordx4 v6, s[76:79], s22 offen lds
    v_mfma_f32_16x16x32_bf16 v[44:47], v[232:235], v[116:119], v[44:47]
    ds_read_b64_tr_b16 v[226:227], v4 offset:42752
    s_waitcnt lgkmcnt(6)
    v_mfma_f32_16x16x32_bf16 v[48:51], v[236:239], v[112:115], v[48:51]
    ds_read_b64_tr_b16 v[228:229], v5 offset:41760
    v_mfma_f32_16x16x32_bf16 v[52:55], v[236:239], v[116:119], v[52:55]
    ds_read_b64_tr_b16 v[230:231], v5 offset:42784
    s_waitcnt lgkmcnt(6)
    v_mfma_f32_16x16x32_bf16 v[56:59], v[240:243], v[112:115], v[56:59]
    v_mfma_f32_16x16x32_bf16 v[60:63], v[240:243], v[116:119], v[60:63]
    s_waitcnt vmcnt(12)
    s_barrier
    ds_read_b64_tr_b16 v[232:233], v4 offset:49152
    ds_read_b64_tr_b16 v[234:235], v4 offset:50176
    s_waitcnt lgkmcnt(6)
    v_mfma_f32_16x16x32_bf16 v[64:67], v[244:247], v[112:115], v[64:67]
    ds_read_b64_tr_b16 v[236:237], v5 offset:49184
    v_mfma_f32_16x16x32_bf16 v[68:71], v[244:247], v[116:119], v[68:71]
    s_add_u32 s22, s19, 0x680000
    s_add_u32 m0, s20, 0x4000
    s_nop 0
    buffer_load_dwordx4 v3, s[4:7], s22 offen lds
    ds_read_b64_tr_b16 v[238:239], v5 offset:50208
    s_mov_b32 s23, 0xe000
    buffer_load_dwordx4 v[100:103], v7, s[8:11], s23 offen offset:1024 sc1
    s_waitcnt lgkmcnt(6)
    v_mfma_f32_16x16x32_bf16 v[72:75], v[224:227], v[112:115], v[72:75]
    ds_read_b64_tr_b16 v[240:241], v4 offset:49408
    v_mfma_f32_16x16x32_bf16 v[76:79], v[224:227], v[116:119], v[76:79]
    ds_read_b64_tr_b16 v[242:243], v4 offset:50432
    s_waitcnt lgkmcnt(6)
    v_mfma_f32_16x16x32_bf16 v[80:83], v[228:231], v[112:115], v[80:83]
    ds_read_b64_tr_b16 v[244:245], v5 offset:49440
    v_mfma_f32_16x16x32_bf16 v[84:87], v[228:231], v[116:119], v[84:87]
    ds_read_b64_tr_b16 v[246:247], v5 offset:50464
    s_waitcnt vmcnt(13) lgkmcnt(6)
    v_mfma_f32_16x16x32_bf16 v[24:27], v[232:235], v[120:123], v[24:27]
    ds_read_b64_tr_b16 v[224:225], v4 offset:49664
    s_waitcnt vmcnt(12)
    v_mfma_f32_16x16x32_bf16 v[28:31], v[232:235], v[124:127], v[28:31]
    ds_read_b64_tr_b16 v[226:227], v4 offset:50688
    s_waitcnt lgkmcnt(6)
    v_mfma_f32_16x16x32_bf16 v[32:35], v[236:239], v[120:123], v[32:35]
    ds_read_b64_tr_b16 v[228:229], v5 offset:49696
    v_mfma_f32_16x16x32_bf16 v[36:39], v[236:239], v[124:127], v[36:39]
    s_add_u32 s22, s19, 0x688000
    s_add_u32 m0, s20, 0x4400
    s_nop 0
    buffer_load_dwordx4 v3, s[4:7], s22 offen lds
    ds_read_b64_tr_b16 v[230:231], v5 offset:50720
    s_mov_b32 s23, 0x6800
    buffer_load_dwordx4 v[104:107], v7, s[8:11], s23 offen offset:0 sc1
    s_waitcnt lgkmcnt(6)
    v_mfma_f32_16x16x32_bf16 v[40:43], v[240:243], v[120:123], v[40:43]
    ds_read_b64_tr_b16 v[232:233], v4 offset:49920
    v_mfma_f32_16x16x32_bf16 v[44:47], v[240:243], v[124:127], v[44:47]
    ds_read_b64_tr_b16 v[234:235], v4 offset:50944
    s_waitcnt lgkmcnt(6)
    v_mfma_f32_16x16x32_bf16 v[48:51], v[244:247], v[120:123], v[48:51]
    ds_read_b64_tr_b16 v[236:237], v5 offset:49952
    v_mfma_f32_16x16x32_bf16 v[52:55], v[244:247], v[124:127], v[52:55]
    ds_read_b64_tr_b16 v[238:239], v5 offset:50976
    s_waitcnt lgkmcnt(6)
    v_mfma_f32_16x16x32_bf16 v[56:59], v[224:227], v[120:123], v[56:59]
    ds_read_b64_tr_b16 v[240:241], v4 offset:57344
    v_mfma_f32_16x16x32_bf16 v[60:63], v[224:227], v[124:127], v[60:63]
    ds_read_b64_tr_b16 v[242:243], v4 offset:58368
    s_waitcnt lgkmcnt(6)
    v_mfma_f32_16x16x32_bf16 v[64:67], v[228:231], v[120:123], v[64:67]
    ds_read_b64_tr_b16 v[244:245], v5 offset:57376
    v_mfma_f32_16x16x32_bf16 v[68:71], v[228:231], v[124:127], v[68:71]
    ds_read_b64_tr_b16 v[246:247], v5 offset:58400
    s_mov_b32 s23, 0xe800
    buffer_load_dwordx4 v[108:111], v7, s[8:11], s23 offen offset:0 sc1
    s_waitcnt lgkmcnt(6)
    v_mfma_f32_16x16x32_bf16 v[72:75], v[232:235], v[120:123], v[72:75]
    ds_read_b64_tr_b16 v[224:225], v4 offset:57600
    v_mfma_f32_16x16x32_bf16 v[76:79], v[232:235], v[124:127], v[76:79]
    ds_read_b64_tr_b16 v[226:227], v4 offset:58624
    s_waitcnt lgkmcnt(6)
    v_mfma_f32_16x16x32_bf16 v[80:83], v[236:239], v[120:123], v[80:83]
    ds_read_b64_tr_b16 v[228:229], v5 offset:57632
    v_mfma_f32_16x16x32_bf16 v[84:87], v[236:239], v[124:127], v[84:87]
    ds_read_b64_tr_b16 v[230:231], v5 offset:58656
    s_waitcnt vmcnt(13) lgkmcnt(6)
    v_mfma_f32_16x16x32_bf16 v[24:27], v[240:243], v[128:131], v[24:27]
    ds_read_b64_tr_b16 v[232:233], v4 offset:57856
    s_add_u32 s22, s14, 0xc0000
    s_add_u32 m0, s20, 0x14000
    s_nop 0
    buffer_load_dwordx4 v6, s[76:79], s22 offen lds
    s_waitcnt vmcnt(12)
    v_mfma_f32_16x16x32_bf16 v[28:31], v[240:243], v[132:135], v[28:31]
    ds_read_b64_tr_b16 v[234:235], v4 offset:58880
    s_waitcnt lgkmcnt(6)
    v_mfma_f32_16x16x32_bf16 v[32:35], v[244:247], v[128:131], v[32:35]
    ds_read_b64_tr_b16 v[236:237], v5 offset:57888
    v_mfma_f32_16x16x32_bf16 v[36:39], v[244:247], v[132:135], v[36:39]
    ds_read_b64_tr_b16 v[238:239], v5 offset:58912
    s_mov_b32 s23, 0x6800
    buffer_load_dwordx4 v[112:115], v7, s[8:11], s23 offen offset:1024 sc1
    s_waitcnt lgkmcnt(6)
    v_mfma_f32_16x16x32_bf16 v[40:43], v[224:227], v[128:131], v[40:43]
    ds_read_b64_tr_b16 v[240:241], v4 offset:58112
    s_add_u32 s22, s14, 0xcc000
    s_add_u32 m0, s20, 0x14400
    s_nop 0
    buffer_load_dwordx4 v6, s[76:79], s22 offen lds
    v_mfma_f32_16x16x32_bf16 v[44:47], v[224:227], v[132:135], v[44:47]
    ds_read_b64_tr_b16 v[242:243], v4 offset:59136
    s_waitcnt lgkmcnt(6)
    v_mfma_f32_16x16x32_bf16 v[48:51], v[228:231], v[128:131], v[48:51]
    ds_read_b64_tr_b16 v[244:245], v5 offset:58144
    v_mfma_f32_16x16x32_bf16 v[52:55], v[228:231], v[132:135], v[52:55]
    ds_read_b64_tr_b16 v[246:247], v5 offset:59168
    s_waitcnt lgkmcnt(6)
    v_mfma_f32_16x16x32_bf16 v[56:59], v[232:235], v[128:131], v[56:59]
    v_mfma_f32_16x16x32_bf16 v[60:63], v[232:235], v[132:135], v[60:63]
    s_waitcnt vmcnt(13)
    s_barrier
    ds_read_b64_tr_b16 v[224:225], v4 offset:0
    ds_read_b64_tr_b16 v[226:227], v4 offset:1024
    s_waitcnt lgkmcnt(6)
    v_mfma_f32_16x16x32_bf16 v[64:67], v[236:239], v[128:131], v[64:67]
    ds_read_b64_tr_b16 v[228:229], v5 offset:32
    v_mfma_f32_16x16x32_bf16 v[68:71], v[236:239], v[132:135], v[68:71]
    s_add_u32 s22, s19, 0x700000
    s_add_u32 m0, s20, 0x8000
    s_nop 0
    buffer_load_dwordx4 v3, s[4:7], s22 offen lds
    ds_read_b64_tr_b16 v[230:231], v5 offset:1056
    s_mov_b32 s23, 0xe800
    buffer_load_dwordx4 v[116:119], v7, s[8:11], s23 offen offset:1024 sc1
    s_waitcnt lgkmcnt(6)
    v_mfma_f32_16x16x32_bf16 v[72:75], v[240:243], v[128:131], v[72:75]
    ds_read_b64_tr_b16 v[232:233], v4 offset:256
    v_mfma_f32_16x16x32_bf16 v[76:79], v[240:243], v[132:135], v[76:79]
    ds_read_b64_tr_b16 v[234:235], v4 offset:1280
    s_waitcnt lgkmcnt(6)
    v_mfma_f32_16x16x32_bf16 v[80:83], v[244:247], v[128:131], v[80:83]
    ds_read_b64_tr_b16 v[236:237], v5 offset:288
    v_mfma_f32_16x16x32_bf16 v[84:87], v[244:247], v[132:135], v[84:87]
    ds_read_b64_tr_b16 v[238:239], v5 offset:1312
    s_waitcnt vmcnt(14) lgkmcnt(6)
    v_mfma_f32_16x16x32_bf16 v[24:27], v[224:227], v[88:91], v[24:27]
    ds_read_b64_tr_b16 v[240:241], v4 offset:512
    s_waitcnt vmcnt(13)
    v_mfma_f32_16x16x32_bf16 v[28:31], v[224:227], v[92:95], v[28:31]
    ds_read_b64_tr_b16 v[242:243], v4 offset:1536
    s_waitcnt lgkmcnt(6)
    v_mfma_f32_16x16x32_bf16 v[32:35], v[228:231], v[88:91], v[32:35]
    ds_read_b64_tr_b16 v[244:245], v5 offset:544
    v_mfma_f32_16x16x32_bf16 v[36:39], v[228:231], v[92:95], v[36:39]
    s_add_u32 s22, s19, 0x708000
    s_add_u32 m0, s20, 0x8400
    s_nop 0
    buffer_load_dwordx4 v3, s[4:7], s22 offen lds
    ds_read_b64_tr_b16 v[246:247], v5 offset:1568
    s_mov_b32 s23, 0x7000
    buffer_load_dwordx4 v[120:123], v7, s[8:11], s23 offen offset:0 sc1
    s_waitcnt lgkmcnt(6)
    v_mfma_f32_16x16x32_bf16 v[40:43], v[232:235], v[88:91], v[40:43]
    ds_read_b64_tr_b16 v[224:225], v4 offset:768
    v_mfma_f32_16x16x32_bf16 v[44:47], v[232:235], v[92:95], v[44:47]
    ds_read_b64_tr_b16 v[226:227], v4 offset:1792
    s_waitcnt lgkmcnt(6)
    v_mfma_f32_16x16x32_bf16 v[48:51], v[236:239], v[88:91], v[48:51]
    ds_read_b64_tr_b16 v[228:229], v5 offset:800
    v_mfma_f32_16x16x32_bf16 v[52:55], v[236:239], v[92:95], v[52:55]
    ds_read_b64_tr_b16 v[230:231], v5 offset:1824
    s_waitcnt lgkmcnt(6)
    v_mfma_f32_16x16x32_bf16 v[56:59], v[240:243], v[88:91], v[56:59]
    ds_read_b64_tr_b16 v[232:233], v4 offset:8192
    v_mfma_f32_16x16x32_bf16 v[60:63], v[240:243], v[92:95], v[60:63]
    ds_read_b64_tr_b16 v[234:235], v4 offset:9216
    s_waitcnt lgkmcnt(6)
    v_mfma_f32_16x16x32_bf16 v[64:67], v[244:247], v[88:91], v[64:67]
    ds_read_b64_tr_b16 v[236:237], v5 offset:8224
    v_mfma_f32_16x16x32_bf16 v[68:71], v[244:247], v[92:95], v[68:71]
    ds_read_b64_tr_b16 v[238:239], v5 offset:9248
    s_mov_b32 s23, 0xf000
    buffer_load_dwordx4 v[124:127], v7, s[8:11], s23 offen offset:0 sc1
    s_waitcnt lgkmcnt(6)
    v_mfma_f32_16x16x32_bf16 v[72:75], v[224:227], v[88:91], v[72:75]
    ds_read_b64_tr_b16 v[240:241], v4 offset:8448
    v_mfma_f32_16x16x32_bf16 v[76:79], v[224:227], v[92:95], v[76:79]
    ds_read_b64_tr_b16 v[242:243], v4 offset:9472
    s_waitcnt lgkmcnt(6)
    v_mfma_f32_16x16x32_bf16 v[80:83], v[228:231], v[88:91], v[80:83]
    ds_read_b64_tr_b16 v[244:245], v5 offset:8480
    v_mfma_f32_16x16x32_bf16 v[84:87], v[228:231], v[92:95], v[84:87]
    ds_read_b64_tr_b16 v[246:247], v5 offset:9504
    s_waitcnt vmcnt(14) lgkmcnt(6)
    v_mfma_f32_16x16x32_bf16 v[24:27], v[232:235], v[96:99], v[24:27]
    ds_read_b64_tr_b16 v[224:225], v4 offset:8704
    s_add_u32 s22, s21, 0x0
    s_add_u32 m0, s20, 0x18000
    s_nop 0
    buffer_load_dwordx4 v2, s[8:11], s22 offen sc1 lds
    s_waitcnt vmcnt(12)
    v_mfma_f32_16x16x32_bf16 v[28:31], v[232:235], v[100:103], v[28:31]
    ds_read_b64_tr_b16 v[226:227], v4 offset:9728
    s_waitcnt lgkmcnt(6)
    v_mfma_f32_16x16x32_bf16 v[32:35], v[236:239], v[96:99], v[32:35]
    ds_read_b64_tr_b16 v[228:229], v5 offset:8736
    v_mfma_f32_16x16x32_bf16 v[36:39], v[236:239], v[100:103], v[36:39]
    ds_read_b64_tr_b16 v[230:231], v5 offset:9760
    s_mov_b32 s23, 0x7000
    buffer_load_dwordx4 v[128:131], v7, s[8:11], s23 offen offset:1024 sc1
    s_waitcnt lgkmcnt(6)
    v_mfma_f32_16x16x32_bf16 v[40:43], v[240:243], v[96:99], v[40:43]
    ds_read_b64_tr_b16 v[232:233], v4 offset:8960
    s_add_u32 s22, s21, 0x400
    s_add_u32 m0, s20, 0x18400
    s_nop 0
    buffer_load_dwordx4 v2, s[8:11], s22 offen sc1 lds
    v_mfma_f32_16x16x32_bf16 v[44:47], v[240:243], v[100:103], v[44:47]
    ds_read_b64_tr_b16 v[234:235], v4 offset:9984
    s_waitcnt lgkmcnt(6)
    v_mfma_f32_16x16x32_bf16 v[48:51], v[244:247], v[96:99], v[48:51]
    ds_read_b64_tr_b16 v[236:237], v5 offset:8992
    v_mfma_f32_16x16x32_bf16 v[52:55], v[244:247], v[100:103], v[52:55]
    ds_read_b64_tr_b16 v[238:239], v5 offset:10016
    s_waitcnt lgkmcnt(6)
    v_mfma_f32_16x16x32_bf16 v[56:59], v[224:227], v[96:99], v[56:59]
    v_mfma_f32_16x16x32_bf16 v[60:63], v[224:227], v[100:103], v[60:63]
    s_waitcnt vmcnt(13)
    s_barrier
    ds_read_b64_tr_b16 v[240:241], v4 offset:16384
    ds_read_b64_tr_b16 v[242:243], v4 offset:17408
    s_waitcnt lgkmcnt(6)
    v_mfma_f32_16x16x32_bf16 v[64:67], v[228:231], v[96:99], v[64:67]
    ds_read_b64_tr_b16 v[244:245], v5 offset:16416
    v_mfma_f32_16x16x32_bf16 v[68:71], v[228:231], v[100:103], v[68:71]
    s_add_u32 s22, s19, 0x780000
    s_add_u32 m0, s20, 0xc000
    s_nop 0
    buffer_load_dwordx4 v3, s[4:7], s22 offen lds
    ds_read_b64_tr_b16 v[246:247], v5 offset:17440
    s_mov_b32 s23, 0xf000
    buffer_load_dwordx4 v[132:135], v7, s[8:11], s23 offen offset:1024 sc1
    s_waitcnt lgkmcnt(6)
    v_mfma_f32_16x16x32_bf16 v[72:75], v[232:235], v[96:99], v[72:75]
    ds_read_b64_tr_b16 v[224:225], v4 offset:16640
    v_mfma_f32_16x16x32_bf16 v[76:79], v[232:235], v[100:103], v[76:79]
    ds_read_b64_tr_b16 v[226:227], v4 offset:17664
    s_waitcnt lgkmcnt(6)
    v_mfma_f32_16x16x32_bf16 v[80:83], v[236:239], v[96:99], v[80:83]
    ds_read_b64_tr_b16 v[228:229], v5 offset:16672
    v_mfma_f32_16x16x32_bf16 v[84:87], v[236:239], v[100:103], v[84:87]
    ds_read_b64_tr_b16 v[230:231], v5 offset:17696
    s_waitcnt vmcnt(14) lgkmcnt(6)
    v_mfma_f32_16x16x32_bf16 v[24:27], v[240:243], v[104:107], v[24:27]
    ds_read_b64_tr_b16 v[232:233], v4 offset:16896
    s_waitcnt vmcnt(13)
    v_mfma_f32_16x16x32_bf16 v[28:31], v[240:243], v[108:111], v[28:31]
    ds_read_b64_tr_b16 v[234:235], v4 offset:17920
    s_waitcnt lgkmcnt(6)
    v_mfma_f32_16x16x32_bf16 v[32:35], v[244:247], v[104:107], v[32:35]
    ds_read_b64_tr_b16 v[236:237], v5 offset:16928
    v_mfma_f32_16x16x32_bf16 v[36:39], v[244:247], v[108:111], v[36:39]
    s_add_u32 s22, s19, 0x788000
    s_add_u32 m0, s20, 0xc400
    s_nop 0
    buffer_load_dwordx4 v3, s[4:7], s22 offen lds
    ds_read_b64_tr_b16 v[238:239], v5 offset:17952
    s_mov_b32 s23, 0x7800
    buffer_load_dwordx4 v[88:91], v7, s[8:11], s23 offen offset:0 sc1
    s_waitcnt lgkmcnt(6)
    v_mfma_f32_16x16x32_bf16 v[40:43], v[224:227], v[104:107], v[40:43]
    ds_read_b64_tr_b16 v[240:241], v4 offset:17152
    v_lshrrev_b32 v20, 4, v1
    v_lshlrev_b32 v21, 4, v20
    s_lshl_b32 s16, s2, 8
    s_add_u32 s16, s16, 0x550000
    buffer_load_dwordx4 v[136:139], v21, s[8:11], s16 offen offset:0 sc1
    buffer_load_dwordx4 v[140:143], v21, s[8:11], s16 offen offset:64 sc1
    buffer_load_dwordx4 v[144:147], v21, s[8:11], s16 offen offset:128 sc1
    buffer_load_dwordx4 v[148:151], v21, s[8:11], s16 offen offset:192 sc1
    v_lshlrev_b32 v11, 11, v20
    v_xor_b32 v20, s3, v20
    v_and_b32 v20, 1, v20
    v_lshl_add_u32 v11, v20, 5, v11
    v_bfe_u32 v20, v1, 2, 2
    v_lshl_add_u32 v11, v20, 6, v11
    v_and_b32 v20, 3, v1
    v_lshl_add_u32 v11, v20, 3, v11
    s_lshr_b32 s16, s3, 1
    s_lshl_b32 s16, s16, 8
    s_add_u32 s16, s16, 65536
    v_add_u32 v11, s16, v11
    v_mfma_f32_16x16x32_bf16 v[44:47], v[224:227], v[108:111], v[44:47]
    ds_read_b64_tr_b16 v[242:243], v4 offset:18176
    s_waitcnt lgkmcnt(6)
    v_mfma_f32_16x16x32_bf16 v[48:51], v[228:231], v[104:107], v[48:51]
    ds_read_b64_tr_b16 v[244:245], v5 offset:17184
    v_mfma_f32_16x16x32_bf16 v[52:55], v[228:231], v[108:111], v[52:55]
    ds_read_b64_tr_b16 v[246:247], v5 offset:18208
    s_waitcnt lgkmcnt(6)
    v_mfma_f32_16x16x32_bf16 v[56:59], v[232:235], v[104:107], v[56:59]
    ds_read_b64_tr_b16 v[224:225], v4 offset:24576
    v_mfma_f32_16x16x32_bf16 v[60:63], v[232:235], v[108:111], v[60:63]
    ds_read_b64_tr_b16 v[226:227], v4 offset:25600
    s_waitcnt lgkmcnt(6)
    v_mfma_f32_16x16x32_bf16 v[64:67], v[236:239], v[104:107], v[64:67]
    ds_read_b64_tr_b16 v[228:229], v5 offset:24608
    v_mfma_f32_16x16x32_bf16 v[68:71], v[236:239], v[108:111], v[68:71]
    ds_read_b64_tr_b16 v[230:231], v5 offset:25632
    s_mov_b32 s23, 0xf800
    buffer_load_dwordx4 v[92:95], v7, s[8:11], s23 offen offset:0 sc1
    s_waitcnt lgkmcnt(6)
    v_mfma_f32_16x16x32_bf16 v[72:75], v[240:243], v[104:107], v[72:75]
    ds_read_b64_tr_b16 v[232:233], v4 offset:24832
    v_mfma_f32_16x16x32_bf16 v[76:79], v[240:243], v[108:111], v[76:79]
    ds_read_b64_tr_b16 v[234:235], v4 offset:25856
    s_waitcnt lgkmcnt(6)
    v_mfma_f32_16x16x32_bf16 v[80:83], v[244:247], v[104:107], v[80:83]
    ds_read_b64_tr_b16 v[236:237], v5 offset:24864
    v_mfma_f32_16x16x32_bf16 v[84:87], v[244:247], v[108:111], v[84:87]
    ds_read_b64_tr_b16 v[238:239], v5 offset:25888
    s_waitcnt vmcnt(18) lgkmcnt(6)
    v_mfma_f32_16x16x32_bf16 v[24:27], v[224:227], v[112:115], v[24:27]
    ds_read_b64_tr_b16 v[240:241], v4 offset:25088
    s_add_u32 s22, s21, 0x4000
    s_add_u32 m0, s20, 0x1c000
    s_nop 0
    buffer_load_dwordx4 v2, s[8:11], s22 offen sc1 lds
    s_waitcnt vmcnt(16)
    v_mfma_f32_16x16x32_bf16 v[28:31], v[224:227], v[116:119], v[28:31]
    ds_read_b64_tr_b16 v[242:243], v4 offset:26112
    s_waitcnt lgkmcnt(6)
    v_mfma_f32_16x16x32_bf16 v[32:35], v[228:231], v[112:115], v[32:35]
    ds_read_b64_tr_b16 v[244:245], v5 offset:25120
    v_mfma_f32_16x16x32_bf16 v[36:39], v[228:231], v[116:119], v[36:39]
    ds_read_b64_tr_b16 v[246:247], v5 offset:26144
    s_mov_b32 s23, 0x7800
    buffer_load_dwordx4 v[96:99], v7, s[8:11], s23 offen offset:1024 sc1
    s_waitcnt lgkmcnt(6)
    v_mfma_f32_16x16x32_bf16 v[40:43], v[232:235], v[112:115], v[40:43]
    ds_read_b64_tr_b16 v[224:225], v4 offset:25344
    s_add_u32 s22, s21, 0x4400
    s_add_u32 m0, s20, 0x1c400
    s_nop 0
    buffer_load_dwordx4 v2, s[8:11], s22 offen sc1 lds
    v_mfma_f32_16x16x32_bf16 v[44:47], v[232:235], v[116:119], v[44:47]
    ds_read_b64_tr_b16 v[226:227], v4 offset:26368
    s_waitcnt lgkmcnt(6)
    v_mfma_f32_16x16x32_bf16 v[48:51], v[236:239], v[112:115], v[48:51]
    ds_read_b64_tr_b16 v[228:229], v5 offset:25376
    v_mfma_f32_16x16x32_bf16 v[52:55], v[236:239], v[116:119], v[52:55]
    ds_read_b64_tr_b16 v[230:231], v5 offset:26400
    s_waitcnt lgkmcnt(6)
    v_mfma_f32_16x16x32_bf16 v[56:59], v[240:243], v[112:115], v[56:59]
    v_mfma_f32_16x16x32_bf16 v[60:63], v[240:243], v[116:119], v[60:63]
    s_waitcnt vmcnt(17)
    s_barrier
    ds_read_b64_tr_b16 v[232:233], v4 offset:32768
    ds_read_b64_tr_b16 v[234:235], v4 offset:33792
    s_waitcnt lgkmcnt(6)
    v_mfma_f32_16x16x32_bf16 v[64:67], v[244:247], v[112:115], v[64:67]
    ds_read_b64_tr_b16 v[236:237], v5 offset:32800
    v_mfma_f32_16x16x32_bf16 v[68:71], v[244:247], v[116:119], v[68:71]
    ds_read_b64_tr_b16 v[238:239], v5 offset:33824
    s_mov_b32 s23, 0xf800
    buffer_load_dwordx4 v[100:103], v7, s[8:11], s23 offen offset:1024 sc1
    s_waitcnt lgkmcnt(6)
    v_mfma_f32_16x16x32_bf16 v[72:75], v[224:227], v[112:115], v[72:75]
    ds_read_b64_tr_b16 v[240:241], v4 offset:33024
    v_mfma_f32_16x16x32_bf16 v[76:79], v[224:227], v[116:119], v[76:79]
    ds_read_b64_tr_b16 v[242:243], v4 offset:34048
    s_waitcnt lgkmcnt(6)
    v_mfma_f32_16x16x32_bf16 v[80:83], v[228:231], v[112:115], v[80:83]
    ds_read_b64_tr_b16 v[244:245], v5 offset:33056
    v_mfma_f32_16x16x32_bf16 v[84:87], v[228:231], v[116:119], v[84:87]
    ds_read_b64_tr_b16 v[246:247], v5 offset:34080
    s_waitcnt vmcnt(17) lgkmcnt(6)
    v_mfma_f32_16x16x32_bf16 v[24:27], v[232:235], v[120:123], v[24:27]
    ds_read_b64_tr_b16 v[224:225], v4 offset:33280
    s_waitcnt vmcnt(16)
    v_mfma_f32_16x16x32_bf16 v[28:31], v[232:235], v[124:127], v[28:31]
    ds_read_b64_tr_b16 v[226:227], v4 offset:34304
    s_waitcnt lgkmcnt(6)
    v_mfma_f32_16x16x32_bf16 v[32:35], v[236:239], v[120:123], v[32:35]
    ds_read_b64_tr_b16 v[228:229], v5 offset:33312
    v_mfma_f32_16x16x32_bf16 v[36:39], v[236:239], v[124:127], v[36:39]
    ds_read_b64_tr_b16 v[230:231], v5 offset:34336
    s_waitcnt lgkmcnt(6)
    v_mfma_f32_16x16x32_bf16 v[40:43], v[240:243], v[120:123], v[40:43]
    ds_read_b64_tr_b16 v[232:233], v4 offset:33536
    v_mfma_f32_16x16x32_bf16 v[44:47], v[240:243], v[124:127], v[44:47]
    ds_read_b64_tr_b16 v[234:235], v4 offset:34560
    s_waitcnt lgkmcnt(6)
    v_mfma_f32_16x16x32_bf16 v[48:51], v[244:247], v[120:123], v[48:51]
    ds_read_b64_tr_b16 v[236:237], v5 offset:33568
    v_mfma_f32_16x16x32_bf16 v[52:55], v[244:247], v[124:127], v[52:55]
    ds_read_b64_tr_b16 v[238:239], v5 offset:34592
    s_waitcnt lgkmcnt(6)
    v_mfma_f32_16x16x32_bf16 v[56:59], v[224:227], v[120:123], v[56:59]
    ds_read_b64_tr_b16 v[240:241], v4 offset:40960
    v_mfma_f32_16x16x32_bf16 v[60:63], v[224:227], v[124:127], v[60:63]
    ds_read_b64_tr_b16 v[242:243], v4 offset:41984
    s_waitcnt lgkmcnt(6)
    v_mfma_f32_16x16x32_bf16 v[64:67], v[228:231], v[120:123], v[64:67]
    ds_read_b64_tr_b16 v[244:245], v5 offset:40992
    v_mfma_f32_16x16x32_bf16 v[68:71], v[228:231], v[124:127], v[68:71]
    ds_read_b64_tr_b16 v[246:247], v5 offset:42016
    s_waitcnt lgkmcnt(6)
    v_mfma_f32_16x16x32_bf16 v[72:75], v[232:235], v[120:123], v[72:75]
    ds_read_b64_tr_b16 v[224:225], v4 offset:41216
    v_mfma_f32_16x16x32_bf16 v[76:79], v[232:235], v[124:127], v[76:79]
    ds_read_b64_tr_b16 v[226:227], v4 offset:42240
    s_waitcnt lgkmcnt(6)
    v_mfma_f32_16x16x32_bf16 v[80:83], v[236:239], v[120:123], v[80:83]
    ds_read_b64_tr_b16 v[228:229], v5 offset:41248
    v_mfma_f32_16x16x32_bf16 v[84:87], v[236:239], v[124:127], v[84:87]
    ds_read_b64_tr_b16 v[230:231], v5 offset:42272
    s_waitcnt vmcnt(14) lgkmcnt(6)
    v_mfma_f32_16x16x32_bf16 v[24:27], v[240:243], v[128:131], v[24:27]
    ds_read_b64_tr_b16 v[232:233], v4 offset:41472
    s_waitcnt vmcnt(11)
    v_mfma_f32_16x16x32_bf16 v[28:31], v[240:243], v[132:135], v[28:31]
    ds_read_b64_tr_b16 v[234:235], v4 offset:42496
    s_waitcnt lgkmcnt(6)
    v_mfma_f32_16x16x32_bf16 v[32:35], v[244:247], v[128:131], v[32:35]
    ds_read_b64_tr_b16 v[236:237], v5 offset:41504
    v_mfma_f32_16x16x32_bf16 v[36:39], v[244:247], v[132:135], v[36:39]
    ds_read_b64_tr_b16 v[238:239], v5 offset:42528
    s_waitcnt lgkmcnt(6)
    v_mfma_f32_16x16x32_bf16 v[40:43], v[224:227], v[128:131], v[40:43]
    ds_read_b64_tr_b16 v[240:241], v4 offset:41728
    v_mfma_f32_16x16x32_bf16 v[44:47], v[224:227], v[132:135], v[44:47]
    ds_read_b64_tr_b16 v[242:243], v4 offset:42752
    s_waitcnt lgkmcnt(6)
    v_mfma_f32_16x16x32_bf16 v[48:51], v[228:231], v[128:131], v[48:51]
    ds_read_b64_tr_b16 v[244:245], v5 offset:41760
    v_mfma_f32_16x16x32_bf16 v[52:55], v[228:231], v[132:135], v[52:55]
    ds_read_b64_tr_b16 v[246:247], v5 offset:42784
    s_waitcnt lgkmcnt(6)
    v_mfma_f32_16x16x32_bf16 v[56:59], v[232:235], v[128:131], v[56:59]
    v_mfma_f32_16x16x32_bf16 v[60:63], v[232:235], v[132:135], v[60:63]
    s_waitcnt vmcnt(10)
    s_barrier
    ds_read_b64_tr_b16 v[224:225], v4 offset:49152
    ds_read_b64_tr_b16 v[226:227], v4 offset:50176
    s_waitcnt lgkmcnt(6)
    v_mfma_f32_16x16x32_bf16 v[64:67], v[236:239], v[128:131], v[64:67]
    ds_read_b64_tr_b16 v[228:229], v5 offset:49184
    v_mfma_f32_16x16x32_bf16 v[68:71], v[236:239], v[132:135], v[68:71]
    ds_read_b64_tr_b16 v[230:231], v5 offset:50208
    s_waitcnt lgkmcnt(6)
    v_mfma_f32_16x16x32_bf16 v[72:75], v[240:243], v[128:131], v[72:75]
    ds_read_b64_tr_b16 v[232:233], v4 offset:49408
    v_mfma_f32_16x16x32_bf16 v[76:79], v[240:243], v[132:135], v[76:79]
    ds_read_b64_tr_b16 v[234:235], v4 offset:50432
    s_waitcnt lgkmcnt(6)
    v_mfma_f32_16x16x32_bf16 v[80:83], v[244:247], v[128:131], v[80:83]
    ds_read_b64_tr_b16 v[236:237], v5 offset:49440
    v_mfma_f32_16x16x32_bf16 v[84:87], v[244:247], v[132:135], v[84:87]
    ds_read_b64_tr_b16 v[238:239], v5 offset:50464
    s_waitcnt vmcnt(9) lgkmcnt(6)
    v_mfma_f32_16x16x32_bf16 v[24:27], v[224:227], v[88:91], v[24:27]
    ds_read_b64_tr_b16 v[240:241], v4 offset:49664
    s_waitcnt vmcnt(4)
    v_mfma_f32_16x16x32_bf16 v[28:31], v[224:227], v[92:95], v[28:31]
    ds_read_b64_tr_b16 v[242:243], v4 offset:50688
    s_waitcnt lgkmcnt(6)
    v_mfma_f32_16x16x32_bf16 v[32:35], v[228:231], v[88:91], v[32:35]
    ds_read_b64_tr_b16 v[244:245], v5 offset:49696
    v_mfma_f32_16x16x32_bf16 v[36:39], v[228:231], v[92:95], v[36:39]
    ds_read_b64_tr_b16 v[246:247], v5 offset:50720
    s_waitcnt lgkmcnt(6)
    v_mfma_f32_16x16x32_bf16 v[40:43], v[232:235], v[88:91], v[40:43]
    ds_read_b64_tr_b16 v[224:225], v4 offset:49920
    v_mfma_f32_16x16x32_bf16 v[44:47], v[232:235], v[92:95], v[44:47]
    ds_read_b64_tr_b16 v[226:227], v4 offset:50944
    s_waitcnt lgkmcnt(6)
    v_mfma_f32_16x16x32_bf16 v[48:51], v[236:239], v[88:91], v[48:51]
    ds_read_b64_tr_b16 v[228:229], v5 offset:49952
    v_mfma_f32_16x16x32_bf16 v[52:55], v[236:239], v[92:95], v[52:55]
    ds_read_b64_tr_b16 v[230:231], v5 offset:50976
    s_waitcnt lgkmcnt(6)
    v_mfma_f32_16x16x32_bf16 v[56:59], v[240:243], v[88:91], v[56:59]
    ds_read_b64_tr_b16 v[232:233], v4 offset:57344
    v_mfma_f32_16x16x32_bf16 v[60:63], v[240:243], v[92:95], v[60:63]
    ds_read_b64_tr_b16 v[234:235], v4 offset:58368
    s_waitcnt lgkmcnt(6)
    v_mfma_f32_16x16x32_bf16 v[64:67], v[244:247], v[88:91], v[64:67]
    ds_read_b64_tr_b16 v[236:237], v5 offset:57376
    v_mfma_f32_16x16x32_bf16 v[68:71], v[244:247], v[92:95], v[68:71]
    ds_read_b64_tr_b16 v[238:239], v5 offset:58400
    s_waitcnt lgkmcnt(6)
    v_mfma_f32_16x16x32_bf16 v[72:75], v[224:227], v[88:91], v[72:75]
    ds_read_b64_tr_b16 v[240:241], v4 offset:57600
    v_mfma_f32_16x16x32_bf16 v[76:79], v[224:227], v[92:95], v[76:79]
    ds_read_b64_tr_b16 v[242:243], v4 offset:58624
    s_waitcnt lgkmcnt(6)
    v_mfma_f32_16x16x32_bf16 v[80:83], v[228:231], v[88:91], v[80:83]
    ds_read_b64_tr_b16 v[244:245], v5 offset:57632
    v_mfma_f32_16x16x32_bf16 v[84:87], v[228:231], v[92:95], v[84:87]
    ds_read_b64_tr_b16 v[246:247], v5 offset:58656
    s_waitcnt vmcnt(2) lgkmcnt(6)
    v_mfma_f32_16x16x32_bf16 v[24:27], v[232:235], v[96:99], v[24:27]
    ds_read_b64_tr_b16 v[224:225], v4 offset:57856
    s_waitcnt vmcnt(0)
    v_mfma_f32_16x16x32_bf16 v[28:31], v[232:235], v[100:103], v[28:31]
    ds_read_b64_tr_b16 v[226:227], v4 offset:58880
    s_waitcnt lgkmcnt(6)
    v_mfma_f32_16x16x32_bf16 v[32:35], v[236:239], v[96:99], v[32:35]
    ds_read_b64_tr_b16 v[228:229], v5 offset:57888
    v_mfma_f32_16x16x32_bf16 v[36:39], v[236:239], v[100:103], v[36:39]
    ds_read_b64_tr_b16 v[230:231], v5 offset:58912
    s_waitcnt lgkmcnt(6)
    v_mfma_f32_16x16x32_bf16 v[40:43], v[240:243], v[96:99], v[40:43]
    ds_read_b64_tr_b16 v[232:233], v4 offset:58112
    v_mfma_f32_16x16x32_bf16 v[44:47], v[240:243], v[100:103], v[44:47]
    ds_read_b64_tr_b16 v[234:235], v4 offset:59136
    s_waitcnt lgkmcnt(6)
    v_mfma_f32_16x16x32_bf16 v[48:51], v[244:247], v[96:99], v[48:51]
    ds_read_b64_tr_b16 v[236:237], v5 offset:58144
    v_mfma_f32_16x16x32_bf16 v[52:55], v[244:247], v[100:103], v[52:55]
    ds_read_b64_tr_b16 v[238:239], v5 offset:59168
    s_waitcnt lgkmcnt(6)
    v_mfma_f32_16x16x32_bf16 v[56:59], v[224:227], v[96:99], v[56:59]
    v_mfma_f32_16x16x32_bf16 v[60:63], v[224:227], v[100:103], v[60:63]
    s_waitcnt lgkmcnt(4)
    v_mfma_f32_16x16x32_bf16 v[64:67], v[228:231], v[96:99], v[64:67]
    v_mfma_f32_16x16x32_bf16 v[68:71], v[228:231], v[100:103], v[68:71]
    s_waitcnt lgkmcnt(2)
    v_mfma_f32_16x16x32_bf16 v[72:75], v[232:235], v[96:99], v[72:75]
    v_mfma_f32_16x16x32_bf16 v[76:79], v[232:235], v[100:103], v[76:79]
    s_waitcnt lgkmcnt(0)
    v_mfma_f32_16x16x32_bf16 v[80:83], v[236:239], v[96:99], v[80:83]
    v_mfma_f32_16x16x32_bf16 v[84:87], v[236:239], v[100:103], v[84:87]
    s_barrier
    s_add_u32 s22, s21, 0x8000
    s_add_u32 m0, s20, 0x20000
    s_nop 0
    buffer_load_dwordx4 v2, s[8:11], s22 offen sc1 lds
    s_add_u32 s22, s21, 0x8400
    s_add_u32 m0, s20, 0x20400
    s_nop 0
    buffer_load_dwordx4 v2, s[8:11], s22 offen sc1 lds
    s_add_u32 s22, s21, 0xc000
    s_add_u32 m0, s20, 0x24000
    s_nop 0
    buffer_load_dwordx4 v2, s[8:11], s22 offen sc1 lds
    s_add_u32 s22, s21, 0xc400
    s_add_u32 m0, s20, 0x24400
    s_nop 0
    buffer_load_dwordx4 v2, s[8:11], s22 offen sc1 lds
    ds_read_b64_tr_b16 v[88:89], v11 offset:0
    ds_read_b64_tr_b16 v[90:91], v11 offset:1024
    ds_read_b64_tr_b16 v[92:93], v11 offset:8192
    ds_read_b64_tr_b16 v[94:95], v11 offset:9216
    ds_read_b64_tr_b16 v[96:97], v11 offset:16384
    ds_read_b64_tr_b16 v[98:99], v11 offset:17408
    ds_read_b64_tr_b16 v[100:101], v11 offset:24576
    ds_read_b64_tr_b16 v[102:103], v11 offset:25600
    s_mov_b32 s23, 0x3e0293ee
    v_mul_f32 v24, s23, v24
    v_mul_f32 v25, s23, v25
    v_mul_f32 v26, s23, v26
    v_mul_f32 v27, s23, v27
    v_mul_f32 v28, s23, v28
    v_mul_f32 v29, s23, v29
    v_mul_f32 v30, s23, v30
    v_mul_f32 v31, s23, v31
    v_mul_f32 v32, s23, v32
    v_mul_f32 v33, s23, v33
    v_mul_f32 v34, s23, v34
    v_mul_f32 v35, s23, v35
    v_mul_f32 v36, s23, v36
    v_mul_f32 v37, s23, v37
    v_mul_f32 v38, s23, v38
    v_mul_f32 v39, s23, v39
    v_cvt_pk_bf16_f32 v152, v24, v25
    v_cvt_pk_bf16_f32 v153, v26, v27
    v_cvt_pk_bf16_f32 v168, v28, v29
    v_cvt_pk_bf16_f32 v169, v30, v31
    v_cvt_pk_bf16_f32 v154, v32, v33
    v_cvt_pk_bf16_f32 v155, v34, v35
    v_cvt_pk_bf16_f32 v170, v36, v37
    v_cvt_pk_bf16_f32 v171, v38, v39
    s_waitcnt lgkmcnt(6)
    v_mfma_f32_16x16x32_bf16 v[104:107], v[88:91], v[136:139], 0
    s_waitcnt lgkmcnt(4)
    v_mfma_f32_16x16x32_bf16 v[104:107], v[92:95], v[140:143], v[104:107]
    s_waitcnt lgkmcnt(2)
    v_mfma_f32_16x16x32_bf16 v[104:107], v[96:99], v[144:147], v[104:107]
    s_waitcnt lgkmcnt(0)
    v_mfma_f32_16x16x32_bf16 v[104:107], v[100:103], v[148:151], v[104:107]
    v_add_u32 v4, 0x10000, v2
    v_add_u32 v5, 0x20000, v2
    s_barrier
    ds_read_b128 v[224:227], v4 offset:32768
    ds_read_b128 v[228:231], v4 offset:33792
    ds_read_b128 v[232:235], v4 offset:34816
    ds_read_b128 v[236:239], v4 offset:35840
    v_mov_b32 v12, 0x3f803f80
    v_mov_b32 v13, 0x3f803f80
    v_mov_b32 v14, 0x3f803f80
    v_mov_b32 v15, 0x3f803f80
    s_waitcnt lgkmcnt(3)
    v_mfma_f32_16x16x32_bf16 v[184:187], v[224:227], v[152:155], 0
    v_mul_f32 v40, s23, v40
    v_mul_f32 v41, s23, v41
    v_mul_f32 v42, s23, v42
    v_mul_f32 v43, s23, v43
    v_mul_f32 v44, s23, v44
    v_mul_f32 v45, s23, v45
    v_lshrrev_b32 v20, 4, v1
    v_lshlrev_b32 v20, 4, v20
    s_lshr_b32 s16, s2, 5
    s_lshl_b32 s16, s16, 14
    s_and_b32 s17, s2, 31
    s_lshl_b32 s17, s17, 9
    s_add_u32 s16, s16, s17
    s_lshl_b32 s17, s3, 6
    s_add_u32 s16, s16, s17
    s_add_u32 s16, s16, 0x580000
    s_mov_b32 exec_lo, 0x10001
    s_mov_b32 exec_hi, 0x10001
    buffer_store_dwordx4 v[104:107], v20, s[8:11], s16 offen sc1
    s_mov_b64 exec, -1
    v_mfma_f32_16x16x32_bf16 v[188:191], v[224:227], v[168:171], 0
    ds_read_b128 v[240:243], v4 offset:36864
    v_mul_f32 v46, s23, v46
    v_mul_f32 v47, s23, v47
    v_mul_f32 v48, s23, v48
    v_mul_f32 v49, s23, v49
    v_mul_f32 v50, s23, v50
    v_mul_f32 v51, s23, v51
    s_mov_b64 s[64:65], s[46:47]
    s_mov_b32 s66, 0x700000
    s_mov_b32 s67, 0x20000
    s_mov_b64 s[68:69], s[48:49]
    s_mov_b32 s70, 0x700000
    s_mov_b32 s71, 0x20000
    s_cmp_lt_u32 s2, 224
    s_cselect_b32 s66, 7340032, 0
    s_cselect_b32 s70, 7340032, 0
    s_and_b32 s29, s2, 7
    s_mul_i32 s29, s29, 28
    s_lshr_b32 s16, s2, 3
    s_add_u32 s29, s29, s16
    s_sub_u32 s16, s3, 4
    v_lshrrev_b32 v20, 3, v1
    v_lshlrev_b32 v20, 3, v20
    s_lshl_b32 s17, s16, 6
    v_add_u32 v20, s17, v20
    s_mov_b32 s17, 7168
    v_mul_lo_u32 v11, s17, v20
    v_and_b32 v20, 7, v1
    v_lshl_add_u32 v11, v20, 4, v11
    s_and_b32 s17, s29, 3
    s_mul_i32 s18, s17, 1835008
    s_lshr_b32 s17, s29, 2
    s_lshl_b32 s17, s17, 7
    s_add_u32 s18, s18, s17
    s_lshl_b32 s15, s16, 13
    s_waitcnt lgkmcnt(3)
    v_mfma_f32_16x16x32_bf16 v[192:195], v[228:231], v[152:155], 0
    s_add_u32 s22, s21, 0x10000
    s_add_u32 m0, s20, 0x10000
    s_nop 0
    buffer_load_dwordx4 v2, s[8:11], s22 offen sc1 lds
    v_mul_f32 v52, s23, v52
    v_mul_f32 v53, s23, v53
    v_mul_f32 v54, s23, v54
    v_mul_f32 v55, s23, v55
    v_cvt_pk_bf16_f32 v156, v40, v41
    v_cvt_pk_bf16_f32 v157, v42, v43
    v_mfma_f32_16x16x32_bf16 v[196:199], v[228:231], v[168:171], 0
    ds_read_b128 v[244:247], v4 offset:37888
    v_cvt_pk_bf16_f32 v172, v44, v45
    v_cvt_pk_bf16_f32 v173, v46, v47
    v_cvt_pk_bf16_f32 v158, v48, v49
    v_cvt_pk_bf16_f32 v159, v50, v51
    v_cvt_pk_bf16_f32 v174, v52, v53
    v_cvt_pk_bf16_f32 v175, v54, v55
    s_waitcnt lgkmcnt(3)
    v_mfma_f32_16x16x32_bf16 v[184:187], v[232:235], v[156:159], v[184:187]
    v_mul_f32 v56, s23, v56
    v_mul_f32 v57, s23, v57
    v_mul_f32 v58, s23, v58
    v_mul_f32 v59, s23, v59
    v_mul_f32 v60, s23, v60
    v_mul_f32 v61, s23, v61
    v_mfma_f32_16x16x32_bf16 v[188:191], v[232:235], v[172:175], v[188:191]
    ds_read_b128 v[224:227], v4 offset:38912
    v_mul_f32 v62, s23, v62
    v_mul_f32 v63, s23, v63
    v_mul_f32 v64, s23, v64
    v_mul_f32 v65, s23, v65
    v_mul_f32 v66, s23, v66
    v_mul_f32 v67, s23, v67
    s_waitcnt lgkmcnt(3)
    v_mfma_f32_16x16x32_bf16 v[192:195], v[236:239], v[156:159], v[192:195]
    v_mul_f32 v68, s23, v68
    v_mul_f32 v69, s23, v69
    v_mul_f32 v70, s23, v70
    v_mul_f32 v71, s23, v71
    v_cvt_pk_bf16_f32 v160, v56, v57
    v_cvt_pk_bf16_f32 v161, v58, v59
    v_mfma_f32_16x16x32_bf16 v[196:199], v[236:239], v[172:175], v[196:199]
    ds_read_b128 v[228:231], v4 offset:39936
    v_cvt_pk_bf16_f32 v176, v60, v61
    v_cvt_pk_bf16_f32 v177, v62, v63
    v_cvt_pk_bf16_f32 v162, v64, v65
    v_cvt_pk_bf16_f32 v163, v66, v67
    v_cvt_pk_bf16_f32 v178, v68, v69
    v_cvt_pk_bf16_f32 v179, v70, v71
    s_waitcnt lgkmcnt(3)
    v_mfma_f32_16x16x32_bf16 v[184:187], v[240:243], v[160:163], v[184:187]
    v_mul_f32 v72, s23, v72
    v_mul_f32 v73, s23, v73
    v_mul_f32 v74, s23, v74
    v_mul_f32 v75, s23, v75
    v_mul_f32 v76, s23, v76
    v_mul_f32 v77, s23, v77
    v_mfma_f32_16x16x32_bf16 v[188:191], v[240:243], v[176:179], v[188:191]
    ds_read_b128 v[232:235], v4 offset:40960
    v_mul_f32 v78, s23, v78
    v_mul_f32 v79, s23, v79
    v_mul_f32 v80, s23, v80
    v_mul_f32 v81, s23, v81
    v_mul_f32 v82, s23, v82
    v_mul_f32 v83, s23, v83
    s_waitcnt lgkmcnt(3)
    v_mfma_f32_16x16x32_bf16 v[192:195], v[244:247], v[160:163], v[192:195]
    s_add_u32 s22, s21, 0x10400
    s_add_u32 m0, s20, 0x10400
    s_nop 0
    buffer_load_dwordx4 v2, s[8:11], s22 offen sc1 lds
    v_mul_f32 v84, s23, v84
    v_mul_f32 v85, s23, v85
    v_mul_f32 v86, s23, v86
    v_mul_f32 v87, s23, v87
    v_cvt_pk_bf16_f32 v164, v72, v73
    v_cvt_pk_bf16_f32 v165, v74, v75
    v_mfma_f32_16x16x32_bf16 v[196:199], v[244:247], v[176:179], v[196:199]
    ds_read_b128 v[236:239], v4 offset:41984
    v_cvt_pk_bf16_f32 v180, v76, v77
    v_cvt_pk_bf16_f32 v181, v78, v79
    v_cvt_pk_bf16_f32 v166, v80, v81
    v_cvt_pk_bf16_f32 v167, v82, v83
    v_cvt_pk_bf16_f32 v182, v84, v85
    v_cvt_pk_bf16_f32 v183, v86, v87
    s_waitcnt lgkmcnt(3)
    v_mfma_f32_16x16x32_bf16 v[184:187], v[224:227], v[164:167], v[184:187]
    v_mfma_f32_16x16x32_bf16 v[188:191], v[224:227], v[180:183], v[188:191]
    ds_read_b128 v[240:243], v4 offset:43008
    s_waitcnt lgkmcnt(3)
    v_mfma_f32_16x16x32_bf16 v[192:195], v[228:231], v[164:167], v[192:195]
    v_mfma_f32_16x16x32_bf16 v[196:199], v[228:231], v[180:183], v[196:199]
    ds_read_b128 v[244:247], v4 offset:44032
    s_waitcnt lgkmcnt(3)
    v_mfma_f32_16x16x32_bf16 v[200:203], v[232:235], v[152:155], 0
    v_mfma_f32_16x16x32_bf16 v[204:207], v[232:235], v[168:171], 0
    ds_read_b128 v[224:227], v4 offset:45056
    s_waitcnt lgkmcnt(3)
    v_mfma_f32_16x16x32_bf16 v[208:211], v[236:239], v[152:155], 0
    v_mfma_f32_16x16x32_bf16 v[212:215], v[236:239], v[168:171], 0
    ds_read_b128 v[228:231], v4 offset:46080
    s_waitcnt lgkmcnt(3)
    v_mfma_f32_16x16x32_bf16 v[200:203], v[240:243], v[156:159], v[200:203]
    v_mfma_f32_16x16x32_bf16 v[204:207], v[240:243], v[172:175], v[204:207]
    ds_read_b128 v[232:235], v4 offset:47104
    s_waitcnt lgkmcnt(3)
    v_mfma_f32_16x16x32_bf16 v[208:211], v[244:247], v[156:159], v[208:211]
    v_max3_f32 v16, v184, v185, v186
    v_mfma_f32_16x16x32_bf16 v[212:215], v[244:247], v[172:175], v[212:215]
    ds_read_b128 v[236:239], v4 offset:48128
    v_max3_f32 v16, v16, v187, v192
    s_waitcnt lgkmcnt(3)
    v_mfma_f32_16x16x32_bf16 v[200:203], v[224:227], v[160:163], v[200:203]
    v_max3_f32 v16, v16, v193, v194
    v_mfma_f32_16x16x32_bf16 v[204:207], v[224:227], v[176:179], v[204:207]
    s_barrier
    ds_read_b128 v[240:243], v4 offset:49152
    v_max_f32 v16, v16, v195
    s_waitcnt lgkmcnt(3)
    v_mfma_f32_16x16x32_bf16 v[208:211], v[228:231], v[160:163], v[208:211]
    v_max3_f32 v17, v188, v189, v190
    v_mfma_f32_16x16x32_bf16 v[212:215], v[228:231], v[176:179], v[212:215]
    s_add_u32 s22, s21, 0x14000
    s_add_u32 m0, s20, 0x14000
    s_nop 0
    buffer_load_dwordx4 v2, s[8:11], s22 offen sc1 lds
    ds_read_b128 v[244:247], v4 offset:50176
    v_max3_f32 v17, v17, v191, v196
    s_waitcnt lgkmcnt(3)
    v_mfma_f32_16x16x32_bf16 v[200:203], v[232:235], v[164:167], v[200:203]
    v_max3_f32 v17, v17, v197, v198
    v_mfma_f32_16x16x32_bf16 v[204:207], v[232:235], v[180:183], v[204:207]
    ds_read_b128 v[224:227], v4 offset:51200
    v_max_f32 v17, v17, v199
    s_waitcnt lgkmcnt(3)
    v_mfma_f32_16x16x32_bf16 v[208:211], v[236:239], v[164:167], v[208:211]
    s_mov_b64 s[72:73], s[40:41]
    s_mov_b32 s74, 0x800000
    s_mov_b32 s75, 0x20000
    v_lshlrev_b32 v21, 7, v1
    s_lshl_b32 s16, s2, 2
    s_add_u32 s16, s16, s3
    s_sub_u32 s16, s16, 4
    s_lshl_b32 s16, s16, 13
    buffer_load_dword v7, v21, s[72:75], s16 offen
    v_mfma_f32_16x16x32_bf16 v[212:215], v[236:239], v[180:183], v[212:215]
    ds_read_b128 v[228:231], v4 offset:52224
    v_max3_f32 v16, v16, v200, v201
    v_max3_f32 v16, v16, v202, v203
    v_max3_f32 v16, v16, v208, v209
    v_max3_f32 v16, v16, v210, v211
    v_max3_f32 v17, v17, v204, v205
    v_max3_f32 v17, v17, v206, v207
    s_nop 0
    v_max3_f32 v17, v17, v212, v213
    v_max3_f32 v17, v17, v214, v215
    v_mov_b32 v18, v16
    v_mov_b32 v19, v17
    s_nop 0
    v_permlane16_swap_b32 v16, v18
    v_permlane16_swap_b32 v17, v19
    v_max_f32 v16, v16, v18
    v_max_f32 v17, v17, v19
    v_mov_b32 v18, v16
    v_mov_b32 v19, v17
    s_nop 0
    v_permlane32_swap_b32 v16, v18
    v_permlane32_swap_b32 v17, v19
    v_max_f32 v16, v16, v18
    v_max_f32 v17, v17, v19
    v_sub_f32 v216, 0, v16
    v_sub_f32 v217, 0, v16
    v_sub_f32 v218, 0, v16
    v_sub_f32 v219, 0, v16
    v_sub_f32 v220, 0, v17
    v_sub_f32 v221, 0, v17
    v_sub_f32 v222, 0, v17
    v_sub_f32 v223, 0, v17
    v_add_f32 v184, v184, v216
    v_add_f32 v185, v185, v216
    v_exp_f32 v184, v184
    v_exp_f32 v185, v185
    s_nop 0
    v_cvt_pk_bf16_f32 v24, v184, v185
    v_add_f32 v186, v186, v216
    v_add_f32 v187, v187, v216
    v_exp_f32 v186, v186
    v_exp_f32 v187, v187
    s_nop 0
    v_cvt_pk_bf16_f32 v25, v186, v187
    v_add_f32 v188, v188, v220
    v_add_f32 v189, v189, v220
    v_exp_f32 v188, v188
    v_exp_f32 v189, v189
    s_nop 0
    v_cvt_pk_bf16_f32 v28, v188, v189
    v_add_f32 v190, v190, v220
    v_add_f32 v191, v191, v220
    v_exp_f32 v190, v190
    v_exp_f32 v191, v191
    s_nop 0
    v_cvt_pk_bf16_f32 v29, v190, v191
    v_add_f32 v192, v192, v216
    v_add_f32 v193, v193, v216
    v_exp_f32 v192, v192
    v_exp_f32 v193, v193
    s_nop 0
    v_cvt_pk_bf16_f32 v26, v192, v193
    v_add_f32 v194, v194, v216
    v_add_f32 v195, v195, v216
    v_exp_f32 v194, v194
    v_exp_f32 v195, v195
    s_nop 0
    v_cvt_pk_bf16_f32 v27, v194, v195
    v_add_f32 v196, v196, v220
    v_add_f32 v197, v197, v220
    v_exp_f32 v196, v196
    v_exp_f32 v197, v197
    s_nop 0
    v_cvt_pk_bf16_f32 v30, v196, v197
    v_add_f32 v198, v198, v220
    v_add_f32 v199, v199, v220
    v_exp_f32 v198, v198
    v_exp_f32 v199, v199
    s_nop 0
    v_cvt_pk_bf16_f32 v31, v198, v199
    s_waitcnt lgkmcnt(3)
    v_mfma_f32_16x16x32_bf16 v[184:187], v[240:243], v[152:155], v[216:219]
    v_mfma_f32_16x16x32_bf16 v[188:191], v[240:243], v[168:171], v[220:223]
    ds_read_b128 v[232:235], v4 offset:53248
    v_add_f32 v200, v200, v216
    v_add_f32 v201, v201, v216
    v_exp_f32 v200, v200
    v_mfma_f32_16x16x32_bf16 v[248:251], v[12:15], v[24:27], 0
    s_waitcnt lgkmcnt(3)
    v_mfma_f32_16x16x32_bf16 v[192:195], v[244:247], v[152:155], v[216:219]
    v_exp_f32 v201, v201
    s_nop 0
    v_cvt_pk_bf16_f32 v32, v200, v201
    v_add_f32 v202, v202, v216
    v_mfma_f32_16x16x32_bf16 v[196:199], v[244:247], v[168:171], v[220:223]
    s_add_u32 s22, s21, 0x14400
    s_add_u32 m0, s20, 0x14400
    s_nop 0
    buffer_load_dwordx4 v2, s[8:11], s22 offen sc1 lds
    ds_read_b128 v[236:239], v4 offset:54272
    v_add_f32 v203, v203, v216
    v_exp_f32 v202, v202
    v_mfma_f32_16x16x32_bf16 v[252:255], v[12:15], v[28:31], 0
    s_waitcnt lgkmcnt(3)
    v_mfma_f32_16x16x32_bf16 v[184:187], v[224:227], v[156:159], v[184:187]
    v_exp_f32 v203, v203
    s_nop 0
    v_cvt_pk_bf16_f32 v33, v202, v203
    v_add_f32 v204, v204, v220
    v_mfma_f32_16x16x32_bf16 v[188:191], v[224:227], v[172:175], v[188:191]
    ds_read_b128 v[240:243], v4 offset:55296
    v_add_f32 v205, v205, v220
    v_exp_f32 v204, v204
    v_exp_f32 v205, v205
    s_mov_b64 s[4:5], s[40:41]
    s_mov_b32 s6, 0x800000
    s_mov_b32 s7, 0x20000
    v_bfe_u32 v20, v1, 2, 2
    v_lshlrev_b32 v21, 13, v20
    v_sub_u32 v3, v3, v21
    v_lshl_add_u32 v3, v20, 11, v3
    s_and_b32 s16, s2, 1
    s_lshl_b32 s24, s16, 22
    s_lshr_b32 s16, s2, 5
    s_lshl_b32 s16, s16, 8
    s_add_u32 s24, s24, s16
    s_lshl_b32 s16, s3, 14
    s_add_u32 s24, s24, s16
    s_add_u32 s24, s24, 196608
    s_waitcnt lgkmcnt(3)
    v_mfma_f32_16x16x32_bf16 v[192:195], v[228:231], v[156:159], v[192:195]
    v_cvt_pk_bf16_f32 v36, v204, v205
    v_add_f32 v206, v206, v220
    v_mfma_f32_16x16x32_bf16 v[196:199], v[228:231], v[172:175], v[196:199]
    ds_read_b128 v[244:247], v4 offset:56320
    v_add_f32 v207, v207, v220
    v_exp_f32 v206, v206
    v_exp_f32 v207, v207
    s_waitcnt lgkmcnt(3)
    v_mfma_f32_16x16x32_bf16 v[184:187], v[232:235], v[160:163], v[184:187]
    v_cvt_pk_bf16_f32 v37, v206, v207
    v_add_f32 v208, v208, v216
    v_add_f32 v209, v209, v216
    v_mfma_f32_16x16x32_bf16 v[188:191], v[232:235], v[176:179], v[188:191]
    ds_read_b128 v[224:227], v4 offset:57344
    v_exp_f32 v208, v208
    v_exp_f32 v209, v209
    s_waitcnt lgkmcnt(3)
    v_mfma_f32_16x16x32_bf16 v[192:195], v[236:239], v[160:163], v[192:195]
    v_cvt_pk_bf16_f32 v34, v208, v209
    v_add_f32 v210, v210, v216
    v_add_f32 v211, v211, v216
    v_mfma_f32_16x16x32_bf16 v[196:199], v[236:239], v[176:179], v[196:199]
    ds_read_b128 v[228:231], v4 offset:58368
    v_exp_f32 v210, v210
    v_exp_f32 v211, v211
    s_nop 0
    v_cvt_pk_bf16_f32 v35, v210, v211
    s_waitcnt lgkmcnt(3)
    v_mfma_f32_16x16x32_bf16 v[184:187], v[240:243], v[164:167], v[184:187]
    v_add_f32 v212, v212, v220
    v_add_f32 v213, v213, v220
    v_mfma_f32_16x16x32_bf16 v[188:191], v[240:243], v[180:183], v[188:191]
    ds_read_b128 v[232:235], v4 offset:59392
    v_exp_f32 v212, v212
    v_exp_f32 v213, v213
    s_nop 0
    v_cvt_pk_bf16_f32 v38, v212, v213
    s_waitcnt lgkmcnt(3)
    v_mfma_f32_16x16x32_bf16 v[192:195], v[244:247], v[164:167], v[192:195]
    v_add_f32 v214, v214, v220
    v_add_f32 v215, v215, v220
    v_exp_f32 v214, v214
    v_mfma_f32_16x16x32_bf16 v[196:199], v[244:247], v[180:183], v[196:199]
    ds_read_b128 v[236:239], v4 offset:60416
    v_exp_f32 v215, v215
    s_nop 0
    v_cvt_pk_bf16_f32 v39, v214, v215
    s_waitcnt lgkmcnt(3)
    v_mfma_f32_16x16x32_bf16 v[200:203], v[224:227], v[152:155], v[216:219]
    v_mfma_f32_16x16x32_bf16 v[204:207], v[224:227], v[168:171], v[220:223]
    ds_read_b128 v[240:243], v4 offset:61440
    v_exp_f32 v184, v184
    v_exp_f32 v185, v185
    v_mfma_f32_16x16x32_bf16 v[248:251], v[12:15], v[32:35], v[248:251]
    s_waitcnt lgkmcnt(3)
    v_mfma_f32_16x16x32_bf16 v[208:211], v[228:231], v[152:155], v[216:219]
    v_cvt_pk_bf16_f32 v40, v184, v185
    v_exp_f32 v186, v186
    v_mfma_f32_16x16x32_bf16 v[212:215], v[228:231], v[168:171], v[220:223]
    ds_read_b128 v[244:247], v4 offset:62464
    v_exp_f32 v187, v187
    v_mfma_f32_16x16x32_bf16 v[252:255], v[12:15], v[36:39], v[252:255]
    s_waitcnt lgkmcnt(3)
    v_mfma_f32_16x16x32_bf16 v[200:203], v[232:235], v[156:159], v[200:203]
    v_cvt_pk_bf16_f32 v41, v186, v187
    v_exp_f32 v188, v188
    v_mfma_f32_16x16x32_bf16 v[204:207], v[232:235], v[172:175], v[204:207]
    ds_read_b128 v[224:227], v4 offset:63488
    v_exp_f32 v189, v189
    s_waitcnt lgkmcnt(3)
    v_mfma_f32_16x16x32_bf16 v[208:211], v[236:239], v[156:159], v[208:211]
    v_cvt_pk_bf16_f32 v44, v188, v189
    v_exp_f32 v190, v190
    v_mfma_f32_16x16x32_bf16 v[212:215], v[236:239], v[172:175], v[212:215]
    ds_read_b128 v[228:231], v4 offset:64512
    v_exp_f32 v191, v191
    s_nop 0
    v_cvt_pk_bf16_f32 v45, v190, v191
    s_waitcnt lgkmcnt(3)
    v_mfma_f32_16x16x32_bf16 v[200:203], v[240:243], v[160:163], v[200:203]
    v_exp_f32 v192, v192
    v_mfma_f32_16x16x32_bf16 v[204:207], v[240:243], v[176:179], v[204:207]
    s_waitcnt vmcnt(8)
    s_barrier
    ds_read_b128 v[232:235], v5 offset:0
    v_exp_f32 v193, v193
    s_nop 0
    v_cvt_pk_bf16_f32 v42, v192, v193
    s_waitcnt lgkmcnt(3)
    v_mfma_f32_16x16x32_bf16 v[208:211], v[244:247], v[160:163], v[208:211]
    v_exp_f32 v194, v194
    v_mfma_f32_16x16x32_bf16 v[212:215], v[244:247], v[176:179], v[212:215]
    s_add_u32 s22, s21, 0x18000
    s_add_u32 m0, s20, 0x18000
    s_nop 0
    buffer_load_dwordx4 v2, s[8:11], s22 offen sc1 lds
    ds_read_b128 v[236:239], v5 offset:1024
    v_exp_f32 v195, v195
    s_nop 0
    v_cvt_pk_bf16_f32 v43, v194, v195
    s_waitcnt lgkmcnt(3)
    v_mfma_f32_16x16x32_bf16 v[200:203], v[224:227], v[164:167], v[200:203]
    v_exp_f32 v196, v196
    v_exp_f32 v197, v197
    v_mfma_f32_16x16x32_bf16 v[204:207], v[224:227], v[180:183], v[204:207]
    ds_read_b128 v[240:243], v5 offset:2048
    v_cvt_pk_bf16_f32 v46, v196, v197
    s_waitcnt lgkmcnt(3)
    v_mfma_f32_16x16x32_bf16 v[208:211], v[228:231], v[164:167], v[208:211]
    v_exp_f32 v198, v198
    v_exp_f32 v199, v199
    v_mfma_f32_16x16x32_bf16 v[212:215], v[228:231], v[180:183], v[212:215]
    ds_read_b128 v[244:247], v5 offset:3072
    v_cvt_pk_bf16_f32 v47, v198, v199
    s_waitcnt lgkmcnt(3)
    v_mfma_f32_16x16x32_bf16 v[184:187], v[232:235], v[152:155], v[216:219]
    v_mfma_f32_16x16x32_bf16 v[188:191], v[232:235], v[168:171], v[220:223]
    ds_read_b128 v[224:227], v5 offset:4096
    v_exp_f32 v200, v200
    v_exp_f32 v201, v201
    v_mfma_f32_16x16x32_bf16 v[248:251], v[12:15], v[40:43], v[248:251]
    s_waitcnt lgkmcnt(3)
    v_mfma_f32_16x16x32_bf16 v[192:195], v[236:239], v[152:155], v[216:219]
    v_cvt_pk_bf16_f32 v48, v200, v201
    v_exp_f32 v202, v202
    v_mfma_f32_16x16x32_bf16 v[196:199], v[236:239], v[168:171], v[220:223]
    s_add_u32 s22, s21, 0x18400
    s_add_u32 m0, s20, 0x18400
    s_nop 0
    buffer_load_dwordx4 v2, s[8:11], s22 offen sc1 lds
    ds_read_b128 v[228:231], v5 offset:5120
    v_exp_f32 v203, v203
    v_mfma_f32_16x16x32_bf16 v[252:255], v[12:15], v[44:47], v[252:255]
    s_waitcnt lgkmcnt(3)
    v_mfma_f32_16x16x32_bf16 v[184:187], v[240:243], v[156:159], v[184:187]
    v_cvt_pk_bf16_f32 v49, v202, v203
    v_exp_f32 v204, v204
    v_mfma_f32_16x16x32_bf16 v[188:191], v[240:243], v[172:175], v[188:191]
    ds_read_b128 v[232:235], v5 offset:6144
    v_exp_f32 v205, v205
    s_waitcnt lgkmcnt(3)
    v_mfma_f32_16x16x32_bf16 v[192:195], v[244:247], v[156:159], v[192:195]
    v_cvt_pk_bf16_f32 v52, v204, v205
    v_exp_f32 v206, v206
    v_mfma_f32_16x16x32_bf16 v[196:199], v[244:247], v[172:175], v[196:199]
    ds_read_b128 v[236:239], v5 offset:7168
    v_exp_f32 v207, v207
    s_nop 0
    v_cvt_pk_bf16_f32 v53, v206, v207
    s_waitcnt lgkmcnt(3)
    v_mfma_f32_16x16x32_bf16 v[184:187], v[224:227], v[160:163], v[184:187]
    v_exp_f32 v208, v208
    v_mfma_f32_16x16x32_bf16 v[188:191], v[224:227], v[176:179], v[188:191]
    ds_read_b128 v[240:243], v5 offset:8192
    v_exp_f32 v209, v209
    s_nop 0
    v_cvt_pk_bf16_f32 v50, v208, v209
    s_waitcnt lgkmcnt(3)
    v_mfma_f32_16x16x32_bf16 v[192:195], v[228:231], v[160:163], v[192:195]
    v_exp_f32 v210, v210
    v_mfma_f32_16x16x32_bf16 v[196:199], v[228:231], v[176:179], v[196:199]
    ds_read_b128 v[244:247], v5 offset:9216
    v_exp_f32 v211, v211
    s_nop 0
    v_cvt_pk_bf16_f32 v51, v210, v211
    s_waitcnt lgkmcnt(3)
    v_mfma_f32_16x16x32_bf16 v[184:187], v[232:235], v[164:167], v[184:187]
    v_exp_f32 v212, v212
    v_exp_f32 v213, v213
    v_mfma_f32_16x16x32_bf16 v[188:191], v[232:235], v[180:183], v[188:191]
    ds_read_b128 v[224:227], v5 offset:10240
    v_cvt_pk_bf16_f32 v54, v212, v213
    s_waitcnt lgkmcnt(3)
    v_mfma_f32_16x16x32_bf16 v[192:195], v[236:239], v[164:167], v[192:195]
    v_exp_f32 v214, v214
    v_exp_f32 v215, v215
    v_mfma_f32_16x16x32_bf16 v[196:199], v[236:239], v[180:183], v[196:199]
    ds_read_b128 v[228:231], v5 offset:11264
    v_cvt_pk_bf16_f32 v55, v214, v215
    s_waitcnt lgkmcnt(3)
    v_mfma_f32_16x16x32_bf16 v[200:203], v[240:243], v[152:155], v[216:219]
    v_mfma_f32_16x16x32_bf16 v[204:207], v[240:243], v[168:171], v[220:223]
    ds_read_b128 v[232:235], v5 offset:12288
    v_exp_f32 v184, v184
    v_exp_f32 v185, v185
    v_mfma_f32_16x16x32_bf16 v[248:251], v[12:15], v[48:51], v[248:251]
    s_waitcnt lgkmcnt(3)
    v_mfma_f32_16x16x32_bf16 v[208:211], v[244:247], v[152:155], v[216:219]
    v_cvt_pk_bf16_f32 v56, v184, v185
    v_exp_f32 v186, v186
    v_mfma_f32_16x16x32_bf16 v[212:215], v[244:247], v[168:171], v[220:223]
    ds_read_b128 v[236:239], v5 offset:13312
    v_exp_f32 v187, v187
    v_mfma_f32_16x16x32_bf16 v[252:255], v[12:15], v[52:55], v[252:255]
    s_waitcnt lgkmcnt(3)
    v_mfma_f32_16x16x32_bf16 v[200:203], v[224:227], v[156:159], v[200:203]
    v_cvt_pk_bf16_f32 v57, v186, v187
    v_exp_f32 v188, v188
    v_mfma_f32_16x16x32_bf16 v[204:207], v[224:227], v[172:175], v[204:207]
    ds_read_b128 v[240:243], v5 offset:14336
    v_exp_f32 v189, v189
    s_waitcnt lgkmcnt(3)
    v_mfma_f32_16x16x32_bf16 v[208:211], v[228:231], v[156:159], v[208:211]
    v_cvt_pk_bf16_f32 v60, v188, v189
    v_exp_f32 v190, v190
    s_waitcnt vmcnt(7)
    v_mfma_f32_16x16x32_bf16 v[212:215], v[228:231], v[172:175], v[212:215]
    ds_read_b128 v[244:247], v5 offset:15360
    v_exp_f32 v191, v191
    s_nop 0
    v_cvt_pk_bf16_f32 v61, v190, v191
    s_waitcnt lgkmcnt(3)
    v_mfma_f32_16x16x32_bf16 v[200:203], v[232:235], v[160:163], v[200:203]
    v_exp_f32 v192, v192
    v_mfma_f32_16x16x32_bf16 v[204:207], v[232:235], v[176:179], v[204:207]
    s_barrier
    ds_read_b128 v[224:227], v5 offset:16384
    v_exp_f32 v193, v193
    s_nop 0
    v_cvt_pk_bf16_f32 v58, v192, v193
    s_waitcnt lgkmcnt(3)
    v_mfma_f32_16x16x32_bf16 v[208:211], v[236:239], v[160:163], v[208:211]
    v_exp_f32 v194, v194
    v_mfma_f32_16x16x32_bf16 v[212:215], v[236:239], v[176:179], v[212:215]
    s_add_u32 s22, s21, 0x1c000
    s_add_u32 m0, s20, 0x1c000
    s_nop 0
    buffer_load_dwordx4 v2, s[8:11], s22 offen sc1 lds
    ds_read_b128 v[228:231], v5 offset:17408
    v_exp_f32 v195, v195
    s_nop 0
    v_cvt_pk_bf16_f32 v59, v194, v195
    s_waitcnt lgkmcnt(3)
    v_mfma_f32_16x16x32_bf16 v[200:203], v[240:243], v[164:167], v[200:203]
    v_exp_f32 v196, v196
    v_exp_f32 v197, v197
    v_mfma_f32_16x16x32_bf16 v[204:207], v[240:243], v[180:183], v[204:207]
    ds_read_b128 v[232:235], v5 offset:18432
    v_cvt_pk_bf16_f32 v62, v196, v197
    s_waitcnt lgkmcnt(3)
    v_mfma_f32_16x16x32_bf16 v[208:211], v[244:247], v[164:167], v[208:211]
    v_exp_f32 v198, v198
    v_exp_f32 v199, v199
    v_mfma_f32_16x16x32_bf16 v[212:215], v[244:247], v[180:183], v[212:215]
    ds_read_b128 v[236:239], v5 offset:19456
    v_cvt_pk_bf16_f32 v63, v198, v199
    s_waitcnt lgkmcnt(3)
    v_mfma_f32_16x16x32_bf16 v[184:187], v[224:227], v[152:155], v[216:219]
    v_mfma_f32_16x16x32_bf16 v[188:191], v[224:227], v[168:171], v[220:223]
    ds_read_b128 v[240:243], v5 offset:20480
    v_exp_f32 v200, v200
    v_exp_f32 v201, v201
    v_mfma_f32_16x16x32_bf16 v[248:251], v[12:15], v[56:59], v[248:251]
    s_waitcnt lgkmcnt(3)
    v_mfma_f32_16x16x32_bf16 v[192:195], v[228:231], v[152:155], v[216:219]
    v_cvt_pk_bf16_f32 v64, v200, v201
    v_exp_f32 v202, v202
    v_mfma_f32_16x16x32_bf16 v[196:199], v[228:231], v[168:171], v[220:223]
    s_add_u32 s22, s21, 0x1c400
    s_add_u32 m0, s20, 0x1c400
    s_nop 0
    buffer_load_dwordx4 v2, s[8:11], s22 offen sc1 lds
    ds_read_b128 v[244:247], v5 offset:21504
    v_exp_f32 v203, v203
    v_mfma_f32_16x16x32_bf16 v[252:255], v[12:15], v[60:63], v[252:255]
    s_waitcnt lgkmcnt(3)
    v_mfma_f32_16x16x32_bf16 v[184:187], v[232:235], v[156:159], v[184:187]
    v_cvt_pk_bf16_f32 v65, v202, v203
    v_exp_f32 v204, v204
    v_mfma_f32_16x16x32_bf16 v[188:191], v[232:235], v[172:175], v[188:191]
    ds_read_b128 v[224:227], v5 offset:22528
    v_exp_f32 v205, v205
    s_waitcnt lgkmcnt(3)
    v_mfma_f32_16x16x32_bf16 v[192:195], v[236:239], v[156:159], v[192:195]
    v_cvt_pk_bf16_f32 v68, v204, v205
    v_exp_f32 v206, v206
    v_mfma_f32_16x16x32_bf16 v[196:199], v[236:239], v[172:175], v[196:199]
    ds_read_b128 v[228:231], v5 offset:23552
    v_exp_f32 v207, v207
    s_nop 0
    v_cvt_pk_bf16_f32 v69, v206, v207
    s_waitcnt lgkmcnt(3)
    v_mfma_f32_16x16x32_bf16 v[184:187], v[240:243], v[160:163], v[184:187]
    v_exp_f32 v208, v208
    v_mfma_f32_16x16x32_bf16 v[188:191], v[240:243], v[176:179], v[188:191]
    ds_read_b128 v[232:235], v5 offset:24576
    v_exp_f32 v209, v209
    s_nop 0
    v_cvt_pk_bf16_f32 v66, v208, v209
    s_waitcnt lgkmcnt(3)
    v_mfma_f32_16x16x32_bf16 v[192:195], v[244:247], v[160:163], v[192:195]
    v_exp_f32 v210, v210
    v_mfma_f32_16x16x32_bf16 v[196:199], v[244:247], v[176:179], v[196:199]
    ds_read_b128 v[236:239], v5 offset:25600
    v_exp_f32 v211, v211
    s_nop 0
    v_cvt_pk_bf16_f32 v67, v210, v211
    s_waitcnt lgkmcnt(3)
    v_mfma_f32_16x16x32_bf16 v[184:187], v[224:227], v[164:167], v[184:187]
    v_exp_f32 v212, v212
    v_exp_f32 v213, v213
    v_mfma_f32_16x16x32_bf16 v[188:191], v[224:227], v[180:183], v[188:191]
    ds_read_b128 v[240:243], v5 offset:26624
    v_cvt_pk_bf16_f32 v70, v212, v213
    s_waitcnt lgkmcnt(3)
    v_mfma_f32_16x16x32_bf16 v[192:195], v[228:231], v[164:167], v[192:195]
    v_exp_f32 v214, v214
    v_exp_f32 v215, v215
    v_mfma_f32_16x16x32_bf16 v[196:199], v[228:231], v[180:183], v[196:199]
    ds_read_b128 v[244:247], v5 offset:27648
    v_cvt_pk_bf16_f32 v71, v214, v215
    s_waitcnt lgkmcnt(3)
    v_mfma_f32_16x16x32_bf16 v[200:203], v[232:235], v[152:155], v[216:219]
    v_mfma_f32_16x16x32_bf16 v[204:207], v[232:235], v[168:171], v[220:223]
    ds_read_b128 v[224:227], v5 offset:28672
    v_exp_f32 v184, v184
    v_exp_f32 v185, v185
    v_mfma_f32_16x16x32_bf16 v[248:251], v[12:15], v[64:67], v[248:251]
    s_waitcnt lgkmcnt(3)
    v_mfma_f32_16x16x32_bf16 v[208:211], v[236:239], v[152:155], v[216:219]
    v_cvt_pk_bf16_f32 v72, v184, v185
    v_exp_f32 v186, v186
    v_mfma_f32_16x16x32_bf16 v[212:215], v[236:239], v[168:171], v[220:223]
    ds_read_b128 v[228:231], v5 offset:29696
    v_exp_f32 v187, v187
    v_mfma_f32_16x16x32_bf16 v[252:255], v[12:15], v[68:71], v[252:255]
    s_waitcnt lgkmcnt(3)
    v_mfma_f32_16x16x32_bf16 v[200:203], v[240:243], v[156:159], v[200:203]
    v_cvt_pk_bf16_f32 v73, v186, v187
    v_exp_f32 v188, v188
    v_mfma_f32_16x16x32_bf16 v[204:207], v[240:243], v[172:175], v[204:207]
    ds_read_b128 v[232:235], v5 offset:30720
    v_exp_f32 v189, v189
    s_waitcnt lgkmcnt(3)
    v_mfma_f32_16x16x32_bf16 v[208:211], v[244:247], v[156:159], v[208:211]
    v_cvt_pk_bf16_f32 v76, v188, v189
    v_exp_f32 v190, v190
    v_mfma_f32_16x16x32_bf16 v[212:215], v[244:247], v[172:175], v[212:215]
    ds_read_b128 v[236:239], v5 offset:31744
    v_exp_f32 v191, v191
    s_nop 0
    v_cvt_pk_bf16_f32 v77, v190, v191
    s_waitcnt lgkmcnt(3)
    v_mfma_f32_16x16x32_bf16 v[200:203], v[224:227], v[160:163], v[200:203]
    v_exp_f32 v192, v192
    v_mfma_f32_16x16x32_bf16 v[204:207], v[224:227], v[176:179], v[204:207]
    s_waitcnt vmcnt(7)
    s_barrier
    ds_read_b128 v[240:243], v4 offset:0
    v_exp_f32 v193, v193
    s_nop 0
    v_cvt_pk_bf16_f32 v74, v192, v193
    s_waitcnt lgkmcnt(3)
    v_mfma_f32_16x16x32_bf16 v[208:211], v[228:231], v[160:163], v[208:211]
    v_exp_f32 v194, v194
    v_mfma_f32_16x16x32_bf16 v[212:215], v[228:231], v[176:179], v[212:215]
    s_add_u32 s22, s21, 0x80000
    s_add_u32 m0, s20, 0x20000
    s_nop 0
    buffer_load_dwordx4 v2, s[8:11], s22 offen sc1 lds
    ds_read_b128 v[244:247], v4 offset:1024
    v_exp_f32 v195, v195
    s_nop 0
    v_cvt_pk_bf16_f32 v75, v194, v195
    s_waitcnt lgkmcnt(3)
    v_mfma_f32_16x16x32_bf16 v[200:203], v[232:235], v[164:167], v[200:203]
    v_exp_f32 v196, v196
    v_exp_f32 v197, v197
    v_mfma_f32_16x16x32_bf16 v[204:207], v[232:235], v[180:183], v[204:207]
    ds_read_b128 v[224:227], v4 offset:2048
    v_cvt_pk_bf16_f32 v78, v196, v197
    s_waitcnt lgkmcnt(3)
    v_mfma_f32_16x16x32_bf16 v[208:211], v[236:239], v[164:167], v[208:211]
    v_exp_f32 v198, v198
    v_exp_f32 v199, v199
    v_mfma_f32_16x16x32_bf16 v[212:215], v[236:239], v[180:183], v[212:215]
    ds_read_b128 v[228:231], v4 offset:3072
    v_cvt_pk_bf16_f32 v79, v198, v199
    s_waitcnt lgkmcnt(3)
    v_mfma_f32_16x16x32_bf16 v[184:187], v[240:243], v[152:155], v[216:219]
    v_mfma_f32_16x16x32_bf16 v[188:191], v[240:243], v[168:171], v[220:223]
    ds_read_b128 v[232:235], v4 offset:4096
    v_exp_f32 v200, v200
    v_exp_f32 v201, v201
    v_mfma_f32_16x16x32_bf16 v[248:251], v[12:15], v[72:75], v[248:251]
    s_waitcnt lgkmcnt(3)
    v_mfma_f32_16x16x32_bf16 v[192:195], v[244:247], v[152:155], v[216:219]
    v_cvt_pk_bf16_f32 v80, v200, v201
    v_exp_f32 v202, v202
    v_mfma_f32_16x16x32_bf16 v[196:199], v[244:247], v[168:171], v[220:223]
    s_add_u32 s22, s21, 0x80400
    s_add_u32 m0, s20, 0x20400
    s_nop 0
    buffer_load_dwordx4 v2, s[8:11], s22 offen sc1 lds
    ds_read_b128 v[236:239], v4 offset:5120
    v_exp_f32 v203, v203
    v_mfma_f32_16x16x32_bf16 v[252:255], v[12:15], v[76:79], v[252:255]
    s_waitcnt lgkmcnt(3)
    v_mfma_f32_16x16x32_bf16 v[184:187], v[224:227], v[156:159], v[184:187]
    v_cvt_pk_bf16_f32 v81, v202, v203
    v_exp_f32 v204, v204
    s_add_u32 s22, s18, 0
    s_add_u32 m0, s15, 0
    s_nop 0
    buffer_load_dwordx4 v11, s[64:67], s22 offen lds
    v_mfma_f32_16x16x32_bf16 v[188:191], v[224:227], v[172:175], v[188:191]
    ds_read_b128 v[240:243], v4 offset:6144
    v_exp_f32 v205, v205
    s_waitcnt lgkmcnt(3)
    v_mfma_f32_16x16x32_bf16 v[192:195], v[228:231], v[156:159], v[192:195]
    v_cvt_pk_bf16_f32 v84, v204, v205
    v_exp_f32 v206, v206
    v_mfma_f32_16x16x32_bf16 v[196:199], v[228:231], v[172:175], v[196:199]
    ds_read_b128 v[244:247], v4 offset:7168
    v_exp_f32 v207, v207
    s_nop 0
    v_cvt_pk_bf16_f32 v85, v206, v207
    s_waitcnt lgkmcnt(3)
    v_mfma_f32_16x16x32_bf16 v[184:187], v[232:235], v[160:163], v[184:187]
    v_exp_f32 v208, v208
    v_mfma_f32_16x16x32_bf16 v[188:191], v[232:235], v[176:179], v[188:191]
    ds_read_b128 v[224:227], v4 offset:8192
    v_exp_f32 v209, v209
    s_nop 0
    v_cvt_pk_bf16_f32 v82, v208, v209
    s_waitcnt lgkmcnt(3)
    v_mfma_f32_16x16x32_bf16 v[192:195], v[236:239], v[160:163], v[192:195]
    v_exp_f32 v210, v210
    v_mfma_f32_16x16x32_bf16 v[196:199], v[236:239], v[176:179], v[196:199]
    ds_read_b128 v[228:231], v4 offset:9216
    v_exp_f32 v211, v211
    s_nop 0
    v_cvt_pk_bf16_f32 v83, v210, v211
    s_waitcnt lgkmcnt(3)
    v_mfma_f32_16x16x32_bf16 v[184:187], v[240:243], v[164:167], v[184:187]
    v_exp_f32 v212, v212
    v_exp_f32 v213, v213
    v_mfma_f32_16x16x32_bf16 v[188:191], v[240:243], v[180:183], v[188:191]
    ds_read_b128 v[232:235], v4 offset:10240
    v_cvt_pk_bf16_f32 v86, v212, v213
    s_waitcnt lgkmcnt(3)
    v_mfma_f32_16x16x32_bf16 v[192:195], v[244:247], v[164:167], v[192:195]
    v_exp_f32 v214, v214
    v_exp_f32 v215, v215
    v_mfma_f32_16x16x32_bf16 v[196:199], v[244:247], v[180:183], v[196:199]
    ds_read_b128 v[236:239], v4 offset:11264
    v_cvt_pk_bf16_f32 v87, v214, v215
    s_waitcnt lgkmcnt(3)
    v_mfma_f32_16x16x32_bf16 v[200:203], v[224:227], v[152:155], v[216:219]
    v_mfma_f32_16x16x32_bf16 v[204:207], v[224:227], v[168:171], v[220:223]
    ds_read_b128 v[240:243], v4 offset:12288
    v_exp_f32 v184, v184
    v_exp_f32 v185, v185
    v_mfma_f32_16x16x32_bf16 v[248:251], v[12:15], v[80:83], v[248:251]
    s_waitcnt lgkmcnt(3)
    v_mfma_f32_16x16x32_bf16 v[208:211], v[228:231], v[152:155], v[216:219]
    v_cvt_pk_bf16_f32 v88, v184, v185
    v_exp_f32 v186, v186
    v_mfma_f32_16x16x32_bf16 v[212:215], v[228:231], v[168:171], v[220:223]
    ds_read_b128 v[244:247], v4 offset:13312
    v_exp_f32 v187, v187
    s_add_u32 s22, s18, 7168
    s_add_u32 m0, s15, 1024
    s_nop 0
    buffer_load_dwordx4 v11, s[64:67], s22 offen lds
    v_mfma_f32_16x16x32_bf16 v[252:255], v[12:15], v[84:87], v[252:255]
    s_waitcnt lgkmcnt(3)
    v_mfma_f32_16x16x32_bf16 v[200:203], v[232:235], v[156:159], v[200:203]
    v_cvt_pk_bf16_f32 v89, v186, v187
    v_exp_f32 v188, v188
    v_mfma_f32_16x16x32_bf16 v[204:207], v[232:235], v[172:175], v[204:207]
    ds_read_b128 v[224:227], v4 offset:14336
    v_exp_f32 v189, v189
    s_waitcnt lgkmcnt(3)
    v_mfma_f32_16x16x32_bf16 v[208:211], v[236:239], v[156:159], v[208:211]
    v_cvt_pk_bf16_f32 v92, v188, v189
    v_exp_f32 v190, v190
    v_mfma_f32_16x16x32_bf16 v[212:215], v[236:239], v[172:175], v[212:215]
    ds_read_b128 v[228:231], v4 offset:15360
    v_exp_f32 v191, v191
    s_nop 0
    v_cvt_pk_bf16_f32 v93, v190, v191
    s_waitcnt lgkmcnt(3)
    v_mfma_f32_16x16x32_bf16 v[200:203], v[240:243], v[160:163], v[200:203]
    v_exp_f32 v192, v192
    v_mfma_f32_16x16x32_bf16 v[204:207], v[240:243], v[176:179], v[204:207]
    s_waitcnt vmcnt(8)
    s_barrier
    ds_read_b128 v[232:235], v4 offset:16384
    v_exp_f32 v193, v193
    s_nop 0
    v_cvt_pk_bf16_f32 v90, v192, v193
    s_waitcnt lgkmcnt(3)
    v_mfma_f32_16x16x32_bf16 v[208:211], v[244:247], v[160:163], v[208:211]
    v_exp_f32 v194, v194
    v_mfma_f32_16x16x32_bf16 v[212:215], v[244:247], v[176:179], v[212:215]
    s_add_u32 s22, s21, 0x84000
    s_add_u32 m0, s20, 0x24000
    s_nop 0
    buffer_load_dwordx4 v2, s[8:11], s22 offen sc1 lds
    ds_read_b128 v[236:239], v4 offset:17408
    v_exp_f32 v195, v195
    s_nop 0
    v_cvt_pk_bf16_f32 v91, v194, v195
    s_waitcnt lgkmcnt(3)
    v_mfma_f32_16x16x32_bf16 v[200:203], v[224:227], v[164:167], v[200:203]
    v_exp_f32 v196, v196
    v_exp_f32 v197, v197
    v_mfma_f32_16x16x32_bf16 v[204:207], v[224:227], v[180:183], v[204:207]
    ds_read_b128 v[240:243], v4 offset:18432
    v_cvt_pk_bf16_f32 v94, v196, v197
    s_waitcnt lgkmcnt(3)
    v_mfma_f32_16x16x32_bf16 v[208:211], v[228:231], v[164:167], v[208:211]
    v_exp_f32 v198, v198
    v_exp_f32 v199, v199
    v_mfma_f32_16x16x32_bf16 v[212:215], v[228:231], v[180:183], v[212:215]
    ds_read_b128 v[244:247], v4 offset:19456
    v_cvt_pk_bf16_f32 v95, v198, v199
    s_waitcnt lgkmcnt(3)
    v_mfma_f32_16x16x32_bf16 v[184:187], v[232:235], v[152:155], v[216:219]
    v_mfma_f32_16x16x32_bf16 v[188:191], v[232:235], v[168:171], v[220:223]
    ds_read_b128 v[224:227], v4 offset:20480
    v_exp_f32 v200, v200
    v_exp_f32 v201, v201
    v_mfma_f32_16x16x32_bf16 v[248:251], v[12:15], v[88:91], v[248:251]
    s_waitcnt lgkmcnt(3)
    v_mfma_f32_16x16x32_bf16 v[192:195], v[236:239], v[152:155], v[216:219]
    v_cvt_pk_bf16_f32 v96, v200, v201
    v_exp_f32 v202, v202
    v_mfma_f32_16x16x32_bf16 v[196:199], v[236:239], v[168:171], v[220:223]
    s_add_u32 s22, s21, 0x84400
    s_add_u32 m0, s20, 0x24400
    s_nop 0
    buffer_load_dwordx4 v2, s[8:11], s22 offen sc1 lds
    ds_read_b128 v[228:231], v4 offset:21504
    v_exp_f32 v203, v203
    s_add_u32 s22, s18, 14336
    s_add_u32 m0, s15, 2048
    s_nop 0
    buffer_load_dwordx4 v11, s[64:67], s22 offen lds
    v_mfma_f32_16x16x32_bf16 v[252:255], v[12:15], v[92:95], v[252:255]
    s_waitcnt lgkmcnt(3)
    v_mfma_f32_16x16x32_bf16 v[184:187], v[240:243], v[156:159], v[184:187]
    v_cvt_pk_bf16_f32 v97, v202, v203
    v_exp_f32 v204, v204
    v_mfma_f32_16x16x32_bf16 v[188:191], v[240:243], v[172:175], v[188:191]
    ds_read_b128 v[232:235], v4 offset:22528
    v_exp_f32 v205, v205
    s_waitcnt lgkmcnt(3)
    v_mfma_f32_16x16x32_bf16 v[192:195], v[244:247], v[156:159], v[192:195]
    v_cvt_pk_bf16_f32 v100, v204, v205
    v_exp_f32 v206, v206
    v_mfma_f32_16x16x32_bf16 v[196:199], v[244:247], v[172:175], v[196:199]
    ds_read_b128 v[236:239], v4 offset:23552
    v_exp_f32 v207, v207
    s_nop 0
    v_cvt_pk_bf16_f32 v101, v206, v207
    s_waitcnt lgkmcnt(3)
    v_mfma_f32_16x16x32_bf16 v[184:187], v[224:227], v[160:163], v[184:187]
    v_exp_f32 v208, v208
    v_mfma_f32_16x16x32_bf16 v[188:191], v[224:227], v[176:179], v[188:191]
    ds_read_b128 v[240:243], v4 offset:24576
    v_exp_f32 v209, v209
    s_nop 0
    v_cvt_pk_bf16_f32 v98, v208, v209
    s_waitcnt lgkmcnt(3)
    v_mfma_f32_16x16x32_bf16 v[192:195], v[228:231], v[160:163], v[192:195]
    v_exp_f32 v210, v210
    v_mfma_f32_16x16x32_bf16 v[196:199], v[228:231], v[176:179], v[196:199]
    ds_read_b128 v[244:247], v4 offset:25600
    v_exp_f32 v211, v211
    s_nop 0
    v_cvt_pk_bf16_f32 v99, v210, v211
    s_waitcnt lgkmcnt(3)
    v_mfma_f32_16x16x32_bf16 v[184:187], v[232:235], v[164:167], v[184:187]
    v_exp_f32 v212, v212
    v_exp_f32 v213, v213
    v_mfma_f32_16x16x32_bf16 v[188:191], v[232:235], v[180:183], v[188:191]
    ds_read_b128 v[224:227], v4 offset:26624
    v_cvt_pk_bf16_f32 v102, v212, v213
    s_waitcnt lgkmcnt(3)
    v_mfma_f32_16x16x32_bf16 v[192:195], v[236:239], v[164:167], v[192:195]
    v_exp_f32 v214, v214
    v_exp_f32 v215, v215
    v_mfma_f32_16x16x32_bf16 v[196:199], v[236:239], v[180:183], v[196:199]
    ds_read_b128 v[228:231], v4 offset:27648
    v_cvt_pk_bf16_f32 v103, v214, v215
    s_waitcnt lgkmcnt(3)
    v_mfma_f32_16x16x32_bf16 v[200:203], v[240:243], v[152:155], v[216:219]
    v_mfma_f32_16x16x32_bf16 v[204:207], v[240:243], v[168:171], v[220:223]
    ds_read_b128 v[232:235], v4 offset:28672
    v_exp_f32 v184, v184
    v_exp_f32 v185, v185
    v_mfma_f32_16x16x32_bf16 v[248:251], v[12:15], v[96:99], v[248:251]
    s_waitcnt lgkmcnt(3)
    v_mfma_f32_16x16x32_bf16 v[208:211], v[244:247], v[152:155], v[216:219]
    v_cvt_pk_bf16_f32 v104, v184, v185
    v_exp_f32 v186, v186
    s_add_u32 s22, s18, 21504
    s_add_u32 m0, s15, 3072
    s_nop 0
    buffer_load_dwordx4 v11, s[64:67], s22 offen lds
    v_mfma_f32_16x16x32_bf16 v[212:215], v[244:247], v[168:171], v[220:223]
    ds_read_b128 v[236:239], v4 offset:29696
    v_exp_f32 v187, v187
    v_mfma_f32_16x16x32_bf16 v[252:255], v[12:15], v[100:103], v[252:255]
    s_waitcnt lgkmcnt(3)
    v_mfma_f32_16x16x32_bf16 v[200:203], v[224:227], v[156:159], v[200:203]
    v_cvt_pk_bf16_f32 v105, v186, v187
    v_exp_f32 v188, v188
    v_mfma_f32_16x16x32_bf16 v[204:207], v[224:227], v[172:175], v[204:207]
    ds_read_b128 v[240:243], v4 offset:30720
    v_exp_f32 v189, v189
    s_waitcnt lgkmcnt(3)
    v_mfma_f32_16x16x32_bf16 v[208:211], v[228:231], v[156:159], v[208:211]
    v_cvt_pk_bf16_f32 v108, v188, v189
    v_exp_f32 v190, v190
    v_mfma_f32_16x16x32_bf16 v[212:215], v[228:231], v[172:175], v[212:215]
    ds_read_b128 v[244:247], v4 offset:31744
    v_exp_f32 v191, v191
    s_nop 0
    v_cvt_pk_bf16_f32 v109, v190, v191
    s_waitcnt lgkmcnt(3)
    v_mfma_f32_16x16x32_bf16 v[200:203], v[232:235], v[160:163], v[200:203]
    v_exp_f32 v192, v192
    v_mfma_f32_16x16x32_bf16 v[204:207], v[232:235], v[176:179], v[204:207]
    s_waitcnt vmcnt(10)
    s_barrier
    ds_read_b128 v[224:227], v4 offset:32768
    v_exp_f32 v193, v193
    s_nop 0
    v_cvt_pk_bf16_f32 v106, v192, v193
    s_waitcnt lgkmcnt(3)
    v_mfma_f32_16x16x32_bf16 v[208:211], v[236:239], v[160:163], v[208:211]
    v_exp_f32 v194, v194
    v_mfma_f32_16x16x32_bf16 v[212:215], v[236:239], v[176:179], v[212:215]
    s_add_u32 s22, s21, 0x88000
    s_add_u32 m0, s20, 0x10000
    s_nop 0
    buffer_load_dwordx4 v2, s[8:11], s22 offen sc1 lds
    ds_read_b128 v[228:231], v4 offset:33792
    v_exp_f32 v195, v195
    s_nop 0
    v_cvt_pk_bf16_f32 v107, v194, v195
    s_waitcnt lgkmcnt(3)
    v_mfma_f32_16x16x32_bf16 v[200:203], v[240:243], v[164:167], v[200:203]
    v_exp_f32 v196, v196
    v_exp_f32 v197, v197
    v_mfma_f32_16x16x32_bf16 v[204:207], v[240:243], v[180:183], v[204:207]
    ds_read_b128 v[232:235], v4 offset:34816
    v_cvt_pk_bf16_f32 v110, v196, v197
    s_waitcnt lgkmcnt(3)
    v_mfma_f32_16x16x32_bf16 v[208:211], v[244:247], v[164:167], v[208:211]
    v_exp_f32 v198, v198
    v_exp_f32 v199, v199
    v_mfma_f32_16x16x32_bf16 v[212:215], v[244:247], v[180:183], v[212:215]
    ds_read_b128 v[236:239], v4 offset:35840
    v_cvt_pk_bf16_f32 v111, v198, v199
    s_waitcnt lgkmcnt(3)
    v_mfma_f32_16x16x32_bf16 v[184:187], v[224:227], v[152:155], v[216:219]
    v_mfma_f32_16x16x32_bf16 v[188:191], v[224:227], v[168:171], v[220:223]
    ds_read_b128 v[240:243], v4 offset:36864
    v_exp_f32 v200, v200
    v_exp_f32 v201, v201
    v_mfma_f32_16x16x32_bf16 v[248:251], v[12:15], v[104:107], v[248:251]
    s_waitcnt lgkmcnt(3)
    v_mfma_f32_16x16x32_bf16 v[192:195], v[228:231], v[152:155], v[216:219]
    v_cvt_pk_bf16_f32 v112, v200, v201
    v_exp_f32 v202, v202
    s_add_u32 s22, s18, 28672
    s_add_u32 m0, s15, 4096
    s_nop 0
    buffer_load_dwordx4 v11, s[64:67], s22 offen lds
    v_mfma_f32_16x16x32_bf16 v[196:199], v[228:231], v[168:171], v[220:223]
    s_add_u32 s22, s21, 0x88400
    s_add_u32 m0, s20, 0x10400
    s_nop 0
    buffer_load_dwordx4 v2, s[8:11], s22 offen sc1 lds
    ds_read_b128 v[244:247], v4 offset:37888
    v_exp_f32 v203, v203
    v_mfma_f32_16x16x32_bf16 v[252:255], v[12:15], v[108:111], v[252:255]
    s_waitcnt lgkmcnt(3)
    v_mfma_f32_16x16x32_bf16 v[184:187], v[232:235], v[156:159], v[184:187]
    v_cvt_pk_bf16_f32 v113, v202, v203
    v_exp_f32 v204, v204
    v_mfma_f32_16x16x32_bf16 v[188:191], v[232:235], v[172:175], v[188:191]
    ds_read_b128 v[224:227], v4 offset:38912
    v_exp_f32 v205, v205
    s_waitcnt lgkmcnt(3)
    v_mfma_f32_16x16x32_bf16 v[192:195], v[236:239], v[156:159], v[192:195]
    v_cvt_pk_bf16_f32 v116, v204, v205
    v_exp_f32 v206, v206
    v_mfma_f32_16x16x32_bf16 v[196:199], v[236:239], v[172:175], v[196:199]
    ds_read_b128 v[228:231], v4 offset:39936
    v_exp_f32 v207, v207
    s_nop 0
    v_cvt_pk_bf16_f32 v117, v206, v207
    s_waitcnt lgkmcnt(3)
    v_mfma_f32_16x16x32_bf16 v[184:187], v[240:243], v[160:163], v[184:187]
    v_exp_f32 v208, v208
    v_mfma_f32_16x16x32_bf16 v[188:191], v[240:243], v[176:179], v[188:191]
    ds_read_b128 v[232:235], v4 offset:40960
    v_exp_f32 v209, v209
    s_nop 0
    v_cvt_pk_bf16_f32 v114, v208, v209
    s_waitcnt lgkmcnt(3)
    v_mfma_f32_16x16x32_bf16 v[192:195], v[244:247], v[160:163], v[192:195]
    v_exp_f32 v210, v210
    v_mfma_f32_16x16x32_bf16 v[196:199], v[244:247], v[176:179], v[196:199]
    ds_read_b128 v[236:239], v4 offset:41984
    v_exp_f32 v211, v211
    s_nop 0
    v_cvt_pk_bf16_f32 v115, v210, v211
    s_waitcnt lgkmcnt(3)
    v_mfma_f32_16x16x32_bf16 v[184:187], v[224:227], v[164:167], v[184:187]
    v_exp_f32 v212, v212
    v_exp_f32 v213, v213
    v_mfma_f32_16x16x32_bf16 v[188:191], v[224:227], v[180:183], v[188:191]
    ds_read_b128 v[240:243], v4 offset:43008
    v_cvt_pk_bf16_f32 v118, v212, v213
    s_waitcnt lgkmcnt(3)
    v_mfma_f32_16x16x32_bf16 v[192:195], v[228:231], v[164:167], v[192:195]
    v_exp_f32 v214, v214
    v_exp_f32 v215, v215
    v_mfma_f32_16x16x32_bf16 v[196:199], v[228:231], v[180:183], v[196:199]
    ds_read_b128 v[244:247], v4 offset:44032
    v_cvt_pk_bf16_f32 v119, v214, v215
    s_waitcnt lgkmcnt(3)
    v_mfma_f32_16x16x32_bf16 v[200:203], v[232:235], v[152:155], v[216:219]
    v_mfma_f32_16x16x32_bf16 v[204:207], v[232:235], v[168:171], v[220:223]
    ds_read_b128 v[224:227], v4 offset:45056
    v_exp_f32 v184, v184
    v_exp_f32 v185, v185
    s_add_u32 s22, s18, 35840
    s_add_u32 m0, s15, 5120
    s_nop 0
    buffer_load_dwordx4 v11, s[64:67], s22 offen lds
    v_mfma_f32_16x16x32_bf16 v[248:251], v[12:15], v[112:115], v[248:251]
    s_waitcnt lgkmcnt(3)
    v_mfma_f32_16x16x32_bf16 v[208:211], v[236:239], v[152:155], v[216:219]
    v_cvt_pk_bf16_f32 v120, v184, v185
    v_exp_f32 v186, v186
    v_mfma_f32_16x16x32_bf16 v[212:215], v[236:239], v[168:171], v[220:223]
    ds_read_b128 v[228:231], v4 offset:46080
    v_exp_f32 v187, v187
    v_mfma_f32_16x16x32_bf16 v[252:255], v[12:15], v[116:119], v[252:255]
    s_waitcnt lgkmcnt(3)
    v_mfma_f32_16x16x32_bf16 v[200:203], v[240:243], v[156:159], v[200:203]
    v_cvt_pk_bf16_f32 v121, v186, v187
    v_exp_f32 v188, v188
    v_mfma_f32_16x16x32_bf16 v[204:207], v[240:243], v[172:175], v[204:207]
    ds_read_b128 v[232:235], v4 offset:47104
    v_exp_f32 v189, v189
    s_waitcnt lgkmcnt(3)
    v_mfma_f32_16x16x32_bf16 v[208:211], v[244:247], v[156:159], v[208:211]
    v_cvt_pk_bf16_f32 v124, v188, v189
    v_exp_f32 v190, v190
    v_mfma_f32_16x16x32_bf16 v[212:215], v[244:247], v[172:175], v[212:215]
    ds_read_b128 v[236:239], v4 offset:48128
    v_exp_f32 v191, v191
    s_nop 0
    v_cvt_pk_bf16_f32 v125, v190, v191
    s_waitcnt lgkmcnt(3)
    v_mfma_f32_16x16x32_bf16 v[200:203], v[224:227], v[160:163], v[200:203]
    v_exp_f32 v192, v192
    v_mfma_f32_16x16x32_bf16 v[204:207], v[224:227], v[176:179], v[204:207]
    s_waitcnt vmcnt(12)
    s_barrier
    ds_read_b128 v[240:243], v4 offset:49152
    v_exp_f32 v193, v193
    s_nop 0
    v_cvt_pk_bf16_f32 v122, v192, v193
    s_waitcnt lgkmcnt(3)
    v_mfma_f32_16x16x32_bf16 v[208:211], v[228:231], v[160:163], v[208:211]
    v_exp_f32 v194, v194
    v_mfma_f32_16x16x32_bf16 v[212:215], v[228:231], v[176:179], v[212:215]
    s_add_u32 s22, s21, 0x8c000
    s_add_u32 m0, s20, 0x14000
    s_nop 0
    buffer_load_dwordx4 v2, s[8:11], s22 offen sc1 lds
    ds_read_b128 v[244:247], v4 offset:50176
    v_exp_f32 v195, v195
    s_nop 0
    v_cvt_pk_bf16_f32 v123, v194, v195
    s_waitcnt lgkmcnt(3)
    v_mfma_f32_16x16x32_bf16 v[200:203], v[232:235], v[164:167], v[200:203]
    v_exp_f32 v196, v196
    v_exp_f32 v197, v197
    v_mfma_f32_16x16x32_bf16 v[204:207], v[232:235], v[180:183], v[204:207]
    ds_read_b128 v[224:227], v4 offset:51200
    v_cvt_pk_bf16_f32 v126, v196, v197
    s_waitcnt lgkmcnt(3)
    v_mfma_f32_16x16x32_bf16 v[208:211], v[236:239], v[164:167], v[208:211]
    v_exp_f32 v198, v198
    v_exp_f32 v199, v199
    v_mfma_f32_16x16x32_bf16 v[212:215], v[236:239], v[180:183], v[212:215]
    ds_read_b128 v[228:231], v4 offset:52224
    v_cvt_pk_bf16_f32 v127, v198, v199
    s_waitcnt lgkmcnt(3)
    v_mfma_f32_16x16x32_bf16 v[184:187], v[240:243], v[152:155], v[216:219]
    v_mfma_f32_16x16x32_bf16 v[188:191], v[240:243], v[168:171], v[220:223]
    ds_read_b128 v[232:235], v4 offset:53248
    v_exp_f32 v200, v200
    v_exp_f32 v201, v201
    s_add_u32 s22, s18, 43008
    s_add_u32 m0, s15, 6144
    s_nop 0
    buffer_load_dwordx4 v11, s[64:67], s22 offen lds
    v_mfma_f32_16x16x32_bf16 v[248:251], v[12:15], v[120:123], v[248:251]
    s_waitcnt lgkmcnt(3)
    v_mfma_f32_16x16x32_bf16 v[192:195], v[244:247], v[152:155], v[216:219]
    v_cvt_pk_bf16_f32 v128, v200, v201
    v_exp_f32 v202, v202
    v_mfma_f32_16x16x32_bf16 v[196:199], v[244:247], v[168:171], v[220:223]
    s_add_u32 s22, s21, 0x8c400
    s_add_u32 m0, s20, 0x14400
    s_nop 0
    buffer_load_dwordx4 v2, s[8:11], s22 offen sc1 lds
    ds_read_b128 v[236:239], v4 offset:54272
    v_exp_f32 v203, v203
    v_mfma_f32_16x16x32_bf16 v[252:255], v[12:15], v[124:127], v[252:255]
    s_waitcnt lgkmcnt(3)
    v_mfma_f32_16x16x32_bf16 v[184:187], v[224:227], v[156:159], v[184:187]
    v_cvt_pk_bf16_f32 v129, v202, v203
    v_exp_f32 v204, v204
    v_mfma_f32_16x16x32_bf16 v[188:191], v[224:227], v[172:175], v[188:191]
    ds_read_b128 v[240:243], v4 offset:55296
    v_exp_f32 v205, v205
    s_waitcnt lgkmcnt(3)
    v_mfma_f32_16x16x32_bf16 v[192:195], v[228:231], v[156:159], v[192:195]
    v_cvt_pk_bf16_f32 v132, v204, v205
    v_exp_f32 v206, v206
    v_mfma_f32_16x16x32_bf16 v[196:199], v[228:231], v[172:175], v[196:199]
    ds_read_b128 v[244:247], v4 offset:56320
    v_exp_f32 v207, v207
    s_nop 0
    v_cvt_pk_bf16_f32 v133, v206, v207
    s_waitcnt lgkmcnt(3)
    v_mfma_f32_16x16x32_bf16 v[184:187], v[232:235], v[160:163], v[184:187]
    v_exp_f32 v208, v208
    v_mfma_f32_16x16x32_bf16 v[188:191], v[232:235], v[176:179], v[188:191]
    ds_read_b128 v[224:227], v4 offset:57344
    v_exp_f32 v209, v209
    s_nop 0
    v_cvt_pk_bf16_f32 v130, v208, v209
    s_waitcnt lgkmcnt(3)
    v_mfma_f32_16x16x32_bf16 v[192:195], v[236:239], v[160:163], v[192:195]
    v_exp_f32 v210, v210
    v_mfma_f32_16x16x32_bf16 v[196:199], v[236:239], v[176:179], v[196:199]
    ds_read_b128 v[228:231], v4 offset:58368
    v_exp_f32 v211, v211
    s_nop 0
    v_cvt_pk_bf16_f32 v131, v210, v211
    s_waitcnt lgkmcnt(3)
    v_mfma_f32_16x16x32_bf16 v[184:187], v[240:243], v[164:167], v[184:187]
    v_exp_f32 v212, v212
    v_exp_f32 v213, v213
    v_mfma_f32_16x16x32_bf16 v[188:191], v[240:243], v[180:183], v[188:191]
    ds_read_b128 v[232:235], v4 offset:59392
    v_cvt_pk_bf16_f32 v134, v212, v213
    s_waitcnt lgkmcnt(3)
    v_mfma_f32_16x16x32_bf16 v[192:195], v[244:247], v[164:167], v[192:195]
    v_exp_f32 v214, v214
    v_exp_f32 v215, v215
    v_mfma_f32_16x16x32_bf16 v[196:199], v[244:247], v[180:183], v[196:199]
    ds_read_b128 v[236:239], v4 offset:60416
    v_cvt_pk_bf16_f32 v135, v214, v215
    s_waitcnt lgkmcnt(3)
    v_mfma_f32_16x16x32_bf16 v[200:203], v[224:227], v[152:155], v[216:219]
    s_add_u32 s22, s18, 50176
    s_add_u32 m0, s15, 7168
    s_nop 0
    buffer_load_dwordx4 v11, s[64:67], s22 offen lds
    v_mfma_f32_16x16x32_bf16 v[204:207], v[224:227], v[168:171], v[220:223]
    ds_read_b128 v[240:243], v4 offset:61440
    v_exp_f32 v184, v184
    v_exp_f32 v185, v185
    v_mfma_f32_16x16x32_bf16 v[248:251], v[12:15], v[128:131], v[248:251]
    s_waitcnt lgkmcnt(3)
    v_mfma_f32_16x16x32_bf16 v[208:211], v[228:231], v[152:155], v[216:219]
    v_cvt_pk_bf16_f32 v136, v184, v185
    v_exp_f32 v186, v186
    v_mfma_f32_16x16x32_bf16 v[212:215], v[228:231], v[168:171], v[220:223]
    ds_read_b128 v[244:247], v4 offset:62464
    v_exp_f32 v187, v187
    v_mfma_f32_16x16x32_bf16 v[252:255], v[12:15], v[132:135], v[252:255]
    s_waitcnt lgkmcnt(3)
    v_mfma_f32_16x16x32_bf16 v[200:203], v[232:235], v[156:159], v[200:203]
    v_cvt_pk_bf16_f32 v137, v186, v187
    v_exp_f32 v188, v188
    v_mfma_f32_16x16x32_bf16 v[204:207], v[232:235], v[172:175], v[204:207]
    ds_read_b128 v[224:227], v4 offset:63488
    v_exp_f32 v189, v189
    s_waitcnt lgkmcnt(3)
    v_mfma_f32_16x16x32_bf16 v[208:211], v[236:239], v[156:159], v[208:211]
    v_cvt_pk_bf16_f32 v140, v188, v189
    v_exp_f32 v190, v190
    v_mfma_f32_16x16x32_bf16 v[212:215], v[236:239], v[172:175], v[212:215]
    ds_read_b128 v[228:231], v4 offset:64512
    v_exp_f32 v191, v191
    s_nop 0
    v_cvt_pk_bf16_f32 v141, v190, v191
    s_waitcnt lgkmcnt(3)
    v_mfma_f32_16x16x32_bf16 v[200:203], v[240:243], v[160:163], v[200:203]
    v_exp_f32 v192, v192
    v_mfma_f32_16x16x32_bf16 v[204:207], v[240:243], v[176:179], v[204:207]
    v_exp_f32 v193, v193
    s_nop 0
    v_cvt_pk_bf16_f32 v138, v192, v193
    s_waitcnt lgkmcnt(2)
    v_mfma_f32_16x16x32_bf16 v[208:211], v[244:247], v[160:163], v[208:211]
    v_exp_f32 v194, v194
    v_mfma_f32_16x16x32_bf16 v[212:215], v[244:247], v[176:179], v[212:215]
    v_exp_f32 v195, v195
    s_nop 0
    v_cvt_pk_bf16_f32 v139, v194, v195
    s_waitcnt lgkmcnt(1)
    v_mfma_f32_16x16x32_bf16 v[200:203], v[224:227], v[164:167], v[200:203]
    v_exp_f32 v196, v196
    v_exp_f32 v197, v197
    v_mfma_f32_16x16x32_bf16 v[204:207], v[224:227], v[180:183], v[204:207]
    v_cvt_pk_bf16_f32 v142, v196, v197
    s_waitcnt lgkmcnt(0)
    v_mfma_f32_16x16x32_bf16 v[208:211], v[228:231], v[164:167], v[208:211]
    v_exp_f32 v198, v198
    v_exp_f32 v199, v199
    v_mfma_f32_16x16x32_bf16 v[212:215], v[228:231], v[180:183], v[212:215]
    v_cvt_pk_bf16_f32 v143, v198, v199
    s_waitcnt vmcnt(14)
    s_barrier
    ds_read_b128 v[232:235], v5 offset:0
    ds_read_b128 v[236:239], v5 offset:1024
    ds_read_b128 v[240:243], v5 offset:2048
    ds_read_b128 v[244:247], v5 offset:3072
    v_mfma_f32_16x16x32_bf16 v[248:251], v[12:15], v[136:139], v[248:251]
    v_mfma_f32_16x16x32_bf16 v[252:255], v[12:15], v[140:143], v[252:255]
    v_exp_f32 v200, v200
    v_exp_f32 v201, v201
    s_nop 0
    v_cvt_pk_bf16_f32 v144, v200, v201
    v_exp_f32 v202, v202
    v_exp_f32 v203, v203
    s_nop 0
    v_cvt_pk_bf16_f32 v145, v202, v203
    v_exp_f32 v204, v204
    v_exp_f32 v205, v205
    s_nop 0
    v_cvt_pk_bf16_f32 v148, v204, v205
    v_exp_f32 v206, v206
    v_exp_f32 v207, v207
    s_nop 0
    v_cvt_pk_bf16_f32 v149, v206, v207
    v_exp_f32 v208, v208
    v_exp_f32 v209, v209
    s_nop 0
    v_cvt_pk_bf16_f32 v146, v208, v209
    v_exp_f32 v210, v210
    v_exp_f32 v211, v211
    s_nop 0
    v_cvt_pk_bf16_f32 v147, v210, v211
    v_exp_f32 v212, v212
    v_exp_f32 v213, v213
    s_nop 0
    v_cvt_pk_bf16_f32 v150, v212, v213
    v_exp_f32 v214, v214
    v_exp_f32 v215, v215
    s_nop 0
    v_cvt_pk_bf16_f32 v151, v214, v215
    v_mfma_f32_16x16x32_bf16 v[248:251], v[12:15], v[144:147], v[248:251]
    s_nop 0
    v_mfma_f32_16x16x32_bf16 v[252:255], v[12:15], v[148:151], v[252:255]
    s_nop 5
    v_mov_b32 v9, v248
    s_nop 0
    v_mov_b32 v10, v252
    v_max_f32 v17, v9, v10
    v_readfirstlane_b32 s17, v8
    s_cmp_eq_u32 s17, s28
    s_cselect_b32 s16, 0, 0x71800000
    v_cmp_ngt_f32 vcc, s16, v17
    v_cmp_u_f32 s[76:77], v9, v10
    s_or_b64 vcc, vcc, s[76:77]
    s_cbranch_vccnz adaLN_cond__sliding_block_cached__moe_arch_mod__prompt_kernel_fixB
adaLN_cond__sliding_block_cached__moe_arch_mod__prompt_kernel_fixBb:
    v_rcp_f32 v9, v9
    v_rcp_f32 v10, v10
    s_lshl_b32 s25, s13, 3
    s_add_u32 s25, s25, s3
    s_lshl_b32 s25, s25, 18
    s_lshl_b32 s26, s12, 12
    s_add_u32 s25, s25, s26
    s_add_u32 s25, s25, 0x1000000
    s_add_u32 s26, s25, 131072
    s_lshl_b32 s63, s13, 3
    s_add_u32 s63, s63, s3
    s_lshl_b32 s63, s63, 5
    s_add_u32 s63, s63, s12
    s_lshl_b32 s63, s63, 2
    s_waitcnt lgkmcnt(3)
    v_mfma_f32_16x16x32_bf16 v[184:187], v[232:235], v[24:27], 0
    v_mfma_f32_16x16x32_bf16 v[188:191], v[232:235], v[28:31], 0
    ds_read_b128 v[224:227], v5 offset:4096
    s_waitcnt lgkmcnt(3)
    v_mfma_f32_16x16x32_bf16 v[192:195], v[236:239], v[24:27], 0
    s_add_u32 s22, s21, 0x90000
    s_add_u32 m0, s20, 0x18000
    s_nop 0
    buffer_load_dwordx4 v2, s[8:11], s22 offen sc1 lds
    v_mfma_f32_16x16x32_bf16 v[196:199], v[236:239], v[28:31], 0
    ds_read_b128 v[228:231], v5 offset:5120
    s_waitcnt lgkmcnt(3)
    v_mfma_f32_16x16x32_bf16 v[184:187], v[240:243], v[32:35], v[184:187]
    v_mfma_f32_16x16x32_bf16 v[188:191], v[240:243], v[36:39], v[188:191]
    ds_read_b128 v[232:235], v5 offset:6144
    s_waitcnt lgkmcnt(3)
    v_mfma_f32_16x16x32_bf16 v[192:195], v[244:247], v[32:35], v[192:195]
    v_mfma_f32_16x16x32_bf16 v[196:199], v[244:247], v[36:39], v[196:199]
    ds_read_b128 v[236:239], v5 offset:7168
    s_waitcnt lgkmcnt(3)
    v_mfma_f32_16x16x32_bf16 v[184:187], v[224:227], v[40:43], v[184:187]
    v_mfma_f32_16x16x32_bf16 v[188:191], v[224:227], v[44:47], v[188:191]
    ds_read_b128 v[240:243], v5 offset:8192
    s_waitcnt lgkmcnt(3)
    v_mfma_f32_16x16x32_bf16 v[192:195], v[228:231], v[40:43], v[192:195]
    s_add_u32 s22, s21, 0x90400
    s_add_u32 m0, s20, 0x18400
    s_nop 0
    buffer_load_dwordx4 v2, s[8:11], s22 offen sc1 lds
    v_mfma_f32_16x16x32_bf16 v[196:199], v[228:231], v[44:47], v[196:199]
    ds_read_b128 v[244:247], v5 offset:9216
    s_waitcnt lgkmcnt(3)
    v_mfma_f32_16x16x32_bf16 v[184:187], v[232:235], v[48:51], v[184:187]
    v_mfma_f32_16x16x32_bf16 v[188:191], v[232:235], v[52:55], v[188:191]
    ds_read_b128 v[224:227], v5 offset:10240
    s_waitcnt lgkmcnt(3)
    v_mfma_f32_16x16x32_bf16 v[192:195], v[236:239], v[48:51], v[192:195]
    v_mfma_f32_16x16x32_bf16 v[196:199], v[236:239], v[52:55], v[196:199]
    ds_read_b128 v[228:231], v5 offset:11264
    s_waitcnt lgkmcnt(3)
    v_mfma_f32_16x16x32_bf16 v[184:187], v[240:243], v[56:59], v[184:187]
    v_mfma_f32_16x16x32_bf16 v[188:191], v[240:243], v[60:63], v[188:191]
    ds_read_b128 v[232:235], v5 offset:12288
    s_waitcnt lgkmcnt(3)
    v_mfma_f32_16x16x32_bf16 v[192:195], v[244:247], v[56:59], v[192:195]
    v_mfma_f32_16x16x32_bf16 v[196:199], v[244:247], v[60:63], v[196:199]
    ds_read_b128 v[236:239], v5 offset:13312
    s_waitcnt lgkmcnt(3)
    v_mfma_f32_16x16x32_bf16 v[184:187], v[224:227], v[64:67], v[184:187]
    v_mfma_f32_16x16x32_bf16 v[188:191], v[224:227], v[68:71], v[188:191]
    ds_read_b128 v[240:243], v5 offset:14336
    s_waitcnt lgkmcnt(3)
    v_mfma_f32_16x16x32_bf16 v[192:195], v[228:231], v[64:67], v[192:195]
    v_mfma_f32_16x16x32_bf16 v[196:199], v[228:231], v[68:71], v[196:199]
    ds_read_b128 v[244:247], v5 offset:15360
    s_waitcnt lgkmcnt(3)
    v_mfma_f32_16x16x32_bf16 v[184:187], v[232:235], v[72:75], v[184:187]
    v_mfma_f32_16x16x32_bf16 v[188:191], v[232:235], v[76:79], v[188:191]
    s_waitcnt vmcnt(12)
    s_barrier
    ds_read_b128 v[224:227], v5 offset:16384
    s_waitcnt lgkmcnt(3)
    v_mfma_f32_16x16x32_bf16 v[192:195], v[236:239], v[72:75], v[192:195]
    v_mfma_f32_16x16x32_bf16 v[196:199], v[236:239], v[76:79], v[196:199]
    s_add_u32 s22, s21, 0x94000
    s_add_u32 m0, s20, 0x1c000
    s_nop 0
    buffer_load_dwordx4 v2, s[8:11], s22 offen sc1 lds
    ds_read_b128 v[228:231], v5 offset:17408
    s_waitcnt lgkmcnt(3)
    v_mfma_f32_16x16x32_bf16 v[184:187], v[240:243], v[80:83], v[184:187]
    v_mfma_f32_16x16x32_bf16 v[188:191], v[240:243], v[84:87], v[188:191]
    ds_read_b128 v[232:235], v5 offset:18432
    s_waitcnt lgkmcnt(3)
    v_mfma_f32_16x16x32_bf16 v[192:195], v[244:247], v[80:83], v[192:195]
    v_mfma_f32_16x16x32_bf16 v[196:199], v[244:247], v[84:87], v[196:199]
    ds_read_b128 v[236:239], v5 offset:19456
    s_waitcnt lgkmcnt(3)
    v_mfma_f32_16x16x32_bf16 v[184:187], v[224:227], v[88:91], v[184:187]
    v_mfma_f32_16x16x32_bf16 v[188:191], v[224:227], v[92:95], v[188:191]
    ds_read_b128 v[240:243], v5 offset:20480
    s_waitcnt lgkmcnt(3)
    v_mfma_f32_16x16x32_bf16 v[192:195], v[228:231], v[88:91], v[192:195]
    v_mfma_f32_16x16x32_bf16 v[196:199], v[228:231], v[92:95], v[196:199]
    s_add_u32 s22, s21, 0x94400
    s_add_u32 m0, s20, 0x1c400
    s_nop 0
    buffer_load_dwordx4 v2, s[8:11], s22 offen sc1 lds
    ds_read_b128 v[244:247], v5 offset:21504
    s_waitcnt lgkmcnt(3)
    v_mfma_f32_16x16x32_bf16 v[184:187], v[232:235], v[96:99], v[184:187]
    v_mfma_f32_16x16x32_bf16 v[188:191], v[232:235], v[100:103], v[188:191]
    ds_read_b128 v[224:227], v5 offset:22528
    s_waitcnt lgkmcnt(3)
    v_mfma_f32_16x16x32_bf16 v[192:195], v[236:239], v[96:99], v[192:195]
    v_mfma_f32_16x16x32_bf16 v[196:199], v[236:239], v[100:103], v[196:199]
    ds_read_b128 v[228:231], v5 offset:23552
    s_waitcnt lgkmcnt(3)
    v_mfma_f32_16x16x32_bf16 v[184:187], v[240:243], v[104:107], v[184:187]
    v_mfma_f32_16x16x32_bf16 v[188:191], v[240:243], v[108:111], v[188:191]
    ds_read_b128 v[232:235], v5 offset:24576
    s_waitcnt lgkmcnt(3)
    v_mfma_f32_16x16x32_bf16 v[192:195], v[244:247], v[104:107], v[192:195]
    v_mfma_f32_16x16x32_bf16 v[196:199], v[244:247], v[108:111], v[196:199]
    ds_read_b128 v[236:239], v5 offset:25600
    s_waitcnt lgkmcnt(3)
    v_mfma_f32_16x16x32_bf16 v[184:187], v[224:227], v[112:115], v[184:187]
    v_mfma_f32_16x16x32_bf16 v[188:191], v[224:227], v[116:119], v[188:191]
    ds_read_b128 v[240:243], v5 offset:26624
    s_waitcnt lgkmcnt(3)
    v_mfma_f32_16x16x32_bf16 v[192:195], v[228:231], v[112:115], v[192:195]
    v_mfma_f32_16x16x32_bf16 v[196:199], v[228:231], v[116:119], v[196:199]
    ds_read_b128 v[244:247], v5 offset:27648
    s_waitcnt lgkmcnt(3)
    v_mfma_f32_16x16x32_bf16 v[184:187], v[232:235], v[120:123], v[184:187]
    v_mfma_f32_16x16x32_bf16 v[188:191], v[232:235], v[124:127], v[188:191]
    ds_read_b128 v[224:227], v5 offset:28672
    s_waitcnt lgkmcnt(3)
    v_mfma_f32_16x16x32_bf16 v[192:195], v[236:239], v[120:123], v[192:195]
    v_mfma_f32_16x16x32_bf16 v[196:199], v[236:239], v[124:127], v[196:199]
    ds_read_b128 v[228:231], v5 offset:29696
    s_waitcnt lgkmcnt(3)
    v_mfma_f32_16x16x32_bf16 v[184:187], v[240:243], v[128:131], v[184:187]
    v_mfma_f32_16x16x32_bf16 v[188:191], v[240:243], v[132:135], v[188:191]
    ds_read_b128 v[232:235], v5 offset:30720
    s_waitcnt lgkmcnt(3)
    v_mfma_f32_16x16x32_bf16 v[192:195], v[244:247], v[128:131], v[192:195]
    v_mfma_f32_16x16x32_bf16 v[196:199], v[244:247], v[132:135], v[196:199]
    ds_read_b128 v[236:239], v5 offset:31744
    s_waitcnt lgkmcnt(3)
    v_mfma_f32_16x16x32_bf16 v[184:187], v[224:227], v[136:139], v[184:187]
    v_mfma_f32_16x16x32_bf16 v[188:191], v[224:227], v[140:143], v[188:191]
    s_waitcnt vmcnt(9)
    s_barrier
    ds_read_b128 v[240:243], v4 offset:0
    s_waitcnt lgkmcnt(3)
    v_mfma_f32_16x16x32_bf16 v[192:195], v[228:231], v[136:139], v[192:195]
    v_mfma_f32_16x16x32_bf16 v[196:199], v[228:231], v[140:143], v[196:199]
    s_add_u32 s22, s21, 0x98000
    s_add_u32 m0, s20, 0x20000
    s_nop 0
    buffer_load_dwordx4 v2, s[8:11], s22 offen sc1 lds
    ds_read_b128 v[244:247], v4 offset:1024
    s_waitcnt lgkmcnt(3)
    v_mfma_f32_16x16x32_bf16 v[184:187], v[232:235], v[144:147], v[184:187]
    v_mfma_f32_16x16x32_bf16 v[188:191], v[232:235], v[148:151], v[188:191]
    ds_read_b128 v[224:227], v4 offset:2048
    s_waitcnt lgkmcnt(3)
    v_mfma_f32_16x16x32_bf16 v[192:195], v[236:239], v[144:147], v[192:195]
    v_mfma_f32_16x16x32_bf16 v[196:199], v[236:239], v[148:151], v[196:199]
    ds_read_b128 v[228:231], v4 offset:3072
    s_waitcnt lgkmcnt(3)
    v_mfma_f32_16x16x32_bf16 v[200:203], v[240:243], v[24:27], 0
    v_mfma_f32_16x16x32_bf16 v[204:207], v[240:243], v[28:31], 0
    ds_read_b128 v[232:235], v4 offset:4096
    s_waitcnt lgkmcnt(3)
    v_mfma_f32_16x16x32_bf16 v[208:211], v[244:247], v[24:27], 0
    v_mfma_f32_16x16x32_bf16 v[212:215], v[244:247], v[28:31], 0
    s_add_u32 s22, s21, 0x98400
    s_add_u32 m0, s20, 0x20400
    s_nop 0
    buffer_load_dwordx4 v2, s[8:11], s22 offen sc1 lds
    ds_read_b128 v[236:239], v4 offset:5120
    v_mul_f32 v184, v184, v9
    s_waitcnt lgkmcnt(3)
    v_mfma_f32_16x16x32_bf16 v[200:203], v[224:227], v[32:35], v[200:203]
    v_mul_f32 v185, v185, v9
    v_mfma_f32_16x16x32_bf16 v[204:207], v[224:227], v[36:39], v[204:207]
    ds_read_b128 v[240:243], v4 offset:6144
    v_mul_f32 v186, v186, v9
    s_waitcnt lgkmcnt(3)
    v_mfma_f32_16x16x32_bf16 v[208:211], v[228:231], v[32:35], v[208:211]
    v_mul_f32 v187, v187, v9
    v_mfma_f32_16x16x32_bf16 v[212:215], v[228:231], v[36:39], v[212:215]
    ds_read_b128 v[244:247], v4 offset:7168
    v_mul_f32 v192, v192, v9
    s_waitcnt lgkmcnt(3)
    v_mfma_f32_16x16x32_bf16 v[200:203], v[232:235], v[40:43], v[200:203]
    v_mul_f32 v193, v193, v9
    v_mfma_f32_16x16x32_bf16 v[204:207], v[232:235], v[44:47], v[204:207]
    ds_read_b128 v[224:227], v4 offset:8192
    v_mul_f32 v194, v194, v9
    s_waitcnt lgkmcnt(3)
    v_mfma_f32_16x16x32_bf16 v[208:211], v[236:239], v[40:43], v[208:211]
    v_mul_f32 v195, v195, v9
    v_mfma_f32_16x16x32_bf16 v[212:215], v[236:239], v[44:47], v[212:215]
    ds_read_b128 v[228:231], v4 offset:9216
    v_cvt_pk_bf16_f32 v216, v184, v185
    s_waitcnt lgkmcnt(3)
    v_mfma_f32_16x16x32_bf16 v[200:203], v[240:243], v[48:51], v[200:203]
    v_cvt_pk_bf16_f32 v217, v186, v187
    v_mfma_f32_16x16x32_bf16 v[204:207], v[240:243], v[52:55], v[204:207]
    ds_read_b128 v[232:235], v4 offset:10240
    v_cvt_pk_bf16_f32 v218, v192, v193
    s_waitcnt lgkmcnt(3)
    v_mfma_f32_16x16x32_bf16 v[208:211], v[244:247], v[48:51], v[208:211]
    v_cvt_pk_bf16_f32 v219, v194, v195
    v_mfma_f32_16x16x32_bf16 v[212:215], v[244:247], v[52:55], v[212:215]
    ds_read_b128 v[236:239], v4 offset:11264
    buffer_store_dwordx4 v[216:219], v2, s[8:11], s25 offen offset:0 sc1
    s_waitcnt lgkmcnt(3)
    v_mfma_f32_16x16x32_bf16 v[200:203], v[224:227], v[56:59], v[200:203]
    v_mul_f32 v188, v188, v10
    v_mfma_f32_16x16x32_bf16 v[204:207], v[224:227], v[60:63], v[204:207]
    ds_read_b128 v[240:243], v4 offset:12288
    v_mul_f32 v189, v189, v10
    s_waitcnt lgkmcnt(3)
    v_mfma_f32_16x16x32_bf16 v[208:211], v[228:231], v[56:59], v[208:211]
    v_mul_f32 v190, v190, v10
    v_mfma_f32_16x16x32_bf16 v[212:215], v[228:231], v[60:63], v[212:215]
    ds_read_b128 v[244:247], v4 offset:13312
    v_mul_f32 v191, v191, v10
    s_waitcnt lgkmcnt(3)
    v_mfma_f32_16x16x32_bf16 v[200:203], v[232:235], v[64:67], v[200:203]
    v_mul_f32 v196, v196, v10
    v_mfma_f32_16x16x32_bf16 v[204:207], v[232:235], v[68:71], v[204:207]
    ds_read_b128 v[224:227], v4 offset:14336
    v_mul_f32 v197, v197, v10
    s_waitcnt lgkmcnt(3)
    v_mfma_f32_16x16x32_bf16 v[208:211], v[236:239], v[64:67], v[208:211]
    v_mul_f32 v198, v198, v10
    v_mfma_f32_16x16x32_bf16 v[212:215], v[236:239], v[68:71], v[212:215]
    ds_read_b128 v[228:231], v4 offset:15360
    v_mul_f32 v199, v199, v10
    s_waitcnt lgkmcnt(3)
    v_mfma_f32_16x16x32_bf16 v[200:203], v[240:243], v[72:75], v[200:203]
    v_cvt_pk_bf16_f32 v220, v188, v189
    v_mfma_f32_16x16x32_bf16 v[204:207], v[240:243], v[76:79], v[204:207]
    s_waitcnt vmcnt(8)
    s_barrier
    ds_read_b128 v[232:235], v4 offset:16384
    v_cvt_pk_bf16_f32 v221, v190, v191
    s_waitcnt lgkmcnt(3)
    v_mfma_f32_16x16x32_bf16 v[208:211], v[244:247], v[72:75], v[208:211]
    v_cvt_pk_bf16_f32 v222, v196, v197
    v_mfma_f32_16x16x32_bf16 v[212:215], v[244:247], v[76:79], v[212:215]
    s_add_u32 s22, s21, 0x9c000
    s_add_u32 m0, s20, 0x24000
    s_nop 0
    buffer_load_dwordx4 v2, s[8:11], s22 offen sc1 lds
    ds_read_b128 v[236:239], v4 offset:17408
    v_cvt_pk_bf16_f32 v223, v198, v199
    s_waitcnt lgkmcnt(3)
    v_mfma_f32_16x16x32_bf16 v[200:203], v[224:227], v[80:83], v[200:203]
    buffer_store_dwordx4 v[220:223], v2, s[8:11], s26 offen offset:0 sc1
    v_mfma_f32_16x16x32_bf16 v[204:207], v[224:227], v[84:87], v[204:207]
    ds_read_b128 v[240:243], v4 offset:18432
    s_waitcnt lgkmcnt(3)
    v_mfma_f32_16x16x32_bf16 v[208:211], v[228:231], v[80:83], v[208:211]
    v_mfma_f32_16x16x32_bf16 v[212:215], v[228:231], v[84:87], v[212:215]
    ds_read_b128 v[244:247], v4 offset:19456
    s_waitcnt lgkmcnt(3)
    v_mfma_f32_16x16x32_bf16 v[200:203], v[232:235], v[88:91], v[200:203]
    v_mfma_f32_16x16x32_bf16 v[204:207], v[232:235], v[92:95], v[204:207]
    ds_read_b128 v[224:227], v4 offset:20480
    s_waitcnt lgkmcnt(3)
    v_mfma_f32_16x16x32_bf16 v[208:211], v[236:239], v[88:91], v[208:211]
    v_mfma_f32_16x16x32_bf16 v[212:215], v[236:239], v[92:95], v[212:215]
    s_add_u32 s22, s21, 0x9c400
    s_add_u32 m0, s20, 0x24400
    s_nop 0
    buffer_load_dwordx4 v2, s[8:11], s22 offen sc1 lds
    ds_read_b128 v[228:231], v4 offset:21504
    s_waitcnt lgkmcnt(3)
    v_mfma_f32_16x16x32_bf16 v[200:203], v[240:243], v[96:99], v[200:203]
    v_mfma_f32_16x16x32_bf16 v[204:207], v[240:243], v[100:103], v[204:207]
    ds_read_b128 v[232:235], v4 offset:22528
    s_waitcnt lgkmcnt(3)
    v_mfma_f32_16x16x32_bf16 v[208:211], v[244:247], v[96:99], v[208:211]
    v_mfma_f32_16x16x32_bf16 v[212:215], v[244:247], v[100:103], v[212:215]
    ds_read_b128 v[236:239], v4 offset:23552
    s_waitcnt lgkmcnt(3)
    v_mfma_f32_16x16x32_bf16 v[200:203], v[224:227], v[104:107], v[200:203]
    v_mfma_f32_16x16x32_bf16 v[204:207], v[224:227], v[108:111], v[204:207]
    ds_read_b128 v[240:243], v4 offset:24576
    s_waitcnt lgkmcnt(3)
    v_mfma_f32_16x16x32_bf16 v[208:211], v[228:231], v[104:107], v[208:211]
    v_mfma_f32_16x16x32_bf16 v[212:215], v[228:231], v[108:111], v[212:215]
    ds_read_b128 v[244:247], v4 offset:25600
    s_waitcnt lgkmcnt(3)
    v_mfma_f32_16x16x32_bf16 v[200:203], v[232:235], v[112:115], v[200:203]
    v_mfma_f32_16x16x32_bf16 v[204:207], v[232:235], v[116:119], v[204:207]
    ds_read_b128 v[224:227], v4 offset:26624
    s_waitcnt lgkmcnt(3)
    v_mfma_f32_16x16x32_bf16 v[208:211], v[236:239], v[112:115], v[208:211]
    v_mfma_f32_16x16x32_bf16 v[212:215], v[236:239], v[116:119], v[212:215]
    ds_read_b128 v[228:231], v4 offset:27648
    s_waitcnt lgkmcnt(3)
    v_mfma_f32_16x16x32_bf16 v[200:203], v[240:243], v[120:123], v[200:203]
    v_mfma_f32_16x16x32_bf16 v[204:207], v[240:243], v[124:127], v[204:207]
    ds_read_b128 v[232:235], v4 offset:28672
    s_waitcnt lgkmcnt(3)
    v_mfma_f32_16x16x32_bf16 v[208:211], v[244:247], v[120:123], v[208:211]
    v_mfma_f32_16x16x32_bf16 v[212:215], v[244:247], v[124:127], v[212:215]
    ds_read_b128 v[236:239], v4 offset:29696
    s_waitcnt lgkmcnt(3)
    v_mfma_f32_16x16x32_bf16 v[200:203], v[224:227], v[128:131], v[200:203]
    v_mfma_f32_16x16x32_bf16 v[204:207], v[224:227], v[132:135], v[204:207]
    ds_read_b128 v[240:243], v4 offset:30720
    s_waitcnt lgkmcnt(3)
    v_mfma_f32_16x16x32_bf16 v[208:211], v[228:231], v[128:131], v[208:211]
    v_mfma_f32_16x16x32_bf16 v[212:215], v[228:231], v[132:135], v[212:215]
    ds_read_b128 v[244:247], v4 offset:31744
    s_waitcnt lgkmcnt(3)
    v_mfma_f32_16x16x32_bf16 v[200:203], v[232:235], v[136:139], v[200:203]
    v_mfma_f32_16x16x32_bf16 v[204:207], v[232:235], v[140:143], v[204:207]
    s_waitcnt vmcnt(8)
    s_barrier
    ds_read_b128 v[224:227], v4 offset:32768
    s_waitcnt lgkmcnt(3)
    v_mfma_f32_16x16x32_bf16 v[208:211], v[236:239], v[136:139], v[208:211]
    v_mfma_f32_16x16x32_bf16 v[212:215], v[236:239], v[140:143], v[212:215]
    s_add_u32 s22, s24, 0x0
    s_add_u32 m0, s20, 0x10000
    s_nop 0
    buffer_load_dwordx4 v3, s[4:7], s22 offen lds
    ds_read_b128 v[228:231], v4 offset:33792
    s_waitcnt lgkmcnt(3)
    v_mfma_f32_16x16x32_bf16 v[200:203], v[240:243], v[144:147], v[200:203]
    v_mfma_f32_16x16x32_bf16 v[204:207], v[240:243], v[148:151], v[204:207]
    ds_read_b128 v[232:235], v4 offset:34816
    s_waitcnt lgkmcnt(3)
    v_mfma_f32_16x16x32_bf16 v[208:211], v[244:247], v[144:147], v[208:211]
    v_mfma_f32_16x16x32_bf16 v[212:215], v[244:247], v[148:151], v[212:215]
    ds_read_b128 v[236:239], v4 offset:35840
    s_waitcnt lgkmcnt(3)
    v_mfma_f32_16x16x32_bf16 v[184:187], v[224:227], v[24:27], 0
    v_mfma_f32_16x16x32_bf16 v[188:191], v[224:227], v[28:31], 0
    ds_read_b128 v[240:243], v4 offset:36864
    s_waitcnt lgkmcnt(3)
    v_mfma_f32_16x16x32_bf16 v[192:195], v[228:231], v[24:27], 0
    v_mfma_f32_16x16x32_bf16 v[196:199], v[228:231], v[28:31], 0
    s_add_u32 s22, s24, 0x2000
    s_add_u32 m0, s20, 0x10400
    s_nop 0
    buffer_load_dwordx4 v3, s[4:7], s22 offen lds
    ds_read_b128 v[244:247], v4 offset:37888
    v_mul_f32 v200, v200, v9
    s_waitcnt lgkmcnt(3)
    v_mfma_f32_16x16x32_bf16 v[184:187], v[232:235], v[32:35], v[184:187]
    v_mul_f32 v201, v201, v9
    v_mfma_f32_16x16x32_bf16 v[188:191], v[232:235], v[36:39], v[188:191]
    ds_read_b128 v[224:227], v4 offset:38912
    v_mul_f32 v202, v202, v9
    s_waitcnt lgkmcnt(3)
    v_mfma_f32_16x16x32_bf16 v[192:195], v[236:239], v[32:35], v[192:195]
    v_mul_f32 v203, v203, v9
    v_mfma_f32_16x16x32_bf16 v[196:199], v[236:239], v[36:39], v[196:199]
    ds_read_b128 v[228:231], v4 offset:39936
    v_mul_f32 v208, v208, v9
    s_waitcnt lgkmcnt(3)
    v_mfma_f32_16x16x32_bf16 v[184:187], v[240:243], v[40:43], v[184:187]
    v_mul_f32 v209, v209, v9
    v_mfma_f32_16x16x32_bf16 v[188:191], v[240:243], v[44:47], v[188:191]
    ds_read_b128 v[232:235], v4 offset:40960
    v_mul_f32 v210, v210, v9
    s_waitcnt lgkmcnt(3)
    v_mfma_f32_16x16x32_bf16 v[192:195], v[244:247], v[40:43], v[192:195]
    v_mul_f32 v211, v211, v9
    v_mfma_f32_16x16x32_bf16 v[196:199], v[244:247], v[44:47], v[196:199]
    ds_read_b128 v[236:239], v4 offset:41984
    v_cvt_pk_bf16_f32 v216, v200, v201
    s_waitcnt lgkmcnt(3)
    v_mfma_f32_16x16x32_bf16 v[184:187], v[224:227], v[48:51], v[184:187]
    v_cvt_pk_bf16_f32 v217, v202, v203
    s_waitcnt vmcnt(3)
    s_add_u32 s16, s63, 0x570000
    v_mov_b32 v7, s28
    v_mov_b32 v8, 0
    s_mov_b64 exec, 1
    buffer_store_dword v7, v8, s[8:11], s16 offen sc1
    s_mov_b64 exec, -1
    v_mfma_f32_16x16x32_bf16 v[188:191], v[224:227], v[52:55], v[188:191]
    ds_read_b128 v[240:243], v4 offset:43008
    v_cvt_pk_bf16_f32 v218, v208, v209
    s_waitcnt lgkmcnt(3)
    v_mfma_f32_16x16x32_bf16 v[192:195], v[228:231], v[48:51], v[192:195]
    v_cvt_pk_bf16_f32 v219, v210, v211
    v_mfma_f32_16x16x32_bf16 v[196:199], v[228:231], v[52:55], v[196:199]
    ds_read_b128 v[244:247], v4 offset:44032
    buffer_store_dwordx4 v[216:219], v2, s[8:11], s25 offen offset:1024 sc1
    s_waitcnt lgkmcnt(3)
    v_mfma_f32_16x16x32_bf16 v[184:187], v[232:235], v[56:59], v[184:187]
    v_mul_f32 v204, v204, v10
    v_mfma_f32_16x16x32_bf16 v[188:191], v[232:235], v[60:63], v[188:191]
    ds_read_b128 v[224:227], v4 offset:45056
    v_mul_f32 v205, v205, v10
    s_waitcnt lgkmcnt(3)
    v_mfma_f32_16x16x32_bf16 v[192:195], v[236:239], v[56:59], v[192:195]
    v_mul_f32 v206, v206, v10
    v_mfma_f32_16x16x32_bf16 v[196:199], v[236:239], v[60:63], v[196:199]
    ds_read_b128 v[228:231], v4 offset:46080
    v_mul_f32 v207, v207, v10
    s_waitcnt lgkmcnt(3)
    v_mfma_f32_16x16x32_bf16 v[184:187], v[240:243], v[64:67], v[184:187]
    v_mul_f32 v212, v212, v10
    v_mfma_f32_16x16x32_bf16 v[188:191], v[240:243], v[68:71], v[188:191]
    ds_read_b128 v[232:235], v4 offset:47104
    v_mul_f32 v213, v213, v10
    s_waitcnt lgkmcnt(3)
    v_mfma_f32_16x16x32_bf16 v[192:195], v[244:247], v[64:67], v[192:195]
    v_mul_f32 v214, v214, v10
    v_mfma_f32_16x16x32_bf16 v[196:199], v[244:247], v[68:71], v[196:199]
    ds_read_b128 v[236:239], v4 offset:48128
    v_mul_f32 v215, v215, v10
    s_waitcnt lgkmcnt(3)
    v_mfma_f32_16x16x32_bf16 v[184:187], v[224:227], v[72:75], v[184:187]
    v_cvt_pk_bf16_f32 v220, v204, v205
    v_mfma_f32_16x16x32_bf16 v[188:191], v[224:227], v[76:79], v[188:191]
    s_barrier
    ds_read_b128 v[240:243], v4 offset:49152
    v_cvt_pk_bf16_f32 v221, v206, v207
    s_waitcnt lgkmcnt(3)
    v_mfma_f32_16x16x32_bf16 v[192:195], v[228:231], v[72:75], v[192:195]
    v_cvt_pk_bf16_f32 v222, v212, v213
    v_mfma_f32_16x16x32_bf16 v[196:199], v[228:231], v[76:79], v[196:199]
    s_add_u32 s22, s24, 0x80000
    s_add_u32 m0, s20, 0x14000
    s_nop 0
    buffer_load_dwordx4 v3, s[4:7], s22 offen lds
    ds_read_b128 v[244:247], v4 offset:50176
    v_cvt_pk_bf16_f32 v223, v214, v215
    s_waitcnt lgkmcnt(3)
    v_mfma_f32_16x16x32_bf16 v[184:187], v[232:235], v[80:83], v[184:187]
    buffer_store_dwordx4 v[220:223], v2, s[8:11], s26 offen offset:1024 sc1
    v_mfma_f32_16x16x32_bf16 v[188:191], v[232:235], v[84:87], v[188:191]
    ds_read_b128 v[224:227], v4 offset:51200
    s_waitcnt lgkmcnt(3)
    v_mfma_f32_16x16x32_bf16 v[192:195], v[236:239], v[80:83], v[192:195]
    v_mfma_f32_16x16x32_bf16 v[196:199], v[236:239], v[84:87], v[196:199]
    ds_read_b128 v[228:231], v4 offset:52224
    s_waitcnt lgkmcnt(3)
    v_mfma_f32_16x16x32_bf16 v[184:187], v[240:243], v[88:91], v[184:187]
    v_mfma_f32_16x16x32_bf16 v[188:191], v[240:243], v[92:95], v[188:191]
    ds_read_b128 v[232:235], v4 offset:53248
    s_waitcnt lgkmcnt(3)
    v_mfma_f32_16x16x32_bf16 v[192:195], v[244:247], v[88:91], v[192:195]
    v_mfma_f32_16x16x32_bf16 v[196:199], v[244:247], v[92:95], v[196:199]
    s_add_u32 s22, s24, 0x82000
    s_add_u32 m0, s20, 0x14400
    s_nop 0
    buffer_load_dwordx4 v3, s[4:7], s22 offen lds
    ds_read_b128 v[236:239], v4 offset:54272
    s_waitcnt lgkmcnt(3)
    v_mfma_f32_16x16x32_bf16 v[184:187], v[224:227], v[96:99], v[184:187]
    v_mfma_f32_16x16x32_bf16 v[188:191], v[224:227], v[100:103], v[188:191]
    ds_read_b128 v[240:243], v4 offset:55296
    s_waitcnt lgkmcnt(3)
    v_mfma_f32_16x16x32_bf16 v[192:195], v[228:231], v[96:99], v[192:195]
    v_mfma_f32_16x16x32_bf16 v[196:199], v[228:231], v[100:103], v[196:199]
    ds_read_b128 v[244:247], v4 offset:56320
    s_waitcnt lgkmcnt(3)
    v_mfma_f32_16x16x32_bf16 v[184:187], v[232:235], v[104:107], v[184:187]
    v_mfma_f32_16x16x32_bf16 v[188:191], v[232:235], v[108:111], v[188:191]
    ds_read_b128 v[224:227], v4 offset:57344
    s_waitcnt lgkmcnt(3)
    v_mfma_f32_16x16x32_bf16 v[192:195], v[236:239], v[104:107], v[192:195]
    v_mfma_f32_16x16x32_bf16 v[196:199], v[236:239], v[108:111], v[196:199]
    ds_read_b128 v[228:231], v4 offset:58368
    s_waitcnt lgkmcnt(3)
    v_mfma_f32_16x16x32_bf16 v[184:187], v[240:243], v[112:115], v[184:187]
    v_mfma_f32_16x16x32_bf16 v[188:191], v[240:243], v[116:119], v[188:191]
    ds_read_b128 v[232:235], v4 offset:59392
    s_waitcnt lgkmcnt(3)
    v_mfma_f32_16x16x32_bf16 v[192:195], v[244:247], v[112:115], v[192:195]
    v_mfma_f32_16x16x32_bf16 v[196:199], v[244:247], v[116:119], v[196:199]
    ds_read_b128 v[236:239], v4 offset:60416
    s_waitcnt lgkmcnt(3)
    v_mfma_f32_16x16x32_bf16 v[184:187], v[224:227], v[120:123], v[184:187]
    v_mfma_f32_16x16x32_bf16 v[188:191], v[224:227], v[124:127], v[188:191]
    ds_read_b128 v[240:243], v4 offset:61440
    s_waitcnt lgkmcnt(3)
    v_mfma_f32_16x16x32_bf16 v[192:195], v[228:231], v[120:123], v[192:195]
    v_mfma_f32_16x16x32_bf16 v[196:199], v[228:231], v[124:127], v[196:199]
    ds_read_b128 v[244:247], v4 offset:62464
    s_waitcnt lgkmcnt(3)
    v_mfma_f32_16x16x32_bf16 v[184:187], v[232:235], v[128:131], v[184:187]
    v_mfma_f32_16x16x32_bf16 v[188:191], v[232:235], v[132:135], v[188:191]
    ds_read_b128 v[224:227], v4 offset:63488
    s_waitcnt lgkmcnt(3)
    v_mfma_f32_16x16x32_bf16 v[192:195], v[236:239], v[128:131], v[192:195]
    v_mfma_f32_16x16x32_bf16 v[196:199], v[236:239], v[132:135], v[196:199]
    ds_read_b128 v[228:231], v4 offset:64512
    s_waitcnt lgkmcnt(3)
    v_mfma_f32_16x16x32_bf16 v[184:187], v[240:243], v[136:139], v[184:187]
    v_mfma_f32_16x16x32_bf16 v[188:191], v[240:243], v[140:143], v[188:191]
    s_barrier
    ds_read_b128 v[232:235], v5 offset:0
    s_waitcnt lgkmcnt(3)
    v_mfma_f32_16x16x32_bf16 v[192:195], v[244:247], v[136:139], v[192:195]
    v_mfma_f32_16x16x32_bf16 v[196:199], v[244:247], v[140:143], v[196:199]
    s_add_u32 s22, s24, 0x100000
    s_add_u32 m0, s20, 0x18000
    s_nop 0
    buffer_load_dwordx4 v3, s[4:7], s22 offen lds
    ds_read_b128 v[236:239], v5 offset:1024
    s_waitcnt lgkmcnt(3)
    v_mfma_f32_16x16x32_bf16 v[184:187], v[224:227], v[144:147], v[184:187]
    v_mfma_f32_16x16x32_bf16 v[188:191], v[224:227], v[148:151], v[188:191]
    ds_read_b128 v[240:243], v5 offset:2048
    s_waitcnt lgkmcnt(3)
    v_mfma_f32_16x16x32_bf16 v[192:195], v[228:231], v[144:147], v[192:195]
    v_mfma_f32_16x16x32_bf16 v[196:199], v[228:231], v[148:151], v[196:199]
    ds_read_b128 v[244:247], v5 offset:3072
    s_waitcnt lgkmcnt(3)
    v_mfma_f32_16x16x32_bf16 v[200:203], v[232:235], v[24:27], 0
    v_mfma_f32_16x16x32_bf16 v[204:207], v[232:235], v[28:31], 0
    ds_read_b128 v[224:227], v5 offset:4096
    s_waitcnt lgkmcnt(3)
    v_mfma_f32_16x16x32_bf16 v[208:211], v[236:239], v[24:27], 0
    v_mfma_f32_16x16x32_bf16 v[212:215], v[236:239], v[28:31], 0
    s_add_u32 s22, s24, 0x102000
    s_add_u32 m0, s20, 0x18400
    s_nop 0
    buffer_load_dwordx4 v3, s[4:7], s22 offen lds
    ds_read_b128 v[228:231], v5 offset:5120
    v_mul_f32 v184, v184, v9
    s_waitcnt lgkmcnt(3)
    v_mfma_f32_16x16x32_bf16 v[200:203], v[240:243], v[32:35], v[200:203]
    v_mul_f32 v185, v185, v9
    s_bfe_u32 s30, s2, 0x20001
    s_lshl_b32 s30, s30, 2
    s_bfe_u32 s17, s2, 0x20003
    s_add_u32 s30, s30, s17
    s_lshr_b32 s31, s2, 5
    s_and_b32 s17, s3, 3
    s_lshl_b32 s19, s30, 2
    s_add_u32 s19, s19, s17
    s_and_b32 s16, s2, 1
    s_lshl_b32 s17, s19, 18
    s_lshl_b32 s23, s16, 16
    s_add_u32 s17, s17, s23
    s_add_u32 s17, s17, 0x1001000
    v_add_u32 v6, s17, v2
    s_lshl_b32 s19, s19, 7
    s_lshl_b32 s23, s16, 6
    s_add_u32 s19, s19, s23
    s_add_u32 s19, s19, 0x570000
    v_and_b32 v13, 15, v1
    v_lshlrev_b32 v13, 2, v13
    buffer_load_dword v12, v13, s[8:11], s19 offen sc1
    v_mfma_f32_16x16x32_bf16 v[204:207], v[240:243], v[36:39], v[204:207]
    ds_read_b128 v[232:235], v5 offset:6144
    v_mul_f32 v186, v186, v9
    s_waitcnt lgkmcnt(3)
    v_mfma_f32_16x16x32_bf16 v[208:211], v[244:247], v[32:35], v[208:211]
    v_mul_f32 v187, v187, v9
    v_mfma_f32_16x16x32_bf16 v[212:215], v[244:247], v[36:39], v[212:215]
    ds_read_b128 v[236:239], v5 offset:7168
    v_mul_f32 v192, v192, v9
    s_waitcnt lgkmcnt(3)
    v_mfma_f32_16x16x32_bf16 v[200:203], v[224:227], v[40:43], v[200:203]
    v_mul_f32 v193, v193, v9
    v_mfma_f32_16x16x32_bf16 v[204:207], v[224:227], v[44:47], v[204:207]
    ds_read_b128 v[240:243], v5 offset:8192
    v_mul_f32 v194, v194, v9
    s_waitcnt lgkmcnt(3)
    v_mfma_f32_16x16x32_bf16 v[208:211], v[228:231], v[40:43], v[208:211]
    v_mul_f32 v195, v195, v9
    v_mfma_f32_16x16x32_bf16 v[212:215], v[228:231], v[44:47], v[212:215]
    ds_read_b128 v[244:247], v5 offset:9216
    v_cvt_pk_bf16_f32 v216, v184, v185
    s_waitcnt lgkmcnt(3)
    v_mfma_f32_16x16x32_bf16 v[200:203], v[232:235], v[48:51], v[200:203]
    v_cvt_pk_bf16_f32 v217, v186, v187
    v_mfma_f32_16x16x32_bf16 v[204:207], v[232:235], v[52:55], v[204:207]
    ds_read_b128 v[224:227], v5 offset:10240
    v_cvt_pk_bf16_f32 v218, v192, v193
    s_waitcnt lgkmcnt(3)
    v_mfma_f32_16x16x32_bf16 v[208:211], v[236:239], v[48:51], v[208:211]
    v_cvt_pk_bf16_f32 v219, v194, v195
    v_mfma_f32_16x16x32_bf16 v[212:215], v[236:239], v[52:55], v[212:215]
    ds_read_b128 v[228:231], v5 offset:11264
    buffer_store_dwordx4 v[216:219], v2, s[8:11], s25 offen offset:2048 sc1
    s_waitcnt lgkmcnt(3)
    v_mfma_f32_16x16x32_bf16 v[200:203], v[240:243], v[56:59], v[200:203]
    v_mul_f32 v188, v188, v10
    v_mfma_f32_16x16x32_bf16 v[204:207], v[240:243], v[60:63], v[204:207]
    ds_read_b128 v[232:235], v5 offset:12288
    v_mul_f32 v189, v189, v10
    s_waitcnt lgkmcnt(3)
    v_mfma_f32_16x16x32_bf16 v[208:211], v[244:247], v[56:59], v[208:211]
    v_mul_f32 v190, v190, v10
    v_mfma_f32_16x16x32_bf16 v[212:215], v[244:247], v[60:63], v[212:215]
    ds_read_b128 v[236:239], v5 offset:13312
    v_mul_f32 v191, v191, v10
    s_waitcnt lgkmcnt(3)
    v_mfma_f32_16x16x32_bf16 v[200:203], v[224:227], v[64:67], v[200:203]
    v_mul_f32 v196, v196, v10
    v_mfma_f32_16x16x32_bf16 v[204:207], v[224:227], v[68:71], v[204:207]
    ds_read_b128 v[240:243], v5 offset:14336
    v_mul_f32 v197, v197, v10
    s_waitcnt lgkmcnt(3)
    v_mfma_f32_16x16x32_bf16 v[208:211], v[228:231], v[64:67], v[208:211]
    v_mul_f32 v198, v198, v10
    v_mfma_f32_16x16x32_bf16 v[212:215], v[228:231], v[68:71], v[212:215]
    ds_read_b128 v[244:247], v5 offset:15360
    v_mul_f32 v199, v199, v10
    s_waitcnt lgkmcnt(3)
    v_mfma_f32_16x16x32_bf16 v[200:203], v[232:235], v[72:75], v[200:203]
    v_cvt_pk_bf16_f32 v220, v188, v189
    v_mfma_f32_16x16x32_bf16 v[204:207], v[232:235], v[76:79], v[204:207]
    s_waitcnt vmcnt(11)
    s_barrier
    ds_read_b128 v[224:227], v5 offset:16384
    v_cvt_pk_bf16_f32 v221, v190, v191
    s_waitcnt lgkmcnt(3)
    v_mfma_f32_16x16x32_bf16 v[208:211], v[236:239], v[72:75], v[208:211]
    v_cvt_pk_bf16_f32 v222, v196, v197
    v_mfma_f32_16x16x32_bf16 v[212:215], v[236:239], v[76:79], v[212:215]
    s_add_u32 s22, s24, 0x180000
    s_add_u32 m0, s20, 0x1c000
    s_nop 0
    buffer_load_dwordx4 v3, s[4:7], s22 offen lds
    ds_read_b128 v[228:231], v5 offset:17408
    v_cvt_pk_bf16_f32 v223, v198, v199
    s_waitcnt lgkmcnt(3)
    v_mfma_f32_16x16x32_bf16 v[200:203], v[240:243], v[80:83], v[200:203]
    buffer_store_dwordx4 v[220:223], v2, s[8:11], s26 offen offset:2048 sc1
    v_mfma_f32_16x16x32_bf16 v[204:207], v[240:243], v[84:87], v[204:207]
    ds_read_b128 v[232:235], v5 offset:18432
    s_waitcnt lgkmcnt(3)
    v_mfma_f32_16x16x32_bf16 v[208:211], v[244:247], v[80:83], v[208:211]
    v_mfma_f32_16x16x32_bf16 v[212:215], v[244:247], v[84:87], v[212:215]
    ds_read_b128 v[236:239], v5 offset:19456
    s_waitcnt lgkmcnt(3)
    v_mfma_f32_16x16x32_bf16 v[200:203], v[224:227], v[88:91], v[200:203]
    v_mfma_f32_16x16x32_bf16 v[204:207], v[224:227], v[92:95], v[204:207]
    ds_read_b128 v[240:243], v5 offset:20480
    s_waitcnt vmcnt(3)
    v_cmp_ne_u32 vcc, s28, v12
    s_cbranch_vccnz adaLN_cond__sliding_block_cached__moe_arch_mod__prompt_kernel_o17r
adaLN_cond__sliding_block_cached__moe_arch_mod__prompt_kernel_o17b:
    s_waitcnt lgkmcnt(3)
    v_mfma_f32_16x16x32_bf16 v[208:211], v[228:231], v[88:91], v[208:211]
    s_mov_b32 s23, 0x0
    buffer_load_dwordx4 v[24:27], v6, s[8:11], s23 offen offset:0 sc1
    v_mfma_f32_16x16x32_bf16 v[212:215], v[228:231], v[92:95], v[212:215]
    s_add_u32 s22, s24, 0x182000
    s_add_u32 m0, s20, 0x1c400
    s_nop 0
    buffer_load_dwordx4 v3, s[4:7], s22 offen lds
    ds_read_b128 v[244:247], v5 offset:21504
    s_waitcnt lgkmcnt(3)
    v_mfma_f32_16x16x32_bf16 v[200:203], v[232:235], v[96:99], v[200:203]
    v_mfma_f32_16x16x32_bf16 v[204:207], v[232:235], v[100:103], v[204:207]
    ds_read_b128 v[224:227], v5 offset:22528
    s_mov_b32 s23, 0x20000
    buffer_load_dwordx4 v[28:31], v6, s[8:11], s23 offen offset:0 sc1
    s_waitcnt lgkmcnt(3)
    v_mfma_f32_16x16x32_bf16 v[208:211], v[236:239], v[96:99], v[208:211]
    s_add_u32 s16, s63, 0x572000
    v_mov_b32 v14, s28
    v_mov_b32 v15, 0
    s_mov_b64 exec, 1
    buffer_store_dword v14, v15, s[8:11], s16 offen sc1
    s_mov_b64 exec, -1
    v_mfma_f32_16x16x32_bf16 v[212:215], v[236:239], v[100:103], v[212:215]
    ds_read_b128 v[228:231], v5 offset:23552
    s_waitcnt lgkmcnt(3)
    v_mfma_f32_16x16x32_bf16 v[200:203], v[240:243], v[104:107], v[200:203]
    v_mfma_f32_16x16x32_bf16 v[204:207], v[240:243], v[108:111], v[204:207]
    ds_read_b128 v[232:235], v5 offset:24576
    s_mov_b32 s23, 0x2000
    buffer_load_dwordx4 v[32:35], v6, s[8:11], s23 offen offset:0 sc1
    s_waitcnt lgkmcnt(3)
    v_mfma_f32_16x16x32_bf16 v[208:211], v[244:247], v[104:107], v[208:211]
    v_mfma_f32_16x16x32_bf16 v[212:215], v[244:247], v[108:111], v[212:215]
    ds_read_b128 v[236:239], v5 offset:25600
    s_waitcnt lgkmcnt(3)
    v_mfma_f32_16x16x32_bf16 v[200:203], v[224:227], v[112:115], v[200:203]
    s_mov_b32 s23, 0x22000
    buffer_load_dwordx4 v[36:39], v6, s[8:11], s23 offen offset:0 sc1
    v_mfma_f32_16x16x32_bf16 v[204:207], v[224:227], v[116:119], v[204:207]
    ds_read_b128 v[240:243], v5 offset:26624
    s_waitcnt lgkmcnt(3)
    v_mfma_f32_16x16x32_bf16 v[208:211], v[228:231], v[112:115], v[208:211]
    v_mfma_f32_16x16x32_bf16 v[212:215], v[228:231], v[116:119], v[212:215]
    ds_read_b128 v[244:247], v5 offset:27648
    s_waitcnt lgkmcnt(3)
    v_mfma_f32_16x16x32_bf16 v[200:203], v[232:235], v[120:123], v[200:203]
    s_mov_b32 s23, 0x4000
    buffer_load_dwordx4 v[40:43], v6, s[8:11], s23 offen offset:0 sc1
    v_mfma_f32_16x16x32_bf16 v[204:207], v[232:235], v[124:127], v[204:207]
    ds_read_b128 v[224:227], v5 offset:28672
    s_waitcnt lgkmcnt(3)
    v_mfma_f32_16x16x32_bf16 v[208:211], v[236:239], v[120:123], v[208:211]
    v_mfma_f32_16x16x32_bf16 v[212:215], v[236:239], v[124:127], v[212:215]
    ds_read_b128 v[228:231], v5 offset:29696
    s_waitcnt lgkmcnt(3)
    v_mfma_f32_16x16x32_bf16 v[200:203], v[240:243], v[128:131], v[200:203]
    s_mov_b32 s23, 0x24000
    buffer_load_dwordx4 v[44:47], v6, s[8:11], s23 offen offset:0 sc1
    v_mfma_f32_16x16x32_bf16 v[204:207], v[240:243], v[132:135], v[204:207]
    ds_read_b128 v[232:235], v5 offset:30720
    s_waitcnt lgkmcnt(3)
    v_mfma_f32_16x16x32_bf16 v[208:211], v[244:247], v[128:131], v[208:211]
    v_mfma_f32_16x16x32_bf16 v[212:215], v[244:247], v[132:135], v[212:215]
    ds_read_b128 v[236:239], v5 offset:31744
    s_mov_b32 s23, 0x6000
    buffer_load_dwordx4 v[48:51], v6, s[8:11], s23 offen offset:0 sc1
    s_waitcnt lgkmcnt(3)
    v_mfma_f32_16x16x32_bf16 v[200:203], v[224:227], v[136:139], v[200:203]
    v_bfe_u32 v18, v1, 2, 2
    v_lshrrev_b32 v19, 4, v1
    v_mfma_f32_16x16x32_bf16 v[204:207], v[224:227], v[140:143], v[204:207]
    v_and_b32 v17, 3, v1
    v_lshlrev_b32 v16, 11, v19
    s_waitcnt lgkmcnt(2)
    v_mfma_f32_16x16x32_bf16 v[208:211], v[228:231], v[136:139], v[208:211]
    v_lshl_add_u32 v16, v18, 6, v16
    v_lshl_add_u32 v16, v17, 3, v16
    v_mfma_f32_16x16x32_bf16 v[212:215], v[228:231], v[140:143], v[212:215]
    s_mov_b32 s23, 0x26000
    buffer_load_dwordx4 v[52:55], v6, s[8:11], s23 offen offset:0 sc1
    v_add_u32 v16, 0x12000, v16
    v_and_b32 v19, 1, v19
    s_waitcnt lgkmcnt(1)
    v_mfma_f32_16x16x32_bf16 v[200:203], v[232:235], v[144:147], v[200:203]
    v_lshlrev_b32 v19, 5, v19
    v_sub_u32 v5, v16, v19
    v_mfma_f32_16x16x32_bf16 v[204:207], v[232:235], v[148:151], v[204:207]
    v_add_u32 v4, v16, v19
    v_add_u32 v7, 0x10000, v4
    s_waitcnt lgkmcnt(0)
    v_mfma_f32_16x16x32_bf16 v[208:211], v[236:239], v[144:147], v[208:211]
    v_add_u32 v8, 0x10000, v5
    v_mfma_f32_16x16x32_bf16 v[212:215], v[236:239], v[148:151], v[212:215]
    v_mul_f32 v200, v200, v9
    v_mul_f32 v201, v201, v9
    v_mul_f32 v202, v202, v9
    v_mul_f32 v203, v203, v9
    s_nop 1
    v_mul_f32 v208, v208, v9
    v_mul_f32 v209, v209, v9
    v_mul_f32 v210, v210, v9
    v_mul_f32 v211, v211, v9
    v_cvt_pk_bf16_f32 v216, v200, v201
    v_cvt_pk_bf16_f32 v217, v202, v203
    v_cvt_pk_bf16_f32 v218, v208, v209
    v_cvt_pk_bf16_f32 v219, v210, v211
    buffer_store_dwordx4 v[216:219], v2, s[8:11], s25 offen offset:3072 sc1
    v_mul_f32 v204, v204, v10
    v_mul_f32 v205, v205, v10
    v_mul_f32 v206, v206, v10
    v_mul_f32 v207, v207, v10
    v_mul_f32 v212, v212, v10
    v_mul_f32 v213, v213, v10
    v_mul_f32 v214, v214, v10
    v_mul_f32 v215, v215, v10
    v_cvt_pk_bf16_f32 v220, v204, v205
    v_cvt_pk_bf16_f32 v221, v206, v207
    v_cvt_pk_bf16_f32 v222, v212, v213
    v_cvt_pk_bf16_f32 v223, v214, v215
    buffer_store_dwordx4 v[220:223], v2, s[8:11], s26 offen offset:3072 sc1
    s_and_b32 s15, s2, 1
    s_barrier
    ds_read_b64_tr_b16 v[224:225], v4 offset:0
    ds_read_b64_tr_b16 v[226:227], v4 offset:1024
    ds_read_b64_tr_b16 v[228:229], v5 offset:32
    ds_read_b64_tr_b16 v[230:231], v5 offset:1056
    ds_read_b64_tr_b16 v[232:233], v4 offset:256
    ds_read_b64_tr_b16 v[234:235], v4 offset:1280
    ds_read_b64_tr_b16 v[236:237], v5 offset:288
    ds_read_b64_tr_b16 v[238:239], v5 offset:1312
    s_waitcnt vmcnt(11) lgkmcnt(6)
    v_mfma_f32_16x16x32_bf16 v[88:91], v[224:227], v[24:27], 0
    ds_read_b64_tr_b16 v[240:241], v4 offset:512
    s_waitcnt vmcnt(9)
    v_mfma_f32_16x16x32_bf16 v[92:95], v[224:227], v[28:31], 0
    ds_read_b64_tr_b16 v[242:243], v4 offset:1536
    s_waitcnt lgkmcnt(6)
    v_mfma_f32_16x16x32_bf16 v[96:99], v[228:231], v[24:27], 0
    ds_read_b64_tr_b16 v[244:245], v5 offset:544
    v_mfma_f32_16x16x32_bf16 v[100:103], v[228:231], v[28:31], 0
    ds_read_b64_tr_b16 v[246:247], v5 offset:1568
    s_waitcnt lgkmcnt(6)
    v_mfma_f32_16x16x32_bf16 v[104:107], v[232:235], v[24:27], 0
    ds_read_b64_tr_b16 v[224:225], v4 offset:768
    v_mfma_f32_16x16x32_bf16 v[108:111], v[232:235], v[28:31], 0
    ds_read_b64_tr_b16 v[226:227], v4 offset:1792
    s_waitcnt lgkmcnt(6)
    v_mfma_f32_16x16x32_bf16 v[112:115], v[236:239], v[24:27], 0
    ds_read_b64_tr_b16 v[228:229], v5 offset:800
    v_mfma_f32_16x16x32_bf16 v[116:119], v[236:239], v[28:31], 0
    ds_read_b64_tr_b16 v[230:231], v5 offset:1824
    s_waitcnt lgkmcnt(6)
    v_mfma_f32_16x16x32_bf16 v[120:123], v[240:243], v[24:27], 0
    s_add_u32 s22, s24, 0x200000
    s_add_u32 m0, s20, 0x20000
    s_nop 0
    buffer_load_dwordx4 v3, s[4:7], s22 offen lds
    v_mfma_f32_16x16x32_bf16 v[124:127], v[240:243], v[28:31], 0
    s_barrier
    ds_read_b64_tr_b16 v[232:233], v4 offset:16384
    ds_read_b64_tr_b16 v[234:235], v4 offset:17408
    s_waitcnt lgkmcnt(6)
    v_mfma_f32_16x16x32_bf16 v[128:131], v[244:247], v[24:27], 0
    ds_read_b64_tr_b16 v[236:237], v5 offset:16416
    s_mov_b32 s23, 0x8000
    buffer_load_dwordx4 v[56:59], v6, s[8:11], s23 offen offset:0 sc1
    v_mfma_f32_16x16x32_bf16 v[132:135], v[244:247], v[28:31], 0
    s_add_u32 s22, s24, 0x202000
    s_add_u32 m0, s20, 0x20400
    s_nop 0
    buffer_load_dwordx4 v3, s[4:7], s22 offen lds
    ds_read_b64_tr_b16 v[238:239], v5 offset:17440
    s_waitcnt lgkmcnt(6)
    v_mfma_f32_16x16x32_bf16 v[136:139], v[224:227], v[24:27], 0
    ds_read_b64_tr_b16 v[240:241], v4 offset:16640
    v_mfma_f32_16x16x32_bf16 v[140:143], v[224:227], v[28:31], 0
    ds_read_b64_tr_b16 v[242:243], v4 offset:17664
    s_mov_b32 s23, 0x28000
    buffer_load_dwordx4 v[60:63], v6, s[8:11], s23 offen offset:0 sc1
    s_waitcnt lgkmcnt(6)
    v_mfma_f32_16x16x32_bf16 v[144:147], v[228:231], v[24:27], 0
    ds_read_b64_tr_b16 v[244:245], v5 offset:16672
    v_mfma_f32_16x16x32_bf16 v[148:151], v[228:231], v[28:31], 0
    ds_read_b64_tr_b16 v[246:247], v5 offset:17696
    s_waitcnt vmcnt(11) lgkmcnt(6)
    v_mfma_f32_16x16x32_bf16 v[88:91], v[232:235], v[32:35], v[88:91]
    ds_read_b64_tr_b16 v[224:225], v4 offset:16896
    s_waitcnt vmcnt(10)
    v_mfma_f32_16x16x32_bf16 v[92:95], v[232:235], v[36:39], v[92:95]
    s_add_u32 s22, s24, 0x280000
    s_add_u32 m0, s20, 0x24000
    s_nop 0
    buffer_load_dwordx4 v3, s[4:7], s22 offen lds
    ds_read_b64_tr_b16 v[226:227], v4 offset:17920
    s_waitcnt lgkmcnt(6)
    v_mfma_f32_16x16x32_bf16 v[96:99], v[236:239], v[32:35], v[96:99]
    ds_read_b64_tr_b16 v[228:229], v5 offset:16928
    v_mfma_f32_16x16x32_bf16 v[100:103], v[236:239], v[36:39], v[100:103]
    ds_read_b64_tr_b16 v[230:231], v5 offset:17952
    s_waitcnt lgkmcnt(6)
    v_mfma_f32_16x16x32_bf16 v[104:107], v[240:243], v[32:35], v[104:107]
    s_add_u32 s22, s24, 0x282000
    s_add_u32 m0, s20, 0x24400
    s_nop 0
    buffer_load_dwordx4 v3, s[4:7], s22 offen lds
    ds_read_b64_tr_b16 v[232:233], v4 offset:17152
    v_mfma_f32_16x16x32_bf16 v[108:111], v[240:243], v[36:39], v[108:111]
    ds_read_b64_tr_b16 v[234:235], v4 offset:18176
    s_waitcnt lgkmcnt(6)
    v_mfma_f32_16x16x32_bf16 v[112:115], v[244:247], v[32:35], v[112:115]
    ds_read_b64_tr_b16 v[236:237], v5 offset:17184
    v_mfma_f32_16x16x32_bf16 v[116:119], v[244:247], v[36:39], v[116:119]
    ds_read_b64_tr_b16 v[238:239], v5 offset:18208
    s_waitcnt lgkmcnt(6)
    v_mfma_f32_16x16x32_bf16 v[120:123], v[224:227], v[32:35], v[120:123]
    v_mfma_f32_16x16x32_bf16 v[124:127], v[224:227], v[36:39], v[124:127]
    s_barrier
    ds_read_b64_tr_b16 v[240:241], v4 offset:32768
    ds_read_b64_tr_b16 v[242:243], v4 offset:33792
    s_waitcnt lgkmcnt(6)
    v_mfma_f32_16x16x32_bf16 v[128:131], v[228:231], v[32:35], v[128:131]
    ds_read_b64_tr_b16 v[244:245], v5 offset:32800
    s_mov_b32 s23, 0xa000
    buffer_load_dwordx4 v[24:27], v6, s[8:11], s23 offen offset:0 sc1
    v_mfma_f32_16x16x32_bf16 v[132:135], v[228:231], v[36:39], v[132:135]
    ds_read_b64_tr_b16 v[246:247], v5 offset:33824
    s_waitcnt lgkmcnt(6)
    v_mfma_f32_16x16x32_bf16 v[136:139], v[232:235], v[32:35], v[136:139]
    ds_read_b64_tr_b16 v[224:225], v4 offset:33024
    v_mfma_f32_16x16x32_bf16 v[140:143], v[232:235], v[36:39], v[140:143]
    ds_read_b64_tr_b16 v[226:227], v4 offset:34048
    s_mov_b32 s23, 0x2a000
    buffer_load_dwordx4 v[28:31], v6, s[8:11], s23 offen offset:0 sc1
    s_waitcnt lgkmcnt(6)
    v_mfma_f32_16x16x32_bf16 v[144:147], v[236:239], v[32:35], v[144:147]
    s_add_u32 s16, s63, 0x574000
    v_mov_b32 v14, s28
    v_mov_b32 v15, 0
    s_mov_b64 exec, 1
    buffer_store_dword v14, v15, s[8:11], s16 offen sc1
    s_mov_b64 exec, -1
    ds_read_b64_tr_b16 v[228:229], v5 offset:33056
    v_mfma_f32_16x16x32_bf16 v[148:151], v[236:239], v[36:39], v[148:151]
    ds_read_b64_tr_b16 v[230:231], v5 offset:34080
    s_waitcnt vmcnt(14) lgkmcnt(6)
    v_mfma_f32_16x16x32_bf16 v[88:91], v[240:243], v[40:43], v[88:91]
    ds_read_b64_tr_b16 v[232:233], v4 offset:33280
    s_waitcnt vmcnt(13)
    v_mfma_f32_16x16x32_bf16 v[92:95], v[240:243], v[44:47], v[92:95]
    s_add_u32 s22, s24, 0x300000
    s_add_u32 m0, s20, 0x10000
    s_nop 0
    buffer_load_dwordx4 v3, s[4:7], s22 offen lds
    ds_read_b64_tr_b16 v[234:235], v4 offset:34304
    s_waitcnt lgkmcnt(6)
    v_mfma_f32_16x16x32_bf16 v[96:99], v[244:247], v[40:43], v[96:99]
    ds_read_b64_tr_b16 v[236:237], v5 offset:33312
    v_mfma_f32_16x16x32_bf16 v[100:103], v[244:247], v[44:47], v[100:103]
    ds_read_b64_tr_b16 v[238:239], v5 offset:34336
    s_waitcnt lgkmcnt(6)
    v_mfma_f32_16x16x32_bf16 v[104:107], v[224:227], v[40:43], v[104:107]
    s_add_u32 s22, s24, 0x302000
    s_add_u32 m0, s20, 0x10400
    s_nop 0
    buffer_load_dwordx4 v3, s[4:7], s22 offen lds
    ds_read_b64_tr_b16 v[240:241], v4 offset:33536
    v_mfma_f32_16x16x32_bf16 v[108:111], v[224:227], v[44:47], v[108:111]
    ds_read_b64_tr_b16 v[242:243], v4 offset:34560
    s_waitcnt lgkmcnt(6)
    v_mfma_f32_16x16x32_bf16 v[112:115], v[228:231], v[40:43], v[112:115]
    ds_read_b64_tr_b16 v[244:245], v5 offset:33568
    v_mfma_f32_16x16x32_bf16 v[116:119], v[228:231], v[44:47], v[116:119]
    ds_read_b64_tr_b16 v[246:247], v5 offset:34592
    s_waitcnt lgkmcnt(6)
    v_mfma_f32_16x16x32_bf16 v[120:123], v[232:235], v[40:43], v[120:123]
    v_mfma_f32_16x16x32_bf16 v[124:127], v[232:235], v[44:47], v[124:127]
    s_barrier
    ds_read_b64_tr_b16 v[224:225], v4 offset:49152
    ds_read_b64_tr_b16 v[226:227], v4 offset:50176
    s_add_u32 s19, s19, 8192
    buffer_load_dword v12, v13, s[8:11], s19 offen sc1
    s_waitcnt lgkmcnt(6)
    v_mfma_f32_16x16x32_bf16 v[128:131], v[236:239], v[40:43], v[128:131]
    ds_read_b64_tr_b16 v[228:229], v5 offset:49184
    s_mov_b32 s23, 0xc000
    buffer_load_dwordx4 v[32:35], v6, s[8:11], s23 offen offset:0 sc1
    v_mfma_f32_16x16x32_bf16 v[132:135], v[236:239], v[44:47], v[132:135]
    ds_read_b64_tr_b16 v[230:231], v5 offset:50208
    s_waitcnt lgkmcnt(6)
    v_mfma_f32_16x16x32_bf16 v[136:139], v[240:243], v[40:43], v[136:139]
    ds_read_b64_tr_b16 v[232:233], v4 offset:49408
    v_mfma_f32_16x16x32_bf16 v[140:143], v[240:243], v[44:47], v[140:143]
    ds_read_b64_tr_b16 v[234:235], v4 offset:50432
    s_mov_b32 s23, 0x2c000
    buffer_load_dwordx4 v[36:39], v6, s[8:11], s23 offen offset:0 sc1
    s_waitcnt lgkmcnt(6)
    v_mfma_f32_16x16x32_bf16 v[144:147], v[244:247], v[40:43], v[144:147]
    ds_read_b64_tr_b16 v[236:237], v5 offset:49440
    v_mfma_f32_16x16x32_bf16 v[148:151], v[244:247], v[44:47], v[148:151]
    ds_read_b64_tr_b16 v[238:239], v5 offset:50464
    s_waitcnt vmcnt(17) lgkmcnt(6)
    v_mfma_f32_16x16x32_bf16 v[88:91], v[224:227], v[48:51], v[88:91]
    ds_read_b64_tr_b16 v[240:241], v4 offset:49664
    s_waitcnt vmcnt(16)
    v_mfma_f32_16x16x32_bf16 v[92:95], v[224:227], v[52:55], v[92:95]
    s_add_u32 s22, s24, 0x380000
    s_add_u32 m0, s20, 0x14000
    s_nop 0
    buffer_load_dwordx4 v3, s[4:7], s22 offen lds
    ds_read_b64_tr_b16 v[242:243], v4 offset:50688
    s_waitcnt lgkmcnt(6)
    v_mfma_f32_16x16x32_bf16 v[96:99], v[228:231], v[48:51], v[96:99]
    ds_read_b64_tr_b16 v[244:245], v5 offset:49696
    v_mfma_f32_16x16x32_bf16 v[100:103], v[228:231], v[52:55], v[100:103]
    ds_read_b64_tr_b16 v[246:247], v5 offset:50720
    s_waitcnt lgkmcnt(6)
    v_mfma_f32_16x16x32_bf16 v[104:107], v[232:235], v[48:51], v[104:107]
    s_add_u32 s22, s24, 0x382000
    s_add_u32 m0, s20, 0x14400
    s_nop 0
    buffer_load_dwordx4 v3, s[4:7], s22 offen lds
    ds_read_b64_tr_b16 v[224:225], v4 offset:49920
    v_mfma_f32_16x16x32_bf16 v[108:111], v[232:235], v[52:55], v[108:111]
    ds_read_b64_tr_b16 v[226:227], v4 offset:50944
    s_waitcnt lgkmcnt(6)
    v_mfma_f32_16x16x32_bf16 v[112:115], v[236:239], v[48:51], v[112:115]
    ds_read_b64_tr_b16 v[228:229], v5 offset:49952
    v_mfma_f32_16x16x32_bf16 v[116:119], v[236:239], v[52:55], v[116:119]
    ds_read_b64_tr_b16 v[230:231], v5 offset:50976
    s_waitcnt lgkmcnt(6)
    v_mfma_f32_16x16x32_bf16 v[120:123], v[240:243], v[48:51], v[120:123]
    v_mfma_f32_16x16x32_bf16 v[124:127], v[240:243], v[52:55], v[124:127]
    s_waitcnt vmcnt(13)
    s_barrier
    ds_read_b64_tr_b16 v[232:233], v7 offset:0
    ds_read_b64_tr_b16 v[234:235], v7 offset:1024
    s_waitcnt lgkmcnt(6)
    v_mfma_f32_16x16x32_bf16 v[128:131], v[244:247], v[48:51], v[128:131]
    ds_read_b64_tr_b16 v[236:237], v8 offset:32
    s_mov_b32 s23, 0xe000
    buffer_load_dwordx4 v[40:43], v6, s[8:11], s23 offen offset:0 sc1
    v_mfma_f32_16x16x32_bf16 v[132:135], v[244:247], v[52:55], v[132:135]
    ds_read_b64_tr_b16 v[238:239], v8 offset:1056
    s_waitcnt lgkmcnt(6)
    v_mfma_f32_16x16x32_bf16 v[136:139], v[224:227], v[48:51], v[136:139]
    ds_read_b64_tr_b16 v[240:241], v7 offset:256
    v_mfma_f32_16x16x32_bf16 v[140:143], v[224:227], v[52:55], v[140:143]
    ds_read_b64_tr_b16 v[242:243], v7 offset:1280
    s_mov_b32 s23, 0x2e000
    buffer_load_dwordx4 v[44:47], v6, s[8:11], s23 offen offset:0 sc1
    s_waitcnt lgkmcnt(6)
    v_mfma_f32_16x16x32_bf16 v[144:147], v[228:231], v[48:51], v[144:147]
    ds_read_b64_tr_b16 v[244:245], v8 offset:288
    v_mfma_f32_16x16x32_bf16 v[148:151], v[228:231], v[52:55], v[148:151]
    ds_read_b64_tr_b16 v[246:247], v8 offset:1312
    s_waitcnt vmcnt(6)
    v_cmp_ne_u32 vcc, s28, v12
    s_cbranch_vccnz adaLN_cond__sliding_block_cached__moe_arch_mod__prompt_kernel_o218r
adaLN_cond__sliding_block_cached__moe_arch_mod__prompt_kernel_o218b:
    s_waitcnt lgkmcnt(6)
    v_mfma_f32_16x16x32_bf16 v[88:91], v[232:235], v[56:59], v[88:91]
    ds_read_b64_tr_b16 v[224:225], v7 offset:512
    v_mfma_f32_16x16x32_bf16 v[92:95], v[232:235], v[60:63], v[92:95]
    s_add_u32 s22, s24, 0x10000
    s_add_u32 m0, s20, 0x18000
    s_nop 0
    buffer_load_dwordx4 v3, s[4:7], s22 offen lds
    ds_read_b64_tr_b16 v[226:227], v7 offset:1536
    s_waitcnt lgkmcnt(6)
    v_mfma_f32_16x16x32_bf16 v[96:99], v[236:239], v[56:59], v[96:99]
    ds_read_b64_tr_b16 v[228:229], v8 offset:544
    v_mfma_f32_16x16x32_bf16 v[100:103], v[236:239], v[60:63], v[100:103]
    ds_read_b64_tr_b16 v[230:231], v8 offset:1568
    s_waitcnt lgkmcnt(6)
    v_mfma_f32_16x16x32_bf16 v[104:107], v[240:243], v[56:59], v[104:107]
    s_add_u32 s22, s24, 0x12000
    s_add_u32 m0, s20, 0x18400
    s_nop 0
    buffer_load_dwordx4 v3, s[4:7], s22 offen lds
    ds_read_b64_tr_b16 v[232:233], v7 offset:768
    v_mfma_f32_16x16x32_bf16 v[108:111], v[240:243], v[60:63], v[108:111]
    ds_read_b64_tr_b16 v[234:235], v7 offset:1792
    s_waitcnt lgkmcnt(6)
    v_mfma_f32_16x16x32_bf16 v[112:115], v[244:247], v[56:59], v[112:115]
    ds_read_b64_tr_b16 v[236:237], v8 offset:800
    v_mfma_f32_16x16x32_bf16 v[116:119], v[244:247], v[60:63], v[116:119]
    ds_read_b64_tr_b16 v[238:239], v8 offset:1824
    s_waitcnt lgkmcnt(6)
    v_mfma_f32_16x16x32_bf16 v[120:123], v[224:227], v[56:59], v[120:123]
    v_mfma_f32_16x16x32_bf16 v[124:127], v[224:227], v[60:63], v[124:127]
    s_barrier
    ds_read_b64_tr_b16 v[240:241], v7 offset:16384
    ds_read_b64_tr_b16 v[242:243], v7 offset:17408
    s_waitcnt lgkmcnt(6)
    v_mfma_f32_16x16x32_bf16 v[128:131], v[228:231], v[56:59], v[128:131]
    ds_read_b64_tr_b16 v[244:245], v8 offset:16416
    s_mov_b32 s23, 0x0
    buffer_load_dwordx4 v[48:51], v6, s[8:11], s23 offen offset:1024 sc1
    v_mfma_f32_16x16x32_bf16 v[132:135], v[228:231], v[60:63], v[132:135]
    ds_read_b64_tr_b16 v[246:247], v8 offset:17440
    s_waitcnt lgkmcnt(6)
    v_mfma_f32_16x16x32_bf16 v[136:139], v[232:235], v[56:59], v[136:139]
    ds_read_b64_tr_b16 v[224:225], v7 offset:16640
    v_mfma_f32_16x16x32_bf16 v[140:143], v[232:235], v[60:63], v[140:143]
    ds_read_b64_tr_b16 v[226:227], v7 offset:17664
    s_mov_b32 s23, 0x20000
    buffer_load_dwordx4 v[52:55], v6, s[8:11], s23 offen offset:1024 sc1
    s_waitcnt lgkmcnt(6)
    v_mfma_f32_16x16x32_bf16 v[144:147], v[236:239], v[56:59], v[144:147]
    ds_read_b64_tr_b16 v[228:229], v8 offset:16672
    v_mfma_f32_16x16x32_bf16 v[148:151], v[236:239], v[60:63], v[148:151]
    ds_read_b64_tr_b16 v[230:231], v8 offset:17696
    s_waitcnt lgkmcnt(6)
    v_mfma_f32_16x16x32_bf16 v[88:91], v[240:243], v[24:27], v[88:91]
    ds_read_b64_tr_b16 v[232:233], v7 offset:16896
    v_mfma_f32_16x16x32_bf16 v[92:95], v[240:243], v[28:31], v[92:95]
    s_add_u32 s22, s24, 0x90000
    s_add_u32 m0, s20, 0x1c000
    s_nop 0
    buffer_load_dwordx4 v3, s[4:7], s22 offen lds
    ds_read_b64_tr_b16 v[234:235], v7 offset:17920
    s_waitcnt lgkmcnt(6)
    v_mfma_f32_16x16x32_bf16 v[96:99], v[244:247], v[24:27], v[96:99]
    ds_read_b64_tr_b16 v[236:237], v8 offset:16928
    v_mfma_f32_16x16x32_bf16 v[100:103], v[244:247], v[28:31], v[100:103]
    ds_read_b64_tr_b16 v[238:239], v8 offset:17952
    s_waitcnt lgkmcnt(6)
    v_mfma_f32_16x16x32_bf16 v[104:107], v[224:227], v[24:27], v[104:107]
    s_add_u32 s22, s24, 0x92000
    s_add_u32 m0, s20, 0x1c400
    s_nop 0
    buffer_load_dwordx4 v3, s[4:7], s22 offen lds
    ds_read_b64_tr_b16 v[240:241], v7 offset:17152
    v_mfma_f32_16x16x32_bf16 v[108:111], v[224:227], v[28:31], v[108:111]
    ds_read_b64_tr_b16 v[242:243], v7 offset:18176
    s_waitcnt lgkmcnt(6)
    v_mfma_f32_16x16x32_bf16 v[112:115], v[228:231], v[24:27], v[112:115]
    ds_read_b64_tr_b16 v[244:245], v8 offset:17184
    v_mfma_f32_16x16x32_bf16 v[116:119], v[228:231], v[28:31], v[116:119]
    ds_read_b64_tr_b16 v[246:247], v8 offset:18208
    s_waitcnt lgkmcnt(6)
    v_mfma_f32_16x16x32_bf16 v[120:123], v[232:235], v[24:27], v[120:123]
    v_mfma_f32_16x16x32_bf16 v[124:127], v[232:235], v[28:31], v[124:127]
    s_barrier
    ds_read_b64_tr_b16 v[224:225], v4 offset:0
    ds_read_b64_tr_b16 v[226:227], v4 offset:1024
    s_waitcnt lgkmcnt(6)
    v_mfma_f32_16x16x32_bf16 v[128:131], v[236:239], v[24:27], v[128:131]
    s_add_u32 s16, s63, 0x576000
    v_mov_b32 v14, s28
    v_mov_b32 v15, 0
    s_mov_b64 exec, 1
    buffer_store_dword v14, v15, s[8:11], s16 offen sc1
    s_mov_b64 exec, -1
    ds_read_b64_tr_b16 v[228:229], v5 offset:32
    s_mov_b32 s23, 0x2000
    buffer_load_dwordx4 v[56:59], v6, s[8:11], s23 offen offset:1024 sc1
    v_mfma_f32_16x16x32_bf16 v[132:135], v[236:239], v[28:31], v[132:135]
    ds_read_b64_tr_b16 v[230:231], v5 offset:1056
    s_waitcnt lgkmcnt(6)
    v_mfma_f32_16x16x32_bf16 v[136:139], v[240:243], v[24:27], v[136:139]
    ds_read_b64_tr_b16 v[232:233], v4 offset:256
    v_mfma_f32_16x16x32_bf16 v[140:143], v[240:243], v[28:31], v[140:143]
    ds_read_b64_tr_b16 v[234:235], v4 offset:1280
    s_mov_b32 s23, 0x22000
    buffer_load_dwordx4 v[60:63], v6, s[8:11], s23 offen offset:1024 sc1
    s_waitcnt lgkmcnt(6)
    v_mfma_f32_16x16x32_bf16 v[144:147], v[244:247], v[24:27], v[144:147]
    ds_read_b64_tr_b16 v[236:237], v5 offset:288
    v_mfma_f32_16x16x32_bf16 v[148:151], v[244:247], v[28:31], v[148:151]
    ds_read_b64_tr_b16 v[238:239], v5 offset:1312
    s_waitcnt vmcnt(14) lgkmcnt(6)
    v_mfma_f32_16x16x32_bf16 v[88:91], v[224:227], v[32:35], v[88:91]
    ds_read_b64_tr_b16 v[240:241], v4 offset:512
    s_waitcnt vmcnt(13)
    v_mfma_f32_16x16x32_bf16 v[92:95], v[224:227], v[36:39], v[92:95]
    s_add_u32 s22, s24, 0x110000
    s_add_u32 m0, s20, 0x20000
    s_nop 0
    buffer_load_dwordx4 v3, s[4:7], s22 offen lds
    ds_read_b64_tr_b16 v[242:243], v4 offset:1536
    s_waitcnt lgkmcnt(6)
    v_mfma_f32_16x16x32_bf16 v[96:99], v[228:231], v[32:35], v[96:99]
    ds_read_b64_tr_b16 v[244:245], v5 offset:544
    v_mfma_f32_16x16x32_bf16 v[100:103], v[228:231], v[36:39], v[100:103]
    ds_read_b64_tr_b16 v[246:247], v5 offset:1568
    s_waitcnt lgkmcnt(6)
    v_mfma_f32_16x16x32_bf16 v[104:107], v[232:235], v[32:35], v[104:107]
    s_add_u32 s22, s24, 0x112000
    s_add_u32 m0, s20, 0x20400
    s_nop 0
    buffer_load_dwordx4 v3, s[4:7], s22 offen lds
    ds_read_b64_tr_b16 v[224:225], v4 offset:768
    v_mfma_f32_16x16x32_bf16 v[108:111], v[232:235], v[36:39], v[108:111]
    ds_read_b64_tr_b16 v[226:227], v4 offset:1792
    s_waitcnt lgkmcnt(6)
    v_mfma_f32_16x16x32_bf16 v[112:115], v[236:239], v[32:35], v[112:115]
    ds_read_b64_tr_b16 v[228:229], v5 offset:800
    v_mfma_f32_16x16x32_bf16 v[116:119], v[236:239], v[36:39], v[116:119]
    ds_read_b64_tr_b16 v[230:231], v5 offset:1824
    s_waitcnt lgkmcnt(6)
    v_mfma_f32_16x16x32_bf16 v[120:123], v[240:243], v[32:35], v[120:123]
    v_mfma_f32_16x16x32_bf16 v[124:127], v[240:243], v[36:39], v[124:127]
    s_waitcnt vmcnt(13)
    s_barrier
    ds_read_b64_tr_b16 v[232:233], v4 offset:16384
    ds_read_b64_tr_b16 v[234:235], v4 offset:17408
    s_waitcnt lgkmcnt(6)
    v_mfma_f32_16x16x32_bf16 v[128:131], v[244:247], v[32:35], v[128:131]
    ds_read_b64_tr_b16 v[236:237], v5 offset:16416
    s_mov_b32 s23, 0x4000
    buffer_load_dwordx4 v[24:27], v6, s[8:11], s23 offen offset:1024 sc1
    v_mfma_f32_16x16x32_bf16 v[132:135], v[244:247], v[36:39], v[132:135]
    ds_read_b64_tr_b16 v[238:239], v5 offset:17440
    s_waitcnt lgkmcnt(6)
    v_mfma_f32_16x16x32_bf16 v[136:139], v[224:227], v[32:35], v[136:139]
    ds_read_b64_tr_b16 v[240:241], v4 offset:16640
    v_mfma_f32_16x16x32_bf16 v[140:143], v[224:227], v[36:39], v[140:143]
    ds_read_b64_tr_b16 v[242:243], v4 offset:17664
    s_mov_b32 s23, 0x24000
    buffer_load_dwordx4 v[28:31], v6, s[8:11], s23 offen offset:1024 sc1
    s_waitcnt lgkmcnt(6)
    v_mfma_f32_16x16x32_bf16 v[144:147], v[228:231], v[32:35], v[144:147]
    ds_read_b64_tr_b16 v[244:245], v5 offset:16672
    v_mfma_f32_16x16x32_bf16 v[148:151], v[228:231], v[36:39], v[148:151]
    ds_read_b64_tr_b16 v[246:247], v5 offset:17696
    s_waitcnt vmcnt(14) lgkmcnt(6)
    v_mfma_f32_16x16x32_bf16 v[88:91], v[232:235], v[40:43], v[88:91]
    ds_read_b64_tr_b16 v[224:225], v4 offset:16896
    s_waitcnt vmcnt(13)
    v_mfma_f32_16x16x32_bf16 v[92:95], v[232:235], v[44:47], v[92:95]
    s_add_u32 s22, s24, 0x190000
    s_add_u32 m0, s20, 0x24000
    s_nop 0
    buffer_load_dwordx4 v3, s[4:7], s22 offen lds
    ds_read_b64_tr_b16 v[226:227], v4 offset:17920
    s_waitcnt lgkmcnt(6)
    v_mfma_f32_16x16x32_bf16 v[96:99], v[236:239], v[40:43], v[96:99]
    ds_read_b64_tr_b16 v[228:229], v5 offset:16928
    v_mfma_f32_16x16x32_bf16 v[100:103], v[236:239], v[44:47], v[100:103]
    ds_read_b64_tr_b16 v[230:231], v5 offset:17952
    s_waitcnt lgkmcnt(6)
    v_mfma_f32_16x16x32_bf16 v[104:107], v[240:243], v[40:43], v[104:107]
    s_add_u32 s22, s24, 0x192000
    s_add_u32 m0, s20, 0x24400
    s_nop 0
    buffer_load_dwordx4 v3, s[4:7], s22 offen lds
    ds_read_b64_tr_b16 v[232:233], v4 offset:17152
    v_mfma_f32_16x16x32_bf16 v[108:111], v[240:243], v[44:47], v[108:111]
    ds_read_b64_tr_b16 v[234:235], v4 offset:18176
    s_waitcnt lgkmcnt(6)
    v_mfma_f32_16x16x32_bf16 v[112:115], v[244:247], v[40:43], v[112:115]
    ds_read_b64_tr_b16 v[236:237], v5 offset:17184
    v_mfma_f32_16x16x32_bf16 v[116:119], v[244:247], v[44:47], v[116:119]
    ds_read_b64_tr_b16 v[238:239], v5 offset:18208
    s_waitcnt lgkmcnt(6)
    v_mfma_f32_16x16x32_bf16 v[120:123], v[224:227], v[40:43], v[120:123]
    v_mfma_f32_16x16x32_bf16 v[124:127], v[224:227], v[44:47], v[124:127]
    s_waitcnt vmcnt(13)
    s_barrier
    ds_read_b64_tr_b16 v[240:241], v4 offset:32768
    ds_read_b64_tr_b16 v[242:243], v4 offset:33792
    s_waitcnt lgkmcnt(6)
    v_mfma_f32_16x16x32_bf16 v[128:131], v[228:231], v[40:43], v[128:131]
    ds_read_b64_tr_b16 v[244:245], v5 offset:32800
    s_mov_b32 s23, 0x6000
    buffer_load_dwordx4 v[32:35], v6, s[8:11], s23 offen offset:1024 sc1
    v_mfma_f32_16x16x32_bf16 v[132:135], v[228:231], v[44:47], v[132:135]
    ds_read_b64_tr_b16 v[246:247], v5 offset:33824
    s_waitcnt lgkmcnt(6)
    v_mfma_f32_16x16x32_bf16 v[136:139], v[232:235], v[40:43], v[136:139]
    ds_read_b64_tr_b16 v[224:225], v4 offset:33024
    v_mfma_f32_16x16x32_bf16 v[140:143], v[232:235], v[44:47], v[140:143]
    ds_read_b64_tr_b16 v[226:227], v4 offset:34048
    s_mov_b32 s23, 0x26000
    buffer_load_dwordx4 v[36:39], v6, s[8:11], s23 offen offset:1024 sc1
    s_waitcnt lgkmcnt(6)
    v_mfma_f32_16x16x32_bf16 v[144:147], v[236:239], v[40:43], v[144:147]
    ds_read_b64_tr_b16 v[228:229], v5 offset:33056
    v_mfma_f32_16x16x32_bf16 v[148:151], v[236:239], v[44:47], v[148:151]
    ds_read_b64_tr_b16 v[230:231], v5 offset:34080
    s_waitcnt vmcnt(14) lgkmcnt(6)
    v_mfma_f32_16x16x32_bf16 v[88:91], v[240:243], v[48:51], v[88:91]
    ds_read_b64_tr_b16 v[232:233], v4 offset:33280
    s_waitcnt vmcnt(13)
    v_mfma_f32_16x16x32_bf16 v[92:95], v[240:243], v[52:55], v[92:95]
    s_add_u32 s22, s24, 0x210000
    s_add_u32 m0, s20, 0x10000
    s_nop 0
    buffer_load_dwordx4 v3, s[4:7], s22 offen lds
    ds_read_b64_tr_b16 v[234:235], v4 offset:34304
    s_waitcnt lgkmcnt(6)
    v_mfma_f32_16x16x32_bf16 v[96:99], v[244:247], v[48:51], v[96:99]
    ds_read_b64_tr_b16 v[236:237], v5 offset:33312
    v_mfma_f32_16x16x32_bf16 v[100:103], v[244:247], v[52:55], v[100:103]
    ds_read_b64_tr_b16 v[238:239], v5 offset:34336
    s_waitcnt lgkmcnt(6)
    v_mfma_f32_16x16x32_bf16 v[104:107], v[224:227], v[48:51], v[104:107]
    s_add_u32 s22, s24, 0x212000
    s_add_u32 m0, s20, 0x10400
    s_nop 0
    buffer_load_dwordx4 v3, s[4:7], s22 offen lds
    ds_read_b64_tr_b16 v[240:241], v4 offset:33536
    v_mfma_f32_16x16x32_bf16 v[108:111], v[224:227], v[52:55], v[108:111]
    ds_read_b64_tr_b16 v[242:243], v4 offset:34560
    s_waitcnt lgkmcnt(6)
    v_mfma_f32_16x16x32_bf16 v[112:115], v[228:231], v[48:51], v[112:115]
    ds_read_b64_tr_b16 v[244:245], v5 offset:33568
    v_mfma_f32_16x16x32_bf16 v[116:119], v[228:231], v[52:55], v[116:119]
    ds_read_b64_tr_b16 v[246:247], v5 offset:34592
    s_waitcnt lgkmcnt(6)
    v_mfma_f32_16x16x32_bf16 v[120:123], v[232:235], v[48:51], v[120:123]
    v_mfma_f32_16x16x32_bf16 v[124:127], v[232:235], v[52:55], v[124:127]
    s_waitcnt vmcnt(13)
    s_barrier
    ds_read_b64_tr_b16 v[224:225], v4 offset:49152
    ds_read_b64_tr_b16 v[226:227], v4 offset:50176
    s_waitcnt lgkmcnt(6)
    v_mfma_f32_16x16x32_bf16 v[128:131], v[236:239], v[48:51], v[128:131]
    ds_read_b64_tr_b16 v[228:229], v5 offset:49184
    s_mov_b32 s23, 0x8000
    buffer_load_dwordx4 v[40:43], v6, s[8:11], s23 offen offset:1024 sc1
    v_mfma_f32_16x16x32_bf16 v[132:135], v[236:239], v[52:55], v[132:135]
    ds_read_b64_tr_b16 v[230:231], v5 offset:50208
    s_waitcnt lgkmcnt(6)
    v_mfma_f32_16x16x32_bf16 v[136:139], v[240:243], v[48:51], v[136:139]
    ds_read_b64_tr_b16 v[232:233], v4 offset:49408
    v_mfma_f32_16x16x32_bf16 v[140:143], v[240:243], v[52:55], v[140:143]
    ds_read_b64_tr_b16 v[234:235], v4 offset:50432
    s_mov_b32 s23, 0x28000
    buffer_load_dwordx4 v[44:47], v6, s[8:11], s23 offen offset:1024 sc1
    s_waitcnt lgkmcnt(6)
    v_mfma_f32_16x16x32_bf16 v[144:147], v[244:247], v[48:51], v[144:147]
    ds_read_b64_tr_b16 v[236:237], v5 offset:49440
    v_mfma_f32_16x16x32_bf16 v[148:151], v[244:247], v[52:55], v[148:151]
    ds_read_b64_tr_b16 v[238:239], v5 offset:50464
    s_waitcnt vmcnt(13) lgkmcnt(6)
    v_mfma_f32_16x16x32_bf16 v[88:91], v[224:227], v[56:59], v[88:91]
    ds_read_b64_tr_b16 v[240:241], v4 offset:49664
    s_waitcnt vmcnt(12)
    v_mfma_f32_16x16x32_bf16 v[92:95], v[224:227], v[60:63], v[92:95]
    s_add_u32 s22, s24, 0x290000
    s_add_u32 m0, s20, 0x14000
    s_nop 0
    buffer_load_dwordx4 v3, s[4:7], s22 offen lds
    ds_read_b64_tr_b16 v[242:243], v4 offset:50688
    s_waitcnt lgkmcnt(6)
    v_mfma_f32_16x16x32_bf16 v[96:99], v[228:231], v[56:59], v[96:99]
    ds_read_b64_tr_b16 v[244:245], v5 offset:49696
    v_mfma_f32_16x16x32_bf16 v[100:103], v[228:231], v[60:63], v[100:103]
    ds_read_b64_tr_b16 v[246:247], v5 offset:50720
    s_waitcnt lgkmcnt(6)
    v_mfma_f32_16x16x32_bf16 v[104:107], v[232:235], v[56:59], v[104:107]
    s_add_u32 s22, s24, 0x292000
    s_add_u32 m0, s20, 0x14400
    s_nop 0
    buffer_load_dwordx4 v3, s[4:7], s22 offen lds
    ds_read_b64_tr_b16 v[224:225], v4 offset:49920
    v_mfma_f32_16x16x32_bf16 v[108:111], v[232:235], v[60:63], v[108:111]
    ds_read_b64_tr_b16 v[226:227], v4 offset:50944
    s_waitcnt lgkmcnt(6)
    v_mfma_f32_16x16x32_bf16 v[112:115], v[236:239], v[56:59], v[112:115]
    ds_read_b64_tr_b16 v[228:229], v5 offset:49952
    v_mfma_f32_16x16x32_bf16 v[116:119], v[236:239], v[60:63], v[116:119]
    ds_read_b64_tr_b16 v[230:231], v5 offset:50976
    s_waitcnt lgkmcnt(6)
    v_mfma_f32_16x16x32_bf16 v[120:123], v[240:243], v[56:59], v[120:123]
    v_mfma_f32_16x16x32_bf16 v[124:127], v[240:243], v[60:63], v[124:127]
    s_waitcnt vmcnt(12)
    s_barrier
    ds_read_b64_tr_b16 v[232:233], v7 offset:0
    ds_read_b64_tr_b16 v[234:235], v7 offset:1024
    s_waitcnt lgkmcnt(6)
    v_mfma_f32_16x16x32_bf16 v[128:131], v[244:247], v[56:59], v[128:131]
    ds_read_b64_tr_b16 v[236:237], v8 offset:32
    s_mov_b32 s23, 0xa000
    buffer_load_dwordx4 v[48:51], v6, s[8:11], s23 offen offset:1024 sc1
    v_mfma_f32_16x16x32_bf16 v[132:135], v[244:247], v[60:63], v[132:135]
    ds_read_b64_tr_b16 v[238:239], v8 offset:1056
    s_waitcnt lgkmcnt(6)
    v_mfma_f32_16x16x32_bf16 v[136:139], v[224:227], v[56:59], v[136:139]
    ds_read_b64_tr_b16 v[240:241], v7 offset:256
    v_mfma_f32_16x16x32_bf16 v[140:143], v[224:227], v[60:63], v[140:143]
    ds_read_b64_tr_b16 v[242:243], v7 offset:1280
    s_mov_b32 s23, 0x2a000
    buffer_load_dwordx4 v[52:55], v6, s[8:11], s23 offen offset:1024 sc1
    s_waitcnt lgkmcnt(6)
    v_mfma_f32_16x16x32_bf16 v[144:147], v[228:231], v[56:59], v[144:147]
    ds_read_b64_tr_b16 v[244:245], v8 offset:288
    v_mfma_f32_16x16x32_bf16 v[148:151], v[228:231], v[60:63], v[148:151]
    ds_read_b64_tr_b16 v[246:247], v8 offset:1312
    s_waitcnt vmcnt(13) lgkmcnt(6)
    v_mfma_f32_16x16x32_bf16 v[88:91], v[232:235], v[24:27], v[88:91]
    ds_read_b64_tr_b16 v[224:225], v7 offset:512
    s_waitcnt vmcnt(12)
    v_mfma_f32_16x16x32_bf16 v[92:95], v[232:235], v[28:31], v[92:95]
    s_add_u32 s22, s24, 0x310000
    s_add_u32 m0, s20, 0x18000
    s_nop 0
    buffer_load_dwordx4 v3, s[4:7], s22 offen lds
    ds_read_b64_tr_b16 v[226:227], v7 offset:1536
    s_waitcnt lgkmcnt(6)
    v_mfma_f32_16x16x32_bf16 v[96:99], v[236:239], v[24:27], v[96:99]
    ds_read_b64_tr_b16 v[228:229], v8 offset:544
    v_mfma_f32_16x16x32_bf16 v[100:103], v[236:239], v[28:31], v[100:103]
    ds_read_b64_tr_b16 v[230:231], v8 offset:1568
    s_waitcnt lgkmcnt(6)
    v_mfma_f32_16x16x32_bf16 v[104:107], v[240:243], v[24:27], v[104:107]
    s_add_u32 s22, s24, 0x312000
    s_add_u32 m0, s20, 0x18400
    s_nop 0
    buffer_load_dwordx4 v3, s[4:7], s22 offen lds
    ds_read_b64_tr_b16 v[232:233], v7 offset:768
    v_mfma_f32_16x16x32_bf16 v[108:111], v[240:243], v[28:31], v[108:111]
    ds_read_b64_tr_b16 v[234:235], v7 offset:1792
    s_waitcnt lgkmcnt(6)
    v_mfma_f32_16x16x32_bf16 v[112:115], v[244:247], v[24:27], v[112:115]
    ds_read_b64_tr_b16 v[236:237], v8 offset:800
    v_mfma_f32_16x16x32_bf16 v[116:119], v[244:247], v[28:31], v[116:119]
    ds_read_b64_tr_b16 v[238:239], v8 offset:1824
    s_waitcnt lgkmcnt(6)
    v_mfma_f32_16x16x32_bf16 v[120:123], v[224:227], v[24:27], v[120:123]
    v_mfma_f32_16x16x32_bf16 v[124:127], v[224:227], v[28:31], v[124:127]
    s_waitcnt vmcnt(12)
    s_barrier
    ds_read_b64_tr_b16 v[240:241], v7 offset:16384
    ds_read_b64_tr_b16 v[242:243], v7 offset:17408
    s_add_u32 s19, s19, 8192
    buffer_load_dword v12, v13, s[8:11], s19 offen sc1
    s_waitcnt lgkmcnt(6)
    v_mfma_f32_16x16x32_bf16 v[128:131], v[228:231], v[24:27], v[128:131]
    ds_read_b64_tr_b16 v[244:245], v8 offset:16416
    s_mov_b32 s23, 0xc000
    buffer_load_dwordx4 v[56:59], v6, s[8:11], s23 offen offset:1024 sc1
    v_mfma_f32_16x16x32_bf16 v[132:135], v[228:231], v[28:31], v[132:135]
    ds_read_b64_tr_b16 v[246:247], v8 offset:17440
    s_waitcnt lgkmcnt(6)
    v_mfma_f32_16x16x32_bf16 v[136:139], v[232:235], v[24:27], v[136:139]
    ds_read_b64_tr_b16 v[224:225], v7 offset:16640
    v_mfma_f32_16x16x32_bf16 v[140:143], v[232:235], v[28:31], v[140:143]
    ds_read_b64_tr_b16 v[226:227], v7 offset:17664
    s_mov_b32 s23, 0x2c000
    buffer_load_dwordx4 v[60:63], v6, s[8:11], s23 offen offset:1024 sc1
    s_waitcnt lgkmcnt(6)
    v_mfma_f32_16x16x32_bf16 v[144:147], v[236:239], v[24:27], v[144:147]
    ds_read_b64_tr_b16 v[228:229], v8 offset:16672
    v_mfma_f32_16x16x32_bf16 v[148:151], v[236:239], v[28:31], v[148:151]
    ds_read_b64_tr_b16 v[230:231], v8 offset:17696
    s_waitcnt vmcnt(14) lgkmcnt(6)
    v_mfma_f32_16x16x32_bf16 v[88:91], v[240:243], v[32:35], v[88:91]
    ds_read_b64_tr_b16 v[232:233], v7 offset:16896
    s_waitcnt vmcnt(13)
    v_mfma_f32_16x16x32_bf16 v[92:95], v[240:243], v[36:39], v[92:95]
    s_add_u32 s22, s24, 0x390000
    s_add_u32 m0, s20, 0x1c000
    s_nop 0
    buffer_load_dwordx4 v3, s[4:7], s22 offen lds
    ds_read_b64_tr_b16 v[234:235], v7 offset:17920
    s_waitcnt lgkmcnt(6)
    v_mfma_f32_16x16x32_bf16 v[96:99], v[244:247], v[32:35], v[96:99]
    ds_read_b64_tr_b16 v[236:237], v8 offset:16928
    v_mfma_f32_16x16x32_bf16 v[100:103], v[244:247], v[36:39], v[100:103]
    ds_read_b64_tr_b16 v[238:239], v8 offset:17952
    s_waitcnt lgkmcnt(6)
    v_mfma_f32_16x16x32_bf16 v[104:107], v[224:227], v[32:35], v[104:107]
    s_add_u32 s22, s24, 0x392000
    s_add_u32 m0, s20, 0x1c400
    s_nop 0
    buffer_load_dwordx4 v3, s[4:7], s22 offen lds
    ds_read_b64_tr_b16 v[240:241], v7 offset:17152
    v_mfma_f32_16x16x32_bf16 v[108:111], v[224:227], v[36:39], v[108:111]
    ds_read_b64_tr_b16 v[242:243], v7 offset:18176
    s_waitcnt lgkmcnt(6)
    v_mfma_f32_16x16x32_bf16 v[112:115], v[228:231], v[32:35], v[112:115]
    ds_read_b64_tr_b16 v[244:245], v8 offset:17184
    v_mfma_f32_16x16x32_bf16 v[116:119], v[228:231], v[36:39], v[116:119]
    ds_read_b64_tr_b16 v[246:247], v8 offset:18208
    s_waitcnt lgkmcnt(6)
    v_mfma_f32_16x16x32_bf16 v[120:123], v[232:235], v[32:35], v[120:123]
    v_mfma_f32_16x16x32_bf16 v[124:127], v[232:235], v[36:39], v[124:127]
    s_waitcnt vmcnt(13)
    s_barrier
    ds_read_b64_tr_b16 v[224:225], v4 offset:0
    ds_read_b64_tr_b16 v[226:227], v4 offset:1024
    s_waitcnt lgkmcnt(6)
    v_mfma_f32_16x16x32_bf16 v[128:131], v[236:239], v[32:35], v[128:131]
    ds_read_b64_tr_b16 v[228:229], v5 offset:32
    s_mov_b32 s23, 0xe000
    buffer_load_dwordx4 v[24:27], v6, s[8:11], s23 offen offset:1024 sc1
    v_mfma_f32_16x16x32_bf16 v[132:135], v[236:239], v[36:39], v[132:135]
    ds_read_b64_tr_b16 v[230:231], v5 offset:1056
    s_waitcnt lgkmcnt(6)
    v_mfma_f32_16x16x32_bf16 v[136:139], v[240:243], v[32:35], v[136:139]
    ds_read_b64_tr_b16 v[232:233], v4 offset:256
    v_mfma_f32_16x16x32_bf16 v[140:143], v[240:243], v[36:39], v[140:143]
    ds_read_b64_tr_b16 v[234:235], v4 offset:1280
    s_mov_b32 s23, 0x2e000
    buffer_load_dwordx4 v[28:31], v6, s[8:11], s23 offen offset:1024 sc1
    s_waitcnt lgkmcnt(6)
    v_mfma_f32_16x16x32_bf16 v[144:147], v[244:247], v[32:35], v[144:147]
    ds_read_b64_tr_b16 v[236:237], v5 offset:288
    v_mfma_f32_16x16x32_bf16 v[148:151], v[244:247], v[36:39], v[148:151]
    ds_read_b64_tr_b16 v[238:239], v5 offset:1312
    s_waitcnt vmcnt(6)
    v_cmp_ne_u32 vcc, s28, v12
    s_cbranch_vccnz adaLN_cond__sliding_block_cached__moe_arch_mod__prompt_kernel_o219r
adaLN_cond__sliding_block_cached__moe_arch_mod__prompt_kernel_o219b:
    s_waitcnt lgkmcnt(6)
    v_mfma_f32_16x16x32_bf16 v[88:91], v[224:227], v[40:43], v[88:91]
    ds_read_b64_tr_b16 v[240:241], v4 offset:512
    v_mfma_f32_16x16x32_bf16 v[92:95], v[224:227], v[44:47], v[92:95]
    s_add_u32 s22, s24, 0x20000
    s_add_u32 m0, s20, 0x20000
    s_nop 0
    buffer_load_dwordx4 v3, s[4:7], s22 offen lds
    ds_read_b64_tr_b16 v[242:243], v4 offset:1536
    s_waitcnt lgkmcnt(6)
    v_mfma_f32_16x16x32_bf16 v[96:99], v[228:231], v[40:43], v[96:99]
    ds_read_b64_tr_b16 v[244:245], v5 offset:544
    v_mfma_f32_16x16x32_bf16 v[100:103], v[228:231], v[44:47], v[100:103]
    ds_read_b64_tr_b16 v[246:247], v5 offset:1568
    s_waitcnt lgkmcnt(6)
    v_mfma_f32_16x16x32_bf16 v[104:107], v[232:235], v[40:43], v[104:107]
    s_add_u32 s22, s24, 0x22000
    s_add_u32 m0, s20, 0x20400
    s_nop 0
    buffer_load_dwordx4 v3, s[4:7], s22 offen lds
    ds_read_b64_tr_b16 v[224:225], v4 offset:768
    v_mfma_f32_16x16x32_bf16 v[108:111], v[232:235], v[44:47], v[108:111]
    ds_read_b64_tr_b16 v[226:227], v4 offset:1792
    s_waitcnt lgkmcnt(6)
    v_mfma_f32_16x16x32_bf16 v[112:115], v[236:239], v[40:43], v[112:115]
    ds_read_b64_tr_b16 v[228:229], v5 offset:800
    v_mfma_f32_16x16x32_bf16 v[116:119], v[236:239], v[44:47], v[116:119]
    ds_read_b64_tr_b16 v[230:231], v5 offset:1824
    s_waitcnt lgkmcnt(6)
    v_mfma_f32_16x16x32_bf16 v[120:123], v[240:243], v[40:43], v[120:123]
    v_mfma_f32_16x16x32_bf16 v[124:127], v[240:243], v[44:47], v[124:127]
    s_barrier
    ds_read_b64_tr_b16 v[232:233], v4 offset:16384
    ds_read_b64_tr_b16 v[234:235], v4 offset:17408
    s_waitcnt lgkmcnt(6)
    v_mfma_f32_16x16x32_bf16 v[128:131], v[244:247], v[40:43], v[128:131]
    ds_read_b64_tr_b16 v[236:237], v5 offset:16416
    s_mov_b32 s23, 0x0
    buffer_load_dwordx4 v[32:35], v6, s[8:11], s23 offen offset:2048 sc1
    v_mfma_f32_16x16x32_bf16 v[132:135], v[244:247], v[44:47], v[132:135]
    ds_read_b64_tr_b16 v[238:239], v5 offset:17440
    s_waitcnt lgkmcnt(6)
    v_mfma_f32_16x16x32_bf16 v[136:139], v[224:227], v[40:43], v[136:139]
    ds_read_b64_tr_b16 v[240:241], v4 offset:16640
    v_mfma_f32_16x16x32_bf16 v[140:143], v[224:227], v[44:47], v[140:143]
    ds_read_b64_tr_b16 v[242:243], v4 offset:17664
    s_mov_b32 s23, 0x20000
    buffer_load_dwordx4 v[36:39], v6, s[8:11], s23 offen offset:2048 sc1
    s_waitcnt lgkmcnt(6)
    v_mfma_f32_16x16x32_bf16 v[144:147], v[228:231], v[40:43], v[144:147]
    ds_read_b64_tr_b16 v[244:245], v5 offset:16672
    v_mfma_f32_16x16x32_bf16 v[148:151], v[228:231], v[44:47], v[148:151]
    ds_read_b64_tr_b16 v[246:247], v5 offset:17696
    s_waitcnt lgkmcnt(6)
    v_mfma_f32_16x16x32_bf16 v[88:91], v[232:235], v[48:51], v[88:91]
    ds_read_b64_tr_b16 v[224:225], v4 offset:16896
    v_mfma_f32_16x16x32_bf16 v[92:95], v[232:235], v[52:55], v[92:95]
    s_add_u32 s22, s24, 0xa0000
    s_add_u32 m0, s20, 0x24000
    s_nop 0
    buffer_load_dwordx4 v3, s[4:7], s22 offen lds
    ds_read_b64_tr_b16 v[226:227], v4 offset:17920
    s_waitcnt lgkmcnt(6)
    v_mfma_f32_16x16x32_bf16 v[96:99], v[236:239], v[48:51], v[96:99]
    ds_read_b64_tr_b16 v[228:229], v5 offset:16928
    v_mfma_f32_16x16x32_bf16 v[100:103], v[236:239], v[52:55], v[100:103]
    ds_read_b64_tr_b16 v[230:231], v5 offset:17952
    s_waitcnt lgkmcnt(6)
    v_mfma_f32_16x16x32_bf16 v[104:107], v[240:243], v[48:51], v[104:107]
    s_add_u32 s22, s24, 0xa2000
    s_add_u32 m0, s20, 0x24400
    s_nop 0
    buffer_load_dwordx4 v3, s[4:7], s22 offen lds
    ds_read_b64_tr_b16 v[232:233], v4 offset:17152
    v_mfma_f32_16x16x32_bf16 v[108:111], v[240:243], v[52:55], v[108:111]
    ds_read_b64_tr_b16 v[234:235], v4 offset:18176
    s_waitcnt lgkmcnt(6)
    v_mfma_f32_16x16x32_bf16 v[112:115], v[244:247], v[48:51], v[112:115]
    ds_read_b64_tr_b16 v[236:237], v5 offset:17184
    v_mfma_f32_16x16x32_bf16 v[116:119], v[244:247], v[52:55], v[116:119]
    ds_read_b64_tr_b16 v[238:239], v5 offset:18208
    s_waitcnt lgkmcnt(6)
    v_mfma_f32_16x16x32_bf16 v[120:123], v[224:227], v[48:51], v[120:123]
    v_mfma_f32_16x16x32_bf16 v[124:127], v[224:227], v[52:55], v[124:127]
    s_barrier
    ds_read_b64_tr_b16 v[240:241], v4 offset:32768
    ds_read_b64_tr_b16 v[242:243], v4 offset:33792
    s_waitcnt lgkmcnt(6)
    v_mfma_f32_16x16x32_bf16 v[128:131], v[228:231], v[48:51], v[128:131]
    ds_read_b64_tr_b16 v[244:245], v5 offset:32800
    s_mov_b32 s23, 0x2000
    buffer_load_dwordx4 v[40:43], v6, s[8:11], s23 offen offset:2048 sc1
    v_mfma_f32_16x16x32_bf16 v[132:135], v[228:231], v[52:55], v[132:135]
    ds_read_b64_tr_b16 v[246:247], v5 offset:33824
    s_waitcnt lgkmcnt(6)
    v_mfma_f32_16x16x32_bf16 v[136:139], v[232:235], v[48:51], v[136:139]
    ds_read_b64_tr_b16 v[224:225], v4 offset:33024
    v_mfma_f32_16x16x32_bf16 v[140:143], v[232:235], v[52:55], v[140:143]
    ds_read_b64_tr_b16 v[226:227], v4 offset:34048
    s_mov_b32 s23, 0x22000
    buffer_load_dwordx4 v[44:47], v6, s[8:11], s23 offen offset:2048 sc1
    s_waitcnt lgkmcnt(6)
    v_mfma_f32_16x16x32_bf16 v[144:147], v[236:239], v[48:51], v[144:147]
    ds_read_b64_tr_b16 v[228:229], v5 offset:33056
    v_mfma_f32_16x16x32_bf16 v[148:151], v[236:239], v[52:55], v[148:151]
    ds_read_b64_tr_b16 v[230:231], v5 offset:34080
    s_waitcnt vmcnt(13) lgkmcnt(6)
    v_mfma_f32_16x16x32_bf16 v[88:91], v[240:243], v[56:59], v[88:91]
    ds_read_b64_tr_b16 v[232:233], v4 offset:33280
    s_waitcnt vmcnt(12)
    v_mfma_f32_16x16x32_bf16 v[92:95], v[240:243], v[60:63], v[92:95]
    s_add_u32 s22, s24, 0x120000
    s_add_u32 m0, s20, 0x10000
    s_nop 0
    buffer_load_dwordx4 v3, s[4:7], s22 offen lds
    ds_read_b64_tr_b16 v[234:235], v4 offset:34304
    s_waitcnt lgkmcnt(6)
    v_mfma_f32_16x16x32_bf16 v[96:99], v[244:247], v[56:59], v[96:99]
    ds_read_b64_tr_b16 v[236:237], v5 offset:33312
    v_mfma_f32_16x16x32_bf16 v[100:103], v[244:247], v[60:63], v[100:103]
    ds_read_b64_tr_b16 v[238:239], v5 offset:34336
    s_waitcnt lgkmcnt(6)
    v_mfma_f32_16x16x32_bf16 v[104:107], v[224:227], v[56:59], v[104:107]
    s_add_u32 s22, s24, 0x122000
    s_add_u32 m0, s20, 0x10400
    s_nop 0
    buffer_load_dwordx4 v3, s[4:7], s22 offen lds
    ds_read_b64_tr_b16 v[240:241], v4 offset:33536
    v_mfma_f32_16x16x32_bf16 v[108:111], v[224:227], v[60:63], v[108:111]
    ds_read_b64_tr_b16 v[242:243], v4 offset:34560
    s_waitcnt lgkmcnt(6)
    v_mfma_f32_16x16x32_bf16 v[112:115], v[228:231], v[56:59], v[112:115]
    ds_read_b64_tr_b16 v[244:245], v5 offset:33568
    v_mfma_f32_16x16x32_bf16 v[116:119], v[228:231], v[60:63], v[116:119]
    ds_read_b64_tr_b16 v[246:247], v5 offset:34592
    s_waitcnt lgkmcnt(6)
    v_mfma_f32_16x16x32_bf16 v[120:123], v[232:235], v[56:59], v[120:123]
    v_mfma_f32_16x16x32_bf16 v[124:127], v[232:235], v[60:63], v[124:127]
    s_waitcnt vmcnt(12)
    s_barrier
    ds_read_b64_tr_b16 v[224:225], v4 offset:49152
    ds_read_b64_tr_b16 v[226:227], v4 offset:50176
    s_waitcnt lgkmcnt(6)
    v_mfma_f32_16x16x32_bf16 v[128:131], v[236:239], v[56:59], v[128:131]
    ds_read_b64_tr_b16 v[228:229], v5 offset:49184
    s_mov_b32 s23, 0x4000
    buffer_load_dwordx4 v[48:51], v6, s[8:11], s23 offen offset:2048 sc1
    v_mfma_f32_16x16x32_bf16 v[132:135], v[236:239], v[60:63], v[132:135]
    ds_read_b64_tr_b16 v[230:231], v5 offset:50208
    s_waitcnt lgkmcnt(6)
    v_mfma_f32_16x16x32_bf16 v[136:139], v[240:243], v[56:59], v[136:139]
    ds_read_b64_tr_b16 v[232:233], v4 offset:49408
    v_mfma_f32_16x16x32_bf16 v[140:143], v[240:243], v[60:63], v[140:143]
    ds_read_b64_tr_b16 v[234:235], v4 offset:50432
    s_mov_b32 s23, 0x24000
    buffer_load_dwordx4 v[52:55], v6, s[8:11], s23 offen offset:2048 sc1
    s_waitcnt lgkmcnt(6)
    v_mfma_f32_16x16x32_bf16 v[144:147], v[244:247], v[56:59], v[144:147]
    ds_read_b64_tr_b16 v[236:237], v5 offset:49440
    v_mfma_f32_16x16x32_bf16 v[148:151], v[244:247], v[60:63], v[148:151]
    ds_read_b64_tr_b16 v[238:239], v5 offset:50464
    s_waitcnt vmcnt(13) lgkmcnt(6)
    v_mfma_f32_16x16x32_bf16 v[88:91], v[224:227], v[24:27], v[88:91]
    ds_read_b64_tr_b16 v[240:241], v4 offset:49664
    s_waitcnt vmcnt(12)
    v_mfma_f32_16x16x32_bf16 v[92:95], v[224:227], v[28:31], v[92:95]
    s_add_u32 s22, s24, 0x1a0000
    s_add_u32 m0, s20, 0x14000
    s_nop 0
    buffer_load_dwordx4 v3, s[4:7], s22 offen lds
    ds_read_b64_tr_b16 v[242:243], v4 offset:50688
    s_waitcnt lgkmcnt(6)
    v_mfma_f32_16x16x32_bf16 v[96:99], v[228:231], v[24:27], v[96:99]
    ds_read_b64_tr_b16 v[244:245], v5 offset:49696
    v_mfma_f32_16x16x32_bf16 v[100:103], v[228:231], v[28:31], v[100:103]
    ds_read_b64_tr_b16 v[246:247], v5 offset:50720
    s_waitcnt lgkmcnt(6)
    v_mfma_f32_16x16x32_bf16 v[104:107], v[232:235], v[24:27], v[104:107]
    s_add_u32 s22, s24, 0x1a2000
    s_add_u32 m0, s20, 0x14400
    s_nop 0
    buffer_load_dwordx4 v3, s[4:7], s22 offen lds
    ds_read_b64_tr_b16 v[224:225], v4 offset:49920
    v_mfma_f32_16x16x32_bf16 v[108:111], v[232:235], v[28:31], v[108:111]
    ds_read_b64_tr_b16 v[226:227], v4 offset:50944
    s_waitcnt lgkmcnt(6)
    v_mfma_f32_16x16x32_bf16 v[112:115], v[236:239], v[24:27], v[112:115]
    ds_read_b64_tr_b16 v[228:229], v5 offset:49952
    v_mfma_f32_16x16x32_bf16 v[116:119], v[236:239], v[28:31], v[116:119]
    ds_read_b64_tr_b16 v[230:231], v5 offset:50976
    s_waitcnt lgkmcnt(6)
    v_mfma_f32_16x16x32_bf16 v[120:123], v[240:243], v[24:27], v[120:123]
    v_mfma_f32_16x16x32_bf16 v[124:127], v[240:243], v[28:31], v[124:127]
    s_waitcnt vmcnt(12)
    s_barrier
    ds_read_b64_tr_b16 v[232:233], v7 offset:0
    ds_read_b64_tr_b16 v[234:235], v7 offset:1024
    s_waitcnt lgkmcnt(6)
    v_mfma_f32_16x16x32_bf16 v[128:131], v[244:247], v[24:27], v[128:131]
    ds_read_b64_tr_b16 v[236:237], v8 offset:32
    s_mov_b32 s23, 0x6000
    buffer_load_dwordx4 v[56:59], v6, s[8:11], s23 offen offset:2048 sc1
    v_mfma_f32_16x16x32_bf16 v[132:135], v[244:247], v[28:31], v[132:135]
    ds_read_b64_tr_b16 v[238:239], v8 offset:1056
    s_waitcnt lgkmcnt(6)
    v_mfma_f32_16x16x32_bf16 v[136:139], v[224:227], v[24:27], v[136:139]
    ds_read_b64_tr_b16 v[240:241], v7 offset:256
    v_mfma_f32_16x16x32_bf16 v[140:143], v[224:227], v[28:31], v[140:143]
    ds_read_b64_tr_b16 v[242:243], v7 offset:1280
    s_mov_b32 s23, 0x26000
    buffer_load_dwordx4 v[60:63], v6, s[8:11], s23 offen offset:2048 sc1
    s_waitcnt lgkmcnt(6)
    v_mfma_f32_16x16x32_bf16 v[144:147], v[228:231], v[24:27], v[144:147]
    ds_read_b64_tr_b16 v[244:245], v8 offset:288
    v_mfma_f32_16x16x32_bf16 v[148:151], v[228:231], v[28:31], v[148:151]
    ds_read_b64_tr_b16 v[246:247], v8 offset:1312
    s_waitcnt vmcnt(13) lgkmcnt(6)
    v_mfma_f32_16x16x32_bf16 v[88:91], v[232:235], v[32:35], v[88:91]
    ds_read_b64_tr_b16 v[224:225], v7 offset:512
    s_waitcnt vmcnt(12)
    v_mfma_f32_16x16x32_bf16 v[92:95], v[232:235], v[36:39], v[92:95]
    s_add_u32 s22, s24, 0x220000
    s_add_u32 m0, s20, 0x18000
    s_nop 0
    buffer_load_dwordx4 v3, s[4:7], s22 offen lds
    ds_read_b64_tr_b16 v[226:227], v7 offset:1536
    s_waitcnt lgkmcnt(6)
    v_mfma_f32_16x16x32_bf16 v[96:99], v[236:239], v[32:35], v[96:99]
    ds_read_b64_tr_b16 v[228:229], v8 offset:544
    v_mfma_f32_16x16x32_bf16 v[100:103], v[236:239], v[36:39], v[100:103]
    ds_read_b64_tr_b16 v[230:231], v8 offset:1568
    s_waitcnt lgkmcnt(6)
    v_mfma_f32_16x16x32_bf16 v[104:107], v[240:243], v[32:35], v[104:107]
    s_add_u32 s22, s24, 0x222000
    s_add_u32 m0, s20, 0x18400
    s_nop 0
    buffer_load_dwordx4 v3, s[4:7], s22 offen lds
    ds_read_b64_tr_b16 v[232:233], v7 offset:768
    v_mfma_f32_16x16x32_bf16 v[108:111], v[240:243], v[36:39], v[108:111]
    ds_read_b64_tr_b16 v[234:235], v7 offset:1792
    s_mov_b32 s16, 0x544000
    buffer_load_dwordx4 v[184:187], v2, s[8:11], s16 offen sc1
    s_waitcnt lgkmcnt(6)
    v_mfma_f32_16x16x32_bf16 v[112:115], v[244:247], v[32:35], v[112:115]
    ds_read_b64_tr_b16 v[236:237], v8 offset:800
    v_mfma_f32_16x16x32_bf16 v[116:119], v[244:247], v[36:39], v[116:119]
    ds_read_b64_tr_b16 v[238:239], v8 offset:1824
    s_waitcnt lgkmcnt(6)
    v_mfma_f32_16x16x32_bf16 v[120:123], v[224:227], v[32:35], v[120:123]
    v_mfma_f32_16x16x32_bf16 v[124:127], v[224:227], v[36:39], v[124:127]
    s_waitcnt vmcnt(13)
    s_barrier
    ds_read_b64_tr_b16 v[240:241], v7 offset:16384
    ds_read_b64_tr_b16 v[242:243], v7 offset:17408
    s_waitcnt lgkmcnt(6)
    v_mfma_f32_16x16x32_bf16 v[128:131], v[228:231], v[32:35], v[128:131]
    ds_read_b64_tr_b16 v[244:245], v8 offset:16416
    s_mov_b32 s23, 0x8000
    buffer_load_dwordx4 v[24:27], v6, s[8:11], s23 offen offset:2048 sc1
    v_mfma_f32_16x16x32_bf16 v[132:135], v[228:231], v[36:39], v[132:135]
    ds_read_b64_tr_b16 v[246:247], v8 offset:17440
    s_waitcnt lgkmcnt(6)
    v_mfma_f32_16x16x32_bf16 v[136:139], v[232:235], v[32:35], v[136:139]
    ds_read_b64_tr_b16 v[224:225], v7 offset:16640
    v_mfma_f32_16x16x32_bf16 v[140:143], v[232:235], v[36:39], v[140:143]
    ds_read_b64_tr_b16 v[226:227], v7 offset:17664
    s_mov_b32 s23, 0x28000
    buffer_load_dwordx4 v[28:31], v6, s[8:11], s23 offen offset:2048 sc1
    s_waitcnt lgkmcnt(6)
    v_mfma_f32_16x16x32_bf16 v[144:147], v[236:239], v[32:35], v[144:147]
    ds_read_b64_tr_b16 v[228:229], v8 offset:16672
    v_mfma_f32_16x16x32_bf16 v[148:151], v[236:239], v[36:39], v[148:151]
    ds_read_b64_tr_b16 v[230:231], v8 offset:17696
    s_waitcnt vmcnt(14) lgkmcnt(6)
    v_mfma_f32_16x16x32_bf16 v[88:91], v[240:243], v[40:43], v[88:91]
    ds_read_b64_tr_b16 v[232:233], v7 offset:16896
    s_waitcnt vmcnt(13)
    v_mfma_f32_16x16x32_bf16 v[92:95], v[240:243], v[44:47], v[92:95]
    s_add_u32 s22, s24, 0x2a0000
    s_add_u32 m0, s20, 0x1c000
    s_nop 0
    buffer_load_dwordx4 v3, s[4:7], s22 offen lds
    ds_read_b64_tr_b16 v[234:235], v7 offset:17920
    s_waitcnt lgkmcnt(6)
    v_mfma_f32_16x16x32_bf16 v[96:99], v[244:247], v[40:43], v[96:99]
    ds_read_b64_tr_b16 v[236:237], v8 offset:16928
    v_mfma_f32_16x16x32_bf16 v[100:103], v[244:247], v[44:47], v[100:103]
    ds_read_b64_tr_b16 v[238:239], v8 offset:17952
    s_waitcnt lgkmcnt(6)
    v_mfma_f32_16x16x32_bf16 v[104:107], v[224:227], v[40:43], v[104:107]
    s_add_u32 s22, s24, 0x2a2000
    s_add_u32 m0, s20, 0x1c400
    s_nop 0
    buffer_load_dwordx4 v3, s[4:7], s22 offen lds
    ds_read_b64_tr_b16 v[240:241], v7 offset:17152
    v_mfma_f32_16x16x32_bf16 v[108:111], v[224:227], v[44:47], v[108:111]
    ds_read_b64_tr_b16 v[242:243], v7 offset:18176
    s_waitcnt lgkmcnt(6)
    v_mfma_f32_16x16x32_bf16 v[112:115], v[228:231], v[40:43], v[112:115]
    ds_read_b64_tr_b16 v[244:245], v8 offset:17184
    v_mfma_f32_16x16x32_bf16 v[116:119], v[228:231], v[44:47], v[116:119]
    ds_read_b64_tr_b16 v[246:247], v8 offset:18208
    s_waitcnt lgkmcnt(6)
    v_mfma_f32_16x16x32_bf16 v[120:123], v[232:235], v[40:43], v[120:123]
    v_mfma_f32_16x16x32_bf16 v[124:127], v[232:235], v[44:47], v[124:127]
    s_waitcnt vmcnt(13)
    s_barrier
    ds_read_b64_tr_b16 v[224:225], v4 offset:0
    ds_read_b64_tr_b16 v[226:227], v4 offset:1024
    s_waitcnt lgkmcnt(6)
    v_mfma_f32_16x16x32_bf16 v[128:131], v[236:239], v[40:43], v[128:131]
    ds_read_b64_tr_b16 v[228:229], v5 offset:32
    s_mov_b32 s23, 0xa000
    buffer_load_dwordx4 v[32:35], v6, s[8:11], s23 offen offset:2048 sc1
    v_mfma_f32_16x16x32_bf16 v[132:135], v[236:239], v[44:47], v[132:135]
    ds_read_b64_tr_b16 v[230:231], v5 offset:1056
    s_waitcnt lgkmcnt(6)
    v_mfma_f32_16x16x32_bf16 v[136:139], v[240:243], v[40:43], v[136:139]
    ds_read_b64_tr_b16 v[232:233], v4 offset:256
    v_mfma_f32_16x16x32_bf16 v[140:143], v[240:243], v[44:47], v[140:143]
    ds_read_b64_tr_b16 v[234:235], v4 offset:1280
    s_mov_b32 s23, 0x2a000
    buffer_load_dwordx4 v[36:39], v6, s[8:11], s23 offen offset:2048 sc1
    s_waitcnt lgkmcnt(6)
    v_mfma_f32_16x16x32_bf16 v[144:147], v[244:247], v[40:43], v[144:147]
    ds_read_b64_tr_b16 v[236:237], v5 offset:288
    v_mfma_f32_16x16x32_bf16 v[148:151], v[244:247], v[44:47], v[148:151]
    ds_read_b64_tr_b16 v[238:239], v5 offset:1312
    s_waitcnt vmcnt(14) lgkmcnt(6)
    v_mfma_f32_16x16x32_bf16 v[88:91], v[224:227], v[48:51], v[88:91]
    ds_read_b64_tr_b16 v[240:241], v4 offset:512
    s_waitcnt vmcnt(13)
    v_mfma_f32_16x16x32_bf16 v[92:95], v[224:227], v[52:55], v[92:95]
    s_add_u32 s22, s24, 0x320000
    s_add_u32 m0, s20, 0x20000
    s_nop 0
    buffer_load_dwordx4 v3, s[4:7], s22 offen lds
    ds_read_b64_tr_b16 v[242:243], v4 offset:1536
    s_waitcnt lgkmcnt(6)
    v_mfma_f32_16x16x32_bf16 v[96:99], v[228:231], v[48:51], v[96:99]
    ds_read_b64_tr_b16 v[244:245], v5 offset:544
    v_mfma_f32_16x16x32_bf16 v[100:103], v[228:231], v[52:55], v[100:103]
    ds_read_b64_tr_b16 v[246:247], v5 offset:1568
    s_waitcnt lgkmcnt(6)
    v_mfma_f32_16x16x32_bf16 v[104:107], v[232:235], v[48:51], v[104:107]
    s_add_u32 s22, s24, 0x322000
    s_add_u32 m0, s20, 0x20400
    s_nop 0
    buffer_load_dwordx4 v3, s[4:7], s22 offen lds
    ds_read_b64_tr_b16 v[224:225], v4 offset:768
    v_mfma_f32_16x16x32_bf16 v[108:111], v[232:235], v[52:55], v[108:111]
    ds_read_b64_tr_b16 v[226:227], v4 offset:1792
    s_waitcnt lgkmcnt(6)
    v_mfma_f32_16x16x32_bf16 v[112:115], v[236:239], v[48:51], v[112:115]
    ds_read_b64_tr_b16 v[228:229], v5 offset:800
    v_mfma_f32_16x16x32_bf16 v[116:119], v[236:239], v[52:55], v[116:119]
    ds_read_b64_tr_b16 v[230:231], v5 offset:1824
    s_waitcnt lgkmcnt(6)
    v_mfma_f32_16x16x32_bf16 v[120:123], v[240:243], v[48:51], v[120:123]
    v_mfma_f32_16x16x32_bf16 v[124:127], v[240:243], v[52:55], v[124:127]
    s_waitcnt vmcnt(13)
    s_barrier
    ds_read_b64_tr_b16 v[232:233], v4 offset:16384
    ds_read_b64_tr_b16 v[234:235], v4 offset:17408
    s_add_u32 s19, s19, 8192
    buffer_load_dword v12, v13, s[8:11], s19 offen sc1
    s_waitcnt lgkmcnt(6)
    v_mfma_f32_16x16x32_bf16 v[128:131], v[244:247], v[48:51], v[128:131]
    ds_read_b64_tr_b16 v[236:237], v5 offset:16416
    s_mov_b32 s23, 0xc000
    buffer_load_dwordx4 v[40:43], v6, s[8:11], s23 offen offset:2048 sc1
    v_mfma_f32_16x16x32_bf16 v[132:135], v[244:247], v[52:55], v[132:135]
    ds_read_b64_tr_b16 v[238:239], v5 offset:17440
    s_waitcnt lgkmcnt(6)
    v_mfma_f32_16x16x32_bf16 v[136:139], v[224:227], v[48:51], v[136:139]
    ds_read_b64_tr_b16 v[240:241], v4 offset:16640
    v_mfma_f32_16x16x32_bf16 v[140:143], v[224:227], v[52:55], v[140:143]
    ds_read_b64_tr_b16 v[242:243], v4 offset:17664
    s_mov_b32 s23, 0x2c000
    buffer_load_dwordx4 v[44:47], v6, s[8:11], s23 offen offset:2048 sc1
    s_waitcnt lgkmcnt(6)
    v_mfma_f32_16x16x32_bf16 v[144:147], v[228:231], v[48:51], v[144:147]
    ds_read_b64_tr_b16 v[244:245], v5 offset:16672
    v_mfma_f32_16x16x32_bf16 v[148:151], v[228:231], v[52:55], v[148:151]
    ds_read_b64_tr_b16 v[246:247], v5 offset:17696
    s_waitcnt vmcnt(15) lgkmcnt(6)
    v_mfma_f32_16x16x32_bf16 v[88:91], v[232:235], v[56:59], v[88:91]
    ds_read_b64_tr_b16 v[224:225], v4 offset:16896
    s_waitcnt vmcnt(14)
    v_mfma_f32_16x16x32_bf16 v[92:95], v[232:235], v[60:63], v[92:95]
    s_add_u32 s22, s24, 0x3a0000
    s_add_u32 m0, s20, 0x24000
    s_nop 0
    buffer_load_dwordx4 v3, s[4:7], s22 offen lds
    ds_read_b64_tr_b16 v[226:227], v4 offset:17920
    s_waitcnt lgkmcnt(6)
    v_mfma_f32_16x16x32_bf16 v[96:99], v[236:239], v[56:59], v[96:99]
    ds_read_b64_tr_b16 v[228:229], v5 offset:16928
    v_mfma_f32_16x16x32_bf16 v[100:103], v[236:239], v[60:63], v[100:103]
    ds_read_b64_tr_b16 v[230:231], v5 offset:17952
    s_waitcnt lgkmcnt(6)
    v_mfma_f32_16x16x32_bf16 v[104:107], v[240:243], v[56:59], v[104:107]
    s_add_u32 s22, s24, 0x3a2000
    s_add_u32 m0, s20, 0x24400
    s_nop 0
    buffer_load_dwordx4 v3, s[4:7], s22 offen lds
    ds_read_b64_tr_b16 v[232:233], v4 offset:17152
    v_mfma_f32_16x16x32_bf16 v[108:111], v[240:243], v[60:63], v[108:111]
    ds_read_b64_tr_b16 v[234:235], v4 offset:18176
    s_waitcnt lgkmcnt(6)
    v_mfma_f32_16x16x32_bf16 v[112:115], v[244:247], v[56:59], v[112:115]
    ds_read_b64_tr_b16 v[236:237], v5 offset:17184
    v_mfma_f32_16x16x32_bf16 v[116:119], v[244:247], v[60:63], v[116:119]
    ds_read_b64_tr_b16 v[238:239], v5 offset:18208
    s_waitcnt lgkmcnt(6)
    v_mfma_f32_16x16x32_bf16 v[120:123], v[224:227], v[56:59], v[120:123]
    v_mfma_f32_16x16x32_bf16 v[124:127], v[224:227], v[60:63], v[124:127]
    s_waitcnt vmcnt(14)
    s_barrier
    ds_read_b64_tr_b16 v[240:241], v4 offset:32768
    ds_read_b64_tr_b16 v[242:243], v4 offset:33792
    s_waitcnt lgkmcnt(6)
    v_mfma_f32_16x16x32_bf16 v[128:131], v[228:231], v[56:59], v[128:131]
    ds_read_b64_tr_b16 v[244:245], v5 offset:32800
    s_mov_b32 s23, 0xe000
    buffer_load_dwordx4 v[48:51], v6, s[8:11], s23 offen offset:2048 sc1
    v_mfma_f32_16x16x32_bf16 v[132:135], v[228:231], v[60:63], v[132:135]
    ds_read_b64_tr_b16 v[246:247], v5 offset:33824
    s_waitcnt lgkmcnt(6)
    v_mfma_f32_16x16x32_bf16 v[136:139], v[232:235], v[56:59], v[136:139]
    ds_read_b64_tr_b16 v[224:225], v4 offset:33024
    v_mfma_f32_16x16x32_bf16 v[140:143], v[232:235], v[60:63], v[140:143]
    ds_read_b64_tr_b16 v[226:227], v4 offset:34048
    s_mov_b32 s23, 0x2e000
    buffer_load_dwordx4 v[52:55], v6, s[8:11], s23 offen offset:2048 sc1
    s_waitcnt lgkmcnt(6)
    v_mfma_f32_16x16x32_bf16 v[144:147], v[236:239], v[56:59], v[144:147]
    ds_read_b64_tr_b16 v[228:229], v5 offset:33056
    v_mfma_f32_16x16x32_bf16 v[148:151], v[236:239], v[60:63], v[148:151]
    ds_read_b64_tr_b16 v[230:231], v5 offset:34080
    s_waitcnt vmcnt(6)
    v_cmp_ne_u32 vcc, s28, v12
    s_cbranch_vccnz adaLN_cond__sliding_block_cached__moe_arch_mod__prompt_kernel_o220r
adaLN_cond__sliding_block_cached__moe_arch_mod__prompt_kernel_o220b:
    s_waitcnt lgkmcnt(6)
    v_mfma_f32_16x16x32_bf16 v[88:91], v[240:243], v[24:27], v[88:91]
    ds_read_b64_tr_b16 v[232:233], v4 offset:33280
    v_mfma_f32_16x16x32_bf16 v[92:95], v[240:243], v[28:31], v[92:95]
    s_add_u32 s22, s24, 0x30000
    s_add_u32 m0, s20, 0x10000
    s_nop 0
    buffer_load_dwordx4 v3, s[4:7], s22 offen lds
    ds_read_b64_tr_b16 v[234:235], v4 offset:34304
    s_waitcnt lgkmcnt(6)
    v_mfma_f32_16x16x32_bf16 v[96:99], v[244:247], v[24:27], v[96:99]
    ds_read_b64_tr_b16 v[236:237], v5 offset:33312
    v_mfma_f32_16x16x32_bf16 v[100:103], v[244:247], v[28:31], v[100:103]
    ds_read_b64_tr_b16 v[238:239], v5 offset:34336
    s_waitcnt lgkmcnt(6)
    v_mfma_f32_16x16x32_bf16 v[104:107], v[224:227], v[24:27], v[104:107]
    s_add_u32 s22, s24, 0x32000
    s_add_u32 m0, s20, 0x10400
    s_nop 0
    buffer_load_dwordx4 v3, s[4:7], s22 offen lds
    ds_read_b64_tr_b16 v[240:241], v4 offset:33536
    v_mfma_f32_16x16x32_bf16 v[108:111], v[224:227], v[28:31], v[108:111]
    ds_read_b64_tr_b16 v[242:243], v4 offset:34560
    v_xor_b32 v16, s28, v184
    v_xor_b32 v17, s28, v185
    v_xor_b32 v18, s28, v186
    v_xor_b32 v19, s28, v187
    v_or3_b32 v16, v16, v17, v18
    v_or_b32 v16, v16, v19
    v_cmp_ne_u32 vcc, 0, v16
    s_cbranch_vccnz adaLN_cond__sliding_block_cached__moe_arch_mod__prompt_kernel_mf21r
adaLN_cond__sliding_block_cached__moe_arch_mod__prompt_kernel_mf21b:
    s_waitcnt lgkmcnt(6)
    v_mfma_f32_16x16x32_bf16 v[112:115], v[228:231], v[24:27], v[112:115]
    ds_read_b64_tr_b16 v[244:245], v5 offset:33568
    v_mfma_f32_16x16x32_bf16 v[116:119], v[228:231], v[28:31], v[116:119]
    ds_read_b64_tr_b16 v[246:247], v5 offset:34592
    s_waitcnt lgkmcnt(6)
    v_mfma_f32_16x16x32_bf16 v[120:123], v[232:235], v[24:27], v[120:123]
    v_mfma_f32_16x16x32_bf16 v[124:127], v[232:235], v[28:31], v[124:127]
    s_barrier
    ds_read_b64_tr_b16 v[224:225], v4 offset:49152
    ds_read_b64_tr_b16 v[226:227], v4 offset:50176
    s_waitcnt lgkmcnt(6)
    v_mfma_f32_16x16x32_bf16 v[128:131], v[236:239], v[24:27], v[128:131]
    ds_read_b64_tr_b16 v[228:229], v5 offset:49184
    s_mov_b32 s23, 0x0
    buffer_load_dwordx4 v[56:59], v6, s[8:11], s23 offen offset:3072 sc1
    v_mfma_f32_16x16x32_bf16 v[132:135], v[236:239], v[28:31], v[132:135]
    ds_read_b64_tr_b16 v[230:231], v5 offset:50208
    s_waitcnt lgkmcnt(6)
    v_mfma_f32_16x16x32_bf16 v[136:139], v[240:243], v[24:27], v[136:139]
    ds_read_b64_tr_b16 v[232:233], v4 offset:49408
    v_mfma_f32_16x16x32_bf16 v[140:143], v[240:243], v[28:31], v[140:143]
    ds_read_b64_tr_b16 v[234:235], v4 offset:50432
    s_mov_b32 s23, 0x20000
    buffer_load_dwordx4 v[60:63], v6, s[8:11], s23 offen offset:3072 sc1
    s_waitcnt lgkmcnt(6)
    v_mfma_f32_16x16x32_bf16 v[144:147], v[244:247], v[24:27], v[144:147]
    ds_read_b64_tr_b16 v[236:237], v5 offset:49440
    v_mfma_f32_16x16x32_bf16 v[148:151], v[244:247], v[28:31], v[148:151]
    ds_read_b64_tr_b16 v[238:239], v5 offset:50464
    s_waitcnt lgkmcnt(6)
    v_mfma_f32_16x16x32_bf16 v[88:91], v[224:227], v[32:35], v[88:91]
    ds_read_b64_tr_b16 v[240:241], v4 offset:49664
    v_mfma_f32_16x16x32_bf16 v[92:95], v[224:227], v[36:39], v[92:95]
    s_add_u32 s22, s24, 0xb0000
    s_add_u32 m0, s20, 0x14000
    s_nop 0
    buffer_load_dwordx4 v3, s[4:7], s22 offen lds
    ds_read_b64_tr_b16 v[242:243], v4 offset:50688
    s_waitcnt lgkmcnt(6)
    v_mfma_f32_16x16x32_bf16 v[96:99], v[228:231], v[32:35], v[96:99]
    ds_read_b64_tr_b16 v[244:245], v5 offset:49696
    v_mfma_f32_16x16x32_bf16 v[100:103], v[228:231], v[36:39], v[100:103]
    ds_read_b64_tr_b16 v[246:247], v5 offset:50720
    s_waitcnt lgkmcnt(6)
    v_mfma_f32_16x16x32_bf16 v[104:107], v[232:235], v[32:35], v[104:107]
    s_add_u32 s22, s24, 0xb2000
    s_add_u32 m0, s20, 0x14400
    s_nop 0
    buffer_load_dwordx4 v3, s[4:7], s22 offen lds
    ds_read_b64_tr_b16 v[224:225], v4 offset:49920
    v_mfma_f32_16x16x32_bf16 v[108:111], v[232:235], v[36:39], v[108:111]
    ds_read_b64_tr_b16 v[226:227], v4 offset:50944
    s_waitcnt lgkmcnt(6)
    v_mfma_f32_16x16x32_bf16 v[112:115], v[236:239], v[32:35], v[112:115]
    ds_read_b64_tr_b16 v[228:229], v5 offset:49952
    v_mfma_f32_16x16x32_bf16 v[116:119], v[236:239], v[36:39], v[116:119]
    ds_read_b64_tr_b16 v[230:231], v5 offset:50976
    s_waitcnt lgkmcnt(6)
    v_mfma_f32_16x16x32_bf16 v[120:123], v[240:243], v[32:35], v[120:123]
    v_mfma_f32_16x16x32_bf16 v[124:127], v[240:243], v[36:39], v[124:127]
    s_barrier
    ds_read_b64_tr_b16 v[232:233], v7 offset:0
    ds_read_b64_tr_b16 v[234:235], v7 offset:1024
    s_waitcnt lgkmcnt(6)
    v_mfma_f32_16x16x32_bf16 v[128:131], v[244:247], v[32:35], v[128:131]
    ds_read_b64_tr_b16 v[236:237], v8 offset:32
    s_mov_b32 s23, 0x2000
    buffer_load_dwordx4 v[24:27], v6, s[8:11], s23 offen offset:3072 sc1
    v_mfma_f32_16x16x32_bf16 v[132:135], v[244:247], v[36:39], v[132:135]
    ds_read_b64_tr_b16 v[238:239], v8 offset:1056
    s_waitcnt lgkmcnt(6)
    v_mfma_f32_16x16x32_bf16 v[136:139], v[224:227], v[32:35], v[136:139]
    ds_read_b64_tr_b16 v[240:241], v7 offset:256
    v_mfma_f32_16x16x32_bf16 v[140:143], v[224:227], v[36:39], v[140:143]
    ds_read_b64_tr_b16 v[242:243], v7 offset:1280
    s_mov_b32 s23, 0x22000
    buffer_load_dwordx4 v[28:31], v6, s[8:11], s23 offen offset:3072 sc1
    s_waitcnt lgkmcnt(6)
    v_mfma_f32_16x16x32_bf16 v[144:147], v[228:231], v[32:35], v[144:147]
    ds_read_b64_tr_b16 v[244:245], v8 offset:288
    v_mfma_f32_16x16x32_bf16 v[148:151], v[228:231], v[36:39], v[148:151]
    ds_read_b64_tr_b16 v[246:247], v8 offset:1312
    s_waitcnt vmcnt(13) lgkmcnt(6)
    v_mfma_f32_16x16x32_bf16 v[88:91], v[232:235], v[40:43], v[88:91]
    ds_read_b64_tr_b16 v[224:225], v7 offset:512
    s_waitcnt vmcnt(12)
    v_mfma_f32_16x16x32_bf16 v[92:95], v[232:235], v[44:47], v[92:95]
    s_add_u32 s22, s24, 0x130000
    s_add_u32 m0, s20, 0x18000
    s_nop 0
    buffer_load_dwordx4 v3, s[4:7], s22 offen lds
    ds_read_b64_tr_b16 v[226:227], v7 offset:1536
    s_waitcnt lgkmcnt(6)
    v_mfma_f32_16x16x32_bf16 v[96:99], v[236:239], v[40:43], v[96:99]
    ds_read_b64_tr_b16 v[228:229], v8 offset:544
    v_mfma_f32_16x16x32_bf16 v[100:103], v[236:239], v[44:47], v[100:103]
    ds_read_b64_tr_b16 v[230:231], v8 offset:1568
    s_waitcnt lgkmcnt(6)
    v_mfma_f32_16x16x32_bf16 v[104:107], v[240:243], v[40:43], v[104:107]
    s_add_u32 s22, s24, 0x132000
    s_add_u32 m0, s20, 0x18400
    s_nop 0
    buffer_load_dwordx4 v3, s[4:7], s22 offen lds
    ds_read_b64_tr_b16 v[232:233], v7 offset:768
    v_mfma_f32_16x16x32_bf16 v[108:111], v[240:243], v[44:47], v[108:111]
    ds_read_b64_tr_b16 v[234:235], v7 offset:1792
    s_waitcnt lgkmcnt(6)
    v_mfma_f32_16x16x32_bf16 v[112:115], v[244:247], v[40:43], v[112:115]
    ds_read_b64_tr_b16 v[236:237], v8 offset:800
    v_mfma_f32_16x16x32_bf16 v[116:119], v[244:247], v[44:47], v[116:119]
    ds_read_b64_tr_b16 v[238:239], v8 offset:1824
    s_waitcnt lgkmcnt(6)
    v_mfma_f32_16x16x32_bf16 v[120:123], v[224:227], v[40:43], v[120:123]
    v_mfma_f32_16x16x32_bf16 v[124:127], v[224:227], v[44:47], v[124:127]
    s_waitcnt vmcnt(12)
    s_barrier
    ds_read_b64_tr_b16 v[240:241], v7 offset:16384
    ds_read_b64_tr_b16 v[242:243], v7 offset:17408
    s_waitcnt lgkmcnt(6)
    v_mfma_f32_16x16x32_bf16 v[128:131], v[228:231], v[40:43], v[128:131]
    ds_read_b64_tr_b16 v[244:245], v8 offset:16416
    s_mov_b32 s23, 0x4000
    buffer_load_dwordx4 v[32:35], v6, s[8:11], s23 offen offset:3072 sc1
    v_mfma_f32_16x16x32_bf16 v[132:135], v[228:231], v[44:47], v[132:135]
    ds_read_b64_tr_b16 v[246:247], v8 offset:17440
    s_waitcnt lgkmcnt(6)
    v_mfma_f32_16x16x32_bf16 v[136:139], v[232:235], v[40:43], v[136:139]
    ds_read_b64_tr_b16 v[224:225], v7 offset:16640
    v_mfma_f32_16x16x32_bf16 v[140:143], v[232:235], v[44:47], v[140:143]
    ds_read_b64_tr_b16 v[226:227], v7 offset:17664
    s_mov_b32 s23, 0x24000
    buffer_load_dwordx4 v[36:39], v6, s[8:11], s23 offen offset:3072 sc1
    s_waitcnt lgkmcnt(6)
    v_mfma_f32_16x16x32_bf16 v[144:147], v[236:239], v[40:43], v[144:147]
    ds_read_b64_tr_b16 v[228:229], v8 offset:16672
    v_mfma_f32_16x16x32_bf16 v[148:151], v[236:239], v[44:47], v[148:151]
    ds_read_b64_tr_b16 v[230:231], v8 offset:17696
    s_waitcnt vmcnt(13) lgkmcnt(6)
    v_mfma_f32_16x16x32_bf16 v[88:91], v[240:243], v[48:51], v[88:91]
    ds_read_b64_tr_b16 v[232:233], v7 offset:16896
    s_waitcnt vmcnt(12)
    v_mfma_f32_16x16x32_bf16 v[92:95], v[240:243], v[52:55], v[92:95]
    s_add_u32 s22, s24, 0x1b0000
    s_add_u32 m0, s20, 0x1c000
    s_nop 0
    buffer_load_dwordx4 v3, s[4:7], s22 offen lds
    ds_read_b64_tr_b16 v[234:235], v7 offset:17920
    s_waitcnt lgkmcnt(6)
    v_mfma_f32_16x16x32_bf16 v[96:99], v[244:247], v[48:51], v[96:99]
    ds_read_b64_tr_b16 v[236:237], v8 offset:16928
    v_mfma_f32_16x16x32_bf16 v[100:103], v[244:247], v[52:55], v[100:103]
    ds_read_b64_tr_b16 v[238:239], v8 offset:17952
    s_waitcnt lgkmcnt(6)
    v_mfma_f32_16x16x32_bf16 v[104:107], v[224:227], v[48:51], v[104:107]
    s_add_u32 s22, s24, 0x1b2000
    s_add_u32 m0, s20, 0x1c400
    s_nop 0
    buffer_load_dwordx4 v3, s[4:7], s22 offen lds
    ds_read_b64_tr_b16 v[240:241], v7 offset:17152
    v_mfma_f32_16x16x32_bf16 v[108:111], v[224:227], v[52:55], v[108:111]
    ds_read_b64_tr_b16 v[242:243], v7 offset:18176
    s_waitcnt lgkmcnt(6)
    v_mfma_f32_16x16x32_bf16 v[112:115], v[228:231], v[48:51], v[112:115]
    ds_read_b64_tr_b16 v[244:245], v8 offset:17184
    v_mfma_f32_16x16x32_bf16 v[116:119], v[228:231], v[52:55], v[116:119]
    ds_read_b64_tr_b16 v[246:247], v8 offset:18208
    s_waitcnt lgkmcnt(6)
    v_mfma_f32_16x16x32_bf16 v[120:123], v[232:235], v[48:51], v[120:123]
    v_mfma_f32_16x16x32_bf16 v[124:127], v[232:235], v[52:55], v[124:127]
    s_waitcnt vmcnt(12)
    s_barrier
    ds_read_b64_tr_b16 v[224:225], v4 offset:0
    ds_read_b64_tr_b16 v[226:227], v4 offset:1024
    s_waitcnt lgkmcnt(6)
    v_mfma_f32_16x16x32_bf16 v[128:131], v[236:239], v[48:51], v[128:131]
    ds_read_b64_tr_b16 v[228:229], v5 offset:32
    s_mov_b32 s23, 0x6000
    buffer_load_dwordx4 v[40:43], v6, s[8:11], s23 offen offset:3072 sc1
    v_mfma_f32_16x16x32_bf16 v[132:135], v[236:239], v[52:55], v[132:135]
    ds_read_b64_tr_b16 v[230:231], v5 offset:1056
    s_waitcnt lgkmcnt(6)
    v_mfma_f32_16x16x32_bf16 v[136:139], v[240:243], v[48:51], v[136:139]
    ds_read_b64_tr_b16 v[232:233], v4 offset:256
    v_mfma_f32_16x16x32_bf16 v[140:143], v[240:243], v[52:55], v[140:143]
    ds_read_b64_tr_b16 v[234:235], v4 offset:1280
    s_mov_b32 s23, 0x26000
    buffer_load_dwordx4 v[44:47], v6, s[8:11], s23 offen offset:3072 sc1
    s_waitcnt lgkmcnt(6)
    v_mfma_f32_16x16x32_bf16 v[144:147], v[244:247], v[48:51], v[144:147]
    ds_read_b64_tr_b16 v[236:237], v5 offset:288
    v_mfma_f32_16x16x32_bf16 v[148:151], v[244:247], v[52:55], v[148:151]
    ds_read_b64_tr_b16 v[238:239], v5 offset:1312
    s_waitcnt vmcnt(13) lgkmcnt(6)
    v_mfma_f32_16x16x32_bf16 v[88:91], v[224:227], v[56:59], v[88:91]
    ds_read_b64_tr_b16 v[240:241], v4 offset:512
    s_waitcnt vmcnt(12)
    v_mfma_f32_16x16x32_bf16 v[92:95], v[224:227], v[60:63], v[92:95]
    s_add_u32 s22, s24, 0x230000
    s_add_u32 m0, s20, 0x20000
    s_nop 0
    buffer_load_dwordx4 v3, s[4:7], s22 offen lds
    ds_read_b64_tr_b16 v[242:243], v4 offset:1536
    s_waitcnt lgkmcnt(6)
    v_mfma_f32_16x16x32_bf16 v[96:99], v[228:231], v[56:59], v[96:99]
    ds_read_b64_tr_b16 v[244:245], v5 offset:544
    v_mfma_f32_16x16x32_bf16 v[100:103], v[228:231], v[60:63], v[100:103]
    ds_read_b64_tr_b16 v[246:247], v5 offset:1568
    s_waitcnt lgkmcnt(6)
    v_mfma_f32_16x16x32_bf16 v[104:107], v[232:235], v[56:59], v[104:107]
    s_add_u32 s22, s24, 0x232000
    s_add_u32 m0, s20, 0x20400
    s_nop 0
    buffer_load_dwordx4 v3, s[4:7], s22 offen lds
    ds_read_b64_tr_b16 v[224:225], v4 offset:768
    v_mfma_f32_16x16x32_bf16 v[108:111], v[232:235], v[60:63], v[108:111]
    ds_read_b64_tr_b16 v[226:227], v4 offset:1792
    s_waitcnt lgkmcnt(6)
    v_mfma_f32_16x16x32_bf16 v[112:115], v[236:239], v[56:59], v[112:115]
    ds_read_b64_tr_b16 v[228:229], v5 offset:800
    v_mfma_f32_16x16x32_bf16 v[116:119], v[236:239], v[60:63], v[116:119]
    ds_read_b64_tr_b16 v[230:231], v5 offset:1824
    s_waitcnt lgkmcnt(6)
    v_mfma_f32_16x16x32_bf16 v[120:123], v[240:243], v[56:59], v[120:123]
    v_mfma_f32_16x16x32_bf16 v[124:127], v[240:243], v[60:63], v[124:127]
    s_waitcnt vmcnt(12)
    s_barrier
    ds_read_b64_tr_b16 v[232:233], v4 offset:16384
    ds_read_b64_tr_b16 v[234:235], v4 offset:17408
    s_waitcnt lgkmcnt(6)
    v_mfma_f32_16x16x32_bf16 v[128:131], v[244:247], v[56:59], v[128:131]
    ds_read_b64_tr_b16 v[236:237], v5 offset:16416
    s_mov_b32 s23, 0x8000
    buffer_load_dwordx4 v[48:51], v6, s[8:11], s23 offen offset:3072 sc1
    v_mfma_f32_16x16x32_bf16 v[132:135], v[244:247], v[60:63], v[132:135]
    ds_read_b64_tr_b16 v[238:239], v5 offset:17440
    s_waitcnt lgkmcnt(6)
    v_mfma_f32_16x16x32_bf16 v[136:139], v[224:227], v[56:59], v[136:139]
    ds_read_b64_tr_b16 v[240:241], v4 offset:16640
    v_mfma_f32_16x16x32_bf16 v[140:143], v[224:227], v[60:63], v[140:143]
    ds_read_b64_tr_b16 v[242:243], v4 offset:17664
    s_mov_b32 s23, 0x28000
    buffer_load_dwordx4 v[52:55], v6, s[8:11], s23 offen offset:3072 sc1
    s_waitcnt lgkmcnt(6)
    v_mfma_f32_16x16x32_bf16 v[144:147], v[228:231], v[56:59], v[144:147]
    ds_read_b64_tr_b16 v[244:245], v5 offset:16672
    v_mfma_f32_16x16x32_bf16 v[148:151], v[228:231], v[60:63], v[148:151]
    ds_read_b64_tr_b16 v[246:247], v5 offset:17696
    s_waitcnt vmcnt(13) lgkmcnt(6)
    v_mfma_f32_16x16x32_bf16 v[88:91], v[232:235], v[24:27], v[88:91]
    ds_read_b64_tr_b16 v[224:225], v4 offset:16896
    s_waitcnt vmcnt(12)
    v_mfma_f32_16x16x32_bf16 v[92:95], v[232:235], v[28:31], v[92:95]
    s_add_u32 s22, s24, 0x2b0000
    s_add_u32 m0, s20, 0x24000
    s_nop 0
    buffer_load_dwordx4 v3, s[4:7], s22 offen lds
    ds_read_b64_tr_b16 v[226:227], v4 offset:17920
    s_waitcnt lgkmcnt(6)
    v_mfma_f32_16x16x32_bf16 v[96:99], v[236:239], v[24:27], v[96:99]
    ds_read_b64_tr_b16 v[228:229], v5 offset:16928
    v_mfma_f32_16x16x32_bf16 v[100:103], v[236:239], v[28:31], v[100:103]
    ds_read_b64_tr_b16 v[230:231], v5 offset:17952
    s_waitcnt lgkmcnt(6)
    v_mfma_f32_16x16x32_bf16 v[104:107], v[240:243], v[24:27], v[104:107]
    s_add_u32 s22, s24, 0x2b2000
    s_add_u32 m0, s20, 0x24400
    s_nop 0
    buffer_load_dwordx4 v3, s[4:7], s22 offen lds
    ds_read_b64_tr_b16 v[232:233], v4 offset:17152
    v_mfma_f32_16x16x32_bf16 v[108:111], v[240:243], v[28:31], v[108:111]
    ds_read_b64_tr_b16 v[234:235], v4 offset:18176
    s_waitcnt lgkmcnt(6)
    v_mfma_f32_16x16x32_bf16 v[112:115], v[244:247], v[24:27], v[112:115]
    ds_read_b64_tr_b16 v[236:237], v5 offset:17184
    v_mfma_f32_16x16x32_bf16 v[116:119], v[244:247], v[28:31], v[116:119]
    ds_read_b64_tr_b16 v[238:239], v5 offset:18208
    s_waitcnt lgkmcnt(6)
    v_mfma_f32_16x16x32_bf16 v[120:123], v[224:227], v[24:27], v[120:123]
    v_mfma_f32_16x16x32_bf16 v[124:127], v[224:227], v[28:31], v[124:127]
    s_waitcnt vmcnt(12)
    s_barrier
    ds_read_b64_tr_b16 v[240:241], v4 offset:32768
    ds_read_b64_tr_b16 v[242:243], v4 offset:33792
    s_waitcnt lgkmcnt(6)
    v_mfma_f32_16x16x32_bf16 v[128:131], v[228:231], v[24:27], v[128:131]
    ds_read_b64_tr_b16 v[244:245], v5 offset:32800
    s_mov_b32 s23, 0xa000
    buffer_load_dwordx4 v[56:59], v6, s[8:11], s23 offen offset:3072 sc1
    v_mfma_f32_16x16x32_bf16 v[132:135], v[228:231], v[28:31], v[132:135]
    ds_read_b64_tr_b16 v[246:247], v5 offset:33824
    s_waitcnt lgkmcnt(6)
    v_mfma_f32_16x16x32_bf16 v[136:139], v[232:235], v[24:27], v[136:139]
    ds_read_b64_tr_b16 v[224:225], v4 offset:33024
    v_mfma_f32_16x16x32_bf16 v[140:143], v[232:235], v[28:31], v[140:143]
    ds_read_b64_tr_b16 v[226:227], v4 offset:34048
    s_mov_b32 s23, 0x2a000
    buffer_load_dwordx4 v[60:63], v6, s[8:11], s23 offen offset:3072 sc1
    s_waitcnt lgkmcnt(6)
    v_mfma_f32_16x16x32_bf16 v[144:147], v[236:239], v[24:27], v[144:147]
    ds_read_b64_tr_b16 v[228:229], v5 offset:33056
    v_mfma_f32_16x16x32_bf16 v[148:151], v[236:239], v[28:31], v[148:151]
    ds_read_b64_tr_b16 v[230:231], v5 offset:34080
    s_waitcnt vmcnt(13) lgkmcnt(6)
    v_mfma_f32_16x16x32_bf16 v[88:91], v[240:243], v[32:35], v[88:91]
    ds_read_b64_tr_b16 v[232:233], v4 offset:33280
    s_waitcnt vmcnt(12)
    v_mfma_f32_16x16x32_bf16 v[92:95], v[240:243], v[36:39], v[92:95]
    s_add_u32 s22, s24, 0x330000
    s_add_u32 m0, s20, 0x10000
    s_nop 0
    buffer_load_dwordx4 v3, s[4:7], s22 offen lds
    ds_read_b64_tr_b16 v[234:235], v4 offset:34304
    s_waitcnt lgkmcnt(6)
    v_mfma_f32_16x16x32_bf16 v[96:99], v[244:247], v[32:35], v[96:99]
    ds_read_b64_tr_b16 v[236:237], v5 offset:33312
    v_mfma_f32_16x16x32_bf16 v[100:103], v[244:247], v[36:39], v[100:103]
    ds_read_b64_tr_b16 v[238:239], v5 offset:34336
    s_waitcnt lgkmcnt(6)
    v_mfma_f32_16x16x32_bf16 v[104:107], v[224:227], v[32:35], v[104:107]
    s_add_u32 s22, s24, 0x332000
    s_add_u32 m0, s20, 0x10400
    s_nop 0
    buffer_load_dwordx4 v3, s[4:7], s22 offen lds
    ds_read_b64_tr_b16 v[240:241], v4 offset:33536
    v_mfma_f32_16x16x32_bf16 v[108:111], v[224:227], v[36:39], v[108:111]
    ds_read_b64_tr_b16 v[242:243], v4 offset:34560
    v_lshrrev_b32 v16, 4, v1
    v_lshlrev_b32 v16, 3, v16
    s_lshl_b32 s16, s31, 8
    s_add_u32 s16, s16, 0x540080
    buffer_load_dwordx2 v[248:249], v16, s[8:11], s16 offen offset:0 sc1
    buffer_load_dwordx2 v[250:251], v16, s[8:11], s16 offen offset:32 sc1
    buffer_load_dwordx2 v[252:253], v16, s[8:11], s16 offen offset:64 sc1
    buffer_load_dwordx2 v[254:255], v16, s[8:11], s16 offen offset:96 sc1
    s_waitcnt lgkmcnt(6)
    v_mfma_f32_16x16x32_bf16 v[112:115], v[228:231], v[32:35], v[112:115]
    ds_read_b64_tr_b16 v[244:245], v5 offset:33568
    v_mfma_f32_16x16x32_bf16 v[116:119], v[228:231], v[36:39], v[116:119]
    ds_read_b64_tr_b16 v[246:247], v5 offset:34592
    s_waitcnt lgkmcnt(6)
    v_mfma_f32_16x16x32_bf16 v[120:123], v[232:235], v[32:35], v[120:123]
    v_mfma_f32_16x16x32_bf16 v[124:127], v[232:235], v[36:39], v[124:127]
    s_waitcnt vmcnt(16)
    s_barrier
    ds_read_b64_tr_b16 v[224:225], v4 offset:49152
    ds_read_b64_tr_b16 v[226:227], v4 offset:50176
    s_waitcnt lgkmcnt(6)
    v_mfma_f32_16x16x32_bf16 v[128:131], v[236:239], v[32:35], v[128:131]
    ds_read_b64_tr_b16 v[228:229], v5 offset:49184
    s_mov_b32 s23, 0xc000
    buffer_load_dwordx4 v[24:27], v6, s[8:11], s23 offen offset:3072 sc1
    v_mfma_f32_16x16x32_bf16 v[132:135], v[236:239], v[36:39], v[132:135]
    ds_read_b64_tr_b16 v[230:231], v5 offset:50208
    s_waitcnt lgkmcnt(6)
    v_mfma_f32_16x16x32_bf16 v[136:139], v[240:243], v[32:35], v[136:139]
    ds_read_b64_tr_b16 v[232:233], v4 offset:49408
    v_mfma_f32_16x16x32_bf16 v[140:143], v[240:243], v[36:39], v[140:143]
    ds_read_b64_tr_b16 v[234:235], v4 offset:50432
    s_mov_b32 s23, 0x2c000
    buffer_load_dwordx4 v[28:31], v6, s[8:11], s23 offen offset:3072 sc1
    s_waitcnt lgkmcnt(6)
    v_mfma_f32_16x16x32_bf16 v[144:147], v[244:247], v[32:35], v[144:147]
    ds_read_b64_tr_b16 v[236:237], v5 offset:49440
    v_mfma_f32_16x16x32_bf16 v[148:151], v[244:247], v[36:39], v[148:151]
    ds_read_b64_tr_b16 v[238:239], v5 offset:50464
    s_waitcnt vmcnt(17) lgkmcnt(6)
    v_mfma_f32_16x16x32_bf16 v[88:91], v[224:227], v[40:43], v[88:91]
    ds_read_b64_tr_b16 v[240:241], v4 offset:49664
    s_waitcnt vmcnt(16)
    v_mfma_f32_16x16x32_bf16 v[92:95], v[224:227], v[44:47], v[92:95]
    s_add_u32 s22, s24, 0x3b0000
    s_add_u32 m0, s20, 0x14000
    s_nop 0
    buffer_load_dwordx4 v3, s[4:7], s22 offen lds
    ds_read_b64_tr_b16 v[242:243], v4 offset:50688
    s_waitcnt lgkmcnt(6)
    v_mfma_f32_16x16x32_bf16 v[96:99], v[228:231], v[40:43], v[96:99]
    ds_read_b64_tr_b16 v[244:245], v5 offset:49696
    v_mfma_f32_16x16x32_bf16 v[100:103], v[228:231], v[44:47], v[100:103]
    ds_read_b64_tr_b16 v[246:247], v5 offset:50720
    s_waitcnt lgkmcnt(6)
    v_mfma_f32_16x16x32_bf16 v[104:107], v[232:235], v[40:43], v[104:107]
    s_add_u32 s22, s24, 0x3b2000
    s_add_u32 m0, s20, 0x14400
    s_nop 0
    buffer_load_dwordx4 v3, s[4:7], s22 offen lds
    ds_read_b64_tr_b16 v[224:225], v4 offset:49920
    v_mfma_f32_16x16x32_bf16 v[108:111], v[232:235], v[44:47], v[108:111]
    ds_read_b64_tr_b16 v[226:227], v4 offset:50944
    s_waitcnt lgkmcnt(6)
    v_mfma_f32_16x16x32_bf16 v[112:115], v[236:239], v[40:43], v[112:115]
    ds_read_b64_tr_b16 v[228:229], v5 offset:49952
    v_mfma_f32_16x16x32_bf16 v[116:119], v[236:239], v[44:47], v[116:119]
    ds_read_b64_tr_b16 v[230:231], v5 offset:50976
    s_waitcnt lgkmcnt(6)
    v_mfma_f32_16x16x32_bf16 v[120:123], v[240:243], v[40:43], v[120:123]
    v_mfma_f32_16x16x32_bf16 v[124:127], v[240:243], v[44:47], v[124:127]
    s_waitcnt vmcnt(16)
    s_barrier
    ds_read_b64_tr_b16 v[232:233], v7 offset:0
    ds_read_b64_tr_b16 v[234:235], v7 offset:1024
    s_waitcnt lgkmcnt(6)
    v_mfma_f32_16x16x32_bf16 v[128:131], v[244:247], v[40:43], v[128:131]
    ds_read_b64_tr_b16 v[236:237], v8 offset:32
    s_mov_b32 s23, 0xe000
    buffer_load_dwordx4 v[32:35], v6, s[8:11], s23 offen offset:3072 sc1
    v_mfma_f32_16x16x32_bf16 v[132:135], v[244:247], v[44:47], v[132:135]
    ds_read_b64_tr_b16 v[238:239], v8 offset:1056
    s_waitcnt lgkmcnt(6)
    v_mfma_f32_16x16x32_bf16 v[136:139], v[224:227], v[40:43], v[136:139]
    ds_read_b64_tr_b16 v[240:241], v7 offset:256
    v_mfma_f32_16x16x32_bf16 v[140:143], v[224:227], v[44:47], v[140:143]
    ds_read_b64_tr_b16 v[242:243], v7 offset:1280
    s_mov_b32 s23, 0x2e000
    buffer_load_dwordx4 v[36:39], v6, s[8:11], s23 offen offset:3072 sc1
    s_waitcnt lgkmcnt(6)
    v_mfma_f32_16x16x32_bf16 v[144:147], v[228:231], v[40:43], v[144:147]
    ds_read_b64_tr_b16 v[244:245], v8 offset:288
    v_mfma_f32_16x16x32_bf16 v[148:151], v[228:231], v[44:47], v[148:151]
    ds_read_b64_tr_b16 v[246:247], v8 offset:1312
    s_waitcnt vmcnt(17) lgkmcnt(6)
    v_mfma_f32_16x16x32_bf16 v[88:91], v[232:235], v[48:51], v[88:91]
    ds_read_b64_tr_b16 v[224:225], v7 offset:512
    s_waitcnt vmcnt(16)
    v_mfma_f32_16x16x32_bf16 v[92:95], v[232:235], v[52:55], v[92:95]
    ds_read_b64_tr_b16 v[226:227], v7 offset:1536
    s_waitcnt lgkmcnt(6)
    v_mfma_f32_16x16x32_bf16 v[96:99], v[236:239], v[48:51], v[96:99]
    ds_read_b64_tr_b16 v[228:229], v8 offset:544
    v_mfma_f32_16x16x32_bf16 v[100:103], v[236:239], v[52:55], v[100:103]
    ds_read_b64_tr_b16 v[230:231], v8 offset:1568
    s_waitcnt lgkmcnt(6)
    v_mfma_f32_16x16x32_bf16 v[104:107], v[240:243], v[48:51], v[104:107]
    ds_read_b64_tr_b16 v[232:233], v7 offset:768
    v_mfma_f32_16x16x32_bf16 v[108:111], v[240:243], v[52:55], v[108:111]
    ds_read_b64_tr_b16 v[234:235], v7 offset:1792
    s_waitcnt lgkmcnt(6)
    v_mfma_f32_16x16x32_bf16 v[112:115], v[244:247], v[48:51], v[112:115]
    ds_read_b64_tr_b16 v[236:237], v8 offset:800
    v_mfma_f32_16x16x32_bf16 v[116:119], v[244:247], v[52:55], v[116:119]
    ds_read_b64_tr_b16 v[238:239], v8 offset:1824
    s_waitcnt lgkmcnt(6)
    v_mfma_f32_16x16x32_bf16 v[120:123], v[224:227], v[48:51], v[120:123]
    s_mov_b64 s[72:73], s[48:49]
    s_mov_b32 s74, 0x700000
    s_mov_b32 s75, 0x20000
    s_cmp_lt_u32 s2, 224
    s_cselect_b32 s74, 7340032, 0
    s_and_b32 s16, s3, 3
    v_lshrrev_b32 v20, 3, v1
    v_lshlrev_b32 v20, 3, v20
    s_lshl_b32 s17, s16, 6
    v_add_u32 v20, s17, v20
    s_mov_b32 s17, 7168
    v_mul_lo_u32 v21, s17, v20
    v_and_b32 v20, 7, v1
    v_lshl_add_u32 v21, v20, 4, v21
    s_and_b32 s17, s29, 3
    s_mul_i32 s18, s17, 1835008
    s_lshr_b32 s17, s29, 2
    s_lshl_b32 s17, s17, 7
    s_add_u32 s18, s18, s17
    s_lshl_b32 s16, s16, 13
    s_add_u32 s22, s18, 0
    s_add_u32 m0, s16, 32768
    s_nop 0
    buffer_load_dwordx4 v21, s[72:75], s22 offen lds
    s_add_u32 s22, s18, 7168
    s_add_u32 m0, s16, 33792
    s_nop 0
    buffer_load_dwordx4 v21, s[72:75], s22 offen lds
    s_add_u32 s22, s18, 14336
    s_add_u32 m0, s16, 34816
    s_nop 0
    buffer_load_dwordx4 v21, s[72:75], s22 offen lds
    s_add_u32 s22, s18, 21504
    s_add_u32 m0, s16, 35840
    s_nop 0
    buffer_load_dwordx4 v21, s[72:75], s22 offen lds
    s_add_u32 s22, s18, 28672
    s_add_u32 m0, s16, 36864
    s_nop 0
    buffer_load_dwordx4 v21, s[72:75], s22 offen lds
    s_add_u32 s22, s18, 35840
    s_add_u32 m0, s16, 37888
    s_nop 0
    buffer_load_dwordx4 v21, s[72:75], s22 offen lds
    s_add_u32 s22, s18, 43008
    s_add_u32 m0, s16, 38912
    s_nop 0
    buffer_load_dwordx4 v21, s[72:75], s22 offen lds
    s_add_u32 s22, s18, 50176
    s_add_u32 m0, s16, 39936
    s_nop 0
    buffer_load_dwordx4 v21, s[72:75], s22 offen lds
    v_mfma_f32_16x16x32_bf16 v[124:127], v[224:227], v[52:55], v[124:127]
    s_waitcnt vmcnt(22)
    s_barrier
    ds_read_b64_tr_b16 v[240:241], v7 offset:16384
    ds_read_b64_tr_b16 v[242:243], v7 offset:17408
    s_waitcnt lgkmcnt(6)
    v_mfma_f32_16x16x32_bf16 v[128:131], v[228:231], v[48:51], v[128:131]
    ds_read_b64_tr_b16 v[244:245], v8 offset:16416
    v_mfma_f32_16x16x32_bf16 v[132:135], v[228:231], v[52:55], v[132:135]
    ds_read_b64_tr_b16 v[246:247], v8 offset:17440
    s_waitcnt lgkmcnt(6)
    v_mfma_f32_16x16x32_bf16 v[136:139], v[232:235], v[48:51], v[136:139]
    ds_read_b64_tr_b16 v[224:225], v7 offset:16640
    v_mfma_f32_16x16x32_bf16 v[140:143], v[232:235], v[52:55], v[140:143]
    ds_read_b64_tr_b16 v[226:227], v7 offset:17664
    s_waitcnt lgkmcnt(6)
    v_mfma_f32_16x16x32_bf16 v[144:147], v[236:239], v[48:51], v[144:147]
    ds_read_b64_tr_b16 v[228:229], v8 offset:16672
    v_mfma_f32_16x16x32_bf16 v[148:151], v[236:239], v[52:55], v[148:151]
    ds_read_b64_tr_b16 v[230:231], v8 offset:17696
    s_waitcnt vmcnt(21) lgkmcnt(6)
    v_mfma_f32_16x16x32_bf16 v[88:91], v[240:243], v[56:59], v[88:91]
    ds_read_b64_tr_b16 v[232:233], v7 offset:16896
    s_waitcnt vmcnt(20)
    v_mfma_f32_16x16x32_bf16 v[92:95], v[240:243], v[60:63], v[92:95]
    ds_read_b64_tr_b16 v[234:235], v7 offset:17920
    s_waitcnt lgkmcnt(6)
    v_mfma_f32_16x16x32_bf16 v[96:99], v[244:247], v[56:59], v[96:99]
    ds_read_b64_tr_b16 v[236:237], v8 offset:16928
    v_mfma_f32_16x16x32_bf16 v[100:103], v[244:247], v[60:63], v[100:103]
    ds_read_b64_tr_b16 v[238:239], v8 offset:17952
    s_waitcnt lgkmcnt(6)
    v_mfma_f32_16x16x32_bf16 v[104:107], v[224:227], v[56:59], v[104:107]
    ds_read_b64_tr_b16 v[240:241], v7 offset:17152
    v_mfma_f32_16x16x32_bf16 v[108:111], v[224:227], v[60:63], v[108:111]
    ds_read_b64_tr_b16 v[242:243], v7 offset:18176
    s_waitcnt lgkmcnt(6)
    v_mfma_f32_16x16x32_bf16 v[112:115], v[228:231], v[56:59], v[112:115]
    ds_read_b64_tr_b16 v[244:245], v8 offset:17184
    v_mfma_f32_16x16x32_bf16 v[116:119], v[228:231], v[60:63], v[116:119]
    ds_read_b64_tr_b16 v[246:247], v8 offset:18208
    s_waitcnt lgkmcnt(6)
    v_mfma_f32_16x16x32_bf16 v[120:123], v[232:235], v[56:59], v[120:123]
    v_mfma_f32_16x16x32_bf16 v[124:127], v[232:235], v[60:63], v[124:127]
    s_waitcnt vmcnt(18)
    s_barrier
    ds_read_b64_tr_b16 v[224:225], v4 offset:0
    ds_read_b64_tr_b16 v[226:227], v4 offset:1024
    s_waitcnt lgkmcnt(6)
    v_mfma_f32_16x16x32_bf16 v[128:131], v[236:239], v[56:59], v[128:131]
    ds_read_b64_tr_b16 v[228:229], v5 offset:32
    v_mfma_f32_16x16x32_bf16 v[132:135], v[236:239], v[60:63], v[132:135]
    ds_read_b64_tr_b16 v[230:231], v5 offset:1056
    s_waitcnt lgkmcnt(6)
    v_mfma_f32_16x16x32_bf16 v[136:139], v[240:243], v[56:59], v[136:139]
    ds_read_b64_tr_b16 v[232:233], v4 offset:256
    v_mfma_f32_16x16x32_bf16 v[140:143], v[240:243], v[60:63], v[140:143]
    ds_read_b64_tr_b16 v[234:235], v4 offset:1280
    s_waitcnt lgkmcnt(6)
    v_mfma_f32_16x16x32_bf16 v[144:147], v[244:247], v[56:59], v[144:147]
    ds_read_b64_tr_b16 v[236:237], v5 offset:288
    v_mfma_f32_16x16x32_bf16 v[148:151], v[244:247], v[60:63], v[148:151]
    ds_read_b64_tr_b16 v[238:239], v5 offset:1312
    s_waitcnt vmcnt(13) lgkmcnt(6)
    v_mfma_f32_16x16x32_bf16 v[88:91], v[224:227], v[24:27], v[88:91]
    ds_read_b64_tr_b16 v[240:241], v4 offset:512
    s_waitcnt vmcnt(12)
    v_mfma_f32_16x16x32_bf16 v[92:95], v[224:227], v[28:31], v[92:95]
    ds_read_b64_tr_b16 v[242:243], v4 offset:1536
    s_waitcnt lgkmcnt(6)
    v_mfma_f32_16x16x32_bf16 v[96:99], v[228:231], v[24:27], v[96:99]
    ds_read_b64_tr_b16 v[244:245], v5 offset:544
    v_mfma_f32_16x16x32_bf16 v[100:103], v[228:231], v[28:31], v[100:103]
    ds_read_b64_tr_b16 v[246:247], v5 offset:1568
    s_waitcnt lgkmcnt(6)
    v_mfma_f32_16x16x32_bf16 v[104:107], v[232:235], v[24:27], v[104:107]
    ds_read_b64_tr_b16 v[224:225], v4 offset:768
    v_mfma_f32_16x16x32_bf16 v[108:111], v[232:235], v[28:31], v[108:111]
    ds_read_b64_tr_b16 v[226:227], v4 offset:1792
    s_waitcnt lgkmcnt(6)
    v_mfma_f32_16x16x32_bf16 v[112:115], v[236:239], v[24:27], v[112:115]
    ds_read_b64_tr_b16 v[228:229], v5 offset:800
    v_mfma_f32_16x16x32_bf16 v[116:119], v[236:239], v[28:31], v[116:119]
    ds_read_b64_tr_b16 v[230:231], v5 offset:1824
    s_waitcnt lgkmcnt(6)
    v_mfma_f32_16x16x32_bf16 v[120:123], v[240:243], v[24:27], v[120:123]
    v_mfma_f32_16x16x32_bf16 v[124:127], v[240:243], v[28:31], v[124:127]
    s_waitcnt vmcnt(10)
    s_barrier
    ds_read_b64_tr_b16 v[232:233], v4 offset:16384
    ds_read_b64_tr_b16 v[234:235], v4 offset:17408
    s_waitcnt lgkmcnt(6)
    v_mfma_f32_16x16x32_bf16 v[128:131], v[244:247], v[24:27], v[128:131]
    ds_read_b64_tr_b16 v[236:237], v5 offset:16416
    v_mfma_f32_16x16x32_bf16 v[132:135], v[244:247], v[28:31], v[132:135]
    ds_read_b64_tr_b16 v[238:239], v5 offset:17440
    s_waitcnt lgkmcnt(6)
    v_mfma_f32_16x16x32_bf16 v[136:139], v[224:227], v[24:27], v[136:139]
    ds_read_b64_tr_b16 v[240:241], v4 offset:16640
    v_mfma_f32_16x16x32_bf16 v[140:143], v[224:227], v[28:31], v[140:143]
    ds_read_b64_tr_b16 v[242:243], v4 offset:17664
    s_waitcnt lgkmcnt(6)
    v_mfma_f32_16x16x32_bf16 v[144:147], v[228:231], v[24:27], v[144:147]
    ds_read_b64_tr_b16 v[244:245], v5 offset:16672
    v_mfma_f32_16x16x32_bf16 v[148:151], v[228:231], v[28:31], v[148:151]
    ds_read_b64_tr_b16 v[246:247], v5 offset:17696
    s_waitcnt vmcnt(9) lgkmcnt(6)
    v_mfma_f32_16x16x32_bf16 v[88:91], v[232:235], v[32:35], v[88:91]
    ds_read_b64_tr_b16 v[224:225], v4 offset:16896
    s_waitcnt vmcnt(8)
    v_mfma_f32_16x16x32_bf16 v[92:95], v[232:235], v[36:39], v[92:95]
    ds_read_b64_tr_b16 v[226:227], v4 offset:17920
    s_waitcnt lgkmcnt(6)
    v_mfma_f32_16x16x32_bf16 v[96:99], v[236:239], v[32:35], v[96:99]
    ds_read_b64_tr_b16 v[228:229], v5 offset:16928
    v_mfma_f32_16x16x32_bf16 v[100:103], v[236:239], v[36:39], v[100:103]
    ds_read_b64_tr_b16 v[230:231], v5 offset:17952
    s_waitcnt lgkmcnt(6)
    v_mfma_f32_16x16x32_bf16 v[104:107], v[240:243], v[32:35], v[104:107]
    ds_read_b64_tr_b16 v[232:233], v4 offset:17152
    v_mfma_f32_16x16x32_bf16 v[108:111], v[240:243], v[36:39], v[108:111]
    ds_read_b64_tr_b16 v[234:235], v4 offset:18176
    s_waitcnt lgkmcnt(6)
    v_mfma_f32_16x16x32_bf16 v[112:115], v[244:247], v[32:35], v[112:115]
    ds_read_b64_tr_b16 v[236:237], v5 offset:17184
    v_mfma_f32_16x16x32_bf16 v[116:119], v[244:247], v[36:39], v[116:119]
    ds_read_b64_tr_b16 v[238:239], v5 offset:18208
    s_waitcnt lgkmcnt(6)
    v_mfma_f32_16x16x32_bf16 v[120:123], v[224:227], v[32:35], v[120:123]
    v_mfma_f32_16x16x32_bf16 v[124:127], v[224:227], v[36:39], v[124:127]
    s_waitcnt lgkmcnt(4)
    v_mfma_f32_16x16x32_bf16 v[128:131], v[228:231], v[32:35], v[128:131]
    v_mfma_f32_16x16x32_bf16 v[132:135], v[228:231], v[36:39], v[132:135]
    s_waitcnt lgkmcnt(2)
    v_mfma_f32_16x16x32_bf16 v[136:139], v[232:235], v[32:35], v[136:139]
    v_mfma_f32_16x16x32_bf16 v[140:143], v[232:235], v[36:39], v[140:143]
    s_waitcnt lgkmcnt(0)
    v_mfma_f32_16x16x32_bf16 v[144:147], v[236:239], v[32:35], v[144:147]
    v_mfma_f32_16x16x32_bf16 v[148:151], v[236:239], v[36:39], v[148:151]
    s_lshl_b32 s16, s3, 13
    s_xor_b32 s17, s16, 0x8000
    s_add_u32 s16, s16, 0x18000
    s_add_u32 s17, s17, 0x18000
    v_add_u32 v16, s16, v2
    s_mov_b32 s16, s17
    v_add_u32 v17, s16, v2
    ds_write_b128 v16, v[88:91] offset:0
    ds_write_b128 v16, v[92:95] offset:1024
    ds_write_b128 v16, v[96:99] offset:2048
    ds_write_b128 v16, v[100:103] offset:3072
    ds_write_b128 v16, v[104:107] offset:4096
    ds_write_b128 v16, v[108:111] offset:5120
    ds_write_b128 v16, v[112:115] offset:6144
    ds_write_b128 v16, v[116:119] offset:7168
    v_lshlrev_b32 v24, 16, v248
    v_and_b32 v25, 0xffff0000, v248
    v_lshlrev_b32 v26, 16, v249
    v_and_b32 v27, 0xffff0000, v249
    v_lshlrev_b32 v28, 16, v250
    v_and_b32 v29, 0xffff0000, v250
    v_lshlrev_b32 v30, 16, v251
    v_and_b32 v31, 0xffff0000, v251
    v_lshlrev_b32 v32, 16, v252
    v_and_b32 v33, 0xffff0000, v252
    v_lshlrev_b32 v34, 16, v253
    v_and_b32 v35, 0xffff0000, v253
    v_lshlrev_b32 v36, 16, v254
    v_and_b32 v37, 0xffff0000, v254
    v_lshlrev_b32 v38, 16, v255
    v_and_b32 v39, 0xffff0000, v255
    v_and_b32 v18, 15, v1
    v_lshlrev_b32 v18, 6, v18
    v_lshrrev_b32 v19, 4, v1
    v_and_b32 v20, 1, v19
    v_lshl_add_u32 v18, v20, 5, v18
    v_lshrrev_b32 v19, 1, v19
    v_lshl_add_u32 v18, v19, 4, v18
    s_and_b32 s17, s3, 3
    s_lshl_b32 s18, s30, 2
    s_add_u32 s18, s18, s17
    s_lshl_b32 s18, s18, 16
    s_lshl_b32 s19, s15, 22
    s_add_u32 s18, s18, s19
    s_lshl_b32 s19, s31, 12
    s_add_u32 s18, s18, s19
    s_add_u32 s18, s18, 0x2000800
    s_add_u32 s19, s18, 32768
    s_waitcnt lgkmcnt(0)
    s_barrier
    ds_read_b128 v[40:43], v17 offset:0
    ds_read_b128 v[44:47], v17 offset:1024
    ds_read_b128 v[48:51], v17 offset:2048
    ds_read_b128 v[52:55], v17 offset:3072
    ds_read_b128 v[56:59], v17 offset:4096
    ds_read_b128 v[60:63], v17 offset:5120
    ds_read_b128 v[64:67], v17 offset:6144
    ds_read_b128 v[68:71], v17 offset:7168
    s_waitcnt lgkmcnt(7)
    v_pk_add_f32 v[120:121], v[120:121], v[40:41]
    v_pk_add_f32 v[122:123], v[122:123], v[42:43]
    v_pk_mul_f32 v[120:121], v[120:121], v[24:25]
    v_pk_mul_f32 v[122:123], v[122:123], v[26:27]
    v_cvt_pk_bf16_f32 v224, v120, v121
    v_cvt_pk_bf16_f32 v225, v122, v123
    s_waitcnt lgkmcnt(5)
    v_pk_add_f32 v[128:129], v[128:129], v[48:49]
    v_pk_add_f32 v[130:131], v[130:131], v[50:51]
    v_pk_mul_f32 v[128:129], v[128:129], v[28:29]
    v_pk_mul_f32 v[130:131], v[130:131], v[30:31]
    v_cvt_pk_bf16_f32 v226, v128, v129
    v_cvt_pk_bf16_f32 v227, v130, v131
    s_nop 0
    v_permlane16_swap_b32 v224, v226
    v_permlane16_swap_b32 v225, v227
    buffer_store_dwordx4 v[224:227], v18, s[8:11], s18 offen offset:0 sc1
    v_pk_add_f32 v[124:125], v[124:125], v[44:45]
    v_pk_add_f32 v[126:127], v[126:127], v[46:47]
    v_pk_mul_f32 v[124:125], v[124:125], v[24:25]
    v_pk_mul_f32 v[126:127], v[126:127], v[26:27]
    v_cvt_pk_bf16_f32 v228, v124, v125
    v_cvt_pk_bf16_f32 v229, v126, v127
    s_waitcnt lgkmcnt(4)
    v_pk_add_f32 v[132:133], v[132:133], v[52:53]
    v_pk_add_f32 v[134:135], v[134:135], v[54:55]
    v_pk_mul_f32 v[132:133], v[132:133], v[28:29]
    v_pk_mul_f32 v[134:135], v[134:135], v[30:31]
    v_cvt_pk_bf16_f32 v230, v132, v133
    v_cvt_pk_bf16_f32 v231, v134, v135
    s_nop 0
    v_permlane16_swap_b32 v228, v230
    v_permlane16_swap_b32 v229, v231
    buffer_store_dwordx4 v[228:231], v18, s[8:11], s19 offen offset:0 sc1
    s_waitcnt lgkmcnt(3)
    v_pk_add_f32 v[136:137], v[136:137], v[56:57]
    v_pk_add_f32 v[138:139], v[138:139], v[58:59]
    v_pk_mul_f32 v[136:137], v[136:137], v[32:33]
    v_pk_mul_f32 v[138:139], v[138:139], v[34:35]
    v_cvt_pk_bf16_f32 v232, v136, v137
    v_cvt_pk_bf16_f32 v233, v138, v139
    s_waitcnt lgkmcnt(1)
    v_pk_add_f32 v[144:145], v[144:145], v[64:65]
    v_pk_add_f32 v[146:147], v[146:147], v[66:67]
    v_pk_mul_f32 v[144:145], v[144:145], v[36:37]
    v_pk_mul_f32 v[146:147], v[146:147], v[38:39]
    v_cvt_pk_bf16_f32 v234, v144, v145
    v_cvt_pk_bf16_f32 v235, v146, v147
    s_nop 0
    v_permlane16_swap_b32 v232, v234
    v_permlane16_swap_b32 v233, v235
    buffer_store_dwordx4 v[232:235], v18, s[8:11], s18 offen offset:1024 sc1
    v_pk_add_f32 v[140:141], v[140:141], v[60:61]
    v_pk_add_f32 v[142:143], v[142:143], v[62:63]
    v_pk_mul_f32 v[140:141], v[140:141], v[32:33]
    v_pk_mul_f32 v[142:143], v[142:143], v[34:35]
    v_cvt_pk_bf16_f32 v236, v140, v141
    v_cvt_pk_bf16_f32 v237, v142, v143
    s_waitcnt lgkmcnt(0)
    v_pk_add_f32 v[148:149], v[148:149], v[68:69]
    v_pk_add_f32 v[150:151], v[150:151], v[70:71]
    v_pk_mul_f32 v[148:149], v[148:149], v[36:37]
    v_pk_mul_f32 v[150:151], v[150:151], v[38:39]
    v_cvt_pk_bf16_f32 v238, v148, v149
    v_cvt_pk_bf16_f32 v239, v150, v151
    s_nop 0
    v_permlane16_swap_b32 v236, v238
    v_permlane16_swap_b32 v237, v239
    buffer_store_dwordx4 v[236:239], v18, s[8:11], s19 offen offset:1024 sc1
    s_mov_b64 s[64:65], s[44:45]
    s_mov_b32 s66, 0x800
    s_mov_b32 s67, 0x20000
    s_mov_b64 s[76:77], s[32:33]
    s_mov_b32 s78, 0x400000
    s_mov_b32 s79, 0x20000
    s_mov_b64 s[68:69], s[56:57]
    s_mov_b32 s70, 0x400000
    s_mov_b32 s71, 0x20000
    s_lshl_b32 s14, s31, 1
    s_add_u32 s14, s14, s15
    s_lshl_b32 s14, s14, 3
    s_add_u32 s14, s14, s3
    s_lshl_b32 s16, s30, 7
    s_add_u32 s14, s14, s16
    s_lshl_b32 s16, s14, 11
    buffer_load_dwordx4 v[216:219], v2, s[76:79], s16 offen offset:0
    buffer_load_dwordx4 v[220:223], v2, s[76:79], s16 offen offset:1024
    s_lshl_b32 s16, s3, 10
    s_add_u32 m0, s16, 81920
    s_add_u32 s17, s16, 0x540800
    s_cmp_lt_u32 s3, 6
    s_cselect_b32 s17, s17, 0x7ffffff0
    s_sub_u32 s23, s16, 6144
    s_cmp_ge_u32 s3, 6
    s_cselect_b32 s23, s23, 0x7ffffff0
    s_cbranch_scc1 adaLN_cond__sliding_block_cached__moe_arch_mod__prompt_kernel_mlw
    buffer_load_dwordx4 v2, s[8:11], s17 offen sc1 lds
    s_branch adaLN_cond__sliding_block_cached__moe_arch_mod__prompt_kernel_mlj
adaLN_cond__sliding_block_cached__moe_arch_mod__prompt_kernel_mlw:
    buffer_load_dwordx4 v2, s[64:67], s23 offen lds
adaLN_cond__sliding_block_cached__moe_arch_mod__prompt_kernel_mlj:
    s_lshl_b32 s16, s30, 5
    s_lshl_b32 s17, s31, 1
    s_add_u32 s16, s16, s17
    s_add_u32 s16, s16, s15
    s_lshl_b32 s16, s16, 2
    s_add_u32 s16, s16, 0x530000
    s_cmp_eq_u32 s3, 0
    s_cselect_b32 s16, s16, 0x7ffffff0
    v_mov_b32 v16, s28
    v_mov_b32 v17, 0
    s_lshr_b32 s18, s14, 4
    s_lshl_b32 s18, s18, 15
    s_and_b32 s19, s14, 15
    s_lshl_b32 s19, s19, 6
    s_add_u32 s18, s18, s19
    s_add_u32 s18, s18, 0x2000000
    s_add_u32 s19, s18, 16384
    v_lshrrev_b32 v18, 2, v1
    v_lshlrev_b32 v18, 10, v18
    v_and_b32 v19, 3, v1
    v_lshl_add_u32 v18, v19, 4, v18
    v_add_u32 v19, 0x400000, v18
    s_lshl_b32 s25, s30, 7
    s_add_u32 s25, s25, 0x530000
    v_and_b32 v20, 15, v1
    v_lshlrev_b32 v20, 2, v20
    s_waitcnt vmcnt(3)
    s_waitcnt vmcnt(0)
    s_barrier
    s_mov_b64 exec, 1
    buffer_store_dword v16, v17, s[8:11], s16 offen sc1
    s_mov_b64 exec, -1
    v_add_u32 v16, 81920, v2
    ds_read_b128 v[184:187], v16 offset:0
    ds_read_b128 v[188:191], v16 offset:1024
    ds_read_b128 v[192:195], v16 offset:2048
    ds_read_b128 v[196:199], v16 offset:3072
    ds_read_b128 v[200:203], v16 offset:4096
    ds_read_b128 v[204:207], v16 offset:5120
    ds_read_b128 v[208:211], v16 offset:6144
    ds_read_b128 v[212:215], v16 offset:7168
    v_mov_b32 v94, 0
    v_mov_b32 v95, 0
    s_waitcnt lgkmcnt(5)
    v_lshlrev_b32 v76, 16, v192
    v_and_b32 v77, 0xffff0000, v192
    s_waitcnt lgkmcnt(1)
    v_lshlrev_b32 v78, 16, v208
    v_and_b32 v79, 0xffff0000, v208
    v_pk_mul_f32 v[60:61], v[76:77], v[78:79]
    v_lshlrev_b32 v76, 16, v184
    v_and_b32 v77, 0xffff0000, v184
    v_fmac_f32 v94, v76, v78
    v_fmac_f32 v94, v77, v79
    v_add_f32 v95, v95, v60
    v_add_f32 v95, v95, v61
    v_lshlrev_b32 v76, 16, v193
    v_and_b32 v77, 0xffff0000, v193
    v_lshlrev_b32 v78, 16, v209
    v_and_b32 v79, 0xffff0000, v209
    v_pk_mul_f32 v[62:63], v[76:77], v[78:79]
    v_lshlrev_b32 v76, 16, v185
    v_and_b32 v77, 0xffff0000, v185
    v_fmac_f32 v94, v76, v78
    v_fmac_f32 v94, v77, v79
    v_add_f32 v95, v95, v62
    v_add_f32 v95, v95, v63
    v_lshlrev_b32 v76, 16, v194
    v_and_b32 v77, 0xffff0000, v194
    v_lshlrev_b32 v78, 16, v210
    v_and_b32 v79, 0xffff0000, v210
    v_pk_mul_f32 v[64:65], v[76:77], v[78:79]
    v_lshlrev_b32 v76, 16, v186
    v_and_b32 v77, 0xffff0000, v186
    v_fmac_f32 v94, v76, v78
    v_fmac_f32 v94, v77, v79
    v_add_f32 v95, v95, v64
    v_add_f32 v95, v95, v65
    v_lshlrev_b32 v76, 16, v195
    v_and_b32 v77, 0xffff0000, v195
    v_lshlrev_b32 v78, 16, v211
    v_and_b32 v79, 0xffff0000, v211
    v_pk_mul_f32 v[66:67], v[76:77], v[78:79]
    v_lshlrev_b32 v76, 16, v187
    v_and_b32 v77, 0xffff0000, v187
    v_fmac_f32 v94, v76, v78
    v_fmac_f32 v94, v77, v79
    v_add_f32 v95, v95, v66
    v_add_f32 v95, v95, v67
    v_lshlrev_b32 v76, 16, v196
    v_and_b32 v77, 0xffff0000, v196
    s_waitcnt lgkmcnt(0)
    v_lshlrev_b32 v78, 16, v212
    v_and_b32 v79, 0xffff0000, v212
    v_pk_mul_f32 v[68:69], v[76:77], v[78:79]
    v_lshlrev_b32 v76, 16, v188
    v_and_b32 v77, 0xffff0000, v188
    v_fmac_f32 v94, v76, v78
    v_fmac_f32 v94, v77, v79
    v_add_f32 v95, v95, v68
    v_add_f32 v95, v95, v69
    v_lshlrev_b32 v76, 16, v197
    v_and_b32 v77, 0xffff0000, v197
    v_lshlrev_b32 v78, 16, v213
    v_and_b32 v79, 0xffff0000, v213
    v_pk_mul_f32 v[70:71], v[76:77], v[78:79]
    v_lshlrev_b32 v76, 16, v189
    v_and_b32 v77, 0xffff0000, v189
    v_fmac_f32 v94, v76, v78
    v_fmac_f32 v94, v77, v79
    v_add_f32 v95, v95, v70
    v_add_f32 v95, v95, v71
    v_lshlrev_b32 v76, 16, v198
    v_and_b32 v77, 0xffff0000, v198
    v_lshlrev_b32 v78, 16, v214
    v_and_b32 v79, 0xffff0000, v214
    v_pk_mul_f32 v[72:73], v[76:77], v[78:79]
    v_lshlrev_b32 v76, 16, v190
    v_and_b32 v77, 0xffff0000, v190
    v_fmac_f32 v94, v76, v78
    v_fmac_f32 v94, v77, v79
    v_add_f32 v95, v95, v72
    v_add_f32 v95, v95, v73
    v_lshlrev_b32 v76, 16, v199
    v_and_b32 v77, 0xffff0000, v199
    v_lshlrev_b32 v78, 16, v215
    v_and_b32 v79, 0xffff0000, v215
    v_pk_mul_f32 v[74:75], v[76:77], v[78:79]
    v_lshlrev_b32 v76, 16, v191
    v_and_b32 v77, 0xffff0000, v191
    v_fmac_f32 v94, v76, v78
    v_fmac_f32 v94, v77, v79
    v_add_f32 v95, v95, v74
    v_add_f32 v95, v95, v75
    v_add_f32_dpp v94, v94, v94 row_ror:1 row_mask:0xf bank_mask:0xf
    s_nop 0
    v_add_f32_dpp v95, v95, v95 row_ror:1 row_mask:0xf bank_mask:0xf
    v_add_f32_dpp v94, v94, v94 row_ror:2 row_mask:0xf bank_mask:0xf
    s_nop 0
    v_add_f32_dpp v95, v95, v95 row_ror:2 row_mask:0xf bank_mask:0xf
    v_add_f32_dpp v94, v94, v94 row_ror:4 row_mask:0xf bank_mask:0xf
    s_nop 0
    v_add_f32_dpp v95, v95, v95 row_ror:4 row_mask:0xf bank_mask:0xf
    v_add_f32_dpp v94, v94, v94 row_ror:8 row_mask:0xf bank_mask:0xf
    s_nop 0
    v_add_f32_dpp v95, v95, v95 row_ror:8 row_mask:0xf bank_mask:0xf
    v_mov_b32 v76, v94
    s_nop 1
    v_permlane16_swap_b32 v94, v76
    v_add_f32 v94, v94, v76
    v_mov_b32 v77, v95
    s_nop 1
    v_permlane16_swap_b32 v95, v77
    v_add_f32 v95, v95, v77
    v_mov_b32 v76, v94
    s_nop 1
    v_permlane32_swap_b32 v94, v76
    v_add_f32 v94, v94, v76
    v_mov_b32 v77, v95
    s_nop 1
    v_permlane32_swap_b32 v95, v77
    v_add_f32 v95, v95, v77
    v_lshlrev_b32 v28, 16, v216
    v_and_b32 v29, 0xffff0000, v216
    v_lshlrev_b32 v30, 16, v217
    v_and_b32 v31, 0xffff0000, v217
    v_lshlrev_b32 v32, 16, v218
    v_and_b32 v33, 0xffff0000, v218
    v_lshlrev_b32 v34, 16, v219
    v_and_b32 v35, 0xffff0000, v219
    v_lshlrev_b32 v36, 16, v220
    v_and_b32 v37, 0xffff0000, v220
    v_lshlrev_b32 v38, 16, v221
    v_and_b32 v39, 0xffff0000, v221
    v_lshlrev_b32 v40, 16, v222
    v_and_b32 v41, 0xffff0000, v222
    v_lshlrev_b32 v42, 16, v223
    v_and_b32 v43, 0xffff0000, v223
    s_mov_b32 s27, 0
adaLN_cond__sliding_block_cached__moe_arch_mod__prompt_kernel_a22p:
    buffer_load_dword v76, v20, s[8:11], s25 offen sc1
    s_waitcnt vmcnt(0)
    v_cmp_ne_u32 vcc, s28, v76
    s_add_u32 s27, s27, 1
    s_cmp_ge_u32 s27, 65536
    s_cbranch_scc1 adaLN_cond__sliding_block_cached__moe_arch_mod__prompt_kernel_a22g
    s_cbranch_vccnz adaLN_cond__sliding_block_cached__moe_arch_mod__prompt_kernel_a22p
adaLN_cond__sliding_block_cached__moe_arch_mod__prompt_kernel_a22g:
    buffer_load_dwordx4 v[44:47], v18, s[8:11], s18 offen sc1
    buffer_load_dwordx4 v[52:55], v19, s[8:11], s18 offen sc1
    buffer_load_dwordx4 v[48:51], v18, s[8:11], s19 offen sc1
    buffer_load_dwordx4 v[56:59], v19, s[8:11], s19 offen sc1
    v_lshlrev_b32 v21, 2, v0
    s_mov_b32 s16, 0x540800
    buffer_load_dword v106, v21, s[8:11], s16 offen sc1
    buffer_load_dword v104, v21, s[8:11], s16 offen offset:2048 sc1
    s_waitcnt vmcnt(5)
    v_lshlrev_b32 v76, 16, v44
    v_and_b32 v77, 0xffff0000, v44
    s_waitcnt vmcnt(4)
    v_lshlrev_b32 v78, 16, v52
    v_and_b32 v79, 0xffff0000, v52
    v_pk_add_f32 v[76:77], v[76:77], v[78:79]
    v_pk_add_f32 v[28:29], v[28:29], v[76:77]
    v_cvt_pk_bf16_f32 v16, v28, v29
    v_lshlrev_b32 v28, 16, v16
    v_and_b32 v29, 0xffff0000, v16
    v_lshlrev_b32 v80, 16, v45
    v_and_b32 v81, 0xffff0000, v45
    v_lshlrev_b32 v82, 16, v53
    v_and_b32 v83, 0xffff0000, v53
    v_pk_add_f32 v[80:81], v[80:81], v[82:83]
    v_pk_add_f32 v[30:31], v[30:31], v[80:81]
    v_cvt_pk_bf16_f32 v17, v30, v31
    v_lshlrev_b32 v30, 16, v17
    v_and_b32 v31, 0xffff0000, v17
    v_lshlrev_b32 v76, 16, v46
    v_and_b32 v77, 0xffff0000, v46
    v_lshlrev_b32 v78, 16, v54
    v_and_b32 v79, 0xffff0000, v54
    v_pk_add_f32 v[76:77], v[76:77], v[78:79]
    v_pk_add_f32 v[32:33], v[32:33], v[76:77]
    v_cvt_pk_bf16_f32 v16, v32, v33
    v_lshlrev_b32 v32, 16, v16
    v_and_b32 v33, 0xffff0000, v16
    v_lshlrev_b32 v80, 16, v47
    v_and_b32 v81, 0xffff0000, v47
    v_lshlrev_b32 v82, 16, v55
    v_and_b32 v83, 0xffff0000, v55
    v_pk_add_f32 v[80:81], v[80:81], v[82:83]
    v_pk_add_f32 v[34:35], v[34:35], v[80:81]
    v_cvt_pk_bf16_f32 v17, v34, v35
    v_lshlrev_b32 v34, 16, v17
    v_and_b32 v35, 0xffff0000, v17
    s_waitcnt vmcnt(3)
    v_lshlrev_b32 v76, 16, v48
    v_and_b32 v77, 0xffff0000, v48
    s_waitcnt vmcnt(2)
    v_lshlrev_b32 v78, 16, v56
    v_and_b32 v79, 0xffff0000, v56
    v_pk_add_f32 v[76:77], v[76:77], v[78:79]
    v_pk_add_f32 v[36:37], v[36:37], v[76:77]
    v_cvt_pk_bf16_f32 v16, v36, v37
    v_lshlrev_b32 v36, 16, v16
    v_and_b32 v37, 0xffff0000, v16
    v_lshlrev_b32 v80, 16, v49
    v_and_b32 v81, 0xffff0000, v49
    v_lshlrev_b32 v82, 16, v57
    v_and_b32 v83, 0xffff0000, v57
    v_pk_add_f32 v[80:81], v[80:81], v[82:83]
    v_pk_add_f32 v[38:39], v[38:39], v[80:81]
    v_cvt_pk_bf16_f32 v17, v38, v39
    v_lshlrev_b32 v38, 16, v17
    v_and_b32 v39, 0xffff0000, v17
    v_lshlrev_b32 v76, 16, v50
    v_and_b32 v77, 0xffff0000, v50
    v_lshlrev_b32 v78, 16, v58
    v_and_b32 v79, 0xffff0000, v58
    v_pk_add_f32 v[76:77], v[76:77], v[78:79]
    v_pk_add_f32 v[40:41], v[40:41], v[76:77]
    v_cvt_pk_bf16_f32 v16, v40, v41
    v_lshlrev_b32 v40, 16, v16
    v_and_b32 v41, 0xffff0000, v16
    v_lshlrev_b32 v80, 16, v51
    v_and_b32 v81, 0xffff0000, v51
    v_lshlrev_b32 v82, 16, v59
    v_and_b32 v83, 0xffff0000, v59
    v_pk_add_f32 v[80:81], v[80:81], v[82:83]
    v_pk_add_f32 v[42:43], v[42:43], v[80:81]
    v_cvt_pk_bf16_f32 v17, v42, v43
    v_lshlrev_b32 v42, 16, v17
    v_and_b32 v43, 0xffff0000, v17
    v_pk_add_f32 v[76:77], v[28:29], v[30:31]
    v_pk_mul_f32 v[78:79], v[28:29], v[28:29]
    v_pk_mul_f32 v[80:81], v[28:29], v[60:61]
    v_pk_fma_f32 v[78:79], v[30:31], v[30:31], v[78:79]
    v_pk_fma_f32 v[80:81], v[30:31], v[62:63], v[80:81]
    v_pk_add_f32 v[76:77], v[76:77], v[32:33]
    v_pk_fma_f32 v[78:79], v[32:33], v[32:33], v[78:79]
    v_pk_fma_f32 v[80:81], v[32:33], v[64:65], v[80:81]
    v_pk_add_f32 v[76:77], v[76:77], v[34:35]
    v_pk_fma_f32 v[78:79], v[34:35], v[34:35], v[78:79]
    v_pk_fma_f32 v[80:81], v[34:35], v[66:67], v[80:81]
    v_pk_add_f32 v[76:77], v[76:77], v[36:37]
    v_pk_fma_f32 v[78:79], v[36:37], v[36:37], v[78:79]
    v_pk_fma_f32 v[80:81], v[36:37], v[68:69], v[80:81]
    v_pk_add_f32 v[76:77], v[76:77], v[38:39]
    v_pk_fma_f32 v[78:79], v[38:39], v[38:39], v[78:79]
    v_pk_fma_f32 v[80:81], v[38:39], v[70:71], v[80:81]
    v_pk_add_f32 v[76:77], v[76:77], v[40:41]
    v_pk_fma_f32 v[78:79], v[40:41], v[40:41], v[78:79]
    v_pk_fma_f32 v[80:81], v[40:41], v[72:73], v[80:81]
    v_pk_add_f32 v[76:77], v[76:77], v[42:43]
    v_pk_fma_f32 v[78:79], v[42:43], v[42:43], v[78:79]
    v_pk_fma_f32 v[80:81], v[42:43], v[74:75], v[80:81]
    v_add_f32 v96, v76, v77
    v_add_f32 v97, v78, v79
    v_add_f32 v98, v80, v81
    v_add_f32_dpp v96, v96, v96 row_ror:1 row_mask:0xf bank_mask:0xf
    v_add_f32_dpp v97, v97, v97 row_ror:1 row_mask:0xf bank_mask:0xf
    v_add_f32_dpp v98, v98, v98 row_ror:1 row_mask:0xf bank_mask:0xf
    v_add_f32_dpp v96, v96, v96 row_ror:2 row_mask:0xf bank_mask:0xf
    v_add_f32_dpp v97, v97, v97 row_ror:2 row_mask:0xf bank_mask:0xf
    v_add_f32_dpp v98, v98, v98 row_ror:2 row_mask:0xf bank_mask:0xf
    v_add_f32_dpp v96, v96, v96 row_ror:4 row_mask:0xf bank_mask:0xf
    v_add_f32_dpp v97, v97, v97 row_ror:4 row_mask:0xf bank_mask:0xf
    v_add_f32_dpp v98, v98, v98 row_ror:4 row_mask:0xf bank_mask:0xf
    v_add_f32_dpp v96, v96, v96 row_ror:8 row_mask:0xf bank_mask:0xf
    v_add_f32_dpp v97, v97, v97 row_ror:8 row_mask:0xf bank_mask:0xf
    v_add_f32_dpp v98, v98, v98 row_ror:8 row_mask:0xf bank_mask:0xf
    v_mov_b32 v76, v96
    s_nop 1
    v_permlane16_swap_b32 v96, v76
    v_add_f32 v96, v96, v76
    v_mov_b32 v77, v97
    s_nop 1
    v_permlane16_swap_b32 v97, v77
    v_add_f32 v97, v97, v77
    v_mov_b32 v78, v98
    s_nop 1
    v_permlane16_swap_b32 v98, v78
    v_add_f32 v98, v98, v78
    v_mov_b32 v76, v96
    s_nop 1
    v_permlane32_swap_b32 v96, v76
    v_add_f32 v96, v96, v76
    v_mov_b32 v77, v97
    s_nop 1
    v_permlane32_swap_b32 v97, v77
    v_add_f32 v97, v97, v77
    v_mov_b32 v78, v98
    s_nop 1
    v_permlane32_swap_b32 v98, v78
    v_add_f32 v98, v98, v78
    v_mul_f32 v96, 0x3a800000, v96
    v_mul_f32 v97, 0x3a800000, v97
    v_fma_f32 v97, -v96, v96, v97
    v_max_f32 v97, 0, v97
    v_fma_f32 v98, -v96, v95, v98
    v_add_f32 v76, 0x3727c5ac, v97
    v_rsq_f32 v76, v76
    s_nop 0
    v_fma_f32 v27, v98, v76, v94
    v_cvt_pk_bf16_f32 v96, v96, v96
    v_lshlrev_b32 v96, 16, v96
    v_cvt_pk_bf16_f32 v97, v97, v97
    v_lshlrev_b32 v97, 16, v97
    v_add_f32 v97, 0x3727c5ac, v97
    v_cvt_pk_bf16_f32 v97, v97, v97
    v_lshlrev_b32 v97, 16, v97
    v_sqrt_f32 v98, v97
    s_nop 0
    v_cvt_pk_bf16_f32 v98, v98, v98
    v_lshlrev_b32 v98, 16, v98
    v_rcp_f32 v99, v98
    v_mov_b32 v25, v96
    v_mov_b32 v26, v98
    v_ashrrev_i32 v16, 31, v27
    v_or_b32 v16, 0x80000000, v16
    v_xor_b32 v24, v27, v16
    v_and_b32 v24, 0xfffff800, v24
    v_max_u32 v24, 0x800, v24
    s_sub_u32 s16, 2047, s14
    v_or_b32 v24, s16, v24
    s_lshl_b32 s16, s3, 4
    s_add_u32 s16, s16, 65536
    v_mov_b32 v16, s16
    ds_write_b128 v16, v[24:27]
    s_waitcnt lgkmcnt(0)
    s_barrier
    v_and_b32 v16, 7, v1
    v_lshlrev_b32 v16, 4, v16
    v_add_u32 v16, 65536, v16
    ds_read_b32 v76, v16
    s_waitcnt lgkmcnt(0)
    v_mov_b32 v77, v76
    s_nop 1
    v_max_u32_dpp v77, v77, v77 row_ror:1 row_mask:0xf bank_mask:0xf
    s_nop 1
    v_max_u32_dpp v77, v77, v77 row_ror:2 row_mask:0xf bank_mask:0xf
    s_nop 1
    v_max_u32_dpp v77, v77, v77 row_ror:4 row_mask:0xf bank_mask:0xf
    v_cmp_eq_u32 vcc, v76, v77
    s_ff1_i32_b64 s16, vcc
    s_lshl_b32 s16, s16, 4
    s_add_u32 s16, s16, 65536
    v_mov_b32 v16, s16
    ds_read_b128 v[24:27], v16
    s_lshl_b32 s16, s2, 4
    s_add_u32 s16, s16, 0x6e0000
    s_cmp_eq_u32 s3, 0
    s_cselect_b32 s16, s16, 0x7ffffff0
    v_mov_b32 v17, 0
    s_mov_b64 exec, 1
    s_waitcnt lgkmcnt(0)
    buffer_store_dwordx4 v[24:27], v17, s[8:11], s16 offen sc1
    s_mov_b64 exec, -1
    s_mov_b64 s[72:73], s[50:51]
    s_mov_b32 s74, 0x700000
    s_mov_b32 s75, 0x20000
    s_cmp_lt_u32 s2, 224
    s_cselect_b32 s74, 7340032, 0
    s_lshl_b32 s17, s29, 4
    s_sub_u32 s16, s3, 4
    s_lshl_b32 s16, s16, 2
    s_add_u32 s16, s16, s17
    s_lshl_b32 s16, s16, 11
    s_add_u32 s17, s16, 0
    buffer_load_dwordx4 v[152:155], v2, s[72:75], s17 offen offset:0
    buffer_load_dwordx4 v[156:159], v2, s[72:75], s17 offen offset:1024
    s_add_u32 s17, s16, 2048
    buffer_load_dwordx4 v[160:163], v2, s[72:75], s17 offen offset:0
    buffer_load_dwordx4 v[164:167], v2, s[72:75], s17 offen offset:1024
    s_add_u32 s17, s16, 4096
    buffer_load_dwordx4 v[168:171], v2, s[72:75], s17 offen offset:0
    buffer_load_dwordx4 v[172:175], v2, s[72:75], s17 offen offset:1024
    s_add_u32 s17, s16, 6144
    buffer_load_dwordx4 v[176:179], v2, s[72:75], s17 offen offset:0
    buffer_load_dwordx4 v[180:183], v2, s[72:75], s17 offen offset:1024
    v_sub_f32 v44, v28, v96
    v_sub_f32 v45, v29, v96
    v_sub_f32 v46, v30, v96
    v_sub_f32 v47, v31, v96
    v_sub_f32 v48, v32, v96
    v_sub_f32 v49, v33, v96
    v_sub_f32 v50, v34, v96
    v_sub_f32 v51, v35, v96
    v_cvt_pk_bf16_f32 v16, v44, v45
    v_lshlrev_b32 v44, 16, v16
    v_and_b32 v45, 0xffff0000, v16
    v_cvt_pk_bf16_f32 v16, v46, v47
    v_lshlrev_b32 v46, 16, v16
    v_and_b32 v47, 0xffff0000, v16
    v_cvt_pk_bf16_f32 v16, v48, v49
    v_lshlrev_b32 v48, 16, v16
    v_and_b32 v49, 0xffff0000, v16
    v_cvt_pk_bf16_f32 v16, v50, v51
    v_lshlrev_b32 v50, 16, v16
    v_and_b32 v51, 0xffff0000, v16
    v_mul_f32 v52, v44, v99
    v_mul_f32 v53, v45, v99
    v_mul_f32 v54, v46, v99
    v_mul_f32 v55, v47, v99
    v_mul_f32 v56, v48, v99
    v_mul_f32 v57, v49, v99
    v_mul_f32 v58, v50, v99
    v_mul_f32 v59, v51, v99
    v_fma_f32 v44, -v52, v98, v44
    v_fma_f32 v45, -v53, v98, v45
    v_fma_f32 v46, -v54, v98, v46
    v_fma_f32 v47, -v55, v98, v47
    v_fma_f32 v48, -v56, v98, v48
    v_fma_f32 v49, -v57, v98, v49
    v_fma_f32 v50, -v58, v98, v50
    v_fma_f32 v51, -v59, v98, v51
    v_fma_f32 v44, v44, v99, v52
    v_fma_f32 v45, v45, v99, v53
    v_fma_f32 v46, v46, v99, v54
    v_fma_f32 v47, v47, v99, v55
    v_fma_f32 v48, v48, v99, v56
    v_fma_f32 v49, v49, v99, v57
    v_fma_f32 v50, v50, v99, v58
    v_fma_f32 v51, v51, v99, v59
    v_cvt_pk_bf16_f32 v16, v44, v45
    v_lshlrev_b32 v44, 16, v16
    v_and_b32 v45, 0xffff0000, v16
    v_cvt_pk_bf16_f32 v16, v46, v47
    v_lshlrev_b32 v46, 16, v16
    v_and_b32 v47, 0xffff0000, v16
    v_cvt_pk_bf16_f32 v16, v48, v49
    v_lshlrev_b32 v48, 16, v16
    v_and_b32 v49, 0xffff0000, v16
    v_cvt_pk_bf16_f32 v16, v50, v51
    v_lshlrev_b32 v50, 16, v16
    v_and_b32 v51, 0xffff0000, v16
    v_lshlrev_b32 v52, 16, v192
    v_and_b32 v53, 0xffff0000, v192
    v_lshlrev_b32 v54, 16, v193
    v_and_b32 v55, 0xffff0000, v193
    v_lshlrev_b32 v56, 16, v194
    v_and_b32 v57, 0xffff0000, v194
    v_lshlrev_b32 v58, 16, v195
    v_and_b32 v59, 0xffff0000, v195
    v_pk_mul_f32 v[44:45], v[44:45], v[52:53]
    v_pk_mul_f32 v[46:47], v[46:47], v[54:55]
    v_pk_mul_f32 v[48:49], v[48:49], v[56:57]
    v_pk_mul_f32 v[50:51], v[50:51], v[58:59]
    v_cvt_pk_bf16_f32 v16, v44, v45
    v_lshlrev_b32 v44, 16, v16
    v_and_b32 v45, 0xffff0000, v16
    v_cvt_pk_bf16_f32 v16, v46, v47
    v_lshlrev_b32 v46, 16, v16
    v_and_b32 v47, 0xffff0000, v16
    v_cvt_pk_bf16_f32 v16, v48, v49
    v_lshlrev_b32 v48, 16, v16
    v_and_b32 v49, 0xffff0000, v16
    v_cvt_pk_bf16_f32 v16, v50, v51
    v_lshlrev_b32 v50, 16, v16
    v_and_b32 v51, 0xffff0000, v16
    v_lshlrev_b32 v52, 16, v184
    v_and_b32 v53, 0xffff0000, v184
    v_lshlrev_b32 v54, 16, v185
    v_and_b32 v55, 0xffff0000, v185
    v_lshlrev_b32 v56, 16, v186
    v_and_b32 v57, 0xffff0000, v186
    v_lshlrev_b32 v58, 16, v187
    v_and_b32 v59, 0xffff0000, v187
    v_pk_add_f32 v[44:45], v[44:45], v[52:53]
    v_pk_add_f32 v[46:47], v[46:47], v[54:55]
    v_pk_add_f32 v[48:49], v[48:49], v[56:57]
    v_pk_add_f32 v[50:51], v[50:51], v[58:59]
    v_cvt_pk_bf16_f32 v16, v44, v45
    v_lshlrev_b32 v44, 16, v16
    v_and_b32 v45, 0xffff0000, v16
    v_cvt_pk_bf16_f32 v16, v46, v47
    v_lshlrev_b32 v46, 16, v16
    v_and_b32 v47, 0xffff0000, v16
    v_cvt_pk_bf16_f32 v16, v48, v49
    v_lshlrev_b32 v48, 16, v16
    v_and_b32 v49, 0xffff0000, v16
    v_cvt_pk_bf16_f32 v16, v50, v51
    v_lshlrev_b32 v50, 16, v16
    v_and_b32 v51, 0xffff0000, v16
    v_lshlrev_b32 v52, 16, v200
    v_and_b32 v53, 0xffff0000, v200
    v_lshlrev_b32 v54, 16, v201
    v_and_b32 v55, 0xffff0000, v201
    v_lshlrev_b32 v56, 16, v202
    v_and_b32 v57, 0xffff0000, v202
    v_lshlrev_b32 v58, 16, v203
    v_and_b32 v59, 0xffff0000, v203
    v_pk_mul_f32 v[44:45], v[44:45], v[52:53]
    v_pk_mul_f32 v[46:47], v[46:47], v[54:55]
    v_pk_mul_f32 v[48:49], v[48:49], v[56:57]
    v_pk_mul_f32 v[50:51], v[50:51], v[58:59]
    v_cvt_pk_bf16_f32 v16, v44, v45
    v_lshlrev_b32 v44, 16, v16
    v_and_b32 v45, 0xffff0000, v16
    v_cvt_pk_bf16_f32 v16, v46, v47
    v_lshlrev_b32 v46, 16, v16
    v_and_b32 v47, 0xffff0000, v16
    v_cvt_pk_bf16_f32 v16, v48, v49
    v_lshlrev_b32 v48, 16, v16
    v_and_b32 v49, 0xffff0000, v16
    v_cvt_pk_bf16_f32 v16, v50, v51
    v_lshlrev_b32 v50, 16, v16
    v_and_b32 v51, 0xffff0000, v16
    v_pk_add_f32 v[44:45], v[44:45], v[28:29]
    v_pk_add_f32 v[46:47], v[46:47], v[30:31]
    v_pk_add_f32 v[48:49], v[48:49], v[32:33]
    v_pk_add_f32 v[50:51], v[50:51], v[34:35]
    v_cvt_pk_bf16_f32 v28, v44, v45
    v_cvt_pk_bf16_f32 v29, v46, v47
    v_cvt_pk_bf16_f32 v30, v48, v49
    v_cvt_pk_bf16_f32 v31, v50, v51
    v_sub_f32 v44, v36, v96
    v_sub_f32 v45, v37, v96
    v_sub_f32 v46, v38, v96
    v_sub_f32 v47, v39, v96
    v_sub_f32 v48, v40, v96
    v_sub_f32 v49, v41, v96
    v_sub_f32 v50, v42, v96
    v_sub_f32 v51, v43, v96
    v_cvt_pk_bf16_f32 v16, v44, v45
    v_lshlrev_b32 v44, 16, v16
    v_and_b32 v45, 0xffff0000, v16
    v_cvt_pk_bf16_f32 v16, v46, v47
    v_lshlrev_b32 v46, 16, v16
    v_and_b32 v47, 0xffff0000, v16
    v_cvt_pk_bf16_f32 v16, v48, v49
    v_lshlrev_b32 v48, 16, v16
    v_and_b32 v49, 0xffff0000, v16
    v_cvt_pk_bf16_f32 v16, v50, v51
    v_lshlrev_b32 v50, 16, v16
    v_and_b32 v51, 0xffff0000, v16
    v_mul_f32 v52, v44, v99
    v_mul_f32 v53, v45, v99
    v_mul_f32 v54, v46, v99
    v_mul_f32 v55, v47, v99
    v_mul_f32 v56, v48, v99
    v_mul_f32 v57, v49, v99
    v_mul_f32 v58, v50, v99
    v_mul_f32 v59, v51, v99
    v_fma_f32 v44, -v52, v98, v44
    v_fma_f32 v45, -v53, v98, v45
    v_fma_f32 v46, -v54, v98, v46
    v_fma_f32 v47, -v55, v98, v47
    v_fma_f32 v48, -v56, v98, v48
    v_fma_f32 v49, -v57, v98, v49
    v_fma_f32 v50, -v58, v98, v50
    v_fma_f32 v51, -v59, v98, v51
    v_fma_f32 v44, v44, v99, v52
    v_fma_f32 v45, v45, v99, v53
    v_fma_f32 v46, v46, v99, v54
    v_fma_f32 v47, v47, v99, v55
    v_fma_f32 v48, v48, v99, v56
    v_fma_f32 v49, v49, v99, v57
    v_fma_f32 v50, v50, v99, v58
    v_fma_f32 v51, v51, v99, v59
    v_cvt_pk_bf16_f32 v16, v44, v45
    v_lshlrev_b32 v44, 16, v16
    v_and_b32 v45, 0xffff0000, v16
    v_cvt_pk_bf16_f32 v16, v46, v47
    v_lshlrev_b32 v46, 16, v16
    v_and_b32 v47, 0xffff0000, v16
    v_cvt_pk_bf16_f32 v16, v48, v49
    v_lshlrev_b32 v48, 16, v16
    v_and_b32 v49, 0xffff0000, v16
    v_cvt_pk_bf16_f32 v16, v50, v51
    v_lshlrev_b32 v50, 16, v16
    v_and_b32 v51, 0xffff0000, v16
    v_lshlrev_b32 v52, 16, v196
    v_and_b32 v53, 0xffff0000, v196
    v_lshlrev_b32 v54, 16, v197
    v_and_b32 v55, 0xffff0000, v197
    v_lshlrev_b32 v56, 16, v198
    v_and_b32 v57, 0xffff0000, v198
    v_lshlrev_b32 v58, 16, v199
    v_and_b32 v59, 0xffff0000, v199
    v_pk_mul_f32 v[44:45], v[44:45], v[52:53]
    v_pk_mul_f32 v[46:47], v[46:47], v[54:55]
    v_pk_mul_f32 v[48:49], v[48:49], v[56:57]
    v_pk_mul_f32 v[50:51], v[50:51], v[58:59]
    v_cvt_pk_bf16_f32 v16, v44, v45
    v_lshlrev_b32 v44, 16, v16
    v_and_b32 v45, 0xffff0000, v16
    v_cvt_pk_bf16_f32 v16, v46, v47
    v_lshlrev_b32 v46, 16, v16
    v_and_b32 v47, 0xffff0000, v16
    v_cvt_pk_bf16_f32 v16, v48, v49
    v_lshlrev_b32 v48, 16, v16
    v_and_b32 v49, 0xffff0000, v16
    v_cvt_pk_bf16_f32 v16, v50, v51
    v_lshlrev_b32 v50, 16, v16
    v_and_b32 v51, 0xffff0000, v16
    v_lshlrev_b32 v52, 16, v188
    v_and_b32 v53, 0xffff0000, v188
    v_lshlrev_b32 v54, 16, v189
    v_and_b32 v55, 0xffff0000, v189
    v_lshlrev_b32 v56, 16, v190
    v_and_b32 v57, 0xffff0000, v190
    v_lshlrev_b32 v58, 16, v191
    v_and_b32 v59, 0xffff0000, v191
    v_pk_add_f32 v[44:45], v[44:45], v[52:53]
    v_pk_add_f32 v[46:47], v[46:47], v[54:55]
    v_pk_add_f32 v[48:49], v[48:49], v[56:57]
    v_pk_add_f32 v[50:51], v[50:51], v[58:59]
    v_cvt_pk_bf16_f32 v16, v44, v45
    v_lshlrev_b32 v44, 16, v16
    v_and_b32 v45, 0xffff0000, v16
    v_cvt_pk_bf16_f32 v16, v46, v47
    v_lshlrev_b32 v46, 16, v16
    v_and_b32 v47, 0xffff0000, v16
    v_cvt_pk_bf16_f32 v16, v48, v49
    v_lshlrev_b32 v48, 16, v16
    v_and_b32 v49, 0xffff0000, v16
    v_cvt_pk_bf16_f32 v16, v50, v51
    v_lshlrev_b32 v50, 16, v16
    v_and_b32 v51, 0xffff0000, v16
    v_lshlrev_b32 v52, 16, v204
    v_and_b32 v53, 0xffff0000, v204
    v_lshlrev_b32 v54, 16, v205
    v_and_b32 v55, 0xffff0000, v205
    v_lshlrev_b32 v56, 16, v206
    v_and_b32 v57, 0xffff0000, v206
    v_lshlrev_b32 v58, 16, v207
    v_and_b32 v59, 0xffff0000, v207
    v_pk_mul_f32 v[44:45], v[44:45], v[52:53]
    v_pk_mul_f32 v[46:47], v[46:47], v[54:55]
    v_pk_mul_f32 v[48:49], v[48:49], v[56:57]
    v_pk_mul_f32 v[50:51], v[50:51], v[58:59]
    v_cvt_pk_bf16_f32 v16, v44, v45
    v_lshlrev_b32 v44, 16, v16
    v_and_b32 v45, 0xffff0000, v16
    v_cvt_pk_bf16_f32 v16, v46, v47
    v_lshlrev_b32 v46, 16, v16
    v_and_b32 v47, 0xffff0000, v16
    v_cvt_pk_bf16_f32 v16, v48, v49
    v_lshlrev_b32 v48, 16, v16
    v_and_b32 v49, 0xffff0000, v16
    v_cvt_pk_bf16_f32 v16, v50, v51
    v_lshlrev_b32 v50, 16, v16
    v_and_b32 v51, 0xffff0000, v16
    v_pk_add_f32 v[44:45], v[44:45], v[36:37]
    v_pk_add_f32 v[46:47], v[46:47], v[38:39]
    v_pk_add_f32 v[48:49], v[48:49], v[40:41]
    v_pk_add_f32 v[50:51], v[50:51], v[42:43]
    v_cvt_pk_bf16_f32 v36, v44, v45
    v_cvt_pk_bf16_f32 v37, v46, v47
    v_cvt_pk_bf16_f32 v38, v48, v49
    v_cvt_pk_bf16_f32 v39, v50, v51
    s_barrier
    v_and_b32 v16, 3, v1
    v_lshlrev_b32 v16, 4, v16
    v_add_u32 v16, 65792, v16
    ds_read_b32 v76, v16
    s_waitcnt lgkmcnt(0)
    v_mov_b32 v77, v76
    s_nop 1
    v_max_u32_dpp v77, v77, v77 row_ror:1 row_mask:0xf bank_mask:0xf
    s_nop 1
    v_max_u32_dpp v77, v77, v77 row_ror:2 row_mask:0xf bank_mask:0xf
    v_cmp_eq_u32 vcc, v76, v77
    s_ff1_i32_b64 s16, vcc
    s_lshl_b32 s16, s16, 4
    s_add_u32 s16, s16, 65792
    v_mov_b32 v16, s16
    ds_read_b128 v[24:27], v16
    s_waitcnt lgkmcnt(0)
    v_and_b32 v76, 0x7ff, v24
    v_sub_u32 v76, 2047, v76
    s_nop 0
    v_readfirstlane_b32 s12, v76
    v_rcp_f32 v103, v26
    s_lshr_b32 s18, s12, 4
    s_lshl_b32 s18, s18, 15
    s_and_b32 s19, s12, 15
    s_lshl_b32 s19, s19, 6
    s_add_u32 s18, s18, s19
    s_add_u32 s18, s18, 0x2000000
    s_add_u32 s19, s18, 0x400000
    v_lshrrev_b32 v18, 4, v0
    v_lshlrev_b32 v18, 10, v18
    v_and_b32 v19, 15, v0
    v_lshl_add_u32 v18, v19, 2, v18
    s_lshl_b32 s13, s12, 11
    buffer_load_dword v100, v18, s[8:11], s18 offen sc1
    buffer_load_dword v101, v18, s[8:11], s19 offen sc1
    buffer_load_dword v102, v21, s[76:79], s13 offen
    s_lshl_b32 s16, s14, 11
    s_cmp_lg_u32 s12, s14
    s_cselect_b32 s16, s16, 0x7ffffff0
    buffer_store_dwordx4 v[28:31], v2, s[68:71], s16 offen offset:0 sc1
    buffer_store_dwordx4 v[36:39], v2, s[68:71], s16 offen offset:1024 sc1
    s_lshl_b32 s16, s3, 13
    v_add_u32 v20, s16, v2
    s_waitcnt vmcnt(4)
    v_lshlrev_b32 v76, 16, v100
    v_and_b32 v77, 0xffff0000, v100
    s_waitcnt vmcnt(3)
    v_lshlrev_b32 v78, 16, v101
    v_and_b32 v79, 0xffff0000, v101
    v_pk_add_f32 v[76:77], v[76:77], v[78:79]
    s_waitcnt vmcnt(2)
    v_lshlrev_b32 v78, 16, v102
    v_and_b32 v79, 0xffff0000, v102
    v_pk_add_f32 v[92:93], v[78:79], v[76:77]
    v_cvt_pk_bf16_f32 v76, v92, v93
    v_lshlrev_b32 v92, 16, v76
    v_and_b32 v93, 0xffff0000, v76
    v_cvt_pk_bf16_f32 v100, v92, v93
    v_and_b32 v105, 0xffff0000, v104
    v_lshlrev_b32 v104, 16, v104
    v_and_b32 v107, 0xffff0000, v106
    v_lshlrev_b32 v106, 16, v106
    v_sub_f32 v92, v92, v25
    v_sub_f32 v93, v93, v25
    v_cvt_pk_bf16_f32 v76, v92, v93
    v_lshlrev_b32 v92, 16, v76
    v_and_b32 v93, 0xffff0000, v76
    v_mul_f32 v77, v92, v103
    v_fma_f32 v92, -v77, v26, v92
    v_fma_f32 v92, v92, v103, v77
    v_mul_f32 v77, v93, v103
    v_fma_f32 v93, -v77, v26, v93
    v_fma_f32 v93, v93, v103, v77
    v_cvt_pk_bf16_f32 v76, v92, v93
    v_lshlrev_b32 v92, 16, v76
    v_and_b32 v93, 0xffff0000, v76
    v_mul_f32 v92, v92, v104
    v_mul_f32 v93, v93, v105
    v_cvt_pk_bf16_f32 v76, v92, v93
    v_lshlrev_b32 v92, 16, v76
    v_and_b32 v93, 0xffff0000, v76
    v_add_f32 v92, v92, v106
    v_add_f32 v93, v93, v107
    v_cvt_pk_bf16_f32 v101, v92, v93
    v_add_u32 v16, 66560, v21
    ds_write_b32 v16, v101
    ds_write_b32 v16, v100 offset:2048
    s_waitcnt lgkmcnt(0)
    s_barrier
    ds_read_b128 v[60:63], v20 offset:0
    ds_read_b128 v[64:67], v20 offset:1024
    ds_read_b128 v[68:71], v20 offset:2048
    ds_read_b128 v[72:75], v20 offset:3072
    ds_read_b128 v[108:111], v20 offset:4096
    ds_read_b128 v[112:115], v20 offset:5120
    ds_read_b128 v[116:119], v20 offset:6144
    ds_read_b128 v[120:123], v20 offset:7168
    s_and_b32 s16, s3, 3
    s_lshl_b32 s16, s16, 7
    s_and_b32 s17, s29, 3
    s_lshl_b32 s17, s17, 9
    s_add_u32 s16, s16, s17
    s_add_u32 s16, s16, 66560
    v_lshrrev_b32 v16, 3, v1
    v_lshlrev_b32 v16, 4, v16
    v_add_u32 v16, s16, v16
    ds_read_b128 v[104:107], v16
    s_waitcnt lgkmcnt(0)
    v_lshlrev_b32 v76, 16, v104
    v_and_b32 v77, 0xffff, v104
    v_dot2_f32_bf16 v85, v60, v76, 0
    v_dot2_f32_bf16 v84, v60, v77, 0
    v_dot2_f32_bf16 v87, v61, v76, 0
    v_dot2_f32_bf16 v86, v61, v77, 0
    v_dot2_f32_bf16 v89, v62, v76, 0
    v_dot2_f32_bf16 v88, v62, v77, 0
    v_dot2_f32_bf16 v91, v63, v76, 0
    v_dot2_f32_bf16 v90, v63, v77, 0
    v_and_b32 v78, 0xffff0000, v104
    v_lshrrev_b32 v79, 16, v104
    v_dot2c_f32_bf16 v85, v64, v78
    v_dot2c_f32_bf16 v84, v64, v79
    v_dot2c_f32_bf16 v87, v65, v78
    v_dot2c_f32_bf16 v86, v65, v79
    v_dot2c_f32_bf16 v89, v66, v78
    v_dot2c_f32_bf16 v88, v66, v79
    v_dot2c_f32_bf16 v91, v67, v78
    v_dot2c_f32_bf16 v90, v67, v79
    v_lshlrev_b32 v80, 16, v105
    v_and_b32 v81, 0xffff, v105
    v_dot2c_f32_bf16 v85, v68, v80
    v_dot2c_f32_bf16 v84, v68, v81
    v_dot2c_f32_bf16 v87, v69, v80
    v_dot2c_f32_bf16 v86, v69, v81
    v_dot2c_f32_bf16 v89, v70, v80
    v_dot2c_f32_bf16 v88, v70, v81
    v_dot2c_f32_bf16 v91, v71, v80
    v_dot2c_f32_bf16 v90, v71, v81
    v_and_b32 v82, 0xffff0000, v105
    v_lshrrev_b32 v83, 16, v105
    v_dot2c_f32_bf16 v85, v72, v82
    v_dot2c_f32_bf16 v84, v72, v83
    v_dot2c_f32_bf16 v87, v73, v82
    v_dot2c_f32_bf16 v86, v73, v83
    v_dot2c_f32_bf16 v89, v74, v82
    v_dot2c_f32_bf16 v88, v74, v83
    v_dot2c_f32_bf16 v91, v75, v82
    v_dot2c_f32_bf16 v90, v75, v83
    v_lshlrev_b32 v76, 16, v106
    v_and_b32 v77, 0xffff, v106
    v_dot2c_f32_bf16 v85, v108, v76
    v_dot2c_f32_bf16 v84, v108, v77
    v_dot2c_f32_bf16 v87, v109, v76
    v_dot2c_f32_bf16 v86, v109, v77
    v_dot2c_f32_bf16 v89, v110, v76
    v_dot2c_f32_bf16 v88, v110, v77
    v_dot2c_f32_bf16 v91, v111, v76
    v_dot2c_f32_bf16 v90, v111, v77
    v_and_b32 v78, 0xffff0000, v106
    v_lshrrev_b32 v79, 16, v106
    v_dot2c_f32_bf16 v85, v112, v78
    v_dot2c_f32_bf16 v84, v112, v79
    v_dot2c_f32_bf16 v87, v113, v78
    v_dot2c_f32_bf16 v86, v113, v79
    v_dot2c_f32_bf16 v89, v114, v78
    v_dot2c_f32_bf16 v88, v114, v79
    v_dot2c_f32_bf16 v91, v115, v78
    v_dot2c_f32_bf16 v90, v115, v79
    v_lshlrev_b32 v80, 16, v107
    v_and_b32 v81, 0xffff, v107
    v_dot2c_f32_bf16 v85, v116, v80
    v_dot2c_f32_bf16 v84, v116, v81
    v_dot2c_f32_bf16 v87, v117, v80
    v_dot2c_f32_bf16 v86, v117, v81
    v_dot2c_f32_bf16 v89, v118, v80
    v_dot2c_f32_bf16 v88, v118, v81
    v_dot2c_f32_bf16 v91, v119, v80
    v_dot2c_f32_bf16 v90, v119, v81
    v_and_b32 v82, 0xffff0000, v107
    v_lshrrev_b32 v83, 16, v107
    v_dot2c_f32_bf16 v85, v120, v82
    v_dot2c_f32_bf16 v84, v120, v83
    v_dot2c_f32_bf16 v87, v121, v82
    v_dot2c_f32_bf16 v86, v121, v83
    v_dot2c_f32_bf16 v89, v122, v82
    v_dot2c_f32_bf16 v88, v122, v83
    v_dot2c_f32_bf16 v91, v123, v82
    v_dot2c_f32_bf16 v90, v123, v83
    s_nop 0
    v_permlane32_swap_b32 v84, v88
    v_permlane32_swap_b32 v85, v89
    v_permlane32_swap_b32 v86, v90
    v_permlane32_swap_b32 v87, v91
    v_add_f32 v84, v84, v88
    v_add_f32 v85, v85, v89
    v_add_f32 v86, v86, v90
    v_add_f32 v87, v87, v91
    s_nop 0
    v_permlane16_swap_b32 v84, v86
    v_permlane16_swap_b32 v85, v87
    v_add_f32 v84, v84, v86
    v_add_f32 v85, v85, v87
    s_nop 0
    v_add_f32_dpp v84, v84, v84 row_ror:8 row_mask:0xf bank_mask:0xf
    v_add_f32_dpp v85, v85, v85 row_ror:8 row_mask:0xf bank_mask:0xf
    v_and_b32 v16, 7, v1
    v_lshlrev_b32 v16, 5, v16
    v_lshrrev_b32 v17, 4, v1
    v_lshl_add_u32 v16, v17, 3, v16
    s_lshl_b32 s16, s3, 8
    s_add_u32 s16, s16, 70656
    v_add_u32 v16, s16, v16
    ds_write_b64 v16, v[84:85]
    s_lshr_b32 s16, s3, 2
    s_lshl_b32 s17, s16, 10
    s_add_u32 s17, s17, 70656
    v_lshlrev_b32 v17, 2, v1
    v_add_u32 v16, s17, v17
    s_and_b32 s17, s29, 3
    s_lshl_b32 s17, s17, 1
    s_add_u32 s17, s17, s16
    s_mul_i32 s17, s17, 14336
    s_lshr_b32 s16, s29, 2
    s_lshl_b32 s16, s16, 8
    s_add_u32 s17, s17, s16
    s_add_u32 s17, s17, 0x6e1000
    s_and_b32 s16, s3, 3
    s_cmp_eq_u32 s16, 0
    s_cselect_b32 s17, s17, 0x7ffffff0
    s_cmp_lt_u32 s2, 224
    s_cselect_b32 s17, s17, 0x7ffffff0
    s_waitcnt lgkmcnt(0)
    s_barrier
    ds_read_b32 v84, v16 offset:0
    ds_read_b32 v85, v16 offset:256
    ds_read_b32 v86, v16 offset:512
    ds_read_b32 v87, v16 offset:768
    s_waitcnt lgkmcnt(2)
    v_add_f32 v84, v84, v85
    s_waitcnt lgkmcnt(0)
    v_add_f32 v86, v86, v87
    v_add_f32 v84, v84, v86
    v_or_b32 v84, 1, v84
    buffer_store_dword v84, v17, s[8:11], s17 offen sc1
    v_lshrrev_b32 v16, 4, v1
    v_mul_u32_u24 v16, 28672, v16
    v_and_b32 v17, 15, v1
    v_lshl_add_u32 v16, v17, 2, v16
    s_lshl_b32 s16, s29, 6
    s_add_u32 s16, s16, 0x6e1000
    s_add_u32 s17, s16, 14336
    s_mov_b32 s27, 0
adaLN_cond__sliding_block_cached__moe_arch_mod__prompt_kernel_gu23p:
    buffer_load_dword v84, v16, s[8:11], s16 offen sc1
    buffer_load_dword v85, v16, s[8:11], s17 offen sc1
    s_waitcnt vmcnt(0)
    v_min_u32 v86, v84, v85
    v_cmp_eq_u32 vcc, 0, v86
    s_cmp_lt_u32 s2, 224
    s_cselect_b64 s[62:63], -1, 0
    s_and_b64 vcc, vcc, s[62:63]
    s_add_u32 s27, s27, 1
    s_cmp_ge_u32 s27, 65536
    s_cbranch_scc1 adaLN_cond__sliding_block_cached__moe_arch_mod__prompt_kernel_gu23g
    s_cbranch_vccnz adaLN_cond__sliding_block_cached__moe_arch_mod__prompt_kernel_gu23p
adaLN_cond__sliding_block_cached__moe_arch_mod__prompt_kernel_gu23g:
    v_mov_b32 v86, v84
    s_nop 1
    v_permlane16_swap_b32 v84, v86
    v_add_f32 v84, v84, v86
    v_mov_b32 v87, v85
    s_nop 1
    v_permlane16_swap_b32 v85, v87
    v_add_f32 v85, v85, v87
    v_mov_b32 v86, v84
    s_nop 1
    v_permlane32_swap_b32 v84, v86
    v_add_f32 v84, v84, v86
    v_mov_b32 v87, v85
    s_nop 1
    v_permlane32_swap_b32 v85, v87
    v_add_f32 v85, v85, v87
    v_cvt_pk_bf16_f32 v86, v84, v85
    v_lshlrev_b32 v84, 16, v86
    v_and_b32 v85, 0xffff0000, v86
    v_mul_f32 v86, 0xbfb8aa3b, v84
    v_exp_f32 v86, v86
    s_nop 0
    v_add_f32 v86, 1.0, v86
    v_rcp_f32 v86, v86
    s_nop 0
    v_mul_f32 v84, v84, v86
    v_cvt_pk_bf16_f32 v84, v84, v84
    v_lshlrev_b32 v84, 16, v84
    v_mul_f32 v84, v84, v85
    v_cvt_pk_bf16_f32 v84, v84, v84
    v_lshlrev_b32 v84, 16, v84
    s_sub_u32 s16, s3, 4
    s_lshl_b32 s16, s16, 2
    s_add_u32 s17, s16, 0
    v_readlane_b32 s20, v84, s17
    s_lshr_b32 s4, s20, 16
    s_add_u32 s17, s16, 1
    v_readlane_b32 s21, v84, s17
    s_lshr_b32 s5, s21, 16
    s_add_u32 s17, s16, 2
    v_readlane_b32 s22, v84, s17
    s_lshr_b32 s6, s22, 16
    s_add_u32 s17, s16, 3
    v_readlane_b32 s23, v84, s17
    s_lshr_b32 s7, s23, 16
    v_dot2_f32_bf16 v45, v152, s20, 0
    v_dot2_f32_bf16 v44, v152, s4, 0
    v_dot2_f32_bf16 v47, v153, s20, 0
    v_dot2_f32_bf16 v46, v153, s4, 0
    v_dot2_f32_bf16 v49, v154, s20, 0
    v_dot2_f32_bf16 v48, v154, s4, 0
    v_dot2_f32_bf16 v51, v155, s20, 0
    v_dot2_f32_bf16 v50, v155, s4, 0
    v_dot2_f32_bf16 v53, v156, s20, 0
    v_dot2_f32_bf16 v52, v156, s4, 0
    v_dot2_f32_bf16 v55, v157, s20, 0
    v_dot2_f32_bf16 v54, v157, s4, 0
    v_dot2_f32_bf16 v57, v158, s20, 0
    v_dot2_f32_bf16 v56, v158, s4, 0
    v_dot2_f32_bf16 v59, v159, s20, 0
    v_dot2_f32_bf16 v58, v159, s4, 0
    v_dot2c_f32_bf16 v45, s21, v160
    v_dot2c_f32_bf16 v44, s5, v160
    v_dot2c_f32_bf16 v47, s21, v161
    v_dot2c_f32_bf16 v46, s5, v161
    v_dot2c_f32_bf16 v49, s21, v162
    v_dot2c_f32_bf16 v48, s5, v162
    v_dot2c_f32_bf16 v51, s21, v163
    v_dot2c_f32_bf16 v50, s5, v163
    v_dot2c_f32_bf16 v53, s21, v164
    v_dot2c_f32_bf16 v52, s5, v164
    v_dot2c_f32_bf16 v55, s21, v165
    v_dot2c_f32_bf16 v54, s5, v165
    v_dot2c_f32_bf16 v57, s21, v166
    v_dot2c_f32_bf16 v56, s5, v166
    v_dot2c_f32_bf16 v59, s21, v167
    v_dot2c_f32_bf16 v58, s5, v167
    v_dot2c_f32_bf16 v45, s22, v168
    v_dot2c_f32_bf16 v44, s6, v168
    v_dot2c_f32_bf16 v47, s22, v169
    v_dot2c_f32_bf16 v46, s6, v169
    v_dot2c_f32_bf16 v49, s22, v170
    v_dot2c_f32_bf16 v48, s6, v170
    v_dot2c_f32_bf16 v51, s22, v171
    v_dot2c_f32_bf16 v50, s6, v171
    v_dot2c_f32_bf16 v53, s22, v172
    v_dot2c_f32_bf16 v52, s6, v172
    v_dot2c_f32_bf16 v55, s22, v173
    v_dot2c_f32_bf16 v54, s6, v173
    v_dot2c_f32_bf16 v57, s22, v174
    v_dot2c_f32_bf16 v56, s6, v174
    v_dot2c_f32_bf16 v59, s22, v175
    v_dot2c_f32_bf16 v58, s6, v175
    v_dot2c_f32_bf16 v45, s23, v176
    v_dot2c_f32_bf16 v44, s7, v176
    v_dot2c_f32_bf16 v47, s23, v177
    v_dot2c_f32_bf16 v46, s7, v177
    v_dot2c_f32_bf16 v49, s23, v178
    v_dot2c_f32_bf16 v48, s7, v178
    v_dot2c_f32_bf16 v51, s23, v179
    v_dot2c_f32_bf16 v50, s7, v179
    v_dot2c_f32_bf16 v53, s23, v180
    v_dot2c_f32_bf16 v52, s7, v180
    v_dot2c_f32_bf16 v55, s23, v181
    v_dot2c_f32_bf16 v54, s7, v181
    v_dot2c_f32_bf16 v57, s23, v182
    v_dot2c_f32_bf16 v56, s7, v182
    v_dot2c_f32_bf16 v59, s23, v183
    v_dot2c_f32_bf16 v58, s7, v183
    s_sub_u32 s16, s3, 4
    s_lshl_b32 s16, s16, 12
    s_add_u32 s16, s16, 73728
    v_lshlrev_b32 v16, 5, v1
    v_add_u32 v16, s16, v16
    ds_write_b128 v16, v[44:47] offset:0
    ds_write_b128 v16, v[48:51] offset:16
    ds_write_b128 v16, v[52:55] offset:2048
    ds_write_b128 v16, v[56:59] offset:2064
    s_waitcnt lgkmcnt(0)
    s_barrier
    v_lshlrev_b32 v16, 3, v0
    v_add_u32 v17, 73728, v16
    ds_read_b64 v[84:85], v17 offset:0
    ds_read_b64 v[86:87], v17 offset:4096
    ds_read_b64 v[88:89], v17 offset:8192
    ds_read_b64 v[90:91], v17 offset:12288
    s_waitcnt lgkmcnt(2)
    v_pk_add_f32 v[84:85], v[84:85], v[86:87]
    s_waitcnt lgkmcnt(0)
    v_pk_add_f32 v[88:89], v[88:89], v[90:91]
    v_pk_add_f32 v[84:85], v[84:85], v[88:89]
    v_or_b32 v84, 1, v84
    v_or_b32 v85, 1, v85
    s_lshl_b32 s16, s29, 12
    s_add_u32 s16, s16, 0x600000
    s_cmp_lt_u32 s2, 224
    s_cselect_b32 s16, s16, 0x7ffffff0
    buffer_store_dwordx2 v[84:85], v16, s[8:11], s16 offen sc1
    s_cmp_lt_u32 s2, 224
    s_cbranch_scc1 adaLN_cond__sliding_block_cached__moe_arch_mod__prompt_kernel_end
    s_sub_u32 s16, s2, 224
    s_lshl_b32 s17, s16, 7
    s_add_u32 s17, s17, 0x600000
    v_lshrrev_b32 v16, 3, v0
    v_lshlrev_b32 v16, 12, v16
    v_and_b32 v17, 7, v0
    v_lshl_add_u32 v16, v17, 4, v16
    v_cmp_gt_u32 vcc, 256, v0
    v_bfrev_b32 v17, -2
    s_nop 0
    v_cndmask_b32 v17, v17, v16, vcc
    v_mov_b32 v19, 0
    v_cndmask_b32 v18, 1, v19, vcc
    s_lshl_b32 s18, s16, 6
    v_and_b32 v19, 31, v1
    v_lshlrev_b32 v19, 1, v19
    v_add_u32 v19, s18, v19
    s_mov_b32 s19, 0x541800
    buffer_load_ushort v95, v19, s[8:11], s19 offen sc1
    v_add_u32 v20, 66560, v19
    ds_read_u16 v96, v20
    ds_read_u16 v97, v20 offset:2048
    v_mov_b32 v94, v27
    v_cvt_pk_bf16_f32 v94, v94, v94
    v_lshlrev_b32 v94, 16, v94
    v_mul_f32 v94, 0xbfb8aa3b, v94
    v_exp_f32 v94, v94
    s_nop 0
    v_add_f32 v94, 1.0, v94
    v_rcp_f32 v94, v94
    s_nop 0
    v_cvt_pk_bf16_f32 v94, v94, v94
    v_lshlrev_b32 v94, 16, v94
    s_waitcnt vmcnt(0)
    v_lshlrev_b32 v95, 16, v95
    s_waitcnt lgkmcnt(1)
    v_lshlrev_b32 v96, 16, v96
    s_waitcnt lgkmcnt(0)
    v_lshlrev_b32 v97, 16, v97
    s_mov_b32 s27, 0
adaLN_cond__sliding_block_cached__moe_arch_mod__prompt_kernel_y24p:
    s_add_u32 s19, s17, 0x0
    buffer_load_dwordx4 v[44:47], v16, s[8:11], s19 offen sc1
    s_add_u32 s19, s17, 0x40000
    buffer_load_dwordx4 v[48:51], v16, s[8:11], s19 offen sc1
    s_add_u32 s19, s17, 0x80000
    buffer_load_dwordx4 v[52:55], v16, s[8:11], s19 offen sc1
    s_add_u32 s19, s17, 0xc0000
    buffer_load_dwordx4 v[56:59], v17, s[8:11], s19 offen sc1
    s_waitcnt vmcnt(0)
    v_min3_u32 v98, v56, v57, v58
    v_min_u32 v98, v98, v59
    v_or_b32 v98, v98, v18
    v_min3_u32 v98, v98, v44, v45
    v_min3_u32 v98, v98, v46, v47
    v_min3_u32 v98, v98, v48, v49
    v_min3_u32 v98, v98, v50, v51
    v_min3_u32 v98, v98, v52, v53
    v_min3_u32 v98, v98, v54, v55
    v_cmp_eq_u32 vcc, 0, v98
    s_add_u32 s27, s27, 1
    s_cmp_ge_u32 s27, 65536
    s_cbranch_scc1 adaLN_cond__sliding_block_cached__moe_arch_mod__prompt_kernel_y24g
    s_cbranch_vccnz adaLN_cond__sliding_block_cached__moe_arch_mod__prompt_kernel_y24p
adaLN_cond__sliding_block_cached__moe_arch_mod__prompt_kernel_y24g:
    v_pk_add_f32 v[44:45], v[44:45], v[52:53]
    v_pk_add_f32 v[46:47], v[46:47], v[54:55]
    v_pk_add_f32 v[48:49], v[48:49], v[56:57]
    v_pk_add_f32 v[50:51], v[50:51], v[58:59]
    v_pk_add_f32 v[44:45], v[44:45], v[48:49]
    v_pk_add_f32 v[46:47], v[46:47], v[50:51]
    s_nop 0
    v_add_f32_dpp v44, v44, v44 row_ror:8 row_mask:0xf bank_mask:0xf
    v_add_f32_dpp v45, v45, v45 row_ror:8 row_mask:0xf bank_mask:0xf
    v_add_f32_dpp v46, v46, v46 row_ror:8 row_mask:0xf bank_mask:0xf
    v_add_f32_dpp v47, v47, v47 row_ror:8 row_mask:0xf bank_mask:0xf
    s_nop 0
    v_permlane32_swap_b32 v44, v46
    v_permlane32_swap_b32 v45, v47
    v_add_f32 v44, v44, v46
    v_add_f32 v45, v45, v47
    s_nop 1
    v_permlane16_swap_b32 v44, v45
    v_add_f32 v44, v44, v45
    v_and_b32 v16, 7, v1
    v_lshlrev_b32 v16, 4, v16
    v_lshrrev_b32 v17, 4, v1
    v_lshl_add_u32 v16, v17, 2, v16
    s_lshl_b32 s19, s3, 7
    s_add_u32 s19, s19, 91136
    v_add_u32 v16, s19, v16
    ds_write_b32 v16, v44
    v_and_b32 v16, 31, v1
    v_lshlrev_b32 v16, 2, v16
    v_add_u32 v16, 91136, v16
    s_waitcnt lgkmcnt(0)
    s_barrier
    s_cmp_lg_u32 s3, 0
    s_cbranch_scc1 adaLN_cond__sliding_block_cached__moe_arch_mod__prompt_kernel_end
    ds_read_b32 v44, v16 offset:0
    ds_read_b32 v45, v16 offset:128
    ds_read_b32 v46, v16 offset:256
    ds_read_b32 v47, v16 offset:384
    ds_read_b32 v48, v16 offset:512
    ds_read_b32 v49, v16 offset:640
    ds_read_b32 v50, v16 offset:768
    ds_read_b32 v51, v16 offset:896
    s_waitcnt lgkmcnt(3)
    v_add_f32 v44, v44, v48
    s_waitcnt lgkmcnt(2)
    v_add_f32 v45, v45, v49
    s_waitcnt lgkmcnt(1)
    v_add_f32 v46, v46, v50
    s_waitcnt lgkmcnt(0)
    v_add_f32 v47, v47, v51
    v_add_f32 v44, v44, v46
    v_add_f32 v45, v45, v47
    v_add_f32 v44, v44, v45
    v_cvt_pk_bf16_f32 v44, v44, v44
    v_lshlrev_b32 v44, 16, v44
    v_mul_f32 v44, v44, v94
    v_cvt_pk_bf16_f32 v44, v44, v44
    v_lshlrev_b32 v44, 16, v44
    v_add_f32 v44, v44, v96
    v_cvt_pk_bf16_f32 v44, v44, v44
    v_lshlrev_b32 v44, 16, v44
    v_mul_f32 v44, v44, v95
    v_cvt_pk_bf16_f32 v44, v44, v44
    v_lshlrev_b32 v44, 16, v44
    v_add_f32 v44, v44, v97
    v_cvt_pk_bf16_f32 v44, v44, v44
    s_mov_b64 exec, 0xffffffff
    buffer_store_short v44, v19, s[68:71], s13 offen sc1
adaLN_cond__sliding_block_cached__moe_arch_mod__prompt_kernel_end:
    s_endpgm
adaLN_cond__sliding_block_cached__moe_arch_mod__prompt_kernel_n1r:
    s_mov_b32 s27, 0
adaLN_cond__sliding_block_cached__moe_arch_mod__prompt_kernel_n1p:
    buffer_load_dword v134, v132, s[64:67], 0 offen sc1
    s_waitcnt vmcnt(0)
    v_cmp_eq_u32 vcc, 0, v134
    s_cmp_eq_u32 s3, 0
    s_cselect_b64 s[62:63], -1, 0
    s_and_b64 vcc, vcc, s[62:63]
    s_add_u32 s27, s27, 1
    s_cmp_ge_u32 s27, 65536
    s_cbranch_scc1 adaLN_cond__sliding_block_cached__moe_arch_mod__prompt_kernel_n1g
    s_cbranch_vccnz adaLN_cond__sliding_block_cached__moe_arch_mod__prompt_kernel_n1p
adaLN_cond__sliding_block_cached__moe_arch_mod__prompt_kernel_n1g:
    s_waitcnt vmcnt(0) lgkmcnt(0)
    s_nop 15
    s_nop 3
    s_branch adaLN_cond__sliding_block_cached__moe_arch_mod__prompt_kernel_n1b
adaLN_cond__sliding_block_cached__moe_arch_mod__prompt_kernel_kv4r:
    s_waitcnt vmcnt(0) lgkmcnt(0)
    s_nop 15
    s_nop 3
    s_mov_b32 s27, 0
adaLN_cond__sliding_block_cached__moe_arch_mod__prompt_kernel_kv4p:
    buffer_load_dwordx4 v[12:15], v21, s[8:11], s18 offen sc1
    s_waitcnt vmcnt(0)
    v_xor_b32 v8, s28, v12
    v_xor_b32 v20, s28, v13
    v_or_b32 v8, v8, v20
    v_xor_b32 v20, s28, v14
    v_or_b32 v8, v8, v20
    v_xor_b32 v20, s28, v15
    v_or_b32 v8, v8, v20
    v_cmp_ne_u32 vcc, 0, v8
    s_add_u32 s27, s27, 1
    s_cmp_ge_u32 s27, 65536
    s_cbranch_scc1 adaLN_cond__sliding_block_cached__moe_arch_mod__prompt_kernel_kv4g
    s_cbranch_vccnz adaLN_cond__sliding_block_cached__moe_arch_mod__prompt_kernel_kv4p
adaLN_cond__sliding_block_cached__moe_arch_mod__prompt_kernel_kv4g:
    s_waitcnt vmcnt(0) lgkmcnt(0)
    s_nop 15
    s_nop 3
    s_branch adaLN_cond__sliding_block_cached__moe_arch_mod__prompt_kernel_kv4b
adaLN_cond__sliding_block_cached__moe_arch_mod__prompt_kernel_fixA:
    s_waitcnt vmcnt(0) lgkmcnt(0)
    s_nop 15
    s_nop 3
    s_lshr_b32 s16, s12, 3
    s_lshl_b32 s16, s16, 17
    s_add_u32 s16, s16, 0x400000
    v_add_u32 v8, s16, v2
    v_mov_b32 v16, 0xff7fffff
    v_mov_b32 v17, 0xff7fffff
    s_mov_b32 s16, 0
adaLN_cond__sliding_block_cached__moe_arch_mod__prompt_kernel_fixAm:
    s_add_u32 s17, s16, 0
    buffer_load_dwordx4 v[200:203], v8, s[8:11], s17 offen offset:0
    buffer_load_dwordx4 v[204:207], v8, s[8:11], s17 offen offset:1024
    buffer_load_dwordx4 v[208:211], v8, s[8:11], s17 offen offset:2048
    buffer_load_dwordx4 v[212:215], v8, s[8:11], s17 offen offset:3072
    s_waitcnt vmcnt(3)
    v_mfma_f32_16x16x32_bf16 v[184:187], v[200:203], v[152:155], 0
    v_mfma_f32_16x16x32_bf16 v[188:191], v[200:203], v[168:171], 0
    s_waitcnt vmcnt(2)
    v_mfma_f32_16x16x32_bf16 v[192:195], v[204:207], v[152:155], 0
    v_mfma_f32_16x16x32_bf16 v[196:199], v[204:207], v[168:171], 0
    s_waitcnt vmcnt(1)
    v_mfma_f32_16x16x32_bf16 v[184:187], v[208:211], v[156:159], v[184:187]
    v_mfma_f32_16x16x32_bf16 v[188:191], v[208:211], v[172:175], v[188:191]
    s_waitcnt vmcnt(0)
    v_mfma_f32_16x16x32_bf16 v[192:195], v[212:215], v[156:159], v[192:195]
    v_mfma_f32_16x16x32_bf16 v[196:199], v[212:215], v[172:175], v[196:199]
    s_add_u32 s17, s16, 4096
    buffer_load_dwordx4 v[200:203], v8, s[8:11], s17 offen offset:0
    buffer_load_dwordx4 v[204:207], v8, s[8:11], s17 offen offset:1024
    buffer_load_dwordx4 v[208:211], v8, s[8:11], s17 offen offset:2048
    buffer_load_dwordx4 v[212:215], v8, s[8:11], s17 offen offset:3072
    s_waitcnt vmcnt(3)
    v_mfma_f32_16x16x32_bf16 v[184:187], v[200:203], v[160:163], v[184:187]
    v_mfma_f32_16x16x32_bf16 v[188:191], v[200:203], v[176:179], v[188:191]
    s_waitcnt vmcnt(2)
    v_mfma_f32_16x16x32_bf16 v[192:195], v[204:207], v[160:163], v[192:195]
    v_mfma_f32_16x16x32_bf16 v[196:199], v[204:207], v[176:179], v[196:199]
    s_waitcnt vmcnt(1)
    v_mfma_f32_16x16x32_bf16 v[184:187], v[208:211], v[164:167], v[184:187]
    v_mfma_f32_16x16x32_bf16 v[188:191], v[208:211], v[180:183], v[188:191]
    s_waitcnt vmcnt(0)
    v_mfma_f32_16x16x32_bf16 v[192:195], v[212:215], v[164:167], v[192:195]
    v_mfma_f32_16x16x32_bf16 v[196:199], v[212:215], v[180:183], v[196:199]
    s_nop 3
    v_max3_f32 v16, v16, v184, v185
    v_max3_f32 v16, v16, v186, v187
    v_max3_f32 v17, v17, v188, v189
    v_max3_f32 v17, v17, v190, v191
    v_max3_f32 v16, v16, v192, v193
    v_max3_f32 v16, v16, v194, v195
    v_max3_f32 v17, v17, v196, v197
    v_max3_f32 v17, v17, v198, v199
    s_add_u32 s16, s16, 8192
    s_cmp_lt_u32 s16, 0x20000
    s_cbranch_scc1 adaLN_cond__sliding_block_cached__moe_arch_mod__prompt_kernel_fixAm
    v_mov_b32 v18, v16
    v_mov_b32 v19, v17
    s_nop 0
    v_permlane16_swap_b32 v16, v18
    v_permlane16_swap_b32 v17, v19
    v_max_f32 v16, v16, v18
    v_max_f32 v17, v17, v19
    v_mov_b32 v18, v16
    v_mov_b32 v19, v17
    s_nop 0
    v_permlane32_swap_b32 v16, v18
    v_permlane32_swap_b32 v17, v19
    v_max_f32 v16, v16, v18
    v_max_f32 v17, v17, v19
    v_sub_f32 v216, 0, v16
    v_sub_f32 v217, 0, v16
    v_sub_f32 v218, 0, v16
    v_sub_f32 v219, 0, v16
    v_sub_f32 v220, 0, v17
    v_sub_f32 v221, 0, v17
    v_sub_f32 v222, 0, v17
    v_sub_f32 v223, 0, v17
    s_mov_b32 s17, 0x0
    buffer_load_dwordx4 v[200:203], v8, s[8:11], s17 offen offset:0
    buffer_load_dwordx4 v[204:207], v8, s[8:11], s17 offen offset:1024
    buffer_load_dwordx4 v[208:211], v8, s[8:11], s17 offen offset:2048
    buffer_load_dwordx4 v[212:215], v8, s[8:11], s17 offen offset:3072
    s_waitcnt vmcnt(3)
    v_mfma_f32_16x16x32_bf16 v[184:187], v[200:203], v[152:155], v[216:219]
    v_mfma_f32_16x16x32_bf16 v[188:191], v[200:203], v[168:171], v[220:223]
    s_waitcnt vmcnt(2)
    v_mfma_f32_16x16x32_bf16 v[192:195], v[204:207], v[152:155], v[216:219]
    v_mfma_f32_16x16x32_bf16 v[196:199], v[204:207], v[168:171], v[220:223]
    s_waitcnt vmcnt(1)
    v_mfma_f32_16x16x32_bf16 v[184:187], v[208:211], v[156:159], v[184:187]
    v_mfma_f32_16x16x32_bf16 v[188:191], v[208:211], v[172:175], v[188:191]
    s_waitcnt vmcnt(0)
    v_mfma_f32_16x16x32_bf16 v[192:195], v[212:215], v[156:159], v[192:195]
    v_mfma_f32_16x16x32_bf16 v[196:199], v[212:215], v[172:175], v[196:199]
    s_mov_b32 s17, 0x1000
    buffer_load_dwordx4 v[200:203], v8, s[8:11], s17 offen offset:0
    buffer_load_dwordx4 v[204:207], v8, s[8:11], s17 offen offset:1024
    buffer_load_dwordx4 v[208:211], v8, s[8:11], s17 offen offset:2048
    buffer_load_dwordx4 v[212:215], v8, s[8:11], s17 offen offset:3072
    s_waitcnt vmcnt(3)
    v_mfma_f32_16x16x32_bf16 v[184:187], v[200:203], v[160:163], v[184:187]
    v_mfma_f32_16x16x32_bf16 v[188:191], v[200:203], v[176:179], v[188:191]
    s_waitcnt vmcnt(2)
    v_mfma_f32_16x16x32_bf16 v[192:195], v[204:207], v[160:163], v[192:195]
    v_mfma_f32_16x16x32_bf16 v[196:199], v[204:207], v[176:179], v[196:199]
    s_waitcnt vmcnt(1)
    v_mfma_f32_16x16x32_bf16 v[184:187], v[208:211], v[164:167], v[184:187]
    v_mfma_f32_16x16x32_bf16 v[188:191], v[208:211], v[180:183], v[188:191]
    s_waitcnt vmcnt(0)
    v_mfma_f32_16x16x32_bf16 v[192:195], v[212:215], v[164:167], v[192:195]
    v_mfma_f32_16x16x32_bf16 v[196:199], v[212:215], v[180:183], v[196:199]
    s_nop 3
    v_exp_f32 v184, v184
    v_exp_f32 v185, v185
    s_nop 0
    v_add_f32 v9, v184, v185
    v_cvt_pk_bf16_f32 v24, v184, v185
    v_exp_f32 v186, v186
    v_exp_f32 v187, v187
    v_add_f32 v9, v9, v186
    v_add_f32 v9, v9, v187
    v_cvt_pk_bf16_f32 v25, v186, v187
    v_exp_f32 v188, v188
    v_exp_f32 v189, v189
    s_nop 0
    v_add_f32 v10, v188, v189
    v_cvt_pk_bf16_f32 v28, v188, v189
    v_exp_f32 v190, v190
    v_exp_f32 v191, v191
    v_add_f32 v10, v10, v190
    v_add_f32 v10, v10, v191
    v_cvt_pk_bf16_f32 v29, v190, v191
    v_exp_f32 v192, v192
    v_exp_f32 v193, v193
    v_add_f32 v9, v9, v192
    v_add_f32 v9, v9, v193
    v_cvt_pk_bf16_f32 v26, v192, v193
    v_exp_f32 v194, v194
    v_exp_f32 v195, v195
    v_add_f32 v9, v9, v194
    v_add_f32 v9, v9, v195
    v_cvt_pk_bf16_f32 v27, v194, v195
    v_exp_f32 v196, v196
    v_exp_f32 v197, v197
    v_add_f32 v10, v10, v196
    v_add_f32 v10, v10, v197
    v_cvt_pk_bf16_f32 v30, v196, v197
    v_exp_f32 v198, v198
    v_exp_f32 v199, v199
    v_add_f32 v10, v10, v198
    v_add_f32 v10, v10, v199
    v_cvt_pk_bf16_f32 v31, v198, v199
    s_mov_b32 s17, 0x2000
    buffer_load_dwordx4 v[200:203], v8, s[8:11], s17 offen offset:0
    buffer_load_dwordx4 v[204:207], v8, s[8:11], s17 offen offset:1024
    buffer_load_dwordx4 v[208:211], v8, s[8:11], s17 offen offset:2048
    buffer_load_dwordx4 v[212:215], v8, s[8:11], s17 offen offset:3072
    s_waitcnt vmcnt(3)
    v_mfma_f32_16x16x32_bf16 v[184:187], v[200:203], v[152:155], v[216:219]
    v_mfma_f32_16x16x32_bf16 v[188:191], v[200:203], v[168:171], v[220:223]
    s_waitcnt vmcnt(2)
    v_mfma_f32_16x16x32_bf16 v[192:195], v[204:207], v[152:155], v[216:219]
    v_mfma_f32_16x16x32_bf16 v[196:199], v[204:207], v[168:171], v[220:223]
    s_waitcnt vmcnt(1)
    v_mfma_f32_16x16x32_bf16 v[184:187], v[208:211], v[156:159], v[184:187]
    v_mfma_f32_16x16x32_bf16 v[188:191], v[208:211], v[172:175], v[188:191]
    s_waitcnt vmcnt(0)
    v_mfma_f32_16x16x32_bf16 v[192:195], v[212:215], v[156:159], v[192:195]
    v_mfma_f32_16x16x32_bf16 v[196:199], v[212:215], v[172:175], v[196:199]
    s_mov_b32 s17, 0x3000
    buffer_load_dwordx4 v[200:203], v8, s[8:11], s17 offen offset:0
    buffer_load_dwordx4 v[204:207], v8, s[8:11], s17 offen offset:1024
    buffer_load_dwordx4 v[208:211], v8, s[8:11], s17 offen offset:2048
    buffer_load_dwordx4 v[212:215], v8, s[8:11], s17 offen offset:3072
    s_waitcnt vmcnt(3)
    v_mfma_f32_16x16x32_bf16 v[184:187], v[200:203], v[160:163], v[184:187]
    v_mfma_f32_16x16x32_bf16 v[188:191], v[200:203], v[176:179], v[188:191]
    s_waitcnt vmcnt(2)
    v_mfma_f32_16x16x32_bf16 v[192:195], v[204:207], v[160:163], v[192:195]
    v_mfma_f32_16x16x32_bf16 v[196:199], v[204:207], v[176:179], v[196:199]
    s_waitcnt vmcnt(1)
    v_mfma_f32_16x16x32_bf16 v[184:187], v[208:211], v[164:167], v[184:187]
    v_mfma_f32_16x16x32_bf16 v[188:191], v[208:211], v[180:183], v[188:191]
    s_waitcnt vmcnt(0)
    v_mfma_f32_16x16x32_bf16 v[192:195], v[212:215], v[164:167], v[192:195]
    v_mfma_f32_16x16x32_bf16 v[196:199], v[212:215], v[180:183], v[196:199]
    s_nop 3
    v_exp_f32 v184, v184
    v_exp_f32 v185, v185
    v_add_f32 v9, v9, v184
    v_add_f32 v9, v9, v185
    v_cvt_pk_bf16_f32 v32, v184, v185
    v_exp_f32 v186, v186
    v_exp_f32 v187, v187
    v_add_f32 v9, v9, v186
    v_add_f32 v9, v9, v187
    v_cvt_pk_bf16_f32 v33, v186, v187
    v_exp_f32 v188, v188
    v_exp_f32 v189, v189
    v_add_f32 v10, v10, v188
    v_add_f32 v10, v10, v189
    v_cvt_pk_bf16_f32 v36, v188, v189
    v_exp_f32 v190, v190
    v_exp_f32 v191, v191
    v_add_f32 v10, v10, v190
    v_add_f32 v10, v10, v191
    v_cvt_pk_bf16_f32 v37, v190, v191
    v_exp_f32 v192, v192
    v_exp_f32 v193, v193
    v_add_f32 v9, v9, v192
    v_add_f32 v9, v9, v193
    v_cvt_pk_bf16_f32 v34, v192, v193
    v_exp_f32 v194, v194
    v_exp_f32 v195, v195
    v_add_f32 v9, v9, v194
    v_add_f32 v9, v9, v195
    v_cvt_pk_bf16_f32 v35, v194, v195
    v_exp_f32 v196, v196
    v_exp_f32 v197, v197
    v_add_f32 v10, v10, v196
    v_add_f32 v10, v10, v197
    v_cvt_pk_bf16_f32 v38, v196, v197
    v_exp_f32 v198, v198
    v_exp_f32 v199, v199
    v_add_f32 v10, v10, v198
    v_add_f32 v10, v10, v199
    v_cvt_pk_bf16_f32 v39, v198, v199
    s_mov_b32 s17, 0x4000
    buffer_load_dwordx4 v[200:203], v8, s[8:11], s17 offen offset:0
    buffer_load_dwordx4 v[204:207], v8, s[8:11], s17 offen offset:1024
    buffer_load_dwordx4 v[208:211], v8, s[8:11], s17 offen offset:2048
    buffer_load_dwordx4 v[212:215], v8, s[8:11], s17 offen offset:3072
    s_waitcnt vmcnt(3)
    v_mfma_f32_16x16x32_bf16 v[184:187], v[200:203], v[152:155], v[216:219]
    v_mfma_f32_16x16x32_bf16 v[188:191], v[200:203], v[168:171], v[220:223]
    s_waitcnt vmcnt(2)
    v_mfma_f32_16x16x32_bf16 v[192:195], v[204:207], v[152:155], v[216:219]
    v_mfma_f32_16x16x32_bf16 v[196:199], v[204:207], v[168:171], v[220:223]
    s_waitcnt vmcnt(1)
    v_mfma_f32_16x16x32_bf16 v[184:187], v[208:211], v[156:159], v[184:187]
    v_mfma_f32_16x16x32_bf16 v[188:191], v[208:211], v[172:175], v[188:191]
    s_waitcnt vmcnt(0)
    v_mfma_f32_16x16x32_bf16 v[192:195], v[212:215], v[156:159], v[192:195]
    v_mfma_f32_16x16x32_bf16 v[196:199], v[212:215], v[172:175], v[196:199]
    s_mov_b32 s17, 0x5000
    buffer_load_dwordx4 v[200:203], v8, s[8:11], s17 offen offset:0
    buffer_load_dwordx4 v[204:207], v8, s[8:11], s17 offen offset:1024
    buffer_load_dwordx4 v[208:211], v8, s[8:11], s17 offen offset:2048
    buffer_load_dwordx4 v[212:215], v8, s[8:11], s17 offen offset:3072
    s_waitcnt vmcnt(3)
    v_mfma_f32_16x16x32_bf16 v[184:187], v[200:203], v[160:163], v[184:187]
    v_mfma_f32_16x16x32_bf16 v[188:191], v[200:203], v[176:179], v[188:191]
    s_waitcnt vmcnt(2)
    v_mfma_f32_16x16x32_bf16 v[192:195], v[204:207], v[160:163], v[192:195]
    v_mfma_f32_16x16x32_bf16 v[196:199], v[204:207], v[176:179], v[196:199]
    s_waitcnt vmcnt(1)
    v_mfma_f32_16x16x32_bf16 v[184:187], v[208:211], v[164:167], v[184:187]
    v_mfma_f32_16x16x32_bf16 v[188:191], v[208:211], v[180:183], v[188:191]
    s_waitcnt vmcnt(0)
    v_mfma_f32_16x16x32_bf16 v[192:195], v[212:215], v[164:167], v[192:195]
    v_mfma_f32_16x16x32_bf16 v[196:199], v[212:215], v[180:183], v[196:199]
    s_nop 3
    v_exp_f32 v184, v184
    v_exp_f32 v185, v185
    v_add_f32 v9, v9, v184
    v_add_f32 v9, v9, v185
    v_cvt_pk_bf16_f32 v40, v184, v185
    v_exp_f32 v186, v186
    v_exp_f32 v187, v187
    v_add_f32 v9, v9, v186
    v_add_f32 v9, v9, v187
    v_cvt_pk_bf16_f32 v41, v186, v187
    v_exp_f32 v188, v188
    v_exp_f32 v189, v189
    v_add_f32 v10, v10, v188
    v_add_f32 v10, v10, v189
    v_cvt_pk_bf16_f32 v44, v188, v189
    v_exp_f32 v190, v190
    v_exp_f32 v191, v191
    v_add_f32 v10, v10, v190
    v_add_f32 v10, v10, v191
    v_cvt_pk_bf16_f32 v45, v190, v191
    v_exp_f32 v192, v192
    v_exp_f32 v193, v193
    v_add_f32 v9, v9, v192
    v_add_f32 v9, v9, v193
    v_cvt_pk_bf16_f32 v42, v192, v193
    v_exp_f32 v194, v194
    v_exp_f32 v195, v195
    v_add_f32 v9, v9, v194
    v_add_f32 v9, v9, v195
    v_cvt_pk_bf16_f32 v43, v194, v195
    v_exp_f32 v196, v196
    v_exp_f32 v197, v197
    v_add_f32 v10, v10, v196
    v_add_f32 v10, v10, v197
    v_cvt_pk_bf16_f32 v46, v196, v197
    v_exp_f32 v198, v198
    v_exp_f32 v199, v199
    v_add_f32 v10, v10, v198
    v_add_f32 v10, v10, v199
    v_cvt_pk_bf16_f32 v47, v198, v199
    s_mov_b32 s17, 0x6000
    buffer_load_dwordx4 v[200:203], v8, s[8:11], s17 offen offset:0
    buffer_load_dwordx4 v[204:207], v8, s[8:11], s17 offen offset:1024
    buffer_load_dwordx4 v[208:211], v8, s[8:11], s17 offen offset:2048
    buffer_load_dwordx4 v[212:215], v8, s[8:11], s17 offen offset:3072
    s_waitcnt vmcnt(3)
    v_mfma_f32_16x16x32_bf16 v[184:187], v[200:203], v[152:155], v[216:219]
    v_mfma_f32_16x16x32_bf16 v[188:191], v[200:203], v[168:171], v[220:223]
    s_waitcnt vmcnt(2)
    v_mfma_f32_16x16x32_bf16 v[192:195], v[204:207], v[152:155], v[216:219]
    v_mfma_f32_16x16x32_bf16 v[196:199], v[204:207], v[168:171], v[220:223]
    s_waitcnt vmcnt(1)
    v_mfma_f32_16x16x32_bf16 v[184:187], v[208:211], v[156:159], v[184:187]
    v_mfma_f32_16x16x32_bf16 v[188:191], v[208:211], v[172:175], v[188:191]
    s_waitcnt vmcnt(0)
    v_mfma_f32_16x16x32_bf16 v[192:195], v[212:215], v[156:159], v[192:195]
    v_mfma_f32_16x16x32_bf16 v[196:199], v[212:215], v[172:175], v[196:199]
    s_mov_b32 s17, 0x7000
    buffer_load_dwordx4 v[200:203], v8, s[8:11], s17 offen offset:0
    buffer_load_dwordx4 v[204:207], v8, s[8:11], s17 offen offset:1024
    buffer_load_dwordx4 v[208:211], v8, s[8:11], s17 offen offset:2048
    buffer_load_dwordx4 v[212:215], v8, s[8:11], s17 offen offset:3072
    s_waitcnt vmcnt(3)
    v_mfma_f32_16x16x32_bf16 v[184:187], v[200:203], v[160:163], v[184:187]
    v_mfma_f32_16x16x32_bf16 v[188:191], v[200:203], v[176:179], v[188:191]
    s_waitcnt vmcnt(2)
    v_mfma_f32_16x16x32_bf16 v[192:195], v[204:207], v[160:163], v[192:195]
    v_mfma_f32_16x16x32_bf16 v[196:199], v[204:207], v[176:179], v[196:199]
    s_waitcnt vmcnt(1)
    v_mfma_f32_16x16x32_bf16 v[184:187], v[208:211], v[164:167], v[184:187]
    v_mfma_f32_16x16x32_bf16 v[188:191], v[208:211], v[180:183], v[188:191]
    s_waitcnt vmcnt(0)
    v_mfma_f32_16x16x32_bf16 v[192:195], v[212:215], v[164:167], v[192:195]
    v_mfma_f32_16x16x32_bf16 v[196:199], v[212:215], v[180:183], v[196:199]
    s_nop 3
    v_exp_f32 v184, v184
    v_exp_f32 v185, v185
    v_add_f32 v9, v9, v184
    v_add_f32 v9, v9, v185
    v_cvt_pk_bf16_f32 v48, v184, v185
    v_exp_f32 v186, v186
    v_exp_f32 v187, v187
    v_add_f32 v9, v9, v186
    v_add_f32 v9, v9, v187
    v_cvt_pk_bf16_f32 v49, v186, v187
    v_exp_f32 v188, v188
    v_exp_f32 v189, v189
    v_add_f32 v10, v10, v188
    v_add_f32 v10, v10, v189
    v_cvt_pk_bf16_f32 v52, v188, v189
    v_exp_f32 v190, v190
    v_exp_f32 v191, v191
    v_add_f32 v10, v10, v190
    v_add_f32 v10, v10, v191
    v_cvt_pk_bf16_f32 v53, v190, v191
    v_exp_f32 v192, v192
    v_exp_f32 v193, v193
    v_add_f32 v9, v9, v192
    v_add_f32 v9, v9, v193
    v_cvt_pk_bf16_f32 v50, v192, v193
    v_exp_f32 v194, v194
    v_exp_f32 v195, v195
    v_add_f32 v9, v9, v194
    v_add_f32 v9, v9, v195
    v_cvt_pk_bf16_f32 v51, v194, v195
    v_exp_f32 v196, v196
    v_exp_f32 v197, v197
    v_add_f32 v10, v10, v196
    v_add_f32 v10, v10, v197
    v_cvt_pk_bf16_f32 v54, v196, v197
    v_exp_f32 v198, v198
    v_exp_f32 v199, v199
    v_add_f32 v10, v10, v198
    v_add_f32 v10, v10, v199
    v_cvt_pk_bf16_f32 v55, v198, v199
    s_mov_b32 s17, 0x8000
    buffer_load_dwordx4 v[200:203], v8, s[8:11], s17 offen offset:0
    buffer_load_dwordx4 v[204:207], v8, s[8:11], s17 offen offset:1024
    buffer_load_dwordx4 v[208:211], v8, s[8:11], s17 offen offset:2048
    buffer_load_dwordx4 v[212:215], v8, s[8:11], s17 offen offset:3072
    s_waitcnt vmcnt(3)
    v_mfma_f32_16x16x32_bf16 v[184:187], v[200:203], v[152:155], v[216:219]
    v_mfma_f32_16x16x32_bf16 v[188:191], v[200:203], v[168:171], v[220:223]
    s_waitcnt vmcnt(2)
    v_mfma_f32_16x16x32_bf16 v[192:195], v[204:207], v[152:155], v[216:219]
    v_mfma_f32_16x16x32_bf16 v[196:199], v[204:207], v[168:171], v[220:223]
    s_waitcnt vmcnt(1)
    v_mfma_f32_16x16x32_bf16 v[184:187], v[208:211], v[156:159], v[184:187]
    v_mfma_f32_16x16x32_bf16 v[188:191], v[208:211], v[172:175], v[188:191]
    s_waitcnt vmcnt(0)
    v_mfma_f32_16x16x32_bf16 v[192:195], v[212:215], v[156:159], v[192:195]
    v_mfma_f32_16x16x32_bf16 v[196:199], v[212:215], v[172:175], v[196:199]
    s_mov_b32 s17, 0x9000
    buffer_load_dwordx4 v[200:203], v8, s[8:11], s17 offen offset:0
    buffer_load_dwordx4 v[204:207], v8, s[8:11], s17 offen offset:1024
    buffer_load_dwordx4 v[208:211], v8, s[8:11], s17 offen offset:2048
    buffer_load_dwordx4 v[212:215], v8, s[8:11], s17 offen offset:3072
    s_waitcnt vmcnt(3)
    v_mfma_f32_16x16x32_bf16 v[184:187], v[200:203], v[160:163], v[184:187]
    v_mfma_f32_16x16x32_bf16 v[188:191], v[200:203], v[176:179], v[188:191]
    s_waitcnt vmcnt(2)
    v_mfma_f32_16x16x32_bf16 v[192:195], v[204:207], v[160:163], v[192:195]
    v_mfma_f32_16x16x32_bf16 v[196:199], v[204:207], v[176:179], v[196:199]
    s_waitcnt vmcnt(1)
    v_mfma_f32_16x16x32_bf16 v[184:187], v[208:211], v[164:167], v[184:187]
    v_mfma_f32_16x16x32_bf16 v[188:191], v[208:211], v[180:183], v[188:191]
    s_waitcnt vmcnt(0)
    v_mfma_f32_16x16x32_bf16 v[192:195], v[212:215], v[164:167], v[192:195]
    v_mfma_f32_16x16x32_bf16 v[196:199], v[212:215], v[180:183], v[196:199]
    s_nop 3
    v_exp_f32 v184, v184
    v_exp_f32 v185, v185
    v_add_f32 v9, v9, v184
    v_add_f32 v9, v9, v185
    v_cvt_pk_bf16_f32 v56, v184, v185
    v_exp_f32 v186, v186
    v_exp_f32 v187, v187
    v_add_f32 v9, v9, v186
    v_add_f32 v9, v9, v187
    v_cvt_pk_bf16_f32 v57, v186, v187
    v_exp_f32 v188, v188
    v_exp_f32 v189, v189
    v_add_f32 v10, v10, v188
    v_add_f32 v10, v10, v189
    v_cvt_pk_bf16_f32 v60, v188, v189
    v_exp_f32 v190, v190
    v_exp_f32 v191, v191
    v_add_f32 v10, v10, v190
    v_add_f32 v10, v10, v191
    v_cvt_pk_bf16_f32 v61, v190, v191
    v_exp_f32 v192, v192
    v_exp_f32 v193, v193
    v_add_f32 v9, v9, v192
    v_add_f32 v9, v9, v193
    v_cvt_pk_bf16_f32 v58, v192, v193
    v_exp_f32 v194, v194
    v_exp_f32 v195, v195
    v_add_f32 v9, v9, v194
    v_add_f32 v9, v9, v195
    v_cvt_pk_bf16_f32 v59, v194, v195
    v_exp_f32 v196, v196
    v_exp_f32 v197, v197
    v_add_f32 v10, v10, v196
    v_add_f32 v10, v10, v197
    v_cvt_pk_bf16_f32 v62, v196, v197
    v_exp_f32 v198, v198
    v_exp_f32 v199, v199
    v_add_f32 v10, v10, v198
    v_add_f32 v10, v10, v199
    v_cvt_pk_bf16_f32 v63, v198, v199
    s_mov_b32 s17, 0xa000
    buffer_load_dwordx4 v[200:203], v8, s[8:11], s17 offen offset:0
    buffer_load_dwordx4 v[204:207], v8, s[8:11], s17 offen offset:1024
    buffer_load_dwordx4 v[208:211], v8, s[8:11], s17 offen offset:2048
    buffer_load_dwordx4 v[212:215], v8, s[8:11], s17 offen offset:3072
    s_waitcnt vmcnt(3)
    v_mfma_f32_16x16x32_bf16 v[184:187], v[200:203], v[152:155], v[216:219]
    v_mfma_f32_16x16x32_bf16 v[188:191], v[200:203], v[168:171], v[220:223]
    s_waitcnt vmcnt(2)
    v_mfma_f32_16x16x32_bf16 v[192:195], v[204:207], v[152:155], v[216:219]
    v_mfma_f32_16x16x32_bf16 v[196:199], v[204:207], v[168:171], v[220:223]
    s_waitcnt vmcnt(1)
    v_mfma_f32_16x16x32_bf16 v[184:187], v[208:211], v[156:159], v[184:187]
    v_mfma_f32_16x16x32_bf16 v[188:191], v[208:211], v[172:175], v[188:191]
    s_waitcnt vmcnt(0)
    v_mfma_f32_16x16x32_bf16 v[192:195], v[212:215], v[156:159], v[192:195]
    v_mfma_f32_16x16x32_bf16 v[196:199], v[212:215], v[172:175], v[196:199]
    s_mov_b32 s17, 0xb000
    buffer_load_dwordx4 v[200:203], v8, s[8:11], s17 offen offset:0
    buffer_load_dwordx4 v[204:207], v8, s[8:11], s17 offen offset:1024
    buffer_load_dwordx4 v[208:211], v8, s[8:11], s17 offen offset:2048
    buffer_load_dwordx4 v[212:215], v8, s[8:11], s17 offen offset:3072
    s_waitcnt vmcnt(3)
    v_mfma_f32_16x16x32_bf16 v[184:187], v[200:203], v[160:163], v[184:187]
    v_mfma_f32_16x16x32_bf16 v[188:191], v[200:203], v[176:179], v[188:191]
    s_waitcnt vmcnt(2)
    v_mfma_f32_16x16x32_bf16 v[192:195], v[204:207], v[160:163], v[192:195]
    v_mfma_f32_16x16x32_bf16 v[196:199], v[204:207], v[176:179], v[196:199]
    s_waitcnt vmcnt(1)
    v_mfma_f32_16x16x32_bf16 v[184:187], v[208:211], v[164:167], v[184:187]
    v_mfma_f32_16x16x32_bf16 v[188:191], v[208:211], v[180:183], v[188:191]
    s_waitcnt vmcnt(0)
    v_mfma_f32_16x16x32_bf16 v[192:195], v[212:215], v[164:167], v[192:195]
    v_mfma_f32_16x16x32_bf16 v[196:199], v[212:215], v[180:183], v[196:199]
    s_nop 3
    v_exp_f32 v184, v184
    v_exp_f32 v185, v185
    v_add_f32 v9, v9, v184
    v_add_f32 v9, v9, v185
    v_cvt_pk_bf16_f32 v64, v184, v185
    v_exp_f32 v186, v186
    v_exp_f32 v187, v187
    v_add_f32 v9, v9, v186
    v_add_f32 v9, v9, v187
    v_cvt_pk_bf16_f32 v65, v186, v187
    v_exp_f32 v188, v188
    v_exp_f32 v189, v189
    v_add_f32 v10, v10, v188
    v_add_f32 v10, v10, v189
    v_cvt_pk_bf16_f32 v68, v188, v189
    v_exp_f32 v190, v190
    v_exp_f32 v191, v191
    v_add_f32 v10, v10, v190
    v_add_f32 v10, v10, v191
    v_cvt_pk_bf16_f32 v69, v190, v191
    v_exp_f32 v192, v192
    v_exp_f32 v193, v193
    v_add_f32 v9, v9, v192
    v_add_f32 v9, v9, v193
    v_cvt_pk_bf16_f32 v66, v192, v193
    v_exp_f32 v194, v194
    v_exp_f32 v195, v195
    v_add_f32 v9, v9, v194
    v_add_f32 v9, v9, v195
    v_cvt_pk_bf16_f32 v67, v194, v195
    v_exp_f32 v196, v196
    v_exp_f32 v197, v197
    v_add_f32 v10, v10, v196
    v_add_f32 v10, v10, v197
    v_cvt_pk_bf16_f32 v70, v196, v197
    v_exp_f32 v198, v198
    v_exp_f32 v199, v199
    v_add_f32 v10, v10, v198
    v_add_f32 v10, v10, v199
    v_cvt_pk_bf16_f32 v71, v198, v199
    s_mov_b32 s17, 0xc000
    buffer_load_dwordx4 v[200:203], v8, s[8:11], s17 offen offset:0
    buffer_load_dwordx4 v[204:207], v8, s[8:11], s17 offen offset:1024
    buffer_load_dwordx4 v[208:211], v8, s[8:11], s17 offen offset:2048
    buffer_load_dwordx4 v[212:215], v8, s[8:11], s17 offen offset:3072
    s_waitcnt vmcnt(3)
    v_mfma_f32_16x16x32_bf16 v[184:187], v[200:203], v[152:155], v[216:219]
    v_mfma_f32_16x16x32_bf16 v[188:191], v[200:203], v[168:171], v[220:223]
    s_waitcnt vmcnt(2)
    v_mfma_f32_16x16x32_bf16 v[192:195], v[204:207], v[152:155], v[216:219]
    v_mfma_f32_16x16x32_bf16 v[196:199], v[204:207], v[168:171], v[220:223]
    s_waitcnt vmcnt(1)
    v_mfma_f32_16x16x32_bf16 v[184:187], v[208:211], v[156:159], v[184:187]
    v_mfma_f32_16x16x32_bf16 v[188:191], v[208:211], v[172:175], v[188:191]
    s_waitcnt vmcnt(0)
    v_mfma_f32_16x16x32_bf16 v[192:195], v[212:215], v[156:159], v[192:195]
    v_mfma_f32_16x16x32_bf16 v[196:199], v[212:215], v[172:175], v[196:199]
    s_mov_b32 s17, 0xd000
    buffer_load_dwordx4 v[200:203], v8, s[8:11], s17 offen offset:0
    buffer_load_dwordx4 v[204:207], v8, s[8:11], s17 offen offset:1024
    buffer_load_dwordx4 v[208:211], v8, s[8:11], s17 offen offset:2048
    buffer_load_dwordx4 v[212:215], v8, s[8:11], s17 offen offset:3072
    s_waitcnt vmcnt(3)
    v_mfma_f32_16x16x32_bf16 v[184:187], v[200:203], v[160:163], v[184:187]
    v_mfma_f32_16x16x32_bf16 v[188:191], v[200:203], v[176:179], v[188:191]
    s_waitcnt vmcnt(2)
    v_mfma_f32_16x16x32_bf16 v[192:195], v[204:207], v[160:163], v[192:195]
    v_mfma_f32_16x16x32_bf16 v[196:199], v[204:207], v[176:179], v[196:199]
    s_waitcnt vmcnt(1)
    v_mfma_f32_16x16x32_bf16 v[184:187], v[208:211], v[164:167], v[184:187]
    v_mfma_f32_16x16x32_bf16 v[188:191], v[208:211], v[180:183], v[188:191]
    s_waitcnt vmcnt(0)
    v_mfma_f32_16x16x32_bf16 v[192:195], v[212:215], v[164:167], v[192:195]
    v_mfma_f32_16x16x32_bf16 v[196:199], v[212:215], v[180:183], v[196:199]
    s_nop 3
    v_exp_f32 v184, v184
    v_exp_f32 v185, v185
    v_add_f32 v9, v9, v184
    v_add_f32 v9, v9, v185
    v_cvt_pk_bf16_f32 v72, v184, v185
    v_exp_f32 v186, v186
    v_exp_f32 v187, v187
    v_add_f32 v9, v9, v186
    v_add_f32 v9, v9, v187
    v_cvt_pk_bf16_f32 v73, v186, v187
    v_exp_f32 v188, v188
    v_exp_f32 v189, v189
    v_add_f32 v10, v10, v188
    v_add_f32 v10, v10, v189
    v_cvt_pk_bf16_f32 v76, v188, v189
    v_exp_f32 v190, v190
    v_exp_f32 v191, v191
    v_add_f32 v10, v10, v190
    v_add_f32 v10, v10, v191
    v_cvt_pk_bf16_f32 v77, v190, v191
    v_exp_f32 v192, v192
    v_exp_f32 v193, v193
    v_add_f32 v9, v9, v192
    v_add_f32 v9, v9, v193
    v_cvt_pk_bf16_f32 v74, v192, v193
    v_exp_f32 v194, v194
    v_exp_f32 v195, v195
    v_add_f32 v9, v9, v194
    v_add_f32 v9, v9, v195
    v_cvt_pk_bf16_f32 v75, v194, v195
    v_exp_f32 v196, v196
    v_exp_f32 v197, v197
    v_add_f32 v10, v10, v196
    v_add_f32 v10, v10, v197
    v_cvt_pk_bf16_f32 v78, v196, v197
    v_exp_f32 v198, v198
    v_exp_f32 v199, v199
    v_add_f32 v10, v10, v198
    v_add_f32 v10, v10, v199
    v_cvt_pk_bf16_f32 v79, v198, v199
    s_mov_b32 s17, 0xe000
    buffer_load_dwordx4 v[200:203], v8, s[8:11], s17 offen offset:0
    buffer_load_dwordx4 v[204:207], v8, s[8:11], s17 offen offset:1024
    buffer_load_dwordx4 v[208:211], v8, s[8:11], s17 offen offset:2048
    buffer_load_dwordx4 v[212:215], v8, s[8:11], s17 offen offset:3072
    s_waitcnt vmcnt(3)
    v_mfma_f32_16x16x32_bf16 v[184:187], v[200:203], v[152:155], v[216:219]
    v_mfma_f32_16x16x32_bf16 v[188:191], v[200:203], v[168:171], v[220:223]
    s_waitcnt vmcnt(2)
    v_mfma_f32_16x16x32_bf16 v[192:195], v[204:207], v[152:155], v[216:219]
    v_mfma_f32_16x16x32_bf16 v[196:199], v[204:207], v[168:171], v[220:223]
    s_waitcnt vmcnt(1)
    v_mfma_f32_16x16x32_bf16 v[184:187], v[208:211], v[156:159], v[184:187]
    v_mfma_f32_16x16x32_bf16 v[188:191], v[208:211], v[172:175], v[188:191]
    s_waitcnt vmcnt(0)
    v_mfma_f32_16x16x32_bf16 v[192:195], v[212:215], v[156:159], v[192:195]
    v_mfma_f32_16x16x32_bf16 v[196:199], v[212:215], v[172:175], v[196:199]
    s_mov_b32 s17, 0xf000
    buffer_load_dwordx4 v[200:203], v8, s[8:11], s17 offen offset:0
    buffer_load_dwordx4 v[204:207], v8, s[8:11], s17 offen offset:1024
    buffer_load_dwordx4 v[208:211], v8, s[8:11], s17 offen offset:2048
    buffer_load_dwordx4 v[212:215], v8, s[8:11], s17 offen offset:3072
    s_waitcnt vmcnt(3)
    v_mfma_f32_16x16x32_bf16 v[184:187], v[200:203], v[160:163], v[184:187]
    v_mfma_f32_16x16x32_bf16 v[188:191], v[200:203], v[176:179], v[188:191]
    s_waitcnt vmcnt(2)
    v_mfma_f32_16x16x32_bf16 v[192:195], v[204:207], v[160:163], v[192:195]
    v_mfma_f32_16x16x32_bf16 v[196:199], v[204:207], v[176:179], v[196:199]
    s_waitcnt vmcnt(1)
    v_mfma_f32_16x16x32_bf16 v[184:187], v[208:211], v[164:167], v[184:187]
    v_mfma_f32_16x16x32_bf16 v[188:191], v[208:211], v[180:183], v[188:191]
    s_waitcnt vmcnt(0)
    v_mfma_f32_16x16x32_bf16 v[192:195], v[212:215], v[164:167], v[192:195]
    v_mfma_f32_16x16x32_bf16 v[196:199], v[212:215], v[180:183], v[196:199]
    s_nop 3
    v_exp_f32 v184, v184
    v_exp_f32 v185, v185
    v_add_f32 v9, v9, v184
    v_add_f32 v9, v9, v185
    v_cvt_pk_bf16_f32 v80, v184, v185
    v_exp_f32 v186, v186
    v_exp_f32 v187, v187
    v_add_f32 v9, v9, v186
    v_add_f32 v9, v9, v187
    v_cvt_pk_bf16_f32 v81, v186, v187
    v_exp_f32 v188, v188
    v_exp_f32 v189, v189
    v_add_f32 v10, v10, v188
    v_add_f32 v10, v10, v189
    v_cvt_pk_bf16_f32 v84, v188, v189
    v_exp_f32 v190, v190
    v_exp_f32 v191, v191
    v_add_f32 v10, v10, v190
    v_add_f32 v10, v10, v191
    v_cvt_pk_bf16_f32 v85, v190, v191
    v_exp_f32 v192, v192
    v_exp_f32 v193, v193
    v_add_f32 v9, v9, v192
    v_add_f32 v9, v9, v193
    v_cvt_pk_bf16_f32 v82, v192, v193
    v_exp_f32 v194, v194
    v_exp_f32 v195, v195
    v_add_f32 v9, v9, v194
    v_add_f32 v9, v9, v195
    v_cvt_pk_bf16_f32 v83, v194, v195
    v_exp_f32 v196, v196
    v_exp_f32 v197, v197
    v_add_f32 v10, v10, v196
    v_add_f32 v10, v10, v197
    v_cvt_pk_bf16_f32 v86, v196, v197
    v_exp_f32 v198, v198
    v_exp_f32 v199, v199
    v_add_f32 v10, v10, v198
    v_add_f32 v10, v10, v199
    v_cvt_pk_bf16_f32 v87, v198, v199
    s_mov_b32 s17, 0x10000
    buffer_load_dwordx4 v[200:203], v8, s[8:11], s17 offen offset:0
    buffer_load_dwordx4 v[204:207], v8, s[8:11], s17 offen offset:1024
    buffer_load_dwordx4 v[208:211], v8, s[8:11], s17 offen offset:2048
    buffer_load_dwordx4 v[212:215], v8, s[8:11], s17 offen offset:3072
    s_waitcnt vmcnt(3)
    v_mfma_f32_16x16x32_bf16 v[184:187], v[200:203], v[152:155], v[216:219]
    v_mfma_f32_16x16x32_bf16 v[188:191], v[200:203], v[168:171], v[220:223]
    s_waitcnt vmcnt(2)
    v_mfma_f32_16x16x32_bf16 v[192:195], v[204:207], v[152:155], v[216:219]
    v_mfma_f32_16x16x32_bf16 v[196:199], v[204:207], v[168:171], v[220:223]
    s_waitcnt vmcnt(1)
    v_mfma_f32_16x16x32_bf16 v[184:187], v[208:211], v[156:159], v[184:187]
    v_mfma_f32_16x16x32_bf16 v[188:191], v[208:211], v[172:175], v[188:191]
    s_waitcnt vmcnt(0)
    v_mfma_f32_16x16x32_bf16 v[192:195], v[212:215], v[156:159], v[192:195]
    v_mfma_f32_16x16x32_bf16 v[196:199], v[212:215], v[172:175], v[196:199]
    s_mov_b32 s17, 0x11000
    buffer_load_dwordx4 v[200:203], v8, s[8:11], s17 offen offset:0
    buffer_load_dwordx4 v[204:207], v8, s[8:11], s17 offen offset:1024
    buffer_load_dwordx4 v[208:211], v8, s[8:11], s17 offen offset:2048
    buffer_load_dwordx4 v[212:215], v8, s[8:11], s17 offen offset:3072
    s_waitcnt vmcnt(3)
    v_mfma_f32_16x16x32_bf16 v[184:187], v[200:203], v[160:163], v[184:187]
    v_mfma_f32_16x16x32_bf16 v[188:191], v[200:203], v[176:179], v[188:191]
    s_waitcnt vmcnt(2)
    v_mfma_f32_16x16x32_bf16 v[192:195], v[204:207], v[160:163], v[192:195]
    v_mfma_f32_16x16x32_bf16 v[196:199], v[204:207], v[176:179], v[196:199]
    s_waitcnt vmcnt(1)
    v_mfma_f32_16x16x32_bf16 v[184:187], v[208:211], v[164:167], v[184:187]
    v_mfma_f32_16x16x32_bf16 v[188:191], v[208:211], v[180:183], v[188:191]
    s_waitcnt vmcnt(0)
    v_mfma_f32_16x16x32_bf16 v[192:195], v[212:215], v[164:167], v[192:195]
    v_mfma_f32_16x16x32_bf16 v[196:199], v[212:215], v[180:183], v[196:199]
    s_nop 3
    v_exp_f32 v184, v184
    v_exp_f32 v185, v185
    v_add_f32 v9, v9, v184
    v_add_f32 v9, v9, v185
    v_cvt_pk_bf16_f32 v88, v184, v185
    v_exp_f32 v186, v186
    v_exp_f32 v187, v187
    v_add_f32 v9, v9, v186
    v_add_f32 v9, v9, v187
    v_cvt_pk_bf16_f32 v89, v186, v187
    v_exp_f32 v188, v188
    v_exp_f32 v189, v189
    v_add_f32 v10, v10, v188
    v_add_f32 v10, v10, v189
    v_cvt_pk_bf16_f32 v92, v188, v189
    v_exp_f32 v190, v190
    v_exp_f32 v191, v191
    v_add_f32 v10, v10, v190
    v_add_f32 v10, v10, v191
    v_cvt_pk_bf16_f32 v93, v190, v191
    v_exp_f32 v192, v192
    v_exp_f32 v193, v193
    v_add_f32 v9, v9, v192
    v_add_f32 v9, v9, v193
    v_cvt_pk_bf16_f32 v90, v192, v193
    v_exp_f32 v194, v194
    v_exp_f32 v195, v195
    v_add_f32 v9, v9, v194
    v_add_f32 v9, v9, v195
    v_cvt_pk_bf16_f32 v91, v194, v195
    v_exp_f32 v196, v196
    v_exp_f32 v197, v197
    v_add_f32 v10, v10, v196
    v_add_f32 v10, v10, v197
    v_cvt_pk_bf16_f32 v94, v196, v197
    v_exp_f32 v198, v198
    v_exp_f32 v199, v199
    v_add_f32 v10, v10, v198
    v_add_f32 v10, v10, v199
    v_cvt_pk_bf16_f32 v95, v198, v199
    s_mov_b32 s17, 0x12000
    buffer_load_dwordx4 v[200:203], v8, s[8:11], s17 offen offset:0
    buffer_load_dwordx4 v[204:207], v8, s[8:11], s17 offen offset:1024
    buffer_load_dwordx4 v[208:211], v8, s[8:11], s17 offen offset:2048
    buffer_load_dwordx4 v[212:215], v8, s[8:11], s17 offen offset:3072
    s_waitcnt vmcnt(3)
    v_mfma_f32_16x16x32_bf16 v[184:187], v[200:203], v[152:155], v[216:219]
    v_mfma_f32_16x16x32_bf16 v[188:191], v[200:203], v[168:171], v[220:223]
    s_waitcnt vmcnt(2)
    v_mfma_f32_16x16x32_bf16 v[192:195], v[204:207], v[152:155], v[216:219]
    v_mfma_f32_16x16x32_bf16 v[196:199], v[204:207], v[168:171], v[220:223]
    s_waitcnt vmcnt(1)
    v_mfma_f32_16x16x32_bf16 v[184:187], v[208:211], v[156:159], v[184:187]
    v_mfma_f32_16x16x32_bf16 v[188:191], v[208:211], v[172:175], v[188:191]
    s_waitcnt vmcnt(0)
    v_mfma_f32_16x16x32_bf16 v[192:195], v[212:215], v[156:159], v[192:195]
    v_mfma_f32_16x16x32_bf16 v[196:199], v[212:215], v[172:175], v[196:199]
    s_mov_b32 s17, 0x13000
    buffer_load_dwordx4 v[200:203], v8, s[8:11], s17 offen offset:0
    buffer_load_dwordx4 v[204:207], v8, s[8:11], s17 offen offset:1024
    buffer_load_dwordx4 v[208:211], v8, s[8:11], s17 offen offset:2048
    buffer_load_dwordx4 v[212:215], v8, s[8:11], s17 offen offset:3072
    s_waitcnt vmcnt(3)
    v_mfma_f32_16x16x32_bf16 v[184:187], v[200:203], v[160:163], v[184:187]
    v_mfma_f32_16x16x32_bf16 v[188:191], v[200:203], v[176:179], v[188:191]
    s_waitcnt vmcnt(2)
    v_mfma_f32_16x16x32_bf16 v[192:195], v[204:207], v[160:163], v[192:195]
    v_mfma_f32_16x16x32_bf16 v[196:199], v[204:207], v[176:179], v[196:199]
    s_waitcnt vmcnt(1)
    v_mfma_f32_16x16x32_bf16 v[184:187], v[208:211], v[164:167], v[184:187]
    v_mfma_f32_16x16x32_bf16 v[188:191], v[208:211], v[180:183], v[188:191]
    s_waitcnt vmcnt(0)
    v_mfma_f32_16x16x32_bf16 v[192:195], v[212:215], v[164:167], v[192:195]
    v_mfma_f32_16x16x32_bf16 v[196:199], v[212:215], v[180:183], v[196:199]
    s_nop 3
    v_exp_f32 v184, v184
    v_exp_f32 v185, v185
    v_add_f32 v9, v9, v184
    v_add_f32 v9, v9, v185
    v_cvt_pk_bf16_f32 v96, v184, v185
    v_exp_f32 v186, v186
    v_exp_f32 v187, v187
    v_add_f32 v9, v9, v186
    v_add_f32 v9, v9, v187
    v_cvt_pk_bf16_f32 v97, v186, v187
    v_exp_f32 v188, v188
    v_exp_f32 v189, v189
    v_add_f32 v10, v10, v188
    v_add_f32 v10, v10, v189
    v_cvt_pk_bf16_f32 v100, v188, v189
    v_exp_f32 v190, v190
    v_exp_f32 v191, v191
    v_add_f32 v10, v10, v190
    v_add_f32 v10, v10, v191
    v_cvt_pk_bf16_f32 v101, v190, v191
    v_exp_f32 v192, v192
    v_exp_f32 v193, v193
    v_add_f32 v9, v9, v192
    v_add_f32 v9, v9, v193
    v_cvt_pk_bf16_f32 v98, v192, v193
    v_exp_f32 v194, v194
    v_exp_f32 v195, v195
    v_add_f32 v9, v9, v194
    v_add_f32 v9, v9, v195
    v_cvt_pk_bf16_f32 v99, v194, v195
    v_exp_f32 v196, v196
    v_exp_f32 v197, v197
    v_add_f32 v10, v10, v196
    v_add_f32 v10, v10, v197
    v_cvt_pk_bf16_f32 v102, v196, v197
    v_exp_f32 v198, v198
    v_exp_f32 v199, v199
    v_add_f32 v10, v10, v198
    v_add_f32 v10, v10, v199
    v_cvt_pk_bf16_f32 v103, v198, v199
    s_mov_b32 s17, 0x14000
    buffer_load_dwordx4 v[200:203], v8, s[8:11], s17 offen offset:0
    buffer_load_dwordx4 v[204:207], v8, s[8:11], s17 offen offset:1024
    buffer_load_dwordx4 v[208:211], v8, s[8:11], s17 offen offset:2048
    buffer_load_dwordx4 v[212:215], v8, s[8:11], s17 offen offset:3072
    s_waitcnt vmcnt(3)
    v_mfma_f32_16x16x32_bf16 v[184:187], v[200:203], v[152:155], v[216:219]
    v_mfma_f32_16x16x32_bf16 v[188:191], v[200:203], v[168:171], v[220:223]
    s_waitcnt vmcnt(2)
    v_mfma_f32_16x16x32_bf16 v[192:195], v[204:207], v[152:155], v[216:219]
    v_mfma_f32_16x16x32_bf16 v[196:199], v[204:207], v[168:171], v[220:223]
    s_waitcnt vmcnt(1)
    v_mfma_f32_16x16x32_bf16 v[184:187], v[208:211], v[156:159], v[184:187]
    v_mfma_f32_16x16x32_bf16 v[188:191], v[208:211], v[172:175], v[188:191]
    s_waitcnt vmcnt(0)
    v_mfma_f32_16x16x32_bf16 v[192:195], v[212:215], v[156:159], v[192:195]
    v_mfma_f32_16x16x32_bf16 v[196:199], v[212:215], v[172:175], v[196:199]
    s_mov_b32 s17, 0x15000
    buffer_load_dwordx4 v[200:203], v8, s[8:11], s17 offen offset:0
    buffer_load_dwordx4 v[204:207], v8, s[8:11], s17 offen offset:1024
    buffer_load_dwordx4 v[208:211], v8, s[8:11], s17 offen offset:2048
    buffer_load_dwordx4 v[212:215], v8, s[8:11], s17 offen offset:3072
    s_waitcnt vmcnt(3)
    v_mfma_f32_16x16x32_bf16 v[184:187], v[200:203], v[160:163], v[184:187]
    v_mfma_f32_16x16x32_bf16 v[188:191], v[200:203], v[176:179], v[188:191]
    s_waitcnt vmcnt(2)
    v_mfma_f32_16x16x32_bf16 v[192:195], v[204:207], v[160:163], v[192:195]
    v_mfma_f32_16x16x32_bf16 v[196:199], v[204:207], v[176:179], v[196:199]
    s_waitcnt vmcnt(1)
    v_mfma_f32_16x16x32_bf16 v[184:187], v[208:211], v[164:167], v[184:187]
    v_mfma_f32_16x16x32_bf16 v[188:191], v[208:211], v[180:183], v[188:191]
    s_waitcnt vmcnt(0)
    v_mfma_f32_16x16x32_bf16 v[192:195], v[212:215], v[164:167], v[192:195]
    v_mfma_f32_16x16x32_bf16 v[196:199], v[212:215], v[180:183], v[196:199]
    s_nop 3
    v_exp_f32 v184, v184
    v_exp_f32 v185, v185
    v_add_f32 v9, v9, v184
    v_add_f32 v9, v9, v185
    v_cvt_pk_bf16_f32 v104, v184, v185
    v_exp_f32 v186, v186
    v_exp_f32 v187, v187
    v_add_f32 v9, v9, v186
    v_add_f32 v9, v9, v187
    v_cvt_pk_bf16_f32 v105, v186, v187
    v_exp_f32 v188, v188
    v_exp_f32 v189, v189
    v_add_f32 v10, v10, v188
    v_add_f32 v10, v10, v189
    v_cvt_pk_bf16_f32 v108, v188, v189
    v_exp_f32 v190, v190
    v_exp_f32 v191, v191
    v_add_f32 v10, v10, v190
    v_add_f32 v10, v10, v191
    v_cvt_pk_bf16_f32 v109, v190, v191
    v_exp_f32 v192, v192
    v_exp_f32 v193, v193
    v_add_f32 v9, v9, v192
    v_add_f32 v9, v9, v193
    v_cvt_pk_bf16_f32 v106, v192, v193
    v_exp_f32 v194, v194
    v_exp_f32 v195, v195
    v_add_f32 v9, v9, v194
    v_add_f32 v9, v9, v195
    v_cvt_pk_bf16_f32 v107, v194, v195
    v_exp_f32 v196, v196
    v_exp_f32 v197, v197
    v_add_f32 v10, v10, v196
    v_add_f32 v10, v10, v197
    v_cvt_pk_bf16_f32 v110, v196, v197
    v_exp_f32 v198, v198
    v_exp_f32 v199, v199
    v_add_f32 v10, v10, v198
    v_add_f32 v10, v10, v199
    v_cvt_pk_bf16_f32 v111, v198, v199
    s_mov_b32 s17, 0x16000
    buffer_load_dwordx4 v[200:203], v8, s[8:11], s17 offen offset:0
    buffer_load_dwordx4 v[204:207], v8, s[8:11], s17 offen offset:1024
    buffer_load_dwordx4 v[208:211], v8, s[8:11], s17 offen offset:2048
    buffer_load_dwordx4 v[212:215], v8, s[8:11], s17 offen offset:3072
    s_waitcnt vmcnt(3)
    v_mfma_f32_16x16x32_bf16 v[184:187], v[200:203], v[152:155], v[216:219]
    v_mfma_f32_16x16x32_bf16 v[188:191], v[200:203], v[168:171], v[220:223]
    s_waitcnt vmcnt(2)
    v_mfma_f32_16x16x32_bf16 v[192:195], v[204:207], v[152:155], v[216:219]
    v_mfma_f32_16x16x32_bf16 v[196:199], v[204:207], v[168:171], v[220:223]
    s_waitcnt vmcnt(1)
    v_mfma_f32_16x16x32_bf16 v[184:187], v[208:211], v[156:159], v[184:187]
    v_mfma_f32_16x16x32_bf16 v[188:191], v[208:211], v[172:175], v[188:191]
    s_waitcnt vmcnt(0)
    v_mfma_f32_16x16x32_bf16 v[192:195], v[212:215], v[156:159], v[192:195]
    v_mfma_f32_16x16x32_bf16 v[196:199], v[212:215], v[172:175], v[196:199]
    s_mov_b32 s17, 0x17000
    buffer_load_dwordx4 v[200:203], v8, s[8:11], s17 offen offset:0
    buffer_load_dwordx4 v[204:207], v8, s[8:11], s17 offen offset:1024
    buffer_load_dwordx4 v[208:211], v8, s[8:11], s17 offen offset:2048
    buffer_load_dwordx4 v[212:215], v8, s[8:11], s17 offen offset:3072
    s_waitcnt vmcnt(3)
    v_mfma_f32_16x16x32_bf16 v[184:187], v[200:203], v[160:163], v[184:187]
    v_mfma_f32_16x16x32_bf16 v[188:191], v[200:203], v[176:179], v[188:191]
    s_waitcnt vmcnt(2)
    v_mfma_f32_16x16x32_bf16 v[192:195], v[204:207], v[160:163], v[192:195]
    v_mfma_f32_16x16x32_bf16 v[196:199], v[204:207], v[176:179], v[196:199]
    s_waitcnt vmcnt(1)
    v_mfma_f32_16x16x32_bf16 v[184:187], v[208:211], v[164:167], v[184:187]
    v_mfma_f32_16x16x32_bf16 v[188:191], v[208:211], v[180:183], v[188:191]
    s_waitcnt vmcnt(0)
    v_mfma_f32_16x16x32_bf16 v[192:195], v[212:215], v[164:167], v[192:195]
    v_mfma_f32_16x16x32_bf16 v[196:199], v[212:215], v[180:183], v[196:199]
    s_nop 3
    v_exp_f32 v184, v184
    v_exp_f32 v185, v185
    v_add_f32 v9, v9, v184
    v_add_f32 v9, v9, v185
    v_cvt_pk_bf16_f32 v112, v184, v185
    v_exp_f32 v186, v186
    v_exp_f32 v187, v187
    v_add_f32 v9, v9, v186
    v_add_f32 v9, v9, v187
    v_cvt_pk_bf16_f32 v113, v186, v187
    v_exp_f32 v188, v188
    v_exp_f32 v189, v189
    v_add_f32 v10, v10, v188
    v_add_f32 v10, v10, v189
    v_cvt_pk_bf16_f32 v116, v188, v189
    v_exp_f32 v190, v190
    v_exp_f32 v191, v191
    v_add_f32 v10, v10, v190
    v_add_f32 v10, v10, v191
    v_cvt_pk_bf16_f32 v117, v190, v191
    v_exp_f32 v192, v192
    v_exp_f32 v193, v193
    v_add_f32 v9, v9, v192
    v_add_f32 v9, v9, v193
    v_cvt_pk_bf16_f32 v114, v192, v193
    v_exp_f32 v194, v194
    v_exp_f32 v195, v195
    v_add_f32 v9, v9, v194
    v_add_f32 v9, v9, v195
    v_cvt_pk_bf16_f32 v115, v194, v195
    v_exp_f32 v196, v196
    v_exp_f32 v197, v197
    v_add_f32 v10, v10, v196
    v_add_f32 v10, v10, v197
    v_cvt_pk_bf16_f32 v118, v196, v197
    v_exp_f32 v198, v198
    v_exp_f32 v199, v199
    v_add_f32 v10, v10, v198
    v_add_f32 v10, v10, v199
    v_cvt_pk_bf16_f32 v119, v198, v199
    s_mov_b32 s17, 0x18000
    buffer_load_dwordx4 v[200:203], v8, s[8:11], s17 offen offset:0
    buffer_load_dwordx4 v[204:207], v8, s[8:11], s17 offen offset:1024
    buffer_load_dwordx4 v[208:211], v8, s[8:11], s17 offen offset:2048
    buffer_load_dwordx4 v[212:215], v8, s[8:11], s17 offen offset:3072
    s_waitcnt vmcnt(3)
    v_mfma_f32_16x16x32_bf16 v[184:187], v[200:203], v[152:155], v[216:219]
    v_mfma_f32_16x16x32_bf16 v[188:191], v[200:203], v[168:171], v[220:223]
    s_waitcnt vmcnt(2)
    v_mfma_f32_16x16x32_bf16 v[192:195], v[204:207], v[152:155], v[216:219]
    v_mfma_f32_16x16x32_bf16 v[196:199], v[204:207], v[168:171], v[220:223]
    s_waitcnt vmcnt(1)
    v_mfma_f32_16x16x32_bf16 v[184:187], v[208:211], v[156:159], v[184:187]
    v_mfma_f32_16x16x32_bf16 v[188:191], v[208:211], v[172:175], v[188:191]
    s_waitcnt vmcnt(0)
    v_mfma_f32_16x16x32_bf16 v[192:195], v[212:215], v[156:159], v[192:195]
    v_mfma_f32_16x16x32_bf16 v[196:199], v[212:215], v[172:175], v[196:199]
    s_mov_b32 s17, 0x19000
    buffer_load_dwordx4 v[200:203], v8, s[8:11], s17 offen offset:0
    buffer_load_dwordx4 v[204:207], v8, s[8:11], s17 offen offset:1024
    buffer_load_dwordx4 v[208:211], v8, s[8:11], s17 offen offset:2048
    buffer_load_dwordx4 v[212:215], v8, s[8:11], s17 offen offset:3072
    s_waitcnt vmcnt(3)
    v_mfma_f32_16x16x32_bf16 v[184:187], v[200:203], v[160:163], v[184:187]
    v_mfma_f32_16x16x32_bf16 v[188:191], v[200:203], v[176:179], v[188:191]
    s_waitcnt vmcnt(2)
    v_mfma_f32_16x16x32_bf16 v[192:195], v[204:207], v[160:163], v[192:195]
    v_mfma_f32_16x16x32_bf16 v[196:199], v[204:207], v[176:179], v[196:199]
    s_waitcnt vmcnt(1)
    v_mfma_f32_16x16x32_bf16 v[184:187], v[208:211], v[164:167], v[184:187]
    v_mfma_f32_16x16x32_bf16 v[188:191], v[208:211], v[180:183], v[188:191]
    s_waitcnt vmcnt(0)
    v_mfma_f32_16x16x32_bf16 v[192:195], v[212:215], v[164:167], v[192:195]
    v_mfma_f32_16x16x32_bf16 v[196:199], v[212:215], v[180:183], v[196:199]
    s_nop 3
    v_exp_f32 v184, v184
    v_exp_f32 v185, v185
    v_add_f32 v9, v9, v184
    v_add_f32 v9, v9, v185
    v_cvt_pk_bf16_f32 v120, v184, v185
    v_exp_f32 v186, v186
    v_exp_f32 v187, v187
    v_add_f32 v9, v9, v186
    v_add_f32 v9, v9, v187
    v_cvt_pk_bf16_f32 v121, v186, v187
    v_exp_f32 v188, v188
    v_exp_f32 v189, v189
    v_add_f32 v10, v10, v188
    v_add_f32 v10, v10, v189
    v_cvt_pk_bf16_f32 v124, v188, v189
    v_exp_f32 v190, v190
    v_exp_f32 v191, v191
    v_add_f32 v10, v10, v190
    v_add_f32 v10, v10, v191
    v_cvt_pk_bf16_f32 v125, v190, v191
    v_exp_f32 v192, v192
    v_exp_f32 v193, v193
    v_add_f32 v9, v9, v192
    v_add_f32 v9, v9, v193
    v_cvt_pk_bf16_f32 v122, v192, v193
    v_exp_f32 v194, v194
    v_exp_f32 v195, v195
    v_add_f32 v9, v9, v194
    v_add_f32 v9, v9, v195
    v_cvt_pk_bf16_f32 v123, v194, v195
    v_exp_f32 v196, v196
    v_exp_f32 v197, v197
    v_add_f32 v10, v10, v196
    v_add_f32 v10, v10, v197
    v_cvt_pk_bf16_f32 v126, v196, v197
    v_exp_f32 v198, v198
    v_exp_f32 v199, v199
    v_add_f32 v10, v10, v198
    v_add_f32 v10, v10, v199
    v_cvt_pk_bf16_f32 v127, v198, v199
    s_mov_b32 s17, 0x1a000
    buffer_load_dwordx4 v[200:203], v8, s[8:11], s17 offen offset:0
    buffer_load_dwordx4 v[204:207], v8, s[8:11], s17 offen offset:1024
    buffer_load_dwordx4 v[208:211], v8, s[8:11], s17 offen offset:2048
    buffer_load_dwordx4 v[212:215], v8, s[8:11], s17 offen offset:3072
    s_waitcnt vmcnt(3)
    v_mfma_f32_16x16x32_bf16 v[184:187], v[200:203], v[152:155], v[216:219]
    v_mfma_f32_16x16x32_bf16 v[188:191], v[200:203], v[168:171], v[220:223]
    s_waitcnt vmcnt(2)
    v_mfma_f32_16x16x32_bf16 v[192:195], v[204:207], v[152:155], v[216:219]
    v_mfma_f32_16x16x32_bf16 v[196:199], v[204:207], v[168:171], v[220:223]
    s_waitcnt vmcnt(1)
    v_mfma_f32_16x16x32_bf16 v[184:187], v[208:211], v[156:159], v[184:187]
    v_mfma_f32_16x16x32_bf16 v[188:191], v[208:211], v[172:175], v[188:191]
    s_waitcnt vmcnt(0)
    v_mfma_f32_16x16x32_bf16 v[192:195], v[212:215], v[156:159], v[192:195]
    v_mfma_f32_16x16x32_bf16 v[196:199], v[212:215], v[172:175], v[196:199]
    s_mov_b32 s17, 0x1b000
    buffer_load_dwordx4 v[200:203], v8, s[8:11], s17 offen offset:0
    buffer_load_dwordx4 v[204:207], v8, s[8:11], s17 offen offset:1024
    buffer_load_dwordx4 v[208:211], v8, s[8:11], s17 offen offset:2048
    buffer_load_dwordx4 v[212:215], v8, s[8:11], s17 offen offset:3072
    s_waitcnt vmcnt(3)
    v_mfma_f32_16x16x32_bf16 v[184:187], v[200:203], v[160:163], v[184:187]
    v_mfma_f32_16x16x32_bf16 v[188:191], v[200:203], v[176:179], v[188:191]
    s_waitcnt vmcnt(2)
    v_mfma_f32_16x16x32_bf16 v[192:195], v[204:207], v[160:163], v[192:195]
    v_mfma_f32_16x16x32_bf16 v[196:199], v[204:207], v[176:179], v[196:199]
    s_waitcnt vmcnt(1)
    v_mfma_f32_16x16x32_bf16 v[184:187], v[208:211], v[164:167], v[184:187]
    v_mfma_f32_16x16x32_bf16 v[188:191], v[208:211], v[180:183], v[188:191]
    s_waitcnt vmcnt(0)
    v_mfma_f32_16x16x32_bf16 v[192:195], v[212:215], v[164:167], v[192:195]
    v_mfma_f32_16x16x32_bf16 v[196:199], v[212:215], v[180:183], v[196:199]
    s_nop 3
    v_exp_f32 v184, v184
    v_exp_f32 v185, v185
    v_add_f32 v9, v9, v184
    v_add_f32 v9, v9, v185
    v_cvt_pk_bf16_f32 v128, v184, v185
    v_exp_f32 v186, v186
    v_exp_f32 v187, v187
    v_add_f32 v9, v9, v186
    v_add_f32 v9, v9, v187
    v_cvt_pk_bf16_f32 v129, v186, v187
    v_exp_f32 v188, v188
    v_exp_f32 v189, v189
    v_add_f32 v10, v10, v188
    v_add_f32 v10, v10, v189
    v_cvt_pk_bf16_f32 v132, v188, v189
    v_exp_f32 v190, v190
    v_exp_f32 v191, v191
    v_add_f32 v10, v10, v190
    v_add_f32 v10, v10, v191
    v_cvt_pk_bf16_f32 v133, v190, v191
    v_exp_f32 v192, v192
    v_exp_f32 v193, v193
    v_add_f32 v9, v9, v192
    v_add_f32 v9, v9, v193
    v_cvt_pk_bf16_f32 v130, v192, v193
    v_exp_f32 v194, v194
    v_exp_f32 v195, v195
    v_add_f32 v9, v9, v194
    v_add_f32 v9, v9, v195
    v_cvt_pk_bf16_f32 v131, v194, v195
    v_exp_f32 v196, v196
    v_exp_f32 v197, v197
    v_add_f32 v10, v10, v196
    v_add_f32 v10, v10, v197
    v_cvt_pk_bf16_f32 v134, v196, v197
    v_exp_f32 v198, v198
    v_exp_f32 v199, v199
    v_add_f32 v10, v10, v198
    v_add_f32 v10, v10, v199
    v_cvt_pk_bf16_f32 v135, v198, v199
    s_mov_b32 s17, 0x1c000
    buffer_load_dwordx4 v[200:203], v8, s[8:11], s17 offen offset:0
    buffer_load_dwordx4 v[204:207], v8, s[8:11], s17 offen offset:1024
    buffer_load_dwordx4 v[208:211], v8, s[8:11], s17 offen offset:2048
    buffer_load_dwordx4 v[212:215], v8, s[8:11], s17 offen offset:3072
    s_waitcnt vmcnt(3)
    v_mfma_f32_16x16x32_bf16 v[184:187], v[200:203], v[152:155], v[216:219]
    v_mfma_f32_16x16x32_bf16 v[188:191], v[200:203], v[168:171], v[220:223]
    s_waitcnt vmcnt(2)
    v_mfma_f32_16x16x32_bf16 v[192:195], v[204:207], v[152:155], v[216:219]
    v_mfma_f32_16x16x32_bf16 v[196:199], v[204:207], v[168:171], v[220:223]
    s_waitcnt vmcnt(1)
    v_mfma_f32_16x16x32_bf16 v[184:187], v[208:211], v[156:159], v[184:187]
    v_mfma_f32_16x16x32_bf16 v[188:191], v[208:211], v[172:175], v[188:191]
    s_waitcnt vmcnt(0)
    v_mfma_f32_16x16x32_bf16 v[192:195], v[212:215], v[156:159], v[192:195]
    v_mfma_f32_16x16x32_bf16 v[196:199], v[212:215], v[172:175], v[196:199]
    s_mov_b32 s17, 0x1d000
    buffer_load_dwordx4 v[200:203], v8, s[8:11], s17 offen offset:0
    buffer_load_dwordx4 v[204:207], v8, s[8:11], s17 offen offset:1024
    buffer_load_dwordx4 v[208:211], v8, s[8:11], s17 offen offset:2048
    buffer_load_dwordx4 v[212:215], v8, s[8:11], s17 offen offset:3072
    s_waitcnt vmcnt(3)
    v_mfma_f32_16x16x32_bf16 v[184:187], v[200:203], v[160:163], v[184:187]
    v_mfma_f32_16x16x32_bf16 v[188:191], v[200:203], v[176:179], v[188:191]
    s_waitcnt vmcnt(2)
    v_mfma_f32_16x16x32_bf16 v[192:195], v[204:207], v[160:163], v[192:195]
    v_mfma_f32_16x16x32_bf16 v[196:199], v[204:207], v[176:179], v[196:199]
    s_waitcnt vmcnt(1)
    v_mfma_f32_16x16x32_bf16 v[184:187], v[208:211], v[164:167], v[184:187]
    v_mfma_f32_16x16x32_bf16 v[188:191], v[208:211], v[180:183], v[188:191]
    s_waitcnt vmcnt(0)
    v_mfma_f32_16x16x32_bf16 v[192:195], v[212:215], v[164:167], v[192:195]
    v_mfma_f32_16x16x32_bf16 v[196:199], v[212:215], v[180:183], v[196:199]
    s_nop 3
    v_exp_f32 v184, v184
    v_exp_f32 v185, v185
    v_add_f32 v9, v9, v184
    v_add_f32 v9, v9, v185
    v_cvt_pk_bf16_f32 v136, v184, v185
    v_exp_f32 v186, v186
    v_exp_f32 v187, v187
    v_add_f32 v9, v9, v186
    v_add_f32 v9, v9, v187
    v_cvt_pk_bf16_f32 v137, v186, v187
    v_exp_f32 v188, v188
    v_exp_f32 v189, v189
    v_add_f32 v10, v10, v188
    v_add_f32 v10, v10, v189
    v_cvt_pk_bf16_f32 v140, v188, v189
    v_exp_f32 v190, v190
    v_exp_f32 v191, v191
    v_add_f32 v10, v10, v190
    v_add_f32 v10, v10, v191
    v_cvt_pk_bf16_f32 v141, v190, v191
    v_exp_f32 v192, v192
    v_exp_f32 v193, v193
    v_add_f32 v9, v9, v192
    v_add_f32 v9, v9, v193
    v_cvt_pk_bf16_f32 v138, v192, v193
    v_exp_f32 v194, v194
    v_exp_f32 v195, v195
    v_add_f32 v9, v9, v194
    v_add_f32 v9, v9, v195
    v_cvt_pk_bf16_f32 v139, v194, v195
    v_exp_f32 v196, v196
    v_exp_f32 v197, v197
    v_add_f32 v10, v10, v196
    v_add_f32 v10, v10, v197
    v_cvt_pk_bf16_f32 v142, v196, v197
    v_exp_f32 v198, v198
    v_exp_f32 v199, v199
    v_add_f32 v10, v10, v198
    v_add_f32 v10, v10, v199
    v_cvt_pk_bf16_f32 v143, v198, v199
    s_mov_b32 s17, 0x1e000
    buffer_load_dwordx4 v[200:203], v8, s[8:11], s17 offen offset:0
    buffer_load_dwordx4 v[204:207], v8, s[8:11], s17 offen offset:1024
    buffer_load_dwordx4 v[208:211], v8, s[8:11], s17 offen offset:2048
    buffer_load_dwordx4 v[212:215], v8, s[8:11], s17 offen offset:3072
    s_waitcnt vmcnt(3)
    v_mfma_f32_16x16x32_bf16 v[184:187], v[200:203], v[152:155], v[216:219]
    v_mfma_f32_16x16x32_bf16 v[188:191], v[200:203], v[168:171], v[220:223]
    s_waitcnt vmcnt(2)
    v_mfma_f32_16x16x32_bf16 v[192:195], v[204:207], v[152:155], v[216:219]
    v_mfma_f32_16x16x32_bf16 v[196:199], v[204:207], v[168:171], v[220:223]
    s_waitcnt vmcnt(1)
    v_mfma_f32_16x16x32_bf16 v[184:187], v[208:211], v[156:159], v[184:187]
    v_mfma_f32_16x16x32_bf16 v[188:191], v[208:211], v[172:175], v[188:191]
    s_waitcnt vmcnt(0)
    v_mfma_f32_16x16x32_bf16 v[192:195], v[212:215], v[156:159], v[192:195]
    v_mfma_f32_16x16x32_bf16 v[196:199], v[212:215], v[172:175], v[196:199]
    s_mov_b32 s17, 0x1f000
    buffer_load_dwordx4 v[200:203], v8, s[8:11], s17 offen offset:0
    buffer_load_dwordx4 v[204:207], v8, s[8:11], s17 offen offset:1024
    buffer_load_dwordx4 v[208:211], v8, s[8:11], s17 offen offset:2048
    buffer_load_dwordx4 v[212:215], v8, s[8:11], s17 offen offset:3072
    s_waitcnt vmcnt(3)
    v_mfma_f32_16x16x32_bf16 v[184:187], v[200:203], v[160:163], v[184:187]
    v_mfma_f32_16x16x32_bf16 v[188:191], v[200:203], v[176:179], v[188:191]
    s_waitcnt vmcnt(2)
    v_mfma_f32_16x16x32_bf16 v[192:195], v[204:207], v[160:163], v[192:195]
    v_mfma_f32_16x16x32_bf16 v[196:199], v[204:207], v[176:179], v[196:199]
    s_waitcnt vmcnt(1)
    v_mfma_f32_16x16x32_bf16 v[184:187], v[208:211], v[164:167], v[184:187]
    v_mfma_f32_16x16x32_bf16 v[188:191], v[208:211], v[180:183], v[188:191]
    s_waitcnt vmcnt(0)
    v_mfma_f32_16x16x32_bf16 v[192:195], v[212:215], v[164:167], v[192:195]
    v_mfma_f32_16x16x32_bf16 v[196:199], v[212:215], v[180:183], v[196:199]
    s_nop 3
    v_exp_f32 v184, v184
    v_exp_f32 v185, v185
    v_add_f32 v9, v9, v184
    v_add_f32 v9, v9, v185
    v_cvt_pk_bf16_f32 v144, v184, v185
    v_exp_f32 v186, v186
    v_exp_f32 v187, v187
    v_add_f32 v9, v9, v186
    v_add_f32 v9, v9, v187
    v_cvt_pk_bf16_f32 v145, v186, v187
    v_exp_f32 v188, v188
    v_exp_f32 v189, v189
    v_add_f32 v10, v10, v188
    v_add_f32 v10, v10, v189
    v_cvt_pk_bf16_f32 v148, v188, v189
    v_exp_f32 v190, v190
    v_exp_f32 v191, v191
    v_add_f32 v10, v10, v190
    v_add_f32 v10, v10, v191
    v_cvt_pk_bf16_f32 v149, v190, v191
    v_exp_f32 v192, v192
    v_exp_f32 v193, v193
    v_add_f32 v9, v9, v192
    v_add_f32 v9, v9, v193
    v_cvt_pk_bf16_f32 v146, v192, v193
    v_exp_f32 v194, v194
    v_exp_f32 v195, v195
    v_add_f32 v9, v9, v194
    v_add_f32 v9, v9, v195
    v_cvt_pk_bf16_f32 v147, v194, v195
    v_exp_f32 v196, v196
    v_exp_f32 v197, v197
    v_add_f32 v10, v10, v196
    v_add_f32 v10, v10, v197
    v_cvt_pk_bf16_f32 v150, v196, v197
    v_exp_f32 v198, v198
    v_exp_f32 v199, v199
    v_add_f32 v10, v10, v198
    v_add_f32 v10, v10, v199
    v_cvt_pk_bf16_f32 v151, v198, v199
    v_mov_b32 v16, v9
    v_mov_b32 v18, v10
    s_nop 0
    v_permlane16_swap_b32 v9, v16
    v_permlane16_swap_b32 v10, v18
    v_add_f32 v9, v9, v16
    v_add_f32 v10, v10, v18
    v_mov_b32 v16, v9
    v_mov_b32 v18, v10
    s_nop 0
    v_permlane32_swap_b32 v9, v16
    v_permlane32_swap_b32 v10, v18
    v_add_f32 v9, v9, v16
    v_add_f32 v10, v10, v18
    s_waitcnt vmcnt(0) lgkmcnt(0)
    s_nop 15
    s_nop 3
    s_branch adaLN_cond__sliding_block_cached__moe_arch_mod__prompt_kernel_fixAb
adaLN_cond__sliding_block_cached__moe_arch_mod__prompt_kernel_mp5r:
    s_waitcnt vmcnt(0) lgkmcnt(0)
    s_nop 15
    s_nop 3
    s_mov_b32 s27, 0
adaLN_cond__sliding_block_cached__moe_arch_mod__prompt_kernel_mp5p:
    buffer_load_dword v248, v250, s[8:11], s14 offen sc1
    s_waitcnt vmcnt(0)
    v_cmp_ne_u32 vcc, s28, v248
    s_add_u32 s27, s27, 1
    s_cmp_ge_u32 s27, 65536
    s_cbranch_scc1 adaLN_cond__sliding_block_cached__moe_arch_mod__prompt_kernel_mp5g
    s_cbranch_vccnz adaLN_cond__sliding_block_cached__moe_arch_mod__prompt_kernel_mp5p
adaLN_cond__sliding_block_cached__moe_arch_mod__prompt_kernel_mp5g:
    s_waitcnt vmcnt(0) lgkmcnt(0)
    s_nop 15
    s_nop 3
    s_branch adaLN_cond__sliding_block_cached__moe_arch_mod__prompt_kernel_mp5b
adaLN_cond__sliding_block_cached__moe_arch_mod__prompt_kernel_o6r:
    s_waitcnt vmcnt(0) lgkmcnt(0)
    s_nop 15
    s_nop 3
    s_mov_b32 s27, 0
adaLN_cond__sliding_block_cached__moe_arch_mod__prompt_kernel_o6p:
    buffer_load_dword v12, v13, s[8:11], s19 offen sc1
    s_waitcnt vmcnt(0)
    v_cmp_ne_u32 vcc, s28, v12
    s_add_u32 s27, s27, 1
    s_cmp_ge_u32 s27, 65536
    s_cbranch_scc1 adaLN_cond__sliding_block_cached__moe_arch_mod__prompt_kernel_o6g
    s_cbranch_vccnz adaLN_cond__sliding_block_cached__moe_arch_mod__prompt_kernel_o6p
adaLN_cond__sliding_block_cached__moe_arch_mod__prompt_kernel_o6g:
    s_waitcnt vmcnt(0) lgkmcnt(0)
    s_nop 15
    s_nop 3
    s_branch adaLN_cond__sliding_block_cached__moe_arch_mod__prompt_kernel_o6b
adaLN_cond__sliding_block_cached__moe_arch_mod__prompt_kernel_o27r:
    s_waitcnt vmcnt(0) lgkmcnt(0)
    s_nop 15
    s_nop 3
    s_mov_b32 s27, 0
adaLN_cond__sliding_block_cached__moe_arch_mod__prompt_kernel_o27p:
    buffer_load_dword v12, v13, s[8:11], s19 offen sc1
    s_waitcnt vmcnt(0)
    v_cmp_ne_u32 vcc, s28, v12
    s_add_u32 s27, s27, 1
    s_cmp_ge_u32 s27, 65536
    s_cbranch_scc1 adaLN_cond__sliding_block_cached__moe_arch_mod__prompt_kernel_o27g
    s_cbranch_vccnz adaLN_cond__sliding_block_cached__moe_arch_mod__prompt_kernel_o27p
adaLN_cond__sliding_block_cached__moe_arch_mod__prompt_kernel_o27g:
    s_waitcnt vmcnt(0) lgkmcnt(0)
    s_nop 15
    s_nop 3
    s_branch adaLN_cond__sliding_block_cached__moe_arch_mod__prompt_kernel_o27b
adaLN_cond__sliding_block_cached__moe_arch_mod__prompt_kernel_o28r:
    s_waitcnt vmcnt(0) lgkmcnt(0)
    s_nop 15
    s_nop 3
    s_mov_b32 s27, 0
adaLN_cond__sliding_block_cached__moe_arch_mod__prompt_kernel_o28p:
    buffer_load_dword v12, v13, s[8:11], s19 offen sc1
    s_waitcnt vmcnt(0)
    v_cmp_ne_u32 vcc, s28, v12
    s_add_u32 s27, s27, 1
    s_cmp_ge_u32 s27, 65536
    s_cbranch_scc1 adaLN_cond__sliding_block_cached__moe_arch_mod__prompt_kernel_o28g
    s_cbranch_vccnz adaLN_cond__sliding_block_cached__moe_arch_mod__prompt_kernel_o28p
adaLN_cond__sliding_block_cached__moe_arch_mod__prompt_kernel_o28g:
    s_waitcnt vmcnt(0) lgkmcnt(0)
    s_nop 15
    s_nop 3
    s_branch adaLN_cond__sliding_block_cached__moe_arch_mod__prompt_kernel_o28b
adaLN_cond__sliding_block_cached__moe_arch_mod__prompt_kernel_o29r:
    s_waitcnt vmcnt(0) lgkmcnt(0)
    s_nop 15
    s_nop 3
    s_mov_b32 s27, 0
adaLN_cond__sliding_block_cached__moe_arch_mod__prompt_kernel_o29p:
    buffer_load_dword v12, v13, s[8:11], s19 offen sc1
    s_waitcnt vmcnt(0)
    v_cmp_ne_u32 vcc, s28, v12
    s_add_u32 s27, s27, 1
    s_cmp_ge_u32 s27, 65536
    s_cbranch_scc1 adaLN_cond__sliding_block_cached__moe_arch_mod__prompt_kernel_o29g
    s_cbranch_vccnz adaLN_cond__sliding_block_cached__moe_arch_mod__prompt_kernel_o29p
adaLN_cond__sliding_block_cached__moe_arch_mod__prompt_kernel_o29g:
    s_waitcnt vmcnt(0) lgkmcnt(0)
    s_nop 15
    s_nop 3
    s_branch adaLN_cond__sliding_block_cached__moe_arch_mod__prompt_kernel_o29b
adaLN_cond__sliding_block_cached__moe_arch_mod__prompt_kernel_mf10r:
    s_waitcnt vmcnt(0) lgkmcnt(0)
    s_nop 15
    s_nop 3
    s_mov_b32 s27, 0
adaLN_cond__sliding_block_cached__moe_arch_mod__prompt_kernel_mf10p:
    s_mov_b32 s16, 0x544000
    buffer_load_dwordx4 v[184:187], v2, s[8:11], s16 offen sc1
    s_waitcnt vmcnt(0)
    v_xor_b32 v16, s28, v184
    v_xor_b32 v17, s28, v185
    v_xor_b32 v18, s28, v186
    v_xor_b32 v19, s28, v187
    v_or3_b32 v16, v16, v17, v18
    v_or_b32 v16, v16, v19
    v_cmp_ne_u32 vcc, 0, v16
    s_add_u32 s27, s27, 1
    s_cmp_ge_u32 s27, 65536
    s_cbranch_scc1 adaLN_cond__sliding_block_cached__moe_arch_mod__prompt_kernel_mf10g
    s_cbranch_vccnz adaLN_cond__sliding_block_cached__moe_arch_mod__prompt_kernel_mf10p
adaLN_cond__sliding_block_cached__moe_arch_mod__prompt_kernel_mf10g:
    s_waitcnt vmcnt(0) lgkmcnt(0)
    s_nop 15
    s_nop 3
    s_branch adaLN_cond__sliding_block_cached__moe_arch_mod__prompt_kernel_mf10b
adaLN_cond__sliding_block_cached__moe_arch_mod__prompt_kernel_kv16r:
    s_waitcnt vmcnt(0) lgkmcnt(0)
    s_nop 15
    s_nop 3
    s_mov_b32 s27, 0
adaLN_cond__sliding_block_cached__moe_arch_mod__prompt_kernel_kv16p:
    buffer_load_dwordx4 v[12:15], v21, s[8:11], s18 offen sc1
    s_waitcnt vmcnt(0)
    v_xor_b32 v8, s28, v12
    v_xor_b32 v20, s28, v13
    v_or_b32 v8, v8, v20
    v_xor_b32 v20, s28, v14
    v_or_b32 v8, v8, v20
    v_xor_b32 v20, s28, v15
    v_or_b32 v8, v8, v20
    v_cmp_ne_u32 vcc, 0, v8
    s_add_u32 s27, s27, 1
    s_cmp_ge_u32 s27, 65536
    s_cbranch_scc1 adaLN_cond__sliding_block_cached__moe_arch_mod__prompt_kernel_kv16g
    s_cbranch_vccnz adaLN_cond__sliding_block_cached__moe_arch_mod__prompt_kernel_kv16p
adaLN_cond__sliding_block_cached__moe_arch_mod__prompt_kernel_kv16g:
    s_waitcnt vmcnt(0) lgkmcnt(0)
    s_nop 15
    s_nop 3
    s_branch adaLN_cond__sliding_block_cached__moe_arch_mod__prompt_kernel_kv16b
adaLN_cond__sliding_block_cached__moe_arch_mod__prompt_kernel_fixB:
    s_waitcnt vmcnt(0) lgkmcnt(0)
    s_nop 15
    s_nop 3
    s_lshr_b32 s16, s12, 3
    s_lshl_b32 s16, s16, 17
    s_add_u32 s16, s16, 0x400000
    v_add_u32 v8, s16, v2
    v_mov_b32 v16, 0xff7fffff
    v_mov_b32 v17, 0xff7fffff
    s_mov_b32 s16, 0
adaLN_cond__sliding_block_cached__moe_arch_mod__prompt_kernel_fixBm:
    s_add_u32 s17, s16, 0
    buffer_load_dwordx4 v[200:203], v8, s[8:11], s17 offen offset:0
    buffer_load_dwordx4 v[204:207], v8, s[8:11], s17 offen offset:1024
    buffer_load_dwordx4 v[208:211], v8, s[8:11], s17 offen offset:2048
    buffer_load_dwordx4 v[212:215], v8, s[8:11], s17 offen offset:3072
    s_waitcnt vmcnt(3)
    v_mfma_f32_16x16x32_bf16 v[184:187], v[200:203], v[152:155], 0
    v_mfma_f32_16x16x32_bf16 v[188:191], v[200:203], v[168:171], 0
    s_waitcnt vmcnt(2)
    v_mfma_f32_16x16x32_bf16 v[192:195], v[204:207], v[152:155], 0
    v_mfma_f32_16x16x32_bf16 v[196:199], v[204:207], v[168:171], 0
    s_waitcnt vmcnt(1)
    v_mfma_f32_16x16x32_bf16 v[184:187], v[208:211], v[156:159], v[184:187]
    v_mfma_f32_16x16x32_bf16 v[188:191], v[208:211], v[172:175], v[188:191]
    s_waitcnt vmcnt(0)
    v_mfma_f32_16x16x32_bf16 v[192:195], v[212:215], v[156:159], v[192:195]
    v_mfma_f32_16x16x32_bf16 v[196:199], v[212:215], v[172:175], v[196:199]
    s_add_u32 s17, s16, 4096
    buffer_load_dwordx4 v[200:203], v8, s[8:11], s17 offen offset:0
    buffer_load_dwordx4 v[204:207], v8, s[8:11], s17 offen offset:1024
    buffer_load_dwordx4 v[208:211], v8, s[8:11], s17 offen offset:2048
    buffer_load_dwordx4 v[212:215], v8, s[8:11], s17 offen offset:3072
    s_waitcnt vmcnt(3)
    v_mfma_f32_16x16x32_bf16 v[184:187], v[200:203], v[160:163], v[184:187]
    v_mfma_f32_16x16x32_bf16 v[188:191], v[200:203], v[176:179], v[188:191]
    s_waitcnt vmcnt(2)
    v_mfma_f32_16x16x32_bf16 v[192:195], v[204:207], v[160:163], v[192:195]
    v_mfma_f32_16x16x32_bf16 v[196:199], v[204:207], v[176:179], v[196:199]
    s_waitcnt vmcnt(1)
    v_mfma_f32_16x16x32_bf16 v[184:187], v[208:211], v[164:167], v[184:187]
    v_mfma_f32_16x16x32_bf16 v[188:191], v[208:211], v[180:183], v[188:191]
    s_waitcnt vmcnt(0)
    v_mfma_f32_16x16x32_bf16 v[192:195], v[212:215], v[164:167], v[192:195]
    v_mfma_f32_16x16x32_bf16 v[196:199], v[212:215], v[180:183], v[196:199]
    s_nop 3
    v_max3_f32 v16, v16, v184, v185
    v_max3_f32 v16, v16, v186, v187
    v_max3_f32 v17, v17, v188, v189
    v_max3_f32 v17, v17, v190, v191
    v_max3_f32 v16, v16, v192, v193
    v_max3_f32 v16, v16, v194, v195
    v_max3_f32 v17, v17, v196, v197
    v_max3_f32 v17, v17, v198, v199
    s_add_u32 s16, s16, 8192
    s_cmp_lt_u32 s16, 0x20000
    s_cbranch_scc1 adaLN_cond__sliding_block_cached__moe_arch_mod__prompt_kernel_fixBm
    v_mov_b32 v18, v16
    v_mov_b32 v19, v17
    s_nop 0
    v_permlane16_swap_b32 v16, v18
    v_permlane16_swap_b32 v17, v19
    v_max_f32 v16, v16, v18
    v_max_f32 v17, v17, v19
    v_mov_b32 v18, v16
    v_mov_b32 v19, v17
    s_nop 0
    v_permlane32_swap_b32 v16, v18
    v_permlane32_swap_b32 v17, v19
    v_max_f32 v16, v16, v18
    v_max_f32 v17, v17, v19
    v_sub_f32 v216, 0, v16
    v_sub_f32 v217, 0, v16
    v_sub_f32 v218, 0, v16
    v_sub_f32 v219, 0, v16
    v_sub_f32 v220, 0, v17
    v_sub_f32 v221, 0, v17
    v_sub_f32 v222, 0, v17
    v_sub_f32 v223, 0, v17
    s_mov_b32 s17, 0x0
    buffer_load_dwordx4 v[200:203], v8, s[8:11], s17 offen offset:0
    buffer_load_dwordx4 v[204:207], v8, s[8:11], s17 offen offset:1024
    buffer_load_dwordx4 v[208:211], v8, s[8:11], s17 offen offset:2048
    buffer_load_dwordx4 v[212:215], v8, s[8:11], s17 offen offset:3072
    s_waitcnt vmcnt(3)
    v_mfma_f32_16x16x32_bf16 v[184:187], v[200:203], v[152:155], v[216:219]
    v_mfma_f32_16x16x32_bf16 v[188:191], v[200:203], v[168:171], v[220:223]
    s_waitcnt vmcnt(2)
    v_mfma_f32_16x16x32_bf16 v[192:195], v[204:207], v[152:155], v[216:219]
    v_mfma_f32_16x16x32_bf16 v[196:199], v[204:207], v[168:171], v[220:223]
    s_waitcnt vmcnt(1)
    v_mfma_f32_16x16x32_bf16 v[184:187], v[208:211], v[156:159], v[184:187]
    v_mfma_f32_16x16x32_bf16 v[188:191], v[208:211], v[172:175], v[188:191]
    s_waitcnt vmcnt(0)
    v_mfma_f32_16x16x32_bf16 v[192:195], v[212:215], v[156:159], v[192:195]
    v_mfma_f32_16x16x32_bf16 v[196:199], v[212:215], v[172:175], v[196:199]
    s_mov_b32 s17, 0x1000
    buffer_load_dwordx4 v[200:203], v8, s[8:11], s17 offen offset:0
    buffer_load_dwordx4 v[204:207], v8, s[8:11], s17 offen offset:1024
    buffer_load_dwordx4 v[208:211], v8, s[8:11], s17 offen offset:2048
    buffer_load_dwordx4 v[212:215], v8, s[8:11], s17 offen offset:3072
    s_waitcnt vmcnt(3)
    v_mfma_f32_16x16x32_bf16 v[184:187], v[200:203], v[160:163], v[184:187]
    v_mfma_f32_16x16x32_bf16 v[188:191], v[200:203], v[176:179], v[188:191]
    s_waitcnt vmcnt(2)
    v_mfma_f32_16x16x32_bf16 v[192:195], v[204:207], v[160:163], v[192:195]
    v_mfma_f32_16x16x32_bf16 v[196:199], v[204:207], v[176:179], v[196:199]
    s_waitcnt vmcnt(1)
    v_mfma_f32_16x16x32_bf16 v[184:187], v[208:211], v[164:167], v[184:187]
    v_mfma_f32_16x16x32_bf16 v[188:191], v[208:211], v[180:183], v[188:191]
    s_waitcnt vmcnt(0)
    v_mfma_f32_16x16x32_bf16 v[192:195], v[212:215], v[164:167], v[192:195]
    v_mfma_f32_16x16x32_bf16 v[196:199], v[212:215], v[180:183], v[196:199]
    s_nop 3
    v_exp_f32 v184, v184
    v_exp_f32 v185, v185
    s_nop 0
    v_add_f32 v9, v184, v185
    v_cvt_pk_bf16_f32 v24, v184, v185
    v_exp_f32 v186, v186
    v_exp_f32 v187, v187
    v_add_f32 v9, v9, v186
    v_add_f32 v9, v9, v187
    v_cvt_pk_bf16_f32 v25, v186, v187
    v_exp_f32 v188, v188
    v_exp_f32 v189, v189
    s_nop 0
    v_add_f32 v10, v188, v189
    v_cvt_pk_bf16_f32 v28, v188, v189
    v_exp_f32 v190, v190
    v_exp_f32 v191, v191
    v_add_f32 v10, v10, v190
    v_add_f32 v10, v10, v191
    v_cvt_pk_bf16_f32 v29, v190, v191
    v_exp_f32 v192, v192
    v_exp_f32 v193, v193
    v_add_f32 v9, v9, v192
    v_add_f32 v9, v9, v193
    v_cvt_pk_bf16_f32 v26, v192, v193
    v_exp_f32 v194, v194
    v_exp_f32 v195, v195
    v_add_f32 v9, v9, v194
    v_add_f32 v9, v9, v195
    v_cvt_pk_bf16_f32 v27, v194, v195
    v_exp_f32 v196, v196
    v_exp_f32 v197, v197
    v_add_f32 v10, v10, v196
    v_add_f32 v10, v10, v197
    v_cvt_pk_bf16_f32 v30, v196, v197
    v_exp_f32 v198, v198
    v_exp_f32 v199, v199
    v_add_f32 v10, v10, v198
    v_add_f32 v10, v10, v199
    v_cvt_pk_bf16_f32 v31, v198, v199
    s_mov_b32 s17, 0x2000
    buffer_load_dwordx4 v[200:203], v8, s[8:11], s17 offen offset:0
    buffer_load_dwordx4 v[204:207], v8, s[8:11], s17 offen offset:1024
    buffer_load_dwordx4 v[208:211], v8, s[8:11], s17 offen offset:2048
    buffer_load_dwordx4 v[212:215], v8, s[8:11], s17 offen offset:3072
    s_waitcnt vmcnt(3)
    v_mfma_f32_16x16x32_bf16 v[184:187], v[200:203], v[152:155], v[216:219]
    v_mfma_f32_16x16x32_bf16 v[188:191], v[200:203], v[168:171], v[220:223]
    s_waitcnt vmcnt(2)
    v_mfma_f32_16x16x32_bf16 v[192:195], v[204:207], v[152:155], v[216:219]
    v_mfma_f32_16x16x32_bf16 v[196:199], v[204:207], v[168:171], v[220:223]
    s_waitcnt vmcnt(1)
    v_mfma_f32_16x16x32_bf16 v[184:187], v[208:211], v[156:159], v[184:187]
    v_mfma_f32_16x16x32_bf16 v[188:191], v[208:211], v[172:175], v[188:191]
    s_waitcnt vmcnt(0)
    v_mfma_f32_16x16x32_bf16 v[192:195], v[212:215], v[156:159], v[192:195]
    v_mfma_f32_16x16x32_bf16 v[196:199], v[212:215], v[172:175], v[196:199]
    s_mov_b32 s17, 0x3000
    buffer_load_dwordx4 v[200:203], v8, s[8:11], s17 offen offset:0
    buffer_load_dwordx4 v[204:207], v8, s[8:11], s17 offen offset:1024
    buffer_load_dwordx4 v[208:211], v8, s[8:11], s17 offen offset:2048
    buffer_load_dwordx4 v[212:215], v8, s[8:11], s17 offen offset:3072
    s_waitcnt vmcnt(3)
    v_mfma_f32_16x16x32_bf16 v[184:187], v[200:203], v[160:163], v[184:187]
    v_mfma_f32_16x16x32_bf16 v[188:191], v[200:203], v[176:179], v[188:191]
    s_waitcnt vmcnt(2)
    v_mfma_f32_16x16x32_bf16 v[192:195], v[204:207], v[160:163], v[192:195]
    v_mfma_f32_16x16x32_bf16 v[196:199], v[204:207], v[176:179], v[196:199]
    s_waitcnt vmcnt(1)
    v_mfma_f32_16x16x32_bf16 v[184:187], v[208:211], v[164:167], v[184:187]
    v_mfma_f32_16x16x32_bf16 v[188:191], v[208:211], v[180:183], v[188:191]
    s_waitcnt vmcnt(0)
    v_mfma_f32_16x16x32_bf16 v[192:195], v[212:215], v[164:167], v[192:195]
    v_mfma_f32_16x16x32_bf16 v[196:199], v[212:215], v[180:183], v[196:199]
    s_nop 3
    v_exp_f32 v184, v184
    v_exp_f32 v185, v185
    v_add_f32 v9, v9, v184
    v_add_f32 v9, v9, v185
    v_cvt_pk_bf16_f32 v32, v184, v185
    v_exp_f32 v186, v186
    v_exp_f32 v187, v187
    v_add_f32 v9, v9, v186
    v_add_f32 v9, v9, v187
    v_cvt_pk_bf16_f32 v33, v186, v187
    v_exp_f32 v188, v188
    v_exp_f32 v189, v189
    v_add_f32 v10, v10, v188
    v_add_f32 v10, v10, v189
    v_cvt_pk_bf16_f32 v36, v188, v189
    v_exp_f32 v190, v190
    v_exp_f32 v191, v191
    v_add_f32 v10, v10, v190
    v_add_f32 v10, v10, v191
    v_cvt_pk_bf16_f32 v37, v190, v191
    v_exp_f32 v192, v192
    v_exp_f32 v193, v193
    v_add_f32 v9, v9, v192
    v_add_f32 v9, v9, v193
    v_cvt_pk_bf16_f32 v34, v192, v193
    v_exp_f32 v194, v194
    v_exp_f32 v195, v195
    v_add_f32 v9, v9, v194
    v_add_f32 v9, v9, v195
    v_cvt_pk_bf16_f32 v35, v194, v195
    v_exp_f32 v196, v196
    v_exp_f32 v197, v197
    v_add_f32 v10, v10, v196
    v_add_f32 v10, v10, v197
    v_cvt_pk_bf16_f32 v38, v196, v197
    v_exp_f32 v198, v198
    v_exp_f32 v199, v199
    v_add_f32 v10, v10, v198
    v_add_f32 v10, v10, v199
    v_cvt_pk_bf16_f32 v39, v198, v199
    s_mov_b32 s17, 0x4000
    buffer_load_dwordx4 v[200:203], v8, s[8:11], s17 offen offset:0
    buffer_load_dwordx4 v[204:207], v8, s[8:11], s17 offen offset:1024
    buffer_load_dwordx4 v[208:211], v8, s[8:11], s17 offen offset:2048
    buffer_load_dwordx4 v[212:215], v8, s[8:11], s17 offen offset:3072
    s_waitcnt vmcnt(3)
    v_mfma_f32_16x16x32_bf16 v[184:187], v[200:203], v[152:155], v[216:219]
    v_mfma_f32_16x16x32_bf16 v[188:191], v[200:203], v[168:171], v[220:223]
    s_waitcnt vmcnt(2)
    v_mfma_f32_16x16x32_bf16 v[192:195], v[204:207], v[152:155], v[216:219]
    v_mfma_f32_16x16x32_bf16 v[196:199], v[204:207], v[168:171], v[220:223]
    s_waitcnt vmcnt(1)
    v_mfma_f32_16x16x32_bf16 v[184:187], v[208:211], v[156:159], v[184:187]
    v_mfma_f32_16x16x32_bf16 v[188:191], v[208:211], v[172:175], v[188:191]
    s_waitcnt vmcnt(0)
    v_mfma_f32_16x16x32_bf16 v[192:195], v[212:215], v[156:159], v[192:195]
    v_mfma_f32_16x16x32_bf16 v[196:199], v[212:215], v[172:175], v[196:199]
    s_mov_b32 s17, 0x5000
    buffer_load_dwordx4 v[200:203], v8, s[8:11], s17 offen offset:0
    buffer_load_dwordx4 v[204:207], v8, s[8:11], s17 offen offset:1024
    buffer_load_dwordx4 v[208:211], v8, s[8:11], s17 offen offset:2048
    buffer_load_dwordx4 v[212:215], v8, s[8:11], s17 offen offset:3072
    s_waitcnt vmcnt(3)
    v_mfma_f32_16x16x32_bf16 v[184:187], v[200:203], v[160:163], v[184:187]
    v_mfma_f32_16x16x32_bf16 v[188:191], v[200:203], v[176:179], v[188:191]
    s_waitcnt vmcnt(2)
    v_mfma_f32_16x16x32_bf16 v[192:195], v[204:207], v[160:163], v[192:195]
    v_mfma_f32_16x16x32_bf16 v[196:199], v[204:207], v[176:179], v[196:199]
    s_waitcnt vmcnt(1)
    v_mfma_f32_16x16x32_bf16 v[184:187], v[208:211], v[164:167], v[184:187]
    v_mfma_f32_16x16x32_bf16 v[188:191], v[208:211], v[180:183], v[188:191]
    s_waitcnt vmcnt(0)
    v_mfma_f32_16x16x32_bf16 v[192:195], v[212:215], v[164:167], v[192:195]
    v_mfma_f32_16x16x32_bf16 v[196:199], v[212:215], v[180:183], v[196:199]
    s_nop 3
    v_exp_f32 v184, v184
    v_exp_f32 v185, v185
    v_add_f32 v9, v9, v184
    v_add_f32 v9, v9, v185
    v_cvt_pk_bf16_f32 v40, v184, v185
    v_exp_f32 v186, v186
    v_exp_f32 v187, v187
    v_add_f32 v9, v9, v186
    v_add_f32 v9, v9, v187
    v_cvt_pk_bf16_f32 v41, v186, v187
    v_exp_f32 v188, v188
    v_exp_f32 v189, v189
    v_add_f32 v10, v10, v188
    v_add_f32 v10, v10, v189
    v_cvt_pk_bf16_f32 v44, v188, v189
    v_exp_f32 v190, v190
    v_exp_f32 v191, v191
    v_add_f32 v10, v10, v190
    v_add_f32 v10, v10, v191
    v_cvt_pk_bf16_f32 v45, v190, v191
    v_exp_f32 v192, v192
    v_exp_f32 v193, v193
    v_add_f32 v9, v9, v192
    v_add_f32 v9, v9, v193
    v_cvt_pk_bf16_f32 v42, v192, v193
    v_exp_f32 v194, v194
    v_exp_f32 v195, v195
    v_add_f32 v9, v9, v194
    v_add_f32 v9, v9, v195
    v_cvt_pk_bf16_f32 v43, v194, v195
    v_exp_f32 v196, v196
    v_exp_f32 v197, v197
    v_add_f32 v10, v10, v196
    v_add_f32 v10, v10, v197
    v_cvt_pk_bf16_f32 v46, v196, v197
    v_exp_f32 v198, v198
    v_exp_f32 v199, v199
    v_add_f32 v10, v10, v198
    v_add_f32 v10, v10, v199
    v_cvt_pk_bf16_f32 v47, v198, v199
    s_mov_b32 s17, 0x6000
    buffer_load_dwordx4 v[200:203], v8, s[8:11], s17 offen offset:0
    buffer_load_dwordx4 v[204:207], v8, s[8:11], s17 offen offset:1024
    buffer_load_dwordx4 v[208:211], v8, s[8:11], s17 offen offset:2048
    buffer_load_dwordx4 v[212:215], v8, s[8:11], s17 offen offset:3072
    s_waitcnt vmcnt(3)
    v_mfma_f32_16x16x32_bf16 v[184:187], v[200:203], v[152:155], v[216:219]
    v_mfma_f32_16x16x32_bf16 v[188:191], v[200:203], v[168:171], v[220:223]
    s_waitcnt vmcnt(2)
    v_mfma_f32_16x16x32_bf16 v[192:195], v[204:207], v[152:155], v[216:219]
    v_mfma_f32_16x16x32_bf16 v[196:199], v[204:207], v[168:171], v[220:223]
    s_waitcnt vmcnt(1)
    v_mfma_f32_16x16x32_bf16 v[184:187], v[208:211], v[156:159], v[184:187]
    v_mfma_f32_16x16x32_bf16 v[188:191], v[208:211], v[172:175], v[188:191]
    s_waitcnt vmcnt(0)
    v_mfma_f32_16x16x32_bf16 v[192:195], v[212:215], v[156:159], v[192:195]
    v_mfma_f32_16x16x32_bf16 v[196:199], v[212:215], v[172:175], v[196:199]
    s_mov_b32 s17, 0x7000
    buffer_load_dwordx4 v[200:203], v8, s[8:11], s17 offen offset:0
    buffer_load_dwordx4 v[204:207], v8, s[8:11], s17 offen offset:1024
    buffer_load_dwordx4 v[208:211], v8, s[8:11], s17 offen offset:2048
    buffer_load_dwordx4 v[212:215], v8, s[8:11], s17 offen offset:3072
    s_waitcnt vmcnt(3)
    v_mfma_f32_16x16x32_bf16 v[184:187], v[200:203], v[160:163], v[184:187]
    v_mfma_f32_16x16x32_bf16 v[188:191], v[200:203], v[176:179], v[188:191]
    s_waitcnt vmcnt(2)
    v_mfma_f32_16x16x32_bf16 v[192:195], v[204:207], v[160:163], v[192:195]
    v_mfma_f32_16x16x32_bf16 v[196:199], v[204:207], v[176:179], v[196:199]
    s_waitcnt vmcnt(1)
    v_mfma_f32_16x16x32_bf16 v[184:187], v[208:211], v[164:167], v[184:187]
    v_mfma_f32_16x16x32_bf16 v[188:191], v[208:211], v[180:183], v[188:191]
    s_waitcnt vmcnt(0)
    v_mfma_f32_16x16x32_bf16 v[192:195], v[212:215], v[164:167], v[192:195]
    v_mfma_f32_16x16x32_bf16 v[196:199], v[212:215], v[180:183], v[196:199]
    s_nop 3
    v_exp_f32 v184, v184
    v_exp_f32 v185, v185
    v_add_f32 v9, v9, v184
    v_add_f32 v9, v9, v185
    v_cvt_pk_bf16_f32 v48, v184, v185
    v_exp_f32 v186, v186
    v_exp_f32 v187, v187
    v_add_f32 v9, v9, v186
    v_add_f32 v9, v9, v187
    v_cvt_pk_bf16_f32 v49, v186, v187
    v_exp_f32 v188, v188
    v_exp_f32 v189, v189
    v_add_f32 v10, v10, v188
    v_add_f32 v10, v10, v189
    v_cvt_pk_bf16_f32 v52, v188, v189
    v_exp_f32 v190, v190
    v_exp_f32 v191, v191
    v_add_f32 v10, v10, v190
    v_add_f32 v10, v10, v191
    v_cvt_pk_bf16_f32 v53, v190, v191
    v_exp_f32 v192, v192
    v_exp_f32 v193, v193
    v_add_f32 v9, v9, v192
    v_add_f32 v9, v9, v193
    v_cvt_pk_bf16_f32 v50, v192, v193
    v_exp_f32 v194, v194
    v_exp_f32 v195, v195
    v_add_f32 v9, v9, v194
    v_add_f32 v9, v9, v195
    v_cvt_pk_bf16_f32 v51, v194, v195
    v_exp_f32 v196, v196
    v_exp_f32 v197, v197
    v_add_f32 v10, v10, v196
    v_add_f32 v10, v10, v197
    v_cvt_pk_bf16_f32 v54, v196, v197
    v_exp_f32 v198, v198
    v_exp_f32 v199, v199
    v_add_f32 v10, v10, v198
    v_add_f32 v10, v10, v199
    v_cvt_pk_bf16_f32 v55, v198, v199
    s_mov_b32 s17, 0x8000
    buffer_load_dwordx4 v[200:203], v8, s[8:11], s17 offen offset:0
    buffer_load_dwordx4 v[204:207], v8, s[8:11], s17 offen offset:1024
    buffer_load_dwordx4 v[208:211], v8, s[8:11], s17 offen offset:2048
    buffer_load_dwordx4 v[212:215], v8, s[8:11], s17 offen offset:3072
    s_waitcnt vmcnt(3)
    v_mfma_f32_16x16x32_bf16 v[184:187], v[200:203], v[152:155], v[216:219]
    v_mfma_f32_16x16x32_bf16 v[188:191], v[200:203], v[168:171], v[220:223]
    s_waitcnt vmcnt(2)
    v_mfma_f32_16x16x32_bf16 v[192:195], v[204:207], v[152:155], v[216:219]
    v_mfma_f32_16x16x32_bf16 v[196:199], v[204:207], v[168:171], v[220:223]
    s_waitcnt vmcnt(1)
    v_mfma_f32_16x16x32_bf16 v[184:187], v[208:211], v[156:159], v[184:187]
    v_mfma_f32_16x16x32_bf16 v[188:191], v[208:211], v[172:175], v[188:191]
    s_waitcnt vmcnt(0)
    v_mfma_f32_16x16x32_bf16 v[192:195], v[212:215], v[156:159], v[192:195]
    v_mfma_f32_16x16x32_bf16 v[196:199], v[212:215], v[172:175], v[196:199]
    s_mov_b32 s17, 0x9000
    buffer_load_dwordx4 v[200:203], v8, s[8:11], s17 offen offset:0
    buffer_load_dwordx4 v[204:207], v8, s[8:11], s17 offen offset:1024
    buffer_load_dwordx4 v[208:211], v8, s[8:11], s17 offen offset:2048
    buffer_load_dwordx4 v[212:215], v8, s[8:11], s17 offen offset:3072
    s_waitcnt vmcnt(3)
    v_mfma_f32_16x16x32_bf16 v[184:187], v[200:203], v[160:163], v[184:187]
    v_mfma_f32_16x16x32_bf16 v[188:191], v[200:203], v[176:179], v[188:191]
    s_waitcnt vmcnt(2)
    v_mfma_f32_16x16x32_bf16 v[192:195], v[204:207], v[160:163], v[192:195]
    v_mfma_f32_16x16x32_bf16 v[196:199], v[204:207], v[176:179], v[196:199]
    s_waitcnt vmcnt(1)
    v_mfma_f32_16x16x32_bf16 v[184:187], v[208:211], v[164:167], v[184:187]
    v_mfma_f32_16x16x32_bf16 v[188:191], v[208:211], v[180:183], v[188:191]
    s_waitcnt vmcnt(0)
    v_mfma_f32_16x16x32_bf16 v[192:195], v[212:215], v[164:167], v[192:195]
    v_mfma_f32_16x16x32_bf16 v[196:199], v[212:215], v[180:183], v[196:199]
    s_nop 3
    v_exp_f32 v184, v184
    v_exp_f32 v185, v185
    v_add_f32 v9, v9, v184
    v_add_f32 v9, v9, v185
    v_cvt_pk_bf16_f32 v56, v184, v185
    v_exp_f32 v186, v186
    v_exp_f32 v187, v187
    v_add_f32 v9, v9, v186
    v_add_f32 v9, v9, v187
    v_cvt_pk_bf16_f32 v57, v186, v187
    v_exp_f32 v188, v188
    v_exp_f32 v189, v189
    v_add_f32 v10, v10, v188
    v_add_f32 v10, v10, v189
    v_cvt_pk_bf16_f32 v60, v188, v189
    v_exp_f32 v190, v190
    v_exp_f32 v191, v191
    v_add_f32 v10, v10, v190
    v_add_f32 v10, v10, v191
    v_cvt_pk_bf16_f32 v61, v190, v191
    v_exp_f32 v192, v192
    v_exp_f32 v193, v193
    v_add_f32 v9, v9, v192
    v_add_f32 v9, v9, v193
    v_cvt_pk_bf16_f32 v58, v192, v193
    v_exp_f32 v194, v194
    v_exp_f32 v195, v195
    v_add_f32 v9, v9, v194
    v_add_f32 v9, v9, v195
    v_cvt_pk_bf16_f32 v59, v194, v195
    v_exp_f32 v196, v196
    v_exp_f32 v197, v197
    v_add_f32 v10, v10, v196
    v_add_f32 v10, v10, v197
    v_cvt_pk_bf16_f32 v62, v196, v197
    v_exp_f32 v198, v198
    v_exp_f32 v199, v199
    v_add_f32 v10, v10, v198
    v_add_f32 v10, v10, v199
    v_cvt_pk_bf16_f32 v63, v198, v199
    s_mov_b32 s17, 0xa000
    buffer_load_dwordx4 v[200:203], v8, s[8:11], s17 offen offset:0
    buffer_load_dwordx4 v[204:207], v8, s[8:11], s17 offen offset:1024
    buffer_load_dwordx4 v[208:211], v8, s[8:11], s17 offen offset:2048
    buffer_load_dwordx4 v[212:215], v8, s[8:11], s17 offen offset:3072
    s_waitcnt vmcnt(3)
    v_mfma_f32_16x16x32_bf16 v[184:187], v[200:203], v[152:155], v[216:219]
    v_mfma_f32_16x16x32_bf16 v[188:191], v[200:203], v[168:171], v[220:223]
    s_waitcnt vmcnt(2)
    v_mfma_f32_16x16x32_bf16 v[192:195], v[204:207], v[152:155], v[216:219]
    v_mfma_f32_16x16x32_bf16 v[196:199], v[204:207], v[168:171], v[220:223]
    s_waitcnt vmcnt(1)
    v_mfma_f32_16x16x32_bf16 v[184:187], v[208:211], v[156:159], v[184:187]
    v_mfma_f32_16x16x32_bf16 v[188:191], v[208:211], v[172:175], v[188:191]
    s_waitcnt vmcnt(0)
    v_mfma_f32_16x16x32_bf16 v[192:195], v[212:215], v[156:159], v[192:195]
    v_mfma_f32_16x16x32_bf16 v[196:199], v[212:215], v[172:175], v[196:199]
    s_mov_b32 s17, 0xb000
    buffer_load_dwordx4 v[200:203], v8, s[8:11], s17 offen offset:0
    buffer_load_dwordx4 v[204:207], v8, s[8:11], s17 offen offset:1024
    buffer_load_dwordx4 v[208:211], v8, s[8:11], s17 offen offset:2048
    buffer_load_dwordx4 v[212:215], v8, s[8:11], s17 offen offset:3072
    s_waitcnt vmcnt(3)
    v_mfma_f32_16x16x32_bf16 v[184:187], v[200:203], v[160:163], v[184:187]
    v_mfma_f32_16x16x32_bf16 v[188:191], v[200:203], v[176:179], v[188:191]
    s_waitcnt vmcnt(2)
    v_mfma_f32_16x16x32_bf16 v[192:195], v[204:207], v[160:163], v[192:195]
    v_mfma_f32_16x16x32_bf16 v[196:199], v[204:207], v[176:179], v[196:199]
    s_waitcnt vmcnt(1)
    v_mfma_f32_16x16x32_bf16 v[184:187], v[208:211], v[164:167], v[184:187]
    v_mfma_f32_16x16x32_bf16 v[188:191], v[208:211], v[180:183], v[188:191]
    s_waitcnt vmcnt(0)
    v_mfma_f32_16x16x32_bf16 v[192:195], v[212:215], v[164:167], v[192:195]
    v_mfma_f32_16x16x32_bf16 v[196:199], v[212:215], v[180:183], v[196:199]
    s_nop 3
    v_exp_f32 v184, v184
    v_exp_f32 v185, v185
    v_add_f32 v9, v9, v184
    v_add_f32 v9, v9, v185
    v_cvt_pk_bf16_f32 v64, v184, v185
    v_exp_f32 v186, v186
    v_exp_f32 v187, v187
    v_add_f32 v9, v9, v186
    v_add_f32 v9, v9, v187
    v_cvt_pk_bf16_f32 v65, v186, v187
    v_exp_f32 v188, v188
    v_exp_f32 v189, v189
    v_add_f32 v10, v10, v188
    v_add_f32 v10, v10, v189
    v_cvt_pk_bf16_f32 v68, v188, v189
    v_exp_f32 v190, v190
    v_exp_f32 v191, v191
    v_add_f32 v10, v10, v190
    v_add_f32 v10, v10, v191
    v_cvt_pk_bf16_f32 v69, v190, v191
    v_exp_f32 v192, v192
    v_exp_f32 v193, v193
    v_add_f32 v9, v9, v192
    v_add_f32 v9, v9, v193
    v_cvt_pk_bf16_f32 v66, v192, v193
    v_exp_f32 v194, v194
    v_exp_f32 v195, v195
    v_add_f32 v9, v9, v194
    v_add_f32 v9, v9, v195
    v_cvt_pk_bf16_f32 v67, v194, v195
    v_exp_f32 v196, v196
    v_exp_f32 v197, v197
    v_add_f32 v10, v10, v196
    v_add_f32 v10, v10, v197
    v_cvt_pk_bf16_f32 v70, v196, v197
    v_exp_f32 v198, v198
    v_exp_f32 v199, v199
    v_add_f32 v10, v10, v198
    v_add_f32 v10, v10, v199
    v_cvt_pk_bf16_f32 v71, v198, v199
    s_mov_b32 s17, 0xc000
    buffer_load_dwordx4 v[200:203], v8, s[8:11], s17 offen offset:0
    buffer_load_dwordx4 v[204:207], v8, s[8:11], s17 offen offset:1024
    buffer_load_dwordx4 v[208:211], v8, s[8:11], s17 offen offset:2048
    buffer_load_dwordx4 v[212:215], v8, s[8:11], s17 offen offset:3072
    s_waitcnt vmcnt(3)
    v_mfma_f32_16x16x32_bf16 v[184:187], v[200:203], v[152:155], v[216:219]
    v_mfma_f32_16x16x32_bf16 v[188:191], v[200:203], v[168:171], v[220:223]
    s_waitcnt vmcnt(2)
    v_mfma_f32_16x16x32_bf16 v[192:195], v[204:207], v[152:155], v[216:219]
    v_mfma_f32_16x16x32_bf16 v[196:199], v[204:207], v[168:171], v[220:223]
    s_waitcnt vmcnt(1)
    v_mfma_f32_16x16x32_bf16 v[184:187], v[208:211], v[156:159], v[184:187]
    v_mfma_f32_16x16x32_bf16 v[188:191], v[208:211], v[172:175], v[188:191]
    s_waitcnt vmcnt(0)
    v_mfma_f32_16x16x32_bf16 v[192:195], v[212:215], v[156:159], v[192:195]
    v_mfma_f32_16x16x32_bf16 v[196:199], v[212:215], v[172:175], v[196:199]
    s_mov_b32 s17, 0xd000
    buffer_load_dwordx4 v[200:203], v8, s[8:11], s17 offen offset:0
    buffer_load_dwordx4 v[204:207], v8, s[8:11], s17 offen offset:1024
    buffer_load_dwordx4 v[208:211], v8, s[8:11], s17 offen offset:2048
    buffer_load_dwordx4 v[212:215], v8, s[8:11], s17 offen offset:3072
    s_waitcnt vmcnt(3)
    v_mfma_f32_16x16x32_bf16 v[184:187], v[200:203], v[160:163], v[184:187]
    v_mfma_f32_16x16x32_bf16 v[188:191], v[200:203], v[176:179], v[188:191]
    s_waitcnt vmcnt(2)
    v_mfma_f32_16x16x32_bf16 v[192:195], v[204:207], v[160:163], v[192:195]
    v_mfma_f32_16x16x32_bf16 v[196:199], v[204:207], v[176:179], v[196:199]
    s_waitcnt vmcnt(1)
    v_mfma_f32_16x16x32_bf16 v[184:187], v[208:211], v[164:167], v[184:187]
    v_mfma_f32_16x16x32_bf16 v[188:191], v[208:211], v[180:183], v[188:191]
    s_waitcnt vmcnt(0)
    v_mfma_f32_16x16x32_bf16 v[192:195], v[212:215], v[164:167], v[192:195]
    v_mfma_f32_16x16x32_bf16 v[196:199], v[212:215], v[180:183], v[196:199]
    s_nop 3
    v_exp_f32 v184, v184
    v_exp_f32 v185, v185
    v_add_f32 v9, v9, v184
    v_add_f32 v9, v9, v185
    v_cvt_pk_bf16_f32 v72, v184, v185
    v_exp_f32 v186, v186
    v_exp_f32 v187, v187
    v_add_f32 v9, v9, v186
    v_add_f32 v9, v9, v187
    v_cvt_pk_bf16_f32 v73, v186, v187
    v_exp_f32 v188, v188
    v_exp_f32 v189, v189
    v_add_f32 v10, v10, v188
    v_add_f32 v10, v10, v189
    v_cvt_pk_bf16_f32 v76, v188, v189
    v_exp_f32 v190, v190
    v_exp_f32 v191, v191
    v_add_f32 v10, v10, v190
    v_add_f32 v10, v10, v191
    v_cvt_pk_bf16_f32 v77, v190, v191
    v_exp_f32 v192, v192
    v_exp_f32 v193, v193
    v_add_f32 v9, v9, v192
    v_add_f32 v9, v9, v193
    v_cvt_pk_bf16_f32 v74, v192, v193
    v_exp_f32 v194, v194
    v_exp_f32 v195, v195
    v_add_f32 v9, v9, v194
    v_add_f32 v9, v9, v195
    v_cvt_pk_bf16_f32 v75, v194, v195
    v_exp_f32 v196, v196
    v_exp_f32 v197, v197
    v_add_f32 v10, v10, v196
    v_add_f32 v10, v10, v197
    v_cvt_pk_bf16_f32 v78, v196, v197
    v_exp_f32 v198, v198
    v_exp_f32 v199, v199
    v_add_f32 v10, v10, v198
    v_add_f32 v10, v10, v199
    v_cvt_pk_bf16_f32 v79, v198, v199
    s_mov_b32 s17, 0xe000
    buffer_load_dwordx4 v[200:203], v8, s[8:11], s17 offen offset:0
    buffer_load_dwordx4 v[204:207], v8, s[8:11], s17 offen offset:1024
    buffer_load_dwordx4 v[208:211], v8, s[8:11], s17 offen offset:2048
    buffer_load_dwordx4 v[212:215], v8, s[8:11], s17 offen offset:3072
    s_waitcnt vmcnt(3)
    v_mfma_f32_16x16x32_bf16 v[184:187], v[200:203], v[152:155], v[216:219]
    v_mfma_f32_16x16x32_bf16 v[188:191], v[200:203], v[168:171], v[220:223]
    s_waitcnt vmcnt(2)
    v_mfma_f32_16x16x32_bf16 v[192:195], v[204:207], v[152:155], v[216:219]
    v_mfma_f32_16x16x32_bf16 v[196:199], v[204:207], v[168:171], v[220:223]
    s_waitcnt vmcnt(1)
    v_mfma_f32_16x16x32_bf16 v[184:187], v[208:211], v[156:159], v[184:187]
    v_mfma_f32_16x16x32_bf16 v[188:191], v[208:211], v[172:175], v[188:191]
    s_waitcnt vmcnt(0)
    v_mfma_f32_16x16x32_bf16 v[192:195], v[212:215], v[156:159], v[192:195]
    v_mfma_f32_16x16x32_bf16 v[196:199], v[212:215], v[172:175], v[196:199]
    s_mov_b32 s17, 0xf000
    buffer_load_dwordx4 v[200:203], v8, s[8:11], s17 offen offset:0
    buffer_load_dwordx4 v[204:207], v8, s[8:11], s17 offen offset:1024
    buffer_load_dwordx4 v[208:211], v8, s[8:11], s17 offen offset:2048
    buffer_load_dwordx4 v[212:215], v8, s[8:11], s17 offen offset:3072
    s_waitcnt vmcnt(3)
    v_mfma_f32_16x16x32_bf16 v[184:187], v[200:203], v[160:163], v[184:187]
    v_mfma_f32_16x16x32_bf16 v[188:191], v[200:203], v[176:179], v[188:191]
    s_waitcnt vmcnt(2)
    v_mfma_f32_16x16x32_bf16 v[192:195], v[204:207], v[160:163], v[192:195]
    v_mfma_f32_16x16x32_bf16 v[196:199], v[204:207], v[176:179], v[196:199]
    s_waitcnt vmcnt(1)
    v_mfma_f32_16x16x32_bf16 v[184:187], v[208:211], v[164:167], v[184:187]
    v_mfma_f32_16x16x32_bf16 v[188:191], v[208:211], v[180:183], v[188:191]
    s_waitcnt vmcnt(0)
    v_mfma_f32_16x16x32_bf16 v[192:195], v[212:215], v[164:167], v[192:195]
    v_mfma_f32_16x16x32_bf16 v[196:199], v[212:215], v[180:183], v[196:199]
    s_nop 3
    v_exp_f32 v184, v184
    v_exp_f32 v185, v185
    v_add_f32 v9, v9, v184
    v_add_f32 v9, v9, v185
    v_cvt_pk_bf16_f32 v80, v184, v185
    v_exp_f32 v186, v186
    v_exp_f32 v187, v187
    v_add_f32 v9, v9, v186
    v_add_f32 v9, v9, v187
    v_cvt_pk_bf16_f32 v81, v186, v187
    v_exp_f32 v188, v188
    v_exp_f32 v189, v189
    v_add_f32 v10, v10, v188
    v_add_f32 v10, v10, v189
    v_cvt_pk_bf16_f32 v84, v188, v189
    v_exp_f32 v190, v190
    v_exp_f32 v191, v191
    v_add_f32 v10, v10, v190
    v_add_f32 v10, v10, v191
    v_cvt_pk_bf16_f32 v85, v190, v191
    v_exp_f32 v192, v192
    v_exp_f32 v193, v193
    v_add_f32 v9, v9, v192
    v_add_f32 v9, v9, v193
    v_cvt_pk_bf16_f32 v82, v192, v193
    v_exp_f32 v194, v194
    v_exp_f32 v195, v195
    v_add_f32 v9, v9, v194
    v_add_f32 v9, v9, v195
    v_cvt_pk_bf16_f32 v83, v194, v195
    v_exp_f32 v196, v196
    v_exp_f32 v197, v197
    v_add_f32 v10, v10, v196
    v_add_f32 v10, v10, v197
    v_cvt_pk_bf16_f32 v86, v196, v197
    v_exp_f32 v198, v198
    v_exp_f32 v199, v199
    v_add_f32 v10, v10, v198
    v_add_f32 v10, v10, v199
    v_cvt_pk_bf16_f32 v87, v198, v199
    s_mov_b32 s17, 0x10000
    buffer_load_dwordx4 v[200:203], v8, s[8:11], s17 offen offset:0
    buffer_load_dwordx4 v[204:207], v8, s[8:11], s17 offen offset:1024
    buffer_load_dwordx4 v[208:211], v8, s[8:11], s17 offen offset:2048
    buffer_load_dwordx4 v[212:215], v8, s[8:11], s17 offen offset:3072
    s_waitcnt vmcnt(3)
    v_mfma_f32_16x16x32_bf16 v[184:187], v[200:203], v[152:155], v[216:219]
    v_mfma_f32_16x16x32_bf16 v[188:191], v[200:203], v[168:171], v[220:223]
    s_waitcnt vmcnt(2)
    v_mfma_f32_16x16x32_bf16 v[192:195], v[204:207], v[152:155], v[216:219]
    v_mfma_f32_16x16x32_bf16 v[196:199], v[204:207], v[168:171], v[220:223]
    s_waitcnt vmcnt(1)
    v_mfma_f32_16x16x32_bf16 v[184:187], v[208:211], v[156:159], v[184:187]
    v_mfma_f32_16x16x32_bf16 v[188:191], v[208:211], v[172:175], v[188:191]
    s_waitcnt vmcnt(0)
    v_mfma_f32_16x16x32_bf16 v[192:195], v[212:215], v[156:159], v[192:195]
    v_mfma_f32_16x16x32_bf16 v[196:199], v[212:215], v[172:175], v[196:199]
    s_mov_b32 s17, 0x11000
    buffer_load_dwordx4 v[200:203], v8, s[8:11], s17 offen offset:0
    buffer_load_dwordx4 v[204:207], v8, s[8:11], s17 offen offset:1024
    buffer_load_dwordx4 v[208:211], v8, s[8:11], s17 offen offset:2048
    buffer_load_dwordx4 v[212:215], v8, s[8:11], s17 offen offset:3072
    s_waitcnt vmcnt(3)
    v_mfma_f32_16x16x32_bf16 v[184:187], v[200:203], v[160:163], v[184:187]
    v_mfma_f32_16x16x32_bf16 v[188:191], v[200:203], v[176:179], v[188:191]
    s_waitcnt vmcnt(2)
    v_mfma_f32_16x16x32_bf16 v[192:195], v[204:207], v[160:163], v[192:195]
    v_mfma_f32_16x16x32_bf16 v[196:199], v[204:207], v[176:179], v[196:199]
    s_waitcnt vmcnt(1)
    v_mfma_f32_16x16x32_bf16 v[184:187], v[208:211], v[164:167], v[184:187]
    v_mfma_f32_16x16x32_bf16 v[188:191], v[208:211], v[180:183], v[188:191]
    s_waitcnt vmcnt(0)
    v_mfma_f32_16x16x32_bf16 v[192:195], v[212:215], v[164:167], v[192:195]
    v_mfma_f32_16x16x32_bf16 v[196:199], v[212:215], v[180:183], v[196:199]
    s_nop 3
    v_exp_f32 v184, v184
    v_exp_f32 v185, v185
    v_add_f32 v9, v9, v184
    v_add_f32 v9, v9, v185
    v_cvt_pk_bf16_f32 v88, v184, v185
    v_exp_f32 v186, v186
    v_exp_f32 v187, v187
    v_add_f32 v9, v9, v186
    v_add_f32 v9, v9, v187
    v_cvt_pk_bf16_f32 v89, v186, v187
    v_exp_f32 v188, v188
    v_exp_f32 v189, v189
    v_add_f32 v10, v10, v188
    v_add_f32 v10, v10, v189
    v_cvt_pk_bf16_f32 v92, v188, v189
    v_exp_f32 v190, v190
    v_exp_f32 v191, v191
    v_add_f32 v10, v10, v190
    v_add_f32 v10, v10, v191
    v_cvt_pk_bf16_f32 v93, v190, v191
    v_exp_f32 v192, v192
    v_exp_f32 v193, v193
    v_add_f32 v9, v9, v192
    v_add_f32 v9, v9, v193
    v_cvt_pk_bf16_f32 v90, v192, v193
    v_exp_f32 v194, v194
    v_exp_f32 v195, v195
    v_add_f32 v9, v9, v194
    v_add_f32 v9, v9, v195
    v_cvt_pk_bf16_f32 v91, v194, v195
    v_exp_f32 v196, v196
    v_exp_f32 v197, v197
    v_add_f32 v10, v10, v196
    v_add_f32 v10, v10, v197
    v_cvt_pk_bf16_f32 v94, v196, v197
    v_exp_f32 v198, v198
    v_exp_f32 v199, v199
    v_add_f32 v10, v10, v198
    v_add_f32 v10, v10, v199
    v_cvt_pk_bf16_f32 v95, v198, v199
    s_mov_b32 s17, 0x12000
    buffer_load_dwordx4 v[200:203], v8, s[8:11], s17 offen offset:0
    buffer_load_dwordx4 v[204:207], v8, s[8:11], s17 offen offset:1024
    buffer_load_dwordx4 v[208:211], v8, s[8:11], s17 offen offset:2048
    buffer_load_dwordx4 v[212:215], v8, s[8:11], s17 offen offset:3072
    s_waitcnt vmcnt(3)
    v_mfma_f32_16x16x32_bf16 v[184:187], v[200:203], v[152:155], v[216:219]
    v_mfma_f32_16x16x32_bf16 v[188:191], v[200:203], v[168:171], v[220:223]
    s_waitcnt vmcnt(2)
    v_mfma_f32_16x16x32_bf16 v[192:195], v[204:207], v[152:155], v[216:219]
    v_mfma_f32_16x16x32_bf16 v[196:199], v[204:207], v[168:171], v[220:223]
    s_waitcnt vmcnt(1)
    v_mfma_f32_16x16x32_bf16 v[184:187], v[208:211], v[156:159], v[184:187]
    v_mfma_f32_16x16x32_bf16 v[188:191], v[208:211], v[172:175], v[188:191]
    s_waitcnt vmcnt(0)
    v_mfma_f32_16x16x32_bf16 v[192:195], v[212:215], v[156:159], v[192:195]
    v_mfma_f32_16x16x32_bf16 v[196:199], v[212:215], v[172:175], v[196:199]
    s_mov_b32 s17, 0x13000
    buffer_load_dwordx4 v[200:203], v8, s[8:11], s17 offen offset:0
    buffer_load_dwordx4 v[204:207], v8, s[8:11], s17 offen offset:1024
    buffer_load_dwordx4 v[208:211], v8, s[8:11], s17 offen offset:2048
    buffer_load_dwordx4 v[212:215], v8, s[8:11], s17 offen offset:3072
    s_waitcnt vmcnt(3)
    v_mfma_f32_16x16x32_bf16 v[184:187], v[200:203], v[160:163], v[184:187]
    v_mfma_f32_16x16x32_bf16 v[188:191], v[200:203], v[176:179], v[188:191]
    s_waitcnt vmcnt(2)
    v_mfma_f32_16x16x32_bf16 v[192:195], v[204:207], v[160:163], v[192:195]
    v_mfma_f32_16x16x32_bf16 v[196:199], v[204:207], v[176:179], v[196:199]
    s_waitcnt vmcnt(1)
    v_mfma_f32_16x16x32_bf16 v[184:187], v[208:211], v[164:167], v[184:187]
    v_mfma_f32_16x16x32_bf16 v[188:191], v[208:211], v[180:183], v[188:191]
    s_waitcnt vmcnt(0)
    v_mfma_f32_16x16x32_bf16 v[192:195], v[212:215], v[164:167], v[192:195]
    v_mfma_f32_16x16x32_bf16 v[196:199], v[212:215], v[180:183], v[196:199]
    s_nop 3
    v_exp_f32 v184, v184
    v_exp_f32 v185, v185
    v_add_f32 v9, v9, v184
    v_add_f32 v9, v9, v185
    v_cvt_pk_bf16_f32 v96, v184, v185
    v_exp_f32 v186, v186
    v_exp_f32 v187, v187
    v_add_f32 v9, v9, v186
    v_add_f32 v9, v9, v187
    v_cvt_pk_bf16_f32 v97, v186, v187
    v_exp_f32 v188, v188
    v_exp_f32 v189, v189
    v_add_f32 v10, v10, v188
    v_add_f32 v10, v10, v189
    v_cvt_pk_bf16_f32 v100, v188, v189
    v_exp_f32 v190, v190
    v_exp_f32 v191, v191
    v_add_f32 v10, v10, v190
    v_add_f32 v10, v10, v191
    v_cvt_pk_bf16_f32 v101, v190, v191
    v_exp_f32 v192, v192
    v_exp_f32 v193, v193
    v_add_f32 v9, v9, v192
    v_add_f32 v9, v9, v193
    v_cvt_pk_bf16_f32 v98, v192, v193
    v_exp_f32 v194, v194
    v_exp_f32 v195, v195
    v_add_f32 v9, v9, v194
    v_add_f32 v9, v9, v195
    v_cvt_pk_bf16_f32 v99, v194, v195
    v_exp_f32 v196, v196
    v_exp_f32 v197, v197
    v_add_f32 v10, v10, v196
    v_add_f32 v10, v10, v197
    v_cvt_pk_bf16_f32 v102, v196, v197
    v_exp_f32 v198, v198
    v_exp_f32 v199, v199
    v_add_f32 v10, v10, v198
    v_add_f32 v10, v10, v199
    v_cvt_pk_bf16_f32 v103, v198, v199
    s_mov_b32 s17, 0x14000
    buffer_load_dwordx4 v[200:203], v8, s[8:11], s17 offen offset:0
    buffer_load_dwordx4 v[204:207], v8, s[8:11], s17 offen offset:1024
    buffer_load_dwordx4 v[208:211], v8, s[8:11], s17 offen offset:2048
    buffer_load_dwordx4 v[212:215], v8, s[8:11], s17 offen offset:3072
    s_waitcnt vmcnt(3)
    v_mfma_f32_16x16x32_bf16 v[184:187], v[200:203], v[152:155], v[216:219]
    v_mfma_f32_16x16x32_bf16 v[188:191], v[200:203], v[168:171], v[220:223]
    s_waitcnt vmcnt(2)
    v_mfma_f32_16x16x32_bf16 v[192:195], v[204:207], v[152:155], v[216:219]
    v_mfma_f32_16x16x32_bf16 v[196:199], v[204:207], v[168:171], v[220:223]
    s_waitcnt vmcnt(1)
    v_mfma_f32_16x16x32_bf16 v[184:187], v[208:211], v[156:159], v[184:187]
    v_mfma_f32_16x16x32_bf16 v[188:191], v[208:211], v[172:175], v[188:191]
    s_waitcnt vmcnt(0)
    v_mfma_f32_16x16x32_bf16 v[192:195], v[212:215], v[156:159], v[192:195]
    v_mfma_f32_16x16x32_bf16 v[196:199], v[212:215], v[172:175], v[196:199]
    s_mov_b32 s17, 0x15000
    buffer_load_dwordx4 v[200:203], v8, s[8:11], s17 offen offset:0
    buffer_load_dwordx4 v[204:207], v8, s[8:11], s17 offen offset:1024
    buffer_load_dwordx4 v[208:211], v8, s[8:11], s17 offen offset:2048
    buffer_load_dwordx4 v[212:215], v8, s[8:11], s17 offen offset:3072
    s_waitcnt vmcnt(3)
    v_mfma_f32_16x16x32_bf16 v[184:187], v[200:203], v[160:163], v[184:187]
    v_mfma_f32_16x16x32_bf16 v[188:191], v[200:203], v[176:179], v[188:191]
    s_waitcnt vmcnt(2)
    v_mfma_f32_16x16x32_bf16 v[192:195], v[204:207], v[160:163], v[192:195]
    v_mfma_f32_16x16x32_bf16 v[196:199], v[204:207], v[176:179], v[196:199]
    s_waitcnt vmcnt(1)
    v_mfma_f32_16x16x32_bf16 v[184:187], v[208:211], v[164:167], v[184:187]
    v_mfma_f32_16x16x32_bf16 v[188:191], v[208:211], v[180:183], v[188:191]
    s_waitcnt vmcnt(0)
    v_mfma_f32_16x16x32_bf16 v[192:195], v[212:215], v[164:167], v[192:195]
    v_mfma_f32_16x16x32_bf16 v[196:199], v[212:215], v[180:183], v[196:199]
    s_nop 3
    v_exp_f32 v184, v184
    v_exp_f32 v185, v185
    v_add_f32 v9, v9, v184
    v_add_f32 v9, v9, v185
    v_cvt_pk_bf16_f32 v104, v184, v185
    v_exp_f32 v186, v186
    v_exp_f32 v187, v187
    v_add_f32 v9, v9, v186
    v_add_f32 v9, v9, v187
    v_cvt_pk_bf16_f32 v105, v186, v187
    v_exp_f32 v188, v188
    v_exp_f32 v189, v189
    v_add_f32 v10, v10, v188
    v_add_f32 v10, v10, v189
    v_cvt_pk_bf16_f32 v108, v188, v189
    v_exp_f32 v190, v190
    v_exp_f32 v191, v191
    v_add_f32 v10, v10, v190
    v_add_f32 v10, v10, v191
    v_cvt_pk_bf16_f32 v109, v190, v191
    v_exp_f32 v192, v192
    v_exp_f32 v193, v193
    v_add_f32 v9, v9, v192
    v_add_f32 v9, v9, v193
    v_cvt_pk_bf16_f32 v106, v192, v193
    v_exp_f32 v194, v194
    v_exp_f32 v195, v195
    v_add_f32 v9, v9, v194
    v_add_f32 v9, v9, v195
    v_cvt_pk_bf16_f32 v107, v194, v195
    v_exp_f32 v196, v196
    v_exp_f32 v197, v197
    v_add_f32 v10, v10, v196
    v_add_f32 v10, v10, v197
    v_cvt_pk_bf16_f32 v110, v196, v197
    v_exp_f32 v198, v198
    v_exp_f32 v199, v199
    v_add_f32 v10, v10, v198
    v_add_f32 v10, v10, v199
    v_cvt_pk_bf16_f32 v111, v198, v199
    s_mov_b32 s17, 0x16000
    buffer_load_dwordx4 v[200:203], v8, s[8:11], s17 offen offset:0
    buffer_load_dwordx4 v[204:207], v8, s[8:11], s17 offen offset:1024
    buffer_load_dwordx4 v[208:211], v8, s[8:11], s17 offen offset:2048
    buffer_load_dwordx4 v[212:215], v8, s[8:11], s17 offen offset:3072
    s_waitcnt vmcnt(3)
    v_mfma_f32_16x16x32_bf16 v[184:187], v[200:203], v[152:155], v[216:219]
    v_mfma_f32_16x16x32_bf16 v[188:191], v[200:203], v[168:171], v[220:223]
    s_waitcnt vmcnt(2)
    v_mfma_f32_16x16x32_bf16 v[192:195], v[204:207], v[152:155], v[216:219]
    v_mfma_f32_16x16x32_bf16 v[196:199], v[204:207], v[168:171], v[220:223]
    s_waitcnt vmcnt(1)
    v_mfma_f32_16x16x32_bf16 v[184:187], v[208:211], v[156:159], v[184:187]
    v_mfma_f32_16x16x32_bf16 v[188:191], v[208:211], v[172:175], v[188:191]
    s_waitcnt vmcnt(0)
    v_mfma_f32_16x16x32_bf16 v[192:195], v[212:215], v[156:159], v[192:195]
    v_mfma_f32_16x16x32_bf16 v[196:199], v[212:215], v[172:175], v[196:199]
    s_mov_b32 s17, 0x17000
    buffer_load_dwordx4 v[200:203], v8, s[8:11], s17 offen offset:0
    buffer_load_dwordx4 v[204:207], v8, s[8:11], s17 offen offset:1024
    buffer_load_dwordx4 v[208:211], v8, s[8:11], s17 offen offset:2048
    buffer_load_dwordx4 v[212:215], v8, s[8:11], s17 offen offset:3072
    s_waitcnt vmcnt(3)
    v_mfma_f32_16x16x32_bf16 v[184:187], v[200:203], v[160:163], v[184:187]
    v_mfma_f32_16x16x32_bf16 v[188:191], v[200:203], v[176:179], v[188:191]
    s_waitcnt vmcnt(2)
    v_mfma_f32_16x16x32_bf16 v[192:195], v[204:207], v[160:163], v[192:195]
    v_mfma_f32_16x16x32_bf16 v[196:199], v[204:207], v[176:179], v[196:199]
    s_waitcnt vmcnt(1)
    v_mfma_f32_16x16x32_bf16 v[184:187], v[208:211], v[164:167], v[184:187]
    v_mfma_f32_16x16x32_bf16 v[188:191], v[208:211], v[180:183], v[188:191]
    s_waitcnt vmcnt(0)
    v_mfma_f32_16x16x32_bf16 v[192:195], v[212:215], v[164:167], v[192:195]
    v_mfma_f32_16x16x32_bf16 v[196:199], v[212:215], v[180:183], v[196:199]
    s_nop 3
    v_exp_f32 v184, v184
    v_exp_f32 v185, v185
    v_add_f32 v9, v9, v184
    v_add_f32 v9, v9, v185
    v_cvt_pk_bf16_f32 v112, v184, v185
    v_exp_f32 v186, v186
    v_exp_f32 v187, v187
    v_add_f32 v9, v9, v186
    v_add_f32 v9, v9, v187
    v_cvt_pk_bf16_f32 v113, v186, v187
    v_exp_f32 v188, v188
    v_exp_f32 v189, v189
    v_add_f32 v10, v10, v188
    v_add_f32 v10, v10, v189
    v_cvt_pk_bf16_f32 v116, v188, v189
    v_exp_f32 v190, v190
    v_exp_f32 v191, v191
    v_add_f32 v10, v10, v190
    v_add_f32 v10, v10, v191
    v_cvt_pk_bf16_f32 v117, v190, v191
    v_exp_f32 v192, v192
    v_exp_f32 v193, v193
    v_add_f32 v9, v9, v192
    v_add_f32 v9, v9, v193
    v_cvt_pk_bf16_f32 v114, v192, v193
    v_exp_f32 v194, v194
    v_exp_f32 v195, v195
    v_add_f32 v9, v9, v194
    v_add_f32 v9, v9, v195
    v_cvt_pk_bf16_f32 v115, v194, v195
    v_exp_f32 v196, v196
    v_exp_f32 v197, v197
    v_add_f32 v10, v10, v196
    v_add_f32 v10, v10, v197
    v_cvt_pk_bf16_f32 v118, v196, v197
    v_exp_f32 v198, v198
    v_exp_f32 v199, v199
    v_add_f32 v10, v10, v198
    v_add_f32 v10, v10, v199
    v_cvt_pk_bf16_f32 v119, v198, v199
    s_mov_b32 s17, 0x18000
    buffer_load_dwordx4 v[200:203], v8, s[8:11], s17 offen offset:0
    buffer_load_dwordx4 v[204:207], v8, s[8:11], s17 offen offset:1024
    buffer_load_dwordx4 v[208:211], v8, s[8:11], s17 offen offset:2048
    buffer_load_dwordx4 v[212:215], v8, s[8:11], s17 offen offset:3072
    s_waitcnt vmcnt(3)
    v_mfma_f32_16x16x32_bf16 v[184:187], v[200:203], v[152:155], v[216:219]
    v_mfma_f32_16x16x32_bf16 v[188:191], v[200:203], v[168:171], v[220:223]
    s_waitcnt vmcnt(2)
    v_mfma_f32_16x16x32_bf16 v[192:195], v[204:207], v[152:155], v[216:219]
    v_mfma_f32_16x16x32_bf16 v[196:199], v[204:207], v[168:171], v[220:223]
    s_waitcnt vmcnt(1)
    v_mfma_f32_16x16x32_bf16 v[184:187], v[208:211], v[156:159], v[184:187]
    v_mfma_f32_16x16x32_bf16 v[188:191], v[208:211], v[172:175], v[188:191]
    s_waitcnt vmcnt(0)
    v_mfma_f32_16x16x32_bf16 v[192:195], v[212:215], v[156:159], v[192:195]
    v_mfma_f32_16x16x32_bf16 v[196:199], v[212:215], v[172:175], v[196:199]
    s_mov_b32 s17, 0x19000
    buffer_load_dwordx4 v[200:203], v8, s[8:11], s17 offen offset:0
    buffer_load_dwordx4 v[204:207], v8, s[8:11], s17 offen offset:1024
    buffer_load_dwordx4 v[208:211], v8, s[8:11], s17 offen offset:2048
    buffer_load_dwordx4 v[212:215], v8, s[8:11], s17 offen offset:3072
    s_waitcnt vmcnt(3)
    v_mfma_f32_16x16x32_bf16 v[184:187], v[200:203], v[160:163], v[184:187]
    v_mfma_f32_16x16x32_bf16 v[188:191], v[200:203], v[176:179], v[188:191]
    s_waitcnt vmcnt(2)
    v_mfma_f32_16x16x32_bf16 v[192:195], v[204:207], v[160:163], v[192:195]
    v_mfma_f32_16x16x32_bf16 v[196:199], v[204:207], v[176:179], v[196:199]
    s_waitcnt vmcnt(1)
    v_mfma_f32_16x16x32_bf16 v[184:187], v[208:211], v[164:167], v[184:187]
    v_mfma_f32_16x16x32_bf16 v[188:191], v[208:211], v[180:183], v[188:191]
    s_waitcnt vmcnt(0)
    v_mfma_f32_16x16x32_bf16 v[192:195], v[212:215], v[164:167], v[192:195]
    v_mfma_f32_16x16x32_bf16 v[196:199], v[212:215], v[180:183], v[196:199]
    s_nop 3
    v_exp_f32 v184, v184
    v_exp_f32 v185, v185
    v_add_f32 v9, v9, v184
    v_add_f32 v9, v9, v185
    v_cvt_pk_bf16_f32 v120, v184, v185
    v_exp_f32 v186, v186
    v_exp_f32 v187, v187
    v_add_f32 v9, v9, v186
    v_add_f32 v9, v9, v187
    v_cvt_pk_bf16_f32 v121, v186, v187
    v_exp_f32 v188, v188
    v_exp_f32 v189, v189
    v_add_f32 v10, v10, v188
    v_add_f32 v10, v10, v189
    v_cvt_pk_bf16_f32 v124, v188, v189
    v_exp_f32 v190, v190
    v_exp_f32 v191, v191
    v_add_f32 v10, v10, v190
    v_add_f32 v10, v10, v191
    v_cvt_pk_bf16_f32 v125, v190, v191
    v_exp_f32 v192, v192
    v_exp_f32 v193, v193
    v_add_f32 v9, v9, v192
    v_add_f32 v9, v9, v193
    v_cvt_pk_bf16_f32 v122, v192, v193
    v_exp_f32 v194, v194
    v_exp_f32 v195, v195
    v_add_f32 v9, v9, v194
    v_add_f32 v9, v9, v195
    v_cvt_pk_bf16_f32 v123, v194, v195
    v_exp_f32 v196, v196
    v_exp_f32 v197, v197
    v_add_f32 v10, v10, v196
    v_add_f32 v10, v10, v197
    v_cvt_pk_bf16_f32 v126, v196, v197
    v_exp_f32 v198, v198
    v_exp_f32 v199, v199
    v_add_f32 v10, v10, v198
    v_add_f32 v10, v10, v199
    v_cvt_pk_bf16_f32 v127, v198, v199
    s_mov_b32 s17, 0x1a000
    buffer_load_dwordx4 v[200:203], v8, s[8:11], s17 offen offset:0
    buffer_load_dwordx4 v[204:207], v8, s[8:11], s17 offen offset:1024
    buffer_load_dwordx4 v[208:211], v8, s[8:11], s17 offen offset:2048
    buffer_load_dwordx4 v[212:215], v8, s[8:11], s17 offen offset:3072
    s_waitcnt vmcnt(3)
    v_mfma_f32_16x16x32_bf16 v[184:187], v[200:203], v[152:155], v[216:219]
    v_mfma_f32_16x16x32_bf16 v[188:191], v[200:203], v[168:171], v[220:223]
    s_waitcnt vmcnt(2)
    v_mfma_f32_16x16x32_bf16 v[192:195], v[204:207], v[152:155], v[216:219]
    v_mfma_f32_16x16x32_bf16 v[196:199], v[204:207], v[168:171], v[220:223]
    s_waitcnt vmcnt(1)
    v_mfma_f32_16x16x32_bf16 v[184:187], v[208:211], v[156:159], v[184:187]
    v_mfma_f32_16x16x32_bf16 v[188:191], v[208:211], v[172:175], v[188:191]
    s_waitcnt vmcnt(0)
    v_mfma_f32_16x16x32_bf16 v[192:195], v[212:215], v[156:159], v[192:195]
    v_mfma_f32_16x16x32_bf16 v[196:199], v[212:215], v[172:175], v[196:199]
    s_mov_b32 s17, 0x1b000
    buffer_load_dwordx4 v[200:203], v8, s[8:11], s17 offen offset:0
    buffer_load_dwordx4 v[204:207], v8, s[8:11], s17 offen offset:1024
    buffer_load_dwordx4 v[208:211], v8, s[8:11], s17 offen offset:2048
    buffer_load_dwordx4 v[212:215], v8, s[8:11], s17 offen offset:3072
    s_waitcnt vmcnt(3)
    v_mfma_f32_16x16x32_bf16 v[184:187], v[200:203], v[160:163], v[184:187]
    v_mfma_f32_16x16x32_bf16 v[188:191], v[200:203], v[176:179], v[188:191]
    s_waitcnt vmcnt(2)
    v_mfma_f32_16x16x32_bf16 v[192:195], v[204:207], v[160:163], v[192:195]
    v_mfma_f32_16x16x32_bf16 v[196:199], v[204:207], v[176:179], v[196:199]
    s_waitcnt vmcnt(1)
    v_mfma_f32_16x16x32_bf16 v[184:187], v[208:211], v[164:167], v[184:187]
    v_mfma_f32_16x16x32_bf16 v[188:191], v[208:211], v[180:183], v[188:191]
    s_waitcnt vmcnt(0)
    v_mfma_f32_16x16x32_bf16 v[192:195], v[212:215], v[164:167], v[192:195]
    v_mfma_f32_16x16x32_bf16 v[196:199], v[212:215], v[180:183], v[196:199]
    s_nop 3
    v_exp_f32 v184, v184
    v_exp_f32 v185, v185
    v_add_f32 v9, v9, v184
    v_add_f32 v9, v9, v185
    v_cvt_pk_bf16_f32 v128, v184, v185
    v_exp_f32 v186, v186
    v_exp_f32 v187, v187
    v_add_f32 v9, v9, v186
    v_add_f32 v9, v9, v187
    v_cvt_pk_bf16_f32 v129, v186, v187
    v_exp_f32 v188, v188
    v_exp_f32 v189, v189
    v_add_f32 v10, v10, v188
    v_add_f32 v10, v10, v189
    v_cvt_pk_bf16_f32 v132, v188, v189
    v_exp_f32 v190, v190
    v_exp_f32 v191, v191
    v_add_f32 v10, v10, v190
    v_add_f32 v10, v10, v191
    v_cvt_pk_bf16_f32 v133, v190, v191
    v_exp_f32 v192, v192
    v_exp_f32 v193, v193
    v_add_f32 v9, v9, v192
    v_add_f32 v9, v9, v193
    v_cvt_pk_bf16_f32 v130, v192, v193
    v_exp_f32 v194, v194
    v_exp_f32 v195, v195
    v_add_f32 v9, v9, v194
    v_add_f32 v9, v9, v195
    v_cvt_pk_bf16_f32 v131, v194, v195
    v_exp_f32 v196, v196
    v_exp_f32 v197, v197
    v_add_f32 v10, v10, v196
    v_add_f32 v10, v10, v197
    v_cvt_pk_bf16_f32 v134, v196, v197
    v_exp_f32 v198, v198
    v_exp_f32 v199, v199
    v_add_f32 v10, v10, v198
    v_add_f32 v10, v10, v199
    v_cvt_pk_bf16_f32 v135, v198, v199
    s_mov_b32 s17, 0x1c000
    buffer_load_dwordx4 v[200:203], v8, s[8:11], s17 offen offset:0
    buffer_load_dwordx4 v[204:207], v8, s[8:11], s17 offen offset:1024
    buffer_load_dwordx4 v[208:211], v8, s[8:11], s17 offen offset:2048
    buffer_load_dwordx4 v[212:215], v8, s[8:11], s17 offen offset:3072
    s_waitcnt vmcnt(3)
    v_mfma_f32_16x16x32_bf16 v[184:187], v[200:203], v[152:155], v[216:219]
    v_mfma_f32_16x16x32_bf16 v[188:191], v[200:203], v[168:171], v[220:223]
    s_waitcnt vmcnt(2)
    v_mfma_f32_16x16x32_bf16 v[192:195], v[204:207], v[152:155], v[216:219]
    v_mfma_f32_16x16x32_bf16 v[196:199], v[204:207], v[168:171], v[220:223]
    s_waitcnt vmcnt(1)
    v_mfma_f32_16x16x32_bf16 v[184:187], v[208:211], v[156:159], v[184:187]
    v_mfma_f32_16x16x32_bf16 v[188:191], v[208:211], v[172:175], v[188:191]
    s_waitcnt vmcnt(0)
    v_mfma_f32_16x16x32_bf16 v[192:195], v[212:215], v[156:159], v[192:195]
    v_mfma_f32_16x16x32_bf16 v[196:199], v[212:215], v[172:175], v[196:199]
    s_mov_b32 s17, 0x1d000
    buffer_load_dwordx4 v[200:203], v8, s[8:11], s17 offen offset:0
    buffer_load_dwordx4 v[204:207], v8, s[8:11], s17 offen offset:1024
    buffer_load_dwordx4 v[208:211], v8, s[8:11], s17 offen offset:2048
    buffer_load_dwordx4 v[212:215], v8, s[8:11], s17 offen offset:3072
    s_waitcnt vmcnt(3)
    v_mfma_f32_16x16x32_bf16 v[184:187], v[200:203], v[160:163], v[184:187]
    v_mfma_f32_16x16x32_bf16 v[188:191], v[200:203], v[176:179], v[188:191]
    s_waitcnt vmcnt(2)
    v_mfma_f32_16x16x32_bf16 v[192:195], v[204:207], v[160:163], v[192:195]
    v_mfma_f32_16x16x32_bf16 v[196:199], v[204:207], v[176:179], v[196:199]
    s_waitcnt vmcnt(1)
    v_mfma_f32_16x16x32_bf16 v[184:187], v[208:211], v[164:167], v[184:187]
    v_mfma_f32_16x16x32_bf16 v[188:191], v[208:211], v[180:183], v[188:191]
    s_waitcnt vmcnt(0)
    v_mfma_f32_16x16x32_bf16 v[192:195], v[212:215], v[164:167], v[192:195]
    v_mfma_f32_16x16x32_bf16 v[196:199], v[212:215], v[180:183], v[196:199]
    s_nop 3
    v_exp_f32 v184, v184
    v_exp_f32 v185, v185
    v_add_f32 v9, v9, v184
    v_add_f32 v9, v9, v185
    v_cvt_pk_bf16_f32 v136, v184, v185
    v_exp_f32 v186, v186
    v_exp_f32 v187, v187
    v_add_f32 v9, v9, v186
    v_add_f32 v9, v9, v187
    v_cvt_pk_bf16_f32 v137, v186, v187
    v_exp_f32 v188, v188
    v_exp_f32 v189, v189
    v_add_f32 v10, v10, v188
    v_add_f32 v10, v10, v189
    v_cvt_pk_bf16_f32 v140, v188, v189
    v_exp_f32 v190, v190
    v_exp_f32 v191, v191
    v_add_f32 v10, v10, v190
    v_add_f32 v10, v10, v191
    v_cvt_pk_bf16_f32 v141, v190, v191
    v_exp_f32 v192, v192
    v_exp_f32 v193, v193
    v_add_f32 v9, v9, v192
    v_add_f32 v9, v9, v193
    v_cvt_pk_bf16_f32 v138, v192, v193
    v_exp_f32 v194, v194
    v_exp_f32 v195, v195
    v_add_f32 v9, v9, v194
    v_add_f32 v9, v9, v195
    v_cvt_pk_bf16_f32 v139, v194, v195
    v_exp_f32 v196, v196
    v_exp_f32 v197, v197
    v_add_f32 v10, v10, v196
    v_add_f32 v10, v10, v197
    v_cvt_pk_bf16_f32 v142, v196, v197
    v_exp_f32 v198, v198
    v_exp_f32 v199, v199
    v_add_f32 v10, v10, v198
    v_add_f32 v10, v10, v199
    v_cvt_pk_bf16_f32 v143, v198, v199
    s_mov_b32 s17, 0x1e000
    buffer_load_dwordx4 v[200:203], v8, s[8:11], s17 offen offset:0
    buffer_load_dwordx4 v[204:207], v8, s[8:11], s17 offen offset:1024
    buffer_load_dwordx4 v[208:211], v8, s[8:11], s17 offen offset:2048
    buffer_load_dwordx4 v[212:215], v8, s[8:11], s17 offen offset:3072
    s_waitcnt vmcnt(3)
    v_mfma_f32_16x16x32_bf16 v[184:187], v[200:203], v[152:155], v[216:219]
    v_mfma_f32_16x16x32_bf16 v[188:191], v[200:203], v[168:171], v[220:223]
    s_waitcnt vmcnt(2)
    v_mfma_f32_16x16x32_bf16 v[192:195], v[204:207], v[152:155], v[216:219]
    v_mfma_f32_16x16x32_bf16 v[196:199], v[204:207], v[168:171], v[220:223]
    s_waitcnt vmcnt(1)
    v_mfma_f32_16x16x32_bf16 v[184:187], v[208:211], v[156:159], v[184:187]
    v_mfma_f32_16x16x32_bf16 v[188:191], v[208:211], v[172:175], v[188:191]
    s_waitcnt vmcnt(0)
    v_mfma_f32_16x16x32_bf16 v[192:195], v[212:215], v[156:159], v[192:195]
    v_mfma_f32_16x16x32_bf16 v[196:199], v[212:215], v[172:175], v[196:199]
    s_mov_b32 s17, 0x1f000
    buffer_load_dwordx4 v[200:203], v8, s[8:11], s17 offen offset:0
    buffer_load_dwordx4 v[204:207], v8, s[8:11], s17 offen offset:1024
    buffer_load_dwordx4 v[208:211], v8, s[8:11], s17 offen offset:2048
    buffer_load_dwordx4 v[212:215], v8, s[8:11], s17 offen offset:3072
    s_waitcnt vmcnt(3)
    v_mfma_f32_16x16x32_bf16 v[184:187], v[200:203], v[160:163], v[184:187]
    v_mfma_f32_16x16x32_bf16 v[188:191], v[200:203], v[176:179], v[188:191]
    s_waitcnt vmcnt(2)
    v_mfma_f32_16x16x32_bf16 v[192:195], v[204:207], v[160:163], v[192:195]
    v_mfma_f32_16x16x32_bf16 v[196:199], v[204:207], v[176:179], v[196:199]
    s_waitcnt vmcnt(1)
    v_mfma_f32_16x16x32_bf16 v[184:187], v[208:211], v[164:167], v[184:187]
    v_mfma_f32_16x16x32_bf16 v[188:191], v[208:211], v[180:183], v[188:191]
    s_waitcnt vmcnt(0)
    v_mfma_f32_16x16x32_bf16 v[192:195], v[212:215], v[164:167], v[192:195]
    v_mfma_f32_16x16x32_bf16 v[196:199], v[212:215], v[180:183], v[196:199]
    s_nop 3
    v_exp_f32 v184, v184
    v_exp_f32 v185, v185
    v_add_f32 v9, v9, v184
    v_add_f32 v9, v9, v185
    v_cvt_pk_bf16_f32 v144, v184, v185
    v_exp_f32 v186, v186
    v_exp_f32 v187, v187
    v_add_f32 v9, v9, v186
    v_add_f32 v9, v9, v187
    v_cvt_pk_bf16_f32 v145, v186, v187
    v_exp_f32 v188, v188
    v_exp_f32 v189, v189
    v_add_f32 v10, v10, v188
    v_add_f32 v10, v10, v189
    v_cvt_pk_bf16_f32 v148, v188, v189
    v_exp_f32 v190, v190
    v_exp_f32 v191, v191
    v_add_f32 v10, v10, v190
    v_add_f32 v10, v10, v191
    v_cvt_pk_bf16_f32 v149, v190, v191
    v_exp_f32 v192, v192
    v_exp_f32 v193, v193
    v_add_f32 v9, v9, v192
    v_add_f32 v9, v9, v193
    v_cvt_pk_bf16_f32 v146, v192, v193
    v_exp_f32 v194, v194
    v_exp_f32 v195, v195
    v_add_f32 v9, v9, v194
    v_add_f32 v9, v9, v195
    v_cvt_pk_bf16_f32 v147, v194, v195
    v_exp_f32 v196, v196
    v_exp_f32 v197, v197
    v_add_f32 v10, v10, v196
    v_add_f32 v10, v10, v197
    v_cvt_pk_bf16_f32 v150, v196, v197
    v_exp_f32 v198, v198
    v_exp_f32 v199, v199
    v_add_f32 v10, v10, v198
    v_add_f32 v10, v10, v199
    v_cvt_pk_bf16_f32 v151, v198, v199
    v_mov_b32 v16, v9
    v_mov_b32 v18, v10
    s_nop 0
    v_permlane16_swap_b32 v9, v16
    v_permlane16_swap_b32 v10, v18
    v_add_f32 v9, v9, v16
    v_add_f32 v10, v10, v18
    v_mov_b32 v16, v9
    v_mov_b32 v18, v10
    s_nop 0
    v_permlane32_swap_b32 v9, v16
    v_permlane32_swap_b32 v10, v18
    v_add_f32 v9, v9, v16
    v_add_f32 v10, v10, v18
    s_waitcnt vmcnt(0) lgkmcnt(0)
    s_nop 15
    s_nop 3
    s_branch adaLN_cond__sliding_block_cached__moe_arch_mod__prompt_kernel_fixBb
adaLN_cond__sliding_block_cached__moe_arch_mod__prompt_kernel_o17r:
    s_waitcnt vmcnt(0) lgkmcnt(0)
    s_nop 15
    s_nop 3
    s_mov_b32 s27, 0
adaLN_cond__sliding_block_cached__moe_arch_mod__prompt_kernel_o17p:
    buffer_load_dword v12, v13, s[8:11], s19 offen sc1
    s_waitcnt vmcnt(0)
    v_cmp_ne_u32 vcc, s28, v12
    s_add_u32 s27, s27, 1
    s_cmp_ge_u32 s27, 65536
    s_cbranch_scc1 adaLN_cond__sliding_block_cached__moe_arch_mod__prompt_kernel_o17g
    s_cbranch_vccnz adaLN_cond__sliding_block_cached__moe_arch_mod__prompt_kernel_o17p
adaLN_cond__sliding_block_cached__moe_arch_mod__prompt_kernel_o17g:
    s_waitcnt vmcnt(0) lgkmcnt(0)
    s_nop 15
    s_nop 3
    s_branch adaLN_cond__sliding_block_cached__moe_arch_mod__prompt_kernel_o17b
adaLN_cond__sliding_block_cached__moe_arch_mod__prompt_kernel_o218r:
    s_waitcnt vmcnt(0) lgkmcnt(0)
    s_nop 15
    s_nop 3
    s_mov_b32 s27, 0
adaLN_cond__sliding_block_cached__moe_arch_mod__prompt_kernel_o218p:
    buffer_load_dword v12, v13, s[8:11], s19 offen sc1
    s_waitcnt vmcnt(0)
    v_cmp_ne_u32 vcc, s28, v12
    s_add_u32 s27, s27, 1
    s_cmp_ge_u32 s27, 65536
    s_cbranch_scc1 adaLN_cond__sliding_block_cached__moe_arch_mod__prompt_kernel_o218g
    s_cbranch_vccnz adaLN_cond__sliding_block_cached__moe_arch_mod__prompt_kernel_o218p
adaLN_cond__sliding_block_cached__moe_arch_mod__prompt_kernel_o218g:
    s_waitcnt vmcnt(0) lgkmcnt(0)
    s_nop 15
    s_nop 3
    s_branch adaLN_cond__sliding_block_cached__moe_arch_mod__prompt_kernel_o218b
adaLN_cond__sliding_block_cached__moe_arch_mod__prompt_kernel_o219r:
    s_waitcnt vmcnt(0) lgkmcnt(0)
    s_nop 15
    s_nop 3
    s_mov_b32 s27, 0
adaLN_cond__sliding_block_cached__moe_arch_mod__prompt_kernel_o219p:
    buffer_load_dword v12, v13, s[8:11], s19 offen sc1
    s_waitcnt vmcnt(0)
    v_cmp_ne_u32 vcc, s28, v12
    s_add_u32 s27, s27, 1
    s_cmp_ge_u32 s27, 65536
    s_cbranch_scc1 adaLN_cond__sliding_block_cached__moe_arch_mod__prompt_kernel_o219g
    s_cbranch_vccnz adaLN_cond__sliding_block_cached__moe_arch_mod__prompt_kernel_o219p
adaLN_cond__sliding_block_cached__moe_arch_mod__prompt_kernel_o219g:
    s_waitcnt vmcnt(0) lgkmcnt(0)
    s_nop 15
    s_nop 3
    s_branch adaLN_cond__sliding_block_cached__moe_arch_mod__prompt_kernel_o219b
adaLN_cond__sliding_block_cached__moe_arch_mod__prompt_kernel_o220r:
    s_waitcnt vmcnt(0) lgkmcnt(0)
    s_nop 15
    s_nop 3
    s_mov_b32 s27, 0
adaLN_cond__sliding_block_cached__moe_arch_mod__prompt_kernel_o220p:
    buffer_load_dword v12, v13, s[8:11], s19 offen sc1
    s_waitcnt vmcnt(0)
    v_cmp_ne_u32 vcc, s28, v12
    s_add_u32 s27, s27, 1
    s_cmp_ge_u32 s27, 65536
    s_cbranch_scc1 adaLN_cond__sliding_block_cached__moe_arch_mod__prompt_kernel_o220g
    s_cbranch_vccnz adaLN_cond__sliding_block_cached__moe_arch_mod__prompt_kernel_o220p
adaLN_cond__sliding_block_cached__moe_arch_mod__prompt_kernel_o220g:
    s_waitcnt vmcnt(0) lgkmcnt(0)
    s_nop 15
    s_nop 3
    s_branch adaLN_cond__sliding_block_cached__moe_arch_mod__prompt_kernel_o220b
adaLN_cond__sliding_block_cached__moe_arch_mod__prompt_kernel_mf21r:
    s_waitcnt vmcnt(0) lgkmcnt(0)
    s_nop 15
    s_nop 3
    s_mov_b32 s27, 0
adaLN_cond__sliding_block_cached__moe_arch_mod__prompt_kernel_mf21p:
    s_mov_b32 s16, 0x544000
    buffer_load_dwordx4 v[184:187], v2, s[8:11], s16 offen sc1
    s_waitcnt vmcnt(0)
    v_xor_b32 v16, s28, v184
    v_xor_b32 v17, s28, v185
    v_xor_b32 v18, s28, v186
    v_xor_b32 v19, s28, v187
    v_or3_b32 v16, v16, v17, v18
    v_or_b32 v16, v16, v19
    v_cmp_ne_u32 vcc, 0, v16
    s_add_u32 s27, s27, 1
    s_cmp_ge_u32 s27, 65536
    s_cbranch_scc1 adaLN_cond__sliding_block_cached__moe_arch_mod__prompt_kernel_mf21g
    s_cbranch_vccnz adaLN_cond__sliding_block_cached__moe_arch_mod__prompt_kernel_mf21p
adaLN_cond__sliding_block_cached__moe_arch_mod__prompt_kernel_mf21g:
    s_waitcnt vmcnt(0) lgkmcnt(0)
    s_nop 15
    s_nop 3
    s_branch adaLN_cond__sliding_block_cached__moe_arch_mod__prompt_kernel_mf21b
adaLN_cond__sliding_block_cached__moe_arch_mod__prompt_kernel_codeend:
    s_endpgm
.section .rodata,"a"
.p2align 6
.amdhsa_kernel adaLN_cond__sliding_block_cached__moe_arch_mod__prompt_kernel
  .amdhsa_next_free_vgpr 256
  .amdhsa_next_free_sgpr 80
  .amdhsa_accum_offset 256
  .amdhsa_group_segment_fixed_size 0
  .amdhsa_kernarg_size 120
  .amdhsa_user_sgpr_count 2
  .amdhsa_user_sgpr_kernarg_segment_ptr 1
  .amdhsa_system_sgpr_workgroup_id_x 1
  .amdhsa_float_denorm_mode_32 3
.end_amdhsa_kernel
```

```asm
; @launch grid=(256,1,1) block=(512,1,1) lds=163840
.amdgcn_target "amdgcn-amd-amdhsa--gfx950"
.text
.globl adaLN_cond__sliding_block_cached__moe_arch_mod__prompt_kernel
.p2align 8
.type adaLN_cond__sliding_block_cached__moe_arch_mod__prompt_kernel,@function
adaLN_cond__sliding_block_cached__moe_arch_mod__prompt_kernel:
    s_cmp_ge_u32 s2, 256
    s_cbranch_scc1 adaLN_cond__sliding_block_cached__moe_arch_mod__prompt_kernel_end
    s_getpc_b64 s[76:77]
adaLN_cond__sliding_block_cached__moe_arch_mod__prompt_kernel_pc0:
    s_sub_u32 s76, s76, adaLN_cond__sliding_block_cached__moe_arch_mod__prompt_kernel_pc0-adaLN_cond__sliding_block_cached__moe_arch_mod__prompt_kernel
    s_subb_u32 s77, s77, 0
    v_and_b32 v16, 63, v0
    v_lshlrev_b32 v16, 7, v16
    v_lshrrev_b32 v17, 6, v0
    s_lshr_b32 s62, s2, 3
    s_lshl_b32 s62, s62, 13
    v_lshlrev_b32 v18, 13, v17
    v_mov_b32 v19, s62
    v_cmp_eq_u32 vcc, 7, v17
    s_nop 1
    v_cndmask_b32 v18, v18, v19, vcc
    v_add_u32 v16, v16, v18
    v_min_u32 v16, adaLN_cond__sliding_block_cached__moe_arch_mod__prompt_kernel_codeend-adaLN_cond__sliding_block_cached__moe_arch_mod__prompt_kernel-4, v16
    v_mov_b32 v25, s77
    v_add_co_u32 v24, vcc, s76, v16
    s_nop 1
    v_addc_co_u32 v25, vcc, 0, v25, vcc
    v_cmp_gt_u32 vcc, 2, v17
    v_cmp_eq_u32 s[62:63], 7, v17
    s_or_b64 vcc, vcc, s[62:63]
    s_and_saveexec_b64 s[62:63], vcc
    s_cbranch_execz adaLN_cond__sliding_block_cached__moe_arch_mod__prompt_kernel_nocp0
    global_load_dword v26, v[24:25], off
adaLN_cond__sliding_block_cached__moe_arch_mod__prompt_kernel_nocp0:
    s_mov_b64 exec, s[62:63]
    s_load_dwordx4 s[56:59], s[0:1], 96
    s_load_dwordx2 s[60:61], s[0:1], 112
    s_load_dwordx8 s[48:55], s[0:1], 64
    s_load_dwordx16 s[32:47], s[0:1], 0
    s_memrealtime s[62:63]
    v_lshrrev_b32 v16, 6, v0
    v_and_b32 v1, 63, v0
    v_readfirstlane_b32 s3, v16
    v_lshlrev_b32 v2, 4, v1
    s_and_b32 s12, s2, 3
    s_lshl_b32 s12, s12, 3
    s_bfe_u32 s13, s2, 0x30003
    s_add_u32 s12, s12, s13
    s_bfe_u32 s13, s2, 0x10002
    s_lshl_b32 s13, s13, 2
    s_lshr_b32 s14, s2, 6
    s_add_u32 s13, s13, s14
    v_bfe_u32 v16, v1, 2, 2
    v_lshrrev_b32 v17, 4, v1
    v_and_b32 v18, 3, v1
    v_lshlrev_b32 v19, 6, v17
    v_lshl_add_u32 v19, v18, 4, v19
    v_lshl_add_u32 v3, v16, 13, v19
    s_and_b32 s14, s3, 1
    s_lshl_b32 s14, s14, 5
    v_xor_b32 v3, s14, v3
    v_lshlrev_b32 v4, 11, v17
    v_lshl_add_u32 v4, v16, 6, v4
    v_lshl_add_u32 v4, v18, 3, v4
    v_and_b32 v20, 1, v17
    v_lshlrev_b32 v20, 5, v20
    v_sub_u32 v5, v4, v20
    v_add_u32 v4, v4, v20
    s_lshl_b32 s14, s13, 3
    s_add_u32 s14, s14, s3
    s_lshl_b32 s14, s14, 16
    v_add_u32 v7, s14, v2
    s_cmp_ge_u32 s3, 4
    s_cbranch_scc1 adaLN_cond__sliding_block_cached__moe_arch_mod__prompt_kernel_roleB
    v_mov_b32 v132, 0
    v_mov_b32 v133, 0
    v_lshrrev_b32 v16, 3, v0
    v_and_b32 v17, 7, v0
    v_mul_u32_u24 v135, 24576, v16
    v_lshl_add_u32 v135, v17, 4, v135
    v_lshlrev_b32 v136, 2, v16
    s_and_b32 s14, s2, 31
    s_lshr_b32 s15, s2, 5
    s_mul_i32 s26, s15, 1572864
    s_lshl_b32 s16, s14, 7
    s_add_u32 s26, s26, s16
    s_lshl_b32 s29, s15, 8
    v_lshlrev_b32 v137, 3, v0
    s_lshl_b32 s18, s2, 3
    s_add_u32 s18, s18, s3
    s_lshl_b32 s18, s18, 11
    v_and_b32 v18, 15, v1
    v_lshrrev_b32 v19, 4, v1
    v_lshlrev_b32 v138, 11, v18
    v_lshl_add_u32 v138, v19, 4, v138
    s_lshr_b32 s30, s2, 4
    s_and_b32 s31, s2, 15
    s_lshl_b32 s19, s30, 3
    s_add_u32 s19, s19, s3
    s_lshl_b32 s22, s19, 15
    s_lshl_b32 s23, s31, 7
    s_add_u32 s22, s22, s23
    s_lshl_b32 s23, s2, 12
    s_add_u32 s23, s23, 0x600000
    s_or_b32 s25, s2, s3
    s_cmp_eq_u32 s25, 0
    s_cselect_b32 s25, 0, 0x7ffffff0
    s_waitcnt lgkmcnt(0)
    s_mov_b64 s[64:65], s[58:59]
    s_mov_b32 s66, 0x100
    s_mov_b32 s67, 0x20000
    s_or_b32 s28, s62, 1
    v_mov_b32 v134, s28
    s_mov_b64 exec, 1
    buffer_store_dword v134, v132, s[64:67], s25 offen sc1
    s_mov_b64 exec, -1
    s_mov_b64 s[68:69], s[52:53]
    s_mov_b32 s70, 0x800
    s_mov_b32 s71, 0x20000
    s_mov_b64 s[72:73], s[54:55]
    s_mov_b32 s74, 0xc00000
    s_mov_b32 s75, 0x20000
    s_mov_b64 s[76:77], s[32:33]
    s_mov_b32 s78, 0x400000
    s_mov_b32 s79, 0x20000
    s_mov_b64 s[8:9], s[60:61]
    s_mov_b32 s10, 0x3400000
    s_mov_b32 s11, 0x20000
    buffer_load_dwordx4 v[32:35], v2, s[76:79], s18 offen offset:0
    buffer_load_dwordx4 v[36:39], v2, s[76:79], s18 offen offset:1024
    buffer_load_dword v72, v136, s[68:71], s29 offen
    buffer_load_dwordx4 v[24:27], v135, s[72:75], s26 offen
    s_add_u32 s26, s26, 12288
    buffer_load_dwordx4 v[28:31], v135, s[72:75], s26 offen
    s_cmp_eq_u32 s3, 0
    s_cselect_b32 s25, 0, 0x7ffffff0
    buffer_load_dword v134, v132, s[64:67], s25 offen sc1
    buffer_store_dwordx2 v[132:133], v137, s[8:11], s23 offen sc1
    s_barrier
    buffer_load_dwordx4 v[40:43], v138, s[76:79], s22 offen offset:0
    buffer_load_dwordx4 v[44:47], v138, s[76:79], s22 offen offset:64
    s_mov_b32 s29, s19
    s_waitcnt vmcnt(8)
    v_lshlrev_b32 v56, 16, v32
    v_and_b32 v57, 0xffff0000, v32
    v_lshlrev_b32 v58, 16, v33
    v_and_b32 v59, 0xffff0000, v33
    v_lshlrev_b32 v60, 16, v34
    v_and_b32 v61, 0xffff0000, v34
    v_lshlrev_b32 v62, 16, v35
    v_and_b32 v63, 0xffff0000, v35
    s_waitcnt vmcnt(7)
    v_lshlrev_b32 v64, 16, v36
    v_and_b32 v65, 0xffff0000, v36
    v_lshlrev_b32 v66, 16, v37
    v_and_b32 v67, 0xffff0000, v37
    v_lshlrev_b32 v68, 16, v38
    v_and_b32 v69, 0xffff0000, v38
    v_lshlrev_b32 v70, 16, v39
    v_and_b32 v71, 0xffff0000, v39
    v_add_f32 v20, v56, v57
    v_add_f32 v21, v58, v59
    v_add_f32 v20, v20, v60
    v_add_f32 v21, v21, v61
    v_add_f32 v20, v20, v62
    v_add_f32 v21, v21, v63
    v_add_f32 v20, v20, v64
    v_add_f32 v21, v21, v65
    v_add_f32 v20, v20, v66
    v_add_f32 v21, v21, v67
    v_add_f32 v20, v20, v68
    v_add_f32 v21, v21, v69
    v_add_f32 v20, v20, v70
    v_add_f32 v21, v21, v71
    v_add_f32 v128, v20, v21
    s_nop 1
    v_add_f32_dpp v128, v128, v128 row_ror:1 row_mask:0xf bank_mask:0xf
    s_nop 1
    v_add_f32_dpp v128, v128, v128 row_ror:2 row_mask:0xf bank_mask:0xf
    s_nop 1
    v_add_f32_dpp v128, v128, v128 row_ror:4 row_mask:0xf bank_mask:0xf
    s_nop 1
    v_add_f32_dpp v128, v128, v128 row_ror:8 row_mask:0xf bank_mask:0xf
    v_mov_b32 v20, v128
    s_nop 1
    v_permlane16_swap_b32 v128, v20
    v_add_f32 v128, v128, v20
    v_mov_b32 v20, v128
    s_nop 1
    v_permlane32_swap_b32 v128, v20
    v_add_f32 v128, v128, v20
    v_mul_f32 v128, 0x3a800000, v128
    v_sub_f32 v18, v56, v128
    v_mul_f32 v20, v18, v18
    v_sub_f32 v19, v57, v128
    v_mul_f32 v21, v19, v19
    v_sub_f32 v18, v58, v128
    v_sub_f32 v19, v59, v128
    v_fmac_f32 v20, v18, v18
    v_fmac_f32 v21, v19, v19
    v_sub_f32 v18, v60, v128
    v_sub_f32 v19, v61, v128
    v_fmac_f32 v20, v18, v18
    v_fmac_f32 v21, v19, v19
    v_sub_f32 v18, v62, v128
    v_sub_f32 v19, v63, v128
    v_fmac_f32 v20, v18, v18
    v_fmac_f32 v21, v19, v19
    v_sub_f32 v18, v64, v128
    v_sub_f32 v19, v65, v128
    v_fmac_f32 v20, v18, v18
    v_fmac_f32 v21, v19, v19
    v_sub_f32 v18, v66, v128
    v_sub_f32 v19, v67, v128
    v_fmac_f32 v20, v18, v18
    v_fmac_f32 v21, v19, v19
    v_sub_f32 v18, v68, v128
    v_sub_f32 v19, v69, v128
    v_fmac_f32 v20, v18, v18
    v_fmac_f32 v21, v19, v19
    v_sub_f32 v18, v70, v128
    v_sub_f32 v19, v71, v128
    v_fmac_f32 v20, v18, v18
    v_fmac_f32 v21, v19, v19
    v_add_f32 v17, v20, v21
    s_nop 1
    v_add_f32_dpp v17, v17, v17 row_ror:1 row_mask:0xf bank_mask:0xf
    s_nop 1
    v_add_f32_dpp v17, v17, v17 row_ror:2 row_mask:0xf bank_mask:0xf
    s_nop 1
    v_add_f32_dpp v17, v17, v17 row_ror:4 row_mask:0xf bank_mask:0xf
    s_nop 1
    v_add_f32_dpp v17, v17, v17 row_ror:8 row_mask:0xf bank_mask:0xf
    v_mov_b32 v20, v17
    s_nop 1
    v_permlane16_swap_b32 v17, v20
    v_add_f32 v17, v17, v20
    v_mov_b32 v20, v17
    s_nop 1
    v_permlane32_swap_b32 v17, v20
    v_add_f32 v17, v17, v20
    v_mul_f32 v17, 0x3a800000, v17
    v_cvt_pk_bf16_f32 v128, v128, v128
    v_lshlrev_b32 v128, 16, v128
    v_cvt_pk_bf16_f32 v17, v17, v17
    v_lshlrev_b32 v17, 16, v17
    v_add_f32 v17, 0x3727c5ac, v17
    v_cvt_pk_bf16_f32 v17, v17, v17
    v_lshlrev_b32 v17, 16, v17
    v_sqrt_f32 v129, v17
    s_nop 0
    v_cvt_pk_bf16_f32 v129, v129, v129
    v_lshlrev_b32 v129, 16, v129
    v_rcp_f32 v130, v129
    s_lshl_b32 s16, s3, 4
    s_add_u32 s16, s16, 149520
    v_mov_b32 v19, s16
    ds_write_b128 v19, v[128:131]
    s_waitcnt vmcnt(6)
    v_and_b32 v73, 0xffff0000, v72
    v_lshlrev_b32 v72, 16, v72
    v_mul_f32 v16, 0xbfb8aa3b, v72
    v_exp_f32 v16, v16
    s_nop 0
    v_add_f32 v16, 1.0, v16
    v_rcp_f32 v16, v16
    s_nop 0
    v_mul_f32 v72, v72, v16
    v_mul_f32 v17, 0xbfb8aa3b, v73
    v_exp_f32 v17, v17
    s_nop 0
    v_add_f32 v17, 1.0, v17
    v_rcp_f32 v17, v17
    s_nop 0
    v_mul_f32 v73, v73, v17
    v_cvt_pk_bf16_f32 v16, v72, v73
    v_lshlrev_b32 v72, 16, v16
    v_and_b32 v73, 0xffff0000, v16
    s_lshl_b32 s16, s2, 8
    s_add_u32 s16, s16, 0x550000
    s_mov_b32 exec_lo, 0x01010101
    s_mov_b32 exec_hi, 0x01010101
    buffer_store_dword v16, v136, s[8:11], s16 offen sc1
    s_mov_b64 exec, -1
    v_lshrrev_b32 v74, 16, v72
    v_lshrrev_b32 v75, 16, v73
    s_waitcnt vmcnt(6)
    v_dot2_f32_bf16 v49, v24, v72, 0
    v_dot2_f32_bf16 v48, v24, v74, 0
    v_dot2_f32_bf16 v51, v25, v72, 0
    v_dot2_f32_bf16 v50, v25, v74, 0
    v_dot2_f32_bf16 v53, v26, v72, 0
    v_dot2_f32_bf16 v52, v26, v74, 0
    v_dot2_f32_bf16 v55, v27, v72, 0
    v_dot2_f32_bf16 v54, v27, v74, 0
    s_waitcnt vmcnt(5)
    v_dot2c_f32_bf16 v49, v28, v73
    v_dot2c_f32_bf16 v48, v28, v75
    v_dot2c_f32_bf16 v51, v29, v73
    v_dot2c_f32_bf16 v50, v29, v75
    v_dot2c_f32_bf16 v53, v30, v73
    v_dot2c_f32_bf16 v52, v30, v75
    v_dot2c_f32_bf16 v55, v31, v73
    v_dot2c_f32_bf16 v54, v31, v75
    s_nop 0
    v_permlane32_swap_b32 v48, v52
    v_permlane32_swap_b32 v49, v53
    v_permlane32_swap_b32 v50, v54
    v_permlane32_swap_b32 v51, v55
    v_add_f32 v48, v48, v52
    v_add_f32 v49, v49, v53
    v_add_f32 v50, v50, v54
    v_add_f32 v51, v51, v55
    s_nop 0
    v_permlane16_swap_b32 v48, v50
    v_permlane16_swap_b32 v49, v51
    v_add_f32 v48, v48, v50
    v_add_f32 v49, v49, v51
    s_nop 0
    v_add_f32_dpp v48, v48, v48 row_ror:8 row_mask:0xf bank_mask:0xf
    v_add_f32_dpp v49, v49, v49 row_ror:8 row_mask:0xf bank_mask:0xf
    v_and_b32 v16, 7, v1
    v_lshlrev_b32 v16, 5, v16
    v_lshrrev_b32 v17, 4, v1
    v_lshl_add_u32 v16, v17, 3, v16
    s_lshl_b32 s16, s3, 8
    s_add_u32 s16, s16, 147456
    v_add_u32 v16, s16, v16
    ds_write_b64 v16, v[48:49]
    s_waitcnt vmcnt(4)
    v_cmp_eq_u32 vcc, 0, v134
    s_cmp_eq_u32 s3, 0
    s_cselect_b64 s[62:63], -1, 0
    s_and_b64 vcc, vcc, s[62:63]
    s_cbranch_vccnz adaLN_cond__sliding_block_cached__moe_arch_mod__prompt_kernel_n1r
adaLN_cond__sliding_block_cached__moe_arch_mod__prompt_kernel_n1b:
    v_mov_b32 v19, 149504
    s_cmp_eq_u32 s3, 0
    s_cselect_b64 exec, 1, 0
    ds_write_b32 v19, v134
    s_mov_b64 exec, -1
    v_mov_b32 v19, 149504
    v_and_b32 v17, 31, v1
    v_lshlrev_b32 v18, 3, v17
    v_add_u32 v18, 147456, v18
    v_lshlrev_b32 v17, 4, v17
    s_waitcnt lgkmcnt(0)
    s_barrier
    ds_read_b32 v134, v19
    ds_read_b64 v[96:97], v18 offset:0
    ds_read_b64 v[100:101], v18 offset:256
    ds_read_b64 v[104:105], v18 offset:512
    ds_read_b64 v[108:109], v18 offset:768
    ds_read_b64 v[112:113], v18 offset:1024
    ds_read_b64 v[116:117], v18 offset:1280
    ds_read_b64 v[120:121], v18 offset:1536
    ds_read_b64 v[124:125], v18 offset:1792
    s_waitcnt lgkmcnt(8)
    v_readfirstlane_b32 s28, v134
    v_and_b32 v20, 7, v1
    v_lshlrev_b32 v20, 4, v20
    v_add_u32 v21, 149520, v20
    ds_read_b128 v[128:131], v21
    s_waitcnt lgkmcnt(0)
    v_mov_b32 v131, s28
    s_lshl_b32 s16, s2, 7
    s_add_u32 s16, s16, 0x520000
    s_cmp_eq_u32 s3, 0
    s_cselect_b32 s16, s16, 0x7ffffff0
    s_mov_b64 exec, 0xff
    buffer_store_dwordx4 v[128:131], v20, s[8:11], s16 offen sc1
    s_mov_b64 exec, -1
    v_pk_add_f32 v[96:97], v[96:97], v[112:113]
    v_pk_add_f32 v[100:101], v[100:101], v[116:117]
    v_pk_add_f32 v[104:105], v[104:105], v[120:121]
    v_pk_add_f32 v[108:109], v[108:109], v[124:125]
    v_pk_add_f32 v[96:97], v[96:97], v[104:105]
    v_pk_add_f32 v[100:101], v[100:101], v[108:109]
    v_pk_add_f32 v[96:97], v[96:97], v[100:101]
    v_mov_b32 v98, s28
    v_mov_b32 v99, s28
    s_lshl_b32 s16, s14, 3
    s_add_u32 s16, s16, s15
    s_lshl_b32 s16, s16, 9
    s_add_u32 s16, s16, 0x500000
    s_cmp_eq_u32 s3, 0
    s_cselect_b32 s16, s16, 0x7ffffff0
    s_mov_b64 exec, 0xffffffff
    buffer_store_dwordx4 v[96:99], v17, s[8:11], s16 offen sc1
    s_mov_b64 exec, -1
    s_lshr_b32 s16, s3, 2
    s_lshl_b32 s16, s16, 4
    s_add_u32 s16, s16, s31
    s_lshl_b32 s16, s16, 12
    s_and_b32 s17, s3, 3
    s_lshl_b32 s17, s17, 7
    s_add_u32 s16, s16, s17
    s_add_u32 s16, s16, 0x500000
    v_lshrrev_b32 v139, 3, v1
    v_lshlrev_b32 v139, 9, v139
    v_and_b32 v16, 7, v1
    v_lshl_add_u32 v139, v16, 4, v139
    v_and_b32 v140, 15, v1
    v_lshlrev_b32 v140, 4, v140
    s_lshl_b32 s17, s29, 8
    s_add_u32 s17, s17, 0x520000
    s_waitcnt vmcnt(4)
    v_lshlrev_b32 v56, 16, v40
    v_and_b32 v57, 0xffff0000, v40
    v_lshlrev_b32 v58, 16, v41
    v_and_b32 v59, 0xffff0000, v41
    v_lshlrev_b32 v60, 16, v42
    v_and_b32 v61, 0xffff0000, v42
    v_lshlrev_b32 v62, 16, v43
    v_and_b32 v63, 0xffff0000, v43
    s_waitcnt vmcnt(3)
    v_lshlrev_b32 v64, 16, v44
    v_and_b32 v65, 0xffff0000, v44
    v_lshlrev_b32 v66, 16, v45
    v_and_b32 v67, 0xffff0000, v45
    v_lshlrev_b32 v68, 16, v46
    v_and_b32 v69, 0xffff0000, v46
    v_lshlrev_b32 v70, 16, v47
    v_and_b32 v71, 0xffff0000, v47
    s_mov_b32 s27, 0
adaLN_cond__sliding_block_cached__moe_arch_mod__prompt_kernel_g2p:
    buffer_load_dwordx4 v[76:79], v139, s[8:11], s16 offen sc1
    buffer_load_dwordx4 v[80:83], v140, s[8:11], s17 offen sc1
    s_waitcnt vmcnt(1)
    v_cmp_ne_u32 vcc, s28, v78
    v_cmp_ne_u32 s[62:63], s28, v79
    s_or_b64 vcc, vcc, s[62:63]
    s_waitcnt vmcnt(0)
    v_cmp_ne_u32 s[62:63], s28, v83
    s_or_b64 vcc, vcc, s[62:63]
    s_add_u32 s27, s27, 1
    s_cmp_ge_u32 s27, 65536
    s_cbranch_scc1 adaLN_cond__sliding_block_cached__moe_arch_mod__prompt_kernel_g2g
    s_cbranch_vccnz adaLN_cond__sliding_block_cached__moe_arch_mod__prompt_kernel_g2p
adaLN_cond__sliding_block_cached__moe_arch_mod__prompt_kernel_g2g:
    v_add_f32_dpp v76, v76, v76 row_ror:8 row_mask:0xf bank_mask:0xf
    v_add_f32_dpp v77, v77, v77 row_ror:8 row_mask:0xf bank_mask:0xf
    v_mov_b32 v17, v76
    s_nop 1
    v_permlane16_swap_b32 v76, v17
    v_add_f32 v76, v76, v17
    v_mov_b32 v18, v77
    s_nop 1
    v_permlane16_swap_b32 v77, v18
    v_add_f32 v77, v77, v18
    v_mov_b32 v17, v76
    s_nop 1
    v_permlane32_swap_b32 v76, v17
    v_add_f32 v76, v76, v17
    v_mov_b32 v18, v77
    s_nop 1
    v_permlane32_swap_b32 v77, v18
    v_add_f32 v77, v77, v18
    v_cvt_pk_bf16_f32 v17, v76, v77
    v_lshlrev_b32 v76, 16, v17
    v_and_b32 v77, 0xffff0000, v17
    v_add_f32 v76, 0, v76
    v_add_f32 v77, 0, v77
    s_lshl_b32 s16, s3, 6
    s_add_u32 s16, s16, 151552
    v_lshl_add_u32 v16, v16, 3, s16
    ds_write_b64 v16, v[76:77]
    v_lshrrev_b32 v17, 4, v1
    v_lshlrev_b32 v17, 5, v17
    v_add_u32 v17, 151552, v17
    v_sub_f32 v56, v56, v80
    v_sub_f32 v57, v57, v80
    v_sub_f32 v58, v58, v80
    v_sub_f32 v59, v59, v80
    v_sub_f32 v60, v60, v80
    v_sub_f32 v61, v61, v80
    v_sub_f32 v62, v62, v80
    v_sub_f32 v63, v63, v80
    v_sub_f32 v64, v64, v80
    v_sub_f32 v65, v65, v80
    v_sub_f32 v66, v66, v80
    v_sub_f32 v67, v67, v80
    v_sub_f32 v68, v68, v80
    v_sub_f32 v69, v69, v80
    v_sub_f32 v70, v70, v80
    v_sub_f32 v71, v71, v80
    v_cvt_pk_bf16_f32 v18, v56, v57
    v_lshlrev_b32 v56, 16, v18
    v_and_b32 v57, 0xffff0000, v18
    v_cvt_pk_bf16_f32 v19, v58, v59
    v_lshlrev_b32 v58, 16, v19
    v_and_b32 v59, 0xffff0000, v19
    v_cvt_pk_bf16_f32 v18, v60, v61
    v_lshlrev_b32 v60, 16, v18
    v_and_b32 v61, 0xffff0000, v18
    v_cvt_pk_bf16_f32 v19, v62, v63
    v_lshlrev_b32 v62, 16, v19
    v_and_b32 v63, 0xffff0000, v19
    v_cvt_pk_bf16_f32 v18, v64, v65
    v_lshlrev_b32 v64, 16, v18
    v_and_b32 v65, 0xffff0000, v18
    v_cvt_pk_bf16_f32 v19, v66, v67
    v_lshlrev_b32 v66, 16, v19
    v_and_b32 v67, 0xffff0000, v19
    v_cvt_pk_bf16_f32 v18, v68, v69
    v_lshlrev_b32 v68, 16, v18
    v_and_b32 v69, 0xffff0000, v18
    v_cvt_pk_bf16_f32 v19, v70, v71
    v_lshlrev_b32 v70, 16, v19
    v_and_b32 v71, 0xffff0000, v19
    v_mul_f32 v56, v56, v82
    v_mul_f32 v57, v57, v82
    v_mul_f32 v58, v58, v82
    v_mul_f32 v59, v59, v82
    v_mul_f32 v60, v60, v82
    v_mul_f32 v61, v61, v82
    v_mul_f32 v62, v62, v82
    v_mul_f32 v63, v63, v82
    v_mul_f32 v64, v64, v82
    v_mul_f32 v65, v65, v82
    v_mul_f32 v66, v66, v82
    v_mul_f32 v67, v67, v82
    v_mul_f32 v68, v68, v82
    v_mul_f32 v69, v69, v82
    v_mul_f32 v70, v70, v82
    v_mul_f32 v71, v71, v82
    v_cvt_pk_bf16_f32 v18, v56, v57
    v_lshlrev_b32 v56, 16, v18
    v_and_b32 v57, 0xffff0000, v18
    v_cvt_pk_bf16_f32 v19, v58, v59
    v_lshlrev_b32 v58, 16, v19
    v_and_b32 v59, 0xffff0000, v19
    v_cvt_pk_bf16_f32 v18, v60, v61
    v_lshlrev_b32 v60, 16, v18
    v_and_b32 v61, 0xffff0000, v18
    v_cvt_pk_bf16_f32 v19, v62, v63
    v_lshlrev_b32 v62, 16, v19
    v_and_b32 v63, 0xffff0000, v19
    v_cvt_pk_bf16_f32 v18, v64, v65
    v_lshlrev_b32 v64, 16, v18
    v_and_b32 v65, 0xffff0000, v18
    v_cvt_pk_bf16_f32 v19, v66, v67
    v_lshlrev_b32 v66, 16, v19
    v_and_b32 v67, 0xffff0000, v19
    v_cvt_pk_bf16_f32 v18, v68, v69
    v_lshlrev_b32 v68, 16, v18
    v_and_b32 v69, 0xffff0000, v18
    v_cvt_pk_bf16_f32 v19, v70, v71
    v_lshlrev_b32 v70, 16, v19
    v_and_b32 v71, 0xffff0000, v19
    s_lshl_b32 s16, s29, 15
    s_lshl_b32 s17, s31, 11
    s_add_u32 s16, s16, s17
    s_waitcnt lgkmcnt(0)
    s_barrier
    ds_read_b128 v[96:99], v17 offset:256
    ds_read_b128 v[104:107], v17 offset:0
    ds_read_b128 v[100:103], v17 offset:272
    ds_read_b128 v[108:111], v17 offset:16
    ds_read_b128 v[112:115], v17 offset:384
    ds_read_b128 v[120:123], v17 offset:128
    ds_read_b128 v[116:119], v17 offset:400
    ds_read_b128 v[124:127], v17 offset:144
    s_waitcnt lgkmcnt(7)
    v_pk_mul_f32 v[56:57], v[56:57], v[96:97]
    v_pk_mul_f32 v[58:59], v[58:59], v[98:99]
    s_waitcnt lgkmcnt(5)
    v_pk_mul_f32 v[60:61], v[60:61], v[100:101]
    v_pk_mul_f32 v[62:63], v[62:63], v[102:103]
    v_cvt_pk_bf16_f32 v18, v56, v57
    v_lshlrev_b32 v56, 16, v18
    v_and_b32 v57, 0xffff0000, v18
    v_cvt_pk_bf16_f32 v19, v58, v59
    v_lshlrev_b32 v58, 16, v19
    v_and_b32 v59, 0xffff0000, v19
    v_cvt_pk_bf16_f32 v18, v60, v61
    v_lshlrev_b32 v60, 16, v18
    v_and_b32 v61, 0xffff0000, v18
    v_cvt_pk_bf16_f32 v19, v62, v63
    v_lshlrev_b32 v62, 16, v19
    v_and_b32 v63, 0xffff0000, v19
    v_pk_add_f32 v[56:57], v[56:57], v[104:105]
    v_pk_add_f32 v[58:59], v[58:59], v[106:107]
    s_waitcnt lgkmcnt(4)
    v_pk_add_f32 v[60:61], v[60:61], v[108:109]
    v_pk_add_f32 v[62:63], v[62:63], v[110:111]
    v_cvt_pk_bf16_f32 v32, v56, v57
    v_cvt_pk_bf16_f32 v33, v58, v59
    v_cvt_pk_bf16_f32 v34, v60, v61
    v_cvt_pk_bf16_f32 v35, v62, v63
    buffer_store_dwordx4 v[32:35], v2, s[8:11], s16 offen offset:0 sc1
    s_waitcnt lgkmcnt(3)
    v_pk_mul_f32 v[64:65], v[64:65], v[112:113]
    v_pk_mul_f32 v[66:67], v[66:67], v[114:115]
    s_waitcnt lgkmcnt(1)
    v_pk_mul_f32 v[68:69], v[68:69], v[116:117]
    v_pk_mul_f32 v[70:71], v[70:71], v[118:119]
    v_cvt_pk_bf16_f32 v18, v64, v65
    v_lshlrev_b32 v64, 16, v18
    v_and_b32 v65, 0xffff0000, v18
    v_cvt_pk_bf16_f32 v19, v66, v67
    v_lshlrev_b32 v66, 16, v19
    v_and_b32 v67, 0xffff0000, v19
    v_cvt_pk_bf16_f32 v18, v68, v69
    v_lshlrev_b32 v68, 16, v18
    v_and_b32 v69, 0xffff0000, v18
    v_cvt_pk_bf16_f32 v19, v70, v71
    v_lshlrev_b32 v70, 16, v19
    v_and_b32 v71, 0xffff0000, v19
    v_pk_add_f32 v[64:65], v[64:65], v[120:121]
    v_pk_add_f32 v[66:67], v[66:67], v[122:123]
    s_waitcnt lgkmcnt(0)
    v_pk_add_f32 v[68:69], v[68:69], v[124:125]
    v_pk_add_f32 v[70:71], v[70:71], v[126:127]
    v_cvt_pk_bf16_f32 v36, v64, v65
    v_cvt_pk_bf16_f32 v37, v66, v67
    v_cvt_pk_bf16_f32 v38, v68, v69
    v_cvt_pk_bf16_f32 v39, v70, v71
    buffer_store_dwordx4 v[36:39], v2, s[8:11], s16 offen offset:1024 sc1
    s_lshl_b32 s19, s3, 16
    s_lshl_b32 s20, s3, 11
    s_lshl_b32 s16, s12, 8
    s_add_u32 s4, s38, s16
    s_addc_u32 s5, s39, 0
    s_sub_u32 s6, 0x800000, s16
    s_mov_b32 s7, 0x20000
    s_barrier
    s_add_u32 s22, s19, 0x0
    s_add_u32 m0, s20, 0x0
    s_nop 0
    buffer_load_dwordx4 v3, s[4:7], s22 offen lds
    s_add_u32 s22, s19, 0x8000
    s_add_u32 m0, s20, 0x400
    s_nop 0
    buffer_load_dwordx4 v3, s[4:7], s22 offen lds
    s_add_u32 s22, s19, 0x80000
    s_add_u32 m0, s20, 0x4000
    s_nop 0
    buffer_load_dwordx4 v3, s[4:7], s22 offen lds
    s_add_u32 s22, s19, 0x88000
    s_add_u32 m0, s20, 0x4400
    s_nop 0
    buffer_load_dwordx4 v3, s[4:7], s22 offen lds
    s_add_u32 s22, s19, 0x100000
    s_add_u32 m0, s20, 0x8000
    s_nop 0
    buffer_load_dwordx4 v3, s[4:7], s22 offen lds
    s_add_u32 s22, s19, 0x108000
    s_add_u32 m0, s20, 0x8400
    s_nop 0
    buffer_load_dwordx4 v3, s[4:7], s22 offen lds
    v_mov_b32 v134, s28
    s_lshl_b32 s16, s29, 4
    s_add_u32 s16, s16, s31
    s_lshl_b32 s16, s16, 2
    s_add_u32 s16, s16, 0x528000
    v_and_b32 v16, 31, v1
    v_lshlrev_b32 v16, 2, v16
    s_lshl_b32 s17, s13, 3
    s_add_u32 s17, s17, s3
    s_lshl_b32 s17, s17, 7
    s_add_u32 s17, s17, 0x528000
    s_waitcnt vmcnt(6)
    s_mov_b64 exec, 1
    buffer_store_dword v134, v132, s[8:11], s16 offen sc1
    s_mov_b64 exec, -1
    s_waitcnt vmcnt(0)
    s_mov_b32 s27, 0
adaLN_cond__sliding_block_cached__moe_arch_mod__prompt_kernel_h3p:
    buffer_load_dword v17, v16, s[8:11], s17 offen sc1
    s_waitcnt vmcnt(0)
    v_cmp_ne_u32 vcc, s28, v17
    s_add_u32 s27, s27, 1
    s_cmp_ge_u32 s27, 65536
    s_cbranch_scc1 adaLN_cond__sliding_block_cached__moe_arch_mod__prompt_kernel_h3g
    s_cbranch_vccnz adaLN_cond__sliding_block_cached__moe_arch_mod__prompt_kernel_h3p
adaLN_cond__sliding_block_cached__moe_arch_mod__prompt_kernel_h3g:
    s_mov_b32 s23, 0x0
    buffer_load_dwordx4 v[88:91], v7, s[8:11], s23 offen offset:0 sc1
    s_mov_b32 s23, 0x8000
    buffer_load_dwordx4 v[92:95], v7, s[8:11], s23 offen offset:0 sc1
    s_mov_b32 s23, 0x0
    buffer_load_dwordx4 v[96:99], v7, s[8:11], s23 offen offset:1024 sc1
    s_mov_b32 s23, 0x8000
    buffer_load_dwordx4 v[100:103], v7, s[8:11], s23 offen offset:1024 sc1
    s_mov_b32 s23, 0x800
    buffer_load_dwordx4 v[104:107], v7, s[8:11], s23 offen offset:0 sc1
    s_mov_b32 s23, 0x8800
    buffer_load_dwordx4 v[108:111], v7, s[8:11], s23 offen offset:0 sc1
    s_mov_b32 s23, 0x800
    buffer_load_dwordx4 v[112:115], v7, s[8:11], s23 offen offset:1024 sc1
    s_mov_b32 s23, 0x8800
    buffer_load_dwordx4 v[116:119], v7, s[8:11], s23 offen offset:1024 sc1
    s_lshr_b32 s21, s12, 3
    s_lshl_b32 s21, s21, 17
    s_add_u32 s21, s21, s20
    s_add_u32 s21, s21, 0x400000
    s_barrier
    ds_read_b64_tr_b16 v[224:225], v4 offset:0
    ds_read_b64_tr_b16 v[226:227], v4 offset:1024
    ds_read_b64_tr_b16 v[228:229], v5 offset:32
    ds_read_b64_tr_b16 v[230:231], v5 offset:1056
    ds_read_b64_tr_b16 v[232:233], v4 offset:256
    ds_read_b64_tr_b16 v[234:235], v4 offset:1280
    ds_read_b64_tr_b16 v[236:237], v5 offset:288
    ds_read_b64_tr_b16 v[238:239], v5 offset:1312
    s_waitcnt vmcnt(7) lgkmcnt(6)
    v_mfma_f32_16x16x32_bf16 v[24:27], v[224:227], v[88:91], 0
    ds_read_b64_tr_b16 v[240:241], v4 offset:512
    s_waitcnt vmcnt(6)
    v_mfma_f32_16x16x32_bf16 v[28:31], v[224:227], v[92:95], 0
    ds_read_b64_tr_b16 v[242:243], v4 offset:1536
    s_waitcnt lgkmcnt(6)
    v_mfma_f32_16x16x32_bf16 v[32:35], v[228:231], v[88:91], 0
    ds_read_b64_tr_b16 v[244:245], v5 offset:544
    v_mfma_f32_16x16x32_bf16 v[36:39], v[228:231], v[92:95], 0
    ds_read_b64_tr_b16 v[246:247], v5 offset:1568
    s_mov_b32 s23, 0x1000
    buffer_load_dwordx4 v[120:123], v7, s[8:11], s23 offen offset:0 sc1
    s_waitcnt lgkmcnt(6)
    v_mfma_f32_16x16x32_bf16 v[40:43], v[232:235], v[88:91], 0
    ds_read_b64_tr_b16 v[224:225], v4 offset:768
    v_mfma_f32_16x16x32_bf16 v[44:47], v[232:235], v[92:95], 0
    ds_read_b64_tr_b16 v[226:227], v4 offset:1792
    s_waitcnt lgkmcnt(6)
    v_mfma_f32_16x16x32_bf16 v[48:51], v[236:239], v[88:91], 0
    ds_read_b64_tr_b16 v[228:229], v5 offset:800
    v_mfma_f32_16x16x32_bf16 v[52:55], v[236:239], v[92:95], 0
    ds_read_b64_tr_b16 v[230:231], v5 offset:1824
    s_waitcnt lgkmcnt(6)
    v_mfma_f32_16x16x32_bf16 v[56:59], v[240:243], v[88:91], 0
    ds_read_b64_tr_b16 v[232:233], v4 offset:8192
    v_mfma_f32_16x16x32_bf16 v[60:63], v[240:243], v[92:95], 0
    ds_read_b64_tr_b16 v[234:235], v4 offset:9216
    s_waitcnt lgkmcnt(6)
    v_mfma_f32_16x16x32_bf16 v[64:67], v[244:247], v[88:91], 0
    ds_read_b64_tr_b16 v[236:237], v5 offset:8224
    v_mfma_f32_16x16x32_bf16 v[68:71], v[244:247], v[92:95], 0
    ds_read_b64_tr_b16 v[238:239], v5 offset:9248
    s_mov_b32 s23, 0x9000
    buffer_load_dwordx4 v[124:127], v7, s[8:11], s23 offen offset:0 sc1
    s_waitcnt lgkmcnt(6)
    v_mfma_f32_16x16x32_bf16 v[72:75], v[224:227], v[88:91], 0
    ds_read_b64_tr_b16 v[240:241], v4 offset:8448
    v_mfma_f32_16x16x32_bf16 v[76:79], v[224:227], v[92:95], 0
    ds_read_b64_tr_b16 v[242:243], v4 offset:9472
    s_waitcnt lgkmcnt(6)
    v_mfma_f32_16x16x32_bf16 v[80:83], v[228:231], v[88:91], 0
    ds_read_b64_tr_b16 v[244:245], v5 offset:8480
    v_mfma_f32_16x16x32_bf16 v[84:87], v[228:231], v[92:95], 0
    ds_read_b64_tr_b16 v[246:247], v5 offset:9504
    s_waitcnt vmcnt(7) lgkmcnt(6)
    v_mfma_f32_16x16x32_bf16 v[24:27], v[232:235], v[96:99], v[24:27]
    ds_read_b64_tr_b16 v[224:225], v4 offset:8704
    s_waitcnt vmcnt(6)
    v_mfma_f32_16x16x32_bf16 v[28:31], v[232:235], v[100:103], v[28:31]
    ds_read_b64_tr_b16 v[226:227], v4 offset:9728
    s_waitcnt lgkmcnt(6)
    v_mfma_f32_16x16x32_bf16 v[32:35], v[236:239], v[96:99], v[32:35]
    ds_read_b64_tr_b16 v[228:229], v5 offset:8736
    v_mfma_f32_16x16x32_bf16 v[36:39], v[236:239], v[100:103], v[36:39]
    ds_read_b64_tr_b16 v[230:231], v5 offset:9760
    s_mov_b32 s23, 0x1000
    buffer_load_dwordx4 v[128:131], v7, s[8:11], s23 offen offset:1024 sc1
    s_waitcnt lgkmcnt(6)
    v_mfma_f32_16x16x32_bf16 v[40:43], v[240:243], v[96:99], v[40:43]
    ds_read_b64_tr_b16 v[232:233], v4 offset:8960
    v_mfma_f32_16x16x32_bf16 v[44:47], v[240:243], v[100:103], v[44:47]
    ds_read_b64_tr_b16 v[234:235], v4 offset:9984
    s_waitcnt lgkmcnt(6)
    v_mfma_f32_16x16x32_bf16 v[48:51], v[244:247], v[96:99], v[48:51]
    ds_read_b64_tr_b16 v[236:237], v5 offset:8992
    v_mfma_f32_16x16x32_bf16 v[52:55], v[244:247], v[100:103], v[52:55]
    ds_read_b64_tr_b16 v[238:239], v5 offset:10016
    s_waitcnt lgkmcnt(6)
    v_mfma_f32_16x16x32_bf16 v[56:59], v[224:227], v[96:99], v[56:59]
    v_mfma_f32_16x16x32_bf16 v[60:63], v[224:227], v[100:103], v[60:63]
    s_barrier
    ds_read_b64_tr_b16 v[240:241], v4 offset:16384
    ds_read_b64_tr_b16 v[242:243], v4 offset:17408
    s_waitcnt lgkmcnt(6)
    v_mfma_f32_16x16x32_bf16 v[64:67], v[228:231], v[96:99], v[64:67]
    ds_read_b64_tr_b16 v[244:245], v5 offset:16416
    v_mfma_f32_16x16x32_bf16 v[68:71], v[228:231], v[100:103], v[68:71]
    s_add_u32 s22, s19, 0x180000
    s_add_u32 m0, s20, 0xc000
    s_nop 0
    buffer_load_dwordx4 v3, s[4:7], s22 offen lds
    ds_read_b64_tr_b16 v[246:247], v5 offset:17440
    s_mov_b32 s23, 0x9000
    buffer_load_dwordx4 v[132:135], v7, s[8:11], s23 offen offset:1024 sc1
    s_waitcnt lgkmcnt(6)
    v_mfma_f32_16x16x32_bf16 v[72:75], v[232:235], v[96:99], v[72:75]
    ds_read_b64_tr_b16 v[224:225], v4 offset:16640
    v_mfma_f32_16x16x32_bf16 v[76:79], v[232:235], v[100:103], v[76:79]
    ds_read_b64_tr_b16 v[226:227], v4 offset:17664
    s_waitcnt lgkmcnt(6)
    v_mfma_f32_16x16x32_bf16 v[80:83], v[236:239], v[96:99], v[80:83]
    ds_read_b64_tr_b16 v[228:229], v5 offset:16672
    v_mfma_f32_16x16x32_bf16 v[84:87], v[236:239], v[100:103], v[84:87]
    ds_read_b64_tr_b16 v[230:231], v5 offset:17696
    s_waitcnt vmcnt(8) lgkmcnt(6)
    v_mfma_f32_16x16x32_bf16 v[24:27], v[240:243], v[104:107], v[24:27]
    ds_read_b64_tr_b16 v[232:233], v4 offset:16896
    s_waitcnt vmcnt(7)
    v_mfma_f32_16x16x32_bf16 v[28:31], v[240:243], v[108:111], v[28:31]
    ds_read_b64_tr_b16 v[234:235], v4 offset:17920
    s_waitcnt lgkmcnt(6)
    v_mfma_f32_16x16x32_bf16 v[32:35], v[244:247], v[104:107], v[32:35]
    ds_read_b64_tr_b16 v[236:237], v5 offset:16928
    v_mfma_f32_16x16x32_bf16 v[36:39], v[244:247], v[108:111], v[36:39]
    s_add_u32 s22, s19, 0x188000
    s_add_u32 m0, s20, 0xc400
    s_nop 0
    buffer_load_dwordx4 v3, s[4:7], s22 offen lds
    ds_read_b64_tr_b16 v[238:239], v5 offset:17952
    s_mov_b32 s23, 0x1800
    buffer_load_dwordx4 v[88:91], v7, s[8:11], s23 offen offset:0 sc1
    s_waitcnt lgkmcnt(6)
    v_mfma_f32_16x16x32_bf16 v[40:43], v[224:227], v[104:107], v[40:43]
    ds_read_b64_tr_b16 v[240:241], v4 offset:17152
    v_mfma_f32_16x16x32_bf16 v[44:47], v[224:227], v[108:111], v[44:47]
    ds_read_b64_tr_b16 v[242:243], v4 offset:18176
    s_waitcnt lgkmcnt(6)
    v_mfma_f32_16x16x32_bf16 v[48:51], v[228:231], v[104:107], v[48:51]
    ds_read_b64_tr_b16 v[244:245], v5 offset:17184
    v_mfma_f32_16x16x32_bf16 v[52:55], v[228:231], v[108:111], v[52:55]
    ds_read_b64_tr_b16 v[246:247], v5 offset:18208
    s_waitcnt lgkmcnt(6)
    v_mfma_f32_16x16x32_bf16 v[56:59], v[232:235], v[104:107], v[56:59]
    ds_read_b64_tr_b16 v[224:225], v4 offset:24576
    v_mfma_f32_16x16x32_bf16 v[60:63], v[232:235], v[108:111], v[60:63]
    ds_read_b64_tr_b16 v[226:227], v4 offset:25600
    s_waitcnt lgkmcnt(6)
    v_mfma_f32_16x16x32_bf16 v[64:67], v[236:239], v[104:107], v[64:67]
    ds_read_b64_tr_b16 v[228:229], v5 offset:24608
    v_mfma_f32_16x16x32_bf16 v[68:71], v[236:239], v[108:111], v[68:71]
    ds_read_b64_tr_b16 v[230:231], v5 offset:25632
    s_mov_b32 s23, 0x9800
    buffer_load_dwordx4 v[92:95], v7, s[8:11], s23 offen offset:0 sc1
    s_waitcnt lgkmcnt(6)
    v_mfma_f32_16x16x32_bf16 v[72:75], v[240:243], v[104:107], v[72:75]
    ds_read_b64_tr_b16 v[232:233], v4 offset:24832
    v_mfma_f32_16x16x32_bf16 v[76:79], v[240:243], v[108:111], v[76:79]
    ds_read_b64_tr_b16 v[234:235], v4 offset:25856
    s_waitcnt lgkmcnt(6)
    v_mfma_f32_16x16x32_bf16 v[80:83], v[244:247], v[104:107], v[80:83]
    ds_read_b64_tr_b16 v[236:237], v5 offset:24864
    v_mfma_f32_16x16x32_bf16 v[84:87], v[244:247], v[108:111], v[84:87]
    ds_read_b64_tr_b16 v[238:239], v5 offset:25888
    s_waitcnt vmcnt(9) lgkmcnt(6)
    v_mfma_f32_16x16x32_bf16 v[24:27], v[224:227], v[112:115], v[24:27]
    ds_read_b64_tr_b16 v[240:241], v4 offset:25088
    s_waitcnt vmcnt(8)
    v_mfma_f32_16x16x32_bf16 v[28:31], v[224:227], v[116:119], v[28:31]
    ds_read_b64_tr_b16 v[242:243], v4 offset:26112
    s_waitcnt lgkmcnt(6)
    v_mfma_f32_16x16x32_bf16 v[32:35], v[228:231], v[112:115], v[32:35]
    ds_read_b64_tr_b16 v[244:245], v5 offset:25120
    v_mfma_f32_16x16x32_bf16 v[36:39], v[228:231], v[116:119], v[36:39]
    ds_read_b64_tr_b16 v[246:247], v5 offset:26144
    s_mov_b32 s23, 0x1800
    buffer_load_dwordx4 v[96:99], v7, s[8:11], s23 offen offset:1024 sc1
    s_waitcnt lgkmcnt(6)
    v_mfma_f32_16x16x32_bf16 v[40:43], v[232:235], v[112:115], v[40:43]
    ds_read_b64_tr_b16 v[224:225], v4 offset:25344
    v_mfma_f32_16x16x32_bf16 v[44:47], v[232:235], v[116:119], v[44:47]
    ds_read_b64_tr_b16 v[226:227], v4 offset:26368
    s_waitcnt lgkmcnt(6)
    v_mfma_f32_16x16x32_bf16 v[48:51], v[236:239], v[112:115], v[48:51]
    ds_read_b64_tr_b16 v[228:229], v5 offset:25376
    v_mfma_f32_16x16x32_bf16 v[52:55], v[236:239], v[116:119], v[52:55]
    ds_read_b64_tr_b16 v[230:231], v5 offset:26400
    s_waitcnt lgkmcnt(6)
    v_mfma_f32_16x16x32_bf16 v[56:59], v[240:243], v[112:115], v[56:59]
    v_mfma_f32_16x16x32_bf16 v[60:63], v[240:243], v[116:119], v[60:63]
    s_barrier
    ds_read_b64_tr_b16 v[232:233], v4 offset:32768
    ds_read_b64_tr_b16 v[234:235], v4 offset:33792
    s_waitcnt lgkmcnt(6)
    v_mfma_f32_16x16x32_bf16 v[64:67], v[244:247], v[112:115], v[64:67]
    ds_read_b64_tr_b16 v[236:237], v5 offset:32800
    v_mfma_f32_16x16x32_bf16 v[68:71], v[244:247], v[116:119], v[68:71]
    s_add_u32 s22, s19, 0x200000
    s_add_u32 m0, s20, 0x0
    s_nop 0
    buffer_load_dwordx4 v3, s[4:7], s22 offen lds
    ds_read_b64_tr_b16 v[238:239], v5 offset:33824
    s_mov_b32 s23, 0x9800
    buffer_load_dwordx4 v[100:103], v7, s[8:11], s23 offen offset:1024 sc1
    s_waitcnt lgkmcnt(6)
    v_mfma_f32_16x16x32_bf16 v[72:75], v[224:227], v[112:115], v[72:75]
    ds_read_b64_tr_b16 v[240:241], v4 offset:33024
    v_mfma_f32_16x16x32_bf16 v[76:79], v[224:227], v[116:119], v[76:79]
    ds_read_b64_tr_b16 v[242:243], v4 offset:34048
    s_waitcnt lgkmcnt(6)
    v_mfma_f32_16x16x32_bf16 v[80:83], v[228:231], v[112:115], v[80:83]
    ds_read_b64_tr_b16 v[244:245], v5 offset:33056
    v_mfma_f32_16x16x32_bf16 v[84:87], v[228:231], v[116:119], v[84:87]
    ds_read_b64_tr_b16 v[246:247], v5 offset:34080
    s_waitcnt vmcnt(10) lgkmcnt(6)
    v_mfma_f32_16x16x32_bf16 v[24:27], v[232:235], v[120:123], v[24:27]
    ds_read_b64_tr_b16 v[224:225], v4 offset:33280
    s_waitcnt vmcnt(9)
    v_mfma_f32_16x16x32_bf16 v[28:31], v[232:235], v[124:127], v[28:31]
    ds_read_b64_tr_b16 v[226:227], v4 offset:34304
    s_waitcnt lgkmcnt(6)
    v_mfma_f32_16x16x32_bf16 v[32:35], v[236:239], v[120:123], v[32:35]
    ds_read_b64_tr_b16 v[228:229], v5 offset:33312
    v_mfma_f32_16x16x32_bf16 v[36:39], v[236:239], v[124:127], v[36:39]
    s_add_u32 s22, s19, 0x208000
    s_add_u32 m0, s20, 0x400
    s_nop 0
    buffer_load_dwordx4 v3, s[4:7], s22 offen lds
    ds_read_b64_tr_b16 v[230:231], v5 offset:34336
    s_mov_b32 s23, 0x2000
    buffer_load_dwordx4 v[104:107], v7, s[8:11], s23 offen offset:0 sc1
    s_waitcnt lgkmcnt(6)
    v_mfma_f32_16x16x32_bf16 v[40:43], v[240:243], v[120:123], v[40:43]
    ds_read_b64_tr_b16 v[232:233], v4 offset:33536
    v_mfma_f32_16x16x32_bf16 v[44:47], v[240:243], v[124:127], v[44:47]
    ds_read_b64_tr_b16 v[234:235], v4 offset:34560
    s_waitcnt lgkmcnt(6)
    v_mfma_f32_16x16x32_bf16 v[48:51], v[244:247], v[120:123], v[48:51]
    ds_read_b64_tr_b16 v[236:237], v5 offset:33568
    v_mfma_f32_16x16x32_bf16 v[52:55], v[244:247], v[124:127], v[52:55]
    ds_read_b64_tr_b16 v[238:239], v5 offset:34592
    s_waitcnt lgkmcnt(6)
    v_mfma_f32_16x16x32_bf16 v[56:59], v[224:227], v[120:123], v[56:59]
    ds_read_b64_tr_b16 v[240:241], v4 offset:40960
    v_mfma_f32_16x16x32_bf16 v[60:63], v[224:227], v[124:127], v[60:63]
    ds_read_b64_tr_b16 v[242:243], v4 offset:41984
    s_waitcnt lgkmcnt(6)
    v_mfma_f32_16x16x32_bf16 v[64:67], v[228:231], v[120:123], v[64:67]
    ds_read_b64_tr_b16 v[244:245], v5 offset:40992
    v_mfma_f32_16x16x32_bf16 v[68:71], v[228:231], v[124:127], v[68:71]
    ds_read_b64_tr_b16 v[246:247], v5 offset:42016
    s_mov_b32 s23, 0xa000
    buffer_load_dwordx4 v[108:111], v7, s[8:11], s23 offen offset:0 sc1
    s_waitcnt lgkmcnt(6)
    v_mfma_f32_16x16x32_bf16 v[72:75], v[232:235], v[120:123], v[72:75]
    ds_read_b64_tr_b16 v[224:225], v4 offset:41216
    v_mfma_f32_16x16x32_bf16 v[76:79], v[232:235], v[124:127], v[76:79]
    ds_read_b64_tr_b16 v[226:227], v4 offset:42240
    s_waitcnt lgkmcnt(6)
    v_mfma_f32_16x16x32_bf16 v[80:83], v[236:239], v[120:123], v[80:83]
    ds_read_b64_tr_b16 v[228:229], v5 offset:41248
    v_mfma_f32_16x16x32_bf16 v[84:87], v[236:239], v[124:127], v[84:87]
    ds_read_b64_tr_b16 v[230:231], v5 offset:42272
    s_waitcnt vmcnt(11) lgkmcnt(6)
    v_mfma_f32_16x16x32_bf16 v[24:27], v[240:243], v[128:131], v[24:27]
    ds_read_b64_tr_b16 v[232:233], v4 offset:41472
    s_waitcnt vmcnt(9)
    v_mfma_f32_16x16x32_bf16 v[28:31], v[240:243], v[132:135], v[28:31]
    ds_read_b64_tr_b16 v[234:235], v4 offset:42496
    s_waitcnt lgkmcnt(6)
    v_mfma_f32_16x16x32_bf16 v[32:35], v[244:247], v[128:131], v[32:35]
    ds_read_b64_tr_b16 v[236:237], v5 offset:41504
    v_mfma_f32_16x16x32_bf16 v[36:39], v[244:247], v[132:135], v[36:39]
    ds_read_b64_tr_b16 v[238:239], v5 offset:42528
    s_mov_b32 s23, 0x2000
    buffer_load_dwordx4 v[112:115], v7, s[8:11], s23 offen offset:1024 sc1
    s_waitcnt lgkmcnt(6)
    v_mfma_f32_16x16x32_bf16 v[40:43], v[224:227], v[128:131], v[40:43]
    ds_read_b64_tr_b16 v[240:241], v4 offset:41728
    v_mfma_f32_16x16x32_bf16 v[44:47], v[224:227], v[132:135], v[44:47]
    ds_read_b64_tr_b16 v[242:243], v4 offset:42752
    s_waitcnt lgkmcnt(6)
    v_mfma_f32_16x16x32_bf16 v[48:51], v[228:231], v[128:131], v[48:51]
    ds_read_b64_tr_b16 v[244:245], v5 offset:41760
    v_mfma_f32_16x16x32_bf16 v[52:55], v[228:231], v[132:135], v[52:55]
    ds_read_b64_tr_b16 v[246:247], v5 offset:42784
    s_waitcnt lgkmcnt(6)
    v_mfma_f32_16x16x32_bf16 v[56:59], v[232:235], v[128:131], v[56:59]
    v_mfma_f32_16x16x32_bf16 v[60:63], v[232:235], v[132:135], v[60:63]
    s_waitcnt vmcnt(9)
    s_barrier
    ds_read_b64_tr_b16 v[224:225], v4 offset:49152
    ds_read_b64_tr_b16 v[226:227], v4 offset:50176
    s_waitcnt lgkmcnt(6)
    v_mfma_f32_16x16x32_bf16 v[64:67], v[236:239], v[128:131], v[64:67]
    ds_read_b64_tr_b16 v[228:229], v5 offset:49184
    v_mfma_f32_16x16x32_bf16 v[68:71], v[236:239], v[132:135], v[68:71]
    s_add_u32 s22, s19, 0x280000
    s_add_u32 m0, s20, 0x4000
    s_nop 0
    buffer_load_dwordx4 v3, s[4:7], s22 offen lds
    ds_read_b64_tr_b16 v[230:231], v5 offset:50208
    s_mov_b32 s23, 0xa000
    buffer_load_dwordx4 v[116:119], v7, s[8:11], s23 offen offset:1024 sc1
    s_waitcnt lgkmcnt(6)
    v_mfma_f32_16x16x32_bf16 v[72:75], v[240:243], v[128:131], v[72:75]
    ds_read_b64_tr_b16 v[232:233], v4 offset:49408
    v_mfma_f32_16x16x32_bf16 v[76:79], v[240:243], v[132:135], v[76:79]
    ds_read_b64_tr_b16 v[234:235], v4 offset:50432
    s_waitcnt lgkmcnt(6)
    v_mfma_f32_16x16x32_bf16 v[80:83], v[244:247], v[128:131], v[80:83]
    ds_read_b64_tr_b16 v[236:237], v5 offset:49440
    v_mfma_f32_16x16x32_bf16 v[84:87], v[244:247], v[132:135], v[84:87]
    ds_read_b64_tr_b16 v[238:239], v5 offset:50464
    s_waitcnt vmcnt(10) lgkmcnt(6)
    v_mfma_f32_16x16x32_bf16 v[24:27], v[224:227], v[88:91], v[24:27]
    ds_read_b64_tr_b16 v[240:241], v4 offset:49664
    s_waitcnt vmcnt(9)
    v_mfma_f32_16x16x32_bf16 v[28:31], v[224:227], v[92:95], v[28:31]
    ds_read_b64_tr_b16 v[242:243], v4 offset:50688
    s_waitcnt lgkmcnt(6)
    v_mfma_f32_16x16x32_bf16 v[32:35], v[228:231], v[88:91], v[32:35]
    ds_read_b64_tr_b16 v[244:245], v5 offset:49696
    v_mfma_f32_16x16x32_bf16 v[36:39], v[228:231], v[92:95], v[36:39]
    s_add_u32 s22, s19, 0x288000
    s_add_u32 m0, s20, 0x4400
    s_nop 0
    buffer_load_dwordx4 v3, s[4:7], s22 offen lds
    ds_read_b64_tr_b16 v[246:247], v5 offset:50720
    s_mov_b32 s23, 0x2800
    buffer_load_dwordx4 v[120:123], v7, s[8:11], s23 offen offset:0 sc1
    s_waitcnt lgkmcnt(6)
    v_mfma_f32_16x16x32_bf16 v[40:43], v[232:235], v[88:91], v[40:43]
    ds_read_b64_tr_b16 v[224:225], v4 offset:49920
    v_mfma_f32_16x16x32_bf16 v[44:47], v[232:235], v[92:95], v[44:47]
    ds_read_b64_tr_b16 v[226:227], v4 offset:50944
    s_waitcnt lgkmcnt(6)
    v_mfma_f32_16x16x32_bf16 v[48:51], v[236:239], v[88:91], v[48:51]
    ds_read_b64_tr_b16 v[228:229], v5 offset:49952
    v_mfma_f32_16x16x32_bf16 v[52:55], v[236:239], v[92:95], v[52:55]
    ds_read_b64_tr_b16 v[230:231], v5 offset:50976
    s_waitcnt lgkmcnt(6)
    v_mfma_f32_16x16x32_bf16 v[56:59], v[240:243], v[88:91], v[56:59]
    ds_read_b64_tr_b16 v[232:233], v4 offset:57344
    v_mfma_f32_16x16x32_bf16 v[60:63], v[240:243], v[92:95], v[60:63]
    ds_read_b64_tr_b16 v[234:235], v4 offset:58368
    s_waitcnt lgkmcnt(6)
    v_mfma_f32_16x16x32_bf16 v[64:67], v[244:247], v[88:91], v[64:67]
    ds_read_b64_tr_b16 v[236:237], v5 offset:57376
    v_mfma_f32_16x16x32_bf16 v[68:71], v[244:247], v[92:95], v[68:71]
    ds_read_b64_tr_b16 v[238:239], v5 offset:58400
    s_mov_b32 s23, 0xa800
    buffer_load_dwordx4 v[124:127], v7, s[8:11], s23 offen offset:0 sc1
    s_waitcnt lgkmcnt(6)
    v_mfma_f32_16x16x32_bf16 v[72:75], v[224:227], v[88:91], v[72:75]
    ds_read_b64_tr_b16 v[240:241], v4 offset:57600
    v_mfma_f32_16x16x32_bf16 v[76:79], v[224:227], v[92:95], v[76:79]
    ds_read_b64_tr_b16 v[242:243], v4 offset:58624
    s_waitcnt lgkmcnt(6)
    v_mfma_f32_16x16x32_bf16 v[80:83], v[228:231], v[88:91], v[80:83]
    ds_read_b64_tr_b16 v[244:245], v5 offset:57632
    v_mfma_f32_16x16x32_bf16 v[84:87], v[228:231], v[92:95], v[84:87]
    ds_read_b64_tr_b16 v[246:247], v5 offset:58656
    s_waitcnt vmcnt(11) lgkmcnt(6)
    v_mfma_f32_16x16x32_bf16 v[24:27], v[232:235], v[96:99], v[24:27]
    ds_read_b64_tr_b16 v[224:225], v4 offset:57856
    s_waitcnt vmcnt(9)
    v_mfma_f32_16x16x32_bf16 v[28:31], v[232:235], v[100:103], v[28:31]
    ds_read_b64_tr_b16 v[226:227], v4 offset:58880
    s_waitcnt lgkmcnt(6)
    v_mfma_f32_16x16x32_bf16 v[32:35], v[236:239], v[96:99], v[32:35]
    ds_read_b64_tr_b16 v[228:229], v5 offset:57888
    v_mfma_f32_16x16x32_bf16 v[36:39], v[236:239], v[100:103], v[36:39]
    ds_read_b64_tr_b16 v[230:231], v5 offset:58912
    s_mov_b32 s23, 0x2800
    buffer_load_dwordx4 v[128:131], v7, s[8:11], s23 offen offset:1024 sc1
    s_waitcnt lgkmcnt(6)
    v_mfma_f32_16x16x32_bf16 v[40:43], v[240:243], v[96:99], v[40:43]
    ds_read_b64_tr_b16 v[232:233], v4 offset:58112
    v_mfma_f32_16x16x32_bf16 v[44:47], v[240:243], v[100:103], v[44:47]
    ds_read_b64_tr_b16 v[234:235], v4 offset:59136
    s_waitcnt lgkmcnt(6)
    v_mfma_f32_16x16x32_bf16 v[48:51], v[244:247], v[96:99], v[48:51]
    ds_read_b64_tr_b16 v[236:237], v5 offset:58144
    v_mfma_f32_16x16x32_bf16 v[52:55], v[244:247], v[100:103], v[52:55]
    ds_read_b64_tr_b16 v[238:239], v5 offset:59168
    s_waitcnt lgkmcnt(6)
    v_mfma_f32_16x16x32_bf16 v[56:59], v[224:227], v[96:99], v[56:59]
    v_mfma_f32_16x16x32_bf16 v[60:63], v[224:227], v[100:103], v[60:63]
    s_waitcnt vmcnt(9)
    s_barrier
    ds_read_b64_tr_b16 v[240:241], v4 offset:0
    ds_read_b64_tr_b16 v[242:243], v4 offset:1024
    s_waitcnt lgkmcnt(6)
    v_mfma_f32_16x16x32_bf16 v[64:67], v[228:231], v[96:99], v[64:67]
    ds_read_b64_tr_b16 v[244:245], v5 offset:32
    v_mfma_f32_16x16x32_bf16 v[68:71], v[228:231], v[100:103], v[68:71]
    s_add_u32 s22, s19, 0x300000
    s_add_u32 m0, s20, 0x8000
    s_nop 0
    buffer_load_dwordx4 v3, s[4:7], s22 offen lds
    ds_read_b64_tr_b16 v[246:247], v5 offset:1056
    s_mov_b32 s23, 0xa800
    buffer_load_dwordx4 v[132:135], v7, s[8:11], s23 offen offset:1024 sc1
    s_waitcnt lgkmcnt(6)
    v_mfma_f32_16x16x32_bf16 v[72:75], v[232:235], v[96:99], v[72:75]
    ds_read_b64_tr_b16 v[224:225], v4 offset:256
    v_mfma_f32_16x16x32_bf16 v[76:79], v[232:235], v[100:103], v[76:79]
    ds_read_b64_tr_b16 v[226:227], v4 offset:1280
    s_waitcnt lgkmcnt(6)
    v_mfma_f32_16x16x32_bf16 v[80:83], v[236:239], v[96:99], v[80:83]
    ds_read_b64_tr_b16 v[228:229], v5 offset:288
    v_mfma_f32_16x16x32_bf16 v[84:87], v[236:239], v[100:103], v[84:87]
    ds_read_b64_tr_b16 v[230:231], v5 offset:1312
    s_waitcnt vmcnt(10) lgkmcnt(6)
    v_mfma_f32_16x16x32_bf16 v[24:27], v[240:243], v[104:107], v[24:27]
    ds_read_b64_tr_b16 v[232:233], v4 offset:512
    s_waitcnt vmcnt(9)
    v_mfma_f32_16x16x32_bf16 v[28:31], v[240:243], v[108:111], v[28:31]
    ds_read_b64_tr_b16 v[234:235], v4 offset:1536
    s_waitcnt lgkmcnt(6)
    v_mfma_f32_16x16x32_bf16 v[32:35], v[244:247], v[104:107], v[32:35]
    ds_read_b64_tr_b16 v[236:237], v5 offset:544
    v_mfma_f32_16x16x32_bf16 v[36:39], v[244:247], v[108:111], v[36:39]
    s_add_u32 s22, s19, 0x308000
    s_add_u32 m0, s20, 0x8400
    s_nop 0
    buffer_load_dwordx4 v3, s[4:7], s22 offen lds
    ds_read_b64_tr_b16 v[238:239], v5 offset:1568
    s_mov_b32 s23, 0x3000
    buffer_load_dwordx4 v[88:91], v7, s[8:11], s23 offen offset:0 sc1
    s_waitcnt lgkmcnt(6)
    v_mfma_f32_16x16x32_bf16 v[40:43], v[224:227], v[104:107], v[40:43]
    ds_read_b64_tr_b16 v[240:241], v4 offset:768
    v_mfma_f32_16x16x32_bf16 v[44:47], v[224:227], v[108:111], v[44:47]
    ds_read_b64_tr_b16 v[242:243], v4 offset:1792
    s_waitcnt lgkmcnt(6)
    v_mfma_f32_16x16x32_bf16 v[48:51], v[228:231], v[104:107], v[48:51]
    ds_read_b64_tr_b16 v[244:245], v5 offset:800
    v_mfma_f32_16x16x32_bf16 v[52:55], v[228:231], v[108:111], v[52:55]
    ds_read_b64_tr_b16 v[246:247], v5 offset:1824
    s_waitcnt lgkmcnt(6)
    v_mfma_f32_16x16x32_bf16 v[56:59], v[232:235], v[104:107], v[56:59]
    ds_read_b64_tr_b16 v[224:225], v4 offset:8192
    v_mfma_f32_16x16x32_bf16 v[60:63], v[232:235], v[108:111], v[60:63]
    ds_read_b64_tr_b16 v[226:227], v4 offset:9216
    s_waitcnt lgkmcnt(6)
    v_mfma_f32_16x16x32_bf16 v[64:67], v[236:239], v[104:107], v[64:67]
    ds_read_b64_tr_b16 v[228:229], v5 offset:8224
    v_mfma_f32_16x16x32_bf16 v[68:71], v[236:239], v[108:111], v[68:71]
    ds_read_b64_tr_b16 v[230:231], v5 offset:9248
    s_mov_b32 s23, 0xb000
    buffer_load_dwordx4 v[92:95], v7, s[8:11], s23 offen offset:0 sc1
    s_waitcnt lgkmcnt(6)
    v_mfma_f32_16x16x32_bf16 v[72:75], v[240:243], v[104:107], v[72:75]
    ds_read_b64_tr_b16 v[232:233], v4 offset:8448
    v_mfma_f32_16x16x32_bf16 v[76:79], v[240:243], v[108:111], v[76:79]
    ds_read_b64_tr_b16 v[234:235], v4 offset:9472
    s_waitcnt lgkmcnt(6)
    v_mfma_f32_16x16x32_bf16 v[80:83], v[244:247], v[104:107], v[80:83]
    ds_read_b64_tr_b16 v[236:237], v5 offset:8480
    v_mfma_f32_16x16x32_bf16 v[84:87], v[244:247], v[108:111], v[84:87]
    ds_read_b64_tr_b16 v[238:239], v5 offset:9504
    s_waitcnt vmcnt(11) lgkmcnt(6)
    v_mfma_f32_16x16x32_bf16 v[24:27], v[224:227], v[112:115], v[24:27]
    ds_read_b64_tr_b16 v[240:241], v4 offset:8704
    s_waitcnt vmcnt(9)
    v_mfma_f32_16x16x32_bf16 v[28:31], v[224:227], v[116:119], v[28:31]
    ds_read_b64_tr_b16 v[242:243], v4 offset:9728
    s_waitcnt lgkmcnt(6)
    v_mfma_f32_16x16x32_bf16 v[32:35], v[228:231], v[112:115], v[32:35]
    ds_read_b64_tr_b16 v[244:245], v5 offset:8736
    v_mfma_f32_16x16x32_bf16 v[36:39], v[228:231], v[116:119], v[36:39]
    ds_read_b64_tr_b16 v[246:247], v5 offset:9760
    s_mov_b32 s23, 0x3000
    buffer_load_dwordx4 v[96:99], v7, s[8:11], s23 offen offset:1024 sc1
    s_waitcnt lgkmcnt(6)
    v_mfma_f32_16x16x32_bf16 v[40:43], v[232:235], v[112:115], v[40:43]
    ds_read_b64_tr_b16 v[224:225], v4 offset:8960
    v_mfma_f32_16x16x32_bf16 v[44:47], v[232:235], v[116:119], v[44:47]
    ds_read_b64_tr_b16 v[226:227], v4 offset:9984
    s_waitcnt lgkmcnt(6)
    v_mfma_f32_16x16x32_bf16 v[48:51], v[236:239], v[112:115], v[48:51]
    ds_read_b64_tr_b16 v[228:229], v5 offset:8992
    v_mfma_f32_16x16x32_bf16 v[52:55], v[236:239], v[116:119], v[52:55]
    ds_read_b64_tr_b16 v[230:231], v5 offset:10016
    s_waitcnt lgkmcnt(6)
    v_mfma_f32_16x16x32_bf16 v[56:59], v[240:243], v[112:115], v[56:59]
    v_mfma_f32_16x16x32_bf16 v[60:63], v[240:243], v[116:119], v[60:63]
    s_waitcnt vmcnt(9)
    s_barrier
    ds_read_b64_tr_b16 v[232:233], v4 offset:16384
    ds_read_b64_tr_b16 v[234:235], v4 offset:17408
    s_waitcnt lgkmcnt(6)
    v_mfma_f32_16x16x32_bf16 v[64:67], v[244:247], v[112:115], v[64:67]
    ds_read_b64_tr_b16 v[236:237], v5 offset:16416
    v_mfma_f32_16x16x32_bf16 v[68:71], v[244:247], v[116:119], v[68:71]
    s_add_u32 s22, s19, 0x380000
    s_add_u32 m0, s20, 0xc000
    s_nop 0
    buffer_load_dwordx4 v3, s[4:7], s22 offen lds
    ds_read_b64_tr_b16 v[238:239], v5 offset:17440
    s_mov_b32 s23, 0xb000
    buffer_load_dwordx4 v[100:103], v7, s[8:11], s23 offen offset:1024 sc1
    s_waitcnt lgkmcnt(6)
    v_mfma_f32_16x16x32_bf16 v[72:75], v[224:227], v[112:115], v[72:75]
    ds_read_b64_tr_b16 v[240:241], v4 offset:16640
    v_mfma_f32_16x16x32_bf16 v[76:79], v[224:227], v[116:119], v[76:79]
    ds_read_b64_tr_b16 v[242:243], v4 offset:17664
    s_waitcnt lgkmcnt(6)
    v_mfma_f32_16x16x32_bf16 v[80:83], v[228:231], v[112:115], v[80:83]
    ds_read_b64_tr_b16 v[244:245], v5 offset:16672
    v_mfma_f32_16x16x32_bf16 v[84:87], v[228:231], v[116:119], v[84:87]
    ds_read_b64_tr_b16 v[246:247], v5 offset:17696
    s_waitcnt vmcnt(10) lgkmcnt(6)
    v_mfma_f32_16x16x32_bf16 v[24:27], v[232:235], v[120:123], v[24:27]
    ds_read_b64_tr_b16 v[224:225], v4 offset:16896
    s_waitcnt vmcnt(9)
    v_mfma_f32_16x16x32_bf16 v[28:31], v[232:235], v[124:127], v[28:31]
    ds_read_b64_tr_b16 v[226:227], v4 offset:17920
    s_waitcnt lgkmcnt(6)
    v_mfma_f32_16x16x32_bf16 v[32:35], v[236:239], v[120:123], v[32:35]
    ds_read_b64_tr_b16 v[228:229], v5 offset:16928
    v_mfma_f32_16x16x32_bf16 v[36:39], v[236:239], v[124:127], v[36:39]
    s_add_u32 s22, s19, 0x388000
    s_add_u32 m0, s20, 0xc400
    s_nop 0
    buffer_load_dwordx4 v3, s[4:7], s22 offen lds
    ds_read_b64_tr_b16 v[230:231], v5 offset:17952
    s_mov_b32 s23, 0x3800
    buffer_load_dwordx4 v[104:107], v7, s[8:11], s23 offen offset:0 sc1
    s_waitcnt lgkmcnt(6)
    v_mfma_f32_16x16x32_bf16 v[40:43], v[240:243], v[120:123], v[40:43]
    ds_read_b64_tr_b16 v[232:233], v4 offset:17152
    v_mfma_f32_16x16x32_bf16 v[44:47], v[240:243], v[124:127], v[44:47]
    ds_read_b64_tr_b16 v[234:235], v4 offset:18176
    s_waitcnt lgkmcnt(6)
    v_mfma_f32_16x16x32_bf16 v[48:51], v[244:247], v[120:123], v[48:51]
    ds_read_b64_tr_b16 v[236:237], v5 offset:17184
    v_mfma_f32_16x16x32_bf16 v[52:55], v[244:247], v[124:127], v[52:55]
    ds_read_b64_tr_b16 v[238:239], v5 offset:18208
    s_waitcnt lgkmcnt(6)
    v_mfma_f32_16x16x32_bf16 v[56:59], v[224:227], v[120:123], v[56:59]
    ds_read_b64_tr_b16 v[240:241], v4 offset:24576
    v_mfma_f32_16x16x32_bf16 v[60:63], v[224:227], v[124:127], v[60:63]
    ds_read_b64_tr_b16 v[242:243], v4 offset:25600
    s_waitcnt lgkmcnt(6)
    v_mfma_f32_16x16x32_bf16 v[64:67], v[228:231], v[120:123], v[64:67]
    ds_read_b64_tr_b16 v[244:245], v5 offset:24608
    v_mfma_f32_16x16x32_bf16 v[68:71], v[228:231], v[124:127], v[68:71]
    ds_read_b64_tr_b16 v[246:247], v5 offset:25632
    s_mov_b32 s23, 0xb800
    buffer_load_dwordx4 v[108:111], v7, s[8:11], s23 offen offset:0 sc1
    s_waitcnt lgkmcnt(6)
    v_mfma_f32_16x16x32_bf16 v[72:75], v[232:235], v[120:123], v[72:75]
    ds_read_b64_tr_b16 v[224:225], v4 offset:24832
    v_mfma_f32_16x16x32_bf16 v[76:79], v[232:235], v[124:127], v[76:79]
    ds_read_b64_tr_b16 v[226:227], v4 offset:25856
    s_waitcnt lgkmcnt(6)
    v_mfma_f32_16x16x32_bf16 v[80:83], v[236:239], v[120:123], v[80:83]
    ds_read_b64_tr_b16 v[228:229], v5 offset:24864
    v_mfma_f32_16x16x32_bf16 v[84:87], v[236:239], v[124:127], v[84:87]
    ds_read_b64_tr_b16 v[230:231], v5 offset:25888
    s_waitcnt vmcnt(11) lgkmcnt(6)
    v_mfma_f32_16x16x32_bf16 v[24:27], v[240:243], v[128:131], v[24:27]
    ds_read_b64_tr_b16 v[232:233], v4 offset:25088
    s_waitcnt vmcnt(9)
    v_mfma_f32_16x16x32_bf16 v[28:31], v[240:243], v[132:135], v[28:31]
    ds_read_b64_tr_b16 v[234:235], v4 offset:26112
    s_waitcnt lgkmcnt(6)
    v_mfma_f32_16x16x32_bf16 v[32:35], v[244:247], v[128:131], v[32:35]
    ds_read_b64_tr_b16 v[236:237], v5 offset:25120
    v_mfma_f32_16x16x32_bf16 v[36:39], v[244:247], v[132:135], v[36:39]
    ds_read_b64_tr_b16 v[238:239], v5 offset:26144
    s_mov_b32 s23, 0x3800
    buffer_load_dwordx4 v[112:115], v7, s[8:11], s23 offen offset:1024 sc1
    s_waitcnt lgkmcnt(6)
    v_mfma_f32_16x16x32_bf16 v[40:43], v[224:227], v[128:131], v[40:43]
    ds_read_b64_tr_b16 v[240:241], v4 offset:25344
    v_mfma_f32_16x16x32_bf16 v[44:47], v[224:227], v[132:135], v[44:47]
    ds_read_b64_tr_b16 v[242:243], v4 offset:26368
    s_waitcnt lgkmcnt(6)
    v_mfma_f32_16x16x32_bf16 v[48:51], v[228:231], v[128:131], v[48:51]
    ds_read_b64_tr_b16 v[244:245], v5 offset:25376
    v_mfma_f32_16x16x32_bf16 v[52:55], v[228:231], v[132:135], v[52:55]
    ds_read_b64_tr_b16 v[246:247], v5 offset:26400
    s_waitcnt lgkmcnt(6)
    v_mfma_f32_16x16x32_bf16 v[56:59], v[232:235], v[128:131], v[56:59]
    v_mfma_f32_16x16x32_bf16 v[60:63], v[232:235], v[132:135], v[60:63]
    s_waitcnt vmcnt(9)
    s_barrier
    ds_read_b64_tr_b16 v[224:225], v4 offset:32768
    ds_read_b64_tr_b16 v[226:227], v4 offset:33792
    s_waitcnt lgkmcnt(6)
    v_mfma_f32_16x16x32_bf16 v[64:67], v[236:239], v[128:131], v[64:67]
    ds_read_b64_tr_b16 v[228:229], v5 offset:32800
    v_mfma_f32_16x16x32_bf16 v[68:71], v[236:239], v[132:135], v[68:71]
    s_add_u32 s22, s19, 0x400000
    s_add_u32 m0, s20, 0x0
    s_nop 0
    buffer_load_dwordx4 v3, s[4:7], s22 offen lds
    ds_read_b64_tr_b16 v[230:231], v5 offset:33824
    s_mov_b32 s23, 0xb800
    buffer_load_dwordx4 v[116:119], v7, s[8:11], s23 offen offset:1024 sc1
    s_waitcnt lgkmcnt(6)
    v_mfma_f32_16x16x32_bf16 v[72:75], v[240:243], v[128:131], v[72:75]
    ds_read_b64_tr_b16 v[232:233], v4 offset:33024
    v_mfma_f32_16x16x32_bf16 v[76:79], v[240:243], v[132:135], v[76:79]
    ds_read_b64_tr_b16 v[234:235], v4 offset:34048
    s_waitcnt lgkmcnt(6)
    v_mfma_f32_16x16x32_bf16 v[80:83], v[244:247], v[128:131], v[80:83]
    ds_read_b64_tr_b16 v[236:237], v5 offset:33056
    v_mfma_f32_16x16x32_bf16 v[84:87], v[244:247], v[132:135], v[84:87]
    ds_read_b64_tr_b16 v[238:239], v5 offset:34080
    s_waitcnt vmcnt(10) lgkmcnt(6)
    v_mfma_f32_16x16x32_bf16 v[24:27], v[224:227], v[88:91], v[24:27]
    ds_read_b64_tr_b16 v[240:241], v4 offset:33280
    s_waitcnt vmcnt(9)
    v_mfma_f32_16x16x32_bf16 v[28:31], v[224:227], v[92:95], v[28:31]
    ds_read_b64_tr_b16 v[242:243], v4 offset:34304
    s_waitcnt lgkmcnt(6)
    v_mfma_f32_16x16x32_bf16 v[32:35], v[228:231], v[88:91], v[32:35]
    ds_read_b64_tr_b16 v[244:245], v5 offset:33312
    v_mfma_f32_16x16x32_bf16 v[36:39], v[228:231], v[92:95], v[36:39]
    s_add_u32 s22, s19, 0x408000
    s_add_u32 m0, s20, 0x400
    s_nop 0
    buffer_load_dwordx4 v3, s[4:7], s22 offen lds
    ds_read_b64_tr_b16 v[246:247], v5 offset:34336
    s_mov_b32 s23, 0x4000
    buffer_load_dwordx4 v[120:123], v7, s[8:11], s23 offen offset:0 sc1
    s_waitcnt lgkmcnt(6)
    v_mfma_f32_16x16x32_bf16 v[40:43], v[232:235], v[88:91], v[40:43]
    ds_read_b64_tr_b16 v[224:225], v4 offset:33536
    v_mfma_f32_16x16x32_bf16 v[44:47], v[232:235], v[92:95], v[44:47]
    ds_read_b64_tr_b16 v[226:227], v4 offset:34560
    s_waitcnt lgkmcnt(6)
    v_mfma_f32_16x16x32_bf16 v[48:51], v[236:239], v[88:91], v[48:51]
    ds_read_b64_tr_b16 v[228:229], v5 offset:33568
    v_mfma_f32_16x16x32_bf16 v[52:55], v[236:239], v[92:95], v[52:55]
    ds_read_b64_tr_b16 v[230:231], v5 offset:34592
    s_waitcnt lgkmcnt(6)
    v_mfma_f32_16x16x32_bf16 v[56:59], v[240:243], v[88:91], v[56:59]
    ds_read_b64_tr_b16 v[232:233], v4 offset:40960
    v_mfma_f32_16x16x32_bf16 v[60:63], v[240:243], v[92:95], v[60:63]
    ds_read_b64_tr_b16 v[234:235], v4 offset:41984
    s_waitcnt lgkmcnt(6)
    v_mfma_f32_16x16x32_bf16 v[64:67], v[244:247], v[88:91], v[64:67]
    ds_read_b64_tr_b16 v[236:237], v5 offset:40992
    v_mfma_f32_16x16x32_bf16 v[68:71], v[244:247], v[92:95], v[68:71]
    ds_read_b64_tr_b16 v[238:239], v5 offset:42016
    s_mov_b32 s23, 0xc000
    buffer_load_dwordx4 v[124:127], v7, s[8:11], s23 offen offset:0 sc1
    s_waitcnt lgkmcnt(6)
    v_mfma_f32_16x16x32_bf16 v[72:75], v[224:227], v[88:91], v[72:75]
    ds_read_b64_tr_b16 v[240:241], v4 offset:41216
    v_lshrrev_b32 v21, 4, v1
    v_lshlrev_b32 v21, 9, v21
    v_and_b32 v20, 15, v1
    v_lshl_add_u32 v21, v20, 4, v21
    s_lshr_b32 s18, s12, 3
    s_lshl_b32 s18, s18, 11
    s_add_u32 s18, s18, 0x528100
    buffer_load_dwordx4 v[12:15], v21, s[8:11], s18 offen sc1
    v_mfma_f32_16x16x32_bf16 v[76:79], v[224:227], v[92:95], v[76:79]
    ds_read_b64_tr_b16 v[242:243], v4 offset:42240
    s_waitcnt lgkmcnt(6)
    v_mfma_f32_16x16x32_bf16 v[80:83], v[228:231], v[88:91], v[80:83]
    ds_read_b64_tr_b16 v[244:245], v5 offset:41248
    v_mfma_f32_16x16x32_bf16 v[84:87], v[228:231], v[92:95], v[84:87]
    ds_read_b64_tr_b16 v[246:247], v5 offset:42272
    s_waitcnt vmcnt(12) lgkmcnt(6)
    v_mfma_f32_16x16x32_bf16 v[24:27], v[232:235], v[96:99], v[24:27]
    ds_read_b64_tr_b16 v[224:225], v4 offset:41472
    s_waitcnt vmcnt(10)
    v_mfma_f32_16x16x32_bf16 v[28:31], v[232:235], v[100:103], v[28:31]
    ds_read_b64_tr_b16 v[226:227], v4 offset:42496
    s_waitcnt lgkmcnt(6)
    v_mfma_f32_16x16x32_bf16 v[32:35], v[236:239], v[96:99], v[32:35]
    ds_read_b64_tr_b16 v[228:229], v5 offset:41504
    v_mfma_f32_16x16x32_bf16 v[36:39], v[236:239], v[100:103], v[36:39]
    ds_read_b64_tr_b16 v[230:231], v5 offset:42528
    s_mov_b32 s23, 0x4000
    buffer_load_dwordx4 v[128:131], v7, s[8:11], s23 offen offset:1024 sc1
    s_waitcnt lgkmcnt(6)
    v_mfma_f32_16x16x32_bf16 v[40:43], v[240:243], v[96:99], v[40:43]
    ds_read_b64_tr_b16 v[232:233], v4 offset:41728
    v_mfma_f32_16x16x32_bf16 v[44:47], v[240:243], v[100:103], v[44:47]
    ds_read_b64_tr_b16 v[234:235], v4 offset:42752
    s_waitcnt lgkmcnt(6)
    v_mfma_f32_16x16x32_bf16 v[48:51], v[244:247], v[96:99], v[48:51]
    ds_read_b64_tr_b16 v[236:237], v5 offset:41760
    v_mfma_f32_16x16x32_bf16 v[52:55], v[244:247], v[100:103], v[52:55]
    ds_read_b64_tr_b16 v[238:239], v5 offset:42784
    s_waitcnt lgkmcnt(6)
    v_mfma_f32_16x16x32_bf16 v[56:59], v[224:227], v[96:99], v[56:59]
    v_mfma_f32_16x16x32_bf16 v[60:63], v[224:227], v[100:103], v[60:63]
    s_waitcnt vmcnt(10)
    s_barrier
    ds_read_b64_tr_b16 v[240:241], v4 offset:49152
    ds_read_b64_tr_b16 v[242:243], v4 offset:50176
    s_waitcnt lgkmcnt(6)
    v_mfma_f32_16x16x32_bf16 v[64:67], v[228:231], v[96:99], v[64:67]
    ds_read_b64_tr_b16 v[244:245], v5 offset:49184
    v_mfma_f32_16x16x32_bf16 v[68:71], v[228:231], v[100:103], v[68:71]
    s_add_u32 s22, s19, 0x480000
    s_add_u32 m0, s20, 0x4000
    s_nop 0
    buffer_load_dwordx4 v3, s[4:7], s22 offen lds
    ds_read_b64_tr_b16 v[246:247], v5 offset:50208
    s_mov_b32 s23, 0xc000
    buffer_load_dwordx4 v[132:135], v7, s[8:11], s23 offen offset:1024 sc1
    s_waitcnt lgkmcnt(6)
    v_mfma_f32_16x16x32_bf16 v[72:75], v[232:235], v[96:99], v[72:75]
    ds_read_b64_tr_b16 v[224:225], v4 offset:49408
    v_mfma_f32_16x16x32_bf16 v[76:79], v[232:235], v[100:103], v[76:79]
    ds_read_b64_tr_b16 v[226:227], v4 offset:50432
    s_waitcnt lgkmcnt(6)
    v_mfma_f32_16x16x32_bf16 v[80:83], v[236:239], v[96:99], v[80:83]
    ds_read_b64_tr_b16 v[228:229], v5 offset:49440
    v_mfma_f32_16x16x32_bf16 v[84:87], v[236:239], v[100:103], v[84:87]
    ds_read_b64_tr_b16 v[230:231], v5 offset:50464
    s_waitcnt vmcnt(11) lgkmcnt(6)
    v_mfma_f32_16x16x32_bf16 v[24:27], v[240:243], v[104:107], v[24:27]
    ds_read_b64_tr_b16 v[232:233], v4 offset:49664
    s_waitcnt vmcnt(10)
    v_mfma_f32_16x16x32_bf16 v[28:31], v[240:243], v[108:111], v[28:31]
    ds_read_b64_tr_b16 v[234:235], v4 offset:50688
    s_waitcnt lgkmcnt(6)
    v_mfma_f32_16x16x32_bf16 v[32:35], v[244:247], v[104:107], v[32:35]
    ds_read_b64_tr_b16 v[236:237], v5 offset:49696
    v_mfma_f32_16x16x32_bf16 v[36:39], v[244:247], v[108:111], v[36:39]
    s_add_u32 s22, s19, 0x488000
    s_add_u32 m0, s20, 0x4400
    s_nop 0
    buffer_load_dwordx4 v3, s[4:7], s22 offen lds
    ds_read_b64_tr_b16 v[238:239], v5 offset:50720
    s_mov_b32 s23, 0x4800
    buffer_load_dwordx4 v[88:91], v7, s[8:11], s23 offen offset:0 sc1
    s_waitcnt lgkmcnt(6)
    v_mfma_f32_16x16x32_bf16 v[40:43], v[224:227], v[104:107], v[40:43]
    ds_read_b64_tr_b16 v[240:241], v4 offset:49920
    v_mfma_f32_16x16x32_bf16 v[44:47], v[224:227], v[108:111], v[44:47]
    ds_read_b64_tr_b16 v[242:243], v4 offset:50944
    s_waitcnt lgkmcnt(6)
    v_mfma_f32_16x16x32_bf16 v[48:51], v[228:231], v[104:107], v[48:51]
    ds_read_b64_tr_b16 v[244:245], v5 offset:49952
    v_mfma_f32_16x16x32_bf16 v[52:55], v[228:231], v[108:111], v[52:55]
    ds_read_b64_tr_b16 v[246:247], v5 offset:50976
    s_waitcnt lgkmcnt(6)
    v_mfma_f32_16x16x32_bf16 v[56:59], v[232:235], v[104:107], v[56:59]
    ds_read_b64_tr_b16 v[224:225], v4 offset:57344
    v_mfma_f32_16x16x32_bf16 v[60:63], v[232:235], v[108:111], v[60:63]
    ds_read_b64_tr_b16 v[226:227], v4 offset:58368
    s_waitcnt lgkmcnt(6)
    v_mfma_f32_16x16x32_bf16 v[64:67], v[236:239], v[104:107], v[64:67]
    ds_read_b64_tr_b16 v[228:229], v5 offset:57376
    v_mfma_f32_16x16x32_bf16 v[68:71], v[236:239], v[108:111], v[68:71]
    ds_read_b64_tr_b16 v[230:231], v5 offset:58400
    s_mov_b32 s23, 0xc800
    buffer_load_dwordx4 v[92:95], v7, s[8:11], s23 offen offset:0 sc1
    s_waitcnt lgkmcnt(6)
    v_mfma_f32_16x16x32_bf16 v[72:75], v[240:243], v[104:107], v[72:75]
    ds_read_b64_tr_b16 v[232:233], v4 offset:57600
    v_mfma_f32_16x16x32_bf16 v[76:79], v[240:243], v[108:111], v[76:79]
    ds_read_b64_tr_b16 v[234:235], v4 offset:58624
    s_waitcnt lgkmcnt(6)
    v_mfma_f32_16x16x32_bf16 v[80:83], v[244:247], v[104:107], v[80:83]
    ds_read_b64_tr_b16 v[236:237], v5 offset:57632
    v_mfma_f32_16x16x32_bf16 v[84:87], v[244:247], v[108:111], v[84:87]
    ds_read_b64_tr_b16 v[238:239], v5 offset:58656
    s_waitcnt vmcnt(12) lgkmcnt(6)
    v_mfma_f32_16x16x32_bf16 v[24:27], v[224:227], v[112:115], v[24:27]
    ds_read_b64_tr_b16 v[240:241], v4 offset:57856
    s_waitcnt vmcnt(10)
    v_mfma_f32_16x16x32_bf16 v[28:31], v[224:227], v[116:119], v[28:31]
    ds_read_b64_tr_b16 v[242:243], v4 offset:58880
    s_waitcnt lgkmcnt(6)
    v_mfma_f32_16x16x32_bf16 v[32:35], v[228:231], v[112:115], v[32:35]
    ds_read_b64_tr_b16 v[244:245], v5 offset:57888
    v_mfma_f32_16x16x32_bf16 v[36:39], v[228:231], v[116:119], v[36:39]
    ds_read_b64_tr_b16 v[246:247], v5 offset:58912
    s_mov_b32 s23, 0x4800
    buffer_load_dwordx4 v[96:99], v7, s[8:11], s23 offen offset:1024 sc1
    s_waitcnt lgkmcnt(6)
    v_mfma_f32_16x16x32_bf16 v[40:43], v[232:235], v[112:115], v[40:43]
    ds_read_b64_tr_b16 v[224:225], v4 offset:58112
    v_mfma_f32_16x16x32_bf16 v[44:47], v[232:235], v[116:119], v[44:47]
    ds_read_b64_tr_b16 v[226:227], v4 offset:59136
    s_waitcnt lgkmcnt(6)
    v_mfma_f32_16x16x32_bf16 v[48:51], v[236:239], v[112:115], v[48:51]
    ds_read_b64_tr_b16 v[228:229], v5 offset:58144
    v_mfma_f32_16x16x32_bf16 v[52:55], v[236:239], v[116:119], v[52:55]
    ds_read_b64_tr_b16 v[230:231], v5 offset:59168
    s_waitcnt lgkmcnt(6)
    v_mfma_f32_16x16x32_bf16 v[56:59], v[240:243], v[112:115], v[56:59]
    v_mfma_f32_16x16x32_bf16 v[60:63], v[240:243], v[116:119], v[60:63]
    s_waitcnt vmcnt(10)
    s_barrier
    ds_read_b64_tr_b16 v[232:233], v4 offset:0
    ds_read_b64_tr_b16 v[234:235], v4 offset:1024
    s_waitcnt lgkmcnt(6)
    v_mfma_f32_16x16x32_bf16 v[64:67], v[244:247], v[112:115], v[64:67]
    ds_read_b64_tr_b16 v[236:237], v5 offset:32
    v_mfma_f32_16x16x32_bf16 v[68:71], v[244:247], v[116:119], v[68:71]
    s_add_u32 s22, s19, 0x500000
    s_add_u32 m0, s20, 0x8000
    s_nop 0
    buffer_load_dwordx4 v3, s[4:7], s22 offen lds
    ds_read_b64_tr_b16 v[238:239], v5 offset:1056
    s_mov_b32 s23, 0xc800
    buffer_load_dwordx4 v[100:103], v7, s[8:11], s23 offen offset:1024 sc1
    s_waitcnt lgkmcnt(6)
    v_mfma_f32_16x16x32_bf16 v[72:75], v[224:227], v[112:115], v[72:75]
    ds_read_b64_tr_b16 v[240:241], v4 offset:256
    v_mfma_f32_16x16x32_bf16 v[76:79], v[224:227], v[116:119], v[76:79]
    ds_read_b64_tr_b16 v[242:243], v4 offset:1280
    s_waitcnt lgkmcnt(6)
    v_mfma_f32_16x16x32_bf16 v[80:83], v[228:231], v[112:115], v[80:83]
    ds_read_b64_tr_b16 v[244:245], v5 offset:288
    v_mfma_f32_16x16x32_bf16 v[84:87], v[228:231], v[116:119], v[84:87]
    ds_read_b64_tr_b16 v[246:247], v5 offset:1312
    s_waitcnt vmcnt(11) lgkmcnt(6)
    v_mfma_f32_16x16x32_bf16 v[24:27], v[232:235], v[120:123], v[24:27]
    ds_read_b64_tr_b16 v[224:225], v4 offset:512
    s_waitcnt vmcnt(10)
    v_mfma_f32_16x16x32_bf16 v[28:31], v[232:235], v[124:127], v[28:31]
    ds_read_b64_tr_b16 v[226:227], v4 offset:1536
    s_waitcnt lgkmcnt(6)
    v_mfma_f32_16x16x32_bf16 v[32:35], v[236:239], v[120:123], v[32:35]
    ds_read_b64_tr_b16 v[228:229], v5 offset:544
    v_mfma_f32_16x16x32_bf16 v[36:39], v[236:239], v[124:127], v[36:39]
    s_add_u32 s22, s19, 0x508000
    s_add_u32 m0, s20, 0x8400
    s_nop 0
    buffer_load_dwordx4 v3, s[4:7], s22 offen lds
    ds_read_b64_tr_b16 v[230:231], v5 offset:1568
    s_mov_b32 s23, 0x5000
    buffer_load_dwordx4 v[104:107], v7, s[8:11], s23 offen offset:0 sc1
    s_waitcnt lgkmcnt(6)
    v_mfma_f32_16x16x32_bf16 v[40:43], v[240:243], v[120:123], v[40:43]
    ds_read_b64_tr_b16 v[232:233], v4 offset:768
    v_mfma_f32_16x16x32_bf16 v[44:47], v[240:243], v[124:127], v[44:47]
    ds_read_b64_tr_b16 v[234:235], v4 offset:1792
    s_waitcnt lgkmcnt(6)
    v_mfma_f32_16x16x32_bf16 v[48:51], v[244:247], v[120:123], v[48:51]
    ds_read_b64_tr_b16 v[236:237], v5 offset:800
    v_mfma_f32_16x16x32_bf16 v[52:55], v[244:247], v[124:127], v[52:55]
    ds_read_b64_tr_b16 v[238:239], v5 offset:1824
    s_waitcnt lgkmcnt(6)
    v_mfma_f32_16x16x32_bf16 v[56:59], v[224:227], v[120:123], v[56:59]
    ds_read_b64_tr_b16 v[240:241], v4 offset:8192
    v_mfma_f32_16x16x32_bf16 v[60:63], v[224:227], v[124:127], v[60:63]
    ds_read_b64_tr_b16 v[242:243], v4 offset:9216
    s_waitcnt lgkmcnt(6)
    v_mfma_f32_16x16x32_bf16 v[64:67], v[228:231], v[120:123], v[64:67]
    ds_read_b64_tr_b16 v[244:245], v5 offset:8224
    v_mfma_f32_16x16x32_bf16 v[68:71], v[228:231], v[124:127], v[68:71]
    ds_read_b64_tr_b16 v[246:247], v5 offset:9248
    s_mov_b32 s23, 0xd000
    buffer_load_dwordx4 v[108:111], v7, s[8:11], s23 offen offset:0 sc1
    s_waitcnt lgkmcnt(6)
    v_mfma_f32_16x16x32_bf16 v[72:75], v[232:235], v[120:123], v[72:75]
    ds_read_b64_tr_b16 v[224:225], v4 offset:8448
    v_mfma_f32_16x16x32_bf16 v[76:79], v[232:235], v[124:127], v[76:79]
    ds_read_b64_tr_b16 v[226:227], v4 offset:9472
    s_waitcnt lgkmcnt(6)
    v_mfma_f32_16x16x32_bf16 v[80:83], v[236:239], v[120:123], v[80:83]
    ds_read_b64_tr_b16 v[228:229], v5 offset:8480
    v_mfma_f32_16x16x32_bf16 v[84:87], v[236:239], v[124:127], v[84:87]
    ds_read_b64_tr_b16 v[230:231], v5 offset:9504
    s_waitcnt vmcnt(11) lgkmcnt(6)
    v_mfma_f32_16x16x32_bf16 v[24:27], v[240:243], v[128:131], v[24:27]
    ds_read_b64_tr_b16 v[232:233], v4 offset:8704
    s_waitcnt vmcnt(9)
    v_mfma_f32_16x16x32_bf16 v[28:31], v[240:243], v[132:135], v[28:31]
    ds_read_b64_tr_b16 v[234:235], v4 offset:9728
    s_waitcnt lgkmcnt(6)
    v_mfma_f32_16x16x32_bf16 v[32:35], v[244:247], v[128:131], v[32:35]
    ds_read_b64_tr_b16 v[236:237], v5 offset:8736
    v_mfma_f32_16x16x32_bf16 v[36:39], v[244:247], v[132:135], v[36:39]
    ds_read_b64_tr_b16 v[238:239], v5 offset:9760
    s_mov_b32 s23, 0x5000
    buffer_load_dwordx4 v[112:115], v7, s[8:11], s23 offen offset:1024 sc1
    s_waitcnt lgkmcnt(6)
    v_mfma_f32_16x16x32_bf16 v[40:43], v[224:227], v[128:131], v[40:43]
    ds_read_b64_tr_b16 v[240:241], v4 offset:8960
    v_mfma_f32_16x16x32_bf16 v[44:47], v[224:227], v[132:135], v[44:47]
    ds_read_b64_tr_b16 v[242:243], v4 offset:9984
    s_waitcnt lgkmcnt(6)
    v_mfma_f32_16x16x32_bf16 v[48:51], v[228:231], v[128:131], v[48:51]
    ds_read_b64_tr_b16 v[244:245], v5 offset:8992
    v_mfma_f32_16x16x32_bf16 v[52:55], v[228:231], v[132:135], v[52:55]
    ds_read_b64_tr_b16 v[246:247], v5 offset:10016
    s_waitcnt lgkmcnt(6)
    v_mfma_f32_16x16x32_bf16 v[56:59], v[232:235], v[128:131], v[56:59]
    v_mfma_f32_16x16x32_bf16 v[60:63], v[232:235], v[132:135], v[60:63]
    s_waitcnt vmcnt(9)
    s_barrier
    ds_read_b64_tr_b16 v[224:225], v4 offset:16384
    ds_read_b64_tr_b16 v[226:227], v4 offset:17408
    s_waitcnt lgkmcnt(6)
    v_mfma_f32_16x16x32_bf16 v[64:67], v[236:239], v[128:131], v[64:67]
    ds_read_b64_tr_b16 v[228:229], v5 offset:16416
    v_mfma_f32_16x16x32_bf16 v[68:71], v[236:239], v[132:135], v[68:71]
    s_add_u32 s22, s19, 0x580000
    s_add_u32 m0, s20, 0xc000
    s_nop 0
    buffer_load_dwordx4 v3, s[4:7], s22 offen lds
    ds_read_b64_tr_b16 v[230:231], v5 offset:17440
    s_mov_b32 s23, 0xd000
    buffer_load_dwordx4 v[116:119], v7, s[8:11], s23 offen offset:1024 sc1
    s_waitcnt lgkmcnt(6)
    v_mfma_f32_16x16x32_bf16 v[72:75], v[240:243], v[128:131], v[72:75]
    ds_read_b64_tr_b16 v[232:233], v4 offset:16640
    v_mfma_f32_16x16x32_bf16 v[76:79], v[240:243], v[132:135], v[76:79]
    ds_read_b64_tr_b16 v[234:235], v4 offset:17664
    s_waitcnt lgkmcnt(6)
    v_mfma_f32_16x16x32_bf16 v[80:83], v[244:247], v[128:131], v[80:83]
    ds_read_b64_tr_b16 v[236:237], v5 offset:16672
    v_mfma_f32_16x16x32_bf16 v[84:87], v[244:247], v[132:135], v[84:87]
    ds_read_b64_tr_b16 v[238:239], v5 offset:17696
    s_waitcnt vmcnt(10) lgkmcnt(6)
    v_mfma_f32_16x16x32_bf16 v[24:27], v[224:227], v[88:91], v[24:27]
    ds_read_b64_tr_b16 v[240:241], v4 offset:16896
    s_waitcnt vmcnt(9)
    v_mfma_f32_16x16x32_bf16 v[28:31], v[224:227], v[92:95], v[28:31]
    ds_read_b64_tr_b16 v[242:243], v4 offset:17920
    s_waitcnt lgkmcnt(6)
    v_mfma_f32_16x16x32_bf16 v[32:35], v[228:231], v[88:91], v[32:35]
    ds_read_b64_tr_b16 v[244:245], v5 offset:16928
    v_mfma_f32_16x16x32_bf16 v[36:39], v[228:231], v[92:95], v[36:39]
    s_add_u32 s22, s19, 0x588000
    s_add_u32 m0, s20, 0xc400
    s_nop 0
    buffer_load_dwordx4 v3, s[4:7], s22 offen lds
    ds_read_b64_tr_b16 v[246:247], v5 offset:17952
    s_mov_b32 s23, 0x5800
    buffer_load_dwordx4 v[120:123], v7, s[8:11], s23 offen offset:0 sc1
    s_waitcnt lgkmcnt(6)
    v_mfma_f32_16x16x32_bf16 v[40:43], v[232:235], v[88:91], v[40:43]
    ds_read_b64_tr_b16 v[224:225], v4 offset:17152
    v_mfma_f32_16x16x32_bf16 v[44:47], v[232:235], v[92:95], v[44:47]
    ds_read_b64_tr_b16 v[226:227], v4 offset:18176
    s_waitcnt lgkmcnt(6)
    v_mfma_f32_16x16x32_bf16 v[48:51], v[236:239], v[88:91], v[48:51]
    ds_read_b64_tr_b16 v[228:229], v5 offset:17184
    v_mfma_f32_16x16x32_bf16 v[52:55], v[236:239], v[92:95], v[52:55]
    ds_read_b64_tr_b16 v[230:231], v5 offset:18208
    s_waitcnt lgkmcnt(6)
    v_mfma_f32_16x16x32_bf16 v[56:59], v[240:243], v[88:91], v[56:59]
    ds_read_b64_tr_b16 v[232:233], v4 offset:24576
    v_mfma_f32_16x16x32_bf16 v[60:63], v[240:243], v[92:95], v[60:63]
    ds_read_b64_tr_b16 v[234:235], v4 offset:25600
    s_waitcnt lgkmcnt(6)
    v_mfma_f32_16x16x32_bf16 v[64:67], v[244:247], v[88:91], v[64:67]
    ds_read_b64_tr_b16 v[236:237], v5 offset:24608
    v_mfma_f32_16x16x32_bf16 v[68:71], v[244:247], v[92:95], v[68:71]
    ds_read_b64_tr_b16 v[238:239], v5 offset:25632
    s_mov_b32 s23, 0xd800
    buffer_load_dwordx4 v[124:127], v7, s[8:11], s23 offen offset:0 sc1
    s_waitcnt lgkmcnt(6)
    v_mfma_f32_16x16x32_bf16 v[72:75], v[224:227], v[88:91], v[72:75]
    ds_read_b64_tr_b16 v[240:241], v4 offset:24832
    v_xor_b32 v8, s28, v12
    v_xor_b32 v20, s28, v13
    v_or_b32 v8, v8, v20
    v_xor_b32 v20, s28, v14
    v_or_b32 v8, v8, v20
    v_xor_b32 v20, s28, v15
    v_or_b32 v8, v8, v20
    v_cmp_ne_u32 vcc, 0, v8
    s_cbranch_vccnz adaLN_cond__sliding_block_cached__moe_arch_mod__prompt_kernel_kv4r
adaLN_cond__sliding_block_cached__moe_arch_mod__prompt_kernel_kv4b:
    v_mfma_f32_16x16x32_bf16 v[76:79], v[224:227], v[92:95], v[76:79]
    ds_read_b64_tr_b16 v[242:243], v4 offset:25856
    v_mov_b32 v20, 0
    s_mov_b32 s16, 0x564000
    buffer_load_dword v8, v20, s[8:11], s16 offen sc1
    s_waitcnt lgkmcnt(6)
    v_mfma_f32_16x16x32_bf16 v[80:83], v[228:231], v[88:91], v[80:83]
    ds_read_b64_tr_b16 v[244:245], v5 offset:24864
    v_mfma_f32_16x16x32_bf16 v[84:87], v[228:231], v[92:95], v[84:87]
    ds_read_b64_tr_b16 v[246:247], v5 offset:25888
    s_waitcnt vmcnt(12) lgkmcnt(6)
    v_mfma_f32_16x16x32_bf16 v[24:27], v[232:235], v[96:99], v[24:27]
    ds_read_b64_tr_b16 v[224:225], v4 offset:25088
    s_waitcnt vmcnt(10)
    v_mfma_f32_16x16x32_bf16 v[28:31], v[232:235], v[100:103], v[28:31]
    ds_read_b64_tr_b16 v[226:227], v4 offset:26112
    s_waitcnt lgkmcnt(6)
    v_mfma_f32_16x16x32_bf16 v[32:35], v[236:239], v[96:99], v[32:35]
    ds_read_b64_tr_b16 v[228:229], v5 offset:25120
    v_mfma_f32_16x16x32_bf16 v[36:39], v[236:239], v[100:103], v[36:39]
    ds_read_b64_tr_b16 v[230:231], v5 offset:26144
    s_mov_b32 s23, 0x5800
    buffer_load_dwordx4 v[128:131], v7, s[8:11], s23 offen offset:1024 sc1
    s_waitcnt lgkmcnt(6)
    v_mfma_f32_16x16x32_bf16 v[40:43], v[240:243], v[96:99], v[40:43]
    ds_read_b64_tr_b16 v[232:233], v4 offset:25344
    s_mov_b64 s[76:77], s[54:55]
    s_mov_b32 s78, 0xc00000
    s_mov_b32 s79, 0x20000
    v_bfe_u32 v20, v1, 2, 2
    v_lshlrev_b32 v20, 12, v20
    v_add_u32 v6, v3, v20
    s_lshr_b32 s16, s2, 5
    s_lshl_b32 s16, s16, 7
    s_lshl_b32 s17, s3, 3
    s_add_u32 s16, s16, s17
    s_mul_i32 s14, s16, 12288
    s_and_b32 s16, s2, 31
    s_lshl_b32 s16, s16, 8
    s_add_u32 s14, s14, s16
    s_add_u32 s14, s14, 4096
    v_mfma_f32_16x16x32_bf16 v[44:47], v[240:243], v[100:103], v[44:47]
    ds_read_b64_tr_b16 v[234:235], v4 offset:26368
    s_waitcnt lgkmcnt(6)
    v_mfma_f32_16x16x32_bf16 v[48:51], v[244:247], v[96:99], v[48:51]
    ds_read_b64_tr_b16 v[236:237], v5 offset:25376
    v_mfma_f32_16x16x32_bf16 v[52:55], v[244:247], v[100:103], v[52:55]
    ds_read_b64_tr_b16 v[238:239], v5 offset:26400
    s_waitcnt lgkmcnt(6)
    v_mfma_f32_16x16x32_bf16 v[56:59], v[224:227], v[96:99], v[56:59]
    v_mfma_f32_16x16x32_bf16 v[60:63], v[224:227], v[100:103], v[60:63]
    s_waitcnt vmcnt(10)
    s_barrier
    ds_read_b64_tr_b16 v[240:241], v4 offset:32768
    ds_read_b64_tr_b16 v[242:243], v4 offset:33792
    s_waitcnt lgkmcnt(6)
    v_mfma_f32_16x16x32_bf16 v[64:67], v[228:231], v[96:99], v[64:67]
    ds_read_b64_tr_b16 v[244:245], v5 offset:32800
    v_mfma_f32_16x16x32_bf16 v[68:71], v[228:231], v[100:103], v[68:71]
    s_add_u32 s22, s19, 0x600000
    s_add_u32 m0, s20, 0x0
    s_nop 0
    buffer_load_dwordx4 v3, s[4:7], s22 offen lds
    ds_read_b64_tr_b16 v[246:247], v5 offset:33824
    s_mov_b32 s23, 0xd800
    buffer_load_dwordx4 v[132:135], v7, s[8:11], s23 offen offset:1024 sc1
    s_waitcnt lgkmcnt(6)
    v_mfma_f32_16x16x32_bf16 v[72:75], v[232:235], v[96:99], v[72:75]
    ds_read_b64_tr_b16 v[224:225], v4 offset:33024
    v_mfma_f32_16x16x32_bf16 v[76:79], v[232:235], v[100:103], v[76:79]
    ds_read_b64_tr_b16 v[226:227], v4 offset:34048
    s_waitcnt lgkmcnt(6)
    v_mfma_f32_16x16x32_bf16 v[80:83], v[236:239], v[96:99], v[80:83]
    ds_read_b64_tr_b16 v[228:229], v5 offset:33056
    v_mfma_f32_16x16x32_bf16 v[84:87], v[236:239], v[100:103], v[84:87]
    ds_read_b64_tr_b16 v[230:231], v5 offset:34080
    s_waitcnt vmcnt(11) lgkmcnt(6)
    v_mfma_f32_16x16x32_bf16 v[24:27], v[240:243], v[104:107], v[24:27]
    ds_read_b64_tr_b16 v[232:233], v4 offset:33280
    s_waitcnt vmcnt(10)
    v_mfma_f32_16x16x32_bf16 v[28:31], v[240:243], v[108:111], v[28:31]
    ds_read_b64_tr_b16 v[234:235], v4 offset:34304
    s_waitcnt lgkmcnt(6)
    v_mfma_f32_16x16x32_bf16 v[32:35], v[244:247], v[104:107], v[32:35]
    ds_read_b64_tr_b16 v[236:237], v5 offset:33312
    v_mfma_f32_16x16x32_bf16 v[36:39], v[244:247], v[108:111], v[36:39]
    s_add_u32 s22, s19, 0x608000
    s_add_u32 m0, s20, 0x400
    s_nop 0
    buffer_load_dwordx4 v3, s[4:7], s22 offen lds
    ds_read_b64_tr_b16 v[238:239], v5 offset:34336
    s_mov_b32 s23, 0x6000
    buffer_load_dwordx4 v[88:91], v7, s[8:11], s23 offen offset:0 sc1
    s_waitcnt lgkmcnt(6)
    v_mfma_f32_16x16x32_bf16 v[40:43], v[224:227], v[104:107], v[40:43]
    ds_read_b64_tr_b16 v[240:241], v4 offset:33536
    v_mfma_f32_16x16x32_bf16 v[44:47], v[224:227], v[108:111], v[44:47]
    ds_read_b64_tr_b16 v[242:243], v4 offset:34560
    s_waitcnt lgkmcnt(6)
    v_mfma_f32_16x16x32_bf16 v[48:51], v[228:231], v[104:107], v[48:51]
    ds_read_b64_tr_b16 v[244:245], v5 offset:33568
    v_mfma_f32_16x16x32_bf16 v[52:55], v[228:231], v[108:111], v[52:55]
    ds_read_b64_tr_b16 v[246:247], v5 offset:34592
    s_waitcnt lgkmcnt(6)
    v_mfma_f32_16x16x32_bf16 v[56:59], v[232:235], v[104:107], v[56:59]
    ds_read_b64_tr_b16 v[224:225], v4 offset:40960
    v_mfma_f32_16x16x32_bf16 v[60:63], v[232:235], v[108:111], v[60:63]
    ds_read_b64_tr_b16 v[226:227], v4 offset:41984
    s_waitcnt lgkmcnt(6)
    v_mfma_f32_16x16x32_bf16 v[64:67], v[236:239], v[104:107], v[64:67]
    ds_read_b64_tr_b16 v[228:229], v5 offset:40992
    v_mfma_f32_16x16x32_bf16 v[68:71], v[236:239], v[108:111], v[68:71]
    ds_read_b64_tr_b16 v[230:231], v5 offset:42016
    s_mov_b32 s23, 0xe000
    buffer_load_dwordx4 v[92:95], v7, s[8:11], s23 offen offset:0 sc1
    s_waitcnt lgkmcnt(6)
    v_mfma_f32_16x16x32_bf16 v[72:75], v[240:243], v[104:107], v[72:75]
    ds_read_b64_tr_b16 v[232:233], v4 offset:41216
    v_mfma_f32_16x16x32_bf16 v[76:79], v[240:243], v[108:111], v[76:79]
    ds_read_b64_tr_b16 v[234:235], v4 offset:42240
    s_waitcnt lgkmcnt(6)
    v_mfma_f32_16x16x32_bf16 v[80:83], v[244:247], v[104:107], v[80:83]
    ds_read_b64_tr_b16 v[236:237], v5 offset:41248
    v_mfma_f32_16x16x32_bf16 v[84:87], v[244:247], v[108:111], v[84:87]
    ds_read_b64_tr_b16 v[238:239], v5 offset:42272
    s_waitcnt vmcnt(12) lgkmcnt(6)
    v_mfma_f32_16x16x32_bf16 v[24:27], v[224:227], v[112:115], v[24:27]
    ds_read_b64_tr_b16 v[240:241], v4 offset:41472
    s_add_u32 s22, s14, 0x0
    s_add_u32 m0, s20, 0x10000
    s_nop 0
    buffer_load_dwordx4 v6, s[76:79], s22 offen lds
    s_waitcnt vmcnt(11)
    v_mfma_f32_16x16x32_bf16 v[28:31], v[224:227], v[116:119], v[28:31]
    ds_read_b64_tr_b16 v[242:243], v4 offset:42496
    s_waitcnt lgkmcnt(6)
    v_mfma_f32_16x16x32_bf16 v[32:35], v[228:231], v[112:115], v[32:35]
    ds_read_b64_tr_b16 v[244:245], v5 offset:41504
    v_mfma_f32_16x16x32_bf16 v[36:39], v[228:231], v[116:119], v[36:39]
    ds_read_b64_tr_b16 v[246:247], v5 offset:42528
    s_mov_b32 s23, 0x6000
    buffer_load_dwordx4 v[96:99], v7, s[8:11], s23 offen offset:1024 sc1
    s_waitcnt lgkmcnt(6)
    v_mfma_f32_16x16x32_bf16 v[40:43], v[232:235], v[112:115], v[40:43]
    ds_read_b64_tr_b16 v[224:225], v4 offset:41728
    s_add_u32 s22, s14, 0xc000
    s_add_u32 m0, s20, 0x10400
    s_nop 0
    buffer_load_dwordx4 v6, s[76:79], s22 offen lds
    v_mfma_f32_16x16x32_bf16 v[44:47], v[232:235], v[116:119], v[44:47]
    ds_read_b64_tr_b16 v[226:227], v4 offset:42752
    s_waitcnt lgkmcnt(6)
    v_mfma_f32_16x16x32_bf16 v[48:51], v[236:239], v[112:115], v[48:51]
    ds_read_b64_tr_b16 v[228:229], v5 offset:41760
    v_mfma_f32_16x16x32_bf16 v[52:55], v[236:239], v[116:119], v[52:55]
    ds_read_b64_tr_b16 v[230:231], v5 offset:42784
    s_waitcnt lgkmcnt(6)
    v_mfma_f32_16x16x32_bf16 v[56:59], v[240:243], v[112:115], v[56:59]
    v_mfma_f32_16x16x32_bf16 v[60:63], v[240:243], v[116:119], v[60:63]
    s_waitcnt vmcnt(12)
    s_barrier
    ds_read_b64_tr_b16 v[232:233], v4 offset:49152
    ds_read_b64_tr_b16 v[234:235], v4 offset:50176
    s_waitcnt lgkmcnt(6)
    v_mfma_f32_16x16x32_bf16 v[64:67], v[244:247], v[112:115], v[64:67]
    ds_read_b64_tr_b16 v[236:237], v5 offset:49184
    v_mfma_f32_16x16x32_bf16 v[68:71], v[244:247], v[116:119], v[68:71]
    s_add_u32 s22, s19, 0x680000
    s_add_u32 m0, s20, 0x4000
    s_nop 0
    buffer_load_dwordx4 v3, s[4:7], s22 offen lds
    ds_read_b64_tr_b16 v[238:239], v5 offset:50208
    s_mov_b32 s23, 0xe000
    buffer_load_dwordx4 v[100:103], v7, s[8:11], s23 offen offset:1024 sc1
    s_waitcnt lgkmcnt(6)
    v_mfma_f32_16x16x32_bf16 v[72:75], v[224:227], v[112:115], v[72:75]
    ds_read_b64_tr_b16 v[240:241], v4 offset:49408
    v_mfma_f32_16x16x32_bf16 v[76:79], v[224:227], v[116:119], v[76:79]
    ds_read_b64_tr_b16 v[242:243], v4 offset:50432
    s_waitcnt lgkmcnt(6)
    v_mfma_f32_16x16x32_bf16 v[80:83], v[228:231], v[112:115], v[80:83]
    ds_read_b64_tr_b16 v[244:245], v5 offset:49440
    v_mfma_f32_16x16x32_bf16 v[84:87], v[228:231], v[116:119], v[84:87]
    ds_read_b64_tr_b16 v[246:247], v5 offset:50464
    s_waitcnt vmcnt(13) lgkmcnt(6)
    v_mfma_f32_16x16x32_bf16 v[24:27], v[232:235], v[120:123], v[24:27]
    ds_read_b64_tr_b16 v[224:225], v4 offset:49664
    s_waitcnt vmcnt(12)
    v_mfma_f32_16x16x32_bf16 v[28:31], v[232:235], v[124:127], v[28:31]
    ds_read_b64_tr_b16 v[226:227], v4 offset:50688
    s_waitcnt lgkmcnt(6)
    v_mfma_f32_16x16x32_bf16 v[32:35], v[236:239], v[120:123], v[32:35]
    ds_read_b64_tr_b16 v[228:229], v5 offset:49696
    v_mfma_f32_16x16x32_bf16 v[36:39], v[236:239], v[124:127], v[36:39]
    s_add_u32 s22, s19, 0x688000
    s_add_u32 m0, s20, 0x4400
    s_nop 0
    buffer_load_dwordx4 v3, s[4:7], s22 offen lds
    ds_read_b64_tr_b16 v[230:231], v5 offset:50720
    s_mov_b32 s23, 0x6800
    buffer_load_dwordx4 v[104:107], v7, s[8:11], s23 offen offset:0 sc1
    s_waitcnt lgkmcnt(6)
    v_mfma_f32_16x16x32_bf16 v[40:43], v[240:243], v[120:123], v[40:43]
    ds_read_b64_tr_b16 v[232:233], v4 offset:49920
    v_mfma_f32_16x16x32_bf16 v[44:47], v[240:243], v[124:127], v[44:47]
    ds_read_b64_tr_b16 v[234:235], v4 offset:50944
    s_waitcnt lgkmcnt(6)
    v_mfma_f32_16x16x32_bf16 v[48:51], v[244:247], v[120:123], v[48:51]
    ds_read_b64_tr_b16 v[236:237], v5 offset:49952
    v_mfma_f32_16x16x32_bf16 v[52:55], v[244:247], v[124:127], v[52:55]
    ds_read_b64_tr_b16 v[238:239], v5 offset:50976
    s_waitcnt lgkmcnt(6)
    v_mfma_f32_16x16x32_bf16 v[56:59], v[224:227], v[120:123], v[56:59]
    ds_read_b64_tr_b16 v[240:241], v4 offset:57344
    v_mfma_f32_16x16x32_bf16 v[60:63], v[224:227], v[124:127], v[60:63]
    ds_read_b64_tr_b16 v[242:243], v4 offset:58368
    s_waitcnt lgkmcnt(6)
    v_mfma_f32_16x16x32_bf16 v[64:67], v[228:231], v[120:123], v[64:67]
    ds_read_b64_tr_b16 v[244:245], v5 offset:57376
    v_mfma_f32_16x16x32_bf16 v[68:71], v[228:231], v[124:127], v[68:71]
    ds_read_b64_tr_b16 v[246:247], v5 offset:58400
    s_mov_b32 s23, 0xe800
    buffer_load_dwordx4 v[108:111], v7, s[8:11], s23 offen offset:0 sc1
    s_waitcnt lgkmcnt(6)
    v_mfma_f32_16x16x32_bf16 v[72:75], v[232:235], v[120:123], v[72:75]
    ds_read_b64_tr_b16 v[224:225], v4 offset:57600
    v_mfma_f32_16x16x32_bf16 v[76:79], v[232:235], v[124:127], v[76:79]
    ds_read_b64_tr_b16 v[226:227], v4 offset:58624
    s_waitcnt lgkmcnt(6)
    v_mfma_f32_16x16x32_bf16 v[80:83], v[236:239], v[120:123], v[80:83]
    ds_read_b64_tr_b16 v[228:229], v5 offset:57632
    v_mfma_f32_16x16x32_bf16 v[84:87], v[236:239], v[124:127], v[84:87]
    ds_read_b64_tr_b16 v[230:231], v5 offset:58656
    s_waitcnt vmcnt(13) lgkmcnt(6)
    v_mfma_f32_16x16x32_bf16 v[24:27], v[240:243], v[128:131], v[24:27]
    ds_read_b64_tr_b16 v[232:233], v4 offset:57856
    s_add_u32 s22, s14, 0xc0000
    s_add_u32 m0, s20, 0x14000
    s_nop 0
    buffer_load_dwordx4 v6, s[76:79], s22 offen lds
    s_waitcnt vmcnt(12)
    v_mfma_f32_16x16x32_bf16 v[28:31], v[240:243], v[132:135], v[28:31]
    ds_read_b64_tr_b16 v[234:235], v4 offset:58880
    s_waitcnt lgkmcnt(6)
    v_mfma_f32_16x16x32_bf16 v[32:35], v[244:247], v[128:131], v[32:35]
    ds_read_b64_tr_b16 v[236:237], v5 offset:57888
    v_mfma_f32_16x16x32_bf16 v[36:39], v[244:247], v[132:135], v[36:39]
    ds_read_b64_tr_b16 v[238:239], v5 offset:58912
    s_mov_b32 s23, 0x6800
    buffer_load_dwordx4 v[112:115], v7, s[8:11], s23 offen offset:1024 sc1
    s_waitcnt lgkmcnt(6)
    v_mfma_f32_16x16x32_bf16 v[40:43], v[224:227], v[128:131], v[40:43]
    ds_read_b64_tr_b16 v[240:241], v4 offset:58112
    s_add_u32 s22, s14, 0xcc000
    s_add_u32 m0, s20, 0x14400
    s_nop 0
    buffer_load_dwordx4 v6, s[76:79], s22 offen lds
    v_mfma_f32_16x16x32_bf16 v[44:47], v[224:227], v[132:135], v[44:47]
    ds_read_b64_tr_b16 v[242:243], v4 offset:59136
    s_waitcnt lgkmcnt(6)
    v_mfma_f32_16x16x32_bf16 v[48:51], v[228:231], v[128:131], v[48:51]
    ds_read_b64_tr_b16 v[244:245], v5 offset:58144
    v_mfma_f32_16x16x32_bf16 v[52:55], v[228:231], v[132:135], v[52:55]
    ds_read_b64_tr_b16 v[246:247], v5 offset:59168
    s_waitcnt lgkmcnt(6)
    v_mfma_f32_16x16x32_bf16 v[56:59], v[232:235], v[128:131], v[56:59]
    v_mfma_f32_16x16x32_bf16 v[60:63], v[232:235], v[132:135], v[60:63]
    s_waitcnt vmcnt(13)
    s_barrier
    ds_read_b64_tr_b16 v[224:225], v4 offset:0
    ds_read_b64_tr_b16 v[226:227], v4 offset:1024
    s_waitcnt lgkmcnt(6)
    v_mfma_f32_16x16x32_bf16 v[64:67], v[236:239], v[128:131], v[64:67]
    ds_read_b64_tr_b16 v[228:229], v5 offset:32
    v_mfma_f32_16x16x32_bf16 v[68:71], v[236:239], v[132:135], v[68:71]
    s_add_u32 s22, s19, 0x700000
    s_add_u32 m0, s20, 0x8000
    s_nop 0
    buffer_load_dwordx4 v3, s[4:7], s22 offen lds
    ds_read_b64_tr_b16 v[230:231], v5 offset:1056
    s_mov_b32 s23, 0xe800
    buffer_load_dwordx4 v[116:119], v7, s[8:11], s23 offen offset:1024 sc1
    s_waitcnt lgkmcnt(6)
    v_mfma_f32_16x16x32_bf16 v[72:75], v[240:243], v[128:131], v[72:75]
    ds_read_b64_tr_b16 v[232:233], v4 offset:256
    v_mfma_f32_16x16x32_bf16 v[76:79], v[240:243], v[132:135], v[76:79]
    ds_read_b64_tr_b16 v[234:235], v4 offset:1280
    s_waitcnt lgkmcnt(6)
    v_mfma_f32_16x16x32_bf16 v[80:83], v[244:247], v[128:131], v[80:83]
    ds_read_b64_tr_b16 v[236:237], v5 offset:288
    v_mfma_f32_16x16x32_bf16 v[84:87], v[244:247], v[132:135], v[84:87]
    ds_read_b64_tr_b16 v[238:239], v5 offset:1312
    s_waitcnt vmcnt(14) lgkmcnt(6)
    v_mfma_f32_16x16x32_bf16 v[24:27], v[224:227], v[88:91], v[24:27]
    ds_read_b64_tr_b16 v[240:241], v4 offset:512
    s_waitcnt vmcnt(13)
    v_mfma_f32_16x16x32_bf16 v[28:31], v[224:227], v[92:95], v[28:31]
    ds_read_b64_tr_b16 v[242:243], v4 offset:1536
    s_waitcnt lgkmcnt(6)
    v_mfma_f32_16x16x32_bf16 v[32:35], v[228:231], v[88:91], v[32:35]
    ds_read_b64_tr_b16 v[244:245], v5 offset:544
    v_mfma_f32_16x16x32_bf16 v[36:39], v[228:231], v[92:95], v[36:39]
    s_add_u32 s22, s19, 0x708000
    s_add_u32 m0, s20, 0x8400
    s_nop 0
    buffer_load_dwordx4 v3, s[4:7], s22 offen lds
    ds_read_b64_tr_b16 v[246:247], v5 offset:1568
    s_mov_b32 s23, 0x7000
    buffer_load_dwordx4 v[120:123], v7, s[8:11], s23 offen offset:0 sc1
    s_waitcnt lgkmcnt(6)
    v_mfma_f32_16x16x32_bf16 v[40:43], v[232:235], v[88:91], v[40:43]
    ds_read_b64_tr_b16 v[224:225], v4 offset:768
    v_mfma_f32_16x16x32_bf16 v[44:47], v[232:235], v[92:95], v[44:47]
    ds_read_b64_tr_b16 v[226:227], v4 offset:1792
    s_waitcnt lgkmcnt(6)
    v_mfma_f32_16x16x32_bf16 v[48:51], v[236:239], v[88:91], v[48:51]
    ds_read_b64_tr_b16 v[228:229], v5 offset:800
    v_mfma_f32_16x16x32_bf16 v[52:55], v[236:239], v[92:95], v[52:55]
    ds_read_b64_tr_b16 v[230:231], v5 offset:1824
    s_waitcnt lgkmcnt(6)
    v_mfma_f32_16x16x32_bf16 v[56:59], v[240:243], v[88:91], v[56:59]
    ds_read_b64_tr_b16 v[232:233], v4 offset:8192
    v_mfma_f32_16x16x32_bf16 v[60:63], v[240:243], v[92:95], v[60:63]
    ds_read_b64_tr_b16 v[234:235], v4 offset:9216
    s_waitcnt lgkmcnt(6)
    v_mfma_f32_16x16x32_bf16 v[64:67], v[244:247], v[88:91], v[64:67]
    ds_read_b64_tr_b16 v[236:237], v5 offset:8224
    v_mfma_f32_16x16x32_bf16 v[68:71], v[244:247], v[92:95], v[68:71]
    ds_read_b64_tr_b16 v[238:239], v5 offset:9248
    s_mov_b32 s23, 0xf000
    buffer_load_dwordx4 v[124:127], v7, s[8:11], s23 offen offset:0 sc1
    s_waitcnt lgkmcnt(6)
    v_mfma_f32_16x16x32_bf16 v[72:75], v[224:227], v[88:91], v[72:75]
    ds_read_b64_tr_b16 v[240:241], v4 offset:8448
    v_mfma_f32_16x16x32_bf16 v[76:79], v[224:227], v[92:95], v[76:79]
    ds_read_b64_tr_b16 v[242:243], v4 offset:9472
    s_waitcnt lgkmcnt(6)
    v_mfma_f32_16x16x32_bf16 v[80:83], v[228:231], v[88:91], v[80:83]
    ds_read_b64_tr_b16 v[244:245], v5 offset:8480
    v_mfma_f32_16x16x32_bf16 v[84:87], v[228:231], v[92:95], v[84:87]
    ds_read_b64_tr_b16 v[246:247], v5 offset:9504
    s_waitcnt vmcnt(14) lgkmcnt(6)
    v_mfma_f32_16x16x32_bf16 v[24:27], v[232:235], v[96:99], v[24:27]
    ds_read_b64_tr_b16 v[224:225], v4 offset:8704
    s_add_u32 s22, s21, 0x0
    s_add_u32 m0, s20, 0x18000
    s_nop 0
    buffer_load_dwordx4 v2, s[8:11], s22 offen sc1 lds
    s_waitcnt vmcnt(12)
    v_mfma_f32_16x16x32_bf16 v[28:31], v[232:235], v[100:103], v[28:31]
    ds_read_b64_tr_b16 v[226:227], v4 offset:9728
    s_waitcnt lgkmcnt(6)
    v_mfma_f32_16x16x32_bf16 v[32:35], v[236:239], v[96:99], v[32:35]
    ds_read_b64_tr_b16 v[228:229], v5 offset:8736
    v_mfma_f32_16x16x32_bf16 v[36:39], v[236:239], v[100:103], v[36:39]
    ds_read_b64_tr_b16 v[230:231], v5 offset:9760
    s_mov_b32 s23, 0x7000
    buffer_load_dwordx4 v[128:131], v7, s[8:11], s23 offen offset:1024 sc1
    s_waitcnt lgkmcnt(6)
    v_mfma_f32_16x16x32_bf16 v[40:43], v[240:243], v[96:99], v[40:43]
    ds_read_b64_tr_b16 v[232:233], v4 offset:8960
    s_add_u32 s22, s21, 0x400
    s_add_u32 m0, s20, 0x18400
    s_nop 0
    buffer_load_dwordx4 v2, s[8:11], s22 offen sc1 lds
    v_mfma_f32_16x16x32_bf16 v[44:47], v[240:243], v[100:103], v[44:47]
    ds_read_b64_tr_b16 v[234:235], v4 offset:9984
    s_waitcnt lgkmcnt(6)
    v_mfma_f32_16x16x32_bf16 v[48:51], v[244:247], v[96:99], v[48:51]
    ds_read_b64_tr_b16 v[236:237], v5 offset:8992
    v_mfma_f32_16x16x32_bf16 v[52:55], v[244:247], v[100:103], v[52:55]
    ds_read_b64_tr_b16 v[238:239], v5 offset:10016
    s_waitcnt lgkmcnt(6)
    v_mfma_f32_16x16x32_bf16 v[56:59], v[224:227], v[96:99], v[56:59]
    v_mfma_f32_16x16x32_bf16 v[60:63], v[224:227], v[100:103], v[60:63]
    s_waitcnt vmcnt(13)
    s_barrier
    ds_read_b64_tr_b16 v[240:241], v4 offset:16384
    ds_read_b64_tr_b16 v[242:243], v4 offset:17408
    s_waitcnt lgkmcnt(6)
    v_mfma_f32_16x16x32_bf16 v[64:67], v[228:231], v[96:99], v[64:67]
    ds_read_b64_tr_b16 v[244:245], v5 offset:16416
    v_mfma_f32_16x16x32_bf16 v[68:71], v[228:231], v[100:103], v[68:71]
    s_add_u32 s22, s19, 0x780000
    s_add_u32 m0, s20, 0xc000
    s_nop 0
    buffer_load_dwordx4 v3, s[4:7], s22 offen lds
    ds_read_b64_tr_b16 v[246:247], v5 offset:17440
    s_mov_b32 s23, 0xf000
    buffer_load_dwordx4 v[132:135], v7, s[8:11], s23 offen offset:1024 sc1
    s_waitcnt lgkmcnt(6)
    v_mfma_f32_16x16x32_bf16 v[72:75], v[232:235], v[96:99], v[72:75]
    ds_read_b64_tr_b16 v[224:225], v4 offset:16640
    v_mfma_f32_16x16x32_bf16 v[76:79], v[232:235], v[100:103], v[76:79]
    ds_read_b64_tr_b16 v[226:227], v4 offset:17664
    s_waitcnt lgkmcnt(6)
    v_mfma_f32_16x16x32_bf16 v[80:83], v[236:239], v[96:99], v[80:83]
    ds_read_b64_tr_b16 v[228:229], v5 offset:16672
    v_mfma_f32_16x16x32_bf16 v[84:87], v[236:239], v[100:103], v[84:87]
    ds_read_b64_tr_b16 v[230:231], v5 offset:17696
    s_waitcnt vmcnt(14) lgkmcnt(6)
    v_mfma_f32_16x16x32_bf16 v[24:27], v[240:243], v[104:107], v[24:27]
    ds_read_b64_tr_b16 v[232:233], v4 offset:16896
    s_waitcnt vmcnt(13)
    v_mfma_f32_16x16x32_bf16 v[28:31], v[240:243], v[108:111], v[28:31]
    ds_read_b64_tr_b16 v[234:235], v4 offset:17920
    s_waitcnt lgkmcnt(6)
    v_mfma_f32_16x16x32_bf16 v[32:35], v[244:247], v[104:107], v[32:35]
    ds_read_b64_tr_b16 v[236:237], v5 offset:16928
    v_mfma_f32_16x16x32_bf16 v[36:39], v[244:247], v[108:111], v[36:39]
    s_add_u32 s22, s19, 0x788000
    s_add_u32 m0, s20, 0xc400
    s_nop 0
    buffer_load_dwordx4 v3, s[4:7], s22 offen lds
    ds_read_b64_tr_b16 v[238:239], v5 offset:17952
    s_mov_b32 s23, 0x7800
    buffer_load_dwordx4 v[88:91], v7, s[8:11], s23 offen offset:0 sc1
    s_waitcnt lgkmcnt(6)
    v_mfma_f32_16x16x32_bf16 v[40:43], v[224:227], v[104:107], v[40:43]
    ds_read_b64_tr_b16 v[240:241], v4 offset:17152
    v_lshrrev_b32 v20, 4, v1
    v_lshlrev_b32 v21, 4, v20
    s_lshl_b32 s16, s2, 8
    s_add_u32 s16, s16, 0x550000
    buffer_load_dwordx4 v[136:139], v21, s[8:11], s16 offen offset:0 sc1
    buffer_load_dwordx4 v[140:143], v21, s[8:11], s16 offen offset:64 sc1
    buffer_load_dwordx4 v[144:147], v21, s[8:11], s16 offen offset:128 sc1
    buffer_load_dwordx4 v[148:151], v21, s[8:11], s16 offen offset:192 sc1
    v_lshlrev_b32 v11, 11, v20
    v_xor_b32 v20, s3, v20
    v_and_b32 v20, 1, v20
    v_lshl_add_u32 v11, v20, 5, v11
    v_bfe_u32 v20, v1, 2, 2
    v_lshl_add_u32 v11, v20, 6, v11
    v_and_b32 v20, 3, v1
    v_lshl_add_u32 v11, v20, 3, v11
    s_lshr_b32 s16, s3, 1
    s_lshl_b32 s16, s16, 8
    s_add_u32 s16, s16, 65536
    v_add_u32 v11, s16, v11
    v_mfma_f32_16x16x32_bf16 v[44:47], v[224:227], v[108:111], v[44:47]
    ds_read_b64_tr_b16 v[242:243], v4 offset:18176
    s_waitcnt lgkmcnt(6)
    v_mfma_f32_16x16x32_bf16 v[48:51], v[228:231], v[104:107], v[48:51]
    ds_read_b64_tr_b16 v[244:245], v5 offset:17184
    v_mfma_f32_16x16x32_bf16 v[52:55], v[228:231], v[108:111], v[52:55]
    ds_read_b64_tr_b16 v[246:247], v5 offset:18208
    s_waitcnt lgkmcnt(6)
    v_mfma_f32_16x16x32_bf16 v[56:59], v[232:235], v[104:107], v[56:59]
    ds_read_b64_tr_b16 v[224:225], v4 offset:24576
    v_mfma_f32_16x16x32_bf16 v[60:63], v[232:235], v[108:111], v[60:63]
    ds_read_b64_tr_b16 v[226:227], v4 offset:25600
    s_waitcnt lgkmcnt(6)
    v_mfma_f32_16x16x32_bf16 v[64:67], v[236:239], v[104:107], v[64:67]
    ds_read_b64_tr_b16 v[228:229], v5 offset:24608
    v_mfma_f32_16x16x32_bf16 v[68:71], v[236:239], v[108:111], v[68:71]
    ds_read_b64_tr_b16 v[230:231], v5 offset:25632
    s_mov_b32 s23, 0xf800
    buffer_load_dwordx4 v[92:95], v7, s[8:11], s23 offen offset:0 sc1
    s_waitcnt lgkmcnt(6)
    v_mfma_f32_16x16x32_bf16 v[72:75], v[240:243], v[104:107], v[72:75]
    ds_read_b64_tr_b16 v[232:233], v4 offset:24832
    v_mfma_f32_16x16x32_bf16 v[76:79], v[240:243], v[108:111], v[76:79]
    ds_read_b64_tr_b16 v[234:235], v4 offset:25856
    s_waitcnt lgkmcnt(6)
    v_mfma_f32_16x16x32_bf16 v[80:83], v[244:247], v[104:107], v[80:83]
    ds_read_b64_tr_b16 v[236:237], v5 offset:24864
    v_mfma_f32_16x16x32_bf16 v[84:87], v[244:247], v[108:111], v[84:87]
    ds_read_b64_tr_b16 v[238:239], v5 offset:25888
    s_waitcnt vmcnt(18) lgkmcnt(6)
    v_mfma_f32_16x16x32_bf16 v[24:27], v[224:227], v[112:115], v[24:27]
    ds_read_b64_tr_b16 v[240:241], v4 offset:25088
    s_add_u32 s22, s21, 0x4000
    s_add_u32 m0, s20, 0x1c000
    s_nop 0
    buffer_load_dwordx4 v2, s[8:11], s22 offen sc1 lds
    s_waitcnt vmcnt(16)
    v_mfma_f32_16x16x32_bf16 v[28:31], v[224:227], v[116:119], v[28:31]
    ds_read_b64_tr_b16 v[242:243], v4 offset:26112
    s_waitcnt lgkmcnt(6)
    v_mfma_f32_16x16x32_bf16 v[32:35], v[228:231], v[112:115], v[32:35]
    ds_read_b64_tr_b16 v[244:245], v5 offset:25120
    v_mfma_f32_16x16x32_bf16 v[36:39], v[228:231], v[116:119], v[36:39]
    ds_read_b64_tr_b16 v[246:247], v5 offset:26144
    s_mov_b32 s23, 0x7800
    buffer_load_dwordx4 v[96:99], v7, s[8:11], s23 offen offset:1024 sc1
    s_waitcnt lgkmcnt(6)
    v_mfma_f32_16x16x32_bf16 v[40:43], v[232:235], v[112:115], v[40:43]
    ds_read_b64_tr_b16 v[224:225], v4 offset:25344
    s_add_u32 s22, s21, 0x4400
    s_add_u32 m0, s20, 0x1c400
    s_nop 0
    buffer_load_dwordx4 v2, s[8:11], s22 offen sc1 lds
    v_mfma_f32_16x16x32_bf16 v[44:47], v[232:235], v[116:119], v[44:47]
    ds_read_b64_tr_b16 v[226:227], v4 offset:26368
    s_waitcnt lgkmcnt(6)
    v_mfma_f32_16x16x32_bf16 v[48:51], v[236:239], v[112:115], v[48:51]
    ds_read_b64_tr_b16 v[228:229], v5 offset:25376
    v_mfma_f32_16x16x32_bf16 v[52:55], v[236:239], v[116:119], v[52:55]
    ds_read_b64_tr_b16 v[230:231], v5 offset:26400
    s_waitcnt lgkmcnt(6)
    v_mfma_f32_16x16x32_bf16 v[56:59], v[240:243], v[112:115], v[56:59]
    v_mfma_f32_16x16x32_bf16 v[60:63], v[240:243], v[116:119], v[60:63]
    s_waitcnt vmcnt(17)
    s_barrier
    ds_read_b64_tr_b16 v[232:233], v4 offset:32768
    ds_read_b64_tr_b16 v[234:235], v4 offset:33792
    s_waitcnt lgkmcnt(6)
    v_mfma_f32_16x16x32_bf16 v[64:67], v[244:247], v[112:115], v[64:67]
    ds_read_b64_tr_b16 v[236:237], v5 offset:32800
    v_mfma_f32_16x16x32_bf16 v[68:71], v[244:247], v[116:119], v[68:71]
    ds_read_b64_tr_b16 v[238:239], v5 offset:33824
    s_mov_b32 s23, 0xf800
    buffer_load_dwordx4 v[100:103], v7, s[8:11], s23 offen offset:1024 sc1
    s_waitcnt lgkmcnt(6)
    v_mfma_f32_16x16x32_bf16 v[72:75], v[224:227], v[112:115], v[72:75]
    ds_read_b64_tr_b16 v[240:241], v4 offset:33024
    v_mfma_f32_16x16x32_bf16 v[76:79], v[224:227], v[116:119], v[76:79]
    ds_read_b64_tr_b16 v[242:243], v4 offset:34048
    s_waitcnt lgkmcnt(6)
    v_mfma_f32_16x16x32_bf16 v[80:83], v[228:231], v[112:115], v[80:83]
    ds_read_b64_tr_b16 v[244:245], v5 offset:33056
    v_mfma_f32_16x16x32_bf16 v[84:87], v[228:231], v[116:119], v[84:87]
    ds_read_b64_tr_b16 v[246:247], v5 offset:34080
    s_waitcnt vmcnt(17) lgkmcnt(6)
    v_mfma_f32_16x16x32_bf16 v[24:27], v[232:235], v[120:123], v[24:27]
    ds_read_b64_tr_b16 v[224:225], v4 offset:33280
    s_waitcnt vmcnt(16)
    v_mfma_f32_16x16x32_bf16 v[28:31], v[232:235], v[124:127], v[28:31]
    ds_read_b64_tr_b16 v[226:227], v4 offset:34304
    s_waitcnt lgkmcnt(6)
    v_mfma_f32_16x16x32_bf16 v[32:35], v[236:239], v[120:123], v[32:35]
    ds_read_b64_tr_b16 v[228:229], v5 offset:33312
    v_mfma_f32_16x16x32_bf16 v[36:39], v[236:239], v[124:127], v[36:39]
    ds_read_b64_tr_b16 v[230:231], v5 offset:34336
    s_waitcnt lgkmcnt(6)
    v_mfma_f32_16x16x32_bf16 v[40:43], v[240:243], v[120:123], v[40:43]
    ds_read_b64_tr_b16 v[232:233], v4 offset:33536
    v_mfma_f32_16x16x32_bf16 v[44:47], v[240:243], v[124:127], v[44:47]
    ds_read_b64_tr_b16 v[234:235], v4 offset:34560
    s_waitcnt lgkmcnt(6)
    v_mfma_f32_16x16x32_bf16 v[48:51], v[244:247], v[120:123], v[48:51]
    ds_read_b64_tr_b16 v[236:237], v5 offset:33568
    v_mfma_f32_16x16x32_bf16 v[52:55], v[244:247], v[124:127], v[52:55]
    ds_read_b64_tr_b16 v[238:239], v5 offset:34592
    s_waitcnt lgkmcnt(6)
    v_mfma_f32_16x16x32_bf16 v[56:59], v[224:227], v[120:123], v[56:59]
    ds_read_b64_tr_b16 v[240:241], v4 offset:40960
    v_mfma_f32_16x16x32_bf16 v[60:63], v[224:227], v[124:127], v[60:63]
    ds_read_b64_tr_b16 v[242:243], v4 offset:41984
    s_waitcnt lgkmcnt(6)
    v_mfma_f32_16x16x32_bf16 v[64:67], v[228:231], v[120:123], v[64:67]
    ds_read_b64_tr_b16 v[244:245], v5 offset:40992
    v_mfma_f32_16x16x32_bf16 v[68:71], v[228:231], v[124:127], v[68:71]
    ds_read_b64_tr_b16 v[246:247], v5 offset:42016
    s_waitcnt lgkmcnt(6)
    v_mfma_f32_16x16x32_bf16 v[72:75], v[232:235], v[120:123], v[72:75]
    ds_read_b64_tr_b16 v[224:225], v4 offset:41216
    v_mfma_f32_16x16x32_bf16 v[76:79], v[232:235], v[124:127], v[76:79]
    ds_read_b64_tr_b16 v[226:227], v4 offset:42240
    s_waitcnt lgkmcnt(6)
    v_mfma_f32_16x16x32_bf16 v[80:83], v[236:239], v[120:123], v[80:83]
    ds_read_b64_tr_b16 v[228:229], v5 offset:41248
    v_mfma_f32_16x16x32_bf16 v[84:87], v[236:239], v[124:127], v[84:87]
    ds_read_b64_tr_b16 v[230:231], v5 offset:42272
    s_waitcnt vmcnt(14) lgkmcnt(6)
    v_mfma_f32_16x16x32_bf16 v[24:27], v[240:243], v[128:131], v[24:27]
    ds_read_b64_tr_b16 v[232:233], v4 offset:41472
    s_waitcnt vmcnt(11)
    v_mfma_f32_16x16x32_bf16 v[28:31], v[240:243], v[132:135], v[28:31]
    ds_read_b64_tr_b16 v[234:235], v4 offset:42496
    s_waitcnt lgkmcnt(6)
    v_mfma_f32_16x16x32_bf16 v[32:35], v[244:247], v[128:131], v[32:35]
    ds_read_b64_tr_b16 v[236:237], v5 offset:41504
    v_mfma_f32_16x16x32_bf16 v[36:39], v[244:247], v[132:135], v[36:39]
    ds_read_b64_tr_b16 v[238:239], v5 offset:42528
    s_waitcnt lgkmcnt(6)
    v_mfma_f32_16x16x32_bf16 v[40:43], v[224:227], v[128:131], v[40:43]
    ds_read_b64_tr_b16 v[240:241], v4 offset:41728
    v_mfma_f32_16x16x32_bf16 v[44:47], v[224:227], v[132:135], v[44:47]
    ds_read_b64_tr_b16 v[242:243], v4 offset:42752
    s_waitcnt lgkmcnt(6)
    v_mfma_f32_16x16x32_bf16 v[48:51], v[228:231], v[128:131], v[48:51]
    ds_read_b64_tr_b16 v[244:245], v5 offset:41760
    v_mfma_f32_16x16x32_bf16 v[52:55], v[228:231], v[132:135], v[52:55]
    ds_read_b64_tr_b16 v[246:247], v5 offset:42784
    s_waitcnt lgkmcnt(6)
    v_mfma_f32_16x16x32_bf16 v[56:59], v[232:235], v[128:131], v[56:59]
    v_mfma_f32_16x16x32_bf16 v[60:63], v[232:235], v[132:135], v[60:63]
    s_waitcnt vmcnt(10)
    s_barrier
    ds_read_b64_tr_b16 v[224:225], v4 offset:49152
    ds_read_b64_tr_b16 v[226:227], v4 offset:50176
    s_waitcnt lgkmcnt(6)
    v_mfma_f32_16x16x32_bf16 v[64:67], v[236:239], v[128:131], v[64:67]
    ds_read_b64_tr_b16 v[228:229], v5 offset:49184
    v_mfma_f32_16x16x32_bf16 v[68:71], v[236:239], v[132:135], v[68:71]
    ds_read_b64_tr_b16 v[230:231], v5 offset:50208
    s_waitcnt lgkmcnt(6)
    v_mfma_f32_16x16x32_bf16 v[72:75], v[240:243], v[128:131], v[72:75]
    ds_read_b64_tr_b16 v[232:233], v4 offset:49408
    v_mfma_f32_16x16x32_bf16 v[76:79], v[240:243], v[132:135], v[76:79]
    ds_read_b64_tr_b16 v[234:235], v4 offset:50432
    s_waitcnt lgkmcnt(6)
    v_mfma_f32_16x16x32_bf16 v[80:83], v[244:247], v[128:131], v[80:83]
    ds_read_b64_tr_b16 v[236:237], v5 offset:49440
    v_mfma_f32_16x16x32_bf16 v[84:87], v[244:247], v[132:135], v[84:87]
    ds_read_b64_tr_b16 v[238:239], v5 offset:50464
    s_waitcnt vmcnt(9) lgkmcnt(6)
    v_mfma_f32_16x16x32_bf16 v[24:27], v[224:227], v[88:91], v[24:27]
    ds_read_b64_tr_b16 v[240:241], v4 offset:49664
    s_waitcnt vmcnt(4)
    v_mfma_f32_16x16x32_bf16 v[28:31], v[224:227], v[92:95], v[28:31]
    ds_read_b64_tr_b16 v[242:243], v4 offset:50688
    s_waitcnt lgkmcnt(6)
    v_mfma_f32_16x16x32_bf16 v[32:35], v[228:231], v[88:91], v[32:35]
    ds_read_b64_tr_b16 v[244:245], v5 offset:49696
    v_mfma_f32_16x16x32_bf16 v[36:39], v[228:231], v[92:95], v[36:39]
    ds_read_b64_tr_b16 v[246:247], v5 offset:50720
    s_waitcnt lgkmcnt(6)
    v_mfma_f32_16x16x32_bf16 v[40:43], v[232:235], v[88:91], v[40:43]
    ds_read_b64_tr_b16 v[224:225], v4 offset:49920
    v_mfma_f32_16x16x32_bf16 v[44:47], v[232:235], v[92:95], v[44:47]
    ds_read_b64_tr_b16 v[226:227], v4 offset:50944
    s_waitcnt lgkmcnt(6)
    v_mfma_f32_16x16x32_bf16 v[48:51], v[236:239], v[88:91], v[48:51]
    ds_read_b64_tr_b16 v[228:229], v5 offset:49952
    v_mfma_f32_16x16x32_bf16 v[52:55], v[236:239], v[92:95], v[52:55]
    ds_read_b64_tr_b16 v[230:231], v5 offset:50976
    s_waitcnt lgkmcnt(6)
    v_mfma_f32_16x16x32_bf16 v[56:59], v[240:243], v[88:91], v[56:59]
    ds_read_b64_tr_b16 v[232:233], v4 offset:57344
    v_mfma_f32_16x16x32_bf16 v[60:63], v[240:243], v[92:95], v[60:63]
    ds_read_b64_tr_b16 v[234:235], v4 offset:58368
    s_waitcnt lgkmcnt(6)
    v_mfma_f32_16x16x32_bf16 v[64:67], v[244:247], v[88:91], v[64:67]
    ds_read_b64_tr_b16 v[236:237], v5 offset:57376
    v_mfma_f32_16x16x32_bf16 v[68:71], v[244:247], v[92:95], v[68:71]
    ds_read_b64_tr_b16 v[238:239], v5 offset:58400
    s_waitcnt lgkmcnt(6)
    v_mfma_f32_16x16x32_bf16 v[72:75], v[224:227], v[88:91], v[72:75]
    ds_read_b64_tr_b16 v[240:241], v4 offset:57600
    v_mfma_f32_16x16x32_bf16 v[76:79], v[224:227], v[92:95], v[76:79]
    ds_read_b64_tr_b16 v[242:243], v4 offset:58624
    s_waitcnt lgkmcnt(6)
    v_mfma_f32_16x16x32_bf16 v[80:83], v[228:231], v[88:91], v[80:83]
    ds_read_b64_tr_b16 v[244:245], v5 offset:57632
    v_mfma_f32_16x16x32_bf16 v[84:87], v[228:231], v[92:95], v[84:87]
    ds_read_b64_tr_b16 v[246:247], v5 offset:58656
    s_waitcnt vmcnt(2) lgkmcnt(6)
    v_mfma_f32_16x16x32_bf16 v[24:27], v[232:235], v[96:99], v[24:27]
    ds_read_b64_tr_b16 v[224:225], v4 offset:57856
    s_waitcnt vmcnt(0)
    v_mfma_f32_16x16x32_bf16 v[28:31], v[232:235], v[100:103], v[28:31]
    ds_read_b64_tr_b16 v[226:227], v4 offset:58880
    s_waitcnt lgkmcnt(6)
    v_mfma_f32_16x16x32_bf16 v[32:35], v[236:239], v[96:99], v[32:35]
    ds_read_b64_tr_b16 v[228:229], v5 offset:57888
    v_mfma_f32_16x16x32_bf16 v[36:39], v[236:239], v[100:103], v[36:39]
    ds_read_b64_tr_b16 v[230:231], v5 offset:58912
    s_waitcnt lgkmcnt(6)
    v_mfma_f32_16x16x32_bf16 v[40:43], v[240:243], v[96:99], v[40:43]
    ds_read_b64_tr_b16 v[232:233], v4 offset:58112
    v_mfma_f32_16x16x32_bf16 v[44:47], v[240:243], v[100:103], v[44:47]
    ds_read_b64_tr_b16 v[234:235], v4 offset:59136
    s_waitcnt lgkmcnt(6)
    v_mfma_f32_16x16x32_bf16 v[48:51], v[244:247], v[96:99], v[48:51]
    ds_read_b64_tr_b16 v[236:237], v5 offset:58144
    v_mfma_f32_16x16x32_bf16 v[52:55], v[244:247], v[100:103], v[52:55]
    ds_read_b64_tr_b16 v[238:239], v5 offset:59168
    s_waitcnt lgkmcnt(6)
    v_mfma_f32_16x16x32_bf16 v[56:59], v[224:227], v[96:99], v[56:59]
    v_mfma_f32_16x16x32_bf16 v[60:63], v[224:227], v[100:103], v[60:63]
    s_waitcnt lgkmcnt(4)
    v_mfma_f32_16x16x32_bf16 v[64:67], v[228:231], v[96:99], v[64:67]
    v_mfma_f32_16x16x32_bf16 v[68:71], v[228:231], v[100:103], v[68:71]
    s_waitcnt lgkmcnt(2)
    v_mfma_f32_16x16x32_bf16 v[72:75], v[232:235], v[96:99], v[72:75]
    v_mfma_f32_16x16x32_bf16 v[76:79], v[232:235], v[100:103], v[76:79]
    s_waitcnt lgkmcnt(0)
    v_mfma_f32_16x16x32_bf16 v[80:83], v[236:239], v[96:99], v[80:83]
    v_mfma_f32_16x16x32_bf16 v[84:87], v[236:239], v[100:103], v[84:87]
    s_barrier
    s_add_u32 s22, s21, 0x8000
    s_add_u32 m0, s20, 0x20000
    s_nop 0
    buffer_load_dwordx4 v2, s[8:11], s22 offen sc1 lds
    s_add_u32 s22, s21, 0x8400
    s_add_u32 m0, s20, 0x20400
    s_nop 0
    buffer_load_dwordx4 v2, s[8:11], s22 offen sc1 lds
    s_add_u32 s22, s21, 0xc000
    s_add_u32 m0, s20, 0x24000
    s_nop 0
    buffer_load_dwordx4 v2, s[8:11], s22 offen sc1 lds
    s_add_u32 s22, s21, 0xc400
    s_add_u32 m0, s20, 0x24400
    s_nop 0
    buffer_load_dwordx4 v2, s[8:11], s22 offen sc1 lds
    ds_read_b64_tr_b16 v[88:89], v11 offset:0
    ds_read_b64_tr_b16 v[90:91], v11 offset:1024
    ds_read_b64_tr_b16 v[92:93], v11 offset:8192
    ds_read_b64_tr_b16 v[94:95], v11 offset:9216
    ds_read_b64_tr_b16 v[96:97], v11 offset:16384
    ds_read_b64_tr_b16 v[98:99], v11 offset:17408
    ds_read_b64_tr_b16 v[100:101], v11 offset:24576
    ds_read_b64_tr_b16 v[102:103], v11 offset:25600
    s_mov_b32 s23, 0x3e0293ee
    v_mul_f32 v24, s23, v24
    v_mul_f32 v25, s23, v25
    v_mul_f32 v26, s23, v26
    v_mul_f32 v27, s23, v27
    v_mul_f32 v28, s23, v28
    v_mul_f32 v29, s23, v29
    v_mul_f32 v30, s23, v30
    v_mul_f32 v31, s23, v31
    v_mul_f32 v32, s23, v32
    v_mul_f32 v33, s23, v33
    v_mul_f32 v34, s23, v34
    v_mul_f32 v35, s23, v35
    v_mul_f32 v36, s23, v36
    v_mul_f32 v37, s23, v37
    v_mul_f32 v38, s23, v38
    v_mul_f32 v39, s23, v39
    v_cvt_pk_bf16_f32 v152, v24, v25
    v_cvt_pk_bf16_f32 v153, v26, v27
    v_cvt_pk_bf16_f32 v168, v28, v29
    v_cvt_pk_bf16_f32 v169, v30, v31
    v_cvt_pk_bf16_f32 v154, v32, v33
    v_cvt_pk_bf16_f32 v155, v34, v35
    v_cvt_pk_bf16_f32 v170, v36, v37
    v_cvt_pk_bf16_f32 v171, v38, v39
    s_waitcnt lgkmcnt(6)
    v_mfma_f32_16x16x32_bf16 v[104:107], v[88:91], v[136:139], 0
    s_waitcnt lgkmcnt(4)
    v_mfma_f32_16x16x32_bf16 v[104:107], v[92:95], v[140:143], v[104:107]
    s_waitcnt lgkmcnt(2)
    v_mfma_f32_16x16x32_bf16 v[104:107], v[96:99], v[144:147], v[104:107]
    s_waitcnt lgkmcnt(0)
    v_mfma_f32_16x16x32_bf16 v[104:107], v[100:103], v[148:151], v[104:107]
    v_add_u32 v4, 0x10000, v2
    v_add_u32 v5, 0x20000, v2
    s_barrier
    ds_read_b128 v[224:227], v4 offset:32768
    ds_read_b128 v[228:231], v4 offset:33792
    ds_read_b128 v[232:235], v4 offset:34816
    ds_read_b128 v[236:239], v4 offset:35840
    v_mov_b32 v12, 0x3f803f80
    v_mov_b32 v13, 0x3f803f80
    v_mov_b32 v14, 0x3f803f80
    v_mov_b32 v15, 0x3f803f80
    s_waitcnt lgkmcnt(3)
    v_mfma_f32_16x16x32_bf16 v[184:187], v[224:227], v[152:155], 0
    v_mul_f32 v40, s23, v40
    v_mul_f32 v41, s23, v41
    v_mul_f32 v42, s23, v42
    v_mul_f32 v43, s23, v43
    v_mul_f32 v44, s23, v44
    v_mul_f32 v45, s23, v45
    v_lshrrev_b32 v20, 4, v1
    v_lshlrev_b32 v20, 4, v20
    s_lshr_b32 s16, s2, 5
    s_lshl_b32 s16, s16, 14
    s_and_b32 s17, s2, 31
    s_lshl_b32 s17, s17, 9
    s_add_u32 s16, s16, s17
    s_lshl_b32 s17, s3, 6
    s_add_u32 s16, s16, s17
    s_add_u32 s16, s16, 0x580000
    s_mov_b32 exec_lo, 0x10001
    s_mov_b32 exec_hi, 0x10001
    buffer_store_dwordx4 v[104:107], v20, s[8:11], s16 offen sc1
    s_mov_b64 exec, -1
    v_mfma_f32_16x16x32_bf16 v[188:191], v[224:227], v[168:171], 0
    ds_read_b128 v[240:243], v4 offset:36864
    v_mul_f32 v46, s23, v46
    v_mul_f32 v47, s23, v47
    v_mul_f32 v48, s23, v48
    v_mul_f32 v49, s23, v49
    v_mul_f32 v50, s23, v50
    v_mul_f32 v51, s23, v51
    s_and_b32 s29, s2, 7
    s_mul_i32 s29, s29, 28
    s_lshr_b32 s16, s2, 3
    s_add_u32 s29, s29, s16
    s_waitcnt lgkmcnt(3)
    v_mfma_f32_16x16x32_bf16 v[192:195], v[228:231], v[152:155], 0
    s_add_u32 s22, s21, 0x10000
    s_add_u32 m0, s20, 0x10000
    s_nop 0
    buffer_load_dwordx4 v2, s[8:11], s22 offen sc1 lds
    v_mul_f32 v52, s23, v52
    v_mul_f32 v53, s23, v53
    v_mul_f32 v54, s23, v54
    v_mul_f32 v55, s23, v55
    v_cvt_pk_bf16_f32 v156, v40, v41
    v_cvt_pk_bf16_f32 v157, v42, v43
    v_mfma_f32_16x16x32_bf16 v[196:199], v[228:231], v[168:171], 0
    ds_read_b128 v[244:247], v4 offset:37888
    v_cvt_pk_bf16_f32 v172, v44, v45
    v_cvt_pk_bf16_f32 v173, v46, v47
    v_cvt_pk_bf16_f32 v158, v48, v49
    v_cvt_pk_bf16_f32 v159, v50, v51
    v_cvt_pk_bf16_f32 v174, v52, v53
    v_cvt_pk_bf16_f32 v175, v54, v55
    s_waitcnt lgkmcnt(3)
    v_mfma_f32_16x16x32_bf16 v[184:187], v[232:235], v[156:159], v[184:187]
    v_mul_f32 v56, s23, v56
    v_mul_f32 v57, s23, v57
    v_mul_f32 v58, s23, v58
    v_mul_f32 v59, s23, v59
    v_mul_f32 v60, s23, v60
    v_mul_f32 v61, s23, v61
    v_mfma_f32_16x16x32_bf16 v[188:191], v[232:235], v[172:175], v[188:191]
    ds_read_b128 v[224:227], v4 offset:38912
    v_mul_f32 v62, s23, v62
    v_mul_f32 v63, s23, v63
    v_mul_f32 v64, s23, v64
    v_mul_f32 v65, s23, v65
    v_mul_f32 v66, s23, v66
    v_mul_f32 v67, s23, v67
    s_waitcnt lgkmcnt(3)
    v_mfma_f32_16x16x32_bf16 v[192:195], v[236:239], v[156:159], v[192:195]
    v_mul_f32 v68, s23, v68
    v_mul_f32 v69, s23, v69
    v_mul_f32 v70, s23, v70
    v_mul_f32 v71, s23, v71
    v_cvt_pk_bf16_f32 v160, v56, v57
    v_cvt_pk_bf16_f32 v161, v58, v59
    v_mfma_f32_16x16x32_bf16 v[196:199], v[236:239], v[172:175], v[196:199]
    ds_read_b128 v[228:231], v4 offset:39936
    v_cvt_pk_bf16_f32 v176, v60, v61
    v_cvt_pk_bf16_f32 v177, v62, v63
    v_cvt_pk_bf16_f32 v162, v64, v65
    v_cvt_pk_bf16_f32 v163, v66, v67
    v_cvt_pk_bf16_f32 v178, v68, v69
    v_cvt_pk_bf16_f32 v179, v70, v71
    s_waitcnt lgkmcnt(3)
    v_mfma_f32_16x16x32_bf16 v[184:187], v[240:243], v[160:163], v[184:187]
    v_mul_f32 v72, s23, v72
    v_mul_f32 v73, s23, v73
    v_mul_f32 v74, s23, v74
    v_mul_f32 v75, s23, v75
    v_mul_f32 v76, s23, v76
    v_mul_f32 v77, s23, v77
    v_mfma_f32_16x16x32_bf16 v[188:191], v[240:243], v[176:179], v[188:191]
    ds_read_b128 v[232:235], v4 offset:40960
    v_mul_f32 v78, s23, v78
    v_mul_f32 v79, s23, v79
    v_mul_f32 v80, s23, v80
    v_mul_f32 v81, s23, v81
    v_mul_f32 v82, s23, v82
    v_mul_f32 v83, s23, v83
    s_waitcnt lgkmcnt(3)
    v_mfma_f32_16x16x32_bf16 v[192:195], v[244:247], v[160:163], v[192:195]
    s_add_u32 s22, s21, 0x10400
    s_add_u32 m0, s20, 0x10400
    s_nop 0
    buffer_load_dwordx4 v2, s[8:11], s22 offen sc1 lds
    v_mul_f32 v84, s23, v84
    v_mul_f32 v85, s23, v85
    v_mul_f32 v86, s23, v86
    v_mul_f32 v87, s23, v87
    v_cvt_pk_bf16_f32 v164, v72, v73
    v_cvt_pk_bf16_f32 v165, v74, v75
    v_mfma_f32_16x16x32_bf16 v[196:199], v[244:247], v[176:179], v[196:199]
    ds_read_b128 v[236:239], v4 offset:41984
    v_cvt_pk_bf16_f32 v180, v76, v77
    v_cvt_pk_bf16_f32 v181, v78, v79
    v_cvt_pk_bf16_f32 v166, v80, v81
    v_cvt_pk_bf16_f32 v167, v82, v83
    v_cvt_pk_bf16_f32 v182, v84, v85
    v_cvt_pk_bf16_f32 v183, v86, v87
    s_waitcnt lgkmcnt(3)
    v_mfma_f32_16x16x32_bf16 v[184:187], v[224:227], v[164:167], v[184:187]
    v_mfma_f32_16x16x32_bf16 v[188:191], v[224:227], v[180:183], v[188:191]
    ds_read_b128 v[240:243], v4 offset:43008
    s_waitcnt lgkmcnt(3)
    v_mfma_f32_16x16x32_bf16 v[192:195], v[228:231], v[164:167], v[192:195]
    v_mfma_f32_16x16x32_bf16 v[196:199], v[228:231], v[180:183], v[196:199]
    ds_read_b128 v[244:247], v4 offset:44032
    s_waitcnt lgkmcnt(3)
    v_mfma_f32_16x16x32_bf16 v[200:203], v[232:235], v[152:155], 0
    v_mfma_f32_16x16x32_bf16 v[204:207], v[232:235], v[168:171], 0
    ds_read_b128 v[224:227], v4 offset:45056
    s_waitcnt lgkmcnt(3)
    v_mfma_f32_16x16x32_bf16 v[208:211], v[236:239], v[152:155], 0
    v_mfma_f32_16x16x32_bf16 v[212:215], v[236:239], v[168:171], 0
    ds_read_b128 v[228:231], v4 offset:46080
    s_waitcnt lgkmcnt(3)
    v_mfma_f32_16x16x32_bf16 v[200:203], v[240:243], v[156:159], v[200:203]
    v_mfma_f32_16x16x32_bf16 v[204:207], v[240:243], v[172:175], v[204:207]
    ds_read_b128 v[232:235], v4 offset:47104
    s_waitcnt lgkmcnt(3)
    v_mfma_f32_16x16x32_bf16 v[208:211], v[244:247], v[156:159], v[208:211]
    v_max3_f32 v16, v184, v185, v186
    v_mfma_f32_16x16x32_bf16 v[212:215], v[244:247], v[172:175], v[212:215]
    ds_read_b128 v[236:239], v4 offset:48128
    v_max3_f32 v16, v16, v187, v192
    s_waitcnt lgkmcnt(3)
    v_mfma_f32_16x16x32_bf16 v[200:203], v[224:227], v[160:163], v[200:203]
    v_max3_f32 v16, v16, v193, v194
    v_mfma_f32_16x16x32_bf16 v[204:207], v[224:227], v[176:179], v[204:207]
    s_barrier
    ds_read_b128 v[240:243], v4 offset:49152
    v_max_f32 v16, v16, v195
    s_waitcnt lgkmcnt(3)
    v_mfma_f32_16x16x32_bf16 v[208:211], v[228:231], v[160:163], v[208:211]
    v_max3_f32 v17, v188, v189, v190
    v_mfma_f32_16x16x32_bf16 v[212:215], v[228:231], v[176:179], v[212:215]
    s_add_u32 s22, s21, 0x14000
    s_add_u32 m0, s20, 0x14000
    s_nop 0
    buffer_load_dwordx4 v2, s[8:11], s22 offen sc1 lds
    ds_read_b128 v[244:247], v4 offset:50176
    v_max3_f32 v17, v17, v191, v196
    s_waitcnt lgkmcnt(3)
    v_mfma_f32_16x16x32_bf16 v[200:203], v[232:235], v[164:167], v[200:203]
    v_max3_f32 v17, v17, v197, v198
    v_mfma_f32_16x16x32_bf16 v[204:207], v[232:235], v[180:183], v[204:207]
    ds_read_b128 v[224:227], v4 offset:51200
    v_max_f32 v17, v17, v199
    s_waitcnt lgkmcnt(3)
    v_mfma_f32_16x16x32_bf16 v[208:211], v[236:239], v[164:167], v[208:211]
    v_mfma_f32_16x16x32_bf16 v[212:215], v[236:239], v[180:183], v[212:215]
    ds_read_b128 v[228:231], v4 offset:52224
    v_max3_f32 v16, v16, v200, v201
    v_max3_f32 v16, v16, v202, v203
    s_nop 3
    v_max3_f32 v16, v16, v208, v209
    v_max3_f32 v16, v16, v210, v211
    v_max3_f32 v17, v17, v204, v205
    v_max3_f32 v17, v17, v206, v207
    v_max3_f32 v17, v17, v212, v213
    v_max3_f32 v17, v17, v214, v215
    v_mov_b32 v18, v16
    v_mov_b32 v19, v17
    s_nop 0
    v_permlane16_swap_b32 v16, v18
    v_permlane16_swap_b32 v17, v19
    v_max_f32 v16, v16, v18
    v_max_f32 v17, v17, v19
    v_mov_b32 v18, v16
    v_mov_b32 v19, v17
    s_nop 0
    v_permlane32_swap_b32 v16, v18
    v_permlane32_swap_b32 v17, v19
    v_max_f32 v16, v16, v18
    v_max_f32 v17, v17, v19
    v_sub_f32 v216, 0, v16
    v_sub_f32 v217, 0, v16
    v_sub_f32 v218, 0, v16
    v_sub_f32 v219, 0, v16
    v_sub_f32 v220, 0, v17
    v_sub_f32 v221, 0, v17
    v_sub_f32 v222, 0, v17
    v_sub_f32 v223, 0, v17
    v_add_f32 v184, v184, v216
    v_add_f32 v185, v185, v216
    v_exp_f32 v184, v184
    v_exp_f32 v185, v185
    s_nop 0
    v_cvt_pk_bf16_f32 v24, v184, v185
    v_add_f32 v186, v186, v216
    v_add_f32 v187, v187, v216
    v_exp_f32 v186, v186
    v_exp_f32 v187, v187
    s_nop 0
    v_cvt_pk_bf16_f32 v25, v186, v187
    v_add_f32 v188, v188, v220
    v_add_f32 v189, v189, v220
    v_exp_f32 v188, v188
    v_exp_f32 v189, v189
    s_nop 0
    v_cvt_pk_bf16_f32 v28, v188, v189
    v_add_f32 v190, v190, v220
    v_add_f32 v191, v191, v220
    v_exp_f32 v190, v190
    v_exp_f32 v191, v191
    s_nop 0
    v_cvt_pk_bf16_f32 v29, v190, v191
    v_add_f32 v192, v192, v216
    v_add_f32 v193, v193, v216
    v_exp_f32 v192, v192
    v_exp_f32 v193, v193
    s_nop 0
    v_cvt_pk_bf16_f32 v26, v192, v193
    v_add_f32 v194, v194, v216
    v_add_f32 v195, v195, v216
    v_exp_f32 v194, v194
    v_exp_f32 v195, v195
    s_nop 0
    v_cvt_pk_bf16_f32 v27, v194, v195
    v_add_f32 v196, v196, v220
    v_add_f32 v197, v197, v220
    v_exp_f32 v196, v196
    v_exp_f32 v197, v197
    s_nop 0
    v_cvt_pk_bf16_f32 v30, v196, v197
    v_add_f32 v198, v198, v220
    v_add_f32 v199, v199, v220
    v_exp_f32 v198, v198
    v_exp_f32 v199, v199
    s_nop 0
    v_cvt_pk_bf16_f32 v31, v198, v199
    s_waitcnt lgkmcnt(3)
    v_mfma_f32_16x16x32_bf16 v[184:187], v[240:243], v[152:155], v[216:219]
    v_mfma_f32_16x16x32_bf16 v[188:191], v[240:243], v[168:171], v[220:223]
    ds_read_b128 v[232:235], v4 offset:53248
    v_add_f32 v200, v200, v216
    v_add_f32 v201, v201, v216
    v_exp_f32 v200, v200
    v_mfma_f32_16x16x32_bf16 v[248:251], v[12:15], v[24:27], 0
    s_waitcnt lgkmcnt(3)
    v_mfma_f32_16x16x32_bf16 v[192:195], v[244:247], v[152:155], v[216:219]
    v_exp_f32 v201, v201
    s_nop 0
    v_cvt_pk_bf16_f32 v32, v200, v201
    v_add_f32 v202, v202, v216
    v_mfma_f32_16x16x32_bf16 v[196:199], v[244:247], v[168:171], v[220:223]
    s_add_u32 s22, s21, 0x14400
    s_add_u32 m0, s20, 0x14400
    s_nop 0
    buffer_load_dwordx4 v2, s[8:11], s22 offen sc1 lds
    ds_read_b128 v[236:239], v4 offset:54272
    v_add_f32 v203, v203, v216
    v_exp_f32 v202, v202
    v_mfma_f32_16x16x32_bf16 v[252:255], v[12:15], v[28:31], 0
    s_waitcnt lgkmcnt(3)
    v_mfma_f32_16x16x32_bf16 v[184:187], v[224:227], v[156:159], v[184:187]
    v_exp_f32 v203, v203
    s_nop 0
    v_cvt_pk_bf16_f32 v33, v202, v203
    v_add_f32 v204, v204, v220
    v_mfma_f32_16x16x32_bf16 v[188:191], v[224:227], v[172:175], v[188:191]
    ds_read_b128 v[240:243], v4 offset:55296
    v_add_f32 v205, v205, v220
    v_exp_f32 v204, v204
    v_exp_f32 v205, v205
    s_mov_b64 s[4:5], s[40:41]
    s_mov_b32 s6, 0x800000
    s_mov_b32 s7, 0x20000
    v_bfe_u32 v20, v1, 2, 2
    v_lshlrev_b32 v21, 13, v20
    v_sub_u32 v3, v3, v21
    v_lshl_add_u32 v3, v20, 11, v3
    s_and_b32 s16, s2, 1
    s_lshl_b32 s24, s16, 22
    s_lshr_b32 s16, s2, 5
    s_lshl_b32 s16, s16, 8
    s_add_u32 s24, s24, s16
    s_lshl_b32 s16, s3, 14
    s_add_u32 s24, s24, s16
    s_waitcnt lgkmcnt(3)
    v_mfma_f32_16x16x32_bf16 v[192:195], v[228:231], v[156:159], v[192:195]
    v_cvt_pk_bf16_f32 v36, v204, v205
    v_add_f32 v206, v206, v220
    v_mfma_f32_16x16x32_bf16 v[196:199], v[228:231], v[172:175], v[196:199]
    ds_read_b128 v[244:247], v4 offset:56320
    v_add_f32 v207, v207, v220
    v_exp_f32 v206, v206
    v_exp_f32 v207, v207
    s_waitcnt lgkmcnt(3)
    v_mfma_f32_16x16x32_bf16 v[184:187], v[232:235], v[160:163], v[184:187]
    v_cvt_pk_bf16_f32 v37, v206, v207
    v_add_f32 v208, v208, v216
    v_add_f32 v209, v209, v216
    v_mfma_f32_16x16x32_bf16 v[188:191], v[232:235], v[176:179], v[188:191]
    ds_read_b128 v[224:227], v4 offset:57344
    v_exp_f32 v208, v208
    v_exp_f32 v209, v209
    s_waitcnt lgkmcnt(3)
    v_mfma_f32_16x16x32_bf16 v[192:195], v[236:239], v[160:163], v[192:195]
    v_cvt_pk_bf16_f32 v34, v208, v209
    v_add_f32 v210, v210, v216
    v_add_f32 v211, v211, v216
    v_mfma_f32_16x16x32_bf16 v[196:199], v[236:239], v[176:179], v[196:199]
    ds_read_b128 v[228:231], v4 offset:58368
    v_exp_f32 v210, v210
    v_exp_f32 v211, v211
    s_nop 0
    v_cvt_pk_bf16_f32 v35, v210, v211
    s_waitcnt lgkmcnt(3)
    v_mfma_f32_16x16x32_bf16 v[184:187], v[240:243], v[164:167], v[184:187]
    v_add_f32 v212, v212, v220
    v_add_f32 v213, v213, v220
    v_mfma_f32_16x16x32_bf16 v[188:191], v[240:243], v[180:183], v[188:191]
    ds_read_b128 v[232:235], v4 offset:59392
    v_exp_f32 v212, v212
    v_exp_f32 v213, v213
    s_nop 0
    v_cvt_pk_bf16_f32 v38, v212, v213
    s_waitcnt lgkmcnt(3)
    v_mfma_f32_16x16x32_bf16 v[192:195], v[244:247], v[164:167], v[192:195]
    v_add_f32 v214, v214, v220
    v_add_f32 v215, v215, v220
    v_exp_f32 v214, v214
    v_mfma_f32_16x16x32_bf16 v[196:199], v[244:247], v[180:183], v[196:199]
    ds_read_b128 v[236:239], v4 offset:60416
    v_exp_f32 v215, v215
    s_nop 0
    v_cvt_pk_bf16_f32 v39, v214, v215
    s_waitcnt lgkmcnt(3)
    v_mfma_f32_16x16x32_bf16 v[200:203], v[224:227], v[152:155], v[216:219]
    v_mfma_f32_16x16x32_bf16 v[204:207], v[224:227], v[168:171], v[220:223]
    ds_read_b128 v[240:243], v4 offset:61440
    v_exp_f32 v184, v184
    v_exp_f32 v185, v185
    v_mfma_f32_16x16x32_bf16 v[248:251], v[12:15], v[32:35], v[248:251]
    s_waitcnt lgkmcnt(3)
    v_mfma_f32_16x16x32_bf16 v[208:211], v[228:231], v[152:155], v[216:219]
    v_cvt_pk_bf16_f32 v40, v184, v185
    v_exp_f32 v186, v186
    v_mfma_f32_16x16x32_bf16 v[212:215], v[228:231], v[168:171], v[220:223]
    ds_read_b128 v[244:247], v4 offset:62464
    v_exp_f32 v187, v187
    v_mfma_f32_16x16x32_bf16 v[252:255], v[12:15], v[36:39], v[252:255]
    s_waitcnt lgkmcnt(3)
    v_mfma_f32_16x16x32_bf16 v[200:203], v[232:235], v[156:159], v[200:203]
    v_cvt_pk_bf16_f32 v41, v186, v187
    v_exp_f32 v188, v188
    v_mfma_f32_16x16x32_bf16 v[204:207], v[232:235], v[172:175], v[204:207]
    ds_read_b128 v[224:227], v4 offset:63488
    v_exp_f32 v189, v189
    s_waitcnt lgkmcnt(3)
    v_mfma_f32_16x16x32_bf16 v[208:211], v[236:239], v[156:159], v[208:211]
    v_cvt_pk_bf16_f32 v44, v188, v189
    v_exp_f32 v190, v190
    v_mfma_f32_16x16x32_bf16 v[212:215], v[236:239], v[172:175], v[212:215]
    ds_read_b128 v[228:231], v4 offset:64512
    v_exp_f32 v191, v191
    s_nop 0
    v_cvt_pk_bf16_f32 v45, v190, v191
    s_waitcnt lgkmcnt(3)
    v_mfma_f32_16x16x32_bf16 v[200:203], v[240:243], v[160:163], v[200:203]
    v_exp_f32 v192, v192
    v_mfma_f32_16x16x32_bf16 v[204:207], v[240:243], v[176:179], v[204:207]
    s_waitcnt vmcnt(7)
    s_barrier
    ds_read_b128 v[232:235], v5 offset:0
    v_exp_f32 v193, v193
    s_nop 0
    v_cvt_pk_bf16_f32 v42, v192, v193
    s_waitcnt lgkmcnt(3)
    v_mfma_f32_16x16x32_bf16 v[208:211], v[244:247], v[160:163], v[208:211]
    v_exp_f32 v194, v194
    v_mfma_f32_16x16x32_bf16 v[212:215], v[244:247], v[176:179], v[212:215]
    s_add_u32 s22, s21, 0x18000
    s_add_u32 m0, s20, 0x18000
    s_nop 0
    buffer_load_dwordx4 v2, s[8:11], s22 offen sc1 lds
    ds_read_b128 v[236:239], v5 offset:1024
    v_exp_f32 v195, v195
    s_nop 0
    v_cvt_pk_bf16_f32 v43, v194, v195
    s_waitcnt lgkmcnt(3)
    v_mfma_f32_16x16x32_bf16 v[200:203], v[224:227], v[164:167], v[200:203]
    v_exp_f32 v196, v196
    v_exp_f32 v197, v197
    v_mfma_f32_16x16x32_bf16 v[204:207], v[224:227], v[180:183], v[204:207]
    ds_read_b128 v[240:243], v5 offset:2048
    v_cvt_pk_bf16_f32 v46, v196, v197
    s_waitcnt lgkmcnt(3)
    v_mfma_f32_16x16x32_bf16 v[208:211], v[228:231], v[164:167], v[208:211]
    v_exp_f32 v198, v198
    v_exp_f32 v199, v199
    v_mfma_f32_16x16x32_bf16 v[212:215], v[228:231], v[180:183], v[212:215]
    ds_read_b128 v[244:247], v5 offset:3072
    v_cvt_pk_bf16_f32 v47, v198, v199
    s_waitcnt lgkmcnt(3)
    v_mfma_f32_16x16x32_bf16 v[184:187], v[232:235], v[152:155], v[216:219]
    v_mfma_f32_16x16x32_bf16 v[188:191], v[232:235], v[168:171], v[220:223]
    ds_read_b128 v[224:227], v5 offset:4096
    v_exp_f32 v200, v200
    v_exp_f32 v201, v201
    v_mfma_f32_16x16x32_bf16 v[248:251], v[12:15], v[40:43], v[248:251]
    s_waitcnt lgkmcnt(3)
    v_mfma_f32_16x16x32_bf16 v[192:195], v[236:239], v[152:155], v[216:219]
    v_cvt_pk_bf16_f32 v48, v200, v201
    v_exp_f32 v202, v202
    v_mfma_f32_16x16x32_bf16 v[196:199], v[236:239], v[168:171], v[220:223]
    s_add_u32 s22, s21, 0x18400
    s_add_u32 m0, s20, 0x18400
    s_nop 0
    buffer_load_dwordx4 v2, s[8:11], s22 offen sc1 lds
    ds_read_b128 v[228:231], v5 offset:5120
    v_exp_f32 v203, v203
    v_mfma_f32_16x16x32_bf16 v[252:255], v[12:15], v[44:47], v[252:255]
    s_waitcnt lgkmcnt(3)
    v_mfma_f32_16x16x32_bf16 v[184:187], v[240:243], v[156:159], v[184:187]
    v_cvt_pk_bf16_f32 v49, v202, v203
    v_exp_f32 v204, v204
    v_mfma_f32_16x16x32_bf16 v[188:191], v[240:243], v[172:175], v[188:191]
    ds_read_b128 v[232:235], v5 offset:6144
    v_exp_f32 v205, v205
    s_waitcnt lgkmcnt(3)
    v_mfma_f32_16x16x32_bf16 v[192:195], v[244:247], v[156:159], v[192:195]
    v_cvt_pk_bf16_f32 v52, v204, v205
    v_exp_f32 v206, v206
    v_mfma_f32_16x16x32_bf16 v[196:199], v[244:247], v[172:175], v[196:199]
    ds_read_b128 v[236:239], v5 offset:7168
    v_exp_f32 v207, v207
    s_nop 0
    v_cvt_pk_bf16_f32 v53, v206, v207
    s_waitcnt lgkmcnt(3)
    v_mfma_f32_16x16x32_bf16 v[184:187], v[224:227], v[160:163], v[184:187]
    v_exp_f32 v208, v208
    v_mfma_f32_16x16x32_bf16 v[188:191], v[224:227], v[176:179], v[188:191]
    ds_read_b128 v[240:243], v5 offset:8192
    v_exp_f32 v209, v209
    s_nop 0
    v_cvt_pk_bf16_f32 v50, v208, v209
    s_waitcnt lgkmcnt(3)
    v_mfma_f32_16x16x32_bf16 v[192:195], v[228:231], v[160:163], v[192:195]
    v_exp_f32 v210, v210
    v_mfma_f32_16x16x32_bf16 v[196:199], v[228:231], v[176:179], v[196:199]
    ds_read_b128 v[244:247], v5 offset:9216
    v_exp_f32 v211, v211
    s_nop 0
    v_cvt_pk_bf16_f32 v51, v210, v211
    s_waitcnt lgkmcnt(3)
    v_mfma_f32_16x16x32_bf16 v[184:187], v[232:235], v[164:167], v[184:187]
    v_exp_f32 v212, v212
    v_exp_f32 v213, v213
    v_mfma_f32_16x16x32_bf16 v[188:191], v[232:235], v[180:183], v[188:191]
    ds_read_b128 v[224:227], v5 offset:10240
    v_cvt_pk_bf16_f32 v54, v212, v213
    s_waitcnt lgkmcnt(3)
    v_mfma_f32_16x16x32_bf16 v[192:195], v[236:239], v[164:167], v[192:195]
    v_exp_f32 v214, v214
    v_exp_f32 v215, v215
    v_mfma_f32_16x16x32_bf16 v[196:199], v[236:239], v[180:183], v[196:199]
    ds_read_b128 v[228:231], v5 offset:11264
    v_cvt_pk_bf16_f32 v55, v214, v215
    s_waitcnt lgkmcnt(3)
    v_mfma_f32_16x16x32_bf16 v[200:203], v[240:243], v[152:155], v[216:219]
    v_mfma_f32_16x16x32_bf16 v[204:207], v[240:243], v[168:171], v[220:223]
    ds_read_b128 v[232:235], v5 offset:12288
    v_exp_f32 v184, v184
    v_exp_f32 v185, v185
    v_mfma_f32_16x16x32_bf16 v[248:251], v[12:15], v[48:51], v[248:251]
    s_waitcnt lgkmcnt(3)
    v_mfma_f32_16x16x32_bf16 v[208:211], v[244:247], v[152:155], v[216:219]
    v_cvt_pk_bf16_f32 v56, v184, v185
    v_exp_f32 v186, v186
    v_mfma_f32_16x16x32_bf16 v[212:215], v[244:247], v[168:171], v[220:223]
    ds_read_b128 v[236:239], v5 offset:13312
    v_exp_f32 v187, v187
    v_mfma_f32_16x16x32_bf16 v[252:255], v[12:15], v[52:55], v[252:255]
    s_waitcnt lgkmcnt(3)
    v_mfma_f32_16x16x32_bf16 v[200:203], v[224:227], v[156:159], v[200:203]
    v_cvt_pk_bf16_f32 v57, v186, v187
    v_exp_f32 v188, v188
    v_mfma_f32_16x16x32_bf16 v[204:207], v[224:227], v[172:175], v[204:207]
    ds_read_b128 v[240:243], v5 offset:14336
    v_exp_f32 v189, v189
    s_waitcnt lgkmcnt(3)
    v_mfma_f32_16x16x32_bf16 v[208:211], v[228:231], v[156:159], v[208:211]
    v_cvt_pk_bf16_f32 v60, v188, v189
    v_exp_f32 v190, v190
    s_waitcnt vmcnt(6)
    v_mfma_f32_16x16x32_bf16 v[212:215], v[228:231], v[172:175], v[212:215]
    ds_read_b128 v[244:247], v5 offset:15360
    v_exp_f32 v191, v191
    s_nop 0
    v_cvt_pk_bf16_f32 v61, v190, v191
    s_waitcnt lgkmcnt(3)
    v_mfma_f32_16x16x32_bf16 v[200:203], v[232:235], v[160:163], v[200:203]
    v_exp_f32 v192, v192
    v_mfma_f32_16x16x32_bf16 v[204:207], v[232:235], v[176:179], v[204:207]
    s_barrier
    ds_read_b128 v[224:227], v5 offset:16384
    v_exp_f32 v193, v193
    s_nop 0
    v_cvt_pk_bf16_f32 v58, v192, v193
    s_waitcnt lgkmcnt(3)
    v_mfma_f32_16x16x32_bf16 v[208:211], v[236:239], v[160:163], v[208:211]
    v_exp_f32 v194, v194
    v_mfma_f32_16x16x32_bf16 v[212:215], v[236:239], v[176:179], v[212:215]
    s_add_u32 s22, s21, 0x1c000
    s_add_u32 m0, s20, 0x1c000
    s_nop 0
    buffer_load_dwordx4 v2, s[8:11], s22 offen sc1 lds
    ds_read_b128 v[228:231], v5 offset:17408
    v_exp_f32 v195, v195
    s_nop 0
    v_cvt_pk_bf16_f32 v59, v194, v195
    s_waitcnt lgkmcnt(3)
    v_mfma_f32_16x16x32_bf16 v[200:203], v[240:243], v[164:167], v[200:203]
    v_exp_f32 v196, v196
    v_exp_f32 v197, v197
    v_mfma_f32_16x16x32_bf16 v[204:207], v[240:243], v[180:183], v[204:207]
    ds_read_b128 v[232:235], v5 offset:18432
    v_cvt_pk_bf16_f32 v62, v196, v197
    s_waitcnt lgkmcnt(3)
    v_mfma_f32_16x16x32_bf16 v[208:211], v[244:247], v[164:167], v[208:211]
    v_exp_f32 v198, v198
    v_exp_f32 v199, v199
    v_mov_b32 v20, s28
    v_mov_b32 v21, 0
    s_lshl_b32 s16, s2, 2
    s_add_u32 s16, s16, 0x560000
    s_cmp_eq_u32 s3, 0
    s_cselect_b32 s16, s16, 0x7ffffff0
    s_mov_b64 exec, 1
    buffer_store_dword v20, v21, s[8:11], s16 offen sc1
    s_mov_b64 exec, -1
    v_mfma_f32_16x16x32_bf16 v[212:215], v[244:247], v[180:183], v[212:215]
    ds_read_b128 v[236:239], v5 offset:19456
    v_cvt_pk_bf16_f32 v63, v198, v199
    s_waitcnt lgkmcnt(3)
    v_mfma_f32_16x16x32_bf16 v[184:187], v[224:227], v[152:155], v[216:219]
    v_mfma_f32_16x16x32_bf16 v[188:191], v[224:227], v[168:171], v[220:223]
    ds_read_b128 v[240:243], v5 offset:20480
    v_exp_f32 v200, v200
    v_exp_f32 v201, v201
    v_mfma_f32_16x16x32_bf16 v[248:251], v[12:15], v[56:59], v[248:251]
    s_waitcnt lgkmcnt(3)
    v_mfma_f32_16x16x32_bf16 v[192:195], v[228:231], v[152:155], v[216:219]
    v_cvt_pk_bf16_f32 v64, v200, v201
    v_exp_f32 v202, v202
    v_mfma_f32_16x16x32_bf16 v[196:199], v[228:231], v[168:171], v[220:223]
    s_add_u32 s22, s21, 0x1c400
    s_add_u32 m0, s20, 0x1c400
    s_nop 0
    buffer_load_dwordx4 v2, s[8:11], s22 offen sc1 lds
    ds_read_b128 v[244:247], v5 offset:21504
    v_exp_f32 v203, v203
    v_mfma_f32_16x16x32_bf16 v[252:255], v[12:15], v[60:63], v[252:255]
    s_waitcnt lgkmcnt(3)
    v_mfma_f32_16x16x32_bf16 v[184:187], v[232:235], v[156:159], v[184:187]
    v_cvt_pk_bf16_f32 v65, v202, v203
    v_exp_f32 v204, v204
    v_mfma_f32_16x16x32_bf16 v[188:191], v[232:235], v[172:175], v[188:191]
    ds_read_b128 v[224:227], v5 offset:22528
    v_exp_f32 v205, v205
    s_waitcnt lgkmcnt(3)
    v_mfma_f32_16x16x32_bf16 v[192:195], v[236:239], v[156:159], v[192:195]
    v_cvt_pk_bf16_f32 v68, v204, v205
    v_exp_f32 v206, v206
    v_mfma_f32_16x16x32_bf16 v[196:199], v[236:239], v[172:175], v[196:199]
    ds_read_b128 v[228:231], v5 offset:23552
    v_exp_f32 v207, v207
    s_nop 0
    v_cvt_pk_bf16_f32 v69, v206, v207
    s_waitcnt lgkmcnt(3)
    v_mfma_f32_16x16x32_bf16 v[184:187], v[240:243], v[160:163], v[184:187]
    v_exp_f32 v208, v208
    v_mfma_f32_16x16x32_bf16 v[188:191], v[240:243], v[176:179], v[188:191]
    ds_read_b128 v[232:235], v5 offset:24576
    v_exp_f32 v209, v209
    s_nop 0
    v_cvt_pk_bf16_f32 v66, v208, v209
    s_waitcnt lgkmcnt(3)
    v_mfma_f32_16x16x32_bf16 v[192:195], v[244:247], v[160:163], v[192:195]
    v_exp_f32 v210, v210
    v_mfma_f32_16x16x32_bf16 v[196:199], v[244:247], v[176:179], v[196:199]
    ds_read_b128 v[236:239], v5 offset:25600
    v_exp_f32 v211, v211
    s_nop 0
    v_cvt_pk_bf16_f32 v67, v210, v211
    s_waitcnt lgkmcnt(3)
    v_mfma_f32_16x16x32_bf16 v[184:187], v[224:227], v[164:167], v[184:187]
    v_exp_f32 v212, v212
    v_exp_f32 v213, v213
    v_mfma_f32_16x16x32_bf16 v[188:191], v[224:227], v[180:183], v[188:191]
    ds_read_b128 v[240:243], v5 offset:26624
    v_cvt_pk_bf16_f32 v70, v212, v213
    s_waitcnt lgkmcnt(3)
    v_mfma_f32_16x16x32_bf16 v[192:195], v[228:231], v[164:167], v[192:195]
    v_exp_f32 v214, v214
    v_exp_f32 v215, v215
    v_mfma_f32_16x16x32_bf16 v[196:199], v[228:231], v[180:183], v[196:199]
    ds_read_b128 v[244:247], v5 offset:27648
    v_cvt_pk_bf16_f32 v71, v214, v215
    s_waitcnt lgkmcnt(3)
    v_mfma_f32_16x16x32_bf16 v[200:203], v[232:235], v[152:155], v[216:219]
    v_mfma_f32_16x16x32_bf16 v[204:207], v[232:235], v[168:171], v[220:223]
    ds_read_b128 v[224:227], v5 offset:28672
    v_exp_f32 v184, v184
    v_exp_f32 v185, v185
    v_mfma_f32_16x16x32_bf16 v[248:251], v[12:15], v[64:67], v[248:251]
    s_waitcnt lgkmcnt(3)
    v_mfma_f32_16x16x32_bf16 v[208:211], v[236:239], v[152:155], v[216:219]
    v_cvt_pk_bf16_f32 v72, v184, v185
    v_exp_f32 v186, v186
    v_mfma_f32_16x16x32_bf16 v[212:215], v[236:239], v[168:171], v[220:223]
    ds_read_b128 v[228:231], v5 offset:29696
    v_exp_f32 v187, v187
    v_mfma_f32_16x16x32_bf16 v[252:255], v[12:15], v[68:71], v[252:255]
    s_waitcnt lgkmcnt(3)
    v_mfma_f32_16x16x32_bf16 v[200:203], v[240:243], v[156:159], v[200:203]
    v_cvt_pk_bf16_f32 v73, v186, v187
    v_exp_f32 v188, v188
    v_mfma_f32_16x16x32_bf16 v[204:207], v[240:243], v[172:175], v[204:207]
    ds_read_b128 v[232:235], v5 offset:30720
    v_exp_f32 v189, v189
    s_waitcnt lgkmcnt(3)
    v_mfma_f32_16x16x32_bf16 v[208:211], v[244:247], v[156:159], v[208:211]
    v_cvt_pk_bf16_f32 v76, v188, v189
    v_exp_f32 v190, v190
    v_mfma_f32_16x16x32_bf16 v[212:215], v[244:247], v[172:175], v[212:215]
    ds_read_b128 v[236:239], v5 offset:31744
    v_exp_f32 v191, v191
    s_nop 0
    v_cvt_pk_bf16_f32 v77, v190, v191
    s_waitcnt lgkmcnt(3)
    v_mfma_f32_16x16x32_bf16 v[200:203], v[224:227], v[160:163], v[200:203]
    v_exp_f32 v192, v192
    v_mfma_f32_16x16x32_bf16 v[204:207], v[224:227], v[176:179], v[204:207]
    s_waitcnt vmcnt(7)
    s_barrier
    ds_read_b128 v[240:243], v4 offset:0
    v_exp_f32 v193, v193
    s_nop 0
    v_cvt_pk_bf16_f32 v74, v192, v193
    s_waitcnt lgkmcnt(3)
    v_mfma_f32_16x16x32_bf16 v[208:211], v[228:231], v[160:163], v[208:211]
    v_exp_f32 v194, v194
    v_mfma_f32_16x16x32_bf16 v[212:215], v[228:231], v[176:179], v[212:215]
    s_add_u32 s22, s21, 0x80000
    s_add_u32 m0, s20, 0x20000
    s_nop 0
    buffer_load_dwordx4 v2, s[8:11], s22 offen sc1 lds
    ds_read_b128 v[244:247], v4 offset:1024
    v_exp_f32 v195, v195
    s_nop 0
    v_cvt_pk_bf16_f32 v75, v194, v195
    s_waitcnt lgkmcnt(3)
    v_mfma_f32_16x16x32_bf16 v[200:203], v[232:235], v[164:167], v[200:203]
    v_exp_f32 v196, v196
    v_exp_f32 v197, v197
    v_mfma_f32_16x16x32_bf16 v[204:207], v[232:235], v[180:183], v[204:207]
    ds_read_b128 v[224:227], v4 offset:2048
    v_cvt_pk_bf16_f32 v78, v196, v197
    s_waitcnt lgkmcnt(3)
    v_mfma_f32_16x16x32_bf16 v[208:211], v[236:239], v[164:167], v[208:211]
    v_exp_f32 v198, v198
    v_exp_f32 v199, v199
    v_mfma_f32_16x16x32_bf16 v[212:215], v[236:239], v[180:183], v[212:215]
    ds_read_b128 v[228:231], v4 offset:3072
    v_cvt_pk_bf16_f32 v79, v198, v199
    s_waitcnt lgkmcnt(3)
    v_mfma_f32_16x16x32_bf16 v[184:187], v[240:243], v[152:155], v[216:219]
    v_mfma_f32_16x16x32_bf16 v[188:191], v[240:243], v[168:171], v[220:223]
    ds_read_b128 v[232:235], v4 offset:4096
    v_exp_f32 v200, v200
    v_exp_f32 v201, v201
    v_mfma_f32_16x16x32_bf16 v[248:251], v[12:15], v[72:75], v[248:251]
    s_waitcnt lgkmcnt(3)
    v_mfma_f32_16x16x32_bf16 v[192:195], v[244:247], v[152:155], v[216:219]
    v_cvt_pk_bf16_f32 v80, v200, v201
    v_exp_f32 v202, v202
    v_mfma_f32_16x16x32_bf16 v[196:199], v[244:247], v[168:171], v[220:223]
    s_add_u32 s22, s21, 0x80400
    s_add_u32 m0, s20, 0x20400
    s_nop 0
    buffer_load_dwordx4 v2, s[8:11], s22 offen sc1 lds
    ds_read_b128 v[236:239], v4 offset:5120
    v_exp_f32 v203, v203
    v_mfma_f32_16x16x32_bf16 v[252:255], v[12:15], v[76:79], v[252:255]
    s_waitcnt lgkmcnt(3)
    v_mfma_f32_16x16x32_bf16 v[184:187], v[224:227], v[156:159], v[184:187]
    v_cvt_pk_bf16_f32 v81, v202, v203
    v_exp_f32 v204, v204
    v_mfma_f32_16x16x32_bf16 v[188:191], v[224:227], v[172:175], v[188:191]
    ds_read_b128 v[240:243], v4 offset:6144
    v_exp_f32 v205, v205
    s_waitcnt lgkmcnt(3)
    v_mfma_f32_16x16x32_bf16 v[192:195], v[228:231], v[156:159], v[192:195]
    v_cvt_pk_bf16_f32 v84, v204, v205
    v_exp_f32 v206, v206
    v_mfma_f32_16x16x32_bf16 v[196:199], v[228:231], v[172:175], v[196:199]
    ds_read_b128 v[244:247], v4 offset:7168
    v_exp_f32 v207, v207
    s_nop 0
    v_cvt_pk_bf16_f32 v85, v206, v207
    s_waitcnt lgkmcnt(3)
    v_mfma_f32_16x16x32_bf16 v[184:187], v[232:235], v[160:163], v[184:187]
    v_exp_f32 v208, v208
    v_mfma_f32_16x16x32_bf16 v[188:191], v[232:235], v[176:179], v[188:191]
    ds_read_b128 v[224:227], v4 offset:8192
    v_exp_f32 v209, v209
    s_nop 0
    v_cvt_pk_bf16_f32 v82, v208, v209
    s_waitcnt lgkmcnt(3)
    v_mfma_f32_16x16x32_bf16 v[192:195], v[236:239], v[160:163], v[192:195]
    v_exp_f32 v210, v210
    v_mfma_f32_16x16x32_bf16 v[196:199], v[236:239], v[176:179], v[196:199]
    ds_read_b128 v[228:231], v4 offset:9216
    v_exp_f32 v211, v211
    s_nop 0
    v_cvt_pk_bf16_f32 v83, v210, v211
    s_waitcnt lgkmcnt(3)
    v_mfma_f32_16x16x32_bf16 v[184:187], v[240:243], v[164:167], v[184:187]
    v_exp_f32 v212, v212
    v_exp_f32 v213, v213
    v_mfma_f32_16x16x32_bf16 v[188:191], v[240:243], v[180:183], v[188:191]
    ds_read_b128 v[232:235], v4 offset:10240
    v_cvt_pk_bf16_f32 v86, v212, v213
    s_waitcnt lgkmcnt(3)
    v_mfma_f32_16x16x32_bf16 v[192:195], v[244:247], v[164:167], v[192:195]
    v_exp_f32 v214, v214
    v_exp_f32 v215, v215
    v_mfma_f32_16x16x32_bf16 v[196:199], v[244:247], v[180:183], v[196:199]
    ds_read_b128 v[236:239], v4 offset:11264
    v_cvt_pk_bf16_f32 v87, v214, v215
    s_waitcnt lgkmcnt(3)
    v_mfma_f32_16x16x32_bf16 v[200:203], v[224:227], v[152:155], v[216:219]
    v_mfma_f32_16x16x32_bf16 v[204:207], v[224:227], v[168:171], v[220:223]
    ds_read_b128 v[240:243], v4 offset:12288
    v_exp_f32 v184, v184
    v_exp_f32 v185, v185
    v_mfma_f32_16x16x32_bf16 v[248:251], v[12:15], v[80:83], v[248:251]
    s_waitcnt lgkmcnt(3)
    v_mfma_f32_16x16x32_bf16 v[208:211], v[228:231], v[152:155], v[216:219]
    v_cvt_pk_bf16_f32 v88, v184, v185
    v_exp_f32 v186, v186
    v_mfma_f32_16x16x32_bf16 v[212:215], v[228:231], v[168:171], v[220:223]
    ds_read_b128 v[244:247], v4 offset:13312
    v_exp_f32 v187, v187
    v_mfma_f32_16x16x32_bf16 v[252:255], v[12:15], v[84:87], v[252:255]
    s_waitcnt lgkmcnt(3)
    v_mfma_f32_16x16x32_bf16 v[200:203], v[232:235], v[156:159], v[200:203]
    v_cvt_pk_bf16_f32 v89, v186, v187
    v_exp_f32 v188, v188
    v_mfma_f32_16x16x32_bf16 v[204:207], v[232:235], v[172:175], v[204:207]
    ds_read_b128 v[224:227], v4 offset:14336
    v_exp_f32 v189, v189
    s_waitcnt lgkmcnt(3)
    v_mfma_f32_16x16x32_bf16 v[208:211], v[236:239], v[156:159], v[208:211]
    v_cvt_pk_bf16_f32 v92, v188, v189
    v_exp_f32 v190, v190
    v_mfma_f32_16x16x32_bf16 v[212:215], v[236:239], v[172:175], v[212:215]
    ds_read_b128 v[228:231], v4 offset:15360
    v_exp_f32 v191, v191
    s_nop 0
    v_cvt_pk_bf16_f32 v93, v190, v191
    s_waitcnt lgkmcnt(3)
    v_mfma_f32_16x16x32_bf16 v[200:203], v[240:243], v[160:163], v[200:203]
    v_exp_f32 v192, v192
    v_mfma_f32_16x16x32_bf16 v[204:207], v[240:243], v[176:179], v[204:207]
    s_waitcnt vmcnt(7)
    s_barrier
    ds_read_b128 v[232:235], v4 offset:16384
    v_exp_f32 v193, v193
    s_nop 0
    v_cvt_pk_bf16_f32 v90, v192, v193
    s_waitcnt lgkmcnt(3)
    v_mfma_f32_16x16x32_bf16 v[208:211], v[244:247], v[160:163], v[208:211]
    v_exp_f32 v194, v194
    v_mfma_f32_16x16x32_bf16 v[212:215], v[244:247], v[176:179], v[212:215]
    s_add_u32 s22, s21, 0x84000
    s_add_u32 m0, s20, 0x24000
    s_nop 0
    buffer_load_dwordx4 v2, s[8:11], s22 offen sc1 lds
    ds_read_b128 v[236:239], v4 offset:17408
    v_exp_f32 v195, v195
    s_nop 0
    v_cvt_pk_bf16_f32 v91, v194, v195
    s_waitcnt lgkmcnt(3)
    v_mfma_f32_16x16x32_bf16 v[200:203], v[224:227], v[164:167], v[200:203]
    v_exp_f32 v196, v196
    v_exp_f32 v197, v197
    v_mfma_f32_16x16x32_bf16 v[204:207], v[224:227], v[180:183], v[204:207]
    ds_read_b128 v[240:243], v4 offset:18432
    v_cvt_pk_bf16_f32 v94, v196, v197
    s_waitcnt lgkmcnt(3)
    v_mfma_f32_16x16x32_bf16 v[208:211], v[228:231], v[164:167], v[208:211]
    v_exp_f32 v198, v198
    v_exp_f32 v199, v199
    v_mfma_f32_16x16x32_bf16 v[212:215], v[228:231], v[180:183], v[212:215]
    ds_read_b128 v[244:247], v4 offset:19456
    v_cvt_pk_bf16_f32 v95, v198, v199
    s_waitcnt lgkmcnt(3)
    v_mfma_f32_16x16x32_bf16 v[184:187], v[232:235], v[152:155], v[216:219]
    v_mfma_f32_16x16x32_bf16 v[188:191], v[232:235], v[168:171], v[220:223]
    ds_read_b128 v[224:227], v4 offset:20480
    v_exp_f32 v200, v200
    v_exp_f32 v201, v201
    v_mfma_f32_16x16x32_bf16 v[248:251], v[12:15], v[88:91], v[248:251]
    s_waitcnt lgkmcnt(3)
    v_mfma_f32_16x16x32_bf16 v[192:195], v[236:239], v[152:155], v[216:219]
    v_cvt_pk_bf16_f32 v96, v200, v201
    v_exp_f32 v202, v202
    v_mfma_f32_16x16x32_bf16 v[196:199], v[236:239], v[168:171], v[220:223]
    s_add_u32 s22, s21, 0x84400
    s_add_u32 m0, s20, 0x24400
    s_nop 0
    buffer_load_dwordx4 v2, s[8:11], s22 offen sc1 lds
    ds_read_b128 v[228:231], v4 offset:21504
    v_exp_f32 v203, v203
    v_mfma_f32_16x16x32_bf16 v[252:255], v[12:15], v[92:95], v[252:255]
    s_waitcnt lgkmcnt(3)
    v_mfma_f32_16x16x32_bf16 v[184:187], v[240:243], v[156:159], v[184:187]
    v_cvt_pk_bf16_f32 v97, v202, v203
    v_exp_f32 v204, v204
    v_mfma_f32_16x16x32_bf16 v[188:191], v[240:243], v[172:175], v[188:191]
    ds_read_b128 v[232:235], v4 offset:22528
    v_exp_f32 v205, v205
    s_waitcnt lgkmcnt(3)
    v_mfma_f32_16x16x32_bf16 v[192:195], v[244:247], v[156:159], v[192:195]
    v_cvt_pk_bf16_f32 v100, v204, v205
    v_exp_f32 v206, v206
    v_mfma_f32_16x16x32_bf16 v[196:199], v[244:247], v[172:175], v[196:199]
    ds_read_b128 v[236:239], v4 offset:23552
    v_exp_f32 v207, v207
    s_nop 0
    v_cvt_pk_bf16_f32 v101, v206, v207
    s_waitcnt lgkmcnt(3)
    v_mfma_f32_16x16x32_bf16 v[184:187], v[224:227], v[160:163], v[184:187]
    v_exp_f32 v208, v208
    v_mfma_f32_16x16x32_bf16 v[188:191], v[224:227], v[176:179], v[188:191]
    ds_read_b128 v[240:243], v4 offset:24576
    v_exp_f32 v209, v209
    s_nop 0
    v_cvt_pk_bf16_f32 v98, v208, v209
    s_waitcnt lgkmcnt(3)
    v_mfma_f32_16x16x32_bf16 v[192:195], v[228:231], v[160:163], v[192:195]
    v_exp_f32 v210, v210
    v_mfma_f32_16x16x32_bf16 v[196:199], v[228:231], v[176:179], v[196:199]
    ds_read_b128 v[244:247], v4 offset:25600
    v_exp_f32 v211, v211
    s_nop 0
    v_cvt_pk_bf16_f32 v99, v210, v211
    s_waitcnt lgkmcnt(3)
    v_mfma_f32_16x16x32_bf16 v[184:187], v[232:235], v[164:167], v[184:187]
    v_exp_f32 v212, v212
    v_exp_f32 v213, v213
    v_mfma_f32_16x16x32_bf16 v[188:191], v[232:235], v[180:183], v[188:191]
    ds_read_b128 v[224:227], v4 offset:26624
    v_cvt_pk_bf16_f32 v102, v212, v213
    s_waitcnt lgkmcnt(3)
    v_mfma_f32_16x16x32_bf16 v[192:195], v[236:239], v[164:167], v[192:195]
    v_exp_f32 v214, v214
    v_exp_f32 v215, v215
    v_mfma_f32_16x16x32_bf16 v[196:199], v[236:239], v[180:183], v[196:199]
    ds_read_b128 v[228:231], v4 offset:27648
    v_cvt_pk_bf16_f32 v103, v214, v215
    s_waitcnt lgkmcnt(3)
    v_mfma_f32_16x16x32_bf16 v[200:203], v[240:243], v[152:155], v[216:219]
    v_mfma_f32_16x16x32_bf16 v[204:207], v[240:243], v[168:171], v[220:223]
    ds_read_b128 v[232:235], v4 offset:28672
    v_exp_f32 v184, v184
    v_exp_f32 v185, v185
    v_mfma_f32_16x16x32_bf16 v[248:251], v[12:15], v[96:99], v[248:251]
    s_waitcnt lgkmcnt(3)
    v_mfma_f32_16x16x32_bf16 v[208:211], v[244:247], v[152:155], v[216:219]
    v_cvt_pk_bf16_f32 v104, v184, v185
    v_exp_f32 v186, v186
    v_mfma_f32_16x16x32_bf16 v[212:215], v[244:247], v[168:171], v[220:223]
    ds_read_b128 v[236:239], v4 offset:29696
    v_exp_f32 v187, v187
    v_mfma_f32_16x16x32_bf16 v[252:255], v[12:15], v[100:103], v[252:255]
    s_waitcnt lgkmcnt(3)
    v_mfma_f32_16x16x32_bf16 v[200:203], v[224:227], v[156:159], v[200:203]
    v_cvt_pk_bf16_f32 v105, v186, v187
    v_exp_f32 v188, v188
    v_mfma_f32_16x16x32_bf16 v[204:207], v[224:227], v[172:175], v[204:207]
    ds_read_b128 v[240:243], v4 offset:30720
    v_exp_f32 v189, v189
    s_waitcnt lgkmcnt(3)
    v_mfma_f32_16x16x32_bf16 v[208:211], v[228:231], v[156:159], v[208:211]
    v_cvt_pk_bf16_f32 v108, v188, v189
    v_exp_f32 v190, v190
    v_mfma_f32_16x16x32_bf16 v[212:215], v[228:231], v[172:175], v[212:215]
    ds_read_b128 v[244:247], v4 offset:31744
    v_exp_f32 v191, v191
    s_nop 0
    v_cvt_pk_bf16_f32 v109, v190, v191
    s_waitcnt lgkmcnt(3)
    v_mfma_f32_16x16x32_bf16 v[200:203], v[232:235], v[160:163], v[200:203]
    v_exp_f32 v192, v192
    v_mfma_f32_16x16x32_bf16 v[204:207], v[232:235], v[176:179], v[204:207]
    s_waitcnt vmcnt(7)
    s_barrier
    ds_read_b128 v[224:227], v4 offset:32768
    v_exp_f32 v193, v193
    s_nop 0
    v_cvt_pk_bf16_f32 v106, v192, v193
    s_waitcnt lgkmcnt(3)
    v_mfma_f32_16x16x32_bf16 v[208:211], v[236:239], v[160:163], v[208:211]
    v_exp_f32 v194, v194
    v_mfma_f32_16x16x32_bf16 v[212:215], v[236:239], v[176:179], v[212:215]
    s_add_u32 s22, s21, 0x88000
    s_add_u32 m0, s20, 0x10000
    s_nop 0
    buffer_load_dwordx4 v2, s[8:11], s22 offen sc1 lds
    ds_read_b128 v[228:231], v4 offset:33792
    v_exp_f32 v195, v195
    s_nop 0
    v_cvt_pk_bf16_f32 v107, v194, v195
    s_waitcnt lgkmcnt(3)
    v_mfma_f32_16x16x32_bf16 v[200:203], v[240:243], v[164:167], v[200:203]
    v_exp_f32 v196, v196
    v_exp_f32 v197, v197
    v_mfma_f32_16x16x32_bf16 v[204:207], v[240:243], v[180:183], v[204:207]
    ds_read_b128 v[232:235], v4 offset:34816
    v_cvt_pk_bf16_f32 v110, v196, v197
    s_waitcnt lgkmcnt(3)
    v_mfma_f32_16x16x32_bf16 v[208:211], v[244:247], v[164:167], v[208:211]
    v_exp_f32 v198, v198
    v_exp_f32 v199, v199
    v_mfma_f32_16x16x32_bf16 v[212:215], v[244:247], v[180:183], v[212:215]
    ds_read_b128 v[236:239], v4 offset:35840
    v_cvt_pk_bf16_f32 v111, v198, v199
    s_waitcnt lgkmcnt(3)
    v_mfma_f32_16x16x32_bf16 v[184:187], v[224:227], v[152:155], v[216:219]
    v_mfma_f32_16x16x32_bf16 v[188:191], v[224:227], v[168:171], v[220:223]
    ds_read_b128 v[240:243], v4 offset:36864
    v_exp_f32 v200, v200
    v_exp_f32 v201, v201
    v_mfma_f32_16x16x32_bf16 v[248:251], v[12:15], v[104:107], v[248:251]
    s_waitcnt lgkmcnt(3)
    v_mfma_f32_16x16x32_bf16 v[192:195], v[228:231], v[152:155], v[216:219]
    v_cvt_pk_bf16_f32 v112, v200, v201
    v_exp_f32 v202, v202
    v_mfma_f32_16x16x32_bf16 v[196:199], v[228:231], v[168:171], v[220:223]
    s_add_u32 s22, s21, 0x88400
    s_add_u32 m0, s20, 0x10400
    s_nop 0
    buffer_load_dwordx4 v2, s[8:11], s22 offen sc1 lds
    ds_read_b128 v[244:247], v4 offset:37888
    v_exp_f32 v203, v203
    v_mfma_f32_16x16x32_bf16 v[252:255], v[12:15], v[108:111], v[252:255]
    s_waitcnt lgkmcnt(3)
    v_mfma_f32_16x16x32_bf16 v[184:187], v[232:235], v[156:159], v[184:187]
    v_cvt_pk_bf16_f32 v113, v202, v203
    v_exp_f32 v204, v204
    v_mfma_f32_16x16x32_bf16 v[188:191], v[232:235], v[172:175], v[188:191]
    ds_read_b128 v[224:227], v4 offset:38912
    v_exp_f32 v205, v205
    s_waitcnt lgkmcnt(3)
    v_mfma_f32_16x16x32_bf16 v[192:195], v[236:239], v[156:159], v[192:195]
    v_cvt_pk_bf16_f32 v116, v204, v205
    v_exp_f32 v206, v206
    v_mfma_f32_16x16x32_bf16 v[196:199], v[236:239], v[172:175], v[196:199]
    ds_read_b128 v[228:231], v4 offset:39936
    v_exp_f32 v207, v207
    s_nop 0
    v_cvt_pk_bf16_f32 v117, v206, v207
    s_waitcnt lgkmcnt(3)
    v_mfma_f32_16x16x32_bf16 v[184:187], v[240:243], v[160:163], v[184:187]
    v_exp_f32 v208, v208
    v_mfma_f32_16x16x32_bf16 v[188:191], v[240:243], v[176:179], v[188:191]
    ds_read_b128 v[232:235], v4 offset:40960
    v_exp_f32 v209, v209
    s_nop 0
    v_cvt_pk_bf16_f32 v114, v208, v209
    s_waitcnt lgkmcnt(3)
    v_mfma_f32_16x16x32_bf16 v[192:195], v[244:247], v[160:163], v[192:195]
    v_exp_f32 v210, v210
    v_mfma_f32_16x16x32_bf16 v[196:199], v[244:247], v[176:179], v[196:199]
    ds_read_b128 v[236:239], v4 offset:41984
    v_exp_f32 v211, v211
    s_nop 0
    v_cvt_pk_bf16_f32 v115, v210, v211
    s_waitcnt lgkmcnt(3)
    v_mfma_f32_16x16x32_bf16 v[184:187], v[224:227], v[164:167], v[184:187]
    v_exp_f32 v212, v212
    v_exp_f32 v213, v213
    v_mfma_f32_16x16x32_bf16 v[188:191], v[224:227], v[180:183], v[188:191]
    ds_read_b128 v[240:243], v4 offset:43008
    v_cvt_pk_bf16_f32 v118, v212, v213
    s_waitcnt lgkmcnt(3)
    v_mfma_f32_16x16x32_bf16 v[192:195], v[228:231], v[164:167], v[192:195]
    v_exp_f32 v214, v214
    v_exp_f32 v215, v215
    v_mfma_f32_16x16x32_bf16 v[196:199], v[228:231], v[180:183], v[196:199]
    ds_read_b128 v[244:247], v4 offset:44032
    v_cvt_pk_bf16_f32 v119, v214, v215
    s_waitcnt lgkmcnt(3)
    v_mfma_f32_16x16x32_bf16 v[200:203], v[232:235], v[152:155], v[216:219]
    v_mfma_f32_16x16x32_bf16 v[204:207], v[232:235], v[168:171], v[220:223]
    ds_read_b128 v[224:227], v4 offset:45056
    v_exp_f32 v184, v184
    v_exp_f32 v185, v185
    v_mfma_f32_16x16x32_bf16 v[248:251], v[12:15], v[112:115], v[248:251]
    s_waitcnt lgkmcnt(3)
    v_mfma_f32_16x16x32_bf16 v[208:211], v[236:239], v[152:155], v[216:219]
    v_cvt_pk_bf16_f32 v120, v184, v185
    v_exp_f32 v186, v186
    v_mfma_f32_16x16x32_bf16 v[212:215], v[236:239], v[168:171], v[220:223]
    ds_read_b128 v[228:231], v4 offset:46080
    v_exp_f32 v187, v187
    v_mfma_f32_16x16x32_bf16 v[252:255], v[12:15], v[116:119], v[252:255]
    s_waitcnt lgkmcnt(3)
    v_mfma_f32_16x16x32_bf16 v[200:203], v[240:243], v[156:159], v[200:203]
    v_cvt_pk_bf16_f32 v121, v186, v187
    v_exp_f32 v188, v188
    v_mfma_f32_16x16x32_bf16 v[204:207], v[240:243], v[172:175], v[204:207]
    ds_read_b128 v[232:235], v4 offset:47104
    v_exp_f32 v189, v189
    s_waitcnt lgkmcnt(3)
    v_mfma_f32_16x16x32_bf16 v[208:211], v[244:247], v[156:159], v[208:211]
    v_cvt_pk_bf16_f32 v124, v188, v189
    v_exp_f32 v190, v190
    v_mfma_f32_16x16x32_bf16 v[212:215], v[244:247], v[172:175], v[212:215]
    ds_read_b128 v[236:239], v4 offset:48128
    v_exp_f32 v191, v191
    s_nop 0
    v_cvt_pk_bf16_f32 v125, v190, v191
    s_waitcnt lgkmcnt(3)
    v_mfma_f32_16x16x32_bf16 v[200:203], v[224:227], v[160:163], v[200:203]
    v_exp_f32 v192, v192
    v_mfma_f32_16x16x32_bf16 v[204:207], v[224:227], v[176:179], v[204:207]
    s_waitcnt vmcnt(6)
    s_barrier
    ds_read_b128 v[240:243], v4 offset:49152
    v_exp_f32 v193, v193
    s_nop 0
    v_cvt_pk_bf16_f32 v122, v192, v193
    s_waitcnt lgkmcnt(3)
    v_mfma_f32_16x16x32_bf16 v[208:211], v[228:231], v[160:163], v[208:211]
    v_exp_f32 v194, v194
    v_mfma_f32_16x16x32_bf16 v[212:215], v[228:231], v[176:179], v[212:215]
    s_add_u32 s22, s21, 0x8c000
    s_add_u32 m0, s20, 0x14000
    s_nop 0
    buffer_load_dwordx4 v2, s[8:11], s22 offen sc1 lds
    ds_read_b128 v[244:247], v4 offset:50176
    v_exp_f32 v195, v195
    s_nop 0
    v_cvt_pk_bf16_f32 v123, v194, v195
    s_waitcnt lgkmcnt(3)
    v_mfma_f32_16x16x32_bf16 v[200:203], v[232:235], v[164:167], v[200:203]
    v_exp_f32 v196, v196
    v_exp_f32 v197, v197
    v_mfma_f32_16x16x32_bf16 v[204:207], v[232:235], v[180:183], v[204:207]
    ds_read_b128 v[224:227], v4 offset:51200
    v_cvt_pk_bf16_f32 v126, v196, v197
    s_waitcnt lgkmcnt(3)
    v_mfma_f32_16x16x32_bf16 v[208:211], v[236:239], v[164:167], v[208:211]
    v_exp_f32 v198, v198
    v_exp_f32 v199, v199
    v_mfma_f32_16x16x32_bf16 v[212:215], v[236:239], v[180:183], v[212:215]
    ds_read_b128 v[228:231], v4 offset:52224
    v_cvt_pk_bf16_f32 v127, v198, v199
    s_waitcnt lgkmcnt(3)
    v_mfma_f32_16x16x32_bf16 v[184:187], v[240:243], v[152:155], v[216:219]
    v_mfma_f32_16x16x32_bf16 v[188:191], v[240:243], v[168:171], v[220:223]
    ds_read_b128 v[232:235], v4 offset:53248
    v_exp_f32 v200, v200
    v_exp_f32 v201, v201
    v_mfma_f32_16x16x32_bf16 v[248:251], v[12:15], v[120:123], v[248:251]
    s_waitcnt lgkmcnt(3)
    v_mfma_f32_16x16x32_bf16 v[192:195], v[244:247], v[152:155], v[216:219]
    v_cvt_pk_bf16_f32 v128, v200, v201
    v_exp_f32 v202, v202
    v_mfma_f32_16x16x32_bf16 v[196:199], v[244:247], v[168:171], v[220:223]
    s_add_u32 s22, s21, 0x8c400
    s_add_u32 m0, s20, 0x14400
    s_nop 0
    buffer_load_dwordx4 v2, s[8:11], s22 offen sc1 lds
    ds_read_b128 v[236:239], v4 offset:54272
    v_exp_f32 v203, v203
    v_mfma_f32_16x16x32_bf16 v[252:255], v[12:15], v[124:127], v[252:255]
    s_waitcnt lgkmcnt(3)
    v_mfma_f32_16x16x32_bf16 v[184:187], v[224:227], v[156:159], v[184:187]
    v_cvt_pk_bf16_f32 v129, v202, v203
    v_exp_f32 v204, v204
    v_mfma_f32_16x16x32_bf16 v[188:191], v[224:227], v[172:175], v[188:191]
    ds_read_b128 v[240:243], v4 offset:55296
    v_exp_f32 v205, v205
    s_waitcnt lgkmcnt(3)
    v_mfma_f32_16x16x32_bf16 v[192:195], v[228:231], v[156:159], v[192:195]
    v_cvt_pk_bf16_f32 v132, v204, v205
    v_exp_f32 v206, v206
    v_mfma_f32_16x16x32_bf16 v[196:199], v[228:231], v[172:175], v[196:199]
    ds_read_b128 v[244:247], v4 offset:56320
    v_exp_f32 v207, v207
    s_nop 0
    v_cvt_pk_bf16_f32 v133, v206, v207
    s_waitcnt lgkmcnt(3)
    v_mfma_f32_16x16x32_bf16 v[184:187], v[232:235], v[160:163], v[184:187]
    v_exp_f32 v208, v208
    v_mfma_f32_16x16x32_bf16 v[188:191], v[232:235], v[176:179], v[188:191]
    ds_read_b128 v[224:227], v4 offset:57344
    v_exp_f32 v209, v209
    s_nop 0
    v_cvt_pk_bf16_f32 v130, v208, v209
    s_waitcnt lgkmcnt(3)
    v_mfma_f32_16x16x32_bf16 v[192:195], v[236:239], v[160:163], v[192:195]
    v_exp_f32 v210, v210
    v_mfma_f32_16x16x32_bf16 v[196:199], v[236:239], v[176:179], v[196:199]
    ds_read_b128 v[228:231], v4 offset:58368
    v_exp_f32 v211, v211
    s_nop 0
    v_cvt_pk_bf16_f32 v131, v210, v211
    s_waitcnt lgkmcnt(3)
    v_mfma_f32_16x16x32_bf16 v[184:187], v[240:243], v[164:167], v[184:187]
    v_exp_f32 v212, v212
    v_exp_f32 v213, v213
    v_mfma_f32_16x16x32_bf16 v[188:191], v[240:243], v[180:183], v[188:191]
    ds_read_b128 v[232:235], v4 offset:59392
    v_cvt_pk_bf16_f32 v134, v212, v213
    s_waitcnt lgkmcnt(3)
    v_mfma_f32_16x16x32_bf16 v[192:195], v[244:247], v[164:167], v[192:195]
    v_exp_f32 v214, v214
    v_exp_f32 v215, v215
    v_mfma_f32_16x16x32_bf16 v[196:199], v[244:247], v[180:183], v[196:199]
    ds_read_b128 v[236:239], v4 offset:60416
    v_cvt_pk_bf16_f32 v135, v214, v215
    s_waitcnt lgkmcnt(3)
    v_mfma_f32_16x16x32_bf16 v[200:203], v[224:227], v[152:155], v[216:219]
    v_mfma_f32_16x16x32_bf16 v[204:207], v[224:227], v[168:171], v[220:223]
    ds_read_b128 v[240:243], v4 offset:61440
    v_exp_f32 v184, v184
    v_exp_f32 v185, v185
    v_mfma_f32_16x16x32_bf16 v[248:251], v[12:15], v[128:131], v[248:251]
    s_waitcnt lgkmcnt(3)
    v_mfma_f32_16x16x32_bf16 v[208:211], v[228:231], v[152:155], v[216:219]
    v_cvt_pk_bf16_f32 v136, v184, v185
    v_exp_f32 v186, v186
    v_mfma_f32_16x16x32_bf16 v[212:215], v[228:231], v[168:171], v[220:223]
    ds_read_b128 v[244:247], v4 offset:62464
    v_exp_f32 v187, v187
    v_mfma_f32_16x16x32_bf16 v[252:255], v[12:15], v[132:135], v[252:255]
    s_waitcnt lgkmcnt(3)
    v_mfma_f32_16x16x32_bf16 v[200:203], v[232:235], v[156:159], v[200:203]
    v_cvt_pk_bf16_f32 v137, v186, v187
    v_exp_f32 v188, v188
    v_mfma_f32_16x16x32_bf16 v[204:207], v[232:235], v[172:175], v[204:207]
    ds_read_b128 v[224:227], v4 offset:63488
    v_exp_f32 v189, v189
    s_waitcnt lgkmcnt(3)
    v_mfma_f32_16x16x32_bf16 v[208:211], v[236:239], v[156:159], v[208:211]
    v_cvt_pk_bf16_f32 v140, v188, v189
    v_exp_f32 v190, v190
    v_mfma_f32_16x16x32_bf16 v[212:215], v[236:239], v[172:175], v[212:215]
    ds_read_b128 v[228:231], v4 offset:64512
    v_exp_f32 v191, v191
    s_nop 0
    v_cvt_pk_bf16_f32 v141, v190, v191
    s_waitcnt lgkmcnt(3)
    v_mfma_f32_16x16x32_bf16 v[200:203], v[240:243], v[160:163], v[200:203]
    v_exp_f32 v192, v192
    v_mfma_f32_16x16x32_bf16 v[204:207], v[240:243], v[176:179], v[204:207]
    v_exp_f32 v193, v193
    s_nop 0
    v_cvt_pk_bf16_f32 v138, v192, v193
    s_waitcnt lgkmcnt(2)
    v_mfma_f32_16x16x32_bf16 v[208:211], v[244:247], v[160:163], v[208:211]
    v_exp_f32 v194, v194
    v_mfma_f32_16x16x32_bf16 v[212:215], v[244:247], v[176:179], v[212:215]
    v_exp_f32 v195, v195
    s_nop 0
    v_cvt_pk_bf16_f32 v139, v194, v195
    s_waitcnt lgkmcnt(1)
    v_mfma_f32_16x16x32_bf16 v[200:203], v[224:227], v[164:167], v[200:203]
    v_exp_f32 v196, v196
    v_exp_f32 v197, v197
    v_mfma_f32_16x16x32_bf16 v[204:207], v[224:227], v[180:183], v[204:207]
    v_cvt_pk_bf16_f32 v142, v196, v197
    s_waitcnt lgkmcnt(0)
    v_mfma_f32_16x16x32_bf16 v[208:211], v[228:231], v[164:167], v[208:211]
    v_exp_f32 v198, v198
    v_exp_f32 v199, v199
    v_mfma_f32_16x16x32_bf16 v[212:215], v[228:231], v[180:183], v[212:215]
    v_cvt_pk_bf16_f32 v143, v198, v199
    s_waitcnt vmcnt(6)
    s_barrier
    ds_read_b128 v[232:235], v5 offset:0
    ds_read_b128 v[236:239], v5 offset:1024
    ds_read_b128 v[240:243], v5 offset:2048
    ds_read_b128 v[244:247], v5 offset:3072
    v_mfma_f32_16x16x32_bf16 v[248:251], v[12:15], v[136:139], v[248:251]
    v_mfma_f32_16x16x32_bf16 v[252:255], v[12:15], v[140:143], v[252:255]
    v_exp_f32 v200, v200
    v_exp_f32 v201, v201
    s_nop 0
    v_cvt_pk_bf16_f32 v144, v200, v201
    v_exp_f32 v202, v202
    v_exp_f32 v203, v203
    s_nop 0
    v_cvt_pk_bf16_f32 v145, v202, v203
    v_exp_f32 v204, v204
    v_exp_f32 v205, v205
    s_nop 0
    v_cvt_pk_bf16_f32 v148, v204, v205
    v_exp_f32 v206, v206
    v_exp_f32 v207, v207
    s_nop 0
    v_cvt_pk_bf16_f32 v149, v206, v207
    v_exp_f32 v208, v208
    v_exp_f32 v209, v209
    s_nop 0
    v_cvt_pk_bf16_f32 v146, v208, v209
    v_exp_f32 v210, v210
    v_exp_f32 v211, v211
    s_nop 0
    v_cvt_pk_bf16_f32 v147, v210, v211
    v_exp_f32 v212, v212
    v_exp_f32 v213, v213
    s_nop 0
    v_cvt_pk_bf16_f32 v150, v212, v213
    v_exp_f32 v214, v214
    v_exp_f32 v215, v215
    s_nop 0
    v_cvt_pk_bf16_f32 v151, v214, v215
    v_mfma_f32_16x16x32_bf16 v[248:251], v[12:15], v[144:147], v[248:251]
    s_nop 0
    v_mfma_f32_16x16x32_bf16 v[252:255], v[12:15], v[148:151], v[252:255]
    s_nop 5
    v_mov_b32 v9, v248
    s_nop 0
    v_mov_b32 v10, v252
    v_max_f32 v17, v9, v10
    v_readfirstlane_b32 s17, v8
    s_cmp_eq_u32 s17, s28
    s_cselect_b32 s16, 0, 0x71800000
    v_cmp_ngt_f32 vcc, s16, v17
    v_cmp_u_f32 s[76:77], v9, v10
    s_or_b64 vcc, vcc, s[76:77]
    s_cbranch_vccnz adaLN_cond__sliding_block_cached__moe_arch_mod__prompt_kernel_fixA
adaLN_cond__sliding_block_cached__moe_arch_mod__prompt_kernel_fixAb:
    v_rcp_f32 v9, v9
    v_rcp_f32 v10, v10
    s_lshl_b32 s25, s13, 3
    s_add_u32 s25, s25, s3
    s_lshl_b32 s25, s25, 18
    s_lshl_b32 s26, s12, 12
    s_add_u32 s25, s25, s26
    s_add_u32 s25, s25, 0x1000000
    s_add_u32 s26, s25, 131072
    s_lshl_b32 s63, s13, 3
    s_add_u32 s63, s63, s3
    s_lshl_b32 s63, s63, 5
    s_add_u32 s63, s63, s12
    s_lshl_b32 s63, s63, 2
    s_waitcnt lgkmcnt(3)
    v_mfma_f32_16x16x32_bf16 v[184:187], v[232:235], v[24:27], 0
    v_mfma_f32_16x16x32_bf16 v[188:191], v[232:235], v[28:31], 0
    ds_read_b128 v[224:227], v5 offset:4096
    s_waitcnt lgkmcnt(3)
    v_mfma_f32_16x16x32_bf16 v[192:195], v[236:239], v[24:27], 0
    s_add_u32 s22, s21, 0x90000
    s_add_u32 m0, s20, 0x18000
    s_nop 0
    buffer_load_dwordx4 v2, s[8:11], s22 offen sc1 lds
    v_mfma_f32_16x16x32_bf16 v[196:199], v[236:239], v[28:31], 0
    ds_read_b128 v[228:231], v5 offset:5120
    s_waitcnt lgkmcnt(3)
    v_mfma_f32_16x16x32_bf16 v[184:187], v[240:243], v[32:35], v[184:187]
    v_mfma_f32_16x16x32_bf16 v[188:191], v[240:243], v[36:39], v[188:191]
    ds_read_b128 v[232:235], v5 offset:6144
    s_waitcnt lgkmcnt(3)
    v_mfma_f32_16x16x32_bf16 v[192:195], v[244:247], v[32:35], v[192:195]
    v_mfma_f32_16x16x32_bf16 v[196:199], v[244:247], v[36:39], v[196:199]
    ds_read_b128 v[236:239], v5 offset:7168
    s_waitcnt lgkmcnt(3)
    v_mfma_f32_16x16x32_bf16 v[184:187], v[224:227], v[40:43], v[184:187]
    v_mfma_f32_16x16x32_bf16 v[188:191], v[224:227], v[44:47], v[188:191]
    ds_read_b128 v[240:243], v5 offset:8192
    s_waitcnt lgkmcnt(3)
    v_mfma_f32_16x16x32_bf16 v[192:195], v[228:231], v[40:43], v[192:195]
    s_add_u32 s22, s21, 0x90400
    s_add_u32 m0, s20, 0x18400
    s_nop 0
    buffer_load_dwordx4 v2, s[8:11], s22 offen sc1 lds
    v_and_b32 v250, 7, v1
    v_lshlrev_b32 v250, 7, v250
    s_lshr_b32 s14, s2, 3
    s_lshl_b32 s14, s14, 2
    s_add_u32 s14, s14, 0x560000
    buffer_load_dword v248, v250, s[8:11], s14 offen sc1
    v_mfma_f32_16x16x32_bf16 v[196:199], v[228:231], v[44:47], v[196:199]
    ds_read_b128 v[244:247], v5 offset:9216
    s_waitcnt lgkmcnt(3)
    v_mfma_f32_16x16x32_bf16 v[184:187], v[232:235], v[48:51], v[184:187]
    v_mfma_f32_16x16x32_bf16 v[188:191], v[232:235], v[52:55], v[188:191]
    ds_read_b128 v[224:227], v5 offset:10240
    s_waitcnt lgkmcnt(3)
    v_mfma_f32_16x16x32_bf16 v[192:195], v[236:239], v[48:51], v[192:195]
    v_mfma_f32_16x16x32_bf16 v[196:199], v[236:239], v[52:55], v[196:199]
    ds_read_b128 v[228:231], v5 offset:11264
    s_waitcnt lgkmcnt(3)
    v_mfma_f32_16x16x32_bf16 v[184:187], v[240:243], v[56:59], v[184:187]
    v_mfma_f32_16x16x32_bf16 v[188:191], v[240:243], v[60:63], v[188:191]
    ds_read_b128 v[232:235], v5 offset:12288
    s_waitcnt lgkmcnt(3)
    v_mfma_f32_16x16x32_bf16 v[192:195], v[244:247], v[56:59], v[192:195]
    v_mfma_f32_16x16x32_bf16 v[196:199], v[244:247], v[60:63], v[196:199]
    ds_read_b128 v[236:239], v5 offset:13312
    s_waitcnt lgkmcnt(3)
    v_mfma_f32_16x16x32_bf16 v[184:187], v[224:227], v[64:67], v[184:187]
    v_mfma_f32_16x16x32_bf16 v[188:191], v[224:227], v[68:71], v[188:191]
    ds_read_b128 v[240:243], v5 offset:14336
    s_waitcnt lgkmcnt(3)
    v_mfma_f32_16x16x32_bf16 v[192:195], v[228:231], v[64:67], v[192:195]
    v_mfma_f32_16x16x32_bf16 v[196:199], v[228:231], v[68:71], v[196:199]
    ds_read_b128 v[244:247], v5 offset:15360
    s_waitcnt lgkmcnt(3)
    v_mfma_f32_16x16x32_bf16 v[184:187], v[232:235], v[72:75], v[184:187]
    v_mfma_f32_16x16x32_bf16 v[188:191], v[232:235], v[76:79], v[188:191]
    s_waitcnt vmcnt(7)
    s_barrier
    ds_read_b128 v[224:227], v5 offset:16384
    s_waitcnt lgkmcnt(3)
    v_mfma_f32_16x16x32_bf16 v[192:195], v[236:239], v[72:75], v[192:195]
    v_mfma_f32_16x16x32_bf16 v[196:199], v[236:239], v[76:79], v[196:199]
    s_add_u32 s22, s21, 0x94000
    s_add_u32 m0, s20, 0x1c000
    s_nop 0
    buffer_load_dwordx4 v2, s[8:11], s22 offen sc1 lds
    ds_read_b128 v[228:231], v5 offset:17408
    s_waitcnt lgkmcnt(3)
    v_mfma_f32_16x16x32_bf16 v[184:187], v[240:243], v[80:83], v[184:187]
    v_mfma_f32_16x16x32_bf16 v[188:191], v[240:243], v[84:87], v[188:191]
    ds_read_b128 v[232:235], v5 offset:18432
    s_waitcnt lgkmcnt(3)
    v_mfma_f32_16x16x32_bf16 v[192:195], v[244:247], v[80:83], v[192:195]
    v_mfma_f32_16x16x32_bf16 v[196:199], v[244:247], v[84:87], v[196:199]
    ds_read_b128 v[236:239], v5 offset:19456
    s_waitcnt lgkmcnt(3)
    v_mfma_f32_16x16x32_bf16 v[184:187], v[224:227], v[88:91], v[184:187]
    v_mfma_f32_16x16x32_bf16 v[188:191], v[224:227], v[92:95], v[188:191]
    ds_read_b128 v[240:243], v5 offset:20480
    s_waitcnt lgkmcnt(3)
    v_mfma_f32_16x16x32_bf16 v[192:195], v[228:231], v[88:91], v[192:195]
    v_mfma_f32_16x16x32_bf16 v[196:199], v[228:231], v[92:95], v[196:199]
    s_add_u32 s22, s21, 0x94400
    s_add_u32 m0, s20, 0x1c400
    s_nop 0
    buffer_load_dwordx4 v2, s[8:11], s22 offen sc1 lds
    ds_read_b128 v[244:247], v5 offset:21504
    s_waitcnt lgkmcnt(3)
    v_mfma_f32_16x16x32_bf16 v[184:187], v[232:235], v[96:99], v[184:187]
    v_mfma_f32_16x16x32_bf16 v[188:191], v[232:235], v[100:103], v[188:191]
    ds_read_b128 v[224:227], v5 offset:22528
    s_waitcnt lgkmcnt(3)
    v_mfma_f32_16x16x32_bf16 v[192:195], v[236:239], v[96:99], v[192:195]
    v_mfma_f32_16x16x32_bf16 v[196:199], v[236:239], v[100:103], v[196:199]
    ds_read_b128 v[228:231], v5 offset:23552
    s_waitcnt lgkmcnt(3)
    v_mfma_f32_16x16x32_bf16 v[184:187], v[240:243], v[104:107], v[184:187]
    v_mfma_f32_16x16x32_bf16 v[188:191], v[240:243], v[108:111], v[188:191]
    ds_read_b128 v[232:235], v5 offset:24576
    s_waitcnt lgkmcnt(3)
    v_mfma_f32_16x16x32_bf16 v[192:195], v[244:247], v[104:107], v[192:195]
    v_mfma_f32_16x16x32_bf16 v[196:199], v[244:247], v[108:111], v[196:199]
    ds_read_b128 v[236:239], v5 offset:25600
    s_waitcnt lgkmcnt(3)
    v_mfma_f32_16x16x32_bf16 v[184:187], v[224:227], v[112:115], v[184:187]
    s_waitcnt vmcnt(2)
    v_cmp_ne_u32 vcc, s28, v248
    s_cbranch_vccnz adaLN_cond__sliding_block_cached__moe_arch_mod__prompt_kernel_mp5r
adaLN_cond__sliding_block_cached__moe_arch_mod__prompt_kernel_mp5b:
    v_mfma_f32_16x16x32_bf16 v[188:191], v[224:227], v[116:119], v[188:191]
    ds_read_b128 v[240:243], v5 offset:26624
    v_lshrrev_b32 v250, 4, v1
    v_lshlrev_b32 v250, 14, v250
    v_and_b32 v253, 15, v1
    v_lshl_add_u32 v250, v253, 2, v250
    s_lshl_b32 s14, s2, 6
    s_add_u32 s14, s14, 0x580000
    buffer_load_dword v249, v250, s[8:11], s14 offen sc1
    s_add_u32 s14, s14, 0x10000
    buffer_load_dword v254, v250, s[8:11], s14 offen sc1
    s_waitcnt lgkmcnt(3)
    v_mfma_f32_16x16x32_bf16 v[192:195], v[228:231], v[112:115], v[192:195]
    v_mfma_f32_16x16x32_bf16 v[196:199], v[228:231], v[116:119], v[196:199]
    ds_read_b128 v[244:247], v5 offset:27648
    s_waitcnt lgkmcnt(3)
    v_mfma_f32_16x16x32_bf16 v[184:187], v[232:235], v[120:123], v[184:187]
    v_mfma_f32_16x16x32_bf16 v[188:191], v[232:235], v[124:127], v[188:191]
    ds_read_b128 v[224:227], v5 offset:28672
    s_waitcnt lgkmcnt(3)
    v_mfma_f32_16x16x32_bf16 v[192:195], v[236:239], v[120:123], v[192:195]
    v_mfma_f32_16x16x32_bf16 v[196:199], v[236:239], v[124:127], v[196:199]
    ds_read_b128 v[228:231], v5 offset:29696
    s_waitcnt lgkmcnt(3)
    v_mfma_f32_16x16x32_bf16 v[184:187], v[240:243], v[128:131], v[184:187]
    v_mfma_f32_16x16x32_bf16 v[188:191], v[240:243], v[132:135], v[188:191]
    ds_read_b128 v[232:235], v5 offset:30720
    s_waitcnt lgkmcnt(3)
    v_mfma_f32_16x16x32_bf16 v[192:195], v[244:247], v[128:131], v[192:195]
    v_mfma_f32_16x16x32_bf16 v[196:199], v[244:247], v[132:135], v[196:199]
    ds_read_b128 v[236:239], v5 offset:31744
    s_waitcnt lgkmcnt(3)
    v_mfma_f32_16x16x32_bf16 v[184:187], v[224:227], v[136:139], v[184:187]
    v_mfma_f32_16x16x32_bf16 v[188:191], v[224:227], v[140:143], v[188:191]
    s_barrier
    ds_read_b128 v[240:243], v4 offset:0
    s_waitcnt lgkmcnt(3)
    v_mfma_f32_16x16x32_bf16 v[192:195], v[228:231], v[136:139], v[192:195]
    v_mfma_f32_16x16x32_bf16 v[196:199], v[228:231], v[140:143], v[196:199]
    s_add_u32 s22, s21, 0x98000
    s_add_u32 m0, s20, 0x20000
    s_nop 0
    buffer_load_dwordx4 v2, s[8:11], s22 offen sc1 lds
    ds_read_b128 v[244:247], v4 offset:1024
    s_waitcnt lgkmcnt(3)
    v_mfma_f32_16x16x32_bf16 v[184:187], v[232:235], v[144:147], v[184:187]
    v_mfma_f32_16x16x32_bf16 v[188:191], v[232:235], v[148:151], v[188:191]
    ds_read_b128 v[224:227], v4 offset:2048
    s_waitcnt lgkmcnt(3)
    v_mfma_f32_16x16x32_bf16 v[192:195], v[236:239], v[144:147], v[192:195]
    v_mfma_f32_16x16x32_bf16 v[196:199], v[236:239], v[148:151], v[196:199]
    ds_read_b128 v[228:231], v4 offset:3072
    s_waitcnt lgkmcnt(3)
    v_mfma_f32_16x16x32_bf16 v[200:203], v[240:243], v[24:27], 0
    v_mfma_f32_16x16x32_bf16 v[204:207], v[240:243], v[28:31], 0
    ds_read_b128 v[232:235], v4 offset:4096
    s_waitcnt lgkmcnt(3)
    v_mfma_f32_16x16x32_bf16 v[208:211], v[244:247], v[24:27], 0
    v_mfma_f32_16x16x32_bf16 v[212:215], v[244:247], v[28:31], 0
    s_add_u32 s22, s21, 0x98400
    s_add_u32 m0, s20, 0x20400
    s_nop 0
    buffer_load_dwordx4 v2, s[8:11], s22 offen sc1 lds
    ds_read_b128 v[236:239], v4 offset:5120
    v_mul_f32 v184, v184, v9
    s_waitcnt lgkmcnt(3)
    v_mfma_f32_16x16x32_bf16 v[200:203], v[224:227], v[32:35], v[200:203]
    v_mul_f32 v185, v185, v9
    s_waitcnt vmcnt(2)
    v_add_f32 v249, v249, v254
    v_mov_b32 v250, v249
    s_nop 1
    v_permlane16_swap_b32 v249, v250
    v_add_f32 v249, v249, v250
    v_mov_b32 v250, v249
    s_nop 1
    v_permlane32_swap_b32 v249, v250
    v_add_f32 v249, v249, v250
    v_cvt_pk_bf16_f32 v249, v249, v249
    v_lshlrev_b32 v249, 16, v249
    s_lshr_b32 s14, s2, 6
    s_cmp_eq_u32 s14, 2
    s_cselect_b32 s14, 1.0, 0
    v_add_f32 v249, s14, v249
    v_cvt_pk_bf16_f32 v249, v249, v249
    v_lshlrev_b32 v253, 1, v253
    s_lshl_b32 s14, s2, 5
    s_add_u32 s14, s14, 0x540000
    s_cmp_eq_u32 s3, 0
    s_cselect_b32 s14, s14, 0x7ffffff0
    s_mov_b64 exec, 0xffff
    buffer_store_short v249, v253, s[8:11], s14 offen sc1
    s_mov_b64 exec, -1
    v_mfma_f32_16x16x32_bf16 v[204:207], v[224:227], v[36:39], v[204:207]
    ds_read_b128 v[240:243], v4 offset:6144
    v_mul_f32 v186, v186, v9
    s_waitcnt lgkmcnt(3)
    v_mfma_f32_16x16x32_bf16 v[208:211], v[228:231], v[32:35], v[208:211]
    v_mul_f32 v187, v187, v9
    v_mfma_f32_16x16x32_bf16 v[212:215], v[228:231], v[36:39], v[212:215]
    ds_read_b128 v[244:247], v4 offset:7168
    v_mul_f32 v192, v192, v9
    s_waitcnt lgkmcnt(3)
    v_mfma_f32_16x16x32_bf16 v[200:203], v[232:235], v[40:43], v[200:203]
    v_mul_f32 v193, v193, v9
    v_mfma_f32_16x16x32_bf16 v[204:207], v[232:235], v[44:47], v[204:207]
    ds_read_b128 v[224:227], v4 offset:8192
    v_mul_f32 v194, v194, v9
    s_waitcnt lgkmcnt(3)
    v_mfma_f32_16x16x32_bf16 v[208:211], v[236:239], v[40:43], v[208:211]
    v_mul_f32 v195, v195, v9
    v_mfma_f32_16x16x32_bf16 v[212:215], v[236:239], v[44:47], v[212:215]
    ds_read_b128 v[228:231], v4 offset:9216
    v_cvt_pk_bf16_f32 v216, v184, v185
    s_waitcnt lgkmcnt(3)
    v_mfma_f32_16x16x32_bf16 v[200:203], v[240:243], v[48:51], v[200:203]
    v_cvt_pk_bf16_f32 v217, v186, v187
    v_mfma_f32_16x16x32_bf16 v[204:207], v[240:243], v[52:55], v[204:207]
    ds_read_b128 v[232:235], v4 offset:10240
    v_cvt_pk_bf16_f32 v218, v192, v193
    s_waitcnt lgkmcnt(3)
    v_mfma_f32_16x16x32_bf16 v[208:211], v[244:247], v[48:51], v[208:211]
    v_cvt_pk_bf16_f32 v219, v194, v195
    v_mfma_f32_16x16x32_bf16 v[212:215], v[244:247], v[52:55], v[212:215]
    ds_read_b128 v[236:239], v4 offset:11264
    buffer_store_dwordx4 v[216:219], v2, s[8:11], s25 offen offset:0 sc1
    s_waitcnt lgkmcnt(3)
    v_mfma_f32_16x16x32_bf16 v[200:203], v[224:227], v[56:59], v[200:203]
    v_mul_f32 v188, v188, v10
    v_mfma_f32_16x16x32_bf16 v[204:207], v[224:227], v[60:63], v[204:207]
    ds_read_b128 v[240:243], v4 offset:12288
    v_mul_f32 v189, v189, v10
    s_waitcnt lgkmcnt(3)
    v_mfma_f32_16x16x32_bf16 v[208:211], v[228:231], v[56:59], v[208:211]
    v_mul_f32 v190, v190, v10
    v_mfma_f32_16x16x32_bf16 v[212:215], v[228:231], v[60:63], v[212:215]
    ds_read_b128 v[244:247], v4 offset:13312
    v_mul_f32 v191, v191, v10
    s_waitcnt lgkmcnt(3)
    v_mfma_f32_16x16x32_bf16 v[200:203], v[232:235], v[64:67], v[200:203]
    v_mul_f32 v196, v196, v10
    v_mfma_f32_16x16x32_bf16 v[204:207], v[232:235], v[68:71], v[204:207]
    ds_read_b128 v[224:227], v4 offset:14336
    v_mul_f32 v197, v197, v10
    s_waitcnt lgkmcnt(3)
    v_mfma_f32_16x16x32_bf16 v[208:211], v[236:239], v[64:67], v[208:211]
    v_mul_f32 v198, v198, v10
    v_mfma_f32_16x16x32_bf16 v[212:215], v[236:239], v[68:71], v[212:215]
    ds_read_b128 v[228:231], v4 offset:15360
    v_mul_f32 v199, v199, v10
    s_waitcnt lgkmcnt(3)
    v_mfma_f32_16x16x32_bf16 v[200:203], v[240:243], v[72:75], v[200:203]
    v_cvt_pk_bf16_f32 v220, v188, v189
    v_mfma_f32_16x16x32_bf16 v[204:207], v[240:243], v[76:79], v[204:207]
    s_barrier
    ds_read_b128 v[232:235], v4 offset:16384
    v_cvt_pk_bf16_f32 v221, v190, v191
    s_waitcnt lgkmcnt(3)
    v_mfma_f32_16x16x32_bf16 v[208:211], v[244:247], v[72:75], v[208:211]
    v_cvt_pk_bf16_f32 v222, v196, v197
    v_mfma_f32_16x16x32_bf16 v[212:215], v[244:247], v[76:79], v[212:215]
    s_add_u32 s22, s21, 0x9c000
    s_add_u32 m0, s20, 0x24000
    s_nop 0
    buffer_load_dwordx4 v2, s[8:11], s22 offen sc1 lds
    ds_read_b128 v[236:239], v4 offset:17408
    v_cvt_pk_bf16_f32 v223, v198, v199
    s_waitcnt lgkmcnt(3)
    v_mfma_f32_16x16x32_bf16 v[200:203], v[224:227], v[80:83], v[200:203]
    buffer_store_dwordx4 v[220:223], v2, s[8:11], s26 offen offset:0 sc1
    v_mfma_f32_16x16x32_bf16 v[204:207], v[224:227], v[84:87], v[204:207]
    ds_read_b128 v[240:243], v4 offset:18432
    s_waitcnt lgkmcnt(3)
    v_mfma_f32_16x16x32_bf16 v[208:211], v[228:231], v[80:83], v[208:211]
    v_mfma_f32_16x16x32_bf16 v[212:215], v[228:231], v[84:87], v[212:215]
    ds_read_b128 v[244:247], v4 offset:19456
    s_waitcnt lgkmcnt(3)
    v_mfma_f32_16x16x32_bf16 v[200:203], v[232:235], v[88:91], v[200:203]
    v_mfma_f32_16x16x32_bf16 v[204:207], v[232:235], v[92:95], v[204:207]
    ds_read_b128 v[224:227], v4 offset:20480
    s_waitcnt lgkmcnt(3)
    v_mfma_f32_16x16x32_bf16 v[208:211], v[236:239], v[88:91], v[208:211]
    v_mfma_f32_16x16x32_bf16 v[212:215], v[236:239], v[92:95], v[212:215]
    s_add_u32 s22, s21, 0x9c400
    s_add_u32 m0, s20, 0x24400
    s_nop 0
    buffer_load_dwordx4 v2, s[8:11], s22 offen sc1 lds
    ds_read_b128 v[228:231], v4 offset:21504
    s_waitcnt lgkmcnt(3)
    v_mfma_f32_16x16x32_bf16 v[200:203], v[240:243], v[96:99], v[200:203]
    v_mfma_f32_16x16x32_bf16 v[204:207], v[240:243], v[100:103], v[204:207]
    ds_read_b128 v[232:235], v4 offset:22528
    s_waitcnt lgkmcnt(3)
    v_mfma_f32_16x16x32_bf16 v[208:211], v[244:247], v[96:99], v[208:211]
    v_mfma_f32_16x16x32_bf16 v[212:215], v[244:247], v[100:103], v[212:215]
    ds_read_b128 v[236:239], v4 offset:23552
    s_waitcnt lgkmcnt(3)
    v_mfma_f32_16x16x32_bf16 v[200:203], v[224:227], v[104:107], v[200:203]
    v_mfma_f32_16x16x32_bf16 v[204:207], v[224:227], v[108:111], v[204:207]
    ds_read_b128 v[240:243], v4 offset:24576
    s_waitcnt lgkmcnt(3)
    v_mfma_f32_16x16x32_bf16 v[208:211], v[228:231], v[104:107], v[208:211]
    v_mfma_f32_16x16x32_bf16 v[212:215], v[228:231], v[108:111], v[212:215]
    ds_read_b128 v[244:247], v4 offset:25600
    s_waitcnt lgkmcnt(3)
    v_mfma_f32_16x16x32_bf16 v[200:203], v[232:235], v[112:115], v[200:203]
    s_waitcnt vmcnt(4)
    v_mov_b32 v248, s28
    v_mov_b32 v249, 0
    s_lshl_b32 s14, s2, 2
    s_add_u32 s14, s14, 0x544000
    s_cmp_eq_u32 s3, 0
    s_cselect_b32 s14, s14, 0x7ffffff0
    s_mov_b64 exec, 1
    buffer_store_dword v248, v249, s[8:11], s14 offen sc1
    s_mov_b64 exec, -1
    v_mfma_f32_16x16x32_bf16 v[204:207], v[232:235], v[116:119], v[204:207]
    ds_read_b128 v[224:227], v4 offset:26624
    s_waitcnt lgkmcnt(3)
    v_mfma_f32_16x16x32_bf16 v[208:211], v[236:239], v[112:115], v[208:211]
    v_mfma_f32_16x16x32_bf16 v[212:215], v[236:239], v[116:119], v[212:215]
    ds_read_b128 v[228:231], v4 offset:27648
    s_waitcnt lgkmcnt(3)
    v_mfma_f32_16x16x32_bf16 v[200:203], v[240:243], v[120:123], v[200:203]
    v_mfma_f32_16x16x32_bf16 v[204:207], v[240:243], v[124:127], v[204:207]
    ds_read_b128 v[232:235], v4 offset:28672
    s_waitcnt lgkmcnt(3)
    v_mfma_f32_16x16x32_bf16 v[208:211], v[244:247], v[120:123], v[208:211]
    v_mfma_f32_16x16x32_bf16 v[212:215], v[244:247], v[124:127], v[212:215]
    ds_read_b128 v[236:239], v4 offset:29696
    s_waitcnt lgkmcnt(3)
    v_mfma_f32_16x16x32_bf16 v[200:203], v[224:227], v[128:131], v[200:203]
    v_mfma_f32_16x16x32_bf16 v[204:207], v[224:227], v[132:135], v[204:207]
    ds_read_b128 v[240:243], v4 offset:30720
    s_waitcnt lgkmcnt(3)
    v_mfma_f32_16x16x32_bf16 v[208:211], v[228:231], v[128:131], v[208:211]
    v_mfma_f32_16x16x32_bf16 v[212:215], v[228:231], v[132:135], v[212:215]
    ds_read_b128 v[244:247], v4 offset:31744
    s_waitcnt lgkmcnt(3)
    v_mfma_f32_16x16x32_bf16 v[200:203], v[232:235], v[136:139], v[200:203]
    v_mfma_f32_16x16x32_bf16 v[204:207], v[232:235], v[140:143], v[204:207]
    s_barrier
    ds_read_b128 v[224:227], v4 offset:32768
    s_waitcnt lgkmcnt(3)
    v_mfma_f32_16x16x32_bf16 v[208:211], v[236:239], v[136:139], v[208:211]
    v_mfma_f32_16x16x32_bf16 v[212:215], v[236:239], v[140:143], v[212:215]
    s_add_u32 s22, s24, 0x0
    s_add_u32 m0, s20, 0x10000
    s_nop 0
    buffer_load_dwordx4 v3, s[4:7], s22 offen lds
    ds_read_b128 v[228:231], v4 offset:33792
    s_waitcnt lgkmcnt(3)
    v_mfma_f32_16x16x32_bf16 v[200:203], v[240:243], v[144:147], v[200:203]
    v_mfma_f32_16x16x32_bf16 v[204:207], v[240:243], v[148:151], v[204:207]
    ds_read_b128 v[232:235], v4 offset:34816
    s_waitcnt lgkmcnt(3)
    v_mfma_f32_16x16x32_bf16 v[208:211], v[244:247], v[144:147], v[208:211]
    v_mfma_f32_16x16x32_bf16 v[212:215], v[244:247], v[148:151], v[212:215]
    ds_read_b128 v[236:239], v4 offset:35840
    s_waitcnt lgkmcnt(3)
    v_mfma_f32_16x16x32_bf16 v[184:187], v[224:227], v[24:27], 0
    v_mfma_f32_16x16x32_bf16 v[188:191], v[224:227], v[28:31], 0
    ds_read_b128 v[240:243], v4 offset:36864
    s_waitcnt lgkmcnt(3)
    v_mfma_f32_16x16x32_bf16 v[192:195], v[228:231], v[24:27], 0
    v_mfma_f32_16x16x32_bf16 v[196:199], v[228:231], v[28:31], 0
    s_add_u32 s22, s24, 0x2000
    s_add_u32 m0, s20, 0x10400
    s_nop 0
    buffer_load_dwordx4 v3, s[4:7], s22 offen lds
    ds_read_b128 v[244:247], v4 offset:37888
    v_mul_f32 v200, v200, v9
    s_waitcnt lgkmcnt(3)
    v_mfma_f32_16x16x32_bf16 v[184:187], v[232:235], v[32:35], v[184:187]
    v_mul_f32 v201, v201, v9
    v_mfma_f32_16x16x32_bf16 v[188:191], v[232:235], v[36:39], v[188:191]
    ds_read_b128 v[224:227], v4 offset:38912
    v_mul_f32 v202, v202, v9
    s_waitcnt lgkmcnt(3)
    v_mfma_f32_16x16x32_bf16 v[192:195], v[236:239], v[32:35], v[192:195]
    v_mul_f32 v203, v203, v9
    v_mfma_f32_16x16x32_bf16 v[196:199], v[236:239], v[36:39], v[196:199]
    ds_read_b128 v[228:231], v4 offset:39936
    v_mul_f32 v208, v208, v9
    s_waitcnt lgkmcnt(3)
    v_mfma_f32_16x16x32_bf16 v[184:187], v[240:243], v[40:43], v[184:187]
    v_mul_f32 v209, v209, v9
    v_mfma_f32_16x16x32_bf16 v[188:191], v[240:243], v[44:47], v[188:191]
    ds_read_b128 v[232:235], v4 offset:40960
    v_mul_f32 v210, v210, v9
    s_waitcnt lgkmcnt(3)
    v_mfma_f32_16x16x32_bf16 v[192:195], v[244:247], v[40:43], v[192:195]
    v_mul_f32 v211, v211, v9
    v_mfma_f32_16x16x32_bf16 v[196:199], v[244:247], v[44:47], v[196:199]
    ds_read_b128 v[236:239], v4 offset:41984
    v_cvt_pk_bf16_f32 v216, v200, v201
    s_waitcnt lgkmcnt(3)
    v_mfma_f32_16x16x32_bf16 v[184:187], v[224:227], v[48:51], v[184:187]
    v_cvt_pk_bf16_f32 v217, v202, v203
    s_waitcnt vmcnt(4)
    s_add_u32 s16, s63, 0x570000
    v_mov_b32 v7, s28
    v_mov_b32 v8, 0
    s_mov_b64 exec, 1
    buffer_store_dword v7, v8, s[8:11], s16 offen sc1
    s_mov_b64 exec, -1
    v_mfma_f32_16x16x32_bf16 v[188:191], v[224:227], v[52:55], v[188:191]
    ds_read_b128 v[240:243], v4 offset:43008
    v_cvt_pk_bf16_f32 v218, v208, v209
    s_waitcnt lgkmcnt(3)
    v_mfma_f32_16x16x32_bf16 v[192:195], v[228:231], v[48:51], v[192:195]
    v_cvt_pk_bf16_f32 v219, v210, v211
    v_mfma_f32_16x16x32_bf16 v[196:199], v[228:231], v[52:55], v[196:199]
    ds_read_b128 v[244:247], v4 offset:44032
    buffer_store_dwordx4 v[216:219], v2, s[8:11], s25 offen offset:1024 sc1
    s_waitcnt lgkmcnt(3)
    v_mfma_f32_16x16x32_bf16 v[184:187], v[232:235], v[56:59], v[184:187]
    v_mul_f32 v204, v204, v10
    v_mfma_f32_16x16x32_bf16 v[188:191], v[232:235], v[60:63], v[188:191]
    ds_read_b128 v[224:227], v4 offset:45056
    v_mul_f32 v205, v205, v10
    s_waitcnt lgkmcnt(3)
    v_mfma_f32_16x16x32_bf16 v[192:195], v[236:239], v[56:59], v[192:195]
    v_mul_f32 v206, v206, v10
    v_mfma_f32_16x16x32_bf16 v[196:199], v[236:239], v[60:63], v[196:199]
    ds_read_b128 v[228:231], v4 offset:46080
    v_mul_f32 v207, v207, v10
    s_waitcnt lgkmcnt(3)
    v_mfma_f32_16x16x32_bf16 v[184:187], v[240:243], v[64:67], v[184:187]
    v_mul_f32 v212, v212, v10
    v_mfma_f32_16x16x32_bf16 v[188:191], v[240:243], v[68:71], v[188:191]
    ds_read_b128 v[232:235], v4 offset:47104
    v_mul_f32 v213, v213, v10
    s_waitcnt lgkmcnt(3)
    v_mfma_f32_16x16x32_bf16 v[192:195], v[244:247], v[64:67], v[192:195]
    v_mul_f32 v214, v214, v10
    v_mfma_f32_16x16x32_bf16 v[196:199], v[244:247], v[68:71], v[196:199]
    ds_read_b128 v[236:239], v4 offset:48128
    v_mul_f32 v215, v215, v10
    s_waitcnt lgkmcnt(3)
    v_mfma_f32_16x16x32_bf16 v[184:187], v[224:227], v[72:75], v[184:187]
    v_cvt_pk_bf16_f32 v220, v204, v205
    v_mfma_f32_16x16x32_bf16 v[188:191], v[224:227], v[76:79], v[188:191]
    s_barrier
    ds_read_b128 v[240:243], v4 offset:49152
    v_cvt_pk_bf16_f32 v221, v206, v207
    s_waitcnt lgkmcnt(3)
    v_mfma_f32_16x16x32_bf16 v[192:195], v[228:231], v[72:75], v[192:195]
    v_cvt_pk_bf16_f32 v222, v212, v213
    v_mfma_f32_16x16x32_bf16 v[196:199], v[228:231], v[76:79], v[196:199]
    s_add_u32 s22, s24, 0x80000
    s_add_u32 m0, s20, 0x14000
    s_nop 0
    buffer_load_dwordx4 v3, s[4:7], s22 offen lds
    ds_read_b128 v[244:247], v4 offset:50176
    v_cvt_pk_bf16_f32 v223, v214, v215
    s_waitcnt lgkmcnt(3)
    v_mfma_f32_16x16x32_bf16 v[184:187], v[232:235], v[80:83], v[184:187]
    buffer_store_dwordx4 v[220:223], v2, s[8:11], s26 offen offset:1024 sc1
    v_mfma_f32_16x16x32_bf16 v[188:191], v[232:235], v[84:87], v[188:191]
    ds_read_b128 v[224:227], v4 offset:51200
    s_waitcnt lgkmcnt(3)
    v_mfma_f32_16x16x32_bf16 v[192:195], v[236:239], v[80:83], v[192:195]
    v_mfma_f32_16x16x32_bf16 v[196:199], v[236:239], v[84:87], v[196:199]
    ds_read_b128 v[228:231], v4 offset:52224
    s_waitcnt lgkmcnt(3)
    v_mfma_f32_16x16x32_bf16 v[184:187], v[240:243], v[88:91], v[184:187]
    v_mfma_f32_16x16x32_bf16 v[188:191], v[240:243], v[92:95], v[188:191]
    ds_read_b128 v[232:235], v4 offset:53248
    s_waitcnt lgkmcnt(3)
    v_mfma_f32_16x16x32_bf16 v[192:195], v[244:247], v[88:91], v[192:195]
    v_mfma_f32_16x16x32_bf16 v[196:199], v[244:247], v[92:95], v[196:199]
    s_add_u32 s22, s24, 0x82000
    s_add_u32 m0, s20, 0x14400
    s_nop 0
    buffer_load_dwordx4 v3, s[4:7], s22 offen lds
    ds_read_b128 v[236:239], v4 offset:54272
    s_waitcnt lgkmcnt(3)
    v_mfma_f32_16x16x32_bf16 v[184:187], v[224:227], v[96:99], v[184:187]
    v_mfma_f32_16x16x32_bf16 v[188:191], v[224:227], v[100:103], v[188:191]
    ds_read_b128 v[240:243], v4 offset:55296
    s_waitcnt lgkmcnt(3)
    v_mfma_f32_16x16x32_bf16 v[192:195], v[228:231], v[96:99], v[192:195]
    v_mfma_f32_16x16x32_bf16 v[196:199], v[228:231], v[100:103], v[196:199]
    ds_read_b128 v[244:247], v4 offset:56320
    s_waitcnt lgkmcnt(3)
    v_mfma_f32_16x16x32_bf16 v[184:187], v[232:235], v[104:107], v[184:187]
    v_mfma_f32_16x16x32_bf16 v[188:191], v[232:235], v[108:111], v[188:191]
    ds_read_b128 v[224:227], v4 offset:57344
    s_waitcnt lgkmcnt(3)
    v_mfma_f32_16x16x32_bf16 v[192:195], v[236:239], v[104:107], v[192:195]
    v_mfma_f32_16x16x32_bf16 v[196:199], v[236:239], v[108:111], v[196:199]
    ds_read_b128 v[228:231], v4 offset:58368
    s_waitcnt lgkmcnt(3)
    v_mfma_f32_16x16x32_bf16 v[184:187], v[240:243], v[112:115], v[184:187]
    v_mfma_f32_16x16x32_bf16 v[188:191], v[240:243], v[116:119], v[188:191]
    ds_read_b128 v[232:235], v4 offset:59392
    s_waitcnt lgkmcnt(3)
    v_mfma_f32_16x16x32_bf16 v[192:195], v[244:247], v[112:115], v[192:195]
    v_mfma_f32_16x16x32_bf16 v[196:199], v[244:247], v[116:119], v[196:199]
    ds_read_b128 v[236:239], v4 offset:60416
    s_waitcnt lgkmcnt(3)
    v_mfma_f32_16x16x32_bf16 v[184:187], v[224:227], v[120:123], v[184:187]
    v_mfma_f32_16x16x32_bf16 v[188:191], v[224:227], v[124:127], v[188:191]
    ds_read_b128 v[240:243], v4 offset:61440
    s_waitcnt lgkmcnt(3)
    v_mfma_f32_16x16x32_bf16 v[192:195], v[228:231], v[120:123], v[192:195]
    v_mfma_f32_16x16x32_bf16 v[196:199], v[228:231], v[124:127], v[196:199]
    ds_read_b128 v[244:247], v4 offset:62464
    s_waitcnt lgkmcnt(3)
    v_mfma_f32_16x16x32_bf16 v[184:187], v[232:235], v[128:131], v[184:187]
    v_mfma_f32_16x16x32_bf16 v[188:191], v[232:235], v[132:135], v[188:191]
    ds_read_b128 v[224:227], v4 offset:63488
    s_waitcnt lgkmcnt(3)
    v_mfma_f32_16x16x32_bf16 v[192:195], v[236:239], v[128:131], v[192:195]
    v_mfma_f32_16x16x32_bf16 v[196:199], v[236:239], v[132:135], v[196:199]
    ds_read_b128 v[228:231], v4 offset:64512
    s_waitcnt lgkmcnt(3)
    v_mfma_f32_16x16x32_bf16 v[184:187], v[240:243], v[136:139], v[184:187]
    v_mfma_f32_16x16x32_bf16 v[188:191], v[240:243], v[140:143], v[188:191]
    s_barrier
    ds_read_b128 v[232:235], v5 offset:0
    s_waitcnt lgkmcnt(3)
    v_mfma_f32_16x16x32_bf16 v[192:195], v[244:247], v[136:139], v[192:195]
    v_mfma_f32_16x16x32_bf16 v[196:199], v[244:247], v[140:143], v[196:199]
    s_add_u32 s22, s24, 0x100000
    s_add_u32 m0, s20, 0x18000
    s_nop 0
    buffer_load_dwordx4 v3, s[4:7], s22 offen lds
    ds_read_b128 v[236:239], v5 offset:1024
    s_waitcnt lgkmcnt(3)
    v_mfma_f32_16x16x32_bf16 v[184:187], v[224:227], v[144:147], v[184:187]
    v_mfma_f32_16x16x32_bf16 v[188:191], v[224:227], v[148:151], v[188:191]
    ds_read_b128 v[240:243], v5 offset:2048
    s_waitcnt lgkmcnt(3)
    v_mfma_f32_16x16x32_bf16 v[192:195], v[228:231], v[144:147], v[192:195]
    v_mfma_f32_16x16x32_bf16 v[196:199], v[228:231], v[148:151], v[196:199]
    ds_read_b128 v[244:247], v5 offset:3072
    s_waitcnt lgkmcnt(3)
    v_mfma_f32_16x16x32_bf16 v[200:203], v[232:235], v[24:27], 0
    v_mfma_f32_16x16x32_bf16 v[204:207], v[232:235], v[28:31], 0
    ds_read_b128 v[224:227], v5 offset:4096
    s_waitcnt lgkmcnt(3)
    v_mfma_f32_16x16x32_bf16 v[208:211], v[236:239], v[24:27], 0
    v_mfma_f32_16x16x32_bf16 v[212:215], v[236:239], v[28:31], 0
    s_add_u32 s22, s24, 0x102000
    s_add_u32 m0, s20, 0x18400
    s_nop 0
    buffer_load_dwordx4 v3, s[4:7], s22 offen lds
    ds_read_b128 v[228:231], v5 offset:5120
    v_mul_f32 v184, v184, v9
    s_waitcnt lgkmcnt(3)
    v_mfma_f32_16x16x32_bf16 v[200:203], v[240:243], v[32:35], v[200:203]
    v_mul_f32 v185, v185, v9
    s_bfe_u32 s30, s2, 0x20001
    s_lshl_b32 s30, s30, 2
    s_bfe_u32 s17, s2, 0x20003
    s_add_u32 s30, s30, s17
    s_lshr_b32 s31, s2, 5
    s_and_b32 s17, s3, 3
    s_lshl_b32 s19, s30, 2
    s_add_u32 s19, s19, s17
    s_and_b32 s16, s2, 1
    s_lshl_b32 s17, s19, 18
    s_lshl_b32 s23, s16, 16
    s_add_u32 s17, s17, s23
    s_add_u32 s17, s17, 0x1000000
    v_add_u32 v6, s17, v2
    s_lshl_b32 s19, s19, 7
    s_lshl_b32 s23, s16, 6
    s_add_u32 s19, s19, s23
    s_add_u32 s19, s19, 0x570000
    v_and_b32 v13, 15, v1
    v_lshlrev_b32 v13, 2, v13
    buffer_load_dword v12, v13, s[8:11], s19 offen sc1
    v_mfma_f32_16x16x32_bf16 v[204:207], v[240:243], v[36:39], v[204:207]
    ds_read_b128 v[232:235], v5 offset:6144
    v_mul_f32 v186, v186, v9
    s_waitcnt lgkmcnt(3)
    v_mfma_f32_16x16x32_bf16 v[208:211], v[244:247], v[32:35], v[208:211]
    v_mul_f32 v187, v187, v9
    v_mfma_f32_16x16x32_bf16 v[212:215], v[244:247], v[36:39], v[212:215]
    ds_read_b128 v[236:239], v5 offset:7168
    v_mul_f32 v192, v192, v9
    s_waitcnt lgkmcnt(3)
    v_mfma_f32_16x16x32_bf16 v[200:203], v[224:227], v[40:43], v[200:203]
    v_mul_f32 v193, v193, v9
    v_mfma_f32_16x16x32_bf16 v[204:207], v[224:227], v[44:47], v[204:207]
    ds_read_b128 v[240:243], v5 offset:8192
    v_mul_f32 v194, v194, v9
    s_waitcnt lgkmcnt(3)
    v_mfma_f32_16x16x32_bf16 v[208:211], v[228:231], v[40:43], v[208:211]
    v_mul_f32 v195, v195, v9
    v_mfma_f32_16x16x32_bf16 v[212:215], v[228:231], v[44:47], v[212:215]
    ds_read_b128 v[244:247], v5 offset:9216
    v_cvt_pk_bf16_f32 v216, v184, v185
    s_waitcnt lgkmcnt(3)
    v_mfma_f32_16x16x32_bf16 v[200:203], v[232:235], v[48:51], v[200:203]
    v_cvt_pk_bf16_f32 v217, v186, v187
    v_mfma_f32_16x16x32_bf16 v[204:207], v[232:235], v[52:55], v[204:207]
    ds_read_b128 v[224:227], v5 offset:10240
    v_cvt_pk_bf16_f32 v218, v192, v193
    s_waitcnt lgkmcnt(3)
    v_mfma_f32_16x16x32_bf16 v[208:211], v[236:239], v[48:51], v[208:211]
    v_cvt_pk_bf16_f32 v219, v194, v195
    v_mfma_f32_16x16x32_bf16 v[212:215], v[236:239], v[52:55], v[212:215]
    ds_read_b128 v[228:231], v5 offset:11264
    buffer_store_dwordx4 v[216:219], v2, s[8:11], s25 offen offset:2048 sc1
    s_waitcnt lgkmcnt(3)
    v_mfma_f32_16x16x32_bf16 v[200:203], v[240:243], v[56:59], v[200:203]
    v_mul_f32 v188, v188, v10
    v_mfma_f32_16x16x32_bf16 v[204:207], v[240:243], v[60:63], v[204:207]
    ds_read_b128 v[232:235], v5 offset:12288
    v_mul_f32 v189, v189, v10
    s_waitcnt lgkmcnt(3)
    v_mfma_f32_16x16x32_bf16 v[208:211], v[244:247], v[56:59], v[208:211]
    v_mul_f32 v190, v190, v10
    v_mfma_f32_16x16x32_bf16 v[212:215], v[244:247], v[60:63], v[212:215]
    ds_read_b128 v[236:239], v5 offset:13312
    v_mul_f32 v191, v191, v10
    s_waitcnt lgkmcnt(3)
    v_mfma_f32_16x16x32_bf16 v[200:203], v[224:227], v[64:67], v[200:203]
    v_mul_f32 v196, v196, v10
    v_mfma_f32_16x16x32_bf16 v[204:207], v[224:227], v[68:71], v[204:207]
    ds_read_b128 v[240:243], v5 offset:14336
    v_mul_f32 v197, v197, v10
    s_waitcnt lgkmcnt(3)
    v_mfma_f32_16x16x32_bf16 v[208:211], v[228:231], v[64:67], v[208:211]
    v_mul_f32 v198, v198, v10
    v_mfma_f32_16x16x32_bf16 v[212:215], v[228:231], v[68:71], v[212:215]
    ds_read_b128 v[244:247], v5 offset:15360
    v_mul_f32 v199, v199, v10
    s_waitcnt lgkmcnt(3)
    v_mfma_f32_16x16x32_bf16 v[200:203], v[232:235], v[72:75], v[200:203]
    v_cvt_pk_bf16_f32 v220, v188, v189
    v_mfma_f32_16x16x32_bf16 v[204:207], v[232:235], v[76:79], v[204:207]
    s_waitcnt vmcnt(12)
    s_barrier
    ds_read_b128 v[224:227], v5 offset:16384
    v_cvt_pk_bf16_f32 v221, v190, v191
    s_waitcnt lgkmcnt(3)
    v_mfma_f32_16x16x32_bf16 v[208:211], v[236:239], v[72:75], v[208:211]
    v_cvt_pk_bf16_f32 v222, v196, v197
    v_mfma_f32_16x16x32_bf16 v[212:215], v[236:239], v[76:79], v[212:215]
    s_add_u32 s22, s24, 0x180000
    s_add_u32 m0, s20, 0x1c000
    s_nop 0
    buffer_load_dwordx4 v3, s[4:7], s22 offen lds
    ds_read_b128 v[228:231], v5 offset:17408
    v_cvt_pk_bf16_f32 v223, v198, v199
    s_waitcnt lgkmcnt(3)
    v_mfma_f32_16x16x32_bf16 v[200:203], v[240:243], v[80:83], v[200:203]
    buffer_store_dwordx4 v[220:223], v2, s[8:11], s26 offen offset:2048 sc1
    v_mfma_f32_16x16x32_bf16 v[204:207], v[240:243], v[84:87], v[204:207]
    ds_read_b128 v[232:235], v5 offset:18432
    s_waitcnt lgkmcnt(3)
    v_mfma_f32_16x16x32_bf16 v[208:211], v[244:247], v[80:83], v[208:211]
    v_mfma_f32_16x16x32_bf16 v[212:215], v[244:247], v[84:87], v[212:215]
    ds_read_b128 v[236:239], v5 offset:19456
    s_waitcnt lgkmcnt(3)
    v_mfma_f32_16x16x32_bf16 v[200:203], v[224:227], v[88:91], v[200:203]
    v_mfma_f32_16x16x32_bf16 v[204:207], v[224:227], v[92:95], v[204:207]
    ds_read_b128 v[240:243], v5 offset:20480
    s_waitcnt vmcnt(3)
    v_cmp_ne_u32 vcc, s28, v12
    s_cbranch_vccnz adaLN_cond__sliding_block_cached__moe_arch_mod__prompt_kernel_o6r
adaLN_cond__sliding_block_cached__moe_arch_mod__prompt_kernel_o6b:
    s_waitcnt lgkmcnt(3)
    v_mfma_f32_16x16x32_bf16 v[208:211], v[228:231], v[88:91], v[208:211]
    s_mov_b32 s23, 0x0
    buffer_load_dwordx4 v[24:27], v6, s[8:11], s23 offen offset:0 sc1
    v_mfma_f32_16x16x32_bf16 v[212:215], v[228:231], v[92:95], v[212:215]
    s_add_u32 s22, s24, 0x182000
    s_add_u32 m0, s20, 0x1c400
    s_nop 0
    buffer_load_dwordx4 v3, s[4:7], s22 offen lds
    ds_read_b128 v[244:247], v5 offset:21504
    s_waitcnt lgkmcnt(3)
    v_mfma_f32_16x16x32_bf16 v[200:203], v[232:235], v[96:99], v[200:203]
    v_mfma_f32_16x16x32_bf16 v[204:207], v[232:235], v[100:103], v[204:207]
    ds_read_b128 v[224:227], v5 offset:22528
    s_mov_b32 s23, 0x20000
    buffer_load_dwordx4 v[28:31], v6, s[8:11], s23 offen offset:0 sc1
    s_waitcnt lgkmcnt(3)
    v_mfma_f32_16x16x32_bf16 v[208:211], v[236:239], v[96:99], v[208:211]
    s_add_u32 s16, s63, 0x572000
    v_mov_b32 v14, s28
    v_mov_b32 v15, 0
    s_mov_b64 exec, 1
    buffer_store_dword v14, v15, s[8:11], s16 offen sc1
    s_mov_b64 exec, -1
    v_mfma_f32_16x16x32_bf16 v[212:215], v[236:239], v[100:103], v[212:215]
    ds_read_b128 v[228:231], v5 offset:23552
    s_waitcnt lgkmcnt(3)
    v_mfma_f32_16x16x32_bf16 v[200:203], v[240:243], v[104:107], v[200:203]
    v_mfma_f32_16x16x32_bf16 v[204:207], v[240:243], v[108:111], v[204:207]
    ds_read_b128 v[232:235], v5 offset:24576
    s_mov_b32 s23, 0x2000
    buffer_load_dwordx4 v[32:35], v6, s[8:11], s23 offen offset:0 sc1
    s_waitcnt lgkmcnt(3)
    v_mfma_f32_16x16x32_bf16 v[208:211], v[244:247], v[104:107], v[208:211]
    v_mfma_f32_16x16x32_bf16 v[212:215], v[244:247], v[108:111], v[212:215]
    ds_read_b128 v[236:239], v5 offset:25600
    s_waitcnt lgkmcnt(3)
    v_mfma_f32_16x16x32_bf16 v[200:203], v[224:227], v[112:115], v[200:203]
    s_mov_b32 s23, 0x22000
    buffer_load_dwordx4 v[36:39], v6, s[8:11], s23 offen offset:0 sc1
    v_mfma_f32_16x16x32_bf16 v[204:207], v[224:227], v[116:119], v[204:207]
    ds_read_b128 v[240:243], v5 offset:26624
    s_waitcnt lgkmcnt(3)
    v_mfma_f32_16x16x32_bf16 v[208:211], v[228:231], v[112:115], v[208:211]
    v_mfma_f32_16x16x32_bf16 v[212:215], v[228:231], v[116:119], v[212:215]
    ds_read_b128 v[244:247], v5 offset:27648
    s_waitcnt lgkmcnt(3)
    v_mfma_f32_16x16x32_bf16 v[200:203], v[232:235], v[120:123], v[200:203]
    s_mov_b32 s23, 0x4000
    buffer_load_dwordx4 v[40:43], v6, s[8:11], s23 offen offset:0 sc1
    v_mfma_f32_16x16x32_bf16 v[204:207], v[232:235], v[124:127], v[204:207]
    ds_read_b128 v[224:227], v5 offset:28672
    s_waitcnt lgkmcnt(3)
    v_mfma_f32_16x16x32_bf16 v[208:211], v[236:239], v[120:123], v[208:211]
    v_mfma_f32_16x16x32_bf16 v[212:215], v[236:239], v[124:127], v[212:215]
    ds_read_b128 v[228:231], v5 offset:29696
    s_waitcnt lgkmcnt(3)
    v_mfma_f32_16x16x32_bf16 v[200:203], v[240:243], v[128:131], v[200:203]
    s_mov_b32 s23, 0x24000
    buffer_load_dwordx4 v[44:47], v6, s[8:11], s23 offen offset:0 sc1
    v_mfma_f32_16x16x32_bf16 v[204:207], v[240:243], v[132:135], v[204:207]
    ds_read_b128 v[232:235], v5 offset:30720
    s_waitcnt lgkmcnt(3)
    v_mfma_f32_16x16x32_bf16 v[208:211], v[244:247], v[128:131], v[208:211]
    v_mfma_f32_16x16x32_bf16 v[212:215], v[244:247], v[132:135], v[212:215]
    ds_read_b128 v[236:239], v5 offset:31744
    s_mov_b32 s23, 0x6000
    buffer_load_dwordx4 v[48:51], v6, s[8:11], s23 offen offset:0 sc1
    s_waitcnt lgkmcnt(3)
    v_mfma_f32_16x16x32_bf16 v[200:203], v[224:227], v[136:139], v[200:203]
    v_bfe_u32 v18, v1, 2, 2
    v_lshrrev_b32 v19, 4, v1
    v_mfma_f32_16x16x32_bf16 v[204:207], v[224:227], v[140:143], v[204:207]
    v_and_b32 v17, 3, v1
    v_lshlrev_b32 v16, 11, v19
    s_waitcnt lgkmcnt(2)
    v_mfma_f32_16x16x32_bf16 v[208:211], v[228:231], v[136:139], v[208:211]
    v_lshl_add_u32 v16, v18, 6, v16
    v_lshl_add_u32 v16, v17, 3, v16
    v_mfma_f32_16x16x32_bf16 v[212:215], v[228:231], v[140:143], v[212:215]
    s_mov_b32 s23, 0x26000
    buffer_load_dwordx4 v[52:55], v6, s[8:11], s23 offen offset:0 sc1
    v_add_u32 v16, 0x10000, v16
    v_and_b32 v19, 1, v19
    s_waitcnt lgkmcnt(1)
    v_mfma_f32_16x16x32_bf16 v[200:203], v[232:235], v[144:147], v[200:203]
    v_lshlrev_b32 v19, 5, v19
    v_sub_u32 v5, v16, v19
    v_mfma_f32_16x16x32_bf16 v[204:207], v[232:235], v[148:151], v[204:207]
    v_add_u32 v4, v16, v19
    v_add_u32 v7, 0x10000, v4
    s_waitcnt lgkmcnt(0)
    v_mfma_f32_16x16x32_bf16 v[208:211], v[236:239], v[144:147], v[208:211]
    v_add_u32 v8, 0x10000, v5
    v_mfma_f32_16x16x32_bf16 v[212:215], v[236:239], v[148:151], v[212:215]
    v_mul_f32 v200, v200, v9
    v_mul_f32 v201, v201, v9
    v_mul_f32 v202, v202, v9
    v_mul_f32 v203, v203, v9
    s_nop 1
    v_mul_f32 v208, v208, v9
    v_mul_f32 v209, v209, v9
    v_mul_f32 v210, v210, v9
    v_mul_f32 v211, v211, v9
    v_cvt_pk_bf16_f32 v216, v200, v201
    v_cvt_pk_bf16_f32 v217, v202, v203
    v_cvt_pk_bf16_f32 v218, v208, v209
    v_cvt_pk_bf16_f32 v219, v210, v211
    buffer_store_dwordx4 v[216:219], v2, s[8:11], s25 offen offset:3072 sc1
    v_mul_f32 v204, v204, v10
    v_mul_f32 v205, v205, v10
    v_mul_f32 v206, v206, v10
    v_mul_f32 v207, v207, v10
    v_mul_f32 v212, v212, v10
    v_mul_f32 v213, v213, v10
    v_mul_f32 v214, v214, v10
    v_mul_f32 v215, v215, v10
    v_cvt_pk_bf16_f32 v220, v204, v205
    v_cvt_pk_bf16_f32 v221, v206, v207
    v_cvt_pk_bf16_f32 v222, v212, v213
    v_cvt_pk_bf16_f32 v223, v214, v215
    buffer_store_dwordx4 v[220:223], v2, s[8:11], s26 offen offset:3072 sc1
    s_and_b32 s15, s2, 1
    s_barrier
    ds_read_b64_tr_b16 v[224:225], v4 offset:0
    ds_read_b64_tr_b16 v[226:227], v4 offset:1024
    ds_read_b64_tr_b16 v[228:229], v5 offset:32
    ds_read_b64_tr_b16 v[230:231], v5 offset:1056
    ds_read_b64_tr_b16 v[232:233], v4 offset:256
    ds_read_b64_tr_b16 v[234:235], v4 offset:1280
    ds_read_b64_tr_b16 v[236:237], v5 offset:288
    ds_read_b64_tr_b16 v[238:239], v5 offset:1312
    s_waitcnt vmcnt(11) lgkmcnt(6)
    v_mfma_f32_16x16x32_bf16 v[88:91], v[224:227], v[24:27], 0
    ds_read_b64_tr_b16 v[240:241], v4 offset:512
    s_waitcnt vmcnt(9)
    v_mfma_f32_16x16x32_bf16 v[92:95], v[224:227], v[28:31], 0
    s_add_u32 s22, s24, 0x200000
    s_add_u32 m0, s20, 0x20000
    s_nop 0
    buffer_load_dwordx4 v3, s[4:7], s22 offen lds
    ds_read_b64_tr_b16 v[242:243], v4 offset:1536
    s_waitcnt lgkmcnt(6)
    v_mfma_f32_16x16x32_bf16 v[96:99], v[228:231], v[24:27], 0
    ds_read_b64_tr_b16 v[244:245], v5 offset:544
    s_mov_b32 s23, 0x8000
    buffer_load_dwordx4 v[56:59], v6, s[8:11], s23 offen offset:0 sc1
    v_mfma_f32_16x16x32_bf16 v[100:103], v[228:231], v[28:31], 0
    ds_read_b64_tr_b16 v[246:247], v5 offset:1568
    s_waitcnt lgkmcnt(6)
    v_mfma_f32_16x16x32_bf16 v[104:107], v[232:235], v[24:27], 0
    s_add_u32 s22, s24, 0x202000
    s_add_u32 m0, s20, 0x20400
    s_nop 0
    buffer_load_dwordx4 v3, s[4:7], s22 offen lds
    ds_read_b64_tr_b16 v[224:225], v4 offset:768
    v_mfma_f32_16x16x32_bf16 v[108:111], v[232:235], v[28:31], 0
    ds_read_b64_tr_b16 v[226:227], v4 offset:1792
    s_mov_b32 s23, 0x28000
    buffer_load_dwordx4 v[60:63], v6, s[8:11], s23 offen offset:0 sc1
    s_waitcnt lgkmcnt(6)
    v_mfma_f32_16x16x32_bf16 v[112:115], v[236:239], v[24:27], 0
    ds_read_b64_tr_b16 v[228:229], v5 offset:800
    v_mfma_f32_16x16x32_bf16 v[116:119], v[236:239], v[28:31], 0
    ds_read_b64_tr_b16 v[230:231], v5 offset:1824
    s_waitcnt lgkmcnt(6)
    v_mfma_f32_16x16x32_bf16 v[120:123], v[240:243], v[24:27], 0
    v_mfma_f32_16x16x32_bf16 v[124:127], v[240:243], v[28:31], 0
    s_barrier
    ds_read_b64_tr_b16 v[232:233], v4 offset:16384
    ds_read_b64_tr_b16 v[234:235], v4 offset:17408
    s_waitcnt lgkmcnt(6)
    v_mfma_f32_16x16x32_bf16 v[128:131], v[244:247], v[24:27], 0
    s_add_u32 s22, s24, 0x280000
    s_add_u32 m0, s20, 0x24000
    s_nop 0
    buffer_load_dwordx4 v3, s[4:7], s22 offen lds
    ds_read_b64_tr_b16 v[236:237], v5 offset:16416
    v_mfma_f32_16x16x32_bf16 v[132:135], v[244:247], v[28:31], 0
    ds_read_b64_tr_b16 v[238:239], v5 offset:17440
    s_waitcnt lgkmcnt(6)
    v_mfma_f32_16x16x32_bf16 v[136:139], v[224:227], v[24:27], 0
    ds_read_b64_tr_b16 v[240:241], v4 offset:16640
    v_mfma_f32_16x16x32_bf16 v[140:143], v[224:227], v[28:31], 0
    s_add_u32 s22, s24, 0x282000
    s_add_u32 m0, s20, 0x24400
    s_nop 0
    buffer_load_dwordx4 v3, s[4:7], s22 offen lds
    ds_read_b64_tr_b16 v[242:243], v4 offset:17664
    s_waitcnt lgkmcnt(6)
    v_mfma_f32_16x16x32_bf16 v[144:147], v[228:231], v[24:27], 0
    ds_read_b64_tr_b16 v[244:245], v5 offset:16672
    v_mfma_f32_16x16x32_bf16 v[148:151], v[228:231], v[28:31], 0
    ds_read_b64_tr_b16 v[246:247], v5 offset:17696
    s_waitcnt vmcnt(13) lgkmcnt(6)
    v_mfma_f32_16x16x32_bf16 v[88:91], v[232:235], v[32:35], v[88:91]
    ds_read_b64_tr_b16 v[224:225], v4 offset:16896
    s_waitcnt vmcnt(12)
    v_mfma_f32_16x16x32_bf16 v[92:95], v[232:235], v[36:39], v[92:95]
    ds_read_b64_tr_b16 v[226:227], v4 offset:17920
    s_waitcnt lgkmcnt(6)
    v_mfma_f32_16x16x32_bf16 v[96:99], v[236:239], v[32:35], v[96:99]
    ds_read_b64_tr_b16 v[228:229], v5 offset:16928
    s_mov_b32 s23, 0xa000
    buffer_load_dwordx4 v[24:27], v6, s[8:11], s23 offen offset:0 sc1
    v_mfma_f32_16x16x32_bf16 v[100:103], v[236:239], v[36:39], v[100:103]
    ds_read_b64_tr_b16 v[230:231], v5 offset:17952
    s_waitcnt lgkmcnt(6)
    v_mfma_f32_16x16x32_bf16 v[104:107], v[240:243], v[32:35], v[104:107]
    ds_read_b64_tr_b16 v[232:233], v4 offset:17152
    v_mfma_f32_16x16x32_bf16 v[108:111], v[240:243], v[36:39], v[108:111]
    ds_read_b64_tr_b16 v[234:235], v4 offset:18176
    s_mov_b32 s23, 0x2a000
    buffer_load_dwordx4 v[28:31], v6, s[8:11], s23 offen offset:0 sc1
    s_waitcnt lgkmcnt(6)
    v_mfma_f32_16x16x32_bf16 v[112:115], v[244:247], v[32:35], v[112:115]
    ds_read_b64_tr_b16 v[236:237], v5 offset:17184
    v_mfma_f32_16x16x32_bf16 v[116:119], v[244:247], v[36:39], v[116:119]
    ds_read_b64_tr_b16 v[238:239], v5 offset:18208
    s_waitcnt lgkmcnt(6)
    v_mfma_f32_16x16x32_bf16 v[120:123], v[224:227], v[32:35], v[120:123]
    v_mfma_f32_16x16x32_bf16 v[124:127], v[224:227], v[36:39], v[124:127]
    s_barrier
    ds_read_b64_tr_b16 v[240:241], v4 offset:32768
    ds_read_b64_tr_b16 v[242:243], v4 offset:33792
    s_waitcnt lgkmcnt(6)
    v_mfma_f32_16x16x32_bf16 v[128:131], v[228:231], v[32:35], v[128:131]
    s_add_u32 s22, s24, 0x300000
    s_add_u32 m0, s20, 0x10000
    s_nop 0
    buffer_load_dwordx4 v3, s[4:7], s22 offen lds
    ds_read_b64_tr_b16 v[244:245], v5 offset:32800
    v_mfma_f32_16x16x32_bf16 v[132:135], v[228:231], v[36:39], v[132:135]
    ds_read_b64_tr_b16 v[246:247], v5 offset:33824
    s_waitcnt lgkmcnt(6)
    v_mfma_f32_16x16x32_bf16 v[136:139], v[232:235], v[32:35], v[136:139]
    ds_read_b64_tr_b16 v[224:225], v4 offset:33024
    v_mfma_f32_16x16x32_bf16 v[140:143], v[232:235], v[36:39], v[140:143]
    s_add_u32 s22, s24, 0x302000
    s_add_u32 m0, s20, 0x10400
    s_nop 0
    buffer_load_dwordx4 v3, s[4:7], s22 offen lds
    ds_read_b64_tr_b16 v[226:227], v4 offset:34048
    s_waitcnt lgkmcnt(6)
    v_mfma_f32_16x16x32_bf16 v[144:147], v[236:239], v[32:35], v[144:147]
    s_add_u32 s16, s63, 0x574000
    v_mov_b32 v14, s28
    v_mov_b32 v15, 0
    s_mov_b64 exec, 1
    buffer_store_dword v14, v15, s[8:11], s16 offen sc1
    s_mov_b64 exec, -1
    ds_read_b64_tr_b16 v[228:229], v5 offset:33056
    v_mfma_f32_16x16x32_bf16 v[148:151], v[236:239], v[36:39], v[148:151]
    ds_read_b64_tr_b16 v[230:231], v5 offset:34080
    s_waitcnt vmcnt(16) lgkmcnt(6)
    v_mfma_f32_16x16x32_bf16 v[88:91], v[240:243], v[40:43], v[88:91]
    ds_read_b64_tr_b16 v[232:233], v4 offset:33280
    s_waitcnt vmcnt(15)
    v_mfma_f32_16x16x32_bf16 v[92:95], v[240:243], v[44:47], v[92:95]
    ds_read_b64_tr_b16 v[234:235], v4 offset:34304
    s_waitcnt lgkmcnt(6)
    v_mfma_f32_16x16x32_bf16 v[96:99], v[244:247], v[40:43], v[96:99]
    ds_read_b64_tr_b16 v[236:237], v5 offset:33312
    s_mov_b32 s23, 0xc000
    buffer_load_dwordx4 v[32:35], v6, s[8:11], s23 offen offset:0 sc1
    v_mfma_f32_16x16x32_bf16 v[100:103], v[244:247], v[44:47], v[100:103]
    ds_read_b64_tr_b16 v[238:239], v5 offset:34336
    s_waitcnt lgkmcnt(6)
    v_mfma_f32_16x16x32_bf16 v[104:107], v[224:227], v[40:43], v[104:107]
    ds_read_b64_tr_b16 v[240:241], v4 offset:33536
    v_mfma_f32_16x16x32_bf16 v[108:111], v[224:227], v[44:47], v[108:111]
    ds_read_b64_tr_b16 v[242:243], v4 offset:34560
    s_mov_b32 s23, 0x2c000
    buffer_load_dwordx4 v[36:39], v6, s[8:11], s23 offen offset:0 sc1
    s_waitcnt lgkmcnt(6)
    v_mfma_f32_16x16x32_bf16 v[112:115], v[228:231], v[40:43], v[112:115]
    ds_read_b64_tr_b16 v[244:245], v5 offset:33568
    v_mfma_f32_16x16x32_bf16 v[116:119], v[228:231], v[44:47], v[116:119]
    ds_read_b64_tr_b16 v[246:247], v5 offset:34592
    s_waitcnt lgkmcnt(6)
    v_mfma_f32_16x16x32_bf16 v[120:123], v[232:235], v[40:43], v[120:123]
    v_mfma_f32_16x16x32_bf16 v[124:127], v[232:235], v[44:47], v[124:127]
    s_barrier
    ds_read_b64_tr_b16 v[224:225], v4 offset:49152
    ds_read_b64_tr_b16 v[226:227], v4 offset:50176
    s_add_u32 s19, s19, 8192
    buffer_load_dword v12, v13, s[8:11], s19 offen sc1
    s_waitcnt lgkmcnt(6)
    v_mfma_f32_16x16x32_bf16 v[128:131], v[236:239], v[40:43], v[128:131]
    s_add_u32 s22, s24, 0x380000
    s_add_u32 m0, s20, 0x14000
    s_nop 0
    buffer_load_dwordx4 v3, s[4:7], s22 offen lds
    ds_read_b64_tr_b16 v[228:229], v5 offset:49184
    v_mfma_f32_16x16x32_bf16 v[132:135], v[236:239], v[44:47], v[132:135]
    ds_read_b64_tr_b16 v[230:231], v5 offset:50208
    s_waitcnt lgkmcnt(6)
    v_mfma_f32_16x16x32_bf16 v[136:139], v[240:243], v[40:43], v[136:139]
    ds_read_b64_tr_b16 v[232:233], v4 offset:49408
    v_mfma_f32_16x16x32_bf16 v[140:143], v[240:243], v[44:47], v[140:143]
    s_add_u32 s22, s24, 0x382000
    s_add_u32 m0, s20, 0x14400
    s_nop 0
    buffer_load_dwordx4 v3, s[4:7], s22 offen lds
    ds_read_b64_tr_b16 v[234:235], v4 offset:50432
    s_waitcnt lgkmcnt(6)
    v_mfma_f32_16x16x32_bf16 v[144:147], v[244:247], v[40:43], v[144:147]
    ds_read_b64_tr_b16 v[236:237], v5 offset:49440
    v_mfma_f32_16x16x32_bf16 v[148:151], v[244:247], v[44:47], v[148:151]
    ds_read_b64_tr_b16 v[238:239], v5 offset:50464
    s_waitcnt vmcnt(19) lgkmcnt(6)
    v_mfma_f32_16x16x32_bf16 v[88:91], v[224:227], v[48:51], v[88:91]
    ds_read_b64_tr_b16 v[240:241], v4 offset:49664
    s_waitcnt vmcnt(18)
    v_mfma_f32_16x16x32_bf16 v[92:95], v[224:227], v[52:55], v[92:95]
    ds_read_b64_tr_b16 v[242:243], v4 offset:50688
    s_waitcnt lgkmcnt(6)
    v_mfma_f32_16x16x32_bf16 v[96:99], v[228:231], v[48:51], v[96:99]
    ds_read_b64_tr_b16 v[244:245], v5 offset:49696
    s_mov_b32 s23, 0xe000
    buffer_load_dwordx4 v[40:43], v6, s[8:11], s23 offen offset:0 sc1
    v_mfma_f32_16x16x32_bf16 v[100:103], v[228:231], v[52:55], v[100:103]
    ds_read_b64_tr_b16 v[246:247], v5 offset:50720
    s_waitcnt lgkmcnt(6)
    v_mfma_f32_16x16x32_bf16 v[104:107], v[232:235], v[48:51], v[104:107]
    ds_read_b64_tr_b16 v[224:225], v4 offset:49920
    v_mfma_f32_16x16x32_bf16 v[108:111], v[232:235], v[52:55], v[108:111]
    ds_read_b64_tr_b16 v[226:227], v4 offset:50944
    s_mov_b32 s23, 0x2e000
    buffer_load_dwordx4 v[44:47], v6, s[8:11], s23 offen offset:0 sc1
    s_waitcnt lgkmcnt(6)
    v_mfma_f32_16x16x32_bf16 v[112:115], v[236:239], v[48:51], v[112:115]
    ds_read_b64_tr_b16 v[228:229], v5 offset:49952
    v_mfma_f32_16x16x32_bf16 v[116:119], v[236:239], v[52:55], v[116:119]
    ds_read_b64_tr_b16 v[230:231], v5 offset:50976
    s_waitcnt lgkmcnt(6)
    v_mfma_f32_16x16x32_bf16 v[120:123], v[240:243], v[48:51], v[120:123]
    v_mfma_f32_16x16x32_bf16 v[124:127], v[240:243], v[52:55], v[124:127]
    s_waitcnt vmcnt(15)
    s_barrier
    ds_read_b64_tr_b16 v[232:233], v7 offset:0
    ds_read_b64_tr_b16 v[234:235], v7 offset:1024
    s_waitcnt lgkmcnt(6)
    v_mfma_f32_16x16x32_bf16 v[128:131], v[244:247], v[48:51], v[128:131]
    s_add_u32 s22, s24, 0x10000
    s_add_u32 m0, s20, 0x18000
    s_nop 0
    buffer_load_dwordx4 v3, s[4:7], s22 offen lds
    ds_read_b64_tr_b16 v[236:237], v8 offset:32
    v_mfma_f32_16x16x32_bf16 v[132:135], v[244:247], v[52:55], v[132:135]
    ds_read_b64_tr_b16 v[238:239], v8 offset:1056
    s_waitcnt lgkmcnt(6)
    v_mfma_f32_16x16x32_bf16 v[136:139], v[224:227], v[48:51], v[136:139]
    ds_read_b64_tr_b16 v[240:241], v7 offset:256
    v_mfma_f32_16x16x32_bf16 v[140:143], v[224:227], v[52:55], v[140:143]
    s_add_u32 s22, s24, 0x12000
    s_add_u32 m0, s20, 0x18400
    s_nop 0
    buffer_load_dwordx4 v3, s[4:7], s22 offen lds
    ds_read_b64_tr_b16 v[242:243], v7 offset:1280
    s_waitcnt lgkmcnt(6)
    v_mfma_f32_16x16x32_bf16 v[144:147], v[228:231], v[48:51], v[144:147]
    ds_read_b64_tr_b16 v[244:245], v8 offset:288
    v_mfma_f32_16x16x32_bf16 v[148:151], v[228:231], v[52:55], v[148:151]
    ds_read_b64_tr_b16 v[246:247], v8 offset:1312
    s_waitcnt vmcnt(6)
    v_cmp_ne_u32 vcc, s28, v12
    s_cbranch_vccnz adaLN_cond__sliding_block_cached__moe_arch_mod__prompt_kernel_o27r
adaLN_cond__sliding_block_cached__moe_arch_mod__prompt_kernel_o27b:
    s_waitcnt lgkmcnt(6)
    v_mfma_f32_16x16x32_bf16 v[88:91], v[232:235], v[56:59], v[88:91]
    ds_read_b64_tr_b16 v[224:225], v7 offset:512
    v_mfma_f32_16x16x32_bf16 v[92:95], v[232:235], v[60:63], v[92:95]
    ds_read_b64_tr_b16 v[226:227], v7 offset:1536
    s_waitcnt lgkmcnt(6)
    v_mfma_f32_16x16x32_bf16 v[96:99], v[236:239], v[56:59], v[96:99]
    ds_read_b64_tr_b16 v[228:229], v8 offset:544
    s_mov_b32 s23, 0x0
    buffer_load_dwordx4 v[48:51], v6, s[8:11], s23 offen offset:1024 sc1
    v_mfma_f32_16x16x32_bf16 v[100:103], v[236:239], v[60:63], v[100:103]
    ds_read_b64_tr_b16 v[230:231], v8 offset:1568
    s_waitcnt lgkmcnt(6)
    v_mfma_f32_16x16x32_bf16 v[104:107], v[240:243], v[56:59], v[104:107]
    ds_read_b64_tr_b16 v[232:233], v7 offset:768
    v_mfma_f32_16x16x32_bf16 v[108:111], v[240:243], v[60:63], v[108:111]
    ds_read_b64_tr_b16 v[234:235], v7 offset:1792
    s_mov_b32 s23, 0x20000
    buffer_load_dwordx4 v[52:55], v6, s[8:11], s23 offen offset:1024 sc1
    s_waitcnt lgkmcnt(6)
    v_mfma_f32_16x16x32_bf16 v[112:115], v[244:247], v[56:59], v[112:115]
    ds_read_b64_tr_b16 v[236:237], v8 offset:800
    v_mfma_f32_16x16x32_bf16 v[116:119], v[244:247], v[60:63], v[116:119]
    ds_read_b64_tr_b16 v[238:239], v8 offset:1824
    s_waitcnt lgkmcnt(6)
    v_mfma_f32_16x16x32_bf16 v[120:123], v[224:227], v[56:59], v[120:123]
    v_mfma_f32_16x16x32_bf16 v[124:127], v[224:227], v[60:63], v[124:127]
    s_barrier
    ds_read_b64_tr_b16 v[240:241], v7 offset:16384
    ds_read_b64_tr_b16 v[242:243], v7 offset:17408
    s_waitcnt lgkmcnt(6)
    v_mfma_f32_16x16x32_bf16 v[128:131], v[228:231], v[56:59], v[128:131]
    s_add_u32 s22, s24, 0x90000
    s_add_u32 m0, s20, 0x1c000
    s_nop 0
    buffer_load_dwordx4 v3, s[4:7], s22 offen lds
    ds_read_b64_tr_b16 v[244:245], v8 offset:16416
    v_mfma_f32_16x16x32_bf16 v[132:135], v[228:231], v[60:63], v[132:135]
    ds_read_b64_tr_b16 v[246:247], v8 offset:17440
    s_waitcnt lgkmcnt(6)
    v_mfma_f32_16x16x32_bf16 v[136:139], v[232:235], v[56:59], v[136:139]
    ds_read_b64_tr_b16 v[224:225], v7 offset:16640
    v_mfma_f32_16x16x32_bf16 v[140:143], v[232:235], v[60:63], v[140:143]
    s_add_u32 s22, s24, 0x92000
    s_add_u32 m0, s20, 0x1c400
    s_nop 0
    buffer_load_dwordx4 v3, s[4:7], s22 offen lds
    ds_read_b64_tr_b16 v[226:227], v7 offset:17664
    s_waitcnt lgkmcnt(6)
    v_mfma_f32_16x16x32_bf16 v[144:147], v[236:239], v[56:59], v[144:147]
    ds_read_b64_tr_b16 v[228:229], v8 offset:16672
    v_mfma_f32_16x16x32_bf16 v[148:151], v[236:239], v[60:63], v[148:151]
    ds_read_b64_tr_b16 v[230:231], v8 offset:17696
    s_waitcnt lgkmcnt(6)
    v_mfma_f32_16x16x32_bf16 v[88:91], v[240:243], v[24:27], v[88:91]
    ds_read_b64_tr_b16 v[232:233], v7 offset:16896
    v_mfma_f32_16x16x32_bf16 v[92:95], v[240:243], v[28:31], v[92:95]
    ds_read_b64_tr_b16 v[234:235], v7 offset:17920
    s_waitcnt lgkmcnt(6)
    v_mfma_f32_16x16x32_bf16 v[96:99], v[244:247], v[24:27], v[96:99]
    ds_read_b64_tr_b16 v[236:237], v8 offset:16928
    s_mov_b32 s23, 0x2000
    buffer_load_dwordx4 v[56:59], v6, s[8:11], s23 offen offset:1024 sc1
    v_mfma_f32_16x16x32_bf16 v[100:103], v[244:247], v[28:31], v[100:103]
    ds_read_b64_tr_b16 v[238:239], v8 offset:17952
    s_waitcnt lgkmcnt(6)
    v_mfma_f32_16x16x32_bf16 v[104:107], v[224:227], v[24:27], v[104:107]
    ds_read_b64_tr_b16 v[240:241], v7 offset:17152
    v_mfma_f32_16x16x32_bf16 v[108:111], v[224:227], v[28:31], v[108:111]
    ds_read_b64_tr_b16 v[242:243], v7 offset:18176
    s_mov_b32 s23, 0x22000
    buffer_load_dwordx4 v[60:63], v6, s[8:11], s23 offen offset:1024 sc1
    s_waitcnt lgkmcnt(6)
    v_mfma_f32_16x16x32_bf16 v[112:115], v[228:231], v[24:27], v[112:115]
    ds_read_b64_tr_b16 v[244:245], v8 offset:17184
    v_mfma_f32_16x16x32_bf16 v[116:119], v[228:231], v[28:31], v[116:119]
    ds_read_b64_tr_b16 v[246:247], v8 offset:18208
    s_waitcnt lgkmcnt(6)
    v_mfma_f32_16x16x32_bf16 v[120:123], v[232:235], v[24:27], v[120:123]
    v_mfma_f32_16x16x32_bf16 v[124:127], v[232:235], v[28:31], v[124:127]
    s_barrier
    ds_read_b64_tr_b16 v[224:225], v4 offset:0
    ds_read_b64_tr_b16 v[226:227], v4 offset:1024
    s_waitcnt lgkmcnt(6)
    v_mfma_f32_16x16x32_bf16 v[128:131], v[236:239], v[24:27], v[128:131]
    s_add_u32 s16, s63, 0x576000
    v_mov_b32 v14, s28
    v_mov_b32 v15, 0
    s_mov_b64 exec, 1
    buffer_store_dword v14, v15, s[8:11], s16 offen sc1
    s_mov_b64 exec, -1
    s_add_u32 s22, s24, 0x110000
    s_add_u32 m0, s20, 0x20000
    s_nop 0
    buffer_load_dwordx4 v3, s[4:7], s22 offen lds
    ds_read_b64_tr_b16 v[228:229], v5 offset:32
    v_mfma_f32_16x16x32_bf16 v[132:135], v[236:239], v[28:31], v[132:135]
    ds_read_b64_tr_b16 v[230:231], v5 offset:1056
    s_waitcnt lgkmcnt(6)
    v_mfma_f32_16x16x32_bf16 v[136:139], v[240:243], v[24:27], v[136:139]
    ds_read_b64_tr_b16 v[232:233], v4 offset:256
    v_mfma_f32_16x16x32_bf16 v[140:143], v[240:243], v[28:31], v[140:143]
    s_add_u32 s22, s24, 0x112000
    s_add_u32 m0, s20, 0x20400
    s_nop 0
    buffer_load_dwordx4 v3, s[4:7], s22 offen lds
    ds_read_b64_tr_b16 v[234:235], v4 offset:1280
    s_waitcnt lgkmcnt(6)
    v_mfma_f32_16x16x32_bf16 v[144:147], v[244:247], v[24:27], v[144:147]
    ds_read_b64_tr_b16 v[236:237], v5 offset:288
    v_mfma_f32_16x16x32_bf16 v[148:151], v[244:247], v[28:31], v[148:151]
    ds_read_b64_tr_b16 v[238:239], v5 offset:1312
    s_waitcnt lgkmcnt(6)
    v_mfma_f32_16x16x32_bf16 v[88:91], v[224:227], v[32:35], v[88:91]
    ds_read_b64_tr_b16 v[240:241], v4 offset:512
    v_mfma_f32_16x16x32_bf16 v[92:95], v[224:227], v[36:39], v[92:95]
    ds_read_b64_tr_b16 v[242:243], v4 offset:1536
    s_waitcnt lgkmcnt(6)
    v_mfma_f32_16x16x32_bf16 v[96:99], v[228:231], v[32:35], v[96:99]
    ds_read_b64_tr_b16 v[244:245], v5 offset:544
    s_mov_b32 s23, 0x4000
    buffer_load_dwordx4 v[24:27], v6, s[8:11], s23 offen offset:1024 sc1
    v_mfma_f32_16x16x32_bf16 v[100:103], v[228:231], v[36:39], v[100:103]
    ds_read_b64_tr_b16 v[246:247], v5 offset:1568
    s_waitcnt lgkmcnt(6)
    v_mfma_f32_16x16x32_bf16 v[104:107], v[232:235], v[32:35], v[104:107]
    ds_read_b64_tr_b16 v[224:225], v4 offset:768
    v_mfma_f32_16x16x32_bf16 v[108:111], v[232:235], v[36:39], v[108:111]
    ds_read_b64_tr_b16 v[226:227], v4 offset:1792
    s_mov_b32 s23, 0x24000
    buffer_load_dwordx4 v[28:31], v6, s[8:11], s23 offen offset:1024 sc1
    s_waitcnt lgkmcnt(6)
    v_mfma_f32_16x16x32_bf16 v[112:115], v[236:239], v[32:35], v[112:115]
    ds_read_b64_tr_b16 v[228:229], v5 offset:800
    v_mfma_f32_16x16x32_bf16 v[116:119], v[236:239], v[36:39], v[116:119]
    ds_read_b64_tr_b16 v[230:231], v5 offset:1824
    s_waitcnt lgkmcnt(6)
    v_mfma_f32_16x16x32_bf16 v[120:123], v[240:243], v[32:35], v[120:123]
    v_mfma_f32_16x16x32_bf16 v[124:127], v[240:243], v[36:39], v[124:127]
    s_waitcnt vmcnt(15)
    s_barrier
    ds_read_b64_tr_b16 v[232:233], v4 offset:16384
    ds_read_b64_tr_b16 v[234:235], v4 offset:17408
    s_waitcnt lgkmcnt(6)
    v_mfma_f32_16x16x32_bf16 v[128:131], v[244:247], v[32:35], v[128:131]
    s_add_u32 s22, s24, 0x190000
    s_add_u32 m0, s20, 0x24000
    s_nop 0
    buffer_load_dwordx4 v3, s[4:7], s22 offen lds
    ds_read_b64_tr_b16 v[236:237], v5 offset:16416
    v_mfma_f32_16x16x32_bf16 v[132:135], v[244:247], v[36:39], v[132:135]
    ds_read_b64_tr_b16 v[238:239], v5 offset:17440
    s_waitcnt lgkmcnt(6)
    v_mfma_f32_16x16x32_bf16 v[136:139], v[224:227], v[32:35], v[136:139]
    ds_read_b64_tr_b16 v[240:241], v4 offset:16640
    v_mfma_f32_16x16x32_bf16 v[140:143], v[224:227], v[36:39], v[140:143]
    s_add_u32 s22, s24, 0x192000
    s_add_u32 m0, s20, 0x24400
    s_nop 0
    buffer_load_dwordx4 v3, s[4:7], s22 offen lds
    ds_read_b64_tr_b16 v[242:243], v4 offset:17664
    s_waitcnt lgkmcnt(6)
    v_mfma_f32_16x16x32_bf16 v[144:147], v[228:231], v[32:35], v[144:147]
    ds_read_b64_tr_b16 v[244:245], v5 offset:16672
    v_mfma_f32_16x16x32_bf16 v[148:151], v[228:231], v[36:39], v[148:151]
    ds_read_b64_tr_b16 v[246:247], v5 offset:17696
    s_waitcnt vmcnt(16) lgkmcnt(6)
    v_mfma_f32_16x16x32_bf16 v[88:91], v[232:235], v[40:43], v[88:91]
    ds_read_b64_tr_b16 v[224:225], v4 offset:16896
    s_waitcnt vmcnt(15)
    v_mfma_f32_16x16x32_bf16 v[92:95], v[232:235], v[44:47], v[92:95]
    ds_read_b64_tr_b16 v[226:227], v4 offset:17920
    s_waitcnt lgkmcnt(6)
    v_mfma_f32_16x16x32_bf16 v[96:99], v[236:239], v[40:43], v[96:99]
    ds_read_b64_tr_b16 v[228:229], v5 offset:16928
    s_mov_b32 s23, 0x6000
    buffer_load_dwordx4 v[32:35], v6, s[8:11], s23 offen offset:1024 sc1
    v_mfma_f32_16x16x32_bf16 v[100:103], v[236:239], v[44:47], v[100:103]
    ds_read_b64_tr_b16 v[230:231], v5 offset:17952
    s_waitcnt lgkmcnt(6)
    v_mfma_f32_16x16x32_bf16 v[104:107], v[240:243], v[40:43], v[104:107]
    ds_read_b64_tr_b16 v[232:233], v4 offset:17152
    v_mfma_f32_16x16x32_bf16 v[108:111], v[240:243], v[44:47], v[108:111]
    ds_read_b64_tr_b16 v[234:235], v4 offset:18176
    s_mov_b32 s23, 0x26000
    buffer_load_dwordx4 v[36:39], v6, s[8:11], s23 offen offset:1024 sc1
    s_waitcnt lgkmcnt(6)
    v_mfma_f32_16x16x32_bf16 v[112:115], v[244:247], v[40:43], v[112:115]
    ds_read_b64_tr_b16 v[236:237], v5 offset:17184
    v_mfma_f32_16x16x32_bf16 v[116:119], v[244:247], v[44:47], v[116:119]
    ds_read_b64_tr_b16 v[238:239], v5 offset:18208
    s_waitcnt lgkmcnt(6)
    v_mfma_f32_16x16x32_bf16 v[120:123], v[224:227], v[40:43], v[120:123]
    v_mfma_f32_16x16x32_bf16 v[124:127], v[224:227], v[44:47], v[124:127]
    s_waitcnt vmcnt(15)
    s_barrier
    ds_read_b64_tr_b16 v[240:241], v4 offset:32768
    ds_read_b64_tr_b16 v[242:243], v4 offset:33792
    s_waitcnt lgkmcnt(6)
    v_mfma_f32_16x16x32_bf16 v[128:131], v[228:231], v[40:43], v[128:131]
    s_add_u32 s22, s24, 0x210000
    s_add_u32 m0, s20, 0x10000
    s_nop 0
    buffer_load_dwordx4 v3, s[4:7], s22 offen lds
    ds_read_b64_tr_b16 v[244:245], v5 offset:32800
    v_mfma_f32_16x16x32_bf16 v[132:135], v[228:231], v[44:47], v[132:135]
    ds_read_b64_tr_b16 v[246:247], v5 offset:33824
    s_waitcnt lgkmcnt(6)
    v_mfma_f32_16x16x32_bf16 v[136:139], v[232:235], v[40:43], v[136:139]
    ds_read_b64_tr_b16 v[224:225], v4 offset:33024
    v_mfma_f32_16x16x32_bf16 v[140:143], v[232:235], v[44:47], v[140:143]
    s_add_u32 s22, s24, 0x212000
    s_add_u32 m0, s20, 0x10400
    s_nop 0
    buffer_load_dwordx4 v3, s[4:7], s22 offen lds
    ds_read_b64_tr_b16 v[226:227], v4 offset:34048
    s_waitcnt lgkmcnt(6)
    v_mfma_f32_16x16x32_bf16 v[144:147], v[236:239], v[40:43], v[144:147]
    ds_read_b64_tr_b16 v[228:229], v5 offset:33056
    v_mfma_f32_16x16x32_bf16 v[148:151], v[236:239], v[44:47], v[148:151]
    ds_read_b64_tr_b16 v[230:231], v5 offset:34080
    s_waitcnt vmcnt(16) lgkmcnt(6)
    v_mfma_f32_16x16x32_bf16 v[88:91], v[240:243], v[48:51], v[88:91]
    ds_read_b64_tr_b16 v[232:233], v4 offset:33280
    s_waitcnt vmcnt(15)
    v_mfma_f32_16x16x32_bf16 v[92:95], v[240:243], v[52:55], v[92:95]
    ds_read_b64_tr_b16 v[234:235], v4 offset:34304
    s_waitcnt lgkmcnt(6)
    v_mfma_f32_16x16x32_bf16 v[96:99], v[244:247], v[48:51], v[96:99]
    ds_read_b64_tr_b16 v[236:237], v5 offset:33312
    s_mov_b32 s23, 0x8000
    buffer_load_dwordx4 v[40:43], v6, s[8:11], s23 offen offset:1024 sc1
    v_mfma_f32_16x16x32_bf16 v[100:103], v[244:247], v[52:55], v[100:103]
    ds_read_b64_tr_b16 v[238:239], v5 offset:34336
    s_waitcnt lgkmcnt(6)
    v_mfma_f32_16x16x32_bf16 v[104:107], v[224:227], v[48:51], v[104:107]
    ds_read_b64_tr_b16 v[240:241], v4 offset:33536
    v_mfma_f32_16x16x32_bf16 v[108:111], v[224:227], v[52:55], v[108:111]
    ds_read_b64_tr_b16 v[242:243], v4 offset:34560
    s_mov_b32 s23, 0x28000
    buffer_load_dwordx4 v[44:47], v6, s[8:11], s23 offen offset:1024 sc1
    s_waitcnt lgkmcnt(6)
    v_mfma_f32_16x16x32_bf16 v[112:115], v[228:231], v[48:51], v[112:115]
    ds_read_b64_tr_b16 v[244:245], v5 offset:33568
    v_mfma_f32_16x16x32_bf16 v[116:119], v[228:231], v[52:55], v[116:119]
    ds_read_b64_tr_b16 v[246:247], v5 offset:34592
    s_waitcnt lgkmcnt(6)
    v_mfma_f32_16x16x32_bf16 v[120:123], v[232:235], v[48:51], v[120:123]
    v_mfma_f32_16x16x32_bf16 v[124:127], v[232:235], v[52:55], v[124:127]
    s_waitcnt vmcnt(15)
    s_barrier
    ds_read_b64_tr_b16 v[224:225], v4 offset:49152
    ds_read_b64_tr_b16 v[226:227], v4 offset:50176
    s_waitcnt lgkmcnt(6)
    v_mfma_f32_16x16x32_bf16 v[128:131], v[236:239], v[48:51], v[128:131]
    s_add_u32 s22, s24, 0x290000
    s_add_u32 m0, s20, 0x14000
    s_nop 0
    buffer_load_dwordx4 v3, s[4:7], s22 offen lds
    ds_read_b64_tr_b16 v[228:229], v5 offset:49184
    v_mfma_f32_16x16x32_bf16 v[132:135], v[236:239], v[52:55], v[132:135]
    ds_read_b64_tr_b16 v[230:231], v5 offset:50208
    s_waitcnt lgkmcnt(6)
    v_mfma_f32_16x16x32_bf16 v[136:139], v[240:243], v[48:51], v[136:139]
    ds_read_b64_tr_b16 v[232:233], v4 offset:49408
    v_mfma_f32_16x16x32_bf16 v[140:143], v[240:243], v[52:55], v[140:143]
    s_add_u32 s22, s24, 0x292000
    s_add_u32 m0, s20, 0x14400
    s_nop 0
    buffer_load_dwordx4 v3, s[4:7], s22 offen lds
    ds_read_b64_tr_b16 v[234:235], v4 offset:50432
    s_waitcnt lgkmcnt(6)
    v_mfma_f32_16x16x32_bf16 v[144:147], v[244:247], v[48:51], v[144:147]
    ds_read_b64_tr_b16 v[236:237], v5 offset:49440
    v_mfma_f32_16x16x32_bf16 v[148:151], v[244:247], v[52:55], v[148:151]
    ds_read_b64_tr_b16 v[238:239], v5 offset:50464
    s_waitcnt vmcnt(16) lgkmcnt(6)
    v_mfma_f32_16x16x32_bf16 v[88:91], v[224:227], v[56:59], v[88:91]
    ds_read_b64_tr_b16 v[240:241], v4 offset:49664
    s_waitcnt vmcnt(15)
    v_mfma_f32_16x16x32_bf16 v[92:95], v[224:227], v[60:63], v[92:95]
    ds_read_b64_tr_b16 v[242:243], v4 offset:50688
    s_waitcnt lgkmcnt(6)
    v_mfma_f32_16x16x32_bf16 v[96:99], v[228:231], v[56:59], v[96:99]
    ds_read_b64_tr_b16 v[244:245], v5 offset:49696
    s_mov_b32 s23, 0xa000
    buffer_load_dwordx4 v[48:51], v6, s[8:11], s23 offen offset:1024 sc1
    v_mfma_f32_16x16x32_bf16 v[100:103], v[228:231], v[60:63], v[100:103]
    ds_read_b64_tr_b16 v[246:247], v5 offset:50720
    s_waitcnt lgkmcnt(6)
    v_mfma_f32_16x16x32_bf16 v[104:107], v[232:235], v[56:59], v[104:107]
    ds_read_b64_tr_b16 v[224:225], v4 offset:49920
    v_mfma_f32_16x16x32_bf16 v[108:111], v[232:235], v[60:63], v[108:111]
    ds_read_b64_tr_b16 v[226:227], v4 offset:50944
    s_mov_b32 s23, 0x2a000
    buffer_load_dwordx4 v[52:55], v6, s[8:11], s23 offen offset:1024 sc1
    s_waitcnt lgkmcnt(6)
    v_mfma_f32_16x16x32_bf16 v[112:115], v[236:239], v[56:59], v[112:115]
    ds_read_b64_tr_b16 v[228:229], v5 offset:49952
    v_mfma_f32_16x16x32_bf16 v[116:119], v[236:239], v[60:63], v[116:119]
    ds_read_b64_tr_b16 v[230:231], v5 offset:50976
    s_waitcnt lgkmcnt(6)
    v_mfma_f32_16x16x32_bf16 v[120:123], v[240:243], v[56:59], v[120:123]
    v_mfma_f32_16x16x32_bf16 v[124:127], v[240:243], v[60:63], v[124:127]
    s_waitcnt vmcnt(14)
    s_barrier
    ds_read_b64_tr_b16 v[232:233], v7 offset:0
    ds_read_b64_tr_b16 v[234:235], v7 offset:1024
    s_waitcnt lgkmcnt(6)
    v_mfma_f32_16x16x32_bf16 v[128:131], v[244:247], v[56:59], v[128:131]
    s_add_u32 s22, s24, 0x310000
    s_add_u32 m0, s20, 0x18000
    s_nop 0
    buffer_load_dwordx4 v3, s[4:7], s22 offen lds
    ds_read_b64_tr_b16 v[236:237], v8 offset:32
    v_mfma_f32_16x16x32_bf16 v[132:135], v[244:247], v[60:63], v[132:135]
    ds_read_b64_tr_b16 v[238:239], v8 offset:1056
    s_waitcnt lgkmcnt(6)
    v_mfma_f32_16x16x32_bf16 v[136:139], v[224:227], v[56:59], v[136:139]
    ds_read_b64_tr_b16 v[240:241], v7 offset:256
    v_mfma_f32_16x16x32_bf16 v[140:143], v[224:227], v[60:63], v[140:143]
    s_add_u32 s22, s24, 0x312000
    s_add_u32 m0, s20, 0x18400
    s_nop 0
    buffer_load_dwordx4 v3, s[4:7], s22 offen lds
    ds_read_b64_tr_b16 v[242:243], v7 offset:1280
    s_waitcnt lgkmcnt(6)
    v_mfma_f32_16x16x32_bf16 v[144:147], v[228:231], v[56:59], v[144:147]
    ds_read_b64_tr_b16 v[244:245], v8 offset:288
    v_mfma_f32_16x16x32_bf16 v[148:151], v[228:231], v[60:63], v[148:151]
    ds_read_b64_tr_b16 v[246:247], v8 offset:1312
    s_waitcnt vmcnt(15) lgkmcnt(6)
    v_mfma_f32_16x16x32_bf16 v[88:91], v[232:235], v[24:27], v[88:91]
    ds_read_b64_tr_b16 v[224:225], v7 offset:512
    s_waitcnt vmcnt(14)
    v_mfma_f32_16x16x32_bf16 v[92:95], v[232:235], v[28:31], v[92:95]
    ds_read_b64_tr_b16 v[226:227], v7 offset:1536
    s_waitcnt lgkmcnt(6)
    v_mfma_f32_16x16x32_bf16 v[96:99], v[236:239], v[24:27], v[96:99]
    ds_read_b64_tr_b16 v[228:229], v8 offset:544
    s_mov_b32 s23, 0xc000
    buffer_load_dwordx4 v[56:59], v6, s[8:11], s23 offen offset:1024 sc1
    v_mfma_f32_16x16x32_bf16 v[100:103], v[236:239], v[28:31], v[100:103]
    ds_read_b64_tr_b16 v[230:231], v8 offset:1568
    s_waitcnt lgkmcnt(6)
    v_mfma_f32_16x16x32_bf16 v[104:107], v[240:243], v[24:27], v[104:107]
    ds_read_b64_tr_b16 v[232:233], v7 offset:768
    v_mfma_f32_16x16x32_bf16 v[108:111], v[240:243], v[28:31], v[108:111]
    ds_read_b64_tr_b16 v[234:235], v7 offset:1792
    s_mov_b32 s23, 0x2c000
    buffer_load_dwordx4 v[60:63], v6, s[8:11], s23 offen offset:1024 sc1
    s_waitcnt lgkmcnt(6)
    v_mfma_f32_16x16x32_bf16 v[112:115], v[244:247], v[24:27], v[112:115]
    ds_read_b64_tr_b16 v[236:237], v8 offset:800
    v_mfma_f32_16x16x32_bf16 v[116:119], v[244:247], v[28:31], v[116:119]
    ds_read_b64_tr_b16 v[238:239], v8 offset:1824
    s_waitcnt lgkmcnt(6)
    v_mfma_f32_16x16x32_bf16 v[120:123], v[224:227], v[24:27], v[120:123]
    v_mfma_f32_16x16x32_bf16 v[124:127], v[224:227], v[28:31], v[124:127]
    s_waitcnt vmcnt(14)
    s_barrier
    ds_read_b64_tr_b16 v[240:241], v7 offset:16384
    ds_read_b64_tr_b16 v[242:243], v7 offset:17408
    s_add_u32 s19, s19, 8192
    buffer_load_dword v12, v13, s[8:11], s19 offen sc1
    s_waitcnt lgkmcnt(6)
    v_mfma_f32_16x16x32_bf16 v[128:131], v[228:231], v[24:27], v[128:131]
    s_add_u32 s22, s24, 0x390000
    s_add_u32 m0, s20, 0x1c000
    s_nop 0
    buffer_load_dwordx4 v3, s[4:7], s22 offen lds
    ds_read_b64_tr_b16 v[244:245], v8 offset:16416
    v_mfma_f32_16x16x32_bf16 v[132:135], v[228:231], v[28:31], v[132:135]
    ds_read_b64_tr_b16 v[246:247], v8 offset:17440
    s_waitcnt lgkmcnt(6)
    v_mfma_f32_16x16x32_bf16 v[136:139], v[232:235], v[24:27], v[136:139]
    ds_read_b64_tr_b16 v[224:225], v7 offset:16640
    v_mfma_f32_16x16x32_bf16 v[140:143], v[232:235], v[28:31], v[140:143]
    s_add_u32 s22, s24, 0x392000
    s_add_u32 m0, s20, 0x1c400
    s_nop 0
    buffer_load_dwordx4 v3, s[4:7], s22 offen lds
    ds_read_b64_tr_b16 v[226:227], v7 offset:17664
    s_waitcnt lgkmcnt(6)
    v_mfma_f32_16x16x32_bf16 v[144:147], v[236:239], v[24:27], v[144:147]
    ds_read_b64_tr_b16 v[228:229], v8 offset:16672
    v_mfma_f32_16x16x32_bf16 v[148:151], v[236:239], v[28:31], v[148:151]
    ds_read_b64_tr_b16 v[230:231], v8 offset:17696
    s_waitcnt vmcnt(16) lgkmcnt(6)
    v_mfma_f32_16x16x32_bf16 v[88:91], v[240:243], v[32:35], v[88:91]
    ds_read_b64_tr_b16 v[232:233], v7 offset:16896
    s_waitcnt vmcnt(15)
    v_mfma_f32_16x16x32_bf16 v[92:95], v[240:243], v[36:39], v[92:95]
    ds_read_b64_tr_b16 v[234:235], v7 offset:17920
    s_waitcnt lgkmcnt(6)
    v_mfma_f32_16x16x32_bf16 v[96:99], v[244:247], v[32:35], v[96:99]
    ds_read_b64_tr_b16 v[236:237], v8 offset:16928
    s_mov_b32 s23, 0xe000
    buffer_load_dwordx4 v[24:27], v6, s[8:11], s23 offen offset:1024 sc1
    v_mfma_f32_16x16x32_bf16 v[100:103], v[244:247], v[36:39], v[100:103]
    ds_read_b64_tr_b16 v[238:239], v8 offset:17952
    s_waitcnt lgkmcnt(6)
    v_mfma_f32_16x16x32_bf16 v[104:107], v[224:227], v[32:35], v[104:107]
    ds_read_b64_tr_b16 v[240:241], v7 offset:17152
    v_mfma_f32_16x16x32_bf16 v[108:111], v[224:227], v[36:39], v[108:111]
    ds_read_b64_tr_b16 v[242:243], v7 offset:18176
    s_mov_b32 s23, 0x2e000
    buffer_load_dwordx4 v[28:31], v6, s[8:11], s23 offen offset:1024 sc1
    s_waitcnt lgkmcnt(6)
    v_mfma_f32_16x16x32_bf16 v[112:115], v[228:231], v[32:35], v[112:115]
    ds_read_b64_tr_b16 v[244:245], v8 offset:17184
    v_mfma_f32_16x16x32_bf16 v[116:119], v[228:231], v[36:39], v[116:119]
    ds_read_b64_tr_b16 v[246:247], v8 offset:18208
    s_waitcnt lgkmcnt(6)
    v_mfma_f32_16x16x32_bf16 v[120:123], v[232:235], v[32:35], v[120:123]
    v_mfma_f32_16x16x32_bf16 v[124:127], v[232:235], v[36:39], v[124:127]
    s_waitcnt vmcnt(15)
    s_barrier
    ds_read_b64_tr_b16 v[224:225], v4 offset:0
    ds_read_b64_tr_b16 v[226:227], v4 offset:1024
    s_waitcnt lgkmcnt(6)
    v_mfma_f32_16x16x32_bf16 v[128:131], v[236:239], v[32:35], v[128:131]
    s_add_u32 s22, s24, 0x20000
    s_add_u32 m0, s20, 0x20000
    s_nop 0
    buffer_load_dwordx4 v3, s[4:7], s22 offen lds
    ds_read_b64_tr_b16 v[228:229], v5 offset:32
    v_mfma_f32_16x16x32_bf16 v[132:135], v[236:239], v[36:39], v[132:135]
    ds_read_b64_tr_b16 v[230:231], v5 offset:1056
    s_waitcnt lgkmcnt(6)
    v_mfma_f32_16x16x32_bf16 v[136:139], v[240:243], v[32:35], v[136:139]
    ds_read_b64_tr_b16 v[232:233], v4 offset:256
    v_mfma_f32_16x16x32_bf16 v[140:143], v[240:243], v[36:39], v[140:143]
    s_add_u32 s22, s24, 0x22000
    s_add_u32 m0, s20, 0x20400
    s_nop 0
    buffer_load_dwordx4 v3, s[4:7], s22 offen lds
    ds_read_b64_tr_b16 v[234:235], v4 offset:1280
    s_waitcnt lgkmcnt(6)
    v_mfma_f32_16x16x32_bf16 v[144:147], v[244:247], v[32:35], v[144:147]
    ds_read_b64_tr_b16 v[236:237], v5 offset:288
    v_mfma_f32_16x16x32_bf16 v[148:151], v[244:247], v[36:39], v[148:151]
    ds_read_b64_tr_b16 v[238:239], v5 offset:1312
    s_waitcnt vmcnt(6)
    v_cmp_ne_u32 vcc, s28, v12
    s_cbranch_vccnz adaLN_cond__sliding_block_cached__moe_arch_mod__prompt_kernel_o28r
adaLN_cond__sliding_block_cached__moe_arch_mod__prompt_kernel_o28b:
    s_waitcnt lgkmcnt(6)
    v_mfma_f32_16x16x32_bf16 v[88:91], v[224:227], v[40:43], v[88:91]
    ds_read_b64_tr_b16 v[240:241], v4 offset:512
    v_mfma_f32_16x16x32_bf16 v[92:95], v[224:227], v[44:47], v[92:95]
    ds_read_b64_tr_b16 v[242:243], v4 offset:1536
    s_waitcnt lgkmcnt(6)
    v_mfma_f32_16x16x32_bf16 v[96:99], v[228:231], v[40:43], v[96:99]
    ds_read_b64_tr_b16 v[244:245], v5 offset:544
    s_mov_b32 s23, 0x0
    buffer_load_dwordx4 v[32:35], v6, s[8:11], s23 offen offset:2048 sc1
    v_mfma_f32_16x16x32_bf16 v[100:103], v[228:231], v[44:47], v[100:103]
    ds_read_b64_tr_b16 v[246:247], v5 offset:1568
    s_waitcnt lgkmcnt(6)
    v_mfma_f32_16x16x32_bf16 v[104:107], v[232:235], v[40:43], v[104:107]
    ds_read_b64_tr_b16 v[224:225], v4 offset:768
    v_mfma_f32_16x16x32_bf16 v[108:111], v[232:235], v[44:47], v[108:111]
    ds_read_b64_tr_b16 v[226:227], v4 offset:1792
    s_mov_b32 s23, 0x20000
    buffer_load_dwordx4 v[36:39], v6, s[8:11], s23 offen offset:2048 sc1
    s_waitcnt lgkmcnt(6)
    v_mfma_f32_16x16x32_bf16 v[112:115], v[236:239], v[40:43], v[112:115]
    ds_read_b64_tr_b16 v[228:229], v5 offset:800
    v_mfma_f32_16x16x32_bf16 v[116:119], v[236:239], v[44:47], v[116:119]
    ds_read_b64_tr_b16 v[230:231], v5 offset:1824
    s_waitcnt lgkmcnt(6)
    v_mfma_f32_16x16x32_bf16 v[120:123], v[240:243], v[40:43], v[120:123]
    v_mfma_f32_16x16x32_bf16 v[124:127], v[240:243], v[44:47], v[124:127]
    s_barrier
    ds_read_b64_tr_b16 v[232:233], v4 offset:16384
    ds_read_b64_tr_b16 v[234:235], v4 offset:17408
    s_waitcnt lgkmcnt(6)
    v_mfma_f32_16x16x32_bf16 v[128:131], v[244:247], v[40:43], v[128:131]
    s_add_u32 s22, s24, 0xa0000
    s_add_u32 m0, s20, 0x24000
    s_nop 0
    buffer_load_dwordx4 v3, s[4:7], s22 offen lds
    ds_read_b64_tr_b16 v[236:237], v5 offset:16416
    v_mfma_f32_16x16x32_bf16 v[132:135], v[244:247], v[44:47], v[132:135]
    ds_read_b64_tr_b16 v[238:239], v5 offset:17440
    s_waitcnt lgkmcnt(6)
    v_mfma_f32_16x16x32_bf16 v[136:139], v[224:227], v[40:43], v[136:139]
    ds_read_b64_tr_b16 v[240:241], v4 offset:16640
    v_mfma_f32_16x16x32_bf16 v[140:143], v[224:227], v[44:47], v[140:143]
    s_add_u32 s22, s24, 0xa2000
    s_add_u32 m0, s20, 0x24400
    s_nop 0
    buffer_load_dwordx4 v3, s[4:7], s22 offen lds
    ds_read_b64_tr_b16 v[242:243], v4 offset:17664
    s_waitcnt lgkmcnt(6)
    v_mfma_f32_16x16x32_bf16 v[144:147], v[228:231], v[40:43], v[144:147]
    ds_read_b64_tr_b16 v[244:245], v5 offset:16672
    v_mfma_f32_16x16x32_bf16 v[148:151], v[228:231], v[44:47], v[148:151]
    ds_read_b64_tr_b16 v[246:247], v5 offset:17696
    s_waitcnt lgkmcnt(6)
    v_mfma_f32_16x16x32_bf16 v[88:91], v[232:235], v[48:51], v[88:91]
    ds_read_b64_tr_b16 v[224:225], v4 offset:16896
    v_mfma_f32_16x16x32_bf16 v[92:95], v[232:235], v[52:55], v[92:95]
    ds_read_b64_tr_b16 v[226:227], v4 offset:17920
    s_waitcnt lgkmcnt(6)
    v_mfma_f32_16x16x32_bf16 v[96:99], v[236:239], v[48:51], v[96:99]
    ds_read_b64_tr_b16 v[228:229], v5 offset:16928
    s_mov_b32 s23, 0x2000
    buffer_load_dwordx4 v[40:43], v6, s[8:11], s23 offen offset:2048 sc1
    v_mfma_f32_16x16x32_bf16 v[100:103], v[236:239], v[52:55], v[100:103]
    ds_read_b64_tr_b16 v[230:231], v5 offset:17952
    s_waitcnt lgkmcnt(6)
    v_mfma_f32_16x16x32_bf16 v[104:107], v[240:243], v[48:51], v[104:107]
    ds_read_b64_tr_b16 v[232:233], v4 offset:17152
    v_mfma_f32_16x16x32_bf16 v[108:111], v[240:243], v[52:55], v[108:111]
    ds_read_b64_tr_b16 v[234:235], v4 offset:18176
    s_mov_b32 s23, 0x22000
    buffer_load_dwordx4 v[44:47], v6, s[8:11], s23 offen offset:2048 sc1
    s_waitcnt lgkmcnt(6)
    v_mfma_f32_16x16x32_bf16 v[112:115], v[244:247], v[48:51], v[112:115]
    ds_read_b64_tr_b16 v[236:237], v5 offset:17184
    v_mfma_f32_16x16x32_bf16 v[116:119], v[244:247], v[52:55], v[116:119]
    ds_read_b64_tr_b16 v[238:239], v5 offset:18208
    s_waitcnt lgkmcnt(6)
    v_mfma_f32_16x16x32_bf16 v[120:123], v[224:227], v[48:51], v[120:123]
    v_mfma_f32_16x16x32_bf16 v[124:127], v[224:227], v[52:55], v[124:127]
    s_barrier
    ds_read_b64_tr_b16 v[240:241], v4 offset:32768
    ds_read_b64_tr_b16 v[242:243], v4 offset:33792
    s_waitcnt lgkmcnt(6)
    v_mfma_f32_16x16x32_bf16 v[128:131], v[228:231], v[48:51], v[128:131]
    s_add_u32 s22, s24, 0x120000
    s_add_u32 m0, s20, 0x10000
    s_nop 0
    buffer_load_dwordx4 v3, s[4:7], s22 offen lds
    ds_read_b64_tr_b16 v[244:245], v5 offset:32800
    v_mfma_f32_16x16x32_bf16 v[132:135], v[228:231], v[52:55], v[132:135]
    ds_read_b64_tr_b16 v[246:247], v5 offset:33824
    s_waitcnt lgkmcnt(6)
    v_mfma_f32_16x16x32_bf16 v[136:139], v[232:235], v[48:51], v[136:139]
    ds_read_b64_tr_b16 v[224:225], v4 offset:33024
    v_mfma_f32_16x16x32_bf16 v[140:143], v[232:235], v[52:55], v[140:143]
    s_add_u32 s22, s24, 0x122000
    s_add_u32 m0, s20, 0x10400
    s_nop 0
    buffer_load_dwordx4 v3, s[4:7], s22 offen lds
    ds_read_b64_tr_b16 v[226:227], v4 offset:34048
    s_waitcnt lgkmcnt(6)
    v_mfma_f32_16x16x32_bf16 v[144:147], v[236:239], v[48:51], v[144:147]
    ds_read_b64_tr_b16 v[228:229], v5 offset:33056
    v_mfma_f32_16x16x32_bf16 v[148:151], v[236:239], v[52:55], v[148:151]
    ds_read_b64_tr_b16 v[230:231], v5 offset:34080
    s_waitcnt lgkmcnt(6)
    v_mfma_f32_16x16x32_bf16 v[88:91], v[240:243], v[56:59], v[88:91]
    ds_read_b64_tr_b16 v[232:233], v4 offset:33280
    v_mfma_f32_16x16x32_bf16 v[92:95], v[240:243], v[60:63], v[92:95]
    ds_read_b64_tr_b16 v[234:235], v4 offset:34304
    s_waitcnt lgkmcnt(6)
    v_mfma_f32_16x16x32_bf16 v[96:99], v[244:247], v[56:59], v[96:99]
    ds_read_b64_tr_b16 v[236:237], v5 offset:33312
    s_mov_b32 s23, 0x4000
    buffer_load_dwordx4 v[48:51], v6, s[8:11], s23 offen offset:2048 sc1
    v_mfma_f32_16x16x32_bf16 v[100:103], v[244:247], v[60:63], v[100:103]
    ds_read_b64_tr_b16 v[238:239], v5 offset:34336
    s_waitcnt lgkmcnt(6)
    v_mfma_f32_16x16x32_bf16 v[104:107], v[224:227], v[56:59], v[104:107]
    ds_read_b64_tr_b16 v[240:241], v4 offset:33536
    v_mfma_f32_16x16x32_bf16 v[108:111], v[224:227], v[60:63], v[108:111]
    ds_read_b64_tr_b16 v[242:243], v4 offset:34560
    s_mov_b32 s23, 0x24000
    buffer_load_dwordx4 v[52:55], v6, s[8:11], s23 offen offset:2048 sc1
    s_waitcnt lgkmcnt(6)
    v_mfma_f32_16x16x32_bf16 v[112:115], v[228:231], v[56:59], v[112:115]
    ds_read_b64_tr_b16 v[244:245], v5 offset:33568
    v_mfma_f32_16x16x32_bf16 v[116:119], v[228:231], v[60:63], v[116:119]
    ds_read_b64_tr_b16 v[246:247], v5 offset:34592
    s_waitcnt lgkmcnt(6)
    v_mfma_f32_16x16x32_bf16 v[120:123], v[232:235], v[56:59], v[120:123]
    v_mfma_f32_16x16x32_bf16 v[124:127], v[232:235], v[60:63], v[124:127]
    s_waitcnt vmcnt(14)
    s_barrier
    ds_read_b64_tr_b16 v[224:225], v4 offset:49152
    ds_read_b64_tr_b16 v[226:227], v4 offset:50176
    s_waitcnt lgkmcnt(6)
    v_mfma_f32_16x16x32_bf16 v[128:131], v[236:239], v[56:59], v[128:131]
    s_add_u32 s22, s24, 0x1a0000
    s_add_u32 m0, s20, 0x14000
    s_nop 0
    buffer_load_dwordx4 v3, s[4:7], s22 offen lds
    ds_read_b64_tr_b16 v[228:229], v5 offset:49184
    v_mfma_f32_16x16x32_bf16 v[132:135], v[236:239], v[60:63], v[132:135]
    ds_read_b64_tr_b16 v[230:231], v5 offset:50208
    s_waitcnt lgkmcnt(6)
    v_mfma_f32_16x16x32_bf16 v[136:139], v[240:243], v[56:59], v[136:139]
    ds_read_b64_tr_b16 v[232:233], v4 offset:49408
    v_mfma_f32_16x16x32_bf16 v[140:143], v[240:243], v[60:63], v[140:143]
    s_add_u32 s22, s24, 0x1a2000
    s_add_u32 m0, s20, 0x14400
    s_nop 0
    buffer_load_dwordx4 v3, s[4:7], s22 offen lds
    ds_read_b64_tr_b16 v[234:235], v4 offset:50432
    s_waitcnt lgkmcnt(6)
    v_mfma_f32_16x16x32_bf16 v[144:147], v[244:247], v[56:59], v[144:147]
    ds_read_b64_tr_b16 v[236:237], v5 offset:49440
    v_mfma_f32_16x16x32_bf16 v[148:151], v[244:247], v[60:63], v[148:151]
    ds_read_b64_tr_b16 v[238:239], v5 offset:50464
    s_waitcnt vmcnt(15) lgkmcnt(6)
    v_mfma_f32_16x16x32_bf16 v[88:91], v[224:227], v[24:27], v[88:91]
    ds_read_b64_tr_b16 v[240:241], v4 offset:49664
    s_waitcnt vmcnt(14)
    v_mfma_f32_16x16x32_bf16 v[92:95], v[224:227], v[28:31], v[92:95]
    ds_read_b64_tr_b16 v[242:243], v4 offset:50688
    s_waitcnt lgkmcnt(6)
    v_mfma_f32_16x16x32_bf16 v[96:99], v[228:231], v[24:27], v[96:99]
    ds_read_b64_tr_b16 v[244:245], v5 offset:49696
    s_mov_b32 s23, 0x6000
    buffer_load_dwordx4 v[56:59], v6, s[8:11], s23 offen offset:2048 sc1
    v_mfma_f32_16x16x32_bf16 v[100:103], v[228:231], v[28:31], v[100:103]
    ds_read_b64_tr_b16 v[246:247], v5 offset:50720
    s_waitcnt lgkmcnt(6)
    v_mfma_f32_16x16x32_bf16 v[104:107], v[232:235], v[24:27], v[104:107]
    ds_read_b64_tr_b16 v[224:225], v4 offset:49920
    v_mfma_f32_16x16x32_bf16 v[108:111], v[232:235], v[28:31], v[108:111]
    ds_read_b64_tr_b16 v[226:227], v4 offset:50944
    s_mov_b32 s23, 0x26000
    buffer_load_dwordx4 v[60:63], v6, s[8:11], s23 offen offset:2048 sc1
    s_waitcnt lgkmcnt(6)
    v_mfma_f32_16x16x32_bf16 v[112:115], v[236:239], v[24:27], v[112:115]
    ds_read_b64_tr_b16 v[228:229], v5 offset:49952
    v_mfma_f32_16x16x32_bf16 v[116:119], v[236:239], v[28:31], v[116:119]
    ds_read_b64_tr_b16 v[230:231], v5 offset:50976
    s_waitcnt lgkmcnt(6)
    v_mfma_f32_16x16x32_bf16 v[120:123], v[240:243], v[24:27], v[120:123]
    v_mfma_f32_16x16x32_bf16 v[124:127], v[240:243], v[28:31], v[124:127]
    s_waitcnt vmcnt(14)
    s_barrier
    ds_read_b64_tr_b16 v[232:233], v7 offset:0
    ds_read_b64_tr_b16 v[234:235], v7 offset:1024
    s_waitcnt lgkmcnt(6)
    v_mfma_f32_16x16x32_bf16 v[128:131], v[244:247], v[24:27], v[128:131]
    s_add_u32 s22, s24, 0x220000
    s_add_u32 m0, s20, 0x18000
    s_nop 0
    buffer_load_dwordx4 v3, s[4:7], s22 offen lds
    ds_read_b64_tr_b16 v[236:237], v8 offset:32
    v_mfma_f32_16x16x32_bf16 v[132:135], v[244:247], v[28:31], v[132:135]
    ds_read_b64_tr_b16 v[238:239], v8 offset:1056
    s_waitcnt lgkmcnt(6)
    v_mfma_f32_16x16x32_bf16 v[136:139], v[224:227], v[24:27], v[136:139]
    ds_read_b64_tr_b16 v[240:241], v7 offset:256
    v_mfma_f32_16x16x32_bf16 v[140:143], v[224:227], v[28:31], v[140:143]
    s_add_u32 s22, s24, 0x222000
    s_add_u32 m0, s20, 0x18400
    s_nop 0
    buffer_load_dwordx4 v3, s[4:7], s22 offen lds
    ds_read_b64_tr_b16 v[242:243], v7 offset:1280
    s_waitcnt lgkmcnt(6)
    v_mfma_f32_16x16x32_bf16 v[144:147], v[228:231], v[24:27], v[144:147]
    ds_read_b64_tr_b16 v[244:245], v8 offset:288
    v_mfma_f32_16x16x32_bf16 v[148:151], v[228:231], v[28:31], v[148:151]
    ds_read_b64_tr_b16 v[246:247], v8 offset:1312
    s_waitcnt vmcnt(15) lgkmcnt(6)
    v_mfma_f32_16x16x32_bf16 v[88:91], v[232:235], v[32:35], v[88:91]
    ds_read_b64_tr_b16 v[224:225], v7 offset:512
    s_waitcnt vmcnt(14)
    v_mfma_f32_16x16x32_bf16 v[92:95], v[232:235], v[36:39], v[92:95]
    ds_read_b64_tr_b16 v[226:227], v7 offset:1536
    s_waitcnt lgkmcnt(6)
    v_mfma_f32_16x16x32_bf16 v[96:99], v[236:239], v[32:35], v[96:99]
    ds_read_b64_tr_b16 v[228:229], v8 offset:544
    s_mov_b32 s23, 0x8000
    buffer_load_dwordx4 v[24:27], v6, s[8:11], s23 offen offset:2048 sc1
    v_mfma_f32_16x16x32_bf16 v[100:103], v[236:239], v[36:39], v[100:103]
    ds_read_b64_tr_b16 v[230:231], v8 offset:1568
    s_waitcnt lgkmcnt(6)
    v_mfma_f32_16x16x32_bf16 v[104:107], v[240:243], v[32:35], v[104:107]
    ds_read_b64_tr_b16 v[232:233], v7 offset:768
    v_mfma_f32_16x16x32_bf16 v[108:111], v[240:243], v[36:39], v[108:111]
    ds_read_b64_tr_b16 v[234:235], v7 offset:1792
    s_mov_b32 s23, 0x28000
    buffer_load_dwordx4 v[28:31], v6, s[8:11], s23 offen offset:2048 sc1
    s_mov_b32 s16, 0x544000
    buffer_load_dwordx4 v[184:187], v2, s[8:11], s16 offen sc1
    s_waitcnt lgkmcnt(6)
    v_mfma_f32_16x16x32_bf16 v[112:115], v[244:247], v[32:35], v[112:115]
    ds_read_b64_tr_b16 v[236:237], v8 offset:800
    v_mfma_f32_16x16x32_bf16 v[116:119], v[244:247], v[36:39], v[116:119]
    ds_read_b64_tr_b16 v[238:239], v8 offset:1824
    s_waitcnt lgkmcnt(6)
    v_mfma_f32_16x16x32_bf16 v[120:123], v[224:227], v[32:35], v[120:123]
    v_mfma_f32_16x16x32_bf16 v[124:127], v[224:227], v[36:39], v[124:127]
    s_waitcnt vmcnt(15)
    s_barrier
    ds_read_b64_tr_b16 v[240:241], v7 offset:16384
    ds_read_b64_tr_b16 v[242:243], v7 offset:17408
    s_waitcnt lgkmcnt(6)
    v_mfma_f32_16x16x32_bf16 v[128:131], v[228:231], v[32:35], v[128:131]
    s_add_u32 s22, s24, 0x2a0000
    s_add_u32 m0, s20, 0x1c000
    s_nop 0
    buffer_load_dwordx4 v3, s[4:7], s22 offen lds
    ds_read_b64_tr_b16 v[244:245], v8 offset:16416
    v_mfma_f32_16x16x32_bf16 v[132:135], v[228:231], v[36:39], v[132:135]
    ds_read_b64_tr_b16 v[246:247], v8 offset:17440
    s_waitcnt lgkmcnt(6)
    v_mfma_f32_16x16x32_bf16 v[136:139], v[232:235], v[32:35], v[136:139]
    ds_read_b64_tr_b16 v[224:225], v7 offset:16640
    v_mfma_f32_16x16x32_bf16 v[140:143], v[232:235], v[36:39], v[140:143]
    s_add_u32 s22, s24, 0x2a2000
    s_add_u32 m0, s20, 0x1c400
    s_nop 0
    buffer_load_dwordx4 v3, s[4:7], s22 offen lds
    ds_read_b64_tr_b16 v[226:227], v7 offset:17664
    s_waitcnt lgkmcnt(6)
    v_mfma_f32_16x16x32_bf16 v[144:147], v[236:239], v[32:35], v[144:147]
    ds_read_b64_tr_b16 v[228:229], v8 offset:16672
    v_mfma_f32_16x16x32_bf16 v[148:151], v[236:239], v[36:39], v[148:151]
    ds_read_b64_tr_b16 v[230:231], v8 offset:17696
    s_waitcnt vmcnt(16) lgkmcnt(6)
    v_mfma_f32_16x16x32_bf16 v[88:91], v[240:243], v[40:43], v[88:91]
    ds_read_b64_tr_b16 v[232:233], v7 offset:16896
    s_waitcnt vmcnt(15)
    v_mfma_f32_16x16x32_bf16 v[92:95], v[240:243], v[44:47], v[92:95]
    ds_read_b64_tr_b16 v[234:235], v7 offset:17920
    s_waitcnt lgkmcnt(6)
    v_mfma_f32_16x16x32_bf16 v[96:99], v[244:247], v[40:43], v[96:99]
    ds_read_b64_tr_b16 v[236:237], v8 offset:16928
    s_mov_b32 s23, 0xa000
    buffer_load_dwordx4 v[32:35], v6, s[8:11], s23 offen offset:2048 sc1
    v_mfma_f32_16x16x32_bf16 v[100:103], v[244:247], v[44:47], v[100:103]
    ds_read_b64_tr_b16 v[238:239], v8 offset:17952
    s_waitcnt lgkmcnt(6)
    v_mfma_f32_16x16x32_bf16 v[104:107], v[224:227], v[40:43], v[104:107]
    ds_read_b64_tr_b16 v[240:241], v7 offset:17152
    v_mfma_f32_16x16x32_bf16 v[108:111], v[224:227], v[44:47], v[108:111]
    ds_read_b64_tr_b16 v[242:243], v7 offset:18176
    s_mov_b32 s23, 0x2a000
    buffer_load_dwordx4 v[36:39], v6, s[8:11], s23 offen offset:2048 sc1
    s_waitcnt lgkmcnt(6)
    v_mfma_f32_16x16x32_bf16 v[112:115], v[228:231], v[40:43], v[112:115]
    ds_read_b64_tr_b16 v[244:245], v8 offset:17184
    v_mfma_f32_16x16x32_bf16 v[116:119], v[228:231], v[44:47], v[116:119]
    ds_read_b64_tr_b16 v[246:247], v8 offset:18208
    s_waitcnt lgkmcnt(6)
    v_mfma_f32_16x16x32_bf16 v[120:123], v[232:235], v[40:43], v[120:123]
    v_mfma_f32_16x16x32_bf16 v[124:127], v[232:235], v[44:47], v[124:127]
    s_waitcnt vmcnt(15)
    s_barrier
    ds_read_b64_tr_b16 v[224:225], v4 offset:0
    ds_read_b64_tr_b16 v[226:227], v4 offset:1024
    s_waitcnt lgkmcnt(6)
    v_mfma_f32_16x16x32_bf16 v[128:131], v[236:239], v[40:43], v[128:131]
    s_add_u32 s22, s24, 0x320000
    s_add_u32 m0, s20, 0x20000
    s_nop 0
    buffer_load_dwordx4 v3, s[4:7], s22 offen lds
    ds_read_b64_tr_b16 v[228:229], v5 offset:32
    v_mfma_f32_16x16x32_bf16 v[132:135], v[236:239], v[44:47], v[132:135]
    ds_read_b64_tr_b16 v[230:231], v5 offset:1056
    s_waitcnt lgkmcnt(6)
    v_mfma_f32_16x16x32_bf16 v[136:139], v[240:243], v[40:43], v[136:139]
    ds_read_b64_tr_b16 v[232:233], v4 offset:256
    v_mfma_f32_16x16x32_bf16 v[140:143], v[240:243], v[44:47], v[140:143]
    s_add_u32 s22, s24, 0x322000
    s_add_u32 m0, s20, 0x20400
    s_nop 0
    buffer_load_dwordx4 v3, s[4:7], s22 offen lds
    ds_read_b64_tr_b16 v[234:235], v4 offset:1280
    s_waitcnt lgkmcnt(6)
    v_mfma_f32_16x16x32_bf16 v[144:147], v[244:247], v[40:43], v[144:147]
    ds_read_b64_tr_b16 v[236:237], v5 offset:288
    v_mfma_f32_16x16x32_bf16 v[148:151], v[244:247], v[44:47], v[148:151]
    ds_read_b64_tr_b16 v[238:239], v5 offset:1312
    s_waitcnt vmcnt(16) lgkmcnt(6)
    v_mfma_f32_16x16x32_bf16 v[88:91], v[224:227], v[48:51], v[88:91]
    ds_read_b64_tr_b16 v[240:241], v4 offset:512
    s_waitcnt vmcnt(15)
    v_mfma_f32_16x16x32_bf16 v[92:95], v[224:227], v[52:55], v[92:95]
    ds_read_b64_tr_b16 v[242:243], v4 offset:1536
    s_waitcnt lgkmcnt(6)
    v_mfma_f32_16x16x32_bf16 v[96:99], v[228:231], v[48:51], v[96:99]
    ds_read_b64_tr_b16 v[244:245], v5 offset:544
    s_mov_b32 s23, 0xc000
    buffer_load_dwordx4 v[40:43], v6, s[8:11], s23 offen offset:2048 sc1
    v_mfma_f32_16x16x32_bf16 v[100:103], v[228:231], v[52:55], v[100:103]
    ds_read_b64_tr_b16 v[246:247], v5 offset:1568
    s_waitcnt lgkmcnt(6)
    v_mfma_f32_16x16x32_bf16 v[104:107], v[232:235], v[48:51], v[104:107]
    ds_read_b64_tr_b16 v[224:225], v4 offset:768
    v_mfma_f32_16x16x32_bf16 v[108:111], v[232:235], v[52:55], v[108:111]
    ds_read_b64_tr_b16 v[226:227], v4 offset:1792
    s_mov_b32 s23, 0x2c000
    buffer_load_dwordx4 v[44:47], v6, s[8:11], s23 offen offset:2048 sc1
    s_waitcnt lgkmcnt(6)
    v_mfma_f32_16x16x32_bf16 v[112:115], v[236:239], v[48:51], v[112:115]
    ds_read_b64_tr_b16 v[228:229], v5 offset:800
    v_mfma_f32_16x16x32_bf16 v[116:119], v[236:239], v[52:55], v[116:119]
    ds_read_b64_tr_b16 v[230:231], v5 offset:1824
    s_waitcnt lgkmcnt(6)
    v_mfma_f32_16x16x32_bf16 v[120:123], v[240:243], v[48:51], v[120:123]
    v_mfma_f32_16x16x32_bf16 v[124:127], v[240:243], v[52:55], v[124:127]
    s_waitcnt vmcnt(15)
    s_barrier
    ds_read_b64_tr_b16 v[232:233], v4 offset:16384
    ds_read_b64_tr_b16 v[234:235], v4 offset:17408
    s_add_u32 s19, s19, 8192
    buffer_load_dword v12, v13, s[8:11], s19 offen sc1
    s_waitcnt lgkmcnt(6)
    v_mfma_f32_16x16x32_bf16 v[128:131], v[244:247], v[48:51], v[128:131]
    s_add_u32 s22, s24, 0x3a0000
    s_add_u32 m0, s20, 0x24000
    s_nop 0
    buffer_load_dwordx4 v3, s[4:7], s22 offen lds
    ds_read_b64_tr_b16 v[236:237], v5 offset:16416
    v_mfma_f32_16x16x32_bf16 v[132:135], v[244:247], v[52:55], v[132:135]
    ds_read_b64_tr_b16 v[238:239], v5 offset:17440
    s_waitcnt lgkmcnt(6)
    v_mfma_f32_16x16x32_bf16 v[136:139], v[224:227], v[48:51], v[136:139]
    ds_read_b64_tr_b16 v[240:241], v4 offset:16640
    v_mfma_f32_16x16x32_bf16 v[140:143], v[224:227], v[52:55], v[140:143]
    s_add_u32 s22, s24, 0x3a2000
    s_add_u32 m0, s20, 0x24400
    s_nop 0
    buffer_load_dwordx4 v3, s[4:7], s22 offen lds
    ds_read_b64_tr_b16 v[242:243], v4 offset:17664
    s_waitcnt lgkmcnt(6)
    v_mfma_f32_16x16x32_bf16 v[144:147], v[228:231], v[48:51], v[144:147]
    ds_read_b64_tr_b16 v[244:245], v5 offset:16672
    v_mfma_f32_16x16x32_bf16 v[148:151], v[228:231], v[52:55], v[148:151]
    ds_read_b64_tr_b16 v[246:247], v5 offset:17696
    s_waitcnt vmcnt(17) lgkmcnt(6)
    v_mfma_f32_16x16x32_bf16 v[88:91], v[232:235], v[56:59], v[88:91]
    ds_read_b64_tr_b16 v[224:225], v4 offset:16896
    s_waitcnt vmcnt(16)
    v_mfma_f32_16x16x32_bf16 v[92:95], v[232:235], v[60:63], v[92:95]
    ds_read_b64_tr_b16 v[226:227], v4 offset:17920
    s_waitcnt lgkmcnt(6)
    v_mfma_f32_16x16x32_bf16 v[96:99], v[236:239], v[56:59], v[96:99]
    ds_read_b64_tr_b16 v[228:229], v5 offset:16928
    s_mov_b32 s23, 0xe000
    buffer_load_dwordx4 v[48:51], v6, s[8:11], s23 offen offset:2048 sc1
    v_mfma_f32_16x16x32_bf16 v[100:103], v[236:239], v[60:63], v[100:103]
    ds_read_b64_tr_b16 v[230:231], v5 offset:17952
    s_waitcnt lgkmcnt(6)
    v_mfma_f32_16x16x32_bf16 v[104:107], v[240:243], v[56:59], v[104:107]
    ds_read_b64_tr_b16 v[232:233], v4 offset:17152
    v_mfma_f32_16x16x32_bf16 v[108:111], v[240:243], v[60:63], v[108:111]
    ds_read_b64_tr_b16 v[234:235], v4 offset:18176
    s_mov_b32 s23, 0x2e000
    buffer_load_dwordx4 v[52:55], v6, s[8:11], s23 offen offset:2048 sc1
    s_waitcnt lgkmcnt(6)
    v_mfma_f32_16x16x32_bf16 v[112:115], v[244:247], v[56:59], v[112:115]
    ds_read_b64_tr_b16 v[236:237], v5 offset:17184
    v_mfma_f32_16x16x32_bf16 v[116:119], v[244:247], v[60:63], v[116:119]
    ds_read_b64_tr_b16 v[238:239], v5 offset:18208
    s_waitcnt lgkmcnt(6)
    v_mfma_f32_16x16x32_bf16 v[120:123], v[224:227], v[56:59], v[120:123]
    v_mfma_f32_16x16x32_bf16 v[124:127], v[224:227], v[60:63], v[124:127]
    s_waitcnt vmcnt(16)
    s_barrier
    ds_read_b64_tr_b16 v[240:241], v4 offset:32768
    ds_read_b64_tr_b16 v[242:243], v4 offset:33792
    s_waitcnt lgkmcnt(6)
    v_mfma_f32_16x16x32_bf16 v[128:131], v[228:231], v[56:59], v[128:131]
    s_add_u32 s22, s24, 0x30000
    s_add_u32 m0, s20, 0x10000
    s_nop 0
    buffer_load_dwordx4 v3, s[4:7], s22 offen lds
    ds_read_b64_tr_b16 v[244:245], v5 offset:32800
    v_mfma_f32_16x16x32_bf16 v[132:135], v[228:231], v[60:63], v[132:135]
    ds_read_b64_tr_b16 v[246:247], v5 offset:33824
    s_waitcnt lgkmcnt(6)
    v_mfma_f32_16x16x32_bf16 v[136:139], v[232:235], v[56:59], v[136:139]
    ds_read_b64_tr_b16 v[224:225], v4 offset:33024
    v_mfma_f32_16x16x32_bf16 v[140:143], v[232:235], v[60:63], v[140:143]
    s_add_u32 s22, s24, 0x32000
    s_add_u32 m0, s20, 0x10400
    s_nop 0
    buffer_load_dwordx4 v3, s[4:7], s22 offen lds
    ds_read_b64_tr_b16 v[226:227], v4 offset:34048
    s_waitcnt lgkmcnt(6)
    v_mfma_f32_16x16x32_bf16 v[144:147], v[236:239], v[56:59], v[144:147]
    ds_read_b64_tr_b16 v[228:229], v5 offset:33056
    v_mfma_f32_16x16x32_bf16 v[148:151], v[236:239], v[60:63], v[148:151]
    ds_read_b64_tr_b16 v[230:231], v5 offset:34080
    s_waitcnt vmcnt(6)
    v_cmp_ne_u32 vcc, s28, v12
    s_cbranch_vccnz adaLN_cond__sliding_block_cached__moe_arch_mod__prompt_kernel_o29r
adaLN_cond__sliding_block_cached__moe_arch_mod__prompt_kernel_o29b:
    s_waitcnt lgkmcnt(6)
    v_mfma_f32_16x16x32_bf16 v[88:91], v[240:243], v[24:27], v[88:91]
    ds_read_b64_tr_b16 v[232:233], v4 offset:33280
    v_mfma_f32_16x16x32_bf16 v[92:95], v[240:243], v[28:31], v[92:95]
    ds_read_b64_tr_b16 v[234:235], v4 offset:34304
    s_waitcnt lgkmcnt(6)
    v_mfma_f32_16x16x32_bf16 v[96:99], v[244:247], v[24:27], v[96:99]
    ds_read_b64_tr_b16 v[236:237], v5 offset:33312
    s_mov_b32 s23, 0x0
    buffer_load_dwordx4 v[56:59], v6, s[8:11], s23 offen offset:3072 sc1
    v_mfma_f32_16x16x32_bf16 v[100:103], v[244:247], v[28:31], v[100:103]
    ds_read_b64_tr_b16 v[238:239], v5 offset:34336
    s_waitcnt lgkmcnt(6)
    v_mfma_f32_16x16x32_bf16 v[104:107], v[224:227], v[24:27], v[104:107]
    ds_read_b64_tr_b16 v[240:241], v4 offset:33536
    v_mfma_f32_16x16x32_bf16 v[108:111], v[224:227], v[28:31], v[108:111]
    ds_read_b64_tr_b16 v[242:243], v4 offset:34560
    s_mov_b32 s23, 0x20000
    buffer_load_dwordx4 v[60:63], v6, s[8:11], s23 offen offset:3072 sc1
    v_xor_b32 v16, s28, v184
    v_xor_b32 v17, s28, v185
    v_xor_b32 v18, s28, v186
    v_xor_b32 v19, s28, v187
    v_or3_b32 v16, v16, v17, v18
    v_or_b32 v16, v16, v19
    v_cmp_ne_u32 vcc, 0, v16
    s_cbranch_vccnz adaLN_cond__sliding_block_cached__moe_arch_mod__prompt_kernel_mf10r
adaLN_cond__sliding_block_cached__moe_arch_mod__prompt_kernel_mf10b:
    s_waitcnt lgkmcnt(6)
    v_mfma_f32_16x16x32_bf16 v[112:115], v[228:231], v[24:27], v[112:115]
    ds_read_b64_tr_b16 v[244:245], v5 offset:33568
    v_mfma_f32_16x16x32_bf16 v[116:119], v[228:231], v[28:31], v[116:119]
    ds_read_b64_tr_b16 v[246:247], v5 offset:34592
    s_waitcnt lgkmcnt(6)
    v_mfma_f32_16x16x32_bf16 v[120:123], v[232:235], v[24:27], v[120:123]
    v_mfma_f32_16x16x32_bf16 v[124:127], v[232:235], v[28:31], v[124:127]
    s_barrier
    ds_read_b64_tr_b16 v[224:225], v4 offset:49152
    ds_read_b64_tr_b16 v[226:227], v4 offset:50176
    s_waitcnt lgkmcnt(6)
    v_mfma_f32_16x16x32_bf16 v[128:131], v[236:239], v[24:27], v[128:131]
    s_add_u32 s22, s24, 0xb0000
    s_add_u32 m0, s20, 0x14000
    s_nop 0
    buffer_load_dwordx4 v3, s[4:7], s22 offen lds
    ds_read_b64_tr_b16 v[228:229], v5 offset:49184
    v_mfma_f32_16x16x32_bf16 v[132:135], v[236:239], v[28:31], v[132:135]
    ds_read_b64_tr_b16 v[230:231], v5 offset:50208
    s_waitcnt lgkmcnt(6)
    v_mfma_f32_16x16x32_bf16 v[136:139], v[240:243], v[24:27], v[136:139]
    ds_read_b64_tr_b16 v[232:233], v4 offset:49408
    v_mfma_f32_16x16x32_bf16 v[140:143], v[240:243], v[28:31], v[140:143]
    s_add_u32 s22, s24, 0xb2000
    s_add_u32 m0, s20, 0x14400
    s_nop 0
    buffer_load_dwordx4 v3, s[4:7], s22 offen lds
    ds_read_b64_tr_b16 v[234:235], v4 offset:50432
    s_waitcnt lgkmcnt(6)
    v_mfma_f32_16x16x32_bf16 v[144:147], v[244:247], v[24:27], v[144:147]
    ds_read_b64_tr_b16 v[236:237], v5 offset:49440
    v_mfma_f32_16x16x32_bf16 v[148:151], v[244:247], v[28:31], v[148:151]
    ds_read_b64_tr_b16 v[238:239], v5 offset:50464
    s_waitcnt lgkmcnt(6)
    v_mfma_f32_16x16x32_bf16 v[88:91], v[224:227], v[32:35], v[88:91]
    ds_read_b64_tr_b16 v[240:241], v4 offset:49664
    v_mfma_f32_16x16x32_bf16 v[92:95], v[224:227], v[36:39], v[92:95]
    ds_read_b64_tr_b16 v[242:243], v4 offset:50688
    s_waitcnt lgkmcnt(6)
    v_mfma_f32_16x16x32_bf16 v[96:99], v[228:231], v[32:35], v[96:99]
    ds_read_b64_tr_b16 v[244:245], v5 offset:49696
    s_mov_b32 s23, 0x2000
    buffer_load_dwordx4 v[24:27], v6, s[8:11], s23 offen offset:3072 sc1
    v_mfma_f32_16x16x32_bf16 v[100:103], v[228:231], v[36:39], v[100:103]
    ds_read_b64_tr_b16 v[246:247], v5 offset:50720
    s_waitcnt lgkmcnt(6)
    v_mfma_f32_16x16x32_bf16 v[104:107], v[232:235], v[32:35], v[104:107]
    ds_read_b64_tr_b16 v[224:225], v4 offset:49920
    v_mfma_f32_16x16x32_bf16 v[108:111], v[232:235], v[36:39], v[108:111]
    ds_read_b64_tr_b16 v[226:227], v4 offset:50944
    s_mov_b32 s23, 0x22000
    buffer_load_dwordx4 v[28:31], v6, s[8:11], s23 offen offset:3072 sc1
    s_waitcnt lgkmcnt(6)
    v_mfma_f32_16x16x32_bf16 v[112:115], v[236:239], v[32:35], v[112:115]
    ds_read_b64_tr_b16 v[228:229], v5 offset:49952
    v_mfma_f32_16x16x32_bf16 v[116:119], v[236:239], v[36:39], v[116:119]
    ds_read_b64_tr_b16 v[230:231], v5 offset:50976
    s_waitcnt lgkmcnt(6)
    v_mfma_f32_16x16x32_bf16 v[120:123], v[240:243], v[32:35], v[120:123]
    v_mfma_f32_16x16x32_bf16 v[124:127], v[240:243], v[36:39], v[124:127]
    s_barrier
    ds_read_b64_tr_b16 v[232:233], v7 offset:0
    ds_read_b64_tr_b16 v[234:235], v7 offset:1024
    s_waitcnt lgkmcnt(6)
    v_mfma_f32_16x16x32_bf16 v[128:131], v[244:247], v[32:35], v[128:131]
    s_add_u32 s22, s24, 0x130000
    s_add_u32 m0, s20, 0x18000
    s_nop 0
    buffer_load_dwordx4 v3, s[4:7], s22 offen lds
    ds_read_b64_tr_b16 v[236:237], v8 offset:32
    v_mfma_f32_16x16x32_bf16 v[132:135], v[244:247], v[36:39], v[132:135]
    ds_read_b64_tr_b16 v[238:239], v8 offset:1056
    s_waitcnt lgkmcnt(6)
    v_mfma_f32_16x16x32_bf16 v[136:139], v[224:227], v[32:35], v[136:139]
    ds_read_b64_tr_b16 v[240:241], v7 offset:256
    v_mfma_f32_16x16x32_bf16 v[140:143], v[224:227], v[36:39], v[140:143]
    s_add_u32 s22, s24, 0x132000
    s_add_u32 m0, s20, 0x18400
    s_nop 0
    buffer_load_dwordx4 v3, s[4:7], s22 offen lds
    ds_read_b64_tr_b16 v[242:243], v7 offset:1280
    s_waitcnt lgkmcnt(6)
    v_mfma_f32_16x16x32_bf16 v[144:147], v[228:231], v[32:35], v[144:147]
    ds_read_b64_tr_b16 v[244:245], v8 offset:288
    v_mfma_f32_16x16x32_bf16 v[148:151], v[228:231], v[36:39], v[148:151]
    ds_read_b64_tr_b16 v[246:247], v8 offset:1312
    s_waitcnt lgkmcnt(6)
    v_mfma_f32_16x16x32_bf16 v[88:91], v[232:235], v[40:43], v[88:91]
    ds_read_b64_tr_b16 v[224:225], v7 offset:512
    v_mfma_f32_16x16x32_bf16 v[92:95], v[232:235], v[44:47], v[92:95]
    ds_read_b64_tr_b16 v[226:227], v7 offset:1536
    s_waitcnt lgkmcnt(6)
    v_mfma_f32_16x16x32_bf16 v[96:99], v[236:239], v[40:43], v[96:99]
    ds_read_b64_tr_b16 v[228:229], v8 offset:544
    s_mov_b32 s23, 0x4000
    buffer_load_dwordx4 v[32:35], v6, s[8:11], s23 offen offset:3072 sc1
    v_mfma_f32_16x16x32_bf16 v[100:103], v[236:239], v[44:47], v[100:103]
    ds_read_b64_tr_b16 v[230:231], v8 offset:1568
    s_waitcnt lgkmcnt(6)
    v_mfma_f32_16x16x32_bf16 v[104:107], v[240:243], v[40:43], v[104:107]
    ds_read_b64_tr_b16 v[232:233], v7 offset:768
    v_mfma_f32_16x16x32_bf16 v[108:111], v[240:243], v[44:47], v[108:111]
    ds_read_b64_tr_b16 v[234:235], v7 offset:1792
    s_mov_b32 s23, 0x24000
    buffer_load_dwordx4 v[36:39], v6, s[8:11], s23 offen offset:3072 sc1
    s_waitcnt lgkmcnt(6)
    v_mfma_f32_16x16x32_bf16 v[112:115], v[244:247], v[40:43], v[112:115]
    ds_read_b64_tr_b16 v[236:237], v8 offset:800
    v_mfma_f32_16x16x32_bf16 v[116:119], v[244:247], v[44:47], v[116:119]
    ds_read_b64_tr_b16 v[238:239], v8 offset:1824
    s_waitcnt lgkmcnt(6)
    v_mfma_f32_16x16x32_bf16 v[120:123], v[224:227], v[40:43], v[120:123]
    v_mfma_f32_16x16x32_bf16 v[124:127], v[224:227], v[44:47], v[124:127]
    s_waitcnt vmcnt(14)
    s_barrier
    ds_read_b64_tr_b16 v[240:241], v7 offset:16384
    ds_read_b64_tr_b16 v[242:243], v7 offset:17408
    s_waitcnt lgkmcnt(6)
    v_mfma_f32_16x16x32_bf16 v[128:131], v[228:231], v[40:43], v[128:131]
    s_add_u32 s22, s24, 0x1b0000
    s_add_u32 m0, s20, 0x1c000
    s_nop 0
    buffer_load_dwordx4 v3, s[4:7], s22 offen lds
    ds_read_b64_tr_b16 v[244:245], v8 offset:16416
    v_mfma_f32_16x16x32_bf16 v[132:135], v[228:231], v[44:47], v[132:135]
    ds_read_b64_tr_b16 v[246:247], v8 offset:17440
    s_waitcnt lgkmcnt(6)
    v_mfma_f32_16x16x32_bf16 v[136:139], v[232:235], v[40:43], v[136:139]
    ds_read_b64_tr_b16 v[224:225], v7 offset:16640
    v_mfma_f32_16x16x32_bf16 v[140:143], v[232:235], v[44:47], v[140:143]
    s_add_u32 s22, s24, 0x1b2000
    s_add_u32 m0, s20, 0x1c400
    s_nop 0
    buffer_load_dwordx4 v3, s[4:7], s22 offen lds
    ds_read_b64_tr_b16 v[226:227], v7 offset:17664
    s_waitcnt lgkmcnt(6)
    v_mfma_f32_16x16x32_bf16 v[144:147], v[236:239], v[40:43], v[144:147]
    ds_read_b64_tr_b16 v[228:229], v8 offset:16672
    v_mfma_f32_16x16x32_bf16 v[148:151], v[236:239], v[44:47], v[148:151]
    ds_read_b64_tr_b16 v[230:231], v8 offset:17696
    s_waitcnt vmcnt(15) lgkmcnt(6)
    v_mfma_f32_16x16x32_bf16 v[88:91], v[240:243], v[48:51], v[88:91]
    ds_read_b64_tr_b16 v[232:233], v7 offset:16896
    s_waitcnt vmcnt(14)
    v_mfma_f32_16x16x32_bf16 v[92:95], v[240:243], v[52:55], v[92:95]
    ds_read_b64_tr_b16 v[234:235], v7 offset:17920
    s_waitcnt lgkmcnt(6)
    v_mfma_f32_16x16x32_bf16 v[96:99], v[244:247], v[48:51], v[96:99]
    ds_read_b64_tr_b16 v[236:237], v8 offset:16928
    s_mov_b32 s23, 0x6000
    buffer_load_dwordx4 v[40:43], v6, s[8:11], s23 offen offset:3072 sc1
    v_mfma_f32_16x16x32_bf16 v[100:103], v[244:247], v[52:55], v[100:103]
    ds_read_b64_tr_b16 v[238:239], v8 offset:17952
    s_waitcnt lgkmcnt(6)
    v_mfma_f32_16x16x32_bf16 v[104:107], v[224:227], v[48:51], v[104:107]
    ds_read_b64_tr_b16 v[240:241], v7 offset:17152
    v_mfma_f32_16x16x32_bf16 v[108:111], v[224:227], v[52:55], v[108:111]
    ds_read_b64_tr_b16 v[242:243], v7 offset:18176
    s_mov_b32 s23, 0x26000
    buffer_load_dwordx4 v[44:47], v6, s[8:11], s23 offen offset:3072 sc1
    s_waitcnt lgkmcnt(6)
    v_mfma_f32_16x16x32_bf16 v[112:115], v[228:231], v[48:51], v[112:115]
    ds_read_b64_tr_b16 v[244:245], v8 offset:17184
    v_mfma_f32_16x16x32_bf16 v[116:119], v[228:231], v[52:55], v[116:119]
    ds_read_b64_tr_b16 v[246:247], v8 offset:18208
    s_waitcnt lgkmcnt(6)
    v_mfma_f32_16x16x32_bf16 v[120:123], v[232:235], v[48:51], v[120:123]
    v_mfma_f32_16x16x32_bf16 v[124:127], v[232:235], v[52:55], v[124:127]
    s_waitcnt vmcnt(14)
    s_barrier
    ds_read_b64_tr_b16 v[224:225], v4 offset:0
    ds_read_b64_tr_b16 v[226:227], v4 offset:1024
    s_waitcnt lgkmcnt(6)
    v_mfma_f32_16x16x32_bf16 v[128:131], v[236:239], v[48:51], v[128:131]
    s_add_u32 s22, s24, 0x230000
    s_add_u32 m0, s20, 0x20000
    s_nop 0
    buffer_load_dwordx4 v3, s[4:7], s22 offen lds
    ds_read_b64_tr_b16 v[228:229], v5 offset:32
    v_mfma_f32_16x16x32_bf16 v[132:135], v[236:239], v[52:55], v[132:135]
    ds_read_b64_tr_b16 v[230:231], v5 offset:1056
    s_waitcnt lgkmcnt(6)
    v_mfma_f32_16x16x32_bf16 v[136:139], v[240:243], v[48:51], v[136:139]
    ds_read_b64_tr_b16 v[232:233], v4 offset:256
    v_mfma_f32_16x16x32_bf16 v[140:143], v[240:243], v[52:55], v[140:143]
    s_add_u32 s22, s24, 0x232000
    s_add_u32 m0, s20, 0x20400
    s_nop 0
    buffer_load_dwordx4 v3, s[4:7], s22 offen lds
    ds_read_b64_tr_b16 v[234:235], v4 offset:1280
    s_waitcnt lgkmcnt(6)
    v_mfma_f32_16x16x32_bf16 v[144:147], v[244:247], v[48:51], v[144:147]
    ds_read_b64_tr_b16 v[236:237], v5 offset:288
    v_mfma_f32_16x16x32_bf16 v[148:151], v[244:247], v[52:55], v[148:151]
    ds_read_b64_tr_b16 v[238:239], v5 offset:1312
    s_waitcnt vmcnt(15) lgkmcnt(6)
    v_mfma_f32_16x16x32_bf16 v[88:91], v[224:227], v[56:59], v[88:91]
    ds_read_b64_tr_b16 v[240:241], v4 offset:512
    s_waitcnt vmcnt(14)
    v_mfma_f32_16x16x32_bf16 v[92:95], v[224:227], v[60:63], v[92:95]
    ds_read_b64_tr_b16 v[242:243], v4 offset:1536
    s_waitcnt lgkmcnt(6)
    v_mfma_f32_16x16x32_bf16 v[96:99], v[228:231], v[56:59], v[96:99]
    ds_read_b64_tr_b16 v[244:245], v5 offset:544
    s_mov_b32 s23, 0x8000
    buffer_load_dwordx4 v[48:51], v6, s[8:11], s23 offen offset:3072 sc1
    v_mfma_f32_16x16x32_bf16 v[100:103], v[228:231], v[60:63], v[100:103]
    ds_read_b64_tr_b16 v[246:247], v5 offset:1568
    s_waitcnt lgkmcnt(6)
    v_mfma_f32_16x16x32_bf16 v[104:107], v[232:235], v[56:59], v[104:107]
    ds_read_b64_tr_b16 v[224:225], v4 offset:768
    v_mfma_f32_16x16x32_bf16 v[108:111], v[232:235], v[60:63], v[108:111]
    ds_read_b64_tr_b16 v[226:227], v4 offset:1792
    s_mov_b32 s23, 0x28000
    buffer_load_dwordx4 v[52:55], v6, s[8:11], s23 offen offset:3072 sc1
    s_waitcnt lgkmcnt(6)
    v_mfma_f32_16x16x32_bf16 v[112:115], v[236:239], v[56:59], v[112:115]
    ds_read_b64_tr_b16 v[228:229], v5 offset:800
    v_mfma_f32_16x16x32_bf16 v[116:119], v[236:239], v[60:63], v[116:119]
    ds_read_b64_tr_b16 v[230:231], v5 offset:1824
    s_waitcnt lgkmcnt(6)
    v_mfma_f32_16x16x32_bf16 v[120:123], v[240:243], v[56:59], v[120:123]
    v_mfma_f32_16x16x32_bf16 v[124:127], v[240:243], v[60:63], v[124:127]
    s_waitcnt vmcnt(14)
    s_barrier
    ds_read_b64_tr_b16 v[232:233], v4 offset:16384
    ds_read_b64_tr_b16 v[234:235], v4 offset:17408
    s_waitcnt lgkmcnt(6)
    v_mfma_f32_16x16x32_bf16 v[128:131], v[244:247], v[56:59], v[128:131]
    s_add_u32 s22, s24, 0x2b0000
    s_add_u32 m0, s20, 0x24000
    s_nop 0
    buffer_load_dwordx4 v3, s[4:7], s22 offen lds
    ds_read_b64_tr_b16 v[236:237], v5 offset:16416
    v_mfma_f32_16x16x32_bf16 v[132:135], v[244:247], v[60:63], v[132:135]
    ds_read_b64_tr_b16 v[238:239], v5 offset:17440
    s_waitcnt lgkmcnt(6)
    v_mfma_f32_16x16x32_bf16 v[136:139], v[224:227], v[56:59], v[136:139]
    ds_read_b64_tr_b16 v[240:241], v4 offset:16640
    v_mfma_f32_16x16x32_bf16 v[140:143], v[224:227], v[60:63], v[140:143]
    s_add_u32 s22, s24, 0x2b2000
    s_add_u32 m0, s20, 0x24400
    s_nop 0
    buffer_load_dwordx4 v3, s[4:7], s22 offen lds
    ds_read_b64_tr_b16 v[242:243], v4 offset:17664
    s_waitcnt lgkmcnt(6)
    v_mfma_f32_16x16x32_bf16 v[144:147], v[228:231], v[56:59], v[144:147]
    ds_read_b64_tr_b16 v[244:245], v5 offset:16672
    v_mfma_f32_16x16x32_bf16 v[148:151], v[228:231], v[60:63], v[148:151]
    ds_read_b64_tr_b16 v[246:247], v5 offset:17696
    s_waitcnt vmcnt(15) lgkmcnt(6)
    v_mfma_f32_16x16x32_bf16 v[88:91], v[232:235], v[24:27], v[88:91]
    ds_read_b64_tr_b16 v[224:225], v4 offset:16896
    s_waitcnt vmcnt(14)
    v_mfma_f32_16x16x32_bf16 v[92:95], v[232:235], v[28:31], v[92:95]
    ds_read_b64_tr_b16 v[226:227], v4 offset:17920
    s_waitcnt lgkmcnt(6)
    v_mfma_f32_16x16x32_bf16 v[96:99], v[236:239], v[24:27], v[96:99]
    ds_read_b64_tr_b16 v[228:229], v5 offset:16928
    s_mov_b32 s23, 0xa000
    buffer_load_dwordx4 v[56:59], v6, s[8:11], s23 offen offset:3072 sc1
    v_mfma_f32_16x16x32_bf16 v[100:103], v[236:239], v[28:31], v[100:103]
    ds_read_b64_tr_b16 v[230:231], v5 offset:17952
    s_waitcnt lgkmcnt(6)
    v_mfma_f32_16x16x32_bf16 v[104:107], v[240:243], v[24:27], v[104:107]
    ds_read_b64_tr_b16 v[232:233], v4 offset:17152
    v_mfma_f32_16x16x32_bf16 v[108:111], v[240:243], v[28:31], v[108:111]
    ds_read_b64_tr_b16 v[234:235], v4 offset:18176
    s_mov_b32 s23, 0x2a000
    buffer_load_dwordx4 v[60:63], v6, s[8:11], s23 offen offset:3072 sc1
    s_waitcnt lgkmcnt(6)
    v_mfma_f32_16x16x32_bf16 v[112:115], v[244:247], v[24:27], v[112:115]
    ds_read_b64_tr_b16 v[236:237], v5 offset:17184
    v_mfma_f32_16x16x32_bf16 v[116:119], v[244:247], v[28:31], v[116:119]
    ds_read_b64_tr_b16 v[238:239], v5 offset:18208
    s_waitcnt lgkmcnt(6)
    v_mfma_f32_16x16x32_bf16 v[120:123], v[224:227], v[24:27], v[120:123]
    v_mfma_f32_16x16x32_bf16 v[124:127], v[224:227], v[28:31], v[124:127]
    s_waitcnt vmcnt(14)
    s_barrier
    ds_read_b64_tr_b16 v[240:241], v4 offset:32768
    ds_read_b64_tr_b16 v[242:243], v4 offset:33792
    s_waitcnt lgkmcnt(6)
    v_mfma_f32_16x16x32_bf16 v[128:131], v[228:231], v[24:27], v[128:131]
    s_add_u32 s22, s24, 0x330000
    s_add_u32 m0, s20, 0x10000
    s_nop 0
    buffer_load_dwordx4 v3, s[4:7], s22 offen lds
    ds_read_b64_tr_b16 v[244:245], v5 offset:32800
    v_mfma_f32_16x16x32_bf16 v[132:135], v[228:231], v[28:31], v[132:135]
    ds_read_b64_tr_b16 v[246:247], v5 offset:33824
    s_waitcnt lgkmcnt(6)
    v_mfma_f32_16x16x32_bf16 v[136:139], v[232:235], v[24:27], v[136:139]
    ds_read_b64_tr_b16 v[224:225], v4 offset:33024
    v_mfma_f32_16x16x32_bf16 v[140:143], v[232:235], v[28:31], v[140:143]
    s_add_u32 s22, s24, 0x332000
    s_add_u32 m0, s20, 0x10400
    s_nop 0
    buffer_load_dwordx4 v3, s[4:7], s22 offen lds
    ds_read_b64_tr_b16 v[226:227], v4 offset:34048
    s_waitcnt lgkmcnt(6)
    v_mfma_f32_16x16x32_bf16 v[144:147], v[236:239], v[24:27], v[144:147]
    ds_read_b64_tr_b16 v[228:229], v5 offset:33056
    v_mfma_f32_16x16x32_bf16 v[148:151], v[236:239], v[28:31], v[148:151]
    ds_read_b64_tr_b16 v[230:231], v5 offset:34080
    s_waitcnt vmcnt(15) lgkmcnt(6)
    v_mfma_f32_16x16x32_bf16 v[88:91], v[240:243], v[32:35], v[88:91]
    ds_read_b64_tr_b16 v[232:233], v4 offset:33280
    s_waitcnt vmcnt(14)
    v_mfma_f32_16x16x32_bf16 v[92:95], v[240:243], v[36:39], v[92:95]
    ds_read_b64_tr_b16 v[234:235], v4 offset:34304
    s_waitcnt lgkmcnt(6)
    v_mfma_f32_16x16x32_bf16 v[96:99], v[244:247], v[32:35], v[96:99]
    ds_read_b64_tr_b16 v[236:237], v5 offset:33312
    s_mov_b32 s23, 0xc000
    buffer_load_dwordx4 v[24:27], v6, s[8:11], s23 offen offset:3072 sc1
    v_mfma_f32_16x16x32_bf16 v[100:103], v[244:247], v[36:39], v[100:103]
    ds_read_b64_tr_b16 v[238:239], v5 offset:34336
    s_waitcnt lgkmcnt(6)
    v_mfma_f32_16x16x32_bf16 v[104:107], v[224:227], v[32:35], v[104:107]
    ds_read_b64_tr_b16 v[240:241], v4 offset:33536
    v_mfma_f32_16x16x32_bf16 v[108:111], v[224:227], v[36:39], v[108:111]
    ds_read_b64_tr_b16 v[242:243], v4 offset:34560
    s_mov_b32 s23, 0x2c000
    buffer_load_dwordx4 v[28:31], v6, s[8:11], s23 offen offset:3072 sc1
    v_lshrrev_b32 v16, 4, v1
    v_lshlrev_b32 v16, 3, v16
    s_lshl_b32 s16, s31, 8
    s_add_u32 s16, s16, 0x540000
    buffer_load_dwordx2 v[248:249], v16, s[8:11], s16 offen offset:0 sc1
    buffer_load_dwordx2 v[250:251], v16, s[8:11], s16 offen offset:32 sc1
    buffer_load_dwordx2 v[252:253], v16, s[8:11], s16 offen offset:64 sc1
    buffer_load_dwordx2 v[254:255], v16, s[8:11], s16 offen offset:96 sc1
    s_waitcnt lgkmcnt(6)
    v_mfma_f32_16x16x32_bf16 v[112:115], v[228:231], v[32:35], v[112:115]
    ds_read_b64_tr_b16 v[244:245], v5 offset:33568
    v_mfma_f32_16x16x32_bf16 v[116:119], v[228:231], v[36:39], v[116:119]
    ds_read_b64_tr_b16 v[246:247], v5 offset:34592
    s_waitcnt lgkmcnt(6)
    v_mfma_f32_16x16x32_bf16 v[120:123], v[232:235], v[32:35], v[120:123]
    v_mfma_f32_16x16x32_bf16 v[124:127], v[232:235], v[36:39], v[124:127]
    s_waitcnt vmcnt(18)
    s_barrier
    ds_read_b64_tr_b16 v[224:225], v4 offset:49152
    ds_read_b64_tr_b16 v[226:227], v4 offset:50176
    s_waitcnt lgkmcnt(6)
    v_mfma_f32_16x16x32_bf16 v[128:131], v[236:239], v[32:35], v[128:131]
    s_add_u32 s22, s24, 0x3b0000
    s_add_u32 m0, s20, 0x14000
    s_nop 0
    buffer_load_dwordx4 v3, s[4:7], s22 offen lds
    ds_read_b64_tr_b16 v[228:229], v5 offset:49184
    v_mfma_f32_16x16x32_bf16 v[132:135], v[236:239], v[36:39], v[132:135]
    ds_read_b64_tr_b16 v[230:231], v5 offset:50208
    s_waitcnt lgkmcnt(6)
    v_mfma_f32_16x16x32_bf16 v[136:139], v[240:243], v[32:35], v[136:139]
    ds_read_b64_tr_b16 v[232:233], v4 offset:49408
    v_mfma_f32_16x16x32_bf16 v[140:143], v[240:243], v[36:39], v[140:143]
    s_add_u32 s22, s24, 0x3b2000
    s_add_u32 m0, s20, 0x14400
    s_nop 0
    buffer_load_dwordx4 v3, s[4:7], s22 offen lds
    ds_read_b64_tr_b16 v[234:235], v4 offset:50432
    s_waitcnt lgkmcnt(6)
    v_mfma_f32_16x16x32_bf16 v[144:147], v[244:247], v[32:35], v[144:147]
    ds_read_b64_tr_b16 v[236:237], v5 offset:49440
    v_mfma_f32_16x16x32_bf16 v[148:151], v[244:247], v[36:39], v[148:151]
    ds_read_b64_tr_b16 v[238:239], v5 offset:50464
    s_waitcnt vmcnt(19) lgkmcnt(6)
    v_mfma_f32_16x16x32_bf16 v[88:91], v[224:227], v[40:43], v[88:91]
    ds_read_b64_tr_b16 v[240:241], v4 offset:49664
    s_waitcnt vmcnt(18)
    v_mfma_f32_16x16x32_bf16 v[92:95], v[224:227], v[44:47], v[92:95]
    ds_read_b64_tr_b16 v[242:243], v4 offset:50688
    s_waitcnt lgkmcnt(6)
    v_mfma_f32_16x16x32_bf16 v[96:99], v[228:231], v[40:43], v[96:99]
    ds_read_b64_tr_b16 v[244:245], v5 offset:49696
    s_mov_b32 s23, 0xe000
    buffer_load_dwordx4 v[32:35], v6, s[8:11], s23 offen offset:3072 sc1
    v_mfma_f32_16x16x32_bf16 v[100:103], v[228:231], v[44:47], v[100:103]
    ds_read_b64_tr_b16 v[246:247], v5 offset:50720
    s_waitcnt lgkmcnt(6)
    v_mfma_f32_16x16x32_bf16 v[104:107], v[232:235], v[40:43], v[104:107]
    ds_read_b64_tr_b16 v[224:225], v4 offset:49920
    v_mfma_f32_16x16x32_bf16 v[108:111], v[232:235], v[44:47], v[108:111]
    ds_read_b64_tr_b16 v[226:227], v4 offset:50944
    s_mov_b32 s23, 0x2e000
    buffer_load_dwordx4 v[36:39], v6, s[8:11], s23 offen offset:3072 sc1
    s_waitcnt lgkmcnt(6)
    v_mfma_f32_16x16x32_bf16 v[112:115], v[236:239], v[40:43], v[112:115]
    ds_read_b64_tr_b16 v[228:229], v5 offset:49952
    v_mfma_f32_16x16x32_bf16 v[116:119], v[236:239], v[44:47], v[116:119]
    ds_read_b64_tr_b16 v[230:231], v5 offset:50976
    s_waitcnt lgkmcnt(6)
    v_mfma_f32_16x16x32_bf16 v[120:123], v[240:243], v[40:43], v[120:123]
    v_mfma_f32_16x16x32_bf16 v[124:127], v[240:243], v[44:47], v[124:127]
    s_waitcnt vmcnt(18)
    s_barrier
    ds_read_b64_tr_b16 v[232:233], v7 offset:0
    ds_read_b64_tr_b16 v[234:235], v7 offset:1024
    s_waitcnt lgkmcnt(6)
    v_mfma_f32_16x16x32_bf16 v[128:131], v[244:247], v[40:43], v[128:131]
    ds_read_b64_tr_b16 v[236:237], v8 offset:32
    v_mfma_f32_16x16x32_bf16 v[132:135], v[244:247], v[44:47], v[132:135]
    ds_read_b64_tr_b16 v[238:239], v8 offset:1056
    s_waitcnt lgkmcnt(6)
    v_mfma_f32_16x16x32_bf16 v[136:139], v[224:227], v[40:43], v[136:139]
    ds_read_b64_tr_b16 v[240:241], v7 offset:256
    v_mfma_f32_16x16x32_bf16 v[140:143], v[224:227], v[44:47], v[140:143]
    ds_read_b64_tr_b16 v[242:243], v7 offset:1280
    s_waitcnt lgkmcnt(6)
    v_mfma_f32_16x16x32_bf16 v[144:147], v[228:231], v[40:43], v[144:147]
    ds_read_b64_tr_b16 v[244:245], v8 offset:288
    v_mfma_f32_16x16x32_bf16 v[148:151], v[228:231], v[44:47], v[148:151]
    ds_read_b64_tr_b16 v[246:247], v8 offset:1312
    s_waitcnt vmcnt(17) lgkmcnt(6)
    v_mfma_f32_16x16x32_bf16 v[88:91], v[232:235], v[48:51], v[88:91]
    ds_read_b64_tr_b16 v[224:225], v7 offset:512
    s_waitcnt vmcnt(16)
    v_mfma_f32_16x16x32_bf16 v[92:95], v[232:235], v[52:55], v[92:95]
    ds_read_b64_tr_b16 v[226:227], v7 offset:1536
    s_waitcnt lgkmcnt(6)
    v_mfma_f32_16x16x32_bf16 v[96:99], v[236:239], v[48:51], v[96:99]
    ds_read_b64_tr_b16 v[228:229], v8 offset:544
    v_mfma_f32_16x16x32_bf16 v[100:103], v[236:239], v[52:55], v[100:103]
    ds_read_b64_tr_b16 v[230:231], v8 offset:1568
    s_waitcnt lgkmcnt(6)
    v_mfma_f32_16x16x32_bf16 v[104:107], v[240:243], v[48:51], v[104:107]
    ds_read_b64_tr_b16 v[232:233], v7 offset:768
    v_mfma_f32_16x16x32_bf16 v[108:111], v[240:243], v[52:55], v[108:111]
    ds_read_b64_tr_b16 v[234:235], v7 offset:1792
    s_waitcnt lgkmcnt(6)
    v_mfma_f32_16x16x32_bf16 v[112:115], v[244:247], v[48:51], v[112:115]
    ds_read_b64_tr_b16 v[236:237], v8 offset:800
    v_mfma_f32_16x16x32_bf16 v[116:119], v[244:247], v[52:55], v[116:119]
    ds_read_b64_tr_b16 v[238:239], v8 offset:1824
    s_waitcnt lgkmcnt(6)
    v_mfma_f32_16x16x32_bf16 v[120:123], v[224:227], v[48:51], v[120:123]
    v_mfma_f32_16x16x32_bf16 v[124:127], v[224:227], v[52:55], v[124:127]
    s_waitcnt vmcnt(14)
    s_barrier
    ds_read_b64_tr_b16 v[240:241], v7 offset:16384
    ds_read_b64_tr_b16 v[242:243], v7 offset:17408
    s_waitcnt lgkmcnt(6)
    v_mfma_f32_16x16x32_bf16 v[128:131], v[228:231], v[48:51], v[128:131]
    ds_read_b64_tr_b16 v[244:245], v8 offset:16416
    v_mfma_f32_16x16x32_bf16 v[132:135], v[228:231], v[52:55], v[132:135]
    ds_read_b64_tr_b16 v[246:247], v8 offset:17440
    s_waitcnt lgkmcnt(6)
    v_mfma_f32_16x16x32_bf16 v[136:139], v[232:235], v[48:51], v[136:139]
    ds_read_b64_tr_b16 v[224:225], v7 offset:16640
    v_mfma_f32_16x16x32_bf16 v[140:143], v[232:235], v[52:55], v[140:143]
    ds_read_b64_tr_b16 v[226:227], v7 offset:17664
    s_waitcnt lgkmcnt(6)
    v_mfma_f32_16x16x32_bf16 v[144:147], v[236:239], v[48:51], v[144:147]
    ds_read_b64_tr_b16 v[228:229], v8 offset:16672
    v_mfma_f32_16x16x32_bf16 v[148:151], v[236:239], v[52:55], v[148:151]
    ds_read_b64_tr_b16 v[230:231], v8 offset:17696
    s_waitcnt vmcnt(13) lgkmcnt(6)
    v_mfma_f32_16x16x32_bf16 v[88:91], v[240:243], v[56:59], v[88:91]
    ds_read_b64_tr_b16 v[232:233], v7 offset:16896
    s_waitcnt vmcnt(12)
    v_mfma_f32_16x16x32_bf16 v[92:95], v[240:243], v[60:63], v[92:95]
    ds_read_b64_tr_b16 v[234:235], v7 offset:17920
    s_waitcnt lgkmcnt(6)
    v_mfma_f32_16x16x32_bf16 v[96:99], v[244:247], v[56:59], v[96:99]
    ds_read_b64_tr_b16 v[236:237], v8 offset:16928
    v_mfma_f32_16x16x32_bf16 v[100:103], v[244:247], v[60:63], v[100:103]
    ds_read_b64_tr_b16 v[238:239], v8 offset:17952
    s_waitcnt lgkmcnt(6)
    v_mfma_f32_16x16x32_bf16 v[104:107], v[224:227], v[56:59], v[104:107]
    ds_read_b64_tr_b16 v[240:241], v7 offset:17152
    v_mfma_f32_16x16x32_bf16 v[108:111], v[224:227], v[60:63], v[108:111]
    ds_read_b64_tr_b16 v[242:243], v7 offset:18176
    s_waitcnt lgkmcnt(6)
    v_mfma_f32_16x16x32_bf16 v[112:115], v[228:231], v[56:59], v[112:115]
    ds_read_b64_tr_b16 v[244:245], v8 offset:17184
    v_mfma_f32_16x16x32_bf16 v[116:119], v[228:231], v[60:63], v[116:119]
    ds_read_b64_tr_b16 v[246:247], v8 offset:18208
    s_waitcnt lgkmcnt(6)
    v_mfma_f32_16x16x32_bf16 v[120:123], v[232:235], v[56:59], v[120:123]
    v_mfma_f32_16x16x32_bf16 v[124:127], v[232:235], v[60:63], v[124:127]
    s_waitcnt vmcnt(10)
    s_barrier
    ds_read_b64_tr_b16 v[224:225], v4 offset:0
    ds_read_b64_tr_b16 v[226:227], v4 offset:1024
    s_waitcnt lgkmcnt(6)
    v_mfma_f32_16x16x32_bf16 v[128:131], v[236:239], v[56:59], v[128:131]
    ds_read_b64_tr_b16 v[228:229], v5 offset:32
    v_mfma_f32_16x16x32_bf16 v[132:135], v[236:239], v[60:63], v[132:135]
    ds_read_b64_tr_b16 v[230:231], v5 offset:1056
    s_waitcnt lgkmcnt(6)
    v_mfma_f32_16x16x32_bf16 v[136:139], v[240:243], v[56:59], v[136:139]
    ds_read_b64_tr_b16 v[232:233], v4 offset:256
    v_mfma_f32_16x16x32_bf16 v[140:143], v[240:243], v[60:63], v[140:143]
    ds_read_b64_tr_b16 v[234:235], v4 offset:1280
    s_waitcnt lgkmcnt(6)
    v_mfma_f32_16x16x32_bf16 v[144:147], v[244:247], v[56:59], v[144:147]
    ds_read_b64_tr_b16 v[236:237], v5 offset:288
    v_mfma_f32_16x16x32_bf16 v[148:151], v[244:247], v[60:63], v[148:151]
    ds_read_b64_tr_b16 v[238:239], v5 offset:1312
    s_waitcnt vmcnt(9) lgkmcnt(6)
    v_mfma_f32_16x16x32_bf16 v[88:91], v[224:227], v[24:27], v[88:91]
    ds_read_b64_tr_b16 v[240:241], v4 offset:512
    s_waitcnt vmcnt(8)
    v_mfma_f32_16x16x32_bf16 v[92:95], v[224:227], v[28:31], v[92:95]
    ds_read_b64_tr_b16 v[242:243], v4 offset:1536
    s_waitcnt lgkmcnt(6)
    v_mfma_f32_16x16x32_bf16 v[96:99], v[228:231], v[24:27], v[96:99]
    ds_read_b64_tr_b16 v[244:245], v5 offset:544
    v_mfma_f32_16x16x32_bf16 v[100:103], v[228:231], v[28:31], v[100:103]
    ds_read_b64_tr_b16 v[246:247], v5 offset:1568
    s_waitcnt lgkmcnt(6)
    v_mfma_f32_16x16x32_bf16 v[104:107], v[232:235], v[24:27], v[104:107]
    ds_read_b64_tr_b16 v[224:225], v4 offset:768
    v_mfma_f32_16x16x32_bf16 v[108:111], v[232:235], v[28:31], v[108:111]
    ds_read_b64_tr_b16 v[226:227], v4 offset:1792
    s_waitcnt lgkmcnt(6)
    v_mfma_f32_16x16x32_bf16 v[112:115], v[236:239], v[24:27], v[112:115]
    ds_read_b64_tr_b16 v[228:229], v5 offset:800
    v_mfma_f32_16x16x32_bf16 v[116:119], v[236:239], v[28:31], v[116:119]
    ds_read_b64_tr_b16 v[230:231], v5 offset:1824
    s_waitcnt lgkmcnt(6)
    v_mfma_f32_16x16x32_bf16 v[120:123], v[240:243], v[24:27], v[120:123]
    v_mfma_f32_16x16x32_bf16 v[124:127], v[240:243], v[28:31], v[124:127]
    s_waitcnt vmcnt(2)
    s_barrier
    ds_read_b64_tr_b16 v[232:233], v4 offset:16384
    ds_read_b64_tr_b16 v[234:235], v4 offset:17408
    s_waitcnt lgkmcnt(6)
    v_mfma_f32_16x16x32_bf16 v[128:131], v[244:247], v[24:27], v[128:131]
    ds_read_b64_tr_b16 v[236:237], v5 offset:16416
    v_mfma_f32_16x16x32_bf16 v[132:135], v[244:247], v[28:31], v[132:135]
    ds_read_b64_tr_b16 v[238:239], v5 offset:17440
    s_waitcnt lgkmcnt(6)
    v_mfma_f32_16x16x32_bf16 v[136:139], v[224:227], v[24:27], v[136:139]
    ds_read_b64_tr_b16 v[240:241], v4 offset:16640
    v_mfma_f32_16x16x32_bf16 v[140:143], v[224:227], v[28:31], v[140:143]
    ds_read_b64_tr_b16 v[242:243], v4 offset:17664
    s_waitcnt lgkmcnt(6)
    v_mfma_f32_16x16x32_bf16 v[144:147], v[228:231], v[24:27], v[144:147]
    ds_read_b64_tr_b16 v[244:245], v5 offset:16672
    v_mfma_f32_16x16x32_bf16 v[148:151], v[228:231], v[28:31], v[148:151]
    ds_read_b64_tr_b16 v[246:247], v5 offset:17696
    s_waitcnt vmcnt(1) lgkmcnt(6)
    v_mfma_f32_16x16x32_bf16 v[88:91], v[232:235], v[32:35], v[88:91]
    ds_read_b64_tr_b16 v[224:225], v4 offset:16896
    s_waitcnt vmcnt(0)
    v_mfma_f32_16x16x32_bf16 v[92:95], v[232:235], v[36:39], v[92:95]
    ds_read_b64_tr_b16 v[226:227], v4 offset:17920
    s_waitcnt lgkmcnt(6)
    v_mfma_f32_16x16x32_bf16 v[96:99], v[236:239], v[32:35], v[96:99]
    ds_read_b64_tr_b16 v[228:229], v5 offset:16928
    v_mfma_f32_16x16x32_bf16 v[100:103], v[236:239], v[36:39], v[100:103]
    ds_read_b64_tr_b16 v[230:231], v5 offset:17952
    s_waitcnt lgkmcnt(6)
    v_mfma_f32_16x16x32_bf16 v[104:107], v[240:243], v[32:35], v[104:107]
    ds_read_b64_tr_b16 v[232:233], v4 offset:17152
    v_mfma_f32_16x16x32_bf16 v[108:111], v[240:243], v[36:39], v[108:111]
    ds_read_b64_tr_b16 v[234:235], v4 offset:18176
    s_waitcnt lgkmcnt(6)
    v_mfma_f32_16x16x32_bf16 v[112:115], v[244:247], v[32:35], v[112:115]
    ds_read_b64_tr_b16 v[236:237], v5 offset:17184
    v_mfma_f32_16x16x32_bf16 v[116:119], v[244:247], v[36:39], v[116:119]
    ds_read_b64_tr_b16 v[238:239], v5 offset:18208
    s_waitcnt lgkmcnt(6)
    v_mfma_f32_16x16x32_bf16 v[120:123], v[224:227], v[32:35], v[120:123]
    v_mfma_f32_16x16x32_bf16 v[124:127], v[224:227], v[36:39], v[124:127]
    s_waitcnt lgkmcnt(4)
    v_mfma_f32_16x16x32_bf16 v[128:131], v[228:231], v[32:35], v[128:131]
    v_mfma_f32_16x16x32_bf16 v[132:135], v[228:231], v[36:39], v[132:135]
    s_waitcnt lgkmcnt(2)
    v_mfma_f32_16x16x32_bf16 v[136:139], v[232:235], v[32:35], v[136:139]
    v_mfma_f32_16x16x32_bf16 v[140:143], v[232:235], v[36:39], v[140:143]
    s_waitcnt lgkmcnt(0)
    v_mfma_f32_16x16x32_bf16 v[144:147], v[236:239], v[32:35], v[144:147]
    v_mfma_f32_16x16x32_bf16 v[148:151], v[236:239], v[36:39], v[148:151]
    s_lshl_b32 s16, s3, 13
    s_xor_b32 s17, s16, 0x8000
    s_add_u32 s16, s16, 0x18000
    s_add_u32 s17, s17, 0x18000
    v_add_u32 v16, s16, v2
    s_mov_b32 s16, s17
    v_add_u32 v17, s16, v2
    ds_write_b128 v16, v[120:123] offset:0
    ds_write_b128 v16, v[124:127] offset:1024
    ds_write_b128 v16, v[128:131] offset:2048
    ds_write_b128 v16, v[132:135] offset:3072
    ds_write_b128 v16, v[136:139] offset:4096
    ds_write_b128 v16, v[140:143] offset:5120
    ds_write_b128 v16, v[144:147] offset:6144
    ds_write_b128 v16, v[148:151] offset:7168
    v_lshlrev_b32 v24, 16, v248
    v_and_b32 v25, 0xffff0000, v248
    v_lshlrev_b32 v26, 16, v249
    v_and_b32 v27, 0xffff0000, v249
    v_lshlrev_b32 v28, 16, v250
    v_and_b32 v29, 0xffff0000, v250
    v_lshlrev_b32 v30, 16, v251
    v_and_b32 v31, 0xffff0000, v251
    v_lshlrev_b32 v32, 16, v252
    v_and_b32 v33, 0xffff0000, v252
    v_lshlrev_b32 v34, 16, v253
    v_and_b32 v35, 0xffff0000, v253
    v_lshlrev_b32 v36, 16, v254
    v_and_b32 v37, 0xffff0000, v254
    v_lshlrev_b32 v38, 16, v255
    v_and_b32 v39, 0xffff0000, v255
    v_and_b32 v18, 15, v1
    v_lshlrev_b32 v18, 6, v18
    v_lshrrev_b32 v19, 4, v1
    v_and_b32 v20, 1, v19
    v_lshl_add_u32 v18, v20, 5, v18
    v_lshrrev_b32 v19, 1, v19
    v_lshl_add_u32 v18, v19, 4, v18
    s_and_b32 s17, s3, 3
    s_lshl_b32 s18, s30, 2
    s_add_u32 s18, s18, s17
    s_lshl_b32 s18, s18, 16
    s_lshl_b32 s19, s15, 22
    s_add_u32 s18, s18, s19
    s_lshl_b32 s19, s31, 12
    s_add_u32 s18, s18, s19
    s_add_u32 s18, s18, 0x2000000
    s_add_u32 s19, s18, 32768
    s_waitcnt lgkmcnt(0)
    s_barrier
    ds_read_b128 v[40:43], v17 offset:0
    ds_read_b128 v[44:47], v17 offset:1024
    ds_read_b128 v[48:51], v17 offset:2048
    ds_read_b128 v[52:55], v17 offset:3072
    ds_read_b128 v[56:59], v17 offset:4096
    ds_read_b128 v[60:63], v17 offset:5120
    ds_read_b128 v[64:67], v17 offset:6144
    ds_read_b128 v[68:71], v17 offset:7168
    s_waitcnt lgkmcnt(7)
    v_pk_add_f32 v[88:89], v[88:89], v[40:41]
    v_pk_add_f32 v[90:91], v[90:91], v[42:43]
    v_pk_mul_f32 v[88:89], v[88:89], v[24:25]
    v_pk_mul_f32 v[90:91], v[90:91], v[26:27]
    v_cvt_pk_bf16_f32 v224, v88, v89
    v_cvt_pk_bf16_f32 v225, v90, v91
    s_waitcnt lgkmcnt(5)
    v_pk_add_f32 v[96:97], v[96:97], v[48:49]
    v_pk_add_f32 v[98:99], v[98:99], v[50:51]
    v_pk_mul_f32 v[96:97], v[96:97], v[28:29]
    v_pk_mul_f32 v[98:99], v[98:99], v[30:31]
    v_cvt_pk_bf16_f32 v226, v96, v97
    v_cvt_pk_bf16_f32 v227, v98, v99
    s_nop 0
    v_permlane16_swap_b32 v224, v226
    v_permlane16_swap_b32 v225, v227
    buffer_store_dwordx4 v[224:227], v18, s[8:11], s18 offen offset:0 sc1
    v_pk_add_f32 v[92:93], v[92:93], v[44:45]
    v_pk_add_f32 v[94:95], v[94:95], v[46:47]
    v_pk_mul_f32 v[92:93], v[92:93], v[24:25]
    v_pk_mul_f32 v[94:95], v[94:95], v[26:27]
    v_cvt_pk_bf16_f32 v228, v92, v93
    v_cvt_pk_bf16_f32 v229, v94, v95
    s_waitcnt lgkmcnt(4)
    v_pk_add_f32 v[100:101], v[100:101], v[52:53]
    v_pk_add_f32 v[102:103], v[102:103], v[54:55]
    v_pk_mul_f32 v[100:101], v[100:101], v[28:29]
    v_pk_mul_f32 v[102:103], v[102:103], v[30:31]
    v_cvt_pk_bf16_f32 v230, v100, v101
    v_cvt_pk_bf16_f32 v231, v102, v103
    s_nop 0
    v_permlane16_swap_b32 v228, v230
    v_permlane16_swap_b32 v229, v231
    buffer_store_dwordx4 v[228:231], v18, s[8:11], s19 offen offset:0 sc1
    s_waitcnt lgkmcnt(3)
    v_pk_add_f32 v[104:105], v[104:105], v[56:57]
    v_pk_add_f32 v[106:107], v[106:107], v[58:59]
    v_pk_mul_f32 v[104:105], v[104:105], v[32:33]
    v_pk_mul_f32 v[106:107], v[106:107], v[34:35]
    v_cvt_pk_bf16_f32 v232, v104, v105
    v_cvt_pk_bf16_f32 v233, v106, v107
    s_waitcnt lgkmcnt(1)
    v_pk_add_f32 v[112:113], v[112:113], v[64:65]
    v_pk_add_f32 v[114:115], v[114:115], v[66:67]
    v_pk_mul_f32 v[112:113], v[112:113], v[36:37]
    v_pk_mul_f32 v[114:115], v[114:115], v[38:39]
    v_cvt_pk_bf16_f32 v234, v112, v113
    v_cvt_pk_bf16_f32 v235, v114, v115
    s_nop 0
    v_permlane16_swap_b32 v232, v234
    v_permlane16_swap_b32 v233, v235
    buffer_store_dwordx4 v[232:235], v18, s[8:11], s18 offen offset:1024 sc1
    v_pk_add_f32 v[108:109], v[108:109], v[60:61]
    v_pk_add_f32 v[110:111], v[110:111], v[62:63]
    v_pk_mul_f32 v[108:109], v[108:109], v[32:33]
    v_pk_mul_f32 v[110:111], v[110:111], v[34:35]
    v_cvt_pk_bf16_f32 v236, v108, v109
    v_cvt_pk_bf16_f32 v237, v110, v111
    s_waitcnt lgkmcnt(0)
    v_pk_add_f32 v[116:117], v[116:117], v[68:69]
    v_pk_add_f32 v[118:119], v[118:119], v[70:71]
    v_pk_mul_f32 v[116:117], v[116:117], v[36:37]
    v_pk_mul_f32 v[118:119], v[118:119], v[38:39]
    v_cvt_pk_bf16_f32 v238, v116, v117
    v_cvt_pk_bf16_f32 v239, v118, v119
    s_nop 0
    v_permlane16_swap_b32 v236, v238
    v_permlane16_swap_b32 v237, v239
    buffer_store_dwordx4 v[236:239], v18, s[8:11], s19 offen offset:1024 sc1
    s_mov_b64 s[64:65], s[44:45]
    s_mov_b32 s66, 0x800
    s_mov_b32 s67, 0x20000
    s_mov_b64 s[76:77], s[32:33]
    s_mov_b32 s78, 0x400000
    s_mov_b32 s79, 0x20000
    s_mov_b64 s[68:69], s[56:57]
    s_mov_b32 s70, 0x400000
    s_mov_b32 s71, 0x20000
    s_lshl_b32 s14, s31, 1
    s_add_u32 s14, s14, s15
    s_lshl_b32 s14, s14, 3
    s_add_u32 s14, s14, s3
    s_lshl_b32 s16, s30, 7
    s_add_u32 s14, s14, s16
    s_lshl_b32 s16, s14, 11
    buffer_load_dwordx4 v[216:219], v2, s[76:79], s16 offen offset:0
    buffer_load_dwordx4 v[220:223], v2, s[76:79], s16 offen offset:1024
    s_lshl_b32 s16, s3, 10
    s_add_u32 m0, s16, 81920
    s_add_u32 s16, s16, 0x540800
    buffer_load_dwordx4 v2, s[8:11], s16 offen sc1 lds
    s_lshl_b32 s16, s30, 5
    s_lshl_b32 s17, s31, 1
    s_add_u32 s16, s16, s17
    s_add_u32 s16, s16, s15
    s_lshl_b32 s16, s16, 2
    s_add_u32 s16, s16, 0x530000
    s_cmp_eq_u32 s3, 0
    s_cselect_b32 s16, s16, 0x7ffffff0
    v_mov_b32 v16, s28
    v_mov_b32 v17, 0
    s_lshr_b32 s18, s14, 4
    s_lshl_b32 s18, s18, 15
    s_and_b32 s19, s14, 15
    s_lshl_b32 s19, s19, 6
    s_add_u32 s18, s18, s19
    s_add_u32 s18, s18, 0x2000000
    s_add_u32 s19, s18, 16384
    v_lshrrev_b32 v18, 2, v1
    v_lshlrev_b32 v18, 10, v18
    v_and_b32 v19, 3, v1
    v_lshl_add_u32 v18, v19, 4, v18
    v_add_u32 v19, 0x400000, v18
    s_lshl_b32 s25, s30, 7
    s_add_u32 s25, s25, 0x530000
    v_and_b32 v20, 15, v1
    v_lshlrev_b32 v20, 2, v20
    s_waitcnt vmcnt(3)
    s_waitcnt vmcnt(0)
    s_barrier
    s_mov_b64 exec, 1
    buffer_store_dword v16, v17, s[8:11], s16 offen sc1
    s_mov_b64 exec, -1
    v_add_u32 v16, 81920, v2
    ds_read_b128 v[184:187], v16 offset:0
    ds_read_b128 v[188:191], v16 offset:1024
    ds_read_b128 v[192:195], v16 offset:2048
    ds_read_b128 v[196:199], v16 offset:3072
    ds_read_b128 v[200:203], v16 offset:4096
    ds_read_b128 v[204:207], v16 offset:5120
    ds_read_b128 v[208:211], v16 offset:6144
    ds_read_b128 v[212:215], v16 offset:7168
    v_mov_b32 v94, 0
    v_mov_b32 v95, 0
    s_waitcnt lgkmcnt(5)
    v_lshlrev_b32 v76, 16, v192
    v_and_b32 v77, 0xffff0000, v192
    s_waitcnt lgkmcnt(1)
    v_lshlrev_b32 v78, 16, v208
    v_and_b32 v79, 0xffff0000, v208
    v_pk_mul_f32 v[60:61], v[76:77], v[78:79]
    v_lshlrev_b32 v76, 16, v184
    v_and_b32 v77, 0xffff0000, v184
    v_fmac_f32 v94, v76, v78
    v_fmac_f32 v94, v77, v79
    v_add_f32 v95, v95, v60
    v_add_f32 v95, v95, v61
    v_lshlrev_b32 v76, 16, v193
    v_and_b32 v77, 0xffff0000, v193
    v_lshlrev_b32 v78, 16, v209
    v_and_b32 v79, 0xffff0000, v209
    v_pk_mul_f32 v[62:63], v[76:77], v[78:79]
    v_lshlrev_b32 v76, 16, v185
    v_and_b32 v77, 0xffff0000, v185
    v_fmac_f32 v94, v76, v78
    v_fmac_f32 v94, v77, v79
    v_add_f32 v95, v95, v62
    v_add_f32 v95, v95, v63
    v_lshlrev_b32 v76, 16, v194
    v_and_b32 v77, 0xffff0000, v194
    v_lshlrev_b32 v78, 16, v210
    v_and_b32 v79, 0xffff0000, v210
    v_pk_mul_f32 v[64:65], v[76:77], v[78:79]
    v_lshlrev_b32 v76, 16, v186
    v_and_b32 v77, 0xffff0000, v186
    v_fmac_f32 v94, v76, v78
    v_fmac_f32 v94, v77, v79
    v_add_f32 v95, v95, v64
    v_add_f32 v95, v95, v65
    v_lshlrev_b32 v76, 16, v195
    v_and_b32 v77, 0xffff0000, v195
    v_lshlrev_b32 v78, 16, v211
    v_and_b32 v79, 0xffff0000, v211
    v_pk_mul_f32 v[66:67], v[76:77], v[78:79]
    v_lshlrev_b32 v76, 16, v187
    v_and_b32 v77, 0xffff0000, v187
    v_fmac_f32 v94, v76, v78
    v_fmac_f32 v94, v77, v79
    v_add_f32 v95, v95, v66
    v_add_f32 v95, v95, v67
    v_lshlrev_b32 v76, 16, v196
    v_and_b32 v77, 0xffff0000, v196
    s_waitcnt lgkmcnt(0)
    v_lshlrev_b32 v78, 16, v212
    v_and_b32 v79, 0xffff0000, v212
    v_pk_mul_f32 v[68:69], v[76:77], v[78:79]
    v_lshlrev_b32 v76, 16, v188
    v_and_b32 v77, 0xffff0000, v188
    v_fmac_f32 v94, v76, v78
    v_fmac_f32 v94, v77, v79
    v_add_f32 v95, v95, v68
    v_add_f32 v95, v95, v69
    v_lshlrev_b32 v76, 16, v197
    v_and_b32 v77, 0xffff0000, v197
    v_lshlrev_b32 v78, 16, v213
    v_and_b32 v79, 0xffff0000, v213
    v_pk_mul_f32 v[70:71], v[76:77], v[78:79]
    v_lshlrev_b32 v76, 16, v189
    v_and_b32 v77, 0xffff0000, v189
    v_fmac_f32 v94, v76, v78
    v_fmac_f32 v94, v77, v79
    v_add_f32 v95, v95, v70
    v_add_f32 v95, v95, v71
    v_lshlrev_b32 v76, 16, v198
    v_and_b32 v77, 0xffff0000, v198
    v_lshlrev_b32 v78, 16, v214
    v_and_b32 v79, 0xffff0000, v214
    v_pk_mul_f32 v[72:73], v[76:77], v[78:79]
    v_lshlrev_b32 v76, 16, v190
    v_and_b32 v77, 0xffff0000, v190
    v_fmac_f32 v94, v76, v78
    v_fmac_f32 v94, v77, v79
    v_add_f32 v95, v95, v72
    v_add_f32 v95, v95, v73
    v_lshlrev_b32 v76, 16, v199
    v_and_b32 v77, 0xffff0000, v199
    v_lshlrev_b32 v78, 16, v215
    v_and_b32 v79, 0xffff0000, v215
    v_pk_mul_f32 v[74:75], v[76:77], v[78:79]
    v_lshlrev_b32 v76, 16, v191
    v_and_b32 v77, 0xffff0000, v191
    v_fmac_f32 v94, v76, v78
    v_fmac_f32 v94, v77, v79
    v_add_f32 v95, v95, v74
    v_add_f32 v95, v95, v75
    v_add_f32_dpp v94, v94, v94 row_ror:1 row_mask:0xf bank_mask:0xf
    s_nop 0
    v_add_f32_dpp v95, v95, v95 row_ror:1 row_mask:0xf bank_mask:0xf
    v_add_f32_dpp v94, v94, v94 row_ror:2 row_mask:0xf bank_mask:0xf
    s_nop 0
    v_add_f32_dpp v95, v95, v95 row_ror:2 row_mask:0xf bank_mask:0xf
    v_add_f32_dpp v94, v94, v94 row_ror:4 row_mask:0xf bank_mask:0xf
    s_nop 0
    v_add_f32_dpp v95, v95, v95 row_ror:4 row_mask:0xf bank_mask:0xf
    v_add_f32_dpp v94, v94, v94 row_ror:8 row_mask:0xf bank_mask:0xf
    s_nop 0
    v_add_f32_dpp v95, v95, v95 row_ror:8 row_mask:0xf bank_mask:0xf
    v_mov_b32 v76, v94
    s_nop 1
    v_permlane16_swap_b32 v94, v76
    v_add_f32 v94, v94, v76
    v_mov_b32 v77, v95
    s_nop 1
    v_permlane16_swap_b32 v95, v77
    v_add_f32 v95, v95, v77
    v_mov_b32 v76, v94
    s_nop 1
    v_permlane32_swap_b32 v94, v76
    v_add_f32 v94, v94, v76
    v_mov_b32 v77, v95
    s_nop 1
    v_permlane32_swap_b32 v95, v77
    v_add_f32 v95, v95, v77
    v_lshlrev_b32 v28, 16, v216
    v_and_b32 v29, 0xffff0000, v216
    v_lshlrev_b32 v30, 16, v217
    v_and_b32 v31, 0xffff0000, v217
    v_lshlrev_b32 v32, 16, v218
    v_and_b32 v33, 0xffff0000, v218
    v_lshlrev_b32 v34, 16, v219
    v_and_b32 v35, 0xffff0000, v219
    v_lshlrev_b32 v36, 16, v220
    v_and_b32 v37, 0xffff0000, v220
    v_lshlrev_b32 v38, 16, v221
    v_and_b32 v39, 0xffff0000, v221
    v_lshlrev_b32 v40, 16, v222
    v_and_b32 v41, 0xffff0000, v222
    v_lshlrev_b32 v42, 16, v223
    v_and_b32 v43, 0xffff0000, v223
    s_mov_b32 s27, 0
adaLN_cond__sliding_block_cached__moe_arch_mod__prompt_kernel_a11p:
    buffer_load_dword v76, v20, s[8:11], s25 offen sc1
    s_waitcnt vmcnt(0)
    v_cmp_ne_u32 vcc, s28, v76
    s_add_u32 s27, s27, 1
    s_cmp_ge_u32 s27, 65536
    s_cbranch_scc1 adaLN_cond__sliding_block_cached__moe_arch_mod__prompt_kernel_a11g
    s_cbranch_vccnz adaLN_cond__sliding_block_cached__moe_arch_mod__prompt_kernel_a11p
adaLN_cond__sliding_block_cached__moe_arch_mod__prompt_kernel_a11g:
    buffer_load_dwordx4 v[44:47], v18, s[8:11], s18 offen sc1
    buffer_load_dwordx4 v[52:55], v19, s[8:11], s18 offen sc1
    buffer_load_dwordx4 v[48:51], v18, s[8:11], s19 offen sc1
    buffer_load_dwordx4 v[56:59], v19, s[8:11], s19 offen sc1
    v_lshlrev_b32 v21, 2, v0
    s_mov_b32 s16, 0x540800
    buffer_load_dword v106, v21, s[8:11], s16 offen sc1
    buffer_load_dword v104, v21, s[8:11], s16 offen offset:2048 sc1
    s_waitcnt vmcnt(5)
    v_lshlrev_b32 v76, 16, v44
    v_and_b32 v77, 0xffff0000, v44
    s_waitcnt vmcnt(4)
    v_lshlrev_b32 v78, 16, v52
    v_and_b32 v79, 0xffff0000, v52
    v_pk_add_f32 v[76:77], v[76:77], v[78:79]
    v_pk_add_f32 v[28:29], v[28:29], v[76:77]
    v_cvt_pk_bf16_f32 v16, v28, v29
    v_lshlrev_b32 v28, 16, v16
    v_and_b32 v29, 0xffff0000, v16
    v_lshlrev_b32 v80, 16, v45
    v_and_b32 v81, 0xffff0000, v45
    v_lshlrev_b32 v82, 16, v53
    v_and_b32 v83, 0xffff0000, v53
    v_pk_add_f32 v[80:81], v[80:81], v[82:83]
    v_pk_add_f32 v[30:31], v[30:31], v[80:81]
    v_cvt_pk_bf16_f32 v17, v30, v31
    v_lshlrev_b32 v30, 16, v17
    v_and_b32 v31, 0xffff0000, v17
    v_lshlrev_b32 v76, 16, v46
    v_and_b32 v77, 0xffff0000, v46
    v_lshlrev_b32 v78, 16, v54
    v_and_b32 v79, 0xffff0000, v54
    v_pk_add_f32 v[76:77], v[76:77], v[78:79]
    v_pk_add_f32 v[32:33], v[32:33], v[76:77]
    v_cvt_pk_bf16_f32 v16, v32, v33
    v_lshlrev_b32 v32, 16, v16
    v_and_b32 v33, 0xffff0000, v16
    v_lshlrev_b32 v80, 16, v47
    v_and_b32 v81, 0xffff0000, v47
    v_lshlrev_b32 v82, 16, v55
    v_and_b32 v83, 0xffff0000, v55
    v_pk_add_f32 v[80:81], v[80:81], v[82:83]
    v_pk_add_f32 v[34:35], v[34:35], v[80:81]
    v_cvt_pk_bf16_f32 v17, v34, v35
    v_lshlrev_b32 v34, 16, v17
    v_and_b32 v35, 0xffff0000, v17
    s_waitcnt vmcnt(3)
    v_lshlrev_b32 v76, 16, v48
    v_and_b32 v77, 0xffff0000, v48
    s_waitcnt vmcnt(2)
    v_lshlrev_b32 v78, 16, v56
    v_and_b32 v79, 0xffff0000, v56
    v_pk_add_f32 v[76:77], v[76:77], v[78:79]
    v_pk_add_f32 v[36:37], v[36:37], v[76:77]
    v_cvt_pk_bf16_f32 v16, v36, v37
    v_lshlrev_b32 v36, 16, v16
    v_and_b32 v37, 0xffff0000, v16
    v_lshlrev_b32 v80, 16, v49
    v_and_b32 v81, 0xffff0000, v49
    v_lshlrev_b32 v82, 16, v57
    v_and_b32 v83, 0xffff0000, v57
    v_pk_add_f32 v[80:81], v[80:81], v[82:83]
    v_pk_add_f32 v[38:39], v[38:39], v[80:81]
    v_cvt_pk_bf16_f32 v17, v38, v39
    v_lshlrev_b32 v38, 16, v17
    v_and_b32 v39, 0xffff0000, v17
    v_lshlrev_b32 v76, 16, v50
    v_and_b32 v77, 0xffff0000, v50
    v_lshlrev_b32 v78, 16, v58
    v_and_b32 v79, 0xffff0000, v58
    v_pk_add_f32 v[76:77], v[76:77], v[78:79]
    v_pk_add_f32 v[40:41], v[40:41], v[76:77]
    v_cvt_pk_bf16_f32 v16, v40, v41
    v_lshlrev_b32 v40, 16, v16
    v_and_b32 v41, 0xffff0000, v16
    v_lshlrev_b32 v80, 16, v51
    v_and_b32 v81, 0xffff0000, v51
    v_lshlrev_b32 v82, 16, v59
    v_and_b32 v83, 0xffff0000, v59
    v_pk_add_f32 v[80:81], v[80:81], v[82:83]
    v_pk_add_f32 v[42:43], v[42:43], v[80:81]
    v_cvt_pk_bf16_f32 v17, v42, v43
    v_lshlrev_b32 v42, 16, v17
    v_and_b32 v43, 0xffff0000, v17
    v_pk_add_f32 v[76:77], v[28:29], v[30:31]
    v_pk_mul_f32 v[78:79], v[28:29], v[28:29]
    v_pk_mul_f32 v[80:81], v[28:29], v[60:61]
    v_pk_fma_f32 v[78:79], v[30:31], v[30:31], v[78:79]
    v_pk_fma_f32 v[80:81], v[30:31], v[62:63], v[80:81]
    v_pk_add_f32 v[76:77], v[76:77], v[32:33]
    v_pk_fma_f32 v[78:79], v[32:33], v[32:33], v[78:79]
    v_pk_fma_f32 v[80:81], v[32:33], v[64:65], v[80:81]
    v_pk_add_f32 v[76:77], v[76:77], v[34:35]
    v_pk_fma_f32 v[78:79], v[34:35], v[34:35], v[78:79]
    v_pk_fma_f32 v[80:81], v[34:35], v[66:67], v[80:81]
    v_pk_add_f32 v[76:77], v[76:77], v[36:37]
    v_pk_fma_f32 v[78:79], v[36:37], v[36:37], v[78:79]
    v_pk_fma_f32 v[80:81], v[36:37], v[68:69], v[80:81]
    v_pk_add_f32 v[76:77], v[76:77], v[38:39]
    v_pk_fma_f32 v[78:79], v[38:39], v[38:39], v[78:79]
    v_pk_fma_f32 v[80:81], v[38:39], v[70:71], v[80:81]
    v_pk_add_f32 v[76:77], v[76:77], v[40:41]
    v_pk_fma_f32 v[78:79], v[40:41], v[40:41], v[78:79]
    v_pk_fma_f32 v[80:81], v[40:41], v[72:73], v[80:81]
    v_pk_add_f32 v[76:77], v[76:77], v[42:43]
    v_pk_fma_f32 v[78:79], v[42:43], v[42:43], v[78:79]
    v_pk_fma_f32 v[80:81], v[42:43], v[74:75], v[80:81]
    v_add_f32 v96, v76, v77
    v_add_f32 v97, v78, v79
    v_add_f32 v98, v80, v81
    v_add_f32_dpp v96, v96, v96 row_ror:1 row_mask:0xf bank_mask:0xf
    v_add_f32_dpp v97, v97, v97 row_ror:1 row_mask:0xf bank_mask:0xf
    v_add_f32_dpp v98, v98, v98 row_ror:1 row_mask:0xf bank_mask:0xf
    v_add_f32_dpp v96, v96, v96 row_ror:2 row_mask:0xf bank_mask:0xf
    v_add_f32_dpp v97, v97, v97 row_ror:2 row_mask:0xf bank_mask:0xf
    v_add_f32_dpp v98, v98, v98 row_ror:2 row_mask:0xf bank_mask:0xf
    v_add_f32_dpp v96, v96, v96 row_ror:4 row_mask:0xf bank_mask:0xf
    v_add_f32_dpp v97, v97, v97 row_ror:4 row_mask:0xf bank_mask:0xf
    v_add_f32_dpp v98, v98, v98 row_ror:4 row_mask:0xf bank_mask:0xf
    v_add_f32_dpp v96, v96, v96 row_ror:8 row_mask:0xf bank_mask:0xf
    v_add_f32_dpp v97, v97, v97 row_ror:8 row_mask:0xf bank_mask:0xf
    v_add_f32_dpp v98, v98, v98 row_ror:8 row_mask:0xf bank_mask:0xf
    v_mov_b32 v76, v96
    s_nop 1
    v_permlane16_swap_b32 v96, v76
    v_add_f32 v96, v96, v76
    v_mov_b32 v77, v97
    s_nop 1
    v_permlane16_swap_b32 v97, v77
    v_add_f32 v97, v97, v77
    v_mov_b32 v78, v98
    s_nop 1
    v_permlane16_swap_b32 v98, v78
    v_add_f32 v98, v98, v78
    v_mov_b32 v76, v96
    s_nop 1
    v_permlane32_swap_b32 v96, v76
    v_add_f32 v96, v96, v76
    v_mov_b32 v77, v97
    s_nop 1
    v_permlane32_swap_b32 v97, v77
    v_add_f32 v97, v97, v77
    v_mov_b32 v78, v98
    s_nop 1
    v_permlane32_swap_b32 v98, v78
    v_add_f32 v98, v98, v78
    v_mul_f32 v96, 0x3a800000, v96
    v_mul_f32 v97, 0x3a800000, v97
    v_fma_f32 v97, -v96, v96, v97
    v_max_f32 v97, 0, v97
    v_fma_f32 v98, -v96, v95, v98
    v_add_f32 v76, 0x3727c5ac, v97
    v_rsq_f32 v76, v76
    s_nop 0
    v_fma_f32 v27, v98, v76, v94
    v_cvt_pk_bf16_f32 v96, v96, v96
    v_lshlrev_b32 v96, 16, v96
    v_cvt_pk_bf16_f32 v97, v97, v97
    v_lshlrev_b32 v97, 16, v97
    v_add_f32 v97, 0x3727c5ac, v97
    v_cvt_pk_bf16_f32 v97, v97, v97
    v_lshlrev_b32 v97, 16, v97
    v_sqrt_f32 v98, v97
    s_nop 0
    v_cvt_pk_bf16_f32 v98, v98, v98
    v_lshlrev_b32 v98, 16, v98
    v_rcp_f32 v99, v98
    v_mov_b32 v25, v96
    v_mov_b32 v26, v98
    v_ashrrev_i32 v16, 31, v27
    v_or_b32 v16, 0x80000000, v16
    v_xor_b32 v24, v27, v16
    v_and_b32 v24, 0xfffff800, v24
    v_max_u32 v24, 0x800, v24
    s_sub_u32 s16, 2047, s14
    v_or_b32 v24, s16, v24
    s_lshl_b32 s16, s3, 4
    s_add_u32 s16, s16, 65536
    v_mov_b32 v16, s16
    ds_write_b128 v16, v[24:27]
    s_waitcnt lgkmcnt(0)
    s_barrier
    v_and_b32 v16, 7, v1
    v_lshlrev_b32 v16, 4, v16
    v_add_u32 v16, 65536, v16
    ds_read_b32 v76, v16
    s_waitcnt lgkmcnt(0)
    v_mov_b32 v77, v76
    s_nop 1
    v_max_u32_dpp v77, v77, v77 row_ror:1 row_mask:0xf bank_mask:0xf
    s_nop 1
    v_max_u32_dpp v77, v77, v77 row_ror:2 row_mask:0xf bank_mask:0xf
    s_nop 1
    v_max_u32_dpp v77, v77, v77 row_ror:4 row_mask:0xf bank_mask:0xf
    v_cmp_eq_u32 vcc, v76, v77
    s_ff1_i32_b64 s16, vcc
    s_lshl_b32 s16, s16, 4
    s_add_u32 s16, s16, 65536
    v_mov_b32 v16, s16
    ds_read_b128 v[24:27], v16
    s_lshl_b32 s16, s2, 4
    s_add_u32 s16, s16, 0x6e0000
    s_cmp_eq_u32 s3, 0
    s_cselect_b32 s16, s16, 0x7ffffff0
    v_mov_b32 v17, 0
    s_mov_b64 exec, 1
    s_waitcnt lgkmcnt(0)
    buffer_store_dwordx4 v[24:27], v17, s[8:11], s16 offen sc1
    s_mov_b64 exec, -1
    v_sub_f32 v44, v28, v96
    v_sub_f32 v45, v29, v96
    v_sub_f32 v46, v30, v96
    v_sub_f32 v47, v31, v96
    v_sub_f32 v48, v32, v96
    v_sub_f32 v49, v33, v96
    v_sub_f32 v50, v34, v96
    v_sub_f32 v51, v35, v96
    v_cvt_pk_bf16_f32 v16, v44, v45
    v_lshlrev_b32 v44, 16, v16
    v_and_b32 v45, 0xffff0000, v16
    v_cvt_pk_bf16_f32 v16, v46, v47
    v_lshlrev_b32 v46, 16, v16
    v_and_b32 v47, 0xffff0000, v16
    v_cvt_pk_bf16_f32 v16, v48, v49
    v_lshlrev_b32 v48, 16, v16
    v_and_b32 v49, 0xffff0000, v16
    v_cvt_pk_bf16_f32 v16, v50, v51
    v_lshlrev_b32 v50, 16, v16
    v_and_b32 v51, 0xffff0000, v16
    v_mul_f32 v52, v44, v99
    v_mul_f32 v53, v45, v99
    v_mul_f32 v54, v46, v99
    v_mul_f32 v55, v47, v99
    v_mul_f32 v56, v48, v99
    v_mul_f32 v57, v49, v99
    v_mul_f32 v58, v50, v99
    v_mul_f32 v59, v51, v99
    v_fma_f32 v44, -v52, v98, v44
    v_fma_f32 v45, -v53, v98, v45
    v_fma_f32 v46, -v54, v98, v46
    v_fma_f32 v47, -v55, v98, v47
    v_fma_f32 v48, -v56, v98, v48
    v_fma_f32 v49, -v57, v98, v49
    v_fma_f32 v50, -v58, v98, v50
    v_fma_f32 v51, -v59, v98, v51
    v_fma_f32 v44, v44, v99, v52
    v_fma_f32 v45, v45, v99, v53
    v_fma_f32 v46, v46, v99, v54
    v_fma_f32 v47, v47, v99, v55
    v_fma_f32 v48, v48, v99, v56
    v_fma_f32 v49, v49, v99, v57
    v_fma_f32 v50, v50, v99, v58
    v_fma_f32 v51, v51, v99, v59
    v_cvt_pk_bf16_f32 v16, v44, v45
    v_lshlrev_b32 v44, 16, v16
    v_and_b32 v45, 0xffff0000, v16
    v_cvt_pk_bf16_f32 v16, v46, v47
    v_lshlrev_b32 v46, 16, v16
    v_and_b32 v47, 0xffff0000, v16
    v_cvt_pk_bf16_f32 v16, v48, v49
    v_lshlrev_b32 v48, 16, v16
    v_and_b32 v49, 0xffff0000, v16
    v_cvt_pk_bf16_f32 v16, v50, v51
    v_lshlrev_b32 v50, 16, v16
    v_and_b32 v51, 0xffff0000, v16
    v_lshlrev_b32 v52, 16, v192
    v_and_b32 v53, 0xffff0000, v192
    v_lshlrev_b32 v54, 16, v193
    v_and_b32 v55, 0xffff0000, v193
    v_lshlrev_b32 v56, 16, v194
    v_and_b32 v57, 0xffff0000, v194
    v_lshlrev_b32 v58, 16, v195
    v_and_b32 v59, 0xffff0000, v195
    v_pk_mul_f32 v[44:45], v[44:45], v[52:53]
    v_pk_mul_f32 v[46:47], v[46:47], v[54:55]
    v_pk_mul_f32 v[48:49], v[48:49], v[56:57]
    v_pk_mul_f32 v[50:51], v[50:51], v[58:59]
    v_cvt_pk_bf16_f32 v16, v44, v45
    v_lshlrev_b32 v44, 16, v16
    v_and_b32 v45, 0xffff0000, v16
    v_cvt_pk_bf16_f32 v16, v46, v47
    v_lshlrev_b32 v46, 16, v16
    v_and_b32 v47, 0xffff0000, v16
    v_cvt_pk_bf16_f32 v16, v48, v49
    v_lshlrev_b32 v48, 16, v16
    v_and_b32 v49, 0xffff0000, v16
    v_cvt_pk_bf16_f32 v16, v50, v51
    v_lshlrev_b32 v50, 16, v16
    v_and_b32 v51, 0xffff0000, v16
    v_lshlrev_b32 v52, 16, v184
    v_and_b32 v53, 0xffff0000, v184
    v_lshlrev_b32 v54, 16, v185
    v_and_b32 v55, 0xffff0000, v185
    v_lshlrev_b32 v56, 16, v186
    v_and_b32 v57, 0xffff0000, v186
    v_lshlrev_b32 v58, 16, v187
    v_and_b32 v59, 0xffff0000, v187
    v_pk_add_f32 v[44:45], v[44:45], v[52:53]
    v_pk_add_f32 v[46:47], v[46:47], v[54:55]
    v_pk_add_f32 v[48:49], v[48:49], v[56:57]
    v_pk_add_f32 v[50:51], v[50:51], v[58:59]
    v_cvt_pk_bf16_f32 v16, v44, v45
    v_lshlrev_b32 v44, 16, v16
    v_and_b32 v45, 0xffff0000, v16
    v_cvt_pk_bf16_f32 v16, v46, v47
    v_lshlrev_b32 v46, 16, v16
    v_and_b32 v47, 0xffff0000, v16
    v_cvt_pk_bf16_f32 v16, v48, v49
    v_lshlrev_b32 v48, 16, v16
    v_and_b32 v49, 0xffff0000, v16
    v_cvt_pk_bf16_f32 v16, v50, v51
    v_lshlrev_b32 v50, 16, v16
    v_and_b32 v51, 0xffff0000, v16
    v_lshlrev_b32 v52, 16, v200
    v_and_b32 v53, 0xffff0000, v200
    v_lshlrev_b32 v54, 16, v201
    v_and_b32 v55, 0xffff0000, v201
    v_lshlrev_b32 v56, 16, v202
    v_and_b32 v57, 0xffff0000, v202
    v_lshlrev_b32 v58, 16, v203
    v_and_b32 v59, 0xffff0000, v203
    v_pk_mul_f32 v[44:45], v[44:45], v[52:53]
    v_pk_mul_f32 v[46:47], v[46:47], v[54:55]
    v_pk_mul_f32 v[48:49], v[48:49], v[56:57]
    v_pk_mul_f32 v[50:51], v[50:51], v[58:59]
    v_cvt_pk_bf16_f32 v16, v44, v45
    v_lshlrev_b32 v44, 16, v16
    v_and_b32 v45, 0xffff0000, v16
    v_cvt_pk_bf16_f32 v16, v46, v47
    v_lshlrev_b32 v46, 16, v16
    v_and_b32 v47, 0xffff0000, v16
    v_cvt_pk_bf16_f32 v16, v48, v49
    v_lshlrev_b32 v48, 16, v16
    v_and_b32 v49, 0xffff0000, v16
    v_cvt_pk_bf16_f32 v16, v50, v51
    v_lshlrev_b32 v50, 16, v16
    v_and_b32 v51, 0xffff0000, v16
    v_pk_add_f32 v[44:45], v[44:45], v[28:29]
    v_pk_add_f32 v[46:47], v[46:47], v[30:31]
    v_pk_add_f32 v[48:49], v[48:49], v[32:33]
    v_pk_add_f32 v[50:51], v[50:51], v[34:35]
    v_cvt_pk_bf16_f32 v28, v44, v45
    v_cvt_pk_bf16_f32 v29, v46, v47
    v_cvt_pk_bf16_f32 v30, v48, v49
    v_cvt_pk_bf16_f32 v31, v50, v51
    v_sub_f32 v44, v36, v96
    v_sub_f32 v45, v37, v96
    v_sub_f32 v46, v38, v96
    v_sub_f32 v47, v39, v96
    v_sub_f32 v48, v40, v96
    v_sub_f32 v49, v41, v96
    v_sub_f32 v50, v42, v96
    v_sub_f32 v51, v43, v96
    v_cvt_pk_bf16_f32 v16, v44, v45
    v_lshlrev_b32 v44, 16, v16
    v_and_b32 v45, 0xffff0000, v16
    v_cvt_pk_bf16_f32 v16, v46, v47
    v_lshlrev_b32 v46, 16, v16
    v_and_b32 v47, 0xffff0000, v16
    v_cvt_pk_bf16_f32 v16, v48, v49
    v_lshlrev_b32 v48, 16, v16
    v_and_b32 v49, 0xffff0000, v16
    v_cvt_pk_bf16_f32 v16, v50, v51
    v_lshlrev_b32 v50, 16, v16
    v_and_b32 v51, 0xffff0000, v16
    v_mul_f32 v52, v44, v99
    v_mul_f32 v53, v45, v99
    v_mul_f32 v54, v46, v99
    v_mul_f32 v55, v47, v99
    v_mul_f32 v56, v48, v99
    v_mul_f32 v57, v49, v99
    v_mul_f32 v58, v50, v99
    v_mul_f32 v59, v51, v99
    v_fma_f32 v44, -v52, v98, v44
    v_fma_f32 v45, -v53, v98, v45
    v_fma_f32 v46, -v54, v98, v46
    v_fma_f32 v47, -v55, v98, v47
    v_fma_f32 v48, -v56, v98, v48
    v_fma_f32 v49, -v57, v98, v49
    v_fma_f32 v50, -v58, v98, v50
    v_fma_f32 v51, -v59, v98, v51
    v_fma_f32 v44, v44, v99, v52
    v_fma_f32 v45, v45, v99, v53
    v_fma_f32 v46, v46, v99, v54
    v_fma_f32 v47, v47, v99, v55
    v_fma_f32 v48, v48, v99, v56
    v_fma_f32 v49, v49, v99, v57
    v_fma_f32 v50, v50, v99, v58
    v_fma_f32 v51, v51, v99, v59
    v_cvt_pk_bf16_f32 v16, v44, v45
    v_lshlrev_b32 v44, 16, v16
    v_and_b32 v45, 0xffff0000, v16
    v_cvt_pk_bf16_f32 v16, v46, v47
    v_lshlrev_b32 v46, 16, v16
    v_and_b32 v47, 0xffff0000, v16
    v_cvt_pk_bf16_f32 v16, v48, v49
    v_lshlrev_b32 v48, 16, v16
    v_and_b32 v49, 0xffff0000, v16
    v_cvt_pk_bf16_f32 v16, v50, v51
    v_lshlrev_b32 v50, 16, v16
    v_and_b32 v51, 0xffff0000, v16
    v_lshlrev_b32 v52, 16, v196
    v_and_b32 v53, 0xffff0000, v196
    v_lshlrev_b32 v54, 16, v197
    v_and_b32 v55, 0xffff0000, v197
    v_lshlrev_b32 v56, 16, v198
    v_and_b32 v57, 0xffff0000, v198
    v_lshlrev_b32 v58, 16, v199
    v_and_b32 v59, 0xffff0000, v199
    v_pk_mul_f32 v[44:45], v[44:45], v[52:53]
    v_pk_mul_f32 v[46:47], v[46:47], v[54:55]
    v_pk_mul_f32 v[48:49], v[48:49], v[56:57]
    v_pk_mul_f32 v[50:51], v[50:51], v[58:59]
    v_cvt_pk_bf16_f32 v16, v44, v45
    v_lshlrev_b32 v44, 16, v16
    v_and_b32 v45, 0xffff0000, v16
    v_cvt_pk_bf16_f32 v16, v46, v47
    v_lshlrev_b32 v46, 16, v16
    v_and_b32 v47, 0xffff0000, v16
    v_cvt_pk_bf16_f32 v16, v48, v49
    v_lshlrev_b32 v48, 16, v16
    v_and_b32 v49, 0xffff0000, v16
    v_cvt_pk_bf16_f32 v16, v50, v51
    v_lshlrev_b32 v50, 16, v16
    v_and_b32 v51, 0xffff0000, v16
    v_lshlrev_b32 v52, 16, v188
    v_and_b32 v53, 0xffff0000, v188
    v_lshlrev_b32 v54, 16, v189
    v_and_b32 v55, 0xffff0000, v189
    v_lshlrev_b32 v56, 16, v190
    v_and_b32 v57, 0xffff0000, v190
    v_lshlrev_b32 v58, 16, v191
    v_and_b32 v59, 0xffff0000, v191
    v_pk_add_f32 v[44:45], v[44:45], v[52:53]
    v_pk_add_f32 v[46:47], v[46:47], v[54:55]
    v_pk_add_f32 v[48:49], v[48:49], v[56:57]
    v_pk_add_f32 v[50:51], v[50:51], v[58:59]
    v_cvt_pk_bf16_f32 v16, v44, v45
    v_lshlrev_b32 v44, 16, v16
    v_and_b32 v45, 0xffff0000, v16
    v_cvt_pk_bf16_f32 v16, v46, v47
    v_lshlrev_b32 v46, 16, v16
    v_and_b32 v47, 0xffff0000, v16
    v_cvt_pk_bf16_f32 v16, v48, v49
    v_lshlrev_b32 v48, 16, v16
    v_and_b32 v49, 0xffff0000, v16
    v_cvt_pk_bf16_f32 v16, v50, v51
    v_lshlrev_b32 v50, 16, v16
    v_and_b32 v51, 0xffff0000, v16
    v_lshlrev_b32 v52, 16, v204
    v_and_b32 v53, 0xffff0000, v204
    v_lshlrev_b32 v54, 16, v205
    v_and_b32 v55, 0xffff0000, v205
    v_lshlrev_b32 v56, 16, v206
    v_and_b32 v57, 0xffff0000, v206
    v_lshlrev_b32 v58, 16, v207
    v_and_b32 v59, 0xffff0000, v207
    v_pk_mul_f32 v[44:45], v[44:45], v[52:53]
    v_pk_mul_f32 v[46:47], v[46:47], v[54:55]
    v_pk_mul_f32 v[48:49], v[48:49], v[56:57]
    v_pk_mul_f32 v[50:51], v[50:51], v[58:59]
    v_cvt_pk_bf16_f32 v16, v44, v45
    v_lshlrev_b32 v44, 16, v16
    v_and_b32 v45, 0xffff0000, v16
    v_cvt_pk_bf16_f32 v16, v46, v47
    v_lshlrev_b32 v46, 16, v16
    v_and_b32 v47, 0xffff0000, v16
    v_cvt_pk_bf16_f32 v16, v48, v49
    v_lshlrev_b32 v48, 16, v16
    v_and_b32 v49, 0xffff0000, v16
    v_cvt_pk_bf16_f32 v16, v50, v51
    v_lshlrev_b32 v50, 16, v16
    v_and_b32 v51, 0xffff0000, v16
    v_pk_add_f32 v[44:45], v[44:45], v[36:37]
    v_pk_add_f32 v[46:47], v[46:47], v[38:39]
    v_pk_add_f32 v[48:49], v[48:49], v[40:41]
    v_pk_add_f32 v[50:51], v[50:51], v[42:43]
    v_cvt_pk_bf16_f32 v36, v44, v45
    v_cvt_pk_bf16_f32 v37, v46, v47
    v_cvt_pk_bf16_f32 v38, v48, v49
    v_cvt_pk_bf16_f32 v39, v50, v51
    v_lshlrev_b32 v18, 4, v0
    s_mov_b32 s16, 0x6e0000
    s_mov_b32 s27, 0
adaLN_cond__sliding_block_cached__moe_arch_mod__prompt_kernel_w12p:
    buffer_load_dwordx4 v[24:27], v18, s[8:11], s16 offen sc1
    s_waitcnt vmcnt(0)
    v_cmp_eq_u32 vcc, 0, v24
    s_add_u32 s27, s27, 1
    s_cmp_ge_u32 s27, 65536
    s_cbranch_scc1 adaLN_cond__sliding_block_cached__moe_arch_mod__prompt_kernel_w12g
    s_cbranch_vccnz adaLN_cond__sliding_block_cached__moe_arch_mod__prompt_kernel_w12p
adaLN_cond__sliding_block_cached__moe_arch_mod__prompt_kernel_w12g:
    v_mov_b32 v76, v24
    s_nop 1
    v_max_u32_dpp v76, v76, v76 row_ror:1 row_mask:0xf bank_mask:0xf
    s_nop 1
    v_max_u32_dpp v76, v76, v76 row_ror:2 row_mask:0xf bank_mask:0xf
    s_nop 1
    v_max_u32_dpp v76, v76, v76 row_ror:4 row_mask:0xf bank_mask:0xf
    s_nop 1
    v_max_u32_dpp v76, v76, v76 row_ror:8 row_mask:0xf bank_mask:0xf
    v_mov_b32 v77, v76
    s_nop 1
    v_permlane16_swap_b32 v76, v77
    v_max_u32 v76, v76, v77
    v_mov_b32 v77, v76
    s_nop 1
    v_permlane32_swap_b32 v76, v77
    v_max_u32 v76, v76, v77
    v_cmp_eq_u32 vcc, v76, v24
    s_lshl_b32 s16, s3, 4
    s_add_u32 s16, s16, 65792
    v_mov_b32 v16, s16
    s_and_saveexec_b64 s[62:63], vcc
    ds_write_b128 v16, v[24:27]
    s_mov_b64 exec, s[62:63]
    s_waitcnt lgkmcnt(0)
    s_barrier
    v_and_b32 v16, 3, v1
    v_lshlrev_b32 v16, 4, v16
    v_add_u32 v16, 65792, v16
    ds_read_b32 v76, v16
    s_waitcnt lgkmcnt(0)
    v_mov_b32 v77, v76
    s_nop 1
    v_max_u32_dpp v77, v77, v77 row_ror:1 row_mask:0xf bank_mask:0xf
    s_nop 1
    v_max_u32_dpp v77, v77, v77 row_ror:2 row_mask:0xf bank_mask:0xf
    v_cmp_eq_u32 vcc, v76, v77
    s_ff1_i32_b64 s16, vcc
    s_lshl_b32 s16, s16, 4
    s_add_u32 s16, s16, 65792
    v_mov_b32 v16, s16
    ds_read_b128 v[24:27], v16
    s_waitcnt lgkmcnt(0)
    v_and_b32 v76, 0x7ff, v24
    v_sub_u32 v76, 2047, v76
    s_nop 0
    v_readfirstlane_b32 s12, v76
    v_rcp_f32 v103, v26
    s_lshr_b32 s18, s12, 4
    s_lshl_b32 s18, s18, 15
    s_and_b32 s19, s12, 15
    s_lshl_b32 s19, s19, 6
    s_add_u32 s18, s18, s19
    s_add_u32 s18, s18, 0x2000000
    s_add_u32 s19, s18, 0x400000
    v_lshrrev_b32 v18, 4, v0
    v_lshlrev_b32 v18, 10, v18
    v_and_b32 v19, 15, v0
    v_lshl_add_u32 v18, v19, 2, v18
    s_lshl_b32 s13, s12, 11
    buffer_load_dword v100, v18, s[8:11], s18 offen sc1
    buffer_load_dword v101, v18, s[8:11], s19 offen sc1
    buffer_load_dword v102, v21, s[76:79], s13 offen
    s_lshl_b32 s16, s14, 11
    s_cmp_lg_u32 s12, s14
    s_cselect_b32 s16, s16, 0x7ffffff0
    buffer_store_dwordx4 v[28:31], v2, s[68:71], s16 offen offset:0 sc1
    buffer_store_dwordx4 v[36:39], v2, s[68:71], s16 offen offset:1024 sc1
    s_lshl_b32 s16, s3, 13
    v_add_u32 v20, s16, v2
    s_waitcnt vmcnt(4)
    v_lshlrev_b32 v76, 16, v100
    v_and_b32 v77, 0xffff0000, v100
    s_waitcnt vmcnt(3)
    v_lshlrev_b32 v78, 16, v101
    v_and_b32 v79, 0xffff0000, v101
    v_pk_add_f32 v[76:77], v[76:77], v[78:79]
    s_waitcnt vmcnt(2)
    v_lshlrev_b32 v78, 16, v102
    v_and_b32 v79, 0xffff0000, v102
    v_pk_add_f32 v[92:93], v[78:79], v[76:77]
    v_cvt_pk_bf16_f32 v76, v92, v93
    v_lshlrev_b32 v92, 16, v76
    v_and_b32 v93, 0xffff0000, v76
    v_cvt_pk_bf16_f32 v100, v92, v93
    v_and_b32 v105, 0xffff0000, v104
    v_lshlrev_b32 v104, 16, v104
    v_and_b32 v107, 0xffff0000, v106
    v_lshlrev_b32 v106, 16, v106
    v_sub_f32 v92, v92, v25
    v_sub_f32 v93, v93, v25
    v_cvt_pk_bf16_f32 v76, v92, v93
    v_lshlrev_b32 v92, 16, v76
    v_and_b32 v93, 0xffff0000, v76
    v_mul_f32 v77, v92, v103
    v_fma_f32 v92, -v77, v26, v92
    v_fma_f32 v92, v92, v103, v77
    v_mul_f32 v77, v93, v103
    v_fma_f32 v93, -v77, v26, v93
    v_fma_f32 v93, v93, v103, v77
    v_cvt_pk_bf16_f32 v76, v92, v93
    v_lshlrev_b32 v92, 16, v76
    v_and_b32 v93, 0xffff0000, v76
    v_mul_f32 v92, v92, v104
    v_mul_f32 v93, v93, v105
    v_cvt_pk_bf16_f32 v76, v92, v93
    v_lshlrev_b32 v92, 16, v76
    v_and_b32 v93, 0xffff0000, v76
    v_add_f32 v92, v92, v106
    v_add_f32 v93, v93, v107
    v_cvt_pk_bf16_f32 v101, v92, v93
    v_add_u32 v16, 66560, v21
    ds_write_b32 v16, v101
    ds_write_b32 v16, v100 offset:2048
    s_waitcnt lgkmcnt(0)
    s_barrier
    ds_read_b128 v[60:63], v20 offset:0
    ds_read_b128 v[64:67], v20 offset:1024
    ds_read_b128 v[68:71], v20 offset:2048
    ds_read_b128 v[72:75], v20 offset:3072
    ds_read_b128 v[108:111], v20 offset:4096
    ds_read_b128 v[112:115], v20 offset:5120
    ds_read_b128 v[116:119], v20 offset:6144
    ds_read_b128 v[120:123], v20 offset:7168
    s_and_b32 s16, s3, 3
    s_lshl_b32 s16, s16, 7
    s_and_b32 s17, s29, 3
    s_lshl_b32 s17, s17, 9
    s_add_u32 s16, s16, s17
    s_add_u32 s16, s16, 66560
    v_lshrrev_b32 v16, 3, v1
    v_lshlrev_b32 v16, 4, v16
    v_add_u32 v16, s16, v16
    ds_read_b128 v[104:107], v16
    s_waitcnt lgkmcnt(0)
    v_lshlrev_b32 v76, 16, v104
    v_and_b32 v77, 0xffff, v104
    v_dot2_f32_bf16 v85, v60, v76, 0
    v_dot2_f32_bf16 v84, v60, v77, 0
    v_dot2_f32_bf16 v87, v61, v76, 0
    v_dot2_f32_bf16 v86, v61, v77, 0
    v_dot2_f32_bf16 v89, v62, v76, 0
    v_dot2_f32_bf16 v88, v62, v77, 0
    v_dot2_f32_bf16 v91, v63, v76, 0
    v_dot2_f32_bf16 v90, v63, v77, 0
    v_and_b32 v78, 0xffff0000, v104
    v_lshrrev_b32 v79, 16, v104
    v_dot2c_f32_bf16 v85, v64, v78
    v_dot2c_f32_bf16 v84, v64, v79
    v_dot2c_f32_bf16 v87, v65, v78
    v_dot2c_f32_bf16 v86, v65, v79
    v_dot2c_f32_bf16 v89, v66, v78
    v_dot2c_f32_bf16 v88, v66, v79
    v_dot2c_f32_bf16 v91, v67, v78
    v_dot2c_f32_bf16 v90, v67, v79
    v_lshlrev_b32 v80, 16, v105
    v_and_b32 v81, 0xffff, v105
    v_dot2c_f32_bf16 v85, v68, v80
    v_dot2c_f32_bf16 v84, v68, v81
    v_dot2c_f32_bf16 v87, v69, v80
    v_dot2c_f32_bf16 v86, v69, v81
    v_dot2c_f32_bf16 v89, v70, v80
    v_dot2c_f32_bf16 v88, v70, v81
    v_dot2c_f32_bf16 v91, v71, v80
    v_dot2c_f32_bf16 v90, v71, v81
    v_and_b32 v82, 0xffff0000, v105
    v_lshrrev_b32 v83, 16, v105
    v_dot2c_f32_bf16 v85, v72, v82
    v_dot2c_f32_bf16 v84, v72, v83
    v_dot2c_f32_bf16 v87, v73, v82
    v_dot2c_f32_bf16 v86, v73, v83
    v_dot2c_f32_bf16 v89, v74, v82
    v_dot2c_f32_bf16 v88, v74, v83
    v_dot2c_f32_bf16 v91, v75, v82
    v_dot2c_f32_bf16 v90, v75, v83
    v_lshlrev_b32 v76, 16, v106
    v_and_b32 v77, 0xffff, v106
    v_dot2c_f32_bf16 v85, v108, v76
    v_dot2c_f32_bf16 v84, v108, v77
    v_dot2c_f32_bf16 v87, v109, v76
    v_dot2c_f32_bf16 v86, v109, v77
    v_dot2c_f32_bf16 v89, v110, v76
    v_dot2c_f32_bf16 v88, v110, v77
    v_dot2c_f32_bf16 v91, v111, v76
    v_dot2c_f32_bf16 v90, v111, v77
    v_and_b32 v78, 0xffff0000, v106
    v_lshrrev_b32 v79, 16, v106
    v_dot2c_f32_bf16 v85, v112, v78
    v_dot2c_f32_bf16 v84, v112, v79
    v_dot2c_f32_bf16 v87, v113, v78
    v_dot2c_f32_bf16 v86, v113, v79
    v_dot2c_f32_bf16 v89, v114, v78
    v_dot2c_f32_bf16 v88, v114, v79
    v_dot2c_f32_bf16 v91, v115, v78
    v_dot2c_f32_bf16 v90, v115, v79
    v_lshlrev_b32 v80, 16, v107
    v_and_b32 v81, 0xffff, v107
    v_dot2c_f32_bf16 v85, v116, v80
    v_dot2c_f32_bf16 v84, v116, v81
    v_dot2c_f32_bf16 v87, v117, v80
    v_dot2c_f32_bf16 v86, v117, v81
    v_dot2c_f32_bf16 v89, v118, v80
    v_dot2c_f32_bf16 v88, v118, v81
    v_dot2c_f32_bf16 v91, v119, v80
    v_dot2c_f32_bf16 v90, v119, v81
    v_and_b32 v82, 0xffff0000, v107
    v_lshrrev_b32 v83, 16, v107
    v_dot2c_f32_bf16 v85, v120, v82
    v_dot2c_f32_bf16 v84, v120, v83
    v_dot2c_f32_bf16 v87, v121, v82
    v_dot2c_f32_bf16 v86, v121, v83
    v_dot2c_f32_bf16 v89, v122, v82
    v_dot2c_f32_bf16 v88, v122, v83
    v_dot2c_f32_bf16 v91, v123, v82
    v_dot2c_f32_bf16 v90, v123, v83
    s_nop 0
    v_permlane32_swap_b32 v84, v88
    v_permlane32_swap_b32 v85, v89
    v_permlane32_swap_b32 v86, v90
    v_permlane32_swap_b32 v87, v91
    v_add_f32 v84, v84, v88
    v_add_f32 v85, v85, v89
    v_add_f32 v86, v86, v90
    v_add_f32 v87, v87, v91
    s_nop 0
    v_permlane16_swap_b32 v84, v86
    v_permlane16_swap_b32 v85, v87
    v_add_f32 v84, v84, v86
    v_add_f32 v85, v85, v87
    s_nop 0
    v_add_f32_dpp v84, v84, v84 row_ror:8 row_mask:0xf bank_mask:0xf
    v_add_f32_dpp v85, v85, v85 row_ror:8 row_mask:0xf bank_mask:0xf
    v_and_b32 v16, 7, v1
    v_lshlrev_b32 v16, 5, v16
    v_lshrrev_b32 v17, 4, v1
    v_lshl_add_u32 v16, v17, 3, v16
    s_lshl_b32 s16, s3, 8
    s_add_u32 s16, s16, 70656
    v_add_u32 v16, s16, v16
    ds_write_b64 v16, v[84:85]
    s_lshr_b32 s16, s3, 2
    s_lshl_b32 s17, s16, 10
    s_add_u32 s17, s17, 70656
    v_lshlrev_b32 v17, 2, v1
    v_add_u32 v16, s17, v17
    s_and_b32 s17, s29, 3
    s_lshl_b32 s17, s17, 1
    s_add_u32 s17, s17, s16
    s_mul_i32 s17, s17, 14336
    s_lshr_b32 s16, s29, 2
    s_lshl_b32 s16, s16, 8
    s_add_u32 s17, s17, s16
    s_add_u32 s17, s17, 0x6e1000
    s_and_b32 s16, s3, 3
    s_cmp_eq_u32 s16, 0
    s_cselect_b32 s17, s17, 0x7ffffff0
    s_cmp_lt_u32 s2, 224
    s_cselect_b32 s17, s17, 0x7ffffff0
    s_waitcnt lgkmcnt(0)
    s_barrier
    ds_read_b32 v84, v16 offset:0
    ds_read_b32 v85, v16 offset:256
    ds_read_b32 v86, v16 offset:512
    ds_read_b32 v87, v16 offset:768
    s_waitcnt lgkmcnt(2)
    v_add_f32 v84, v84, v85
    s_waitcnt lgkmcnt(0)
    v_add_f32 v86, v86, v87
    v_add_f32 v84, v84, v86
    v_or_b32 v84, 1, v84
    buffer_store_dword v84, v17, s[8:11], s17 offen sc1
    s_barrier
    v_lshlrev_b32 v16, 3, v0
    v_add_u32 v17, 73728, v16
    ds_read_b64 v[84:85], v17 offset:0
    ds_read_b64 v[86:87], v17 offset:4096
    ds_read_b64 v[88:89], v17 offset:8192
    ds_read_b64 v[90:91], v17 offset:12288
    s_waitcnt lgkmcnt(2)
    v_pk_add_f32 v[84:85], v[84:85], v[86:87]
    s_waitcnt lgkmcnt(0)
    v_pk_add_f32 v[88:89], v[88:89], v[90:91]
    v_pk_add_f32 v[84:85], v[84:85], v[88:89]
    v_or_b32 v84, 1, v84
    v_or_b32 v85, 1, v85
    s_lshl_b32 s16, s29, 12
    s_add_u32 s16, s16, 0x600000
    s_cmp_lt_u32 s2, 224
    s_cselect_b32 s16, s16, 0x7ffffff0
    buffer_store_dwordx2 v[84:85], v16, s[8:11], s16 offen sc1
    s_cmp_lt_u32 s2, 224
    s_cbranch_scc1 adaLN_cond__sliding_block_cached__moe_arch_mod__prompt_kernel_end
    s_sub_u32 s16, s2, 224
    s_lshl_b32 s17, s16, 7
    s_add_u32 s17, s17, 0x600000
    v_lshrrev_b32 v16, 3, v0
    v_lshlrev_b32 v16, 12, v16
    v_and_b32 v17, 7, v0
    v_lshl_add_u32 v16, v17, 4, v16
    v_cmp_gt_u32 vcc, 256, v0
    v_bfrev_b32 v17, -2
    s_nop 0
    v_cndmask_b32 v17, v17, v16, vcc
    v_mov_b32 v19, 0
    v_cndmask_b32 v18, 1, v19, vcc
    s_lshl_b32 s18, s16, 6
    v_and_b32 v19, 31, v1
    v_lshlrev_b32 v19, 1, v19
    v_add_u32 v19, s18, v19
    s_mov_b32 s19, 0x541800
    buffer_load_ushort v95, v19, s[8:11], s19 offen sc1
    v_add_u32 v20, 66560, v19
    ds_read_u16 v96, v20
    ds_read_u16 v97, v20 offset:2048
    v_mov_b32 v94, v27
    v_cvt_pk_bf16_f32 v94, v94, v94
    v_lshlrev_b32 v94, 16, v94
    v_mul_f32 v94, 0xbfb8aa3b, v94
    v_exp_f32 v94, v94
    s_nop 0
    v_add_f32 v94, 1.0, v94
    v_rcp_f32 v94, v94
    s_nop 0
    v_cvt_pk_bf16_f32 v94, v94, v94
    v_lshlrev_b32 v94, 16, v94
    s_waitcnt vmcnt(0)
    v_lshlrev_b32 v95, 16, v95
    s_waitcnt lgkmcnt(1)
    v_lshlrev_b32 v96, 16, v96
    s_waitcnt lgkmcnt(0)
    v_lshlrev_b32 v97, 16, v97
    s_mov_b32 s27, 0
adaLN_cond__sliding_block_cached__moe_arch_mod__prompt_kernel_y13p:
    s_add_u32 s19, s17, 0x0
    buffer_load_dwordx4 v[44:47], v16, s[8:11], s19 offen sc1
    s_add_u32 s19, s17, 0x40000
    buffer_load_dwordx4 v[48:51], v16, s[8:11], s19 offen sc1
    s_add_u32 s19, s17, 0x80000
    buffer_load_dwordx4 v[52:55], v16, s[8:11], s19 offen sc1
    s_add_u32 s19, s17, 0xc0000
    buffer_load_dwordx4 v[56:59], v17, s[8:11], s19 offen sc1
    s_waitcnt vmcnt(0)
    v_min3_u32 v98, v56, v57, v58
    v_min_u32 v98, v98, v59
    v_or_b32 v98, v98, v18
    v_min3_u32 v98, v98, v44, v45
    v_min3_u32 v98, v98, v46, v47
    v_min3_u32 v98, v98, v48, v49
    v_min3_u32 v98, v98, v50, v51
    v_min3_u32 v98, v98, v52, v53
    v_min3_u32 v98, v98, v54, v55
    v_cmp_eq_u32 vcc, 0, v98
    s_add_u32 s27, s27, 1
    s_cmp_ge_u32 s27, 65536
    s_cbranch_scc1 adaLN_cond__sliding_block_cached__moe_arch_mod__prompt_kernel_y13g
    s_cbranch_vccnz adaLN_cond__sliding_block_cached__moe_arch_mod__prompt_kernel_y13p
adaLN_cond__sliding_block_cached__moe_arch_mod__prompt_kernel_y13g:
    v_pk_add_f32 v[44:45], v[44:45], v[52:53]
    v_pk_add_f32 v[46:47], v[46:47], v[54:55]
    v_pk_add_f32 v[48:49], v[48:49], v[56:57]
    v_pk_add_f32 v[50:51], v[50:51], v[58:59]
    v_pk_add_f32 v[44:45], v[44:45], v[48:49]
    v_pk_add_f32 v[46:47], v[46:47], v[50:51]
    s_nop 0
    v_add_f32_dpp v44, v44, v44 row_ror:8 row_mask:0xf bank_mask:0xf
    v_add_f32_dpp v45, v45, v45 row_ror:8 row_mask:0xf bank_mask:0xf
    v_add_f32_dpp v46, v46, v46 row_ror:8 row_mask:0xf bank_mask:0xf
    v_add_f32_dpp v47, v47, v47 row_ror:8 row_mask:0xf bank_mask:0xf
    s_nop 0
    v_permlane32_swap_b32 v44, v46
    v_permlane32_swap_b32 v45, v47
    v_add_f32 v44, v44, v46
    v_add_f32 v45, v45, v47
    s_nop 1
    v_permlane16_swap_b32 v44, v45
    v_add_f32 v44, v44, v45
    v_and_b32 v16, 7, v1
    v_lshlrev_b32 v16, 4, v16
    v_lshrrev_b32 v17, 4, v1
    v_lshl_add_u32 v16, v17, 2, v16
    s_lshl_b32 s19, s3, 7
    s_add_u32 s19, s19, 91136
    v_add_u32 v16, s19, v16
    ds_write_b32 v16, v44
    v_and_b32 v16, 31, v1
    v_lshlrev_b32 v16, 2, v16
    v_add_u32 v16, 91136, v16
    s_waitcnt lgkmcnt(0)
    s_barrier
    s_cmp_lg_u32 s3, 0
    s_cbranch_scc1 adaLN_cond__sliding_block_cached__moe_arch_mod__prompt_kernel_end
    ds_read_b32 v44, v16 offset:0
    ds_read_b32 v45, v16 offset:128
    ds_read_b32 v46, v16 offset:256
    ds_read_b32 v47, v16 offset:384
    ds_read_b32 v48, v16 offset:512
    ds_read_b32 v49, v16 offset:640
    ds_read_b32 v50, v16 offset:768
    ds_read_b32 v51, v16 offset:896
    s_waitcnt lgkmcnt(3)
    v_add_f32 v44, v44, v48
    s_waitcnt lgkmcnt(2)
    v_add_f32 v45, v45, v49
    s_waitcnt lgkmcnt(1)
    v_add_f32 v46, v46, v50
    s_waitcnt lgkmcnt(0)
    v_add_f32 v47, v47, v51
    v_add_f32 v44, v44, v46
    v_add_f32 v45, v45, v47
    v_add_f32 v44, v44, v45
    v_cvt_pk_bf16_f32 v44, v44, v44
    v_lshlrev_b32 v44, 16, v44
    v_mul_f32 v44, v44, v94
    v_cvt_pk_bf16_f32 v44, v44, v44
    v_lshlrev_b32 v44, 16, v44
    v_add_f32 v44, v44, v96
    v_cvt_pk_bf16_f32 v44, v44, v44
    v_lshlrev_b32 v44, 16, v44
    v_mul_f32 v44, v44, v95
    v_cvt_pk_bf16_f32 v44, v44, v44
    v_lshlrev_b32 v44, 16, v44
    v_add_f32 v44, v44, v97
    v_cvt_pk_bf16_f32 v44, v44, v44
    s_mov_b64 exec, 0xffffffff
    buffer_store_short v44, v19, s[68:71], s13 offen sc1
    s_branch adaLN_cond__sliding_block_cached__moe_arch_mod__prompt_kernel_end
adaLN_cond__sliding_block_cached__moe_arch_mod__prompt_kernel_roleB:
    v_mov_b32 v132, 0
    v_mov_b32 v133, 0
    v_lshrrev_b32 v16, 3, v0
    v_and_b32 v17, 7, v0
    v_mul_u32_u24 v135, 24576, v16
    v_lshl_add_u32 v135, v17, 4, v135
    v_lshlrev_b32 v136, 2, v16
    s_and_b32 s14, s2, 31
    s_lshr_b32 s15, s2, 5
    s_mul_i32 s26, s15, 1572864
    s_lshl_b32 s16, s14, 7
    s_add_u32 s26, s26, s16
    s_lshl_b32 s29, s15, 8
    v_lshlrev_b32 v137, 3, v0
    s_lshl_b32 s18, s2, 3
    s_add_u32 s18, s18, s3
    s_lshl_b32 s18, s18, 11
    v_and_b32 v18, 15, v1
    v_lshrrev_b32 v19, 4, v1
    v_lshlrev_b32 v138, 11, v18
    v_lshl_add_u32 v138, v19, 4, v138
    s_lshr_b32 s30, s2, 4
    s_and_b32 s31, s2, 15
    s_lshl_b32 s19, s30, 3
    s_add_u32 s19, s19, s3
    s_lshl_b32 s22, s19, 15
    s_lshl_b32 s23, s31, 7
    s_add_u32 s22, s22, s23
    s_lshl_b32 s23, s2, 12
    s_add_u32 s23, s23, 0x600000
    s_or_b32 s25, s2, s3
    s_cmp_eq_u32 s25, 0
    s_cselect_b32 s25, 0, 0x7ffffff0
    s_waitcnt lgkmcnt(0)
    s_mov_b64 s[64:65], s[58:59]
    s_mov_b32 s66, 0x100
    s_mov_b32 s67, 0x20000
    s_or_b32 s28, s62, 1
    v_mov_b32 v134, s28
    s_mov_b64 exec, 1
    buffer_store_dword v134, v132, s[64:67], s25 offen sc1
    s_mov_b64 exec, -1
    s_mov_b64 s[68:69], s[52:53]
    s_mov_b32 s70, 0x800
    s_mov_b32 s71, 0x20000
    s_mov_b64 s[72:73], s[54:55]
    s_mov_b32 s74, 0xc00000
    s_mov_b32 s75, 0x20000
    s_mov_b64 s[76:77], s[32:33]
    s_mov_b32 s78, 0x400000
    s_mov_b32 s79, 0x20000
    s_mov_b64 s[8:9], s[60:61]
    s_mov_b32 s10, 0x3400000
    s_mov_b32 s11, 0x20000
    buffer_load_dwordx4 v[32:35], v2, s[76:79], s18 offen offset:0
    buffer_load_dwordx4 v[36:39], v2, s[76:79], s18 offen offset:1024
    buffer_load_dword v72, v136, s[68:71], s29 offen
    buffer_load_dwordx4 v[24:27], v135, s[72:75], s26 offen
    s_add_u32 s26, s26, 12288
    buffer_load_dwordx4 v[28:31], v135, s[72:75], s26 offen
    buffer_store_dwordx2 v[132:133], v137, s[8:11], s23 offen sc1
    s_barrier
    buffer_load_dwordx4 v[40:43], v138, s[76:79], s22 offen offset:0
    buffer_load_dwordx4 v[44:47], v138, s[76:79], s22 offen offset:64
    s_mov_b32 s29, s19
    s_mov_b64 s[64:65], s[34:35]
    s_mov_b32 s66, 0x200000
    s_mov_b32 s67, 0x20000
    s_mov_b64 s[68:69], s[36:37]
    s_mov_b32 s70, 0x200000
    s_mov_b32 s71, 0x20000
    s_lshl_b32 s20, s2, 2
    s_add_u32 s20, s20, s3
    s_sub_u32 s20, s20, 4
    s_lshr_b32 s22, s20, 8
    s_bfe_u32 s23, s20, 0x40004
    s_and_b32 s24, s20, 15
    s_lshl_b32 s25, s22, 19
    s_lshl_b32 s26, s23, 13
    s_add_u32 s25, s25, s26
    s_add_u32 s25, s25, 393216
    v_and_b32 v16, 15, v1
    v_lshrrev_b32 v17, 4, v1
    s_lshl_b32 s21, s22, 17
    s_cmp_ge_u32 s24, 8
    s_cbranch_scc1 adaLN_cond__sliding_block_cached__moe_arch_mod__prompt_kernel_kvV
    v_lshlrev_b32 v18, 8, v16
    v_lshl_add_u32 v18, v17, 3, v18
    s_and_b32 s26, s24, 1
    s_lshl_b32 s26, s26, 12
    s_add_u32 s25, s25, s26
    s_lshr_b32 s26, s24, 1
    s_lshl_b32 s26, s26, 6
    s_add_u32 s25, s25, s26
    buffer_load_dwordx2 v[84:85], v18, s[64:67], s25 offen
    buffer_load_dwordx2 v[86:87], v18, s[64:67], s25 offen offset:32
    s_mov_b32 s26, 0x7ffffff0
    buffer_load_ushort v88, v18, s[64:67], s26 offen
    buffer_load_ushort v89, v18, s[64:67], s26 offen
    buffer_load_ushort v90, v18, s[64:67], s26 offen
    buffer_load_ushort v91, v18, s[64:67], s26 offen
    buffer_load_ushort v92, v18, s[64:67], s26 offen
    buffer_load_ushort v93, v18, s[64:67], s26 offen
    s_lshl_b32 s26, s23, 13
    s_add_u32 s21, s21, s26
    s_lshl_b32 s26, s24, 10
    s_add_u32 s21, s21, s26
    s_add_u32 s21, s21, 0x400000
    s_branch adaLN_cond__sliding_block_cached__moe_arch_mod__prompt_kernel_kvJ
adaLN_cond__sliding_block_cached__moe_arch_mod__prompt_kernel_kvV:
    s_bfe_u32 s26, s24, 0x20001
    s_lshl_b32 s26, s26, 6
    s_add_u32 s25, s25, s26
    s_and_b32 s26, s24, 1
    s_lshl_b32 s26, s26, 3
    s_add_u32 s25, s25, s26
    s_add_u32 s26, s25, 4096
    v_lshrrev_b32 v18, 2, v16
    v_lshlrev_b32 v18, 4, v18
    v_and_b32 v19, 3, v16
    v_lshl_add_u32 v18, v19, 1, v18
    v_lshl_add_u32 v18, v17, 10, v18
    buffer_load_ushort v88, v18, s[68:71], s25 offen offset:0
    buffer_load_ushort v89, v18, s[68:71], s25 offen offset:256
    buffer_load_ushort v90, v18, s[68:71], s25 offen offset:512
    buffer_load_ushort v91, v18, s[68:71], s25 offen offset:768
    buffer_load_ushort v92, v18, s[68:71], s26 offen offset:0
    buffer_load_ushort v93, v18, s[68:71], s26 offen offset:256
    buffer_load_ushort v94, v18, s[68:71], s26 offen offset:512
    buffer_load_ushort v95, v18, s[68:71], s26 offen offset:768
    s_bfe_u32 s26, s24, 0x20001
    s_lshl_b32 s26, s26, 15
    s_add_u32 s21, s21, s26
    s_lshl_b32 s26, s23, 11
    s_add_u32 s21, s21, s26
    s_and_b32 s26, s24, 1
    s_lshl_b32 s26, s26, 10
    s_add_u32 s21, s21, s26
    s_add_u32 s21, s21, 0x480000
adaLN_cond__sliding_block_cached__moe_arch_mod__prompt_kernel_kvJ:
    s_waitcnt vmcnt(15)
    v_lshlrev_b32 v56, 16, v32
    v_and_b32 v57, 0xffff0000, v32
    v_lshlrev_b32 v58, 16, v33
    v_and_b32 v59, 0xffff0000, v33
    v_lshlrev_b32 v60, 16, v34
    v_and_b32 v61, 0xffff0000, v34
    v_lshlrev_b32 v62, 16, v35
    v_and_b32 v63, 0xffff0000, v35
    s_waitcnt vmcnt(14)
    v_lshlrev_b32 v64, 16, v36
    v_and_b32 v65, 0xffff0000, v36
    v_lshlrev_b32 v66, 16, v37
    v_and_b32 v67, 0xffff0000, v37
    v_lshlrev_b32 v68, 16, v38
    v_and_b32 v69, 0xffff0000, v38
    v_lshlrev_b32 v70, 16, v39
    v_and_b32 v71, 0xffff0000, v39
    v_add_f32 v20, v56, v57
    v_add_f32 v21, v58, v59
    v_add_f32 v20, v20, v60
    v_add_f32 v21, v21, v61
    v_add_f32 v20, v20, v62
    v_add_f32 v21, v21, v63
    v_add_f32 v20, v20, v64
    v_add_f32 v21, v21, v65
    v_add_f32 v20, v20, v66
    v_add_f32 v21, v21, v67
    v_add_f32 v20, v20, v68
    v_add_f32 v21, v21, v69
    v_add_f32 v20, v20, v70
    v_add_f32 v21, v21, v71
    v_add_f32 v128, v20, v21
    s_nop 1
    v_add_f32_dpp v128, v128, v128 row_ror:1 row_mask:0xf bank_mask:0xf
    s_nop 1
    v_add_f32_dpp v128, v128, v128 row_ror:2 row_mask:0xf bank_mask:0xf
    s_nop 1
    v_add_f32_dpp v128, v128, v128 row_ror:4 row_mask:0xf bank_mask:0xf
    s_nop 1
    v_add_f32_dpp v128, v128, v128 row_ror:8 row_mask:0xf bank_mask:0xf
    v_mov_b32 v20, v128
    s_nop 1
    v_permlane16_swap_b32 v128, v20
    v_add_f32 v128, v128, v20
    v_mov_b32 v20, v128
    s_nop 1
    v_permlane32_swap_b32 v128, v20
    v_add_f32 v128, v128, v20
    v_mul_f32 v128, 0x3a800000, v128
    v_sub_f32 v18, v56, v128
    v_mul_f32 v20, v18, v18
    v_sub_f32 v19, v57, v128
    v_mul_f32 v21, v19, v19
    v_sub_f32 v18, v58, v128
    v_sub_f32 v19, v59, v128
    v_fmac_f32 v20, v18, v18
    v_fmac_f32 v21, v19, v19
    v_sub_f32 v18, v60, v128
    v_sub_f32 v19, v61, v128
    v_fmac_f32 v20, v18, v18
    v_fmac_f32 v21, v19, v19
    v_sub_f32 v18, v62, v128
    v_sub_f32 v19, v63, v128
    v_fmac_f32 v20, v18, v18
    v_fmac_f32 v21, v19, v19
    v_sub_f32 v18, v64, v128
    v_sub_f32 v19, v65, v128
    v_fmac_f32 v20, v18, v18
    v_fmac_f32 v21, v19, v19
    v_sub_f32 v18, v66, v128
    v_sub_f32 v19, v67, v128
    v_fmac_f32 v20, v18, v18
    v_fmac_f32 v21, v19, v19
    v_sub_f32 v18, v68, v128
    v_sub_f32 v19, v69, v128
    v_fmac_f32 v20, v18, v18
    v_fmac_f32 v21, v19, v19
    v_sub_f32 v18, v70, v128
    v_sub_f32 v19, v71, v128
    v_fmac_f32 v20, v18, v18
    v_fmac_f32 v21, v19, v19
    v_add_f32 v17, v20, v21
    s_nop 1
    v_add_f32_dpp v17, v17, v17 row_ror:1 row_mask:0xf bank_mask:0xf
    s_nop 1
    v_add_f32_dpp v17, v17, v17 row_ror:2 row_mask:0xf bank_mask:0xf
    s_nop 1
    v_add_f32_dpp v17, v17, v17 row_ror:4 row_mask:0xf bank_mask:0xf
    s_nop 1
    v_add_f32_dpp v17, v17, v17 row_ror:8 row_mask:0xf bank_mask:0xf
    v_mov_b32 v20, v17
    s_nop 1
    v_permlane16_swap_b32 v17, v20
    v_add_f32 v17, v17, v20
    v_mov_b32 v20, v17
    s_nop 1
    v_permlane32_swap_b32 v17, v20
    v_add_f32 v17, v17, v20
    v_mul_f32 v17, 0x3a800000, v17
    v_cvt_pk_bf16_f32 v128, v128, v128
    v_lshlrev_b32 v128, 16, v128
    v_cvt_pk_bf16_f32 v17, v17, v17
    v_lshlrev_b32 v17, 16, v17
    v_add_f32 v17, 0x3727c5ac, v17
    v_cvt_pk_bf16_f32 v17, v17, v17
    v_lshlrev_b32 v17, 16, v17
    v_sqrt_f32 v129, v17
    s_nop 0
    v_cvt_pk_bf16_f32 v129, v129, v129
    v_lshlrev_b32 v129, 16, v129
    v_rcp_f32 v130, v129
    s_lshl_b32 s16, s3, 4
    s_add_u32 s16, s16, 149520
    v_mov_b32 v19, s16
    ds_write_b128 v19, v[128:131]
    s_waitcnt vmcnt(13)
    v_and_b32 v73, 0xffff0000, v72
    v_lshlrev_b32 v72, 16, v72
    v_mul_f32 v16, 0xbfb8aa3b, v72
    v_exp_f32 v16, v16
    s_nop 0
    v_add_f32 v16, 1.0, v16
    v_rcp_f32 v16, v16
    s_nop 0
    v_mul_f32 v72, v72, v16
    v_mul_f32 v17, 0xbfb8aa3b, v73
    v_exp_f32 v17, v17
    s_nop 0
    v_add_f32 v17, 1.0, v17
    v_rcp_f32 v17, v17
    s_nop 0
    v_mul_f32 v73, v73, v17
    v_cvt_pk_bf16_f32 v16, v72, v73
    v_lshlrev_b32 v72, 16, v16
    v_and_b32 v73, 0xffff0000, v16
    s_lshl_b32 s16, s2, 8
    s_add_u32 s16, s16, 0x550000
    s_mov_b32 exec_lo, 0x01010101
    s_mov_b32 exec_hi, 0x01010101
    buffer_store_dword v16, v136, s[8:11], s16 offen sc1
    s_mov_b64 exec, -1
    v_lshrrev_b32 v74, 16, v72
    v_lshrrev_b32 v75, 16, v73
    s_waitcnt vmcnt(13)
    v_dot2_f32_bf16 v49, v24, v72, 0
    v_dot2_f32_bf16 v48, v24, v74, 0
    v_dot2_f32_bf16 v51, v25, v72, 0
    v_dot2_f32_bf16 v50, v25, v74, 0
    v_dot2_f32_bf16 v53, v26, v72, 0
    v_dot2_f32_bf16 v52, v26, v74, 0
    v_dot2_f32_bf16 v55, v27, v72, 0
    v_dot2_f32_bf16 v54, v27, v74, 0
    s_waitcnt vmcnt(12)
    v_dot2c_f32_bf16 v49, v28, v73
    v_dot2c_f32_bf16 v48, v28, v75
    v_dot2c_f32_bf16 v51, v29, v73
    v_dot2c_f32_bf16 v50, v29, v75
    v_dot2c_f32_bf16 v53, v30, v73
    v_dot2c_f32_bf16 v52, v30, v75
    v_dot2c_f32_bf16 v55, v31, v73
    v_dot2c_f32_bf16 v54, v31, v75
    s_nop 0
    v_permlane32_swap_b32 v48, v52
    v_permlane32_swap_b32 v49, v53
    v_permlane32_swap_b32 v50, v54
    v_permlane32_swap_b32 v51, v55
    v_add_f32 v48, v48, v52
    v_add_f32 v49, v49, v53
    v_add_f32 v50, v50, v54
    v_add_f32 v51, v51, v55
    s_nop 0
    v_permlane16_swap_b32 v48, v50
    v_permlane16_swap_b32 v49, v51
    v_add_f32 v48, v48, v50
    v_add_f32 v49, v49, v51
    s_nop 0
    v_add_f32_dpp v48, v48, v48 row_ror:8 row_mask:0xf bank_mask:0xf
    v_add_f32_dpp v49, v49, v49 row_ror:8 row_mask:0xf bank_mask:0xf
    v_and_b32 v16, 7, v1
    v_lshlrev_b32 v16, 5, v16
    v_lshrrev_b32 v17, 4, v1
    v_lshl_add_u32 v16, v17, 3, v16
    s_lshl_b32 s16, s3, 8
    s_add_u32 s16, s16, 147456
    v_add_u32 v16, s16, v16
    ds_write_b64 v16, v[48:49]
    v_mov_b32 v19, 149504
    v_and_b32 v17, 31, v1
    v_lshlrev_b32 v18, 3, v17
    v_add_u32 v18, 147456, v18
    v_lshlrev_b32 v17, 4, v17
    s_waitcnt lgkmcnt(0)
    s_barrier
    ds_read_b32 v134, v19
    ds_read_b64 v[96:97], v18 offset:0
    ds_read_b64 v[100:101], v18 offset:256
    ds_read_b64 v[104:105], v18 offset:512
    ds_read_b64 v[108:109], v18 offset:768
    ds_read_b64 v[112:113], v18 offset:1024
    ds_read_b64 v[116:117], v18 offset:1280
    ds_read_b64 v[120:121], v18 offset:1536
    ds_read_b64 v[124:125], v18 offset:1792
    s_waitcnt lgkmcnt(8)
    v_readfirstlane_b32 s28, v134
    v_and_b32 v20, 7, v1
    v_lshlrev_b32 v20, 4, v20
    v_add_u32 v21, 149520, v20
    ds_read_b128 v[128:131], v21
    s_waitcnt lgkmcnt(0)
    v_mov_b32 v131, s28
    s_lshl_b32 s16, s2, 7
    s_add_u32 s16, s16, 0x520000
    s_cmp_eq_u32 s3, 0
    s_cselect_b32 s16, s16, 0x7ffffff0
    s_mov_b64 exec, 0xff
    buffer_store_dwordx4 v[128:131], v20, s[8:11], s16 offen sc1
    s_mov_b64 exec, -1
    v_pk_add_f32 v[96:97], v[96:97], v[112:113]
    v_pk_add_f32 v[100:101], v[100:101], v[116:117]
    v_pk_add_f32 v[104:105], v[104:105], v[120:121]
    v_pk_add_f32 v[108:109], v[108:109], v[124:125]
    v_pk_add_f32 v[96:97], v[96:97], v[104:105]
    v_pk_add_f32 v[100:101], v[100:101], v[108:109]
    v_pk_add_f32 v[96:97], v[96:97], v[100:101]
    v_mov_b32 v98, s28
    v_mov_b32 v99, s28
    s_lshl_b32 s16, s14, 3
    s_add_u32 s16, s16, s15
    s_lshl_b32 s16, s16, 9
    s_add_u32 s16, s16, 0x500000
    s_cmp_eq_u32 s3, 0
    s_cselect_b32 s16, s16, 0x7ffffff0
    s_mov_b64 exec, 0xffffffff
    buffer_store_dwordx4 v[96:99], v17, s[8:11], s16 offen sc1
    s_mov_b64 exec, -1
    s_lshr_b32 s16, s3, 2
    s_lshl_b32 s16, s16, 4
    s_add_u32 s16, s16, s31
    s_lshl_b32 s16, s16, 12
    s_and_b32 s17, s3, 3
    s_lshl_b32 s17, s17, 7
    s_add_u32 s16, s16, s17
    s_add_u32 s16, s16, 0x500000
    v_lshrrev_b32 v139, 3, v1
    v_lshlrev_b32 v139, 9, v139
    v_and_b32 v16, 7, v1
    v_lshl_add_u32 v139, v16, 4, v139
    v_and_b32 v140, 15, v1
    v_lshlrev_b32 v140, 4, v140
    s_lshl_b32 s17, s29, 8
    s_add_u32 s17, s17, 0x520000
    s_waitcnt vmcnt(12)
    v_lshlrev_b32 v56, 16, v40
    v_and_b32 v57, 0xffff0000, v40
    v_lshlrev_b32 v58, 16, v41
    v_and_b32 v59, 0xffff0000, v41
    v_lshlrev_b32 v60, 16, v42
    v_and_b32 v61, 0xffff0000, v42
    v_lshlrev_b32 v62, 16, v43
    v_and_b32 v63, 0xffff0000, v43
    s_waitcnt vmcnt(11)
    v_lshlrev_b32 v64, 16, v44
    v_and_b32 v65, 0xffff0000, v44
    v_lshlrev_b32 v66, 16, v45
    v_and_b32 v67, 0xffff0000, v45
    v_lshlrev_b32 v68, 16, v46
    v_and_b32 v69, 0xffff0000, v46
    v_lshlrev_b32 v70, 16, v47
    v_and_b32 v71, 0xffff0000, v47
    v_mov_b32 v135, 2097152
    v_mul_lo_u32 v135, v135, v1
    s_mov_b64 s[76:77], s[40:41]
    s_mov_b32 s78, 0x800000
    s_mov_b32 s79, 0x20000
    s_mov_b32 s62, 0x0
    s_cmp_eq_u32 s3, 4
    s_cselect_b32 s62, s62, 0x7ffffff0
    buffer_load_dword v136, v135, s[76:79], s62 offen
    s_mov_b64 s[76:77], s[46:47]
    s_mov_b32 s78, 0x700000
    s_mov_b32 s79, 0x20000
    s_mov_b32 s62, 0x0
    s_cmp_eq_u32 s3, 4
    s_cselect_b32 s62, s62, 0x7ffffff0
    buffer_load_dword v136, v135, s[76:79], s62 offen
    s_mov_b64 s[76:77], s[48:49]
    s_mov_b32 s78, 0x700000
    s_mov_b32 s79, 0x20000
    s_mov_b32 s62, 0x0
    s_cmp_eq_u32 s3, 5
    s_cselect_b32 s62, s62, 0x7ffffff0
    buffer_load_dword v136, v135, s[76:79], s62 offen
    s_mov_b64 s[76:77], s[50:51]
    s_mov_b32 s78, 0x700000
    s_mov_b32 s79, 0x20000
    s_mov_b32 s62, 0x0
    s_cmp_eq_u32 s3, 5
    s_cselect_b32 s62, s62, 0x7ffffff0
    buffer_load_dword v136, v135, s[76:79], s62 offen
    s_mov_b64 s[76:77], s[38:39]
    s_mov_b32 s78, 0x800000
    s_mov_b32 s79, 0x20000
    s_mov_b32 s62, 0x0
    s_cmp_eq_u32 s3, 6
    s_cselect_b32 s62, s62, 0x7ffffff0
    buffer_load_dword v136, v135, s[76:79], s62 offen
    s_mov_b64 s[76:77], s[56:57]
    s_mov_b32 s78, 0x400000
    s_mov_b32 s79, 0x20000
    s_mov_b32 s62, 0x0
    s_cmp_eq_u32 s3, 6
    s_cselect_b32 s62, s62, 0x7ffffff0
    buffer_load_dword v136, v135, s[76:79], s62 offen
    s_mov_b64 s[76:77], s[54:55]
    s_mov_b32 s78, 0xc00000
    s_mov_b32 s79, 0x20000
    s_mov_b32 s62, 0x0
    s_cmp_eq_u32 s3, 7
    s_cselect_b32 s62, s62, 0x7ffffff0
    buffer_load_dword v136, v135, s[76:79], s62 offen
    s_mov_b64 s[76:77], s[44:45]
    s_mov_b32 s78, 0x800
    s_mov_b32 s79, 0x20000
    s_mov_b32 s62, 0x0
    s_cmp_eq_u32 s3, 7
    s_cselect_b32 s62, s62, 0x7ffffff0
    buffer_load_dword v136, v135, s[76:79], s62 offen
    s_mov_b32 s27, 0
adaLN_cond__sliding_block_cached__moe_arch_mod__prompt_kernel_g14p:
    buffer_load_dwordx4 v[76:79], v139, s[8:11], s16 offen sc1
    buffer_load_dwordx4 v[80:83], v140, s[8:11], s17 offen sc1
    s_waitcnt vmcnt(1)
    v_cmp_ne_u32 vcc, s28, v78
    v_cmp_ne_u32 s[62:63], s28, v79
    s_or_b64 vcc, vcc, s[62:63]
    s_waitcnt vmcnt(0)
    v_cmp_ne_u32 s[62:63], s28, v83
    s_or_b64 vcc, vcc, s[62:63]
    s_add_u32 s27, s27, 1
    s_cmp_ge_u32 s27, 65536
    s_cbranch_scc1 adaLN_cond__sliding_block_cached__moe_arch_mod__prompt_kernel_g14g
    s_cbranch_vccnz adaLN_cond__sliding_block_cached__moe_arch_mod__prompt_kernel_g14p
adaLN_cond__sliding_block_cached__moe_arch_mod__prompt_kernel_g14g:
    v_add_f32_dpp v76, v76, v76 row_ror:8 row_mask:0xf bank_mask:0xf
    v_add_f32_dpp v77, v77, v77 row_ror:8 row_mask:0xf bank_mask:0xf
    v_mov_b32 v17, v76
    s_nop 1
    v_permlane16_swap_b32 v76, v17
    v_add_f32 v76, v76, v17
    v_mov_b32 v18, v77
    s_nop 1
    v_permlane16_swap_b32 v77, v18
    v_add_f32 v77, v77, v18
    v_mov_b32 v17, v76
    s_nop 1
    v_permlane32_swap_b32 v76, v17
    v_add_f32 v76, v76, v17
    v_mov_b32 v18, v77
    s_nop 1
    v_permlane32_swap_b32 v77, v18
    v_add_f32 v77, v77, v18
    v_cvt_pk_bf16_f32 v17, v76, v77
    v_lshlrev_b32 v76, 16, v17
    v_and_b32 v77, 0xffff0000, v17
    v_add_f32 v76, 1.0, v76
    v_add_f32 v77, 1.0, v77
    v_cvt_pk_bf16_f32 v17, v76, v77
    v_lshlrev_b32 v76, 16, v17
    v_and_b32 v77, 0xffff0000, v17
    s_lshl_b32 s16, s3, 6
    s_add_u32 s16, s16, 151552
    v_lshl_add_u32 v16, v16, 3, s16
    ds_write_b64 v16, v[76:77]
    v_lshrrev_b32 v17, 4, v1
    v_lshlrev_b32 v17, 5, v17
    v_add_u32 v17, 151552, v17
    v_sub_f32 v56, v56, v80
    v_sub_f32 v57, v57, v80
    v_sub_f32 v58, v58, v80
    v_sub_f32 v59, v59, v80
    v_sub_f32 v60, v60, v80
    v_sub_f32 v61, v61, v80
    v_sub_f32 v62, v62, v80
    v_sub_f32 v63, v63, v80
    v_sub_f32 v64, v64, v80
    v_sub_f32 v65, v65, v80
    v_sub_f32 v66, v66, v80
    v_sub_f32 v67, v67, v80
    v_sub_f32 v68, v68, v80
    v_sub_f32 v69, v69, v80
    v_sub_f32 v70, v70, v80
    v_sub_f32 v71, v71, v80
    v_cvt_pk_bf16_f32 v18, v56, v57
    v_lshlrev_b32 v56, 16, v18
    v_and_b32 v57, 0xffff0000, v18
    v_cvt_pk_bf16_f32 v19, v58, v59
    v_lshlrev_b32 v58, 16, v19
    v_and_b32 v59, 0xffff0000, v19
    v_cvt_pk_bf16_f32 v18, v60, v61
    v_lshlrev_b32 v60, 16, v18
    v_and_b32 v61, 0xffff0000, v18
    v_cvt_pk_bf16_f32 v19, v62, v63
    v_lshlrev_b32 v62, 16, v19
    v_and_b32 v63, 0xffff0000, v19
    v_cvt_pk_bf16_f32 v18, v64, v65
    v_lshlrev_b32 v64, 16, v18
    v_and_b32 v65, 0xffff0000, v18
    v_cvt_pk_bf16_f32 v19, v66, v67
    v_lshlrev_b32 v66, 16, v19
    v_and_b32 v67, 0xffff0000, v19
    v_cvt_pk_bf16_f32 v18, v68, v69
    v_lshlrev_b32 v68, 16, v18
    v_and_b32 v69, 0xffff0000, v18
    v_cvt_pk_bf16_f32 v19, v70, v71
    v_lshlrev_b32 v70, 16, v19
    v_and_b32 v71, 0xffff0000, v19
    v_mul_f32 v56, v56, v82
    v_mul_f32 v57, v57, v82
    v_mul_f32 v58, v58, v82
    v_mul_f32 v59, v59, v82
    v_mul_f32 v60, v60, v82
    v_mul_f32 v61, v61, v82
    v_mul_f32 v62, v62, v82
    v_mul_f32 v63, v63, v82
    v_mul_f32 v64, v64, v82
    v_mul_f32 v65, v65, v82
    v_mul_f32 v66, v66, v82
    v_mul_f32 v67, v67, v82
    v_mul_f32 v68, v68, v82
    v_mul_f32 v69, v69, v82
    v_mul_f32 v70, v70, v82
    v_mul_f32 v71, v71, v82
    v_cvt_pk_bf16_f32 v18, v56, v57
    v_lshlrev_b32 v56, 16, v18
    v_and_b32 v57, 0xffff0000, v18
    v_cvt_pk_bf16_f32 v19, v58, v59
    v_lshlrev_b32 v58, 16, v19
    v_and_b32 v59, 0xffff0000, v19
    v_cvt_pk_bf16_f32 v18, v60, v61
    v_lshlrev_b32 v60, 16, v18
    v_and_b32 v61, 0xffff0000, v18
    v_cvt_pk_bf16_f32 v19, v62, v63
    v_lshlrev_b32 v62, 16, v19
    v_and_b32 v63, 0xffff0000, v19
    v_cvt_pk_bf16_f32 v18, v64, v65
    v_lshlrev_b32 v64, 16, v18
    v_and_b32 v65, 0xffff0000, v18
    v_cvt_pk_bf16_f32 v19, v66, v67
    v_lshlrev_b32 v66, 16, v19
    v_and_b32 v67, 0xffff0000, v19
    v_cvt_pk_bf16_f32 v18, v68, v69
    v_lshlrev_b32 v68, 16, v18
    v_and_b32 v69, 0xffff0000, v18
    v_cvt_pk_bf16_f32 v19, v70, v71
    v_lshlrev_b32 v70, 16, v19
    v_and_b32 v71, 0xffff0000, v19
    s_lshl_b32 s16, s29, 15
    s_lshl_b32 s17, s31, 11
    s_add_u32 s16, s16, s17
    s_waitcnt lgkmcnt(0)
    s_barrier
    s_cmp_lt_u32 s24, 8
    s_cbranch_scc1 adaLN_cond__sliding_block_cached__moe_arch_mod__prompt_kernel_kvS
    v_lshl_or_b32 v84, v89, 16, v88
    v_lshl_or_b32 v85, v91, 16, v90
    v_lshl_or_b32 v86, v93, 16, v92
    v_lshl_or_b32 v87, v95, 16, v94
    v_and_b32 v88, 0x7fff, v88
    v_and_b32 v89, 0x7fff, v89
    v_and_b32 v90, 0x7fff, v90
    v_and_b32 v91, 0x7fff, v91
    v_and_b32 v92, 0x7fff, v92
    v_and_b32 v93, 0x7fff, v93
    v_and_b32 v94, 0x7fff, v94
    v_and_b32 v95, 0x7fff, v95
    v_max3_u32 v88, v88, v89, v90
    v_max3_u32 v91, v91, v92, v93
    v_max3_u32 v88, v88, v94, v95
    v_max_u32 v88, v88, v91
    v_cmp_le_u32 vcc, 0x4980, v88
    v_mov_b32 v89, s28
    s_mov_b32 s26, 0x564000
    s_and_saveexec_b64 s[62:63], vcc
    buffer_store_dword v89, v132, s[8:11], s26 offen sc1
    s_mov_b64 exec, s[62:63]
adaLN_cond__sliding_block_cached__moe_arch_mod__prompt_kernel_kvS:
    buffer_store_dwordx4 v[84:87], v2, s[8:11], s21 offen sc1
    ds_read_b128 v[96:99], v17 offset:256
    ds_read_b128 v[104:107], v17 offset:0
    ds_read_b128 v[100:103], v17 offset:272
    ds_read_b128 v[108:111], v17 offset:16
    ds_read_b128 v[112:115], v17 offset:384
    ds_read_b128 v[120:123], v17 offset:128
    ds_read_b128 v[116:119], v17 offset:400
    ds_read_b128 v[124:127], v17 offset:144
    s_waitcnt lgkmcnt(7)
    v_pk_mul_f32 v[56:57], v[56:57], v[96:97]
    v_pk_mul_f32 v[58:59], v[58:59], v[98:99]
    s_waitcnt lgkmcnt(5)
    v_pk_mul_f32 v[60:61], v[60:61], v[100:101]
    v_pk_mul_f32 v[62:63], v[62:63], v[102:103]
    v_cvt_pk_bf16_f32 v18, v56, v57
    v_lshlrev_b32 v56, 16, v18
    v_and_b32 v57, 0xffff0000, v18
    v_cvt_pk_bf16_f32 v19, v58, v59
    v_lshlrev_b32 v58, 16, v19
    v_and_b32 v59, 0xffff0000, v19
    v_cvt_pk_bf16_f32 v18, v60, v61
    v_lshlrev_b32 v60, 16, v18
    v_and_b32 v61, 0xffff0000, v18
    v_cvt_pk_bf16_f32 v19, v62, v63
    v_lshlrev_b32 v62, 16, v19
    v_and_b32 v63, 0xffff0000, v19
    v_pk_add_f32 v[56:57], v[56:57], v[104:105]
    v_pk_add_f32 v[58:59], v[58:59], v[106:107]
    s_waitcnt lgkmcnt(4)
    v_pk_add_f32 v[60:61], v[60:61], v[108:109]
    v_pk_add_f32 v[62:63], v[62:63], v[110:111]
    v_cvt_pk_bf16_f32 v32, v56, v57
    v_cvt_pk_bf16_f32 v33, v58, v59
    v_cvt_pk_bf16_f32 v34, v60, v61
    v_cvt_pk_bf16_f32 v35, v62, v63
    buffer_store_dwordx4 v[32:35], v2, s[8:11], s16 offen offset:0 sc1
    s_waitcnt lgkmcnt(3)
    v_pk_mul_f32 v[64:65], v[64:65], v[112:113]
    v_pk_mul_f32 v[66:67], v[66:67], v[114:115]
    s_waitcnt lgkmcnt(1)
    v_pk_mul_f32 v[68:69], v[68:69], v[116:117]
    v_pk_mul_f32 v[70:71], v[70:71], v[118:119]
    v_cvt_pk_bf16_f32 v18, v64, v65
    v_lshlrev_b32 v64, 16, v18
    v_and_b32 v65, 0xffff0000, v18
    v_cvt_pk_bf16_f32 v19, v66, v67
    v_lshlrev_b32 v66, 16, v19
    v_and_b32 v67, 0xffff0000, v19
    v_cvt_pk_bf16_f32 v18, v68, v69
    v_lshlrev_b32 v68, 16, v18
    v_and_b32 v69, 0xffff0000, v18
    v_cvt_pk_bf16_f32 v19, v70, v71
    v_lshlrev_b32 v70, 16, v19
    v_and_b32 v71, 0xffff0000, v19
    v_pk_add_f32 v[64:65], v[64:65], v[120:121]
    v_pk_add_f32 v[66:67], v[66:67], v[122:123]
    s_waitcnt lgkmcnt(0)
    v_pk_add_f32 v[68:69], v[68:69], v[124:125]
    v_pk_add_f32 v[70:71], v[70:71], v[126:127]
    v_cvt_pk_bf16_f32 v36, v64, v65
    v_cvt_pk_bf16_f32 v37, v66, v67
    v_cvt_pk_bf16_f32 v38, v68, v69
    v_cvt_pk_bf16_f32 v39, v70, v71
    buffer_store_dwordx4 v[36:39], v2, s[8:11], s16 offen offset:1024 sc1
    s_lshl_b32 s19, s3, 16
    s_lshl_b32 s20, s3, 11
    s_lshl_b32 s16, s12, 8
    s_add_u32 s4, s38, s16
    s_addc_u32 s5, s39, 0
    s_sub_u32 s6, 0x800000, s16
    s_mov_b32 s7, 0x20000
    s_barrier
    s_add_u32 s22, s19, 0x0
    s_add_u32 m0, s20, 0x0
    s_nop 0
    buffer_load_dwordx4 v3, s[4:7], s22 offen lds
    s_add_u32 s22, s19, 0x8000
    s_add_u32 m0, s20, 0x400
    s_nop 0
    buffer_load_dwordx4 v3, s[4:7], s22 offen lds
    s_add_u32 s22, s19, 0x80000
    s_add_u32 m0, s20, 0x4000
    s_nop 0
    buffer_load_dwordx4 v3, s[4:7], s22 offen lds
    s_add_u32 s22, s19, 0x88000
    s_add_u32 m0, s20, 0x4400
    s_nop 0
    buffer_load_dwordx4 v3, s[4:7], s22 offen lds
    s_add_u32 s22, s19, 0x100000
    s_add_u32 m0, s20, 0x8000
    s_nop 0
    buffer_load_dwordx4 v3, s[4:7], s22 offen lds
    s_add_u32 s22, s19, 0x108000
    s_add_u32 m0, s20, 0x8400
    s_nop 0
    buffer_load_dwordx4 v3, s[4:7], s22 offen lds
    v_mov_b32 v134, s28
    s_lshl_b32 s16, s29, 4
    s_add_u32 s16, s16, s31
    s_lshl_b32 s16, s16, 2
    s_add_u32 s16, s16, 0x528000
    v_and_b32 v16, 31, v1
    v_lshlrev_b32 v16, 2, v16
    s_lshl_b32 s17, s13, 3
    s_add_u32 s17, s17, s3
    s_lshl_b32 s17, s17, 7
    s_add_u32 s17, s17, 0x528000
    s_waitcnt vmcnt(6)
    s_mov_b64 exec, 1
    buffer_store_dword v134, v132, s[8:11], s16 offen sc1
    s_mov_b64 exec, -1
    s_waitcnt vmcnt(0)
    s_mov_b32 s27, 0
adaLN_cond__sliding_block_cached__moe_arch_mod__prompt_kernel_h15p:
    buffer_load_dword v17, v16, s[8:11], s17 offen sc1
    s_waitcnt vmcnt(0)
    v_cmp_ne_u32 vcc, s28, v17
    s_add_u32 s27, s27, 1
    s_cmp_ge_u32 s27, 65536
    s_cbranch_scc1 adaLN_cond__sliding_block_cached__moe_arch_mod__prompt_kernel_h15g
    s_cbranch_vccnz adaLN_cond__sliding_block_cached__moe_arch_mod__prompt_kernel_h15p
adaLN_cond__sliding_block_cached__moe_arch_mod__prompt_kernel_h15g:
    s_mov_b32 s23, 0x0
    buffer_load_dwordx4 v[88:91], v7, s[8:11], s23 offen offset:0 sc1
    s_mov_b32 s23, 0x8000
    buffer_load_dwordx4 v[92:95], v7, s[8:11], s23 offen offset:0 sc1
    s_mov_b32 s23, 0x0
    buffer_load_dwordx4 v[96:99], v7, s[8:11], s23 offen offset:1024 sc1
    s_mov_b32 s23, 0x8000
    buffer_load_dwordx4 v[100:103], v7, s[8:11], s23 offen offset:1024 sc1
    s_mov_b32 s23, 0x800
    buffer_load_dwordx4 v[104:107], v7, s[8:11], s23 offen offset:0 sc1
    s_mov_b32 s23, 0x8800
    buffer_load_dwordx4 v[108:111], v7, s[8:11], s23 offen offset:0 sc1
    s_mov_b32 s23, 0x800
    buffer_load_dwordx4 v[112:115], v7, s[8:11], s23 offen offset:1024 sc1
    s_mov_b32 s23, 0x8800
    buffer_load_dwordx4 v[116:119], v7, s[8:11], s23 offen offset:1024 sc1
    s_lshr_b32 s21, s12, 3
    s_lshl_b32 s21, s21, 17
    s_add_u32 s21, s21, s20
    s_add_u32 s21, s21, 0x400000
    s_barrier
    ds_read_b64_tr_b16 v[224:225], v4 offset:0
    ds_read_b64_tr_b16 v[226:227], v4 offset:1024
    ds_read_b64_tr_b16 v[228:229], v5 offset:32
    ds_read_b64_tr_b16 v[230:231], v5 offset:1056
    ds_read_b64_tr_b16 v[232:233], v4 offset:256
    ds_read_b64_tr_b16 v[234:235], v4 offset:1280
    ds_read_b64_tr_b16 v[236:237], v5 offset:288
    ds_read_b64_tr_b16 v[238:239], v5 offset:1312
    s_waitcnt vmcnt(7) lgkmcnt(6)
    v_mfma_f32_16x16x32_bf16 v[24:27], v[224:227], v[88:91], 0
    ds_read_b64_tr_b16 v[240:241], v4 offset:512
    s_waitcnt vmcnt(6)
    v_mfma_f32_16x16x32_bf16 v[28:31], v[224:227], v[92:95], 0
    ds_read_b64_tr_b16 v[242:243], v4 offset:1536
    s_waitcnt lgkmcnt(6)
    v_mfma_f32_16x16x32_bf16 v[32:35], v[228:231], v[88:91], 0
    ds_read_b64_tr_b16 v[244:245], v5 offset:544
    v_mfma_f32_16x16x32_bf16 v[36:39], v[228:231], v[92:95], 0
    ds_read_b64_tr_b16 v[246:247], v5 offset:1568
    s_mov_b32 s23, 0x1000
    buffer_load_dwordx4 v[120:123], v7, s[8:11], s23 offen offset:0 sc1
    s_waitcnt lgkmcnt(6)
    v_mfma_f32_16x16x32_bf16 v[40:43], v[232:235], v[88:91], 0
    ds_read_b64_tr_b16 v[224:225], v4 offset:768
    v_mfma_f32_16x16x32_bf16 v[44:47], v[232:235], v[92:95], 0
    ds_read_b64_tr_b16 v[226:227], v4 offset:1792
    s_waitcnt lgkmcnt(6)
    v_mfma_f32_16x16x32_bf16 v[48:51], v[236:239], v[88:91], 0
    ds_read_b64_tr_b16 v[228:229], v5 offset:800
    v_mfma_f32_16x16x32_bf16 v[52:55], v[236:239], v[92:95], 0
    ds_read_b64_tr_b16 v[230:231], v5 offset:1824
    s_waitcnt lgkmcnt(6)
    v_mfma_f32_16x16x32_bf16 v[56:59], v[240:243], v[88:91], 0
    ds_read_b64_tr_b16 v[232:233], v4 offset:8192
    v_mfma_f32_16x16x32_bf16 v[60:63], v[240:243], v[92:95], 0
    ds_read_b64_tr_b16 v[234:235], v4 offset:9216
    s_waitcnt lgkmcnt(6)
    v_mfma_f32_16x16x32_bf16 v[64:67], v[244:247], v[88:91], 0
    ds_read_b64_tr_b16 v[236:237], v5 offset:8224
    v_mfma_f32_16x16x32_bf16 v[68:71], v[244:247], v[92:95], 0
    ds_read_b64_tr_b16 v[238:239], v5 offset:9248
    s_mov_b32 s23, 0x9000
    buffer_load_dwordx4 v[124:127], v7, s[8:11], s23 offen offset:0 sc1
    s_waitcnt lgkmcnt(6)
    v_mfma_f32_16x16x32_bf16 v[72:75], v[224:227], v[88:91], 0
    ds_read_b64_tr_b16 v[240:241], v4 offset:8448
    v_mfma_f32_16x16x32_bf16 v[76:79], v[224:227], v[92:95], 0
    ds_read_b64_tr_b16 v[242:243], v4 offset:9472
    s_waitcnt lgkmcnt(6)
    v_mfma_f32_16x16x32_bf16 v[80:83], v[228:231], v[88:91], 0
    ds_read_b64_tr_b16 v[244:245], v5 offset:8480
    v_mfma_f32_16x16x32_bf16 v[84:87], v[228:231], v[92:95], 0
    ds_read_b64_tr_b16 v[246:247], v5 offset:9504
    s_waitcnt vmcnt(7) lgkmcnt(6)
    v_mfma_f32_16x16x32_bf16 v[24:27], v[232:235], v[96:99], v[24:27]
    ds_read_b64_tr_b16 v[224:225], v4 offset:8704
    s_waitcnt vmcnt(6)
    v_mfma_f32_16x16x32_bf16 v[28:31], v[232:235], v[100:103], v[28:31]
    ds_read_b64_tr_b16 v[226:227], v4 offset:9728
    s_waitcnt lgkmcnt(6)
    v_mfma_f32_16x16x32_bf16 v[32:35], v[236:239], v[96:99], v[32:35]
    ds_read_b64_tr_b16 v[228:229], v5 offset:8736
    v_mfma_f32_16x16x32_bf16 v[36:39], v[236:239], v[100:103], v[36:39]
    ds_read_b64_tr_b16 v[230:231], v5 offset:9760
    s_mov_b32 s23, 0x1000
    buffer_load_dwordx4 v[128:131], v7, s[8:11], s23 offen offset:1024 sc1
    s_waitcnt lgkmcnt(6)
    v_mfma_f32_16x16x32_bf16 v[40:43], v[240:243], v[96:99], v[40:43]
    ds_read_b64_tr_b16 v[232:233], v4 offset:8960
    v_mfma_f32_16x16x32_bf16 v[44:47], v[240:243], v[100:103], v[44:47]
    ds_read_b64_tr_b16 v[234:235], v4 offset:9984
    s_waitcnt lgkmcnt(6)
    v_mfma_f32_16x16x32_bf16 v[48:51], v[244:247], v[96:99], v[48:51]
    ds_read_b64_tr_b16 v[236:237], v5 offset:8992
    v_mfma_f32_16x16x32_bf16 v[52:55], v[244:247], v[100:103], v[52:55]
    ds_read_b64_tr_b16 v[238:239], v5 offset:10016
    s_waitcnt lgkmcnt(6)
    v_mfma_f32_16x16x32_bf16 v[56:59], v[224:227], v[96:99], v[56:59]
    v_mfma_f32_16x16x32_bf16 v[60:63], v[224:227], v[100:103], v[60:63]
    s_barrier
    ds_read_b64_tr_b16 v[240:241], v4 offset:16384
    ds_read_b64_tr_b16 v[242:243], v4 offset:17408
    s_waitcnt lgkmcnt(6)
    v_mfma_f32_16x16x32_bf16 v[64:67], v[228:231], v[96:99], v[64:67]
    ds_read_b64_tr_b16 v[244:245], v5 offset:16416
    v_mfma_f32_16x16x32_bf16 v[68:71], v[228:231], v[100:103], v[68:71]
    s_add_u32 s22, s19, 0x180000
    s_add_u32 m0, s20, 0xc000
    s_nop 0
    buffer_load_dwordx4 v3, s[4:7], s22 offen lds
    ds_read_b64_tr_b16 v[246:247], v5 offset:17440
    s_mov_b32 s23, 0x9000
    buffer_load_dwordx4 v[132:135], v7, s[8:11], s23 offen offset:1024 sc1
    s_waitcnt lgkmcnt(6)
    v_mfma_f32_16x16x32_bf16 v[72:75], v[232:235], v[96:99], v[72:75]
    ds_read_b64_tr_b16 v[224:225], v4 offset:16640
    v_mfma_f32_16x16x32_bf16 v[76:79], v[232:235], v[100:103], v[76:79]
    ds_read_b64_tr_b16 v[226:227], v4 offset:17664
    s_waitcnt lgkmcnt(6)
    v_mfma_f32_16x16x32_bf16 v[80:83], v[236:239], v[96:99], v[80:83]
    ds_read_b64_tr_b16 v[228:229], v5 offset:16672
    v_mfma_f32_16x16x32_bf16 v[84:87], v[236:239], v[100:103], v[84:87]
    ds_read_b64_tr_b16 v[230:231], v5 offset:17696
    s_waitcnt vmcnt(8) lgkmcnt(6)
    v_mfma_f32_16x16x32_bf16 v[24:27], v[240:243], v[104:107], v[24:27]
    ds_read_b64_tr_b16 v[232:233], v4 offset:16896
    s_waitcnt vmcnt(7)
    v_mfma_f32_16x16x32_bf16 v[28:31], v[240:243], v[108:111], v[28:31]
    ds_read_b64_tr_b16 v[234:235], v4 offset:17920
    s_waitcnt lgkmcnt(6)
    v_mfma_f32_16x16x32_bf16 v[32:35], v[244:247], v[104:107], v[32:35]
    ds_read_b64_tr_b16 v[236:237], v5 offset:16928
    v_mfma_f32_16x16x32_bf16 v[36:39], v[244:247], v[108:111], v[36:39]
    s_add_u32 s22, s19, 0x188000
    s_add_u32 m0, s20, 0xc400
    s_nop 0
    buffer_load_dwordx4 v3, s[4:7], s22 offen lds
    ds_read_b64_tr_b16 v[238:239], v5 offset:17952
    s_mov_b32 s23, 0x1800
    buffer_load_dwordx4 v[88:91], v7, s[8:11], s23 offen offset:0 sc1
    s_waitcnt lgkmcnt(6)
    v_mfma_f32_16x16x32_bf16 v[40:43], v[224:227], v[104:107], v[40:43]
    ds_read_b64_tr_b16 v[240:241], v4 offset:17152
    v_mfma_f32_16x16x32_bf16 v[44:47], v[224:227], v[108:111], v[44:47]
    ds_read_b64_tr_b16 v[242:243], v4 offset:18176
    s_waitcnt lgkmcnt(6)
    v_mfma_f32_16x16x32_bf16 v[48:51], v[228:231], v[104:107], v[48:51]
    ds_read_b64_tr_b16 v[244:245], v5 offset:17184
    v_mfma_f32_16x16x32_bf16 v[52:55], v[228:231], v[108:111], v[52:55]
    ds_read_b64_tr_b16 v[246:247], v5 offset:18208
    s_waitcnt lgkmcnt(6)
    v_mfma_f32_16x16x32_bf16 v[56:59], v[232:235], v[104:107], v[56:59]
    ds_read_b64_tr_b16 v[224:225], v4 offset:24576
    v_mfma_f32_16x16x32_bf16 v[60:63], v[232:235], v[108:111], v[60:63]
    ds_read_b64_tr_b16 v[226:227], v4 offset:25600
    s_waitcnt lgkmcnt(6)
    v_mfma_f32_16x16x32_bf16 v[64:67], v[236:239], v[104:107], v[64:67]
    ds_read_b64_tr_b16 v[228:229], v5 offset:24608
    v_mfma_f32_16x16x32_bf16 v[68:71], v[236:239], v[108:111], v[68:71]
    ds_read_b64_tr_b16 v[230:231], v5 offset:25632
    s_mov_b32 s23, 0x9800
    buffer_load_dwordx4 v[92:95], v7, s[8:11], s23 offen offset:0 sc1
    s_waitcnt lgkmcnt(6)
    v_mfma_f32_16x16x32_bf16 v[72:75], v[240:243], v[104:107], v[72:75]
    ds_read_b64_tr_b16 v[232:233], v4 offset:24832
    v_mfma_f32_16x16x32_bf16 v[76:79], v[240:243], v[108:111], v[76:79]
    ds_read_b64_tr_b16 v[234:235], v4 offset:25856
    s_waitcnt lgkmcnt(6)
    v_mfma_f32_16x16x32_bf16 v[80:83], v[244:247], v[104:107], v[80:83]
    ds_read_b64_tr_b16 v[236:237], v5 offset:24864
    v_mfma_f32_16x16x32_bf16 v[84:87], v[244:247], v[108:111], v[84:87]
    ds_read_b64_tr_b16 v[238:239], v5 offset:25888
    s_waitcnt vmcnt(9) lgkmcnt(6)
    v_mfma_f32_16x16x32_bf16 v[24:27], v[224:227], v[112:115], v[24:27]
    ds_read_b64_tr_b16 v[240:241], v4 offset:25088
    s_waitcnt vmcnt(8)
    v_mfma_f32_16x16x32_bf16 v[28:31], v[224:227], v[116:119], v[28:31]
    ds_read_b64_tr_b16 v[242:243], v4 offset:26112
    s_waitcnt lgkmcnt(6)
    v_mfma_f32_16x16x32_bf16 v[32:35], v[228:231], v[112:115], v[32:35]
    ds_read_b64_tr_b16 v[244:245], v5 offset:25120
    v_mfma_f32_16x16x32_bf16 v[36:39], v[228:231], v[116:119], v[36:39]
    ds_read_b64_tr_b16 v[246:247], v5 offset:26144
    s_mov_b32 s23, 0x1800
    buffer_load_dwordx4 v[96:99], v7, s[8:11], s23 offen offset:1024 sc1
    s_waitcnt lgkmcnt(6)
    v_mfma_f32_16x16x32_bf16 v[40:43], v[232:235], v[112:115], v[40:43]
    ds_read_b64_tr_b16 v[224:225], v4 offset:25344
    v_mfma_f32_16x16x32_bf16 v[44:47], v[232:235], v[116:119], v[44:47]
    ds_read_b64_tr_b16 v[226:227], v4 offset:26368
    s_waitcnt lgkmcnt(6)
    v_mfma_f32_16x16x32_bf16 v[48:51], v[236:239], v[112:115], v[48:51]
    ds_read_b64_tr_b16 v[228:229], v5 offset:25376
    v_mfma_f32_16x16x32_bf16 v[52:55], v[236:239], v[116:119], v[52:55]
    ds_read_b64_tr_b16 v[230:231], v5 offset:26400
    s_waitcnt lgkmcnt(6)
    v_mfma_f32_16x16x32_bf16 v[56:59], v[240:243], v[112:115], v[56:59]
    v_mfma_f32_16x16x32_bf16 v[60:63], v[240:243], v[116:119], v[60:63]
    s_barrier
    ds_read_b64_tr_b16 v[232:233], v4 offset:32768
    ds_read_b64_tr_b16 v[234:235], v4 offset:33792
    s_waitcnt lgkmcnt(6)
    v_mfma_f32_16x16x32_bf16 v[64:67], v[244:247], v[112:115], v[64:67]
    ds_read_b64_tr_b16 v[236:237], v5 offset:32800
    v_mfma_f32_16x16x32_bf16 v[68:71], v[244:247], v[116:119], v[68:71]
    s_add_u32 s22, s19, 0x200000
    s_add_u32 m0, s20, 0x0
    s_nop 0
    buffer_load_dwordx4 v3, s[4:7], s22 offen lds
    ds_read_b64_tr_b16 v[238:239], v5 offset:33824
    s_mov_b32 s23, 0x9800
    buffer_load_dwordx4 v[100:103], v7, s[8:11], s23 offen offset:1024 sc1
    s_waitcnt lgkmcnt(6)
    v_mfma_f32_16x16x32_bf16 v[72:75], v[224:227], v[112:115], v[72:75]
    ds_read_b64_tr_b16 v[240:241], v4 offset:33024
    v_mfma_f32_16x16x32_bf16 v[76:79], v[224:227], v[116:119], v[76:79]
    ds_read_b64_tr_b16 v[242:243], v4 offset:34048
    s_waitcnt lgkmcnt(6)
    v_mfma_f32_16x16x32_bf16 v[80:83], v[228:231], v[112:115], v[80:83]
    ds_read_b64_tr_b16 v[244:245], v5 offset:33056
    v_mfma_f32_16x16x32_bf16 v[84:87], v[228:231], v[116:119], v[84:87]
    ds_read_b64_tr_b16 v[246:247], v5 offset:34080
    s_waitcnt vmcnt(10) lgkmcnt(6)
    v_mfma_f32_16x16x32_bf16 v[24:27], v[232:235], v[120:123], v[24:27]
    ds_read_b64_tr_b16 v[224:225], v4 offset:33280
    s_waitcnt vmcnt(9)
    v_mfma_f32_16x16x32_bf16 v[28:31], v[232:235], v[124:127], v[28:31]
    ds_read_b64_tr_b16 v[226:227], v4 offset:34304
    s_waitcnt lgkmcnt(6)
    v_mfma_f32_16x16x32_bf16 v[32:35], v[236:239], v[120:123], v[32:35]
    ds_read_b64_tr_b16 v[228:229], v5 offset:33312
    v_mfma_f32_16x16x32_bf16 v[36:39], v[236:239], v[124:127], v[36:39]
    s_add_u32 s22, s19, 0x208000
    s_add_u32 m0, s20, 0x400
    s_nop 0
    buffer_load_dwordx4 v3, s[4:7], s22 offen lds
    ds_read_b64_tr_b16 v[230:231], v5 offset:34336
    s_mov_b32 s23, 0x2000
    buffer_load_dwordx4 v[104:107], v7, s[8:11], s23 offen offset:0 sc1
    s_waitcnt lgkmcnt(6)
    v_mfma_f32_16x16x32_bf16 v[40:43], v[240:243], v[120:123], v[40:43]
    ds_read_b64_tr_b16 v[232:233], v4 offset:33536
    v_mfma_f32_16x16x32_bf16 v[44:47], v[240:243], v[124:127], v[44:47]
    ds_read_b64_tr_b16 v[234:235], v4 offset:34560
    s_waitcnt lgkmcnt(6)
    v_mfma_f32_16x16x32_bf16 v[48:51], v[244:247], v[120:123], v[48:51]
    ds_read_b64_tr_b16 v[236:237], v5 offset:33568
    v_mfma_f32_16x16x32_bf16 v[52:55], v[244:247], v[124:127], v[52:55]
    ds_read_b64_tr_b16 v[238:239], v5 offset:34592
    s_waitcnt lgkmcnt(6)
    v_mfma_f32_16x16x32_bf16 v[56:59], v[224:227], v[120:123], v[56:59]
    ds_read_b64_tr_b16 v[240:241], v4 offset:40960
    v_mfma_f32_16x16x32_bf16 v[60:63], v[224:227], v[124:127], v[60:63]
    ds_read_b64_tr_b16 v[242:243], v4 offset:41984
    s_waitcnt lgkmcnt(6)
    v_mfma_f32_16x16x32_bf16 v[64:67], v[228:231], v[120:123], v[64:67]
    ds_read_b64_tr_b16 v[244:245], v5 offset:40992
    v_mfma_f32_16x16x32_bf16 v[68:71], v[228:231], v[124:127], v[68:71]
    ds_read_b64_tr_b16 v[246:247], v5 offset:42016
    s_mov_b32 s23, 0xa000
    buffer_load_dwordx4 v[108:111], v7, s[8:11], s23 offen offset:0 sc1
    s_waitcnt lgkmcnt(6)
    v_mfma_f32_16x16x32_bf16 v[72:75], v[232:235], v[120:123], v[72:75]
    ds_read_b64_tr_b16 v[224:225], v4 offset:41216
    v_mfma_f32_16x16x32_bf16 v[76:79], v[232:235], v[124:127], v[76:79]
    ds_read_b64_tr_b16 v[226:227], v4 offset:42240
    s_waitcnt lgkmcnt(6)
    v_mfma_f32_16x16x32_bf16 v[80:83], v[236:239], v[120:123], v[80:83]
    ds_read_b64_tr_b16 v[228:229], v5 offset:41248
    v_mfma_f32_16x16x32_bf16 v[84:87], v[236:239], v[124:127], v[84:87]
    ds_read_b64_tr_b16 v[230:231], v5 offset:42272
    s_waitcnt vmcnt(11) lgkmcnt(6)
    v_mfma_f32_16x16x32_bf16 v[24:27], v[240:243], v[128:131], v[24:27]
    ds_read_b64_tr_b16 v[232:233], v4 offset:41472
    s_waitcnt vmcnt(9)
    v_mfma_f32_16x16x32_bf16 v[28:31], v[240:243], v[132:135], v[28:31]
    ds_read_b64_tr_b16 v[234:235], v4 offset:42496
    s_waitcnt lgkmcnt(6)
    v_mfma_f32_16x16x32_bf16 v[32:35], v[244:247], v[128:131], v[32:35]
    ds_read_b64_tr_b16 v[236:237], v5 offset:41504
    v_mfma_f32_16x16x32_bf16 v[36:39], v[244:247], v[132:135], v[36:39]
    ds_read_b64_tr_b16 v[238:239], v5 offset:42528
    s_mov_b32 s23, 0x2000
    buffer_load_dwordx4 v[112:115], v7, s[8:11], s23 offen offset:1024 sc1
    s_waitcnt lgkmcnt(6)
    v_mfma_f32_16x16x32_bf16 v[40:43], v[224:227], v[128:131], v[40:43]
    ds_read_b64_tr_b16 v[240:241], v4 offset:41728
    v_mfma_f32_16x16x32_bf16 v[44:47], v[224:227], v[132:135], v[44:47]
    ds_read_b64_tr_b16 v[242:243], v4 offset:42752
    s_waitcnt lgkmcnt(6)
    v_mfma_f32_16x16x32_bf16 v[48:51], v[228:231], v[128:131], v[48:51]
    ds_read_b64_tr_b16 v[244:245], v5 offset:41760
    v_mfma_f32_16x16x32_bf16 v[52:55], v[228:231], v[132:135], v[52:55]
    ds_read_b64_tr_b16 v[246:247], v5 offset:42784
    s_waitcnt lgkmcnt(6)
    v_mfma_f32_16x16x32_bf16 v[56:59], v[232:235], v[128:131], v[56:59]
    v_mfma_f32_16x16x32_bf16 v[60:63], v[232:235], v[132:135], v[60:63]
    s_waitcnt vmcnt(9)
    s_barrier
    ds_read_b64_tr_b16 v[224:225], v4 offset:49152
    ds_read_b64_tr_b16 v[226:227], v4 offset:50176
    s_waitcnt lgkmcnt(6)
    v_mfma_f32_16x16x32_bf16 v[64:67], v[236:239], v[128:131], v[64:67]
    ds_read_b64_tr_b16 v[228:229], v5 offset:49184
    v_mfma_f32_16x16x32_bf16 v[68:71], v[236:239], v[132:135], v[68:71]
    s_add_u32 s22, s19, 0x280000
    s_add_u32 m0, s20, 0x4000
    s_nop 0
    buffer_load_dwordx4 v3, s[4:7], s22 offen lds
    ds_read_b64_tr_b16 v[230:231], v5 offset:50208
    s_mov_b32 s23, 0xa000
    buffer_load_dwordx4 v[116:119], v7, s[8:11], s23 offen offset:1024 sc1
    s_waitcnt lgkmcnt(6)
    v_mfma_f32_16x16x32_bf16 v[72:75], v[240:243], v[128:131], v[72:75]
    ds_read_b64_tr_b16 v[232:233], v4 offset:49408
    v_mfma_f32_16x16x32_bf16 v[76:79], v[240:243], v[132:135], v[76:79]
    ds_read_b64_tr_b16 v[234:235], v4 offset:50432
    s_waitcnt lgkmcnt(6)
    v_mfma_f32_16x16x32_bf16 v[80:83], v[244:247], v[128:131], v[80:83]
    ds_read_b64_tr_b16 v[236:237], v5 offset:49440
    v_mfma_f32_16x16x32_bf16 v[84:87], v[244:247], v[132:135], v[84:87]
    ds_read_b64_tr_b16 v[238:239], v5 offset:50464
    s_waitcnt vmcnt(10) lgkmcnt(6)
    v_mfma_f32_16x16x32_bf16 v[24:27], v[224:227], v[88:91], v[24:27]
    ds_read_b64_tr_b16 v[240:241], v4 offset:49664
    s_waitcnt vmcnt(9)
    v_mfma_f32_16x16x32_bf16 v[28:31], v[224:227], v[92:95], v[28:31]
    ds_read_b64_tr_b16 v[242:243], v4 offset:50688
    s_waitcnt lgkmcnt(6)
    v_mfma_f32_16x16x32_bf16 v[32:35], v[228:231], v[88:91], v[32:35]
    ds_read_b64_tr_b16 v[244:245], v5 offset:49696
    v_mfma_f32_16x16x32_bf16 v[36:39], v[228:231], v[92:95], v[36:39]
    s_add_u32 s22, s19, 0x288000
    s_add_u32 m0, s20, 0x4400
    s_nop 0
    buffer_load_dwordx4 v3, s[4:7], s22 offen lds
    ds_read_b64_tr_b16 v[246:247], v5 offset:50720
    s_mov_b32 s23, 0x2800
    buffer_load_dwordx4 v[120:123], v7, s[8:11], s23 offen offset:0 sc1
    s_waitcnt lgkmcnt(6)
    v_mfma_f32_16x16x32_bf16 v[40:43], v[232:235], v[88:91], v[40:43]
    ds_read_b64_tr_b16 v[224:225], v4 offset:49920
    v_mfma_f32_16x16x32_bf16 v[44:47], v[232:235], v[92:95], v[44:47]
    ds_read_b64_tr_b16 v[226:227], v4 offset:50944
    s_waitcnt lgkmcnt(6)
    v_mfma_f32_16x16x32_bf16 v[48:51], v[236:239], v[88:91], v[48:51]
    ds_read_b64_tr_b16 v[228:229], v5 offset:49952
    v_mfma_f32_16x16x32_bf16 v[52:55], v[236:239], v[92:95], v[52:55]
    ds_read_b64_tr_b16 v[230:231], v5 offset:50976
    s_waitcnt lgkmcnt(6)
    v_mfma_f32_16x16x32_bf16 v[56:59], v[240:243], v[88:91], v[56:59]
    ds_read_b64_tr_b16 v[232:233], v4 offset:57344
    v_mfma_f32_16x16x32_bf16 v[60:63], v[240:243], v[92:95], v[60:63]
    ds_read_b64_tr_b16 v[234:235], v4 offset:58368
    s_waitcnt lgkmcnt(6)
    v_mfma_f32_16x16x32_bf16 v[64:67], v[244:247], v[88:91], v[64:67]
    ds_read_b64_tr_b16 v[236:237], v5 offset:57376
    v_mfma_f32_16x16x32_bf16 v[68:71], v[244:247], v[92:95], v[68:71]
    ds_read_b64_tr_b16 v[238:239], v5 offset:58400
    s_mov_b32 s23, 0xa800
    buffer_load_dwordx4 v[124:127], v7, s[8:11], s23 offen offset:0 sc1
    s_waitcnt lgkmcnt(6)
    v_mfma_f32_16x16x32_bf16 v[72:75], v[224:227], v[88:91], v[72:75]
    ds_read_b64_tr_b16 v[240:241], v4 offset:57600
    v_mfma_f32_16x16x32_bf16 v[76:79], v[224:227], v[92:95], v[76:79]
    ds_read_b64_tr_b16 v[242:243], v4 offset:58624
    s_waitcnt lgkmcnt(6)
    v_mfma_f32_16x16x32_bf16 v[80:83], v[228:231], v[88:91], v[80:83]
    ds_read_b64_tr_b16 v[244:245], v5 offset:57632
    v_mfma_f32_16x16x32_bf16 v[84:87], v[228:231], v[92:95], v[84:87]
    ds_read_b64_tr_b16 v[246:247], v5 offset:58656
    s_waitcnt vmcnt(11) lgkmcnt(6)
    v_mfma_f32_16x16x32_bf16 v[24:27], v[232:235], v[96:99], v[24:27]
    ds_read_b64_tr_b16 v[224:225], v4 offset:57856
    s_waitcnt vmcnt(9)
    v_mfma_f32_16x16x32_bf16 v[28:31], v[232:235], v[100:103], v[28:31]
    ds_read_b64_tr_b16 v[226:227], v4 offset:58880
    s_waitcnt lgkmcnt(6)
    v_mfma_f32_16x16x32_bf16 v[32:35], v[236:239], v[96:99], v[32:35]
    ds_read_b64_tr_b16 v[228:229], v5 offset:57888
    v_mfma_f32_16x16x32_bf16 v[36:39], v[236:239], v[100:103], v[36:39]
    ds_read_b64_tr_b16 v[230:231], v5 offset:58912
    s_mov_b32 s23, 0x2800
    buffer_load_dwordx4 v[128:131], v7, s[8:11], s23 offen offset:1024 sc1
    s_waitcnt lgkmcnt(6)
    v_mfma_f32_16x16x32_bf16 v[40:43], v[240:243], v[96:99], v[40:43]
    ds_read_b64_tr_b16 v[232:233], v4 offset:58112
    v_mfma_f32_16x16x32_bf16 v[44:47], v[240:243], v[100:103], v[44:47]
    ds_read_b64_tr_b16 v[234:235], v4 offset:59136
    s_waitcnt lgkmcnt(6)
    v_mfma_f32_16x16x32_bf16 v[48:51], v[244:247], v[96:99], v[48:51]
    ds_read_b64_tr_b16 v[236:237], v5 offset:58144
    v_mfma_f32_16x16x32_bf16 v[52:55], v[244:247], v[100:103], v[52:55]
    ds_read_b64_tr_b16 v[238:239], v5 offset:59168
    s_waitcnt lgkmcnt(6)
    v_mfma_f32_16x16x32_bf16 v[56:59], v[224:227], v[96:99], v[56:59]
    v_mfma_f32_16x16x32_bf16 v[60:63], v[224:227], v[100:103], v[60:63]
    s_waitcnt vmcnt(9)
    s_barrier
    ds_read_b64_tr_b16 v[240:241], v4 offset:0
    ds_read_b64_tr_b16 v[242:243], v4 offset:1024
    s_waitcnt lgkmcnt(6)
    v_mfma_f32_16x16x32_bf16 v[64:67], v[228:231], v[96:99], v[64:67]
    ds_read_b64_tr_b16 v[244:245], v5 offset:32
    v_mfma_f32_16x16x32_bf16 v[68:71], v[228:231], v[100:103], v[68:71]
    s_add_u32 s22, s19, 0x300000
    s_add_u32 m0, s20, 0x8000
    s_nop 0
    buffer_load_dwordx4 v3, s[4:7], s22 offen lds
    ds_read_b64_tr_b16 v[246:247], v5 offset:1056
    s_mov_b32 s23, 0xa800
    buffer_load_dwordx4 v[132:135], v7, s[8:11], s23 offen offset:1024 sc1
    s_waitcnt lgkmcnt(6)
    v_mfma_f32_16x16x32_bf16 v[72:75], v[232:235], v[96:99], v[72:75]
    ds_read_b64_tr_b16 v[224:225], v4 offset:256
    v_mfma_f32_16x16x32_bf16 v[76:79], v[232:235], v[100:103], v[76:79]
    ds_read_b64_tr_b16 v[226:227], v4 offset:1280
    s_waitcnt lgkmcnt(6)
    v_mfma_f32_16x16x32_bf16 v[80:83], v[236:239], v[96:99], v[80:83]
    ds_read_b64_tr_b16 v[228:229], v5 offset:288
    v_mfma_f32_16x16x32_bf16 v[84:87], v[236:239], v[100:103], v[84:87]
    ds_read_b64_tr_b16 v[230:231], v5 offset:1312
    s_waitcnt vmcnt(10) lgkmcnt(6)
    v_mfma_f32_16x16x32_bf16 v[24:27], v[240:243], v[104:107], v[24:27]
    ds_read_b64_tr_b16 v[232:233], v4 offset:512
    s_waitcnt vmcnt(9)
    v_mfma_f32_16x16x32_bf16 v[28:31], v[240:243], v[108:111], v[28:31]
    ds_read_b64_tr_b16 v[234:235], v4 offset:1536
    s_waitcnt lgkmcnt(6)
    v_mfma_f32_16x16x32_bf16 v[32:35], v[244:247], v[104:107], v[32:35]
    ds_read_b64_tr_b16 v[236:237], v5 offset:544
    v_mfma_f32_16x16x32_bf16 v[36:39], v[244:247], v[108:111], v[36:39]
    s_add_u32 s22, s19, 0x308000
    s_add_u32 m0, s20, 0x8400
    s_nop 0
    buffer_load_dwordx4 v3, s[4:7], s22 offen lds
    ds_read_b64_tr_b16 v[238:239], v5 offset:1568
    s_mov_b32 s23, 0x3000
    buffer_load_dwordx4 v[88:91], v7, s[8:11], s23 offen offset:0 sc1
    s_waitcnt lgkmcnt(6)
    v_mfma_f32_16x16x32_bf16 v[40:43], v[224:227], v[104:107], v[40:43]
    ds_read_b64_tr_b16 v[240:241], v4 offset:768
    v_mfma_f32_16x16x32_bf16 v[44:47], v[224:227], v[108:111], v[44:47]
    ds_read_b64_tr_b16 v[242:243], v4 offset:1792
    s_waitcnt lgkmcnt(6)
    v_mfma_f32_16x16x32_bf16 v[48:51], v[228:231], v[104:107], v[48:51]
    ds_read_b64_tr_b16 v[244:245], v5 offset:800
    v_mfma_f32_16x16x32_bf16 v[52:55], v[228:231], v[108:111], v[52:55]
    ds_read_b64_tr_b16 v[246:247], v5 offset:1824
    s_waitcnt lgkmcnt(6)
    v_mfma_f32_16x16x32_bf16 v[56:59], v[232:235], v[104:107], v[56:59]
    ds_read_b64_tr_b16 v[224:225], v4 offset:8192
    v_mfma_f32_16x16x32_bf16 v[60:63], v[232:235], v[108:111], v[60:63]
    ds_read_b64_tr_b16 v[226:227], v4 offset:9216
    s_waitcnt lgkmcnt(6)
    v_mfma_f32_16x16x32_bf16 v[64:67], v[236:239], v[104:107], v[64:67]
    ds_read_b64_tr_b16 v[228:229], v5 offset:8224
    v_mfma_f32_16x16x32_bf16 v[68:71], v[236:239], v[108:111], v[68:71]
    ds_read_b64_tr_b16 v[230:231], v5 offset:9248
    s_mov_b32 s23, 0xb000
    buffer_load_dwordx4 v[92:95], v7, s[8:11], s23 offen offset:0 sc1
    s_waitcnt lgkmcnt(6)
    v_mfma_f32_16x16x32_bf16 v[72:75], v[240:243], v[104:107], v[72:75]
    ds_read_b64_tr_b16 v[232:233], v4 offset:8448
    v_mfma_f32_16x16x32_bf16 v[76:79], v[240:243], v[108:111], v[76:79]
    ds_read_b64_tr_b16 v[234:235], v4 offset:9472
    s_waitcnt lgkmcnt(6)
    v_mfma_f32_16x16x32_bf16 v[80:83], v[244:247], v[104:107], v[80:83]
    ds_read_b64_tr_b16 v[236:237], v5 offset:8480
    v_mfma_f32_16x16x32_bf16 v[84:87], v[244:247], v[108:111], v[84:87]
    ds_read_b64_tr_b16 v[238:239], v5 offset:9504
    s_waitcnt vmcnt(11) lgkmcnt(6)
    v_mfma_f32_16x16x32_bf16 v[24:27], v[224:227], v[112:115], v[24:27]
    ds_read_b64_tr_b16 v[240:241], v4 offset:8704
    s_waitcnt vmcnt(9)
    v_mfma_f32_16x16x32_bf16 v[28:31], v[224:227], v[116:119], v[28:31]
    ds_read_b64_tr_b16 v[242:243], v4 offset:9728
    s_waitcnt lgkmcnt(6)
    v_mfma_f32_16x16x32_bf16 v[32:35], v[228:231], v[112:115], v[32:35]
    ds_read_b64_tr_b16 v[244:245], v5 offset:8736
    v_mfma_f32_16x16x32_bf16 v[36:39], v[228:231], v[116:119], v[36:39]
    ds_read_b64_tr_b16 v[246:247], v5 offset:9760
    s_mov_b32 s23, 0x3000
    buffer_load_dwordx4 v[96:99], v7, s[8:11], s23 offen offset:1024 sc1
    s_waitcnt lgkmcnt(6)
    v_mfma_f32_16x16x32_bf16 v[40:43], v[232:235], v[112:115], v[40:43]
    ds_read_b64_tr_b16 v[224:225], v4 offset:8960
    v_mfma_f32_16x16x32_bf16 v[44:47], v[232:235], v[116:119], v[44:47]
    ds_read_b64_tr_b16 v[226:227], v4 offset:9984
    s_waitcnt lgkmcnt(6)
    v_mfma_f32_16x16x32_bf16 v[48:51], v[236:239], v[112:115], v[48:51]
    ds_read_b64_tr_b16 v[228:229], v5 offset:8992
    v_mfma_f32_16x16x32_bf16 v[52:55], v[236:239], v[116:119], v[52:55]
    ds_read_b64_tr_b16 v[230:231], v5 offset:10016
    s_waitcnt lgkmcnt(6)
    v_mfma_f32_16x16x32_bf16 v[56:59], v[240:243], v[112:115], v[56:59]
    v_mfma_f32_16x16x32_bf16 v[60:63], v[240:243], v[116:119], v[60:63]
    s_waitcnt vmcnt(9)
    s_barrier
    ds_read_b64_tr_b16 v[232:233], v4 offset:16384
    ds_read_b64_tr_b16 v[234:235], v4 offset:17408
    s_waitcnt lgkmcnt(6)
    v_mfma_f32_16x16x32_bf16 v[64:67], v[244:247], v[112:115], v[64:67]
    ds_read_b64_tr_b16 v[236:237], v5 offset:16416
    v_mfma_f32_16x16x32_bf16 v[68:71], v[244:247], v[116:119], v[68:71]
    s_add_u32 s22, s19, 0x380000
    s_add_u32 m0, s20, 0xc000
    s_nop 0
    buffer_load_dwordx4 v3, s[4:7], s22 offen lds
    ds_read_b64_tr_b16 v[238:239], v5 offset:17440
    s_mov_b32 s23, 0xb000
    buffer_load_dwordx4 v[100:103], v7, s[8:11], s23 offen offset:1024 sc1
    s_waitcnt lgkmcnt(6)
    v_mfma_f32_16x16x32_bf16 v[72:75], v[224:227], v[112:115], v[72:75]
    ds_read_b64_tr_b16 v[240:241], v4 offset:16640
    v_mfma_f32_16x16x32_bf16 v[76:79], v[224:227], v[116:119], v[76:79]
    ds_read_b64_tr_b16 v[242:243], v4 offset:17664
    s_waitcnt lgkmcnt(6)
    v_mfma_f32_16x16x32_bf16 v[80:83], v[228:231], v[112:115], v[80:83]
    ds_read_b64_tr_b16 v[244:245], v5 offset:16672
    v_mfma_f32_16x16x32_bf16 v[84:87], v[228:231], v[116:119], v[84:87]
    ds_read_b64_tr_b16 v[246:247], v5 offset:17696
    s_waitcnt vmcnt(10) lgkmcnt(6)
    v_mfma_f32_16x16x32_bf16 v[24:27], v[232:235], v[120:123], v[24:27]
    ds_read_b64_tr_b16 v[224:225], v4 offset:16896
    s_waitcnt vmcnt(9)
    v_mfma_f32_16x16x32_bf16 v[28:31], v[232:235], v[124:127], v[28:31]
    ds_read_b64_tr_b16 v[226:227], v4 offset:17920
    s_waitcnt lgkmcnt(6)
    v_mfma_f32_16x16x32_bf16 v[32:35], v[236:239], v[120:123], v[32:35]
    ds_read_b64_tr_b16 v[228:229], v5 offset:16928
    v_mfma_f32_16x16x32_bf16 v[36:39], v[236:239], v[124:127], v[36:39]
    s_add_u32 s22, s19, 0x388000
    s_add_u32 m0, s20, 0xc400
    s_nop 0
    buffer_load_dwordx4 v3, s[4:7], s22 offen lds
    ds_read_b64_tr_b16 v[230:231], v5 offset:17952
    s_mov_b32 s23, 0x3800
    buffer_load_dwordx4 v[104:107], v7, s[8:11], s23 offen offset:0 sc1
    s_waitcnt lgkmcnt(6)
    v_mfma_f32_16x16x32_bf16 v[40:43], v[240:243], v[120:123], v[40:43]
    ds_read_b64_tr_b16 v[232:233], v4 offset:17152
    v_mfma_f32_16x16x32_bf16 v[44:47], v[240:243], v[124:127], v[44:47]
    ds_read_b64_tr_b16 v[234:235], v4 offset:18176
    s_waitcnt lgkmcnt(6)
    v_mfma_f32_16x16x32_bf16 v[48:51], v[244:247], v[120:123], v[48:51]
    ds_read_b64_tr_b16 v[236:237], v5 offset:17184
    v_mfma_f32_16x16x32_bf16 v[52:55], v[244:247], v[124:127], v[52:55]
    ds_read_b64_tr_b16 v[238:239], v5 offset:18208
    s_waitcnt lgkmcnt(6)
    v_mfma_f32_16x16x32_bf16 v[56:59], v[224:227], v[120:123], v[56:59]
    ds_read_b64_tr_b16 v[240:241], v4 offset:24576
    v_mfma_f32_16x16x32_bf16 v[60:63], v[224:227], v[124:127], v[60:63]
    ds_read_b64_tr_b16 v[242:243], v4 offset:25600
    s_waitcnt lgkmcnt(6)
    v_mfma_f32_16x16x32_bf16 v[64:67], v[228:231], v[120:123], v[64:67]
    ds_read_b64_tr_b16 v[244:245], v5 offset:24608
    v_mfma_f32_16x16x32_bf16 v[68:71], v[228:231], v[124:127], v[68:71]
    ds_read_b64_tr_b16 v[246:247], v5 offset:25632
    s_mov_b32 s23, 0xb800
    buffer_load_dwordx4 v[108:111], v7, s[8:11], s23 offen offset:0 sc1
    s_waitcnt lgkmcnt(6)
    v_mfma_f32_16x16x32_bf16 v[72:75], v[232:235], v[120:123], v[72:75]
    ds_read_b64_tr_b16 v[224:225], v4 offset:24832
    v_mfma_f32_16x16x32_bf16 v[76:79], v[232:235], v[124:127], v[76:79]
    ds_read_b64_tr_b16 v[226:227], v4 offset:25856
    s_waitcnt lgkmcnt(6)
    v_mfma_f32_16x16x32_bf16 v[80:83], v[236:239], v[120:123], v[80:83]
    ds_read_b64_tr_b16 v[228:229], v5 offset:24864
    v_mfma_f32_16x16x32_bf16 v[84:87], v[236:239], v[124:127], v[84:87]
    ds_read_b64_tr_b16 v[230:231], v5 offset:25888
    s_waitcnt vmcnt(11) lgkmcnt(6)
    v_mfma_f32_16x16x32_bf16 v[24:27], v[240:243], v[128:131], v[24:27]
    ds_read_b64_tr_b16 v[232:233], v4 offset:25088
    s_waitcnt vmcnt(9)
    v_mfma_f32_16x16x32_bf16 v[28:31], v[240:243], v[132:135], v[28:31]
    ds_read_b64_tr_b16 v[234:235], v4 offset:26112
    s_waitcnt lgkmcnt(6)
    v_mfma_f32_16x16x32_bf16 v[32:35], v[244:247], v[128:131], v[32:35]
    ds_read_b64_tr_b16 v[236:237], v5 offset:25120
    v_mfma_f32_16x16x32_bf16 v[36:39], v[244:247], v[132:135], v[36:39]
    ds_read_b64_tr_b16 v[238:239], v5 offset:26144
    s_mov_b32 s23, 0x3800
    buffer_load_dwordx4 v[112:115], v7, s[8:11], s23 offen offset:1024 sc1
    s_waitcnt lgkmcnt(6)
    v_mfma_f32_16x16x32_bf16 v[40:43], v[224:227], v[128:131], v[40:43]
    ds_read_b64_tr_b16 v[240:241], v4 offset:25344
    v_mfma_f32_16x16x32_bf16 v[44:47], v[224:227], v[132:135], v[44:47]
    ds_read_b64_tr_b16 v[242:243], v4 offset:26368
    s_waitcnt lgkmcnt(6)
    v_mfma_f32_16x16x32_bf16 v[48:51], v[228:231], v[128:131], v[48:51]
    ds_read_b64_tr_b16 v[244:245], v5 offset:25376
    v_mfma_f32_16x16x32_bf16 v[52:55], v[228:231], v[132:135], v[52:55]
    ds_read_b64_tr_b16 v[246:247], v5 offset:26400
    s_waitcnt lgkmcnt(6)
    v_mfma_f32_16x16x32_bf16 v[56:59], v[232:235], v[128:131], v[56:59]
    v_mfma_f32_16x16x32_bf16 v[60:63], v[232:235], v[132:135], v[60:63]
    s_waitcnt vmcnt(9)
    s_barrier
    ds_read_b64_tr_b16 v[224:225], v4 offset:32768
    ds_read_b64_tr_b16 v[226:227], v4 offset:33792
    s_waitcnt lgkmcnt(6)
    v_mfma_f32_16x16x32_bf16 v[64:67], v[236:239], v[128:131], v[64:67]
    ds_read_b64_tr_b16 v[228:229], v5 offset:32800
    v_mfma_f32_16x16x32_bf16 v[68:71], v[236:239], v[132:135], v[68:71]
    s_add_u32 s22, s19, 0x400000
    s_add_u32 m0, s20, 0x0
    s_nop 0
    buffer_load_dwordx4 v3, s[4:7], s22 offen lds
    ds_read_b64_tr_b16 v[230:231], v5 offset:33824
    s_mov_b32 s23, 0xb800
    buffer_load_dwordx4 v[116:119], v7, s[8:11], s23 offen offset:1024 sc1
    s_waitcnt lgkmcnt(6)
    v_mfma_f32_16x16x32_bf16 v[72:75], v[240:243], v[128:131], v[72:75]
    ds_read_b64_tr_b16 v[232:233], v4 offset:33024
    v_mfma_f32_16x16x32_bf16 v[76:79], v[240:243], v[132:135], v[76:79]
    ds_read_b64_tr_b16 v[234:235], v4 offset:34048
    s_waitcnt lgkmcnt(6)
    v_mfma_f32_16x16x32_bf16 v[80:83], v[244:247], v[128:131], v[80:83]
    ds_read_b64_tr_b16 v[236:237], v5 offset:33056
    v_mfma_f32_16x16x32_bf16 v[84:87], v[244:247], v[132:135], v[84:87]
    ds_read_b64_tr_b16 v[238:239], v5 offset:34080
    s_waitcnt vmcnt(10) lgkmcnt(6)
    v_mfma_f32_16x16x32_bf16 v[24:27], v[224:227], v[88:91], v[24:27]
    ds_read_b64_tr_b16 v[240:241], v4 offset:33280
    s_waitcnt vmcnt(9)
    v_mfma_f32_16x16x32_bf16 v[28:31], v[224:227], v[92:95], v[28:31]
    ds_read_b64_tr_b16 v[242:243], v4 offset:34304
    s_waitcnt lgkmcnt(6)
    v_mfma_f32_16x16x32_bf16 v[32:35], v[228:231], v[88:91], v[32:35]
    ds_read_b64_tr_b16 v[244:245], v5 offset:33312
    v_mfma_f32_16x16x32_bf16 v[36:39], v[228:231], v[92:95], v[36:39]
    s_add_u32 s22, s19, 0x408000
    s_add_u32 m0, s20, 0x400
    s_nop 0
    buffer_load_dwordx4 v3, s[4:7], s22 offen lds
    ds_read_b64_tr_b16 v[246:247], v5 offset:34336
    s_mov_b32 s23, 0x4000
    buffer_load_dwordx4 v[120:123], v7, s[8:11], s23 offen offset:0 sc1
    s_waitcnt lgkmcnt(6)
    v_mfma_f32_16x16x32_bf16 v[40:43], v[232:235], v[88:91], v[40:43]
    ds_read_b64_tr_b16 v[224:225], v4 offset:33536
    v_mfma_f32_16x16x32_bf16 v[44:47], v[232:235], v[92:95], v[44:47]
    ds_read_b64_tr_b16 v[226:227], v4 offset:34560
    s_waitcnt lgkmcnt(6)
    v_mfma_f32_16x16x32_bf16 v[48:51], v[236:239], v[88:91], v[48:51]
    ds_read_b64_tr_b16 v[228:229], v5 offset:33568
    v_mfma_f32_16x16x32_bf16 v[52:55], v[236:239], v[92:95], v[52:55]
    ds_read_b64_tr_b16 v[230:231], v5 offset:34592
    s_waitcnt lgkmcnt(6)
    v_mfma_f32_16x16x32_bf16 v[56:59], v[240:243], v[88:91], v[56:59]
    ds_read_b64_tr_b16 v[232:233], v4 offset:40960
    v_mfma_f32_16x16x32_bf16 v[60:63], v[240:243], v[92:95], v[60:63]
    ds_read_b64_tr_b16 v[234:235], v4 offset:41984
    s_waitcnt lgkmcnt(6)
    v_mfma_f32_16x16x32_bf16 v[64:67], v[244:247], v[88:91], v[64:67]
    ds_read_b64_tr_b16 v[236:237], v5 offset:40992
    v_mfma_f32_16x16x32_bf16 v[68:71], v[244:247], v[92:95], v[68:71]
    ds_read_b64_tr_b16 v[238:239], v5 offset:42016
    s_mov_b32 s23, 0xc000
    buffer_load_dwordx4 v[124:127], v7, s[8:11], s23 offen offset:0 sc1
    s_waitcnt lgkmcnt(6)
    v_mfma_f32_16x16x32_bf16 v[72:75], v[224:227], v[88:91], v[72:75]
    ds_read_b64_tr_b16 v[240:241], v4 offset:41216
    v_lshrrev_b32 v21, 4, v1
    v_lshlrev_b32 v21, 9, v21
    v_and_b32 v20, 15, v1
    v_lshl_add_u32 v21, v20, 4, v21
    s_lshr_b32 s18, s12, 3
    s_lshl_b32 s18, s18, 11
    s_add_u32 s18, s18, 0x528100
    buffer_load_dwordx4 v[12:15], v21, s[8:11], s18 offen sc1
    v_mfma_f32_16x16x32_bf16 v[76:79], v[224:227], v[92:95], v[76:79]
    ds_read_b64_tr_b16 v[242:243], v4 offset:42240
    s_waitcnt lgkmcnt(6)
    v_mfma_f32_16x16x32_bf16 v[80:83], v[228:231], v[88:91], v[80:83]
    ds_read_b64_tr_b16 v[244:245], v5 offset:41248
    v_mfma_f32_16x16x32_bf16 v[84:87], v[228:231], v[92:95], v[84:87]
    ds_read_b64_tr_b16 v[246:247], v5 offset:42272
    s_waitcnt vmcnt(12) lgkmcnt(6)
    v_mfma_f32_16x16x32_bf16 v[24:27], v[232:235], v[96:99], v[24:27]
    ds_read_b64_tr_b16 v[224:225], v4 offset:41472
    s_waitcnt vmcnt(10)
    v_mfma_f32_16x16x32_bf16 v[28:31], v[232:235], v[100:103], v[28:31]
    ds_read_b64_tr_b16 v[226:227], v4 offset:42496
    s_waitcnt lgkmcnt(6)
    v_mfma_f32_16x16x32_bf16 v[32:35], v[236:239], v[96:99], v[32:35]
    ds_read_b64_tr_b16 v[228:229], v5 offset:41504
    v_mfma_f32_16x16x32_bf16 v[36:39], v[236:239], v[100:103], v[36:39]
    ds_read_b64_tr_b16 v[230:231], v5 offset:42528
    s_mov_b32 s23, 0x4000
    buffer_load_dwordx4 v[128:131], v7, s[8:11], s23 offen offset:1024 sc1
    s_waitcnt lgkmcnt(6)
    v_mfma_f32_16x16x32_bf16 v[40:43], v[240:243], v[96:99], v[40:43]
    ds_read_b64_tr_b16 v[232:233], v4 offset:41728
    v_mfma_f32_16x16x32_bf16 v[44:47], v[240:243], v[100:103], v[44:47]
    ds_read_b64_tr_b16 v[234:235], v4 offset:42752
    s_waitcnt lgkmcnt(6)
    v_mfma_f32_16x16x32_bf16 v[48:51], v[244:247], v[96:99], v[48:51]
    ds_read_b64_tr_b16 v[236:237], v5 offset:41760
    v_mfma_f32_16x16x32_bf16 v[52:55], v[244:247], v[100:103], v[52:55]
    ds_read_b64_tr_b16 v[238:239], v5 offset:42784
    s_waitcnt lgkmcnt(6)
    v_mfma_f32_16x16x32_bf16 v[56:59], v[224:227], v[96:99], v[56:59]
    v_mfma_f32_16x16x32_bf16 v[60:63], v[224:227], v[100:103], v[60:63]
    s_waitcnt vmcnt(10)
    s_barrier
    ds_read_b64_tr_b16 v[240:241], v4 offset:49152
    ds_read_b64_tr_b16 v[242:243], v4 offset:50176
    s_waitcnt lgkmcnt(6)
    v_mfma_f32_16x16x32_bf16 v[64:67], v[228:231], v[96:99], v[64:67]
    ds_read_b64_tr_b16 v[244:245], v5 offset:49184
    v_mfma_f32_16x16x32_bf16 v[68:71], v[228:231], v[100:103], v[68:71]
    s_add_u32 s22, s19, 0x480000
    s_add_u32 m0, s20, 0x4000
    s_nop 0
    buffer_load_dwordx4 v3, s[4:7], s22 offen lds
    ds_read_b64_tr_b16 v[246:247], v5 offset:50208
    s_mov_b32 s23, 0xc000
    buffer_load_dwordx4 v[132:135], v7, s[8:11], s23 offen offset:1024 sc1
    s_waitcnt lgkmcnt(6)
    v_mfma_f32_16x16x32_bf16 v[72:75], v[232:235], v[96:99], v[72:75]
    ds_read_b64_tr_b16 v[224:225], v4 offset:49408
    v_mfma_f32_16x16x32_bf16 v[76:79], v[232:235], v[100:103], v[76:79]
    ds_read_b64_tr_b16 v[226:227], v4 offset:50432
    s_waitcnt lgkmcnt(6)
    v_mfma_f32_16x16x32_bf16 v[80:83], v[236:239], v[96:99], v[80:83]
    ds_read_b64_tr_b16 v[228:229], v5 offset:49440
    v_mfma_f32_16x16x32_bf16 v[84:87], v[236:239], v[100:103], v[84:87]
    ds_read_b64_tr_b16 v[230:231], v5 offset:50464
    s_waitcnt vmcnt(11) lgkmcnt(6)
    v_mfma_f32_16x16x32_bf16 v[24:27], v[240:243], v[104:107], v[24:27]
    ds_read_b64_tr_b16 v[232:233], v4 offset:49664
    s_waitcnt vmcnt(10)
    v_mfma_f32_16x16x32_bf16 v[28:31], v[240:243], v[108:111], v[28:31]
    ds_read_b64_tr_b16 v[234:235], v4 offset:50688
    s_waitcnt lgkmcnt(6)
    v_mfma_f32_16x16x32_bf16 v[32:35], v[244:247], v[104:107], v[32:35]
    ds_read_b64_tr_b16 v[236:237], v5 offset:49696
    v_mfma_f32_16x16x32_bf16 v[36:39], v[244:247], v[108:111], v[36:39]
    s_add_u32 s22, s19, 0x488000
    s_add_u32 m0, s20, 0x4400
    s_nop 0
    buffer_load_dwordx4 v3, s[4:7], s22 offen lds
    ds_read_b64_tr_b16 v[238:239], v5 offset:50720
    s_mov_b32 s23, 0x4800
    buffer_load_dwordx4 v[88:91], v7, s[8:11], s23 offen offset:0 sc1
    s_waitcnt lgkmcnt(6)
    v_mfma_f32_16x16x32_bf16 v[40:43], v[224:227], v[104:107], v[40:43]
    ds_read_b64_tr_b16 v[240:241], v4 offset:49920
    v_mfma_f32_16x16x32_bf16 v[44:47], v[224:227], v[108:111], v[44:47]
    ds_read_b64_tr_b16 v[242:243], v4 offset:50944
    s_waitcnt lgkmcnt(6)
    v_mfma_f32_16x16x32_bf16 v[48:51], v[228:231], v[104:107], v[48:51]
    ds_read_b64_tr_b16 v[244:245], v5 offset:49952
    v_mfma_f32_16x16x32_bf16 v[52:55], v[228:231], v[108:111], v[52:55]
    ds_read_b64_tr_b16 v[246:247], v5 offset:50976
    s_waitcnt lgkmcnt(6)
    v_mfma_f32_16x16x32_bf16 v[56:59], v[232:235], v[104:107], v[56:59]
    ds_read_b64_tr_b16 v[224:225], v4 offset:57344
    v_mfma_f32_16x16x32_bf16 v[60:63], v[232:235], v[108:111], v[60:63]
    ds_read_b64_tr_b16 v[226:227], v4 offset:58368
    s_waitcnt lgkmcnt(6)
    v_mfma_f32_16x16x32_bf16 v[64:67], v[236:239], v[104:107], v[64:67]
    ds_read_b64_tr_b16 v[228:229], v5 offset:57376
    v_mfma_f32_16x16x32_bf16 v[68:71], v[236:239], v[108:111], v[68:71]
    ds_read_b64_tr_b16 v[230:231], v5 offset:58400
    s_mov_b32 s23, 0xc800
    buffer_load_dwordx4 v[92:95], v7, s[8:11], s23 offen offset:0 sc1
    s_waitcnt lgkmcnt(6)
    v_mfma_f32_16x16x32_bf16 v[72:75], v[240:243], v[104:107], v[72:75]
    ds_read_b64_tr_b16 v[232:233], v4 offset:57600
    v_mfma_f32_16x16x32_bf16 v[76:79], v[240:243], v[108:111], v[76:79]
    ds_read_b64_tr_b16 v[234:235], v4 offset:58624
    s_waitcnt lgkmcnt(6)
    v_mfma_f32_16x16x32_bf16 v[80:83], v[244:247], v[104:107], v[80:83]
    ds_read_b64_tr_b16 v[236:237], v5 offset:57632
    v_mfma_f32_16x16x32_bf16 v[84:87], v[244:247], v[108:111], v[84:87]
    ds_read_b64_tr_b16 v[238:239], v5 offset:58656
    s_waitcnt vmcnt(12) lgkmcnt(6)
    v_mfma_f32_16x16x32_bf16 v[24:27], v[224:227], v[112:115], v[24:27]
    ds_read_b64_tr_b16 v[240:241], v4 offset:57856
    s_waitcnt vmcnt(10)
    v_mfma_f32_16x16x32_bf16 v[28:31], v[224:227], v[116:119], v[28:31]
    ds_read_b64_tr_b16 v[242:243], v4 offset:58880
    s_waitcnt lgkmcnt(6)
    v_mfma_f32_16x16x32_bf16 v[32:35], v[228:231], v[112:115], v[32:35]
    ds_read_b64_tr_b16 v[244:245], v5 offset:57888
    v_mfma_f32_16x16x32_bf16 v[36:39], v[228:231], v[116:119], v[36:39]
    ds_read_b64_tr_b16 v[246:247], v5 offset:58912
    s_mov_b32 s23, 0x4800
    buffer_load_dwordx4 v[96:99], v7, s[8:11], s23 offen offset:1024 sc1
    s_waitcnt lgkmcnt(6)
    v_mfma_f32_16x16x32_bf16 v[40:43], v[232:235], v[112:115], v[40:43]
    ds_read_b64_tr_b16 v[224:225], v4 offset:58112
    v_mfma_f32_16x16x32_bf16 v[44:47], v[232:235], v[116:119], v[44:47]
    ds_read_b64_tr_b16 v[226:227], v4 offset:59136
    s_waitcnt lgkmcnt(6)
    v_mfma_f32_16x16x32_bf16 v[48:51], v[236:239], v[112:115], v[48:51]
    ds_read_b64_tr_b16 v[228:229], v5 offset:58144
    v_mfma_f32_16x16x32_bf16 v[52:55], v[236:239], v[116:119], v[52:55]
    ds_read_b64_tr_b16 v[230:231], v5 offset:59168
    s_waitcnt lgkmcnt(6)
    v_mfma_f32_16x16x32_bf16 v[56:59], v[240:243], v[112:115], v[56:59]
    v_mfma_f32_16x16x32_bf16 v[60:63], v[240:243], v[116:119], v[60:63]
    s_waitcnt vmcnt(10)
    s_barrier
    ds_read_b64_tr_b16 v[232:233], v4 offset:0
    ds_read_b64_tr_b16 v[234:235], v4 offset:1024
    s_waitcnt lgkmcnt(6)
    v_mfma_f32_16x16x32_bf16 v[64:67], v[244:247], v[112:115], v[64:67]
    ds_read_b64_tr_b16 v[236:237], v5 offset:32
    v_mfma_f32_16x16x32_bf16 v[68:71], v[244:247], v[116:119], v[68:71]
    s_add_u32 s22, s19, 0x500000
    s_add_u32 m0, s20, 0x8000
    s_nop 0
    buffer_load_dwordx4 v3, s[4:7], s22 offen lds
    ds_read_b64_tr_b16 v[238:239], v5 offset:1056
    s_mov_b32 s23, 0xc800
    buffer_load_dwordx4 v[100:103], v7, s[8:11], s23 offen offset:1024 sc1
    s_waitcnt lgkmcnt(6)
    v_mfma_f32_16x16x32_bf16 v[72:75], v[224:227], v[112:115], v[72:75]
    ds_read_b64_tr_b16 v[240:241], v4 offset:256
    v_mfma_f32_16x16x32_bf16 v[76:79], v[224:227], v[116:119], v[76:79]
    ds_read_b64_tr_b16 v[242:243], v4 offset:1280
    s_waitcnt lgkmcnt(6)
    v_mfma_f32_16x16x32_bf16 v[80:83], v[228:231], v[112:115], v[80:83]
    ds_read_b64_tr_b16 v[244:245], v5 offset:288
    v_mfma_f32_16x16x32_bf16 v[84:87], v[228:231], v[116:119], v[84:87]
    ds_read_b64_tr_b16 v[246:247], v5 offset:1312
    s_waitcnt vmcnt(11) lgkmcnt(6)
    v_mfma_f32_16x16x32_bf16 v[24:27], v[232:235], v[120:123], v[24:27]
    ds_read_b64_tr_b16 v[224:225], v4 offset:512
    s_waitcnt vmcnt(10)
    v_mfma_f32_16x16x32_bf16 v[28:31], v[232:235], v[124:127], v[28:31]
    ds_read_b64_tr_b16 v[226:227], v4 offset:1536
    s_waitcnt lgkmcnt(6)
    v_mfma_f32_16x16x32_bf16 v[32:35], v[236:239], v[120:123], v[32:35]
    ds_read_b64_tr_b16 v[228:229], v5 offset:544
    v_mfma_f32_16x16x32_bf16 v[36:39], v[236:239], v[124:127], v[36:39]
    s_add_u32 s22, s19, 0x508000
    s_add_u32 m0, s20, 0x8400
    s_nop 0
    buffer_load_dwordx4 v3, s[4:7], s22 offen lds
    ds_read_b64_tr_b16 v[230:231], v5 offset:1568
    s_mov_b32 s23, 0x5000
    buffer_load_dwordx4 v[104:107], v7, s[8:11], s23 offen offset:0 sc1
    s_waitcnt lgkmcnt(6)
    v_mfma_f32_16x16x32_bf16 v[40:43], v[240:243], v[120:123], v[40:43]
    ds_read_b64_tr_b16 v[232:233], v4 offset:768
    v_mfma_f32_16x16x32_bf16 v[44:47], v[240:243], v[124:127], v[44:47]
    ds_read_b64_tr_b16 v[234:235], v4 offset:1792
    s_waitcnt lgkmcnt(6)
    v_mfma_f32_16x16x32_bf16 v[48:51], v[244:247], v[120:123], v[48:51]
    ds_read_b64_tr_b16 v[236:237], v5 offset:800
    v_mfma_f32_16x16x32_bf16 v[52:55], v[244:247], v[124:127], v[52:55]
    ds_read_b64_tr_b16 v[238:239], v5 offset:1824
    s_waitcnt lgkmcnt(6)
    v_mfma_f32_16x16x32_bf16 v[56:59], v[224:227], v[120:123], v[56:59]
    ds_read_b64_tr_b16 v[240:241], v4 offset:8192
    v_mfma_f32_16x16x32_bf16 v[60:63], v[224:227], v[124:127], v[60:63]
    ds_read_b64_tr_b16 v[242:243], v4 offset:9216
    s_waitcnt lgkmcnt(6)
    v_mfma_f32_16x16x32_bf16 v[64:67], v[228:231], v[120:123], v[64:67]
    ds_read_b64_tr_b16 v[244:245], v5 offset:8224
    v_mfma_f32_16x16x32_bf16 v[68:71], v[228:231], v[124:127], v[68:71]
    ds_read_b64_tr_b16 v[246:247], v5 offset:9248
    s_mov_b32 s23, 0xd000
    buffer_load_dwordx4 v[108:111], v7, s[8:11], s23 offen offset:0 sc1
    s_waitcnt lgkmcnt(6)
    v_mfma_f32_16x16x32_bf16 v[72:75], v[232:235], v[120:123], v[72:75]
    ds_read_b64_tr_b16 v[224:225], v4 offset:8448
    v_mfma_f32_16x16x32_bf16 v[76:79], v[232:235], v[124:127], v[76:79]
    ds_read_b64_tr_b16 v[226:227], v4 offset:9472
    s_waitcnt lgkmcnt(6)
    v_mfma_f32_16x16x32_bf16 v[80:83], v[236:239], v[120:123], v[80:83]
    ds_read_b64_tr_b16 v[228:229], v5 offset:8480
    v_mfma_f32_16x16x32_bf16 v[84:87], v[236:239], v[124:127], v[84:87]
    ds_read_b64_tr_b16 v[230:231], v5 offset:9504
    s_waitcnt vmcnt(11) lgkmcnt(6)
    v_mfma_f32_16x16x32_bf16 v[24:27], v[240:243], v[128:131], v[24:27]
    ds_read_b64_tr_b16 v[232:233], v4 offset:8704
    s_waitcnt vmcnt(9)
    v_mfma_f32_16x16x32_bf16 v[28:31], v[240:243], v[132:135], v[28:31]
    ds_read_b64_tr_b16 v[234:235], v4 offset:9728
    s_waitcnt lgkmcnt(6)
    v_mfma_f32_16x16x32_bf16 v[32:35], v[244:247], v[128:131], v[32:35]
    ds_read_b64_tr_b16 v[236:237], v5 offset:8736
    v_mfma_f32_16x16x32_bf16 v[36:39], v[244:247], v[132:135], v[36:39]
    ds_read_b64_tr_b16 v[238:239], v5 offset:9760
    s_mov_b32 s23, 0x5000
    buffer_load_dwordx4 v[112:115], v7, s[8:11], s23 offen offset:1024 sc1
    s_waitcnt lgkmcnt(6)
    v_mfma_f32_16x16x32_bf16 v[40:43], v[224:227], v[128:131], v[40:43]
    ds_read_b64_tr_b16 v[240:241], v4 offset:8960
    v_mfma_f32_16x16x32_bf16 v[44:47], v[224:227], v[132:135], v[44:47]
    ds_read_b64_tr_b16 v[242:243], v4 offset:9984
    s_waitcnt lgkmcnt(6)
    v_mfma_f32_16x16x32_bf16 v[48:51], v[228:231], v[128:131], v[48:51]
    ds_read_b64_tr_b16 v[244:245], v5 offset:8992
    v_mfma_f32_16x16x32_bf16 v[52:55], v[228:231], v[132:135], v[52:55]
    ds_read_b64_tr_b16 v[246:247], v5 offset:10016
    s_waitcnt lgkmcnt(6)
    v_mfma_f32_16x16x32_bf16 v[56:59], v[232:235], v[128:131], v[56:59]
    v_mfma_f32_16x16x32_bf16 v[60:63], v[232:235], v[132:135], v[60:63]
    s_waitcnt vmcnt(9)
    s_barrier
    ds_read_b64_tr_b16 v[224:225], v4 offset:16384
    ds_read_b64_tr_b16 v[226:227], v4 offset:17408
    s_waitcnt lgkmcnt(6)
    v_mfma_f32_16x16x32_bf16 v[64:67], v[236:239], v[128:131], v[64:67]
    ds_read_b64_tr_b16 v[228:229], v5 offset:16416
    v_mfma_f32_16x16x32_bf16 v[68:71], v[236:239], v[132:135], v[68:71]
    s_add_u32 s22, s19, 0x580000
    s_add_u32 m0, s20, 0xc000
    s_nop 0
    buffer_load_dwordx4 v3, s[4:7], s22 offen lds
    ds_read_b64_tr_b16 v[230:231], v5 offset:17440
    s_mov_b32 s23, 0xd000
    buffer_load_dwordx4 v[116:119], v7, s[8:11], s23 offen offset:1024 sc1
    s_waitcnt lgkmcnt(6)
    v_mfma_f32_16x16x32_bf16 v[72:75], v[240:243], v[128:131], v[72:75]
    ds_read_b64_tr_b16 v[232:233], v4 offset:16640
    v_mfma_f32_16x16x32_bf16 v[76:79], v[240:243], v[132:135], v[76:79]
    ds_read_b64_tr_b16 v[234:235], v4 offset:17664
    s_waitcnt lgkmcnt(6)
    v_mfma_f32_16x16x32_bf16 v[80:83], v[244:247], v[128:131], v[80:83]
    ds_read_b64_tr_b16 v[236:237], v5 offset:16672
    v_mfma_f32_16x16x32_bf16 v[84:87], v[244:247], v[132:135], v[84:87]
    ds_read_b64_tr_b16 v[238:239], v5 offset:17696
    s_waitcnt vmcnt(10) lgkmcnt(6)
    v_mfma_f32_16x16x32_bf16 v[24:27], v[224:227], v[88:91], v[24:27]
    ds_read_b64_tr_b16 v[240:241], v4 offset:16896
    s_waitcnt vmcnt(9)
    v_mfma_f32_16x16x32_bf16 v[28:31], v[224:227], v[92:95], v[28:31]
    ds_read_b64_tr_b16 v[242:243], v4 offset:17920
    s_waitcnt lgkmcnt(6)
    v_mfma_f32_16x16x32_bf16 v[32:35], v[228:231], v[88:91], v[32:35]
    ds_read_b64_tr_b16 v[244:245], v5 offset:16928
    v_mfma_f32_16x16x32_bf16 v[36:39], v[228:231], v[92:95], v[36:39]
    s_add_u32 s22, s19, 0x588000
    s_add_u32 m0, s20, 0xc400
    s_nop 0
    buffer_load_dwordx4 v3, s[4:7], s22 offen lds
    ds_read_b64_tr_b16 v[246:247], v5 offset:17952
    s_mov_b32 s23, 0x5800
    buffer_load_dwordx4 v[120:123], v7, s[8:11], s23 offen offset:0 sc1
    s_waitcnt lgkmcnt(6)
    v_mfma_f32_16x16x32_bf16 v[40:43], v[232:235], v[88:91], v[40:43]
    ds_read_b64_tr_b16 v[224:225], v4 offset:17152
    v_mfma_f32_16x16x32_bf16 v[44:47], v[232:235], v[92:95], v[44:47]
    ds_read_b64_tr_b16 v[226:227], v4 offset:18176
    s_waitcnt lgkmcnt(6)
    v_mfma_f32_16x16x32_bf16 v[48:51], v[236:239], v[88:91], v[48:51]
    ds_read_b64_tr_b16 v[228:229], v5 offset:17184
    v_mfma_f32_16x16x32_bf16 v[52:55], v[236:239], v[92:95], v[52:55]
    ds_read_b64_tr_b16 v[230:231], v5 offset:18208
    s_waitcnt lgkmcnt(6)
    v_mfma_f32_16x16x32_bf16 v[56:59], v[240:243], v[88:91], v[56:59]
    ds_read_b64_tr_b16 v[232:233], v4 offset:24576
    v_mfma_f32_16x16x32_bf16 v[60:63], v[240:243], v[92:95], v[60:63]
    ds_read_b64_tr_b16 v[234:235], v4 offset:25600
    s_waitcnt lgkmcnt(6)
    v_mfma_f32_16x16x32_bf16 v[64:67], v[244:247], v[88:91], v[64:67]
    ds_read_b64_tr_b16 v[236:237], v5 offset:24608
    v_mfma_f32_16x16x32_bf16 v[68:71], v[244:247], v[92:95], v[68:71]
    ds_read_b64_tr_b16 v[238:239], v5 offset:25632
    s_mov_b32 s23, 0xd800
    buffer_load_dwordx4 v[124:127], v7, s[8:11], s23 offen offset:0 sc1
    s_waitcnt lgkmcnt(6)
    v_mfma_f32_16x16x32_bf16 v[72:75], v[224:227], v[88:91], v[72:75]
    ds_read_b64_tr_b16 v[240:241], v4 offset:24832
    v_xor_b32 v8, s28, v12
    v_xor_b32 v20, s28, v13
    v_or_b32 v8, v8, v20
    v_xor_b32 v20, s28, v14
    v_or_b32 v8, v8, v20
    v_xor_b32 v20, s28, v15
    v_or_b32 v8, v8, v20
    v_cmp_ne_u32 vcc, 0, v8
    s_cbranch_vccnz adaLN_cond__sliding_block_cached__moe_arch_mod__prompt_kernel_kv16r
adaLN_cond__sliding_block_cached__moe_arch_mod__prompt_kernel_kv16b:
    v_mfma_f32_16x16x32_bf16 v[76:79], v[224:227], v[92:95], v[76:79]
    ds_read_b64_tr_b16 v[242:243], v4 offset:25856
    v_mov_b32 v20, 0
    s_mov_b32 s16, 0x564000
    buffer_load_dword v8, v20, s[8:11], s16 offen sc1
    s_waitcnt lgkmcnt(6)
    v_mfma_f32_16x16x32_bf16 v[80:83], v[228:231], v[88:91], v[80:83]
    ds_read_b64_tr_b16 v[244:245], v5 offset:24864
    v_mfma_f32_16x16x32_bf16 v[84:87], v[228:231], v[92:95], v[84:87]
    ds_read_b64_tr_b16 v[246:247], v5 offset:25888
    s_waitcnt vmcnt(12) lgkmcnt(6)
    v_mfma_f32_16x16x32_bf16 v[24:27], v[232:235], v[96:99], v[24:27]
    ds_read_b64_tr_b16 v[224:225], v4 offset:25088
    s_waitcnt vmcnt(10)
    v_mfma_f32_16x16x32_bf16 v[28:31], v[232:235], v[100:103], v[28:31]
    ds_read_b64_tr_b16 v[226:227], v4 offset:26112
    s_waitcnt lgkmcnt(6)
    v_mfma_f32_16x16x32_bf16 v[32:35], v[236:239], v[96:99], v[32:35]
    ds_read_b64_tr_b16 v[228:229], v5 offset:25120
    v_mfma_f32_16x16x32_bf16 v[36:39], v[236:239], v[100:103], v[36:39]
    ds_read_b64_tr_b16 v[230:231], v5 offset:26144
    s_mov_b32 s23, 0x5800
    buffer_load_dwordx4 v[128:131], v7, s[8:11], s23 offen offset:1024 sc1
    s_waitcnt lgkmcnt(6)
    v_mfma_f32_16x16x32_bf16 v[40:43], v[240:243], v[96:99], v[40:43]
    ds_read_b64_tr_b16 v[232:233], v4 offset:25344
    s_mov_b64 s[76:77], s[54:55]
    s_mov_b32 s78, 0xc00000
    s_mov_b32 s79, 0x20000
    v_bfe_u32 v20, v1, 2, 2
    v_lshlrev_b32 v20, 12, v20
    v_add_u32 v6, v3, v20
    s_lshr_b32 s16, s2, 5
    s_lshl_b32 s16, s16, 7
    s_lshl_b32 s17, s3, 3
    s_add_u32 s16, s16, s17
    s_mul_i32 s14, s16, 12288
    s_and_b32 s16, s2, 31
    s_lshl_b32 s16, s16, 8
    s_add_u32 s14, s14, s16
    s_add_u32 s14, s14, 4096
    v_mfma_f32_16x16x32_bf16 v[44:47], v[240:243], v[100:103], v[44:47]
    ds_read_b64_tr_b16 v[234:235], v4 offset:26368
    s_waitcnt lgkmcnt(6)
    v_mfma_f32_16x16x32_bf16 v[48:51], v[244:247], v[96:99], v[48:51]
    ds_read_b64_tr_b16 v[236:237], v5 offset:25376
    v_mfma_f32_16x16x32_bf16 v[52:55], v[244:247], v[100:103], v[52:55]
    ds_read_b64_tr_b16 v[238:239], v5 offset:26400
    s_waitcnt lgkmcnt(6)
    v_mfma_f32_16x16x32_bf16 v[56:59], v[224:227], v[96:99], v[56:59]
    v_mfma_f32_16x16x32_bf16 v[60:63], v[224:227], v[100:103], v[60:63]
    s_waitcnt vmcnt(10)
    s_barrier
    ds_read_b64_tr_b16 v[240:241], v4 offset:32768
    ds_read_b64_tr_b16 v[242:243], v4 offset:33792
    s_waitcnt lgkmcnt(6)
    v_mfma_f32_16x16x32_bf16 v[64:67], v[228:231], v[96:99], v[64:67]
    ds_read_b64_tr_b16 v[244:245], v5 offset:32800
    v_mfma_f32_16x16x32_bf16 v[68:71], v[228:231], v[100:103], v[68:71]
    s_add_u32 s22, s19, 0x600000
    s_add_u32 m0, s20, 0x0
    s_nop 0
    buffer_load_dwordx4 v3, s[4:7], s22 offen lds
    ds_read_b64_tr_b16 v[246:247], v5 offset:33824
    s_mov_b32 s23, 0xd800
    buffer_load_dwordx4 v[132:135], v7, s[8:11], s23 offen offset:1024 sc1
    s_waitcnt lgkmcnt(6)
    v_mfma_f32_16x16x32_bf16 v[72:75], v[232:235], v[96:99], v[72:75]
    ds_read_b64_tr_b16 v[224:225], v4 offset:33024
    v_mfma_f32_16x16x32_bf16 v[76:79], v[232:235], v[100:103], v[76:79]
    ds_read_b64_tr_b16 v[226:227], v4 offset:34048
    s_waitcnt lgkmcnt(6)
    v_mfma_f32_16x16x32_bf16 v[80:83], v[236:239], v[96:99], v[80:83]
    ds_read_b64_tr_b16 v[228:229], v5 offset:33056
    v_mfma_f32_16x16x32_bf16 v[84:87], v[236:239], v[100:103], v[84:87]
    ds_read_b64_tr_b16 v[230:231], v5 offset:34080
    s_waitcnt vmcnt(11) lgkmcnt(6)
    v_mfma_f32_16x16x32_bf16 v[24:27], v[240:243], v[104:107], v[24:27]
    ds_read_b64_tr_b16 v[232:233], v4 offset:33280
    s_waitcnt vmcnt(10)
    v_mfma_f32_16x16x32_bf16 v[28:31], v[240:243], v[108:111], v[28:31]
    ds_read_b64_tr_b16 v[234:235], v4 offset:34304
    s_waitcnt lgkmcnt(6)
    v_mfma_f32_16x16x32_bf16 v[32:35], v[244:247], v[104:107], v[32:35]
    ds_read_b64_tr_b16 v[236:237], v5 offset:33312
    v_mfma_f32_16x16x32_bf16 v[36:39], v[244:247], v[108:111], v[36:39]
    s_add_u32 s22, s19, 0x608000
    s_add_u32 m0, s20, 0x400
    s_nop 0
    buffer_load_dwordx4 v3, s[4:7], s22 offen lds
    ds_read_b64_tr_b16 v[238:239], v5 offset:34336
    s_mov_b32 s23, 0x6000
    buffer_load_dwordx4 v[88:91], v7, s[8:11], s23 offen offset:0 sc1
    s_waitcnt lgkmcnt(6)
    v_mfma_f32_16x16x32_bf16 v[40:43], v[224:227], v[104:107], v[40:43]
    ds_read_b64_tr_b16 v[240:241], v4 offset:33536
    v_mfma_f32_16x16x32_bf16 v[44:47], v[224:227], v[108:111], v[44:47]
    ds_read_b64_tr_b16 v[242:243], v4 offset:34560
    s_waitcnt lgkmcnt(6)
    v_mfma_f32_16x16x32_bf16 v[48:51], v[228:231], v[104:107], v[48:51]
    ds_read_b64_tr_b16 v[244:245], v5 offset:33568
    v_mfma_f32_16x16x32_bf16 v[52:55], v[228:231], v[108:111], v[52:55]
    ds_read_b64_tr_b16 v[246:247], v5 offset:34592
    s_waitcnt lgkmcnt(6)
    v_mfma_f32_16x16x32_bf16 v[56:59], v[232:235], v[104:107], v[56:59]
    ds_read_b64_tr_b16 v[224:225], v4 offset:40960
    v_mfma_f32_16x16x32_bf16 v[60:63], v[232:235], v[108:111], v[60:63]
    ds_read_b64_tr_b16 v[226:227], v4 offset:41984
    s_waitcnt lgkmcnt(6)
    v_mfma_f32_16x16x32_bf16 v[64:67], v[236:239], v[104:107], v[64:67]
    ds_read_b64_tr_b16 v[228:229], v5 offset:40992
    v_mfma_f32_16x16x32_bf16 v[68:71], v[236:239], v[108:111], v[68:71]
    ds_read_b64_tr_b16 v[230:231], v5 offset:42016
    s_mov_b32 s23, 0xe000
    buffer_load_dwordx4 v[92:95], v7, s[8:11], s23 offen offset:0 sc1
    s_waitcnt lgkmcnt(6)
    v_mfma_f32_16x16x32_bf16 v[72:75], v[240:243], v[104:107], v[72:75]
    ds_read_b64_tr_b16 v[232:233], v4 offset:41216
    v_mfma_f32_16x16x32_bf16 v[76:79], v[240:243], v[108:111], v[76:79]
    ds_read_b64_tr_b16 v[234:235], v4 offset:42240
    s_waitcnt lgkmcnt(6)
    v_mfma_f32_16x16x32_bf16 v[80:83], v[244:247], v[104:107], v[80:83]
    ds_read_b64_tr_b16 v[236:237], v5 offset:41248
    v_mfma_f32_16x16x32_bf16 v[84:87], v[244:247], v[108:111], v[84:87]
    ds_read_b64_tr_b16 v[238:239], v5 offset:42272
    s_waitcnt vmcnt(12) lgkmcnt(6)
    v_mfma_f32_16x16x32_bf16 v[24:27], v[224:227], v[112:115], v[24:27]
    ds_read_b64_tr_b16 v[240:241], v4 offset:41472
    s_add_u32 s22, s14, 0x0
    s_add_u32 m0, s20, 0x10000
    s_nop 0
    buffer_load_dwordx4 v6, s[76:79], s22 offen lds
    s_waitcnt vmcnt(11)
    v_mfma_f32_16x16x32_bf16 v[28:31], v[224:227], v[116:119], v[28:31]
    ds_read_b64_tr_b16 v[242:243], v4 offset:42496
    s_waitcnt lgkmcnt(6)
    v_mfma_f32_16x16x32_bf16 v[32:35], v[228:231], v[112:115], v[32:35]
    ds_read_b64_tr_b16 v[244:245], v5 offset:41504
    v_mfma_f32_16x16x32_bf16 v[36:39], v[228:231], v[116:119], v[36:39]
    ds_read_b64_tr_b16 v[246:247], v5 offset:42528
    s_mov_b32 s23, 0x6000
    buffer_load_dwordx4 v[96:99], v7, s[8:11], s23 offen offset:1024 sc1
    s_waitcnt lgkmcnt(6)
    v_mfma_f32_16x16x32_bf16 v[40:43], v[232:235], v[112:115], v[40:43]
    ds_read_b64_tr_b16 v[224:225], v4 offset:41728
    s_add_u32 s22, s14, 0xc000
    s_add_u32 m0, s20, 0x10400
    s_nop 0
    buffer_load_dwordx4 v6, s[76:79], s22 offen lds
    v_mfma_f32_16x16x32_bf16 v[44:47], v[232:235], v[116:119], v[44:47]
    ds_read_b64_tr_b16 v[226:227], v4 offset:42752
    s_waitcnt lgkmcnt(6)
    v_mfma_f32_16x16x32_bf16 v[48:51], v[236:239], v[112:115], v[48:51]
    ds_read_b64_tr_b16 v[228:229], v5 offset:41760
    v_mfma_f32_16x16x32_bf16 v[52:55], v[236:239], v[116:119], v[52:55]
    ds_read_b64_tr_b16 v[230:231], v5 offset:42784
    s_waitcnt lgkmcnt(6)
    v_mfma_f32_16x16x32_bf16 v[56:59], v[240:243], v[112:115], v[56:59]
    v_mfma_f32_16x16x32_bf16 v[60:63], v[240:243], v[116:119], v[60:63]
    s_waitcnt vmcnt(12)
    s_barrier
    ds_read_b64_tr_b16 v[232:233], v4 offset:49152
    ds_read_b64_tr_b16 v[234:235], v4 offset:50176
    s_waitcnt lgkmcnt(6)
    v_mfma_f32_16x16x32_bf16 v[64:67], v[244:247], v[112:115], v[64:67]
    ds_read_b64_tr_b16 v[236:237], v5 offset:49184
    v_mfma_f32_16x16x32_bf16 v[68:71], v[244:247], v[116:119], v[68:71]
    s_add_u32 s22, s19, 0x680000
    s_add_u32 m0, s20, 0x4000
    s_nop 0
    buffer_load_dwordx4 v3, s[4:7], s22 offen lds
    ds_read_b64_tr_b16 v[238:239], v5 offset:50208
    s_mov_b32 s23, 0xe000
    buffer_load_dwordx4 v[100:103], v7, s[8:11], s23 offen offset:1024 sc1
    s_waitcnt lgkmcnt(6)
    v_mfma_f32_16x16x32_bf16 v[72:75], v[224:227], v[112:115], v[72:75]
    ds_read_b64_tr_b16 v[240:241], v4 offset:49408
    v_mfma_f32_16x16x32_bf16 v[76:79], v[224:227], v[116:119], v[76:79]
    ds_read_b64_tr_b16 v[242:243], v4 offset:50432
    s_waitcnt lgkmcnt(6)
    v_mfma_f32_16x16x32_bf16 v[80:83], v[228:231], v[112:115], v[80:83]
    ds_read_b64_tr_b16 v[244:245], v5 offset:49440
    v_mfma_f32_16x16x32_bf16 v[84:87], v[228:231], v[116:119], v[84:87]
    ds_read_b64_tr_b16 v[246:247], v5 offset:50464
    s_waitcnt vmcnt(13) lgkmcnt(6)
    v_mfma_f32_16x16x32_bf16 v[24:27], v[232:235], v[120:123], v[24:27]
    ds_read_b64_tr_b16 v[224:225], v4 offset:49664
    s_waitcnt vmcnt(12)
    v_mfma_f32_16x16x32_bf16 v[28:31], v[232:235], v[124:127], v[28:31]
    ds_read_b64_tr_b16 v[226:227], v4 offset:50688
    s_waitcnt lgkmcnt(6)
    v_mfma_f32_16x16x32_bf16 v[32:35], v[236:239], v[120:123], v[32:35]
    ds_read_b64_tr_b16 v[228:229], v5 offset:49696
    v_mfma_f32_16x16x32_bf16 v[36:39], v[236:239], v[124:127], v[36:39]
    s_add_u32 s22, s19, 0x688000
    s_add_u32 m0, s20, 0x4400
    s_nop 0
    buffer_load_dwordx4 v3, s[4:7], s22 offen lds
    ds_read_b64_tr_b16 v[230:231], v5 offset:50720
    s_mov_b32 s23, 0x6800
    buffer_load_dwordx4 v[104:107], v7, s[8:11], s23 offen offset:0 sc1
    s_waitcnt lgkmcnt(6)
    v_mfma_f32_16x16x32_bf16 v[40:43], v[240:243], v[120:123], v[40:43]
    ds_read_b64_tr_b16 v[232:233], v4 offset:49920
    v_mfma_f32_16x16x32_bf16 v[44:47], v[240:243], v[124:127], v[44:47]
    ds_read_b64_tr_b16 v[234:235], v4 offset:50944
    s_waitcnt lgkmcnt(6)
    v_mfma_f32_16x16x32_bf16 v[48:51], v[244:247], v[120:123], v[48:51]
    ds_read_b64_tr_b16 v[236:237], v5 offset:49952
    v_mfma_f32_16x16x32_bf16 v[52:55], v[244:247], v[124:127], v[52:55]
    ds_read_b64_tr_b16 v[238:239], v5 offset:50976
    s_waitcnt lgkmcnt(6)
    v_mfma_f32_16x16x32_bf16 v[56:59], v[224:227], v[120:123], v[56:59]
    ds_read_b64_tr_b16 v[240:241], v4 offset:57344
    v_mfma_f32_16x16x32_bf16 v[60:63], v[224:227], v[124:127], v[60:63]
    ds_read_b64_tr_b16 v[242:243], v4 offset:58368
    s_waitcnt lgkmcnt(6)
    v_mfma_f32_16x16x32_bf16 v[64:67], v[228:231], v[120:123], v[64:67]
    ds_read_b64_tr_b16 v[244:245], v5 offset:57376
    v_mfma_f32_16x16x32_bf16 v[68:71], v[228:231], v[124:127], v[68:71]
    ds_read_b64_tr_b16 v[246:247], v5 offset:58400
    s_mov_b32 s23, 0xe800
    buffer_load_dwordx4 v[108:111], v7, s[8:11], s23 offen offset:0 sc1
    s_waitcnt lgkmcnt(6)
    v_mfma_f32_16x16x32_bf16 v[72:75], v[232:235], v[120:123], v[72:75]
    ds_read_b64_tr_b16 v[224:225], v4 offset:57600
    v_mfma_f32_16x16x32_bf16 v[76:79], v[232:235], v[124:127], v[76:79]
    ds_read_b64_tr_b16 v[226:227], v4 offset:58624
    s_waitcnt lgkmcnt(6)
    v_mfma_f32_16x16x32_bf16 v[80:83], v[236:239], v[120:123], v[80:83]
    ds_read_b64_tr_b16 v[228:229], v5 offset:57632
    v_mfma_f32_16x16x32_bf16 v[84:87], v[236:239], v[124:127], v[84:87]
    ds_read_b64_tr_b16 v[230:231], v5 offset:58656
    s_waitcnt vmcnt(13) lgkmcnt(6)
    v_mfma_f32_16x16x32_bf16 v[24:27], v[240:243], v[128:131], v[24:27]
    ds_read_b64_tr_b16 v[232:233], v4 offset:57856
    s_add_u32 s22, s14, 0xc0000
    s_add_u32 m0, s20, 0x14000
    s_nop 0
    buffer_load_dwordx4 v6, s[76:79], s22 offen lds
    s_waitcnt vmcnt(12)
    v_mfma_f32_16x16x32_bf16 v[28:31], v[240:243], v[132:135], v[28:31]
    ds_read_b64_tr_b16 v[234:235], v4 offset:58880
    s_waitcnt lgkmcnt(6)
    v_mfma_f32_16x16x32_bf16 v[32:35], v[244:247], v[128:131], v[32:35]
    ds_read_b64_tr_b16 v[236:237], v5 offset:57888
    v_mfma_f32_16x16x32_bf16 v[36:39], v[244:247], v[132:135], v[36:39]
    ds_read_b64_tr_b16 v[238:239], v5 offset:58912
    s_mov_b32 s23, 0x6800
    buffer_load_dwordx4 v[112:115], v7, s[8:11], s23 offen offset:1024 sc1
    s_waitcnt lgkmcnt(6)
    v_mfma_f32_16x16x32_bf16 v[40:43], v[224:227], v[128:131], v[40:43]
    ds_read_b64_tr_b16 v[240:241], v4 offset:58112
    s_add_u32 s22, s14, 0xcc000
    s_add_u32 m0, s20, 0x14400
    s_nop 0
    buffer_load_dwordx4 v6, s[76:79], s22 offen lds
    v_mfma_f32_16x16x32_bf16 v[44:47], v[224:227], v[132:135], v[44:47]
    ds_read_b64_tr_b16 v[242:243], v4 offset:59136
    s_waitcnt lgkmcnt(6)
    v_mfma_f32_16x16x32_bf16 v[48:51], v[228:231], v[128:131], v[48:51]
    ds_read_b64_tr_b16 v[244:245], v5 offset:58144
    v_mfma_f32_16x16x32_bf16 v[52:55], v[228:231], v[132:135], v[52:55]
    ds_read_b64_tr_b16 v[246:247], v5 offset:59168
    s_waitcnt lgkmcnt(6)
    v_mfma_f32_16x16x32_bf16 v[56:59], v[232:235], v[128:131], v[56:59]
    v_mfma_f32_16x16x32_bf16 v[60:63], v[232:235], v[132:135], v[60:63]
    s_waitcnt vmcnt(13)
    s_barrier
    ds_read_b64_tr_b16 v[224:225], v4 offset:0
    ds_read_b64_tr_b16 v[226:227], v4 offset:1024
    s_waitcnt lgkmcnt(6)
    v_mfma_f32_16x16x32_bf16 v[64:67], v[236:239], v[128:131], v[64:67]
    ds_read_b64_tr_b16 v[228:229], v5 offset:32
    v_mfma_f32_16x16x32_bf16 v[68:71], v[236:239], v[132:135], v[68:71]
    s_add_u32 s22, s19, 0x700000
    s_add_u32 m0, s20, 0x8000
    s_nop 0
    buffer_load_dwordx4 v3, s[4:7], s22 offen lds
    ds_read_b64_tr_b16 v[230:231], v5 offset:1056
    s_mov_b32 s23, 0xe800
    buffer_load_dwordx4 v[116:119], v7, s[8:11], s23 offen offset:1024 sc1
    s_waitcnt lgkmcnt(6)
    v_mfma_f32_16x16x32_bf16 v[72:75], v[240:243], v[128:131], v[72:75]
    ds_read_b64_tr_b16 v[232:233], v4 offset:256
    v_mfma_f32_16x16x32_bf16 v[76:79], v[240:243], v[132:135], v[76:79]
    ds_read_b64_tr_b16 v[234:235], v4 offset:1280
    s_waitcnt lgkmcnt(6)
    v_mfma_f32_16x16x32_bf16 v[80:83], v[244:247], v[128:131], v[80:83]
    ds_read_b64_tr_b16 v[236:237], v5 offset:288
    v_mfma_f32_16x16x32_bf16 v[84:87], v[244:247], v[132:135], v[84:87]
    ds_read_b64_tr_b16 v[238:239], v5 offset:1312
    s_waitcnt vmcnt(14) lgkmcnt(6)
    v_mfma_f32_16x16x32_bf16 v[24:27], v[224:227], v[88:91], v[24:27]
    ds_read_b64_tr_b16 v[240:241], v4 offset:512
    s_waitcnt vmcnt(13)
    v_mfma_f32_16x16x32_bf16 v[28:31], v[224:227], v[92:95], v[28:31]
    ds_read_b64_tr_b16 v[242:243], v4 offset:1536
    s_waitcnt lgkmcnt(6)
    v_mfma_f32_16x16x32_bf16 v[32:35], v[228:231], v[88:91], v[32:35]
    ds_read_b64_tr_b16 v[244:245], v5 offset:544
    v_mfma_f32_16x16x32_bf16 v[36:39], v[228:231], v[92:95], v[36:39]
    s_add_u32 s22, s19, 0x708000
    s_add_u32 m0, s20, 0x8400
    s_nop 0
    buffer_load_dwordx4 v3, s[4:7], s22 offen lds
    ds_read_b64_tr_b16 v[246:247], v5 offset:1568
    s_mov_b32 s23, 0x7000
    buffer_load_dwordx4 v[120:123], v7, s[8:11], s23 offen offset:0 sc1
    s_waitcnt lgkmcnt(6)
    v_mfma_f32_16x16x32_bf16 v[40:43], v[232:235], v[88:91], v[40:43]
    ds_read_b64_tr_b16 v[224:225], v4 offset:768
    v_mfma_f32_16x16x32_bf16 v[44:47], v[232:235], v[92:95], v[44:47]
    ds_read_b64_tr_b16 v[226:227], v4 offset:1792
    s_waitcnt lgkmcnt(6)
    v_mfma_f32_16x16x32_bf16 v[48:51], v[236:239], v[88:91], v[48:51]
    ds_read_b64_tr_b16 v[228:229], v5 offset:800
    v_mfma_f32_16x16x32_bf16 v[52:55], v[236:239], v[92:95], v[52:55]
    ds_read_b64_tr_b16 v[230:231], v5 offset:1824
    s_waitcnt lgkmcnt(6)
    v_mfma_f32_16x16x32_bf16 v[56:59], v[240:243], v[88:91], v[56:59]
    ds_read_b64_tr_b16 v[232:233], v4 offset:8192
    v_mfma_f32_16x16x32_bf16 v[60:63], v[240:243], v[92:95], v[60:63]
    ds_read_b64_tr_b16 v[234:235], v4 offset:9216
    s_waitcnt lgkmcnt(6)
    v_mfma_f32_16x16x32_bf16 v[64:67], v[244:247], v[88:91], v[64:67]
    ds_read_b64_tr_b16 v[236:237], v5 offset:8224
    v_mfma_f32_16x16x32_bf16 v[68:71], v[244:247], v[92:95], v[68:71]
    ds_read_b64_tr_b16 v[238:239], v5 offset:9248
    s_mov_b32 s23, 0xf000
    buffer_load_dwordx4 v[124:127], v7, s[8:11], s23 offen offset:0 sc1
    s_waitcnt lgkmcnt(6)
    v_mfma_f32_16x16x32_bf16 v[72:75], v[224:227], v[88:91], v[72:75]
    ds_read_b64_tr_b16 v[240:241], v4 offset:8448
    v_mfma_f32_16x16x32_bf16 v[76:79], v[224:227], v[92:95], v[76:79]
    ds_read_b64_tr_b16 v[242:243], v4 offset:9472
    s_waitcnt lgkmcnt(6)
    v_mfma_f32_16x16x32_bf16 v[80:83], v[228:231], v[88:91], v[80:83]
    ds_read_b64_tr_b16 v[244:245], v5 offset:8480
    v_mfma_f32_16x16x32_bf16 v[84:87], v[228:231], v[92:95], v[84:87]
    ds_read_b64_tr_b16 v[246:247], v5 offset:9504
    s_waitcnt vmcnt(14) lgkmcnt(6)
    v_mfma_f32_16x16x32_bf16 v[24:27], v[232:235], v[96:99], v[24:27]
    ds_read_b64_tr_b16 v[224:225], v4 offset:8704
    s_add_u32 s22, s21, 0x0
    s_add_u32 m0, s20, 0x18000
    s_nop 0
    buffer_load_dwordx4 v2, s[8:11], s22 offen sc1 lds
    s_waitcnt vmcnt(12)
    v_mfma_f32_16x16x32_bf16 v[28:31], v[232:235], v[100:103], v[28:31]
    ds_read_b64_tr_b16 v[226:227], v4 offset:9728
    s_waitcnt lgkmcnt(6)
    v_mfma_f32_16x16x32_bf16 v[32:35], v[236:239], v[96:99], v[32:35]
    ds_read_b64_tr_b16 v[228:229], v5 offset:8736
    v_mfma_f32_16x16x32_bf16 v[36:39], v[236:239], v[100:103], v[36:39]
    ds_read_b64_tr_b16 v[230:231], v5 offset:9760
    s_mov_b32 s23, 0x7000
    buffer_load_dwordx4 v[128:131], v7, s[8:11], s23 offen offset:1024 sc1
    s_waitcnt lgkmcnt(6)
    v_mfma_f32_16x16x32_bf16 v[40:43], v[240:243], v[96:99], v[40:43]
    ds_read_b64_tr_b16 v[232:233], v4 offset:8960
    s_add_u32 s22, s21, 0x400
    s_add_u32 m0, s20, 0x18400
    s_nop 0
    buffer_load_dwordx4 v2, s[8:11], s22 offen sc1 lds
    v_mfma_f32_16x16x32_bf16 v[44:47], v[240:243], v[100:103], v[44:47]
    ds_read_b64_tr_b16 v[234:235], v4 offset:9984
    s_waitcnt lgkmcnt(6)
    v_mfma_f32_16x16x32_bf16 v[48:51], v[244:247], v[96:99], v[48:51]
    ds_read_b64_tr_b16 v[236:237], v5 offset:8992
    v_mfma_f32_16x16x32_bf16 v[52:55], v[244:247], v[100:103], v[52:55]
    ds_read_b64_tr_b16 v[238:239], v5 offset:10016
    s_waitcnt lgkmcnt(6)
    v_mfma_f32_16x16x32_bf16 v[56:59], v[224:227], v[96:99], v[56:59]
    v_mfma_f32_16x16x32_bf16 v[60:63], v[224:227], v[100:103], v[60:63]
    s_waitcnt vmcnt(13)
    s_barrier
    ds_read_b64_tr_b16 v[240:241], v4 offset:16384
    ds_read_b64_tr_b16 v[242:243], v4 offset:17408
    s_waitcnt lgkmcnt(6)
    v_mfma_f32_16x16x32_bf16 v[64:67], v[228:231], v[96:99], v[64:67]
    ds_read_b64_tr_b16 v[244:245], v5 offset:16416
    v_mfma_f32_16x16x32_bf16 v[68:71], v[228:231], v[100:103], v[68:71]
    s_add_u32 s22, s19, 0x780000
    s_add_u32 m0, s20, 0xc000
    s_nop 0
    buffer_load_dwordx4 v3, s[4:7], s22 offen lds
    ds_read_b64_tr_b16 v[246:247], v5 offset:17440
    s_mov_b32 s23, 0xf000
    buffer_load_dwordx4 v[132:135], v7, s[8:11], s23 offen offset:1024 sc1
    s_waitcnt lgkmcnt(6)
    v_mfma_f32_16x16x32_bf16 v[72:75], v[232:235], v[96:99], v[72:75]
    ds_read_b64_tr_b16 v[224:225], v4 offset:16640
    v_mfma_f32_16x16x32_bf16 v[76:79], v[232:235], v[100:103], v[76:79]
    ds_read_b64_tr_b16 v[226:227], v4 offset:17664
    s_waitcnt lgkmcnt(6)
    v_mfma_f32_16x16x32_bf16 v[80:83], v[236:239], v[96:99], v[80:83]
    ds_read_b64_tr_b16 v[228:229], v5 offset:16672
    v_mfma_f32_16x16x32_bf16 v[84:87], v[236:239], v[100:103], v[84:87]
    ds_read_b64_tr_b16 v[230:231], v5 offset:17696
    s_waitcnt vmcnt(14) lgkmcnt(6)
    v_mfma_f32_16x16x32_bf16 v[24:27], v[240:243], v[104:107], v[24:27]
    ds_read_b64_tr_b16 v[232:233], v4 offset:16896
    s_waitcnt vmcnt(13)
    v_mfma_f32_16x16x32_bf16 v[28:31], v[240:243], v[108:111], v[28:31]
    ds_read_b64_tr_b16 v[234:235], v4 offset:17920
    s_waitcnt lgkmcnt(6)
    v_mfma_f32_16x16x32_bf16 v[32:35], v[244:247], v[104:107], v[32:35]
    ds_read_b64_tr_b16 v[236:237], v5 offset:16928
    v_mfma_f32_16x16x32_bf16 v[36:39], v[244:247], v[108:111], v[36:39]
    s_add_u32 s22, s19, 0x788000
    s_add_u32 m0, s20, 0xc400
    s_nop 0
    buffer_load_dwordx4 v3, s[4:7], s22 offen lds
    ds_read_b64_tr_b16 v[238:239], v5 offset:17952
    s_mov_b32 s23, 0x7800
    buffer_load_dwordx4 v[88:91], v7, s[8:11], s23 offen offset:0 sc1
    s_waitcnt lgkmcnt(6)
    v_mfma_f32_16x16x32_bf16 v[40:43], v[224:227], v[104:107], v[40:43]
    ds_read_b64_tr_b16 v[240:241], v4 offset:17152
    v_lshrrev_b32 v20, 4, v1
    v_lshlrev_b32 v21, 4, v20
    s_lshl_b32 s16, s2, 8
    s_add_u32 s16, s16, 0x550000
    buffer_load_dwordx4 v[136:139], v21, s[8:11], s16 offen offset:0 sc1
    buffer_load_dwordx4 v[140:143], v21, s[8:11], s16 offen offset:64 sc1
    buffer_load_dwordx4 v[144:147], v21, s[8:11], s16 offen offset:128 sc1
    buffer_load_dwordx4 v[148:151], v21, s[8:11], s16 offen offset:192 sc1
    v_lshlrev_b32 v11, 11, v20
    v_xor_b32 v20, s3, v20
    v_and_b32 v20, 1, v20
    v_lshl_add_u32 v11, v20, 5, v11
    v_bfe_u32 v20, v1, 2, 2
    v_lshl_add_u32 v11, v20, 6, v11
    v_and_b32 v20, 3, v1
    v_lshl_add_u32 v11, v20, 3, v11
    s_lshr_b32 s16, s3, 1
    s_lshl_b32 s16, s16, 8
    s_add_u32 s16, s16, 65536
    v_add_u32 v11, s16, v11
    v_mfma_f32_16x16x32_bf16 v[44:47], v[224:227], v[108:111], v[44:47]
    ds_read_b64_tr_b16 v[242:243], v4 offset:18176
    s_waitcnt lgkmcnt(6)
    v_mfma_f32_16x16x32_bf16 v[48:51], v[228:231], v[104:107], v[48:51]
    ds_read_b64_tr_b16 v[244:245], v5 offset:17184
    v_mfma_f32_16x16x32_bf16 v[52:55], v[228:231], v[108:111], v[52:55]
    ds_read_b64_tr_b16 v[246:247], v5 offset:18208
    s_waitcnt lgkmcnt(6)
    v_mfma_f32_16x16x32_bf16 v[56:59], v[232:235], v[104:107], v[56:59]
    ds_read_b64_tr_b16 v[224:225], v4 offset:24576
    v_mfma_f32_16x16x32_bf16 v[60:63], v[232:235], v[108:111], v[60:63]
    ds_read_b64_tr_b16 v[226:227], v4 offset:25600
    s_waitcnt lgkmcnt(6)
    v_mfma_f32_16x16x32_bf16 v[64:67], v[236:239], v[104:107], v[64:67]
    ds_read_b64_tr_b16 v[228:229], v5 offset:24608
    v_mfma_f32_16x16x32_bf16 v[68:71], v[236:239], v[108:111], v[68:71]
    ds_read_b64_tr_b16 v[230:231], v5 offset:25632
    s_mov_b32 s23, 0xf800
    buffer_load_dwordx4 v[92:95], v7, s[8:11], s23 offen offset:0 sc1
    s_waitcnt lgkmcnt(6)
    v_mfma_f32_16x16x32_bf16 v[72:75], v[240:243], v[104:107], v[72:75]
    ds_read_b64_tr_b16 v[232:233], v4 offset:24832
    v_mfma_f32_16x16x32_bf16 v[76:79], v[240:243], v[108:111], v[76:79]
    ds_read_b64_tr_b16 v[234:235], v4 offset:25856
    s_waitcnt lgkmcnt(6)
    v_mfma_f32_16x16x32_bf16 v[80:83], v[244:247], v[104:107], v[80:83]
    ds_read_b64_tr_b16 v[236:237], v5 offset:24864
    v_mfma_f32_16x16x32_bf16 v[84:87], v[244:247], v[108:111], v[84:87]
    ds_read_b64_tr_b16 v[238:239], v5 offset:25888
    s_waitcnt vmcnt(18) lgkmcnt(6)
    v_mfma_f32_16x16x32_bf16 v[24:27], v[224:227], v[112:115], v[24:27]
    ds_read_b64_tr_b16 v[240:241], v4 offset:25088
    s_add_u32 s22, s21, 0x4000
    s_add_u32 m0, s20, 0x1c000
    s_nop 0
    buffer_load_dwordx4 v2, s[8:11], s22 offen sc1 lds
    s_waitcnt vmcnt(16)
    v_mfma_f32_16x16x32_bf16 v[28:31], v[224:227], v[116:119], v[28:31]
    ds_read_b64_tr_b16 v[242:243], v4 offset:26112
    s_waitcnt lgkmcnt(6)
    v_mfma_f32_16x16x32_bf16 v[32:35], v[228:231], v[112:115], v[32:35]
    ds_read_b64_tr_b16 v[244:245], v5 offset:25120
    v_mfma_f32_16x16x32_bf16 v[36:39], v[228:231], v[116:119], v[36:39]
    ds_read_b64_tr_b16 v[246:247], v5 offset:26144
    s_mov_b32 s23, 0x7800
    buffer_load_dwordx4 v[96:99], v7, s[8:11], s23 offen offset:1024 sc1
    s_waitcnt lgkmcnt(6)
    v_mfma_f32_16x16x32_bf16 v[40:43], v[232:235], v[112:115], v[40:43]
    ds_read_b64_tr_b16 v[224:225], v4 offset:25344
    s_add_u32 s22, s21, 0x4400
    s_add_u32 m0, s20, 0x1c400
    s_nop 0
    buffer_load_dwordx4 v2, s[8:11], s22 offen sc1 lds
    v_mfma_f32_16x16x32_bf16 v[44:47], v[232:235], v[116:119], v[44:47]
    ds_read_b64_tr_b16 v[226:227], v4 offset:26368
    s_waitcnt lgkmcnt(6)
    v_mfma_f32_16x16x32_bf16 v[48:51], v[236:239], v[112:115], v[48:51]
    ds_read_b64_tr_b16 v[228:229], v5 offset:25376
    v_mfma_f32_16x16x32_bf16 v[52:55], v[236:239], v[116:119], v[52:55]
    ds_read_b64_tr_b16 v[230:231], v5 offset:26400
    s_waitcnt lgkmcnt(6)
    v_mfma_f32_16x16x32_bf16 v[56:59], v[240:243], v[112:115], v[56:59]
    v_mfma_f32_16x16x32_bf16 v[60:63], v[240:243], v[116:119], v[60:63]
    s_waitcnt vmcnt(17)
    s_barrier
    ds_read_b64_tr_b16 v[232:233], v4 offset:32768
    ds_read_b64_tr_b16 v[234:235], v4 offset:33792
    s_waitcnt lgkmcnt(6)
    v_mfma_f32_16x16x32_bf16 v[64:67], v[244:247], v[112:115], v[64:67]
    ds_read_b64_tr_b16 v[236:237], v5 offset:32800
    v_mfma_f32_16x16x32_bf16 v[68:71], v[244:247], v[116:119], v[68:71]
    ds_read_b64_tr_b16 v[238:239], v5 offset:33824
    s_mov_b32 s23, 0xf800
    buffer_load_dwordx4 v[100:103], v7, s[8:11], s23 offen offset:1024 sc1
    s_waitcnt lgkmcnt(6)
    v_mfma_f32_16x16x32_bf16 v[72:75], v[224:227], v[112:115], v[72:75]
    ds_read_b64_tr_b16 v[240:241], v4 offset:33024
    v_mfma_f32_16x16x32_bf16 v[76:79], v[224:227], v[116:119], v[76:79]
    ds_read_b64_tr_b16 v[242:243], v4 offset:34048
    s_waitcnt lgkmcnt(6)
    v_mfma_f32_16x16x32_bf16 v[80:83], v[228:231], v[112:115], v[80:83]
    ds_read_b64_tr_b16 v[244:245], v5 offset:33056
    v_mfma_f32_16x16x32_bf16 v[84:87], v[228:231], v[116:119], v[84:87]
    ds_read_b64_tr_b16 v[246:247], v5 offset:34080
    s_waitcnt vmcnt(17) lgkmcnt(6)
    v_mfma_f32_16x16x32_bf16 v[24:27], v[232:235], v[120:123], v[24:27]
    ds_read_b64_tr_b16 v[224:225], v4 offset:33280
    s_waitcnt vmcnt(16)
    v_mfma_f32_16x16x32_bf16 v[28:31], v[232:235], v[124:127], v[28:31]
    ds_read_b64_tr_b16 v[226:227], v4 offset:34304
    s_waitcnt lgkmcnt(6)
    v_mfma_f32_16x16x32_bf16 v[32:35], v[236:239], v[120:123], v[32:35]
    ds_read_b64_tr_b16 v[228:229], v5 offset:33312
    v_mfma_f32_16x16x32_bf16 v[36:39], v[236:239], v[124:127], v[36:39]
    ds_read_b64_tr_b16 v[230:231], v5 offset:34336
    s_waitcnt lgkmcnt(6)
    v_mfma_f32_16x16x32_bf16 v[40:43], v[240:243], v[120:123], v[40:43]
    ds_read_b64_tr_b16 v[232:233], v4 offset:33536
    v_mfma_f32_16x16x32_bf16 v[44:47], v[240:243], v[124:127], v[44:47]
    ds_read_b64_tr_b16 v[234:235], v4 offset:34560
    s_waitcnt lgkmcnt(6)
    v_mfma_f32_16x16x32_bf16 v[48:51], v[244:247], v[120:123], v[48:51]
    ds_read_b64_tr_b16 v[236:237], v5 offset:33568
    v_mfma_f32_16x16x32_bf16 v[52:55], v[244:247], v[124:127], v[52:55]
    ds_read_b64_tr_b16 v[238:239], v5 offset:34592
    s_waitcnt lgkmcnt(6)
    v_mfma_f32_16x16x32_bf16 v[56:59], v[224:227], v[120:123], v[56:59]
    ds_read_b64_tr_b16 v[240:241], v4 offset:40960
    v_mfma_f32_16x16x32_bf16 v[60:63], v[224:227], v[124:127], v[60:63]
    ds_read_b64_tr_b16 v[242:243], v4 offset:41984
    s_waitcnt lgkmcnt(6)
    v_mfma_f32_16x16x32_bf16 v[64:67], v[228:231], v[120:123], v[64:67]
    ds_read_b64_tr_b16 v[244:245], v5 offset:40992
    v_mfma_f32_16x16x32_bf16 v[68:71], v[228:231], v[124:127], v[68:71]
    ds_read_b64_tr_b16 v[246:247], v5 offset:42016
    s_waitcnt lgkmcnt(6)
    v_mfma_f32_16x16x32_bf16 v[72:75], v[232:235], v[120:123], v[72:75]
    ds_read_b64_tr_b16 v[224:225], v4 offset:41216
    v_mfma_f32_16x16x32_bf16 v[76:79], v[232:235], v[124:127], v[76:79]
    ds_read_b64_tr_b16 v[226:227], v4 offset:42240
    s_waitcnt lgkmcnt(6)
    v_mfma_f32_16x16x32_bf16 v[80:83], v[236:239], v[120:123], v[80:83]
    ds_read_b64_tr_b16 v[228:229], v5 offset:41248
    v_mfma_f32_16x16x32_bf16 v[84:87], v[236:239], v[124:127], v[84:87]
    ds_read_b64_tr_b16 v[230:231], v5 offset:42272
    s_waitcnt vmcnt(14) lgkmcnt(6)
    v_mfma_f32_16x16x32_bf16 v[24:27], v[240:243], v[128:131], v[24:27]
    ds_read_b64_tr_b16 v[232:233], v4 offset:41472
    s_waitcnt vmcnt(11)
    v_mfma_f32_16x16x32_bf16 v[28:31], v[240:243], v[132:135], v[28:31]
    ds_read_b64_tr_b16 v[234:235], v4 offset:42496
    s_waitcnt lgkmcnt(6)
    v_mfma_f32_16x16x32_bf16 v[32:35], v[244:247], v[128:131], v[32:35]
    ds_read_b64_tr_b16 v[236:237], v5 offset:41504
    v_mfma_f32_16x16x32_bf16 v[36:39], v[244:247], v[132:135], v[36:39]
    ds_read_b64_tr_b16 v[238:239], v5 offset:42528
    s_waitcnt lgkmcnt(6)
    v_mfma_f32_16x16x32_bf16 v[40:43], v[224:227], v[128:131], v[40:43]
    ds_read_b64_tr_b16 v[240:241], v4 offset:41728
    v_mfma_f32_16x16x32_bf16 v[44:47], v[224:227], v[132:135], v[44:47]
    ds_read_b64_tr_b16 v[242:243], v4 offset:42752
    s_waitcnt lgkmcnt(6)
    v_mfma_f32_16x16x32_bf16 v[48:51], v[228:231], v[128:131], v[48:51]
    ds_read_b64_tr_b16 v[244:245], v5 offset:41760
    v_mfma_f32_16x16x32_bf16 v[52:55], v[228:231], v[132:135], v[52:55]
    ds_read_b64_tr_b16 v[246:247], v5 offset:42784
    s_waitcnt lgkmcnt(6)
    v_mfma_f32_16x16x32_bf16 v[56:59], v[232:235], v[128:131], v[56:59]
    v_mfma_f32_16x16x32_bf16 v[60:63], v[232:235], v[132:135], v[60:63]
    s_waitcnt vmcnt(10)
    s_barrier
    ds_read_b64_tr_b16 v[224:225], v4 offset:49152
    ds_read_b64_tr_b16 v[226:227], v4 offset:50176
    s_waitcnt lgkmcnt(6)
    v_mfma_f32_16x16x32_bf16 v[64:67], v[236:239], v[128:131], v[64:67]
    ds_read_b64_tr_b16 v[228:229], v5 offset:49184
    v_mfma_f32_16x16x32_bf16 v[68:71], v[236:239], v[132:135], v[68:71]
    ds_read_b64_tr_b16 v[230:231], v5 offset:50208
    s_waitcnt lgkmcnt(6)
    v_mfma_f32_16x16x32_bf16 v[72:75], v[240:243], v[128:131], v[72:75]
    ds_read_b64_tr_b16 v[232:233], v4 offset:49408
    v_mfma_f32_16x16x32_bf16 v[76:79], v[240:243], v[132:135], v[76:79]
    ds_read_b64_tr_b16 v[234:235], v4 offset:50432
    s_waitcnt lgkmcnt(6)
    v_mfma_f32_16x16x32_bf16 v[80:83], v[244:247], v[128:131], v[80:83]
    ds_read_b64_tr_b16 v[236:237], v5 offset:49440
    v_mfma_f32_16x16x32_bf16 v[84:87], v[244:247], v[132:135], v[84:87]
    ds_read_b64_tr_b16 v[238:239], v5 offset:50464
    s_waitcnt vmcnt(9) lgkmcnt(6)
    v_mfma_f32_16x16x32_bf16 v[24:27], v[224:227], v[88:91], v[24:27]
    ds_read_b64_tr_b16 v[240:241], v4 offset:49664
    s_waitcnt vmcnt(4)
    v_mfma_f32_16x16x32_bf16 v[28:31], v[224:227], v[92:95], v[28:31]
    ds_read_b64_tr_b16 v[242:243], v4 offset:50688
    s_waitcnt lgkmcnt(6)
    v_mfma_f32_16x16x32_bf16 v[32:35], v[228:231], v[88:91], v[32:35]
    ds_read_b64_tr_b16 v[244:245], v5 offset:49696
    v_mfma_f32_16x16x32_bf16 v[36:39], v[228:231], v[92:95], v[36:39]
    ds_read_b64_tr_b16 v[246:247], v5 offset:50720
    s_waitcnt lgkmcnt(6)
    v_mfma_f32_16x16x32_bf16 v[40:43], v[232:235], v[88:91], v[40:43]
    ds_read_b64_tr_b16 v[224:225], v4 offset:49920
    v_mfma_f32_16x16x32_bf16 v[44:47], v[232:235], v[92:95], v[44:47]
    ds_read_b64_tr_b16 v[226:227], v4 offset:50944
    s_waitcnt lgkmcnt(6)
    v_mfma_f32_16x16x32_bf16 v[48:51], v[236:239], v[88:91], v[48:51]
    ds_read_b64_tr_b16 v[228:229], v5 offset:49952
    v_mfma_f32_16x16x32_bf16 v[52:55], v[236:239], v[92:95], v[52:55]
    ds_read_b64_tr_b16 v[230:231], v5 offset:50976
    s_waitcnt lgkmcnt(6)
    v_mfma_f32_16x16x32_bf16 v[56:59], v[240:243], v[88:91], v[56:59]
    ds_read_b64_tr_b16 v[232:233], v4 offset:57344
    v_mfma_f32_16x16x32_bf16 v[60:63], v[240:243], v[92:95], v[60:63]
    ds_read_b64_tr_b16 v[234:235], v4 offset:58368
    s_waitcnt lgkmcnt(6)
    v_mfma_f32_16x16x32_bf16 v[64:67], v[244:247], v[88:91], v[64:67]
    ds_read_b64_tr_b16 v[236:237], v5 offset:57376
    v_mfma_f32_16x16x32_bf16 v[68:71], v[244:247], v[92:95], v[68:71]
    ds_read_b64_tr_b16 v[238:239], v5 offset:58400
    s_waitcnt lgkmcnt(6)
    v_mfma_f32_16x16x32_bf16 v[72:75], v[224:227], v[88:91], v[72:75]
    ds_read_b64_tr_b16 v[240:241], v4 offset:57600
    v_mfma_f32_16x16x32_bf16 v[76:79], v[224:227], v[92:95], v[76:79]
    ds_read_b64_tr_b16 v[242:243], v4 offset:58624
    s_waitcnt lgkmcnt(6)
    v_mfma_f32_16x16x32_bf16 v[80:83], v[228:231], v[88:91], v[80:83]
    ds_read_b64_tr_b16 v[244:245], v5 offset:57632
    v_mfma_f32_16x16x32_bf16 v[84:87], v[228:231], v[92:95], v[84:87]
    ds_read_b64_tr_b16 v[246:247], v5 offset:58656
    s_waitcnt vmcnt(2) lgkmcnt(6)
    v_mfma_f32_16x16x32_bf16 v[24:27], v[232:235], v[96:99], v[24:27]
    ds_read_b64_tr_b16 v[224:225], v4 offset:57856
    s_waitcnt vmcnt(0)
    v_mfma_f32_16x16x32_bf16 v[28:31], v[232:235], v[100:103], v[28:31]
    ds_read_b64_tr_b16 v[226:227], v4 offset:58880
    s_waitcnt lgkmcnt(6)
    v_mfma_f32_16x16x32_bf16 v[32:35], v[236:239], v[96:99], v[32:35]
    ds_read_b64_tr_b16 v[228:229], v5 offset:57888
    v_mfma_f32_16x16x32_bf16 v[36:39], v[236:239], v[100:103], v[36:39]
    ds_read_b64_tr_b16 v[230:231], v5 offset:58912
    s_waitcnt lgkmcnt(6)
    v_mfma_f32_16x16x32_bf16 v[40:43], v[240:243], v[96:99], v[40:43]
    ds_read_b64_tr_b16 v[232:233], v4 offset:58112
    v_mfma_f32_16x16x32_bf16 v[44:47], v[240:243], v[100:103], v[44:47]
    ds_read_b64_tr_b16 v[234:235], v4 offset:59136
    s_waitcnt lgkmcnt(6)
    v_mfma_f32_16x16x32_bf16 v[48:51], v[244:247], v[96:99], v[48:51]
    ds_read_b64_tr_b16 v[236:237], v5 offset:58144
    v_mfma_f32_16x16x32_bf16 v[52:55], v[244:247], v[100:103], v[52:55]
    ds_read_b64_tr_b16 v[238:239], v5 offset:59168
    s_waitcnt lgkmcnt(6)
    v_mfma_f32_16x16x32_bf16 v[56:59], v[224:227], v[96:99], v[56:59]
    v_mfma_f32_16x16x32_bf16 v[60:63], v[224:227], v[100:103], v[60:63]
    s_waitcnt lgkmcnt(4)
    v_mfma_f32_16x16x32_bf16 v[64:67], v[228:231], v[96:99], v[64:67]
    v_mfma_f32_16x16x32_bf16 v[68:71], v[228:231], v[100:103], v[68:71]
    s_waitcnt lgkmcnt(2)
    v_mfma_f32_16x16x32_bf16 v[72:75], v[232:235], v[96:99], v[72:75]
    v_mfma_f32_16x16x32_bf16 v[76:79], v[232:235], v[100:103], v[76:79]
    s_waitcnt lgkmcnt(0)
    v_mfma_f32_16x16x32_bf16 v[80:83], v[236:239], v[96:99], v[80:83]
    v_mfma_f32_16x16x32_bf16 v[84:87], v[236:239], v[100:103], v[84:87]
    s_barrier
    s_add_u32 s22, s21, 0x8000
    s_add_u32 m0, s20, 0x20000
    s_nop 0
    buffer_load_dwordx4 v2, s[8:11], s22 offen sc1 lds
    s_add_u32 s22, s21, 0x8400
    s_add_u32 m0, s20, 0x20400
    s_nop 0
    buffer_load_dwordx4 v2, s[8:11], s22 offen sc1 lds
    s_add_u32 s22, s21, 0xc000
    s_add_u32 m0, s20, 0x24000
    s_nop 0
    buffer_load_dwordx4 v2, s[8:11], s22 offen sc1 lds
    s_add_u32 s22, s21, 0xc400
    s_add_u32 m0, s20, 0x24400
    s_nop 0
    buffer_load_dwordx4 v2, s[8:11], s22 offen sc1 lds
    ds_read_b64_tr_b16 v[88:89], v11 offset:0
    ds_read_b64_tr_b16 v[90:91], v11 offset:1024
    ds_read_b64_tr_b16 v[92:93], v11 offset:8192
    ds_read_b64_tr_b16 v[94:95], v11 offset:9216
    ds_read_b64_tr_b16 v[96:97], v11 offset:16384
    ds_read_b64_tr_b16 v[98:99], v11 offset:17408
    ds_read_b64_tr_b16 v[100:101], v11 offset:24576
    ds_read_b64_tr_b16 v[102:103], v11 offset:25600
    s_mov_b32 s23, 0x3e0293ee
    v_mul_f32 v24, s23, v24
    v_mul_f32 v25, s23, v25
    v_mul_f32 v26, s23, v26
    v_mul_f32 v27, s23, v27
    v_mul_f32 v28, s23, v28
    v_mul_f32 v29, s23, v29
    v_mul_f32 v30, s23, v30
    v_mul_f32 v31, s23, v31
    v_mul_f32 v32, s23, v32
    v_mul_f32 v33, s23, v33
    v_mul_f32 v34, s23, v34
    v_mul_f32 v35, s23, v35
    v_mul_f32 v36, s23, v36
    v_mul_f32 v37, s23, v37
    v_mul_f32 v38, s23, v38
    v_mul_f32 v39, s23, v39
    v_cvt_pk_bf16_f32 v152, v24, v25
    v_cvt_pk_bf16_f32 v153, v26, v27
    v_cvt_pk_bf16_f32 v168, v28, v29
    v_cvt_pk_bf16_f32 v169, v30, v31
    v_cvt_pk_bf16_f32 v154, v32, v33
    v_cvt_pk_bf16_f32 v155, v34, v35
    v_cvt_pk_bf16_f32 v170, v36, v37
    v_cvt_pk_bf16_f32 v171, v38, v39
    s_waitcnt lgkmcnt(6)
    v_mfma_f32_16x16x32_bf16 v[104:107], v[88:91], v[136:139], 0
    s_waitcnt lgkmcnt(4)
    v_mfma_f32_16x16x32_bf16 v[104:107], v[92:95], v[140:143], v[104:107]
    s_waitcnt lgkmcnt(2)
    v_mfma_f32_16x16x32_bf16 v[104:107], v[96:99], v[144:147], v[104:107]
    s_waitcnt lgkmcnt(0)
    v_mfma_f32_16x16x32_bf16 v[104:107], v[100:103], v[148:151], v[104:107]
    v_add_u32 v4, 0x10000, v2
    v_add_u32 v5, 0x20000, v2
    s_barrier
    ds_read_b128 v[224:227], v4 offset:32768
    ds_read_b128 v[228:231], v4 offset:33792
    ds_read_b128 v[232:235], v4 offset:34816
    ds_read_b128 v[236:239], v4 offset:35840
    v_mov_b32 v12, 0x3f803f80
    v_mov_b32 v13, 0x3f803f80
    v_mov_b32 v14, 0x3f803f80
    v_mov_b32 v15, 0x3f803f80
    s_waitcnt lgkmcnt(3)
    v_mfma_f32_16x16x32_bf16 v[184:187], v[224:227], v[152:155], 0
    v_mul_f32 v40, s23, v40
    v_mul_f32 v41, s23, v41
    v_mul_f32 v42, s23, v42
    v_mul_f32 v43, s23, v43
    v_mul_f32 v44, s23, v44
    v_mul_f32 v45, s23, v45
    v_lshrrev_b32 v20, 4, v1
    v_lshlrev_b32 v20, 4, v20
    s_lshr_b32 s16, s2, 5
    s_lshl_b32 s16, s16, 14
    s_and_b32 s17, s2, 31
    s_lshl_b32 s17, s17, 9
    s_add_u32 s16, s16, s17
    s_lshl_b32 s17, s3, 6
    s_add_u32 s16, s16, s17
    s_add_u32 s16, s16, 0x580000
    s_mov_b32 exec_lo, 0x10001
    s_mov_b32 exec_hi, 0x10001
    buffer_store_dwordx4 v[104:107], v20, s[8:11], s16 offen sc1
    s_mov_b64 exec, -1
    v_mfma_f32_16x16x32_bf16 v[188:191], v[224:227], v[168:171], 0
    ds_read_b128 v[240:243], v4 offset:36864
    v_mul_f32 v46, s23, v46
    v_mul_f32 v47, s23, v47
    v_mul_f32 v48, s23, v48
    v_mul_f32 v49, s23, v49
    v_mul_f32 v50, s23, v50
    v_mul_f32 v51, s23, v51
    s_mov_b64 s[64:65], s[46:47]
    s_mov_b32 s66, 0x700000
    s_mov_b32 s67, 0x20000
    s_mov_b64 s[68:69], s[48:49]
    s_mov_b32 s70, 0x700000
    s_mov_b32 s71, 0x20000
    s_cmp_lt_u32 s2, 224
    s_cselect_b32 s66, 7340032, 0
    s_cselect_b32 s70, 7340032, 0
    s_and_b32 s29, s2, 7
    s_mul_i32 s29, s29, 28
    s_lshr_b32 s16, s2, 3
    s_add_u32 s29, s29, s16
    s_sub_u32 s16, s3, 4
    v_lshrrev_b32 v20, 3, v1
    v_lshlrev_b32 v20, 3, v20
    s_lshl_b32 s17, s16, 6
    v_add_u32 v20, s17, v20
    s_mov_b32 s17, 7168
    v_mul_lo_u32 v11, s17, v20
    v_and_b32 v20, 7, v1
    v_lshl_add_u32 v11, v20, 4, v11
    s_and_b32 s17, s29, 3
    s_mul_i32 s18, s17, 1835008
    s_lshr_b32 s17, s29, 2
    s_lshl_b32 s17, s17, 7
    s_add_u32 s18, s18, s17
    s_lshl_b32 s15, s16, 13
    s_waitcnt lgkmcnt(3)
    v_mfma_f32_16x16x32_bf16 v[192:195], v[228:231], v[152:155], 0
    s_add_u32 s22, s21, 0x10000
    s_add_u32 m0, s20, 0x10000
    s_nop 0
    buffer_load_dwordx4 v2, s[8:11], s22 offen sc1 lds
    v_mul_f32 v52, s23, v52
    v_mul_f32 v53, s23, v53
    v_mul_f32 v54, s23, v54
    v_mul_f32 v55, s23, v55
    v_cvt_pk_bf16_f32 v156, v40, v41
    v_cvt_pk_bf16_f32 v157, v42, v43
    v_mfma_f32_16x16x32_bf16 v[196:199], v[228:231], v[168:171], 0
    ds_read_b128 v[244:247], v4 offset:37888
    v_cvt_pk_bf16_f32 v172, v44, v45
    v_cvt_pk_bf16_f32 v173, v46, v47
    v_cvt_pk_bf16_f32 v158, v48, v49
    v_cvt_pk_bf16_f32 v159, v50, v51
    v_cvt_pk_bf16_f32 v174, v52, v53
    v_cvt_pk_bf16_f32 v175, v54, v55
    s_waitcnt lgkmcnt(3)
    v_mfma_f32_16x16x32_bf16 v[184:187], v[232:235], v[156:159], v[184:187]
    v_mul_f32 v56, s23, v56
    v_mul_f32 v57, s23, v57
    v_mul_f32 v58, s23, v58
    v_mul_f32 v59, s23, v59
    v_mul_f32 v60, s23, v60
    v_mul_f32 v61, s23, v61
    v_mfma_f32_16x16x32_bf16 v[188:191], v[232:235], v[172:175], v[188:191]
    ds_read_b128 v[224:227], v4 offset:38912
    v_mul_f32 v62, s23, v62
    v_mul_f32 v63, s23, v63
    v_mul_f32 v64, s23, v64
    v_mul_f32 v65, s23, v65
    v_mul_f32 v66, s23, v66
    v_mul_f32 v67, s23, v67
    s_waitcnt lgkmcnt(3)
    v_mfma_f32_16x16x32_bf16 v[192:195], v[236:239], v[156:159], v[192:195]
    v_mul_f32 v68, s23, v68
    v_mul_f32 v69, s23, v69
    v_mul_f32 v70, s23, v70
    v_mul_f32 v71, s23, v71
    v_cvt_pk_bf16_f32 v160, v56, v57
    v_cvt_pk_bf16_f32 v161, v58, v59
    v_mfma_f32_16x16x32_bf16 v[196:199], v[236:239], v[172:175], v[196:199]
    ds_read_b128 v[228:231], v4 offset:39936
    v_cvt_pk_bf16_f32 v176, v60, v61
    v_cvt_pk_bf16_f32 v177, v62, v63
    v_cvt_pk_bf16_f32 v162, v64, v65
    v_cvt_pk_bf16_f32 v163, v66, v67
    v_cvt_pk_bf16_f32 v178, v68, v69
    v_cvt_pk_bf16_f32 v179, v70, v71
    s_waitcnt lgkmcnt(3)
    v_mfma_f32_16x16x32_bf16 v[184:187], v[240:243], v[160:163], v[184:187]
    v_mul_f32 v72, s23, v72
    v_mul_f32 v73, s23, v73
    v_mul_f32 v74, s23, v74
    v_mul_f32 v75, s23, v75
    v_mul_f32 v76, s23, v76
    v_mul_f32 v77, s23, v77
    v_mfma_f32_16x16x32_bf16 v[188:191], v[240:243], v[176:179], v[188:191]
    ds_read_b128 v[232:235], v4 offset:40960
    v_mul_f32 v78, s23, v78
    v_mul_f32 v79, s23, v79
    v_mul_f32 v80, s23, v80
    v_mul_f32 v81, s23, v81
    v_mul_f32 v82, s23, v82
    v_mul_f32 v83, s23, v83
    s_waitcnt lgkmcnt(3)
    v_mfma_f32_16x16x32_bf16 v[192:195], v[244:247], v[160:163], v[192:195]
    s_add_u32 s22, s21, 0x10400
    s_add_u32 m0, s20, 0x10400
    s_nop 0
    buffer_load_dwordx4 v2, s[8:11], s22 offen sc1 lds
    v_mul_f32 v84, s23, v84
    v_mul_f32 v85, s23, v85
    v_mul_f32 v86, s23, v86
    v_mul_f32 v87, s23, v87
    v_cvt_pk_bf16_f32 v164, v72, v73
    v_cvt_pk_bf16_f32 v165, v74, v75
    v_mfma_f32_16x16x32_bf16 v[196:199], v[244:247], v[176:179], v[196:199]
    ds_read_b128 v[236:239], v4 offset:41984
    v_cvt_pk_bf16_f32 v180, v76, v77
    v_cvt_pk_bf16_f32 v181, v78, v79
    v_cvt_pk_bf16_f32 v166, v80, v81
    v_cvt_pk_bf16_f32 v167, v82, v83
    v_cvt_pk_bf16_f32 v182, v84, v85
    v_cvt_pk_bf16_f32 v183, v86, v87
    s_waitcnt lgkmcnt(3)
    v_mfma_f32_16x16x32_bf16 v[184:187], v[224:227], v[164:167], v[184:187]
    v_mfma_f32_16x16x32_bf16 v[188:191], v[224:227], v[180:183], v[188:191]
    ds_read_b128 v[240:243], v4 offset:43008
    s_waitcnt lgkmcnt(3)
    v_mfma_f32_16x16x32_bf16 v[192:195], v[228:231], v[164:167], v[192:195]
    v_mfma_f32_16x16x32_bf16 v[196:199], v[228:231], v[180:183], v[196:199]
    ds_read_b128 v[244:247], v4 offset:44032
    s_waitcnt lgkmcnt(3)
    v_mfma_f32_16x16x32_bf16 v[200:203], v[232:235], v[152:155], 0
    v_mfma_f32_16x16x32_bf16 v[204:207], v[232:235], v[168:171], 0
    ds_read_b128 v[224:227], v4 offset:45056
    s_waitcnt lgkmcnt(3)
    v_mfma_f32_16x16x32_bf16 v[208:211], v[236:239], v[152:155], 0
    v_mfma_f32_16x16x32_bf16 v[212:215], v[236:239], v[168:171], 0
    ds_read_b128 v[228:231], v4 offset:46080
    s_waitcnt lgkmcnt(3)
    v_mfma_f32_16x16x32_bf16 v[200:203], v[240:243], v[156:159], v[200:203]
    v_mfma_f32_16x16x32_bf16 v[204:207], v[240:243], v[172:175], v[204:207]
    ds_read_b128 v[232:235], v4 offset:47104
    s_waitcnt lgkmcnt(3)
    v_mfma_f32_16x16x32_bf16 v[208:211], v[244:247], v[156:159], v[208:211]
    v_max3_f32 v16, v184, v185, v186
    v_mfma_f32_16x16x32_bf16 v[212:215], v[244:247], v[172:175], v[212:215]
    ds_read_b128 v[236:239], v4 offset:48128
    v_max3_f32 v16, v16, v187, v192
    s_waitcnt lgkmcnt(3)
    v_mfma_f32_16x16x32_bf16 v[200:203], v[224:227], v[160:163], v[200:203]
    v_max3_f32 v16, v16, v193, v194
    v_mfma_f32_16x16x32_bf16 v[204:207], v[224:227], v[176:179], v[204:207]
    s_barrier
    ds_read_b128 v[240:243], v4 offset:49152
    v_max_f32 v16, v16, v195
    s_waitcnt lgkmcnt(3)
    v_mfma_f32_16x16x32_bf16 v[208:211], v[228:231], v[160:163], v[208:211]
    v_max3_f32 v17, v188, v189, v190
    v_mfma_f32_16x16x32_bf16 v[212:215], v[228:231], v[176:179], v[212:215]
    s_add_u32 s22, s21, 0x14000
    s_add_u32 m0, s20, 0x14000
    s_nop 0
    buffer_load_dwordx4 v2, s[8:11], s22 offen sc1 lds
    ds_read_b128 v[244:247], v4 offset:50176
    v_max3_f32 v17, v17, v191, v196
    s_waitcnt lgkmcnt(3)
    v_mfma_f32_16x16x32_bf16 v[200:203], v[232:235], v[164:167], v[200:203]
    v_max3_f32 v17, v17, v197, v198
    v_mfma_f32_16x16x32_bf16 v[204:207], v[232:235], v[180:183], v[204:207]
    ds_read_b128 v[224:227], v4 offset:51200
    v_max_f32 v17, v17, v199
    s_waitcnt lgkmcnt(3)
    v_mfma_f32_16x16x32_bf16 v[208:211], v[236:239], v[164:167], v[208:211]
    s_mov_b64 s[72:73], s[40:41]
    s_mov_b32 s74, 0x800000
    s_mov_b32 s75, 0x20000
    v_lshlrev_b32 v21, 7, v1
    s_lshl_b32 s16, s2, 2
    s_add_u32 s16, s16, s3
    s_sub_u32 s16, s16, 4
    s_lshl_b32 s16, s16, 13
    buffer_load_dword v7, v21, s[72:75], s16 offen
    v_mfma_f32_16x16x32_bf16 v[212:215], v[236:239], v[180:183], v[212:215]
    ds_read_b128 v[228:231], v4 offset:52224
    v_max3_f32 v16, v16, v200, v201
    v_max3_f32 v16, v16, v202, v203
    v_max3_f32 v16, v16, v208, v209
    v_max3_f32 v16, v16, v210, v211
    v_max3_f32 v17, v17, v204, v205
    v_max3_f32 v17, v17, v206, v207
    s_nop 0
    v_max3_f32 v17, v17, v212, v213
    v_max3_f32 v17, v17, v214, v215
    v_mov_b32 v18, v16
    v_mov_b32 v19, v17
    s_nop 0
    v_permlane16_swap_b32 v16, v18
    v_permlane16_swap_b32 v17, v19
    v_max_f32 v16, v16, v18
    v_max_f32 v17, v17, v19
    v_mov_b32 v18, v16
    v_mov_b32 v19, v17
    s_nop 0
    v_permlane32_swap_b32 v16, v18
    v_permlane32_swap_b32 v17, v19
    v_max_f32 v16, v16, v18
    v_max_f32 v17, v17, v19
    v_sub_f32 v216, 0, v16
    v_sub_f32 v217, 0, v16
    v_sub_f32 v218, 0, v16
    v_sub_f32 v219, 0, v16
    v_sub_f32 v220, 0, v17
    v_sub_f32 v221, 0, v17
    v_sub_f32 v222, 0, v17
    v_sub_f32 v223, 0, v17
    v_add_f32 v184, v184, v216
    v_add_f32 v185, v185, v216
    v_exp_f32 v184, v184
    v_exp_f32 v185, v185
    s_nop 0
    v_cvt_pk_bf16_f32 v24, v184, v185
    v_add_f32 v186, v186, v216
    v_add_f32 v187, v187, v216
    v_exp_f32 v186, v186
    v_exp_f32 v187, v187
    s_nop 0
    v_cvt_pk_bf16_f32 v25, v186, v187
    v_add_f32 v188, v188, v220
    v_add_f32 v189, v189, v220
    v_exp_f32 v188, v188
    v_exp_f32 v189, v189
    s_nop 0
    v_cvt_pk_bf16_f32 v28, v188, v189
    v_add_f32 v190, v190, v220
    v_add_f32 v191, v191, v220
    v_exp_f32 v190, v190
    v_exp_f32 v191, v191
    s_nop 0
    v_cvt_pk_bf16_f32 v29, v190, v191
    v_add_f32 v192, v192, v216
    v_add_f32 v193, v193, v216
    v_exp_f32 v192, v192
    v_exp_f32 v193, v193
    s_nop 0
    v_cvt_pk_bf16_f32 v26, v192, v193
    v_add_f32 v194, v194, v216
    v_add_f32 v195, v195, v216
    v_exp_f32 v194, v194
    v_exp_f32 v195, v195
    s_nop 0
    v_cvt_pk_bf16_f32 v27, v194, v195
    v_add_f32 v196, v196, v220
    v_add_f32 v197, v197, v220
    v_exp_f32 v196, v196
    v_exp_f32 v197, v197
    s_nop 0
    v_cvt_pk_bf16_f32 v30, v196, v197
    v_add_f32 v198, v198, v220
    v_add_f32 v199, v199, v220
    v_exp_f32 v198, v198
    v_exp_f32 v199, v199
    s_nop 0
    v_cvt_pk_bf16_f32 v31, v198, v199
    s_waitcnt lgkmcnt(3)
    v_mfma_f32_16x16x32_bf16 v[184:187], v[240:243], v[152:155], v[216:219]
    v_mfma_f32_16x16x32_bf16 v[188:191], v[240:243], v[168:171], v[220:223]
    ds_read_b128 v[232:235], v4 offset:53248
    v_add_f32 v200, v200, v216
    v_add_f32 v201, v201, v216
    v_exp_f32 v200, v200
    v_mfma_f32_16x16x32_bf16 v[248:251], v[12:15], v[24:27], 0
    s_waitcnt lgkmcnt(3)
    v_mfma_f32_16x16x32_bf16 v[192:195], v[244:247], v[152:155], v[216:219]
    v_exp_f32 v201, v201
    s_nop 0
    v_cvt_pk_bf16_f32 v32, v200, v201
    v_add_f32 v202, v202, v216
    v_mfma_f32_16x16x32_bf16 v[196:199], v[244:247], v[168:171], v[220:223]
    s_add_u32 s22, s21, 0x14400
    s_add_u32 m0, s20, 0x14400
    s_nop 0
    buffer_load_dwordx4 v2, s[8:11], s22 offen sc1 lds
    ds_read_b128 v[236:239], v4 offset:54272
    v_add_f32 v203, v203, v216
    v_exp_f32 v202, v202
    v_mfma_f32_16x16x32_bf16 v[252:255], v[12:15], v[28:31], 0
    s_waitcnt lgkmcnt(3)
    v_mfma_f32_16x16x32_bf16 v[184:187], v[224:227], v[156:159], v[184:187]
    v_exp_f32 v203, v203
    s_nop 0
    v_cvt_pk_bf16_f32 v33, v202, v203
    v_add_f32 v204, v204, v220
    v_mfma_f32_16x16x32_bf16 v[188:191], v[224:227], v[172:175], v[188:191]
    ds_read_b128 v[240:243], v4 offset:55296
    v_add_f32 v205, v205, v220
    v_exp_f32 v204, v204
    v_exp_f32 v205, v205
    s_mov_b64 s[4:5], s[40:41]
    s_mov_b32 s6, 0x800000
    s_mov_b32 s7, 0x20000
    v_bfe_u32 v20, v1, 2, 2
    v_lshlrev_b32 v21, 13, v20
    v_sub_u32 v3, v3, v21
    v_lshl_add_u32 v3, v20, 11, v3
    s_and_b32 s16, s2, 1
    s_lshl_b32 s24, s16, 22
    s_lshr_b32 s16, s2, 5
    s_lshl_b32 s16, s16, 8
    s_add_u32 s24, s24, s16
    s_lshl_b32 s16, s3, 14
    s_add_u32 s24, s24, s16
    s_add_u32 s24, s24, 196608
    s_waitcnt lgkmcnt(3)
    v_mfma_f32_16x16x32_bf16 v[192:195], v[228:231], v[156:159], v[192:195]
    v_cvt_pk_bf16_f32 v36, v204, v205
    v_add_f32 v206, v206, v220
    v_mfma_f32_16x16x32_bf16 v[196:199], v[228:231], v[172:175], v[196:199]
    ds_read_b128 v[244:247], v4 offset:56320
    v_add_f32 v207, v207, v220
    v_exp_f32 v206, v206
    v_exp_f32 v207, v207
    s_waitcnt lgkmcnt(3)
    v_mfma_f32_16x16x32_bf16 v[184:187], v[232:235], v[160:163], v[184:187]
    v_cvt_pk_bf16_f32 v37, v206, v207
    v_add_f32 v208, v208, v216
    v_add_f32 v209, v209, v216
    v_mfma_f32_16x16x32_bf16 v[188:191], v[232:235], v[176:179], v[188:191]
    ds_read_b128 v[224:227], v4 offset:57344
    v_exp_f32 v208, v208
    v_exp_f32 v209, v209
    s_waitcnt lgkmcnt(3)
    v_mfma_f32_16x16x32_bf16 v[192:195], v[236:239], v[160:163], v[192:195]
    v_cvt_pk_bf16_f32 v34, v208, v209
    v_add_f32 v210, v210, v216
    v_add_f32 v211, v211, v216
    v_mfma_f32_16x16x32_bf16 v[196:199], v[236:239], v[176:179], v[196:199]
    ds_read_b128 v[228:231], v4 offset:58368
    v_exp_f32 v210, v210
    v_exp_f32 v211, v211
    s_nop 0
    v_cvt_pk_bf16_f32 v35, v210, v211
    s_waitcnt lgkmcnt(3)
    v_mfma_f32_16x16x32_bf16 v[184:187], v[240:243], v[164:167], v[184:187]
    v_add_f32 v212, v212, v220
    v_add_f32 v213, v213, v220
    v_mfma_f32_16x16x32_bf16 v[188:191], v[240:243], v[180:183], v[188:191]
    ds_read_b128 v[232:235], v4 offset:59392
    v_exp_f32 v212, v212
    v_exp_f32 v213, v213
    s_nop 0
    v_cvt_pk_bf16_f32 v38, v212, v213
    s_waitcnt lgkmcnt(3)
    v_mfma_f32_16x16x32_bf16 v[192:195], v[244:247], v[164:167], v[192:195]
    v_add_f32 v214, v214, v220
    v_add_f32 v215, v215, v220
    v_exp_f32 v214, v214
    v_mfma_f32_16x16x32_bf16 v[196:199], v[244:247], v[180:183], v[196:199]
    ds_read_b128 v[236:239], v4 offset:60416
    v_exp_f32 v215, v215
    s_nop 0
    v_cvt_pk_bf16_f32 v39, v214, v215
    s_waitcnt lgkmcnt(3)
    v_mfma_f32_16x16x32_bf16 v[200:203], v[224:227], v[152:155], v[216:219]
    v_mfma_f32_16x16x32_bf16 v[204:207], v[224:227], v[168:171], v[220:223]
    ds_read_b128 v[240:243], v4 offset:61440
    v_exp_f32 v184, v184
    v_exp_f32 v185, v185
    v_mfma_f32_16x16x32_bf16 v[248:251], v[12:15], v[32:35], v[248:251]
    s_waitcnt lgkmcnt(3)
    v_mfma_f32_16x16x32_bf16 v[208:211], v[228:231], v[152:155], v[216:219]
    v_cvt_pk_bf16_f32 v40, v184, v185
    v_exp_f32 v186, v186
    v_mfma_f32_16x16x32_bf16 v[212:215], v[228:231], v[168:171], v[220:223]
    ds_read_b128 v[244:247], v4 offset:62464
    v_exp_f32 v187, v187
    v_mfma_f32_16x16x32_bf16 v[252:255], v[12:15], v[36:39], v[252:255]
    s_waitcnt lgkmcnt(3)
    v_mfma_f32_16x16x32_bf16 v[200:203], v[232:235], v[156:159], v[200:203]
    v_cvt_pk_bf16_f32 v41, v186, v187
    v_exp_f32 v188, v188
    v_mfma_f32_16x16x32_bf16 v[204:207], v[232:235], v[172:175], v[204:207]
    ds_read_b128 v[224:227], v4 offset:63488
    v_exp_f32 v189, v189
    s_waitcnt lgkmcnt(3)
    v_mfma_f32_16x16x32_bf16 v[208:211], v[236:239], v[156:159], v[208:211]
    v_cvt_pk_bf16_f32 v44, v188, v189
    v_exp_f32 v190, v190
    v_mfma_f32_16x16x32_bf16 v[212:215], v[236:239], v[172:175], v[212:215]
    ds_read_b128 v[228:231], v4 offset:64512
    v_exp_f32 v191, v191
    s_nop 0
    v_cvt_pk_bf16_f32 v45, v190, v191
    s_waitcnt lgkmcnt(3)
    v_mfma_f32_16x16x32_bf16 v[200:203], v[240:243], v[160:163], v[200:203]
    v_exp_f32 v192, v192
    v_mfma_f32_16x16x32_bf16 v[204:207], v[240:243], v[176:179], v[204:207]
    s_waitcnt vmcnt(8)
    s_barrier
    ds_read_b128 v[232:235], v5 offset:0
    v_exp_f32 v193, v193
    s_nop 0
    v_cvt_pk_bf16_f32 v42, v192, v193
    s_waitcnt lgkmcnt(3)
    v_mfma_f32_16x16x32_bf16 v[208:211], v[244:247], v[160:163], v[208:211]
    v_exp_f32 v194, v194
    v_mfma_f32_16x16x32_bf16 v[212:215], v[244:247], v[176:179], v[212:215]
    s_add_u32 s22, s21, 0x18000
    s_add_u32 m0, s20, 0x18000
    s_nop 0
    buffer_load_dwordx4 v2, s[8:11], s22 offen sc1 lds
    ds_read_b128 v[236:239], v5 offset:1024
    v_exp_f32 v195, v195
    s_nop 0
    v_cvt_pk_bf16_f32 v43, v194, v195
    s_waitcnt lgkmcnt(3)
    v_mfma_f32_16x16x32_bf16 v[200:203], v[224:227], v[164:167], v[200:203]
    v_exp_f32 v196, v196
    v_exp_f32 v197, v197
    v_mfma_f32_16x16x32_bf16 v[204:207], v[224:227], v[180:183], v[204:207]
    ds_read_b128 v[240:243], v5 offset:2048
    v_cvt_pk_bf16_f32 v46, v196, v197
    s_waitcnt lgkmcnt(3)
    v_mfma_f32_16x16x32_bf16 v[208:211], v[228:231], v[164:167], v[208:211]
    v_exp_f32 v198, v198
    v_exp_f32 v199, v199
    v_mfma_f32_16x16x32_bf16 v[212:215], v[228:231], v[180:183], v[212:215]
    ds_read_b128 v[244:247], v5 offset:3072
    v_cvt_pk_bf16_f32 v47, v198, v199
    s_waitcnt lgkmcnt(3)
    v_mfma_f32_16x16x32_bf16 v[184:187], v[232:235], v[152:155], v[216:219]
    v_mfma_f32_16x16x32_bf16 v[188:191], v[232:235], v[168:171], v[220:223]
    ds_read_b128 v[224:227], v5 offset:4096
    v_exp_f32 v200, v200
    v_exp_f32 v201, v201
    v_mfma_f32_16x16x32_bf16 v[248:251], v[12:15], v[40:43], v[248:251]
    s_waitcnt lgkmcnt(3)
    v_mfma_f32_16x16x32_bf16 v[192:195], v[236:239], v[152:155], v[216:219]
    v_cvt_pk_bf16_f32 v48, v200, v201
    v_exp_f32 v202, v202
    v_mfma_f32_16x16x32_bf16 v[196:199], v[236:239], v[168:171], v[220:223]
    s_add_u32 s22, s21, 0x18400
    s_add_u32 m0, s20, 0x18400
    s_nop 0
    buffer_load_dwordx4 v2, s[8:11], s22 offen sc1 lds
    ds_read_b128 v[228:231], v5 offset:5120
    v_exp_f32 v203, v203
    v_mfma_f32_16x16x32_bf16 v[252:255], v[12:15], v[44:47], v[252:255]
    s_waitcnt lgkmcnt(3)
    v_mfma_f32_16x16x32_bf16 v[184:187], v[240:243], v[156:159], v[184:187]
    v_cvt_pk_bf16_f32 v49, v202, v203
    v_exp_f32 v204, v204
    v_mfma_f32_16x16x32_bf16 v[188:191], v[240:243], v[172:175], v[188:191]
    ds_read_b128 v[232:235], v5 offset:6144
    v_exp_f32 v205, v205
    s_waitcnt lgkmcnt(3)
    v_mfma_f32_16x16x32_bf16 v[192:195], v[244:247], v[156:159], v[192:195]
    v_cvt_pk_bf16_f32 v52, v204, v205
    v_exp_f32 v206, v206
    v_mfma_f32_16x16x32_bf16 v[196:199], v[244:247], v[172:175], v[196:199]
    ds_read_b128 v[236:239], v5 offset:7168
    v_exp_f32 v207, v207
    s_nop 0
    v_cvt_pk_bf16_f32 v53, v206, v207
    s_waitcnt lgkmcnt(3)
    v_mfma_f32_16x16x32_bf16 v[184:187], v[224:227], v[160:163], v[184:187]
    v_exp_f32 v208, v208
    v_mfma_f32_16x16x32_bf16 v[188:191], v[224:227], v[176:179], v[188:191]
    ds_read_b128 v[240:243], v5 offset:8192
    v_exp_f32 v209, v209
    s_nop 0
    v_cvt_pk_bf16_f32 v50, v208, v209
    s_waitcnt lgkmcnt(3)
    v_mfma_f32_16x16x32_bf16 v[192:195], v[228:231], v[160:163], v[192:195]
    v_exp_f32 v210, v210
    v_mfma_f32_16x16x32_bf16 v[196:199], v[228:231], v[176:179], v[196:199]
    ds_read_b128 v[244:247], v5 offset:9216
    v_exp_f32 v211, v211
    s_nop 0
    v_cvt_pk_bf16_f32 v51, v210, v211
    s_waitcnt lgkmcnt(3)
    v_mfma_f32_16x16x32_bf16 v[184:187], v[232:235], v[164:167], v[184:187]
    v_exp_f32 v212, v212
    v_exp_f32 v213, v213
    v_mfma_f32_16x16x32_bf16 v[188:191], v[232:235], v[180:183], v[188:191]
    ds_read_b128 v[224:227], v5 offset:10240
    v_cvt_pk_bf16_f32 v54, v212, v213
    s_waitcnt lgkmcnt(3)
    v_mfma_f32_16x16x32_bf16 v[192:195], v[236:239], v[164:167], v[192:195]
    v_exp_f32 v214, v214
    v_exp_f32 v215, v215
    v_mfma_f32_16x16x32_bf16 v[196:199], v[236:239], v[180:183], v[196:199]
    ds_read_b128 v[228:231], v5 offset:11264
    v_cvt_pk_bf16_f32 v55, v214, v215
    s_waitcnt lgkmcnt(3)
    v_mfma_f32_16x16x32_bf16 v[200:203], v[240:243], v[152:155], v[216:219]
    v_mfma_f32_16x16x32_bf16 v[204:207], v[240:243], v[168:171], v[220:223]
    ds_read_b128 v[232:235], v5 offset:12288
    v_exp_f32 v184, v184
    v_exp_f32 v185, v185
    v_mfma_f32_16x16x32_bf16 v[248:251], v[12:15], v[48:51], v[248:251]
    s_waitcnt lgkmcnt(3)
    v_mfma_f32_16x16x32_bf16 v[208:211], v[244:247], v[152:155], v[216:219]
    v_cvt_pk_bf16_f32 v56, v184, v185
    v_exp_f32 v186, v186
    v_mfma_f32_16x16x32_bf16 v[212:215], v[244:247], v[168:171], v[220:223]
    ds_read_b128 v[236:239], v5 offset:13312
    v_exp_f32 v187, v187
    v_mfma_f32_16x16x32_bf16 v[252:255], v[12:15], v[52:55], v[252:255]
    s_waitcnt lgkmcnt(3)
    v_mfma_f32_16x16x32_bf16 v[200:203], v[224:227], v[156:159], v[200:203]
    v_cvt_pk_bf16_f32 v57, v186, v187
    v_exp_f32 v188, v188
    v_mfma_f32_16x16x32_bf16 v[204:207], v[224:227], v[172:175], v[204:207]
    ds_read_b128 v[240:243], v5 offset:14336
    v_exp_f32 v189, v189
    s_waitcnt lgkmcnt(3)
    v_mfma_f32_16x16x32_bf16 v[208:211], v[228:231], v[156:159], v[208:211]
    v_cvt_pk_bf16_f32 v60, v188, v189
    v_exp_f32 v190, v190
    s_waitcnt vmcnt(7)
    v_mfma_f32_16x16x32_bf16 v[212:215], v[228:231], v[172:175], v[212:215]
    ds_read_b128 v[244:247], v5 offset:15360
    v_exp_f32 v191, v191
    s_nop 0
    v_cvt_pk_bf16_f32 v61, v190, v191
    s_waitcnt lgkmcnt(3)
    v_mfma_f32_16x16x32_bf16 v[200:203], v[232:235], v[160:163], v[200:203]
    v_exp_f32 v192, v192
    v_mfma_f32_16x16x32_bf16 v[204:207], v[232:235], v[176:179], v[204:207]
    s_barrier
    ds_read_b128 v[224:227], v5 offset:16384
    v_exp_f32 v193, v193
    s_nop 0
    v_cvt_pk_bf16_f32 v58, v192, v193
    s_waitcnt lgkmcnt(3)
    v_mfma_f32_16x16x32_bf16 v[208:211], v[236:239], v[160:163], v[208:211]
    v_exp_f32 v194, v194
    v_mfma_f32_16x16x32_bf16 v[212:215], v[236:239], v[176:179], v[212:215]
    s_add_u32 s22, s21, 0x1c000
    s_add_u32 m0, s20, 0x1c000
    s_nop 0
    buffer_load_dwordx4 v2, s[8:11], s22 offen sc1 lds
    ds_read_b128 v[228:231], v5 offset:17408
    v_exp_f32 v195, v195
    s_nop 0
    v_cvt_pk_bf16_f32 v59, v194, v195
    s_waitcnt lgkmcnt(3)
    v_mfma_f32_16x16x32_bf16 v[200:203], v[240:243], v[164:167], v[200:203]
    v_exp_f32 v196, v196
    v_exp_f32 v197, v197
    v_mfma_f32_16x16x32_bf16 v[204:207], v[240:243], v[180:183], v[204:207]
    ds_read_b128 v[232:235], v5 offset:18432
    v_cvt_pk_bf16_f32 v62, v196, v197
    s_waitcnt lgkmcnt(3)
    v_mfma_f32_16x16x32_bf16 v[208:211], v[244:247], v[164:167], v[208:211]
    v_exp_f32 v198, v198
    v_exp_f32 v199, v199
    v_mfma_f32_16x16x32_bf16 v[212:215], v[244:247], v[180:183], v[212:215]
    ds_read_b128 v[236:239], v5 offset:19456
    v_cvt_pk_bf16_f32 v63, v198, v199
    s_waitcnt lgkmcnt(3)
    v_mfma_f32_16x16x32_bf16 v[184:187], v[224:227], v[152:155], v[216:219]
    v_mfma_f32_16x16x32_bf16 v[188:191], v[224:227], v[168:171], v[220:223]
    ds_read_b128 v[240:243], v5 offset:20480
    v_exp_f32 v200, v200
    v_exp_f32 v201, v201
    v_mfma_f32_16x16x32_bf16 v[248:251], v[12:15], v[56:59], v[248:251]
    s_waitcnt lgkmcnt(3)
    v_mfma_f32_16x16x32_bf16 v[192:195], v[228:231], v[152:155], v[216:219]
    v_cvt_pk_bf16_f32 v64, v200, v201
    v_exp_f32 v202, v202
    v_mfma_f32_16x16x32_bf16 v[196:199], v[228:231], v[168:171], v[220:223]
    s_add_u32 s22, s21, 0x1c400
    s_add_u32 m0, s20, 0x1c400
    s_nop 0
    buffer_load_dwordx4 v2, s[8:11], s22 offen sc1 lds
    ds_read_b128 v[244:247], v5 offset:21504
    v_exp_f32 v203, v203
    v_mfma_f32_16x16x32_bf16 v[252:255], v[12:15], v[60:63], v[252:255]
    s_waitcnt lgkmcnt(3)
    v_mfma_f32_16x16x32_bf16 v[184:187], v[232:235], v[156:159], v[184:187]
    v_cvt_pk_bf16_f32 v65, v202, v203
    v_exp_f32 v204, v204
    v_mfma_f32_16x16x32_bf16 v[188:191], v[232:235], v[172:175], v[188:191]
    ds_read_b128 v[224:227], v5 offset:22528
    v_exp_f32 v205, v205
    s_waitcnt lgkmcnt(3)
    v_mfma_f32_16x16x32_bf16 v[192:195], v[236:239], v[156:159], v[192:195]
    v_cvt_pk_bf16_f32 v68, v204, v205
    v_exp_f32 v206, v206
    v_mfma_f32_16x16x32_bf16 v[196:199], v[236:239], v[172:175], v[196:199]
    ds_read_b128 v[228:231], v5 offset:23552
    v_exp_f32 v207, v207
    s_nop 0
    v_cvt_pk_bf16_f32 v69, v206, v207
    s_waitcnt lgkmcnt(3)
    v_mfma_f32_16x16x32_bf16 v[184:187], v[240:243], v[160:163], v[184:187]
    v_exp_f32 v208, v208
    v_mfma_f32_16x16x32_bf16 v[188:191], v[240:243], v[176:179], v[188:191]
    ds_read_b128 v[232:235], v5 offset:24576
    v_exp_f32 v209, v209
    s_nop 0
    v_cvt_pk_bf16_f32 v66, v208, v209
    s_waitcnt lgkmcnt(3)
    v_mfma_f32_16x16x32_bf16 v[192:195], v[244:247], v[160:163], v[192:195]
    v_exp_f32 v210, v210
    v_mfma_f32_16x16x32_bf16 v[196:199], v[244:247], v[176:179], v[196:199]
    ds_read_b128 v[236:239], v5 offset:25600
    v_exp_f32 v211, v211
    s_nop 0
    v_cvt_pk_bf16_f32 v67, v210, v211
    s_waitcnt lgkmcnt(3)
    v_mfma_f32_16x16x32_bf16 v[184:187], v[224:227], v[164:167], v[184:187]
    v_exp_f32 v212, v212
    v_exp_f32 v213, v213
    v_mfma_f32_16x16x32_bf16 v[188:191], v[224:227], v[180:183], v[188:191]
    ds_read_b128 v[240:243], v5 offset:26624
    v_cvt_pk_bf16_f32 v70, v212, v213
    s_waitcnt lgkmcnt(3)
    v_mfma_f32_16x16x32_bf16 v[192:195], v[228:231], v[164:167], v[192:195]
    v_exp_f32 v214, v214
    v_exp_f32 v215, v215
    v_mfma_f32_16x16x32_bf16 v[196:199], v[228:231], v[180:183], v[196:199]
    ds_read_b128 v[244:247], v5 offset:27648
    v_cvt_pk_bf16_f32 v71, v214, v215
    s_waitcnt lgkmcnt(3)
    v_mfma_f32_16x16x32_bf16 v[200:203], v[232:235], v[152:155], v[216:219]
    v_mfma_f32_16x16x32_bf16 v[204:207], v[232:235], v[168:171], v[220:223]
    ds_read_b128 v[224:227], v5 offset:28672
    v_exp_f32 v184, v184
    v_exp_f32 v185, v185
    v_mfma_f32_16x16x32_bf16 v[248:251], v[12:15], v[64:67], v[248:251]
    s_waitcnt lgkmcnt(3)
    v_mfma_f32_16x16x32_bf16 v[208:211], v[236:239], v[152:155], v[216:219]
    v_cvt_pk_bf16_f32 v72, v184, v185
    v_exp_f32 v186, v186
    v_mfma_f32_16x16x32_bf16 v[212:215], v[236:239], v[168:171], v[220:223]
    ds_read_b128 v[228:231], v5 offset:29696
    v_exp_f32 v187, v187
    v_mfma_f32_16x16x32_bf16 v[252:255], v[12:15], v[68:71], v[252:255]
    s_waitcnt lgkmcnt(3)
    v_mfma_f32_16x16x32_bf16 v[200:203], v[240:243], v[156:159], v[200:203]
    v_cvt_pk_bf16_f32 v73, v186, v187
    v_exp_f32 v188, v188
    v_mfma_f32_16x16x32_bf16 v[204:207], v[240:243], v[172:175], v[204:207]
    ds_read_b128 v[232:235], v5 offset:30720
    v_exp_f32 v189, v189
    s_waitcnt lgkmcnt(3)
    v_mfma_f32_16x16x32_bf16 v[208:211], v[244:247], v[156:159], v[208:211]
    v_cvt_pk_bf16_f32 v76, v188, v189
    v_exp_f32 v190, v190
    v_mfma_f32_16x16x32_bf16 v[212:215], v[244:247], v[172:175], v[212:215]
    ds_read_b128 v[236:239], v5 offset:31744
    v_exp_f32 v191, v191
    s_nop 0
    v_cvt_pk_bf16_f32 v77, v190, v191
    s_waitcnt lgkmcnt(3)
    v_mfma_f32_16x16x32_bf16 v[200:203], v[224:227], v[160:163], v[200:203]
    v_exp_f32 v192, v192
    v_mfma_f32_16x16x32_bf16 v[204:207], v[224:227], v[176:179], v[204:207]
    s_waitcnt vmcnt(7)
    s_barrier
    ds_read_b128 v[240:243], v4 offset:0
    v_exp_f32 v193, v193
    s_nop 0
    v_cvt_pk_bf16_f32 v74, v192, v193
    s_waitcnt lgkmcnt(3)
    v_mfma_f32_16x16x32_bf16 v[208:211], v[228:231], v[160:163], v[208:211]
    v_exp_f32 v194, v194
    v_mfma_f32_16x16x32_bf16 v[212:215], v[228:231], v[176:179], v[212:215]
    s_add_u32 s22, s21, 0x80000
    s_add_u32 m0, s20, 0x20000
    s_nop 0
    buffer_load_dwordx4 v2, s[8:11], s22 offen sc1 lds
    ds_read_b128 v[244:247], v4 offset:1024
    v_exp_f32 v195, v195
    s_nop 0
    v_cvt_pk_bf16_f32 v75, v194, v195
    s_waitcnt lgkmcnt(3)
    v_mfma_f32_16x16x32_bf16 v[200:203], v[232:235], v[164:167], v[200:203]
    v_exp_f32 v196, v196
    v_exp_f32 v197, v197
    v_mfma_f32_16x16x32_bf16 v[204:207], v[232:235], v[180:183], v[204:207]
    ds_read_b128 v[224:227], v4 offset:2048
    v_cvt_pk_bf16_f32 v78, v196, v197
    s_waitcnt lgkmcnt(3)
    v_mfma_f32_16x16x32_bf16 v[208:211], v[236:239], v[164:167], v[208:211]
    v_exp_f32 v198, v198
    v_exp_f32 v199, v199
    v_mfma_f32_16x16x32_bf16 v[212:215], v[236:239], v[180:183], v[212:215]
    ds_read_b128 v[228:231], v4 offset:3072
    v_cvt_pk_bf16_f32 v79, v198, v199
    s_waitcnt lgkmcnt(3)
    v_mfma_f32_16x16x32_bf16 v[184:187], v[240:243], v[152:155], v[216:219]
    v_mfma_f32_16x16x32_bf16 v[188:191], v[240:243], v[168:171], v[220:223]
    ds_read_b128 v[232:235], v4 offset:4096
    v_exp_f32 v200, v200
    v_exp_f32 v201, v201
    v_mfma_f32_16x16x32_bf16 v[248:251], v[12:15], v[72:75], v[248:251]
    s_waitcnt lgkmcnt(3)
    v_mfma_f32_16x16x32_bf16 v[192:195], v[244:247], v[152:155], v[216:219]
    v_cvt_pk_bf16_f32 v80, v200, v201
    v_exp_f32 v202, v202
    v_mfma_f32_16x16x32_bf16 v[196:199], v[244:247], v[168:171], v[220:223]
    s_add_u32 s22, s21, 0x80400
    s_add_u32 m0, s20, 0x20400
    s_nop 0
    buffer_load_dwordx4 v2, s[8:11], s22 offen sc1 lds
    ds_read_b128 v[236:239], v4 offset:5120
    v_exp_f32 v203, v203
    v_mfma_f32_16x16x32_bf16 v[252:255], v[12:15], v[76:79], v[252:255]
    s_waitcnt lgkmcnt(3)
    v_mfma_f32_16x16x32_bf16 v[184:187], v[224:227], v[156:159], v[184:187]
    v_cvt_pk_bf16_f32 v81, v202, v203
    v_exp_f32 v204, v204
    s_add_u32 s22, s18, 0
    s_add_u32 m0, s15, 0
    s_nop 0
    buffer_load_dwordx4 v11, s[64:67], s22 offen lds
    v_mfma_f32_16x16x32_bf16 v[188:191], v[224:227], v[172:175], v[188:191]
    ds_read_b128 v[240:243], v4 offset:6144
    v_exp_f32 v205, v205
    s_waitcnt lgkmcnt(3)
    v_mfma_f32_16x16x32_bf16 v[192:195], v[228:231], v[156:159], v[192:195]
    v_cvt_pk_bf16_f32 v84, v204, v205
    v_exp_f32 v206, v206
    v_mfma_f32_16x16x32_bf16 v[196:199], v[228:231], v[172:175], v[196:199]
    ds_read_b128 v[244:247], v4 offset:7168
    v_exp_f32 v207, v207
    s_nop 0
    v_cvt_pk_bf16_f32 v85, v206, v207
    s_waitcnt lgkmcnt(3)
    v_mfma_f32_16x16x32_bf16 v[184:187], v[232:235], v[160:163], v[184:187]
    v_exp_f32 v208, v208
    v_mfma_f32_16x16x32_bf16 v[188:191], v[232:235], v[176:179], v[188:191]
    ds_read_b128 v[224:227], v4 offset:8192
    v_exp_f32 v209, v209
    s_nop 0
    v_cvt_pk_bf16_f32 v82, v208, v209
    s_waitcnt lgkmcnt(3)
    v_mfma_f32_16x16x32_bf16 v[192:195], v[236:239], v[160:163], v[192:195]
    v_exp_f32 v210, v210
    v_mfma_f32_16x16x32_bf16 v[196:199], v[236:239], v[176:179], v[196:199]
    ds_read_b128 v[228:231], v4 offset:9216
    v_exp_f32 v211, v211
    s_nop 0
    v_cvt_pk_bf16_f32 v83, v210, v211
    s_waitcnt lgkmcnt(3)
    v_mfma_f32_16x16x32_bf16 v[184:187], v[240:243], v[164:167], v[184:187]
    v_exp_f32 v212, v212
    v_exp_f32 v213, v213
    v_mfma_f32_16x16x32_bf16 v[188:191], v[240:243], v[180:183], v[188:191]
    ds_read_b128 v[232:235], v4 offset:10240
    v_cvt_pk_bf16_f32 v86, v212, v213
    s_waitcnt lgkmcnt(3)
    v_mfma_f32_16x16x32_bf16 v[192:195], v[244:247], v[164:167], v[192:195]
    v_exp_f32 v214, v214
    v_exp_f32 v215, v215
    v_mfma_f32_16x16x32_bf16 v[196:199], v[244:247], v[180:183], v[196:199]
    ds_read_b128 v[236:239], v4 offset:11264
    v_cvt_pk_bf16_f32 v87, v214, v215
    s_waitcnt lgkmcnt(3)
    v_mfma_f32_16x16x32_bf16 v[200:203], v[224:227], v[152:155], v[216:219]
    v_mfma_f32_16x16x32_bf16 v[204:207], v[224:227], v[168:171], v[220:223]
    ds_read_b128 v[240:243], v4 offset:12288
    v_exp_f32 v184, v184
    v_exp_f32 v185, v185
    v_mfma_f32_16x16x32_bf16 v[248:251], v[12:15], v[80:83], v[248:251]
    s_waitcnt lgkmcnt(3)
    v_mfma_f32_16x16x32_bf16 v[208:211], v[228:231], v[152:155], v[216:219]
    v_cvt_pk_bf16_f32 v88, v184, v185
    v_exp_f32 v186, v186
    v_mfma_f32_16x16x32_bf16 v[212:215], v[228:231], v[168:171], v[220:223]
    ds_read_b128 v[244:247], v4 offset:13312
    v_exp_f32 v187, v187
    s_add_u32 s22, s18, 7168
    s_add_u32 m0, s15, 1024
    s_nop 0
    buffer_load_dwordx4 v11, s[64:67], s22 offen lds
    v_mfma_f32_16x16x32_bf16 v[252:255], v[12:15], v[84:87], v[252:255]
    s_waitcnt lgkmcnt(3)
    v_mfma_f32_16x16x32_bf16 v[200:203], v[232:235], v[156:159], v[200:203]
    v_cvt_pk_bf16_f32 v89, v186, v187
    v_exp_f32 v188, v188
    v_mfma_f32_16x16x32_bf16 v[204:207], v[232:235], v[172:175], v[204:207]
    ds_read_b128 v[224:227], v4 offset:14336
    v_exp_f32 v189, v189
    s_waitcnt lgkmcnt(3)
    v_mfma_f32_16x16x32_bf16 v[208:211], v[236:239], v[156:159], v[208:211]
    v_cvt_pk_bf16_f32 v92, v188, v189
    v_exp_f32 v190, v190
    v_mfma_f32_16x16x32_bf16 v[212:215], v[236:239], v[172:175], v[212:215]
    ds_read_b128 v[228:231], v4 offset:15360
    v_exp_f32 v191, v191
    s_nop 0
    v_cvt_pk_bf16_f32 v93, v190, v191
    s_waitcnt lgkmcnt(3)
    v_mfma_f32_16x16x32_bf16 v[200:203], v[240:243], v[160:163], v[200:203]
    v_exp_f32 v192, v192
    v_mfma_f32_16x16x32_bf16 v[204:207], v[240:243], v[176:179], v[204:207]
    s_waitcnt vmcnt(8)
    s_barrier
    ds_read_b128 v[232:235], v4 offset:16384
    v_exp_f32 v193, v193
    s_nop 0
    v_cvt_pk_bf16_f32 v90, v192, v193
    s_waitcnt lgkmcnt(3)
    v_mfma_f32_16x16x32_bf16 v[208:211], v[244:247], v[160:163], v[208:211]
    v_exp_f32 v194, v194
    v_mfma_f32_16x16x32_bf16 v[212:215], v[244:247], v[176:179], v[212:215]
    s_add_u32 s22, s21, 0x84000
    s_add_u32 m0, s20, 0x24000
    s_nop 0
    buffer_load_dwordx4 v2, s[8:11], s22 offen sc1 lds
    ds_read_b128 v[236:239], v4 offset:17408
    v_exp_f32 v195, v195
    s_nop 0
    v_cvt_pk_bf16_f32 v91, v194, v195
    s_waitcnt lgkmcnt(3)
    v_mfma_f32_16x16x32_bf16 v[200:203], v[224:227], v[164:167], v[200:203]
    v_exp_f32 v196, v196
    v_exp_f32 v197, v197
    v_mfma_f32_16x16x32_bf16 v[204:207], v[224:227], v[180:183], v[204:207]
    ds_read_b128 v[240:243], v4 offset:18432
    v_cvt_pk_bf16_f32 v94, v196, v197
    s_waitcnt lgkmcnt(3)
    v_mfma_f32_16x16x32_bf16 v[208:211], v[228:231], v[164:167], v[208:211]
    v_exp_f32 v198, v198
    v_exp_f32 v199, v199
    v_mfma_f32_16x16x32_bf16 v[212:215], v[228:231], v[180:183], v[212:215]
    ds_read_b128 v[244:247], v4 offset:19456
    v_cvt_pk_bf16_f32 v95, v198, v199
    s_waitcnt lgkmcnt(3)
    v_mfma_f32_16x16x32_bf16 v[184:187], v[232:235], v[152:155], v[216:219]
    v_mfma_f32_16x16x32_bf16 v[188:191], v[232:235], v[168:171], v[220:223]
    ds_read_b128 v[224:227], v4 offset:20480
    v_exp_f32 v200, v200
    v_exp_f32 v201, v201
    v_mfma_f32_16x16x32_bf16 v[248:251], v[12:15], v[88:91], v[248:251]
    s_waitcnt lgkmcnt(3)
    v_mfma_f32_16x16x32_bf16 v[192:195], v[236:239], v[152:155], v[216:219]
    v_cvt_pk_bf16_f32 v96, v200, v201
    v_exp_f32 v202, v202
    v_mfma_f32_16x16x32_bf16 v[196:199], v[236:239], v[168:171], v[220:223]
    s_add_u32 s22, s21, 0x84400
    s_add_u32 m0, s20, 0x24400
    s_nop 0
    buffer_load_dwordx4 v2, s[8:11], s22 offen sc1 lds
    ds_read_b128 v[228:231], v4 offset:21504
    v_exp_f32 v203, v203
    s_add_u32 s22, s18, 14336
    s_add_u32 m0, s15, 2048
    s_nop 0
    buffer_load_dwordx4 v11, s[64:67], s22 offen lds
    v_mfma_f32_16x16x32_bf16 v[252:255], v[12:15], v[92:95], v[252:255]
    s_waitcnt lgkmcnt(3)
    v_mfma_f32_16x16x32_bf16 v[184:187], v[240:243], v[156:159], v[184:187]
    v_cvt_pk_bf16_f32 v97, v202, v203
    v_exp_f32 v204, v204
    v_mfma_f32_16x16x32_bf16 v[188:191], v[240:243], v[172:175], v[188:191]
    ds_read_b128 v[232:235], v4 offset:22528
    v_exp_f32 v205, v205
    s_waitcnt lgkmcnt(3)
    v_mfma_f32_16x16x32_bf16 v[192:195], v[244:247], v[156:159], v[192:195]
    v_cvt_pk_bf16_f32 v100, v204, v205
    v_exp_f32 v206, v206
    v_mfma_f32_16x16x32_bf16 v[196:199], v[244:247], v[172:175], v[196:199]
    ds_read_b128 v[236:239], v4 offset:23552
    v_exp_f32 v207, v207
    s_nop 0
    v_cvt_pk_bf16_f32 v101, v206, v207
    s_waitcnt lgkmcnt(3)
    v_mfma_f32_16x16x32_bf16 v[184:187], v[224:227], v[160:163], v[184:187]
    v_exp_f32 v208, v208
    v_mfma_f32_16x16x32_bf16 v[188:191], v[224:227], v[176:179], v[188:191]
    ds_read_b128 v[240:243], v4 offset:24576
    v_exp_f32 v209, v209
    s_nop 0
    v_cvt_pk_bf16_f32 v98, v208, v209
    s_waitcnt lgkmcnt(3)
    v_mfma_f32_16x16x32_bf16 v[192:195], v[228:231], v[160:163], v[192:195]
    v_exp_f32 v210, v210
    v_mfma_f32_16x16x32_bf16 v[196:199], v[228:231], v[176:179], v[196:199]
    ds_read_b128 v[244:247], v4 offset:25600
    v_exp_f32 v211, v211
    s_nop 0
    v_cvt_pk_bf16_f32 v99, v210, v211
    s_waitcnt lgkmcnt(3)
    v_mfma_f32_16x16x32_bf16 v[184:187], v[232:235], v[164:167], v[184:187]
    v_exp_f32 v212, v212
    v_exp_f32 v213, v213
    v_mfma_f32_16x16x32_bf16 v[188:191], v[232:235], v[180:183], v[188:191]
    ds_read_b128 v[224:227], v4 offset:26624
    v_cvt_pk_bf16_f32 v102, v212, v213
    s_waitcnt lgkmcnt(3)
    v_mfma_f32_16x16x32_bf16 v[192:195], v[236:239], v[164:167], v[192:195]
    v_exp_f32 v214, v214
    v_exp_f32 v215, v215
    v_mfma_f32_16x16x32_bf16 v[196:199], v[236:239], v[180:183], v[196:199]
    ds_read_b128 v[228:231], v4 offset:27648
    v_cvt_pk_bf16_f32 v103, v214, v215
    s_waitcnt lgkmcnt(3)
    v_mfma_f32_16x16x32_bf16 v[200:203], v[240:243], v[152:155], v[216:219]
    v_mfma_f32_16x16x32_bf16 v[204:207], v[240:243], v[168:171], v[220:223]
    ds_read_b128 v[232:235], v4 offset:28672
    v_exp_f32 v184, v184
    v_exp_f32 v185, v185
    v_mfma_f32_16x16x32_bf16 v[248:251], v[12:15], v[96:99], v[248:251]
    s_waitcnt lgkmcnt(3)
    v_mfma_f32_16x16x32_bf16 v[208:211], v[244:247], v[152:155], v[216:219]
    v_cvt_pk_bf16_f32 v104, v184, v185
    v_exp_f32 v186, v186
    s_add_u32 s22, s18, 21504
    s_add_u32 m0, s15, 3072
    s_nop 0
    buffer_load_dwordx4 v11, s[64:67], s22 offen lds
    v_mfma_f32_16x16x32_bf16 v[212:215], v[244:247], v[168:171], v[220:223]
    ds_read_b128 v[236:239], v4 offset:29696
    v_exp_f32 v187, v187
    v_mfma_f32_16x16x32_bf16 v[252:255], v[12:15], v[100:103], v[252:255]
    s_waitcnt lgkmcnt(3)
    v_mfma_f32_16x16x32_bf16 v[200:203], v[224:227], v[156:159], v[200:203]
    v_cvt_pk_bf16_f32 v105, v186, v187
    v_exp_f32 v188, v188
    v_mfma_f32_16x16x32_bf16 v[204:207], v[224:227], v[172:175], v[204:207]
    ds_read_b128 v[240:243], v4 offset:30720
    v_exp_f32 v189, v189
    s_waitcnt lgkmcnt(3)
    v_mfma_f32_16x16x32_bf16 v[208:211], v[228:231], v[156:159], v[208:211]
    v_cvt_pk_bf16_f32 v108, v188, v189
    v_exp_f32 v190, v190
    v_mfma_f32_16x16x32_bf16 v[212:215], v[228:231], v[172:175], v[212:215]
    ds_read_b128 v[244:247], v4 offset:31744
    v_exp_f32 v191, v191
    s_nop 0
    v_cvt_pk_bf16_f32 v109, v190, v191
    s_waitcnt lgkmcnt(3)
    v_mfma_f32_16x16x32_bf16 v[200:203], v[232:235], v[160:163], v[200:203]
    v_exp_f32 v192, v192
    v_mfma_f32_16x16x32_bf16 v[204:207], v[232:235], v[176:179], v[204:207]
    s_waitcnt vmcnt(10)
    s_barrier
    ds_read_b128 v[224:227], v4 offset:32768
    v_exp_f32 v193, v193
    s_nop 0
    v_cvt_pk_bf16_f32 v106, v192, v193
    s_waitcnt lgkmcnt(3)
    v_mfma_f32_16x16x32_bf16 v[208:211], v[236:239], v[160:163], v[208:211]
    v_exp_f32 v194, v194
    v_mfma_f32_16x16x32_bf16 v[212:215], v[236:239], v[176:179], v[212:215]
    s_add_u32 s22, s21, 0x88000
    s_add_u32 m0, s20, 0x10000
    s_nop 0
    buffer_load_dwordx4 v2, s[8:11], s22 offen sc1 lds
    ds_read_b128 v[228:231], v4 offset:33792
    v_exp_f32 v195, v195
    s_nop 0
    v_cvt_pk_bf16_f32 v107, v194, v195
    s_waitcnt lgkmcnt(3)
    v_mfma_f32_16x16x32_bf16 v[200:203], v[240:243], v[164:167], v[200:203]
    v_exp_f32 v196, v196
    v_exp_f32 v197, v197
    v_mfma_f32_16x16x32_bf16 v[204:207], v[240:243], v[180:183], v[204:207]
    ds_read_b128 v[232:235], v4 offset:34816
    v_cvt_pk_bf16_f32 v110, v196, v197
    s_waitcnt lgkmcnt(3)
    v_mfma_f32_16x16x32_bf16 v[208:211], v[244:247], v[164:167], v[208:211]
    v_exp_f32 v198, v198
    v_exp_f32 v199, v199
    v_mfma_f32_16x16x32_bf16 v[212:215], v[244:247], v[180:183], v[212:215]
    ds_read_b128 v[236:239], v4 offset:35840
    v_cvt_pk_bf16_f32 v111, v198, v199
    s_waitcnt lgkmcnt(3)
    v_mfma_f32_16x16x32_bf16 v[184:187], v[224:227], v[152:155], v[216:219]
    v_mfma_f32_16x16x32_bf16 v[188:191], v[224:227], v[168:171], v[220:223]
    ds_read_b128 v[240:243], v4 offset:36864
    v_exp_f32 v200, v200
    v_exp_f32 v201, v201
    v_mfma_f32_16x16x32_bf16 v[248:251], v[12:15], v[104:107], v[248:251]
    s_waitcnt lgkmcnt(3)
    v_mfma_f32_16x16x32_bf16 v[192:195], v[228:231], v[152:155], v[216:219]
    v_cvt_pk_bf16_f32 v112, v200, v201
    v_exp_f32 v202, v202
    s_add_u32 s22, s18, 28672
    s_add_u32 m0, s15, 4096
    s_nop 0
    buffer_load_dwordx4 v11, s[64:67], s22 offen lds
    v_mfma_f32_16x16x32_bf16 v[196:199], v[228:231], v[168:171], v[220:223]
    s_add_u32 s22, s21, 0x88400
    s_add_u32 m0, s20, 0x10400
    s_nop 0
    buffer_load_dwordx4 v2, s[8:11], s22 offen sc1 lds
    ds_read_b128 v[244:247], v4 offset:37888
    v_exp_f32 v203, v203
    v_mfma_f32_16x16x32_bf16 v[252:255], v[12:15], v[108:111], v[252:255]
    s_waitcnt lgkmcnt(3)
    v_mfma_f32_16x16x32_bf16 v[184:187], v[232:235], v[156:159], v[184:187]
    v_cvt_pk_bf16_f32 v113, v202, v203
    v_exp_f32 v204, v204
    v_mfma_f32_16x16x32_bf16 v[188:191], v[232:235], v[172:175], v[188:191]
    ds_read_b128 v[224:227], v4 offset:38912
    v_exp_f32 v205, v205
    s_waitcnt lgkmcnt(3)
    v_mfma_f32_16x16x32_bf16 v[192:195], v[236:239], v[156:159], v[192:195]
    v_cvt_pk_bf16_f32 v116, v204, v205
    v_exp_f32 v206, v206
    v_mfma_f32_16x16x32_bf16 v[196:199], v[236:239], v[172:175], v[196:199]
    ds_read_b128 v[228:231], v4 offset:39936
    v_exp_f32 v207, v207
    s_nop 0
    v_cvt_pk_bf16_f32 v117, v206, v207
    s_waitcnt lgkmcnt(3)
    v_mfma_f32_16x16x32_bf16 v[184:187], v[240:243], v[160:163], v[184:187]
    v_exp_f32 v208, v208
    v_mfma_f32_16x16x32_bf16 v[188:191], v[240:243], v[176:179], v[188:191]
    ds_read_b128 v[232:235], v4 offset:40960
    v_exp_f32 v209, v209
    s_nop 0
    v_cvt_pk_bf16_f32 v114, v208, v209
    s_waitcnt lgkmcnt(3)
    v_mfma_f32_16x16x32_bf16 v[192:195], v[244:247], v[160:163], v[192:195]
    v_exp_f32 v210, v210
    v_mfma_f32_16x16x32_bf16 v[196:199], v[244:247], v[176:179], v[196:199]
    ds_read_b128 v[236:239], v4 offset:41984
    v_exp_f32 v211, v211
    s_nop 0
    v_cvt_pk_bf16_f32 v115, v210, v211
    s_waitcnt lgkmcnt(3)
    v_mfma_f32_16x16x32_bf16 v[184:187], v[224:227], v[164:167], v[184:187]
    v_exp_f32 v212, v212
    v_exp_f32 v213, v213
    v_mfma_f32_16x16x32_bf16 v[188:191], v[224:227], v[180:183], v[188:191]
    ds_read_b128 v[240:243], v4 offset:43008
    v_cvt_pk_bf16_f32 v118, v212, v213
    s_waitcnt lgkmcnt(3)
    v_mfma_f32_16x16x32_bf16 v[192:195], v[228:231], v[164:167], v[192:195]
    v_exp_f32 v214, v214
    v_exp_f32 v215, v215
    v_mfma_f32_16x16x32_bf16 v[196:199], v[228:231], v[180:183], v[196:199]
    ds_read_b128 v[244:247], v4 offset:44032
    v_cvt_pk_bf16_f32 v119, v214, v215
    s_waitcnt lgkmcnt(3)
    v_mfma_f32_16x16x32_bf16 v[200:203], v[232:235], v[152:155], v[216:219]
    v_mfma_f32_16x16x32_bf16 v[204:207], v[232:235], v[168:171], v[220:223]
    ds_read_b128 v[224:227], v4 offset:45056
    v_exp_f32 v184, v184
    v_exp_f32 v185, v185
    s_add_u32 s22, s18, 35840
    s_add_u32 m0, s15, 5120
    s_nop 0
    buffer_load_dwordx4 v11, s[64:67], s22 offen lds
    v_mfma_f32_16x16x32_bf16 v[248:251], v[12:15], v[112:115], v[248:251]
    s_waitcnt lgkmcnt(3)
    v_mfma_f32_16x16x32_bf16 v[208:211], v[236:239], v[152:155], v[216:219]
    v_cvt_pk_bf16_f32 v120, v184, v185
    v_exp_f32 v186, v186
    v_mfma_f32_16x16x32_bf16 v[212:215], v[236:239], v[168:171], v[220:223]
    ds_read_b128 v[228:231], v4 offset:46080
    v_exp_f32 v187, v187
    v_mfma_f32_16x16x32_bf16 v[252:255], v[12:15], v[116:119], v[252:255]
    s_waitcnt lgkmcnt(3)
    v_mfma_f32_16x16x32_bf16 v[200:203], v[240:243], v[156:159], v[200:203]
    v_cvt_pk_bf16_f32 v121, v186, v187
    v_exp_f32 v188, v188
    v_mfma_f32_16x16x32_bf16 v[204:207], v[240:243], v[172:175], v[204:207]
    ds_read_b128 v[232:235], v4 offset:47104
    v_exp_f32 v189, v189
    s_waitcnt lgkmcnt(3)
    v_mfma_f32_16x16x32_bf16 v[208:211], v[244:247], v[156:159], v[208:211]
    v_cvt_pk_bf16_f32 v124, v188, v189
    v_exp_f32 v190, v190
    v_mfma_f32_16x16x32_bf16 v[212:215], v[244:247], v[172:175], v[212:215]
    ds_read_b128 v[236:239], v4 offset:48128
    v_exp_f32 v191, v191
    s_nop 0
    v_cvt_pk_bf16_f32 v125, v190, v191
    s_waitcnt lgkmcnt(3)
    v_mfma_f32_16x16x32_bf16 v[200:203], v[224:227], v[160:163], v[200:203]
    v_exp_f32 v192, v192
    v_mfma_f32_16x16x32_bf16 v[204:207], v[224:227], v[176:179], v[204:207]
    s_waitcnt vmcnt(12)
    s_barrier
    ds_read_b128 v[240:243], v4 offset:49152
    v_exp_f32 v193, v193
    s_nop 0
    v_cvt_pk_bf16_f32 v122, v192, v193
    s_waitcnt lgkmcnt(3)
    v_mfma_f32_16x16x32_bf16 v[208:211], v[228:231], v[160:163], v[208:211]
    v_exp_f32 v194, v194
    v_mfma_f32_16x16x32_bf16 v[212:215], v[228:231], v[176:179], v[212:215]
    s_add_u32 s22, s21, 0x8c000
    s_add_u32 m0, s20, 0x14000
    s_nop 0
    buffer_load_dwordx4 v2, s[8:11], s22 offen sc1 lds
    ds_read_b128 v[244:247], v4 offset:50176
    v_exp_f32 v195, v195
    s_nop 0
    v_cvt_pk_bf16_f32 v123, v194, v195
    s_waitcnt lgkmcnt(3)
    v_mfma_f32_16x16x32_bf16 v[200:203], v[232:235], v[164:167], v[200:203]
    v_exp_f32 v196, v196
    v_exp_f32 v197, v197
    v_mfma_f32_16x16x32_bf16 v[204:207], v[232:235], v[180:183], v[204:207]
    ds_read_b128 v[224:227], v4 offset:51200
    v_cvt_pk_bf16_f32 v126, v196, v197
    s_waitcnt lgkmcnt(3)
    v_mfma_f32_16x16x32_bf16 v[208:211], v[236:239], v[164:167], v[208:211]
    v_exp_f32 v198, v198
    v_exp_f32 v199, v199
    v_mfma_f32_16x16x32_bf16 v[212:215], v[236:239], v[180:183], v[212:215]
    ds_read_b128 v[228:231], v4 offset:52224
    v_cvt_pk_bf16_f32 v127, v198, v199
    s_waitcnt lgkmcnt(3)
    v_mfma_f32_16x16x32_bf16 v[184:187], v[240:243], v[152:155], v[216:219]
    v_mfma_f32_16x16x32_bf16 v[188:191], v[240:243], v[168:171], v[220:223]
    ds_read_b128 v[232:235], v4 offset:53248
    v_exp_f32 v200, v200
    v_exp_f32 v201, v201
    s_add_u32 s22, s18, 43008
    s_add_u32 m0, s15, 6144
    s_nop 0
    buffer_load_dwordx4 v11, s[64:67], s22 offen lds
    v_mfma_f32_16x16x32_bf16 v[248:251], v[12:15], v[120:123], v[248:251]
    s_waitcnt lgkmcnt(3)
    v_mfma_f32_16x16x32_bf16 v[192:195], v[244:247], v[152:155], v[216:219]
    v_cvt_pk_bf16_f32 v128, v200, v201
    v_exp_f32 v202, v202
    v_mfma_f32_16x16x32_bf16 v[196:199], v[244:247], v[168:171], v[220:223]
    s_add_u32 s22, s21, 0x8c400
    s_add_u32 m0, s20, 0x14400
    s_nop 0
    buffer_load_dwordx4 v2, s[8:11], s22 offen sc1 lds
    ds_read_b128 v[236:239], v4 offset:54272
    v_exp_f32 v203, v203
    v_mfma_f32_16x16x32_bf16 v[252:255], v[12:15], v[124:127], v[252:255]
    s_waitcnt lgkmcnt(3)
    v_mfma_f32_16x16x32_bf16 v[184:187], v[224:227], v[156:159], v[184:187]
    v_cvt_pk_bf16_f32 v129, v202, v203
    v_exp_f32 v204, v204
    v_mfma_f32_16x16x32_bf16 v[188:191], v[224:227], v[172:175], v[188:191]
    ds_read_b128 v[240:243], v4 offset:55296
    v_exp_f32 v205, v205
    s_waitcnt lgkmcnt(3)
    v_mfma_f32_16x16x32_bf16 v[192:195], v[228:231], v[156:159], v[192:195]
    v_cvt_pk_bf16_f32 v132, v204, v205
    v_exp_f32 v206, v206
    v_mfma_f32_16x16x32_bf16 v[196:199], v[228:231], v[172:175], v[196:199]
    ds_read_b128 v[244:247], v4 offset:56320
    v_exp_f32 v207, v207
    s_nop 0
    v_cvt_pk_bf16_f32 v133, v206, v207
    s_waitcnt lgkmcnt(3)
    v_mfma_f32_16x16x32_bf16 v[184:187], v[232:235], v[160:163], v[184:187]
    v_exp_f32 v208, v208
    v_mfma_f32_16x16x32_bf16 v[188:191], v[232:235], v[176:179], v[188:191]
    ds_read_b128 v[224:227], v4 offset:57344
    v_exp_f32 v209, v209
    s_nop 0
    v_cvt_pk_bf16_f32 v130, v208, v209
    s_waitcnt lgkmcnt(3)
    v_mfma_f32_16x16x32_bf16 v[192:195], v[236:239], v[160:163], v[192:195]
    v_exp_f32 v210, v210
    v_mfma_f32_16x16x32_bf16 v[196:199], v[236:239], v[176:179], v[196:199]
    ds_read_b128 v[228:231], v4 offset:58368
    v_exp_f32 v211, v211
    s_nop 0
    v_cvt_pk_bf16_f32 v131, v210, v211
    s_waitcnt lgkmcnt(3)
    v_mfma_f32_16x16x32_bf16 v[184:187], v[240:243], v[164:167], v[184:187]
    v_exp_f32 v212, v212
    v_exp_f32 v213, v213
    v_mfma_f32_16x16x32_bf16 v[188:191], v[240:243], v[180:183], v[188:191]
    ds_read_b128 v[232:235], v4 offset:59392
    v_cvt_pk_bf16_f32 v134, v212, v213
    s_waitcnt lgkmcnt(3)
    v_mfma_f32_16x16x32_bf16 v[192:195], v[244:247], v[164:167], v[192:195]
    v_exp_f32 v214, v214
    v_exp_f32 v215, v215
    v_mfma_f32_16x16x32_bf16 v[196:199], v[244:247], v[180:183], v[196:199]
    ds_read_b128 v[236:239], v4 offset:60416
    v_cvt_pk_bf16_f32 v135, v214, v215
    s_waitcnt lgkmcnt(3)
    v_mfma_f32_16x16x32_bf16 v[200:203], v[224:227], v[152:155], v[216:219]
    s_add_u32 s22, s18, 50176
    s_add_u32 m0, s15, 7168
    s_nop 0
    buffer_load_dwordx4 v11, s[64:67], s22 offen lds
    v_mfma_f32_16x16x32_bf16 v[204:207], v[224:227], v[168:171], v[220:223]
    ds_read_b128 v[240:243], v4 offset:61440
    v_exp_f32 v184, v184
    v_exp_f32 v185, v185
    v_mfma_f32_16x16x32_bf16 v[248:251], v[12:15], v[128:131], v[248:251]
    s_waitcnt lgkmcnt(3)
    v_mfma_f32_16x16x32_bf16 v[208:211], v[228:231], v[152:155], v[216:219]
    v_cvt_pk_bf16_f32 v136, v184, v185
    v_exp_f32 v186, v186
    v_mfma_f32_16x16x32_bf16 v[212:215], v[228:231], v[168:171], v[220:223]
    ds_read_b128 v[244:247], v4 offset:62464
    v_exp_f32 v187, v187
    v_mfma_f32_16x16x32_bf16 v[252:255], v[12:15], v[132:135], v[252:255]
    s_waitcnt lgkmcnt(3)
    v_mfma_f32_16x16x32_bf16 v[200:203], v[232:235], v[156:159], v[200:203]
    v_cvt_pk_bf16_f32 v137, v186, v187
    v_exp_f32 v188, v188
    v_mfma_f32_16x16x32_bf16 v[204:207], v[232:235], v[172:175], v[204:207]
    ds_read_b128 v[224:227], v4 offset:63488
    v_exp_f32 v189, v189
    s_waitcnt lgkmcnt(3)
    v_mfma_f32_16x16x32_bf16 v[208:211], v[236:239], v[156:159], v[208:211]
    v_cvt_pk_bf16_f32 v140, v188, v189
    v_exp_f32 v190, v190
    v_mfma_f32_16x16x32_bf16 v[212:215], v[236:239], v[172:175], v[212:215]
    ds_read_b128 v[228:231], v4 offset:64512
    v_exp_f32 v191, v191
    s_nop 0
    v_cvt_pk_bf16_f32 v141, v190, v191
    s_waitcnt lgkmcnt(3)
    v_mfma_f32_16x16x32_bf16 v[200:203], v[240:243], v[160:163], v[200:203]
    v_exp_f32 v192, v192
    v_mfma_f32_16x16x32_bf16 v[204:207], v[240:243], v[176:179], v[204:207]
    v_exp_f32 v193, v193
    s_nop 0
    v_cvt_pk_bf16_f32 v138, v192, v193
    s_waitcnt lgkmcnt(2)
    v_mfma_f32_16x16x32_bf16 v[208:211], v[244:247], v[160:163], v[208:211]
    v_exp_f32 v194, v194
    v_mfma_f32_16x16x32_bf16 v[212:215], v[244:247], v[176:179], v[212:215]
    v_exp_f32 v195, v195
    s_nop 0
    v_cvt_pk_bf16_f32 v139, v194, v195
    s_waitcnt lgkmcnt(1)
    v_mfma_f32_16x16x32_bf16 v[200:203], v[224:227], v[164:167], v[200:203]
    v_exp_f32 v196, v196
    v_exp_f32 v197, v197
    v_mfma_f32_16x16x32_bf16 v[204:207], v[224:227], v[180:183], v[204:207]
    v_cvt_pk_bf16_f32 v142, v196, v197
    s_waitcnt lgkmcnt(0)
    v_mfma_f32_16x16x32_bf16 v[208:211], v[228:231], v[164:167], v[208:211]
    v_exp_f32 v198, v198
    v_exp_f32 v199, v199
    v_mfma_f32_16x16x32_bf16 v[212:215], v[228:231], v[180:183], v[212:215]
    v_cvt_pk_bf16_f32 v143, v198, v199
    s_waitcnt vmcnt(14)
    s_barrier
    ds_read_b128 v[232:235], v5 offset:0
    ds_read_b128 v[236:239], v5 offset:1024
    ds_read_b128 v[240:243], v5 offset:2048
    ds_read_b128 v[244:247], v5 offset:3072
    v_mfma_f32_16x16x32_bf16 v[248:251], v[12:15], v[136:139], v[248:251]
    v_mfma_f32_16x16x32_bf16 v[252:255], v[12:15], v[140:143], v[252:255]
    v_exp_f32 v200, v200
    v_exp_f32 v201, v201
    s_nop 0
    v_cvt_pk_bf16_f32 v144, v200, v201
    v_exp_f32 v202, v202
    v_exp_f32 v203, v203
    s_nop 0
    v_cvt_pk_bf16_f32 v145, v202, v203
    v_exp_f32 v204, v204
    v_exp_f32 v205, v205
    s_nop 0
    v_cvt_pk_bf16_f32 v148, v204, v205
    v_exp_f32 v206, v206
    v_exp_f32 v207, v207
    s_nop 0
    v_cvt_pk_bf16_f32 v149, v206, v207
    v_exp_f32 v208, v208
    v_exp_f32 v209, v209
    s_nop 0
    v_cvt_pk_bf16_f32 v146, v208, v209
    v_exp_f32 v210, v210
    v_exp_f32 v211, v211
    s_nop 0
    v_cvt_pk_bf16_f32 v147, v210, v211
    v_exp_f32 v212, v212
    v_exp_f32 v213, v213
    s_nop 0
    v_cvt_pk_bf16_f32 v150, v212, v213
    v_exp_f32 v214, v214
    v_exp_f32 v215, v215
    s_nop 0
    v_cvt_pk_bf16_f32 v151, v214, v215
    v_mfma_f32_16x16x32_bf16 v[248:251], v[12:15], v[144:147], v[248:251]
    s_nop 0
    v_mfma_f32_16x16x32_bf16 v[252:255], v[12:15], v[148:151], v[252:255]
    s_nop 5
    v_mov_b32 v9, v248
    s_nop 0
    v_mov_b32 v10, v252
    v_max_f32 v17, v9, v10
    v_readfirstlane_b32 s17, v8
    s_cmp_eq_u32 s17, s28
    s_cselect_b32 s16, 0, 0x71800000
    v_cmp_ngt_f32 vcc, s16, v17
    v_cmp_u_f32 s[76:77], v9, v10
    s_or_b64 vcc, vcc, s[76:77]
    s_cbranch_vccnz adaLN_cond__sliding_block_cached__moe_arch_mod__prompt_kernel_fixB
adaLN_cond__sliding_block_cached__moe_arch_mod__prompt_kernel_fixBb:
    v_rcp_f32 v9, v9
    v_rcp_f32 v10, v10
    s_lshl_b32 s25, s13, 3
    s_add_u32 s25, s25, s3
    s_lshl_b32 s25, s25, 18
    s_lshl_b32 s26, s12, 12
    s_add_u32 s25, s25, s26
    s_add_u32 s25, s25, 0x1000000
    s_add_u32 s26, s25, 131072
    s_lshl_b32 s63, s13, 3
    s_add_u32 s63, s63, s3
    s_lshl_b32 s63, s63, 5
    s_add_u32 s63, s63, s12
    s_lshl_b32 s63, s63, 2
    s_waitcnt lgkmcnt(3)
    v_mfma_f32_16x16x32_bf16 v[184:187], v[232:235], v[24:27], 0
    v_mfma_f32_16x16x32_bf16 v[188:191], v[232:235], v[28:31], 0
    ds_read_b128 v[224:227], v5 offset:4096
    s_waitcnt lgkmcnt(3)
    v_mfma_f32_16x16x32_bf16 v[192:195], v[236:239], v[24:27], 0
    s_add_u32 s22, s21, 0x90000
    s_add_u32 m0, s20, 0x18000
    s_nop 0
    buffer_load_dwordx4 v2, s[8:11], s22 offen sc1 lds
    v_mfma_f32_16x16x32_bf16 v[196:199], v[236:239], v[28:31], 0
    ds_read_b128 v[228:231], v5 offset:5120
    s_waitcnt lgkmcnt(3)
    v_mfma_f32_16x16x32_bf16 v[184:187], v[240:243], v[32:35], v[184:187]
    v_mfma_f32_16x16x32_bf16 v[188:191], v[240:243], v[36:39], v[188:191]
    ds_read_b128 v[232:235], v5 offset:6144
    s_waitcnt lgkmcnt(3)
    v_mfma_f32_16x16x32_bf16 v[192:195], v[244:247], v[32:35], v[192:195]
    v_mfma_f32_16x16x32_bf16 v[196:199], v[244:247], v[36:39], v[196:199]
    ds_read_b128 v[236:239], v5 offset:7168
    s_waitcnt lgkmcnt(3)
    v_mfma_f32_16x16x32_bf16 v[184:187], v[224:227], v[40:43], v[184:187]
    v_mfma_f32_16x16x32_bf16 v[188:191], v[224:227], v[44:47], v[188:191]
    ds_read_b128 v[240:243], v5 offset:8192
    s_waitcnt lgkmcnt(3)
    v_mfma_f32_16x16x32_bf16 v[192:195], v[228:231], v[40:43], v[192:195]
    s_add_u32 s22, s21, 0x90400
    s_add_u32 m0, s20, 0x18400
    s_nop 0
    buffer_load_dwordx4 v2, s[8:11], s22 offen sc1 lds
    v_mfma_f32_16x16x32_bf16 v[196:199], v[228:231], v[44:47], v[196:199]
    ds_read_b128 v[244:247], v5 offset:9216
    s_waitcnt lgkmcnt(3)
    v_mfma_f32_16x16x32_bf16 v[184:187], v[232:235], v[48:51], v[184:187]
    v_mfma_f32_16x16x32_bf16 v[188:191], v[232:235], v[52:55], v[188:191]
    ds_read_b128 v[224:227], v5 offset:10240
    s_waitcnt lgkmcnt(3)
    v_mfma_f32_16x16x32_bf16 v[192:195], v[236:239], v[48:51], v[192:195]
    v_mfma_f32_16x16x32_bf16 v[196:199], v[236:239], v[52:55], v[196:199]
    ds_read_b128 v[228:231], v5 offset:11264
    s_waitcnt lgkmcnt(3)
    v_mfma_f32_16x16x32_bf16 v[184:187], v[240:243], v[56:59], v[184:187]
    v_mfma_f32_16x16x32_bf16 v[188:191], v[240:243], v[60:63], v[188:191]
    ds_read_b128 v[232:235], v5 offset:12288
    s_waitcnt lgkmcnt(3)
    v_mfma_f32_16x16x32_bf16 v[192:195], v[244:247], v[56:59], v[192:195]
    v_mfma_f32_16x16x32_bf16 v[196:199], v[244:247], v[60:63], v[196:199]
    ds_read_b128 v[236:239], v5 offset:13312
    s_waitcnt lgkmcnt(3)
    v_mfma_f32_16x16x32_bf16 v[184:187], v[224:227], v[64:67], v[184:187]
    v_mfma_f32_16x16x32_bf16 v[188:191], v[224:227], v[68:71], v[188:191]
    ds_read_b128 v[240:243], v5 offset:14336
    s_waitcnt lgkmcnt(3)
    v_mfma_f32_16x16x32_bf16 v[192:195], v[228:231], v[64:67], v[192:195]
    v_mfma_f32_16x16x32_bf16 v[196:199], v[228:231], v[68:71], v[196:199]
    ds_read_b128 v[244:247], v5 offset:15360
    s_waitcnt lgkmcnt(3)
    v_mfma_f32_16x16x32_bf16 v[184:187], v[232:235], v[72:75], v[184:187]
    v_mfma_f32_16x16x32_bf16 v[188:191], v[232:235], v[76:79], v[188:191]
    s_waitcnt vmcnt(12)
    s_barrier
    ds_read_b128 v[224:227], v5 offset:16384
    s_waitcnt lgkmcnt(3)
    v_mfma_f32_16x16x32_bf16 v[192:195], v[236:239], v[72:75], v[192:195]
    v_mfma_f32_16x16x32_bf16 v[196:199], v[236:239], v[76:79], v[196:199]
    s_add_u32 s22, s21, 0x94000
    s_add_u32 m0, s20, 0x1c000
    s_nop 0
    buffer_load_dwordx4 v2, s[8:11], s22 offen sc1 lds
    ds_read_b128 v[228:231], v5 offset:17408
    s_waitcnt lgkmcnt(3)
    v_mfma_f32_16x16x32_bf16 v[184:187], v[240:243], v[80:83], v[184:187]
    v_mfma_f32_16x16x32_bf16 v[188:191], v[240:243], v[84:87], v[188:191]
    ds_read_b128 v[232:235], v5 offset:18432
    s_waitcnt lgkmcnt(3)
    v_mfma_f32_16x16x32_bf16 v[192:195], v[244:247], v[80:83], v[192:195]
    v_mfma_f32_16x16x32_bf16 v[196:199], v[244:247], v[84:87], v[196:199]
    ds_read_b128 v[236:239], v5 offset:19456
    s_waitcnt lgkmcnt(3)
    v_mfma_f32_16x16x32_bf16 v[184:187], v[224:227], v[88:91], v[184:187]
    v_mfma_f32_16x16x32_bf16 v[188:191], v[224:227], v[92:95], v[188:191]
    ds_read_b128 v[240:243], v5 offset:20480
    s_waitcnt lgkmcnt(3)
    v_mfma_f32_16x16x32_bf16 v[192:195], v[228:231], v[88:91], v[192:195]
    v_mfma_f32_16x16x32_bf16 v[196:199], v[228:231], v[92:95], v[196:199]
    s_add_u32 s22, s21, 0x94400
    s_add_u32 m0, s20, 0x1c400
    s_nop 0
    buffer_load_dwordx4 v2, s[8:11], s22 offen sc1 lds
    ds_read_b128 v[244:247], v5 offset:21504
    s_waitcnt lgkmcnt(3)
    v_mfma_f32_16x16x32_bf16 v[184:187], v[232:235], v[96:99], v[184:187]
    v_mfma_f32_16x16x32_bf16 v[188:191], v[232:235], v[100:103], v[188:191]
    ds_read_b128 v[224:227], v5 offset:22528
    s_waitcnt lgkmcnt(3)
    v_mfma_f32_16x16x32_bf16 v[192:195], v[236:239], v[96:99], v[192:195]
    v_mfma_f32_16x16x32_bf16 v[196:199], v[236:239], v[100:103], v[196:199]
    ds_read_b128 v[228:231], v5 offset:23552
    s_waitcnt lgkmcnt(3)
    v_mfma_f32_16x16x32_bf16 v[184:187], v[240:243], v[104:107], v[184:187]
    v_mfma_f32_16x16x32_bf16 v[188:191], v[240:243], v[108:111], v[188:191]
    ds_read_b128 v[232:235], v5 offset:24576
    s_waitcnt lgkmcnt(3)
    v_mfma_f32_16x16x32_bf16 v[192:195], v[244:247], v[104:107], v[192:195]
    v_mfma_f32_16x16x32_bf16 v[196:199], v[244:247], v[108:111], v[196:199]
    ds_read_b128 v[236:239], v5 offset:25600
    s_waitcnt lgkmcnt(3)
    v_mfma_f32_16x16x32_bf16 v[184:187], v[224:227], v[112:115], v[184:187]
    v_mfma_f32_16x16x32_bf16 v[188:191], v[224:227], v[116:119], v[188:191]
    ds_read_b128 v[240:243], v5 offset:26624
    s_waitcnt lgkmcnt(3)
    v_mfma_f32_16x16x32_bf16 v[192:195], v[228:231], v[112:115], v[192:195]
    v_mfma_f32_16x16x32_bf16 v[196:199], v[228:231], v[116:119], v[196:199]
    ds_read_b128 v[244:247], v5 offset:27648
    s_waitcnt lgkmcnt(3)
    v_mfma_f32_16x16x32_bf16 v[184:187], v[232:235], v[120:123], v[184:187]
    v_mfma_f32_16x16x32_bf16 v[188:191], v[232:235], v[124:127], v[188:191]
    ds_read_b128 v[224:227], v5 offset:28672
    s_waitcnt lgkmcnt(3)
    v_mfma_f32_16x16x32_bf16 v[192:195], v[236:239], v[120:123], v[192:195]
    v_mfma_f32_16x16x32_bf16 v[196:199], v[236:239], v[124:127], v[196:199]
    ds_read_b128 v[228:231], v5 offset:29696
    s_waitcnt lgkmcnt(3)
    v_mfma_f32_16x16x32_bf16 v[184:187], v[240:243], v[128:131], v[184:187]
    v_mfma_f32_16x16x32_bf16 v[188:191], v[240:243], v[132:135], v[188:191]
    ds_read_b128 v[232:235], v5 offset:30720
    s_waitcnt lgkmcnt(3)
    v_mfma_f32_16x16x32_bf16 v[192:195], v[244:247], v[128:131], v[192:195]
    v_mfma_f32_16x16x32_bf16 v[196:199], v[244:247], v[132:135], v[196:199]
    ds_read_b128 v[236:239], v5 offset:31744
    s_waitcnt lgkmcnt(3)
    v_mfma_f32_16x16x32_bf16 v[184:187], v[224:227], v[136:139], v[184:187]
    v_mfma_f32_16x16x32_bf16 v[188:191], v[224:227], v[140:143], v[188:191]
    s_waitcnt vmcnt(9)
    s_barrier
    ds_read_b128 v[240:243], v4 offset:0
    s_waitcnt lgkmcnt(3)
    v_mfma_f32_16x16x32_bf16 v[192:195], v[228:231], v[136:139], v[192:195]
    v_mfma_f32_16x16x32_bf16 v[196:199], v[228:231], v[140:143], v[196:199]
    s_add_u32 s22, s21, 0x98000
    s_add_u32 m0, s20, 0x20000
    s_nop 0
    buffer_load_dwordx4 v2, s[8:11], s22 offen sc1 lds
    ds_read_b128 v[244:247], v4 offset:1024
    s_waitcnt lgkmcnt(3)
    v_mfma_f32_16x16x32_bf16 v[184:187], v[232:235], v[144:147], v[184:187]
    v_mfma_f32_16x16x32_bf16 v[188:191], v[232:235], v[148:151], v[188:191]
    ds_read_b128 v[224:227], v4 offset:2048
    s_waitcnt lgkmcnt(3)
    v_mfma_f32_16x16x32_bf16 v[192:195], v[236:239], v[144:147], v[192:195]
    v_mfma_f32_16x16x32_bf16 v[196:199], v[236:239], v[148:151], v[196:199]
    ds_read_b128 v[228:231], v4 offset:3072
    s_waitcnt lgkmcnt(3)
    v_mfma_f32_16x16x32_bf16 v[200:203], v[240:243], v[24:27], 0
    v_mfma_f32_16x16x32_bf16 v[204:207], v[240:243], v[28:31], 0
    ds_read_b128 v[232:235], v4 offset:4096
    s_waitcnt lgkmcnt(3)
    v_mfma_f32_16x16x32_bf16 v[208:211], v[244:247], v[24:27], 0
    v_mfma_f32_16x16x32_bf16 v[212:215], v[244:247], v[28:31], 0
    s_add_u32 s22, s21, 0x98400
    s_add_u32 m0, s20, 0x20400
    s_nop 0
    buffer_load_dwordx4 v2, s[8:11], s22 offen sc1 lds
    ds_read_b128 v[236:239], v4 offset:5120
    v_mul_f32 v184, v184, v9
    s_waitcnt lgkmcnt(3)
    v_mfma_f32_16x16x32_bf16 v[200:203], v[224:227], v[32:35], v[200:203]
    v_mul_f32 v185, v185, v9
    v_mfma_f32_16x16x32_bf16 v[204:207], v[224:227], v[36:39], v[204:207]
    ds_read_b128 v[240:243], v4 offset:6144
    v_mul_f32 v186, v186, v9
    s_waitcnt lgkmcnt(3)
    v_mfma_f32_16x16x32_bf16 v[208:211], v[228:231], v[32:35], v[208:211]
    v_mul_f32 v187, v187, v9
    v_mfma_f32_16x16x32_bf16 v[212:215], v[228:231], v[36:39], v[212:215]
    ds_read_b128 v[244:247], v4 offset:7168
    v_mul_f32 v192, v192, v9
    s_waitcnt lgkmcnt(3)
    v_mfma_f32_16x16x32_bf16 v[200:203], v[232:235], v[40:43], v[200:203]
    v_mul_f32 v193, v193, v9
    v_mfma_f32_16x16x32_bf16 v[204:207], v[232:235], v[44:47], v[204:207]
    ds_read_b128 v[224:227], v4 offset:8192
    v_mul_f32 v194, v194, v9
    s_waitcnt lgkmcnt(3)
    v_mfma_f32_16x16x32_bf16 v[208:211], v[236:239], v[40:43], v[208:211]
    v_mul_f32 v195, v195, v9
    v_mfma_f32_16x16x32_bf16 v[212:215], v[236:239], v[44:47], v[212:215]
    ds_read_b128 v[228:231], v4 offset:9216
    v_cvt_pk_bf16_f32 v216, v184, v185
    s_waitcnt lgkmcnt(3)
    v_mfma_f32_16x16x32_bf16 v[200:203], v[240:243], v[48:51], v[200:203]
    v_cvt_pk_bf16_f32 v217, v186, v187
    v_mfma_f32_16x16x32_bf16 v[204:207], v[240:243], v[52:55], v[204:207]
    ds_read_b128 v[232:235], v4 offset:10240
    v_cvt_pk_bf16_f32 v218, v192, v193
    s_waitcnt lgkmcnt(3)
    v_mfma_f32_16x16x32_bf16 v[208:211], v[244:247], v[48:51], v[208:211]
    v_cvt_pk_bf16_f32 v219, v194, v195
    v_mfma_f32_16x16x32_bf16 v[212:215], v[244:247], v[52:55], v[212:215]
    ds_read_b128 v[236:239], v4 offset:11264
    buffer_store_dwordx4 v[216:219], v2, s[8:11], s25 offen offset:0 sc1
    s_waitcnt lgkmcnt(3)
    v_mfma_f32_16x16x32_bf16 v[200:203], v[224:227], v[56:59], v[200:203]
    v_mul_f32 v188, v188, v10
    v_mfma_f32_16x16x32_bf16 v[204:207], v[224:227], v[60:63], v[204:207]
    ds_read_b128 v[240:243], v4 offset:12288
    v_mul_f32 v189, v189, v10
    s_waitcnt lgkmcnt(3)
    v_mfma_f32_16x16x32_bf16 v[208:211], v[228:231], v[56:59], v[208:211]
    v_mul_f32 v190, v190, v10
    v_mfma_f32_16x16x32_bf16 v[212:215], v[228:231], v[60:63], v[212:215]
    ds_read_b128 v[244:247], v4 offset:13312
    v_mul_f32 v191, v191, v10
    s_waitcnt lgkmcnt(3)
    v_mfma_f32_16x16x32_bf16 v[200:203], v[232:235], v[64:67], v[200:203]
    v_mul_f32 v196, v196, v10
    v_mfma_f32_16x16x32_bf16 v[204:207], v[232:235], v[68:71], v[204:207]
    ds_read_b128 v[224:227], v4 offset:14336
    v_mul_f32 v197, v197, v10
    s_waitcnt lgkmcnt(3)
    v_mfma_f32_16x16x32_bf16 v[208:211], v[236:239], v[64:67], v[208:211]
    v_mul_f32 v198, v198, v10
    v_mfma_f32_16x16x32_bf16 v[212:215], v[236:239], v[68:71], v[212:215]
    ds_read_b128 v[228:231], v4 offset:15360
    v_mul_f32 v199, v199, v10
    s_waitcnt lgkmcnt(3)
    v_mfma_f32_16x16x32_bf16 v[200:203], v[240:243], v[72:75], v[200:203]
    v_cvt_pk_bf16_f32 v220, v188, v189
    v_mfma_f32_16x16x32_bf16 v[204:207], v[240:243], v[76:79], v[204:207]
    s_waitcnt vmcnt(8)
    s_barrier
    ds_read_b128 v[232:235], v4 offset:16384
    v_cvt_pk_bf16_f32 v221, v190, v191
    s_waitcnt lgkmcnt(3)
    v_mfma_f32_16x16x32_bf16 v[208:211], v[244:247], v[72:75], v[208:211]
    v_cvt_pk_bf16_f32 v222, v196, v197
    v_mfma_f32_16x16x32_bf16 v[212:215], v[244:247], v[76:79], v[212:215]
    s_add_u32 s22, s21, 0x9c000
    s_add_u32 m0, s20, 0x24000
    s_nop 0
    buffer_load_dwordx4 v2, s[8:11], s22 offen sc1 lds
    ds_read_b128 v[236:239], v4 offset:17408
    v_cvt_pk_bf16_f32 v223, v198, v199
    s_waitcnt lgkmcnt(3)
    v_mfma_f32_16x16x32_bf16 v[200:203], v[224:227], v[80:83], v[200:203]
    buffer_store_dwordx4 v[220:223], v2, s[8:11], s26 offen offset:0 sc1
    v_mfma_f32_16x16x32_bf16 v[204:207], v[224:227], v[84:87], v[204:207]
    ds_read_b128 v[240:243], v4 offset:18432
    s_waitcnt lgkmcnt(3)
    v_mfma_f32_16x16x32_bf16 v[208:211], v[228:231], v[80:83], v[208:211]
    v_mfma_f32_16x16x32_bf16 v[212:215], v[228:231], v[84:87], v[212:215]
    ds_read_b128 v[244:247], v4 offset:19456
    s_waitcnt lgkmcnt(3)
    v_mfma_f32_16x16x32_bf16 v[200:203], v[232:235], v[88:91], v[200:203]
    v_mfma_f32_16x16x32_bf16 v[204:207], v[232:235], v[92:95], v[204:207]
    ds_read_b128 v[224:227], v4 offset:20480
    s_waitcnt lgkmcnt(3)
    v_mfma_f32_16x16x32_bf16 v[208:211], v[236:239], v[88:91], v[208:211]
    v_mfma_f32_16x16x32_bf16 v[212:215], v[236:239], v[92:95], v[212:215]
    s_add_u32 s22, s21, 0x9c400
    s_add_u32 m0, s20, 0x24400
    s_nop 0
    buffer_load_dwordx4 v2, s[8:11], s22 offen sc1 lds
    ds_read_b128 v[228:231], v4 offset:21504
    s_waitcnt lgkmcnt(3)
    v_mfma_f32_16x16x32_bf16 v[200:203], v[240:243], v[96:99], v[200:203]
    v_mfma_f32_16x16x32_bf16 v[204:207], v[240:243], v[100:103], v[204:207]
    ds_read_b128 v[232:235], v4 offset:22528
    s_waitcnt lgkmcnt(3)
    v_mfma_f32_16x16x32_bf16 v[208:211], v[244:247], v[96:99], v[208:211]
    v_mfma_f32_16x16x32_bf16 v[212:215], v[244:247], v[100:103], v[212:215]
    ds_read_b128 v[236:239], v4 offset:23552
    s_waitcnt lgkmcnt(3)
    v_mfma_f32_16x16x32_bf16 v[200:203], v[224:227], v[104:107], v[200:203]
    v_mfma_f32_16x16x32_bf16 v[204:207], v[224:227], v[108:111], v[204:207]
    ds_read_b128 v[240:243], v4 offset:24576
    s_waitcnt lgkmcnt(3)
    v_mfma_f32_16x16x32_bf16 v[208:211], v[228:231], v[104:107], v[208:211]
    v_mfma_f32_16x16x32_bf16 v[212:215], v[228:231], v[108:111], v[212:215]
    ds_read_b128 v[244:247], v4 offset:25600
    s_waitcnt lgkmcnt(3)
    v_mfma_f32_16x16x32_bf16 v[200:203], v[232:235], v[112:115], v[200:203]
    v_mfma_f32_16x16x32_bf16 v[204:207], v[232:235], v[116:119], v[204:207]
    ds_read_b128 v[224:227], v4 offset:26624
    s_waitcnt lgkmcnt(3)
    v_mfma_f32_16x16x32_bf16 v[208:211], v[236:239], v[112:115], v[208:211]
    v_mfma_f32_16x16x32_bf16 v[212:215], v[236:239], v[116:119], v[212:215]
    ds_read_b128 v[228:231], v4 offset:27648
    s_waitcnt lgkmcnt(3)
    v_mfma_f32_16x16x32_bf16 v[200:203], v[240:243], v[120:123], v[200:203]
    v_mfma_f32_16x16x32_bf16 v[204:207], v[240:243], v[124:127], v[204:207]
    ds_read_b128 v[232:235], v4 offset:28672
    s_waitcnt lgkmcnt(3)
    v_mfma_f32_16x16x32_bf16 v[208:211], v[244:247], v[120:123], v[208:211]
    v_mfma_f32_16x16x32_bf16 v[212:215], v[244:247], v[124:127], v[212:215]
    ds_read_b128 v[236:239], v4 offset:29696
    s_waitcnt lgkmcnt(3)
    v_mfma_f32_16x16x32_bf16 v[200:203], v[224:227], v[128:131], v[200:203]
    v_mfma_f32_16x16x32_bf16 v[204:207], v[224:227], v[132:135], v[204:207]
    ds_read_b128 v[240:243], v4 offset:30720
    s_waitcnt lgkmcnt(3)
    v_mfma_f32_16x16x32_bf16 v[208:211], v[228:231], v[128:131], v[208:211]
    v_mfma_f32_16x16x32_bf16 v[212:215], v[228:231], v[132:135], v[212:215]
    ds_read_b128 v[244:247], v4 offset:31744
    s_waitcnt lgkmcnt(3)
    v_mfma_f32_16x16x32_bf16 v[200:203], v[232:235], v[136:139], v[200:203]
    v_mfma_f32_16x16x32_bf16 v[204:207], v[232:235], v[140:143], v[204:207]
    s_waitcnt vmcnt(8)
    s_barrier
    ds_read_b128 v[224:227], v4 offset:32768
    s_waitcnt lgkmcnt(3)
    v_mfma_f32_16x16x32_bf16 v[208:211], v[236:239], v[136:139], v[208:211]
    v_mfma_f32_16x16x32_bf16 v[212:215], v[236:239], v[140:143], v[212:215]
    s_add_u32 s22, s24, 0x0
    s_add_u32 m0, s20, 0x10000
    s_nop 0
    buffer_load_dwordx4 v3, s[4:7], s22 offen lds
    ds_read_b128 v[228:231], v4 offset:33792
    s_waitcnt lgkmcnt(3)
    v_mfma_f32_16x16x32_bf16 v[200:203], v[240:243], v[144:147], v[200:203]
    v_mfma_f32_16x16x32_bf16 v[204:207], v[240:243], v[148:151], v[204:207]
    ds_read_b128 v[232:235], v4 offset:34816
    s_waitcnt lgkmcnt(3)
    v_mfma_f32_16x16x32_bf16 v[208:211], v[244:247], v[144:147], v[208:211]
    v_mfma_f32_16x16x32_bf16 v[212:215], v[244:247], v[148:151], v[212:215]
    ds_read_b128 v[236:239], v4 offset:35840
    s_waitcnt lgkmcnt(3)
    v_mfma_f32_16x16x32_bf16 v[184:187], v[224:227], v[24:27], 0
    v_mfma_f32_16x16x32_bf16 v[188:191], v[224:227], v[28:31], 0
    ds_read_b128 v[240:243], v4 offset:36864
    s_waitcnt lgkmcnt(3)
    v_mfma_f32_16x16x32_bf16 v[192:195], v[228:231], v[24:27], 0
    v_mfma_f32_16x16x32_bf16 v[196:199], v[228:231], v[28:31], 0
    s_add_u32 s22, s24, 0x2000
    s_add_u32 m0, s20, 0x10400
    s_nop 0
    buffer_load_dwordx4 v3, s[4:7], s22 offen lds
    ds_read_b128 v[244:247], v4 offset:37888
    v_mul_f32 v200, v200, v9
    s_waitcnt lgkmcnt(3)
    v_mfma_f32_16x16x32_bf16 v[184:187], v[232:235], v[32:35], v[184:187]
    v_mul_f32 v201, v201, v9
    v_mfma_f32_16x16x32_bf16 v[188:191], v[232:235], v[36:39], v[188:191]
    ds_read_b128 v[224:227], v4 offset:38912
    v_mul_f32 v202, v202, v9
    s_waitcnt lgkmcnt(3)
    v_mfma_f32_16x16x32_bf16 v[192:195], v[236:239], v[32:35], v[192:195]
    v_mul_f32 v203, v203, v9
    v_mfma_f32_16x16x32_bf16 v[196:199], v[236:239], v[36:39], v[196:199]
    ds_read_b128 v[228:231], v4 offset:39936
    v_mul_f32 v208, v208, v9
    s_waitcnt lgkmcnt(3)
    v_mfma_f32_16x16x32_bf16 v[184:187], v[240:243], v[40:43], v[184:187]
    v_mul_f32 v209, v209, v9
    v_mfma_f32_16x16x32_bf16 v[188:191], v[240:243], v[44:47], v[188:191]
    ds_read_b128 v[232:235], v4 offset:40960
    v_mul_f32 v210, v210, v9
    s_waitcnt lgkmcnt(3)
    v_mfma_f32_16x16x32_bf16 v[192:195], v[244:247], v[40:43], v[192:195]
    v_mul_f32 v211, v211, v9
    v_mfma_f32_16x16x32_bf16 v[196:199], v[244:247], v[44:47], v[196:199]
    ds_read_b128 v[236:239], v4 offset:41984
    v_cvt_pk_bf16_f32 v216, v200, v201
    s_waitcnt lgkmcnt(3)
    v_mfma_f32_16x16x32_bf16 v[184:187], v[224:227], v[48:51], v[184:187]
    v_cvt_pk_bf16_f32 v217, v202, v203
    s_waitcnt vmcnt(3)
    s_add_u32 s16, s63, 0x570000
    v_mov_b32 v7, s28
    v_mov_b32 v8, 0
    s_mov_b64 exec, 1
    buffer_store_dword v7, v8, s[8:11], s16 offen sc1
    s_mov_b64 exec, -1
    v_mfma_f32_16x16x32_bf16 v[188:191], v[224:227], v[52:55], v[188:191]
    ds_read_b128 v[240:243], v4 offset:43008
    v_cvt_pk_bf16_f32 v218, v208, v209
    s_waitcnt lgkmcnt(3)
    v_mfma_f32_16x16x32_bf16 v[192:195], v[228:231], v[48:51], v[192:195]
    v_cvt_pk_bf16_f32 v219, v210, v211
    v_mfma_f32_16x16x32_bf16 v[196:199], v[228:231], v[52:55], v[196:199]
    ds_read_b128 v[244:247], v4 offset:44032
    buffer_store_dwordx4 v[216:219], v2, s[8:11], s25 offen offset:1024 sc1
    s_waitcnt lgkmcnt(3)
    v_mfma_f32_16x16x32_bf16 v[184:187], v[232:235], v[56:59], v[184:187]
    v_mul_f32 v204, v204, v10
    v_mfma_f32_16x16x32_bf16 v[188:191], v[232:235], v[60:63], v[188:191]
    ds_read_b128 v[224:227], v4 offset:45056
    v_mul_f32 v205, v205, v10
    s_waitcnt lgkmcnt(3)
    v_mfma_f32_16x16x32_bf16 v[192:195], v[236:239], v[56:59], v[192:195]
    v_mul_f32 v206, v206, v10
    v_mfma_f32_16x16x32_bf16 v[196:199], v[236:239], v[60:63], v[196:199]
    ds_read_b128 v[228:231], v4 offset:46080
    v_mul_f32 v207, v207, v10
    s_waitcnt lgkmcnt(3)
    v_mfma_f32_16x16x32_bf16 v[184:187], v[240:243], v[64:67], v[184:187]
    v_mul_f32 v212, v212, v10
    v_mfma_f32_16x16x32_bf16 v[188:191], v[240:243], v[68:71], v[188:191]
    ds_read_b128 v[232:235], v4 offset:47104
    v_mul_f32 v213, v213, v10
    s_waitcnt lgkmcnt(3)
    v_mfma_f32_16x16x32_bf16 v[192:195], v[244:247], v[64:67], v[192:195]
    v_mul_f32 v214, v214, v10
    v_mfma_f32_16x16x32_bf16 v[196:199], v[244:247], v[68:71], v[196:199]
    ds_read_b128 v[236:239], v4 offset:48128
    v_mul_f32 v215, v215, v10
    s_waitcnt lgkmcnt(3)
    v_mfma_f32_16x16x32_bf16 v[184:187], v[224:227], v[72:75], v[184:187]
    v_cvt_pk_bf16_f32 v220, v204, v205
    v_mfma_f32_16x16x32_bf16 v[188:191], v[224:227], v[76:79], v[188:191]
    s_barrier
    ds_read_b128 v[240:243], v4 offset:49152
    v_cvt_pk_bf16_f32 v221, v206, v207
    s_waitcnt lgkmcnt(3)
    v_mfma_f32_16x16x32_bf16 v[192:195], v[228:231], v[72:75], v[192:195]
    v_cvt_pk_bf16_f32 v222, v212, v213
    v_mfma_f32_16x16x32_bf16 v[196:199], v[228:231], v[76:79], v[196:199]
    s_add_u32 s22, s24, 0x80000
    s_add_u32 m0, s20, 0x14000
    s_nop 0
    buffer_load_dwordx4 v3, s[4:7], s22 offen lds
    ds_read_b128 v[244:247], v4 offset:50176
    v_cvt_pk_bf16_f32 v223, v214, v215
    s_waitcnt lgkmcnt(3)
    v_mfma_f32_16x16x32_bf16 v[184:187], v[232:235], v[80:83], v[184:187]
    buffer_store_dwordx4 v[220:223], v2, s[8:11], s26 offen offset:1024 sc1
    v_mfma_f32_16x16x32_bf16 v[188:191], v[232:235], v[84:87], v[188:191]
    ds_read_b128 v[224:227], v4 offset:51200
    s_waitcnt lgkmcnt(3)
    v_mfma_f32_16x16x32_bf16 v[192:195], v[236:239], v[80:83], v[192:195]
    v_mfma_f32_16x16x32_bf16 v[196:199], v[236:239], v[84:87], v[196:199]
    ds_read_b128 v[228:231], v4 offset:52224
    s_waitcnt lgkmcnt(3)
    v_mfma_f32_16x16x32_bf16 v[184:187], v[240:243], v[88:91], v[184:187]
    v_mfma_f32_16x16x32_bf16 v[188:191], v[240:243], v[92:95], v[188:191]
    ds_read_b128 v[232:235], v4 offset:53248
    s_waitcnt lgkmcnt(3)
    v_mfma_f32_16x16x32_bf16 v[192:195], v[244:247], v[88:91], v[192:195]
    v_mfma_f32_16x16x32_bf16 v[196:199], v[244:247], v[92:95], v[196:199]
    s_add_u32 s22, s24, 0x82000
    s_add_u32 m0, s20, 0x14400
    s_nop 0
    buffer_load_dwordx4 v3, s[4:7], s22 offen lds
    ds_read_b128 v[236:239], v4 offset:54272
    s_waitcnt lgkmcnt(3)
    v_mfma_f32_16x16x32_bf16 v[184:187], v[224:227], v[96:99], v[184:187]
    v_mfma_f32_16x16x32_bf16 v[188:191], v[224:227], v[100:103], v[188:191]
    ds_read_b128 v[240:243], v4 offset:55296
    s_waitcnt lgkmcnt(3)
    v_mfma_f32_16x16x32_bf16 v[192:195], v[228:231], v[96:99], v[192:195]
    v_mfma_f32_16x16x32_bf16 v[196:199], v[228:231], v[100:103], v[196:199]
    ds_read_b128 v[244:247], v4 offset:56320
    s_waitcnt lgkmcnt(3)
    v_mfma_f32_16x16x32_bf16 v[184:187], v[232:235], v[104:107], v[184:187]
    v_mfma_f32_16x16x32_bf16 v[188:191], v[232:235], v[108:111], v[188:191]
    ds_read_b128 v[224:227], v4 offset:57344
    s_waitcnt lgkmcnt(3)
    v_mfma_f32_16x16x32_bf16 v[192:195], v[236:239], v[104:107], v[192:195]
    v_mfma_f32_16x16x32_bf16 v[196:199], v[236:239], v[108:111], v[196:199]
    ds_read_b128 v[228:231], v4 offset:58368
    s_waitcnt lgkmcnt(3)
    v_mfma_f32_16x16x32_bf16 v[184:187], v[240:243], v[112:115], v[184:187]
    v_mfma_f32_16x16x32_bf16 v[188:191], v[240:243], v[116:119], v[188:191]
    ds_read_b128 v[232:235], v4 offset:59392
    s_waitcnt lgkmcnt(3)
    v_mfma_f32_16x16x32_bf16 v[192:195], v[244:247], v[112:115], v[192:195]
    v_mfma_f32_16x16x32_bf16 v[196:199], v[244:247], v[116:119], v[196:199]
    ds_read_b128 v[236:239], v4 offset:60416
    s_waitcnt lgkmcnt(3)
    v_mfma_f32_16x16x32_bf16 v[184:187], v[224:227], v[120:123], v[184:187]
    v_mfma_f32_16x16x32_bf16 v[188:191], v[224:227], v[124:127], v[188:191]
    ds_read_b128 v[240:243], v4 offset:61440
    s_waitcnt lgkmcnt(3)
    v_mfma_f32_16x16x32_bf16 v[192:195], v[228:231], v[120:123], v[192:195]
    v_mfma_f32_16x16x32_bf16 v[196:199], v[228:231], v[124:127], v[196:199]
    ds_read_b128 v[244:247], v4 offset:62464
    s_waitcnt lgkmcnt(3)
    v_mfma_f32_16x16x32_bf16 v[184:187], v[232:235], v[128:131], v[184:187]
    v_mfma_f32_16x16x32_bf16 v[188:191], v[232:235], v[132:135], v[188:191]
    ds_read_b128 v[224:227], v4 offset:63488
    s_waitcnt lgkmcnt(3)
    v_mfma_f32_16x16x32_bf16 v[192:195], v[236:239], v[128:131], v[192:195]
    v_mfma_f32_16x16x32_bf16 v[196:199], v[236:239], v[132:135], v[196:199]
    ds_read_b128 v[228:231], v4 offset:64512
    s_waitcnt lgkmcnt(3)
    v_mfma_f32_16x16x32_bf16 v[184:187], v[240:243], v[136:139], v[184:187]
    v_mfma_f32_16x16x32_bf16 v[188:191], v[240:243], v[140:143], v[188:191]
    s_barrier
    ds_read_b128 v[232:235], v5 offset:0
    s_waitcnt lgkmcnt(3)
    v_mfma_f32_16x16x32_bf16 v[192:195], v[244:247], v[136:139], v[192:195]
    v_mfma_f32_16x16x32_bf16 v[196:199], v[244:247], v[140:143], v[196:199]
    s_add_u32 s22, s24, 0x100000
    s_add_u32 m0, s20, 0x18000
    s_nop 0
    buffer_load_dwordx4 v3, s[4:7], s22 offen lds
    ds_read_b128 v[236:239], v5 offset:1024
    s_waitcnt lgkmcnt(3)
    v_mfma_f32_16x16x32_bf16 v[184:187], v[224:227], v[144:147], v[184:187]
    v_mfma_f32_16x16x32_bf16 v[188:191], v[224:227], v[148:151], v[188:191]
    ds_read_b128 v[240:243], v5 offset:2048
    s_waitcnt lgkmcnt(3)
    v_mfma_f32_16x16x32_bf16 v[192:195], v[228:231], v[144:147], v[192:195]
    v_mfma_f32_16x16x32_bf16 v[196:199], v[228:231], v[148:151], v[196:199]
    ds_read_b128 v[244:247], v5 offset:3072
    s_waitcnt lgkmcnt(3)
    v_mfma_f32_16x16x32_bf16 v[200:203], v[232:235], v[24:27], 0
    v_mfma_f32_16x16x32_bf16 v[204:207], v[232:235], v[28:31], 0
    ds_read_b128 v[224:227], v5 offset:4096
    s_waitcnt lgkmcnt(3)
    v_mfma_f32_16x16x32_bf16 v[208:211], v[236:239], v[24:27], 0
    v_mfma_f32_16x16x32_bf16 v[212:215], v[236:239], v[28:31], 0
    s_add_u32 s22, s24, 0x102000
    s_add_u32 m0, s20, 0x18400
    s_nop 0
    buffer_load_dwordx4 v3, s[4:7], s22 offen lds
    ds_read_b128 v[228:231], v5 offset:5120
    v_mul_f32 v184, v184, v9
    s_waitcnt lgkmcnt(3)
    v_mfma_f32_16x16x32_bf16 v[200:203], v[240:243], v[32:35], v[200:203]
    v_mul_f32 v185, v185, v9
    s_bfe_u32 s30, s2, 0x20001
    s_lshl_b32 s30, s30, 2
    s_bfe_u32 s17, s2, 0x20003
    s_add_u32 s30, s30, s17
    s_lshr_b32 s31, s2, 5
    s_and_b32 s17, s3, 3
    s_lshl_b32 s19, s30, 2
    s_add_u32 s19, s19, s17
    s_and_b32 s16, s2, 1
    s_lshl_b32 s17, s19, 18
    s_lshl_b32 s23, s16, 16
    s_add_u32 s17, s17, s23
    s_add_u32 s17, s17, 0x1001000
    v_add_u32 v6, s17, v2
    s_lshl_b32 s19, s19, 7
    s_lshl_b32 s23, s16, 6
    s_add_u32 s19, s19, s23
    s_add_u32 s19, s19, 0x570000
    v_and_b32 v13, 15, v1
    v_lshlrev_b32 v13, 2, v13
    buffer_load_dword v12, v13, s[8:11], s19 offen sc1
    v_mfma_f32_16x16x32_bf16 v[204:207], v[240:243], v[36:39], v[204:207]
    ds_read_b128 v[232:235], v5 offset:6144
    v_mul_f32 v186, v186, v9
    s_waitcnt lgkmcnt(3)
    v_mfma_f32_16x16x32_bf16 v[208:211], v[244:247], v[32:35], v[208:211]
    v_mul_f32 v187, v187, v9
    v_mfma_f32_16x16x32_bf16 v[212:215], v[244:247], v[36:39], v[212:215]
    ds_read_b128 v[236:239], v5 offset:7168
    v_mul_f32 v192, v192, v9
    s_waitcnt lgkmcnt(3)
    v_mfma_f32_16x16x32_bf16 v[200:203], v[224:227], v[40:43], v[200:203]
    v_mul_f32 v193, v193, v9
    v_mfma_f32_16x16x32_bf16 v[204:207], v[224:227], v[44:47], v[204:207]
    ds_read_b128 v[240:243], v5 offset:8192
    v_mul_f32 v194, v194, v9
    s_waitcnt lgkmcnt(3)
    v_mfma_f32_16x16x32_bf16 v[208:211], v[228:231], v[40:43], v[208:211]
    v_mul_f32 v195, v195, v9
    v_mfma_f32_16x16x32_bf16 v[212:215], v[228:231], v[44:47], v[212:215]
    ds_read_b128 v[244:247], v5 offset:9216
    v_cvt_pk_bf16_f32 v216, v184, v185
    s_waitcnt lgkmcnt(3)
    v_mfma_f32_16x16x32_bf16 v[200:203], v[232:235], v[48:51], v[200:203]
    v_cvt_pk_bf16_f32 v217, v186, v187
    v_mfma_f32_16x16x32_bf16 v[204:207], v[232:235], v[52:55], v[204:207]
    ds_read_b128 v[224:227], v5 offset:10240
    v_cvt_pk_bf16_f32 v218, v192, v193
    s_waitcnt lgkmcnt(3)
    v_mfma_f32_16x16x32_bf16 v[208:211], v[236:239], v[48:51], v[208:211]
    v_cvt_pk_bf16_f32 v219, v194, v195
    v_mfma_f32_16x16x32_bf16 v[212:215], v[236:239], v[52:55], v[212:215]
    ds_read_b128 v[228:231], v5 offset:11264
    buffer_store_dwordx4 v[216:219], v2, s[8:11], s25 offen offset:2048 sc1
    s_waitcnt lgkmcnt(3)
    v_mfma_f32_16x16x32_bf16 v[200:203], v[240:243], v[56:59], v[200:203]
    v_mul_f32 v188, v188, v10
    v_mfma_f32_16x16x32_bf16 v[204:207], v[240:243], v[60:63], v[204:207]
    ds_read_b128 v[232:235], v5 offset:12288
    v_mul_f32 v189, v189, v10
    s_waitcnt lgkmcnt(3)
    v_mfma_f32_16x16x32_bf16 v[208:211], v[244:247], v[56:59], v[208:211]
    v_mul_f32 v190, v190, v10
    v_mfma_f32_16x16x32_bf16 v[212:215], v[244:247], v[60:63], v[212:215]
    ds_read_b128 v[236:239], v5 offset:13312
    v_mul_f32 v191, v191, v10
    s_waitcnt lgkmcnt(3)
    v_mfma_f32_16x16x32_bf16 v[200:203], v[224:227], v[64:67], v[200:203]
    v_mul_f32 v196, v196, v10
    v_mfma_f32_16x16x32_bf16 v[204:207], v[224:227], v[68:71], v[204:207]
    ds_read_b128 v[240:243], v5 offset:14336
    v_mul_f32 v197, v197, v10
    s_waitcnt lgkmcnt(3)
    v_mfma_f32_16x16x32_bf16 v[208:211], v[228:231], v[64:67], v[208:211]
    v_mul_f32 v198, v198, v10
    v_mfma_f32_16x16x32_bf16 v[212:215], v[228:231], v[68:71], v[212:215]
    ds_read_b128 v[244:247], v5 offset:15360
    v_mul_f32 v199, v199, v10
    s_waitcnt lgkmcnt(3)
    v_mfma_f32_16x16x32_bf16 v[200:203], v[232:235], v[72:75], v[200:203]
    v_cvt_pk_bf16_f32 v220, v188, v189
    v_mfma_f32_16x16x32_bf16 v[204:207], v[232:235], v[76:79], v[204:207]
    s_waitcnt vmcnt(11)
    s_barrier
    ds_read_b128 v[224:227], v5 offset:16384
    v_cvt_pk_bf16_f32 v221, v190, v191
    s_waitcnt lgkmcnt(3)
    v_mfma_f32_16x16x32_bf16 v[208:211], v[236:239], v[72:75], v[208:211]
    v_cvt_pk_bf16_f32 v222, v196, v197
    v_mfma_f32_16x16x32_bf16 v[212:215], v[236:239], v[76:79], v[212:215]
    s_add_u32 s22, s24, 0x180000
    s_add_u32 m0, s20, 0x1c000
    s_nop 0
    buffer_load_dwordx4 v3, s[4:7], s22 offen lds
    ds_read_b128 v[228:231], v5 offset:17408
    v_cvt_pk_bf16_f32 v223, v198, v199
    s_waitcnt lgkmcnt(3)
    v_mfma_f32_16x16x32_bf16 v[200:203], v[240:243], v[80:83], v[200:203]
    buffer_store_dwordx4 v[220:223], v2, s[8:11], s26 offen offset:2048 sc1
    v_mfma_f32_16x16x32_bf16 v[204:207], v[240:243], v[84:87], v[204:207]
    ds_read_b128 v[232:235], v5 offset:18432
    s_waitcnt lgkmcnt(3)
    v_mfma_f32_16x16x32_bf16 v[208:211], v[244:247], v[80:83], v[208:211]
    v_mfma_f32_16x16x32_bf16 v[212:215], v[244:247], v[84:87], v[212:215]
    ds_read_b128 v[236:239], v5 offset:19456
    s_waitcnt lgkmcnt(3)
    v_mfma_f32_16x16x32_bf16 v[200:203], v[224:227], v[88:91], v[200:203]
    v_mfma_f32_16x16x32_bf16 v[204:207], v[224:227], v[92:95], v[204:207]
    ds_read_b128 v[240:243], v5 offset:20480
    s_waitcnt vmcnt(3)
    v_cmp_ne_u32 vcc, s28, v12
    s_cbranch_vccnz adaLN_cond__sliding_block_cached__moe_arch_mod__prompt_kernel_o17r
adaLN_cond__sliding_block_cached__moe_arch_mod__prompt_kernel_o17b:
    s_waitcnt lgkmcnt(3)
    v_mfma_f32_16x16x32_bf16 v[208:211], v[228:231], v[88:91], v[208:211]
    s_mov_b32 s23, 0x0
    buffer_load_dwordx4 v[24:27], v6, s[8:11], s23 offen offset:0 sc1
    v_mfma_f32_16x16x32_bf16 v[212:215], v[228:231], v[92:95], v[212:215]
    s_add_u32 s22, s24, 0x182000
    s_add_u32 m0, s20, 0x1c400
    s_nop 0
    buffer_load_dwordx4 v3, s[4:7], s22 offen lds
    ds_read_b128 v[244:247], v5 offset:21504
    s_waitcnt lgkmcnt(3)
    v_mfma_f32_16x16x32_bf16 v[200:203], v[232:235], v[96:99], v[200:203]
    v_mfma_f32_16x16x32_bf16 v[204:207], v[232:235], v[100:103], v[204:207]
    ds_read_b128 v[224:227], v5 offset:22528
    s_mov_b32 s23, 0x20000
    buffer_load_dwordx4 v[28:31], v6, s[8:11], s23 offen offset:0 sc1
    s_waitcnt lgkmcnt(3)
    v_mfma_f32_16x16x32_bf16 v[208:211], v[236:239], v[96:99], v[208:211]
    s_add_u32 s16, s63, 0x572000
    v_mov_b32 v14, s28
    v_mov_b32 v15, 0
    s_mov_b64 exec, 1
    buffer_store_dword v14, v15, s[8:11], s16 offen sc1
    s_mov_b64 exec, -1
    v_mfma_f32_16x16x32_bf16 v[212:215], v[236:239], v[100:103], v[212:215]
    ds_read_b128 v[228:231], v5 offset:23552
    s_waitcnt lgkmcnt(3)
    v_mfma_f32_16x16x32_bf16 v[200:203], v[240:243], v[104:107], v[200:203]
    v_mfma_f32_16x16x32_bf16 v[204:207], v[240:243], v[108:111], v[204:207]
    ds_read_b128 v[232:235], v5 offset:24576
    s_mov_b32 s23, 0x2000
    buffer_load_dwordx4 v[32:35], v6, s[8:11], s23 offen offset:0 sc1
    s_waitcnt lgkmcnt(3)
    v_mfma_f32_16x16x32_bf16 v[208:211], v[244:247], v[104:107], v[208:211]
    v_mfma_f32_16x16x32_bf16 v[212:215], v[244:247], v[108:111], v[212:215]
    ds_read_b128 v[236:239], v5 offset:25600
    s_waitcnt lgkmcnt(3)
    v_mfma_f32_16x16x32_bf16 v[200:203], v[224:227], v[112:115], v[200:203]
    s_mov_b32 s23, 0x22000
    buffer_load_dwordx4 v[36:39], v6, s[8:11], s23 offen offset:0 sc1
    v_mfma_f32_16x16x32_bf16 v[204:207], v[224:227], v[116:119], v[204:207]
    ds_read_b128 v[240:243], v5 offset:26624
    s_waitcnt lgkmcnt(3)
    v_mfma_f32_16x16x32_bf16 v[208:211], v[228:231], v[112:115], v[208:211]
    v_mfma_f32_16x16x32_bf16 v[212:215], v[228:231], v[116:119], v[212:215]
    ds_read_b128 v[244:247], v5 offset:27648
    s_waitcnt lgkmcnt(3)
    v_mfma_f32_16x16x32_bf16 v[200:203], v[232:235], v[120:123], v[200:203]
    s_mov_b32 s23, 0x4000
    buffer_load_dwordx4 v[40:43], v6, s[8:11], s23 offen offset:0 sc1
    v_mfma_f32_16x16x32_bf16 v[204:207], v[232:235], v[124:127], v[204:207]
    ds_read_b128 v[224:227], v5 offset:28672
    s_waitcnt lgkmcnt(3)
    v_mfma_f32_16x16x32_bf16 v[208:211], v[236:239], v[120:123], v[208:211]
    v_mfma_f32_16x16x32_bf16 v[212:215], v[236:239], v[124:127], v[212:215]
    ds_read_b128 v[228:231], v5 offset:29696
    s_waitcnt lgkmcnt(3)
    v_mfma_f32_16x16x32_bf16 v[200:203], v[240:243], v[128:131], v[200:203]
    s_mov_b32 s23, 0x24000
    buffer_load_dwordx4 v[44:47], v6, s[8:11], s23 offen offset:0 sc1
    v_mfma_f32_16x16x32_bf16 v[204:207], v[240:243], v[132:135], v[204:207]
    ds_read_b128 v[232:235], v5 offset:30720
    s_waitcnt lgkmcnt(3)
    v_mfma_f32_16x16x32_bf16 v[208:211], v[244:247], v[128:131], v[208:211]
    v_mfma_f32_16x16x32_bf16 v[212:215], v[244:247], v[132:135], v[212:215]
    ds_read_b128 v[236:239], v5 offset:31744
    s_mov_b32 s23, 0x6000
    buffer_load_dwordx4 v[48:51], v6, s[8:11], s23 offen offset:0 sc1
    s_waitcnt lgkmcnt(3)
    v_mfma_f32_16x16x32_bf16 v[200:203], v[224:227], v[136:139], v[200:203]
    v_bfe_u32 v18, v1, 2, 2
    v_lshrrev_b32 v19, 4, v1
    v_mfma_f32_16x16x32_bf16 v[204:207], v[224:227], v[140:143], v[204:207]
    v_and_b32 v17, 3, v1
    v_lshlrev_b32 v16, 11, v19
    s_waitcnt lgkmcnt(2)
    v_mfma_f32_16x16x32_bf16 v[208:211], v[228:231], v[136:139], v[208:211]
    v_lshl_add_u32 v16, v18, 6, v16
    v_lshl_add_u32 v16, v17, 3, v16
    v_mfma_f32_16x16x32_bf16 v[212:215], v[228:231], v[140:143], v[212:215]
    s_mov_b32 s23, 0x26000
    buffer_load_dwordx4 v[52:55], v6, s[8:11], s23 offen offset:0 sc1
    v_add_u32 v16, 0x12000, v16
    v_and_b32 v19, 1, v19
    s_waitcnt lgkmcnt(1)
    v_mfma_f32_16x16x32_bf16 v[200:203], v[232:235], v[144:147], v[200:203]
    v_lshlrev_b32 v19, 5, v19
    v_sub_u32 v5, v16, v19
    v_mfma_f32_16x16x32_bf16 v[204:207], v[232:235], v[148:151], v[204:207]
    v_add_u32 v4, v16, v19
    v_add_u32 v7, 0x10000, v4
    s_waitcnt lgkmcnt(0)
    v_mfma_f32_16x16x32_bf16 v[208:211], v[236:239], v[144:147], v[208:211]
    v_add_u32 v8, 0x10000, v5
    v_mfma_f32_16x16x32_bf16 v[212:215], v[236:239], v[148:151], v[212:215]
    v_mul_f32 v200, v200, v9
    v_mul_f32 v201, v201, v9
    v_mul_f32 v202, v202, v9
    v_mul_f32 v203, v203, v9
    s_nop 1
    v_mul_f32 v208, v208, v9
    v_mul_f32 v209, v209, v9
    v_mul_f32 v210, v210, v9
    v_mul_f32 v211, v211, v9
    v_cvt_pk_bf16_f32 v216, v200, v201
    v_cvt_pk_bf16_f32 v217, v202, v203
    v_cvt_pk_bf16_f32 v218, v208, v209
    v_cvt_pk_bf16_f32 v219, v210, v211
    buffer_store_dwordx4 v[216:219], v2, s[8:11], s25 offen offset:3072 sc1
    v_mul_f32 v204, v204, v10
    v_mul_f32 v205, v205, v10
    v_mul_f32 v206, v206, v10
    v_mul_f32 v207, v207, v10
    v_mul_f32 v212, v212, v10
    v_mul_f32 v213, v213, v10
    v_mul_f32 v214, v214, v10
    v_mul_f32 v215, v215, v10
    v_cvt_pk_bf16_f32 v220, v204, v205
    v_cvt_pk_bf16_f32 v221, v206, v207
    v_cvt_pk_bf16_f32 v222, v212, v213
    v_cvt_pk_bf16_f32 v223, v214, v215
    buffer_store_dwordx4 v[220:223], v2, s[8:11], s26 offen offset:3072 sc1
    s_and_b32 s15, s2, 1
    s_barrier
    ds_read_b64_tr_b16 v[224:225], v4 offset:0
    ds_read_b64_tr_b16 v[226:227], v4 offset:1024
    ds_read_b64_tr_b16 v[228:229], v5 offset:32
    ds_read_b64_tr_b16 v[230:231], v5 offset:1056
    ds_read_b64_tr_b16 v[232:233], v4 offset:256
    ds_read_b64_tr_b16 v[234:235], v4 offset:1280
    ds_read_b64_tr_b16 v[236:237], v5 offset:288
    ds_read_b64_tr_b16 v[238:239], v5 offset:1312
    s_waitcnt vmcnt(11) lgkmcnt(6)
    v_mfma_f32_16x16x32_bf16 v[88:91], v[224:227], v[24:27], 0
    ds_read_b64_tr_b16 v[240:241], v4 offset:512
    s_waitcnt vmcnt(9)
    v_mfma_f32_16x16x32_bf16 v[92:95], v[224:227], v[28:31], 0
    ds_read_b64_tr_b16 v[242:243], v4 offset:1536
    s_waitcnt lgkmcnt(6)
    v_mfma_f32_16x16x32_bf16 v[96:99], v[228:231], v[24:27], 0
    ds_read_b64_tr_b16 v[244:245], v5 offset:544
    v_mfma_f32_16x16x32_bf16 v[100:103], v[228:231], v[28:31], 0
    ds_read_b64_tr_b16 v[246:247], v5 offset:1568
    s_waitcnt lgkmcnt(6)
    v_mfma_f32_16x16x32_bf16 v[104:107], v[232:235], v[24:27], 0
    ds_read_b64_tr_b16 v[224:225], v4 offset:768
    v_mfma_f32_16x16x32_bf16 v[108:111], v[232:235], v[28:31], 0
    ds_read_b64_tr_b16 v[226:227], v4 offset:1792
    s_waitcnt lgkmcnt(6)
    v_mfma_f32_16x16x32_bf16 v[112:115], v[236:239], v[24:27], 0
    ds_read_b64_tr_b16 v[228:229], v5 offset:800
    v_mfma_f32_16x16x32_bf16 v[116:119], v[236:239], v[28:31], 0
    ds_read_b64_tr_b16 v[230:231], v5 offset:1824
    s_waitcnt lgkmcnt(6)
    v_mfma_f32_16x16x32_bf16 v[120:123], v[240:243], v[24:27], 0
    s_add_u32 s22, s24, 0x200000
    s_add_u32 m0, s20, 0x20000
    s_nop 0
    buffer_load_dwordx4 v3, s[4:7], s22 offen lds
    v_mfma_f32_16x16x32_bf16 v[124:127], v[240:243], v[28:31], 0
    s_barrier
    ds_read_b64_tr_b16 v[232:233], v4 offset:16384
    ds_read_b64_tr_b16 v[234:235], v4 offset:17408
    s_waitcnt lgkmcnt(6)
    v_mfma_f32_16x16x32_bf16 v[128:131], v[244:247], v[24:27], 0
    ds_read_b64_tr_b16 v[236:237], v5 offset:16416
    s_mov_b32 s23, 0x8000
    buffer_load_dwordx4 v[56:59], v6, s[8:11], s23 offen offset:0 sc1
    v_mfma_f32_16x16x32_bf16 v[132:135], v[244:247], v[28:31], 0
    s_add_u32 s22, s24, 0x202000
    s_add_u32 m0, s20, 0x20400
    s_nop 0
    buffer_load_dwordx4 v3, s[4:7], s22 offen lds
    ds_read_b64_tr_b16 v[238:239], v5 offset:17440
    s_waitcnt lgkmcnt(6)
    v_mfma_f32_16x16x32_bf16 v[136:139], v[224:227], v[24:27], 0
    ds_read_b64_tr_b16 v[240:241], v4 offset:16640
    v_mfma_f32_16x16x32_bf16 v[140:143], v[224:227], v[28:31], 0
    ds_read_b64_tr_b16 v[242:243], v4 offset:17664
    s_mov_b32 s23, 0x28000
    buffer_load_dwordx4 v[60:63], v6, s[8:11], s23 offen offset:0 sc1
    s_waitcnt lgkmcnt(6)
    v_mfma_f32_16x16x32_bf16 v[144:147], v[228:231], v[24:27], 0
    ds_read_b64_tr_b16 v[244:245], v5 offset:16672
    v_mfma_f32_16x16x32_bf16 v[148:151], v[228:231], v[28:31], 0
    ds_read_b64_tr_b16 v[246:247], v5 offset:17696
    s_waitcnt vmcnt(11) lgkmcnt(6)
    v_mfma_f32_16x16x32_bf16 v[88:91], v[232:235], v[32:35], v[88:91]
    ds_read_b64_tr_b16 v[224:225], v4 offset:16896
    s_waitcnt vmcnt(10)
    v_mfma_f32_16x16x32_bf16 v[92:95], v[232:235], v[36:39], v[92:95]
    s_add_u32 s22, s24, 0x280000
    s_add_u32 m0, s20, 0x24000
    s_nop 0
    buffer_load_dwordx4 v3, s[4:7], s22 offen lds
    ds_read_b64_tr_b16 v[226:227], v4 offset:17920
    s_waitcnt lgkmcnt(6)
    v_mfma_f32_16x16x32_bf16 v[96:99], v[236:239], v[32:35], v[96:99]
    ds_read_b64_tr_b16 v[228:229], v5 offset:16928
    v_mfma_f32_16x16x32_bf16 v[100:103], v[236:239], v[36:39], v[100:103]
    ds_read_b64_tr_b16 v[230:231], v5 offset:17952
    s_waitcnt lgkmcnt(6)
    v_mfma_f32_16x16x32_bf16 v[104:107], v[240:243], v[32:35], v[104:107]
    s_add_u32 s22, s24, 0x282000
    s_add_u32 m0, s20, 0x24400
    s_nop 0
    buffer_load_dwordx4 v3, s[4:7], s22 offen lds
    ds_read_b64_tr_b16 v[232:233], v4 offset:17152
    v_mfma_f32_16x16x32_bf16 v[108:111], v[240:243], v[36:39], v[108:111]
    ds_read_b64_tr_b16 v[234:235], v4 offset:18176
    s_waitcnt lgkmcnt(6)
    v_mfma_f32_16x16x32_bf16 v[112:115], v[244:247], v[32:35], v[112:115]
    ds_read_b64_tr_b16 v[236:237], v5 offset:17184
    v_mfma_f32_16x16x32_bf16 v[116:119], v[244:247], v[36:39], v[116:119]
    ds_read_b64_tr_b16 v[238:239], v5 offset:18208
    s_waitcnt lgkmcnt(6)
    v_mfma_f32_16x16x32_bf16 v[120:123], v[224:227], v[32:35], v[120:123]
    v_mfma_f32_16x16x32_bf16 v[124:127], v[224:227], v[36:39], v[124:127]
    s_barrier
    ds_read_b64_tr_b16 v[240:241], v4 offset:32768
    ds_read_b64_tr_b16 v[242:243], v4 offset:33792
    s_waitcnt lgkmcnt(6)
    v_mfma_f32_16x16x32_bf16 v[128:131], v[228:231], v[32:35], v[128:131]
    ds_read_b64_tr_b16 v[244:245], v5 offset:32800
    s_mov_b32 s23, 0xa000
    buffer_load_dwordx4 v[24:27], v6, s[8:11], s23 offen offset:0 sc1
    v_mfma_f32_16x16x32_bf16 v[132:135], v[228:231], v[36:39], v[132:135]
    ds_read_b64_tr_b16 v[246:247], v5 offset:33824
    s_waitcnt lgkmcnt(6)
    v_mfma_f32_16x16x32_bf16 v[136:139], v[232:235], v[32:35], v[136:139]
    ds_read_b64_tr_b16 v[224:225], v4 offset:33024
    v_mfma_f32_16x16x32_bf16 v[140:143], v[232:235], v[36:39], v[140:143]
    ds_read_b64_tr_b16 v[226:227], v4 offset:34048
    s_mov_b32 s23, 0x2a000
    buffer_load_dwordx4 v[28:31], v6, s[8:11], s23 offen offset:0 sc1
    s_waitcnt lgkmcnt(6)
    v_mfma_f32_16x16x32_bf16 v[144:147], v[236:239], v[32:35], v[144:147]
    s_add_u32 s16, s63, 0x574000
    v_mov_b32 v14, s28
    v_mov_b32 v15, 0
    s_mov_b64 exec, 1
    buffer_store_dword v14, v15, s[8:11], s16 offen sc1
    s_mov_b64 exec, -1
    ds_read_b64_tr_b16 v[228:229], v5 offset:33056
    v_mfma_f32_16x16x32_bf16 v[148:151], v[236:239], v[36:39], v[148:151]
    ds_read_b64_tr_b16 v[230:231], v5 offset:34080
    s_waitcnt vmcnt(14) lgkmcnt(6)
    v_mfma_f32_16x16x32_bf16 v[88:91], v[240:243], v[40:43], v[88:91]
    ds_read_b64_tr_b16 v[232:233], v4 offset:33280
    s_waitcnt vmcnt(13)
    v_mfma_f32_16x16x32_bf16 v[92:95], v[240:243], v[44:47], v[92:95]
    s_add_u32 s22, s24, 0x300000
    s_add_u32 m0, s20, 0x10000
    s_nop 0
    buffer_load_dwordx4 v3, s[4:7], s22 offen lds
    ds_read_b64_tr_b16 v[234:235], v4 offset:34304
    s_waitcnt lgkmcnt(6)
    v_mfma_f32_16x16x32_bf16 v[96:99], v[244:247], v[40:43], v[96:99]
    ds_read_b64_tr_b16 v[236:237], v5 offset:33312
    v_mfma_f32_16x16x32_bf16 v[100:103], v[244:247], v[44:47], v[100:103]
    ds_read_b64_tr_b16 v[238:239], v5 offset:34336
    s_waitcnt lgkmcnt(6)
    v_mfma_f32_16x16x32_bf16 v[104:107], v[224:227], v[40:43], v[104:107]
    s_add_u32 s22, s24, 0x302000
    s_add_u32 m0, s20, 0x10400
    s_nop 0
    buffer_load_dwordx4 v3, s[4:7], s22 offen lds
    ds_read_b64_tr_b16 v[240:241], v4 offset:33536
    v_mfma_f32_16x16x32_bf16 v[108:111], v[224:227], v[44:47], v[108:111]
    ds_read_b64_tr_b16 v[242:243], v4 offset:34560
    s_waitcnt lgkmcnt(6)
    v_mfma_f32_16x16x32_bf16 v[112:115], v[228:231], v[40:43], v[112:115]
    ds_read_b64_tr_b16 v[244:245], v5 offset:33568
    v_mfma_f32_16x16x32_bf16 v[116:119], v[228:231], v[44:47], v[116:119]
    ds_read_b64_tr_b16 v[246:247], v5 offset:34592
    s_waitcnt lgkmcnt(6)
    v_mfma_f32_16x16x32_bf16 v[120:123], v[232:235], v[40:43], v[120:123]
    v_mfma_f32_16x16x32_bf16 v[124:127], v[232:235], v[44:47], v[124:127]
    s_barrier
    ds_read_b64_tr_b16 v[224:225], v4 offset:49152
    ds_read_b64_tr_b16 v[226:227], v4 offset:50176
    s_add_u32 s19, s19, 8192
    buffer_load_dword v12, v13, s[8:11], s19 offen sc1
    s_waitcnt lgkmcnt(6)
    v_mfma_f32_16x16x32_bf16 v[128:131], v[236:239], v[40:43], v[128:131]
    ds_read_b64_tr_b16 v[228:229], v5 offset:49184
    s_mov_b32 s23, 0xc000
    buffer_load_dwordx4 v[32:35], v6, s[8:11], s23 offen offset:0 sc1
    v_mfma_f32_16x16x32_bf16 v[132:135], v[236:239], v[44:47], v[132:135]
    ds_read_b64_tr_b16 v[230:231], v5 offset:50208
    s_waitcnt lgkmcnt(6)
    v_mfma_f32_16x16x32_bf16 v[136:139], v[240:243], v[40:43], v[136:139]
    ds_read_b64_tr_b16 v[232:233], v4 offset:49408
    v_mfma_f32_16x16x32_bf16 v[140:143], v[240:243], v[44:47], v[140:143]
    ds_read_b64_tr_b16 v[234:235], v4 offset:50432
    s_mov_b32 s23, 0x2c000
    buffer_load_dwordx4 v[36:39], v6, s[8:11], s23 offen offset:0 sc1
    s_waitcnt lgkmcnt(6)
    v_mfma_f32_16x16x32_bf16 v[144:147], v[244:247], v[40:43], v[144:147]
    ds_read_b64_tr_b16 v[236:237], v5 offset:49440
    v_mfma_f32_16x16x32_bf16 v[148:151], v[244:247], v[44:47], v[148:151]
    ds_read_b64_tr_b16 v[238:239], v5 offset:50464
    s_waitcnt vmcnt(17) lgkmcnt(6)
    v_mfma_f32_16x16x32_bf16 v[88:91], v[224:227], v[48:51], v[88:91]
    ds_read_b64_tr_b16 v[240:241], v4 offset:49664
    s_waitcnt vmcnt(16)
    v_mfma_f32_16x16x32_bf16 v[92:95], v[224:227], v[52:55], v[92:95]
    s_add_u32 s22, s24, 0x380000
    s_add_u32 m0, s20, 0x14000
    s_nop 0
    buffer_load_dwordx4 v3, s[4:7], s22 offen lds
    ds_read_b64_tr_b16 v[242:243], v4 offset:50688
    s_waitcnt lgkmcnt(6)
    v_mfma_f32_16x16x32_bf16 v[96:99], v[228:231], v[48:51], v[96:99]
    ds_read_b64_tr_b16 v[244:245], v5 offset:49696
    v_mfma_f32_16x16x32_bf16 v[100:103], v[228:231], v[52:55], v[100:103]
    ds_read_b64_tr_b16 v[246:247], v5 offset:50720
    s_waitcnt lgkmcnt(6)
    v_mfma_f32_16x16x32_bf16 v[104:107], v[232:235], v[48:51], v[104:107]
    s_add_u32 s22, s24, 0x382000
    s_add_u32 m0, s20, 0x14400
    s_nop 0
    buffer_load_dwordx4 v3, s[4:7], s22 offen lds
    ds_read_b64_tr_b16 v[224:225], v4 offset:49920
    v_mfma_f32_16x16x32_bf16 v[108:111], v[232:235], v[52:55], v[108:111]
    ds_read_b64_tr_b16 v[226:227], v4 offset:50944
    s_waitcnt lgkmcnt(6)
    v_mfma_f32_16x16x32_bf16 v[112:115], v[236:239], v[48:51], v[112:115]
    ds_read_b64_tr_b16 v[228:229], v5 offset:49952
    v_mfma_f32_16x16x32_bf16 v[116:119], v[236:239], v[52:55], v[116:119]
    ds_read_b64_tr_b16 v[230:231], v5 offset:50976
    s_waitcnt lgkmcnt(6)
    v_mfma_f32_16x16x32_bf16 v[120:123], v[240:243], v[48:51], v[120:123]
    v_mfma_f32_16x16x32_bf16 v[124:127], v[240:243], v[52:55], v[124:127]
    s_waitcnt vmcnt(13)
    s_barrier
    ds_read_b64_tr_b16 v[232:233], v7 offset:0
    ds_read_b64_tr_b16 v[234:235], v7 offset:1024
    s_waitcnt lgkmcnt(6)
    v_mfma_f32_16x16x32_bf16 v[128:131], v[244:247], v[48:51], v[128:131]
    ds_read_b64_tr_b16 v[236:237], v8 offset:32
    s_mov_b32 s23, 0xe000
    buffer_load_dwordx4 v[40:43], v6, s[8:11], s23 offen offset:0 sc1
    v_mfma_f32_16x16x32_bf16 v[132:135], v[244:247], v[52:55], v[132:135]
    ds_read_b64_tr_b16 v[238:239], v8 offset:1056
    s_waitcnt lgkmcnt(6)
    v_mfma_f32_16x16x32_bf16 v[136:139], v[224:227], v[48:51], v[136:139]
    ds_read_b64_tr_b16 v[240:241], v7 offset:256
    v_mfma_f32_16x16x32_bf16 v[140:143], v[224:227], v[52:55], v[140:143]
    ds_read_b64_tr_b16 v[242:243], v7 offset:1280
    s_mov_b32 s23, 0x2e000
    buffer_load_dwordx4 v[44:47], v6, s[8:11], s23 offen offset:0 sc1
    s_waitcnt lgkmcnt(6)
    v_mfma_f32_16x16x32_bf16 v[144:147], v[228:231], v[48:51], v[144:147]
    ds_read_b64_tr_b16 v[244:245], v8 offset:288
    v_mfma_f32_16x16x32_bf16 v[148:151], v[228:231], v[52:55], v[148:151]
    ds_read_b64_tr_b16 v[246:247], v8 offset:1312
    s_waitcnt vmcnt(6)
    v_cmp_ne_u32 vcc, s28, v12
    s_cbranch_vccnz adaLN_cond__sliding_block_cached__moe_arch_mod__prompt_kernel_o218r
adaLN_cond__sliding_block_cached__moe_arch_mod__prompt_kernel_o218b:
    s_waitcnt lgkmcnt(6)
    v_mfma_f32_16x16x32_bf16 v[88:91], v[232:235], v[56:59], v[88:91]
    ds_read_b64_tr_b16 v[224:225], v7 offset:512
    v_mfma_f32_16x16x32_bf16 v[92:95], v[232:235], v[60:63], v[92:95]
    s_add_u32 s22, s24, 0x10000
    s_add_u32 m0, s20, 0x18000
    s_nop 0
    buffer_load_dwordx4 v3, s[4:7], s22 offen lds
    ds_read_b64_tr_b16 v[226:227], v7 offset:1536
    s_waitcnt lgkmcnt(6)
    v_mfma_f32_16x16x32_bf16 v[96:99], v[236:239], v[56:59], v[96:99]
    ds_read_b64_tr_b16 v[228:229], v8 offset:544
    v_mfma_f32_16x16x32_bf16 v[100:103], v[236:239], v[60:63], v[100:103]
    ds_read_b64_tr_b16 v[230:231], v8 offset:1568
    s_waitcnt lgkmcnt(6)
    v_mfma_f32_16x16x32_bf16 v[104:107], v[240:243], v[56:59], v[104:107]
    s_add_u32 s22, s24, 0x12000
    s_add_u32 m0, s20, 0x18400
    s_nop 0
    buffer_load_dwordx4 v3, s[4:7], s22 offen lds
    ds_read_b64_tr_b16 v[232:233], v7 offset:768
    v_mfma_f32_16x16x32_bf16 v[108:111], v[240:243], v[60:63], v[108:111]
    ds_read_b64_tr_b16 v[234:235], v7 offset:1792
    s_waitcnt lgkmcnt(6)
    v_mfma_f32_16x16x32_bf16 v[112:115], v[244:247], v[56:59], v[112:115]
    ds_read_b64_tr_b16 v[236:237], v8 offset:800
    v_mfma_f32_16x16x32_bf16 v[116:119], v[244:247], v[60:63], v[116:119]
    ds_read_b64_tr_b16 v[238:239], v8 offset:1824
    s_waitcnt lgkmcnt(6)
    v_mfma_f32_16x16x32_bf16 v[120:123], v[224:227], v[56:59], v[120:123]
    v_mfma_f32_16x16x32_bf16 v[124:127], v[224:227], v[60:63], v[124:127]
    s_barrier
    ds_read_b64_tr_b16 v[240:241], v7 offset:16384
    ds_read_b64_tr_b16 v[242:243], v7 offset:17408
    s_waitcnt lgkmcnt(6)
    v_mfma_f32_16x16x32_bf16 v[128:131], v[228:231], v[56:59], v[128:131]
    ds_read_b64_tr_b16 v[244:245], v8 offset:16416
    s_mov_b32 s23, 0x0
    buffer_load_dwordx4 v[48:51], v6, s[8:11], s23 offen offset:1024 sc1
    v_mfma_f32_16x16x32_bf16 v[132:135], v[228:231], v[60:63], v[132:135]
    ds_read_b64_tr_b16 v[246:247], v8 offset:17440
    s_waitcnt lgkmcnt(6)
    v_mfma_f32_16x16x32_bf16 v[136:139], v[232:235], v[56:59], v[136:139]
    ds_read_b64_tr_b16 v[224:225], v7 offset:16640
    v_mfma_f32_16x16x32_bf16 v[140:143], v[232:235], v[60:63], v[140:143]
    ds_read_b64_tr_b16 v[226:227], v7 offset:17664
    s_mov_b32 s23, 0x20000
    buffer_load_dwordx4 v[52:55], v6, s[8:11], s23 offen offset:1024 sc1
    s_waitcnt lgkmcnt(6)
    v_mfma_f32_16x16x32_bf16 v[144:147], v[236:239], v[56:59], v[144:147]
    ds_read_b64_tr_b16 v[228:229], v8 offset:16672
    v_mfma_f32_16x16x32_bf16 v[148:151], v[236:239], v[60:63], v[148:151]
    ds_read_b64_tr_b16 v[230:231], v8 offset:17696
    s_waitcnt lgkmcnt(6)
    v_mfma_f32_16x16x32_bf16 v[88:91], v[240:243], v[24:27], v[88:91]
    ds_read_b64_tr_b16 v[232:233], v7 offset:16896
    v_mfma_f32_16x16x32_bf16 v[92:95], v[240:243], v[28:31], v[92:95]
    s_add_u32 s22, s24, 0x90000
    s_add_u32 m0, s20, 0x1c000
    s_nop 0
    buffer_load_dwordx4 v3, s[4:7], s22 offen lds
    ds_read_b64_tr_b16 v[234:235], v7 offset:17920
    s_waitcnt lgkmcnt(6)
    v_mfma_f32_16x16x32_bf16 v[96:99], v[244:247], v[24:27], v[96:99]
    ds_read_b64_tr_b16 v[236:237], v8 offset:16928
    v_mfma_f32_16x16x32_bf16 v[100:103], v[244:247], v[28:31], v[100:103]
    ds_read_b64_tr_b16 v[238:239], v8 offset:17952
    s_waitcnt lgkmcnt(6)
    v_mfma_f32_16x16x32_bf16 v[104:107], v[224:227], v[24:27], v[104:107]
    s_add_u32 s22, s24, 0x92000
    s_add_u32 m0, s20, 0x1c400
    s_nop 0
    buffer_load_dwordx4 v3, s[4:7], s22 offen lds
    ds_read_b64_tr_b16 v[240:241], v7 offset:17152
    v_mfma_f32_16x16x32_bf16 v[108:111], v[224:227], v[28:31], v[108:111]
    ds_read_b64_tr_b16 v[242:243], v7 offset:18176
    s_waitcnt lgkmcnt(6)
    v_mfma_f32_16x16x32_bf16 v[112:115], v[228:231], v[24:27], v[112:115]
    ds_read_b64_tr_b16 v[244:245], v8 offset:17184
    v_mfma_f32_16x16x32_bf16 v[116:119], v[228:231], v[28:31], v[116:119]
    ds_read_b64_tr_b16 v[246:247], v8 offset:18208
    s_waitcnt lgkmcnt(6)
    v_mfma_f32_16x16x32_bf16 v[120:123], v[232:235], v[24:27], v[120:123]
    v_mfma_f32_16x16x32_bf16 v[124:127], v[232:235], v[28:31], v[124:127]
    s_barrier
    ds_read_b64_tr_b16 v[224:225], v4 offset:0
    ds_read_b64_tr_b16 v[226:227], v4 offset:1024
    s_waitcnt lgkmcnt(6)
    v_mfma_f32_16x16x32_bf16 v[128:131], v[236:239], v[24:27], v[128:131]
    s_add_u32 s16, s63, 0x576000
    v_mov_b32 v14, s28
    v_mov_b32 v15, 0
    s_mov_b64 exec, 1
    buffer_store_dword v14, v15, s[8:11], s16 offen sc1
    s_mov_b64 exec, -1
    ds_read_b64_tr_b16 v[228:229], v5 offset:32
    s_mov_b32 s23, 0x2000
    buffer_load_dwordx4 v[56:59], v6, s[8:11], s23 offen offset:1024 sc1
    v_mfma_f32_16x16x32_bf16 v[132:135], v[236:239], v[28:31], v[132:135]
    ds_read_b64_tr_b16 v[230:231], v5 offset:1056
    s_waitcnt lgkmcnt(6)
    v_mfma_f32_16x16x32_bf16 v[136:139], v[240:243], v[24:27], v[136:139]
    ds_read_b64_tr_b16 v[232:233], v4 offset:256
    v_mfma_f32_16x16x32_bf16 v[140:143], v[240:243], v[28:31], v[140:143]
    ds_read_b64_tr_b16 v[234:235], v4 offset:1280
    s_mov_b32 s23, 0x22000
    buffer_load_dwordx4 v[60:63], v6, s[8:11], s23 offen offset:1024 sc1
    s_waitcnt lgkmcnt(6)
    v_mfma_f32_16x16x32_bf16 v[144:147], v[244:247], v[24:27], v[144:147]
    ds_read_b64_tr_b16 v[236:237], v5 offset:288
    v_mfma_f32_16x16x32_bf16 v[148:151], v[244:247], v[28:31], v[148:151]
    ds_read_b64_tr_b16 v[238:239], v5 offset:1312
    s_waitcnt vmcnt(14) lgkmcnt(6)
    v_mfma_f32_16x16x32_bf16 v[88:91], v[224:227], v[32:35], v[88:91]
    ds_read_b64_tr_b16 v[240:241], v4 offset:512
    s_waitcnt vmcnt(13)
    v_mfma_f32_16x16x32_bf16 v[92:95], v[224:227], v[36:39], v[92:95]
    s_add_u32 s22, s24, 0x110000
    s_add_u32 m0, s20, 0x20000
    s_nop 0
    buffer_load_dwordx4 v3, s[4:7], s22 offen lds
    ds_read_b64_tr_b16 v[242:243], v4 offset:1536
    s_waitcnt lgkmcnt(6)
    v_mfma_f32_16x16x32_bf16 v[96:99], v[228:231], v[32:35], v[96:99]
    ds_read_b64_tr_b16 v[244:245], v5 offset:544
    v_mfma_f32_16x16x32_bf16 v[100:103], v[228:231], v[36:39], v[100:103]
    ds_read_b64_tr_b16 v[246:247], v5 offset:1568
    s_waitcnt lgkmcnt(6)
    v_mfma_f32_16x16x32_bf16 v[104:107], v[232:235], v[32:35], v[104:107]
    s_add_u32 s22, s24, 0x112000
    s_add_u32 m0, s20, 0x20400
    s_nop 0
    buffer_load_dwordx4 v3, s[4:7], s22 offen lds
    ds_read_b64_tr_b16 v[224:225], v4 offset:768
    v_mfma_f32_16x16x32_bf16 v[108:111], v[232:235], v[36:39], v[108:111]
    ds_read_b64_tr_b16 v[226:227], v4 offset:1792
    s_waitcnt lgkmcnt(6)
    v_mfma_f32_16x16x32_bf16 v[112:115], v[236:239], v[32:35], v[112:115]
    ds_read_b64_tr_b16 v[228:229], v5 offset:800
    v_mfma_f32_16x16x32_bf16 v[116:119], v[236:239], v[36:39], v[116:119]
    ds_read_b64_tr_b16 v[230:231], v5 offset:1824
    s_waitcnt lgkmcnt(6)
    v_mfma_f32_16x16x32_bf16 v[120:123], v[240:243], v[32:35], v[120:123]
    v_mfma_f32_16x16x32_bf16 v[124:127], v[240:243], v[36:39], v[124:127]
    s_waitcnt vmcnt(13)
    s_barrier
    ds_read_b64_tr_b16 v[232:233], v4 offset:16384
    ds_read_b64_tr_b16 v[234:235], v4 offset:17408
    s_waitcnt lgkmcnt(6)
    v_mfma_f32_16x16x32_bf16 v[128:131], v[244:247], v[32:35], v[128:131]
    ds_read_b64_tr_b16 v[236:237], v5 offset:16416
    s_mov_b32 s23, 0x4000
    buffer_load_dwordx4 v[24:27], v6, s[8:11], s23 offen offset:1024 sc1
    v_mfma_f32_16x16x32_bf16 v[132:135], v[244:247], v[36:39], v[132:135]
    ds_read_b64_tr_b16 v[238:239], v5 offset:17440
    s_waitcnt lgkmcnt(6)
    v_mfma_f32_16x16x32_bf16 v[136:139], v[224:227], v[32:35], v[136:139]
    ds_read_b64_tr_b16 v[240:241], v4 offset:16640
    v_mfma_f32_16x16x32_bf16 v[140:143], v[224:227], v[36:39], v[140:143]
    ds_read_b64_tr_b16 v[242:243], v4 offset:17664
    s_mov_b32 s23, 0x24000
    buffer_load_dwordx4 v[28:31], v6, s[8:11], s23 offen offset:1024 sc1
    s_waitcnt lgkmcnt(6)
    v_mfma_f32_16x16x32_bf16 v[144:147], v[228:231], v[32:35], v[144:147]
    ds_read_b64_tr_b16 v[244:245], v5 offset:16672
    v_mfma_f32_16x16x32_bf16 v[148:151], v[228:231], v[36:39], v[148:151]
    ds_read_b64_tr_b16 v[246:247], v5 offset:17696
    s_waitcnt vmcnt(14) lgkmcnt(6)
    v_mfma_f32_16x16x32_bf16 v[88:91], v[232:235], v[40:43], v[88:91]
    ds_read_b64_tr_b16 v[224:225], v4 offset:16896
    s_waitcnt vmcnt(13)
    v_mfma_f32_16x16x32_bf16 v[92:95], v[232:235], v[44:47], v[92:95]
    s_add_u32 s22, s24, 0x190000
    s_add_u32 m0, s20, 0x24000
    s_nop 0
    buffer_load_dwordx4 v3, s[4:7], s22 offen lds
    ds_read_b64_tr_b16 v[226:227], v4 offset:17920
    s_waitcnt lgkmcnt(6)
    v_mfma_f32_16x16x32_bf16 v[96:99], v[236:239], v[40:43], v[96:99]
    ds_read_b64_tr_b16 v[228:229], v5 offset:16928
    v_mfma_f32_16x16x32_bf16 v[100:103], v[236:239], v[44:47], v[100:103]
    ds_read_b64_tr_b16 v[230:231], v5 offset:17952
    s_waitcnt lgkmcnt(6)
    v_mfma_f32_16x16x32_bf16 v[104:107], v[240:243], v[40:43], v[104:107]
    s_add_u32 s22, s24, 0x192000
    s_add_u32 m0, s20, 0x24400
    s_nop 0
    buffer_load_dwordx4 v3, s[4:7], s22 offen lds
    ds_read_b64_tr_b16 v[232:233], v4 offset:17152
    v_mfma_f32_16x16x32_bf16 v[108:111], v[240:243], v[44:47], v[108:111]
    ds_read_b64_tr_b16 v[234:235], v4 offset:18176
    s_waitcnt lgkmcnt(6)
    v_mfma_f32_16x16x32_bf16 v[112:115], v[244:247], v[40:43], v[112:115]
    ds_read_b64_tr_b16 v[236:237], v5 offset:17184
    v_mfma_f32_16x16x32_bf16 v[116:119], v[244:247], v[44:47], v[116:119]
    ds_read_b64_tr_b16 v[238:239], v5 offset:18208
    s_waitcnt lgkmcnt(6)
    v_mfma_f32_16x16x32_bf16 v[120:123], v[224:227], v[40:43], v[120:123]
    v_mfma_f32_16x16x32_bf16 v[124:127], v[224:227], v[44:47], v[124:127]
    s_waitcnt vmcnt(13)
    s_barrier
    ds_read_b64_tr_b16 v[240:241], v4 offset:32768
    ds_read_b64_tr_b16 v[242:243], v4 offset:33792
    s_waitcnt lgkmcnt(6)
    v_mfma_f32_16x16x32_bf16 v[128:131], v[228:231], v[40:43], v[128:131]
    ds_read_b64_tr_b16 v[244:245], v5 offset:32800
    s_mov_b32 s23, 0x6000
    buffer_load_dwordx4 v[32:35], v6, s[8:11], s23 offen offset:1024 sc1
    v_mfma_f32_16x16x32_bf16 v[132:135], v[228:231], v[44:47], v[132:135]
    ds_read_b64_tr_b16 v[246:247], v5 offset:33824
    s_waitcnt lgkmcnt(6)
    v_mfma_f32_16x16x32_bf16 v[136:139], v[232:235], v[40:43], v[136:139]
    ds_read_b64_tr_b16 v[224:225], v4 offset:33024
    v_mfma_f32_16x16x32_bf16 v[140:143], v[232:235], v[44:47], v[140:143]
    ds_read_b64_tr_b16 v[226:227], v4 offset:34048
    s_mov_b32 s23, 0x26000
    buffer_load_dwordx4 v[36:39], v6, s[8:11], s23 offen offset:1024 sc1
    s_waitcnt lgkmcnt(6)
    v_mfma_f32_16x16x32_bf16 v[144:147], v[236:239], v[40:43], v[144:147]
    ds_read_b64_tr_b16 v[228:229], v5 offset:33056
    v_mfma_f32_16x16x32_bf16 v[148:151], v[236:239], v[44:47], v[148:151]
    ds_read_b64_tr_b16 v[230:231], v5 offset:34080
    s_waitcnt vmcnt(14) lgkmcnt(6)
    v_mfma_f32_16x16x32_bf16 v[88:91], v[240:243], v[48:51], v[88:91]
    ds_read_b64_tr_b16 v[232:233], v4 offset:33280
    s_waitcnt vmcnt(13)
    v_mfma_f32_16x16x32_bf16 v[92:95], v[240:243], v[52:55], v[92:95]
    s_add_u32 s22, s24, 0x210000
    s_add_u32 m0, s20, 0x10000
    s_nop 0
    buffer_load_dwordx4 v3, s[4:7], s22 offen lds
    ds_read_b64_tr_b16 v[234:235], v4 offset:34304
    s_waitcnt lgkmcnt(6)
    v_mfma_f32_16x16x32_bf16 v[96:99], v[244:247], v[48:51], v[96:99]
    ds_read_b64_tr_b16 v[236:237], v5 offset:33312
    v_mfma_f32_16x16x32_bf16 v[100:103], v[244:247], v[52:55], v[100:103]
    ds_read_b64_tr_b16 v[238:239], v5 offset:34336
    s_waitcnt lgkmcnt(6)
    v_mfma_f32_16x16x32_bf16 v[104:107], v[224:227], v[48:51], v[104:107]
    s_add_u32 s22, s24, 0x212000
    s_add_u32 m0, s20, 0x10400
    s_nop 0
    buffer_load_dwordx4 v3, s[4:7], s22 offen lds
    ds_read_b64_tr_b16 v[240:241], v4 offset:33536
    v_mfma_f32_16x16x32_bf16 v[108:111], v[224:227], v[52:55], v[108:111]
    ds_read_b64_tr_b16 v[242:243], v4 offset:34560
    s_waitcnt lgkmcnt(6)
    v_mfma_f32_16x16x32_bf16 v[112:115], v[228:231], v[48:51], v[112:115]
    ds_read_b64_tr_b16 v[244:245], v5 offset:33568
    v_mfma_f32_16x16x32_bf16 v[116:119], v[228:231], v[52:55], v[116:119]
    ds_read_b64_tr_b16 v[246:247], v5 offset:34592
    s_waitcnt lgkmcnt(6)
    v_mfma_f32_16x16x32_bf16 v[120:123], v[232:235], v[48:51], v[120:123]
    v_mfma_f32_16x16x32_bf16 v[124:127], v[232:235], v[52:55], v[124:127]
    s_waitcnt vmcnt(13)
    s_barrier
    ds_read_b64_tr_b16 v[224:225], v4 offset:49152
    ds_read_b64_tr_b16 v[226:227], v4 offset:50176
    s_waitcnt lgkmcnt(6)
    v_mfma_f32_16x16x32_bf16 v[128:131], v[236:239], v[48:51], v[128:131]
    ds_read_b64_tr_b16 v[228:229], v5 offset:49184
    s_mov_b32 s23, 0x8000
    buffer_load_dwordx4 v[40:43], v6, s[8:11], s23 offen offset:1024 sc1
    v_mfma_f32_16x16x32_bf16 v[132:135], v[236:239], v[52:55], v[132:135]
    ds_read_b64_tr_b16 v[230:231], v5 offset:50208
    s_waitcnt lgkmcnt(6)
    v_mfma_f32_16x16x32_bf16 v[136:139], v[240:243], v[48:51], v[136:139]
    ds_read_b64_tr_b16 v[232:233], v4 offset:49408
    v_mfma_f32_16x16x32_bf16 v[140:143], v[240:243], v[52:55], v[140:143]
    ds_read_b64_tr_b16 v[234:235], v4 offset:50432
    s_mov_b32 s23, 0x28000
    buffer_load_dwordx4 v[44:47], v6, s[8:11], s23 offen offset:1024 sc1
    s_waitcnt lgkmcnt(6)
    v_mfma_f32_16x16x32_bf16 v[144:147], v[244:247], v[48:51], v[144:147]
    ds_read_b64_tr_b16 v[236:237], v5 offset:49440
    v_mfma_f32_16x16x32_bf16 v[148:151], v[244:247], v[52:55], v[148:151]
    ds_read_b64_tr_b16 v[238:239], v5 offset:50464
    s_waitcnt vmcnt(13) lgkmcnt(6)
    v_mfma_f32_16x16x32_bf16 v[88:91], v[224:227], v[56:59], v[88:91]
    ds_read_b64_tr_b16 v[240:241], v4 offset:49664
    s_waitcnt vmcnt(12)
    v_mfma_f32_16x16x32_bf16 v[92:95], v[224:227], v[60:63], v[92:95]
    s_add_u32 s22, s24, 0x290000
    s_add_u32 m0, s20, 0x14000
    s_nop 0
    buffer_load_dwordx4 v3, s[4:7], s22 offen lds
    ds_read_b64_tr_b16 v[242:243], v4 offset:50688
    s_waitcnt lgkmcnt(6)
    v_mfma_f32_16x16x32_bf16 v[96:99], v[228:231], v[56:59], v[96:99]
    ds_read_b64_tr_b16 v[244:245], v5 offset:49696
    v_mfma_f32_16x16x32_bf16 v[100:103], v[228:231], v[60:63], v[100:103]
    ds_read_b64_tr_b16 v[246:247], v5 offset:50720
    s_waitcnt lgkmcnt(6)
    v_mfma_f32_16x16x32_bf16 v[104:107], v[232:235], v[56:59], v[104:107]
    s_add_u32 s22, s24, 0x292000
    s_add_u32 m0, s20, 0x14400
    s_nop 0
    buffer_load_dwordx4 v3, s[4:7], s22 offen lds
    ds_read_b64_tr_b16 v[224:225], v4 offset:49920
    v_mfma_f32_16x16x32_bf16 v[108:111], v[232:235], v[60:63], v[108:111]
    ds_read_b64_tr_b16 v[226:227], v4 offset:50944
    s_waitcnt lgkmcnt(6)
    v_mfma_f32_16x16x32_bf16 v[112:115], v[236:239], v[56:59], v[112:115]
    ds_read_b64_tr_b16 v[228:229], v5 offset:49952
    v_mfma_f32_16x16x32_bf16 v[116:119], v[236:239], v[60:63], v[116:119]
    ds_read_b64_tr_b16 v[230:231], v5 offset:50976
    s_waitcnt lgkmcnt(6)
    v_mfma_f32_16x16x32_bf16 v[120:123], v[240:243], v[56:59], v[120:123]
    v_mfma_f32_16x16x32_bf16 v[124:127], v[240:243], v[60:63], v[124:127]
    s_waitcnt vmcnt(12)
    s_barrier
    ds_read_b64_tr_b16 v[232:233], v7 offset:0
    ds_read_b64_tr_b16 v[234:235], v7 offset:1024
    s_waitcnt lgkmcnt(6)
    v_mfma_f32_16x16x32_bf16 v[128:131], v[244:247], v[56:59], v[128:131]
    ds_read_b64_tr_b16 v[236:237], v8 offset:32
    s_mov_b32 s23, 0xa000
    buffer_load_dwordx4 v[48:51], v6, s[8:11], s23 offen offset:1024 sc1
    v_mfma_f32_16x16x32_bf16 v[132:135], v[244:247], v[60:63], v[132:135]
    ds_read_b64_tr_b16 v[238:239], v8 offset:1056
    s_waitcnt lgkmcnt(6)
    v_mfma_f32_16x16x32_bf16 v[136:139], v[224:227], v[56:59], v[136:139]
    ds_read_b64_tr_b16 v[240:241], v7 offset:256
    v_mfma_f32_16x16x32_bf16 v[140:143], v[224:227], v[60:63], v[140:143]
    ds_read_b64_tr_b16 v[242:243], v7 offset:1280
    s_mov_b32 s23, 0x2a000
    buffer_load_dwordx4 v[52:55], v6, s[8:11], s23 offen offset:1024 sc1
    s_waitcnt lgkmcnt(6)
    v_mfma_f32_16x16x32_bf16 v[144:147], v[228:231], v[56:59], v[144:147]
    ds_read_b64_tr_b16 v[244:245], v8 offset:288
    v_mfma_f32_16x16x32_bf16 v[148:151], v[228:231], v[60:63], v[148:151]
    ds_read_b64_tr_b16 v[246:247], v8 offset:1312
    s_waitcnt vmcnt(13) lgkmcnt(6)
    v_mfma_f32_16x16x32_bf16 v[88:91], v[232:235], v[24:27], v[88:91]
    ds_read_b64_tr_b16 v[224:225], v7 offset:512
    s_waitcnt vmcnt(12)
    v_mfma_f32_16x16x32_bf16 v[92:95], v[232:235], v[28:31], v[92:95]
    s_add_u32 s22, s24, 0x310000
    s_add_u32 m0, s20, 0x18000
    s_nop 0
    buffer_load_dwordx4 v3, s[4:7], s22 offen lds
    ds_read_b64_tr_b16 v[226:227], v7 offset:1536
    s_waitcnt lgkmcnt(6)
    v_mfma_f32_16x16x32_bf16 v[96:99], v[236:239], v[24:27], v[96:99]
    ds_read_b64_tr_b16 v[228:229], v8 offset:544
    v_mfma_f32_16x16x32_bf16 v[100:103], v[236:239], v[28:31], v[100:103]
    ds_read_b64_tr_b16 v[230:231], v8 offset:1568
    s_waitcnt lgkmcnt(6)
    v_mfma_f32_16x16x32_bf16 v[104:107], v[240:243], v[24:27], v[104:107]
    s_add_u32 s22, s24, 0x312000
    s_add_u32 m0, s20, 0x18400
    s_nop 0
    buffer_load_dwordx4 v3, s[4:7], s22 offen lds
    ds_read_b64_tr_b16 v[232:233], v7 offset:768
    v_mfma_f32_16x16x32_bf16 v[108:111], v[240:243], v[28:31], v[108:111]
    ds_read_b64_tr_b16 v[234:235], v7 offset:1792
    s_waitcnt lgkmcnt(6)
    v_mfma_f32_16x16x32_bf16 v[112:115], v[244:247], v[24:27], v[112:115]
    ds_read_b64_tr_b16 v[236:237], v8 offset:800
    v_mfma_f32_16x16x32_bf16 v[116:119], v[244:247], v[28:31], v[116:119]
    ds_read_b64_tr_b16 v[238:239], v8 offset:1824
    s_waitcnt lgkmcnt(6)
    v_mfma_f32_16x16x32_bf16 v[120:123], v[224:227], v[24:27], v[120:123]
    v_mfma_f32_16x16x32_bf16 v[124:127], v[224:227], v[28:31], v[124:127]
    s_waitcnt vmcnt(12)
    s_barrier
    ds_read_b64_tr_b16 v[240:241], v7 offset:16384
    ds_read_b64_tr_b16 v[242:243], v7 offset:17408
    s_add_u32 s19, s19, 8192
    buffer_load_dword v12, v13, s[8:11], s19 offen sc1
    s_waitcnt lgkmcnt(6)
    v_mfma_f32_16x16x32_bf16 v[128:131], v[228:231], v[24:27], v[128:131]
    ds_read_b64_tr_b16 v[244:245], v8 offset:16416
    s_mov_b32 s23, 0xc000
    buffer_load_dwordx4 v[56:59], v6, s[8:11], s23 offen offset:1024 sc1
    v_mfma_f32_16x16x32_bf16 v[132:135], v[228:231], v[28:31], v[132:135]
    ds_read_b64_tr_b16 v[246:247], v8 offset:17440
    s_waitcnt lgkmcnt(6)
    v_mfma_f32_16x16x32_bf16 v[136:139], v[232:235], v[24:27], v[136:139]
    ds_read_b64_tr_b16 v[224:225], v7 offset:16640
    v_mfma_f32_16x16x32_bf16 v[140:143], v[232:235], v[28:31], v[140:143]
    ds_read_b64_tr_b16 v[226:227], v7 offset:17664
    s_mov_b32 s23, 0x2c000
    buffer_load_dwordx4 v[60:63], v6, s[8:11], s23 offen offset:1024 sc1
    s_waitcnt lgkmcnt(6)
    v_mfma_f32_16x16x32_bf16 v[144:147], v[236:239], v[24:27], v[144:147]
    ds_read_b64_tr_b16 v[228:229], v8 offset:16672
    v_mfma_f32_16x16x32_bf16 v[148:151], v[236:239], v[28:31], v[148:151]
    ds_read_b64_tr_b16 v[230:231], v8 offset:17696
    s_waitcnt vmcnt(14) lgkmcnt(6)
    v_mfma_f32_16x16x32_bf16 v[88:91], v[240:243], v[32:35], v[88:91]
    ds_read_b64_tr_b16 v[232:233], v7 offset:16896
    s_waitcnt vmcnt(13)
    v_mfma_f32_16x16x32_bf16 v[92:95], v[240:243], v[36:39], v[92:95]
    s_add_u32 s22, s24, 0x390000
    s_add_u32 m0, s20, 0x1c000
    s_nop 0
    buffer_load_dwordx4 v3, s[4:7], s22 offen lds
    ds_read_b64_tr_b16 v[234:235], v7 offset:17920
    s_waitcnt lgkmcnt(6)
    v_mfma_f32_16x16x32_bf16 v[96:99], v[244:247], v[32:35], v[96:99]
    ds_read_b64_tr_b16 v[236:237], v8 offset:16928
    v_mfma_f32_16x16x32_bf16 v[100:103], v[244:247], v[36:39], v[100:103]
    ds_read_b64_tr_b16 v[238:239], v8 offset:17952
    s_waitcnt lgkmcnt(6)
    v_mfma_f32_16x16x32_bf16 v[104:107], v[224:227], v[32:35], v[104:107]
    s_add_u32 s22, s24, 0x392000
    s_add_u32 m0, s20, 0x1c400
    s_nop 0
    buffer_load_dwordx4 v3, s[4:7], s22 offen lds
    ds_read_b64_tr_b16 v[240:241], v7 offset:17152
    v_mfma_f32_16x16x32_bf16 v[108:111], v[224:227], v[36:39], v[108:111]
    ds_read_b64_tr_b16 v[242:243], v7 offset:18176
    s_waitcnt lgkmcnt(6)
    v_mfma_f32_16x16x32_bf16 v[112:115], v[228:231], v[32:35], v[112:115]
    ds_read_b64_tr_b16 v[244:245], v8 offset:17184
    v_mfma_f32_16x16x32_bf16 v[116:119], v[228:231], v[36:39], v[116:119]
    ds_read_b64_tr_b16 v[246:247], v8 offset:18208
    s_waitcnt lgkmcnt(6)
    v_mfma_f32_16x16x32_bf16 v[120:123], v[232:235], v[32:35], v[120:123]
    v_mfma_f32_16x16x32_bf16 v[124:127], v[232:235], v[36:39], v[124:127]
    s_waitcnt vmcnt(13)
    s_barrier
    ds_read_b64_tr_b16 v[224:225], v4 offset:0
    ds_read_b64_tr_b16 v[226:227], v4 offset:1024
    s_waitcnt lgkmcnt(6)
    v_mfma_f32_16x16x32_bf16 v[128:131], v[236:239], v[32:35], v[128:131]
    ds_read_b64_tr_b16 v[228:229], v5 offset:32
    s_mov_b32 s23, 0xe000
    buffer_load_dwordx4 v[24:27], v6, s[8:11], s23 offen offset:1024 sc1
    v_mfma_f32_16x16x32_bf16 v[132:135], v[236:239], v[36:39], v[132:135]
    ds_read_b64_tr_b16 v[230:231], v5 offset:1056
    s_waitcnt lgkmcnt(6)
    v_mfma_f32_16x16x32_bf16 v[136:139], v[240:243], v[32:35], v[136:139]
    ds_read_b64_tr_b16 v[232:233], v4 offset:256
    v_mfma_f32_16x16x32_bf16 v[140:143], v[240:243], v[36:39], v[140:143]
    ds_read_b64_tr_b16 v[234:235], v4 offset:1280
    s_mov_b32 s23, 0x2e000
    buffer_load_dwordx4 v[28:31], v6, s[8:11], s23 offen offset:1024 sc1
    s_waitcnt lgkmcnt(6)
    v_mfma_f32_16x16x32_bf16 v[144:147], v[244:247], v[32:35], v[144:147]
    ds_read_b64_tr_b16 v[236:237], v5 offset:288
    v_mfma_f32_16x16x32_bf16 v[148:151], v[244:247], v[36:39], v[148:151]
    ds_read_b64_tr_b16 v[238:239], v5 offset:1312
    s_waitcnt vmcnt(6)
    v_cmp_ne_u32 vcc, s28, v12
    s_cbranch_vccnz adaLN_cond__sliding_block_cached__moe_arch_mod__prompt_kernel_o219r
adaLN_cond__sliding_block_cached__moe_arch_mod__prompt_kernel_o219b:
    s_waitcnt lgkmcnt(6)
    v_mfma_f32_16x16x32_bf16 v[88:91], v[224:227], v[40:43], v[88:91]
    ds_read_b64_tr_b16 v[240:241], v4 offset:512
    v_mfma_f32_16x16x32_bf16 v[92:95], v[224:227], v[44:47], v[92:95]
    s_add_u32 s22, s24, 0x20000
    s_add_u32 m0, s20, 0x20000
    s_nop 0
    buffer_load_dwordx4 v3, s[4:7], s22 offen lds
    ds_read_b64_tr_b16 v[242:243], v4 offset:1536
    s_waitcnt lgkmcnt(6)
    v_mfma_f32_16x16x32_bf16 v[96:99], v[228:231], v[40:43], v[96:99]
    ds_read_b64_tr_b16 v[244:245], v5 offset:544
    v_mfma_f32_16x16x32_bf16 v[100:103], v[228:231], v[44:47], v[100:103]
    ds_read_b64_tr_b16 v[246:247], v5 offset:1568
    s_waitcnt lgkmcnt(6)
    v_mfma_f32_16x16x32_bf16 v[104:107], v[232:235], v[40:43], v[104:107]
    s_add_u32 s22, s24, 0x22000
    s_add_u32 m0, s20, 0x20400
    s_nop 0
    buffer_load_dwordx4 v3, s[4:7], s22 offen lds
    ds_read_b64_tr_b16 v[224:225], v4 offset:768
    v_mfma_f32_16x16x32_bf16 v[108:111], v[232:235], v[44:47], v[108:111]
    ds_read_b64_tr_b16 v[226:227], v4 offset:1792
    s_waitcnt lgkmcnt(6)
    v_mfma_f32_16x16x32_bf16 v[112:115], v[236:239], v[40:43], v[112:115]
    ds_read_b64_tr_b16 v[228:229], v5 offset:800
    v_mfma_f32_16x16x32_bf16 v[116:119], v[236:239], v[44:47], v[116:119]
    ds_read_b64_tr_b16 v[230:231], v5 offset:1824
    s_waitcnt lgkmcnt(6)
    v_mfma_f32_16x16x32_bf16 v[120:123], v[240:243], v[40:43], v[120:123]
    v_mfma_f32_16x16x32_bf16 v[124:127], v[240:243], v[44:47], v[124:127]
    s_barrier
    ds_read_b64_tr_b16 v[232:233], v4 offset:16384
    ds_read_b64_tr_b16 v[234:235], v4 offset:17408
    s_waitcnt lgkmcnt(6)
    v_mfma_f32_16x16x32_bf16 v[128:131], v[244:247], v[40:43], v[128:131]
    ds_read_b64_tr_b16 v[236:237], v5 offset:16416
    s_mov_b32 s23, 0x0
    buffer_load_dwordx4 v[32:35], v6, s[8:11], s23 offen offset:2048 sc1
    v_mfma_f32_16x16x32_bf16 v[132:135], v[244:247], v[44:47], v[132:135]
    ds_read_b64_tr_b16 v[238:239], v5 offset:17440
    s_waitcnt lgkmcnt(6)
    v_mfma_f32_16x16x32_bf16 v[136:139], v[224:227], v[40:43], v[136:139]
    ds_read_b64_tr_b16 v[240:241], v4 offset:16640
    v_mfma_f32_16x16x32_bf16 v[140:143], v[224:227], v[44:47], v[140:143]
    ds_read_b64_tr_b16 v[242:243], v4 offset:17664
    s_mov_b32 s23, 0x20000
    buffer_load_dwordx4 v[36:39], v6, s[8:11], s23 offen offset:2048 sc1
    s_waitcnt lgkmcnt(6)
    v_mfma_f32_16x16x32_bf16 v[144:147], v[228:231], v[40:43], v[144:147]
    ds_read_b64_tr_b16 v[244:245], v5 offset:16672
    v_mfma_f32_16x16x32_bf16 v[148:151], v[228:231], v[44:47], v[148:151]
    ds_read_b64_tr_b16 v[246:247], v5 offset:17696
    s_waitcnt lgkmcnt(6)
    v_mfma_f32_16x16x32_bf16 v[88:91], v[232:235], v[48:51], v[88:91]
    ds_read_b64_tr_b16 v[224:225], v4 offset:16896
    v_mfma_f32_16x16x32_bf16 v[92:95], v[232:235], v[52:55], v[92:95]
    s_add_u32 s22, s24, 0xa0000
    s_add_u32 m0, s20, 0x24000
    s_nop 0
    buffer_load_dwordx4 v3, s[4:7], s22 offen lds
    ds_read_b64_tr_b16 v[226:227], v4 offset:17920
    s_waitcnt lgkmcnt(6)
    v_mfma_f32_16x16x32_bf16 v[96:99], v[236:239], v[48:51], v[96:99]
    ds_read_b64_tr_b16 v[228:229], v5 offset:16928
    v_mfma_f32_16x16x32_bf16 v[100:103], v[236:239], v[52:55], v[100:103]
    ds_read_b64_tr_b16 v[230:231], v5 offset:17952
    s_waitcnt lgkmcnt(6)
    v_mfma_f32_16x16x32_bf16 v[104:107], v[240:243], v[48:51], v[104:107]
    s_add_u32 s22, s24, 0xa2000
    s_add_u32 m0, s20, 0x24400
    s_nop 0
    buffer_load_dwordx4 v3, s[4:7], s22 offen lds
    ds_read_b64_tr_b16 v[232:233], v4 offset:17152
    v_mfma_f32_16x16x32_bf16 v[108:111], v[240:243], v[52:55], v[108:111]
    ds_read_b64_tr_b16 v[234:235], v4 offset:18176
    s_waitcnt lgkmcnt(6)
    v_mfma_f32_16x16x32_bf16 v[112:115], v[244:247], v[48:51], v[112:115]
    ds_read_b64_tr_b16 v[236:237], v5 offset:17184
    v_mfma_f32_16x16x32_bf16 v[116:119], v[244:247], v[52:55], v[116:119]
    ds_read_b64_tr_b16 v[238:239], v5 offset:18208
    s_waitcnt lgkmcnt(6)
    v_mfma_f32_16x16x32_bf16 v[120:123], v[224:227], v[48:51], v[120:123]
    v_mfma_f32_16x16x32_bf16 v[124:127], v[224:227], v[52:55], v[124:127]
    s_barrier
    ds_read_b64_tr_b16 v[240:241], v4 offset:32768
    ds_read_b64_tr_b16 v[242:243], v4 offset:33792
    s_waitcnt lgkmcnt(6)
    v_mfma_f32_16x16x32_bf16 v[128:131], v[228:231], v[48:51], v[128:131]
    ds_read_b64_tr_b16 v[244:245], v5 offset:32800
    s_mov_b32 s23, 0x2000
    buffer_load_dwordx4 v[40:43], v6, s[8:11], s23 offen offset:2048 sc1
    v_mfma_f32_16x16x32_bf16 v[132:135], v[228:231], v[52:55], v[132:135]
    ds_read_b64_tr_b16 v[246:247], v5 offset:33824
    s_waitcnt lgkmcnt(6)
    v_mfma_f32_16x16x32_bf16 v[136:139], v[232:235], v[48:51], v[136:139]
    ds_read_b64_tr_b16 v[224:225], v4 offset:33024
    v_mfma_f32_16x16x32_bf16 v[140:143], v[232:235], v[52:55], v[140:143]
    ds_read_b64_tr_b16 v[226:227], v4 offset:34048
    s_mov_b32 s23, 0x22000
    buffer_load_dwordx4 v[44:47], v6, s[8:11], s23 offen offset:2048 sc1
    s_waitcnt lgkmcnt(6)
    v_mfma_f32_16x16x32_bf16 v[144:147], v[236:239], v[48:51], v[144:147]
    ds_read_b64_tr_b16 v[228:229], v5 offset:33056
    v_mfma_f32_16x16x32_bf16 v[148:151], v[236:239], v[52:55], v[148:151]
    ds_read_b64_tr_b16 v[230:231], v5 offset:34080
    s_waitcnt vmcnt(13) lgkmcnt(6)
    v_mfma_f32_16x16x32_bf16 v[88:91], v[240:243], v[56:59], v[88:91]
    ds_read_b64_tr_b16 v[232:233], v4 offset:33280
    s_waitcnt vmcnt(12)
    v_mfma_f32_16x16x32_bf16 v[92:95], v[240:243], v[60:63], v[92:95]
    s_add_u32 s22, s24, 0x120000
    s_add_u32 m0, s20, 0x10000
    s_nop 0
    buffer_load_dwordx4 v3, s[4:7], s22 offen lds
    ds_read_b64_tr_b16 v[234:235], v4 offset:34304
    s_waitcnt lgkmcnt(6)
    v_mfma_f32_16x16x32_bf16 v[96:99], v[244:247], v[56:59], v[96:99]
    ds_read_b64_tr_b16 v[236:237], v5 offset:33312
    v_mfma_f32_16x16x32_bf16 v[100:103], v[244:247], v[60:63], v[100:103]
    ds_read_b64_tr_b16 v[238:239], v5 offset:34336
    s_waitcnt lgkmcnt(6)
    v_mfma_f32_16x16x32_bf16 v[104:107], v[224:227], v[56:59], v[104:107]
    s_add_u32 s22, s24, 0x122000
    s_add_u32 m0, s20, 0x10400
    s_nop 0
    buffer_load_dwordx4 v3, s[4:7], s22 offen lds
    ds_read_b64_tr_b16 v[240:241], v4 offset:33536
    v_mfma_f32_16x16x32_bf16 v[108:111], v[224:227], v[60:63], v[108:111]
    ds_read_b64_tr_b16 v[242:243], v4 offset:34560
    s_waitcnt lgkmcnt(6)
    v_mfma_f32_16x16x32_bf16 v[112:115], v[228:231], v[56:59], v[112:115]
    ds_read_b64_tr_b16 v[244:245], v5 offset:33568
    v_mfma_f32_16x16x32_bf16 v[116:119], v[228:231], v[60:63], v[116:119]
    ds_read_b64_tr_b16 v[246:247], v5 offset:34592
    s_waitcnt lgkmcnt(6)
    v_mfma_f32_16x16x32_bf16 v[120:123], v[232:235], v[56:59], v[120:123]
    v_mfma_f32_16x16x32_bf16 v[124:127], v[232:235], v[60:63], v[124:127]
    s_waitcnt vmcnt(12)
    s_barrier
    ds_read_b64_tr_b16 v[224:225], v4 offset:49152
    ds_read_b64_tr_b16 v[226:227], v4 offset:50176
    s_waitcnt lgkmcnt(6)
    v_mfma_f32_16x16x32_bf16 v[128:131], v[236:239], v[56:59], v[128:131]
    ds_read_b64_tr_b16 v[228:229], v5 offset:49184
    s_mov_b32 s23, 0x4000
    buffer_load_dwordx4 v[48:51], v6, s[8:11], s23 offen offset:2048 sc1
    v_mfma_f32_16x16x32_bf16 v[132:135], v[236:239], v[60:63], v[132:135]
    ds_read_b64_tr_b16 v[230:231], v5 offset:50208
    s_waitcnt lgkmcnt(6)
    v_mfma_f32_16x16x32_bf16 v[136:139], v[240:243], v[56:59], v[136:139]
    ds_read_b64_tr_b16 v[232:233], v4 offset:49408
    v_mfma_f32_16x16x32_bf16 v[140:143], v[240:243], v[60:63], v[140:143]
    ds_read_b64_tr_b16 v[234:235], v4 offset:50432
    s_mov_b32 s23, 0x24000
    buffer_load_dwordx4 v[52:55], v6, s[8:11], s23 offen offset:2048 sc1
    s_waitcnt lgkmcnt(6)
    v_mfma_f32_16x16x32_bf16 v[144:147], v[244:247], v[56:59], v[144:147]
    ds_read_b64_tr_b16 v[236:237], v5 offset:49440
    v_mfma_f32_16x16x32_bf16 v[148:151], v[244:247], v[60:63], v[148:151]
    ds_read_b64_tr_b16 v[238:239], v5 offset:50464
    s_waitcnt vmcnt(13) lgkmcnt(6)
    v_mfma_f32_16x16x32_bf16 v[88:91], v[224:227], v[24:27], v[88:91]
    ds_read_b64_tr_b16 v[240:241], v4 offset:49664
    s_waitcnt vmcnt(12)
    v_mfma_f32_16x16x32_bf16 v[92:95], v[224:227], v[28:31], v[92:95]
    s_add_u32 s22, s24, 0x1a0000
    s_add_u32 m0, s20, 0x14000
    s_nop 0
    buffer_load_dwordx4 v3, s[4:7], s22 offen lds
    ds_read_b64_tr_b16 v[242:243], v4 offset:50688
    s_waitcnt lgkmcnt(6)
    v_mfma_f32_16x16x32_bf16 v[96:99], v[228:231], v[24:27], v[96:99]
    ds_read_b64_tr_b16 v[244:245], v5 offset:49696
    v_mfma_f32_16x16x32_bf16 v[100:103], v[228:231], v[28:31], v[100:103]
    ds_read_b64_tr_b16 v[246:247], v5 offset:50720
    s_waitcnt lgkmcnt(6)
    v_mfma_f32_16x16x32_bf16 v[104:107], v[232:235], v[24:27], v[104:107]
    s_add_u32 s22, s24, 0x1a2000
    s_add_u32 m0, s20, 0x14400
    s_nop 0
    buffer_load_dwordx4 v3, s[4:7], s22 offen lds
    ds_read_b64_tr_b16 v[224:225], v4 offset:49920
    v_mfma_f32_16x16x32_bf16 v[108:111], v[232:235], v[28:31], v[108:111]
    ds_read_b64_tr_b16 v[226:227], v4 offset:50944
    s_waitcnt lgkmcnt(6)
    v_mfma_f32_16x16x32_bf16 v[112:115], v[236:239], v[24:27], v[112:115]
    ds_read_b64_tr_b16 v[228:229], v5 offset:49952
    v_mfma_f32_16x16x32_bf16 v[116:119], v[236:239], v[28:31], v[116:119]
    ds_read_b64_tr_b16 v[230:231], v5 offset:50976
    s_waitcnt lgkmcnt(6)
    v_mfma_f32_16x16x32_bf16 v[120:123], v[240:243], v[24:27], v[120:123]
    v_mfma_f32_16x16x32_bf16 v[124:127], v[240:243], v[28:31], v[124:127]
    s_waitcnt vmcnt(12)
    s_barrier
    ds_read_b64_tr_b16 v[232:233], v7 offset:0
    ds_read_b64_tr_b16 v[234:235], v7 offset:1024
    s_waitcnt lgkmcnt(6)
    v_mfma_f32_16x16x32_bf16 v[128:131], v[244:247], v[24:27], v[128:131]
    ds_read_b64_tr_b16 v[236:237], v8 offset:32
    s_mov_b32 s23, 0x6000
    buffer_load_dwordx4 v[56:59], v6, s[8:11], s23 offen offset:2048 sc1
    v_mfma_f32_16x16x32_bf16 v[132:135], v[244:247], v[28:31], v[132:135]
    ds_read_b64_tr_b16 v[238:239], v8 offset:1056
    s_waitcnt lgkmcnt(6)
    v_mfma_f32_16x16x32_bf16 v[136:139], v[224:227], v[24:27], v[136:139]
    ds_read_b64_tr_b16 v[240:241], v7 offset:256
    v_mfma_f32_16x16x32_bf16 v[140:143], v[224:227], v[28:31], v[140:143]
    ds_read_b64_tr_b16 v[242:243], v7 offset:1280
    s_mov_b32 s23, 0x26000
    buffer_load_dwordx4 v[60:63], v6, s[8:11], s23 offen offset:2048 sc1
    s_waitcnt lgkmcnt(6)
    v_mfma_f32_16x16x32_bf16 v[144:147], v[228:231], v[24:27], v[144:147]
    ds_read_b64_tr_b16 v[244:245], v8 offset:288
    v_mfma_f32_16x16x32_bf16 v[148:151], v[228:231], v[28:31], v[148:151]
    ds_read_b64_tr_b16 v[246:247], v8 offset:1312
    s_waitcnt vmcnt(13) lgkmcnt(6)
    v_mfma_f32_16x16x32_bf16 v[88:91], v[232:235], v[32:35], v[88:91]
    ds_read_b64_tr_b16 v[224:225], v7 offset:512
    s_waitcnt vmcnt(12)
    v_mfma_f32_16x16x32_bf16 v[92:95], v[232:235], v[36:39], v[92:95]
    s_add_u32 s22, s24, 0x220000
    s_add_u32 m0, s20, 0x18000
    s_nop 0
    buffer_load_dwordx4 v3, s[4:7], s22 offen lds
    ds_read_b64_tr_b16 v[226:227], v7 offset:1536
    s_waitcnt lgkmcnt(6)
    v_mfma_f32_16x16x32_bf16 v[96:99], v[236:239], v[32:35], v[96:99]
    ds_read_b64_tr_b16 v[228:229], v8 offset:544
    v_mfma_f32_16x16x32_bf16 v[100:103], v[236:239], v[36:39], v[100:103]
    ds_read_b64_tr_b16 v[230:231], v8 offset:1568
    s_waitcnt lgkmcnt(6)
    v_mfma_f32_16x16x32_bf16 v[104:107], v[240:243], v[32:35], v[104:107]
    s_add_u32 s22, s24, 0x222000
    s_add_u32 m0, s20, 0x18400
    s_nop 0
    buffer_load_dwordx4 v3, s[4:7], s22 offen lds
    ds_read_b64_tr_b16 v[232:233], v7 offset:768
    v_mfma_f32_16x16x32_bf16 v[108:111], v[240:243], v[36:39], v[108:111]
    ds_read_b64_tr_b16 v[234:235], v7 offset:1792
    s_mov_b32 s16, 0x544000
    buffer_load_dwordx4 v[184:187], v2, s[8:11], s16 offen sc1
    s_waitcnt lgkmcnt(6)
    v_mfma_f32_16x16x32_bf16 v[112:115], v[244:247], v[32:35], v[112:115]
    ds_read_b64_tr_b16 v[236:237], v8 offset:800
    v_mfma_f32_16x16x32_bf16 v[116:119], v[244:247], v[36:39], v[116:119]
    ds_read_b64_tr_b16 v[238:239], v8 offset:1824
    s_waitcnt lgkmcnt(6)
    v_mfma_f32_16x16x32_bf16 v[120:123], v[224:227], v[32:35], v[120:123]
    v_mfma_f32_16x16x32_bf16 v[124:127], v[224:227], v[36:39], v[124:127]
    s_waitcnt vmcnt(13)
    s_barrier
    ds_read_b64_tr_b16 v[240:241], v7 offset:16384
    ds_read_b64_tr_b16 v[242:243], v7 offset:17408
    s_waitcnt lgkmcnt(6)
    v_mfma_f32_16x16x32_bf16 v[128:131], v[228:231], v[32:35], v[128:131]
    ds_read_b64_tr_b16 v[244:245], v8 offset:16416
    s_mov_b32 s23, 0x8000
    buffer_load_dwordx4 v[24:27], v6, s[8:11], s23 offen offset:2048 sc1
    v_mfma_f32_16x16x32_bf16 v[132:135], v[228:231], v[36:39], v[132:135]
    ds_read_b64_tr_b16 v[246:247], v8 offset:17440
    s_waitcnt lgkmcnt(6)
    v_mfma_f32_16x16x32_bf16 v[136:139], v[232:235], v[32:35], v[136:139]
    ds_read_b64_tr_b16 v[224:225], v7 offset:16640
    v_mfma_f32_16x16x32_bf16 v[140:143], v[232:235], v[36:39], v[140:143]
    ds_read_b64_tr_b16 v[226:227], v7 offset:17664
    s_mov_b32 s23, 0x28000
    buffer_load_dwordx4 v[28:31], v6, s[8:11], s23 offen offset:2048 sc1
    s_waitcnt lgkmcnt(6)
    v_mfma_f32_16x16x32_bf16 v[144:147], v[236:239], v[32:35], v[144:147]
    ds_read_b64_tr_b16 v[228:229], v8 offset:16672
    v_mfma_f32_16x16x32_bf16 v[148:151], v[236:239], v[36:39], v[148:151]
    ds_read_b64_tr_b16 v[230:231], v8 offset:17696
    s_waitcnt vmcnt(14) lgkmcnt(6)
    v_mfma_f32_16x16x32_bf16 v[88:91], v[240:243], v[40:43], v[88:91]
    ds_read_b64_tr_b16 v[232:233], v7 offset:16896
    s_waitcnt vmcnt(13)
    v_mfma_f32_16x16x32_bf16 v[92:95], v[240:243], v[44:47], v[92:95]
    s_add_u32 s22, s24, 0x2a0000
    s_add_u32 m0, s20, 0x1c000
    s_nop 0
    buffer_load_dwordx4 v3, s[4:7], s22 offen lds
    ds_read_b64_tr_b16 v[234:235], v7 offset:17920
    s_waitcnt lgkmcnt(6)
    v_mfma_f32_16x16x32_bf16 v[96:99], v[244:247], v[40:43], v[96:99]
    ds_read_b64_tr_b16 v[236:237], v8 offset:16928
    v_mfma_f32_16x16x32_bf16 v[100:103], v[244:247], v[44:47], v[100:103]
    ds_read_b64_tr_b16 v[238:239], v8 offset:17952
    s_waitcnt lgkmcnt(6)
    v_mfma_f32_16x16x32_bf16 v[104:107], v[224:227], v[40:43], v[104:107]
    s_add_u32 s22, s24, 0x2a2000
    s_add_u32 m0, s20, 0x1c400
    s_nop 0
    buffer_load_dwordx4 v3, s[4:7], s22 offen lds
    ds_read_b64_tr_b16 v[240:241], v7 offset:17152
    v_mfma_f32_16x16x32_bf16 v[108:111], v[224:227], v[44:47], v[108:111]
    ds_read_b64_tr_b16 v[242:243], v7 offset:18176
    s_waitcnt lgkmcnt(6)
    v_mfma_f32_16x16x32_bf16 v[112:115], v[228:231], v[40:43], v[112:115]
    ds_read_b64_tr_b16 v[244:245], v8 offset:17184
    v_mfma_f32_16x16x32_bf16 v[116:119], v[228:231], v[44:47], v[116:119]
    ds_read_b64_tr_b16 v[246:247], v8 offset:18208
    s_waitcnt lgkmcnt(6)
    v_mfma_f32_16x16x32_bf16 v[120:123], v[232:235], v[40:43], v[120:123]
    v_mfma_f32_16x16x32_bf16 v[124:127], v[232:235], v[44:47], v[124:127]
    s_waitcnt vmcnt(13)
    s_barrier
    ds_read_b64_tr_b16 v[224:225], v4 offset:0
    ds_read_b64_tr_b16 v[226:227], v4 offset:1024
    s_waitcnt lgkmcnt(6)
    v_mfma_f32_16x16x32_bf16 v[128:131], v[236:239], v[40:43], v[128:131]
    ds_read_b64_tr_b16 v[228:229], v5 offset:32
    s_mov_b32 s23, 0xa000
    buffer_load_dwordx4 v[32:35], v6, s[8:11], s23 offen offset:2048 sc1
    v_mfma_f32_16x16x32_bf16 v[132:135], v[236:239], v[44:47], v[132:135]
    ds_read_b64_tr_b16 v[230:231], v5 offset:1056
    s_waitcnt lgkmcnt(6)
    v_mfma_f32_16x16x32_bf16 v[136:139], v[240:243], v[40:43], v[136:139]
    ds_read_b64_tr_b16 v[232:233], v4 offset:256
    v_mfma_f32_16x16x32_bf16 v[140:143], v[240:243], v[44:47], v[140:143]
    ds_read_b64_tr_b16 v[234:235], v4 offset:1280
    s_mov_b32 s23, 0x2a000
    buffer_load_dwordx4 v[36:39], v6, s[8:11], s23 offen offset:2048 sc1
    s_waitcnt lgkmcnt(6)
    v_mfma_f32_16x16x32_bf16 v[144:147], v[244:247], v[40:43], v[144:147]
    ds_read_b64_tr_b16 v[236:237], v5 offset:288
    v_mfma_f32_16x16x32_bf16 v[148:151], v[244:247], v[44:47], v[148:151]
    ds_read_b64_tr_b16 v[238:239], v5 offset:1312
    s_waitcnt vmcnt(14) lgkmcnt(6)
    v_mfma_f32_16x16x32_bf16 v[88:91], v[224:227], v[48:51], v[88:91]
    ds_read_b64_tr_b16 v[240:241], v4 offset:512
    s_waitcnt vmcnt(13)
    v_mfma_f32_16x16x32_bf16 v[92:95], v[224:227], v[52:55], v[92:95]
    s_add_u32 s22, s24, 0x320000
    s_add_u32 m0, s20, 0x20000
    s_nop 0
    buffer_load_dwordx4 v3, s[4:7], s22 offen lds
    ds_read_b64_tr_b16 v[242:243], v4 offset:1536
    s_waitcnt lgkmcnt(6)
    v_mfma_f32_16x16x32_bf16 v[96:99], v[228:231], v[48:51], v[96:99]
    ds_read_b64_tr_b16 v[244:245], v5 offset:544
    v_mfma_f32_16x16x32_bf16 v[100:103], v[228:231], v[52:55], v[100:103]
    ds_read_b64_tr_b16 v[246:247], v5 offset:1568
    s_waitcnt lgkmcnt(6)
    v_mfma_f32_16x16x32_bf16 v[104:107], v[232:235], v[48:51], v[104:107]
    s_add_u32 s22, s24, 0x322000
    s_add_u32 m0, s20, 0x20400
    s_nop 0
    buffer_load_dwordx4 v3, s[4:7], s22 offen lds
    ds_read_b64_tr_b16 v[224:225], v4 offset:768
    v_mfma_f32_16x16x32_bf16 v[108:111], v[232:235], v[52:55], v[108:111]
    ds_read_b64_tr_b16 v[226:227], v4 offset:1792
    s_waitcnt lgkmcnt(6)
    v_mfma_f32_16x16x32_bf16 v[112:115], v[236:239], v[48:51], v[112:115]
    ds_read_b64_tr_b16 v[228:229], v5 offset:800
    v_mfma_f32_16x16x32_bf16 v[116:119], v[236:239], v[52:55], v[116:119]
    ds_read_b64_tr_b16 v[230:231], v5 offset:1824
    s_waitcnt lgkmcnt(6)
    v_mfma_f32_16x16x32_bf16 v[120:123], v[240:243], v[48:51], v[120:123]
    v_mfma_f32_16x16x32_bf16 v[124:127], v[240:243], v[52:55], v[124:127]
    s_waitcnt vmcnt(13)
    s_barrier
    ds_read_b64_tr_b16 v[232:233], v4 offset:16384
    ds_read_b64_tr_b16 v[234:235], v4 offset:17408
    s_add_u32 s19, s19, 8192
    buffer_load_dword v12, v13, s[8:11], s19 offen sc1
    s_waitcnt lgkmcnt(6)
    v_mfma_f32_16x16x32_bf16 v[128:131], v[244:247], v[48:51], v[128:131]
    ds_read_b64_tr_b16 v[236:237], v5 offset:16416
    s_mov_b32 s23, 0xc000
    buffer_load_dwordx4 v[40:43], v6, s[8:11], s23 offen offset:2048 sc1
    v_mfma_f32_16x16x32_bf16 v[132:135], v[244:247], v[52:55], v[132:135]
    ds_read_b64_tr_b16 v[238:239], v5 offset:17440
    s_waitcnt lgkmcnt(6)
    v_mfma_f32_16x16x32_bf16 v[136:139], v[224:227], v[48:51], v[136:139]
    ds_read_b64_tr_b16 v[240:241], v4 offset:16640
    v_mfma_f32_16x16x32_bf16 v[140:143], v[224:227], v[52:55], v[140:143]
    ds_read_b64_tr_b16 v[242:243], v4 offset:17664
    s_mov_b32 s23, 0x2c000
    buffer_load_dwordx4 v[44:47], v6, s[8:11], s23 offen offset:2048 sc1
    s_waitcnt lgkmcnt(6)
    v_mfma_f32_16x16x32_bf16 v[144:147], v[228:231], v[48:51], v[144:147]
    ds_read_b64_tr_b16 v[244:245], v5 offset:16672
    v_mfma_f32_16x16x32_bf16 v[148:151], v[228:231], v[52:55], v[148:151]
    ds_read_b64_tr_b16 v[246:247], v5 offset:17696
    s_waitcnt vmcnt(15) lgkmcnt(6)
    v_mfma_f32_16x16x32_bf16 v[88:91], v[232:235], v[56:59], v[88:91]
    ds_read_b64_tr_b16 v[224:225], v4 offset:16896
    s_waitcnt vmcnt(14)
    v_mfma_f32_16x16x32_bf16 v[92:95], v[232:235], v[60:63], v[92:95]
    s_add_u32 s22, s24, 0x3a0000
    s_add_u32 m0, s20, 0x24000
    s_nop 0
    buffer_load_dwordx4 v3, s[4:7], s22 offen lds
    ds_read_b64_tr_b16 v[226:227], v4 offset:17920
    s_waitcnt lgkmcnt(6)
    v_mfma_f32_16x16x32_bf16 v[96:99], v[236:239], v[56:59], v[96:99]
    ds_read_b64_tr_b16 v[228:229], v5 offset:16928
    v_mfma_f32_16x16x32_bf16 v[100:103], v[236:239], v[60:63], v[100:103]
    ds_read_b64_tr_b16 v[230:231], v5 offset:17952
    s_waitcnt lgkmcnt(6)
    v_mfma_f32_16x16x32_bf16 v[104:107], v[240:243], v[56:59], v[104:107]
    s_add_u32 s22, s24, 0x3a2000
    s_add_u32 m0, s20, 0x24400
    s_nop 0
    buffer_load_dwordx4 v3, s[4:7], s22 offen lds
    ds_read_b64_tr_b16 v[232:233], v4 offset:17152
    v_mfma_f32_16x16x32_bf16 v[108:111], v[240:243], v[60:63], v[108:111]
    ds_read_b64_tr_b16 v[234:235], v4 offset:18176
    s_waitcnt lgkmcnt(6)
    v_mfma_f32_16x16x32_bf16 v[112:115], v[244:247], v[56:59], v[112:115]
    ds_read_b64_tr_b16 v[236:237], v5 offset:17184
    v_mfma_f32_16x16x32_bf16 v[116:119], v[244:247], v[60:63], v[116:119]
    ds_read_b64_tr_b16 v[238:239], v5 offset:18208
    s_waitcnt lgkmcnt(6)
    v_mfma_f32_16x16x32_bf16 v[120:123], v[224:227], v[56:59], v[120:123]
    v_mfma_f32_16x16x32_bf16 v[124:127], v[224:227], v[60:63], v[124:127]
    s_waitcnt vmcnt(14)
    s_barrier
    ds_read_b64_tr_b16 v[240:241], v4 offset:32768
    ds_read_b64_tr_b16 v[242:243], v4 offset:33792
    s_waitcnt lgkmcnt(6)
    v_mfma_f32_16x16x32_bf16 v[128:131], v[228:231], v[56:59], v[128:131]
    ds_read_b64_tr_b16 v[244:245], v5 offset:32800
    s_mov_b32 s23, 0xe000
    buffer_load_dwordx4 v[48:51], v6, s[8:11], s23 offen offset:2048 sc1
    v_mfma_f32_16x16x32_bf16 v[132:135], v[228:231], v[60:63], v[132:135]
    ds_read_b64_tr_b16 v[246:247], v5 offset:33824
    s_waitcnt lgkmcnt(6)
    v_mfma_f32_16x16x32_bf16 v[136:139], v[232:235], v[56:59], v[136:139]
    ds_read_b64_tr_b16 v[224:225], v4 offset:33024
    v_mfma_f32_16x16x32_bf16 v[140:143], v[232:235], v[60:63], v[140:143]
    ds_read_b64_tr_b16 v[226:227], v4 offset:34048
    s_mov_b32 s23, 0x2e000
    buffer_load_dwordx4 v[52:55], v6, s[8:11], s23 offen offset:2048 sc1
    s_waitcnt lgkmcnt(6)
    v_mfma_f32_16x16x32_bf16 v[144:147], v[236:239], v[56:59], v[144:147]
    ds_read_b64_tr_b16 v[228:229], v5 offset:33056
    v_mfma_f32_16x16x32_bf16 v[148:151], v[236:239], v[60:63], v[148:151]
    ds_read_b64_tr_b16 v[230:231], v5 offset:34080
    s_waitcnt vmcnt(6)
    v_cmp_ne_u32 vcc, s28, v12
    s_cbranch_vccnz adaLN_cond__sliding_block_cached__moe_arch_mod__prompt_kernel_o220r
adaLN_cond__sliding_block_cached__moe_arch_mod__prompt_kernel_o220b:
    s_waitcnt lgkmcnt(6)
    v_mfma_f32_16x16x32_bf16 v[88:91], v[240:243], v[24:27], v[88:91]
    ds_read_b64_tr_b16 v[232:233], v4 offset:33280
    v_mfma_f32_16x16x32_bf16 v[92:95], v[240:243], v[28:31], v[92:95]
    s_add_u32 s22, s24, 0x30000
    s_add_u32 m0, s20, 0x10000
    s_nop 0
    buffer_load_dwordx4 v3, s[4:7], s22 offen lds
    ds_read_b64_tr_b16 v[234:235], v4 offset:34304
    s_waitcnt lgkmcnt(6)
    v_mfma_f32_16x16x32_bf16 v[96:99], v[244:247], v[24:27], v[96:99]
    ds_read_b64_tr_b16 v[236:237], v5 offset:33312
    v_mfma_f32_16x16x32_bf16 v[100:103], v[244:247], v[28:31], v[100:103]
    ds_read_b64_tr_b16 v[238:239], v5 offset:34336
    s_waitcnt lgkmcnt(6)
    v_mfma_f32_16x16x32_bf16 v[104:107], v[224:227], v[24:27], v[104:107]
    s_add_u32 s22, s24, 0x32000
    s_add_u32 m0, s20, 0x10400
    s_nop 0
    buffer_load_dwordx4 v3, s[4:7], s22 offen lds
    ds_read_b64_tr_b16 v[240:241], v4 offset:33536
    v_mfma_f32_16x16x32_bf16 v[108:111], v[224:227], v[28:31], v[108:111]
    ds_read_b64_tr_b16 v[242:243], v4 offset:34560
    v_xor_b32 v16, s28, v184
    v_xor_b32 v17, s28, v185
    v_xor_b32 v18, s28, v186
    v_xor_b32 v19, s28, v187
    v_or3_b32 v16, v16, v17, v18
    v_or_b32 v16, v16, v19
    v_cmp_ne_u32 vcc, 0, v16
    s_cbranch_vccnz adaLN_cond__sliding_block_cached__moe_arch_mod__prompt_kernel_mf21r
adaLN_cond__sliding_block_cached__moe_arch_mod__prompt_kernel_mf21b:
    s_waitcnt lgkmcnt(6)
    v_mfma_f32_16x16x32_bf16 v[112:115], v[228:231], v[24:27], v[112:115]
    ds_read_b64_tr_b16 v[244:245], v5 offset:33568
    v_mfma_f32_16x16x32_bf16 v[116:119], v[228:231], v[28:31], v[116:119]
    ds_read_b64_tr_b16 v[246:247], v5 offset:34592
    s_waitcnt lgkmcnt(6)
    v_mfma_f32_16x16x32_bf16 v[120:123], v[232:235], v[24:27], v[120:123]
    v_mfma_f32_16x16x32_bf16 v[124:127], v[232:235], v[28:31], v[124:127]
    s_barrier
    ds_read_b64_tr_b16 v[224:225], v4 offset:49152
    ds_read_b64_tr_b16 v[226:227], v4 offset:50176
    s_waitcnt lgkmcnt(6)
    v_mfma_f32_16x16x32_bf16 v[128:131], v[236:239], v[24:27], v[128:131]
    ds_read_b64_tr_b16 v[228:229], v5 offset:49184
    s_mov_b32 s23, 0x0
    buffer_load_dwordx4 v[56:59], v6, s[8:11], s23 offen offset:3072 sc1
    v_mfma_f32_16x16x32_bf16 v[132:135], v[236:239], v[28:31], v[132:135]
    ds_read_b64_tr_b16 v[230:231], v5 offset:50208
    s_waitcnt lgkmcnt(6)
    v_mfma_f32_16x16x32_bf16 v[136:139], v[240:243], v[24:27], v[136:139]
    ds_read_b64_tr_b16 v[232:233], v4 offset:49408
    v_mfma_f32_16x16x32_bf16 v[140:143], v[240:243], v[28:31], v[140:143]
    ds_read_b64_tr_b16 v[234:235], v4 offset:50432
    s_mov_b32 s23, 0x20000
    buffer_load_dwordx4 v[60:63], v6, s[8:11], s23 offen offset:3072 sc1
    s_waitcnt lgkmcnt(6)
    v_mfma_f32_16x16x32_bf16 v[144:147], v[244:247], v[24:27], v[144:147]
    ds_read_b64_tr_b16 v[236:237], v5 offset:49440
    v_mfma_f32_16x16x32_bf16 v[148:151], v[244:247], v[28:31], v[148:151]
    ds_read_b64_tr_b16 v[238:239], v5 offset:50464
    s_waitcnt lgkmcnt(6)
    v_mfma_f32_16x16x32_bf16 v[88:91], v[224:227], v[32:35], v[88:91]
    ds_read_b64_tr_b16 v[240:241], v4 offset:49664
    v_mfma_f32_16x16x32_bf16 v[92:95], v[224:227], v[36:39], v[92:95]
    s_add_u32 s22, s24, 0xb0000
    s_add_u32 m0, s20, 0x14000
    s_nop 0
    buffer_load_dwordx4 v3, s[4:7], s22 offen lds
    ds_read_b64_tr_b16 v[242:243], v4 offset:50688
    s_waitcnt lgkmcnt(6)
    v_mfma_f32_16x16x32_bf16 v[96:99], v[228:231], v[32:35], v[96:99]
    ds_read_b64_tr_b16 v[244:245], v5 offset:49696
    v_mfma_f32_16x16x32_bf16 v[100:103], v[228:231], v[36:39], v[100:103]
    ds_read_b64_tr_b16 v[246:247], v5 offset:50720
    s_waitcnt lgkmcnt(6)
    v_mfma_f32_16x16x32_bf16 v[104:107], v[232:235], v[32:35], v[104:107]
    s_add_u32 s22, s24, 0xb2000
    s_add_u32 m0, s20, 0x14400
    s_nop 0
    buffer_load_dwordx4 v3, s[4:7], s22 offen lds
    ds_read_b64_tr_b16 v[224:225], v4 offset:49920
    v_mfma_f32_16x16x32_bf16 v[108:111], v[232:235], v[36:39], v[108:111]
    ds_read_b64_tr_b16 v[226:227], v4 offset:50944
    s_waitcnt lgkmcnt(6)
    v_mfma_f32_16x16x32_bf16 v[112:115], v[236:239], v[32:35], v[112:115]
    ds_read_b64_tr_b16 v[228:229], v5 offset:49952
    v_mfma_f32_16x16x32_bf16 v[116:119], v[236:239], v[36:39], v[116:119]
    ds_read_b64_tr_b16 v[230:231], v5 offset:50976
    s_waitcnt lgkmcnt(6)
    v_mfma_f32_16x16x32_bf16 v[120:123], v[240:243], v[32:35], v[120:123]
    v_mfma_f32_16x16x32_bf16 v[124:127], v[240:243], v[36:39], v[124:127]
    s_barrier
    ds_read_b64_tr_b16 v[232:233], v7 offset:0
    ds_read_b64_tr_b16 v[234:235], v7 offset:1024
    s_waitcnt lgkmcnt(6)
    v_mfma_f32_16x16x32_bf16 v[128:131], v[244:247], v[32:35], v[128:131]
    ds_read_b64_tr_b16 v[236:237], v8 offset:32
    s_mov_b32 s23, 0x2000
    buffer_load_dwordx4 v[24:27], v6, s[8:11], s23 offen offset:3072 sc1
    v_mfma_f32_16x16x32_bf16 v[132:135], v[244:247], v[36:39], v[132:135]
    ds_read_b64_tr_b16 v[238:239], v8 offset:1056
    s_waitcnt lgkmcnt(6)
    v_mfma_f32_16x16x32_bf16 v[136:139], v[224:227], v[32:35], v[136:139]
    ds_read_b64_tr_b16 v[240:241], v7 offset:256
    v_mfma_f32_16x16x32_bf16 v[140:143], v[224:227], v[36:39], v[140:143]
    ds_read_b64_tr_b16 v[242:243], v7 offset:1280
    s_mov_b32 s23, 0x22000
    buffer_load_dwordx4 v[28:31], v6, s[8:11], s23 offen offset:3072 sc1
    s_waitcnt lgkmcnt(6)
    v_mfma_f32_16x16x32_bf16 v[144:147], v[228:231], v[32:35], v[144:147]
    ds_read_b64_tr_b16 v[244:245], v8 offset:288
    v_mfma_f32_16x16x32_bf16 v[148:151], v[228:231], v[36:39], v[148:151]
    ds_read_b64_tr_b16 v[246:247], v8 offset:1312
    s_waitcnt vmcnt(13) lgkmcnt(6)
    v_mfma_f32_16x16x32_bf16 v[88:91], v[232:235], v[40:43], v[88:91]
    ds_read_b64_tr_b16 v[224:225], v7 offset:512
    s_waitcnt vmcnt(12)
    v_mfma_f32_16x16x32_bf16 v[92:95], v[232:235], v[44:47], v[92:95]
    s_add_u32 s22, s24, 0x130000
    s_add_u32 m0, s20, 0x18000
    s_nop 0
    buffer_load_dwordx4 v3, s[4:7], s22 offen lds
    ds_read_b64_tr_b16 v[226:227], v7 offset:1536
    s_waitcnt lgkmcnt(6)
    v_mfma_f32_16x16x32_bf16 v[96:99], v[236:239], v[40:43], v[96:99]
    ds_read_b64_tr_b16 v[228:229], v8 offset:544
    v_mfma_f32_16x16x32_bf16 v[100:103], v[236:239], v[44:47], v[100:103]
    ds_read_b64_tr_b16 v[230:231], v8 offset:1568
    s_waitcnt lgkmcnt(6)
    v_mfma_f32_16x16x32_bf16 v[104:107], v[240:243], v[40:43], v[104:107]
    s_add_u32 s22, s24, 0x132000
    s_add_u32 m0, s20, 0x18400
    s_nop 0
    buffer_load_dwordx4 v3, s[4:7], s22 offen lds
    ds_read_b64_tr_b16 v[232:233], v7 offset:768
    v_mfma_f32_16x16x32_bf16 v[108:111], v[240:243], v[44:47], v[108:111]
    ds_read_b64_tr_b16 v[234:235], v7 offset:1792
    s_waitcnt lgkmcnt(6)
    v_mfma_f32_16x16x32_bf16 v[112:115], v[244:247], v[40:43], v[112:115]
    ds_read_b64_tr_b16 v[236:237], v8 offset:800
    v_mfma_f32_16x16x32_bf16 v[116:119], v[244:247], v[44:47], v[116:119]
    ds_read_b64_tr_b16 v[238:239], v8 offset:1824
    s_waitcnt lgkmcnt(6)
    v_mfma_f32_16x16x32_bf16 v[120:123], v[224:227], v[40:43], v[120:123]
    v_mfma_f32_16x16x32_bf16 v[124:127], v[224:227], v[44:47], v[124:127]
    s_waitcnt vmcnt(12)
    s_barrier
    ds_read_b64_tr_b16 v[240:241], v7 offset:16384
    ds_read_b64_tr_b16 v[242:243], v7 offset:17408
    s_waitcnt lgkmcnt(6)
    v_mfma_f32_16x16x32_bf16 v[128:131], v[228:231], v[40:43], v[128:131]
    ds_read_b64_tr_b16 v[244:245], v8 offset:16416
    s_mov_b32 s23, 0x4000
    buffer_load_dwordx4 v[32:35], v6, s[8:11], s23 offen offset:3072 sc1
    v_mfma_f32_16x16x32_bf16 v[132:135], v[228:231], v[44:47], v[132:135]
    ds_read_b64_tr_b16 v[246:247], v8 offset:17440
    s_waitcnt lgkmcnt(6)
    v_mfma_f32_16x16x32_bf16 v[136:139], v[232:235], v[40:43], v[136:139]
    ds_read_b64_tr_b16 v[224:225], v7 offset:16640
    v_mfma_f32_16x16x32_bf16 v[140:143], v[232:235], v[44:47], v[140:143]
    ds_read_b64_tr_b16 v[226:227], v7 offset:17664
    s_mov_b32 s23, 0x24000
    buffer_load_dwordx4 v[36:39], v6, s[8:11], s23 offen offset:3072 sc1
    s_waitcnt lgkmcnt(6)
    v_mfma_f32_16x16x32_bf16 v[144:147], v[236:239], v[40:43], v[144:147]
    ds_read_b64_tr_b16 v[228:229], v8 offset:16672
    v_mfma_f32_16x16x32_bf16 v[148:151], v[236:239], v[44:47], v[148:151]
    ds_read_b64_tr_b16 v[230:231], v8 offset:17696
    s_waitcnt vmcnt(13) lgkmcnt(6)
    v_mfma_f32_16x16x32_bf16 v[88:91], v[240:243], v[48:51], v[88:91]
    ds_read_b64_tr_b16 v[232:233], v7 offset:16896
    s_waitcnt vmcnt(12)
    v_mfma_f32_16x16x32_bf16 v[92:95], v[240:243], v[52:55], v[92:95]
    s_add_u32 s22, s24, 0x1b0000
    s_add_u32 m0, s20, 0x1c000
    s_nop 0
    buffer_load_dwordx4 v3, s[4:7], s22 offen lds
    ds_read_b64_tr_b16 v[234:235], v7 offset:17920
    s_waitcnt lgkmcnt(6)
    v_mfma_f32_16x16x32_bf16 v[96:99], v[244:247], v[48:51], v[96:99]
    ds_read_b64_tr_b16 v[236:237], v8 offset:16928
    v_mfma_f32_16x16x32_bf16 v[100:103], v[244:247], v[52:55], v[100:103]
    ds_read_b64_tr_b16 v[238:239], v8 offset:17952
    s_waitcnt lgkmcnt(6)
    v_mfma_f32_16x16x32_bf16 v[104:107], v[224:227], v[48:51], v[104:107]
    s_add_u32 s22, s24, 0x1b2000
    s_add_u32 m0, s20, 0x1c400
    s_nop 0
    buffer_load_dwordx4 v3, s[4:7], s22 offen lds
    ds_read_b64_tr_b16 v[240:241], v7 offset:17152
    v_mfma_f32_16x16x32_bf16 v[108:111], v[224:227], v[52:55], v[108:111]
    ds_read_b64_tr_b16 v[242:243], v7 offset:18176
    s_waitcnt lgkmcnt(6)
    v_mfma_f32_16x16x32_bf16 v[112:115], v[228:231], v[48:51], v[112:115]
    ds_read_b64_tr_b16 v[244:245], v8 offset:17184
    v_mfma_f32_16x16x32_bf16 v[116:119], v[228:231], v[52:55], v[116:119]
    ds_read_b64_tr_b16 v[246:247], v8 offset:18208
    s_waitcnt lgkmcnt(6)
    v_mfma_f32_16x16x32_bf16 v[120:123], v[232:235], v[48:51], v[120:123]
    v_mfma_f32_16x16x32_bf16 v[124:127], v[232:235], v[52:55], v[124:127]
    s_waitcnt vmcnt(12)
    s_barrier
    ds_read_b64_tr_b16 v[224:225], v4 offset:0
    ds_read_b64_tr_b16 v[226:227], v4 offset:1024
    s_waitcnt lgkmcnt(6)
    v_mfma_f32_16x16x32_bf16 v[128:131], v[236:239], v[48:51], v[128:131]
    ds_read_b64_tr_b16 v[228:229], v5 offset:32
    s_mov_b32 s23, 0x6000
    buffer_load_dwordx4 v[40:43], v6, s[8:11], s23 offen offset:3072 sc1
    v_mfma_f32_16x16x32_bf16 v[132:135], v[236:239], v[52:55], v[132:135]
    ds_read_b64_tr_b16 v[230:231], v5 offset:1056
    s_waitcnt lgkmcnt(6)
    v_mfma_f32_16x16x32_bf16 v[136:139], v[240:243], v[48:51], v[136:139]
    ds_read_b64_tr_b16 v[232:233], v4 offset:256
    v_mfma_f32_16x16x32_bf16 v[140:143], v[240:243], v[52:55], v[140:143]
    ds_read_b64_tr_b16 v[234:235], v4 offset:1280
    s_mov_b32 s23, 0x26000
    buffer_load_dwordx4 v[44:47], v6, s[8:11], s23 offen offset:3072 sc1
    s_waitcnt lgkmcnt(6)
    v_mfma_f32_16x16x32_bf16 v[144:147], v[244:247], v[48:51], v[144:147]
    ds_read_b64_tr_b16 v[236:237], v5 offset:288
    v_mfma_f32_16x16x32_bf16 v[148:151], v[244:247], v[52:55], v[148:151]
    ds_read_b64_tr_b16 v[238:239], v5 offset:1312
    s_waitcnt vmcnt(13) lgkmcnt(6)
    v_mfma_f32_16x16x32_bf16 v[88:91], v[224:227], v[56:59], v[88:91]
    ds_read_b64_tr_b16 v[240:241], v4 offset:512
    s_waitcnt vmcnt(12)
    v_mfma_f32_16x16x32_bf16 v[92:95], v[224:227], v[60:63], v[92:95]
    s_add_u32 s22, s24, 0x230000
    s_add_u32 m0, s20, 0x20000
    s_nop 0
    buffer_load_dwordx4 v3, s[4:7], s22 offen lds
    ds_read_b64_tr_b16 v[242:243], v4 offset:1536
    s_waitcnt lgkmcnt(6)
    v_mfma_f32_16x16x32_bf16 v[96:99], v[228:231], v[56:59], v[96:99]
    ds_read_b64_tr_b16 v[244:245], v5 offset:544
    v_mfma_f32_16x16x32_bf16 v[100:103], v[228:231], v[60:63], v[100:103]
    ds_read_b64_tr_b16 v[246:247], v5 offset:1568
    s_waitcnt lgkmcnt(6)
    v_mfma_f32_16x16x32_bf16 v[104:107], v[232:235], v[56:59], v[104:107]
    s_add_u32 s22, s24, 0x232000
    s_add_u32 m0, s20, 0x20400
    s_nop 0
    buffer_load_dwordx4 v3, s[4:7], s22 offen lds
    ds_read_b64_tr_b16 v[224:225], v4 offset:768
    v_mfma_f32_16x16x32_bf16 v[108:111], v[232:235], v[60:63], v[108:111]
    ds_read_b64_tr_b16 v[226:227], v4 offset:1792
    s_waitcnt lgkmcnt(6)
    v_mfma_f32_16x16x32_bf16 v[112:115], v[236:239], v[56:59], v[112:115]
    ds_read_b64_tr_b16 v[228:229], v5 offset:800
    v_mfma_f32_16x16x32_bf16 v[116:119], v[236:239], v[60:63], v[116:119]
    ds_read_b64_tr_b16 v[230:231], v5 offset:1824
    s_waitcnt lgkmcnt(6)
    v_mfma_f32_16x16x32_bf16 v[120:123], v[240:243], v[56:59], v[120:123]
    v_mfma_f32_16x16x32_bf16 v[124:127], v[240:243], v[60:63], v[124:127]
    s_waitcnt vmcnt(12)
    s_barrier
    ds_read_b64_tr_b16 v[232:233], v4 offset:16384
    ds_read_b64_tr_b16 v[234:235], v4 offset:17408
    s_waitcnt lgkmcnt(6)
    v_mfma_f32_16x16x32_bf16 v[128:131], v[244:247], v[56:59], v[128:131]
    ds_read_b64_tr_b16 v[236:237], v5 offset:16416
    s_mov_b32 s23, 0x8000
    buffer_load_dwordx4 v[48:51], v6, s[8:11], s23 offen offset:3072 sc1
    v_mfma_f32_16x16x32_bf16 v[132:135], v[244:247], v[60:63], v[132:135]
    ds_read_b64_tr_b16 v[238:239], v5 offset:17440
    s_waitcnt lgkmcnt(6)
    v_mfma_f32_16x16x32_bf16 v[136:139], v[224:227], v[56:59], v[136:139]
    ds_read_b64_tr_b16 v[240:241], v4 offset:16640
    v_mfma_f32_16x16x32_bf16 v[140:143], v[224:227], v[60:63], v[140:143]
    ds_read_b64_tr_b16 v[242:243], v4 offset:17664
    s_mov_b32 s23, 0x28000
    buffer_load_dwordx4 v[52:55], v6, s[8:11], s23 offen offset:3072 sc1
    s_waitcnt lgkmcnt(6)
    v_mfma_f32_16x16x32_bf16 v[144:147], v[228:231], v[56:59], v[144:147]
    ds_read_b64_tr_b16 v[244:245], v5 offset:16672
    v_mfma_f32_16x16x32_bf16 v[148:151], v[228:231], v[60:63], v[148:151]
    ds_read_b64_tr_b16 v[246:247], v5 offset:17696
    s_waitcnt vmcnt(13) lgkmcnt(6)
    v_mfma_f32_16x16x32_bf16 v[88:91], v[232:235], v[24:27], v[88:91]
    ds_read_b64_tr_b16 v[224:225], v4 offset:16896
    s_waitcnt vmcnt(12)
    v_mfma_f32_16x16x32_bf16 v[92:95], v[232:235], v[28:31], v[92:95]
    s_add_u32 s22, s24, 0x2b0000
    s_add_u32 m0, s20, 0x24000
    s_nop 0
    buffer_load_dwordx4 v3, s[4:7], s22 offen lds
    ds_read_b64_tr_b16 v[226:227], v4 offset:17920
    s_waitcnt lgkmcnt(6)
    v_mfma_f32_16x16x32_bf16 v[96:99], v[236:239], v[24:27], v[96:99]
    ds_read_b64_tr_b16 v[228:229], v5 offset:16928
    v_mfma_f32_16x16x32_bf16 v[100:103], v[236:239], v[28:31], v[100:103]
    ds_read_b64_tr_b16 v[230:231], v5 offset:17952
    s_waitcnt lgkmcnt(6)
    v_mfma_f32_16x16x32_bf16 v[104:107], v[240:243], v[24:27], v[104:107]
    s_add_u32 s22, s24, 0x2b2000
    s_add_u32 m0, s20, 0x24400
    s_nop 0
    buffer_load_dwordx4 v3, s[4:7], s22 offen lds
    ds_read_b64_tr_b16 v[232:233], v4 offset:17152
    v_mfma_f32_16x16x32_bf16 v[108:111], v[240:243], v[28:31], v[108:111]
    ds_read_b64_tr_b16 v[234:235], v4 offset:18176
    s_waitcnt lgkmcnt(6)
    v_mfma_f32_16x16x32_bf16 v[112:115], v[244:247], v[24:27], v[112:115]
    ds_read_b64_tr_b16 v[236:237], v5 offset:17184
    v_mfma_f32_16x16x32_bf16 v[116:119], v[244:247], v[28:31], v[116:119]
    ds_read_b64_tr_b16 v[238:239], v5 offset:18208
    s_waitcnt lgkmcnt(6)
    v_mfma_f32_16x16x32_bf16 v[120:123], v[224:227], v[24:27], v[120:123]
    v_mfma_f32_16x16x32_bf16 v[124:127], v[224:227], v[28:31], v[124:127]
    s_waitcnt vmcnt(12)
    s_barrier
    ds_read_b64_tr_b16 v[240:241], v4 offset:32768
    ds_read_b64_tr_b16 v[242:243], v4 offset:33792
    s_waitcnt lgkmcnt(6)
    v_mfma_f32_16x16x32_bf16 v[128:131], v[228:231], v[24:27], v[128:131]
    ds_read_b64_tr_b16 v[244:245], v5 offset:32800
    s_mov_b32 s23, 0xa000
    buffer_load_dwordx4 v[56:59], v6, s[8:11], s23 offen offset:3072 sc1
    v_mfma_f32_16x16x32_bf16 v[132:135], v[228:231], v[28:31], v[132:135]
    ds_read_b64_tr_b16 v[246:247], v5 offset:33824
    s_waitcnt lgkmcnt(6)
    v_mfma_f32_16x16x32_bf16 v[136:139], v[232:235], v[24:27], v[136:139]
    ds_read_b64_tr_b16 v[224:225], v4 offset:33024
    v_mfma_f32_16x16x32_bf16 v[140:143], v[232:235], v[28:31], v[140:143]
    ds_read_b64_tr_b16 v[226:227], v4 offset:34048
    s_mov_b32 s23, 0x2a000
    buffer_load_dwordx4 v[60:63], v6, s[8:11], s23 offen offset:3072 sc1
    s_waitcnt lgkmcnt(6)
    v_mfma_f32_16x16x32_bf16 v[144:147], v[236:239], v[24:27], v[144:147]
    ds_read_b64_tr_b16 v[228:229], v5 offset:33056
    v_mfma_f32_16x16x32_bf16 v[148:151], v[236:239], v[28:31], v[148:151]
    ds_read_b64_tr_b16 v[230:231], v5 offset:34080
    s_waitcnt vmcnt(13) lgkmcnt(6)
    v_mfma_f32_16x16x32_bf16 v[88:91], v[240:243], v[32:35], v[88:91]
    ds_read_b64_tr_b16 v[232:233], v4 offset:33280
    s_waitcnt vmcnt(12)
    v_mfma_f32_16x16x32_bf16 v[92:95], v[240:243], v[36:39], v[92:95]
    s_add_u32 s22, s24, 0x330000
    s_add_u32 m0, s20, 0x10000
    s_nop 0
    buffer_load_dwordx4 v3, s[4:7], s22 offen lds
    ds_read_b64_tr_b16 v[234:235], v4 offset:34304
    s_waitcnt lgkmcnt(6)
    v_mfma_f32_16x16x32_bf16 v[96:99], v[244:247], v[32:35], v[96:99]
    ds_read_b64_tr_b16 v[236:237], v5 offset:33312
    v_mfma_f32_16x16x32_bf16 v[100:103], v[244:247], v[36:39], v[100:103]
    ds_read_b64_tr_b16 v[238:239], v5 offset:34336
    s_waitcnt lgkmcnt(6)
    v_mfma_f32_16x16x32_bf16 v[104:107], v[224:227], v[32:35], v[104:107]
    s_add_u32 s22, s24, 0x332000
    s_add_u32 m0, s20, 0x10400
    s_nop 0
    buffer_load_dwordx4 v3, s[4:7], s22 offen lds
    ds_read_b64_tr_b16 v[240:241], v4 offset:33536
    v_mfma_f32_16x16x32_bf16 v[108:111], v[224:227], v[36:39], v[108:111]
    ds_read_b64_tr_b16 v[242:243], v4 offset:34560
    v_lshrrev_b32 v16, 4, v1
    v_lshlrev_b32 v16, 3, v16
    s_lshl_b32 s16, s31, 8
    s_add_u32 s16, s16, 0x540080
    buffer_load_dwordx2 v[248:249], v16, s[8:11], s16 offen offset:0 sc1
    buffer_load_dwordx2 v[250:251], v16, s[8:11], s16 offen offset:32 sc1
    buffer_load_dwordx2 v[252:253], v16, s[8:11], s16 offen offset:64 sc1
    buffer_load_dwordx2 v[254:255], v16, s[8:11], s16 offen offset:96 sc1
    s_waitcnt lgkmcnt(6)
    v_mfma_f32_16x16x32_bf16 v[112:115], v[228:231], v[32:35], v[112:115]
    ds_read_b64_tr_b16 v[244:245], v5 offset:33568
    v_mfma_f32_16x16x32_bf16 v[116:119], v[228:231], v[36:39], v[116:119]
    ds_read_b64_tr_b16 v[246:247], v5 offset:34592
    s_waitcnt lgkmcnt(6)
    v_mfma_f32_16x16x32_bf16 v[120:123], v[232:235], v[32:35], v[120:123]
    v_mfma_f32_16x16x32_bf16 v[124:127], v[232:235], v[36:39], v[124:127]
    s_waitcnt vmcnt(16)
    s_barrier
    ds_read_b64_tr_b16 v[224:225], v4 offset:49152
    ds_read_b64_tr_b16 v[226:227], v4 offset:50176
    s_waitcnt lgkmcnt(6)
    v_mfma_f32_16x16x32_bf16 v[128:131], v[236:239], v[32:35], v[128:131]
    ds_read_b64_tr_b16 v[228:229], v5 offset:49184
    s_mov_b32 s23, 0xc000
    buffer_load_dwordx4 v[24:27], v6, s[8:11], s23 offen offset:3072 sc1
    v_mfma_f32_16x16x32_bf16 v[132:135], v[236:239], v[36:39], v[132:135]
    ds_read_b64_tr_b16 v[230:231], v5 offset:50208
    s_waitcnt lgkmcnt(6)
    v_mfma_f32_16x16x32_bf16 v[136:139], v[240:243], v[32:35], v[136:139]
    ds_read_b64_tr_b16 v[232:233], v4 offset:49408
    v_mfma_f32_16x16x32_bf16 v[140:143], v[240:243], v[36:39], v[140:143]
    ds_read_b64_tr_b16 v[234:235], v4 offset:50432
    s_mov_b32 s23, 0x2c000
    buffer_load_dwordx4 v[28:31], v6, s[8:11], s23 offen offset:3072 sc1
    s_waitcnt lgkmcnt(6)
    v_mfma_f32_16x16x32_bf16 v[144:147], v[244:247], v[32:35], v[144:147]
    ds_read_b64_tr_b16 v[236:237], v5 offset:49440
    v_mfma_f32_16x16x32_bf16 v[148:151], v[244:247], v[36:39], v[148:151]
    ds_read_b64_tr_b16 v[238:239], v5 offset:50464
    s_waitcnt vmcnt(17) lgkmcnt(6)
    v_mfma_f32_16x16x32_bf16 v[88:91], v[224:227], v[40:43], v[88:91]
    ds_read_b64_tr_b16 v[240:241], v4 offset:49664
    s_waitcnt vmcnt(16)
    v_mfma_f32_16x16x32_bf16 v[92:95], v[224:227], v[44:47], v[92:95]
    s_add_u32 s22, s24, 0x3b0000
    s_add_u32 m0, s20, 0x14000
    s_nop 0
    buffer_load_dwordx4 v3, s[4:7], s22 offen lds
    ds_read_b64_tr_b16 v[242:243], v4 offset:50688
    s_waitcnt lgkmcnt(6)
    v_mfma_f32_16x16x32_bf16 v[96:99], v[228:231], v[40:43], v[96:99]
    ds_read_b64_tr_b16 v[244:245], v5 offset:49696
    v_mfma_f32_16x16x32_bf16 v[100:103], v[228:231], v[44:47], v[100:103]
    ds_read_b64_tr_b16 v[246:247], v5 offset:50720
    s_waitcnt lgkmcnt(6)
    v_mfma_f32_16x16x32_bf16 v[104:107], v[232:235], v[40:43], v[104:107]
    s_add_u32 s22, s24, 0x3b2000
    s_add_u32 m0, s20, 0x14400
    s_nop 0
    buffer_load_dwordx4 v3, s[4:7], s22 offen lds
    ds_read_b64_tr_b16 v[224:225], v4 offset:49920
    v_mfma_f32_16x16x32_bf16 v[108:111], v[232:235], v[44:47], v[108:111]
    ds_read_b64_tr_b16 v[226:227], v4 offset:50944
    s_waitcnt lgkmcnt(6)
    v_mfma_f32_16x16x32_bf16 v[112:115], v[236:239], v[40:43], v[112:115]
    ds_read_b64_tr_b16 v[228:229], v5 offset:49952
    v_mfma_f32_16x16x32_bf16 v[116:119], v[236:239], v[44:47], v[116:119]
    ds_read_b64_tr_b16 v[230:231], v5 offset:50976
    s_waitcnt lgkmcnt(6)
    v_mfma_f32_16x16x32_bf16 v[120:123], v[240:243], v[40:43], v[120:123]
    v_mfma_f32_16x16x32_bf16 v[124:127], v[240:243], v[44:47], v[124:127]
    s_waitcnt vmcnt(16)
    s_barrier
    ds_read_b64_tr_b16 v[232:233], v7 offset:0
    ds_read_b64_tr_b16 v[234:235], v7 offset:1024
    s_waitcnt lgkmcnt(6)
    v_mfma_f32_16x16x32_bf16 v[128:131], v[244:247], v[40:43], v[128:131]
    ds_read_b64_tr_b16 v[236:237], v8 offset:32
    s_mov_b32 s23, 0xe000
    buffer_load_dwordx4 v[32:35], v6, s[8:11], s23 offen offset:3072 sc1
    v_mfma_f32_16x16x32_bf16 v[132:135], v[244:247], v[44:47], v[132:135]
    ds_read_b64_tr_b16 v[238:239], v8 offset:1056
    s_waitcnt lgkmcnt(6)
    v_mfma_f32_16x16x32_bf16 v[136:139], v[224:227], v[40:43], v[136:139]
    ds_read_b64_tr_b16 v[240:241], v7 offset:256
    v_mfma_f32_16x16x32_bf16 v[140:143], v[224:227], v[44:47], v[140:143]
    ds_read_b64_tr_b16 v[242:243], v7 offset:1280
    s_mov_b32 s23, 0x2e000
    buffer_load_dwordx4 v[36:39], v6, s[8:11], s23 offen offset:3072 sc1
    s_waitcnt lgkmcnt(6)
    v_mfma_f32_16x16x32_bf16 v[144:147], v[228:231], v[40:43], v[144:147]
    ds_read_b64_tr_b16 v[244:245], v8 offset:288
    v_mfma_f32_16x16x32_bf16 v[148:151], v[228:231], v[44:47], v[148:151]
    ds_read_b64_tr_b16 v[246:247], v8 offset:1312
    s_waitcnt vmcnt(17) lgkmcnt(6)
    v_mfma_f32_16x16x32_bf16 v[88:91], v[232:235], v[48:51], v[88:91]
    ds_read_b64_tr_b16 v[224:225], v7 offset:512
    s_waitcnt vmcnt(16)
    v_mfma_f32_16x16x32_bf16 v[92:95], v[232:235], v[52:55], v[92:95]
    ds_read_b64_tr_b16 v[226:227], v7 offset:1536
    s_waitcnt lgkmcnt(6)
    v_mfma_f32_16x16x32_bf16 v[96:99], v[236:239], v[48:51], v[96:99]
    ds_read_b64_tr_b16 v[228:229], v8 offset:544
    v_mfma_f32_16x16x32_bf16 v[100:103], v[236:239], v[52:55], v[100:103]
    ds_read_b64_tr_b16 v[230:231], v8 offset:1568
    s_waitcnt lgkmcnt(6)
    v_mfma_f32_16x16x32_bf16 v[104:107], v[240:243], v[48:51], v[104:107]
    ds_read_b64_tr_b16 v[232:233], v7 offset:768
    v_mfma_f32_16x16x32_bf16 v[108:111], v[240:243], v[52:55], v[108:111]
    ds_read_b64_tr_b16 v[234:235], v7 offset:1792
    s_waitcnt lgkmcnt(6)
    v_mfma_f32_16x16x32_bf16 v[112:115], v[244:247], v[48:51], v[112:115]
    ds_read_b64_tr_b16 v[236:237], v8 offset:800
    v_mfma_f32_16x16x32_bf16 v[116:119], v[244:247], v[52:55], v[116:119]
    ds_read_b64_tr_b16 v[238:239], v8 offset:1824
    s_waitcnt lgkmcnt(6)
    v_mfma_f32_16x16x32_bf16 v[120:123], v[224:227], v[48:51], v[120:123]
    s_mov_b64 s[72:73], s[48:49]
    s_mov_b32 s74, 0x700000
    s_mov_b32 s75, 0x20000
    s_cmp_lt_u32 s2, 224
    s_cselect_b32 s74, 7340032, 0
    s_and_b32 s16, s3, 3
    v_lshrrev_b32 v20, 3, v1
    v_lshlrev_b32 v20, 3, v20
    s_lshl_b32 s17, s16, 6
    v_add_u32 v20, s17, v20
    s_mov_b32 s17, 7168
    v_mul_lo_u32 v21, s17, v20
    v_and_b32 v20, 7, v1
    v_lshl_add_u32 v21, v20, 4, v21
    s_and_b32 s17, s29, 3
    s_mul_i32 s18, s17, 1835008
    s_lshr_b32 s17, s29, 2
    s_lshl_b32 s17, s17, 7
    s_add_u32 s18, s18, s17
    s_lshl_b32 s16, s16, 13
    s_add_u32 s22, s18, 0
    s_add_u32 m0, s16, 32768
    s_nop 0
    buffer_load_dwordx4 v21, s[72:75], s22 offen lds
    s_add_u32 s22, s18, 7168
    s_add_u32 m0, s16, 33792
    s_nop 0
    buffer_load_dwordx4 v21, s[72:75], s22 offen lds
    s_add_u32 s22, s18, 14336
    s_add_u32 m0, s16, 34816
    s_nop 0
    buffer_load_dwordx4 v21, s[72:75], s22 offen lds
    s_add_u32 s22, s18, 21504
    s_add_u32 m0, s16, 35840
    s_nop 0
    buffer_load_dwordx4 v21, s[72:75], s22 offen lds
    s_add_u32 s22, s18, 28672
    s_add_u32 m0, s16, 36864
    s_nop 0
    buffer_load_dwordx4 v21, s[72:75], s22 offen lds
    s_add_u32 s22, s18, 35840
    s_add_u32 m0, s16, 37888
    s_nop 0
    buffer_load_dwordx4 v21, s[72:75], s22 offen lds
    s_add_u32 s22, s18, 43008
    s_add_u32 m0, s16, 38912
    s_nop 0
    buffer_load_dwordx4 v21, s[72:75], s22 offen lds
    s_add_u32 s22, s18, 50176
    s_add_u32 m0, s16, 39936
    s_nop 0
    buffer_load_dwordx4 v21, s[72:75], s22 offen lds
    v_mfma_f32_16x16x32_bf16 v[124:127], v[224:227], v[52:55], v[124:127]
    s_waitcnt vmcnt(22)
    s_barrier
    ds_read_b64_tr_b16 v[240:241], v7 offset:16384
    ds_read_b64_tr_b16 v[242:243], v7 offset:17408
    s_waitcnt lgkmcnt(6)
    v_mfma_f32_16x16x32_bf16 v[128:131], v[228:231], v[48:51], v[128:131]
    ds_read_b64_tr_b16 v[244:245], v8 offset:16416
    v_mfma_f32_16x16x32_bf16 v[132:135], v[228:231], v[52:55], v[132:135]
    ds_read_b64_tr_b16 v[246:247], v8 offset:17440
    s_waitcnt lgkmcnt(6)
    v_mfma_f32_16x16x32_bf16 v[136:139], v[232:235], v[48:51], v[136:139]
    ds_read_b64_tr_b16 v[224:225], v7 offset:16640
    v_mfma_f32_16x16x32_bf16 v[140:143], v[232:235], v[52:55], v[140:143]
    ds_read_b64_tr_b16 v[226:227], v7 offset:17664
    s_waitcnt lgkmcnt(6)
    v_mfma_f32_16x16x32_bf16 v[144:147], v[236:239], v[48:51], v[144:147]
    ds_read_b64_tr_b16 v[228:229], v8 offset:16672
    v_mfma_f32_16x16x32_bf16 v[148:151], v[236:239], v[52:55], v[148:151]
    ds_read_b64_tr_b16 v[230:231], v8 offset:17696
    s_waitcnt vmcnt(21) lgkmcnt(6)
    v_mfma_f32_16x16x32_bf16 v[88:91], v[240:243], v[56:59], v[88:91]
    ds_read_b64_tr_b16 v[232:233], v7 offset:16896
    s_waitcnt vmcnt(20)
    v_mfma_f32_16x16x32_bf16 v[92:95], v[240:243], v[60:63], v[92:95]
    ds_read_b64_tr_b16 v[234:235], v7 offset:17920
    s_waitcnt lgkmcnt(6)
    v_mfma_f32_16x16x32_bf16 v[96:99], v[244:247], v[56:59], v[96:99]
    ds_read_b64_tr_b16 v[236:237], v8 offset:16928
    v_mfma_f32_16x16x32_bf16 v[100:103], v[244:247], v[60:63], v[100:103]
    ds_read_b64_tr_b16 v[238:239], v8 offset:17952
    s_waitcnt lgkmcnt(6)
    v_mfma_f32_16x16x32_bf16 v[104:107], v[224:227], v[56:59], v[104:107]
    ds_read_b64_tr_b16 v[240:241], v7 offset:17152
    v_mfma_f32_16x16x32_bf16 v[108:111], v[224:227], v[60:63], v[108:111]
    ds_read_b64_tr_b16 v[242:243], v7 offset:18176
    s_waitcnt lgkmcnt(6)
    v_mfma_f32_16x16x32_bf16 v[112:115], v[228:231], v[56:59], v[112:115]
    ds_read_b64_tr_b16 v[244:245], v8 offset:17184
    v_mfma_f32_16x16x32_bf16 v[116:119], v[228:231], v[60:63], v[116:119]
    ds_read_b64_tr_b16 v[246:247], v8 offset:18208
    s_waitcnt lgkmcnt(6)
    v_mfma_f32_16x16x32_bf16 v[120:123], v[232:235], v[56:59], v[120:123]
    v_mfma_f32_16x16x32_bf16 v[124:127], v[232:235], v[60:63], v[124:127]
    s_waitcnt vmcnt(18)
    s_barrier
    ds_read_b64_tr_b16 v[224:225], v4 offset:0
    ds_read_b64_tr_b16 v[226:227], v4 offset:1024
    s_waitcnt lgkmcnt(6)
    v_mfma_f32_16x16x32_bf16 v[128:131], v[236:239], v[56:59], v[128:131]
    ds_read_b64_tr_b16 v[228:229], v5 offset:32
    v_mfma_f32_16x16x32_bf16 v[132:135], v[236:239], v[60:63], v[132:135]
    ds_read_b64_tr_b16 v[230:231], v5 offset:1056
    s_waitcnt lgkmcnt(6)
    v_mfma_f32_16x16x32_bf16 v[136:139], v[240:243], v[56:59], v[136:139]
    ds_read_b64_tr_b16 v[232:233], v4 offset:256
    v_mfma_f32_16x16x32_bf16 v[140:143], v[240:243], v[60:63], v[140:143]
    ds_read_b64_tr_b16 v[234:235], v4 offset:1280
    s_waitcnt lgkmcnt(6)
    v_mfma_f32_16x16x32_bf16 v[144:147], v[244:247], v[56:59], v[144:147]
    ds_read_b64_tr_b16 v[236:237], v5 offset:288
    v_mfma_f32_16x16x32_bf16 v[148:151], v[244:247], v[60:63], v[148:151]
    ds_read_b64_tr_b16 v[238:239], v5 offset:1312
    s_waitcnt vmcnt(13) lgkmcnt(6)
    v_mfma_f32_16x16x32_bf16 v[88:91], v[224:227], v[24:27], v[88:91]
    ds_read_b64_tr_b16 v[240:241], v4 offset:512
    s_waitcnt vmcnt(12)
    v_mfma_f32_16x16x32_bf16 v[92:95], v[224:227], v[28:31], v[92:95]
    ds_read_b64_tr_b16 v[242:243], v4 offset:1536
    s_waitcnt lgkmcnt(6)
    v_mfma_f32_16x16x32_bf16 v[96:99], v[228:231], v[24:27], v[96:99]
    ds_read_b64_tr_b16 v[244:245], v5 offset:544
    v_mfma_f32_16x16x32_bf16 v[100:103], v[228:231], v[28:31], v[100:103]
    ds_read_b64_tr_b16 v[246:247], v5 offset:1568
    s_waitcnt lgkmcnt(6)
    v_mfma_f32_16x16x32_bf16 v[104:107], v[232:235], v[24:27], v[104:107]
    ds_read_b64_tr_b16 v[224:225], v4 offset:768
    v_mfma_f32_16x16x32_bf16 v[108:111], v[232:235], v[28:31], v[108:111]
    ds_read_b64_tr_b16 v[226:227], v4 offset:1792
    s_waitcnt lgkmcnt(6)
    v_mfma_f32_16x16x32_bf16 v[112:115], v[236:239], v[24:27], v[112:115]
    ds_read_b64_tr_b16 v[228:229], v5 offset:800
    v_mfma_f32_16x16x32_bf16 v[116:119], v[236:239], v[28:31], v[116:119]
    ds_read_b64_tr_b16 v[230:231], v5 offset:1824
    s_waitcnt lgkmcnt(6)
    v_mfma_f32_16x16x32_bf16 v[120:123], v[240:243], v[24:27], v[120:123]
    v_mfma_f32_16x16x32_bf16 v[124:127], v[240:243], v[28:31], v[124:127]
    s_waitcnt vmcnt(10)
    s_barrier
    ds_read_b64_tr_b16 v[232:233], v4 offset:16384
    ds_read_b64_tr_b16 v[234:235], v4 offset:17408
    s_waitcnt lgkmcnt(6)
    v_mfma_f32_16x16x32_bf16 v[128:131], v[244:247], v[24:27], v[128:131]
    ds_read_b64_tr_b16 v[236:237], v5 offset:16416
    v_mfma_f32_16x16x32_bf16 v[132:135], v[244:247], v[28:31], v[132:135]
    ds_read_b64_tr_b16 v[238:239], v5 offset:17440
    s_waitcnt lgkmcnt(6)
    v_mfma_f32_16x16x32_bf16 v[136:139], v[224:227], v[24:27], v[136:139]
    ds_read_b64_tr_b16 v[240:241], v4 offset:16640
    v_mfma_f32_16x16x32_bf16 v[140:143], v[224:227], v[28:31], v[140:143]
    ds_read_b64_tr_b16 v[242:243], v4 offset:17664
    s_waitcnt lgkmcnt(6)
    v_mfma_f32_16x16x32_bf16 v[144:147], v[228:231], v[24:27], v[144:147]
    ds_read_b64_tr_b16 v[244:245], v5 offset:16672
    v_mfma_f32_16x16x32_bf16 v[148:151], v[228:231], v[28:31], v[148:151]
    ds_read_b64_tr_b16 v[246:247], v5 offset:17696
    s_waitcnt vmcnt(9) lgkmcnt(6)
    v_mfma_f32_16x16x32_bf16 v[88:91], v[232:235], v[32:35], v[88:91]
    ds_read_b64_tr_b16 v[224:225], v4 offset:16896
    s_waitcnt vmcnt(8)
    v_mfma_f32_16x16x32_bf16 v[92:95], v[232:235], v[36:39], v[92:95]
    ds_read_b64_tr_b16 v[226:227], v4 offset:17920
    s_waitcnt lgkmcnt(6)
    v_mfma_f32_16x16x32_bf16 v[96:99], v[236:239], v[32:35], v[96:99]
    ds_read_b64_tr_b16 v[228:229], v5 offset:16928
    v_mfma_f32_16x16x32_bf16 v[100:103], v[236:239], v[36:39], v[100:103]
    ds_read_b64_tr_b16 v[230:231], v5 offset:17952
    s_waitcnt lgkmcnt(6)
    v_mfma_f32_16x16x32_bf16 v[104:107], v[240:243], v[32:35], v[104:107]
    ds_read_b64_tr_b16 v[232:233], v4 offset:17152
    v_mfma_f32_16x16x32_bf16 v[108:111], v[240:243], v[36:39], v[108:111]
    ds_read_b64_tr_b16 v[234:235], v4 offset:18176
    s_waitcnt lgkmcnt(6)
    v_mfma_f32_16x16x32_bf16 v[112:115], v[244:247], v[32:35], v[112:115]
    ds_read_b64_tr_b16 v[236:237], v5 offset:17184
    v_mfma_f32_16x16x32_bf16 v[116:119], v[244:247], v[36:39], v[116:119]
    ds_read_b64_tr_b16 v[238:239], v5 offset:18208
    s_waitcnt lgkmcnt(6)
    v_mfma_f32_16x16x32_bf16 v[120:123], v[224:227], v[32:35], v[120:123]
    v_mfma_f32_16x16x32_bf16 v[124:127], v[224:227], v[36:39], v[124:127]
    s_waitcnt lgkmcnt(4)
    v_mfma_f32_16x16x32_bf16 v[128:131], v[228:231], v[32:35], v[128:131]
    v_mfma_f32_16x16x32_bf16 v[132:135], v[228:231], v[36:39], v[132:135]
    s_waitcnt lgkmcnt(2)
    v_mfma_f32_16x16x32_bf16 v[136:139], v[232:235], v[32:35], v[136:139]
    v_mfma_f32_16x16x32_bf16 v[140:143], v[232:235], v[36:39], v[140:143]
    s_waitcnt lgkmcnt(0)
    v_mfma_f32_16x16x32_bf16 v[144:147], v[236:239], v[32:35], v[144:147]
    v_mfma_f32_16x16x32_bf16 v[148:151], v[236:239], v[36:39], v[148:151]
    s_lshl_b32 s16, s3, 13
    s_xor_b32 s17, s16, 0x8000
    s_add_u32 s16, s16, 0x18000
    s_add_u32 s17, s17, 0x18000
    v_add_u32 v16, s16, v2
    s_mov_b32 s16, s17
    v_add_u32 v17, s16, v2
    ds_write_b128 v16, v[88:91] offset:0
    ds_write_b128 v16, v[92:95] offset:1024
    ds_write_b128 v16, v[96:99] offset:2048
    ds_write_b128 v16, v[100:103] offset:3072
    ds_write_b128 v16, v[104:107] offset:4096
    ds_write_b128 v16, v[108:111] offset:5120
    ds_write_b128 v16, v[112:115] offset:6144
    ds_write_b128 v16, v[116:119] offset:7168
    v_lshlrev_b32 v24, 16, v248
    v_and_b32 v25, 0xffff0000, v248
    v_lshlrev_b32 v26, 16, v249
    v_and_b32 v27, 0xffff0000, v249
    v_lshlrev_b32 v28, 16, v250
    v_and_b32 v29, 0xffff0000, v250
    v_lshlrev_b32 v30, 16, v251
    v_and_b32 v31, 0xffff0000, v251
    v_lshlrev_b32 v32, 16, v252
    v_and_b32 v33, 0xffff0000, v252
    v_lshlrev_b32 v34, 16, v253
    v_and_b32 v35, 0xffff0000, v253
    v_lshlrev_b32 v36, 16, v254
    v_and_b32 v37, 0xffff0000, v254
    v_lshlrev_b32 v38, 16, v255
    v_and_b32 v39, 0xffff0000, v255
    v_and_b32 v18, 15, v1
    v_lshlrev_b32 v18, 6, v18
    v_lshrrev_b32 v19, 4, v1
    v_and_b32 v20, 1, v19
    v_lshl_add_u32 v18, v20, 5, v18
    v_lshrrev_b32 v19, 1, v19
    v_lshl_add_u32 v18, v19, 4, v18
    s_and_b32 s17, s3, 3
    s_lshl_b32 s18, s30, 2
    s_add_u32 s18, s18, s17
    s_lshl_b32 s18, s18, 16
    s_lshl_b32 s19, s15, 22
    s_add_u32 s18, s18, s19
    s_lshl_b32 s19, s31, 12
    s_add_u32 s18, s18, s19
    s_add_u32 s18, s18, 0x2000800
    s_add_u32 s19, s18, 32768
    s_waitcnt lgkmcnt(0)
    s_barrier
    ds_read_b128 v[40:43], v17 offset:0
    ds_read_b128 v[44:47], v17 offset:1024
    ds_read_b128 v[48:51], v17 offset:2048
    ds_read_b128 v[52:55], v17 offset:3072
    ds_read_b128 v[56:59], v17 offset:4096
    ds_read_b128 v[60:63], v17 offset:5120
    ds_read_b128 v[64:67], v17 offset:6144
    ds_read_b128 v[68:71], v17 offset:7168
    s_waitcnt lgkmcnt(7)
    v_pk_add_f32 v[120:121], v[120:121], v[40:41]
    v_pk_add_f32 v[122:123], v[122:123], v[42:43]
    v_pk_mul_f32 v[120:121], v[120:121], v[24:25]
    v_pk_mul_f32 v[122:123], v[122:123], v[26:27]
    v_cvt_pk_bf16_f32 v224, v120, v121
    v_cvt_pk_bf16_f32 v225, v122, v123
    s_waitcnt lgkmcnt(5)
    v_pk_add_f32 v[128:129], v[128:129], v[48:49]
    v_pk_add_f32 v[130:131], v[130:131], v[50:51]
    v_pk_mul_f32 v[128:129], v[128:129], v[28:29]
    v_pk_mul_f32 v[130:131], v[130:131], v[30:31]
    v_cvt_pk_bf16_f32 v226, v128, v129
    v_cvt_pk_bf16_f32 v227, v130, v131
    s_nop 0
    v_permlane16_swap_b32 v224, v226
    v_permlane16_swap_b32 v225, v227
    buffer_store_dwordx4 v[224:227], v18, s[8:11], s18 offen offset:0 sc1
    v_pk_add_f32 v[124:125], v[124:125], v[44:45]
    v_pk_add_f32 v[126:127], v[126:127], v[46:47]
    v_pk_mul_f32 v[124:125], v[124:125], v[24:25]
    v_pk_mul_f32 v[126:127], v[126:127], v[26:27]
    v_cvt_pk_bf16_f32 v228, v124, v125
    v_cvt_pk_bf16_f32 v229, v126, v127
    s_waitcnt lgkmcnt(4)
    v_pk_add_f32 v[132:133], v[132:133], v[52:53]
    v_pk_add_f32 v[134:135], v[134:135], v[54:55]
    v_pk_mul_f32 v[132:133], v[132:133], v[28:29]
    v_pk_mul_f32 v[134:135], v[134:135], v[30:31]
    v_cvt_pk_bf16_f32 v230, v132, v133
    v_cvt_pk_bf16_f32 v231, v134, v135
    s_nop 0
    v_permlane16_swap_b32 v228, v230
    v_permlane16_swap_b32 v229, v231
    buffer_store_dwordx4 v[228:231], v18, s[8:11], s19 offen offset:0 sc1
    s_waitcnt lgkmcnt(3)
    v_pk_add_f32 v[136:137], v[136:137], v[56:57]
    v_pk_add_f32 v[138:139], v[138:139], v[58:59]
    v_pk_mul_f32 v[136:137], v[136:137], v[32:33]
    v_pk_mul_f32 v[138:139], v[138:139], v[34:35]
    v_cvt_pk_bf16_f32 v232, v136, v137
    v_cvt_pk_bf16_f32 v233, v138, v139
    s_waitcnt lgkmcnt(1)
    v_pk_add_f32 v[144:145], v[144:145], v[64:65]
    v_pk_add_f32 v[146:147], v[146:147], v[66:67]
    v_pk_mul_f32 v[144:145], v[144:145], v[36:37]
    v_pk_mul_f32 v[146:147], v[146:147], v[38:39]
    v_cvt_pk_bf16_f32 v234, v144, v145
    v_cvt_pk_bf16_f32 v235, v146, v147
    s_nop 0
    v_permlane16_swap_b32 v232, v234
    v_permlane16_swap_b32 v233, v235
    buffer_store_dwordx4 v[232:235], v18, s[8:11], s18 offen offset:1024 sc1
    v_pk_add_f32 v[140:141], v[140:141], v[60:61]
    v_pk_add_f32 v[142:143], v[142:143], v[62:63]
    v_pk_mul_f32 v[140:141], v[140:141], v[32:33]
    v_pk_mul_f32 v[142:143], v[142:143], v[34:35]
    v_cvt_pk_bf16_f32 v236, v140, v141
    v_cvt_pk_bf16_f32 v237, v142, v143
    s_waitcnt lgkmcnt(0)
    v_pk_add_f32 v[148:149], v[148:149], v[68:69]
    v_pk_add_f32 v[150:151], v[150:151], v[70:71]
    v_pk_mul_f32 v[148:149], v[148:149], v[36:37]
    v_pk_mul_f32 v[150:151], v[150:151], v[38:39]
    v_cvt_pk_bf16_f32 v238, v148, v149
    v_cvt_pk_bf16_f32 v239, v150, v151
    s_nop 0
    v_permlane16_swap_b32 v236, v238
    v_permlane16_swap_b32 v237, v239
    buffer_store_dwordx4 v[236:239], v18, s[8:11], s19 offen offset:1024 sc1
    s_mov_b64 s[64:65], s[44:45]
    s_mov_b32 s66, 0x800
    s_mov_b32 s67, 0x20000
    s_mov_b64 s[76:77], s[32:33]
    s_mov_b32 s78, 0x400000
    s_mov_b32 s79, 0x20000
    s_mov_b64 s[68:69], s[56:57]
    s_mov_b32 s70, 0x400000
    s_mov_b32 s71, 0x20000
    s_lshl_b32 s14, s31, 1
    s_add_u32 s14, s14, s15
    s_lshl_b32 s14, s14, 3
    s_add_u32 s14, s14, s3
    s_lshl_b32 s16, s30, 7
    s_add_u32 s14, s14, s16
    s_lshl_b32 s16, s14, 11
    buffer_load_dwordx4 v[216:219], v2, s[76:79], s16 offen offset:0
    buffer_load_dwordx4 v[220:223], v2, s[76:79], s16 offen offset:1024
    s_lshl_b32 s16, s3, 10
    s_add_u32 m0, s16, 81920
    s_add_u32 s17, s16, 0x540800
    s_cmp_lt_u32 s3, 6
    s_cselect_b32 s17, s17, 0x7ffffff0
    s_sub_u32 s23, s16, 6144
    s_cmp_ge_u32 s3, 6
    s_cselect_b32 s23, s23, 0x7ffffff0
    s_cbranch_scc1 adaLN_cond__sliding_block_cached__moe_arch_mod__prompt_kernel_mlw
    buffer_load_dwordx4 v2, s[8:11], s17 offen sc1 lds
    s_branch adaLN_cond__sliding_block_cached__moe_arch_mod__prompt_kernel_mlj
adaLN_cond__sliding_block_cached__moe_arch_mod__prompt_kernel_mlw:
    buffer_load_dwordx4 v2, s[64:67], s23 offen lds
adaLN_cond__sliding_block_cached__moe_arch_mod__prompt_kernel_mlj:
    s_lshl_b32 s16, s30, 5
    s_lshl_b32 s17, s31, 1
    s_add_u32 s16, s16, s17
    s_add_u32 s16, s16, s15
    s_lshl_b32 s16, s16, 2
    s_add_u32 s16, s16, 0x530000
    s_cmp_eq_u32 s3, 0
    s_cselect_b32 s16, s16, 0x7ffffff0
    v_mov_b32 v16, s28
    v_mov_b32 v17, 0
    s_lshr_b32 s18, s14, 4
    s_lshl_b32 s18, s18, 15
    s_and_b32 s19, s14, 15
    s_lshl_b32 s19, s19, 6
    s_add_u32 s18, s18, s19
    s_add_u32 s18, s18, 0x2000000
    s_add_u32 s19, s18, 16384
    v_lshrrev_b32 v18, 2, v1
    v_lshlrev_b32 v18, 10, v18
    v_and_b32 v19, 3, v1
    v_lshl_add_u32 v18, v19, 4, v18
    v_add_u32 v19, 0x400000, v18
    s_lshl_b32 s25, s30, 7
    s_add_u32 s25, s25, 0x530000
    v_and_b32 v20, 15, v1
    v_lshlrev_b32 v20, 2, v20
    s_waitcnt vmcnt(3)
    s_waitcnt vmcnt(0)
    s_barrier
    s_mov_b64 exec, 1
    buffer_store_dword v16, v17, s[8:11], s16 offen sc1
    s_mov_b64 exec, -1
    v_add_u32 v16, 81920, v2
    ds_read_b128 v[184:187], v16 offset:0
    ds_read_b128 v[188:191], v16 offset:1024
    ds_read_b128 v[192:195], v16 offset:2048
    ds_read_b128 v[196:199], v16 offset:3072
    ds_read_b128 v[200:203], v16 offset:4096
    ds_read_b128 v[204:207], v16 offset:5120
    ds_read_b128 v[208:211], v16 offset:6144
    ds_read_b128 v[212:215], v16 offset:7168
    v_mov_b32 v94, 0
    v_mov_b32 v95, 0
    s_waitcnt lgkmcnt(5)
    v_lshlrev_b32 v76, 16, v192
    v_and_b32 v77, 0xffff0000, v192
    s_waitcnt lgkmcnt(1)
    v_lshlrev_b32 v78, 16, v208
    v_and_b32 v79, 0xffff0000, v208
    v_pk_mul_f32 v[60:61], v[76:77], v[78:79]
    v_lshlrev_b32 v76, 16, v184
    v_and_b32 v77, 0xffff0000, v184
    v_fmac_f32 v94, v76, v78
    v_fmac_f32 v94, v77, v79
    v_add_f32 v95, v95, v60
    v_add_f32 v95, v95, v61
    v_lshlrev_b32 v76, 16, v193
    v_and_b32 v77, 0xffff0000, v193
    v_lshlrev_b32 v78, 16, v209
    v_and_b32 v79, 0xffff0000, v209
    v_pk_mul_f32 v[62:63], v[76:77], v[78:79]
    v_lshlrev_b32 v76, 16, v185
    v_and_b32 v77, 0xffff0000, v185
    v_fmac_f32 v94, v76, v78
    v_fmac_f32 v94, v77, v79
    v_add_f32 v95, v95, v62
    v_add_f32 v95, v95, v63
    v_lshlrev_b32 v76, 16, v194
    v_and_b32 v77, 0xffff0000, v194
    v_lshlrev_b32 v78, 16, v210
    v_and_b32 v79, 0xffff0000, v210
    v_pk_mul_f32 v[64:65], v[76:77], v[78:79]
    v_lshlrev_b32 v76, 16, v186
    v_and_b32 v77, 0xffff0000, v186
    v_fmac_f32 v94, v76, v78
    v_fmac_f32 v94, v77, v79
    v_add_f32 v95, v95, v64
    v_add_f32 v95, v95, v65
    v_lshlrev_b32 v76, 16, v195
    v_and_b32 v77, 0xffff0000, v195
    v_lshlrev_b32 v78, 16, v211
    v_and_b32 v79, 0xffff0000, v211
    v_pk_mul_f32 v[66:67], v[76:77], v[78:79]
    v_lshlrev_b32 v76, 16, v187
    v_and_b32 v77, 0xffff0000, v187
    v_fmac_f32 v94, v76, v78
    v_fmac_f32 v94, v77, v79
    v_add_f32 v95, v95, v66
    v_add_f32 v95, v95, v67
    v_lshlrev_b32 v76, 16, v196
    v_and_b32 v77, 0xffff0000, v196
    s_waitcnt lgkmcnt(0)
    v_lshlrev_b32 v78, 16, v212
    v_and_b32 v79, 0xffff0000, v212
    v_pk_mul_f32 v[68:69], v[76:77], v[78:79]
    v_lshlrev_b32 v76, 16, v188
    v_and_b32 v77, 0xffff0000, v188
    v_fmac_f32 v94, v76, v78
    v_fmac_f32 v94, v77, v79
    v_add_f32 v95, v95, v68
    v_add_f32 v95, v95, v69
    v_lshlrev_b32 v76, 16, v197
    v_and_b32 v77, 0xffff0000, v197
    v_lshlrev_b32 v78, 16, v213
    v_and_b32 v79, 0xffff0000, v213
    v_pk_mul_f32 v[70:71], v[76:77], v[78:79]
    v_lshlrev_b32 v76, 16, v189
    v_and_b32 v77, 0xffff0000, v189
    v_fmac_f32 v94, v76, v78
    v_fmac_f32 v94, v77, v79
    v_add_f32 v95, v95, v70
    v_add_f32 v95, v95, v71
    v_lshlrev_b32 v76, 16, v198
    v_and_b32 v77, 0xffff0000, v198
    v_lshlrev_b32 v78, 16, v214
    v_and_b32 v79, 0xffff0000, v214
    v_pk_mul_f32 v[72:73], v[76:77], v[78:79]
    v_lshlrev_b32 v76, 16, v190
    v_and_b32 v77, 0xffff0000, v190
    v_fmac_f32 v94, v76, v78
    v_fmac_f32 v94, v77, v79
    v_add_f32 v95, v95, v72
    v_add_f32 v95, v95, v73
    v_lshlrev_b32 v76, 16, v199
    v_and_b32 v77, 0xffff0000, v199
    v_lshlrev_b32 v78, 16, v215
    v_and_b32 v79, 0xffff0000, v215
    v_pk_mul_f32 v[74:75], v[76:77], v[78:79]
    v_lshlrev_b32 v76, 16, v191
    v_and_b32 v77, 0xffff0000, v191
    v_fmac_f32 v94, v76, v78
    v_fmac_f32 v94, v77, v79
    v_add_f32 v95, v95, v74
    v_add_f32 v95, v95, v75
    v_add_f32_dpp v94, v94, v94 row_ror:1 row_mask:0xf bank_mask:0xf
    s_nop 0
    v_add_f32_dpp v95, v95, v95 row_ror:1 row_mask:0xf bank_mask:0xf
    v_add_f32_dpp v94, v94, v94 row_ror:2 row_mask:0xf bank_mask:0xf
    s_nop 0
    v_add_f32_dpp v95, v95, v95 row_ror:2 row_mask:0xf bank_mask:0xf
    v_add_f32_dpp v94, v94, v94 row_ror:4 row_mask:0xf bank_mask:0xf
    s_nop 0
    v_add_f32_dpp v95, v95, v95 row_ror:4 row_mask:0xf bank_mask:0xf
    v_add_f32_dpp v94, v94, v94 row_ror:8 row_mask:0xf bank_mask:0xf
    s_nop 0
    v_add_f32_dpp v95, v95, v95 row_ror:8 row_mask:0xf bank_mask:0xf
    v_mov_b32 v76, v94
    s_nop 1
    v_permlane16_swap_b32 v94, v76
    v_add_f32 v94, v94, v76
    v_mov_b32 v77, v95
    s_nop 1
    v_permlane16_swap_b32 v95, v77
    v_add_f32 v95, v95, v77
    v_mov_b32 v76, v94
    s_nop 1
    v_permlane32_swap_b32 v94, v76
    v_add_f32 v94, v94, v76
    v_mov_b32 v77, v95
    s_nop 1
    v_permlane32_swap_b32 v95, v77
    v_add_f32 v95, v95, v77
    v_lshlrev_b32 v28, 16, v216
    v_and_b32 v29, 0xffff0000, v216
    v_lshlrev_b32 v30, 16, v217
    v_and_b32 v31, 0xffff0000, v217
    v_lshlrev_b32 v32, 16, v218
    v_and_b32 v33, 0xffff0000, v218
    v_lshlrev_b32 v34, 16, v219
    v_and_b32 v35, 0xffff0000, v219
    v_lshlrev_b32 v36, 16, v220
    v_and_b32 v37, 0xffff0000, v220
    v_lshlrev_b32 v38, 16, v221
    v_and_b32 v39, 0xffff0000, v221
    v_lshlrev_b32 v40, 16, v222
    v_and_b32 v41, 0xffff0000, v222
    v_lshlrev_b32 v42, 16, v223
    v_and_b32 v43, 0xffff0000, v223
    s_mov_b32 s27, 0
adaLN_cond__sliding_block_cached__moe_arch_mod__prompt_kernel_a22p:
    buffer_load_dword v76, v20, s[8:11], s25 offen sc1
    s_waitcnt vmcnt(0)
    v_cmp_ne_u32 vcc, s28, v76
    s_add_u32 s27, s27, 1
    s_cmp_ge_u32 s27, 65536
    s_cbranch_scc1 adaLN_cond__sliding_block_cached__moe_arch_mod__prompt_kernel_a22g
    s_cbranch_vccnz adaLN_cond__sliding_block_cached__moe_arch_mod__prompt_kernel_a22p
adaLN_cond__sliding_block_cached__moe_arch_mod__prompt_kernel_a22g:
    buffer_load_dwordx4 v[44:47], v18, s[8:11], s18 offen sc1
    buffer_load_dwordx4 v[52:55], v19, s[8:11], s18 offen sc1
    buffer_load_dwordx4 v[48:51], v18, s[8:11], s19 offen sc1
    buffer_load_dwordx4 v[56:59], v19, s[8:11], s19 offen sc1
    v_lshlrev_b32 v21, 2, v0
    s_mov_b32 s16, 0x540800
    buffer_load_dword v106, v21, s[8:11], s16 offen sc1
    buffer_load_dword v104, v21, s[8:11], s16 offen offset:2048 sc1
    s_waitcnt vmcnt(5)
    v_lshlrev_b32 v76, 16, v44
    v_and_b32 v77, 0xffff0000, v44
    s_waitcnt vmcnt(4)
    v_lshlrev_b32 v78, 16, v52
    v_and_b32 v79, 0xffff0000, v52
    v_pk_add_f32 v[76:77], v[76:77], v[78:79]
    v_pk_add_f32 v[28:29], v[28:29], v[76:77]
    v_cvt_pk_bf16_f32 v16, v28, v29
    v_lshlrev_b32 v28, 16, v16
    v_and_b32 v29, 0xffff0000, v16
    v_lshlrev_b32 v80, 16, v45
    v_and_b32 v81, 0xffff0000, v45
    v_lshlrev_b32 v82, 16, v53
    v_and_b32 v83, 0xffff0000, v53
    v_pk_add_f32 v[80:81], v[80:81], v[82:83]
    v_pk_add_f32 v[30:31], v[30:31], v[80:81]
    v_cvt_pk_bf16_f32 v17, v30, v31
    v_lshlrev_b32 v30, 16, v17
    v_and_b32 v31, 0xffff0000, v17
    v_lshlrev_b32 v76, 16, v46
    v_and_b32 v77, 0xffff0000, v46
    v_lshlrev_b32 v78, 16, v54
    v_and_b32 v79, 0xffff0000, v54
    v_pk_add_f32 v[76:77], v[76:77], v[78:79]
    v_pk_add_f32 v[32:33], v[32:33], v[76:77]
    v_cvt_pk_bf16_f32 v16, v32, v33
    v_lshlrev_b32 v32, 16, v16
    v_and_b32 v33, 0xffff0000, v16
    v_lshlrev_b32 v80, 16, v47
    v_and_b32 v81, 0xffff0000, v47
    v_lshlrev_b32 v82, 16, v55
    v_and_b32 v83, 0xffff0000, v55
    v_pk_add_f32 v[80:81], v[80:81], v[82:83]
    v_pk_add_f32 v[34:35], v[34:35], v[80:81]
    v_cvt_pk_bf16_f32 v17, v34, v35
    v_lshlrev_b32 v34, 16, v17
    v_and_b32 v35, 0xffff0000, v17
    s_waitcnt vmcnt(3)
    v_lshlrev_b32 v76, 16, v48
    v_and_b32 v77, 0xffff0000, v48
    s_waitcnt vmcnt(2)
    v_lshlrev_b32 v78, 16, v56
    v_and_b32 v79, 0xffff0000, v56
    v_pk_add_f32 v[76:77], v[76:77], v[78:79]
    v_pk_add_f32 v[36:37], v[36:37], v[76:77]
    v_cvt_pk_bf16_f32 v16, v36, v37
    v_lshlrev_b32 v36, 16, v16
    v_and_b32 v37, 0xffff0000, v16
    v_lshlrev_b32 v80, 16, v49
    v_and_b32 v81, 0xffff0000, v49
    v_lshlrev_b32 v82, 16, v57
    v_and_b32 v83, 0xffff0000, v57
    v_pk_add_f32 v[80:81], v[80:81], v[82:83]
    v_pk_add_f32 v[38:39], v[38:39], v[80:81]
    v_cvt_pk_bf16_f32 v17, v38, v39
    v_lshlrev_b32 v38, 16, v17
    v_and_b32 v39, 0xffff0000, v17
    v_lshlrev_b32 v76, 16, v50
    v_and_b32 v77, 0xffff0000, v50
    v_lshlrev_b32 v78, 16, v58
    v_and_b32 v79, 0xffff0000, v58
    v_pk_add_f32 v[76:77], v[76:77], v[78:79]
    v_pk_add_f32 v[40:41], v[40:41], v[76:77]
    v_cvt_pk_bf16_f32 v16, v40, v41
    v_lshlrev_b32 v40, 16, v16
    v_and_b32 v41, 0xffff0000, v16
    v_lshlrev_b32 v80, 16, v51
    v_and_b32 v81, 0xffff0000, v51
    v_lshlrev_b32 v82, 16, v59
    v_and_b32 v83, 0xffff0000, v59
    v_pk_add_f32 v[80:81], v[80:81], v[82:83]
    v_pk_add_f32 v[42:43], v[42:43], v[80:81]
    v_cvt_pk_bf16_f32 v17, v42, v43
    v_lshlrev_b32 v42, 16, v17
    v_and_b32 v43, 0xffff0000, v17
    v_pk_add_f32 v[76:77], v[28:29], v[30:31]
    v_pk_mul_f32 v[78:79], v[28:29], v[28:29]
    v_pk_mul_f32 v[80:81], v[28:29], v[60:61]
    v_pk_fma_f32 v[78:79], v[30:31], v[30:31], v[78:79]
    v_pk_fma_f32 v[80:81], v[30:31], v[62:63], v[80:81]
    v_pk_add_f32 v[76:77], v[76:77], v[32:33]
    v_pk_fma_f32 v[78:79], v[32:33], v[32:33], v[78:79]
    v_pk_fma_f32 v[80:81], v[32:33], v[64:65], v[80:81]
    v_pk_add_f32 v[76:77], v[76:77], v[34:35]
    v_pk_fma_f32 v[78:79], v[34:35], v[34:35], v[78:79]
    v_pk_fma_f32 v[80:81], v[34:35], v[66:67], v[80:81]
    v_pk_add_f32 v[76:77], v[76:77], v[36:37]
    v_pk_fma_f32 v[78:79], v[36:37], v[36:37], v[78:79]
    v_pk_fma_f32 v[80:81], v[36:37], v[68:69], v[80:81]
    v_pk_add_f32 v[76:77], v[76:77], v[38:39]
    v_pk_fma_f32 v[78:79], v[38:39], v[38:39], v[78:79]
    v_pk_fma_f32 v[80:81], v[38:39], v[70:71], v[80:81]
    v_pk_add_f32 v[76:77], v[76:77], v[40:41]
    v_pk_fma_f32 v[78:79], v[40:41], v[40:41], v[78:79]
    v_pk_fma_f32 v[80:81], v[40:41], v[72:73], v[80:81]
    v_pk_add_f32 v[76:77], v[76:77], v[42:43]
    v_pk_fma_f32 v[78:79], v[42:43], v[42:43], v[78:79]
    v_pk_fma_f32 v[80:81], v[42:43], v[74:75], v[80:81]
    v_add_f32 v96, v76, v77
    v_add_f32 v97, v78, v79
    v_add_f32 v98, v80, v81
    v_add_f32_dpp v96, v96, v96 row_ror:1 row_mask:0xf bank_mask:0xf
    v_add_f32_dpp v97, v97, v97 row_ror:1 row_mask:0xf bank_mask:0xf
    v_add_f32_dpp v98, v98, v98 row_ror:1 row_mask:0xf bank_mask:0xf
    v_add_f32_dpp v96, v96, v96 row_ror:2 row_mask:0xf bank_mask:0xf
    v_add_f32_dpp v97, v97, v97 row_ror:2 row_mask:0xf bank_mask:0xf
    v_add_f32_dpp v98, v98, v98 row_ror:2 row_mask:0xf bank_mask:0xf
    v_add_f32_dpp v96, v96, v96 row_ror:4 row_mask:0xf bank_mask:0xf
    v_add_f32_dpp v97, v97, v97 row_ror:4 row_mask:0xf bank_mask:0xf
    v_add_f32_dpp v98, v98, v98 row_ror:4 row_mask:0xf bank_mask:0xf
    v_add_f32_dpp v96, v96, v96 row_ror:8 row_mask:0xf bank_mask:0xf
    v_add_f32_dpp v97, v97, v97 row_ror:8 row_mask:0xf bank_mask:0xf
    v_add_f32_dpp v98, v98, v98 row_ror:8 row_mask:0xf bank_mask:0xf
    v_mov_b32 v76, v96
    s_nop 1
    v_permlane16_swap_b32 v96, v76
    v_add_f32 v96, v96, v76
    v_mov_b32 v77, v97
    s_nop 1
    v_permlane16_swap_b32 v97, v77
    v_add_f32 v97, v97, v77
    v_mov_b32 v78, v98
    s_nop 1
    v_permlane16_swap_b32 v98, v78
    v_add_f32 v98, v98, v78
    v_mov_b32 v76, v96
    s_nop 1
    v_permlane32_swap_b32 v96, v76
    v_add_f32 v96, v96, v76
    v_mov_b32 v77, v97
    s_nop 1
    v_permlane32_swap_b32 v97, v77
    v_add_f32 v97, v97, v77
    v_mov_b32 v78, v98
    s_nop 1
    v_permlane32_swap_b32 v98, v78
    v_add_f32 v98, v98, v78
    v_mul_f32 v96, 0x3a800000, v96
    v_mul_f32 v97, 0x3a800000, v97
    v_fma_f32 v97, -v96, v96, v97
    v_max_f32 v97, 0, v97
    v_fma_f32 v98, -v96, v95, v98
    v_add_f32 v76, 0x3727c5ac, v97
    v_rsq_f32 v76, v76
    s_nop 0
    v_fma_f32 v27, v98, v76, v94
    v_cvt_pk_bf16_f32 v96, v96, v96
    v_lshlrev_b32 v96, 16, v96
    v_cvt_pk_bf16_f32 v97, v97, v97
    v_lshlrev_b32 v97, 16, v97
    v_add_f32 v97, 0x3727c5ac, v97
    v_cvt_pk_bf16_f32 v97, v97, v97
    v_lshlrev_b32 v97, 16, v97
    v_sqrt_f32 v98, v97
    s_nop 0
    v_cvt_pk_bf16_f32 v98, v98, v98
    v_lshlrev_b32 v98, 16, v98
    v_rcp_f32 v99, v98
    v_mov_b32 v25, v96
    v_mov_b32 v26, v98
    v_ashrrev_i32 v16, 31, v27
    v_or_b32 v16, 0x80000000, v16
    v_xor_b32 v24, v27, v16
    v_and_b32 v24, 0xfffff800, v24
    v_max_u32 v24, 0x800, v24
    s_sub_u32 s16, 2047, s14
    v_or_b32 v24, s16, v24
    s_lshl_b32 s16, s3, 4
    s_add_u32 s16, s16, 65536
    v_mov_b32 v16, s16
    ds_write_b128 v16, v[24:27]
    s_waitcnt lgkmcnt(0)
    s_barrier
    v_and_b32 v16, 7, v1
    v_lshlrev_b32 v16, 4, v16
    v_add_u32 v16, 65536, v16
    ds_read_b32 v76, v16
    s_waitcnt lgkmcnt(0)
    v_mov_b32 v77, v76
    s_nop 1
    v_max_u32_dpp v77, v77, v77 row_ror:1 row_mask:0xf bank_mask:0xf
    s_nop 1
    v_max_u32_dpp v77, v77, v77 row_ror:2 row_mask:0xf bank_mask:0xf
    s_nop 1
    v_max_u32_dpp v77, v77, v77 row_ror:4 row_mask:0xf bank_mask:0xf
    v_cmp_eq_u32 vcc, v76, v77
    s_ff1_i32_b64 s16, vcc
    s_lshl_b32 s16, s16, 4
    s_add_u32 s16, s16, 65536
    v_mov_b32 v16, s16
    ds_read_b128 v[24:27], v16
    s_lshl_b32 s16, s2, 4
    s_add_u32 s16, s16, 0x6e0000
    s_cmp_eq_u32 s3, 0
    s_cselect_b32 s16, s16, 0x7ffffff0
    v_mov_b32 v17, 0
    s_mov_b64 exec, 1
    s_waitcnt lgkmcnt(0)
    buffer_store_dwordx4 v[24:27], v17, s[8:11], s16 offen sc1
    s_mov_b64 exec, -1
    s_mov_b64 s[72:73], s[50:51]
    s_mov_b32 s74, 0x700000
    s_mov_b32 s75, 0x20000
    s_cmp_lt_u32 s2, 224
    s_cselect_b32 s74, 7340032, 0
    s_lshl_b32 s17, s29, 4
    s_sub_u32 s16, s3, 4
    s_lshl_b32 s16, s16, 2
    s_add_u32 s16, s16, s17
    s_lshl_b32 s16, s16, 11
    s_add_u32 s17, s16, 0
    buffer_load_dwordx4 v[152:155], v2, s[72:75], s17 offen offset:0
    buffer_load_dwordx4 v[156:159], v2, s[72:75], s17 offen offset:1024
    s_add_u32 s17, s16, 2048
    buffer_load_dwordx4 v[160:163], v2, s[72:75], s17 offen offset:0
    buffer_load_dwordx4 v[164:167], v2, s[72:75], s17 offen offset:1024
    s_add_u32 s17, s16, 4096
    buffer_load_dwordx4 v[168:171], v2, s[72:75], s17 offen offset:0
    buffer_load_dwordx4 v[172:175], v2, s[72:75], s17 offen offset:1024
    s_add_u32 s17, s16, 6144
    buffer_load_dwordx4 v[176:179], v2, s[72:75], s17 offen offset:0
    buffer_load_dwordx4 v[180:183], v2, s[72:75], s17 offen offset:1024
    v_sub_f32 v44, v28, v96
    v_sub_f32 v45, v29, v96
    v_sub_f32 v46, v30, v96
    v_sub_f32 v47, v31, v96
    v_sub_f32 v48, v32, v96
    v_sub_f32 v49, v33, v96
    v_sub_f32 v50, v34, v96
    v_sub_f32 v51, v35, v96
    v_cvt_pk_bf16_f32 v16, v44, v45
    v_lshlrev_b32 v44, 16, v16
    v_and_b32 v45, 0xffff0000, v16
    v_cvt_pk_bf16_f32 v16, v46, v47
    v_lshlrev_b32 v46, 16, v16
    v_and_b32 v47, 0xffff0000, v16
    v_cvt_pk_bf16_f32 v16, v48, v49
    v_lshlrev_b32 v48, 16, v16
    v_and_b32 v49, 0xffff0000, v16
    v_cvt_pk_bf16_f32 v16, v50, v51
    v_lshlrev_b32 v50, 16, v16
    v_and_b32 v51, 0xffff0000, v16
    v_mul_f32 v52, v44, v99
    v_mul_f32 v53, v45, v99
    v_mul_f32 v54, v46, v99
    v_mul_f32 v55, v47, v99
    v_mul_f32 v56, v48, v99
    v_mul_f32 v57, v49, v99
    v_mul_f32 v58, v50, v99
    v_mul_f32 v59, v51, v99
    v_fma_f32 v44, -v52, v98, v44
    v_fma_f32 v45, -v53, v98, v45
    v_fma_f32 v46, -v54, v98, v46
    v_fma_f32 v47, -v55, v98, v47
    v_fma_f32 v48, -v56, v98, v48
    v_fma_f32 v49, -v57, v98, v49
    v_fma_f32 v50, -v58, v98, v50
    v_fma_f32 v51, -v59, v98, v51
    v_fma_f32 v44, v44, v99, v52
    v_fma_f32 v45, v45, v99, v53
    v_fma_f32 v46, v46, v99, v54
    v_fma_f32 v47, v47, v99, v55
    v_fma_f32 v48, v48, v99, v56
    v_fma_f32 v49, v49, v99, v57
    v_fma_f32 v50, v50, v99, v58
    v_fma_f32 v51, v51, v99, v59
    v_cvt_pk_bf16_f32 v16, v44, v45
    v_lshlrev_b32 v44, 16, v16
    v_and_b32 v45, 0xffff0000, v16
    v_cvt_pk_bf16_f32 v16, v46, v47
    v_lshlrev_b32 v46, 16, v16
    v_and_b32 v47, 0xffff0000, v16
    v_cvt_pk_bf16_f32 v16, v48, v49
    v_lshlrev_b32 v48, 16, v16
    v_and_b32 v49, 0xffff0000, v16
    v_cvt_pk_bf16_f32 v16, v50, v51
    v_lshlrev_b32 v50, 16, v16
    v_and_b32 v51, 0xffff0000, v16
    v_lshlrev_b32 v52, 16, v192
    v_and_b32 v53, 0xffff0000, v192
    v_lshlrev_b32 v54, 16, v193
    v_and_b32 v55, 0xffff0000, v193
    v_lshlrev_b32 v56, 16, v194
    v_and_b32 v57, 0xffff0000, v194
    v_lshlrev_b32 v58, 16, v195
    v_and_b32 v59, 0xffff0000, v195
    v_pk_mul_f32 v[44:45], v[44:45], v[52:53]
    v_pk_mul_f32 v[46:47], v[46:47], v[54:55]
    v_pk_mul_f32 v[48:49], v[48:49], v[56:57]
    v_pk_mul_f32 v[50:51], v[50:51], v[58:59]
    v_cvt_pk_bf16_f32 v16, v44, v45
    v_lshlrev_b32 v44, 16, v16
    v_and_b32 v45, 0xffff0000, v16
    v_cvt_pk_bf16_f32 v16, v46, v47
    v_lshlrev_b32 v46, 16, v16
    v_and_b32 v47, 0xffff0000, v16
    v_cvt_pk_bf16_f32 v16, v48, v49
    v_lshlrev_b32 v48, 16, v16
    v_and_b32 v49, 0xffff0000, v16
    v_cvt_pk_bf16_f32 v16, v50, v51
    v_lshlrev_b32 v50, 16, v16
    v_and_b32 v51, 0xffff0000, v16
    v_lshlrev_b32 v52, 16, v184
    v_and_b32 v53, 0xffff0000, v184
    v_lshlrev_b32 v54, 16, v185
    v_and_b32 v55, 0xffff0000, v185
    v_lshlrev_b32 v56, 16, v186
    v_and_b32 v57, 0xffff0000, v186
    v_lshlrev_b32 v58, 16, v187
    v_and_b32 v59, 0xffff0000, v187
    v_pk_add_f32 v[44:45], v[44:45], v[52:53]
    v_pk_add_f32 v[46:47], v[46:47], v[54:55]
    v_pk_add_f32 v[48:49], v[48:49], v[56:57]
    v_pk_add_f32 v[50:51], v[50:51], v[58:59]
    v_cvt_pk_bf16_f32 v16, v44, v45
    v_lshlrev_b32 v44, 16, v16
    v_and_b32 v45, 0xffff0000, v16
    v_cvt_pk_bf16_f32 v16, v46, v47
    v_lshlrev_b32 v46, 16, v16
    v_and_b32 v47, 0xffff0000, v16
    v_cvt_pk_bf16_f32 v16, v48, v49
    v_lshlrev_b32 v48, 16, v16
    v_and_b32 v49, 0xffff0000, v16
    v_cvt_pk_bf16_f32 v16, v50, v51
    v_lshlrev_b32 v50, 16, v16
    v_and_b32 v51, 0xffff0000, v16
    v_lshlrev_b32 v52, 16, v200
    v_and_b32 v53, 0xffff0000, v200
    v_lshlrev_b32 v54, 16, v201
    v_and_b32 v55, 0xffff0000, v201
    v_lshlrev_b32 v56, 16, v202
    v_and_b32 v57, 0xffff0000, v202
    v_lshlrev_b32 v58, 16, v203
    v_and_b32 v59, 0xffff0000, v203
    v_pk_mul_f32 v[44:45], v[44:45], v[52:53]
    v_pk_mul_f32 v[46:47], v[46:47], v[54:55]
    v_pk_mul_f32 v[48:49], v[48:49], v[56:57]
    v_pk_mul_f32 v[50:51], v[50:51], v[58:59]
    v_cvt_pk_bf16_f32 v16, v44, v45
    v_lshlrev_b32 v44, 16, v16
    v_and_b32 v45, 0xffff0000, v16
    v_cvt_pk_bf16_f32 v16, v46, v47
    v_lshlrev_b32 v46, 16, v16
    v_and_b32 v47, 0xffff0000, v16
    v_cvt_pk_bf16_f32 v16, v48, v49
    v_lshlrev_b32 v48, 16, v16
    v_and_b32 v49, 0xffff0000, v16
    v_cvt_pk_bf16_f32 v16, v50, v51
    v_lshlrev_b32 v50, 16, v16
    v_and_b32 v51, 0xffff0000, v16
    v_pk_add_f32 v[44:45], v[44:45], v[28:29]
    v_pk_add_f32 v[46:47], v[46:47], v[30:31]
    v_pk_add_f32 v[48:49], v[48:49], v[32:33]
    v_pk_add_f32 v[50:51], v[50:51], v[34:35]
    v_cvt_pk_bf16_f32 v28, v44, v45
    v_cvt_pk_bf16_f32 v29, v46, v47
    v_cvt_pk_bf16_f32 v30, v48, v49
    v_cvt_pk_bf16_f32 v31, v50, v51
    v_sub_f32 v44, v36, v96
    v_sub_f32 v45, v37, v96
    v_sub_f32 v46, v38, v96
    v_sub_f32 v47, v39, v96
    v_sub_f32 v48, v40, v96
    v_sub_f32 v49, v41, v96
    v_sub_f32 v50, v42, v96
    v_sub_f32 v51, v43, v96
    v_cvt_pk_bf16_f32 v16, v44, v45
    v_lshlrev_b32 v44, 16, v16
    v_and_b32 v45, 0xffff0000, v16
    v_cvt_pk_bf16_f32 v16, v46, v47
    v_lshlrev_b32 v46, 16, v16
    v_and_b32 v47, 0xffff0000, v16
    v_cvt_pk_bf16_f32 v16, v48, v49
    v_lshlrev_b32 v48, 16, v16
    v_and_b32 v49, 0xffff0000, v16
    v_cvt_pk_bf16_f32 v16, v50, v51
    v_lshlrev_b32 v50, 16, v16
    v_and_b32 v51, 0xffff0000, v16
    v_mul_f32 v52, v44, v99
    v_mul_f32 v53, v45, v99
    v_mul_f32 v54, v46, v99
    v_mul_f32 v55, v47, v99
    v_mul_f32 v56, v48, v99
    v_mul_f32 v57, v49, v99
    v_mul_f32 v58, v50, v99
    v_mul_f32 v59, v51, v99
    v_fma_f32 v44, -v52, v98, v44
    v_fma_f32 v45, -v53, v98, v45
    v_fma_f32 v46, -v54, v98, v46
    v_fma_f32 v47, -v55, v98, v47
    v_fma_f32 v48, -v56, v98, v48
    v_fma_f32 v49, -v57, v98, v49
    v_fma_f32 v50, -v58, v98, v50
    v_fma_f32 v51, -v59, v98, v51
    v_fma_f32 v44, v44, v99, v52
    v_fma_f32 v45, v45, v99, v53
    v_fma_f32 v46, v46, v99, v54
    v_fma_f32 v47, v47, v99, v55
    v_fma_f32 v48, v48, v99, v56
    v_fma_f32 v49, v49, v99, v57
    v_fma_f32 v50, v50, v99, v58
    v_fma_f32 v51, v51, v99, v59
    v_cvt_pk_bf16_f32 v16, v44, v45
    v_lshlrev_b32 v44, 16, v16
    v_and_b32 v45, 0xffff0000, v16
    v_cvt_pk_bf16_f32 v16, v46, v47
    v_lshlrev_b32 v46, 16, v16
    v_and_b32 v47, 0xffff0000, v16
    v_cvt_pk_bf16_f32 v16, v48, v49
    v_lshlrev_b32 v48, 16, v16
    v_and_b32 v49, 0xffff0000, v16
    v_cvt_pk_bf16_f32 v16, v50, v51
    v_lshlrev_b32 v50, 16, v16
    v_and_b32 v51, 0xffff0000, v16
    v_lshlrev_b32 v52, 16, v196
    v_and_b32 v53, 0xffff0000, v196
    v_lshlrev_b32 v54, 16, v197
    v_and_b32 v55, 0xffff0000, v197
    v_lshlrev_b32 v56, 16, v198
    v_and_b32 v57, 0xffff0000, v198
    v_lshlrev_b32 v58, 16, v199
    v_and_b32 v59, 0xffff0000, v199
    v_pk_mul_f32 v[44:45], v[44:45], v[52:53]
    v_pk_mul_f32 v[46:47], v[46:47], v[54:55]
    v_pk_mul_f32 v[48:49], v[48:49], v[56:57]
    v_pk_mul_f32 v[50:51], v[50:51], v[58:59]
    v_cvt_pk_bf16_f32 v16, v44, v45
    v_lshlrev_b32 v44, 16, v16
    v_and_b32 v45, 0xffff0000, v16
    v_cvt_pk_bf16_f32 v16, v46, v47
    v_lshlrev_b32 v46, 16, v16
    v_and_b32 v47, 0xffff0000, v16
    v_cvt_pk_bf16_f32 v16, v48, v49
    v_lshlrev_b32 v48, 16, v16
    v_and_b32 v49, 0xffff0000, v16
    v_cvt_pk_bf16_f32 v16, v50, v51
    v_lshlrev_b32 v50, 16, v16
    v_and_b32 v51, 0xffff0000, v16
    v_lshlrev_b32 v52, 16, v188
    v_and_b32 v53, 0xffff0000, v188
    v_lshlrev_b32 v54, 16, v189
    v_and_b32 v55, 0xffff0000, v189
    v_lshlrev_b32 v56, 16, v190
    v_and_b32 v57, 0xffff0000, v190
    v_lshlrev_b32 v58, 16, v191
    v_and_b32 v59, 0xffff0000, v191
    v_pk_add_f32 v[44:45], v[44:45], v[52:53]
    v_pk_add_f32 v[46:47], v[46:47], v[54:55]
    v_pk_add_f32 v[48:49], v[48:49], v[56:57]
    v_pk_add_f32 v[50:51], v[50:51], v[58:59]
    v_cvt_pk_bf16_f32 v16, v44, v45
    v_lshlrev_b32 v44, 16, v16
    v_and_b32 v45, 0xffff0000, v16
    v_cvt_pk_bf16_f32 v16, v46, v47
    v_lshlrev_b32 v46, 16, v16
    v_and_b32 v47, 0xffff0000, v16
    v_cvt_pk_bf16_f32 v16, v48, v49
    v_lshlrev_b32 v48, 16, v16
    v_and_b32 v49, 0xffff0000, v16
    v_cvt_pk_bf16_f32 v16, v50, v51
    v_lshlrev_b32 v50, 16, v16
    v_and_b32 v51, 0xffff0000, v16
    v_lshlrev_b32 v52, 16, v204
    v_and_b32 v53, 0xffff0000, v204
    v_lshlrev_b32 v54, 16, v205
    v_and_b32 v55, 0xffff0000, v205
    v_lshlrev_b32 v56, 16, v206
    v_and_b32 v57, 0xffff0000, v206
    v_lshlrev_b32 v58, 16, v207
    v_and_b32 v59, 0xffff0000, v207
    v_pk_mul_f32 v[44:45], v[44:45], v[52:53]
    v_pk_mul_f32 v[46:47], v[46:47], v[54:55]
    v_pk_mul_f32 v[48:49], v[48:49], v[56:57]
    v_pk_mul_f32 v[50:51], v[50:51], v[58:59]
    v_cvt_pk_bf16_f32 v16, v44, v45
    v_lshlrev_b32 v44, 16, v16
    v_and_b32 v45, 0xffff0000, v16
    v_cvt_pk_bf16_f32 v16, v46, v47
    v_lshlrev_b32 v46, 16, v16
    v_and_b32 v47, 0xffff0000, v16
    v_cvt_pk_bf16_f32 v16, v48, v49
    v_lshlrev_b32 v48, 16, v16
    v_and_b32 v49, 0xffff0000, v16
    v_cvt_pk_bf16_f32 v16, v50, v51
    v_lshlrev_b32 v50, 16, v16
    v_and_b32 v51, 0xffff0000, v16
    v_pk_add_f32 v[44:45], v[44:45], v[36:37]
    v_pk_add_f32 v[46:47], v[46:47], v[38:39]
    v_pk_add_f32 v[48:49], v[48:49], v[40:41]
    v_pk_add_f32 v[50:51], v[50:51], v[42:43]
    v_cvt_pk_bf16_f32 v36, v44, v45
    v_cvt_pk_bf16_f32 v37, v46, v47
    v_cvt_pk_bf16_f32 v38, v48, v49
    v_cvt_pk_bf16_f32 v39, v50, v51
    s_barrier
    v_and_b32 v16, 3, v1
    v_lshlrev_b32 v16, 4, v16
    v_add_u32 v16, 65792, v16
    ds_read_b32 v76, v16
    s_waitcnt lgkmcnt(0)
    v_mov_b32 v77, v76
    s_nop 1
    v_max_u32_dpp v77, v77, v77 row_ror:1 row_mask:0xf bank_mask:0xf
    s_nop 1
    v_max_u32_dpp v77, v77, v77 row_ror:2 row_mask:0xf bank_mask:0xf
    v_cmp_eq_u32 vcc, v76, v77
    s_ff1_i32_b64 s16, vcc
    s_lshl_b32 s16, s16, 4
    s_add_u32 s16, s16, 65792
    v_mov_b32 v16, s16
    ds_read_b128 v[24:27], v16
    s_waitcnt lgkmcnt(0)
    v_and_b32 v76, 0x7ff, v24
    v_sub_u32 v76, 2047, v76
    s_nop 0
    v_readfirstlane_b32 s12, v76
    v_rcp_f32 v103, v26
    s_lshr_b32 s18, s12, 4
    s_lshl_b32 s18, s18, 15
    s_and_b32 s19, s12, 15
    s_lshl_b32 s19, s19, 6
    s_add_u32 s18, s18, s19
    s_add_u32 s18, s18, 0x2000000
    s_add_u32 s19, s18, 0x400000
    v_lshrrev_b32 v18, 4, v0
    v_lshlrev_b32 v18, 10, v18
    v_and_b32 v19, 15, v0
    v_lshl_add_u32 v18, v19, 2, v18
    s_lshl_b32 s13, s12, 11
    buffer_load_dword v100, v18, s[8:11], s18 offen sc1
    buffer_load_dword v101, v18, s[8:11], s19 offen sc1
    buffer_load_dword v102, v21, s[76:79], s13 offen
    s_lshl_b32 s16, s14, 11
    s_cmp_lg_u32 s12, s14
    s_cselect_b32 s16, s16, 0x7ffffff0
    buffer_store_dwordx4 v[28:31], v2, s[68:71], s16 offen offset:0 sc1
    buffer_store_dwordx4 v[36:39], v2, s[68:71], s16 offen offset:1024 sc1
    s_lshl_b32 s16, s3, 13
    v_add_u32 v20, s16, v2
    s_waitcnt vmcnt(4)
    v_lshlrev_b32 v76, 16, v100
    v_and_b32 v77, 0xffff0000, v100
    s_waitcnt vmcnt(3)
    v_lshlrev_b32 v78, 16, v101
    v_and_b32 v79, 0xffff0000, v101
    v_pk_add_f32 v[76:77], v[76:77], v[78:79]
    s_waitcnt vmcnt(2)
    v_lshlrev_b32 v78, 16, v102
    v_and_b32 v79, 0xffff0000, v102
    v_pk_add_f32 v[92:93], v[78:79], v[76:77]
    v_cvt_pk_bf16_f32 v76, v92, v93
    v_lshlrev_b32 v92, 16, v76
    v_and_b32 v93, 0xffff0000, v76
    v_cvt_pk_bf16_f32 v100, v92, v93
    v_and_b32 v105, 0xffff0000, v104
    v_lshlrev_b32 v104, 16, v104
    v_and_b32 v107, 0xffff0000, v106
    v_lshlrev_b32 v106, 16, v106
    v_sub_f32 v92, v92, v25
    v_sub_f32 v93, v93, v25
    v_cvt_pk_bf16_f32 v76, v92, v93
    v_lshlrev_b32 v92, 16, v76
    v_and_b32 v93, 0xffff0000, v76
    v_mul_f32 v77, v92, v103
    v_fma_f32 v92, -v77, v26, v92
    v_fma_f32 v92, v92, v103, v77
    v_mul_f32 v77, v93, v103
    v_fma_f32 v93, -v77, v26, v93
    v_fma_f32 v93, v93, v103, v77
    v_cvt_pk_bf16_f32 v76, v92, v93
    v_lshlrev_b32 v92, 16, v76
    v_and_b32 v93, 0xffff0000, v76
    v_mul_f32 v92, v92, v104
    v_mul_f32 v93, v93, v105
    v_cvt_pk_bf16_f32 v76, v92, v93
    v_lshlrev_b32 v92, 16, v76
    v_and_b32 v93, 0xffff0000, v76
    v_add_f32 v92, v92, v106
    v_add_f32 v93, v93, v107
    v_cvt_pk_bf16_f32 v101, v92, v93
    v_add_u32 v16, 66560, v21
    ds_write_b32 v16, v101
    ds_write_b32 v16, v100 offset:2048
    s_waitcnt lgkmcnt(0)
    s_barrier
    ds_read_b128 v[60:63], v20 offset:0
    ds_read_b128 v[64:67], v20 offset:1024
    ds_read_b128 v[68:71], v20 offset:2048
    ds_read_b128 v[72:75], v20 offset:3072
    ds_read_b128 v[108:111], v20 offset:4096
    ds_read_b128 v[112:115], v20 offset:5120
    ds_read_b128 v[116:119], v20 offset:6144
    ds_read_b128 v[120:123], v20 offset:7168
    s_and_b32 s16, s3, 3
    s_lshl_b32 s16, s16, 7
    s_and_b32 s17, s29, 3
    s_lshl_b32 s17, s17, 9
    s_add_u32 s16, s16, s17
    s_add_u32 s16, s16, 66560
    v_lshrrev_b32 v16, 3, v1
    v_lshlrev_b32 v16, 4, v16
    v_add_u32 v16, s16, v16
    ds_read_b128 v[104:107], v16
    s_waitcnt lgkmcnt(0)
    v_lshlrev_b32 v76, 16, v104
    v_and_b32 v77, 0xffff, v104
    v_dot2_f32_bf16 v85, v60, v76, 0
    v_dot2_f32_bf16 v84, v60, v77, 0
    v_dot2_f32_bf16 v87, v61, v76, 0
    v_dot2_f32_bf16 v86, v61, v77, 0
    v_dot2_f32_bf16 v89, v62, v76, 0
    v_dot2_f32_bf16 v88, v62, v77, 0
    v_dot2_f32_bf16 v91, v63, v76, 0
    v_dot2_f32_bf16 v90, v63, v77, 0
    v_and_b32 v78, 0xffff0000, v104
    v_lshrrev_b32 v79, 16, v104
    v_dot2c_f32_bf16 v85, v64, v78
    v_dot2c_f32_bf16 v84, v64, v79
    v_dot2c_f32_bf16 v87, v65, v78
    v_dot2c_f32_bf16 v86, v65, v79
    v_dot2c_f32_bf16 v89, v66, v78
    v_dot2c_f32_bf16 v88, v66, v79
    v_dot2c_f32_bf16 v91, v67, v78
    v_dot2c_f32_bf16 v90, v67, v79
    v_lshlrev_b32 v80, 16, v105
    v_and_b32 v81, 0xffff, v105
    v_dot2c_f32_bf16 v85, v68, v80
    v_dot2c_f32_bf16 v84, v68, v81
    v_dot2c_f32_bf16 v87, v69, v80
    v_dot2c_f32_bf16 v86, v69, v81
    v_dot2c_f32_bf16 v89, v70, v80
    v_dot2c_f32_bf16 v88, v70, v81
    v_dot2c_f32_bf16 v91, v71, v80
    v_dot2c_f32_bf16 v90, v71, v81
    v_and_b32 v82, 0xffff0000, v105
    v_lshrrev_b32 v83, 16, v105
    v_dot2c_f32_bf16 v85, v72, v82
    v_dot2c_f32_bf16 v84, v72, v83
    v_dot2c_f32_bf16 v87, v73, v82
    v_dot2c_f32_bf16 v86, v73, v83
    v_dot2c_f32_bf16 v89, v74, v82
    v_dot2c_f32_bf16 v88, v74, v83
    v_dot2c_f32_bf16 v91, v75, v82
    v_dot2c_f32_bf16 v90, v75, v83
    v_lshlrev_b32 v76, 16, v106
    v_and_b32 v77, 0xffff, v106
    v_dot2c_f32_bf16 v85, v108, v76
    v_dot2c_f32_bf16 v84, v108, v77
    v_dot2c_f32_bf16 v87, v109, v76
    v_dot2c_f32_bf16 v86, v109, v77
    v_dot2c_f32_bf16 v89, v110, v76
    v_dot2c_f32_bf16 v88, v110, v77
    v_dot2c_f32_bf16 v91, v111, v76
    v_dot2c_f32_bf16 v90, v111, v77
    v_and_b32 v78, 0xffff0000, v106
    v_lshrrev_b32 v79, 16, v106
    v_dot2c_f32_bf16 v85, v112, v78
    v_dot2c_f32_bf16 v84, v112, v79
    v_dot2c_f32_bf16 v87, v113, v78
    v_dot2c_f32_bf16 v86, v113, v79
    v_dot2c_f32_bf16 v89, v114, v78
    v_dot2c_f32_bf16 v88, v114, v79
    v_dot2c_f32_bf16 v91, v115, v78
    v_dot2c_f32_bf16 v90, v115, v79
    v_lshlrev_b32 v80, 16, v107
    v_and_b32 v81, 0xffff, v107
    v_dot2c_f32_bf16 v85, v116, v80
    v_dot2c_f32_bf16 v84, v116, v81
    v_dot2c_f32_bf16 v87, v117, v80
    v_dot2c_f32_bf16 v86, v117, v81
    v_dot2c_f32_bf16 v89, v118, v80
    v_dot2c_f32_bf16 v88, v118, v81
    v_dot2c_f32_bf16 v91, v119, v80
    v_dot2c_f32_bf16 v90, v119, v81
    v_and_b32 v82, 0xffff0000, v107
    v_lshrrev_b32 v83, 16, v107
    v_dot2c_f32_bf16 v85, v120, v82
    v_dot2c_f32_bf16 v84, v120, v83
    v_dot2c_f32_bf16 v87, v121, v82
    v_dot2c_f32_bf16 v86, v121, v83
    v_dot2c_f32_bf16 v89, v122, v82
    v_dot2c_f32_bf16 v88, v122, v83
    v_dot2c_f32_bf16 v91, v123, v82
    v_dot2c_f32_bf16 v90, v123, v83
    s_nop 0
    v_permlane32_swap_b32 v84, v88
    v_permlane32_swap_b32 v85, v89
    v_permlane32_swap_b32 v86, v90
    v_permlane32_swap_b32 v87, v91
    v_add_f32 v84, v84, v88
    v_add_f32 v85, v85, v89
    v_add_f32 v86, v86, v90
    v_add_f32 v87, v87, v91
    s_nop 0
    v_permlane16_swap_b32 v84, v86
    v_permlane16_swap_b32 v85, v87
    v_add_f32 v84, v84, v86
    v_add_f32 v85, v85, v87
    s_nop 0
    v_add_f32_dpp v84, v84, v84 row_ror:8 row_mask:0xf bank_mask:0xf
    v_add_f32_dpp v85, v85, v85 row_ror:8 row_mask:0xf bank_mask:0xf
    v_and_b32 v16, 7, v1
    v_lshlrev_b32 v16, 5, v16
    v_lshrrev_b32 v17, 4, v1
    v_lshl_add_u32 v16, v17, 3, v16
    s_lshl_b32 s16, s3, 8
    s_add_u32 s16, s16, 70656
    v_add_u32 v16, s16, v16
    ds_write_b64 v16, v[84:85]
    s_lshr_b32 s16, s3, 2
    s_lshl_b32 s17, s16, 10
    s_add_u32 s17, s17, 70656
    v_lshlrev_b32 v17, 2, v1
    v_add_u32 v16, s17, v17
    s_and_b32 s17, s29, 3
    s_lshl_b32 s17, s17, 1
    s_add_u32 s17, s17, s16
    s_mul_i32 s17, s17, 14336
    s_lshr_b32 s16, s29, 2
    s_lshl_b32 s16, s16, 8
    s_add_u32 s17, s17, s16
    s_add_u32 s17, s17, 0x6e1000
    s_and_b32 s16, s3, 3
    s_cmp_eq_u32 s16, 0
    s_cselect_b32 s17, s17, 0x7ffffff0
    s_cmp_lt_u32 s2, 224
    s_cselect_b32 s17, s17, 0x7ffffff0
    s_waitcnt lgkmcnt(0)
    s_barrier
    ds_read_b32 v84, v16 offset:0
    ds_read_b32 v85, v16 offset:256
    ds_read_b32 v86, v16 offset:512
    ds_read_b32 v87, v16 offset:768
    s_waitcnt lgkmcnt(2)
    v_add_f32 v84, v84, v85
    s_waitcnt lgkmcnt(0)
    v_add_f32 v86, v86, v87
    v_add_f32 v84, v84, v86
    v_or_b32 v84, 1, v84
    buffer_store_dword v84, v17, s[8:11], s17 offen sc1
    v_lshrrev_b32 v16, 4, v1
    v_mul_u32_u24 v16, 28672, v16
    v_and_b32 v17, 15, v1
    v_lshl_add_u32 v16, v17, 2, v16
    s_lshl_b32 s16, s29, 6
    s_add_u32 s16, s16, 0x6e1000
    s_add_u32 s17, s16, 14336
    s_mov_b32 s27, 0
adaLN_cond__sliding_block_cached__moe_arch_mod__prompt_kernel_gu23p:
    buffer_load_dword v84, v16, s[8:11], s16 offen sc1
    buffer_load_dword v85, v16, s[8:11], s17 offen sc1
    s_waitcnt vmcnt(0)
    v_min_u32 v86, v84, v85
    v_cmp_eq_u32 vcc, 0, v86
    s_cmp_lt_u32 s2, 224
    s_cselect_b64 s[62:63], -1, 0
    s_and_b64 vcc, vcc, s[62:63]
    s_add_u32 s27, s27, 1
    s_cmp_ge_u32 s27, 65536
    s_cbranch_scc1 adaLN_cond__sliding_block_cached__moe_arch_mod__prompt_kernel_gu23g
    s_cbranch_vccnz adaLN_cond__sliding_block_cached__moe_arch_mod__prompt_kernel_gu23p
adaLN_cond__sliding_block_cached__moe_arch_mod__prompt_kernel_gu23g:
    v_mov_b32 v86, v84
    s_nop 1
    v_permlane16_swap_b32 v84, v86
    v_add_f32 v84, v84, v86
    v_mov_b32 v87, v85
    s_nop 1
    v_permlane16_swap_b32 v85, v87
    v_add_f32 v85, v85, v87
    v_mov_b32 v86, v84
    s_nop 1
    v_permlane32_swap_b32 v84, v86
    v_add_f32 v84, v84, v86
    v_mov_b32 v87, v85
    s_nop 1
    v_permlane32_swap_b32 v85, v87
    v_add_f32 v85, v85, v87
    v_cvt_pk_bf16_f32 v86, v84, v85
    v_lshlrev_b32 v84, 16, v86
    v_and_b32 v85, 0xffff0000, v86
    v_mul_f32 v86, 0xbfb8aa3b, v84
    v_exp_f32 v86, v86
    s_nop 0
    v_add_f32 v86, 1.0, v86
    v_rcp_f32 v86, v86
    s_nop 0
    v_mul_f32 v84, v84, v86
    v_cvt_pk_bf16_f32 v84, v84, v84
    v_lshlrev_b32 v84, 16, v84
    v_mul_f32 v84, v84, v85
    v_cvt_pk_bf16_f32 v84, v84, v84
    v_lshlrev_b32 v84, 16, v84
    s_sub_u32 s16, s3, 4
    s_lshl_b32 s16, s16, 2
    s_add_u32 s17, s16, 0
    v_readlane_b32 s20, v84, s17
    s_lshr_b32 s4, s20, 16
    s_add_u32 s17, s16, 1
    v_readlane_b32 s21, v84, s17
    s_lshr_b32 s5, s21, 16
    s_add_u32 s17, s16, 2
    v_readlane_b32 s22, v84, s17
    s_lshr_b32 s6, s22, 16
    s_add_u32 s17, s16, 3
    v_readlane_b32 s23, v84, s17
    s_lshr_b32 s7, s23, 16
    v_dot2_f32_bf16 v45, v152, s20, 0
    v_dot2_f32_bf16 v44, v152, s4, 0
    v_dot2_f32_bf16 v47, v153, s20, 0
    v_dot2_f32_bf16 v46, v153, s4, 0
    v_dot2_f32_bf16 v49, v154, s20, 0
    v_dot2_f32_bf16 v48, v154, s4, 0
    v_dot2_f32_bf16 v51, v155, s20, 0
    v_dot2_f32_bf16 v50, v155, s4, 0
    v_dot2_f32_bf16 v53, v156, s20, 0
    v_dot2_f32_bf16 v52, v156, s4, 0
    v_dot2_f32_bf16 v55, v157, s20, 0
    v_dot2_f32_bf16 v54, v157, s4, 0
    v_dot2_f32_bf16 v57, v158, s20, 0
    v_dot2_f32_bf16 v56, v158, s4, 0
    v_dot2_f32_bf16 v59, v159, s20, 0
    v_dot2_f32_bf16 v58, v159, s4, 0
    v_dot2c_f32_bf16 v45, s21, v160
    v_dot2c_f32_bf16 v44, s5, v160
    v_dot2c_f32_bf16 v47, s21, v161
    v_dot2c_f32_bf16 v46, s5, v161
    v_dot2c_f32_bf16 v49, s21, v162
    v_dot2c_f32_bf16 v48, s5, v162
    v_dot2c_f32_bf16 v51, s21, v163
    v_dot2c_f32_bf16 v50, s5, v163
    v_dot2c_f32_bf16 v53, s21, v164
    v_dot2c_f32_bf16 v52, s5, v164
    v_dot2c_f32_bf16 v55, s21, v165
    v_dot2c_f32_bf16 v54, s5, v165
    v_dot2c_f32_bf16 v57, s21, v166
    v_dot2c_f32_bf16 v56, s5, v166
    v_dot2c_f32_bf16 v59, s21, v167
    v_dot2c_f32_bf16 v58, s5, v167
    v_dot2c_f32_bf16 v45, s22, v168
    v_dot2c_f32_bf16 v44, s6, v168
    v_dot2c_f32_bf16 v47, s22, v169
    v_dot2c_f32_bf16 v46, s6, v169
    v_dot2c_f32_bf16 v49, s22, v170
    v_dot2c_f32_bf16 v48, s6, v170
    v_dot2c_f32_bf16 v51, s22, v171
    v_dot2c_f32_bf16 v50, s6, v171
    v_dot2c_f32_bf16 v53, s22, v172
    v_dot2c_f32_bf16 v52, s6, v172
    v_dot2c_f32_bf16 v55, s22, v173
    v_dot2c_f32_bf16 v54, s6, v173
    v_dot2c_f32_bf16 v57, s22, v174
    v_dot2c_f32_bf16 v56, s6, v174
    v_dot2c_f32_bf16 v59, s22, v175
    v_dot2c_f32_bf16 v58, s6, v175
    v_dot2c_f32_bf16 v45, s23, v176
    v_dot2c_f32_bf16 v44, s7, v176
    v_dot2c_f32_bf16 v47, s23, v177
    v_dot2c_f32_bf16 v46, s7, v177
    v_dot2c_f32_bf16 v49, s23, v178
    v_dot2c_f32_bf16 v48, s7, v178
    v_dot2c_f32_bf16 v51, s23, v179
    v_dot2c_f32_bf16 v50, s7, v179
    v_dot2c_f32_bf16 v53, s23, v180
    v_dot2c_f32_bf16 v52, s7, v180
    v_dot2c_f32_bf16 v55, s23, v181
    v_dot2c_f32_bf16 v54, s7, v181
    v_dot2c_f32_bf16 v57, s23, v182
    v_dot2c_f32_bf16 v56, s7, v182
    v_dot2c_f32_bf16 v59, s23, v183
    v_dot2c_f32_bf16 v58, s7, v183
    s_sub_u32 s16, s3, 4
    s_lshl_b32 s16, s16, 12
    s_add_u32 s16, s16, 73728
    v_lshlrev_b32 v16, 5, v1
    v_add_u32 v16, s16, v16
    ds_write_b128 v16, v[44:47] offset:0
    ds_write_b128 v16, v[48:51] offset:16
    ds_write_b128 v16, v[52:55] offset:2048
    ds_write_b128 v16, v[56:59] offset:2064
    s_waitcnt lgkmcnt(0)
    s_barrier
    v_lshlrev_b32 v16, 3, v0
    v_add_u32 v17, 73728, v16
    ds_read_b64 v[84:85], v17 offset:0
    ds_read_b64 v[86:87], v17 offset:4096
    ds_read_b64 v[88:89], v17 offset:8192
    ds_read_b64 v[90:91], v17 offset:12288
    s_waitcnt lgkmcnt(2)
    v_pk_add_f32 v[84:85], v[84:85], v[86:87]
    s_waitcnt lgkmcnt(0)
    v_pk_add_f32 v[88:89], v[88:89], v[90:91]
    v_pk_add_f32 v[84:85], v[84:85], v[88:89]
    v_or_b32 v84, 1, v84
    v_or_b32 v85, 1, v85
    s_lshl_b32 s16, s29, 12
    s_add_u32 s16, s16, 0x600000
    s_cmp_lt_u32 s2, 224
    s_cselect_b32 s16, s16, 0x7ffffff0
    buffer_store_dwordx2 v[84:85], v16, s[8:11], s16 offen sc1
    s_cmp_lt_u32 s2, 224
    s_cbranch_scc1 adaLN_cond__sliding_block_cached__moe_arch_mod__prompt_kernel_end
    s_sub_u32 s16, s2, 224
    s_lshl_b32 s17, s16, 7
    s_add_u32 s17, s17, 0x600000
    v_lshrrev_b32 v16, 3, v0
    v_lshlrev_b32 v16, 12, v16
    v_and_b32 v17, 7, v0
    v_lshl_add_u32 v16, v17, 4, v16
    v_cmp_gt_u32 vcc, 256, v0
    v_bfrev_b32 v17, -2
    s_nop 0
    v_cndmask_b32 v17, v17, v16, vcc
    v_mov_b32 v19, 0
    v_cndmask_b32 v18, 1, v19, vcc
    s_lshl_b32 s18, s16, 6
    v_and_b32 v19, 31, v1
    v_lshlrev_b32 v19, 1, v19
    v_add_u32 v19, s18, v19
    s_mov_b32 s19, 0x541800
    buffer_load_ushort v95, v19, s[8:11], s19 offen sc1
    v_add_u32 v20, 66560, v19
    ds_read_u16 v96, v20
    ds_read_u16 v97, v20 offset:2048
    v_mov_b32 v94, v27
    v_cvt_pk_bf16_f32 v94, v94, v94
    v_lshlrev_b32 v94, 16, v94
    v_mul_f32 v94, 0xbfb8aa3b, v94
    v_exp_f32 v94, v94
    s_nop 0
    v_add_f32 v94, 1.0, v94
    v_rcp_f32 v94, v94
    s_nop 0
    v_cvt_pk_bf16_f32 v94, v94, v94
    v_lshlrev_b32 v94, 16, v94
    s_waitcnt vmcnt(0)
    v_lshlrev_b32 v95, 16, v95
    s_waitcnt lgkmcnt(1)
    v_lshlrev_b32 v96, 16, v96
    s_waitcnt lgkmcnt(0)
    v_lshlrev_b32 v97, 16, v97
    s_mov_b32 s27, 0
adaLN_cond__sliding_block_cached__moe_arch_mod__prompt_kernel_y24p:
    s_add_u32 s19, s17, 0x0
    buffer_load_dwordx4 v[44:47], v16, s[8:11], s19 offen sc1
    s_add_u32 s19, s17, 0x40000
    buffer_load_dwordx4 v[48:51], v16, s[8:11], s19 offen sc1
    s_add_u32 s19, s17, 0x80000
    buffer_load_dwordx4 v[52:55], v16, s[8:11], s19 offen sc1
    s_add_u32 s19, s17, 0xc0000
    buffer_load_dwordx4 v[56:59], v17, s[8:11], s19 offen sc1
    s_waitcnt vmcnt(0)
    v_min3_u32 v98, v56, v57, v58
    v_min_u32 v98, v98, v59
    v_or_b32 v98, v98, v18
    v_min3_u32 v98, v98, v44, v45
    v_min3_u32 v98, v98, v46, v47
    v_min3_u32 v98, v98, v48, v49
    v_min3_u32 v98, v98, v50, v51
    v_min3_u32 v98, v98, v52, v53
    v_min3_u32 v98, v98, v54, v55
    v_cmp_eq_u32 vcc, 0, v98
    s_add_u32 s27, s27, 1
    s_cmp_ge_u32 s27, 65536
    s_cbranch_scc1 adaLN_cond__sliding_block_cached__moe_arch_mod__prompt_kernel_y24g
    s_cbranch_vccnz adaLN_cond__sliding_block_cached__moe_arch_mod__prompt_kernel_y24p
adaLN_cond__sliding_block_cached__moe_arch_mod__prompt_kernel_y24g:
    v_pk_add_f32 v[44:45], v[44:45], v[52:53]
    v_pk_add_f32 v[46:47], v[46:47], v[54:55]
    v_pk_add_f32 v[48:49], v[48:49], v[56:57]
    v_pk_add_f32 v[50:51], v[50:51], v[58:59]
    v_pk_add_f32 v[44:45], v[44:45], v[48:49]
    v_pk_add_f32 v[46:47], v[46:47], v[50:51]
    s_nop 0
    v_add_f32_dpp v44, v44, v44 row_ror:8 row_mask:0xf bank_mask:0xf
    v_add_f32_dpp v45, v45, v45 row_ror:8 row_mask:0xf bank_mask:0xf
    v_add_f32_dpp v46, v46, v46 row_ror:8 row_mask:0xf bank_mask:0xf
    v_add_f32_dpp v47, v47, v47 row_ror:8 row_mask:0xf bank_mask:0xf
    s_nop 0
    v_permlane32_swap_b32 v44, v46
    v_permlane32_swap_b32 v45, v47
    v_add_f32 v44, v44, v46
    v_add_f32 v45, v45, v47
    s_nop 1
    v_permlane16_swap_b32 v44, v45
    v_add_f32 v44, v44, v45
    v_and_b32 v16, 7, v1
    v_lshlrev_b32 v16, 4, v16
    v_lshrrev_b32 v17, 4, v1
    v_lshl_add_u32 v16, v17, 2, v16
    s_lshl_b32 s19, s3, 7
    s_add_u32 s19, s19, 91136
    v_add_u32 v16, s19, v16
    ds_write_b32 v16, v44
    v_and_b32 v16, 31, v1
    v_lshlrev_b32 v16, 2, v16
    v_add_u32 v16, 91136, v16
    s_waitcnt lgkmcnt(0)
    s_barrier
    s_cmp_lg_u32 s3, 0
    s_cbranch_scc1 adaLN_cond__sliding_block_cached__moe_arch_mod__prompt_kernel_end
    ds_read_b32 v44, v16 offset:0
    ds_read_b32 v45, v16 offset:128
    ds_read_b32 v46, v16 offset:256
    ds_read_b32 v47, v16 offset:384
    ds_read_b32 v48, v16 offset:512
    ds_read_b32 v49, v16 offset:640
    ds_read_b32 v50, v16 offset:768
    ds_read_b32 v51, v16 offset:896
    s_waitcnt lgkmcnt(3)
    v_add_f32 v44, v44, v48
    s_waitcnt lgkmcnt(2)
    v_add_f32 v45, v45, v49
    s_waitcnt lgkmcnt(1)
    v_add_f32 v46, v46, v50
    s_waitcnt lgkmcnt(0)
    v_add_f32 v47, v47, v51
    v_add_f32 v44, v44, v46
    v_add_f32 v45, v45, v47
    v_add_f32 v44, v44, v45
    v_cvt_pk_bf16_f32 v44, v44, v44
    v_lshlrev_b32 v44, 16, v44
    v_mul_f32 v44, v44, v94
    v_cvt_pk_bf16_f32 v44, v44, v44
    v_lshlrev_b32 v44, 16, v44
    v_add_f32 v44, v44, v96
    v_cvt_pk_bf16_f32 v44, v44, v44
    v_lshlrev_b32 v44, 16, v44
    v_mul_f32 v44, v44, v95
    v_cvt_pk_bf16_f32 v44, v44, v44
    v_lshlrev_b32 v44, 16, v44
    v_add_f32 v44, v44, v97
    v_cvt_pk_bf16_f32 v44, v44, v44
    s_mov_b64 exec, 0xffffffff
    buffer_store_short v44, v19, s[68:71], s13 offen sc1
adaLN_cond__sliding_block_cached__moe_arch_mod__prompt_kernel_end:
    s_endpgm
adaLN_cond__sliding_block_cached__moe_arch_mod__prompt_kernel_n1r:
    s_mov_b32 s27, 0
adaLN_cond__sliding_block_cached__moe_arch_mod__prompt_kernel_n1p:
    buffer_load_dword v134, v132, s[64:67], 0 offen sc1
    s_waitcnt vmcnt(0)
    v_cmp_eq_u32 vcc, 0, v134
    s_cmp_eq_u32 s3, 0
    s_cselect_b64 s[62:63], -1, 0
    s_and_b64 vcc, vcc, s[62:63]
    s_add_u32 s27, s27, 1
    s_cmp_ge_u32 s27, 65536
    s_cbranch_scc1 adaLN_cond__sliding_block_cached__moe_arch_mod__prompt_kernel_n1g
    s_cbranch_vccnz adaLN_cond__sliding_block_cached__moe_arch_mod__prompt_kernel_n1p
adaLN_cond__sliding_block_cached__moe_arch_mod__prompt_kernel_n1g:
    s_waitcnt vmcnt(0) lgkmcnt(0)
    s_nop 15
    s_nop 3
    s_branch adaLN_cond__sliding_block_cached__moe_arch_mod__prompt_kernel_n1b
adaLN_cond__sliding_block_cached__moe_arch_mod__prompt_kernel_kv4r:
    s_waitcnt vmcnt(0) lgkmcnt(0)
    s_nop 15
    s_nop 3
    s_mov_b32 s27, 0
adaLN_cond__sliding_block_cached__moe_arch_mod__prompt_kernel_kv4p:
    buffer_load_dwordx4 v[12:15], v21, s[8:11], s18 offen sc1
    s_waitcnt vmcnt(0)
    v_xor_b32 v8, s28, v12
    v_xor_b32 v20, s28, v13
    v_or_b32 v8, v8, v20
    v_xor_b32 v20, s28, v14
    v_or_b32 v8, v8, v20
    v_xor_b32 v20, s28, v15
    v_or_b32 v8, v8, v20
    v_cmp_ne_u32 vcc, 0, v8
    s_add_u32 s27, s27, 1
    s_cmp_ge_u32 s27, 65536
    s_cbranch_scc1 adaLN_cond__sliding_block_cached__moe_arch_mod__prompt_kernel_kv4g
    s_cbranch_vccnz adaLN_cond__sliding_block_cached__moe_arch_mod__prompt_kernel_kv4p
adaLN_cond__sliding_block_cached__moe_arch_mod__prompt_kernel_kv4g:
    s_waitcnt vmcnt(0) lgkmcnt(0)
    s_nop 15
    s_nop 3
    s_branch adaLN_cond__sliding_block_cached__moe_arch_mod__prompt_kernel_kv4b
adaLN_cond__sliding_block_cached__moe_arch_mod__prompt_kernel_fixA:
    s_waitcnt vmcnt(0) lgkmcnt(0)
    s_nop 15
    s_nop 3
    s_lshr_b32 s16, s12, 3
    s_lshl_b32 s16, s16, 17
    s_add_u32 s16, s16, 0x400000
    v_add_u32 v8, s16, v2
    v_mov_b32 v16, 0xff7fffff
    v_mov_b32 v17, 0xff7fffff
    s_mov_b32 s16, 0
adaLN_cond__sliding_block_cached__moe_arch_mod__prompt_kernel_fixAm:
    s_add_u32 s17, s16, 0
    buffer_load_dwordx4 v[200:203], v8, s[8:11], s17 offen offset:0
    buffer_load_dwordx4 v[204:207], v8, s[8:11], s17 offen offset:1024
    buffer_load_dwordx4 v[208:211], v8, s[8:11], s17 offen offset:2048
    buffer_load_dwordx4 v[212:215], v8, s[8:11], s17 offen offset:3072
    s_waitcnt vmcnt(3)
    v_mfma_f32_16x16x32_bf16 v[184:187], v[200:203], v[152:155], 0
    v_mfma_f32_16x16x32_bf16 v[188:191], v[200:203], v[168:171], 0
    s_waitcnt vmcnt(2)
    v_mfma_f32_16x16x32_bf16 v[192:195], v[204:207], v[152:155], 0
    v_mfma_f32_16x16x32_bf16 v[196:199], v[204:207], v[168:171], 0
    s_waitcnt vmcnt(1)
    v_mfma_f32_16x16x32_bf16 v[184:187], v[208:211], v[156:159], v[184:187]
    v_mfma_f32_16x16x32_bf16 v[188:191], v[208:211], v[172:175], v[188:191]
    s_waitcnt vmcnt(0)
    v_mfma_f32_16x16x32_bf16 v[192:195], v[212:215], v[156:159], v[192:195]
    v_mfma_f32_16x16x32_bf16 v[196:199], v[212:215], v[172:175], v[196:199]
    s_add_u32 s17, s16, 4096
    buffer_load_dwordx4 v[200:203], v8, s[8:11], s17 offen offset:0
    buffer_load_dwordx4 v[204:207], v8, s[8:11], s17 offen offset:1024
    buffer_load_dwordx4 v[208:211], v8, s[8:11], s17 offen offset:2048
    buffer_load_dwordx4 v[212:215], v8, s[8:11], s17 offen offset:3072
    s_waitcnt vmcnt(3)
    v_mfma_f32_16x16x32_bf16 v[184:187], v[200:203], v[160:163], v[184:187]
    v_mfma_f32_16x16x32_bf16 v[188:191], v[200:203], v[176:179], v[188:191]
    s_waitcnt vmcnt(2)
    v_mfma_f32_16x16x32_bf16 v[192:195], v[204:207], v[160:163], v[192:195]
    v_mfma_f32_16x16x32_bf16 v[196:199], v[204:207], v[176:179], v[196:199]
    s_waitcnt vmcnt(1)
    v_mfma_f32_16x16x32_bf16 v[184:187], v[208:211], v[164:167], v[184:187]
    v_mfma_f32_16x16x32_bf16 v[188:191], v[208:211], v[180:183], v[188:191]
    s_waitcnt vmcnt(0)
    v_mfma_f32_16x16x32_bf16 v[192:195], v[212:215], v[164:167], v[192:195]
    v_mfma_f32_16x16x32_bf16 v[196:199], v[212:215], v[180:183], v[196:199]
    s_nop 3
    v_max3_f32 v16, v16, v184, v185
    v_max3_f32 v16, v16, v186, v187
    v_max3_f32 v17, v17, v188, v189
    v_max3_f32 v17, v17, v190, v191
    v_max3_f32 v16, v16, v192, v193
    v_max3_f32 v16, v16, v194, v195
    v_max3_f32 v17, v17, v196, v197
    v_max3_f32 v17, v17, v198, v199
    s_add_u32 s16, s16, 8192
    s_cmp_lt_u32 s16, 0x20000
    s_cbranch_scc1 adaLN_cond__sliding_block_cached__moe_arch_mod__prompt_kernel_fixAm
    v_mov_b32 v18, v16
    v_mov_b32 v19, v17
    s_nop 0
    v_permlane16_swap_b32 v16, v18
    v_permlane16_swap_b32 v17, v19
    v_max_f32 v16, v16, v18
    v_max_f32 v17, v17, v19
    v_mov_b32 v18, v16
    v_mov_b32 v19, v17
    s_nop 0
    v_permlane32_swap_b32 v16, v18
    v_permlane32_swap_b32 v17, v19
    v_max_f32 v16, v16, v18
    v_max_f32 v17, v17, v19
    v_sub_f32 v216, 0, v16
    v_sub_f32 v217, 0, v16
    v_sub_f32 v218, 0, v16
    v_sub_f32 v219, 0, v16
    v_sub_f32 v220, 0, v17
    v_sub_f32 v221, 0, v17
    v_sub_f32 v222, 0, v17
    v_sub_f32 v223, 0, v17
    s_mov_b32 s17, 0x0
    buffer_load_dwordx4 v[200:203], v8, s[8:11], s17 offen offset:0
    buffer_load_dwordx4 v[204:207], v8, s[8:11], s17 offen offset:1024
    buffer_load_dwordx4 v[208:211], v8, s[8:11], s17 offen offset:2048
    buffer_load_dwordx4 v[212:215], v8, s[8:11], s17 offen offset:3072
    s_waitcnt vmcnt(3)
    v_mfma_f32_16x16x32_bf16 v[184:187], v[200:203], v[152:155], v[216:219]
    v_mfma_f32_16x16x32_bf16 v[188:191], v[200:203], v[168:171], v[220:223]
    s_waitcnt vmcnt(2)
    v_mfma_f32_16x16x32_bf16 v[192:195], v[204:207], v[152:155], v[216:219]
    v_mfma_f32_16x16x32_bf16 v[196:199], v[204:207], v[168:171], v[220:223]
    s_waitcnt vmcnt(1)
    v_mfma_f32_16x16x32_bf16 v[184:187], v[208:211], v[156:159], v[184:187]
    v_mfma_f32_16x16x32_bf16 v[188:191], v[208:211], v[172:175], v[188:191]
    s_waitcnt vmcnt(0)
    v_mfma_f32_16x16x32_bf16 v[192:195], v[212:215], v[156:159], v[192:195]
    v_mfma_f32_16x16x32_bf16 v[196:199], v[212:215], v[172:175], v[196:199]
    s_mov_b32 s17, 0x1000
    buffer_load_dwordx4 v[200:203], v8, s[8:11], s17 offen offset:0
    buffer_load_dwordx4 v[204:207], v8, s[8:11], s17 offen offset:1024
    buffer_load_dwordx4 v[208:211], v8, s[8:11], s17 offen offset:2048
    buffer_load_dwordx4 v[212:215], v8, s[8:11], s17 offen offset:3072
    s_waitcnt vmcnt(3)
    v_mfma_f32_16x16x32_bf16 v[184:187], v[200:203], v[160:163], v[184:187]
    v_mfma_f32_16x16x32_bf16 v[188:191], v[200:203], v[176:179], v[188:191]
    s_waitcnt vmcnt(2)
    v_mfma_f32_16x16x32_bf16 v[192:195], v[204:207], v[160:163], v[192:195]
    v_mfma_f32_16x16x32_bf16 v[196:199], v[204:207], v[176:179], v[196:199]
    s_waitcnt vmcnt(1)
    v_mfma_f32_16x16x32_bf16 v[184:187], v[208:211], v[164:167], v[184:187]
    v_mfma_f32_16x16x32_bf16 v[188:191], v[208:211], v[180:183], v[188:191]
    s_waitcnt vmcnt(0)
    v_mfma_f32_16x16x32_bf16 v[192:195], v[212:215], v[164:167], v[192:195]
    v_mfma_f32_16x16x32_bf16 v[196:199], v[212:215], v[180:183], v[196:199]
    s_nop 3
    v_exp_f32 v184, v184
    v_exp_f32 v185, v185
    s_nop 0
    v_add_f32 v9, v184, v185
    v_cvt_pk_bf16_f32 v24, v184, v185
    v_exp_f32 v186, v186
    v_exp_f32 v187, v187
    v_add_f32 v9, v9, v186
    v_add_f32 v9, v9, v187
    v_cvt_pk_bf16_f32 v25, v186, v187
    v_exp_f32 v188, v188
    v_exp_f32 v189, v189
    s_nop 0
    v_add_f32 v10, v188, v189
    v_cvt_pk_bf16_f32 v28, v188, v189
    v_exp_f32 v190, v190
    v_exp_f32 v191, v191
    v_add_f32 v10, v10, v190
    v_add_f32 v10, v10, v191
    v_cvt_pk_bf16_f32 v29, v190, v191
    v_exp_f32 v192, v192
    v_exp_f32 v193, v193
    v_add_f32 v9, v9, v192
    v_add_f32 v9, v9, v193
    v_cvt_pk_bf16_f32 v26, v192, v193
    v_exp_f32 v194, v194
    v_exp_f32 v195, v195
    v_add_f32 v9, v9, v194
    v_add_f32 v9, v9, v195
    v_cvt_pk_bf16_f32 v27, v194, v195
    v_exp_f32 v196, v196
    v_exp_f32 v197, v197
    v_add_f32 v10, v10, v196
    v_add_f32 v10, v10, v197
    v_cvt_pk_bf16_f32 v30, v196, v197
    v_exp_f32 v198, v198
    v_exp_f32 v199, v199
    v_add_f32 v10, v10, v198
    v_add_f32 v10, v10, v199
    v_cvt_pk_bf16_f32 v31, v198, v199
    s_mov_b32 s17, 0x2000
    buffer_load_dwordx4 v[200:203], v8, s[8:11], s17 offen offset:0
    buffer_load_dwordx4 v[204:207], v8, s[8:11], s17 offen offset:1024
    buffer_load_dwordx4 v[208:211], v8, s[8:11], s17 offen offset:2048
    buffer_load_dwordx4 v[212:215], v8, s[8:11], s17 offen offset:3072
    s_waitcnt vmcnt(3)
    v_mfma_f32_16x16x32_bf16 v[184:187], v[200:203], v[152:155], v[216:219]
    v_mfma_f32_16x16x32_bf16 v[188:191], v[200:203], v[168:171], v[220:223]
    s_waitcnt vmcnt(2)
    v_mfma_f32_16x16x32_bf16 v[192:195], v[204:207], v[152:155], v[216:219]
    v_mfma_f32_16x16x32_bf16 v[196:199], v[204:207], v[168:171], v[220:223]
    s_waitcnt vmcnt(1)
    v_mfma_f32_16x16x32_bf16 v[184:187], v[208:211], v[156:159], v[184:187]
    v_mfma_f32_16x16x32_bf16 v[188:191], v[208:211], v[172:175], v[188:191]
    s_waitcnt vmcnt(0)
    v_mfma_f32_16x16x32_bf16 v[192:195], v[212:215], v[156:159], v[192:195]
    v_mfma_f32_16x16x32_bf16 v[196:199], v[212:215], v[172:175], v[196:199]
    s_mov_b32 s17, 0x3000
    buffer_load_dwordx4 v[200:203], v8, s[8:11], s17 offen offset:0
    buffer_load_dwordx4 v[204:207], v8, s[8:11], s17 offen offset:1024
    buffer_load_dwordx4 v[208:211], v8, s[8:11], s17 offen offset:2048
    buffer_load_dwordx4 v[212:215], v8, s[8:11], s17 offen offset:3072
    s_waitcnt vmcnt(3)
    v_mfma_f32_16x16x32_bf16 v[184:187], v[200:203], v[160:163], v[184:187]
    v_mfma_f32_16x16x32_bf16 v[188:191], v[200:203], v[176:179], v[188:191]
    s_waitcnt vmcnt(2)
    v_mfma_f32_16x16x32_bf16 v[192:195], v[204:207], v[160:163], v[192:195]
    v_mfma_f32_16x16x32_bf16 v[196:199], v[204:207], v[176:179], v[196:199]
    s_waitcnt vmcnt(1)
    v_mfma_f32_16x16x32_bf16 v[184:187], v[208:211], v[164:167], v[184:187]
    v_mfma_f32_16x16x32_bf16 v[188:191], v[208:211], v[180:183], v[188:191]
    s_waitcnt vmcnt(0)
    v_mfma_f32_16x16x32_bf16 v[192:195], v[212:215], v[164:167], v[192:195]
    v_mfma_f32_16x16x32_bf16 v[196:199], v[212:215], v[180:183], v[196:199]
    s_nop 3
    v_exp_f32 v184, v184
    v_exp_f32 v185, v185
    v_add_f32 v9, v9, v184
    v_add_f32 v9, v9, v185
    v_cvt_pk_bf16_f32 v32, v184, v185
    v_exp_f32 v186, v186
    v_exp_f32 v187, v187
    v_add_f32 v9, v9, v186
    v_add_f32 v9, v9, v187
    v_cvt_pk_bf16_f32 v33, v186, v187
    v_exp_f32 v188, v188
    v_exp_f32 v189, v189
    v_add_f32 v10, v10, v188
    v_add_f32 v10, v10, v189
    v_cvt_pk_bf16_f32 v36, v188, v189
    v_exp_f32 v190, v190
    v_exp_f32 v191, v191
    v_add_f32 v10, v10, v190
    v_add_f32 v10, v10, v191
    v_cvt_pk_bf16_f32 v37, v190, v191
    v_exp_f32 v192, v192
    v_exp_f32 v193, v193
    v_add_f32 v9, v9, v192
    v_add_f32 v9, v9, v193
    v_cvt_pk_bf16_f32 v34, v192, v193
    v_exp_f32 v194, v194
    v_exp_f32 v195, v195
    v_add_f32 v9, v9, v194
    v_add_f32 v9, v9, v195
    v_cvt_pk_bf16_f32 v35, v194, v195
    v_exp_f32 v196, v196
    v_exp_f32 v197, v197
    v_add_f32 v10, v10, v196
    v_add_f32 v10, v10, v197
    v_cvt_pk_bf16_f32 v38, v196, v197
    v_exp_f32 v198, v198
    v_exp_f32 v199, v199
    v_add_f32 v10, v10, v198
    v_add_f32 v10, v10, v199
    v_cvt_pk_bf16_f32 v39, v198, v199
    s_mov_b32 s17, 0x4000
    buffer_load_dwordx4 v[200:203], v8, s[8:11], s17 offen offset:0
    buffer_load_dwordx4 v[204:207], v8, s[8:11], s17 offen offset:1024
    buffer_load_dwordx4 v[208:211], v8, s[8:11], s17 offen offset:2048
    buffer_load_dwordx4 v[212:215], v8, s[8:11], s17 offen offset:3072
    s_waitcnt vmcnt(3)
    v_mfma_f32_16x16x32_bf16 v[184:187], v[200:203], v[152:155], v[216:219]
    v_mfma_f32_16x16x32_bf16 v[188:191], v[200:203], v[168:171], v[220:223]
    s_waitcnt vmcnt(2)
    v_mfma_f32_16x16x32_bf16 v[192:195], v[204:207], v[152:155], v[216:219]
    v_mfma_f32_16x16x32_bf16 v[196:199], v[204:207], v[168:171], v[220:223]
    s_waitcnt vmcnt(1)
    v_mfma_f32_16x16x32_bf16 v[184:187], v[208:211], v[156:159], v[184:187]
    v_mfma_f32_16x16x32_bf16 v[188:191], v[208:211], v[172:175], v[188:191]
    s_waitcnt vmcnt(0)
    v_mfma_f32_16x16x32_bf16 v[192:195], v[212:215], v[156:159], v[192:195]
    v_mfma_f32_16x16x32_bf16 v[196:199], v[212:215], v[172:175], v[196:199]
    s_mov_b32 s17, 0x5000
    buffer_load_dwordx4 v[200:203], v8, s[8:11], s17 offen offset:0
    buffer_load_dwordx4 v[204:207], v8, s[8:11], s17 offen offset:1024
    buffer_load_dwordx4 v[208:211], v8, s[8:11], s17 offen offset:2048
    buffer_load_dwordx4 v[212:215], v8, s[8:11], s17 offen offset:3072
    s_waitcnt vmcnt(3)
    v_mfma_f32_16x16x32_bf16 v[184:187], v[200:203], v[160:163], v[184:187]
    v_mfma_f32_16x16x32_bf16 v[188:191], v[200:203], v[176:179], v[188:191]
    s_waitcnt vmcnt(2)
    v_mfma_f32_16x16x32_bf16 v[192:195], v[204:207], v[160:163], v[192:195]
    v_mfma_f32_16x16x32_bf16 v[196:199], v[204:207], v[176:179], v[196:199]
    s_waitcnt vmcnt(1)
    v_mfma_f32_16x16x32_bf16 v[184:187], v[208:211], v[164:167], v[184:187]
    v_mfma_f32_16x16x32_bf16 v[188:191], v[208:211], v[180:183], v[188:191]
    s_waitcnt vmcnt(0)
    v_mfma_f32_16x16x32_bf16 v[192:195], v[212:215], v[164:167], v[192:195]
    v_mfma_f32_16x16x32_bf16 v[196:199], v[212:215], v[180:183], v[196:199]
    s_nop 3
    v_exp_f32 v184, v184
    v_exp_f32 v185, v185
    v_add_f32 v9, v9, v184
    v_add_f32 v9, v9, v185
    v_cvt_pk_bf16_f32 v40, v184, v185
    v_exp_f32 v186, v186
    v_exp_f32 v187, v187
    v_add_f32 v9, v9, v186
    v_add_f32 v9, v9, v187
    v_cvt_pk_bf16_f32 v41, v186, v187
    v_exp_f32 v188, v188
    v_exp_f32 v189, v189
    v_add_f32 v10, v10, v188
    v_add_f32 v10, v10, v189
    v_cvt_pk_bf16_f32 v44, v188, v189
    v_exp_f32 v190, v190
    v_exp_f32 v191, v191
    v_add_f32 v10, v10, v190
    v_add_f32 v10, v10, v191
    v_cvt_pk_bf16_f32 v45, v190, v191
    v_exp_f32 v192, v192
    v_exp_f32 v193, v193
    v_add_f32 v9, v9, v192
    v_add_f32 v9, v9, v193
    v_cvt_pk_bf16_f32 v42, v192, v193
    v_exp_f32 v194, v194
    v_exp_f32 v195, v195
    v_add_f32 v9, v9, v194
    v_add_f32 v9, v9, v195
    v_cvt_pk_bf16_f32 v43, v194, v195
    v_exp_f32 v196, v196
    v_exp_f32 v197, v197
    v_add_f32 v10, v10, v196
    v_add_f32 v10, v10, v197
    v_cvt_pk_bf16_f32 v46, v196, v197
    v_exp_f32 v198, v198
    v_exp_f32 v199, v199
    v_add_f32 v10, v10, v198
    v_add_f32 v10, v10, v199
    v_cvt_pk_bf16_f32 v47, v198, v199
    s_mov_b32 s17, 0x6000
    buffer_load_dwordx4 v[200:203], v8, s[8:11], s17 offen offset:0
    buffer_load_dwordx4 v[204:207], v8, s[8:11], s17 offen offset:1024
    buffer_load_dwordx4 v[208:211], v8, s[8:11], s17 offen offset:2048
    buffer_load_dwordx4 v[212:215], v8, s[8:11], s17 offen offset:3072
    s_waitcnt vmcnt(3)
    v_mfma_f32_16x16x32_bf16 v[184:187], v[200:203], v[152:155], v[216:219]
    v_mfma_f32_16x16x32_bf16 v[188:191], v[200:203], v[168:171], v[220:223]
    s_waitcnt vmcnt(2)
    v_mfma_f32_16x16x32_bf16 v[192:195], v[204:207], v[152:155], v[216:219]
    v_mfma_f32_16x16x32_bf16 v[196:199], v[204:207], v[168:171], v[220:223]
    s_waitcnt vmcnt(1)
    v_mfma_f32_16x16x32_bf16 v[184:187], v[208:211], v[156:159], v[184:187]
    v_mfma_f32_16x16x32_bf16 v[188:191], v[208:211], v[172:175], v[188:191]
    s_waitcnt vmcnt(0)
    v_mfma_f32_16x16x32_bf16 v[192:195], v[212:215], v[156:159], v[192:195]
    v_mfma_f32_16x16x32_bf16 v[196:199], v[212:215], v[172:175], v[196:199]
    s_mov_b32 s17, 0x7000
    buffer_load_dwordx4 v[200:203], v8, s[8:11], s17 offen offset:0
    buffer_load_dwordx4 v[204:207], v8, s[8:11], s17 offen offset:1024
    buffer_load_dwordx4 v[208:211], v8, s[8:11], s17 offen offset:2048
    buffer_load_dwordx4 v[212:215], v8, s[8:11], s17 offen offset:3072
    s_waitcnt vmcnt(3)
    v_mfma_f32_16x16x32_bf16 v[184:187], v[200:203], v[160:163], v[184:187]
    v_mfma_f32_16x16x32_bf16 v[188:191], v[200:203], v[176:179], v[188:191]
    s_waitcnt vmcnt(2)
    v_mfma_f32_16x16x32_bf16 v[192:195], v[204:207], v[160:163], v[192:195]
    v_mfma_f32_16x16x32_bf16 v[196:199], v[204:207], v[176:179], v[196:199]
    s_waitcnt vmcnt(1)
    v_mfma_f32_16x16x32_bf16 v[184:187], v[208:211], v[164:167], v[184:187]
    v_mfma_f32_16x16x32_bf16 v[188:191], v[208:211], v[180:183], v[188:191]
    s_waitcnt vmcnt(0)
    v_mfma_f32_16x16x32_bf16 v[192:195], v[212:215], v[164:167], v[192:195]
    v_mfma_f32_16x16x32_bf16 v[196:199], v[212:215], v[180:183], v[196:199]
    s_nop 3
    v_exp_f32 v184, v184
    v_exp_f32 v185, v185
    v_add_f32 v9, v9, v184
    v_add_f32 v9, v9, v185
    v_cvt_pk_bf16_f32 v48, v184, v185
    v_exp_f32 v186, v186
    v_exp_f32 v187, v187
    v_add_f32 v9, v9, v186
    v_add_f32 v9, v9, v187
    v_cvt_pk_bf16_f32 v49, v186, v187
    v_exp_f32 v188, v188
    v_exp_f32 v189, v189
    v_add_f32 v10, v10, v188
    v_add_f32 v10, v10, v189
    v_cvt_pk_bf16_f32 v52, v188, v189
    v_exp_f32 v190, v190
    v_exp_f32 v191, v191
    v_add_f32 v10, v10, v190
    v_add_f32 v10, v10, v191
    v_cvt_pk_bf16_f32 v53, v190, v191
    v_exp_f32 v192, v192
    v_exp_f32 v193, v193
    v_add_f32 v9, v9, v192
    v_add_f32 v9, v9, v193
    v_cvt_pk_bf16_f32 v50, v192, v193
    v_exp_f32 v194, v194
    v_exp_f32 v195, v195
    v_add_f32 v9, v9, v194
    v_add_f32 v9, v9, v195
    v_cvt_pk_bf16_f32 v51, v194, v195
    v_exp_f32 v196, v196
    v_exp_f32 v197, v197
    v_add_f32 v10, v10, v196
    v_add_f32 v10, v10, v197
    v_cvt_pk_bf16_f32 v54, v196, v197
    v_exp_f32 v198, v198
    v_exp_f32 v199, v199
    v_add_f32 v10, v10, v198
    v_add_f32 v10, v10, v199
    v_cvt_pk_bf16_f32 v55, v198, v199
    s_mov_b32 s17, 0x8000
    buffer_load_dwordx4 v[200:203], v8, s[8:11], s17 offen offset:0
    buffer_load_dwordx4 v[204:207], v8, s[8:11], s17 offen offset:1024
    buffer_load_dwordx4 v[208:211], v8, s[8:11], s17 offen offset:2048
    buffer_load_dwordx4 v[212:215], v8, s[8:11], s17 offen offset:3072
    s_waitcnt vmcnt(3)
    v_mfma_f32_16x16x32_bf16 v[184:187], v[200:203], v[152:155], v[216:219]
    v_mfma_f32_16x16x32_bf16 v[188:191], v[200:203], v[168:171], v[220:223]
    s_waitcnt vmcnt(2)
    v_mfma_f32_16x16x32_bf16 v[192:195], v[204:207], v[152:155], v[216:219]
    v_mfma_f32_16x16x32_bf16 v[196:199], v[204:207], v[168:171], v[220:223]
    s_waitcnt vmcnt(1)
    v_mfma_f32_16x16x32_bf16 v[184:187], v[208:211], v[156:159], v[184:187]
    v_mfma_f32_16x16x32_bf16 v[188:191], v[208:211], v[172:175], v[188:191]
    s_waitcnt vmcnt(0)
    v_mfma_f32_16x16x32_bf16 v[192:195], v[212:215], v[156:159], v[192:195]
    v_mfma_f32_16x16x32_bf16 v[196:199], v[212:215], v[172:175], v[196:199]
    s_mov_b32 s17, 0x9000
    buffer_load_dwordx4 v[200:203], v8, s[8:11], s17 offen offset:0
    buffer_load_dwordx4 v[204:207], v8, s[8:11], s17 offen offset:1024
    buffer_load_dwordx4 v[208:211], v8, s[8:11], s17 offen offset:2048
    buffer_load_dwordx4 v[212:215], v8, s[8:11], s17 offen offset:3072
    s_waitcnt vmcnt(3)
    v_mfma_f32_16x16x32_bf16 v[184:187], v[200:203], v[160:163], v[184:187]
    v_mfma_f32_16x16x32_bf16 v[188:191], v[200:203], v[176:179], v[188:191]
    s_waitcnt vmcnt(2)
    v_mfma_f32_16x16x32_bf16 v[192:195], v[204:207], v[160:163], v[192:195]
    v_mfma_f32_16x16x32_bf16 v[196:199], v[204:207], v[176:179], v[196:199]
    s_waitcnt vmcnt(1)
    v_mfma_f32_16x16x32_bf16 v[184:187], v[208:211], v[164:167], v[184:187]
    v_mfma_f32_16x16x32_bf16 v[188:191], v[208:211], v[180:183], v[188:191]
    s_waitcnt vmcnt(0)
    v_mfma_f32_16x16x32_bf16 v[192:195], v[212:215], v[164:167], v[192:195]
    v_mfma_f32_16x16x32_bf16 v[196:199], v[212:215], v[180:183], v[196:199]
    s_nop 3
    v_exp_f32 v184, v184
    v_exp_f32 v185, v185
    v_add_f32 v9, v9, v184
    v_add_f32 v9, v9, v185
    v_cvt_pk_bf16_f32 v56, v184, v185
    v_exp_f32 v186, v186
    v_exp_f32 v187, v187
    v_add_f32 v9, v9, v186
    v_add_f32 v9, v9, v187
    v_cvt_pk_bf16_f32 v57, v186, v187
    v_exp_f32 v188, v188
    v_exp_f32 v189, v189
    v_add_f32 v10, v10, v188
    v_add_f32 v10, v10, v189
    v_cvt_pk_bf16_f32 v60, v188, v189
    v_exp_f32 v190, v190
    v_exp_f32 v191, v191
    v_add_f32 v10, v10, v190
    v_add_f32 v10, v10, v191
    v_cvt_pk_bf16_f32 v61, v190, v191
    v_exp_f32 v192, v192
    v_exp_f32 v193, v193
    v_add_f32 v9, v9, v192
    v_add_f32 v9, v9, v193
    v_cvt_pk_bf16_f32 v58, v192, v193
    v_exp_f32 v194, v194
    v_exp_f32 v195, v195
    v_add_f32 v9, v9, v194
    v_add_f32 v9, v9, v195
    v_cvt_pk_bf16_f32 v59, v194, v195
    v_exp_f32 v196, v196
    v_exp_f32 v197, v197
    v_add_f32 v10, v10, v196
    v_add_f32 v10, v10, v197
    v_cvt_pk_bf16_f32 v62, v196, v197
    v_exp_f32 v198, v198
    v_exp_f32 v199, v199
    v_add_f32 v10, v10, v198
    v_add_f32 v10, v10, v199
    v_cvt_pk_bf16_f32 v63, v198, v199
    s_mov_b32 s17, 0xa000
    buffer_load_dwordx4 v[200:203], v8, s[8:11], s17 offen offset:0
    buffer_load_dwordx4 v[204:207], v8, s[8:11], s17 offen offset:1024
    buffer_load_dwordx4 v[208:211], v8, s[8:11], s17 offen offset:2048
    buffer_load_dwordx4 v[212:215], v8, s[8:11], s17 offen offset:3072
    s_waitcnt vmcnt(3)
    v_mfma_f32_16x16x32_bf16 v[184:187], v[200:203], v[152:155], v[216:219]
    v_mfma_f32_16x16x32_bf16 v[188:191], v[200:203], v[168:171], v[220:223]
    s_waitcnt vmcnt(2)
    v_mfma_f32_16x16x32_bf16 v[192:195], v[204:207], v[152:155], v[216:219]
    v_mfma_f32_16x16x32_bf16 v[196:199], v[204:207], v[168:171], v[220:223]
    s_waitcnt vmcnt(1)
    v_mfma_f32_16x16x32_bf16 v[184:187], v[208:211], v[156:159], v[184:187]
    v_mfma_f32_16x16x32_bf16 v[188:191], v[208:211], v[172:175], v[188:191]
    s_waitcnt vmcnt(0)
    v_mfma_f32_16x16x32_bf16 v[192:195], v[212:215], v[156:159], v[192:195]
    v_mfma_f32_16x16x32_bf16 v[196:199], v[212:215], v[172:175], v[196:199]
    s_mov_b32 s17, 0xb000
    buffer_load_dwordx4 v[200:203], v8, s[8:11], s17 offen offset:0
    buffer_load_dwordx4 v[204:207], v8, s[8:11], s17 offen offset:1024
    buffer_load_dwordx4 v[208:211], v8, s[8:11], s17 offen offset:2048
    buffer_load_dwordx4 v[212:215], v8, s[8:11], s17 offen offset:3072
    s_waitcnt vmcnt(3)
    v_mfma_f32_16x16x32_bf16 v[184:187], v[200:203], v[160:163], v[184:187]
    v_mfma_f32_16x16x32_bf16 v[188:191], v[200:203], v[176:179], v[188:191]
    s_waitcnt vmcnt(2)
    v_mfma_f32_16x16x32_bf16 v[192:195], v[204:207], v[160:163], v[192:195]
    v_mfma_f32_16x16x32_bf16 v[196:199], v[204:207], v[176:179], v[196:199]
    s_waitcnt vmcnt(1)
    v_mfma_f32_16x16x32_bf16 v[184:187], v[208:211], v[164:167], v[184:187]
    v_mfma_f32_16x16x32_bf16 v[188:191], v[208:211], v[180:183], v[188:191]
    s_waitcnt vmcnt(0)
    v_mfma_f32_16x16x32_bf16 v[192:195], v[212:215], v[164:167], v[192:195]
    v_mfma_f32_16x16x32_bf16 v[196:199], v[212:215], v[180:183], v[196:199]
    s_nop 3
    v_exp_f32 v184, v184
    v_exp_f32 v185, v185
    v_add_f32 v9, v9, v184
    v_add_f32 v9, v9, v185
    v_cvt_pk_bf16_f32 v64, v184, v185
    v_exp_f32 v186, v186
    v_exp_f32 v187, v187
    v_add_f32 v9, v9, v186
    v_add_f32 v9, v9, v187
    v_cvt_pk_bf16_f32 v65, v186, v187
    v_exp_f32 v188, v188
    v_exp_f32 v189, v189
    v_add_f32 v10, v10, v188
    v_add_f32 v10, v10, v189
    v_cvt_pk_bf16_f32 v68, v188, v189
    v_exp_f32 v190, v190
    v_exp_f32 v191, v191
    v_add_f32 v10, v10, v190
    v_add_f32 v10, v10, v191
    v_cvt_pk_bf16_f32 v69, v190, v191
    v_exp_f32 v192, v192
    v_exp_f32 v193, v193
    v_add_f32 v9, v9, v192
    v_add_f32 v9, v9, v193
    v_cvt_pk_bf16_f32 v66, v192, v193
    v_exp_f32 v194, v194
    v_exp_f32 v195, v195
    v_add_f32 v9, v9, v194
    v_add_f32 v9, v9, v195
    v_cvt_pk_bf16_f32 v67, v194, v195
    v_exp_f32 v196, v196
    v_exp_f32 v197, v197
    v_add_f32 v10, v10, v196
    v_add_f32 v10, v10, v197
    v_cvt_pk_bf16_f32 v70, v196, v197
    v_exp_f32 v198, v198
    v_exp_f32 v199, v199
    v_add_f32 v10, v10, v198
    v_add_f32 v10, v10, v199
    v_cvt_pk_bf16_f32 v71, v198, v199
    s_mov_b32 s17, 0xc000
    buffer_load_dwordx4 v[200:203], v8, s[8:11], s17 offen offset:0
    buffer_load_dwordx4 v[204:207], v8, s[8:11], s17 offen offset:1024
    buffer_load_dwordx4 v[208:211], v8, s[8:11], s17 offen offset:2048
    buffer_load_dwordx4 v[212:215], v8, s[8:11], s17 offen offset:3072
    s_waitcnt vmcnt(3)
    v_mfma_f32_16x16x32_bf16 v[184:187], v[200:203], v[152:155], v[216:219]
    v_mfma_f32_16x16x32_bf16 v[188:191], v[200:203], v[168:171], v[220:223]
    s_waitcnt vmcnt(2)
    v_mfma_f32_16x16x32_bf16 v[192:195], v[204:207], v[152:155], v[216:219]
    v_mfma_f32_16x16x32_bf16 v[196:199], v[204:207], v[168:171], v[220:223]
    s_waitcnt vmcnt(1)
    v_mfma_f32_16x16x32_bf16 v[184:187], v[208:211], v[156:159], v[184:187]
    v_mfma_f32_16x16x32_bf16 v[188:191], v[208:211], v[172:175], v[188:191]
    s_waitcnt vmcnt(0)
    v_mfma_f32_16x16x32_bf16 v[192:195], v[212:215], v[156:159], v[192:195]
    v_mfma_f32_16x16x32_bf16 v[196:199], v[212:215], v[172:175], v[196:199]
    s_mov_b32 s17, 0xd000
    buffer_load_dwordx4 v[200:203], v8, s[8:11], s17 offen offset:0
    buffer_load_dwordx4 v[204:207], v8, s[8:11], s17 offen offset:1024
    buffer_load_dwordx4 v[208:211], v8, s[8:11], s17 offen offset:2048
    buffer_load_dwordx4 v[212:215], v8, s[8:11], s17 offen offset:3072
    s_waitcnt vmcnt(3)
    v_mfma_f32_16x16x32_bf16 v[184:187], v[200:203], v[160:163], v[184:187]
    v_mfma_f32_16x16x32_bf16 v[188:191], v[200:203], v[176:179], v[188:191]
    s_waitcnt vmcnt(2)
    v_mfma_f32_16x16x32_bf16 v[192:195], v[204:207], v[160:163], v[192:195]
    v_mfma_f32_16x16x32_bf16 v[196:199], v[204:207], v[176:179], v[196:199]
    s_waitcnt vmcnt(1)
    v_mfma_f32_16x16x32_bf16 v[184:187], v[208:211], v[164:167], v[184:187]
    v_mfma_f32_16x16x32_bf16 v[188:191], v[208:211], v[180:183], v[188:191]
    s_waitcnt vmcnt(0)
    v_mfma_f32_16x16x32_bf16 v[192:195], v[212:215], v[164:167], v[192:195]
    v_mfma_f32_16x16x32_bf16 v[196:199], v[212:215], v[180:183], v[196:199]
    s_nop 3
    v_exp_f32 v184, v184
    v_exp_f32 v185, v185
    v_add_f32 v9, v9, v184
    v_add_f32 v9, v9, v185
    v_cvt_pk_bf16_f32 v72, v184, v185
    v_exp_f32 v186, v186
    v_exp_f32 v187, v187
    v_add_f32 v9, v9, v186
    v_add_f32 v9, v9, v187
    v_cvt_pk_bf16_f32 v73, v186, v187
    v_exp_f32 v188, v188
    v_exp_f32 v189, v189
    v_add_f32 v10, v10, v188
    v_add_f32 v10, v10, v189
    v_cvt_pk_bf16_f32 v76, v188, v189
    v_exp_f32 v190, v190
    v_exp_f32 v191, v191
    v_add_f32 v10, v10, v190
    v_add_f32 v10, v10, v191
    v_cvt_pk_bf16_f32 v77, v190, v191
    v_exp_f32 v192, v192
    v_exp_f32 v193, v193
    v_add_f32 v9, v9, v192
    v_add_f32 v9, v9, v193
    v_cvt_pk_bf16_f32 v74, v192, v193
    v_exp_f32 v194, v194
    v_exp_f32 v195, v195
    v_add_f32 v9, v9, v194
    v_add_f32 v9, v9, v195
    v_cvt_pk_bf16_f32 v75, v194, v195
    v_exp_f32 v196, v196
    v_exp_f32 v197, v197
    v_add_f32 v10, v10, v196
    v_add_f32 v10, v10, v197
    v_cvt_pk_bf16_f32 v78, v196, v197
    v_exp_f32 v198, v198
    v_exp_f32 v199, v199
    v_add_f32 v10, v10, v198
    v_add_f32 v10, v10, v199
    v_cvt_pk_bf16_f32 v79, v198, v199
    s_mov_b32 s17, 0xe000
    buffer_load_dwordx4 v[200:203], v8, s[8:11], s17 offen offset:0
    buffer_load_dwordx4 v[204:207], v8, s[8:11], s17 offen offset:1024
    buffer_load_dwordx4 v[208:211], v8, s[8:11], s17 offen offset:2048
    buffer_load_dwordx4 v[212:215], v8, s[8:11], s17 offen offset:3072
    s_waitcnt vmcnt(3)
    v_mfma_f32_16x16x32_bf16 v[184:187], v[200:203], v[152:155], v[216:219]
    v_mfma_f32_16x16x32_bf16 v[188:191], v[200:203], v[168:171], v[220:223]
    s_waitcnt vmcnt(2)
    v_mfma_f32_16x16x32_bf16 v[192:195], v[204:207], v[152:155], v[216:219]
    v_mfma_f32_16x16x32_bf16 v[196:199], v[204:207], v[168:171], v[220:223]
    s_waitcnt vmcnt(1)
    v_mfma_f32_16x16x32_bf16 v[184:187], v[208:211], v[156:159], v[184:187]
    v_mfma_f32_16x16x32_bf16 v[188:191], v[208:211], v[172:175], v[188:191]
    s_waitcnt vmcnt(0)
    v_mfma_f32_16x16x32_bf16 v[192:195], v[212:215], v[156:159], v[192:195]
    v_mfma_f32_16x16x32_bf16 v[196:199], v[212:215], v[172:175], v[196:199]
    s_mov_b32 s17, 0xf000
    buffer_load_dwordx4 v[200:203], v8, s[8:11], s17 offen offset:0
    buffer_load_dwordx4 v[204:207], v8, s[8:11], s17 offen offset:1024
    buffer_load_dwordx4 v[208:211], v8, s[8:11], s17 offen offset:2048
    buffer_load_dwordx4 v[212:215], v8, s[8:11], s17 offen offset:3072
    s_waitcnt vmcnt(3)
    v_mfma_f32_16x16x32_bf16 v[184:187], v[200:203], v[160:163], v[184:187]
    v_mfma_f32_16x16x32_bf16 v[188:191], v[200:203], v[176:179], v[188:191]
    s_waitcnt vmcnt(2)
    v_mfma_f32_16x16x32_bf16 v[192:195], v[204:207], v[160:163], v[192:195]
    v_mfma_f32_16x16x32_bf16 v[196:199], v[204:207], v[176:179], v[196:199]
    s_waitcnt vmcnt(1)
    v_mfma_f32_16x16x32_bf16 v[184:187], v[208:211], v[164:167], v[184:187]
    v_mfma_f32_16x16x32_bf16 v[188:191], v[208:211], v[180:183], v[188:191]
    s_waitcnt vmcnt(0)
    v_mfma_f32_16x16x32_bf16 v[192:195], v[212:215], v[164:167], v[192:195]
    v_mfma_f32_16x16x32_bf16 v[196:199], v[212:215], v[180:183], v[196:199]
    s_nop 3
    v_exp_f32 v184, v184
    v_exp_f32 v185, v185
    v_add_f32 v9, v9, v184
    v_add_f32 v9, v9, v185
    v_cvt_pk_bf16_f32 v80, v184, v185
    v_exp_f32 v186, v186
    v_exp_f32 v187, v187
    v_add_f32 v9, v9, v186
    v_add_f32 v9, v9, v187
    v_cvt_pk_bf16_f32 v81, v186, v187
    v_exp_f32 v188, v188
    v_exp_f32 v189, v189
    v_add_f32 v10, v10, v188
    v_add_f32 v10, v10, v189
    v_cvt_pk_bf16_f32 v84, v188, v189
    v_exp_f32 v190, v190
    v_exp_f32 v191, v191
    v_add_f32 v10, v10, v190
    v_add_f32 v10, v10, v191
    v_cvt_pk_bf16_f32 v85, v190, v191
    v_exp_f32 v192, v192
    v_exp_f32 v193, v193
    v_add_f32 v9, v9, v192
    v_add_f32 v9, v9, v193
    v_cvt_pk_bf16_f32 v82, v192, v193
    v_exp_f32 v194, v194
    v_exp_f32 v195, v195
    v_add_f32 v9, v9, v194
    v_add_f32 v9, v9, v195
    v_cvt_pk_bf16_f32 v83, v194, v195
    v_exp_f32 v196, v196
    v_exp_f32 v197, v197
    v_add_f32 v10, v10, v196
    v_add_f32 v10, v10, v197
    v_cvt_pk_bf16_f32 v86, v196, v197
    v_exp_f32 v198, v198
    v_exp_f32 v199, v199
    v_add_f32 v10, v10, v198
    v_add_f32 v10, v10, v199
    v_cvt_pk_bf16_f32 v87, v198, v199
    s_mov_b32 s17, 0x10000
    buffer_load_dwordx4 v[200:203], v8, s[8:11], s17 offen offset:0
    buffer_load_dwordx4 v[204:207], v8, s[8:11], s17 offen offset:1024
    buffer_load_dwordx4 v[208:211], v8, s[8:11], s17 offen offset:2048
    buffer_load_dwordx4 v[212:215], v8, s[8:11], s17 offen offset:3072
    s_waitcnt vmcnt(3)
    v_mfma_f32_16x16x32_bf16 v[184:187], v[200:203], v[152:155], v[216:219]
    v_mfma_f32_16x16x32_bf16 v[188:191], v[200:203], v[168:171], v[220:223]
    s_waitcnt vmcnt(2)
    v_mfma_f32_16x16x32_bf16 v[192:195], v[204:207], v[152:155], v[216:219]
    v_mfma_f32_16x16x32_bf16 v[196:199], v[204:207], v[168:171], v[220:223]
    s_waitcnt vmcnt(1)
    v_mfma_f32_16x16x32_bf16 v[184:187], v[208:211], v[156:159], v[184:187]
    v_mfma_f32_16x16x32_bf16 v[188:191], v[208:211], v[172:175], v[188:191]
    s_waitcnt vmcnt(0)
    v_mfma_f32_16x16x32_bf16 v[192:195], v[212:215], v[156:159], v[192:195]
    v_mfma_f32_16x16x32_bf16 v[196:199], v[212:215], v[172:175], v[196:199]
    s_mov_b32 s17, 0x11000
    buffer_load_dwordx4 v[200:203], v8, s[8:11], s17 offen offset:0
    buffer_load_dwordx4 v[204:207], v8, s[8:11], s17 offen offset:1024
    buffer_load_dwordx4 v[208:211], v8, s[8:11], s17 offen offset:2048
    buffer_load_dwordx4 v[212:215], v8, s[8:11], s17 offen offset:3072
    s_waitcnt vmcnt(3)
    v_mfma_f32_16x16x32_bf16 v[184:187], v[200:203], v[160:163], v[184:187]
    v_mfma_f32_16x16x32_bf16 v[188:191], v[200:203], v[176:179], v[188:191]
    s_waitcnt vmcnt(2)
    v_mfma_f32_16x16x32_bf16 v[192:195], v[204:207], v[160:163], v[192:195]
    v_mfma_f32_16x16x32_bf16 v[196:199], v[204:207], v[176:179], v[196:199]
    s_waitcnt vmcnt(1)
    v_mfma_f32_16x16x32_bf16 v[184:187], v[208:211], v[164:167], v[184:187]
    v_mfma_f32_16x16x32_bf16 v[188:191], v[208:211], v[180:183], v[188:191]
    s_waitcnt vmcnt(0)
    v_mfma_f32_16x16x32_bf16 v[192:195], v[212:215], v[164:167], v[192:195]
    v_mfma_f32_16x16x32_bf16 v[196:199], v[212:215], v[180:183], v[196:199]
    s_nop 3
    v_exp_f32 v184, v184
    v_exp_f32 v185, v185
    v_add_f32 v9, v9, v184
    v_add_f32 v9, v9, v185
    v_cvt_pk_bf16_f32 v88, v184, v185
    v_exp_f32 v186, v186
    v_exp_f32 v187, v187
    v_add_f32 v9, v9, v186
    v_add_f32 v9, v9, v187
    v_cvt_pk_bf16_f32 v89, v186, v187
    v_exp_f32 v188, v188
    v_exp_f32 v189, v189
    v_add_f32 v10, v10, v188
    v_add_f32 v10, v10, v189
    v_cvt_pk_bf16_f32 v92, v188, v189
    v_exp_f32 v190, v190
    v_exp_f32 v191, v191
    v_add_f32 v10, v10, v190
    v_add_f32 v10, v10, v191
    v_cvt_pk_bf16_f32 v93, v190, v191
    v_exp_f32 v192, v192
    v_exp_f32 v193, v193
    v_add_f32 v9, v9, v192
    v_add_f32 v9, v9, v193
    v_cvt_pk_bf16_f32 v90, v192, v193
    v_exp_f32 v194, v194
    v_exp_f32 v195, v195
    v_add_f32 v9, v9, v194
    v_add_f32 v9, v9, v195
    v_cvt_pk_bf16_f32 v91, v194, v195
    v_exp_f32 v196, v196
    v_exp_f32 v197, v197
    v_add_f32 v10, v10, v196
    v_add_f32 v10, v10, v197
    v_cvt_pk_bf16_f32 v94, v196, v197
    v_exp_f32 v198, v198
    v_exp_f32 v199, v199
    v_add_f32 v10, v10, v198
    v_add_f32 v10, v10, v199
    v_cvt_pk_bf16_f32 v95, v198, v199
    s_mov_b32 s17, 0x12000
    buffer_load_dwordx4 v[200:203], v8, s[8:11], s17 offen offset:0
    buffer_load_dwordx4 v[204:207], v8, s[8:11], s17 offen offset:1024
    buffer_load_dwordx4 v[208:211], v8, s[8:11], s17 offen offset:2048
    buffer_load_dwordx4 v[212:215], v8, s[8:11], s17 offen offset:3072
    s_waitcnt vmcnt(3)
    v_mfma_f32_16x16x32_bf16 v[184:187], v[200:203], v[152:155], v[216:219]
    v_mfma_f32_16x16x32_bf16 v[188:191], v[200:203], v[168:171], v[220:223]
    s_waitcnt vmcnt(2)
    v_mfma_f32_16x16x32_bf16 v[192:195], v[204:207], v[152:155], v[216:219]
    v_mfma_f32_16x16x32_bf16 v[196:199], v[204:207], v[168:171], v[220:223]
    s_waitcnt vmcnt(1)
    v_mfma_f32_16x16x32_bf16 v[184:187], v[208:211], v[156:159], v[184:187]
    v_mfma_f32_16x16x32_bf16 v[188:191], v[208:211], v[172:175], v[188:191]
    s_waitcnt vmcnt(0)
    v_mfma_f32_16x16x32_bf16 v[192:195], v[212:215], v[156:159], v[192:195]
    v_mfma_f32_16x16x32_bf16 v[196:199], v[212:215], v[172:175], v[196:199]
    s_mov_b32 s17, 0x13000
    buffer_load_dwordx4 v[200:203], v8, s[8:11], s17 offen offset:0
    buffer_load_dwordx4 v[204:207], v8, s[8:11], s17 offen offset:1024
    buffer_load_dwordx4 v[208:211], v8, s[8:11], s17 offen offset:2048
    buffer_load_dwordx4 v[212:215], v8, s[8:11], s17 offen offset:3072
    s_waitcnt vmcnt(3)
    v_mfma_f32_16x16x32_bf16 v[184:187], v[200:203], v[160:163], v[184:187]
    v_mfma_f32_16x16x32_bf16 v[188:191], v[200:203], v[176:179], v[188:191]
    s_waitcnt vmcnt(2)
    v_mfma_f32_16x16x32_bf16 v[192:195], v[204:207], v[160:163], v[192:195]
    v_mfma_f32_16x16x32_bf16 v[196:199], v[204:207], v[176:179], v[196:199]
    s_waitcnt vmcnt(1)
    v_mfma_f32_16x16x32_bf16 v[184:187], v[208:211], v[164:167], v[184:187]
    v_mfma_f32_16x16x32_bf16 v[188:191], v[208:211], v[180:183], v[188:191]
    s_waitcnt vmcnt(0)
    v_mfma_f32_16x16x32_bf16 v[192:195], v[212:215], v[164:167], v[192:195]
    v_mfma_f32_16x16x32_bf16 v[196:199], v[212:215], v[180:183], v[196:199]
    s_nop 3
    v_exp_f32 v184, v184
    v_exp_f32 v185, v185
    v_add_f32 v9, v9, v184
    v_add_f32 v9, v9, v185
    v_cvt_pk_bf16_f32 v96, v184, v185
    v_exp_f32 v186, v186
    v_exp_f32 v187, v187
    v_add_f32 v9, v9, v186
    v_add_f32 v9, v9, v187
    v_cvt_pk_bf16_f32 v97, v186, v187
    v_exp_f32 v188, v188
    v_exp_f32 v189, v189
    v_add_f32 v10, v10, v188
    v_add_f32 v10, v10, v189
    v_cvt_pk_bf16_f32 v100, v188, v189
    v_exp_f32 v190, v190
    v_exp_f32 v191, v191
    v_add_f32 v10, v10, v190
    v_add_f32 v10, v10, v191
    v_cvt_pk_bf16_f32 v101, v190, v191
    v_exp_f32 v192, v192
    v_exp_f32 v193, v193
    v_add_f32 v9, v9, v192
    v_add_f32 v9, v9, v193
    v_cvt_pk_bf16_f32 v98, v192, v193
    v_exp_f32 v194, v194
    v_exp_f32 v195, v195
    v_add_f32 v9, v9, v194
    v_add_f32 v9, v9, v195
    v_cvt_pk_bf16_f32 v99, v194, v195
    v_exp_f32 v196, v196
    v_exp_f32 v197, v197
    v_add_f32 v10, v10, v196
    v_add_f32 v10, v10, v197
    v_cvt_pk_bf16_f32 v102, v196, v197
    v_exp_f32 v198, v198
    v_exp_f32 v199, v199
    v_add_f32 v10, v10, v198
    v_add_f32 v10, v10, v199
    v_cvt_pk_bf16_f32 v103, v198, v199
    s_mov_b32 s17, 0x14000
    buffer_load_dwordx4 v[200:203], v8, s[8:11], s17 offen offset:0
    buffer_load_dwordx4 v[204:207], v8, s[8:11], s17 offen offset:1024
    buffer_load_dwordx4 v[208:211], v8, s[8:11], s17 offen offset:2048
    buffer_load_dwordx4 v[212:215], v8, s[8:11], s17 offen offset:3072
    s_waitcnt vmcnt(3)
    v_mfma_f32_16x16x32_bf16 v[184:187], v[200:203], v[152:155], v[216:219]
    v_mfma_f32_16x16x32_bf16 v[188:191], v[200:203], v[168:171], v[220:223]
    s_waitcnt vmcnt(2)
    v_mfma_f32_16x16x32_bf16 v[192:195], v[204:207], v[152:155], v[216:219]
    v_mfma_f32_16x16x32_bf16 v[196:199], v[204:207], v[168:171], v[220:223]
    s_waitcnt vmcnt(1)
    v_mfma_f32_16x16x32_bf16 v[184:187], v[208:211], v[156:159], v[184:187]
    v_mfma_f32_16x16x32_bf16 v[188:191], v[208:211], v[172:175], v[188:191]
    s_waitcnt vmcnt(0)
    v_mfma_f32_16x16x32_bf16 v[192:195], v[212:215], v[156:159], v[192:195]
    v_mfma_f32_16x16x32_bf16 v[196:199], v[212:215], v[172:175], v[196:199]
    s_mov_b32 s17, 0x15000
    buffer_load_dwordx4 v[200:203], v8, s[8:11], s17 offen offset:0
    buffer_load_dwordx4 v[204:207], v8, s[8:11], s17 offen offset:1024
    buffer_load_dwordx4 v[208:211], v8, s[8:11], s17 offen offset:2048
    buffer_load_dwordx4 v[212:215], v8, s[8:11], s17 offen offset:3072
    s_waitcnt vmcnt(3)
    v_mfma_f32_16x16x32_bf16 v[184:187], v[200:203], v[160:163], v[184:187]
    v_mfma_f32_16x16x32_bf16 v[188:191], v[200:203], v[176:179], v[188:191]
    s_waitcnt vmcnt(2)
    v_mfma_f32_16x16x32_bf16 v[192:195], v[204:207], v[160:163], v[192:195]
    v_mfma_f32_16x16x32_bf16 v[196:199], v[204:207], v[176:179], v[196:199]
    s_waitcnt vmcnt(1)
    v_mfma_f32_16x16x32_bf16 v[184:187], v[208:211], v[164:167], v[184:187]
    v_mfma_f32_16x16x32_bf16 v[188:191], v[208:211], v[180:183], v[188:191]
    s_waitcnt vmcnt(0)
    v_mfma_f32_16x16x32_bf16 v[192:195], v[212:215], v[164:167], v[192:195]
    v_mfma_f32_16x16x32_bf16 v[196:199], v[212:215], v[180:183], v[196:199]
    s_nop 3
    v_exp_f32 v184, v184
    v_exp_f32 v185, v185
    v_add_f32 v9, v9, v184
    v_add_f32 v9, v9, v185
    v_cvt_pk_bf16_f32 v104, v184, v185
    v_exp_f32 v186, v186
    v_exp_f32 v187, v187
    v_add_f32 v9, v9, v186
    v_add_f32 v9, v9, v187
    v_cvt_pk_bf16_f32 v105, v186, v187
    v_exp_f32 v188, v188
    v_exp_f32 v189, v189
    v_add_f32 v10, v10, v188
    v_add_f32 v10, v10, v189
    v_cvt_pk_bf16_f32 v108, v188, v189
    v_exp_f32 v190, v190
    v_exp_f32 v191, v191
    v_add_f32 v10, v10, v190
    v_add_f32 v10, v10, v191
    v_cvt_pk_bf16_f32 v109, v190, v191
    v_exp_f32 v192, v192
    v_exp_f32 v193, v193
    v_add_f32 v9, v9, v192
    v_add_f32 v9, v9, v193
    v_cvt_pk_bf16_f32 v106, v192, v193
    v_exp_f32 v194, v194
    v_exp_f32 v195, v195
    v_add_f32 v9, v9, v194
    v_add_f32 v9, v9, v195
    v_cvt_pk_bf16_f32 v107, v194, v195
    v_exp_f32 v196, v196
    v_exp_f32 v197, v197
    v_add_f32 v10, v10, v196
    v_add_f32 v10, v10, v197
    v_cvt_pk_bf16_f32 v110, v196, v197
    v_exp_f32 v198, v198
    v_exp_f32 v199, v199
    v_add_f32 v10, v10, v198
    v_add_f32 v10, v10, v199
    v_cvt_pk_bf16_f32 v111, v198, v199
    s_mov_b32 s17, 0x16000
    buffer_load_dwordx4 v[200:203], v8, s[8:11], s17 offen offset:0
    buffer_load_dwordx4 v[204:207], v8, s[8:11], s17 offen offset:1024
    buffer_load_dwordx4 v[208:211], v8, s[8:11], s17 offen offset:2048
    buffer_load_dwordx4 v[212:215], v8, s[8:11], s17 offen offset:3072
    s_waitcnt vmcnt(3)
    v_mfma_f32_16x16x32_bf16 v[184:187], v[200:203], v[152:155], v[216:219]
    v_mfma_f32_16x16x32_bf16 v[188:191], v[200:203], v[168:171], v[220:223]
    s_waitcnt vmcnt(2)
    v_mfma_f32_16x16x32_bf16 v[192:195], v[204:207], v[152:155], v[216:219]
    v_mfma_f32_16x16x32_bf16 v[196:199], v[204:207], v[168:171], v[220:223]
    s_waitcnt vmcnt(1)
    v_mfma_f32_16x16x32_bf16 v[184:187], v[208:211], v[156:159], v[184:187]
    v_mfma_f32_16x16x32_bf16 v[188:191], v[208:211], v[172:175], v[188:191]
    s_waitcnt vmcnt(0)
    v_mfma_f32_16x16x32_bf16 v[192:195], v[212:215], v[156:159], v[192:195]
    v_mfma_f32_16x16x32_bf16 v[196:199], v[212:215], v[172:175], v[196:199]
    s_mov_b32 s17, 0x17000
    buffer_load_dwordx4 v[200:203], v8, s[8:11], s17 offen offset:0
    buffer_load_dwordx4 v[204:207], v8, s[8:11], s17 offen offset:1024
    buffer_load_dwordx4 v[208:211], v8, s[8:11], s17 offen offset:2048
    buffer_load_dwordx4 v[212:215], v8, s[8:11], s17 offen offset:3072
    s_waitcnt vmcnt(3)
    v_mfma_f32_16x16x32_bf16 v[184:187], v[200:203], v[160:163], v[184:187]
    v_mfma_f32_16x16x32_bf16 v[188:191], v[200:203], v[176:179], v[188:191]
    s_waitcnt vmcnt(2)
    v_mfma_f32_16x16x32_bf16 v[192:195], v[204:207], v[160:163], v[192:195]
    v_mfma_f32_16x16x32_bf16 v[196:199], v[204:207], v[176:179], v[196:199]
    s_waitcnt vmcnt(1)
    v_mfma_f32_16x16x32_bf16 v[184:187], v[208:211], v[164:167], v[184:187]
    v_mfma_f32_16x16x32_bf16 v[188:191], v[208:211], v[180:183], v[188:191]
    s_waitcnt vmcnt(0)
    v_mfma_f32_16x16x32_bf16 v[192:195], v[212:215], v[164:167], v[192:195]
    v_mfma_f32_16x16x32_bf16 v[196:199], v[212:215], v[180:183], v[196:199]
    s_nop 3
    v_exp_f32 v184, v184
    v_exp_f32 v185, v185
    v_add_f32 v9, v9, v184
    v_add_f32 v9, v9, v185
    v_cvt_pk_bf16_f32 v112, v184, v185
    v_exp_f32 v186, v186
    v_exp_f32 v187, v187
    v_add_f32 v9, v9, v186
    v_add_f32 v9, v9, v187
    v_cvt_pk_bf16_f32 v113, v186, v187
    v_exp_f32 v188, v188
    v_exp_f32 v189, v189
    v_add_f32 v10, v10, v188
    v_add_f32 v10, v10, v189
    v_cvt_pk_bf16_f32 v116, v188, v189
    v_exp_f32 v190, v190
    v_exp_f32 v191, v191
    v_add_f32 v10, v10, v190
    v_add_f32 v10, v10, v191
    v_cvt_pk_bf16_f32 v117, v190, v191
    v_exp_f32 v192, v192
    v_exp_f32 v193, v193
    v_add_f32 v9, v9, v192
    v_add_f32 v9, v9, v193
    v_cvt_pk_bf16_f32 v114, v192, v193
    v_exp_f32 v194, v194
    v_exp_f32 v195, v195
    v_add_f32 v9, v9, v194
    v_add_f32 v9, v9, v195
    v_cvt_pk_bf16_f32 v115, v194, v195
    v_exp_f32 v196, v196
    v_exp_f32 v197, v197
    v_add_f32 v10, v10, v196
    v_add_f32 v10, v10, v197
    v_cvt_pk_bf16_f32 v118, v196, v197
    v_exp_f32 v198, v198
    v_exp_f32 v199, v199
    v_add_f32 v10, v10, v198
    v_add_f32 v10, v10, v199
    v_cvt_pk_bf16_f32 v119, v198, v199
    s_mov_b32 s17, 0x18000
    buffer_load_dwordx4 v[200:203], v8, s[8:11], s17 offen offset:0
    buffer_load_dwordx4 v[204:207], v8, s[8:11], s17 offen offset:1024
    buffer_load_dwordx4 v[208:211], v8, s[8:11], s17 offen offset:2048
    buffer_load_dwordx4 v[212:215], v8, s[8:11], s17 offen offset:3072
    s_waitcnt vmcnt(3)
    v_mfma_f32_16x16x32_bf16 v[184:187], v[200:203], v[152:155], v[216:219]
    v_mfma_f32_16x16x32_bf16 v[188:191], v[200:203], v[168:171], v[220:223]
    s_waitcnt vmcnt(2)
    v_mfma_f32_16x16x32_bf16 v[192:195], v[204:207], v[152:155], v[216:219]
    v_mfma_f32_16x16x32_bf16 v[196:199], v[204:207], v[168:171], v[220:223]
    s_waitcnt vmcnt(1)
    v_mfma_f32_16x16x32_bf16 v[184:187], v[208:211], v[156:159], v[184:187]
    v_mfma_f32_16x16x32_bf16 v[188:191], v[208:211], v[172:175], v[188:191]
    s_waitcnt vmcnt(0)
    v_mfma_f32_16x16x32_bf16 v[192:195], v[212:215], v[156:159], v[192:195]
    v_mfma_f32_16x16x32_bf16 v[196:199], v[212:215], v[172:175], v[196:199]
    s_mov_b32 s17, 0x19000
    buffer_load_dwordx4 v[200:203], v8, s[8:11], s17 offen offset:0
    buffer_load_dwordx4 v[204:207], v8, s[8:11], s17 offen offset:1024
    buffer_load_dwordx4 v[208:211], v8, s[8:11], s17 offen offset:2048
    buffer_load_dwordx4 v[212:215], v8, s[8:11], s17 offen offset:3072
    s_waitcnt vmcnt(3)
    v_mfma_f32_16x16x32_bf16 v[184:187], v[200:203], v[160:163], v[184:187]
    v_mfma_f32_16x16x32_bf16 v[188:191], v[200:203], v[176:179], v[188:191]
    s_waitcnt vmcnt(2)
    v_mfma_f32_16x16x32_bf16 v[192:195], v[204:207], v[160:163], v[192:195]
    v_mfma_f32_16x16x32_bf16 v[196:199], v[204:207], v[176:179], v[196:199]
    s_waitcnt vmcnt(1)
    v_mfma_f32_16x16x32_bf16 v[184:187], v[208:211], v[164:167], v[184:187]
    v_mfma_f32_16x16x32_bf16 v[188:191], v[208:211], v[180:183], v[188:191]
    s_waitcnt vmcnt(0)
    v_mfma_f32_16x16x32_bf16 v[192:195], v[212:215], v[164:167], v[192:195]
    v_mfma_f32_16x16x32_bf16 v[196:199], v[212:215], v[180:183], v[196:199]
    s_nop 3
    v_exp_f32 v184, v184
    v_exp_f32 v185, v185
    v_add_f32 v9, v9, v184
    v_add_f32 v9, v9, v185
    v_cvt_pk_bf16_f32 v120, v184, v185
    v_exp_f32 v186, v186
    v_exp_f32 v187, v187
    v_add_f32 v9, v9, v186
    v_add_f32 v9, v9, v187
    v_cvt_pk_bf16_f32 v121, v186, v187
    v_exp_f32 v188, v188
    v_exp_f32 v189, v189
    v_add_f32 v10, v10, v188
    v_add_f32 v10, v10, v189
    v_cvt_pk_bf16_f32 v124, v188, v189
    v_exp_f32 v190, v190
    v_exp_f32 v191, v191
    v_add_f32 v10, v10, v190
    v_add_f32 v10, v10, v191
    v_cvt_pk_bf16_f32 v125, v190, v191
    v_exp_f32 v192, v192
    v_exp_f32 v193, v193
    v_add_f32 v9, v9, v192
    v_add_f32 v9, v9, v193
    v_cvt_pk_bf16_f32 v122, v192, v193
    v_exp_f32 v194, v194
    v_exp_f32 v195, v195
    v_add_f32 v9, v9, v194
    v_add_f32 v9, v9, v195
    v_cvt_pk_bf16_f32 v123, v194, v195
    v_exp_f32 v196, v196
    v_exp_f32 v197, v197
    v_add_f32 v10, v10, v196
    v_add_f32 v10, v10, v197
    v_cvt_pk_bf16_f32 v126, v196, v197
    v_exp_f32 v198, v198
    v_exp_f32 v199, v199
    v_add_f32 v10, v10, v198
    v_add_f32 v10, v10, v199
    v_cvt_pk_bf16_f32 v127, v198, v199
    s_mov_b32 s17, 0x1a000
    buffer_load_dwordx4 v[200:203], v8, s[8:11], s17 offen offset:0
    buffer_load_dwordx4 v[204:207], v8, s[8:11], s17 offen offset:1024
    buffer_load_dwordx4 v[208:211], v8, s[8:11], s17 offen offset:2048
    buffer_load_dwordx4 v[212:215], v8, s[8:11], s17 offen offset:3072
    s_waitcnt vmcnt(3)
    v_mfma_f32_16x16x32_bf16 v[184:187], v[200:203], v[152:155], v[216:219]
    v_mfma_f32_16x16x32_bf16 v[188:191], v[200:203], v[168:171], v[220:223]
    s_waitcnt vmcnt(2)
    v_mfma_f32_16x16x32_bf16 v[192:195], v[204:207], v[152:155], v[216:219]
    v_mfma_f32_16x16x32_bf16 v[196:199], v[204:207], v[168:171], v[220:223]
    s_waitcnt vmcnt(1)
    v_mfma_f32_16x16x32_bf16 v[184:187], v[208:211], v[156:159], v[184:187]
    v_mfma_f32_16x16x32_bf16 v[188:191], v[208:211], v[172:175], v[188:191]
    s_waitcnt vmcnt(0)
    v_mfma_f32_16x16x32_bf16 v[192:195], v[212:215], v[156:159], v[192:195]
    v_mfma_f32_16x16x32_bf16 v[196:199], v[212:215], v[172:175], v[196:199]
    s_mov_b32 s17, 0x1b000
    buffer_load_dwordx4 v[200:203], v8, s[8:11], s17 offen offset:0
    buffer_load_dwordx4 v[204:207], v8, s[8:11], s17 offen offset:1024
    buffer_load_dwordx4 v[208:211], v8, s[8:11], s17 offen offset:2048
    buffer_load_dwordx4 v[212:215], v8, s[8:11], s17 offen offset:3072
    s_waitcnt vmcnt(3)
    v_mfma_f32_16x16x32_bf16 v[184:187], v[200:203], v[160:163], v[184:187]
    v_mfma_f32_16x16x32_bf16 v[188:191], v[200:203], v[176:179], v[188:191]
    s_waitcnt vmcnt(2)
    v_mfma_f32_16x16x32_bf16 v[192:195], v[204:207], v[160:163], v[192:195]
    v_mfma_f32_16x16x32_bf16 v[196:199], v[204:207], v[176:179], v[196:199]
    s_waitcnt vmcnt(1)
    v_mfma_f32_16x16x32_bf16 v[184:187], v[208:211], v[164:167], v[184:187]
    v_mfma_f32_16x16x32_bf16 v[188:191], v[208:211], v[180:183], v[188:191]
    s_waitcnt vmcnt(0)
    v_mfma_f32_16x16x32_bf16 v[192:195], v[212:215], v[164:167], v[192:195]
    v_mfma_f32_16x16x32_bf16 v[196:199], v[212:215], v[180:183], v[196:199]
    s_nop 3
    v_exp_f32 v184, v184
    v_exp_f32 v185, v185
    v_add_f32 v9, v9, v184
    v_add_f32 v9, v9, v185
    v_cvt_pk_bf16_f32 v128, v184, v185
    v_exp_f32 v186, v186
    v_exp_f32 v187, v187
    v_add_f32 v9, v9, v186
    v_add_f32 v9, v9, v187
    v_cvt_pk_bf16_f32 v129, v186, v187
    v_exp_f32 v188, v188
    v_exp_f32 v189, v189
    v_add_f32 v10, v10, v188
    v_add_f32 v10, v10, v189
    v_cvt_pk_bf16_f32 v132, v188, v189
    v_exp_f32 v190, v190
    v_exp_f32 v191, v191
    v_add_f32 v10, v10, v190
    v_add_f32 v10, v10, v191
    v_cvt_pk_bf16_f32 v133, v190, v191
    v_exp_f32 v192, v192
    v_exp_f32 v193, v193
    v_add_f32 v9, v9, v192
    v_add_f32 v9, v9, v193
    v_cvt_pk_bf16_f32 v130, v192, v193
    v_exp_f32 v194, v194
    v_exp_f32 v195, v195
    v_add_f32 v9, v9, v194
    v_add_f32 v9, v9, v195
    v_cvt_pk_bf16_f32 v131, v194, v195
    v_exp_f32 v196, v196
    v_exp_f32 v197, v197
    v_add_f32 v10, v10, v196
    v_add_f32 v10, v10, v197
    v_cvt_pk_bf16_f32 v134, v196, v197
    v_exp_f32 v198, v198
    v_exp_f32 v199, v199
    v_add_f32 v10, v10, v198
    v_add_f32 v10, v10, v199
    v_cvt_pk_bf16_f32 v135, v198, v199
    s_mov_b32 s17, 0x1c000
    buffer_load_dwordx4 v[200:203], v8, s[8:11], s17 offen offset:0
    buffer_load_dwordx4 v[204:207], v8, s[8:11], s17 offen offset:1024
    buffer_load_dwordx4 v[208:211], v8, s[8:11], s17 offen offset:2048
    buffer_load_dwordx4 v[212:215], v8, s[8:11], s17 offen offset:3072
    s_waitcnt vmcnt(3)
    v_mfma_f32_16x16x32_bf16 v[184:187], v[200:203], v[152:155], v[216:219]
    v_mfma_f32_16x16x32_bf16 v[188:191], v[200:203], v[168:171], v[220:223]
    s_waitcnt vmcnt(2)
    v_mfma_f32_16x16x32_bf16 v[192:195], v[204:207], v[152:155], v[216:219]
    v_mfma_f32_16x16x32_bf16 v[196:199], v[204:207], v[168:171], v[220:223]
    s_waitcnt vmcnt(1)
    v_mfma_f32_16x16x32_bf16 v[184:187], v[208:211], v[156:159], v[184:187]
    v_mfma_f32_16x16x32_bf16 v[188:191], v[208:211], v[172:175], v[188:191]
    s_waitcnt vmcnt(0)
    v_mfma_f32_16x16x32_bf16 v[192:195], v[212:215], v[156:159], v[192:195]
    v_mfma_f32_16x16x32_bf16 v[196:199], v[212:215], v[172:175], v[196:199]
    s_mov_b32 s17, 0x1d000
    buffer_load_dwordx4 v[200:203], v8, s[8:11], s17 offen offset:0
    buffer_load_dwordx4 v[204:207], v8, s[8:11], s17 offen offset:1024
    buffer_load_dwordx4 v[208:211], v8, s[8:11], s17 offen offset:2048
    buffer_load_dwordx4 v[212:215], v8, s[8:11], s17 offen offset:3072
    s_waitcnt vmcnt(3)
    v_mfma_f32_16x16x32_bf16 v[184:187], v[200:203], v[160:163], v[184:187]
    v_mfma_f32_16x16x32_bf16 v[188:191], v[200:203], v[176:179], v[188:191]
    s_waitcnt vmcnt(2)
    v_mfma_f32_16x16x32_bf16 v[192:195], v[204:207], v[160:163], v[192:195]
    v_mfma_f32_16x16x32_bf16 v[196:199], v[204:207], v[176:179], v[196:199]
    s_waitcnt vmcnt(1)
    v_mfma_f32_16x16x32_bf16 v[184:187], v[208:211], v[164:167], v[184:187]
    v_mfma_f32_16x16x32_bf16 v[188:191], v[208:211], v[180:183], v[188:191]
    s_waitcnt vmcnt(0)
    v_mfma_f32_16x16x32_bf16 v[192:195], v[212:215], v[164:167], v[192:195]
    v_mfma_f32_16x16x32_bf16 v[196:199], v[212:215], v[180:183], v[196:199]
    s_nop 3
    v_exp_f32 v184, v184
    v_exp_f32 v185, v185
    v_add_f32 v9, v9, v184
    v_add_f32 v9, v9, v185
    v_cvt_pk_bf16_f32 v136, v184, v185
    v_exp_f32 v186, v186
    v_exp_f32 v187, v187
    v_add_f32 v9, v9, v186
    v_add_f32 v9, v9, v187
    v_cvt_pk_bf16_f32 v137, v186, v187
    v_exp_f32 v188, v188
    v_exp_f32 v189, v189
    v_add_f32 v10, v10, v188
    v_add_f32 v10, v10, v189
    v_cvt_pk_bf16_f32 v140, v188, v189
    v_exp_f32 v190, v190
    v_exp_f32 v191, v191
    v_add_f32 v10, v10, v190
    v_add_f32 v10, v10, v191
    v_cvt_pk_bf16_f32 v141, v190, v191
    v_exp_f32 v192, v192
    v_exp_f32 v193, v193
    v_add_f32 v9, v9, v192
    v_add_f32 v9, v9, v193
    v_cvt_pk_bf16_f32 v138, v192, v193
    v_exp_f32 v194, v194
    v_exp_f32 v195, v195
    v_add_f32 v9, v9, v194
    v_add_f32 v9, v9, v195
    v_cvt_pk_bf16_f32 v139, v194, v195
    v_exp_f32 v196, v196
    v_exp_f32 v197, v197
    v_add_f32 v10, v10, v196
    v_add_f32 v10, v10, v197
    v_cvt_pk_bf16_f32 v142, v196, v197
    v_exp_f32 v198, v198
    v_exp_f32 v199, v199
    v_add_f32 v10, v10, v198
    v_add_f32 v10, v10, v199
    v_cvt_pk_bf16_f32 v143, v198, v199
    s_mov_b32 s17, 0x1e000
    buffer_load_dwordx4 v[200:203], v8, s[8:11], s17 offen offset:0
    buffer_load_dwordx4 v[204:207], v8, s[8:11], s17 offen offset:1024
    buffer_load_dwordx4 v[208:211], v8, s[8:11], s17 offen offset:2048
    buffer_load_dwordx4 v[212:215], v8, s[8:11], s17 offen offset:3072
    s_waitcnt vmcnt(3)
    v_mfma_f32_16x16x32_bf16 v[184:187], v[200:203], v[152:155], v[216:219]
    v_mfma_f32_16x16x32_bf16 v[188:191], v[200:203], v[168:171], v[220:223]
    s_waitcnt vmcnt(2)
    v_mfma_f32_16x16x32_bf16 v[192:195], v[204:207], v[152:155], v[216:219]
    v_mfma_f32_16x16x32_bf16 v[196:199], v[204:207], v[168:171], v[220:223]
    s_waitcnt vmcnt(1)
    v_mfma_f32_16x16x32_bf16 v[184:187], v[208:211], v[156:159], v[184:187]
    v_mfma_f32_16x16x32_bf16 v[188:191], v[208:211], v[172:175], v[188:191]
    s_waitcnt vmcnt(0)
    v_mfma_f32_16x16x32_bf16 v[192:195], v[212:215], v[156:159], v[192:195]
    v_mfma_f32_16x16x32_bf16 v[196:199], v[212:215], v[172:175], v[196:199]
    s_mov_b32 s17, 0x1f000
    buffer_load_dwordx4 v[200:203], v8, s[8:11], s17 offen offset:0
    buffer_load_dwordx4 v[204:207], v8, s[8:11], s17 offen offset:1024
    buffer_load_dwordx4 v[208:211], v8, s[8:11], s17 offen offset:2048
    buffer_load_dwordx4 v[212:215], v8, s[8:11], s17 offen offset:3072
    s_waitcnt vmcnt(3)
    v_mfma_f32_16x16x32_bf16 v[184:187], v[200:203], v[160:163], v[184:187]
    v_mfma_f32_16x16x32_bf16 v[188:191], v[200:203], v[176:179], v[188:191]
    s_waitcnt vmcnt(2)
    v_mfma_f32_16x16x32_bf16 v[192:195], v[204:207], v[160:163], v[192:195]
    v_mfma_f32_16x16x32_bf16 v[196:199], v[204:207], v[176:179], v[196:199]
    s_waitcnt vmcnt(1)
    v_mfma_f32_16x16x32_bf16 v[184:187], v[208:211], v[164:167], v[184:187]
    v_mfma_f32_16x16x32_bf16 v[188:191], v[208:211], v[180:183], v[188:191]
    s_waitcnt vmcnt(0)
    v_mfma_f32_16x16x32_bf16 v[192:195], v[212:215], v[164:167], v[192:195]
    v_mfma_f32_16x16x32_bf16 v[196:199], v[212:215], v[180:183], v[196:199]
    s_nop 3
    v_exp_f32 v184, v184
    v_exp_f32 v185, v185
    v_add_f32 v9, v9, v184
    v_add_f32 v9, v9, v185
    v_cvt_pk_bf16_f32 v144, v184, v185
    v_exp_f32 v186, v186
    v_exp_f32 v187, v187
    v_add_f32 v9, v9, v186
    v_add_f32 v9, v9, v187
    v_cvt_pk_bf16_f32 v145, v186, v187
    v_exp_f32 v188, v188
    v_exp_f32 v189, v189
    v_add_f32 v10, v10, v188
    v_add_f32 v10, v10, v189
    v_cvt_pk_bf16_f32 v148, v188, v189
    v_exp_f32 v190, v190
    v_exp_f32 v191, v191
    v_add_f32 v10, v10, v190
    v_add_f32 v10, v10, v191
    v_cvt_pk_bf16_f32 v149, v190, v191
    v_exp_f32 v192, v192
    v_exp_f32 v193, v193
    v_add_f32 v9, v9, v192
    v_add_f32 v9, v9, v193
    v_cvt_pk_bf16_f32 v146, v192, v193
    v_exp_f32 v194, v194
    v_exp_f32 v195, v195
    v_add_f32 v9, v9, v194
    v_add_f32 v9, v9, v195
    v_cvt_pk_bf16_f32 v147, v194, v195
    v_exp_f32 v196, v196
    v_exp_f32 v197, v197
    v_add_f32 v10, v10, v196
    v_add_f32 v10, v10, v197
    v_cvt_pk_bf16_f32 v150, v196, v197
    v_exp_f32 v198, v198
    v_exp_f32 v199, v199
    v_add_f32 v10, v10, v198
    v_add_f32 v10, v10, v199
    v_cvt_pk_bf16_f32 v151, v198, v199
    v_mov_b32 v16, v9
    v_mov_b32 v18, v10
    s_nop 0
    v_permlane16_swap_b32 v9, v16
    v_permlane16_swap_b32 v10, v18
    v_add_f32 v9, v9, v16
    v_add_f32 v10, v10, v18
    v_mov_b32 v16, v9
    v_mov_b32 v18, v10
    s_nop 0
    v_permlane32_swap_b32 v9, v16
    v_permlane32_swap_b32 v10, v18
    v_add_f32 v9, v9, v16
    v_add_f32 v10, v10, v18
    s_waitcnt vmcnt(0) lgkmcnt(0)
    s_nop 15
    s_nop 3
    s_branch adaLN_cond__sliding_block_cached__moe_arch_mod__prompt_kernel_fixAb
adaLN_cond__sliding_block_cached__moe_arch_mod__prompt_kernel_mp5r:
    s_waitcnt vmcnt(0) lgkmcnt(0)
    s_nop 15
    s_nop 3
    s_mov_b32 s27, 0
adaLN_cond__sliding_block_cached__moe_arch_mod__prompt_kernel_mp5p:
    buffer_load_dword v248, v250, s[8:11], s14 offen sc1
    s_waitcnt vmcnt(0)
    v_cmp_ne_u32 vcc, s28, v248
    s_add_u32 s27, s27, 1
    s_cmp_ge_u32 s27, 65536
    s_cbranch_scc1 adaLN_cond__sliding_block_cached__moe_arch_mod__prompt_kernel_mp5g
    s_cbranch_vccnz adaLN_cond__sliding_block_cached__moe_arch_mod__prompt_kernel_mp5p
adaLN_cond__sliding_block_cached__moe_arch_mod__prompt_kernel_mp5g:
    s_waitcnt vmcnt(0) lgkmcnt(0)
    s_nop 15
    s_nop 3
    s_branch adaLN_cond__sliding_block_cached__moe_arch_mod__prompt_kernel_mp5b
adaLN_cond__sliding_block_cached__moe_arch_mod__prompt_kernel_o6r:
    s_waitcnt vmcnt(0) lgkmcnt(0)
    s_nop 15
    s_nop 3
    s_mov_b32 s27, 0
adaLN_cond__sliding_block_cached__moe_arch_mod__prompt_kernel_o6p:
    buffer_load_dword v12, v13, s[8:11], s19 offen sc1
    s_waitcnt vmcnt(0)
    v_cmp_ne_u32 vcc, s28, v12
    s_add_u32 s27, s27, 1
    s_cmp_ge_u32 s27, 65536
    s_cbranch_scc1 adaLN_cond__sliding_block_cached__moe_arch_mod__prompt_kernel_o6g
    s_cbranch_vccnz adaLN_cond__sliding_block_cached__moe_arch_mod__prompt_kernel_o6p
adaLN_cond__sliding_block_cached__moe_arch_mod__prompt_kernel_o6g:
    s_waitcnt vmcnt(0) lgkmcnt(0)
    s_nop 15
    s_nop 3
    s_branch adaLN_cond__sliding_block_cached__moe_arch_mod__prompt_kernel_o6b
adaLN_cond__sliding_block_cached__moe_arch_mod__prompt_kernel_o27r:
    s_waitcnt vmcnt(0) lgkmcnt(0)
    s_nop 15
    s_nop 3
    s_mov_b32 s27, 0
adaLN_cond__sliding_block_cached__moe_arch_mod__prompt_kernel_o27p:
    buffer_load_dword v12, v13, s[8:11], s19 offen sc1
    s_waitcnt vmcnt(0)
    v_cmp_ne_u32 vcc, s28, v12
    s_add_u32 s27, s27, 1
    s_cmp_ge_u32 s27, 65536
    s_cbranch_scc1 adaLN_cond__sliding_block_cached__moe_arch_mod__prompt_kernel_o27g
    s_cbranch_vccnz adaLN_cond__sliding_block_cached__moe_arch_mod__prompt_kernel_o27p
adaLN_cond__sliding_block_cached__moe_arch_mod__prompt_kernel_o27g:
    s_waitcnt vmcnt(0) lgkmcnt(0)
    s_nop 15
    s_nop 3
    s_branch adaLN_cond__sliding_block_cached__moe_arch_mod__prompt_kernel_o27b
adaLN_cond__sliding_block_cached__moe_arch_mod__prompt_kernel_o28r:
    s_waitcnt vmcnt(0) lgkmcnt(0)
    s_nop 15
    s_nop 3
    s_mov_b32 s27, 0
adaLN_cond__sliding_block_cached__moe_arch_mod__prompt_kernel_o28p:
    buffer_load_dword v12, v13, s[8:11], s19 offen sc1
    s_waitcnt vmcnt(0)
    v_cmp_ne_u32 vcc, s28, v12
    s_add_u32 s27, s27, 1
    s_cmp_ge_u32 s27, 65536
    s_cbranch_scc1 adaLN_cond__sliding_block_cached__moe_arch_mod__prompt_kernel_o28g
    s_cbranch_vccnz adaLN_cond__sliding_block_cached__moe_arch_mod__prompt_kernel_o28p
adaLN_cond__sliding_block_cached__moe_arch_mod__prompt_kernel_o28g:
    s_waitcnt vmcnt(0) lgkmcnt(0)
    s_nop 15
    s_nop 3
    s_branch adaLN_cond__sliding_block_cached__moe_arch_mod__prompt_kernel_o28b
adaLN_cond__sliding_block_cached__moe_arch_mod__prompt_kernel_o29r:
    s_waitcnt vmcnt(0) lgkmcnt(0)
    s_nop 15
    s_nop 3
    s_mov_b32 s27, 0
adaLN_cond__sliding_block_cached__moe_arch_mod__prompt_kernel_o29p:
    buffer_load_dword v12, v13, s[8:11], s19 offen sc1
    s_waitcnt vmcnt(0)
    v_cmp_ne_u32 vcc, s28, v12
    s_add_u32 s27, s27, 1
    s_cmp_ge_u32 s27, 65536
    s_cbranch_scc1 adaLN_cond__sliding_block_cached__moe_arch_mod__prompt_kernel_o29g
    s_cbranch_vccnz adaLN_cond__sliding_block_cached__moe_arch_mod__prompt_kernel_o29p
adaLN_cond__sliding_block_cached__moe_arch_mod__prompt_kernel_o29g:
    s_waitcnt vmcnt(0) lgkmcnt(0)
    s_nop 15
    s_nop 3
    s_branch adaLN_cond__sliding_block_cached__moe_arch_mod__prompt_kernel_o29b
adaLN_cond__sliding_block_cached__moe_arch_mod__prompt_kernel_mf10r:
    s_waitcnt vmcnt(0) lgkmcnt(0)
    s_nop 15
    s_nop 3
    s_mov_b32 s27, 0
adaLN_cond__sliding_block_cached__moe_arch_mod__prompt_kernel_mf10p:
    s_mov_b32 s16, 0x544000
    buffer_load_dwordx4 v[184:187], v2, s[8:11], s16 offen sc1
    s_waitcnt vmcnt(0)
    v_xor_b32 v16, s28, v184
    v_xor_b32 v17, s28, v185
    v_xor_b32 v18, s28, v186
    v_xor_b32 v19, s28, v187
    v_or3_b32 v16, v16, v17, v18
    v_or_b32 v16, v16, v19
    v_cmp_ne_u32 vcc, 0, v16
    s_add_u32 s27, s27, 1
    s_cmp_ge_u32 s27, 65536
    s_cbranch_scc1 adaLN_cond__sliding_block_cached__moe_arch_mod__prompt_kernel_mf10g
    s_cbranch_vccnz adaLN_cond__sliding_block_cached__moe_arch_mod__prompt_kernel_mf10p
adaLN_cond__sliding_block_cached__moe_arch_mod__prompt_kernel_mf10g:
    s_waitcnt vmcnt(0) lgkmcnt(0)
    s_nop 15
    s_nop 3
    s_branch adaLN_cond__sliding_block_cached__moe_arch_mod__prompt_kernel_mf10b
adaLN_cond__sliding_block_cached__moe_arch_mod__prompt_kernel_kv16r:
    s_waitcnt vmcnt(0) lgkmcnt(0)
    s_nop 15
    s_nop 3
    s_mov_b32 s27, 0
adaLN_cond__sliding_block_cached__moe_arch_mod__prompt_kernel_kv16p:
    buffer_load_dwordx4 v[12:15], v21, s[8:11], s18 offen sc1
    s_waitcnt vmcnt(0)
    v_xor_b32 v8, s28, v12
    v_xor_b32 v20, s28, v13
    v_or_b32 v8, v8, v20
    v_xor_b32 v20, s28, v14
    v_or_b32 v8, v8, v20
    v_xor_b32 v20, s28, v15
    v_or_b32 v8, v8, v20
    v_cmp_ne_u32 vcc, 0, v8
    s_add_u32 s27, s27, 1
    s_cmp_ge_u32 s27, 65536
    s_cbranch_scc1 adaLN_cond__sliding_block_cached__moe_arch_mod__prompt_kernel_kv16g
    s_cbranch_vccnz adaLN_cond__sliding_block_cached__moe_arch_mod__prompt_kernel_kv16p
adaLN_cond__sliding_block_cached__moe_arch_mod__prompt_kernel_kv16g:
    s_waitcnt vmcnt(0) lgkmcnt(0)
    s_nop 15
    s_nop 3
    s_branch adaLN_cond__sliding_block_cached__moe_arch_mod__prompt_kernel_kv16b
adaLN_cond__sliding_block_cached__moe_arch_mod__prompt_kernel_fixB:
    s_waitcnt vmcnt(0) lgkmcnt(0)
    s_nop 15
    s_nop 3
    s_lshr_b32 s16, s12, 3
    s_lshl_b32 s16, s16, 17
    s_add_u32 s16, s16, 0x400000
    v_add_u32 v8, s16, v2
    v_mov_b32 v16, 0xff7fffff
    v_mov_b32 v17, 0xff7fffff
    s_mov_b32 s16, 0
adaLN_cond__sliding_block_cached__moe_arch_mod__prompt_kernel_fixBm:
    s_add_u32 s17, s16, 0
    buffer_load_dwordx4 v[200:203], v8, s[8:11], s17 offen offset:0
    buffer_load_dwordx4 v[204:207], v8, s[8:11], s17 offen offset:1024
    buffer_load_dwordx4 v[208:211], v8, s[8:11], s17 offen offset:2048
    buffer_load_dwordx4 v[212:215], v8, s[8:11], s17 offen offset:3072
    s_waitcnt vmcnt(3)
    v_mfma_f32_16x16x32_bf16 v[184:187], v[200:203], v[152:155], 0
    v_mfma_f32_16x16x32_bf16 v[188:191], v[200:203], v[168:171], 0
    s_waitcnt vmcnt(2)
    v_mfma_f32_16x16x32_bf16 v[192:195], v[204:207], v[152:155], 0
    v_mfma_f32_16x16x32_bf16 v[196:199], v[204:207], v[168:171], 0
    s_waitcnt vmcnt(1)
    v_mfma_f32_16x16x32_bf16 v[184:187], v[208:211], v[156:159], v[184:187]
    v_mfma_f32_16x16x32_bf16 v[188:191], v[208:211], v[172:175], v[188:191]
    s_waitcnt vmcnt(0)
    v_mfma_f32_16x16x32_bf16 v[192:195], v[212:215], v[156:159], v[192:195]
    v_mfma_f32_16x16x32_bf16 v[196:199], v[212:215], v[172:175], v[196:199]
    s_add_u32 s17, s16, 4096
    buffer_load_dwordx4 v[200:203], v8, s[8:11], s17 offen offset:0
    buffer_load_dwordx4 v[204:207], v8, s[8:11], s17 offen offset:1024
    buffer_load_dwordx4 v[208:211], v8, s[8:11], s17 offen offset:2048
    buffer_load_dwordx4 v[212:215], v8, s[8:11], s17 offen offset:3072
    s_waitcnt vmcnt(3)
    v_mfma_f32_16x16x32_bf16 v[184:187], v[200:203], v[160:163], v[184:187]
    v_mfma_f32_16x16x32_bf16 v[188:191], v[200:203], v[176:179], v[188:191]
    s_waitcnt vmcnt(2)
    v_mfma_f32_16x16x32_bf16 v[192:195], v[204:207], v[160:163], v[192:195]
    v_mfma_f32_16x16x32_bf16 v[196:199], v[204:207], v[176:179], v[196:199]
    s_waitcnt vmcnt(1)
    v_mfma_f32_16x16x32_bf16 v[184:187], v[208:211], v[164:167], v[184:187]
    v_mfma_f32_16x16x32_bf16 v[188:191], v[208:211], v[180:183], v[188:191]
    s_waitcnt vmcnt(0)
    v_mfma_f32_16x16x32_bf16 v[192:195], v[212:215], v[164:167], v[192:195]
    v_mfma_f32_16x16x32_bf16 v[196:199], v[212:215], v[180:183], v[196:199]
    s_nop 3
    v_max3_f32 v16, v16, v184, v185
    v_max3_f32 v16, v16, v186, v187
    v_max3_f32 v17, v17, v188, v189
    v_max3_f32 v17, v17, v190, v191
    v_max3_f32 v16, v16, v192, v193
    v_max3_f32 v16, v16, v194, v195
    v_max3_f32 v17, v17, v196, v197
    v_max3_f32 v17, v17, v198, v199
    s_add_u32 s16, s16, 8192
    s_cmp_lt_u32 s16, 0x20000
    s_cbranch_scc1 adaLN_cond__sliding_block_cached__moe_arch_mod__prompt_kernel_fixBm
    v_mov_b32 v18, v16
    v_mov_b32 v19, v17
    s_nop 0
    v_permlane16_swap_b32 v16, v18
    v_permlane16_swap_b32 v17, v19
    v_max_f32 v16, v16, v18
    v_max_f32 v17, v17, v19
    v_mov_b32 v18, v16
    v_mov_b32 v19, v17
    s_nop 0
    v_permlane32_swap_b32 v16, v18
    v_permlane32_swap_b32 v17, v19
    v_max_f32 v16, v16, v18
    v_max_f32 v17, v17, v19
    v_sub_f32 v216, 0, v16
    v_sub_f32 v217, 0, v16
    v_sub_f32 v218, 0, v16
    v_sub_f32 v219, 0, v16
    v_sub_f32 v220, 0, v17
    v_sub_f32 v221, 0, v17
    v_sub_f32 v222, 0, v17
    v_sub_f32 v223, 0, v17
    s_mov_b32 s17, 0x0
    buffer_load_dwordx4 v[200:203], v8, s[8:11], s17 offen offset:0
    buffer_load_dwordx4 v[204:207], v8, s[8:11], s17 offen offset:1024
    buffer_load_dwordx4 v[208:211], v8, s[8:11], s17 offen offset:2048
    buffer_load_dwordx4 v[212:215], v8, s[8:11], s17 offen offset:3072
    s_waitcnt vmcnt(3)
    v_mfma_f32_16x16x32_bf16 v[184:187], v[200:203], v[152:155], v[216:219]
    v_mfma_f32_16x16x32_bf16 v[188:191], v[200:203], v[168:171], v[220:223]
    s_waitcnt vmcnt(2)
    v_mfma_f32_16x16x32_bf16 v[192:195], v[204:207], v[152:155], v[216:219]
    v_mfma_f32_16x16x32_bf16 v[196:199], v[204:207], v[168:171], v[220:223]
    s_waitcnt vmcnt(1)
    v_mfma_f32_16x16x32_bf16 v[184:187], v[208:211], v[156:159], v[184:187]
    v_mfma_f32_16x16x32_bf16 v[188:191], v[208:211], v[172:175], v[188:191]
    s_waitcnt vmcnt(0)
    v_mfma_f32_16x16x32_bf16 v[192:195], v[212:215], v[156:159], v[192:195]
    v_mfma_f32_16x16x32_bf16 v[196:199], v[212:215], v[172:175], v[196:199]
    s_mov_b32 s17, 0x1000
    buffer_load_dwordx4 v[200:203], v8, s[8:11], s17 offen offset:0
    buffer_load_dwordx4 v[204:207], v8, s[8:11], s17 offen offset:1024
    buffer_load_dwordx4 v[208:211], v8, s[8:11], s17 offen offset:2048
    buffer_load_dwordx4 v[212:215], v8, s[8:11], s17 offen offset:3072
    s_waitcnt vmcnt(3)
    v_mfma_f32_16x16x32_bf16 v[184:187], v[200:203], v[160:163], v[184:187]
    v_mfma_f32_16x16x32_bf16 v[188:191], v[200:203], v[176:179], v[188:191]
    s_waitcnt vmcnt(2)
    v_mfma_f32_16x16x32_bf16 v[192:195], v[204:207], v[160:163], v[192:195]
    v_mfma_f32_16x16x32_bf16 v[196:199], v[204:207], v[176:179], v[196:199]
    s_waitcnt vmcnt(1)
    v_mfma_f32_16x16x32_bf16 v[184:187], v[208:211], v[164:167], v[184:187]
    v_mfma_f32_16x16x32_bf16 v[188:191], v[208:211], v[180:183], v[188:191]
    s_waitcnt vmcnt(0)
    v_mfma_f32_16x16x32_bf16 v[192:195], v[212:215], v[164:167], v[192:195]
    v_mfma_f32_16x16x32_bf16 v[196:199], v[212:215], v[180:183], v[196:199]
    s_nop 3
    v_exp_f32 v184, v184
    v_exp_f32 v185, v185
    s_nop 0
    v_add_f32 v9, v184, v185
    v_cvt_pk_bf16_f32 v24, v184, v185
    v_exp_f32 v186, v186
    v_exp_f32 v187, v187
    v_add_f32 v9, v9, v186
    v_add_f32 v9, v9, v187
    v_cvt_pk_bf16_f32 v25, v186, v187
    v_exp_f32 v188, v188
    v_exp_f32 v189, v189
    s_nop 0
    v_add_f32 v10, v188, v189
    v_cvt_pk_bf16_f32 v28, v188, v189
    v_exp_f32 v190, v190
    v_exp_f32 v191, v191
    v_add_f32 v10, v10, v190
    v_add_f32 v10, v10, v191
    v_cvt_pk_bf16_f32 v29, v190, v191
    v_exp_f32 v192, v192
    v_exp_f32 v193, v193
    v_add_f32 v9, v9, v192
    v_add_f32 v9, v9, v193
    v_cvt_pk_bf16_f32 v26, v192, v193
    v_exp_f32 v194, v194
    v_exp_f32 v195, v195
    v_add_f32 v9, v9, v194
    v_add_f32 v9, v9, v195
    v_cvt_pk_bf16_f32 v27, v194, v195
    v_exp_f32 v196, v196
    v_exp_f32 v197, v197
    v_add_f32 v10, v10, v196
    v_add_f32 v10, v10, v197
    v_cvt_pk_bf16_f32 v30, v196, v197
    v_exp_f32 v198, v198
    v_exp_f32 v199, v199
    v_add_f32 v10, v10, v198
    v_add_f32 v10, v10, v199
    v_cvt_pk_bf16_f32 v31, v198, v199
    s_mov_b32 s17, 0x2000
    buffer_load_dwordx4 v[200:203], v8, s[8:11], s17 offen offset:0
    buffer_load_dwordx4 v[204:207], v8, s[8:11], s17 offen offset:1024
    buffer_load_dwordx4 v[208:211], v8, s[8:11], s17 offen offset:2048
    buffer_load_dwordx4 v[212:215], v8, s[8:11], s17 offen offset:3072
    s_waitcnt vmcnt(3)
    v_mfma_f32_16x16x32_bf16 v[184:187], v[200:203], v[152:155], v[216:219]
    v_mfma_f32_16x16x32_bf16 v[188:191], v[200:203], v[168:171], v[220:223]
    s_waitcnt vmcnt(2)
    v_mfma_f32_16x16x32_bf16 v[192:195], v[204:207], v[152:155], v[216:219]
    v_mfma_f32_16x16x32_bf16 v[196:199], v[204:207], v[168:171], v[220:223]
    s_waitcnt vmcnt(1)
    v_mfma_f32_16x16x32_bf16 v[184:187], v[208:211], v[156:159], v[184:187]
    v_mfma_f32_16x16x32_bf16 v[188:191], v[208:211], v[172:175], v[188:191]
    s_waitcnt vmcnt(0)
    v_mfma_f32_16x16x32_bf16 v[192:195], v[212:215], v[156:159], v[192:195]
    v_mfma_f32_16x16x32_bf16 v[196:199], v[212:215], v[172:175], v[196:199]
    s_mov_b32 s17, 0x3000
    buffer_load_dwordx4 v[200:203], v8, s[8:11], s17 offen offset:0
    buffer_load_dwordx4 v[204:207], v8, s[8:11], s17 offen offset:1024
    buffer_load_dwordx4 v[208:211], v8, s[8:11], s17 offen offset:2048
    buffer_load_dwordx4 v[212:215], v8, s[8:11], s17 offen offset:3072
    s_waitcnt vmcnt(3)
    v_mfma_f32_16x16x32_bf16 v[184:187], v[200:203], v[160:163], v[184:187]
    v_mfma_f32_16x16x32_bf16 v[188:191], v[200:203], v[176:179], v[188:191]
    s_waitcnt vmcnt(2)
    v_mfma_f32_16x16x32_bf16 v[192:195], v[204:207], v[160:163], v[192:195]
    v_mfma_f32_16x16x32_bf16 v[196:199], v[204:207], v[176:179], v[196:199]
    s_waitcnt vmcnt(1)
    v_mfma_f32_16x16x32_bf16 v[184:187], v[208:211], v[164:167], v[184:187]
    v_mfma_f32_16x16x32_bf16 v[188:191], v[208:211], v[180:183], v[188:191]
    s_waitcnt vmcnt(0)
    v_mfma_f32_16x16x32_bf16 v[192:195], v[212:215], v[164:167], v[192:195]
    v_mfma_f32_16x16x32_bf16 v[196:199], v[212:215], v[180:183], v[196:199]
    s_nop 3
    v_exp_f32 v184, v184
    v_exp_f32 v185, v185
    v_add_f32 v9, v9, v184
    v_add_f32 v9, v9, v185
    v_cvt_pk_bf16_f32 v32, v184, v185
    v_exp_f32 v186, v186
    v_exp_f32 v187, v187
    v_add_f32 v9, v9, v186
    v_add_f32 v9, v9, v187
    v_cvt_pk_bf16_f32 v33, v186, v187
    v_exp_f32 v188, v188
    v_exp_f32 v189, v189
    v_add_f32 v10, v10, v188
    v_add_f32 v10, v10, v189
    v_cvt_pk_bf16_f32 v36, v188, v189
    v_exp_f32 v190, v190
    v_exp_f32 v191, v191
    v_add_f32 v10, v10, v190
    v_add_f32 v10, v10, v191
    v_cvt_pk_bf16_f32 v37, v190, v191
    v_exp_f32 v192, v192
    v_exp_f32 v193, v193
    v_add_f32 v9, v9, v192
    v_add_f32 v9, v9, v193
    v_cvt_pk_bf16_f32 v34, v192, v193
    v_exp_f32 v194, v194
    v_exp_f32 v195, v195
    v_add_f32 v9, v9, v194
    v_add_f32 v9, v9, v195
    v_cvt_pk_bf16_f32 v35, v194, v195
    v_exp_f32 v196, v196
    v_exp_f32 v197, v197
    v_add_f32 v10, v10, v196
    v_add_f32 v10, v10, v197
    v_cvt_pk_bf16_f32 v38, v196, v197
    v_exp_f32 v198, v198
    v_exp_f32 v199, v199
    v_add_f32 v10, v10, v198
    v_add_f32 v10, v10, v199
    v_cvt_pk_bf16_f32 v39, v198, v199
    s_mov_b32 s17, 0x4000
    buffer_load_dwordx4 v[200:203], v8, s[8:11], s17 offen offset:0
    buffer_load_dwordx4 v[204:207], v8, s[8:11], s17 offen offset:1024
    buffer_load_dwordx4 v[208:211], v8, s[8:11], s17 offen offset:2048
    buffer_load_dwordx4 v[212:215], v8, s[8:11], s17 offen offset:3072
    s_waitcnt vmcnt(3)
    v_mfma_f32_16x16x32_bf16 v[184:187], v[200:203], v[152:155], v[216:219]
    v_mfma_f32_16x16x32_bf16 v[188:191], v[200:203], v[168:171], v[220:223]
    s_waitcnt vmcnt(2)
    v_mfma_f32_16x16x32_bf16 v[192:195], v[204:207], v[152:155], v[216:219]
    v_mfma_f32_16x16x32_bf16 v[196:199], v[204:207], v[168:171], v[220:223]
    s_waitcnt vmcnt(1)
    v_mfma_f32_16x16x32_bf16 v[184:187], v[208:211], v[156:159], v[184:187]
    v_mfma_f32_16x16x32_bf16 v[188:191], v[208:211], v[172:175], v[188:191]
    s_waitcnt vmcnt(0)
    v_mfma_f32_16x16x32_bf16 v[192:195], v[212:215], v[156:159], v[192:195]
    v_mfma_f32_16x16x32_bf16 v[196:199], v[212:215], v[172:175], v[196:199]
    s_mov_b32 s17, 0x5000
    buffer_load_dwordx4 v[200:203], v8, s[8:11], s17 offen offset:0
    buffer_load_dwordx4 v[204:207], v8, s[8:11], s17 offen offset:1024
    buffer_load_dwordx4 v[208:211], v8, s[8:11], s17 offen offset:2048
    buffer_load_dwordx4 v[212:215], v8, s[8:11], s17 offen offset:3072
    s_waitcnt vmcnt(3)
    v_mfma_f32_16x16x32_bf16 v[184:187], v[200:203], v[160:163], v[184:187]
    v_mfma_f32_16x16x32_bf16 v[188:191], v[200:203], v[176:179], v[188:191]
    s_waitcnt vmcnt(2)
    v_mfma_f32_16x16x32_bf16 v[192:195], v[204:207], v[160:163], v[192:195]
    v_mfma_f32_16x16x32_bf16 v[196:199], v[204:207], v[176:179], v[196:199]
    s_waitcnt vmcnt(1)
    v_mfma_f32_16x16x32_bf16 v[184:187], v[208:211], v[164:167], v[184:187]
    v_mfma_f32_16x16x32_bf16 v[188:191], v[208:211], v[180:183], v[188:191]
    s_waitcnt vmcnt(0)
    v_mfma_f32_16x16x32_bf16 v[192:195], v[212:215], v[164:167], v[192:195]
    v_mfma_f32_16x16x32_bf16 v[196:199], v[212:215], v[180:183], v[196:199]
    s_nop 3
    v_exp_f32 v184, v184
    v_exp_f32 v185, v185
    v_add_f32 v9, v9, v184
    v_add_f32 v9, v9, v185
    v_cvt_pk_bf16_f32 v40, v184, v185
    v_exp_f32 v186, v186
    v_exp_f32 v187, v187
    v_add_f32 v9, v9, v186
    v_add_f32 v9, v9, v187
    v_cvt_pk_bf16_f32 v41, v186, v187
    v_exp_f32 v188, v188
    v_exp_f32 v189, v189
    v_add_f32 v10, v10, v188
    v_add_f32 v10, v10, v189
    v_cvt_pk_bf16_f32 v44, v188, v189
    v_exp_f32 v190, v190
    v_exp_f32 v191, v191
    v_add_f32 v10, v10, v190
    v_add_f32 v10, v10, v191
    v_cvt_pk_bf16_f32 v45, v190, v191
    v_exp_f32 v192, v192
    v_exp_f32 v193, v193
    v_add_f32 v9, v9, v192
    v_add_f32 v9, v9, v193
    v_cvt_pk_bf16_f32 v42, v192, v193
    v_exp_f32 v194, v194
    v_exp_f32 v195, v195
    v_add_f32 v9, v9, v194
    v_add_f32 v9, v9, v195
    v_cvt_pk_bf16_f32 v43, v194, v195
    v_exp_f32 v196, v196
    v_exp_f32 v197, v197
    v_add_f32 v10, v10, v196
    v_add_f32 v10, v10, v197
    v_cvt_pk_bf16_f32 v46, v196, v197
    v_exp_f32 v198, v198
    v_exp_f32 v199, v199
    v_add_f32 v10, v10, v198
    v_add_f32 v10, v10, v199
    v_cvt_pk_bf16_f32 v47, v198, v199
    s_mov_b32 s17, 0x6000
    buffer_load_dwordx4 v[200:203], v8, s[8:11], s17 offen offset:0
    buffer_load_dwordx4 v[204:207], v8, s[8:11], s17 offen offset:1024
    buffer_load_dwordx4 v[208:211], v8, s[8:11], s17 offen offset:2048
    buffer_load_dwordx4 v[212:215], v8, s[8:11], s17 offen offset:3072
    s_waitcnt vmcnt(3)
    v_mfma_f32_16x16x32_bf16 v[184:187], v[200:203], v[152:155], v[216:219]
    v_mfma_f32_16x16x32_bf16 v[188:191], v[200:203], v[168:171], v[220:223]
    s_waitcnt vmcnt(2)
    v_mfma_f32_16x16x32_bf16 v[192:195], v[204:207], v[152:155], v[216:219]
    v_mfma_f32_16x16x32_bf16 v[196:199], v[204:207], v[168:171], v[220:223]
    s_waitcnt vmcnt(1)
    v_mfma_f32_16x16x32_bf16 v[184:187], v[208:211], v[156:159], v[184:187]
    v_mfma_f32_16x16x32_bf16 v[188:191], v[208:211], v[172:175], v[188:191]
    s_waitcnt vmcnt(0)
    v_mfma_f32_16x16x32_bf16 v[192:195], v[212:215], v[156:159], v[192:195]
    v_mfma_f32_16x16x32_bf16 v[196:199], v[212:215], v[172:175], v[196:199]
    s_mov_b32 s17, 0x7000
    buffer_load_dwordx4 v[200:203], v8, s[8:11], s17 offen offset:0
    buffer_load_dwordx4 v[204:207], v8, s[8:11], s17 offen offset:1024
    buffer_load_dwordx4 v[208:211], v8, s[8:11], s17 offen offset:2048
    buffer_load_dwordx4 v[212:215], v8, s[8:11], s17 offen offset:3072
    s_waitcnt vmcnt(3)
    v_mfma_f32_16x16x32_bf16 v[184:187], v[200:203], v[160:163], v[184:187]
    v_mfma_f32_16x16x32_bf16 v[188:191], v[200:203], v[176:179], v[188:191]
    s_waitcnt vmcnt(2)
    v_mfma_f32_16x16x32_bf16 v[192:195], v[204:207], v[160:163], v[192:195]
    v_mfma_f32_16x16x32_bf16 v[196:199], v[204:207], v[176:179], v[196:199]
    s_waitcnt vmcnt(1)
    v_mfma_f32_16x16x32_bf16 v[184:187], v[208:211], v[164:167], v[184:187]
    v_mfma_f32_16x16x32_bf16 v[188:191], v[208:211], v[180:183], v[188:191]
    s_waitcnt vmcnt(0)
    v_mfma_f32_16x16x32_bf16 v[192:195], v[212:215], v[164:167], v[192:195]
    v_mfma_f32_16x16x32_bf16 v[196:199], v[212:215], v[180:183], v[196:199]
    s_nop 3
    v_exp_f32 v184, v184
    v_exp_f32 v185, v185
    v_add_f32 v9, v9, v184
    v_add_f32 v9, v9, v185
    v_cvt_pk_bf16_f32 v48, v184, v185
    v_exp_f32 v186, v186
    v_exp_f32 v187, v187
    v_add_f32 v9, v9, v186
    v_add_f32 v9, v9, v187
    v_cvt_pk_bf16_f32 v49, v186, v187
    v_exp_f32 v188, v188
    v_exp_f32 v189, v189
    v_add_f32 v10, v10, v188
    v_add_f32 v10, v10, v189
    v_cvt_pk_bf16_f32 v52, v188, v189
    v_exp_f32 v190, v190
    v_exp_f32 v191, v191
    v_add_f32 v10, v10, v190
    v_add_f32 v10, v10, v191
    v_cvt_pk_bf16_f32 v53, v190, v191
    v_exp_f32 v192, v192
    v_exp_f32 v193, v193
    v_add_f32 v9, v9, v192
    v_add_f32 v9, v9, v193
    v_cvt_pk_bf16_f32 v50, v192, v193
    v_exp_f32 v194, v194
    v_exp_f32 v195, v195
    v_add_f32 v9, v9, v194
    v_add_f32 v9, v9, v195
    v_cvt_pk_bf16_f32 v51, v194, v195
    v_exp_f32 v196, v196
    v_exp_f32 v197, v197
    v_add_f32 v10, v10, v196
    v_add_f32 v10, v10, v197
    v_cvt_pk_bf16_f32 v54, v196, v197
    v_exp_f32 v198, v198
    v_exp_f32 v199, v199
    v_add_f32 v10, v10, v198
    v_add_f32 v10, v10, v199
    v_cvt_pk_bf16_f32 v55, v198, v199
    s_mov_b32 s17, 0x8000
    buffer_load_dwordx4 v[200:203], v8, s[8:11], s17 offen offset:0
    buffer_load_dwordx4 v[204:207], v8, s[8:11], s17 offen offset:1024
    buffer_load_dwordx4 v[208:211], v8, s[8:11], s17 offen offset:2048
    buffer_load_dwordx4 v[212:215], v8, s[8:11], s17 offen offset:3072
    s_waitcnt vmcnt(3)
    v_mfma_f32_16x16x32_bf16 v[184:187], v[200:203], v[152:155], v[216:219]
    v_mfma_f32_16x16x32_bf16 v[188:191], v[200:203], v[168:171], v[220:223]
    s_waitcnt vmcnt(2)
    v_mfma_f32_16x16x32_bf16 v[192:195], v[204:207], v[152:155], v[216:219]
    v_mfma_f32_16x16x32_bf16 v[196:199], v[204:207], v[168:171], v[220:223]
    s_waitcnt vmcnt(1)
    v_mfma_f32_16x16x32_bf16 v[184:187], v[208:211], v[156:159], v[184:187]
    v_mfma_f32_16x16x32_bf16 v[188:191], v[208:211], v[172:175], v[188:191]
    s_waitcnt vmcnt(0)
    v_mfma_f32_16x16x32_bf16 v[192:195], v[212:215], v[156:159], v[192:195]
    v_mfma_f32_16x16x32_bf16 v[196:199], v[212:215], v[172:175], v[196:199]
    s_mov_b32 s17, 0x9000
    buffer_load_dwordx4 v[200:203], v8, s[8:11], s17 offen offset:0
    buffer_load_dwordx4 v[204:207], v8, s[8:11], s17 offen offset:1024
    buffer_load_dwordx4 v[208:211], v8, s[8:11], s17 offen offset:2048
    buffer_load_dwordx4 v[212:215], v8, s[8:11], s17 offen offset:3072
    s_waitcnt vmcnt(3)
    v_mfma_f32_16x16x32_bf16 v[184:187], v[200:203], v[160:163], v[184:187]
    v_mfma_f32_16x16x32_bf16 v[188:191], v[200:203], v[176:179], v[188:191]
    s_waitcnt vmcnt(2)
    v_mfma_f32_16x16x32_bf16 v[192:195], v[204:207], v[160:163], v[192:195]
    v_mfma_f32_16x16x32_bf16 v[196:199], v[204:207], v[176:179], v[196:199]
    s_waitcnt vmcnt(1)
    v_mfma_f32_16x16x32_bf16 v[184:187], v[208:211], v[164:167], v[184:187]
    v_mfma_f32_16x16x32_bf16 v[188:191], v[208:211], v[180:183], v[188:191]
    s_waitcnt vmcnt(0)
    v_mfma_f32_16x16x32_bf16 v[192:195], v[212:215], v[164:167], v[192:195]
    v_mfma_f32_16x16x32_bf16 v[196:199], v[212:215], v[180:183], v[196:199]
    s_nop 3
    v_exp_f32 v184, v184
    v_exp_f32 v185, v185
    v_add_f32 v9, v9, v184
    v_add_f32 v9, v9, v185
    v_cvt_pk_bf16_f32 v56, v184, v185
    v_exp_f32 v186, v186
    v_exp_f32 v187, v187
    v_add_f32 v9, v9, v186
    v_add_f32 v9, v9, v187
    v_cvt_pk_bf16_f32 v57, v186, v187
    v_exp_f32 v188, v188
    v_exp_f32 v189, v189
    v_add_f32 v10, v10, v188
    v_add_f32 v10, v10, v189
    v_cvt_pk_bf16_f32 v60, v188, v189
    v_exp_f32 v190, v190
    v_exp_f32 v191, v191
    v_add_f32 v10, v10, v190
    v_add_f32 v10, v10, v191
    v_cvt_pk_bf16_f32 v61, v190, v191
    v_exp_f32 v192, v192
    v_exp_f32 v193, v193
    v_add_f32 v9, v9, v192
    v_add_f32 v9, v9, v193
    v_cvt_pk_bf16_f32 v58, v192, v193
    v_exp_f32 v194, v194
    v_exp_f32 v195, v195
    v_add_f32 v9, v9, v194
    v_add_f32 v9, v9, v195
    v_cvt_pk_bf16_f32 v59, v194, v195
    v_exp_f32 v196, v196
    v_exp_f32 v197, v197
    v_add_f32 v10, v10, v196
    v_add_f32 v10, v10, v197
    v_cvt_pk_bf16_f32 v62, v196, v197
    v_exp_f32 v198, v198
    v_exp_f32 v199, v199
    v_add_f32 v10, v10, v198
    v_add_f32 v10, v10, v199
    v_cvt_pk_bf16_f32 v63, v198, v199
    s_mov_b32 s17, 0xa000
    buffer_load_dwordx4 v[200:203], v8, s[8:11], s17 offen offset:0
    buffer_load_dwordx4 v[204:207], v8, s[8:11], s17 offen offset:1024
    buffer_load_dwordx4 v[208:211], v8, s[8:11], s17 offen offset:2048
    buffer_load_dwordx4 v[212:215], v8, s[8:11], s17 offen offset:3072
    s_waitcnt vmcnt(3)
    v_mfma_f32_16x16x32_bf16 v[184:187], v[200:203], v[152:155], v[216:219]
    v_mfma_f32_16x16x32_bf16 v[188:191], v[200:203], v[168:171], v[220:223]
    s_waitcnt vmcnt(2)
    v_mfma_f32_16x16x32_bf16 v[192:195], v[204:207], v[152:155], v[216:219]
    v_mfma_f32_16x16x32_bf16 v[196:199], v[204:207], v[168:171], v[220:223]
    s_waitcnt vmcnt(1)
    v_mfma_f32_16x16x32_bf16 v[184:187], v[208:211], v[156:159], v[184:187]
    v_mfma_f32_16x16x32_bf16 v[188:191], v[208:211], v[172:175], v[188:191]
    s_waitcnt vmcnt(0)
    v_mfma_f32_16x16x32_bf16 v[192:195], v[212:215], v[156:159], v[192:195]
    v_mfma_f32_16x16x32_bf16 v[196:199], v[212:215], v[172:175], v[196:199]
    s_mov_b32 s17, 0xb000
    buffer_load_dwordx4 v[200:203], v8, s[8:11], s17 offen offset:0
    buffer_load_dwordx4 v[204:207], v8, s[8:11], s17 offen offset:1024
    buffer_load_dwordx4 v[208:211], v8, s[8:11], s17 offen offset:2048
    buffer_load_dwordx4 v[212:215], v8, s[8:11], s17 offen offset:3072
    s_waitcnt vmcnt(3)
    v_mfma_f32_16x16x32_bf16 v[184:187], v[200:203], v[160:163], v[184:187]
    v_mfma_f32_16x16x32_bf16 v[188:191], v[200:203], v[176:179], v[188:191]
    s_waitcnt vmcnt(2)
    v_mfma_f32_16x16x32_bf16 v[192:195], v[204:207], v[160:163], v[192:195]
    v_mfma_f32_16x16x32_bf16 v[196:199], v[204:207], v[176:179], v[196:199]
    s_waitcnt vmcnt(1)
    v_mfma_f32_16x16x32_bf16 v[184:187], v[208:211], v[164:167], v[184:187]
    v_mfma_f32_16x16x32_bf16 v[188:191], v[208:211], v[180:183], v[188:191]
    s_waitcnt vmcnt(0)
    v_mfma_f32_16x16x32_bf16 v[192:195], v[212:215], v[164:167], v[192:195]
    v_mfma_f32_16x16x32_bf16 v[196:199], v[212:215], v[180:183], v[196:199]
    s_nop 3
    v_exp_f32 v184, v184
    v_exp_f32 v185, v185
    v_add_f32 v9, v9, v184
    v_add_f32 v9, v9, v185
    v_cvt_pk_bf16_f32 v64, v184, v185
    v_exp_f32 v186, v186
    v_exp_f32 v187, v187
    v_add_f32 v9, v9, v186
    v_add_f32 v9, v9, v187
    v_cvt_pk_bf16_f32 v65, v186, v187
    v_exp_f32 v188, v188
    v_exp_f32 v189, v189
    v_add_f32 v10, v10, v188
    v_add_f32 v10, v10, v189
    v_cvt_pk_bf16_f32 v68, v188, v189
    v_exp_f32 v190, v190
    v_exp_f32 v191, v191
    v_add_f32 v10, v10, v190
    v_add_f32 v10, v10, v191
    v_cvt_pk_bf16_f32 v69, v190, v191
    v_exp_f32 v192, v192
    v_exp_f32 v193, v193
    v_add_f32 v9, v9, v192
    v_add_f32 v9, v9, v193
    v_cvt_pk_bf16_f32 v66, v192, v193
    v_exp_f32 v194, v194
    v_exp_f32 v195, v195
    v_add_f32 v9, v9, v194
    v_add_f32 v9, v9, v195
    v_cvt_pk_bf16_f32 v67, v194, v195
    v_exp_f32 v196, v196
    v_exp_f32 v197, v197
    v_add_f32 v10, v10, v196
    v_add_f32 v10, v10, v197
    v_cvt_pk_bf16_f32 v70, v196, v197
    v_exp_f32 v198, v198
    v_exp_f32 v199, v199
    v_add_f32 v10, v10, v198
    v_add_f32 v10, v10, v199
    v_cvt_pk_bf16_f32 v71, v198, v199
    s_mov_b32 s17, 0xc000
    buffer_load_dwordx4 v[200:203], v8, s[8:11], s17 offen offset:0
    buffer_load_dwordx4 v[204:207], v8, s[8:11], s17 offen offset:1024
    buffer_load_dwordx4 v[208:211], v8, s[8:11], s17 offen offset:2048
    buffer_load_dwordx4 v[212:215], v8, s[8:11], s17 offen offset:3072
    s_waitcnt vmcnt(3)
    v_mfma_f32_16x16x32_bf16 v[184:187], v[200:203], v[152:155], v[216:219]
    v_mfma_f32_16x16x32_bf16 v[188:191], v[200:203], v[168:171], v[220:223]
    s_waitcnt vmcnt(2)
    v_mfma_f32_16x16x32_bf16 v[192:195], v[204:207], v[152:155], v[216:219]
    v_mfma_f32_16x16x32_bf16 v[196:199], v[204:207], v[168:171], v[220:223]
    s_waitcnt vmcnt(1)
    v_mfma_f32_16x16x32_bf16 v[184:187], v[208:211], v[156:159], v[184:187]
    v_mfma_f32_16x16x32_bf16 v[188:191], v[208:211], v[172:175], v[188:191]
    s_waitcnt vmcnt(0)
    v_mfma_f32_16x16x32_bf16 v[192:195], v[212:215], v[156:159], v[192:195]
    v_mfma_f32_16x16x32_bf16 v[196:199], v[212:215], v[172:175], v[196:199]
    s_mov_b32 s17, 0xd000
    buffer_load_dwordx4 v[200:203], v8, s[8:11], s17 offen offset:0
    buffer_load_dwordx4 v[204:207], v8, s[8:11], s17 offen offset:1024
    buffer_load_dwordx4 v[208:211], v8, s[8:11], s17 offen offset:2048
    buffer_load_dwordx4 v[212:215], v8, s[8:11], s17 offen offset:3072
    s_waitcnt vmcnt(3)
    v_mfma_f32_16x16x32_bf16 v[184:187], v[200:203], v[160:163], v[184:187]
    v_mfma_f32_16x16x32_bf16 v[188:191], v[200:203], v[176:179], v[188:191]
    s_waitcnt vmcnt(2)
    v_mfma_f32_16x16x32_bf16 v[192:195], v[204:207], v[160:163], v[192:195]
    v_mfma_f32_16x16x32_bf16 v[196:199], v[204:207], v[176:179], v[196:199]
    s_waitcnt vmcnt(1)
    v_mfma_f32_16x16x32_bf16 v[184:187], v[208:211], v[164:167], v[184:187]
    v_mfma_f32_16x16x32_bf16 v[188:191], v[208:211], v[180:183], v[188:191]
    s_waitcnt vmcnt(0)
    v_mfma_f32_16x16x32_bf16 v[192:195], v[212:215], v[164:167], v[192:195]
    v_mfma_f32_16x16x32_bf16 v[196:199], v[212:215], v[180:183], v[196:199]
    s_nop 3
    v_exp_f32 v184, v184
    v_exp_f32 v185, v185
    v_add_f32 v9, v9, v184
    v_add_f32 v9, v9, v185
    v_cvt_pk_bf16_f32 v72, v184, v185
    v_exp_f32 v186, v186
    v_exp_f32 v187, v187
    v_add_f32 v9, v9, v186
    v_add_f32 v9, v9, v187
    v_cvt_pk_bf16_f32 v73, v186, v187
    v_exp_f32 v188, v188
    v_exp_f32 v189, v189
    v_add_f32 v10, v10, v188
    v_add_f32 v10, v10, v189
    v_cvt_pk_bf16_f32 v76, v188, v189
    v_exp_f32 v190, v190
    v_exp_f32 v191, v191
    v_add_f32 v10, v10, v190
    v_add_f32 v10, v10, v191
    v_cvt_pk_bf16_f32 v77, v190, v191
    v_exp_f32 v192, v192
    v_exp_f32 v193, v193
    v_add_f32 v9, v9, v192
    v_add_f32 v9, v9, v193
    v_cvt_pk_bf16_f32 v74, v192, v193
    v_exp_f32 v194, v194
    v_exp_f32 v195, v195
    v_add_f32 v9, v9, v194
    v_add_f32 v9, v9, v195
    v_cvt_pk_bf16_f32 v75, v194, v195
    v_exp_f32 v196, v196
    v_exp_f32 v197, v197
    v_add_f32 v10, v10, v196
    v_add_f32 v10, v10, v197
    v_cvt_pk_bf16_f32 v78, v196, v197
    v_exp_f32 v198, v198
    v_exp_f32 v199, v199
    v_add_f32 v10, v10, v198
    v_add_f32 v10, v10, v199
    v_cvt_pk_bf16_f32 v79, v198, v199
    s_mov_b32 s17, 0xe000
    buffer_load_dwordx4 v[200:203], v8, s[8:11], s17 offen offset:0
    buffer_load_dwordx4 v[204:207], v8, s[8:11], s17 offen offset:1024
    buffer_load_dwordx4 v[208:211], v8, s[8:11], s17 offen offset:2048
    buffer_load_dwordx4 v[212:215], v8, s[8:11], s17 offen offset:3072
    s_waitcnt vmcnt(3)
    v_mfma_f32_16x16x32_bf16 v[184:187], v[200:203], v[152:155], v[216:219]
    v_mfma_f32_16x16x32_bf16 v[188:191], v[200:203], v[168:171], v[220:223]
    s_waitcnt vmcnt(2)
    v_mfma_f32_16x16x32_bf16 v[192:195], v[204:207], v[152:155], v[216:219]
    v_mfma_f32_16x16x32_bf16 v[196:199], v[204:207], v[168:171], v[220:223]
    s_waitcnt vmcnt(1)
    v_mfma_f32_16x16x32_bf16 v[184:187], v[208:211], v[156:159], v[184:187]
    v_mfma_f32_16x16x32_bf16 v[188:191], v[208:211], v[172:175], v[188:191]
    s_waitcnt vmcnt(0)
    v_mfma_f32_16x16x32_bf16 v[192:195], v[212:215], v[156:159], v[192:195]
    v_mfma_f32_16x16x32_bf16 v[196:199], v[212:215], v[172:175], v[196:199]
    s_mov_b32 s17, 0xf000
    buffer_load_dwordx4 v[200:203], v8, s[8:11], s17 offen offset:0
    buffer_load_dwordx4 v[204:207], v8, s[8:11], s17 offen offset:1024
    buffer_load_dwordx4 v[208:211], v8, s[8:11], s17 offen offset:2048
    buffer_load_dwordx4 v[212:215], v8, s[8:11], s17 offen offset:3072
    s_waitcnt vmcnt(3)
    v_mfma_f32_16x16x32_bf16 v[184:187], v[200:203], v[160:163], v[184:187]
    v_mfma_f32_16x16x32_bf16 v[188:191], v[200:203], v[176:179], v[188:191]
    s_waitcnt vmcnt(2)
    v_mfma_f32_16x16x32_bf16 v[192:195], v[204:207], v[160:163], v[192:195]
    v_mfma_f32_16x16x32_bf16 v[196:199], v[204:207], v[176:179], v[196:199]
    s_waitcnt vmcnt(1)
    v_mfma_f32_16x16x32_bf16 v[184:187], v[208:211], v[164:167], v[184:187]
    v_mfma_f32_16x16x32_bf16 v[188:191], v[208:211], v[180:183], v[188:191]
    s_waitcnt vmcnt(0)
    v_mfma_f32_16x16x32_bf16 v[192:195], v[212:215], v[164:167], v[192:195]
    v_mfma_f32_16x16x32_bf16 v[196:199], v[212:215], v[180:183], v[196:199]
    s_nop 3
    v_exp_f32 v184, v184
    v_exp_f32 v185, v185
    v_add_f32 v9, v9, v184
    v_add_f32 v9, v9, v185
    v_cvt_pk_bf16_f32 v80, v184, v185
    v_exp_f32 v186, v186
    v_exp_f32 v187, v187
    v_add_f32 v9, v9, v186
    v_add_f32 v9, v9, v187
    v_cvt_pk_bf16_f32 v81, v186, v187
    v_exp_f32 v188, v188
    v_exp_f32 v189, v189
    v_add_f32 v10, v10, v188
    v_add_f32 v10, v10, v189
    v_cvt_pk_bf16_f32 v84, v188, v189
    v_exp_f32 v190, v190
    v_exp_f32 v191, v191
    v_add_f32 v10, v10, v190
    v_add_f32 v10, v10, v191
    v_cvt_pk_bf16_f32 v85, v190, v191
    v_exp_f32 v192, v192
    v_exp_f32 v193, v193
    v_add_f32 v9, v9, v192
    v_add_f32 v9, v9, v193
    v_cvt_pk_bf16_f32 v82, v192, v193
    v_exp_f32 v194, v194
    v_exp_f32 v195, v195
    v_add_f32 v9, v9, v194
    v_add_f32 v9, v9, v195
    v_cvt_pk_bf16_f32 v83, v194, v195
    v_exp_f32 v196, v196
    v_exp_f32 v197, v197
    v_add_f32 v10, v10, v196
    v_add_f32 v10, v10, v197
    v_cvt_pk_bf16_f32 v86, v196, v197
    v_exp_f32 v198, v198
    v_exp_f32 v199, v199
    v_add_f32 v10, v10, v198
    v_add_f32 v10, v10, v199
    v_cvt_pk_bf16_f32 v87, v198, v199
    s_mov_b32 s17, 0x10000
    buffer_load_dwordx4 v[200:203], v8, s[8:11], s17 offen offset:0
    buffer_load_dwordx4 v[204:207], v8, s[8:11], s17 offen offset:1024
    buffer_load_dwordx4 v[208:211], v8, s[8:11], s17 offen offset:2048
    buffer_load_dwordx4 v[212:215], v8, s[8:11], s17 offen offset:3072
    s_waitcnt vmcnt(3)
    v_mfma_f32_16x16x32_bf16 v[184:187], v[200:203], v[152:155], v[216:219]
    v_mfma_f32_16x16x32_bf16 v[188:191], v[200:203], v[168:171], v[220:223]
    s_waitcnt vmcnt(2)
    v_mfma_f32_16x16x32_bf16 v[192:195], v[204:207], v[152:155], v[216:219]
    v_mfma_f32_16x16x32_bf16 v[196:199], v[204:207], v[168:171], v[220:223]
    s_waitcnt vmcnt(1)
    v_mfma_f32_16x16x32_bf16 v[184:187], v[208:211], v[156:159], v[184:187]
    v_mfma_f32_16x16x32_bf16 v[188:191], v[208:211], v[172:175], v[188:191]
    s_waitcnt vmcnt(0)
    v_mfma_f32_16x16x32_bf16 v[192:195], v[212:215], v[156:159], v[192:195]
    v_mfma_f32_16x16x32_bf16 v[196:199], v[212:215], v[172:175], v[196:199]
    s_mov_b32 s17, 0x11000
    buffer_load_dwordx4 v[200:203], v8, s[8:11], s17 offen offset:0
    buffer_load_dwordx4 v[204:207], v8, s[8:11], s17 offen offset:1024
    buffer_load_dwordx4 v[208:211], v8, s[8:11], s17 offen offset:2048
    buffer_load_dwordx4 v[212:215], v8, s[8:11], s17 offen offset:3072
    s_waitcnt vmcnt(3)
    v_mfma_f32_16x16x32_bf16 v[184:187], v[200:203], v[160:163], v[184:187]
    v_mfma_f32_16x16x32_bf16 v[188:191], v[200:203], v[176:179], v[188:191]
    s_waitcnt vmcnt(2)
    v_mfma_f32_16x16x32_bf16 v[192:195], v[204:207], v[160:163], v[192:195]
    v_mfma_f32_16x16x32_bf16 v[196:199], v[204:207], v[176:179], v[196:199]
    s_waitcnt vmcnt(1)
    v_mfma_f32_16x16x32_bf16 v[184:187], v[208:211], v[164:167], v[184:187]
    v_mfma_f32_16x16x32_bf16 v[188:191], v[208:211], v[180:183], v[188:191]
    s_waitcnt vmcnt(0)
    v_mfma_f32_16x16x32_bf16 v[192:195], v[212:215], v[164:167], v[192:195]
    v_mfma_f32_16x16x32_bf16 v[196:199], v[212:215], v[180:183], v[196:199]
    s_nop 3
    v_exp_f32 v184, v184
    v_exp_f32 v185, v185
    v_add_f32 v9, v9, v184
    v_add_f32 v9, v9, v185
    v_cvt_pk_bf16_f32 v88, v184, v185
    v_exp_f32 v186, v186
    v_exp_f32 v187, v187
    v_add_f32 v9, v9, v186
    v_add_f32 v9, v9, v187
    v_cvt_pk_bf16_f32 v89, v186, v187
    v_exp_f32 v188, v188
    v_exp_f32 v189, v189
    v_add_f32 v10, v10, v188
    v_add_f32 v10, v10, v189
    v_cvt_pk_bf16_f32 v92, v188, v189
    v_exp_f32 v190, v190
    v_exp_f32 v191, v191
    v_add_f32 v10, v10, v190
    v_add_f32 v10, v10, v191
    v_cvt_pk_bf16_f32 v93, v190, v191
    v_exp_f32 v192, v192
    v_exp_f32 v193, v193
    v_add_f32 v9, v9, v192
    v_add_f32 v9, v9, v193
    v_cvt_pk_bf16_f32 v90, v192, v193
    v_exp_f32 v194, v194
    v_exp_f32 v195, v195
    v_add_f32 v9, v9, v194
    v_add_f32 v9, v9, v195
    v_cvt_pk_bf16_f32 v91, v194, v195
    v_exp_f32 v196, v196
    v_exp_f32 v197, v197
    v_add_f32 v10, v10, v196
    v_add_f32 v10, v10, v197
    v_cvt_pk_bf16_f32 v94, v196, v197
    v_exp_f32 v198, v198
    v_exp_f32 v199, v199
    v_add_f32 v10, v10, v198
    v_add_f32 v10, v10, v199
    v_cvt_pk_bf16_f32 v95, v198, v199
    s_mov_b32 s17, 0x12000
    buffer_load_dwordx4 v[200:203], v8, s[8:11], s17 offen offset:0
    buffer_load_dwordx4 v[204:207], v8, s[8:11], s17 offen offset:1024
    buffer_load_dwordx4 v[208:211], v8, s[8:11], s17 offen offset:2048
    buffer_load_dwordx4 v[212:215], v8, s[8:11], s17 offen offset:3072
    s_waitcnt vmcnt(3)
    v_mfma_f32_16x16x32_bf16 v[184:187], v[200:203], v[152:155], v[216:219]
    v_mfma_f32_16x16x32_bf16 v[188:191], v[200:203], v[168:171], v[220:223]
    s_waitcnt vmcnt(2)
    v_mfma_f32_16x16x32_bf16 v[192:195], v[204:207], v[152:155], v[216:219]
    v_mfma_f32_16x16x32_bf16 v[196:199], v[204:207], v[168:171], v[220:223]
    s_waitcnt vmcnt(1)
    v_mfma_f32_16x16x32_bf16 v[184:187], v[208:211], v[156:159], v[184:187]
    v_mfma_f32_16x16x32_bf16 v[188:191], v[208:211], v[172:175], v[188:191]
    s_waitcnt vmcnt(0)
    v_mfma_f32_16x16x32_bf16 v[192:195], v[212:215], v[156:159], v[192:195]
    v_mfma_f32_16x16x32_bf16 v[196:199], v[212:215], v[172:175], v[196:199]
    s_mov_b32 s17, 0x13000
    buffer_load_dwordx4 v[200:203], v8, s[8:11], s17 offen offset:0
    buffer_load_dwordx4 v[204:207], v8, s[8:11], s17 offen offset:1024
    buffer_load_dwordx4 v[208:211], v8, s[8:11], s17 offen offset:2048
    buffer_load_dwordx4 v[212:215], v8, s[8:11], s17 offen offset:3072
    s_waitcnt vmcnt(3)
    v_mfma_f32_16x16x32_bf16 v[184:187], v[200:203], v[160:163], v[184:187]
    v_mfma_f32_16x16x32_bf16 v[188:191], v[200:203], v[176:179], v[188:191]
    s_waitcnt vmcnt(2)
    v_mfma_f32_16x16x32_bf16 v[192:195], v[204:207], v[160:163], v[192:195]
    v_mfma_f32_16x16x32_bf16 v[196:199], v[204:207], v[176:179], v[196:199]
    s_waitcnt vmcnt(1)
    v_mfma_f32_16x16x32_bf16 v[184:187], v[208:211], v[164:167], v[184:187]
    v_mfma_f32_16x16x32_bf16 v[188:191], v[208:211], v[180:183], v[188:191]
    s_waitcnt vmcnt(0)
    v_mfma_f32_16x16x32_bf16 v[192:195], v[212:215], v[164:167], v[192:195]
    v_mfma_f32_16x16x32_bf16 v[196:199], v[212:215], v[180:183], v[196:199]
    s_nop 3
    v_exp_f32 v184, v184
    v_exp_f32 v185, v185
    v_add_f32 v9, v9, v184
    v_add_f32 v9, v9, v185
    v_cvt_pk_bf16_f32 v96, v184, v185
    v_exp_f32 v186, v186
    v_exp_f32 v187, v187
    v_add_f32 v9, v9, v186
    v_add_f32 v9, v9, v187
    v_cvt_pk_bf16_f32 v97, v186, v187
    v_exp_f32 v188, v188
    v_exp_f32 v189, v189
    v_add_f32 v10, v10, v188
    v_add_f32 v10, v10, v189
    v_cvt_pk_bf16_f32 v100, v188, v189
    v_exp_f32 v190, v190
    v_exp_f32 v191, v191
    v_add_f32 v10, v10, v190
    v_add_f32 v10, v10, v191
    v_cvt_pk_bf16_f32 v101, v190, v191
    v_exp_f32 v192, v192
    v_exp_f32 v193, v193
    v_add_f32 v9, v9, v192
    v_add_f32 v9, v9, v193
    v_cvt_pk_bf16_f32 v98, v192, v193
    v_exp_f32 v194, v194
    v_exp_f32 v195, v195
    v_add_f32 v9, v9, v194
    v_add_f32 v9, v9, v195
    v_cvt_pk_bf16_f32 v99, v194, v195
    v_exp_f32 v196, v196
    v_exp_f32 v197, v197
    v_add_f32 v10, v10, v196
    v_add_f32 v10, v10, v197
    v_cvt_pk_bf16_f32 v102, v196, v197
    v_exp_f32 v198, v198
    v_exp_f32 v199, v199
    v_add_f32 v10, v10, v198
    v_add_f32 v10, v10, v199
    v_cvt_pk_bf16_f32 v103, v198, v199
    s_mov_b32 s17, 0x14000
    buffer_load_dwordx4 v[200:203], v8, s[8:11], s17 offen offset:0
    buffer_load_dwordx4 v[204:207], v8, s[8:11], s17 offen offset:1024
    buffer_load_dwordx4 v[208:211], v8, s[8:11], s17 offen offset:2048
    buffer_load_dwordx4 v[212:215], v8, s[8:11], s17 offen offset:3072
    s_waitcnt vmcnt(3)
    v_mfma_f32_16x16x32_bf16 v[184:187], v[200:203], v[152:155], v[216:219]
    v_mfma_f32_16x16x32_bf16 v[188:191], v[200:203], v[168:171], v[220:223]
    s_waitcnt vmcnt(2)
    v_mfma_f32_16x16x32_bf16 v[192:195], v[204:207], v[152:155], v[216:219]
    v_mfma_f32_16x16x32_bf16 v[196:199], v[204:207], v[168:171], v[220:223]
    s_waitcnt vmcnt(1)
    v_mfma_f32_16x16x32_bf16 v[184:187], v[208:211], v[156:159], v[184:187]
    v_mfma_f32_16x16x32_bf16 v[188:191], v[208:211], v[172:175], v[188:191]
    s_waitcnt vmcnt(0)
    v_mfma_f32_16x16x32_bf16 v[192:195], v[212:215], v[156:159], v[192:195]
    v_mfma_f32_16x16x32_bf16 v[196:199], v[212:215], v[172:175], v[196:199]
    s_mov_b32 s17, 0x15000
    buffer_load_dwordx4 v[200:203], v8, s[8:11], s17 offen offset:0
    buffer_load_dwordx4 v[204:207], v8, s[8:11], s17 offen offset:1024
    buffer_load_dwordx4 v[208:211], v8, s[8:11], s17 offen offset:2048
    buffer_load_dwordx4 v[212:215], v8, s[8:11], s17 offen offset:3072
    s_waitcnt vmcnt(3)
    v_mfma_f32_16x16x32_bf16 v[184:187], v[200:203], v[160:163], v[184:187]
    v_mfma_f32_16x16x32_bf16 v[188:191], v[200:203], v[176:179], v[188:191]
    s_waitcnt vmcnt(2)
    v_mfma_f32_16x16x32_bf16 v[192:195], v[204:207], v[160:163], v[192:195]
    v_mfma_f32_16x16x32_bf16 v[196:199], v[204:207], v[176:179], v[196:199]
    s_waitcnt vmcnt(1)
    v_mfma_f32_16x16x32_bf16 v[184:187], v[208:211], v[164:167], v[184:187]
    v_mfma_f32_16x16x32_bf16 v[188:191], v[208:211], v[180:183], v[188:191]
    s_waitcnt vmcnt(0)
    v_mfma_f32_16x16x32_bf16 v[192:195], v[212:215], v[164:167], v[192:195]
    v_mfma_f32_16x16x32_bf16 v[196:199], v[212:215], v[180:183], v[196:199]
    s_nop 3
    v_exp_f32 v184, v184
    v_exp_f32 v185, v185
    v_add_f32 v9, v9, v184
    v_add_f32 v9, v9, v185
    v_cvt_pk_bf16_f32 v104, v184, v185
    v_exp_f32 v186, v186
    v_exp_f32 v187, v187
    v_add_f32 v9, v9, v186
    v_add_f32 v9, v9, v187
    v_cvt_pk_bf16_f32 v105, v186, v187
    v_exp_f32 v188, v188
    v_exp_f32 v189, v189
    v_add_f32 v10, v10, v188
    v_add_f32 v10, v10, v189
    v_cvt_pk_bf16_f32 v108, v188, v189
    v_exp_f32 v190, v190
    v_exp_f32 v191, v191
    v_add_f32 v10, v10, v190
    v_add_f32 v10, v10, v191
    v_cvt_pk_bf16_f32 v109, v190, v191
    v_exp_f32 v192, v192
    v_exp_f32 v193, v193
    v_add_f32 v9, v9, v192
    v_add_f32 v9, v9, v193
    v_cvt_pk_bf16_f32 v106, v192, v193
    v_exp_f32 v194, v194
    v_exp_f32 v195, v195
    v_add_f32 v9, v9, v194
    v_add_f32 v9, v9, v195
    v_cvt_pk_bf16_f32 v107, v194, v195
    v_exp_f32 v196, v196
    v_exp_f32 v197, v197
    v_add_f32 v10, v10, v196
    v_add_f32 v10, v10, v197
    v_cvt_pk_bf16_f32 v110, v196, v197
    v_exp_f32 v198, v198
    v_exp_f32 v199, v199
    v_add_f32 v10, v10, v198
    v_add_f32 v10, v10, v199
    v_cvt_pk_bf16_f32 v111, v198, v199
    s_mov_b32 s17, 0x16000
    buffer_load_dwordx4 v[200:203], v8, s[8:11], s17 offen offset:0
    buffer_load_dwordx4 v[204:207], v8, s[8:11], s17 offen offset:1024
    buffer_load_dwordx4 v[208:211], v8, s[8:11], s17 offen offset:2048
    buffer_load_dwordx4 v[212:215], v8, s[8:11], s17 offen offset:3072
    s_waitcnt vmcnt(3)
    v_mfma_f32_16x16x32_bf16 v[184:187], v[200:203], v[152:155], v[216:219]
    v_mfma_f32_16x16x32_bf16 v[188:191], v[200:203], v[168:171], v[220:223]
    s_waitcnt vmcnt(2)
    v_mfma_f32_16x16x32_bf16 v[192:195], v[204:207], v[152:155], v[216:219]
    v_mfma_f32_16x16x32_bf16 v[196:199], v[204:207], v[168:171], v[220:223]
    s_waitcnt vmcnt(1)
    v_mfma_f32_16x16x32_bf16 v[184:187], v[208:211], v[156:159], v[184:187]
    v_mfma_f32_16x16x32_bf16 v[188:191], v[208:211], v[172:175], v[188:191]
    s_waitcnt vmcnt(0)
    v_mfma_f32_16x16x32_bf16 v[192:195], v[212:215], v[156:159], v[192:195]
    v_mfma_f32_16x16x32_bf16 v[196:199], v[212:215], v[172:175], v[196:199]
    s_mov_b32 s17, 0x17000
    buffer_load_dwordx4 v[200:203], v8, s[8:11], s17 offen offset:0
    buffer_load_dwordx4 v[204:207], v8, s[8:11], s17 offen offset:1024
    buffer_load_dwordx4 v[208:211], v8, s[8:11], s17 offen offset:2048
    buffer_load_dwordx4 v[212:215], v8, s[8:11], s17 offen offset:3072
    s_waitcnt vmcnt(3)
    v_mfma_f32_16x16x32_bf16 v[184:187], v[200:203], v[160:163], v[184:187]
    v_mfma_f32_16x16x32_bf16 v[188:191], v[200:203], v[176:179], v[188:191]
    s_waitcnt vmcnt(2)
    v_mfma_f32_16x16x32_bf16 v[192:195], v[204:207], v[160:163], v[192:195]
    v_mfma_f32_16x16x32_bf16 v[196:199], v[204:207], v[176:179], v[196:199]
    s_waitcnt vmcnt(1)
    v_mfma_f32_16x16x32_bf16 v[184:187], v[208:211], v[164:167], v[184:187]
    v_mfma_f32_16x16x32_bf16 v[188:191], v[208:211], v[180:183], v[188:191]
    s_waitcnt vmcnt(0)
    v_mfma_f32_16x16x32_bf16 v[192:195], v[212:215], v[164:167], v[192:195]
    v_mfma_f32_16x16x32_bf16 v[196:199], v[212:215], v[180:183], v[196:199]
    s_nop 3
    v_exp_f32 v184, v184
    v_exp_f32 v185, v185
    v_add_f32 v9, v9, v184
    v_add_f32 v9, v9, v185
    v_cvt_pk_bf16_f32 v112, v184, v185
    v_exp_f32 v186, v186
    v_exp_f32 v187, v187
    v_add_f32 v9, v9, v186
    v_add_f32 v9, v9, v187
    v_cvt_pk_bf16_f32 v113, v186, v187
    v_exp_f32 v188, v188
    v_exp_f32 v189, v189
    v_add_f32 v10, v10, v188
    v_add_f32 v10, v10, v189
    v_cvt_pk_bf16_f32 v116, v188, v189
    v_exp_f32 v190, v190
    v_exp_f32 v191, v191
    v_add_f32 v10, v10, v190
    v_add_f32 v10, v10, v191
    v_cvt_pk_bf16_f32 v117, v190, v191
    v_exp_f32 v192, v192
    v_exp_f32 v193, v193
    v_add_f32 v9, v9, v192
    v_add_f32 v9, v9, v193
    v_cvt_pk_bf16_f32 v114, v192, v193
    v_exp_f32 v194, v194
    v_exp_f32 v195, v195
    v_add_f32 v9, v9, v194
    v_add_f32 v9, v9, v195
    v_cvt_pk_bf16_f32 v115, v194, v195
    v_exp_f32 v196, v196
    v_exp_f32 v197, v197
    v_add_f32 v10, v10, v196
    v_add_f32 v10, v10, v197
    v_cvt_pk_bf16_f32 v118, v196, v197
    v_exp_f32 v198, v198
    v_exp_f32 v199, v199
    v_add_f32 v10, v10, v198
    v_add_f32 v10, v10, v199
    v_cvt_pk_bf16_f32 v119, v198, v199
    s_mov_b32 s17, 0x18000
    buffer_load_dwordx4 v[200:203], v8, s[8:11], s17 offen offset:0
    buffer_load_dwordx4 v[204:207], v8, s[8:11], s17 offen offset:1024
    buffer_load_dwordx4 v[208:211], v8, s[8:11], s17 offen offset:2048
    buffer_load_dwordx4 v[212:215], v8, s[8:11], s17 offen offset:3072
    s_waitcnt vmcnt(3)
    v_mfma_f32_16x16x32_bf16 v[184:187], v[200:203], v[152:155], v[216:219]
    v_mfma_f32_16x16x32_bf16 v[188:191], v[200:203], v[168:171], v[220:223]
    s_waitcnt vmcnt(2)
    v_mfma_f32_16x16x32_bf16 v[192:195], v[204:207], v[152:155], v[216:219]
    v_mfma_f32_16x16x32_bf16 v[196:199], v[204:207], v[168:171], v[220:223]
    s_waitcnt vmcnt(1)
    v_mfma_f32_16x16x32_bf16 v[184:187], v[208:211], v[156:159], v[184:187]
    v_mfma_f32_16x16x32_bf16 v[188:191], v[208:211], v[172:175], v[188:191]
    s_waitcnt vmcnt(0)
    v_mfma_f32_16x16x32_bf16 v[192:195], v[212:215], v[156:159], v[192:195]
    v_mfma_f32_16x16x32_bf16 v[196:199], v[212:215], v[172:175], v[196:199]
    s_mov_b32 s17, 0x19000
    buffer_load_dwordx4 v[200:203], v8, s[8:11], s17 offen offset:0
    buffer_load_dwordx4 v[204:207], v8, s[8:11], s17 offen offset:1024
    buffer_load_dwordx4 v[208:211], v8, s[8:11], s17 offen offset:2048
    buffer_load_dwordx4 v[212:215], v8, s[8:11], s17 offen offset:3072
    s_waitcnt vmcnt(3)
    v_mfma_f32_16x16x32_bf16 v[184:187], v[200:203], v[160:163], v[184:187]
    v_mfma_f32_16x16x32_bf16 v[188:191], v[200:203], v[176:179], v[188:191]
    s_waitcnt vmcnt(2)
    v_mfma_f32_16x16x32_bf16 v[192:195], v[204:207], v[160:163], v[192:195]
    v_mfma_f32_16x16x32_bf16 v[196:199], v[204:207], v[176:179], v[196:199]
    s_waitcnt vmcnt(1)
    v_mfma_f32_16x16x32_bf16 v[184:187], v[208:211], v[164:167], v[184:187]
    v_mfma_f32_16x16x32_bf16 v[188:191], v[208:211], v[180:183], v[188:191]
    s_waitcnt vmcnt(0)
    v_mfma_f32_16x16x32_bf16 v[192:195], v[212:215], v[164:167], v[192:195]
    v_mfma_f32_16x16x32_bf16 v[196:199], v[212:215], v[180:183], v[196:199]
    s_nop 3
    v_exp_f32 v184, v184
    v_exp_f32 v185, v185
    v_add_f32 v9, v9, v184
    v_add_f32 v9, v9, v185
    v_cvt_pk_bf16_f32 v120, v184, v185
    v_exp_f32 v186, v186
    v_exp_f32 v187, v187
    v_add_f32 v9, v9, v186
    v_add_f32 v9, v9, v187
    v_cvt_pk_bf16_f32 v121, v186, v187
    v_exp_f32 v188, v188
    v_exp_f32 v189, v189
    v_add_f32 v10, v10, v188
    v_add_f32 v10, v10, v189
    v_cvt_pk_bf16_f32 v124, v188, v189
    v_exp_f32 v190, v190
    v_exp_f32 v191, v191
    v_add_f32 v10, v10, v190
    v_add_f32 v10, v10, v191
    v_cvt_pk_bf16_f32 v125, v190, v191
    v_exp_f32 v192, v192
    v_exp_f32 v193, v193
    v_add_f32 v9, v9, v192
    v_add_f32 v9, v9, v193
    v_cvt_pk_bf16_f32 v122, v192, v193
    v_exp_f32 v194, v194
    v_exp_f32 v195, v195
    v_add_f32 v9, v9, v194
    v_add_f32 v9, v9, v195
    v_cvt_pk_bf16_f32 v123, v194, v195
    v_exp_f32 v196, v196
    v_exp_f32 v197, v197
    v_add_f32 v10, v10, v196
    v_add_f32 v10, v10, v197
    v_cvt_pk_bf16_f32 v126, v196, v197
    v_exp_f32 v198, v198
    v_exp_f32 v199, v199
    v_add_f32 v10, v10, v198
    v_add_f32 v10, v10, v199
    v_cvt_pk_bf16_f32 v127, v198, v199
    s_mov_b32 s17, 0x1a000
    buffer_load_dwordx4 v[200:203], v8, s[8:11], s17 offen offset:0
    buffer_load_dwordx4 v[204:207], v8, s[8:11], s17 offen offset:1024
    buffer_load_dwordx4 v[208:211], v8, s[8:11], s17 offen offset:2048
    buffer_load_dwordx4 v[212:215], v8, s[8:11], s17 offen offset:3072
    s_waitcnt vmcnt(3)
    v_mfma_f32_16x16x32_bf16 v[184:187], v[200:203], v[152:155], v[216:219]
    v_mfma_f32_16x16x32_bf16 v[188:191], v[200:203], v[168:171], v[220:223]
    s_waitcnt vmcnt(2)
    v_mfma_f32_16x16x32_bf16 v[192:195], v[204:207], v[152:155], v[216:219]
    v_mfma_f32_16x16x32_bf16 v[196:199], v[204:207], v[168:171], v[220:223]
    s_waitcnt vmcnt(1)
    v_mfma_f32_16x16x32_bf16 v[184:187], v[208:211], v[156:159], v[184:187]
    v_mfma_f32_16x16x32_bf16 v[188:191], v[208:211], v[172:175], v[188:191]
    s_waitcnt vmcnt(0)
    v_mfma_f32_16x16x32_bf16 v[192:195], v[212:215], v[156:159], v[192:195]
    v_mfma_f32_16x16x32_bf16 v[196:199], v[212:215], v[172:175], v[196:199]
    s_mov_b32 s17, 0x1b000
    buffer_load_dwordx4 v[200:203], v8, s[8:11], s17 offen offset:0
    buffer_load_dwordx4 v[204:207], v8, s[8:11], s17 offen offset:1024
    buffer_load_dwordx4 v[208:211], v8, s[8:11], s17 offen offset:2048
    buffer_load_dwordx4 v[212:215], v8, s[8:11], s17 offen offset:3072
    s_waitcnt vmcnt(3)
    v_mfma_f32_16x16x32_bf16 v[184:187], v[200:203], v[160:163], v[184:187]
    v_mfma_f32_16x16x32_bf16 v[188:191], v[200:203], v[176:179], v[188:191]
    s_waitcnt vmcnt(2)
    v_mfma_f32_16x16x32_bf16 v[192:195], v[204:207], v[160:163], v[192:195]
    v_mfma_f32_16x16x32_bf16 v[196:199], v[204:207], v[176:179], v[196:199]
    s_waitcnt vmcnt(1)
    v_mfma_f32_16x16x32_bf16 v[184:187], v[208:211], v[164:167], v[184:187]
    v_mfma_f32_16x16x32_bf16 v[188:191], v[208:211], v[180:183], v[188:191]
    s_waitcnt vmcnt(0)
    v_mfma_f32_16x16x32_bf16 v[192:195], v[212:215], v[164:167], v[192:195]
    v_mfma_f32_16x16x32_bf16 v[196:199], v[212:215], v[180:183], v[196:199]
    s_nop 3
    v_exp_f32 v184, v184
    v_exp_f32 v185, v185
    v_add_f32 v9, v9, v184
    v_add_f32 v9, v9, v185
    v_cvt_pk_bf16_f32 v128, v184, v185
    v_exp_f32 v186, v186
    v_exp_f32 v187, v187
    v_add_f32 v9, v9, v186
    v_add_f32 v9, v9, v187
    v_cvt_pk_bf16_f32 v129, v186, v187
    v_exp_f32 v188, v188
    v_exp_f32 v189, v189
    v_add_f32 v10, v10, v188
    v_add_f32 v10, v10, v189
    v_cvt_pk_bf16_f32 v132, v188, v189
    v_exp_f32 v190, v190
    v_exp_f32 v191, v191
    v_add_f32 v10, v10, v190
    v_add_f32 v10, v10, v191
    v_cvt_pk_bf16_f32 v133, v190, v191
    v_exp_f32 v192, v192
    v_exp_f32 v193, v193
    v_add_f32 v9, v9, v192
    v_add_f32 v9, v9, v193
    v_cvt_pk_bf16_f32 v130, v192, v193
    v_exp_f32 v194, v194
    v_exp_f32 v195, v195
    v_add_f32 v9, v9, v194
    v_add_f32 v9, v9, v195
    v_cvt_pk_bf16_f32 v131, v194, v195
    v_exp_f32 v196, v196
    v_exp_f32 v197, v197
    v_add_f32 v10, v10, v196
    v_add_f32 v10, v10, v197
    v_cvt_pk_bf16_f32 v134, v196, v197
    v_exp_f32 v198, v198
    v_exp_f32 v199, v199
    v_add_f32 v10, v10, v198
    v_add_f32 v10, v10, v199
    v_cvt_pk_bf16_f32 v135, v198, v199
    s_mov_b32 s17, 0x1c000
    buffer_load_dwordx4 v[200:203], v8, s[8:11], s17 offen offset:0
    buffer_load_dwordx4 v[204:207], v8, s[8:11], s17 offen offset:1024
    buffer_load_dwordx4 v[208:211], v8, s[8:11], s17 offen offset:2048
    buffer_load_dwordx4 v[212:215], v8, s[8:11], s17 offen offset:3072
    s_waitcnt vmcnt(3)
    v_mfma_f32_16x16x32_bf16 v[184:187], v[200:203], v[152:155], v[216:219]
    v_mfma_f32_16x16x32_bf16 v[188:191], v[200:203], v[168:171], v[220:223]
    s_waitcnt vmcnt(2)
    v_mfma_f32_16x16x32_bf16 v[192:195], v[204:207], v[152:155], v[216:219]
    v_mfma_f32_16x16x32_bf16 v[196:199], v[204:207], v[168:171], v[220:223]
    s_waitcnt vmcnt(1)
    v_mfma_f32_16x16x32_bf16 v[184:187], v[208:211], v[156:159], v[184:187]
    v_mfma_f32_16x16x32_bf16 v[188:191], v[208:211], v[172:175], v[188:191]
    s_waitcnt vmcnt(0)
    v_mfma_f32_16x16x32_bf16 v[192:195], v[212:215], v[156:159], v[192:195]
    v_mfma_f32_16x16x32_bf16 v[196:199], v[212:215], v[172:175], v[196:199]
    s_mov_b32 s17, 0x1d000
    buffer_load_dwordx4 v[200:203], v8, s[8:11], s17 offen offset:0
    buffer_load_dwordx4 v[204:207], v8, s[8:11], s17 offen offset:1024
    buffer_load_dwordx4 v[208:211], v8, s[8:11], s17 offen offset:2048
    buffer_load_dwordx4 v[212:215], v8, s[8:11], s17 offen offset:3072
    s_waitcnt vmcnt(3)
    v_mfma_f32_16x16x32_bf16 v[184:187], v[200:203], v[160:163], v[184:187]
    v_mfma_f32_16x16x32_bf16 v[188:191], v[200:203], v[176:179], v[188:191]
    s_waitcnt vmcnt(2)
    v_mfma_f32_16x16x32_bf16 v[192:195], v[204:207], v[160:163], v[192:195]
    v_mfma_f32_16x16x32_bf16 v[196:199], v[204:207], v[176:179], v[196:199]
    s_waitcnt vmcnt(1)
    v_mfma_f32_16x16x32_bf16 v[184:187], v[208:211], v[164:167], v[184:187]
    v_mfma_f32_16x16x32_bf16 v[188:191], v[208:211], v[180:183], v[188:191]
    s_waitcnt vmcnt(0)
    v_mfma_f32_16x16x32_bf16 v[192:195], v[212:215], v[164:167], v[192:195]
    v_mfma_f32_16x16x32_bf16 v[196:199], v[212:215], v[180:183], v[196:199]
    s_nop 3
    v_exp_f32 v184, v184
    v_exp_f32 v185, v185
    v_add_f32 v9, v9, v184
    v_add_f32 v9, v9, v185
    v_cvt_pk_bf16_f32 v136, v184, v185
    v_exp_f32 v186, v186
    v_exp_f32 v187, v187
    v_add_f32 v9, v9, v186
    v_add_f32 v9, v9, v187
    v_cvt_pk_bf16_f32 v137, v186, v187
    v_exp_f32 v188, v188
    v_exp_f32 v189, v189
    v_add_f32 v10, v10, v188
    v_add_f32 v10, v10, v189
    v_cvt_pk_bf16_f32 v140, v188, v189
    v_exp_f32 v190, v190
    v_exp_f32 v191, v191
    v_add_f32 v10, v10, v190
    v_add_f32 v10, v10, v191
    v_cvt_pk_bf16_f32 v141, v190, v191
    v_exp_f32 v192, v192
    v_exp_f32 v193, v193
    v_add_f32 v9, v9, v192
    v_add_f32 v9, v9, v193
    v_cvt_pk_bf16_f32 v138, v192, v193
    v_exp_f32 v194, v194
    v_exp_f32 v195, v195
    v_add_f32 v9, v9, v194
    v_add_f32 v9, v9, v195
    v_cvt_pk_bf16_f32 v139, v194, v195
    v_exp_f32 v196, v196
    v_exp_f32 v197, v197
    v_add_f32 v10, v10, v196
    v_add_f32 v10, v10, v197
    v_cvt_pk_bf16_f32 v142, v196, v197
    v_exp_f32 v198, v198
    v_exp_f32 v199, v199
    v_add_f32 v10, v10, v198
    v_add_f32 v10, v10, v199
    v_cvt_pk_bf16_f32 v143, v198, v199
    s_mov_b32 s17, 0x1e000
    buffer_load_dwordx4 v[200:203], v8, s[8:11], s17 offen offset:0
    buffer_load_dwordx4 v[204:207], v8, s[8:11], s17 offen offset:1024
    buffer_load_dwordx4 v[208:211], v8, s[8:11], s17 offen offset:2048
    buffer_load_dwordx4 v[212:215], v8, s[8:11], s17 offen offset:3072
    s_waitcnt vmcnt(3)
    v_mfma_f32_16x16x32_bf16 v[184:187], v[200:203], v[152:155], v[216:219]
    v_mfma_f32_16x16x32_bf16 v[188:191], v[200:203], v[168:171], v[220:223]
    s_waitcnt vmcnt(2)
    v_mfma_f32_16x16x32_bf16 v[192:195], v[204:207], v[152:155], v[216:219]
    v_mfma_f32_16x16x32_bf16 v[196:199], v[204:207], v[168:171], v[220:223]
    s_waitcnt vmcnt(1)
    v_mfma_f32_16x16x32_bf16 v[184:187], v[208:211], v[156:159], v[184:187]
    v_mfma_f32_16x16x32_bf16 v[188:191], v[208:211], v[172:175], v[188:191]
    s_waitcnt vmcnt(0)
    v_mfma_f32_16x16x32_bf16 v[192:195], v[212:215], v[156:159], v[192:195]
    v_mfma_f32_16x16x32_bf16 v[196:199], v[212:215], v[172:175], v[196:199]
    s_mov_b32 s17, 0x1f000
    buffer_load_dwordx4 v[200:203], v8, s[8:11], s17 offen offset:0
    buffer_load_dwordx4 v[204:207], v8, s[8:11], s17 offen offset:1024
    buffer_load_dwordx4 v[208:211], v8, s[8:11], s17 offen offset:2048
    buffer_load_dwordx4 v[212:215], v8, s[8:11], s17 offen offset:3072
    s_waitcnt vmcnt(3)
    v_mfma_f32_16x16x32_bf16 v[184:187], v[200:203], v[160:163], v[184:187]
    v_mfma_f32_16x16x32_bf16 v[188:191], v[200:203], v[176:179], v[188:191]
    s_waitcnt vmcnt(2)
    v_mfma_f32_16x16x32_bf16 v[192:195], v[204:207], v[160:163], v[192:195]
    v_mfma_f32_16x16x32_bf16 v[196:199], v[204:207], v[176:179], v[196:199]
    s_waitcnt vmcnt(1)
    v_mfma_f32_16x16x32_bf16 v[184:187], v[208:211], v[164:167], v[184:187]
    v_mfma_f32_16x16x32_bf16 v[188:191], v[208:211], v[180:183], v[188:191]
    s_waitcnt vmcnt(0)
    v_mfma_f32_16x16x32_bf16 v[192:195], v[212:215], v[164:167], v[192:195]
    v_mfma_f32_16x16x32_bf16 v[196:199], v[212:215], v[180:183], v[196:199]
    s_nop 3
    v_exp_f32 v184, v184
    v_exp_f32 v185, v185
    v_add_f32 v9, v9, v184
    v_add_f32 v9, v9, v185
    v_cvt_pk_bf16_f32 v144, v184, v185
    v_exp_f32 v186, v186
    v_exp_f32 v187, v187
    v_add_f32 v9, v9, v186
    v_add_f32 v9, v9, v187
    v_cvt_pk_bf16_f32 v145, v186, v187
    v_exp_f32 v188, v188
    v_exp_f32 v189, v189
    v_add_f32 v10, v10, v188
    v_add_f32 v10, v10, v189
    v_cvt_pk_bf16_f32 v148, v188, v189
    v_exp_f32 v190, v190
    v_exp_f32 v191, v191
    v_add_f32 v10, v10, v190
    v_add_f32 v10, v10, v191
    v_cvt_pk_bf16_f32 v149, v190, v191
    v_exp_f32 v192, v192
    v_exp_f32 v193, v193
    v_add_f32 v9, v9, v192
    v_add_f32 v9, v9, v193
    v_cvt_pk_bf16_f32 v146, v192, v193
    v_exp_f32 v194, v194
    v_exp_f32 v195, v195
    v_add_f32 v9, v9, v194
    v_add_f32 v9, v9, v195
    v_cvt_pk_bf16_f32 v147, v194, v195
    v_exp_f32 v196, v196
    v_exp_f32 v197, v197
    v_add_f32 v10, v10, v196
    v_add_f32 v10, v10, v197
    v_cvt_pk_bf16_f32 v150, v196, v197
    v_exp_f32 v198, v198
    v_exp_f32 v199, v199
    v_add_f32 v10, v10, v198
    v_add_f32 v10, v10, v199
    v_cvt_pk_bf16_f32 v151, v198, v199
    v_mov_b32 v16, v9
    v_mov_b32 v18, v10
    s_nop 0
    v_permlane16_swap_b32 v9, v16
    v_permlane16_swap_b32 v10, v18
    v_add_f32 v9, v9, v16
    v_add_f32 v10, v10, v18
    v_mov_b32 v16, v9
    v_mov_b32 v18, v10
    s_nop 0
    v_permlane32_swap_b32 v9, v16
    v_permlane32_swap_b32 v10, v18
    v_add_f32 v9, v9, v16
    v_add_f32 v10, v10, v18
    s_waitcnt vmcnt(0) lgkmcnt(0)
    s_nop 15
    s_nop 3
    s_branch adaLN_cond__sliding_block_cached__moe_arch_mod__prompt_kernel_fixBb
adaLN_cond__sliding_block_cached__moe_arch_mod__prompt_kernel_o17r:
    s_waitcnt vmcnt(0) lgkmcnt(0)
    s_nop 15
    s_nop 3
    s_mov_b32 s27, 0
adaLN_cond__sliding_block_cached__moe_arch_mod__prompt_kernel_o17p:
    buffer_load_dword v12, v13, s[8:11], s19 offen sc1
    s_waitcnt vmcnt(0)
    v_cmp_ne_u32 vcc, s28, v12
    s_add_u32 s27, s27, 1
    s_cmp_ge_u32 s27, 65536
    s_cbranch_scc1 adaLN_cond__sliding_block_cached__moe_arch_mod__prompt_kernel_o17g
    s_cbranch_vccnz adaLN_cond__sliding_block_cached__moe_arch_mod__prompt_kernel_o17p
adaLN_cond__sliding_block_cached__moe_arch_mod__prompt_kernel_o17g:
    s_waitcnt vmcnt(0) lgkmcnt(0)
    s_nop 15
    s_nop 3
    s_branch adaLN_cond__sliding_block_cached__moe_arch_mod__prompt_kernel_o17b
adaLN_cond__sliding_block_cached__moe_arch_mod__prompt_kernel_o218r:
    s_waitcnt vmcnt(0) lgkmcnt(0)
    s_nop 15
    s_nop 3
    s_mov_b32 s27, 0
adaLN_cond__sliding_block_cached__moe_arch_mod__prompt_kernel_o218p:
    buffer_load_dword v12, v13, s[8:11], s19 offen sc1
    s_waitcnt vmcnt(0)
    v_cmp_ne_u32 vcc, s28, v12
    s_add_u32 s27, s27, 1
    s_cmp_ge_u32 s27, 65536
    s_cbranch_scc1 adaLN_cond__sliding_block_cached__moe_arch_mod__prompt_kernel_o218g
    s_cbranch_vccnz adaLN_cond__sliding_block_cached__moe_arch_mod__prompt_kernel_o218p
adaLN_cond__sliding_block_cached__moe_arch_mod__prompt_kernel_o218g:
    s_waitcnt vmcnt(0) lgkmcnt(0)
    s_nop 15
    s_nop 3
    s_branch adaLN_cond__sliding_block_cached__moe_arch_mod__prompt_kernel_o218b
adaLN_cond__sliding_block_cached__moe_arch_mod__prompt_kernel_o219r:
    s_waitcnt vmcnt(0) lgkmcnt(0)
    s_nop 15
    s_nop 3
    s_mov_b32 s27, 0
adaLN_cond__sliding_block_cached__moe_arch_mod__prompt_kernel_o219p:
    buffer_load_dword v12, v13, s[8:11], s19 offen sc1
    s_waitcnt vmcnt(0)
    v_cmp_ne_u32 vcc, s28, v12
    s_add_u32 s27, s27, 1
    s_cmp_ge_u32 s27, 65536
    s_cbranch_scc1 adaLN_cond__sliding_block_cached__moe_arch_mod__prompt_kernel_o219g
    s_cbranch_vccnz adaLN_cond__sliding_block_cached__moe_arch_mod__prompt_kernel_o219p
adaLN_cond__sliding_block_cached__moe_arch_mod__prompt_kernel_o219g:
    s_waitcnt vmcnt(0) lgkmcnt(0)
    s_nop 15
    s_nop 3
    s_branch adaLN_cond__sliding_block_cached__moe_arch_mod__prompt_kernel_o219b
adaLN_cond__sliding_block_cached__moe_arch_mod__prompt_kernel_o220r:
    s_waitcnt vmcnt(0) lgkmcnt(0)
    s_nop 15
    s_nop 3
    s_mov_b32 s27, 0
adaLN_cond__sliding_block_cached__moe_arch_mod__prompt_kernel_o220p:
    buffer_load_dword v12, v13, s[8:11], s19 offen sc1
    s_waitcnt vmcnt(0)
    v_cmp_ne_u32 vcc, s28, v12
    s_add_u32 s27, s27, 1
    s_cmp_ge_u32 s27, 65536
    s_cbranch_scc1 adaLN_cond__sliding_block_cached__moe_arch_mod__prompt_kernel_o220g
    s_cbranch_vccnz adaLN_cond__sliding_block_cached__moe_arch_mod__prompt_kernel_o220p
adaLN_cond__sliding_block_cached__moe_arch_mod__prompt_kernel_o220g:
    s_waitcnt vmcnt(0) lgkmcnt(0)
    s_nop 15
    s_nop 3
    s_branch adaLN_cond__sliding_block_cached__moe_arch_mod__prompt_kernel_o220b
adaLN_cond__sliding_block_cached__moe_arch_mod__prompt_kernel_mf21r:
    s_waitcnt vmcnt(0) lgkmcnt(0)
    s_nop 15
    s_nop 3
    s_mov_b32 s27, 0
adaLN_cond__sliding_block_cached__moe_arch_mod__prompt_kernel_mf21p:
    s_mov_b32 s16, 0x544000
    buffer_load_dwordx4 v[184:187], v2, s[8:11], s16 offen sc1
    s_waitcnt vmcnt(0)
    v_xor_b32 v16, s28, v184
    v_xor_b32 v17, s28, v185
    v_xor_b32 v18, s28, v186
    v_xor_b32 v19, s28, v187
    v_or3_b32 v16, v16, v17, v18
    v_or_b32 v16, v16, v19
    v_cmp_ne_u32 vcc, 0, v16
    s_add_u32 s27, s27, 1
    s_cmp_ge_u32 s27, 65536
    s_cbranch_scc1 adaLN_cond__sliding_block_cached__moe_arch_mod__prompt_kernel_mf21g
    s_cbranch_vccnz adaLN_cond__sliding_block_cached__moe_arch_mod__prompt_kernel_mf21p
adaLN_cond__sliding_block_cached__moe_arch_mod__prompt_kernel_mf21g:
    s_waitcnt vmcnt(0) lgkmcnt(0)
    s_nop 15
    s_nop 3
    s_branch adaLN_cond__sliding_block_cached__moe_arch_mod__prompt_kernel_mf21b
adaLN_cond__sliding_block_cached__moe_arch_mod__prompt_kernel_codeend:
    s_endpgm
.section .rodata,"a"
.p2align 6
.amdhsa_kernel adaLN_cond__sliding_block_cached__moe_arch_mod__prompt_kernel
  .amdhsa_next_free_vgpr 256
  .amdhsa_next_free_sgpr 80
  .amdhsa_accum_offset 256
  .amdhsa_group_segment_fixed_size 0
  .amdhsa_kernarg_size 120
  .amdhsa_user_sgpr_count 2
  .amdhsa_user_sgpr_kernarg_segment_ptr 1
  .amdhsa_system_sgpr_workgroup_id_x 1
  .amdhsa_float_denorm_mode_32 3
.end_amdhsa_kernel
```

```asm
; @launch grid=(256,1,1) block=(512,1,1) lds=163840
.amdgcn_target "amdgcn-amd-amdhsa--gfx950"
.text
.globl adaLN_cond__sliding_block_cached__moe_arch_mod__prompt_kernel
.p2align 8
.type adaLN_cond__sliding_block_cached__moe_arch_mod__prompt_kernel,@function
adaLN_cond__sliding_block_cached__moe_arch_mod__prompt_kernel:
    s_cmp_ge_u32 s2, 256
    s_cbranch_scc1 adaLN_cond__sliding_block_cached__moe_arch_mod__prompt_kernel_end
    s_getpc_b64 s[76:77]
adaLN_cond__sliding_block_cached__moe_arch_mod__prompt_kernel_pc0:
    s_sub_u32 s76, s76, adaLN_cond__sliding_block_cached__moe_arch_mod__prompt_kernel_pc0-adaLN_cond__sliding_block_cached__moe_arch_mod__prompt_kernel
    s_subb_u32 s77, s77, 0
    v_and_b32 v16, 63, v0
    v_lshlrev_b32 v16, 7, v16
    v_lshrrev_b32 v17, 6, v0
    s_lshr_b32 s62, s2, 3
    s_lshl_b32 s62, s62, 13
    v_lshlrev_b32 v18, 13, v17
    v_mov_b32 v19, s62
    v_cmp_eq_u32 vcc, 7, v17
    s_nop 1
    v_cndmask_b32 v18, v18, v19, vcc
    v_add_u32 v16, v16, v18
    v_min_u32 v16, adaLN_cond__sliding_block_cached__moe_arch_mod__prompt_kernel_codeend-adaLN_cond__sliding_block_cached__moe_arch_mod__prompt_kernel-4, v16
    v_mov_b32 v25, s77
    v_add_co_u32 v24, vcc, s76, v16
    s_nop 1
    v_addc_co_u32 v25, vcc, 0, v25, vcc
    v_cmp_gt_u32 vcc, 2, v17
    v_cmp_eq_u32 s[62:63], 7, v17
    s_or_b64 vcc, vcc, s[62:63]
    s_and_saveexec_b64 s[62:63], vcc
    s_cbranch_execz adaLN_cond__sliding_block_cached__moe_arch_mod__prompt_kernel_nocp0
    global_load_dword v26, v[24:25], off
adaLN_cond__sliding_block_cached__moe_arch_mod__prompt_kernel_nocp0:
    s_mov_b64 exec, s[62:63]
    s_load_dwordx4 s[56:59], s[0:1], 96
    s_load_dwordx2 s[60:61], s[0:1], 112
    s_load_dwordx8 s[48:55], s[0:1], 64
    s_load_dwordx16 s[32:47], s[0:1], 0
    s_memrealtime s[62:63]
    v_lshrrev_b32 v16, 6, v0
    v_and_b32 v1, 63, v0
    v_readfirstlane_b32 s3, v16
    v_lshlrev_b32 v2, 4, v1
    s_and_b32 s12, s2, 3
    s_lshl_b32 s12, s12, 3
    s_bfe_u32 s13, s2, 0x30003
    s_add_u32 s12, s12, s13
    s_bfe_u32 s13, s2, 0x10002
    s_lshl_b32 s13, s13, 2
    s_lshr_b32 s14, s2, 6
    s_add_u32 s13, s13, s14
    v_bfe_u32 v16, v1, 2, 2
    v_lshrrev_b32 v17, 4, v1
    v_and_b32 v18, 3, v1
    v_lshlrev_b32 v19, 6, v17
    v_lshl_add_u32 v19, v18, 4, v19
    v_lshl_add_u32 v3, v16, 13, v19
    s_and_b32 s14, s3, 1
    s_lshl_b32 s14, s14, 5
    v_xor_b32 v3, s14, v3
    v_lshlrev_b32 v4, 11, v17
    v_lshl_add_u32 v4, v16, 6, v4
    v_lshl_add_u32 v4, v18, 3, v4
    v_and_b32 v20, 1, v17
    v_lshlrev_b32 v20, 5, v20
    v_sub_u32 v5, v4, v20
    v_add_u32 v4, v4, v20
    s_lshl_b32 s14, s13, 3
    s_add_u32 s14, s14, s3
    s_lshl_b32 s14, s14, 16
    v_add_u32 v7, s14, v2
    s_cmp_ge_u32 s3, 4
    s_cbranch_scc1 adaLN_cond__sliding_block_cached__moe_arch_mod__prompt_kernel_roleB
    v_mov_b32 v132, 0
    v_mov_b32 v133, 0
    v_lshrrev_b32 v16, 3, v0
    v_and_b32 v17, 7, v0
    v_mul_u32_u24 v135, 24576, v16
    v_lshl_add_u32 v135, v17, 4, v135
    v_lshlrev_b32 v136, 2, v16
    s_and_b32 s14, s2, 31
    s_lshr_b32 s15, s2, 5
    s_mul_i32 s26, s15, 1572864
    s_lshl_b32 s16, s14, 7
    s_add_u32 s26, s26, s16
    s_lshl_b32 s29, s15, 8
    v_lshlrev_b32 v137, 3, v0
    s_lshl_b32 s18, s2, 3
    s_add_u32 s18, s18, s3
    s_lshl_b32 s18, s18, 11
    v_and_b32 v18, 15, v1
    v_lshrrev_b32 v19, 4, v1
    v_lshlrev_b32 v138, 11, v18
    v_lshl_add_u32 v138, v19, 4, v138
    s_lshr_b32 s30, s2, 4
    s_and_b32 s31, s2, 15
    s_lshl_b32 s19, s30, 3
    s_add_u32 s19, s19, s3
    s_lshl_b32 s22, s19, 15
    s_lshl_b32 s23, s31, 7
    s_add_u32 s22, s22, s23
    s_lshl_b32 s23, s2, 12
    s_add_u32 s23, s23, 0x600000
    s_or_b32 s25, s2, s3
    s_cmp_eq_u32 s25, 0
    s_cselect_b32 s25, 0, 0x7ffffff0
    s_waitcnt lgkmcnt(0)
    s_mov_b64 s[64:65], s[58:59]
    s_mov_b32 s66, 0x100
    s_mov_b32 s67, 0x20000
    s_or_b32 s28, s62, 1
    v_mov_b32 v134, s28
    s_mov_b64 exec, 1
    buffer_store_dword v134, v132, s[64:67], s25 offen sc1
    s_mov_b64 exec, -1
    s_mov_b64 s[68:69], s[52:53]
    s_mov_b32 s70, 0x800
    s_mov_b32 s71, 0x20000
    s_mov_b64 s[72:73], s[54:55]
    s_mov_b32 s74, 0xc00000
    s_mov_b32 s75, 0x20000
    s_mov_b64 s[76:77], s[32:33]
    s_mov_b32 s78, 0x400000
    s_mov_b32 s79, 0x20000
    s_mov_b64 s[8:9], s[60:61]
    s_mov_b32 s10, 0x3400000
    s_mov_b32 s11, 0x20000
    buffer_load_dwordx4 v[32:35], v2, s[76:79], s18 offen offset:0
    buffer_load_dwordx4 v[36:39], v2, s[76:79], s18 offen offset:1024
    buffer_load_dword v72, v136, s[68:71], s29 offen
    buffer_load_dwordx4 v[24:27], v135, s[72:75], s26 offen
    s_add_u32 s26, s26, 12288
    buffer_load_dwordx4 v[28:31], v135, s[72:75], s26 offen
    s_cmp_eq_u32 s3, 0
    s_cselect_b32 s25, 0, 0x7ffffff0
    buffer_load_dword v134, v132, s[64:67], s25 offen sc1
    buffer_store_dwordx2 v[132:133], v137, s[8:11], s23 offen sc1
    s_barrier
    buffer_load_dwordx4 v[40:43], v138, s[76:79], s22 offen offset:0
    buffer_load_dwordx4 v[44:47], v138, s[76:79], s22 offen offset:64
    s_mov_b32 s29, s19
    s_waitcnt vmcnt(8)
    v_lshlrev_b32 v56, 16, v32
    v_and_b32 v57, 0xffff0000, v32
    v_lshlrev_b32 v58, 16, v33
    v_and_b32 v59, 0xffff0000, v33
    v_lshlrev_b32 v60, 16, v34
    v_and_b32 v61, 0xffff0000, v34
    v_lshlrev_b32 v62, 16, v35
    v_and_b32 v63, 0xffff0000, v35
    s_waitcnt vmcnt(7)
    v_lshlrev_b32 v64, 16, v36
    v_and_b32 v65, 0xffff0000, v36
    v_lshlrev_b32 v66, 16, v37
    v_and_b32 v67, 0xffff0000, v37
    v_lshlrev_b32 v68, 16, v38
    v_and_b32 v69, 0xffff0000, v38
    v_lshlrev_b32 v70, 16, v39
    v_and_b32 v71, 0xffff0000, v39
    v_add_f32 v20, v56, v57
    v_add_f32 v21, v58, v59
    v_add_f32 v20, v20, v60
    v_add_f32 v21, v21, v61
    v_add_f32 v20, v20, v62
    v_add_f32 v21, v21, v63
    v_add_f32 v20, v20, v64
    v_add_f32 v21, v21, v65
    v_add_f32 v20, v20, v66
    v_add_f32 v21, v21, v67
    v_add_f32 v20, v20, v68
    v_add_f32 v21, v21, v69
    v_add_f32 v20, v20, v70
    v_add_f32 v21, v21, v71
    v_add_f32 v128, v20, v21
    s_nop 1
    v_add_f32_dpp v128, v128, v128 row_ror:1 row_mask:0xf bank_mask:0xf
    s_nop 1
    v_add_f32_dpp v128, v128, v128 row_ror:2 row_mask:0xf bank_mask:0xf
    s_nop 1
    v_add_f32_dpp v128, v128, v128 row_ror:4 row_mask:0xf bank_mask:0xf
    s_nop 1
    v_add_f32_dpp v128, v128, v128 row_ror:8 row_mask:0xf bank_mask:0xf
    v_mov_b32 v20, v128
    s_nop 1
    v_permlane16_swap_b32 v128, v20
    v_add_f32 v128, v128, v20
    v_mov_b32 v20, v128
    s_nop 1
    v_permlane32_swap_b32 v128, v20
    v_add_f32 v128, v128, v20
    v_mul_f32 v128, 0x3a800000, v128
    v_sub_f32 v18, v56, v128
    v_mul_f32 v20, v18, v18
    v_sub_f32 v19, v57, v128
    v_mul_f32 v21, v19, v19
    v_sub_f32 v18, v58, v128
    v_sub_f32 v19, v59, v128
    v_fmac_f32 v20, v18, v18
    v_fmac_f32 v21, v19, v19
    v_sub_f32 v18, v60, v128
    v_sub_f32 v19, v61, v128
    v_fmac_f32 v20, v18, v18
    v_fmac_f32 v21, v19, v19
    v_sub_f32 v18, v62, v128
    v_sub_f32 v19, v63, v128
    v_fmac_f32 v20, v18, v18
    v_fmac_f32 v21, v19, v19
    v_sub_f32 v18, v64, v128
    v_sub_f32 v19, v65, v128
    v_fmac_f32 v20, v18, v18
    v_fmac_f32 v21, v19, v19
    v_sub_f32 v18, v66, v128
    v_sub_f32 v19, v67, v128
    v_fmac_f32 v20, v18, v18
    v_fmac_f32 v21, v19, v19
    v_sub_f32 v18, v68, v128
    v_sub_f32 v19, v69, v128
    v_fmac_f32 v20, v18, v18
    v_fmac_f32 v21, v19, v19
    v_sub_f32 v18, v70, v128
    v_sub_f32 v19, v71, v128
    v_fmac_f32 v20, v18, v18
    v_fmac_f32 v21, v19, v19
    v_add_f32 v17, v20, v21
    s_nop 1
    v_add_f32_dpp v17, v17, v17 row_ror:1 row_mask:0xf bank_mask:0xf
    s_nop 1
    v_add_f32_dpp v17, v17, v17 row_ror:2 row_mask:0xf bank_mask:0xf
    s_nop 1
    v_add_f32_dpp v17, v17, v17 row_ror:4 row_mask:0xf bank_mask:0xf
    s_nop 1
    v_add_f32_dpp v17, v17, v17 row_ror:8 row_mask:0xf bank_mask:0xf
    v_mov_b32 v20, v17
    s_nop 1
    v_permlane16_swap_b32 v17, v20
    v_add_f32 v17, v17, v20
    v_mov_b32 v20, v17
    s_nop 1
    v_permlane32_swap_b32 v17, v20
    v_add_f32 v17, v17, v20
    v_mul_f32 v17, 0x3a800000, v17
    v_cvt_pk_bf16_f32 v128, v128, v128
    v_lshlrev_b32 v128, 16, v128
    v_cvt_pk_bf16_f32 v17, v17, v17
    v_lshlrev_b32 v17, 16, v17
    v_add_f32 v17, 0x3727c5ac, v17
    v_cvt_pk_bf16_f32 v17, v17, v17
    v_lshlrev_b32 v17, 16, v17
    v_sqrt_f32 v129, v17
    s_nop 0
    v_cvt_pk_bf16_f32 v129, v129, v129
    v_lshlrev_b32 v129, 16, v129
    v_rcp_f32 v130, v129
    s_lshl_b32 s16, s3, 4
    s_add_u32 s16, s16, 149520
    v_mov_b32 v19, s16
    ds_write_b128 v19, v[128:131]
    s_waitcnt vmcnt(6)
    v_and_b32 v73, 0xffff0000, v72
    v_lshlrev_b32 v72, 16, v72
    v_mul_f32 v16, 0xbfb8aa3b, v72
    v_exp_f32 v16, v16
    s_nop 0
    v_add_f32 v16, 1.0, v16
    v_rcp_f32 v16, v16
    s_nop 0
    v_mul_f32 v72, v72, v16
    v_mul_f32 v17, 0xbfb8aa3b, v73
    v_exp_f32 v17, v17
    s_nop 0
    v_add_f32 v17, 1.0, v17
    v_rcp_f32 v17, v17
    s_nop 0
    v_mul_f32 v73, v73, v17
    v_cvt_pk_bf16_f32 v16, v72, v73
    v_lshlrev_b32 v72, 16, v16
    v_and_b32 v73, 0xffff0000, v16
    s_lshl_b32 s16, s2, 8
    s_add_u32 s16, s16, 0x550000
    s_mov_b32 exec_lo, 0x01010101
    s_mov_b32 exec_hi, 0x01010101
    buffer_store_dword v16, v136, s[8:11], s16 offen sc1
    s_mov_b64 exec, -1
    v_lshrrev_b32 v74, 16, v72
    v_lshrrev_b32 v75, 16, v73
    s_waitcnt vmcnt(6)
    v_dot2_f32_bf16 v49, v24, v72, 0
    v_dot2_f32_bf16 v48, v24, v74, 0
    v_dot2_f32_bf16 v51, v25, v72, 0
    v_dot2_f32_bf16 v50, v25, v74, 0
    v_dot2_f32_bf16 v53, v26, v72, 0
    v_dot2_f32_bf16 v52, v26, v74, 0
    v_dot2_f32_bf16 v55, v27, v72, 0
    v_dot2_f32_bf16 v54, v27, v74, 0
    s_waitcnt vmcnt(5)
    v_dot2c_f32_bf16 v49, v28, v73
    v_dot2c_f32_bf16 v48, v28, v75
    v_dot2c_f32_bf16 v51, v29, v73
    v_dot2c_f32_bf16 v50, v29, v75
    v_dot2c_f32_bf16 v53, v30, v73
    v_dot2c_f32_bf16 v52, v30, v75
    v_dot2c_f32_bf16 v55, v31, v73
    v_dot2c_f32_bf16 v54, v31, v75
    s_nop 0
    v_permlane32_swap_b32 v48, v52
    v_permlane32_swap_b32 v49, v53
    v_permlane32_swap_b32 v50, v54
    v_permlane32_swap_b32 v51, v55
    v_add_f32 v48, v48, v52
    v_add_f32 v49, v49, v53
    v_add_f32 v50, v50, v54
    v_add_f32 v51, v51, v55
    s_nop 0
    v_permlane16_swap_b32 v48, v50
    v_permlane16_swap_b32 v49, v51
    v_add_f32 v48, v48, v50
    v_add_f32 v49, v49, v51
    s_nop 0
    v_add_f32_dpp v48, v48, v48 row_ror:8 row_mask:0xf bank_mask:0xf
    v_add_f32_dpp v49, v49, v49 row_ror:8 row_mask:0xf bank_mask:0xf
    v_and_b32 v16, 7, v1
    v_lshlrev_b32 v16, 5, v16
    v_lshrrev_b32 v17, 4, v1
    v_lshl_add_u32 v16, v17, 3, v16
    s_lshl_b32 s16, s3, 8
    s_add_u32 s16, s16, 147456
    v_add_u32 v16, s16, v16
    ds_write_b64 v16, v[48:49]
    s_waitcnt vmcnt(4)
    v_cmp_eq_u32 vcc, 0, v134
    s_cmp_eq_u32 s3, 0
    s_cselect_b64 s[62:63], -1, 0
    s_and_b64 vcc, vcc, s[62:63]
    s_cbranch_vccnz adaLN_cond__sliding_block_cached__moe_arch_mod__prompt_kernel_n1r
adaLN_cond__sliding_block_cached__moe_arch_mod__prompt_kernel_n1b:
    v_mov_b32 v19, 149504
    s_cmp_eq_u32 s3, 0
    s_cselect_b64 exec, 1, 0
    ds_write_b32 v19, v134
    s_mov_b64 exec, -1
    v_mov_b32 v19, 149504
    v_and_b32 v17, 31, v1
    v_lshlrev_b32 v18, 3, v17
    v_add_u32 v18, 147456, v18
    v_lshlrev_b32 v17, 4, v17
    s_waitcnt lgkmcnt(0)
    s_barrier
    ds_read_b32 v134, v19
    ds_read_b64 v[96:97], v18 offset:0
    ds_read_b64 v[100:101], v18 offset:256
    ds_read_b64 v[104:105], v18 offset:512
    ds_read_b64 v[108:109], v18 offset:768
    ds_read_b64 v[112:113], v18 offset:1024
    ds_read_b64 v[116:117], v18 offset:1280
    ds_read_b64 v[120:121], v18 offset:1536
    ds_read_b64 v[124:125], v18 offset:1792
    s_waitcnt lgkmcnt(8)
    v_readfirstlane_b32 s28, v134
    v_and_b32 v20, 7, v1
    v_lshlrev_b32 v20, 4, v20
    v_add_u32 v21, 149520, v20
    ds_read_b128 v[128:131], v21
    s_waitcnt lgkmcnt(0)
    v_mov_b32 v131, s28
    s_lshl_b32 s16, s2, 7
    s_add_u32 s16, s16, 0x520000
    s_cmp_eq_u32 s3, 0
    s_cselect_b32 s16, s16, 0x7ffffff0
    s_mov_b64 exec, 0xff
    buffer_store_dwordx4 v[128:131], v20, s[8:11], s16 offen sc1
    s_mov_b64 exec, -1
    v_pk_add_f32 v[96:97], v[96:97], v[112:113]
    v_pk_add_f32 v[100:101], v[100:101], v[116:117]
    v_pk_add_f32 v[104:105], v[104:105], v[120:121]
    v_pk_add_f32 v[108:109], v[108:109], v[124:125]
    v_pk_add_f32 v[96:97], v[96:97], v[104:105]
    v_pk_add_f32 v[100:101], v[100:101], v[108:109]
    v_pk_add_f32 v[96:97], v[96:97], v[100:101]
    v_mov_b32 v98, s28
    v_mov_b32 v99, s28
    s_lshl_b32 s16, s14, 3
    s_add_u32 s16, s16, s15
    s_lshl_b32 s16, s16, 9
    s_add_u32 s16, s16, 0x500000
    s_cmp_eq_u32 s3, 0
    s_cselect_b32 s16, s16, 0x7ffffff0
    s_mov_b64 exec, 0xffffffff
    buffer_store_dwordx4 v[96:99], v17, s[8:11], s16 offen sc1
    s_mov_b64 exec, -1
    s_lshr_b32 s16, s3, 2
    s_lshl_b32 s16, s16, 4
    s_add_u32 s16, s16, s31
    s_lshl_b32 s16, s16, 12
    s_and_b32 s17, s3, 3
    s_lshl_b32 s17, s17, 7
    s_add_u32 s16, s16, s17
    s_add_u32 s16, s16, 0x500000
    v_lshrrev_b32 v139, 3, v1
    v_lshlrev_b32 v139, 9, v139
    v_and_b32 v16, 7, v1
    v_lshl_add_u32 v139, v16, 4, v139
    v_and_b32 v140, 15, v1
    v_lshlrev_b32 v140, 4, v140
    s_lshl_b32 s17, s29, 8
    s_add_u32 s17, s17, 0x520000
    s_waitcnt vmcnt(4)
    v_lshlrev_b32 v56, 16, v40
    v_and_b32 v57, 0xffff0000, v40
    v_lshlrev_b32 v58, 16, v41
    v_and_b32 v59, 0xffff0000, v41
    v_lshlrev_b32 v60, 16, v42
    v_and_b32 v61, 0xffff0000, v42
    v_lshlrev_b32 v62, 16, v43
    v_and_b32 v63, 0xffff0000, v43
    s_waitcnt vmcnt(3)
    v_lshlrev_b32 v64, 16, v44
    v_and_b32 v65, 0xffff0000, v44
    v_lshlrev_b32 v66, 16, v45
    v_and_b32 v67, 0xffff0000, v45
    v_lshlrev_b32 v68, 16, v46
    v_and_b32 v69, 0xffff0000, v46
    v_lshlrev_b32 v70, 16, v47
    v_and_b32 v71, 0xffff0000, v47
    s_mov_b32 s27, 0
adaLN_cond__sliding_block_cached__moe_arch_mod__prompt_kernel_g2p:
    buffer_load_dwordx4 v[76:79], v139, s[8:11], s16 offen sc1
    buffer_load_dwordx4 v[80:83], v140, s[8:11], s17 offen sc1
    s_waitcnt vmcnt(1)
    v_cmp_ne_u32 vcc, s28, v78
    v_cmp_ne_u32 s[62:63], s28, v79
    s_or_b64 vcc, vcc, s[62:63]
    s_waitcnt vmcnt(0)
    v_cmp_ne_u32 s[62:63], s28, v83
    s_or_b64 vcc, vcc, s[62:63]
    s_add_u32 s27, s27, 1
    s_cmp_ge_u32 s27, 65536
    s_cbranch_scc1 adaLN_cond__sliding_block_cached__moe_arch_mod__prompt_kernel_g2g
    s_cbranch_vccnz adaLN_cond__sliding_block_cached__moe_arch_mod__prompt_kernel_g2p
adaLN_cond__sliding_block_cached__moe_arch_mod__prompt_kernel_g2g:
    v_add_f32_dpp v76, v76, v76 row_ror:8 row_mask:0xf bank_mask:0xf
    v_add_f32_dpp v77, v77, v77 row_ror:8 row_mask:0xf bank_mask:0xf
    v_mov_b32 v17, v76
    s_nop 1
    v_permlane16_swap_b32 v76, v17
    v_add_f32 v76, v76, v17
    v_mov_b32 v18, v77
    s_nop 1
    v_permlane16_swap_b32 v77, v18
    v_add_f32 v77, v77, v18
    v_mov_b32 v17, v76
    s_nop 1
    v_permlane32_swap_b32 v76, v17
    v_add_f32 v76, v76, v17
    v_mov_b32 v18, v77
    s_nop 1
    v_permlane32_swap_b32 v77, v18
    v_add_f32 v77, v77, v18
    v_cvt_pk_bf16_f32 v17, v76, v77
    v_lshlrev_b32 v76, 16, v17
    v_and_b32 v77, 0xffff0000, v17
    v_add_f32 v76, 0, v76
    v_add_f32 v77, 0, v77
    s_lshl_b32 s16, s3, 6
    s_add_u32 s16, s16, 151552
    v_lshl_add_u32 v16, v16, 3, s16
    ds_write_b64 v16, v[76:77]
    v_lshrrev_b32 v17, 4, v1
    v_lshlrev_b32 v17, 5, v17
    v_add_u32 v17, 151552, v17
    v_sub_f32 v56, v56, v80
    v_sub_f32 v57, v57, v80
    v_sub_f32 v58, v58, v80
    v_sub_f32 v59, v59, v80
    v_sub_f32 v60, v60, v80
    v_sub_f32 v61, v61, v80
    v_sub_f32 v62, v62, v80
    v_sub_f32 v63, v63, v80
    v_sub_f32 v64, v64, v80
    v_sub_f32 v65, v65, v80
    v_sub_f32 v66, v66, v80
    v_sub_f32 v67, v67, v80
    v_sub_f32 v68, v68, v80
    v_sub_f32 v69, v69, v80
    v_sub_f32 v70, v70, v80
    v_sub_f32 v71, v71, v80
    v_cvt_pk_bf16_f32 v18, v56, v57
    v_lshlrev_b32 v56, 16, v18
    v_and_b32 v57, 0xffff0000, v18
    v_cvt_pk_bf16_f32 v19, v58, v59
    v_lshlrev_b32 v58, 16, v19
    v_and_b32 v59, 0xffff0000, v19
    v_cvt_pk_bf16_f32 v18, v60, v61
    v_lshlrev_b32 v60, 16, v18
    v_and_b32 v61, 0xffff0000, v18
    v_cvt_pk_bf16_f32 v19, v62, v63
    v_lshlrev_b32 v62, 16, v19
    v_and_b32 v63, 0xffff0000, v19
    v_cvt_pk_bf16_f32 v18, v64, v65
    v_lshlrev_b32 v64, 16, v18
    v_and_b32 v65, 0xffff0000, v18
    v_cvt_pk_bf16_f32 v19, v66, v67
    v_lshlrev_b32 v66, 16, v19
    v_and_b32 v67, 0xffff0000, v19
    v_cvt_pk_bf16_f32 v18, v68, v69
    v_lshlrev_b32 v68, 16, v18
    v_and_b32 v69, 0xffff0000, v18
    v_cvt_pk_bf16_f32 v19, v70, v71
    v_lshlrev_b32 v70, 16, v19
    v_and_b32 v71, 0xffff0000, v19
    v_mul_f32 v56, v56, v82
    v_mul_f32 v57, v57, v82
    v_mul_f32 v58, v58, v82
    v_mul_f32 v59, v59, v82
    v_mul_f32 v60, v60, v82
    v_mul_f32 v61, v61, v82
    v_mul_f32 v62, v62, v82
    v_mul_f32 v63, v63, v82
    v_mul_f32 v64, v64, v82
    v_mul_f32 v65, v65, v82
    v_mul_f32 v66, v66, v82
    v_mul_f32 v67, v67, v82
    v_mul_f32 v68, v68, v82
    v_mul_f32 v69, v69, v82
    v_mul_f32 v70, v70, v82
    v_mul_f32 v71, v71, v82
    v_cvt_pk_bf16_f32 v18, v56, v57
    v_lshlrev_b32 v56, 16, v18
    v_and_b32 v57, 0xffff0000, v18
    v_cvt_pk_bf16_f32 v19, v58, v59
    v_lshlrev_b32 v58, 16, v19
    v_and_b32 v59, 0xffff0000, v19
    v_cvt_pk_bf16_f32 v18, v60, v61
    v_lshlrev_b32 v60, 16, v18
    v_and_b32 v61, 0xffff0000, v18
    v_cvt_pk_bf16_f32 v19, v62, v63
    v_lshlrev_b32 v62, 16, v19
    v_and_b32 v63, 0xffff0000, v19
    v_cvt_pk_bf16_f32 v18, v64, v65
    v_lshlrev_b32 v64, 16, v18
    v_and_b32 v65, 0xffff0000, v18
    v_cvt_pk_bf16_f32 v19, v66, v67
    v_lshlrev_b32 v66, 16, v19
    v_and_b32 v67, 0xffff0000, v19
    v_cvt_pk_bf16_f32 v18, v68, v69
    v_lshlrev_b32 v68, 16, v18
    v_and_b32 v69, 0xffff0000, v18
    v_cvt_pk_bf16_f32 v19, v70, v71
    v_lshlrev_b32 v70, 16, v19
    v_and_b32 v71, 0xffff0000, v19
    s_lshl_b32 s16, s29, 15
    s_lshl_b32 s17, s31, 11
    s_add_u32 s16, s16, s17
    s_waitcnt lgkmcnt(0)
    s_barrier
    ds_read_b128 v[96:99], v17 offset:256
    ds_read_b128 v[104:107], v17 offset:0
    ds_read_b128 v[100:103], v17 offset:272
    ds_read_b128 v[108:111], v17 offset:16
    ds_read_b128 v[112:115], v17 offset:384
    ds_read_b128 v[120:123], v17 offset:128
    ds_read_b128 v[116:119], v17 offset:400
    ds_read_b128 v[124:127], v17 offset:144
    s_waitcnt lgkmcnt(7)
    v_pk_mul_f32 v[56:57], v[56:57], v[96:97]
    v_pk_mul_f32 v[58:59], v[58:59], v[98:99]
    s_waitcnt lgkmcnt(5)
    v_pk_mul_f32 v[60:61], v[60:61], v[100:101]
    v_pk_mul_f32 v[62:63], v[62:63], v[102:103]
    v_cvt_pk_bf16_f32 v18, v56, v57
    v_lshlrev_b32 v56, 16, v18
    v_and_b32 v57, 0xffff0000, v18
    v_cvt_pk_bf16_f32 v19, v58, v59
    v_lshlrev_b32 v58, 16, v19
    v_and_b32 v59, 0xffff0000, v19
    v_cvt_pk_bf16_f32 v18, v60, v61
    v_lshlrev_b32 v60, 16, v18
    v_and_b32 v61, 0xffff0000, v18
    v_cvt_pk_bf16_f32 v19, v62, v63
    v_lshlrev_b32 v62, 16, v19
    v_and_b32 v63, 0xffff0000, v19
    v_pk_add_f32 v[56:57], v[56:57], v[104:105]
    v_pk_add_f32 v[58:59], v[58:59], v[106:107]
    s_waitcnt lgkmcnt(4)
    v_pk_add_f32 v[60:61], v[60:61], v[108:109]
    v_pk_add_f32 v[62:63], v[62:63], v[110:111]
    v_cvt_pk_bf16_f32 v32, v56, v57
    v_cvt_pk_bf16_f32 v33, v58, v59
    v_cvt_pk_bf16_f32 v34, v60, v61
    v_cvt_pk_bf16_f32 v35, v62, v63
    buffer_store_dwordx4 v[32:35], v2, s[8:11], s16 offen offset:0 sc1
    s_waitcnt lgkmcnt(3)
    v_pk_mul_f32 v[64:65], v[64:65], v[112:113]
    v_pk_mul_f32 v[66:67], v[66:67], v[114:115]
    s_waitcnt lgkmcnt(1)
    v_pk_mul_f32 v[68:69], v[68:69], v[116:117]
    v_pk_mul_f32 v[70:71], v[70:71], v[118:119]
    v_cvt_pk_bf16_f32 v18, v64, v65
    v_lshlrev_b32 v64, 16, v18
    v_and_b32 v65, 0xffff0000, v18
    v_cvt_pk_bf16_f32 v19, v66, v67
    v_lshlrev_b32 v66, 16, v19
    v_and_b32 v67, 0xffff0000, v19
    v_cvt_pk_bf16_f32 v18, v68, v69
    v_lshlrev_b32 v68, 16, v18
    v_and_b32 v69, 0xffff0000, v18
    v_cvt_pk_bf16_f32 v19, v70, v71
    v_lshlrev_b32 v70, 16, v19
    v_and_b32 v71, 0xffff0000, v19
    v_pk_add_f32 v[64:65], v[64:65], v[120:121]
    v_pk_add_f32 v[66:67], v[66:67], v[122:123]
    s_waitcnt lgkmcnt(0)
    v_pk_add_f32 v[68:69], v[68:69], v[124:125]
    v_pk_add_f32 v[70:71], v[70:71], v[126:127]
    v_cvt_pk_bf16_f32 v36, v64, v65
    v_cvt_pk_bf16_f32 v37, v66, v67
    v_cvt_pk_bf16_f32 v38, v68, v69
    v_cvt_pk_bf16_f32 v39, v70, v71
    buffer_store_dwordx4 v[36:39], v2, s[8:11], s16 offen offset:1024 sc1
    s_lshl_b32 s19, s3, 16
    s_lshl_b32 s20, s3, 11
    s_lshl_b32 s16, s12, 8
    s_add_u32 s4, s38, s16
    s_addc_u32 s5, s39, 0
    s_sub_u32 s6, 0x800000, s16
    s_mov_b32 s7, 0x20000
    s_barrier
    s_add_u32 s22, s19, 0x0
    s_add_u32 m0, s20, 0x0
    s_nop 0
    buffer_load_dwordx4 v3, s[4:7], s22 offen lds
    s_add_u32 s22, s19, 0x8000
    s_add_u32 m0, s20, 0x400
    s_nop 0
    buffer_load_dwordx4 v3, s[4:7], s22 offen lds
    s_add_u32 s22, s19, 0x80000
    s_add_u32 m0, s20, 0x4000
    s_nop 0
    buffer_load_dwordx4 v3, s[4:7], s22 offen lds
    s_add_u32 s22, s19, 0x88000
    s_add_u32 m0, s20, 0x4400
    s_nop 0
    buffer_load_dwordx4 v3, s[4:7], s22 offen lds
    s_add_u32 s22, s19, 0x100000
    s_add_u32 m0, s20, 0x8000
    s_nop 0
    buffer_load_dwordx4 v3, s[4:7], s22 offen lds
    s_add_u32 s22, s19, 0x108000
    s_add_u32 m0, s20, 0x8400
    s_nop 0
    buffer_load_dwordx4 v3, s[4:7], s22 offen lds
    v_mov_b32 v134, s28
    s_lshl_b32 s16, s29, 4
    s_add_u32 s16, s16, s31
    s_lshl_b32 s16, s16, 2
    s_add_u32 s16, s16, 0x528000
    v_and_b32 v16, 31, v1
    v_lshlrev_b32 v16, 2, v16
    s_lshl_b32 s17, s13, 3
    s_add_u32 s17, s17, s3
    s_lshl_b32 s17, s17, 7
    s_add_u32 s17, s17, 0x528000
    s_waitcnt vmcnt(6)
    s_mov_b64 exec, 1
    buffer_store_dword v134, v132, s[8:11], s16 offen sc1
    s_mov_b64 exec, -1
    s_waitcnt vmcnt(0)
    s_mov_b32 s27, 0
adaLN_cond__sliding_block_cached__moe_arch_mod__prompt_kernel_h3p:
    buffer_load_dword v17, v16, s[8:11], s17 offen sc1
    s_waitcnt vmcnt(0)
    v_cmp_ne_u32 vcc, s28, v17
    s_add_u32 s27, s27, 1
    s_cmp_ge_u32 s27, 65536
    s_cbranch_scc1 adaLN_cond__sliding_block_cached__moe_arch_mod__prompt_kernel_h3g
    s_cbranch_vccnz adaLN_cond__sliding_block_cached__moe_arch_mod__prompt_kernel_h3p
adaLN_cond__sliding_block_cached__moe_arch_mod__prompt_kernel_h3g:
    s_mov_b32 s23, 0x0
    buffer_load_dwordx4 v[88:91], v7, s[8:11], s23 offen offset:0 sc1
    s_mov_b32 s23, 0x8000
    buffer_load_dwordx4 v[92:95], v7, s[8:11], s23 offen offset:0 sc1
    s_mov_b32 s23, 0x0
    buffer_load_dwordx4 v[96:99], v7, s[8:11], s23 offen offset:1024 sc1
    s_mov_b32 s23, 0x8000
    buffer_load_dwordx4 v[100:103], v7, s[8:11], s23 offen offset:1024 sc1
    s_mov_b32 s23, 0x800
    buffer_load_dwordx4 v[104:107], v7, s[8:11], s23 offen offset:0 sc1
    s_mov_b32 s23, 0x8800
    buffer_load_dwordx4 v[108:111], v7, s[8:11], s23 offen offset:0 sc1
    s_mov_b32 s23, 0x800
    buffer_load_dwordx4 v[112:115], v7, s[8:11], s23 offen offset:1024 sc1
    s_mov_b32 s23, 0x8800
    buffer_load_dwordx4 v[116:119], v7, s[8:11], s23 offen offset:1024 sc1
    s_lshr_b32 s21, s12, 3
    s_lshl_b32 s21, s21, 17
    s_add_u32 s21, s21, s20
    s_add_u32 s21, s21, 0x400000
    s_barrier
    ds_read_b64_tr_b16 v[224:225], v4 offset:0
    ds_read_b64_tr_b16 v[226:227], v4 offset:1024
    ds_read_b64_tr_b16 v[228:229], v5 offset:32
    ds_read_b64_tr_b16 v[230:231], v5 offset:1056
    ds_read_b64_tr_b16 v[232:233], v4 offset:256
    ds_read_b64_tr_b16 v[234:235], v4 offset:1280
    ds_read_b64_tr_b16 v[236:237], v5 offset:288
    ds_read_b64_tr_b16 v[238:239], v5 offset:1312
    s_waitcnt vmcnt(7) lgkmcnt(6)
    v_mfma_f32_16x16x32_bf16 v[24:27], v[224:227], v[88:91], 0
    ds_read_b64_tr_b16 v[240:241], v4 offset:512
    s_waitcnt vmcnt(6)
    v_mfma_f32_16x16x32_bf16 v[28:31], v[224:227], v[92:95], 0
    ds_read_b64_tr_b16 v[242:243], v4 offset:1536
    s_waitcnt lgkmcnt(6)
    v_mfma_f32_16x16x32_bf16 v[32:35], v[228:231], v[88:91], 0
    ds_read_b64_tr_b16 v[244:245], v5 offset:544
    v_mfma_f32_16x16x32_bf16 v[36:39], v[228:231], v[92:95], 0
    ds_read_b64_tr_b16 v[246:247], v5 offset:1568
    s_mov_b32 s23, 0x1000
    buffer_load_dwordx4 v[120:123], v7, s[8:11], s23 offen offset:0 sc1
    s_waitcnt lgkmcnt(6)
    v_mfma_f32_16x16x32_bf16 v[40:43], v[232:235], v[88:91], 0
    ds_read_b64_tr_b16 v[224:225], v4 offset:768
    v_mfma_f32_16x16x32_bf16 v[44:47], v[232:235], v[92:95], 0
    ds_read_b64_tr_b16 v[226:227], v4 offset:1792
    s_waitcnt lgkmcnt(6)
    v_mfma_f32_16x16x32_bf16 v[48:51], v[236:239], v[88:91], 0
    ds_read_b64_tr_b16 v[228:229], v5 offset:800
    v_mfma_f32_16x16x32_bf16 v[52:55], v[236:239], v[92:95], 0
    ds_read_b64_tr_b16 v[230:231], v5 offset:1824
    s_waitcnt lgkmcnt(6)
    v_mfma_f32_16x16x32_bf16 v[56:59], v[240:243], v[88:91], 0
    ds_read_b64_tr_b16 v[232:233], v4 offset:8192
    v_mfma_f32_16x16x32_bf16 v[60:63], v[240:243], v[92:95], 0
    ds_read_b64_tr_b16 v[234:235], v4 offset:9216
    s_waitcnt lgkmcnt(6)
    v_mfma_f32_16x16x32_bf16 v[64:67], v[244:247], v[88:91], 0
    ds_read_b64_tr_b16 v[236:237], v5 offset:8224
    v_mfma_f32_16x16x32_bf16 v[68:71], v[244:247], v[92:95], 0
    ds_read_b64_tr_b16 v[238:239], v5 offset:9248
    s_mov_b32 s23, 0x9000
    buffer_load_dwordx4 v[124:127], v7, s[8:11], s23 offen offset:0 sc1
    s_waitcnt lgkmcnt(6)
    v_mfma_f32_16x16x32_bf16 v[72:75], v[224:227], v[88:91], 0
    ds_read_b64_tr_b16 v[240:241], v4 offset:8448
    v_mfma_f32_16x16x32_bf16 v[76:79], v[224:227], v[92:95], 0
    ds_read_b64_tr_b16 v[242:243], v4 offset:9472
    s_waitcnt lgkmcnt(6)
    v_mfma_f32_16x16x32_bf16 v[80:83], v[228:231], v[88:91], 0
    ds_read_b64_tr_b16 v[244:245], v5 offset:8480
    v_mfma_f32_16x16x32_bf16 v[84:87], v[228:231], v[92:95], 0
    ds_read_b64_tr_b16 v[246:247], v5 offset:9504
    s_waitcnt vmcnt(7) lgkmcnt(6)
    v_mfma_f32_16x16x32_bf16 v[24:27], v[232:235], v[96:99], v[24:27]
    ds_read_b64_tr_b16 v[224:225], v4 offset:8704
    s_waitcnt vmcnt(6)
    v_mfma_f32_16x16x32_bf16 v[28:31], v[232:235], v[100:103], v[28:31]
    ds_read_b64_tr_b16 v[226:227], v4 offset:9728
    s_waitcnt lgkmcnt(6)
    v_mfma_f32_16x16x32_bf16 v[32:35], v[236:239], v[96:99], v[32:35]
    ds_read_b64_tr_b16 v[228:229], v5 offset:8736
    v_mfma_f32_16x16x32_bf16 v[36:39], v[236:239], v[100:103], v[36:39]
    ds_read_b64_tr_b16 v[230:231], v5 offset:9760
    s_mov_b32 s23, 0x1000
    buffer_load_dwordx4 v[128:131], v7, s[8:11], s23 offen offset:1024 sc1
    s_waitcnt lgkmcnt(6)
    v_mfma_f32_16x16x32_bf16 v[40:43], v[240:243], v[96:99], v[40:43]
    ds_read_b64_tr_b16 v[232:233], v4 offset:8960
    v_mfma_f32_16x16x32_bf16 v[44:47], v[240:243], v[100:103], v[44:47]
    ds_read_b64_tr_b16 v[234:235], v4 offset:9984
    s_waitcnt lgkmcnt(6)
    v_mfma_f32_16x16x32_bf16 v[48:51], v[244:247], v[96:99], v[48:51]
    ds_read_b64_tr_b16 v[236:237], v5 offset:8992
    v_mfma_f32_16x16x32_bf16 v[52:55], v[244:247], v[100:103], v[52:55]
    ds_read_b64_tr_b16 v[238:239], v5 offset:10016
    s_waitcnt lgkmcnt(6)
    v_mfma_f32_16x16x32_bf16 v[56:59], v[224:227], v[96:99], v[56:59]
    v_mfma_f32_16x16x32_bf16 v[60:63], v[224:227], v[100:103], v[60:63]
    s_barrier
    ds_read_b64_tr_b16 v[240:241], v4 offset:16384
    ds_read_b64_tr_b16 v[242:243], v4 offset:17408
    s_waitcnt lgkmcnt(6)
    v_mfma_f32_16x16x32_bf16 v[64:67], v[228:231], v[96:99], v[64:67]
    ds_read_b64_tr_b16 v[244:245], v5 offset:16416
    v_mfma_f32_16x16x32_bf16 v[68:71], v[228:231], v[100:103], v[68:71]
    s_add_u32 s22, s19, 0x180000
    s_add_u32 m0, s20, 0xc000
    s_nop 0
    buffer_load_dwordx4 v3, s[4:7], s22 offen lds
    ds_read_b64_tr_b16 v[246:247], v5 offset:17440
    s_mov_b32 s23, 0x9000
    buffer_load_dwordx4 v[132:135], v7, s[8:11], s23 offen offset:1024 sc1
    s_waitcnt lgkmcnt(6)
    v_mfma_f32_16x16x32_bf16 v[72:75], v[232:235], v[96:99], v[72:75]
    ds_read_b64_tr_b16 v[224:225], v4 offset:16640
    v_mfma_f32_16x16x32_bf16 v[76:79], v[232:235], v[100:103], v[76:79]
    ds_read_b64_tr_b16 v[226:227], v4 offset:17664
    s_waitcnt lgkmcnt(6)
    v_mfma_f32_16x16x32_bf16 v[80:83], v[236:239], v[96:99], v[80:83]
    ds_read_b64_tr_b16 v[228:229], v5 offset:16672
    v_mfma_f32_16x16x32_bf16 v[84:87], v[236:239], v[100:103], v[84:87]
    ds_read_b64_tr_b16 v[230:231], v5 offset:17696
    s_waitcnt vmcnt(8) lgkmcnt(6)
    v_mfma_f32_16x16x32_bf16 v[24:27], v[240:243], v[104:107], v[24:27]
    ds_read_b64_tr_b16 v[232:233], v4 offset:16896
    s_waitcnt vmcnt(7)
    v_mfma_f32_16x16x32_bf16 v[28:31], v[240:243], v[108:111], v[28:31]
    ds_read_b64_tr_b16 v[234:235], v4 offset:17920
    s_waitcnt lgkmcnt(6)
    v_mfma_f32_16x16x32_bf16 v[32:35], v[244:247], v[104:107], v[32:35]
    ds_read_b64_tr_b16 v[236:237], v5 offset:16928
    v_mfma_f32_16x16x32_bf16 v[36:39], v[244:247], v[108:111], v[36:39]
    s_add_u32 s22, s19, 0x188000
    s_add_u32 m0, s20, 0xc400
    s_nop 0
    buffer_load_dwordx4 v3, s[4:7], s22 offen lds
    ds_read_b64_tr_b16 v[238:239], v5 offset:17952
    s_mov_b32 s23, 0x1800
    buffer_load_dwordx4 v[88:91], v7, s[8:11], s23 offen offset:0 sc1
    s_waitcnt lgkmcnt(6)
    v_mfma_f32_16x16x32_bf16 v[40:43], v[224:227], v[104:107], v[40:43]
    ds_read_b64_tr_b16 v[240:241], v4 offset:17152
    v_mfma_f32_16x16x32_bf16 v[44:47], v[224:227], v[108:111], v[44:47]
    ds_read_b64_tr_b16 v[242:243], v4 offset:18176
    s_waitcnt lgkmcnt(6)
    v_mfma_f32_16x16x32_bf16 v[48:51], v[228:231], v[104:107], v[48:51]
    ds_read_b64_tr_b16 v[244:245], v5 offset:17184
    v_mfma_f32_16x16x32_bf16 v[52:55], v[228:231], v[108:111], v[52:55]
    ds_read_b64_tr_b16 v[246:247], v5 offset:18208
    s_waitcnt lgkmcnt(6)
    v_mfma_f32_16x16x32_bf16 v[56:59], v[232:235], v[104:107], v[56:59]
    ds_read_b64_tr_b16 v[224:225], v4 offset:24576
    v_mfma_f32_16x16x32_bf16 v[60:63], v[232:235], v[108:111], v[60:63]
    ds_read_b64_tr_b16 v[226:227], v4 offset:25600
    s_waitcnt lgkmcnt(6)
    v_mfma_f32_16x16x32_bf16 v[64:67], v[236:239], v[104:107], v[64:67]
    ds_read_b64_tr_b16 v[228:229], v5 offset:24608
    v_mfma_f32_16x16x32_bf16 v[68:71], v[236:239], v[108:111], v[68:71]
    ds_read_b64_tr_b16 v[230:231], v5 offset:25632
    s_mov_b32 s23, 0x9800
    buffer_load_dwordx4 v[92:95], v7, s[8:11], s23 offen offset:0 sc1
    s_waitcnt lgkmcnt(6)
    v_mfma_f32_16x16x32_bf16 v[72:75], v[240:243], v[104:107], v[72:75]
    ds_read_b64_tr_b16 v[232:233], v4 offset:24832
    v_mfma_f32_16x16x32_bf16 v[76:79], v[240:243], v[108:111], v[76:79]
    ds_read_b64_tr_b16 v[234:235], v4 offset:25856
    s_waitcnt lgkmcnt(6)
    v_mfma_f32_16x16x32_bf16 v[80:83], v[244:247], v[104:107], v[80:83]
    ds_read_b64_tr_b16 v[236:237], v5 offset:24864
    v_mfma_f32_16x16x32_bf16 v[84:87], v[244:247], v[108:111], v[84:87]
    ds_read_b64_tr_b16 v[238:239], v5 offset:25888
    s_waitcnt vmcnt(9) lgkmcnt(6)
    v_mfma_f32_16x16x32_bf16 v[24:27], v[224:227], v[112:115], v[24:27]
    ds_read_b64_tr_b16 v[240:241], v4 offset:25088
    s_waitcnt vmcnt(8)
    v_mfma_f32_16x16x32_bf16 v[28:31], v[224:227], v[116:119], v[28:31]
    ds_read_b64_tr_b16 v[242:243], v4 offset:26112
    s_waitcnt lgkmcnt(6)
    v_mfma_f32_16x16x32_bf16 v[32:35], v[228:231], v[112:115], v[32:35]
    ds_read_b64_tr_b16 v[244:245], v5 offset:25120
    v_mfma_f32_16x16x32_bf16 v[36:39], v[228:231], v[116:119], v[36:39]
    ds_read_b64_tr_b16 v[246:247], v5 offset:26144
    s_mov_b32 s23, 0x1800
    buffer_load_dwordx4 v[96:99], v7, s[8:11], s23 offen offset:1024 sc1
    s_waitcnt lgkmcnt(6)
    v_mfma_f32_16x16x32_bf16 v[40:43], v[232:235], v[112:115], v[40:43]
    ds_read_b64_tr_b16 v[224:225], v4 offset:25344
    v_mfma_f32_16x16x32_bf16 v[44:47], v[232:235], v[116:119], v[44:47]
    ds_read_b64_tr_b16 v[226:227], v4 offset:26368
    s_waitcnt lgkmcnt(6)
    v_mfma_f32_16x16x32_bf16 v[48:51], v[236:239], v[112:115], v[48:51]
    ds_read_b64_tr_b16 v[228:229], v5 offset:25376
    v_mfma_f32_16x16x32_bf16 v[52:55], v[236:239], v[116:119], v[52:55]
    ds_read_b64_tr_b16 v[230:231], v5 offset:26400
    s_waitcnt lgkmcnt(6)
    v_mfma_f32_16x16x32_bf16 v[56:59], v[240:243], v[112:115], v[56:59]
    v_mfma_f32_16x16x32_bf16 v[60:63], v[240:243], v[116:119], v[60:63]
    s_barrier
    ds_read_b64_tr_b16 v[232:233], v4 offset:32768
    ds_read_b64_tr_b16 v[234:235], v4 offset:33792
    s_waitcnt lgkmcnt(6)
    v_mfma_f32_16x16x32_bf16 v[64:67], v[244:247], v[112:115], v[64:67]
    ds_read_b64_tr_b16 v[236:237], v5 offset:32800
    v_mfma_f32_16x16x32_bf16 v[68:71], v[244:247], v[116:119], v[68:71]
    s_add_u32 s22, s19, 0x200000
    s_add_u32 m0, s20, 0x0
    s_nop 0
    buffer_load_dwordx4 v3, s[4:7], s22 offen lds
    ds_read_b64_tr_b16 v[238:239], v5 offset:33824
    s_mov_b32 s23, 0x9800
    buffer_load_dwordx4 v[100:103], v7, s[8:11], s23 offen offset:1024 sc1
    s_waitcnt lgkmcnt(6)
    v_mfma_f32_16x16x32_bf16 v[72:75], v[224:227], v[112:115], v[72:75]
    ds_read_b64_tr_b16 v[240:241], v4 offset:33024
    v_mfma_f32_16x16x32_bf16 v[76:79], v[224:227], v[116:119], v[76:79]
    ds_read_b64_tr_b16 v[242:243], v4 offset:34048
    s_waitcnt lgkmcnt(6)
    v_mfma_f32_16x16x32_bf16 v[80:83], v[228:231], v[112:115], v[80:83]
    ds_read_b64_tr_b16 v[244:245], v5 offset:33056
    v_mfma_f32_16x16x32_bf16 v[84:87], v[228:231], v[116:119], v[84:87]
    ds_read_b64_tr_b16 v[246:247], v5 offset:34080
    s_waitcnt vmcnt(10) lgkmcnt(6)
    v_mfma_f32_16x16x32_bf16 v[24:27], v[232:235], v[120:123], v[24:27]
    ds_read_b64_tr_b16 v[224:225], v4 offset:33280
    s_waitcnt vmcnt(9)
    v_mfma_f32_16x16x32_bf16 v[28:31], v[232:235], v[124:127], v[28:31]
    ds_read_b64_tr_b16 v[226:227], v4 offset:34304
    s_waitcnt lgkmcnt(6)
    v_mfma_f32_16x16x32_bf16 v[32:35], v[236:239], v[120:123], v[32:35]
    ds_read_b64_tr_b16 v[228:229], v5 offset:33312
    v_mfma_f32_16x16x32_bf16 v[36:39], v[236:239], v[124:127], v[36:39]
    s_add_u32 s22, s19, 0x208000
    s_add_u32 m0, s20, 0x400
    s_nop 0
    buffer_load_dwordx4 v3, s[4:7], s22 offen lds
    ds_read_b64_tr_b16 v[230:231], v5 offset:34336
    s_mov_b32 s23, 0x2000
    buffer_load_dwordx4 v[104:107], v7, s[8:11], s23 offen offset:0 sc1
    s_waitcnt lgkmcnt(6)
    v_mfma_f32_16x16x32_bf16 v[40:43], v[240:243], v[120:123], v[40:43]
    ds_read_b64_tr_b16 v[232:233], v4 offset:33536
    v_mfma_f32_16x16x32_bf16 v[44:47], v[240:243], v[124:127], v[44:47]
    ds_read_b64_tr_b16 v[234:235], v4 offset:34560
    s_waitcnt lgkmcnt(6)
    v_mfma_f32_16x16x32_bf16 v[48:51], v[244:247], v[120:123], v[48:51]
    ds_read_b64_tr_b16 v[236:237], v5 offset:33568
    v_mfma_f32_16x16x32_bf16 v[52:55], v[244:247], v[124:127], v[52:55]
    ds_read_b64_tr_b16 v[238:239], v5 offset:34592
    s_waitcnt lgkmcnt(6)
    v_mfma_f32_16x16x32_bf16 v[56:59], v[224:227], v[120:123], v[56:59]
    ds_read_b64_tr_b16 v[240:241], v4 offset:40960
    v_mfma_f32_16x16x32_bf16 v[60:63], v[224:227], v[124:127], v[60:63]
    ds_read_b64_tr_b16 v[242:243], v4 offset:41984
    s_waitcnt lgkmcnt(6)
    v_mfma_f32_16x16x32_bf16 v[64:67], v[228:231], v[120:123], v[64:67]
    ds_read_b64_tr_b16 v[244:245], v5 offset:40992
    v_mfma_f32_16x16x32_bf16 v[68:71], v[228:231], v[124:127], v[68:71]
    ds_read_b64_tr_b16 v[246:247], v5 offset:42016
    s_mov_b32 s23, 0xa000
    buffer_load_dwordx4 v[108:111], v7, s[8:11], s23 offen offset:0 sc1
    s_waitcnt lgkmcnt(6)
    v_mfma_f32_16x16x32_bf16 v[72:75], v[232:235], v[120:123], v[72:75]
    ds_read_b64_tr_b16 v[224:225], v4 offset:41216
    v_mfma_f32_16x16x32_bf16 v[76:79], v[232:235], v[124:127], v[76:79]
    ds_read_b64_tr_b16 v[226:227], v4 offset:42240
    s_waitcnt lgkmcnt(6)
    v_mfma_f32_16x16x32_bf16 v[80:83], v[236:239], v[120:123], v[80:83]
    ds_read_b64_tr_b16 v[228:229], v5 offset:41248
    v_mfma_f32_16x16x32_bf16 v[84:87], v[236:239], v[124:127], v[84:87]
    ds_read_b64_tr_b16 v[230:231], v5 offset:42272
    s_waitcnt vmcnt(11) lgkmcnt(6)
    v_mfma_f32_16x16x32_bf16 v[24:27], v[240:243], v[128:131], v[24:27]
    ds_read_b64_tr_b16 v[232:233], v4 offset:41472
    s_waitcnt vmcnt(9)
    v_mfma_f32_16x16x32_bf16 v[28:31], v[240:243], v[132:135], v[28:31]
    ds_read_b64_tr_b16 v[234:235], v4 offset:42496
    s_waitcnt lgkmcnt(6)
    v_mfma_f32_16x16x32_bf16 v[32:35], v[244:247], v[128:131], v[32:35]
    ds_read_b64_tr_b16 v[236:237], v5 offset:41504
    v_mfma_f32_16x16x32_bf16 v[36:39], v[244:247], v[132:135], v[36:39]
    ds_read_b64_tr_b16 v[238:239], v5 offset:42528
    s_mov_b32 s23, 0x2000
    buffer_load_dwordx4 v[112:115], v7, s[8:11], s23 offen offset:1024 sc1
    s_waitcnt lgkmcnt(6)
    v_mfma_f32_16x16x32_bf16 v[40:43], v[224:227], v[128:131], v[40:43]
    ds_read_b64_tr_b16 v[240:241], v4 offset:41728
    v_mfma_f32_16x16x32_bf16 v[44:47], v[224:227], v[132:135], v[44:47]
    ds_read_b64_tr_b16 v[242:243], v4 offset:42752
    s_waitcnt lgkmcnt(6)
    v_mfma_f32_16x16x32_bf16 v[48:51], v[228:231], v[128:131], v[48:51]
    ds_read_b64_tr_b16 v[244:245], v5 offset:41760
    v_mfma_f32_16x16x32_bf16 v[52:55], v[228:231], v[132:135], v[52:55]
    ds_read_b64_tr_b16 v[246:247], v5 offset:42784
    s_waitcnt lgkmcnt(6)
    v_mfma_f32_16x16x32_bf16 v[56:59], v[232:235], v[128:131], v[56:59]
    v_mfma_f32_16x16x32_bf16 v[60:63], v[232:235], v[132:135], v[60:63]
    s_waitcnt vmcnt(9)
    s_barrier
    ds_read_b64_tr_b16 v[224:225], v4 offset:49152
    ds_read_b64_tr_b16 v[226:227], v4 offset:50176
    s_waitcnt lgkmcnt(6)
    v_mfma_f32_16x16x32_bf16 v[64:67], v[236:239], v[128:131], v[64:67]
    ds_read_b64_tr_b16 v[228:229], v5 offset:49184
    v_mfma_f32_16x16x32_bf16 v[68:71], v[236:239], v[132:135], v[68:71]
    s_add_u32 s22, s19, 0x280000
    s_add_u32 m0, s20, 0x4000
    s_nop 0
    buffer_load_dwordx4 v3, s[4:7], s22 offen lds
    ds_read_b64_tr_b16 v[230:231], v5 offset:50208
    s_mov_b32 s23, 0xa000
    buffer_load_dwordx4 v[116:119], v7, s[8:11], s23 offen offset:1024 sc1
    s_waitcnt lgkmcnt(6)
    v_mfma_f32_16x16x32_bf16 v[72:75], v[240:243], v[128:131], v[72:75]
    ds_read_b64_tr_b16 v[232:233], v4 offset:49408
    v_mfma_f32_16x16x32_bf16 v[76:79], v[240:243], v[132:135], v[76:79]
    ds_read_b64_tr_b16 v[234:235], v4 offset:50432
    s_waitcnt lgkmcnt(6)
    v_mfma_f32_16x16x32_bf16 v[80:83], v[244:247], v[128:131], v[80:83]
    ds_read_b64_tr_b16 v[236:237], v5 offset:49440
    v_mfma_f32_16x16x32_bf16 v[84:87], v[244:247], v[132:135], v[84:87]
    ds_read_b64_tr_b16 v[238:239], v5 offset:50464
    s_waitcnt vmcnt(10) lgkmcnt(6)
    v_mfma_f32_16x16x32_bf16 v[24:27], v[224:227], v[88:91], v[24:27]
    ds_read_b64_tr_b16 v[240:241], v4 offset:49664
    s_waitcnt vmcnt(9)
    v_mfma_f32_16x16x32_bf16 v[28:31], v[224:227], v[92:95], v[28:31]
    ds_read_b64_tr_b16 v[242:243], v4 offset:50688
    s_waitcnt lgkmcnt(6)
    v_mfma_f32_16x16x32_bf16 v[32:35], v[228:231], v[88:91], v[32:35]
    ds_read_b64_tr_b16 v[244:245], v5 offset:49696
    v_mfma_f32_16x16x32_bf16 v[36:39], v[228:231], v[92:95], v[36:39]
    s_add_u32 s22, s19, 0x288000
    s_add_u32 m0, s20, 0x4400
    s_nop 0
    buffer_load_dwordx4 v3, s[4:7], s22 offen lds
    ds_read_b64_tr_b16 v[246:247], v5 offset:50720
    s_mov_b32 s23, 0x2800
    buffer_load_dwordx4 v[120:123], v7, s[8:11], s23 offen offset:0 sc1
    s_waitcnt lgkmcnt(6)
    v_mfma_f32_16x16x32_bf16 v[40:43], v[232:235], v[88:91], v[40:43]
    ds_read_b64_tr_b16 v[224:225], v4 offset:49920
    v_mfma_f32_16x16x32_bf16 v[44:47], v[232:235], v[92:95], v[44:47]
    ds_read_b64_tr_b16 v[226:227], v4 offset:50944
    s_waitcnt lgkmcnt(6)
    v_mfma_f32_16x16x32_bf16 v[48:51], v[236:239], v[88:91], v[48:51]
    ds_read_b64_tr_b16 v[228:229], v5 offset:49952
    v_mfma_f32_16x16x32_bf16 v[52:55], v[236:239], v[92:95], v[52:55]
    ds_read_b64_tr_b16 v[230:231], v5 offset:50976
    s_waitcnt lgkmcnt(6)
    v_mfma_f32_16x16x32_bf16 v[56:59], v[240:243], v[88:91], v[56:59]
    ds_read_b64_tr_b16 v[232:233], v4 offset:57344
    v_mfma_f32_16x16x32_bf16 v[60:63], v[240:243], v[92:95], v[60:63]
    ds_read_b64_tr_b16 v[234:235], v4 offset:58368
    s_waitcnt lgkmcnt(6)
    v_mfma_f32_16x16x32_bf16 v[64:67], v[244:247], v[88:91], v[64:67]
    ds_read_b64_tr_b16 v[236:237], v5 offset:57376
    v_mfma_f32_16x16x32_bf16 v[68:71], v[244:247], v[92:95], v[68:71]
    ds_read_b64_tr_b16 v[238:239], v5 offset:58400
    s_mov_b32 s23, 0xa800
    buffer_load_dwordx4 v[124:127], v7, s[8:11], s23 offen offset:0 sc1
    s_waitcnt lgkmcnt(6)
    v_mfma_f32_16x16x32_bf16 v[72:75], v[224:227], v[88:91], v[72:75]
    ds_read_b64_tr_b16 v[240:241], v4 offset:57600
    v_mfma_f32_16x16x32_bf16 v[76:79], v[224:227], v[92:95], v[76:79]
    ds_read_b64_tr_b16 v[242:243], v4 offset:58624
    s_waitcnt lgkmcnt(6)
    v_mfma_f32_16x16x32_bf16 v[80:83], v[228:231], v[88:91], v[80:83]
    ds_read_b64_tr_b16 v[244:245], v5 offset:57632
    v_mfma_f32_16x16x32_bf16 v[84:87], v[228:231], v[92:95], v[84:87]
    ds_read_b64_tr_b16 v[246:247], v5 offset:58656
    s_waitcnt vmcnt(11) lgkmcnt(6)
    v_mfma_f32_16x16x32_bf16 v[24:27], v[232:235], v[96:99], v[24:27]
    ds_read_b64_tr_b16 v[224:225], v4 offset:57856
    s_waitcnt vmcnt(9)
    v_mfma_f32_16x16x32_bf16 v[28:31], v[232:235], v[100:103], v[28:31]
    ds_read_b64_tr_b16 v[226:227], v4 offset:58880
    s_waitcnt lgkmcnt(6)
    v_mfma_f32_16x16x32_bf16 v[32:35], v[236:239], v[96:99], v[32:35]
    ds_read_b64_tr_b16 v[228:229], v5 offset:57888
    v_mfma_f32_16x16x32_bf16 v[36:39], v[236:239], v[100:103], v[36:39]
    ds_read_b64_tr_b16 v[230:231], v5 offset:58912
    s_mov_b32 s23, 0x2800
    buffer_load_dwordx4 v[128:131], v7, s[8:11], s23 offen offset:1024 sc1
    s_waitcnt lgkmcnt(6)
    v_mfma_f32_16x16x32_bf16 v[40:43], v[240:243], v[96:99], v[40:43]
    ds_read_b64_tr_b16 v[232:233], v4 offset:58112
    v_mfma_f32_16x16x32_bf16 v[44:47], v[240:243], v[100:103], v[44:47]
    ds_read_b64_tr_b16 v[234:235], v4 offset:59136
    s_waitcnt lgkmcnt(6)
    v_mfma_f32_16x16x32_bf16 v[48:51], v[244:247], v[96:99], v[48:51]
    ds_read_b64_tr_b16 v[236:237], v5 offset:58144
    v_mfma_f32_16x16x32_bf16 v[52:55], v[244:247], v[100:103], v[52:55]
    ds_read_b64_tr_b16 v[238:239], v5 offset:59168
    s_waitcnt lgkmcnt(6)
    v_mfma_f32_16x16x32_bf16 v[56:59], v[224:227], v[96:99], v[56:59]
    v_mfma_f32_16x16x32_bf16 v[60:63], v[224:227], v[100:103], v[60:63]
    s_waitcnt vmcnt(9)
    s_barrier
    ds_read_b64_tr_b16 v[240:241], v4 offset:0
    ds_read_b64_tr_b16 v[242:243], v4 offset:1024
    s_waitcnt lgkmcnt(6)
    v_mfma_f32_16x16x32_bf16 v[64:67], v[228:231], v[96:99], v[64:67]
    ds_read_b64_tr_b16 v[244:245], v5 offset:32
    v_mfma_f32_16x16x32_bf16 v[68:71], v[228:231], v[100:103], v[68:71]
    s_add_u32 s22, s19, 0x300000
    s_add_u32 m0, s20, 0x8000
    s_nop 0
    buffer_load_dwordx4 v3, s[4:7], s22 offen lds
    ds_read_b64_tr_b16 v[246:247], v5 offset:1056
    s_mov_b32 s23, 0xa800
    buffer_load_dwordx4 v[132:135], v7, s[8:11], s23 offen offset:1024 sc1
    s_waitcnt lgkmcnt(6)
    v_mfma_f32_16x16x32_bf16 v[72:75], v[232:235], v[96:99], v[72:75]
    ds_read_b64_tr_b16 v[224:225], v4 offset:256
    v_mfma_f32_16x16x32_bf16 v[76:79], v[232:235], v[100:103], v[76:79]
    ds_read_b64_tr_b16 v[226:227], v4 offset:1280
    s_waitcnt lgkmcnt(6)
    v_mfma_f32_16x16x32_bf16 v[80:83], v[236:239], v[96:99], v[80:83]
    ds_read_b64_tr_b16 v[228:229], v5 offset:288
    v_mfma_f32_16x16x32_bf16 v[84:87], v[236:239], v[100:103], v[84:87]
    ds_read_b64_tr_b16 v[230:231], v5 offset:1312
    s_waitcnt vmcnt(10) lgkmcnt(6)
    v_mfma_f32_16x16x32_bf16 v[24:27], v[240:243], v[104:107], v[24:27]
    ds_read_b64_tr_b16 v[232:233], v4 offset:512
    s_waitcnt vmcnt(9)
    v_mfma_f32_16x16x32_bf16 v[28:31], v[240:243], v[108:111], v[28:31]
    ds_read_b64_tr_b16 v[234:235], v4 offset:1536
    s_waitcnt lgkmcnt(6)
    v_mfma_f32_16x16x32_bf16 v[32:35], v[244:247], v[104:107], v[32:35]
    ds_read_b64_tr_b16 v[236:237], v5 offset:544
    v_mfma_f32_16x16x32_bf16 v[36:39], v[244:247], v[108:111], v[36:39]
    s_add_u32 s22, s19, 0x308000
    s_add_u32 m0, s20, 0x8400
    s_nop 0
    buffer_load_dwordx4 v3, s[4:7], s22 offen lds
    ds_read_b64_tr_b16 v[238:239], v5 offset:1568
    s_mov_b32 s23, 0x3000
    buffer_load_dwordx4 v[88:91], v7, s[8:11], s23 offen offset:0 sc1
    s_waitcnt lgkmcnt(6)
    v_mfma_f32_16x16x32_bf16 v[40:43], v[224:227], v[104:107], v[40:43]
    ds_read_b64_tr_b16 v[240:241], v4 offset:768
    v_mfma_f32_16x16x32_bf16 v[44:47], v[224:227], v[108:111], v[44:47]
    ds_read_b64_tr_b16 v[242:243], v4 offset:1792
    s_waitcnt lgkmcnt(6)
    v_mfma_f32_16x16x32_bf16 v[48:51], v[228:231], v[104:107], v[48:51]
    ds_read_b64_tr_b16 v[244:245], v5 offset:800
    v_mfma_f32_16x16x32_bf16 v[52:55], v[228:231], v[108:111], v[52:55]
    ds_read_b64_tr_b16 v[246:247], v5 offset:1824
    s_waitcnt lgkmcnt(6)
    v_mfma_f32_16x16x32_bf16 v[56:59], v[232:235], v[104:107], v[56:59]
    ds_read_b64_tr_b16 v[224:225], v4 offset:8192
    v_mfma_f32_16x16x32_bf16 v[60:63], v[232:235], v[108:111], v[60:63]
    ds_read_b64_tr_b16 v[226:227], v4 offset:9216
    s_waitcnt lgkmcnt(6)
    v_mfma_f32_16x16x32_bf16 v[64:67], v[236:239], v[104:107], v[64:67]
    ds_read_b64_tr_b16 v[228:229], v5 offset:8224
    v_mfma_f32_16x16x32_bf16 v[68:71], v[236:239], v[108:111], v[68:71]
    ds_read_b64_tr_b16 v[230:231], v5 offset:9248
    s_mov_b32 s23, 0xb000
    buffer_load_dwordx4 v[92:95], v7, s[8:11], s23 offen offset:0 sc1
    s_waitcnt lgkmcnt(6)
    v_mfma_f32_16x16x32_bf16 v[72:75], v[240:243], v[104:107], v[72:75]
    ds_read_b64_tr_b16 v[232:233], v4 offset:8448
    v_mfma_f32_16x16x32_bf16 v[76:79], v[240:243], v[108:111], v[76:79]
    ds_read_b64_tr_b16 v[234:235], v4 offset:9472
    s_waitcnt lgkmcnt(6)
    v_mfma_f32_16x16x32_bf16 v[80:83], v[244:247], v[104:107], v[80:83]
    ds_read_b64_tr_b16 v[236:237], v5 offset:8480
    v_mfma_f32_16x16x32_bf16 v[84:87], v[244:247], v[108:111], v[84:87]
    ds_read_b64_tr_b16 v[238:239], v5 offset:9504
    s_waitcnt vmcnt(11) lgkmcnt(6)
    v_mfma_f32_16x16x32_bf16 v[24:27], v[224:227], v[112:115], v[24:27]
    ds_read_b64_tr_b16 v[240:241], v4 offset:8704
    s_waitcnt vmcnt(9)
    v_mfma_f32_16x16x32_bf16 v[28:31], v[224:227], v[116:119], v[28:31]
    ds_read_b64_tr_b16 v[242:243], v4 offset:9728
    s_waitcnt lgkmcnt(6)
    v_mfma_f32_16x16x32_bf16 v[32:35], v[228:231], v[112:115], v[32:35]
    ds_read_b64_tr_b16 v[244:245], v5 offset:8736
    v_mfma_f32_16x16x32_bf16 v[36:39], v[228:231], v[116:119], v[36:39]
    ds_read_b64_tr_b16 v[246:247], v5 offset:9760
    s_mov_b32 s23, 0x3000
    buffer_load_dwordx4 v[96:99], v7, s[8:11], s23 offen offset:1024 sc1
    s_waitcnt lgkmcnt(6)
    v_mfma_f32_16x16x32_bf16 v[40:43], v[232:235], v[112:115], v[40:43]
    ds_read_b64_tr_b16 v[224:225], v4 offset:8960
    v_mfma_f32_16x16x32_bf16 v[44:47], v[232:235], v[116:119], v[44:47]
    ds_read_b64_tr_b16 v[226:227], v4 offset:9984
    s_waitcnt lgkmcnt(6)
    v_mfma_f32_16x16x32_bf16 v[48:51], v[236:239], v[112:115], v[48:51]
    ds_read_b64_tr_b16 v[228:229], v5 offset:8992
    v_mfma_f32_16x16x32_bf16 v[52:55], v[236:239], v[116:119], v[52:55]
    ds_read_b64_tr_b16 v[230:231], v5 offset:10016
    s_waitcnt lgkmcnt(6)
    v_mfma_f32_16x16x32_bf16 v[56:59], v[240:243], v[112:115], v[56:59]
    v_mfma_f32_16x16x32_bf16 v[60:63], v[240:243], v[116:119], v[60:63]
    s_waitcnt vmcnt(9)
    s_barrier
    ds_read_b64_tr_b16 v[232:233], v4 offset:16384
    ds_read_b64_tr_b16 v[234:235], v4 offset:17408
    s_waitcnt lgkmcnt(6)
    v_mfma_f32_16x16x32_bf16 v[64:67], v[244:247], v[112:115], v[64:67]
    ds_read_b64_tr_b16 v[236:237], v5 offset:16416
    v_mfma_f32_16x16x32_bf16 v[68:71], v[244:247], v[116:119], v[68:71]
    s_add_u32 s22, s19, 0x380000
    s_add_u32 m0, s20, 0xc000
    s_nop 0
    buffer_load_dwordx4 v3, s[4:7], s22 offen lds
    ds_read_b64_tr_b16 v[238:239], v5 offset:17440
    s_mov_b32 s23, 0xb000
    buffer_load_dwordx4 v[100:103], v7, s[8:11], s23 offen offset:1024 sc1
    s_waitcnt lgkmcnt(6)
    v_mfma_f32_16x16x32_bf16 v[72:75], v[224:227], v[112:115], v[72:75]
    ds_read_b64_tr_b16 v[240:241], v4 offset:16640
    v_mfma_f32_16x16x32_bf16 v[76:79], v[224:227], v[116:119], v[76:79]
    ds_read_b64_tr_b16 v[242:243], v4 offset:17664
    s_waitcnt lgkmcnt(6)
    v_mfma_f32_16x16x32_bf16 v[80:83], v[228:231], v[112:115], v[80:83]
    ds_read_b64_tr_b16 v[244:245], v5 offset:16672
    v_mfma_f32_16x16x32_bf16 v[84:87], v[228:231], v[116:119], v[84:87]
    ds_read_b64_tr_b16 v[246:247], v5 offset:17696
    s_waitcnt vmcnt(10) lgkmcnt(6)
    v_mfma_f32_16x16x32_bf16 v[24:27], v[232:235], v[120:123], v[24:27]
    ds_read_b64_tr_b16 v[224:225], v4 offset:16896
    s_waitcnt vmcnt(9)
    v_mfma_f32_16x16x32_bf16 v[28:31], v[232:235], v[124:127], v[28:31]
    ds_read_b64_tr_b16 v[226:227], v4 offset:17920
    s_waitcnt lgkmcnt(6)
    v_mfma_f32_16x16x32_bf16 v[32:35], v[236:239], v[120:123], v[32:35]
    ds_read_b64_tr_b16 v[228:229], v5 offset:16928
    v_mfma_f32_16x16x32_bf16 v[36:39], v[236:239], v[124:127], v[36:39]
    s_add_u32 s22, s19, 0x388000
    s_add_u32 m0, s20, 0xc400
    s_nop 0
    buffer_load_dwordx4 v3, s[4:7], s22 offen lds
    ds_read_b64_tr_b16 v[230:231], v5 offset:17952
    s_mov_b32 s23, 0x3800
    buffer_load_dwordx4 v[104:107], v7, s[8:11], s23 offen offset:0 sc1
    s_waitcnt lgkmcnt(6)
    v_mfma_f32_16x16x32_bf16 v[40:43], v[240:243], v[120:123], v[40:43]
    ds_read_b64_tr_b16 v[232:233], v4 offset:17152
    v_mfma_f32_16x16x32_bf16 v[44:47], v[240:243], v[124:127], v[44:47]
    ds_read_b64_tr_b16 v[234:235], v4 offset:18176
    s_waitcnt lgkmcnt(6)
    v_mfma_f32_16x16x32_bf16 v[48:51], v[244:247], v[120:123], v[48:51]
    ds_read_b64_tr_b16 v[236:237], v5 offset:17184
    v_mfma_f32_16x16x32_bf16 v[52:55], v[244:247], v[124:127], v[52:55]
    ds_read_b64_tr_b16 v[238:239], v5 offset:18208
    s_waitcnt lgkmcnt(6)
    v_mfma_f32_16x16x32_bf16 v[56:59], v[224:227], v[120:123], v[56:59]
    ds_read_b64_tr_b16 v[240:241], v4 offset:24576
    v_mfma_f32_16x16x32_bf16 v[60:63], v[224:227], v[124:127], v[60:63]
    ds_read_b64_tr_b16 v[242:243], v4 offset:25600
    s_waitcnt lgkmcnt(6)
    v_mfma_f32_16x16x32_bf16 v[64:67], v[228:231], v[120:123], v[64:67]
    ds_read_b64_tr_b16 v[244:245], v5 offset:24608
    v_mfma_f32_16x16x32_bf16 v[68:71], v[228:231], v[124:127], v[68:71]
    ds_read_b64_tr_b16 v[246:247], v5 offset:25632
    s_mov_b32 s23, 0xb800
    buffer_load_dwordx4 v[108:111], v7, s[8:11], s23 offen offset:0 sc1
    s_waitcnt lgkmcnt(6)
    v_mfma_f32_16x16x32_bf16 v[72:75], v[232:235], v[120:123], v[72:75]
    ds_read_b64_tr_b16 v[224:225], v4 offset:24832
    v_mfma_f32_16x16x32_bf16 v[76:79], v[232:235], v[124:127], v[76:79]
    ds_read_b64_tr_b16 v[226:227], v4 offset:25856
    s_waitcnt lgkmcnt(6)
    v_mfma_f32_16x16x32_bf16 v[80:83], v[236:239], v[120:123], v[80:83]
    ds_read_b64_tr_b16 v[228:229], v5 offset:24864
    v_mfma_f32_16x16x32_bf16 v[84:87], v[236:239], v[124:127], v[84:87]
    ds_read_b64_tr_b16 v[230:231], v5 offset:25888
    s_waitcnt vmcnt(11) lgkmcnt(6)
    v_mfma_f32_16x16x32_bf16 v[24:27], v[240:243], v[128:131], v[24:27]
    ds_read_b64_tr_b16 v[232:233], v4 offset:25088
    s_waitcnt vmcnt(9)
    v_mfma_f32_16x16x32_bf16 v[28:31], v[240:243], v[132:135], v[28:31]
    ds_read_b64_tr_b16 v[234:235], v4 offset:26112
    s_waitcnt lgkmcnt(6)
    v_mfma_f32_16x16x32_bf16 v[32:35], v[244:247], v[128:131], v[32:35]
    ds_read_b64_tr_b16 v[236:237], v5 offset:25120
    v_mfma_f32_16x16x32_bf16 v[36:39], v[244:247], v[132:135], v[36:39]
    ds_read_b64_tr_b16 v[238:239], v5 offset:26144
    s_mov_b32 s23, 0x3800
    buffer_load_dwordx4 v[112:115], v7, s[8:11], s23 offen offset:1024 sc1
    s_waitcnt lgkmcnt(6)
    v_mfma_f32_16x16x32_bf16 v[40:43], v[224:227], v[128:131], v[40:43]
    ds_read_b64_tr_b16 v[240:241], v4 offset:25344
    v_mfma_f32_16x16x32_bf16 v[44:47], v[224:227], v[132:135], v[44:47]
    ds_read_b64_tr_b16 v[242:243], v4 offset:26368
    s_waitcnt lgkmcnt(6)
    v_mfma_f32_16x16x32_bf16 v[48:51], v[228:231], v[128:131], v[48:51]
    ds_read_b64_tr_b16 v[244:245], v5 offset:25376
    v_mfma_f32_16x16x32_bf16 v[52:55], v[228:231], v[132:135], v[52:55]
    ds_read_b64_tr_b16 v[246:247], v5 offset:26400
    s_waitcnt lgkmcnt(6)
    v_mfma_f32_16x16x32_bf16 v[56:59], v[232:235], v[128:131], v[56:59]
    v_mfma_f32_16x16x32_bf16 v[60:63], v[232:235], v[132:135], v[60:63]
    s_waitcnt vmcnt(9)
    s_barrier
    ds_read_b64_tr_b16 v[224:225], v4 offset:32768
    ds_read_b64_tr_b16 v[226:227], v4 offset:33792
    s_waitcnt lgkmcnt(6)
    v_mfma_f32_16x16x32_bf16 v[64:67], v[236:239], v[128:131], v[64:67]
    ds_read_b64_tr_b16 v[228:229], v5 offset:32800
    v_mfma_f32_16x16x32_bf16 v[68:71], v[236:239], v[132:135], v[68:71]
    s_add_u32 s22, s19, 0x400000
    s_add_u32 m0, s20, 0x0
    s_nop 0
    buffer_load_dwordx4 v3, s[4:7], s22 offen lds
    ds_read_b64_tr_b16 v[230:231], v5 offset:33824
    s_mov_b32 s23, 0xb800
    buffer_load_dwordx4 v[116:119], v7, s[8:11], s23 offen offset:1024 sc1
    s_waitcnt lgkmcnt(6)
    v_mfma_f32_16x16x32_bf16 v[72:75], v[240:243], v[128:131], v[72:75]
    ds_read_b64_tr_b16 v[232:233], v4 offset:33024
    v_mfma_f32_16x16x32_bf16 v[76:79], v[240:243], v[132:135], v[76:79]
    ds_read_b64_tr_b16 v[234:235], v4 offset:34048
    s_waitcnt lgkmcnt(6)
    v_mfma_f32_16x16x32_bf16 v[80:83], v[244:247], v[128:131], v[80:83]
    ds_read_b64_tr_b16 v[236:237], v5 offset:33056
    v_mfma_f32_16x16x32_bf16 v[84:87], v[244:247], v[132:135], v[84:87]
    ds_read_b64_tr_b16 v[238:239], v5 offset:34080
    s_waitcnt vmcnt(10) lgkmcnt(6)
    v_mfma_f32_16x16x32_bf16 v[24:27], v[224:227], v[88:91], v[24:27]
    ds_read_b64_tr_b16 v[240:241], v4 offset:33280
    s_waitcnt vmcnt(9)
    v_mfma_f32_16x16x32_bf16 v[28:31], v[224:227], v[92:95], v[28:31]
    ds_read_b64_tr_b16 v[242:243], v4 offset:34304
    s_waitcnt lgkmcnt(6)
    v_mfma_f32_16x16x32_bf16 v[32:35], v[228:231], v[88:91], v[32:35]
    ds_read_b64_tr_b16 v[244:245], v5 offset:33312
    v_mfma_f32_16x16x32_bf16 v[36:39], v[228:231], v[92:95], v[36:39]
    s_add_u32 s22, s19, 0x408000
    s_add_u32 m0, s20, 0x400
    s_nop 0
    buffer_load_dwordx4 v3, s[4:7], s22 offen lds
    ds_read_b64_tr_b16 v[246:247], v5 offset:34336
    s_mov_b32 s23, 0x4000
    buffer_load_dwordx4 v[120:123], v7, s[8:11], s23 offen offset:0 sc1
    s_waitcnt lgkmcnt(6)
    v_mfma_f32_16x16x32_bf16 v[40:43], v[232:235], v[88:91], v[40:43]
    ds_read_b64_tr_b16 v[224:225], v4 offset:33536
    v_mfma_f32_16x16x32_bf16 v[44:47], v[232:235], v[92:95], v[44:47]
    ds_read_b64_tr_b16 v[226:227], v4 offset:34560
    s_waitcnt lgkmcnt(6)
    v_mfma_f32_16x16x32_bf16 v[48:51], v[236:239], v[88:91], v[48:51]
    ds_read_b64_tr_b16 v[228:229], v5 offset:33568
    v_mfma_f32_16x16x32_bf16 v[52:55], v[236:239], v[92:95], v[52:55]
    ds_read_b64_tr_b16 v[230:231], v5 offset:34592
    s_waitcnt lgkmcnt(6)
    v_mfma_f32_16x16x32_bf16 v[56:59], v[240:243], v[88:91], v[56:59]
    ds_read_b64_tr_b16 v[232:233], v4 offset:40960
    v_mfma_f32_16x16x32_bf16 v[60:63], v[240:243], v[92:95], v[60:63]
    ds_read_b64_tr_b16 v[234:235], v4 offset:41984
    s_waitcnt lgkmcnt(6)
    v_mfma_f32_16x16x32_bf16 v[64:67], v[244:247], v[88:91], v[64:67]
    ds_read_b64_tr_b16 v[236:237], v5 offset:40992
    v_mfma_f32_16x16x32_bf16 v[68:71], v[244:247], v[92:95], v[68:71]
    ds_read_b64_tr_b16 v[238:239], v5 offset:42016
    s_mov_b32 s23, 0xc000
    buffer_load_dwordx4 v[124:127], v7, s[8:11], s23 offen offset:0 sc1
    s_waitcnt lgkmcnt(6)
    v_mfma_f32_16x16x32_bf16 v[72:75], v[224:227], v[88:91], v[72:75]
    ds_read_b64_tr_b16 v[240:241], v4 offset:41216
    v_lshrrev_b32 v21, 4, v1
    v_lshlrev_b32 v21, 9, v21
    v_and_b32 v20, 15, v1
    v_lshl_add_u32 v21, v20, 4, v21
    s_lshr_b32 s18, s12, 3
    s_lshl_b32 s18, s18, 11
    s_add_u32 s18, s18, 0x528100
    buffer_load_dwordx4 v[12:15], v21, s[8:11], s18 offen sc1
    v_mfma_f32_16x16x32_bf16 v[76:79], v[224:227], v[92:95], v[76:79]
    ds_read_b64_tr_b16 v[242:243], v4 offset:42240
    s_waitcnt lgkmcnt(6)
    v_mfma_f32_16x16x32_bf16 v[80:83], v[228:231], v[88:91], v[80:83]
    ds_read_b64_tr_b16 v[244:245], v5 offset:41248
    v_mfma_f32_16x16x32_bf16 v[84:87], v[228:231], v[92:95], v[84:87]
    ds_read_b64_tr_b16 v[246:247], v5 offset:42272
    s_waitcnt vmcnt(12) lgkmcnt(6)
    v_mfma_f32_16x16x32_bf16 v[24:27], v[232:235], v[96:99], v[24:27]
    ds_read_b64_tr_b16 v[224:225], v4 offset:41472
    s_waitcnt vmcnt(10)
    v_mfma_f32_16x16x32_bf16 v[28:31], v[232:235], v[100:103], v[28:31]
    ds_read_b64_tr_b16 v[226:227], v4 offset:42496
    s_waitcnt lgkmcnt(6)
    v_mfma_f32_16x16x32_bf16 v[32:35], v[236:239], v[96:99], v[32:35]
    ds_read_b64_tr_b16 v[228:229], v5 offset:41504
    v_mfma_f32_16x16x32_bf16 v[36:39], v[236:239], v[100:103], v[36:39]
    ds_read_b64_tr_b16 v[230:231], v5 offset:42528
    s_mov_b32 s23, 0x4000
    buffer_load_dwordx4 v[128:131], v7, s[8:11], s23 offen offset:1024 sc1
    s_waitcnt lgkmcnt(6)
    v_mfma_f32_16x16x32_bf16 v[40:43], v[240:243], v[96:99], v[40:43]
    ds_read_b64_tr_b16 v[232:233], v4 offset:41728
    v_mfma_f32_16x16x32_bf16 v[44:47], v[240:243], v[100:103], v[44:47]
    ds_read_b64_tr_b16 v[234:235], v4 offset:42752
    s_waitcnt lgkmcnt(6)
    v_mfma_f32_16x16x32_bf16 v[48:51], v[244:247], v[96:99], v[48:51]
    ds_read_b64_tr_b16 v[236:237], v5 offset:41760
    v_mfma_f32_16x16x32_bf16 v[52:55], v[244:247], v[100:103], v[52:55]
    ds_read_b64_tr_b16 v[238:239], v5 offset:42784
    s_waitcnt lgkmcnt(6)
    v_mfma_f32_16x16x32_bf16 v[56:59], v[224:227], v[96:99], v[56:59]
    v_mfma_f32_16x16x32_bf16 v[60:63], v[224:227], v[100:103], v[60:63]
    s_waitcnt vmcnt(10)
    s_barrier
    ds_read_b64_tr_b16 v[240:241], v4 offset:49152
    ds_read_b64_tr_b16 v[242:243], v4 offset:50176
    s_waitcnt lgkmcnt(6)
    v_mfma_f32_16x16x32_bf16 v[64:67], v[228:231], v[96:99], v[64:67]
    ds_read_b64_tr_b16 v[244:245], v5 offset:49184
    v_mfma_f32_16x16x32_bf16 v[68:71], v[228:231], v[100:103], v[68:71]
    s_add_u32 s22, s19, 0x480000
    s_add_u32 m0, s20, 0x4000
    s_nop 0
    buffer_load_dwordx4 v3, s[4:7], s22 offen lds
    ds_read_b64_tr_b16 v[246:247], v5 offset:50208
    s_mov_b32 s23, 0xc000
    buffer_load_dwordx4 v[132:135], v7, s[8:11], s23 offen offset:1024 sc1
    s_waitcnt lgkmcnt(6)
    v_mfma_f32_16x16x32_bf16 v[72:75], v[232:235], v[96:99], v[72:75]
    ds_read_b64_tr_b16 v[224:225], v4 offset:49408
    v_mfma_f32_16x16x32_bf16 v[76:79], v[232:235], v[100:103], v[76:79]
    ds_read_b64_tr_b16 v[226:227], v4 offset:50432
    s_waitcnt lgkmcnt(6)
    v_mfma_f32_16x16x32_bf16 v[80:83], v[236:239], v[96:99], v[80:83]
    ds_read_b64_tr_b16 v[228:229], v5 offset:49440
    v_mfma_f32_16x16x32_bf16 v[84:87], v[236:239], v[100:103], v[84:87]
    ds_read_b64_tr_b16 v[230:231], v5 offset:50464
    s_waitcnt vmcnt(11) lgkmcnt(6)
    v_mfma_f32_16x16x32_bf16 v[24:27], v[240:243], v[104:107], v[24:27]
    ds_read_b64_tr_b16 v[232:233], v4 offset:49664
    s_waitcnt vmcnt(10)
    v_mfma_f32_16x16x32_bf16 v[28:31], v[240:243], v[108:111], v[28:31]
    ds_read_b64_tr_b16 v[234:235], v4 offset:50688
    s_waitcnt lgkmcnt(6)
    v_mfma_f32_16x16x32_bf16 v[32:35], v[244:247], v[104:107], v[32:35]
    ds_read_b64_tr_b16 v[236:237], v5 offset:49696
    v_mfma_f32_16x16x32_bf16 v[36:39], v[244:247], v[108:111], v[36:39]
    s_add_u32 s22, s19, 0x488000
    s_add_u32 m0, s20, 0x4400
    s_nop 0
    buffer_load_dwordx4 v3, s[4:7], s22 offen lds
    ds_read_b64_tr_b16 v[238:239], v5 offset:50720
    s_mov_b32 s23, 0x4800
    buffer_load_dwordx4 v[88:91], v7, s[8:11], s23 offen offset:0 sc1
    s_waitcnt lgkmcnt(6)
    v_mfma_f32_16x16x32_bf16 v[40:43], v[224:227], v[104:107], v[40:43]
    ds_read_b64_tr_b16 v[240:241], v4 offset:49920
    v_mfma_f32_16x16x32_bf16 v[44:47], v[224:227], v[108:111], v[44:47]
    ds_read_b64_tr_b16 v[242:243], v4 offset:50944
    s_waitcnt lgkmcnt(6)
    v_mfma_f32_16x16x32_bf16 v[48:51], v[228:231], v[104:107], v[48:51]
    ds_read_b64_tr_b16 v[244:245], v5 offset:49952
    v_mfma_f32_16x16x32_bf16 v[52:55], v[228:231], v[108:111], v[52:55]
    ds_read_b64_tr_b16 v[246:247], v5 offset:50976
    s_waitcnt lgkmcnt(6)
    v_mfma_f32_16x16x32_bf16 v[56:59], v[232:235], v[104:107], v[56:59]
    ds_read_b64_tr_b16 v[224:225], v4 offset:57344
    v_mfma_f32_16x16x32_bf16 v[60:63], v[232:235], v[108:111], v[60:63]
    ds_read_b64_tr_b16 v[226:227], v4 offset:58368
    s_waitcnt lgkmcnt(6)
    v_mfma_f32_16x16x32_bf16 v[64:67], v[236:239], v[104:107], v[64:67]
    ds_read_b64_tr_b16 v[228:229], v5 offset:57376
    v_mfma_f32_16x16x32_bf16 v[68:71], v[236:239], v[108:111], v[68:71]
    ds_read_b64_tr_b16 v[230:231], v5 offset:58400
    s_mov_b32 s23, 0xc800
    buffer_load_dwordx4 v[92:95], v7, s[8:11], s23 offen offset:0 sc1
    s_waitcnt lgkmcnt(6)
    v_mfma_f32_16x16x32_bf16 v[72:75], v[240:243], v[104:107], v[72:75]
    ds_read_b64_tr_b16 v[232:233], v4 offset:57600
    v_mfma_f32_16x16x32_bf16 v[76:79], v[240:243], v[108:111], v[76:79]
    ds_read_b64_tr_b16 v[234:235], v4 offset:58624
    s_waitcnt lgkmcnt(6)
    v_mfma_f32_16x16x32_bf16 v[80:83], v[244:247], v[104:107], v[80:83]
    ds_read_b64_tr_b16 v[236:237], v5 offset:57632
    v_mfma_f32_16x16x32_bf16 v[84:87], v[244:247], v[108:111], v[84:87]
    ds_read_b64_tr_b16 v[238:239], v5 offset:58656
    s_waitcnt vmcnt(12) lgkmcnt(6)
    v_mfma_f32_16x16x32_bf16 v[24:27], v[224:227], v[112:115], v[24:27]
    ds_read_b64_tr_b16 v[240:241], v4 offset:57856
    s_waitcnt vmcnt(10)
    v_mfma_f32_16x16x32_bf16 v[28:31], v[224:227], v[116:119], v[28:31]
    ds_read_b64_tr_b16 v[242:243], v4 offset:58880
    s_waitcnt lgkmcnt(6)
    v_mfma_f32_16x16x32_bf16 v[32:35], v[228:231], v[112:115], v[32:35]
    ds_read_b64_tr_b16 v[244:245], v5 offset:57888
    v_mfma_f32_16x16x32_bf16 v[36:39], v[228:231], v[116:119], v[36:39]
    ds_read_b64_tr_b16 v[246:247], v5 offset:58912
    s_mov_b32 s23, 0x4800
    buffer_load_dwordx4 v[96:99], v7, s[8:11], s23 offen offset:1024 sc1
    s_waitcnt lgkmcnt(6)
    v_mfma_f32_16x16x32_bf16 v[40:43], v[232:235], v[112:115], v[40:43]
    ds_read_b64_tr_b16 v[224:225], v4 offset:58112
    v_mfma_f32_16x16x32_bf16 v[44:47], v[232:235], v[116:119], v[44:47]
    ds_read_b64_tr_b16 v[226:227], v4 offset:59136
    s_waitcnt lgkmcnt(6)
    v_mfma_f32_16x16x32_bf16 v[48:51], v[236:239], v[112:115], v[48:51]
    ds_read_b64_tr_b16 v[228:229], v5 offset:58144
    v_mfma_f32_16x16x32_bf16 v[52:55], v[236:239], v[116:119], v[52:55]
    ds_read_b64_tr_b16 v[230:231], v5 offset:59168
    s_waitcnt lgkmcnt(6)
    v_mfma_f32_16x16x32_bf16 v[56:59], v[240:243], v[112:115], v[56:59]
    v_mfma_f32_16x16x32_bf16 v[60:63], v[240:243], v[116:119], v[60:63]
    s_waitcnt vmcnt(10)
    s_barrier
    ds_read_b64_tr_b16 v[232:233], v4 offset:0
    ds_read_b64_tr_b16 v[234:235], v4 offset:1024
    s_waitcnt lgkmcnt(6)
    v_mfma_f32_16x16x32_bf16 v[64:67], v[244:247], v[112:115], v[64:67]
    ds_read_b64_tr_b16 v[236:237], v5 offset:32
    v_mfma_f32_16x16x32_bf16 v[68:71], v[244:247], v[116:119], v[68:71]
    s_add_u32 s22, s19, 0x500000
    s_add_u32 m0, s20, 0x8000
    s_nop 0
    buffer_load_dwordx4 v3, s[4:7], s22 offen lds
    ds_read_b64_tr_b16 v[238:239], v5 offset:1056
    s_mov_b32 s23, 0xc800
    buffer_load_dwordx4 v[100:103], v7, s[8:11], s23 offen offset:1024 sc1
    s_waitcnt lgkmcnt(6)
    v_mfma_f32_16x16x32_bf16 v[72:75], v[224:227], v[112:115], v[72:75]
    ds_read_b64_tr_b16 v[240:241], v4 offset:256
    v_mfma_f32_16x16x32_bf16 v[76:79], v[224:227], v[116:119], v[76:79]
    ds_read_b64_tr_b16 v[242:243], v4 offset:1280
    s_waitcnt lgkmcnt(6)
    v_mfma_f32_16x16x32_bf16 v[80:83], v[228:231], v[112:115], v[80:83]
    ds_read_b64_tr_b16 v[244:245], v5 offset:288
    v_mfma_f32_16x16x32_bf16 v[84:87], v[228:231], v[116:119], v[84:87]
    ds_read_b64_tr_b16 v[246:247], v5 offset:1312
    s_waitcnt vmcnt(11) lgkmcnt(6)
    v_mfma_f32_16x16x32_bf16 v[24:27], v[232:235], v[120:123], v[24:27]
    ds_read_b64_tr_b16 v[224:225], v4 offset:512
    s_waitcnt vmcnt(10)
    v_mfma_f32_16x16x32_bf16 v[28:31], v[232:235], v[124:127], v[28:31]
    ds_read_b64_tr_b16 v[226:227], v4 offset:1536
    s_waitcnt lgkmcnt(6)
    v_mfma_f32_16x16x32_bf16 v[32:35], v[236:239], v[120:123], v[32:35]
    ds_read_b64_tr_b16 v[228:229], v5 offset:544
    v_mfma_f32_16x16x32_bf16 v[36:39], v[236:239], v[124:127], v[36:39]
    s_add_u32 s22, s19, 0x508000
    s_add_u32 m0, s20, 0x8400
    s_nop 0
    buffer_load_dwordx4 v3, s[4:7], s22 offen lds
    ds_read_b64_tr_b16 v[230:231], v5 offset:1568
    s_mov_b32 s23, 0x5000
    buffer_load_dwordx4 v[104:107], v7, s[8:11], s23 offen offset:0 sc1
    s_waitcnt lgkmcnt(6)
    v_mfma_f32_16x16x32_bf16 v[40:43], v[240:243], v[120:123], v[40:43]
    ds_read_b64_tr_b16 v[232:233], v4 offset:768
    v_mfma_f32_16x16x32_bf16 v[44:47], v[240:243], v[124:127], v[44:47]
    ds_read_b64_tr_b16 v[234:235], v4 offset:1792
    s_waitcnt lgkmcnt(6)
    v_mfma_f32_16x16x32_bf16 v[48:51], v[244:247], v[120:123], v[48:51]
    ds_read_b64_tr_b16 v[236:237], v5 offset:800
    v_mfma_f32_16x16x32_bf16 v[52:55], v[244:247], v[124:127], v[52:55]
    ds_read_b64_tr_b16 v[238:239], v5 offset:1824
    s_waitcnt lgkmcnt(6)
    v_mfma_f32_16x16x32_bf16 v[56:59], v[224:227], v[120:123], v[56:59]
    ds_read_b64_tr_b16 v[240:241], v4 offset:8192
    v_mfma_f32_16x16x32_bf16 v[60:63], v[224:227], v[124:127], v[60:63]
    ds_read_b64_tr_b16 v[242:243], v4 offset:9216
    s_waitcnt lgkmcnt(6)
    v_mfma_f32_16x16x32_bf16 v[64:67], v[228:231], v[120:123], v[64:67]
    ds_read_b64_tr_b16 v[244:245], v5 offset:8224
    v_mfma_f32_16x16x32_bf16 v[68:71], v[228:231], v[124:127], v[68:71]
    ds_read_b64_tr_b16 v[246:247], v5 offset:9248
    s_mov_b32 s23, 0xd000
    buffer_load_dwordx4 v[108:111], v7, s[8:11], s23 offen offset:0 sc1
    s_waitcnt lgkmcnt(6)
    v_mfma_f32_16x16x32_bf16 v[72:75], v[232:235], v[120:123], v[72:75]
    ds_read_b64_tr_b16 v[224:225], v4 offset:8448
    v_mfma_f32_16x16x32_bf16 v[76:79], v[232:235], v[124:127], v[76:79]
    ds_read_b64_tr_b16 v[226:227], v4 offset:9472
    s_waitcnt lgkmcnt(6)
    v_mfma_f32_16x16x32_bf16 v[80:83], v[236:239], v[120:123], v[80:83]
    ds_read_b64_tr_b16 v[228:229], v5 offset:8480
    v_mfma_f32_16x16x32_bf16 v[84:87], v[236:239], v[124:127], v[84:87]
    ds_read_b64_tr_b16 v[230:231], v5 offset:9504
    s_waitcnt vmcnt(11) lgkmcnt(6)
    v_mfma_f32_16x16x32_bf16 v[24:27], v[240:243], v[128:131], v[24:27]
    ds_read_b64_tr_b16 v[232:233], v4 offset:8704
    s_waitcnt vmcnt(9)
    v_mfma_f32_16x16x32_bf16 v[28:31], v[240:243], v[132:135], v[28:31]
    ds_read_b64_tr_b16 v[234:235], v4 offset:9728
    s_waitcnt lgkmcnt(6)
    v_mfma_f32_16x16x32_bf16 v[32:35], v[244:247], v[128:131], v[32:35]
    ds_read_b64_tr_b16 v[236:237], v5 offset:8736
    v_mfma_f32_16x16x32_bf16 v[36:39], v[244:247], v[132:135], v[36:39]
    ds_read_b64_tr_b16 v[238:239], v5 offset:9760
    s_mov_b32 s23, 0x5000
    buffer_load_dwordx4 v[112:115], v7, s[8:11], s23 offen offset:1024 sc1
    s_waitcnt lgkmcnt(6)
    v_mfma_f32_16x16x32_bf16 v[40:43], v[224:227], v[128:131], v[40:43]
    ds_read_b64_tr_b16 v[240:241], v4 offset:8960
    v_mfma_f32_16x16x32_bf16 v[44:47], v[224:227], v[132:135], v[44:47]
    ds_read_b64_tr_b16 v[242:243], v4 offset:9984
    s_waitcnt lgkmcnt(6)
    v_mfma_f32_16x16x32_bf16 v[48:51], v[228:231], v[128:131], v[48:51]
    ds_read_b64_tr_b16 v[244:245], v5 offset:8992
    v_mfma_f32_16x16x32_bf16 v[52:55], v[228:231], v[132:135], v[52:55]
    ds_read_b64_tr_b16 v[246:247], v5 offset:10016
    s_waitcnt lgkmcnt(6)
    v_mfma_f32_16x16x32_bf16 v[56:59], v[232:235], v[128:131], v[56:59]
    v_mfma_f32_16x16x32_bf16 v[60:63], v[232:235], v[132:135], v[60:63]
    s_waitcnt vmcnt(9)
    s_barrier
    ds_read_b64_tr_b16 v[224:225], v4 offset:16384
    ds_read_b64_tr_b16 v[226:227], v4 offset:17408
    s_waitcnt lgkmcnt(6)
    v_mfma_f32_16x16x32_bf16 v[64:67], v[236:239], v[128:131], v[64:67]
    ds_read_b64_tr_b16 v[228:229], v5 offset:16416
    v_mfma_f32_16x16x32_bf16 v[68:71], v[236:239], v[132:135], v[68:71]
    s_add_u32 s22, s19, 0x580000
    s_add_u32 m0, s20, 0xc000
    s_nop 0
    buffer_load_dwordx4 v3, s[4:7], s22 offen lds
    ds_read_b64_tr_b16 v[230:231], v5 offset:17440
    s_mov_b32 s23, 0xd000
    buffer_load_dwordx4 v[116:119], v7, s[8:11], s23 offen offset:1024 sc1
    s_waitcnt lgkmcnt(6)
    v_mfma_f32_16x16x32_bf16 v[72:75], v[240:243], v[128:131], v[72:75]
    ds_read_b64_tr_b16 v[232:233], v4 offset:16640
    v_mfma_f32_16x16x32_bf16 v[76:79], v[240:243], v[132:135], v[76:79]
    ds_read_b64_tr_b16 v[234:235], v4 offset:17664
    s_waitcnt lgkmcnt(6)
    v_mfma_f32_16x16x32_bf16 v[80:83], v[244:247], v[128:131], v[80:83]
    ds_read_b64_tr_b16 v[236:237], v5 offset:16672
    v_mfma_f32_16x16x32_bf16 v[84:87], v[244:247], v[132:135], v[84:87]
    ds_read_b64_tr_b16 v[238:239], v5 offset:17696
    s_waitcnt vmcnt(10) lgkmcnt(6)
    v_mfma_f32_16x16x32_bf16 v[24:27], v[224:227], v[88:91], v[24:27]
    ds_read_b64_tr_b16 v[240:241], v4 offset:16896
    s_waitcnt vmcnt(9)
    v_mfma_f32_16x16x32_bf16 v[28:31], v[224:227], v[92:95], v[28:31]
    ds_read_b64_tr_b16 v[242:243], v4 offset:17920
    s_waitcnt lgkmcnt(6)
    v_mfma_f32_16x16x32_bf16 v[32:35], v[228:231], v[88:91], v[32:35]
    ds_read_b64_tr_b16 v[244:245], v5 offset:16928
    v_mfma_f32_16x16x32_bf16 v[36:39], v[228:231], v[92:95], v[36:39]
    s_add_u32 s22, s19, 0x588000
    s_add_u32 m0, s20, 0xc400
    s_nop 0
    buffer_load_dwordx4 v3, s[4:7], s22 offen lds
    ds_read_b64_tr_b16 v[246:247], v5 offset:17952
    s_mov_b32 s23, 0x5800
    buffer_load_dwordx4 v[120:123], v7, s[8:11], s23 offen offset:0 sc1
    s_waitcnt lgkmcnt(6)
    v_mfma_f32_16x16x32_bf16 v[40:43], v[232:235], v[88:91], v[40:43]
    ds_read_b64_tr_b16 v[224:225], v4 offset:17152
    v_mfma_f32_16x16x32_bf16 v[44:47], v[232:235], v[92:95], v[44:47]
    ds_read_b64_tr_b16 v[226:227], v4 offset:18176
    s_waitcnt lgkmcnt(6)
    v_mfma_f32_16x16x32_bf16 v[48:51], v[236:239], v[88:91], v[48:51]
    ds_read_b64_tr_b16 v[228:229], v5 offset:17184
    v_mfma_f32_16x16x32_bf16 v[52:55], v[236:239], v[92:95], v[52:55]
    ds_read_b64_tr_b16 v[230:231], v5 offset:18208
    s_waitcnt lgkmcnt(6)
    v_mfma_f32_16x16x32_bf16 v[56:59], v[240:243], v[88:91], v[56:59]
    ds_read_b64_tr_b16 v[232:233], v4 offset:24576
    v_mfma_f32_16x16x32_bf16 v[60:63], v[240:243], v[92:95], v[60:63]
    ds_read_b64_tr_b16 v[234:235], v4 offset:25600
    s_waitcnt lgkmcnt(6)
    v_mfma_f32_16x16x32_bf16 v[64:67], v[244:247], v[88:91], v[64:67]
    ds_read_b64_tr_b16 v[236:237], v5 offset:24608
    v_mfma_f32_16x16x32_bf16 v[68:71], v[244:247], v[92:95], v[68:71]
    ds_read_b64_tr_b16 v[238:239], v5 offset:25632
    s_mov_b32 s23, 0xd800
    buffer_load_dwordx4 v[124:127], v7, s[8:11], s23 offen offset:0 sc1
    s_waitcnt lgkmcnt(6)
    v_mfma_f32_16x16x32_bf16 v[72:75], v[224:227], v[88:91], v[72:75]
    ds_read_b64_tr_b16 v[240:241], v4 offset:24832
    v_xor_b32 v8, s28, v12
    v_xor_b32 v20, s28, v13
    v_or_b32 v8, v8, v20
    v_xor_b32 v20, s28, v14
    v_or_b32 v8, v8, v20
    v_xor_b32 v20, s28, v15
    v_or_b32 v8, v8, v20
    v_cmp_ne_u32 vcc, 0, v8
    s_cbranch_vccnz adaLN_cond__sliding_block_cached__moe_arch_mod__prompt_kernel_kv4r
adaLN_cond__sliding_block_cached__moe_arch_mod__prompt_kernel_kv4b:
    v_mfma_f32_16x16x32_bf16 v[76:79], v[224:227], v[92:95], v[76:79]
    ds_read_b64_tr_b16 v[242:243], v4 offset:25856
    v_mov_b32 v20, 0
    s_mov_b32 s16, 0x564000
    buffer_load_dword v8, v20, s[8:11], s16 offen sc1
    s_waitcnt lgkmcnt(6)
    v_mfma_f32_16x16x32_bf16 v[80:83], v[228:231], v[88:91], v[80:83]
    ds_read_b64_tr_b16 v[244:245], v5 offset:24864
    v_mfma_f32_16x16x32_bf16 v[84:87], v[228:231], v[92:95], v[84:87]
    ds_read_b64_tr_b16 v[246:247], v5 offset:25888
    s_waitcnt vmcnt(12) lgkmcnt(6)
    v_mfma_f32_16x16x32_bf16 v[24:27], v[232:235], v[96:99], v[24:27]
    ds_read_b64_tr_b16 v[224:225], v4 offset:25088
    s_waitcnt vmcnt(10)
    v_mfma_f32_16x16x32_bf16 v[28:31], v[232:235], v[100:103], v[28:31]
    ds_read_b64_tr_b16 v[226:227], v4 offset:26112
    s_waitcnt lgkmcnt(6)
    v_mfma_f32_16x16x32_bf16 v[32:35], v[236:239], v[96:99], v[32:35]
    ds_read_b64_tr_b16 v[228:229], v5 offset:25120
    v_mfma_f32_16x16x32_bf16 v[36:39], v[236:239], v[100:103], v[36:39]
    ds_read_b64_tr_b16 v[230:231], v5 offset:26144
    s_mov_b32 s23, 0x5800
    buffer_load_dwordx4 v[128:131], v7, s[8:11], s23 offen offset:1024 sc1
    s_waitcnt lgkmcnt(6)
    v_mfma_f32_16x16x32_bf16 v[40:43], v[240:243], v[96:99], v[40:43]
    ds_read_b64_tr_b16 v[232:233], v4 offset:25344
    s_mov_b64 s[76:77], s[54:55]
    s_mov_b32 s78, 0xc00000
    s_mov_b32 s79, 0x20000
    v_bfe_u32 v20, v1, 2, 2
    v_lshlrev_b32 v20, 12, v20
    v_add_u32 v6, v3, v20
    s_lshr_b32 s16, s2, 5
    s_lshl_b32 s16, s16, 7
    s_lshl_b32 s17, s3, 3
    s_add_u32 s16, s16, s17
    s_mul_i32 s14, s16, 12288
    s_and_b32 s16, s2, 31
    s_lshl_b32 s16, s16, 8
    s_add_u32 s14, s14, s16
    s_add_u32 s14, s14, 4096
    v_mfma_f32_16x16x32_bf16 v[44:47], v[240:243], v[100:103], v[44:47]
    ds_read_b64_tr_b16 v[234:235], v4 offset:26368
    s_waitcnt lgkmcnt(6)
    v_mfma_f32_16x16x32_bf16 v[48:51], v[244:247], v[96:99], v[48:51]
    ds_read_b64_tr_b16 v[236:237], v5 offset:25376
    v_mfma_f32_16x16x32_bf16 v[52:55], v[244:247], v[100:103], v[52:55]
    ds_read_b64_tr_b16 v[238:239], v5 offset:26400
    s_waitcnt lgkmcnt(6)
    v_mfma_f32_16x16x32_bf16 v[56:59], v[224:227], v[96:99], v[56:59]
    v_mfma_f32_16x16x32_bf16 v[60:63], v[224:227], v[100:103], v[60:63]
    s_waitcnt vmcnt(10)
    s_barrier
    ds_read_b64_tr_b16 v[240:241], v4 offset:32768
    ds_read_b64_tr_b16 v[242:243], v4 offset:33792
    s_waitcnt lgkmcnt(6)
    v_mfma_f32_16x16x32_bf16 v[64:67], v[228:231], v[96:99], v[64:67]
    ds_read_b64_tr_b16 v[244:245], v5 offset:32800
    v_mfma_f32_16x16x32_bf16 v[68:71], v[228:231], v[100:103], v[68:71]
    s_add_u32 s22, s19, 0x600000
    s_add_u32 m0, s20, 0x0
    s_nop 0
    buffer_load_dwordx4 v3, s[4:7], s22 offen lds
    ds_read_b64_tr_b16 v[246:247], v5 offset:33824
    s_mov_b32 s23, 0xd800
    buffer_load_dwordx4 v[132:135], v7, s[8:11], s23 offen offset:1024 sc1
    s_waitcnt lgkmcnt(6)
    v_mfma_f32_16x16x32_bf16 v[72:75], v[232:235], v[96:99], v[72:75]
    ds_read_b64_tr_b16 v[224:225], v4 offset:33024
    v_mfma_f32_16x16x32_bf16 v[76:79], v[232:235], v[100:103], v[76:79]
    ds_read_b64_tr_b16 v[226:227], v4 offset:34048
    s_waitcnt lgkmcnt(6)
    v_mfma_f32_16x16x32_bf16 v[80:83], v[236:239], v[96:99], v[80:83]
    ds_read_b64_tr_b16 v[228:229], v5 offset:33056
    v_mfma_f32_16x16x32_bf16 v[84:87], v[236:239], v[100:103], v[84:87]
    ds_read_b64_tr_b16 v[230:231], v5 offset:34080
    s_waitcnt vmcnt(11) lgkmcnt(6)
    v_mfma_f32_16x16x32_bf16 v[24:27], v[240:243], v[104:107], v[24:27]
    ds_read_b64_tr_b16 v[232:233], v4 offset:33280
    s_waitcnt vmcnt(10)
    v_mfma_f32_16x16x32_bf16 v[28:31], v[240:243], v[108:111], v[28:31]
    ds_read_b64_tr_b16 v[234:235], v4 offset:34304
    s_waitcnt lgkmcnt(6)
    v_mfma_f32_16x16x32_bf16 v[32:35], v[244:247], v[104:107], v[32:35]
    ds_read_b64_tr_b16 v[236:237], v5 offset:33312
    v_mfma_f32_16x16x32_bf16 v[36:39], v[244:247], v[108:111], v[36:39]
    s_add_u32 s22, s19, 0x608000
    s_add_u32 m0, s20, 0x400
    s_nop 0
    buffer_load_dwordx4 v3, s[4:7], s22 offen lds
    ds_read_b64_tr_b16 v[238:239], v5 offset:34336
    s_mov_b32 s23, 0x6000
    buffer_load_dwordx4 v[88:91], v7, s[8:11], s23 offen offset:0 sc1
    s_waitcnt lgkmcnt(6)
    v_mfma_f32_16x16x32_bf16 v[40:43], v[224:227], v[104:107], v[40:43]
    ds_read_b64_tr_b16 v[240:241], v4 offset:33536
    v_mfma_f32_16x16x32_bf16 v[44:47], v[224:227], v[108:111], v[44:47]
    ds_read_b64_tr_b16 v[242:243], v4 offset:34560
    s_waitcnt lgkmcnt(6)
    v_mfma_f32_16x16x32_bf16 v[48:51], v[228:231], v[104:107], v[48:51]
    ds_read_b64_tr_b16 v[244:245], v5 offset:33568
    v_mfma_f32_16x16x32_bf16 v[52:55], v[228:231], v[108:111], v[52:55]
    ds_read_b64_tr_b16 v[246:247], v5 offset:34592
    s_waitcnt lgkmcnt(6)
    v_mfma_f32_16x16x32_bf16 v[56:59], v[232:235], v[104:107], v[56:59]
    ds_read_b64_tr_b16 v[224:225], v4 offset:40960
    v_mfma_f32_16x16x32_bf16 v[60:63], v[232:235], v[108:111], v[60:63]
    ds_read_b64_tr_b16 v[226:227], v4 offset:41984
    s_waitcnt lgkmcnt(6)
    v_mfma_f32_16x16x32_bf16 v[64:67], v[236:239], v[104:107], v[64:67]
    ds_read_b64_tr_b16 v[228:229], v5 offset:40992
    v_mfma_f32_16x16x32_bf16 v[68:71], v[236:239], v[108:111], v[68:71]
    ds_read_b64_tr_b16 v[230:231], v5 offset:42016
    s_mov_b32 s23, 0xe000
    buffer_load_dwordx4 v[92:95], v7, s[8:11], s23 offen offset:0 sc1
    s_waitcnt lgkmcnt(6)
    v_mfma_f32_16x16x32_bf16 v[72:75], v[240:243], v[104:107], v[72:75]
    ds_read_b64_tr_b16 v[232:233], v4 offset:41216
    v_mfma_f32_16x16x32_bf16 v[76:79], v[240:243], v[108:111], v[76:79]
    ds_read_b64_tr_b16 v[234:235], v4 offset:42240
    s_waitcnt lgkmcnt(6)
    v_mfma_f32_16x16x32_bf16 v[80:83], v[244:247], v[104:107], v[80:83]
    ds_read_b64_tr_b16 v[236:237], v5 offset:41248
    v_mfma_f32_16x16x32_bf16 v[84:87], v[244:247], v[108:111], v[84:87]
    ds_read_b64_tr_b16 v[238:239], v5 offset:42272
    s_waitcnt vmcnt(12) lgkmcnt(6)
    v_mfma_f32_16x16x32_bf16 v[24:27], v[224:227], v[112:115], v[24:27]
    ds_read_b64_tr_b16 v[240:241], v4 offset:41472
    s_add_u32 s22, s14, 0x0
    s_add_u32 m0, s20, 0x10000
    s_nop 0
    buffer_load_dwordx4 v6, s[76:79], s22 offen lds
    s_waitcnt vmcnt(11)
    v_mfma_f32_16x16x32_bf16 v[28:31], v[224:227], v[116:119], v[28:31]
    ds_read_b64_tr_b16 v[242:243], v4 offset:42496
    s_waitcnt lgkmcnt(6)
    v_mfma_f32_16x16x32_bf16 v[32:35], v[228:231], v[112:115], v[32:35]
    ds_read_b64_tr_b16 v[244:245], v5 offset:41504
    v_mfma_f32_16x16x32_bf16 v[36:39], v[228:231], v[116:119], v[36:39]
    ds_read_b64_tr_b16 v[246:247], v5 offset:42528
    s_mov_b32 s23, 0x6000
    buffer_load_dwordx4 v[96:99], v7, s[8:11], s23 offen offset:1024 sc1
    s_waitcnt lgkmcnt(6)
    v_mfma_f32_16x16x32_bf16 v[40:43], v[232:235], v[112:115], v[40:43]
    ds_read_b64_tr_b16 v[224:225], v4 offset:41728
    s_add_u32 s22, s14, 0xc000
    s_add_u32 m0, s20, 0x10400
    s_nop 0
    buffer_load_dwordx4 v6, s[76:79], s22 offen lds
    v_mfma_f32_16x16x32_bf16 v[44:47], v[232:235], v[116:119], v[44:47]
    ds_read_b64_tr_b16 v[226:227], v4 offset:42752
    s_waitcnt lgkmcnt(6)
    v_mfma_f32_16x16x32_bf16 v[48:51], v[236:239], v[112:115], v[48:51]
    ds_read_b64_tr_b16 v[228:229], v5 offset:41760
    v_mfma_f32_16x16x32_bf16 v[52:55], v[236:239], v[116:119], v[52:55]
    ds_read_b64_tr_b16 v[230:231], v5 offset:42784
    s_waitcnt lgkmcnt(6)
    v_mfma_f32_16x16x32_bf16 v[56:59], v[240:243], v[112:115], v[56:59]
    v_mfma_f32_16x16x32_bf16 v[60:63], v[240:243], v[116:119], v[60:63]
    s_waitcnt vmcnt(12)
    s_barrier
    ds_read_b64_tr_b16 v[232:233], v4 offset:49152
    ds_read_b64_tr_b16 v[234:235], v4 offset:50176
    s_waitcnt lgkmcnt(6)
    v_mfma_f32_16x16x32_bf16 v[64:67], v[244:247], v[112:115], v[64:67]
    ds_read_b64_tr_b16 v[236:237], v5 offset:49184
    v_mfma_f32_16x16x32_bf16 v[68:71], v[244:247], v[116:119], v[68:71]
    s_add_u32 s22, s19, 0x680000
    s_add_u32 m0, s20, 0x4000
    s_nop 0
    buffer_load_dwordx4 v3, s[4:7], s22 offen lds
    ds_read_b64_tr_b16 v[238:239], v5 offset:50208
    s_mov_b32 s23, 0xe000
    buffer_load_dwordx4 v[100:103], v7, s[8:11], s23 offen offset:1024 sc1
    s_waitcnt lgkmcnt(6)
    v_mfma_f32_16x16x32_bf16 v[72:75], v[224:227], v[112:115], v[72:75]
    ds_read_b64_tr_b16 v[240:241], v4 offset:49408
    v_mfma_f32_16x16x32_bf16 v[76:79], v[224:227], v[116:119], v[76:79]
    ds_read_b64_tr_b16 v[242:243], v4 offset:50432
    s_waitcnt lgkmcnt(6)
    v_mfma_f32_16x16x32_bf16 v[80:83], v[228:231], v[112:115], v[80:83]
    ds_read_b64_tr_b16 v[244:245], v5 offset:49440
    v_mfma_f32_16x16x32_bf16 v[84:87], v[228:231], v[116:119], v[84:87]
    ds_read_b64_tr_b16 v[246:247], v5 offset:50464
    s_waitcnt vmcnt(13) lgkmcnt(6)
    v_mfma_f32_16x16x32_bf16 v[24:27], v[232:235], v[120:123], v[24:27]
    ds_read_b64_tr_b16 v[224:225], v4 offset:49664
    s_waitcnt vmcnt(12)
    v_mfma_f32_16x16x32_bf16 v[28:31], v[232:235], v[124:127], v[28:31]
    ds_read_b64_tr_b16 v[226:227], v4 offset:50688
    s_waitcnt lgkmcnt(6)
    v_mfma_f32_16x16x32_bf16 v[32:35], v[236:239], v[120:123], v[32:35]
    ds_read_b64_tr_b16 v[228:229], v5 offset:49696
    v_mfma_f32_16x16x32_bf16 v[36:39], v[236:239], v[124:127], v[36:39]
    s_add_u32 s22, s19, 0x688000
    s_add_u32 m0, s20, 0x4400
    s_nop 0
    buffer_load_dwordx4 v3, s[4:7], s22 offen lds
    ds_read_b64_tr_b16 v[230:231], v5 offset:50720
    s_mov_b32 s23, 0x6800
    buffer_load_dwordx4 v[104:107], v7, s[8:11], s23 offen offset:0 sc1
    s_waitcnt lgkmcnt(6)
    v_mfma_f32_16x16x32_bf16 v[40:43], v[240:243], v[120:123], v[40:43]
    ds_read_b64_tr_b16 v[232:233], v4 offset:49920
    v_mfma_f32_16x16x32_bf16 v[44:47], v[240:243], v[124:127], v[44:47]
    ds_read_b64_tr_b16 v[234:235], v4 offset:50944
    s_waitcnt lgkmcnt(6)
    v_mfma_f32_16x16x32_bf16 v[48:51], v[244:247], v[120:123], v[48:51]
    ds_read_b64_tr_b16 v[236:237], v5 offset:49952
    v_mfma_f32_16x16x32_bf16 v[52:55], v[244:247], v[124:127], v[52:55]
    ds_read_b64_tr_b16 v[238:239], v5 offset:50976
    s_waitcnt lgkmcnt(6)
    v_mfma_f32_16x16x32_bf16 v[56:59], v[224:227], v[120:123], v[56:59]
    ds_read_b64_tr_b16 v[240:241], v4 offset:57344
    v_mfma_f32_16x16x32_bf16 v[60:63], v[224:227], v[124:127], v[60:63]
    ds_read_b64_tr_b16 v[242:243], v4 offset:58368
    s_waitcnt lgkmcnt(6)
    v_mfma_f32_16x16x32_bf16 v[64:67], v[228:231], v[120:123], v[64:67]
    ds_read_b64_tr_b16 v[244:245], v5 offset:57376
    v_mfma_f32_16x16x32_bf16 v[68:71], v[228:231], v[124:127], v[68:71]
    ds_read_b64_tr_b16 v[246:247], v5 offset:58400
    s_mov_b32 s23, 0xe800
    buffer_load_dwordx4 v[108:111], v7, s[8:11], s23 offen offset:0 sc1
    s_waitcnt lgkmcnt(6)
    v_mfma_f32_16x16x32_bf16 v[72:75], v[232:235], v[120:123], v[72:75]
    ds_read_b64_tr_b16 v[224:225], v4 offset:57600
    v_mfma_f32_16x16x32_bf16 v[76:79], v[232:235], v[124:127], v[76:79]
    ds_read_b64_tr_b16 v[226:227], v4 offset:58624
    s_waitcnt lgkmcnt(6)
    v_mfma_f32_16x16x32_bf16 v[80:83], v[236:239], v[120:123], v[80:83]
    ds_read_b64_tr_b16 v[228:229], v5 offset:57632
    v_mfma_f32_16x16x32_bf16 v[84:87], v[236:239], v[124:127], v[84:87]
    ds_read_b64_tr_b16 v[230:231], v5 offset:58656
    s_waitcnt vmcnt(13) lgkmcnt(6)
    v_mfma_f32_16x16x32_bf16 v[24:27], v[240:243], v[128:131], v[24:27]
    ds_read_b64_tr_b16 v[232:233], v4 offset:57856
    s_add_u32 s22, s14, 0xc0000
    s_add_u32 m0, s20, 0x14000
    s_nop 0
    buffer_load_dwordx4 v6, s[76:79], s22 offen lds
    s_waitcnt vmcnt(12)
    v_mfma_f32_16x16x32_bf16 v[28:31], v[240:243], v[132:135], v[28:31]
    ds_read_b64_tr_b16 v[234:235], v4 offset:58880
    s_waitcnt lgkmcnt(6)
    v_mfma_f32_16x16x32_bf16 v[32:35], v[244:247], v[128:131], v[32:35]
    ds_read_b64_tr_b16 v[236:237], v5 offset:57888
    v_mfma_f32_16x16x32_bf16 v[36:39], v[244:247], v[132:135], v[36:39]
    ds_read_b64_tr_b16 v[238:239], v5 offset:58912
    s_mov_b32 s23, 0x6800
    buffer_load_dwordx4 v[112:115], v7, s[8:11], s23 offen offset:1024 sc1
    s_waitcnt lgkmcnt(6)
    v_mfma_f32_16x16x32_bf16 v[40:43], v[224:227], v[128:131], v[40:43]
    ds_read_b64_tr_b16 v[240:241], v4 offset:58112
    s_add_u32 s22, s14, 0xcc000
    s_add_u32 m0, s20, 0x14400
    s_nop 0
    buffer_load_dwordx4 v6, s[76:79], s22 offen lds
    v_mfma_f32_16x16x32_bf16 v[44:47], v[224:227], v[132:135], v[44:47]
    ds_read_b64_tr_b16 v[242:243], v4 offset:59136
    s_waitcnt lgkmcnt(6)
    v_mfma_f32_16x16x32_bf16 v[48:51], v[228:231], v[128:131], v[48:51]
    ds_read_b64_tr_b16 v[244:245], v5 offset:58144
    v_mfma_f32_16x16x32_bf16 v[52:55], v[228:231], v[132:135], v[52:55]
    ds_read_b64_tr_b16 v[246:247], v5 offset:59168
    s_waitcnt lgkmcnt(6)
    v_mfma_f32_16x16x32_bf16 v[56:59], v[232:235], v[128:131], v[56:59]
    v_mfma_f32_16x16x32_bf16 v[60:63], v[232:235], v[132:135], v[60:63]
    s_waitcnt vmcnt(13)
    s_barrier
    ds_read_b64_tr_b16 v[224:225], v4 offset:0
    ds_read_b64_tr_b16 v[226:227], v4 offset:1024
    s_waitcnt lgkmcnt(6)
    v_mfma_f32_16x16x32_bf16 v[64:67], v[236:239], v[128:131], v[64:67]
    ds_read_b64_tr_b16 v[228:229], v5 offset:32
    v_mfma_f32_16x16x32_bf16 v[68:71], v[236:239], v[132:135], v[68:71]
    s_add_u32 s22, s19, 0x700000
    s_add_u32 m0, s20, 0x8000
    s_nop 0
    buffer_load_dwordx4 v3, s[4:7], s22 offen lds
    ds_read_b64_tr_b16 v[230:231], v5 offset:1056
    s_mov_b32 s23, 0xe800
    buffer_load_dwordx4 v[116:119], v7, s[8:11], s23 offen offset:1024 sc1
    s_waitcnt lgkmcnt(6)
    v_mfma_f32_16x16x32_bf16 v[72:75], v[240:243], v[128:131], v[72:75]
    ds_read_b64_tr_b16 v[232:233], v4 offset:256
    v_mfma_f32_16x16x32_bf16 v[76:79], v[240:243], v[132:135], v[76:79]
    ds_read_b64_tr_b16 v[234:235], v4 offset:1280
    s_waitcnt lgkmcnt(6)
    v_mfma_f32_16x16x32_bf16 v[80:83], v[244:247], v[128:131], v[80:83]
    ds_read_b64_tr_b16 v[236:237], v5 offset:288
    v_mfma_f32_16x16x32_bf16 v[84:87], v[244:247], v[132:135], v[84:87]
    ds_read_b64_tr_b16 v[238:239], v5 offset:1312
    s_waitcnt vmcnt(14) lgkmcnt(6)
    v_mfma_f32_16x16x32_bf16 v[24:27], v[224:227], v[88:91], v[24:27]
    ds_read_b64_tr_b16 v[240:241], v4 offset:512
    s_waitcnt vmcnt(13)
    v_mfma_f32_16x16x32_bf16 v[28:31], v[224:227], v[92:95], v[28:31]
    ds_read_b64_tr_b16 v[242:243], v4 offset:1536
    s_waitcnt lgkmcnt(6)
    v_mfma_f32_16x16x32_bf16 v[32:35], v[228:231], v[88:91], v[32:35]
    ds_read_b64_tr_b16 v[244:245], v5 offset:544
    v_mfma_f32_16x16x32_bf16 v[36:39], v[228:231], v[92:95], v[36:39]
    s_add_u32 s22, s19, 0x708000
    s_add_u32 m0, s20, 0x8400
    s_nop 0
    buffer_load_dwordx4 v3, s[4:7], s22 offen lds
    ds_read_b64_tr_b16 v[246:247], v5 offset:1568
    s_mov_b32 s23, 0x7000
    buffer_load_dwordx4 v[120:123], v7, s[8:11], s23 offen offset:0 sc1
    s_waitcnt lgkmcnt(6)
    v_mfma_f32_16x16x32_bf16 v[40:43], v[232:235], v[88:91], v[40:43]
    ds_read_b64_tr_b16 v[224:225], v4 offset:768
    v_mfma_f32_16x16x32_bf16 v[44:47], v[232:235], v[92:95], v[44:47]
    ds_read_b64_tr_b16 v[226:227], v4 offset:1792
    s_waitcnt lgkmcnt(6)
    v_mfma_f32_16x16x32_bf16 v[48:51], v[236:239], v[88:91], v[48:51]
    ds_read_b64_tr_b16 v[228:229], v5 offset:800
    v_mfma_f32_16x16x32_bf16 v[52:55], v[236:239], v[92:95], v[52:55]
    ds_read_b64_tr_b16 v[230:231], v5 offset:1824
    s_waitcnt lgkmcnt(6)
    v_mfma_f32_16x16x32_bf16 v[56:59], v[240:243], v[88:91], v[56:59]
    ds_read_b64_tr_b16 v[232:233], v4 offset:8192
    v_mfma_f32_16x16x32_bf16 v[60:63], v[240:243], v[92:95], v[60:63]
    ds_read_b64_tr_b16 v[234:235], v4 offset:9216
    s_waitcnt lgkmcnt(6)
    v_mfma_f32_16x16x32_bf16 v[64:67], v[244:247], v[88:91], v[64:67]
    ds_read_b64_tr_b16 v[236:237], v5 offset:8224
    v_mfma_f32_16x16x32_bf16 v[68:71], v[244:247], v[92:95], v[68:71]
    ds_read_b64_tr_b16 v[238:239], v5 offset:9248
    s_mov_b32 s23, 0xf000
    buffer_load_dwordx4 v[124:127], v7, s[8:11], s23 offen offset:0 sc1
    s_waitcnt lgkmcnt(6)
    v_mfma_f32_16x16x32_bf16 v[72:75], v[224:227], v[88:91], v[72:75]
    ds_read_b64_tr_b16 v[240:241], v4 offset:8448
    v_mfma_f32_16x16x32_bf16 v[76:79], v[224:227], v[92:95], v[76:79]
    ds_read_b64_tr_b16 v[242:243], v4 offset:9472
    s_waitcnt lgkmcnt(6)
    v_mfma_f32_16x16x32_bf16 v[80:83], v[228:231], v[88:91], v[80:83]
    ds_read_b64_tr_b16 v[244:245], v5 offset:8480
    v_mfma_f32_16x16x32_bf16 v[84:87], v[228:231], v[92:95], v[84:87]
    ds_read_b64_tr_b16 v[246:247], v5 offset:9504
    s_waitcnt vmcnt(14) lgkmcnt(6)
    v_mfma_f32_16x16x32_bf16 v[24:27], v[232:235], v[96:99], v[24:27]
    ds_read_b64_tr_b16 v[224:225], v4 offset:8704
    s_add_u32 s22, s21, 0x0
    s_add_u32 m0, s20, 0x18000
    s_nop 0
    buffer_load_dwordx4 v2, s[8:11], s22 offen sc1 lds
    s_waitcnt vmcnt(12)
    v_mfma_f32_16x16x32_bf16 v[28:31], v[232:235], v[100:103], v[28:31]
    ds_read_b64_tr_b16 v[226:227], v4 offset:9728
    s_waitcnt lgkmcnt(6)
    v_mfma_f32_16x16x32_bf16 v[32:35], v[236:239], v[96:99], v[32:35]
    ds_read_b64_tr_b16 v[228:229], v5 offset:8736
    v_mfma_f32_16x16x32_bf16 v[36:39], v[236:239], v[100:103], v[36:39]
    ds_read_b64_tr_b16 v[230:231], v5 offset:9760
    s_mov_b32 s23, 0x7000
    buffer_load_dwordx4 v[128:131], v7, s[8:11], s23 offen offset:1024 sc1
    s_waitcnt lgkmcnt(6)
    v_mfma_f32_16x16x32_bf16 v[40:43], v[240:243], v[96:99], v[40:43]
    ds_read_b64_tr_b16 v[232:233], v4 offset:8960
    s_add_u32 s22, s21, 0x400
    s_add_u32 m0, s20, 0x18400
    s_nop 0
    buffer_load_dwordx4 v2, s[8:11], s22 offen sc1 lds
    v_mfma_f32_16x16x32_bf16 v[44:47], v[240:243], v[100:103], v[44:47]
    ds_read_b64_tr_b16 v[234:235], v4 offset:9984
    s_waitcnt lgkmcnt(6)
    v_mfma_f32_16x16x32_bf16 v[48:51], v[244:247], v[96:99], v[48:51]
    ds_read_b64_tr_b16 v[236:237], v5 offset:8992
    v_mfma_f32_16x16x32_bf16 v[52:55], v[244:247], v[100:103], v[52:55]
    ds_read_b64_tr_b16 v[238:239], v5 offset:10016
    s_waitcnt lgkmcnt(6)
    v_mfma_f32_16x16x32_bf16 v[56:59], v[224:227], v[96:99], v[56:59]
    v_mfma_f32_16x16x32_bf16 v[60:63], v[224:227], v[100:103], v[60:63]
    s_waitcnt vmcnt(13)
    s_barrier
    ds_read_b64_tr_b16 v[240:241], v4 offset:16384
    ds_read_b64_tr_b16 v[242:243], v4 offset:17408
    s_waitcnt lgkmcnt(6)
    v_mfma_f32_16x16x32_bf16 v[64:67], v[228:231], v[96:99], v[64:67]
    ds_read_b64_tr_b16 v[244:245], v5 offset:16416
    v_mfma_f32_16x16x32_bf16 v[68:71], v[228:231], v[100:103], v[68:71]
    s_add_u32 s22, s19, 0x780000
    s_add_u32 m0, s20, 0xc000
    s_nop 0
    buffer_load_dwordx4 v3, s[4:7], s22 offen lds
    ds_read_b64_tr_b16 v[246:247], v5 offset:17440
    s_mov_b32 s23, 0xf000
    buffer_load_dwordx4 v[132:135], v7, s[8:11], s23 offen offset:1024 sc1
    s_waitcnt lgkmcnt(6)
    v_mfma_f32_16x16x32_bf16 v[72:75], v[232:235], v[96:99], v[72:75]
    ds_read_b64_tr_b16 v[224:225], v4 offset:16640
    v_mfma_f32_16x16x32_bf16 v[76:79], v[232:235], v[100:103], v[76:79]
    ds_read_b64_tr_b16 v[226:227], v4 offset:17664
    s_waitcnt lgkmcnt(6)
    v_mfma_f32_16x16x32_bf16 v[80:83], v[236:239], v[96:99], v[80:83]
    ds_read_b64_tr_b16 v[228:229], v5 offset:16672
    v_mfma_f32_16x16x32_bf16 v[84:87], v[236:239], v[100:103], v[84:87]
    ds_read_b64_tr_b16 v[230:231], v5 offset:17696
    s_waitcnt vmcnt(14) lgkmcnt(6)
    v_mfma_f32_16x16x32_bf16 v[24:27], v[240:243], v[104:107], v[24:27]
    ds_read_b64_tr_b16 v[232:233], v4 offset:16896
    s_waitcnt vmcnt(13)
    v_mfma_f32_16x16x32_bf16 v[28:31], v[240:243], v[108:111], v[28:31]
    ds_read_b64_tr_b16 v[234:235], v4 offset:17920
    s_waitcnt lgkmcnt(6)
    v_mfma_f32_16x16x32_bf16 v[32:35], v[244:247], v[104:107], v[32:35]
    ds_read_b64_tr_b16 v[236:237], v5 offset:16928
    v_mfma_f32_16x16x32_bf16 v[36:39], v[244:247], v[108:111], v[36:39]
    s_add_u32 s22, s19, 0x788000
    s_add_u32 m0, s20, 0xc400
    s_nop 0
    buffer_load_dwordx4 v3, s[4:7], s22 offen lds
    ds_read_b64_tr_b16 v[238:239], v5 offset:17952
    s_mov_b32 s23, 0x7800
    buffer_load_dwordx4 v[88:91], v7, s[8:11], s23 offen offset:0 sc1
    s_waitcnt lgkmcnt(6)
    v_mfma_f32_16x16x32_bf16 v[40:43], v[224:227], v[104:107], v[40:43]
    ds_read_b64_tr_b16 v[240:241], v4 offset:17152
    v_lshrrev_b32 v20, 4, v1
    v_lshlrev_b32 v21, 4, v20
    s_lshl_b32 s16, s2, 8
    s_add_u32 s16, s16, 0x550000
    buffer_load_dwordx4 v[136:139], v21, s[8:11], s16 offen offset:0 sc1
    buffer_load_dwordx4 v[140:143], v21, s[8:11], s16 offen offset:64 sc1
    buffer_load_dwordx4 v[144:147], v21, s[8:11], s16 offen offset:128 sc1
    buffer_load_dwordx4 v[148:151], v21, s[8:11], s16 offen offset:192 sc1
    v_lshlrev_b32 v11, 11, v20
    v_xor_b32 v20, s3, v20
    v_and_b32 v20, 1, v20
    v_lshl_add_u32 v11, v20, 5, v11
    v_bfe_u32 v20, v1, 2, 2
    v_lshl_add_u32 v11, v20, 6, v11
    v_and_b32 v20, 3, v1
    v_lshl_add_u32 v11, v20, 3, v11
    s_lshr_b32 s16, s3, 1
    s_lshl_b32 s16, s16, 8
    s_add_u32 s16, s16, 65536
    v_add_u32 v11, s16, v11
    v_mfma_f32_16x16x32_bf16 v[44:47], v[224:227], v[108:111], v[44:47]
    ds_read_b64_tr_b16 v[242:243], v4 offset:18176
    s_waitcnt lgkmcnt(6)
    v_mfma_f32_16x16x32_bf16 v[48:51], v[228:231], v[104:107], v[48:51]
    ds_read_b64_tr_b16 v[244:245], v5 offset:17184
    v_mfma_f32_16x16x32_bf16 v[52:55], v[228:231], v[108:111], v[52:55]
    ds_read_b64_tr_b16 v[246:247], v5 offset:18208
    s_waitcnt lgkmcnt(6)
    v_mfma_f32_16x16x32_bf16 v[56:59], v[232:235], v[104:107], v[56:59]
    ds_read_b64_tr_b16 v[224:225], v4 offset:24576
    v_mfma_f32_16x16x32_bf16 v[60:63], v[232:235], v[108:111], v[60:63]
    ds_read_b64_tr_b16 v[226:227], v4 offset:25600
    s_waitcnt lgkmcnt(6)
    v_mfma_f32_16x16x32_bf16 v[64:67], v[236:239], v[104:107], v[64:67]
    ds_read_b64_tr_b16 v[228:229], v5 offset:24608
    v_mfma_f32_16x16x32_bf16 v[68:71], v[236:239], v[108:111], v[68:71]
    ds_read_b64_tr_b16 v[230:231], v5 offset:25632
    s_mov_b32 s23, 0xf800
    buffer_load_dwordx4 v[92:95], v7, s[8:11], s23 offen offset:0 sc1
    s_waitcnt lgkmcnt(6)
    v_mfma_f32_16x16x32_bf16 v[72:75], v[240:243], v[104:107], v[72:75]
    ds_read_b64_tr_b16 v[232:233], v4 offset:24832
    v_mfma_f32_16x16x32_bf16 v[76:79], v[240:243], v[108:111], v[76:79]
    ds_read_b64_tr_b16 v[234:235], v4 offset:25856
    s_waitcnt lgkmcnt(6)
    v_mfma_f32_16x16x32_bf16 v[80:83], v[244:247], v[104:107], v[80:83]
    ds_read_b64_tr_b16 v[236:237], v5 offset:24864
    v_mfma_f32_16x16x32_bf16 v[84:87], v[244:247], v[108:111], v[84:87]
    ds_read_b64_tr_b16 v[238:239], v5 offset:25888
    s_waitcnt vmcnt(18) lgkmcnt(6)
    v_mfma_f32_16x16x32_bf16 v[24:27], v[224:227], v[112:115], v[24:27]
    ds_read_b64_tr_b16 v[240:241], v4 offset:25088
    s_add_u32 s22, s21, 0x4000
    s_add_u32 m0, s20, 0x1c000
    s_nop 0
    buffer_load_dwordx4 v2, s[8:11], s22 offen sc1 lds
    s_waitcnt vmcnt(16)
    v_mfma_f32_16x16x32_bf16 v[28:31], v[224:227], v[116:119], v[28:31]
    ds_read_b64_tr_b16 v[242:243], v4 offset:26112
    s_waitcnt lgkmcnt(6)
    v_mfma_f32_16x16x32_bf16 v[32:35], v[228:231], v[112:115], v[32:35]
    ds_read_b64_tr_b16 v[244:245], v5 offset:25120
    v_mfma_f32_16x16x32_bf16 v[36:39], v[228:231], v[116:119], v[36:39]
    ds_read_b64_tr_b16 v[246:247], v5 offset:26144
    s_mov_b32 s23, 0x7800
    buffer_load_dwordx4 v[96:99], v7, s[8:11], s23 offen offset:1024 sc1
    s_waitcnt lgkmcnt(6)
    v_mfma_f32_16x16x32_bf16 v[40:43], v[232:235], v[112:115], v[40:43]
    ds_read_b64_tr_b16 v[224:225], v4 offset:25344
    s_add_u32 s22, s21, 0x4400
    s_add_u32 m0, s20, 0x1c400
    s_nop 0
    buffer_load_dwordx4 v2, s[8:11], s22 offen sc1 lds
    v_mfma_f32_16x16x32_bf16 v[44:47], v[232:235], v[116:119], v[44:47]
    ds_read_b64_tr_b16 v[226:227], v4 offset:26368
    s_waitcnt lgkmcnt(6)
    v_mfma_f32_16x16x32_bf16 v[48:51], v[236:239], v[112:115], v[48:51]
    ds_read_b64_tr_b16 v[228:229], v5 offset:25376
    v_mfma_f32_16x16x32_bf16 v[52:55], v[236:239], v[116:119], v[52:55]
    ds_read_b64_tr_b16 v[230:231], v5 offset:26400
    s_waitcnt lgkmcnt(6)
    v_mfma_f32_16x16x32_bf16 v[56:59], v[240:243], v[112:115], v[56:59]
    v_mfma_f32_16x16x32_bf16 v[60:63], v[240:243], v[116:119], v[60:63]
    s_waitcnt vmcnt(17)
    s_barrier
    ds_read_b64_tr_b16 v[232:233], v4 offset:32768
    ds_read_b64_tr_b16 v[234:235], v4 offset:33792
    s_waitcnt lgkmcnt(6)
    v_mfma_f32_16x16x32_bf16 v[64:67], v[244:247], v[112:115], v[64:67]
    ds_read_b64_tr_b16 v[236:237], v5 offset:32800
    v_mfma_f32_16x16x32_bf16 v[68:71], v[244:247], v[116:119], v[68:71]
    ds_read_b64_tr_b16 v[238:239], v5 offset:33824
    s_mov_b32 s23, 0xf800
    buffer_load_dwordx4 v[100:103], v7, s[8:11], s23 offen offset:1024 sc1
    s_waitcnt lgkmcnt(6)
    v_mfma_f32_16x16x32_bf16 v[72:75], v[224:227], v[112:115], v[72:75]
    ds_read_b64_tr_b16 v[240:241], v4 offset:33024
    v_mfma_f32_16x16x32_bf16 v[76:79], v[224:227], v[116:119], v[76:79]
    ds_read_b64_tr_b16 v[242:243], v4 offset:34048
    s_waitcnt lgkmcnt(6)
    v_mfma_f32_16x16x32_bf16 v[80:83], v[228:231], v[112:115], v[80:83]
    ds_read_b64_tr_b16 v[244:245], v5 offset:33056
    v_mfma_f32_16x16x32_bf16 v[84:87], v[228:231], v[116:119], v[84:87]
    ds_read_b64_tr_b16 v[246:247], v5 offset:34080
    s_waitcnt vmcnt(17) lgkmcnt(6)
    v_mfma_f32_16x16x32_bf16 v[24:27], v[232:235], v[120:123], v[24:27]
    ds_read_b64_tr_b16 v[224:225], v4 offset:33280
    s_waitcnt vmcnt(16)
    v_mfma_f32_16x16x32_bf16 v[28:31], v[232:235], v[124:127], v[28:31]
    ds_read_b64_tr_b16 v[226:227], v4 offset:34304
    s_waitcnt lgkmcnt(6)
    v_mfma_f32_16x16x32_bf16 v[32:35], v[236:239], v[120:123], v[32:35]
    ds_read_b64_tr_b16 v[228:229], v5 offset:33312
    v_mfma_f32_16x16x32_bf16 v[36:39], v[236:239], v[124:127], v[36:39]
    ds_read_b64_tr_b16 v[230:231], v5 offset:34336
    s_waitcnt lgkmcnt(6)
    v_mfma_f32_16x16x32_bf16 v[40:43], v[240:243], v[120:123], v[40:43]
    ds_read_b64_tr_b16 v[232:233], v4 offset:33536
    v_mfma_f32_16x16x32_bf16 v[44:47], v[240:243], v[124:127], v[44:47]
    ds_read_b64_tr_b16 v[234:235], v4 offset:34560
    s_waitcnt lgkmcnt(6)
    v_mfma_f32_16x16x32_bf16 v[48:51], v[244:247], v[120:123], v[48:51]
    ds_read_b64_tr_b16 v[236:237], v5 offset:33568
    v_mfma_f32_16x16x32_bf16 v[52:55], v[244:247], v[124:127], v[52:55]
    ds_read_b64_tr_b16 v[238:239], v5 offset:34592
    s_waitcnt lgkmcnt(6)
    v_mfma_f32_16x16x32_bf16 v[56:59], v[224:227], v[120:123], v[56:59]
    ds_read_b64_tr_b16 v[240:241], v4 offset:40960
    v_mfma_f32_16x16x32_bf16 v[60:63], v[224:227], v[124:127], v[60:63]
    ds_read_b64_tr_b16 v[242:243], v4 offset:41984
    s_waitcnt lgkmcnt(6)
    v_mfma_f32_16x16x32_bf16 v[64:67], v[228:231], v[120:123], v[64:67]
    ds_read_b64_tr_b16 v[244:245], v5 offset:40992
    v_mfma_f32_16x16x32_bf16 v[68:71], v[228:231], v[124:127], v[68:71]
    ds_read_b64_tr_b16 v[246:247], v5 offset:42016
    s_waitcnt lgkmcnt(6)
    v_mfma_f32_16x16x32_bf16 v[72:75], v[232:235], v[120:123], v[72:75]
    ds_read_b64_tr_b16 v[224:225], v4 offset:41216
    v_mfma_f32_16x16x32_bf16 v[76:79], v[232:235], v[124:127], v[76:79]
    ds_read_b64_tr_b16 v[226:227], v4 offset:42240
    s_waitcnt lgkmcnt(6)
    v_mfma_f32_16x16x32_bf16 v[80:83], v[236:239], v[120:123], v[80:83]
    ds_read_b64_tr_b16 v[228:229], v5 offset:41248
    v_mfma_f32_16x16x32_bf16 v[84:87], v[236:239], v[124:127], v[84:87]
    ds_read_b64_tr_b16 v[230:231], v5 offset:42272
    s_waitcnt vmcnt(14) lgkmcnt(6)
    v_mfma_f32_16x16x32_bf16 v[24:27], v[240:243], v[128:131], v[24:27]
    ds_read_b64_tr_b16 v[232:233], v4 offset:41472
    s_waitcnt vmcnt(11)
    v_mfma_f32_16x16x32_bf16 v[28:31], v[240:243], v[132:135], v[28:31]
    ds_read_b64_tr_b16 v[234:235], v4 offset:42496
    s_waitcnt lgkmcnt(6)
    v_mfma_f32_16x16x32_bf16 v[32:35], v[244:247], v[128:131], v[32:35]
    ds_read_b64_tr_b16 v[236:237], v5 offset:41504
    v_mfma_f32_16x16x32_bf16 v[36:39], v[244:247], v[132:135], v[36:39]
    ds_read_b64_tr_b16 v[238:239], v5 offset:42528
    s_waitcnt lgkmcnt(6)
    v_mfma_f32_16x16x32_bf16 v[40:43], v[224:227], v[128:131], v[40:43]
    ds_read_b64_tr_b16 v[240:241], v4 offset:41728
    v_mfma_f32_16x16x32_bf16 v[44:47], v[224:227], v[132:135], v[44:47]
    ds_read_b64_tr_b16 v[242:243], v4 offset:42752
    s_waitcnt lgkmcnt(6)
    v_mfma_f32_16x16x32_bf16 v[48:51], v[228:231], v[128:131], v[48:51]
    ds_read_b64_tr_b16 v[244:245], v5 offset:41760
    v_mfma_f32_16x16x32_bf16 v[52:55], v[228:231], v[132:135], v[52:55]
    ds_read_b64_tr_b16 v[246:247], v5 offset:42784
    s_waitcnt lgkmcnt(6)
    v_mfma_f32_16x16x32_bf16 v[56:59], v[232:235], v[128:131], v[56:59]
    v_mfma_f32_16x16x32_bf16 v[60:63], v[232:235], v[132:135], v[60:63]
    s_waitcnt vmcnt(10)
    s_barrier
    ds_read_b64_tr_b16 v[224:225], v4 offset:49152
    ds_read_b64_tr_b16 v[226:227], v4 offset:50176
    s_waitcnt lgkmcnt(6)
    v_mfma_f32_16x16x32_bf16 v[64:67], v[236:239], v[128:131], v[64:67]
    ds_read_b64_tr_b16 v[228:229], v5 offset:49184
    v_mfma_f32_16x16x32_bf16 v[68:71], v[236:239], v[132:135], v[68:71]
    ds_read_b64_tr_b16 v[230:231], v5 offset:50208
    s_waitcnt lgkmcnt(6)
    v_mfma_f32_16x16x32_bf16 v[72:75], v[240:243], v[128:131], v[72:75]
    ds_read_b64_tr_b16 v[232:233], v4 offset:49408
    v_mfma_f32_16x16x32_bf16 v[76:79], v[240:243], v[132:135], v[76:79]
    ds_read_b64_tr_b16 v[234:235], v4 offset:50432
    s_waitcnt lgkmcnt(6)
    v_mfma_f32_16x16x32_bf16 v[80:83], v[244:247], v[128:131], v[80:83]
    ds_read_b64_tr_b16 v[236:237], v5 offset:49440
    v_mfma_f32_16x16x32_bf16 v[84:87], v[244:247], v[132:135], v[84:87]
    ds_read_b64_tr_b16 v[238:239], v5 offset:50464
    s_waitcnt vmcnt(9) lgkmcnt(6)
    v_mfma_f32_16x16x32_bf16 v[24:27], v[224:227], v[88:91], v[24:27]
    ds_read_b64_tr_b16 v[240:241], v4 offset:49664
    s_waitcnt vmcnt(4)
    v_mfma_f32_16x16x32_bf16 v[28:31], v[224:227], v[92:95], v[28:31]
    ds_read_b64_tr_b16 v[242:243], v4 offset:50688
    s_waitcnt lgkmcnt(6)
    v_mfma_f32_16x16x32_bf16 v[32:35], v[228:231], v[88:91], v[32:35]
    ds_read_b64_tr_b16 v[244:245], v5 offset:49696
    v_mfma_f32_16x16x32_bf16 v[36:39], v[228:231], v[92:95], v[36:39]
    ds_read_b64_tr_b16 v[246:247], v5 offset:50720
    s_waitcnt lgkmcnt(6)
    v_mfma_f32_16x16x32_bf16 v[40:43], v[232:235], v[88:91], v[40:43]
    ds_read_b64_tr_b16 v[224:225], v4 offset:49920
    v_mfma_f32_16x16x32_bf16 v[44:47], v[232:235], v[92:95], v[44:47]
    ds_read_b64_tr_b16 v[226:227], v4 offset:50944
    s_waitcnt lgkmcnt(6)
    v_mfma_f32_16x16x32_bf16 v[48:51], v[236:239], v[88:91], v[48:51]
    ds_read_b64_tr_b16 v[228:229], v5 offset:49952
    v_mfma_f32_16x16x32_bf16 v[52:55], v[236:239], v[92:95], v[52:55]
    ds_read_b64_tr_b16 v[230:231], v5 offset:50976
    s_waitcnt lgkmcnt(6)
    v_mfma_f32_16x16x32_bf16 v[56:59], v[240:243], v[88:91], v[56:59]
    ds_read_b64_tr_b16 v[232:233], v4 offset:57344
    v_mfma_f32_16x16x32_bf16 v[60:63], v[240:243], v[92:95], v[60:63]
    ds_read_b64_tr_b16 v[234:235], v4 offset:58368
    s_waitcnt lgkmcnt(6)
    v_mfma_f32_16x16x32_bf16 v[64:67], v[244:247], v[88:91], v[64:67]
    ds_read_b64_tr_b16 v[236:237], v5 offset:57376
    v_mfma_f32_16x16x32_bf16 v[68:71], v[244:247], v[92:95], v[68:71]
    ds_read_b64_tr_b16 v[238:239], v5 offset:58400
    s_waitcnt lgkmcnt(6)
    v_mfma_f32_16x16x32_bf16 v[72:75], v[224:227], v[88:91], v[72:75]
    ds_read_b64_tr_b16 v[240:241], v4 offset:57600
    v_mfma_f32_16x16x32_bf16 v[76:79], v[224:227], v[92:95], v[76:79]
    ds_read_b64_tr_b16 v[242:243], v4 offset:58624
    s_waitcnt lgkmcnt(6)
    v_mfma_f32_16x16x32_bf16 v[80:83], v[228:231], v[88:91], v[80:83]
    ds_read_b64_tr_b16 v[244:245], v5 offset:57632
    v_mfma_f32_16x16x32_bf16 v[84:87], v[228:231], v[92:95], v[84:87]
    ds_read_b64_tr_b16 v[246:247], v5 offset:58656
    s_waitcnt vmcnt(2) lgkmcnt(6)
    v_mfma_f32_16x16x32_bf16 v[24:27], v[232:235], v[96:99], v[24:27]
    ds_read_b64_tr_b16 v[224:225], v4 offset:57856
    s_waitcnt vmcnt(0)
    v_mfma_f32_16x16x32_bf16 v[28:31], v[232:235], v[100:103], v[28:31]
    ds_read_b64_tr_b16 v[226:227], v4 offset:58880
    s_waitcnt lgkmcnt(6)
    v_mfma_f32_16x16x32_bf16 v[32:35], v[236:239], v[96:99], v[32:35]
    ds_read_b64_tr_b16 v[228:229], v5 offset:57888
    v_mfma_f32_16x16x32_bf16 v[36:39], v[236:239], v[100:103], v[36:39]
    ds_read_b64_tr_b16 v[230:231], v5 offset:58912
    s_waitcnt lgkmcnt(6)
    v_mfma_f32_16x16x32_bf16 v[40:43], v[240:243], v[96:99], v[40:43]
    ds_read_b64_tr_b16 v[232:233], v4 offset:58112
    v_mfma_f32_16x16x32_bf16 v[44:47], v[240:243], v[100:103], v[44:47]
    ds_read_b64_tr_b16 v[234:235], v4 offset:59136
    s_waitcnt lgkmcnt(6)
    v_mfma_f32_16x16x32_bf16 v[48:51], v[244:247], v[96:99], v[48:51]
    ds_read_b64_tr_b16 v[236:237], v5 offset:58144
    v_mfma_f32_16x16x32_bf16 v[52:55], v[244:247], v[100:103], v[52:55]
    ds_read_b64_tr_b16 v[238:239], v5 offset:59168
    s_waitcnt lgkmcnt(6)
    v_mfma_f32_16x16x32_bf16 v[56:59], v[224:227], v[96:99], v[56:59]
    v_mfma_f32_16x16x32_bf16 v[60:63], v[224:227], v[100:103], v[60:63]
    s_waitcnt lgkmcnt(4)
    v_mfma_f32_16x16x32_bf16 v[64:67], v[228:231], v[96:99], v[64:67]
    v_mfma_f32_16x16x32_bf16 v[68:71], v[228:231], v[100:103], v[68:71]
    s_waitcnt lgkmcnt(2)
    v_mfma_f32_16x16x32_bf16 v[72:75], v[232:235], v[96:99], v[72:75]
    v_mfma_f32_16x16x32_bf16 v[76:79], v[232:235], v[100:103], v[76:79]
    s_waitcnt lgkmcnt(0)
    v_mfma_f32_16x16x32_bf16 v[80:83], v[236:239], v[96:99], v[80:83]
    v_mfma_f32_16x16x32_bf16 v[84:87], v[236:239], v[100:103], v[84:87]
    s_barrier
    s_add_u32 s22, s21, 0x8000
    s_add_u32 m0, s20, 0x20000
    s_nop 0
    buffer_load_dwordx4 v2, s[8:11], s22 offen sc1 lds
    s_add_u32 s22, s21, 0x8400
    s_add_u32 m0, s20, 0x20400
    s_nop 0
    buffer_load_dwordx4 v2, s[8:11], s22 offen sc1 lds
    s_add_u32 s22, s21, 0xc000
    s_add_u32 m0, s20, 0x24000
    s_nop 0
    buffer_load_dwordx4 v2, s[8:11], s22 offen sc1 lds
    s_add_u32 s22, s21, 0xc400
    s_add_u32 m0, s20, 0x24400
    s_nop 0
    buffer_load_dwordx4 v2, s[8:11], s22 offen sc1 lds
    ds_read_b64_tr_b16 v[88:89], v11 offset:0
    ds_read_b64_tr_b16 v[90:91], v11 offset:1024
    ds_read_b64_tr_b16 v[92:93], v11 offset:8192
    ds_read_b64_tr_b16 v[94:95], v11 offset:9216
    ds_read_b64_tr_b16 v[96:97], v11 offset:16384
    ds_read_b64_tr_b16 v[98:99], v11 offset:17408
    ds_read_b64_tr_b16 v[100:101], v11 offset:24576
    ds_read_b64_tr_b16 v[102:103], v11 offset:25600
    s_mov_b32 s23, 0x3e0293ee
    v_mul_f32 v24, s23, v24
    v_mul_f32 v25, s23, v25
    v_mul_f32 v26, s23, v26
    v_mul_f32 v27, s23, v27
    v_mul_f32 v28, s23, v28
    v_mul_f32 v29, s23, v29
    v_mul_f32 v30, s23, v30
    v_mul_f32 v31, s23, v31
    v_mul_f32 v32, s23, v32
    v_mul_f32 v33, s23, v33
    v_mul_f32 v34, s23, v34
    v_mul_f32 v35, s23, v35
    v_mul_f32 v36, s23, v36
    v_mul_f32 v37, s23, v37
    v_mul_f32 v38, s23, v38
    v_mul_f32 v39, s23, v39
    v_cvt_pk_bf16_f32 v152, v24, v25
    v_cvt_pk_bf16_f32 v153, v26, v27
    v_cvt_pk_bf16_f32 v168, v28, v29
    v_cvt_pk_bf16_f32 v169, v30, v31
    v_cvt_pk_bf16_f32 v154, v32, v33
    v_cvt_pk_bf16_f32 v155, v34, v35
    v_cvt_pk_bf16_f32 v170, v36, v37
    v_cvt_pk_bf16_f32 v171, v38, v39
    s_waitcnt lgkmcnt(6)
    v_mfma_f32_16x16x32_bf16 v[104:107], v[88:91], v[136:139], 0
    s_waitcnt lgkmcnt(4)
    v_mfma_f32_16x16x32_bf16 v[104:107], v[92:95], v[140:143], v[104:107]
    s_waitcnt lgkmcnt(2)
    v_mfma_f32_16x16x32_bf16 v[104:107], v[96:99], v[144:147], v[104:107]
    s_waitcnt lgkmcnt(0)
    v_mfma_f32_16x16x32_bf16 v[104:107], v[100:103], v[148:151], v[104:107]
    v_add_u32 v4, 0x10000, v2
    v_add_u32 v5, 0x20000, v2
    s_barrier
    ds_read_b128 v[224:227], v4 offset:32768
    ds_read_b128 v[228:231], v4 offset:33792
    ds_read_b128 v[232:235], v4 offset:34816
    ds_read_b128 v[236:239], v4 offset:35840
    v_mov_b32 v12, 0x3f803f80
    v_mov_b32 v13, 0x3f803f80
    v_mov_b32 v14, 0x3f803f80
    v_mov_b32 v15, 0x3f803f80
    s_waitcnt lgkmcnt(3)
    v_mfma_f32_16x16x32_bf16 v[184:187], v[224:227], v[152:155], 0
    v_mul_f32 v40, s23, v40
    v_mul_f32 v41, s23, v41
    v_mul_f32 v42, s23, v42
    v_mul_f32 v43, s23, v43
    v_mul_f32 v44, s23, v44
    v_mul_f32 v45, s23, v45
    v_lshrrev_b32 v20, 4, v1
    v_lshlrev_b32 v20, 4, v20
    s_lshr_b32 s16, s2, 5
    s_lshl_b32 s16, s16, 14
    s_and_b32 s17, s2, 31
    s_lshl_b32 s17, s17, 9
    s_add_u32 s16, s16, s17
    s_lshl_b32 s17, s3, 6
    s_add_u32 s16, s16, s17
    s_add_u32 s16, s16, 0x580000
    s_mov_b32 exec_lo, 0x10001
    s_mov_b32 exec_hi, 0x10001
    buffer_store_dwordx4 v[104:107], v20, s[8:11], s16 offen sc1
    s_mov_b64 exec, -1
    v_mfma_f32_16x16x32_bf16 v[188:191], v[224:227], v[168:171], 0
    ds_read_b128 v[240:243], v4 offset:36864
    v_mul_f32 v46, s23, v46
    v_mul_f32 v47, s23, v47
    v_mul_f32 v48, s23, v48
    v_mul_f32 v49, s23, v49
    v_mul_f32 v50, s23, v50
    v_mul_f32 v51, s23, v51
    s_and_b32 s29, s2, 7
    s_mul_i32 s29, s29, 28
    s_lshr_b32 s16, s2, 3
    s_add_u32 s29, s29, s16
    s_waitcnt lgkmcnt(3)
    v_mfma_f32_16x16x32_bf16 v[192:195], v[228:231], v[152:155], 0
    s_add_u32 s22, s21, 0x10000
    s_add_u32 m0, s20, 0x10000
    s_nop 0
    buffer_load_dwordx4 v2, s[8:11], s22 offen sc1 lds
    v_mul_f32 v52, s23, v52
    v_mul_f32 v53, s23, v53
    v_mul_f32 v54, s23, v54
    v_mul_f32 v55, s23, v55
    v_cvt_pk_bf16_f32 v156, v40, v41
    v_cvt_pk_bf16_f32 v157, v42, v43
    v_mfma_f32_16x16x32_bf16 v[196:199], v[228:231], v[168:171], 0
    ds_read_b128 v[244:247], v4 offset:37888
    v_cvt_pk_bf16_f32 v172, v44, v45
    v_cvt_pk_bf16_f32 v173, v46, v47
    v_cvt_pk_bf16_f32 v158, v48, v49
    v_cvt_pk_bf16_f32 v159, v50, v51
    v_cvt_pk_bf16_f32 v174, v52, v53
    v_cvt_pk_bf16_f32 v175, v54, v55
    s_waitcnt lgkmcnt(3)
    v_mfma_f32_16x16x32_bf16 v[184:187], v[232:235], v[156:159], v[184:187]
    v_mul_f32 v56, s23, v56
    v_mul_f32 v57, s23, v57
    v_mul_f32 v58, s23, v58
    v_mul_f32 v59, s23, v59
    v_mul_f32 v60, s23, v60
    v_mul_f32 v61, s23, v61
    v_mfma_f32_16x16x32_bf16 v[188:191], v[232:235], v[172:175], v[188:191]
    ds_read_b128 v[224:227], v4 offset:38912
    v_mul_f32 v62, s23, v62
    v_mul_f32 v63, s23, v63
    v_mul_f32 v64, s23, v64
    v_mul_f32 v65, s23, v65
    v_mul_f32 v66, s23, v66
    v_mul_f32 v67, s23, v67
    s_waitcnt lgkmcnt(3)
    v_mfma_f32_16x16x32_bf16 v[192:195], v[236:239], v[156:159], v[192:195]
    v_mul_f32 v68, s23, v68
    v_mul_f32 v69, s23, v69
    v_mul_f32 v70, s23, v70
    v_mul_f32 v71, s23, v71
    v_cvt_pk_bf16_f32 v160, v56, v57
    v_cvt_pk_bf16_f32 v161, v58, v59
    v_mfma_f32_16x16x32_bf16 v[196:199], v[236:239], v[172:175], v[196:199]
    ds_read_b128 v[228:231], v4 offset:39936
    v_cvt_pk_bf16_f32 v176, v60, v61
    v_cvt_pk_bf16_f32 v177, v62, v63
    v_cvt_pk_bf16_f32 v162, v64, v65
    v_cvt_pk_bf16_f32 v163, v66, v67
    v_cvt_pk_bf16_f32 v178, v68, v69
    v_cvt_pk_bf16_f32 v179, v70, v71
    s_waitcnt lgkmcnt(3)
    v_mfma_f32_16x16x32_bf16 v[184:187], v[240:243], v[160:163], v[184:187]
    v_mul_f32 v72, s23, v72
    v_mul_f32 v73, s23, v73
    v_mul_f32 v74, s23, v74
    v_mul_f32 v75, s23, v75
    v_mul_f32 v76, s23, v76
    v_mul_f32 v77, s23, v77
    v_mfma_f32_16x16x32_bf16 v[188:191], v[240:243], v[176:179], v[188:191]
    ds_read_b128 v[232:235], v4 offset:40960
    v_mul_f32 v78, s23, v78
    v_mul_f32 v79, s23, v79
    v_mul_f32 v80, s23, v80
    v_mul_f32 v81, s23, v81
    v_mul_f32 v82, s23, v82
    v_mul_f32 v83, s23, v83
    s_waitcnt lgkmcnt(3)
    v_mfma_f32_16x16x32_bf16 v[192:195], v[244:247], v[160:163], v[192:195]
    s_add_u32 s22, s21, 0x10400
    s_add_u32 m0, s20, 0x10400
    s_nop 0
    buffer_load_dwordx4 v2, s[8:11], s22 offen sc1 lds
    v_mul_f32 v84, s23, v84
    v_mul_f32 v85, s23, v85
    v_mul_f32 v86, s23, v86
    v_mul_f32 v87, s23, v87
    v_cvt_pk_bf16_f32 v164, v72, v73
    v_cvt_pk_bf16_f32 v165, v74, v75
    v_mfma_f32_16x16x32_bf16 v[196:199], v[244:247], v[176:179], v[196:199]
    ds_read_b128 v[236:239], v4 offset:41984
    v_cvt_pk_bf16_f32 v180, v76, v77
    v_cvt_pk_bf16_f32 v181, v78, v79
    v_cvt_pk_bf16_f32 v166, v80, v81
    v_cvt_pk_bf16_f32 v167, v82, v83
    v_cvt_pk_bf16_f32 v182, v84, v85
    v_cvt_pk_bf16_f32 v183, v86, v87
    s_waitcnt lgkmcnt(3)
    v_mfma_f32_16x16x32_bf16 v[184:187], v[224:227], v[164:167], v[184:187]
    v_mfma_f32_16x16x32_bf16 v[188:191], v[224:227], v[180:183], v[188:191]
    ds_read_b128 v[240:243], v4 offset:43008
    s_waitcnt lgkmcnt(3)
    v_mfma_f32_16x16x32_bf16 v[192:195], v[228:231], v[164:167], v[192:195]
    v_mfma_f32_16x16x32_bf16 v[196:199], v[228:231], v[180:183], v[196:199]
    ds_read_b128 v[244:247], v4 offset:44032
    s_waitcnt lgkmcnt(3)
    v_mfma_f32_16x16x32_bf16 v[200:203], v[232:235], v[152:155], 0
    v_mfma_f32_16x16x32_bf16 v[204:207], v[232:235], v[168:171], 0
    ds_read_b128 v[224:227], v4 offset:45056
    s_waitcnt lgkmcnt(3)
    v_mfma_f32_16x16x32_bf16 v[208:211], v[236:239], v[152:155], 0
    v_mfma_f32_16x16x32_bf16 v[212:215], v[236:239], v[168:171], 0
    ds_read_b128 v[228:231], v4 offset:46080
    s_waitcnt lgkmcnt(3)
    v_mfma_f32_16x16x32_bf16 v[200:203], v[240:243], v[156:159], v[200:203]
    v_mfma_f32_16x16x32_bf16 v[204:207], v[240:243], v[172:175], v[204:207]
    ds_read_b128 v[232:235], v4 offset:47104
    s_waitcnt lgkmcnt(3)
    v_mfma_f32_16x16x32_bf16 v[208:211], v[244:247], v[156:159], v[208:211]
    v_max3_f32 v16, v184, v185, v186
    v_mfma_f32_16x16x32_bf16 v[212:215], v[244:247], v[172:175], v[212:215]
    ds_read_b128 v[236:239], v4 offset:48128
    v_max3_f32 v16, v16, v187, v192
    s_waitcnt lgkmcnt(3)
    v_mfma_f32_16x16x32_bf16 v[200:203], v[224:227], v[160:163], v[200:203]
    v_max3_f32 v16, v16, v193, v194
    v_mfma_f32_16x16x32_bf16 v[204:207], v[224:227], v[176:179], v[204:207]
    s_barrier
    ds_read_b128 v[240:243], v4 offset:49152
    v_max_f32 v16, v16, v195
    s_waitcnt lgkmcnt(3)
    v_mfma_f32_16x16x32_bf16 v[208:211], v[228:231], v[160:163], v[208:211]
    v_max3_f32 v17, v188, v189, v190
    v_mfma_f32_16x16x32_bf16 v[212:215], v[228:231], v[176:179], v[212:215]
    s_add_u32 s22, s21, 0x14000
    s_add_u32 m0, s20, 0x14000
    s_nop 0
    buffer_load_dwordx4 v2, s[8:11], s22 offen sc1 lds
    ds_read_b128 v[244:247], v4 offset:50176
    v_max3_f32 v17, v17, v191, v196
    s_waitcnt lgkmcnt(3)
    v_mfma_f32_16x16x32_bf16 v[200:203], v[232:235], v[164:167], v[200:203]
    v_max3_f32 v17, v17, v197, v198
    v_mfma_f32_16x16x32_bf16 v[204:207], v[232:235], v[180:183], v[204:207]
    ds_read_b128 v[224:227], v4 offset:51200
    v_max_f32 v17, v17, v199
    s_waitcnt lgkmcnt(3)
    v_mfma_f32_16x16x32_bf16 v[208:211], v[236:239], v[164:167], v[208:211]
    v_mfma_f32_16x16x32_bf16 v[212:215], v[236:239], v[180:183], v[212:215]
    ds_read_b128 v[228:231], v4 offset:52224
    v_max3_f32 v16, v16, v200, v201
    v_max3_f32 v16, v16, v202, v203
    s_nop 3
    v_max3_f32 v16, v16, v208, v209
    v_max3_f32 v16, v16, v210, v211
    v_max3_f32 v17, v17, v204, v205
    v_max3_f32 v17, v17, v206, v207
    v_max3_f32 v17, v17, v212, v213
    v_max3_f32 v17, v17, v214, v215
    v_mov_b32 v18, v16
    v_mov_b32 v19, v17
    s_nop 0
    v_permlane16_swap_b32 v16, v18
    v_permlane16_swap_b32 v17, v19
    v_max_f32 v16, v16, v18
    v_max_f32 v17, v17, v19
    v_mov_b32 v18, v16
    v_mov_b32 v19, v17
    s_nop 0
    v_permlane32_swap_b32 v16, v18
    v_permlane32_swap_b32 v17, v19
    v_max_f32 v16, v16, v18
    v_max_f32 v17, v17, v19
    v_sub_f32 v216, 0, v16
    v_sub_f32 v217, 0, v16
    v_sub_f32 v218, 0, v16
    v_sub_f32 v219, 0, v16
    v_sub_f32 v220, 0, v17
    v_sub_f32 v221, 0, v17
    v_sub_f32 v222, 0, v17
    v_sub_f32 v223, 0, v17
    v_add_f32 v184, v184, v216
    v_add_f32 v185, v185, v216
    v_exp_f32 v184, v184
    v_exp_f32 v185, v185
    v_add_f32 v186, v186, v216
    v_add_f32 v187, v187, v216
    v_exp_f32 v186, v186
    v_exp_f32 v187, v187
    v_cvt_pk_bf16_f32 v24, v184, v185
    v_add_f32 v188, v188, v220
    v_add_f32 v189, v189, v220
    v_exp_f32 v188, v188
    v_exp_f32 v189, v189
    v_cvt_pk_bf16_f32 v25, v186, v187
    v_add_f32 v190, v190, v220
    v_add_f32 v191, v191, v220
    v_exp_f32 v190, v190
    v_exp_f32 v191, v191
    v_cvt_pk_bf16_f32 v28, v188, v189
    v_add_f32 v192, v192, v216
    v_add_f32 v193, v193, v216
    v_exp_f32 v192, v192
    v_exp_f32 v193, v193
    v_cvt_pk_bf16_f32 v29, v190, v191
    v_add_f32 v194, v194, v216
    v_add_f32 v195, v195, v216
    v_exp_f32 v194, v194
    v_exp_f32 v195, v195
    v_cvt_pk_bf16_f32 v26, v192, v193
    v_add_f32 v196, v196, v220
    v_add_f32 v197, v197, v220
    v_exp_f32 v196, v196
    v_exp_f32 v197, v197
    v_cvt_pk_bf16_f32 v27, v194, v195
    v_add_f32 v198, v198, v220
    v_add_f32 v199, v199, v220
    v_exp_f32 v198, v198
    v_exp_f32 v199, v199
    v_cvt_pk_bf16_f32 v30, v196, v197
    v_cvt_pk_bf16_f32 v31, v198, v199
    s_waitcnt lgkmcnt(3)
    v_mfma_f32_16x16x32_bf16 v[184:187], v[240:243], v[152:155], v[216:219]
    v_mfma_f32_16x16x32_bf16 v[188:191], v[240:243], v[168:171], v[220:223]
    ds_read_b128 v[232:235], v4 offset:53248
    v_add_f32 v200, v200, v216
    v_add_f32 v201, v201, v216
    v_exp_f32 v200, v200
    v_mfma_f32_16x16x32_bf16 v[248:251], v[12:15], v[24:27], 0
    s_waitcnt lgkmcnt(3)
    v_mfma_f32_16x16x32_bf16 v[192:195], v[244:247], v[152:155], v[216:219]
    v_exp_f32 v201, v201
    v_add_f32 v202, v202, v216
    v_add_f32 v203, v203, v216
    v_mfma_f32_16x16x32_bf16 v[196:199], v[244:247], v[168:171], v[220:223]
    s_add_u32 s22, s21, 0x14400
    s_add_u32 m0, s20, 0x14400
    s_nop 0
    buffer_load_dwordx4 v2, s[8:11], s22 offen sc1 lds
    ds_read_b128 v[236:239], v4 offset:54272
    v_exp_f32 v202, v202
    v_exp_f32 v203, v203
    v_mfma_f32_16x16x32_bf16 v[252:255], v[12:15], v[28:31], 0
    s_waitcnt lgkmcnt(3)
    v_mfma_f32_16x16x32_bf16 v[184:187], v[224:227], v[156:159], v[184:187]
    v_cvt_pk_bf16_f32 v32, v200, v201
    v_add_f32 v204, v204, v220
    v_add_f32 v205, v205, v220
    v_mfma_f32_16x16x32_bf16 v[188:191], v[224:227], v[172:175], v[188:191]
    ds_read_b128 v[240:243], v4 offset:55296
    v_exp_f32 v204, v204
    v_exp_f32 v205, v205
    v_cvt_pk_bf16_f32 v33, v202, v203
    s_mov_b64 s[4:5], s[40:41]
    s_mov_b32 s6, 0x800000
    s_mov_b32 s7, 0x20000
    v_bfe_u32 v20, v1, 2, 2
    v_lshlrev_b32 v21, 13, v20
    v_sub_u32 v3, v3, v21
    v_lshl_add_u32 v3, v20, 11, v3
    s_and_b32 s16, s2, 1
    s_lshl_b32 s24, s16, 22
    s_lshr_b32 s16, s2, 5
    s_lshl_b32 s16, s16, 8
    s_add_u32 s24, s24, s16
    s_lshl_b32 s16, s3, 14
    s_add_u32 s24, s24, s16
    s_waitcnt lgkmcnt(3)
    v_mfma_f32_16x16x32_bf16 v[192:195], v[228:231], v[156:159], v[192:195]
    v_add_f32 v206, v206, v220
    v_add_f32 v207, v207, v220
    v_mfma_f32_16x16x32_bf16 v[196:199], v[228:231], v[172:175], v[196:199]
    ds_read_b128 v[244:247], v4 offset:56320
    v_exp_f32 v206, v206
    v_exp_f32 v207, v207
    v_cvt_pk_bf16_f32 v36, v204, v205
    s_waitcnt lgkmcnt(3)
    v_mfma_f32_16x16x32_bf16 v[184:187], v[232:235], v[160:163], v[184:187]
    v_add_f32 v208, v208, v216
    v_add_f32 v209, v209, v216
    v_exp_f32 v208, v208
    v_mfma_f32_16x16x32_bf16 v[188:191], v[232:235], v[176:179], v[188:191]
    ds_read_b128 v[224:227], v4 offset:57344
    v_exp_f32 v209, v209
    v_cvt_pk_bf16_f32 v37, v206, v207
    s_waitcnt lgkmcnt(3)
    v_mfma_f32_16x16x32_bf16 v[192:195], v[236:239], v[160:163], v[192:195]
    v_add_f32 v210, v210, v216
    v_add_f32 v211, v211, v216
    v_exp_f32 v210, v210
    v_mfma_f32_16x16x32_bf16 v[196:199], v[236:239], v[176:179], v[196:199]
    ds_read_b128 v[228:231], v4 offset:58368
    v_exp_f32 v211, v211
    v_cvt_pk_bf16_f32 v34, v208, v209
    v_add_f32 v212, v212, v220
    s_waitcnt lgkmcnt(3)
    v_mfma_f32_16x16x32_bf16 v[184:187], v[240:243], v[164:167], v[184:187]
    v_add_f32 v213, v213, v220
    v_exp_f32 v212, v212
    v_mfma_f32_16x16x32_bf16 v[188:191], v[240:243], v[180:183], v[188:191]
    ds_read_b128 v[232:235], v4 offset:59392
    v_exp_f32 v213, v213
    v_cvt_pk_bf16_f32 v35, v210, v211
    v_add_f32 v214, v214, v220
    s_waitcnt lgkmcnt(3)
    v_mfma_f32_16x16x32_bf16 v[192:195], v[244:247], v[164:167], v[192:195]
    v_add_f32 v215, v215, v220
    v_exp_f32 v214, v214
    v_exp_f32 v215, v215
    v_mfma_f32_16x16x32_bf16 v[196:199], v[244:247], v[180:183], v[196:199]
    ds_read_b128 v[236:239], v4 offset:60416
    v_cvt_pk_bf16_f32 v38, v212, v213
    v_cvt_pk_bf16_f32 v39, v214, v215
    s_waitcnt lgkmcnt(3)
    v_mfma_f32_16x16x32_bf16 v[200:203], v[224:227], v[152:155], v[216:219]
    v_mfma_f32_16x16x32_bf16 v[204:207], v[224:227], v[168:171], v[220:223]
    ds_read_b128 v[240:243], v4 offset:61440
    v_exp_f32 v184, v184
    v_exp_f32 v185, v185
    v_mfma_f32_16x16x32_bf16 v[248:251], v[12:15], v[32:35], v[248:251]
    s_waitcnt lgkmcnt(3)
    v_mfma_f32_16x16x32_bf16 v[208:211], v[228:231], v[152:155], v[216:219]
    v_exp_f32 v186, v186
    v_exp_f32 v187, v187
    v_mfma_f32_16x16x32_bf16 v[212:215], v[228:231], v[168:171], v[220:223]
    ds_read_b128 v[244:247], v4 offset:62464
    v_cvt_pk_bf16_f32 v40, v184, v185
    v_mfma_f32_16x16x32_bf16 v[252:255], v[12:15], v[36:39], v[252:255]
    s_waitcnt lgkmcnt(3)
    v_mfma_f32_16x16x32_bf16 v[200:203], v[232:235], v[156:159], v[200:203]
    v_exp_f32 v188, v188
    v_exp_f32 v189, v189
    v_mfma_f32_16x16x32_bf16 v[204:207], v[232:235], v[172:175], v[204:207]
    ds_read_b128 v[224:227], v4 offset:63488
    v_cvt_pk_bf16_f32 v41, v186, v187
    s_waitcnt lgkmcnt(3)
    v_mfma_f32_16x16x32_bf16 v[208:211], v[236:239], v[156:159], v[208:211]
    v_exp_f32 v190, v190
    v_exp_f32 v191, v191
    v_mfma_f32_16x16x32_bf16 v[212:215], v[236:239], v[172:175], v[212:215]
    ds_read_b128 v[228:231], v4 offset:64512
    v_cvt_pk_bf16_f32 v44, v188, v189
    v_exp_f32 v192, v192
    s_waitcnt lgkmcnt(3)
    v_mfma_f32_16x16x32_bf16 v[200:203], v[240:243], v[160:163], v[200:203]
    v_exp_f32 v193, v193
    v_mfma_f32_16x16x32_bf16 v[204:207], v[240:243], v[176:179], v[204:207]
    s_waitcnt vmcnt(7)
    s_barrier
    ds_read_b128 v[232:235], v5 offset:0
    v_cvt_pk_bf16_f32 v45, v190, v191
    v_exp_f32 v194, v194
    s_waitcnt lgkmcnt(3)
    v_mfma_f32_16x16x32_bf16 v[208:211], v[244:247], v[160:163], v[208:211]
    v_exp_f32 v195, v195
    v_mfma_f32_16x16x32_bf16 v[212:215], v[244:247], v[176:179], v[212:215]
    s_add_u32 s22, s21, 0x18000
    s_add_u32 m0, s20, 0x18000
    s_nop 0
    buffer_load_dwordx4 v2, s[8:11], s22 offen sc1 lds
    ds_read_b128 v[236:239], v5 offset:1024
    v_cvt_pk_bf16_f32 v42, v192, v193
    v_exp_f32 v196, v196
    s_waitcnt lgkmcnt(3)
    v_mfma_f32_16x16x32_bf16 v[200:203], v[224:227], v[164:167], v[200:203]
    v_exp_f32 v197, v197
    v_cvt_pk_bf16_f32 v43, v194, v195
    v_mfma_f32_16x16x32_bf16 v[204:207], v[224:227], v[180:183], v[204:207]
    ds_read_b128 v[240:243], v5 offset:2048
    v_exp_f32 v198, v198
    s_waitcnt lgkmcnt(3)
    v_mfma_f32_16x16x32_bf16 v[208:211], v[228:231], v[164:167], v[208:211]
    v_exp_f32 v199, v199
    v_cvt_pk_bf16_f32 v46, v196, v197
    v_mfma_f32_16x16x32_bf16 v[212:215], v[228:231], v[180:183], v[212:215]
    ds_read_b128 v[244:247], v5 offset:3072
    v_cvt_pk_bf16_f32 v47, v198, v199
    s_waitcnt lgkmcnt(3)
    v_mfma_f32_16x16x32_bf16 v[184:187], v[232:235], v[152:155], v[216:219]
    v_mfma_f32_16x16x32_bf16 v[188:191], v[232:235], v[168:171], v[220:223]
    ds_read_b128 v[224:227], v5 offset:4096
    v_exp_f32 v200, v200
    v_exp_f32 v201, v201
    v_mfma_f32_16x16x32_bf16 v[248:251], v[12:15], v[40:43], v[248:251]
    s_waitcnt lgkmcnt(3)
    v_mfma_f32_16x16x32_bf16 v[192:195], v[236:239], v[152:155], v[216:219]
    v_exp_f32 v202, v202
    v_exp_f32 v203, v203
    v_mfma_f32_16x16x32_bf16 v[196:199], v[236:239], v[168:171], v[220:223]
    s_add_u32 s22, s21, 0x18400
    s_add_u32 m0, s20, 0x18400
    s_nop 0
    buffer_load_dwordx4 v2, s[8:11], s22 offen sc1 lds
    ds_read_b128 v[228:231], v5 offset:5120
    v_cvt_pk_bf16_f32 v48, v200, v201
    v_mfma_f32_16x16x32_bf16 v[252:255], v[12:15], v[44:47], v[252:255]
    s_waitcnt lgkmcnt(3)
    v_mfma_f32_16x16x32_bf16 v[184:187], v[240:243], v[156:159], v[184:187]
    v_exp_f32 v204, v204
    v_exp_f32 v205, v205
    v_mfma_f32_16x16x32_bf16 v[188:191], v[240:243], v[172:175], v[188:191]
    ds_read_b128 v[232:235], v5 offset:6144
    v_cvt_pk_bf16_f32 v49, v202, v203
    s_waitcnt lgkmcnt(3)
    v_mfma_f32_16x16x32_bf16 v[192:195], v[244:247], v[156:159], v[192:195]
    v_exp_f32 v206, v206
    v_exp_f32 v207, v207
    v_mfma_f32_16x16x32_bf16 v[196:199], v[244:247], v[172:175], v[196:199]
    ds_read_b128 v[236:239], v5 offset:7168
    v_cvt_pk_bf16_f32 v52, v204, v205
    v_exp_f32 v208, v208
    s_waitcnt lgkmcnt(3)
    v_mfma_f32_16x16x32_bf16 v[184:187], v[224:227], v[160:163], v[184:187]
    v_exp_f32 v209, v209
    v_mfma_f32_16x16x32_bf16 v[188:191], v[224:227], v[176:179], v[188:191]
    ds_read_b128 v[240:243], v5 offset:8192
    v_cvt_pk_bf16_f32 v53, v206, v207
    v_exp_f32 v210, v210
    s_waitcnt lgkmcnt(3)
    v_mfma_f32_16x16x32_bf16 v[192:195], v[228:231], v[160:163], v[192:195]
    v_exp_f32 v211, v211
    v_mfma_f32_16x16x32_bf16 v[196:199], v[228:231], v[176:179], v[196:199]
    ds_read_b128 v[244:247], v5 offset:9216
    v_cvt_pk_bf16_f32 v50, v208, v209
    v_exp_f32 v212, v212
    s_waitcnt lgkmcnt(3)
    v_mfma_f32_16x16x32_bf16 v[184:187], v[232:235], v[164:167], v[184:187]
    v_exp_f32 v213, v213
    v_cvt_pk_bf16_f32 v51, v210, v211
    v_mfma_f32_16x16x32_bf16 v[188:191], v[232:235], v[180:183], v[188:191]
    ds_read_b128 v[224:227], v5 offset:10240
    v_exp_f32 v214, v214
    s_waitcnt lgkmcnt(3)
    v_mfma_f32_16x16x32_bf16 v[192:195], v[236:239], v[164:167], v[192:195]
    v_exp_f32 v215, v215
    v_cvt_pk_bf16_f32 v54, v212, v213
    v_mfma_f32_16x16x32_bf16 v[196:199], v[236:239], v[180:183], v[196:199]
    ds_read_b128 v[228:231], v5 offset:11264
    v_cvt_pk_bf16_f32 v55, v214, v215
    s_waitcnt lgkmcnt(3)
    v_mfma_f32_16x16x32_bf16 v[200:203], v[240:243], v[152:155], v[216:219]
    v_mfma_f32_16x16x32_bf16 v[204:207], v[240:243], v[168:171], v[220:223]
    ds_read_b128 v[232:235], v5 offset:12288
    v_exp_f32 v184, v184
    v_exp_f32 v185, v185
    v_mfma_f32_16x16x32_bf16 v[248:251], v[12:15], v[48:51], v[248:251]
    s_waitcnt lgkmcnt(3)
    v_mfma_f32_16x16x32_bf16 v[208:211], v[244:247], v[152:155], v[216:219]
    v_exp_f32 v186, v186
    v_exp_f32 v187, v187
    v_mfma_f32_16x16x32_bf16 v[212:215], v[244:247], v[168:171], v[220:223]
    ds_read_b128 v[236:239], v5 offset:13312
    v_cvt_pk_bf16_f32 v56, v184, v185
    v_mfma_f32_16x16x32_bf16 v[252:255], v[12:15], v[52:55], v[252:255]
    s_waitcnt lgkmcnt(3)
    v_mfma_f32_16x16x32_bf16 v[200:203], v[224:227], v[156:159], v[200:203]
    v_exp_f32 v188, v188
    v_exp_f32 v189, v189
    v_mfma_f32_16x16x32_bf16 v[204:207], v[224:227], v[172:175], v[204:207]
    ds_read_b128 v[240:243], v5 offset:14336
    v_cvt_pk_bf16_f32 v57, v186, v187
    s_waitcnt lgkmcnt(3)
    v_mfma_f32_16x16x32_bf16 v[208:211], v[228:231], v[156:159], v[208:211]
    v_exp_f32 v190, v190
    v_exp_f32 v191, v191
    s_waitcnt vmcnt(6)
    v_mfma_f32_16x16x32_bf16 v[212:215], v[228:231], v[172:175], v[212:215]
    ds_read_b128 v[244:247], v5 offset:15360
    v_cvt_pk_bf16_f32 v60, v188, v189
    v_exp_f32 v192, v192
    s_waitcnt lgkmcnt(3)
    v_mfma_f32_16x16x32_bf16 v[200:203], v[232:235], v[160:163], v[200:203]
    v_exp_f32 v193, v193
    v_mfma_f32_16x16x32_bf16 v[204:207], v[232:235], v[176:179], v[204:207]
    s_barrier
    ds_read_b128 v[224:227], v5 offset:16384
    v_cvt_pk_bf16_f32 v61, v190, v191
    v_exp_f32 v194, v194
    s_waitcnt lgkmcnt(3)
    v_mfma_f32_16x16x32_bf16 v[208:211], v[236:239], v[160:163], v[208:211]
    v_exp_f32 v195, v195
    v_mfma_f32_16x16x32_bf16 v[212:215], v[236:239], v[176:179], v[212:215]
    s_add_u32 s22, s21, 0x1c000
    s_add_u32 m0, s20, 0x1c000
    s_nop 0
    buffer_load_dwordx4 v2, s[8:11], s22 offen sc1 lds
    ds_read_b128 v[228:231], v5 offset:17408
    v_cvt_pk_bf16_f32 v58, v192, v193
    v_exp_f32 v196, v196
    s_waitcnt lgkmcnt(3)
    v_mfma_f32_16x16x32_bf16 v[200:203], v[240:243], v[164:167], v[200:203]
    v_exp_f32 v197, v197
    v_cvt_pk_bf16_f32 v59, v194, v195
    v_mfma_f32_16x16x32_bf16 v[204:207], v[240:243], v[180:183], v[204:207]
    ds_read_b128 v[232:235], v5 offset:18432
    v_exp_f32 v198, v198
    s_waitcnt lgkmcnt(3)
    v_mfma_f32_16x16x32_bf16 v[208:211], v[244:247], v[164:167], v[208:211]
    v_exp_f32 v199, v199
    v_cvt_pk_bf16_f32 v62, v196, v197
    v_mov_b32 v20, s28
    v_mov_b32 v21, 0
    s_lshl_b32 s16, s2, 2
    s_add_u32 s16, s16, 0x560000
    s_cmp_eq_u32 s3, 0
    s_cselect_b32 s16, s16, 0x7ffffff0
    s_mov_b64 exec, 1
    buffer_store_dword v20, v21, s[8:11], s16 offen sc1
    s_mov_b64 exec, -1
    v_mfma_f32_16x16x32_bf16 v[212:215], v[244:247], v[180:183], v[212:215]
    ds_read_b128 v[236:239], v5 offset:19456
    v_cvt_pk_bf16_f32 v63, v198, v199
    s_waitcnt lgkmcnt(3)
    v_mfma_f32_16x16x32_bf16 v[184:187], v[224:227], v[152:155], v[216:219]
    v_mfma_f32_16x16x32_bf16 v[188:191], v[224:227], v[168:171], v[220:223]
    ds_read_b128 v[240:243], v5 offset:20480
    v_exp_f32 v200, v200
    v_exp_f32 v201, v201
    v_mfma_f32_16x16x32_bf16 v[248:251], v[12:15], v[56:59], v[248:251]
    s_waitcnt lgkmcnt(3)
    v_mfma_f32_16x16x32_bf16 v[192:195], v[228:231], v[152:155], v[216:219]
    v_exp_f32 v202, v202
    v_exp_f32 v203, v203
    v_mfma_f32_16x16x32_bf16 v[196:199], v[228:231], v[168:171], v[220:223]
    s_add_u32 s22, s21, 0x1c400
    s_add_u32 m0, s20, 0x1c400
    s_nop 0
    buffer_load_dwordx4 v2, s[8:11], s22 offen sc1 lds
    ds_read_b128 v[244:247], v5 offset:21504
    v_cvt_pk_bf16_f32 v64, v200, v201
    v_mfma_f32_16x16x32_bf16 v[252:255], v[12:15], v[60:63], v[252:255]
    s_waitcnt lgkmcnt(3)
    v_mfma_f32_16x16x32_bf16 v[184:187], v[232:235], v[156:159], v[184:187]
    v_exp_f32 v204, v204
    v_exp_f32 v205, v205
    v_mfma_f32_16x16x32_bf16 v[188:191], v[232:235], v[172:175], v[188:191]
    ds_read_b128 v[224:227], v5 offset:22528
    v_cvt_pk_bf16_f32 v65, v202, v203
    s_waitcnt lgkmcnt(3)
    v_mfma_f32_16x16x32_bf16 v[192:195], v[236:239], v[156:159], v[192:195]
    v_exp_f32 v206, v206
    v_exp_f32 v207, v207
    v_mfma_f32_16x16x32_bf16 v[196:199], v[236:239], v[172:175], v[196:199]
    ds_read_b128 v[228:231], v5 offset:23552
    v_cvt_pk_bf16_f32 v68, v204, v205
    v_exp_f32 v208, v208
    s_waitcnt lgkmcnt(3)
    v_mfma_f32_16x16x32_bf16 v[184:187], v[240:243], v[160:163], v[184:187]
    v_exp_f32 v209, v209
    v_mfma_f32_16x16x32_bf16 v[188:191], v[240:243], v[176:179], v[188:191]
    ds_read_b128 v[232:235], v5 offset:24576
    v_cvt_pk_bf16_f32 v69, v206, v207
    v_exp_f32 v210, v210
    s_waitcnt lgkmcnt(3)
    v_mfma_f32_16x16x32_bf16 v[192:195], v[244:247], v[160:163], v[192:195]
    v_exp_f32 v211, v211
    v_mfma_f32_16x16x32_bf16 v[196:199], v[244:247], v[176:179], v[196:199]
    ds_read_b128 v[236:239], v5 offset:25600
    v_cvt_pk_bf16_f32 v66, v208, v209
    v_exp_f32 v212, v212
    s_waitcnt lgkmcnt(3)
    v_mfma_f32_16x16x32_bf16 v[184:187], v[224:227], v[164:167], v[184:187]
    v_exp_f32 v213, v213
    v_cvt_pk_bf16_f32 v67, v210, v211
    v_mfma_f32_16x16x32_bf16 v[188:191], v[224:227], v[180:183], v[188:191]
    ds_read_b128 v[240:243], v5 offset:26624
    v_exp_f32 v214, v214
    s_waitcnt lgkmcnt(3)
    v_mfma_f32_16x16x32_bf16 v[192:195], v[228:231], v[164:167], v[192:195]
    v_exp_f32 v215, v215
    v_cvt_pk_bf16_f32 v70, v212, v213
    v_mfma_f32_16x16x32_bf16 v[196:199], v[228:231], v[180:183], v[196:199]
    ds_read_b128 v[244:247], v5 offset:27648
    v_cvt_pk_bf16_f32 v71, v214, v215
    s_waitcnt lgkmcnt(3)
    v_mfma_f32_16x16x32_bf16 v[200:203], v[232:235], v[152:155], v[216:219]
    v_mfma_f32_16x16x32_bf16 v[204:207], v[232:235], v[168:171], v[220:223]
    ds_read_b128 v[224:227], v5 offset:28672
    v_exp_f32 v184, v184
    v_exp_f32 v185, v185
    v_mfma_f32_16x16x32_bf16 v[248:251], v[12:15], v[64:67], v[248:251]
    s_waitcnt lgkmcnt(3)
    v_mfma_f32_16x16x32_bf16 v[208:211], v[236:239], v[152:155], v[216:219]
    v_exp_f32 v186, v186
    v_exp_f32 v187, v187
    v_mfma_f32_16x16x32_bf16 v[212:215], v[236:239], v[168:171], v[220:223]
    ds_read_b128 v[228:231], v5 offset:29696
    v_cvt_pk_bf16_f32 v72, v184, v185
    v_mfma_f32_16x16x32_bf16 v[252:255], v[12:15], v[68:71], v[252:255]
    s_waitcnt lgkmcnt(3)
    v_mfma_f32_16x16x32_bf16 v[200:203], v[240:243], v[156:159], v[200:203]
    v_exp_f32 v188, v188
    v_exp_f32 v189, v189
    v_mfma_f32_16x16x32_bf16 v[204:207], v[240:243], v[172:175], v[204:207]
    ds_read_b128 v[232:235], v5 offset:30720
    v_cvt_pk_bf16_f32 v73, v186, v187
    s_waitcnt lgkmcnt(3)
    v_mfma_f32_16x16x32_bf16 v[208:211], v[244:247], v[156:159], v[208:211]
    v_exp_f32 v190, v190
    v_exp_f32 v191, v191
    v_mfma_f32_16x16x32_bf16 v[212:215], v[244:247], v[172:175], v[212:215]
    ds_read_b128 v[236:239], v5 offset:31744
    v_cvt_pk_bf16_f32 v76, v188, v189
    v_exp_f32 v192, v192
    s_waitcnt lgkmcnt(3)
    v_mfma_f32_16x16x32_bf16 v[200:203], v[224:227], v[160:163], v[200:203]
    v_exp_f32 v193, v193
    v_mfma_f32_16x16x32_bf16 v[204:207], v[224:227], v[176:179], v[204:207]
    s_waitcnt vmcnt(7)
    s_barrier
    ds_read_b128 v[240:243], v4 offset:0
    v_cvt_pk_bf16_f32 v77, v190, v191
    v_exp_f32 v194, v194
    s_waitcnt lgkmcnt(3)
    v_mfma_f32_16x16x32_bf16 v[208:211], v[228:231], v[160:163], v[208:211]
    v_exp_f32 v195, v195
    v_mfma_f32_16x16x32_bf16 v[212:215], v[228:231], v[176:179], v[212:215]
    s_add_u32 s22, s21, 0x80000
    s_add_u32 m0, s20, 0x20000
    s_nop 0
    buffer_load_dwordx4 v2, s[8:11], s22 offen sc1 lds
    ds_read_b128 v[244:247], v4 offset:1024
    v_cvt_pk_bf16_f32 v74, v192, v193
    v_exp_f32 v196, v196
    s_waitcnt lgkmcnt(3)
    v_mfma_f32_16x16x32_bf16 v[200:203], v[232:235], v[164:167], v[200:203]
    v_exp_f32 v197, v197
    v_cvt_pk_bf16_f32 v75, v194, v195
    v_mfma_f32_16x16x32_bf16 v[204:207], v[232:235], v[180:183], v[204:207]
    ds_read_b128 v[224:227], v4 offset:2048
    v_exp_f32 v198, v198
    s_waitcnt lgkmcnt(3)
    v_mfma_f32_16x16x32_bf16 v[208:211], v[236:239], v[164:167], v[208:211]
    v_exp_f32 v199, v199
    v_cvt_pk_bf16_f32 v78, v196, v197
    v_mfma_f32_16x16x32_bf16 v[212:215], v[236:239], v[180:183], v[212:215]
    ds_read_b128 v[228:231], v4 offset:3072
    v_cvt_pk_bf16_f32 v79, v198, v199
    s_waitcnt lgkmcnt(3)
    v_mfma_f32_16x16x32_bf16 v[184:187], v[240:243], v[152:155], v[216:219]
    v_mfma_f32_16x16x32_bf16 v[188:191], v[240:243], v[168:171], v[220:223]
    ds_read_b128 v[232:235], v4 offset:4096
    v_exp_f32 v200, v200
    v_exp_f32 v201, v201
    v_mfma_f32_16x16x32_bf16 v[248:251], v[12:15], v[72:75], v[248:251]
    s_waitcnt lgkmcnt(3)
    v_mfma_f32_16x16x32_bf16 v[192:195], v[244:247], v[152:155], v[216:219]
    v_exp_f32 v202, v202
    v_exp_f32 v203, v203
    v_mfma_f32_16x16x32_bf16 v[196:199], v[244:247], v[168:171], v[220:223]
    s_add_u32 s22, s21, 0x80400
    s_add_u32 m0, s20, 0x20400
    s_nop 0
    buffer_load_dwordx4 v2, s[8:11], s22 offen sc1 lds
    ds_read_b128 v[236:239], v4 offset:5120
    v_cvt_pk_bf16_f32 v80, v200, v201
    v_mfma_f32_16x16x32_bf16 v[252:255], v[12:15], v[76:79], v[252:255]
    s_waitcnt lgkmcnt(3)
    v_mfma_f32_16x16x32_bf16 v[184:187], v[224:227], v[156:159], v[184:187]
    v_exp_f32 v204, v204
    v_exp_f32 v205, v205
    v_mfma_f32_16x16x32_bf16 v[188:191], v[224:227], v[172:175], v[188:191]
    ds_read_b128 v[240:243], v4 offset:6144
    v_cvt_pk_bf16_f32 v81, v202, v203
    s_waitcnt lgkmcnt(3)
    v_mfma_f32_16x16x32_bf16 v[192:195], v[228:231], v[156:159], v[192:195]
    v_exp_f32 v206, v206
    v_exp_f32 v207, v207
    v_mfma_f32_16x16x32_bf16 v[196:199], v[228:231], v[172:175], v[196:199]
    ds_read_b128 v[244:247], v4 offset:7168
    v_cvt_pk_bf16_f32 v84, v204, v205
    v_exp_f32 v208, v208
    s_waitcnt lgkmcnt(3)
    v_mfma_f32_16x16x32_bf16 v[184:187], v[232:235], v[160:163], v[184:187]
    v_exp_f32 v209, v209
    v_mfma_f32_16x16x32_bf16 v[188:191], v[232:235], v[176:179], v[188:191]
    ds_read_b128 v[224:227], v4 offset:8192
    v_cvt_pk_bf16_f32 v85, v206, v207
    v_exp_f32 v210, v210
    s_waitcnt lgkmcnt(3)
    v_mfma_f32_16x16x32_bf16 v[192:195], v[236:239], v[160:163], v[192:195]
    v_exp_f32 v211, v211
    v_mfma_f32_16x16x32_bf16 v[196:199], v[236:239], v[176:179], v[196:199]
    ds_read_b128 v[228:231], v4 offset:9216
    v_cvt_pk_bf16_f32 v82, v208, v209
    v_exp_f32 v212, v212
    s_waitcnt lgkmcnt(3)
    v_mfma_f32_16x16x32_bf16 v[184:187], v[240:243], v[164:167], v[184:187]
    v_exp_f32 v213, v213
    v_cvt_pk_bf16_f32 v83, v210, v211
    v_mfma_f32_16x16x32_bf16 v[188:191], v[240:243], v[180:183], v[188:191]
    ds_read_b128 v[232:235], v4 offset:10240
    v_exp_f32 v214, v214
    s_waitcnt lgkmcnt(3)
    v_mfma_f32_16x16x32_bf16 v[192:195], v[244:247], v[164:167], v[192:195]
    v_exp_f32 v215, v215
    v_cvt_pk_bf16_f32 v86, v212, v213
    v_mfma_f32_16x16x32_bf16 v[196:199], v[244:247], v[180:183], v[196:199]
    ds_read_b128 v[236:239], v4 offset:11264
    v_cvt_pk_bf16_f32 v87, v214, v215
    s_waitcnt lgkmcnt(3)
    v_mfma_f32_16x16x32_bf16 v[200:203], v[224:227], v[152:155], v[216:219]
    v_mfma_f32_16x16x32_bf16 v[204:207], v[224:227], v[168:171], v[220:223]
    ds_read_b128 v[240:243], v4 offset:12288
    v_exp_f32 v184, v184
    v_exp_f32 v185, v185
    v_mfma_f32_16x16x32_bf16 v[248:251], v[12:15], v[80:83], v[248:251]
    s_waitcnt lgkmcnt(3)
    v_mfma_f32_16x16x32_bf16 v[208:211], v[228:231], v[152:155], v[216:219]
    v_exp_f32 v186, v186
    v_exp_f32 v187, v187
    v_mfma_f32_16x16x32_bf16 v[212:215], v[228:231], v[168:171], v[220:223]
    ds_read_b128 v[244:247], v4 offset:13312
    v_cvt_pk_bf16_f32 v88, v184, v185
    v_mfma_f32_16x16x32_bf16 v[252:255], v[12:15], v[84:87], v[252:255]
    s_waitcnt lgkmcnt(3)
    v_mfma_f32_16x16x32_bf16 v[200:203], v[232:235], v[156:159], v[200:203]
    v_exp_f32 v188, v188
    v_exp_f32 v189, v189
    v_mfma_f32_16x16x32_bf16 v[204:207], v[232:235], v[172:175], v[204:207]
    ds_read_b128 v[224:227], v4 offset:14336
    v_cvt_pk_bf16_f32 v89, v186, v187
    s_waitcnt lgkmcnt(3)
    v_mfma_f32_16x16x32_bf16 v[208:211], v[236:239], v[156:159], v[208:211]
    v_exp_f32 v190, v190
    v_exp_f32 v191, v191
    v_mfma_f32_16x16x32_bf16 v[212:215], v[236:239], v[172:175], v[212:215]
    ds_read_b128 v[228:231], v4 offset:15360
    v_cvt_pk_bf16_f32 v92, v188, v189
    v_exp_f32 v192, v192
    s_waitcnt lgkmcnt(3)
    v_mfma_f32_16x16x32_bf16 v[200:203], v[240:243], v[160:163], v[200:203]
    v_exp_f32 v193, v193
    v_mfma_f32_16x16x32_bf16 v[204:207], v[240:243], v[176:179], v[204:207]
    s_waitcnt vmcnt(7)
    s_barrier
    ds_read_b128 v[232:235], v4 offset:16384
    v_cvt_pk_bf16_f32 v93, v190, v191
    v_exp_f32 v194, v194
    s_waitcnt lgkmcnt(3)
    v_mfma_f32_16x16x32_bf16 v[208:211], v[244:247], v[160:163], v[208:211]
    v_exp_f32 v195, v195
    v_mfma_f32_16x16x32_bf16 v[212:215], v[244:247], v[176:179], v[212:215]
    s_add_u32 s22, s21, 0x84000
    s_add_u32 m0, s20, 0x24000
    s_nop 0
    buffer_load_dwordx4 v2, s[8:11], s22 offen sc1 lds
    ds_read_b128 v[236:239], v4 offset:17408
    v_cvt_pk_bf16_f32 v90, v192, v193
    v_exp_f32 v196, v196
    s_waitcnt lgkmcnt(3)
    v_mfma_f32_16x16x32_bf16 v[200:203], v[224:227], v[164:167], v[200:203]
    v_exp_f32 v197, v197
    v_cvt_pk_bf16_f32 v91, v194, v195
    v_mfma_f32_16x16x32_bf16 v[204:207], v[224:227], v[180:183], v[204:207]
    ds_read_b128 v[240:243], v4 offset:18432
    v_exp_f32 v198, v198
    s_waitcnt lgkmcnt(3)
    v_mfma_f32_16x16x32_bf16 v[208:211], v[228:231], v[164:167], v[208:211]
    v_exp_f32 v199, v199
    v_cvt_pk_bf16_f32 v94, v196, v197
    v_mfma_f32_16x16x32_bf16 v[212:215], v[228:231], v[180:183], v[212:215]
    ds_read_b128 v[244:247], v4 offset:19456
    v_cvt_pk_bf16_f32 v95, v198, v199
    s_waitcnt lgkmcnt(3)
    v_mfma_f32_16x16x32_bf16 v[184:187], v[232:235], v[152:155], v[216:219]
    v_mfma_f32_16x16x32_bf16 v[188:191], v[232:235], v[168:171], v[220:223]
    ds_read_b128 v[224:227], v4 offset:20480
    v_exp_f32 v200, v200
    v_exp_f32 v201, v201
    v_mfma_f32_16x16x32_bf16 v[248:251], v[12:15], v[88:91], v[248:251]
    s_waitcnt lgkmcnt(3)
    v_mfma_f32_16x16x32_bf16 v[192:195], v[236:239], v[152:155], v[216:219]
    v_exp_f32 v202, v202
    v_exp_f32 v203, v203
    v_mfma_f32_16x16x32_bf16 v[196:199], v[236:239], v[168:171], v[220:223]
    s_add_u32 s22, s21, 0x84400
    s_add_u32 m0, s20, 0x24400
    s_nop 0
    buffer_load_dwordx4 v2, s[8:11], s22 offen sc1 lds
    ds_read_b128 v[228:231], v4 offset:21504
    v_cvt_pk_bf16_f32 v96, v200, v201
    v_mfma_f32_16x16x32_bf16 v[252:255], v[12:15], v[92:95], v[252:255]
    s_waitcnt lgkmcnt(3)
    v_mfma_f32_16x16x32_bf16 v[184:187], v[240:243], v[156:159], v[184:187]
    v_exp_f32 v204, v204
    v_exp_f32 v205, v205
    v_mfma_f32_16x16x32_bf16 v[188:191], v[240:243], v[172:175], v[188:191]
    ds_read_b128 v[232:235], v4 offset:22528
    v_cvt_pk_bf16_f32 v97, v202, v203
    s_waitcnt lgkmcnt(3)
    v_mfma_f32_16x16x32_bf16 v[192:195], v[244:247], v[156:159], v[192:195]
    v_exp_f32 v206, v206
    v_exp_f32 v207, v207
    v_mfma_f32_16x16x32_bf16 v[196:199], v[244:247], v[172:175], v[196:199]
    ds_read_b128 v[236:239], v4 offset:23552
    v_cvt_pk_bf16_f32 v100, v204, v205
    v_exp_f32 v208, v208
    s_waitcnt lgkmcnt(3)
    v_mfma_f32_16x16x32_bf16 v[184:187], v[224:227], v[160:163], v[184:187]
    v_exp_f32 v209, v209
    v_mfma_f32_16x16x32_bf16 v[188:191], v[224:227], v[176:179], v[188:191]
    ds_read_b128 v[240:243], v4 offset:24576
    v_cvt_pk_bf16_f32 v101, v206, v207
    v_exp_f32 v210, v210
    s_waitcnt lgkmcnt(3)
    v_mfma_f32_16x16x32_bf16 v[192:195], v[228:231], v[160:163], v[192:195]
    v_exp_f32 v211, v211
    v_mfma_f32_16x16x32_bf16 v[196:199], v[228:231], v[176:179], v[196:199]
    ds_read_b128 v[244:247], v4 offset:25600
    v_cvt_pk_bf16_f32 v98, v208, v209
    v_exp_f32 v212, v212
    s_waitcnt lgkmcnt(3)
    v_mfma_f32_16x16x32_bf16 v[184:187], v[232:235], v[164:167], v[184:187]
    v_exp_f32 v213, v213
    v_cvt_pk_bf16_f32 v99, v210, v211
    v_mfma_f32_16x16x32_bf16 v[188:191], v[232:235], v[180:183], v[188:191]
    ds_read_b128 v[224:227], v4 offset:26624
    v_exp_f32 v214, v214
    s_waitcnt lgkmcnt(3)
    v_mfma_f32_16x16x32_bf16 v[192:195], v[236:239], v[164:167], v[192:195]
    v_exp_f32 v215, v215
    v_cvt_pk_bf16_f32 v102, v212, v213
    v_mfma_f32_16x16x32_bf16 v[196:199], v[236:239], v[180:183], v[196:199]
    ds_read_b128 v[228:231], v4 offset:27648
    v_cvt_pk_bf16_f32 v103, v214, v215
    s_waitcnt lgkmcnt(3)
    v_mfma_f32_16x16x32_bf16 v[200:203], v[240:243], v[152:155], v[216:219]
    v_mfma_f32_16x16x32_bf16 v[204:207], v[240:243], v[168:171], v[220:223]
    ds_read_b128 v[232:235], v4 offset:28672
    v_exp_f32 v184, v184
    v_exp_f32 v185, v185
    v_mfma_f32_16x16x32_bf16 v[248:251], v[12:15], v[96:99], v[248:251]
    s_waitcnt lgkmcnt(3)
    v_mfma_f32_16x16x32_bf16 v[208:211], v[244:247], v[152:155], v[216:219]
    v_exp_f32 v186, v186
    v_exp_f32 v187, v187
    v_mfma_f32_16x16x32_bf16 v[212:215], v[244:247], v[168:171], v[220:223]
    ds_read_b128 v[236:239], v4 offset:29696
    v_cvt_pk_bf16_f32 v104, v184, v185
    v_mfma_f32_16x16x32_bf16 v[252:255], v[12:15], v[100:103], v[252:255]
    s_waitcnt lgkmcnt(3)
    v_mfma_f32_16x16x32_bf16 v[200:203], v[224:227], v[156:159], v[200:203]
    v_exp_f32 v188, v188
    v_exp_f32 v189, v189
    v_mfma_f32_16x16x32_bf16 v[204:207], v[224:227], v[172:175], v[204:207]
    ds_read_b128 v[240:243], v4 offset:30720
    v_cvt_pk_bf16_f32 v105, v186, v187
    s_waitcnt lgkmcnt(3)
    v_mfma_f32_16x16x32_bf16 v[208:211], v[228:231], v[156:159], v[208:211]
    v_exp_f32 v190, v190
    v_exp_f32 v191, v191
    v_mfma_f32_16x16x32_bf16 v[212:215], v[228:231], v[172:175], v[212:215]
    ds_read_b128 v[244:247], v4 offset:31744
    v_cvt_pk_bf16_f32 v108, v188, v189
    v_exp_f32 v192, v192
    s_waitcnt lgkmcnt(3)
    v_mfma_f32_16x16x32_bf16 v[200:203], v[232:235], v[160:163], v[200:203]
    v_exp_f32 v193, v193
    v_mfma_f32_16x16x32_bf16 v[204:207], v[232:235], v[176:179], v[204:207]
    s_waitcnt vmcnt(7)
    s_barrier
    ds_read_b128 v[224:227], v4 offset:32768
    v_cvt_pk_bf16_f32 v109, v190, v191
    v_exp_f32 v194, v194
    s_waitcnt lgkmcnt(3)
    v_mfma_f32_16x16x32_bf16 v[208:211], v[236:239], v[160:163], v[208:211]
    v_exp_f32 v195, v195
    v_mfma_f32_16x16x32_bf16 v[212:215], v[236:239], v[176:179], v[212:215]
    s_add_u32 s22, s21, 0x88000
    s_add_u32 m0, s20, 0x10000
    s_nop 0
    buffer_load_dwordx4 v2, s[8:11], s22 offen sc1 lds
    ds_read_b128 v[228:231], v4 offset:33792
    v_cvt_pk_bf16_f32 v106, v192, v193
    v_exp_f32 v196, v196
    s_waitcnt lgkmcnt(3)
    v_mfma_f32_16x16x32_bf16 v[200:203], v[240:243], v[164:167], v[200:203]
    v_exp_f32 v197, v197
    v_cvt_pk_bf16_f32 v107, v194, v195
    v_mfma_f32_16x16x32_bf16 v[204:207], v[240:243], v[180:183], v[204:207]
    ds_read_b128 v[232:235], v4 offset:34816
    v_exp_f32 v198, v198
    s_waitcnt lgkmcnt(3)
    v_mfma_f32_16x16x32_bf16 v[208:211], v[244:247], v[164:167], v[208:211]
    v_exp_f32 v199, v199
    v_cvt_pk_bf16_f32 v110, v196, v197
    v_mfma_f32_16x16x32_bf16 v[212:215], v[244:247], v[180:183], v[212:215]
    ds_read_b128 v[236:239], v4 offset:35840
    v_cvt_pk_bf16_f32 v111, v198, v199
    s_waitcnt lgkmcnt(3)
    v_mfma_f32_16x16x32_bf16 v[184:187], v[224:227], v[152:155], v[216:219]
    v_mfma_f32_16x16x32_bf16 v[188:191], v[224:227], v[168:171], v[220:223]
    ds_read_b128 v[240:243], v4 offset:36864
    v_exp_f32 v200, v200
    v_exp_f32 v201, v201
    v_mfma_f32_16x16x32_bf16 v[248:251], v[12:15], v[104:107], v[248:251]
    s_waitcnt lgkmcnt(3)
    v_mfma_f32_16x16x32_bf16 v[192:195], v[228:231], v[152:155], v[216:219]
    v_exp_f32 v202, v202
    v_exp_f32 v203, v203
    v_mfma_f32_16x16x32_bf16 v[196:199], v[228:231], v[168:171], v[220:223]
    s_add_u32 s22, s21, 0x88400
    s_add_u32 m0, s20, 0x10400
    s_nop 0
    buffer_load_dwordx4 v2, s[8:11], s22 offen sc1 lds
    ds_read_b128 v[244:247], v4 offset:37888
    v_cvt_pk_bf16_f32 v112, v200, v201
    v_mfma_f32_16x16x32_bf16 v[252:255], v[12:15], v[108:111], v[252:255]
    s_waitcnt lgkmcnt(3)
    v_mfma_f32_16x16x32_bf16 v[184:187], v[232:235], v[156:159], v[184:187]
    v_exp_f32 v204, v204
    v_exp_f32 v205, v205
    v_mfma_f32_16x16x32_bf16 v[188:191], v[232:235], v[172:175], v[188:191]
    ds_read_b128 v[224:227], v4 offset:38912
    v_cvt_pk_bf16_f32 v113, v202, v203
    s_waitcnt lgkmcnt(3)
    v_mfma_f32_16x16x32_bf16 v[192:195], v[236:239], v[156:159], v[192:195]
    v_exp_f32 v206, v206
    v_exp_f32 v207, v207
    v_mfma_f32_16x16x32_bf16 v[196:199], v[236:239], v[172:175], v[196:199]
    ds_read_b128 v[228:231], v4 offset:39936
    v_cvt_pk_bf16_f32 v116, v204, v205
    v_exp_f32 v208, v208
    s_waitcnt lgkmcnt(3)
    v_mfma_f32_16x16x32_bf16 v[184:187], v[240:243], v[160:163], v[184:187]
    v_exp_f32 v209, v209
    v_mfma_f32_16x16x32_bf16 v[188:191], v[240:243], v[176:179], v[188:191]
    ds_read_b128 v[232:235], v4 offset:40960
    v_cvt_pk_bf16_f32 v117, v206, v207
    v_exp_f32 v210, v210
    s_waitcnt lgkmcnt(3)
    v_mfma_f32_16x16x32_bf16 v[192:195], v[244:247], v[160:163], v[192:195]
    v_exp_f32 v211, v211
    v_mfma_f32_16x16x32_bf16 v[196:199], v[244:247], v[176:179], v[196:199]
    ds_read_b128 v[236:239], v4 offset:41984
    v_cvt_pk_bf16_f32 v114, v208, v209
    v_exp_f32 v212, v212
    s_waitcnt lgkmcnt(3)
    v_mfma_f32_16x16x32_bf16 v[184:187], v[224:227], v[164:167], v[184:187]
    v_exp_f32 v213, v213
    v_cvt_pk_bf16_f32 v115, v210, v211
    v_mfma_f32_16x16x32_bf16 v[188:191], v[224:227], v[180:183], v[188:191]
    ds_read_b128 v[240:243], v4 offset:43008
    v_exp_f32 v214, v214
    s_waitcnt lgkmcnt(3)
    v_mfma_f32_16x16x32_bf16 v[192:195], v[228:231], v[164:167], v[192:195]
    v_exp_f32 v215, v215
    v_cvt_pk_bf16_f32 v118, v212, v213
    v_mfma_f32_16x16x32_bf16 v[196:199], v[228:231], v[180:183], v[196:199]
    ds_read_b128 v[244:247], v4 offset:44032
    v_cvt_pk_bf16_f32 v119, v214, v215
    s_waitcnt lgkmcnt(3)
    v_mfma_f32_16x16x32_bf16 v[200:203], v[232:235], v[152:155], v[216:219]
    v_mfma_f32_16x16x32_bf16 v[204:207], v[232:235], v[168:171], v[220:223]
    ds_read_b128 v[224:227], v4 offset:45056
    v_exp_f32 v184, v184
    v_exp_f32 v185, v185
    v_mfma_f32_16x16x32_bf16 v[248:251], v[12:15], v[112:115], v[248:251]
    s_waitcnt lgkmcnt(3)
    v_mfma_f32_16x16x32_bf16 v[208:211], v[236:239], v[152:155], v[216:219]
    v_exp_f32 v186, v186
    v_exp_f32 v187, v187
    v_mfma_f32_16x16x32_bf16 v[212:215], v[236:239], v[168:171], v[220:223]
    ds_read_b128 v[228:231], v4 offset:46080
    v_cvt_pk_bf16_f32 v120, v184, v185
    v_mfma_f32_16x16x32_bf16 v[252:255], v[12:15], v[116:119], v[252:255]
    s_waitcnt lgkmcnt(3)
    v_mfma_f32_16x16x32_bf16 v[200:203], v[240:243], v[156:159], v[200:203]
    v_exp_f32 v188, v188
    v_exp_f32 v189, v189
    v_mfma_f32_16x16x32_bf16 v[204:207], v[240:243], v[172:175], v[204:207]
    ds_read_b128 v[232:235], v4 offset:47104
    v_cvt_pk_bf16_f32 v121, v186, v187
    s_waitcnt lgkmcnt(3)
    v_mfma_f32_16x16x32_bf16 v[208:211], v[244:247], v[156:159], v[208:211]
    v_exp_f32 v190, v190
    v_exp_f32 v191, v191
    v_mfma_f32_16x16x32_bf16 v[212:215], v[244:247], v[172:175], v[212:215]
    ds_read_b128 v[236:239], v4 offset:48128
    v_cvt_pk_bf16_f32 v124, v188, v189
    v_exp_f32 v192, v192
    s_waitcnt lgkmcnt(3)
    v_mfma_f32_16x16x32_bf16 v[200:203], v[224:227], v[160:163], v[200:203]
    v_exp_f32 v193, v193
    v_mfma_f32_16x16x32_bf16 v[204:207], v[224:227], v[176:179], v[204:207]
    s_waitcnt vmcnt(6)
    s_barrier
    ds_read_b128 v[240:243], v4 offset:49152
    v_cvt_pk_bf16_f32 v125, v190, v191
    v_exp_f32 v194, v194
    s_waitcnt lgkmcnt(3)
    v_mfma_f32_16x16x32_bf16 v[208:211], v[228:231], v[160:163], v[208:211]
    v_exp_f32 v195, v195
    v_mfma_f32_16x16x32_bf16 v[212:215], v[228:231], v[176:179], v[212:215]
    s_add_u32 s22, s21, 0x8c000
    s_add_u32 m0, s20, 0x14000
    s_nop 0
    buffer_load_dwordx4 v2, s[8:11], s22 offen sc1 lds
    ds_read_b128 v[244:247], v4 offset:50176
    v_cvt_pk_bf16_f32 v122, v192, v193
    v_exp_f32 v196, v196
    s_waitcnt lgkmcnt(3)
    v_mfma_f32_16x16x32_bf16 v[200:203], v[232:235], v[164:167], v[200:203]
    v_exp_f32 v197, v197
    v_cvt_pk_bf16_f32 v123, v194, v195
    v_mfma_f32_16x16x32_bf16 v[204:207], v[232:235], v[180:183], v[204:207]
    ds_read_b128 v[224:227], v4 offset:51200
    v_exp_f32 v198, v198
    s_waitcnt lgkmcnt(3)
    v_mfma_f32_16x16x32_bf16 v[208:211], v[236:239], v[164:167], v[208:211]
    v_exp_f32 v199, v199
    v_cvt_pk_bf16_f32 v126, v196, v197
    v_mfma_f32_16x16x32_bf16 v[212:215], v[236:239], v[180:183], v[212:215]
    ds_read_b128 v[228:231], v4 offset:52224
    v_cvt_pk_bf16_f32 v127, v198, v199
    s_waitcnt lgkmcnt(3)
    v_mfma_f32_16x16x32_bf16 v[184:187], v[240:243], v[152:155], v[216:219]
    v_mfma_f32_16x16x32_bf16 v[188:191], v[240:243], v[168:171], v[220:223]
    ds_read_b128 v[232:235], v4 offset:53248
    v_exp_f32 v200, v200
    v_exp_f32 v201, v201
    v_mfma_f32_16x16x32_bf16 v[248:251], v[12:15], v[120:123], v[248:251]
    s_waitcnt lgkmcnt(3)
    v_mfma_f32_16x16x32_bf16 v[192:195], v[244:247], v[152:155], v[216:219]
    v_exp_f32 v202, v202
    v_exp_f32 v203, v203
    v_mfma_f32_16x16x32_bf16 v[196:199], v[244:247], v[168:171], v[220:223]
    s_add_u32 s22, s21, 0x8c400
    s_add_u32 m0, s20, 0x14400
    s_nop 0
    buffer_load_dwordx4 v2, s[8:11], s22 offen sc1 lds
    ds_read_b128 v[236:239], v4 offset:54272
    v_cvt_pk_bf16_f32 v128, v200, v201
    v_mfma_f32_16x16x32_bf16 v[252:255], v[12:15], v[124:127], v[252:255]
    s_waitcnt lgkmcnt(3)
    v_mfma_f32_16x16x32_bf16 v[184:187], v[224:227], v[156:159], v[184:187]
    v_exp_f32 v204, v204
    v_exp_f32 v205, v205
    v_mfma_f32_16x16x32_bf16 v[188:191], v[224:227], v[172:175], v[188:191]
    ds_read_b128 v[240:243], v4 offset:55296
    v_cvt_pk_bf16_f32 v129, v202, v203
    s_waitcnt lgkmcnt(3)
    v_mfma_f32_16x16x32_bf16 v[192:195], v[228:231], v[156:159], v[192:195]
    v_exp_f32 v206, v206
    v_exp_f32 v207, v207
    v_mfma_f32_16x16x32_bf16 v[196:199], v[228:231], v[172:175], v[196:199]
    ds_read_b128 v[244:247], v4 offset:56320
    v_cvt_pk_bf16_f32 v132, v204, v205
    v_exp_f32 v208, v208
    s_waitcnt lgkmcnt(3)
    v_mfma_f32_16x16x32_bf16 v[184:187], v[232:235], v[160:163], v[184:187]
    v_exp_f32 v209, v209
    v_mfma_f32_16x16x32_bf16 v[188:191], v[232:235], v[176:179], v[188:191]
    ds_read_b128 v[224:227], v4 offset:57344
    v_cvt_pk_bf16_f32 v133, v206, v207
    v_exp_f32 v210, v210
    s_waitcnt lgkmcnt(3)
    v_mfma_f32_16x16x32_bf16 v[192:195], v[236:239], v[160:163], v[192:195]
    v_exp_f32 v211, v211
    v_mfma_f32_16x16x32_bf16 v[196:199], v[236:239], v[176:179], v[196:199]
    ds_read_b128 v[228:231], v4 offset:58368
    v_cvt_pk_bf16_f32 v130, v208, v209
    v_exp_f32 v212, v212
    s_waitcnt lgkmcnt(3)
    v_mfma_f32_16x16x32_bf16 v[184:187], v[240:243], v[164:167], v[184:187]
    v_exp_f32 v213, v213
    v_cvt_pk_bf16_f32 v131, v210, v211
    v_mfma_f32_16x16x32_bf16 v[188:191], v[240:243], v[180:183], v[188:191]
    ds_read_b128 v[232:235], v4 offset:59392
    v_exp_f32 v214, v214
    s_waitcnt lgkmcnt(3)
    v_mfma_f32_16x16x32_bf16 v[192:195], v[244:247], v[164:167], v[192:195]
    v_exp_f32 v215, v215
    v_cvt_pk_bf16_f32 v134, v212, v213
    v_mfma_f32_16x16x32_bf16 v[196:199], v[244:247], v[180:183], v[196:199]
    ds_read_b128 v[236:239], v4 offset:60416
    v_cvt_pk_bf16_f32 v135, v214, v215
    s_waitcnt lgkmcnt(3)
    v_mfma_f32_16x16x32_bf16 v[200:203], v[224:227], v[152:155], v[216:219]
    v_mfma_f32_16x16x32_bf16 v[204:207], v[224:227], v[168:171], v[220:223]
    ds_read_b128 v[240:243], v4 offset:61440
    v_exp_f32 v184, v184
    v_exp_f32 v185, v185
    v_mfma_f32_16x16x32_bf16 v[248:251], v[12:15], v[128:131], v[248:251]
    s_waitcnt lgkmcnt(3)
    v_mfma_f32_16x16x32_bf16 v[208:211], v[228:231], v[152:155], v[216:219]
    v_exp_f32 v186, v186
    v_exp_f32 v187, v187
    v_mfma_f32_16x16x32_bf16 v[212:215], v[228:231], v[168:171], v[220:223]
    ds_read_b128 v[244:247], v4 offset:62464
    v_cvt_pk_bf16_f32 v136, v184, v185
    v_mfma_f32_16x16x32_bf16 v[252:255], v[12:15], v[132:135], v[252:255]
    s_waitcnt lgkmcnt(3)
    v_mfma_f32_16x16x32_bf16 v[200:203], v[232:235], v[156:159], v[200:203]
    v_exp_f32 v188, v188
    v_exp_f32 v189, v189
    v_mfma_f32_16x16x32_bf16 v[204:207], v[232:235], v[172:175], v[204:207]
    ds_read_b128 v[224:227], v4 offset:63488
    v_cvt_pk_bf16_f32 v137, v186, v187
    s_waitcnt lgkmcnt(3)
    v_mfma_f32_16x16x32_bf16 v[208:211], v[236:239], v[156:159], v[208:211]
    v_exp_f32 v190, v190
    v_exp_f32 v191, v191
    v_mfma_f32_16x16x32_bf16 v[212:215], v[236:239], v[172:175], v[212:215]
    ds_read_b128 v[228:231], v4 offset:64512
    v_cvt_pk_bf16_f32 v140, v188, v189
    v_exp_f32 v192, v192
    s_waitcnt lgkmcnt(3)
    v_mfma_f32_16x16x32_bf16 v[200:203], v[240:243], v[160:163], v[200:203]
    v_exp_f32 v193, v193
    v_mfma_f32_16x16x32_bf16 v[204:207], v[240:243], v[176:179], v[204:207]
    v_cvt_pk_bf16_f32 v141, v190, v191
    v_exp_f32 v194, v194
    s_waitcnt lgkmcnt(2)
    v_mfma_f32_16x16x32_bf16 v[208:211], v[244:247], v[160:163], v[208:211]
    v_exp_f32 v195, v195
    v_mfma_f32_16x16x32_bf16 v[212:215], v[244:247], v[176:179], v[212:215]
    v_cvt_pk_bf16_f32 v138, v192, v193
    v_exp_f32 v196, v196
    s_waitcnt lgkmcnt(1)
    v_mfma_f32_16x16x32_bf16 v[200:203], v[224:227], v[164:167], v[200:203]
    v_exp_f32 v197, v197
    v_cvt_pk_bf16_f32 v139, v194, v195
    v_mfma_f32_16x16x32_bf16 v[204:207], v[224:227], v[180:183], v[204:207]
    v_exp_f32 v198, v198
    s_waitcnt lgkmcnt(0)
    v_mfma_f32_16x16x32_bf16 v[208:211], v[228:231], v[164:167], v[208:211]
    v_exp_f32 v199, v199
    v_cvt_pk_bf16_f32 v142, v196, v197
    v_mfma_f32_16x16x32_bf16 v[212:215], v[228:231], v[180:183], v[212:215]
    v_cvt_pk_bf16_f32 v143, v198, v199
    s_waitcnt vmcnt(6)
    s_barrier
    ds_read_b128 v[232:235], v5 offset:0
    ds_read_b128 v[236:239], v5 offset:1024
    ds_read_b128 v[240:243], v5 offset:2048
    ds_read_b128 v[244:247], v5 offset:3072
    v_mfma_f32_16x16x32_bf16 v[248:251], v[12:15], v[136:139], v[248:251]
    v_mfma_f32_16x16x32_bf16 v[252:255], v[12:15], v[140:143], v[252:255]
    v_exp_f32 v200, v200
    v_exp_f32 v201, v201
    v_exp_f32 v202, v202
    v_exp_f32 v203, v203
    v_cvt_pk_bf16_f32 v144, v200, v201
    v_exp_f32 v204, v204
    v_exp_f32 v205, v205
    v_cvt_pk_bf16_f32 v145, v202, v203
    v_exp_f32 v206, v206
    v_exp_f32 v207, v207
    v_cvt_pk_bf16_f32 v148, v204, v205
    v_exp_f32 v208, v208
    v_exp_f32 v209, v209
    v_cvt_pk_bf16_f32 v149, v206, v207
    v_exp_f32 v210, v210
    v_exp_f32 v211, v211
    v_cvt_pk_bf16_f32 v146, v208, v209
    v_exp_f32 v212, v212
    v_exp_f32 v213, v213
    v_cvt_pk_bf16_f32 v147, v210, v211
    v_exp_f32 v214, v214
    v_exp_f32 v215, v215
    v_cvt_pk_bf16_f32 v150, v212, v213
    v_cvt_pk_bf16_f32 v151, v214, v215
    v_mfma_f32_16x16x32_bf16 v[248:251], v[12:15], v[144:147], v[248:251]
    s_nop 0
    v_mfma_f32_16x16x32_bf16 v[252:255], v[12:15], v[148:151], v[252:255]
    s_nop 5
    v_mov_b32 v9, v248
    s_nop 0
    v_mov_b32 v10, v252
    v_max_f32 v17, v9, v10
    v_readfirstlane_b32 s17, v8
    s_cmp_eq_u32 s17, s28
    s_cselect_b32 s16, 0, 0x71800000
    v_cmp_ngt_f32 vcc, s16, v17
    v_cmp_u_f32 s[76:77], v9, v10
    s_or_b64 vcc, vcc, s[76:77]
    s_cbranch_vccnz adaLN_cond__sliding_block_cached__moe_arch_mod__prompt_kernel_fixA
adaLN_cond__sliding_block_cached__moe_arch_mod__prompt_kernel_fixAb:
    v_rcp_f32 v9, v9
    v_rcp_f32 v10, v10
    s_lshl_b32 s25, s13, 3
    s_add_u32 s25, s25, s3
    s_lshl_b32 s25, s25, 18
    s_lshl_b32 s26, s12, 12
    s_add_u32 s25, s25, s26
    s_add_u32 s25, s25, 0x1000000
    s_add_u32 s26, s25, 131072
    s_lshl_b32 s63, s13, 3
    s_add_u32 s63, s63, s3
    s_lshl_b32 s63, s63, 5
    s_add_u32 s63, s63, s12
    s_lshl_b32 s63, s63, 2
    s_waitcnt lgkmcnt(3)
    v_mfma_f32_16x16x32_bf16 v[184:187], v[232:235], v[24:27], 0
    v_mfma_f32_16x16x32_bf16 v[188:191], v[232:235], v[28:31], 0
    ds_read_b128 v[224:227], v5 offset:4096
    s_waitcnt lgkmcnt(3)
    v_mfma_f32_16x16x32_bf16 v[192:195], v[236:239], v[24:27], 0
    s_add_u32 s22, s21, 0x90000
    s_add_u32 m0, s20, 0x18000
    s_nop 0
    buffer_load_dwordx4 v2, s[8:11], s22 offen sc1 lds
    v_mfma_f32_16x16x32_bf16 v[196:199], v[236:239], v[28:31], 0
    ds_read_b128 v[228:231], v5 offset:5120
    s_waitcnt lgkmcnt(3)
    v_mfma_f32_16x16x32_bf16 v[184:187], v[240:243], v[32:35], v[184:187]
    v_mfma_f32_16x16x32_bf16 v[188:191], v[240:243], v[36:39], v[188:191]
    ds_read_b128 v[232:235], v5 offset:6144
    s_waitcnt lgkmcnt(3)
    v_mfma_f32_16x16x32_bf16 v[192:195], v[244:247], v[32:35], v[192:195]
    v_mfma_f32_16x16x32_bf16 v[196:199], v[244:247], v[36:39], v[196:199]
    ds_read_b128 v[236:239], v5 offset:7168
    s_waitcnt lgkmcnt(3)
    v_mfma_f32_16x16x32_bf16 v[184:187], v[224:227], v[40:43], v[184:187]
    v_mfma_f32_16x16x32_bf16 v[188:191], v[224:227], v[44:47], v[188:191]
    ds_read_b128 v[240:243], v5 offset:8192
    s_waitcnt lgkmcnt(3)
    v_mfma_f32_16x16x32_bf16 v[192:195], v[228:231], v[40:43], v[192:195]
    s_add_u32 s22, s21, 0x90400
    s_add_u32 m0, s20, 0x18400
    s_nop 0
    buffer_load_dwordx4 v2, s[8:11], s22 offen sc1 lds
    v_and_b32 v250, 7, v1
    v_lshlrev_b32 v250, 7, v250
    s_lshr_b32 s14, s2, 3
    s_lshl_b32 s14, s14, 2
    s_add_u32 s14, s14, 0x560000
    buffer_load_dword v248, v250, s[8:11], s14 offen sc1
    v_mfma_f32_16x16x32_bf16 v[196:199], v[228:231], v[44:47], v[196:199]
    ds_read_b128 v[244:247], v5 offset:9216
    s_waitcnt lgkmcnt(3)
    v_mfma_f32_16x16x32_bf16 v[184:187], v[232:235], v[48:51], v[184:187]
    v_mfma_f32_16x16x32_bf16 v[188:191], v[232:235], v[52:55], v[188:191]
    ds_read_b128 v[224:227], v5 offset:10240
    s_waitcnt lgkmcnt(3)
    v_mfma_f32_16x16x32_bf16 v[192:195], v[236:239], v[48:51], v[192:195]
    v_mfma_f32_16x16x32_bf16 v[196:199], v[236:239], v[52:55], v[196:199]
    ds_read_b128 v[228:231], v5 offset:11264
    s_waitcnt lgkmcnt(3)
    v_mfma_f32_16x16x32_bf16 v[184:187], v[240:243], v[56:59], v[184:187]
    v_mfma_f32_16x16x32_bf16 v[188:191], v[240:243], v[60:63], v[188:191]
    ds_read_b128 v[232:235], v5 offset:12288
    s_waitcnt lgkmcnt(3)
    v_mfma_f32_16x16x32_bf16 v[192:195], v[244:247], v[56:59], v[192:195]
    v_mfma_f32_16x16x32_bf16 v[196:199], v[244:247], v[60:63], v[196:199]
    ds_read_b128 v[236:239], v5 offset:13312
    s_waitcnt lgkmcnt(3)
    v_mfma_f32_16x16x32_bf16 v[184:187], v[224:227], v[64:67], v[184:187]
    v_mfma_f32_16x16x32_bf16 v[188:191], v[224:227], v[68:71], v[188:191]
    ds_read_b128 v[240:243], v5 offset:14336
    s_waitcnt lgkmcnt(3)
    v_mfma_f32_16x16x32_bf16 v[192:195], v[228:231], v[64:67], v[192:195]
    v_mfma_f32_16x16x32_bf16 v[196:199], v[228:231], v[68:71], v[196:199]
    ds_read_b128 v[244:247], v5 offset:15360
    s_waitcnt lgkmcnt(3)
    v_mfma_f32_16x16x32_bf16 v[184:187], v[232:235], v[72:75], v[184:187]
    v_mfma_f32_16x16x32_bf16 v[188:191], v[232:235], v[76:79], v[188:191]
    s_waitcnt vmcnt(7)
    s_barrier
    ds_read_b128 v[224:227], v5 offset:16384
    s_waitcnt lgkmcnt(3)
    v_mfma_f32_16x16x32_bf16 v[192:195], v[236:239], v[72:75], v[192:195]
    v_mfma_f32_16x16x32_bf16 v[196:199], v[236:239], v[76:79], v[196:199]
    s_add_u32 s22, s21, 0x94000
    s_add_u32 m0, s20, 0x1c000
    s_nop 0
    buffer_load_dwordx4 v2, s[8:11], s22 offen sc1 lds
    ds_read_b128 v[228:231], v5 offset:17408
    s_waitcnt lgkmcnt(3)
    v_mfma_f32_16x16x32_bf16 v[184:187], v[240:243], v[80:83], v[184:187]
    v_mfma_f32_16x16x32_bf16 v[188:191], v[240:243], v[84:87], v[188:191]
    ds_read_b128 v[232:235], v5 offset:18432
    s_waitcnt lgkmcnt(3)
    v_mfma_f32_16x16x32_bf16 v[192:195], v[244:247], v[80:83], v[192:195]
    v_mfma_f32_16x16x32_bf16 v[196:199], v[244:247], v[84:87], v[196:199]
    ds_read_b128 v[236:239], v5 offset:19456
    s_waitcnt lgkmcnt(3)
    v_mfma_f32_16x16x32_bf16 v[184:187], v[224:227], v[88:91], v[184:187]
    v_mfma_f32_16x16x32_bf16 v[188:191], v[224:227], v[92:95], v[188:191]
    ds_read_b128 v[240:243], v5 offset:20480
    s_waitcnt lgkmcnt(3)
    v_mfma_f32_16x16x32_bf16 v[192:195], v[228:231], v[88:91], v[192:195]
    v_mfma_f32_16x16x32_bf16 v[196:199], v[228:231], v[92:95], v[196:199]
    s_add_u32 s22, s21, 0x94400
    s_add_u32 m0, s20, 0x1c400
    s_nop 0
    buffer_load_dwordx4 v2, s[8:11], s22 offen sc1 lds
    ds_read_b128 v[244:247], v5 offset:21504
    s_waitcnt lgkmcnt(3)
    v_mfma_f32_16x16x32_bf16 v[184:187], v[232:235], v[96:99], v[184:187]
    v_mfma_f32_16x16x32_bf16 v[188:191], v[232:235], v[100:103], v[188:191]
    ds_read_b128 v[224:227], v5 offset:22528
    s_waitcnt lgkmcnt(3)
    v_mfma_f32_16x16x32_bf16 v[192:195], v[236:239], v[96:99], v[192:195]
    v_mfma_f32_16x16x32_bf16 v[196:199], v[236:239], v[100:103], v[196:199]
    ds_read_b128 v[228:231], v5 offset:23552
    s_waitcnt lgkmcnt(3)
    v_mfma_f32_16x16x32_bf16 v[184:187], v[240:243], v[104:107], v[184:187]
    v_mfma_f32_16x16x32_bf16 v[188:191], v[240:243], v[108:111], v[188:191]
    ds_read_b128 v[232:235], v5 offset:24576
    s_waitcnt lgkmcnt(3)
    v_mfma_f32_16x16x32_bf16 v[192:195], v[244:247], v[104:107], v[192:195]
    v_mfma_f32_16x16x32_bf16 v[196:199], v[244:247], v[108:111], v[196:199]
    ds_read_b128 v[236:239], v5 offset:25600
    s_waitcnt lgkmcnt(3)
    v_mfma_f32_16x16x32_bf16 v[184:187], v[224:227], v[112:115], v[184:187]
    s_waitcnt vmcnt(2)
    v_cmp_ne_u32 vcc, s28, v248
    s_cbranch_vccnz adaLN_cond__sliding_block_cached__moe_arch_mod__prompt_kernel_mp5r
adaLN_cond__sliding_block_cached__moe_arch_mod__prompt_kernel_mp5b:
    v_mfma_f32_16x16x32_bf16 v[188:191], v[224:227], v[116:119], v[188:191]
    ds_read_b128 v[240:243], v5 offset:26624
    v_lshrrev_b32 v250, 4, v1
    v_lshlrev_b32 v250, 14, v250
    v_and_b32 v253, 15, v1
    v_lshl_add_u32 v250, v253, 2, v250
    s_lshl_b32 s14, s2, 6
    s_add_u32 s14, s14, 0x580000
    buffer_load_dword v249, v250, s[8:11], s14 offen sc1
    s_add_u32 s14, s14, 0x10000
    buffer_load_dword v254, v250, s[8:11], s14 offen sc1
    s_waitcnt lgkmcnt(3)
    v_mfma_f32_16x16x32_bf16 v[192:195], v[228:231], v[112:115], v[192:195]
    v_mfma_f32_16x16x32_bf16 v[196:199], v[228:231], v[116:119], v[196:199]
    ds_read_b128 v[244:247], v5 offset:27648
    s_waitcnt lgkmcnt(3)
    v_mfma_f32_16x16x32_bf16 v[184:187], v[232:235], v[120:123], v[184:187]
    v_mfma_f32_16x16x32_bf16 v[188:191], v[232:235], v[124:127], v[188:191]
    ds_read_b128 v[224:227], v5 offset:28672
    s_waitcnt lgkmcnt(3)
    v_mfma_f32_16x16x32_bf16 v[192:195], v[236:239], v[120:123], v[192:195]
    v_mfma_f32_16x16x32_bf16 v[196:199], v[236:239], v[124:127], v[196:199]
    ds_read_b128 v[228:231], v5 offset:29696
    s_waitcnt lgkmcnt(3)
    v_mfma_f32_16x16x32_bf16 v[184:187], v[240:243], v[128:131], v[184:187]
    v_mfma_f32_16x16x32_bf16 v[188:191], v[240:243], v[132:135], v[188:191]
    ds_read_b128 v[232:235], v5 offset:30720
    s_waitcnt lgkmcnt(3)
    v_mfma_f32_16x16x32_bf16 v[192:195], v[244:247], v[128:131], v[192:195]
    v_mfma_f32_16x16x32_bf16 v[196:199], v[244:247], v[132:135], v[196:199]
    ds_read_b128 v[236:239], v5 offset:31744
    s_waitcnt lgkmcnt(3)
    v_mfma_f32_16x16x32_bf16 v[184:187], v[224:227], v[136:139], v[184:187]
    v_mfma_f32_16x16x32_bf16 v[188:191], v[224:227], v[140:143], v[188:191]
    s_barrier
    ds_read_b128 v[240:243], v4 offset:0
    s_waitcnt lgkmcnt(3)
    v_mfma_f32_16x16x32_bf16 v[192:195], v[228:231], v[136:139], v[192:195]
    v_mfma_f32_16x16x32_bf16 v[196:199], v[228:231], v[140:143], v[196:199]
    s_add_u32 s22, s21, 0x98000
    s_add_u32 m0, s20, 0x20000
    s_nop 0
    buffer_load_dwordx4 v2, s[8:11], s22 offen sc1 lds
    ds_read_b128 v[244:247], v4 offset:1024
    s_waitcnt lgkmcnt(3)
    v_mfma_f32_16x16x32_bf16 v[184:187], v[232:235], v[144:147], v[184:187]
    v_mfma_f32_16x16x32_bf16 v[188:191], v[232:235], v[148:151], v[188:191]
    ds_read_b128 v[224:227], v4 offset:2048
    s_waitcnt lgkmcnt(3)
    v_mfma_f32_16x16x32_bf16 v[192:195], v[236:239], v[144:147], v[192:195]
    v_mfma_f32_16x16x32_bf16 v[196:199], v[236:239], v[148:151], v[196:199]
    ds_read_b128 v[228:231], v4 offset:3072
    s_waitcnt lgkmcnt(3)
    v_mfma_f32_16x16x32_bf16 v[200:203], v[240:243], v[24:27], 0
    v_mfma_f32_16x16x32_bf16 v[204:207], v[240:243], v[28:31], 0
    ds_read_b128 v[232:235], v4 offset:4096
    s_waitcnt lgkmcnt(3)
    v_mfma_f32_16x16x32_bf16 v[208:211], v[244:247], v[24:27], 0
    v_mfma_f32_16x16x32_bf16 v[212:215], v[244:247], v[28:31], 0
    s_add_u32 s22, s21, 0x98400
    s_add_u32 m0, s20, 0x20400
    s_nop 0
    buffer_load_dwordx4 v2, s[8:11], s22 offen sc1 lds
    ds_read_b128 v[236:239], v4 offset:5120
    v_mul_f32 v184, v184, v9
    s_waitcnt lgkmcnt(3)
    v_mfma_f32_16x16x32_bf16 v[200:203], v[224:227], v[32:35], v[200:203]
    v_mul_f32 v185, v185, v9
    s_waitcnt vmcnt(2)
    v_add_f32 v249, v249, v254
    v_mov_b32 v250, v249
    s_nop 1
    v_permlane16_swap_b32 v249, v250
    v_add_f32 v249, v249, v250
    v_mov_b32 v250, v249
    s_nop 1
    v_permlane32_swap_b32 v249, v250
    v_add_f32 v249, v249, v250
    v_cvt_pk_bf16_f32 v249, v249, v249
    v_lshlrev_b32 v249, 16, v249
    s_lshr_b32 s14, s2, 6
    s_cmp_eq_u32 s14, 2
    s_cselect_b32 s14, 1.0, 0
    v_add_f32 v249, s14, v249
    v_cvt_pk_bf16_f32 v249, v249, v249
    v_lshlrev_b32 v253, 1, v253
    s_lshl_b32 s14, s2, 5
    s_add_u32 s14, s14, 0x540000
    s_cmp_eq_u32 s3, 0
    s_cselect_b32 s14, s14, 0x7ffffff0
    s_mov_b64 exec, 0xffff
    buffer_store_short v249, v253, s[8:11], s14 offen sc1
    s_mov_b64 exec, -1
    v_mfma_f32_16x16x32_bf16 v[204:207], v[224:227], v[36:39], v[204:207]
    ds_read_b128 v[240:243], v4 offset:6144
    v_mul_f32 v186, v186, v9
    s_waitcnt lgkmcnt(3)
    v_mfma_f32_16x16x32_bf16 v[208:211], v[228:231], v[32:35], v[208:211]
    v_mul_f32 v187, v187, v9
    v_mfma_f32_16x16x32_bf16 v[212:215], v[228:231], v[36:39], v[212:215]
    ds_read_b128 v[244:247], v4 offset:7168
    v_mul_f32 v192, v192, v9
    s_waitcnt lgkmcnt(3)
    v_mfma_f32_16x16x32_bf16 v[200:203], v[232:235], v[40:43], v[200:203]
    v_mul_f32 v193, v193, v9
    v_mfma_f32_16x16x32_bf16 v[204:207], v[232:235], v[44:47], v[204:207]
    ds_read_b128 v[224:227], v4 offset:8192
    v_mul_f32 v194, v194, v9
    s_waitcnt lgkmcnt(3)
    v_mfma_f32_16x16x32_bf16 v[208:211], v[236:239], v[40:43], v[208:211]
    v_mul_f32 v195, v195, v9
    v_mfma_f32_16x16x32_bf16 v[212:215], v[236:239], v[44:47], v[212:215]
    ds_read_b128 v[228:231], v4 offset:9216
    v_cvt_pk_bf16_f32 v216, v184, v185
    s_waitcnt lgkmcnt(3)
    v_mfma_f32_16x16x32_bf16 v[200:203], v[240:243], v[48:51], v[200:203]
    v_cvt_pk_bf16_f32 v217, v186, v187
    v_mfma_f32_16x16x32_bf16 v[204:207], v[240:243], v[52:55], v[204:207]
    ds_read_b128 v[232:235], v4 offset:10240
    v_cvt_pk_bf16_f32 v218, v192, v193
    s_waitcnt lgkmcnt(3)
    v_mfma_f32_16x16x32_bf16 v[208:211], v[244:247], v[48:51], v[208:211]
    v_cvt_pk_bf16_f32 v219, v194, v195
    v_mfma_f32_16x16x32_bf16 v[212:215], v[244:247], v[52:55], v[212:215]
    ds_read_b128 v[236:239], v4 offset:11264
    buffer_store_dwordx4 v[216:219], v2, s[8:11], s25 offen offset:0 sc1
    s_waitcnt lgkmcnt(3)
    v_mfma_f32_16x16x32_bf16 v[200:203], v[224:227], v[56:59], v[200:203]
    v_mul_f32 v188, v188, v10
    v_mfma_f32_16x16x32_bf16 v[204:207], v[224:227], v[60:63], v[204:207]
    ds_read_b128 v[240:243], v4 offset:12288
    v_mul_f32 v189, v189, v10
    s_waitcnt lgkmcnt(3)
    v_mfma_f32_16x16x32_bf16 v[208:211], v[228:231], v[56:59], v[208:211]
    v_mul_f32 v190, v190, v10
    v_mfma_f32_16x16x32_bf16 v[212:215], v[228:231], v[60:63], v[212:215]
    ds_read_b128 v[244:247], v4 offset:13312
    v_mul_f32 v191, v191, v10
    s_waitcnt lgkmcnt(3)
    v_mfma_f32_16x16x32_bf16 v[200:203], v[232:235], v[64:67], v[200:203]
    v_mul_f32 v196, v196, v10
    v_mfma_f32_16x16x32_bf16 v[204:207], v[232:235], v[68:71], v[204:207]
    ds_read_b128 v[224:227], v4 offset:14336
    v_mul_f32 v197, v197, v10
    s_waitcnt lgkmcnt(3)
    v_mfma_f32_16x16x32_bf16 v[208:211], v[236:239], v[64:67], v[208:211]
    v_mul_f32 v198, v198, v10
    v_mfma_f32_16x16x32_bf16 v[212:215], v[236:239], v[68:71], v[212:215]
    ds_read_b128 v[228:231], v4 offset:15360
    v_mul_f32 v199, v199, v10
    s_waitcnt lgkmcnt(3)
    v_mfma_f32_16x16x32_bf16 v[200:203], v[240:243], v[72:75], v[200:203]
    v_cvt_pk_bf16_f32 v220, v188, v189
    v_mfma_f32_16x16x32_bf16 v[204:207], v[240:243], v[76:79], v[204:207]
    s_barrier
    ds_read_b128 v[232:235], v4 offset:16384
    v_cvt_pk_bf16_f32 v221, v190, v191
    s_waitcnt lgkmcnt(3)
    v_mfma_f32_16x16x32_bf16 v[208:211], v[244:247], v[72:75], v[208:211]
    v_cvt_pk_bf16_f32 v222, v196, v197
    v_mfma_f32_16x16x32_bf16 v[212:215], v[244:247], v[76:79], v[212:215]
    s_add_u32 s22, s21, 0x9c000
    s_add_u32 m0, s20, 0x24000
    s_nop 0
    buffer_load_dwordx4 v2, s[8:11], s22 offen sc1 lds
    ds_read_b128 v[236:239], v4 offset:17408
    v_cvt_pk_bf16_f32 v223, v198, v199
    s_waitcnt lgkmcnt(3)
    v_mfma_f32_16x16x32_bf16 v[200:203], v[224:227], v[80:83], v[200:203]
    buffer_store_dwordx4 v[220:223], v2, s[8:11], s26 offen offset:0 sc1
    v_mfma_f32_16x16x32_bf16 v[204:207], v[224:227], v[84:87], v[204:207]
    ds_read_b128 v[240:243], v4 offset:18432
    s_waitcnt lgkmcnt(3)
    v_mfma_f32_16x16x32_bf16 v[208:211], v[228:231], v[80:83], v[208:211]
    v_mfma_f32_16x16x32_bf16 v[212:215], v[228:231], v[84:87], v[212:215]
    ds_read_b128 v[244:247], v4 offset:19456
    s_waitcnt lgkmcnt(3)
    v_mfma_f32_16x16x32_bf16 v[200:203], v[232:235], v[88:91], v[200:203]
    v_mfma_f32_16x16x32_bf16 v[204:207], v[232:235], v[92:95], v[204:207]
    ds_read_b128 v[224:227], v4 offset:20480
    s_waitcnt lgkmcnt(3)
    v_mfma_f32_16x16x32_bf16 v[208:211], v[236:239], v[88:91], v[208:211]
    v_mfma_f32_16x16x32_bf16 v[212:215], v[236:239], v[92:95], v[212:215]
    s_add_u32 s22, s21, 0x9c400
    s_add_u32 m0, s20, 0x24400
    s_nop 0
    buffer_load_dwordx4 v2, s[8:11], s22 offen sc1 lds
    ds_read_b128 v[228:231], v4 offset:21504
    s_waitcnt lgkmcnt(3)
    v_mfma_f32_16x16x32_bf16 v[200:203], v[240:243], v[96:99], v[200:203]
    v_mfma_f32_16x16x32_bf16 v[204:207], v[240:243], v[100:103], v[204:207]
    ds_read_b128 v[232:235], v4 offset:22528
    s_waitcnt lgkmcnt(3)
    v_mfma_f32_16x16x32_bf16 v[208:211], v[244:247], v[96:99], v[208:211]
    v_mfma_f32_16x16x32_bf16 v[212:215], v[244:247], v[100:103], v[212:215]
    ds_read_b128 v[236:239], v4 offset:23552
    s_waitcnt lgkmcnt(3)
    v_mfma_f32_16x16x32_bf16 v[200:203], v[224:227], v[104:107], v[200:203]
    v_mfma_f32_16x16x32_bf16 v[204:207], v[224:227], v[108:111], v[204:207]
    ds_read_b128 v[240:243], v4 offset:24576
    s_waitcnt lgkmcnt(3)
    v_mfma_f32_16x16x32_bf16 v[208:211], v[228:231], v[104:107], v[208:211]
    v_mfma_f32_16x16x32_bf16 v[212:215], v[228:231], v[108:111], v[212:215]
    ds_read_b128 v[244:247], v4 offset:25600
    s_waitcnt lgkmcnt(3)
    v_mfma_f32_16x16x32_bf16 v[200:203], v[232:235], v[112:115], v[200:203]
    s_waitcnt vmcnt(4)
    v_mov_b32 v248, s28
    v_mov_b32 v249, 0
    s_lshl_b32 s14, s2, 2
    s_add_u32 s14, s14, 0x544000
    s_cmp_eq_u32 s3, 0
    s_cselect_b32 s14, s14, 0x7ffffff0
    s_mov_b64 exec, 1
    buffer_store_dword v248, v249, s[8:11], s14 offen sc1
    s_mov_b64 exec, -1
    v_mfma_f32_16x16x32_bf16 v[204:207], v[232:235], v[116:119], v[204:207]
    ds_read_b128 v[224:227], v4 offset:26624
    s_waitcnt lgkmcnt(3)
    v_mfma_f32_16x16x32_bf16 v[208:211], v[236:239], v[112:115], v[208:211]
    v_mfma_f32_16x16x32_bf16 v[212:215], v[236:239], v[116:119], v[212:215]
    ds_read_b128 v[228:231], v4 offset:27648
    s_waitcnt lgkmcnt(3)
    v_mfma_f32_16x16x32_bf16 v[200:203], v[240:243], v[120:123], v[200:203]
    v_mfma_f32_16x16x32_bf16 v[204:207], v[240:243], v[124:127], v[204:207]
    ds_read_b128 v[232:235], v4 offset:28672
    s_waitcnt lgkmcnt(3)
    v_mfma_f32_16x16x32_bf16 v[208:211], v[244:247], v[120:123], v[208:211]
    v_mfma_f32_16x16x32_bf16 v[212:215], v[244:247], v[124:127], v[212:215]
    ds_read_b128 v[236:239], v4 offset:29696
    s_waitcnt lgkmcnt(3)
    v_mfma_f32_16x16x32_bf16 v[200:203], v[224:227], v[128:131], v[200:203]
    v_mfma_f32_16x16x32_bf16 v[204:207], v[224:227], v[132:135], v[204:207]
    ds_read_b128 v[240:243], v4 offset:30720
    s_waitcnt lgkmcnt(3)
    v_mfma_f32_16x16x32_bf16 v[208:211], v[228:231], v[128:131], v[208:211]
    v_mfma_f32_16x16x32_bf16 v[212:215], v[228:231], v[132:135], v[212:215]
    ds_read_b128 v[244:247], v4 offset:31744
    s_waitcnt lgkmcnt(3)
    v_mfma_f32_16x16x32_bf16 v[200:203], v[232:235], v[136:139], v[200:203]
    v_mfma_f32_16x16x32_bf16 v[204:207], v[232:235], v[140:143], v[204:207]
    s_barrier
    ds_read_b128 v[224:227], v4 offset:32768
    s_waitcnt lgkmcnt(3)
    v_mfma_f32_16x16x32_bf16 v[208:211], v[236:239], v[136:139], v[208:211]
    v_mfma_f32_16x16x32_bf16 v[212:215], v[236:239], v[140:143], v[212:215]
    s_add_u32 s22, s24, 0x0
    s_add_u32 m0, s20, 0x10000
    s_nop 0
    buffer_load_dwordx4 v3, s[4:7], s22 offen lds
    ds_read_b128 v[228:231], v4 offset:33792
    s_waitcnt lgkmcnt(3)
    v_mfma_f32_16x16x32_bf16 v[200:203], v[240:243], v[144:147], v[200:203]
    v_mfma_f32_16x16x32_bf16 v[204:207], v[240:243], v[148:151], v[204:207]
    ds_read_b128 v[232:235], v4 offset:34816
    s_waitcnt lgkmcnt(3)
    v_mfma_f32_16x16x32_bf16 v[208:211], v[244:247], v[144:147], v[208:211]
    v_mfma_f32_16x16x32_bf16 v[212:215], v[244:247], v[148:151], v[212:215]
    ds_read_b128 v[236:239], v4 offset:35840
    s_waitcnt lgkmcnt(3)
    v_mfma_f32_16x16x32_bf16 v[184:187], v[224:227], v[24:27], 0
    v_mfma_f32_16x16x32_bf16 v[188:191], v[224:227], v[28:31], 0
    ds_read_b128 v[240:243], v4 offset:36864
    s_waitcnt lgkmcnt(3)
    v_mfma_f32_16x16x32_bf16 v[192:195], v[228:231], v[24:27], 0
    v_mfma_f32_16x16x32_bf16 v[196:199], v[228:231], v[28:31], 0
    s_add_u32 s22, s24, 0x2000
    s_add_u32 m0, s20, 0x10400
    s_nop 0
    buffer_load_dwordx4 v3, s[4:7], s22 offen lds
    ds_read_b128 v[244:247], v4 offset:37888
    v_mul_f32 v200, v200, v9
    s_waitcnt lgkmcnt(3)
    v_mfma_f32_16x16x32_bf16 v[184:187], v[232:235], v[32:35], v[184:187]
    v_mul_f32 v201, v201, v9
    v_mfma_f32_16x16x32_bf16 v[188:191], v[232:235], v[36:39], v[188:191]
    ds_read_b128 v[224:227], v4 offset:38912
    v_mul_f32 v202, v202, v9
    s_waitcnt lgkmcnt(3)
    v_mfma_f32_16x16x32_bf16 v[192:195], v[236:239], v[32:35], v[192:195]
    v_mul_f32 v203, v203, v9
    v_mfma_f32_16x16x32_bf16 v[196:199], v[236:239], v[36:39], v[196:199]
    ds_read_b128 v[228:231], v4 offset:39936
    v_mul_f32 v208, v208, v9
    s_waitcnt lgkmcnt(3)
    v_mfma_f32_16x16x32_bf16 v[184:187], v[240:243], v[40:43], v[184:187]
    v_mul_f32 v209, v209, v9
    v_mfma_f32_16x16x32_bf16 v[188:191], v[240:243], v[44:47], v[188:191]
    ds_read_b128 v[232:235], v4 offset:40960
    v_mul_f32 v210, v210, v9
    s_waitcnt lgkmcnt(3)
    v_mfma_f32_16x16x32_bf16 v[192:195], v[244:247], v[40:43], v[192:195]
    v_mul_f32 v211, v211, v9
    v_mfma_f32_16x16x32_bf16 v[196:199], v[244:247], v[44:47], v[196:199]
    ds_read_b128 v[236:239], v4 offset:41984
    v_cvt_pk_bf16_f32 v216, v200, v201
    s_waitcnt lgkmcnt(3)
    v_mfma_f32_16x16x32_bf16 v[184:187], v[224:227], v[48:51], v[184:187]
    v_cvt_pk_bf16_f32 v217, v202, v203
    s_waitcnt vmcnt(4)
    s_add_u32 s16, s63, 0x570000
    v_mov_b32 v7, s28
    v_mov_b32 v8, 0
    s_mov_b64 exec, 1
    buffer_store_dword v7, v8, s[8:11], s16 offen sc1
    s_mov_b64 exec, -1
    v_mfma_f32_16x16x32_bf16 v[188:191], v[224:227], v[52:55], v[188:191]
    ds_read_b128 v[240:243], v4 offset:43008
    v_cvt_pk_bf16_f32 v218, v208, v209
    s_waitcnt lgkmcnt(3)
    v_mfma_f32_16x16x32_bf16 v[192:195], v[228:231], v[48:51], v[192:195]
    v_cvt_pk_bf16_f32 v219, v210, v211
    v_mfma_f32_16x16x32_bf16 v[196:199], v[228:231], v[52:55], v[196:199]
    ds_read_b128 v[244:247], v4 offset:44032
    buffer_store_dwordx4 v[216:219], v2, s[8:11], s25 offen offset:1024 sc1
    s_waitcnt lgkmcnt(3)
    v_mfma_f32_16x16x32_bf16 v[184:187], v[232:235], v[56:59], v[184:187]
    v_mul_f32 v204, v204, v10
    v_mfma_f32_16x16x32_bf16 v[188:191], v[232:235], v[60:63], v[188:191]
    ds_read_b128 v[224:227], v4 offset:45056
    v_mul_f32 v205, v205, v10
    s_waitcnt lgkmcnt(3)
    v_mfma_f32_16x16x32_bf16 v[192:195], v[236:239], v[56:59], v[192:195]
    v_mul_f32 v206, v206, v10
    v_mfma_f32_16x16x32_bf16 v[196:199], v[236:239], v[60:63], v[196:199]
    ds_read_b128 v[228:231], v4 offset:46080
    v_mul_f32 v207, v207, v10
    s_waitcnt lgkmcnt(3)
    v_mfma_f32_16x16x32_bf16 v[184:187], v[240:243], v[64:67], v[184:187]
    v_mul_f32 v212, v212, v10
    v_mfma_f32_16x16x32_bf16 v[188:191], v[240:243], v[68:71], v[188:191]
    ds_read_b128 v[232:235], v4 offset:47104
    v_mul_f32 v213, v213, v10
    s_waitcnt lgkmcnt(3)
    v_mfma_f32_16x16x32_bf16 v[192:195], v[244:247], v[64:67], v[192:195]
    v_mul_f32 v214, v214, v10
    v_mfma_f32_16x16x32_bf16 v[196:199], v[244:247], v[68:71], v[196:199]
    ds_read_b128 v[236:239], v4 offset:48128
    v_mul_f32 v215, v215, v10
    s_waitcnt lgkmcnt(3)
    v_mfma_f32_16x16x32_bf16 v[184:187], v[224:227], v[72:75], v[184:187]
    v_cvt_pk_bf16_f32 v220, v204, v205
    v_mfma_f32_16x16x32_bf16 v[188:191], v[224:227], v[76:79], v[188:191]
    s_barrier
    ds_read_b128 v[240:243], v4 offset:49152
    v_cvt_pk_bf16_f32 v221, v206, v207
    s_waitcnt lgkmcnt(3)
    v_mfma_f32_16x16x32_bf16 v[192:195], v[228:231], v[72:75], v[192:195]
    v_cvt_pk_bf16_f32 v222, v212, v213
    v_mfma_f32_16x16x32_bf16 v[196:199], v[228:231], v[76:79], v[196:199]
    s_add_u32 s22, s24, 0x80000
    s_add_u32 m0, s20, 0x14000
    s_nop 0
    buffer_load_dwordx4 v3, s[4:7], s22 offen lds
    ds_read_b128 v[244:247], v4 offset:50176
    v_cvt_pk_bf16_f32 v223, v214, v215
    s_waitcnt lgkmcnt(3)
    v_mfma_f32_16x16x32_bf16 v[184:187], v[232:235], v[80:83], v[184:187]
    buffer_store_dwordx4 v[220:223], v2, s[8:11], s26 offen offset:1024 sc1
    v_mfma_f32_16x16x32_bf16 v[188:191], v[232:235], v[84:87], v[188:191]
    ds_read_b128 v[224:227], v4 offset:51200
    s_waitcnt lgkmcnt(3)
    v_mfma_f32_16x16x32_bf16 v[192:195], v[236:239], v[80:83], v[192:195]
    v_mfma_f32_16x16x32_bf16 v[196:199], v[236:239], v[84:87], v[196:199]
    ds_read_b128 v[228:231], v4 offset:52224
    s_waitcnt lgkmcnt(3)
    v_mfma_f32_16x16x32_bf16 v[184:187], v[240:243], v[88:91], v[184:187]
    v_mfma_f32_16x16x32_bf16 v[188:191], v[240:243], v[92:95], v[188:191]
    ds_read_b128 v[232:235], v4 offset:53248
    s_waitcnt lgkmcnt(3)
    v_mfma_f32_16x16x32_bf16 v[192:195], v[244:247], v[88:91], v[192:195]
    v_mfma_f32_16x16x32_bf16 v[196:199], v[244:247], v[92:95], v[196:199]
    s_add_u32 s22, s24, 0x82000
    s_add_u32 m0, s20, 0x14400
    s_nop 0
    buffer_load_dwordx4 v3, s[4:7], s22 offen lds
    ds_read_b128 v[236:239], v4 offset:54272
    s_waitcnt lgkmcnt(3)
    v_mfma_f32_16x16x32_bf16 v[184:187], v[224:227], v[96:99], v[184:187]
    v_mfma_f32_16x16x32_bf16 v[188:191], v[224:227], v[100:103], v[188:191]
    ds_read_b128 v[240:243], v4 offset:55296
    s_waitcnt lgkmcnt(3)
    v_mfma_f32_16x16x32_bf16 v[192:195], v[228:231], v[96:99], v[192:195]
    v_mfma_f32_16x16x32_bf16 v[196:199], v[228:231], v[100:103], v[196:199]
    ds_read_b128 v[244:247], v4 offset:56320
    s_waitcnt lgkmcnt(3)
    v_mfma_f32_16x16x32_bf16 v[184:187], v[232:235], v[104:107], v[184:187]
    v_mfma_f32_16x16x32_bf16 v[188:191], v[232:235], v[108:111], v[188:191]
    ds_read_b128 v[224:227], v4 offset:57344
    s_waitcnt lgkmcnt(3)
    v_mfma_f32_16x16x32_bf16 v[192:195], v[236:239], v[104:107], v[192:195]
    v_mfma_f32_16x16x32_bf16 v[196:199], v[236:239], v[108:111], v[196:199]
    ds_read_b128 v[228:231], v4 offset:58368
    s_waitcnt lgkmcnt(3)
    v_mfma_f32_16x16x32_bf16 v[184:187], v[240:243], v[112:115], v[184:187]
    v_mfma_f32_16x16x32_bf16 v[188:191], v[240:243], v[116:119], v[188:191]
    ds_read_b128 v[232:235], v4 offset:59392
    s_waitcnt lgkmcnt(3)
    v_mfma_f32_16x16x32_bf16 v[192:195], v[244:247], v[112:115], v[192:195]
    v_mfma_f32_16x16x32_bf16 v[196:199], v[244:247], v[116:119], v[196:199]
    ds_read_b128 v[236:239], v4 offset:60416
    s_waitcnt lgkmcnt(3)
    v_mfma_f32_16x16x32_bf16 v[184:187], v[224:227], v[120:123], v[184:187]
    v_mfma_f32_16x16x32_bf16 v[188:191], v[224:227], v[124:127], v[188:191]
    ds_read_b128 v[240:243], v4 offset:61440
    s_waitcnt lgkmcnt(3)
    v_mfma_f32_16x16x32_bf16 v[192:195], v[228:231], v[120:123], v[192:195]
    v_mfma_f32_16x16x32_bf16 v[196:199], v[228:231], v[124:127], v[196:199]
    ds_read_b128 v[244:247], v4 offset:62464
    s_waitcnt lgkmcnt(3)
    v_mfma_f32_16x16x32_bf16 v[184:187], v[232:235], v[128:131], v[184:187]
    v_mfma_f32_16x16x32_bf16 v[188:191], v[232:235], v[132:135], v[188:191]
    ds_read_b128 v[224:227], v4 offset:63488
    s_waitcnt lgkmcnt(3)
    v_mfma_f32_16x16x32_bf16 v[192:195], v[236:239], v[128:131], v[192:195]
    v_mfma_f32_16x16x32_bf16 v[196:199], v[236:239], v[132:135], v[196:199]
    ds_read_b128 v[228:231], v4 offset:64512
    s_waitcnt lgkmcnt(3)
    v_mfma_f32_16x16x32_bf16 v[184:187], v[240:243], v[136:139], v[184:187]
    v_mfma_f32_16x16x32_bf16 v[188:191], v[240:243], v[140:143], v[188:191]
    s_barrier
    ds_read_b128 v[232:235], v5 offset:0
    s_waitcnt lgkmcnt(3)
    v_mfma_f32_16x16x32_bf16 v[192:195], v[244:247], v[136:139], v[192:195]
    v_mfma_f32_16x16x32_bf16 v[196:199], v[244:247], v[140:143], v[196:199]
    s_add_u32 s22, s24, 0x100000
    s_add_u32 m0, s20, 0x18000
    s_nop 0
    buffer_load_dwordx4 v3, s[4:7], s22 offen lds
    ds_read_b128 v[236:239], v5 offset:1024
    s_waitcnt lgkmcnt(3)
    v_mfma_f32_16x16x32_bf16 v[184:187], v[224:227], v[144:147], v[184:187]
    v_mfma_f32_16x16x32_bf16 v[188:191], v[224:227], v[148:151], v[188:191]
    ds_read_b128 v[240:243], v5 offset:2048
    s_waitcnt lgkmcnt(3)
    v_mfma_f32_16x16x32_bf16 v[192:195], v[228:231], v[144:147], v[192:195]
    v_mfma_f32_16x16x32_bf16 v[196:199], v[228:231], v[148:151], v[196:199]
    ds_read_b128 v[244:247], v5 offset:3072
    s_waitcnt lgkmcnt(3)
    v_mfma_f32_16x16x32_bf16 v[200:203], v[232:235], v[24:27], 0
    v_mfma_f32_16x16x32_bf16 v[204:207], v[232:235], v[28:31], 0
    ds_read_b128 v[224:227], v5 offset:4096
    s_waitcnt lgkmcnt(3)
    v_mfma_f32_16x16x32_bf16 v[208:211], v[236:239], v[24:27], 0
    v_mfma_f32_16x16x32_bf16 v[212:215], v[236:239], v[28:31], 0
    s_add_u32 s22, s24, 0x102000
    s_add_u32 m0, s20, 0x18400
    s_nop 0
    buffer_load_dwordx4 v3, s[4:7], s22 offen lds
    ds_read_b128 v[228:231], v5 offset:5120
    v_mul_f32 v184, v184, v9
    s_waitcnt lgkmcnt(3)
    v_mfma_f32_16x16x32_bf16 v[200:203], v[240:243], v[32:35], v[200:203]
    v_mul_f32 v185, v185, v9
    s_bfe_u32 s30, s2, 0x20001
    s_lshl_b32 s30, s30, 2
    s_bfe_u32 s17, s2, 0x20003
    s_add_u32 s30, s30, s17
    s_lshr_b32 s31, s2, 5
    s_and_b32 s17, s3, 3
    s_lshl_b32 s19, s30, 2
    s_add_u32 s19, s19, s17
    s_and_b32 s16, s2, 1
    s_lshl_b32 s17, s19, 18
    s_lshl_b32 s23, s16, 16
    s_add_u32 s17, s17, s23
    s_add_u32 s17, s17, 0x1000000
    v_add_u32 v6, s17, v2
    s_lshl_b32 s19, s19, 7
    s_lshl_b32 s23, s16, 6
    s_add_u32 s19, s19, s23
    s_add_u32 s19, s19, 0x570000
    v_and_b32 v13, 15, v1
    v_lshlrev_b32 v13, 2, v13
    buffer_load_dword v12, v13, s[8:11], s19 offen sc1
    v_mfma_f32_16x16x32_bf16 v[204:207], v[240:243], v[36:39], v[204:207]
    ds_read_b128 v[232:235], v5 offset:6144
    v_mul_f32 v186, v186, v9
    s_waitcnt lgkmcnt(3)
    v_mfma_f32_16x16x32_bf16 v[208:211], v[244:247], v[32:35], v[208:211]
    v_mul_f32 v187, v187, v9
    v_mfma_f32_16x16x32_bf16 v[212:215], v[244:247], v[36:39], v[212:215]
    ds_read_b128 v[236:239], v5 offset:7168
    v_mul_f32 v192, v192, v9
    s_waitcnt lgkmcnt(3)
    v_mfma_f32_16x16x32_bf16 v[200:203], v[224:227], v[40:43], v[200:203]
    v_mul_f32 v193, v193, v9
    v_mfma_f32_16x16x32_bf16 v[204:207], v[224:227], v[44:47], v[204:207]
    ds_read_b128 v[240:243], v5 offset:8192
    v_mul_f32 v194, v194, v9
    s_waitcnt lgkmcnt(3)
    v_mfma_f32_16x16x32_bf16 v[208:211], v[228:231], v[40:43], v[208:211]
    v_mul_f32 v195, v195, v9
    v_mfma_f32_16x16x32_bf16 v[212:215], v[228:231], v[44:47], v[212:215]
    ds_read_b128 v[244:247], v5 offset:9216
    v_cvt_pk_bf16_f32 v216, v184, v185
    s_waitcnt lgkmcnt(3)
    v_mfma_f32_16x16x32_bf16 v[200:203], v[232:235], v[48:51], v[200:203]
    v_cvt_pk_bf16_f32 v217, v186, v187
    v_mfma_f32_16x16x32_bf16 v[204:207], v[232:235], v[52:55], v[204:207]
    ds_read_b128 v[224:227], v5 offset:10240
    v_cvt_pk_bf16_f32 v218, v192, v193
    s_waitcnt lgkmcnt(3)
    v_mfma_f32_16x16x32_bf16 v[208:211], v[236:239], v[48:51], v[208:211]
    v_cvt_pk_bf16_f32 v219, v194, v195
    v_mfma_f32_16x16x32_bf16 v[212:215], v[236:239], v[52:55], v[212:215]
    ds_read_b128 v[228:231], v5 offset:11264
    buffer_store_dwordx4 v[216:219], v2, s[8:11], s25 offen offset:2048 sc1
    s_waitcnt lgkmcnt(3)
    v_mfma_f32_16x16x32_bf16 v[200:203], v[240:243], v[56:59], v[200:203]
    v_mul_f32 v188, v188, v10
    v_mfma_f32_16x16x32_bf16 v[204:207], v[240:243], v[60:63], v[204:207]
    ds_read_b128 v[232:235], v5 offset:12288
    v_mul_f32 v189, v189, v10
    s_waitcnt lgkmcnt(3)
    v_mfma_f32_16x16x32_bf16 v[208:211], v[244:247], v[56:59], v[208:211]
    v_mul_f32 v190, v190, v10
    v_mfma_f32_16x16x32_bf16 v[212:215], v[244:247], v[60:63], v[212:215]
    ds_read_b128 v[236:239], v5 offset:13312
    v_mul_f32 v191, v191, v10
    s_waitcnt lgkmcnt(3)
    v_mfma_f32_16x16x32_bf16 v[200:203], v[224:227], v[64:67], v[200:203]
    v_mul_f32 v196, v196, v10
    v_mfma_f32_16x16x32_bf16 v[204:207], v[224:227], v[68:71], v[204:207]
    ds_read_b128 v[240:243], v5 offset:14336
    v_mul_f32 v197, v197, v10
    s_waitcnt lgkmcnt(3)
    v_mfma_f32_16x16x32_bf16 v[208:211], v[228:231], v[64:67], v[208:211]
    v_mul_f32 v198, v198, v10
    v_mfma_f32_16x16x32_bf16 v[212:215], v[228:231], v[68:71], v[212:215]
    ds_read_b128 v[244:247], v5 offset:15360
    v_mul_f32 v199, v199, v10
    s_waitcnt lgkmcnt(3)
    v_mfma_f32_16x16x32_bf16 v[200:203], v[232:235], v[72:75], v[200:203]
    v_cvt_pk_bf16_f32 v220, v188, v189
    v_mfma_f32_16x16x32_bf16 v[204:207], v[232:235], v[76:79], v[204:207]
    s_waitcnt vmcnt(12)
    s_barrier
    ds_read_b128 v[224:227], v5 offset:16384
    v_cvt_pk_bf16_f32 v221, v190, v191
    s_waitcnt lgkmcnt(3)
    v_mfma_f32_16x16x32_bf16 v[208:211], v[236:239], v[72:75], v[208:211]
    v_cvt_pk_bf16_f32 v222, v196, v197
    v_mfma_f32_16x16x32_bf16 v[212:215], v[236:239], v[76:79], v[212:215]
    s_add_u32 s22, s24, 0x180000
    s_add_u32 m0, s20, 0x1c000
    s_nop 0
    buffer_load_dwordx4 v3, s[4:7], s22 offen lds
    ds_read_b128 v[228:231], v5 offset:17408
    v_cvt_pk_bf16_f32 v223, v198, v199
    s_waitcnt lgkmcnt(3)
    v_mfma_f32_16x16x32_bf16 v[200:203], v[240:243], v[80:83], v[200:203]
    buffer_store_dwordx4 v[220:223], v2, s[8:11], s26 offen offset:2048 sc1
    v_mfma_f32_16x16x32_bf16 v[204:207], v[240:243], v[84:87], v[204:207]
    ds_read_b128 v[232:235], v5 offset:18432
    s_waitcnt lgkmcnt(3)
    v_mfma_f32_16x16x32_bf16 v[208:211], v[244:247], v[80:83], v[208:211]
    v_mfma_f32_16x16x32_bf16 v[212:215], v[244:247], v[84:87], v[212:215]
    ds_read_b128 v[236:239], v5 offset:19456
    s_waitcnt lgkmcnt(3)
    v_mfma_f32_16x16x32_bf16 v[200:203], v[224:227], v[88:91], v[200:203]
    v_mfma_f32_16x16x32_bf16 v[204:207], v[224:227], v[92:95], v[204:207]
    ds_read_b128 v[240:243], v5 offset:20480
    s_waitcnt vmcnt(3)
    v_cmp_ne_u32 vcc, s28, v12
    s_cbranch_vccnz adaLN_cond__sliding_block_cached__moe_arch_mod__prompt_kernel_o6r
adaLN_cond__sliding_block_cached__moe_arch_mod__prompt_kernel_o6b:
    s_waitcnt lgkmcnt(3)
    v_mfma_f32_16x16x32_bf16 v[208:211], v[228:231], v[88:91], v[208:211]
    s_mov_b32 s23, 0x0
    buffer_load_dwordx4 v[24:27], v6, s[8:11], s23 offen offset:0 sc1
    v_mfma_f32_16x16x32_bf16 v[212:215], v[228:231], v[92:95], v[212:215]
    s_add_u32 s22, s24, 0x182000
    s_add_u32 m0, s20, 0x1c400
    s_nop 0
    buffer_load_dwordx4 v3, s[4:7], s22 offen lds
    ds_read_b128 v[244:247], v5 offset:21504
    s_waitcnt lgkmcnt(3)
    v_mfma_f32_16x16x32_bf16 v[200:203], v[232:235], v[96:99], v[200:203]
    v_mfma_f32_16x16x32_bf16 v[204:207], v[232:235], v[100:103], v[204:207]
    ds_read_b128 v[224:227], v5 offset:22528
    s_mov_b32 s23, 0x20000
    buffer_load_dwordx4 v[28:31], v6, s[8:11], s23 offen offset:0 sc1
    s_waitcnt lgkmcnt(3)
    v_mfma_f32_16x16x32_bf16 v[208:211], v[236:239], v[96:99], v[208:211]
    s_add_u32 s16, s63, 0x572000
    v_mov_b32 v14, s28
    v_mov_b32 v15, 0
    s_mov_b64 exec, 1
    buffer_store_dword v14, v15, s[8:11], s16 offen sc1
    s_mov_b64 exec, -1
    v_mfma_f32_16x16x32_bf16 v[212:215], v[236:239], v[100:103], v[212:215]
    ds_read_b128 v[228:231], v5 offset:23552
    s_waitcnt lgkmcnt(3)
    v_mfma_f32_16x16x32_bf16 v[200:203], v[240:243], v[104:107], v[200:203]
    v_mfma_f32_16x16x32_bf16 v[204:207], v[240:243], v[108:111], v[204:207]
    ds_read_b128 v[232:235], v5 offset:24576
    s_mov_b32 s23, 0x2000
    buffer_load_dwordx4 v[32:35], v6, s[8:11], s23 offen offset:0 sc1
    s_waitcnt lgkmcnt(3)
    v_mfma_f32_16x16x32_bf16 v[208:211], v[244:247], v[104:107], v[208:211]
    v_mfma_f32_16x16x32_bf16 v[212:215], v[244:247], v[108:111], v[212:215]
    ds_read_b128 v[236:239], v5 offset:25600
    s_waitcnt lgkmcnt(3)
    v_mfma_f32_16x16x32_bf16 v[200:203], v[224:227], v[112:115], v[200:203]
    s_mov_b32 s23, 0x22000
    buffer_load_dwordx4 v[36:39], v6, s[8:11], s23 offen offset:0 sc1
    v_mfma_f32_16x16x32_bf16 v[204:207], v[224:227], v[116:119], v[204:207]
    ds_read_b128 v[240:243], v5 offset:26624
    s_waitcnt lgkmcnt(3)
    v_mfma_f32_16x16x32_bf16 v[208:211], v[228:231], v[112:115], v[208:211]
    v_mfma_f32_16x16x32_bf16 v[212:215], v[228:231], v[116:119], v[212:215]
    ds_read_b128 v[244:247], v5 offset:27648
    s_waitcnt lgkmcnt(3)
    v_mfma_f32_16x16x32_bf16 v[200:203], v[232:235], v[120:123], v[200:203]
    s_mov_b32 s23, 0x4000
    buffer_load_dwordx4 v[40:43], v6, s[8:11], s23 offen offset:0 sc1
    v_mfma_f32_16x16x32_bf16 v[204:207], v[232:235], v[124:127], v[204:207]
    ds_read_b128 v[224:227], v5 offset:28672
    s_waitcnt lgkmcnt(3)
    v_mfma_f32_16x16x32_bf16 v[208:211], v[236:239], v[120:123], v[208:211]
    v_mfma_f32_16x16x32_bf16 v[212:215], v[236:239], v[124:127], v[212:215]
    ds_read_b128 v[228:231], v5 offset:29696
    s_waitcnt lgkmcnt(3)
    v_mfma_f32_16x16x32_bf16 v[200:203], v[240:243], v[128:131], v[200:203]
    s_mov_b32 s23, 0x24000
    buffer_load_dwordx4 v[44:47], v6, s[8:11], s23 offen offset:0 sc1
    v_mfma_f32_16x16x32_bf16 v[204:207], v[240:243], v[132:135], v[204:207]
    ds_read_b128 v[232:235], v5 offset:30720
    s_waitcnt lgkmcnt(3)
    v_mfma_f32_16x16x32_bf16 v[208:211], v[244:247], v[128:131], v[208:211]
    v_mfma_f32_16x16x32_bf16 v[212:215], v[244:247], v[132:135], v[212:215]
    ds_read_b128 v[236:239], v5 offset:31744
    s_mov_b32 s23, 0x6000
    buffer_load_dwordx4 v[48:51], v6, s[8:11], s23 offen offset:0 sc1
    s_waitcnt lgkmcnt(3)
    v_mfma_f32_16x16x32_bf16 v[200:203], v[224:227], v[136:139], v[200:203]
    v_bfe_u32 v18, v1, 2, 2
    v_lshrrev_b32 v19, 4, v1
    v_mfma_f32_16x16x32_bf16 v[204:207], v[224:227], v[140:143], v[204:207]
    v_and_b32 v17, 3, v1
    v_lshlrev_b32 v16, 11, v19
    s_waitcnt lgkmcnt(2)
    v_mfma_f32_16x16x32_bf16 v[208:211], v[228:231], v[136:139], v[208:211]
    v_lshl_add_u32 v16, v18, 6, v16
    v_lshl_add_u32 v16, v17, 3, v16
    v_mfma_f32_16x16x32_bf16 v[212:215], v[228:231], v[140:143], v[212:215]
    s_mov_b32 s23, 0x26000
    buffer_load_dwordx4 v[52:55], v6, s[8:11], s23 offen offset:0 sc1
    v_add_u32 v16, 0x10000, v16
    v_and_b32 v19, 1, v19
    s_waitcnt lgkmcnt(1)
    v_mfma_f32_16x16x32_bf16 v[200:203], v[232:235], v[144:147], v[200:203]
    v_lshlrev_b32 v19, 5, v19
    v_sub_u32 v5, v16, v19
    v_mfma_f32_16x16x32_bf16 v[204:207], v[232:235], v[148:151], v[204:207]
    v_add_u32 v4, v16, v19
    v_add_u32 v7, 0x10000, v4
    s_waitcnt lgkmcnt(0)
    v_mfma_f32_16x16x32_bf16 v[208:211], v[236:239], v[144:147], v[208:211]
    v_add_u32 v8, 0x10000, v5
    v_mfma_f32_16x16x32_bf16 v[212:215], v[236:239], v[148:151], v[212:215]
    v_mul_f32 v200, v200, v9
    v_mul_f32 v201, v201, v9
    v_mul_f32 v202, v202, v9
    v_mul_f32 v203, v203, v9
    s_nop 1
    v_mul_f32 v208, v208, v9
    v_mul_f32 v209, v209, v9
    v_mul_f32 v210, v210, v9
    v_mul_f32 v211, v211, v9
    v_cvt_pk_bf16_f32 v216, v200, v201
    v_cvt_pk_bf16_f32 v217, v202, v203
    v_cvt_pk_bf16_f32 v218, v208, v209
    v_cvt_pk_bf16_f32 v219, v210, v211
    buffer_store_dwordx4 v[216:219], v2, s[8:11], s25 offen offset:3072 sc1
    v_mul_f32 v204, v204, v10
    v_mul_f32 v205, v205, v10
    v_mul_f32 v206, v206, v10
    v_mul_f32 v207, v207, v10
    v_mul_f32 v212, v212, v10
    v_mul_f32 v213, v213, v10
    v_mul_f32 v214, v214, v10
    v_mul_f32 v215, v215, v10
    v_cvt_pk_bf16_f32 v220, v204, v205
    v_cvt_pk_bf16_f32 v221, v206, v207
    v_cvt_pk_bf16_f32 v222, v212, v213
    v_cvt_pk_bf16_f32 v223, v214, v215
    buffer_store_dwordx4 v[220:223], v2, s[8:11], s26 offen offset:3072 sc1
    s_and_b32 s15, s2, 1
    s_barrier
    ds_read_b64_tr_b16 v[224:225], v4 offset:0
    ds_read_b64_tr_b16 v[226:227], v4 offset:1024
    ds_read_b64_tr_b16 v[228:229], v5 offset:32
    ds_read_b64_tr_b16 v[230:231], v5 offset:1056
    ds_read_b64_tr_b16 v[232:233], v4 offset:256
    ds_read_b64_tr_b16 v[234:235], v4 offset:1280
    ds_read_b64_tr_b16 v[236:237], v5 offset:288
    ds_read_b64_tr_b16 v[238:239], v5 offset:1312
    s_waitcnt vmcnt(11) lgkmcnt(6)
    v_mfma_f32_16x16x32_bf16 v[88:91], v[224:227], v[24:27], 0
    ds_read_b64_tr_b16 v[240:241], v4 offset:512
    s_waitcnt vmcnt(9)
    v_mfma_f32_16x16x32_bf16 v[92:95], v[224:227], v[28:31], 0
    s_add_u32 s22, s24, 0x200000
    s_add_u32 m0, s20, 0x20000
    s_nop 0
    buffer_load_dwordx4 v3, s[4:7], s22 offen lds
    ds_read_b64_tr_b16 v[242:243], v4 offset:1536
    s_waitcnt lgkmcnt(6)
    v_mfma_f32_16x16x32_bf16 v[96:99], v[228:231], v[24:27], 0
    ds_read_b64_tr_b16 v[244:245], v5 offset:544
    s_mov_b32 s23, 0x8000
    buffer_load_dwordx4 v[56:59], v6, s[8:11], s23 offen offset:0 sc1
    v_mfma_f32_16x16x32_bf16 v[100:103], v[228:231], v[28:31], 0
    ds_read_b64_tr_b16 v[246:247], v5 offset:1568
    s_waitcnt lgkmcnt(6)
    v_mfma_f32_16x16x32_bf16 v[104:107], v[232:235], v[24:27], 0
    s_add_u32 s22, s24, 0x202000
    s_add_u32 m0, s20, 0x20400
    s_nop 0
    buffer_load_dwordx4 v3, s[4:7], s22 offen lds
    ds_read_b64_tr_b16 v[224:225], v4 offset:768
    v_mfma_f32_16x16x32_bf16 v[108:111], v[232:235], v[28:31], 0
    ds_read_b64_tr_b16 v[226:227], v4 offset:1792
    s_mov_b32 s23, 0x28000
    buffer_load_dwordx4 v[60:63], v6, s[8:11], s23 offen offset:0 sc1
    s_waitcnt lgkmcnt(6)
    v_mfma_f32_16x16x32_bf16 v[112:115], v[236:239], v[24:27], 0
    ds_read_b64_tr_b16 v[228:229], v5 offset:800
    v_mfma_f32_16x16x32_bf16 v[116:119], v[236:239], v[28:31], 0
    ds_read_b64_tr_b16 v[230:231], v5 offset:1824
    s_waitcnt lgkmcnt(6)
    v_mfma_f32_16x16x32_bf16 v[120:123], v[240:243], v[24:27], 0
    v_mfma_f32_16x16x32_bf16 v[124:127], v[240:243], v[28:31], 0
    s_barrier
    ds_read_b64_tr_b16 v[232:233], v4 offset:16384
    ds_read_b64_tr_b16 v[234:235], v4 offset:17408
    s_waitcnt lgkmcnt(6)
    v_mfma_f32_16x16x32_bf16 v[128:131], v[244:247], v[24:27], 0
    s_add_u32 s22, s24, 0x280000
    s_add_u32 m0, s20, 0x24000
    s_nop 0
    buffer_load_dwordx4 v3, s[4:7], s22 offen lds
    ds_read_b64_tr_b16 v[236:237], v5 offset:16416
    v_mfma_f32_16x16x32_bf16 v[132:135], v[244:247], v[28:31], 0
    ds_read_b64_tr_b16 v[238:239], v5 offset:17440
    s_waitcnt lgkmcnt(6)
    v_mfma_f32_16x16x32_bf16 v[136:139], v[224:227], v[24:27], 0
    ds_read_b64_tr_b16 v[240:241], v4 offset:16640
    v_mfma_f32_16x16x32_bf16 v[140:143], v[224:227], v[28:31], 0
    s_add_u32 s22, s24, 0x282000
    s_add_u32 m0, s20, 0x24400
    s_nop 0
    buffer_load_dwordx4 v3, s[4:7], s22 offen lds
    ds_read_b64_tr_b16 v[242:243], v4 offset:17664
    s_waitcnt lgkmcnt(6)
    v_mfma_f32_16x16x32_bf16 v[144:147], v[228:231], v[24:27], 0
    ds_read_b64_tr_b16 v[244:245], v5 offset:16672
    v_mfma_f32_16x16x32_bf16 v[148:151], v[228:231], v[28:31], 0
    ds_read_b64_tr_b16 v[246:247], v5 offset:17696
    s_waitcnt vmcnt(13) lgkmcnt(6)
    v_mfma_f32_16x16x32_bf16 v[88:91], v[232:235], v[32:35], v[88:91]
    ds_read_b64_tr_b16 v[224:225], v4 offset:16896
    s_waitcnt vmcnt(12)
    v_mfma_f32_16x16x32_bf16 v[92:95], v[232:235], v[36:39], v[92:95]
    ds_read_b64_tr_b16 v[226:227], v4 offset:17920
    s_waitcnt lgkmcnt(6)
    v_mfma_f32_16x16x32_bf16 v[96:99], v[236:239], v[32:35], v[96:99]
    ds_read_b64_tr_b16 v[228:229], v5 offset:16928
    s_mov_b32 s23, 0xa000
    buffer_load_dwordx4 v[24:27], v6, s[8:11], s23 offen offset:0 sc1
    v_mfma_f32_16x16x32_bf16 v[100:103], v[236:239], v[36:39], v[100:103]
    ds_read_b64_tr_b16 v[230:231], v5 offset:17952
    s_waitcnt lgkmcnt(6)
    v_mfma_f32_16x16x32_bf16 v[104:107], v[240:243], v[32:35], v[104:107]
    ds_read_b64_tr_b16 v[232:233], v4 offset:17152
    v_mfma_f32_16x16x32_bf16 v[108:111], v[240:243], v[36:39], v[108:111]
    ds_read_b64_tr_b16 v[234:235], v4 offset:18176
    s_mov_b32 s23, 0x2a000
    buffer_load_dwordx4 v[28:31], v6, s[8:11], s23 offen offset:0 sc1
    s_waitcnt lgkmcnt(6)
    v_mfma_f32_16x16x32_bf16 v[112:115], v[244:247], v[32:35], v[112:115]
    ds_read_b64_tr_b16 v[236:237], v5 offset:17184
    v_mfma_f32_16x16x32_bf16 v[116:119], v[244:247], v[36:39], v[116:119]
    ds_read_b64_tr_b16 v[238:239], v5 offset:18208
    s_waitcnt lgkmcnt(6)
    v_mfma_f32_16x16x32_bf16 v[120:123], v[224:227], v[32:35], v[120:123]
    v_mfma_f32_16x16x32_bf16 v[124:127], v[224:227], v[36:39], v[124:127]
    s_barrier
    ds_read_b64_tr_b16 v[240:241], v4 offset:32768
    ds_read_b64_tr_b16 v[242:243], v4 offset:33792
    s_waitcnt lgkmcnt(6)
    v_mfma_f32_16x16x32_bf16 v[128:131], v[228:231], v[32:35], v[128:131]
    s_add_u32 s22, s24, 0x300000
    s_add_u32 m0, s20, 0x10000
    s_nop 0
    buffer_load_dwordx4 v3, s[4:7], s22 offen lds
    ds_read_b64_tr_b16 v[244:245], v5 offset:32800
    v_mfma_f32_16x16x32_bf16 v[132:135], v[228:231], v[36:39], v[132:135]
    ds_read_b64_tr_b16 v[246:247], v5 offset:33824
    s_waitcnt lgkmcnt(6)
    v_mfma_f32_16x16x32_bf16 v[136:139], v[232:235], v[32:35], v[136:139]
    ds_read_b64_tr_b16 v[224:225], v4 offset:33024
    v_mfma_f32_16x16x32_bf16 v[140:143], v[232:235], v[36:39], v[140:143]
    s_add_u32 s22, s24, 0x302000
    s_add_u32 m0, s20, 0x10400
    s_nop 0
    buffer_load_dwordx4 v3, s[4:7], s22 offen lds
    ds_read_b64_tr_b16 v[226:227], v4 offset:34048
    s_waitcnt lgkmcnt(6)
    v_mfma_f32_16x16x32_bf16 v[144:147], v[236:239], v[32:35], v[144:147]
    s_add_u32 s16, s63, 0x574000
    v_mov_b32 v14, s28
    v_mov_b32 v15, 0
    s_mov_b64 exec, 1
    buffer_store_dword v14, v15, s[8:11], s16 offen sc1
    s_mov_b64 exec, -1
    ds_read_b64_tr_b16 v[228:229], v5 offset:33056
    v_mfma_f32_16x16x32_bf16 v[148:151], v[236:239], v[36:39], v[148:151]
    ds_read_b64_tr_b16 v[230:231], v5 offset:34080
    s_waitcnt vmcnt(16) lgkmcnt(6)
    v_mfma_f32_16x16x32_bf16 v[88:91], v[240:243], v[40:43], v[88:91]
    ds_read_b64_tr_b16 v[232:233], v4 offset:33280
    s_waitcnt vmcnt(15)
    v_mfma_f32_16x16x32_bf16 v[92:95], v[240:243], v[44:47], v[92:95]
    ds_read_b64_tr_b16 v[234:235], v4 offset:34304
    s_waitcnt lgkmcnt(6)
    v_mfma_f32_16x16x32_bf16 v[96:99], v[244:247], v[40:43], v[96:99]
    ds_read_b64_tr_b16 v[236:237], v5 offset:33312
    s_mov_b32 s23, 0xc000
    buffer_load_dwordx4 v[32:35], v6, s[8:11], s23 offen offset:0 sc1
    v_mfma_f32_16x16x32_bf16 v[100:103], v[244:247], v[44:47], v[100:103]
    ds_read_b64_tr_b16 v[238:239], v5 offset:34336
    s_waitcnt lgkmcnt(6)
    v_mfma_f32_16x16x32_bf16 v[104:107], v[224:227], v[40:43], v[104:107]
    ds_read_b64_tr_b16 v[240:241], v4 offset:33536
    v_mfma_f32_16x16x32_bf16 v[108:111], v[224:227], v[44:47], v[108:111]
    ds_read_b64_tr_b16 v[242:243], v4 offset:34560
    s_mov_b32 s23, 0x2c000
    buffer_load_dwordx4 v[36:39], v6, s[8:11], s23 offen offset:0 sc1
    s_waitcnt lgkmcnt(6)
    v_mfma_f32_16x16x32_bf16 v[112:115], v[228:231], v[40:43], v[112:115]
    ds_read_b64_tr_b16 v[244:245], v5 offset:33568
    v_mfma_f32_16x16x32_bf16 v[116:119], v[228:231], v[44:47], v[116:119]
    ds_read_b64_tr_b16 v[246:247], v5 offset:34592
    s_waitcnt lgkmcnt(6)
    v_mfma_f32_16x16x32_bf16 v[120:123], v[232:235], v[40:43], v[120:123]
    v_mfma_f32_16x16x32_bf16 v[124:127], v[232:235], v[44:47], v[124:127]
    s_barrier
    ds_read_b64_tr_b16 v[224:225], v4 offset:49152
    ds_read_b64_tr_b16 v[226:227], v4 offset:50176
    s_add_u32 s19, s19, 8192
    buffer_load_dword v12, v13, s[8:11], s19 offen sc1
    s_waitcnt lgkmcnt(6)
    v_mfma_f32_16x16x32_bf16 v[128:131], v[236:239], v[40:43], v[128:131]
    s_add_u32 s22, s24, 0x380000
    s_add_u32 m0, s20, 0x14000
    s_nop 0
    buffer_load_dwordx4 v3, s[4:7], s22 offen lds
    ds_read_b64_tr_b16 v[228:229], v5 offset:49184
    v_mfma_f32_16x16x32_bf16 v[132:135], v[236:239], v[44:47], v[132:135]
    ds_read_b64_tr_b16 v[230:231], v5 offset:50208
    s_waitcnt lgkmcnt(6)
    v_mfma_f32_16x16x32_bf16 v[136:139], v[240:243], v[40:43], v[136:139]
    ds_read_b64_tr_b16 v[232:233], v4 offset:49408
    v_mfma_f32_16x16x32_bf16 v[140:143], v[240:243], v[44:47], v[140:143]
    s_add_u32 s22, s24, 0x382000
    s_add_u32 m0, s20, 0x14400
    s_nop 0
    buffer_load_dwordx4 v3, s[4:7], s22 offen lds
    ds_read_b64_tr_b16 v[234:235], v4 offset:50432
    s_waitcnt lgkmcnt(6)
    v_mfma_f32_16x16x32_bf16 v[144:147], v[244:247], v[40:43], v[144:147]
    ds_read_b64_tr_b16 v[236:237], v5 offset:49440
    v_mfma_f32_16x16x32_bf16 v[148:151], v[244:247], v[44:47], v[148:151]
    ds_read_b64_tr_b16 v[238:239], v5 offset:50464
    s_waitcnt vmcnt(19) lgkmcnt(6)
    v_mfma_f32_16x16x32_bf16 v[88:91], v[224:227], v[48:51], v[88:91]
    ds_read_b64_tr_b16 v[240:241], v4 offset:49664
    s_waitcnt vmcnt(18)
    v_mfma_f32_16x16x32_bf16 v[92:95], v[224:227], v[52:55], v[92:95]
    ds_read_b64_tr_b16 v[242:243], v4 offset:50688
    s_waitcnt lgkmcnt(6)
    v_mfma_f32_16x16x32_bf16 v[96:99], v[228:231], v[48:51], v[96:99]
    ds_read_b64_tr_b16 v[244:245], v5 offset:49696
    s_mov_b32 s23, 0xe000
    buffer_load_dwordx4 v[40:43], v6, s[8:11], s23 offen offset:0 sc1
    v_mfma_f32_16x16x32_bf16 v[100:103], v[228:231], v[52:55], v[100:103]
    ds_read_b64_tr_b16 v[246:247], v5 offset:50720
    s_waitcnt lgkmcnt(6)
    v_mfma_f32_16x16x32_bf16 v[104:107], v[232:235], v[48:51], v[104:107]
    ds_read_b64_tr_b16 v[224:225], v4 offset:49920
    v_mfma_f32_16x16x32_bf16 v[108:111], v[232:235], v[52:55], v[108:111]
    ds_read_b64_tr_b16 v[226:227], v4 offset:50944
    s_mov_b32 s23, 0x2e000
    buffer_load_dwordx4 v[44:47], v6, s[8:11], s23 offen offset:0 sc1
    s_waitcnt lgkmcnt(6)
    v_mfma_f32_16x16x32_bf16 v[112:115], v[236:239], v[48:51], v[112:115]
    ds_read_b64_tr_b16 v[228:229], v5 offset:49952
    v_mfma_f32_16x16x32_bf16 v[116:119], v[236:239], v[52:55], v[116:119]
    ds_read_b64_tr_b16 v[230:231], v5 offset:50976
    s_waitcnt lgkmcnt(6)
    v_mfma_f32_16x16x32_bf16 v[120:123], v[240:243], v[48:51], v[120:123]
    v_mfma_f32_16x16x32_bf16 v[124:127], v[240:243], v[52:55], v[124:127]
    s_waitcnt vmcnt(15)
    s_barrier
    ds_read_b64_tr_b16 v[232:233], v7 offset:0
    ds_read_b64_tr_b16 v[234:235], v7 offset:1024
    s_waitcnt lgkmcnt(6)
    v_mfma_f32_16x16x32_bf16 v[128:131], v[244:247], v[48:51], v[128:131]
    s_add_u32 s22, s24, 0x10000
    s_add_u32 m0, s20, 0x18000
    s_nop 0
    buffer_load_dwordx4 v3, s[4:7], s22 offen lds
    ds_read_b64_tr_b16 v[236:237], v8 offset:32
    v_mfma_f32_16x16x32_bf16 v[132:135], v[244:247], v[52:55], v[132:135]
    ds_read_b64_tr_b16 v[238:239], v8 offset:1056
    s_waitcnt lgkmcnt(6)
    v_mfma_f32_16x16x32_bf16 v[136:139], v[224:227], v[48:51], v[136:139]
    ds_read_b64_tr_b16 v[240:241], v7 offset:256
    v_mfma_f32_16x16x32_bf16 v[140:143], v[224:227], v[52:55], v[140:143]
    s_add_u32 s22, s24, 0x12000
    s_add_u32 m0, s20, 0x18400
    s_nop 0
    buffer_load_dwordx4 v3, s[4:7], s22 offen lds
    ds_read_b64_tr_b16 v[242:243], v7 offset:1280
    s_waitcnt lgkmcnt(6)
    v_mfma_f32_16x16x32_bf16 v[144:147], v[228:231], v[48:51], v[144:147]
    ds_read_b64_tr_b16 v[244:245], v8 offset:288
    v_mfma_f32_16x16x32_bf16 v[148:151], v[228:231], v[52:55], v[148:151]
    ds_read_b64_tr_b16 v[246:247], v8 offset:1312
    s_waitcnt vmcnt(6)
    v_cmp_ne_u32 vcc, s28, v12
    s_cbranch_vccnz adaLN_cond__sliding_block_cached__moe_arch_mod__prompt_kernel_o27r
adaLN_cond__sliding_block_cached__moe_arch_mod__prompt_kernel_o27b:
    s_waitcnt lgkmcnt(6)
    v_mfma_f32_16x16x32_bf16 v[88:91], v[232:235], v[56:59], v[88:91]
    ds_read_b64_tr_b16 v[224:225], v7 offset:512
    v_mfma_f32_16x16x32_bf16 v[92:95], v[232:235], v[60:63], v[92:95]
    ds_read_b64_tr_b16 v[226:227], v7 offset:1536
    s_waitcnt lgkmcnt(6)
    v_mfma_f32_16x16x32_bf16 v[96:99], v[236:239], v[56:59], v[96:99]
    ds_read_b64_tr_b16 v[228:229], v8 offset:544
    s_mov_b32 s23, 0x0
    buffer_load_dwordx4 v[48:51], v6, s[8:11], s23 offen offset:1024 sc1
    v_mfma_f32_16x16x32_bf16 v[100:103], v[236:239], v[60:63], v[100:103]
    ds_read_b64_tr_b16 v[230:231], v8 offset:1568
    s_waitcnt lgkmcnt(6)
    v_mfma_f32_16x16x32_bf16 v[104:107], v[240:243], v[56:59], v[104:107]
    ds_read_b64_tr_b16 v[232:233], v7 offset:768
    v_mfma_f32_16x16x32_bf16 v[108:111], v[240:243], v[60:63], v[108:111]
    ds_read_b64_tr_b16 v[234:235], v7 offset:1792
    s_mov_b32 s23, 0x20000
    buffer_load_dwordx4 v[52:55], v6, s[8:11], s23 offen offset:1024 sc1
    s_waitcnt lgkmcnt(6)
    v_mfma_f32_16x16x32_bf16 v[112:115], v[244:247], v[56:59], v[112:115]
    ds_read_b64_tr_b16 v[236:237], v8 offset:800
    v_mfma_f32_16x16x32_bf16 v[116:119], v[244:247], v[60:63], v[116:119]
    ds_read_b64_tr_b16 v[238:239], v8 offset:1824
    s_waitcnt lgkmcnt(6)
    v_mfma_f32_16x16x32_bf16 v[120:123], v[224:227], v[56:59], v[120:123]
    v_mfma_f32_16x16x32_bf16 v[124:127], v[224:227], v[60:63], v[124:127]
    s_barrier
    ds_read_b64_tr_b16 v[240:241], v7 offset:16384
    ds_read_b64_tr_b16 v[242:243], v7 offset:17408
    s_waitcnt lgkmcnt(6)
    v_mfma_f32_16x16x32_bf16 v[128:131], v[228:231], v[56:59], v[128:131]
    s_add_u32 s22, s24, 0x90000
    s_add_u32 m0, s20, 0x1c000
    s_nop 0
    buffer_load_dwordx4 v3, s[4:7], s22 offen lds
    ds_read_b64_tr_b16 v[244:245], v8 offset:16416
    v_mfma_f32_16x16x32_bf16 v[132:135], v[228:231], v[60:63], v[132:135]
    ds_read_b64_tr_b16 v[246:247], v8 offset:17440
    s_waitcnt lgkmcnt(6)
    v_mfma_f32_16x16x32_bf16 v[136:139], v[232:235], v[56:59], v[136:139]
    ds_read_b64_tr_b16 v[224:225], v7 offset:16640
    v_mfma_f32_16x16x32_bf16 v[140:143], v[232:235], v[60:63], v[140:143]
    s_add_u32 s22, s24, 0x92000
    s_add_u32 m0, s20, 0x1c400
    s_nop 0
    buffer_load_dwordx4 v3, s[4:7], s22 offen lds
    ds_read_b64_tr_b16 v[226:227], v7 offset:17664
    s_waitcnt lgkmcnt(6)
    v_mfma_f32_16x16x32_bf16 v[144:147], v[236:239], v[56:59], v[144:147]
    ds_read_b64_tr_b16 v[228:229], v8 offset:16672
    v_mfma_f32_16x16x32_bf16 v[148:151], v[236:239], v[60:63], v[148:151]
    ds_read_b64_tr_b16 v[230:231], v8 offset:17696
    s_waitcnt lgkmcnt(6)
    v_mfma_f32_16x16x32_bf16 v[88:91], v[240:243], v[24:27], v[88:91]
    ds_read_b64_tr_b16 v[232:233], v7 offset:16896
    v_mfma_f32_16x16x32_bf16 v[92:95], v[240:243], v[28:31], v[92:95]
    ds_read_b64_tr_b16 v[234:235], v7 offset:17920
    s_waitcnt lgkmcnt(6)
    v_mfma_f32_16x16x32_bf16 v[96:99], v[244:247], v[24:27], v[96:99]
    ds_read_b64_tr_b16 v[236:237], v8 offset:16928
    s_mov_b32 s23, 0x2000
    buffer_load_dwordx4 v[56:59], v6, s[8:11], s23 offen offset:1024 sc1
    v_mfma_f32_16x16x32_bf16 v[100:103], v[244:247], v[28:31], v[100:103]
    ds_read_b64_tr_b16 v[238:239], v8 offset:17952
    s_waitcnt lgkmcnt(6)
    v_mfma_f32_16x16x32_bf16 v[104:107], v[224:227], v[24:27], v[104:107]
    ds_read_b64_tr_b16 v[240:241], v7 offset:17152
    v_mfma_f32_16x16x32_bf16 v[108:111], v[224:227], v[28:31], v[108:111]
    ds_read_b64_tr_b16 v[242:243], v7 offset:18176
    s_mov_b32 s23, 0x22000
    buffer_load_dwordx4 v[60:63], v6, s[8:11], s23 offen offset:1024 sc1
    s_waitcnt lgkmcnt(6)
    v_mfma_f32_16x16x32_bf16 v[112:115], v[228:231], v[24:27], v[112:115]
    ds_read_b64_tr_b16 v[244:245], v8 offset:17184
    v_mfma_f32_16x16x32_bf16 v[116:119], v[228:231], v[28:31], v[116:119]
    ds_read_b64_tr_b16 v[246:247], v8 offset:18208
    s_waitcnt lgkmcnt(6)
    v_mfma_f32_16x16x32_bf16 v[120:123], v[232:235], v[24:27], v[120:123]
    v_mfma_f32_16x16x32_bf16 v[124:127], v[232:235], v[28:31], v[124:127]
    s_barrier
    ds_read_b64_tr_b16 v[224:225], v4 offset:0
    ds_read_b64_tr_b16 v[226:227], v4 offset:1024
    s_waitcnt lgkmcnt(6)
    v_mfma_f32_16x16x32_bf16 v[128:131], v[236:239], v[24:27], v[128:131]
    s_add_u32 s16, s63, 0x576000
    v_mov_b32 v14, s28
    v_mov_b32 v15, 0
    s_mov_b64 exec, 1
    buffer_store_dword v14, v15, s[8:11], s16 offen sc1
    s_mov_b64 exec, -1
    s_add_u32 s22, s24, 0x110000
    s_add_u32 m0, s20, 0x20000
    s_nop 0
    buffer_load_dwordx4 v3, s[4:7], s22 offen lds
    ds_read_b64_tr_b16 v[228:229], v5 offset:32
    v_mfma_f32_16x16x32_bf16 v[132:135], v[236:239], v[28:31], v[132:135]
    ds_read_b64_tr_b16 v[230:231], v5 offset:1056
    s_waitcnt lgkmcnt(6)
    v_mfma_f32_16x16x32_bf16 v[136:139], v[240:243], v[24:27], v[136:139]
    ds_read_b64_tr_b16 v[232:233], v4 offset:256
    v_mfma_f32_16x16x32_bf16 v[140:143], v[240:243], v[28:31], v[140:143]
    s_add_u32 s22, s24, 0x112000
    s_add_u32 m0, s20, 0x20400
    s_nop 0
    buffer_load_dwordx4 v3, s[4:7], s22 offen lds
    ds_read_b64_tr_b16 v[234:235], v4 offset:1280
    s_waitcnt lgkmcnt(6)
    v_mfma_f32_16x16x32_bf16 v[144:147], v[244:247], v[24:27], v[144:147]
    ds_read_b64_tr_b16 v[236:237], v5 offset:288
    v_mfma_f32_16x16x32_bf16 v[148:151], v[244:247], v[28:31], v[148:151]
    ds_read_b64_tr_b16 v[238:239], v5 offset:1312
    s_waitcnt lgkmcnt(6)
    v_mfma_f32_16x16x32_bf16 v[88:91], v[224:227], v[32:35], v[88:91]
    ds_read_b64_tr_b16 v[240:241], v4 offset:512
    v_mfma_f32_16x16x32_bf16 v[92:95], v[224:227], v[36:39], v[92:95]
    ds_read_b64_tr_b16 v[242:243], v4 offset:1536
    s_waitcnt lgkmcnt(6)
    v_mfma_f32_16x16x32_bf16 v[96:99], v[228:231], v[32:35], v[96:99]
    ds_read_b64_tr_b16 v[244:245], v5 offset:544
    s_mov_b32 s23, 0x4000
    buffer_load_dwordx4 v[24:27], v6, s[8:11], s23 offen offset:1024 sc1
    v_mfma_f32_16x16x32_bf16 v[100:103], v[228:231], v[36:39], v[100:103]
    ds_read_b64_tr_b16 v[246:247], v5 offset:1568
    s_waitcnt lgkmcnt(6)
    v_mfma_f32_16x16x32_bf16 v[104:107], v[232:235], v[32:35], v[104:107]
    ds_read_b64_tr_b16 v[224:225], v4 offset:768
    v_mfma_f32_16x16x32_bf16 v[108:111], v[232:235], v[36:39], v[108:111]
    ds_read_b64_tr_b16 v[226:227], v4 offset:1792
    s_mov_b32 s23, 0x24000
    buffer_load_dwordx4 v[28:31], v6, s[8:11], s23 offen offset:1024 sc1
    s_waitcnt lgkmcnt(6)
    v_mfma_f32_16x16x32_bf16 v[112:115], v[236:239], v[32:35], v[112:115]
    ds_read_b64_tr_b16 v[228:229], v5 offset:800
    v_mfma_f32_16x16x32_bf16 v[116:119], v[236:239], v[36:39], v[116:119]
    ds_read_b64_tr_b16 v[230:231], v5 offset:1824
    s_waitcnt lgkmcnt(6)
    v_mfma_f32_16x16x32_bf16 v[120:123], v[240:243], v[32:35], v[120:123]
    v_mfma_f32_16x16x32_bf16 v[124:127], v[240:243], v[36:39], v[124:127]
    s_waitcnt vmcnt(15)
    s_barrier
    ds_read_b64_tr_b16 v[232:233], v4 offset:16384
    ds_read_b64_tr_b16 v[234:235], v4 offset:17408
    s_waitcnt lgkmcnt(6)
    v_mfma_f32_16x16x32_bf16 v[128:131], v[244:247], v[32:35], v[128:131]
    s_add_u32 s22, s24, 0x190000
    s_add_u32 m0, s20, 0x24000
    s_nop 0
    buffer_load_dwordx4 v3, s[4:7], s22 offen lds
    ds_read_b64_tr_b16 v[236:237], v5 offset:16416
    v_mfma_f32_16x16x32_bf16 v[132:135], v[244:247], v[36:39], v[132:135]
    ds_read_b64_tr_b16 v[238:239], v5 offset:17440
    s_waitcnt lgkmcnt(6)
    v_mfma_f32_16x16x32_bf16 v[136:139], v[224:227], v[32:35], v[136:139]
    ds_read_b64_tr_b16 v[240:241], v4 offset:16640
    v_mfma_f32_16x16x32_bf16 v[140:143], v[224:227], v[36:39], v[140:143]
    s_add_u32 s22, s24, 0x192000
    s_add_u32 m0, s20, 0x24400
    s_nop 0
    buffer_load_dwordx4 v3, s[4:7], s22 offen lds
    ds_read_b64_tr_b16 v[242:243], v4 offset:17664
    s_waitcnt lgkmcnt(6)
    v_mfma_f32_16x16x32_bf16 v[144:147], v[228:231], v[32:35], v[144:147]
    ds_read_b64_tr_b16 v[244:245], v5 offset:16672
    v_mfma_f32_16x16x32_bf16 v[148:151], v[228:231], v[36:39], v[148:151]
    ds_read_b64_tr_b16 v[246:247], v5 offset:17696
    s_waitcnt vmcnt(16) lgkmcnt(6)
    v_mfma_f32_16x16x32_bf16 v[88:91], v[232:235], v[40:43], v[88:91]
    ds_read_b64_tr_b16 v[224:225], v4 offset:16896
    s_waitcnt vmcnt(15)
    v_mfma_f32_16x16x32_bf16 v[92:95], v[232:235], v[44:47], v[92:95]
    ds_read_b64_tr_b16 v[226:227], v4 offset:17920
    s_waitcnt lgkmcnt(6)
    v_mfma_f32_16x16x32_bf16 v[96:99], v[236:239], v[40:43], v[96:99]
    ds_read_b64_tr_b16 v[228:229], v5 offset:16928
    s_mov_b32 s23, 0x6000
    buffer_load_dwordx4 v[32:35], v6, s[8:11], s23 offen offset:1024 sc1
    v_mfma_f32_16x16x32_bf16 v[100:103], v[236:239], v[44:47], v[100:103]
    ds_read_b64_tr_b16 v[230:231], v5 offset:17952
    s_waitcnt lgkmcnt(6)
    v_mfma_f32_16x16x32_bf16 v[104:107], v[240:243], v[40:43], v[104:107]
    ds_read_b64_tr_b16 v[232:233], v4 offset:17152
    v_mfma_f32_16x16x32_bf16 v[108:111], v[240:243], v[44:47], v[108:111]
    ds_read_b64_tr_b16 v[234:235], v4 offset:18176
    s_mov_b32 s23, 0x26000
    buffer_load_dwordx4 v[36:39], v6, s[8:11], s23 offen offset:1024 sc1
    s_waitcnt lgkmcnt(6)
    v_mfma_f32_16x16x32_bf16 v[112:115], v[244:247], v[40:43], v[112:115]
    ds_read_b64_tr_b16 v[236:237], v5 offset:17184
    v_mfma_f32_16x16x32_bf16 v[116:119], v[244:247], v[44:47], v[116:119]
    ds_read_b64_tr_b16 v[238:239], v5 offset:18208
    s_waitcnt lgkmcnt(6)
    v_mfma_f32_16x16x32_bf16 v[120:123], v[224:227], v[40:43], v[120:123]
    v_mfma_f32_16x16x32_bf16 v[124:127], v[224:227], v[44:47], v[124:127]
    s_waitcnt vmcnt(15)
    s_barrier
    ds_read_b64_tr_b16 v[240:241], v4 offset:32768
    ds_read_b64_tr_b16 v[242:243], v4 offset:33792
    s_waitcnt lgkmcnt(6)
    v_mfma_f32_16x16x32_bf16 v[128:131], v[228:231], v[40:43], v[128:131]
    s_add_u32 s22, s24, 0x210000
    s_add_u32 m0, s20, 0x10000
    s_nop 0
    buffer_load_dwordx4 v3, s[4:7], s22 offen lds
    ds_read_b64_tr_b16 v[244:245], v5 offset:32800
    v_mfma_f32_16x16x32_bf16 v[132:135], v[228:231], v[44:47], v[132:135]
    ds_read_b64_tr_b16 v[246:247], v5 offset:33824
    s_waitcnt lgkmcnt(6)
    v_mfma_f32_16x16x32_bf16 v[136:139], v[232:235], v[40:43], v[136:139]
    ds_read_b64_tr_b16 v[224:225], v4 offset:33024
    v_mfma_f32_16x16x32_bf16 v[140:143], v[232:235], v[44:47], v[140:143]
    s_add_u32 s22, s24, 0x212000
    s_add_u32 m0, s20, 0x10400
    s_nop 0
    buffer_load_dwordx4 v3, s[4:7], s22 offen lds
    ds_read_b64_tr_b16 v[226:227], v4 offset:34048
    s_waitcnt lgkmcnt(6)
    v_mfma_f32_16x16x32_bf16 v[144:147], v[236:239], v[40:43], v[144:147]
    ds_read_b64_tr_b16 v[228:229], v5 offset:33056
    v_mfma_f32_16x16x32_bf16 v[148:151], v[236:239], v[44:47], v[148:151]
    ds_read_b64_tr_b16 v[230:231], v5 offset:34080
    s_waitcnt vmcnt(16) lgkmcnt(6)
    v_mfma_f32_16x16x32_bf16 v[88:91], v[240:243], v[48:51], v[88:91]
    ds_read_b64_tr_b16 v[232:233], v4 offset:33280
    s_waitcnt vmcnt(15)
    v_mfma_f32_16x16x32_bf16 v[92:95], v[240:243], v[52:55], v[92:95]
    ds_read_b64_tr_b16 v[234:235], v4 offset:34304
    s_waitcnt lgkmcnt(6)
    v_mfma_f32_16x16x32_bf16 v[96:99], v[244:247], v[48:51], v[96:99]
    ds_read_b64_tr_b16 v[236:237], v5 offset:33312
    s_mov_b32 s23, 0x8000
    buffer_load_dwordx4 v[40:43], v6, s[8:11], s23 offen offset:1024 sc1
    v_mfma_f32_16x16x32_bf16 v[100:103], v[244:247], v[52:55], v[100:103]
    ds_read_b64_tr_b16 v[238:239], v5 offset:34336
    s_waitcnt lgkmcnt(6)
    v_mfma_f32_16x16x32_bf16 v[104:107], v[224:227], v[48:51], v[104:107]
    ds_read_b64_tr_b16 v[240:241], v4 offset:33536
    v_mfma_f32_16x16x32_bf16 v[108:111], v[224:227], v[52:55], v[108:111]
    ds_read_b64_tr_b16 v[242:243], v4 offset:34560
    s_mov_b32 s23, 0x28000
    buffer_load_dwordx4 v[44:47], v6, s[8:11], s23 offen offset:1024 sc1
    s_waitcnt lgkmcnt(6)
    v_mfma_f32_16x16x32_bf16 v[112:115], v[228:231], v[48:51], v[112:115]
    ds_read_b64_tr_b16 v[244:245], v5 offset:33568
    v_mfma_f32_16x16x32_bf16 v[116:119], v[228:231], v[52:55], v[116:119]
    ds_read_b64_tr_b16 v[246:247], v5 offset:34592
    s_waitcnt lgkmcnt(6)
    v_mfma_f32_16x16x32_bf16 v[120:123], v[232:235], v[48:51], v[120:123]
    v_mfma_f32_16x16x32_bf16 v[124:127], v[232:235], v[52:55], v[124:127]
    s_waitcnt vmcnt(15)
    s_barrier
    ds_read_b64_tr_b16 v[224:225], v4 offset:49152
    ds_read_b64_tr_b16 v[226:227], v4 offset:50176
    s_waitcnt lgkmcnt(6)
    v_mfma_f32_16x16x32_bf16 v[128:131], v[236:239], v[48:51], v[128:131]
    s_add_u32 s22, s24, 0x290000
    s_add_u32 m0, s20, 0x14000
    s_nop 0
    buffer_load_dwordx4 v3, s[4:7], s22 offen lds
    ds_read_b64_tr_b16 v[228:229], v5 offset:49184
    v_mfma_f32_16x16x32_bf16 v[132:135], v[236:239], v[52:55], v[132:135]
    ds_read_b64_tr_b16 v[230:231], v5 offset:50208
    s_waitcnt lgkmcnt(6)
    v_mfma_f32_16x16x32_bf16 v[136:139], v[240:243], v[48:51], v[136:139]
    ds_read_b64_tr_b16 v[232:233], v4 offset:49408
    v_mfma_f32_16x16x32_bf16 v[140:143], v[240:243], v[52:55], v[140:143]
    s_add_u32 s22, s24, 0x292000
    s_add_u32 m0, s20, 0x14400
    s_nop 0
    buffer_load_dwordx4 v3, s[4:7], s22 offen lds
    ds_read_b64_tr_b16 v[234:235], v4 offset:50432
    s_waitcnt lgkmcnt(6)
    v_mfma_f32_16x16x32_bf16 v[144:147], v[244:247], v[48:51], v[144:147]
    ds_read_b64_tr_b16 v[236:237], v5 offset:49440
    v_mfma_f32_16x16x32_bf16 v[148:151], v[244:247], v[52:55], v[148:151]
    ds_read_b64_tr_b16 v[238:239], v5 offset:50464
    s_waitcnt vmcnt(16) lgkmcnt(6)
    v_mfma_f32_16x16x32_bf16 v[88:91], v[224:227], v[56:59], v[88:91]
    ds_read_b64_tr_b16 v[240:241], v4 offset:49664
    s_waitcnt vmcnt(15)
    v_mfma_f32_16x16x32_bf16 v[92:95], v[224:227], v[60:63], v[92:95]
    ds_read_b64_tr_b16 v[242:243], v4 offset:50688
    s_waitcnt lgkmcnt(6)
    v_mfma_f32_16x16x32_bf16 v[96:99], v[228:231], v[56:59], v[96:99]
    ds_read_b64_tr_b16 v[244:245], v5 offset:49696
    s_mov_b32 s23, 0xa000
    buffer_load_dwordx4 v[48:51], v6, s[8:11], s23 offen offset:1024 sc1
    v_mfma_f32_16x16x32_bf16 v[100:103], v[228:231], v[60:63], v[100:103]
    ds_read_b64_tr_b16 v[246:247], v5 offset:50720
    s_waitcnt lgkmcnt(6)
    v_mfma_f32_16x16x32_bf16 v[104:107], v[232:235], v[56:59], v[104:107]
    ds_read_b64_tr_b16 v[224:225], v4 offset:49920
    v_mfma_f32_16x16x32_bf16 v[108:111], v[232:235], v[60:63], v[108:111]
    ds_read_b64_tr_b16 v[226:227], v4 offset:50944
    s_mov_b32 s23, 0x2a000
    buffer_load_dwordx4 v[52:55], v6, s[8:11], s23 offen offset:1024 sc1
    s_waitcnt lgkmcnt(6)
    v_mfma_f32_16x16x32_bf16 v[112:115], v[236:239], v[56:59], v[112:115]
    ds_read_b64_tr_b16 v[228:229], v5 offset:49952
    v_mfma_f32_16x16x32_bf16 v[116:119], v[236:239], v[60:63], v[116:119]
    ds_read_b64_tr_b16 v[230:231], v5 offset:50976
    s_waitcnt lgkmcnt(6)
    v_mfma_f32_16x16x32_bf16 v[120:123], v[240:243], v[56:59], v[120:123]
    v_mfma_f32_16x16x32_bf16 v[124:127], v[240:243], v[60:63], v[124:127]
    s_waitcnt vmcnt(14)
    s_barrier
    ds_read_b64_tr_b16 v[232:233], v7 offset:0
    ds_read_b64_tr_b16 v[234:235], v7 offset:1024
    s_waitcnt lgkmcnt(6)
    v_mfma_f32_16x16x32_bf16 v[128:131], v[244:247], v[56:59], v[128:131]
    s_add_u32 s22, s24, 0x310000
    s_add_u32 m0, s20, 0x18000
    s_nop 0
    buffer_load_dwordx4 v3, s[4:7], s22 offen lds
    ds_read_b64_tr_b16 v[236:237], v8 offset:32
    v_mfma_f32_16x16x32_bf16 v[132:135], v[244:247], v[60:63], v[132:135]
    ds_read_b64_tr_b16 v[238:239], v8 offset:1056
    s_waitcnt lgkmcnt(6)
    v_mfma_f32_16x16x32_bf16 v[136:139], v[224:227], v[56:59], v[136:139]
    ds_read_b64_tr_b16 v[240:241], v7 offset:256
    v_mfma_f32_16x16x32_bf16 v[140:143], v[224:227], v[60:63], v[140:143]
    s_add_u32 s22, s24, 0x312000
    s_add_u32 m0, s20, 0x18400
    s_nop 0
    buffer_load_dwordx4 v3, s[4:7], s22 offen lds
    ds_read_b64_tr_b16 v[242:243], v7 offset:1280
    s_waitcnt lgkmcnt(6)
    v_mfma_f32_16x16x32_bf16 v[144:147], v[228:231], v[56:59], v[144:147]
    ds_read_b64_tr_b16 v[244:245], v8 offset:288
    v_mfma_f32_16x16x32_bf16 v[148:151], v[228:231], v[60:63], v[148:151]
    ds_read_b64_tr_b16 v[246:247], v8 offset:1312
    s_waitcnt vmcnt(15) lgkmcnt(6)
    v_mfma_f32_16x16x32_bf16 v[88:91], v[232:235], v[24:27], v[88:91]
    ds_read_b64_tr_b16 v[224:225], v7 offset:512
    s_waitcnt vmcnt(14)
    v_mfma_f32_16x16x32_bf16 v[92:95], v[232:235], v[28:31], v[92:95]
    ds_read_b64_tr_b16 v[226:227], v7 offset:1536
    s_waitcnt lgkmcnt(6)
    v_mfma_f32_16x16x32_bf16 v[96:99], v[236:239], v[24:27], v[96:99]
    ds_read_b64_tr_b16 v[228:229], v8 offset:544
    s_mov_b32 s23, 0xc000
    buffer_load_dwordx4 v[56:59], v6, s[8:11], s23 offen offset:1024 sc1
    v_mfma_f32_16x16x32_bf16 v[100:103], v[236:239], v[28:31], v[100:103]
    ds_read_b64_tr_b16 v[230:231], v8 offset:1568
    s_waitcnt lgkmcnt(6)
    v_mfma_f32_16x16x32_bf16 v[104:107], v[240:243], v[24:27], v[104:107]
    ds_read_b64_tr_b16 v[232:233], v7 offset:768
    v_mfma_f32_16x16x32_bf16 v[108:111], v[240:243], v[28:31], v[108:111]
    ds_read_b64_tr_b16 v[234:235], v7 offset:1792
    s_mov_b32 s23, 0x2c000
    buffer_load_dwordx4 v[60:63], v6, s[8:11], s23 offen offset:1024 sc1
    s_waitcnt lgkmcnt(6)
    v_mfma_f32_16x16x32_bf16 v[112:115], v[244:247], v[24:27], v[112:115]
    ds_read_b64_tr_b16 v[236:237], v8 offset:800
    v_mfma_f32_16x16x32_bf16 v[116:119], v[244:247], v[28:31], v[116:119]
    ds_read_b64_tr_b16 v[238:239], v8 offset:1824
    s_waitcnt lgkmcnt(6)
    v_mfma_f32_16x16x32_bf16 v[120:123], v[224:227], v[24:27], v[120:123]
    v_mfma_f32_16x16x32_bf16 v[124:127], v[224:227], v[28:31], v[124:127]
    s_waitcnt vmcnt(14)
    s_barrier
    ds_read_b64_tr_b16 v[240:241], v7 offset:16384
    ds_read_b64_tr_b16 v[242:243], v7 offset:17408
    s_add_u32 s19, s19, 8192
    buffer_load_dword v12, v13, s[8:11], s19 offen sc1
    s_waitcnt lgkmcnt(6)
    v_mfma_f32_16x16x32_bf16 v[128:131], v[228:231], v[24:27], v[128:131]
    s_add_u32 s22, s24, 0x390000
    s_add_u32 m0, s20, 0x1c000
    s_nop 0
    buffer_load_dwordx4 v3, s[4:7], s22 offen lds
    ds_read_b64_tr_b16 v[244:245], v8 offset:16416
    v_mfma_f32_16x16x32_bf16 v[132:135], v[228:231], v[28:31], v[132:135]
    ds_read_b64_tr_b16 v[246:247], v8 offset:17440
    s_waitcnt lgkmcnt(6)
    v_mfma_f32_16x16x32_bf16 v[136:139], v[232:235], v[24:27], v[136:139]
    ds_read_b64_tr_b16 v[224:225], v7 offset:16640
    v_mfma_f32_16x16x32_bf16 v[140:143], v[232:235], v[28:31], v[140:143]
    s_add_u32 s22, s24, 0x392000
    s_add_u32 m0, s20, 0x1c400
    s_nop 0
    buffer_load_dwordx4 v3, s[4:7], s22 offen lds
    ds_read_b64_tr_b16 v[226:227], v7 offset:17664
    s_waitcnt lgkmcnt(6)
    v_mfma_f32_16x16x32_bf16 v[144:147], v[236:239], v[24:27], v[144:147]
    ds_read_b64_tr_b16 v[228:229], v8 offset:16672
    v_mfma_f32_16x16x32_bf16 v[148:151], v[236:239], v[28:31], v[148:151]
    ds_read_b64_tr_b16 v[230:231], v8 offset:17696
    s_waitcnt vmcnt(16) lgkmcnt(6)
    v_mfma_f32_16x16x32_bf16 v[88:91], v[240:243], v[32:35], v[88:91]
    ds_read_b64_tr_b16 v[232:233], v7 offset:16896
    s_waitcnt vmcnt(15)
    v_mfma_f32_16x16x32_bf16 v[92:95], v[240:243], v[36:39], v[92:95]
    ds_read_b64_tr_b16 v[234:235], v7 offset:17920
    s_waitcnt lgkmcnt(6)
    v_mfma_f32_16x16x32_bf16 v[96:99], v[244:247], v[32:35], v[96:99]
    ds_read_b64_tr_b16 v[236:237], v8 offset:16928
    s_mov_b32 s23, 0xe000
    buffer_load_dwordx4 v[24:27], v6, s[8:11], s23 offen offset:1024 sc1
    v_mfma_f32_16x16x32_bf16 v[100:103], v[244:247], v[36:39], v[100:103]
    ds_read_b64_tr_b16 v[238:239], v8 offset:17952
    s_waitcnt lgkmcnt(6)
    v_mfma_f32_16x16x32_bf16 v[104:107], v[224:227], v[32:35], v[104:107]
    ds_read_b64_tr_b16 v[240:241], v7 offset:17152
    v_mfma_f32_16x16x32_bf16 v[108:111], v[224:227], v[36:39], v[108:111]
    ds_read_b64_tr_b16 v[242:243], v7 offset:18176
    s_mov_b32 s23, 0x2e000
    buffer_load_dwordx4 v[28:31], v6, s[8:11], s23 offen offset:1024 sc1
    s_waitcnt lgkmcnt(6)
    v_mfma_f32_16x16x32_bf16 v[112:115], v[228:231], v[32:35], v[112:115]
    ds_read_b64_tr_b16 v[244:245], v8 offset:17184
    v_mfma_f32_16x16x32_bf16 v[116:119], v[228:231], v[36:39], v[116:119]
    ds_read_b64_tr_b16 v[246:247], v8 offset:18208
    s_waitcnt lgkmcnt(6)
    v_mfma_f32_16x16x32_bf16 v[120:123], v[232:235], v[32:35], v[120:123]
    v_mfma_f32_16x16x32_bf16 v[124:127], v[232:235], v[36:39], v[124:127]
    s_waitcnt vmcnt(15)
    s_barrier
    ds_read_b64_tr_b16 v[224:225], v4 offset:0
    ds_read_b64_tr_b16 v[226:227], v4 offset:1024
    s_waitcnt lgkmcnt(6)
    v_mfma_f32_16x16x32_bf16 v[128:131], v[236:239], v[32:35], v[128:131]
    s_add_u32 s22, s24, 0x20000
    s_add_u32 m0, s20, 0x20000
    s_nop 0
    buffer_load_dwordx4 v3, s[4:7], s22 offen lds
    ds_read_b64_tr_b16 v[228:229], v5 offset:32
    v_mfma_f32_16x16x32_bf16 v[132:135], v[236:239], v[36:39], v[132:135]
    ds_read_b64_tr_b16 v[230:231], v5 offset:1056
    s_waitcnt lgkmcnt(6)
    v_mfma_f32_16x16x32_bf16 v[136:139], v[240:243], v[32:35], v[136:139]
    ds_read_b64_tr_b16 v[232:233], v4 offset:256
    v_mfma_f32_16x16x32_bf16 v[140:143], v[240:243], v[36:39], v[140:143]
    s_add_u32 s22, s24, 0x22000
    s_add_u32 m0, s20, 0x20400
    s_nop 0
    buffer_load_dwordx4 v3, s[4:7], s22 offen lds
    ds_read_b64_tr_b16 v[234:235], v4 offset:1280
    s_waitcnt lgkmcnt(6)
    v_mfma_f32_16x16x32_bf16 v[144:147], v[244:247], v[32:35], v[144:147]
    ds_read_b64_tr_b16 v[236:237], v5 offset:288
    v_mfma_f32_16x16x32_bf16 v[148:151], v[244:247], v[36:39], v[148:151]
    ds_read_b64_tr_b16 v[238:239], v5 offset:1312
    s_waitcnt vmcnt(6)
    v_cmp_ne_u32 vcc, s28, v12
    s_cbranch_vccnz adaLN_cond__sliding_block_cached__moe_arch_mod__prompt_kernel_o28r
adaLN_cond__sliding_block_cached__moe_arch_mod__prompt_kernel_o28b:
    s_waitcnt lgkmcnt(6)
    v_mfma_f32_16x16x32_bf16 v[88:91], v[224:227], v[40:43], v[88:91]
    ds_read_b64_tr_b16 v[240:241], v4 offset:512
    v_mfma_f32_16x16x32_bf16 v[92:95], v[224:227], v[44:47], v[92:95]
    ds_read_b64_tr_b16 v[242:243], v4 offset:1536
    s_waitcnt lgkmcnt(6)
    v_mfma_f32_16x16x32_bf16 v[96:99], v[228:231], v[40:43], v[96:99]
    ds_read_b64_tr_b16 v[244:245], v5 offset:544
    s_mov_b32 s23, 0x0
    buffer_load_dwordx4 v[32:35], v6, s[8:11], s23 offen offset:2048 sc1
    v_mfma_f32_16x16x32_bf16 v[100:103], v[228:231], v[44:47], v[100:103]
    ds_read_b64_tr_b16 v[246:247], v5 offset:1568
    s_waitcnt lgkmcnt(6)
    v_mfma_f32_16x16x32_bf16 v[104:107], v[232:235], v[40:43], v[104:107]
    ds_read_b64_tr_b16 v[224:225], v4 offset:768
    v_mfma_f32_16x16x32_bf16 v[108:111], v[232:235], v[44:47], v[108:111]
    ds_read_b64_tr_b16 v[226:227], v4 offset:1792
    s_mov_b32 s23, 0x20000
    buffer_load_dwordx4 v[36:39], v6, s[8:11], s23 offen offset:2048 sc1
    s_waitcnt lgkmcnt(6)
    v_mfma_f32_16x16x32_bf16 v[112:115], v[236:239], v[40:43], v[112:115]
    ds_read_b64_tr_b16 v[228:229], v5 offset:800
    v_mfma_f32_16x16x32_bf16 v[116:119], v[236:239], v[44:47], v[116:119]
    ds_read_b64_tr_b16 v[230:231], v5 offset:1824
    s_waitcnt lgkmcnt(6)
    v_mfma_f32_16x16x32_bf16 v[120:123], v[240:243], v[40:43], v[120:123]
    v_mfma_f32_16x16x32_bf16 v[124:127], v[240:243], v[44:47], v[124:127]
    s_barrier
    ds_read_b64_tr_b16 v[232:233], v4 offset:16384
    ds_read_b64_tr_b16 v[234:235], v4 offset:17408
    s_waitcnt lgkmcnt(6)
    v_mfma_f32_16x16x32_bf16 v[128:131], v[244:247], v[40:43], v[128:131]
    s_add_u32 s22, s24, 0xa0000
    s_add_u32 m0, s20, 0x24000
    s_nop 0
    buffer_load_dwordx4 v3, s[4:7], s22 offen lds
    ds_read_b64_tr_b16 v[236:237], v5 offset:16416
    v_mfma_f32_16x16x32_bf16 v[132:135], v[244:247], v[44:47], v[132:135]
    ds_read_b64_tr_b16 v[238:239], v5 offset:17440
    s_waitcnt lgkmcnt(6)
    v_mfma_f32_16x16x32_bf16 v[136:139], v[224:227], v[40:43], v[136:139]
    ds_read_b64_tr_b16 v[240:241], v4 offset:16640
    v_mfma_f32_16x16x32_bf16 v[140:143], v[224:227], v[44:47], v[140:143]
    s_add_u32 s22, s24, 0xa2000
    s_add_u32 m0, s20, 0x24400
    s_nop 0
    buffer_load_dwordx4 v3, s[4:7], s22 offen lds
    ds_read_b64_tr_b16 v[242:243], v4 offset:17664
    s_waitcnt lgkmcnt(6)
    v_mfma_f32_16x16x32_bf16 v[144:147], v[228:231], v[40:43], v[144:147]
    ds_read_b64_tr_b16 v[244:245], v5 offset:16672
    v_mfma_f32_16x16x32_bf16 v[148:151], v[228:231], v[44:47], v[148:151]
    ds_read_b64_tr_b16 v[246:247], v5 offset:17696
    s_waitcnt lgkmcnt(6)
    v_mfma_f32_16x16x32_bf16 v[88:91], v[232:235], v[48:51], v[88:91]
    ds_read_b64_tr_b16 v[224:225], v4 offset:16896
    v_mfma_f32_16x16x32_bf16 v[92:95], v[232:235], v[52:55], v[92:95]
    ds_read_b64_tr_b16 v[226:227], v4 offset:17920
    s_waitcnt lgkmcnt(6)
    v_mfma_f32_16x16x32_bf16 v[96:99], v[236:239], v[48:51], v[96:99]
    ds_read_b64_tr_b16 v[228:229], v5 offset:16928
    s_mov_b32 s23, 0x2000
    buffer_load_dwordx4 v[40:43], v6, s[8:11], s23 offen offset:2048 sc1
    v_mfma_f32_16x16x32_bf16 v[100:103], v[236:239], v[52:55], v[100:103]
    ds_read_b64_tr_b16 v[230:231], v5 offset:17952
    s_waitcnt lgkmcnt(6)
    v_mfma_f32_16x16x32_bf16 v[104:107], v[240:243], v[48:51], v[104:107]
    ds_read_b64_tr_b16 v[232:233], v4 offset:17152
    v_mfma_f32_16x16x32_bf16 v[108:111], v[240:243], v[52:55], v[108:111]
    ds_read_b64_tr_b16 v[234:235], v4 offset:18176
    s_mov_b32 s23, 0x22000
    buffer_load_dwordx4 v[44:47], v6, s[8:11], s23 offen offset:2048 sc1
    s_waitcnt lgkmcnt(6)
    v_mfma_f32_16x16x32_bf16 v[112:115], v[244:247], v[48:51], v[112:115]
    ds_read_b64_tr_b16 v[236:237], v5 offset:17184
    v_mfma_f32_16x16x32_bf16 v[116:119], v[244:247], v[52:55], v[116:119]
    ds_read_b64_tr_b16 v[238:239], v5 offset:18208
    s_waitcnt lgkmcnt(6)
    v_mfma_f32_16x16x32_bf16 v[120:123], v[224:227], v[48:51], v[120:123]
    v_mfma_f32_16x16x32_bf16 v[124:127], v[224:227], v[52:55], v[124:127]
    s_barrier
    ds_read_b64_tr_b16 v[240:241], v4 offset:32768
    ds_read_b64_tr_b16 v[242:243], v4 offset:33792
    s_waitcnt lgkmcnt(6)
    v_mfma_f32_16x16x32_bf16 v[128:131], v[228:231], v[48:51], v[128:131]
    s_add_u32 s22, s24, 0x120000
    s_add_u32 m0, s20, 0x10000
    s_nop 0
    buffer_load_dwordx4 v3, s[4:7], s22 offen lds
    ds_read_b64_tr_b16 v[244:245], v5 offset:32800
    v_mfma_f32_16x16x32_bf16 v[132:135], v[228:231], v[52:55], v[132:135]
    ds_read_b64_tr_b16 v[246:247], v5 offset:33824
    s_waitcnt lgkmcnt(6)
    v_mfma_f32_16x16x32_bf16 v[136:139], v[232:235], v[48:51], v[136:139]
    ds_read_b64_tr_b16 v[224:225], v4 offset:33024
    v_mfma_f32_16x16x32_bf16 v[140:143], v[232:235], v[52:55], v[140:143]
    s_add_u32 s22, s24, 0x122000
    s_add_u32 m0, s20, 0x10400
    s_nop 0
    buffer_load_dwordx4 v3, s[4:7], s22 offen lds
    ds_read_b64_tr_b16 v[226:227], v4 offset:34048
    s_waitcnt lgkmcnt(6)
    v_mfma_f32_16x16x32_bf16 v[144:147], v[236:239], v[48:51], v[144:147]
    ds_read_b64_tr_b16 v[228:229], v5 offset:33056
    v_mfma_f32_16x16x32_bf16 v[148:151], v[236:239], v[52:55], v[148:151]
    ds_read_b64_tr_b16 v[230:231], v5 offset:34080
    s_waitcnt lgkmcnt(6)
    v_mfma_f32_16x16x32_bf16 v[88:91], v[240:243], v[56:59], v[88:91]
    ds_read_b64_tr_b16 v[232:233], v4 offset:33280
    v_mfma_f32_16x16x32_bf16 v[92:95], v[240:243], v[60:63], v[92:95]
    ds_read_b64_tr_b16 v[234:235], v4 offset:34304
    s_waitcnt lgkmcnt(6)
    v_mfma_f32_16x16x32_bf16 v[96:99], v[244:247], v[56:59], v[96:99]
    ds_read_b64_tr_b16 v[236:237], v5 offset:33312
    s_mov_b32 s23, 0x4000
    buffer_load_dwordx4 v[48:51], v6, s[8:11], s23 offen offset:2048 sc1
    v_mfma_f32_16x16x32_bf16 v[100:103], v[244:247], v[60:63], v[100:103]
    ds_read_b64_tr_b16 v[238:239], v5 offset:34336
    s_waitcnt lgkmcnt(6)
    v_mfma_f32_16x16x32_bf16 v[104:107], v[224:227], v[56:59], v[104:107]
    ds_read_b64_tr_b16 v[240:241], v4 offset:33536
    v_mfma_f32_16x16x32_bf16 v[108:111], v[224:227], v[60:63], v[108:111]
    ds_read_b64_tr_b16 v[242:243], v4 offset:34560
    s_mov_b32 s23, 0x24000
    buffer_load_dwordx4 v[52:55], v6, s[8:11], s23 offen offset:2048 sc1
    s_waitcnt lgkmcnt(6)
    v_mfma_f32_16x16x32_bf16 v[112:115], v[228:231], v[56:59], v[112:115]
    ds_read_b64_tr_b16 v[244:245], v5 offset:33568
    v_mfma_f32_16x16x32_bf16 v[116:119], v[228:231], v[60:63], v[116:119]
    ds_read_b64_tr_b16 v[246:247], v5 offset:34592
    s_waitcnt lgkmcnt(6)
    v_mfma_f32_16x16x32_bf16 v[120:123], v[232:235], v[56:59], v[120:123]
    v_mfma_f32_16x16x32_bf16 v[124:127], v[232:235], v[60:63], v[124:127]
    s_waitcnt vmcnt(14)
    s_barrier
    ds_read_b64_tr_b16 v[224:225], v4 offset:49152
    ds_read_b64_tr_b16 v[226:227], v4 offset:50176
    s_waitcnt lgkmcnt(6)
    v_mfma_f32_16x16x32_bf16 v[128:131], v[236:239], v[56:59], v[128:131]
    s_add_u32 s22, s24, 0x1a0000
    s_add_u32 m0, s20, 0x14000
    s_nop 0
    buffer_load_dwordx4 v3, s[4:7], s22 offen lds
    ds_read_b64_tr_b16 v[228:229], v5 offset:49184
    v_mfma_f32_16x16x32_bf16 v[132:135], v[236:239], v[60:63], v[132:135]
    ds_read_b64_tr_b16 v[230:231], v5 offset:50208
    s_waitcnt lgkmcnt(6)
    v_mfma_f32_16x16x32_bf16 v[136:139], v[240:243], v[56:59], v[136:139]
    ds_read_b64_tr_b16 v[232:233], v4 offset:49408
    v_mfma_f32_16x16x32_bf16 v[140:143], v[240:243], v[60:63], v[140:143]
    s_add_u32 s22, s24, 0x1a2000
    s_add_u32 m0, s20, 0x14400
    s_nop 0
    buffer_load_dwordx4 v3, s[4:7], s22 offen lds
    ds_read_b64_tr_b16 v[234:235], v4 offset:50432
    s_waitcnt lgkmcnt(6)
    v_mfma_f32_16x16x32_bf16 v[144:147], v[244:247], v[56:59], v[144:147]
    ds_read_b64_tr_b16 v[236:237], v5 offset:49440
    v_mfma_f32_16x16x32_bf16 v[148:151], v[244:247], v[60:63], v[148:151]
    ds_read_b64_tr_b16 v[238:239], v5 offset:50464
    s_waitcnt vmcnt(15) lgkmcnt(6)
    v_mfma_f32_16x16x32_bf16 v[88:91], v[224:227], v[24:27], v[88:91]
    ds_read_b64_tr_b16 v[240:241], v4 offset:49664
    s_waitcnt vmcnt(14)
    v_mfma_f32_16x16x32_bf16 v[92:95], v[224:227], v[28:31], v[92:95]
    ds_read_b64_tr_b16 v[242:243], v4 offset:50688
    s_waitcnt lgkmcnt(6)
    v_mfma_f32_16x16x32_bf16 v[96:99], v[228:231], v[24:27], v[96:99]
    ds_read_b64_tr_b16 v[244:245], v5 offset:49696
    s_mov_b32 s23, 0x6000
    buffer_load_dwordx4 v[56:59], v6, s[8:11], s23 offen offset:2048 sc1
    v_mfma_f32_16x16x32_bf16 v[100:103], v[228:231], v[28:31], v[100:103]
    ds_read_b64_tr_b16 v[246:247], v5 offset:50720
    s_waitcnt lgkmcnt(6)
    v_mfma_f32_16x16x32_bf16 v[104:107], v[232:235], v[24:27], v[104:107]
    ds_read_b64_tr_b16 v[224:225], v4 offset:49920
    v_mfma_f32_16x16x32_bf16 v[108:111], v[232:235], v[28:31], v[108:111]
    ds_read_b64_tr_b16 v[226:227], v4 offset:50944
    s_mov_b32 s23, 0x26000
    buffer_load_dwordx4 v[60:63], v6, s[8:11], s23 offen offset:2048 sc1
    s_waitcnt lgkmcnt(6)
    v_mfma_f32_16x16x32_bf16 v[112:115], v[236:239], v[24:27], v[112:115]
    ds_read_b64_tr_b16 v[228:229], v5 offset:49952
    v_mfma_f32_16x16x32_bf16 v[116:119], v[236:239], v[28:31], v[116:119]
    ds_read_b64_tr_b16 v[230:231], v5 offset:50976
    s_waitcnt lgkmcnt(6)
    v_mfma_f32_16x16x32_bf16 v[120:123], v[240:243], v[24:27], v[120:123]
    v_mfma_f32_16x16x32_bf16 v[124:127], v[240:243], v[28:31], v[124:127]
    s_waitcnt vmcnt(14)
    s_barrier
    ds_read_b64_tr_b16 v[232:233], v7 offset:0
    ds_read_b64_tr_b16 v[234:235], v7 offset:1024
    s_waitcnt lgkmcnt(6)
    v_mfma_f32_16x16x32_bf16 v[128:131], v[244:247], v[24:27], v[128:131]
    s_add_u32 s22, s24, 0x220000
    s_add_u32 m0, s20, 0x18000
    s_nop 0
    buffer_load_dwordx4 v3, s[4:7], s22 offen lds
    ds_read_b64_tr_b16 v[236:237], v8 offset:32
    v_mfma_f32_16x16x32_bf16 v[132:135], v[244:247], v[28:31], v[132:135]
    ds_read_b64_tr_b16 v[238:239], v8 offset:1056
    s_waitcnt lgkmcnt(6)
    v_mfma_f32_16x16x32_bf16 v[136:139], v[224:227], v[24:27], v[136:139]
    ds_read_b64_tr_b16 v[240:241], v7 offset:256
    v_mfma_f32_16x16x32_bf16 v[140:143], v[224:227], v[28:31], v[140:143]
    s_add_u32 s22, s24, 0x222000
    s_add_u32 m0, s20, 0x18400
    s_nop 0
    buffer_load_dwordx4 v3, s[4:7], s22 offen lds
    ds_read_b64_tr_b16 v[242:243], v7 offset:1280
    s_waitcnt lgkmcnt(6)
    v_mfma_f32_16x16x32_bf16 v[144:147], v[228:231], v[24:27], v[144:147]
    ds_read_b64_tr_b16 v[244:245], v8 offset:288
    v_mfma_f32_16x16x32_bf16 v[148:151], v[228:231], v[28:31], v[148:151]
    ds_read_b64_tr_b16 v[246:247], v8 offset:1312
    s_waitcnt vmcnt(15) lgkmcnt(6)
    v_mfma_f32_16x16x32_bf16 v[88:91], v[232:235], v[32:35], v[88:91]
    ds_read_b64_tr_b16 v[224:225], v7 offset:512
    s_waitcnt vmcnt(14)
    v_mfma_f32_16x16x32_bf16 v[92:95], v[232:235], v[36:39], v[92:95]
    ds_read_b64_tr_b16 v[226:227], v7 offset:1536
    s_waitcnt lgkmcnt(6)
    v_mfma_f32_16x16x32_bf16 v[96:99], v[236:239], v[32:35], v[96:99]
    ds_read_b64_tr_b16 v[228:229], v8 offset:544
    s_mov_b32 s23, 0x8000
    buffer_load_dwordx4 v[24:27], v6, s[8:11], s23 offen offset:2048 sc1
    v_mfma_f32_16x16x32_bf16 v[100:103], v[236:239], v[36:39], v[100:103]
    ds_read_b64_tr_b16 v[230:231], v8 offset:1568
    s_waitcnt lgkmcnt(6)
    v_mfma_f32_16x16x32_bf16 v[104:107], v[240:243], v[32:35], v[104:107]
    ds_read_b64_tr_b16 v[232:233], v7 offset:768
    v_mfma_f32_16x16x32_bf16 v[108:111], v[240:243], v[36:39], v[108:111]
    ds_read_b64_tr_b16 v[234:235], v7 offset:1792
    s_mov_b32 s23, 0x28000
    buffer_load_dwordx4 v[28:31], v6, s[8:11], s23 offen offset:2048 sc1
    s_mov_b32 s16, 0x544000
    buffer_load_dwordx4 v[184:187], v2, s[8:11], s16 offen sc1
    s_waitcnt lgkmcnt(6)
    v_mfma_f32_16x16x32_bf16 v[112:115], v[244:247], v[32:35], v[112:115]
    ds_read_b64_tr_b16 v[236:237], v8 offset:800
    v_mfma_f32_16x16x32_bf16 v[116:119], v[244:247], v[36:39], v[116:119]
    ds_read_b64_tr_b16 v[238:239], v8 offset:1824
    s_waitcnt lgkmcnt(6)
    v_mfma_f32_16x16x32_bf16 v[120:123], v[224:227], v[32:35], v[120:123]
    v_mfma_f32_16x16x32_bf16 v[124:127], v[224:227], v[36:39], v[124:127]
    s_waitcnt vmcnt(15)
    s_barrier
    ds_read_b64_tr_b16 v[240:241], v7 offset:16384
    ds_read_b64_tr_b16 v[242:243], v7 offset:17408
    s_waitcnt lgkmcnt(6)
    v_mfma_f32_16x16x32_bf16 v[128:131], v[228:231], v[32:35], v[128:131]
    s_add_u32 s22, s24, 0x2a0000
    s_add_u32 m0, s20, 0x1c000
    s_nop 0
    buffer_load_dwordx4 v3, s[4:7], s22 offen lds
    ds_read_b64_tr_b16 v[244:245], v8 offset:16416
    v_mfma_f32_16x16x32_bf16 v[132:135], v[228:231], v[36:39], v[132:135]
    ds_read_b64_tr_b16 v[246:247], v8 offset:17440
    s_waitcnt lgkmcnt(6)
    v_mfma_f32_16x16x32_bf16 v[136:139], v[232:235], v[32:35], v[136:139]
    ds_read_b64_tr_b16 v[224:225], v7 offset:16640
    v_mfma_f32_16x16x32_bf16 v[140:143], v[232:235], v[36:39], v[140:143]
    s_add_u32 s22, s24, 0x2a2000
    s_add_u32 m0, s20, 0x1c400
    s_nop 0
    buffer_load_dwordx4 v3, s[4:7], s22 offen lds
    ds_read_b64_tr_b16 v[226:227], v7 offset:17664
    s_waitcnt lgkmcnt(6)
    v_mfma_f32_16x16x32_bf16 v[144:147], v[236:239], v[32:35], v[144:147]
    ds_read_b64_tr_b16 v[228:229], v8 offset:16672
    v_mfma_f32_16x16x32_bf16 v[148:151], v[236:239], v[36:39], v[148:151]
    ds_read_b64_tr_b16 v[230:231], v8 offset:17696
    s_waitcnt vmcnt(16) lgkmcnt(6)
    v_mfma_f32_16x16x32_bf16 v[88:91], v[240:243], v[40:43], v[88:91]
    ds_read_b64_tr_b16 v[232:233], v7 offset:16896
    s_waitcnt vmcnt(15)
    v_mfma_f32_16x16x32_bf16 v[92:95], v[240:243], v[44:47], v[92:95]
    ds_read_b64_tr_b16 v[234:235], v7 offset:17920
    s_waitcnt lgkmcnt(6)
    v_mfma_f32_16x16x32_bf16 v[96:99], v[244:247], v[40:43], v[96:99]
    ds_read_b64_tr_b16 v[236:237], v8 offset:16928
    s_mov_b32 s23, 0xa000
    buffer_load_dwordx4 v[32:35], v6, s[8:11], s23 offen offset:2048 sc1
    v_mfma_f32_16x16x32_bf16 v[100:103], v[244:247], v[44:47], v[100:103]
    ds_read_b64_tr_b16 v[238:239], v8 offset:17952
    s_waitcnt lgkmcnt(6)
    v_mfma_f32_16x16x32_bf16 v[104:107], v[224:227], v[40:43], v[104:107]
    ds_read_b64_tr_b16 v[240:241], v7 offset:17152
    v_mfma_f32_16x16x32_bf16 v[108:111], v[224:227], v[44:47], v[108:111]
    ds_read_b64_tr_b16 v[242:243], v7 offset:18176
    s_mov_b32 s23, 0x2a000
    buffer_load_dwordx4 v[36:39], v6, s[8:11], s23 offen offset:2048 sc1
    s_waitcnt lgkmcnt(6)
    v_mfma_f32_16x16x32_bf16 v[112:115], v[228:231], v[40:43], v[112:115]
    ds_read_b64_tr_b16 v[244:245], v8 offset:17184
    v_mfma_f32_16x16x32_bf16 v[116:119], v[228:231], v[44:47], v[116:119]
    ds_read_b64_tr_b16 v[246:247], v8 offset:18208
    s_waitcnt lgkmcnt(6)
    v_mfma_f32_16x16x32_bf16 v[120:123], v[232:235], v[40:43], v[120:123]
    v_mfma_f32_16x16x32_bf16 v[124:127], v[232:235], v[44:47], v[124:127]
    s_waitcnt vmcnt(15)
    s_barrier
    ds_read_b64_tr_b16 v[224:225], v4 offset:0
    ds_read_b64_tr_b16 v[226:227], v4 offset:1024
    s_waitcnt lgkmcnt(6)
    v_mfma_f32_16x16x32_bf16 v[128:131], v[236:239], v[40:43], v[128:131]
    s_add_u32 s22, s24, 0x320000
    s_add_u32 m0, s20, 0x20000
    s_nop 0
    buffer_load_dwordx4 v3, s[4:7], s22 offen lds
    ds_read_b64_tr_b16 v[228:229], v5 offset:32
    v_mfma_f32_16x16x32_bf16 v[132:135], v[236:239], v[44:47], v[132:135]
    ds_read_b64_tr_b16 v[230:231], v5 offset:1056
    s_waitcnt lgkmcnt(6)
    v_mfma_f32_16x16x32_bf16 v[136:139], v[240:243], v[40:43], v[136:139]
    ds_read_b64_tr_b16 v[232:233], v4 offset:256
    v_mfma_f32_16x16x32_bf16 v[140:143], v[240:243], v[44:47], v[140:143]
    s_add_u32 s22, s24, 0x322000
    s_add_u32 m0, s20, 0x20400
    s_nop 0
    buffer_load_dwordx4 v3, s[4:7], s22 offen lds
    ds_read_b64_tr_b16 v[234:235], v4 offset:1280
    s_waitcnt lgkmcnt(6)
    v_mfma_f32_16x16x32_bf16 v[144:147], v[244:247], v[40:43], v[144:147]
    ds_read_b64_tr_b16 v[236:237], v5 offset:288
    v_mfma_f32_16x16x32_bf16 v[148:151], v[244:247], v[44:47], v[148:151]
    ds_read_b64_tr_b16 v[238:239], v5 offset:1312
    s_waitcnt vmcnt(16) lgkmcnt(6)
    v_mfma_f32_16x16x32_bf16 v[88:91], v[224:227], v[48:51], v[88:91]
    ds_read_b64_tr_b16 v[240:241], v4 offset:512
    s_waitcnt vmcnt(15)
    v_mfma_f32_16x16x32_bf16 v[92:95], v[224:227], v[52:55], v[92:95]
    ds_read_b64_tr_b16 v[242:243], v4 offset:1536
    s_waitcnt lgkmcnt(6)
    v_mfma_f32_16x16x32_bf16 v[96:99], v[228:231], v[48:51], v[96:99]
    ds_read_b64_tr_b16 v[244:245], v5 offset:544
    s_mov_b32 s23, 0xc000
    buffer_load_dwordx4 v[40:43], v6, s[8:11], s23 offen offset:2048 sc1
    v_mfma_f32_16x16x32_bf16 v[100:103], v[228:231], v[52:55], v[100:103]
    ds_read_b64_tr_b16 v[246:247], v5 offset:1568
    s_waitcnt lgkmcnt(6)
    v_mfma_f32_16x16x32_bf16 v[104:107], v[232:235], v[48:51], v[104:107]
    ds_read_b64_tr_b16 v[224:225], v4 offset:768
    v_mfma_f32_16x16x32_bf16 v[108:111], v[232:235], v[52:55], v[108:111]
    ds_read_b64_tr_b16 v[226:227], v4 offset:1792
    s_mov_b32 s23, 0x2c000
    buffer_load_dwordx4 v[44:47], v6, s[8:11], s23 offen offset:2048 sc1
    s_waitcnt lgkmcnt(6)
    v_mfma_f32_16x16x32_bf16 v[112:115], v[236:239], v[48:51], v[112:115]
    ds_read_b64_tr_b16 v[228:229], v5 offset:800
    v_mfma_f32_16x16x32_bf16 v[116:119], v[236:239], v[52:55], v[116:119]
    ds_read_b64_tr_b16 v[230:231], v5 offset:1824
    s_waitcnt lgkmcnt(6)
    v_mfma_f32_16x16x32_bf16 v[120:123], v[240:243], v[48:51], v[120:123]
    v_mfma_f32_16x16x32_bf16 v[124:127], v[240:243], v[52:55], v[124:127]
    s_waitcnt vmcnt(15)
    s_barrier
    ds_read_b64_tr_b16 v[232:233], v4 offset:16384
    ds_read_b64_tr_b16 v[234:235], v4 offset:17408
    s_add_u32 s19, s19, 8192
    buffer_load_dword v12, v13, s[8:11], s19 offen sc1
    s_waitcnt lgkmcnt(6)
    v_mfma_f32_16x16x32_bf16 v[128:131], v[244:247], v[48:51], v[128:131]
    s_add_u32 s22, s24, 0x3a0000
    s_add_u32 m0, s20, 0x24000
    s_nop 0
    buffer_load_dwordx4 v3, s[4:7], s22 offen lds
    ds_read_b64_tr_b16 v[236:237], v5 offset:16416
    v_mfma_f32_16x16x32_bf16 v[132:135], v[244:247], v[52:55], v[132:135]
    ds_read_b64_tr_b16 v[238:239], v5 offset:17440
    s_waitcnt lgkmcnt(6)
    v_mfma_f32_16x16x32_bf16 v[136:139], v[224:227], v[48:51], v[136:139]
    ds_read_b64_tr_b16 v[240:241], v4 offset:16640
    v_mfma_f32_16x16x32_bf16 v[140:143], v[224:227], v[52:55], v[140:143]
    s_add_u32 s22, s24, 0x3a2000
    s_add_u32 m0, s20, 0x24400
    s_nop 0
    buffer_load_dwordx4 v3, s[4:7], s22 offen lds
    ds_read_b64_tr_b16 v[242:243], v4 offset:17664
    s_waitcnt lgkmcnt(6)
    v_mfma_f32_16x16x32_bf16 v[144:147], v[228:231], v[48:51], v[144:147]
    ds_read_b64_tr_b16 v[244:245], v5 offset:16672
    v_mfma_f32_16x16x32_bf16 v[148:151], v[228:231], v[52:55], v[148:151]
    ds_read_b64_tr_b16 v[246:247], v5 offset:17696
    s_waitcnt vmcnt(17) lgkmcnt(6)
    v_mfma_f32_16x16x32_bf16 v[88:91], v[232:235], v[56:59], v[88:91]
    ds_read_b64_tr_b16 v[224:225], v4 offset:16896
    s_waitcnt vmcnt(16)
    v_mfma_f32_16x16x32_bf16 v[92:95], v[232:235], v[60:63], v[92:95]
    ds_read_b64_tr_b16 v[226:227], v4 offset:17920
    s_waitcnt lgkmcnt(6)
    v_mfma_f32_16x16x32_bf16 v[96:99], v[236:239], v[56:59], v[96:99]
    ds_read_b64_tr_b16 v[228:229], v5 offset:16928
    s_mov_b32 s23, 0xe000
    buffer_load_dwordx4 v[48:51], v6, s[8:11], s23 offen offset:2048 sc1
    v_mfma_f32_16x16x32_bf16 v[100:103], v[236:239], v[60:63], v[100:103]
    ds_read_b64_tr_b16 v[230:231], v5 offset:17952
    s_waitcnt lgkmcnt(6)
    v_mfma_f32_16x16x32_bf16 v[104:107], v[240:243], v[56:59], v[104:107]
    ds_read_b64_tr_b16 v[232:233], v4 offset:17152
    v_mfma_f32_16x16x32_bf16 v[108:111], v[240:243], v[60:63], v[108:111]
    ds_read_b64_tr_b16 v[234:235], v4 offset:18176
    s_mov_b32 s23, 0x2e000
    buffer_load_dwordx4 v[52:55], v6, s[8:11], s23 offen offset:2048 sc1
    s_waitcnt lgkmcnt(6)
    v_mfma_f32_16x16x32_bf16 v[112:115], v[244:247], v[56:59], v[112:115]
    ds_read_b64_tr_b16 v[236:237], v5 offset:17184
    v_mfma_f32_16x16x32_bf16 v[116:119], v[244:247], v[60:63], v[116:119]
    ds_read_b64_tr_b16 v[238:239], v5 offset:18208
    s_waitcnt lgkmcnt(6)
    v_mfma_f32_16x16x32_bf16 v[120:123], v[224:227], v[56:59], v[120:123]
    v_mfma_f32_16x16x32_bf16 v[124:127], v[224:227], v[60:63], v[124:127]
    s_waitcnt vmcnt(16)
    s_barrier
    ds_read_b64_tr_b16 v[240:241], v4 offset:32768
    ds_read_b64_tr_b16 v[242:243], v4 offset:33792
    s_waitcnt lgkmcnt(6)
    v_mfma_f32_16x16x32_bf16 v[128:131], v[228:231], v[56:59], v[128:131]
    s_add_u32 s22, s24, 0x30000
    s_add_u32 m0, s20, 0x10000
    s_nop 0
    buffer_load_dwordx4 v3, s[4:7], s22 offen lds
    ds_read_b64_tr_b16 v[244:245], v5 offset:32800
    v_mfma_f32_16x16x32_bf16 v[132:135], v[228:231], v[60:63], v[132:135]
    ds_read_b64_tr_b16 v[246:247], v5 offset:33824
    s_waitcnt lgkmcnt(6)
    v_mfma_f32_16x16x32_bf16 v[136:139], v[232:235], v[56:59], v[136:139]
    ds_read_b64_tr_b16 v[224:225], v4 offset:33024
    v_mfma_f32_16x16x32_bf16 v[140:143], v[232:235], v[60:63], v[140:143]
    s_add_u32 s22, s24, 0x32000
    s_add_u32 m0, s20, 0x10400
    s_nop 0
    buffer_load_dwordx4 v3, s[4:7], s22 offen lds
    ds_read_b64_tr_b16 v[226:227], v4 offset:34048
    s_waitcnt lgkmcnt(6)
    v_mfma_f32_16x16x32_bf16 v[144:147], v[236:239], v[56:59], v[144:147]
    ds_read_b64_tr_b16 v[228:229], v5 offset:33056
    v_mfma_f32_16x16x32_bf16 v[148:151], v[236:239], v[60:63], v[148:151]
    ds_read_b64_tr_b16 v[230:231], v5 offset:34080
    s_waitcnt vmcnt(6)
    v_cmp_ne_u32 vcc, s28, v12
    s_cbranch_vccnz adaLN_cond__sliding_block_cached__moe_arch_mod__prompt_kernel_o29r
adaLN_cond__sliding_block_cached__moe_arch_mod__prompt_kernel_o29b:
    s_waitcnt lgkmcnt(6)
    v_mfma_f32_16x16x32_bf16 v[88:91], v[240:243], v[24:27], v[88:91]
    ds_read_b64_tr_b16 v[232:233], v4 offset:33280
    v_mfma_f32_16x16x32_bf16 v[92:95], v[240:243], v[28:31], v[92:95]
    ds_read_b64_tr_b16 v[234:235], v4 offset:34304
    s_waitcnt lgkmcnt(6)
    v_mfma_f32_16x16x32_bf16 v[96:99], v[244:247], v[24:27], v[96:99]
    ds_read_b64_tr_b16 v[236:237], v5 offset:33312
    s_mov_b32 s23, 0x0
    buffer_load_dwordx4 v[56:59], v6, s[8:11], s23 offen offset:3072 sc1
    v_mfma_f32_16x16x32_bf16 v[100:103], v[244:247], v[28:31], v[100:103]
    ds_read_b64_tr_b16 v[238:239], v5 offset:34336
    s_waitcnt lgkmcnt(6)
    v_mfma_f32_16x16x32_bf16 v[104:107], v[224:227], v[24:27], v[104:107]
    ds_read_b64_tr_b16 v[240:241], v4 offset:33536
    v_mfma_f32_16x16x32_bf16 v[108:111], v[224:227], v[28:31], v[108:111]
    ds_read_b64_tr_b16 v[242:243], v4 offset:34560
    s_mov_b32 s23, 0x20000
    buffer_load_dwordx4 v[60:63], v6, s[8:11], s23 offen offset:3072 sc1
    v_xor_b32 v16, s28, v184
    v_xor_b32 v17, s28, v185
    v_xor_b32 v18, s28, v186
    v_xor_b32 v19, s28, v187
    v_or3_b32 v16, v16, v17, v18
    v_or_b32 v16, v16, v19
    v_cmp_ne_u32 vcc, 0, v16
    s_cbranch_vccnz adaLN_cond__sliding_block_cached__moe_arch_mod__prompt_kernel_mf10r
adaLN_cond__sliding_block_cached__moe_arch_mod__prompt_kernel_mf10b:
    s_waitcnt lgkmcnt(6)
    v_mfma_f32_16x16x32_bf16 v[112:115], v[228:231], v[24:27], v[112:115]
    ds_read_b64_tr_b16 v[244:245], v5 offset:33568
    v_mfma_f32_16x16x32_bf16 v[116:119], v[228:231], v[28:31], v[116:119]
    ds_read_b64_tr_b16 v[246:247], v5 offset:34592
    s_waitcnt lgkmcnt(6)
    v_mfma_f32_16x16x32_bf16 v[120:123], v[232:235], v[24:27], v[120:123]
    v_mfma_f32_16x16x32_bf16 v[124:127], v[232:235], v[28:31], v[124:127]
    s_barrier
    ds_read_b64_tr_b16 v[224:225], v4 offset:49152
    ds_read_b64_tr_b16 v[226:227], v4 offset:50176
    s_waitcnt lgkmcnt(6)
    v_mfma_f32_16x16x32_bf16 v[128:131], v[236:239], v[24:27], v[128:131]
    s_add_u32 s22, s24, 0xb0000
    s_add_u32 m0, s20, 0x14000
    s_nop 0
    buffer_load_dwordx4 v3, s[4:7], s22 offen lds
    ds_read_b64_tr_b16 v[228:229], v5 offset:49184
    v_mfma_f32_16x16x32_bf16 v[132:135], v[236:239], v[28:31], v[132:135]
    ds_read_b64_tr_b16 v[230:231], v5 offset:50208
    s_waitcnt lgkmcnt(6)
    v_mfma_f32_16x16x32_bf16 v[136:139], v[240:243], v[24:27], v[136:139]
    ds_read_b64_tr_b16 v[232:233], v4 offset:49408
    v_mfma_f32_16x16x32_bf16 v[140:143], v[240:243], v[28:31], v[140:143]
    s_add_u32 s22, s24, 0xb2000
    s_add_u32 m0, s20, 0x14400
    s_nop 0
    buffer_load_dwordx4 v3, s[4:7], s22 offen lds
    ds_read_b64_tr_b16 v[234:235], v4 offset:50432
    s_waitcnt lgkmcnt(6)
    v_mfma_f32_16x16x32_bf16 v[144:147], v[244:247], v[24:27], v[144:147]
    ds_read_b64_tr_b16 v[236:237], v5 offset:49440
    v_mfma_f32_16x16x32_bf16 v[148:151], v[244:247], v[28:31], v[148:151]
    ds_read_b64_tr_b16 v[238:239], v5 offset:50464
    s_waitcnt lgkmcnt(6)
    v_mfma_f32_16x16x32_bf16 v[88:91], v[224:227], v[32:35], v[88:91]
    ds_read_b64_tr_b16 v[240:241], v4 offset:49664
    v_mfma_f32_16x16x32_bf16 v[92:95], v[224:227], v[36:39], v[92:95]
    ds_read_b64_tr_b16 v[242:243], v4 offset:50688
    s_waitcnt lgkmcnt(6)
    v_mfma_f32_16x16x32_bf16 v[96:99], v[228:231], v[32:35], v[96:99]
    ds_read_b64_tr_b16 v[244:245], v5 offset:49696
    s_mov_b32 s23, 0x2000
    buffer_load_dwordx4 v[24:27], v6, s[8:11], s23 offen offset:3072 sc1
    v_mfma_f32_16x16x32_bf16 v[100:103], v[228:231], v[36:39], v[100:103]
    ds_read_b64_tr_b16 v[246:247], v5 offset:50720
    s_waitcnt lgkmcnt(6)
    v_mfma_f32_16x16x32_bf16 v[104:107], v[232:235], v[32:35], v[104:107]
    ds_read_b64_tr_b16 v[224:225], v4 offset:49920
    v_mfma_f32_16x16x32_bf16 v[108:111], v[232:235], v[36:39], v[108:111]
    ds_read_b64_tr_b16 v[226:227], v4 offset:50944
    s_mov_b32 s23, 0x22000
    buffer_load_dwordx4 v[28:31], v6, s[8:11], s23 offen offset:3072 sc1
    s_waitcnt lgkmcnt(6)
    v_mfma_f32_16x16x32_bf16 v[112:115], v[236:239], v[32:35], v[112:115]
    ds_read_b64_tr_b16 v[228:229], v5 offset:49952
    v_mfma_f32_16x16x32_bf16 v[116:119], v[236:239], v[36:39], v[116:119]
    ds_read_b64_tr_b16 v[230:231], v5 offset:50976
    s_waitcnt lgkmcnt(6)
    v_mfma_f32_16x16x32_bf16 v[120:123], v[240:243], v[32:35], v[120:123]
    v_mfma_f32_16x16x32_bf16 v[124:127], v[240:243], v[36:39], v[124:127]
    s_barrier
    ds_read_b64_tr_b16 v[232:233], v7 offset:0
    ds_read_b64_tr_b16 v[234:235], v7 offset:1024
    s_waitcnt lgkmcnt(6)
    v_mfma_f32_16x16x32_bf16 v[128:131], v[244:247], v[32:35], v[128:131]
    s_add_u32 s22, s24, 0x130000
    s_add_u32 m0, s20, 0x18000
    s_nop 0
    buffer_load_dwordx4 v3, s[4:7], s22 offen lds
    ds_read_b64_tr_b16 v[236:237], v8 offset:32
    v_mfma_f32_16x16x32_bf16 v[132:135], v[244:247], v[36:39], v[132:135]
    ds_read_b64_tr_b16 v[238:239], v8 offset:1056
    s_waitcnt lgkmcnt(6)
    v_mfma_f32_16x16x32_bf16 v[136:139], v[224:227], v[32:35], v[136:139]
    ds_read_b64_tr_b16 v[240:241], v7 offset:256
    v_mfma_f32_16x16x32_bf16 v[140:143], v[224:227], v[36:39], v[140:143]
    s_add_u32 s22, s24, 0x132000
    s_add_u32 m0, s20, 0x18400
    s_nop 0
    buffer_load_dwordx4 v3, s[4:7], s22 offen lds
    ds_read_b64_tr_b16 v[242:243], v7 offset:1280
    s_waitcnt lgkmcnt(6)
    v_mfma_f32_16x16x32_bf16 v[144:147], v[228:231], v[32:35], v[144:147]
    ds_read_b64_tr_b16 v[244:245], v8 offset:288
    v_mfma_f32_16x16x32_bf16 v[148:151], v[228:231], v[36:39], v[148:151]
    ds_read_b64_tr_b16 v[246:247], v8 offset:1312
    s_waitcnt lgkmcnt(6)
    v_mfma_f32_16x16x32_bf16 v[88:91], v[232:235], v[40:43], v[88:91]
    ds_read_b64_tr_b16 v[224:225], v7 offset:512
    v_mfma_f32_16x16x32_bf16 v[92:95], v[232:235], v[44:47], v[92:95]
    ds_read_b64_tr_b16 v[226:227], v7 offset:1536
    s_waitcnt lgkmcnt(6)
    v_mfma_f32_16x16x32_bf16 v[96:99], v[236:239], v[40:43], v[96:99]
    ds_read_b64_tr_b16 v[228:229], v8 offset:544
    s_mov_b32 s23, 0x4000
    buffer_load_dwordx4 v[32:35], v6, s[8:11], s23 offen offset:3072 sc1
    v_mfma_f32_16x16x32_bf16 v[100:103], v[236:239], v[44:47], v[100:103]
    ds_read_b64_tr_b16 v[230:231], v8 offset:1568
    s_waitcnt lgkmcnt(6)
    v_mfma_f32_16x16x32_bf16 v[104:107], v[240:243], v[40:43], v[104:107]
    ds_read_b64_tr_b16 v[232:233], v7 offset:768
    v_mfma_f32_16x16x32_bf16 v[108:111], v[240:243], v[44:47], v[108:111]
    ds_read_b64_tr_b16 v[234:235], v7 offset:1792
    s_mov_b32 s23, 0x24000
    buffer_load_dwordx4 v[36:39], v6, s[8:11], s23 offen offset:3072 sc1
    s_waitcnt lgkmcnt(6)
    v_mfma_f32_16x16x32_bf16 v[112:115], v[244:247], v[40:43], v[112:115]
    ds_read_b64_tr_b16 v[236:237], v8 offset:800
    v_mfma_f32_16x16x32_bf16 v[116:119], v[244:247], v[44:47], v[116:119]
    ds_read_b64_tr_b16 v[238:239], v8 offset:1824
    s_waitcnt lgkmcnt(6)
    v_mfma_f32_16x16x32_bf16 v[120:123], v[224:227], v[40:43], v[120:123]
    v_mfma_f32_16x16x32_bf16 v[124:127], v[224:227], v[44:47], v[124:127]
    s_waitcnt vmcnt(14)
    s_barrier
    ds_read_b64_tr_b16 v[240:241], v7 offset:16384
    ds_read_b64_tr_b16 v[242:243], v7 offset:17408
    s_waitcnt lgkmcnt(6)
    v_mfma_f32_16x16x32_bf16 v[128:131], v[228:231], v[40:43], v[128:131]
    s_add_u32 s22, s24, 0x1b0000
    s_add_u32 m0, s20, 0x1c000
    s_nop 0
    buffer_load_dwordx4 v3, s[4:7], s22 offen lds
    ds_read_b64_tr_b16 v[244:245], v8 offset:16416
    v_mfma_f32_16x16x32_bf16 v[132:135], v[228:231], v[44:47], v[132:135]
    ds_read_b64_tr_b16 v[246:247], v8 offset:17440
    s_waitcnt lgkmcnt(6)
    v_mfma_f32_16x16x32_bf16 v[136:139], v[232:235], v[40:43], v[136:139]
    ds_read_b64_tr_b16 v[224:225], v7 offset:16640
    v_mfma_f32_16x16x32_bf16 v[140:143], v[232:235], v[44:47], v[140:143]
    s_add_u32 s22, s24, 0x1b2000
    s_add_u32 m0, s20, 0x1c400
    s_nop 0
    buffer_load_dwordx4 v3, s[4:7], s22 offen lds
    ds_read_b64_tr_b16 v[226:227], v7 offset:17664
    s_waitcnt lgkmcnt(6)
    v_mfma_f32_16x16x32_bf16 v[144:147], v[236:239], v[40:43], v[144:147]
    ds_read_b64_tr_b16 v[228:229], v8 offset:16672
    v_mfma_f32_16x16x32_bf16 v[148:151], v[236:239], v[44:47], v[148:151]
    ds_read_b64_tr_b16 v[230:231], v8 offset:17696
    s_waitcnt vmcnt(15) lgkmcnt(6)
    v_mfma_f32_16x16x32_bf16 v[88:91], v[240:243], v[48:51], v[88:91]
    ds_read_b64_tr_b16 v[232:233], v7 offset:16896
    s_waitcnt vmcnt(14)
    v_mfma_f32_16x16x32_bf16 v[92:95], v[240:243], v[52:55], v[92:95]
    ds_read_b64_tr_b16 v[234:235], v7 offset:17920
    s_waitcnt lgkmcnt(6)
    v_mfma_f32_16x16x32_bf16 v[96:99], v[244:247], v[48:51], v[96:99]
    ds_read_b64_tr_b16 v[236:237], v8 offset:16928
    s_mov_b32 s23, 0x6000
    buffer_load_dwordx4 v[40:43], v6, s[8:11], s23 offen offset:3072 sc1
    v_mfma_f32_16x16x32_bf16 v[100:103], v[244:247], v[52:55], v[100:103]
    ds_read_b64_tr_b16 v[238:239], v8 offset:17952
    s_waitcnt lgkmcnt(6)
    v_mfma_f32_16x16x32_bf16 v[104:107], v[224:227], v[48:51], v[104:107]
    ds_read_b64_tr_b16 v[240:241], v7 offset:17152
    v_mfma_f32_16x16x32_bf16 v[108:111], v[224:227], v[52:55], v[108:111]
    ds_read_b64_tr_b16 v[242:243], v7 offset:18176
    s_mov_b32 s23, 0x26000
    buffer_load_dwordx4 v[44:47], v6, s[8:11], s23 offen offset:3072 sc1
    s_waitcnt lgkmcnt(6)
    v_mfma_f32_16x16x32_bf16 v[112:115], v[228:231], v[48:51], v[112:115]
    ds_read_b64_tr_b16 v[244:245], v8 offset:17184
    v_mfma_f32_16x16x32_bf16 v[116:119], v[228:231], v[52:55], v[116:119]
    ds_read_b64_tr_b16 v[246:247], v8 offset:18208
    s_waitcnt lgkmcnt(6)
    v_mfma_f32_16x16x32_bf16 v[120:123], v[232:235], v[48:51], v[120:123]
    v_mfma_f32_16x16x32_bf16 v[124:127], v[232:235], v[52:55], v[124:127]
    s_waitcnt vmcnt(14)
    s_barrier
    ds_read_b64_tr_b16 v[224:225], v4 offset:0
    ds_read_b64_tr_b16 v[226:227], v4 offset:1024
    s_waitcnt lgkmcnt(6)
    v_mfma_f32_16x16x32_bf16 v[128:131], v[236:239], v[48:51], v[128:131]
    s_add_u32 s22, s24, 0x230000
    s_add_u32 m0, s20, 0x20000
    s_nop 0
    buffer_load_dwordx4 v3, s[4:7], s22 offen lds
    ds_read_b64_tr_b16 v[228:229], v5 offset:32
    v_mfma_f32_16x16x32_bf16 v[132:135], v[236:239], v[52:55], v[132:135]
    ds_read_b64_tr_b16 v[230:231], v5 offset:1056
    s_waitcnt lgkmcnt(6)
    v_mfma_f32_16x16x32_bf16 v[136:139], v[240:243], v[48:51], v[136:139]
    ds_read_b64_tr_b16 v[232:233], v4 offset:256
    v_mfma_f32_16x16x32_bf16 v[140:143], v[240:243], v[52:55], v[140:143]
    s_add_u32 s22, s24, 0x232000
    s_add_u32 m0, s20, 0x20400
    s_nop 0
    buffer_load_dwordx4 v3, s[4:7], s22 offen lds
    ds_read_b64_tr_b16 v[234:235], v4 offset:1280
    s_waitcnt lgkmcnt(6)
    v_mfma_f32_16x16x32_bf16 v[144:147], v[244:247], v[48:51], v[144:147]
    ds_read_b64_tr_b16 v[236:237], v5 offset:288
    v_mfma_f32_16x16x32_bf16 v[148:151], v[244:247], v[52:55], v[148:151]
    ds_read_b64_tr_b16 v[238:239], v5 offset:1312
    s_waitcnt vmcnt(15) lgkmcnt(6)
    v_mfma_f32_16x16x32_bf16 v[88:91], v[224:227], v[56:59], v[88:91]
    ds_read_b64_tr_b16 v[240:241], v4 offset:512
    s_waitcnt vmcnt(14)
    v_mfma_f32_16x16x32_bf16 v[92:95], v[224:227], v[60:63], v[92:95]
    ds_read_b64_tr_b16 v[242:243], v4 offset:1536
    s_waitcnt lgkmcnt(6)
    v_mfma_f32_16x16x32_bf16 v[96:99], v[228:231], v[56:59], v[96:99]
    ds_read_b64_tr_b16 v[244:245], v5 offset:544
    s_mov_b32 s23, 0x8000
    buffer_load_dwordx4 v[48:51], v6, s[8:11], s23 offen offset:3072 sc1
    v_mfma_f32_16x16x32_bf16 v[100:103], v[228:231], v[60:63], v[100:103]
    ds_read_b64_tr_b16 v[246:247], v5 offset:1568
    s_waitcnt lgkmcnt(6)
    v_mfma_f32_16x16x32_bf16 v[104:107], v[232:235], v[56:59], v[104:107]
    ds_read_b64_tr_b16 v[224:225], v4 offset:768
    v_mfma_f32_16x16x32_bf16 v[108:111], v[232:235], v[60:63], v[108:111]
    ds_read_b64_tr_b16 v[226:227], v4 offset:1792
    s_mov_b32 s23, 0x28000
    buffer_load_dwordx4 v[52:55], v6, s[8:11], s23 offen offset:3072 sc1
    s_waitcnt lgkmcnt(6)
    v_mfma_f32_16x16x32_bf16 v[112:115], v[236:239], v[56:59], v[112:115]
    ds_read_b64_tr_b16 v[228:229], v5 offset:800
    v_mfma_f32_16x16x32_bf16 v[116:119], v[236:239], v[60:63], v[116:119]
    ds_read_b64_tr_b16 v[230:231], v5 offset:1824
    s_waitcnt lgkmcnt(6)
    v_mfma_f32_16x16x32_bf16 v[120:123], v[240:243], v[56:59], v[120:123]
    v_mfma_f32_16x16x32_bf16 v[124:127], v[240:243], v[60:63], v[124:127]
    s_waitcnt vmcnt(14)
    s_barrier
    ds_read_b64_tr_b16 v[232:233], v4 offset:16384
    ds_read_b64_tr_b16 v[234:235], v4 offset:17408
    s_waitcnt lgkmcnt(6)
    v_mfma_f32_16x16x32_bf16 v[128:131], v[244:247], v[56:59], v[128:131]
    s_add_u32 s22, s24, 0x2b0000
    s_add_u32 m0, s20, 0x24000
    s_nop 0
    buffer_load_dwordx4 v3, s[4:7], s22 offen lds
    ds_read_b64_tr_b16 v[236:237], v5 offset:16416
    v_mfma_f32_16x16x32_bf16 v[132:135], v[244:247], v[60:63], v[132:135]
    ds_read_b64_tr_b16 v[238:239], v5 offset:17440
    s_waitcnt lgkmcnt(6)
    v_mfma_f32_16x16x32_bf16 v[136:139], v[224:227], v[56:59], v[136:139]
    ds_read_b64_tr_b16 v[240:241], v4 offset:16640
    v_mfma_f32_16x16x32_bf16 v[140:143], v[224:227], v[60:63], v[140:143]
    s_add_u32 s22, s24, 0x2b2000
    s_add_u32 m0, s20, 0x24400
    s_nop 0
    buffer_load_dwordx4 v3, s[4:7], s22 offen lds
    ds_read_b64_tr_b16 v[242:243], v4 offset:17664
    s_waitcnt lgkmcnt(6)
    v_mfma_f32_16x16x32_bf16 v[144:147], v[228:231], v[56:59], v[144:147]
    ds_read_b64_tr_b16 v[244:245], v5 offset:16672
    v_mfma_f32_16x16x32_bf16 v[148:151], v[228:231], v[60:63], v[148:151]
    ds_read_b64_tr_b16 v[246:247], v5 offset:17696
    s_waitcnt vmcnt(15) lgkmcnt(6)
    v_mfma_f32_16x16x32_bf16 v[88:91], v[232:235], v[24:27], v[88:91]
    ds_read_b64_tr_b16 v[224:225], v4 offset:16896
    s_waitcnt vmcnt(14)
    v_mfma_f32_16x16x32_bf16 v[92:95], v[232:235], v[28:31], v[92:95]
    ds_read_b64_tr_b16 v[226:227], v4 offset:17920
    s_waitcnt lgkmcnt(6)
    v_mfma_f32_16x16x32_bf16 v[96:99], v[236:239], v[24:27], v[96:99]
    ds_read_b64_tr_b16 v[228:229], v5 offset:16928
    s_mov_b32 s23, 0xa000
    buffer_load_dwordx4 v[56:59], v6, s[8:11], s23 offen offset:3072 sc1
    v_mfma_f32_16x16x32_bf16 v[100:103], v[236:239], v[28:31], v[100:103]
    ds_read_b64_tr_b16 v[230:231], v5 offset:17952
    s_waitcnt lgkmcnt(6)
    v_mfma_f32_16x16x32_bf16 v[104:107], v[240:243], v[24:27], v[104:107]
    ds_read_b64_tr_b16 v[232:233], v4 offset:17152
    v_mfma_f32_16x16x32_bf16 v[108:111], v[240:243], v[28:31], v[108:111]
    ds_read_b64_tr_b16 v[234:235], v4 offset:18176
    s_mov_b32 s23, 0x2a000
    buffer_load_dwordx4 v[60:63], v6, s[8:11], s23 offen offset:3072 sc1
    s_waitcnt lgkmcnt(6)
    v_mfma_f32_16x16x32_bf16 v[112:115], v[244:247], v[24:27], v[112:115]
    ds_read_b64_tr_b16 v[236:237], v5 offset:17184
    v_mfma_f32_16x16x32_bf16 v[116:119], v[244:247], v[28:31], v[116:119]
    ds_read_b64_tr_b16 v[238:239], v5 offset:18208
    s_waitcnt lgkmcnt(6)
    v_mfma_f32_16x16x32_bf16 v[120:123], v[224:227], v[24:27], v[120:123]
    v_mfma_f32_16x16x32_bf16 v[124:127], v[224:227], v[28:31], v[124:127]
    s_waitcnt vmcnt(14)
    s_barrier
    ds_read_b64_tr_b16 v[240:241], v4 offset:32768
    ds_read_b64_tr_b16 v[242:243], v4 offset:33792
    s_waitcnt lgkmcnt(6)
    v_mfma_f32_16x16x32_bf16 v[128:131], v[228:231], v[24:27], v[128:131]
    s_add_u32 s22, s24, 0x330000
    s_add_u32 m0, s20, 0x10000
    s_nop 0
    buffer_load_dwordx4 v3, s[4:7], s22 offen lds
    ds_read_b64_tr_b16 v[244:245], v5 offset:32800
    v_mfma_f32_16x16x32_bf16 v[132:135], v[228:231], v[28:31], v[132:135]
    ds_read_b64_tr_b16 v[246:247], v5 offset:33824
    s_waitcnt lgkmcnt(6)
    v_mfma_f32_16x16x32_bf16 v[136:139], v[232:235], v[24:27], v[136:139]
    ds_read_b64_tr_b16 v[224:225], v4 offset:33024
    v_mfma_f32_16x16x32_bf16 v[140:143], v[232:235], v[28:31], v[140:143]
    s_add_u32 s22, s24, 0x332000
    s_add_u32 m0, s20, 0x10400
    s_nop 0
    buffer_load_dwordx4 v3, s[4:7], s22 offen lds
    ds_read_b64_tr_b16 v[226:227], v4 offset:34048
    s_waitcnt lgkmcnt(6)
    v_mfma_f32_16x16x32_bf16 v[144:147], v[236:239], v[24:27], v[144:147]
    ds_read_b64_tr_b16 v[228:229], v5 offset:33056
    v_mfma_f32_16x16x32_bf16 v[148:151], v[236:239], v[28:31], v[148:151]
    ds_read_b64_tr_b16 v[230:231], v5 offset:34080
    s_waitcnt vmcnt(15) lgkmcnt(6)
    v_mfma_f32_16x16x32_bf16 v[88:91], v[240:243], v[32:35], v[88:91]
    ds_read_b64_tr_b16 v[232:233], v4 offset:33280
    s_waitcnt vmcnt(14)
    v_mfma_f32_16x16x32_bf16 v[92:95], v[240:243], v[36:39], v[92:95]
    ds_read_b64_tr_b16 v[234:235], v4 offset:34304
    s_waitcnt lgkmcnt(6)
    v_mfma_f32_16x16x32_bf16 v[96:99], v[244:247], v[32:35], v[96:99]
    ds_read_b64_tr_b16 v[236:237], v5 offset:33312
    s_mov_b32 s23, 0xc000
    buffer_load_dwordx4 v[24:27], v6, s[8:11], s23 offen offset:3072 sc1
    v_mfma_f32_16x16x32_bf16 v[100:103], v[244:247], v[36:39], v[100:103]
    ds_read_b64_tr_b16 v[238:239], v5 offset:34336
    s_waitcnt lgkmcnt(6)
    v_mfma_f32_16x16x32_bf16 v[104:107], v[224:227], v[32:35], v[104:107]
    ds_read_b64_tr_b16 v[240:241], v4 offset:33536
    v_mfma_f32_16x16x32_bf16 v[108:111], v[224:227], v[36:39], v[108:111]
    ds_read_b64_tr_b16 v[242:243], v4 offset:34560
    s_mov_b32 s23, 0x2c000
    buffer_load_dwordx4 v[28:31], v6, s[8:11], s23 offen offset:3072 sc1
    v_lshrrev_b32 v16, 4, v1
    v_lshlrev_b32 v16, 3, v16
    s_lshl_b32 s16, s31, 8
    s_add_u32 s16, s16, 0x540000
    buffer_load_dwordx2 v[248:249], v16, s[8:11], s16 offen offset:0 sc1
    buffer_load_dwordx2 v[250:251], v16, s[8:11], s16 offen offset:32 sc1
    buffer_load_dwordx2 v[252:253], v16, s[8:11], s16 offen offset:64 sc1
    buffer_load_dwordx2 v[254:255], v16, s[8:11], s16 offen offset:96 sc1
    s_waitcnt lgkmcnt(6)
    v_mfma_f32_16x16x32_bf16 v[112:115], v[228:231], v[32:35], v[112:115]
    ds_read_b64_tr_b16 v[244:245], v5 offset:33568
    v_mfma_f32_16x16x32_bf16 v[116:119], v[228:231], v[36:39], v[116:119]
    ds_read_b64_tr_b16 v[246:247], v5 offset:34592
    s_waitcnt lgkmcnt(6)
    v_mfma_f32_16x16x32_bf16 v[120:123], v[232:235], v[32:35], v[120:123]
    v_mfma_f32_16x16x32_bf16 v[124:127], v[232:235], v[36:39], v[124:127]
    s_waitcnt vmcnt(18)
    s_barrier
    ds_read_b64_tr_b16 v[224:225], v4 offset:49152
    ds_read_b64_tr_b16 v[226:227], v4 offset:50176
    s_waitcnt lgkmcnt(6)
    v_mfma_f32_16x16x32_bf16 v[128:131], v[236:239], v[32:35], v[128:131]
    s_add_u32 s22, s24, 0x3b0000
    s_add_u32 m0, s20, 0x14000
    s_nop 0
    buffer_load_dwordx4 v3, s[4:7], s22 offen lds
    ds_read_b64_tr_b16 v[228:229], v5 offset:49184
    v_mfma_f32_16x16x32_bf16 v[132:135], v[236:239], v[36:39], v[132:135]
    ds_read_b64_tr_b16 v[230:231], v5 offset:50208
    s_waitcnt lgkmcnt(6)
    v_mfma_f32_16x16x32_bf16 v[136:139], v[240:243], v[32:35], v[136:139]
    ds_read_b64_tr_b16 v[232:233], v4 offset:49408
    v_mfma_f32_16x16x32_bf16 v[140:143], v[240:243], v[36:39], v[140:143]
    s_add_u32 s22, s24, 0x3b2000
    s_add_u32 m0, s20, 0x14400
    s_nop 0
    buffer_load_dwordx4 v3, s[4:7], s22 offen lds
    ds_read_b64_tr_b16 v[234:235], v4 offset:50432
    s_waitcnt lgkmcnt(6)
    v_mfma_f32_16x16x32_bf16 v[144:147], v[244:247], v[32:35], v[144:147]
    ds_read_b64_tr_b16 v[236:237], v5 offset:49440
    v_mfma_f32_16x16x32_bf16 v[148:151], v[244:247], v[36:39], v[148:151]
    ds_read_b64_tr_b16 v[238:239], v5 offset:50464
    s_waitcnt vmcnt(19) lgkmcnt(6)
    v_mfma_f32_16x16x32_bf16 v[88:91], v[224:227], v[40:43], v[88:91]
    ds_read_b64_tr_b16 v[240:241], v4 offset:49664
    s_waitcnt vmcnt(18)
    v_mfma_f32_16x16x32_bf16 v[92:95], v[224:227], v[44:47], v[92:95]
    ds_read_b64_tr_b16 v[242:243], v4 offset:50688
    s_waitcnt lgkmcnt(6)
    v_mfma_f32_16x16x32_bf16 v[96:99], v[228:231], v[40:43], v[96:99]
    ds_read_b64_tr_b16 v[244:245], v5 offset:49696
    s_mov_b32 s23, 0xe000
    buffer_load_dwordx4 v[32:35], v6, s[8:11], s23 offen offset:3072 sc1
    v_mfma_f32_16x16x32_bf16 v[100:103], v[228:231], v[44:47], v[100:103]
    ds_read_b64_tr_b16 v[246:247], v5 offset:50720
    s_waitcnt lgkmcnt(6)
    v_mfma_f32_16x16x32_bf16 v[104:107], v[232:235], v[40:43], v[104:107]
    ds_read_b64_tr_b16 v[224:225], v4 offset:49920
    v_mfma_f32_16x16x32_bf16 v[108:111], v[232:235], v[44:47], v[108:111]
    ds_read_b64_tr_b16 v[226:227], v4 offset:50944
    s_mov_b32 s23, 0x2e000
    buffer_load_dwordx4 v[36:39], v6, s[8:11], s23 offen offset:3072 sc1
    s_waitcnt lgkmcnt(6)
    v_mfma_f32_16x16x32_bf16 v[112:115], v[236:239], v[40:43], v[112:115]
    ds_read_b64_tr_b16 v[228:229], v5 offset:49952
    v_mfma_f32_16x16x32_bf16 v[116:119], v[236:239], v[44:47], v[116:119]
    ds_read_b64_tr_b16 v[230:231], v5 offset:50976
    s_waitcnt lgkmcnt(6)
    v_mfma_f32_16x16x32_bf16 v[120:123], v[240:243], v[40:43], v[120:123]
    v_mfma_f32_16x16x32_bf16 v[124:127], v[240:243], v[44:47], v[124:127]
    s_waitcnt vmcnt(18)
    s_barrier
    ds_read_b64_tr_b16 v[232:233], v7 offset:0
    ds_read_b64_tr_b16 v[234:235], v7 offset:1024
    s_waitcnt lgkmcnt(6)
    v_mfma_f32_16x16x32_bf16 v[128:131], v[244:247], v[40:43], v[128:131]
    ds_read_b64_tr_b16 v[236:237], v8 offset:32
    v_mfma_f32_16x16x32_bf16 v[132:135], v[244:247], v[44:47], v[132:135]
    ds_read_b64_tr_b16 v[238:239], v8 offset:1056
    s_waitcnt lgkmcnt(6)
    v_mfma_f32_16x16x32_bf16 v[136:139], v[224:227], v[40:43], v[136:139]
    ds_read_b64_tr_b16 v[240:241], v7 offset:256
    v_mfma_f32_16x16x32_bf16 v[140:143], v[224:227], v[44:47], v[140:143]
    ds_read_b64_tr_b16 v[242:243], v7 offset:1280
    s_waitcnt lgkmcnt(6)
    v_mfma_f32_16x16x32_bf16 v[144:147], v[228:231], v[40:43], v[144:147]
    ds_read_b64_tr_b16 v[244:245], v8 offset:288
    v_mfma_f32_16x16x32_bf16 v[148:151], v[228:231], v[44:47], v[148:151]
    ds_read_b64_tr_b16 v[246:247], v8 offset:1312
    s_waitcnt vmcnt(17) lgkmcnt(6)
    v_mfma_f32_16x16x32_bf16 v[88:91], v[232:235], v[48:51], v[88:91]
    ds_read_b64_tr_b16 v[224:225], v7 offset:512
    s_waitcnt vmcnt(16)
    v_mfma_f32_16x16x32_bf16 v[92:95], v[232:235], v[52:55], v[92:95]
    ds_read_b64_tr_b16 v[226:227], v7 offset:1536
    s_waitcnt lgkmcnt(6)
    v_mfma_f32_16x16x32_bf16 v[96:99], v[236:239], v[48:51], v[96:99]
    ds_read_b64_tr_b16 v[228:229], v8 offset:544
    v_mfma_f32_16x16x32_bf16 v[100:103], v[236:239], v[52:55], v[100:103]
    ds_read_b64_tr_b16 v[230:231], v8 offset:1568
    s_waitcnt lgkmcnt(6)
    v_mfma_f32_16x16x32_bf16 v[104:107], v[240:243], v[48:51], v[104:107]
    ds_read_b64_tr_b16 v[232:233], v7 offset:768
    v_mfma_f32_16x16x32_bf16 v[108:111], v[240:243], v[52:55], v[108:111]
    ds_read_b64_tr_b16 v[234:235], v7 offset:1792
    s_waitcnt lgkmcnt(6)
    v_mfma_f32_16x16x32_bf16 v[112:115], v[244:247], v[48:51], v[112:115]
    ds_read_b64_tr_b16 v[236:237], v8 offset:800
    v_mfma_f32_16x16x32_bf16 v[116:119], v[244:247], v[52:55], v[116:119]
    ds_read_b64_tr_b16 v[238:239], v8 offset:1824
    s_waitcnt lgkmcnt(6)
    v_mfma_f32_16x16x32_bf16 v[120:123], v[224:227], v[48:51], v[120:123]
    v_mfma_f32_16x16x32_bf16 v[124:127], v[224:227], v[52:55], v[124:127]
    s_waitcnt vmcnt(14)
    s_barrier
    ds_read_b64_tr_b16 v[240:241], v7 offset:16384
    ds_read_b64_tr_b16 v[242:243], v7 offset:17408
    s_waitcnt lgkmcnt(6)
    v_mfma_f32_16x16x32_bf16 v[128:131], v[228:231], v[48:51], v[128:131]
    ds_read_b64_tr_b16 v[244:245], v8 offset:16416
    v_mfma_f32_16x16x32_bf16 v[132:135], v[228:231], v[52:55], v[132:135]
    ds_read_b64_tr_b16 v[246:247], v8 offset:17440
    s_waitcnt lgkmcnt(6)
    v_mfma_f32_16x16x32_bf16 v[136:139], v[232:235], v[48:51], v[136:139]
    ds_read_b64_tr_b16 v[224:225], v7 offset:16640
    v_mfma_f32_16x16x32_bf16 v[140:143], v[232:235], v[52:55], v[140:143]
    ds_read_b64_tr_b16 v[226:227], v7 offset:17664
    s_waitcnt lgkmcnt(6)
    v_mfma_f32_16x16x32_bf16 v[144:147], v[236:239], v[48:51], v[144:147]
    ds_read_b64_tr_b16 v[228:229], v8 offset:16672
    v_mfma_f32_16x16x32_bf16 v[148:151], v[236:239], v[52:55], v[148:151]
    ds_read_b64_tr_b16 v[230:231], v8 offset:17696
    s_waitcnt vmcnt(13) lgkmcnt(6)
    v_mfma_f32_16x16x32_bf16 v[88:91], v[240:243], v[56:59], v[88:91]
    ds_read_b64_tr_b16 v[232:233], v7 offset:16896
    s_waitcnt vmcnt(12)
    v_mfma_f32_16x16x32_bf16 v[92:95], v[240:243], v[60:63], v[92:95]
    ds_read_b64_tr_b16 v[234:235], v7 offset:17920
    s_waitcnt lgkmcnt(6)
    v_mfma_f32_16x16x32_bf16 v[96:99], v[244:247], v[56:59], v[96:99]
    ds_read_b64_tr_b16 v[236:237], v8 offset:16928
    v_mfma_f32_16x16x32_bf16 v[100:103], v[244:247], v[60:63], v[100:103]
    ds_read_b64_tr_b16 v[238:239], v8 offset:17952
    s_waitcnt lgkmcnt(6)
    v_mfma_f32_16x16x32_bf16 v[104:107], v[224:227], v[56:59], v[104:107]
    ds_read_b64_tr_b16 v[240:241], v7 offset:17152
    v_mfma_f32_16x16x32_bf16 v[108:111], v[224:227], v[60:63], v[108:111]
    ds_read_b64_tr_b16 v[242:243], v7 offset:18176
    s_waitcnt lgkmcnt(6)
    v_mfma_f32_16x16x32_bf16 v[112:115], v[228:231], v[56:59], v[112:115]
    ds_read_b64_tr_b16 v[244:245], v8 offset:17184
    v_mfma_f32_16x16x32_bf16 v[116:119], v[228:231], v[60:63], v[116:119]
    ds_read_b64_tr_b16 v[246:247], v8 offset:18208
    s_waitcnt lgkmcnt(6)
    v_mfma_f32_16x16x32_bf16 v[120:123], v[232:235], v[56:59], v[120:123]
    v_mfma_f32_16x16x32_bf16 v[124:127], v[232:235], v[60:63], v[124:127]
    s_waitcnt vmcnt(10)
    s_barrier
    ds_read_b64_tr_b16 v[224:225], v4 offset:0
    ds_read_b64_tr_b16 v[226:227], v4 offset:1024
    s_waitcnt lgkmcnt(6)
    v_mfma_f32_16x16x32_bf16 v[128:131], v[236:239], v[56:59], v[128:131]
    ds_read_b64_tr_b16 v[228:229], v5 offset:32
    v_mfma_f32_16x16x32_bf16 v[132:135], v[236:239], v[60:63], v[132:135]
    ds_read_b64_tr_b16 v[230:231], v5 offset:1056
    s_waitcnt lgkmcnt(6)
    v_mfma_f32_16x16x32_bf16 v[136:139], v[240:243], v[56:59], v[136:139]
    ds_read_b64_tr_b16 v[232:233], v4 offset:256
    v_mfma_f32_16x16x32_bf16 v[140:143], v[240:243], v[60:63], v[140:143]
    ds_read_b64_tr_b16 v[234:235], v4 offset:1280
    s_waitcnt lgkmcnt(6)
    v_mfma_f32_16x16x32_bf16 v[144:147], v[244:247], v[56:59], v[144:147]
    ds_read_b64_tr_b16 v[236:237], v5 offset:288
    v_mfma_f32_16x16x32_bf16 v[148:151], v[244:247], v[60:63], v[148:151]
    ds_read_b64_tr_b16 v[238:239], v5 offset:1312
    s_waitcnt vmcnt(9) lgkmcnt(6)
    v_mfma_f32_16x16x32_bf16 v[88:91], v[224:227], v[24:27], v[88:91]
    ds_read_b64_tr_b16 v[240:241], v4 offset:512
    s_waitcnt vmcnt(8)
    v_mfma_f32_16x16x32_bf16 v[92:95], v[224:227], v[28:31], v[92:95]
    ds_read_b64_tr_b16 v[242:243], v4 offset:1536
    s_waitcnt lgkmcnt(6)
    v_mfma_f32_16x16x32_bf16 v[96:99], v[228:231], v[24:27], v[96:99]
    ds_read_b64_tr_b16 v[244:245], v5 offset:544
    v_mfma_f32_16x16x32_bf16 v[100:103], v[228:231], v[28:31], v[100:103]
    ds_read_b64_tr_b16 v[246:247], v5 offset:1568
    s_waitcnt lgkmcnt(6)
    v_mfma_f32_16x16x32_bf16 v[104:107], v[232:235], v[24:27], v[104:107]
    ds_read_b64_tr_b16 v[224:225], v4 offset:768
    v_mfma_f32_16x16x32_bf16 v[108:111], v[232:235], v[28:31], v[108:111]
    ds_read_b64_tr_b16 v[226:227], v4 offset:1792
    s_waitcnt lgkmcnt(6)
    v_mfma_f32_16x16x32_bf16 v[112:115], v[236:239], v[24:27], v[112:115]
    ds_read_b64_tr_b16 v[228:229], v5 offset:800
    v_mfma_f32_16x16x32_bf16 v[116:119], v[236:239], v[28:31], v[116:119]
    ds_read_b64_tr_b16 v[230:231], v5 offset:1824
    s_waitcnt lgkmcnt(6)
    v_mfma_f32_16x16x32_bf16 v[120:123], v[240:243], v[24:27], v[120:123]
    v_mfma_f32_16x16x32_bf16 v[124:127], v[240:243], v[28:31], v[124:127]
    s_waitcnt vmcnt(2)
    s_barrier
    ds_read_b64_tr_b16 v[232:233], v4 offset:16384
    ds_read_b64_tr_b16 v[234:235], v4 offset:17408
    s_waitcnt lgkmcnt(6)
    v_mfma_f32_16x16x32_bf16 v[128:131], v[244:247], v[24:27], v[128:131]
    ds_read_b64_tr_b16 v[236:237], v5 offset:16416
    v_mfma_f32_16x16x32_bf16 v[132:135], v[244:247], v[28:31], v[132:135]
    ds_read_b64_tr_b16 v[238:239], v5 offset:17440
    s_waitcnt lgkmcnt(6)
    v_mfma_f32_16x16x32_bf16 v[136:139], v[224:227], v[24:27], v[136:139]
    ds_read_b64_tr_b16 v[240:241], v4 offset:16640
    v_mfma_f32_16x16x32_bf16 v[140:143], v[224:227], v[28:31], v[140:143]
    ds_read_b64_tr_b16 v[242:243], v4 offset:17664
    s_waitcnt lgkmcnt(6)
    v_mfma_f32_16x16x32_bf16 v[144:147], v[228:231], v[24:27], v[144:147]
    ds_read_b64_tr_b16 v[244:245], v5 offset:16672
    v_mfma_f32_16x16x32_bf16 v[148:151], v[228:231], v[28:31], v[148:151]
    ds_read_b64_tr_b16 v[246:247], v5 offset:17696
    s_waitcnt vmcnt(1) lgkmcnt(6)
    v_mfma_f32_16x16x32_bf16 v[88:91], v[232:235], v[32:35], v[88:91]
    ds_read_b64_tr_b16 v[224:225], v4 offset:16896
    s_waitcnt vmcnt(0)
    v_mfma_f32_16x16x32_bf16 v[92:95], v[232:235], v[36:39], v[92:95]
    ds_read_b64_tr_b16 v[226:227], v4 offset:17920
    s_waitcnt lgkmcnt(6)
    v_mfma_f32_16x16x32_bf16 v[96:99], v[236:239], v[32:35], v[96:99]
    ds_read_b64_tr_b16 v[228:229], v5 offset:16928
    v_mfma_f32_16x16x32_bf16 v[100:103], v[236:239], v[36:39], v[100:103]
    ds_read_b64_tr_b16 v[230:231], v5 offset:17952
    s_waitcnt lgkmcnt(6)
    v_mfma_f32_16x16x32_bf16 v[104:107], v[240:243], v[32:35], v[104:107]
    ds_read_b64_tr_b16 v[232:233], v4 offset:17152
    v_mfma_f32_16x16x32_bf16 v[108:111], v[240:243], v[36:39], v[108:111]
    ds_read_b64_tr_b16 v[234:235], v4 offset:18176
    s_waitcnt lgkmcnt(6)
    v_mfma_f32_16x16x32_bf16 v[112:115], v[244:247], v[32:35], v[112:115]
    ds_read_b64_tr_b16 v[236:237], v5 offset:17184
    v_mfma_f32_16x16x32_bf16 v[116:119], v[244:247], v[36:39], v[116:119]
    ds_read_b64_tr_b16 v[238:239], v5 offset:18208
    s_waitcnt lgkmcnt(6)
    v_mfma_f32_16x16x32_bf16 v[120:123], v[224:227], v[32:35], v[120:123]
    v_mfma_f32_16x16x32_bf16 v[124:127], v[224:227], v[36:39], v[124:127]
    s_waitcnt lgkmcnt(4)
    v_mfma_f32_16x16x32_bf16 v[128:131], v[228:231], v[32:35], v[128:131]
    v_mfma_f32_16x16x32_bf16 v[132:135], v[228:231], v[36:39], v[132:135]
    s_waitcnt lgkmcnt(2)
    v_mfma_f32_16x16x32_bf16 v[136:139], v[232:235], v[32:35], v[136:139]
    v_mfma_f32_16x16x32_bf16 v[140:143], v[232:235], v[36:39], v[140:143]
    s_waitcnt lgkmcnt(0)
    v_mfma_f32_16x16x32_bf16 v[144:147], v[236:239], v[32:35], v[144:147]
    v_mfma_f32_16x16x32_bf16 v[148:151], v[236:239], v[36:39], v[148:151]
    s_lshl_b32 s16, s3, 13
    s_xor_b32 s17, s16, 0x8000
    s_add_u32 s16, s16, 0x18000
    s_add_u32 s17, s17, 0x18000
    v_add_u32 v16, s16, v2
    s_mov_b32 s16, s17
    v_add_u32 v17, s16, v2
    ds_write_b128 v16, v[120:123] offset:0
    ds_write_b128 v16, v[124:127] offset:1024
    ds_write_b128 v16, v[128:131] offset:2048
    ds_write_b128 v16, v[132:135] offset:3072
    ds_write_b128 v16, v[136:139] offset:4096
    ds_write_b128 v16, v[140:143] offset:5120
    ds_write_b128 v16, v[144:147] offset:6144
    ds_write_b128 v16, v[148:151] offset:7168
    v_lshlrev_b32 v24, 16, v248
    v_and_b32 v25, 0xffff0000, v248
    v_lshlrev_b32 v26, 16, v249
    v_and_b32 v27, 0xffff0000, v249
    v_lshlrev_b32 v28, 16, v250
    v_and_b32 v29, 0xffff0000, v250
    v_lshlrev_b32 v30, 16, v251
    v_and_b32 v31, 0xffff0000, v251
    v_lshlrev_b32 v32, 16, v252
    v_and_b32 v33, 0xffff0000, v252
    v_lshlrev_b32 v34, 16, v253
    v_and_b32 v35, 0xffff0000, v253
    v_lshlrev_b32 v36, 16, v254
    v_and_b32 v37, 0xffff0000, v254
    v_lshlrev_b32 v38, 16, v255
    v_and_b32 v39, 0xffff0000, v255
    v_and_b32 v18, 15, v1
    v_lshlrev_b32 v18, 6, v18
    v_lshrrev_b32 v19, 4, v1
    v_and_b32 v20, 1, v19
    v_lshl_add_u32 v18, v20, 5, v18
    v_lshrrev_b32 v19, 1, v19
    v_lshl_add_u32 v18, v19, 4, v18
    s_and_b32 s17, s3, 3
    s_lshl_b32 s18, s30, 2
    s_add_u32 s18, s18, s17
    s_lshl_b32 s18, s18, 16
    s_lshl_b32 s19, s15, 22
    s_add_u32 s18, s18, s19
    s_lshl_b32 s19, s31, 12
    s_add_u32 s18, s18, s19
    s_add_u32 s18, s18, 0x2000000
    s_add_u32 s19, s18, 32768
    s_waitcnt lgkmcnt(0)
    s_barrier
    ds_read_b128 v[40:43], v17 offset:0
    ds_read_b128 v[44:47], v17 offset:1024
    ds_read_b128 v[48:51], v17 offset:2048
    ds_read_b128 v[52:55], v17 offset:3072
    ds_read_b128 v[56:59], v17 offset:4096
    ds_read_b128 v[60:63], v17 offset:5120
    ds_read_b128 v[64:67], v17 offset:6144
    ds_read_b128 v[68:71], v17 offset:7168
    s_waitcnt lgkmcnt(7)
    v_pk_add_f32 v[88:89], v[88:89], v[40:41]
    v_pk_add_f32 v[90:91], v[90:91], v[42:43]
    v_pk_mul_f32 v[88:89], v[88:89], v[24:25]
    v_pk_mul_f32 v[90:91], v[90:91], v[26:27]
    v_cvt_pk_bf16_f32 v224, v88, v89
    v_cvt_pk_bf16_f32 v225, v90, v91
    s_waitcnt lgkmcnt(5)
    v_pk_add_f32 v[96:97], v[96:97], v[48:49]
    v_pk_add_f32 v[98:99], v[98:99], v[50:51]
    v_pk_mul_f32 v[96:97], v[96:97], v[28:29]
    v_pk_mul_f32 v[98:99], v[98:99], v[30:31]
    v_cvt_pk_bf16_f32 v226, v96, v97
    v_cvt_pk_bf16_f32 v227, v98, v99
    s_nop 0
    v_permlane16_swap_b32 v224, v226
    v_permlane16_swap_b32 v225, v227
    buffer_store_dwordx4 v[224:227], v18, s[8:11], s18 offen offset:0 sc1
    v_pk_add_f32 v[92:93], v[92:93], v[44:45]
    v_pk_add_f32 v[94:95], v[94:95], v[46:47]
    v_pk_mul_f32 v[92:93], v[92:93], v[24:25]
    v_pk_mul_f32 v[94:95], v[94:95], v[26:27]
    v_cvt_pk_bf16_f32 v228, v92, v93
    v_cvt_pk_bf16_f32 v229, v94, v95
    s_waitcnt lgkmcnt(4)
    v_pk_add_f32 v[100:101], v[100:101], v[52:53]
    v_pk_add_f32 v[102:103], v[102:103], v[54:55]
    v_pk_mul_f32 v[100:101], v[100:101], v[28:29]
    v_pk_mul_f32 v[102:103], v[102:103], v[30:31]
    v_cvt_pk_bf16_f32 v230, v100, v101
    v_cvt_pk_bf16_f32 v231, v102, v103
    s_nop 0
    v_permlane16_swap_b32 v228, v230
    v_permlane16_swap_b32 v229, v231
    buffer_store_dwordx4 v[228:231], v18, s[8:11], s19 offen offset:0 sc1
    s_waitcnt lgkmcnt(3)
    v_pk_add_f32 v[104:105], v[104:105], v[56:57]
    v_pk_add_f32 v[106:107], v[106:107], v[58:59]
    v_pk_mul_f32 v[104:105], v[104:105], v[32:33]
    v_pk_mul_f32 v[106:107], v[106:107], v[34:35]
    v_cvt_pk_bf16_f32 v232, v104, v105
    v_cvt_pk_bf16_f32 v233, v106, v107
    s_waitcnt lgkmcnt(1)
    v_pk_add_f32 v[112:113], v[112:113], v[64:65]
    v_pk_add_f32 v[114:115], v[114:115], v[66:67]
    v_pk_mul_f32 v[112:113], v[112:113], v[36:37]
    v_pk_mul_f32 v[114:115], v[114:115], v[38:39]
    v_cvt_pk_bf16_f32 v234, v112, v113
    v_cvt_pk_bf16_f32 v235, v114, v115
    s_nop 0
    v_permlane16_swap_b32 v232, v234
    v_permlane16_swap_b32 v233, v235
    buffer_store_dwordx4 v[232:235], v18, s[8:11], s18 offen offset:1024 sc1
    v_pk_add_f32 v[108:109], v[108:109], v[60:61]
    v_pk_add_f32 v[110:111], v[110:111], v[62:63]
    v_pk_mul_f32 v[108:109], v[108:109], v[32:33]
    v_pk_mul_f32 v[110:111], v[110:111], v[34:35]
    v_cvt_pk_bf16_f32 v236, v108, v109
    v_cvt_pk_bf16_f32 v237, v110, v111
    s_waitcnt lgkmcnt(0)
    v_pk_add_f32 v[116:117], v[116:117], v[68:69]
    v_pk_add_f32 v[118:119], v[118:119], v[70:71]
    v_pk_mul_f32 v[116:117], v[116:117], v[36:37]
    v_pk_mul_f32 v[118:119], v[118:119], v[38:39]
    v_cvt_pk_bf16_f32 v238, v116, v117
    v_cvt_pk_bf16_f32 v239, v118, v119
    s_nop 0
    v_permlane16_swap_b32 v236, v238
    v_permlane16_swap_b32 v237, v239
    buffer_store_dwordx4 v[236:239], v18, s[8:11], s19 offen offset:1024 sc1
    s_mov_b64 s[64:65], s[44:45]
    s_mov_b32 s66, 0x800
    s_mov_b32 s67, 0x20000
    s_mov_b64 s[76:77], s[32:33]
    s_mov_b32 s78, 0x400000
    s_mov_b32 s79, 0x20000
    s_mov_b64 s[68:69], s[56:57]
    s_mov_b32 s70, 0x400000
    s_mov_b32 s71, 0x20000
    s_lshl_b32 s14, s31, 1
    s_add_u32 s14, s14, s15
    s_lshl_b32 s14, s14, 3
    s_add_u32 s14, s14, s3
    s_lshl_b32 s16, s30, 7
    s_add_u32 s14, s14, s16
    s_lshl_b32 s16, s14, 11
    buffer_load_dwordx4 v[216:219], v2, s[76:79], s16 offen offset:0
    buffer_load_dwordx4 v[220:223], v2, s[76:79], s16 offen offset:1024
    s_lshl_b32 s16, s3, 10
    s_add_u32 m0, s16, 81920
    s_add_u32 s16, s16, 0x540800
    buffer_load_dwordx4 v2, s[8:11], s16 offen sc1 lds
    s_lshl_b32 s16, s30, 5
    s_lshl_b32 s17, s31, 1
    s_add_u32 s16, s16, s17
    s_add_u32 s16, s16, s15
    s_lshl_b32 s16, s16, 2
    s_add_u32 s16, s16, 0x530000
    s_cmp_eq_u32 s3, 0
    s_cselect_b32 s16, s16, 0x7ffffff0
    v_mov_b32 v16, s28
    v_mov_b32 v17, 0
    s_lshr_b32 s18, s14, 4
    s_lshl_b32 s18, s18, 15
    s_and_b32 s19, s14, 15
    s_lshl_b32 s19, s19, 6
    s_add_u32 s18, s18, s19
    s_add_u32 s18, s18, 0x2000000
    s_add_u32 s19, s18, 16384
    v_lshrrev_b32 v18, 2, v1
    v_lshlrev_b32 v18, 10, v18
    v_and_b32 v19, 3, v1
    v_lshl_add_u32 v18, v19, 4, v18
    v_add_u32 v19, 0x400000, v18
    s_lshl_b32 s25, s30, 7
    s_add_u32 s25, s25, 0x530000
    v_and_b32 v20, 15, v1
    v_lshlrev_b32 v20, 2, v20
    s_waitcnt vmcnt(3)
    s_waitcnt vmcnt(0)
    s_barrier
    s_mov_b64 exec, 1
    buffer_store_dword v16, v17, s[8:11], s16 offen sc1
    s_mov_b64 exec, -1
    v_add_u32 v16, 81920, v2
    ds_read_b128 v[184:187], v16 offset:0
    ds_read_b128 v[188:191], v16 offset:1024
    ds_read_b128 v[192:195], v16 offset:2048
    ds_read_b128 v[196:199], v16 offset:3072
    ds_read_b128 v[200:203], v16 offset:4096
    ds_read_b128 v[204:207], v16 offset:5120
    ds_read_b128 v[208:211], v16 offset:6144
    ds_read_b128 v[212:215], v16 offset:7168
    v_mov_b32 v94, 0
    v_mov_b32 v95, 0
    s_waitcnt lgkmcnt(5)
    v_lshlrev_b32 v76, 16, v192
    v_and_b32 v77, 0xffff0000, v192
    s_waitcnt lgkmcnt(1)
    v_lshlrev_b32 v78, 16, v208
    v_and_b32 v79, 0xffff0000, v208
    v_pk_mul_f32 v[60:61], v[76:77], v[78:79]
    v_lshlrev_b32 v76, 16, v184
    v_and_b32 v77, 0xffff0000, v184
    v_fmac_f32 v94, v76, v78
    v_fmac_f32 v94, v77, v79
    v_add_f32 v95, v95, v60
    v_add_f32 v95, v95, v61
    v_lshlrev_b32 v76, 16, v193
    v_and_b32 v77, 0xffff0000, v193
    v_lshlrev_b32 v78, 16, v209
    v_and_b32 v79, 0xffff0000, v209
    v_pk_mul_f32 v[62:63], v[76:77], v[78:79]
    v_lshlrev_b32 v76, 16, v185
    v_and_b32 v77, 0xffff0000, v185
    v_fmac_f32 v94, v76, v78
    v_fmac_f32 v94, v77, v79
    v_add_f32 v95, v95, v62
    v_add_f32 v95, v95, v63
    v_lshlrev_b32 v76, 16, v194
    v_and_b32 v77, 0xffff0000, v194
    v_lshlrev_b32 v78, 16, v210
    v_and_b32 v79, 0xffff0000, v210
    v_pk_mul_f32 v[64:65], v[76:77], v[78:79]
    v_lshlrev_b32 v76, 16, v186
    v_and_b32 v77, 0xffff0000, v186
    v_fmac_f32 v94, v76, v78
    v_fmac_f32 v94, v77, v79
    v_add_f32 v95, v95, v64
    v_add_f32 v95, v95, v65
    v_lshlrev_b32 v76, 16, v195
    v_and_b32 v77, 0xffff0000, v195
    v_lshlrev_b32 v78, 16, v211
    v_and_b32 v79, 0xffff0000, v211
    v_pk_mul_f32 v[66:67], v[76:77], v[78:79]
    v_lshlrev_b32 v76, 16, v187
    v_and_b32 v77, 0xffff0000, v187
    v_fmac_f32 v94, v76, v78
    v_fmac_f32 v94, v77, v79
    v_add_f32 v95, v95, v66
    v_add_f32 v95, v95, v67
    v_lshlrev_b32 v76, 16, v196
    v_and_b32 v77, 0xffff0000, v196
    s_waitcnt lgkmcnt(0)
    v_lshlrev_b32 v78, 16, v212
    v_and_b32 v79, 0xffff0000, v212
    v_pk_mul_f32 v[68:69], v[76:77], v[78:79]
    v_lshlrev_b32 v76, 16, v188
    v_and_b32 v77, 0xffff0000, v188
    v_fmac_f32 v94, v76, v78
    v_fmac_f32 v94, v77, v79
    v_add_f32 v95, v95, v68
    v_add_f32 v95, v95, v69
    v_lshlrev_b32 v76, 16, v197
    v_and_b32 v77, 0xffff0000, v197
    v_lshlrev_b32 v78, 16, v213
    v_and_b32 v79, 0xffff0000, v213
    v_pk_mul_f32 v[70:71], v[76:77], v[78:79]
    v_lshlrev_b32 v76, 16, v189
    v_and_b32 v77, 0xffff0000, v189
    v_fmac_f32 v94, v76, v78
    v_fmac_f32 v94, v77, v79
    v_add_f32 v95, v95, v70
    v_add_f32 v95, v95, v71
    v_lshlrev_b32 v76, 16, v198
    v_and_b32 v77, 0xffff0000, v198
    v_lshlrev_b32 v78, 16, v214
    v_and_b32 v79, 0xffff0000, v214
    v_pk_mul_f32 v[72:73], v[76:77], v[78:79]
    v_lshlrev_b32 v76, 16, v190
    v_and_b32 v77, 0xffff0000, v190
    v_fmac_f32 v94, v76, v78
    v_fmac_f32 v94, v77, v79
    v_add_f32 v95, v95, v72
    v_add_f32 v95, v95, v73
    v_lshlrev_b32 v76, 16, v199
    v_and_b32 v77, 0xffff0000, v199
    v_lshlrev_b32 v78, 16, v215
    v_and_b32 v79, 0xffff0000, v215
    v_pk_mul_f32 v[74:75], v[76:77], v[78:79]
    v_lshlrev_b32 v76, 16, v191
    v_and_b32 v77, 0xffff0000, v191
    v_fmac_f32 v94, v76, v78
    v_fmac_f32 v94, v77, v79
    v_add_f32 v95, v95, v74
    v_add_f32 v95, v95, v75
    v_add_f32_dpp v94, v94, v94 row_ror:1 row_mask:0xf bank_mask:0xf
    s_nop 0
    v_add_f32_dpp v95, v95, v95 row_ror:1 row_mask:0xf bank_mask:0xf
    v_add_f32_dpp v94, v94, v94 row_ror:2 row_mask:0xf bank_mask:0xf
    s_nop 0
    v_add_f32_dpp v95, v95, v95 row_ror:2 row_mask:0xf bank_mask:0xf
    v_add_f32_dpp v94, v94, v94 row_ror:4 row_mask:0xf bank_mask:0xf
    s_nop 0
    v_add_f32_dpp v95, v95, v95 row_ror:4 row_mask:0xf bank_mask:0xf
    v_add_f32_dpp v94, v94, v94 row_ror:8 row_mask:0xf bank_mask:0xf
    s_nop 0
    v_add_f32_dpp v95, v95, v95 row_ror:8 row_mask:0xf bank_mask:0xf
    v_mov_b32 v76, v94
    s_nop 1
    v_permlane16_swap_b32 v94, v76
    v_add_f32 v94, v94, v76
    v_mov_b32 v77, v95
    s_nop 1
    v_permlane16_swap_b32 v95, v77
    v_add_f32 v95, v95, v77
    v_mov_b32 v76, v94
    s_nop 1
    v_permlane32_swap_b32 v94, v76
    v_add_f32 v94, v94, v76
    v_mov_b32 v77, v95
    s_nop 1
    v_permlane32_swap_b32 v95, v77
    v_add_f32 v95, v95, v77
    v_lshlrev_b32 v28, 16, v216
    v_and_b32 v29, 0xffff0000, v216
    v_lshlrev_b32 v30, 16, v217
    v_and_b32 v31, 0xffff0000, v217
    v_lshlrev_b32 v32, 16, v218
    v_and_b32 v33, 0xffff0000, v218
    v_lshlrev_b32 v34, 16, v219
    v_and_b32 v35, 0xffff0000, v219
    v_lshlrev_b32 v36, 16, v220
    v_and_b32 v37, 0xffff0000, v220
    v_lshlrev_b32 v38, 16, v221
    v_and_b32 v39, 0xffff0000, v221
    v_lshlrev_b32 v40, 16, v222
    v_and_b32 v41, 0xffff0000, v222
    v_lshlrev_b32 v42, 16, v223
    v_and_b32 v43, 0xffff0000, v223
    s_mov_b32 s27, 0
adaLN_cond__sliding_block_cached__moe_arch_mod__prompt_kernel_a11p:
    buffer_load_dword v76, v20, s[8:11], s25 offen sc1
    s_waitcnt vmcnt(0)
    v_cmp_ne_u32 vcc, s28, v76
    s_add_u32 s27, s27, 1
    s_cmp_ge_u32 s27, 65536
    s_cbranch_scc1 adaLN_cond__sliding_block_cached__moe_arch_mod__prompt_kernel_a11g
    s_cbranch_vccnz adaLN_cond__sliding_block_cached__moe_arch_mod__prompt_kernel_a11p
adaLN_cond__sliding_block_cached__moe_arch_mod__prompt_kernel_a11g:
    buffer_load_dwordx4 v[44:47], v18, s[8:11], s18 offen sc1
    buffer_load_dwordx4 v[52:55], v19, s[8:11], s18 offen sc1
    buffer_load_dwordx4 v[48:51], v18, s[8:11], s19 offen sc1
    buffer_load_dwordx4 v[56:59], v19, s[8:11], s19 offen sc1
    v_lshlrev_b32 v21, 2, v0
    s_mov_b32 s16, 0x540800
    buffer_load_dword v106, v21, s[8:11], s16 offen sc1
    buffer_load_dword v104, v21, s[8:11], s16 offen offset:2048 sc1
    s_waitcnt vmcnt(5)
    v_lshlrev_b32 v76, 16, v44
    v_and_b32 v77, 0xffff0000, v44
    s_waitcnt vmcnt(4)
    v_lshlrev_b32 v78, 16, v52
    v_and_b32 v79, 0xffff0000, v52
    v_pk_add_f32 v[76:77], v[76:77], v[78:79]
    v_pk_add_f32 v[28:29], v[28:29], v[76:77]
    v_cvt_pk_bf16_f32 v16, v28, v29
    v_lshlrev_b32 v28, 16, v16
    v_and_b32 v29, 0xffff0000, v16
    v_lshlrev_b32 v80, 16, v45
    v_and_b32 v81, 0xffff0000, v45
    v_lshlrev_b32 v82, 16, v53
    v_and_b32 v83, 0xffff0000, v53
    v_pk_add_f32 v[80:81], v[80:81], v[82:83]
    v_pk_add_f32 v[30:31], v[30:31], v[80:81]
    v_cvt_pk_bf16_f32 v17, v30, v31
    v_lshlrev_b32 v30, 16, v17
    v_and_b32 v31, 0xffff0000, v17
    v_lshlrev_b32 v76, 16, v46
    v_and_b32 v77, 0xffff0000, v46
    v_lshlrev_b32 v78, 16, v54
    v_and_b32 v79, 0xffff0000, v54
    v_pk_add_f32 v[76:77], v[76:77], v[78:79]
    v_pk_add_f32 v[32:33], v[32:33], v[76:77]
    v_cvt_pk_bf16_f32 v16, v32, v33
    v_lshlrev_b32 v32, 16, v16
    v_and_b32 v33, 0xffff0000, v16
    v_lshlrev_b32 v80, 16, v47
    v_and_b32 v81, 0xffff0000, v47
    v_lshlrev_b32 v82, 16, v55
    v_and_b32 v83, 0xffff0000, v55
    v_pk_add_f32 v[80:81], v[80:81], v[82:83]
    v_pk_add_f32 v[34:35], v[34:35], v[80:81]
    v_cvt_pk_bf16_f32 v17, v34, v35
    v_lshlrev_b32 v34, 16, v17
    v_and_b32 v35, 0xffff0000, v17
    s_waitcnt vmcnt(3)
    v_lshlrev_b32 v76, 16, v48
    v_and_b32 v77, 0xffff0000, v48
    s_waitcnt vmcnt(2)
    v_lshlrev_b32 v78, 16, v56
    v_and_b32 v79, 0xffff0000, v56
    v_pk_add_f32 v[76:77], v[76:77], v[78:79]
    v_pk_add_f32 v[36:37], v[36:37], v[76:77]
    v_cvt_pk_bf16_f32 v16, v36, v37
    v_lshlrev_b32 v36, 16, v16
    v_and_b32 v37, 0xffff0000, v16
    v_lshlrev_b32 v80, 16, v49
    v_and_b32 v81, 0xffff0000, v49
    v_lshlrev_b32 v82, 16, v57
    v_and_b32 v83, 0xffff0000, v57
    v_pk_add_f32 v[80:81], v[80:81], v[82:83]
    v_pk_add_f32 v[38:39], v[38:39], v[80:81]
    v_cvt_pk_bf16_f32 v17, v38, v39
    v_lshlrev_b32 v38, 16, v17
    v_and_b32 v39, 0xffff0000, v17
    v_lshlrev_b32 v76, 16, v50
    v_and_b32 v77, 0xffff0000, v50
    v_lshlrev_b32 v78, 16, v58
    v_and_b32 v79, 0xffff0000, v58
    v_pk_add_f32 v[76:77], v[76:77], v[78:79]
    v_pk_add_f32 v[40:41], v[40:41], v[76:77]
    v_cvt_pk_bf16_f32 v16, v40, v41
    v_lshlrev_b32 v40, 16, v16
    v_and_b32 v41, 0xffff0000, v16
    v_lshlrev_b32 v80, 16, v51
    v_and_b32 v81, 0xffff0000, v51
    v_lshlrev_b32 v82, 16, v59
    v_and_b32 v83, 0xffff0000, v59
    v_pk_add_f32 v[80:81], v[80:81], v[82:83]
    v_pk_add_f32 v[42:43], v[42:43], v[80:81]
    v_cvt_pk_bf16_f32 v17, v42, v43
    v_lshlrev_b32 v42, 16, v17
    v_and_b32 v43, 0xffff0000, v17
    v_pk_add_f32 v[76:77], v[28:29], v[30:31]
    v_pk_mul_f32 v[78:79], v[28:29], v[28:29]
    v_pk_mul_f32 v[80:81], v[28:29], v[60:61]
    v_pk_fma_f32 v[78:79], v[30:31], v[30:31], v[78:79]
    v_pk_fma_f32 v[80:81], v[30:31], v[62:63], v[80:81]
    v_pk_add_f32 v[76:77], v[76:77], v[32:33]
    v_pk_fma_f32 v[78:79], v[32:33], v[32:33], v[78:79]
    v_pk_fma_f32 v[80:81], v[32:33], v[64:65], v[80:81]
    v_pk_add_f32 v[76:77], v[76:77], v[34:35]
    v_pk_fma_f32 v[78:79], v[34:35], v[34:35], v[78:79]
    v_pk_fma_f32 v[80:81], v[34:35], v[66:67], v[80:81]
    v_pk_add_f32 v[76:77], v[76:77], v[36:37]
    v_pk_fma_f32 v[78:79], v[36:37], v[36:37], v[78:79]
    v_pk_fma_f32 v[80:81], v[36:37], v[68:69], v[80:81]
    v_pk_add_f32 v[76:77], v[76:77], v[38:39]
    v_pk_fma_f32 v[78:79], v[38:39], v[38:39], v[78:79]
    v_pk_fma_f32 v[80:81], v[38:39], v[70:71], v[80:81]
    v_pk_add_f32 v[76:77], v[76:77], v[40:41]
    v_pk_fma_f32 v[78:79], v[40:41], v[40:41], v[78:79]
    v_pk_fma_f32 v[80:81], v[40:41], v[72:73], v[80:81]
    v_pk_add_f32 v[76:77], v[76:77], v[42:43]
    v_pk_fma_f32 v[78:79], v[42:43], v[42:43], v[78:79]
    v_pk_fma_f32 v[80:81], v[42:43], v[74:75], v[80:81]
    v_add_f32 v96, v76, v77
    v_add_f32 v97, v78, v79
    v_add_f32 v98, v80, v81
    v_add_f32_dpp v96, v96, v96 row_ror:1 row_mask:0xf bank_mask:0xf
    v_add_f32_dpp v97, v97, v97 row_ror:1 row_mask:0xf bank_mask:0xf
    v_add_f32_dpp v98, v98, v98 row_ror:1 row_mask:0xf bank_mask:0xf
    v_add_f32_dpp v96, v96, v96 row_ror:2 row_mask:0xf bank_mask:0xf
    v_add_f32_dpp v97, v97, v97 row_ror:2 row_mask:0xf bank_mask:0xf
    v_add_f32_dpp v98, v98, v98 row_ror:2 row_mask:0xf bank_mask:0xf
    v_add_f32_dpp v96, v96, v96 row_ror:4 row_mask:0xf bank_mask:0xf
    v_add_f32_dpp v97, v97, v97 row_ror:4 row_mask:0xf bank_mask:0xf
    v_add_f32_dpp v98, v98, v98 row_ror:4 row_mask:0xf bank_mask:0xf
    v_add_f32_dpp v96, v96, v96 row_ror:8 row_mask:0xf bank_mask:0xf
    v_add_f32_dpp v97, v97, v97 row_ror:8 row_mask:0xf bank_mask:0xf
    v_add_f32_dpp v98, v98, v98 row_ror:8 row_mask:0xf bank_mask:0xf
    v_mov_b32 v76, v96
    s_nop 1
    v_permlane16_swap_b32 v96, v76
    v_add_f32 v96, v96, v76
    v_mov_b32 v77, v97
    s_nop 1
    v_permlane16_swap_b32 v97, v77
    v_add_f32 v97, v97, v77
    v_mov_b32 v78, v98
    s_nop 1
    v_permlane16_swap_b32 v98, v78
    v_add_f32 v98, v98, v78
    v_mov_b32 v76, v96
    s_nop 1
    v_permlane32_swap_b32 v96, v76
    v_add_f32 v96, v96, v76
    v_mov_b32 v77, v97
    s_nop 1
    v_permlane32_swap_b32 v97, v77
    v_add_f32 v97, v97, v77
    v_mov_b32 v78, v98
    s_nop 1
    v_permlane32_swap_b32 v98, v78
    v_add_f32 v98, v98, v78
    v_mul_f32 v96, 0x3a800000, v96
    v_mul_f32 v97, 0x3a800000, v97
    v_fma_f32 v97, -v96, v96, v97
    v_max_f32 v97, 0, v97
    v_fma_f32 v98, -v96, v95, v98
    v_add_f32 v76, 0x3727c5ac, v97
    v_rsq_f32 v76, v76
    s_nop 0
    v_fma_f32 v27, v98, v76, v94
    v_cvt_pk_bf16_f32 v96, v96, v96
    v_lshlrev_b32 v96, 16, v96
    v_cvt_pk_bf16_f32 v97, v97, v97
    v_lshlrev_b32 v97, 16, v97
    v_add_f32 v97, 0x3727c5ac, v97
    v_cvt_pk_bf16_f32 v97, v97, v97
    v_lshlrev_b32 v97, 16, v97
    v_sqrt_f32 v98, v97
    s_nop 0
    v_cvt_pk_bf16_f32 v98, v98, v98
    v_lshlrev_b32 v98, 16, v98
    v_rcp_f32 v99, v98
    v_mov_b32 v25, v96
    v_mov_b32 v26, v98
    v_ashrrev_i32 v16, 31, v27
    v_or_b32 v16, 0x80000000, v16
    v_xor_b32 v24, v27, v16
    v_and_b32 v24, 0xfffff800, v24
    v_max_u32 v24, 0x800, v24
    s_sub_u32 s16, 2047, s14
    v_or_b32 v24, s16, v24
    s_lshl_b32 s16, s3, 4
    s_add_u32 s16, s16, 65536
    v_mov_b32 v16, s16
    ds_write_b128 v16, v[24:27]
    s_waitcnt lgkmcnt(0)
    s_barrier
    v_and_b32 v16, 7, v1
    v_lshlrev_b32 v16, 4, v16
    v_add_u32 v16, 65536, v16
    ds_read_b32 v76, v16
    s_waitcnt lgkmcnt(0)
    v_mov_b32 v77, v76
    s_nop 1
    v_max_u32_dpp v77, v77, v77 row_ror:1 row_mask:0xf bank_mask:0xf
    s_nop 1
    v_max_u32_dpp v77, v77, v77 row_ror:2 row_mask:0xf bank_mask:0xf
    s_nop 1
    v_max_u32_dpp v77, v77, v77 row_ror:4 row_mask:0xf bank_mask:0xf
    v_cmp_eq_u32 vcc, v76, v77
    s_ff1_i32_b64 s16, vcc
    s_lshl_b32 s16, s16, 4
    s_add_u32 s16, s16, 65536
    v_mov_b32 v16, s16
    ds_read_b128 v[24:27], v16
    s_lshl_b32 s16, s2, 4
    s_add_u32 s16, s16, 0x6e0000
    s_cmp_eq_u32 s3, 0
    s_cselect_b32 s16, s16, 0x7ffffff0
    v_mov_b32 v17, 0
    s_mov_b64 exec, 1
    s_waitcnt lgkmcnt(0)
    buffer_store_dwordx4 v[24:27], v17, s[8:11], s16 offen sc1
    s_mov_b64 exec, -1
    v_sub_f32 v44, v28, v96
    v_sub_f32 v45, v29, v96
    v_sub_f32 v46, v30, v96
    v_sub_f32 v47, v31, v96
    v_sub_f32 v48, v32, v96
    v_sub_f32 v49, v33, v96
    v_sub_f32 v50, v34, v96
    v_sub_f32 v51, v35, v96
    v_cvt_pk_bf16_f32 v16, v44, v45
    v_lshlrev_b32 v44, 16, v16
    v_and_b32 v45, 0xffff0000, v16
    v_cvt_pk_bf16_f32 v16, v46, v47
    v_lshlrev_b32 v46, 16, v16
    v_and_b32 v47, 0xffff0000, v16
    v_cvt_pk_bf16_f32 v16, v48, v49
    v_lshlrev_b32 v48, 16, v16
    v_and_b32 v49, 0xffff0000, v16
    v_cvt_pk_bf16_f32 v16, v50, v51
    v_lshlrev_b32 v50, 16, v16
    v_and_b32 v51, 0xffff0000, v16
    v_mul_f32 v52, v44, v99
    v_mul_f32 v53, v45, v99
    v_mul_f32 v54, v46, v99
    v_mul_f32 v55, v47, v99
    v_mul_f32 v56, v48, v99
    v_mul_f32 v57, v49, v99
    v_mul_f32 v58, v50, v99
    v_mul_f32 v59, v51, v99
    v_fma_f32 v44, -v52, v98, v44
    v_fma_f32 v45, -v53, v98, v45
    v_fma_f32 v46, -v54, v98, v46
    v_fma_f32 v47, -v55, v98, v47
    v_fma_f32 v48, -v56, v98, v48
    v_fma_f32 v49, -v57, v98, v49
    v_fma_f32 v50, -v58, v98, v50
    v_fma_f32 v51, -v59, v98, v51
    v_fma_f32 v44, v44, v99, v52
    v_fma_f32 v45, v45, v99, v53
    v_fma_f32 v46, v46, v99, v54
    v_fma_f32 v47, v47, v99, v55
    v_fma_f32 v48, v48, v99, v56
    v_fma_f32 v49, v49, v99, v57
    v_fma_f32 v50, v50, v99, v58
    v_fma_f32 v51, v51, v99, v59
    v_cvt_pk_bf16_f32 v16, v44, v45
    v_lshlrev_b32 v44, 16, v16
    v_and_b32 v45, 0xffff0000, v16
    v_cvt_pk_bf16_f32 v16, v46, v47
    v_lshlrev_b32 v46, 16, v16
    v_and_b32 v47, 0xffff0000, v16
    v_cvt_pk_bf16_f32 v16, v48, v49
    v_lshlrev_b32 v48, 16, v16
    v_and_b32 v49, 0xffff0000, v16
    v_cvt_pk_bf16_f32 v16, v50, v51
    v_lshlrev_b32 v50, 16, v16
    v_and_b32 v51, 0xffff0000, v16
    v_lshlrev_b32 v52, 16, v192
    v_and_b32 v53, 0xffff0000, v192
    v_lshlrev_b32 v54, 16, v193
    v_and_b32 v55, 0xffff0000, v193
    v_lshlrev_b32 v56, 16, v194
    v_and_b32 v57, 0xffff0000, v194
    v_lshlrev_b32 v58, 16, v195
    v_and_b32 v59, 0xffff0000, v195
    v_pk_mul_f32 v[44:45], v[44:45], v[52:53]
    v_pk_mul_f32 v[46:47], v[46:47], v[54:55]
    v_pk_mul_f32 v[48:49], v[48:49], v[56:57]
    v_pk_mul_f32 v[50:51], v[50:51], v[58:59]
    v_cvt_pk_bf16_f32 v16, v44, v45
    v_lshlrev_b32 v44, 16, v16
    v_and_b32 v45, 0xffff0000, v16
    v_cvt_pk_bf16_f32 v16, v46, v47
    v_lshlrev_b32 v46, 16, v16
    v_and_b32 v47, 0xffff0000, v16
    v_cvt_pk_bf16_f32 v16, v48, v49
    v_lshlrev_b32 v48, 16, v16
    v_and_b32 v49, 0xffff0000, v16
    v_cvt_pk_bf16_f32 v16, v50, v51
    v_lshlrev_b32 v50, 16, v16
    v_and_b32 v51, 0xffff0000, v16
    v_lshlrev_b32 v52, 16, v184
    v_and_b32 v53, 0xffff0000, v184
    v_lshlrev_b32 v54, 16, v185
    v_and_b32 v55, 0xffff0000, v185
    v_lshlrev_b32 v56, 16, v186
    v_and_b32 v57, 0xffff0000, v186
    v_lshlrev_b32 v58, 16, v187
    v_and_b32 v59, 0xffff0000, v187
    v_pk_add_f32 v[44:45], v[44:45], v[52:53]
    v_pk_add_f32 v[46:47], v[46:47], v[54:55]
    v_pk_add_f32 v[48:49], v[48:49], v[56:57]
    v_pk_add_f32 v[50:51], v[50:51], v[58:59]
    v_cvt_pk_bf16_f32 v16, v44, v45
    v_lshlrev_b32 v44, 16, v16
    v_and_b32 v45, 0xffff0000, v16
    v_cvt_pk_bf16_f32 v16, v46, v47
    v_lshlrev_b32 v46, 16, v16
    v_and_b32 v47, 0xffff0000, v16
    v_cvt_pk_bf16_f32 v16, v48, v49
    v_lshlrev_b32 v48, 16, v16
    v_and_b32 v49, 0xffff0000, v16
    v_cvt_pk_bf16_f32 v16, v50, v51
    v_lshlrev_b32 v50, 16, v16
    v_and_b32 v51, 0xffff0000, v16
    v_lshlrev_b32 v52, 16, v200
    v_and_b32 v53, 0xffff0000, v200
    v_lshlrev_b32 v54, 16, v201
    v_and_b32 v55, 0xffff0000, v201
    v_lshlrev_b32 v56, 16, v202
    v_and_b32 v57, 0xffff0000, v202
    v_lshlrev_b32 v58, 16, v203
    v_and_b32 v59, 0xffff0000, v203
    v_pk_mul_f32 v[44:45], v[44:45], v[52:53]
    v_pk_mul_f32 v[46:47], v[46:47], v[54:55]
    v_pk_mul_f32 v[48:49], v[48:49], v[56:57]
    v_pk_mul_f32 v[50:51], v[50:51], v[58:59]
    v_cvt_pk_bf16_f32 v16, v44, v45
    v_lshlrev_b32 v44, 16, v16
    v_and_b32 v45, 0xffff0000, v16
    v_cvt_pk_bf16_f32 v16, v46, v47
    v_lshlrev_b32 v46, 16, v16
    v_and_b32 v47, 0xffff0000, v16
    v_cvt_pk_bf16_f32 v16, v48, v49
    v_lshlrev_b32 v48, 16, v16
    v_and_b32 v49, 0xffff0000, v16
    v_cvt_pk_bf16_f32 v16, v50, v51
    v_lshlrev_b32 v50, 16, v16
    v_and_b32 v51, 0xffff0000, v16
    v_pk_add_f32 v[44:45], v[44:45], v[28:29]
    v_pk_add_f32 v[46:47], v[46:47], v[30:31]
    v_pk_add_f32 v[48:49], v[48:49], v[32:33]
    v_pk_add_f32 v[50:51], v[50:51], v[34:35]
    v_cvt_pk_bf16_f32 v28, v44, v45
    v_cvt_pk_bf16_f32 v29, v46, v47
    v_cvt_pk_bf16_f32 v30, v48, v49
    v_cvt_pk_bf16_f32 v31, v50, v51
    v_sub_f32 v44, v36, v96
    v_sub_f32 v45, v37, v96
    v_sub_f32 v46, v38, v96
    v_sub_f32 v47, v39, v96
    v_sub_f32 v48, v40, v96
    v_sub_f32 v49, v41, v96
    v_sub_f32 v50, v42, v96
    v_sub_f32 v51, v43, v96
    v_cvt_pk_bf16_f32 v16, v44, v45
    v_lshlrev_b32 v44, 16, v16
    v_and_b32 v45, 0xffff0000, v16
    v_cvt_pk_bf16_f32 v16, v46, v47
    v_lshlrev_b32 v46, 16, v16
    v_and_b32 v47, 0xffff0000, v16
    v_cvt_pk_bf16_f32 v16, v48, v49
    v_lshlrev_b32 v48, 16, v16
    v_and_b32 v49, 0xffff0000, v16
    v_cvt_pk_bf16_f32 v16, v50, v51
    v_lshlrev_b32 v50, 16, v16
    v_and_b32 v51, 0xffff0000, v16
    v_mul_f32 v52, v44, v99
    v_mul_f32 v53, v45, v99
    v_mul_f32 v54, v46, v99
    v_mul_f32 v55, v47, v99
    v_mul_f32 v56, v48, v99
    v_mul_f32 v57, v49, v99
    v_mul_f32 v58, v50, v99
    v_mul_f32 v59, v51, v99
    v_fma_f32 v44, -v52, v98, v44
    v_fma_f32 v45, -v53, v98, v45
    v_fma_f32 v46, -v54, v98, v46
    v_fma_f32 v47, -v55, v98, v47
    v_fma_f32 v48, -v56, v98, v48
    v_fma_f32 v49, -v57, v98, v49
    v_fma_f32 v50, -v58, v98, v50
    v_fma_f32 v51, -v59, v98, v51
    v_fma_f32 v44, v44, v99, v52
    v_fma_f32 v45, v45, v99, v53
    v_fma_f32 v46, v46, v99, v54
    v_fma_f32 v47, v47, v99, v55
    v_fma_f32 v48, v48, v99, v56
    v_fma_f32 v49, v49, v99, v57
    v_fma_f32 v50, v50, v99, v58
    v_fma_f32 v51, v51, v99, v59
    v_cvt_pk_bf16_f32 v16, v44, v45
    v_lshlrev_b32 v44, 16, v16
    v_and_b32 v45, 0xffff0000, v16
    v_cvt_pk_bf16_f32 v16, v46, v47
    v_lshlrev_b32 v46, 16, v16
    v_and_b32 v47, 0xffff0000, v16
    v_cvt_pk_bf16_f32 v16, v48, v49
    v_lshlrev_b32 v48, 16, v16
    v_and_b32 v49, 0xffff0000, v16
    v_cvt_pk_bf16_f32 v16, v50, v51
    v_lshlrev_b32 v50, 16, v16
    v_and_b32 v51, 0xffff0000, v16
    v_lshlrev_b32 v52, 16, v196
    v_and_b32 v53, 0xffff0000, v196
    v_lshlrev_b32 v54, 16, v197
    v_and_b32 v55, 0xffff0000, v197
    v_lshlrev_b32 v56, 16, v198
    v_and_b32 v57, 0xffff0000, v198
    v_lshlrev_b32 v58, 16, v199
    v_and_b32 v59, 0xffff0000, v199
    v_pk_mul_f32 v[44:45], v[44:45], v[52:53]
    v_pk_mul_f32 v[46:47], v[46:47], v[54:55]
    v_pk_mul_f32 v[48:49], v[48:49], v[56:57]
    v_pk_mul_f32 v[50:51], v[50:51], v[58:59]
    v_cvt_pk_bf16_f32 v16, v44, v45
    v_lshlrev_b32 v44, 16, v16
    v_and_b32 v45, 0xffff0000, v16
    v_cvt_pk_bf16_f32 v16, v46, v47
    v_lshlrev_b32 v46, 16, v16
    v_and_b32 v47, 0xffff0000, v16
    v_cvt_pk_bf16_f32 v16, v48, v49
    v_lshlrev_b32 v48, 16, v16
    v_and_b32 v49, 0xffff0000, v16
    v_cvt_pk_bf16_f32 v16, v50, v51
    v_lshlrev_b32 v50, 16, v16
    v_and_b32 v51, 0xffff0000, v16
    v_lshlrev_b32 v52, 16, v188
    v_and_b32 v53, 0xffff0000, v188
    v_lshlrev_b32 v54, 16, v189
    v_and_b32 v55, 0xffff0000, v189
    v_lshlrev_b32 v56, 16, v190
    v_and_b32 v57, 0xffff0000, v190
    v_lshlrev_b32 v58, 16, v191
    v_and_b32 v59, 0xffff0000, v191
    v_pk_add_f32 v[44:45], v[44:45], v[52:53]
    v_pk_add_f32 v[46:47], v[46:47], v[54:55]
    v_pk_add_f32 v[48:49], v[48:49], v[56:57]
    v_pk_add_f32 v[50:51], v[50:51], v[58:59]
    v_cvt_pk_bf16_f32 v16, v44, v45
    v_lshlrev_b32 v44, 16, v16
    v_and_b32 v45, 0xffff0000, v16
    v_cvt_pk_bf16_f32 v16, v46, v47
    v_lshlrev_b32 v46, 16, v16
    v_and_b32 v47, 0xffff0000, v16
    v_cvt_pk_bf16_f32 v16, v48, v49
    v_lshlrev_b32 v48, 16, v16
    v_and_b32 v49, 0xffff0000, v16
    v_cvt_pk_bf16_f32 v16, v50, v51
    v_lshlrev_b32 v50, 16, v16
    v_and_b32 v51, 0xffff0000, v16
    v_lshlrev_b32 v52, 16, v204
    v_and_b32 v53, 0xffff0000, v204
    v_lshlrev_b32 v54, 16, v205
    v_and_b32 v55, 0xffff0000, v205
    v_lshlrev_b32 v56, 16, v206
    v_and_b32 v57, 0xffff0000, v206
    v_lshlrev_b32 v58, 16, v207
    v_and_b32 v59, 0xffff0000, v207
    v_pk_mul_f32 v[44:45], v[44:45], v[52:53]
    v_pk_mul_f32 v[46:47], v[46:47], v[54:55]
    v_pk_mul_f32 v[48:49], v[48:49], v[56:57]
    v_pk_mul_f32 v[50:51], v[50:51], v[58:59]
    v_cvt_pk_bf16_f32 v16, v44, v45
    v_lshlrev_b32 v44, 16, v16
    v_and_b32 v45, 0xffff0000, v16
    v_cvt_pk_bf16_f32 v16, v46, v47
    v_lshlrev_b32 v46, 16, v16
    v_and_b32 v47, 0xffff0000, v16
    v_cvt_pk_bf16_f32 v16, v48, v49
    v_lshlrev_b32 v48, 16, v16
    v_and_b32 v49, 0xffff0000, v16
    v_cvt_pk_bf16_f32 v16, v50, v51
    v_lshlrev_b32 v50, 16, v16
    v_and_b32 v51, 0xffff0000, v16
    v_pk_add_f32 v[44:45], v[44:45], v[36:37]
    v_pk_add_f32 v[46:47], v[46:47], v[38:39]
    v_pk_add_f32 v[48:49], v[48:49], v[40:41]
    v_pk_add_f32 v[50:51], v[50:51], v[42:43]
    v_cvt_pk_bf16_f32 v36, v44, v45
    v_cvt_pk_bf16_f32 v37, v46, v47
    v_cvt_pk_bf16_f32 v38, v48, v49
    v_cvt_pk_bf16_f32 v39, v50, v51
    v_lshlrev_b32 v18, 4, v0
    s_mov_b32 s16, 0x6e0000
    s_mov_b32 s27, 0
adaLN_cond__sliding_block_cached__moe_arch_mod__prompt_kernel_w12p:
    buffer_load_dwordx4 v[24:27], v18, s[8:11], s16 offen sc1
    s_waitcnt vmcnt(0)
    v_cmp_eq_u32 vcc, 0, v24
    s_add_u32 s27, s27, 1
    s_cmp_ge_u32 s27, 65536
    s_cbranch_scc1 adaLN_cond__sliding_block_cached__moe_arch_mod__prompt_kernel_w12g
    s_cbranch_vccnz adaLN_cond__sliding_block_cached__moe_arch_mod__prompt_kernel_w12p
adaLN_cond__sliding_block_cached__moe_arch_mod__prompt_kernel_w12g:
    v_mov_b32 v76, v24
    s_nop 1
    v_max_u32_dpp v76, v76, v76 row_ror:1 row_mask:0xf bank_mask:0xf
    s_nop 1
    v_max_u32_dpp v76, v76, v76 row_ror:2 row_mask:0xf bank_mask:0xf
    s_nop 1
    v_max_u32_dpp v76, v76, v76 row_ror:4 row_mask:0xf bank_mask:0xf
    s_nop 1
    v_max_u32_dpp v76, v76, v76 row_ror:8 row_mask:0xf bank_mask:0xf
    v_mov_b32 v77, v76
    s_nop 1
    v_permlane16_swap_b32 v76, v77
    v_max_u32 v76, v76, v77
    v_mov_b32 v77, v76
    s_nop 1
    v_permlane32_swap_b32 v76, v77
    v_max_u32 v76, v76, v77
    v_cmp_eq_u32 vcc, v76, v24
    s_lshl_b32 s16, s3, 4
    s_add_u32 s16, s16, 65792
    v_mov_b32 v16, s16
    s_and_saveexec_b64 s[62:63], vcc
    ds_write_b128 v16, v[24:27]
    s_mov_b64 exec, s[62:63]
    s_waitcnt lgkmcnt(0)
    s_barrier
    v_and_b32 v16, 3, v1
    v_lshlrev_b32 v16, 4, v16
    v_add_u32 v16, 65792, v16
    ds_read_b32 v76, v16
    s_waitcnt lgkmcnt(0)
    v_mov_b32 v77, v76
    s_nop 1
    v_max_u32_dpp v77, v77, v77 row_ror:1 row_mask:0xf bank_mask:0xf
    s_nop 1
    v_max_u32_dpp v77, v77, v77 row_ror:2 row_mask:0xf bank_mask:0xf
    v_cmp_eq_u32 vcc, v76, v77
    s_ff1_i32_b64 s16, vcc
    s_lshl_b32 s16, s16, 4
    s_add_u32 s16, s16, 65792
    v_mov_b32 v16, s16
    ds_read_b128 v[24:27], v16
    s_waitcnt lgkmcnt(0)
    v_and_b32 v76, 0x7ff, v24
    v_sub_u32 v76, 2047, v76
    s_nop 0
    v_readfirstlane_b32 s12, v76
    v_rcp_f32 v103, v26
    s_lshr_b32 s18, s12, 4
    s_lshl_b32 s18, s18, 15
    s_and_b32 s19, s12, 15
    s_lshl_b32 s19, s19, 6
    s_add_u32 s18, s18, s19
    s_add_u32 s18, s18, 0x2000000
    s_add_u32 s19, s18, 0x400000
    v_lshrrev_b32 v18, 4, v0
    v_lshlrev_b32 v18, 10, v18
    v_and_b32 v19, 15, v0
    v_lshl_add_u32 v18, v19, 2, v18
    s_lshl_b32 s13, s12, 11
    buffer_load_dword v100, v18, s[8:11], s18 offen sc1
    buffer_load_dword v101, v18, s[8:11], s19 offen sc1
    buffer_load_dword v102, v21, s[76:79], s13 offen
    s_lshl_b32 s16, s14, 11
    s_cmp_lg_u32 s12, s14
    s_cselect_b32 s16, s16, 0x7ffffff0
    buffer_store_dwordx4 v[28:31], v2, s[68:71], s16 offen offset:0 sc1
    buffer_store_dwordx4 v[36:39], v2, s[68:71], s16 offen offset:1024 sc1
    s_lshl_b32 s16, s3, 13
    v_add_u32 v20, s16, v2
    s_waitcnt vmcnt(4)
    v_lshlrev_b32 v76, 16, v100
    v_and_b32 v77, 0xffff0000, v100
    s_waitcnt vmcnt(3)
    v_lshlrev_b32 v78, 16, v101
    v_and_b32 v79, 0xffff0000, v101
    v_pk_add_f32 v[76:77], v[76:77], v[78:79]
    s_waitcnt vmcnt(2)
    v_lshlrev_b32 v78, 16, v102
    v_and_b32 v79, 0xffff0000, v102
    v_pk_add_f32 v[92:93], v[78:79], v[76:77]
    v_cvt_pk_bf16_f32 v76, v92, v93
    v_lshlrev_b32 v92, 16, v76
    v_and_b32 v93, 0xffff0000, v76
    v_cvt_pk_bf16_f32 v100, v92, v93
    v_and_b32 v105, 0xffff0000, v104
    v_lshlrev_b32 v104, 16, v104
    v_and_b32 v107, 0xffff0000, v106
    v_lshlrev_b32 v106, 16, v106
    v_sub_f32 v92, v92, v25
    v_sub_f32 v93, v93, v25
    v_cvt_pk_bf16_f32 v76, v92, v93
    v_lshlrev_b32 v92, 16, v76
    v_and_b32 v93, 0xffff0000, v76
    v_mul_f32 v77, v92, v103
    v_fma_f32 v92, -v77, v26, v92
    v_fma_f32 v92, v92, v103, v77
    v_mul_f32 v77, v93, v103
    v_fma_f32 v93, -v77, v26, v93
    v_fma_f32 v93, v93, v103, v77
    v_cvt_pk_bf16_f32 v76, v92, v93
    v_lshlrev_b32 v92, 16, v76
    v_and_b32 v93, 0xffff0000, v76
    v_mul_f32 v92, v92, v104
    v_mul_f32 v93, v93, v105
    v_cvt_pk_bf16_f32 v76, v92, v93
    v_lshlrev_b32 v92, 16, v76
    v_and_b32 v93, 0xffff0000, v76
    v_add_f32 v92, v92, v106
    v_add_f32 v93, v93, v107
    v_cvt_pk_bf16_f32 v101, v92, v93
    v_add_u32 v16, 66560, v21
    ds_write_b32 v16, v101
    ds_write_b32 v16, v100 offset:2048
    s_waitcnt lgkmcnt(0)
    s_barrier
    ds_read_b128 v[60:63], v20 offset:0
    ds_read_b128 v[64:67], v20 offset:1024
    ds_read_b128 v[68:71], v20 offset:2048
    ds_read_b128 v[72:75], v20 offset:3072
    ds_read_b128 v[108:111], v20 offset:4096
    ds_read_b128 v[112:115], v20 offset:5120
    ds_read_b128 v[116:119], v20 offset:6144
    ds_read_b128 v[120:123], v20 offset:7168
    s_and_b32 s16, s3, 3
    s_lshl_b32 s16, s16, 7
    s_and_b32 s17, s29, 3
    s_lshl_b32 s17, s17, 9
    s_add_u32 s16, s16, s17
    s_add_u32 s16, s16, 66560
    v_lshrrev_b32 v16, 3, v1
    v_lshlrev_b32 v16, 4, v16
    v_add_u32 v16, s16, v16
    ds_read_b128 v[104:107], v16
    s_waitcnt lgkmcnt(0)
    v_lshlrev_b32 v76, 16, v104
    v_and_b32 v77, 0xffff, v104
    v_dot2_f32_bf16 v85, v60, v76, 0
    v_dot2_f32_bf16 v84, v60, v77, 0
    v_dot2_f32_bf16 v87, v61, v76, 0
    v_dot2_f32_bf16 v86, v61, v77, 0
    v_dot2_f32_bf16 v89, v62, v76, 0
    v_dot2_f32_bf16 v88, v62, v77, 0
    v_dot2_f32_bf16 v91, v63, v76, 0
    v_dot2_f32_bf16 v90, v63, v77, 0
    v_and_b32 v78, 0xffff0000, v104
    v_lshrrev_b32 v79, 16, v104
    v_dot2c_f32_bf16 v85, v64, v78
    v_dot2c_f32_bf16 v84, v64, v79
    v_dot2c_f32_bf16 v87, v65, v78
    v_dot2c_f32_bf16 v86, v65, v79
    v_dot2c_f32_bf16 v89, v66, v78
    v_dot2c_f32_bf16 v88, v66, v79
    v_dot2c_f32_bf16 v91, v67, v78
    v_dot2c_f32_bf16 v90, v67, v79
    v_lshlrev_b32 v80, 16, v105
    v_and_b32 v81, 0xffff, v105
    v_dot2c_f32_bf16 v85, v68, v80
    v_dot2c_f32_bf16 v84, v68, v81
    v_dot2c_f32_bf16 v87, v69, v80
    v_dot2c_f32_bf16 v86, v69, v81
    v_dot2c_f32_bf16 v89, v70, v80
    v_dot2c_f32_bf16 v88, v70, v81
    v_dot2c_f32_bf16 v91, v71, v80
    v_dot2c_f32_bf16 v90, v71, v81
    v_and_b32 v82, 0xffff0000, v105
    v_lshrrev_b32 v83, 16, v105
    v_dot2c_f32_bf16 v85, v72, v82
    v_dot2c_f32_bf16 v84, v72, v83
    v_dot2c_f32_bf16 v87, v73, v82
    v_dot2c_f32_bf16 v86, v73, v83
    v_dot2c_f32_bf16 v89, v74, v82
    v_dot2c_f32_bf16 v88, v74, v83
    v_dot2c_f32_bf16 v91, v75, v82
    v_dot2c_f32_bf16 v90, v75, v83
    v_lshlrev_b32 v76, 16, v106
    v_and_b32 v77, 0xffff, v106
    v_dot2c_f32_bf16 v85, v108, v76
    v_dot2c_f32_bf16 v84, v108, v77
    v_dot2c_f32_bf16 v87, v109, v76
    v_dot2c_f32_bf16 v86, v109, v77
    v_dot2c_f32_bf16 v89, v110, v76
    v_dot2c_f32_bf16 v88, v110, v77
    v_dot2c_f32_bf16 v91, v111, v76
    v_dot2c_f32_bf16 v90, v111, v77
    v_and_b32 v78, 0xffff0000, v106
    v_lshrrev_b32 v79, 16, v106
    v_dot2c_f32_bf16 v85, v112, v78
    v_dot2c_f32_bf16 v84, v112, v79
    v_dot2c_f32_bf16 v87, v113, v78
    v_dot2c_f32_bf16 v86, v113, v79
    v_dot2c_f32_bf16 v89, v114, v78
    v_dot2c_f32_bf16 v88, v114, v79
    v_dot2c_f32_bf16 v91, v115, v78
    v_dot2c_f32_bf16 v90, v115, v79
    v_lshlrev_b32 v80, 16, v107
    v_and_b32 v81, 0xffff, v107
    v_dot2c_f32_bf16 v85, v116, v80
    v_dot2c_f32_bf16 v84, v116, v81
    v_dot2c_f32_bf16 v87, v117, v80
    v_dot2c_f32_bf16 v86, v117, v81
    v_dot2c_f32_bf16 v89, v118, v80
    v_dot2c_f32_bf16 v88, v118, v81
    v_dot2c_f32_bf16 v91, v119, v80
    v_dot2c_f32_bf16 v90, v119, v81
    v_and_b32 v82, 0xffff0000, v107
    v_lshrrev_b32 v83, 16, v107
    v_dot2c_f32_bf16 v85, v120, v82
    v_dot2c_f32_bf16 v84, v120, v83
    v_dot2c_f32_bf16 v87, v121, v82
    v_dot2c_f32_bf16 v86, v121, v83
    v_dot2c_f32_bf16 v89, v122, v82
    v_dot2c_f32_bf16 v88, v122, v83
    v_dot2c_f32_bf16 v91, v123, v82
    v_dot2c_f32_bf16 v90, v123, v83
    s_nop 0
    v_permlane32_swap_b32 v84, v88
    v_permlane32_swap_b32 v85, v89
    v_permlane32_swap_b32 v86, v90
    v_permlane32_swap_b32 v87, v91
    v_add_f32 v84, v84, v88
    v_add_f32 v85, v85, v89
    v_add_f32 v86, v86, v90
    v_add_f32 v87, v87, v91
    s_nop 0
    v_permlane16_swap_b32 v84, v86
    v_permlane16_swap_b32 v85, v87
    v_add_f32 v84, v84, v86
    v_add_f32 v85, v85, v87
    s_nop 0
    v_add_f32_dpp v84, v84, v84 row_ror:8 row_mask:0xf bank_mask:0xf
    v_add_f32_dpp v85, v85, v85 row_ror:8 row_mask:0xf bank_mask:0xf
    v_and_b32 v16, 7, v1
    v_lshlrev_b32 v16, 5, v16
    v_lshrrev_b32 v17, 4, v1
    v_lshl_add_u32 v16, v17, 3, v16
    s_lshl_b32 s16, s3, 8
    s_add_u32 s16, s16, 70656
    v_add_u32 v16, s16, v16
    ds_write_b64 v16, v[84:85]
    s_lshr_b32 s16, s3, 2
    s_lshl_b32 s17, s16, 10
    s_add_u32 s17, s17, 70656
    v_lshlrev_b32 v17, 2, v1
    v_add_u32 v16, s17, v17
    s_and_b32 s17, s29, 3
    s_lshl_b32 s17, s17, 1
    s_add_u32 s17, s17, s16
    s_mul_i32 s17, s17, 14336
    s_lshr_b32 s16, s29, 2
    s_lshl_b32 s16, s16, 8
    s_add_u32 s17, s17, s16
    s_add_u32 s17, s17, 0x6e1000
    s_and_b32 s16, s3, 3
    s_cmp_eq_u32 s16, 0
    s_cselect_b32 s17, s17, 0x7ffffff0
    s_cmp_lt_u32 s2, 224
    s_cselect_b32 s17, s17, 0x7ffffff0
    s_waitcnt lgkmcnt(0)
    s_barrier
    ds_read_b32 v84, v16 offset:0
    ds_read_b32 v85, v16 offset:256
    ds_read_b32 v86, v16 offset:512
    ds_read_b32 v87, v16 offset:768
    s_waitcnt lgkmcnt(2)
    v_add_f32 v84, v84, v85
    s_waitcnt lgkmcnt(0)
    v_add_f32 v86, v86, v87
    v_add_f32 v84, v84, v86
    v_or_b32 v84, 1, v84
    buffer_store_dword v84, v17, s[8:11], s17 offen sc1
    s_barrier
    v_lshlrev_b32 v16, 3, v0
    v_add_u32 v17, 73728, v16
    ds_read_b64 v[84:85], v17 offset:0
    ds_read_b64 v[86:87], v17 offset:4096
    ds_read_b64 v[88:89], v17 offset:8192
    ds_read_b64 v[90:91], v17 offset:12288
    s_waitcnt lgkmcnt(2)
    v_pk_add_f32 v[84:85], v[84:85], v[86:87]
    s_waitcnt lgkmcnt(0)
    v_pk_add_f32 v[88:89], v[88:89], v[90:91]
    v_pk_add_f32 v[84:85], v[84:85], v[88:89]
    v_or_b32 v84, 1, v84
    v_or_b32 v85, 1, v85
    s_lshl_b32 s16, s29, 12
    s_add_u32 s16, s16, 0x600000
    s_cmp_lt_u32 s2, 224
    s_cselect_b32 s16, s16, 0x7ffffff0
    buffer_store_dwordx2 v[84:85], v16, s[8:11], s16 offen sc1
    s_cmp_lt_u32 s2, 224
    s_cbranch_scc1 adaLN_cond__sliding_block_cached__moe_arch_mod__prompt_kernel_end
    s_sub_u32 s16, s2, 224
    s_lshl_b32 s17, s16, 7
    s_add_u32 s17, s17, 0x600000
    v_lshrrev_b32 v16, 3, v0
    v_lshlrev_b32 v16, 12, v16
    v_and_b32 v17, 7, v0
    v_lshl_add_u32 v16, v17, 4, v16
    v_cmp_gt_u32 vcc, 256, v0
    v_bfrev_b32 v17, -2
    s_nop 0
    v_cndmask_b32 v17, v17, v16, vcc
    v_mov_b32 v19, 0
    v_cndmask_b32 v18, 1, v19, vcc
    s_lshl_b32 s18, s16, 6
    v_and_b32 v19, 31, v1
    v_lshlrev_b32 v19, 1, v19
    v_add_u32 v19, s18, v19
    s_mov_b32 s19, 0x541800
    buffer_load_ushort v95, v19, s[8:11], s19 offen sc1
    v_add_u32 v20, 66560, v19
    ds_read_u16 v96, v20
    ds_read_u16 v97, v20 offset:2048
    v_mov_b32 v94, v27
    v_cvt_pk_bf16_f32 v94, v94, v94
    v_lshlrev_b32 v94, 16, v94
    v_mul_f32 v94, 0xbfb8aa3b, v94
    v_exp_f32 v94, v94
    s_nop 0
    v_add_f32 v94, 1.0, v94
    v_rcp_f32 v94, v94
    s_nop 0
    v_cvt_pk_bf16_f32 v94, v94, v94
    v_lshlrev_b32 v94, 16, v94
    s_waitcnt vmcnt(0)
    v_lshlrev_b32 v95, 16, v95
    s_waitcnt lgkmcnt(1)
    v_lshlrev_b32 v96, 16, v96
    s_waitcnt lgkmcnt(0)
    v_lshlrev_b32 v97, 16, v97
    s_mov_b32 s27, 0
adaLN_cond__sliding_block_cached__moe_arch_mod__prompt_kernel_y13p:
    s_add_u32 s19, s17, 0x0
    buffer_load_dwordx4 v[44:47], v16, s[8:11], s19 offen sc1
    s_add_u32 s19, s17, 0x40000
    buffer_load_dwordx4 v[48:51], v16, s[8:11], s19 offen sc1
    s_add_u32 s19, s17, 0x80000
    buffer_load_dwordx4 v[52:55], v16, s[8:11], s19 offen sc1
    s_add_u32 s19, s17, 0xc0000
    buffer_load_dwordx4 v[56:59], v17, s[8:11], s19 offen sc1
    s_waitcnt vmcnt(0)
    v_min3_u32 v98, v56, v57, v58
    v_min_u32 v98, v98, v59
    v_or_b32 v98, v98, v18
    v_min3_u32 v98, v98, v44, v45
    v_min3_u32 v98, v98, v46, v47
    v_min3_u32 v98, v98, v48, v49
    v_min3_u32 v98, v98, v50, v51
    v_min3_u32 v98, v98, v52, v53
    v_min3_u32 v98, v98, v54, v55
    v_cmp_eq_u32 vcc, 0, v98
    s_add_u32 s27, s27, 1
    s_cmp_ge_u32 s27, 65536
    s_cbranch_scc1 adaLN_cond__sliding_block_cached__moe_arch_mod__prompt_kernel_y13g
    s_cbranch_vccnz adaLN_cond__sliding_block_cached__moe_arch_mod__prompt_kernel_y13p
adaLN_cond__sliding_block_cached__moe_arch_mod__prompt_kernel_y13g:
    v_pk_add_f32 v[44:45], v[44:45], v[52:53]
    v_pk_add_f32 v[46:47], v[46:47], v[54:55]
    v_pk_add_f32 v[48:49], v[48:49], v[56:57]
    v_pk_add_f32 v[50:51], v[50:51], v[58:59]
    v_pk_add_f32 v[44:45], v[44:45], v[48:49]
    v_pk_add_f32 v[46:47], v[46:47], v[50:51]
    s_nop 0
    v_add_f32_dpp v44, v44, v44 row_ror:8 row_mask:0xf bank_mask:0xf
    v_add_f32_dpp v45, v45, v45 row_ror:8 row_mask:0xf bank_mask:0xf
    v_add_f32_dpp v46, v46, v46 row_ror:8 row_mask:0xf bank_mask:0xf
    v_add_f32_dpp v47, v47, v47 row_ror:8 row_mask:0xf bank_mask:0xf
    s_nop 0
    v_permlane32_swap_b32 v44, v46
    v_permlane32_swap_b32 v45, v47
    v_add_f32 v44, v44, v46
    v_add_f32 v45, v45, v47
    s_nop 1
    v_permlane16_swap_b32 v44, v45
    v_add_f32 v44, v44, v45
    v_and_b32 v16, 7, v1
    v_lshlrev_b32 v16, 4, v16
    v_lshrrev_b32 v17, 4, v1
    v_lshl_add_u32 v16, v17, 2, v16
    s_lshl_b32 s19, s3, 7
    s_add_u32 s19, s19, 91136
    v_add_u32 v16, s19, v16
    ds_write_b32 v16, v44
    v_and_b32 v16, 31, v1
    v_lshlrev_b32 v16, 2, v16
    v_add_u32 v16, 91136, v16
    s_waitcnt lgkmcnt(0)
    s_barrier
    s_cmp_lg_u32 s3, 0
    s_cbranch_scc1 adaLN_cond__sliding_block_cached__moe_arch_mod__prompt_kernel_end
    ds_read_b32 v44, v16 offset:0
    ds_read_b32 v45, v16 offset:128
    ds_read_b32 v46, v16 offset:256
    ds_read_b32 v47, v16 offset:384
    ds_read_b32 v48, v16 offset:512
    ds_read_b32 v49, v16 offset:640
    ds_read_b32 v50, v16 offset:768
    ds_read_b32 v51, v16 offset:896
    s_waitcnt lgkmcnt(3)
    v_add_f32 v44, v44, v48
    s_waitcnt lgkmcnt(2)
    v_add_f32 v45, v45, v49
    s_waitcnt lgkmcnt(1)
    v_add_f32 v46, v46, v50
    s_waitcnt lgkmcnt(0)
    v_add_f32 v47, v47, v51
    v_add_f32 v44, v44, v46
    v_add_f32 v45, v45, v47
    v_add_f32 v44, v44, v45
    v_cvt_pk_bf16_f32 v44, v44, v44
    v_lshlrev_b32 v44, 16, v44
    v_mul_f32 v44, v44, v94
    v_cvt_pk_bf16_f32 v44, v44, v44
    v_lshlrev_b32 v44, 16, v44
    v_add_f32 v44, v44, v96
    v_cvt_pk_bf16_f32 v44, v44, v44
    v_lshlrev_b32 v44, 16, v44
    v_mul_f32 v44, v44, v95
    v_cvt_pk_bf16_f32 v44, v44, v44
    v_lshlrev_b32 v44, 16, v44
    v_add_f32 v44, v44, v97
    v_cvt_pk_bf16_f32 v44, v44, v44
    s_mov_b64 exec, 0xffffffff
    buffer_store_short v44, v19, s[68:71], s13 offen sc1
    s_branch adaLN_cond__sliding_block_cached__moe_arch_mod__prompt_kernel_end
adaLN_cond__sliding_block_cached__moe_arch_mod__prompt_kernel_roleB:
    v_mov_b32 v132, 0
    v_mov_b32 v133, 0
    v_lshrrev_b32 v16, 3, v0
    v_and_b32 v17, 7, v0
    v_mul_u32_u24 v135, 24576, v16
    v_lshl_add_u32 v135, v17, 4, v135
    v_lshlrev_b32 v136, 2, v16
    s_and_b32 s14, s2, 31
    s_lshr_b32 s15, s2, 5
    s_mul_i32 s26, s15, 1572864
    s_lshl_b32 s16, s14, 7
    s_add_u32 s26, s26, s16
    s_lshl_b32 s29, s15, 8
    v_lshlrev_b32 v137, 3, v0
    s_lshl_b32 s18, s2, 3
    s_add_u32 s18, s18, s3
    s_lshl_b32 s18, s18, 11
    v_and_b32 v18, 15, v1
    v_lshrrev_b32 v19, 4, v1
    v_lshlrev_b32 v138, 11, v18
    v_lshl_add_u32 v138, v19, 4, v138
    s_lshr_b32 s30, s2, 4
    s_and_b32 s31, s2, 15
    s_lshl_b32 s19, s30, 3
    s_add_u32 s19, s19, s3
    s_lshl_b32 s22, s19, 15
    s_lshl_b32 s23, s31, 7
    s_add_u32 s22, s22, s23
    s_lshl_b32 s23, s2, 12
    s_add_u32 s23, s23, 0x600000
    s_or_b32 s25, s2, s3
    s_cmp_eq_u32 s25, 0
    s_cselect_b32 s25, 0, 0x7ffffff0
    s_waitcnt lgkmcnt(0)
    s_mov_b64 s[64:65], s[58:59]
    s_mov_b32 s66, 0x100
    s_mov_b32 s67, 0x20000
    s_or_b32 s28, s62, 1
    v_mov_b32 v134, s28
    s_mov_b64 exec, 1
    buffer_store_dword v134, v132, s[64:67], s25 offen sc1
    s_mov_b64 exec, -1
    s_mov_b64 s[68:69], s[52:53]
    s_mov_b32 s70, 0x800
    s_mov_b32 s71, 0x20000
    s_mov_b64 s[72:73], s[54:55]
    s_mov_b32 s74, 0xc00000
    s_mov_b32 s75, 0x20000
    s_mov_b64 s[76:77], s[32:33]
    s_mov_b32 s78, 0x400000
    s_mov_b32 s79, 0x20000
    s_mov_b64 s[8:9], s[60:61]
    s_mov_b32 s10, 0x3400000
    s_mov_b32 s11, 0x20000
    buffer_load_dwordx4 v[32:35], v2, s[76:79], s18 offen offset:0
    buffer_load_dwordx4 v[36:39], v2, s[76:79], s18 offen offset:1024
    buffer_load_dword v72, v136, s[68:71], s29 offen
    buffer_load_dwordx4 v[24:27], v135, s[72:75], s26 offen
    s_add_u32 s26, s26, 12288
    buffer_load_dwordx4 v[28:31], v135, s[72:75], s26 offen
    buffer_store_dwordx2 v[132:133], v137, s[8:11], s23 offen sc1
    s_barrier
    buffer_load_dwordx4 v[40:43], v138, s[76:79], s22 offen offset:0
    buffer_load_dwordx4 v[44:47], v138, s[76:79], s22 offen offset:64
    s_mov_b32 s29, s19
    s_mov_b64 s[64:65], s[34:35]
    s_mov_b32 s66, 0x200000
    s_mov_b32 s67, 0x20000
    s_mov_b64 s[68:69], s[36:37]
    s_mov_b32 s70, 0x200000
    s_mov_b32 s71, 0x20000
    s_lshl_b32 s20, s2, 2
    s_add_u32 s20, s20, s3
    s_sub_u32 s20, s20, 4
    s_lshr_b32 s22, s20, 8
    s_bfe_u32 s23, s20, 0x40004
    s_and_b32 s24, s20, 15
    s_lshl_b32 s25, s22, 19
    s_lshl_b32 s26, s23, 13
    s_add_u32 s25, s25, s26
    s_add_u32 s25, s25, 393216
    v_and_b32 v16, 15, v1
    v_lshrrev_b32 v17, 4, v1
    s_lshl_b32 s21, s22, 17
    s_cmp_ge_u32 s24, 8
    s_cbranch_scc1 adaLN_cond__sliding_block_cached__moe_arch_mod__prompt_kernel_kvV
    v_lshlrev_b32 v18, 8, v16
    v_lshl_add_u32 v18, v17, 3, v18
    s_and_b32 s26, s24, 1
    s_lshl_b32 s26, s26, 12
    s_add_u32 s25, s25, s26
    s_lshr_b32 s26, s24, 1
    s_lshl_b32 s26, s26, 6
    s_add_u32 s25, s25, s26
    buffer_load_dwordx2 v[84:85], v18, s[64:67], s25 offen
    buffer_load_dwordx2 v[86:87], v18, s[64:67], s25 offen offset:32
    s_mov_b32 s26, 0x7ffffff0
    buffer_load_ushort v88, v18, s[64:67], s26 offen
    buffer_load_ushort v89, v18, s[64:67], s26 offen
    buffer_load_ushort v90, v18, s[64:67], s26 offen
    buffer_load_ushort v91, v18, s[64:67], s26 offen
    buffer_load_ushort v92, v18, s[64:67], s26 offen
    buffer_load_ushort v93, v18, s[64:67], s26 offen
    s_lshl_b32 s26, s23, 13
    s_add_u32 s21, s21, s26
    s_lshl_b32 s26, s24, 10
    s_add_u32 s21, s21, s26
    s_add_u32 s21, s21, 0x400000
    s_branch adaLN_cond__sliding_block_cached__moe_arch_mod__prompt_kernel_kvJ
adaLN_cond__sliding_block_cached__moe_arch_mod__prompt_kernel_kvV:
    s_bfe_u32 s26, s24, 0x20001
    s_lshl_b32 s26, s26, 6
    s_add_u32 s25, s25, s26
    s_and_b32 s26, s24, 1
    s_lshl_b32 s26, s26, 3
    s_add_u32 s25, s25, s26
    s_add_u32 s26, s25, 4096
    v_lshrrev_b32 v18, 2, v16
    v_lshlrev_b32 v18, 4, v18
    v_and_b32 v19, 3, v16
    v_lshl_add_u32 v18, v19, 1, v18
    v_lshl_add_u32 v18, v17, 10, v18
    buffer_load_ushort v88, v18, s[68:71], s25 offen offset:0
    buffer_load_ushort v89, v18, s[68:71], s25 offen offset:256
    buffer_load_ushort v90, v18, s[68:71], s25 offen offset:512
    buffer_load_ushort v91, v18, s[68:71], s25 offen offset:768
    buffer_load_ushort v92, v18, s[68:71], s26 offen offset:0
    buffer_load_ushort v93, v18, s[68:71], s26 offen offset:256
    buffer_load_ushort v94, v18, s[68:71], s26 offen offset:512
    buffer_load_ushort v95, v18, s[68:71], s26 offen offset:768
    s_bfe_u32 s26, s24, 0x20001
    s_lshl_b32 s26, s26, 15
    s_add_u32 s21, s21, s26
    s_lshl_b32 s26, s23, 11
    s_add_u32 s21, s21, s26
    s_and_b32 s26, s24, 1
    s_lshl_b32 s26, s26, 10
    s_add_u32 s21, s21, s26
    s_add_u32 s21, s21, 0x480000
adaLN_cond__sliding_block_cached__moe_arch_mod__prompt_kernel_kvJ:
    s_waitcnt vmcnt(15)
    v_lshlrev_b32 v56, 16, v32
    v_and_b32 v57, 0xffff0000, v32
    v_lshlrev_b32 v58, 16, v33
    v_and_b32 v59, 0xffff0000, v33
    v_lshlrev_b32 v60, 16, v34
    v_and_b32 v61, 0xffff0000, v34
    v_lshlrev_b32 v62, 16, v35
    v_and_b32 v63, 0xffff0000, v35
    s_waitcnt vmcnt(14)
    v_lshlrev_b32 v64, 16, v36
    v_and_b32 v65, 0xffff0000, v36
    v_lshlrev_b32 v66, 16, v37
    v_and_b32 v67, 0xffff0000, v37
    v_lshlrev_b32 v68, 16, v38
    v_and_b32 v69, 0xffff0000, v38
    v_lshlrev_b32 v70, 16, v39
    v_and_b32 v71, 0xffff0000, v39
    v_add_f32 v20, v56, v57
    v_add_f32 v21, v58, v59
    v_add_f32 v20, v20, v60
    v_add_f32 v21, v21, v61
    v_add_f32 v20, v20, v62
    v_add_f32 v21, v21, v63
    v_add_f32 v20, v20, v64
    v_add_f32 v21, v21, v65
    v_add_f32 v20, v20, v66
    v_add_f32 v21, v21, v67
    v_add_f32 v20, v20, v68
    v_add_f32 v21, v21, v69
    v_add_f32 v20, v20, v70
    v_add_f32 v21, v21, v71
    v_add_f32 v128, v20, v21
    s_nop 1
    v_add_f32_dpp v128, v128, v128 row_ror:1 row_mask:0xf bank_mask:0xf
    s_nop 1
    v_add_f32_dpp v128, v128, v128 row_ror:2 row_mask:0xf bank_mask:0xf
    s_nop 1
    v_add_f32_dpp v128, v128, v128 row_ror:4 row_mask:0xf bank_mask:0xf
    s_nop 1
    v_add_f32_dpp v128, v128, v128 row_ror:8 row_mask:0xf bank_mask:0xf
    v_mov_b32 v20, v128
    s_nop 1
    v_permlane16_swap_b32 v128, v20
    v_add_f32 v128, v128, v20
    v_mov_b32 v20, v128
    s_nop 1
    v_permlane32_swap_b32 v128, v20
    v_add_f32 v128, v128, v20
    v_mul_f32 v128, 0x3a800000, v128
    v_sub_f32 v18, v56, v128
    v_mul_f32 v20, v18, v18
    v_sub_f32 v19, v57, v128
    v_mul_f32 v21, v19, v19
    v_sub_f32 v18, v58, v128
    v_sub_f32 v19, v59, v128
    v_fmac_f32 v20, v18, v18
    v_fmac_f32 v21, v19, v19
    v_sub_f32 v18, v60, v128
    v_sub_f32 v19, v61, v128
    v_fmac_f32 v20, v18, v18
    v_fmac_f32 v21, v19, v19
    v_sub_f32 v18, v62, v128
    v_sub_f32 v19, v63, v128
    v_fmac_f32 v20, v18, v18
    v_fmac_f32 v21, v19, v19
    v_sub_f32 v18, v64, v128
    v_sub_f32 v19, v65, v128
    v_fmac_f32 v20, v18, v18
    v_fmac_f32 v21, v19, v19
    v_sub_f32 v18, v66, v128
    v_sub_f32 v19, v67, v128
    v_fmac_f32 v20, v18, v18
    v_fmac_f32 v21, v19, v19
    v_sub_f32 v18, v68, v128
    v_sub_f32 v19, v69, v128
    v_fmac_f32 v20, v18, v18
    v_fmac_f32 v21, v19, v19
    v_sub_f32 v18, v70, v128
    v_sub_f32 v19, v71, v128
    v_fmac_f32 v20, v18, v18
    v_fmac_f32 v21, v19, v19
    v_add_f32 v17, v20, v21
    s_nop 1
    v_add_f32_dpp v17, v17, v17 row_ror:1 row_mask:0xf bank_mask:0xf
    s_nop 1
    v_add_f32_dpp v17, v17, v17 row_ror:2 row_mask:0xf bank_mask:0xf
    s_nop 1
    v_add_f32_dpp v17, v17, v17 row_ror:4 row_mask:0xf bank_mask:0xf
    s_nop 1
    v_add_f32_dpp v17, v17, v17 row_ror:8 row_mask:0xf bank_mask:0xf
    v_mov_b32 v20, v17
    s_nop 1
    v_permlane16_swap_b32 v17, v20
    v_add_f32 v17, v17, v20
    v_mov_b32 v20, v17
    s_nop 1
    v_permlane32_swap_b32 v17, v20
    v_add_f32 v17, v17, v20
    v_mul_f32 v17, 0x3a800000, v17
    v_cvt_pk_bf16_f32 v128, v128, v128
    v_lshlrev_b32 v128, 16, v128
    v_cvt_pk_bf16_f32 v17, v17, v17
    v_lshlrev_b32 v17, 16, v17
    v_add_f32 v17, 0x3727c5ac, v17
    v_cvt_pk_bf16_f32 v17, v17, v17
    v_lshlrev_b32 v17, 16, v17
    v_sqrt_f32 v129, v17
    s_nop 0
    v_cvt_pk_bf16_f32 v129, v129, v129
    v_lshlrev_b32 v129, 16, v129
    v_rcp_f32 v130, v129
    s_lshl_b32 s16, s3, 4
    s_add_u32 s16, s16, 149520
    v_mov_b32 v19, s16
    ds_write_b128 v19, v[128:131]
    s_waitcnt vmcnt(13)
    v_and_b32 v73, 0xffff0000, v72
    v_lshlrev_b32 v72, 16, v72
    v_mul_f32 v16, 0xbfb8aa3b, v72
    v_exp_f32 v16, v16
    s_nop 0
    v_add_f32 v16, 1.0, v16
    v_rcp_f32 v16, v16
    s_nop 0
    v_mul_f32 v72, v72, v16
    v_mul_f32 v17, 0xbfb8aa3b, v73
    v_exp_f32 v17, v17
    s_nop 0
    v_add_f32 v17, 1.0, v17
    v_rcp_f32 v17, v17
    s_nop 0
    v_mul_f32 v73, v73, v17
    v_cvt_pk_bf16_f32 v16, v72, v73
    v_lshlrev_b32 v72, 16, v16
    v_and_b32 v73, 0xffff0000, v16
    s_lshl_b32 s16, s2, 8
    s_add_u32 s16, s16, 0x550000
    s_mov_b32 exec_lo, 0x01010101
    s_mov_b32 exec_hi, 0x01010101
    buffer_store_dword v16, v136, s[8:11], s16 offen sc1
    s_mov_b64 exec, -1
    v_lshrrev_b32 v74, 16, v72
    v_lshrrev_b32 v75, 16, v73
    s_waitcnt vmcnt(13)
    v_dot2_f32_bf16 v49, v24, v72, 0
    v_dot2_f32_bf16 v48, v24, v74, 0
    v_dot2_f32_bf16 v51, v25, v72, 0
    v_dot2_f32_bf16 v50, v25, v74, 0
    v_dot2_f32_bf16 v53, v26, v72, 0
    v_dot2_f32_bf16 v52, v26, v74, 0
    v_dot2_f32_bf16 v55, v27, v72, 0
    v_dot2_f32_bf16 v54, v27, v74, 0
    s_waitcnt vmcnt(12)
    v_dot2c_f32_bf16 v49, v28, v73
    v_dot2c_f32_bf16 v48, v28, v75
    v_dot2c_f32_bf16 v51, v29, v73
    v_dot2c_f32_bf16 v50, v29, v75
    v_dot2c_f32_bf16 v53, v30, v73
    v_dot2c_f32_bf16 v52, v30, v75
    v_dot2c_f32_bf16 v55, v31, v73
    v_dot2c_f32_bf16 v54, v31, v75
    s_nop 0
    v_permlane32_swap_b32 v48, v52
    v_permlane32_swap_b32 v49, v53
    v_permlane32_swap_b32 v50, v54
    v_permlane32_swap_b32 v51, v55
    v_add_f32 v48, v48, v52
    v_add_f32 v49, v49, v53
    v_add_f32 v50, v50, v54
    v_add_f32 v51, v51, v55
    s_nop 0
    v_permlane16_swap_b32 v48, v50
    v_permlane16_swap_b32 v49, v51
    v_add_f32 v48, v48, v50
    v_add_f32 v49, v49, v51
    s_nop 0
    v_add_f32_dpp v48, v48, v48 row_ror:8 row_mask:0xf bank_mask:0xf
    v_add_f32_dpp v49, v49, v49 row_ror:8 row_mask:0xf bank_mask:0xf
    v_and_b32 v16, 7, v1
    v_lshlrev_b32 v16, 5, v16
    v_lshrrev_b32 v17, 4, v1
    v_lshl_add_u32 v16, v17, 3, v16
    s_lshl_b32 s16, s3, 8
    s_add_u32 s16, s16, 147456
    v_add_u32 v16, s16, v16
    ds_write_b64 v16, v[48:49]
    v_mov_b32 v19, 149504
    v_and_b32 v17, 31, v1
    v_lshlrev_b32 v18, 3, v17
    v_add_u32 v18, 147456, v18
    v_lshlrev_b32 v17, 4, v17
    s_waitcnt lgkmcnt(0)
    s_barrier
    ds_read_b32 v134, v19
    ds_read_b64 v[96:97], v18 offset:0
    ds_read_b64 v[100:101], v18 offset:256
    ds_read_b64 v[104:105], v18 offset:512
    ds_read_b64 v[108:109], v18 offset:768
    ds_read_b64 v[112:113], v18 offset:1024
    ds_read_b64 v[116:117], v18 offset:1280
    ds_read_b64 v[120:121], v18 offset:1536
    ds_read_b64 v[124:125], v18 offset:1792
    s_waitcnt lgkmcnt(8)
    v_readfirstlane_b32 s28, v134
    v_and_b32 v20, 7, v1
    v_lshlrev_b32 v20, 4, v20
    v_add_u32 v21, 149520, v20
    ds_read_b128 v[128:131], v21
    s_waitcnt lgkmcnt(0)
    v_mov_b32 v131, s28
    s_lshl_b32 s16, s2, 7
    s_add_u32 s16, s16, 0x520000
    s_cmp_eq_u32 s3, 0
    s_cselect_b32 s16, s16, 0x7ffffff0
    s_mov_b64 exec, 0xff
    buffer_store_dwordx4 v[128:131], v20, s[8:11], s16 offen sc1
    s_mov_b64 exec, -1
    v_pk_add_f32 v[96:97], v[96:97], v[112:113]
    v_pk_add_f32 v[100:101], v[100:101], v[116:117]
    v_pk_add_f32 v[104:105], v[104:105], v[120:121]
    v_pk_add_f32 v[108:109], v[108:109], v[124:125]
    v_pk_add_f32 v[96:97], v[96:97], v[104:105]
    v_pk_add_f32 v[100:101], v[100:101], v[108:109]
    v_pk_add_f32 v[96:97], v[96:97], v[100:101]
    v_mov_b32 v98, s28
    v_mov_b32 v99, s28
    s_lshl_b32 s16, s14, 3
    s_add_u32 s16, s16, s15
    s_lshl_b32 s16, s16, 9
    s_add_u32 s16, s16, 0x500000
    s_cmp_eq_u32 s3, 0
    s_cselect_b32 s16, s16, 0x7ffffff0
    s_mov_b64 exec, 0xffffffff
    buffer_store_dwordx4 v[96:99], v17, s[8:11], s16 offen sc1
    s_mov_b64 exec, -1
    s_lshr_b32 s16, s3, 2
    s_lshl_b32 s16, s16, 4
    s_add_u32 s16, s16, s31
    s_lshl_b32 s16, s16, 12
    s_and_b32 s17, s3, 3
    s_lshl_b32 s17, s17, 7
    s_add_u32 s16, s16, s17
    s_add_u32 s16, s16, 0x500000
    v_lshrrev_b32 v139, 3, v1
    v_lshlrev_b32 v139, 9, v139
    v_and_b32 v16, 7, v1
    v_lshl_add_u32 v139, v16, 4, v139
    v_and_b32 v140, 15, v1
    v_lshlrev_b32 v140, 4, v140
    s_lshl_b32 s17, s29, 8
    s_add_u32 s17, s17, 0x520000
    s_waitcnt vmcnt(12)
    v_lshlrev_b32 v56, 16, v40
    v_and_b32 v57, 0xffff0000, v40
    v_lshlrev_b32 v58, 16, v41
    v_and_b32 v59, 0xffff0000, v41
    v_lshlrev_b32 v60, 16, v42
    v_and_b32 v61, 0xffff0000, v42
    v_lshlrev_b32 v62, 16, v43
    v_and_b32 v63, 0xffff0000, v43
    s_waitcnt vmcnt(11)
    v_lshlrev_b32 v64, 16, v44
    v_and_b32 v65, 0xffff0000, v44
    v_lshlrev_b32 v66, 16, v45
    v_and_b32 v67, 0xffff0000, v45
    v_lshlrev_b32 v68, 16, v46
    v_and_b32 v69, 0xffff0000, v46
    v_lshlrev_b32 v70, 16, v47
    v_and_b32 v71, 0xffff0000, v47
    v_mov_b32 v135, 2097152
    v_mul_lo_u32 v135, v135, v1
    s_mov_b64 s[76:77], s[40:41]
    s_mov_b32 s78, 0x800000
    s_mov_b32 s79, 0x20000
    s_mov_b32 s62, 0x0
    s_cmp_eq_u32 s3, 4
    s_cselect_b32 s62, s62, 0x7ffffff0
    buffer_load_dword v136, v135, s[76:79], s62 offen
    s_mov_b64 s[76:77], s[46:47]
    s_mov_b32 s78, 0x700000
    s_mov_b32 s79, 0x20000
    s_mov_b32 s62, 0x0
    s_cmp_eq_u32 s3, 4
    s_cselect_b32 s62, s62, 0x7ffffff0
    buffer_load_dword v136, v135, s[76:79], s62 offen
    s_mov_b64 s[76:77], s[48:49]
    s_mov_b32 s78, 0x700000
    s_mov_b32 s79, 0x20000
    s_mov_b32 s62, 0x0
    s_cmp_eq_u32 s3, 5
    s_cselect_b32 s62, s62, 0x7ffffff0
    buffer_load_dword v136, v135, s[76:79], s62 offen
    s_mov_b64 s[76:77], s[50:51]
    s_mov_b32 s78, 0x700000
    s_mov_b32 s79, 0x20000
    s_mov_b32 s62, 0x0
    s_cmp_eq_u32 s3, 5
    s_cselect_b32 s62, s62, 0x7ffffff0
    buffer_load_dword v136, v135, s[76:79], s62 offen
    s_mov_b64 s[76:77], s[38:39]
    s_mov_b32 s78, 0x800000
    s_mov_b32 s79, 0x20000
    s_mov_b32 s62, 0x0
    s_cmp_eq_u32 s3, 6
    s_cselect_b32 s62, s62, 0x7ffffff0
    buffer_load_dword v136, v135, s[76:79], s62 offen
    s_mov_b64 s[76:77], s[56:57]
    s_mov_b32 s78, 0x400000
    s_mov_b32 s79, 0x20000
    s_mov_b32 s62, 0x0
    s_cmp_eq_u32 s3, 6
    s_cselect_b32 s62, s62, 0x7ffffff0
    buffer_load_dword v136, v135, s[76:79], s62 offen
    s_mov_b64 s[76:77], s[54:55]
    s_mov_b32 s78, 0xc00000
    s_mov_b32 s79, 0x20000
    s_mov_b32 s62, 0x0
    s_cmp_eq_u32 s3, 7
    s_cselect_b32 s62, s62, 0x7ffffff0
    buffer_load_dword v136, v135, s[76:79], s62 offen
    s_mov_b64 s[76:77], s[44:45]
    s_mov_b32 s78, 0x800
    s_mov_b32 s79, 0x20000
    s_mov_b32 s62, 0x0
    s_cmp_eq_u32 s3, 7
    s_cselect_b32 s62, s62, 0x7ffffff0
    buffer_load_dword v136, v135, s[76:79], s62 offen
    s_mov_b32 s27, 0
adaLN_cond__sliding_block_cached__moe_arch_mod__prompt_kernel_g14p:
    buffer_load_dwordx4 v[76:79], v139, s[8:11], s16 offen sc1
    buffer_load_dwordx4 v[80:83], v140, s[8:11], s17 offen sc1
    s_waitcnt vmcnt(1)
    v_cmp_ne_u32 vcc, s28, v78
    v_cmp_ne_u32 s[62:63], s28, v79
    s_or_b64 vcc, vcc, s[62:63]
    s_waitcnt vmcnt(0)
    v_cmp_ne_u32 s[62:63], s28, v83
    s_or_b64 vcc, vcc, s[62:63]
    s_add_u32 s27, s27, 1
    s_cmp_ge_u32 s27, 65536
    s_cbranch_scc1 adaLN_cond__sliding_block_cached__moe_arch_mod__prompt_kernel_g14g
    s_cbranch_vccnz adaLN_cond__sliding_block_cached__moe_arch_mod__prompt_kernel_g14p
adaLN_cond__sliding_block_cached__moe_arch_mod__prompt_kernel_g14g:
    v_add_f32_dpp v76, v76, v76 row_ror:8 row_mask:0xf bank_mask:0xf
    v_add_f32_dpp v77, v77, v77 row_ror:8 row_mask:0xf bank_mask:0xf
    v_mov_b32 v17, v76
    s_nop 1
    v_permlane16_swap_b32 v76, v17
    v_add_f32 v76, v76, v17
    v_mov_b32 v18, v77
    s_nop 1
    v_permlane16_swap_b32 v77, v18
    v_add_f32 v77, v77, v18
    v_mov_b32 v17, v76
    s_nop 1
    v_permlane32_swap_b32 v76, v17
    v_add_f32 v76, v76, v17
    v_mov_b32 v18, v77
    s_nop 1
    v_permlane32_swap_b32 v77, v18
    v_add_f32 v77, v77, v18
    v_cvt_pk_bf16_f32 v17, v76, v77
    v_lshlrev_b32 v76, 16, v17
    v_and_b32 v77, 0xffff0000, v17
    v_add_f32 v76, 1.0, v76
    v_add_f32 v77, 1.0, v77
    v_cvt_pk_bf16_f32 v17, v76, v77
    v_lshlrev_b32 v76, 16, v17
    v_and_b32 v77, 0xffff0000, v17
    s_lshl_b32 s16, s3, 6
    s_add_u32 s16, s16, 151552
    v_lshl_add_u32 v16, v16, 3, s16
    ds_write_b64 v16, v[76:77]
    v_lshrrev_b32 v17, 4, v1
    v_lshlrev_b32 v17, 5, v17
    v_add_u32 v17, 151552, v17
    v_sub_f32 v56, v56, v80
    v_sub_f32 v57, v57, v80
    v_sub_f32 v58, v58, v80
    v_sub_f32 v59, v59, v80
    v_sub_f32 v60, v60, v80
    v_sub_f32 v61, v61, v80
    v_sub_f32 v62, v62, v80
    v_sub_f32 v63, v63, v80
    v_sub_f32 v64, v64, v80
    v_sub_f32 v65, v65, v80
    v_sub_f32 v66, v66, v80
    v_sub_f32 v67, v67, v80
    v_sub_f32 v68, v68, v80
    v_sub_f32 v69, v69, v80
    v_sub_f32 v70, v70, v80
    v_sub_f32 v71, v71, v80
    v_cvt_pk_bf16_f32 v18, v56, v57
    v_lshlrev_b32 v56, 16, v18
    v_and_b32 v57, 0xffff0000, v18
    v_cvt_pk_bf16_f32 v19, v58, v59
    v_lshlrev_b32 v58, 16, v19
    v_and_b32 v59, 0xffff0000, v19
    v_cvt_pk_bf16_f32 v18, v60, v61
    v_lshlrev_b32 v60, 16, v18
    v_and_b32 v61, 0xffff0000, v18
    v_cvt_pk_bf16_f32 v19, v62, v63
    v_lshlrev_b32 v62, 16, v19
    v_and_b32 v63, 0xffff0000, v19
    v_cvt_pk_bf16_f32 v18, v64, v65
    v_lshlrev_b32 v64, 16, v18
    v_and_b32 v65, 0xffff0000, v18
    v_cvt_pk_bf16_f32 v19, v66, v67
    v_lshlrev_b32 v66, 16, v19
    v_and_b32 v67, 0xffff0000, v19
    v_cvt_pk_bf16_f32 v18, v68, v69
    v_lshlrev_b32 v68, 16, v18
    v_and_b32 v69, 0xffff0000, v18
    v_cvt_pk_bf16_f32 v19, v70, v71
    v_lshlrev_b32 v70, 16, v19
    v_and_b32 v71, 0xffff0000, v19
    v_mul_f32 v56, v56, v82
    v_mul_f32 v57, v57, v82
    v_mul_f32 v58, v58, v82
    v_mul_f32 v59, v59, v82
    v_mul_f32 v60, v60, v82
    v_mul_f32 v61, v61, v82
    v_mul_f32 v62, v62, v82
    v_mul_f32 v63, v63, v82
    v_mul_f32 v64, v64, v82
    v_mul_f32 v65, v65, v82
    v_mul_f32 v66, v66, v82
    v_mul_f32 v67, v67, v82
    v_mul_f32 v68, v68, v82
    v_mul_f32 v69, v69, v82
    v_mul_f32 v70, v70, v82
    v_mul_f32 v71, v71, v82
    v_cvt_pk_bf16_f32 v18, v56, v57
    v_lshlrev_b32 v56, 16, v18
    v_and_b32 v57, 0xffff0000, v18
    v_cvt_pk_bf16_f32 v19, v58, v59
    v_lshlrev_b32 v58, 16, v19
    v_and_b32 v59, 0xffff0000, v19
    v_cvt_pk_bf16_f32 v18, v60, v61
    v_lshlrev_b32 v60, 16, v18
    v_and_b32 v61, 0xffff0000, v18
    v_cvt_pk_bf16_f32 v19, v62, v63
    v_lshlrev_b32 v62, 16, v19
    v_and_b32 v63, 0xffff0000, v19
    v_cvt_pk_bf16_f32 v18, v64, v65
    v_lshlrev_b32 v64, 16, v18
    v_and_b32 v65, 0xffff0000, v18
    v_cvt_pk_bf16_f32 v19, v66, v67
    v_lshlrev_b32 v66, 16, v19
    v_and_b32 v67, 0xffff0000, v19
    v_cvt_pk_bf16_f32 v18, v68, v69
    v_lshlrev_b32 v68, 16, v18
    v_and_b32 v69, 0xffff0000, v18
    v_cvt_pk_bf16_f32 v19, v70, v71
    v_lshlrev_b32 v70, 16, v19
    v_and_b32 v71, 0xffff0000, v19
    s_lshl_b32 s16, s29, 15
    s_lshl_b32 s17, s31, 11
    s_add_u32 s16, s16, s17
    s_waitcnt lgkmcnt(0)
    s_barrier
    s_cmp_lt_u32 s24, 8
    s_cbranch_scc1 adaLN_cond__sliding_block_cached__moe_arch_mod__prompt_kernel_kvS
    v_lshl_or_b32 v84, v89, 16, v88
    v_lshl_or_b32 v85, v91, 16, v90
    v_lshl_or_b32 v86, v93, 16, v92
    v_lshl_or_b32 v87, v95, 16, v94
    v_and_b32 v88, 0x7fff, v88
    v_and_b32 v89, 0x7fff, v89
    v_and_b32 v90, 0x7fff, v90
    v_and_b32 v91, 0x7fff, v91
    v_and_b32 v92, 0x7fff, v92
    v_and_b32 v93, 0x7fff, v93
    v_and_b32 v94, 0x7fff, v94
    v_and_b32 v95, 0x7fff, v95
    v_max3_u32 v88, v88, v89, v90
    v_max3_u32 v91, v91, v92, v93
    v_max3_u32 v88, v88, v94, v95
    v_max_u32 v88, v88, v91
    v_cmp_le_u32 vcc, 0x4980, v88
    v_mov_b32 v89, s28
    s_mov_b32 s26, 0x564000
    s_and_saveexec_b64 s[62:63], vcc
    buffer_store_dword v89, v132, s[8:11], s26 offen sc1
    s_mov_b64 exec, s[62:63]
adaLN_cond__sliding_block_cached__moe_arch_mod__prompt_kernel_kvS:
    buffer_store_dwordx4 v[84:87], v2, s[8:11], s21 offen sc1
    ds_read_b128 v[96:99], v17 offset:256
    ds_read_b128 v[104:107], v17 offset:0
    ds_read_b128 v[100:103], v17 offset:272
    ds_read_b128 v[108:111], v17 offset:16
    ds_read_b128 v[112:115], v17 offset:384
    ds_read_b128 v[120:123], v17 offset:128
    ds_read_b128 v[116:119], v17 offset:400
    ds_read_b128 v[124:127], v17 offset:144
    s_waitcnt lgkmcnt(7)
    v_pk_mul_f32 v[56:57], v[56:57], v[96:97]
    v_pk_mul_f32 v[58:59], v[58:59], v[98:99]
    s_waitcnt lgkmcnt(5)
    v_pk_mul_f32 v[60:61], v[60:61], v[100:101]
    v_pk_mul_f32 v[62:63], v[62:63], v[102:103]
    v_cvt_pk_bf16_f32 v18, v56, v57
    v_lshlrev_b32 v56, 16, v18
    v_and_b32 v57, 0xffff0000, v18
    v_cvt_pk_bf16_f32 v19, v58, v59
    v_lshlrev_b32 v58, 16, v19
    v_and_b32 v59, 0xffff0000, v19
    v_cvt_pk_bf16_f32 v18, v60, v61
    v_lshlrev_b32 v60, 16, v18
    v_and_b32 v61, 0xffff0000, v18
    v_cvt_pk_bf16_f32 v19, v62, v63
    v_lshlrev_b32 v62, 16, v19
    v_and_b32 v63, 0xffff0000, v19
    v_pk_add_f32 v[56:57], v[56:57], v[104:105]
    v_pk_add_f32 v[58:59], v[58:59], v[106:107]
    s_waitcnt lgkmcnt(4)
    v_pk_add_f32 v[60:61], v[60:61], v[108:109]
    v_pk_add_f32 v[62:63], v[62:63], v[110:111]
    v_cvt_pk_bf16_f32 v32, v56, v57
    v_cvt_pk_bf16_f32 v33, v58, v59
    v_cvt_pk_bf16_f32 v34, v60, v61
    v_cvt_pk_bf16_f32 v35, v62, v63
    buffer_store_dwordx4 v[32:35], v2, s[8:11], s16 offen offset:0 sc1
    s_waitcnt lgkmcnt(3)
    v_pk_mul_f32 v[64:65], v[64:65], v[112:113]
    v_pk_mul_f32 v[66:67], v[66:67], v[114:115]
    s_waitcnt lgkmcnt(1)
    v_pk_mul_f32 v[68:69], v[68:69], v[116:117]
    v_pk_mul_f32 v[70:71], v[70:71], v[118:119]
    v_cvt_pk_bf16_f32 v18, v64, v65
    v_lshlrev_b32 v64, 16, v18
    v_and_b32 v65, 0xffff0000, v18
    v_cvt_pk_bf16_f32 v19, v66, v67
    v_lshlrev_b32 v66, 16, v19
    v_and_b32 v67, 0xffff0000, v19
    v_cvt_pk_bf16_f32 v18, v68, v69
    v_lshlrev_b32 v68, 16, v18
    v_and_b32 v69, 0xffff0000, v18
    v_cvt_pk_bf16_f32 v19, v70, v71
    v_lshlrev_b32 v70, 16, v19
    v_and_b32 v71, 0xffff0000, v19
    v_pk_add_f32 v[64:65], v[64:65], v[120:121]
    v_pk_add_f32 v[66:67], v[66:67], v[122:123]
    s_waitcnt lgkmcnt(0)
    v_pk_add_f32 v[68:69], v[68:69], v[124:125]
    v_pk_add_f32 v[70:71], v[70:71], v[126:127]
    v_cvt_pk_bf16_f32 v36, v64, v65
    v_cvt_pk_bf16_f32 v37, v66, v67
    v_cvt_pk_bf16_f32 v38, v68, v69
    v_cvt_pk_bf16_f32 v39, v70, v71
    buffer_store_dwordx4 v[36:39], v2, s[8:11], s16 offen offset:1024 sc1
    s_lshl_b32 s19, s3, 16
    s_lshl_b32 s20, s3, 11
    s_lshl_b32 s16, s12, 8
    s_add_u32 s4, s38, s16
    s_addc_u32 s5, s39, 0
    s_sub_u32 s6, 0x800000, s16
    s_mov_b32 s7, 0x20000
    s_barrier
    s_add_u32 s22, s19, 0x0
    s_add_u32 m0, s20, 0x0
    s_nop 0
    buffer_load_dwordx4 v3, s[4:7], s22 offen lds
    s_add_u32 s22, s19, 0x8000
    s_add_u32 m0, s20, 0x400
    s_nop 0
    buffer_load_dwordx4 v3, s[4:7], s22 offen lds
    s_add_u32 s22, s19, 0x80000
    s_add_u32 m0, s20, 0x4000
    s_nop 0
    buffer_load_dwordx4 v3, s[4:7], s22 offen lds
    s_add_u32 s22, s19, 0x88000
    s_add_u32 m0, s20, 0x4400
    s_nop 0
    buffer_load_dwordx4 v3, s[4:7], s22 offen lds
    s_add_u32 s22, s19, 0x100000
    s_add_u32 m0, s20, 0x8000
    s_nop 0
    buffer_load_dwordx4 v3, s[4:7], s22 offen lds
    s_add_u32 s22, s19, 0x108000
    s_add_u32 m0, s20, 0x8400
    s_nop 0
    buffer_load_dwordx4 v3, s[4:7], s22 offen lds
    v_mov_b32 v134, s28
    s_lshl_b32 s16, s29, 4
    s_add_u32 s16, s16, s31
    s_lshl_b32 s16, s16, 2
    s_add_u32 s16, s16, 0x528000
    v_and_b32 v16, 31, v1
    v_lshlrev_b32 v16, 2, v16
    s_lshl_b32 s17, s13, 3
    s_add_u32 s17, s17, s3
    s_lshl_b32 s17, s17, 7
    s_add_u32 s17, s17, 0x528000
    s_waitcnt vmcnt(6)
    s_mov_b64 exec, 1
    buffer_store_dword v134, v132, s[8:11], s16 offen sc1
    s_mov_b64 exec, -1
    s_waitcnt vmcnt(0)
    s_mov_b32 s27, 0
adaLN_cond__sliding_block_cached__moe_arch_mod__prompt_kernel_h15p:
    buffer_load_dword v17, v16, s[8:11], s17 offen sc1
    s_waitcnt vmcnt(0)
    v_cmp_ne_u32 vcc, s28, v17
    s_add_u32 s27, s27, 1
    s_cmp_ge_u32 s27, 65536
    s_cbranch_scc1 adaLN_cond__sliding_block_cached__moe_arch_mod__prompt_kernel_h15g
    s_cbranch_vccnz adaLN_cond__sliding_block_cached__moe_arch_mod__prompt_kernel_h15p
adaLN_cond__sliding_block_cached__moe_arch_mod__prompt_kernel_h15g:
    s_mov_b32 s23, 0x0
    buffer_load_dwordx4 v[88:91], v7, s[8:11], s23 offen offset:0 sc1
    s_mov_b32 s23, 0x8000
    buffer_load_dwordx4 v[92:95], v7, s[8:11], s23 offen offset:0 sc1
    s_mov_b32 s23, 0x0
    buffer_load_dwordx4 v[96:99], v7, s[8:11], s23 offen offset:1024 sc1
    s_mov_b32 s23, 0x8000
    buffer_load_dwordx4 v[100:103], v7, s[8:11], s23 offen offset:1024 sc1
    s_mov_b32 s23, 0x800
    buffer_load_dwordx4 v[104:107], v7, s[8:11], s23 offen offset:0 sc1
    s_mov_b32 s23, 0x8800
    buffer_load_dwordx4 v[108:111], v7, s[8:11], s23 offen offset:0 sc1
    s_mov_b32 s23, 0x800
    buffer_load_dwordx4 v[112:115], v7, s[8:11], s23 offen offset:1024 sc1
    s_mov_b32 s23, 0x8800
    buffer_load_dwordx4 v[116:119], v7, s[8:11], s23 offen offset:1024 sc1
    s_lshr_b32 s21, s12, 3
    s_lshl_b32 s21, s21, 17
    s_add_u32 s21, s21, s20
    s_add_u32 s21, s21, 0x400000
    s_barrier
    ds_read_b64_tr_b16 v[224:225], v4 offset:0
    ds_read_b64_tr_b16 v[226:227], v4 offset:1024
    ds_read_b64_tr_b16 v[228:229], v5 offset:32
    ds_read_b64_tr_b16 v[230:231], v5 offset:1056
    ds_read_b64_tr_b16 v[232:233], v4 offset:256
    ds_read_b64_tr_b16 v[234:235], v4 offset:1280
    ds_read_b64_tr_b16 v[236:237], v5 offset:288
    ds_read_b64_tr_b16 v[238:239], v5 offset:1312
    s_waitcnt vmcnt(7) lgkmcnt(6)
    v_mfma_f32_16x16x32_bf16 v[24:27], v[224:227], v[88:91], 0
    ds_read_b64_tr_b16 v[240:241], v4 offset:512
    s_waitcnt vmcnt(6)
    v_mfma_f32_16x16x32_bf16 v[28:31], v[224:227], v[92:95], 0
    ds_read_b64_tr_b16 v[242:243], v4 offset:1536
    s_waitcnt lgkmcnt(6)
    v_mfma_f32_16x16x32_bf16 v[32:35], v[228:231], v[88:91], 0
    ds_read_b64_tr_b16 v[244:245], v5 offset:544
    v_mfma_f32_16x16x32_bf16 v[36:39], v[228:231], v[92:95], 0
    ds_read_b64_tr_b16 v[246:247], v5 offset:1568
    s_mov_b32 s23, 0x1000
    buffer_load_dwordx4 v[120:123], v7, s[8:11], s23 offen offset:0 sc1
    s_waitcnt lgkmcnt(6)
    v_mfma_f32_16x16x32_bf16 v[40:43], v[232:235], v[88:91], 0
    ds_read_b64_tr_b16 v[224:225], v4 offset:768
    v_mfma_f32_16x16x32_bf16 v[44:47], v[232:235], v[92:95], 0
    ds_read_b64_tr_b16 v[226:227], v4 offset:1792
    s_waitcnt lgkmcnt(6)
    v_mfma_f32_16x16x32_bf16 v[48:51], v[236:239], v[88:91], 0
    ds_read_b64_tr_b16 v[228:229], v5 offset:800
    v_mfma_f32_16x16x32_bf16 v[52:55], v[236:239], v[92:95], 0
    ds_read_b64_tr_b16 v[230:231], v5 offset:1824
    s_waitcnt lgkmcnt(6)
    v_mfma_f32_16x16x32_bf16 v[56:59], v[240:243], v[88:91], 0
    ds_read_b64_tr_b16 v[232:233], v4 offset:8192
    v_mfma_f32_16x16x32_bf16 v[60:63], v[240:243], v[92:95], 0
    ds_read_b64_tr_b16 v[234:235], v4 offset:9216
    s_waitcnt lgkmcnt(6)
    v_mfma_f32_16x16x32_bf16 v[64:67], v[244:247], v[88:91], 0
    ds_read_b64_tr_b16 v[236:237], v5 offset:8224
    v_mfma_f32_16x16x32_bf16 v[68:71], v[244:247], v[92:95], 0
    ds_read_b64_tr_b16 v[238:239], v5 offset:9248
    s_mov_b32 s23, 0x9000
    buffer_load_dwordx4 v[124:127], v7, s[8:11], s23 offen offset:0 sc1
    s_waitcnt lgkmcnt(6)
    v_mfma_f32_16x16x32_bf16 v[72:75], v[224:227], v[88:91], 0
    ds_read_b64_tr_b16 v[240:241], v4 offset:8448
    v_mfma_f32_16x16x32_bf16 v[76:79], v[224:227], v[92:95], 0
    ds_read_b64_tr_b16 v[242:243], v4 offset:9472
    s_waitcnt lgkmcnt(6)
    v_mfma_f32_16x16x32_bf16 v[80:83], v[228:231], v[88:91], 0
    ds_read_b64_tr_b16 v[244:245], v5 offset:8480
    v_mfma_f32_16x16x32_bf16 v[84:87], v[228:231], v[92:95], 0
    ds_read_b64_tr_b16 v[246:247], v5 offset:9504
    s_waitcnt vmcnt(7) lgkmcnt(6)
    v_mfma_f32_16x16x32_bf16 v[24:27], v[232:235], v[96:99], v[24:27]
    ds_read_b64_tr_b16 v[224:225], v4 offset:8704
    s_waitcnt vmcnt(6)
    v_mfma_f32_16x16x32_bf16 v[28:31], v[232:235], v[100:103], v[28:31]
    ds_read_b64_tr_b16 v[226:227], v4 offset:9728
    s_waitcnt lgkmcnt(6)
    v_mfma_f32_16x16x32_bf16 v[32:35], v[236:239], v[96:99], v[32:35]
    ds_read_b64_tr_b16 v[228:229], v5 offset:8736
    v_mfma_f32_16x16x32_bf16 v[36:39], v[236:239], v[100:103], v[36:39]
    ds_read_b64_tr_b16 v[230:231], v5 offset:9760
    s_mov_b32 s23, 0x1000
    buffer_load_dwordx4 v[128:131], v7, s[8:11], s23 offen offset:1024 sc1
    s_waitcnt lgkmcnt(6)
    v_mfma_f32_16x16x32_bf16 v[40:43], v[240:243], v[96:99], v[40:43]
    ds_read_b64_tr_b16 v[232:233], v4 offset:8960
    v_mfma_f32_16x16x32_bf16 v[44:47], v[240:243], v[100:103], v[44:47]
    ds_read_b64_tr_b16 v[234:235], v4 offset:9984
    s_waitcnt lgkmcnt(6)
    v_mfma_f32_16x16x32_bf16 v[48:51], v[244:247], v[96:99], v[48:51]
    ds_read_b64_tr_b16 v[236:237], v5 offset:8992
    v_mfma_f32_16x16x32_bf16 v[52:55], v[244:247], v[100:103], v[52:55]
    ds_read_b64_tr_b16 v[238:239], v5 offset:10016
    s_waitcnt lgkmcnt(6)
    v_mfma_f32_16x16x32_bf16 v[56:59], v[224:227], v[96:99], v[56:59]
    v_mfma_f32_16x16x32_bf16 v[60:63], v[224:227], v[100:103], v[60:63]
    s_barrier
    ds_read_b64_tr_b16 v[240:241], v4 offset:16384
    ds_read_b64_tr_b16 v[242:243], v4 offset:17408
    s_waitcnt lgkmcnt(6)
    v_mfma_f32_16x16x32_bf16 v[64:67], v[228:231], v[96:99], v[64:67]
    ds_read_b64_tr_b16 v[244:245], v5 offset:16416
    v_mfma_f32_16x16x32_bf16 v[68:71], v[228:231], v[100:103], v[68:71]
    s_add_u32 s22, s19, 0x180000
    s_add_u32 m0, s20, 0xc000
    s_nop 0
    buffer_load_dwordx4 v3, s[4:7], s22 offen lds
    ds_read_b64_tr_b16 v[246:247], v5 offset:17440
    s_mov_b32 s23, 0x9000
    buffer_load_dwordx4 v[132:135], v7, s[8:11], s23 offen offset:1024 sc1
    s_waitcnt lgkmcnt(6)
    v_mfma_f32_16x16x32_bf16 v[72:75], v[232:235], v[96:99], v[72:75]
    ds_read_b64_tr_b16 v[224:225], v4 offset:16640
    v_mfma_f32_16x16x32_bf16 v[76:79], v[232:235], v[100:103], v[76:79]
    ds_read_b64_tr_b16 v[226:227], v4 offset:17664
    s_waitcnt lgkmcnt(6)
    v_mfma_f32_16x16x32_bf16 v[80:83], v[236:239], v[96:99], v[80:83]
    ds_read_b64_tr_b16 v[228:229], v5 offset:16672
    v_mfma_f32_16x16x32_bf16 v[84:87], v[236:239], v[100:103], v[84:87]
    ds_read_b64_tr_b16 v[230:231], v5 offset:17696
    s_waitcnt vmcnt(8) lgkmcnt(6)
    v_mfma_f32_16x16x32_bf16 v[24:27], v[240:243], v[104:107], v[24:27]
    ds_read_b64_tr_b16 v[232:233], v4 offset:16896
    s_waitcnt vmcnt(7)
    v_mfma_f32_16x16x32_bf16 v[28:31], v[240:243], v[108:111], v[28:31]
    ds_read_b64_tr_b16 v[234:235], v4 offset:17920
    s_waitcnt lgkmcnt(6)
    v_mfma_f32_16x16x32_bf16 v[32:35], v[244:247], v[104:107], v[32:35]
    ds_read_b64_tr_b16 v[236:237], v5 offset:16928
    v_mfma_f32_16x16x32_bf16 v[36:39], v[244:247], v[108:111], v[36:39]
    s_add_u32 s22, s19, 0x188000
    s_add_u32 m0, s20, 0xc400
    s_nop 0
    buffer_load_dwordx4 v3, s[4:7], s22 offen lds
    ds_read_b64_tr_b16 v[238:239], v5 offset:17952
    s_mov_b32 s23, 0x1800
    buffer_load_dwordx4 v[88:91], v7, s[8:11], s23 offen offset:0 sc1
    s_waitcnt lgkmcnt(6)
    v_mfma_f32_16x16x32_bf16 v[40:43], v[224:227], v[104:107], v[40:43]
    ds_read_b64_tr_b16 v[240:241], v4 offset:17152
    v_mfma_f32_16x16x32_bf16 v[44:47], v[224:227], v[108:111], v[44:47]
    ds_read_b64_tr_b16 v[242:243], v4 offset:18176
    s_waitcnt lgkmcnt(6)
    v_mfma_f32_16x16x32_bf16 v[48:51], v[228:231], v[104:107], v[48:51]
    ds_read_b64_tr_b16 v[244:245], v5 offset:17184
    v_mfma_f32_16x16x32_bf16 v[52:55], v[228:231], v[108:111], v[52:55]
    ds_read_b64_tr_b16 v[246:247], v5 offset:18208
    s_waitcnt lgkmcnt(6)
    v_mfma_f32_16x16x32_bf16 v[56:59], v[232:235], v[104:107], v[56:59]
    ds_read_b64_tr_b16 v[224:225], v4 offset:24576
    v_mfma_f32_16x16x32_bf16 v[60:63], v[232:235], v[108:111], v[60:63]
    ds_read_b64_tr_b16 v[226:227], v4 offset:25600
    s_waitcnt lgkmcnt(6)
    v_mfma_f32_16x16x32_bf16 v[64:67], v[236:239], v[104:107], v[64:67]
    ds_read_b64_tr_b16 v[228:229], v5 offset:24608
    v_mfma_f32_16x16x32_bf16 v[68:71], v[236:239], v[108:111], v[68:71]
    ds_read_b64_tr_b16 v[230:231], v5 offset:25632
    s_mov_b32 s23, 0x9800
    buffer_load_dwordx4 v[92:95], v7, s[8:11], s23 offen offset:0 sc1
    s_waitcnt lgkmcnt(6)
    v_mfma_f32_16x16x32_bf16 v[72:75], v[240:243], v[104:107], v[72:75]
    ds_read_b64_tr_b16 v[232:233], v4 offset:24832
    v_mfma_f32_16x16x32_bf16 v[76:79], v[240:243], v[108:111], v[76:79]
    ds_read_b64_tr_b16 v[234:235], v4 offset:25856
    s_waitcnt lgkmcnt(6)
    v_mfma_f32_16x16x32_bf16 v[80:83], v[244:247], v[104:107], v[80:83]
    ds_read_b64_tr_b16 v[236:237], v5 offset:24864
    v_mfma_f32_16x16x32_bf16 v[84:87], v[244:247], v[108:111], v[84:87]
    ds_read_b64_tr_b16 v[238:239], v5 offset:25888
    s_waitcnt vmcnt(9) lgkmcnt(6)
    v_mfma_f32_16x16x32_bf16 v[24:27], v[224:227], v[112:115], v[24:27]
    ds_read_b64_tr_b16 v[240:241], v4 offset:25088
    s_waitcnt vmcnt(8)
    v_mfma_f32_16x16x32_bf16 v[28:31], v[224:227], v[116:119], v[28:31]
    ds_read_b64_tr_b16 v[242:243], v4 offset:26112
    s_waitcnt lgkmcnt(6)
    v_mfma_f32_16x16x32_bf16 v[32:35], v[228:231], v[112:115], v[32:35]
    ds_read_b64_tr_b16 v[244:245], v5 offset:25120
    v_mfma_f32_16x16x32_bf16 v[36:39], v[228:231], v[116:119], v[36:39]
    ds_read_b64_tr_b16 v[246:247], v5 offset:26144
    s_mov_b32 s23, 0x1800
    buffer_load_dwordx4 v[96:99], v7, s[8:11], s23 offen offset:1024 sc1
    s_waitcnt lgkmcnt(6)
    v_mfma_f32_16x16x32_bf16 v[40:43], v[232:235], v[112:115], v[40:43]
    ds_read_b64_tr_b16 v[224:225], v4 offset:25344
    v_mfma_f32_16x16x32_bf16 v[44:47], v[232:235], v[116:119], v[44:47]
    ds_read_b64_tr_b16 v[226:227], v4 offset:26368
    s_waitcnt lgkmcnt(6)
    v_mfma_f32_16x16x32_bf16 v[48:51], v[236:239], v[112:115], v[48:51]
    ds_read_b64_tr_b16 v[228:229], v5 offset:25376
    v_mfma_f32_16x16x32_bf16 v[52:55], v[236:239], v[116:119], v[52:55]
    ds_read_b64_tr_b16 v[230:231], v5 offset:26400
    s_waitcnt lgkmcnt(6)
    v_mfma_f32_16x16x32_bf16 v[56:59], v[240:243], v[112:115], v[56:59]
    v_mfma_f32_16x16x32_bf16 v[60:63], v[240:243], v[116:119], v[60:63]
    s_barrier
    ds_read_b64_tr_b16 v[232:233], v4 offset:32768
    ds_read_b64_tr_b16 v[234:235], v4 offset:33792
    s_waitcnt lgkmcnt(6)
    v_mfma_f32_16x16x32_bf16 v[64:67], v[244:247], v[112:115], v[64:67]
    ds_read_b64_tr_b16 v[236:237], v5 offset:32800
    v_mfma_f32_16x16x32_bf16 v[68:71], v[244:247], v[116:119], v[68:71]
    s_add_u32 s22, s19, 0x200000
    s_add_u32 m0, s20, 0x0
    s_nop 0
    buffer_load_dwordx4 v3, s[4:7], s22 offen lds
    ds_read_b64_tr_b16 v[238:239], v5 offset:33824
    s_mov_b32 s23, 0x9800
    buffer_load_dwordx4 v[100:103], v7, s[8:11], s23 offen offset:1024 sc1
    s_waitcnt lgkmcnt(6)
    v_mfma_f32_16x16x32_bf16 v[72:75], v[224:227], v[112:115], v[72:75]
    ds_read_b64_tr_b16 v[240:241], v4 offset:33024
    v_mfma_f32_16x16x32_bf16 v[76:79], v[224:227], v[116:119], v[76:79]
    ds_read_b64_tr_b16 v[242:243], v4 offset:34048
    s_waitcnt lgkmcnt(6)
    v_mfma_f32_16x16x32_bf16 v[80:83], v[228:231], v[112:115], v[80:83]
    ds_read_b64_tr_b16 v[244:245], v5 offset:33056
    v_mfma_f32_16x16x32_bf16 v[84:87], v[228:231], v[116:119], v[84:87]
    ds_read_b64_tr_b16 v[246:247], v5 offset:34080
    s_waitcnt vmcnt(10) lgkmcnt(6)
    v_mfma_f32_16x16x32_bf16 v[24:27], v[232:235], v[120:123], v[24:27]
    ds_read_b64_tr_b16 v[224:225], v4 offset:33280
    s_waitcnt vmcnt(9)
    v_mfma_f32_16x16x32_bf16 v[28:31], v[232:235], v[124:127], v[28:31]
    ds_read_b64_tr_b16 v[226:227], v4 offset:34304
    s_waitcnt lgkmcnt(6)
    v_mfma_f32_16x16x32_bf16 v[32:35], v[236:239], v[120:123], v[32:35]
    ds_read_b64_tr_b16 v[228:229], v5 offset:33312
    v_mfma_f32_16x16x32_bf16 v[36:39], v[236:239], v[124:127], v[36:39]
    s_add_u32 s22, s19, 0x208000
    s_add_u32 m0, s20, 0x400
    s_nop 0
    buffer_load_dwordx4 v3, s[4:7], s22 offen lds
    ds_read_b64_tr_b16 v[230:231], v5 offset:34336
    s_mov_b32 s23, 0x2000
    buffer_load_dwordx4 v[104:107], v7, s[8:11], s23 offen offset:0 sc1
    s_waitcnt lgkmcnt(6)
    v_mfma_f32_16x16x32_bf16 v[40:43], v[240:243], v[120:123], v[40:43]
    ds_read_b64_tr_b16 v[232:233], v4 offset:33536
    v_mfma_f32_16x16x32_bf16 v[44:47], v[240:243], v[124:127], v[44:47]
    ds_read_b64_tr_b16 v[234:235], v4 offset:34560
    s_waitcnt lgkmcnt(6)
    v_mfma_f32_16x16x32_bf16 v[48:51], v[244:247], v[120:123], v[48:51]
    ds_read_b64_tr_b16 v[236:237], v5 offset:33568
    v_mfma_f32_16x16x32_bf16 v[52:55], v[244:247], v[124:127], v[52:55]
    ds_read_b64_tr_b16 v[238:239], v5 offset:34592
    s_waitcnt lgkmcnt(6)
    v_mfma_f32_16x16x32_bf16 v[56:59], v[224:227], v[120:123], v[56:59]
    ds_read_b64_tr_b16 v[240:241], v4 offset:40960
    v_mfma_f32_16x16x32_bf16 v[60:63], v[224:227], v[124:127], v[60:63]
    ds_read_b64_tr_b16 v[242:243], v4 offset:41984
    s_waitcnt lgkmcnt(6)
    v_mfma_f32_16x16x32_bf16 v[64:67], v[228:231], v[120:123], v[64:67]
    ds_read_b64_tr_b16 v[244:245], v5 offset:40992
    v_mfma_f32_16x16x32_bf16 v[68:71], v[228:231], v[124:127], v[68:71]
    ds_read_b64_tr_b16 v[246:247], v5 offset:42016
    s_mov_b32 s23, 0xa000
    buffer_load_dwordx4 v[108:111], v7, s[8:11], s23 offen offset:0 sc1
    s_waitcnt lgkmcnt(6)
    v_mfma_f32_16x16x32_bf16 v[72:75], v[232:235], v[120:123], v[72:75]
    ds_read_b64_tr_b16 v[224:225], v4 offset:41216
    v_mfma_f32_16x16x32_bf16 v[76:79], v[232:235], v[124:127], v[76:79]
    ds_read_b64_tr_b16 v[226:227], v4 offset:42240
    s_waitcnt lgkmcnt(6)
    v_mfma_f32_16x16x32_bf16 v[80:83], v[236:239], v[120:123], v[80:83]
    ds_read_b64_tr_b16 v[228:229], v5 offset:41248
    v_mfma_f32_16x16x32_bf16 v[84:87], v[236:239], v[124:127], v[84:87]
    ds_read_b64_tr_b16 v[230:231], v5 offset:42272
    s_waitcnt vmcnt(11) lgkmcnt(6)
    v_mfma_f32_16x16x32_bf16 v[24:27], v[240:243], v[128:131], v[24:27]
    ds_read_b64_tr_b16 v[232:233], v4 offset:41472
    s_waitcnt vmcnt(9)
    v_mfma_f32_16x16x32_bf16 v[28:31], v[240:243], v[132:135], v[28:31]
    ds_read_b64_tr_b16 v[234:235], v4 offset:42496
    s_waitcnt lgkmcnt(6)
    v_mfma_f32_16x16x32_bf16 v[32:35], v[244:247], v[128:131], v[32:35]
    ds_read_b64_tr_b16 v[236:237], v5 offset:41504
    v_mfma_f32_16x16x32_bf16 v[36:39], v[244:247], v[132:135], v[36:39]
    ds_read_b64_tr_b16 v[238:239], v5 offset:42528
    s_mov_b32 s23, 0x2000
    buffer_load_dwordx4 v[112:115], v7, s[8:11], s23 offen offset:1024 sc1
    s_waitcnt lgkmcnt(6)
    v_mfma_f32_16x16x32_bf16 v[40:43], v[224:227], v[128:131], v[40:43]
    ds_read_b64_tr_b16 v[240:241], v4 offset:41728
    v_mfma_f32_16x16x32_bf16 v[44:47], v[224:227], v[132:135], v[44:47]
    ds_read_b64_tr_b16 v[242:243], v4 offset:42752
    s_waitcnt lgkmcnt(6)
    v_mfma_f32_16x16x32_bf16 v[48:51], v[228:231], v[128:131], v[48:51]
    ds_read_b64_tr_b16 v[244:245], v5 offset:41760
    v_mfma_f32_16x16x32_bf16 v[52:55], v[228:231], v[132:135], v[52:55]
    ds_read_b64_tr_b16 v[246:247], v5 offset:42784
    s_waitcnt lgkmcnt(6)
    v_mfma_f32_16x16x32_bf16 v[56:59], v[232:235], v[128:131], v[56:59]
    v_mfma_f32_16x16x32_bf16 v[60:63], v[232:235], v[132:135], v[60:63]
    s_waitcnt vmcnt(9)
    s_barrier
    ds_read_b64_tr_b16 v[224:225], v4 offset:49152
    ds_read_b64_tr_b16 v[226:227], v4 offset:50176
    s_waitcnt lgkmcnt(6)
    v_mfma_f32_16x16x32_bf16 v[64:67], v[236:239], v[128:131], v[64:67]
    ds_read_b64_tr_b16 v[228:229], v5 offset:49184
    v_mfma_f32_16x16x32_bf16 v[68:71], v[236:239], v[132:135], v[68:71]
    s_add_u32 s22, s19, 0x280000
    s_add_u32 m0, s20, 0x4000
    s_nop 0
    buffer_load_dwordx4 v3, s[4:7], s22 offen lds
    ds_read_b64_tr_b16 v[230:231], v5 offset:50208
    s_mov_b32 s23, 0xa000
    buffer_load_dwordx4 v[116:119], v7, s[8:11], s23 offen offset:1024 sc1
    s_waitcnt lgkmcnt(6)
    v_mfma_f32_16x16x32_bf16 v[72:75], v[240:243], v[128:131], v[72:75]
    ds_read_b64_tr_b16 v[232:233], v4 offset:49408
    v_mfma_f32_16x16x32_bf16 v[76:79], v[240:243], v[132:135], v[76:79]
    ds_read_b64_tr_b16 v[234:235], v4 offset:50432
    s_waitcnt lgkmcnt(6)
    v_mfma_f32_16x16x32_bf16 v[80:83], v[244:247], v[128:131], v[80:83]
    ds_read_b64_tr_b16 v[236:237], v5 offset:49440
    v_mfma_f32_16x16x32_bf16 v[84:87], v[244:247], v[132:135], v[84:87]
    ds_read_b64_tr_b16 v[238:239], v5 offset:50464
    s_waitcnt vmcnt(10) lgkmcnt(6)
    v_mfma_f32_16x16x32_bf16 v[24:27], v[224:227], v[88:91], v[24:27]
    ds_read_b64_tr_b16 v[240:241], v4 offset:49664
    s_waitcnt vmcnt(9)
    v_mfma_f32_16x16x32_bf16 v[28:31], v[224:227], v[92:95], v[28:31]
    ds_read_b64_tr_b16 v[242:243], v4 offset:50688
    s_waitcnt lgkmcnt(6)
    v_mfma_f32_16x16x32_bf16 v[32:35], v[228:231], v[88:91], v[32:35]
    ds_read_b64_tr_b16 v[244:245], v5 offset:49696
    v_mfma_f32_16x16x32_bf16 v[36:39], v[228:231], v[92:95], v[36:39]
    s_add_u32 s22, s19, 0x288000
    s_add_u32 m0, s20, 0x4400
    s_nop 0
    buffer_load_dwordx4 v3, s[4:7], s22 offen lds
    ds_read_b64_tr_b16 v[246:247], v5 offset:50720
    s_mov_b32 s23, 0x2800
    buffer_load_dwordx4 v[120:123], v7, s[8:11], s23 offen offset:0 sc1
    s_waitcnt lgkmcnt(6)
    v_mfma_f32_16x16x32_bf16 v[40:43], v[232:235], v[88:91], v[40:43]
    ds_read_b64_tr_b16 v[224:225], v4 offset:49920
    v_mfma_f32_16x16x32_bf16 v[44:47], v[232:235], v[92:95], v[44:47]
    ds_read_b64_tr_b16 v[226:227], v4 offset:50944
    s_waitcnt lgkmcnt(6)
    v_mfma_f32_16x16x32_bf16 v[48:51], v[236:239], v[88:91], v[48:51]
    ds_read_b64_tr_b16 v[228:229], v5 offset:49952
    v_mfma_f32_16x16x32_bf16 v[52:55], v[236:239], v[92:95], v[52:55]
    ds_read_b64_tr_b16 v[230:231], v5 offset:50976
    s_waitcnt lgkmcnt(6)
    v_mfma_f32_16x16x32_bf16 v[56:59], v[240:243], v[88:91], v[56:59]
    ds_read_b64_tr_b16 v[232:233], v4 offset:57344
    v_mfma_f32_16x16x32_bf16 v[60:63], v[240:243], v[92:95], v[60:63]
    ds_read_b64_tr_b16 v[234:235], v4 offset:58368
    s_waitcnt lgkmcnt(6)
    v_mfma_f32_16x16x32_bf16 v[64:67], v[244:247], v[88:91], v[64:67]
    ds_read_b64_tr_b16 v[236:237], v5 offset:57376
    v_mfma_f32_16x16x32_bf16 v[68:71], v[244:247], v[92:95], v[68:71]
    ds_read_b64_tr_b16 v[238:239], v5 offset:58400
    s_mov_b32 s23, 0xa800
    buffer_load_dwordx4 v[124:127], v7, s[8:11], s23 offen offset:0 sc1
    s_waitcnt lgkmcnt(6)
    v_mfma_f32_16x16x32_bf16 v[72:75], v[224:227], v[88:91], v[72:75]
    ds_read_b64_tr_b16 v[240:241], v4 offset:57600
    v_mfma_f32_16x16x32_bf16 v[76:79], v[224:227], v[92:95], v[76:79]
    ds_read_b64_tr_b16 v[242:243], v4 offset:58624
    s_waitcnt lgkmcnt(6)
    v_mfma_f32_16x16x32_bf16 v[80:83], v[228:231], v[88:91], v[80:83]
    ds_read_b64_tr_b16 v[244:245], v5 offset:57632
    v_mfma_f32_16x16x32_bf16 v[84:87], v[228:231], v[92:95], v[84:87]
    ds_read_b64_tr_b16 v[246:247], v5 offset:58656
    s_waitcnt vmcnt(11) lgkmcnt(6)
    v_mfma_f32_16x16x32_bf16 v[24:27], v[232:235], v[96:99], v[24:27]
    ds_read_b64_tr_b16 v[224:225], v4 offset:57856
    s_waitcnt vmcnt(9)
    v_mfma_f32_16x16x32_bf16 v[28:31], v[232:235], v[100:103], v[28:31]
    ds_read_b64_tr_b16 v[226:227], v4 offset:58880
    s_waitcnt lgkmcnt(6)
    v_mfma_f32_16x16x32_bf16 v[32:35], v[236:239], v[96:99], v[32:35]
    ds_read_b64_tr_b16 v[228:229], v5 offset:57888
    v_mfma_f32_16x16x32_bf16 v[36:39], v[236:239], v[100:103], v[36:39]
    ds_read_b64_tr_b16 v[230:231], v5 offset:58912
    s_mov_b32 s23, 0x2800
    buffer_load_dwordx4 v[128:131], v7, s[8:11], s23 offen offset:1024 sc1
    s_waitcnt lgkmcnt(6)
    v_mfma_f32_16x16x32_bf16 v[40:43], v[240:243], v[96:99], v[40:43]
    ds_read_b64_tr_b16 v[232:233], v4 offset:58112
    v_mfma_f32_16x16x32_bf16 v[44:47], v[240:243], v[100:103], v[44:47]
    ds_read_b64_tr_b16 v[234:235], v4 offset:59136
    s_waitcnt lgkmcnt(6)
    v_mfma_f32_16x16x32_bf16 v[48:51], v[244:247], v[96:99], v[48:51]
    ds_read_b64_tr_b16 v[236:237], v5 offset:58144
    v_mfma_f32_16x16x32_bf16 v[52:55], v[244:247], v[100:103], v[52:55]
    ds_read_b64_tr_b16 v[238:239], v5 offset:59168
    s_waitcnt lgkmcnt(6)
    v_mfma_f32_16x16x32_bf16 v[56:59], v[224:227], v[96:99], v[56:59]
    v_mfma_f32_16x16x32_bf16 v[60:63], v[224:227], v[100:103], v[60:63]
    s_waitcnt vmcnt(9)
    s_barrier
    ds_read_b64_tr_b16 v[240:241], v4 offset:0
    ds_read_b64_tr_b16 v[242:243], v4 offset:1024
    s_waitcnt lgkmcnt(6)
    v_mfma_f32_16x16x32_bf16 v[64:67], v[228:231], v[96:99], v[64:67]
    ds_read_b64_tr_b16 v[244:245], v5 offset:32
    v_mfma_f32_16x16x32_bf16 v[68:71], v[228:231], v[100:103], v[68:71]
    s_add_u32 s22, s19, 0x300000
    s_add_u32 m0, s20, 0x8000
    s_nop 0
    buffer_load_dwordx4 v3, s[4:7], s22 offen lds
    ds_read_b64_tr_b16 v[246:247], v5 offset:1056
    s_mov_b32 s23, 0xa800
    buffer_load_dwordx4 v[132:135], v7, s[8:11], s23 offen offset:1024 sc1
    s_waitcnt lgkmcnt(6)
    v_mfma_f32_16x16x32_bf16 v[72:75], v[232:235], v[96:99], v[72:75]
    ds_read_b64_tr_b16 v[224:225], v4 offset:256
    v_mfma_f32_16x16x32_bf16 v[76:79], v[232:235], v[100:103], v[76:79]
    ds_read_b64_tr_b16 v[226:227], v4 offset:1280
    s_waitcnt lgkmcnt(6)
    v_mfma_f32_16x16x32_bf16 v[80:83], v[236:239], v[96:99], v[80:83]
    ds_read_b64_tr_b16 v[228:229], v5 offset:288
    v_mfma_f32_16x16x32_bf16 v[84:87], v[236:239], v[100:103], v[84:87]
    ds_read_b64_tr_b16 v[230:231], v5 offset:1312
    s_waitcnt vmcnt(10) lgkmcnt(6)
    v_mfma_f32_16x16x32_bf16 v[24:27], v[240:243], v[104:107], v[24:27]
    ds_read_b64_tr_b16 v[232:233], v4 offset:512
    s_waitcnt vmcnt(9)
    v_mfma_f32_16x16x32_bf16 v[28:31], v[240:243], v[108:111], v[28:31]
    ds_read_b64_tr_b16 v[234:235], v4 offset:1536
    s_waitcnt lgkmcnt(6)
    v_mfma_f32_16x16x32_bf16 v[32:35], v[244:247], v[104:107], v[32:35]
    ds_read_b64_tr_b16 v[236:237], v5 offset:544
    v_mfma_f32_16x16x32_bf16 v[36:39], v[244:247], v[108:111], v[36:39]
    s_add_u32 s22, s19, 0x308000
    s_add_u32 m0, s20, 0x8400
    s_nop 0
    buffer_load_dwordx4 v3, s[4:7], s22 offen lds
    ds_read_b64_tr_b16 v[238:239], v5 offset:1568
    s_mov_b32 s23, 0x3000
    buffer_load_dwordx4 v[88:91], v7, s[8:11], s23 offen offset:0 sc1
    s_waitcnt lgkmcnt(6)
    v_mfma_f32_16x16x32_bf16 v[40:43], v[224:227], v[104:107], v[40:43]
    ds_read_b64_tr_b16 v[240:241], v4 offset:768
    v_mfma_f32_16x16x32_bf16 v[44:47], v[224:227], v[108:111], v[44:47]
    ds_read_b64_tr_b16 v[242:243], v4 offset:1792
    s_waitcnt lgkmcnt(6)
    v_mfma_f32_16x16x32_bf16 v[48:51], v[228:231], v[104:107], v[48:51]
    ds_read_b64_tr_b16 v[244:245], v5 offset:800
    v_mfma_f32_16x16x32_bf16 v[52:55], v[228:231], v[108:111], v[52:55]
    ds_read_b64_tr_b16 v[246:247], v5 offset:1824
    s_waitcnt lgkmcnt(6)
    v_mfma_f32_16x16x32_bf16 v[56:59], v[232:235], v[104:107], v[56:59]
    ds_read_b64_tr_b16 v[224:225], v4 offset:8192
    v_mfma_f32_16x16x32_bf16 v[60:63], v[232:235], v[108:111], v[60:63]
    ds_read_b64_tr_b16 v[226:227], v4 offset:9216
    s_waitcnt lgkmcnt(6)
    v_mfma_f32_16x16x32_bf16 v[64:67], v[236:239], v[104:107], v[64:67]
    ds_read_b64_tr_b16 v[228:229], v5 offset:8224
    v_mfma_f32_16x16x32_bf16 v[68:71], v[236:239], v[108:111], v[68:71]
    ds_read_b64_tr_b16 v[230:231], v5 offset:9248
    s_mov_b32 s23, 0xb000
    buffer_load_dwordx4 v[92:95], v7, s[8:11], s23 offen offset:0 sc1
    s_waitcnt lgkmcnt(6)
    v_mfma_f32_16x16x32_bf16 v[72:75], v[240:243], v[104:107], v[72:75]
    ds_read_b64_tr_b16 v[232:233], v4 offset:8448
    v_mfma_f32_16x16x32_bf16 v[76:79], v[240:243], v[108:111], v[76:79]
    ds_read_b64_tr_b16 v[234:235], v4 offset:9472
    s_waitcnt lgkmcnt(6)
    v_mfma_f32_16x16x32_bf16 v[80:83], v[244:247], v[104:107], v[80:83]
    ds_read_b64_tr_b16 v[236:237], v5 offset:8480
    v_mfma_f32_16x16x32_bf16 v[84:87], v[244:247], v[108:111], v[84:87]
    ds_read_b64_tr_b16 v[238:239], v5 offset:9504
    s_waitcnt vmcnt(11) lgkmcnt(6)
    v_mfma_f32_16x16x32_bf16 v[24:27], v[224:227], v[112:115], v[24:27]
    ds_read_b64_tr_b16 v[240:241], v4 offset:8704
    s_waitcnt vmcnt(9)
    v_mfma_f32_16x16x32_bf16 v[28:31], v[224:227], v[116:119], v[28:31]
    ds_read_b64_tr_b16 v[242:243], v4 offset:9728
    s_waitcnt lgkmcnt(6)
    v_mfma_f32_16x16x32_bf16 v[32:35], v[228:231], v[112:115], v[32:35]
    ds_read_b64_tr_b16 v[244:245], v5 offset:8736
    v_mfma_f32_16x16x32_bf16 v[36:39], v[228:231], v[116:119], v[36:39]
    ds_read_b64_tr_b16 v[246:247], v5 offset:9760
    s_mov_b32 s23, 0x3000
    buffer_load_dwordx4 v[96:99], v7, s[8:11], s23 offen offset:1024 sc1
    s_waitcnt lgkmcnt(6)
    v_mfma_f32_16x16x32_bf16 v[40:43], v[232:235], v[112:115], v[40:43]
    ds_read_b64_tr_b16 v[224:225], v4 offset:8960
    v_mfma_f32_16x16x32_bf16 v[44:47], v[232:235], v[116:119], v[44:47]
    ds_read_b64_tr_b16 v[226:227], v4 offset:9984
    s_waitcnt lgkmcnt(6)
    v_mfma_f32_16x16x32_bf16 v[48:51], v[236:239], v[112:115], v[48:51]
    ds_read_b64_tr_b16 v[228:229], v5 offset:8992
    v_mfma_f32_16x16x32_bf16 v[52:55], v[236:239], v[116:119], v[52:55]
    ds_read_b64_tr_b16 v[230:231], v5 offset:10016
    s_waitcnt lgkmcnt(6)
    v_mfma_f32_16x16x32_bf16 v[56:59], v[240:243], v[112:115], v[56:59]
    v_mfma_f32_16x16x32_bf16 v[60:63], v[240:243], v[116:119], v[60:63]
    s_waitcnt vmcnt(9)
    s_barrier
    ds_read_b64_tr_b16 v[232:233], v4 offset:16384
    ds_read_b64_tr_b16 v[234:235], v4 offset:17408
    s_waitcnt lgkmcnt(6)
    v_mfma_f32_16x16x32_bf16 v[64:67], v[244:247], v[112:115], v[64:67]
    ds_read_b64_tr_b16 v[236:237], v5 offset:16416
    v_mfma_f32_16x16x32_bf16 v[68:71], v[244:247], v[116:119], v[68:71]
    s_add_u32 s22, s19, 0x380000
    s_add_u32 m0, s20, 0xc000
    s_nop 0
    buffer_load_dwordx4 v3, s[4:7], s22 offen lds
    ds_read_b64_tr_b16 v[238:239], v5 offset:17440
    s_mov_b32 s23, 0xb000
    buffer_load_dwordx4 v[100:103], v7, s[8:11], s23 offen offset:1024 sc1
    s_waitcnt lgkmcnt(6)
    v_mfma_f32_16x16x32_bf16 v[72:75], v[224:227], v[112:115], v[72:75]
    ds_read_b64_tr_b16 v[240:241], v4 offset:16640
    v_mfma_f32_16x16x32_bf16 v[76:79], v[224:227], v[116:119], v[76:79]
    ds_read_b64_tr_b16 v[242:243], v4 offset:17664
    s_waitcnt lgkmcnt(6)
    v_mfma_f32_16x16x32_bf16 v[80:83], v[228:231], v[112:115], v[80:83]
    ds_read_b64_tr_b16 v[244:245], v5 offset:16672
    v_mfma_f32_16x16x32_bf16 v[84:87], v[228:231], v[116:119], v[84:87]
    ds_read_b64_tr_b16 v[246:247], v5 offset:17696
    s_waitcnt vmcnt(10) lgkmcnt(6)
    v_mfma_f32_16x16x32_bf16 v[24:27], v[232:235], v[120:123], v[24:27]
    ds_read_b64_tr_b16 v[224:225], v4 offset:16896
    s_waitcnt vmcnt(9)
    v_mfma_f32_16x16x32_bf16 v[28:31], v[232:235], v[124:127], v[28:31]
    ds_read_b64_tr_b16 v[226:227], v4 offset:17920
    s_waitcnt lgkmcnt(6)
    v_mfma_f32_16x16x32_bf16 v[32:35], v[236:239], v[120:123], v[32:35]
    ds_read_b64_tr_b16 v[228:229], v5 offset:16928
    v_mfma_f32_16x16x32_bf16 v[36:39], v[236:239], v[124:127], v[36:39]
    s_add_u32 s22, s19, 0x388000
    s_add_u32 m0, s20, 0xc400
    s_nop 0
    buffer_load_dwordx4 v3, s[4:7], s22 offen lds
    ds_read_b64_tr_b16 v[230:231], v5 offset:17952
    s_mov_b32 s23, 0x3800
    buffer_load_dwordx4 v[104:107], v7, s[8:11], s23 offen offset:0 sc1
    s_waitcnt lgkmcnt(6)
    v_mfma_f32_16x16x32_bf16 v[40:43], v[240:243], v[120:123], v[40:43]
    ds_read_b64_tr_b16 v[232:233], v4 offset:17152
    v_mfma_f32_16x16x32_bf16 v[44:47], v[240:243], v[124:127], v[44:47]
    ds_read_b64_tr_b16 v[234:235], v4 offset:18176
    s_waitcnt lgkmcnt(6)
    v_mfma_f32_16x16x32_bf16 v[48:51], v[244:247], v[120:123], v[48:51]
    ds_read_b64_tr_b16 v[236:237], v5 offset:17184
    v_mfma_f32_16x16x32_bf16 v[52:55], v[244:247], v[124:127], v[52:55]
    ds_read_b64_tr_b16 v[238:239], v5 offset:18208
    s_waitcnt lgkmcnt(6)
    v_mfma_f32_16x16x32_bf16 v[56:59], v[224:227], v[120:123], v[56:59]
    ds_read_b64_tr_b16 v[240:241], v4 offset:24576
    v_mfma_f32_16x16x32_bf16 v[60:63], v[224:227], v[124:127], v[60:63]
    ds_read_b64_tr_b16 v[242:243], v4 offset:25600
    s_waitcnt lgkmcnt(6)
    v_mfma_f32_16x16x32_bf16 v[64:67], v[228:231], v[120:123], v[64:67]
    ds_read_b64_tr_b16 v[244:245], v5 offset:24608
    v_mfma_f32_16x16x32_bf16 v[68:71], v[228:231], v[124:127], v[68:71]
    ds_read_b64_tr_b16 v[246:247], v5 offset:25632
    s_mov_b32 s23, 0xb800
    buffer_load_dwordx4 v[108:111], v7, s[8:11], s23 offen offset:0 sc1
    s_waitcnt lgkmcnt(6)
    v_mfma_f32_16x16x32_bf16 v[72:75], v[232:235], v[120:123], v[72:75]
    ds_read_b64_tr_b16 v[224:225], v4 offset:24832
    v_mfma_f32_16x16x32_bf16 v[76:79], v[232:235], v[124:127], v[76:79]
    ds_read_b64_tr_b16 v[226:227], v4 offset:25856
    s_waitcnt lgkmcnt(6)
    v_mfma_f32_16x16x32_bf16 v[80:83], v[236:239], v[120:123], v[80:83]
    ds_read_b64_tr_b16 v[228:229], v5 offset:24864
    v_mfma_f32_16x16x32_bf16 v[84:87], v[236:239], v[124:127], v[84:87]
    ds_read_b64_tr_b16 v[230:231], v5 offset:25888
    s_waitcnt vmcnt(11) lgkmcnt(6)
    v_mfma_f32_16x16x32_bf16 v[24:27], v[240:243], v[128:131], v[24:27]
    ds_read_b64_tr_b16 v[232:233], v4 offset:25088
    s_waitcnt vmcnt(9)
    v_mfma_f32_16x16x32_bf16 v[28:31], v[240:243], v[132:135], v[28:31]
    ds_read_b64_tr_b16 v[234:235], v4 offset:26112
    s_waitcnt lgkmcnt(6)
    v_mfma_f32_16x16x32_bf16 v[32:35], v[244:247], v[128:131], v[32:35]
    ds_read_b64_tr_b16 v[236:237], v5 offset:25120
    v_mfma_f32_16x16x32_bf16 v[36:39], v[244:247], v[132:135], v[36:39]
    ds_read_b64_tr_b16 v[238:239], v5 offset:26144
    s_mov_b32 s23, 0x3800
    buffer_load_dwordx4 v[112:115], v7, s[8:11], s23 offen offset:1024 sc1
    s_waitcnt lgkmcnt(6)
    v_mfma_f32_16x16x32_bf16 v[40:43], v[224:227], v[128:131], v[40:43]
    ds_read_b64_tr_b16 v[240:241], v4 offset:25344
    v_mfma_f32_16x16x32_bf16 v[44:47], v[224:227], v[132:135], v[44:47]
    ds_read_b64_tr_b16 v[242:243], v4 offset:26368
    s_waitcnt lgkmcnt(6)
    v_mfma_f32_16x16x32_bf16 v[48:51], v[228:231], v[128:131], v[48:51]
    ds_read_b64_tr_b16 v[244:245], v5 offset:25376
    v_mfma_f32_16x16x32_bf16 v[52:55], v[228:231], v[132:135], v[52:55]
    ds_read_b64_tr_b16 v[246:247], v5 offset:26400
    s_waitcnt lgkmcnt(6)
    v_mfma_f32_16x16x32_bf16 v[56:59], v[232:235], v[128:131], v[56:59]
    v_mfma_f32_16x16x32_bf16 v[60:63], v[232:235], v[132:135], v[60:63]
    s_waitcnt vmcnt(9)
    s_barrier
    ds_read_b64_tr_b16 v[224:225], v4 offset:32768
    ds_read_b64_tr_b16 v[226:227], v4 offset:33792
    s_waitcnt lgkmcnt(6)
    v_mfma_f32_16x16x32_bf16 v[64:67], v[236:239], v[128:131], v[64:67]
    ds_read_b64_tr_b16 v[228:229], v5 offset:32800
    v_mfma_f32_16x16x32_bf16 v[68:71], v[236:239], v[132:135], v[68:71]
    s_add_u32 s22, s19, 0x400000
    s_add_u32 m0, s20, 0x0
    s_nop 0
    buffer_load_dwordx4 v3, s[4:7], s22 offen lds
    ds_read_b64_tr_b16 v[230:231], v5 offset:33824
    s_mov_b32 s23, 0xb800
    buffer_load_dwordx4 v[116:119], v7, s[8:11], s23 offen offset:1024 sc1
    s_waitcnt lgkmcnt(6)
    v_mfma_f32_16x16x32_bf16 v[72:75], v[240:243], v[128:131], v[72:75]
    ds_read_b64_tr_b16 v[232:233], v4 offset:33024
    v_mfma_f32_16x16x32_bf16 v[76:79], v[240:243], v[132:135], v[76:79]
    ds_read_b64_tr_b16 v[234:235], v4 offset:34048
    s_waitcnt lgkmcnt(6)
    v_mfma_f32_16x16x32_bf16 v[80:83], v[244:247], v[128:131], v[80:83]
    ds_read_b64_tr_b16 v[236:237], v5 offset:33056
    v_mfma_f32_16x16x32_bf16 v[84:87], v[244:247], v[132:135], v[84:87]
    ds_read_b64_tr_b16 v[238:239], v5 offset:34080
    s_waitcnt vmcnt(10) lgkmcnt(6)
    v_mfma_f32_16x16x32_bf16 v[24:27], v[224:227], v[88:91], v[24:27]
    ds_read_b64_tr_b16 v[240:241], v4 offset:33280
    s_waitcnt vmcnt(9)
    v_mfma_f32_16x16x32_bf16 v[28:31], v[224:227], v[92:95], v[28:31]
    ds_read_b64_tr_b16 v[242:243], v4 offset:34304
    s_waitcnt lgkmcnt(6)
    v_mfma_f32_16x16x32_bf16 v[32:35], v[228:231], v[88:91], v[32:35]
    ds_read_b64_tr_b16 v[244:245], v5 offset:33312
    v_mfma_f32_16x16x32_bf16 v[36:39], v[228:231], v[92:95], v[36:39]
    s_add_u32 s22, s19, 0x408000
    s_add_u32 m0, s20, 0x400
    s_nop 0
    buffer_load_dwordx4 v3, s[4:7], s22 offen lds
    ds_read_b64_tr_b16 v[246:247], v5 offset:34336
    s_mov_b32 s23, 0x4000
    buffer_load_dwordx4 v[120:123], v7, s[8:11], s23 offen offset:0 sc1
    s_waitcnt lgkmcnt(6)
    v_mfma_f32_16x16x32_bf16 v[40:43], v[232:235], v[88:91], v[40:43]
    ds_read_b64_tr_b16 v[224:225], v4 offset:33536
    v_mfma_f32_16x16x32_bf16 v[44:47], v[232:235], v[92:95], v[44:47]
    ds_read_b64_tr_b16 v[226:227], v4 offset:34560
    s_waitcnt lgkmcnt(6)
    v_mfma_f32_16x16x32_bf16 v[48:51], v[236:239], v[88:91], v[48:51]
    ds_read_b64_tr_b16 v[228:229], v5 offset:33568
    v_mfma_f32_16x16x32_bf16 v[52:55], v[236:239], v[92:95], v[52:55]
    ds_read_b64_tr_b16 v[230:231], v5 offset:34592
    s_waitcnt lgkmcnt(6)
    v_mfma_f32_16x16x32_bf16 v[56:59], v[240:243], v[88:91], v[56:59]
    ds_read_b64_tr_b16 v[232:233], v4 offset:40960
    v_mfma_f32_16x16x32_bf16 v[60:63], v[240:243], v[92:95], v[60:63]
    ds_read_b64_tr_b16 v[234:235], v4 offset:41984
    s_waitcnt lgkmcnt(6)
    v_mfma_f32_16x16x32_bf16 v[64:67], v[244:247], v[88:91], v[64:67]
    ds_read_b64_tr_b16 v[236:237], v5 offset:40992
    v_mfma_f32_16x16x32_bf16 v[68:71], v[244:247], v[92:95], v[68:71]
    ds_read_b64_tr_b16 v[238:239], v5 offset:42016
    s_mov_b32 s23, 0xc000
    buffer_load_dwordx4 v[124:127], v7, s[8:11], s23 offen offset:0 sc1
    s_waitcnt lgkmcnt(6)
    v_mfma_f32_16x16x32_bf16 v[72:75], v[224:227], v[88:91], v[72:75]
    ds_read_b64_tr_b16 v[240:241], v4 offset:41216
    v_lshrrev_b32 v21, 4, v1
    v_lshlrev_b32 v21, 9, v21
    v_and_b32 v20, 15, v1
    v_lshl_add_u32 v21, v20, 4, v21
    s_lshr_b32 s18, s12, 3
    s_lshl_b32 s18, s18, 11
    s_add_u32 s18, s18, 0x528100
    buffer_load_dwordx4 v[12:15], v21, s[8:11], s18 offen sc1
    v_mfma_f32_16x16x32_bf16 v[76:79], v[224:227], v[92:95], v[76:79]
    ds_read_b64_tr_b16 v[242:243], v4 offset:42240
    s_waitcnt lgkmcnt(6)
    v_mfma_f32_16x16x32_bf16 v[80:83], v[228:231], v[88:91], v[80:83]
    ds_read_b64_tr_b16 v[244:245], v5 offset:41248
    v_mfma_f32_16x16x32_bf16 v[84:87], v[228:231], v[92:95], v[84:87]
    ds_read_b64_tr_b16 v[246:247], v5 offset:42272
    s_waitcnt vmcnt(12) lgkmcnt(6)
    v_mfma_f32_16x16x32_bf16 v[24:27], v[232:235], v[96:99], v[24:27]
    ds_read_b64_tr_b16 v[224:225], v4 offset:41472
    s_waitcnt vmcnt(10)
    v_mfma_f32_16x16x32_bf16 v[28:31], v[232:235], v[100:103], v[28:31]
    ds_read_b64_tr_b16 v[226:227], v4 offset:42496
    s_waitcnt lgkmcnt(6)
    v_mfma_f32_16x16x32_bf16 v[32:35], v[236:239], v[96:99], v[32:35]
    ds_read_b64_tr_b16 v[228:229], v5 offset:41504
    v_mfma_f32_16x16x32_bf16 v[36:39], v[236:239], v[100:103], v[36:39]
    ds_read_b64_tr_b16 v[230:231], v5 offset:42528
    s_mov_b32 s23, 0x4000
    buffer_load_dwordx4 v[128:131], v7, s[8:11], s23 offen offset:1024 sc1
    s_waitcnt lgkmcnt(6)
    v_mfma_f32_16x16x32_bf16 v[40:43], v[240:243], v[96:99], v[40:43]
    ds_read_b64_tr_b16 v[232:233], v4 offset:41728
    v_mfma_f32_16x16x32_bf16 v[44:47], v[240:243], v[100:103], v[44:47]
    ds_read_b64_tr_b16 v[234:235], v4 offset:42752
    s_waitcnt lgkmcnt(6)
    v_mfma_f32_16x16x32_bf16 v[48:51], v[244:247], v[96:99], v[48:51]
    ds_read_b64_tr_b16 v[236:237], v5 offset:41760
    v_mfma_f32_16x16x32_bf16 v[52:55], v[244:247], v[100:103], v[52:55]
    ds_read_b64_tr_b16 v[238:239], v5 offset:42784
    s_waitcnt lgkmcnt(6)
    v_mfma_f32_16x16x32_bf16 v[56:59], v[224:227], v[96:99], v[56:59]
    v_mfma_f32_16x16x32_bf16 v[60:63], v[224:227], v[100:103], v[60:63]
    s_waitcnt vmcnt(10)
    s_barrier
    ds_read_b64_tr_b16 v[240:241], v4 offset:49152
    ds_read_b64_tr_b16 v[242:243], v4 offset:50176
    s_waitcnt lgkmcnt(6)
    v_mfma_f32_16x16x32_bf16 v[64:67], v[228:231], v[96:99], v[64:67]
    ds_read_b64_tr_b16 v[244:245], v5 offset:49184
    v_mfma_f32_16x16x32_bf16 v[68:71], v[228:231], v[100:103], v[68:71]
    s_add_u32 s22, s19, 0x480000
    s_add_u32 m0, s20, 0x4000
    s_nop 0
    buffer_load_dwordx4 v3, s[4:7], s22 offen lds
    ds_read_b64_tr_b16 v[246:247], v5 offset:50208
    s_mov_b32 s23, 0xc000
    buffer_load_dwordx4 v[132:135], v7, s[8:11], s23 offen offset:1024 sc1
    s_waitcnt lgkmcnt(6)
    v_mfma_f32_16x16x32_bf16 v[72:75], v[232:235], v[96:99], v[72:75]
    ds_read_b64_tr_b16 v[224:225], v4 offset:49408
    v_mfma_f32_16x16x32_bf16 v[76:79], v[232:235], v[100:103], v[76:79]
    ds_read_b64_tr_b16 v[226:227], v4 offset:50432
    s_waitcnt lgkmcnt(6)
    v_mfma_f32_16x16x32_bf16 v[80:83], v[236:239], v[96:99], v[80:83]
    ds_read_b64_tr_b16 v[228:229], v5 offset:49440
    v_mfma_f32_16x16x32_bf16 v[84:87], v[236:239], v[100:103], v[84:87]
    ds_read_b64_tr_b16 v[230:231], v5 offset:50464
    s_waitcnt vmcnt(11) lgkmcnt(6)
    v_mfma_f32_16x16x32_bf16 v[24:27], v[240:243], v[104:107], v[24:27]
    ds_read_b64_tr_b16 v[232:233], v4 offset:49664
    s_waitcnt vmcnt(10)
    v_mfma_f32_16x16x32_bf16 v[28:31], v[240:243], v[108:111], v[28:31]
    ds_read_b64_tr_b16 v[234:235], v4 offset:50688
    s_waitcnt lgkmcnt(6)
    v_mfma_f32_16x16x32_bf16 v[32:35], v[244:247], v[104:107], v[32:35]
    ds_read_b64_tr_b16 v[236:237], v5 offset:49696
    v_mfma_f32_16x16x32_bf16 v[36:39], v[244:247], v[108:111], v[36:39]
    s_add_u32 s22, s19, 0x488000
    s_add_u32 m0, s20, 0x4400
    s_nop 0
    buffer_load_dwordx4 v3, s[4:7], s22 offen lds
    ds_read_b64_tr_b16 v[238:239], v5 offset:50720
    s_mov_b32 s23, 0x4800
    buffer_load_dwordx4 v[88:91], v7, s[8:11], s23 offen offset:0 sc1
    s_waitcnt lgkmcnt(6)
    v_mfma_f32_16x16x32_bf16 v[40:43], v[224:227], v[104:107], v[40:43]
    ds_read_b64_tr_b16 v[240:241], v4 offset:49920
    v_mfma_f32_16x16x32_bf16 v[44:47], v[224:227], v[108:111], v[44:47]
    ds_read_b64_tr_b16 v[242:243], v4 offset:50944
    s_waitcnt lgkmcnt(6)
    v_mfma_f32_16x16x32_bf16 v[48:51], v[228:231], v[104:107], v[48:51]
    ds_read_b64_tr_b16 v[244:245], v5 offset:49952
    v_mfma_f32_16x16x32_bf16 v[52:55], v[228:231], v[108:111], v[52:55]
    ds_read_b64_tr_b16 v[246:247], v5 offset:50976
    s_waitcnt lgkmcnt(6)
    v_mfma_f32_16x16x32_bf16 v[56:59], v[232:235], v[104:107], v[56:59]
    ds_read_b64_tr_b16 v[224:225], v4 offset:57344
    v_mfma_f32_16x16x32_bf16 v[60:63], v[232:235], v[108:111], v[60:63]
    ds_read_b64_tr_b16 v[226:227], v4 offset:58368
    s_waitcnt lgkmcnt(6)
    v_mfma_f32_16x16x32_bf16 v[64:67], v[236:239], v[104:107], v[64:67]
    ds_read_b64_tr_b16 v[228:229], v5 offset:57376
    v_mfma_f32_16x16x32_bf16 v[68:71], v[236:239], v[108:111], v[68:71]
    ds_read_b64_tr_b16 v[230:231], v5 offset:58400
    s_mov_b32 s23, 0xc800
    buffer_load_dwordx4 v[92:95], v7, s[8:11], s23 offen offset:0 sc1
    s_waitcnt lgkmcnt(6)
    v_mfma_f32_16x16x32_bf16 v[72:75], v[240:243], v[104:107], v[72:75]
    ds_read_b64_tr_b16 v[232:233], v4 offset:57600
    v_mfma_f32_16x16x32_bf16 v[76:79], v[240:243], v[108:111], v[76:79]
    ds_read_b64_tr_b16 v[234:235], v4 offset:58624
    s_waitcnt lgkmcnt(6)
    v_mfma_f32_16x16x32_bf16 v[80:83], v[244:247], v[104:107], v[80:83]
    ds_read_b64_tr_b16 v[236:237], v5 offset:57632
    v_mfma_f32_16x16x32_bf16 v[84:87], v[244:247], v[108:111], v[84:87]
    ds_read_b64_tr_b16 v[238:239], v5 offset:58656
    s_waitcnt vmcnt(12) lgkmcnt(6)
    v_mfma_f32_16x16x32_bf16 v[24:27], v[224:227], v[112:115], v[24:27]
    ds_read_b64_tr_b16 v[240:241], v4 offset:57856
    s_waitcnt vmcnt(10)
    v_mfma_f32_16x16x32_bf16 v[28:31], v[224:227], v[116:119], v[28:31]
    ds_read_b64_tr_b16 v[242:243], v4 offset:58880
    s_waitcnt lgkmcnt(6)
    v_mfma_f32_16x16x32_bf16 v[32:35], v[228:231], v[112:115], v[32:35]
    ds_read_b64_tr_b16 v[244:245], v5 offset:57888
    v_mfma_f32_16x16x32_bf16 v[36:39], v[228:231], v[116:119], v[36:39]
    ds_read_b64_tr_b16 v[246:247], v5 offset:58912
    s_mov_b32 s23, 0x4800
    buffer_load_dwordx4 v[96:99], v7, s[8:11], s23 offen offset:1024 sc1
    s_waitcnt lgkmcnt(6)
    v_mfma_f32_16x16x32_bf16 v[40:43], v[232:235], v[112:115], v[40:43]
    ds_read_b64_tr_b16 v[224:225], v4 offset:58112
    v_mfma_f32_16x16x32_bf16 v[44:47], v[232:235], v[116:119], v[44:47]
    ds_read_b64_tr_b16 v[226:227], v4 offset:59136
    s_waitcnt lgkmcnt(6)
    v_mfma_f32_16x16x32_bf16 v[48:51], v[236:239], v[112:115], v[48:51]
    ds_read_b64_tr_b16 v[228:229], v5 offset:58144
    v_mfma_f32_16x16x32_bf16 v[52:55], v[236:239], v[116:119], v[52:55]
    ds_read_b64_tr_b16 v[230:231], v5 offset:59168
    s_waitcnt lgkmcnt(6)
    v_mfma_f32_16x16x32_bf16 v[56:59], v[240:243], v[112:115], v[56:59]
    v_mfma_f32_16x16x32_bf16 v[60:63], v[240:243], v[116:119], v[60:63]
    s_waitcnt vmcnt(10)
    s_barrier
    ds_read_b64_tr_b16 v[232:233], v4 offset:0
    ds_read_b64_tr_b16 v[234:235], v4 offset:1024
    s_waitcnt lgkmcnt(6)
    v_mfma_f32_16x16x32_bf16 v[64:67], v[244:247], v[112:115], v[64:67]
    ds_read_b64_tr_b16 v[236:237], v5 offset:32
    v_mfma_f32_16x16x32_bf16 v[68:71], v[244:247], v[116:119], v[68:71]
    s_add_u32 s22, s19, 0x500000
    s_add_u32 m0, s20, 0x8000
    s_nop 0
    buffer_load_dwordx4 v3, s[4:7], s22 offen lds
    ds_read_b64_tr_b16 v[238:239], v5 offset:1056
    s_mov_b32 s23, 0xc800
    buffer_load_dwordx4 v[100:103], v7, s[8:11], s23 offen offset:1024 sc1
    s_waitcnt lgkmcnt(6)
    v_mfma_f32_16x16x32_bf16 v[72:75], v[224:227], v[112:115], v[72:75]
    ds_read_b64_tr_b16 v[240:241], v4 offset:256
    v_mfma_f32_16x16x32_bf16 v[76:79], v[224:227], v[116:119], v[76:79]
    ds_read_b64_tr_b16 v[242:243], v4 offset:1280
    s_waitcnt lgkmcnt(6)
    v_mfma_f32_16x16x32_bf16 v[80:83], v[228:231], v[112:115], v[80:83]
    ds_read_b64_tr_b16 v[244:245], v5 offset:288
    v_mfma_f32_16x16x32_bf16 v[84:87], v[228:231], v[116:119], v[84:87]
    ds_read_b64_tr_b16 v[246:247], v5 offset:1312
    s_waitcnt vmcnt(11) lgkmcnt(6)
    v_mfma_f32_16x16x32_bf16 v[24:27], v[232:235], v[120:123], v[24:27]
    ds_read_b64_tr_b16 v[224:225], v4 offset:512
    s_waitcnt vmcnt(10)
    v_mfma_f32_16x16x32_bf16 v[28:31], v[232:235], v[124:127], v[28:31]
    ds_read_b64_tr_b16 v[226:227], v4 offset:1536
    s_waitcnt lgkmcnt(6)
    v_mfma_f32_16x16x32_bf16 v[32:35], v[236:239], v[120:123], v[32:35]
    ds_read_b64_tr_b16 v[228:229], v5 offset:544
    v_mfma_f32_16x16x32_bf16 v[36:39], v[236:239], v[124:127], v[36:39]
    s_add_u32 s22, s19, 0x508000
    s_add_u32 m0, s20, 0x8400
    s_nop 0
    buffer_load_dwordx4 v3, s[4:7], s22 offen lds
    ds_read_b64_tr_b16 v[230:231], v5 offset:1568
    s_mov_b32 s23, 0x5000
    buffer_load_dwordx4 v[104:107], v7, s[8:11], s23 offen offset:0 sc1
    s_waitcnt lgkmcnt(6)
    v_mfma_f32_16x16x32_bf16 v[40:43], v[240:243], v[120:123], v[40:43]
    ds_read_b64_tr_b16 v[232:233], v4 offset:768
    v_mfma_f32_16x16x32_bf16 v[44:47], v[240:243], v[124:127], v[44:47]
    ds_read_b64_tr_b16 v[234:235], v4 offset:1792
    s_waitcnt lgkmcnt(6)
    v_mfma_f32_16x16x32_bf16 v[48:51], v[244:247], v[120:123], v[48:51]
    ds_read_b64_tr_b16 v[236:237], v5 offset:800
    v_mfma_f32_16x16x32_bf16 v[52:55], v[244:247], v[124:127], v[52:55]
    ds_read_b64_tr_b16 v[238:239], v5 offset:1824
    s_waitcnt lgkmcnt(6)
    v_mfma_f32_16x16x32_bf16 v[56:59], v[224:227], v[120:123], v[56:59]
    ds_read_b64_tr_b16 v[240:241], v4 offset:8192
    v_mfma_f32_16x16x32_bf16 v[60:63], v[224:227], v[124:127], v[60:63]
    ds_read_b64_tr_b16 v[242:243], v4 offset:9216
    s_waitcnt lgkmcnt(6)
    v_mfma_f32_16x16x32_bf16 v[64:67], v[228:231], v[120:123], v[64:67]
    ds_read_b64_tr_b16 v[244:245], v5 offset:8224
    v_mfma_f32_16x16x32_bf16 v[68:71], v[228:231], v[124:127], v[68:71]
    ds_read_b64_tr_b16 v[246:247], v5 offset:9248
    s_mov_b32 s23, 0xd000
    buffer_load_dwordx4 v[108:111], v7, s[8:11], s23 offen offset:0 sc1
    s_waitcnt lgkmcnt(6)
    v_mfma_f32_16x16x32_bf16 v[72:75], v[232:235], v[120:123], v[72:75]
    ds_read_b64_tr_b16 v[224:225], v4 offset:8448
    v_mfma_f32_16x16x32_bf16 v[76:79], v[232:235], v[124:127], v[76:79]
    ds_read_b64_tr_b16 v[226:227], v4 offset:9472
    s_waitcnt lgkmcnt(6)
    v_mfma_f32_16x16x32_bf16 v[80:83], v[236:239], v[120:123], v[80:83]
    ds_read_b64_tr_b16 v[228:229], v5 offset:8480
    v_mfma_f32_16x16x32_bf16 v[84:87], v[236:239], v[124:127], v[84:87]
    ds_read_b64_tr_b16 v[230:231], v5 offset:9504
    s_waitcnt vmcnt(11) lgkmcnt(6)
    v_mfma_f32_16x16x32_bf16 v[24:27], v[240:243], v[128:131], v[24:27]
    ds_read_b64_tr_b16 v[232:233], v4 offset:8704
    s_waitcnt vmcnt(9)
    v_mfma_f32_16x16x32_bf16 v[28:31], v[240:243], v[132:135], v[28:31]
    ds_read_b64_tr_b16 v[234:235], v4 offset:9728
    s_waitcnt lgkmcnt(6)
    v_mfma_f32_16x16x32_bf16 v[32:35], v[244:247], v[128:131], v[32:35]
    ds_read_b64_tr_b16 v[236:237], v5 offset:8736
    v_mfma_f32_16x16x32_bf16 v[36:39], v[244:247], v[132:135], v[36:39]
    ds_read_b64_tr_b16 v[238:239], v5 offset:9760
    s_mov_b32 s23, 0x5000
    buffer_load_dwordx4 v[112:115], v7, s[8:11], s23 offen offset:1024 sc1
    s_waitcnt lgkmcnt(6)
    v_mfma_f32_16x16x32_bf16 v[40:43], v[224:227], v[128:131], v[40:43]
    ds_read_b64_tr_b16 v[240:241], v4 offset:8960
    v_mfma_f32_16x16x32_bf16 v[44:47], v[224:227], v[132:135], v[44:47]
    ds_read_b64_tr_b16 v[242:243], v4 offset:9984
    s_waitcnt lgkmcnt(6)
    v_mfma_f32_16x16x32_bf16 v[48:51], v[228:231], v[128:131], v[48:51]
    ds_read_b64_tr_b16 v[244:245], v5 offset:8992
    v_mfma_f32_16x16x32_bf16 v[52:55], v[228:231], v[132:135], v[52:55]
    ds_read_b64_tr_b16 v[246:247], v5 offset:10016
    s_waitcnt lgkmcnt(6)
    v_mfma_f32_16x16x32_bf16 v[56:59], v[232:235], v[128:131], v[56:59]
    v_mfma_f32_16x16x32_bf16 v[60:63], v[232:235], v[132:135], v[60:63]
    s_waitcnt vmcnt(9)
    s_barrier
    ds_read_b64_tr_b16 v[224:225], v4 offset:16384
    ds_read_b64_tr_b16 v[226:227], v4 offset:17408
    s_waitcnt lgkmcnt(6)
    v_mfma_f32_16x16x32_bf16 v[64:67], v[236:239], v[128:131], v[64:67]
    ds_read_b64_tr_b16 v[228:229], v5 offset:16416
    v_mfma_f32_16x16x32_bf16 v[68:71], v[236:239], v[132:135], v[68:71]
    s_add_u32 s22, s19, 0x580000
    s_add_u32 m0, s20, 0xc000
    s_nop 0
    buffer_load_dwordx4 v3, s[4:7], s22 offen lds
    ds_read_b64_tr_b16 v[230:231], v5 offset:17440
    s_mov_b32 s23, 0xd000
    buffer_load_dwordx4 v[116:119], v7, s[8:11], s23 offen offset:1024 sc1
    s_waitcnt lgkmcnt(6)
    v_mfma_f32_16x16x32_bf16 v[72:75], v[240:243], v[128:131], v[72:75]
    ds_read_b64_tr_b16 v[232:233], v4 offset:16640
    v_mfma_f32_16x16x32_bf16 v[76:79], v[240:243], v[132:135], v[76:79]
    ds_read_b64_tr_b16 v[234:235], v4 offset:17664
    s_waitcnt lgkmcnt(6)
    v_mfma_f32_16x16x32_bf16 v[80:83], v[244:247], v[128:131], v[80:83]
    ds_read_b64_tr_b16 v[236:237], v5 offset:16672
    v_mfma_f32_16x16x32_bf16 v[84:87], v[244:247], v[132:135], v[84:87]
    ds_read_b64_tr_b16 v[238:239], v5 offset:17696
    s_waitcnt vmcnt(10) lgkmcnt(6)
    v_mfma_f32_16x16x32_bf16 v[24:27], v[224:227], v[88:91], v[24:27]
    ds_read_b64_tr_b16 v[240:241], v4 offset:16896
    s_waitcnt vmcnt(9)
    v_mfma_f32_16x16x32_bf16 v[28:31], v[224:227], v[92:95], v[28:31]
    ds_read_b64_tr_b16 v[242:243], v4 offset:17920
    s_waitcnt lgkmcnt(6)
    v_mfma_f32_16x16x32_bf16 v[32:35], v[228:231], v[88:91], v[32:35]
    ds_read_b64_tr_b16 v[244:245], v5 offset:16928
    v_mfma_f32_16x16x32_bf16 v[36:39], v[228:231], v[92:95], v[36:39]
    s_add_u32 s22, s19, 0x588000
    s_add_u32 m0, s20, 0xc400
    s_nop 0
    buffer_load_dwordx4 v3, s[4:7], s22 offen lds
    ds_read_b64_tr_b16 v[246:247], v5 offset:17952
    s_mov_b32 s23, 0x5800
    buffer_load_dwordx4 v[120:123], v7, s[8:11], s23 offen offset:0 sc1
    s_waitcnt lgkmcnt(6)
    v_mfma_f32_16x16x32_bf16 v[40:43], v[232:235], v[88:91], v[40:43]
    ds_read_b64_tr_b16 v[224:225], v4 offset:17152
    v_mfma_f32_16x16x32_bf16 v[44:47], v[232:235], v[92:95], v[44:47]
    ds_read_b64_tr_b16 v[226:227], v4 offset:18176
    s_waitcnt lgkmcnt(6)
    v_mfma_f32_16x16x32_bf16 v[48:51], v[236:239], v[88:91], v[48:51]
    ds_read_b64_tr_b16 v[228:229], v5 offset:17184
    v_mfma_f32_16x16x32_bf16 v[52:55], v[236:239], v[92:95], v[52:55]
    ds_read_b64_tr_b16 v[230:231], v5 offset:18208
    s_waitcnt lgkmcnt(6)
    v_mfma_f32_16x16x32_bf16 v[56:59], v[240:243], v[88:91], v[56:59]
    ds_read_b64_tr_b16 v[232:233], v4 offset:24576
    v_mfma_f32_16x16x32_bf16 v[60:63], v[240:243], v[92:95], v[60:63]
    ds_read_b64_tr_b16 v[234:235], v4 offset:25600
    s_waitcnt lgkmcnt(6)
    v_mfma_f32_16x16x32_bf16 v[64:67], v[244:247], v[88:91], v[64:67]
    ds_read_b64_tr_b16 v[236:237], v5 offset:24608
    v_mfma_f32_16x16x32_bf16 v[68:71], v[244:247], v[92:95], v[68:71]
    ds_read_b64_tr_b16 v[238:239], v5 offset:25632
    s_mov_b32 s23, 0xd800
    buffer_load_dwordx4 v[124:127], v7, s[8:11], s23 offen offset:0 sc1
    s_waitcnt lgkmcnt(6)
    v_mfma_f32_16x16x32_bf16 v[72:75], v[224:227], v[88:91], v[72:75]
    ds_read_b64_tr_b16 v[240:241], v4 offset:24832
    v_xor_b32 v8, s28, v12
    v_xor_b32 v20, s28, v13
    v_or_b32 v8, v8, v20
    v_xor_b32 v20, s28, v14
    v_or_b32 v8, v8, v20
    v_xor_b32 v20, s28, v15
    v_or_b32 v8, v8, v20
    v_cmp_ne_u32 vcc, 0, v8
    s_cbranch_vccnz adaLN_cond__sliding_block_cached__moe_arch_mod__prompt_kernel_kv16r
adaLN_cond__sliding_block_cached__moe_arch_mod__prompt_kernel_kv16b:
    v_mfma_f32_16x16x32_bf16 v[76:79], v[224:227], v[92:95], v[76:79]
    ds_read_b64_tr_b16 v[242:243], v4 offset:25856
    v_mov_b32 v20, 0
    s_mov_b32 s16, 0x564000
    buffer_load_dword v8, v20, s[8:11], s16 offen sc1
    s_waitcnt lgkmcnt(6)
    v_mfma_f32_16x16x32_bf16 v[80:83], v[228:231], v[88:91], v[80:83]
    ds_read_b64_tr_b16 v[244:245], v5 offset:24864
    v_mfma_f32_16x16x32_bf16 v[84:87], v[228:231], v[92:95], v[84:87]
    ds_read_b64_tr_b16 v[246:247], v5 offset:25888
    s_waitcnt vmcnt(12) lgkmcnt(6)
    v_mfma_f32_16x16x32_bf16 v[24:27], v[232:235], v[96:99], v[24:27]
    ds_read_b64_tr_b16 v[224:225], v4 offset:25088
    s_waitcnt vmcnt(10)
    v_mfma_f32_16x16x32_bf16 v[28:31], v[232:235], v[100:103], v[28:31]
    ds_read_b64_tr_b16 v[226:227], v4 offset:26112
    s_waitcnt lgkmcnt(6)
    v_mfma_f32_16x16x32_bf16 v[32:35], v[236:239], v[96:99], v[32:35]
    ds_read_b64_tr_b16 v[228:229], v5 offset:25120
    v_mfma_f32_16x16x32_bf16 v[36:39], v[236:239], v[100:103], v[36:39]
    ds_read_b64_tr_b16 v[230:231], v5 offset:26144
    s_mov_b32 s23, 0x5800
    buffer_load_dwordx4 v[128:131], v7, s[8:11], s23 offen offset:1024 sc1
    s_waitcnt lgkmcnt(6)
    v_mfma_f32_16x16x32_bf16 v[40:43], v[240:243], v[96:99], v[40:43]
    ds_read_b64_tr_b16 v[232:233], v4 offset:25344
    s_mov_b64 s[76:77], s[54:55]
    s_mov_b32 s78, 0xc00000
    s_mov_b32 s79, 0x20000
    v_bfe_u32 v20, v1, 2, 2
    v_lshlrev_b32 v20, 12, v20
    v_add_u32 v6, v3, v20
    s_lshr_b32 s16, s2, 5
    s_lshl_b32 s16, s16, 7
    s_lshl_b32 s17, s3, 3
    s_add_u32 s16, s16, s17
    s_mul_i32 s14, s16, 12288
    s_and_b32 s16, s2, 31
    s_lshl_b32 s16, s16, 8
    s_add_u32 s14, s14, s16
    s_add_u32 s14, s14, 4096
    v_mfma_f32_16x16x32_bf16 v[44:47], v[240:243], v[100:103], v[44:47]
    ds_read_b64_tr_b16 v[234:235], v4 offset:26368
    s_waitcnt lgkmcnt(6)
    v_mfma_f32_16x16x32_bf16 v[48:51], v[244:247], v[96:99], v[48:51]
    ds_read_b64_tr_b16 v[236:237], v5 offset:25376
    v_mfma_f32_16x16x32_bf16 v[52:55], v[244:247], v[100:103], v[52:55]
    ds_read_b64_tr_b16 v[238:239], v5 offset:26400
    s_waitcnt lgkmcnt(6)
    v_mfma_f32_16x16x32_bf16 v[56:59], v[224:227], v[96:99], v[56:59]
    v_mfma_f32_16x16x32_bf16 v[60:63], v[224:227], v[100:103], v[60:63]
    s_waitcnt vmcnt(10)
    s_barrier
    ds_read_b64_tr_b16 v[240:241], v4 offset:32768
    ds_read_b64_tr_b16 v[242:243], v4 offset:33792
    s_waitcnt lgkmcnt(6)
    v_mfma_f32_16x16x32_bf16 v[64:67], v[228:231], v[96:99], v[64:67]
    ds_read_b64_tr_b16 v[244:245], v5 offset:32800
    v_mfma_f32_16x16x32_bf16 v[68:71], v[228:231], v[100:103], v[68:71]
    s_add_u32 s22, s19, 0x600000
    s_add_u32 m0, s20, 0x0
    s_nop 0
    buffer_load_dwordx4 v3, s[4:7], s22 offen lds
    ds_read_b64_tr_b16 v[246:247], v5 offset:33824
    s_mov_b32 s23, 0xd800
    buffer_load_dwordx4 v[132:135], v7, s[8:11], s23 offen offset:1024 sc1
    s_waitcnt lgkmcnt(6)
    v_mfma_f32_16x16x32_bf16 v[72:75], v[232:235], v[96:99], v[72:75]
    ds_read_b64_tr_b16 v[224:225], v4 offset:33024
    v_mfma_f32_16x16x32_bf16 v[76:79], v[232:235], v[100:103], v[76:79]
    ds_read_b64_tr_b16 v[226:227], v4 offset:34048
    s_waitcnt lgkmcnt(6)
    v_mfma_f32_16x16x32_bf16 v[80:83], v[236:239], v[96:99], v[80:83]
    ds_read_b64_tr_b16 v[228:229], v5 offset:33056
    v_mfma_f32_16x16x32_bf16 v[84:87], v[236:239], v[100:103], v[84:87]
    ds_read_b64_tr_b16 v[230:231], v5 offset:34080
    s_waitcnt vmcnt(11) lgkmcnt(6)
    v_mfma_f32_16x16x32_bf16 v[24:27], v[240:243], v[104:107], v[24:27]
    ds_read_b64_tr_b16 v[232:233], v4 offset:33280
    s_waitcnt vmcnt(10)
    v_mfma_f32_16x16x32_bf16 v[28:31], v[240:243], v[108:111], v[28:31]
    ds_read_b64_tr_b16 v[234:235], v4 offset:34304
    s_waitcnt lgkmcnt(6)
    v_mfma_f32_16x16x32_bf16 v[32:35], v[244:247], v[104:107], v[32:35]
    ds_read_b64_tr_b16 v[236:237], v5 offset:33312
    v_mfma_f32_16x16x32_bf16 v[36:39], v[244:247], v[108:111], v[36:39]
    s_add_u32 s22, s19, 0x608000
    s_add_u32 m0, s20, 0x400
    s_nop 0
    buffer_load_dwordx4 v3, s[4:7], s22 offen lds
    ds_read_b64_tr_b16 v[238:239], v5 offset:34336
    s_mov_b32 s23, 0x6000
    buffer_load_dwordx4 v[88:91], v7, s[8:11], s23 offen offset:0 sc1
    s_waitcnt lgkmcnt(6)
    v_mfma_f32_16x16x32_bf16 v[40:43], v[224:227], v[104:107], v[40:43]
    ds_read_b64_tr_b16 v[240:241], v4 offset:33536
    v_mfma_f32_16x16x32_bf16 v[44:47], v[224:227], v[108:111], v[44:47]
    ds_read_b64_tr_b16 v[242:243], v4 offset:34560
    s_waitcnt lgkmcnt(6)
    v_mfma_f32_16x16x32_bf16 v[48:51], v[228:231], v[104:107], v[48:51]
    ds_read_b64_tr_b16 v[244:245], v5 offset:33568
    v_mfma_f32_16x16x32_bf16 v[52:55], v[228:231], v[108:111], v[52:55]
    ds_read_b64_tr_b16 v[246:247], v5 offset:34592
    s_waitcnt lgkmcnt(6)
    v_mfma_f32_16x16x32_bf16 v[56:59], v[232:235], v[104:107], v[56:59]
    ds_read_b64_tr_b16 v[224:225], v4 offset:40960
    v_mfma_f32_16x16x32_bf16 v[60:63], v[232:235], v[108:111], v[60:63]
    ds_read_b64_tr_b16 v[226:227], v4 offset:41984
    s_waitcnt lgkmcnt(6)
    v_mfma_f32_16x16x32_bf16 v[64:67], v[236:239], v[104:107], v[64:67]
    ds_read_b64_tr_b16 v[228:229], v5 offset:40992
    v_mfma_f32_16x16x32_bf16 v[68:71], v[236:239], v[108:111], v[68:71]
    ds_read_b64_tr_b16 v[230:231], v5 offset:42016
    s_mov_b32 s23, 0xe000
    buffer_load_dwordx4 v[92:95], v7, s[8:11], s23 offen offset:0 sc1
    s_waitcnt lgkmcnt(6)
    v_mfma_f32_16x16x32_bf16 v[72:75], v[240:243], v[104:107], v[72:75]
    ds_read_b64_tr_b16 v[232:233], v4 offset:41216
    v_mfma_f32_16x16x32_bf16 v[76:79], v[240:243], v[108:111], v[76:79]
    ds_read_b64_tr_b16 v[234:235], v4 offset:42240
    s_waitcnt lgkmcnt(6)
    v_mfma_f32_16x16x32_bf16 v[80:83], v[244:247], v[104:107], v[80:83]
    ds_read_b64_tr_b16 v[236:237], v5 offset:41248
    v_mfma_f32_16x16x32_bf16 v[84:87], v[244:247], v[108:111], v[84:87]
    ds_read_b64_tr_b16 v[238:239], v5 offset:42272
    s_waitcnt vmcnt(12) lgkmcnt(6)
    v_mfma_f32_16x16x32_bf16 v[24:27], v[224:227], v[112:115], v[24:27]
    ds_read_b64_tr_b16 v[240:241], v4 offset:41472
    s_add_u32 s22, s14, 0x0
    s_add_u32 m0, s20, 0x10000
    s_nop 0
    buffer_load_dwordx4 v6, s[76:79], s22 offen lds
    s_waitcnt vmcnt(11)
    v_mfma_f32_16x16x32_bf16 v[28:31], v[224:227], v[116:119], v[28:31]
    ds_read_b64_tr_b16 v[242:243], v4 offset:42496
    s_waitcnt lgkmcnt(6)
    v_mfma_f32_16x16x32_bf16 v[32:35], v[228:231], v[112:115], v[32:35]
    ds_read_b64_tr_b16 v[244:245], v5 offset:41504
    v_mfma_f32_16x16x32_bf16 v[36:39], v[228:231], v[116:119], v[36:39]
    ds_read_b64_tr_b16 v[246:247], v5 offset:42528
    s_mov_b32 s23, 0x6000
    buffer_load_dwordx4 v[96:99], v7, s[8:11], s23 offen offset:1024 sc1
    s_waitcnt lgkmcnt(6)
    v_mfma_f32_16x16x32_bf16 v[40:43], v[232:235], v[112:115], v[40:43]
    ds_read_b64_tr_b16 v[224:225], v4 offset:41728
    s_add_u32 s22, s14, 0xc000
    s_add_u32 m0, s20, 0x10400
    s_nop 0
    buffer_load_dwordx4 v6, s[76:79], s22 offen lds
    v_mfma_f32_16x16x32_bf16 v[44:47], v[232:235], v[116:119], v[44:47]
    ds_read_b64_tr_b16 v[226:227], v4 offset:42752
    s_waitcnt lgkmcnt(6)
    v_mfma_f32_16x16x32_bf16 v[48:51], v[236:239], v[112:115], v[48:51]
    ds_read_b64_tr_b16 v[228:229], v5 offset:41760
    v_mfma_f32_16x16x32_bf16 v[52:55], v[236:239], v[116:119], v[52:55]
    ds_read_b64_tr_b16 v[230:231], v5 offset:42784
    s_waitcnt lgkmcnt(6)
    v_mfma_f32_16x16x32_bf16 v[56:59], v[240:243], v[112:115], v[56:59]
    v_mfma_f32_16x16x32_bf16 v[60:63], v[240:243], v[116:119], v[60:63]
    s_waitcnt vmcnt(12)
    s_barrier
    ds_read_b64_tr_b16 v[232:233], v4 offset:49152
    ds_read_b64_tr_b16 v[234:235], v4 offset:50176
    s_waitcnt lgkmcnt(6)
    v_mfma_f32_16x16x32_bf16 v[64:67], v[244:247], v[112:115], v[64:67]
    ds_read_b64_tr_b16 v[236:237], v5 offset:49184
    v_mfma_f32_16x16x32_bf16 v[68:71], v[244:247], v[116:119], v[68:71]
    s_add_u32 s22, s19, 0x680000
    s_add_u32 m0, s20, 0x4000
    s_nop 0
    buffer_load_dwordx4 v3, s[4:7], s22 offen lds
    ds_read_b64_tr_b16 v[238:239], v5 offset:50208
    s_mov_b32 s23, 0xe000
    buffer_load_dwordx4 v[100:103], v7, s[8:11], s23 offen offset:1024 sc1
    s_waitcnt lgkmcnt(6)
    v_mfma_f32_16x16x32_bf16 v[72:75], v[224:227], v[112:115], v[72:75]
    ds_read_b64_tr_b16 v[240:241], v4 offset:49408
    v_mfma_f32_16x16x32_bf16 v[76:79], v[224:227], v[116:119], v[76:79]
    ds_read_b64_tr_b16 v[242:243], v4 offset:50432
    s_waitcnt lgkmcnt(6)
    v_mfma_f32_16x16x32_bf16 v[80:83], v[228:231], v[112:115], v[80:83]
    ds_read_b64_tr_b16 v[244:245], v5 offset:49440
    v_mfma_f32_16x16x32_bf16 v[84:87], v[228:231], v[116:119], v[84:87]
    ds_read_b64_tr_b16 v[246:247], v5 offset:50464
    s_waitcnt vmcnt(13) lgkmcnt(6)
    v_mfma_f32_16x16x32_bf16 v[24:27], v[232:235], v[120:123], v[24:27]
    ds_read_b64_tr_b16 v[224:225], v4 offset:49664
    s_waitcnt vmcnt(12)
    v_mfma_f32_16x16x32_bf16 v[28:31], v[232:235], v[124:127], v[28:31]
    ds_read_b64_tr_b16 v[226:227], v4 offset:50688
    s_waitcnt lgkmcnt(6)
    v_mfma_f32_16x16x32_bf16 v[32:35], v[236:239], v[120:123], v[32:35]
    ds_read_b64_tr_b16 v[228:229], v5 offset:49696
    v_mfma_f32_16x16x32_bf16 v[36:39], v[236:239], v[124:127], v[36:39]
    s_add_u32 s22, s19, 0x688000
    s_add_u32 m0, s20, 0x4400
    s_nop 0
    buffer_load_dwordx4 v3, s[4:7], s22 offen lds
    ds_read_b64_tr_b16 v[230:231], v5 offset:50720
    s_mov_b32 s23, 0x6800
    buffer_load_dwordx4 v[104:107], v7, s[8:11], s23 offen offset:0 sc1
    s_waitcnt lgkmcnt(6)
    v_mfma_f32_16x16x32_bf16 v[40:43], v[240:243], v[120:123], v[40:43]
    ds_read_b64_tr_b16 v[232:233], v4 offset:49920
    v_mfma_f32_16x16x32_bf16 v[44:47], v[240:243], v[124:127], v[44:47]
    ds_read_b64_tr_b16 v[234:235], v4 offset:50944
    s_waitcnt lgkmcnt(6)
    v_mfma_f32_16x16x32_bf16 v[48:51], v[244:247], v[120:123], v[48:51]
    ds_read_b64_tr_b16 v[236:237], v5 offset:49952
    v_mfma_f32_16x16x32_bf16 v[52:55], v[244:247], v[124:127], v[52:55]
    ds_read_b64_tr_b16 v[238:239], v5 offset:50976
    s_waitcnt lgkmcnt(6)
    v_mfma_f32_16x16x32_bf16 v[56:59], v[224:227], v[120:123], v[56:59]
    ds_read_b64_tr_b16 v[240:241], v4 offset:57344
    v_mfma_f32_16x16x32_bf16 v[60:63], v[224:227], v[124:127], v[60:63]
    ds_read_b64_tr_b16 v[242:243], v4 offset:58368
    s_waitcnt lgkmcnt(6)
    v_mfma_f32_16x16x32_bf16 v[64:67], v[228:231], v[120:123], v[64:67]
    ds_read_b64_tr_b16 v[244:245], v5 offset:57376
    v_mfma_f32_16x16x32_bf16 v[68:71], v[228:231], v[124:127], v[68:71]
    ds_read_b64_tr_b16 v[246:247], v5 offset:58400
    s_mov_b32 s23, 0xe800
    buffer_load_dwordx4 v[108:111], v7, s[8:11], s23 offen offset:0 sc1
    s_waitcnt lgkmcnt(6)
    v_mfma_f32_16x16x32_bf16 v[72:75], v[232:235], v[120:123], v[72:75]
    ds_read_b64_tr_b16 v[224:225], v4 offset:57600
    v_mfma_f32_16x16x32_bf16 v[76:79], v[232:235], v[124:127], v[76:79]
    ds_read_b64_tr_b16 v[226:227], v4 offset:58624
    s_waitcnt lgkmcnt(6)
    v_mfma_f32_16x16x32_bf16 v[80:83], v[236:239], v[120:123], v[80:83]
    ds_read_b64_tr_b16 v[228:229], v5 offset:57632
    v_mfma_f32_16x16x32_bf16 v[84:87], v[236:239], v[124:127], v[84:87]
    ds_read_b64_tr_b16 v[230:231], v5 offset:58656
    s_waitcnt vmcnt(13) lgkmcnt(6)
    v_mfma_f32_16x16x32_bf16 v[24:27], v[240:243], v[128:131], v[24:27]
    ds_read_b64_tr_b16 v[232:233], v4 offset:57856
    s_add_u32 s22, s14, 0xc0000
    s_add_u32 m0, s20, 0x14000
    s_nop 0
    buffer_load_dwordx4 v6, s[76:79], s22 offen lds
    s_waitcnt vmcnt(12)
    v_mfma_f32_16x16x32_bf16 v[28:31], v[240:243], v[132:135], v[28:31]
    ds_read_b64_tr_b16 v[234:235], v4 offset:58880
    s_waitcnt lgkmcnt(6)
    v_mfma_f32_16x16x32_bf16 v[32:35], v[244:247], v[128:131], v[32:35]
    ds_read_b64_tr_b16 v[236:237], v5 offset:57888
    v_mfma_f32_16x16x32_bf16 v[36:39], v[244:247], v[132:135], v[36:39]
    ds_read_b64_tr_b16 v[238:239], v5 offset:58912
    s_mov_b32 s23, 0x6800
    buffer_load_dwordx4 v[112:115], v7, s[8:11], s23 offen offset:1024 sc1
    s_waitcnt lgkmcnt(6)
    v_mfma_f32_16x16x32_bf16 v[40:43], v[224:227], v[128:131], v[40:43]
    ds_read_b64_tr_b16 v[240:241], v4 offset:58112
    s_add_u32 s22, s14, 0xcc000
    s_add_u32 m0, s20, 0x14400
    s_nop 0
    buffer_load_dwordx4 v6, s[76:79], s22 offen lds
    v_mfma_f32_16x16x32_bf16 v[44:47], v[224:227], v[132:135], v[44:47]
    ds_read_b64_tr_b16 v[242:243], v4 offset:59136
    s_waitcnt lgkmcnt(6)
    v_mfma_f32_16x16x32_bf16 v[48:51], v[228:231], v[128:131], v[48:51]
    ds_read_b64_tr_b16 v[244:245], v5 offset:58144
    v_mfma_f32_16x16x32_bf16 v[52:55], v[228:231], v[132:135], v[52:55]
    ds_read_b64_tr_b16 v[246:247], v5 offset:59168
    s_waitcnt lgkmcnt(6)
    v_mfma_f32_16x16x32_bf16 v[56:59], v[232:235], v[128:131], v[56:59]
    v_mfma_f32_16x16x32_bf16 v[60:63], v[232:235], v[132:135], v[60:63]
    s_waitcnt vmcnt(13)
    s_barrier
    ds_read_b64_tr_b16 v[224:225], v4 offset:0
    ds_read_b64_tr_b16 v[226:227], v4 offset:1024
    s_waitcnt lgkmcnt(6)
    v_mfma_f32_16x16x32_bf16 v[64:67], v[236:239], v[128:131], v[64:67]
    ds_read_b64_tr_b16 v[228:229], v5 offset:32
    v_mfma_f32_16x16x32_bf16 v[68:71], v[236:239], v[132:135], v[68:71]
    s_add_u32 s22, s19, 0x700000
    s_add_u32 m0, s20, 0x8000
    s_nop 0
    buffer_load_dwordx4 v3, s[4:7], s22 offen lds
    ds_read_b64_tr_b16 v[230:231], v5 offset:1056
    s_mov_b32 s23, 0xe800
    buffer_load_dwordx4 v[116:119], v7, s[8:11], s23 offen offset:1024 sc1
    s_waitcnt lgkmcnt(6)
    v_mfma_f32_16x16x32_bf16 v[72:75], v[240:243], v[128:131], v[72:75]
    ds_read_b64_tr_b16 v[232:233], v4 offset:256
    v_mfma_f32_16x16x32_bf16 v[76:79], v[240:243], v[132:135], v[76:79]
    ds_read_b64_tr_b16 v[234:235], v4 offset:1280
    s_waitcnt lgkmcnt(6)
    v_mfma_f32_16x16x32_bf16 v[80:83], v[244:247], v[128:131], v[80:83]
    ds_read_b64_tr_b16 v[236:237], v5 offset:288
    v_mfma_f32_16x16x32_bf16 v[84:87], v[244:247], v[132:135], v[84:87]
    ds_read_b64_tr_b16 v[238:239], v5 offset:1312
    s_waitcnt vmcnt(14) lgkmcnt(6)
    v_mfma_f32_16x16x32_bf16 v[24:27], v[224:227], v[88:91], v[24:27]
    ds_read_b64_tr_b16 v[240:241], v4 offset:512
    s_waitcnt vmcnt(13)
    v_mfma_f32_16x16x32_bf16 v[28:31], v[224:227], v[92:95], v[28:31]
    ds_read_b64_tr_b16 v[242:243], v4 offset:1536
    s_waitcnt lgkmcnt(6)
    v_mfma_f32_16x16x32_bf16 v[32:35], v[228:231], v[88:91], v[32:35]
    ds_read_b64_tr_b16 v[244:245], v5 offset:544
    v_mfma_f32_16x16x32_bf16 v[36:39], v[228:231], v[92:95], v[36:39]
    s_add_u32 s22, s19, 0x708000
    s_add_u32 m0, s20, 0x8400
    s_nop 0
    buffer_load_dwordx4 v3, s[4:7], s22 offen lds
    ds_read_b64_tr_b16 v[246:247], v5 offset:1568
    s_mov_b32 s23, 0x7000
    buffer_load_dwordx4 v[120:123], v7, s[8:11], s23 offen offset:0 sc1
    s_waitcnt lgkmcnt(6)
    v_mfma_f32_16x16x32_bf16 v[40:43], v[232:235], v[88:91], v[40:43]
    ds_read_b64_tr_b16 v[224:225], v4 offset:768
    v_mfma_f32_16x16x32_bf16 v[44:47], v[232:235], v[92:95], v[44:47]
    ds_read_b64_tr_b16 v[226:227], v4 offset:1792
    s_waitcnt lgkmcnt(6)
    v_mfma_f32_16x16x32_bf16 v[48:51], v[236:239], v[88:91], v[48:51]
    ds_read_b64_tr_b16 v[228:229], v5 offset:800
    v_mfma_f32_16x16x32_bf16 v[52:55], v[236:239], v[92:95], v[52:55]
    ds_read_b64_tr_b16 v[230:231], v5 offset:1824
    s_waitcnt lgkmcnt(6)
    v_mfma_f32_16x16x32_bf16 v[56:59], v[240:243], v[88:91], v[56:59]
    ds_read_b64_tr_b16 v[232:233], v4 offset:8192
    v_mfma_f32_16x16x32_bf16 v[60:63], v[240:243], v[92:95], v[60:63]
    ds_read_b64_tr_b16 v[234:235], v4 offset:9216
    s_waitcnt lgkmcnt(6)
    v_mfma_f32_16x16x32_bf16 v[64:67], v[244:247], v[88:91], v[64:67]
    ds_read_b64_tr_b16 v[236:237], v5 offset:8224
    v_mfma_f32_16x16x32_bf16 v[68:71], v[244:247], v[92:95], v[68:71]
    ds_read_b64_tr_b16 v[238:239], v5 offset:9248
    s_mov_b32 s23, 0xf000
    buffer_load_dwordx4 v[124:127], v7, s[8:11], s23 offen offset:0 sc1
    s_waitcnt lgkmcnt(6)
    v_mfma_f32_16x16x32_bf16 v[72:75], v[224:227], v[88:91], v[72:75]
    ds_read_b64_tr_b16 v[240:241], v4 offset:8448
    v_mfma_f32_16x16x32_bf16 v[76:79], v[224:227], v[92:95], v[76:79]
    ds_read_b64_tr_b16 v[242:243], v4 offset:9472
    s_waitcnt lgkmcnt(6)
    v_mfma_f32_16x16x32_bf16 v[80:83], v[228:231], v[88:91], v[80:83]
    ds_read_b64_tr_b16 v[244:245], v5 offset:8480
    v_mfma_f32_16x16x32_bf16 v[84:87], v[228:231], v[92:95], v[84:87]
    ds_read_b64_tr_b16 v[246:247], v5 offset:9504
    s_waitcnt vmcnt(14) lgkmcnt(6)
    v_mfma_f32_16x16x32_bf16 v[24:27], v[232:235], v[96:99], v[24:27]
    ds_read_b64_tr_b16 v[224:225], v4 offset:8704
    s_add_u32 s22, s21, 0x0
    s_add_u32 m0, s20, 0x18000
    s_nop 0
    buffer_load_dwordx4 v2, s[8:11], s22 offen sc1 lds
    s_waitcnt vmcnt(12)
    v_mfma_f32_16x16x32_bf16 v[28:31], v[232:235], v[100:103], v[28:31]
    ds_read_b64_tr_b16 v[226:227], v4 offset:9728
    s_waitcnt lgkmcnt(6)
    v_mfma_f32_16x16x32_bf16 v[32:35], v[236:239], v[96:99], v[32:35]
    ds_read_b64_tr_b16 v[228:229], v5 offset:8736
    v_mfma_f32_16x16x32_bf16 v[36:39], v[236:239], v[100:103], v[36:39]
    ds_read_b64_tr_b16 v[230:231], v5 offset:9760
    s_mov_b32 s23, 0x7000
    buffer_load_dwordx4 v[128:131], v7, s[8:11], s23 offen offset:1024 sc1
    s_waitcnt lgkmcnt(6)
    v_mfma_f32_16x16x32_bf16 v[40:43], v[240:243], v[96:99], v[40:43]
    ds_read_b64_tr_b16 v[232:233], v4 offset:8960
    s_add_u32 s22, s21, 0x400
    s_add_u32 m0, s20, 0x18400
    s_nop 0
    buffer_load_dwordx4 v2, s[8:11], s22 offen sc1 lds
    v_mfma_f32_16x16x32_bf16 v[44:47], v[240:243], v[100:103], v[44:47]
    ds_read_b64_tr_b16 v[234:235], v4 offset:9984
    s_waitcnt lgkmcnt(6)
    v_mfma_f32_16x16x32_bf16 v[48:51], v[244:247], v[96:99], v[48:51]
    ds_read_b64_tr_b16 v[236:237], v5 offset:8992
    v_mfma_f32_16x16x32_bf16 v[52:55], v[244:247], v[100:103], v[52:55]
    ds_read_b64_tr_b16 v[238:239], v5 offset:10016
    s_waitcnt lgkmcnt(6)
    v_mfma_f32_16x16x32_bf16 v[56:59], v[224:227], v[96:99], v[56:59]
    v_mfma_f32_16x16x32_bf16 v[60:63], v[224:227], v[100:103], v[60:63]
    s_waitcnt vmcnt(13)
    s_barrier
    ds_read_b64_tr_b16 v[240:241], v4 offset:16384
    ds_read_b64_tr_b16 v[242:243], v4 offset:17408
    s_waitcnt lgkmcnt(6)
    v_mfma_f32_16x16x32_bf16 v[64:67], v[228:231], v[96:99], v[64:67]
    ds_read_b64_tr_b16 v[244:245], v5 offset:16416
    v_mfma_f32_16x16x32_bf16 v[68:71], v[228:231], v[100:103], v[68:71]
    s_add_u32 s22, s19, 0x780000
    s_add_u32 m0, s20, 0xc000
    s_nop 0
    buffer_load_dwordx4 v3, s[4:7], s22 offen lds
    ds_read_b64_tr_b16 v[246:247], v5 offset:17440
    s_mov_b32 s23, 0xf000
    buffer_load_dwordx4 v[132:135], v7, s[8:11], s23 offen offset:1024 sc1
    s_waitcnt lgkmcnt(6)
    v_mfma_f32_16x16x32_bf16 v[72:75], v[232:235], v[96:99], v[72:75]
    ds_read_b64_tr_b16 v[224:225], v4 offset:16640
    v_mfma_f32_16x16x32_bf16 v[76:79], v[232:235], v[100:103], v[76:79]
    ds_read_b64_tr_b16 v[226:227], v4 offset:17664
    s_waitcnt lgkmcnt(6)
    v_mfma_f32_16x16x32_bf16 v[80:83], v[236:239], v[96:99], v[80:83]
    ds_read_b64_tr_b16 v[228:229], v5 offset:16672
    v_mfma_f32_16x16x32_bf16 v[84:87], v[236:239], v[100:103], v[84:87]
    ds_read_b64_tr_b16 v[230:231], v5 offset:17696
    s_waitcnt vmcnt(14) lgkmcnt(6)
    v_mfma_f32_16x16x32_bf16 v[24:27], v[240:243], v[104:107], v[24:27]
    ds_read_b64_tr_b16 v[232:233], v4 offset:16896
    s_waitcnt vmcnt(13)
    v_mfma_f32_16x16x32_bf16 v[28:31], v[240:243], v[108:111], v[28:31]
    ds_read_b64_tr_b16 v[234:235], v4 offset:17920
    s_waitcnt lgkmcnt(6)
    v_mfma_f32_16x16x32_bf16 v[32:35], v[244:247], v[104:107], v[32:35]
    ds_read_b64_tr_b16 v[236:237], v5 offset:16928
    v_mfma_f32_16x16x32_bf16 v[36:39], v[244:247], v[108:111], v[36:39]
    s_add_u32 s22, s19, 0x788000
    s_add_u32 m0, s20, 0xc400
    s_nop 0
    buffer_load_dwordx4 v3, s[4:7], s22 offen lds
    ds_read_b64_tr_b16 v[238:239], v5 offset:17952
    s_mov_b32 s23, 0x7800
    buffer_load_dwordx4 v[88:91], v7, s[8:11], s23 offen offset:0 sc1
    s_waitcnt lgkmcnt(6)
    v_mfma_f32_16x16x32_bf16 v[40:43], v[224:227], v[104:107], v[40:43]
    ds_read_b64_tr_b16 v[240:241], v4 offset:17152
    v_lshrrev_b32 v20, 4, v1
    v_lshlrev_b32 v21, 4, v20
    s_lshl_b32 s16, s2, 8
    s_add_u32 s16, s16, 0x550000
    buffer_load_dwordx4 v[136:139], v21, s[8:11], s16 offen offset:0 sc1
    buffer_load_dwordx4 v[140:143], v21, s[8:11], s16 offen offset:64 sc1
    buffer_load_dwordx4 v[144:147], v21, s[8:11], s16 offen offset:128 sc1
    buffer_load_dwordx4 v[148:151], v21, s[8:11], s16 offen offset:192 sc1
    v_lshlrev_b32 v11, 11, v20
    v_xor_b32 v20, s3, v20
    v_and_b32 v20, 1, v20
    v_lshl_add_u32 v11, v20, 5, v11
    v_bfe_u32 v20, v1, 2, 2
    v_lshl_add_u32 v11, v20, 6, v11
    v_and_b32 v20, 3, v1
    v_lshl_add_u32 v11, v20, 3, v11
    s_lshr_b32 s16, s3, 1
    s_lshl_b32 s16, s16, 8
    s_add_u32 s16, s16, 65536
    v_add_u32 v11, s16, v11
    v_mfma_f32_16x16x32_bf16 v[44:47], v[224:227], v[108:111], v[44:47]
    ds_read_b64_tr_b16 v[242:243], v4 offset:18176
    s_waitcnt lgkmcnt(6)
    v_mfma_f32_16x16x32_bf16 v[48:51], v[228:231], v[104:107], v[48:51]
    ds_read_b64_tr_b16 v[244:245], v5 offset:17184
    v_mfma_f32_16x16x32_bf16 v[52:55], v[228:231], v[108:111], v[52:55]
    ds_read_b64_tr_b16 v[246:247], v5 offset:18208
    s_waitcnt lgkmcnt(6)
    v_mfma_f32_16x16x32_bf16 v[56:59], v[232:235], v[104:107], v[56:59]
    ds_read_b64_tr_b16 v[224:225], v4 offset:24576
    v_mfma_f32_16x16x32_bf16 v[60:63], v[232:235], v[108:111], v[60:63]
    ds_read_b64_tr_b16 v[226:227], v4 offset:25600
    s_waitcnt lgkmcnt(6)
    v_mfma_f32_16x16x32_bf16 v[64:67], v[236:239], v[104:107], v[64:67]
    ds_read_b64_tr_b16 v[228:229], v5 offset:24608
    v_mfma_f32_16x16x32_bf16 v[68:71], v[236:239], v[108:111], v[68:71]
    ds_read_b64_tr_b16 v[230:231], v5 offset:25632
    s_mov_b32 s23, 0xf800
    buffer_load_dwordx4 v[92:95], v7, s[8:11], s23 offen offset:0 sc1
    s_waitcnt lgkmcnt(6)
    v_mfma_f32_16x16x32_bf16 v[72:75], v[240:243], v[104:107], v[72:75]
    ds_read_b64_tr_b16 v[232:233], v4 offset:24832
    v_mfma_f32_16x16x32_bf16 v[76:79], v[240:243], v[108:111], v[76:79]
    ds_read_b64_tr_b16 v[234:235], v4 offset:25856
    s_waitcnt lgkmcnt(6)
    v_mfma_f32_16x16x32_bf16 v[80:83], v[244:247], v[104:107], v[80:83]
    ds_read_b64_tr_b16 v[236:237], v5 offset:24864
    v_mfma_f32_16x16x32_bf16 v[84:87], v[244:247], v[108:111], v[84:87]
    ds_read_b64_tr_b16 v[238:239], v5 offset:25888
    s_waitcnt vmcnt(18) lgkmcnt(6)
    v_mfma_f32_16x16x32_bf16 v[24:27], v[224:227], v[112:115], v[24:27]
    ds_read_b64_tr_b16 v[240:241], v4 offset:25088
    s_add_u32 s22, s21, 0x4000
    s_add_u32 m0, s20, 0x1c000
    s_nop 0
    buffer_load_dwordx4 v2, s[8:11], s22 offen sc1 lds
    s_waitcnt vmcnt(16)
    v_mfma_f32_16x16x32_bf16 v[28:31], v[224:227], v[116:119], v[28:31]
    ds_read_b64_tr_b16 v[242:243], v4 offset:26112
    s_waitcnt lgkmcnt(6)
    v_mfma_f32_16x16x32_bf16 v[32:35], v[228:231], v[112:115], v[32:35]
    ds_read_b64_tr_b16 v[244:245], v5 offset:25120
    v_mfma_f32_16x16x32_bf16 v[36:39], v[228:231], v[116:119], v[36:39]
    ds_read_b64_tr_b16 v[246:247], v5 offset:26144
    s_mov_b32 s23, 0x7800
    buffer_load_dwordx4 v[96:99], v7, s[8:11], s23 offen offset:1024 sc1
    s_waitcnt lgkmcnt(6)
    v_mfma_f32_16x16x32_bf16 v[40:43], v[232:235], v[112:115], v[40:43]
    ds_read_b64_tr_b16 v[224:225], v4 offset:25344
    s_add_u32 s22, s21, 0x4400
    s_add_u32 m0, s20, 0x1c400
    s_nop 0
    buffer_load_dwordx4 v2, s[8:11], s22 offen sc1 lds
    v_mfma_f32_16x16x32_bf16 v[44:47], v[232:235], v[116:119], v[44:47]
    ds_read_b64_tr_b16 v[226:227], v4 offset:26368
    s_waitcnt lgkmcnt(6)
    v_mfma_f32_16x16x32_bf16 v[48:51], v[236:239], v[112:115], v[48:51]
    ds_read_b64_tr_b16 v[228:229], v5 offset:25376
    v_mfma_f32_16x16x32_bf16 v[52:55], v[236:239], v[116:119], v[52:55]
    ds_read_b64_tr_b16 v[230:231], v5 offset:26400
    s_waitcnt lgkmcnt(6)
    v_mfma_f32_16x16x32_bf16 v[56:59], v[240:243], v[112:115], v[56:59]
    v_mfma_f32_16x16x32_bf16 v[60:63], v[240:243], v[116:119], v[60:63]
    s_waitcnt vmcnt(17)
    s_barrier
    ds_read_b64_tr_b16 v[232:233], v4 offset:32768
    ds_read_b64_tr_b16 v[234:235], v4 offset:33792
    s_waitcnt lgkmcnt(6)
    v_mfma_f32_16x16x32_bf16 v[64:67], v[244:247], v[112:115], v[64:67]
    ds_read_b64_tr_b16 v[236:237], v5 offset:32800
    v_mfma_f32_16x16x32_bf16 v[68:71], v[244:247], v[116:119], v[68:71]
    ds_read_b64_tr_b16 v[238:239], v5 offset:33824
    s_mov_b32 s23, 0xf800
    buffer_load_dwordx4 v[100:103], v7, s[8:11], s23 offen offset:1024 sc1
    s_waitcnt lgkmcnt(6)
    v_mfma_f32_16x16x32_bf16 v[72:75], v[224:227], v[112:115], v[72:75]
    ds_read_b64_tr_b16 v[240:241], v4 offset:33024
    v_mfma_f32_16x16x32_bf16 v[76:79], v[224:227], v[116:119], v[76:79]
    ds_read_b64_tr_b16 v[242:243], v4 offset:34048
    s_waitcnt lgkmcnt(6)
    v_mfma_f32_16x16x32_bf16 v[80:83], v[228:231], v[112:115], v[80:83]
    ds_read_b64_tr_b16 v[244:245], v5 offset:33056
    v_mfma_f32_16x16x32_bf16 v[84:87], v[228:231], v[116:119], v[84:87]
    ds_read_b64_tr_b16 v[246:247], v5 offset:34080
    s_waitcnt vmcnt(17) lgkmcnt(6)
    v_mfma_f32_16x16x32_bf16 v[24:27], v[232:235], v[120:123], v[24:27]
    ds_read_b64_tr_b16 v[224:225], v4 offset:33280
    s_waitcnt vmcnt(16)
    v_mfma_f32_16x16x32_bf16 v[28:31], v[232:235], v[124:127], v[28:31]
    ds_read_b64_tr_b16 v[226:227], v4 offset:34304
    s_waitcnt lgkmcnt(6)
    v_mfma_f32_16x16x32_bf16 v[32:35], v[236:239], v[120:123], v[32:35]
    ds_read_b64_tr_b16 v[228:229], v5 offset:33312
    v_mfma_f32_16x16x32_bf16 v[36:39], v[236:239], v[124:127], v[36:39]
    ds_read_b64_tr_b16 v[230:231], v5 offset:34336
    s_waitcnt lgkmcnt(6)
    v_mfma_f32_16x16x32_bf16 v[40:43], v[240:243], v[120:123], v[40:43]
    ds_read_b64_tr_b16 v[232:233], v4 offset:33536
    v_mfma_f32_16x16x32_bf16 v[44:47], v[240:243], v[124:127], v[44:47]
    ds_read_b64_tr_b16 v[234:235], v4 offset:34560
    s_waitcnt lgkmcnt(6)
    v_mfma_f32_16x16x32_bf16 v[48:51], v[244:247], v[120:123], v[48:51]
    ds_read_b64_tr_b16 v[236:237], v5 offset:33568
    v_mfma_f32_16x16x32_bf16 v[52:55], v[244:247], v[124:127], v[52:55]
    ds_read_b64_tr_b16 v[238:239], v5 offset:34592
    s_waitcnt lgkmcnt(6)
    v_mfma_f32_16x16x32_bf16 v[56:59], v[224:227], v[120:123], v[56:59]
    ds_read_b64_tr_b16 v[240:241], v4 offset:40960
    v_mfma_f32_16x16x32_bf16 v[60:63], v[224:227], v[124:127], v[60:63]
    ds_read_b64_tr_b16 v[242:243], v4 offset:41984
    s_waitcnt lgkmcnt(6)
    v_mfma_f32_16x16x32_bf16 v[64:67], v[228:231], v[120:123], v[64:67]
    ds_read_b64_tr_b16 v[244:245], v5 offset:40992
    v_mfma_f32_16x16x32_bf16 v[68:71], v[228:231], v[124:127], v[68:71]
    ds_read_b64_tr_b16 v[246:247], v5 offset:42016
    s_waitcnt lgkmcnt(6)
    v_mfma_f32_16x16x32_bf16 v[72:75], v[232:235], v[120:123], v[72:75]
    ds_read_b64_tr_b16 v[224:225], v4 offset:41216
    v_mfma_f32_16x16x32_bf16 v[76:79], v[232:235], v[124:127], v[76:79]
    ds_read_b64_tr_b16 v[226:227], v4 offset:42240
    s_waitcnt lgkmcnt(6)
    v_mfma_f32_16x16x32_bf16 v[80:83], v[236:239], v[120:123], v[80:83]
    ds_read_b64_tr_b16 v[228:229], v5 offset:41248
    v_mfma_f32_16x16x32_bf16 v[84:87], v[236:239], v[124:127], v[84:87]
    ds_read_b64_tr_b16 v[230:231], v5 offset:42272
    s_waitcnt vmcnt(14) lgkmcnt(6)
    v_mfma_f32_16x16x32_bf16 v[24:27], v[240:243], v[128:131], v[24:27]
    ds_read_b64_tr_b16 v[232:233], v4 offset:41472
    s_waitcnt vmcnt(11)
    v_mfma_f32_16x16x32_bf16 v[28:31], v[240:243], v[132:135], v[28:31]
    ds_read_b64_tr_b16 v[234:235], v4 offset:42496
    s_waitcnt lgkmcnt(6)
    v_mfma_f32_16x16x32_bf16 v[32:35], v[244:247], v[128:131], v[32:35]
    ds_read_b64_tr_b16 v[236:237], v5 offset:41504
    v_mfma_f32_16x16x32_bf16 v[36:39], v[244:247], v[132:135], v[36:39]
    ds_read_b64_tr_b16 v[238:239], v5 offset:42528
    s_waitcnt lgkmcnt(6)
    v_mfma_f32_16x16x32_bf16 v[40:43], v[224:227], v[128:131], v[40:43]
    ds_read_b64_tr_b16 v[240:241], v4 offset:41728
    v_mfma_f32_16x16x32_bf16 v[44:47], v[224:227], v[132:135], v[44:47]
    ds_read_b64_tr_b16 v[242:243], v4 offset:42752
    s_waitcnt lgkmcnt(6)
    v_mfma_f32_16x16x32_bf16 v[48:51], v[228:231], v[128:131], v[48:51]
    ds_read_b64_tr_b16 v[244:245], v5 offset:41760
    v_mfma_f32_16x16x32_bf16 v[52:55], v[228:231], v[132:135], v[52:55]
    ds_read_b64_tr_b16 v[246:247], v5 offset:42784
    s_waitcnt lgkmcnt(6)
    v_mfma_f32_16x16x32_bf16 v[56:59], v[232:235], v[128:131], v[56:59]
    v_mfma_f32_16x16x32_bf16 v[60:63], v[232:235], v[132:135], v[60:63]
    s_waitcnt vmcnt(10)
    s_barrier
    ds_read_b64_tr_b16 v[224:225], v4 offset:49152
    ds_read_b64_tr_b16 v[226:227], v4 offset:50176
    s_waitcnt lgkmcnt(6)
    v_mfma_f32_16x16x32_bf16 v[64:67], v[236:239], v[128:131], v[64:67]
    ds_read_b64_tr_b16 v[228:229], v5 offset:49184
    v_mfma_f32_16x16x32_bf16 v[68:71], v[236:239], v[132:135], v[68:71]
    ds_read_b64_tr_b16 v[230:231], v5 offset:50208
    s_waitcnt lgkmcnt(6)
    v_mfma_f32_16x16x32_bf16 v[72:75], v[240:243], v[128:131], v[72:75]
    ds_read_b64_tr_b16 v[232:233], v4 offset:49408
    v_mfma_f32_16x16x32_bf16 v[76:79], v[240:243], v[132:135], v[76:79]
    ds_read_b64_tr_b16 v[234:235], v4 offset:50432
    s_waitcnt lgkmcnt(6)
    v_mfma_f32_16x16x32_bf16 v[80:83], v[244:247], v[128:131], v[80:83]
    ds_read_b64_tr_b16 v[236:237], v5 offset:49440
    v_mfma_f32_16x16x32_bf16 v[84:87], v[244:247], v[132:135], v[84:87]
    ds_read_b64_tr_b16 v[238:239], v5 offset:50464
    s_waitcnt vmcnt(9) lgkmcnt(6)
    v_mfma_f32_16x16x32_bf16 v[24:27], v[224:227], v[88:91], v[24:27]
    ds_read_b64_tr_b16 v[240:241], v4 offset:49664
    s_waitcnt vmcnt(4)
    v_mfma_f32_16x16x32_bf16 v[28:31], v[224:227], v[92:95], v[28:31]
    ds_read_b64_tr_b16 v[242:243], v4 offset:50688
    s_waitcnt lgkmcnt(6)
    v_mfma_f32_16x16x32_bf16 v[32:35], v[228:231], v[88:91], v[32:35]
    ds_read_b64_tr_b16 v[244:245], v5 offset:49696
    v_mfma_f32_16x16x32_bf16 v[36:39], v[228:231], v[92:95], v[36:39]
    ds_read_b64_tr_b16 v[246:247], v5 offset:50720
    s_waitcnt lgkmcnt(6)
    v_mfma_f32_16x16x32_bf16 v[40:43], v[232:235], v[88:91], v[40:43]
    ds_read_b64_tr_b16 v[224:225], v4 offset:49920
    v_mfma_f32_16x16x32_bf16 v[44:47], v[232:235], v[92:95], v[44:47]
    ds_read_b64_tr_b16 v[226:227], v4 offset:50944
    s_waitcnt lgkmcnt(6)
    v_mfma_f32_16x16x32_bf16 v[48:51], v[236:239], v[88:91], v[48:51]
    ds_read_b64_tr_b16 v[228:229], v5 offset:49952
    v_mfma_f32_16x16x32_bf16 v[52:55], v[236:239], v[92:95], v[52:55]
    ds_read_b64_tr_b16 v[230:231], v5 offset:50976
    s_waitcnt lgkmcnt(6)
    v_mfma_f32_16x16x32_bf16 v[56:59], v[240:243], v[88:91], v[56:59]
    ds_read_b64_tr_b16 v[232:233], v4 offset:57344
    v_mfma_f32_16x16x32_bf16 v[60:63], v[240:243], v[92:95], v[60:63]
    ds_read_b64_tr_b16 v[234:235], v4 offset:58368
    s_waitcnt lgkmcnt(6)
    v_mfma_f32_16x16x32_bf16 v[64:67], v[244:247], v[88:91], v[64:67]
    ds_read_b64_tr_b16 v[236:237], v5 offset:57376
    v_mfma_f32_16x16x32_bf16 v[68:71], v[244:247], v[92:95], v[68:71]
    ds_read_b64_tr_b16 v[238:239], v5 offset:58400
    s_waitcnt lgkmcnt(6)
    v_mfma_f32_16x16x32_bf16 v[72:75], v[224:227], v[88:91], v[72:75]
    ds_read_b64_tr_b16 v[240:241], v4 offset:57600
    v_mfma_f32_16x16x32_bf16 v[76:79], v[224:227], v[92:95], v[76:79]
    ds_read_b64_tr_b16 v[242:243], v4 offset:58624
    s_waitcnt lgkmcnt(6)
    v_mfma_f32_16x16x32_bf16 v[80:83], v[228:231], v[88:91], v[80:83]
    ds_read_b64_tr_b16 v[244:245], v5 offset:57632
    v_mfma_f32_16x16x32_bf16 v[84:87], v[228:231], v[92:95], v[84:87]
    ds_read_b64_tr_b16 v[246:247], v5 offset:58656
    s_waitcnt vmcnt(2) lgkmcnt(6)
    v_mfma_f32_16x16x32_bf16 v[24:27], v[232:235], v[96:99], v[24:27]
    ds_read_b64_tr_b16 v[224:225], v4 offset:57856
    s_waitcnt vmcnt(0)
    v_mfma_f32_16x16x32_bf16 v[28:31], v[232:235], v[100:103], v[28:31]
    ds_read_b64_tr_b16 v[226:227], v4 offset:58880
    s_waitcnt lgkmcnt(6)
    v_mfma_f32_16x16x32_bf16 v[32:35], v[236:239], v[96:99], v[32:35]
    ds_read_b64_tr_b16 v[228:229], v5 offset:57888
    v_mfma_f32_16x16x32_bf16 v[36:39], v[236:239], v[100:103], v[36:39]
    ds_read_b64_tr_b16 v[230:231], v5 offset:58912
    s_waitcnt lgkmcnt(6)
    v_mfma_f32_16x16x32_bf16 v[40:43], v[240:243], v[96:99], v[40:43]
    ds_read_b64_tr_b16 v[232:233], v4 offset:58112
    v_mfma_f32_16x16x32_bf16 v[44:47], v[240:243], v[100:103], v[44:47]
    ds_read_b64_tr_b16 v[234:235], v4 offset:59136
    s_waitcnt lgkmcnt(6)
    v_mfma_f32_16x16x32_bf16 v[48:51], v[244:247], v[96:99], v[48:51]
    ds_read_b64_tr_b16 v[236:237], v5 offset:58144
    v_mfma_f32_16x16x32_bf16 v[52:55], v[244:247], v[100:103], v[52:55]
    ds_read_b64_tr_b16 v[238:239], v5 offset:59168
    s_waitcnt lgkmcnt(6)
    v_mfma_f32_16x16x32_bf16 v[56:59], v[224:227], v[96:99], v[56:59]
    v_mfma_f32_16x16x32_bf16 v[60:63], v[224:227], v[100:103], v[60:63]
    s_waitcnt lgkmcnt(4)
    v_mfma_f32_16x16x32_bf16 v[64:67], v[228:231], v[96:99], v[64:67]
    v_mfma_f32_16x16x32_bf16 v[68:71], v[228:231], v[100:103], v[68:71]
    s_waitcnt lgkmcnt(2)
    v_mfma_f32_16x16x32_bf16 v[72:75], v[232:235], v[96:99], v[72:75]
    v_mfma_f32_16x16x32_bf16 v[76:79], v[232:235], v[100:103], v[76:79]
    s_waitcnt lgkmcnt(0)
    v_mfma_f32_16x16x32_bf16 v[80:83], v[236:239], v[96:99], v[80:83]
    v_mfma_f32_16x16x32_bf16 v[84:87], v[236:239], v[100:103], v[84:87]
    s_barrier
    s_add_u32 s22, s21, 0x8000
    s_add_u32 m0, s20, 0x20000
    s_nop 0
    buffer_load_dwordx4 v2, s[8:11], s22 offen sc1 lds
    s_add_u32 s22, s21, 0x8400
    s_add_u32 m0, s20, 0x20400
    s_nop 0
    buffer_load_dwordx4 v2, s[8:11], s22 offen sc1 lds
    s_add_u32 s22, s21, 0xc000
    s_add_u32 m0, s20, 0x24000
    s_nop 0
    buffer_load_dwordx4 v2, s[8:11], s22 offen sc1 lds
    s_add_u32 s22, s21, 0xc400
    s_add_u32 m0, s20, 0x24400
    s_nop 0
    buffer_load_dwordx4 v2, s[8:11], s22 offen sc1 lds
    ds_read_b64_tr_b16 v[88:89], v11 offset:0
    ds_read_b64_tr_b16 v[90:91], v11 offset:1024
    ds_read_b64_tr_b16 v[92:93], v11 offset:8192
    ds_read_b64_tr_b16 v[94:95], v11 offset:9216
    ds_read_b64_tr_b16 v[96:97], v11 offset:16384
    ds_read_b64_tr_b16 v[98:99], v11 offset:17408
    ds_read_b64_tr_b16 v[100:101], v11 offset:24576
    ds_read_b64_tr_b16 v[102:103], v11 offset:25600
    s_mov_b32 s23, 0x3e0293ee
    v_mul_f32 v24, s23, v24
    v_mul_f32 v25, s23, v25
    v_mul_f32 v26, s23, v26
    v_mul_f32 v27, s23, v27
    v_mul_f32 v28, s23, v28
    v_mul_f32 v29, s23, v29
    v_mul_f32 v30, s23, v30
    v_mul_f32 v31, s23, v31
    v_mul_f32 v32, s23, v32
    v_mul_f32 v33, s23, v33
    v_mul_f32 v34, s23, v34
    v_mul_f32 v35, s23, v35
    v_mul_f32 v36, s23, v36
    v_mul_f32 v37, s23, v37
    v_mul_f32 v38, s23, v38
    v_mul_f32 v39, s23, v39
    v_cvt_pk_bf16_f32 v152, v24, v25
    v_cvt_pk_bf16_f32 v153, v26, v27
    v_cvt_pk_bf16_f32 v168, v28, v29
    v_cvt_pk_bf16_f32 v169, v30, v31
    v_cvt_pk_bf16_f32 v154, v32, v33
    v_cvt_pk_bf16_f32 v155, v34, v35
    v_cvt_pk_bf16_f32 v170, v36, v37
    v_cvt_pk_bf16_f32 v171, v38, v39
    s_waitcnt lgkmcnt(6)
    v_mfma_f32_16x16x32_bf16 v[104:107], v[88:91], v[136:139], 0
    s_waitcnt lgkmcnt(4)
    v_mfma_f32_16x16x32_bf16 v[104:107], v[92:95], v[140:143], v[104:107]
    s_waitcnt lgkmcnt(2)
    v_mfma_f32_16x16x32_bf16 v[104:107], v[96:99], v[144:147], v[104:107]
    s_waitcnt lgkmcnt(0)
    v_mfma_f32_16x16x32_bf16 v[104:107], v[100:103], v[148:151], v[104:107]
    v_add_u32 v4, 0x10000, v2
    v_add_u32 v5, 0x20000, v2
    s_barrier
    ds_read_b128 v[224:227], v4 offset:32768
    ds_read_b128 v[228:231], v4 offset:33792
    ds_read_b128 v[232:235], v4 offset:34816
    ds_read_b128 v[236:239], v4 offset:35840
    v_mov_b32 v12, 0x3f803f80
    v_mov_b32 v13, 0x3f803f80
    v_mov_b32 v14, 0x3f803f80
    v_mov_b32 v15, 0x3f803f80
    s_waitcnt lgkmcnt(3)
    v_mfma_f32_16x16x32_bf16 v[184:187], v[224:227], v[152:155], 0
    v_mul_f32 v40, s23, v40
    v_mul_f32 v41, s23, v41
    v_mul_f32 v42, s23, v42
    v_mul_f32 v43, s23, v43
    v_mul_f32 v44, s23, v44
    v_mul_f32 v45, s23, v45
    v_lshrrev_b32 v20, 4, v1
    v_lshlrev_b32 v20, 4, v20
    s_lshr_b32 s16, s2, 5
    s_lshl_b32 s16, s16, 14
    s_and_b32 s17, s2, 31
    s_lshl_b32 s17, s17, 9
    s_add_u32 s16, s16, s17
    s_lshl_b32 s17, s3, 6
    s_add_u32 s16, s16, s17
    s_add_u32 s16, s16, 0x580000
    s_mov_b32 exec_lo, 0x10001
    s_mov_b32 exec_hi, 0x10001
    buffer_store_dwordx4 v[104:107], v20, s[8:11], s16 offen sc1
    s_mov_b64 exec, -1
    v_mfma_f32_16x16x32_bf16 v[188:191], v[224:227], v[168:171], 0
    ds_read_b128 v[240:243], v4 offset:36864
    v_mul_f32 v46, s23, v46
    v_mul_f32 v47, s23, v47
    v_mul_f32 v48, s23, v48
    v_mul_f32 v49, s23, v49
    v_mul_f32 v50, s23, v50
    v_mul_f32 v51, s23, v51
    s_mov_b64 s[64:65], s[46:47]
    s_mov_b32 s66, 0x700000
    s_mov_b32 s67, 0x20000
    s_mov_b64 s[68:69], s[48:49]
    s_mov_b32 s70, 0x700000
    s_mov_b32 s71, 0x20000
    s_cmp_lt_u32 s2, 224
    s_cselect_b32 s66, 7340032, 0
    s_cselect_b32 s70, 7340032, 0
    s_and_b32 s29, s2, 7
    s_mul_i32 s29, s29, 28
    s_lshr_b32 s16, s2, 3
    s_add_u32 s29, s29, s16
    s_sub_u32 s16, s3, 4
    v_lshrrev_b32 v20, 3, v1
    v_lshlrev_b32 v20, 3, v20
    s_lshl_b32 s17, s16, 6
    v_add_u32 v20, s17, v20
    s_mov_b32 s17, 7168
    v_mul_lo_u32 v11, s17, v20
    v_and_b32 v20, 7, v1
    v_lshl_add_u32 v11, v20, 4, v11
    s_and_b32 s17, s29, 3
    s_mul_i32 s18, s17, 1835008
    s_lshr_b32 s17, s29, 2
    s_lshl_b32 s17, s17, 7
    s_add_u32 s18, s18, s17
    s_lshl_b32 s15, s16, 13
    s_waitcnt lgkmcnt(3)
    v_mfma_f32_16x16x32_bf16 v[192:195], v[228:231], v[152:155], 0
    s_add_u32 s22, s21, 0x10000
    s_add_u32 m0, s20, 0x10000
    s_nop 0
    buffer_load_dwordx4 v2, s[8:11], s22 offen sc1 lds
    v_mul_f32 v52, s23, v52
    v_mul_f32 v53, s23, v53
    v_mul_f32 v54, s23, v54
    v_mul_f32 v55, s23, v55
    v_cvt_pk_bf16_f32 v156, v40, v41
    v_cvt_pk_bf16_f32 v157, v42, v43
    v_mfma_f32_16x16x32_bf16 v[196:199], v[228:231], v[168:171], 0
    ds_read_b128 v[244:247], v4 offset:37888
    v_cvt_pk_bf16_f32 v172, v44, v45
    v_cvt_pk_bf16_f32 v173, v46, v47
    v_cvt_pk_bf16_f32 v158, v48, v49
    v_cvt_pk_bf16_f32 v159, v50, v51
    v_cvt_pk_bf16_f32 v174, v52, v53
    v_cvt_pk_bf16_f32 v175, v54, v55
    s_waitcnt lgkmcnt(3)
    v_mfma_f32_16x16x32_bf16 v[184:187], v[232:235], v[156:159], v[184:187]
    v_mul_f32 v56, s23, v56
    v_mul_f32 v57, s23, v57
    v_mul_f32 v58, s23, v58
    v_mul_f32 v59, s23, v59
    v_mul_f32 v60, s23, v60
    v_mul_f32 v61, s23, v61
    v_mfma_f32_16x16x32_bf16 v[188:191], v[232:235], v[172:175], v[188:191]
    ds_read_b128 v[224:227], v4 offset:38912
    v_mul_f32 v62, s23, v62
    v_mul_f32 v63, s23, v63
    v_mul_f32 v64, s23, v64
    v_mul_f32 v65, s23, v65
    v_mul_f32 v66, s23, v66
    v_mul_f32 v67, s23, v67
    s_waitcnt lgkmcnt(3)
    v_mfma_f32_16x16x32_bf16 v[192:195], v[236:239], v[156:159], v[192:195]
    v_mul_f32 v68, s23, v68
    v_mul_f32 v69, s23, v69
    v_mul_f32 v70, s23, v70
    v_mul_f32 v71, s23, v71
    v_cvt_pk_bf16_f32 v160, v56, v57
    v_cvt_pk_bf16_f32 v161, v58, v59
    v_mfma_f32_16x16x32_bf16 v[196:199], v[236:239], v[172:175], v[196:199]
    ds_read_b128 v[228:231], v4 offset:39936
    v_cvt_pk_bf16_f32 v176, v60, v61
    v_cvt_pk_bf16_f32 v177, v62, v63
    v_cvt_pk_bf16_f32 v162, v64, v65
    v_cvt_pk_bf16_f32 v163, v66, v67
    v_cvt_pk_bf16_f32 v178, v68, v69
    v_cvt_pk_bf16_f32 v179, v70, v71
    s_waitcnt lgkmcnt(3)
    v_mfma_f32_16x16x32_bf16 v[184:187], v[240:243], v[160:163], v[184:187]
    v_mul_f32 v72, s23, v72
    v_mul_f32 v73, s23, v73
    v_mul_f32 v74, s23, v74
    v_mul_f32 v75, s23, v75
    v_mul_f32 v76, s23, v76
    v_mul_f32 v77, s23, v77
    v_mfma_f32_16x16x32_bf16 v[188:191], v[240:243], v[176:179], v[188:191]
    ds_read_b128 v[232:235], v4 offset:40960
    v_mul_f32 v78, s23, v78
    v_mul_f32 v79, s23, v79
    v_mul_f32 v80, s23, v80
    v_mul_f32 v81, s23, v81
    v_mul_f32 v82, s23, v82
    v_mul_f32 v83, s23, v83
    s_waitcnt lgkmcnt(3)
    v_mfma_f32_16x16x32_bf16 v[192:195], v[244:247], v[160:163], v[192:195]
    s_add_u32 s22, s21, 0x10400
    s_add_u32 m0, s20, 0x10400
    s_nop 0
    buffer_load_dwordx4 v2, s[8:11], s22 offen sc1 lds
    v_mul_f32 v84, s23, v84
    v_mul_f32 v85, s23, v85
    v_mul_f32 v86, s23, v86
    v_mul_f32 v87, s23, v87
    v_cvt_pk_bf16_f32 v164, v72, v73
    v_cvt_pk_bf16_f32 v165, v74, v75
    v_mfma_f32_16x16x32_bf16 v[196:199], v[244:247], v[176:179], v[196:199]
    ds_read_b128 v[236:239], v4 offset:41984
    v_cvt_pk_bf16_f32 v180, v76, v77
    v_cvt_pk_bf16_f32 v181, v78, v79
    v_cvt_pk_bf16_f32 v166, v80, v81
    v_cvt_pk_bf16_f32 v167, v82, v83
    v_cvt_pk_bf16_f32 v182, v84, v85
    v_cvt_pk_bf16_f32 v183, v86, v87
    s_waitcnt lgkmcnt(3)
    v_mfma_f32_16x16x32_bf16 v[184:187], v[224:227], v[164:167], v[184:187]
    v_mfma_f32_16x16x32_bf16 v[188:191], v[224:227], v[180:183], v[188:191]
    ds_read_b128 v[240:243], v4 offset:43008
    s_waitcnt lgkmcnt(3)
    v_mfma_f32_16x16x32_bf16 v[192:195], v[228:231], v[164:167], v[192:195]
    v_mfma_f32_16x16x32_bf16 v[196:199], v[228:231], v[180:183], v[196:199]
    ds_read_b128 v[244:247], v4 offset:44032
    s_waitcnt lgkmcnt(3)
    v_mfma_f32_16x16x32_bf16 v[200:203], v[232:235], v[152:155], 0
    v_mfma_f32_16x16x32_bf16 v[204:207], v[232:235], v[168:171], 0
    ds_read_b128 v[224:227], v4 offset:45056
    s_waitcnt lgkmcnt(3)
    v_mfma_f32_16x16x32_bf16 v[208:211], v[236:239], v[152:155], 0
    v_mfma_f32_16x16x32_bf16 v[212:215], v[236:239], v[168:171], 0
    ds_read_b128 v[228:231], v4 offset:46080
    s_waitcnt lgkmcnt(3)
    v_mfma_f32_16x16x32_bf16 v[200:203], v[240:243], v[156:159], v[200:203]
    v_mfma_f32_16x16x32_bf16 v[204:207], v[240:243], v[172:175], v[204:207]
    ds_read_b128 v[232:235], v4 offset:47104
    s_waitcnt lgkmcnt(3)
    v_mfma_f32_16x16x32_bf16 v[208:211], v[244:247], v[156:159], v[208:211]
    v_max3_f32 v16, v184, v185, v186
    v_mfma_f32_16x16x32_bf16 v[212:215], v[244:247], v[172:175], v[212:215]
    ds_read_b128 v[236:239], v4 offset:48128
    v_max3_f32 v16, v16, v187, v192
    s_waitcnt lgkmcnt(3)
    v_mfma_f32_16x16x32_bf16 v[200:203], v[224:227], v[160:163], v[200:203]
    v_max3_f32 v16, v16, v193, v194
    v_mfma_f32_16x16x32_bf16 v[204:207], v[224:227], v[176:179], v[204:207]
    s_barrier
    ds_read_b128 v[240:243], v4 offset:49152
    v_max_f32 v16, v16, v195
    s_waitcnt lgkmcnt(3)
    v_mfma_f32_16x16x32_bf16 v[208:211], v[228:231], v[160:163], v[208:211]
    v_max3_f32 v17, v188, v189, v190
    v_mfma_f32_16x16x32_bf16 v[212:215], v[228:231], v[176:179], v[212:215]
    s_add_u32 s22, s21, 0x14000
    s_add_u32 m0, s20, 0x14000
    s_nop 0
    buffer_load_dwordx4 v2, s[8:11], s22 offen sc1 lds
    ds_read_b128 v[244:247], v4 offset:50176
    v_max3_f32 v17, v17, v191, v196
    s_waitcnt lgkmcnt(3)
    v_mfma_f32_16x16x32_bf16 v[200:203], v[232:235], v[164:167], v[200:203]
    v_max3_f32 v17, v17, v197, v198
    v_mfma_f32_16x16x32_bf16 v[204:207], v[232:235], v[180:183], v[204:207]
    ds_read_b128 v[224:227], v4 offset:51200
    v_max_f32 v17, v17, v199
    s_waitcnt lgkmcnt(3)
    v_mfma_f32_16x16x32_bf16 v[208:211], v[236:239], v[164:167], v[208:211]
    s_mov_b64 s[72:73], s[40:41]
    s_mov_b32 s74, 0x800000
    s_mov_b32 s75, 0x20000
    v_lshlrev_b32 v21, 7, v1
    s_lshl_b32 s16, s2, 2
    s_add_u32 s16, s16, s3
    s_sub_u32 s16, s16, 4
    s_lshl_b32 s16, s16, 13
    buffer_load_dword v7, v21, s[72:75], s16 offen
    v_mfma_f32_16x16x32_bf16 v[212:215], v[236:239], v[180:183], v[212:215]
    ds_read_b128 v[228:231], v4 offset:52224
    v_max3_f32 v16, v16, v200, v201
    v_max3_f32 v16, v16, v202, v203
    v_max3_f32 v16, v16, v208, v209
    v_max3_f32 v16, v16, v210, v211
    v_max3_f32 v17, v17, v204, v205
    v_max3_f32 v17, v17, v206, v207
    s_nop 0
    v_max3_f32 v17, v17, v212, v213
    v_max3_f32 v17, v17, v214, v215
    v_mov_b32 v18, v16
    v_mov_b32 v19, v17
    s_nop 0
    v_permlane16_swap_b32 v16, v18
    v_permlane16_swap_b32 v17, v19
    v_max_f32 v16, v16, v18
    v_max_f32 v17, v17, v19
    v_mov_b32 v18, v16
    v_mov_b32 v19, v17
    s_nop 0
    v_permlane32_swap_b32 v16, v18
    v_permlane32_swap_b32 v17, v19
    v_max_f32 v16, v16, v18
    v_max_f32 v17, v17, v19
    v_sub_f32 v216, 0, v16
    v_sub_f32 v217, 0, v16
    v_sub_f32 v218, 0, v16
    v_sub_f32 v219, 0, v16
    v_sub_f32 v220, 0, v17
    v_sub_f32 v221, 0, v17
    v_sub_f32 v222, 0, v17
    v_sub_f32 v223, 0, v17
    v_add_f32 v184, v184, v216
    v_add_f32 v185, v185, v216
    v_exp_f32 v184, v184
    v_exp_f32 v185, v185
    v_add_f32 v186, v186, v216
    v_add_f32 v187, v187, v216
    v_exp_f32 v186, v186
    v_exp_f32 v187, v187
    v_cvt_pk_bf16_f32 v24, v184, v185
    v_add_f32 v188, v188, v220
    v_add_f32 v189, v189, v220
    v_exp_f32 v188, v188
    v_exp_f32 v189, v189
    v_cvt_pk_bf16_f32 v25, v186, v187
    v_add_f32 v190, v190, v220
    v_add_f32 v191, v191, v220
    v_exp_f32 v190, v190
    v_exp_f32 v191, v191
    v_cvt_pk_bf16_f32 v28, v188, v189
    v_add_f32 v192, v192, v216
    v_add_f32 v193, v193, v216
    v_exp_f32 v192, v192
    v_exp_f32 v193, v193
    v_cvt_pk_bf16_f32 v29, v190, v191
    v_add_f32 v194, v194, v216
    v_add_f32 v195, v195, v216
    v_exp_f32 v194, v194
    v_exp_f32 v195, v195
    v_cvt_pk_bf16_f32 v26, v192, v193
    v_add_f32 v196, v196, v220
    v_add_f32 v197, v197, v220
    v_exp_f32 v196, v196
    v_exp_f32 v197, v197
    v_cvt_pk_bf16_f32 v27, v194, v195
    v_add_f32 v198, v198, v220
    v_add_f32 v199, v199, v220
    v_exp_f32 v198, v198
    v_exp_f32 v199, v199
    v_cvt_pk_bf16_f32 v30, v196, v197
    v_cvt_pk_bf16_f32 v31, v198, v199
    s_waitcnt lgkmcnt(3)
    v_mfma_f32_16x16x32_bf16 v[184:187], v[240:243], v[152:155], v[216:219]
    v_mfma_f32_16x16x32_bf16 v[188:191], v[240:243], v[168:171], v[220:223]
    ds_read_b128 v[232:235], v4 offset:53248
    v_add_f32 v200, v200, v216
    v_add_f32 v201, v201, v216
    v_exp_f32 v200, v200
    v_mfma_f32_16x16x32_bf16 v[248:251], v[12:15], v[24:27], 0
    s_waitcnt lgkmcnt(3)
    v_mfma_f32_16x16x32_bf16 v[192:195], v[244:247], v[152:155], v[216:219]
    v_exp_f32 v201, v201
    v_add_f32 v202, v202, v216
    v_add_f32 v203, v203, v216
    v_mfma_f32_16x16x32_bf16 v[196:199], v[244:247], v[168:171], v[220:223]
    s_add_u32 s22, s21, 0x14400
    s_add_u32 m0, s20, 0x14400
    s_nop 0
    buffer_load_dwordx4 v2, s[8:11], s22 offen sc1 lds
    ds_read_b128 v[236:239], v4 offset:54272
    v_exp_f32 v202, v202
    v_exp_f32 v203, v203
    v_mfma_f32_16x16x32_bf16 v[252:255], v[12:15], v[28:31], 0
    s_waitcnt lgkmcnt(3)
    v_mfma_f32_16x16x32_bf16 v[184:187], v[224:227], v[156:159], v[184:187]
    v_cvt_pk_bf16_f32 v32, v200, v201
    v_add_f32 v204, v204, v220
    v_add_f32 v205, v205, v220
    v_mfma_f32_16x16x32_bf16 v[188:191], v[224:227], v[172:175], v[188:191]
    ds_read_b128 v[240:243], v4 offset:55296
    v_exp_f32 v204, v204
    v_exp_f32 v205, v205
    v_cvt_pk_bf16_f32 v33, v202, v203
    s_mov_b64 s[4:5], s[40:41]
    s_mov_b32 s6, 0x800000
    s_mov_b32 s7, 0x20000
    v_bfe_u32 v20, v1, 2, 2
    v_lshlrev_b32 v21, 13, v20
    v_sub_u32 v3, v3, v21
    v_lshl_add_u32 v3, v20, 11, v3
    s_and_b32 s16, s2, 1
    s_lshl_b32 s24, s16, 22
    s_lshr_b32 s16, s2, 5
    s_lshl_b32 s16, s16, 8
    s_add_u32 s24, s24, s16
    s_lshl_b32 s16, s3, 14
    s_add_u32 s24, s24, s16
    s_add_u32 s24, s24, 196608
    s_waitcnt lgkmcnt(3)
    v_mfma_f32_16x16x32_bf16 v[192:195], v[228:231], v[156:159], v[192:195]
    v_add_f32 v206, v206, v220
    v_add_f32 v207, v207, v220
    v_mfma_f32_16x16x32_bf16 v[196:199], v[228:231], v[172:175], v[196:199]
    ds_read_b128 v[244:247], v4 offset:56320
    v_exp_f32 v206, v206
    v_exp_f32 v207, v207
    v_cvt_pk_bf16_f32 v36, v204, v205
    s_waitcnt lgkmcnt(3)
    v_mfma_f32_16x16x32_bf16 v[184:187], v[232:235], v[160:163], v[184:187]
    v_add_f32 v208, v208, v216
    v_add_f32 v209, v209, v216
    v_exp_f32 v208, v208
    v_mfma_f32_16x16x32_bf16 v[188:191], v[232:235], v[176:179], v[188:191]
    ds_read_b128 v[224:227], v4 offset:57344
    v_exp_f32 v209, v209
    v_cvt_pk_bf16_f32 v37, v206, v207
    s_waitcnt lgkmcnt(3)
    v_mfma_f32_16x16x32_bf16 v[192:195], v[236:239], v[160:163], v[192:195]
    v_add_f32 v210, v210, v216
    v_add_f32 v211, v211, v216
    v_exp_f32 v210, v210
    v_mfma_f32_16x16x32_bf16 v[196:199], v[236:239], v[176:179], v[196:199]
    ds_read_b128 v[228:231], v4 offset:58368
    v_exp_f32 v211, v211
    v_cvt_pk_bf16_f32 v34, v208, v209
    v_add_f32 v212, v212, v220
    s_waitcnt lgkmcnt(3)
    v_mfma_f32_16x16x32_bf16 v[184:187], v[240:243], v[164:167], v[184:187]
    v_add_f32 v213, v213, v220
    v_exp_f32 v212, v212
    v_mfma_f32_16x16x32_bf16 v[188:191], v[240:243], v[180:183], v[188:191]
    ds_read_b128 v[232:235], v4 offset:59392
    v_exp_f32 v213, v213
    v_cvt_pk_bf16_f32 v35, v210, v211
    v_add_f32 v214, v214, v220
    s_waitcnt lgkmcnt(3)
    v_mfma_f32_16x16x32_bf16 v[192:195], v[244:247], v[164:167], v[192:195]
    v_add_f32 v215, v215, v220
    v_exp_f32 v214, v214
    v_exp_f32 v215, v215
    v_mfma_f32_16x16x32_bf16 v[196:199], v[244:247], v[180:183], v[196:199]
    ds_read_b128 v[236:239], v4 offset:60416
    v_cvt_pk_bf16_f32 v38, v212, v213
    v_cvt_pk_bf16_f32 v39, v214, v215
    s_waitcnt lgkmcnt(3)
    v_mfma_f32_16x16x32_bf16 v[200:203], v[224:227], v[152:155], v[216:219]
    v_mfma_f32_16x16x32_bf16 v[204:207], v[224:227], v[168:171], v[220:223]
    ds_read_b128 v[240:243], v4 offset:61440
    v_exp_f32 v184, v184
    v_exp_f32 v185, v185
    v_mfma_f32_16x16x32_bf16 v[248:251], v[12:15], v[32:35], v[248:251]
    s_waitcnt lgkmcnt(3)
    v_mfma_f32_16x16x32_bf16 v[208:211], v[228:231], v[152:155], v[216:219]
    v_exp_f32 v186, v186
    v_exp_f32 v187, v187
    v_mfma_f32_16x16x32_bf16 v[212:215], v[228:231], v[168:171], v[220:223]
    ds_read_b128 v[244:247], v4 offset:62464
    v_cvt_pk_bf16_f32 v40, v184, v185
    v_mfma_f32_16x16x32_bf16 v[252:255], v[12:15], v[36:39], v[252:255]
    s_waitcnt lgkmcnt(3)
    v_mfma_f32_16x16x32_bf16 v[200:203], v[232:235], v[156:159], v[200:203]
    v_exp_f32 v188, v188
    v_exp_f32 v189, v189
    v_mfma_f32_16x16x32_bf16 v[204:207], v[232:235], v[172:175], v[204:207]
    ds_read_b128 v[224:227], v4 offset:63488
    v_cvt_pk_bf16_f32 v41, v186, v187
    s_waitcnt lgkmcnt(3)
    v_mfma_f32_16x16x32_bf16 v[208:211], v[236:239], v[156:159], v[208:211]
    v_exp_f32 v190, v190
    v_exp_f32 v191, v191
    v_mfma_f32_16x16x32_bf16 v[212:215], v[236:239], v[172:175], v[212:215]
    ds_read_b128 v[228:231], v4 offset:64512
    v_cvt_pk_bf16_f32 v44, v188, v189
    v_exp_f32 v192, v192
    s_waitcnt lgkmcnt(3)
    v_mfma_f32_16x16x32_bf16 v[200:203], v[240:243], v[160:163], v[200:203]
    v_exp_f32 v193, v193
    v_mfma_f32_16x16x32_bf16 v[204:207], v[240:243], v[176:179], v[204:207]
    s_waitcnt vmcnt(8)
    s_barrier
    ds_read_b128 v[232:235], v5 offset:0
    v_cvt_pk_bf16_f32 v45, v190, v191
    v_exp_f32 v194, v194
    s_waitcnt lgkmcnt(3)
    v_mfma_f32_16x16x32_bf16 v[208:211], v[244:247], v[160:163], v[208:211]
    v_exp_f32 v195, v195
    v_mfma_f32_16x16x32_bf16 v[212:215], v[244:247], v[176:179], v[212:215]
    s_add_u32 s22, s21, 0x18000
    s_add_u32 m0, s20, 0x18000
    s_nop 0
    buffer_load_dwordx4 v2, s[8:11], s22 offen sc1 lds
    ds_read_b128 v[236:239], v5 offset:1024
    v_cvt_pk_bf16_f32 v42, v192, v193
    v_exp_f32 v196, v196
    s_waitcnt lgkmcnt(3)
    v_mfma_f32_16x16x32_bf16 v[200:203], v[224:227], v[164:167], v[200:203]
    v_exp_f32 v197, v197
    v_cvt_pk_bf16_f32 v43, v194, v195
    v_mfma_f32_16x16x32_bf16 v[204:207], v[224:227], v[180:183], v[204:207]
    ds_read_b128 v[240:243], v5 offset:2048
    v_exp_f32 v198, v198
    s_waitcnt lgkmcnt(3)
    v_mfma_f32_16x16x32_bf16 v[208:211], v[228:231], v[164:167], v[208:211]
    v_exp_f32 v199, v199
    v_cvt_pk_bf16_f32 v46, v196, v197
    v_mfma_f32_16x16x32_bf16 v[212:215], v[228:231], v[180:183], v[212:215]
    ds_read_b128 v[244:247], v5 offset:3072
    v_cvt_pk_bf16_f32 v47, v198, v199
    s_waitcnt lgkmcnt(3)
    v_mfma_f32_16x16x32_bf16 v[184:187], v[232:235], v[152:155], v[216:219]
    v_mfma_f32_16x16x32_bf16 v[188:191], v[232:235], v[168:171], v[220:223]
    ds_read_b128 v[224:227], v5 offset:4096
    v_exp_f32 v200, v200
    v_exp_f32 v201, v201
    v_mfma_f32_16x16x32_bf16 v[248:251], v[12:15], v[40:43], v[248:251]
    s_waitcnt lgkmcnt(3)
    v_mfma_f32_16x16x32_bf16 v[192:195], v[236:239], v[152:155], v[216:219]
    v_exp_f32 v202, v202
    v_exp_f32 v203, v203
    v_mfma_f32_16x16x32_bf16 v[196:199], v[236:239], v[168:171], v[220:223]
    s_add_u32 s22, s21, 0x18400
    s_add_u32 m0, s20, 0x18400
    s_nop 0
    buffer_load_dwordx4 v2, s[8:11], s22 offen sc1 lds
    ds_read_b128 v[228:231], v5 offset:5120
    v_cvt_pk_bf16_f32 v48, v200, v201
    v_mfma_f32_16x16x32_bf16 v[252:255], v[12:15], v[44:47], v[252:255]
    s_waitcnt lgkmcnt(3)
    v_mfma_f32_16x16x32_bf16 v[184:187], v[240:243], v[156:159], v[184:187]
    v_exp_f32 v204, v204
    v_exp_f32 v205, v205
    v_mfma_f32_16x16x32_bf16 v[188:191], v[240:243], v[172:175], v[188:191]
    ds_read_b128 v[232:235], v5 offset:6144
    v_cvt_pk_bf16_f32 v49, v202, v203
    s_waitcnt lgkmcnt(3)
    v_mfma_f32_16x16x32_bf16 v[192:195], v[244:247], v[156:159], v[192:195]
    v_exp_f32 v206, v206
    v_exp_f32 v207, v207
    v_mfma_f32_16x16x32_bf16 v[196:199], v[244:247], v[172:175], v[196:199]
    ds_read_b128 v[236:239], v5 offset:7168
    v_cvt_pk_bf16_f32 v52, v204, v205
    v_exp_f32 v208, v208
    s_waitcnt lgkmcnt(3)
    v_mfma_f32_16x16x32_bf16 v[184:187], v[224:227], v[160:163], v[184:187]
    v_exp_f32 v209, v209
    v_mfma_f32_16x16x32_bf16 v[188:191], v[224:227], v[176:179], v[188:191]
    ds_read_b128 v[240:243], v5 offset:8192
    v_cvt_pk_bf16_f32 v53, v206, v207
    v_exp_f32 v210, v210
    s_waitcnt lgkmcnt(3)
    v_mfma_f32_16x16x32_bf16 v[192:195], v[228:231], v[160:163], v[192:195]
    v_exp_f32 v211, v211
    v_mfma_f32_16x16x32_bf16 v[196:199], v[228:231], v[176:179], v[196:199]
    ds_read_b128 v[244:247], v5 offset:9216
    v_cvt_pk_bf16_f32 v50, v208, v209
    v_exp_f32 v212, v212
    s_waitcnt lgkmcnt(3)
    v_mfma_f32_16x16x32_bf16 v[184:187], v[232:235], v[164:167], v[184:187]
    v_exp_f32 v213, v213
    v_cvt_pk_bf16_f32 v51, v210, v211
    v_mfma_f32_16x16x32_bf16 v[188:191], v[232:235], v[180:183], v[188:191]
    ds_read_b128 v[224:227], v5 offset:10240
    v_exp_f32 v214, v214
    s_waitcnt lgkmcnt(3)
    v_mfma_f32_16x16x32_bf16 v[192:195], v[236:239], v[164:167], v[192:195]
    v_exp_f32 v215, v215
    v_cvt_pk_bf16_f32 v54, v212, v213
    v_mfma_f32_16x16x32_bf16 v[196:199], v[236:239], v[180:183], v[196:199]
    ds_read_b128 v[228:231], v5 offset:11264
    v_cvt_pk_bf16_f32 v55, v214, v215
    s_waitcnt lgkmcnt(3)
    v_mfma_f32_16x16x32_bf16 v[200:203], v[240:243], v[152:155], v[216:219]
    v_mfma_f32_16x16x32_bf16 v[204:207], v[240:243], v[168:171], v[220:223]
    ds_read_b128 v[232:235], v5 offset:12288
    v_exp_f32 v184, v184
    v_exp_f32 v185, v185
    v_mfma_f32_16x16x32_bf16 v[248:251], v[12:15], v[48:51], v[248:251]
    s_waitcnt lgkmcnt(3)
    v_mfma_f32_16x16x32_bf16 v[208:211], v[244:247], v[152:155], v[216:219]
    v_exp_f32 v186, v186
    v_exp_f32 v187, v187
    v_mfma_f32_16x16x32_bf16 v[212:215], v[244:247], v[168:171], v[220:223]
    ds_read_b128 v[236:239], v5 offset:13312
    v_cvt_pk_bf16_f32 v56, v184, v185
    v_mfma_f32_16x16x32_bf16 v[252:255], v[12:15], v[52:55], v[252:255]
    s_waitcnt lgkmcnt(3)
    v_mfma_f32_16x16x32_bf16 v[200:203], v[224:227], v[156:159], v[200:203]
    v_exp_f32 v188, v188
    v_exp_f32 v189, v189
    v_mfma_f32_16x16x32_bf16 v[204:207], v[224:227], v[172:175], v[204:207]
    ds_read_b128 v[240:243], v5 offset:14336
    v_cvt_pk_bf16_f32 v57, v186, v187
    s_waitcnt lgkmcnt(3)
    v_mfma_f32_16x16x32_bf16 v[208:211], v[228:231], v[156:159], v[208:211]
    v_exp_f32 v190, v190
    v_exp_f32 v191, v191
    s_waitcnt vmcnt(7)
    v_mfma_f32_16x16x32_bf16 v[212:215], v[228:231], v[172:175], v[212:215]
    ds_read_b128 v[244:247], v5 offset:15360
    v_cvt_pk_bf16_f32 v60, v188, v189
    v_exp_f32 v192, v192
    s_waitcnt lgkmcnt(3)
    v_mfma_f32_16x16x32_bf16 v[200:203], v[232:235], v[160:163], v[200:203]
    v_exp_f32 v193, v193
    v_mfma_f32_16x16x32_bf16 v[204:207], v[232:235], v[176:179], v[204:207]
    s_barrier
    ds_read_b128 v[224:227], v5 offset:16384
    v_cvt_pk_bf16_f32 v61, v190, v191
    v_exp_f32 v194, v194
    s_waitcnt lgkmcnt(3)
    v_mfma_f32_16x16x32_bf16 v[208:211], v[236:239], v[160:163], v[208:211]
    v_exp_f32 v195, v195
    v_mfma_f32_16x16x32_bf16 v[212:215], v[236:239], v[176:179], v[212:215]
    s_add_u32 s22, s21, 0x1c000
    s_add_u32 m0, s20, 0x1c000
    s_nop 0
    buffer_load_dwordx4 v2, s[8:11], s22 offen sc1 lds
    ds_read_b128 v[228:231], v5 offset:17408
    v_cvt_pk_bf16_f32 v58, v192, v193
    v_exp_f32 v196, v196
    s_waitcnt lgkmcnt(3)
    v_mfma_f32_16x16x32_bf16 v[200:203], v[240:243], v[164:167], v[200:203]
    v_exp_f32 v197, v197
    v_cvt_pk_bf16_f32 v59, v194, v195
    v_mfma_f32_16x16x32_bf16 v[204:207], v[240:243], v[180:183], v[204:207]
    ds_read_b128 v[232:235], v5 offset:18432
    v_exp_f32 v198, v198
    s_waitcnt lgkmcnt(3)
    v_mfma_f32_16x16x32_bf16 v[208:211], v[244:247], v[164:167], v[208:211]
    v_exp_f32 v199, v199
    v_cvt_pk_bf16_f32 v62, v196, v197
    v_mfma_f32_16x16x32_bf16 v[212:215], v[244:247], v[180:183], v[212:215]
    ds_read_b128 v[236:239], v5 offset:19456
    v_cvt_pk_bf16_f32 v63, v198, v199
    s_waitcnt lgkmcnt(3)
    v_mfma_f32_16x16x32_bf16 v[184:187], v[224:227], v[152:155], v[216:219]
    v_mfma_f32_16x16x32_bf16 v[188:191], v[224:227], v[168:171], v[220:223]
    ds_read_b128 v[240:243], v5 offset:20480
    v_exp_f32 v200, v200
    v_exp_f32 v201, v201
    v_mfma_f32_16x16x32_bf16 v[248:251], v[12:15], v[56:59], v[248:251]
    s_waitcnt lgkmcnt(3)
    v_mfma_f32_16x16x32_bf16 v[192:195], v[228:231], v[152:155], v[216:219]
    v_exp_f32 v202, v202
    v_exp_f32 v203, v203
    v_mfma_f32_16x16x32_bf16 v[196:199], v[228:231], v[168:171], v[220:223]
    s_add_u32 s22, s21, 0x1c400
    s_add_u32 m0, s20, 0x1c400
    s_nop 0
    buffer_load_dwordx4 v2, s[8:11], s22 offen sc1 lds
    ds_read_b128 v[244:247], v5 offset:21504
    v_cvt_pk_bf16_f32 v64, v200, v201
    v_mfma_f32_16x16x32_bf16 v[252:255], v[12:15], v[60:63], v[252:255]
    s_waitcnt lgkmcnt(3)
    v_mfma_f32_16x16x32_bf16 v[184:187], v[232:235], v[156:159], v[184:187]
    v_exp_f32 v204, v204
    v_exp_f32 v205, v205
    v_mfma_f32_16x16x32_bf16 v[188:191], v[232:235], v[172:175], v[188:191]
    ds_read_b128 v[224:227], v5 offset:22528
    v_cvt_pk_bf16_f32 v65, v202, v203
    s_waitcnt lgkmcnt(3)
    v_mfma_f32_16x16x32_bf16 v[192:195], v[236:239], v[156:159], v[192:195]
    v_exp_f32 v206, v206
    v_exp_f32 v207, v207
    v_mfma_f32_16x16x32_bf16 v[196:199], v[236:239], v[172:175], v[196:199]
    ds_read_b128 v[228:231], v5 offset:23552
    v_cvt_pk_bf16_f32 v68, v204, v205
    v_exp_f32 v208, v208
    s_waitcnt lgkmcnt(3)
    v_mfma_f32_16x16x32_bf16 v[184:187], v[240:243], v[160:163], v[184:187]
    v_exp_f32 v209, v209
    v_mfma_f32_16x16x32_bf16 v[188:191], v[240:243], v[176:179], v[188:191]
    ds_read_b128 v[232:235], v5 offset:24576
    v_cvt_pk_bf16_f32 v69, v206, v207
    v_exp_f32 v210, v210
    s_waitcnt lgkmcnt(3)
    v_mfma_f32_16x16x32_bf16 v[192:195], v[244:247], v[160:163], v[192:195]
    v_exp_f32 v211, v211
    v_mfma_f32_16x16x32_bf16 v[196:199], v[244:247], v[176:179], v[196:199]
    ds_read_b128 v[236:239], v5 offset:25600
    v_cvt_pk_bf16_f32 v66, v208, v209
    v_exp_f32 v212, v212
    s_waitcnt lgkmcnt(3)
    v_mfma_f32_16x16x32_bf16 v[184:187], v[224:227], v[164:167], v[184:187]
    v_exp_f32 v213, v213
    v_cvt_pk_bf16_f32 v67, v210, v211
    v_mfma_f32_16x16x32_bf16 v[188:191], v[224:227], v[180:183], v[188:191]
    ds_read_b128 v[240:243], v5 offset:26624
    v_exp_f32 v214, v214
    s_waitcnt lgkmcnt(3)
    v_mfma_f32_16x16x32_bf16 v[192:195], v[228:231], v[164:167], v[192:195]
    v_exp_f32 v215, v215
    v_cvt_pk_bf16_f32 v70, v212, v213
    v_mfma_f32_16x16x32_bf16 v[196:199], v[228:231], v[180:183], v[196:199]
    ds_read_b128 v[244:247], v5 offset:27648
    v_cvt_pk_bf16_f32 v71, v214, v215
    s_waitcnt lgkmcnt(3)
    v_mfma_f32_16x16x32_bf16 v[200:203], v[232:235], v[152:155], v[216:219]
    v_mfma_f32_16x16x32_bf16 v[204:207], v[232:235], v[168:171], v[220:223]
    ds_read_b128 v[224:227], v5 offset:28672
    v_exp_f32 v184, v184
    v_exp_f32 v185, v185
    v_mfma_f32_16x16x32_bf16 v[248:251], v[12:15], v[64:67], v[248:251]
    s_waitcnt lgkmcnt(3)
    v_mfma_f32_16x16x32_bf16 v[208:211], v[236:239], v[152:155], v[216:219]
    v_exp_f32 v186, v186
    v_exp_f32 v187, v187
    v_mfma_f32_16x16x32_bf16 v[212:215], v[236:239], v[168:171], v[220:223]
    ds_read_b128 v[228:231], v5 offset:29696
    v_cvt_pk_bf16_f32 v72, v184, v185
    v_mfma_f32_16x16x32_bf16 v[252:255], v[12:15], v[68:71], v[252:255]
    s_waitcnt lgkmcnt(3)
    v_mfma_f32_16x16x32_bf16 v[200:203], v[240:243], v[156:159], v[200:203]
    v_exp_f32 v188, v188
    v_exp_f32 v189, v189
    v_mfma_f32_16x16x32_bf16 v[204:207], v[240:243], v[172:175], v[204:207]
    ds_read_b128 v[232:235], v5 offset:30720
    v_cvt_pk_bf16_f32 v73, v186, v187
    s_waitcnt lgkmcnt(3)
    v_mfma_f32_16x16x32_bf16 v[208:211], v[244:247], v[156:159], v[208:211]
    v_exp_f32 v190, v190
    v_exp_f32 v191, v191
    v_mfma_f32_16x16x32_bf16 v[212:215], v[244:247], v[172:175], v[212:215]
    ds_read_b128 v[236:239], v5 offset:31744
    v_cvt_pk_bf16_f32 v76, v188, v189
    v_exp_f32 v192, v192
    s_waitcnt lgkmcnt(3)
    v_mfma_f32_16x16x32_bf16 v[200:203], v[224:227], v[160:163], v[200:203]
    v_exp_f32 v193, v193
    v_mfma_f32_16x16x32_bf16 v[204:207], v[224:227], v[176:179], v[204:207]
    s_waitcnt vmcnt(7)
    s_barrier
    ds_read_b128 v[240:243], v4 offset:0
    v_cvt_pk_bf16_f32 v77, v190, v191
    v_exp_f32 v194, v194
    s_waitcnt lgkmcnt(3)
    v_mfma_f32_16x16x32_bf16 v[208:211], v[228:231], v[160:163], v[208:211]
    v_exp_f32 v195, v195
    v_mfma_f32_16x16x32_bf16 v[212:215], v[228:231], v[176:179], v[212:215]
    s_add_u32 s22, s21, 0x80000
    s_add_u32 m0, s20, 0x20000
    s_nop 0
    buffer_load_dwordx4 v2, s[8:11], s22 offen sc1 lds
    ds_read_b128 v[244:247], v4 offset:1024
    v_cvt_pk_bf16_f32 v74, v192, v193
    v_exp_f32 v196, v196
    s_waitcnt lgkmcnt(3)
    v_mfma_f32_16x16x32_bf16 v[200:203], v[232:235], v[164:167], v[200:203]
    v_exp_f32 v197, v197
    v_cvt_pk_bf16_f32 v75, v194, v195
    v_mfma_f32_16x16x32_bf16 v[204:207], v[232:235], v[180:183], v[204:207]
    ds_read_b128 v[224:227], v4 offset:2048
    v_exp_f32 v198, v198
    s_waitcnt lgkmcnt(3)
    v_mfma_f32_16x16x32_bf16 v[208:211], v[236:239], v[164:167], v[208:211]
    v_exp_f32 v199, v199
    v_cvt_pk_bf16_f32 v78, v196, v197
    v_mfma_f32_16x16x32_bf16 v[212:215], v[236:239], v[180:183], v[212:215]
    ds_read_b128 v[228:231], v4 offset:3072
    v_cvt_pk_bf16_f32 v79, v198, v199
    s_waitcnt lgkmcnt(3)
    v_mfma_f32_16x16x32_bf16 v[184:187], v[240:243], v[152:155], v[216:219]
    v_mfma_f32_16x16x32_bf16 v[188:191], v[240:243], v[168:171], v[220:223]
    ds_read_b128 v[232:235], v4 offset:4096
    v_exp_f32 v200, v200
    v_exp_f32 v201, v201
    v_mfma_f32_16x16x32_bf16 v[248:251], v[12:15], v[72:75], v[248:251]
    s_waitcnt lgkmcnt(3)
    v_mfma_f32_16x16x32_bf16 v[192:195], v[244:247], v[152:155], v[216:219]
    v_exp_f32 v202, v202
    v_exp_f32 v203, v203
    v_mfma_f32_16x16x32_bf16 v[196:199], v[244:247], v[168:171], v[220:223]
    s_add_u32 s22, s21, 0x80400
    s_add_u32 m0, s20, 0x20400
    s_nop 0
    buffer_load_dwordx4 v2, s[8:11], s22 offen sc1 lds
    ds_read_b128 v[236:239], v4 offset:5120
    v_cvt_pk_bf16_f32 v80, v200, v201
    v_mfma_f32_16x16x32_bf16 v[252:255], v[12:15], v[76:79], v[252:255]
    s_waitcnt lgkmcnt(3)
    v_mfma_f32_16x16x32_bf16 v[184:187], v[224:227], v[156:159], v[184:187]
    v_exp_f32 v204, v204
    v_exp_f32 v205, v205
    s_add_u32 s22, s18, 0
    s_add_u32 m0, s15, 0
    s_nop 0
    buffer_load_dwordx4 v11, s[64:67], s22 offen lds
    v_mfma_f32_16x16x32_bf16 v[188:191], v[224:227], v[172:175], v[188:191]
    ds_read_b128 v[240:243], v4 offset:6144
    v_cvt_pk_bf16_f32 v81, v202, v203
    s_waitcnt lgkmcnt(3)
    v_mfma_f32_16x16x32_bf16 v[192:195], v[228:231], v[156:159], v[192:195]
    v_exp_f32 v206, v206
    v_exp_f32 v207, v207
    v_mfma_f32_16x16x32_bf16 v[196:199], v[228:231], v[172:175], v[196:199]
    ds_read_b128 v[244:247], v4 offset:7168
    v_cvt_pk_bf16_f32 v84, v204, v205
    v_exp_f32 v208, v208
    s_waitcnt lgkmcnt(3)
    v_mfma_f32_16x16x32_bf16 v[184:187], v[232:235], v[160:163], v[184:187]
    v_exp_f32 v209, v209
    v_mfma_f32_16x16x32_bf16 v[188:191], v[232:235], v[176:179], v[188:191]
    ds_read_b128 v[224:227], v4 offset:8192
    v_cvt_pk_bf16_f32 v85, v206, v207
    v_exp_f32 v210, v210
    s_waitcnt lgkmcnt(3)
    v_mfma_f32_16x16x32_bf16 v[192:195], v[236:239], v[160:163], v[192:195]
    v_exp_f32 v211, v211
    v_mfma_f32_16x16x32_bf16 v[196:199], v[236:239], v[176:179], v[196:199]
    ds_read_b128 v[228:231], v4 offset:9216
    v_cvt_pk_bf16_f32 v82, v208, v209
    v_exp_f32 v212, v212
    s_waitcnt lgkmcnt(3)
    v_mfma_f32_16x16x32_bf16 v[184:187], v[240:243], v[164:167], v[184:187]
    v_exp_f32 v213, v213
    v_cvt_pk_bf16_f32 v83, v210, v211
    v_mfma_f32_16x16x32_bf16 v[188:191], v[240:243], v[180:183], v[188:191]
    ds_read_b128 v[232:235], v4 offset:10240
    v_exp_f32 v214, v214
    s_waitcnt lgkmcnt(3)
    v_mfma_f32_16x16x32_bf16 v[192:195], v[244:247], v[164:167], v[192:195]
    v_exp_f32 v215, v215
    v_cvt_pk_bf16_f32 v86, v212, v213
    v_mfma_f32_16x16x32_bf16 v[196:199], v[244:247], v[180:183], v[196:199]
    ds_read_b128 v[236:239], v4 offset:11264
    v_cvt_pk_bf16_f32 v87, v214, v215
    s_waitcnt lgkmcnt(3)
    v_mfma_f32_16x16x32_bf16 v[200:203], v[224:227], v[152:155], v[216:219]
    v_mfma_f32_16x16x32_bf16 v[204:207], v[224:227], v[168:171], v[220:223]
    ds_read_b128 v[240:243], v4 offset:12288
    v_exp_f32 v184, v184
    v_exp_f32 v185, v185
    v_mfma_f32_16x16x32_bf16 v[248:251], v[12:15], v[80:83], v[248:251]
    s_waitcnt lgkmcnt(3)
    v_mfma_f32_16x16x32_bf16 v[208:211], v[228:231], v[152:155], v[216:219]
    v_exp_f32 v186, v186
    v_exp_f32 v187, v187
    v_mfma_f32_16x16x32_bf16 v[212:215], v[228:231], v[168:171], v[220:223]
    ds_read_b128 v[244:247], v4 offset:13312
    v_cvt_pk_bf16_f32 v88, v184, v185
    s_add_u32 s22, s18, 7168
    s_add_u32 m0, s15, 1024
    s_nop 0
    buffer_load_dwordx4 v11, s[64:67], s22 offen lds
    v_mfma_f32_16x16x32_bf16 v[252:255], v[12:15], v[84:87], v[252:255]
    s_waitcnt lgkmcnt(3)
    v_mfma_f32_16x16x32_bf16 v[200:203], v[232:235], v[156:159], v[200:203]
    v_exp_f32 v188, v188
    v_exp_f32 v189, v189
    v_mfma_f32_16x16x32_bf16 v[204:207], v[232:235], v[172:175], v[204:207]
    ds_read_b128 v[224:227], v4 offset:14336
    v_cvt_pk_bf16_f32 v89, v186, v187
    s_waitcnt lgkmcnt(3)
    v_mfma_f32_16x16x32_bf16 v[208:211], v[236:239], v[156:159], v[208:211]
    v_exp_f32 v190, v190
    v_exp_f32 v191, v191
    v_mfma_f32_16x16x32_bf16 v[212:215], v[236:239], v[172:175], v[212:215]
    ds_read_b128 v[228:231], v4 offset:15360
    v_cvt_pk_bf16_f32 v92, v188, v189
    v_exp_f32 v192, v192
    s_waitcnt lgkmcnt(3)
    v_mfma_f32_16x16x32_bf16 v[200:203], v[240:243], v[160:163], v[200:203]
    v_exp_f32 v193, v193
    v_mfma_f32_16x16x32_bf16 v[204:207], v[240:243], v[176:179], v[204:207]
    s_waitcnt vmcnt(8)
    s_barrier
    ds_read_b128 v[232:235], v4 offset:16384
    v_cvt_pk_bf16_f32 v93, v190, v191
    v_exp_f32 v194, v194
    s_waitcnt lgkmcnt(3)
    v_mfma_f32_16x16x32_bf16 v[208:211], v[244:247], v[160:163], v[208:211]
    v_exp_f32 v195, v195
    v_mfma_f32_16x16x32_bf16 v[212:215], v[244:247], v[176:179], v[212:215]
    s_add_u32 s22, s21, 0x84000
    s_add_u32 m0, s20, 0x24000
    s_nop 0
    buffer_load_dwordx4 v2, s[8:11], s22 offen sc1 lds
    ds_read_b128 v[236:239], v4 offset:17408
    v_cvt_pk_bf16_f32 v90, v192, v193
    v_exp_f32 v196, v196
    s_waitcnt lgkmcnt(3)
    v_mfma_f32_16x16x32_bf16 v[200:203], v[224:227], v[164:167], v[200:203]
    v_exp_f32 v197, v197
    v_cvt_pk_bf16_f32 v91, v194, v195
    v_mfma_f32_16x16x32_bf16 v[204:207], v[224:227], v[180:183], v[204:207]
    ds_read_b128 v[240:243], v4 offset:18432
    v_exp_f32 v198, v198
    s_waitcnt lgkmcnt(3)
    v_mfma_f32_16x16x32_bf16 v[208:211], v[228:231], v[164:167], v[208:211]
    v_exp_f32 v199, v199
    v_cvt_pk_bf16_f32 v94, v196, v197
    v_mfma_f32_16x16x32_bf16 v[212:215], v[228:231], v[180:183], v[212:215]
    ds_read_b128 v[244:247], v4 offset:19456
    v_cvt_pk_bf16_f32 v95, v198, v199
    s_waitcnt lgkmcnt(3)
    v_mfma_f32_16x16x32_bf16 v[184:187], v[232:235], v[152:155], v[216:219]
    v_mfma_f32_16x16x32_bf16 v[188:191], v[232:235], v[168:171], v[220:223]
    ds_read_b128 v[224:227], v4 offset:20480
    v_exp_f32 v200, v200
    v_exp_f32 v201, v201
    v_mfma_f32_16x16x32_bf16 v[248:251], v[12:15], v[88:91], v[248:251]
    s_waitcnt lgkmcnt(3)
    v_mfma_f32_16x16x32_bf16 v[192:195], v[236:239], v[152:155], v[216:219]
    v_exp_f32 v202, v202
    v_exp_f32 v203, v203
    v_mfma_f32_16x16x32_bf16 v[196:199], v[236:239], v[168:171], v[220:223]
    s_add_u32 s22, s21, 0x84400
    s_add_u32 m0, s20, 0x24400
    s_nop 0
    buffer_load_dwordx4 v2, s[8:11], s22 offen sc1 lds
    ds_read_b128 v[228:231], v4 offset:21504
    v_cvt_pk_bf16_f32 v96, v200, v201
    s_add_u32 s22, s18, 14336
    s_add_u32 m0, s15, 2048
    s_nop 0
    buffer_load_dwordx4 v11, s[64:67], s22 offen lds
    v_mfma_f32_16x16x32_bf16 v[252:255], v[12:15], v[92:95], v[252:255]
    s_waitcnt lgkmcnt(3)
    v_mfma_f32_16x16x32_bf16 v[184:187], v[240:243], v[156:159], v[184:187]
    v_exp_f32 v204, v204
    v_exp_f32 v205, v205
    v_mfma_f32_16x16x32_bf16 v[188:191], v[240:243], v[172:175], v[188:191]
    ds_read_b128 v[232:235], v4 offset:22528
    v_cvt_pk_bf16_f32 v97, v202, v203
    s_waitcnt lgkmcnt(3)
    v_mfma_f32_16x16x32_bf16 v[192:195], v[244:247], v[156:159], v[192:195]
    v_exp_f32 v206, v206
    v_exp_f32 v207, v207
    v_mfma_f32_16x16x32_bf16 v[196:199], v[244:247], v[172:175], v[196:199]
    ds_read_b128 v[236:239], v4 offset:23552
    v_cvt_pk_bf16_f32 v100, v204, v205
    v_exp_f32 v208, v208
    s_waitcnt lgkmcnt(3)
    v_mfma_f32_16x16x32_bf16 v[184:187], v[224:227], v[160:163], v[184:187]
    v_exp_f32 v209, v209
    v_mfma_f32_16x16x32_bf16 v[188:191], v[224:227], v[176:179], v[188:191]
    ds_read_b128 v[240:243], v4 offset:24576
    v_cvt_pk_bf16_f32 v101, v206, v207
    v_exp_f32 v210, v210
    s_waitcnt lgkmcnt(3)
    v_mfma_f32_16x16x32_bf16 v[192:195], v[228:231], v[160:163], v[192:195]
    v_exp_f32 v211, v211
    v_mfma_f32_16x16x32_bf16 v[196:199], v[228:231], v[176:179], v[196:199]
    ds_read_b128 v[244:247], v4 offset:25600
    v_cvt_pk_bf16_f32 v98, v208, v209
    v_exp_f32 v212, v212
    s_waitcnt lgkmcnt(3)
    v_mfma_f32_16x16x32_bf16 v[184:187], v[232:235], v[164:167], v[184:187]
    v_exp_f32 v213, v213
    v_cvt_pk_bf16_f32 v99, v210, v211
    v_mfma_f32_16x16x32_bf16 v[188:191], v[232:235], v[180:183], v[188:191]
    ds_read_b128 v[224:227], v4 offset:26624
    v_exp_f32 v214, v214
    s_waitcnt lgkmcnt(3)
    v_mfma_f32_16x16x32_bf16 v[192:195], v[236:239], v[164:167], v[192:195]
    v_exp_f32 v215, v215
    v_cvt_pk_bf16_f32 v102, v212, v213
    v_mfma_f32_16x16x32_bf16 v[196:199], v[236:239], v[180:183], v[196:199]
    ds_read_b128 v[228:231], v4 offset:27648
    v_cvt_pk_bf16_f32 v103, v214, v215
    s_waitcnt lgkmcnt(3)
    v_mfma_f32_16x16x32_bf16 v[200:203], v[240:243], v[152:155], v[216:219]
    v_mfma_f32_16x16x32_bf16 v[204:207], v[240:243], v[168:171], v[220:223]
    ds_read_b128 v[232:235], v4 offset:28672
    v_exp_f32 v184, v184
    v_exp_f32 v185, v185
    v_mfma_f32_16x16x32_bf16 v[248:251], v[12:15], v[96:99], v[248:251]
    s_waitcnt lgkmcnt(3)
    v_mfma_f32_16x16x32_bf16 v[208:211], v[244:247], v[152:155], v[216:219]
    v_exp_f32 v186, v186
    v_exp_f32 v187, v187
    s_add_u32 s22, s18, 21504
    s_add_u32 m0, s15, 3072
    s_nop 0
    buffer_load_dwordx4 v11, s[64:67], s22 offen lds
    v_mfma_f32_16x16x32_bf16 v[212:215], v[244:247], v[168:171], v[220:223]
    ds_read_b128 v[236:239], v4 offset:29696
    v_cvt_pk_bf16_f32 v104, v184, v185
    v_mfma_f32_16x16x32_bf16 v[252:255], v[12:15], v[100:103], v[252:255]
    s_waitcnt lgkmcnt(3)
    v_mfma_f32_16x16x32_bf16 v[200:203], v[224:227], v[156:159], v[200:203]
    v_exp_f32 v188, v188
    v_exp_f32 v189, v189
    v_mfma_f32_16x16x32_bf16 v[204:207], v[224:227], v[172:175], v[204:207]
    ds_read_b128 v[240:243], v4 offset:30720
    v_cvt_pk_bf16_f32 v105, v186, v187
    s_waitcnt lgkmcnt(3)
    v_mfma_f32_16x16x32_bf16 v[208:211], v[228:231], v[156:159], v[208:211]
    v_exp_f32 v190, v190
    v_exp_f32 v191, v191
    v_mfma_f32_16x16x32_bf16 v[212:215], v[228:231], v[172:175], v[212:215]
    ds_read_b128 v[244:247], v4 offset:31744
    v_cvt_pk_bf16_f32 v108, v188, v189
    v_exp_f32 v192, v192
    s_waitcnt lgkmcnt(3)
    v_mfma_f32_16x16x32_bf16 v[200:203], v[232:235], v[160:163], v[200:203]
    v_exp_f32 v193, v193
    v_mfma_f32_16x16x32_bf16 v[204:207], v[232:235], v[176:179], v[204:207]
    s_waitcnt vmcnt(10)
    s_barrier
    ds_read_b128 v[224:227], v4 offset:32768
    v_cvt_pk_bf16_f32 v109, v190, v191
    v_exp_f32 v194, v194
    s_waitcnt lgkmcnt(3)
    v_mfma_f32_16x16x32_bf16 v[208:211], v[236:239], v[160:163], v[208:211]
    v_exp_f32 v195, v195
    v_mfma_f32_16x16x32_bf16 v[212:215], v[236:239], v[176:179], v[212:215]
    s_add_u32 s22, s21, 0x88000
    s_add_u32 m0, s20, 0x10000
    s_nop 0
    buffer_load_dwordx4 v2, s[8:11], s22 offen sc1 lds
    ds_read_b128 v[228:231], v4 offset:33792
    v_cvt_pk_bf16_f32 v106, v192, v193
    v_exp_f32 v196, v196
    s_waitcnt lgkmcnt(3)
    v_mfma_f32_16x16x32_bf16 v[200:203], v[240:243], v[164:167], v[200:203]
    v_exp_f32 v197, v197
    v_cvt_pk_bf16_f32 v107, v194, v195
    v_mfma_f32_16x16x32_bf16 v[204:207], v[240:243], v[180:183], v[204:207]
    ds_read_b128 v[232:235], v4 offset:34816
    v_exp_f32 v198, v198
    s_waitcnt lgkmcnt(3)
    v_mfma_f32_16x16x32_bf16 v[208:211], v[244:247], v[164:167], v[208:211]
    v_exp_f32 v199, v199
    v_cvt_pk_bf16_f32 v110, v196, v197
    v_mfma_f32_16x16x32_bf16 v[212:215], v[244:247], v[180:183], v[212:215]
    ds_read_b128 v[236:239], v4 offset:35840
    v_cvt_pk_bf16_f32 v111, v198, v199
    s_waitcnt lgkmcnt(3)
    v_mfma_f32_16x16x32_bf16 v[184:187], v[224:227], v[152:155], v[216:219]
    v_mfma_f32_16x16x32_bf16 v[188:191], v[224:227], v[168:171], v[220:223]
    ds_read_b128 v[240:243], v4 offset:36864
    v_exp_f32 v200, v200
    v_exp_f32 v201, v201
    v_mfma_f32_16x16x32_bf16 v[248:251], v[12:15], v[104:107], v[248:251]
    s_waitcnt lgkmcnt(3)
    v_mfma_f32_16x16x32_bf16 v[192:195], v[228:231], v[152:155], v[216:219]
    v_exp_f32 v202, v202
    v_exp_f32 v203, v203
    s_add_u32 s22, s18, 28672
    s_add_u32 m0, s15, 4096
    s_nop 0
    buffer_load_dwordx4 v11, s[64:67], s22 offen lds
    v_mfma_f32_16x16x32_bf16 v[196:199], v[228:231], v[168:171], v[220:223]
    s_add_u32 s22, s21, 0x88400
    s_add_u32 m0, s20, 0x10400
    s_nop 0
    buffer_load_dwordx4 v2, s[8:11], s22 offen sc1 lds
    ds_read_b128 v[244:247], v4 offset:37888
    v_cvt_pk_bf16_f32 v112, v200, v201
    v_mfma_f32_16x16x32_bf16 v[252:255], v[12:15], v[108:111], v[252:255]
    s_waitcnt lgkmcnt(3)
    v_mfma_f32_16x16x32_bf16 v[184:187], v[232:235], v[156:159], v[184:187]
    v_exp_f32 v204, v204
    v_exp_f32 v205, v205
    v_mfma_f32_16x16x32_bf16 v[188:191], v[232:235], v[172:175], v[188:191]
    ds_read_b128 v[224:227], v4 offset:38912
    v_cvt_pk_bf16_f32 v113, v202, v203
    s_waitcnt lgkmcnt(3)
    v_mfma_f32_16x16x32_bf16 v[192:195], v[236:239], v[156:159], v[192:195]
    v_exp_f32 v206, v206
    v_exp_f32 v207, v207
    v_mfma_f32_16x16x32_bf16 v[196:199], v[236:239], v[172:175], v[196:199]
    ds_read_b128 v[228:231], v4 offset:39936
    v_cvt_pk_bf16_f32 v116, v204, v205
    v_exp_f32 v208, v208
    s_waitcnt lgkmcnt(3)
    v_mfma_f32_16x16x32_bf16 v[184:187], v[240:243], v[160:163], v[184:187]
    v_exp_f32 v209, v209
    v_mfma_f32_16x16x32_bf16 v[188:191], v[240:243], v[176:179], v[188:191]
    ds_read_b128 v[232:235], v4 offset:40960
    v_cvt_pk_bf16_f32 v117, v206, v207
    v_exp_f32 v210, v210
    s_waitcnt lgkmcnt(3)
    v_mfma_f32_16x16x32_bf16 v[192:195], v[244:247], v[160:163], v[192:195]
    v_exp_f32 v211, v211
    v_mfma_f32_16x16x32_bf16 v[196:199], v[244:247], v[176:179], v[196:199]
    ds_read_b128 v[236:239], v4 offset:41984
    v_cvt_pk_bf16_f32 v114, v208, v209
    v_exp_f32 v212, v212
    s_waitcnt lgkmcnt(3)
    v_mfma_f32_16x16x32_bf16 v[184:187], v[224:227], v[164:167], v[184:187]
    v_exp_f32 v213, v213
    v_cvt_pk_bf16_f32 v115, v210, v211
    v_mfma_f32_16x16x32_bf16 v[188:191], v[224:227], v[180:183], v[188:191]
    ds_read_b128 v[240:243], v4 offset:43008
    v_exp_f32 v214, v214
    s_waitcnt lgkmcnt(3)
    v_mfma_f32_16x16x32_bf16 v[192:195], v[228:231], v[164:167], v[192:195]
    v_exp_f32 v215, v215
    v_cvt_pk_bf16_f32 v118, v212, v213
    v_mfma_f32_16x16x32_bf16 v[196:199], v[228:231], v[180:183], v[196:199]
    ds_read_b128 v[244:247], v4 offset:44032
    v_cvt_pk_bf16_f32 v119, v214, v215
    s_waitcnt lgkmcnt(3)
    v_mfma_f32_16x16x32_bf16 v[200:203], v[232:235], v[152:155], v[216:219]
    v_mfma_f32_16x16x32_bf16 v[204:207], v[232:235], v[168:171], v[220:223]
    ds_read_b128 v[224:227], v4 offset:45056
    v_exp_f32 v184, v184
    v_exp_f32 v185, v185
    s_add_u32 s22, s18, 35840
    s_add_u32 m0, s15, 5120
    s_nop 0
    buffer_load_dwordx4 v11, s[64:67], s22 offen lds
    v_mfma_f32_16x16x32_bf16 v[248:251], v[12:15], v[112:115], v[248:251]
    s_waitcnt lgkmcnt(3)
    v_mfma_f32_16x16x32_bf16 v[208:211], v[236:239], v[152:155], v[216:219]
    v_exp_f32 v186, v186
    v_exp_f32 v187, v187
    v_mfma_f32_16x16x32_bf16 v[212:215], v[236:239], v[168:171], v[220:223]
    ds_read_b128 v[228:231], v4 offset:46080
    v_cvt_pk_bf16_f32 v120, v184, v185
    v_mfma_f32_16x16x32_bf16 v[252:255], v[12:15], v[116:119], v[252:255]
    s_waitcnt lgkmcnt(3)
    v_mfma_f32_16x16x32_bf16 v[200:203], v[240:243], v[156:159], v[200:203]
    v_exp_f32 v188, v188
    v_exp_f32 v189, v189
    v_mfma_f32_16x16x32_bf16 v[204:207], v[240:243], v[172:175], v[204:207]
    ds_read_b128 v[232:235], v4 offset:47104
    v_cvt_pk_bf16_f32 v121, v186, v187
    s_waitcnt lgkmcnt(3)
    v_mfma_f32_16x16x32_bf16 v[208:211], v[244:247], v[156:159], v[208:211]
    v_exp_f32 v190, v190
    v_exp_f32 v191, v191
    v_mfma_f32_16x16x32_bf16 v[212:215], v[244:247], v[172:175], v[212:215]
    ds_read_b128 v[236:239], v4 offset:48128
    v_cvt_pk_bf16_f32 v124, v188, v189
    v_exp_f32 v192, v192
    s_waitcnt lgkmcnt(3)
    v_mfma_f32_16x16x32_bf16 v[200:203], v[224:227], v[160:163], v[200:203]
    v_exp_f32 v193, v193
    v_mfma_f32_16x16x32_bf16 v[204:207], v[224:227], v[176:179], v[204:207]
    s_waitcnt vmcnt(12)
    s_barrier
    ds_read_b128 v[240:243], v4 offset:49152
    v_cvt_pk_bf16_f32 v125, v190, v191
    v_exp_f32 v194, v194
    s_waitcnt lgkmcnt(3)
    v_mfma_f32_16x16x32_bf16 v[208:211], v[228:231], v[160:163], v[208:211]
    v_exp_f32 v195, v195
    v_mfma_f32_16x16x32_bf16 v[212:215], v[228:231], v[176:179], v[212:215]
    s_add_u32 s22, s21, 0x8c000
    s_add_u32 m0, s20, 0x14000
    s_nop 0
    buffer_load_dwordx4 v2, s[8:11], s22 offen sc1 lds
    ds_read_b128 v[244:247], v4 offset:50176
    v_cvt_pk_bf16_f32 v122, v192, v193
    v_exp_f32 v196, v196
    s_waitcnt lgkmcnt(3)
    v_mfma_f32_16x16x32_bf16 v[200:203], v[232:235], v[164:167], v[200:203]
    v_exp_f32 v197, v197
    v_cvt_pk_bf16_f32 v123, v194, v195
    v_mfma_f32_16x16x32_bf16 v[204:207], v[232:235], v[180:183], v[204:207]
    ds_read_b128 v[224:227], v4 offset:51200
    v_exp_f32 v198, v198
    s_waitcnt lgkmcnt(3)
    v_mfma_f32_16x16x32_bf16 v[208:211], v[236:239], v[164:167], v[208:211]
    v_exp_f32 v199, v199
    v_cvt_pk_bf16_f32 v126, v196, v197
    v_mfma_f32_16x16x32_bf16 v[212:215], v[236:239], v[180:183], v[212:215]
    ds_read_b128 v[228:231], v4 offset:52224
    v_cvt_pk_bf16_f32 v127, v198, v199
    s_waitcnt lgkmcnt(3)
    v_mfma_f32_16x16x32_bf16 v[184:187], v[240:243], v[152:155], v[216:219]
    v_mfma_f32_16x16x32_bf16 v[188:191], v[240:243], v[168:171], v[220:223]
    ds_read_b128 v[232:235], v4 offset:53248
    v_exp_f32 v200, v200
    v_exp_f32 v201, v201
    s_add_u32 s22, s18, 43008
    s_add_u32 m0, s15, 6144
    s_nop 0
    buffer_load_dwordx4 v11, s[64:67], s22 offen lds
    v_mfma_f32_16x16x32_bf16 v[248:251], v[12:15], v[120:123], v[248:251]
    s_waitcnt lgkmcnt(3)
    v_mfma_f32_16x16x32_bf16 v[192:195], v[244:247], v[152:155], v[216:219]
    v_exp_f32 v202, v202
    v_exp_f32 v203, v203
    v_mfma_f32_16x16x32_bf16 v[196:199], v[244:247], v[168:171], v[220:223]
    s_add_u32 s22, s21, 0x8c400
    s_add_u32 m0, s20, 0x14400
    s_nop 0
    buffer_load_dwordx4 v2, s[8:11], s22 offen sc1 lds
    ds_read_b128 v[236:239], v4 offset:54272
    v_cvt_pk_bf16_f32 v128, v200, v201
    v_mfma_f32_16x16x32_bf16 v[252:255], v[12:15], v[124:127], v[252:255]
    s_waitcnt lgkmcnt(3)
    v_mfma_f32_16x16x32_bf16 v[184:187], v[224:227], v[156:159], v[184:187]
    v_exp_f32 v204, v204
    v_exp_f32 v205, v205
    v_mfma_f32_16x16x32_bf16 v[188:191], v[224:227], v[172:175], v[188:191]
    ds_read_b128 v[240:243], v4 offset:55296
    v_cvt_pk_bf16_f32 v129, v202, v203
    s_waitcnt lgkmcnt(3)
    v_mfma_f32_16x16x32_bf16 v[192:195], v[228:231], v[156:159], v[192:195]
    v_exp_f32 v206, v206
    v_exp_f32 v207, v207
    v_mfma_f32_16x16x32_bf16 v[196:199], v[228:231], v[172:175], v[196:199]
    ds_read_b128 v[244:247], v4 offset:56320
    v_cvt_pk_bf16_f32 v132, v204, v205
    v_exp_f32 v208, v208
    s_waitcnt lgkmcnt(3)
    v_mfma_f32_16x16x32_bf16 v[184:187], v[232:235], v[160:163], v[184:187]
    v_exp_f32 v209, v209
    v_mfma_f32_16x16x32_bf16 v[188:191], v[232:235], v[176:179], v[188:191]
    ds_read_b128 v[224:227], v4 offset:57344
    v_cvt_pk_bf16_f32 v133, v206, v207
    v_exp_f32 v210, v210
    s_waitcnt lgkmcnt(3)
    v_mfma_f32_16x16x32_bf16 v[192:195], v[236:239], v[160:163], v[192:195]
    v_exp_f32 v211, v211
    v_mfma_f32_16x16x32_bf16 v[196:199], v[236:239], v[176:179], v[196:199]
    ds_read_b128 v[228:231], v4 offset:58368
    v_cvt_pk_bf16_f32 v130, v208, v209
    v_exp_f32 v212, v212
    s_waitcnt lgkmcnt(3)
    v_mfma_f32_16x16x32_bf16 v[184:187], v[240:243], v[164:167], v[184:187]
    v_exp_f32 v213, v213
    v_cvt_pk_bf16_f32 v131, v210, v211
    v_mfma_f32_16x16x32_bf16 v[188:191], v[240:243], v[180:183], v[188:191]
    ds_read_b128 v[232:235], v4 offset:59392
    v_exp_f32 v214, v214
    s_waitcnt lgkmcnt(3)
    v_mfma_f32_16x16x32_bf16 v[192:195], v[244:247], v[164:167], v[192:195]
    v_exp_f32 v215, v215
    v_cvt_pk_bf16_f32 v134, v212, v213
    v_mfma_f32_16x16x32_bf16 v[196:199], v[244:247], v[180:183], v[196:199]
    ds_read_b128 v[236:239], v4 offset:60416
    v_cvt_pk_bf16_f32 v135, v214, v215
    s_waitcnt lgkmcnt(3)
    v_mfma_f32_16x16x32_bf16 v[200:203], v[224:227], v[152:155], v[216:219]
    s_add_u32 s22, s18, 50176
    s_add_u32 m0, s15, 7168
    s_nop 0
    buffer_load_dwordx4 v11, s[64:67], s22 offen lds
    v_mfma_f32_16x16x32_bf16 v[204:207], v[224:227], v[168:171], v[220:223]
    ds_read_b128 v[240:243], v4 offset:61440
    v_exp_f32 v184, v184
    v_exp_f32 v185, v185
    v_mfma_f32_16x16x32_bf16 v[248:251], v[12:15], v[128:131], v[248:251]
    s_waitcnt lgkmcnt(3)
    v_mfma_f32_16x16x32_bf16 v[208:211], v[228:231], v[152:155], v[216:219]
    v_exp_f32 v186, v186
    v_exp_f32 v187, v187
    v_mfma_f32_16x16x32_bf16 v[212:215], v[228:231], v[168:171], v[220:223]
    ds_read_b128 v[244:247], v4 offset:62464
    v_cvt_pk_bf16_f32 v136, v184, v185
    v_mfma_f32_16x16x32_bf16 v[252:255], v[12:15], v[132:135], v[252:255]
    s_waitcnt lgkmcnt(3)
    v_mfma_f32_16x16x32_bf16 v[200:203], v[232:235], v[156:159], v[200:203]
    v_exp_f32 v188, v188
    v_exp_f32 v189, v189
    v_mfma_f32_16x16x32_bf16 v[204:207], v[232:235], v[172:175], v[204:207]
    ds_read_b128 v[224:227], v4 offset:63488
    v_cvt_pk_bf16_f32 v137, v186, v187
    s_waitcnt lgkmcnt(3)
    v_mfma_f32_16x16x32_bf16 v[208:211], v[236:239], v[156:159], v[208:211]
    v_exp_f32 v190, v190
    v_exp_f32 v191, v191
    v_mfma_f32_16x16x32_bf16 v[212:215], v[236:239], v[172:175], v[212:215]
    ds_read_b128 v[228:231], v4 offset:64512
    v_cvt_pk_bf16_f32 v140, v188, v189
    v_exp_f32 v192, v192
    s_waitcnt lgkmcnt(3)
    v_mfma_f32_16x16x32_bf16 v[200:203], v[240:243], v[160:163], v[200:203]
    v_exp_f32 v193, v193
    v_mfma_f32_16x16x32_bf16 v[204:207], v[240:243], v[176:179], v[204:207]
    v_cvt_pk_bf16_f32 v141, v190, v191
    v_exp_f32 v194, v194
    s_waitcnt lgkmcnt(2)
    v_mfma_f32_16x16x32_bf16 v[208:211], v[244:247], v[160:163], v[208:211]
    v_exp_f32 v195, v195
    v_mfma_f32_16x16x32_bf16 v[212:215], v[244:247], v[176:179], v[212:215]
    v_cvt_pk_bf16_f32 v138, v192, v193
    v_exp_f32 v196, v196
    s_waitcnt lgkmcnt(1)
    v_mfma_f32_16x16x32_bf16 v[200:203], v[224:227], v[164:167], v[200:203]
    v_exp_f32 v197, v197
    v_cvt_pk_bf16_f32 v139, v194, v195
    v_mfma_f32_16x16x32_bf16 v[204:207], v[224:227], v[180:183], v[204:207]
    v_exp_f32 v198, v198
    s_waitcnt lgkmcnt(0)
    v_mfma_f32_16x16x32_bf16 v[208:211], v[228:231], v[164:167], v[208:211]
    v_exp_f32 v199, v199
    v_cvt_pk_bf16_f32 v142, v196, v197
    v_mfma_f32_16x16x32_bf16 v[212:215], v[228:231], v[180:183], v[212:215]
    v_cvt_pk_bf16_f32 v143, v198, v199
    s_waitcnt vmcnt(14)
    s_barrier
    ds_read_b128 v[232:235], v5 offset:0
    ds_read_b128 v[236:239], v5 offset:1024
    ds_read_b128 v[240:243], v5 offset:2048
    ds_read_b128 v[244:247], v5 offset:3072
    v_mfma_f32_16x16x32_bf16 v[248:251], v[12:15], v[136:139], v[248:251]
    v_mfma_f32_16x16x32_bf16 v[252:255], v[12:15], v[140:143], v[252:255]
    v_exp_f32 v200, v200
    v_exp_f32 v201, v201
    v_exp_f32 v202, v202
    v_exp_f32 v203, v203
    v_cvt_pk_bf16_f32 v144, v200, v201
    v_exp_f32 v204, v204
    v_exp_f32 v205, v205
    v_cvt_pk_bf16_f32 v145, v202, v203
    v_exp_f32 v206, v206
    v_exp_f32 v207, v207
    v_cvt_pk_bf16_f32 v148, v204, v205
    v_exp_f32 v208, v208
    v_exp_f32 v209, v209
    v_cvt_pk_bf16_f32 v149, v206, v207
    v_exp_f32 v210, v210
    v_exp_f32 v211, v211
    v_cvt_pk_bf16_f32 v146, v208, v209
    v_exp_f32 v212, v212
    v_exp_f32 v213, v213
    v_cvt_pk_bf16_f32 v147, v210, v211
    v_exp_f32 v214, v214
    v_exp_f32 v215, v215
    v_cvt_pk_bf16_f32 v150, v212, v213
    v_cvt_pk_bf16_f32 v151, v214, v215
    v_mfma_f32_16x16x32_bf16 v[248:251], v[12:15], v[144:147], v[248:251]
    s_nop 0
    v_mfma_f32_16x16x32_bf16 v[252:255], v[12:15], v[148:151], v[252:255]
    s_nop 5
    v_mov_b32 v9, v248
    s_nop 0
    v_mov_b32 v10, v252
    v_max_f32 v17, v9, v10
    v_readfirstlane_b32 s17, v8
    s_cmp_eq_u32 s17, s28
    s_cselect_b32 s16, 0, 0x71800000
    v_cmp_ngt_f32 vcc, s16, v17
    v_cmp_u_f32 s[76:77], v9, v10
    s_or_b64 vcc, vcc, s[76:77]
    s_cbranch_vccnz adaLN_cond__sliding_block_cached__moe_arch_mod__prompt_kernel_fixB
adaLN_cond__sliding_block_cached__moe_arch_mod__prompt_kernel_fixBb:
    v_rcp_f32 v9, v9
    v_rcp_f32 v10, v10
    s_lshl_b32 s25, s13, 3
    s_add_u32 s25, s25, s3
    s_lshl_b32 s25, s25, 18
    s_lshl_b32 s26, s12, 12
    s_add_u32 s25, s25, s26
    s_add_u32 s25, s25, 0x1000000
    s_add_u32 s26, s25, 131072
    s_lshl_b32 s63, s13, 3
    s_add_u32 s63, s63, s3
    s_lshl_b32 s63, s63, 5
    s_add_u32 s63, s63, s12
    s_lshl_b32 s63, s63, 2
    s_waitcnt lgkmcnt(3)
    v_mfma_f32_16x16x32_bf16 v[184:187], v[232:235], v[24:27], 0
    v_mfma_f32_16x16x32_bf16 v[188:191], v[232:235], v[28:31], 0
    ds_read_b128 v[224:227], v5 offset:4096
    s_waitcnt lgkmcnt(3)
    v_mfma_f32_16x16x32_bf16 v[192:195], v[236:239], v[24:27], 0
    s_add_u32 s22, s21, 0x90000
    s_add_u32 m0, s20, 0x18000
    s_nop 0
    buffer_load_dwordx4 v2, s[8:11], s22 offen sc1 lds
    v_mfma_f32_16x16x32_bf16 v[196:199], v[236:239], v[28:31], 0
    ds_read_b128 v[228:231], v5 offset:5120
    s_waitcnt lgkmcnt(3)
    v_mfma_f32_16x16x32_bf16 v[184:187], v[240:243], v[32:35], v[184:187]
    v_mfma_f32_16x16x32_bf16 v[188:191], v[240:243], v[36:39], v[188:191]
    ds_read_b128 v[232:235], v5 offset:6144
    s_waitcnt lgkmcnt(3)
    v_mfma_f32_16x16x32_bf16 v[192:195], v[244:247], v[32:35], v[192:195]
    v_mfma_f32_16x16x32_bf16 v[196:199], v[244:247], v[36:39], v[196:199]
    ds_read_b128 v[236:239], v5 offset:7168
    s_waitcnt lgkmcnt(3)
    v_mfma_f32_16x16x32_bf16 v[184:187], v[224:227], v[40:43], v[184:187]
    v_mfma_f32_16x16x32_bf16 v[188:191], v[224:227], v[44:47], v[188:191]
    ds_read_b128 v[240:243], v5 offset:8192
    s_waitcnt lgkmcnt(3)
    v_mfma_f32_16x16x32_bf16 v[192:195], v[228:231], v[40:43], v[192:195]
    s_add_u32 s22, s21, 0x90400
    s_add_u32 m0, s20, 0x18400
    s_nop 0
    buffer_load_dwordx4 v2, s[8:11], s22 offen sc1 lds
    v_mfma_f32_16x16x32_bf16 v[196:199], v[228:231], v[44:47], v[196:199]
    ds_read_b128 v[244:247], v5 offset:9216
    s_waitcnt lgkmcnt(3)
    v_mfma_f32_16x16x32_bf16 v[184:187], v[232:235], v[48:51], v[184:187]
    v_mfma_f32_16x16x32_bf16 v[188:191], v[232:235], v[52:55], v[188:191]
    ds_read_b128 v[224:227], v5 offset:10240
    s_waitcnt lgkmcnt(3)
    v_mfma_f32_16x16x32_bf16 v[192:195], v[236:239], v[48:51], v[192:195]
    v_mfma_f32_16x16x32_bf16 v[196:199], v[236:239], v[52:55], v[196:199]
    ds_read_b128 v[228:231], v5 offset:11264
    s_waitcnt lgkmcnt(3)
    v_mfma_f32_16x16x32_bf16 v[184:187], v[240:243], v[56:59], v[184:187]
    v_mfma_f32_16x16x32_bf16 v[188:191], v[240:243], v[60:63], v[188:191]
    ds_read_b128 v[232:235], v5 offset:12288
    s_waitcnt lgkmcnt(3)
    v_mfma_f32_16x16x32_bf16 v[192:195], v[244:247], v[56:59], v[192:195]
    v_mfma_f32_16x16x32_bf16 v[196:199], v[244:247], v[60:63], v[196:199]
    ds_read_b128 v[236:239], v5 offset:13312
    s_waitcnt lgkmcnt(3)
    v_mfma_f32_16x16x32_bf16 v[184:187], v[224:227], v[64:67], v[184:187]
    v_mfma_f32_16x16x32_bf16 v[188:191], v[224:227], v[68:71], v[188:191]
    ds_read_b128 v[240:243], v5 offset:14336
    s_waitcnt lgkmcnt(3)
    v_mfma_f32_16x16x32_bf16 v[192:195], v[228:231], v[64:67], v[192:195]
    v_mfma_f32_16x16x32_bf16 v[196:199], v[228:231], v[68:71], v[196:199]
    ds_read_b128 v[244:247], v5 offset:15360
    s_waitcnt lgkmcnt(3)
    v_mfma_f32_16x16x32_bf16 v[184:187], v[232:235], v[72:75], v[184:187]
    v_mfma_f32_16x16x32_bf16 v[188:191], v[232:235], v[76:79], v[188:191]
    s_waitcnt vmcnt(12)
    s_barrier
    ds_read_b128 v[224:227], v5 offset:16384
    s_waitcnt lgkmcnt(3)
    v_mfma_f32_16x16x32_bf16 v[192:195], v[236:239], v[72:75], v[192:195]
    v_mfma_f32_16x16x32_bf16 v[196:199], v[236:239], v[76:79], v[196:199]
    s_add_u32 s22, s21, 0x94000
    s_add_u32 m0, s20, 0x1c000
    s_nop 0
    buffer_load_dwordx4 v2, s[8:11], s22 offen sc1 lds
    ds_read_b128 v[228:231], v5 offset:17408
    s_waitcnt lgkmcnt(3)
    v_mfma_f32_16x16x32_bf16 v[184:187], v[240:243], v[80:83], v[184:187]
    v_mfma_f32_16x16x32_bf16 v[188:191], v[240:243], v[84:87], v[188:191]
    ds_read_b128 v[232:235], v5 offset:18432
    s_waitcnt lgkmcnt(3)
    v_mfma_f32_16x16x32_bf16 v[192:195], v[244:247], v[80:83], v[192:195]
    v_mfma_f32_16x16x32_bf16 v[196:199], v[244:247], v[84:87], v[196:199]
    ds_read_b128 v[236:239], v5 offset:19456
    s_waitcnt lgkmcnt(3)
    v_mfma_f32_16x16x32_bf16 v[184:187], v[224:227], v[88:91], v[184:187]
    v_mfma_f32_16x16x32_bf16 v[188:191], v[224:227], v[92:95], v[188:191]
    ds_read_b128 v[240:243], v5 offset:20480
    s_waitcnt lgkmcnt(3)
    v_mfma_f32_16x16x32_bf16 v[192:195], v[228:231], v[88:91], v[192:195]
    v_mfma_f32_16x16x32_bf16 v[196:199], v[228:231], v[92:95], v[196:199]
    s_add_u32 s22, s21, 0x94400
    s_add_u32 m0, s20, 0x1c400
    s_nop 0
    buffer_load_dwordx4 v2, s[8:11], s22 offen sc1 lds
    ds_read_b128 v[244:247], v5 offset:21504
    s_waitcnt lgkmcnt(3)
    v_mfma_f32_16x16x32_bf16 v[184:187], v[232:235], v[96:99], v[184:187]
    v_mfma_f32_16x16x32_bf16 v[188:191], v[232:235], v[100:103], v[188:191]
    ds_read_b128 v[224:227], v5 offset:22528
    s_waitcnt lgkmcnt(3)
    v_mfma_f32_16x16x32_bf16 v[192:195], v[236:239], v[96:99], v[192:195]
    v_mfma_f32_16x16x32_bf16 v[196:199], v[236:239], v[100:103], v[196:199]
    ds_read_b128 v[228:231], v5 offset:23552
    s_waitcnt lgkmcnt(3)
    v_mfma_f32_16x16x32_bf16 v[184:187], v[240:243], v[104:107], v[184:187]
    v_mfma_f32_16x16x32_bf16 v[188:191], v[240:243], v[108:111], v[188:191]
    ds_read_b128 v[232:235], v5 offset:24576
    s_waitcnt lgkmcnt(3)
    v_mfma_f32_16x16x32_bf16 v[192:195], v[244:247], v[104:107], v[192:195]
    v_mfma_f32_16x16x32_bf16 v[196:199], v[244:247], v[108:111], v[196:199]
    ds_read_b128 v[236:239], v5 offset:25600
    s_waitcnt lgkmcnt(3)
    v_mfma_f32_16x16x32_bf16 v[184:187], v[224:227], v[112:115], v[184:187]
    v_mfma_f32_16x16x32_bf16 v[188:191], v[224:227], v[116:119], v[188:191]
    ds_read_b128 v[240:243], v5 offset:26624
    s_waitcnt lgkmcnt(3)
    v_mfma_f32_16x16x32_bf16 v[192:195], v[228:231], v[112:115], v[192:195]
    v_mfma_f32_16x16x32_bf16 v[196:199], v[228:231], v[116:119], v[196:199]
    ds_read_b128 v[244:247], v5 offset:27648
    s_waitcnt lgkmcnt(3)
    v_mfma_f32_16x16x32_bf16 v[184:187], v[232:235], v[120:123], v[184:187]
    v_mfma_f32_16x16x32_bf16 v[188:191], v[232:235], v[124:127], v[188:191]
    ds_read_b128 v[224:227], v5 offset:28672
    s_waitcnt lgkmcnt(3)
    v_mfma_f32_16x16x32_bf16 v[192:195], v[236:239], v[120:123], v[192:195]
    v_mfma_f32_16x16x32_bf16 v[196:199], v[236:239], v[124:127], v[196:199]
    ds_read_b128 v[228:231], v5 offset:29696
    s_waitcnt lgkmcnt(3)
    v_mfma_f32_16x16x32_bf16 v[184:187], v[240:243], v[128:131], v[184:187]
    v_mfma_f32_16x16x32_bf16 v[188:191], v[240:243], v[132:135], v[188:191]
    ds_read_b128 v[232:235], v5 offset:30720
    s_waitcnt lgkmcnt(3)
    v_mfma_f32_16x16x32_bf16 v[192:195], v[244:247], v[128:131], v[192:195]
    v_mfma_f32_16x16x32_bf16 v[196:199], v[244:247], v[132:135], v[196:199]
    ds_read_b128 v[236:239], v5 offset:31744
    s_waitcnt lgkmcnt(3)
    v_mfma_f32_16x16x32_bf16 v[184:187], v[224:227], v[136:139], v[184:187]
    v_mfma_f32_16x16x32_bf16 v[188:191], v[224:227], v[140:143], v[188:191]
    s_waitcnt vmcnt(9)
    s_barrier
    ds_read_b128 v[240:243], v4 offset:0
    s_waitcnt lgkmcnt(3)
    v_mfma_f32_16x16x32_bf16 v[192:195], v[228:231], v[136:139], v[192:195]
    v_mfma_f32_16x16x32_bf16 v[196:199], v[228:231], v[140:143], v[196:199]
    s_add_u32 s22, s21, 0x98000
    s_add_u32 m0, s20, 0x20000
    s_nop 0
    buffer_load_dwordx4 v2, s[8:11], s22 offen sc1 lds
    ds_read_b128 v[244:247], v4 offset:1024
    s_waitcnt lgkmcnt(3)
    v_mfma_f32_16x16x32_bf16 v[184:187], v[232:235], v[144:147], v[184:187]
    v_mfma_f32_16x16x32_bf16 v[188:191], v[232:235], v[148:151], v[188:191]
    ds_read_b128 v[224:227], v4 offset:2048
    s_waitcnt lgkmcnt(3)
    v_mfma_f32_16x16x32_bf16 v[192:195], v[236:239], v[144:147], v[192:195]
    v_mfma_f32_16x16x32_bf16 v[196:199], v[236:239], v[148:151], v[196:199]
    ds_read_b128 v[228:231], v4 offset:3072
    s_waitcnt lgkmcnt(3)
    v_mfma_f32_16x16x32_bf16 v[200:203], v[240:243], v[24:27], 0
    v_mfma_f32_16x16x32_bf16 v[204:207], v[240:243], v[28:31], 0
    ds_read_b128 v[232:235], v4 offset:4096
    s_waitcnt lgkmcnt(3)
    v_mfma_f32_16x16x32_bf16 v[208:211], v[244:247], v[24:27], 0
    v_mfma_f32_16x16x32_bf16 v[212:215], v[244:247], v[28:31], 0
    s_add_u32 s22, s21, 0x98400
    s_add_u32 m0, s20, 0x20400
    s_nop 0
    buffer_load_dwordx4 v2, s[8:11], s22 offen sc1 lds
    ds_read_b128 v[236:239], v4 offset:5120
    v_mul_f32 v184, v184, v9
    s_waitcnt lgkmcnt(3)
    v_mfma_f32_16x16x32_bf16 v[200:203], v[224:227], v[32:35], v[200:203]
    v_mul_f32 v185, v185, v9
    v_mfma_f32_16x16x32_bf16 v[204:207], v[224:227], v[36:39], v[204:207]
    ds_read_b128 v[240:243], v4 offset:6144
    v_mul_f32 v186, v186, v9
    s_waitcnt lgkmcnt(3)
    v_mfma_f32_16x16x32_bf16 v[208:211], v[228:231], v[32:35], v[208:211]
    v_mul_f32 v187, v187, v9
    v_mfma_f32_16x16x32_bf16 v[212:215], v[228:231], v[36:39], v[212:215]
    ds_read_b128 v[244:247], v4 offset:7168
    v_mul_f32 v192, v192, v9
    s_waitcnt lgkmcnt(3)
    v_mfma_f32_16x16x32_bf16 v[200:203], v[232:235], v[40:43], v[200:203]
    v_mul_f32 v193, v193, v9
    v_mfma_f32_16x16x32_bf16 v[204:207], v[232:235], v[44:47], v[204:207]
    ds_read_b128 v[224:227], v4 offset:8192
    v_mul_f32 v194, v194, v9
    s_waitcnt lgkmcnt(3)
    v_mfma_f32_16x16x32_bf16 v[208:211], v[236:239], v[40:43], v[208:211]
    v_mul_f32 v195, v195, v9
    v_mfma_f32_16x16x32_bf16 v[212:215], v[236:239], v[44:47], v[212:215]
    ds_read_b128 v[228:231], v4 offset:9216
    v_cvt_pk_bf16_f32 v216, v184, v185
    s_waitcnt lgkmcnt(3)
    v_mfma_f32_16x16x32_bf16 v[200:203], v[240:243], v[48:51], v[200:203]
    v_cvt_pk_bf16_f32 v217, v186, v187
    v_mfma_f32_16x16x32_bf16 v[204:207], v[240:243], v[52:55], v[204:207]
    ds_read_b128 v[232:235], v4 offset:10240
    v_cvt_pk_bf16_f32 v218, v192, v193
    s_waitcnt lgkmcnt(3)
    v_mfma_f32_16x16x32_bf16 v[208:211], v[244:247], v[48:51], v[208:211]
    v_cvt_pk_bf16_f32 v219, v194, v195
    v_mfma_f32_16x16x32_bf16 v[212:215], v[244:247], v[52:55], v[212:215]
    ds_read_b128 v[236:239], v4 offset:11264
    buffer_store_dwordx4 v[216:219], v2, s[8:11], s25 offen offset:0 sc1
    s_waitcnt lgkmcnt(3)
    v_mfma_f32_16x16x32_bf16 v[200:203], v[224:227], v[56:59], v[200:203]
    v_mul_f32 v188, v188, v10
    v_mfma_f32_16x16x32_bf16 v[204:207], v[224:227], v[60:63], v[204:207]
    ds_read_b128 v[240:243], v4 offset:12288
    v_mul_f32 v189, v189, v10
    s_waitcnt lgkmcnt(3)
    v_mfma_f32_16x16x32_bf16 v[208:211], v[228:231], v[56:59], v[208:211]
    v_mul_f32 v190, v190, v10
    v_mfma_f32_16x16x32_bf16 v[212:215], v[228:231], v[60:63], v[212:215]
    ds_read_b128 v[244:247], v4 offset:13312
    v_mul_f32 v191, v191, v10
    s_waitcnt lgkmcnt(3)
    v_mfma_f32_16x16x32_bf16 v[200:203], v[232:235], v[64:67], v[200:203]
    v_mul_f32 v196, v196, v10
    v_mfma_f32_16x16x32_bf16 v[204:207], v[232:235], v[68:71], v[204:207]
    ds_read_b128 v[224:227], v4 offset:14336
    v_mul_f32 v197, v197, v10
    s_waitcnt lgkmcnt(3)
    v_mfma_f32_16x16x32_bf16 v[208:211], v[236:239], v[64:67], v[208:211]
    v_mul_f32 v198, v198, v10
    v_mfma_f32_16x16x32_bf16 v[212:215], v[236:239], v[68:71], v[212:215]
    ds_read_b128 v[228:231], v4 offset:15360
    v_mul_f32 v199, v199, v10
    s_waitcnt lgkmcnt(3)
    v_mfma_f32_16x16x32_bf16 v[200:203], v[240:243], v[72:75], v[200:203]
    v_cvt_pk_bf16_f32 v220, v188, v189
    v_mfma_f32_16x16x32_bf16 v[204:207], v[240:243], v[76:79], v[204:207]
    s_waitcnt vmcnt(8)
    s_barrier
    ds_read_b128 v[232:235], v4 offset:16384
    v_cvt_pk_bf16_f32 v221, v190, v191
    s_waitcnt lgkmcnt(3)
    v_mfma_f32_16x16x32_bf16 v[208:211], v[244:247], v[72:75], v[208:211]
    v_cvt_pk_bf16_f32 v222, v196, v197
    v_mfma_f32_16x16x32_bf16 v[212:215], v[244:247], v[76:79], v[212:215]
    s_add_u32 s22, s21, 0x9c000
    s_add_u32 m0, s20, 0x24000
    s_nop 0
    buffer_load_dwordx4 v2, s[8:11], s22 offen sc1 lds
    ds_read_b128 v[236:239], v4 offset:17408
    v_cvt_pk_bf16_f32 v223, v198, v199
    s_waitcnt lgkmcnt(3)
    v_mfma_f32_16x16x32_bf16 v[200:203], v[224:227], v[80:83], v[200:203]
    buffer_store_dwordx4 v[220:223], v2, s[8:11], s26 offen offset:0 sc1
    v_mfma_f32_16x16x32_bf16 v[204:207], v[224:227], v[84:87], v[204:207]
    ds_read_b128 v[240:243], v4 offset:18432
    s_waitcnt lgkmcnt(3)
    v_mfma_f32_16x16x32_bf16 v[208:211], v[228:231], v[80:83], v[208:211]
    v_mfma_f32_16x16x32_bf16 v[212:215], v[228:231], v[84:87], v[212:215]
    ds_read_b128 v[244:247], v4 offset:19456
    s_waitcnt lgkmcnt(3)
    v_mfma_f32_16x16x32_bf16 v[200:203], v[232:235], v[88:91], v[200:203]
    v_mfma_f32_16x16x32_bf16 v[204:207], v[232:235], v[92:95], v[204:207]
    ds_read_b128 v[224:227], v4 offset:20480
    s_waitcnt lgkmcnt(3)
    v_mfma_f32_16x16x32_bf16 v[208:211], v[236:239], v[88:91], v[208:211]
    v_mfma_f32_16x16x32_bf16 v[212:215], v[236:239], v[92:95], v[212:215]
    s_add_u32 s22, s21, 0x9c400
    s_add_u32 m0, s20, 0x24400
    s_nop 0
    buffer_load_dwordx4 v2, s[8:11], s22 offen sc1 lds
    ds_read_b128 v[228:231], v4 offset:21504
    s_waitcnt lgkmcnt(3)
    v_mfma_f32_16x16x32_bf16 v[200:203], v[240:243], v[96:99], v[200:203]
    v_mfma_f32_16x16x32_bf16 v[204:207], v[240:243], v[100:103], v[204:207]
    ds_read_b128 v[232:235], v4 offset:22528
    s_waitcnt lgkmcnt(3)
    v_mfma_f32_16x16x32_bf16 v[208:211], v[244:247], v[96:99], v[208:211]
    v_mfma_f32_16x16x32_bf16 v[212:215], v[244:247], v[100:103], v[212:215]
    ds_read_b128 v[236:239], v4 offset:23552
    s_waitcnt lgkmcnt(3)
    v_mfma_f32_16x16x32_bf16 v[200:203], v[224:227], v[104:107], v[200:203]
    v_mfma_f32_16x16x32_bf16 v[204:207], v[224:227], v[108:111], v[204:207]
    ds_read_b128 v[240:243], v4 offset:24576
    s_waitcnt lgkmcnt(3)
    v_mfma_f32_16x16x32_bf16 v[208:211], v[228:231], v[104:107], v[208:211]
    v_mfma_f32_16x16x32_bf16 v[212:215], v[228:231], v[108:111], v[212:215]
    ds_read_b128 v[244:247], v4 offset:25600
    s_waitcnt lgkmcnt(3)
    v_mfma_f32_16x16x32_bf16 v[200:203], v[232:235], v[112:115], v[200:203]
    v_mfma_f32_16x16x32_bf16 v[204:207], v[232:235], v[116:119], v[204:207]
    ds_read_b128 v[224:227], v4 offset:26624
    s_waitcnt lgkmcnt(3)
    v_mfma_f32_16x16x32_bf16 v[208:211], v[236:239], v[112:115], v[208:211]
    v_mfma_f32_16x16x32_bf16 v[212:215], v[236:239], v[116:119], v[212:215]
    ds_read_b128 v[228:231], v4 offset:27648
    s_waitcnt lgkmcnt(3)
    v_mfma_f32_16x16x32_bf16 v[200:203], v[240:243], v[120:123], v[200:203]
    v_mfma_f32_16x16x32_bf16 v[204:207], v[240:243], v[124:127], v[204:207]
    ds_read_b128 v[232:235], v4 offset:28672
    s_waitcnt lgkmcnt(3)
    v_mfma_f32_16x16x32_bf16 v[208:211], v[244:247], v[120:123], v[208:211]
    v_mfma_f32_16x16x32_bf16 v[212:215], v[244:247], v[124:127], v[212:215]
    ds_read_b128 v[236:239], v4 offset:29696
    s_waitcnt lgkmcnt(3)
    v_mfma_f32_16x16x32_bf16 v[200:203], v[224:227], v[128:131], v[200:203]
    v_mfma_f32_16x16x32_bf16 v[204:207], v[224:227], v[132:135], v[204:207]
    ds_read_b128 v[240:243], v4 offset:30720
    s_waitcnt lgkmcnt(3)
    v_mfma_f32_16x16x32_bf16 v[208:211], v[228:231], v[128:131], v[208:211]
    v_mfma_f32_16x16x32_bf16 v[212:215], v[228:231], v[132:135], v[212:215]
    ds_read_b128 v[244:247], v4 offset:31744
    s_waitcnt lgkmcnt(3)
    v_mfma_f32_16x16x32_bf16 v[200:203], v[232:235], v[136:139], v[200:203]
    v_mfma_f32_16x16x32_bf16 v[204:207], v[232:235], v[140:143], v[204:207]
    s_waitcnt vmcnt(8)
    s_barrier
    ds_read_b128 v[224:227], v4 offset:32768
    s_waitcnt lgkmcnt(3)
    v_mfma_f32_16x16x32_bf16 v[208:211], v[236:239], v[136:139], v[208:211]
    v_mfma_f32_16x16x32_bf16 v[212:215], v[236:239], v[140:143], v[212:215]
    s_add_u32 s22, s24, 0x0
    s_add_u32 m0, s20, 0x10000
    s_nop 0
    buffer_load_dwordx4 v3, s[4:7], s22 offen lds
    ds_read_b128 v[228:231], v4 offset:33792
    s_waitcnt lgkmcnt(3)
    v_mfma_f32_16x16x32_bf16 v[200:203], v[240:243], v[144:147], v[200:203]
    v_mfma_f32_16x16x32_bf16 v[204:207], v[240:243], v[148:151], v[204:207]
    ds_read_b128 v[232:235], v4 offset:34816
    s_waitcnt lgkmcnt(3)
    v_mfma_f32_16x16x32_bf16 v[208:211], v[244:247], v[144:147], v[208:211]
    v_mfma_f32_16x16x32_bf16 v[212:215], v[244:247], v[148:151], v[212:215]
    ds_read_b128 v[236:239], v4 offset:35840
    s_waitcnt lgkmcnt(3)
    v_mfma_f32_16x16x32_bf16 v[184:187], v[224:227], v[24:27], 0
    v_mfma_f32_16x16x32_bf16 v[188:191], v[224:227], v[28:31], 0
    ds_read_b128 v[240:243], v4 offset:36864
    s_waitcnt lgkmcnt(3)
    v_mfma_f32_16x16x32_bf16 v[192:195], v[228:231], v[24:27], 0
    v_mfma_f32_16x16x32_bf16 v[196:199], v[228:231], v[28:31], 0
    s_add_u32 s22, s24, 0x2000
    s_add_u32 m0, s20, 0x10400
    s_nop 0
    buffer_load_dwordx4 v3, s[4:7], s22 offen lds
    ds_read_b128 v[244:247], v4 offset:37888
    v_mul_f32 v200, v200, v9
    s_waitcnt lgkmcnt(3)
    v_mfma_f32_16x16x32_bf16 v[184:187], v[232:235], v[32:35], v[184:187]
    v_mul_f32 v201, v201, v9
    v_mfma_f32_16x16x32_bf16 v[188:191], v[232:235], v[36:39], v[188:191]
    ds_read_b128 v[224:227], v4 offset:38912
    v_mul_f32 v202, v202, v9
    s_waitcnt lgkmcnt(3)
    v_mfma_f32_16x16x32_bf16 v[192:195], v[236:239], v[32:35], v[192:195]
    v_mul_f32 v203, v203, v9
    v_mfma_f32_16x16x32_bf16 v[196:199], v[236:239], v[36:39], v[196:199]
    ds_read_b128 v[228:231], v4 offset:39936
    v_mul_f32 v208, v208, v9
    s_waitcnt lgkmcnt(3)
    v_mfma_f32_16x16x32_bf16 v[184:187], v[240:243], v[40:43], v[184:187]
    v_mul_f32 v209, v209, v9
    v_mfma_f32_16x16x32_bf16 v[188:191], v[240:243], v[44:47], v[188:191]
    ds_read_b128 v[232:235], v4 offset:40960
    v_mul_f32 v210, v210, v9
    s_waitcnt lgkmcnt(3)
    v_mfma_f32_16x16x32_bf16 v[192:195], v[244:247], v[40:43], v[192:195]
    v_mul_f32 v211, v211, v9
    v_mfma_f32_16x16x32_bf16 v[196:199], v[244:247], v[44:47], v[196:199]
    ds_read_b128 v[236:239], v4 offset:41984
    v_cvt_pk_bf16_f32 v216, v200, v201
    s_waitcnt lgkmcnt(3)
    v_mfma_f32_16x16x32_bf16 v[184:187], v[224:227], v[48:51], v[184:187]
    v_cvt_pk_bf16_f32 v217, v202, v203
    s_waitcnt vmcnt(3)
    s_add_u32 s16, s63, 0x570000
    v_mov_b32 v7, s28
    v_mov_b32 v8, 0
    s_mov_b64 exec, 1
    buffer_store_dword v7, v8, s[8:11], s16 offen sc1
    s_mov_b64 exec, -1
    v_mfma_f32_16x16x32_bf16 v[188:191], v[224:227], v[52:55], v[188:191]
    ds_read_b128 v[240:243], v4 offset:43008
    v_cvt_pk_bf16_f32 v218, v208, v209
    s_waitcnt lgkmcnt(3)
    v_mfma_f32_16x16x32_bf16 v[192:195], v[228:231], v[48:51], v[192:195]
    v_cvt_pk_bf16_f32 v219, v210, v211
    v_mfma_f32_16x16x32_bf16 v[196:199], v[228:231], v[52:55], v[196:199]
    ds_read_b128 v[244:247], v4 offset:44032
    buffer_store_dwordx4 v[216:219], v2, s[8:11], s25 offen offset:1024 sc1
    s_waitcnt lgkmcnt(3)
    v_mfma_f32_16x16x32_bf16 v[184:187], v[232:235], v[56:59], v[184:187]
    v_mul_f32 v204, v204, v10
    v_mfma_f32_16x16x32_bf16 v[188:191], v[232:235], v[60:63], v[188:191]
    ds_read_b128 v[224:227], v4 offset:45056
    v_mul_f32 v205, v205, v10
    s_waitcnt lgkmcnt(3)
    v_mfma_f32_16x16x32_bf16 v[192:195], v[236:239], v[56:59], v[192:195]
    v_mul_f32 v206, v206, v10
    v_mfma_f32_16x16x32_bf16 v[196:199], v[236:239], v[60:63], v[196:199]
    ds_read_b128 v[228:231], v4 offset:46080
    v_mul_f32 v207, v207, v10
    s_waitcnt lgkmcnt(3)
    v_mfma_f32_16x16x32_bf16 v[184:187], v[240:243], v[64:67], v[184:187]
    v_mul_f32 v212, v212, v10
    v_mfma_f32_16x16x32_bf16 v[188:191], v[240:243], v[68:71], v[188:191]
    ds_read_b128 v[232:235], v4 offset:47104
    v_mul_f32 v213, v213, v10
    s_waitcnt lgkmcnt(3)
    v_mfma_f32_16x16x32_bf16 v[192:195], v[244:247], v[64:67], v[192:195]
    v_mul_f32 v214, v214, v10
    v_mfma_f32_16x16x32_bf16 v[196:199], v[244:247], v[68:71], v[196:199]
    ds_read_b128 v[236:239], v4 offset:48128
    v_mul_f32 v215, v215, v10
    s_waitcnt lgkmcnt(3)
    v_mfma_f32_16x16x32_bf16 v[184:187], v[224:227], v[72:75], v[184:187]
    v_cvt_pk_bf16_f32 v220, v204, v205
    v_mfma_f32_16x16x32_bf16 v[188:191], v[224:227], v[76:79], v[188:191]
    s_barrier
    ds_read_b128 v[240:243], v4 offset:49152
    v_cvt_pk_bf16_f32 v221, v206, v207
    s_waitcnt lgkmcnt(3)
    v_mfma_f32_16x16x32_bf16 v[192:195], v[228:231], v[72:75], v[192:195]
    v_cvt_pk_bf16_f32 v222, v212, v213
    v_mfma_f32_16x16x32_bf16 v[196:199], v[228:231], v[76:79], v[196:199]
    s_add_u32 s22, s24, 0x80000
    s_add_u32 m0, s20, 0x14000
    s_nop 0
    buffer_load_dwordx4 v3, s[4:7], s22 offen lds
    ds_read_b128 v[244:247], v4 offset:50176
    v_cvt_pk_bf16_f32 v223, v214, v215
    s_waitcnt lgkmcnt(3)
    v_mfma_f32_16x16x32_bf16 v[184:187], v[232:235], v[80:83], v[184:187]
    buffer_store_dwordx4 v[220:223], v2, s[8:11], s26 offen offset:1024 sc1
    v_mfma_f32_16x16x32_bf16 v[188:191], v[232:235], v[84:87], v[188:191]
    ds_read_b128 v[224:227], v4 offset:51200
    s_waitcnt lgkmcnt(3)
    v_mfma_f32_16x16x32_bf16 v[192:195], v[236:239], v[80:83], v[192:195]
    v_mfma_f32_16x16x32_bf16 v[196:199], v[236:239], v[84:87], v[196:199]
    ds_read_b128 v[228:231], v4 offset:52224
    s_waitcnt lgkmcnt(3)
    v_mfma_f32_16x16x32_bf16 v[184:187], v[240:243], v[88:91], v[184:187]
    v_mfma_f32_16x16x32_bf16 v[188:191], v[240:243], v[92:95], v[188:191]
    ds_read_b128 v[232:235], v4 offset:53248
    s_waitcnt lgkmcnt(3)
    v_mfma_f32_16x16x32_bf16 v[192:195], v[244:247], v[88:91], v[192:195]
    v_mfma_f32_16x16x32_bf16 v[196:199], v[244:247], v[92:95], v[196:199]
    s_add_u32 s22, s24, 0x82000
    s_add_u32 m0, s20, 0x14400
    s_nop 0
    buffer_load_dwordx4 v3, s[4:7], s22 offen lds
    ds_read_b128 v[236:239], v4 offset:54272
    s_waitcnt lgkmcnt(3)
    v_mfma_f32_16x16x32_bf16 v[184:187], v[224:227], v[96:99], v[184:187]
    v_mfma_f32_16x16x32_bf16 v[188:191], v[224:227], v[100:103], v[188:191]
    ds_read_b128 v[240:243], v4 offset:55296
    s_waitcnt lgkmcnt(3)
    v_mfma_f32_16x16x32_bf16 v[192:195], v[228:231], v[96:99], v[192:195]
    v_mfma_f32_16x16x32_bf16 v[196:199], v[228:231], v[100:103], v[196:199]
    ds_read_b128 v[244:247], v4 offset:56320
    s_waitcnt lgkmcnt(3)
    v_mfma_f32_16x16x32_bf16 v[184:187], v[232:235], v[104:107], v[184:187]
    v_mfma_f32_16x16x32_bf16 v[188:191], v[232:235], v[108:111], v[188:191]
    ds_read_b128 v[224:227], v4 offset:57344
    s_waitcnt lgkmcnt(3)
    v_mfma_f32_16x16x32_bf16 v[192:195], v[236:239], v[104:107], v[192:195]
    v_mfma_f32_16x16x32_bf16 v[196:199], v[236:239], v[108:111], v[196:199]
    ds_read_b128 v[228:231], v4 offset:58368
    s_waitcnt lgkmcnt(3)
    v_mfma_f32_16x16x32_bf16 v[184:187], v[240:243], v[112:115], v[184:187]
    v_mfma_f32_16x16x32_bf16 v[188:191], v[240:243], v[116:119], v[188:191]
    ds_read_b128 v[232:235], v4 offset:59392
    s_waitcnt lgkmcnt(3)
    v_mfma_f32_16x16x32_bf16 v[192:195], v[244:247], v[112:115], v[192:195]
    v_mfma_f32_16x16x32_bf16 v[196:199], v[244:247], v[116:119], v[196:199]
    ds_read_b128 v[236:239], v4 offset:60416
    s_waitcnt lgkmcnt(3)
    v_mfma_f32_16x16x32_bf16 v[184:187], v[224:227], v[120:123], v[184:187]
    v_mfma_f32_16x16x32_bf16 v[188:191], v[224:227], v[124:127], v[188:191]
    ds_read_b128 v[240:243], v4 offset:61440
    s_waitcnt lgkmcnt(3)
    v_mfma_f32_16x16x32_bf16 v[192:195], v[228:231], v[120:123], v[192:195]
    v_mfma_f32_16x16x32_bf16 v[196:199], v[228:231], v[124:127], v[196:199]
    ds_read_b128 v[244:247], v4 offset:62464
    s_waitcnt lgkmcnt(3)
    v_mfma_f32_16x16x32_bf16 v[184:187], v[232:235], v[128:131], v[184:187]
    v_mfma_f32_16x16x32_bf16 v[188:191], v[232:235], v[132:135], v[188:191]
    ds_read_b128 v[224:227], v4 offset:63488
    s_waitcnt lgkmcnt(3)
    v_mfma_f32_16x16x32_bf16 v[192:195], v[236:239], v[128:131], v[192:195]
    v_mfma_f32_16x16x32_bf16 v[196:199], v[236:239], v[132:135], v[196:199]
    ds_read_b128 v[228:231], v4 offset:64512
    s_waitcnt lgkmcnt(3)
    v_mfma_f32_16x16x32_bf16 v[184:187], v[240:243], v[136:139], v[184:187]
    v_mfma_f32_16x16x32_bf16 v[188:191], v[240:243], v[140:143], v[188:191]
    s_barrier
    ds_read_b128 v[232:235], v5 offset:0
    s_waitcnt lgkmcnt(3)
    v_mfma_f32_16x16x32_bf16 v[192:195], v[244:247], v[136:139], v[192:195]
    v_mfma_f32_16x16x32_bf16 v[196:199], v[244:247], v[140:143], v[196:199]
    s_add_u32 s22, s24, 0x100000
    s_add_u32 m0, s20, 0x18000
    s_nop 0
    buffer_load_dwordx4 v3, s[4:7], s22 offen lds
    ds_read_b128 v[236:239], v5 offset:1024
    s_waitcnt lgkmcnt(3)
    v_mfma_f32_16x16x32_bf16 v[184:187], v[224:227], v[144:147], v[184:187]
    v_mfma_f32_16x16x32_bf16 v[188:191], v[224:227], v[148:151], v[188:191]
    ds_read_b128 v[240:243], v5 offset:2048
    s_waitcnt lgkmcnt(3)
    v_mfma_f32_16x16x32_bf16 v[192:195], v[228:231], v[144:147], v[192:195]
    v_mfma_f32_16x16x32_bf16 v[196:199], v[228:231], v[148:151], v[196:199]
    ds_read_b128 v[244:247], v5 offset:3072
    s_waitcnt lgkmcnt(3)
    v_mfma_f32_16x16x32_bf16 v[200:203], v[232:235], v[24:27], 0
    v_mfma_f32_16x16x32_bf16 v[204:207], v[232:235], v[28:31], 0
    ds_read_b128 v[224:227], v5 offset:4096
    s_waitcnt lgkmcnt(3)
    v_mfma_f32_16x16x32_bf16 v[208:211], v[236:239], v[24:27], 0
    v_mfma_f32_16x16x32_bf16 v[212:215], v[236:239], v[28:31], 0
    s_add_u32 s22, s24, 0x102000
    s_add_u32 m0, s20, 0x18400
    s_nop 0
    buffer_load_dwordx4 v3, s[4:7], s22 offen lds
    ds_read_b128 v[228:231], v5 offset:5120
    v_mul_f32 v184, v184, v9
    s_waitcnt lgkmcnt(3)
    v_mfma_f32_16x16x32_bf16 v[200:203], v[240:243], v[32:35], v[200:203]
    v_mul_f32 v185, v185, v9
    s_bfe_u32 s30, s2, 0x20001
    s_lshl_b32 s30, s30, 2
    s_bfe_u32 s17, s2, 0x20003
    s_add_u32 s30, s30, s17
    s_lshr_b32 s31, s2, 5
    s_and_b32 s17, s3, 3
    s_lshl_b32 s19, s30, 2
    s_add_u32 s19, s19, s17
    s_and_b32 s16, s2, 1
    s_lshl_b32 s17, s19, 18
    s_lshl_b32 s23, s16, 16
    s_add_u32 s17, s17, s23
    s_add_u32 s17, s17, 0x1001000
    v_add_u32 v6, s17, v2
    s_lshl_b32 s19, s19, 7
    s_lshl_b32 s23, s16, 6
    s_add_u32 s19, s19, s23
    s_add_u32 s19, s19, 0x570000
    v_and_b32 v13, 15, v1
    v_lshlrev_b32 v13, 2, v13
    buffer_load_dword v12, v13, s[8:11], s19 offen sc1
    v_mfma_f32_16x16x32_bf16 v[204:207], v[240:243], v[36:39], v[204:207]
    ds_read_b128 v[232:235], v5 offset:6144
    v_mul_f32 v186, v186, v9
    s_waitcnt lgkmcnt(3)
    v_mfma_f32_16x16x32_bf16 v[208:211], v[244:247], v[32:35], v[208:211]
    v_mul_f32 v187, v187, v9
    v_mfma_f32_16x16x32_bf16 v[212:215], v[244:247], v[36:39], v[212:215]
    ds_read_b128 v[236:239], v5 offset:7168
    v_mul_f32 v192, v192, v9
    s_waitcnt lgkmcnt(3)
    v_mfma_f32_16x16x32_bf16 v[200:203], v[224:227], v[40:43], v[200:203]
    v_mul_f32 v193, v193, v9
    v_mfma_f32_16x16x32_bf16 v[204:207], v[224:227], v[44:47], v[204:207]
    ds_read_b128 v[240:243], v5 offset:8192
    v_mul_f32 v194, v194, v9
    s_waitcnt lgkmcnt(3)
    v_mfma_f32_16x16x32_bf16 v[208:211], v[228:231], v[40:43], v[208:211]
    v_mul_f32 v195, v195, v9
    v_mfma_f32_16x16x32_bf16 v[212:215], v[228:231], v[44:47], v[212:215]
    ds_read_b128 v[244:247], v5 offset:9216
    v_cvt_pk_bf16_f32 v216, v184, v185
    s_waitcnt lgkmcnt(3)
    v_mfma_f32_16x16x32_bf16 v[200:203], v[232:235], v[48:51], v[200:203]
    v_cvt_pk_bf16_f32 v217, v186, v187
    v_mfma_f32_16x16x32_bf16 v[204:207], v[232:235], v[52:55], v[204:207]
    ds_read_b128 v[224:227], v5 offset:10240
    v_cvt_pk_bf16_f32 v218, v192, v193
    s_waitcnt lgkmcnt(3)
    v_mfma_f32_16x16x32_bf16 v[208:211], v[236:239], v[48:51], v[208:211]
    v_cvt_pk_bf16_f32 v219, v194, v195
    v_mfma_f32_16x16x32_bf16 v[212:215], v[236:239], v[52:55], v[212:215]
    ds_read_b128 v[228:231], v5 offset:11264
    buffer_store_dwordx4 v[216:219], v2, s[8:11], s25 offen offset:2048 sc1
    s_waitcnt lgkmcnt(3)
    v_mfma_f32_16x16x32_bf16 v[200:203], v[240:243], v[56:59], v[200:203]
    v_mul_f32 v188, v188, v10
    v_mfma_f32_16x16x32_bf16 v[204:207], v[240:243], v[60:63], v[204:207]
    ds_read_b128 v[232:235], v5 offset:12288
    v_mul_f32 v189, v189, v10
    s_waitcnt lgkmcnt(3)
    v_mfma_f32_16x16x32_bf16 v[208:211], v[244:247], v[56:59], v[208:211]
    v_mul_f32 v190, v190, v10
    v_mfma_f32_16x16x32_bf16 v[212:215], v[244:247], v[60:63], v[212:215]
    ds_read_b128 v[236:239], v5 offset:13312
    v_mul_f32 v191, v191, v10
    s_waitcnt lgkmcnt(3)
    v_mfma_f32_16x16x32_bf16 v[200:203], v[224:227], v[64:67], v[200:203]
    v_mul_f32 v196, v196, v10
    v_mfma_f32_16x16x32_bf16 v[204:207], v[224:227], v[68:71], v[204:207]
    ds_read_b128 v[240:243], v5 offset:14336
    v_mul_f32 v197, v197, v10
    s_waitcnt lgkmcnt(3)
    v_mfma_f32_16x16x32_bf16 v[208:211], v[228:231], v[64:67], v[208:211]
    v_mul_f32 v198, v198, v10
    v_mfma_f32_16x16x32_bf16 v[212:215], v[228:231], v[68:71], v[212:215]
    ds_read_b128 v[244:247], v5 offset:15360
    v_mul_f32 v199, v199, v10
    s_waitcnt lgkmcnt(3)
    v_mfma_f32_16x16x32_bf16 v[200:203], v[232:235], v[72:75], v[200:203]
    v_cvt_pk_bf16_f32 v220, v188, v189
    v_mfma_f32_16x16x32_bf16 v[204:207], v[232:235], v[76:79], v[204:207]
    s_waitcnt vmcnt(11)
    s_barrier
    ds_read_b128 v[224:227], v5 offset:16384
    v_cvt_pk_bf16_f32 v221, v190, v191
    s_waitcnt lgkmcnt(3)
    v_mfma_f32_16x16x32_bf16 v[208:211], v[236:239], v[72:75], v[208:211]
    v_cvt_pk_bf16_f32 v222, v196, v197
    v_mfma_f32_16x16x32_bf16 v[212:215], v[236:239], v[76:79], v[212:215]
    s_add_u32 s22, s24, 0x180000
    s_add_u32 m0, s20, 0x1c000
    s_nop 0
    buffer_load_dwordx4 v3, s[4:7], s22 offen lds
    ds_read_b128 v[228:231], v5 offset:17408
    v_cvt_pk_bf16_f32 v223, v198, v199
    s_waitcnt lgkmcnt(3)
    v_mfma_f32_16x16x32_bf16 v[200:203], v[240:243], v[80:83], v[200:203]
    buffer_store_dwordx4 v[220:223], v2, s[8:11], s26 offen offset:2048 sc1
    v_mfma_f32_16x16x32_bf16 v[204:207], v[240:243], v[84:87], v[204:207]
    ds_read_b128 v[232:235], v5 offset:18432
    s_waitcnt lgkmcnt(3)
    v_mfma_f32_16x16x32_bf16 v[208:211], v[244:247], v[80:83], v[208:211]
    v_mfma_f32_16x16x32_bf16 v[212:215], v[244:247], v[84:87], v[212:215]
    ds_read_b128 v[236:239], v5 offset:19456
    s_waitcnt lgkmcnt(3)
    v_mfma_f32_16x16x32_bf16 v[200:203], v[224:227], v[88:91], v[200:203]
    v_mfma_f32_16x16x32_bf16 v[204:207], v[224:227], v[92:95], v[204:207]
    ds_read_b128 v[240:243], v5 offset:20480
    s_waitcnt vmcnt(3)
    v_cmp_ne_u32 vcc, s28, v12
    s_cbranch_vccnz adaLN_cond__sliding_block_cached__moe_arch_mod__prompt_kernel_o17r
adaLN_cond__sliding_block_cached__moe_arch_mod__prompt_kernel_o17b:
    s_waitcnt lgkmcnt(3)
    v_mfma_f32_16x16x32_bf16 v[208:211], v[228:231], v[88:91], v[208:211]
    s_mov_b32 s23, 0x0
    buffer_load_dwordx4 v[24:27], v6, s[8:11], s23 offen offset:0 sc1
    v_mfma_f32_16x16x32_bf16 v[212:215], v[228:231], v[92:95], v[212:215]
    s_add_u32 s22, s24, 0x182000
    s_add_u32 m0, s20, 0x1c400
    s_nop 0
    buffer_load_dwordx4 v3, s[4:7], s22 offen lds
    ds_read_b128 v[244:247], v5 offset:21504
    s_waitcnt lgkmcnt(3)
    v_mfma_f32_16x16x32_bf16 v[200:203], v[232:235], v[96:99], v[200:203]
    v_mfma_f32_16x16x32_bf16 v[204:207], v[232:235], v[100:103], v[204:207]
    ds_read_b128 v[224:227], v5 offset:22528
    s_mov_b32 s23, 0x20000
    buffer_load_dwordx4 v[28:31], v6, s[8:11], s23 offen offset:0 sc1
    s_waitcnt lgkmcnt(3)
    v_mfma_f32_16x16x32_bf16 v[208:211], v[236:239], v[96:99], v[208:211]
    s_add_u32 s16, s63, 0x572000
    v_mov_b32 v14, s28
    v_mov_b32 v15, 0
    s_mov_b64 exec, 1
    buffer_store_dword v14, v15, s[8:11], s16 offen sc1
    s_mov_b64 exec, -1
    v_mfma_f32_16x16x32_bf16 v[212:215], v[236:239], v[100:103], v[212:215]
    ds_read_b128 v[228:231], v5 offset:23552
    s_waitcnt lgkmcnt(3)
    v_mfma_f32_16x16x32_bf16 v[200:203], v[240:243], v[104:107], v[200:203]
    v_mfma_f32_16x16x32_bf16 v[204:207], v[240:243], v[108:111], v[204:207]
    ds_read_b128 v[232:235], v5 offset:24576
    s_mov_b32 s23, 0x2000
    buffer_load_dwordx4 v[32:35], v6, s[8:11], s23 offen offset:0 sc1
    s_waitcnt lgkmcnt(3)
    v_mfma_f32_16x16x32_bf16 v[208:211], v[244:247], v[104:107], v[208:211]
    v_mfma_f32_16x16x32_bf16 v[212:215], v[244:247], v[108:111], v[212:215]
    ds_read_b128 v[236:239], v5 offset:25600
    s_waitcnt lgkmcnt(3)
    v_mfma_f32_16x16x32_bf16 v[200:203], v[224:227], v[112:115], v[200:203]
    s_mov_b32 s23, 0x22000
    buffer_load_dwordx4 v[36:39], v6, s[8:11], s23 offen offset:0 sc1
    v_mfma_f32_16x16x32_bf16 v[204:207], v[224:227], v[116:119], v[204:207]
    ds_read_b128 v[240:243], v5 offset:26624
    s_waitcnt lgkmcnt(3)
    v_mfma_f32_16x16x32_bf16 v[208:211], v[228:231], v[112:115], v[208:211]
    v_mfma_f32_16x16x32_bf16 v[212:215], v[228:231], v[116:119], v[212:215]
    ds_read_b128 v[244:247], v5 offset:27648
    s_waitcnt lgkmcnt(3)
    v_mfma_f32_16x16x32_bf16 v[200:203], v[232:235], v[120:123], v[200:203]
    s_mov_b32 s23, 0x4000
    buffer_load_dwordx4 v[40:43], v6, s[8:11], s23 offen offset:0 sc1
    v_mfma_f32_16x16x32_bf16 v[204:207], v[232:235], v[124:127], v[204:207]
    ds_read_b128 v[224:227], v5 offset:28672
    s_waitcnt lgkmcnt(3)
    v_mfma_f32_16x16x32_bf16 v[208:211], v[236:239], v[120:123], v[208:211]
    v_mfma_f32_16x16x32_bf16 v[212:215], v[236:239], v[124:127], v[212:215]
    ds_read_b128 v[228:231], v5 offset:29696
    s_waitcnt lgkmcnt(3)
    v_mfma_f32_16x16x32_bf16 v[200:203], v[240:243], v[128:131], v[200:203]
    s_mov_b32 s23, 0x24000
    buffer_load_dwordx4 v[44:47], v6, s[8:11], s23 offen offset:0 sc1
    v_mfma_f32_16x16x32_bf16 v[204:207], v[240:243], v[132:135], v[204:207]
    ds_read_b128 v[232:235], v5 offset:30720
    s_waitcnt lgkmcnt(3)
    v_mfma_f32_16x16x32_bf16 v[208:211], v[244:247], v[128:131], v[208:211]
    v_mfma_f32_16x16x32_bf16 v[212:215], v[244:247], v[132:135], v[212:215]
    ds_read_b128 v[236:239], v5 offset:31744
    s_mov_b32 s23, 0x6000
    buffer_load_dwordx4 v[48:51], v6, s[8:11], s23 offen offset:0 sc1
    s_waitcnt lgkmcnt(3)
    v_mfma_f32_16x16x32_bf16 v[200:203], v[224:227], v[136:139], v[200:203]
    v_bfe_u32 v18, v1, 2, 2
    v_lshrrev_b32 v19, 4, v1
    v_mfma_f32_16x16x32_bf16 v[204:207], v[224:227], v[140:143], v[204:207]
    v_and_b32 v17, 3, v1
    v_lshlrev_b32 v16, 11, v19
    s_waitcnt lgkmcnt(2)
    v_mfma_f32_16x16x32_bf16 v[208:211], v[228:231], v[136:139], v[208:211]
    v_lshl_add_u32 v16, v18, 6, v16
    v_lshl_add_u32 v16, v17, 3, v16
    v_mfma_f32_16x16x32_bf16 v[212:215], v[228:231], v[140:143], v[212:215]
    s_mov_b32 s23, 0x26000
    buffer_load_dwordx4 v[52:55], v6, s[8:11], s23 offen offset:0 sc1
    v_add_u32 v16, 0x12000, v16
    v_and_b32 v19, 1, v19
    s_waitcnt lgkmcnt(1)
    v_mfma_f32_16x16x32_bf16 v[200:203], v[232:235], v[144:147], v[200:203]
    v_lshlrev_b32 v19, 5, v19
    v_sub_u32 v5, v16, v19
    v_mfma_f32_16x16x32_bf16 v[204:207], v[232:235], v[148:151], v[204:207]
    v_add_u32 v4, v16, v19
    v_add_u32 v7, 0x10000, v4
    s_waitcnt lgkmcnt(0)
    v_mfma_f32_16x16x32_bf16 v[208:211], v[236:239], v[144:147], v[208:211]
    v_add_u32 v8, 0x10000, v5
    v_mfma_f32_16x16x32_bf16 v[212:215], v[236:239], v[148:151], v[212:215]
    v_mul_f32 v200, v200, v9
    v_mul_f32 v201, v201, v9
    v_mul_f32 v202, v202, v9
    v_mul_f32 v203, v203, v9
    s_nop 1
    v_mul_f32 v208, v208, v9
    v_mul_f32 v209, v209, v9
    v_mul_f32 v210, v210, v9
    v_mul_f32 v211, v211, v9
    v_cvt_pk_bf16_f32 v216, v200, v201
    v_cvt_pk_bf16_f32 v217, v202, v203
    v_cvt_pk_bf16_f32 v218, v208, v209
    v_cvt_pk_bf16_f32 v219, v210, v211
    buffer_store_dwordx4 v[216:219], v2, s[8:11], s25 offen offset:3072 sc1
    v_mul_f32 v204, v204, v10
    v_mul_f32 v205, v205, v10
    v_mul_f32 v206, v206, v10
    v_mul_f32 v207, v207, v10
    v_mul_f32 v212, v212, v10
    v_mul_f32 v213, v213, v10
    v_mul_f32 v214, v214, v10
    v_mul_f32 v215, v215, v10
    v_cvt_pk_bf16_f32 v220, v204, v205
    v_cvt_pk_bf16_f32 v221, v206, v207
    v_cvt_pk_bf16_f32 v222, v212, v213
    v_cvt_pk_bf16_f32 v223, v214, v215
    buffer_store_dwordx4 v[220:223], v2, s[8:11], s26 offen offset:3072 sc1
    s_and_b32 s15, s2, 1
    s_barrier
    ds_read_b64_tr_b16 v[224:225], v4 offset:0
    ds_read_b64_tr_b16 v[226:227], v4 offset:1024
    ds_read_b64_tr_b16 v[228:229], v5 offset:32
    ds_read_b64_tr_b16 v[230:231], v5 offset:1056
    ds_read_b64_tr_b16 v[232:233], v4 offset:256
    ds_read_b64_tr_b16 v[234:235], v4 offset:1280
    ds_read_b64_tr_b16 v[236:237], v5 offset:288
    ds_read_b64_tr_b16 v[238:239], v5 offset:1312
    s_waitcnt vmcnt(11) lgkmcnt(6)
    v_mfma_f32_16x16x32_bf16 v[88:91], v[224:227], v[24:27], 0
    ds_read_b64_tr_b16 v[240:241], v4 offset:512
    s_waitcnt vmcnt(9)
    v_mfma_f32_16x16x32_bf16 v[92:95], v[224:227], v[28:31], 0
    ds_read_b64_tr_b16 v[242:243], v4 offset:1536
    s_waitcnt lgkmcnt(6)
    v_mfma_f32_16x16x32_bf16 v[96:99], v[228:231], v[24:27], 0
    ds_read_b64_tr_b16 v[244:245], v5 offset:544
    v_mfma_f32_16x16x32_bf16 v[100:103], v[228:231], v[28:31], 0
    ds_read_b64_tr_b16 v[246:247], v5 offset:1568
    s_waitcnt lgkmcnt(6)
    v_mfma_f32_16x16x32_bf16 v[104:107], v[232:235], v[24:27], 0
    ds_read_b64_tr_b16 v[224:225], v4 offset:768
    v_mfma_f32_16x16x32_bf16 v[108:111], v[232:235], v[28:31], 0
    ds_read_b64_tr_b16 v[226:227], v4 offset:1792
    s_waitcnt lgkmcnt(6)
    v_mfma_f32_16x16x32_bf16 v[112:115], v[236:239], v[24:27], 0
    ds_read_b64_tr_b16 v[228:229], v5 offset:800
    v_mfma_f32_16x16x32_bf16 v[116:119], v[236:239], v[28:31], 0
    ds_read_b64_tr_b16 v[230:231], v5 offset:1824
    s_waitcnt lgkmcnt(6)
    v_mfma_f32_16x16x32_bf16 v[120:123], v[240:243], v[24:27], 0
    s_add_u32 s22, s24, 0x200000
    s_add_u32 m0, s20, 0x20000
    s_nop 0
    buffer_load_dwordx4 v3, s[4:7], s22 offen lds
    v_mfma_f32_16x16x32_bf16 v[124:127], v[240:243], v[28:31], 0
    s_barrier
    ds_read_b64_tr_b16 v[232:233], v4 offset:16384
    ds_read_b64_tr_b16 v[234:235], v4 offset:17408
    s_waitcnt lgkmcnt(6)
    v_mfma_f32_16x16x32_bf16 v[128:131], v[244:247], v[24:27], 0
    ds_read_b64_tr_b16 v[236:237], v5 offset:16416
    s_mov_b32 s23, 0x8000
    buffer_load_dwordx4 v[56:59], v6, s[8:11], s23 offen offset:0 sc1
    v_mfma_f32_16x16x32_bf16 v[132:135], v[244:247], v[28:31], 0
    s_add_u32 s22, s24, 0x202000
    s_add_u32 m0, s20, 0x20400
    s_nop 0
    buffer_load_dwordx4 v3, s[4:7], s22 offen lds
    ds_read_b64_tr_b16 v[238:239], v5 offset:17440
    s_waitcnt lgkmcnt(6)
    v_mfma_f32_16x16x32_bf16 v[136:139], v[224:227], v[24:27], 0
    ds_read_b64_tr_b16 v[240:241], v4 offset:16640
    v_mfma_f32_16x16x32_bf16 v[140:143], v[224:227], v[28:31], 0
    ds_read_b64_tr_b16 v[242:243], v4 offset:17664
    s_mov_b32 s23, 0x28000
    buffer_load_dwordx4 v[60:63], v6, s[8:11], s23 offen offset:0 sc1
    s_waitcnt lgkmcnt(6)
    v_mfma_f32_16x16x32_bf16 v[144:147], v[228:231], v[24:27], 0
    ds_read_b64_tr_b16 v[244:245], v5 offset:16672
    v_mfma_f32_16x16x32_bf16 v[148:151], v[228:231], v[28:31], 0
    ds_read_b64_tr_b16 v[246:247], v5 offset:17696
    s_waitcnt vmcnt(11) lgkmcnt(6)
    v_mfma_f32_16x16x32_bf16 v[88:91], v[232:235], v[32:35], v[88:91]
    ds_read_b64_tr_b16 v[224:225], v4 offset:16896
    s_waitcnt vmcnt(10)
    v_mfma_f32_16x16x32_bf16 v[92:95], v[232:235], v[36:39], v[92:95]
    s_add_u32 s22, s24, 0x280000
    s_add_u32 m0, s20, 0x24000
    s_nop 0
    buffer_load_dwordx4 v3, s[4:7], s22 offen lds
    ds_read_b64_tr_b16 v[226:227], v4 offset:17920
    s_waitcnt lgkmcnt(6)
    v_mfma_f32_16x16x32_bf16 v[96:99], v[236:239], v[32:35], v[96:99]
    ds_read_b64_tr_b16 v[228:229], v5 offset:16928
    v_mfma_f32_16x16x32_bf16 v[100:103], v[236:239], v[36:39], v[100:103]
    ds_read_b64_tr_b16 v[230:231], v5 offset:17952
    s_waitcnt lgkmcnt(6)
    v_mfma_f32_16x16x32_bf16 v[104:107], v[240:243], v[32:35], v[104:107]
    s_add_u32 s22, s24, 0x282000
    s_add_u32 m0, s20, 0x24400
    s_nop 0
    buffer_load_dwordx4 v3, s[4:7], s22 offen lds
    ds_read_b64_tr_b16 v[232:233], v4 offset:17152
    v_mfma_f32_16x16x32_bf16 v[108:111], v[240:243], v[36:39], v[108:111]
    ds_read_b64_tr_b16 v[234:235], v4 offset:18176
    s_waitcnt lgkmcnt(6)
    v_mfma_f32_16x16x32_bf16 v[112:115], v[244:247], v[32:35], v[112:115]
    ds_read_b64_tr_b16 v[236:237], v5 offset:17184
    v_mfma_f32_16x16x32_bf16 v[116:119], v[244:247], v[36:39], v[116:119]
    ds_read_b64_tr_b16 v[238:239], v5 offset:18208
    s_waitcnt lgkmcnt(6)
    v_mfma_f32_16x16x32_bf16 v[120:123], v[224:227], v[32:35], v[120:123]
    v_mfma_f32_16x16x32_bf16 v[124:127], v[224:227], v[36:39], v[124:127]
    s_barrier
    ds_read_b64_tr_b16 v[240:241], v4 offset:32768
    ds_read_b64_tr_b16 v[242:243], v4 offset:33792
    s_waitcnt lgkmcnt(6)
    v_mfma_f32_16x16x32_bf16 v[128:131], v[228:231], v[32:35], v[128:131]
    ds_read_b64_tr_b16 v[244:245], v5 offset:32800
    s_mov_b32 s23, 0xa000
    buffer_load_dwordx4 v[24:27], v6, s[8:11], s23 offen offset:0 sc1
    v_mfma_f32_16x16x32_bf16 v[132:135], v[228:231], v[36:39], v[132:135]
    ds_read_b64_tr_b16 v[246:247], v5 offset:33824
    s_waitcnt lgkmcnt(6)
    v_mfma_f32_16x16x32_bf16 v[136:139], v[232:235], v[32:35], v[136:139]
    ds_read_b64_tr_b16 v[224:225], v4 offset:33024
    v_mfma_f32_16x16x32_bf16 v[140:143], v[232:235], v[36:39], v[140:143]
    ds_read_b64_tr_b16 v[226:227], v4 offset:34048
    s_mov_b32 s23, 0x2a000
    buffer_load_dwordx4 v[28:31], v6, s[8:11], s23 offen offset:0 sc1
    s_waitcnt lgkmcnt(6)
    v_mfma_f32_16x16x32_bf16 v[144:147], v[236:239], v[32:35], v[144:147]
    s_add_u32 s16, s63, 0x574000
    v_mov_b32 v14, s28
    v_mov_b32 v15, 0
    s_mov_b64 exec, 1
    buffer_store_dword v14, v15, s[8:11], s16 offen sc1
    s_mov_b64 exec, -1
    ds_read_b64_tr_b16 v[228:229], v5 offset:33056
    v_mfma_f32_16x16x32_bf16 v[148:151], v[236:239], v[36:39], v[148:151]
    ds_read_b64_tr_b16 v[230:231], v5 offset:34080
    s_waitcnt vmcnt(14) lgkmcnt(6)
    v_mfma_f32_16x16x32_bf16 v[88:91], v[240:243], v[40:43], v[88:91]
    ds_read_b64_tr_b16 v[232:233], v4 offset:33280
    s_waitcnt vmcnt(13)
    v_mfma_f32_16x16x32_bf16 v[92:95], v[240:243], v[44:47], v[92:95]
    s_add_u32 s22, s24, 0x300000
    s_add_u32 m0, s20, 0x10000
    s_nop 0
    buffer_load_dwordx4 v3, s[4:7], s22 offen lds
    ds_read_b64_tr_b16 v[234:235], v4 offset:34304
    s_waitcnt lgkmcnt(6)
    v_mfma_f32_16x16x32_bf16 v[96:99], v[244:247], v[40:43], v[96:99]
    ds_read_b64_tr_b16 v[236:237], v5 offset:33312
    v_mfma_f32_16x16x32_bf16 v[100:103], v[244:247], v[44:47], v[100:103]
    ds_read_b64_tr_b16 v[238:239], v5 offset:34336
    s_waitcnt lgkmcnt(6)
    v_mfma_f32_16x16x32_bf16 v[104:107], v[224:227], v[40:43], v[104:107]
    s_add_u32 s22, s24, 0x302000
    s_add_u32 m0, s20, 0x10400
    s_nop 0
    buffer_load_dwordx4 v3, s[4:7], s22 offen lds
    ds_read_b64_tr_b16 v[240:241], v4 offset:33536
    v_mfma_f32_16x16x32_bf16 v[108:111], v[224:227], v[44:47], v[108:111]
    ds_read_b64_tr_b16 v[242:243], v4 offset:34560
    s_waitcnt lgkmcnt(6)
    v_mfma_f32_16x16x32_bf16 v[112:115], v[228:231], v[40:43], v[112:115]
    ds_read_b64_tr_b16 v[244:245], v5 offset:33568
    v_mfma_f32_16x16x32_bf16 v[116:119], v[228:231], v[44:47], v[116:119]
    ds_read_b64_tr_b16 v[246:247], v5 offset:34592
    s_waitcnt lgkmcnt(6)
    v_mfma_f32_16x16x32_bf16 v[120:123], v[232:235], v[40:43], v[120:123]
    v_mfma_f32_16x16x32_bf16 v[124:127], v[232:235], v[44:47], v[124:127]
    s_barrier
    ds_read_b64_tr_b16 v[224:225], v4 offset:49152
    ds_read_b64_tr_b16 v[226:227], v4 offset:50176
    s_add_u32 s19, s19, 8192
    buffer_load_dword v12, v13, s[8:11], s19 offen sc1
    s_waitcnt lgkmcnt(6)
    v_mfma_f32_16x16x32_bf16 v[128:131], v[236:239], v[40:43], v[128:131]
    ds_read_b64_tr_b16 v[228:229], v5 offset:49184
    s_mov_b32 s23, 0xc000
    buffer_load_dwordx4 v[32:35], v6, s[8:11], s23 offen offset:0 sc1
    v_mfma_f32_16x16x32_bf16 v[132:135], v[236:239], v[44:47], v[132:135]
    ds_read_b64_tr_b16 v[230:231], v5 offset:50208
    s_waitcnt lgkmcnt(6)
    v_mfma_f32_16x16x32_bf16 v[136:139], v[240:243], v[40:43], v[136:139]
    ds_read_b64_tr_b16 v[232:233], v4 offset:49408
    v_mfma_f32_16x16x32_bf16 v[140:143], v[240:243], v[44:47], v[140:143]
    ds_read_b64_tr_b16 v[234:235], v4 offset:50432
    s_mov_b32 s23, 0x2c000
    buffer_load_dwordx4 v[36:39], v6, s[8:11], s23 offen offset:0 sc1
    s_waitcnt lgkmcnt(6)
    v_mfma_f32_16x16x32_bf16 v[144:147], v[244:247], v[40:43], v[144:147]
    ds_read_b64_tr_b16 v[236:237], v5 offset:49440
    v_mfma_f32_16x16x32_bf16 v[148:151], v[244:247], v[44:47], v[148:151]
    ds_read_b64_tr_b16 v[238:239], v5 offset:50464
    s_waitcnt vmcnt(17) lgkmcnt(6)
    v_mfma_f32_16x16x32_bf16 v[88:91], v[224:227], v[48:51], v[88:91]
    ds_read_b64_tr_b16 v[240:241], v4 offset:49664
    s_waitcnt vmcnt(16)
    v_mfma_f32_16x16x32_bf16 v[92:95], v[224:227], v[52:55], v[92:95]
    s_add_u32 s22, s24, 0x380000
    s_add_u32 m0, s20, 0x14000
    s_nop 0
    buffer_load_dwordx4 v3, s[4:7], s22 offen lds
    ds_read_b64_tr_b16 v[242:243], v4 offset:50688
    s_waitcnt lgkmcnt(6)
    v_mfma_f32_16x16x32_bf16 v[96:99], v[228:231], v[48:51], v[96:99]
    ds_read_b64_tr_b16 v[244:245], v5 offset:49696
    v_mfma_f32_16x16x32_bf16 v[100:103], v[228:231], v[52:55], v[100:103]
    ds_read_b64_tr_b16 v[246:247], v5 offset:50720
    s_waitcnt lgkmcnt(6)
    v_mfma_f32_16x16x32_bf16 v[104:107], v[232:235], v[48:51], v[104:107]
    s_add_u32 s22, s24, 0x382000
    s_add_u32 m0, s20, 0x14400
    s_nop 0
    buffer_load_dwordx4 v3, s[4:7], s22 offen lds
    ds_read_b64_tr_b16 v[224:225], v4 offset:49920
    v_mfma_f32_16x16x32_bf16 v[108:111], v[232:235], v[52:55], v[108:111]
    ds_read_b64_tr_b16 v[226:227], v4 offset:50944
    s_waitcnt lgkmcnt(6)
    v_mfma_f32_16x16x32_bf16 v[112:115], v[236:239], v[48:51], v[112:115]
    ds_read_b64_tr_b16 v[228:229], v5 offset:49952
    v_mfma_f32_16x16x32_bf16 v[116:119], v[236:239], v[52:55], v[116:119]
    ds_read_b64_tr_b16 v[230:231], v5 offset:50976
    s_waitcnt lgkmcnt(6)
    v_mfma_f32_16x16x32_bf16 v[120:123], v[240:243], v[48:51], v[120:123]
    v_mfma_f32_16x16x32_bf16 v[124:127], v[240:243], v[52:55], v[124:127]
    s_waitcnt vmcnt(13)
    s_barrier
    ds_read_b64_tr_b16 v[232:233], v7 offset:0
    ds_read_b64_tr_b16 v[234:235], v7 offset:1024
    s_waitcnt lgkmcnt(6)
    v_mfma_f32_16x16x32_bf16 v[128:131], v[244:247], v[48:51], v[128:131]
    ds_read_b64_tr_b16 v[236:237], v8 offset:32
    s_mov_b32 s23, 0xe000
    buffer_load_dwordx4 v[40:43], v6, s[8:11], s23 offen offset:0 sc1
    v_mfma_f32_16x16x32_bf16 v[132:135], v[244:247], v[52:55], v[132:135]
    ds_read_b64_tr_b16 v[238:239], v8 offset:1056
    s_waitcnt lgkmcnt(6)
    v_mfma_f32_16x16x32_bf16 v[136:139], v[224:227], v[48:51], v[136:139]
    ds_read_b64_tr_b16 v[240:241], v7 offset:256
    v_mfma_f32_16x16x32_bf16 v[140:143], v[224:227], v[52:55], v[140:143]
    ds_read_b64_tr_b16 v[242:243], v7 offset:1280
    s_mov_b32 s23, 0x2e000
    buffer_load_dwordx4 v[44:47], v6, s[8:11], s23 offen offset:0 sc1
    s_waitcnt lgkmcnt(6)
    v_mfma_f32_16x16x32_bf16 v[144:147], v[228:231], v[48:51], v[144:147]
    ds_read_b64_tr_b16 v[244:245], v8 offset:288
    v_mfma_f32_16x16x32_bf16 v[148:151], v[228:231], v[52:55], v[148:151]
    ds_read_b64_tr_b16 v[246:247], v8 offset:1312
    s_waitcnt vmcnt(6)
    v_cmp_ne_u32 vcc, s28, v12
    s_cbranch_vccnz adaLN_cond__sliding_block_cached__moe_arch_mod__prompt_kernel_o218r
adaLN_cond__sliding_block_cached__moe_arch_mod__prompt_kernel_o218b:
    s_waitcnt lgkmcnt(6)
    v_mfma_f32_16x16x32_bf16 v[88:91], v[232:235], v[56:59], v[88:91]
    ds_read_b64_tr_b16 v[224:225], v7 offset:512
    v_mfma_f32_16x16x32_bf16 v[92:95], v[232:235], v[60:63], v[92:95]
    s_add_u32 s22, s24, 0x10000
    s_add_u32 m0, s20, 0x18000
    s_nop 0
    buffer_load_dwordx4 v3, s[4:7], s22 offen lds
    ds_read_b64_tr_b16 v[226:227], v7 offset:1536
    s_waitcnt lgkmcnt(6)
    v_mfma_f32_16x16x32_bf16 v[96:99], v[236:239], v[56:59], v[96:99]
    ds_read_b64_tr_b16 v[228:229], v8 offset:544
    v_mfma_f32_16x16x32_bf16 v[100:103], v[236:239], v[60:63], v[100:103]
    ds_read_b64_tr_b16 v[230:231], v8 offset:1568
    s_waitcnt lgkmcnt(6)
    v_mfma_f32_16x16x32_bf16 v[104:107], v[240:243], v[56:59], v[104:107]
    s_add_u32 s22, s24, 0x12000
    s_add_u32 m0, s20, 0x18400
    s_nop 0
    buffer_load_dwordx4 v3, s[4:7], s22 offen lds
    ds_read_b64_tr_b16 v[232:233], v7 offset:768
    v_mfma_f32_16x16x32_bf16 v[108:111], v[240:243], v[60:63], v[108:111]
    ds_read_b64_tr_b16 v[234:235], v7 offset:1792
    s_waitcnt lgkmcnt(6)
    v_mfma_f32_16x16x32_bf16 v[112:115], v[244:247], v[56:59], v[112:115]
    ds_read_b64_tr_b16 v[236:237], v8 offset:800
    v_mfma_f32_16x16x32_bf16 v[116:119], v[244:247], v[60:63], v[116:119]
    ds_read_b64_tr_b16 v[238:239], v8 offset:1824
    s_waitcnt lgkmcnt(6)
    v_mfma_f32_16x16x32_bf16 v[120:123], v[224:227], v[56:59], v[120:123]
    v_mfma_f32_16x16x32_bf16 v[124:127], v[224:227], v[60:63], v[124:127]
    s_barrier
    ds_read_b64_tr_b16 v[240:241], v7 offset:16384
    ds_read_b64_tr_b16 v[242:243], v7 offset:17408
    s_waitcnt lgkmcnt(6)
    v_mfma_f32_16x16x32_bf16 v[128:131], v[228:231], v[56:59], v[128:131]
    ds_read_b64_tr_b16 v[244:245], v8 offset:16416
    s_mov_b32 s23, 0x0
    buffer_load_dwordx4 v[48:51], v6, s[8:11], s23 offen offset:1024 sc1
    v_mfma_f32_16x16x32_bf16 v[132:135], v[228:231], v[60:63], v[132:135]
    ds_read_b64_tr_b16 v[246:247], v8 offset:17440
    s_waitcnt lgkmcnt(6)
    v_mfma_f32_16x16x32_bf16 v[136:139], v[232:235], v[56:59], v[136:139]
    ds_read_b64_tr_b16 v[224:225], v7 offset:16640
    v_mfma_f32_16x16x32_bf16 v[140:143], v[232:235], v[60:63], v[140:143]
    ds_read_b64_tr_b16 v[226:227], v7 offset:17664
    s_mov_b32 s23, 0x20000
    buffer_load_dwordx4 v[52:55], v6, s[8:11], s23 offen offset:1024 sc1
    s_waitcnt lgkmcnt(6)
    v_mfma_f32_16x16x32_bf16 v[144:147], v[236:239], v[56:59], v[144:147]
    ds_read_b64_tr_b16 v[228:229], v8 offset:16672
    v_mfma_f32_16x16x32_bf16 v[148:151], v[236:239], v[60:63], v[148:151]
    ds_read_b64_tr_b16 v[230:231], v8 offset:17696
    s_waitcnt lgkmcnt(6)
    v_mfma_f32_16x16x32_bf16 v[88:91], v[240:243], v[24:27], v[88:91]
    ds_read_b64_tr_b16 v[232:233], v7 offset:16896
    v_mfma_f32_16x16x32_bf16 v[92:95], v[240:243], v[28:31], v[92:95]
    s_add_u32 s22, s24, 0x90000
    s_add_u32 m0, s20, 0x1c000
    s_nop 0
    buffer_load_dwordx4 v3, s[4:7], s22 offen lds
    ds_read_b64_tr_b16 v[234:235], v7 offset:17920
    s_waitcnt lgkmcnt(6)
    v_mfma_f32_16x16x32_bf16 v[96:99], v[244:247], v[24:27], v[96:99]
    ds_read_b64_tr_b16 v[236:237], v8 offset:16928
    v_mfma_f32_16x16x32_bf16 v[100:103], v[244:247], v[28:31], v[100:103]
    ds_read_b64_tr_b16 v[238:239], v8 offset:17952
    s_waitcnt lgkmcnt(6)
    v_mfma_f32_16x16x32_bf16 v[104:107], v[224:227], v[24:27], v[104:107]
    s_add_u32 s22, s24, 0x92000
    s_add_u32 m0, s20, 0x1c400
    s_nop 0
    buffer_load_dwordx4 v3, s[4:7], s22 offen lds
    ds_read_b64_tr_b16 v[240:241], v7 offset:17152
    v_mfma_f32_16x16x32_bf16 v[108:111], v[224:227], v[28:31], v[108:111]
    ds_read_b64_tr_b16 v[242:243], v7 offset:18176
    s_waitcnt lgkmcnt(6)
    v_mfma_f32_16x16x32_bf16 v[112:115], v[228:231], v[24:27], v[112:115]
    ds_read_b64_tr_b16 v[244:245], v8 offset:17184
    v_mfma_f32_16x16x32_bf16 v[116:119], v[228:231], v[28:31], v[116:119]
    ds_read_b64_tr_b16 v[246:247], v8 offset:18208
    s_waitcnt lgkmcnt(6)
    v_mfma_f32_16x16x32_bf16 v[120:123], v[232:235], v[24:27], v[120:123]
    v_mfma_f32_16x16x32_bf16 v[124:127], v[232:235], v[28:31], v[124:127]
    s_barrier
    ds_read_b64_tr_b16 v[224:225], v4 offset:0
    ds_read_b64_tr_b16 v[226:227], v4 offset:1024
    s_waitcnt lgkmcnt(6)
    v_mfma_f32_16x16x32_bf16 v[128:131], v[236:239], v[24:27], v[128:131]
    s_add_u32 s16, s63, 0x576000
    v_mov_b32 v14, s28
    v_mov_b32 v15, 0
    s_mov_b64 exec, 1
    buffer_store_dword v14, v15, s[8:11], s16 offen sc1
    s_mov_b64 exec, -1
    ds_read_b64_tr_b16 v[228:229], v5 offset:32
    s_mov_b32 s23, 0x2000
    buffer_load_dwordx4 v[56:59], v6, s[8:11], s23 offen offset:1024 sc1
    v_mfma_f32_16x16x32_bf16 v[132:135], v[236:239], v[28:31], v[132:135]
    ds_read_b64_tr_b16 v[230:231], v5 offset:1056
    s_waitcnt lgkmcnt(6)
    v_mfma_f32_16x16x32_bf16 v[136:139], v[240:243], v[24:27], v[136:139]
    ds_read_b64_tr_b16 v[232:233], v4 offset:256
    v_mfma_f32_16x16x32_bf16 v[140:143], v[240:243], v[28:31], v[140:143]
    ds_read_b64_tr_b16 v[234:235], v4 offset:1280
    s_mov_b32 s23, 0x22000
    buffer_load_dwordx4 v[60:63], v6, s[8:11], s23 offen offset:1024 sc1
    s_waitcnt lgkmcnt(6)
    v_mfma_f32_16x16x32_bf16 v[144:147], v[244:247], v[24:27], v[144:147]
    ds_read_b64_tr_b16 v[236:237], v5 offset:288
    v_mfma_f32_16x16x32_bf16 v[148:151], v[244:247], v[28:31], v[148:151]
    ds_read_b64_tr_b16 v[238:239], v5 offset:1312
    s_waitcnt vmcnt(14) lgkmcnt(6)
    v_mfma_f32_16x16x32_bf16 v[88:91], v[224:227], v[32:35], v[88:91]
    ds_read_b64_tr_b16 v[240:241], v4 offset:512
    s_waitcnt vmcnt(13)
    v_mfma_f32_16x16x32_bf16 v[92:95], v[224:227], v[36:39], v[92:95]
    s_add_u32 s22, s24, 0x110000
    s_add_u32 m0, s20, 0x20000
    s_nop 0
    buffer_load_dwordx4 v3, s[4:7], s22 offen lds
    ds_read_b64_tr_b16 v[242:243], v4 offset:1536
    s_waitcnt lgkmcnt(6)
    v_mfma_f32_16x16x32_bf16 v[96:99], v[228:231], v[32:35], v[96:99]
    ds_read_b64_tr_b16 v[244:245], v5 offset:544
    v_mfma_f32_16x16x32_bf16 v[100:103], v[228:231], v[36:39], v[100:103]
    ds_read_b64_tr_b16 v[246:247], v5 offset:1568
    s_waitcnt lgkmcnt(6)
    v_mfma_f32_16x16x32_bf16 v[104:107], v[232:235], v[32:35], v[104:107]
    s_add_u32 s22, s24, 0x112000
    s_add_u32 m0, s20, 0x20400
    s_nop 0
    buffer_load_dwordx4 v3, s[4:7], s22 offen lds
    ds_read_b64_tr_b16 v[224:225], v4 offset:768
    v_mfma_f32_16x16x32_bf16 v[108:111], v[232:235], v[36:39], v[108:111]
    ds_read_b64_tr_b16 v[226:227], v4 offset:1792
    s_waitcnt lgkmcnt(6)
    v_mfma_f32_16x16x32_bf16 v[112:115], v[236:239], v[32:35], v[112:115]
    ds_read_b64_tr_b16 v[228:229], v5 offset:800
    v_mfma_f32_16x16x32_bf16 v[116:119], v[236:239], v[36:39], v[116:119]
    ds_read_b64_tr_b16 v[230:231], v5 offset:1824
    s_waitcnt lgkmcnt(6)
    v_mfma_f32_16x16x32_bf16 v[120:123], v[240:243], v[32:35], v[120:123]
    v_mfma_f32_16x16x32_bf16 v[124:127], v[240:243], v[36:39], v[124:127]
    s_waitcnt vmcnt(13)
    s_barrier
    ds_read_b64_tr_b16 v[232:233], v4 offset:16384
    ds_read_b64_tr_b16 v[234:235], v4 offset:17408
    s_waitcnt lgkmcnt(6)
    v_mfma_f32_16x16x32_bf16 v[128:131], v[244:247], v[32:35], v[128:131]
    ds_read_b64_tr_b16 v[236:237], v5 offset:16416
    s_mov_b32 s23, 0x4000
    buffer_load_dwordx4 v[24:27], v6, s[8:11], s23 offen offset:1024 sc1
    v_mfma_f32_16x16x32_bf16 v[132:135], v[244:247], v[36:39], v[132:135]
    ds_read_b64_tr_b16 v[238:239], v5 offset:17440
    s_waitcnt lgkmcnt(6)
    v_mfma_f32_16x16x32_bf16 v[136:139], v[224:227], v[32:35], v[136:139]
    ds_read_b64_tr_b16 v[240:241], v4 offset:16640
    v_mfma_f32_16x16x32_bf16 v[140:143], v[224:227], v[36:39], v[140:143]
    ds_read_b64_tr_b16 v[242:243], v4 offset:17664
    s_mov_b32 s23, 0x24000
    buffer_load_dwordx4 v[28:31], v6, s[8:11], s23 offen offset:1024 sc1
    s_waitcnt lgkmcnt(6)
    v_mfma_f32_16x16x32_bf16 v[144:147], v[228:231], v[32:35], v[144:147]
    ds_read_b64_tr_b16 v[244:245], v5 offset:16672
    v_mfma_f32_16x16x32_bf16 v[148:151], v[228:231], v[36:39], v[148:151]
    ds_read_b64_tr_b16 v[246:247], v5 offset:17696
    s_waitcnt vmcnt(14) lgkmcnt(6)
    v_mfma_f32_16x16x32_bf16 v[88:91], v[232:235], v[40:43], v[88:91]
    ds_read_b64_tr_b16 v[224:225], v4 offset:16896
    s_waitcnt vmcnt(13)
    v_mfma_f32_16x16x32_bf16 v[92:95], v[232:235], v[44:47], v[92:95]
    s_add_u32 s22, s24, 0x190000
    s_add_u32 m0, s20, 0x24000
    s_nop 0
    buffer_load_dwordx4 v3, s[4:7], s22 offen lds
    ds_read_b64_tr_b16 v[226:227], v4 offset:17920
    s_waitcnt lgkmcnt(6)
    v_mfma_f32_16x16x32_bf16 v[96:99], v[236:239], v[40:43], v[96:99]
    ds_read_b64_tr_b16 v[228:229], v5 offset:16928
    v_mfma_f32_16x16x32_bf16 v[100:103], v[236:239], v[44:47], v[100:103]
    ds_read_b64_tr_b16 v[230:231], v5 offset:17952
    s_waitcnt lgkmcnt(6)
    v_mfma_f32_16x16x32_bf16 v[104:107], v[240:243], v[40:43], v[104:107]
    s_add_u32 s22, s24, 0x192000
    s_add_u32 m0, s20, 0x24400
    s_nop 0
    buffer_load_dwordx4 v3, s[4:7], s22 offen lds
    ds_read_b64_tr_b16 v[232:233], v4 offset:17152
    v_mfma_f32_16x16x32_bf16 v[108:111], v[240:243], v[44:47], v[108:111]
    ds_read_b64_tr_b16 v[234:235], v4 offset:18176
    s_waitcnt lgkmcnt(6)
    v_mfma_f32_16x16x32_bf16 v[112:115], v[244:247], v[40:43], v[112:115]
    ds_read_b64_tr_b16 v[236:237], v5 offset:17184
    v_mfma_f32_16x16x32_bf16 v[116:119], v[244:247], v[44:47], v[116:119]
    ds_read_b64_tr_b16 v[238:239], v5 offset:18208
    s_waitcnt lgkmcnt(6)
    v_mfma_f32_16x16x32_bf16 v[120:123], v[224:227], v[40:43], v[120:123]
    v_mfma_f32_16x16x32_bf16 v[124:127], v[224:227], v[44:47], v[124:127]
    s_waitcnt vmcnt(13)
    s_barrier
    ds_read_b64_tr_b16 v[240:241], v4 offset:32768
    ds_read_b64_tr_b16 v[242:243], v4 offset:33792
    s_waitcnt lgkmcnt(6)
    v_mfma_f32_16x16x32_bf16 v[128:131], v[228:231], v[40:43], v[128:131]
    ds_read_b64_tr_b16 v[244:245], v5 offset:32800
    s_mov_b32 s23, 0x6000
    buffer_load_dwordx4 v[32:35], v6, s[8:11], s23 offen offset:1024 sc1
    v_mfma_f32_16x16x32_bf16 v[132:135], v[228:231], v[44:47], v[132:135]
    ds_read_b64_tr_b16 v[246:247], v5 offset:33824
    s_waitcnt lgkmcnt(6)
    v_mfma_f32_16x16x32_bf16 v[136:139], v[232:235], v[40:43], v[136:139]
    ds_read_b64_tr_b16 v[224:225], v4 offset:33024
    v_mfma_f32_16x16x32_bf16 v[140:143], v[232:235], v[44:47], v[140:143]
    ds_read_b64_tr_b16 v[226:227], v4 offset:34048
    s_mov_b32 s23, 0x26000
    buffer_load_dwordx4 v[36:39], v6, s[8:11], s23 offen offset:1024 sc1
    s_waitcnt lgkmcnt(6)
    v_mfma_f32_16x16x32_bf16 v[144:147], v[236:239], v[40:43], v[144:147]
    ds_read_b64_tr_b16 v[228:229], v5 offset:33056
    v_mfma_f32_16x16x32_bf16 v[148:151], v[236:239], v[44:47], v[148:151]
    ds_read_b64_tr_b16 v[230:231], v5 offset:34080
    s_waitcnt vmcnt(14) lgkmcnt(6)
    v_mfma_f32_16x16x32_bf16 v[88:91], v[240:243], v[48:51], v[88:91]
    ds_read_b64_tr_b16 v[232:233], v4 offset:33280
    s_waitcnt vmcnt(13)
    v_mfma_f32_16x16x32_bf16 v[92:95], v[240:243], v[52:55], v[92:95]
    s_add_u32 s22, s24, 0x210000
    s_add_u32 m0, s20, 0x10000
    s_nop 0
    buffer_load_dwordx4 v3, s[4:7], s22 offen lds
    ds_read_b64_tr_b16 v[234:235], v4 offset:34304
    s_waitcnt lgkmcnt(6)
    v_mfma_f32_16x16x32_bf16 v[96:99], v[244:247], v[48:51], v[96:99]
    ds_read_b64_tr_b16 v[236:237], v5 offset:33312
    v_mfma_f32_16x16x32_bf16 v[100:103], v[244:247], v[52:55], v[100:103]
    ds_read_b64_tr_b16 v[238:239], v5 offset:34336
    s_waitcnt lgkmcnt(6)
    v_mfma_f32_16x16x32_bf16 v[104:107], v[224:227], v[48:51], v[104:107]
    s_add_u32 s22, s24, 0x212000
    s_add_u32 m0, s20, 0x10400
    s_nop 0
    buffer_load_dwordx4 v3, s[4:7], s22 offen lds
    ds_read_b64_tr_b16 v[240:241], v4 offset:33536
    v_mfma_f32_16x16x32_bf16 v[108:111], v[224:227], v[52:55], v[108:111]
    ds_read_b64_tr_b16 v[242:243], v4 offset:34560
    s_waitcnt lgkmcnt(6)
    v_mfma_f32_16x16x32_bf16 v[112:115], v[228:231], v[48:51], v[112:115]
    ds_read_b64_tr_b16 v[244:245], v5 offset:33568
    v_mfma_f32_16x16x32_bf16 v[116:119], v[228:231], v[52:55], v[116:119]
    ds_read_b64_tr_b16 v[246:247], v5 offset:34592
    s_waitcnt lgkmcnt(6)
    v_mfma_f32_16x16x32_bf16 v[120:123], v[232:235], v[48:51], v[120:123]
    v_mfma_f32_16x16x32_bf16 v[124:127], v[232:235], v[52:55], v[124:127]
    s_waitcnt vmcnt(13)
    s_barrier
    ds_read_b64_tr_b16 v[224:225], v4 offset:49152
    ds_read_b64_tr_b16 v[226:227], v4 offset:50176
    s_waitcnt lgkmcnt(6)
    v_mfma_f32_16x16x32_bf16 v[128:131], v[236:239], v[48:51], v[128:131]
    ds_read_b64_tr_b16 v[228:229], v5 offset:49184
    s_mov_b32 s23, 0x8000
    buffer_load_dwordx4 v[40:43], v6, s[8:11], s23 offen offset:1024 sc1
    v_mfma_f32_16x16x32_bf16 v[132:135], v[236:239], v[52:55], v[132:135]
    ds_read_b64_tr_b16 v[230:231], v5 offset:50208
    s_waitcnt lgkmcnt(6)
    v_mfma_f32_16x16x32_bf16 v[136:139], v[240:243], v[48:51], v[136:139]
    ds_read_b64_tr_b16 v[232:233], v4 offset:49408
    v_mfma_f32_16x16x32_bf16 v[140:143], v[240:243], v[52:55], v[140:143]
    ds_read_b64_tr_b16 v[234:235], v4 offset:50432
    s_mov_b32 s23, 0x28000
    buffer_load_dwordx4 v[44:47], v6, s[8:11], s23 offen offset:1024 sc1
    s_waitcnt lgkmcnt(6)
    v_mfma_f32_16x16x32_bf16 v[144:147], v[244:247], v[48:51], v[144:147]
    ds_read_b64_tr_b16 v[236:237], v5 offset:49440
    v_mfma_f32_16x16x32_bf16 v[148:151], v[244:247], v[52:55], v[148:151]
    ds_read_b64_tr_b16 v[238:239], v5 offset:50464
    s_waitcnt vmcnt(13) lgkmcnt(6)
    v_mfma_f32_16x16x32_bf16 v[88:91], v[224:227], v[56:59], v[88:91]
    ds_read_b64_tr_b16 v[240:241], v4 offset:49664
    s_waitcnt vmcnt(12)
    v_mfma_f32_16x16x32_bf16 v[92:95], v[224:227], v[60:63], v[92:95]
    s_add_u32 s22, s24, 0x290000
    s_add_u32 m0, s20, 0x14000
    s_nop 0
    buffer_load_dwordx4 v3, s[4:7], s22 offen lds
    ds_read_b64_tr_b16 v[242:243], v4 offset:50688
    s_waitcnt lgkmcnt(6)
    v_mfma_f32_16x16x32_bf16 v[96:99], v[228:231], v[56:59], v[96:99]
    ds_read_b64_tr_b16 v[244:245], v5 offset:49696
    v_mfma_f32_16x16x32_bf16 v[100:103], v[228:231], v[60:63], v[100:103]
    ds_read_b64_tr_b16 v[246:247], v5 offset:50720
    s_waitcnt lgkmcnt(6)
    v_mfma_f32_16x16x32_bf16 v[104:107], v[232:235], v[56:59], v[104:107]
    s_add_u32 s22, s24, 0x292000
    s_add_u32 m0, s20, 0x14400
    s_nop 0
    buffer_load_dwordx4 v3, s[4:7], s22 offen lds
    ds_read_b64_tr_b16 v[224:225], v4 offset:49920
    v_mfma_f32_16x16x32_bf16 v[108:111], v[232:235], v[60:63], v[108:111]
    ds_read_b64_tr_b16 v[226:227], v4 offset:50944
    s_waitcnt lgkmcnt(6)
    v_mfma_f32_16x16x32_bf16 v[112:115], v[236:239], v[56:59], v[112:115]
    ds_read_b64_tr_b16 v[228:229], v5 offset:49952
    v_mfma_f32_16x16x32_bf16 v[116:119], v[236:239], v[60:63], v[116:119]
    ds_read_b64_tr_b16 v[230:231], v5 offset:50976
    s_waitcnt lgkmcnt(6)
    v_mfma_f32_16x16x32_bf16 v[120:123], v[240:243], v[56:59], v[120:123]
    v_mfma_f32_16x16x32_bf16 v[124:127], v[240:243], v[60:63], v[124:127]
    s_waitcnt vmcnt(12)
    s_barrier
    ds_read_b64_tr_b16 v[232:233], v7 offset:0
    ds_read_b64_tr_b16 v[234:235], v7 offset:1024
    s_waitcnt lgkmcnt(6)
    v_mfma_f32_16x16x32_bf16 v[128:131], v[244:247], v[56:59], v[128:131]
    ds_read_b64_tr_b16 v[236:237], v8 offset:32
    s_mov_b32 s23, 0xa000
    buffer_load_dwordx4 v[48:51], v6, s[8:11], s23 offen offset:1024 sc1
    v_mfma_f32_16x16x32_bf16 v[132:135], v[244:247], v[60:63], v[132:135]
    ds_read_b64_tr_b16 v[238:239], v8 offset:1056
    s_waitcnt lgkmcnt(6)
    v_mfma_f32_16x16x32_bf16 v[136:139], v[224:227], v[56:59], v[136:139]
    ds_read_b64_tr_b16 v[240:241], v7 offset:256
    v_mfma_f32_16x16x32_bf16 v[140:143], v[224:227], v[60:63], v[140:143]
    ds_read_b64_tr_b16 v[242:243], v7 offset:1280
    s_mov_b32 s23, 0x2a000
    buffer_load_dwordx4 v[52:55], v6, s[8:11], s23 offen offset:1024 sc1
    s_waitcnt lgkmcnt(6)
    v_mfma_f32_16x16x32_bf16 v[144:147], v[228:231], v[56:59], v[144:147]
    ds_read_b64_tr_b16 v[244:245], v8 offset:288
    v_mfma_f32_16x16x32_bf16 v[148:151], v[228:231], v[60:63], v[148:151]
    ds_read_b64_tr_b16 v[246:247], v8 offset:1312
    s_waitcnt vmcnt(13) lgkmcnt(6)
    v_mfma_f32_16x16x32_bf16 v[88:91], v[232:235], v[24:27], v[88:91]
    ds_read_b64_tr_b16 v[224:225], v7 offset:512
    s_waitcnt vmcnt(12)
    v_mfma_f32_16x16x32_bf16 v[92:95], v[232:235], v[28:31], v[92:95]
    s_add_u32 s22, s24, 0x310000
    s_add_u32 m0, s20, 0x18000
    s_nop 0
    buffer_load_dwordx4 v3, s[4:7], s22 offen lds
    ds_read_b64_tr_b16 v[226:227], v7 offset:1536
    s_waitcnt lgkmcnt(6)
    v_mfma_f32_16x16x32_bf16 v[96:99], v[236:239], v[24:27], v[96:99]
    ds_read_b64_tr_b16 v[228:229], v8 offset:544
    v_mfma_f32_16x16x32_bf16 v[100:103], v[236:239], v[28:31], v[100:103]
    ds_read_b64_tr_b16 v[230:231], v8 offset:1568
    s_waitcnt lgkmcnt(6)
    v_mfma_f32_16x16x32_bf16 v[104:107], v[240:243], v[24:27], v[104:107]
    s_add_u32 s22, s24, 0x312000
    s_add_u32 m0, s20, 0x18400
    s_nop 0
    buffer_load_dwordx4 v3, s[4:7], s22 offen lds
    ds_read_b64_tr_b16 v[232:233], v7 offset:768
    v_mfma_f32_16x16x32_bf16 v[108:111], v[240:243], v[28:31], v[108:111]
    ds_read_b64_tr_b16 v[234:235], v7 offset:1792
    s_waitcnt lgkmcnt(6)
    v_mfma_f32_16x16x32_bf16 v[112:115], v[244:247], v[24:27], v[112:115]
    ds_read_b64_tr_b16 v[236:237], v8 offset:800
    v_mfma_f32_16x16x32_bf16 v[116:119], v[244:247], v[28:31], v[116:119]
    ds_read_b64_tr_b16 v[238:239], v8 offset:1824
    s_waitcnt lgkmcnt(6)
    v_mfma_f32_16x16x32_bf16 v[120:123], v[224:227], v[24:27], v[120:123]
    v_mfma_f32_16x16x32_bf16 v[124:127], v[224:227], v[28:31], v[124:127]
    s_waitcnt vmcnt(12)
    s_barrier
    ds_read_b64_tr_b16 v[240:241], v7 offset:16384
    ds_read_b64_tr_b16 v[242:243], v7 offset:17408
    s_add_u32 s19, s19, 8192
    buffer_load_dword v12, v13, s[8:11], s19 offen sc1
    s_waitcnt lgkmcnt(6)
    v_mfma_f32_16x16x32_bf16 v[128:131], v[228:231], v[24:27], v[128:131]
    ds_read_b64_tr_b16 v[244:245], v8 offset:16416
    s_mov_b32 s23, 0xc000
    buffer_load_dwordx4 v[56:59], v6, s[8:11], s23 offen offset:1024 sc1
    v_mfma_f32_16x16x32_bf16 v[132:135], v[228:231], v[28:31], v[132:135]
    ds_read_b64_tr_b16 v[246:247], v8 offset:17440
    s_waitcnt lgkmcnt(6)
    v_mfma_f32_16x16x32_bf16 v[136:139], v[232:235], v[24:27], v[136:139]
    ds_read_b64_tr_b16 v[224:225], v7 offset:16640
    v_mfma_f32_16x16x32_bf16 v[140:143], v[232:235], v[28:31], v[140:143]
    ds_read_b64_tr_b16 v[226:227], v7 offset:17664
    s_mov_b32 s23, 0x2c000
    buffer_load_dwordx4 v[60:63], v6, s[8:11], s23 offen offset:1024 sc1
    s_waitcnt lgkmcnt(6)
    v_mfma_f32_16x16x32_bf16 v[144:147], v[236:239], v[24:27], v[144:147]
    ds_read_b64_tr_b16 v[228:229], v8 offset:16672
    v_mfma_f32_16x16x32_bf16 v[148:151], v[236:239], v[28:31], v[148:151]
    ds_read_b64_tr_b16 v[230:231], v8 offset:17696
    s_waitcnt vmcnt(14) lgkmcnt(6)
    v_mfma_f32_16x16x32_bf16 v[88:91], v[240:243], v[32:35], v[88:91]
    ds_read_b64_tr_b16 v[232:233], v7 offset:16896
    s_waitcnt vmcnt(13)
    v_mfma_f32_16x16x32_bf16 v[92:95], v[240:243], v[36:39], v[92:95]
    s_add_u32 s22, s24, 0x390000
    s_add_u32 m0, s20, 0x1c000
    s_nop 0
    buffer_load_dwordx4 v3, s[4:7], s22 offen lds
    ds_read_b64_tr_b16 v[234:235], v7 offset:17920
    s_waitcnt lgkmcnt(6)
    v_mfma_f32_16x16x32_bf16 v[96:99], v[244:247], v[32:35], v[96:99]
    ds_read_b64_tr_b16 v[236:237], v8 offset:16928
    v_mfma_f32_16x16x32_bf16 v[100:103], v[244:247], v[36:39], v[100:103]
    ds_read_b64_tr_b16 v[238:239], v8 offset:17952
    s_waitcnt lgkmcnt(6)
    v_mfma_f32_16x16x32_bf16 v[104:107], v[224:227], v[32:35], v[104:107]
    s_add_u32 s22, s24, 0x392000
    s_add_u32 m0, s20, 0x1c400
    s_nop 0
    buffer_load_dwordx4 v3, s[4:7], s22 offen lds
    ds_read_b64_tr_b16 v[240:241], v7 offset:17152
    v_mfma_f32_16x16x32_bf16 v[108:111], v[224:227], v[36:39], v[108:111]
    ds_read_b64_tr_b16 v[242:243], v7 offset:18176
    s_waitcnt lgkmcnt(6)
    v_mfma_f32_16x16x32_bf16 v[112:115], v[228:231], v[32:35], v[112:115]
    ds_read_b64_tr_b16 v[244:245], v8 offset:17184
    v_mfma_f32_16x16x32_bf16 v[116:119], v[228:231], v[36:39], v[116:119]
    ds_read_b64_tr_b16 v[246:247], v8 offset:18208
    s_waitcnt lgkmcnt(6)
    v_mfma_f32_16x16x32_bf16 v[120:123], v[232:235], v[32:35], v[120:123]
    v_mfma_f32_16x16x32_bf16 v[124:127], v[232:235], v[36:39], v[124:127]
    s_waitcnt vmcnt(13)
    s_barrier
    ds_read_b64_tr_b16 v[224:225], v4 offset:0
    ds_read_b64_tr_b16 v[226:227], v4 offset:1024
    s_waitcnt lgkmcnt(6)
    v_mfma_f32_16x16x32_bf16 v[128:131], v[236:239], v[32:35], v[128:131]
    ds_read_b64_tr_b16 v[228:229], v5 offset:32
    s_mov_b32 s23, 0xe000
    buffer_load_dwordx4 v[24:27], v6, s[8:11], s23 offen offset:1024 sc1
    v_mfma_f32_16x16x32_bf16 v[132:135], v[236:239], v[36:39], v[132:135]
    ds_read_b64_tr_b16 v[230:231], v5 offset:1056
    s_waitcnt lgkmcnt(6)
    v_mfma_f32_16x16x32_bf16 v[136:139], v[240:243], v[32:35], v[136:139]
    ds_read_b64_tr_b16 v[232:233], v4 offset:256
    v_mfma_f32_16x16x32_bf16 v[140:143], v[240:243], v[36:39], v[140:143]
    ds_read_b64_tr_b16 v[234:235], v4 offset:1280
    s_mov_b32 s23, 0x2e000
    buffer_load_dwordx4 v[28:31], v6, s[8:11], s23 offen offset:1024 sc1
    s_waitcnt lgkmcnt(6)
    v_mfma_f32_16x16x32_bf16 v[144:147], v[244:247], v[32:35], v[144:147]
    ds_read_b64_tr_b16 v[236:237], v5 offset:288
    v_mfma_f32_16x16x32_bf16 v[148:151], v[244:247], v[36:39], v[148:151]
    ds_read_b64_tr_b16 v[238:239], v5 offset:1312
    s_waitcnt vmcnt(6)
    v_cmp_ne_u32 vcc, s28, v12
    s_cbranch_vccnz adaLN_cond__sliding_block_cached__moe_arch_mod__prompt_kernel_o219r
adaLN_cond__sliding_block_cached__moe_arch_mod__prompt_kernel_o219b:
    s_waitcnt lgkmcnt(6)
    v_mfma_f32_16x16x32_bf16 v[88:91], v[224:227], v[40:43], v[88:91]
    ds_read_b64_tr_b16 v[240:241], v4 offset:512
    v_mfma_f32_16x16x32_bf16 v[92:95], v[224:227], v[44:47], v[92:95]
    s_add_u32 s22, s24, 0x20000
    s_add_u32 m0, s20, 0x20000
    s_nop 0
    buffer_load_dwordx4 v3, s[4:7], s22 offen lds
    ds_read_b64_tr_b16 v[242:243], v4 offset:1536
    s_waitcnt lgkmcnt(6)
    v_mfma_f32_16x16x32_bf16 v[96:99], v[228:231], v[40:43], v[96:99]
    ds_read_b64_tr_b16 v[244:245], v5 offset:544
    v_mfma_f32_16x16x32_bf16 v[100:103], v[228:231], v[44:47], v[100:103]
    ds_read_b64_tr_b16 v[246:247], v5 offset:1568
    s_waitcnt lgkmcnt(6)
    v_mfma_f32_16x16x32_bf16 v[104:107], v[232:235], v[40:43], v[104:107]
    s_add_u32 s22, s24, 0x22000
    s_add_u32 m0, s20, 0x20400
    s_nop 0
    buffer_load_dwordx4 v3, s[4:7], s22 offen lds
    ds_read_b64_tr_b16 v[224:225], v4 offset:768
    v_mfma_f32_16x16x32_bf16 v[108:111], v[232:235], v[44:47], v[108:111]
    ds_read_b64_tr_b16 v[226:227], v4 offset:1792
    s_waitcnt lgkmcnt(6)
    v_mfma_f32_16x16x32_bf16 v[112:115], v[236:239], v[40:43], v[112:115]
    ds_read_b64_tr_b16 v[228:229], v5 offset:800
    v_mfma_f32_16x16x32_bf16 v[116:119], v[236:239], v[44:47], v[116:119]
    ds_read_b64_tr_b16 v[230:231], v5 offset:1824
    s_waitcnt lgkmcnt(6)
    v_mfma_f32_16x16x32_bf16 v[120:123], v[240:243], v[40:43], v[120:123]
    v_mfma_f32_16x16x32_bf16 v[124:127], v[240:243], v[44:47], v[124:127]
    s_barrier
    ds_read_b64_tr_b16 v[232:233], v4 offset:16384
    ds_read_b64_tr_b16 v[234:235], v4 offset:17408
    s_waitcnt lgkmcnt(6)
    v_mfma_f32_16x16x32_bf16 v[128:131], v[244:247], v[40:43], v[128:131]
    ds_read_b64_tr_b16 v[236:237], v5 offset:16416
    s_mov_b32 s23, 0x0
    buffer_load_dwordx4 v[32:35], v6, s[8:11], s23 offen offset:2048 sc1
    v_mfma_f32_16x16x32_bf16 v[132:135], v[244:247], v[44:47], v[132:135]
    ds_read_b64_tr_b16 v[238:239], v5 offset:17440
    s_waitcnt lgkmcnt(6)
    v_mfma_f32_16x16x32_bf16 v[136:139], v[224:227], v[40:43], v[136:139]
    ds_read_b64_tr_b16 v[240:241], v4 offset:16640
    v_mfma_f32_16x16x32_bf16 v[140:143], v[224:227], v[44:47], v[140:143]
    ds_read_b64_tr_b16 v[242:243], v4 offset:17664
    s_mov_b32 s23, 0x20000
    buffer_load_dwordx4 v[36:39], v6, s[8:11], s23 offen offset:2048 sc1
    s_waitcnt lgkmcnt(6)
    v_mfma_f32_16x16x32_bf16 v[144:147], v[228:231], v[40:43], v[144:147]
    ds_read_b64_tr_b16 v[244:245], v5 offset:16672
    v_mfma_f32_16x16x32_bf16 v[148:151], v[228:231], v[44:47], v[148:151]
    ds_read_b64_tr_b16 v[246:247], v5 offset:17696
    s_waitcnt lgkmcnt(6)
    v_mfma_f32_16x16x32_bf16 v[88:91], v[232:235], v[48:51], v[88:91]
    ds_read_b64_tr_b16 v[224:225], v4 offset:16896
    v_mfma_f32_16x16x32_bf16 v[92:95], v[232:235], v[52:55], v[92:95]
    s_add_u32 s22, s24, 0xa0000
    s_add_u32 m0, s20, 0x24000
    s_nop 0
    buffer_load_dwordx4 v3, s[4:7], s22 offen lds
    ds_read_b64_tr_b16 v[226:227], v4 offset:17920
    s_waitcnt lgkmcnt(6)
    v_mfma_f32_16x16x32_bf16 v[96:99], v[236:239], v[48:51], v[96:99]
    ds_read_b64_tr_b16 v[228:229], v5 offset:16928
    v_mfma_f32_16x16x32_bf16 v[100:103], v[236:239], v[52:55], v[100:103]
    ds_read_b64_tr_b16 v[230:231], v5 offset:17952
    s_waitcnt lgkmcnt(6)
    v_mfma_f32_16x16x32_bf16 v[104:107], v[240:243], v[48:51], v[104:107]
    s_add_u32 s22, s24, 0xa2000
    s_add_u32 m0, s20, 0x24400
    s_nop 0
    buffer_load_dwordx4 v3, s[4:7], s22 offen lds
    ds_read_b64_tr_b16 v[232:233], v4 offset:17152
    v_mfma_f32_16x16x32_bf16 v[108:111], v[240:243], v[52:55], v[108:111]
    ds_read_b64_tr_b16 v[234:235], v4 offset:18176
    s_waitcnt lgkmcnt(6)
    v_mfma_f32_16x16x32_bf16 v[112:115], v[244:247], v[48:51], v[112:115]
    ds_read_b64_tr_b16 v[236:237], v5 offset:17184
    v_mfma_f32_16x16x32_bf16 v[116:119], v[244:247], v[52:55], v[116:119]
    ds_read_b64_tr_b16 v[238:239], v5 offset:18208
    s_waitcnt lgkmcnt(6)
    v_mfma_f32_16x16x32_bf16 v[120:123], v[224:227], v[48:51], v[120:123]
    v_mfma_f32_16x16x32_bf16 v[124:127], v[224:227], v[52:55], v[124:127]
    s_barrier
    ds_read_b64_tr_b16 v[240:241], v4 offset:32768
    ds_read_b64_tr_b16 v[242:243], v4 offset:33792
    s_waitcnt lgkmcnt(6)
    v_mfma_f32_16x16x32_bf16 v[128:131], v[228:231], v[48:51], v[128:131]
    ds_read_b64_tr_b16 v[244:245], v5 offset:32800
    s_mov_b32 s23, 0x2000
    buffer_load_dwordx4 v[40:43], v6, s[8:11], s23 offen offset:2048 sc1
    v_mfma_f32_16x16x32_bf16 v[132:135], v[228:231], v[52:55], v[132:135]
    ds_read_b64_tr_b16 v[246:247], v5 offset:33824
    s_waitcnt lgkmcnt(6)
    v_mfma_f32_16x16x32_bf16 v[136:139], v[232:235], v[48:51], v[136:139]
    ds_read_b64_tr_b16 v[224:225], v4 offset:33024
    v_mfma_f32_16x16x32_bf16 v[140:143], v[232:235], v[52:55], v[140:143]
    ds_read_b64_tr_b16 v[226:227], v4 offset:34048
    s_mov_b32 s23, 0x22000
    buffer_load_dwordx4 v[44:47], v6, s[8:11], s23 offen offset:2048 sc1
    s_waitcnt lgkmcnt(6)
    v_mfma_f32_16x16x32_bf16 v[144:147], v[236:239], v[48:51], v[144:147]
    ds_read_b64_tr_b16 v[228:229], v5 offset:33056
    v_mfma_f32_16x16x32_bf16 v[148:151], v[236:239], v[52:55], v[148:151]
    ds_read_b64_tr_b16 v[230:231], v5 offset:34080
    s_waitcnt vmcnt(13) lgkmcnt(6)
    v_mfma_f32_16x16x32_bf16 v[88:91], v[240:243], v[56:59], v[88:91]
    ds_read_b64_tr_b16 v[232:233], v4 offset:33280
    s_waitcnt vmcnt(12)
    v_mfma_f32_16x16x32_bf16 v[92:95], v[240:243], v[60:63], v[92:95]
    s_add_u32 s22, s24, 0x120000
    s_add_u32 m0, s20, 0x10000
    s_nop 0
    buffer_load_dwordx4 v3, s[4:7], s22 offen lds
    ds_read_b64_tr_b16 v[234:235], v4 offset:34304
    s_waitcnt lgkmcnt(6)
    v_mfma_f32_16x16x32_bf16 v[96:99], v[244:247], v[56:59], v[96:99]
    ds_read_b64_tr_b16 v[236:237], v5 offset:33312
    v_mfma_f32_16x16x32_bf16 v[100:103], v[244:247], v[60:63], v[100:103]
    ds_read_b64_tr_b16 v[238:239], v5 offset:34336
    s_waitcnt lgkmcnt(6)
    v_mfma_f32_16x16x32_bf16 v[104:107], v[224:227], v[56:59], v[104:107]
    s_add_u32 s22, s24, 0x122000
    s_add_u32 m0, s20, 0x10400
    s_nop 0
    buffer_load_dwordx4 v3, s[4:7], s22 offen lds
    ds_read_b64_tr_b16 v[240:241], v4 offset:33536
    v_mfma_f32_16x16x32_bf16 v[108:111], v[224:227], v[60:63], v[108:111]
    ds_read_b64_tr_b16 v[242:243], v4 offset:34560
    s_waitcnt lgkmcnt(6)
    v_mfma_f32_16x16x32_bf16 v[112:115], v[228:231], v[56:59], v[112:115]
    ds_read_b64_tr_b16 v[244:245], v5 offset:33568
    v_mfma_f32_16x16x32_bf16 v[116:119], v[228:231], v[60:63], v[116:119]
    ds_read_b64_tr_b16 v[246:247], v5 offset:34592
    s_waitcnt lgkmcnt(6)
    v_mfma_f32_16x16x32_bf16 v[120:123], v[232:235], v[56:59], v[120:123]
    v_mfma_f32_16x16x32_bf16 v[124:127], v[232:235], v[60:63], v[124:127]
    s_waitcnt vmcnt(12)
    s_barrier
    ds_read_b64_tr_b16 v[224:225], v4 offset:49152
    ds_read_b64_tr_b16 v[226:227], v4 offset:50176
    s_waitcnt lgkmcnt(6)
    v_mfma_f32_16x16x32_bf16 v[128:131], v[236:239], v[56:59], v[128:131]
    ds_read_b64_tr_b16 v[228:229], v5 offset:49184
    s_mov_b32 s23, 0x4000
    buffer_load_dwordx4 v[48:51], v6, s[8:11], s23 offen offset:2048 sc1
    v_mfma_f32_16x16x32_bf16 v[132:135], v[236:239], v[60:63], v[132:135]
    ds_read_b64_tr_b16 v[230:231], v5 offset:50208
    s_waitcnt lgkmcnt(6)
    v_mfma_f32_16x16x32_bf16 v[136:139], v[240:243], v[56:59], v[136:139]
    ds_read_b64_tr_b16 v[232:233], v4 offset:49408
    v_mfma_f32_16x16x32_bf16 v[140:143], v[240:243], v[60:63], v[140:143]
    ds_read_b64_tr_b16 v[234:235], v4 offset:50432
    s_mov_b32 s23, 0x24000
    buffer_load_dwordx4 v[52:55], v6, s[8:11], s23 offen offset:2048 sc1
    s_waitcnt lgkmcnt(6)
    v_mfma_f32_16x16x32_bf16 v[144:147], v[244:247], v[56:59], v[144:147]
    ds_read_b64_tr_b16 v[236:237], v5 offset:49440
    v_mfma_f32_16x16x32_bf16 v[148:151], v[244:247], v[60:63], v[148:151]
    ds_read_b64_tr_b16 v[238:239], v5 offset:50464
    s_waitcnt vmcnt(13) lgkmcnt(6)
    v_mfma_f32_16x16x32_bf16 v[88:91], v[224:227], v[24:27], v[88:91]
    ds_read_b64_tr_b16 v[240:241], v4 offset:49664
    s_waitcnt vmcnt(12)
    v_mfma_f32_16x16x32_bf16 v[92:95], v[224:227], v[28:31], v[92:95]
    s_add_u32 s22, s24, 0x1a0000
    s_add_u32 m0, s20, 0x14000
    s_nop 0
    buffer_load_dwordx4 v3, s[4:7], s22 offen lds
    ds_read_b64_tr_b16 v[242:243], v4 offset:50688
    s_waitcnt lgkmcnt(6)
    v_mfma_f32_16x16x32_bf16 v[96:99], v[228:231], v[24:27], v[96:99]
    ds_read_b64_tr_b16 v[244:245], v5 offset:49696
    v_mfma_f32_16x16x32_bf16 v[100:103], v[228:231], v[28:31], v[100:103]
    ds_read_b64_tr_b16 v[246:247], v5 offset:50720
    s_waitcnt lgkmcnt(6)
    v_mfma_f32_16x16x32_bf16 v[104:107], v[232:235], v[24:27], v[104:107]
    s_add_u32 s22, s24, 0x1a2000
    s_add_u32 m0, s20, 0x14400
    s_nop 0
    buffer_load_dwordx4 v3, s[4:7], s22 offen lds
    ds_read_b64_tr_b16 v[224:225], v4 offset:49920
    v_mfma_f32_16x16x32_bf16 v[108:111], v[232:235], v[28:31], v[108:111]
    ds_read_b64_tr_b16 v[226:227], v4 offset:50944
    s_waitcnt lgkmcnt(6)
    v_mfma_f32_16x16x32_bf16 v[112:115], v[236:239], v[24:27], v[112:115]
    ds_read_b64_tr_b16 v[228:229], v5 offset:49952
    v_mfma_f32_16x16x32_bf16 v[116:119], v[236:239], v[28:31], v[116:119]
    ds_read_b64_tr_b16 v[230:231], v5 offset:50976
    s_waitcnt lgkmcnt(6)
    v_mfma_f32_16x16x32_bf16 v[120:123], v[240:243], v[24:27], v[120:123]
    v_mfma_f32_16x16x32_bf16 v[124:127], v[240:243], v[28:31], v[124:127]
    s_waitcnt vmcnt(12)
    s_barrier
    ds_read_b64_tr_b16 v[232:233], v7 offset:0
    ds_read_b64_tr_b16 v[234:235], v7 offset:1024
    s_waitcnt lgkmcnt(6)
    v_mfma_f32_16x16x32_bf16 v[128:131], v[244:247], v[24:27], v[128:131]
    ds_read_b64_tr_b16 v[236:237], v8 offset:32
    s_mov_b32 s23, 0x6000
    buffer_load_dwordx4 v[56:59], v6, s[8:11], s23 offen offset:2048 sc1
    v_mfma_f32_16x16x32_bf16 v[132:135], v[244:247], v[28:31], v[132:135]
    ds_read_b64_tr_b16 v[238:239], v8 offset:1056
    s_waitcnt lgkmcnt(6)
    v_mfma_f32_16x16x32_bf16 v[136:139], v[224:227], v[24:27], v[136:139]
    ds_read_b64_tr_b16 v[240:241], v7 offset:256
    v_mfma_f32_16x16x32_bf16 v[140:143], v[224:227], v[28:31], v[140:143]
    ds_read_b64_tr_b16 v[242:243], v7 offset:1280
    s_mov_b32 s23, 0x26000
    buffer_load_dwordx4 v[60:63], v6, s[8:11], s23 offen offset:2048 sc1
    s_waitcnt lgkmcnt(6)
    v_mfma_f32_16x16x32_bf16 v[144:147], v[228:231], v[24:27], v[144:147]
    ds_read_b64_tr_b16 v[244:245], v8 offset:288
    v_mfma_f32_16x16x32_bf16 v[148:151], v[228:231], v[28:31], v[148:151]
    ds_read_b64_tr_b16 v[246:247], v8 offset:1312
    s_waitcnt vmcnt(13) lgkmcnt(6)
    v_mfma_f32_16x16x32_bf16 v[88:91], v[232:235], v[32:35], v[88:91]
    ds_read_b64_tr_b16 v[224:225], v7 offset:512
    s_waitcnt vmcnt(12)
    v_mfma_f32_16x16x32_bf16 v[92:95], v[232:235], v[36:39], v[92:95]
    s_add_u32 s22, s24, 0x220000
    s_add_u32 m0, s20, 0x18000
    s_nop 0
    buffer_load_dwordx4 v3, s[4:7], s22 offen lds
    ds_read_b64_tr_b16 v[226:227], v7 offset:1536
    s_waitcnt lgkmcnt(6)
    v_mfma_f32_16x16x32_bf16 v[96:99], v[236:239], v[32:35], v[96:99]
    ds_read_b64_tr_b16 v[228:229], v8 offset:544
    v_mfma_f32_16x16x32_bf16 v[100:103], v[236:239], v[36:39], v[100:103]
    ds_read_b64_tr_b16 v[230:231], v8 offset:1568
    s_waitcnt lgkmcnt(6)
    v_mfma_f32_16x16x32_bf16 v[104:107], v[240:243], v[32:35], v[104:107]
    s_add_u32 s22, s24, 0x222000
    s_add_u32 m0, s20, 0x18400
    s_nop 0
    buffer_load_dwordx4 v3, s[4:7], s22 offen lds
    ds_read_b64_tr_b16 v[232:233], v7 offset:768
    v_mfma_f32_16x16x32_bf16 v[108:111], v[240:243], v[36:39], v[108:111]
    ds_read_b64_tr_b16 v[234:235], v7 offset:1792
    s_mov_b32 s16, 0x544000
    buffer_load_dwordx4 v[184:187], v2, s[8:11], s16 offen sc1
    s_waitcnt lgkmcnt(6)
    v_mfma_f32_16x16x32_bf16 v[112:115], v[244:247], v[32:35], v[112:115]
    ds_read_b64_tr_b16 v[236:237], v8 offset:800
    v_mfma_f32_16x16x32_bf16 v[116:119], v[244:247], v[36:39], v[116:119]
    ds_read_b64_tr_b16 v[238:239], v8 offset:1824
    s_waitcnt lgkmcnt(6)
    v_mfma_f32_16x16x32_bf16 v[120:123], v[224:227], v[32:35], v[120:123]
    v_mfma_f32_16x16x32_bf16 v[124:127], v[224:227], v[36:39], v[124:127]
    s_waitcnt vmcnt(13)
    s_barrier
    ds_read_b64_tr_b16 v[240:241], v7 offset:16384
    ds_read_b64_tr_b16 v[242:243], v7 offset:17408
    s_waitcnt lgkmcnt(6)
    v_mfma_f32_16x16x32_bf16 v[128:131], v[228:231], v[32:35], v[128:131]
    ds_read_b64_tr_b16 v[244:245], v8 offset:16416
    s_mov_b32 s23, 0x8000
    buffer_load_dwordx4 v[24:27], v6, s[8:11], s23 offen offset:2048 sc1
    v_mfma_f32_16x16x32_bf16 v[132:135], v[228:231], v[36:39], v[132:135]
    ds_read_b64_tr_b16 v[246:247], v8 offset:17440
    s_waitcnt lgkmcnt(6)
    v_mfma_f32_16x16x32_bf16 v[136:139], v[232:235], v[32:35], v[136:139]
    ds_read_b64_tr_b16 v[224:225], v7 offset:16640
    v_mfma_f32_16x16x32_bf16 v[140:143], v[232:235], v[36:39], v[140:143]
    ds_read_b64_tr_b16 v[226:227], v7 offset:17664
    s_mov_b32 s23, 0x28000
    buffer_load_dwordx4 v[28:31], v6, s[8:11], s23 offen offset:2048 sc1
    s_waitcnt lgkmcnt(6)
    v_mfma_f32_16x16x32_bf16 v[144:147], v[236:239], v[32:35], v[144:147]
    ds_read_b64_tr_b16 v[228:229], v8 offset:16672
    v_mfma_f32_16x16x32_bf16 v[148:151], v[236:239], v[36:39], v[148:151]
    ds_read_b64_tr_b16 v[230:231], v8 offset:17696
    s_waitcnt vmcnt(14) lgkmcnt(6)
    v_mfma_f32_16x16x32_bf16 v[88:91], v[240:243], v[40:43], v[88:91]
    ds_read_b64_tr_b16 v[232:233], v7 offset:16896
    s_waitcnt vmcnt(13)
    v_mfma_f32_16x16x32_bf16 v[92:95], v[240:243], v[44:47], v[92:95]
    s_add_u32 s22, s24, 0x2a0000
    s_add_u32 m0, s20, 0x1c000
    s_nop 0
    buffer_load_dwordx4 v3, s[4:7], s22 offen lds
    ds_read_b64_tr_b16 v[234:235], v7 offset:17920
    s_waitcnt lgkmcnt(6)
    v_mfma_f32_16x16x32_bf16 v[96:99], v[244:247], v[40:43], v[96:99]
    ds_read_b64_tr_b16 v[236:237], v8 offset:16928
    v_mfma_f32_16x16x32_bf16 v[100:103], v[244:247], v[44:47], v[100:103]
    ds_read_b64_tr_b16 v[238:239], v8 offset:17952
    s_waitcnt lgkmcnt(6)
    v_mfma_f32_16x16x32_bf16 v[104:107], v[224:227], v[40:43], v[104:107]
    s_add_u32 s22, s24, 0x2a2000
    s_add_u32 m0, s20, 0x1c400
    s_nop 0
    buffer_load_dwordx4 v3, s[4:7], s22 offen lds
    ds_read_b64_tr_b16 v[240:241], v7 offset:17152
    v_mfma_f32_16x16x32_bf16 v[108:111], v[224:227], v[44:47], v[108:111]
    ds_read_b64_tr_b16 v[242:243], v7 offset:18176
    s_waitcnt lgkmcnt(6)
    v_mfma_f32_16x16x32_bf16 v[112:115], v[228:231], v[40:43], v[112:115]
    ds_read_b64_tr_b16 v[244:245], v8 offset:17184
    v_mfma_f32_16x16x32_bf16 v[116:119], v[228:231], v[44:47], v[116:119]
    ds_read_b64_tr_b16 v[246:247], v8 offset:18208
    s_waitcnt lgkmcnt(6)
    v_mfma_f32_16x16x32_bf16 v[120:123], v[232:235], v[40:43], v[120:123]
    v_mfma_f32_16x16x32_bf16 v[124:127], v[232:235], v[44:47], v[124:127]
    s_waitcnt vmcnt(13)
    s_barrier
    ds_read_b64_tr_b16 v[224:225], v4 offset:0
    ds_read_b64_tr_b16 v[226:227], v4 offset:1024
    s_waitcnt lgkmcnt(6)
    v_mfma_f32_16x16x32_bf16 v[128:131], v[236:239], v[40:43], v[128:131]
    ds_read_b64_tr_b16 v[228:229], v5 offset:32
    s_mov_b32 s23, 0xa000
    buffer_load_dwordx4 v[32:35], v6, s[8:11], s23 offen offset:2048 sc1
    v_mfma_f32_16x16x32_bf16 v[132:135], v[236:239], v[44:47], v[132:135]
    ds_read_b64_tr_b16 v[230:231], v5 offset:1056
    s_waitcnt lgkmcnt(6)
    v_mfma_f32_16x16x32_bf16 v[136:139], v[240:243], v[40:43], v[136:139]
    ds_read_b64_tr_b16 v[232:233], v4 offset:256
    v_mfma_f32_16x16x32_bf16 v[140:143], v[240:243], v[44:47], v[140:143]
    ds_read_b64_tr_b16 v[234:235], v4 offset:1280
    s_mov_b32 s23, 0x2a000
    buffer_load_dwordx4 v[36:39], v6, s[8:11], s23 offen offset:2048 sc1
    s_waitcnt lgkmcnt(6)
    v_mfma_f32_16x16x32_bf16 v[144:147], v[244:247], v[40:43], v[144:147]
    ds_read_b64_tr_b16 v[236:237], v5 offset:288
    v_mfma_f32_16x16x32_bf16 v[148:151], v[244:247], v[44:47], v[148:151]
    ds_read_b64_tr_b16 v[238:239], v5 offset:1312
    s_waitcnt vmcnt(14) lgkmcnt(6)
    v_mfma_f32_16x16x32_bf16 v[88:91], v[224:227], v[48:51], v[88:91]
    ds_read_b64_tr_b16 v[240:241], v4 offset:512
    s_waitcnt vmcnt(13)
    v_mfma_f32_16x16x32_bf16 v[92:95], v[224:227], v[52:55], v[92:95]
    s_add_u32 s22, s24, 0x320000
    s_add_u32 m0, s20, 0x20000
    s_nop 0
    buffer_load_dwordx4 v3, s[4:7], s22 offen lds
    ds_read_b64_tr_b16 v[242:243], v4 offset:1536
    s_waitcnt lgkmcnt(6)
    v_mfma_f32_16x16x32_bf16 v[96:99], v[228:231], v[48:51], v[96:99]
    ds_read_b64_tr_b16 v[244:245], v5 offset:544
    v_mfma_f32_16x16x32_bf16 v[100:103], v[228:231], v[52:55], v[100:103]
    ds_read_b64_tr_b16 v[246:247], v5 offset:1568
    s_waitcnt lgkmcnt(6)
    v_mfma_f32_16x16x32_bf16 v[104:107], v[232:235], v[48:51], v[104:107]
    s_add_u32 s22, s24, 0x322000
    s_add_u32 m0, s20, 0x20400
    s_nop 0
    buffer_load_dwordx4 v3, s[4:7], s22 offen lds
    ds_read_b64_tr_b16 v[224:225], v4 offset:768
    v_mfma_f32_16x16x32_bf16 v[108:111], v[232:235], v[52:55], v[108:111]
    ds_read_b64_tr_b16 v[226:227], v4 offset:1792
    s_waitcnt lgkmcnt(6)
    v_mfma_f32_16x16x32_bf16 v[112:115], v[236:239], v[48:51], v[112:115]
    ds_read_b64_tr_b16 v[228:229], v5 offset:800
    v_mfma_f32_16x16x32_bf16 v[116:119], v[236:239], v[52:55], v[116:119]
    ds_read_b64_tr_b16 v[230:231], v5 offset:1824
    s_waitcnt lgkmcnt(6)
    v_mfma_f32_16x16x32_bf16 v[120:123], v[240:243], v[48:51], v[120:123]
    v_mfma_f32_16x16x32_bf16 v[124:127], v[240:243], v[52:55], v[124:127]
    s_waitcnt vmcnt(13)
    s_barrier
    ds_read_b64_tr_b16 v[232:233], v4 offset:16384
    ds_read_b64_tr_b16 v[234:235], v4 offset:17408
    s_add_u32 s19, s19, 8192
    buffer_load_dword v12, v13, s[8:11], s19 offen sc1
    s_waitcnt lgkmcnt(6)
    v_mfma_f32_16x16x32_bf16 v[128:131], v[244:247], v[48:51], v[128:131]
    ds_read_b64_tr_b16 v[236:237], v5 offset:16416
    s_mov_b32 s23, 0xc000
    buffer_load_dwordx4 v[40:43], v6, s[8:11], s23 offen offset:2048 sc1
    v_mfma_f32_16x16x32_bf16 v[132:135], v[244:247], v[52:55], v[132:135]
    ds_read_b64_tr_b16 v[238:239], v5 offset:17440
    s_waitcnt lgkmcnt(6)
    v_mfma_f32_16x16x32_bf16 v[136:139], v[224:227], v[48:51], v[136:139]
    ds_read_b64_tr_b16 v[240:241], v4 offset:16640
    v_mfma_f32_16x16x32_bf16 v[140:143], v[224:227], v[52:55], v[140:143]
    ds_read_b64_tr_b16 v[242:243], v4 offset:17664
    s_mov_b32 s23, 0x2c000
    buffer_load_dwordx4 v[44:47], v6, s[8:11], s23 offen offset:2048 sc1
    s_waitcnt lgkmcnt(6)
    v_mfma_f32_16x16x32_bf16 v[144:147], v[228:231], v[48:51], v[144:147]
    ds_read_b64_tr_b16 v[244:245], v5 offset:16672
    v_mfma_f32_16x16x32_bf16 v[148:151], v[228:231], v[52:55], v[148:151]
    ds_read_b64_tr_b16 v[246:247], v5 offset:17696
    s_waitcnt vmcnt(15) lgkmcnt(6)
    v_mfma_f32_16x16x32_bf16 v[88:91], v[232:235], v[56:59], v[88:91]
    ds_read_b64_tr_b16 v[224:225], v4 offset:16896
    s_waitcnt vmcnt(14)
    v_mfma_f32_16x16x32_bf16 v[92:95], v[232:235], v[60:63], v[92:95]
    s_add_u32 s22, s24, 0x3a0000
    s_add_u32 m0, s20, 0x24000
    s_nop 0
    buffer_load_dwordx4 v3, s[4:7], s22 offen lds
    ds_read_b64_tr_b16 v[226:227], v4 offset:17920
    s_waitcnt lgkmcnt(6)
    v_mfma_f32_16x16x32_bf16 v[96:99], v[236:239], v[56:59], v[96:99]
    ds_read_b64_tr_b16 v[228:229], v5 offset:16928
    v_mfma_f32_16x16x32_bf16 v[100:103], v[236:239], v[60:63], v[100:103]
    ds_read_b64_tr_b16 v[230:231], v5 offset:17952
    s_waitcnt lgkmcnt(6)
    v_mfma_f32_16x16x32_bf16 v[104:107], v[240:243], v[56:59], v[104:107]
    s_add_u32 s22, s24, 0x3a2000
    s_add_u32 m0, s20, 0x24400
    s_nop 0
    buffer_load_dwordx4 v3, s[4:7], s22 offen lds
    ds_read_b64_tr_b16 v[232:233], v4 offset:17152
    v_mfma_f32_16x16x32_bf16 v[108:111], v[240:243], v[60:63], v[108:111]
    ds_read_b64_tr_b16 v[234:235], v4 offset:18176
    s_waitcnt lgkmcnt(6)
    v_mfma_f32_16x16x32_bf16 v[112:115], v[244:247], v[56:59], v[112:115]
    ds_read_b64_tr_b16 v[236:237], v5 offset:17184
    v_mfma_f32_16x16x32_bf16 v[116:119], v[244:247], v[60:63], v[116:119]
    ds_read_b64_tr_b16 v[238:239], v5 offset:18208
    s_waitcnt lgkmcnt(6)
    v_mfma_f32_16x16x32_bf16 v[120:123], v[224:227], v[56:59], v[120:123]
    v_mfma_f32_16x16x32_bf16 v[124:127], v[224:227], v[60:63], v[124:127]
    s_waitcnt vmcnt(14)
    s_barrier
    ds_read_b64_tr_b16 v[240:241], v4 offset:32768
    ds_read_b64_tr_b16 v[242:243], v4 offset:33792
    s_waitcnt lgkmcnt(6)
    v_mfma_f32_16x16x32_bf16 v[128:131], v[228:231], v[56:59], v[128:131]
    ds_read_b64_tr_b16 v[244:245], v5 offset:32800
    s_mov_b32 s23, 0xe000
    buffer_load_dwordx4 v[48:51], v6, s[8:11], s23 offen offset:2048 sc1
    v_mfma_f32_16x16x32_bf16 v[132:135], v[228:231], v[60:63], v[132:135]
    ds_read_b64_tr_b16 v[246:247], v5 offset:33824
    s_waitcnt lgkmcnt(6)
    v_mfma_f32_16x16x32_bf16 v[136:139], v[232:235], v[56:59], v[136:139]
    ds_read_b64_tr_b16 v[224:225], v4 offset:33024
    v_mfma_f32_16x16x32_bf16 v[140:143], v[232:235], v[60:63], v[140:143]
    ds_read_b64_tr_b16 v[226:227], v4 offset:34048
    s_mov_b32 s23, 0x2e000
    buffer_load_dwordx4 v[52:55], v6, s[8:11], s23 offen offset:2048 sc1
    s_waitcnt lgkmcnt(6)
    v_mfma_f32_16x16x32_bf16 v[144:147], v[236:239], v[56:59], v[144:147]
    ds_read_b64_tr_b16 v[228:229], v5 offset:33056
    v_mfma_f32_16x16x32_bf16 v[148:151], v[236:239], v[60:63], v[148:151]
    ds_read_b64_tr_b16 v[230:231], v5 offset:34080
    s_waitcnt vmcnt(6)
    v_cmp_ne_u32 vcc, s28, v12
    s_cbranch_vccnz adaLN_cond__sliding_block_cached__moe_arch_mod__prompt_kernel_o220r
adaLN_cond__sliding_block_cached__moe_arch_mod__prompt_kernel_o220b:
    s_waitcnt lgkmcnt(6)
    v_mfma_f32_16x16x32_bf16 v[88:91], v[240:243], v[24:27], v[88:91]
    ds_read_b64_tr_b16 v[232:233], v4 offset:33280
    v_mfma_f32_16x16x32_bf16 v[92:95], v[240:243], v[28:31], v[92:95]
    s_add_u32 s22, s24, 0x30000
    s_add_u32 m0, s20, 0x10000
    s_nop 0
    buffer_load_dwordx4 v3, s[4:7], s22 offen lds
    ds_read_b64_tr_b16 v[234:235], v4 offset:34304
    s_waitcnt lgkmcnt(6)
    v_mfma_f32_16x16x32_bf16 v[96:99], v[244:247], v[24:27], v[96:99]
    ds_read_b64_tr_b16 v[236:237], v5 offset:33312
    v_mfma_f32_16x16x32_bf16 v[100:103], v[244:247], v[28:31], v[100:103]
    ds_read_b64_tr_b16 v[238:239], v5 offset:34336
    s_waitcnt lgkmcnt(6)
    v_mfma_f32_16x16x32_bf16 v[104:107], v[224:227], v[24:27], v[104:107]
    s_add_u32 s22, s24, 0x32000
    s_add_u32 m0, s20, 0x10400
    s_nop 0
    buffer_load_dwordx4 v3, s[4:7], s22 offen lds
    ds_read_b64_tr_b16 v[240:241], v4 offset:33536
    v_mfma_f32_16x16x32_bf16 v[108:111], v[224:227], v[28:31], v[108:111]
    ds_read_b64_tr_b16 v[242:243], v4 offset:34560
    v_xor_b32 v16, s28, v184
    v_xor_b32 v17, s28, v185
    v_xor_b32 v18, s28, v186
    v_xor_b32 v19, s28, v187
    v_or3_b32 v16, v16, v17, v18
    v_or_b32 v16, v16, v19
    v_cmp_ne_u32 vcc, 0, v16
    s_cbranch_vccnz adaLN_cond__sliding_block_cached__moe_arch_mod__prompt_kernel_mf21r
adaLN_cond__sliding_block_cached__moe_arch_mod__prompt_kernel_mf21b:
    s_waitcnt lgkmcnt(6)
    v_mfma_f32_16x16x32_bf16 v[112:115], v[228:231], v[24:27], v[112:115]
    ds_read_b64_tr_b16 v[244:245], v5 offset:33568
    v_mfma_f32_16x16x32_bf16 v[116:119], v[228:231], v[28:31], v[116:119]
    ds_read_b64_tr_b16 v[246:247], v5 offset:34592
    s_waitcnt lgkmcnt(6)
    v_mfma_f32_16x16x32_bf16 v[120:123], v[232:235], v[24:27], v[120:123]
    v_mfma_f32_16x16x32_bf16 v[124:127], v[232:235], v[28:31], v[124:127]
    s_barrier
    ds_read_b64_tr_b16 v[224:225], v4 offset:49152
    ds_read_b64_tr_b16 v[226:227], v4 offset:50176
    s_waitcnt lgkmcnt(6)
    v_mfma_f32_16x16x32_bf16 v[128:131], v[236:239], v[24:27], v[128:131]
    ds_read_b64_tr_b16 v[228:229], v5 offset:49184
    s_mov_b32 s23, 0x0
    buffer_load_dwordx4 v[56:59], v6, s[8:11], s23 offen offset:3072 sc1
    v_mfma_f32_16x16x32_bf16 v[132:135], v[236:239], v[28:31], v[132:135]
    ds_read_b64_tr_b16 v[230:231], v5 offset:50208
    s_waitcnt lgkmcnt(6)
    v_mfma_f32_16x16x32_bf16 v[136:139], v[240:243], v[24:27], v[136:139]
    ds_read_b64_tr_b16 v[232:233], v4 offset:49408
    v_mfma_f32_16x16x32_bf16 v[140:143], v[240:243], v[28:31], v[140:143]
    ds_read_b64_tr_b16 v[234:235], v4 offset:50432
    s_mov_b32 s23, 0x20000
    buffer_load_dwordx4 v[60:63], v6, s[8:11], s23 offen offset:3072 sc1
    s_waitcnt lgkmcnt(6)
    v_mfma_f32_16x16x32_bf16 v[144:147], v[244:247], v[24:27], v[144:147]
    ds_read_b64_tr_b16 v[236:237], v5 offset:49440
    v_mfma_f32_16x16x32_bf16 v[148:151], v[244:247], v[28:31], v[148:151]
    ds_read_b64_tr_b16 v[238:239], v5 offset:50464
    s_waitcnt lgkmcnt(6)
    v_mfma_f32_16x16x32_bf16 v[88:91], v[224:227], v[32:35], v[88:91]
    ds_read_b64_tr_b16 v[240:241], v4 offset:49664
    v_mfma_f32_16x16x32_bf16 v[92:95], v[224:227], v[36:39], v[92:95]
    s_add_u32 s22, s24, 0xb0000
    s_add_u32 m0, s20, 0x14000
    s_nop 0
    buffer_load_dwordx4 v3, s[4:7], s22 offen lds
    ds_read_b64_tr_b16 v[242:243], v4 offset:50688
    s_waitcnt lgkmcnt(6)
    v_mfma_f32_16x16x32_bf16 v[96:99], v[228:231], v[32:35], v[96:99]
    ds_read_b64_tr_b16 v[244:245], v5 offset:49696
    v_mfma_f32_16x16x32_bf16 v[100:103], v[228:231], v[36:39], v[100:103]
    ds_read_b64_tr_b16 v[246:247], v5 offset:50720
    s_waitcnt lgkmcnt(6)
    v_mfma_f32_16x16x32_bf16 v[104:107], v[232:235], v[32:35], v[104:107]
    s_add_u32 s22, s24, 0xb2000
    s_add_u32 m0, s20, 0x14400
    s_nop 0
    buffer_load_dwordx4 v3, s[4:7], s22 offen lds
    ds_read_b64_tr_b16 v[224:225], v4 offset:49920
    v_mfma_f32_16x16x32_bf16 v[108:111], v[232:235], v[36:39], v[108:111]
    ds_read_b64_tr_b16 v[226:227], v4 offset:50944
    s_waitcnt lgkmcnt(6)
    v_mfma_f32_16x16x32_bf16 v[112:115], v[236:239], v[32:35], v[112:115]
    ds_read_b64_tr_b16 v[228:229], v5 offset:49952
    v_mfma_f32_16x16x32_bf16 v[116:119], v[236:239], v[36:39], v[116:119]
    ds_read_b64_tr_b16 v[230:231], v5 offset:50976
    s_waitcnt lgkmcnt(6)
    v_mfma_f32_16x16x32_bf16 v[120:123], v[240:243], v[32:35], v[120:123]
    v_mfma_f32_16x16x32_bf16 v[124:127], v[240:243], v[36:39], v[124:127]
    s_barrier
    ds_read_b64_tr_b16 v[232:233], v7 offset:0
    ds_read_b64_tr_b16 v[234:235], v7 offset:1024
    s_waitcnt lgkmcnt(6)
    v_mfma_f32_16x16x32_bf16 v[128:131], v[244:247], v[32:35], v[128:131]
    ds_read_b64_tr_b16 v[236:237], v8 offset:32
    s_mov_b32 s23, 0x2000
    buffer_load_dwordx4 v[24:27], v6, s[8:11], s23 offen offset:3072 sc1
    v_mfma_f32_16x16x32_bf16 v[132:135], v[244:247], v[36:39], v[132:135]
    ds_read_b64_tr_b16 v[238:239], v8 offset:1056
    s_waitcnt lgkmcnt(6)
    v_mfma_f32_16x16x32_bf16 v[136:139], v[224:227], v[32:35], v[136:139]
    ds_read_b64_tr_b16 v[240:241], v7 offset:256
    v_mfma_f32_16x16x32_bf16 v[140:143], v[224:227], v[36:39], v[140:143]
    ds_read_b64_tr_b16 v[242:243], v7 offset:1280
    s_mov_b32 s23, 0x22000
    buffer_load_dwordx4 v[28:31], v6, s[8:11], s23 offen offset:3072 sc1
    s_waitcnt lgkmcnt(6)
    v_mfma_f32_16x16x32_bf16 v[144:147], v[228:231], v[32:35], v[144:147]
    ds_read_b64_tr_b16 v[244:245], v8 offset:288
    v_mfma_f32_16x16x32_bf16 v[148:151], v[228:231], v[36:39], v[148:151]
    ds_read_b64_tr_b16 v[246:247], v8 offset:1312
    s_waitcnt vmcnt(13) lgkmcnt(6)
    v_mfma_f32_16x16x32_bf16 v[88:91], v[232:235], v[40:43], v[88:91]
    ds_read_b64_tr_b16 v[224:225], v7 offset:512
    s_waitcnt vmcnt(12)
    v_mfma_f32_16x16x32_bf16 v[92:95], v[232:235], v[44:47], v[92:95]
    s_add_u32 s22, s24, 0x130000
    s_add_u32 m0, s20, 0x18000
    s_nop 0
    buffer_load_dwordx4 v3, s[4:7], s22 offen lds
    ds_read_b64_tr_b16 v[226:227], v7 offset:1536
    s_waitcnt lgkmcnt(6)
    v_mfma_f32_16x16x32_bf16 v[96:99], v[236:239], v[40:43], v[96:99]
    ds_read_b64_tr_b16 v[228:229], v8 offset:544
    v_mfma_f32_16x16x32_bf16 v[100:103], v[236:239], v[44:47], v[100:103]
    ds_read_b64_tr_b16 v[230:231], v8 offset:1568
    s_waitcnt lgkmcnt(6)
    v_mfma_f32_16x16x32_bf16 v[104:107], v[240:243], v[40:43], v[104:107]
    s_add_u32 s22, s24, 0x132000
    s_add_u32 m0, s20, 0x18400
    s_nop 0
    buffer_load_dwordx4 v3, s[4:7], s22 offen lds
    ds_read_b64_tr_b16 v[232:233], v7 offset:768
    v_mfma_f32_16x16x32_bf16 v[108:111], v[240:243], v[44:47], v[108:111]
    ds_read_b64_tr_b16 v[234:235], v7 offset:1792
    s_waitcnt lgkmcnt(6)
    v_mfma_f32_16x16x32_bf16 v[112:115], v[244:247], v[40:43], v[112:115]
    ds_read_b64_tr_b16 v[236:237], v8 offset:800
    v_mfma_f32_16x16x32_bf16 v[116:119], v[244:247], v[44:47], v[116:119]
    ds_read_b64_tr_b16 v[238:239], v8 offset:1824
    s_waitcnt lgkmcnt(6)
    v_mfma_f32_16x16x32_bf16 v[120:123], v[224:227], v[40:43], v[120:123]
    v_mfma_f32_16x16x32_bf16 v[124:127], v[224:227], v[44:47], v[124:127]
    s_waitcnt vmcnt(12)
    s_barrier
    ds_read_b64_tr_b16 v[240:241], v7 offset:16384
    ds_read_b64_tr_b16 v[242:243], v7 offset:17408
    s_waitcnt lgkmcnt(6)
    v_mfma_f32_16x16x32_bf16 v[128:131], v[228:231], v[40:43], v[128:131]
    ds_read_b64_tr_b16 v[244:245], v8 offset:16416
    s_mov_b32 s23, 0x4000
    buffer_load_dwordx4 v[32:35], v6, s[8:11], s23 offen offset:3072 sc1
    v_mfma_f32_16x16x32_bf16 v[132:135], v[228:231], v[44:47], v[132:135]
    ds_read_b64_tr_b16 v[246:247], v8 offset:17440
    s_waitcnt lgkmcnt(6)
    v_mfma_f32_16x16x32_bf16 v[136:139], v[232:235], v[40:43], v[136:139]
    ds_read_b64_tr_b16 v[224:225], v7 offset:16640
    v_mfma_f32_16x16x32_bf16 v[140:143], v[232:235], v[44:47], v[140:143]
    ds_read_b64_tr_b16 v[226:227], v7 offset:17664
    s_mov_b32 s23, 0x24000
    buffer_load_dwordx4 v[36:39], v6, s[8:11], s23 offen offset:3072 sc1
    s_waitcnt lgkmcnt(6)
    v_mfma_f32_16x16x32_bf16 v[144:147], v[236:239], v[40:43], v[144:147]
    ds_read_b64_tr_b16 v[228:229], v8 offset:16672
    v_mfma_f32_16x16x32_bf16 v[148:151], v[236:239], v[44:47], v[148:151]
    ds_read_b64_tr_b16 v[230:231], v8 offset:17696
    s_waitcnt vmcnt(13) lgkmcnt(6)
    v_mfma_f32_16x16x32_bf16 v[88:91], v[240:243], v[48:51], v[88:91]
    ds_read_b64_tr_b16 v[232:233], v7 offset:16896
    s_waitcnt vmcnt(12)
    v_mfma_f32_16x16x32_bf16 v[92:95], v[240:243], v[52:55], v[92:95]
    s_add_u32 s22, s24, 0x1b0000
    s_add_u32 m0, s20, 0x1c000
    s_nop 0
    buffer_load_dwordx4 v3, s[4:7], s22 offen lds
    ds_read_b64_tr_b16 v[234:235], v7 offset:17920
    s_waitcnt lgkmcnt(6)
    v_mfma_f32_16x16x32_bf16 v[96:99], v[244:247], v[48:51], v[96:99]
    ds_read_b64_tr_b16 v[236:237], v8 offset:16928
    v_mfma_f32_16x16x32_bf16 v[100:103], v[244:247], v[52:55], v[100:103]
    ds_read_b64_tr_b16 v[238:239], v8 offset:17952
    s_waitcnt lgkmcnt(6)
    v_mfma_f32_16x16x32_bf16 v[104:107], v[224:227], v[48:51], v[104:107]
    s_add_u32 s22, s24, 0x1b2000
    s_add_u32 m0, s20, 0x1c400
    s_nop 0
    buffer_load_dwordx4 v3, s[4:7], s22 offen lds
    ds_read_b64_tr_b16 v[240:241], v7 offset:17152
    v_mfma_f32_16x16x32_bf16 v[108:111], v[224:227], v[52:55], v[108:111]
    ds_read_b64_tr_b16 v[242:243], v7 offset:18176
    s_waitcnt lgkmcnt(6)
    v_mfma_f32_16x16x32_bf16 v[112:115], v[228:231], v[48:51], v[112:115]
    ds_read_b64_tr_b16 v[244:245], v8 offset:17184
    v_mfma_f32_16x16x32_bf16 v[116:119], v[228:231], v[52:55], v[116:119]
    ds_read_b64_tr_b16 v[246:247], v8 offset:18208
    s_waitcnt lgkmcnt(6)
    v_mfma_f32_16x16x32_bf16 v[120:123], v[232:235], v[48:51], v[120:123]
    v_mfma_f32_16x16x32_bf16 v[124:127], v[232:235], v[52:55], v[124:127]
    s_waitcnt vmcnt(12)
    s_barrier
    ds_read_b64_tr_b16 v[224:225], v4 offset:0
    ds_read_b64_tr_b16 v[226:227], v4 offset:1024
    s_waitcnt lgkmcnt(6)
    v_mfma_f32_16x16x32_bf16 v[128:131], v[236:239], v[48:51], v[128:131]
    ds_read_b64_tr_b16 v[228:229], v5 offset:32
    s_mov_b32 s23, 0x6000
    buffer_load_dwordx4 v[40:43], v6, s[8:11], s23 offen offset:3072 sc1
    v_mfma_f32_16x16x32_bf16 v[132:135], v[236:239], v[52:55], v[132:135]
    ds_read_b64_tr_b16 v[230:231], v5 offset:1056
    s_waitcnt lgkmcnt(6)
    v_mfma_f32_16x16x32_bf16 v[136:139], v[240:243], v[48:51], v[136:139]
    ds_read_b64_tr_b16 v[232:233], v4 offset:256
    v_mfma_f32_16x16x32_bf16 v[140:143], v[240:243], v[52:55], v[140:143]
    ds_read_b64_tr_b16 v[234:235], v4 offset:1280
    s_mov_b32 s23, 0x26000
    buffer_load_dwordx4 v[44:47], v6, s[8:11], s23 offen offset:3072 sc1
    s_waitcnt lgkmcnt(6)
    v_mfma_f32_16x16x32_bf16 v[144:147], v[244:247], v[48:51], v[144:147]
    ds_read_b64_tr_b16 v[236:237], v5 offset:288
    v_mfma_f32_16x16x32_bf16 v[148:151], v[244:247], v[52:55], v[148:151]
    ds_read_b64_tr_b16 v[238:239], v5 offset:1312
    s_waitcnt vmcnt(13) lgkmcnt(6)
    v_mfma_f32_16x16x32_bf16 v[88:91], v[224:227], v[56:59], v[88:91]
    ds_read_b64_tr_b16 v[240:241], v4 offset:512
    s_waitcnt vmcnt(12)
    v_mfma_f32_16x16x32_bf16 v[92:95], v[224:227], v[60:63], v[92:95]
    s_add_u32 s22, s24, 0x230000
    s_add_u32 m0, s20, 0x20000
    s_nop 0
    buffer_load_dwordx4 v3, s[4:7], s22 offen lds
    ds_read_b64_tr_b16 v[242:243], v4 offset:1536
    s_waitcnt lgkmcnt(6)
    v_mfma_f32_16x16x32_bf16 v[96:99], v[228:231], v[56:59], v[96:99]
    ds_read_b64_tr_b16 v[244:245], v5 offset:544
    v_mfma_f32_16x16x32_bf16 v[100:103], v[228:231], v[60:63], v[100:103]
    ds_read_b64_tr_b16 v[246:247], v5 offset:1568
    s_waitcnt lgkmcnt(6)
    v_mfma_f32_16x16x32_bf16 v[104:107], v[232:235], v[56:59], v[104:107]
    s_add_u32 s22, s24, 0x232000
    s_add_u32 m0, s20, 0x20400
    s_nop 0
    buffer_load_dwordx4 v3, s[4:7], s22 offen lds
    ds_read_b64_tr_b16 v[224:225], v4 offset:768
    v_mfma_f32_16x16x32_bf16 v[108:111], v[232:235], v[60:63], v[108:111]
    ds_read_b64_tr_b16 v[226:227], v4 offset:1792
    s_waitcnt lgkmcnt(6)
    v_mfma_f32_16x16x32_bf16 v[112:115], v[236:239], v[56:59], v[112:115]
    ds_read_b64_tr_b16 v[228:229], v5 offset:800
    v_mfma_f32_16x16x32_bf16 v[116:119], v[236:239], v[60:63], v[116:119]
    ds_read_b64_tr_b16 v[230:231], v5 offset:1824
    s_waitcnt lgkmcnt(6)
    v_mfma_f32_16x16x32_bf16 v[120:123], v[240:243], v[56:59], v[120:123]
    v_mfma_f32_16x16x32_bf16 v[124:127], v[240:243], v[60:63], v[124:127]
    s_waitcnt vmcnt(12)
    s_barrier
    ds_read_b64_tr_b16 v[232:233], v4 offset:16384
    ds_read_b64_tr_b16 v[234:235], v4 offset:17408
    s_waitcnt lgkmcnt(6)
    v_mfma_f32_16x16x32_bf16 v[128:131], v[244:247], v[56:59], v[128:131]
    ds_read_b64_tr_b16 v[236:237], v5 offset:16416
    s_mov_b32 s23, 0x8000
    buffer_load_dwordx4 v[48:51], v6, s[8:11], s23 offen offset:3072 sc1
    v_mfma_f32_16x16x32_bf16 v[132:135], v[244:247], v[60:63], v[132:135]
    ds_read_b64_tr_b16 v[238:239], v5 offset:17440
    s_waitcnt lgkmcnt(6)
    v_mfma_f32_16x16x32_bf16 v[136:139], v[224:227], v[56:59], v[136:139]
    ds_read_b64_tr_b16 v[240:241], v4 offset:16640
    v_mfma_f32_16x16x32_bf16 v[140:143], v[224:227], v[60:63], v[140:143]
    ds_read_b64_tr_b16 v[242:243], v4 offset:17664
    s_mov_b32 s23, 0x28000
    buffer_load_dwordx4 v[52:55], v6, s[8:11], s23 offen offset:3072 sc1
    s_waitcnt lgkmcnt(6)
    v_mfma_f32_16x16x32_bf16 v[144:147], v[228:231], v[56:59], v[144:147]
    ds_read_b64_tr_b16 v[244:245], v5 offset:16672
    v_mfma_f32_16x16x32_bf16 v[148:151], v[228:231], v[60:63], v[148:151]
    ds_read_b64_tr_b16 v[246:247], v5 offset:17696
    s_waitcnt vmcnt(13) lgkmcnt(6)
    v_mfma_f32_16x16x32_bf16 v[88:91], v[232:235], v[24:27], v[88:91]
    ds_read_b64_tr_b16 v[224:225], v4 offset:16896
    s_waitcnt vmcnt(12)
    v_mfma_f32_16x16x32_bf16 v[92:95], v[232:235], v[28:31], v[92:95]
    s_add_u32 s22, s24, 0x2b0000
    s_add_u32 m0, s20, 0x24000
    s_nop 0
    buffer_load_dwordx4 v3, s[4:7], s22 offen lds
    ds_read_b64_tr_b16 v[226:227], v4 offset:17920
    s_waitcnt lgkmcnt(6)
    v_mfma_f32_16x16x32_bf16 v[96:99], v[236:239], v[24:27], v[96:99]
    ds_read_b64_tr_b16 v[228:229], v5 offset:16928
    v_mfma_f32_16x16x32_bf16 v[100:103], v[236:239], v[28:31], v[100:103]
    ds_read_b64_tr_b16 v[230:231], v5 offset:17952
    s_waitcnt lgkmcnt(6)
    v_mfma_f32_16x16x32_bf16 v[104:107], v[240:243], v[24:27], v[104:107]
    s_add_u32 s22, s24, 0x2b2000
    s_add_u32 m0, s20, 0x24400
    s_nop 0
    buffer_load_dwordx4 v3, s[4:7], s22 offen lds
    ds_read_b64_tr_b16 v[232:233], v4 offset:17152
    v_mfma_f32_16x16x32_bf16 v[108:111], v[240:243], v[28:31], v[108:111]
    ds_read_b64_tr_b16 v[234:235], v4 offset:18176
    s_waitcnt lgkmcnt(6)
    v_mfma_f32_16x16x32_bf16 v[112:115], v[244:247], v[24:27], v[112:115]
    ds_read_b64_tr_b16 v[236:237], v5 offset:17184
    v_mfma_f32_16x16x32_bf16 v[116:119], v[244:247], v[28:31], v[116:119]
    ds_read_b64_tr_b16 v[238:239], v5 offset:18208
    s_waitcnt lgkmcnt(6)
    v_mfma_f32_16x16x32_bf16 v[120:123], v[224:227], v[24:27], v[120:123]
    v_mfma_f32_16x16x32_bf16 v[124:127], v[224:227], v[28:31], v[124:127]
    s_waitcnt vmcnt(12)
    s_barrier
    ds_read_b64_tr_b16 v[240:241], v4 offset:32768
    ds_read_b64_tr_b16 v[242:243], v4 offset:33792
    s_waitcnt lgkmcnt(6)
    v_mfma_f32_16x16x32_bf16 v[128:131], v[228:231], v[24:27], v[128:131]
    ds_read_b64_tr_b16 v[244:245], v5 offset:32800
    s_mov_b32 s23, 0xa000
    buffer_load_dwordx4 v[56:59], v6, s[8:11], s23 offen offset:3072 sc1
    v_mfma_f32_16x16x32_bf16 v[132:135], v[228:231], v[28:31], v[132:135]
    ds_read_b64_tr_b16 v[246:247], v5 offset:33824
    s_waitcnt lgkmcnt(6)
    v_mfma_f32_16x16x32_bf16 v[136:139], v[232:235], v[24:27], v[136:139]
    ds_read_b64_tr_b16 v[224:225], v4 offset:33024
    v_mfma_f32_16x16x32_bf16 v[140:143], v[232:235], v[28:31], v[140:143]
    ds_read_b64_tr_b16 v[226:227], v4 offset:34048
    s_mov_b32 s23, 0x2a000
    buffer_load_dwordx4 v[60:63], v6, s[8:11], s23 offen offset:3072 sc1
    s_waitcnt lgkmcnt(6)
    v_mfma_f32_16x16x32_bf16 v[144:147], v[236:239], v[24:27], v[144:147]
    ds_read_b64_tr_b16 v[228:229], v5 offset:33056
    v_mfma_f32_16x16x32_bf16 v[148:151], v[236:239], v[28:31], v[148:151]
    ds_read_b64_tr_b16 v[230:231], v5 offset:34080
    s_waitcnt vmcnt(13) lgkmcnt(6)
    v_mfma_f32_16x16x32_bf16 v[88:91], v[240:243], v[32:35], v[88:91]
    ds_read_b64_tr_b16 v[232:233], v4 offset:33280
    s_waitcnt vmcnt(12)
    v_mfma_f32_16x16x32_bf16 v[92:95], v[240:243], v[36:39], v[92:95]
    s_add_u32 s22, s24, 0x330000
    s_add_u32 m0, s20, 0x10000
    s_nop 0
    buffer_load_dwordx4 v3, s[4:7], s22 offen lds
    ds_read_b64_tr_b16 v[234:235], v4 offset:34304
    s_waitcnt lgkmcnt(6)
    v_mfma_f32_16x16x32_bf16 v[96:99], v[244:247], v[32:35], v[96:99]
    ds_read_b64_tr_b16 v[236:237], v5 offset:33312
    v_mfma_f32_16x16x32_bf16 v[100:103], v[244:247], v[36:39], v[100:103]
    ds_read_b64_tr_b16 v[238:239], v5 offset:34336
    s_waitcnt lgkmcnt(6)
    v_mfma_f32_16x16x32_bf16 v[104:107], v[224:227], v[32:35], v[104:107]
    s_add_u32 s22, s24, 0x332000
    s_add_u32 m0, s20, 0x10400
    s_nop 0
    buffer_load_dwordx4 v3, s[4:7], s22 offen lds
    ds_read_b64_tr_b16 v[240:241], v4 offset:33536
    v_mfma_f32_16x16x32_bf16 v[108:111], v[224:227], v[36:39], v[108:111]
    ds_read_b64_tr_b16 v[242:243], v4 offset:34560
    v_lshrrev_b32 v16, 4, v1
    v_lshlrev_b32 v16, 3, v16
    s_lshl_b32 s16, s31, 8
    s_add_u32 s16, s16, 0x540080
    buffer_load_dwordx2 v[248:249], v16, s[8:11], s16 offen offset:0 sc1
    buffer_load_dwordx2 v[250:251], v16, s[8:11], s16 offen offset:32 sc1
    buffer_load_dwordx2 v[252:253], v16, s[8:11], s16 offen offset:64 sc1
    buffer_load_dwordx2 v[254:255], v16, s[8:11], s16 offen offset:96 sc1
    s_waitcnt lgkmcnt(6)
    v_mfma_f32_16x16x32_bf16 v[112:115], v[228:231], v[32:35], v[112:115]
    ds_read_b64_tr_b16 v[244:245], v5 offset:33568
    v_mfma_f32_16x16x32_bf16 v[116:119], v[228:231], v[36:39], v[116:119]
    ds_read_b64_tr_b16 v[246:247], v5 offset:34592
    s_waitcnt lgkmcnt(6)
    v_mfma_f32_16x16x32_bf16 v[120:123], v[232:235], v[32:35], v[120:123]
    v_mfma_f32_16x16x32_bf16 v[124:127], v[232:235], v[36:39], v[124:127]
    s_waitcnt vmcnt(16)
    s_barrier
    ds_read_b64_tr_b16 v[224:225], v4 offset:49152
    ds_read_b64_tr_b16 v[226:227], v4 offset:50176
    s_waitcnt lgkmcnt(6)
    v_mfma_f32_16x16x32_bf16 v[128:131], v[236:239], v[32:35], v[128:131]
    ds_read_b64_tr_b16 v[228:229], v5 offset:49184
    s_mov_b32 s23, 0xc000
    buffer_load_dwordx4 v[24:27], v6, s[8:11], s23 offen offset:3072 sc1
    v_mfma_f32_16x16x32_bf16 v[132:135], v[236:239], v[36:39], v[132:135]
    ds_read_b64_tr_b16 v[230:231], v5 offset:50208
    s_waitcnt lgkmcnt(6)
    v_mfma_f32_16x16x32_bf16 v[136:139], v[240:243], v[32:35], v[136:139]
    ds_read_b64_tr_b16 v[232:233], v4 offset:49408
    v_mfma_f32_16x16x32_bf16 v[140:143], v[240:243], v[36:39], v[140:143]
    ds_read_b64_tr_b16 v[234:235], v4 offset:50432
    s_mov_b32 s23, 0x2c000
    buffer_load_dwordx4 v[28:31], v6, s[8:11], s23 offen offset:3072 sc1
    s_waitcnt lgkmcnt(6)
    v_mfma_f32_16x16x32_bf16 v[144:147], v[244:247], v[32:35], v[144:147]
    ds_read_b64_tr_b16 v[236:237], v5 offset:49440
    v_mfma_f32_16x16x32_bf16 v[148:151], v[244:247], v[36:39], v[148:151]
    ds_read_b64_tr_b16 v[238:239], v5 offset:50464
    s_waitcnt vmcnt(17) lgkmcnt(6)
    v_mfma_f32_16x16x32_bf16 v[88:91], v[224:227], v[40:43], v[88:91]
    ds_read_b64_tr_b16 v[240:241], v4 offset:49664
    s_waitcnt vmcnt(16)
    v_mfma_f32_16x16x32_bf16 v[92:95], v[224:227], v[44:47], v[92:95]
    s_add_u32 s22, s24, 0x3b0000
    s_add_u32 m0, s20, 0x14000
    s_nop 0
    buffer_load_dwordx4 v3, s[4:7], s22 offen lds
    ds_read_b64_tr_b16 v[242:243], v4 offset:50688
    s_waitcnt lgkmcnt(6)
    v_mfma_f32_16x16x32_bf16 v[96:99], v[228:231], v[40:43], v[96:99]
    ds_read_b64_tr_b16 v[244:245], v5 offset:49696
    v_mfma_f32_16x16x32_bf16 v[100:103], v[228:231], v[44:47], v[100:103]
    ds_read_b64_tr_b16 v[246:247], v5 offset:50720
    s_waitcnt lgkmcnt(6)
    v_mfma_f32_16x16x32_bf16 v[104:107], v[232:235], v[40:43], v[104:107]
    s_add_u32 s22, s24, 0x3b2000
    s_add_u32 m0, s20, 0x14400
    s_nop 0
    buffer_load_dwordx4 v3, s[4:7], s22 offen lds
    ds_read_b64_tr_b16 v[224:225], v4 offset:49920
    v_mfma_f32_16x16x32_bf16 v[108:111], v[232:235], v[44:47], v[108:111]
    ds_read_b64_tr_b16 v[226:227], v4 offset:50944
    s_waitcnt lgkmcnt(6)
    v_mfma_f32_16x16x32_bf16 v[112:115], v[236:239], v[40:43], v[112:115]
    ds_read_b64_tr_b16 v[228:229], v5 offset:49952
    v_mfma_f32_16x16x32_bf16 v[116:119], v[236:239], v[44:47], v[116:119]
    ds_read_b64_tr_b16 v[230:231], v5 offset:50976
    s_waitcnt lgkmcnt(6)
    v_mfma_f32_16x16x32_bf16 v[120:123], v[240:243], v[40:43], v[120:123]
    v_mfma_f32_16x16x32_bf16 v[124:127], v[240:243], v[44:47], v[124:127]
    s_waitcnt vmcnt(16)
    s_barrier
    ds_read_b64_tr_b16 v[232:233], v7 offset:0
    ds_read_b64_tr_b16 v[234:235], v7 offset:1024
    s_waitcnt lgkmcnt(6)
    v_mfma_f32_16x16x32_bf16 v[128:131], v[244:247], v[40:43], v[128:131]
    ds_read_b64_tr_b16 v[236:237], v8 offset:32
    s_mov_b32 s23, 0xe000
    buffer_load_dwordx4 v[32:35], v6, s[8:11], s23 offen offset:3072 sc1
    v_mfma_f32_16x16x32_bf16 v[132:135], v[244:247], v[44:47], v[132:135]
    ds_read_b64_tr_b16 v[238:239], v8 offset:1056
    s_waitcnt lgkmcnt(6)
    v_mfma_f32_16x16x32_bf16 v[136:139], v[224:227], v[40:43], v[136:139]
    ds_read_b64_tr_b16 v[240:241], v7 offset:256
    v_mfma_f32_16x16x32_bf16 v[140:143], v[224:227], v[44:47], v[140:143]
    ds_read_b64_tr_b16 v[242:243], v7 offset:1280
    s_mov_b32 s23, 0x2e000
    buffer_load_dwordx4 v[36:39], v6, s[8:11], s23 offen offset:3072 sc1
    s_waitcnt lgkmcnt(6)
    v_mfma_f32_16x16x32_bf16 v[144:147], v[228:231], v[40:43], v[144:147]
    ds_read_b64_tr_b16 v[244:245], v8 offset:288
    v_mfma_f32_16x16x32_bf16 v[148:151], v[228:231], v[44:47], v[148:151]
    ds_read_b64_tr_b16 v[246:247], v8 offset:1312
    s_waitcnt vmcnt(17) lgkmcnt(6)
    v_mfma_f32_16x16x32_bf16 v[88:91], v[232:235], v[48:51], v[88:91]
    ds_read_b64_tr_b16 v[224:225], v7 offset:512
    s_waitcnt vmcnt(16)
    v_mfma_f32_16x16x32_bf16 v[92:95], v[232:235], v[52:55], v[92:95]
    ds_read_b64_tr_b16 v[226:227], v7 offset:1536
    s_waitcnt lgkmcnt(6)
    v_mfma_f32_16x16x32_bf16 v[96:99], v[236:239], v[48:51], v[96:99]
    ds_read_b64_tr_b16 v[228:229], v8 offset:544
    v_mfma_f32_16x16x32_bf16 v[100:103], v[236:239], v[52:55], v[100:103]
    ds_read_b64_tr_b16 v[230:231], v8 offset:1568
    s_waitcnt lgkmcnt(6)
    v_mfma_f32_16x16x32_bf16 v[104:107], v[240:243], v[48:51], v[104:107]
    ds_read_b64_tr_b16 v[232:233], v7 offset:768
    v_mfma_f32_16x16x32_bf16 v[108:111], v[240:243], v[52:55], v[108:111]
    ds_read_b64_tr_b16 v[234:235], v7 offset:1792
    s_waitcnt lgkmcnt(6)
    v_mfma_f32_16x16x32_bf16 v[112:115], v[244:247], v[48:51], v[112:115]
    ds_read_b64_tr_b16 v[236:237], v8 offset:800
    v_mfma_f32_16x16x32_bf16 v[116:119], v[244:247], v[52:55], v[116:119]
    ds_read_b64_tr_b16 v[238:239], v8 offset:1824
    s_waitcnt lgkmcnt(6)
    v_mfma_f32_16x16x32_bf16 v[120:123], v[224:227], v[48:51], v[120:123]
    s_mov_b64 s[72:73], s[48:49]
    s_mov_b32 s74, 0x700000
    s_mov_b32 s75, 0x20000
    s_cmp_lt_u32 s2, 224
    s_cselect_b32 s74, 7340032, 0
    s_and_b32 s16, s3, 3
    v_lshrrev_b32 v20, 3, v1
    v_lshlrev_b32 v20, 3, v20
    s_lshl_b32 s17, s16, 6
    v_add_u32 v20, s17, v20
    s_mov_b32 s17, 7168
    v_mul_lo_u32 v21, s17, v20
    v_and_b32 v20, 7, v1
    v_lshl_add_u32 v21, v20, 4, v21
    s_and_b32 s17, s29, 3
    s_mul_i32 s18, s17, 1835008
    s_lshr_b32 s17, s29, 2
    s_lshl_b32 s17, s17, 7
    s_add_u32 s18, s18, s17
    s_lshl_b32 s16, s16, 13
    s_add_u32 s22, s18, 0
    s_add_u32 m0, s16, 32768
    s_nop 0
    buffer_load_dwordx4 v21, s[72:75], s22 offen lds
    s_add_u32 s22, s18, 7168
    s_add_u32 m0, s16, 33792
    s_nop 0
    buffer_load_dwordx4 v21, s[72:75], s22 offen lds
    s_add_u32 s22, s18, 14336
    s_add_u32 m0, s16, 34816
    s_nop 0
    buffer_load_dwordx4 v21, s[72:75], s22 offen lds
    s_add_u32 s22, s18, 21504
    s_add_u32 m0, s16, 35840
    s_nop 0
    buffer_load_dwordx4 v21, s[72:75], s22 offen lds
    s_add_u32 s22, s18, 28672
    s_add_u32 m0, s16, 36864
    s_nop 0
    buffer_load_dwordx4 v21, s[72:75], s22 offen lds
    s_add_u32 s22, s18, 35840
    s_add_u32 m0, s16, 37888
    s_nop 0
    buffer_load_dwordx4 v21, s[72:75], s22 offen lds
    s_add_u32 s22, s18, 43008
    s_add_u32 m0, s16, 38912
    s_nop 0
    buffer_load_dwordx4 v21, s[72:75], s22 offen lds
    s_add_u32 s22, s18, 50176
    s_add_u32 m0, s16, 39936
    s_nop 0
    buffer_load_dwordx4 v21, s[72:75], s22 offen lds
    v_mfma_f32_16x16x32_bf16 v[124:127], v[224:227], v[52:55], v[124:127]
    s_waitcnt vmcnt(22)
    s_barrier
    ds_read_b64_tr_b16 v[240:241], v7 offset:16384
    ds_read_b64_tr_b16 v[242:243], v7 offset:17408
    s_waitcnt lgkmcnt(6)
    v_mfma_f32_16x16x32_bf16 v[128:131], v[228:231], v[48:51], v[128:131]
    ds_read_b64_tr_b16 v[244:245], v8 offset:16416
    v_mfma_f32_16x16x32_bf16 v[132:135], v[228:231], v[52:55], v[132:135]
    ds_read_b64_tr_b16 v[246:247], v8 offset:17440
    s_waitcnt lgkmcnt(6)
    v_mfma_f32_16x16x32_bf16 v[136:139], v[232:235], v[48:51], v[136:139]
    ds_read_b64_tr_b16 v[224:225], v7 offset:16640
    v_mfma_f32_16x16x32_bf16 v[140:143], v[232:235], v[52:55], v[140:143]
    ds_read_b64_tr_b16 v[226:227], v7 offset:17664
    s_waitcnt lgkmcnt(6)
    v_mfma_f32_16x16x32_bf16 v[144:147], v[236:239], v[48:51], v[144:147]
    ds_read_b64_tr_b16 v[228:229], v8 offset:16672
    v_mfma_f32_16x16x32_bf16 v[148:151], v[236:239], v[52:55], v[148:151]
    ds_read_b64_tr_b16 v[230:231], v8 offset:17696
    s_waitcnt vmcnt(21) lgkmcnt(6)
    v_mfma_f32_16x16x32_bf16 v[88:91], v[240:243], v[56:59], v[88:91]
    ds_read_b64_tr_b16 v[232:233], v7 offset:16896
    s_waitcnt vmcnt(20)
    v_mfma_f32_16x16x32_bf16 v[92:95], v[240:243], v[60:63], v[92:95]
    ds_read_b64_tr_b16 v[234:235], v7 offset:17920
    s_waitcnt lgkmcnt(6)
    v_mfma_f32_16x16x32_bf16 v[96:99], v[244:247], v[56:59], v[96:99]
    ds_read_b64_tr_b16 v[236:237], v8 offset:16928
    v_mfma_f32_16x16x32_bf16 v[100:103], v[244:247], v[60:63], v[100:103]
    ds_read_b64_tr_b16 v[238:239], v8 offset:17952
    s_waitcnt lgkmcnt(6)
    v_mfma_f32_16x16x32_bf16 v[104:107], v[224:227], v[56:59], v[104:107]
    ds_read_b64_tr_b16 v[240:241], v7 offset:17152
    v_mfma_f32_16x16x32_bf16 v[108:111], v[224:227], v[60:63], v[108:111]
    ds_read_b64_tr_b16 v[242:243], v7 offset:18176
    s_waitcnt lgkmcnt(6)
    v_mfma_f32_16x16x32_bf16 v[112:115], v[228:231], v[56:59], v[112:115]
    ds_read_b64_tr_b16 v[244:245], v8 offset:17184
    v_mfma_f32_16x16x32_bf16 v[116:119], v[228:231], v[60:63], v[116:119]
    ds_read_b64_tr_b16 v[246:247], v8 offset:18208
    s_waitcnt lgkmcnt(6)
    v_mfma_f32_16x16x32_bf16 v[120:123], v[232:235], v[56:59], v[120:123]
    v_mfma_f32_16x16x32_bf16 v[124:127], v[232:235], v[60:63], v[124:127]
    s_waitcnt vmcnt(18)
    s_barrier
    ds_read_b64_tr_b16 v[224:225], v4 offset:0
    ds_read_b64_tr_b16 v[226:227], v4 offset:1024
    s_waitcnt lgkmcnt(6)
    v_mfma_f32_16x16x32_bf16 v[128:131], v[236:239], v[56:59], v[128:131]
    ds_read_b64_tr_b16 v[228:229], v5 offset:32
    v_mfma_f32_16x16x32_bf16 v[132:135], v[236:239], v[60:63], v[132:135]
    ds_read_b64_tr_b16 v[230:231], v5 offset:1056
    s_waitcnt lgkmcnt(6)
    v_mfma_f32_16x16x32_bf16 v[136:139], v[240:243], v[56:59], v[136:139]
    ds_read_b64_tr_b16 v[232:233], v4 offset:256
    v_mfma_f32_16x16x32_bf16 v[140:143], v[240:243], v[60:63], v[140:143]
    ds_read_b64_tr_b16 v[234:235], v4 offset:1280
    s_waitcnt lgkmcnt(6)
    v_mfma_f32_16x16x32_bf16 v[144:147], v[244:247], v[56:59], v[144:147]
    ds_read_b64_tr_b16 v[236:237], v5 offset:288
    v_mfma_f32_16x16x32_bf16 v[148:151], v[244:247], v[60:63], v[148:151]
    ds_read_b64_tr_b16 v[238:239], v5 offset:1312
    s_waitcnt vmcnt(13) lgkmcnt(6)
    v_mfma_f32_16x16x32_bf16 v[88:91], v[224:227], v[24:27], v[88:91]
    ds_read_b64_tr_b16 v[240:241], v4 offset:512
    s_waitcnt vmcnt(12)
    v_mfma_f32_16x16x32_bf16 v[92:95], v[224:227], v[28:31], v[92:95]
    ds_read_b64_tr_b16 v[242:243], v4 offset:1536
    s_waitcnt lgkmcnt(6)
    v_mfma_f32_16x16x32_bf16 v[96:99], v[228:231], v[24:27], v[96:99]
    ds_read_b64_tr_b16 v[244:245], v5 offset:544
    v_mfma_f32_16x16x32_bf16 v[100:103], v[228:231], v[28:31], v[100:103]
    ds_read_b64_tr_b16 v[246:247], v5 offset:1568
    s_waitcnt lgkmcnt(6)
    v_mfma_f32_16x16x32_bf16 v[104:107], v[232:235], v[24:27], v[104:107]
    ds_read_b64_tr_b16 v[224:225], v4 offset:768
    v_mfma_f32_16x16x32_bf16 v[108:111], v[232:235], v[28:31], v[108:111]
    ds_read_b64_tr_b16 v[226:227], v4 offset:1792
    s_waitcnt lgkmcnt(6)
    v_mfma_f32_16x16x32_bf16 v[112:115], v[236:239], v[24:27], v[112:115]
    ds_read_b64_tr_b16 v[228:229], v5 offset:800
    v_mfma_f32_16x16x32_bf16 v[116:119], v[236:239], v[28:31], v[116:119]
    ds_read_b64_tr_b16 v[230:231], v5 offset:1824
    s_waitcnt lgkmcnt(6)
    v_mfma_f32_16x16x32_bf16 v[120:123], v[240:243], v[24:27], v[120:123]
    v_mfma_f32_16x16x32_bf16 v[124:127], v[240:243], v[28:31], v[124:127]
    s_waitcnt vmcnt(10)
    s_barrier
    ds_read_b64_tr_b16 v[232:233], v4 offset:16384
    ds_read_b64_tr_b16 v[234:235], v4 offset:17408
    s_waitcnt lgkmcnt(6)
    v_mfma_f32_16x16x32_bf16 v[128:131], v[244:247], v[24:27], v[128:131]
    ds_read_b64_tr_b16 v[236:237], v5 offset:16416
    v_mfma_f32_16x16x32_bf16 v[132:135], v[244:247], v[28:31], v[132:135]
    ds_read_b64_tr_b16 v[238:239], v5 offset:17440
    s_waitcnt lgkmcnt(6)
    v_mfma_f32_16x16x32_bf16 v[136:139], v[224:227], v[24:27], v[136:139]
    ds_read_b64_tr_b16 v[240:241], v4 offset:16640
    v_mfma_f32_16x16x32_bf16 v[140:143], v[224:227], v[28:31], v[140:143]
    ds_read_b64_tr_b16 v[242:243], v4 offset:17664
    s_waitcnt lgkmcnt(6)
    v_mfma_f32_16x16x32_bf16 v[144:147], v[228:231], v[24:27], v[144:147]
    ds_read_b64_tr_b16 v[244:245], v5 offset:16672
    v_mfma_f32_16x16x32_bf16 v[148:151], v[228:231], v[28:31], v[148:151]
    ds_read_b64_tr_b16 v[246:247], v5 offset:17696
    s_waitcnt vmcnt(9) lgkmcnt(6)
    v_mfma_f32_16x16x32_bf16 v[88:91], v[232:235], v[32:35], v[88:91]
    ds_read_b64_tr_b16 v[224:225], v4 offset:16896
    s_waitcnt vmcnt(8)
    v_mfma_f32_16x16x32_bf16 v[92:95], v[232:235], v[36:39], v[92:95]
    ds_read_b64_tr_b16 v[226:227], v4 offset:17920
    s_waitcnt lgkmcnt(6)
    v_mfma_f32_16x16x32_bf16 v[96:99], v[236:239], v[32:35], v[96:99]
    ds_read_b64_tr_b16 v[228:229], v5 offset:16928
    v_mfma_f32_16x16x32_bf16 v[100:103], v[236:239], v[36:39], v[100:103]
    ds_read_b64_tr_b16 v[230:231], v5 offset:17952
    s_waitcnt lgkmcnt(6)
    v_mfma_f32_16x16x32_bf16 v[104:107], v[240:243], v[32:35], v[104:107]
    ds_read_b64_tr_b16 v[232:233], v4 offset:17152
    v_mfma_f32_16x16x32_bf16 v[108:111], v[240:243], v[36:39], v[108:111]
    ds_read_b64_tr_b16 v[234:235], v4 offset:18176
    s_waitcnt lgkmcnt(6)
    v_mfma_f32_16x16x32_bf16 v[112:115], v[244:247], v[32:35], v[112:115]
    ds_read_b64_tr_b16 v[236:237], v5 offset:17184
    v_mfma_f32_16x16x32_bf16 v[116:119], v[244:247], v[36:39], v[116:119]
    ds_read_b64_tr_b16 v[238:239], v5 offset:18208
    s_waitcnt lgkmcnt(6)
    v_mfma_f32_16x16x32_bf16 v[120:123], v[224:227], v[32:35], v[120:123]
    v_mfma_f32_16x16x32_bf16 v[124:127], v[224:227], v[36:39], v[124:127]
    s_waitcnt lgkmcnt(4)
    v_mfma_f32_16x16x32_bf16 v[128:131], v[228:231], v[32:35], v[128:131]
    v_mfma_f32_16x16x32_bf16 v[132:135], v[228:231], v[36:39], v[132:135]
    s_waitcnt lgkmcnt(2)
    v_mfma_f32_16x16x32_bf16 v[136:139], v[232:235], v[32:35], v[136:139]
    v_mfma_f32_16x16x32_bf16 v[140:143], v[232:235], v[36:39], v[140:143]
    s_waitcnt lgkmcnt(0)
    v_mfma_f32_16x16x32_bf16 v[144:147], v[236:239], v[32:35], v[144:147]
    v_mfma_f32_16x16x32_bf16 v[148:151], v[236:239], v[36:39], v[148:151]
    s_lshl_b32 s16, s3, 13
    s_xor_b32 s17, s16, 0x8000
    s_add_u32 s16, s16, 0x18000
    s_add_u32 s17, s17, 0x18000
    v_add_u32 v16, s16, v2
    s_mov_b32 s16, s17
    v_add_u32 v17, s16, v2
    ds_write_b128 v16, v[88:91] offset:0
    ds_write_b128 v16, v[92:95] offset:1024
    ds_write_b128 v16, v[96:99] offset:2048
    ds_write_b128 v16, v[100:103] offset:3072
    ds_write_b128 v16, v[104:107] offset:4096
    ds_write_b128 v16, v[108:111] offset:5120
    ds_write_b128 v16, v[112:115] offset:6144
    ds_write_b128 v16, v[116:119] offset:7168
    v_lshlrev_b32 v24, 16, v248
    v_and_b32 v25, 0xffff0000, v248
    v_lshlrev_b32 v26, 16, v249
    v_and_b32 v27, 0xffff0000, v249
    v_lshlrev_b32 v28, 16, v250
    v_and_b32 v29, 0xffff0000, v250
    v_lshlrev_b32 v30, 16, v251
    v_and_b32 v31, 0xffff0000, v251
    v_lshlrev_b32 v32, 16, v252
    v_and_b32 v33, 0xffff0000, v252
    v_lshlrev_b32 v34, 16, v253
    v_and_b32 v35, 0xffff0000, v253
    v_lshlrev_b32 v36, 16, v254
    v_and_b32 v37, 0xffff0000, v254
    v_lshlrev_b32 v38, 16, v255
    v_and_b32 v39, 0xffff0000, v255
    v_and_b32 v18, 15, v1
    v_lshlrev_b32 v18, 6, v18
    v_lshrrev_b32 v19, 4, v1
    v_and_b32 v20, 1, v19
    v_lshl_add_u32 v18, v20, 5, v18
    v_lshrrev_b32 v19, 1, v19
    v_lshl_add_u32 v18, v19, 4, v18
    s_and_b32 s17, s3, 3
    s_lshl_b32 s18, s30, 2
    s_add_u32 s18, s18, s17
    s_lshl_b32 s18, s18, 16
    s_lshl_b32 s19, s15, 22
    s_add_u32 s18, s18, s19
    s_lshl_b32 s19, s31, 12
    s_add_u32 s18, s18, s19
    s_add_u32 s18, s18, 0x2000800
    s_add_u32 s19, s18, 32768
    s_waitcnt lgkmcnt(0)
    s_barrier
    ds_read_b128 v[40:43], v17 offset:0
    ds_read_b128 v[44:47], v17 offset:1024
    ds_read_b128 v[48:51], v17 offset:2048
    ds_read_b128 v[52:55], v17 offset:3072
    ds_read_b128 v[56:59], v17 offset:4096
    ds_read_b128 v[60:63], v17 offset:5120
    ds_read_b128 v[64:67], v17 offset:6144
    ds_read_b128 v[68:71], v17 offset:7168
    s_waitcnt lgkmcnt(7)
    v_pk_add_f32 v[120:121], v[120:121], v[40:41]
    v_pk_add_f32 v[122:123], v[122:123], v[42:43]
    v_pk_mul_f32 v[120:121], v[120:121], v[24:25]
    v_pk_mul_f32 v[122:123], v[122:123], v[26:27]
    v_cvt_pk_bf16_f32 v224, v120, v121
    v_cvt_pk_bf16_f32 v225, v122, v123
    s_waitcnt lgkmcnt(5)
    v_pk_add_f32 v[128:129], v[128:129], v[48:49]
    v_pk_add_f32 v[130:131], v[130:131], v[50:51]
    v_pk_mul_f32 v[128:129], v[128:129], v[28:29]
    v_pk_mul_f32 v[130:131], v[130:131], v[30:31]
    v_cvt_pk_bf16_f32 v226, v128, v129
    v_cvt_pk_bf16_f32 v227, v130, v131
    s_nop 0
    v_permlane16_swap_b32 v224, v226
    v_permlane16_swap_b32 v225, v227
    buffer_store_dwordx4 v[224:227], v18, s[8:11], s18 offen offset:0 sc1
    v_pk_add_f32 v[124:125], v[124:125], v[44:45]
    v_pk_add_f32 v[126:127], v[126:127], v[46:47]
    v_pk_mul_f32 v[124:125], v[124:125], v[24:25]
    v_pk_mul_f32 v[126:127], v[126:127], v[26:27]
    v_cvt_pk_bf16_f32 v228, v124, v125
    v_cvt_pk_bf16_f32 v229, v126, v127
    s_waitcnt lgkmcnt(4)
    v_pk_add_f32 v[132:133], v[132:133], v[52:53]
    v_pk_add_f32 v[134:135], v[134:135], v[54:55]
    v_pk_mul_f32 v[132:133], v[132:133], v[28:29]
    v_pk_mul_f32 v[134:135], v[134:135], v[30:31]
    v_cvt_pk_bf16_f32 v230, v132, v133
    v_cvt_pk_bf16_f32 v231, v134, v135
    s_nop 0
    v_permlane16_swap_b32 v228, v230
    v_permlane16_swap_b32 v229, v231
    buffer_store_dwordx4 v[228:231], v18, s[8:11], s19 offen offset:0 sc1
    s_waitcnt lgkmcnt(3)
    v_pk_add_f32 v[136:137], v[136:137], v[56:57]
    v_pk_add_f32 v[138:139], v[138:139], v[58:59]
    v_pk_mul_f32 v[136:137], v[136:137], v[32:33]
    v_pk_mul_f32 v[138:139], v[138:139], v[34:35]
    v_cvt_pk_bf16_f32 v232, v136, v137
    v_cvt_pk_bf16_f32 v233, v138, v139
    s_waitcnt lgkmcnt(1)
    v_pk_add_f32 v[144:145], v[144:145], v[64:65]
    v_pk_add_f32 v[146:147], v[146:147], v[66:67]
    v_pk_mul_f32 v[144:145], v[144:145], v[36:37]
    v_pk_mul_f32 v[146:147], v[146:147], v[38:39]
    v_cvt_pk_bf16_f32 v234, v144, v145
    v_cvt_pk_bf16_f32 v235, v146, v147
    s_nop 0
    v_permlane16_swap_b32 v232, v234
    v_permlane16_swap_b32 v233, v235
    buffer_store_dwordx4 v[232:235], v18, s[8:11], s18 offen offset:1024 sc1
    v_pk_add_f32 v[140:141], v[140:141], v[60:61]
    v_pk_add_f32 v[142:143], v[142:143], v[62:63]
    v_pk_mul_f32 v[140:141], v[140:141], v[32:33]
    v_pk_mul_f32 v[142:143], v[142:143], v[34:35]
    v_cvt_pk_bf16_f32 v236, v140, v141
    v_cvt_pk_bf16_f32 v237, v142, v143
    s_waitcnt lgkmcnt(0)
    v_pk_add_f32 v[148:149], v[148:149], v[68:69]
    v_pk_add_f32 v[150:151], v[150:151], v[70:71]
    v_pk_mul_f32 v[148:149], v[148:149], v[36:37]
    v_pk_mul_f32 v[150:151], v[150:151], v[38:39]
    v_cvt_pk_bf16_f32 v238, v148, v149
    v_cvt_pk_bf16_f32 v239, v150, v151
    s_nop 0
    v_permlane16_swap_b32 v236, v238
    v_permlane16_swap_b32 v237, v239
    buffer_store_dwordx4 v[236:239], v18, s[8:11], s19 offen offset:1024 sc1
    s_mov_b64 s[64:65], s[44:45]
    s_mov_b32 s66, 0x800
    s_mov_b32 s67, 0x20000
    s_mov_b64 s[76:77], s[32:33]
    s_mov_b32 s78, 0x400000
    s_mov_b32 s79, 0x20000
    s_mov_b64 s[68:69], s[56:57]
    s_mov_b32 s70, 0x400000
    s_mov_b32 s71, 0x20000
    s_lshl_b32 s14, s31, 1
    s_add_u32 s14, s14, s15
    s_lshl_b32 s14, s14, 3
    s_add_u32 s14, s14, s3
    s_lshl_b32 s16, s30, 7
    s_add_u32 s14, s14, s16
    s_lshl_b32 s16, s14, 11
    buffer_load_dwordx4 v[216:219], v2, s[76:79], s16 offen offset:0
    buffer_load_dwordx4 v[220:223], v2, s[76:79], s16 offen offset:1024
    s_lshl_b32 s16, s3, 10
    s_add_u32 m0, s16, 81920
    s_add_u32 s17, s16, 0x540800
    s_cmp_lt_u32 s3, 6
    s_cselect_b32 s17, s17, 0x7ffffff0
    s_sub_u32 s23, s16, 6144
    s_cmp_ge_u32 s3, 6
    s_cselect_b32 s23, s23, 0x7ffffff0
    s_cbranch_scc1 adaLN_cond__sliding_block_cached__moe_arch_mod__prompt_kernel_mlw
    buffer_load_dwordx4 v2, s[8:11], s17 offen sc1 lds
    s_branch adaLN_cond__sliding_block_cached__moe_arch_mod__prompt_kernel_mlj
adaLN_cond__sliding_block_cached__moe_arch_mod__prompt_kernel_mlw:
    buffer_load_dwordx4 v2, s[64:67], s23 offen lds
adaLN_cond__sliding_block_cached__moe_arch_mod__prompt_kernel_mlj:
    s_lshl_b32 s16, s30, 5
    s_lshl_b32 s17, s31, 1
    s_add_u32 s16, s16, s17
    s_add_u32 s16, s16, s15
    s_lshl_b32 s16, s16, 2
    s_add_u32 s16, s16, 0x530000
    s_cmp_eq_u32 s3, 0
    s_cselect_b32 s16, s16, 0x7ffffff0
    v_mov_b32 v16, s28
    v_mov_b32 v17, 0
    s_lshr_b32 s18, s14, 4
    s_lshl_b32 s18, s18, 15
    s_and_b32 s19, s14, 15
    s_lshl_b32 s19, s19, 6
    s_add_u32 s18, s18, s19
    s_add_u32 s18, s18, 0x2000000
    s_add_u32 s19, s18, 16384
    v_lshrrev_b32 v18, 2, v1
    v_lshlrev_b32 v18, 10, v18
    v_and_b32 v19, 3, v1
    v_lshl_add_u32 v18, v19, 4, v18
    v_add_u32 v19, 0x400000, v18
    s_lshl_b32 s25, s30, 7
    s_add_u32 s25, s25, 0x530000
    v_and_b32 v20, 15, v1
    v_lshlrev_b32 v20, 2, v20
    s_waitcnt vmcnt(3)
    s_waitcnt vmcnt(0)
    s_barrier
    s_mov_b64 exec, 1
    buffer_store_dword v16, v17, s[8:11], s16 offen sc1
    s_mov_b64 exec, -1
    v_add_u32 v16, 81920, v2
    ds_read_b128 v[184:187], v16 offset:0
    ds_read_b128 v[188:191], v16 offset:1024
    ds_read_b128 v[192:195], v16 offset:2048
    ds_read_b128 v[196:199], v16 offset:3072
    ds_read_b128 v[200:203], v16 offset:4096
    ds_read_b128 v[204:207], v16 offset:5120
    ds_read_b128 v[208:211], v16 offset:6144
    ds_read_b128 v[212:215], v16 offset:7168
    v_mov_b32 v94, 0
    v_mov_b32 v95, 0
    s_waitcnt lgkmcnt(5)
    v_lshlrev_b32 v76, 16, v192
    v_and_b32 v77, 0xffff0000, v192
    s_waitcnt lgkmcnt(1)
    v_lshlrev_b32 v78, 16, v208
    v_and_b32 v79, 0xffff0000, v208
    v_pk_mul_f32 v[60:61], v[76:77], v[78:79]
    v_lshlrev_b32 v76, 16, v184
    v_and_b32 v77, 0xffff0000, v184
    v_fmac_f32 v94, v76, v78
    v_fmac_f32 v94, v77, v79
    v_add_f32 v95, v95, v60
    v_add_f32 v95, v95, v61
    v_lshlrev_b32 v76, 16, v193
    v_and_b32 v77, 0xffff0000, v193
    v_lshlrev_b32 v78, 16, v209
    v_and_b32 v79, 0xffff0000, v209
    v_pk_mul_f32 v[62:63], v[76:77], v[78:79]
    v_lshlrev_b32 v76, 16, v185
    v_and_b32 v77, 0xffff0000, v185
    v_fmac_f32 v94, v76, v78
    v_fmac_f32 v94, v77, v79
    v_add_f32 v95, v95, v62
    v_add_f32 v95, v95, v63
    v_lshlrev_b32 v76, 16, v194
    v_and_b32 v77, 0xffff0000, v194
    v_lshlrev_b32 v78, 16, v210
    v_and_b32 v79, 0xffff0000, v210
    v_pk_mul_f32 v[64:65], v[76:77], v[78:79]
    v_lshlrev_b32 v76, 16, v186
    v_and_b32 v77, 0xffff0000, v186
    v_fmac_f32 v94, v76, v78
    v_fmac_f32 v94, v77, v79
    v_add_f32 v95, v95, v64
    v_add_f32 v95, v95, v65
    v_lshlrev_b32 v76, 16, v195
    v_and_b32 v77, 0xffff0000, v195
    v_lshlrev_b32 v78, 16, v211
    v_and_b32 v79, 0xffff0000, v211
    v_pk_mul_f32 v[66:67], v[76:77], v[78:79]
    v_lshlrev_b32 v76, 16, v187
    v_and_b32 v77, 0xffff0000, v187
    v_fmac_f32 v94, v76, v78
    v_fmac_f32 v94, v77, v79
    v_add_f32 v95, v95, v66
    v_add_f32 v95, v95, v67
    v_lshlrev_b32 v76, 16, v196
    v_and_b32 v77, 0xffff0000, v196
    s_waitcnt lgkmcnt(0)
    v_lshlrev_b32 v78, 16, v212
    v_and_b32 v79, 0xffff0000, v212
    v_pk_mul_f32 v[68:69], v[76:77], v[78:79]
    v_lshlrev_b32 v76, 16, v188
    v_and_b32 v77, 0xffff0000, v188
    v_fmac_f32 v94, v76, v78
    v_fmac_f32 v94, v77, v79
    v_add_f32 v95, v95, v68
    v_add_f32 v95, v95, v69
    v_lshlrev_b32 v76, 16, v197
    v_and_b32 v77, 0xffff0000, v197
    v_lshlrev_b32 v78, 16, v213
    v_and_b32 v79, 0xffff0000, v213
    v_pk_mul_f32 v[70:71], v[76:77], v[78:79]
    v_lshlrev_b32 v76, 16, v189
    v_and_b32 v77, 0xffff0000, v189
    v_fmac_f32 v94, v76, v78
    v_fmac_f32 v94, v77, v79
    v_add_f32 v95, v95, v70
    v_add_f32 v95, v95, v71
    v_lshlrev_b32 v76, 16, v198
    v_and_b32 v77, 0xffff0000, v198
    v_lshlrev_b32 v78, 16, v214
    v_and_b32 v79, 0xffff0000, v214
    v_pk_mul_f32 v[72:73], v[76:77], v[78:79]
    v_lshlrev_b32 v76, 16, v190
    v_and_b32 v77, 0xffff0000, v190
    v_fmac_f32 v94, v76, v78
    v_fmac_f32 v94, v77, v79
    v_add_f32 v95, v95, v72
    v_add_f32 v95, v95, v73
    v_lshlrev_b32 v76, 16, v199
    v_and_b32 v77, 0xffff0000, v199
    v_lshlrev_b32 v78, 16, v215
    v_and_b32 v79, 0xffff0000, v215
    v_pk_mul_f32 v[74:75], v[76:77], v[78:79]
    v_lshlrev_b32 v76, 16, v191
    v_and_b32 v77, 0xffff0000, v191
    v_fmac_f32 v94, v76, v78
    v_fmac_f32 v94, v77, v79
    v_add_f32 v95, v95, v74
    v_add_f32 v95, v95, v75
    v_add_f32_dpp v94, v94, v94 row_ror:1 row_mask:0xf bank_mask:0xf
    s_nop 0
    v_add_f32_dpp v95, v95, v95 row_ror:1 row_mask:0xf bank_mask:0xf
    v_add_f32_dpp v94, v94, v94 row_ror:2 row_mask:0xf bank_mask:0xf
    s_nop 0
    v_add_f32_dpp v95, v95, v95 row_ror:2 row_mask:0xf bank_mask:0xf
    v_add_f32_dpp v94, v94, v94 row_ror:4 row_mask:0xf bank_mask:0xf
    s_nop 0
    v_add_f32_dpp v95, v95, v95 row_ror:4 row_mask:0xf bank_mask:0xf
    v_add_f32_dpp v94, v94, v94 row_ror:8 row_mask:0xf bank_mask:0xf
    s_nop 0
    v_add_f32_dpp v95, v95, v95 row_ror:8 row_mask:0xf bank_mask:0xf
    v_mov_b32 v76, v94
    s_nop 1
    v_permlane16_swap_b32 v94, v76
    v_add_f32 v94, v94, v76
    v_mov_b32 v77, v95
    s_nop 1
    v_permlane16_swap_b32 v95, v77
    v_add_f32 v95, v95, v77
    v_mov_b32 v76, v94
    s_nop 1
    v_permlane32_swap_b32 v94, v76
    v_add_f32 v94, v94, v76
    v_mov_b32 v77, v95
    s_nop 1
    v_permlane32_swap_b32 v95, v77
    v_add_f32 v95, v95, v77
    v_lshlrev_b32 v28, 16, v216
    v_and_b32 v29, 0xffff0000, v216
    v_lshlrev_b32 v30, 16, v217
    v_and_b32 v31, 0xffff0000, v217
    v_lshlrev_b32 v32, 16, v218
    v_and_b32 v33, 0xffff0000, v218
    v_lshlrev_b32 v34, 16, v219
    v_and_b32 v35, 0xffff0000, v219
    v_lshlrev_b32 v36, 16, v220
    v_and_b32 v37, 0xffff0000, v220
    v_lshlrev_b32 v38, 16, v221
    v_and_b32 v39, 0xffff0000, v221
    v_lshlrev_b32 v40, 16, v222
    v_and_b32 v41, 0xffff0000, v222
    v_lshlrev_b32 v42, 16, v223
    v_and_b32 v43, 0xffff0000, v223
    s_mov_b32 s27, 0
adaLN_cond__sliding_block_cached__moe_arch_mod__prompt_kernel_a22p:
    buffer_load_dword v76, v20, s[8:11], s25 offen sc1
    s_waitcnt vmcnt(0)
    v_cmp_ne_u32 vcc, s28, v76
    s_add_u32 s27, s27, 1
    s_cmp_ge_u32 s27, 65536
    s_cbranch_scc1 adaLN_cond__sliding_block_cached__moe_arch_mod__prompt_kernel_a22g
    s_cbranch_vccnz adaLN_cond__sliding_block_cached__moe_arch_mod__prompt_kernel_a22p
adaLN_cond__sliding_block_cached__moe_arch_mod__prompt_kernel_a22g:
    buffer_load_dwordx4 v[44:47], v18, s[8:11], s18 offen sc1
    buffer_load_dwordx4 v[52:55], v19, s[8:11], s18 offen sc1
    buffer_load_dwordx4 v[48:51], v18, s[8:11], s19 offen sc1
    buffer_load_dwordx4 v[56:59], v19, s[8:11], s19 offen sc1
    v_lshlrev_b32 v21, 2, v0
    s_mov_b32 s16, 0x540800
    buffer_load_dword v106, v21, s[8:11], s16 offen sc1
    buffer_load_dword v104, v21, s[8:11], s16 offen offset:2048 sc1
    s_waitcnt vmcnt(5)
    v_lshlrev_b32 v76, 16, v44
    v_and_b32 v77, 0xffff0000, v44
    s_waitcnt vmcnt(4)
    v_lshlrev_b32 v78, 16, v52
    v_and_b32 v79, 0xffff0000, v52
    v_pk_add_f32 v[76:77], v[76:77], v[78:79]
    v_pk_add_f32 v[28:29], v[28:29], v[76:77]
    v_cvt_pk_bf16_f32 v16, v28, v29
    v_lshlrev_b32 v28, 16, v16
    v_and_b32 v29, 0xffff0000, v16
    v_lshlrev_b32 v80, 16, v45
    v_and_b32 v81, 0xffff0000, v45
    v_lshlrev_b32 v82, 16, v53
    v_and_b32 v83, 0xffff0000, v53
    v_pk_add_f32 v[80:81], v[80:81], v[82:83]
    v_pk_add_f32 v[30:31], v[30:31], v[80:81]
    v_cvt_pk_bf16_f32 v17, v30, v31
    v_lshlrev_b32 v30, 16, v17
    v_and_b32 v31, 0xffff0000, v17
    v_lshlrev_b32 v76, 16, v46
    v_and_b32 v77, 0xffff0000, v46
    v_lshlrev_b32 v78, 16, v54
    v_and_b32 v79, 0xffff0000, v54
    v_pk_add_f32 v[76:77], v[76:77], v[78:79]
    v_pk_add_f32 v[32:33], v[32:33], v[76:77]
    v_cvt_pk_bf16_f32 v16, v32, v33
    v_lshlrev_b32 v32, 16, v16
    v_and_b32 v33, 0xffff0000, v16
    v_lshlrev_b32 v80, 16, v47
    v_and_b32 v81, 0xffff0000, v47
    v_lshlrev_b32 v82, 16, v55
    v_and_b32 v83, 0xffff0000, v55
    v_pk_add_f32 v[80:81], v[80:81], v[82:83]
    v_pk_add_f32 v[34:35], v[34:35], v[80:81]
    v_cvt_pk_bf16_f32 v17, v34, v35
    v_lshlrev_b32 v34, 16, v17
    v_and_b32 v35, 0xffff0000, v17
    s_waitcnt vmcnt(3)
    v_lshlrev_b32 v76, 16, v48
    v_and_b32 v77, 0xffff0000, v48
    s_waitcnt vmcnt(2)
    v_lshlrev_b32 v78, 16, v56
    v_and_b32 v79, 0xffff0000, v56
    v_pk_add_f32 v[76:77], v[76:77], v[78:79]
    v_pk_add_f32 v[36:37], v[36:37], v[76:77]
    v_cvt_pk_bf16_f32 v16, v36, v37
    v_lshlrev_b32 v36, 16, v16
    v_and_b32 v37, 0xffff0000, v16
    v_lshlrev_b32 v80, 16, v49
    v_and_b32 v81, 0xffff0000, v49
    v_lshlrev_b32 v82, 16, v57
    v_and_b32 v83, 0xffff0000, v57
    v_pk_add_f32 v[80:81], v[80:81], v[82:83]
    v_pk_add_f32 v[38:39], v[38:39], v[80:81]
    v_cvt_pk_bf16_f32 v17, v38, v39
    v_lshlrev_b32 v38, 16, v17
    v_and_b32 v39, 0xffff0000, v17
    v_lshlrev_b32 v76, 16, v50
    v_and_b32 v77, 0xffff0000, v50
    v_lshlrev_b32 v78, 16, v58
    v_and_b32 v79, 0xffff0000, v58
    v_pk_add_f32 v[76:77], v[76:77], v[78:79]
    v_pk_add_f32 v[40:41], v[40:41], v[76:77]
    v_cvt_pk_bf16_f32 v16, v40, v41
    v_lshlrev_b32 v40, 16, v16
    v_and_b32 v41, 0xffff0000, v16
    v_lshlrev_b32 v80, 16, v51
    v_and_b32 v81, 0xffff0000, v51
    v_lshlrev_b32 v82, 16, v59
    v_and_b32 v83, 0xffff0000, v59
    v_pk_add_f32 v[80:81], v[80:81], v[82:83]
    v_pk_add_f32 v[42:43], v[42:43], v[80:81]
    v_cvt_pk_bf16_f32 v17, v42, v43
    v_lshlrev_b32 v42, 16, v17
    v_and_b32 v43, 0xffff0000, v17
    v_pk_add_f32 v[76:77], v[28:29], v[30:31]
    v_pk_mul_f32 v[78:79], v[28:29], v[28:29]
    v_pk_mul_f32 v[80:81], v[28:29], v[60:61]
    v_pk_fma_f32 v[78:79], v[30:31], v[30:31], v[78:79]
    v_pk_fma_f32 v[80:81], v[30:31], v[62:63], v[80:81]
    v_pk_add_f32 v[76:77], v[76:77], v[32:33]
    v_pk_fma_f32 v[78:79], v[32:33], v[32:33], v[78:79]
    v_pk_fma_f32 v[80:81], v[32:33], v[64:65], v[80:81]
    v_pk_add_f32 v[76:77], v[76:77], v[34:35]
    v_pk_fma_f32 v[78:79], v[34:35], v[34:35], v[78:79]
    v_pk_fma_f32 v[80:81], v[34:35], v[66:67], v[80:81]
    v_pk_add_f32 v[76:77], v[76:77], v[36:37]
    v_pk_fma_f32 v[78:79], v[36:37], v[36:37], v[78:79]
    v_pk_fma_f32 v[80:81], v[36:37], v[68:69], v[80:81]
    v_pk_add_f32 v[76:77], v[76:77], v[38:39]
    v_pk_fma_f32 v[78:79], v[38:39], v[38:39], v[78:79]
    v_pk_fma_f32 v[80:81], v[38:39], v[70:71], v[80:81]
    v_pk_add_f32 v[76:77], v[76:77], v[40:41]
    v_pk_fma_f32 v[78:79], v[40:41], v[40:41], v[78:79]
    v_pk_fma_f32 v[80:81], v[40:41], v[72:73], v[80:81]
    v_pk_add_f32 v[76:77], v[76:77], v[42:43]
    v_pk_fma_f32 v[78:79], v[42:43], v[42:43], v[78:79]
    v_pk_fma_f32 v[80:81], v[42:43], v[74:75], v[80:81]
    v_add_f32 v96, v76, v77
    v_add_f32 v97, v78, v79
    v_add_f32 v98, v80, v81
    v_add_f32_dpp v96, v96, v96 row_ror:1 row_mask:0xf bank_mask:0xf
    v_add_f32_dpp v97, v97, v97 row_ror:1 row_mask:0xf bank_mask:0xf
    v_add_f32_dpp v98, v98, v98 row_ror:1 row_mask:0xf bank_mask:0xf
    v_add_f32_dpp v96, v96, v96 row_ror:2 row_mask:0xf bank_mask:0xf
    v_add_f32_dpp v97, v97, v97 row_ror:2 row_mask:0xf bank_mask:0xf
    v_add_f32_dpp v98, v98, v98 row_ror:2 row_mask:0xf bank_mask:0xf
    v_add_f32_dpp v96, v96, v96 row_ror:4 row_mask:0xf bank_mask:0xf
    v_add_f32_dpp v97, v97, v97 row_ror:4 row_mask:0xf bank_mask:0xf
    v_add_f32_dpp v98, v98, v98 row_ror:4 row_mask:0xf bank_mask:0xf
    v_add_f32_dpp v96, v96, v96 row_ror:8 row_mask:0xf bank_mask:0xf
    v_add_f32_dpp v97, v97, v97 row_ror:8 row_mask:0xf bank_mask:0xf
    v_add_f32_dpp v98, v98, v98 row_ror:8 row_mask:0xf bank_mask:0xf
    v_mov_b32 v76, v96
    s_nop 1
    v_permlane16_swap_b32 v96, v76
    v_add_f32 v96, v96, v76
    v_mov_b32 v77, v97
    s_nop 1
    v_permlane16_swap_b32 v97, v77
    v_add_f32 v97, v97, v77
    v_mov_b32 v78, v98
    s_nop 1
    v_permlane16_swap_b32 v98, v78
    v_add_f32 v98, v98, v78
    v_mov_b32 v76, v96
    s_nop 1
    v_permlane32_swap_b32 v96, v76
    v_add_f32 v96, v96, v76
    v_mov_b32 v77, v97
    s_nop 1
    v_permlane32_swap_b32 v97, v77
    v_add_f32 v97, v97, v77
    v_mov_b32 v78, v98
    s_nop 1
    v_permlane32_swap_b32 v98, v78
    v_add_f32 v98, v98, v78
    v_mul_f32 v96, 0x3a800000, v96
    v_mul_f32 v97, 0x3a800000, v97
    v_fma_f32 v97, -v96, v96, v97
    v_max_f32 v97, 0, v97
    v_fma_f32 v98, -v96, v95, v98
    v_add_f32 v76, 0x3727c5ac, v97
    v_rsq_f32 v76, v76
    s_nop 0
    v_fma_f32 v27, v98, v76, v94
    v_cvt_pk_bf16_f32 v96, v96, v96
    v_lshlrev_b32 v96, 16, v96
    v_cvt_pk_bf16_f32 v97, v97, v97
    v_lshlrev_b32 v97, 16, v97
    v_add_f32 v97, 0x3727c5ac, v97
    v_cvt_pk_bf16_f32 v97, v97, v97
    v_lshlrev_b32 v97, 16, v97
    v_sqrt_f32 v98, v97
    s_nop 0
    v_cvt_pk_bf16_f32 v98, v98, v98
    v_lshlrev_b32 v98, 16, v98
    v_rcp_f32 v99, v98
    v_mov_b32 v25, v96
    v_mov_b32 v26, v98
    v_ashrrev_i32 v16, 31, v27
    v_or_b32 v16, 0x80000000, v16
    v_xor_b32 v24, v27, v16
    v_and_b32 v24, 0xfffff800, v24
    v_max_u32 v24, 0x800, v24
    s_sub_u32 s16, 2047, s14
    v_or_b32 v24, s16, v24
    s_lshl_b32 s16, s3, 4
    s_add_u32 s16, s16, 65536
    v_mov_b32 v16, s16
    ds_write_b128 v16, v[24:27]
    s_waitcnt lgkmcnt(0)
    s_barrier
    v_and_b32 v16, 7, v1
    v_lshlrev_b32 v16, 4, v16
    v_add_u32 v16, 65536, v16
    ds_read_b32 v76, v16
    s_waitcnt lgkmcnt(0)
    v_mov_b32 v77, v76
    s_nop 1
    v_max_u32_dpp v77, v77, v77 row_ror:1 row_mask:0xf bank_mask:0xf
    s_nop 1
    v_max_u32_dpp v77, v77, v77 row_ror:2 row_mask:0xf bank_mask:0xf
    s_nop 1
    v_max_u32_dpp v77, v77, v77 row_ror:4 row_mask:0xf bank_mask:0xf
    v_cmp_eq_u32 vcc, v76, v77
    s_ff1_i32_b64 s16, vcc
    s_lshl_b32 s16, s16, 4
    s_add_u32 s16, s16, 65536
    v_mov_b32 v16, s16
    ds_read_b128 v[24:27], v16
    s_lshl_b32 s16, s2, 4
    s_add_u32 s16, s16, 0x6e0000
    s_cmp_eq_u32 s3, 0
    s_cselect_b32 s16, s16, 0x7ffffff0
    v_mov_b32 v17, 0
    s_mov_b64 exec, 1
    s_waitcnt lgkmcnt(0)
    buffer_store_dwordx4 v[24:27], v17, s[8:11], s16 offen sc1
    s_mov_b64 exec, -1
    s_mov_b64 s[72:73], s[50:51]
    s_mov_b32 s74, 0x700000
    s_mov_b32 s75, 0x20000
    s_cmp_lt_u32 s2, 224
    s_cselect_b32 s74, 7340032, 0
    s_lshl_b32 s17, s29, 4
    s_sub_u32 s16, s3, 4
    s_lshl_b32 s16, s16, 2
    s_add_u32 s16, s16, s17
    s_lshl_b32 s16, s16, 11
    s_add_u32 s17, s16, 0
    buffer_load_dwordx4 v[152:155], v2, s[72:75], s17 offen offset:0
    buffer_load_dwordx4 v[156:159], v2, s[72:75], s17 offen offset:1024
    s_add_u32 s17, s16, 2048
    buffer_load_dwordx4 v[160:163], v2, s[72:75], s17 offen offset:0
    buffer_load_dwordx4 v[164:167], v2, s[72:75], s17 offen offset:1024
    s_add_u32 s17, s16, 4096
    buffer_load_dwordx4 v[168:171], v2, s[72:75], s17 offen offset:0
    buffer_load_dwordx4 v[172:175], v2, s[72:75], s17 offen offset:1024
    s_add_u32 s17, s16, 6144
    buffer_load_dwordx4 v[176:179], v2, s[72:75], s17 offen offset:0
    buffer_load_dwordx4 v[180:183], v2, s[72:75], s17 offen offset:1024
    v_sub_f32 v44, v28, v96
    v_sub_f32 v45, v29, v96
    v_sub_f32 v46, v30, v96
    v_sub_f32 v47, v31, v96
    v_sub_f32 v48, v32, v96
    v_sub_f32 v49, v33, v96
    v_sub_f32 v50, v34, v96
    v_sub_f32 v51, v35, v96
    v_cvt_pk_bf16_f32 v16, v44, v45
    v_lshlrev_b32 v44, 16, v16
    v_and_b32 v45, 0xffff0000, v16
    v_cvt_pk_bf16_f32 v16, v46, v47
    v_lshlrev_b32 v46, 16, v16
    v_and_b32 v47, 0xffff0000, v16
    v_cvt_pk_bf16_f32 v16, v48, v49
    v_lshlrev_b32 v48, 16, v16
    v_and_b32 v49, 0xffff0000, v16
    v_cvt_pk_bf16_f32 v16, v50, v51
    v_lshlrev_b32 v50, 16, v16
    v_and_b32 v51, 0xffff0000, v16
    v_mul_f32 v52, v44, v99
    v_mul_f32 v53, v45, v99
    v_mul_f32 v54, v46, v99
    v_mul_f32 v55, v47, v99
    v_mul_f32 v56, v48, v99
    v_mul_f32 v57, v49, v99
    v_mul_f32 v58, v50, v99
    v_mul_f32 v59, v51, v99
    v_fma_f32 v44, -v52, v98, v44
    v_fma_f32 v45, -v53, v98, v45
    v_fma_f32 v46, -v54, v98, v46
    v_fma_f32 v47, -v55, v98, v47
    v_fma_f32 v48, -v56, v98, v48
    v_fma_f32 v49, -v57, v98, v49
    v_fma_f32 v50, -v58, v98, v50
    v_fma_f32 v51, -v59, v98, v51
    v_fma_f32 v44, v44, v99, v52
    v_fma_f32 v45, v45, v99, v53
    v_fma_f32 v46, v46, v99, v54
    v_fma_f32 v47, v47, v99, v55
    v_fma_f32 v48, v48, v99, v56
    v_fma_f32 v49, v49, v99, v57
    v_fma_f32 v50, v50, v99, v58
    v_fma_f32 v51, v51, v99, v59
    v_cvt_pk_bf16_f32 v16, v44, v45
    v_lshlrev_b32 v44, 16, v16
    v_and_b32 v45, 0xffff0000, v16
    v_cvt_pk_bf16_f32 v16, v46, v47
    v_lshlrev_b32 v46, 16, v16
    v_and_b32 v47, 0xffff0000, v16
    v_cvt_pk_bf16_f32 v16, v48, v49
    v_lshlrev_b32 v48, 16, v16
    v_and_b32 v49, 0xffff0000, v16
    v_cvt_pk_bf16_f32 v16, v50, v51
    v_lshlrev_b32 v50, 16, v16
    v_and_b32 v51, 0xffff0000, v16
    v_lshlrev_b32 v52, 16, v192
    v_and_b32 v53, 0xffff0000, v192
    v_lshlrev_b32 v54, 16, v193
    v_and_b32 v55, 0xffff0000, v193
    v_lshlrev_b32 v56, 16, v194
    v_and_b32 v57, 0xffff0000, v194
    v_lshlrev_b32 v58, 16, v195
    v_and_b32 v59, 0xffff0000, v195
    v_pk_mul_f32 v[44:45], v[44:45], v[52:53]
    v_pk_mul_f32 v[46:47], v[46:47], v[54:55]
    v_pk_mul_f32 v[48:49], v[48:49], v[56:57]
    v_pk_mul_f32 v[50:51], v[50:51], v[58:59]
    v_cvt_pk_bf16_f32 v16, v44, v45
    v_lshlrev_b32 v44, 16, v16
    v_and_b32 v45, 0xffff0000, v16
    v_cvt_pk_bf16_f32 v16, v46, v47
    v_lshlrev_b32 v46, 16, v16
    v_and_b32 v47, 0xffff0000, v16
    v_cvt_pk_bf16_f32 v16, v48, v49
    v_lshlrev_b32 v48, 16, v16
    v_and_b32 v49, 0xffff0000, v16
    v_cvt_pk_bf16_f32 v16, v50, v51
    v_lshlrev_b32 v50, 16, v16
    v_and_b32 v51, 0xffff0000, v16
    v_lshlrev_b32 v52, 16, v184
    v_and_b32 v53, 0xffff0000, v184
    v_lshlrev_b32 v54, 16, v185
    v_and_b32 v55, 0xffff0000, v185
    v_lshlrev_b32 v56, 16, v186
    v_and_b32 v57, 0xffff0000, v186
    v_lshlrev_b32 v58, 16, v187
    v_and_b32 v59, 0xffff0000, v187
    v_pk_add_f32 v[44:45], v[44:45], v[52:53]
    v_pk_add_f32 v[46:47], v[46:47], v[54:55]
    v_pk_add_f32 v[48:49], v[48:49], v[56:57]
    v_pk_add_f32 v[50:51], v[50:51], v[58:59]
    v_cvt_pk_bf16_f32 v16, v44, v45
    v_lshlrev_b32 v44, 16, v16
    v_and_b32 v45, 0xffff0000, v16
    v_cvt_pk_bf16_f32 v16, v46, v47
    v_lshlrev_b32 v46, 16, v16
    v_and_b32 v47, 0xffff0000, v16
    v_cvt_pk_bf16_f32 v16, v48, v49
    v_lshlrev_b32 v48, 16, v16
    v_and_b32 v49, 0xffff0000, v16
    v_cvt_pk_bf16_f32 v16, v50, v51
    v_lshlrev_b32 v50, 16, v16
    v_and_b32 v51, 0xffff0000, v16
    v_lshlrev_b32 v52, 16, v200
    v_and_b32 v53, 0xffff0000, v200
    v_lshlrev_b32 v54, 16, v201
    v_and_b32 v55, 0xffff0000, v201
    v_lshlrev_b32 v56, 16, v202
    v_and_b32 v57, 0xffff0000, v202
    v_lshlrev_b32 v58, 16, v203
    v_and_b32 v59, 0xffff0000, v203
    v_pk_mul_f32 v[44:45], v[44:45], v[52:53]
    v_pk_mul_f32 v[46:47], v[46:47], v[54:55]
    v_pk_mul_f32 v[48:49], v[48:49], v[56:57]
    v_pk_mul_f32 v[50:51], v[50:51], v[58:59]
    v_cvt_pk_bf16_f32 v16, v44, v45
    v_lshlrev_b32 v44, 16, v16
    v_and_b32 v45, 0xffff0000, v16
    v_cvt_pk_bf16_f32 v16, v46, v47
    v_lshlrev_b32 v46, 16, v16
    v_and_b32 v47, 0xffff0000, v16
    v_cvt_pk_bf16_f32 v16, v48, v49
    v_lshlrev_b32 v48, 16, v16
    v_and_b32 v49, 0xffff0000, v16
    v_cvt_pk_bf16_f32 v16, v50, v51
    v_lshlrev_b32 v50, 16, v16
    v_and_b32 v51, 0xffff0000, v16
    v_pk_add_f32 v[44:45], v[44:45], v[28:29]
    v_pk_add_f32 v[46:47], v[46:47], v[30:31]
    v_pk_add_f32 v[48:49], v[48:49], v[32:33]
    v_pk_add_f32 v[50:51], v[50:51], v[34:35]
    v_cvt_pk_bf16_f32 v28, v44, v45
    v_cvt_pk_bf16_f32 v29, v46, v47
    v_cvt_pk_bf16_f32 v30, v48, v49
    v_cvt_pk_bf16_f32 v31, v50, v51
    v_sub_f32 v44, v36, v96
    v_sub_f32 v45, v37, v96
    v_sub_f32 v46, v38, v96
    v_sub_f32 v47, v39, v96
    v_sub_f32 v48, v40, v96
    v_sub_f32 v49, v41, v96
    v_sub_f32 v50, v42, v96
    v_sub_f32 v51, v43, v96
    v_cvt_pk_bf16_f32 v16, v44, v45
    v_lshlrev_b32 v44, 16, v16
    v_and_b32 v45, 0xffff0000, v16
    v_cvt_pk_bf16_f32 v16, v46, v47
    v_lshlrev_b32 v46, 16, v16
    v_and_b32 v47, 0xffff0000, v16
    v_cvt_pk_bf16_f32 v16, v48, v49
    v_lshlrev_b32 v48, 16, v16
    v_and_b32 v49, 0xffff0000, v16
    v_cvt_pk_bf16_f32 v16, v50, v51
    v_lshlrev_b32 v50, 16, v16
    v_and_b32 v51, 0xffff0000, v16
    v_mul_f32 v52, v44, v99
    v_mul_f32 v53, v45, v99
    v_mul_f32 v54, v46, v99
    v_mul_f32 v55, v47, v99
    v_mul_f32 v56, v48, v99
    v_mul_f32 v57, v49, v99
    v_mul_f32 v58, v50, v99
    v_mul_f32 v59, v51, v99
    v_fma_f32 v44, -v52, v98, v44
    v_fma_f32 v45, -v53, v98, v45
    v_fma_f32 v46, -v54, v98, v46
    v_fma_f32 v47, -v55, v98, v47
    v_fma_f32 v48, -v56, v98, v48
    v_fma_f32 v49, -v57, v98, v49
    v_fma_f32 v50, -v58, v98, v50
    v_fma_f32 v51, -v59, v98, v51
    v_fma_f32 v44, v44, v99, v52
    v_fma_f32 v45, v45, v99, v53
    v_fma_f32 v46, v46, v99, v54
    v_fma_f32 v47, v47, v99, v55
    v_fma_f32 v48, v48, v99, v56
    v_fma_f32 v49, v49, v99, v57
    v_fma_f32 v50, v50, v99, v58
    v_fma_f32 v51, v51, v99, v59
    v_cvt_pk_bf16_f32 v16, v44, v45
    v_lshlrev_b32 v44, 16, v16
    v_and_b32 v45, 0xffff0000, v16
    v_cvt_pk_bf16_f32 v16, v46, v47
    v_lshlrev_b32 v46, 16, v16
    v_and_b32 v47, 0xffff0000, v16
    v_cvt_pk_bf16_f32 v16, v48, v49
    v_lshlrev_b32 v48, 16, v16
    v_and_b32 v49, 0xffff0000, v16
    v_cvt_pk_bf16_f32 v16, v50, v51
    v_lshlrev_b32 v50, 16, v16
    v_and_b32 v51, 0xffff0000, v16
    v_lshlrev_b32 v52, 16, v196
    v_and_b32 v53, 0xffff0000, v196
    v_lshlrev_b32 v54, 16, v197
    v_and_b32 v55, 0xffff0000, v197
    v_lshlrev_b32 v56, 16, v198
    v_and_b32 v57, 0xffff0000, v198
    v_lshlrev_b32 v58, 16, v199
    v_and_b32 v59, 0xffff0000, v199
    v_pk_mul_f32 v[44:45], v[44:45], v[52:53]
    v_pk_mul_f32 v[46:47], v[46:47], v[54:55]
    v_pk_mul_f32 v[48:49], v[48:49], v[56:57]
    v_pk_mul_f32 v[50:51], v[50:51], v[58:59]
    v_cvt_pk_bf16_f32 v16, v44, v45
    v_lshlrev_b32 v44, 16, v16
    v_and_b32 v45, 0xffff0000, v16
    v_cvt_pk_bf16_f32 v16, v46, v47
    v_lshlrev_b32 v46, 16, v16
    v_and_b32 v47, 0xffff0000, v16
    v_cvt_pk_bf16_f32 v16, v48, v49
    v_lshlrev_b32 v48, 16, v16
    v_and_b32 v49, 0xffff0000, v16
    v_cvt_pk_bf16_f32 v16, v50, v51
    v_lshlrev_b32 v50, 16, v16
    v_and_b32 v51, 0xffff0000, v16
    v_lshlrev_b32 v52, 16, v188
    v_and_b32 v53, 0xffff0000, v188
    v_lshlrev_b32 v54, 16, v189
    v_and_b32 v55, 0xffff0000, v189
    v_lshlrev_b32 v56, 16, v190
    v_and_b32 v57, 0xffff0000, v190
    v_lshlrev_b32 v58, 16, v191
    v_and_b32 v59, 0xffff0000, v191
    v_pk_add_f32 v[44:45], v[44:45], v[52:53]
    v_pk_add_f32 v[46:47], v[46:47], v[54:55]
    v_pk_add_f32 v[48:49], v[48:49], v[56:57]
    v_pk_add_f32 v[50:51], v[50:51], v[58:59]
    v_cvt_pk_bf16_f32 v16, v44, v45
    v_lshlrev_b32 v44, 16, v16
    v_and_b32 v45, 0xffff0000, v16
    v_cvt_pk_bf16_f32 v16, v46, v47
    v_lshlrev_b32 v46, 16, v16
    v_and_b32 v47, 0xffff0000, v16
    v_cvt_pk_bf16_f32 v16, v48, v49
    v_lshlrev_b32 v48, 16, v16
    v_and_b32 v49, 0xffff0000, v16
    v_cvt_pk_bf16_f32 v16, v50, v51
    v_lshlrev_b32 v50, 16, v16
    v_and_b32 v51, 0xffff0000, v16
    v_lshlrev_b32 v52, 16, v204
    v_and_b32 v53, 0xffff0000, v204
    v_lshlrev_b32 v54, 16, v205
    v_and_b32 v55, 0xffff0000, v205
    v_lshlrev_b32 v56, 16, v206
    v_and_b32 v57, 0xffff0000, v206
    v_lshlrev_b32 v58, 16, v207
    v_and_b32 v59, 0xffff0000, v207
    v_pk_mul_f32 v[44:45], v[44:45], v[52:53]
    v_pk_mul_f32 v[46:47], v[46:47], v[54:55]
    v_pk_mul_f32 v[48:49], v[48:49], v[56:57]
    v_pk_mul_f32 v[50:51], v[50:51], v[58:59]
    v_cvt_pk_bf16_f32 v16, v44, v45
    v_lshlrev_b32 v44, 16, v16
    v_and_b32 v45, 0xffff0000, v16
    v_cvt_pk_bf16_f32 v16, v46, v47
    v_lshlrev_b32 v46, 16, v16
    v_and_b32 v47, 0xffff0000, v16
    v_cvt_pk_bf16_f32 v16, v48, v49
    v_lshlrev_b32 v48, 16, v16
    v_and_b32 v49, 0xffff0000, v16
    v_cvt_pk_bf16_f32 v16, v50, v51
    v_lshlrev_b32 v50, 16, v16
    v_and_b32 v51, 0xffff0000, v16
    v_pk_add_f32 v[44:45], v[44:45], v[36:37]
    v_pk_add_f32 v[46:47], v[46:47], v[38:39]
    v_pk_add_f32 v[48:49], v[48:49], v[40:41]
    v_pk_add_f32 v[50:51], v[50:51], v[42:43]
    v_cvt_pk_bf16_f32 v36, v44, v45
    v_cvt_pk_bf16_f32 v37, v46, v47
    v_cvt_pk_bf16_f32 v38, v48, v49
    v_cvt_pk_bf16_f32 v39, v50, v51
    s_barrier
    v_and_b32 v16, 3, v1
    v_lshlrev_b32 v16, 4, v16
    v_add_u32 v16, 65792, v16
    ds_read_b32 v76, v16
    s_waitcnt lgkmcnt(0)
    v_mov_b32 v77, v76
    s_nop 1
    v_max_u32_dpp v77, v77, v77 row_ror:1 row_mask:0xf bank_mask:0xf
    s_nop 1
    v_max_u32_dpp v77, v77, v77 row_ror:2 row_mask:0xf bank_mask:0xf
    v_cmp_eq_u32 vcc, v76, v77
    s_ff1_i32_b64 s16, vcc
    s_lshl_b32 s16, s16, 4
    s_add_u32 s16, s16, 65792
    v_mov_b32 v16, s16
    ds_read_b128 v[24:27], v16
    s_waitcnt lgkmcnt(0)
    v_and_b32 v76, 0x7ff, v24
    v_sub_u32 v76, 2047, v76
    s_nop 0
    v_readfirstlane_b32 s12, v76
    v_rcp_f32 v103, v26
    s_lshr_b32 s18, s12, 4
    s_lshl_b32 s18, s18, 15
    s_and_b32 s19, s12, 15
    s_lshl_b32 s19, s19, 6
    s_add_u32 s18, s18, s19
    s_add_u32 s18, s18, 0x2000000
    s_add_u32 s19, s18, 0x400000
    v_lshrrev_b32 v18, 4, v0
    v_lshlrev_b32 v18, 10, v18
    v_and_b32 v19, 15, v0
    v_lshl_add_u32 v18, v19, 2, v18
    s_lshl_b32 s13, s12, 11
    buffer_load_dword v100, v18, s[8:11], s18 offen sc1
    buffer_load_dword v101, v18, s[8:11], s19 offen sc1
    buffer_load_dword v102, v21, s[76:79], s13 offen
    s_lshl_b32 s16, s14, 11
    s_cmp_lg_u32 s12, s14
    s_cselect_b32 s16, s16, 0x7ffffff0
    buffer_store_dwordx4 v[28:31], v2, s[68:71], s16 offen offset:0 sc1
    buffer_store_dwordx4 v[36:39], v2, s[68:71], s16 offen offset:1024 sc1
    s_lshl_b32 s16, s3, 13
    v_add_u32 v20, s16, v2
    s_waitcnt vmcnt(4)
    v_lshlrev_b32 v76, 16, v100
    v_and_b32 v77, 0xffff0000, v100
    s_waitcnt vmcnt(3)
    v_lshlrev_b32 v78, 16, v101
    v_and_b32 v79, 0xffff0000, v101
    v_pk_add_f32 v[76:77], v[76:77], v[78:79]
    s_waitcnt vmcnt(2)
    v_lshlrev_b32 v78, 16, v102
    v_and_b32 v79, 0xffff0000, v102
    v_pk_add_f32 v[92:93], v[78:79], v[76:77]
    v_cvt_pk_bf16_f32 v76, v92, v93
    v_lshlrev_b32 v92, 16, v76
    v_and_b32 v93, 0xffff0000, v76
    v_cvt_pk_bf16_f32 v100, v92, v93
    v_and_b32 v105, 0xffff0000, v104
    v_lshlrev_b32 v104, 16, v104
    v_and_b32 v107, 0xffff0000, v106
    v_lshlrev_b32 v106, 16, v106
    v_sub_f32 v92, v92, v25
    v_sub_f32 v93, v93, v25
    v_cvt_pk_bf16_f32 v76, v92, v93
    v_lshlrev_b32 v92, 16, v76
    v_and_b32 v93, 0xffff0000, v76
    v_mul_f32 v77, v92, v103
    v_fma_f32 v92, -v77, v26, v92
    v_fma_f32 v92, v92, v103, v77
    v_mul_f32 v77, v93, v103
    v_fma_f32 v93, -v77, v26, v93
    v_fma_f32 v93, v93, v103, v77
    v_cvt_pk_bf16_f32 v76, v92, v93
    v_lshlrev_b32 v92, 16, v76
    v_and_b32 v93, 0xffff0000, v76
    v_mul_f32 v92, v92, v104
    v_mul_f32 v93, v93, v105
    v_cvt_pk_bf16_f32 v76, v92, v93
    v_lshlrev_b32 v92, 16, v76
    v_and_b32 v93, 0xffff0000, v76
    v_add_f32 v92, v92, v106
    v_add_f32 v93, v93, v107
    v_cvt_pk_bf16_f32 v101, v92, v93
    v_add_u32 v16, 66560, v21
    ds_write_b32 v16, v101
    ds_write_b32 v16, v100 offset:2048
    s_waitcnt lgkmcnt(0)
    s_barrier
    ds_read_b128 v[60:63], v20 offset:0
    ds_read_b128 v[64:67], v20 offset:1024
    ds_read_b128 v[68:71], v20 offset:2048
    ds_read_b128 v[72:75], v20 offset:3072
    ds_read_b128 v[108:111], v20 offset:4096
    ds_read_b128 v[112:115], v20 offset:5120
    ds_read_b128 v[116:119], v20 offset:6144
    ds_read_b128 v[120:123], v20 offset:7168
    s_and_b32 s16, s3, 3
    s_lshl_b32 s16, s16, 7
    s_and_b32 s17, s29, 3
    s_lshl_b32 s17, s17, 9
    s_add_u32 s16, s16, s17
    s_add_u32 s16, s16, 66560
    v_lshrrev_b32 v16, 3, v1
    v_lshlrev_b32 v16, 4, v16
    v_add_u32 v16, s16, v16
    ds_read_b128 v[104:107], v16
    s_waitcnt lgkmcnt(0)
    v_lshlrev_b32 v76, 16, v104
    v_and_b32 v77, 0xffff, v104
    v_dot2_f32_bf16 v85, v60, v76, 0
    v_dot2_f32_bf16 v84, v60, v77, 0
    v_dot2_f32_bf16 v87, v61, v76, 0
    v_dot2_f32_bf16 v86, v61, v77, 0
    v_dot2_f32_bf16 v89, v62, v76, 0
    v_dot2_f32_bf16 v88, v62, v77, 0
    v_dot2_f32_bf16 v91, v63, v76, 0
    v_dot2_f32_bf16 v90, v63, v77, 0
    v_and_b32 v78, 0xffff0000, v104
    v_lshrrev_b32 v79, 16, v104
    v_dot2c_f32_bf16 v85, v64, v78
    v_dot2c_f32_bf16 v84, v64, v79
    v_dot2c_f32_bf16 v87, v65, v78
    v_dot2c_f32_bf16 v86, v65, v79
    v_dot2c_f32_bf16 v89, v66, v78
    v_dot2c_f32_bf16 v88, v66, v79
    v_dot2c_f32_bf16 v91, v67, v78
    v_dot2c_f32_bf16 v90, v67, v79
    v_lshlrev_b32 v80, 16, v105
    v_and_b32 v81, 0xffff, v105
    v_dot2c_f32_bf16 v85, v68, v80
    v_dot2c_f32_bf16 v84, v68, v81
    v_dot2c_f32_bf16 v87, v69, v80
    v_dot2c_f32_bf16 v86, v69, v81
    v_dot2c_f32_bf16 v89, v70, v80
    v_dot2c_f32_bf16 v88, v70, v81
    v_dot2c_f32_bf16 v91, v71, v80
    v_dot2c_f32_bf16 v90, v71, v81
    v_and_b32 v82, 0xffff0000, v105
    v_lshrrev_b32 v83, 16, v105
    v_dot2c_f32_bf16 v85, v72, v82
    v_dot2c_f32_bf16 v84, v72, v83
    v_dot2c_f32_bf16 v87, v73, v82
    v_dot2c_f32_bf16 v86, v73, v83
    v_dot2c_f32_bf16 v89, v74, v82
    v_dot2c_f32_bf16 v88, v74, v83
    v_dot2c_f32_bf16 v91, v75, v82
    v_dot2c_f32_bf16 v90, v75, v83
    v_lshlrev_b32 v76, 16, v106
    v_and_b32 v77, 0xffff, v106
    v_dot2c_f32_bf16 v85, v108, v76
    v_dot2c_f32_bf16 v84, v108, v77
    v_dot2c_f32_bf16 v87, v109, v76
    v_dot2c_f32_bf16 v86, v109, v77
    v_dot2c_f32_bf16 v89, v110, v76
    v_dot2c_f32_bf16 v88, v110, v77
    v_dot2c_f32_bf16 v91, v111, v76
    v_dot2c_f32_bf16 v90, v111, v77
    v_and_b32 v78, 0xffff0000, v106
    v_lshrrev_b32 v79, 16, v106
    v_dot2c_f32_bf16 v85, v112, v78
    v_dot2c_f32_bf16 v84, v112, v79
    v_dot2c_f32_bf16 v87, v113, v78
    v_dot2c_f32_bf16 v86, v113, v79
    v_dot2c_f32_bf16 v89, v114, v78
    v_dot2c_f32_bf16 v88, v114, v79
    v_dot2c_f32_bf16 v91, v115, v78
    v_dot2c_f32_bf16 v90, v115, v79
    v_lshlrev_b32 v80, 16, v107
    v_and_b32 v81, 0xffff, v107
    v_dot2c_f32_bf16 v85, v116, v80
    v_dot2c_f32_bf16 v84, v116, v81
    v_dot2c_f32_bf16 v87, v117, v80
    v_dot2c_f32_bf16 v86, v117, v81
    v_dot2c_f32_bf16 v89, v118, v80
    v_dot2c_f32_bf16 v88, v118, v81
    v_dot2c_f32_bf16 v91, v119, v80
    v_dot2c_f32_bf16 v90, v119, v81
    v_and_b32 v82, 0xffff0000, v107
    v_lshrrev_b32 v83, 16, v107
    v_dot2c_f32_bf16 v85, v120, v82
    v_dot2c_f32_bf16 v84, v120, v83
    v_dot2c_f32_bf16 v87, v121, v82
    v_dot2c_f32_bf16 v86, v121, v83
    v_dot2c_f32_bf16 v89, v122, v82
    v_dot2c_f32_bf16 v88, v122, v83
    v_dot2c_f32_bf16 v91, v123, v82
    v_dot2c_f32_bf16 v90, v123, v83
    s_nop 0
    v_permlane32_swap_b32 v84, v88
    v_permlane32_swap_b32 v85, v89
    v_permlane32_swap_b32 v86, v90
    v_permlane32_swap_b32 v87, v91
    v_add_f32 v84, v84, v88
    v_add_f32 v85, v85, v89
    v_add_f32 v86, v86, v90
    v_add_f32 v87, v87, v91
    s_nop 0
    v_permlane16_swap_b32 v84, v86
    v_permlane16_swap_b32 v85, v87
    v_add_f32 v84, v84, v86
    v_add_f32 v85, v85, v87
    s_nop 0
    v_add_f32_dpp v84, v84, v84 row_ror:8 row_mask:0xf bank_mask:0xf
    v_add_f32_dpp v85, v85, v85 row_ror:8 row_mask:0xf bank_mask:0xf
    v_and_b32 v16, 7, v1
    v_lshlrev_b32 v16, 5, v16
    v_lshrrev_b32 v17, 4, v1
    v_lshl_add_u32 v16, v17, 3, v16
    s_lshl_b32 s16, s3, 8
    s_add_u32 s16, s16, 70656
    v_add_u32 v16, s16, v16
    ds_write_b64 v16, v[84:85]
    s_lshr_b32 s16, s3, 2
    s_lshl_b32 s17, s16, 10
    s_add_u32 s17, s17, 70656
    v_lshlrev_b32 v17, 2, v1
    v_add_u32 v16, s17, v17
    s_and_b32 s17, s29, 3
    s_lshl_b32 s17, s17, 1
    s_add_u32 s17, s17, s16
    s_mul_i32 s17, s17, 14336
    s_lshr_b32 s16, s29, 2
    s_lshl_b32 s16, s16, 8
    s_add_u32 s17, s17, s16
    s_add_u32 s17, s17, 0x6e1000
    s_and_b32 s16, s3, 3
    s_cmp_eq_u32 s16, 0
    s_cselect_b32 s17, s17, 0x7ffffff0
    s_cmp_lt_u32 s2, 224
    s_cselect_b32 s17, s17, 0x7ffffff0
    s_waitcnt lgkmcnt(0)
    s_barrier
    ds_read_b32 v84, v16 offset:0
    ds_read_b32 v85, v16 offset:256
    ds_read_b32 v86, v16 offset:512
    ds_read_b32 v87, v16 offset:768
    s_waitcnt lgkmcnt(2)
    v_add_f32 v84, v84, v85
    s_waitcnt lgkmcnt(0)
    v_add_f32 v86, v86, v87
    v_add_f32 v84, v84, v86
    v_or_b32 v84, 1, v84
    buffer_store_dword v84, v17, s[8:11], s17 offen sc1
    v_lshrrev_b32 v16, 4, v1
    v_mul_u32_u24 v16, 28672, v16
    v_and_b32 v17, 15, v1
    v_lshl_add_u32 v16, v17, 2, v16
    s_lshl_b32 s16, s29, 6
    s_add_u32 s16, s16, 0x6e1000
    s_add_u32 s17, s16, 14336
    s_mov_b32 s27, 0
adaLN_cond__sliding_block_cached__moe_arch_mod__prompt_kernel_gu23p:
    buffer_load_dword v84, v16, s[8:11], s16 offen sc1
    buffer_load_dword v85, v16, s[8:11], s17 offen sc1
    s_waitcnt vmcnt(0)
    v_min_u32 v86, v84, v85
    v_cmp_eq_u32 vcc, 0, v86
    s_cmp_lt_u32 s2, 224
    s_cselect_b64 s[62:63], -1, 0
    s_and_b64 vcc, vcc, s[62:63]
    s_add_u32 s27, s27, 1
    s_cmp_ge_u32 s27, 65536
    s_cbranch_scc1 adaLN_cond__sliding_block_cached__moe_arch_mod__prompt_kernel_gu23g
    s_cbranch_vccnz adaLN_cond__sliding_block_cached__moe_arch_mod__prompt_kernel_gu23p
adaLN_cond__sliding_block_cached__moe_arch_mod__prompt_kernel_gu23g:
    v_mov_b32 v86, v84
    s_nop 1
    v_permlane16_swap_b32 v84, v86
    v_add_f32 v84, v84, v86
    v_mov_b32 v87, v85
    s_nop 1
    v_permlane16_swap_b32 v85, v87
    v_add_f32 v85, v85, v87
    v_mov_b32 v86, v84
    s_nop 1
    v_permlane32_swap_b32 v84, v86
    v_add_f32 v84, v84, v86
    v_mov_b32 v87, v85
    s_nop 1
    v_permlane32_swap_b32 v85, v87
    v_add_f32 v85, v85, v87
    v_cvt_pk_bf16_f32 v86, v84, v85
    v_lshlrev_b32 v84, 16, v86
    v_and_b32 v85, 0xffff0000, v86
    v_mul_f32 v86, 0xbfb8aa3b, v84
    v_exp_f32 v86, v86
    s_nop 0
    v_add_f32 v86, 1.0, v86
    v_rcp_f32 v86, v86
    s_nop 0
    v_mul_f32 v84, v84, v86
    v_cvt_pk_bf16_f32 v84, v84, v84
    v_lshlrev_b32 v84, 16, v84
    v_mul_f32 v84, v84, v85
    v_cvt_pk_bf16_f32 v84, v84, v84
    v_lshlrev_b32 v84, 16, v84
    s_sub_u32 s16, s3, 4
    s_lshl_b32 s16, s16, 2
    s_add_u32 s17, s16, 0
    v_readlane_b32 s20, v84, s17
    s_lshr_b32 s4, s20, 16
    s_add_u32 s17, s16, 1
    v_readlane_b32 s21, v84, s17
    s_lshr_b32 s5, s21, 16
    s_add_u32 s17, s16, 2
    v_readlane_b32 s22, v84, s17
    s_lshr_b32 s6, s22, 16
    s_add_u32 s17, s16, 3
    v_readlane_b32 s23, v84, s17
    s_lshr_b32 s7, s23, 16
    v_dot2_f32_bf16 v45, v152, s20, 0
    v_dot2_f32_bf16 v44, v152, s4, 0
    v_dot2_f32_bf16 v47, v153, s20, 0
    v_dot2_f32_bf16 v46, v153, s4, 0
    v_dot2_f32_bf16 v49, v154, s20, 0
    v_dot2_f32_bf16 v48, v154, s4, 0
    v_dot2_f32_bf16 v51, v155, s20, 0
    v_dot2_f32_bf16 v50, v155, s4, 0
    v_dot2_f32_bf16 v53, v156, s20, 0
    v_dot2_f32_bf16 v52, v156, s4, 0
    v_dot2_f32_bf16 v55, v157, s20, 0
    v_dot2_f32_bf16 v54, v157, s4, 0
    v_dot2_f32_bf16 v57, v158, s20, 0
    v_dot2_f32_bf16 v56, v158, s4, 0
    v_dot2_f32_bf16 v59, v159, s20, 0
    v_dot2_f32_bf16 v58, v159, s4, 0
    v_dot2c_f32_bf16 v45, s21, v160
    v_dot2c_f32_bf16 v44, s5, v160
    v_dot2c_f32_bf16 v47, s21, v161
    v_dot2c_f32_bf16 v46, s5, v161
    v_dot2c_f32_bf16 v49, s21, v162
    v_dot2c_f32_bf16 v48, s5, v162
    v_dot2c_f32_bf16 v51, s21, v163
    v_dot2c_f32_bf16 v50, s5, v163
    v_dot2c_f32_bf16 v53, s21, v164
    v_dot2c_f32_bf16 v52, s5, v164
    v_dot2c_f32_bf16 v55, s21, v165
    v_dot2c_f32_bf16 v54, s5, v165
    v_dot2c_f32_bf16 v57, s21, v166
    v_dot2c_f32_bf16 v56, s5, v166
    v_dot2c_f32_bf16 v59, s21, v167
    v_dot2c_f32_bf16 v58, s5, v167
    v_dot2c_f32_bf16 v45, s22, v168
    v_dot2c_f32_bf16 v44, s6, v168
    v_dot2c_f32_bf16 v47, s22, v169
    v_dot2c_f32_bf16 v46, s6, v169
    v_dot2c_f32_bf16 v49, s22, v170
    v_dot2c_f32_bf16 v48, s6, v170
    v_dot2c_f32_bf16 v51, s22, v171
    v_dot2c_f32_bf16 v50, s6, v171
    v_dot2c_f32_bf16 v53, s22, v172
    v_dot2c_f32_bf16 v52, s6, v172
    v_dot2c_f32_bf16 v55, s22, v173
    v_dot2c_f32_bf16 v54, s6, v173
    v_dot2c_f32_bf16 v57, s22, v174
    v_dot2c_f32_bf16 v56, s6, v174
    v_dot2c_f32_bf16 v59, s22, v175
    v_dot2c_f32_bf16 v58, s6, v175
    v_dot2c_f32_bf16 v45, s23, v176
    v_dot2c_f32_bf16 v44, s7, v176
    v_dot2c_f32_bf16 v47, s23, v177
    v_dot2c_f32_bf16 v46, s7, v177
    v_dot2c_f32_bf16 v49, s23, v178
    v_dot2c_f32_bf16 v48, s7, v178
    v_dot2c_f32_bf16 v51, s23, v179
    v_dot2c_f32_bf16 v50, s7, v179
    v_dot2c_f32_bf16 v53, s23, v180
    v_dot2c_f32_bf16 v52, s7, v180
    v_dot2c_f32_bf16 v55, s23, v181
    v_dot2c_f32_bf16 v54, s7, v181
    v_dot2c_f32_bf16 v57, s23, v182
    v_dot2c_f32_bf16 v56, s7, v182
    v_dot2c_f32_bf16 v59, s23, v183
    v_dot2c_f32_bf16 v58, s7, v183
    s_sub_u32 s16, s3, 4
    s_lshl_b32 s16, s16, 12
    s_add_u32 s16, s16, 73728
    v_lshlrev_b32 v16, 5, v1
    v_add_u32 v16, s16, v16
    ds_write_b128 v16, v[44:47] offset:0
    ds_write_b128 v16, v[48:51] offset:16
    ds_write_b128 v16, v[52:55] offset:2048
    ds_write_b128 v16, v[56:59] offset:2064
    s_waitcnt lgkmcnt(0)
    s_barrier
    v_lshlrev_b32 v16, 3, v0
    v_add_u32 v17, 73728, v16
    ds_read_b64 v[84:85], v17 offset:0
    ds_read_b64 v[86:87], v17 offset:4096
    ds_read_b64 v[88:89], v17 offset:8192
    ds_read_b64 v[90:91], v17 offset:12288
    s_waitcnt lgkmcnt(2)
    v_pk_add_f32 v[84:85], v[84:85], v[86:87]
    s_waitcnt lgkmcnt(0)
    v_pk_add_f32 v[88:89], v[88:89], v[90:91]
    v_pk_add_f32 v[84:85], v[84:85], v[88:89]
    v_or_b32 v84, 1, v84
    v_or_b32 v85, 1, v85
    s_lshl_b32 s16, s29, 12
    s_add_u32 s16, s16, 0x600000
    s_cmp_lt_u32 s2, 224
    s_cselect_b32 s16, s16, 0x7ffffff0
    buffer_store_dwordx2 v[84:85], v16, s[8:11], s16 offen sc1
    s_cmp_lt_u32 s2, 224
    s_cbranch_scc1 adaLN_cond__sliding_block_cached__moe_arch_mod__prompt_kernel_end
    s_sub_u32 s16, s2, 224
    s_lshl_b32 s17, s16, 7
    s_add_u32 s17, s17, 0x600000
    v_lshrrev_b32 v16, 3, v0
    v_lshlrev_b32 v16, 12, v16
    v_and_b32 v17, 7, v0
    v_lshl_add_u32 v16, v17, 4, v16
    v_cmp_gt_u32 vcc, 256, v0
    v_bfrev_b32 v17, -2
    s_nop 0
    v_cndmask_b32 v17, v17, v16, vcc
    v_mov_b32 v19, 0
    v_cndmask_b32 v18, 1, v19, vcc
    s_lshl_b32 s18, s16, 6
    v_and_b32 v19, 31, v1
    v_lshlrev_b32 v19, 1, v19
    v_add_u32 v19, s18, v19
    s_mov_b32 s19, 0x541800
    buffer_load_ushort v95, v19, s[8:11], s19 offen sc1
    v_add_u32 v20, 66560, v19
    ds_read_u16 v96, v20
    ds_read_u16 v97, v20 offset:2048
    v_mov_b32 v94, v27
    v_cvt_pk_bf16_f32 v94, v94, v94
    v_lshlrev_b32 v94, 16, v94
    v_mul_f32 v94, 0xbfb8aa3b, v94
    v_exp_f32 v94, v94
    s_nop 0
    v_add_f32 v94, 1.0, v94
    v_rcp_f32 v94, v94
    s_nop 0
    v_cvt_pk_bf16_f32 v94, v94, v94
    v_lshlrev_b32 v94, 16, v94
    s_waitcnt vmcnt(0)
    v_lshlrev_b32 v95, 16, v95
    s_waitcnt lgkmcnt(1)
    v_lshlrev_b32 v96, 16, v96
    s_waitcnt lgkmcnt(0)
    v_lshlrev_b32 v97, 16, v97
    s_mov_b32 s27, 0
adaLN_cond__sliding_block_cached__moe_arch_mod__prompt_kernel_y24p:
    s_add_u32 s19, s17, 0x0
    buffer_load_dwordx4 v[44:47], v16, s[8:11], s19 offen sc1
    s_add_u32 s19, s17, 0x40000
    buffer_load_dwordx4 v[48:51], v16, s[8:11], s19 offen sc1
    s_add_u32 s19, s17, 0x80000
    buffer_load_dwordx4 v[52:55], v16, s[8:11], s19 offen sc1
    s_add_u32 s19, s17, 0xc0000
    buffer_load_dwordx4 v[56:59], v17, s[8:11], s19 offen sc1
    s_waitcnt vmcnt(0)
    v_min3_u32 v98, v56, v57, v58
    v_min_u32 v98, v98, v59
    v_or_b32 v98, v98, v18
    v_min3_u32 v98, v98, v44, v45
    v_min3_u32 v98, v98, v46, v47
    v_min3_u32 v98, v98, v48, v49
    v_min3_u32 v98, v98, v50, v51
    v_min3_u32 v98, v98, v52, v53
    v_min3_u32 v98, v98, v54, v55
    v_cmp_eq_u32 vcc, 0, v98
    s_add_u32 s27, s27, 1
    s_cmp_ge_u32 s27, 65536
    s_cbranch_scc1 adaLN_cond__sliding_block_cached__moe_arch_mod__prompt_kernel_y24g
    s_cbranch_vccnz adaLN_cond__sliding_block_cached__moe_arch_mod__prompt_kernel_y24p
adaLN_cond__sliding_block_cached__moe_arch_mod__prompt_kernel_y24g:
    v_pk_add_f32 v[44:45], v[44:45], v[52:53]
    v_pk_add_f32 v[46:47], v[46:47], v[54:55]
    v_pk_add_f32 v[48:49], v[48:49], v[56:57]
    v_pk_add_f32 v[50:51], v[50:51], v[58:59]
    v_pk_add_f32 v[44:45], v[44:45], v[48:49]
    v_pk_add_f32 v[46:47], v[46:47], v[50:51]
    s_nop 0
    v_add_f32_dpp v44, v44, v44 row_ror:8 row_mask:0xf bank_mask:0xf
    v_add_f32_dpp v45, v45, v45 row_ror:8 row_mask:0xf bank_mask:0xf
    v_add_f32_dpp v46, v46, v46 row_ror:8 row_mask:0xf bank_mask:0xf
    v_add_f32_dpp v47, v47, v47 row_ror:8 row_mask:0xf bank_mask:0xf
    s_nop 0
    v_permlane32_swap_b32 v44, v46
    v_permlane32_swap_b32 v45, v47
    v_add_f32 v44, v44, v46
    v_add_f32 v45, v45, v47
    s_nop 1
    v_permlane16_swap_b32 v44, v45
    v_add_f32 v44, v44, v45
    v_and_b32 v16, 7, v1
    v_lshlrev_b32 v16, 4, v16
    v_lshrrev_b32 v17, 4, v1
    v_lshl_add_u32 v16, v17, 2, v16
    s_lshl_b32 s19, s3, 7
    s_add_u32 s19, s19, 91136
    v_add_u32 v16, s19, v16
    ds_write_b32 v16, v44
    v_and_b32 v16, 31, v1
    v_lshlrev_b32 v16, 2, v16
    v_add_u32 v16, 91136, v16
    s_waitcnt lgkmcnt(0)
    s_barrier
    s_cmp_lg_u32 s3, 0
    s_cbranch_scc1 adaLN_cond__sliding_block_cached__moe_arch_mod__prompt_kernel_end
    ds_read_b32 v44, v16 offset:0
    ds_read_b32 v45, v16 offset:128
    ds_read_b32 v46, v16 offset:256
    ds_read_b32 v47, v16 offset:384
    ds_read_b32 v48, v16 offset:512
    ds_read_b32 v49, v16 offset:640
    ds_read_b32 v50, v16 offset:768
    ds_read_b32 v51, v16 offset:896
    s_waitcnt lgkmcnt(3)
    v_add_f32 v44, v44, v48
    s_waitcnt lgkmcnt(2)
    v_add_f32 v45, v45, v49
    s_waitcnt lgkmcnt(1)
    v_add_f32 v46, v46, v50
    s_waitcnt lgkmcnt(0)
    v_add_f32 v47, v47, v51
    v_add_f32 v44, v44, v46
    v_add_f32 v45, v45, v47
    v_add_f32 v44, v44, v45
    v_cvt_pk_bf16_f32 v44, v44, v44
    v_lshlrev_b32 v44, 16, v44
    v_mul_f32 v44, v44, v94
    v_cvt_pk_bf16_f32 v44, v44, v44
    v_lshlrev_b32 v44, 16, v44
    v_add_f32 v44, v44, v96
    v_cvt_pk_bf16_f32 v44, v44, v44
    v_lshlrev_b32 v44, 16, v44
    v_mul_f32 v44, v44, v95
    v_cvt_pk_bf16_f32 v44, v44, v44
    v_lshlrev_b32 v44, 16, v44
    v_add_f32 v44, v44, v97
    v_cvt_pk_bf16_f32 v44, v44, v44
    s_mov_b64 exec, 0xffffffff
    buffer_store_short v44, v19, s[68:71], s13 offen sc1
adaLN_cond__sliding_block_cached__moe_arch_mod__prompt_kernel_end:
    s_endpgm
adaLN_cond__sliding_block_cached__moe_arch_mod__prompt_kernel_n1r:
    s_mov_b32 s27, 0
adaLN_cond__sliding_block_cached__moe_arch_mod__prompt_kernel_n1p:
    buffer_load_dword v134, v132, s[64:67], 0 offen sc1
    s_waitcnt vmcnt(0)
    v_cmp_eq_u32 vcc, 0, v134
    s_cmp_eq_u32 s3, 0
    s_cselect_b64 s[62:63], -1, 0
    s_and_b64 vcc, vcc, s[62:63]
    s_add_u32 s27, s27, 1
    s_cmp_ge_u32 s27, 65536
    s_cbranch_scc1 adaLN_cond__sliding_block_cached__moe_arch_mod__prompt_kernel_n1g
    s_cbranch_vccnz adaLN_cond__sliding_block_cached__moe_arch_mod__prompt_kernel_n1p
adaLN_cond__sliding_block_cached__moe_arch_mod__prompt_kernel_n1g:
    s_waitcnt vmcnt(0) lgkmcnt(0)
    s_nop 15
    s_nop 3
    s_branch adaLN_cond__sliding_block_cached__moe_arch_mod__prompt_kernel_n1b
adaLN_cond__sliding_block_cached__moe_arch_mod__prompt_kernel_kv4r:
    s_waitcnt vmcnt(0) lgkmcnt(0)
    s_nop 15
    s_nop 3
    s_mov_b32 s27, 0
adaLN_cond__sliding_block_cached__moe_arch_mod__prompt_kernel_kv4p:
    buffer_load_dwordx4 v[12:15], v21, s[8:11], s18 offen sc1
    s_waitcnt vmcnt(0)
    v_xor_b32 v8, s28, v12
    v_xor_b32 v20, s28, v13
    v_or_b32 v8, v8, v20
    v_xor_b32 v20, s28, v14
    v_or_b32 v8, v8, v20
    v_xor_b32 v20, s28, v15
    v_or_b32 v8, v8, v20
    v_cmp_ne_u32 vcc, 0, v8
    s_add_u32 s27, s27, 1
    s_cmp_ge_u32 s27, 65536
    s_cbranch_scc1 adaLN_cond__sliding_block_cached__moe_arch_mod__prompt_kernel_kv4g
    s_cbranch_vccnz adaLN_cond__sliding_block_cached__moe_arch_mod__prompt_kernel_kv4p
adaLN_cond__sliding_block_cached__moe_arch_mod__prompt_kernel_kv4g:
    s_waitcnt vmcnt(0) lgkmcnt(0)
    s_nop 15
    s_nop 3
    s_branch adaLN_cond__sliding_block_cached__moe_arch_mod__prompt_kernel_kv4b
adaLN_cond__sliding_block_cached__moe_arch_mod__prompt_kernel_fixA:
    s_waitcnt vmcnt(0) lgkmcnt(0)
    s_nop 15
    s_nop 3
    s_lshr_b32 s16, s12, 3
    s_lshl_b32 s16, s16, 17
    s_add_u32 s16, s16, 0x400000
    v_add_u32 v8, s16, v2
    v_mov_b32 v16, 0xff7fffff
    v_mov_b32 v17, 0xff7fffff
    s_mov_b32 s16, 0
adaLN_cond__sliding_block_cached__moe_arch_mod__prompt_kernel_fixAm:
    s_add_u32 s17, s16, 0
    buffer_load_dwordx4 v[200:203], v8, s[8:11], s17 offen offset:0
    buffer_load_dwordx4 v[204:207], v8, s[8:11], s17 offen offset:1024
    buffer_load_dwordx4 v[208:211], v8, s[8:11], s17 offen offset:2048
    buffer_load_dwordx4 v[212:215], v8, s[8:11], s17 offen offset:3072
    s_waitcnt vmcnt(3)
    v_mfma_f32_16x16x32_bf16 v[184:187], v[200:203], v[152:155], 0
    v_mfma_f32_16x16x32_bf16 v[188:191], v[200:203], v[168:171], 0
    s_waitcnt vmcnt(2)
    v_mfma_f32_16x16x32_bf16 v[192:195], v[204:207], v[152:155], 0
    v_mfma_f32_16x16x32_bf16 v[196:199], v[204:207], v[168:171], 0
    s_waitcnt vmcnt(1)
    v_mfma_f32_16x16x32_bf16 v[184:187], v[208:211], v[156:159], v[184:187]
    v_mfma_f32_16x16x32_bf16 v[188:191], v[208:211], v[172:175], v[188:191]
    s_waitcnt vmcnt(0)
    v_mfma_f32_16x16x32_bf16 v[192:195], v[212:215], v[156:159], v[192:195]
    v_mfma_f32_16x16x32_bf16 v[196:199], v[212:215], v[172:175], v[196:199]
    s_add_u32 s17, s16, 4096
    buffer_load_dwordx4 v[200:203], v8, s[8:11], s17 offen offset:0
    buffer_load_dwordx4 v[204:207], v8, s[8:11], s17 offen offset:1024
    buffer_load_dwordx4 v[208:211], v8, s[8:11], s17 offen offset:2048
    buffer_load_dwordx4 v[212:215], v8, s[8:11], s17 offen offset:3072
    s_waitcnt vmcnt(3)
    v_mfma_f32_16x16x32_bf16 v[184:187], v[200:203], v[160:163], v[184:187]
    v_mfma_f32_16x16x32_bf16 v[188:191], v[200:203], v[176:179], v[188:191]
    s_waitcnt vmcnt(2)
    v_mfma_f32_16x16x32_bf16 v[192:195], v[204:207], v[160:163], v[192:195]
    v_mfma_f32_16x16x32_bf16 v[196:199], v[204:207], v[176:179], v[196:199]
    s_waitcnt vmcnt(1)
    v_mfma_f32_16x16x32_bf16 v[184:187], v[208:211], v[164:167], v[184:187]
    v_mfma_f32_16x16x32_bf16 v[188:191], v[208:211], v[180:183], v[188:191]
    s_waitcnt vmcnt(0)
    v_mfma_f32_16x16x32_bf16 v[192:195], v[212:215], v[164:167], v[192:195]
    v_mfma_f32_16x16x32_bf16 v[196:199], v[212:215], v[180:183], v[196:199]
    s_nop 3
    v_max3_f32 v16, v16, v184, v185
    v_max3_f32 v16, v16, v186, v187
    v_max3_f32 v17, v17, v188, v189
    v_max3_f32 v17, v17, v190, v191
    v_max3_f32 v16, v16, v192, v193
    v_max3_f32 v16, v16, v194, v195
    v_max3_f32 v17, v17, v196, v197
    v_max3_f32 v17, v17, v198, v199
    s_add_u32 s16, s16, 8192
    s_cmp_lt_u32 s16, 0x20000
    s_cbranch_scc1 adaLN_cond__sliding_block_cached__moe_arch_mod__prompt_kernel_fixAm
    v_mov_b32 v18, v16
    v_mov_b32 v19, v17
    s_nop 0
    v_permlane16_swap_b32 v16, v18
    v_permlane16_swap_b32 v17, v19
    v_max_f32 v16, v16, v18
    v_max_f32 v17, v17, v19
    v_mov_b32 v18, v16
    v_mov_b32 v19, v17
    s_nop 0
    v_permlane32_swap_b32 v16, v18
    v_permlane32_swap_b32 v17, v19
    v_max_f32 v16, v16, v18
    v_max_f32 v17, v17, v19
    v_sub_f32 v216, 0, v16
    v_sub_f32 v217, 0, v16
    v_sub_f32 v218, 0, v16
    v_sub_f32 v219, 0, v16
    v_sub_f32 v220, 0, v17
    v_sub_f32 v221, 0, v17
    v_sub_f32 v222, 0, v17
    v_sub_f32 v223, 0, v17
    s_mov_b32 s17, 0x0
    buffer_load_dwordx4 v[200:203], v8, s[8:11], s17 offen offset:0
    buffer_load_dwordx4 v[204:207], v8, s[8:11], s17 offen offset:1024
    buffer_load_dwordx4 v[208:211], v8, s[8:11], s17 offen offset:2048
    buffer_load_dwordx4 v[212:215], v8, s[8:11], s17 offen offset:3072
    s_waitcnt vmcnt(3)
    v_mfma_f32_16x16x32_bf16 v[184:187], v[200:203], v[152:155], v[216:219]
    v_mfma_f32_16x16x32_bf16 v[188:191], v[200:203], v[168:171], v[220:223]
    s_waitcnt vmcnt(2)
    v_mfma_f32_16x16x32_bf16 v[192:195], v[204:207], v[152:155], v[216:219]
    v_mfma_f32_16x16x32_bf16 v[196:199], v[204:207], v[168:171], v[220:223]
    s_waitcnt vmcnt(1)
    v_mfma_f32_16x16x32_bf16 v[184:187], v[208:211], v[156:159], v[184:187]
    v_mfma_f32_16x16x32_bf16 v[188:191], v[208:211], v[172:175], v[188:191]
    s_waitcnt vmcnt(0)
    v_mfma_f32_16x16x32_bf16 v[192:195], v[212:215], v[156:159], v[192:195]
    v_mfma_f32_16x16x32_bf16 v[196:199], v[212:215], v[172:175], v[196:199]
    s_mov_b32 s17, 0x1000
    buffer_load_dwordx4 v[200:203], v8, s[8:11], s17 offen offset:0
    buffer_load_dwordx4 v[204:207], v8, s[8:11], s17 offen offset:1024
    buffer_load_dwordx4 v[208:211], v8, s[8:11], s17 offen offset:2048
    buffer_load_dwordx4 v[212:215], v8, s[8:11], s17 offen offset:3072
    s_waitcnt vmcnt(3)
    v_mfma_f32_16x16x32_bf16 v[184:187], v[200:203], v[160:163], v[184:187]
    v_mfma_f32_16x16x32_bf16 v[188:191], v[200:203], v[176:179], v[188:191]
    s_waitcnt vmcnt(2)
    v_mfma_f32_16x16x32_bf16 v[192:195], v[204:207], v[160:163], v[192:195]
    v_mfma_f32_16x16x32_bf16 v[196:199], v[204:207], v[176:179], v[196:199]
    s_waitcnt vmcnt(1)
    v_mfma_f32_16x16x32_bf16 v[184:187], v[208:211], v[164:167], v[184:187]
    v_mfma_f32_16x16x32_bf16 v[188:191], v[208:211], v[180:183], v[188:191]
    s_waitcnt vmcnt(0)
    v_mfma_f32_16x16x32_bf16 v[192:195], v[212:215], v[164:167], v[192:195]
    v_mfma_f32_16x16x32_bf16 v[196:199], v[212:215], v[180:183], v[196:199]
    s_nop 3
    v_exp_f32 v184, v184
    v_exp_f32 v185, v185
    s_nop 0
    v_add_f32 v9, v184, v185
    v_cvt_pk_bf16_f32 v24, v184, v185
    v_exp_f32 v186, v186
    v_exp_f32 v187, v187
    v_add_f32 v9, v9, v186
    v_add_f32 v9, v9, v187
    v_cvt_pk_bf16_f32 v25, v186, v187
    v_exp_f32 v188, v188
    v_exp_f32 v189, v189
    s_nop 0
    v_add_f32 v10, v188, v189
    v_cvt_pk_bf16_f32 v28, v188, v189
    v_exp_f32 v190, v190
    v_exp_f32 v191, v191
    v_add_f32 v10, v10, v190
    v_add_f32 v10, v10, v191
    v_cvt_pk_bf16_f32 v29, v190, v191
    v_exp_f32 v192, v192
    v_exp_f32 v193, v193
    v_add_f32 v9, v9, v192
    v_add_f32 v9, v9, v193
    v_cvt_pk_bf16_f32 v26, v192, v193
    v_exp_f32 v194, v194
    v_exp_f32 v195, v195
    v_add_f32 v9, v9, v194
    v_add_f32 v9, v9, v195
    v_cvt_pk_bf16_f32 v27, v194, v195
    v_exp_f32 v196, v196
    v_exp_f32 v197, v197
    v_add_f32 v10, v10, v196
    v_add_f32 v10, v10, v197
    v_cvt_pk_bf16_f32 v30, v196, v197
    v_exp_f32 v198, v198
    v_exp_f32 v199, v199
    v_add_f32 v10, v10, v198
    v_add_f32 v10, v10, v199
    v_cvt_pk_bf16_f32 v31, v198, v199
    s_mov_b32 s17, 0x2000
    buffer_load_dwordx4 v[200:203], v8, s[8:11], s17 offen offset:0
    buffer_load_dwordx4 v[204:207], v8, s[8:11], s17 offen offset:1024
    buffer_load_dwordx4 v[208:211], v8, s[8:11], s17 offen offset:2048
    buffer_load_dwordx4 v[212:215], v8, s[8:11], s17 offen offset:3072
    s_waitcnt vmcnt(3)
    v_mfma_f32_16x16x32_bf16 v[184:187], v[200:203], v[152:155], v[216:219]
    v_mfma_f32_16x16x32_bf16 v[188:191], v[200:203], v[168:171], v[220:223]
    s_waitcnt vmcnt(2)
    v_mfma_f32_16x16x32_bf16 v[192:195], v[204:207], v[152:155], v[216:219]
    v_mfma_f32_16x16x32_bf16 v[196:199], v[204:207], v[168:171], v[220:223]
    s_waitcnt vmcnt(1)
    v_mfma_f32_16x16x32_bf16 v[184:187], v[208:211], v[156:159], v[184:187]
    v_mfma_f32_16x16x32_bf16 v[188:191], v[208:211], v[172:175], v[188:191]
    s_waitcnt vmcnt(0)
    v_mfma_f32_16x16x32_bf16 v[192:195], v[212:215], v[156:159], v[192:195]
    v_mfma_f32_16x16x32_bf16 v[196:199], v[212:215], v[172:175], v[196:199]
    s_mov_b32 s17, 0x3000
    buffer_load_dwordx4 v[200:203], v8, s[8:11], s17 offen offset:0
    buffer_load_dwordx4 v[204:207], v8, s[8:11], s17 offen offset:1024
    buffer_load_dwordx4 v[208:211], v8, s[8:11], s17 offen offset:2048
    buffer_load_dwordx4 v[212:215], v8, s[8:11], s17 offen offset:3072
    s_waitcnt vmcnt(3)
    v_mfma_f32_16x16x32_bf16 v[184:187], v[200:203], v[160:163], v[184:187]
    v_mfma_f32_16x16x32_bf16 v[188:191], v[200:203], v[176:179], v[188:191]
    s_waitcnt vmcnt(2)
    v_mfma_f32_16x16x32_bf16 v[192:195], v[204:207], v[160:163], v[192:195]
    v_mfma_f32_16x16x32_bf16 v[196:199], v[204:207], v[176:179], v[196:199]
    s_waitcnt vmcnt(1)
    v_mfma_f32_16x16x32_bf16 v[184:187], v[208:211], v[164:167], v[184:187]
    v_mfma_f32_16x16x32_bf16 v[188:191], v[208:211], v[180:183], v[188:191]
    s_waitcnt vmcnt(0)
    v_mfma_f32_16x16x32_bf16 v[192:195], v[212:215], v[164:167], v[192:195]
    v_mfma_f32_16x16x32_bf16 v[196:199], v[212:215], v[180:183], v[196:199]
    s_nop 3
    v_exp_f32 v184, v184
    v_exp_f32 v185, v185
    v_add_f32 v9, v9, v184
    v_add_f32 v9, v9, v185
    v_cvt_pk_bf16_f32 v32, v184, v185
    v_exp_f32 v186, v186
    v_exp_f32 v187, v187
    v_add_f32 v9, v9, v186
    v_add_f32 v9, v9, v187
    v_cvt_pk_bf16_f32 v33, v186, v187
    v_exp_f32 v188, v188
    v_exp_f32 v189, v189
    v_add_f32 v10, v10, v188
    v_add_f32 v10, v10, v189
    v_cvt_pk_bf16_f32 v36, v188, v189
    v_exp_f32 v190, v190
    v_exp_f32 v191, v191
    v_add_f32 v10, v10, v190
    v_add_f32 v10, v10, v191
    v_cvt_pk_bf16_f32 v37, v190, v191
    v_exp_f32 v192, v192
    v_exp_f32 v193, v193
    v_add_f32 v9, v9, v192
    v_add_f32 v9, v9, v193
    v_cvt_pk_bf16_f32 v34, v192, v193
    v_exp_f32 v194, v194
    v_exp_f32 v195, v195
    v_add_f32 v9, v9, v194
    v_add_f32 v9, v9, v195
    v_cvt_pk_bf16_f32 v35, v194, v195
    v_exp_f32 v196, v196
    v_exp_f32 v197, v197
    v_add_f32 v10, v10, v196
    v_add_f32 v10, v10, v197
    v_cvt_pk_bf16_f32 v38, v196, v197
    v_exp_f32 v198, v198
    v_exp_f32 v199, v199
    v_add_f32 v10, v10, v198
    v_add_f32 v10, v10, v199
    v_cvt_pk_bf16_f32 v39, v198, v199
    s_mov_b32 s17, 0x4000
    buffer_load_dwordx4 v[200:203], v8, s[8:11], s17 offen offset:0
    buffer_load_dwordx4 v[204:207], v8, s[8:11], s17 offen offset:1024
    buffer_load_dwordx4 v[208:211], v8, s[8:11], s17 offen offset:2048
    buffer_load_dwordx4 v[212:215], v8, s[8:11], s17 offen offset:3072
    s_waitcnt vmcnt(3)
    v_mfma_f32_16x16x32_bf16 v[184:187], v[200:203], v[152:155], v[216:219]
    v_mfma_f32_16x16x32_bf16 v[188:191], v[200:203], v[168:171], v[220:223]
    s_waitcnt vmcnt(2)
    v_mfma_f32_16x16x32_bf16 v[192:195], v[204:207], v[152:155], v[216:219]
    v_mfma_f32_16x16x32_bf16 v[196:199], v[204:207], v[168:171], v[220:223]
    s_waitcnt vmcnt(1)
    v_mfma_f32_16x16x32_bf16 v[184:187], v[208:211], v[156:159], v[184:187]
    v_mfma_f32_16x16x32_bf16 v[188:191], v[208:211], v[172:175], v[188:191]
    s_waitcnt vmcnt(0)
    v_mfma_f32_16x16x32_bf16 v[192:195], v[212:215], v[156:159], v[192:195]
    v_mfma_f32_16x16x32_bf16 v[196:199], v[212:215], v[172:175], v[196:199]
    s_mov_b32 s17, 0x5000
    buffer_load_dwordx4 v[200:203], v8, s[8:11], s17 offen offset:0
    buffer_load_dwordx4 v[204:207], v8, s[8:11], s17 offen offset:1024
    buffer_load_dwordx4 v[208:211], v8, s[8:11], s17 offen offset:2048
    buffer_load_dwordx4 v[212:215], v8, s[8:11], s17 offen offset:3072
    s_waitcnt vmcnt(3)
    v_mfma_f32_16x16x32_bf16 v[184:187], v[200:203], v[160:163], v[184:187]
    v_mfma_f32_16x16x32_bf16 v[188:191], v[200:203], v[176:179], v[188:191]
    s_waitcnt vmcnt(2)
    v_mfma_f32_16x16x32_bf16 v[192:195], v[204:207], v[160:163], v[192:195]
    v_mfma_f32_16x16x32_bf16 v[196:199], v[204:207], v[176:179], v[196:199]
    s_waitcnt vmcnt(1)
    v_mfma_f32_16x16x32_bf16 v[184:187], v[208:211], v[164:167], v[184:187]
    v_mfma_f32_16x16x32_bf16 v[188:191], v[208:211], v[180:183], v[188:191]
    s_waitcnt vmcnt(0)
    v_mfma_f32_16x16x32_bf16 v[192:195], v[212:215], v[164:167], v[192:195]
    v_mfma_f32_16x16x32_bf16 v[196:199], v[212:215], v[180:183], v[196:199]
    s_nop 3
    v_exp_f32 v184, v184
    v_exp_f32 v185, v185
    v_add_f32 v9, v9, v184
    v_add_f32 v9, v9, v185
    v_cvt_pk_bf16_f32 v40, v184, v185
    v_exp_f32 v186, v186
    v_exp_f32 v187, v187
    v_add_f32 v9, v9, v186
    v_add_f32 v9, v9, v187
    v_cvt_pk_bf16_f32 v41, v186, v187
    v_exp_f32 v188, v188
    v_exp_f32 v189, v189
    v_add_f32 v10, v10, v188
    v_add_f32 v10, v10, v189
    v_cvt_pk_bf16_f32 v44, v188, v189
    v_exp_f32 v190, v190
    v_exp_f32 v191, v191
    v_add_f32 v10, v10, v190
    v_add_f32 v10, v10, v191
    v_cvt_pk_bf16_f32 v45, v190, v191
    v_exp_f32 v192, v192
    v_exp_f32 v193, v193
    v_add_f32 v9, v9, v192
    v_add_f32 v9, v9, v193
    v_cvt_pk_bf16_f32 v42, v192, v193
    v_exp_f32 v194, v194
    v_exp_f32 v195, v195
    v_add_f32 v9, v9, v194
    v_add_f32 v9, v9, v195
    v_cvt_pk_bf16_f32 v43, v194, v195
    v_exp_f32 v196, v196
    v_exp_f32 v197, v197
    v_add_f32 v10, v10, v196
    v_add_f32 v10, v10, v197
    v_cvt_pk_bf16_f32 v46, v196, v197
    v_exp_f32 v198, v198
    v_exp_f32 v199, v199
    v_add_f32 v10, v10, v198
    v_add_f32 v10, v10, v199
    v_cvt_pk_bf16_f32 v47, v198, v199
    s_mov_b32 s17, 0x6000
    buffer_load_dwordx4 v[200:203], v8, s[8:11], s17 offen offset:0
    buffer_load_dwordx4 v[204:207], v8, s[8:11], s17 offen offset:1024
    buffer_load_dwordx4 v[208:211], v8, s[8:11], s17 offen offset:2048
    buffer_load_dwordx4 v[212:215], v8, s[8:11], s17 offen offset:3072
    s_waitcnt vmcnt(3)
    v_mfma_f32_16x16x32_bf16 v[184:187], v[200:203], v[152:155], v[216:219]
    v_mfma_f32_16x16x32_bf16 v[188:191], v[200:203], v[168:171], v[220:223]
    s_waitcnt vmcnt(2)
    v_mfma_f32_16x16x32_bf16 v[192:195], v[204:207], v[152:155], v[216:219]
    v_mfma_f32_16x16x32_bf16 v[196:199], v[204:207], v[168:171], v[220:223]
    s_waitcnt vmcnt(1)
    v_mfma_f32_16x16x32_bf16 v[184:187], v[208:211], v[156:159], v[184:187]
    v_mfma_f32_16x16x32_bf16 v[188:191], v[208:211], v[172:175], v[188:191]
    s_waitcnt vmcnt(0)
    v_mfma_f32_16x16x32_bf16 v[192:195], v[212:215], v[156:159], v[192:195]
    v_mfma_f32_16x16x32_bf16 v[196:199], v[212:215], v[172:175], v[196:199]
    s_mov_b32 s17, 0x7000
    buffer_load_dwordx4 v[200:203], v8, s[8:11], s17 offen offset:0
    buffer_load_dwordx4 v[204:207], v8, s[8:11], s17 offen offset:1024
    buffer_load_dwordx4 v[208:211], v8, s[8:11], s17 offen offset:2048
    buffer_load_dwordx4 v[212:215], v8, s[8:11], s17 offen offset:3072
    s_waitcnt vmcnt(3)
    v_mfma_f32_16x16x32_bf16 v[184:187], v[200:203], v[160:163], v[184:187]
    v_mfma_f32_16x16x32_bf16 v[188:191], v[200:203], v[176:179], v[188:191]
    s_waitcnt vmcnt(2)
    v_mfma_f32_16x16x32_bf16 v[192:195], v[204:207], v[160:163], v[192:195]
    v_mfma_f32_16x16x32_bf16 v[196:199], v[204:207], v[176:179], v[196:199]
    s_waitcnt vmcnt(1)
    v_mfma_f32_16x16x32_bf16 v[184:187], v[208:211], v[164:167], v[184:187]
    v_mfma_f32_16x16x32_bf16 v[188:191], v[208:211], v[180:183], v[188:191]
    s_waitcnt vmcnt(0)
    v_mfma_f32_16x16x32_bf16 v[192:195], v[212:215], v[164:167], v[192:195]
    v_mfma_f32_16x16x32_bf16 v[196:199], v[212:215], v[180:183], v[196:199]
    s_nop 3
    v_exp_f32 v184, v184
    v_exp_f32 v185, v185
    v_add_f32 v9, v9, v184
    v_add_f32 v9, v9, v185
    v_cvt_pk_bf16_f32 v48, v184, v185
    v_exp_f32 v186, v186
    v_exp_f32 v187, v187
    v_add_f32 v9, v9, v186
    v_add_f32 v9, v9, v187
    v_cvt_pk_bf16_f32 v49, v186, v187
    v_exp_f32 v188, v188
    v_exp_f32 v189, v189
    v_add_f32 v10, v10, v188
    v_add_f32 v10, v10, v189
    v_cvt_pk_bf16_f32 v52, v188, v189
    v_exp_f32 v190, v190
    v_exp_f32 v191, v191
    v_add_f32 v10, v10, v190
    v_add_f32 v10, v10, v191
    v_cvt_pk_bf16_f32 v53, v190, v191
    v_exp_f32 v192, v192
    v_exp_f32 v193, v193
    v_add_f32 v9, v9, v192
    v_add_f32 v9, v9, v193
    v_cvt_pk_bf16_f32 v50, v192, v193
    v_exp_f32 v194, v194
    v_exp_f32 v195, v195
    v_add_f32 v9, v9, v194
    v_add_f32 v9, v9, v195
    v_cvt_pk_bf16_f32 v51, v194, v195
    v_exp_f32 v196, v196
    v_exp_f32 v197, v197
    v_add_f32 v10, v10, v196
    v_add_f32 v10, v10, v197
    v_cvt_pk_bf16_f32 v54, v196, v197
    v_exp_f32 v198, v198
    v_exp_f32 v199, v199
    v_add_f32 v10, v10, v198
    v_add_f32 v10, v10, v199
    v_cvt_pk_bf16_f32 v55, v198, v199
    s_mov_b32 s17, 0x8000
    buffer_load_dwordx4 v[200:203], v8, s[8:11], s17 offen offset:0
    buffer_load_dwordx4 v[204:207], v8, s[8:11], s17 offen offset:1024
    buffer_load_dwordx4 v[208:211], v8, s[8:11], s17 offen offset:2048
    buffer_load_dwordx4 v[212:215], v8, s[8:11], s17 offen offset:3072
    s_waitcnt vmcnt(3)
    v_mfma_f32_16x16x32_bf16 v[184:187], v[200:203], v[152:155], v[216:219]
    v_mfma_f32_16x16x32_bf16 v[188:191], v[200:203], v[168:171], v[220:223]
    s_waitcnt vmcnt(2)
    v_mfma_f32_16x16x32_bf16 v[192:195], v[204:207], v[152:155], v[216:219]
    v_mfma_f32_16x16x32_bf16 v[196:199], v[204:207], v[168:171], v[220:223]
    s_waitcnt vmcnt(1)
    v_mfma_f32_16x16x32_bf16 v[184:187], v[208:211], v[156:159], v[184:187]
    v_mfma_f32_16x16x32_bf16 v[188:191], v[208:211], v[172:175], v[188:191]
    s_waitcnt vmcnt(0)
    v_mfma_f32_16x16x32_bf16 v[192:195], v[212:215], v[156:159], v[192:195]
    v_mfma_f32_16x16x32_bf16 v[196:199], v[212:215], v[172:175], v[196:199]
    s_mov_b32 s17, 0x9000
    buffer_load_dwordx4 v[200:203], v8, s[8:11], s17 offen offset:0
    buffer_load_dwordx4 v[204:207], v8, s[8:11], s17 offen offset:1024
    buffer_load_dwordx4 v[208:211], v8, s[8:11], s17 offen offset:2048
    buffer_load_dwordx4 v[212:215], v8, s[8:11], s17 offen offset:3072
    s_waitcnt vmcnt(3)
    v_mfma_f32_16x16x32_bf16 v[184:187], v[200:203], v[160:163], v[184:187]
    v_mfma_f32_16x16x32_bf16 v[188:191], v[200:203], v[176:179], v[188:191]
    s_waitcnt vmcnt(2)
    v_mfma_f32_16x16x32_bf16 v[192:195], v[204:207], v[160:163], v[192:195]
    v_mfma_f32_16x16x32_bf16 v[196:199], v[204:207], v[176:179], v[196:199]
    s_waitcnt vmcnt(1)
    v_mfma_f32_16x16x32_bf16 v[184:187], v[208:211], v[164:167], v[184:187]
    v_mfma_f32_16x16x32_bf16 v[188:191], v[208:211], v[180:183], v[188:191]
    s_waitcnt vmcnt(0)
    v_mfma_f32_16x16x32_bf16 v[192:195], v[212:215], v[164:167], v[192:195]
    v_mfma_f32_16x16x32_bf16 v[196:199], v[212:215], v[180:183], v[196:199]
    s_nop 3
    v_exp_f32 v184, v184
    v_exp_f32 v185, v185
    v_add_f32 v9, v9, v184
    v_add_f32 v9, v9, v185
    v_cvt_pk_bf16_f32 v56, v184, v185
    v_exp_f32 v186, v186
    v_exp_f32 v187, v187
    v_add_f32 v9, v9, v186
    v_add_f32 v9, v9, v187
    v_cvt_pk_bf16_f32 v57, v186, v187
    v_exp_f32 v188, v188
    v_exp_f32 v189, v189
    v_add_f32 v10, v10, v188
    v_add_f32 v10, v10, v189
    v_cvt_pk_bf16_f32 v60, v188, v189
    v_exp_f32 v190, v190
    v_exp_f32 v191, v191
    v_add_f32 v10, v10, v190
    v_add_f32 v10, v10, v191
    v_cvt_pk_bf16_f32 v61, v190, v191
    v_exp_f32 v192, v192
    v_exp_f32 v193, v193
    v_add_f32 v9, v9, v192
    v_add_f32 v9, v9, v193
    v_cvt_pk_bf16_f32 v58, v192, v193
    v_exp_f32 v194, v194
    v_exp_f32 v195, v195
    v_add_f32 v9, v9, v194
    v_add_f32 v9, v9, v195
    v_cvt_pk_bf16_f32 v59, v194, v195
    v_exp_f32 v196, v196
    v_exp_f32 v197, v197
    v_add_f32 v10, v10, v196
    v_add_f32 v10, v10, v197
    v_cvt_pk_bf16_f32 v62, v196, v197
    v_exp_f32 v198, v198
    v_exp_f32 v199, v199
    v_add_f32 v10, v10, v198
    v_add_f32 v10, v10, v199
    v_cvt_pk_bf16_f32 v63, v198, v199
    s_mov_b32 s17, 0xa000
    buffer_load_dwordx4 v[200:203], v8, s[8:11], s17 offen offset:0
    buffer_load_dwordx4 v[204:207], v8, s[8:11], s17 offen offset:1024
    buffer_load_dwordx4 v[208:211], v8, s[8:11], s17 offen offset:2048
    buffer_load_dwordx4 v[212:215], v8, s[8:11], s17 offen offset:3072
    s_waitcnt vmcnt(3)
    v_mfma_f32_16x16x32_bf16 v[184:187], v[200:203], v[152:155], v[216:219]
    v_mfma_f32_16x16x32_bf16 v[188:191], v[200:203], v[168:171], v[220:223]
    s_waitcnt vmcnt(2)
    v_mfma_f32_16x16x32_bf16 v[192:195], v[204:207], v[152:155], v[216:219]
    v_mfma_f32_16x16x32_bf16 v[196:199], v[204:207], v[168:171], v[220:223]
    s_waitcnt vmcnt(1)
    v_mfma_f32_16x16x32_bf16 v[184:187], v[208:211], v[156:159], v[184:187]
    v_mfma_f32_16x16x32_bf16 v[188:191], v[208:211], v[172:175], v[188:191]
    s_waitcnt vmcnt(0)
    v_mfma_f32_16x16x32_bf16 v[192:195], v[212:215], v[156:159], v[192:195]
    v_mfma_f32_16x16x32_bf16 v[196:199], v[212:215], v[172:175], v[196:199]
    s_mov_b32 s17, 0xb000
    buffer_load_dwordx4 v[200:203], v8, s[8:11], s17 offen offset:0
    buffer_load_dwordx4 v[204:207], v8, s[8:11], s17 offen offset:1024
    buffer_load_dwordx4 v[208:211], v8, s[8:11], s17 offen offset:2048
    buffer_load_dwordx4 v[212:215], v8, s[8:11], s17 offen offset:3072
    s_waitcnt vmcnt(3)
    v_mfma_f32_16x16x32_bf16 v[184:187], v[200:203], v[160:163], v[184:187]
    v_mfma_f32_16x16x32_bf16 v[188:191], v[200:203], v[176:179], v[188:191]
    s_waitcnt vmcnt(2)
    v_mfma_f32_16x16x32_bf16 v[192:195], v[204:207], v[160:163], v[192:195]
    v_mfma_f32_16x16x32_bf16 v[196:199], v[204:207], v[176:179], v[196:199]
    s_waitcnt vmcnt(1)
    v_mfma_f32_16x16x32_bf16 v[184:187], v[208:211], v[164:167], v[184:187]
    v_mfma_f32_16x16x32_bf16 v[188:191], v[208:211], v[180:183], v[188:191]
    s_waitcnt vmcnt(0)
    v_mfma_f32_16x16x32_bf16 v[192:195], v[212:215], v[164:167], v[192:195]
    v_mfma_f32_16x16x32_bf16 v[196:199], v[212:215], v[180:183], v[196:199]
    s_nop 3
    v_exp_f32 v184, v184
    v_exp_f32 v185, v185
    v_add_f32 v9, v9, v184
    v_add_f32 v9, v9, v185
    v_cvt_pk_bf16_f32 v64, v184, v185
    v_exp_f32 v186, v186
    v_exp_f32 v187, v187
    v_add_f32 v9, v9, v186
    v_add_f32 v9, v9, v187
    v_cvt_pk_bf16_f32 v65, v186, v187
    v_exp_f32 v188, v188
    v_exp_f32 v189, v189
    v_add_f32 v10, v10, v188
    v_add_f32 v10, v10, v189
    v_cvt_pk_bf16_f32 v68, v188, v189
    v_exp_f32 v190, v190
    v_exp_f32 v191, v191
    v_add_f32 v10, v10, v190
    v_add_f32 v10, v10, v191
    v_cvt_pk_bf16_f32 v69, v190, v191
    v_exp_f32 v192, v192
    v_exp_f32 v193, v193
    v_add_f32 v9, v9, v192
    v_add_f32 v9, v9, v193
    v_cvt_pk_bf16_f32 v66, v192, v193
    v_exp_f32 v194, v194
    v_exp_f32 v195, v195
    v_add_f32 v9, v9, v194
    v_add_f32 v9, v9, v195
    v_cvt_pk_bf16_f32 v67, v194, v195
    v_exp_f32 v196, v196
    v_exp_f32 v197, v197
    v_add_f32 v10, v10, v196
    v_add_f32 v10, v10, v197
    v_cvt_pk_bf16_f32 v70, v196, v197
    v_exp_f32 v198, v198
    v_exp_f32 v199, v199
    v_add_f32 v10, v10, v198
    v_add_f32 v10, v10, v199
    v_cvt_pk_bf16_f32 v71, v198, v199
    s_mov_b32 s17, 0xc000
    buffer_load_dwordx4 v[200:203], v8, s[8:11], s17 offen offset:0
    buffer_load_dwordx4 v[204:207], v8, s[8:11], s17 offen offset:1024
    buffer_load_dwordx4 v[208:211], v8, s[8:11], s17 offen offset:2048
    buffer_load_dwordx4 v[212:215], v8, s[8:11], s17 offen offset:3072
    s_waitcnt vmcnt(3)
    v_mfma_f32_16x16x32_bf16 v[184:187], v[200:203], v[152:155], v[216:219]
    v_mfma_f32_16x16x32_bf16 v[188:191], v[200:203], v[168:171], v[220:223]
    s_waitcnt vmcnt(2)
    v_mfma_f32_16x16x32_bf16 v[192:195], v[204:207], v[152:155], v[216:219]
    v_mfma_f32_16x16x32_bf16 v[196:199], v[204:207], v[168:171], v[220:223]
    s_waitcnt vmcnt(1)
    v_mfma_f32_16x16x32_bf16 v[184:187], v[208:211], v[156:159], v[184:187]
    v_mfma_f32_16x16x32_bf16 v[188:191], v[208:211], v[172:175], v[188:191]
    s_waitcnt vmcnt(0)
    v_mfma_f32_16x16x32_bf16 v[192:195], v[212:215], v[156:159], v[192:195]
    v_mfma_f32_16x16x32_bf16 v[196:199], v[212:215], v[172:175], v[196:199]
    s_mov_b32 s17, 0xd000
    buffer_load_dwordx4 v[200:203], v8, s[8:11], s17 offen offset:0
    buffer_load_dwordx4 v[204:207], v8, s[8:11], s17 offen offset:1024
    buffer_load_dwordx4 v[208:211], v8, s[8:11], s17 offen offset:2048
    buffer_load_dwordx4 v[212:215], v8, s[8:11], s17 offen offset:3072
    s_waitcnt vmcnt(3)
    v_mfma_f32_16x16x32_bf16 v[184:187], v[200:203], v[160:163], v[184:187]
    v_mfma_f32_16x16x32_bf16 v[188:191], v[200:203], v[176:179], v[188:191]
    s_waitcnt vmcnt(2)
    v_mfma_f32_16x16x32_bf16 v[192:195], v[204:207], v[160:163], v[192:195]
    v_mfma_f32_16x16x32_bf16 v[196:199], v[204:207], v[176:179], v[196:199]
    s_waitcnt vmcnt(1)
    v_mfma_f32_16x16x32_bf16 v[184:187], v[208:211], v[164:167], v[184:187]
    v_mfma_f32_16x16x32_bf16 v[188:191], v[208:211], v[180:183], v[188:191]
    s_waitcnt vmcnt(0)
    v_mfma_f32_16x16x32_bf16 v[192:195], v[212:215], v[164:167], v[192:195]
    v_mfma_f32_16x16x32_bf16 v[196:199], v[212:215], v[180:183], v[196:199]
    s_nop 3
    v_exp_f32 v184, v184
    v_exp_f32 v185, v185
    v_add_f32 v9, v9, v184
    v_add_f32 v9, v9, v185
    v_cvt_pk_bf16_f32 v72, v184, v185
    v_exp_f32 v186, v186
    v_exp_f32 v187, v187
    v_add_f32 v9, v9, v186
    v_add_f32 v9, v9, v187
    v_cvt_pk_bf16_f32 v73, v186, v187
    v_exp_f32 v188, v188
    v_exp_f32 v189, v189
    v_add_f32 v10, v10, v188
    v_add_f32 v10, v10, v189
    v_cvt_pk_bf16_f32 v76, v188, v189
    v_exp_f32 v190, v190
    v_exp_f32 v191, v191
    v_add_f32 v10, v10, v190
    v_add_f32 v10, v10, v191
    v_cvt_pk_bf16_f32 v77, v190, v191
    v_exp_f32 v192, v192
    v_exp_f32 v193, v193
    v_add_f32 v9, v9, v192
    v_add_f32 v9, v9, v193
    v_cvt_pk_bf16_f32 v74, v192, v193
    v_exp_f32 v194, v194
    v_exp_f32 v195, v195
    v_add_f32 v9, v9, v194
    v_add_f32 v9, v9, v195
    v_cvt_pk_bf16_f32 v75, v194, v195
    v_exp_f32 v196, v196
    v_exp_f32 v197, v197
    v_add_f32 v10, v10, v196
    v_add_f32 v10, v10, v197
    v_cvt_pk_bf16_f32 v78, v196, v197
    v_exp_f32 v198, v198
    v_exp_f32 v199, v199
    v_add_f32 v10, v10, v198
    v_add_f32 v10, v10, v199
    v_cvt_pk_bf16_f32 v79, v198, v199
    s_mov_b32 s17, 0xe000
    buffer_load_dwordx4 v[200:203], v8, s[8:11], s17 offen offset:0
    buffer_load_dwordx4 v[204:207], v8, s[8:11], s17 offen offset:1024
    buffer_load_dwordx4 v[208:211], v8, s[8:11], s17 offen offset:2048
    buffer_load_dwordx4 v[212:215], v8, s[8:11], s17 offen offset:3072
    s_waitcnt vmcnt(3)
    v_mfma_f32_16x16x32_bf16 v[184:187], v[200:203], v[152:155], v[216:219]
    v_mfma_f32_16x16x32_bf16 v[188:191], v[200:203], v[168:171], v[220:223]
    s_waitcnt vmcnt(2)
    v_mfma_f32_16x16x32_bf16 v[192:195], v[204:207], v[152:155], v[216:219]
    v_mfma_f32_16x16x32_bf16 v[196:199], v[204:207], v[168:171], v[220:223]
    s_waitcnt vmcnt(1)
    v_mfma_f32_16x16x32_bf16 v[184:187], v[208:211], v[156:159], v[184:187]
    v_mfma_f32_16x16x32_bf16 v[188:191], v[208:211], v[172:175], v[188:191]
    s_waitcnt vmcnt(0)
    v_mfma_f32_16x16x32_bf16 v[192:195], v[212:215], v[156:159], v[192:195]
    v_mfma_f32_16x16x32_bf16 v[196:199], v[212:215], v[172:175], v[196:199]
    s_mov_b32 s17, 0xf000
    buffer_load_dwordx4 v[200:203], v8, s[8:11], s17 offen offset:0
    buffer_load_dwordx4 v[204:207], v8, s[8:11], s17 offen offset:1024
    buffer_load_dwordx4 v[208:211], v8, s[8:11], s17 offen offset:2048
    buffer_load_dwordx4 v[212:215], v8, s[8:11], s17 offen offset:3072
    s_waitcnt vmcnt(3)
    v_mfma_f32_16x16x32_bf16 v[184:187], v[200:203], v[160:163], v[184:187]
    v_mfma_f32_16x16x32_bf16 v[188:191], v[200:203], v[176:179], v[188:191]
    s_waitcnt vmcnt(2)
    v_mfma_f32_16x16x32_bf16 v[192:195], v[204:207], v[160:163], v[192:195]
    v_mfma_f32_16x16x32_bf16 v[196:199], v[204:207], v[176:179], v[196:199]
    s_waitcnt vmcnt(1)
    v_mfma_f32_16x16x32_bf16 v[184:187], v[208:211], v[164:167], v[184:187]
    v_mfma_f32_16x16x32_bf16 v[188:191], v[208:211], v[180:183], v[188:191]
    s_waitcnt vmcnt(0)
    v_mfma_f32_16x16x32_bf16 v[192:195], v[212:215], v[164:167], v[192:195]
    v_mfma_f32_16x16x32_bf16 v[196:199], v[212:215], v[180:183], v[196:199]
    s_nop 3
    v_exp_f32 v184, v184
    v_exp_f32 v185, v185
    v_add_f32 v9, v9, v184
    v_add_f32 v9, v9, v185
    v_cvt_pk_bf16_f32 v80, v184, v185
    v_exp_f32 v186, v186
    v_exp_f32 v187, v187
    v_add_f32 v9, v9, v186
    v_add_f32 v9, v9, v187
    v_cvt_pk_bf16_f32 v81, v186, v187
    v_exp_f32 v188, v188
    v_exp_f32 v189, v189
    v_add_f32 v10, v10, v188
    v_add_f32 v10, v10, v189
    v_cvt_pk_bf16_f32 v84, v188, v189
    v_exp_f32 v190, v190
    v_exp_f32 v191, v191
    v_add_f32 v10, v10, v190
    v_add_f32 v10, v10, v191
    v_cvt_pk_bf16_f32 v85, v190, v191
    v_exp_f32 v192, v192
    v_exp_f32 v193, v193
    v_add_f32 v9, v9, v192
    v_add_f32 v9, v9, v193
    v_cvt_pk_bf16_f32 v82, v192, v193
    v_exp_f32 v194, v194
    v_exp_f32 v195, v195
    v_add_f32 v9, v9, v194
    v_add_f32 v9, v9, v195
    v_cvt_pk_bf16_f32 v83, v194, v195
    v_exp_f32 v196, v196
    v_exp_f32 v197, v197
    v_add_f32 v10, v10, v196
    v_add_f32 v10, v10, v197
    v_cvt_pk_bf16_f32 v86, v196, v197
    v_exp_f32 v198, v198
    v_exp_f32 v199, v199
    v_add_f32 v10, v10, v198
    v_add_f32 v10, v10, v199
    v_cvt_pk_bf16_f32 v87, v198, v199
    s_mov_b32 s17, 0x10000
    buffer_load_dwordx4 v[200:203], v8, s[8:11], s17 offen offset:0
    buffer_load_dwordx4 v[204:207], v8, s[8:11], s17 offen offset:1024
    buffer_load_dwordx4 v[208:211], v8, s[8:11], s17 offen offset:2048
    buffer_load_dwordx4 v[212:215], v8, s[8:11], s17 offen offset:3072
    s_waitcnt vmcnt(3)
    v_mfma_f32_16x16x32_bf16 v[184:187], v[200:203], v[152:155], v[216:219]
    v_mfma_f32_16x16x32_bf16 v[188:191], v[200:203], v[168:171], v[220:223]
    s_waitcnt vmcnt(2)
    v_mfma_f32_16x16x32_bf16 v[192:195], v[204:207], v[152:155], v[216:219]
    v_mfma_f32_16x16x32_bf16 v[196:199], v[204:207], v[168:171], v[220:223]
    s_waitcnt vmcnt(1)
    v_mfma_f32_16x16x32_bf16 v[184:187], v[208:211], v[156:159], v[184:187]
    v_mfma_f32_16x16x32_bf16 v[188:191], v[208:211], v[172:175], v[188:191]
    s_waitcnt vmcnt(0)
    v_mfma_f32_16x16x32_bf16 v[192:195], v[212:215], v[156:159], v[192:195]
    v_mfma_f32_16x16x32_bf16 v[196:199], v[212:215], v[172:175], v[196:199]
    s_mov_b32 s17, 0x11000
    buffer_load_dwordx4 v[200:203], v8, s[8:11], s17 offen offset:0
    buffer_load_dwordx4 v[204:207], v8, s[8:11], s17 offen offset:1024
    buffer_load_dwordx4 v[208:211], v8, s[8:11], s17 offen offset:2048
    buffer_load_dwordx4 v[212:215], v8, s[8:11], s17 offen offset:3072
    s_waitcnt vmcnt(3)
    v_mfma_f32_16x16x32_bf16 v[184:187], v[200:203], v[160:163], v[184:187]
    v_mfma_f32_16x16x32_bf16 v[188:191], v[200:203], v[176:179], v[188:191]
    s_waitcnt vmcnt(2)
    v_mfma_f32_16x16x32_bf16 v[192:195], v[204:207], v[160:163], v[192:195]
    v_mfma_f32_16x16x32_bf16 v[196:199], v[204:207], v[176:179], v[196:199]
    s_waitcnt vmcnt(1)
    v_mfma_f32_16x16x32_bf16 v[184:187], v[208:211], v[164:167], v[184:187]
    v_mfma_f32_16x16x32_bf16 v[188:191], v[208:211], v[180:183], v[188:191]
    s_waitcnt vmcnt(0)
    v_mfma_f32_16x16x32_bf16 v[192:195], v[212:215], v[164:167], v[192:195]
    v_mfma_f32_16x16x32_bf16 v[196:199], v[212:215], v[180:183], v[196:199]
    s_nop 3
    v_exp_f32 v184, v184
    v_exp_f32 v185, v185
    v_add_f32 v9, v9, v184
    v_add_f32 v9, v9, v185
    v_cvt_pk_bf16_f32 v88, v184, v185
    v_exp_f32 v186, v186
    v_exp_f32 v187, v187
    v_add_f32 v9, v9, v186
    v_add_f32 v9, v9, v187
    v_cvt_pk_bf16_f32 v89, v186, v187
    v_exp_f32 v188, v188
    v_exp_f32 v189, v189
    v_add_f32 v10, v10, v188
    v_add_f32 v10, v10, v189
    v_cvt_pk_bf16_f32 v92, v188, v189
    v_exp_f32 v190, v190
    v_exp_f32 v191, v191
    v_add_f32 v10, v10, v190
    v_add_f32 v10, v10, v191
    v_cvt_pk_bf16_f32 v93, v190, v191
    v_exp_f32 v192, v192
    v_exp_f32 v193, v193
    v_add_f32 v9, v9, v192
    v_add_f32 v9, v9, v193
    v_cvt_pk_bf16_f32 v90, v192, v193
    v_exp_f32 v194, v194
    v_exp_f32 v195, v195
    v_add_f32 v9, v9, v194
    v_add_f32 v9, v9, v195
    v_cvt_pk_bf16_f32 v91, v194, v195
    v_exp_f32 v196, v196
    v_exp_f32 v197, v197
    v_add_f32 v10, v10, v196
    v_add_f32 v10, v10, v197
    v_cvt_pk_bf16_f32 v94, v196, v197
    v_exp_f32 v198, v198
    v_exp_f32 v199, v199
    v_add_f32 v10, v10, v198
    v_add_f32 v10, v10, v199
    v_cvt_pk_bf16_f32 v95, v198, v199
    s_mov_b32 s17, 0x12000
    buffer_load_dwordx4 v[200:203], v8, s[8:11], s17 offen offset:0
    buffer_load_dwordx4 v[204:207], v8, s[8:11], s17 offen offset:1024
    buffer_load_dwordx4 v[208:211], v8, s[8:11], s17 offen offset:2048
    buffer_load_dwordx4 v[212:215], v8, s[8:11], s17 offen offset:3072
    s_waitcnt vmcnt(3)
    v_mfma_f32_16x16x32_bf16 v[184:187], v[200:203], v[152:155], v[216:219]
    v_mfma_f32_16x16x32_bf16 v[188:191], v[200:203], v[168:171], v[220:223]
    s_waitcnt vmcnt(2)
    v_mfma_f32_16x16x32_bf16 v[192:195], v[204:207], v[152:155], v[216:219]
    v_mfma_f32_16x16x32_bf16 v[196:199], v[204:207], v[168:171], v[220:223]
    s_waitcnt vmcnt(1)
    v_mfma_f32_16x16x32_bf16 v[184:187], v[208:211], v[156:159], v[184:187]
    v_mfma_f32_16x16x32_bf16 v[188:191], v[208:211], v[172:175], v[188:191]
    s_waitcnt vmcnt(0)
    v_mfma_f32_16x16x32_bf16 v[192:195], v[212:215], v[156:159], v[192:195]
    v_mfma_f32_16x16x32_bf16 v[196:199], v[212:215], v[172:175], v[196:199]
    s_mov_b32 s17, 0x13000
    buffer_load_dwordx4 v[200:203], v8, s[8:11], s17 offen offset:0
    buffer_load_dwordx4 v[204:207], v8, s[8:11], s17 offen offset:1024
    buffer_load_dwordx4 v[208:211], v8, s[8:11], s17 offen offset:2048
    buffer_load_dwordx4 v[212:215], v8, s[8:11], s17 offen offset:3072
    s_waitcnt vmcnt(3)
    v_mfma_f32_16x16x32_bf16 v[184:187], v[200:203], v[160:163], v[184:187]
    v_mfma_f32_16x16x32_bf16 v[188:191], v[200:203], v[176:179], v[188:191]
    s_waitcnt vmcnt(2)
    v_mfma_f32_16x16x32_bf16 v[192:195], v[204:207], v[160:163], v[192:195]
    v_mfma_f32_16x16x32_bf16 v[196:199], v[204:207], v[176:179], v[196:199]
    s_waitcnt vmcnt(1)
    v_mfma_f32_16x16x32_bf16 v[184:187], v[208:211], v[164:167], v[184:187]
    v_mfma_f32_16x16x32_bf16 v[188:191], v[208:211], v[180:183], v[188:191]
    s_waitcnt vmcnt(0)
    v_mfma_f32_16x16x32_bf16 v[192:195], v[212:215], v[164:167], v[192:195]
    v_mfma_f32_16x16x32_bf16 v[196:199], v[212:215], v[180:183], v[196:199]
    s_nop 3
    v_exp_f32 v184, v184
    v_exp_f32 v185, v185
    v_add_f32 v9, v9, v184
    v_add_f32 v9, v9, v185
    v_cvt_pk_bf16_f32 v96, v184, v185
    v_exp_f32 v186, v186
    v_exp_f32 v187, v187
    v_add_f32 v9, v9, v186
    v_add_f32 v9, v9, v187
    v_cvt_pk_bf16_f32 v97, v186, v187
    v_exp_f32 v188, v188
    v_exp_f32 v189, v189
    v_add_f32 v10, v10, v188
    v_add_f32 v10, v10, v189
    v_cvt_pk_bf16_f32 v100, v188, v189
    v_exp_f32 v190, v190
    v_exp_f32 v191, v191
    v_add_f32 v10, v10, v190
    v_add_f32 v10, v10, v191
    v_cvt_pk_bf16_f32 v101, v190, v191
    v_exp_f32 v192, v192
    v_exp_f32 v193, v193
    v_add_f32 v9, v9, v192
    v_add_f32 v9, v9, v193
    v_cvt_pk_bf16_f32 v98, v192, v193
    v_exp_f32 v194, v194
    v_exp_f32 v195, v195
    v_add_f32 v9, v9, v194
    v_add_f32 v9, v9, v195
    v_cvt_pk_bf16_f32 v99, v194, v195
    v_exp_f32 v196, v196
    v_exp_f32 v197, v197
    v_add_f32 v10, v10, v196
    v_add_f32 v10, v10, v197
    v_cvt_pk_bf16_f32 v102, v196, v197
    v_exp_f32 v198, v198
    v_exp_f32 v199, v199
    v_add_f32 v10, v10, v198
    v_add_f32 v10, v10, v199
    v_cvt_pk_bf16_f32 v103, v198, v199
    s_mov_b32 s17, 0x14000
    buffer_load_dwordx4 v[200:203], v8, s[8:11], s17 offen offset:0
    buffer_load_dwordx4 v[204:207], v8, s[8:11], s17 offen offset:1024
    buffer_load_dwordx4 v[208:211], v8, s[8:11], s17 offen offset:2048
    buffer_load_dwordx4 v[212:215], v8, s[8:11], s17 offen offset:3072
    s_waitcnt vmcnt(3)
    v_mfma_f32_16x16x32_bf16 v[184:187], v[200:203], v[152:155], v[216:219]
    v_mfma_f32_16x16x32_bf16 v[188:191], v[200:203], v[168:171], v[220:223]
    s_waitcnt vmcnt(2)
    v_mfma_f32_16x16x32_bf16 v[192:195], v[204:207], v[152:155], v[216:219]
    v_mfma_f32_16x16x32_bf16 v[196:199], v[204:207], v[168:171], v[220:223]
    s_waitcnt vmcnt(1)
    v_mfma_f32_16x16x32_bf16 v[184:187], v[208:211], v[156:159], v[184:187]
    v_mfma_f32_16x16x32_bf16 v[188:191], v[208:211], v[172:175], v[188:191]
    s_waitcnt vmcnt(0)
    v_mfma_f32_16x16x32_bf16 v[192:195], v[212:215], v[156:159], v[192:195]
    v_mfma_f32_16x16x32_bf16 v[196:199], v[212:215], v[172:175], v[196:199]
    s_mov_b32 s17, 0x15000
    buffer_load_dwordx4 v[200:203], v8, s[8:11], s17 offen offset:0
    buffer_load_dwordx4 v[204:207], v8, s[8:11], s17 offen offset:1024
    buffer_load_dwordx4 v[208:211], v8, s[8:11], s17 offen offset:2048
    buffer_load_dwordx4 v[212:215], v8, s[8:11], s17 offen offset:3072
    s_waitcnt vmcnt(3)
    v_mfma_f32_16x16x32_bf16 v[184:187], v[200:203], v[160:163], v[184:187]
    v_mfma_f32_16x16x32_bf16 v[188:191], v[200:203], v[176:179], v[188:191]
    s_waitcnt vmcnt(2)
    v_mfma_f32_16x16x32_bf16 v[192:195], v[204:207], v[160:163], v[192:195]
    v_mfma_f32_16x16x32_bf16 v[196:199], v[204:207], v[176:179], v[196:199]
    s_waitcnt vmcnt(1)
    v_mfma_f32_16x16x32_bf16 v[184:187], v[208:211], v[164:167], v[184:187]
    v_mfma_f32_16x16x32_bf16 v[188:191], v[208:211], v[180:183], v[188:191]
    s_waitcnt vmcnt(0)
    v_mfma_f32_16x16x32_bf16 v[192:195], v[212:215], v[164:167], v[192:195]
    v_mfma_f32_16x16x32_bf16 v[196:199], v[212:215], v[180:183], v[196:199]
    s_nop 3
    v_exp_f32 v184, v184
    v_exp_f32 v185, v185
    v_add_f32 v9, v9, v184
    v_add_f32 v9, v9, v185
    v_cvt_pk_bf16_f32 v104, v184, v185
    v_exp_f32 v186, v186
    v_exp_f32 v187, v187
    v_add_f32 v9, v9, v186
    v_add_f32 v9, v9, v187
    v_cvt_pk_bf16_f32 v105, v186, v187
    v_exp_f32 v188, v188
    v_exp_f32 v189, v189
    v_add_f32 v10, v10, v188
    v_add_f32 v10, v10, v189
    v_cvt_pk_bf16_f32 v108, v188, v189
    v_exp_f32 v190, v190
    v_exp_f32 v191, v191
    v_add_f32 v10, v10, v190
    v_add_f32 v10, v10, v191
    v_cvt_pk_bf16_f32 v109, v190, v191
    v_exp_f32 v192, v192
    v_exp_f32 v193, v193
    v_add_f32 v9, v9, v192
    v_add_f32 v9, v9, v193
    v_cvt_pk_bf16_f32 v106, v192, v193
    v_exp_f32 v194, v194
    v_exp_f32 v195, v195
    v_add_f32 v9, v9, v194
    v_add_f32 v9, v9, v195
    v_cvt_pk_bf16_f32 v107, v194, v195
    v_exp_f32 v196, v196
    v_exp_f32 v197, v197
    v_add_f32 v10, v10, v196
    v_add_f32 v10, v10, v197
    v_cvt_pk_bf16_f32 v110, v196, v197
    v_exp_f32 v198, v198
    v_exp_f32 v199, v199
    v_add_f32 v10, v10, v198
    v_add_f32 v10, v10, v199
    v_cvt_pk_bf16_f32 v111, v198, v199
    s_mov_b32 s17, 0x16000
    buffer_load_dwordx4 v[200:203], v8, s[8:11], s17 offen offset:0
    buffer_load_dwordx4 v[204:207], v8, s[8:11], s17 offen offset:1024
    buffer_load_dwordx4 v[208:211], v8, s[8:11], s17 offen offset:2048
    buffer_load_dwordx4 v[212:215], v8, s[8:11], s17 offen offset:3072
    s_waitcnt vmcnt(3)
    v_mfma_f32_16x16x32_bf16 v[184:187], v[200:203], v[152:155], v[216:219]
    v_mfma_f32_16x16x32_bf16 v[188:191], v[200:203], v[168:171], v[220:223]
    s_waitcnt vmcnt(2)
    v_mfma_f32_16x16x32_bf16 v[192:195], v[204:207], v[152:155], v[216:219]
    v_mfma_f32_16x16x32_bf16 v[196:199], v[204:207], v[168:171], v[220:223]
    s_waitcnt vmcnt(1)
    v_mfma_f32_16x16x32_bf16 v[184:187], v[208:211], v[156:159], v[184:187]
    v_mfma_f32_16x16x32_bf16 v[188:191], v[208:211], v[172:175], v[188:191]
    s_waitcnt vmcnt(0)
    v_mfma_f32_16x16x32_bf16 v[192:195], v[212:215], v[156:159], v[192:195]
    v_mfma_f32_16x16x32_bf16 v[196:199], v[212:215], v[172:175], v[196:199]
    s_mov_b32 s17, 0x17000
    buffer_load_dwordx4 v[200:203], v8, s[8:11], s17 offen offset:0
    buffer_load_dwordx4 v[204:207], v8, s[8:11], s17 offen offset:1024
    buffer_load_dwordx4 v[208:211], v8, s[8:11], s17 offen offset:2048
    buffer_load_dwordx4 v[212:215], v8, s[8:11], s17 offen offset:3072
    s_waitcnt vmcnt(3)
    v_mfma_f32_16x16x32_bf16 v[184:187], v[200:203], v[160:163], v[184:187]
    v_mfma_f32_16x16x32_bf16 v[188:191], v[200:203], v[176:179], v[188:191]
    s_waitcnt vmcnt(2)
    v_mfma_f32_16x16x32_bf16 v[192:195], v[204:207], v[160:163], v[192:195]
    v_mfma_f32_16x16x32_bf16 v[196:199], v[204:207], v[176:179], v[196:199]
    s_waitcnt vmcnt(1)
    v_mfma_f32_16x16x32_bf16 v[184:187], v[208:211], v[164:167], v[184:187]
    v_mfma_f32_16x16x32_bf16 v[188:191], v[208:211], v[180:183], v[188:191]
    s_waitcnt vmcnt(0)
    v_mfma_f32_16x16x32_bf16 v[192:195], v[212:215], v[164:167], v[192:195]
    v_mfma_f32_16x16x32_bf16 v[196:199], v[212:215], v[180:183], v[196:199]
    s_nop 3
    v_exp_f32 v184, v184
    v_exp_f32 v185, v185
    v_add_f32 v9, v9, v184
    v_add_f32 v9, v9, v185
    v_cvt_pk_bf16_f32 v112, v184, v185
    v_exp_f32 v186, v186
    v_exp_f32 v187, v187
    v_add_f32 v9, v9, v186
    v_add_f32 v9, v9, v187
    v_cvt_pk_bf16_f32 v113, v186, v187
    v_exp_f32 v188, v188
    v_exp_f32 v189, v189
    v_add_f32 v10, v10, v188
    v_add_f32 v10, v10, v189
    v_cvt_pk_bf16_f32 v116, v188, v189
    v_exp_f32 v190, v190
    v_exp_f32 v191, v191
    v_add_f32 v10, v10, v190
    v_add_f32 v10, v10, v191
    v_cvt_pk_bf16_f32 v117, v190, v191
    v_exp_f32 v192, v192
    v_exp_f32 v193, v193
    v_add_f32 v9, v9, v192
    v_add_f32 v9, v9, v193
    v_cvt_pk_bf16_f32 v114, v192, v193
    v_exp_f32 v194, v194
    v_exp_f32 v195, v195
    v_add_f32 v9, v9, v194
    v_add_f32 v9, v9, v195
    v_cvt_pk_bf16_f32 v115, v194, v195
    v_exp_f32 v196, v196
    v_exp_f32 v197, v197
    v_add_f32 v10, v10, v196
    v_add_f32 v10, v10, v197
    v_cvt_pk_bf16_f32 v118, v196, v197
    v_exp_f32 v198, v198
    v_exp_f32 v199, v199
    v_add_f32 v10, v10, v198
    v_add_f32 v10, v10, v199
    v_cvt_pk_bf16_f32 v119, v198, v199
    s_mov_b32 s17, 0x18000
    buffer_load_dwordx4 v[200:203], v8, s[8:11], s17 offen offset:0
    buffer_load_dwordx4 v[204:207], v8, s[8:11], s17 offen offset:1024
    buffer_load_dwordx4 v[208:211], v8, s[8:11], s17 offen offset:2048
    buffer_load_dwordx4 v[212:215], v8, s[8:11], s17 offen offset:3072
    s_waitcnt vmcnt(3)
    v_mfma_f32_16x16x32_bf16 v[184:187], v[200:203], v[152:155], v[216:219]
    v_mfma_f32_16x16x32_bf16 v[188:191], v[200:203], v[168:171], v[220:223]
    s_waitcnt vmcnt(2)
    v_mfma_f32_16x16x32_bf16 v[192:195], v[204:207], v[152:155], v[216:219]
    v_mfma_f32_16x16x32_bf16 v[196:199], v[204:207], v[168:171], v[220:223]
    s_waitcnt vmcnt(1)
    v_mfma_f32_16x16x32_bf16 v[184:187], v[208:211], v[156:159], v[184:187]
    v_mfma_f32_16x16x32_bf16 v[188:191], v[208:211], v[172:175], v[188:191]
    s_waitcnt vmcnt(0)
    v_mfma_f32_16x16x32_bf16 v[192:195], v[212:215], v[156:159], v[192:195]
    v_mfma_f32_16x16x32_bf16 v[196:199], v[212:215], v[172:175], v[196:199]
    s_mov_b32 s17, 0x19000
    buffer_load_dwordx4 v[200:203], v8, s[8:11], s17 offen offset:0
    buffer_load_dwordx4 v[204:207], v8, s[8:11], s17 offen offset:1024
    buffer_load_dwordx4 v[208:211], v8, s[8:11], s17 offen offset:2048
    buffer_load_dwordx4 v[212:215], v8, s[8:11], s17 offen offset:3072
    s_waitcnt vmcnt(3)
    v_mfma_f32_16x16x32_bf16 v[184:187], v[200:203], v[160:163], v[184:187]
    v_mfma_f32_16x16x32_bf16 v[188:191], v[200:203], v[176:179], v[188:191]
    s_waitcnt vmcnt(2)
    v_mfma_f32_16x16x32_bf16 v[192:195], v[204:207], v[160:163], v[192:195]
    v_mfma_f32_16x16x32_bf16 v[196:199], v[204:207], v[176:179], v[196:199]
    s_waitcnt vmcnt(1)
    v_mfma_f32_16x16x32_bf16 v[184:187], v[208:211], v[164:167], v[184:187]
    v_mfma_f32_16x16x32_bf16 v[188:191], v[208:211], v[180:183], v[188:191]
    s_waitcnt vmcnt(0)
    v_mfma_f32_16x16x32_bf16 v[192:195], v[212:215], v[164:167], v[192:195]
    v_mfma_f32_16x16x32_bf16 v[196:199], v[212:215], v[180:183], v[196:199]
    s_nop 3
    v_exp_f32 v184, v184
    v_exp_f32 v185, v185
    v_add_f32 v9, v9, v184
    v_add_f32 v9, v9, v185
    v_cvt_pk_bf16_f32 v120, v184, v185
    v_exp_f32 v186, v186
    v_exp_f32 v187, v187
    v_add_f32 v9, v9, v186
    v_add_f32 v9, v9, v187
    v_cvt_pk_bf16_f32 v121, v186, v187
    v_exp_f32 v188, v188
    v_exp_f32 v189, v189
    v_add_f32 v10, v10, v188
    v_add_f32 v10, v10, v189
    v_cvt_pk_bf16_f32 v124, v188, v189
    v_exp_f32 v190, v190
    v_exp_f32 v191, v191
    v_add_f32 v10, v10, v190
    v_add_f32 v10, v10, v191
    v_cvt_pk_bf16_f32 v125, v190, v191
    v_exp_f32 v192, v192
    v_exp_f32 v193, v193
    v_add_f32 v9, v9, v192
    v_add_f32 v9, v9, v193
    v_cvt_pk_bf16_f32 v122, v192, v193
    v_exp_f32 v194, v194
    v_exp_f32 v195, v195
    v_add_f32 v9, v9, v194
    v_add_f32 v9, v9, v195
    v_cvt_pk_bf16_f32 v123, v194, v195
    v_exp_f32 v196, v196
    v_exp_f32 v197, v197
    v_add_f32 v10, v10, v196
    v_add_f32 v10, v10, v197
    v_cvt_pk_bf16_f32 v126, v196, v197
    v_exp_f32 v198, v198
    v_exp_f32 v199, v199
    v_add_f32 v10, v10, v198
    v_add_f32 v10, v10, v199
    v_cvt_pk_bf16_f32 v127, v198, v199
    s_mov_b32 s17, 0x1a000
    buffer_load_dwordx4 v[200:203], v8, s[8:11], s17 offen offset:0
    buffer_load_dwordx4 v[204:207], v8, s[8:11], s17 offen offset:1024
    buffer_load_dwordx4 v[208:211], v8, s[8:11], s17 offen offset:2048
    buffer_load_dwordx4 v[212:215], v8, s[8:11], s17 offen offset:3072
    s_waitcnt vmcnt(3)
    v_mfma_f32_16x16x32_bf16 v[184:187], v[200:203], v[152:155], v[216:219]
    v_mfma_f32_16x16x32_bf16 v[188:191], v[200:203], v[168:171], v[220:223]
    s_waitcnt vmcnt(2)
    v_mfma_f32_16x16x32_bf16 v[192:195], v[204:207], v[152:155], v[216:219]
    v_mfma_f32_16x16x32_bf16 v[196:199], v[204:207], v[168:171], v[220:223]
    s_waitcnt vmcnt(1)
    v_mfma_f32_16x16x32_bf16 v[184:187], v[208:211], v[156:159], v[184:187]
    v_mfma_f32_16x16x32_bf16 v[188:191], v[208:211], v[172:175], v[188:191]
    s_waitcnt vmcnt(0)
    v_mfma_f32_16x16x32_bf16 v[192:195], v[212:215], v[156:159], v[192:195]
    v_mfma_f32_16x16x32_bf16 v[196:199], v[212:215], v[172:175], v[196:199]
    s_mov_b32 s17, 0x1b000
    buffer_load_dwordx4 v[200:203], v8, s[8:11], s17 offen offset:0
    buffer_load_dwordx4 v[204:207], v8, s[8:11], s17 offen offset:1024
    buffer_load_dwordx4 v[208:211], v8, s[8:11], s17 offen offset:2048
    buffer_load_dwordx4 v[212:215], v8, s[8:11], s17 offen offset:3072
    s_waitcnt vmcnt(3)
    v_mfma_f32_16x16x32_bf16 v[184:187], v[200:203], v[160:163], v[184:187]
    v_mfma_f32_16x16x32_bf16 v[188:191], v[200:203], v[176:179], v[188:191]
    s_waitcnt vmcnt(2)
    v_mfma_f32_16x16x32_bf16 v[192:195], v[204:207], v[160:163], v[192:195]
    v_mfma_f32_16x16x32_bf16 v[196:199], v[204:207], v[176:179], v[196:199]
    s_waitcnt vmcnt(1)
    v_mfma_f32_16x16x32_bf16 v[184:187], v[208:211], v[164:167], v[184:187]
    v_mfma_f32_16x16x32_bf16 v[188:191], v[208:211], v[180:183], v[188:191]
    s_waitcnt vmcnt(0)
    v_mfma_f32_16x16x32_bf16 v[192:195], v[212:215], v[164:167], v[192:195]
    v_mfma_f32_16x16x32_bf16 v[196:199], v[212:215], v[180:183], v[196:199]
    s_nop 3
    v_exp_f32 v184, v184
    v_exp_f32 v185, v185
    v_add_f32 v9, v9, v184
    v_add_f32 v9, v9, v185
    v_cvt_pk_bf16_f32 v128, v184, v185
    v_exp_f32 v186, v186
    v_exp_f32 v187, v187
    v_add_f32 v9, v9, v186
    v_add_f32 v9, v9, v187
    v_cvt_pk_bf16_f32 v129, v186, v187
    v_exp_f32 v188, v188
    v_exp_f32 v189, v189
    v_add_f32 v10, v10, v188
    v_add_f32 v10, v10, v189
    v_cvt_pk_bf16_f32 v132, v188, v189
    v_exp_f32 v190, v190
    v_exp_f32 v191, v191
    v_add_f32 v10, v10, v190
    v_add_f32 v10, v10, v191
    v_cvt_pk_bf16_f32 v133, v190, v191
    v_exp_f32 v192, v192
    v_exp_f32 v193, v193
    v_add_f32 v9, v9, v192
    v_add_f32 v9, v9, v193
    v_cvt_pk_bf16_f32 v130, v192, v193
    v_exp_f32 v194, v194
    v_exp_f32 v195, v195
    v_add_f32 v9, v9, v194
    v_add_f32 v9, v9, v195
    v_cvt_pk_bf16_f32 v131, v194, v195
    v_exp_f32 v196, v196
    v_exp_f32 v197, v197
    v_add_f32 v10, v10, v196
    v_add_f32 v10, v10, v197
    v_cvt_pk_bf16_f32 v134, v196, v197
    v_exp_f32 v198, v198
    v_exp_f32 v199, v199
    v_add_f32 v10, v10, v198
    v_add_f32 v10, v10, v199
    v_cvt_pk_bf16_f32 v135, v198, v199
    s_mov_b32 s17, 0x1c000
    buffer_load_dwordx4 v[200:203], v8, s[8:11], s17 offen offset:0
    buffer_load_dwordx4 v[204:207], v8, s[8:11], s17 offen offset:1024
    buffer_load_dwordx4 v[208:211], v8, s[8:11], s17 offen offset:2048
    buffer_load_dwordx4 v[212:215], v8, s[8:11], s17 offen offset:3072
    s_waitcnt vmcnt(3)
    v_mfma_f32_16x16x32_bf16 v[184:187], v[200:203], v[152:155], v[216:219]
    v_mfma_f32_16x16x32_bf16 v[188:191], v[200:203], v[168:171], v[220:223]
    s_waitcnt vmcnt(2)
    v_mfma_f32_16x16x32_bf16 v[192:195], v[204:207], v[152:155], v[216:219]
    v_mfma_f32_16x16x32_bf16 v[196:199], v[204:207], v[168:171], v[220:223]
    s_waitcnt vmcnt(1)
    v_mfma_f32_16x16x32_bf16 v[184:187], v[208:211], v[156:159], v[184:187]
    v_mfma_f32_16x16x32_bf16 v[188:191], v[208:211], v[172:175], v[188:191]
    s_waitcnt vmcnt(0)
    v_mfma_f32_16x16x32_bf16 v[192:195], v[212:215], v[156:159], v[192:195]
    v_mfma_f32_16x16x32_bf16 v[196:199], v[212:215], v[172:175], v[196:199]
    s_mov_b32 s17, 0x1d000
    buffer_load_dwordx4 v[200:203], v8, s[8:11], s17 offen offset:0
    buffer_load_dwordx4 v[204:207], v8, s[8:11], s17 offen offset:1024
    buffer_load_dwordx4 v[208:211], v8, s[8:11], s17 offen offset:2048
    buffer_load_dwordx4 v[212:215], v8, s[8:11], s17 offen offset:3072
    s_waitcnt vmcnt(3)
    v_mfma_f32_16x16x32_bf16 v[184:187], v[200:203], v[160:163], v[184:187]
    v_mfma_f32_16x16x32_bf16 v[188:191], v[200:203], v[176:179], v[188:191]
    s_waitcnt vmcnt(2)
    v_mfma_f32_16x16x32_bf16 v[192:195], v[204:207], v[160:163], v[192:195]
    v_mfma_f32_16x16x32_bf16 v[196:199], v[204:207], v[176:179], v[196:199]
    s_waitcnt vmcnt(1)
    v_mfma_f32_16x16x32_bf16 v[184:187], v[208:211], v[164:167], v[184:187]
    v_mfma_f32_16x16x32_bf16 v[188:191], v[208:211], v[180:183], v[188:191]
    s_waitcnt vmcnt(0)
    v_mfma_f32_16x16x32_bf16 v[192:195], v[212:215], v[164:167], v[192:195]
    v_mfma_f32_16x16x32_bf16 v[196:199], v[212:215], v[180:183], v[196:199]
    s_nop 3
    v_exp_f32 v184, v184
    v_exp_f32 v185, v185
    v_add_f32 v9, v9, v184
    v_add_f32 v9, v9, v185
    v_cvt_pk_bf16_f32 v136, v184, v185
    v_exp_f32 v186, v186
    v_exp_f32 v187, v187
    v_add_f32 v9, v9, v186
    v_add_f32 v9, v9, v187
    v_cvt_pk_bf16_f32 v137, v186, v187
    v_exp_f32 v188, v188
    v_exp_f32 v189, v189
    v_add_f32 v10, v10, v188
    v_add_f32 v10, v10, v189
    v_cvt_pk_bf16_f32 v140, v188, v189
    v_exp_f32 v190, v190
    v_exp_f32 v191, v191
    v_add_f32 v10, v10, v190
    v_add_f32 v10, v10, v191
    v_cvt_pk_bf16_f32 v141, v190, v191
    v_exp_f32 v192, v192
    v_exp_f32 v193, v193
    v_add_f32 v9, v9, v192
    v_add_f32 v9, v9, v193
    v_cvt_pk_bf16_f32 v138, v192, v193
    v_exp_f32 v194, v194
    v_exp_f32 v195, v195
    v_add_f32 v9, v9, v194
    v_add_f32 v9, v9, v195
    v_cvt_pk_bf16_f32 v139, v194, v195
    v_exp_f32 v196, v196
    v_exp_f32 v197, v197
    v_add_f32 v10, v10, v196
    v_add_f32 v10, v10, v197
    v_cvt_pk_bf16_f32 v142, v196, v197
    v_exp_f32 v198, v198
    v_exp_f32 v199, v199
    v_add_f32 v10, v10, v198
    v_add_f32 v10, v10, v199
    v_cvt_pk_bf16_f32 v143, v198, v199
    s_mov_b32 s17, 0x1e000
    buffer_load_dwordx4 v[200:203], v8, s[8:11], s17 offen offset:0
    buffer_load_dwordx4 v[204:207], v8, s[8:11], s17 offen offset:1024
    buffer_load_dwordx4 v[208:211], v8, s[8:11], s17 offen offset:2048
    buffer_load_dwordx4 v[212:215], v8, s[8:11], s17 offen offset:3072
    s_waitcnt vmcnt(3)
    v_mfma_f32_16x16x32_bf16 v[184:187], v[200:203], v[152:155], v[216:219]
    v_mfma_f32_16x16x32_bf16 v[188:191], v[200:203], v[168:171], v[220:223]
    s_waitcnt vmcnt(2)
    v_mfma_f32_16x16x32_bf16 v[192:195], v[204:207], v[152:155], v[216:219]
    v_mfma_f32_16x16x32_bf16 v[196:199], v[204:207], v[168:171], v[220:223]
    s_waitcnt vmcnt(1)
    v_mfma_f32_16x16x32_bf16 v[184:187], v[208:211], v[156:159], v[184:187]
    v_mfma_f32_16x16x32_bf16 v[188:191], v[208:211], v[172:175], v[188:191]
    s_waitcnt vmcnt(0)
    v_mfma_f32_16x16x32_bf16 v[192:195], v[212:215], v[156:159], v[192:195]
    v_mfma_f32_16x16x32_bf16 v[196:199], v[212:215], v[172:175], v[196:199]
    s_mov_b32 s17, 0x1f000
    buffer_load_dwordx4 v[200:203], v8, s[8:11], s17 offen offset:0
    buffer_load_dwordx4 v[204:207], v8, s[8:11], s17 offen offset:1024
    buffer_load_dwordx4 v[208:211], v8, s[8:11], s17 offen offset:2048
    buffer_load_dwordx4 v[212:215], v8, s[8:11], s17 offen offset:3072
    s_waitcnt vmcnt(3)
    v_mfma_f32_16x16x32_bf16 v[184:187], v[200:203], v[160:163], v[184:187]
    v_mfma_f32_16x16x32_bf16 v[188:191], v[200:203], v[176:179], v[188:191]
    s_waitcnt vmcnt(2)
    v_mfma_f32_16x16x32_bf16 v[192:195], v[204:207], v[160:163], v[192:195]
    v_mfma_f32_16x16x32_bf16 v[196:199], v[204:207], v[176:179], v[196:199]
    s_waitcnt vmcnt(1)
    v_mfma_f32_16x16x32_bf16 v[184:187], v[208:211], v[164:167], v[184:187]
    v_mfma_f32_16x16x32_bf16 v[188:191], v[208:211], v[180:183], v[188:191]
    s_waitcnt vmcnt(0)
    v_mfma_f32_16x16x32_bf16 v[192:195], v[212:215], v[164:167], v[192:195]
    v_mfma_f32_16x16x32_bf16 v[196:199], v[212:215], v[180:183], v[196:199]
    s_nop 3
    v_exp_f32 v184, v184
    v_exp_f32 v185, v185
    v_add_f32 v9, v9, v184
    v_add_f32 v9, v9, v185
    v_cvt_pk_bf16_f32 v144, v184, v185
    v_exp_f32 v186, v186
    v_exp_f32 v187, v187
    v_add_f32 v9, v9, v186
    v_add_f32 v9, v9, v187
    v_cvt_pk_bf16_f32 v145, v186, v187
    v_exp_f32 v188, v188
    v_exp_f32 v189, v189
    v_add_f32 v10, v10, v188
    v_add_f32 v10, v10, v189
    v_cvt_pk_bf16_f32 v148, v188, v189
    v_exp_f32 v190, v190
    v_exp_f32 v191, v191
    v_add_f32 v10, v10, v190
    v_add_f32 v10, v10, v191
    v_cvt_pk_bf16_f32 v149, v190, v191
    v_exp_f32 v192, v192
    v_exp_f32 v193, v193
    v_add_f32 v9, v9, v192
    v_add_f32 v9, v9, v193
    v_cvt_pk_bf16_f32 v146, v192, v193
    v_exp_f32 v194, v194
    v_exp_f32 v195, v195
    v_add_f32 v9, v9, v194
    v_add_f32 v9, v9, v195
    v_cvt_pk_bf16_f32 v147, v194, v195
    v_exp_f32 v196, v196
    v_exp_f32 v197, v197
    v_add_f32 v10, v10, v196
    v_add_f32 v10, v10, v197
    v_cvt_pk_bf16_f32 v150, v196, v197
    v_exp_f32 v198, v198
    v_exp_f32 v199, v199
    v_add_f32 v10, v10, v198
    v_add_f32 v10, v10, v199
    v_cvt_pk_bf16_f32 v151, v198, v199
    v_mov_b32 v16, v9
    v_mov_b32 v18, v10
    s_nop 0
    v_permlane16_swap_b32 v9, v16
    v_permlane16_swap_b32 v10, v18
    v_add_f32 v9, v9, v16
    v_add_f32 v10, v10, v18
    v_mov_b32 v16, v9
    v_mov_b32 v18, v10
    s_nop 0
    v_permlane32_swap_b32 v9, v16
    v_permlane32_swap_b32 v10, v18
    v_add_f32 v9, v9, v16
    v_add_f32 v10, v10, v18
    s_waitcnt vmcnt(0) lgkmcnt(0)
    s_nop 15
    s_nop 3
    s_branch adaLN_cond__sliding_block_cached__moe_arch_mod__prompt_kernel_fixAb
adaLN_cond__sliding_block_cached__moe_arch_mod__prompt_kernel_mp5r:
    s_waitcnt vmcnt(0) lgkmcnt(0)
    s_nop 15
    s_nop 3
    s_mov_b32 s27, 0
adaLN_cond__sliding_block_cached__moe_arch_mod__prompt_kernel_mp5p:
    buffer_load_dword v248, v250, s[8:11], s14 offen sc1
    s_waitcnt vmcnt(0)
    v_cmp_ne_u32 vcc, s28, v248
    s_add_u32 s27, s27, 1
    s_cmp_ge_u32 s27, 65536
    s_cbranch_scc1 adaLN_cond__sliding_block_cached__moe_arch_mod__prompt_kernel_mp5g
    s_cbranch_vccnz adaLN_cond__sliding_block_cached__moe_arch_mod__prompt_kernel_mp5p
adaLN_cond__sliding_block_cached__moe_arch_mod__prompt_kernel_mp5g:
    s_waitcnt vmcnt(0) lgkmcnt(0)
    s_nop 15
    s_nop 3
    s_branch adaLN_cond__sliding_block_cached__moe_arch_mod__prompt_kernel_mp5b
adaLN_cond__sliding_block_cached__moe_arch_mod__prompt_kernel_o6r:
    s_waitcnt vmcnt(0) lgkmcnt(0)
    s_nop 15
    s_nop 3
    s_mov_b32 s27, 0
adaLN_cond__sliding_block_cached__moe_arch_mod__prompt_kernel_o6p:
    buffer_load_dword v12, v13, s[8:11], s19 offen sc1
    s_waitcnt vmcnt(0)
    v_cmp_ne_u32 vcc, s28, v12
    s_add_u32 s27, s27, 1
    s_cmp_ge_u32 s27, 65536
    s_cbranch_scc1 adaLN_cond__sliding_block_cached__moe_arch_mod__prompt_kernel_o6g
    s_cbranch_vccnz adaLN_cond__sliding_block_cached__moe_arch_mod__prompt_kernel_o6p
adaLN_cond__sliding_block_cached__moe_arch_mod__prompt_kernel_o6g:
    s_waitcnt vmcnt(0) lgkmcnt(0)
    s_nop 15
    s_nop 3
    s_branch adaLN_cond__sliding_block_cached__moe_arch_mod__prompt_kernel_o6b
adaLN_cond__sliding_block_cached__moe_arch_mod__prompt_kernel_o27r:
    s_waitcnt vmcnt(0) lgkmcnt(0)
    s_nop 15
    s_nop 3
    s_mov_b32 s27, 0
adaLN_cond__sliding_block_cached__moe_arch_mod__prompt_kernel_o27p:
    buffer_load_dword v12, v13, s[8:11], s19 offen sc1
    s_waitcnt vmcnt(0)
    v_cmp_ne_u32 vcc, s28, v12
    s_add_u32 s27, s27, 1
    s_cmp_ge_u32 s27, 65536
    s_cbranch_scc1 adaLN_cond__sliding_block_cached__moe_arch_mod__prompt_kernel_o27g
    s_cbranch_vccnz adaLN_cond__sliding_block_cached__moe_arch_mod__prompt_kernel_o27p
adaLN_cond__sliding_block_cached__moe_arch_mod__prompt_kernel_o27g:
    s_waitcnt vmcnt(0) lgkmcnt(0)
    s_nop 15
    s_nop 3
    s_branch adaLN_cond__sliding_block_cached__moe_arch_mod__prompt_kernel_o27b
adaLN_cond__sliding_block_cached__moe_arch_mod__prompt_kernel_o28r:
    s_waitcnt vmcnt(0) lgkmcnt(0)
    s_nop 15
    s_nop 3
    s_mov_b32 s27, 0
adaLN_cond__sliding_block_cached__moe_arch_mod__prompt_kernel_o28p:
    buffer_load_dword v12, v13, s[8:11], s19 offen sc1
    s_waitcnt vmcnt(0)
    v_cmp_ne_u32 vcc, s28, v12
    s_add_u32 s27, s27, 1
    s_cmp_ge_u32 s27, 65536
    s_cbranch_scc1 adaLN_cond__sliding_block_cached__moe_arch_mod__prompt_kernel_o28g
    s_cbranch_vccnz adaLN_cond__sliding_block_cached__moe_arch_mod__prompt_kernel_o28p
adaLN_cond__sliding_block_cached__moe_arch_mod__prompt_kernel_o28g:
    s_waitcnt vmcnt(0) lgkmcnt(0)
    s_nop 15
    s_nop 3
    s_branch adaLN_cond__sliding_block_cached__moe_arch_mod__prompt_kernel_o28b
adaLN_cond__sliding_block_cached__moe_arch_mod__prompt_kernel_o29r:
    s_waitcnt vmcnt(0) lgkmcnt(0)
    s_nop 15
    s_nop 3
    s_mov_b32 s27, 0
adaLN_cond__sliding_block_cached__moe_arch_mod__prompt_kernel_o29p:
    buffer_load_dword v12, v13, s[8:11], s19 offen sc1
    s_waitcnt vmcnt(0)
    v_cmp_ne_u32 vcc, s28, v12
    s_add_u32 s27, s27, 1
    s_cmp_ge_u32 s27, 65536
    s_cbranch_scc1 adaLN_cond__sliding_block_cached__moe_arch_mod__prompt_kernel_o29g
    s_cbranch_vccnz adaLN_cond__sliding_block_cached__moe_arch_mod__prompt_kernel_o29p
adaLN_cond__sliding_block_cached__moe_arch_mod__prompt_kernel_o29g:
    s_waitcnt vmcnt(0) lgkmcnt(0)
    s_nop 15
    s_nop 3
    s_branch adaLN_cond__sliding_block_cached__moe_arch_mod__prompt_kernel_o29b
adaLN_cond__sliding_block_cached__moe_arch_mod__prompt_kernel_mf10r:
    s_waitcnt vmcnt(0) lgkmcnt(0)
    s_nop 15
    s_nop 3
    s_mov_b32 s27, 0
adaLN_cond__sliding_block_cached__moe_arch_mod__prompt_kernel_mf10p:
    s_mov_b32 s16, 0x544000
    buffer_load_dwordx4 v[184:187], v2, s[8:11], s16 offen sc1
    s_waitcnt vmcnt(0)
    v_xor_b32 v16, s28, v184
    v_xor_b32 v17, s28, v185
    v_xor_b32 v18, s28, v186
    v_xor_b32 v19, s28, v187
    v_or3_b32 v16, v16, v17, v18
    v_or_b32 v16, v16, v19
    v_cmp_ne_u32 vcc, 0, v16
    s_add_u32 s27, s27, 1
    s_cmp_ge_u32 s27, 65536
    s_cbranch_scc1 adaLN_cond__sliding_block_cached__moe_arch_mod__prompt_kernel_mf10g
    s_cbranch_vccnz adaLN_cond__sliding_block_cached__moe_arch_mod__prompt_kernel_mf10p
adaLN_cond__sliding_block_cached__moe_arch_mod__prompt_kernel_mf10g:
    s_waitcnt vmcnt(0) lgkmcnt(0)
    s_nop 15
    s_nop 3
    s_branch adaLN_cond__sliding_block_cached__moe_arch_mod__prompt_kernel_mf10b
adaLN_cond__sliding_block_cached__moe_arch_mod__prompt_kernel_kv16r:
    s_waitcnt vmcnt(0) lgkmcnt(0)
    s_nop 15
    s_nop 3
    s_mov_b32 s27, 0
adaLN_cond__sliding_block_cached__moe_arch_mod__prompt_kernel_kv16p:
    buffer_load_dwordx4 v[12:15], v21, s[8:11], s18 offen sc1
    s_waitcnt vmcnt(0)
    v_xor_b32 v8, s28, v12
    v_xor_b32 v20, s28, v13
    v_or_b32 v8, v8, v20
    v_xor_b32 v20, s28, v14
    v_or_b32 v8, v8, v20
    v_xor_b32 v20, s28, v15
    v_or_b32 v8, v8, v20
    v_cmp_ne_u32 vcc, 0, v8
    s_add_u32 s27, s27, 1
    s_cmp_ge_u32 s27, 65536
    s_cbranch_scc1 adaLN_cond__sliding_block_cached__moe_arch_mod__prompt_kernel_kv16g
    s_cbranch_vccnz adaLN_cond__sliding_block_cached__moe_arch_mod__prompt_kernel_kv16p
adaLN_cond__sliding_block_cached__moe_arch_mod__prompt_kernel_kv16g:
    s_waitcnt vmcnt(0) lgkmcnt(0)
    s_nop 15
    s_nop 3
    s_branch adaLN_cond__sliding_block_cached__moe_arch_mod__prompt_kernel_kv16b
adaLN_cond__sliding_block_cached__moe_arch_mod__prompt_kernel_fixB:
    s_waitcnt vmcnt(0) lgkmcnt(0)
    s_nop 15
    s_nop 3
    s_lshr_b32 s16, s12, 3
    s_lshl_b32 s16, s16, 17
    s_add_u32 s16, s16, 0x400000
    v_add_u32 v8, s16, v2
    v_mov_b32 v16, 0xff7fffff
    v_mov_b32 v17, 0xff7fffff
    s_mov_b32 s16, 0
adaLN_cond__sliding_block_cached__moe_arch_mod__prompt_kernel_fixBm:
    s_add_u32 s17, s16, 0
    buffer_load_dwordx4 v[200:203], v8, s[8:11], s17 offen offset:0
    buffer_load_dwordx4 v[204:207], v8, s[8:11], s17 offen offset:1024
    buffer_load_dwordx4 v[208:211], v8, s[8:11], s17 offen offset:2048
    buffer_load_dwordx4 v[212:215], v8, s[8:11], s17 offen offset:3072
    s_waitcnt vmcnt(3)
    v_mfma_f32_16x16x32_bf16 v[184:187], v[200:203], v[152:155], 0
    v_mfma_f32_16x16x32_bf16 v[188:191], v[200:203], v[168:171], 0
    s_waitcnt vmcnt(2)
    v_mfma_f32_16x16x32_bf16 v[192:195], v[204:207], v[152:155], 0
    v_mfma_f32_16x16x32_bf16 v[196:199], v[204:207], v[168:171], 0
    s_waitcnt vmcnt(1)
    v_mfma_f32_16x16x32_bf16 v[184:187], v[208:211], v[156:159], v[184:187]
    v_mfma_f32_16x16x32_bf16 v[188:191], v[208:211], v[172:175], v[188:191]
    s_waitcnt vmcnt(0)
    v_mfma_f32_16x16x32_bf16 v[192:195], v[212:215], v[156:159], v[192:195]
    v_mfma_f32_16x16x32_bf16 v[196:199], v[212:215], v[172:175], v[196:199]
    s_add_u32 s17, s16, 4096
    buffer_load_dwordx4 v[200:203], v8, s[8:11], s17 offen offset:0
    buffer_load_dwordx4 v[204:207], v8, s[8:11], s17 offen offset:1024
    buffer_load_dwordx4 v[208:211], v8, s[8:11], s17 offen offset:2048
    buffer_load_dwordx4 v[212:215], v8, s[8:11], s17 offen offset:3072
    s_waitcnt vmcnt(3)
    v_mfma_f32_16x16x32_bf16 v[184:187], v[200:203], v[160:163], v[184:187]
    v_mfma_f32_16x16x32_bf16 v[188:191], v[200:203], v[176:179], v[188:191]
    s_waitcnt vmcnt(2)
    v_mfma_f32_16x16x32_bf16 v[192:195], v[204:207], v[160:163], v[192:195]
    v_mfma_f32_16x16x32_bf16 v[196:199], v[204:207], v[176:179], v[196:199]
    s_waitcnt vmcnt(1)
    v_mfma_f32_16x16x32_bf16 v[184:187], v[208:211], v[164:167], v[184:187]
    v_mfma_f32_16x16x32_bf16 v[188:191], v[208:211], v[180:183], v[188:191]
    s_waitcnt vmcnt(0)
    v_mfma_f32_16x16x32_bf16 v[192:195], v[212:215], v[164:167], v[192:195]
    v_mfma_f32_16x16x32_bf16 v[196:199], v[212:215], v[180:183], v[196:199]
    s_nop 3
    v_max3_f32 v16, v16, v184, v185
    v_max3_f32 v16, v16, v186, v187
    v_max3_f32 v17, v17, v188, v189
    v_max3_f32 v17, v17, v190, v191
    v_max3_f32 v16, v16, v192, v193
    v_max3_f32 v16, v16, v194, v195
    v_max3_f32 v17, v17, v196, v197
    v_max3_f32 v17, v17, v198, v199
    s_add_u32 s16, s16, 8192
    s_cmp_lt_u32 s16, 0x20000
    s_cbranch_scc1 adaLN_cond__sliding_block_cached__moe_arch_mod__prompt_kernel_fixBm
    v_mov_b32 v18, v16
    v_mov_b32 v19, v17
    s_nop 0
    v_permlane16_swap_b32 v16, v18
    v_permlane16_swap_b32 v17, v19
    v_max_f32 v16, v16, v18
    v_max_f32 v17, v17, v19
    v_mov_b32 v18, v16
    v_mov_b32 v19, v17
    s_nop 0
    v_permlane32_swap_b32 v16, v18
    v_permlane32_swap_b32 v17, v19
    v_max_f32 v16, v16, v18
    v_max_f32 v17, v17, v19
    v_sub_f32 v216, 0, v16
    v_sub_f32 v217, 0, v16
    v_sub_f32 v218, 0, v16
    v_sub_f32 v219, 0, v16
    v_sub_f32 v220, 0, v17
    v_sub_f32 v221, 0, v17
    v_sub_f32 v222, 0, v17
    v_sub_f32 v223, 0, v17
    s_mov_b32 s17, 0x0
    buffer_load_dwordx4 v[200:203], v8, s[8:11], s17 offen offset:0
    buffer_load_dwordx4 v[204:207], v8, s[8:11], s17 offen offset:1024
    buffer_load_dwordx4 v[208:211], v8, s[8:11], s17 offen offset:2048
    buffer_load_dwordx4 v[212:215], v8, s[8:11], s17 offen offset:3072
    s_waitcnt vmcnt(3)
    v_mfma_f32_16x16x32_bf16 v[184:187], v[200:203], v[152:155], v[216:219]
    v_mfma_f32_16x16x32_bf16 v[188:191], v[200:203], v[168:171], v[220:223]
    s_waitcnt vmcnt(2)
    v_mfma_f32_16x16x32_bf16 v[192:195], v[204:207], v[152:155], v[216:219]
    v_mfma_f32_16x16x32_bf16 v[196:199], v[204:207], v[168:171], v[220:223]
    s_waitcnt vmcnt(1)
    v_mfma_f32_16x16x32_bf16 v[184:187], v[208:211], v[156:159], v[184:187]
    v_mfma_f32_16x16x32_bf16 v[188:191], v[208:211], v[172:175], v[188:191]
    s_waitcnt vmcnt(0)
    v_mfma_f32_16x16x32_bf16 v[192:195], v[212:215], v[156:159], v[192:195]
    v_mfma_f32_16x16x32_bf16 v[196:199], v[212:215], v[172:175], v[196:199]
    s_mov_b32 s17, 0x1000
    buffer_load_dwordx4 v[200:203], v8, s[8:11], s17 offen offset:0
    buffer_load_dwordx4 v[204:207], v8, s[8:11], s17 offen offset:1024
    buffer_load_dwordx4 v[208:211], v8, s[8:11], s17 offen offset:2048
    buffer_load_dwordx4 v[212:215], v8, s[8:11], s17 offen offset:3072
    s_waitcnt vmcnt(3)
    v_mfma_f32_16x16x32_bf16 v[184:187], v[200:203], v[160:163], v[184:187]
    v_mfma_f32_16x16x32_bf16 v[188:191], v[200:203], v[176:179], v[188:191]
    s_waitcnt vmcnt(2)
    v_mfma_f32_16x16x32_bf16 v[192:195], v[204:207], v[160:163], v[192:195]
    v_mfma_f32_16x16x32_bf16 v[196:199], v[204:207], v[176:179], v[196:199]
    s_waitcnt vmcnt(1)
    v_mfma_f32_16x16x32_bf16 v[184:187], v[208:211], v[164:167], v[184:187]
    v_mfma_f32_16x16x32_bf16 v[188:191], v[208:211], v[180:183], v[188:191]
    s_waitcnt vmcnt(0)
    v_mfma_f32_16x16x32_bf16 v[192:195], v[212:215], v[164:167], v[192:195]
    v_mfma_f32_16x16x32_bf16 v[196:199], v[212:215], v[180:183], v[196:199]
    s_nop 3
    v_exp_f32 v184, v184
    v_exp_f32 v185, v185
    s_nop 0
    v_add_f32 v9, v184, v185
    v_cvt_pk_bf16_f32 v24, v184, v185
    v_exp_f32 v186, v186
    v_exp_f32 v187, v187
    v_add_f32 v9, v9, v186
    v_add_f32 v9, v9, v187
    v_cvt_pk_bf16_f32 v25, v186, v187
    v_exp_f32 v188, v188
    v_exp_f32 v189, v189
    s_nop 0
    v_add_f32 v10, v188, v189
    v_cvt_pk_bf16_f32 v28, v188, v189
    v_exp_f32 v190, v190
    v_exp_f32 v191, v191
    v_add_f32 v10, v10, v190
    v_add_f32 v10, v10, v191
    v_cvt_pk_bf16_f32 v29, v190, v191
    v_exp_f32 v192, v192
    v_exp_f32 v193, v193
    v_add_f32 v9, v9, v192
    v_add_f32 v9, v9, v193
    v_cvt_pk_bf16_f32 v26, v192, v193
    v_exp_f32 v194, v194
    v_exp_f32 v195, v195
    v_add_f32 v9, v9, v194
    v_add_f32 v9, v9, v195
    v_cvt_pk_bf16_f32 v27, v194, v195
    v_exp_f32 v196, v196
    v_exp_f32 v197, v197
    v_add_f32 v10, v10, v196
    v_add_f32 v10, v10, v197
    v_cvt_pk_bf16_f32 v30, v196, v197
    v_exp_f32 v198, v198
    v_exp_f32 v199, v199
    v_add_f32 v10, v10, v198
    v_add_f32 v10, v10, v199
    v_cvt_pk_bf16_f32 v31, v198, v199
    s_mov_b32 s17, 0x2000
    buffer_load_dwordx4 v[200:203], v8, s[8:11], s17 offen offset:0
    buffer_load_dwordx4 v[204:207], v8, s[8:11], s17 offen offset:1024
    buffer_load_dwordx4 v[208:211], v8, s[8:11], s17 offen offset:2048
    buffer_load_dwordx4 v[212:215], v8, s[8:11], s17 offen offset:3072
    s_waitcnt vmcnt(3)
    v_mfma_f32_16x16x32_bf16 v[184:187], v[200:203], v[152:155], v[216:219]
    v_mfma_f32_16x16x32_bf16 v[188:191], v[200:203], v[168:171], v[220:223]
    s_waitcnt vmcnt(2)
    v_mfma_f32_16x16x32_bf16 v[192:195], v[204:207], v[152:155], v[216:219]
    v_mfma_f32_16x16x32_bf16 v[196:199], v[204:207], v[168:171], v[220:223]
    s_waitcnt vmcnt(1)
    v_mfma_f32_16x16x32_bf16 v[184:187], v[208:211], v[156:159], v[184:187]
    v_mfma_f32_16x16x32_bf16 v[188:191], v[208:211], v[172:175], v[188:191]
    s_waitcnt vmcnt(0)
    v_mfma_f32_16x16x32_bf16 v[192:195], v[212:215], v[156:159], v[192:195]
    v_mfma_f32_16x16x32_bf16 v[196:199], v[212:215], v[172:175], v[196:199]
    s_mov_b32 s17, 0x3000
    buffer_load_dwordx4 v[200:203], v8, s[8:11], s17 offen offset:0
    buffer_load_dwordx4 v[204:207], v8, s[8:11], s17 offen offset:1024
    buffer_load_dwordx4 v[208:211], v8, s[8:11], s17 offen offset:2048
    buffer_load_dwordx4 v[212:215], v8, s[8:11], s17 offen offset:3072
    s_waitcnt vmcnt(3)
    v_mfma_f32_16x16x32_bf16 v[184:187], v[200:203], v[160:163], v[184:187]
    v_mfma_f32_16x16x32_bf16 v[188:191], v[200:203], v[176:179], v[188:191]
    s_waitcnt vmcnt(2)
    v_mfma_f32_16x16x32_bf16 v[192:195], v[204:207], v[160:163], v[192:195]
    v_mfma_f32_16x16x32_bf16 v[196:199], v[204:207], v[176:179], v[196:199]
    s_waitcnt vmcnt(1)
    v_mfma_f32_16x16x32_bf16 v[184:187], v[208:211], v[164:167], v[184:187]
    v_mfma_f32_16x16x32_bf16 v[188:191], v[208:211], v[180:183], v[188:191]
    s_waitcnt vmcnt(0)
    v_mfma_f32_16x16x32_bf16 v[192:195], v[212:215], v[164:167], v[192:195]
    v_mfma_f32_16x16x32_bf16 v[196:199], v[212:215], v[180:183], v[196:199]
    s_nop 3
    v_exp_f32 v184, v184
    v_exp_f32 v185, v185
    v_add_f32 v9, v9, v184
    v_add_f32 v9, v9, v185
    v_cvt_pk_bf16_f32 v32, v184, v185
    v_exp_f32 v186, v186
    v_exp_f32 v187, v187
    v_add_f32 v9, v9, v186
    v_add_f32 v9, v9, v187
    v_cvt_pk_bf16_f32 v33, v186, v187
    v_exp_f32 v188, v188
    v_exp_f32 v189, v189
    v_add_f32 v10, v10, v188
    v_add_f32 v10, v10, v189
    v_cvt_pk_bf16_f32 v36, v188, v189
    v_exp_f32 v190, v190
    v_exp_f32 v191, v191
    v_add_f32 v10, v10, v190
    v_add_f32 v10, v10, v191
    v_cvt_pk_bf16_f32 v37, v190, v191
    v_exp_f32 v192, v192
    v_exp_f32 v193, v193
    v_add_f32 v9, v9, v192
    v_add_f32 v9, v9, v193
    v_cvt_pk_bf16_f32 v34, v192, v193
    v_exp_f32 v194, v194
    v_exp_f32 v195, v195
    v_add_f32 v9, v9, v194
    v_add_f32 v9, v9, v195
    v_cvt_pk_bf16_f32 v35, v194, v195
    v_exp_f32 v196, v196
    v_exp_f32 v197, v197
    v_add_f32 v10, v10, v196
    v_add_f32 v10, v10, v197
    v_cvt_pk_bf16_f32 v38, v196, v197
    v_exp_f32 v198, v198
    v_exp_f32 v199, v199
    v_add_f32 v10, v10, v198
    v_add_f32 v10, v10, v199
    v_cvt_pk_bf16_f32 v39, v198, v199
    s_mov_b32 s17, 0x4000
    buffer_load_dwordx4 v[200:203], v8, s[8:11], s17 offen offset:0
    buffer_load_dwordx4 v[204:207], v8, s[8:11], s17 offen offset:1024
    buffer_load_dwordx4 v[208:211], v8, s[8:11], s17 offen offset:2048
    buffer_load_dwordx4 v[212:215], v8, s[8:11], s17 offen offset:3072
    s_waitcnt vmcnt(3)
    v_mfma_f32_16x16x32_bf16 v[184:187], v[200:203], v[152:155], v[216:219]
    v_mfma_f32_16x16x32_bf16 v[188:191], v[200:203], v[168:171], v[220:223]
    s_waitcnt vmcnt(2)
    v_mfma_f32_16x16x32_bf16 v[192:195], v[204:207], v[152:155], v[216:219]
    v_mfma_f32_16x16x32_bf16 v[196:199], v[204:207], v[168:171], v[220:223]
    s_waitcnt vmcnt(1)
    v_mfma_f32_16x16x32_bf16 v[184:187], v[208:211], v[156:159], v[184:187]
    v_mfma_f32_16x16x32_bf16 v[188:191], v[208:211], v[172:175], v[188:191]
    s_waitcnt vmcnt(0)
    v_mfma_f32_16x16x32_bf16 v[192:195], v[212:215], v[156:159], v[192:195]
    v_mfma_f32_16x16x32_bf16 v[196:199], v[212:215], v[172:175], v[196:199]
    s_mov_b32 s17, 0x5000
    buffer_load_dwordx4 v[200:203], v8, s[8:11], s17 offen offset:0
    buffer_load_dwordx4 v[204:207], v8, s[8:11], s17 offen offset:1024
    buffer_load_dwordx4 v[208:211], v8, s[8:11], s17 offen offset:2048
    buffer_load_dwordx4 v[212:215], v8, s[8:11], s17 offen offset:3072
    s_waitcnt vmcnt(3)
    v_mfma_f32_16x16x32_bf16 v[184:187], v[200:203], v[160:163], v[184:187]
    v_mfma_f32_16x16x32_bf16 v[188:191], v[200:203], v[176:179], v[188:191]
    s_waitcnt vmcnt(2)
    v_mfma_f32_16x16x32_bf16 v[192:195], v[204:207], v[160:163], v[192:195]
    v_mfma_f32_16x16x32_bf16 v[196:199], v[204:207], v[176:179], v[196:199]
    s_waitcnt vmcnt(1)
    v_mfma_f32_16x16x32_bf16 v[184:187], v[208:211], v[164:167], v[184:187]
    v_mfma_f32_16x16x32_bf16 v[188:191], v[208:211], v[180:183], v[188:191]
    s_waitcnt vmcnt(0)
    v_mfma_f32_16x16x32_bf16 v[192:195], v[212:215], v[164:167], v[192:195]
    v_mfma_f32_16x16x32_bf16 v[196:199], v[212:215], v[180:183], v[196:199]
    s_nop 3
    v_exp_f32 v184, v184
    v_exp_f32 v185, v185
    v_add_f32 v9, v9, v184
    v_add_f32 v9, v9, v185
    v_cvt_pk_bf16_f32 v40, v184, v185
    v_exp_f32 v186, v186
    v_exp_f32 v187, v187
    v_add_f32 v9, v9, v186
    v_add_f32 v9, v9, v187
    v_cvt_pk_bf16_f32 v41, v186, v187
    v_exp_f32 v188, v188
    v_exp_f32 v189, v189
    v_add_f32 v10, v10, v188
    v_add_f32 v10, v10, v189
    v_cvt_pk_bf16_f32 v44, v188, v189
    v_exp_f32 v190, v190
    v_exp_f32 v191, v191
    v_add_f32 v10, v10, v190
    v_add_f32 v10, v10, v191
    v_cvt_pk_bf16_f32 v45, v190, v191
    v_exp_f32 v192, v192
    v_exp_f32 v193, v193
    v_add_f32 v9, v9, v192
    v_add_f32 v9, v9, v193
    v_cvt_pk_bf16_f32 v42, v192, v193
    v_exp_f32 v194, v194
    v_exp_f32 v195, v195
    v_add_f32 v9, v9, v194
    v_add_f32 v9, v9, v195
    v_cvt_pk_bf16_f32 v43, v194, v195
    v_exp_f32 v196, v196
    v_exp_f32 v197, v197
    v_add_f32 v10, v10, v196
    v_add_f32 v10, v10, v197
    v_cvt_pk_bf16_f32 v46, v196, v197
    v_exp_f32 v198, v198
    v_exp_f32 v199, v199
    v_add_f32 v10, v10, v198
    v_add_f32 v10, v10, v199
    v_cvt_pk_bf16_f32 v47, v198, v199
    s_mov_b32 s17, 0x6000
    buffer_load_dwordx4 v[200:203], v8, s[8:11], s17 offen offset:0
    buffer_load_dwordx4 v[204:207], v8, s[8:11], s17 offen offset:1024
    buffer_load_dwordx4 v[208:211], v8, s[8:11], s17 offen offset:2048
    buffer_load_dwordx4 v[212:215], v8, s[8:11], s17 offen offset:3072
    s_waitcnt vmcnt(3)
    v_mfma_f32_16x16x32_bf16 v[184:187], v[200:203], v[152:155], v[216:219]
    v_mfma_f32_16x16x32_bf16 v[188:191], v[200:203], v[168:171], v[220:223]
    s_waitcnt vmcnt(2)
    v_mfma_f32_16x16x32_bf16 v[192:195], v[204:207], v[152:155], v[216:219]
    v_mfma_f32_16x16x32_bf16 v[196:199], v[204:207], v[168:171], v[220:223]
    s_waitcnt vmcnt(1)
    v_mfma_f32_16x16x32_bf16 v[184:187], v[208:211], v[156:159], v[184:187]
    v_mfma_f32_16x16x32_bf16 v[188:191], v[208:211], v[172:175], v[188:191]
    s_waitcnt vmcnt(0)
    v_mfma_f32_16x16x32_bf16 v[192:195], v[212:215], v[156:159], v[192:195]
    v_mfma_f32_16x16x32_bf16 v[196:199], v[212:215], v[172:175], v[196:199]
    s_mov_b32 s17, 0x7000
    buffer_load_dwordx4 v[200:203], v8, s[8:11], s17 offen offset:0
    buffer_load_dwordx4 v[204:207], v8, s[8:11], s17 offen offset:1024
    buffer_load_dwordx4 v[208:211], v8, s[8:11], s17 offen offset:2048
    buffer_load_dwordx4 v[212:215], v8, s[8:11], s17 offen offset:3072
    s_waitcnt vmcnt(3)
    v_mfma_f32_16x16x32_bf16 v[184:187], v[200:203], v[160:163], v[184:187]
    v_mfma_f32_16x16x32_bf16 v[188:191], v[200:203], v[176:179], v[188:191]
    s_waitcnt vmcnt(2)
    v_mfma_f32_16x16x32_bf16 v[192:195], v[204:207], v[160:163], v[192:195]
    v_mfma_f32_16x16x32_bf16 v[196:199], v[204:207], v[176:179], v[196:199]
    s_waitcnt vmcnt(1)
    v_mfma_f32_16x16x32_bf16 v[184:187], v[208:211], v[164:167], v[184:187]
    v_mfma_f32_16x16x32_bf16 v[188:191], v[208:211], v[180:183], v[188:191]
    s_waitcnt vmcnt(0)
    v_mfma_f32_16x16x32_bf16 v[192:195], v[212:215], v[164:167], v[192:195]
    v_mfma_f32_16x16x32_bf16 v[196:199], v[212:215], v[180:183], v[196:199]
    s_nop 3
    v_exp_f32 v184, v184
    v_exp_f32 v185, v185
    v_add_f32 v9, v9, v184
    v_add_f32 v9, v9, v185
    v_cvt_pk_bf16_f32 v48, v184, v185
    v_exp_f32 v186, v186
    v_exp_f32 v187, v187
    v_add_f32 v9, v9, v186
    v_add_f32 v9, v9, v187
    v_cvt_pk_bf16_f32 v49, v186, v187
    v_exp_f32 v188, v188
    v_exp_f32 v189, v189
    v_add_f32 v10, v10, v188
    v_add_f32 v10, v10, v189
    v_cvt_pk_bf16_f32 v52, v188, v189
    v_exp_f32 v190, v190
    v_exp_f32 v191, v191
    v_add_f32 v10, v10, v190
    v_add_f32 v10, v10, v191
    v_cvt_pk_bf16_f32 v53, v190, v191
    v_exp_f32 v192, v192
    v_exp_f32 v193, v193
    v_add_f32 v9, v9, v192
    v_add_f32 v9, v9, v193
    v_cvt_pk_bf16_f32 v50, v192, v193
    v_exp_f32 v194, v194
    v_exp_f32 v195, v195
    v_add_f32 v9, v9, v194
    v_add_f32 v9, v9, v195
    v_cvt_pk_bf16_f32 v51, v194, v195
    v_exp_f32 v196, v196
    v_exp_f32 v197, v197
    v_add_f32 v10, v10, v196
    v_add_f32 v10, v10, v197
    v_cvt_pk_bf16_f32 v54, v196, v197
    v_exp_f32 v198, v198
    v_exp_f32 v199, v199
    v_add_f32 v10, v10, v198
    v_add_f32 v10, v10, v199
    v_cvt_pk_bf16_f32 v55, v198, v199
    s_mov_b32 s17, 0x8000
    buffer_load_dwordx4 v[200:203], v8, s[8:11], s17 offen offset:0
    buffer_load_dwordx4 v[204:207], v8, s[8:11], s17 offen offset:1024
    buffer_load_dwordx4 v[208:211], v8, s[8:11], s17 offen offset:2048
    buffer_load_dwordx4 v[212:215], v8, s[8:11], s17 offen offset:3072
    s_waitcnt vmcnt(3)
    v_mfma_f32_16x16x32_bf16 v[184:187], v[200:203], v[152:155], v[216:219]
    v_mfma_f32_16x16x32_bf16 v[188:191], v[200:203], v[168:171], v[220:223]
    s_waitcnt vmcnt(2)
    v_mfma_f32_16x16x32_bf16 v[192:195], v[204:207], v[152:155], v[216:219]
    v_mfma_f32_16x16x32_bf16 v[196:199], v[204:207], v[168:171], v[220:223]
    s_waitcnt vmcnt(1)
    v_mfma_f32_16x16x32_bf16 v[184:187], v[208:211], v[156:159], v[184:187]
    v_mfma_f32_16x16x32_bf16 v[188:191], v[208:211], v[172:175], v[188:191]
    s_waitcnt vmcnt(0)
    v_mfma_f32_16x16x32_bf16 v[192:195], v[212:215], v[156:159], v[192:195]
    v_mfma_f32_16x16x32_bf16 v[196:199], v[212:215], v[172:175], v[196:199]
    s_mov_b32 s17, 0x9000
    buffer_load_dwordx4 v[200:203], v8, s[8:11], s17 offen offset:0
    buffer_load_dwordx4 v[204:207], v8, s[8:11], s17 offen offset:1024
    buffer_load_dwordx4 v[208:211], v8, s[8:11], s17 offen offset:2048
    buffer_load_dwordx4 v[212:215], v8, s[8:11], s17 offen offset:3072
    s_waitcnt vmcnt(3)
    v_mfma_f32_16x16x32_bf16 v[184:187], v[200:203], v[160:163], v[184:187]
    v_mfma_f32_16x16x32_bf16 v[188:191], v[200:203], v[176:179], v[188:191]
    s_waitcnt vmcnt(2)
    v_mfma_f32_16x16x32_bf16 v[192:195], v[204:207], v[160:163], v[192:195]
    v_mfma_f32_16x16x32_bf16 v[196:199], v[204:207], v[176:179], v[196:199]
    s_waitcnt vmcnt(1)
    v_mfma_f32_16x16x32_bf16 v[184:187], v[208:211], v[164:167], v[184:187]
    v_mfma_f32_16x16x32_bf16 v[188:191], v[208:211], v[180:183], v[188:191]
    s_waitcnt vmcnt(0)
    v_mfma_f32_16x16x32_bf16 v[192:195], v[212:215], v[164:167], v[192:195]
    v_mfma_f32_16x16x32_bf16 v[196:199], v[212:215], v[180:183], v[196:199]
    s_nop 3
    v_exp_f32 v184, v184
    v_exp_f32 v185, v185
    v_add_f32 v9, v9, v184
    v_add_f32 v9, v9, v185
    v_cvt_pk_bf16_f32 v56, v184, v185
    v_exp_f32 v186, v186
    v_exp_f32 v187, v187
    v_add_f32 v9, v9, v186
    v_add_f32 v9, v9, v187
    v_cvt_pk_bf16_f32 v57, v186, v187
    v_exp_f32 v188, v188
    v_exp_f32 v189, v189
    v_add_f32 v10, v10, v188
    v_add_f32 v10, v10, v189
    v_cvt_pk_bf16_f32 v60, v188, v189
    v_exp_f32 v190, v190
    v_exp_f32 v191, v191
    v_add_f32 v10, v10, v190
    v_add_f32 v10, v10, v191
    v_cvt_pk_bf16_f32 v61, v190, v191
    v_exp_f32 v192, v192
    v_exp_f32 v193, v193
    v_add_f32 v9, v9, v192
    v_add_f32 v9, v9, v193
    v_cvt_pk_bf16_f32 v58, v192, v193
    v_exp_f32 v194, v194
    v_exp_f32 v195, v195
    v_add_f32 v9, v9, v194
    v_add_f32 v9, v9, v195
    v_cvt_pk_bf16_f32 v59, v194, v195
    v_exp_f32 v196, v196
    v_exp_f32 v197, v197
    v_add_f32 v10, v10, v196
    v_add_f32 v10, v10, v197
    v_cvt_pk_bf16_f32 v62, v196, v197
    v_exp_f32 v198, v198
    v_exp_f32 v199, v199
    v_add_f32 v10, v10, v198
    v_add_f32 v10, v10, v199
    v_cvt_pk_bf16_f32 v63, v198, v199
    s_mov_b32 s17, 0xa000
    buffer_load_dwordx4 v[200:203], v8, s[8:11], s17 offen offset:0
    buffer_load_dwordx4 v[204:207], v8, s[8:11], s17 offen offset:1024
    buffer_load_dwordx4 v[208:211], v8, s[8:11], s17 offen offset:2048
    buffer_load_dwordx4 v[212:215], v8, s[8:11], s17 offen offset:3072
    s_waitcnt vmcnt(3)
    v_mfma_f32_16x16x32_bf16 v[184:187], v[200:203], v[152:155], v[216:219]
    v_mfma_f32_16x16x32_bf16 v[188:191], v[200:203], v[168:171], v[220:223]
    s_waitcnt vmcnt(2)
    v_mfma_f32_16x16x32_bf16 v[192:195], v[204:207], v[152:155], v[216:219]
    v_mfma_f32_16x16x32_bf16 v[196:199], v[204:207], v[168:171], v[220:223]
    s_waitcnt vmcnt(1)
    v_mfma_f32_16x16x32_bf16 v[184:187], v[208:211], v[156:159], v[184:187]
    v_mfma_f32_16x16x32_bf16 v[188:191], v[208:211], v[172:175], v[188:191]
    s_waitcnt vmcnt(0)
    v_mfma_f32_16x16x32_bf16 v[192:195], v[212:215], v[156:159], v[192:195]
    v_mfma_f32_16x16x32_bf16 v[196:199], v[212:215], v[172:175], v[196:199]
    s_mov_b32 s17, 0xb000
    buffer_load_dwordx4 v[200:203], v8, s[8:11], s17 offen offset:0
    buffer_load_dwordx4 v[204:207], v8, s[8:11], s17 offen offset:1024
    buffer_load_dwordx4 v[208:211], v8, s[8:11], s17 offen offset:2048
    buffer_load_dwordx4 v[212:215], v8, s[8:11], s17 offen offset:3072
    s_waitcnt vmcnt(3)
    v_mfma_f32_16x16x32_bf16 v[184:187], v[200:203], v[160:163], v[184:187]
    v_mfma_f32_16x16x32_bf16 v[188:191], v[200:203], v[176:179], v[188:191]
    s_waitcnt vmcnt(2)
    v_mfma_f32_16x16x32_bf16 v[192:195], v[204:207], v[160:163], v[192:195]
    v_mfma_f32_16x16x32_bf16 v[196:199], v[204:207], v[176:179], v[196:199]
    s_waitcnt vmcnt(1)
    v_mfma_f32_16x16x32_bf16 v[184:187], v[208:211], v[164:167], v[184:187]
    v_mfma_f32_16x16x32_bf16 v[188:191], v[208:211], v[180:183], v[188:191]
    s_waitcnt vmcnt(0)
    v_mfma_f32_16x16x32_bf16 v[192:195], v[212:215], v[164:167], v[192:195]
    v_mfma_f32_16x16x32_bf16 v[196:199], v[212:215], v[180:183], v[196:199]
    s_nop 3
    v_exp_f32 v184, v184
    v_exp_f32 v185, v185
    v_add_f32 v9, v9, v184
    v_add_f32 v9, v9, v185
    v_cvt_pk_bf16_f32 v64, v184, v185
    v_exp_f32 v186, v186
    v_exp_f32 v187, v187
    v_add_f32 v9, v9, v186
    v_add_f32 v9, v9, v187
    v_cvt_pk_bf16_f32 v65, v186, v187
    v_exp_f32 v188, v188
    v_exp_f32 v189, v189
    v_add_f32 v10, v10, v188
    v_add_f32 v10, v10, v189
    v_cvt_pk_bf16_f32 v68, v188, v189
    v_exp_f32 v190, v190
    v_exp_f32 v191, v191
    v_add_f32 v10, v10, v190
    v_add_f32 v10, v10, v191
    v_cvt_pk_bf16_f32 v69, v190, v191
    v_exp_f32 v192, v192
    v_exp_f32 v193, v193
    v_add_f32 v9, v9, v192
    v_add_f32 v9, v9, v193
    v_cvt_pk_bf16_f32 v66, v192, v193
    v_exp_f32 v194, v194
    v_exp_f32 v195, v195
    v_add_f32 v9, v9, v194
    v_add_f32 v9, v9, v195
    v_cvt_pk_bf16_f32 v67, v194, v195
    v_exp_f32 v196, v196
    v_exp_f32 v197, v197
    v_add_f32 v10, v10, v196
    v_add_f32 v10, v10, v197
    v_cvt_pk_bf16_f32 v70, v196, v197
    v_exp_f32 v198, v198
    v_exp_f32 v199, v199
    v_add_f32 v10, v10, v198
    v_add_f32 v10, v10, v199
    v_cvt_pk_bf16_f32 v71, v198, v199
    s_mov_b32 s17, 0xc000
    buffer_load_dwordx4 v[200:203], v8, s[8:11], s17 offen offset:0
    buffer_load_dwordx4 v[204:207], v8, s[8:11], s17 offen offset:1024
    buffer_load_dwordx4 v[208:211], v8, s[8:11], s17 offen offset:2048
    buffer_load_dwordx4 v[212:215], v8, s[8:11], s17 offen offset:3072
    s_waitcnt vmcnt(3)
    v_mfma_f32_16x16x32_bf16 v[184:187], v[200:203], v[152:155], v[216:219]
    v_mfma_f32_16x16x32_bf16 v[188:191], v[200:203], v[168:171], v[220:223]
    s_waitcnt vmcnt(2)
    v_mfma_f32_16x16x32_bf16 v[192:195], v[204:207], v[152:155], v[216:219]
    v_mfma_f32_16x16x32_bf16 v[196:199], v[204:207], v[168:171], v[220:223]
    s_waitcnt vmcnt(1)
    v_mfma_f32_16x16x32_bf16 v[184:187], v[208:211], v[156:159], v[184:187]
    v_mfma_f32_16x16x32_bf16 v[188:191], v[208:211], v[172:175], v[188:191]
    s_waitcnt vmcnt(0)
    v_mfma_f32_16x16x32_bf16 v[192:195], v[212:215], v[156:159], v[192:195]
    v_mfma_f32_16x16x32_bf16 v[196:199], v[212:215], v[172:175], v[196:199]
    s_mov_b32 s17, 0xd000
    buffer_load_dwordx4 v[200:203], v8, s[8:11], s17 offen offset:0
    buffer_load_dwordx4 v[204:207], v8, s[8:11], s17 offen offset:1024
    buffer_load_dwordx4 v[208:211], v8, s[8:11], s17 offen offset:2048
    buffer_load_dwordx4 v[212:215], v8, s[8:11], s17 offen offset:3072
    s_waitcnt vmcnt(3)
    v_mfma_f32_16x16x32_bf16 v[184:187], v[200:203], v[160:163], v[184:187]
    v_mfma_f32_16x16x32_bf16 v[188:191], v[200:203], v[176:179], v[188:191]
    s_waitcnt vmcnt(2)
    v_mfma_f32_16x16x32_bf16 v[192:195], v[204:207], v[160:163], v[192:195]
    v_mfma_f32_16x16x32_bf16 v[196:199], v[204:207], v[176:179], v[196:199]
    s_waitcnt vmcnt(1)
    v_mfma_f32_16x16x32_bf16 v[184:187], v[208:211], v[164:167], v[184:187]
    v_mfma_f32_16x16x32_bf16 v[188:191], v[208:211], v[180:183], v[188:191]
    s_waitcnt vmcnt(0)
    v_mfma_f32_16x16x32_bf16 v[192:195], v[212:215], v[164:167], v[192:195]
    v_mfma_f32_16x16x32_bf16 v[196:199], v[212:215], v[180:183], v[196:199]
    s_nop 3
    v_exp_f32 v184, v184
    v_exp_f32 v185, v185
    v_add_f32 v9, v9, v184
    v_add_f32 v9, v9, v185
    v_cvt_pk_bf16_f32 v72, v184, v185
    v_exp_f32 v186, v186
    v_exp_f32 v187, v187
    v_add_f32 v9, v9, v186
    v_add_f32 v9, v9, v187
    v_cvt_pk_bf16_f32 v73, v186, v187
    v_exp_f32 v188, v188
    v_exp_f32 v189, v189
    v_add_f32 v10, v10, v188
    v_add_f32 v10, v10, v189
    v_cvt_pk_bf16_f32 v76, v188, v189
    v_exp_f32 v190, v190
    v_exp_f32 v191, v191
    v_add_f32 v10, v10, v190
    v_add_f32 v10, v10, v191
    v_cvt_pk_bf16_f32 v77, v190, v191
    v_exp_f32 v192, v192
    v_exp_f32 v193, v193
    v_add_f32 v9, v9, v192
    v_add_f32 v9, v9, v193
    v_cvt_pk_bf16_f32 v74, v192, v193
    v_exp_f32 v194, v194
    v_exp_f32 v195, v195
    v_add_f32 v9, v9, v194
    v_add_f32 v9, v9, v195
    v_cvt_pk_bf16_f32 v75, v194, v195
    v_exp_f32 v196, v196
    v_exp_f32 v197, v197
    v_add_f32 v10, v10, v196
    v_add_f32 v10, v10, v197
    v_cvt_pk_bf16_f32 v78, v196, v197
    v_exp_f32 v198, v198
    v_exp_f32 v199, v199
    v_add_f32 v10, v10, v198
    v_add_f32 v10, v10, v199
    v_cvt_pk_bf16_f32 v79, v198, v199
    s_mov_b32 s17, 0xe000
    buffer_load_dwordx4 v[200:203], v8, s[8:11], s17 offen offset:0
    buffer_load_dwordx4 v[204:207], v8, s[8:11], s17 offen offset:1024
    buffer_load_dwordx4 v[208:211], v8, s[8:11], s17 offen offset:2048
    buffer_load_dwordx4 v[212:215], v8, s[8:11], s17 offen offset:3072
    s_waitcnt vmcnt(3)
    v_mfma_f32_16x16x32_bf16 v[184:187], v[200:203], v[152:155], v[216:219]
    v_mfma_f32_16x16x32_bf16 v[188:191], v[200:203], v[168:171], v[220:223]
    s_waitcnt vmcnt(2)
    v_mfma_f32_16x16x32_bf16 v[192:195], v[204:207], v[152:155], v[216:219]
    v_mfma_f32_16x16x32_bf16 v[196:199], v[204:207], v[168:171], v[220:223]
    s_waitcnt vmcnt(1)
    v_mfma_f32_16x16x32_bf16 v[184:187], v[208:211], v[156:159], v[184:187]
    v_mfma_f32_16x16x32_bf16 v[188:191], v[208:211], v[172:175], v[188:191]
    s_waitcnt vmcnt(0)
    v_mfma_f32_16x16x32_bf16 v[192:195], v[212:215], v[156:159], v[192:195]
    v_mfma_f32_16x16x32_bf16 v[196:199], v[212:215], v[172:175], v[196:199]
    s_mov_b32 s17, 0xf000
    buffer_load_dwordx4 v[200:203], v8, s[8:11], s17 offen offset:0
    buffer_load_dwordx4 v[204:207], v8, s[8:11], s17 offen offset:1024
    buffer_load_dwordx4 v[208:211], v8, s[8:11], s17 offen offset:2048
    buffer_load_dwordx4 v[212:215], v8, s[8:11], s17 offen offset:3072
    s_waitcnt vmcnt(3)
    v_mfma_f32_16x16x32_bf16 v[184:187], v[200:203], v[160:163], v[184:187]
    v_mfma_f32_16x16x32_bf16 v[188:191], v[200:203], v[176:179], v[188:191]
    s_waitcnt vmcnt(2)
    v_mfma_f32_16x16x32_bf16 v[192:195], v[204:207], v[160:163], v[192:195]
    v_mfma_f32_16x16x32_bf16 v[196:199], v[204:207], v[176:179], v[196:199]
    s_waitcnt vmcnt(1)
    v_mfma_f32_16x16x32_bf16 v[184:187], v[208:211], v[164:167], v[184:187]
    v_mfma_f32_16x16x32_bf16 v[188:191], v[208:211], v[180:183], v[188:191]
    s_waitcnt vmcnt(0)
    v_mfma_f32_16x16x32_bf16 v[192:195], v[212:215], v[164:167], v[192:195]
    v_mfma_f32_16x16x32_bf16 v[196:199], v[212:215], v[180:183], v[196:199]
    s_nop 3
    v_exp_f32 v184, v184
    v_exp_f32 v185, v185
    v_add_f32 v9, v9, v184
    v_add_f32 v9, v9, v185
    v_cvt_pk_bf16_f32 v80, v184, v185
    v_exp_f32 v186, v186
    v_exp_f32 v187, v187
    v_add_f32 v9, v9, v186
    v_add_f32 v9, v9, v187
    v_cvt_pk_bf16_f32 v81, v186, v187
    v_exp_f32 v188, v188
    v_exp_f32 v189, v189
    v_add_f32 v10, v10, v188
    v_add_f32 v10, v10, v189
    v_cvt_pk_bf16_f32 v84, v188, v189
    v_exp_f32 v190, v190
    v_exp_f32 v191, v191
    v_add_f32 v10, v10, v190
    v_add_f32 v10, v10, v191
    v_cvt_pk_bf16_f32 v85, v190, v191
    v_exp_f32 v192, v192
    v_exp_f32 v193, v193
    v_add_f32 v9, v9, v192
    v_add_f32 v9, v9, v193
    v_cvt_pk_bf16_f32 v82, v192, v193
    v_exp_f32 v194, v194
    v_exp_f32 v195, v195
    v_add_f32 v9, v9, v194
    v_add_f32 v9, v9, v195
    v_cvt_pk_bf16_f32 v83, v194, v195
    v_exp_f32 v196, v196
    v_exp_f32 v197, v197
    v_add_f32 v10, v10, v196
    v_add_f32 v10, v10, v197
    v_cvt_pk_bf16_f32 v86, v196, v197
    v_exp_f32 v198, v198
    v_exp_f32 v199, v199
    v_add_f32 v10, v10, v198
    v_add_f32 v10, v10, v199
    v_cvt_pk_bf16_f32 v87, v198, v199
    s_mov_b32 s17, 0x10000
    buffer_load_dwordx4 v[200:203], v8, s[8:11], s17 offen offset:0
    buffer_load_dwordx4 v[204:207], v8, s[8:11], s17 offen offset:1024
    buffer_load_dwordx4 v[208:211], v8, s[8:11], s17 offen offset:2048
    buffer_load_dwordx4 v[212:215], v8, s[8:11], s17 offen offset:3072
    s_waitcnt vmcnt(3)
    v_mfma_f32_16x16x32_bf16 v[184:187], v[200:203], v[152:155], v[216:219]
    v_mfma_f32_16x16x32_bf16 v[188:191], v[200:203], v[168:171], v[220:223]
    s_waitcnt vmcnt(2)
    v_mfma_f32_16x16x32_bf16 v[192:195], v[204:207], v[152:155], v[216:219]
    v_mfma_f32_16x16x32_bf16 v[196:199], v[204:207], v[168:171], v[220:223]
    s_waitcnt vmcnt(1)
    v_mfma_f32_16x16x32_bf16 v[184:187], v[208:211], v[156:159], v[184:187]
    v_mfma_f32_16x16x32_bf16 v[188:191], v[208:211], v[172:175], v[188:191]
    s_waitcnt vmcnt(0)
    v_mfma_f32_16x16x32_bf16 v[192:195], v[212:215], v[156:159], v[192:195]
    v_mfma_f32_16x16x32_bf16 v[196:199], v[212:215], v[172:175], v[196:199]
    s_mov_b32 s17, 0x11000
    buffer_load_dwordx4 v[200:203], v8, s[8:11], s17 offen offset:0
    buffer_load_dwordx4 v[204:207], v8, s[8:11], s17 offen offset:1024
    buffer_load_dwordx4 v[208:211], v8, s[8:11], s17 offen offset:2048
    buffer_load_dwordx4 v[212:215], v8, s[8:11], s17 offen offset:3072
    s_waitcnt vmcnt(3)
    v_mfma_f32_16x16x32_bf16 v[184:187], v[200:203], v[160:163], v[184:187]
    v_mfma_f32_16x16x32_bf16 v[188:191], v[200:203], v[176:179], v[188:191]
    s_waitcnt vmcnt(2)
    v_mfma_f32_16x16x32_bf16 v[192:195], v[204:207], v[160:163], v[192:195]
    v_mfma_f32_16x16x32_bf16 v[196:199], v[204:207], v[176:179], v[196:199]
    s_waitcnt vmcnt(1)
    v_mfma_f32_16x16x32_bf16 v[184:187], v[208:211], v[164:167], v[184:187]
    v_mfma_f32_16x16x32_bf16 v[188:191], v[208:211], v[180:183], v[188:191]
    s_waitcnt vmcnt(0)
    v_mfma_f32_16x16x32_bf16 v[192:195], v[212:215], v[164:167], v[192:195]
    v_mfma_f32_16x16x32_bf16 v[196:199], v[212:215], v[180:183], v[196:199]
    s_nop 3
    v_exp_f32 v184, v184
    v_exp_f32 v185, v185
    v_add_f32 v9, v9, v184
    v_add_f32 v9, v9, v185
    v_cvt_pk_bf16_f32 v88, v184, v185
    v_exp_f32 v186, v186
    v_exp_f32 v187, v187
    v_add_f32 v9, v9, v186
    v_add_f32 v9, v9, v187
    v_cvt_pk_bf16_f32 v89, v186, v187
    v_exp_f32 v188, v188
    v_exp_f32 v189, v189
    v_add_f32 v10, v10, v188
    v_add_f32 v10, v10, v189
    v_cvt_pk_bf16_f32 v92, v188, v189
    v_exp_f32 v190, v190
    v_exp_f32 v191, v191
    v_add_f32 v10, v10, v190
    v_add_f32 v10, v10, v191
    v_cvt_pk_bf16_f32 v93, v190, v191
    v_exp_f32 v192, v192
    v_exp_f32 v193, v193
    v_add_f32 v9, v9, v192
    v_add_f32 v9, v9, v193
    v_cvt_pk_bf16_f32 v90, v192, v193
    v_exp_f32 v194, v194
    v_exp_f32 v195, v195
    v_add_f32 v9, v9, v194
    v_add_f32 v9, v9, v195
    v_cvt_pk_bf16_f32 v91, v194, v195
    v_exp_f32 v196, v196
    v_exp_f32 v197, v197
    v_add_f32 v10, v10, v196
    v_add_f32 v10, v10, v197
    v_cvt_pk_bf16_f32 v94, v196, v197
    v_exp_f32 v198, v198
    v_exp_f32 v199, v199
    v_add_f32 v10, v10, v198
    v_add_f32 v10, v10, v199
    v_cvt_pk_bf16_f32 v95, v198, v199
    s_mov_b32 s17, 0x12000
    buffer_load_dwordx4 v[200:203], v8, s[8:11], s17 offen offset:0
    buffer_load_dwordx4 v[204:207], v8, s[8:11], s17 offen offset:1024
    buffer_load_dwordx4 v[208:211], v8, s[8:11], s17 offen offset:2048
    buffer_load_dwordx4 v[212:215], v8, s[8:11], s17 offen offset:3072
    s_waitcnt vmcnt(3)
    v_mfma_f32_16x16x32_bf16 v[184:187], v[200:203], v[152:155], v[216:219]
    v_mfma_f32_16x16x32_bf16 v[188:191], v[200:203], v[168:171], v[220:223]
    s_waitcnt vmcnt(2)
    v_mfma_f32_16x16x32_bf16 v[192:195], v[204:207], v[152:155], v[216:219]
    v_mfma_f32_16x16x32_bf16 v[196:199], v[204:207], v[168:171], v[220:223]
    s_waitcnt vmcnt(1)
    v_mfma_f32_16x16x32_bf16 v[184:187], v[208:211], v[156:159], v[184:187]
    v_mfma_f32_16x16x32_bf16 v[188:191], v[208:211], v[172:175], v[188:191]
    s_waitcnt vmcnt(0)
    v_mfma_f32_16x16x32_bf16 v[192:195], v[212:215], v[156:159], v[192:195]
    v_mfma_f32_16x16x32_bf16 v[196:199], v[212:215], v[172:175], v[196:199]
    s_mov_b32 s17, 0x13000
    buffer_load_dwordx4 v[200:203], v8, s[8:11], s17 offen offset:0
    buffer_load_dwordx4 v[204:207], v8, s[8:11], s17 offen offset:1024
    buffer_load_dwordx4 v[208:211], v8, s[8:11], s17 offen offset:2048
    buffer_load_dwordx4 v[212:215], v8, s[8:11], s17 offen offset:3072
    s_waitcnt vmcnt(3)
    v_mfma_f32_16x16x32_bf16 v[184:187], v[200:203], v[160:163], v[184:187]
    v_mfma_f32_16x16x32_bf16 v[188:191], v[200:203], v[176:179], v[188:191]
    s_waitcnt vmcnt(2)
    v_mfma_f32_16x16x32_bf16 v[192:195], v[204:207], v[160:163], v[192:195]
    v_mfma_f32_16x16x32_bf16 v[196:199], v[204:207], v[176:179], v[196:199]
    s_waitcnt vmcnt(1)
    v_mfma_f32_16x16x32_bf16 v[184:187], v[208:211], v[164:167], v[184:187]
    v_mfma_f32_16x16x32_bf16 v[188:191], v[208:211], v[180:183], v[188:191]
    s_waitcnt vmcnt(0)
    v_mfma_f32_16x16x32_bf16 v[192:195], v[212:215], v[164:167], v[192:195]
    v_mfma_f32_16x16x32_bf16 v[196:199], v[212:215], v[180:183], v[196:199]
    s_nop 3
    v_exp_f32 v184, v184
    v_exp_f32 v185, v185
    v_add_f32 v9, v9, v184
    v_add_f32 v9, v9, v185
    v_cvt_pk_bf16_f32 v96, v184, v185
    v_exp_f32 v186, v186
    v_exp_f32 v187, v187
    v_add_f32 v9, v9, v186
    v_add_f32 v9, v9, v187
    v_cvt_pk_bf16_f32 v97, v186, v187
    v_exp_f32 v188, v188
    v_exp_f32 v189, v189
    v_add_f32 v10, v10, v188
    v_add_f32 v10, v10, v189
    v_cvt_pk_bf16_f32 v100, v188, v189
    v_exp_f32 v190, v190
    v_exp_f32 v191, v191
    v_add_f32 v10, v10, v190
    v_add_f32 v10, v10, v191
    v_cvt_pk_bf16_f32 v101, v190, v191
    v_exp_f32 v192, v192
    v_exp_f32 v193, v193
    v_add_f32 v9, v9, v192
    v_add_f32 v9, v9, v193
    v_cvt_pk_bf16_f32 v98, v192, v193
    v_exp_f32 v194, v194
    v_exp_f32 v195, v195
    v_add_f32 v9, v9, v194
    v_add_f32 v9, v9, v195
    v_cvt_pk_bf16_f32 v99, v194, v195
    v_exp_f32 v196, v196
    v_exp_f32 v197, v197
    v_add_f32 v10, v10, v196
    v_add_f32 v10, v10, v197
    v_cvt_pk_bf16_f32 v102, v196, v197
    v_exp_f32 v198, v198
    v_exp_f32 v199, v199
    v_add_f32 v10, v10, v198
    v_add_f32 v10, v10, v199
    v_cvt_pk_bf16_f32 v103, v198, v199
    s_mov_b32 s17, 0x14000
    buffer_load_dwordx4 v[200:203], v8, s[8:11], s17 offen offset:0
    buffer_load_dwordx4 v[204:207], v8, s[8:11], s17 offen offset:1024
    buffer_load_dwordx4 v[208:211], v8, s[8:11], s17 offen offset:2048
    buffer_load_dwordx4 v[212:215], v8, s[8:11], s17 offen offset:3072
    s_waitcnt vmcnt(3)
    v_mfma_f32_16x16x32_bf16 v[184:187], v[200:203], v[152:155], v[216:219]
    v_mfma_f32_16x16x32_bf16 v[188:191], v[200:203], v[168:171], v[220:223]
    s_waitcnt vmcnt(2)
    v_mfma_f32_16x16x32_bf16 v[192:195], v[204:207], v[152:155], v[216:219]
    v_mfma_f32_16x16x32_bf16 v[196:199], v[204:207], v[168:171], v[220:223]
    s_waitcnt vmcnt(1)
    v_mfma_f32_16x16x32_bf16 v[184:187], v[208:211], v[156:159], v[184:187]
    v_mfma_f32_16x16x32_bf16 v[188:191], v[208:211], v[172:175], v[188:191]
    s_waitcnt vmcnt(0)
    v_mfma_f32_16x16x32_bf16 v[192:195], v[212:215], v[156:159], v[192:195]
    v_mfma_f32_16x16x32_bf16 v[196:199], v[212:215], v[172:175], v[196:199]
    s_mov_b32 s17, 0x15000
    buffer_load_dwordx4 v[200:203], v8, s[8:11], s17 offen offset:0
    buffer_load_dwordx4 v[204:207], v8, s[8:11], s17 offen offset:1024
    buffer_load_dwordx4 v[208:211], v8, s[8:11], s17 offen offset:2048
    buffer_load_dwordx4 v[212:215], v8, s[8:11], s17 offen offset:3072
    s_waitcnt vmcnt(3)
    v_mfma_f32_16x16x32_bf16 v[184:187], v[200:203], v[160:163], v[184:187]
    v_mfma_f32_16x16x32_bf16 v[188:191], v[200:203], v[176:179], v[188:191]
    s_waitcnt vmcnt(2)
    v_mfma_f32_16x16x32_bf16 v[192:195], v[204:207], v[160:163], v[192:195]
    v_mfma_f32_16x16x32_bf16 v[196:199], v[204:207], v[176:179], v[196:199]
    s_waitcnt vmcnt(1)
    v_mfma_f32_16x16x32_bf16 v[184:187], v[208:211], v[164:167], v[184:187]
    v_mfma_f32_16x16x32_bf16 v[188:191], v[208:211], v[180:183], v[188:191]
    s_waitcnt vmcnt(0)
    v_mfma_f32_16x16x32_bf16 v[192:195], v[212:215], v[164:167], v[192:195]
    v_mfma_f32_16x16x32_bf16 v[196:199], v[212:215], v[180:183], v[196:199]
    s_nop 3
    v_exp_f32 v184, v184
    v_exp_f32 v185, v185
    v_add_f32 v9, v9, v184
    v_add_f32 v9, v9, v185
    v_cvt_pk_bf16_f32 v104, v184, v185
    v_exp_f32 v186, v186
    v_exp_f32 v187, v187
    v_add_f32 v9, v9, v186
    v_add_f32 v9, v9, v187
    v_cvt_pk_bf16_f32 v105, v186, v187
    v_exp_f32 v188, v188
    v_exp_f32 v189, v189
    v_add_f32 v10, v10, v188
    v_add_f32 v10, v10, v189
    v_cvt_pk_bf16_f32 v108, v188, v189
    v_exp_f32 v190, v190
    v_exp_f32 v191, v191
    v_add_f32 v10, v10, v190
    v_add_f32 v10, v10, v191
    v_cvt_pk_bf16_f32 v109, v190, v191
    v_exp_f32 v192, v192
    v_exp_f32 v193, v193
    v_add_f32 v9, v9, v192
    v_add_f32 v9, v9, v193
    v_cvt_pk_bf16_f32 v106, v192, v193
    v_exp_f32 v194, v194
    v_exp_f32 v195, v195
    v_add_f32 v9, v9, v194
    v_add_f32 v9, v9, v195
    v_cvt_pk_bf16_f32 v107, v194, v195
    v_exp_f32 v196, v196
    v_exp_f32 v197, v197
    v_add_f32 v10, v10, v196
    v_add_f32 v10, v10, v197
    v_cvt_pk_bf16_f32 v110, v196, v197
    v_exp_f32 v198, v198
    v_exp_f32 v199, v199
    v_add_f32 v10, v10, v198
    v_add_f32 v10, v10, v199
    v_cvt_pk_bf16_f32 v111, v198, v199
    s_mov_b32 s17, 0x16000
    buffer_load_dwordx4 v[200:203], v8, s[8:11], s17 offen offset:0
    buffer_load_dwordx4 v[204:207], v8, s[8:11], s17 offen offset:1024
    buffer_load_dwordx4 v[208:211], v8, s[8:11], s17 offen offset:2048
    buffer_load_dwordx4 v[212:215], v8, s[8:11], s17 offen offset:3072
    s_waitcnt vmcnt(3)
    v_mfma_f32_16x16x32_bf16 v[184:187], v[200:203], v[152:155], v[216:219]
    v_mfma_f32_16x16x32_bf16 v[188:191], v[200:203], v[168:171], v[220:223]
    s_waitcnt vmcnt(2)
    v_mfma_f32_16x16x32_bf16 v[192:195], v[204:207], v[152:155], v[216:219]
    v_mfma_f32_16x16x32_bf16 v[196:199], v[204:207], v[168:171], v[220:223]
    s_waitcnt vmcnt(1)
    v_mfma_f32_16x16x32_bf16 v[184:187], v[208:211], v[156:159], v[184:187]
    v_mfma_f32_16x16x32_bf16 v[188:191], v[208:211], v[172:175], v[188:191]
    s_waitcnt vmcnt(0)
    v_mfma_f32_16x16x32_bf16 v[192:195], v[212:215], v[156:159], v[192:195]
    v_mfma_f32_16x16x32_bf16 v[196:199], v[212:215], v[172:175], v[196:199]
    s_mov_b32 s17, 0x17000
    buffer_load_dwordx4 v[200:203], v8, s[8:11], s17 offen offset:0
    buffer_load_dwordx4 v[204:207], v8, s[8:11], s17 offen offset:1024
    buffer_load_dwordx4 v[208:211], v8, s[8:11], s17 offen offset:2048
    buffer_load_dwordx4 v[212:215], v8, s[8:11], s17 offen offset:3072
    s_waitcnt vmcnt(3)
    v_mfma_f32_16x16x32_bf16 v[184:187], v[200:203], v[160:163], v[184:187]
    v_mfma_f32_16x16x32_bf16 v[188:191], v[200:203], v[176:179], v[188:191]
    s_waitcnt vmcnt(2)
    v_mfma_f32_16x16x32_bf16 v[192:195], v[204:207], v[160:163], v[192:195]
    v_mfma_f32_16x16x32_bf16 v[196:199], v[204:207], v[176:179], v[196:199]
    s_waitcnt vmcnt(1)
    v_mfma_f32_16x16x32_bf16 v[184:187], v[208:211], v[164:167], v[184:187]
    v_mfma_f32_16x16x32_bf16 v[188:191], v[208:211], v[180:183], v[188:191]
    s_waitcnt vmcnt(0)
    v_mfma_f32_16x16x32_bf16 v[192:195], v[212:215], v[164:167], v[192:195]
    v_mfma_f32_16x16x32_bf16 v[196:199], v[212:215], v[180:183], v[196:199]
    s_nop 3
    v_exp_f32 v184, v184
    v_exp_f32 v185, v185
    v_add_f32 v9, v9, v184
    v_add_f32 v9, v9, v185
    v_cvt_pk_bf16_f32 v112, v184, v185
    v_exp_f32 v186, v186
    v_exp_f32 v187, v187
    v_add_f32 v9, v9, v186
    v_add_f32 v9, v9, v187
    v_cvt_pk_bf16_f32 v113, v186, v187
    v_exp_f32 v188, v188
    v_exp_f32 v189, v189
    v_add_f32 v10, v10, v188
    v_add_f32 v10, v10, v189
    v_cvt_pk_bf16_f32 v116, v188, v189
    v_exp_f32 v190, v190
    v_exp_f32 v191, v191
    v_add_f32 v10, v10, v190
    v_add_f32 v10, v10, v191
    v_cvt_pk_bf16_f32 v117, v190, v191
    v_exp_f32 v192, v192
    v_exp_f32 v193, v193
    v_add_f32 v9, v9, v192
    v_add_f32 v9, v9, v193
    v_cvt_pk_bf16_f32 v114, v192, v193
    v_exp_f32 v194, v194
    v_exp_f32 v195, v195
    v_add_f32 v9, v9, v194
    v_add_f32 v9, v9, v195
    v_cvt_pk_bf16_f32 v115, v194, v195
    v_exp_f32 v196, v196
    v_exp_f32 v197, v197
    v_add_f32 v10, v10, v196
    v_add_f32 v10, v10, v197
    v_cvt_pk_bf16_f32 v118, v196, v197
    v_exp_f32 v198, v198
    v_exp_f32 v199, v199
    v_add_f32 v10, v10, v198
    v_add_f32 v10, v10, v199
    v_cvt_pk_bf16_f32 v119, v198, v199
    s_mov_b32 s17, 0x18000
    buffer_load_dwordx4 v[200:203], v8, s[8:11], s17 offen offset:0
    buffer_load_dwordx4 v[204:207], v8, s[8:11], s17 offen offset:1024
    buffer_load_dwordx4 v[208:211], v8, s[8:11], s17 offen offset:2048
    buffer_load_dwordx4 v[212:215], v8, s[8:11], s17 offen offset:3072
    s_waitcnt vmcnt(3)
    v_mfma_f32_16x16x32_bf16 v[184:187], v[200:203], v[152:155], v[216:219]
    v_mfma_f32_16x16x32_bf16 v[188:191], v[200:203], v[168:171], v[220:223]
    s_waitcnt vmcnt(2)
    v_mfma_f32_16x16x32_bf16 v[192:195], v[204:207], v[152:155], v[216:219]
    v_mfma_f32_16x16x32_bf16 v[196:199], v[204:207], v[168:171], v[220:223]
    s_waitcnt vmcnt(1)
    v_mfma_f32_16x16x32_bf16 v[184:187], v[208:211], v[156:159], v[184:187]
    v_mfma_f32_16x16x32_bf16 v[188:191], v[208:211], v[172:175], v[188:191]
    s_waitcnt vmcnt(0)
    v_mfma_f32_16x16x32_bf16 v[192:195], v[212:215], v[156:159], v[192:195]
    v_mfma_f32_16x16x32_bf16 v[196:199], v[212:215], v[172:175], v[196:199]
    s_mov_b32 s17, 0x19000
    buffer_load_dwordx4 v[200:203], v8, s[8:11], s17 offen offset:0
    buffer_load_dwordx4 v[204:207], v8, s[8:11], s17 offen offset:1024
    buffer_load_dwordx4 v[208:211], v8, s[8:11], s17 offen offset:2048
    buffer_load_dwordx4 v[212:215], v8, s[8:11], s17 offen offset:3072
    s_waitcnt vmcnt(3)
    v_mfma_f32_16x16x32_bf16 v[184:187], v[200:203], v[160:163], v[184:187]
    v_mfma_f32_16x16x32_bf16 v[188:191], v[200:203], v[176:179], v[188:191]
    s_waitcnt vmcnt(2)
    v_mfma_f32_16x16x32_bf16 v[192:195], v[204:207], v[160:163], v[192:195]
    v_mfma_f32_16x16x32_bf16 v[196:199], v[204:207], v[176:179], v[196:199]
    s_waitcnt vmcnt(1)
    v_mfma_f32_16x16x32_bf16 v[184:187], v[208:211], v[164:167], v[184:187]
    v_mfma_f32_16x16x32_bf16 v[188:191], v[208:211], v[180:183], v[188:191]
    s_waitcnt vmcnt(0)
    v_mfma_f32_16x16x32_bf16 v[192:195], v[212:215], v[164:167], v[192:195]
    v_mfma_f32_16x16x32_bf16 v[196:199], v[212:215], v[180:183], v[196:199]
    s_nop 3
    v_exp_f32 v184, v184
    v_exp_f32 v185, v185
    v_add_f32 v9, v9, v184
    v_add_f32 v9, v9, v185
    v_cvt_pk_bf16_f32 v120, v184, v185
    v_exp_f32 v186, v186
    v_exp_f32 v187, v187
    v_add_f32 v9, v9, v186
    v_add_f32 v9, v9, v187
    v_cvt_pk_bf16_f32 v121, v186, v187
    v_exp_f32 v188, v188
    v_exp_f32 v189, v189
    v_add_f32 v10, v10, v188
    v_add_f32 v10, v10, v189
    v_cvt_pk_bf16_f32 v124, v188, v189
    v_exp_f32 v190, v190
    v_exp_f32 v191, v191
    v_add_f32 v10, v10, v190
    v_add_f32 v10, v10, v191
    v_cvt_pk_bf16_f32 v125, v190, v191
    v_exp_f32 v192, v192
    v_exp_f32 v193, v193
    v_add_f32 v9, v9, v192
    v_add_f32 v9, v9, v193
    v_cvt_pk_bf16_f32 v122, v192, v193
    v_exp_f32 v194, v194
    v_exp_f32 v195, v195
    v_add_f32 v9, v9, v194
    v_add_f32 v9, v9, v195
    v_cvt_pk_bf16_f32 v123, v194, v195
    v_exp_f32 v196, v196
    v_exp_f32 v197, v197
    v_add_f32 v10, v10, v196
    v_add_f32 v10, v10, v197
    v_cvt_pk_bf16_f32 v126, v196, v197
    v_exp_f32 v198, v198
    v_exp_f32 v199, v199
    v_add_f32 v10, v10, v198
    v_add_f32 v10, v10, v199
    v_cvt_pk_bf16_f32 v127, v198, v199
    s_mov_b32 s17, 0x1a000
    buffer_load_dwordx4 v[200:203], v8, s[8:11], s17 offen offset:0
    buffer_load_dwordx4 v[204:207], v8, s[8:11], s17 offen offset:1024
    buffer_load_dwordx4 v[208:211], v8, s[8:11], s17 offen offset:2048
    buffer_load_dwordx4 v[212:215], v8, s[8:11], s17 offen offset:3072
    s_waitcnt vmcnt(3)
    v_mfma_f32_16x16x32_bf16 v[184:187], v[200:203], v[152:155], v[216:219]
    v_mfma_f32_16x16x32_bf16 v[188:191], v[200:203], v[168:171], v[220:223]
    s_waitcnt vmcnt(2)
    v_mfma_f32_16x16x32_bf16 v[192:195], v[204:207], v[152:155], v[216:219]
    v_mfma_f32_16x16x32_bf16 v[196:199], v[204:207], v[168:171], v[220:223]
    s_waitcnt vmcnt(1)
    v_mfma_f32_16x16x32_bf16 v[184:187], v[208:211], v[156:159], v[184:187]
    v_mfma_f32_16x16x32_bf16 v[188:191], v[208:211], v[172:175], v[188:191]
    s_waitcnt vmcnt(0)
    v_mfma_f32_16x16x32_bf16 v[192:195], v[212:215], v[156:159], v[192:195]
    v_mfma_f32_16x16x32_bf16 v[196:199], v[212:215], v[172:175], v[196:199]
    s_mov_b32 s17, 0x1b000
    buffer_load_dwordx4 v[200:203], v8, s[8:11], s17 offen offset:0
    buffer_load_dwordx4 v[204:207], v8, s[8:11], s17 offen offset:1024
    buffer_load_dwordx4 v[208:211], v8, s[8:11], s17 offen offset:2048
    buffer_load_dwordx4 v[212:215], v8, s[8:11], s17 offen offset:3072
    s_waitcnt vmcnt(3)
    v_mfma_f32_16x16x32_bf16 v[184:187], v[200:203], v[160:163], v[184:187]
    v_mfma_f32_16x16x32_bf16 v[188:191], v[200:203], v[176:179], v[188:191]
    s_waitcnt vmcnt(2)
    v_mfma_f32_16x16x32_bf16 v[192:195], v[204:207], v[160:163], v[192:195]
    v_mfma_f32_16x16x32_bf16 v[196:199], v[204:207], v[176:179], v[196:199]
    s_waitcnt vmcnt(1)
    v_mfma_f32_16x16x32_bf16 v[184:187], v[208:211], v[164:167], v[184:187]
    v_mfma_f32_16x16x32_bf16 v[188:191], v[208:211], v[180:183], v[188:191]
    s_waitcnt vmcnt(0)
    v_mfma_f32_16x16x32_bf16 v[192:195], v[212:215], v[164:167], v[192:195]
    v_mfma_f32_16x16x32_bf16 v[196:199], v[212:215], v[180:183], v[196:199]
    s_nop 3
    v_exp_f32 v184, v184
    v_exp_f32 v185, v185
    v_add_f32 v9, v9, v184
    v_add_f32 v9, v9, v185
    v_cvt_pk_bf16_f32 v128, v184, v185
    v_exp_f32 v186, v186
    v_exp_f32 v187, v187
    v_add_f32 v9, v9, v186
    v_add_f32 v9, v9, v187
    v_cvt_pk_bf16_f32 v129, v186, v187
    v_exp_f32 v188, v188
    v_exp_f32 v189, v189
    v_add_f32 v10, v10, v188
    v_add_f32 v10, v10, v189
    v_cvt_pk_bf16_f32 v132, v188, v189
    v_exp_f32 v190, v190
    v_exp_f32 v191, v191
    v_add_f32 v10, v10, v190
    v_add_f32 v10, v10, v191
    v_cvt_pk_bf16_f32 v133, v190, v191
    v_exp_f32 v192, v192
    v_exp_f32 v193, v193
    v_add_f32 v9, v9, v192
    v_add_f32 v9, v9, v193
    v_cvt_pk_bf16_f32 v130, v192, v193
    v_exp_f32 v194, v194
    v_exp_f32 v195, v195
    v_add_f32 v9, v9, v194
    v_add_f32 v9, v9, v195
    v_cvt_pk_bf16_f32 v131, v194, v195
    v_exp_f32 v196, v196
    v_exp_f32 v197, v197
    v_add_f32 v10, v10, v196
    v_add_f32 v10, v10, v197
    v_cvt_pk_bf16_f32 v134, v196, v197
    v_exp_f32 v198, v198
    v_exp_f32 v199, v199
    v_add_f32 v10, v10, v198
    v_add_f32 v10, v10, v199
    v_cvt_pk_bf16_f32 v135, v198, v199
    s_mov_b32 s17, 0x1c000
    buffer_load_dwordx4 v[200:203], v8, s[8:11], s17 offen offset:0
    buffer_load_dwordx4 v[204:207], v8, s[8:11], s17 offen offset:1024
    buffer_load_dwordx4 v[208:211], v8, s[8:11], s17 offen offset:2048
    buffer_load_dwordx4 v[212:215], v8, s[8:11], s17 offen offset:3072
    s_waitcnt vmcnt(3)
    v_mfma_f32_16x16x32_bf16 v[184:187], v[200:203], v[152:155], v[216:219]
    v_mfma_f32_16x16x32_bf16 v[188:191], v[200:203], v[168:171], v[220:223]
    s_waitcnt vmcnt(2)
    v_mfma_f32_16x16x32_bf16 v[192:195], v[204:207], v[152:155], v[216:219]
    v_mfma_f32_16x16x32_bf16 v[196:199], v[204:207], v[168:171], v[220:223]
    s_waitcnt vmcnt(1)
    v_mfma_f32_16x16x32_bf16 v[184:187], v[208:211], v[156:159], v[184:187]
    v_mfma_f32_16x16x32_bf16 v[188:191], v[208:211], v[172:175], v[188:191]
    s_waitcnt vmcnt(0)
    v_mfma_f32_16x16x32_bf16 v[192:195], v[212:215], v[156:159], v[192:195]
    v_mfma_f32_16x16x32_bf16 v[196:199], v[212:215], v[172:175], v[196:199]
    s_mov_b32 s17, 0x1d000
    buffer_load_dwordx4 v[200:203], v8, s[8:11], s17 offen offset:0
    buffer_load_dwordx4 v[204:207], v8, s[8:11], s17 offen offset:1024
    buffer_load_dwordx4 v[208:211], v8, s[8:11], s17 offen offset:2048
    buffer_load_dwordx4 v[212:215], v8, s[8:11], s17 offen offset:3072
    s_waitcnt vmcnt(3)
    v_mfma_f32_16x16x32_bf16 v[184:187], v[200:203], v[160:163], v[184:187]
    v_mfma_f32_16x16x32_bf16 v[188:191], v[200:203], v[176:179], v[188:191]
    s_waitcnt vmcnt(2)
    v_mfma_f32_16x16x32_bf16 v[192:195], v[204:207], v[160:163], v[192:195]
    v_mfma_f32_16x16x32_bf16 v[196:199], v[204:207], v[176:179], v[196:199]
    s_waitcnt vmcnt(1)
    v_mfma_f32_16x16x32_bf16 v[184:187], v[208:211], v[164:167], v[184:187]
    v_mfma_f32_16x16x32_bf16 v[188:191], v[208:211], v[180:183], v[188:191]
    s_waitcnt vmcnt(0)
    v_mfma_f32_16x16x32_bf16 v[192:195], v[212:215], v[164:167], v[192:195]
    v_mfma_f32_16x16x32_bf16 v[196:199], v[212:215], v[180:183], v[196:199]
    s_nop 3
    v_exp_f32 v184, v184
    v_exp_f32 v185, v185
    v_add_f32 v9, v9, v184
    v_add_f32 v9, v9, v185
    v_cvt_pk_bf16_f32 v136, v184, v185
    v_exp_f32 v186, v186
    v_exp_f32 v187, v187
    v_add_f32 v9, v9, v186
    v_add_f32 v9, v9, v187
    v_cvt_pk_bf16_f32 v137, v186, v187
    v_exp_f32 v188, v188
    v_exp_f32 v189, v189
    v_add_f32 v10, v10, v188
    v_add_f32 v10, v10, v189
    v_cvt_pk_bf16_f32 v140, v188, v189
    v_exp_f32 v190, v190
    v_exp_f32 v191, v191
    v_add_f32 v10, v10, v190
    v_add_f32 v10, v10, v191
    v_cvt_pk_bf16_f32 v141, v190, v191
    v_exp_f32 v192, v192
    v_exp_f32 v193, v193
    v_add_f32 v9, v9, v192
    v_add_f32 v9, v9, v193
    v_cvt_pk_bf16_f32 v138, v192, v193
    v_exp_f32 v194, v194
    v_exp_f32 v195, v195
    v_add_f32 v9, v9, v194
    v_add_f32 v9, v9, v195
    v_cvt_pk_bf16_f32 v139, v194, v195
    v_exp_f32 v196, v196
    v_exp_f32 v197, v197
    v_add_f32 v10, v10, v196
    v_add_f32 v10, v10, v197
    v_cvt_pk_bf16_f32 v142, v196, v197
    v_exp_f32 v198, v198
    v_exp_f32 v199, v199
    v_add_f32 v10, v10, v198
    v_add_f32 v10, v10, v199
    v_cvt_pk_bf16_f32 v143, v198, v199
    s_mov_b32 s17, 0x1e000
    buffer_load_dwordx4 v[200:203], v8, s[8:11], s17 offen offset:0
    buffer_load_dwordx4 v[204:207], v8, s[8:11], s17 offen offset:1024
    buffer_load_dwordx4 v[208:211], v8, s[8:11], s17 offen offset:2048
    buffer_load_dwordx4 v[212:215], v8, s[8:11], s17 offen offset:3072
    s_waitcnt vmcnt(3)
    v_mfma_f32_16x16x32_bf16 v[184:187], v[200:203], v[152:155], v[216:219]
    v_mfma_f32_16x16x32_bf16 v[188:191], v[200:203], v[168:171], v[220:223]
    s_waitcnt vmcnt(2)
    v_mfma_f32_16x16x32_bf16 v[192:195], v[204:207], v[152:155], v[216:219]
    v_mfma_f32_16x16x32_bf16 v[196:199], v[204:207], v[168:171], v[220:223]
    s_waitcnt vmcnt(1)
    v_mfma_f32_16x16x32_bf16 v[184:187], v[208:211], v[156:159], v[184:187]
    v_mfma_f32_16x16x32_bf16 v[188:191], v[208:211], v[172:175], v[188:191]
    s_waitcnt vmcnt(0)
    v_mfma_f32_16x16x32_bf16 v[192:195], v[212:215], v[156:159], v[192:195]
    v_mfma_f32_16x16x32_bf16 v[196:199], v[212:215], v[172:175], v[196:199]
    s_mov_b32 s17, 0x1f000
    buffer_load_dwordx4 v[200:203], v8, s[8:11], s17 offen offset:0
    buffer_load_dwordx4 v[204:207], v8, s[8:11], s17 offen offset:1024
    buffer_load_dwordx4 v[208:211], v8, s[8:11], s17 offen offset:2048
    buffer_load_dwordx4 v[212:215], v8, s[8:11], s17 offen offset:3072
    s_waitcnt vmcnt(3)
    v_mfma_f32_16x16x32_bf16 v[184:187], v[200:203], v[160:163], v[184:187]
    v_mfma_f32_16x16x32_bf16 v[188:191], v[200:203], v[176:179], v[188:191]
    s_waitcnt vmcnt(2)
    v_mfma_f32_16x16x32_bf16 v[192:195], v[204:207], v[160:163], v[192:195]
    v_mfma_f32_16x16x32_bf16 v[196:199], v[204:207], v[176:179], v[196:199]
    s_waitcnt vmcnt(1)
    v_mfma_f32_16x16x32_bf16 v[184:187], v[208:211], v[164:167], v[184:187]
    v_mfma_f32_16x16x32_bf16 v[188:191], v[208:211], v[180:183], v[188:191]
    s_waitcnt vmcnt(0)
    v_mfma_f32_16x16x32_bf16 v[192:195], v[212:215], v[164:167], v[192:195]
    v_mfma_f32_16x16x32_bf16 v[196:199], v[212:215], v[180:183], v[196:199]
    s_nop 3
    v_exp_f32 v184, v184
    v_exp_f32 v185, v185
    v_add_f32 v9, v9, v184
    v_add_f32 v9, v9, v185
    v_cvt_pk_bf16_f32 v144, v184, v185
    v_exp_f32 v186, v186
    v_exp_f32 v187, v187
    v_add_f32 v9, v9, v186
    v_add_f32 v9, v9, v187
    v_cvt_pk_bf16_f32 v145, v186, v187
    v_exp_f32 v188, v188
    v_exp_f32 v189, v189
    v_add_f32 v10, v10, v188
    v_add_f32 v10, v10, v189
    v_cvt_pk_bf16_f32 v148, v188, v189
    v_exp_f32 v190, v190
    v_exp_f32 v191, v191
    v_add_f32 v10, v10, v190
    v_add_f32 v10, v10, v191
    v_cvt_pk_bf16_f32 v149, v190, v191
    v_exp_f32 v192, v192
    v_exp_f32 v193, v193
    v_add_f32 v9, v9, v192
    v_add_f32 v9, v9, v193
    v_cvt_pk_bf16_f32 v146, v192, v193
    v_exp_f32 v194, v194
    v_exp_f32 v195, v195
    v_add_f32 v9, v9, v194
    v_add_f32 v9, v9, v195
    v_cvt_pk_bf16_f32 v147, v194, v195
    v_exp_f32 v196, v196
    v_exp_f32 v197, v197
    v_add_f32 v10, v10, v196
    v_add_f32 v10, v10, v197
    v_cvt_pk_bf16_f32 v150, v196, v197
    v_exp_f32 v198, v198
    v_exp_f32 v199, v199
    v_add_f32 v10, v10, v198
    v_add_f32 v10, v10, v199
    v_cvt_pk_bf16_f32 v151, v198, v199
    v_mov_b32 v16, v9
    v_mov_b32 v18, v10
    s_nop 0
    v_permlane16_swap_b32 v9, v16
    v_permlane16_swap_b32 v10, v18
    v_add_f32 v9, v9, v16
    v_add_f32 v10, v10, v18
    v_mov_b32 v16, v9
    v_mov_b32 v18, v10
    s_nop 0
    v_permlane32_swap_b32 v9, v16
    v_permlane32_swap_b32 v10, v18
    v_add_f32 v9, v9, v16
    v_add_f32 v10, v10, v18
    s_waitcnt vmcnt(0) lgkmcnt(0)
    s_nop 15
    s_nop 3
    s_branch adaLN_cond__sliding_block_cached__moe_arch_mod__prompt_kernel_fixBb
adaLN_cond__sliding_block_cached__moe_arch_mod__prompt_kernel_o17r:
    s_waitcnt vmcnt(0) lgkmcnt(0)
    s_nop 15
    s_nop 3
    s_mov_b32 s27, 0
adaLN_cond__sliding_block_cached__moe_arch_mod__prompt_kernel_o17p:
    buffer_load_dword v12, v13, s[8:11], s19 offen sc1
    s_waitcnt vmcnt(0)
    v_cmp_ne_u32 vcc, s28, v12
    s_add_u32 s27, s27, 1
    s_cmp_ge_u32 s27, 65536
    s_cbranch_scc1 adaLN_cond__sliding_block_cached__moe_arch_mod__prompt_kernel_o17g
    s_cbranch_vccnz adaLN_cond__sliding_block_cached__moe_arch_mod__prompt_kernel_o17p
adaLN_cond__sliding_block_cached__moe_arch_mod__prompt_kernel_o17g:
    s_waitcnt vmcnt(0) lgkmcnt(0)
    s_nop 15
    s_nop 3
    s_branch adaLN_cond__sliding_block_cached__moe_arch_mod__prompt_kernel_o17b
adaLN_cond__sliding_block_cached__moe_arch_mod__prompt_kernel_o218r:
    s_waitcnt vmcnt(0) lgkmcnt(0)
    s_nop 15
    s_nop 3
    s_mov_b32 s27, 0
adaLN_cond__sliding_block_cached__moe_arch_mod__prompt_kernel_o218p:
    buffer_load_dword v12, v13, s[8:11], s19 offen sc1
    s_waitcnt vmcnt(0)
    v_cmp_ne_u32 vcc, s28, v12
    s_add_u32 s27, s27, 1
    s_cmp_ge_u32 s27, 65536
    s_cbranch_scc1 adaLN_cond__sliding_block_cached__moe_arch_mod__prompt_kernel_o218g
    s_cbranch_vccnz adaLN_cond__sliding_block_cached__moe_arch_mod__prompt_kernel_o218p
adaLN_cond__sliding_block_cached__moe_arch_mod__prompt_kernel_o218g:
    s_waitcnt vmcnt(0) lgkmcnt(0)
    s_nop 15
    s_nop 3
    s_branch adaLN_cond__sliding_block_cached__moe_arch_mod__prompt_kernel_o218b
adaLN_cond__sliding_block_cached__moe_arch_mod__prompt_kernel_o219r:
    s_waitcnt vmcnt(0) lgkmcnt(0)
    s_nop 15
    s_nop 3
    s_mov_b32 s27, 0
adaLN_cond__sliding_block_cached__moe_arch_mod__prompt_kernel_o219p:
    buffer_load_dword v12, v13, s[8:11], s19 offen sc1
    s_waitcnt vmcnt(0)
    v_cmp_ne_u32 vcc, s28, v12
    s_add_u32 s27, s27, 1
    s_cmp_ge_u32 s27, 65536
    s_cbranch_scc1 adaLN_cond__sliding_block_cached__moe_arch_mod__prompt_kernel_o219g
    s_cbranch_vccnz adaLN_cond__sliding_block_cached__moe_arch_mod__prompt_kernel_o219p
adaLN_cond__sliding_block_cached__moe_arch_mod__prompt_kernel_o219g:
    s_waitcnt vmcnt(0) lgkmcnt(0)
    s_nop 15
    s_nop 3
    s_branch adaLN_cond__sliding_block_cached__moe_arch_mod__prompt_kernel_o219b
adaLN_cond__sliding_block_cached__moe_arch_mod__prompt_kernel_o220r:
    s_waitcnt vmcnt(0) lgkmcnt(0)
    s_nop 15
    s_nop 3
    s_mov_b32 s27, 0
adaLN_cond__sliding_block_cached__moe_arch_mod__prompt_kernel_o220p:
    buffer_load_dword v12, v13, s[8:11], s19 offen sc1
    s_waitcnt vmcnt(0)
    v_cmp_ne_u32 vcc, s28, v12
    s_add_u32 s27, s27, 1
    s_cmp_ge_u32 s27, 65536
    s_cbranch_scc1 adaLN_cond__sliding_block_cached__moe_arch_mod__prompt_kernel_o220g
    s_cbranch_vccnz adaLN_cond__sliding_block_cached__moe_arch_mod__prompt_kernel_o220p
adaLN_cond__sliding_block_cached__moe_arch_mod__prompt_kernel_o220g:
    s_waitcnt vmcnt(0) lgkmcnt(0)
    s_nop 15
    s_nop 3
    s_branch adaLN_cond__sliding_block_cached__moe_arch_mod__prompt_kernel_o220b
adaLN_cond__sliding_block_cached__moe_arch_mod__prompt_kernel_mf21r:
    s_waitcnt vmcnt(0) lgkmcnt(0)
    s_nop 15
    s_nop 3
    s_mov_b32 s27, 0
adaLN_cond__sliding_block_cached__moe_arch_mod__prompt_kernel_mf21p:
    s_mov_b32 s16, 0x544000
    buffer_load_dwordx4 v[184:187], v2, s[8:11], s16 offen sc1
    s_waitcnt vmcnt(0)
    v_xor_b32 v16, s28, v184
    v_xor_b32 v17, s28, v185
    v_xor_b32 v18, s28, v186
    v_xor_b32 v19, s28, v187
    v_or3_b32 v16, v16, v17, v18
    v_or_b32 v16, v16, v19
    v_cmp_ne_u32 vcc, 0, v16
    s_add_u32 s27, s27, 1
    s_cmp_ge_u32 s27, 65536
    s_cbranch_scc1 adaLN_cond__sliding_block_cached__moe_arch_mod__prompt_kernel_mf21g
    s_cbranch_vccnz adaLN_cond__sliding_block_cached__moe_arch_mod__prompt_kernel_mf21p
adaLN_cond__sliding_block_cached__moe_arch_mod__prompt_kernel_mf21g:
    s_waitcnt vmcnt(0) lgkmcnt(0)
    s_nop 15
    s_nop 3
    s_branch adaLN_cond__sliding_block_cached__moe_arch_mod__prompt_kernel_mf21b
adaLN_cond__sliding_block_cached__moe_arch_mod__prompt_kernel_codeend:
    s_endpgm
.section .rodata,"a"
.p2align 6
.amdhsa_kernel adaLN_cond__sliding_block_cached__moe_arch_mod__prompt_kernel
  .amdhsa_next_free_vgpr 256
  .amdhsa_next_free_sgpr 80
  .amdhsa_accum_offset 256
  .amdhsa_group_segment_fixed_size 0
  .amdhsa_kernarg_size 120
  .amdhsa_user_sgpr_count 2
  .amdhsa_user_sgpr_kernarg_segment_ptr 1
  .amdhsa_system_sgpr_workgroup_id_x 1
  .amdhsa_float_denorm_mode_32 3
.end_amdhsa_kernel
```

```asm
; @launch grid=(256,1,1) block=(512,1,1) lds=163840
.amdgcn_target "amdgcn-amd-amdhsa--gfx950"
.text
.globl adaLN_cond__sliding_block_cached__moe_arch_mod__prompt_kernel
.p2align 8
.type adaLN_cond__sliding_block_cached__moe_arch_mod__prompt_kernel,@function
adaLN_cond__sliding_block_cached__moe_arch_mod__prompt_kernel:
    s_cmp_ge_u32 s2, 256
    s_cbranch_scc1 adaLN_cond__sliding_block_cached__moe_arch_mod__prompt_kernel_end
    s_getpc_b64 s[76:77]
adaLN_cond__sliding_block_cached__moe_arch_mod__prompt_kernel_pc0:
    s_sub_u32 s76, s76, adaLN_cond__sliding_block_cached__moe_arch_mod__prompt_kernel_pc0-adaLN_cond__sliding_block_cached__moe_arch_mod__prompt_kernel
    s_subb_u32 s77, s77, 0
    v_and_b32 v16, 63, v0
    v_lshlrev_b32 v16, 7, v16
    v_lshrrev_b32 v17, 6, v0
    s_lshr_b32 s62, s2, 3
    s_lshl_b32 s62, s62, 13
    v_lshlrev_b32 v18, 13, v17
    v_mov_b32 v19, s62
    v_cmp_eq_u32 vcc, 7, v17
    s_nop 1
    v_cndmask_b32 v18, v18, v19, vcc
    v_add_u32 v16, v16, v18
    v_min_u32 v16, adaLN_cond__sliding_block_cached__moe_arch_mod__prompt_kernel_codeend-adaLN_cond__sliding_block_cached__moe_arch_mod__prompt_kernel-4, v16
    v_mov_b32 v25, s77
    v_add_co_u32 v24, vcc, s76, v16
    s_nop 1
    v_addc_co_u32 v25, vcc, 0, v25, vcc
    v_cmp_gt_u32 vcc, 2, v17
    v_cmp_eq_u32 s[62:63], 7, v17
    s_or_b64 vcc, vcc, s[62:63]
    s_and_saveexec_b64 s[62:63], vcc
    s_cbranch_execz adaLN_cond__sliding_block_cached__moe_arch_mod__prompt_kernel_nocp0
    global_load_dword v26, v[24:25], off
adaLN_cond__sliding_block_cached__moe_arch_mod__prompt_kernel_nocp0:
    s_mov_b64 exec, s[62:63]
    s_load_dwordx4 s[56:59], s[0:1], 96
    s_load_dwordx2 s[60:61], s[0:1], 112
    s_load_dwordx8 s[48:55], s[0:1], 64
    s_load_dwordx16 s[32:47], s[0:1], 0
    s_memrealtime s[62:63]
    v_lshrrev_b32 v16, 6, v0
    v_and_b32 v1, 63, v0
    v_readfirstlane_b32 s3, v16
    v_lshlrev_b32 v2, 4, v1
    s_and_b32 s12, s2, 3
    s_lshl_b32 s12, s12, 3
    s_bfe_u32 s13, s2, 0x30003
    s_add_u32 s12, s12, s13
    s_bfe_u32 s13, s2, 0x10002
    s_lshl_b32 s13, s13, 2
    s_lshr_b32 s14, s2, 6
    s_add_u32 s13, s13, s14
    v_bfe_u32 v16, v1, 2, 2
    v_lshrrev_b32 v17, 4, v1
    v_and_b32 v18, 3, v1
    v_lshlrev_b32 v19, 6, v17
    v_lshl_add_u32 v19, v18, 4, v19
    v_lshl_add_u32 v3, v16, 13, v19
    s_and_b32 s14, s3, 1
    s_lshl_b32 s14, s14, 5
    v_xor_b32 v3, s14, v3
    v_lshlrev_b32 v4, 11, v17
    v_lshl_add_u32 v4, v16, 6, v4
    v_lshl_add_u32 v4, v18, 3, v4
    v_and_b32 v20, 1, v17
    v_lshlrev_b32 v20, 5, v20
    v_sub_u32 v5, v4, v20
    v_add_u32 v4, v4, v20
    s_lshl_b32 s14, s13, 3
    s_add_u32 s14, s14, s3
    s_lshl_b32 s14, s14, 16
    v_add_u32 v7, s14, v2
    s_cmp_ge_u32 s3, 4
    s_cbranch_scc1 adaLN_cond__sliding_block_cached__moe_arch_mod__prompt_kernel_roleB
    v_mov_b32 v132, 0
    v_mov_b32 v133, 0
    v_lshrrev_b32 v16, 3, v0
    v_and_b32 v17, 7, v0
    v_mul_u32_u24 v135, 24576, v16
    v_lshl_add_u32 v135, v17, 4, v135
    v_lshlrev_b32 v136, 2, v16
    s_and_b32 s14, s2, 31
    s_lshr_b32 s15, s2, 5
    s_mul_i32 s26, s15, 1572864
    s_lshl_b32 s16, s14, 7
    s_add_u32 s26, s26, s16
    s_lshl_b32 s29, s15, 8
    v_lshlrev_b32 v137, 3, v0
    s_lshl_b32 s18, s2, 3
    s_add_u32 s18, s18, s3
    s_lshl_b32 s18, s18, 11
    v_and_b32 v18, 15, v1
    v_lshrrev_b32 v19, 4, v1
    v_lshlrev_b32 v138, 11, v18
    v_lshl_add_u32 v138, v19, 4, v138
    s_lshr_b32 s30, s2, 4
    s_and_b32 s31, s2, 15
    s_lshl_b32 s19, s30, 3
    s_add_u32 s19, s19, s3
    s_lshl_b32 s22, s19, 15
    s_lshl_b32 s23, s31, 7
    s_add_u32 s22, s22, s23
    s_lshl_b32 s23, s2, 12
    s_add_u32 s23, s23, 0x600000
    s_or_b32 s25, s2, s3
    s_cmp_eq_u32 s25, 0
    s_cselect_b32 s25, 0, 0x7ffffff0
    s_waitcnt lgkmcnt(0)
    s_mov_b64 s[64:65], s[58:59]
    s_mov_b32 s66, 0x100
    s_mov_b32 s67, 0x20000
    s_or_b32 s28, s62, 1
    v_mov_b32 v134, s28
    s_mov_b64 exec, 1
    buffer_store_dword v134, v132, s[64:67], s25 offen sc1
    s_mov_b64 exec, -1
    s_mov_b64 s[68:69], s[52:53]
    s_mov_b32 s70, 0x800
    s_mov_b32 s71, 0x20000
    s_mov_b64 s[72:73], s[54:55]
    s_mov_b32 s74, 0xc00000
    s_mov_b32 s75, 0x20000
    s_mov_b64 s[76:77], s[32:33]
    s_mov_b32 s78, 0x400000
    s_mov_b32 s79, 0x20000
    s_mov_b64 s[8:9], s[60:61]
    s_mov_b32 s10, 0x3400000
    s_mov_b32 s11, 0x20000
    buffer_load_dwordx4 v[32:35], v2, s[76:79], s18 offen offset:0
    buffer_load_dwordx4 v[36:39], v2, s[76:79], s18 offen offset:1024
    buffer_load_dword v72, v136, s[68:71], s29 offen
    buffer_load_dwordx4 v[24:27], v135, s[72:75], s26 offen
    s_add_u32 s26, s26, 12288
    buffer_load_dwordx4 v[28:31], v135, s[72:75], s26 offen
    s_cmp_eq_u32 s3, 0
    s_cselect_b32 s25, 0, 0x7ffffff0
    buffer_load_dword v134, v132, s[64:67], s25 offen sc1
    buffer_store_dwordx2 v[132:133], v137, s[8:11], s23 offen sc1
    s_barrier
    buffer_load_dwordx4 v[40:43], v138, s[76:79], s22 offen offset:0
    buffer_load_dwordx4 v[44:47], v138, s[76:79], s22 offen offset:64
    s_mov_b32 s29, s19
    s_waitcnt vmcnt(8)
    v_lshlrev_b32 v56, 16, v32
    v_and_b32 v57, 0xffff0000, v32
    v_lshlrev_b32 v58, 16, v33
    v_and_b32 v59, 0xffff0000, v33
    v_lshlrev_b32 v60, 16, v34
    v_and_b32 v61, 0xffff0000, v34
    v_lshlrev_b32 v62, 16, v35
    v_and_b32 v63, 0xffff0000, v35
    s_waitcnt vmcnt(7)
    v_lshlrev_b32 v64, 16, v36
    v_and_b32 v65, 0xffff0000, v36
    v_lshlrev_b32 v66, 16, v37
    v_and_b32 v67, 0xffff0000, v37
    v_lshlrev_b32 v68, 16, v38
    v_and_b32 v69, 0xffff0000, v38
    v_lshlrev_b32 v70, 16, v39
    v_and_b32 v71, 0xffff0000, v39
    v_add_f32 v20, v56, v57
    v_add_f32 v21, v58, v59
    v_add_f32 v20, v20, v60
    v_add_f32 v21, v21, v61
    v_add_f32 v20, v20, v62
    v_add_f32 v21, v21, v63
    v_add_f32 v20, v20, v64
    v_add_f32 v21, v21, v65
    v_add_f32 v20, v20, v66
    v_add_f32 v21, v21, v67
    v_add_f32 v20, v20, v68
    v_add_f32 v21, v21, v69
    v_add_f32 v20, v20, v70
    v_add_f32 v21, v21, v71
    v_add_f32 v128, v20, v21
    s_nop 1
    v_add_f32_dpp v128, v128, v128 row_ror:1 row_mask:0xf bank_mask:0xf
    s_nop 1
    v_add_f32_dpp v128, v128, v128 row_ror:2 row_mask:0xf bank_mask:0xf
    s_nop 1
    v_add_f32_dpp v128, v128, v128 row_ror:4 row_mask:0xf bank_mask:0xf
    s_nop 1
    v_add_f32_dpp v128, v128, v128 row_ror:8 row_mask:0xf bank_mask:0xf
    v_mov_b32 v20, v128
    s_nop 1
    v_permlane16_swap_b32 v128, v20
    v_add_f32 v128, v128, v20
    v_mov_b32 v20, v128
    s_nop 1
    v_permlane32_swap_b32 v128, v20
    v_add_f32 v128, v128, v20
    v_mul_f32 v128, 0x3a800000, v128
    v_sub_f32 v18, v56, v128
    v_mul_f32 v20, v18, v18
    v_sub_f32 v19, v57, v128
    v_mul_f32 v21, v19, v19
    v_sub_f32 v18, v58, v128
    v_sub_f32 v19, v59, v128
    v_fmac_f32 v20, v18, v18
    v_fmac_f32 v21, v19, v19
    v_sub_f32 v18, v60, v128
    v_sub_f32 v19, v61, v128
    v_fmac_f32 v20, v18, v18
    v_fmac_f32 v21, v19, v19
    v_sub_f32 v18, v62, v128
    v_sub_f32 v19, v63, v128
    v_fmac_f32 v20, v18, v18
    v_fmac_f32 v21, v19, v19
    v_sub_f32 v18, v64, v128
    v_sub_f32 v19, v65, v128
    v_fmac_f32 v20, v18, v18
    v_fmac_f32 v21, v19, v19
    v_sub_f32 v18, v66, v128
    v_sub_f32 v19, v67, v128
    v_fmac_f32 v20, v18, v18
    v_fmac_f32 v21, v19, v19
    v_sub_f32 v18, v68, v128
    v_sub_f32 v19, v69, v128
    v_fmac_f32 v20, v18, v18
    v_fmac_f32 v21, v19, v19
    v_sub_f32 v18, v70, v128
    v_sub_f32 v19, v71, v128
    v_fmac_f32 v20, v18, v18
    v_fmac_f32 v21, v19, v19
    v_add_f32 v17, v20, v21
    s_nop 1
    v_add_f32_dpp v17, v17, v17 row_ror:1 row_mask:0xf bank_mask:0xf
    s_nop 1
    v_add_f32_dpp v17, v17, v17 row_ror:2 row_mask:0xf bank_mask:0xf
    s_nop 1
    v_add_f32_dpp v17, v17, v17 row_ror:4 row_mask:0xf bank_mask:0xf
    s_nop 1
    v_add_f32_dpp v17, v17, v17 row_ror:8 row_mask:0xf bank_mask:0xf
    v_mov_b32 v20, v17
    s_nop 1
    v_permlane16_swap_b32 v17, v20
    v_add_f32 v17, v17, v20
    v_mov_b32 v20, v17
    s_nop 1
    v_permlane32_swap_b32 v17, v20
    v_add_f32 v17, v17, v20
    v_mul_f32 v17, 0x3a800000, v17
    v_cvt_pk_bf16_f32 v128, v128, v128
    v_lshlrev_b32 v128, 16, v128
    v_cvt_pk_bf16_f32 v17, v17, v17
    v_lshlrev_b32 v17, 16, v17
    v_add_f32 v17, 0x3727c5ac, v17
    v_cvt_pk_bf16_f32 v17, v17, v17
    v_lshlrev_b32 v17, 16, v17
    v_sqrt_f32 v129, v17
    s_nop 0
    v_cvt_pk_bf16_f32 v129, v129, v129
    v_lshlrev_b32 v129, 16, v129
    v_rcp_f32 v130, v129
    s_lshl_b32 s16, s3, 4
    s_add_u32 s16, s16, 149520
    v_mov_b32 v19, s16
    ds_write_b128 v19, v[128:131]
    s_waitcnt vmcnt(6)
    v_and_b32 v73, 0xffff0000, v72
    v_lshlrev_b32 v72, 16, v72
    v_mul_f32 v16, 0xbfb8aa3b, v72
    v_exp_f32 v16, v16
    s_nop 0
    v_add_f32 v16, 1.0, v16
    v_rcp_f32 v16, v16
    s_nop 0
    v_mul_f32 v72, v72, v16
    v_mul_f32 v17, 0xbfb8aa3b, v73
    v_exp_f32 v17, v17
    s_nop 0
    v_add_f32 v17, 1.0, v17
    v_rcp_f32 v17, v17
    s_nop 0
    v_mul_f32 v73, v73, v17
    v_cvt_pk_bf16_f32 v16, v72, v73
    v_lshlrev_b32 v72, 16, v16
    v_and_b32 v73, 0xffff0000, v16
    s_lshl_b32 s16, s2, 8
    s_add_u32 s16, s16, 0x550000
    s_mov_b32 exec_lo, 0x01010101
    s_mov_b32 exec_hi, 0x01010101
    buffer_store_dword v16, v136, s[8:11], s16 offen sc1
    s_mov_b64 exec, -1
    v_lshrrev_b32 v74, 16, v72
    v_lshrrev_b32 v75, 16, v73
    s_waitcnt vmcnt(6)
    v_dot2_f32_bf16 v49, v24, v72, 0
    v_dot2_f32_bf16 v48, v24, v74, 0
    v_dot2_f32_bf16 v51, v25, v72, 0
    v_dot2_f32_bf16 v50, v25, v74, 0
    v_dot2_f32_bf16 v53, v26, v72, 0
    v_dot2_f32_bf16 v52, v26, v74, 0
    v_dot2_f32_bf16 v55, v27, v72, 0
    v_dot2_f32_bf16 v54, v27, v74, 0
    s_waitcnt vmcnt(5)
    v_dot2c_f32_bf16 v49, v28, v73
    v_dot2c_f32_bf16 v48, v28, v75
    v_dot2c_f32_bf16 v51, v29, v73
    v_dot2c_f32_bf16 v50, v29, v75
    v_dot2c_f32_bf16 v53, v30, v73
    v_dot2c_f32_bf16 v52, v30, v75
    v_dot2c_f32_bf16 v55, v31, v73
    v_dot2c_f32_bf16 v54, v31, v75
    s_nop 0
    v_permlane32_swap_b32 v48, v52
    v_permlane32_swap_b32 v49, v53
    v_permlane32_swap_b32 v50, v54
    v_permlane32_swap_b32 v51, v55
    v_add_f32 v48, v48, v52
    v_add_f32 v49, v49, v53
    v_add_f32 v50, v50, v54
    v_add_f32 v51, v51, v55
    s_nop 0
    v_permlane16_swap_b32 v48, v50
    v_permlane16_swap_b32 v49, v51
    v_add_f32 v48, v48, v50
    v_add_f32 v49, v49, v51
    s_nop 0
    v_add_f32_dpp v48, v48, v48 row_ror:8 row_mask:0xf bank_mask:0xf
    v_add_f32_dpp v49, v49, v49 row_ror:8 row_mask:0xf bank_mask:0xf
    v_and_b32 v16, 7, v1
    v_lshlrev_b32 v16, 5, v16
    v_lshrrev_b32 v17, 4, v1
    v_lshl_add_u32 v16, v17, 3, v16
    s_lshl_b32 s16, s3, 8
    s_add_u32 s16, s16, 147456
    v_add_u32 v16, s16, v16
    ds_write_b64 v16, v[48:49]
    s_waitcnt vmcnt(4)
    v_cmp_eq_u32 vcc, 0, v134
    s_cmp_eq_u32 s3, 0
    s_cselect_b64 s[62:63], -1, 0
    s_and_b64 vcc, vcc, s[62:63]
    s_cbranch_vccnz adaLN_cond__sliding_block_cached__moe_arch_mod__prompt_kernel_n1r
adaLN_cond__sliding_block_cached__moe_arch_mod__prompt_kernel_n1b:
    v_mov_b32 v19, 149504
    s_cmp_eq_u32 s3, 0
    s_cselect_b64 exec, 1, 0
    ds_write_b32 v19, v134
    s_mov_b64 exec, -1
    v_mov_b32 v19, 149504
    v_and_b32 v17, 31, v1
    v_lshlrev_b32 v18, 3, v17
    v_add_u32 v18, 147456, v18
    v_lshlrev_b32 v17, 4, v17
    s_waitcnt lgkmcnt(0)
    s_barrier
    ds_read_b32 v134, v19
    ds_read_b64 v[96:97], v18 offset:0
    ds_read_b64 v[100:101], v18 offset:256
    ds_read_b64 v[104:105], v18 offset:512
    ds_read_b64 v[108:109], v18 offset:768
    ds_read_b64 v[112:113], v18 offset:1024
    ds_read_b64 v[116:117], v18 offset:1280
    ds_read_b64 v[120:121], v18 offset:1536
    ds_read_b64 v[124:125], v18 offset:1792
    s_waitcnt lgkmcnt(8)
    v_readfirstlane_b32 s28, v134
    v_and_b32 v20, 7, v1
    v_lshlrev_b32 v20, 4, v20
    v_add_u32 v21, 149520, v20
    ds_read_b128 v[128:131], v21
    s_waitcnt lgkmcnt(0)
    v_mov_b32 v131, s28
    s_lshl_b32 s16, s2, 7
    s_add_u32 s16, s16, 0x520000
    s_cmp_eq_u32 s3, 0
    s_cselect_b32 s16, s16, 0x7ffffff0
    s_mov_b64 exec, 0xff
    buffer_store_dwordx4 v[128:131], v20, s[8:11], s16 offen sc1
    s_mov_b64 exec, -1
    v_pk_add_f32 v[96:97], v[96:97], v[112:113]
    v_pk_add_f32 v[100:101], v[100:101], v[116:117]
    v_pk_add_f32 v[104:105], v[104:105], v[120:121]
    v_pk_add_f32 v[108:109], v[108:109], v[124:125]
    v_pk_add_f32 v[96:97], v[96:97], v[104:105]
    v_pk_add_f32 v[100:101], v[100:101], v[108:109]
    v_pk_add_f32 v[96:97], v[96:97], v[100:101]
    v_mov_b32 v98, s28
    v_mov_b32 v99, s28
    s_lshl_b32 s16, s14, 3
    s_add_u32 s16, s16, s15
    s_lshl_b32 s16, s16, 9
    s_add_u32 s16, s16, 0x500000
    s_cmp_eq_u32 s3, 0
    s_cselect_b32 s16, s16, 0x7ffffff0
    s_mov_b64 exec, 0xffffffff
    buffer_store_dwordx4 v[96:99], v17, s[8:11], s16 offen sc1
    s_mov_b64 exec, -1
    s_lshr_b32 s16, s3, 2
    s_lshl_b32 s16, s16, 4
    s_add_u32 s16, s16, s31
    s_lshl_b32 s16, s16, 12
    s_and_b32 s17, s3, 3
    s_lshl_b32 s17, s17, 7
    s_add_u32 s16, s16, s17
    s_add_u32 s16, s16, 0x500000
    v_lshrrev_b32 v139, 3, v1
    v_lshlrev_b32 v139, 9, v139
    v_and_b32 v16, 7, v1
    v_lshl_add_u32 v139, v16, 4, v139
    v_and_b32 v140, 15, v1
    v_lshlrev_b32 v140, 4, v140
    s_lshl_b32 s17, s29, 8
    s_add_u32 s17, s17, 0x520000
    s_waitcnt vmcnt(4)
    v_lshlrev_b32 v56, 16, v40
    v_and_b32 v57, 0xffff0000, v40
    v_lshlrev_b32 v58, 16, v41
    v_and_b32 v59, 0xffff0000, v41
    v_lshlrev_b32 v60, 16, v42
    v_and_b32 v61, 0xffff0000, v42
    v_lshlrev_b32 v62, 16, v43
    v_and_b32 v63, 0xffff0000, v43
    s_waitcnt vmcnt(3)
    v_lshlrev_b32 v64, 16, v44
    v_and_b32 v65, 0xffff0000, v44
    v_lshlrev_b32 v66, 16, v45
    v_and_b32 v67, 0xffff0000, v45
    v_lshlrev_b32 v68, 16, v46
    v_and_b32 v69, 0xffff0000, v46
    v_lshlrev_b32 v70, 16, v47
    v_and_b32 v71, 0xffff0000, v47
    s_mov_b32 s27, 0
adaLN_cond__sliding_block_cached__moe_arch_mod__prompt_kernel_g2p:
    buffer_load_dwordx4 v[76:79], v139, s[8:11], s16 offen sc1
    buffer_load_dwordx4 v[80:83], v140, s[8:11], s17 offen sc1
    s_waitcnt vmcnt(1)
    v_cmp_ne_u32 vcc, s28, v78
    v_cmp_ne_u32 s[62:63], s28, v79
    s_or_b64 vcc, vcc, s[62:63]
    s_waitcnt vmcnt(0)
    v_cmp_ne_u32 s[62:63], s28, v83
    s_or_b64 vcc, vcc, s[62:63]
    s_add_u32 s27, s27, 1
    s_cmp_ge_u32 s27, 65536
    s_cbranch_scc1 adaLN_cond__sliding_block_cached__moe_arch_mod__prompt_kernel_g2g
    s_cbranch_vccnz adaLN_cond__sliding_block_cached__moe_arch_mod__prompt_kernel_g2p
adaLN_cond__sliding_block_cached__moe_arch_mod__prompt_kernel_g2g:
    v_add_f32_dpp v76, v76, v76 row_ror:8 row_mask:0xf bank_mask:0xf
    v_add_f32_dpp v77, v77, v77 row_ror:8 row_mask:0xf bank_mask:0xf
    v_mov_b32 v17, v76
    s_nop 1
    v_permlane16_swap_b32 v76, v17
    v_add_f32 v76, v76, v17
    v_mov_b32 v18, v77
    s_nop 1
    v_permlane16_swap_b32 v77, v18
    v_add_f32 v77, v77, v18
    v_mov_b32 v17, v76
    s_nop 1
    v_permlane32_swap_b32 v76, v17
    v_add_f32 v76, v76, v17
    v_mov_b32 v18, v77
    s_nop 1
    v_permlane32_swap_b32 v77, v18
    v_add_f32 v77, v77, v18
    v_cvt_pk_bf16_f32 v17, v76, v77
    v_lshlrev_b32 v76, 16, v17
    v_and_b32 v77, 0xffff0000, v17
    v_add_f32 v76, 0, v76
    v_add_f32 v77, 0, v77
    s_lshl_b32 s16, s3, 6
    s_add_u32 s16, s16, 151552
    v_lshl_add_u32 v16, v16, 3, s16
    ds_write_b64 v16, v[76:77]
    v_lshrrev_b32 v17, 4, v1
    v_lshlrev_b32 v17, 5, v17
    v_add_u32 v17, 151552, v17
    v_sub_f32 v56, v56, v80
    v_sub_f32 v57, v57, v80
    v_sub_f32 v58, v58, v80
    v_sub_f32 v59, v59, v80
    v_sub_f32 v60, v60, v80
    v_sub_f32 v61, v61, v80
    v_sub_f32 v62, v62, v80
    v_sub_f32 v63, v63, v80
    v_sub_f32 v64, v64, v80
    v_sub_f32 v65, v65, v80
    v_sub_f32 v66, v66, v80
    v_sub_f32 v67, v67, v80
    v_sub_f32 v68, v68, v80
    v_sub_f32 v69, v69, v80
    v_sub_f32 v70, v70, v80
    v_sub_f32 v71, v71, v80
    v_cvt_pk_bf16_f32 v18, v56, v57
    v_lshlrev_b32 v56, 16, v18
    v_and_b32 v57, 0xffff0000, v18
    v_cvt_pk_bf16_f32 v19, v58, v59
    v_lshlrev_b32 v58, 16, v19
    v_and_b32 v59, 0xffff0000, v19
    v_cvt_pk_bf16_f32 v18, v60, v61
    v_lshlrev_b32 v60, 16, v18
    v_and_b32 v61, 0xffff0000, v18
    v_cvt_pk_bf16_f32 v19, v62, v63
    v_lshlrev_b32 v62, 16, v19
    v_and_b32 v63, 0xffff0000, v19
    v_cvt_pk_bf16_f32 v18, v64, v65
    v_lshlrev_b32 v64, 16, v18
    v_and_b32 v65, 0xffff0000, v18
    v_cvt_pk_bf16_f32 v19, v66, v67
    v_lshlrev_b32 v66, 16, v19
    v_and_b32 v67, 0xffff0000, v19
    v_cvt_pk_bf16_f32 v18, v68, v69
    v_lshlrev_b32 v68, 16, v18
    v_and_b32 v69, 0xffff0000, v18
    v_cvt_pk_bf16_f32 v19, v70, v71
    v_lshlrev_b32 v70, 16, v19
    v_and_b32 v71, 0xffff0000, v19
    v_mul_f32 v56, v56, v82
    v_mul_f32 v57, v57, v82
    v_mul_f32 v58, v58, v82
    v_mul_f32 v59, v59, v82
    v_mul_f32 v60, v60, v82
    v_mul_f32 v61, v61, v82
    v_mul_f32 v62, v62, v82
    v_mul_f32 v63, v63, v82
    v_mul_f32 v64, v64, v82
    v_mul_f32 v65, v65, v82
    v_mul_f32 v66, v66, v82
    v_mul_f32 v67, v67, v82
    v_mul_f32 v68, v68, v82
    v_mul_f32 v69, v69, v82
    v_mul_f32 v70, v70, v82
    v_mul_f32 v71, v71, v82
    v_cvt_pk_bf16_f32 v18, v56, v57
    v_lshlrev_b32 v56, 16, v18
    v_and_b32 v57, 0xffff0000, v18
    v_cvt_pk_bf16_f32 v19, v58, v59
    v_lshlrev_b32 v58, 16, v19
    v_and_b32 v59, 0xffff0000, v19
    v_cvt_pk_bf16_f32 v18, v60, v61
    v_lshlrev_b32 v60, 16, v18
    v_and_b32 v61, 0xffff0000, v18
    v_cvt_pk_bf16_f32 v19, v62, v63
    v_lshlrev_b32 v62, 16, v19
    v_and_b32 v63, 0xffff0000, v19
    v_cvt_pk_bf16_f32 v18, v64, v65
    v_lshlrev_b32 v64, 16, v18
    v_and_b32 v65, 0xffff0000, v18
    v_cvt_pk_bf16_f32 v19, v66, v67
    v_lshlrev_b32 v66, 16, v19
    v_and_b32 v67, 0xffff0000, v19
    v_cvt_pk_bf16_f32 v18, v68, v69
    v_lshlrev_b32 v68, 16, v18
    v_and_b32 v69, 0xffff0000, v18
    v_cvt_pk_bf16_f32 v19, v70, v71
    v_lshlrev_b32 v70, 16, v19
    v_and_b32 v71, 0xffff0000, v19
    s_lshl_b32 s16, s29, 15
    s_lshl_b32 s17, s31, 11
    s_add_u32 s16, s16, s17
    s_waitcnt lgkmcnt(0)
    s_barrier
    ds_read_b128 v[96:99], v17 offset:256
    ds_read_b128 v[104:107], v17 offset:0
    ds_read_b128 v[100:103], v17 offset:272
    ds_read_b128 v[108:111], v17 offset:16
    ds_read_b128 v[112:115], v17 offset:384
    ds_read_b128 v[120:123], v17 offset:128
    ds_read_b128 v[116:119], v17 offset:400
    ds_read_b128 v[124:127], v17 offset:144
    s_waitcnt lgkmcnt(7)
    v_pk_mul_f32 v[56:57], v[56:57], v[96:97]
    v_pk_mul_f32 v[58:59], v[58:59], v[98:99]
    s_waitcnt lgkmcnt(5)
    v_pk_mul_f32 v[60:61], v[60:61], v[100:101]
    v_pk_mul_f32 v[62:63], v[62:63], v[102:103]
    v_cvt_pk_bf16_f32 v18, v56, v57
    v_lshlrev_b32 v56, 16, v18
    v_and_b32 v57, 0xffff0000, v18
    v_cvt_pk_bf16_f32 v19, v58, v59
    v_lshlrev_b32 v58, 16, v19
    v_and_b32 v59, 0xffff0000, v19
    v_cvt_pk_bf16_f32 v18, v60, v61
    v_lshlrev_b32 v60, 16, v18
    v_and_b32 v61, 0xffff0000, v18
    v_cvt_pk_bf16_f32 v19, v62, v63
    v_lshlrev_b32 v62, 16, v19
    v_and_b32 v63, 0xffff0000, v19
    v_pk_add_f32 v[56:57], v[56:57], v[104:105]
    v_pk_add_f32 v[58:59], v[58:59], v[106:107]
    s_waitcnt lgkmcnt(4)
    v_pk_add_f32 v[60:61], v[60:61], v[108:109]
    v_pk_add_f32 v[62:63], v[62:63], v[110:111]
    v_cvt_pk_bf16_f32 v32, v56, v57
    v_cvt_pk_bf16_f32 v33, v58, v59
    v_cvt_pk_bf16_f32 v34, v60, v61
    v_cvt_pk_bf16_f32 v35, v62, v63
    buffer_store_dwordx4 v[32:35], v2, s[8:11], s16 offen offset:0 sc1
    s_waitcnt lgkmcnt(3)
    v_pk_mul_f32 v[64:65], v[64:65], v[112:113]
    v_pk_mul_f32 v[66:67], v[66:67], v[114:115]
    s_waitcnt lgkmcnt(1)
    v_pk_mul_f32 v[68:69], v[68:69], v[116:117]
    v_pk_mul_f32 v[70:71], v[70:71], v[118:119]
    v_cvt_pk_bf16_f32 v18, v64, v65
    v_lshlrev_b32 v64, 16, v18
    v_and_b32 v65, 0xffff0000, v18
    v_cvt_pk_bf16_f32 v19, v66, v67
    v_lshlrev_b32 v66, 16, v19
    v_and_b32 v67, 0xffff0000, v19
    v_cvt_pk_bf16_f32 v18, v68, v69
    v_lshlrev_b32 v68, 16, v18
    v_and_b32 v69, 0xffff0000, v18
    v_cvt_pk_bf16_f32 v19, v70, v71
    v_lshlrev_b32 v70, 16, v19
    v_and_b32 v71, 0xffff0000, v19
    v_pk_add_f32 v[64:65], v[64:65], v[120:121]
    v_pk_add_f32 v[66:67], v[66:67], v[122:123]
    s_waitcnt lgkmcnt(0)
    v_pk_add_f32 v[68:69], v[68:69], v[124:125]
    v_pk_add_f32 v[70:71], v[70:71], v[126:127]
    v_cvt_pk_bf16_f32 v36, v64, v65
    v_cvt_pk_bf16_f32 v37, v66, v67
    v_cvt_pk_bf16_f32 v38, v68, v69
    v_cvt_pk_bf16_f32 v39, v70, v71
    buffer_store_dwordx4 v[36:39], v2, s[8:11], s16 offen offset:1024 sc1
    s_lshl_b32 s19, s3, 16
    s_lshl_b32 s20, s3, 11
    s_lshl_b32 s16, s12, 8
    s_add_u32 s4, s38, s16
    s_addc_u32 s5, s39, 0
    s_sub_u32 s6, 0x800000, s16
    s_mov_b32 s7, 0x20000
    s_barrier
    s_add_u32 s22, s19, 0x0
    s_add_u32 m0, s20, 0x0
    s_nop 0
    buffer_load_dwordx4 v3, s[4:7], s22 offen lds
    s_add_u32 s22, s19, 0x8000
    s_add_u32 m0, s20, 0x400
    s_nop 0
    buffer_load_dwordx4 v3, s[4:7], s22 offen lds
    s_add_u32 s22, s19, 0x80000
    s_add_u32 m0, s20, 0x4000
    s_nop 0
    buffer_load_dwordx4 v3, s[4:7], s22 offen lds
    s_add_u32 s22, s19, 0x88000
    s_add_u32 m0, s20, 0x4400
    s_nop 0
    buffer_load_dwordx4 v3, s[4:7], s22 offen lds
    s_add_u32 s22, s19, 0x100000
    s_add_u32 m0, s20, 0x8000
    s_nop 0
    buffer_load_dwordx4 v3, s[4:7], s22 offen lds
    s_add_u32 s22, s19, 0x108000
    s_add_u32 m0, s20, 0x8400
    s_nop 0
    buffer_load_dwordx4 v3, s[4:7], s22 offen lds
    v_mov_b32 v134, s28
    s_lshl_b32 s16, s29, 4
    s_add_u32 s16, s16, s31
    s_lshl_b32 s16, s16, 2
    s_add_u32 s16, s16, 0x528000
    v_and_b32 v16, 31, v1
    v_lshlrev_b32 v16, 2, v16
    s_lshl_b32 s17, s13, 3
    s_add_u32 s17, s17, s3
    s_lshl_b32 s17, s17, 7
    s_add_u32 s17, s17, 0x528000
    s_waitcnt vmcnt(6)
    s_mov_b64 exec, 1
    buffer_store_dword v134, v132, s[8:11], s16 offen sc1
    s_mov_b64 exec, -1
    s_waitcnt vmcnt(0)
    s_mov_b32 s27, 0
adaLN_cond__sliding_block_cached__moe_arch_mod__prompt_kernel_h3p:
    buffer_load_dword v17, v16, s[8:11], s17 offen sc1
    s_waitcnt vmcnt(0)
    v_cmp_ne_u32 vcc, s28, v17
    s_add_u32 s27, s27, 1
    s_cmp_ge_u32 s27, 65536
    s_cbranch_scc1 adaLN_cond__sliding_block_cached__moe_arch_mod__prompt_kernel_h3g
    s_cbranch_vccnz adaLN_cond__sliding_block_cached__moe_arch_mod__prompt_kernel_h3p
adaLN_cond__sliding_block_cached__moe_arch_mod__prompt_kernel_h3g:
    s_mov_b32 s23, 0x0
    buffer_load_dwordx4 v[88:91], v7, s[8:11], s23 offen offset:0 sc1
    s_mov_b32 s23, 0x8000
    buffer_load_dwordx4 v[92:95], v7, s[8:11], s23 offen offset:0 sc1
    s_mov_b32 s23, 0x0
    buffer_load_dwordx4 v[96:99], v7, s[8:11], s23 offen offset:1024 sc1
    s_mov_b32 s23, 0x8000
    buffer_load_dwordx4 v[100:103], v7, s[8:11], s23 offen offset:1024 sc1
    s_mov_b32 s23, 0x800
    buffer_load_dwordx4 v[104:107], v7, s[8:11], s23 offen offset:0 sc1
    s_mov_b32 s23, 0x8800
    buffer_load_dwordx4 v[108:111], v7, s[8:11], s23 offen offset:0 sc1
    s_mov_b32 s23, 0x800
    buffer_load_dwordx4 v[112:115], v7, s[8:11], s23 offen offset:1024 sc1
    s_mov_b32 s23, 0x8800
    buffer_load_dwordx4 v[116:119], v7, s[8:11], s23 offen offset:1024 sc1
    s_lshr_b32 s21, s12, 3
    s_lshl_b32 s21, s21, 17
    s_add_u32 s21, s21, s20
    s_add_u32 s21, s21, 0x400000
    s_barrier
    ds_read_b64_tr_b16 v[224:225], v4 offset:0
    ds_read_b64_tr_b16 v[226:227], v4 offset:1024
    ds_read_b64_tr_b16 v[228:229], v5 offset:32
    ds_read_b64_tr_b16 v[230:231], v5 offset:1056
    ds_read_b64_tr_b16 v[232:233], v4 offset:256
    ds_read_b64_tr_b16 v[234:235], v4 offset:1280
    s_waitcnt vmcnt(7) lgkmcnt(4)
    v_mfma_f32_16x16x32_bf16 v[24:27], v[224:227], v[88:91], 0
    ds_read_b64_tr_b16 v[236:237], v5 offset:288
    s_waitcnt vmcnt(6)
    v_mfma_f32_16x16x32_bf16 v[28:31], v[224:227], v[92:95], 0
    ds_read_b64_tr_b16 v[238:239], v5 offset:1312
    s_waitcnt lgkmcnt(4)
    v_mfma_f32_16x16x32_bf16 v[32:35], v[228:231], v[88:91], 0
    ds_read_b64_tr_b16 v[240:241], v4 offset:512
    v_mfma_f32_16x16x32_bf16 v[36:39], v[228:231], v[92:95], 0
    ds_read_b64_tr_b16 v[242:243], v4 offset:1536
    s_mov_b32 s23, 0x1000
    buffer_load_dwordx4 v[120:123], v7, s[8:11], s23 offen offset:0 sc1
    s_waitcnt lgkmcnt(4)
    v_mfma_f32_16x16x32_bf16 v[40:43], v[232:235], v[88:91], 0
    ds_read_b64_tr_b16 v[244:245], v5 offset:544
    v_mfma_f32_16x16x32_bf16 v[44:47], v[232:235], v[92:95], 0
    ds_read_b64_tr_b16 v[246:247], v5 offset:1568
    s_waitcnt lgkmcnt(4)
    v_mfma_f32_16x16x32_bf16 v[48:51], v[236:239], v[88:91], 0
    ds_read_b64_tr_b16 v[224:225], v4 offset:768
    v_mfma_f32_16x16x32_bf16 v[52:55], v[236:239], v[92:95], 0
    ds_read_b64_tr_b16 v[226:227], v4 offset:1792
    s_waitcnt lgkmcnt(4)
    v_mfma_f32_16x16x32_bf16 v[56:59], v[240:243], v[88:91], 0
    ds_read_b64_tr_b16 v[228:229], v5 offset:800
    v_mfma_f32_16x16x32_bf16 v[60:63], v[240:243], v[92:95], 0
    ds_read_b64_tr_b16 v[230:231], v5 offset:1824
    s_waitcnt lgkmcnt(4)
    v_mfma_f32_16x16x32_bf16 v[64:67], v[244:247], v[88:91], 0
    ds_read_b64_tr_b16 v[232:233], v4 offset:8192
    v_mfma_f32_16x16x32_bf16 v[68:71], v[244:247], v[92:95], 0
    ds_read_b64_tr_b16 v[234:235], v4 offset:9216
    s_mov_b32 s23, 0x9000
    buffer_load_dwordx4 v[124:127], v7, s[8:11], s23 offen offset:0 sc1
    s_waitcnt lgkmcnt(4)
    v_mfma_f32_16x16x32_bf16 v[72:75], v[224:227], v[88:91], 0
    ds_read_b64_tr_b16 v[236:237], v5 offset:8224
    v_mfma_f32_16x16x32_bf16 v[76:79], v[224:227], v[92:95], 0
    ds_read_b64_tr_b16 v[238:239], v5 offset:9248
    s_waitcnt lgkmcnt(4)
    v_mfma_f32_16x16x32_bf16 v[80:83], v[228:231], v[88:91], 0
    ds_read_b64_tr_b16 v[240:241], v4 offset:8448
    v_mfma_f32_16x16x32_bf16 v[84:87], v[228:231], v[92:95], 0
    ds_read_b64_tr_b16 v[242:243], v4 offset:9472
    s_waitcnt vmcnt(7) lgkmcnt(4)
    v_mfma_f32_16x16x32_bf16 v[24:27], v[232:235], v[96:99], v[24:27]
    ds_read_b64_tr_b16 v[244:245], v5 offset:8480
    s_waitcnt vmcnt(6)
    v_mfma_f32_16x16x32_bf16 v[28:31], v[232:235], v[100:103], v[28:31]
    ds_read_b64_tr_b16 v[246:247], v5 offset:9504
    s_waitcnt lgkmcnt(4)
    v_mfma_f32_16x16x32_bf16 v[32:35], v[236:239], v[96:99], v[32:35]
    ds_read_b64_tr_b16 v[224:225], v4 offset:8704
    v_mfma_f32_16x16x32_bf16 v[36:39], v[236:239], v[100:103], v[36:39]
    ds_read_b64_tr_b16 v[226:227], v4 offset:9728
    s_mov_b32 s23, 0x1000
    buffer_load_dwordx4 v[128:131], v7, s[8:11], s23 offen offset:1024 sc1
    s_waitcnt lgkmcnt(4)
    v_mfma_f32_16x16x32_bf16 v[40:43], v[240:243], v[96:99], v[40:43]
    ds_read_b64_tr_b16 v[228:229], v5 offset:8736
    v_mfma_f32_16x16x32_bf16 v[44:47], v[240:243], v[100:103], v[44:47]
    ds_read_b64_tr_b16 v[230:231], v5 offset:9760
    s_waitcnt lgkmcnt(4)
    v_mfma_f32_16x16x32_bf16 v[48:51], v[244:247], v[96:99], v[48:51]
    ds_read_b64_tr_b16 v[232:233], v4 offset:8960
    v_mfma_f32_16x16x32_bf16 v[52:55], v[244:247], v[100:103], v[52:55]
    ds_read_b64_tr_b16 v[234:235], v4 offset:9984
    s_waitcnt lgkmcnt(4)
    v_mfma_f32_16x16x32_bf16 v[56:59], v[224:227], v[96:99], v[56:59]
    ds_read_b64_tr_b16 v[236:237], v5 offset:8992
    v_mfma_f32_16x16x32_bf16 v[60:63], v[224:227], v[100:103], v[60:63]
    ds_read_b64_tr_b16 v[238:239], v5 offset:10016
    s_waitcnt lgkmcnt(4)
    v_mfma_f32_16x16x32_bf16 v[64:67], v[228:231], v[96:99], v[64:67]
    v_mfma_f32_16x16x32_bf16 v[68:71], v[228:231], v[100:103], v[68:71]
    s_barrier
    ds_read_b64_tr_b16 v[240:241], v4 offset:16384
    ds_read_b64_tr_b16 v[242:243], v4 offset:17408
    s_mov_b32 s23, 0x9000
    buffer_load_dwordx4 v[132:135], v7, s[8:11], s23 offen offset:1024 sc1
    s_waitcnt lgkmcnt(4)
    v_mfma_f32_16x16x32_bf16 v[72:75], v[232:235], v[96:99], v[72:75]
    ds_read_b64_tr_b16 v[244:245], v5 offset:16416
    v_mfma_f32_16x16x32_bf16 v[76:79], v[232:235], v[100:103], v[76:79]
    s_add_u32 s22, s19, 0x180000
    s_add_u32 m0, s20, 0xc000
    s_nop 0
    buffer_load_dwordx4 v3, s[4:7], s22 offen lds
    ds_read_b64_tr_b16 v[246:247], v5 offset:17440
    s_waitcnt lgkmcnt(4)
    v_mfma_f32_16x16x32_bf16 v[80:83], v[236:239], v[96:99], v[80:83]
    ds_read_b64_tr_b16 v[224:225], v4 offset:16640
    v_mfma_f32_16x16x32_bf16 v[84:87], v[236:239], v[100:103], v[84:87]
    ds_read_b64_tr_b16 v[226:227], v4 offset:17664
    s_waitcnt vmcnt(8) lgkmcnt(4)
    v_mfma_f32_16x16x32_bf16 v[24:27], v[240:243], v[104:107], v[24:27]
    ds_read_b64_tr_b16 v[228:229], v5 offset:16672
    s_waitcnt vmcnt(7)
    v_mfma_f32_16x16x32_bf16 v[28:31], v[240:243], v[108:111], v[28:31]
    ds_read_b64_tr_b16 v[230:231], v5 offset:17696
    s_waitcnt lgkmcnt(4)
    v_mfma_f32_16x16x32_bf16 v[32:35], v[244:247], v[104:107], v[32:35]
    ds_read_b64_tr_b16 v[232:233], v4 offset:16896
    v_mfma_f32_16x16x32_bf16 v[36:39], v[244:247], v[108:111], v[36:39]
    ds_read_b64_tr_b16 v[234:235], v4 offset:17920
    s_mov_b32 s23, 0x1800
    buffer_load_dwordx4 v[88:91], v7, s[8:11], s23 offen offset:0 sc1
    s_waitcnt lgkmcnt(4)
    v_mfma_f32_16x16x32_bf16 v[40:43], v[224:227], v[104:107], v[40:43]
    ds_read_b64_tr_b16 v[236:237], v5 offset:16928
    v_mfma_f32_16x16x32_bf16 v[44:47], v[224:227], v[108:111], v[44:47]
    s_add_u32 s22, s19, 0x188000
    s_add_u32 m0, s20, 0xc400
    s_nop 0
    buffer_load_dwordx4 v3, s[4:7], s22 offen lds
    ds_read_b64_tr_b16 v[238:239], v5 offset:17952
    s_waitcnt lgkmcnt(4)
    v_mfma_f32_16x16x32_bf16 v[48:51], v[228:231], v[104:107], v[48:51]
    ds_read_b64_tr_b16 v[240:241], v4 offset:17152
    v_mfma_f32_16x16x32_bf16 v[52:55], v[228:231], v[108:111], v[52:55]
    ds_read_b64_tr_b16 v[242:243], v4 offset:18176
    s_waitcnt lgkmcnt(4)
    v_mfma_f32_16x16x32_bf16 v[56:59], v[232:235], v[104:107], v[56:59]
    ds_read_b64_tr_b16 v[244:245], v5 offset:17184
    v_mfma_f32_16x16x32_bf16 v[60:63], v[232:235], v[108:111], v[60:63]
    ds_read_b64_tr_b16 v[246:247], v5 offset:18208
    s_waitcnt lgkmcnt(4)
    v_mfma_f32_16x16x32_bf16 v[64:67], v[236:239], v[104:107], v[64:67]
    ds_read_b64_tr_b16 v[224:225], v4 offset:24576
    v_mfma_f32_16x16x32_bf16 v[68:71], v[236:239], v[108:111], v[68:71]
    ds_read_b64_tr_b16 v[226:227], v4 offset:25600
    s_mov_b32 s23, 0x9800
    buffer_load_dwordx4 v[92:95], v7, s[8:11], s23 offen offset:0 sc1
    s_waitcnt lgkmcnt(4)
    v_mfma_f32_16x16x32_bf16 v[72:75], v[240:243], v[104:107], v[72:75]
    ds_read_b64_tr_b16 v[228:229], v5 offset:24608
    v_mfma_f32_16x16x32_bf16 v[76:79], v[240:243], v[108:111], v[76:79]
    ds_read_b64_tr_b16 v[230:231], v5 offset:25632
    s_waitcnt lgkmcnt(4)
    v_mfma_f32_16x16x32_bf16 v[80:83], v[244:247], v[104:107], v[80:83]
    ds_read_b64_tr_b16 v[232:233], v4 offset:24832
    v_mfma_f32_16x16x32_bf16 v[84:87], v[244:247], v[108:111], v[84:87]
    ds_read_b64_tr_b16 v[234:235], v4 offset:25856
    s_waitcnt vmcnt(9) lgkmcnt(4)
    v_mfma_f32_16x16x32_bf16 v[24:27], v[224:227], v[112:115], v[24:27]
    ds_read_b64_tr_b16 v[236:237], v5 offset:24864
    s_waitcnt vmcnt(8)
    v_mfma_f32_16x16x32_bf16 v[28:31], v[224:227], v[116:119], v[28:31]
    ds_read_b64_tr_b16 v[238:239], v5 offset:25888
    s_waitcnt lgkmcnt(4)
    v_mfma_f32_16x16x32_bf16 v[32:35], v[228:231], v[112:115], v[32:35]
    ds_read_b64_tr_b16 v[240:241], v4 offset:25088
    v_mfma_f32_16x16x32_bf16 v[36:39], v[228:231], v[116:119], v[36:39]
    ds_read_b64_tr_b16 v[242:243], v4 offset:26112
    s_mov_b32 s23, 0x1800
    buffer_load_dwordx4 v[96:99], v7, s[8:11], s23 offen offset:1024 sc1
    s_waitcnt lgkmcnt(4)
    v_mfma_f32_16x16x32_bf16 v[40:43], v[232:235], v[112:115], v[40:43]
    ds_read_b64_tr_b16 v[244:245], v5 offset:25120
    v_mfma_f32_16x16x32_bf16 v[44:47], v[232:235], v[116:119], v[44:47]
    ds_read_b64_tr_b16 v[246:247], v5 offset:26144
    s_waitcnt lgkmcnt(4)
    v_mfma_f32_16x16x32_bf16 v[48:51], v[236:239], v[112:115], v[48:51]
    ds_read_b64_tr_b16 v[224:225], v4 offset:25344
    v_mfma_f32_16x16x32_bf16 v[52:55], v[236:239], v[116:119], v[52:55]
    ds_read_b64_tr_b16 v[226:227], v4 offset:26368
    s_waitcnt lgkmcnt(4)
    v_mfma_f32_16x16x32_bf16 v[56:59], v[240:243], v[112:115], v[56:59]
    ds_read_b64_tr_b16 v[228:229], v5 offset:25376
    v_mfma_f32_16x16x32_bf16 v[60:63], v[240:243], v[116:119], v[60:63]
    ds_read_b64_tr_b16 v[230:231], v5 offset:26400
    s_waitcnt lgkmcnt(4)
    v_mfma_f32_16x16x32_bf16 v[64:67], v[244:247], v[112:115], v[64:67]
    v_mfma_f32_16x16x32_bf16 v[68:71], v[244:247], v[116:119], v[68:71]
    s_barrier
    ds_read_b64_tr_b16 v[232:233], v4 offset:32768
    ds_read_b64_tr_b16 v[234:235], v4 offset:33792
    s_mov_b32 s23, 0x9800
    buffer_load_dwordx4 v[100:103], v7, s[8:11], s23 offen offset:1024 sc1
    s_waitcnt lgkmcnt(4)
    v_mfma_f32_16x16x32_bf16 v[72:75], v[224:227], v[112:115], v[72:75]
    ds_read_b64_tr_b16 v[236:237], v5 offset:32800
    v_mfma_f32_16x16x32_bf16 v[76:79], v[224:227], v[116:119], v[76:79]
    s_add_u32 s22, s19, 0x200000
    s_add_u32 m0, s20, 0x0
    s_nop 0
    buffer_load_dwordx4 v3, s[4:7], s22 offen lds
    ds_read_b64_tr_b16 v[238:239], v5 offset:33824
    s_waitcnt lgkmcnt(4)
    v_mfma_f32_16x16x32_bf16 v[80:83], v[228:231], v[112:115], v[80:83]
    ds_read_b64_tr_b16 v[240:241], v4 offset:33024
    v_mfma_f32_16x16x32_bf16 v[84:87], v[228:231], v[116:119], v[84:87]
    ds_read_b64_tr_b16 v[242:243], v4 offset:34048
    s_waitcnt vmcnt(10) lgkmcnt(4)
    v_mfma_f32_16x16x32_bf16 v[24:27], v[232:235], v[120:123], v[24:27]
    ds_read_b64_tr_b16 v[244:245], v5 offset:33056
    s_waitcnt vmcnt(9)
    v_mfma_f32_16x16x32_bf16 v[28:31], v[232:235], v[124:127], v[28:31]
    ds_read_b64_tr_b16 v[246:247], v5 offset:34080
    s_waitcnt lgkmcnt(4)
    v_mfma_f32_16x16x32_bf16 v[32:35], v[236:239], v[120:123], v[32:35]
    ds_read_b64_tr_b16 v[224:225], v4 offset:33280
    v_mfma_f32_16x16x32_bf16 v[36:39], v[236:239], v[124:127], v[36:39]
    ds_read_b64_tr_b16 v[226:227], v4 offset:34304
    s_mov_b32 s23, 0x2000
    buffer_load_dwordx4 v[104:107], v7, s[8:11], s23 offen offset:0 sc1
    s_waitcnt lgkmcnt(4)
    v_mfma_f32_16x16x32_bf16 v[40:43], v[240:243], v[120:123], v[40:43]
    ds_read_b64_tr_b16 v[228:229], v5 offset:33312
    v_mfma_f32_16x16x32_bf16 v[44:47], v[240:243], v[124:127], v[44:47]
    s_add_u32 s22, s19, 0x208000
    s_add_u32 m0, s20, 0x400
    s_nop 0
    buffer_load_dwordx4 v3, s[4:7], s22 offen lds
    ds_read_b64_tr_b16 v[230:231], v5 offset:34336
    s_waitcnt lgkmcnt(4)
    v_mfma_f32_16x16x32_bf16 v[48:51], v[244:247], v[120:123], v[48:51]
    ds_read_b64_tr_b16 v[232:233], v4 offset:33536
    v_mfma_f32_16x16x32_bf16 v[52:55], v[244:247], v[124:127], v[52:55]
    ds_read_b64_tr_b16 v[234:235], v4 offset:34560
    s_waitcnt lgkmcnt(4)
    v_mfma_f32_16x16x32_bf16 v[56:59], v[224:227], v[120:123], v[56:59]
    ds_read_b64_tr_b16 v[236:237], v5 offset:33568
    v_mfma_f32_16x16x32_bf16 v[60:63], v[224:227], v[124:127], v[60:63]
    ds_read_b64_tr_b16 v[238:239], v5 offset:34592
    s_waitcnt lgkmcnt(4)
    v_mfma_f32_16x16x32_bf16 v[64:67], v[228:231], v[120:123], v[64:67]
    ds_read_b64_tr_b16 v[240:241], v4 offset:40960
    v_mfma_f32_16x16x32_bf16 v[68:71], v[228:231], v[124:127], v[68:71]
    ds_read_b64_tr_b16 v[242:243], v4 offset:41984
    s_mov_b32 s23, 0xa000
    buffer_load_dwordx4 v[108:111], v7, s[8:11], s23 offen offset:0 sc1
    s_waitcnt lgkmcnt(4)
    v_mfma_f32_16x16x32_bf16 v[72:75], v[232:235], v[120:123], v[72:75]
    ds_read_b64_tr_b16 v[244:245], v5 offset:40992
    v_mfma_f32_16x16x32_bf16 v[76:79], v[232:235], v[124:127], v[76:79]
    ds_read_b64_tr_b16 v[246:247], v5 offset:42016
    s_waitcnt lgkmcnt(4)
    v_mfma_f32_16x16x32_bf16 v[80:83], v[236:239], v[120:123], v[80:83]
    ds_read_b64_tr_b16 v[224:225], v4 offset:41216
    v_mfma_f32_16x16x32_bf16 v[84:87], v[236:239], v[124:127], v[84:87]
    ds_read_b64_tr_b16 v[226:227], v4 offset:42240
    s_waitcnt vmcnt(11) lgkmcnt(4)
    v_mfma_f32_16x16x32_bf16 v[24:27], v[240:243], v[128:131], v[24:27]
    ds_read_b64_tr_b16 v[228:229], v5 offset:41248
    s_waitcnt vmcnt(10)
    v_mfma_f32_16x16x32_bf16 v[28:31], v[240:243], v[132:135], v[28:31]
    ds_read_b64_tr_b16 v[230:231], v5 offset:42272
    s_waitcnt lgkmcnt(4)
    v_mfma_f32_16x16x32_bf16 v[32:35], v[244:247], v[128:131], v[32:35]
    ds_read_b64_tr_b16 v[232:233], v4 offset:41472
    v_mfma_f32_16x16x32_bf16 v[36:39], v[244:247], v[132:135], v[36:39]
    ds_read_b64_tr_b16 v[234:235], v4 offset:42496
    s_mov_b32 s23, 0x2000
    buffer_load_dwordx4 v[112:115], v7, s[8:11], s23 offen offset:1024 sc1
    s_waitcnt lgkmcnt(4)
    v_mfma_f32_16x16x32_bf16 v[40:43], v[224:227], v[128:131], v[40:43]
    ds_read_b64_tr_b16 v[236:237], v5 offset:41504
    v_mfma_f32_16x16x32_bf16 v[44:47], v[224:227], v[132:135], v[44:47]
    ds_read_b64_tr_b16 v[238:239], v5 offset:42528
    s_waitcnt lgkmcnt(4)
    v_mfma_f32_16x16x32_bf16 v[48:51], v[228:231], v[128:131], v[48:51]
    ds_read_b64_tr_b16 v[240:241], v4 offset:41728
    v_mfma_f32_16x16x32_bf16 v[52:55], v[228:231], v[132:135], v[52:55]
    ds_read_b64_tr_b16 v[242:243], v4 offset:42752
    s_waitcnt lgkmcnt(4)
    v_mfma_f32_16x16x32_bf16 v[56:59], v[232:235], v[128:131], v[56:59]
    ds_read_b64_tr_b16 v[244:245], v5 offset:41760
    v_mfma_f32_16x16x32_bf16 v[60:63], v[232:235], v[132:135], v[60:63]
    ds_read_b64_tr_b16 v[246:247], v5 offset:42784
    s_waitcnt lgkmcnt(4)
    v_mfma_f32_16x16x32_bf16 v[64:67], v[236:239], v[128:131], v[64:67]
    v_mfma_f32_16x16x32_bf16 v[68:71], v[236:239], v[132:135], v[68:71]
    s_waitcnt vmcnt(8)
    s_barrier
    ds_read_b64_tr_b16 v[224:225], v4 offset:49152
    ds_read_b64_tr_b16 v[226:227], v4 offset:50176
    s_mov_b32 s23, 0xa000
    buffer_load_dwordx4 v[116:119], v7, s[8:11], s23 offen offset:1024 sc1
    s_waitcnt lgkmcnt(4)
    v_mfma_f32_16x16x32_bf16 v[72:75], v[240:243], v[128:131], v[72:75]
    ds_read_b64_tr_b16 v[228:229], v5 offset:49184
    v_mfma_f32_16x16x32_bf16 v[76:79], v[240:243], v[132:135], v[76:79]
    s_add_u32 s22, s19, 0x280000
    s_add_u32 m0, s20, 0x4000
    s_nop 0
    buffer_load_dwordx4 v3, s[4:7], s22 offen lds
    ds_read_b64_tr_b16 v[230:231], v5 offset:50208
    s_waitcnt lgkmcnt(4)
    v_mfma_f32_16x16x32_bf16 v[80:83], v[244:247], v[128:131], v[80:83]
    ds_read_b64_tr_b16 v[232:233], v4 offset:49408
    v_mfma_f32_16x16x32_bf16 v[84:87], v[244:247], v[132:135], v[84:87]
    ds_read_b64_tr_b16 v[234:235], v4 offset:50432
    s_waitcnt lgkmcnt(4)
    v_mfma_f32_16x16x32_bf16 v[24:27], v[224:227], v[88:91], v[24:27]
    ds_read_b64_tr_b16 v[236:237], v5 offset:49440
    s_waitcnt vmcnt(9)
    v_mfma_f32_16x16x32_bf16 v[28:31], v[224:227], v[92:95], v[28:31]
    ds_read_b64_tr_b16 v[238:239], v5 offset:50464
    s_waitcnt lgkmcnt(4)
    v_mfma_f32_16x16x32_bf16 v[32:35], v[228:231], v[88:91], v[32:35]
    ds_read_b64_tr_b16 v[240:241], v4 offset:49664
    v_mfma_f32_16x16x32_bf16 v[36:39], v[228:231], v[92:95], v[36:39]
    ds_read_b64_tr_b16 v[242:243], v4 offset:50688
    s_mov_b32 s23, 0x2800
    buffer_load_dwordx4 v[120:123], v7, s[8:11], s23 offen offset:0 sc1
    s_waitcnt lgkmcnt(4)
    v_mfma_f32_16x16x32_bf16 v[40:43], v[232:235], v[88:91], v[40:43]
    ds_read_b64_tr_b16 v[244:245], v5 offset:49696
    v_mfma_f32_16x16x32_bf16 v[44:47], v[232:235], v[92:95], v[44:47]
    s_add_u32 s22, s19, 0x288000
    s_add_u32 m0, s20, 0x4400
    s_nop 0
    buffer_load_dwordx4 v3, s[4:7], s22 offen lds
    ds_read_b64_tr_b16 v[246:247], v5 offset:50720
    s_waitcnt lgkmcnt(4)
    v_mfma_f32_16x16x32_bf16 v[48:51], v[236:239], v[88:91], v[48:51]
    ds_read_b64_tr_b16 v[224:225], v4 offset:49920
    v_mfma_f32_16x16x32_bf16 v[52:55], v[236:239], v[92:95], v[52:55]
    ds_read_b64_tr_b16 v[226:227], v4 offset:50944
    s_waitcnt lgkmcnt(4)
    v_mfma_f32_16x16x32_bf16 v[56:59], v[240:243], v[88:91], v[56:59]
    ds_read_b64_tr_b16 v[228:229], v5 offset:49952
    v_mfma_f32_16x16x32_bf16 v[60:63], v[240:243], v[92:95], v[60:63]
    ds_read_b64_tr_b16 v[230:231], v5 offset:50976
    s_waitcnt lgkmcnt(4)
    v_mfma_f32_16x16x32_bf16 v[64:67], v[244:247], v[88:91], v[64:67]
    ds_read_b64_tr_b16 v[232:233], v4 offset:57344
    v_mfma_f32_16x16x32_bf16 v[68:71], v[244:247], v[92:95], v[68:71]
    ds_read_b64_tr_b16 v[234:235], v4 offset:58368
    s_mov_b32 s23, 0xa800
    buffer_load_dwordx4 v[124:127], v7, s[8:11], s23 offen offset:0 sc1
    s_waitcnt lgkmcnt(4)
    v_mfma_f32_16x16x32_bf16 v[72:75], v[224:227], v[88:91], v[72:75]
    ds_read_b64_tr_b16 v[236:237], v5 offset:57376
    v_mfma_f32_16x16x32_bf16 v[76:79], v[224:227], v[92:95], v[76:79]
    ds_read_b64_tr_b16 v[238:239], v5 offset:58400
    s_waitcnt lgkmcnt(4)
    v_mfma_f32_16x16x32_bf16 v[80:83], v[228:231], v[88:91], v[80:83]
    ds_read_b64_tr_b16 v[240:241], v4 offset:57600
    v_mfma_f32_16x16x32_bf16 v[84:87], v[228:231], v[92:95], v[84:87]
    ds_read_b64_tr_b16 v[242:243], v4 offset:58624
    s_waitcnt vmcnt(11) lgkmcnt(4)
    v_mfma_f32_16x16x32_bf16 v[24:27], v[232:235], v[96:99], v[24:27]
    ds_read_b64_tr_b16 v[244:245], v5 offset:57632
    s_waitcnt vmcnt(10)
    v_mfma_f32_16x16x32_bf16 v[28:31], v[232:235], v[100:103], v[28:31]
    ds_read_b64_tr_b16 v[246:247], v5 offset:58656
    s_waitcnt lgkmcnt(4)
    v_mfma_f32_16x16x32_bf16 v[32:35], v[236:239], v[96:99], v[32:35]
    ds_read_b64_tr_b16 v[224:225], v4 offset:57856
    v_mfma_f32_16x16x32_bf16 v[36:39], v[236:239], v[100:103], v[36:39]
    ds_read_b64_tr_b16 v[226:227], v4 offset:58880
    s_mov_b32 s23, 0x2800
    buffer_load_dwordx4 v[128:131], v7, s[8:11], s23 offen offset:1024 sc1
    s_waitcnt lgkmcnt(4)
    v_mfma_f32_16x16x32_bf16 v[40:43], v[240:243], v[96:99], v[40:43]
    ds_read_b64_tr_b16 v[228:229], v5 offset:57888
    v_mfma_f32_16x16x32_bf16 v[44:47], v[240:243], v[100:103], v[44:47]
    ds_read_b64_tr_b16 v[230:231], v5 offset:58912
    s_waitcnt lgkmcnt(4)
    v_mfma_f32_16x16x32_bf16 v[48:51], v[244:247], v[96:99], v[48:51]
    ds_read_b64_tr_b16 v[232:233], v4 offset:58112
    v_mfma_f32_16x16x32_bf16 v[52:55], v[244:247], v[100:103], v[52:55]
    ds_read_b64_tr_b16 v[234:235], v4 offset:59136
    s_waitcnt lgkmcnt(4)
    v_mfma_f32_16x16x32_bf16 v[56:59], v[224:227], v[96:99], v[56:59]
    ds_read_b64_tr_b16 v[236:237], v5 offset:58144
    v_mfma_f32_16x16x32_bf16 v[60:63], v[224:227], v[100:103], v[60:63]
    ds_read_b64_tr_b16 v[238:239], v5 offset:59168
    s_waitcnt lgkmcnt(4)
    v_mfma_f32_16x16x32_bf16 v[64:67], v[228:231], v[96:99], v[64:67]
    v_mfma_f32_16x16x32_bf16 v[68:71], v[228:231], v[100:103], v[68:71]
    s_waitcnt vmcnt(8)
    s_barrier
    ds_read_b64_tr_b16 v[240:241], v4 offset:0
    ds_read_b64_tr_b16 v[242:243], v4 offset:1024
    s_mov_b32 s23, 0xa800
    buffer_load_dwordx4 v[132:135], v7, s[8:11], s23 offen offset:1024 sc1
    s_waitcnt lgkmcnt(4)
    v_mfma_f32_16x16x32_bf16 v[72:75], v[232:235], v[96:99], v[72:75]
    ds_read_b64_tr_b16 v[244:245], v5 offset:32
    v_mfma_f32_16x16x32_bf16 v[76:79], v[232:235], v[100:103], v[76:79]
    s_add_u32 s22, s19, 0x300000
    s_add_u32 m0, s20, 0x8000
    s_nop 0
    buffer_load_dwordx4 v3, s[4:7], s22 offen lds
    ds_read_b64_tr_b16 v[246:247], v5 offset:1056
    s_waitcnt lgkmcnt(4)
    v_mfma_f32_16x16x32_bf16 v[80:83], v[236:239], v[96:99], v[80:83]
    ds_read_b64_tr_b16 v[224:225], v4 offset:256
    v_mfma_f32_16x16x32_bf16 v[84:87], v[236:239], v[100:103], v[84:87]
    ds_read_b64_tr_b16 v[226:227], v4 offset:1280
    s_waitcnt lgkmcnt(4)
    v_mfma_f32_16x16x32_bf16 v[24:27], v[240:243], v[104:107], v[24:27]
    ds_read_b64_tr_b16 v[228:229], v5 offset:288
    s_waitcnt vmcnt(9)
    v_mfma_f32_16x16x32_bf16 v[28:31], v[240:243], v[108:111], v[28:31]
    ds_read_b64_tr_b16 v[230:231], v5 offset:1312
    s_waitcnt lgkmcnt(4)
    v_mfma_f32_16x16x32_bf16 v[32:35], v[244:247], v[104:107], v[32:35]
    ds_read_b64_tr_b16 v[232:233], v4 offset:512
    v_mfma_f32_16x16x32_bf16 v[36:39], v[244:247], v[108:111], v[36:39]
    ds_read_b64_tr_b16 v[234:235], v4 offset:1536
    s_mov_b32 s23, 0x3000
    buffer_load_dwordx4 v[88:91], v7, s[8:11], s23 offen offset:0 sc1
    s_waitcnt lgkmcnt(4)
    v_mfma_f32_16x16x32_bf16 v[40:43], v[224:227], v[104:107], v[40:43]
    ds_read_b64_tr_b16 v[236:237], v5 offset:544
    v_mfma_f32_16x16x32_bf16 v[44:47], v[224:227], v[108:111], v[44:47]
    s_add_u32 s22, s19, 0x308000
    s_add_u32 m0, s20, 0x8400
    s_nop 0
    buffer_load_dwordx4 v3, s[4:7], s22 offen lds
    ds_read_b64_tr_b16 v[238:239], v5 offset:1568
    s_waitcnt lgkmcnt(4)
    v_mfma_f32_16x16x32_bf16 v[48:51], v[228:231], v[104:107], v[48:51]
    ds_read_b64_tr_b16 v[240:241], v4 offset:768
    v_mfma_f32_16x16x32_bf16 v[52:55], v[228:231], v[108:111], v[52:55]
    ds_read_b64_tr_b16 v[242:243], v4 offset:1792
    s_waitcnt lgkmcnt(4)
    v_mfma_f32_16x16x32_bf16 v[56:59], v[232:235], v[104:107], v[56:59]
    ds_read_b64_tr_b16 v[244:245], v5 offset:800
    v_mfma_f32_16x16x32_bf16 v[60:63], v[232:235], v[108:111], v[60:63]
    ds_read_b64_tr_b16 v[246:247], v5 offset:1824
    s_waitcnt lgkmcnt(4)
    v_mfma_f32_16x16x32_bf16 v[64:67], v[236:239], v[104:107], v[64:67]
    ds_read_b64_tr_b16 v[224:225], v4 offset:8192
    v_mfma_f32_16x16x32_bf16 v[68:71], v[236:239], v[108:111], v[68:71]
    ds_read_b64_tr_b16 v[226:227], v4 offset:9216
    s_mov_b32 s23, 0xb000
    buffer_load_dwordx4 v[92:95], v7, s[8:11], s23 offen offset:0 sc1
    s_waitcnt lgkmcnt(4)
    v_mfma_f32_16x16x32_bf16 v[72:75], v[240:243], v[104:107], v[72:75]
    ds_read_b64_tr_b16 v[228:229], v5 offset:8224
    v_mfma_f32_16x16x32_bf16 v[76:79], v[240:243], v[108:111], v[76:79]
    ds_read_b64_tr_b16 v[230:231], v5 offset:9248
    s_waitcnt lgkmcnt(4)
    v_mfma_f32_16x16x32_bf16 v[80:83], v[244:247], v[104:107], v[80:83]
    ds_read_b64_tr_b16 v[232:233], v4 offset:8448
    v_mfma_f32_16x16x32_bf16 v[84:87], v[244:247], v[108:111], v[84:87]
    ds_read_b64_tr_b16 v[234:235], v4 offset:9472
    s_waitcnt vmcnt(11) lgkmcnt(4)
    v_mfma_f32_16x16x32_bf16 v[24:27], v[224:227], v[112:115], v[24:27]
    ds_read_b64_tr_b16 v[236:237], v5 offset:8480
    s_waitcnt vmcnt(10)
    v_mfma_f32_16x16x32_bf16 v[28:31], v[224:227], v[116:119], v[28:31]
    ds_read_b64_tr_b16 v[238:239], v5 offset:9504
    s_waitcnt lgkmcnt(4)
    v_mfma_f32_16x16x32_bf16 v[32:35], v[228:231], v[112:115], v[32:35]
    ds_read_b64_tr_b16 v[240:241], v4 offset:8704
    v_mfma_f32_16x16x32_bf16 v[36:39], v[228:231], v[116:119], v[36:39]
    ds_read_b64_tr_b16 v[242:243], v4 offset:9728
    s_mov_b32 s23, 0x3000
    buffer_load_dwordx4 v[96:99], v7, s[8:11], s23 offen offset:1024 sc1
    s_waitcnt lgkmcnt(4)
    v_mfma_f32_16x16x32_bf16 v[40:43], v[232:235], v[112:115], v[40:43]
    ds_read_b64_tr_b16 v[244:245], v5 offset:8736
    v_mfma_f32_16x16x32_bf16 v[44:47], v[232:235], v[116:119], v[44:47]
    ds_read_b64_tr_b16 v[246:247], v5 offset:9760
    s_waitcnt lgkmcnt(4)
    v_mfma_f32_16x16x32_bf16 v[48:51], v[236:239], v[112:115], v[48:51]
    ds_read_b64_tr_b16 v[224:225], v4 offset:8960
    v_mfma_f32_16x16x32_bf16 v[52:55], v[236:239], v[116:119], v[52:55]
    ds_read_b64_tr_b16 v[226:227], v4 offset:9984
    s_waitcnt lgkmcnt(4)
    v_mfma_f32_16x16x32_bf16 v[56:59], v[240:243], v[112:115], v[56:59]
    ds_read_b64_tr_b16 v[228:229], v5 offset:8992
    v_mfma_f32_16x16x32_bf16 v[60:63], v[240:243], v[116:119], v[60:63]
    ds_read_b64_tr_b16 v[230:231], v5 offset:10016
    s_waitcnt lgkmcnt(4)
    v_mfma_f32_16x16x32_bf16 v[64:67], v[244:247], v[112:115], v[64:67]
    v_mfma_f32_16x16x32_bf16 v[68:71], v[244:247], v[116:119], v[68:71]
    s_waitcnt vmcnt(8)
    s_barrier
    ds_read_b64_tr_b16 v[232:233], v4 offset:16384
    ds_read_b64_tr_b16 v[234:235], v4 offset:17408
    s_mov_b32 s23, 0xb000
    buffer_load_dwordx4 v[100:103], v7, s[8:11], s23 offen offset:1024 sc1
    s_waitcnt lgkmcnt(4)
    v_mfma_f32_16x16x32_bf16 v[72:75], v[224:227], v[112:115], v[72:75]
    ds_read_b64_tr_b16 v[236:237], v5 offset:16416
    v_mfma_f32_16x16x32_bf16 v[76:79], v[224:227], v[116:119], v[76:79]
    s_add_u32 s22, s19, 0x380000
    s_add_u32 m0, s20, 0xc000
    s_nop 0
    buffer_load_dwordx4 v3, s[4:7], s22 offen lds
    ds_read_b64_tr_b16 v[238:239], v5 offset:17440
    s_waitcnt lgkmcnt(4)
    v_mfma_f32_16x16x32_bf16 v[80:83], v[228:231], v[112:115], v[80:83]
    ds_read_b64_tr_b16 v[240:241], v4 offset:16640
    v_mfma_f32_16x16x32_bf16 v[84:87], v[228:231], v[116:119], v[84:87]
    ds_read_b64_tr_b16 v[242:243], v4 offset:17664
    s_waitcnt lgkmcnt(4)
    v_mfma_f32_16x16x32_bf16 v[24:27], v[232:235], v[120:123], v[24:27]
    ds_read_b64_tr_b16 v[244:245], v5 offset:16672
    s_waitcnt vmcnt(9)
    v_mfma_f32_16x16x32_bf16 v[28:31], v[232:235], v[124:127], v[28:31]
    ds_read_b64_tr_b16 v[246:247], v5 offset:17696
    s_waitcnt lgkmcnt(4)
    v_mfma_f32_16x16x32_bf16 v[32:35], v[236:239], v[120:123], v[32:35]
    ds_read_b64_tr_b16 v[224:225], v4 offset:16896
    v_mfma_f32_16x16x32_bf16 v[36:39], v[236:239], v[124:127], v[36:39]
    ds_read_b64_tr_b16 v[226:227], v4 offset:17920
    s_mov_b32 s23, 0x3800
    buffer_load_dwordx4 v[104:107], v7, s[8:11], s23 offen offset:0 sc1
    s_waitcnt lgkmcnt(4)
    v_mfma_f32_16x16x32_bf16 v[40:43], v[240:243], v[120:123], v[40:43]
    ds_read_b64_tr_b16 v[228:229], v5 offset:16928
    v_mfma_f32_16x16x32_bf16 v[44:47], v[240:243], v[124:127], v[44:47]
    s_add_u32 s22, s19, 0x388000
    s_add_u32 m0, s20, 0xc400
    s_nop 0
    buffer_load_dwordx4 v3, s[4:7], s22 offen lds
    ds_read_b64_tr_b16 v[230:231], v5 offset:17952
    s_waitcnt lgkmcnt(4)
    v_mfma_f32_16x16x32_bf16 v[48:51], v[244:247], v[120:123], v[48:51]
    ds_read_b64_tr_b16 v[232:233], v4 offset:17152
    v_mfma_f32_16x16x32_bf16 v[52:55], v[244:247], v[124:127], v[52:55]
    ds_read_b64_tr_b16 v[234:235], v4 offset:18176
    s_waitcnt lgkmcnt(4)
    v_mfma_f32_16x16x32_bf16 v[56:59], v[224:227], v[120:123], v[56:59]
    ds_read_b64_tr_b16 v[236:237], v5 offset:17184
    v_mfma_f32_16x16x32_bf16 v[60:63], v[224:227], v[124:127], v[60:63]
    ds_read_b64_tr_b16 v[238:239], v5 offset:18208
    s_waitcnt lgkmcnt(4)
    v_mfma_f32_16x16x32_bf16 v[64:67], v[228:231], v[120:123], v[64:67]
    ds_read_b64_tr_b16 v[240:241], v4 offset:24576
    v_mfma_f32_16x16x32_bf16 v[68:71], v[228:231], v[124:127], v[68:71]
    ds_read_b64_tr_b16 v[242:243], v4 offset:25600
    s_mov_b32 s23, 0xb800
    buffer_load_dwordx4 v[108:111], v7, s[8:11], s23 offen offset:0 sc1
    s_waitcnt lgkmcnt(4)
    v_mfma_f32_16x16x32_bf16 v[72:75], v[232:235], v[120:123], v[72:75]
    ds_read_b64_tr_b16 v[244:245], v5 offset:24608
    v_mfma_f32_16x16x32_bf16 v[76:79], v[232:235], v[124:127], v[76:79]
    ds_read_b64_tr_b16 v[246:247], v5 offset:25632
    s_waitcnt lgkmcnt(4)
    v_mfma_f32_16x16x32_bf16 v[80:83], v[236:239], v[120:123], v[80:83]
    ds_read_b64_tr_b16 v[224:225], v4 offset:24832
    v_mfma_f32_16x16x32_bf16 v[84:87], v[236:239], v[124:127], v[84:87]
    ds_read_b64_tr_b16 v[226:227], v4 offset:25856
    s_waitcnt vmcnt(11) lgkmcnt(4)
    v_mfma_f32_16x16x32_bf16 v[24:27], v[240:243], v[128:131], v[24:27]
    ds_read_b64_tr_b16 v[228:229], v5 offset:24864
    s_waitcnt vmcnt(10)
    v_mfma_f32_16x16x32_bf16 v[28:31], v[240:243], v[132:135], v[28:31]
    ds_read_b64_tr_b16 v[230:231], v5 offset:25888
    s_waitcnt lgkmcnt(4)
    v_mfma_f32_16x16x32_bf16 v[32:35], v[244:247], v[128:131], v[32:35]
    ds_read_b64_tr_b16 v[232:233], v4 offset:25088
    v_mfma_f32_16x16x32_bf16 v[36:39], v[244:247], v[132:135], v[36:39]
    ds_read_b64_tr_b16 v[234:235], v4 offset:26112
    s_mov_b32 s23, 0x3800
    buffer_load_dwordx4 v[112:115], v7, s[8:11], s23 offen offset:1024 sc1
    s_waitcnt lgkmcnt(4)
    v_mfma_f32_16x16x32_bf16 v[40:43], v[224:227], v[128:131], v[40:43]
    ds_read_b64_tr_b16 v[236:237], v5 offset:25120
    v_mfma_f32_16x16x32_bf16 v[44:47], v[224:227], v[132:135], v[44:47]
    ds_read_b64_tr_b16 v[238:239], v5 offset:26144
    s_waitcnt lgkmcnt(4)
    v_mfma_f32_16x16x32_bf16 v[48:51], v[228:231], v[128:131], v[48:51]
    ds_read_b64_tr_b16 v[240:241], v4 offset:25344
    v_mfma_f32_16x16x32_bf16 v[52:55], v[228:231], v[132:135], v[52:55]
    ds_read_b64_tr_b16 v[242:243], v4 offset:26368
    s_waitcnt lgkmcnt(4)
    v_mfma_f32_16x16x32_bf16 v[56:59], v[232:235], v[128:131], v[56:59]
    ds_read_b64_tr_b16 v[244:245], v5 offset:25376
    v_mfma_f32_16x16x32_bf16 v[60:63], v[232:235], v[132:135], v[60:63]
    ds_read_b64_tr_b16 v[246:247], v5 offset:26400
    s_waitcnt lgkmcnt(4)
    v_mfma_f32_16x16x32_bf16 v[64:67], v[236:239], v[128:131], v[64:67]
    v_mfma_f32_16x16x32_bf16 v[68:71], v[236:239], v[132:135], v[68:71]
    s_waitcnt vmcnt(8)
    s_barrier
    ds_read_b64_tr_b16 v[224:225], v4 offset:32768
    ds_read_b64_tr_b16 v[226:227], v4 offset:33792
    s_mov_b32 s23, 0xb800
    buffer_load_dwordx4 v[116:119], v7, s[8:11], s23 offen offset:1024 sc1
    s_waitcnt lgkmcnt(4)
    v_mfma_f32_16x16x32_bf16 v[72:75], v[240:243], v[128:131], v[72:75]
    ds_read_b64_tr_b16 v[228:229], v5 offset:32800
    v_mfma_f32_16x16x32_bf16 v[76:79], v[240:243], v[132:135], v[76:79]
    s_add_u32 s22, s19, 0x400000
    s_add_u32 m0, s20, 0x0
    s_nop 0
    buffer_load_dwordx4 v3, s[4:7], s22 offen lds
    ds_read_b64_tr_b16 v[230:231], v5 offset:33824
    s_waitcnt lgkmcnt(4)
    v_mfma_f32_16x16x32_bf16 v[80:83], v[244:247], v[128:131], v[80:83]
    ds_read_b64_tr_b16 v[232:233], v4 offset:33024
    v_mfma_f32_16x16x32_bf16 v[84:87], v[244:247], v[132:135], v[84:87]
    ds_read_b64_tr_b16 v[234:235], v4 offset:34048
    s_waitcnt lgkmcnt(4)
    v_mfma_f32_16x16x32_bf16 v[24:27], v[224:227], v[88:91], v[24:27]
    ds_read_b64_tr_b16 v[236:237], v5 offset:33056
    s_waitcnt vmcnt(9)
    v_mfma_f32_16x16x32_bf16 v[28:31], v[224:227], v[92:95], v[28:31]
    ds_read_b64_tr_b16 v[238:239], v5 offset:34080
    s_waitcnt lgkmcnt(4)
    v_mfma_f32_16x16x32_bf16 v[32:35], v[228:231], v[88:91], v[32:35]
    ds_read_b64_tr_b16 v[240:241], v4 offset:33280
    v_mfma_f32_16x16x32_bf16 v[36:39], v[228:231], v[92:95], v[36:39]
    ds_read_b64_tr_b16 v[242:243], v4 offset:34304
    s_mov_b32 s23, 0x4000
    buffer_load_dwordx4 v[120:123], v7, s[8:11], s23 offen offset:0 sc1
    s_waitcnt lgkmcnt(4)
    v_mfma_f32_16x16x32_bf16 v[40:43], v[232:235], v[88:91], v[40:43]
    ds_read_b64_tr_b16 v[244:245], v5 offset:33312
    v_mfma_f32_16x16x32_bf16 v[44:47], v[232:235], v[92:95], v[44:47]
    s_add_u32 s22, s19, 0x408000
    s_add_u32 m0, s20, 0x400
    s_nop 0
    buffer_load_dwordx4 v3, s[4:7], s22 offen lds
    ds_read_b64_tr_b16 v[246:247], v5 offset:34336
    s_waitcnt lgkmcnt(4)
    v_mfma_f32_16x16x32_bf16 v[48:51], v[236:239], v[88:91], v[48:51]
    ds_read_b64_tr_b16 v[224:225], v4 offset:33536
    v_mfma_f32_16x16x32_bf16 v[52:55], v[236:239], v[92:95], v[52:55]
    ds_read_b64_tr_b16 v[226:227], v4 offset:34560
    s_waitcnt lgkmcnt(4)
    v_mfma_f32_16x16x32_bf16 v[56:59], v[240:243], v[88:91], v[56:59]
    ds_read_b64_tr_b16 v[228:229], v5 offset:33568
    v_mfma_f32_16x16x32_bf16 v[60:63], v[240:243], v[92:95], v[60:63]
    ds_read_b64_tr_b16 v[230:231], v5 offset:34592
    s_waitcnt lgkmcnt(4)
    v_mfma_f32_16x16x32_bf16 v[64:67], v[244:247], v[88:91], v[64:67]
    ds_read_b64_tr_b16 v[232:233], v4 offset:40960
    v_mfma_f32_16x16x32_bf16 v[68:71], v[244:247], v[92:95], v[68:71]
    ds_read_b64_tr_b16 v[234:235], v4 offset:41984
    s_mov_b32 s23, 0xc000
    buffer_load_dwordx4 v[124:127], v7, s[8:11], s23 offen offset:0 sc1
    s_waitcnt lgkmcnt(4)
    v_mfma_f32_16x16x32_bf16 v[72:75], v[224:227], v[88:91], v[72:75]
    ds_read_b64_tr_b16 v[236:237], v5 offset:40992
    v_lshrrev_b32 v21, 4, v1
    v_lshlrev_b32 v21, 9, v21
    v_and_b32 v20, 15, v1
    v_lshl_add_u32 v21, v20, 4, v21
    s_lshr_b32 s18, s12, 3
    s_lshl_b32 s18, s18, 11
    s_add_u32 s18, s18, 0x528100
    buffer_load_dwordx4 v[12:15], v21, s[8:11], s18 offen sc1
    v_mfma_f32_16x16x32_bf16 v[76:79], v[224:227], v[92:95], v[76:79]
    ds_read_b64_tr_b16 v[238:239], v5 offset:42016
    s_waitcnt lgkmcnt(4)
    v_mfma_f32_16x16x32_bf16 v[80:83], v[228:231], v[88:91], v[80:83]
    ds_read_b64_tr_b16 v[240:241], v4 offset:41216
    v_mfma_f32_16x16x32_bf16 v[84:87], v[228:231], v[92:95], v[84:87]
    ds_read_b64_tr_b16 v[242:243], v4 offset:42240
    s_waitcnt vmcnt(12) lgkmcnt(4)
    v_mfma_f32_16x16x32_bf16 v[24:27], v[232:235], v[96:99], v[24:27]
    ds_read_b64_tr_b16 v[244:245], v5 offset:41248
    s_waitcnt vmcnt(11)
    v_mfma_f32_16x16x32_bf16 v[28:31], v[232:235], v[100:103], v[28:31]
    ds_read_b64_tr_b16 v[246:247], v5 offset:42272
    s_waitcnt lgkmcnt(4)
    v_mfma_f32_16x16x32_bf16 v[32:35], v[236:239], v[96:99], v[32:35]
    ds_read_b64_tr_b16 v[224:225], v4 offset:41472
    v_mfma_f32_16x16x32_bf16 v[36:39], v[236:239], v[100:103], v[36:39]
    ds_read_b64_tr_b16 v[226:227], v4 offset:42496
    s_mov_b32 s23, 0x4000
    buffer_load_dwordx4 v[128:131], v7, s[8:11], s23 offen offset:1024 sc1
    s_waitcnt lgkmcnt(4)
    v_mfma_f32_16x16x32_bf16 v[40:43], v[240:243], v[96:99], v[40:43]
    ds_read_b64_tr_b16 v[228:229], v5 offset:41504
    v_mfma_f32_16x16x32_bf16 v[44:47], v[240:243], v[100:103], v[44:47]
    ds_read_b64_tr_b16 v[230:231], v5 offset:42528
    s_waitcnt lgkmcnt(4)
    v_mfma_f32_16x16x32_bf16 v[48:51], v[244:247], v[96:99], v[48:51]
    ds_read_b64_tr_b16 v[232:233], v4 offset:41728
    v_mfma_f32_16x16x32_bf16 v[52:55], v[244:247], v[100:103], v[52:55]
    ds_read_b64_tr_b16 v[234:235], v4 offset:42752
    s_waitcnt lgkmcnt(4)
    v_mfma_f32_16x16x32_bf16 v[56:59], v[224:227], v[96:99], v[56:59]
    ds_read_b64_tr_b16 v[236:237], v5 offset:41760
    v_mfma_f32_16x16x32_bf16 v[60:63], v[224:227], v[100:103], v[60:63]
    ds_read_b64_tr_b16 v[238:239], v5 offset:42784
    s_waitcnt lgkmcnt(4)
    v_mfma_f32_16x16x32_bf16 v[64:67], v[228:231], v[96:99], v[64:67]
    v_mfma_f32_16x16x32_bf16 v[68:71], v[228:231], v[100:103], v[68:71]
    s_waitcnt vmcnt(9)
    s_barrier
    ds_read_b64_tr_b16 v[240:241], v4 offset:49152
    ds_read_b64_tr_b16 v[242:243], v4 offset:50176
    s_mov_b32 s23, 0xc000
    buffer_load_dwordx4 v[132:135], v7, s[8:11], s23 offen offset:1024 sc1
    s_waitcnt lgkmcnt(4)
    v_mfma_f32_16x16x32_bf16 v[72:75], v[232:235], v[96:99], v[72:75]
    ds_read_b64_tr_b16 v[244:245], v5 offset:49184
    v_mfma_f32_16x16x32_bf16 v[76:79], v[232:235], v[100:103], v[76:79]
    s_add_u32 s22, s19, 0x480000
    s_add_u32 m0, s20, 0x4000
    s_nop 0
    buffer_load_dwordx4 v3, s[4:7], s22 offen lds
    ds_read_b64_tr_b16 v[246:247], v5 offset:50208
    s_waitcnt lgkmcnt(4)
    v_mfma_f32_16x16x32_bf16 v[80:83], v[236:239], v[96:99], v[80:83]
    ds_read_b64_tr_b16 v[224:225], v4 offset:49408
    v_mfma_f32_16x16x32_bf16 v[84:87], v[236:239], v[100:103], v[84:87]
    ds_read_b64_tr_b16 v[226:227], v4 offset:50432
    s_waitcnt lgkmcnt(4)
    v_mfma_f32_16x16x32_bf16 v[24:27], v[240:243], v[104:107], v[24:27]
    ds_read_b64_tr_b16 v[228:229], v5 offset:49440
    s_waitcnt vmcnt(10)
    v_mfma_f32_16x16x32_bf16 v[28:31], v[240:243], v[108:111], v[28:31]
    ds_read_b64_tr_b16 v[230:231], v5 offset:50464
    s_waitcnt lgkmcnt(4)
    v_mfma_f32_16x16x32_bf16 v[32:35], v[244:247], v[104:107], v[32:35]
    ds_read_b64_tr_b16 v[232:233], v4 offset:49664
    v_mfma_f32_16x16x32_bf16 v[36:39], v[244:247], v[108:111], v[36:39]
    ds_read_b64_tr_b16 v[234:235], v4 offset:50688
    s_mov_b32 s23, 0x4800
    buffer_load_dwordx4 v[88:91], v7, s[8:11], s23 offen offset:0 sc1
    s_waitcnt lgkmcnt(4)
    v_mfma_f32_16x16x32_bf16 v[40:43], v[224:227], v[104:107], v[40:43]
    ds_read_b64_tr_b16 v[236:237], v5 offset:49696
    v_mfma_f32_16x16x32_bf16 v[44:47], v[224:227], v[108:111], v[44:47]
    s_add_u32 s22, s19, 0x488000
    s_add_u32 m0, s20, 0x4400
    s_nop 0
    buffer_load_dwordx4 v3, s[4:7], s22 offen lds
    ds_read_b64_tr_b16 v[238:239], v5 offset:50720
    s_waitcnt lgkmcnt(4)
    v_mfma_f32_16x16x32_bf16 v[48:51], v[228:231], v[104:107], v[48:51]
    ds_read_b64_tr_b16 v[240:241], v4 offset:49920
    v_mfma_f32_16x16x32_bf16 v[52:55], v[228:231], v[108:111], v[52:55]
    ds_read_b64_tr_b16 v[242:243], v4 offset:50944
    s_waitcnt lgkmcnt(4)
    v_mfma_f32_16x16x32_bf16 v[56:59], v[232:235], v[104:107], v[56:59]
    ds_read_b64_tr_b16 v[244:245], v5 offset:49952
    v_mfma_f32_16x16x32_bf16 v[60:63], v[232:235], v[108:111], v[60:63]
    ds_read_b64_tr_b16 v[246:247], v5 offset:50976
    s_waitcnt lgkmcnt(4)
    v_mfma_f32_16x16x32_bf16 v[64:67], v[236:239], v[104:107], v[64:67]
    ds_read_b64_tr_b16 v[224:225], v4 offset:57344
    v_mfma_f32_16x16x32_bf16 v[68:71], v[236:239], v[108:111], v[68:71]
    ds_read_b64_tr_b16 v[226:227], v4 offset:58368
    s_mov_b32 s23, 0xc800
    buffer_load_dwordx4 v[92:95], v7, s[8:11], s23 offen offset:0 sc1
    s_waitcnt lgkmcnt(4)
    v_mfma_f32_16x16x32_bf16 v[72:75], v[240:243], v[104:107], v[72:75]
    ds_read_b64_tr_b16 v[228:229], v5 offset:57376
    v_mfma_f32_16x16x32_bf16 v[76:79], v[240:243], v[108:111], v[76:79]
    ds_read_b64_tr_b16 v[230:231], v5 offset:58400
    s_waitcnt lgkmcnt(4)
    v_mfma_f32_16x16x32_bf16 v[80:83], v[244:247], v[104:107], v[80:83]
    ds_read_b64_tr_b16 v[232:233], v4 offset:57600
    v_mfma_f32_16x16x32_bf16 v[84:87], v[244:247], v[108:111], v[84:87]
    ds_read_b64_tr_b16 v[234:235], v4 offset:58624
    s_waitcnt vmcnt(12) lgkmcnt(4)
    v_mfma_f32_16x16x32_bf16 v[24:27], v[224:227], v[112:115], v[24:27]
    ds_read_b64_tr_b16 v[236:237], v5 offset:57632
    s_waitcnt vmcnt(11)
    v_mfma_f32_16x16x32_bf16 v[28:31], v[224:227], v[116:119], v[28:31]
    ds_read_b64_tr_b16 v[238:239], v5 offset:58656
    s_waitcnt lgkmcnt(4)
    v_mfma_f32_16x16x32_bf16 v[32:35], v[228:231], v[112:115], v[32:35]
    ds_read_b64_tr_b16 v[240:241], v4 offset:57856
    v_mfma_f32_16x16x32_bf16 v[36:39], v[228:231], v[116:119], v[36:39]
    ds_read_b64_tr_b16 v[242:243], v4 offset:58880
    s_mov_b32 s23, 0x4800
    buffer_load_dwordx4 v[96:99], v7, s[8:11], s23 offen offset:1024 sc1
    s_waitcnt lgkmcnt(4)
    v_mfma_f32_16x16x32_bf16 v[40:43], v[232:235], v[112:115], v[40:43]
    ds_read_b64_tr_b16 v[244:245], v5 offset:57888
    v_mfma_f32_16x16x32_bf16 v[44:47], v[232:235], v[116:119], v[44:47]
    ds_read_b64_tr_b16 v[246:247], v5 offset:58912
    s_waitcnt lgkmcnt(4)
    v_mfma_f32_16x16x32_bf16 v[48:51], v[236:239], v[112:115], v[48:51]
    ds_read_b64_tr_b16 v[224:225], v4 offset:58112
    v_mfma_f32_16x16x32_bf16 v[52:55], v[236:239], v[116:119], v[52:55]
    ds_read_b64_tr_b16 v[226:227], v4 offset:59136
    s_waitcnt lgkmcnt(4)
    v_mfma_f32_16x16x32_bf16 v[56:59], v[240:243], v[112:115], v[56:59]
    ds_read_b64_tr_b16 v[228:229], v5 offset:58144
    v_mfma_f32_16x16x32_bf16 v[60:63], v[240:243], v[116:119], v[60:63]
    ds_read_b64_tr_b16 v[230:231], v5 offset:59168
    s_waitcnt lgkmcnt(4)
    v_mfma_f32_16x16x32_bf16 v[64:67], v[244:247], v[112:115], v[64:67]
    v_mfma_f32_16x16x32_bf16 v[68:71], v[244:247], v[116:119], v[68:71]
    s_waitcnt vmcnt(9)
    s_barrier
    ds_read_b64_tr_b16 v[232:233], v4 offset:0
    ds_read_b64_tr_b16 v[234:235], v4 offset:1024
    s_mov_b32 s23, 0xc800
    buffer_load_dwordx4 v[100:103], v7, s[8:11], s23 offen offset:1024 sc1
    s_waitcnt lgkmcnt(4)
    v_mfma_f32_16x16x32_bf16 v[72:75], v[224:227], v[112:115], v[72:75]
    ds_read_b64_tr_b16 v[236:237], v5 offset:32
    v_mfma_f32_16x16x32_bf16 v[76:79], v[224:227], v[116:119], v[76:79]
    s_add_u32 s22, s19, 0x500000
    s_add_u32 m0, s20, 0x8000
    s_nop 0
    buffer_load_dwordx4 v3, s[4:7], s22 offen lds
    ds_read_b64_tr_b16 v[238:239], v5 offset:1056
    s_waitcnt lgkmcnt(4)
    v_mfma_f32_16x16x32_bf16 v[80:83], v[228:231], v[112:115], v[80:83]
    ds_read_b64_tr_b16 v[240:241], v4 offset:256
    v_mfma_f32_16x16x32_bf16 v[84:87], v[228:231], v[116:119], v[84:87]
    ds_read_b64_tr_b16 v[242:243], v4 offset:1280
    s_waitcnt lgkmcnt(4)
    v_mfma_f32_16x16x32_bf16 v[24:27], v[232:235], v[120:123], v[24:27]
    ds_read_b64_tr_b16 v[244:245], v5 offset:288
    s_waitcnt vmcnt(10)
    v_mfma_f32_16x16x32_bf16 v[28:31], v[232:235], v[124:127], v[28:31]
    ds_read_b64_tr_b16 v[246:247], v5 offset:1312
    s_waitcnt lgkmcnt(4)
    v_mfma_f32_16x16x32_bf16 v[32:35], v[236:239], v[120:123], v[32:35]
    ds_read_b64_tr_b16 v[224:225], v4 offset:512
    v_mfma_f32_16x16x32_bf16 v[36:39], v[236:239], v[124:127], v[36:39]
    ds_read_b64_tr_b16 v[226:227], v4 offset:1536
    s_mov_b32 s23, 0x5000
    buffer_load_dwordx4 v[104:107], v7, s[8:11], s23 offen offset:0 sc1
    s_waitcnt lgkmcnt(4)
    v_mfma_f32_16x16x32_bf16 v[40:43], v[240:243], v[120:123], v[40:43]
    ds_read_b64_tr_b16 v[228:229], v5 offset:544
    v_mfma_f32_16x16x32_bf16 v[44:47], v[240:243], v[124:127], v[44:47]
    s_add_u32 s22, s19, 0x508000
    s_add_u32 m0, s20, 0x8400
    s_nop 0
    buffer_load_dwordx4 v3, s[4:7], s22 offen lds
    ds_read_b64_tr_b16 v[230:231], v5 offset:1568
    s_waitcnt lgkmcnt(4)
    v_mfma_f32_16x16x32_bf16 v[48:51], v[244:247], v[120:123], v[48:51]
    ds_read_b64_tr_b16 v[232:233], v4 offset:768
    v_mfma_f32_16x16x32_bf16 v[52:55], v[244:247], v[124:127], v[52:55]
    ds_read_b64_tr_b16 v[234:235], v4 offset:1792
    s_waitcnt lgkmcnt(4)
    v_mfma_f32_16x16x32_bf16 v[56:59], v[224:227], v[120:123], v[56:59]
    ds_read_b64_tr_b16 v[236:237], v5 offset:800
    v_mfma_f32_16x16x32_bf16 v[60:63], v[224:227], v[124:127], v[60:63]
    ds_read_b64_tr_b16 v[238:239], v5 offset:1824
    s_waitcnt lgkmcnt(4)
    v_mfma_f32_16x16x32_bf16 v[64:67], v[228:231], v[120:123], v[64:67]
    ds_read_b64_tr_b16 v[240:241], v4 offset:8192
    v_mfma_f32_16x16x32_bf16 v[68:71], v[228:231], v[124:127], v[68:71]
    ds_read_b64_tr_b16 v[242:243], v4 offset:9216
    s_mov_b32 s23, 0xd000
    buffer_load_dwordx4 v[108:111], v7, s[8:11], s23 offen offset:0 sc1
    s_waitcnt lgkmcnt(4)
    v_mfma_f32_16x16x32_bf16 v[72:75], v[232:235], v[120:123], v[72:75]
    ds_read_b64_tr_b16 v[244:245], v5 offset:8224
    v_mfma_f32_16x16x32_bf16 v[76:79], v[232:235], v[124:127], v[76:79]
    ds_read_b64_tr_b16 v[246:247], v5 offset:9248
    s_waitcnt lgkmcnt(4)
    v_mfma_f32_16x16x32_bf16 v[80:83], v[236:239], v[120:123], v[80:83]
    ds_read_b64_tr_b16 v[224:225], v4 offset:8448
    v_mfma_f32_16x16x32_bf16 v[84:87], v[236:239], v[124:127], v[84:87]
    ds_read_b64_tr_b16 v[226:227], v4 offset:9472
    s_waitcnt vmcnt(11) lgkmcnt(4)
    v_mfma_f32_16x16x32_bf16 v[24:27], v[240:243], v[128:131], v[24:27]
    ds_read_b64_tr_b16 v[228:229], v5 offset:8480
    s_waitcnt vmcnt(10)
    v_mfma_f32_16x16x32_bf16 v[28:31], v[240:243], v[132:135], v[28:31]
    ds_read_b64_tr_b16 v[230:231], v5 offset:9504
    s_waitcnt lgkmcnt(4)
    v_mfma_f32_16x16x32_bf16 v[32:35], v[244:247], v[128:131], v[32:35]
    ds_read_b64_tr_b16 v[232:233], v4 offset:8704
    v_mfma_f32_16x16x32_bf16 v[36:39], v[244:247], v[132:135], v[36:39]
    ds_read_b64_tr_b16 v[234:235], v4 offset:9728
    s_mov_b32 s23, 0x5000
    buffer_load_dwordx4 v[112:115], v7, s[8:11], s23 offen offset:1024 sc1
    s_waitcnt lgkmcnt(4)
    v_mfma_f32_16x16x32_bf16 v[40:43], v[224:227], v[128:131], v[40:43]
    ds_read_b64_tr_b16 v[236:237], v5 offset:8736
    v_mfma_f32_16x16x32_bf16 v[44:47], v[224:227], v[132:135], v[44:47]
    ds_read_b64_tr_b16 v[238:239], v5 offset:9760
    s_waitcnt lgkmcnt(4)
    v_mfma_f32_16x16x32_bf16 v[48:51], v[228:231], v[128:131], v[48:51]
    ds_read_b64_tr_b16 v[240:241], v4 offset:8960
    v_mfma_f32_16x16x32_bf16 v[52:55], v[228:231], v[132:135], v[52:55]
    ds_read_b64_tr_b16 v[242:243], v4 offset:9984
    s_waitcnt lgkmcnt(4)
    v_mfma_f32_16x16x32_bf16 v[56:59], v[232:235], v[128:131], v[56:59]
    ds_read_b64_tr_b16 v[244:245], v5 offset:8992
    v_mfma_f32_16x16x32_bf16 v[60:63], v[232:235], v[132:135], v[60:63]
    ds_read_b64_tr_b16 v[246:247], v5 offset:10016
    s_waitcnt lgkmcnt(4)
    v_mfma_f32_16x16x32_bf16 v[64:67], v[236:239], v[128:131], v[64:67]
    v_mfma_f32_16x16x32_bf16 v[68:71], v[236:239], v[132:135], v[68:71]
    s_waitcnt vmcnt(8)
    s_barrier
    ds_read_b64_tr_b16 v[224:225], v4 offset:16384
    ds_read_b64_tr_b16 v[226:227], v4 offset:17408
    s_mov_b32 s23, 0xd000
    buffer_load_dwordx4 v[116:119], v7, s[8:11], s23 offen offset:1024 sc1
    s_waitcnt lgkmcnt(4)
    v_mfma_f32_16x16x32_bf16 v[72:75], v[240:243], v[128:131], v[72:75]
    ds_read_b64_tr_b16 v[228:229], v5 offset:16416
    v_mfma_f32_16x16x32_bf16 v[76:79], v[240:243], v[132:135], v[76:79]
    s_add_u32 s22, s19, 0x580000
    s_add_u32 m0, s20, 0xc000
    s_nop 0
    buffer_load_dwordx4 v3, s[4:7], s22 offen lds
    ds_read_b64_tr_b16 v[230:231], v5 offset:17440
    s_waitcnt lgkmcnt(4)
    v_mfma_f32_16x16x32_bf16 v[80:83], v[244:247], v[128:131], v[80:83]
    ds_read_b64_tr_b16 v[232:233], v4 offset:16640
    v_mfma_f32_16x16x32_bf16 v[84:87], v[244:247], v[132:135], v[84:87]
    ds_read_b64_tr_b16 v[234:235], v4 offset:17664
    s_waitcnt lgkmcnt(4)
    v_mfma_f32_16x16x32_bf16 v[24:27], v[224:227], v[88:91], v[24:27]
    ds_read_b64_tr_b16 v[236:237], v5 offset:16672
    s_waitcnt vmcnt(9)
    v_mfma_f32_16x16x32_bf16 v[28:31], v[224:227], v[92:95], v[28:31]
    ds_read_b64_tr_b16 v[238:239], v5 offset:17696
    s_waitcnt lgkmcnt(4)
    v_mfma_f32_16x16x32_bf16 v[32:35], v[228:231], v[88:91], v[32:35]
    ds_read_b64_tr_b16 v[240:241], v4 offset:16896
    v_mfma_f32_16x16x32_bf16 v[36:39], v[228:231], v[92:95], v[36:39]
    ds_read_b64_tr_b16 v[242:243], v4 offset:17920
    s_mov_b32 s23, 0x5800
    buffer_load_dwordx4 v[120:123], v7, s[8:11], s23 offen offset:0 sc1
    s_waitcnt lgkmcnt(4)
    v_mfma_f32_16x16x32_bf16 v[40:43], v[232:235], v[88:91], v[40:43]
    ds_read_b64_tr_b16 v[244:245], v5 offset:16928
    v_mfma_f32_16x16x32_bf16 v[44:47], v[232:235], v[92:95], v[44:47]
    s_add_u32 s22, s19, 0x588000
    s_add_u32 m0, s20, 0xc400
    s_nop 0
    buffer_load_dwordx4 v3, s[4:7], s22 offen lds
    ds_read_b64_tr_b16 v[246:247], v5 offset:17952
    s_waitcnt lgkmcnt(4)
    v_mfma_f32_16x16x32_bf16 v[48:51], v[236:239], v[88:91], v[48:51]
    ds_read_b64_tr_b16 v[224:225], v4 offset:17152
    v_mfma_f32_16x16x32_bf16 v[52:55], v[236:239], v[92:95], v[52:55]
    ds_read_b64_tr_b16 v[226:227], v4 offset:18176
    s_waitcnt lgkmcnt(4)
    v_mfma_f32_16x16x32_bf16 v[56:59], v[240:243], v[88:91], v[56:59]
    ds_read_b64_tr_b16 v[228:229], v5 offset:17184
    v_mfma_f32_16x16x32_bf16 v[60:63], v[240:243], v[92:95], v[60:63]
    ds_read_b64_tr_b16 v[230:231], v5 offset:18208
    s_waitcnt lgkmcnt(4)
    v_mfma_f32_16x16x32_bf16 v[64:67], v[244:247], v[88:91], v[64:67]
    ds_read_b64_tr_b16 v[232:233], v4 offset:24576
    v_mfma_f32_16x16x32_bf16 v[68:71], v[244:247], v[92:95], v[68:71]
    ds_read_b64_tr_b16 v[234:235], v4 offset:25600
    s_mov_b32 s23, 0xd800
    buffer_load_dwordx4 v[124:127], v7, s[8:11], s23 offen offset:0 sc1
    s_waitcnt lgkmcnt(4)
    v_mfma_f32_16x16x32_bf16 v[72:75], v[224:227], v[88:91], v[72:75]
    ds_read_b64_tr_b16 v[236:237], v5 offset:24608
    v_xor_b32 v8, s28, v12
    v_xor_b32 v20, s28, v13
    v_or_b32 v8, v8, v20
    v_xor_b32 v20, s28, v14
    v_or_b32 v8, v8, v20
    v_xor_b32 v20, s28, v15
    v_or_b32 v8, v8, v20
    v_cmp_ne_u32 vcc, 0, v8
    s_cbranch_vccnz adaLN_cond__sliding_block_cached__moe_arch_mod__prompt_kernel_kv4r
adaLN_cond__sliding_block_cached__moe_arch_mod__prompt_kernel_kv4b:
    v_mfma_f32_16x16x32_bf16 v[76:79], v[224:227], v[92:95], v[76:79]
    ds_read_b64_tr_b16 v[238:239], v5 offset:25632
    v_mov_b32 v20, 0
    s_mov_b32 s16, 0x564000
    buffer_load_dword v8, v20, s[8:11], s16 offen sc1
    s_waitcnt lgkmcnt(4)
    v_mfma_f32_16x16x32_bf16 v[80:83], v[228:231], v[88:91], v[80:83]
    ds_read_b64_tr_b16 v[240:241], v4 offset:24832
    v_mfma_f32_16x16x32_bf16 v[84:87], v[228:231], v[92:95], v[84:87]
    ds_read_b64_tr_b16 v[242:243], v4 offset:25856
    s_waitcnt vmcnt(12) lgkmcnt(4)
    v_mfma_f32_16x16x32_bf16 v[24:27], v[232:235], v[96:99], v[24:27]
    ds_read_b64_tr_b16 v[244:245], v5 offset:24864
    s_waitcnt vmcnt(11)
    v_mfma_f32_16x16x32_bf16 v[28:31], v[232:235], v[100:103], v[28:31]
    ds_read_b64_tr_b16 v[246:247], v5 offset:25888
    s_waitcnt lgkmcnt(4)
    v_mfma_f32_16x16x32_bf16 v[32:35], v[236:239], v[96:99], v[32:35]
    ds_read_b64_tr_b16 v[224:225], v4 offset:25088
    v_mfma_f32_16x16x32_bf16 v[36:39], v[236:239], v[100:103], v[36:39]
    ds_read_b64_tr_b16 v[226:227], v4 offset:26112
    s_mov_b32 s23, 0x5800
    buffer_load_dwordx4 v[128:131], v7, s[8:11], s23 offen offset:1024 sc1
    s_waitcnt lgkmcnt(4)
    v_mfma_f32_16x16x32_bf16 v[40:43], v[240:243], v[96:99], v[40:43]
    ds_read_b64_tr_b16 v[228:229], v5 offset:25120
    s_mov_b64 s[76:77], s[54:55]
    s_mov_b32 s78, 0xc00000
    s_mov_b32 s79, 0x20000
    v_bfe_u32 v20, v1, 2, 2
    v_lshlrev_b32 v20, 12, v20
    v_add_u32 v6, v3, v20
    s_lshr_b32 s16, s2, 5
    s_lshl_b32 s16, s16, 7
    s_lshl_b32 s17, s3, 3
    s_add_u32 s16, s16, s17
    s_mul_i32 s14, s16, 12288
    s_and_b32 s16, s2, 31
    s_lshl_b32 s16, s16, 8
    s_add_u32 s14, s14, s16
    s_add_u32 s14, s14, 4096
    v_mfma_f32_16x16x32_bf16 v[44:47], v[240:243], v[100:103], v[44:47]
    ds_read_b64_tr_b16 v[230:231], v5 offset:26144
    s_waitcnt lgkmcnt(4)
    v_mfma_f32_16x16x32_bf16 v[48:51], v[244:247], v[96:99], v[48:51]
    ds_read_b64_tr_b16 v[232:233], v4 offset:25344
    v_mfma_f32_16x16x32_bf16 v[52:55], v[244:247], v[100:103], v[52:55]
    ds_read_b64_tr_b16 v[234:235], v4 offset:26368
    s_waitcnt lgkmcnt(4)
    v_mfma_f32_16x16x32_bf16 v[56:59], v[224:227], v[96:99], v[56:59]
    ds_read_b64_tr_b16 v[236:237], v5 offset:25376
    v_mfma_f32_16x16x32_bf16 v[60:63], v[224:227], v[100:103], v[60:63]
    ds_read_b64_tr_b16 v[238:239], v5 offset:26400
    s_waitcnt lgkmcnt(4)
    v_mfma_f32_16x16x32_bf16 v[64:67], v[228:231], v[96:99], v[64:67]
    v_mfma_f32_16x16x32_bf16 v[68:71], v[228:231], v[100:103], v[68:71]
    s_waitcnt vmcnt(9)
    s_barrier
    ds_read_b64_tr_b16 v[240:241], v4 offset:32768
    ds_read_b64_tr_b16 v[242:243], v4 offset:33792
    s_mov_b32 s23, 0xd800
    buffer_load_dwordx4 v[132:135], v7, s[8:11], s23 offen offset:1024 sc1
    s_waitcnt lgkmcnt(4)
    v_mfma_f32_16x16x32_bf16 v[72:75], v[232:235], v[96:99], v[72:75]
    ds_read_b64_tr_b16 v[244:245], v5 offset:32800
    v_mfma_f32_16x16x32_bf16 v[76:79], v[232:235], v[100:103], v[76:79]
    s_add_u32 s22, s19, 0x600000
    s_add_u32 m0, s20, 0x0
    s_nop 0
    buffer_load_dwordx4 v3, s[4:7], s22 offen lds
    ds_read_b64_tr_b16 v[246:247], v5 offset:33824
    s_waitcnt lgkmcnt(4)
    v_mfma_f32_16x16x32_bf16 v[80:83], v[236:239], v[96:99], v[80:83]
    ds_read_b64_tr_b16 v[224:225], v4 offset:33024
    v_mfma_f32_16x16x32_bf16 v[84:87], v[236:239], v[100:103], v[84:87]
    ds_read_b64_tr_b16 v[226:227], v4 offset:34048
    s_waitcnt lgkmcnt(4)
    v_mfma_f32_16x16x32_bf16 v[24:27], v[240:243], v[104:107], v[24:27]
    ds_read_b64_tr_b16 v[228:229], v5 offset:33056
    s_waitcnt vmcnt(10)
    v_mfma_f32_16x16x32_bf16 v[28:31], v[240:243], v[108:111], v[28:31]
    ds_read_b64_tr_b16 v[230:231], v5 offset:34080
    s_waitcnt lgkmcnt(4)
    v_mfma_f32_16x16x32_bf16 v[32:35], v[244:247], v[104:107], v[32:35]
    ds_read_b64_tr_b16 v[232:233], v4 offset:33280
    v_mfma_f32_16x16x32_bf16 v[36:39], v[244:247], v[108:111], v[36:39]
    ds_read_b64_tr_b16 v[234:235], v4 offset:34304
    s_mov_b32 s23, 0x6000
    buffer_load_dwordx4 v[88:91], v7, s[8:11], s23 offen offset:0 sc1
    s_waitcnt lgkmcnt(4)
    v_mfma_f32_16x16x32_bf16 v[40:43], v[224:227], v[104:107], v[40:43]
    ds_read_b64_tr_b16 v[236:237], v5 offset:33312
    v_mfma_f32_16x16x32_bf16 v[44:47], v[224:227], v[108:111], v[44:47]
    s_add_u32 s22, s19, 0x608000
    s_add_u32 m0, s20, 0x400
    s_nop 0
    buffer_load_dwordx4 v3, s[4:7], s22 offen lds
    ds_read_b64_tr_b16 v[238:239], v5 offset:34336
    s_waitcnt lgkmcnt(4)
    v_mfma_f32_16x16x32_bf16 v[48:51], v[228:231], v[104:107], v[48:51]
    ds_read_b64_tr_b16 v[240:241], v4 offset:33536
    v_mfma_f32_16x16x32_bf16 v[52:55], v[228:231], v[108:111], v[52:55]
    ds_read_b64_tr_b16 v[242:243], v4 offset:34560
    s_waitcnt lgkmcnt(4)
    v_mfma_f32_16x16x32_bf16 v[56:59], v[232:235], v[104:107], v[56:59]
    ds_read_b64_tr_b16 v[244:245], v5 offset:33568
    v_mfma_f32_16x16x32_bf16 v[60:63], v[232:235], v[108:111], v[60:63]
    ds_read_b64_tr_b16 v[246:247], v5 offset:34592
    s_waitcnt lgkmcnt(4)
    v_mfma_f32_16x16x32_bf16 v[64:67], v[236:239], v[104:107], v[64:67]
    ds_read_b64_tr_b16 v[224:225], v4 offset:40960
    v_mfma_f32_16x16x32_bf16 v[68:71], v[236:239], v[108:111], v[68:71]
    ds_read_b64_tr_b16 v[226:227], v4 offset:41984
    s_mov_b32 s23, 0xe000
    buffer_load_dwordx4 v[92:95], v7, s[8:11], s23 offen offset:0 sc1
    s_waitcnt lgkmcnt(4)
    v_mfma_f32_16x16x32_bf16 v[72:75], v[240:243], v[104:107], v[72:75]
    ds_read_b64_tr_b16 v[228:229], v5 offset:40992
    v_mfma_f32_16x16x32_bf16 v[76:79], v[240:243], v[108:111], v[76:79]
    ds_read_b64_tr_b16 v[230:231], v5 offset:42016
    s_waitcnt lgkmcnt(4)
    v_mfma_f32_16x16x32_bf16 v[80:83], v[244:247], v[104:107], v[80:83]
    ds_read_b64_tr_b16 v[232:233], v4 offset:41216
    v_mfma_f32_16x16x32_bf16 v[84:87], v[244:247], v[108:111], v[84:87]
    ds_read_b64_tr_b16 v[234:235], v4 offset:42240
    s_waitcnt vmcnt(12) lgkmcnt(4)
    v_mfma_f32_16x16x32_bf16 v[24:27], v[224:227], v[112:115], v[24:27]
    ds_read_b64_tr_b16 v[236:237], v5 offset:41248
    s_add_u32 s22, s14, 0x0
    s_add_u32 m0, s20, 0x10000
    s_nop 0
    buffer_load_dwordx4 v6, s[76:79], s22 offen lds
    s_waitcnt vmcnt(12)
    v_mfma_f32_16x16x32_bf16 v[28:31], v[224:227], v[116:119], v[28:31]
    ds_read_b64_tr_b16 v[238:239], v5 offset:42272
    s_waitcnt lgkmcnt(4)
    v_mfma_f32_16x16x32_bf16 v[32:35], v[228:231], v[112:115], v[32:35]
    ds_read_b64_tr_b16 v[240:241], v4 offset:41472
    v_mfma_f32_16x16x32_bf16 v[36:39], v[228:231], v[116:119], v[36:39]
    ds_read_b64_tr_b16 v[242:243], v4 offset:42496
    s_mov_b32 s23, 0x6000
    buffer_load_dwordx4 v[96:99], v7, s[8:11], s23 offen offset:1024 sc1
    s_waitcnt lgkmcnt(4)
    v_mfma_f32_16x16x32_bf16 v[40:43], v[232:235], v[112:115], v[40:43]
    ds_read_b64_tr_b16 v[244:245], v5 offset:41504
    s_add_u32 s22, s14, 0xc000
    s_add_u32 m0, s20, 0x10400
    s_nop 0
    buffer_load_dwordx4 v6, s[76:79], s22 offen lds
    v_mfma_f32_16x16x32_bf16 v[44:47], v[232:235], v[116:119], v[44:47]
    ds_read_b64_tr_b16 v[246:247], v5 offset:42528
    s_waitcnt lgkmcnt(4)
    v_mfma_f32_16x16x32_bf16 v[48:51], v[236:239], v[112:115], v[48:51]
    ds_read_b64_tr_b16 v[224:225], v4 offset:41728
    v_mfma_f32_16x16x32_bf16 v[52:55], v[236:239], v[116:119], v[52:55]
    ds_read_b64_tr_b16 v[226:227], v4 offset:42752
    s_waitcnt lgkmcnt(4)
    v_mfma_f32_16x16x32_bf16 v[56:59], v[240:243], v[112:115], v[56:59]
    ds_read_b64_tr_b16 v[228:229], v5 offset:41760
    v_mfma_f32_16x16x32_bf16 v[60:63], v[240:243], v[116:119], v[60:63]
    ds_read_b64_tr_b16 v[230:231], v5 offset:42784
    s_waitcnt lgkmcnt(4)
    v_mfma_f32_16x16x32_bf16 v[64:67], v[244:247], v[112:115], v[64:67]
    v_mfma_f32_16x16x32_bf16 v[68:71], v[244:247], v[116:119], v[68:71]
    s_waitcnt vmcnt(11)
    s_barrier
    ds_read_b64_tr_b16 v[232:233], v4 offset:49152
    ds_read_b64_tr_b16 v[234:235], v4 offset:50176
    s_mov_b32 s23, 0xe000
    buffer_load_dwordx4 v[100:103], v7, s[8:11], s23 offen offset:1024 sc1
    s_waitcnt lgkmcnt(4)
    v_mfma_f32_16x16x32_bf16 v[72:75], v[224:227], v[112:115], v[72:75]
    ds_read_b64_tr_b16 v[236:237], v5 offset:49184
    v_mfma_f32_16x16x32_bf16 v[76:79], v[224:227], v[116:119], v[76:79]
    s_add_u32 s22, s19, 0x680000
    s_add_u32 m0, s20, 0x4000
    s_nop 0
    buffer_load_dwordx4 v3, s[4:7], s22 offen lds
    ds_read_b64_tr_b16 v[238:239], v5 offset:50208
    s_waitcnt lgkmcnt(4)
    v_mfma_f32_16x16x32_bf16 v[80:83], v[228:231], v[112:115], v[80:83]
    ds_read_b64_tr_b16 v[240:241], v4 offset:49408
    v_mfma_f32_16x16x32_bf16 v[84:87], v[228:231], v[116:119], v[84:87]
    ds_read_b64_tr_b16 v[242:243], v4 offset:50432
    s_waitcnt lgkmcnt(4)
    v_mfma_f32_16x16x32_bf16 v[24:27], v[232:235], v[120:123], v[24:27]
    ds_read_b64_tr_b16 v[244:245], v5 offset:49440
    s_waitcnt vmcnt(12)
    v_mfma_f32_16x16x32_bf16 v[28:31], v[232:235], v[124:127], v[28:31]
    ds_read_b64_tr_b16 v[246:247], v5 offset:50464
    s_waitcnt lgkmcnt(4)
    v_mfma_f32_16x16x32_bf16 v[32:35], v[236:239], v[120:123], v[32:35]
    ds_read_b64_tr_b16 v[224:225], v4 offset:49664
    v_mfma_f32_16x16x32_bf16 v[36:39], v[236:239], v[124:127], v[36:39]
    ds_read_b64_tr_b16 v[226:227], v4 offset:50688
    s_mov_b32 s23, 0x6800
    buffer_load_dwordx4 v[104:107], v7, s[8:11], s23 offen offset:0 sc1
    s_waitcnt lgkmcnt(4)
    v_mfma_f32_16x16x32_bf16 v[40:43], v[240:243], v[120:123], v[40:43]
    ds_read_b64_tr_b16 v[228:229], v5 offset:49696
    v_mfma_f32_16x16x32_bf16 v[44:47], v[240:243], v[124:127], v[44:47]
    s_add_u32 s22, s19, 0x688000
    s_add_u32 m0, s20, 0x4400
    s_nop 0
    buffer_load_dwordx4 v3, s[4:7], s22 offen lds
    ds_read_b64_tr_b16 v[230:231], v5 offset:50720
    s_waitcnt lgkmcnt(4)
    v_mfma_f32_16x16x32_bf16 v[48:51], v[244:247], v[120:123], v[48:51]
    ds_read_b64_tr_b16 v[232:233], v4 offset:49920
    v_mfma_f32_16x16x32_bf16 v[52:55], v[244:247], v[124:127], v[52:55]
    ds_read_b64_tr_b16 v[234:235], v4 offset:50944
    s_waitcnt lgkmcnt(4)
    v_mfma_f32_16x16x32_bf16 v[56:59], v[224:227], v[120:123], v[56:59]
    ds_read_b64_tr_b16 v[236:237], v5 offset:49952
    v_mfma_f32_16x16x32_bf16 v[60:63], v[224:227], v[124:127], v[60:63]
    ds_read_b64_tr_b16 v[238:239], v5 offset:50976
    s_waitcnt lgkmcnt(4)
    v_mfma_f32_16x16x32_bf16 v[64:67], v[228:231], v[120:123], v[64:67]
    ds_read_b64_tr_b16 v[240:241], v4 offset:57344
    v_mfma_f32_16x16x32_bf16 v[68:71], v[228:231], v[124:127], v[68:71]
    ds_read_b64_tr_b16 v[242:243], v4 offset:58368
    s_mov_b32 s23, 0xe800
    buffer_load_dwordx4 v[108:111], v7, s[8:11], s23 offen offset:0 sc1
    s_waitcnt lgkmcnt(4)
    v_mfma_f32_16x16x32_bf16 v[72:75], v[232:235], v[120:123], v[72:75]
    ds_read_b64_tr_b16 v[244:245], v5 offset:57376
    v_mfma_f32_16x16x32_bf16 v[76:79], v[232:235], v[124:127], v[76:79]
    ds_read_b64_tr_b16 v[246:247], v5 offset:58400
    s_waitcnt lgkmcnt(4)
    v_mfma_f32_16x16x32_bf16 v[80:83], v[236:239], v[120:123], v[80:83]
    ds_read_b64_tr_b16 v[224:225], v4 offset:57600
    v_mfma_f32_16x16x32_bf16 v[84:87], v[236:239], v[124:127], v[84:87]
    ds_read_b64_tr_b16 v[226:227], v4 offset:58624
    s_waitcnt vmcnt(13) lgkmcnt(4)
    v_mfma_f32_16x16x32_bf16 v[24:27], v[240:243], v[128:131], v[24:27]
    ds_read_b64_tr_b16 v[228:229], v5 offset:57632
    s_add_u32 s22, s14, 0xc0000
    s_add_u32 m0, s20, 0x14000
    s_nop 0
    buffer_load_dwordx4 v6, s[76:79], s22 offen lds
    s_waitcnt vmcnt(13)
    v_mfma_f32_16x16x32_bf16 v[28:31], v[240:243], v[132:135], v[28:31]
    ds_read_b64_tr_b16 v[230:231], v5 offset:58656
    s_waitcnt lgkmcnt(4)
    v_mfma_f32_16x16x32_bf16 v[32:35], v[244:247], v[128:131], v[32:35]
    ds_read_b64_tr_b16 v[232:233], v4 offset:57856
    v_mfma_f32_16x16x32_bf16 v[36:39], v[244:247], v[132:135], v[36:39]
    ds_read_b64_tr_b16 v[234:235], v4 offset:58880
    s_mov_b32 s23, 0x6800
    buffer_load_dwordx4 v[112:115], v7, s[8:11], s23 offen offset:1024 sc1
    s_waitcnt lgkmcnt(4)
    v_mfma_f32_16x16x32_bf16 v[40:43], v[224:227], v[128:131], v[40:43]
    ds_read_b64_tr_b16 v[236:237], v5 offset:57888
    s_add_u32 s22, s14, 0xcc000
    s_add_u32 m0, s20, 0x14400
    s_nop 0
    buffer_load_dwordx4 v6, s[76:79], s22 offen lds
    v_mfma_f32_16x16x32_bf16 v[44:47], v[224:227], v[132:135], v[44:47]
    ds_read_b64_tr_b16 v[238:239], v5 offset:58912
    s_waitcnt lgkmcnt(4)
    v_mfma_f32_16x16x32_bf16 v[48:51], v[228:231], v[128:131], v[48:51]
    ds_read_b64_tr_b16 v[240:241], v4 offset:58112
    v_mfma_f32_16x16x32_bf16 v[52:55], v[228:231], v[132:135], v[52:55]
    ds_read_b64_tr_b16 v[242:243], v4 offset:59136
    s_waitcnt lgkmcnt(4)
    v_mfma_f32_16x16x32_bf16 v[56:59], v[232:235], v[128:131], v[56:59]
    ds_read_b64_tr_b16 v[244:245], v5 offset:58144
    v_mfma_f32_16x16x32_bf16 v[60:63], v[232:235], v[132:135], v[60:63]
    ds_read_b64_tr_b16 v[246:247], v5 offset:59168
    s_waitcnt lgkmcnt(4)
    v_mfma_f32_16x16x32_bf16 v[64:67], v[236:239], v[128:131], v[64:67]
    v_mfma_f32_16x16x32_bf16 v[68:71], v[236:239], v[132:135], v[68:71]
    s_waitcnt vmcnt(12)
    s_barrier
    ds_read_b64_tr_b16 v[224:225], v4 offset:0
    ds_read_b64_tr_b16 v[226:227], v4 offset:1024
    s_mov_b32 s23, 0xe800
    buffer_load_dwordx4 v[116:119], v7, s[8:11], s23 offen offset:1024 sc1
    s_waitcnt lgkmcnt(4)
    v_mfma_f32_16x16x32_bf16 v[72:75], v[240:243], v[128:131], v[72:75]
    ds_read_b64_tr_b16 v[228:229], v5 offset:32
    v_mfma_f32_16x16x32_bf16 v[76:79], v[240:243], v[132:135], v[76:79]
    s_add_u32 s22, s19, 0x700000
    s_add_u32 m0, s20, 0x8000
    s_nop 0
    buffer_load_dwordx4 v3, s[4:7], s22 offen lds
    ds_read_b64_tr_b16 v[230:231], v5 offset:1056
    s_waitcnt lgkmcnt(4)
    v_mfma_f32_16x16x32_bf16 v[80:83], v[244:247], v[128:131], v[80:83]
    ds_read_b64_tr_b16 v[232:233], v4 offset:256
    v_mfma_f32_16x16x32_bf16 v[84:87], v[244:247], v[132:135], v[84:87]
    ds_read_b64_tr_b16 v[234:235], v4 offset:1280
    s_waitcnt lgkmcnt(4)
    v_mfma_f32_16x16x32_bf16 v[24:27], v[224:227], v[88:91], v[24:27]
    ds_read_b64_tr_b16 v[236:237], v5 offset:288
    s_waitcnt vmcnt(13)
    v_mfma_f32_16x16x32_bf16 v[28:31], v[224:227], v[92:95], v[28:31]
    ds_read_b64_tr_b16 v[238:239], v5 offset:1312
    s_waitcnt lgkmcnt(4)
    v_mfma_f32_16x16x32_bf16 v[32:35], v[228:231], v[88:91], v[32:35]
    ds_read_b64_tr_b16 v[240:241], v4 offset:512
    v_mfma_f32_16x16x32_bf16 v[36:39], v[228:231], v[92:95], v[36:39]
    ds_read_b64_tr_b16 v[242:243], v4 offset:1536
    s_mov_b32 s23, 0x7000
    buffer_load_dwordx4 v[120:123], v7, s[8:11], s23 offen offset:0 sc1
    s_waitcnt lgkmcnt(4)
    v_mfma_f32_16x16x32_bf16 v[40:43], v[232:235], v[88:91], v[40:43]
    ds_read_b64_tr_b16 v[244:245], v5 offset:544
    v_mfma_f32_16x16x32_bf16 v[44:47], v[232:235], v[92:95], v[44:47]
    s_add_u32 s22, s19, 0x708000
    s_add_u32 m0, s20, 0x8400
    s_nop 0
    buffer_load_dwordx4 v3, s[4:7], s22 offen lds
    ds_read_b64_tr_b16 v[246:247], v5 offset:1568
    s_waitcnt lgkmcnt(4)
    v_mfma_f32_16x16x32_bf16 v[48:51], v[236:239], v[88:91], v[48:51]
    ds_read_b64_tr_b16 v[224:225], v4 offset:768
    v_mfma_f32_16x16x32_bf16 v[52:55], v[236:239], v[92:95], v[52:55]
    ds_read_b64_tr_b16 v[226:227], v4 offset:1792
    s_waitcnt lgkmcnt(4)
    v_mfma_f32_16x16x32_bf16 v[56:59], v[240:243], v[88:91], v[56:59]
    ds_read_b64_tr_b16 v[228:229], v5 offset:800
    v_mfma_f32_16x16x32_bf16 v[60:63], v[240:243], v[92:95], v[60:63]
    ds_read_b64_tr_b16 v[230:231], v5 offset:1824
    s_waitcnt lgkmcnt(4)
    v_mfma_f32_16x16x32_bf16 v[64:67], v[244:247], v[88:91], v[64:67]
    ds_read_b64_tr_b16 v[232:233], v4 offset:8192
    v_mfma_f32_16x16x32_bf16 v[68:71], v[244:247], v[92:95], v[68:71]
    ds_read_b64_tr_b16 v[234:235], v4 offset:9216
    s_mov_b32 s23, 0xf000
    buffer_load_dwordx4 v[124:127], v7, s[8:11], s23 offen offset:0 sc1
    s_waitcnt lgkmcnt(4)
    v_mfma_f32_16x16x32_bf16 v[72:75], v[224:227], v[88:91], v[72:75]
    ds_read_b64_tr_b16 v[236:237], v5 offset:8224
    v_mfma_f32_16x16x32_bf16 v[76:79], v[224:227], v[92:95], v[76:79]
    ds_read_b64_tr_b16 v[238:239], v5 offset:9248
    s_waitcnt lgkmcnt(4)
    v_mfma_f32_16x16x32_bf16 v[80:83], v[228:231], v[88:91], v[80:83]
    ds_read_b64_tr_b16 v[240:241], v4 offset:8448
    v_mfma_f32_16x16x32_bf16 v[84:87], v[228:231], v[92:95], v[84:87]
    ds_read_b64_tr_b16 v[242:243], v4 offset:9472
    s_waitcnt vmcnt(14) lgkmcnt(4)
    v_mfma_f32_16x16x32_bf16 v[24:27], v[232:235], v[96:99], v[24:27]
    ds_read_b64_tr_b16 v[244:245], v5 offset:8480
    s_add_u32 s22, s21, 0x0
    s_add_u32 m0, s20, 0x18000
    s_nop 0
    buffer_load_dwordx4 v2, s[8:11], s22 offen sc1 lds
    s_waitcnt vmcnt(13)
    v_mfma_f32_16x16x32_bf16 v[28:31], v[232:235], v[100:103], v[28:31]
    ds_read_b64_tr_b16 v[246:247], v5 offset:9504
    s_waitcnt lgkmcnt(4)
    v_mfma_f32_16x16x32_bf16 v[32:35], v[236:239], v[96:99], v[32:35]
    ds_read_b64_tr_b16 v[224:225], v4 offset:8704
    v_mfma_f32_16x16x32_bf16 v[36:39], v[236:239], v[100:103], v[36:39]
    ds_read_b64_tr_b16 v[226:227], v4 offset:9728
    s_mov_b32 s23, 0x7000
    buffer_load_dwordx4 v[128:131], v7, s[8:11], s23 offen offset:1024 sc1
    s_waitcnt lgkmcnt(4)
    v_mfma_f32_16x16x32_bf16 v[40:43], v[240:243], v[96:99], v[40:43]
    ds_read_b64_tr_b16 v[228:229], v5 offset:8736
    s_add_u32 s22, s21, 0x400
    s_add_u32 m0, s20, 0x18400
    s_nop 0
    buffer_load_dwordx4 v2, s[8:11], s22 offen sc1 lds
    v_mfma_f32_16x16x32_bf16 v[44:47], v[240:243], v[100:103], v[44:47]
    ds_read_b64_tr_b16 v[230:231], v5 offset:9760
    s_waitcnt lgkmcnt(4)
    v_mfma_f32_16x16x32_bf16 v[48:51], v[244:247], v[96:99], v[48:51]
    ds_read_b64_tr_b16 v[232:233], v4 offset:8960
    v_mfma_f32_16x16x32_bf16 v[52:55], v[244:247], v[100:103], v[52:55]
    ds_read_b64_tr_b16 v[234:235], v4 offset:9984
    s_waitcnt lgkmcnt(4)
    v_mfma_f32_16x16x32_bf16 v[56:59], v[224:227], v[96:99], v[56:59]
    ds_read_b64_tr_b16 v[236:237], v5 offset:8992
    v_mfma_f32_16x16x32_bf16 v[60:63], v[224:227], v[100:103], v[60:63]
    ds_read_b64_tr_b16 v[238:239], v5 offset:10016
    s_waitcnt lgkmcnt(4)
    v_mfma_f32_16x16x32_bf16 v[64:67], v[228:231], v[96:99], v[64:67]
    v_mfma_f32_16x16x32_bf16 v[68:71], v[228:231], v[100:103], v[68:71]
    s_waitcnt vmcnt(12)
    s_barrier
    ds_read_b64_tr_b16 v[240:241], v4 offset:16384
    ds_read_b64_tr_b16 v[242:243], v4 offset:17408
    s_mov_b32 s23, 0xf000
    buffer_load_dwordx4 v[132:135], v7, s[8:11], s23 offen offset:1024 sc1
    s_waitcnt lgkmcnt(4)
    v_mfma_f32_16x16x32_bf16 v[72:75], v[232:235], v[96:99], v[72:75]
    ds_read_b64_tr_b16 v[244:245], v5 offset:16416
    v_mfma_f32_16x16x32_bf16 v[76:79], v[232:235], v[100:103], v[76:79]
    s_add_u32 s22, s19, 0x780000
    s_add_u32 m0, s20, 0xc000
    s_nop 0
    buffer_load_dwordx4 v3, s[4:7], s22 offen lds
    ds_read_b64_tr_b16 v[246:247], v5 offset:17440
    s_waitcnt lgkmcnt(4)
    v_mfma_f32_16x16x32_bf16 v[80:83], v[236:239], v[96:99], v[80:83]
    ds_read_b64_tr_b16 v[224:225], v4 offset:16640
    v_mfma_f32_16x16x32_bf16 v[84:87], v[236:239], v[100:103], v[84:87]
    ds_read_b64_tr_b16 v[226:227], v4 offset:17664
    s_waitcnt lgkmcnt(4)
    v_mfma_f32_16x16x32_bf16 v[24:27], v[240:243], v[104:107], v[24:27]
    ds_read_b64_tr_b16 v[228:229], v5 offset:16672
    s_waitcnt vmcnt(13)
    v_mfma_f32_16x16x32_bf16 v[28:31], v[240:243], v[108:111], v[28:31]
    ds_read_b64_tr_b16 v[230:231], v5 offset:17696
    s_waitcnt lgkmcnt(4)
    v_mfma_f32_16x16x32_bf16 v[32:35], v[244:247], v[104:107], v[32:35]
    ds_read_b64_tr_b16 v[232:233], v4 offset:16896
    v_mfma_f32_16x16x32_bf16 v[36:39], v[244:247], v[108:111], v[36:39]
    ds_read_b64_tr_b16 v[234:235], v4 offset:17920
    s_mov_b32 s23, 0x7800
    buffer_load_dwordx4 v[88:91], v7, s[8:11], s23 offen offset:0 sc1
    s_waitcnt lgkmcnt(4)
    v_mfma_f32_16x16x32_bf16 v[40:43], v[224:227], v[104:107], v[40:43]
    ds_read_b64_tr_b16 v[236:237], v5 offset:16928
    v_lshrrev_b32 v20, 4, v1
    v_lshlrev_b32 v21, 4, v20
    s_lshl_b32 s16, s2, 8
    s_add_u32 s16, s16, 0x550000
    buffer_load_dwordx4 v[136:139], v21, s[8:11], s16 offen offset:0 sc1
    buffer_load_dwordx4 v[140:143], v21, s[8:11], s16 offen offset:64 sc1
    buffer_load_dwordx4 v[144:147], v21, s[8:11], s16 offen offset:128 sc1
    buffer_load_dwordx4 v[148:151], v21, s[8:11], s16 offen offset:192 sc1
    v_lshlrev_b32 v11, 11, v20
    v_xor_b32 v20, s3, v20
    v_and_b32 v20, 1, v20
    v_lshl_add_u32 v11, v20, 5, v11
    v_bfe_u32 v20, v1, 2, 2
    v_lshl_add_u32 v11, v20, 6, v11
    v_and_b32 v20, 3, v1
    v_lshl_add_u32 v11, v20, 3, v11
    s_lshr_b32 s16, s3, 1
    s_lshl_b32 s16, s16, 8
    s_add_u32 s16, s16, 65536
    v_add_u32 v11, s16, v11
    v_mfma_f32_16x16x32_bf16 v[44:47], v[224:227], v[108:111], v[44:47]
    s_add_u32 s22, s19, 0x788000
    s_add_u32 m0, s20, 0xc400
    s_nop 0
    buffer_load_dwordx4 v3, s[4:7], s22 offen lds
    ds_read_b64_tr_b16 v[238:239], v5 offset:17952
    s_waitcnt lgkmcnt(4)
    v_mfma_f32_16x16x32_bf16 v[48:51], v[228:231], v[104:107], v[48:51]
    ds_read_b64_tr_b16 v[240:241], v4 offset:17152
    v_mfma_f32_16x16x32_bf16 v[52:55], v[228:231], v[108:111], v[52:55]
    ds_read_b64_tr_b16 v[242:243], v4 offset:18176
    s_waitcnt lgkmcnt(4)
    v_mfma_f32_16x16x32_bf16 v[56:59], v[232:235], v[104:107], v[56:59]
    ds_read_b64_tr_b16 v[244:245], v5 offset:17184
    v_mfma_f32_16x16x32_bf16 v[60:63], v[232:235], v[108:111], v[60:63]
    ds_read_b64_tr_b16 v[246:247], v5 offset:18208
    s_waitcnt lgkmcnt(4)
    v_mfma_f32_16x16x32_bf16 v[64:67], v[236:239], v[104:107], v[64:67]
    ds_read_b64_tr_b16 v[224:225], v4 offset:24576
    v_mfma_f32_16x16x32_bf16 v[68:71], v[236:239], v[108:111], v[68:71]
    ds_read_b64_tr_b16 v[226:227], v4 offset:25600
    s_mov_b32 s23, 0xf800
    buffer_load_dwordx4 v[92:95], v7, s[8:11], s23 offen offset:0 sc1
    s_waitcnt lgkmcnt(4)
    v_mfma_f32_16x16x32_bf16 v[72:75], v[240:243], v[104:107], v[72:75]
    ds_read_b64_tr_b16 v[228:229], v5 offset:24608
    v_mfma_f32_16x16x32_bf16 v[76:79], v[240:243], v[108:111], v[76:79]
    ds_read_b64_tr_b16 v[230:231], v5 offset:25632
    s_waitcnt lgkmcnt(4)
    v_mfma_f32_16x16x32_bf16 v[80:83], v[244:247], v[104:107], v[80:83]
    ds_read_b64_tr_b16 v[232:233], v4 offset:24832
    v_mfma_f32_16x16x32_bf16 v[84:87], v[244:247], v[108:111], v[84:87]
    ds_read_b64_tr_b16 v[234:235], v4 offset:25856
    s_waitcnt vmcnt(18) lgkmcnt(4)
    v_mfma_f32_16x16x32_bf16 v[24:27], v[224:227], v[112:115], v[24:27]
    ds_read_b64_tr_b16 v[236:237], v5 offset:24864
    s_add_u32 s22, s21, 0x4000
    s_add_u32 m0, s20, 0x1c000
    s_nop 0
    buffer_load_dwordx4 v2, s[8:11], s22 offen sc1 lds
    s_waitcnt vmcnt(17)
    v_mfma_f32_16x16x32_bf16 v[28:31], v[224:227], v[116:119], v[28:31]
    ds_read_b64_tr_b16 v[238:239], v5 offset:25888
    s_waitcnt lgkmcnt(4)
    v_mfma_f32_16x16x32_bf16 v[32:35], v[228:231], v[112:115], v[32:35]
    ds_read_b64_tr_b16 v[240:241], v4 offset:25088
    v_mfma_f32_16x16x32_bf16 v[36:39], v[228:231], v[116:119], v[36:39]
    ds_read_b64_tr_b16 v[242:243], v4 offset:26112
    s_mov_b32 s23, 0x7800
    buffer_load_dwordx4 v[96:99], v7, s[8:11], s23 offen offset:1024 sc1
    s_waitcnt lgkmcnt(4)
    v_mfma_f32_16x16x32_bf16 v[40:43], v[232:235], v[112:115], v[40:43]
    ds_read_b64_tr_b16 v[244:245], v5 offset:25120
    s_add_u32 s22, s21, 0x4400
    s_add_u32 m0, s20, 0x1c400
    s_nop 0
    buffer_load_dwordx4 v2, s[8:11], s22 offen sc1 lds
    v_mfma_f32_16x16x32_bf16 v[44:47], v[232:235], v[116:119], v[44:47]
    ds_read_b64_tr_b16 v[246:247], v5 offset:26144
    s_waitcnt lgkmcnt(4)
    v_mfma_f32_16x16x32_bf16 v[48:51], v[236:239], v[112:115], v[48:51]
    ds_read_b64_tr_b16 v[224:225], v4 offset:25344
    v_mfma_f32_16x16x32_bf16 v[52:55], v[236:239], v[116:119], v[52:55]
    ds_read_b64_tr_b16 v[226:227], v4 offset:26368
    s_waitcnt lgkmcnt(4)
    v_mfma_f32_16x16x32_bf16 v[56:59], v[240:243], v[112:115], v[56:59]
    ds_read_b64_tr_b16 v[228:229], v5 offset:25376
    v_mfma_f32_16x16x32_bf16 v[60:63], v[240:243], v[116:119], v[60:63]
    ds_read_b64_tr_b16 v[230:231], v5 offset:26400
    s_waitcnt lgkmcnt(4)
    v_mfma_f32_16x16x32_bf16 v[64:67], v[244:247], v[112:115], v[64:67]
    v_mfma_f32_16x16x32_bf16 v[68:71], v[244:247], v[116:119], v[68:71]
    s_waitcnt vmcnt(16)
    s_barrier
    ds_read_b64_tr_b16 v[232:233], v4 offset:32768
    ds_read_b64_tr_b16 v[234:235], v4 offset:33792
    s_mov_b32 s23, 0xf800
    buffer_load_dwordx4 v[100:103], v7, s[8:11], s23 offen offset:1024 sc1
    s_waitcnt lgkmcnt(4)
    v_mfma_f32_16x16x32_bf16 v[72:75], v[224:227], v[112:115], v[72:75]
    ds_read_b64_tr_b16 v[236:237], v5 offset:32800
    v_mfma_f32_16x16x32_bf16 v[76:79], v[224:227], v[116:119], v[76:79]
    ds_read_b64_tr_b16 v[238:239], v5 offset:33824
    s_waitcnt lgkmcnt(4)
    v_mfma_f32_16x16x32_bf16 v[80:83], v[228:231], v[112:115], v[80:83]
    ds_read_b64_tr_b16 v[240:241], v4 offset:33024
    v_mfma_f32_16x16x32_bf16 v[84:87], v[228:231], v[116:119], v[84:87]
    ds_read_b64_tr_b16 v[242:243], v4 offset:34048
    s_waitcnt lgkmcnt(4)
    v_mfma_f32_16x16x32_bf16 v[24:27], v[232:235], v[120:123], v[24:27]
    ds_read_b64_tr_b16 v[244:245], v5 offset:33056
    s_waitcnt vmcnt(16)
    v_mfma_f32_16x16x32_bf16 v[28:31], v[232:235], v[124:127], v[28:31]
    ds_read_b64_tr_b16 v[246:247], v5 offset:34080
    s_waitcnt lgkmcnt(4)
    v_mfma_f32_16x16x32_bf16 v[32:35], v[236:239], v[120:123], v[32:35]
    ds_read_b64_tr_b16 v[224:225], v4 offset:33280
    v_mfma_f32_16x16x32_bf16 v[36:39], v[236:239], v[124:127], v[36:39]
    ds_read_b64_tr_b16 v[226:227], v4 offset:34304
    s_waitcnt lgkmcnt(4)
    v_mfma_f32_16x16x32_bf16 v[40:43], v[240:243], v[120:123], v[40:43]
    ds_read_b64_tr_b16 v[228:229], v5 offset:33312
    v_mfma_f32_16x16x32_bf16 v[44:47], v[240:243], v[124:127], v[44:47]
    ds_read_b64_tr_b16 v[230:231], v5 offset:34336
    s_waitcnt lgkmcnt(4)
    v_mfma_f32_16x16x32_bf16 v[48:51], v[244:247], v[120:123], v[48:51]
    ds_read_b64_tr_b16 v[232:233], v4 offset:33536
    v_mfma_f32_16x16x32_bf16 v[52:55], v[244:247], v[124:127], v[52:55]
    ds_read_b64_tr_b16 v[234:235], v4 offset:34560
    s_waitcnt lgkmcnt(4)
    v_mfma_f32_16x16x32_bf16 v[56:59], v[224:227], v[120:123], v[56:59]
    ds_read_b64_tr_b16 v[236:237], v5 offset:33568
    v_mfma_f32_16x16x32_bf16 v[60:63], v[224:227], v[124:127], v[60:63]
    ds_read_b64_tr_b16 v[238:239], v5 offset:34592
    s_waitcnt lgkmcnt(4)
    v_mfma_f32_16x16x32_bf16 v[64:67], v[228:231], v[120:123], v[64:67]
    ds_read_b64_tr_b16 v[240:241], v4 offset:40960
    v_mfma_f32_16x16x32_bf16 v[68:71], v[228:231], v[124:127], v[68:71]
    ds_read_b64_tr_b16 v[242:243], v4 offset:41984
    s_waitcnt lgkmcnt(4)
    v_mfma_f32_16x16x32_bf16 v[72:75], v[232:235], v[120:123], v[72:75]
    ds_read_b64_tr_b16 v[244:245], v5 offset:40992
    v_mfma_f32_16x16x32_bf16 v[76:79], v[232:235], v[124:127], v[76:79]
    ds_read_b64_tr_b16 v[246:247], v5 offset:42016
    s_waitcnt lgkmcnt(4)
    v_mfma_f32_16x16x32_bf16 v[80:83], v[236:239], v[120:123], v[80:83]
    ds_read_b64_tr_b16 v[224:225], v4 offset:41216
    v_mfma_f32_16x16x32_bf16 v[84:87], v[236:239], v[124:127], v[84:87]
    ds_read_b64_tr_b16 v[226:227], v4 offset:42240
    s_waitcnt vmcnt(14) lgkmcnt(4)
    v_mfma_f32_16x16x32_bf16 v[24:27], v[240:243], v[128:131], v[24:27]
    ds_read_b64_tr_b16 v[228:229], v5 offset:41248
    s_waitcnt vmcnt(12)
    v_mfma_f32_16x16x32_bf16 v[28:31], v[240:243], v[132:135], v[28:31]
    ds_read_b64_tr_b16 v[230:231], v5 offset:42272
    s_waitcnt lgkmcnt(4)
    v_mfma_f32_16x16x32_bf16 v[32:35], v[244:247], v[128:131], v[32:35]
    ds_read_b64_tr_b16 v[232:233], v4 offset:41472
    v_mfma_f32_16x16x32_bf16 v[36:39], v[244:247], v[132:135], v[36:39]
    ds_read_b64_tr_b16 v[234:235], v4 offset:42496
    s_waitcnt lgkmcnt(4)
    v_mfma_f32_16x16x32_bf16 v[40:43], v[224:227], v[128:131], v[40:43]
    ds_read_b64_tr_b16 v[236:237], v5 offset:41504
    v_mfma_f32_16x16x32_bf16 v[44:47], v[224:227], v[132:135], v[44:47]
    ds_read_b64_tr_b16 v[238:239], v5 offset:42528
    s_waitcnt lgkmcnt(4)
    v_mfma_f32_16x16x32_bf16 v[48:51], v[228:231], v[128:131], v[48:51]
    ds_read_b64_tr_b16 v[240:241], v4 offset:41728
    v_mfma_f32_16x16x32_bf16 v[52:55], v[228:231], v[132:135], v[52:55]
    ds_read_b64_tr_b16 v[242:243], v4 offset:42752
    s_waitcnt lgkmcnt(4)
    v_mfma_f32_16x16x32_bf16 v[56:59], v[232:235], v[128:131], v[56:59]
    ds_read_b64_tr_b16 v[244:245], v5 offset:41760
    v_mfma_f32_16x16x32_bf16 v[60:63], v[232:235], v[132:135], v[60:63]
    ds_read_b64_tr_b16 v[246:247], v5 offset:42784
    s_waitcnt lgkmcnt(4)
    v_mfma_f32_16x16x32_bf16 v[64:67], v[236:239], v[128:131], v[64:67]
    v_mfma_f32_16x16x32_bf16 v[68:71], v[236:239], v[132:135], v[68:71]
    s_waitcnt vmcnt(5)
    s_barrier
    ds_read_b64_tr_b16 v[224:225], v4 offset:49152
    ds_read_b64_tr_b16 v[226:227], v4 offset:50176
    s_waitcnt lgkmcnt(4)
    v_mfma_f32_16x16x32_bf16 v[72:75], v[240:243], v[128:131], v[72:75]
    ds_read_b64_tr_b16 v[228:229], v5 offset:49184
    v_mfma_f32_16x16x32_bf16 v[76:79], v[240:243], v[132:135], v[76:79]
    ds_read_b64_tr_b16 v[230:231], v5 offset:50208
    s_waitcnt lgkmcnt(4)
    v_mfma_f32_16x16x32_bf16 v[80:83], v[244:247], v[128:131], v[80:83]
    ds_read_b64_tr_b16 v[232:233], v4 offset:49408
    v_mfma_f32_16x16x32_bf16 v[84:87], v[244:247], v[132:135], v[84:87]
    ds_read_b64_tr_b16 v[234:235], v4 offset:50432
    s_waitcnt lgkmcnt(4)
    v_mfma_f32_16x16x32_bf16 v[24:27], v[224:227], v[88:91], v[24:27]
    ds_read_b64_tr_b16 v[236:237], v5 offset:49440
    s_waitcnt vmcnt(4)
    v_mfma_f32_16x16x32_bf16 v[28:31], v[224:227], v[92:95], v[28:31]
    ds_read_b64_tr_b16 v[238:239], v5 offset:50464
    s_waitcnt lgkmcnt(4)
    v_mfma_f32_16x16x32_bf16 v[32:35], v[228:231], v[88:91], v[32:35]
    ds_read_b64_tr_b16 v[240:241], v4 offset:49664
    v_mfma_f32_16x16x32_bf16 v[36:39], v[228:231], v[92:95], v[36:39]
    ds_read_b64_tr_b16 v[242:243], v4 offset:50688
    s_waitcnt lgkmcnt(4)
    v_mfma_f32_16x16x32_bf16 v[40:43], v[232:235], v[88:91], v[40:43]
    ds_read_b64_tr_b16 v[244:245], v5 offset:49696
    v_mfma_f32_16x16x32_bf16 v[44:47], v[232:235], v[92:95], v[44:47]
    ds_read_b64_tr_b16 v[246:247], v5 offset:50720
    s_waitcnt lgkmcnt(4)
    v_mfma_f32_16x16x32_bf16 v[48:51], v[236:239], v[88:91], v[48:51]
    ds_read_b64_tr_b16 v[224:225], v4 offset:49920
    v_mfma_f32_16x16x32_bf16 v[52:55], v[236:239], v[92:95], v[52:55]
    ds_read_b64_tr_b16 v[226:227], v4 offset:50944
    s_waitcnt lgkmcnt(4)
    v_mfma_f32_16x16x32_bf16 v[56:59], v[240:243], v[88:91], v[56:59]
    ds_read_b64_tr_b16 v[228:229], v5 offset:49952
    v_mfma_f32_16x16x32_bf16 v[60:63], v[240:243], v[92:95], v[60:63]
    ds_read_b64_tr_b16 v[230:231], v5 offset:50976
    s_waitcnt lgkmcnt(4)
    v_mfma_f32_16x16x32_bf16 v[64:67], v[244:247], v[88:91], v[64:67]
    ds_read_b64_tr_b16 v[232:233], v4 offset:57344
    v_mfma_f32_16x16x32_bf16 v[68:71], v[244:247], v[92:95], v[68:71]
    ds_read_b64_tr_b16 v[234:235], v4 offset:58368
    s_waitcnt lgkmcnt(4)
    v_mfma_f32_16x16x32_bf16 v[72:75], v[224:227], v[88:91], v[72:75]
    ds_read_b64_tr_b16 v[236:237], v5 offset:57376
    v_mfma_f32_16x16x32_bf16 v[76:79], v[224:227], v[92:95], v[76:79]
    ds_read_b64_tr_b16 v[238:239], v5 offset:58400
    s_waitcnt lgkmcnt(4)
    v_mfma_f32_16x16x32_bf16 v[80:83], v[228:231], v[88:91], v[80:83]
    ds_read_b64_tr_b16 v[240:241], v4 offset:57600
    v_mfma_f32_16x16x32_bf16 v[84:87], v[228:231], v[92:95], v[84:87]
    ds_read_b64_tr_b16 v[242:243], v4 offset:58624
    s_waitcnt vmcnt(2) lgkmcnt(4)
    v_mfma_f32_16x16x32_bf16 v[24:27], v[232:235], v[96:99], v[24:27]
    ds_read_b64_tr_b16 v[244:245], v5 offset:57632
    s_waitcnt vmcnt(0)
    v_mfma_f32_16x16x32_bf16 v[28:31], v[232:235], v[100:103], v[28:31]
    ds_read_b64_tr_b16 v[246:247], v5 offset:58656
    s_waitcnt lgkmcnt(4)
    v_mfma_f32_16x16x32_bf16 v[32:35], v[236:239], v[96:99], v[32:35]
    ds_read_b64_tr_b16 v[224:225], v4 offset:57856
    v_mfma_f32_16x16x32_bf16 v[36:39], v[236:239], v[100:103], v[36:39]
    ds_read_b64_tr_b16 v[226:227], v4 offset:58880
    s_waitcnt lgkmcnt(4)
    v_mfma_f32_16x16x32_bf16 v[40:43], v[240:243], v[96:99], v[40:43]
    ds_read_b64_tr_b16 v[228:229], v5 offset:57888
    v_mfma_f32_16x16x32_bf16 v[44:47], v[240:243], v[100:103], v[44:47]
    ds_read_b64_tr_b16 v[230:231], v5 offset:58912
    s_waitcnt lgkmcnt(4)
    v_mfma_f32_16x16x32_bf16 v[48:51], v[244:247], v[96:99], v[48:51]
    ds_read_b64_tr_b16 v[232:233], v4 offset:58112
    v_mfma_f32_16x16x32_bf16 v[52:55], v[244:247], v[100:103], v[52:55]
    ds_read_b64_tr_b16 v[234:235], v4 offset:59136
    s_waitcnt lgkmcnt(4)
    v_mfma_f32_16x16x32_bf16 v[56:59], v[224:227], v[96:99], v[56:59]
    ds_read_b64_tr_b16 v[236:237], v5 offset:58144
    v_mfma_f32_16x16x32_bf16 v[60:63], v[224:227], v[100:103], v[60:63]
    ds_read_b64_tr_b16 v[238:239], v5 offset:59168
    s_waitcnt lgkmcnt(4)
    v_mfma_f32_16x16x32_bf16 v[64:67], v[228:231], v[96:99], v[64:67]
    v_mfma_f32_16x16x32_bf16 v[68:71], v[228:231], v[100:103], v[68:71]
    s_waitcnt lgkmcnt(2)
    v_mfma_f32_16x16x32_bf16 v[72:75], v[232:235], v[96:99], v[72:75]
    v_mfma_f32_16x16x32_bf16 v[76:79], v[232:235], v[100:103], v[76:79]
    s_waitcnt lgkmcnt(0)
    v_mfma_f32_16x16x32_bf16 v[80:83], v[236:239], v[96:99], v[80:83]
    v_mfma_f32_16x16x32_bf16 v[84:87], v[236:239], v[100:103], v[84:87]
    s_barrier
    s_add_u32 s22, s21, 0x8000
    s_add_u32 m0, s20, 0x20000
    s_nop 0
    buffer_load_dwordx4 v2, s[8:11], s22 offen sc1 lds
    s_add_u32 s22, s21, 0x8400
    s_add_u32 m0, s20, 0x20400
    s_nop 0
    buffer_load_dwordx4 v2, s[8:11], s22 offen sc1 lds
    s_add_u32 s22, s21, 0xc000
    s_add_u32 m0, s20, 0x24000
    s_nop 0
    buffer_load_dwordx4 v2, s[8:11], s22 offen sc1 lds
    s_add_u32 s22, s21, 0xc400
    s_add_u32 m0, s20, 0x24400
    s_nop 0
    buffer_load_dwordx4 v2, s[8:11], s22 offen sc1 lds
    ds_read_b64_tr_b16 v[88:89], v11 offset:0
    ds_read_b64_tr_b16 v[90:91], v11 offset:1024
    ds_read_b64_tr_b16 v[92:93], v11 offset:8192
    ds_read_b64_tr_b16 v[94:95], v11 offset:9216
    ds_read_b64_tr_b16 v[96:97], v11 offset:16384
    ds_read_b64_tr_b16 v[98:99], v11 offset:17408
    ds_read_b64_tr_b16 v[100:101], v11 offset:24576
    ds_read_b64_tr_b16 v[102:103], v11 offset:25600
    s_mov_b32 s23, 0x3e0293ee
    v_mul_f32 v24, s23, v24
    v_mul_f32 v25, s23, v25
    v_mul_f32 v26, s23, v26
    v_mul_f32 v27, s23, v27
    v_mul_f32 v28, s23, v28
    v_mul_f32 v29, s23, v29
    v_mul_f32 v30, s23, v30
    v_mul_f32 v31, s23, v31
    v_mul_f32 v32, s23, v32
    v_mul_f32 v33, s23, v33
    v_mul_f32 v34, s23, v34
    v_mul_f32 v35, s23, v35
    v_mul_f32 v36, s23, v36
    v_mul_f32 v37, s23, v37
    v_mul_f32 v38, s23, v38
    v_mul_f32 v39, s23, v39
    v_cvt_pk_bf16_f32 v152, v24, v25
    v_cvt_pk_bf16_f32 v153, v26, v27
    v_cvt_pk_bf16_f32 v168, v28, v29
    v_cvt_pk_bf16_f32 v169, v30, v31
    v_cvt_pk_bf16_f32 v154, v32, v33
    v_cvt_pk_bf16_f32 v155, v34, v35
    v_cvt_pk_bf16_f32 v170, v36, v37
    v_cvt_pk_bf16_f32 v171, v38, v39
    s_waitcnt lgkmcnt(6)
    v_mfma_f32_16x16x32_bf16 v[104:107], v[88:91], v[136:139], 0
    s_waitcnt lgkmcnt(4)
    v_mfma_f32_16x16x32_bf16 v[104:107], v[92:95], v[140:143], v[104:107]
    s_waitcnt lgkmcnt(2)
    v_mfma_f32_16x16x32_bf16 v[104:107], v[96:99], v[144:147], v[104:107]
    s_waitcnt lgkmcnt(0)
    v_mfma_f32_16x16x32_bf16 v[104:107], v[100:103], v[148:151], v[104:107]
    v_add_u32 v4, 0x10000, v2
    v_add_u32 v5, 0x20000, v2
    s_barrier
    ds_read_b128 v[224:227], v4 offset:32768
    ds_read_b128 v[228:231], v4 offset:33792
    ds_read_b128 v[232:235], v4 offset:34816
    ds_read_b128 v[236:239], v4 offset:35840
    v_mov_b32 v12, 0x3f803f80
    v_mov_b32 v13, 0x3f803f80
    v_mov_b32 v14, 0x3f803f80
    v_mov_b32 v15, 0x3f803f80
    s_waitcnt lgkmcnt(3)
    v_mfma_f32_16x16x32_bf16 v[184:187], v[224:227], v[152:155], 0
    v_mul_f32 v40, s23, v40
    v_mul_f32 v41, s23, v41
    v_mul_f32 v42, s23, v42
    v_mul_f32 v43, s23, v43
    v_mul_f32 v44, s23, v44
    v_mul_f32 v45, s23, v45
    v_lshrrev_b32 v20, 4, v1
    v_lshlrev_b32 v20, 4, v20
    s_lshr_b32 s16, s2, 5
    s_lshl_b32 s16, s16, 14
    s_and_b32 s17, s2, 31
    s_lshl_b32 s17, s17, 9
    s_add_u32 s16, s16, s17
    s_lshl_b32 s17, s3, 6
    s_add_u32 s16, s16, s17
    s_add_u32 s16, s16, 0x580000
    s_mov_b32 exec_lo, 0x10001
    s_mov_b32 exec_hi, 0x10001
    buffer_store_dwordx4 v[104:107], v20, s[8:11], s16 offen sc1
    s_mov_b64 exec, -1
    v_mfma_f32_16x16x32_bf16 v[188:191], v[224:227], v[168:171], 0
    ds_read_b128 v[240:243], v4 offset:36864
    v_mul_f32 v46, s23, v46
    v_mul_f32 v47, s23, v47
    v_mul_f32 v48, s23, v48
    v_mul_f32 v49, s23, v49
    v_mul_f32 v50, s23, v50
    v_mul_f32 v51, s23, v51
    s_and_b32 s29, s2, 7
    s_mul_i32 s29, s29, 28
    s_lshr_b32 s16, s2, 3
    s_add_u32 s29, s29, s16
    s_waitcnt lgkmcnt(3)
    v_mfma_f32_16x16x32_bf16 v[192:195], v[228:231], v[152:155], 0
    s_add_u32 s22, s21, 0x10000
    s_add_u32 m0, s20, 0x10000
    s_nop 0
    buffer_load_dwordx4 v2, s[8:11], s22 offen sc1 lds
    v_mul_f32 v52, s23, v52
    v_mul_f32 v53, s23, v53
    v_mul_f32 v54, s23, v54
    v_mul_f32 v55, s23, v55
    v_cvt_pk_bf16_f32 v156, v40, v41
    v_cvt_pk_bf16_f32 v157, v42, v43
    v_mfma_f32_16x16x32_bf16 v[196:199], v[228:231], v[168:171], 0
    ds_read_b128 v[244:247], v4 offset:37888
    v_cvt_pk_bf16_f32 v172, v44, v45
    v_cvt_pk_bf16_f32 v173, v46, v47
    v_cvt_pk_bf16_f32 v158, v48, v49
    v_cvt_pk_bf16_f32 v159, v50, v51
    v_cvt_pk_bf16_f32 v174, v52, v53
    v_cvt_pk_bf16_f32 v175, v54, v55
    s_waitcnt lgkmcnt(3)
    v_mfma_f32_16x16x32_bf16 v[184:187], v[232:235], v[156:159], v[184:187]
    v_mul_f32 v56, s23, v56
    v_mul_f32 v57, s23, v57
    v_mul_f32 v58, s23, v58
    v_mul_f32 v59, s23, v59
    v_mul_f32 v60, s23, v60
    v_mul_f32 v61, s23, v61
    v_mfma_f32_16x16x32_bf16 v[188:191], v[232:235], v[172:175], v[188:191]
    ds_read_b128 v[224:227], v4 offset:38912
    v_mul_f32 v62, s23, v62
    v_mul_f32 v63, s23, v63
    v_mul_f32 v64, s23, v64
    v_mul_f32 v65, s23, v65
    v_mul_f32 v66, s23, v66
    v_mul_f32 v67, s23, v67
    s_waitcnt lgkmcnt(3)
    v_mfma_f32_16x16x32_bf16 v[192:195], v[236:239], v[156:159], v[192:195]
    v_mul_f32 v68, s23, v68
    v_mul_f32 v69, s23, v69
    v_mul_f32 v70, s23, v70
    v_mul_f32 v71, s23, v71
    v_cvt_pk_bf16_f32 v160, v56, v57
    v_cvt_pk_bf16_f32 v161, v58, v59
    v_mfma_f32_16x16x32_bf16 v[196:199], v[236:239], v[172:175], v[196:199]
    ds_read_b128 v[228:231], v4 offset:39936
    v_cvt_pk_bf16_f32 v176, v60, v61
    v_cvt_pk_bf16_f32 v177, v62, v63
    v_cvt_pk_bf16_f32 v162, v64, v65
    v_cvt_pk_bf16_f32 v163, v66, v67
    v_cvt_pk_bf16_f32 v178, v68, v69
    v_cvt_pk_bf16_f32 v179, v70, v71
    s_waitcnt lgkmcnt(3)
    v_mfma_f32_16x16x32_bf16 v[184:187], v[240:243], v[160:163], v[184:187]
    v_mul_f32 v72, s23, v72
    v_mul_f32 v73, s23, v73
    v_mul_f32 v74, s23, v74
    v_mul_f32 v75, s23, v75
    v_mul_f32 v76, s23, v76
    v_mul_f32 v77, s23, v77
    v_mfma_f32_16x16x32_bf16 v[188:191], v[240:243], v[176:179], v[188:191]
    ds_read_b128 v[232:235], v4 offset:40960
    v_mul_f32 v78, s23, v78
    v_mul_f32 v79, s23, v79
    v_mul_f32 v80, s23, v80
    v_mul_f32 v81, s23, v81
    v_mul_f32 v82, s23, v82
    v_mul_f32 v83, s23, v83
    s_waitcnt lgkmcnt(3)
    v_mfma_f32_16x16x32_bf16 v[192:195], v[244:247], v[160:163], v[192:195]
    s_add_u32 s22, s21, 0x10400
    s_add_u32 m0, s20, 0x10400
    s_nop 0
    buffer_load_dwordx4 v2, s[8:11], s22 offen sc1 lds
    v_mul_f32 v84, s23, v84
    v_mul_f32 v85, s23, v85
    v_mul_f32 v86, s23, v86
    v_mul_f32 v87, s23, v87
    v_cvt_pk_bf16_f32 v164, v72, v73
    v_cvt_pk_bf16_f32 v165, v74, v75
    v_mfma_f32_16x16x32_bf16 v[196:199], v[244:247], v[176:179], v[196:199]
    ds_read_b128 v[236:239], v4 offset:41984
    v_cvt_pk_bf16_f32 v180, v76, v77
    v_cvt_pk_bf16_f32 v181, v78, v79
    v_cvt_pk_bf16_f32 v166, v80, v81
    v_cvt_pk_bf16_f32 v167, v82, v83
    v_cvt_pk_bf16_f32 v182, v84, v85
    v_cvt_pk_bf16_f32 v183, v86, v87
    s_waitcnt lgkmcnt(3)
    v_mfma_f32_16x16x32_bf16 v[184:187], v[224:227], v[164:167], v[184:187]
    v_mfma_f32_16x16x32_bf16 v[188:191], v[224:227], v[180:183], v[188:191]
    ds_read_b128 v[240:243], v4 offset:43008
    s_waitcnt lgkmcnt(3)
    v_mfma_f32_16x16x32_bf16 v[192:195], v[228:231], v[164:167], v[192:195]
    v_mfma_f32_16x16x32_bf16 v[196:199], v[228:231], v[180:183], v[196:199]
    ds_read_b128 v[244:247], v4 offset:44032
    s_waitcnt lgkmcnt(3)
    v_mfma_f32_16x16x32_bf16 v[200:203], v[232:235], v[152:155], 0
    v_mfma_f32_16x16x32_bf16 v[204:207], v[232:235], v[168:171], 0
    ds_read_b128 v[224:227], v4 offset:45056
    s_waitcnt lgkmcnt(3)
    v_mfma_f32_16x16x32_bf16 v[208:211], v[236:239], v[152:155], 0
    v_mfma_f32_16x16x32_bf16 v[212:215], v[236:239], v[168:171], 0
    ds_read_b128 v[228:231], v4 offset:46080
    s_waitcnt lgkmcnt(3)
    v_mfma_f32_16x16x32_bf16 v[200:203], v[240:243], v[156:159], v[200:203]
    v_mfma_f32_16x16x32_bf16 v[204:207], v[240:243], v[172:175], v[204:207]
    ds_read_b128 v[232:235], v4 offset:47104
    s_waitcnt lgkmcnt(3)
    v_mfma_f32_16x16x32_bf16 v[208:211], v[244:247], v[156:159], v[208:211]
    v_max3_f32 v16, v184, v185, v186
    v_mfma_f32_16x16x32_bf16 v[212:215], v[244:247], v[172:175], v[212:215]
    ds_read_b128 v[236:239], v4 offset:48128
    v_max3_f32 v16, v16, v187, v192
    s_waitcnt lgkmcnt(3)
    v_mfma_f32_16x16x32_bf16 v[200:203], v[224:227], v[160:163], v[200:203]
    v_max3_f32 v16, v16, v193, v194
    v_mfma_f32_16x16x32_bf16 v[204:207], v[224:227], v[176:179], v[204:207]
    s_barrier
    ds_read_b128 v[240:243], v4 offset:49152
    v_max_f32 v16, v16, v195
    s_waitcnt lgkmcnt(3)
    v_mfma_f32_16x16x32_bf16 v[208:211], v[228:231], v[160:163], v[208:211]
    v_max3_f32 v17, v188, v189, v190
    v_mfma_f32_16x16x32_bf16 v[212:215], v[228:231], v[176:179], v[212:215]
    s_add_u32 s22, s21, 0x14000
    s_add_u32 m0, s20, 0x14000
    s_nop 0
    buffer_load_dwordx4 v2, s[8:11], s22 offen sc1 lds
    ds_read_b128 v[244:247], v4 offset:50176
    v_max3_f32 v17, v17, v191, v196
    s_waitcnt lgkmcnt(3)
    v_mfma_f32_16x16x32_bf16 v[200:203], v[232:235], v[164:167], v[200:203]
    v_max3_f32 v17, v17, v197, v198
    v_mfma_f32_16x16x32_bf16 v[204:207], v[232:235], v[180:183], v[204:207]
    ds_read_b128 v[224:227], v4 offset:51200
    v_max_f32 v17, v17, v199
    s_waitcnt lgkmcnt(3)
    v_mfma_f32_16x16x32_bf16 v[208:211], v[236:239], v[164:167], v[208:211]
    v_mfma_f32_16x16x32_bf16 v[212:215], v[236:239], v[180:183], v[212:215]
    ds_read_b128 v[228:231], v4 offset:52224
    v_max3_f32 v16, v16, v200, v201
    v_max3_f32 v16, v16, v202, v203
    s_nop 3
    v_max3_f32 v16, v16, v208, v209
    v_max3_f32 v16, v16, v210, v211
    v_max3_f32 v17, v17, v204, v205
    v_max3_f32 v17, v17, v206, v207
    v_max3_f32 v17, v17, v212, v213
    v_max3_f32 v17, v17, v214, v215
    v_mov_b32 v18, v16
    v_mov_b32 v19, v17
    s_nop 0
    v_permlane16_swap_b32 v16, v18
    v_permlane16_swap_b32 v17, v19
    v_max_f32 v16, v16, v18
    v_max_f32 v17, v17, v19
    v_mov_b32 v18, v16
    v_mov_b32 v19, v17
    s_nop 0
    v_permlane32_swap_b32 v16, v18
    v_permlane32_swap_b32 v17, v19
    v_max_f32 v16, v16, v18
    v_max_f32 v17, v17, v19
    v_sub_f32 v216, 0, v16
    v_sub_f32 v217, 0, v16
    v_sub_f32 v218, 0, v16
    v_sub_f32 v219, 0, v16
    v_sub_f32 v220, 0, v17
    v_sub_f32 v221, 0, v17
    v_sub_f32 v222, 0, v17
    v_sub_f32 v223, 0, v17
    v_add_f32 v184, v184, v216
    v_add_f32 v185, v185, v216
    v_exp_f32 v184, v184
    v_exp_f32 v185, v185
    v_add_f32 v186, v186, v216
    v_add_f32 v187, v187, v216
    v_exp_f32 v186, v186
    v_exp_f32 v187, v187
    v_cvt_pk_bf16_f32 v24, v184, v185
    v_add_f32 v188, v188, v220
    v_add_f32 v189, v189, v220
    v_exp_f32 v188, v188
    v_exp_f32 v189, v189
    v_cvt_pk_bf16_f32 v25, v186, v187
    v_add_f32 v190, v190, v220
    v_add_f32 v191, v191, v220
    v_exp_f32 v190, v190
    v_exp_f32 v191, v191
    v_cvt_pk_bf16_f32 v28, v188, v189
    v_add_f32 v192, v192, v216
    v_add_f32 v193, v193, v216
    v_exp_f32 v192, v192
    v_exp_f32 v193, v193
    v_cvt_pk_bf16_f32 v29, v190, v191
    v_add_f32 v194, v194, v216
    v_add_f32 v195, v195, v216
    v_exp_f32 v194, v194
    v_exp_f32 v195, v195
    v_cvt_pk_bf16_f32 v26, v192, v193
    v_add_f32 v196, v196, v220
    v_add_f32 v197, v197, v220
    v_exp_f32 v196, v196
    v_exp_f32 v197, v197
    v_cvt_pk_bf16_f32 v27, v194, v195
    v_add_f32 v198, v198, v220
    v_add_f32 v199, v199, v220
    v_exp_f32 v198, v198
    v_exp_f32 v199, v199
    v_cvt_pk_bf16_f32 v30, v196, v197
    v_cvt_pk_bf16_f32 v31, v198, v199
    s_waitcnt lgkmcnt(3)
    v_mfma_f32_16x16x32_bf16 v[184:187], v[240:243], v[152:155], v[216:219]
    v_mfma_f32_16x16x32_bf16 v[188:191], v[240:243], v[168:171], v[220:223]
    ds_read_b128 v[232:235], v4 offset:53248
    v_add_f32 v200, v200, v216
    v_add_f32 v201, v201, v216
    v_exp_f32 v200, v200
    v_mfma_f32_16x16x32_bf16 v[248:251], v[12:15], v[24:27], 0
    s_waitcnt lgkmcnt(3)
    v_mfma_f32_16x16x32_bf16 v[192:195], v[244:247], v[152:155], v[216:219]
    v_exp_f32 v201, v201
    v_add_f32 v202, v202, v216
    v_add_f32 v203, v203, v216
    v_mfma_f32_16x16x32_bf16 v[196:199], v[244:247], v[168:171], v[220:223]
    s_add_u32 s22, s21, 0x14400
    s_add_u32 m0, s20, 0x14400
    s_nop 0
    buffer_load_dwordx4 v2, s[8:11], s22 offen sc1 lds
    ds_read_b128 v[236:239], v4 offset:54272
    v_exp_f32 v202, v202
    v_exp_f32 v203, v203
    v_mfma_f32_16x16x32_bf16 v[252:255], v[12:15], v[28:31], 0
    s_waitcnt lgkmcnt(3)
    v_mfma_f32_16x16x32_bf16 v[184:187], v[224:227], v[156:159], v[184:187]
    v_cvt_pk_bf16_f32 v32, v200, v201
    v_add_f32 v204, v204, v220
    v_add_f32 v205, v205, v220
    v_mfma_f32_16x16x32_bf16 v[188:191], v[224:227], v[172:175], v[188:191]
    ds_read_b128 v[240:243], v4 offset:55296
    v_exp_f32 v204, v204
    v_exp_f32 v205, v205
    v_cvt_pk_bf16_f32 v33, v202, v203
    s_mov_b64 s[4:5], s[40:41]
    s_mov_b32 s6, 0x800000
    s_mov_b32 s7, 0x20000
    v_bfe_u32 v20, v1, 2, 2
    v_lshlrev_b32 v21, 13, v20
    v_sub_u32 v3, v3, v21
    v_lshl_add_u32 v3, v20, 11, v3
    s_and_b32 s16, s2, 1
    s_lshl_b32 s24, s16, 22
    s_lshr_b32 s16, s2, 5
    s_lshl_b32 s16, s16, 8
    s_add_u32 s24, s24, s16
    s_lshl_b32 s16, s3, 14
    s_add_u32 s24, s24, s16
    s_waitcnt lgkmcnt(3)
    v_mfma_f32_16x16x32_bf16 v[192:195], v[228:231], v[156:159], v[192:195]
    v_add_f32 v206, v206, v220
    v_add_f32 v207, v207, v220
    v_mfma_f32_16x16x32_bf16 v[196:199], v[228:231], v[172:175], v[196:199]
    ds_read_b128 v[244:247], v4 offset:56320
    v_exp_f32 v206, v206
    v_exp_f32 v207, v207
    v_cvt_pk_bf16_f32 v36, v204, v205
    s_waitcnt lgkmcnt(3)
    v_mfma_f32_16x16x32_bf16 v[184:187], v[232:235], v[160:163], v[184:187]
    v_add_f32 v208, v208, v216
    v_add_f32 v209, v209, v216
    v_exp_f32 v208, v208
    v_mfma_f32_16x16x32_bf16 v[188:191], v[232:235], v[176:179], v[188:191]
    ds_read_b128 v[224:227], v4 offset:57344
    v_exp_f32 v209, v209
    v_cvt_pk_bf16_f32 v37, v206, v207
    s_waitcnt lgkmcnt(3)
    v_mfma_f32_16x16x32_bf16 v[192:195], v[236:239], v[160:163], v[192:195]
    v_add_f32 v210, v210, v216
    v_add_f32 v211, v211, v216
    v_exp_f32 v210, v210
    v_mfma_f32_16x16x32_bf16 v[196:199], v[236:239], v[176:179], v[196:199]
    ds_read_b128 v[228:231], v4 offset:58368
    v_exp_f32 v211, v211
    v_cvt_pk_bf16_f32 v34, v208, v209
    v_add_f32 v212, v212, v220
    s_waitcnt lgkmcnt(3)
    v_mfma_f32_16x16x32_bf16 v[184:187], v[240:243], v[164:167], v[184:187]
    v_add_f32 v213, v213, v220
    v_exp_f32 v212, v212
    v_mfma_f32_16x16x32_bf16 v[188:191], v[240:243], v[180:183], v[188:191]
    ds_read_b128 v[232:235], v4 offset:59392
    v_exp_f32 v213, v213
    v_cvt_pk_bf16_f32 v35, v210, v211
    v_add_f32 v214, v214, v220
    s_waitcnt lgkmcnt(3)
    v_mfma_f32_16x16x32_bf16 v[192:195], v[244:247], v[164:167], v[192:195]
    v_add_f32 v215, v215, v220
    v_exp_f32 v214, v214
    v_exp_f32 v215, v215
    v_mfma_f32_16x16x32_bf16 v[196:199], v[244:247], v[180:183], v[196:199]
    ds_read_b128 v[236:239], v4 offset:60416
    v_cvt_pk_bf16_f32 v38, v212, v213
    v_cvt_pk_bf16_f32 v39, v214, v215
    s_waitcnt lgkmcnt(3)
    v_mfma_f32_16x16x32_bf16 v[200:203], v[224:227], v[152:155], v[216:219]
    v_mfma_f32_16x16x32_bf16 v[204:207], v[224:227], v[168:171], v[220:223]
    ds_read_b128 v[240:243], v4 offset:61440
    v_exp_f32 v184, v184
    v_exp_f32 v185, v185
    v_mfma_f32_16x16x32_bf16 v[248:251], v[12:15], v[32:35], v[248:251]
    s_waitcnt lgkmcnt(3)
    v_mfma_f32_16x16x32_bf16 v[208:211], v[228:231], v[152:155], v[216:219]
    v_exp_f32 v186, v186
    v_exp_f32 v187, v187
    v_mfma_f32_16x16x32_bf16 v[212:215], v[228:231], v[168:171], v[220:223]
    ds_read_b128 v[244:247], v4 offset:62464
    v_cvt_pk_bf16_f32 v40, v184, v185
    v_mfma_f32_16x16x32_bf16 v[252:255], v[12:15], v[36:39], v[252:255]
    s_waitcnt lgkmcnt(3)
    v_mfma_f32_16x16x32_bf16 v[200:203], v[232:235], v[156:159], v[200:203]
    v_exp_f32 v188, v188
    v_exp_f32 v189, v189
    v_mfma_f32_16x16x32_bf16 v[204:207], v[232:235], v[172:175], v[204:207]
    ds_read_b128 v[224:227], v4 offset:63488
    v_cvt_pk_bf16_f32 v41, v186, v187
    s_waitcnt lgkmcnt(3)
    v_mfma_f32_16x16x32_bf16 v[208:211], v[236:239], v[156:159], v[208:211]
    v_exp_f32 v190, v190
    v_exp_f32 v191, v191
    v_mfma_f32_16x16x32_bf16 v[212:215], v[236:239], v[172:175], v[212:215]
    ds_read_b128 v[228:231], v4 offset:64512
    v_cvt_pk_bf16_f32 v44, v188, v189
    v_exp_f32 v192, v192
    s_waitcnt lgkmcnt(3)
    v_mfma_f32_16x16x32_bf16 v[200:203], v[240:243], v[160:163], v[200:203]
    v_exp_f32 v193, v193
    v_mfma_f32_16x16x32_bf16 v[204:207], v[240:243], v[176:179], v[204:207]
    s_waitcnt vmcnt(7)
    s_barrier
    ds_read_b128 v[232:235], v5 offset:0
    v_cvt_pk_bf16_f32 v45, v190, v191
    v_exp_f32 v194, v194
    s_waitcnt lgkmcnt(3)
    v_mfma_f32_16x16x32_bf16 v[208:211], v[244:247], v[160:163], v[208:211]
    v_exp_f32 v195, v195
    v_mfma_f32_16x16x32_bf16 v[212:215], v[244:247], v[176:179], v[212:215]
    s_add_u32 s22, s21, 0x18000
    s_add_u32 m0, s20, 0x18000
    s_nop 0
    buffer_load_dwordx4 v2, s[8:11], s22 offen sc1 lds
    ds_read_b128 v[236:239], v5 offset:1024
    v_cvt_pk_bf16_f32 v42, v192, v193
    v_exp_f32 v196, v196
    s_waitcnt lgkmcnt(3)
    v_mfma_f32_16x16x32_bf16 v[200:203], v[224:227], v[164:167], v[200:203]
    v_exp_f32 v197, v197
    v_cvt_pk_bf16_f32 v43, v194, v195
    v_mfma_f32_16x16x32_bf16 v[204:207], v[224:227], v[180:183], v[204:207]
    ds_read_b128 v[240:243], v5 offset:2048
    v_exp_f32 v198, v198
    s_waitcnt lgkmcnt(3)
    v_mfma_f32_16x16x32_bf16 v[208:211], v[228:231], v[164:167], v[208:211]
    v_exp_f32 v199, v199
    v_cvt_pk_bf16_f32 v46, v196, v197
    v_mfma_f32_16x16x32_bf16 v[212:215], v[228:231], v[180:183], v[212:215]
    ds_read_b128 v[244:247], v5 offset:3072
    v_cvt_pk_bf16_f32 v47, v198, v199
    s_waitcnt lgkmcnt(3)
    v_mfma_f32_16x16x32_bf16 v[184:187], v[232:235], v[152:155], v[216:219]
    v_mfma_f32_16x16x32_bf16 v[188:191], v[232:235], v[168:171], v[220:223]
    ds_read_b128 v[224:227], v5 offset:4096
    v_exp_f32 v200, v200
    v_exp_f32 v201, v201
    v_mfma_f32_16x16x32_bf16 v[248:251], v[12:15], v[40:43], v[248:251]
    s_waitcnt lgkmcnt(3)
    v_mfma_f32_16x16x32_bf16 v[192:195], v[236:239], v[152:155], v[216:219]
    v_exp_f32 v202, v202
    v_exp_f32 v203, v203
    v_mfma_f32_16x16x32_bf16 v[196:199], v[236:239], v[168:171], v[220:223]
    s_add_u32 s22, s21, 0x18400
    s_add_u32 m0, s20, 0x18400
    s_nop 0
    buffer_load_dwordx4 v2, s[8:11], s22 offen sc1 lds
    ds_read_b128 v[228:231], v5 offset:5120
    v_cvt_pk_bf16_f32 v48, v200, v201
    v_mfma_f32_16x16x32_bf16 v[252:255], v[12:15], v[44:47], v[252:255]
    s_waitcnt lgkmcnt(3)
    v_mfma_f32_16x16x32_bf16 v[184:187], v[240:243], v[156:159], v[184:187]
    v_exp_f32 v204, v204
    v_exp_f32 v205, v205
    v_mfma_f32_16x16x32_bf16 v[188:191], v[240:243], v[172:175], v[188:191]
    ds_read_b128 v[232:235], v5 offset:6144
    v_cvt_pk_bf16_f32 v49, v202, v203
    s_waitcnt lgkmcnt(3)
    v_mfma_f32_16x16x32_bf16 v[192:195], v[244:247], v[156:159], v[192:195]
    v_exp_f32 v206, v206
    v_exp_f32 v207, v207
    v_mfma_f32_16x16x32_bf16 v[196:199], v[244:247], v[172:175], v[196:199]
    ds_read_b128 v[236:239], v5 offset:7168
    v_cvt_pk_bf16_f32 v52, v204, v205
    v_exp_f32 v208, v208
    s_waitcnt lgkmcnt(3)
    v_mfma_f32_16x16x32_bf16 v[184:187], v[224:227], v[160:163], v[184:187]
    v_exp_f32 v209, v209
    v_mfma_f32_16x16x32_bf16 v[188:191], v[224:227], v[176:179], v[188:191]
    ds_read_b128 v[240:243], v5 offset:8192
    v_cvt_pk_bf16_f32 v53, v206, v207
    v_exp_f32 v210, v210
    s_waitcnt lgkmcnt(3)
    v_mfma_f32_16x16x32_bf16 v[192:195], v[228:231], v[160:163], v[192:195]
    v_exp_f32 v211, v211
    v_mfma_f32_16x16x32_bf16 v[196:199], v[228:231], v[176:179], v[196:199]
    ds_read_b128 v[244:247], v5 offset:9216
    v_cvt_pk_bf16_f32 v50, v208, v209
    v_exp_f32 v212, v212
    s_waitcnt lgkmcnt(3)
    v_mfma_f32_16x16x32_bf16 v[184:187], v[232:235], v[164:167], v[184:187]
    v_exp_f32 v213, v213
    v_cvt_pk_bf16_f32 v51, v210, v211
    v_mfma_f32_16x16x32_bf16 v[188:191], v[232:235], v[180:183], v[188:191]
    ds_read_b128 v[224:227], v5 offset:10240
    v_exp_f32 v214, v214
    s_waitcnt lgkmcnt(3)
    v_mfma_f32_16x16x32_bf16 v[192:195], v[236:239], v[164:167], v[192:195]
    v_exp_f32 v215, v215
    v_cvt_pk_bf16_f32 v54, v212, v213
    v_mfma_f32_16x16x32_bf16 v[196:199], v[236:239], v[180:183], v[196:199]
    ds_read_b128 v[228:231], v5 offset:11264
    v_cvt_pk_bf16_f32 v55, v214, v215
    s_waitcnt lgkmcnt(3)
    v_mfma_f32_16x16x32_bf16 v[200:203], v[240:243], v[152:155], v[216:219]
    v_mfma_f32_16x16x32_bf16 v[204:207], v[240:243], v[168:171], v[220:223]
    ds_read_b128 v[232:235], v5 offset:12288
    v_exp_f32 v184, v184
    v_exp_f32 v185, v185
    v_mfma_f32_16x16x32_bf16 v[248:251], v[12:15], v[48:51], v[248:251]
    s_waitcnt lgkmcnt(3)
    v_mfma_f32_16x16x32_bf16 v[208:211], v[244:247], v[152:155], v[216:219]
    v_exp_f32 v186, v186
    v_exp_f32 v187, v187
    v_mfma_f32_16x16x32_bf16 v[212:215], v[244:247], v[168:171], v[220:223]
    ds_read_b128 v[236:239], v5 offset:13312
    v_cvt_pk_bf16_f32 v56, v184, v185
    v_mfma_f32_16x16x32_bf16 v[252:255], v[12:15], v[52:55], v[252:255]
    s_waitcnt lgkmcnt(3)
    v_mfma_f32_16x16x32_bf16 v[200:203], v[224:227], v[156:159], v[200:203]
    v_exp_f32 v188, v188
    v_exp_f32 v189, v189
    v_mfma_f32_16x16x32_bf16 v[204:207], v[224:227], v[172:175], v[204:207]
    ds_read_b128 v[240:243], v5 offset:14336
    v_cvt_pk_bf16_f32 v57, v186, v187
    s_waitcnt lgkmcnt(3)
    v_mfma_f32_16x16x32_bf16 v[208:211], v[228:231], v[156:159], v[208:211]
    v_exp_f32 v190, v190
    v_exp_f32 v191, v191
    s_waitcnt vmcnt(6)
    v_mfma_f32_16x16x32_bf16 v[212:215], v[228:231], v[172:175], v[212:215]
    ds_read_b128 v[244:247], v5 offset:15360
    v_cvt_pk_bf16_f32 v60, v188, v189
    v_exp_f32 v192, v192
    s_waitcnt lgkmcnt(3)
    v_mfma_f32_16x16x32_bf16 v[200:203], v[232:235], v[160:163], v[200:203]
    v_exp_f32 v193, v193
    v_mfma_f32_16x16x32_bf16 v[204:207], v[232:235], v[176:179], v[204:207]
    s_barrier
    ds_read_b128 v[224:227], v5 offset:16384
    v_cvt_pk_bf16_f32 v61, v190, v191
    v_exp_f32 v194, v194
    s_waitcnt lgkmcnt(3)
    v_mfma_f32_16x16x32_bf16 v[208:211], v[236:239], v[160:163], v[208:211]
    v_exp_f32 v195, v195
    v_mfma_f32_16x16x32_bf16 v[212:215], v[236:239], v[176:179], v[212:215]
    s_add_u32 s22, s21, 0x1c000
    s_add_u32 m0, s20, 0x1c000
    s_nop 0
    buffer_load_dwordx4 v2, s[8:11], s22 offen sc1 lds
    ds_read_b128 v[228:231], v5 offset:17408
    v_cvt_pk_bf16_f32 v58, v192, v193
    v_exp_f32 v196, v196
    s_waitcnt lgkmcnt(3)
    v_mfma_f32_16x16x32_bf16 v[200:203], v[240:243], v[164:167], v[200:203]
    v_exp_f32 v197, v197
    v_cvt_pk_bf16_f32 v59, v194, v195
    v_mfma_f32_16x16x32_bf16 v[204:207], v[240:243], v[180:183], v[204:207]
    ds_read_b128 v[232:235], v5 offset:18432
    v_exp_f32 v198, v198
    s_waitcnt lgkmcnt(3)
    v_mfma_f32_16x16x32_bf16 v[208:211], v[244:247], v[164:167], v[208:211]
    v_exp_f32 v199, v199
    v_cvt_pk_bf16_f32 v62, v196, v197
    v_mov_b32 v20, s28
    v_mov_b32 v21, 0
    s_lshl_b32 s16, s2, 2
    s_add_u32 s16, s16, 0x560000
    s_cmp_eq_u32 s3, 0
    s_cselect_b32 s16, s16, 0x7ffffff0
    s_mov_b64 exec, 1
    buffer_store_dword v20, v21, s[8:11], s16 offen sc1
    s_mov_b64 exec, -1
    v_mfma_f32_16x16x32_bf16 v[212:215], v[244:247], v[180:183], v[212:215]
    ds_read_b128 v[236:239], v5 offset:19456
    v_cvt_pk_bf16_f32 v63, v198, v199
    s_waitcnt lgkmcnt(3)
    v_mfma_f32_16x16x32_bf16 v[184:187], v[224:227], v[152:155], v[216:219]
    v_mfma_f32_16x16x32_bf16 v[188:191], v[224:227], v[168:171], v[220:223]
    ds_read_b128 v[240:243], v5 offset:20480
    v_exp_f32 v200, v200
    v_exp_f32 v201, v201
    v_mfma_f32_16x16x32_bf16 v[248:251], v[12:15], v[56:59], v[248:251]
    s_waitcnt lgkmcnt(3)
    v_mfma_f32_16x16x32_bf16 v[192:195], v[228:231], v[152:155], v[216:219]
    v_exp_f32 v202, v202
    v_exp_f32 v203, v203
    v_mfma_f32_16x16x32_bf16 v[196:199], v[228:231], v[168:171], v[220:223]
    s_add_u32 s22, s21, 0x1c400
    s_add_u32 m0, s20, 0x1c400
    s_nop 0
    buffer_load_dwordx4 v2, s[8:11], s22 offen sc1 lds
    ds_read_b128 v[244:247], v5 offset:21504
    v_cvt_pk_bf16_f32 v64, v200, v201
    v_mfma_f32_16x16x32_bf16 v[252:255], v[12:15], v[60:63], v[252:255]
    s_waitcnt lgkmcnt(3)
    v_mfma_f32_16x16x32_bf16 v[184:187], v[232:235], v[156:159], v[184:187]
    v_exp_f32 v204, v204
    v_exp_f32 v205, v205
    v_mfma_f32_16x16x32_bf16 v[188:191], v[232:235], v[172:175], v[188:191]
    ds_read_b128 v[224:227], v5 offset:22528
    v_cvt_pk_bf16_f32 v65, v202, v203
    s_waitcnt lgkmcnt(3)
    v_mfma_f32_16x16x32_bf16 v[192:195], v[236:239], v[156:159], v[192:195]
    v_exp_f32 v206, v206
    v_exp_f32 v207, v207
    v_mfma_f32_16x16x32_bf16 v[196:199], v[236:239], v[172:175], v[196:199]
    ds_read_b128 v[228:231], v5 offset:23552
    v_cvt_pk_bf16_f32 v68, v204, v205
    v_exp_f32 v208, v208
    s_waitcnt lgkmcnt(3)
    v_mfma_f32_16x16x32_bf16 v[184:187], v[240:243], v[160:163], v[184:187]
    v_exp_f32 v209, v209
    v_mfma_f32_16x16x32_bf16 v[188:191], v[240:243], v[176:179], v[188:191]
    ds_read_b128 v[232:235], v5 offset:24576
    v_cvt_pk_bf16_f32 v69, v206, v207
    v_exp_f32 v210, v210
    s_waitcnt lgkmcnt(3)
    v_mfma_f32_16x16x32_bf16 v[192:195], v[244:247], v[160:163], v[192:195]
    v_exp_f32 v211, v211
    v_mfma_f32_16x16x32_bf16 v[196:199], v[244:247], v[176:179], v[196:199]
    ds_read_b128 v[236:239], v5 offset:25600
    v_cvt_pk_bf16_f32 v66, v208, v209
    v_exp_f32 v212, v212
    s_waitcnt lgkmcnt(3)
    v_mfma_f32_16x16x32_bf16 v[184:187], v[224:227], v[164:167], v[184:187]
    v_exp_f32 v213, v213
    v_cvt_pk_bf16_f32 v67, v210, v211
    v_mfma_f32_16x16x32_bf16 v[188:191], v[224:227], v[180:183], v[188:191]
    ds_read_b128 v[240:243], v5 offset:26624
    v_exp_f32 v214, v214
    s_waitcnt lgkmcnt(3)
    v_mfma_f32_16x16x32_bf16 v[192:195], v[228:231], v[164:167], v[192:195]
    v_exp_f32 v215, v215
    v_cvt_pk_bf16_f32 v70, v212, v213
    v_mfma_f32_16x16x32_bf16 v[196:199], v[228:231], v[180:183], v[196:199]
    ds_read_b128 v[244:247], v5 offset:27648
    v_cvt_pk_bf16_f32 v71, v214, v215
    s_waitcnt lgkmcnt(3)
    v_mfma_f32_16x16x32_bf16 v[200:203], v[232:235], v[152:155], v[216:219]
    v_mfma_f32_16x16x32_bf16 v[204:207], v[232:235], v[168:171], v[220:223]
    ds_read_b128 v[224:227], v5 offset:28672
    v_exp_f32 v184, v184
    v_exp_f32 v185, v185
    v_mfma_f32_16x16x32_bf16 v[248:251], v[12:15], v[64:67], v[248:251]
    s_waitcnt lgkmcnt(3)
    v_mfma_f32_16x16x32_bf16 v[208:211], v[236:239], v[152:155], v[216:219]
    v_exp_f32 v186, v186
    v_exp_f32 v187, v187
    v_mfma_f32_16x16x32_bf16 v[212:215], v[236:239], v[168:171], v[220:223]
    ds_read_b128 v[228:231], v5 offset:29696
    v_cvt_pk_bf16_f32 v72, v184, v185
    v_mfma_f32_16x16x32_bf16 v[252:255], v[12:15], v[68:71], v[252:255]
    s_waitcnt lgkmcnt(3)
    v_mfma_f32_16x16x32_bf16 v[200:203], v[240:243], v[156:159], v[200:203]
    v_exp_f32 v188, v188
    v_exp_f32 v189, v189
    v_mfma_f32_16x16x32_bf16 v[204:207], v[240:243], v[172:175], v[204:207]
    ds_read_b128 v[232:235], v5 offset:30720
    v_cvt_pk_bf16_f32 v73, v186, v187
    s_waitcnt lgkmcnt(3)
    v_mfma_f32_16x16x32_bf16 v[208:211], v[244:247], v[156:159], v[208:211]
    v_exp_f32 v190, v190
    v_exp_f32 v191, v191
    v_mfma_f32_16x16x32_bf16 v[212:215], v[244:247], v[172:175], v[212:215]
    ds_read_b128 v[236:239], v5 offset:31744
    v_cvt_pk_bf16_f32 v76, v188, v189
    v_exp_f32 v192, v192
    s_waitcnt lgkmcnt(3)
    v_mfma_f32_16x16x32_bf16 v[200:203], v[224:227], v[160:163], v[200:203]
    v_exp_f32 v193, v193
    v_mfma_f32_16x16x32_bf16 v[204:207], v[224:227], v[176:179], v[204:207]
    s_waitcnt vmcnt(7)
    s_barrier
    ds_read_b128 v[240:243], v4 offset:0
    v_cvt_pk_bf16_f32 v77, v190, v191
    v_exp_f32 v194, v194
    s_waitcnt lgkmcnt(3)
    v_mfma_f32_16x16x32_bf16 v[208:211], v[228:231], v[160:163], v[208:211]
    v_exp_f32 v195, v195
    v_mfma_f32_16x16x32_bf16 v[212:215], v[228:231], v[176:179], v[212:215]
    s_add_u32 s22, s21, 0x80000
    s_add_u32 m0, s20, 0x20000
    s_nop 0
    buffer_load_dwordx4 v2, s[8:11], s22 offen sc1 lds
    ds_read_b128 v[244:247], v4 offset:1024
    v_cvt_pk_bf16_f32 v74, v192, v193
    v_exp_f32 v196, v196
    s_waitcnt lgkmcnt(3)
    v_mfma_f32_16x16x32_bf16 v[200:203], v[232:235], v[164:167], v[200:203]
    v_exp_f32 v197, v197
    v_cvt_pk_bf16_f32 v75, v194, v195
    v_mfma_f32_16x16x32_bf16 v[204:207], v[232:235], v[180:183], v[204:207]
    ds_read_b128 v[224:227], v4 offset:2048
    v_exp_f32 v198, v198
    s_waitcnt lgkmcnt(3)
    v_mfma_f32_16x16x32_bf16 v[208:211], v[236:239], v[164:167], v[208:211]
    v_exp_f32 v199, v199
    v_cvt_pk_bf16_f32 v78, v196, v197
    v_mfma_f32_16x16x32_bf16 v[212:215], v[236:239], v[180:183], v[212:215]
    ds_read_b128 v[228:231], v4 offset:3072
    v_cvt_pk_bf16_f32 v79, v198, v199
    s_waitcnt lgkmcnt(3)
    v_mfma_f32_16x16x32_bf16 v[184:187], v[240:243], v[152:155], v[216:219]
    v_mfma_f32_16x16x32_bf16 v[188:191], v[240:243], v[168:171], v[220:223]
    ds_read_b128 v[232:235], v4 offset:4096
    v_exp_f32 v200, v200
    v_exp_f32 v201, v201
    v_mfma_f32_16x16x32_bf16 v[248:251], v[12:15], v[72:75], v[248:251]
    s_waitcnt lgkmcnt(3)
    v_mfma_f32_16x16x32_bf16 v[192:195], v[244:247], v[152:155], v[216:219]
    v_exp_f32 v202, v202
    v_exp_f32 v203, v203
    v_mfma_f32_16x16x32_bf16 v[196:199], v[244:247], v[168:171], v[220:223]
    s_add_u32 s22, s21, 0x80400
    s_add_u32 m0, s20, 0x20400
    s_nop 0
    buffer_load_dwordx4 v2, s[8:11], s22 offen sc1 lds
    ds_read_b128 v[236:239], v4 offset:5120
    v_cvt_pk_bf16_f32 v80, v200, v201
    v_mfma_f32_16x16x32_bf16 v[252:255], v[12:15], v[76:79], v[252:255]
    s_waitcnt lgkmcnt(3)
    v_mfma_f32_16x16x32_bf16 v[184:187], v[224:227], v[156:159], v[184:187]
    v_exp_f32 v204, v204
    v_exp_f32 v205, v205
    v_mfma_f32_16x16x32_bf16 v[188:191], v[224:227], v[172:175], v[188:191]
    ds_read_b128 v[240:243], v4 offset:6144
    v_cvt_pk_bf16_f32 v81, v202, v203
    s_waitcnt lgkmcnt(3)
    v_mfma_f32_16x16x32_bf16 v[192:195], v[228:231], v[156:159], v[192:195]
    v_exp_f32 v206, v206
    v_exp_f32 v207, v207
    v_mfma_f32_16x16x32_bf16 v[196:199], v[228:231], v[172:175], v[196:199]
    ds_read_b128 v[244:247], v4 offset:7168
    v_cvt_pk_bf16_f32 v84, v204, v205
    v_exp_f32 v208, v208
    s_waitcnt lgkmcnt(3)
    v_mfma_f32_16x16x32_bf16 v[184:187], v[232:235], v[160:163], v[184:187]
    v_exp_f32 v209, v209
    v_mfma_f32_16x16x32_bf16 v[188:191], v[232:235], v[176:179], v[188:191]
    ds_read_b128 v[224:227], v4 offset:8192
    v_cvt_pk_bf16_f32 v85, v206, v207
    v_exp_f32 v210, v210
    s_waitcnt lgkmcnt(3)
    v_mfma_f32_16x16x32_bf16 v[192:195], v[236:239], v[160:163], v[192:195]
    v_exp_f32 v211, v211
    v_mfma_f32_16x16x32_bf16 v[196:199], v[236:239], v[176:179], v[196:199]
    ds_read_b128 v[228:231], v4 offset:9216
    v_cvt_pk_bf16_f32 v82, v208, v209
    v_exp_f32 v212, v212
    s_waitcnt lgkmcnt(3)
    v_mfma_f32_16x16x32_bf16 v[184:187], v[240:243], v[164:167], v[184:187]
    v_exp_f32 v213, v213
    v_cvt_pk_bf16_f32 v83, v210, v211
    v_mfma_f32_16x16x32_bf16 v[188:191], v[240:243], v[180:183], v[188:191]
    ds_read_b128 v[232:235], v4 offset:10240
    v_exp_f32 v214, v214
    s_waitcnt lgkmcnt(3)
    v_mfma_f32_16x16x32_bf16 v[192:195], v[244:247], v[164:167], v[192:195]
    v_exp_f32 v215, v215
    v_cvt_pk_bf16_f32 v86, v212, v213
    v_mfma_f32_16x16x32_bf16 v[196:199], v[244:247], v[180:183], v[196:199]
    ds_read_b128 v[236:239], v4 offset:11264
    v_cvt_pk_bf16_f32 v87, v214, v215
    s_waitcnt lgkmcnt(3)
    v_mfma_f32_16x16x32_bf16 v[200:203], v[224:227], v[152:155], v[216:219]
    v_mfma_f32_16x16x32_bf16 v[204:207], v[224:227], v[168:171], v[220:223]
    ds_read_b128 v[240:243], v4 offset:12288
    v_exp_f32 v184, v184
    v_exp_f32 v185, v185
    v_mfma_f32_16x16x32_bf16 v[248:251], v[12:15], v[80:83], v[248:251]
    s_waitcnt lgkmcnt(3)
    v_mfma_f32_16x16x32_bf16 v[208:211], v[228:231], v[152:155], v[216:219]
    v_exp_f32 v186, v186
    v_exp_f32 v187, v187
    v_mfma_f32_16x16x32_bf16 v[212:215], v[228:231], v[168:171], v[220:223]
    ds_read_b128 v[244:247], v4 offset:13312
    v_cvt_pk_bf16_f32 v88, v184, v185
    v_mfma_f32_16x16x32_bf16 v[252:255], v[12:15], v[84:87], v[252:255]
    s_waitcnt lgkmcnt(3)
    v_mfma_f32_16x16x32_bf16 v[200:203], v[232:235], v[156:159], v[200:203]
    v_exp_f32 v188, v188
    v_exp_f32 v189, v189
    v_mfma_f32_16x16x32_bf16 v[204:207], v[232:235], v[172:175], v[204:207]
    ds_read_b128 v[224:227], v4 offset:14336
    v_cvt_pk_bf16_f32 v89, v186, v187
    s_waitcnt lgkmcnt(3)
    v_mfma_f32_16x16x32_bf16 v[208:211], v[236:239], v[156:159], v[208:211]
    v_exp_f32 v190, v190
    v_exp_f32 v191, v191
    v_mfma_f32_16x16x32_bf16 v[212:215], v[236:239], v[172:175], v[212:215]
    ds_read_b128 v[228:231], v4 offset:15360
    v_cvt_pk_bf16_f32 v92, v188, v189
    v_exp_f32 v192, v192
    s_waitcnt lgkmcnt(3)
    v_mfma_f32_16x16x32_bf16 v[200:203], v[240:243], v[160:163], v[200:203]
    v_exp_f32 v193, v193
    v_mfma_f32_16x16x32_bf16 v[204:207], v[240:243], v[176:179], v[204:207]
    s_waitcnt vmcnt(7)
    s_barrier
    ds_read_b128 v[232:235], v4 offset:16384
    v_cvt_pk_bf16_f32 v93, v190, v191
    v_exp_f32 v194, v194
    s_waitcnt lgkmcnt(3)
    v_mfma_f32_16x16x32_bf16 v[208:211], v[244:247], v[160:163], v[208:211]
    v_exp_f32 v195, v195
    v_mfma_f32_16x16x32_bf16 v[212:215], v[244:247], v[176:179], v[212:215]
    s_add_u32 s22, s21, 0x84000
    s_add_u32 m0, s20, 0x24000
    s_nop 0
    buffer_load_dwordx4 v2, s[8:11], s22 offen sc1 lds
    ds_read_b128 v[236:239], v4 offset:17408
    v_cvt_pk_bf16_f32 v90, v192, v193
    v_exp_f32 v196, v196
    s_waitcnt lgkmcnt(3)
    v_mfma_f32_16x16x32_bf16 v[200:203], v[224:227], v[164:167], v[200:203]
    v_exp_f32 v197, v197
    v_cvt_pk_bf16_f32 v91, v194, v195
    v_mfma_f32_16x16x32_bf16 v[204:207], v[224:227], v[180:183], v[204:207]
    ds_read_b128 v[240:243], v4 offset:18432
    v_exp_f32 v198, v198
    s_waitcnt lgkmcnt(3)
    v_mfma_f32_16x16x32_bf16 v[208:211], v[228:231], v[164:167], v[208:211]
    v_exp_f32 v199, v199
    v_cvt_pk_bf16_f32 v94, v196, v197
    v_mfma_f32_16x16x32_bf16 v[212:215], v[228:231], v[180:183], v[212:215]
    ds_read_b128 v[244:247], v4 offset:19456
    v_cvt_pk_bf16_f32 v95, v198, v199
    s_waitcnt lgkmcnt(3)
    v_mfma_f32_16x16x32_bf16 v[184:187], v[232:235], v[152:155], v[216:219]
    v_mfma_f32_16x16x32_bf16 v[188:191], v[232:235], v[168:171], v[220:223]
    ds_read_b128 v[224:227], v4 offset:20480
    v_exp_f32 v200, v200
    v_exp_f32 v201, v201
    v_mfma_f32_16x16x32_bf16 v[248:251], v[12:15], v[88:91], v[248:251]
    s_waitcnt lgkmcnt(3)
    v_mfma_f32_16x16x32_bf16 v[192:195], v[236:239], v[152:155], v[216:219]
    v_exp_f32 v202, v202
    v_exp_f32 v203, v203
    v_mfma_f32_16x16x32_bf16 v[196:199], v[236:239], v[168:171], v[220:223]
    s_add_u32 s22, s21, 0x84400
    s_add_u32 m0, s20, 0x24400
    s_nop 0
    buffer_load_dwordx4 v2, s[8:11], s22 offen sc1 lds
    ds_read_b128 v[228:231], v4 offset:21504
    v_cvt_pk_bf16_f32 v96, v200, v201
    v_mfma_f32_16x16x32_bf16 v[252:255], v[12:15], v[92:95], v[252:255]
    s_waitcnt lgkmcnt(3)
    v_mfma_f32_16x16x32_bf16 v[184:187], v[240:243], v[156:159], v[184:187]
    v_exp_f32 v204, v204
    v_exp_f32 v205, v205
    v_mfma_f32_16x16x32_bf16 v[188:191], v[240:243], v[172:175], v[188:191]
    ds_read_b128 v[232:235], v4 offset:22528
    v_cvt_pk_bf16_f32 v97, v202, v203
    s_waitcnt lgkmcnt(3)
    v_mfma_f32_16x16x32_bf16 v[192:195], v[244:247], v[156:159], v[192:195]
    v_exp_f32 v206, v206
    v_exp_f32 v207, v207
    v_mfma_f32_16x16x32_bf16 v[196:199], v[244:247], v[172:175], v[196:199]
    ds_read_b128 v[236:239], v4 offset:23552
    v_cvt_pk_bf16_f32 v100, v204, v205
    v_exp_f32 v208, v208
    s_waitcnt lgkmcnt(3)
    v_mfma_f32_16x16x32_bf16 v[184:187], v[224:227], v[160:163], v[184:187]
    v_exp_f32 v209, v209
    v_mfma_f32_16x16x32_bf16 v[188:191], v[224:227], v[176:179], v[188:191]
    ds_read_b128 v[240:243], v4 offset:24576
    v_cvt_pk_bf16_f32 v101, v206, v207
    v_exp_f32 v210, v210
    s_waitcnt lgkmcnt(3)
    v_mfma_f32_16x16x32_bf16 v[192:195], v[228:231], v[160:163], v[192:195]
    v_exp_f32 v211, v211
    v_mfma_f32_16x16x32_bf16 v[196:199], v[228:231], v[176:179], v[196:199]
    ds_read_b128 v[244:247], v4 offset:25600
    v_cvt_pk_bf16_f32 v98, v208, v209
    v_exp_f32 v212, v212
    s_waitcnt lgkmcnt(3)
    v_mfma_f32_16x16x32_bf16 v[184:187], v[232:235], v[164:167], v[184:187]
    v_exp_f32 v213, v213
    v_cvt_pk_bf16_f32 v99, v210, v211
    v_mfma_f32_16x16x32_bf16 v[188:191], v[232:235], v[180:183], v[188:191]
    ds_read_b128 v[224:227], v4 offset:26624
    v_exp_f32 v214, v214
    s_waitcnt lgkmcnt(3)
    v_mfma_f32_16x16x32_bf16 v[192:195], v[236:239], v[164:167], v[192:195]
    v_exp_f32 v215, v215
    v_cvt_pk_bf16_f32 v102, v212, v213
    v_mfma_f32_16x16x32_bf16 v[196:199], v[236:239], v[180:183], v[196:199]
    ds_read_b128 v[228:231], v4 offset:27648
    v_cvt_pk_bf16_f32 v103, v214, v215
    s_waitcnt lgkmcnt(3)
    v_mfma_f32_16x16x32_bf16 v[200:203], v[240:243], v[152:155], v[216:219]
    v_mfma_f32_16x16x32_bf16 v[204:207], v[240:243], v[168:171], v[220:223]
    ds_read_b128 v[232:235], v4 offset:28672
    v_exp_f32 v184, v184
    v_exp_f32 v185, v185
    v_mfma_f32_16x16x32_bf16 v[248:251], v[12:15], v[96:99], v[248:251]
    s_waitcnt lgkmcnt(3)
    v_mfma_f32_16x16x32_bf16 v[208:211], v[244:247], v[152:155], v[216:219]
    v_exp_f32 v186, v186
    v_exp_f32 v187, v187
    v_mfma_f32_16x16x32_bf16 v[212:215], v[244:247], v[168:171], v[220:223]
    ds_read_b128 v[236:239], v4 offset:29696
    v_cvt_pk_bf16_f32 v104, v184, v185
    v_mfma_f32_16x16x32_bf16 v[252:255], v[12:15], v[100:103], v[252:255]
    s_waitcnt lgkmcnt(3)
    v_mfma_f32_16x16x32_bf16 v[200:203], v[224:227], v[156:159], v[200:203]
    v_exp_f32 v188, v188
    v_exp_f32 v189, v189
    v_mfma_f32_16x16x32_bf16 v[204:207], v[224:227], v[172:175], v[204:207]
    ds_read_b128 v[240:243], v4 offset:30720
    v_cvt_pk_bf16_f32 v105, v186, v187
    s_waitcnt lgkmcnt(3)
    v_mfma_f32_16x16x32_bf16 v[208:211], v[228:231], v[156:159], v[208:211]
    v_exp_f32 v190, v190
    v_exp_f32 v191, v191
    v_mfma_f32_16x16x32_bf16 v[212:215], v[228:231], v[172:175], v[212:215]
    ds_read_b128 v[244:247], v4 offset:31744
    v_cvt_pk_bf16_f32 v108, v188, v189
    v_exp_f32 v192, v192
    s_waitcnt lgkmcnt(3)
    v_mfma_f32_16x16x32_bf16 v[200:203], v[232:235], v[160:163], v[200:203]
    v_exp_f32 v193, v193
    v_mfma_f32_16x16x32_bf16 v[204:207], v[232:235], v[176:179], v[204:207]
    s_waitcnt vmcnt(7)
    s_barrier
    ds_read_b128 v[224:227], v4 offset:32768
    v_cvt_pk_bf16_f32 v109, v190, v191
    v_exp_f32 v194, v194
    s_waitcnt lgkmcnt(3)
    v_mfma_f32_16x16x32_bf16 v[208:211], v[236:239], v[160:163], v[208:211]
    v_exp_f32 v195, v195
    v_mfma_f32_16x16x32_bf16 v[212:215], v[236:239], v[176:179], v[212:215]
    s_add_u32 s22, s21, 0x88000
    s_add_u32 m0, s20, 0x10000
    s_nop 0
    buffer_load_dwordx4 v2, s[8:11], s22 offen sc1 lds
    ds_read_b128 v[228:231], v4 offset:33792
    v_cvt_pk_bf16_f32 v106, v192, v193
    v_exp_f32 v196, v196
    s_waitcnt lgkmcnt(3)
    v_mfma_f32_16x16x32_bf16 v[200:203], v[240:243], v[164:167], v[200:203]
    v_exp_f32 v197, v197
    v_cvt_pk_bf16_f32 v107, v194, v195
    v_mfma_f32_16x16x32_bf16 v[204:207], v[240:243], v[180:183], v[204:207]
    ds_read_b128 v[232:235], v4 offset:34816
    v_exp_f32 v198, v198
    s_waitcnt lgkmcnt(3)
    v_mfma_f32_16x16x32_bf16 v[208:211], v[244:247], v[164:167], v[208:211]
    v_exp_f32 v199, v199
    v_cvt_pk_bf16_f32 v110, v196, v197
    v_mfma_f32_16x16x32_bf16 v[212:215], v[244:247], v[180:183], v[212:215]
    ds_read_b128 v[236:239], v4 offset:35840
    v_cvt_pk_bf16_f32 v111, v198, v199
    s_waitcnt lgkmcnt(3)
    v_mfma_f32_16x16x32_bf16 v[184:187], v[224:227], v[152:155], v[216:219]
    v_mfma_f32_16x16x32_bf16 v[188:191], v[224:227], v[168:171], v[220:223]
    ds_read_b128 v[240:243], v4 offset:36864
    v_exp_f32 v200, v200
    v_exp_f32 v201, v201
    v_mfma_f32_16x16x32_bf16 v[248:251], v[12:15], v[104:107], v[248:251]
    s_waitcnt lgkmcnt(3)
    v_mfma_f32_16x16x32_bf16 v[192:195], v[228:231], v[152:155], v[216:219]
    v_exp_f32 v202, v202
    v_exp_f32 v203, v203
    v_mfma_f32_16x16x32_bf16 v[196:199], v[228:231], v[168:171], v[220:223]
    s_add_u32 s22, s21, 0x88400
    s_add_u32 m0, s20, 0x10400
    s_nop 0
    buffer_load_dwordx4 v2, s[8:11], s22 offen sc1 lds
    ds_read_b128 v[244:247], v4 offset:37888
    v_cvt_pk_bf16_f32 v112, v200, v201
    v_mfma_f32_16x16x32_bf16 v[252:255], v[12:15], v[108:111], v[252:255]
    s_waitcnt lgkmcnt(3)
    v_mfma_f32_16x16x32_bf16 v[184:187], v[232:235], v[156:159], v[184:187]
    v_exp_f32 v204, v204
    v_exp_f32 v205, v205
    v_mfma_f32_16x16x32_bf16 v[188:191], v[232:235], v[172:175], v[188:191]
    ds_read_b128 v[224:227], v4 offset:38912
    v_cvt_pk_bf16_f32 v113, v202, v203
    s_waitcnt lgkmcnt(3)
    v_mfma_f32_16x16x32_bf16 v[192:195], v[236:239], v[156:159], v[192:195]
    v_exp_f32 v206, v206
    v_exp_f32 v207, v207
    v_mfma_f32_16x16x32_bf16 v[196:199], v[236:239], v[172:175], v[196:199]
    ds_read_b128 v[228:231], v4 offset:39936
    v_cvt_pk_bf16_f32 v116, v204, v205
    v_exp_f32 v208, v208
    s_waitcnt lgkmcnt(3)
    v_mfma_f32_16x16x32_bf16 v[184:187], v[240:243], v[160:163], v[184:187]
    v_exp_f32 v209, v209
    v_mfma_f32_16x16x32_bf16 v[188:191], v[240:243], v[176:179], v[188:191]
    ds_read_b128 v[232:235], v4 offset:40960
    v_cvt_pk_bf16_f32 v117, v206, v207
    v_exp_f32 v210, v210
    s_waitcnt lgkmcnt(3)
    v_mfma_f32_16x16x32_bf16 v[192:195], v[244:247], v[160:163], v[192:195]
    v_exp_f32 v211, v211
    v_mfma_f32_16x16x32_bf16 v[196:199], v[244:247], v[176:179], v[196:199]
    ds_read_b128 v[236:239], v4 offset:41984
    v_cvt_pk_bf16_f32 v114, v208, v209
    v_exp_f32 v212, v212
    s_waitcnt lgkmcnt(3)
    v_mfma_f32_16x16x32_bf16 v[184:187], v[224:227], v[164:167], v[184:187]
    v_exp_f32 v213, v213
    v_cvt_pk_bf16_f32 v115, v210, v211
    v_mfma_f32_16x16x32_bf16 v[188:191], v[224:227], v[180:183], v[188:191]
    ds_read_b128 v[240:243], v4 offset:43008
    v_exp_f32 v214, v214
    s_waitcnt lgkmcnt(3)
    v_mfma_f32_16x16x32_bf16 v[192:195], v[228:231], v[164:167], v[192:195]
    v_exp_f32 v215, v215
    v_cvt_pk_bf16_f32 v118, v212, v213
    v_mfma_f32_16x16x32_bf16 v[196:199], v[228:231], v[180:183], v[196:199]
    ds_read_b128 v[244:247], v4 offset:44032
    v_cvt_pk_bf16_f32 v119, v214, v215
    s_waitcnt lgkmcnt(3)
    v_mfma_f32_16x16x32_bf16 v[200:203], v[232:235], v[152:155], v[216:219]
    v_mfma_f32_16x16x32_bf16 v[204:207], v[232:235], v[168:171], v[220:223]
    ds_read_b128 v[224:227], v4 offset:45056
    v_exp_f32 v184, v184
    v_exp_f32 v185, v185
    v_mfma_f32_16x16x32_bf16 v[248:251], v[12:15], v[112:115], v[248:251]
    s_waitcnt lgkmcnt(3)
    v_mfma_f32_16x16x32_bf16 v[208:211], v[236:239], v[152:155], v[216:219]
    v_exp_f32 v186, v186
    v_exp_f32 v187, v187
    v_mfma_f32_16x16x32_bf16 v[212:215], v[236:239], v[168:171], v[220:223]
    ds_read_b128 v[228:231], v4 offset:46080
    v_cvt_pk_bf16_f32 v120, v184, v185
    v_mfma_f32_16x16x32_bf16 v[252:255], v[12:15], v[116:119], v[252:255]
    s_waitcnt lgkmcnt(3)
    v_mfma_f32_16x16x32_bf16 v[200:203], v[240:243], v[156:159], v[200:203]
    v_exp_f32 v188, v188
    v_exp_f32 v189, v189
    v_mfma_f32_16x16x32_bf16 v[204:207], v[240:243], v[172:175], v[204:207]
    ds_read_b128 v[232:235], v4 offset:47104
    v_cvt_pk_bf16_f32 v121, v186, v187
    s_waitcnt lgkmcnt(3)
    v_mfma_f32_16x16x32_bf16 v[208:211], v[244:247], v[156:159], v[208:211]
    v_exp_f32 v190, v190
    v_exp_f32 v191, v191
    v_mfma_f32_16x16x32_bf16 v[212:215], v[244:247], v[172:175], v[212:215]
    ds_read_b128 v[236:239], v4 offset:48128
    v_cvt_pk_bf16_f32 v124, v188, v189
    v_exp_f32 v192, v192
    s_waitcnt lgkmcnt(3)
    v_mfma_f32_16x16x32_bf16 v[200:203], v[224:227], v[160:163], v[200:203]
    v_exp_f32 v193, v193
    v_mfma_f32_16x16x32_bf16 v[204:207], v[224:227], v[176:179], v[204:207]
    s_waitcnt vmcnt(6)
    s_barrier
    ds_read_b128 v[240:243], v4 offset:49152
    v_cvt_pk_bf16_f32 v125, v190, v191
    v_exp_f32 v194, v194
    s_waitcnt lgkmcnt(3)
    v_mfma_f32_16x16x32_bf16 v[208:211], v[228:231], v[160:163], v[208:211]
    v_exp_f32 v195, v195
    v_mfma_f32_16x16x32_bf16 v[212:215], v[228:231], v[176:179], v[212:215]
    s_add_u32 s22, s21, 0x8c000
    s_add_u32 m0, s20, 0x14000
    s_nop 0
    buffer_load_dwordx4 v2, s[8:11], s22 offen sc1 lds
    ds_read_b128 v[244:247], v4 offset:50176
    v_cvt_pk_bf16_f32 v122, v192, v193
    v_exp_f32 v196, v196
    s_waitcnt lgkmcnt(3)
    v_mfma_f32_16x16x32_bf16 v[200:203], v[232:235], v[164:167], v[200:203]
    v_exp_f32 v197, v197
    v_cvt_pk_bf16_f32 v123, v194, v195
    v_mfma_f32_16x16x32_bf16 v[204:207], v[232:235], v[180:183], v[204:207]
    ds_read_b128 v[224:227], v4 offset:51200
    v_exp_f32 v198, v198
    s_waitcnt lgkmcnt(3)
    v_mfma_f32_16x16x32_bf16 v[208:211], v[236:239], v[164:167], v[208:211]
    v_exp_f32 v199, v199
    v_cvt_pk_bf16_f32 v126, v196, v197
    v_mfma_f32_16x16x32_bf16 v[212:215], v[236:239], v[180:183], v[212:215]
    ds_read_b128 v[228:231], v4 offset:52224
    v_cvt_pk_bf16_f32 v127, v198, v199
    s_waitcnt lgkmcnt(3)
    v_mfma_f32_16x16x32_bf16 v[184:187], v[240:243], v[152:155], v[216:219]
    v_mfma_f32_16x16x32_bf16 v[188:191], v[240:243], v[168:171], v[220:223]
    ds_read_b128 v[232:235], v4 offset:53248
    v_exp_f32 v200, v200
    v_exp_f32 v201, v201
    v_mfma_f32_16x16x32_bf16 v[248:251], v[12:15], v[120:123], v[248:251]
    s_waitcnt lgkmcnt(3)
    v_mfma_f32_16x16x32_bf16 v[192:195], v[244:247], v[152:155], v[216:219]
    v_exp_f32 v202, v202
    v_exp_f32 v203, v203
    v_mfma_f32_16x16x32_bf16 v[196:199], v[244:247], v[168:171], v[220:223]
    s_add_u32 s22, s21, 0x8c400
    s_add_u32 m0, s20, 0x14400
    s_nop 0
    buffer_load_dwordx4 v2, s[8:11], s22 offen sc1 lds
    ds_read_b128 v[236:239], v4 offset:54272
    v_cvt_pk_bf16_f32 v128, v200, v201
    v_mfma_f32_16x16x32_bf16 v[252:255], v[12:15], v[124:127], v[252:255]
    s_waitcnt lgkmcnt(3)
    v_mfma_f32_16x16x32_bf16 v[184:187], v[224:227], v[156:159], v[184:187]
    v_exp_f32 v204, v204
    v_exp_f32 v205, v205
    v_mfma_f32_16x16x32_bf16 v[188:191], v[224:227], v[172:175], v[188:191]
    ds_read_b128 v[240:243], v4 offset:55296
    v_cvt_pk_bf16_f32 v129, v202, v203
    s_waitcnt lgkmcnt(3)
    v_mfma_f32_16x16x32_bf16 v[192:195], v[228:231], v[156:159], v[192:195]
    v_exp_f32 v206, v206
    v_exp_f32 v207, v207
    v_mfma_f32_16x16x32_bf16 v[196:199], v[228:231], v[172:175], v[196:199]
    ds_read_b128 v[244:247], v4 offset:56320
    v_cvt_pk_bf16_f32 v132, v204, v205
    v_exp_f32 v208, v208
    s_waitcnt lgkmcnt(3)
    v_mfma_f32_16x16x32_bf16 v[184:187], v[232:235], v[160:163], v[184:187]
    v_exp_f32 v209, v209
    v_mfma_f32_16x16x32_bf16 v[188:191], v[232:235], v[176:179], v[188:191]
    ds_read_b128 v[224:227], v4 offset:57344
    v_cvt_pk_bf16_f32 v133, v206, v207
    v_exp_f32 v210, v210
    s_waitcnt lgkmcnt(3)
    v_mfma_f32_16x16x32_bf16 v[192:195], v[236:239], v[160:163], v[192:195]
    v_exp_f32 v211, v211
    v_mfma_f32_16x16x32_bf16 v[196:199], v[236:239], v[176:179], v[196:199]
    ds_read_b128 v[228:231], v4 offset:58368
    v_cvt_pk_bf16_f32 v130, v208, v209
    v_exp_f32 v212, v212
    s_waitcnt lgkmcnt(3)
    v_mfma_f32_16x16x32_bf16 v[184:187], v[240:243], v[164:167], v[184:187]
    v_exp_f32 v213, v213
    v_cvt_pk_bf16_f32 v131, v210, v211
    v_mfma_f32_16x16x32_bf16 v[188:191], v[240:243], v[180:183], v[188:191]
    ds_read_b128 v[232:235], v4 offset:59392
    v_exp_f32 v214, v214
    s_waitcnt lgkmcnt(3)
    v_mfma_f32_16x16x32_bf16 v[192:195], v[244:247], v[164:167], v[192:195]
    v_exp_f32 v215, v215
    v_cvt_pk_bf16_f32 v134, v212, v213
    v_mfma_f32_16x16x32_bf16 v[196:199], v[244:247], v[180:183], v[196:199]
    ds_read_b128 v[236:239], v4 offset:60416
    v_cvt_pk_bf16_f32 v135, v214, v215
    s_waitcnt lgkmcnt(3)
    v_mfma_f32_16x16x32_bf16 v[200:203], v[224:227], v[152:155], v[216:219]
    v_mfma_f32_16x16x32_bf16 v[204:207], v[224:227], v[168:171], v[220:223]
    ds_read_b128 v[240:243], v4 offset:61440
    v_exp_f32 v184, v184
    v_exp_f32 v185, v185
    v_mfma_f32_16x16x32_bf16 v[248:251], v[12:15], v[128:131], v[248:251]
    s_waitcnt lgkmcnt(3)
    v_mfma_f32_16x16x32_bf16 v[208:211], v[228:231], v[152:155], v[216:219]
    v_exp_f32 v186, v186
    v_exp_f32 v187, v187
    v_mfma_f32_16x16x32_bf16 v[212:215], v[228:231], v[168:171], v[220:223]
    ds_read_b128 v[244:247], v4 offset:62464
    v_cvt_pk_bf16_f32 v136, v184, v185
    v_mfma_f32_16x16x32_bf16 v[252:255], v[12:15], v[132:135], v[252:255]
    s_waitcnt lgkmcnt(3)
    v_mfma_f32_16x16x32_bf16 v[200:203], v[232:235], v[156:159], v[200:203]
    v_exp_f32 v188, v188
    v_exp_f32 v189, v189
    v_mfma_f32_16x16x32_bf16 v[204:207], v[232:235], v[172:175], v[204:207]
    ds_read_b128 v[224:227], v4 offset:63488
    v_cvt_pk_bf16_f32 v137, v186, v187
    s_waitcnt lgkmcnt(3)
    v_mfma_f32_16x16x32_bf16 v[208:211], v[236:239], v[156:159], v[208:211]
    v_exp_f32 v190, v190
    v_exp_f32 v191, v191
    v_mfma_f32_16x16x32_bf16 v[212:215], v[236:239], v[172:175], v[212:215]
    ds_read_b128 v[228:231], v4 offset:64512
    v_cvt_pk_bf16_f32 v140, v188, v189
    v_exp_f32 v192, v192
    s_waitcnt lgkmcnt(3)
    v_mfma_f32_16x16x32_bf16 v[200:203], v[240:243], v[160:163], v[200:203]
    v_exp_f32 v193, v193
    v_mfma_f32_16x16x32_bf16 v[204:207], v[240:243], v[176:179], v[204:207]
    v_cvt_pk_bf16_f32 v141, v190, v191
    v_exp_f32 v194, v194
    s_waitcnt lgkmcnt(2)
    v_mfma_f32_16x16x32_bf16 v[208:211], v[244:247], v[160:163], v[208:211]
    v_exp_f32 v195, v195
    v_mfma_f32_16x16x32_bf16 v[212:215], v[244:247], v[176:179], v[212:215]
    v_cvt_pk_bf16_f32 v138, v192, v193
    v_exp_f32 v196, v196
    s_waitcnt lgkmcnt(1)
    v_mfma_f32_16x16x32_bf16 v[200:203], v[224:227], v[164:167], v[200:203]
    v_exp_f32 v197, v197
    v_cvt_pk_bf16_f32 v139, v194, v195
    v_mfma_f32_16x16x32_bf16 v[204:207], v[224:227], v[180:183], v[204:207]
    v_exp_f32 v198, v198
    s_waitcnt lgkmcnt(0)
    v_mfma_f32_16x16x32_bf16 v[208:211], v[228:231], v[164:167], v[208:211]
    v_exp_f32 v199, v199
    v_cvt_pk_bf16_f32 v142, v196, v197
    v_mfma_f32_16x16x32_bf16 v[212:215], v[228:231], v[180:183], v[212:215]
    v_cvt_pk_bf16_f32 v143, v198, v199
    s_waitcnt vmcnt(6)
    s_barrier
    ds_read_b128 v[232:235], v5 offset:0
    ds_read_b128 v[236:239], v5 offset:1024
    ds_read_b128 v[240:243], v5 offset:2048
    ds_read_b128 v[244:247], v5 offset:3072
    v_mfma_f32_16x16x32_bf16 v[248:251], v[12:15], v[136:139], v[248:251]
    v_mfma_f32_16x16x32_bf16 v[252:255], v[12:15], v[140:143], v[252:255]
    v_exp_f32 v200, v200
    v_exp_f32 v201, v201
    v_exp_f32 v202, v202
    v_exp_f32 v203, v203
    v_cvt_pk_bf16_f32 v144, v200, v201
    v_exp_f32 v204, v204
    v_exp_f32 v205, v205
    v_cvt_pk_bf16_f32 v145, v202, v203
    v_exp_f32 v206, v206
    v_exp_f32 v207, v207
    v_cvt_pk_bf16_f32 v148, v204, v205
    v_exp_f32 v208, v208
    v_exp_f32 v209, v209
    v_cvt_pk_bf16_f32 v149, v206, v207
    v_exp_f32 v210, v210
    v_exp_f32 v211, v211
    v_cvt_pk_bf16_f32 v146, v208, v209
    v_exp_f32 v212, v212
    v_exp_f32 v213, v213
    v_cvt_pk_bf16_f32 v147, v210, v211
    v_exp_f32 v214, v214
    v_exp_f32 v215, v215
    v_cvt_pk_bf16_f32 v150, v212, v213
    v_cvt_pk_bf16_f32 v151, v214, v215
    v_mfma_f32_16x16x32_bf16 v[248:251], v[12:15], v[144:147], v[248:251]
    s_nop 0
    v_mfma_f32_16x16x32_bf16 v[252:255], v[12:15], v[148:151], v[252:255]
    s_nop 5
    v_mov_b32 v9, v248
    s_nop 0
    v_mov_b32 v10, v252
    v_max_f32 v17, v9, v10
    v_readfirstlane_b32 s17, v8
    s_cmp_eq_u32 s17, s28
    s_cselect_b32 s16, 0, 0x71800000
    v_cmp_ngt_f32 vcc, s16, v17
    v_cmp_u_f32 s[76:77], v9, v10
    s_or_b64 vcc, vcc, s[76:77]
    s_cbranch_vccnz adaLN_cond__sliding_block_cached__moe_arch_mod__prompt_kernel_fixA
adaLN_cond__sliding_block_cached__moe_arch_mod__prompt_kernel_fixAb:
    v_rcp_f32 v9, v9
    v_rcp_f32 v10, v10
    s_lshl_b32 s25, s13, 3
    s_add_u32 s25, s25, s3
    s_lshl_b32 s25, s25, 18
    s_lshl_b32 s26, s12, 12
    s_add_u32 s25, s25, s26
    s_add_u32 s25, s25, 0x1000000
    s_add_u32 s26, s25, 131072
    s_lshl_b32 s63, s13, 3
    s_add_u32 s63, s63, s3
    s_lshl_b32 s63, s63, 5
    s_add_u32 s63, s63, s12
    s_lshl_b32 s63, s63, 2
    s_waitcnt lgkmcnt(3)
    v_mfma_f32_16x16x32_bf16 v[184:187], v[232:235], v[24:27], 0
    v_mfma_f32_16x16x32_bf16 v[188:191], v[232:235], v[28:31], 0
    ds_read_b128 v[224:227], v5 offset:4096
    s_waitcnt lgkmcnt(3)
    v_mfma_f32_16x16x32_bf16 v[192:195], v[236:239], v[24:27], 0
    s_add_u32 s22, s21, 0x90000
    s_add_u32 m0, s20, 0x18000
    s_nop 0
    buffer_load_dwordx4 v2, s[8:11], s22 offen sc1 lds
    v_mfma_f32_16x16x32_bf16 v[196:199], v[236:239], v[28:31], 0
    ds_read_b128 v[228:231], v5 offset:5120
    s_waitcnt lgkmcnt(3)
    v_mfma_f32_16x16x32_bf16 v[184:187], v[240:243], v[32:35], v[184:187]
    v_mfma_f32_16x16x32_bf16 v[188:191], v[240:243], v[36:39], v[188:191]
    ds_read_b128 v[232:235], v5 offset:6144
    s_waitcnt lgkmcnt(3)
    v_mfma_f32_16x16x32_bf16 v[192:195], v[244:247], v[32:35], v[192:195]
    v_mfma_f32_16x16x32_bf16 v[196:199], v[244:247], v[36:39], v[196:199]
    ds_read_b128 v[236:239], v5 offset:7168
    s_waitcnt lgkmcnt(3)
    v_mfma_f32_16x16x32_bf16 v[184:187], v[224:227], v[40:43], v[184:187]
    v_mfma_f32_16x16x32_bf16 v[188:191], v[224:227], v[44:47], v[188:191]
    ds_read_b128 v[240:243], v5 offset:8192
    s_waitcnt lgkmcnt(3)
    v_mfma_f32_16x16x32_bf16 v[192:195], v[228:231], v[40:43], v[192:195]
    s_add_u32 s22, s21, 0x90400
    s_add_u32 m0, s20, 0x18400
    s_nop 0
    buffer_load_dwordx4 v2, s[8:11], s22 offen sc1 lds
    v_and_b32 v250, 7, v1
    v_lshlrev_b32 v250, 7, v250
    s_lshr_b32 s14, s2, 3
    s_lshl_b32 s14, s14, 2
    s_add_u32 s14, s14, 0x560000
    buffer_load_dword v248, v250, s[8:11], s14 offen sc1
    v_mfma_f32_16x16x32_bf16 v[196:199], v[228:231], v[44:47], v[196:199]
    ds_read_b128 v[244:247], v5 offset:9216
    s_waitcnt lgkmcnt(3)
    v_mfma_f32_16x16x32_bf16 v[184:187], v[232:235], v[48:51], v[184:187]
    v_mfma_f32_16x16x32_bf16 v[188:191], v[232:235], v[52:55], v[188:191]
    ds_read_b128 v[224:227], v5 offset:10240
    s_waitcnt lgkmcnt(3)
    v_mfma_f32_16x16x32_bf16 v[192:195], v[236:239], v[48:51], v[192:195]
    v_mfma_f32_16x16x32_bf16 v[196:199], v[236:239], v[52:55], v[196:199]
    ds_read_b128 v[228:231], v5 offset:11264
    s_waitcnt lgkmcnt(3)
    v_mfma_f32_16x16x32_bf16 v[184:187], v[240:243], v[56:59], v[184:187]
    v_mfma_f32_16x16x32_bf16 v[188:191], v[240:243], v[60:63], v[188:191]
    ds_read_b128 v[232:235], v5 offset:12288
    s_waitcnt lgkmcnt(3)
    v_mfma_f32_16x16x32_bf16 v[192:195], v[244:247], v[56:59], v[192:195]
    v_mfma_f32_16x16x32_bf16 v[196:199], v[244:247], v[60:63], v[196:199]
    ds_read_b128 v[236:239], v5 offset:13312
    s_waitcnt lgkmcnt(3)
    v_mfma_f32_16x16x32_bf16 v[184:187], v[224:227], v[64:67], v[184:187]
    v_mfma_f32_16x16x32_bf16 v[188:191], v[224:227], v[68:71], v[188:191]
    ds_read_b128 v[240:243], v5 offset:14336
    s_waitcnt lgkmcnt(3)
    v_mfma_f32_16x16x32_bf16 v[192:195], v[228:231], v[64:67], v[192:195]
    v_mfma_f32_16x16x32_bf16 v[196:199], v[228:231], v[68:71], v[196:199]
    ds_read_b128 v[244:247], v5 offset:15360
    s_waitcnt lgkmcnt(3)
    v_mfma_f32_16x16x32_bf16 v[184:187], v[232:235], v[72:75], v[184:187]
    v_mfma_f32_16x16x32_bf16 v[188:191], v[232:235], v[76:79], v[188:191]
    s_waitcnt vmcnt(7)
    s_barrier
    ds_read_b128 v[224:227], v5 offset:16384
    s_waitcnt lgkmcnt(3)
    v_mfma_f32_16x16x32_bf16 v[192:195], v[236:239], v[72:75], v[192:195]
    v_mfma_f32_16x16x32_bf16 v[196:199], v[236:239], v[76:79], v[196:199]
    s_add_u32 s22, s21, 0x94000
    s_add_u32 m0, s20, 0x1c000
    s_nop 0
    buffer_load_dwordx4 v2, s[8:11], s22 offen sc1 lds
    ds_read_b128 v[228:231], v5 offset:17408
    s_waitcnt lgkmcnt(3)
    v_mfma_f32_16x16x32_bf16 v[184:187], v[240:243], v[80:83], v[184:187]
    v_mfma_f32_16x16x32_bf16 v[188:191], v[240:243], v[84:87], v[188:191]
    ds_read_b128 v[232:235], v5 offset:18432
    s_waitcnt lgkmcnt(3)
    v_mfma_f32_16x16x32_bf16 v[192:195], v[244:247], v[80:83], v[192:195]
    v_mfma_f32_16x16x32_bf16 v[196:199], v[244:247], v[84:87], v[196:199]
    ds_read_b128 v[236:239], v5 offset:19456
    s_waitcnt lgkmcnt(3)
    v_mfma_f32_16x16x32_bf16 v[184:187], v[224:227], v[88:91], v[184:187]
    v_mfma_f32_16x16x32_bf16 v[188:191], v[224:227], v[92:95], v[188:191]
    ds_read_b128 v[240:243], v5 offset:20480
    s_waitcnt lgkmcnt(3)
    v_mfma_f32_16x16x32_bf16 v[192:195], v[228:231], v[88:91], v[192:195]
    v_mfma_f32_16x16x32_bf16 v[196:199], v[228:231], v[92:95], v[196:199]
    s_add_u32 s22, s21, 0x94400
    s_add_u32 m0, s20, 0x1c400
    s_nop 0
    buffer_load_dwordx4 v2, s[8:11], s22 offen sc1 lds
    ds_read_b128 v[244:247], v5 offset:21504
    s_waitcnt lgkmcnt(3)
    v_mfma_f32_16x16x32_bf16 v[184:187], v[232:235], v[96:99], v[184:187]
    v_mfma_f32_16x16x32_bf16 v[188:191], v[232:235], v[100:103], v[188:191]
    ds_read_b128 v[224:227], v5 offset:22528
    s_waitcnt lgkmcnt(3)
    v_mfma_f32_16x16x32_bf16 v[192:195], v[236:239], v[96:99], v[192:195]
    v_mfma_f32_16x16x32_bf16 v[196:199], v[236:239], v[100:103], v[196:199]
    ds_read_b128 v[228:231], v5 offset:23552
    s_waitcnt lgkmcnt(3)
    v_mfma_f32_16x16x32_bf16 v[184:187], v[240:243], v[104:107], v[184:187]
    v_mfma_f32_16x16x32_bf16 v[188:191], v[240:243], v[108:111], v[188:191]
    ds_read_b128 v[232:235], v5 offset:24576
    s_waitcnt lgkmcnt(3)
    v_mfma_f32_16x16x32_bf16 v[192:195], v[244:247], v[104:107], v[192:195]
    v_mfma_f32_16x16x32_bf16 v[196:199], v[244:247], v[108:111], v[196:199]
    ds_read_b128 v[236:239], v5 offset:25600
    s_waitcnt lgkmcnt(3)
    v_mfma_f32_16x16x32_bf16 v[184:187], v[224:227], v[112:115], v[184:187]
    s_waitcnt vmcnt(2)
    v_cmp_ne_u32 vcc, s28, v248
    s_cbranch_vccnz adaLN_cond__sliding_block_cached__moe_arch_mod__prompt_kernel_mp5r
adaLN_cond__sliding_block_cached__moe_arch_mod__prompt_kernel_mp5b:
    v_mfma_f32_16x16x32_bf16 v[188:191], v[224:227], v[116:119], v[188:191]
    ds_read_b128 v[240:243], v5 offset:26624
    v_lshrrev_b32 v250, 4, v1
    v_lshlrev_b32 v250, 14, v250
    v_and_b32 v253, 15, v1
    v_lshl_add_u32 v250, v253, 2, v250
    s_lshl_b32 s14, s2, 6
    s_add_u32 s14, s14, 0x580000
    buffer_load_dword v249, v250, s[8:11], s14 offen sc1
    s_add_u32 s14, s14, 0x10000
    buffer_load_dword v254, v250, s[8:11], s14 offen sc1
    s_waitcnt lgkmcnt(3)
    v_mfma_f32_16x16x32_bf16 v[192:195], v[228:231], v[112:115], v[192:195]
    v_mfma_f32_16x16x32_bf16 v[196:199], v[228:231], v[116:119], v[196:199]
    ds_read_b128 v[244:247], v5 offset:27648
    s_waitcnt lgkmcnt(3)
    v_mfma_f32_16x16x32_bf16 v[184:187], v[232:235], v[120:123], v[184:187]
    v_mfma_f32_16x16x32_bf16 v[188:191], v[232:235], v[124:127], v[188:191]
    ds_read_b128 v[224:227], v5 offset:28672
    s_waitcnt lgkmcnt(3)
    v_mfma_f32_16x16x32_bf16 v[192:195], v[236:239], v[120:123], v[192:195]
    v_mfma_f32_16x16x32_bf16 v[196:199], v[236:239], v[124:127], v[196:199]
    ds_read_b128 v[228:231], v5 offset:29696
    s_waitcnt lgkmcnt(3)
    v_mfma_f32_16x16x32_bf16 v[184:187], v[240:243], v[128:131], v[184:187]
    v_mfma_f32_16x16x32_bf16 v[188:191], v[240:243], v[132:135], v[188:191]
    ds_read_b128 v[232:235], v5 offset:30720
    s_waitcnt lgkmcnt(3)
    v_mfma_f32_16x16x32_bf16 v[192:195], v[244:247], v[128:131], v[192:195]
    v_mfma_f32_16x16x32_bf16 v[196:199], v[244:247], v[132:135], v[196:199]
    ds_read_b128 v[236:239], v5 offset:31744
    s_waitcnt lgkmcnt(3)
    v_mfma_f32_16x16x32_bf16 v[184:187], v[224:227], v[136:139], v[184:187]
    v_mfma_f32_16x16x32_bf16 v[188:191], v[224:227], v[140:143], v[188:191]
    s_barrier
    ds_read_b128 v[240:243], v4 offset:0
    s_waitcnt lgkmcnt(3)
    v_mfma_f32_16x16x32_bf16 v[192:195], v[228:231], v[136:139], v[192:195]
    v_mfma_f32_16x16x32_bf16 v[196:199], v[228:231], v[140:143], v[196:199]
    s_add_u32 s22, s21, 0x98000
    s_add_u32 m0, s20, 0x20000
    s_nop 0
    buffer_load_dwordx4 v2, s[8:11], s22 offen sc1 lds
    ds_read_b128 v[244:247], v4 offset:1024
    s_waitcnt lgkmcnt(3)
    v_mfma_f32_16x16x32_bf16 v[184:187], v[232:235], v[144:147], v[184:187]
    v_mfma_f32_16x16x32_bf16 v[188:191], v[232:235], v[148:151], v[188:191]
    ds_read_b128 v[224:227], v4 offset:2048
    s_waitcnt lgkmcnt(3)
    v_mfma_f32_16x16x32_bf16 v[192:195], v[236:239], v[144:147], v[192:195]
    v_mfma_f32_16x16x32_bf16 v[196:199], v[236:239], v[148:151], v[196:199]
    ds_read_b128 v[228:231], v4 offset:3072
    s_waitcnt lgkmcnt(3)
    v_mfma_f32_16x16x32_bf16 v[200:203], v[240:243], v[24:27], 0
    v_mfma_f32_16x16x32_bf16 v[204:207], v[240:243], v[28:31], 0
    ds_read_b128 v[232:235], v4 offset:4096
    s_waitcnt lgkmcnt(3)
    v_mfma_f32_16x16x32_bf16 v[208:211], v[244:247], v[24:27], 0
    v_mfma_f32_16x16x32_bf16 v[212:215], v[244:247], v[28:31], 0
    s_add_u32 s22, s21, 0x98400
    s_add_u32 m0, s20, 0x20400
    s_nop 0
    buffer_load_dwordx4 v2, s[8:11], s22 offen sc1 lds
    ds_read_b128 v[236:239], v4 offset:5120
    v_mul_f32 v184, v184, v9
    s_waitcnt lgkmcnt(3)
    v_mfma_f32_16x16x32_bf16 v[200:203], v[224:227], v[32:35], v[200:203]
    v_mul_f32 v185, v185, v9
    s_waitcnt vmcnt(2)
    v_add_f32 v249, v249, v254
    v_mov_b32 v250, v249
    s_nop 1
    v_permlane16_swap_b32 v249, v250
    v_add_f32 v249, v249, v250
    v_mov_b32 v250, v249
    s_nop 1
    v_permlane32_swap_b32 v249, v250
    v_add_f32 v249, v249, v250
    v_cvt_pk_bf16_f32 v249, v249, v249
    v_lshlrev_b32 v249, 16, v249
    s_lshr_b32 s14, s2, 6
    s_cmp_eq_u32 s14, 2
    s_cselect_b32 s14, 1.0, 0
    v_add_f32 v249, s14, v249
    v_cvt_pk_bf16_f32 v249, v249, v249
    v_lshlrev_b32 v253, 1, v253
    s_lshl_b32 s14, s2, 5
    s_add_u32 s14, s14, 0x540000
    s_cmp_eq_u32 s3, 0
    s_cselect_b32 s14, s14, 0x7ffffff0
    s_mov_b64 exec, 0xffff
    buffer_store_short v249, v253, s[8:11], s14 offen sc1
    s_mov_b64 exec, -1
    v_mfma_f32_16x16x32_bf16 v[204:207], v[224:227], v[36:39], v[204:207]
    ds_read_b128 v[240:243], v4 offset:6144
    v_mul_f32 v186, v186, v9
    s_waitcnt lgkmcnt(3)
    v_mfma_f32_16x16x32_bf16 v[208:211], v[228:231], v[32:35], v[208:211]
    v_mul_f32 v187, v187, v9
    v_mfma_f32_16x16x32_bf16 v[212:215], v[228:231], v[36:39], v[212:215]
    ds_read_b128 v[244:247], v4 offset:7168
    v_mul_f32 v192, v192, v9
    s_waitcnt lgkmcnt(3)
    v_mfma_f32_16x16x32_bf16 v[200:203], v[232:235], v[40:43], v[200:203]
    v_mul_f32 v193, v193, v9
    v_mfma_f32_16x16x32_bf16 v[204:207], v[232:235], v[44:47], v[204:207]
    ds_read_b128 v[224:227], v4 offset:8192
    v_mul_f32 v194, v194, v9
    s_waitcnt lgkmcnt(3)
    v_mfma_f32_16x16x32_bf16 v[208:211], v[236:239], v[40:43], v[208:211]
    v_mul_f32 v195, v195, v9
    v_mfma_f32_16x16x32_bf16 v[212:215], v[236:239], v[44:47], v[212:215]
    ds_read_b128 v[228:231], v4 offset:9216
    v_cvt_pk_bf16_f32 v216, v184, v185
    s_waitcnt lgkmcnt(3)
    v_mfma_f32_16x16x32_bf16 v[200:203], v[240:243], v[48:51], v[200:203]
    v_cvt_pk_bf16_f32 v217, v186, v187
    v_mfma_f32_16x16x32_bf16 v[204:207], v[240:243], v[52:55], v[204:207]
    ds_read_b128 v[232:235], v4 offset:10240
    v_cvt_pk_bf16_f32 v218, v192, v193
    s_waitcnt lgkmcnt(3)
    v_mfma_f32_16x16x32_bf16 v[208:211], v[244:247], v[48:51], v[208:211]
    v_cvt_pk_bf16_f32 v219, v194, v195
    v_mfma_f32_16x16x32_bf16 v[212:215], v[244:247], v[52:55], v[212:215]
    ds_read_b128 v[236:239], v4 offset:11264
    buffer_store_dwordx4 v[216:219], v2, s[8:11], s25 offen offset:0 sc1
    s_waitcnt lgkmcnt(3)
    v_mfma_f32_16x16x32_bf16 v[200:203], v[224:227], v[56:59], v[200:203]
    v_mul_f32 v188, v188, v10
    v_mfma_f32_16x16x32_bf16 v[204:207], v[224:227], v[60:63], v[204:207]
    ds_read_b128 v[240:243], v4 offset:12288
    v_mul_f32 v189, v189, v10
    s_waitcnt lgkmcnt(3)
    v_mfma_f32_16x16x32_bf16 v[208:211], v[228:231], v[56:59], v[208:211]
    v_mul_f32 v190, v190, v10
    v_mfma_f32_16x16x32_bf16 v[212:215], v[228:231], v[60:63], v[212:215]
    ds_read_b128 v[244:247], v4 offset:13312
    v_mul_f32 v191, v191, v10
    s_waitcnt lgkmcnt(3)
    v_mfma_f32_16x16x32_bf16 v[200:203], v[232:235], v[64:67], v[200:203]
    v_mul_f32 v196, v196, v10
    v_mfma_f32_16x16x32_bf16 v[204:207], v[232:235], v[68:71], v[204:207]
    ds_read_b128 v[224:227], v4 offset:14336
    v_mul_f32 v197, v197, v10
    s_waitcnt lgkmcnt(3)
    v_mfma_f32_16x16x32_bf16 v[208:211], v[236:239], v[64:67], v[208:211]
    v_mul_f32 v198, v198, v10
    v_mfma_f32_16x16x32_bf16 v[212:215], v[236:239], v[68:71], v[212:215]
    ds_read_b128 v[228:231], v4 offset:15360
    v_mul_f32 v199, v199, v10
    s_waitcnt lgkmcnt(3)
    v_mfma_f32_16x16x32_bf16 v[200:203], v[240:243], v[72:75], v[200:203]
    v_cvt_pk_bf16_f32 v220, v188, v189
    v_mfma_f32_16x16x32_bf16 v[204:207], v[240:243], v[76:79], v[204:207]
    s_barrier
    ds_read_b128 v[232:235], v4 offset:16384
    v_cvt_pk_bf16_f32 v221, v190, v191
    s_waitcnt lgkmcnt(3)
    v_mfma_f32_16x16x32_bf16 v[208:211], v[244:247], v[72:75], v[208:211]
    v_cvt_pk_bf16_f32 v222, v196, v197
    v_mfma_f32_16x16x32_bf16 v[212:215], v[244:247], v[76:79], v[212:215]
    s_add_u32 s22, s21, 0x9c000
    s_add_u32 m0, s20, 0x24000
    s_nop 0
    buffer_load_dwordx4 v2, s[8:11], s22 offen sc1 lds
    ds_read_b128 v[236:239], v4 offset:17408
    v_cvt_pk_bf16_f32 v223, v198, v199
    s_waitcnt lgkmcnt(3)
    v_mfma_f32_16x16x32_bf16 v[200:203], v[224:227], v[80:83], v[200:203]
    buffer_store_dwordx4 v[220:223], v2, s[8:11], s26 offen offset:0 sc1
    v_mfma_f32_16x16x32_bf16 v[204:207], v[224:227], v[84:87], v[204:207]
    ds_read_b128 v[240:243], v4 offset:18432
    s_waitcnt lgkmcnt(3)
    v_mfma_f32_16x16x32_bf16 v[208:211], v[228:231], v[80:83], v[208:211]
    v_mfma_f32_16x16x32_bf16 v[212:215], v[228:231], v[84:87], v[212:215]
    ds_read_b128 v[244:247], v4 offset:19456
    s_waitcnt lgkmcnt(3)
    v_mfma_f32_16x16x32_bf16 v[200:203], v[232:235], v[88:91], v[200:203]
    v_mfma_f32_16x16x32_bf16 v[204:207], v[232:235], v[92:95], v[204:207]
    ds_read_b128 v[224:227], v4 offset:20480
    s_waitcnt lgkmcnt(3)
    v_mfma_f32_16x16x32_bf16 v[208:211], v[236:239], v[88:91], v[208:211]
    v_mfma_f32_16x16x32_bf16 v[212:215], v[236:239], v[92:95], v[212:215]
    s_add_u32 s22, s21, 0x9c400
    s_add_u32 m0, s20, 0x24400
    s_nop 0
    buffer_load_dwordx4 v2, s[8:11], s22 offen sc1 lds
    ds_read_b128 v[228:231], v4 offset:21504
    s_waitcnt lgkmcnt(3)
    v_mfma_f32_16x16x32_bf16 v[200:203], v[240:243], v[96:99], v[200:203]
    v_mfma_f32_16x16x32_bf16 v[204:207], v[240:243], v[100:103], v[204:207]
    ds_read_b128 v[232:235], v4 offset:22528
    s_waitcnt lgkmcnt(3)
    v_mfma_f32_16x16x32_bf16 v[208:211], v[244:247], v[96:99], v[208:211]
    v_mfma_f32_16x16x32_bf16 v[212:215], v[244:247], v[100:103], v[212:215]
    ds_read_b128 v[236:239], v4 offset:23552
    s_waitcnt lgkmcnt(3)
    v_mfma_f32_16x16x32_bf16 v[200:203], v[224:227], v[104:107], v[200:203]
    v_mfma_f32_16x16x32_bf16 v[204:207], v[224:227], v[108:111], v[204:207]
    ds_read_b128 v[240:243], v4 offset:24576
    s_waitcnt lgkmcnt(3)
    v_mfma_f32_16x16x32_bf16 v[208:211], v[228:231], v[104:107], v[208:211]
    v_mfma_f32_16x16x32_bf16 v[212:215], v[228:231], v[108:111], v[212:215]
    ds_read_b128 v[244:247], v4 offset:25600
    s_waitcnt lgkmcnt(3)
    v_mfma_f32_16x16x32_bf16 v[200:203], v[232:235], v[112:115], v[200:203]
    s_waitcnt vmcnt(4)
    v_mov_b32 v248, s28
    v_mov_b32 v249, 0
    s_lshl_b32 s14, s2, 2
    s_add_u32 s14, s14, 0x544000
    s_cmp_eq_u32 s3, 0
    s_cselect_b32 s14, s14, 0x7ffffff0
    s_mov_b64 exec, 1
    buffer_store_dword v248, v249, s[8:11], s14 offen sc1
    s_mov_b64 exec, -1
    v_mfma_f32_16x16x32_bf16 v[204:207], v[232:235], v[116:119], v[204:207]
    ds_read_b128 v[224:227], v4 offset:26624
    s_waitcnt lgkmcnt(3)
    v_mfma_f32_16x16x32_bf16 v[208:211], v[236:239], v[112:115], v[208:211]
    v_mfma_f32_16x16x32_bf16 v[212:215], v[236:239], v[116:119], v[212:215]
    ds_read_b128 v[228:231], v4 offset:27648
    s_waitcnt lgkmcnt(3)
    v_mfma_f32_16x16x32_bf16 v[200:203], v[240:243], v[120:123], v[200:203]
    v_mfma_f32_16x16x32_bf16 v[204:207], v[240:243], v[124:127], v[204:207]
    ds_read_b128 v[232:235], v4 offset:28672
    s_waitcnt lgkmcnt(3)
    v_mfma_f32_16x16x32_bf16 v[208:211], v[244:247], v[120:123], v[208:211]
    v_mfma_f32_16x16x32_bf16 v[212:215], v[244:247], v[124:127], v[212:215]
    ds_read_b128 v[236:239], v4 offset:29696
    s_waitcnt lgkmcnt(3)
    v_mfma_f32_16x16x32_bf16 v[200:203], v[224:227], v[128:131], v[200:203]
    v_mfma_f32_16x16x32_bf16 v[204:207], v[224:227], v[132:135], v[204:207]
    ds_read_b128 v[240:243], v4 offset:30720
    s_waitcnt lgkmcnt(3)
    v_mfma_f32_16x16x32_bf16 v[208:211], v[228:231], v[128:131], v[208:211]
    v_mfma_f32_16x16x32_bf16 v[212:215], v[228:231], v[132:135], v[212:215]
    ds_read_b128 v[244:247], v4 offset:31744
    s_waitcnt lgkmcnt(3)
    v_mfma_f32_16x16x32_bf16 v[200:203], v[232:235], v[136:139], v[200:203]
    s_waitcnt vmcnt(2)
    s_add_u32 s16, s63, 0x570000
    v_mov_b32 v7, s28
    v_mov_b32 v8, 0
    s_mov_b64 exec, 1
    buffer_store_dword v7, v8, s[8:11], s16 offen sc1
    s_mov_b64 exec, -1
    v_mfma_f32_16x16x32_bf16 v[204:207], v[232:235], v[140:143], v[204:207]
    s_barrier
    ds_read_b128 v[224:227], v4 offset:32768
    s_waitcnt lgkmcnt(3)
    v_mfma_f32_16x16x32_bf16 v[208:211], v[236:239], v[136:139], v[208:211]
    v_mfma_f32_16x16x32_bf16 v[212:215], v[236:239], v[140:143], v[212:215]
    s_add_u32 s22, s24, 0x0
    s_add_u32 m0, s20, 0x10000
    s_nop 0
    buffer_load_dwordx4 v3, s[4:7], s22 offen lds
    ds_read_b128 v[228:231], v4 offset:33792
    s_waitcnt lgkmcnt(3)
    v_mfma_f32_16x16x32_bf16 v[200:203], v[240:243], v[144:147], v[200:203]
    v_mfma_f32_16x16x32_bf16 v[204:207], v[240:243], v[148:151], v[204:207]
    ds_read_b128 v[232:235], v4 offset:34816
    s_waitcnt lgkmcnt(3)
    v_mfma_f32_16x16x32_bf16 v[208:211], v[244:247], v[144:147], v[208:211]
    v_mfma_f32_16x16x32_bf16 v[212:215], v[244:247], v[148:151], v[212:215]
    ds_read_b128 v[236:239], v4 offset:35840
    s_waitcnt lgkmcnt(3)
    v_mfma_f32_16x16x32_bf16 v[184:187], v[224:227], v[24:27], 0
    v_mfma_f32_16x16x32_bf16 v[188:191], v[224:227], v[28:31], 0
    ds_read_b128 v[240:243], v4 offset:36864
    s_waitcnt lgkmcnt(3)
    v_mfma_f32_16x16x32_bf16 v[192:195], v[228:231], v[24:27], 0
    v_mfma_f32_16x16x32_bf16 v[196:199], v[228:231], v[28:31], 0
    s_add_u32 s22, s24, 0x2000
    s_add_u32 m0, s20, 0x10400
    s_nop 0
    buffer_load_dwordx4 v3, s[4:7], s22 offen lds
    ds_read_b128 v[244:247], v4 offset:37888
    v_mul_f32 v200, v200, v9
    s_waitcnt lgkmcnt(3)
    v_mfma_f32_16x16x32_bf16 v[184:187], v[232:235], v[32:35], v[184:187]
    v_mul_f32 v201, v201, v9
    v_mfma_f32_16x16x32_bf16 v[188:191], v[232:235], v[36:39], v[188:191]
    ds_read_b128 v[224:227], v4 offset:38912
    v_mul_f32 v202, v202, v9
    s_waitcnt lgkmcnt(3)
    v_mfma_f32_16x16x32_bf16 v[192:195], v[236:239], v[32:35], v[192:195]
    v_mul_f32 v203, v203, v9
    v_mfma_f32_16x16x32_bf16 v[196:199], v[236:239], v[36:39], v[196:199]
    ds_read_b128 v[228:231], v4 offset:39936
    v_mul_f32 v208, v208, v9
    s_waitcnt lgkmcnt(3)
    v_mfma_f32_16x16x32_bf16 v[184:187], v[240:243], v[40:43], v[184:187]
    v_mul_f32 v209, v209, v9
    v_mfma_f32_16x16x32_bf16 v[188:191], v[240:243], v[44:47], v[188:191]
    ds_read_b128 v[232:235], v4 offset:40960
    v_mul_f32 v210, v210, v9
    s_waitcnt lgkmcnt(3)
    v_mfma_f32_16x16x32_bf16 v[192:195], v[244:247], v[40:43], v[192:195]
    v_mul_f32 v211, v211, v9
    v_mfma_f32_16x16x32_bf16 v[196:199], v[244:247], v[44:47], v[196:199]
    ds_read_b128 v[236:239], v4 offset:41984
    v_cvt_pk_bf16_f32 v216, v200, v201
    s_waitcnt lgkmcnt(3)
    v_mfma_f32_16x16x32_bf16 v[184:187], v[224:227], v[48:51], v[184:187]
    v_cvt_pk_bf16_f32 v217, v202, v203
    v_mfma_f32_16x16x32_bf16 v[188:191], v[224:227], v[52:55], v[188:191]
    ds_read_b128 v[240:243], v4 offset:43008
    v_cvt_pk_bf16_f32 v218, v208, v209
    s_waitcnt lgkmcnt(3)
    v_mfma_f32_16x16x32_bf16 v[192:195], v[228:231], v[48:51], v[192:195]
    v_cvt_pk_bf16_f32 v219, v210, v211
    v_mfma_f32_16x16x32_bf16 v[196:199], v[228:231], v[52:55], v[196:199]
    ds_read_b128 v[244:247], v4 offset:44032
    buffer_store_dwordx4 v[216:219], v2, s[8:11], s25 offen offset:1024 sc1
    s_waitcnt lgkmcnt(3)
    v_mfma_f32_16x16x32_bf16 v[184:187], v[232:235], v[56:59], v[184:187]
    v_mul_f32 v204, v204, v10
    v_mfma_f32_16x16x32_bf16 v[188:191], v[232:235], v[60:63], v[188:191]
    ds_read_b128 v[224:227], v4 offset:45056
    v_mul_f32 v205, v205, v10
    s_waitcnt lgkmcnt(3)
    v_mfma_f32_16x16x32_bf16 v[192:195], v[236:239], v[56:59], v[192:195]
    v_mul_f32 v206, v206, v10
    v_mfma_f32_16x16x32_bf16 v[196:199], v[236:239], v[60:63], v[196:199]
    ds_read_b128 v[228:231], v4 offset:46080
    v_mul_f32 v207, v207, v10
    s_waitcnt lgkmcnt(3)
    v_mfma_f32_16x16x32_bf16 v[184:187], v[240:243], v[64:67], v[184:187]
    v_mul_f32 v212, v212, v10
    v_mfma_f32_16x16x32_bf16 v[188:191], v[240:243], v[68:71], v[188:191]
    ds_read_b128 v[232:235], v4 offset:47104
    v_mul_f32 v213, v213, v10
    s_waitcnt lgkmcnt(3)
    v_mfma_f32_16x16x32_bf16 v[192:195], v[244:247], v[64:67], v[192:195]
    v_mul_f32 v214, v214, v10
    v_mfma_f32_16x16x32_bf16 v[196:199], v[244:247], v[68:71], v[196:199]
    ds_read_b128 v[236:239], v4 offset:48128
    v_mul_f32 v215, v215, v10
    s_waitcnt lgkmcnt(3)
    v_mfma_f32_16x16x32_bf16 v[184:187], v[224:227], v[72:75], v[184:187]
    v_cvt_pk_bf16_f32 v220, v204, v205
    v_mfma_f32_16x16x32_bf16 v[188:191], v[224:227], v[76:79], v[188:191]
    s_barrier
    ds_read_b128 v[240:243], v4 offset:49152
    v_cvt_pk_bf16_f32 v221, v206, v207
    s_waitcnt lgkmcnt(3)
    v_mfma_f32_16x16x32_bf16 v[192:195], v[228:231], v[72:75], v[192:195]
    v_cvt_pk_bf16_f32 v222, v212, v213
    v_mfma_f32_16x16x32_bf16 v[196:199], v[228:231], v[76:79], v[196:199]
    s_add_u32 s22, s24, 0x80000
    s_add_u32 m0, s20, 0x14000
    s_nop 0
    buffer_load_dwordx4 v3, s[4:7], s22 offen lds
    ds_read_b128 v[244:247], v4 offset:50176
    v_cvt_pk_bf16_f32 v223, v214, v215
    s_waitcnt lgkmcnt(3)
    v_mfma_f32_16x16x32_bf16 v[184:187], v[232:235], v[80:83], v[184:187]
    buffer_store_dwordx4 v[220:223], v2, s[8:11], s26 offen offset:1024 sc1
    v_mfma_f32_16x16x32_bf16 v[188:191], v[232:235], v[84:87], v[188:191]
    ds_read_b128 v[224:227], v4 offset:51200
    s_waitcnt lgkmcnt(3)
    v_mfma_f32_16x16x32_bf16 v[192:195], v[236:239], v[80:83], v[192:195]
    v_mfma_f32_16x16x32_bf16 v[196:199], v[236:239], v[84:87], v[196:199]
    ds_read_b128 v[228:231], v4 offset:52224
    s_waitcnt lgkmcnt(3)
    v_mfma_f32_16x16x32_bf16 v[184:187], v[240:243], v[88:91], v[184:187]
    v_mfma_f32_16x16x32_bf16 v[188:191], v[240:243], v[92:95], v[188:191]
    ds_read_b128 v[232:235], v4 offset:53248
    s_waitcnt lgkmcnt(3)
    v_mfma_f32_16x16x32_bf16 v[192:195], v[244:247], v[88:91], v[192:195]
    v_mfma_f32_16x16x32_bf16 v[196:199], v[244:247], v[92:95], v[196:199]
    s_add_u32 s22, s24, 0x82000
    s_add_u32 m0, s20, 0x14400
    s_nop 0
    buffer_load_dwordx4 v3, s[4:7], s22 offen lds
    ds_read_b128 v[236:239], v4 offset:54272
    s_waitcnt lgkmcnt(3)
    v_mfma_f32_16x16x32_bf16 v[184:187], v[224:227], v[96:99], v[184:187]
    v_mfma_f32_16x16x32_bf16 v[188:191], v[224:227], v[100:103], v[188:191]
    ds_read_b128 v[240:243], v4 offset:55296
    s_waitcnt lgkmcnt(3)
    v_mfma_f32_16x16x32_bf16 v[192:195], v[228:231], v[96:99], v[192:195]
    v_mfma_f32_16x16x32_bf16 v[196:199], v[228:231], v[100:103], v[196:199]
    ds_read_b128 v[244:247], v4 offset:56320
    s_waitcnt lgkmcnt(3)
    v_mfma_f32_16x16x32_bf16 v[184:187], v[232:235], v[104:107], v[184:187]
    v_mfma_f32_16x16x32_bf16 v[188:191], v[232:235], v[108:111], v[188:191]
    ds_read_b128 v[224:227], v4 offset:57344
    s_waitcnt lgkmcnt(3)
    v_mfma_f32_16x16x32_bf16 v[192:195], v[236:239], v[104:107], v[192:195]
    v_mfma_f32_16x16x32_bf16 v[196:199], v[236:239], v[108:111], v[196:199]
    ds_read_b128 v[228:231], v4 offset:58368
    s_waitcnt lgkmcnt(3)
    v_mfma_f32_16x16x32_bf16 v[184:187], v[240:243], v[112:115], v[184:187]
    v_mfma_f32_16x16x32_bf16 v[188:191], v[240:243], v[116:119], v[188:191]
    ds_read_b128 v[232:235], v4 offset:59392
    s_waitcnt lgkmcnt(3)
    v_mfma_f32_16x16x32_bf16 v[192:195], v[244:247], v[112:115], v[192:195]
    v_mfma_f32_16x16x32_bf16 v[196:199], v[244:247], v[116:119], v[196:199]
    ds_read_b128 v[236:239], v4 offset:60416
    s_waitcnt lgkmcnt(3)
    v_mfma_f32_16x16x32_bf16 v[184:187], v[224:227], v[120:123], v[184:187]
    v_mfma_f32_16x16x32_bf16 v[188:191], v[224:227], v[124:127], v[188:191]
    ds_read_b128 v[240:243], v4 offset:61440
    s_waitcnt lgkmcnt(3)
    v_mfma_f32_16x16x32_bf16 v[192:195], v[228:231], v[120:123], v[192:195]
    v_mfma_f32_16x16x32_bf16 v[196:199], v[228:231], v[124:127], v[196:199]
    ds_read_b128 v[244:247], v4 offset:62464
    s_waitcnt lgkmcnt(3)
    v_mfma_f32_16x16x32_bf16 v[184:187], v[232:235], v[128:131], v[184:187]
    v_mfma_f32_16x16x32_bf16 v[188:191], v[232:235], v[132:135], v[188:191]
    ds_read_b128 v[224:227], v4 offset:63488
    s_waitcnt lgkmcnt(3)
    v_mfma_f32_16x16x32_bf16 v[192:195], v[236:239], v[128:131], v[192:195]
    v_mfma_f32_16x16x32_bf16 v[196:199], v[236:239], v[132:135], v[196:199]
    ds_read_b128 v[228:231], v4 offset:64512
    s_waitcnt lgkmcnt(3)
    v_mfma_f32_16x16x32_bf16 v[184:187], v[240:243], v[136:139], v[184:187]
    v_mfma_f32_16x16x32_bf16 v[188:191], v[240:243], v[140:143], v[188:191]
    s_barrier
    ds_read_b128 v[232:235], v5 offset:0
    s_waitcnt lgkmcnt(3)
    v_mfma_f32_16x16x32_bf16 v[192:195], v[244:247], v[136:139], v[192:195]
    v_mfma_f32_16x16x32_bf16 v[196:199], v[244:247], v[140:143], v[196:199]
    s_add_u32 s22, s24, 0x100000
    s_add_u32 m0, s20, 0x18000
    s_nop 0
    buffer_load_dwordx4 v3, s[4:7], s22 offen lds
    ds_read_b128 v[236:239], v5 offset:1024
    s_waitcnt lgkmcnt(3)
    v_mfma_f32_16x16x32_bf16 v[184:187], v[224:227], v[144:147], v[184:187]
    v_mfma_f32_16x16x32_bf16 v[188:191], v[224:227], v[148:151], v[188:191]
    ds_read_b128 v[240:243], v5 offset:2048
    s_waitcnt lgkmcnt(3)
    v_mfma_f32_16x16x32_bf16 v[192:195], v[228:231], v[144:147], v[192:195]
    v_mfma_f32_16x16x32_bf16 v[196:199], v[228:231], v[148:151], v[196:199]
    ds_read_b128 v[244:247], v5 offset:3072
    s_waitcnt lgkmcnt(3)
    v_mfma_f32_16x16x32_bf16 v[200:203], v[232:235], v[24:27], 0
    v_mfma_f32_16x16x32_bf16 v[204:207], v[232:235], v[28:31], 0
    ds_read_b128 v[224:227], v5 offset:4096
    s_waitcnt lgkmcnt(3)
    v_mfma_f32_16x16x32_bf16 v[208:211], v[236:239], v[24:27], 0
    v_mfma_f32_16x16x32_bf16 v[212:215], v[236:239], v[28:31], 0
    s_add_u32 s22, s24, 0x102000
    s_add_u32 m0, s20, 0x18400
    s_nop 0
    buffer_load_dwordx4 v3, s[4:7], s22 offen lds
    ds_read_b128 v[228:231], v5 offset:5120
    v_mul_f32 v184, v184, v9
    s_waitcnt lgkmcnt(3)
    v_mfma_f32_16x16x32_bf16 v[200:203], v[240:243], v[32:35], v[200:203]
    v_mul_f32 v185, v185, v9
    s_bfe_u32 s30, s2, 0x20001
    s_lshl_b32 s30, s30, 2
    s_bfe_u32 s17, s2, 0x20003
    s_add_u32 s30, s30, s17
    s_lshr_b32 s31, s2, 5
    s_and_b32 s17, s3, 3
    s_lshl_b32 s19, s30, 2
    s_add_u32 s19, s19, s17
    s_and_b32 s16, s2, 1
    s_lshl_b32 s17, s19, 18
    s_lshl_b32 s23, s16, 16
    s_add_u32 s17, s17, s23
    s_add_u32 s17, s17, 0x1000000
    v_add_u32 v6, s17, v2
    s_lshl_b32 s19, s19, 7
    s_lshl_b32 s23, s16, 6
    s_add_u32 s19, s19, s23
    s_add_u32 s19, s19, 0x570000
    v_and_b32 v13, 15, v1
    v_lshlrev_b32 v13, 2, v13
    buffer_load_dword v12, v13, s[8:11], s19 offen sc1
    v_mfma_f32_16x16x32_bf16 v[204:207], v[240:243], v[36:39], v[204:207]
    ds_read_b128 v[232:235], v5 offset:6144
    v_mul_f32 v186, v186, v9
    s_waitcnt lgkmcnt(3)
    v_mfma_f32_16x16x32_bf16 v[208:211], v[244:247], v[32:35], v[208:211]
    v_mul_f32 v187, v187, v9
    v_mfma_f32_16x16x32_bf16 v[212:215], v[244:247], v[36:39], v[212:215]
    ds_read_b128 v[236:239], v5 offset:7168
    v_mul_f32 v192, v192, v9
    s_waitcnt lgkmcnt(3)
    v_mfma_f32_16x16x32_bf16 v[200:203], v[224:227], v[40:43], v[200:203]
    v_mul_f32 v193, v193, v9
    v_mfma_f32_16x16x32_bf16 v[204:207], v[224:227], v[44:47], v[204:207]
    ds_read_b128 v[240:243], v5 offset:8192
    v_mul_f32 v194, v194, v9
    s_waitcnt lgkmcnt(3)
    v_mfma_f32_16x16x32_bf16 v[208:211], v[228:231], v[40:43], v[208:211]
    v_mul_f32 v195, v195, v9
    v_mfma_f32_16x16x32_bf16 v[212:215], v[228:231], v[44:47], v[212:215]
    ds_read_b128 v[244:247], v5 offset:9216
    v_cvt_pk_bf16_f32 v216, v184, v185
    s_waitcnt lgkmcnt(3)
    v_mfma_f32_16x16x32_bf16 v[200:203], v[232:235], v[48:51], v[200:203]
    v_cvt_pk_bf16_f32 v217, v186, v187
    v_mfma_f32_16x16x32_bf16 v[204:207], v[232:235], v[52:55], v[204:207]
    ds_read_b128 v[224:227], v5 offset:10240
    v_cvt_pk_bf16_f32 v218, v192, v193
    s_waitcnt lgkmcnt(3)
    v_mfma_f32_16x16x32_bf16 v[208:211], v[236:239], v[48:51], v[208:211]
    v_cvt_pk_bf16_f32 v219, v194, v195
    v_mfma_f32_16x16x32_bf16 v[212:215], v[236:239], v[52:55], v[212:215]
    ds_read_b128 v[228:231], v5 offset:11264
    buffer_store_dwordx4 v[216:219], v2, s[8:11], s25 offen offset:2048 sc1
    s_waitcnt lgkmcnt(3)
    v_mfma_f32_16x16x32_bf16 v[200:203], v[240:243], v[56:59], v[200:203]
    v_mul_f32 v188, v188, v10
    v_mfma_f32_16x16x32_bf16 v[204:207], v[240:243], v[60:63], v[204:207]
    ds_read_b128 v[232:235], v5 offset:12288
    v_mul_f32 v189, v189, v10
    s_waitcnt lgkmcnt(3)
    v_mfma_f32_16x16x32_bf16 v[208:211], v[244:247], v[56:59], v[208:211]
    v_mul_f32 v190, v190, v10
    v_mfma_f32_16x16x32_bf16 v[212:215], v[244:247], v[60:63], v[212:215]
    ds_read_b128 v[236:239], v5 offset:13312
    v_mul_f32 v191, v191, v10
    s_waitcnt lgkmcnt(3)
    v_mfma_f32_16x16x32_bf16 v[200:203], v[224:227], v[64:67], v[200:203]
    v_mul_f32 v196, v196, v10
    v_mfma_f32_16x16x32_bf16 v[204:207], v[224:227], v[68:71], v[204:207]
    ds_read_b128 v[240:243], v5 offset:14336
    v_mul_f32 v197, v197, v10
    s_waitcnt lgkmcnt(3)
    v_mfma_f32_16x16x32_bf16 v[208:211], v[228:231], v[64:67], v[208:211]
    v_mul_f32 v198, v198, v10
    v_mfma_f32_16x16x32_bf16 v[212:215], v[228:231], v[68:71], v[212:215]
    ds_read_b128 v[244:247], v5 offset:15360
    v_mul_f32 v199, v199, v10
    s_waitcnt lgkmcnt(3)
    v_mfma_f32_16x16x32_bf16 v[200:203], v[232:235], v[72:75], v[200:203]
    v_cvt_pk_bf16_f32 v220, v188, v189
    v_mfma_f32_16x16x32_bf16 v[204:207], v[232:235], v[76:79], v[204:207]
    s_waitcnt vmcnt(12)
    s_barrier
    ds_read_b128 v[224:227], v5 offset:16384
    v_cvt_pk_bf16_f32 v221, v190, v191
    s_waitcnt lgkmcnt(3)
    v_mfma_f32_16x16x32_bf16 v[208:211], v[236:239], v[72:75], v[208:211]
    v_cvt_pk_bf16_f32 v222, v196, v197
    v_mfma_f32_16x16x32_bf16 v[212:215], v[236:239], v[76:79], v[212:215]
    s_add_u32 s22, s24, 0x180000
    s_add_u32 m0, s20, 0x1c000
    s_nop 0
    buffer_load_dwordx4 v3, s[4:7], s22 offen lds
    ds_read_b128 v[228:231], v5 offset:17408
    v_cvt_pk_bf16_f32 v223, v198, v199
    s_waitcnt lgkmcnt(3)
    v_mfma_f32_16x16x32_bf16 v[200:203], v[240:243], v[80:83], v[200:203]
    buffer_store_dwordx4 v[220:223], v2, s[8:11], s26 offen offset:2048 sc1
    s_waitcnt vmcnt(7)
    s_add_u32 s16, s63, 0x572000
    v_mov_b32 v14, s28
    v_mov_b32 v15, 0
    s_mov_b64 exec, 1
    buffer_store_dword v14, v15, s[8:11], s16 offen sc1
    s_mov_b64 exec, -1
    v_mfma_f32_16x16x32_bf16 v[204:207], v[240:243], v[84:87], v[204:207]
    ds_read_b128 v[232:235], v5 offset:18432
    s_waitcnt lgkmcnt(3)
    v_mfma_f32_16x16x32_bf16 v[208:211], v[244:247], v[80:83], v[208:211]
    v_mfma_f32_16x16x32_bf16 v[212:215], v[244:247], v[84:87], v[212:215]
    ds_read_b128 v[236:239], v5 offset:19456
    s_waitcnt lgkmcnt(3)
    v_mfma_f32_16x16x32_bf16 v[200:203], v[224:227], v[88:91], v[200:203]
    v_mfma_f32_16x16x32_bf16 v[204:207], v[224:227], v[92:95], v[204:207]
    ds_read_b128 v[240:243], v5 offset:20480
    s_waitcnt vmcnt(4)
    v_cmp_ne_u32 vcc, s28, v12
    s_cbranch_vccnz adaLN_cond__sliding_block_cached__moe_arch_mod__prompt_kernel_o6r
adaLN_cond__sliding_block_cached__moe_arch_mod__prompt_kernel_o6b:
    s_waitcnt lgkmcnt(3)
    v_mfma_f32_16x16x32_bf16 v[208:211], v[228:231], v[88:91], v[208:211]
    s_mov_b32 s23, 0x0
    buffer_load_dwordx4 v[24:27], v6, s[8:11], s23 offen offset:0 sc1
    v_mfma_f32_16x16x32_bf16 v[212:215], v[228:231], v[92:95], v[212:215]
    s_add_u32 s22, s24, 0x182000
    s_add_u32 m0, s20, 0x1c400
    s_nop 0
    buffer_load_dwordx4 v3, s[4:7], s22 offen lds
    ds_read_b128 v[244:247], v5 offset:21504
    s_waitcnt lgkmcnt(3)
    v_mfma_f32_16x16x32_bf16 v[200:203], v[232:235], v[96:99], v[200:203]
    v_mfma_f32_16x16x32_bf16 v[204:207], v[232:235], v[100:103], v[204:207]
    ds_read_b128 v[224:227], v5 offset:22528
    s_mov_b32 s23, 0x20000
    buffer_load_dwordx4 v[28:31], v6, s[8:11], s23 offen offset:0 sc1
    s_waitcnt lgkmcnt(3)
    v_mfma_f32_16x16x32_bf16 v[208:211], v[236:239], v[96:99], v[208:211]
    v_mfma_f32_16x16x32_bf16 v[212:215], v[236:239], v[100:103], v[212:215]
    ds_read_b128 v[228:231], v5 offset:23552
    s_waitcnt lgkmcnt(3)
    v_mfma_f32_16x16x32_bf16 v[200:203], v[240:243], v[104:107], v[200:203]
    v_mfma_f32_16x16x32_bf16 v[204:207], v[240:243], v[108:111], v[204:207]
    ds_read_b128 v[232:235], v5 offset:24576
    s_mov_b32 s23, 0x2000
    buffer_load_dwordx4 v[32:35], v6, s[8:11], s23 offen offset:0 sc1
    s_waitcnt lgkmcnt(3)
    v_mfma_f32_16x16x32_bf16 v[208:211], v[244:247], v[104:107], v[208:211]
    v_mfma_f32_16x16x32_bf16 v[212:215], v[244:247], v[108:111], v[212:215]
    ds_read_b128 v[236:239], v5 offset:25600
    s_waitcnt lgkmcnt(3)
    v_mfma_f32_16x16x32_bf16 v[200:203], v[224:227], v[112:115], v[200:203]
    s_mov_b32 s23, 0x22000
    buffer_load_dwordx4 v[36:39], v6, s[8:11], s23 offen offset:0 sc1
    v_mfma_f32_16x16x32_bf16 v[204:207], v[224:227], v[116:119], v[204:207]
    ds_read_b128 v[240:243], v5 offset:26624
    s_waitcnt lgkmcnt(3)
    v_mfma_f32_16x16x32_bf16 v[208:211], v[228:231], v[112:115], v[208:211]
    v_mfma_f32_16x16x32_bf16 v[212:215], v[228:231], v[116:119], v[212:215]
    ds_read_b128 v[244:247], v5 offset:27648
    s_waitcnt lgkmcnt(3)
    v_mfma_f32_16x16x32_bf16 v[200:203], v[232:235], v[120:123], v[200:203]
    s_mov_b32 s23, 0x4000
    buffer_load_dwordx4 v[40:43], v6, s[8:11], s23 offen offset:0 sc1
    v_mfma_f32_16x16x32_bf16 v[204:207], v[232:235], v[124:127], v[204:207]
    ds_read_b128 v[224:227], v5 offset:28672
    s_waitcnt lgkmcnt(3)
    v_mfma_f32_16x16x32_bf16 v[208:211], v[236:239], v[120:123], v[208:211]
    v_mfma_f32_16x16x32_bf16 v[212:215], v[236:239], v[124:127], v[212:215]
    ds_read_b128 v[228:231], v5 offset:29696
    s_waitcnt lgkmcnt(3)
    v_mfma_f32_16x16x32_bf16 v[200:203], v[240:243], v[128:131], v[200:203]
    s_mov_b32 s23, 0x24000
    buffer_load_dwordx4 v[44:47], v6, s[8:11], s23 offen offset:0 sc1
    v_mfma_f32_16x16x32_bf16 v[204:207], v[240:243], v[132:135], v[204:207]
    ds_read_b128 v[232:235], v5 offset:30720
    s_waitcnt lgkmcnt(3)
    v_mfma_f32_16x16x32_bf16 v[208:211], v[244:247], v[128:131], v[208:211]
    v_mfma_f32_16x16x32_bf16 v[212:215], v[244:247], v[132:135], v[212:215]
    ds_read_b128 v[236:239], v5 offset:31744
    s_mov_b32 s23, 0x6000
    buffer_load_dwordx4 v[48:51], v6, s[8:11], s23 offen offset:0 sc1
    s_waitcnt lgkmcnt(3)
    v_mfma_f32_16x16x32_bf16 v[200:203], v[224:227], v[136:139], v[200:203]
    v_bfe_u32 v18, v1, 2, 2
    v_lshrrev_b32 v19, 4, v1
    v_mfma_f32_16x16x32_bf16 v[204:207], v[224:227], v[140:143], v[204:207]
    v_and_b32 v17, 3, v1
    v_lshlrev_b32 v16, 11, v19
    s_waitcnt lgkmcnt(2)
    v_mfma_f32_16x16x32_bf16 v[208:211], v[228:231], v[136:139], v[208:211]
    v_lshl_add_u32 v16, v18, 6, v16
    v_lshl_add_u32 v16, v17, 3, v16
    v_mfma_f32_16x16x32_bf16 v[212:215], v[228:231], v[140:143], v[212:215]
    s_mov_b32 s23, 0x26000
    buffer_load_dwordx4 v[52:55], v6, s[8:11], s23 offen offset:0 sc1
    v_add_u32 v16, 0x10000, v16
    v_and_b32 v19, 1, v19
    s_waitcnt lgkmcnt(1)
    v_mfma_f32_16x16x32_bf16 v[200:203], v[232:235], v[144:147], v[200:203]
    v_lshlrev_b32 v19, 5, v19
    v_sub_u32 v5, v16, v19
    v_mfma_f32_16x16x32_bf16 v[204:207], v[232:235], v[148:151], v[204:207]
    v_add_u32 v4, v16, v19
    v_add_u32 v7, 0x10000, v4
    s_waitcnt lgkmcnt(0)
    v_mfma_f32_16x16x32_bf16 v[208:211], v[236:239], v[144:147], v[208:211]
    v_add_u32 v8, 0x10000, v5
    v_mfma_f32_16x16x32_bf16 v[212:215], v[236:239], v[148:151], v[212:215]
    v_mul_f32 v200, v200, v9
    v_mul_f32 v201, v201, v9
    v_mul_f32 v202, v202, v9
    v_mul_f32 v203, v203, v9
    s_nop 1
    v_mul_f32 v208, v208, v9
    v_mul_f32 v209, v209, v9
    v_mul_f32 v210, v210, v9
    v_mul_f32 v211, v211, v9
    v_cvt_pk_bf16_f32 v216, v200, v201
    v_cvt_pk_bf16_f32 v217, v202, v203
    v_cvt_pk_bf16_f32 v218, v208, v209
    v_cvt_pk_bf16_f32 v219, v210, v211
    buffer_store_dwordx4 v[216:219], v2, s[8:11], s25 offen offset:3072 sc1
    v_mul_f32 v204, v204, v10
    v_mul_f32 v205, v205, v10
    v_mul_f32 v206, v206, v10
    v_mul_f32 v207, v207, v10
    v_mul_f32 v212, v212, v10
    v_mul_f32 v213, v213, v10
    v_mul_f32 v214, v214, v10
    v_mul_f32 v215, v215, v10
    v_cvt_pk_bf16_f32 v220, v204, v205
    v_cvt_pk_bf16_f32 v221, v206, v207
    v_cvt_pk_bf16_f32 v222, v212, v213
    v_cvt_pk_bf16_f32 v223, v214, v215
    buffer_store_dwordx4 v[220:223], v2, s[8:11], s26 offen offset:3072 sc1
    s_and_b32 s15, s2, 1
    s_barrier
    ds_read_b64_tr_b16 v[224:225], v4 offset:0
    ds_read_b64_tr_b16 v[226:227], v4 offset:1024
    ds_read_b64_tr_b16 v[228:229], v5 offset:32
    ds_read_b64_tr_b16 v[230:231], v5 offset:1056
    ds_read_b64_tr_b16 v[232:233], v4 offset:256
    ds_read_b64_tr_b16 v[234:235], v4 offset:1280
    ds_read_b64_tr_b16 v[236:237], v5 offset:288
    ds_read_b64_tr_b16 v[238:239], v5 offset:1312
    s_waitcnt vmcnt(10) lgkmcnt(6)
    v_mfma_f32_16x16x32_bf16 v[88:91], v[224:227], v[24:27], 0
    ds_read_b64_tr_b16 v[240:241], v4 offset:512
    s_waitcnt vmcnt(8)
    v_mfma_f32_16x16x32_bf16 v[92:95], v[224:227], v[28:31], 0
    s_add_u32 s22, s24, 0x200000
    s_add_u32 m0, s20, 0x20000
    s_nop 0
    buffer_load_dwordx4 v3, s[4:7], s22 offen lds
    ds_read_b64_tr_b16 v[242:243], v4 offset:1536
    s_waitcnt lgkmcnt(6)
    v_mfma_f32_16x16x32_bf16 v[96:99], v[228:231], v[24:27], 0
    ds_read_b64_tr_b16 v[244:245], v5 offset:544
    s_mov_b32 s23, 0x8000
    buffer_load_dwordx4 v[56:59], v6, s[8:11], s23 offen offset:0 sc1
    v_mfma_f32_16x16x32_bf16 v[100:103], v[228:231], v[28:31], 0
    ds_read_b64_tr_b16 v[246:247], v5 offset:1568
    s_waitcnt lgkmcnt(6)
    v_mfma_f32_16x16x32_bf16 v[104:107], v[232:235], v[24:27], 0
    s_add_u32 s22, s24, 0x202000
    s_add_u32 m0, s20, 0x20400
    s_nop 0
    buffer_load_dwordx4 v3, s[4:7], s22 offen lds
    ds_read_b64_tr_b16 v[224:225], v4 offset:768
    v_mfma_f32_16x16x32_bf16 v[108:111], v[232:235], v[28:31], 0
    ds_read_b64_tr_b16 v[226:227], v4 offset:1792
    s_mov_b32 s23, 0x28000
    buffer_load_dwordx4 v[60:63], v6, s[8:11], s23 offen offset:0 sc1
    s_waitcnt lgkmcnt(6)
    v_mfma_f32_16x16x32_bf16 v[112:115], v[236:239], v[24:27], 0
    ds_read_b64_tr_b16 v[228:229], v5 offset:800
    v_mfma_f32_16x16x32_bf16 v[116:119], v[236:239], v[28:31], 0
    ds_read_b64_tr_b16 v[230:231], v5 offset:1824
    s_waitcnt lgkmcnt(6)
    v_mfma_f32_16x16x32_bf16 v[120:123], v[240:243], v[24:27], 0
    v_mfma_f32_16x16x32_bf16 v[124:127], v[240:243], v[28:31], 0
    s_barrier
    ds_read_b64_tr_b16 v[232:233], v4 offset:16384
    ds_read_b64_tr_b16 v[234:235], v4 offset:17408
    s_waitcnt lgkmcnt(6)
    v_mfma_f32_16x16x32_bf16 v[128:131], v[244:247], v[24:27], 0
    s_add_u32 s22, s24, 0x280000
    s_add_u32 m0, s20, 0x24000
    s_nop 0
    buffer_load_dwordx4 v3, s[4:7], s22 offen lds
    ds_read_b64_tr_b16 v[236:237], v5 offset:16416
    v_mfma_f32_16x16x32_bf16 v[132:135], v[244:247], v[28:31], 0
    ds_read_b64_tr_b16 v[238:239], v5 offset:17440
    s_waitcnt lgkmcnt(6)
    v_mfma_f32_16x16x32_bf16 v[136:139], v[224:227], v[24:27], 0
    ds_read_b64_tr_b16 v[240:241], v4 offset:16640
    v_mfma_f32_16x16x32_bf16 v[140:143], v[224:227], v[28:31], 0
    s_add_u32 s22, s24, 0x282000
    s_add_u32 m0, s20, 0x24400
    s_nop 0
    buffer_load_dwordx4 v3, s[4:7], s22 offen lds
    ds_read_b64_tr_b16 v[242:243], v4 offset:17664
    s_waitcnt lgkmcnt(6)
    v_mfma_f32_16x16x32_bf16 v[144:147], v[228:231], v[24:27], 0
    ds_read_b64_tr_b16 v[244:245], v5 offset:16672
    v_mfma_f32_16x16x32_bf16 v[148:151], v[228:231], v[28:31], 0
    ds_read_b64_tr_b16 v[246:247], v5 offset:17696
    s_waitcnt vmcnt(13) lgkmcnt(6)
    v_mfma_f32_16x16x32_bf16 v[88:91], v[232:235], v[32:35], v[88:91]
    ds_read_b64_tr_b16 v[224:225], v4 offset:16896
    s_waitcnt vmcnt(12)
    v_mfma_f32_16x16x32_bf16 v[92:95], v[232:235], v[36:39], v[92:95]
    ds_read_b64_tr_b16 v[226:227], v4 offset:17920
    s_waitcnt lgkmcnt(6)
    v_mfma_f32_16x16x32_bf16 v[96:99], v[236:239], v[32:35], v[96:99]
    ds_read_b64_tr_b16 v[228:229], v5 offset:16928
    s_mov_b32 s23, 0xa000
    buffer_load_dwordx4 v[24:27], v6, s[8:11], s23 offen offset:0 sc1
    v_mfma_f32_16x16x32_bf16 v[100:103], v[236:239], v[36:39], v[100:103]
    ds_read_b64_tr_b16 v[230:231], v5 offset:17952
    s_waitcnt lgkmcnt(6)
    v_mfma_f32_16x16x32_bf16 v[104:107], v[240:243], v[32:35], v[104:107]
    ds_read_b64_tr_b16 v[232:233], v4 offset:17152
    v_mfma_f32_16x16x32_bf16 v[108:111], v[240:243], v[36:39], v[108:111]
    ds_read_b64_tr_b16 v[234:235], v4 offset:18176
    s_mov_b32 s23, 0x2a000
    buffer_load_dwordx4 v[28:31], v6, s[8:11], s23 offen offset:0 sc1
    s_waitcnt lgkmcnt(6)
    v_mfma_f32_16x16x32_bf16 v[112:115], v[244:247], v[32:35], v[112:115]
    ds_read_b64_tr_b16 v[236:237], v5 offset:17184
    v_mfma_f32_16x16x32_bf16 v[116:119], v[244:247], v[36:39], v[116:119]
    ds_read_b64_tr_b16 v[238:239], v5 offset:18208
    s_waitcnt lgkmcnt(6)
    v_mfma_f32_16x16x32_bf16 v[120:123], v[224:227], v[32:35], v[120:123]
    v_mfma_f32_16x16x32_bf16 v[124:127], v[224:227], v[36:39], v[124:127]
    s_barrier
    ds_read_b64_tr_b16 v[240:241], v4 offset:32768
    ds_read_b64_tr_b16 v[242:243], v4 offset:33792
    s_waitcnt lgkmcnt(6)
    v_mfma_f32_16x16x32_bf16 v[128:131], v[228:231], v[32:35], v[128:131]
    s_add_u32 s22, s24, 0x300000
    s_add_u32 m0, s20, 0x10000
    s_nop 0
    buffer_load_dwordx4 v3, s[4:7], s22 offen lds
    ds_read_b64_tr_b16 v[244:245], v5 offset:32800
    v_mfma_f32_16x16x32_bf16 v[132:135], v[228:231], v[36:39], v[132:135]
    ds_read_b64_tr_b16 v[246:247], v5 offset:33824
    s_waitcnt lgkmcnt(6)
    v_mfma_f32_16x16x32_bf16 v[136:139], v[232:235], v[32:35], v[136:139]
    ds_read_b64_tr_b16 v[224:225], v4 offset:33024
    v_mfma_f32_16x16x32_bf16 v[140:143], v[232:235], v[36:39], v[140:143]
    s_add_u32 s22, s24, 0x302000
    s_add_u32 m0, s20, 0x10400
    s_nop 0
    buffer_load_dwordx4 v3, s[4:7], s22 offen lds
    ds_read_b64_tr_b16 v[226:227], v4 offset:34048
    s_waitcnt lgkmcnt(6)
    v_mfma_f32_16x16x32_bf16 v[144:147], v[236:239], v[32:35], v[144:147]
    s_add_u32 s16, s63, 0x574000
    v_mov_b32 v14, s28
    v_mov_b32 v15, 0
    s_mov_b64 exec, 1
    buffer_store_dword v14, v15, s[8:11], s16 offen sc1
    s_mov_b64 exec, -1
    ds_read_b64_tr_b16 v[228:229], v5 offset:33056
    v_mfma_f32_16x16x32_bf16 v[148:151], v[236:239], v[36:39], v[148:151]
    ds_read_b64_tr_b16 v[230:231], v5 offset:34080
    s_waitcnt vmcnt(16) lgkmcnt(6)
    v_mfma_f32_16x16x32_bf16 v[88:91], v[240:243], v[40:43], v[88:91]
    ds_read_b64_tr_b16 v[232:233], v4 offset:33280
    s_waitcnt vmcnt(15)
    v_mfma_f32_16x16x32_bf16 v[92:95], v[240:243], v[44:47], v[92:95]
    ds_read_b64_tr_b16 v[234:235], v4 offset:34304
    s_waitcnt lgkmcnt(6)
    v_mfma_f32_16x16x32_bf16 v[96:99], v[244:247], v[40:43], v[96:99]
    ds_read_b64_tr_b16 v[236:237], v5 offset:33312
    s_mov_b32 s23, 0xc000
    buffer_load_dwordx4 v[32:35], v6, s[8:11], s23 offen offset:0 sc1
    v_mfma_f32_16x16x32_bf16 v[100:103], v[244:247], v[44:47], v[100:103]
    ds_read_b64_tr_b16 v[238:239], v5 offset:34336
    s_waitcnt lgkmcnt(6)
    v_mfma_f32_16x16x32_bf16 v[104:107], v[224:227], v[40:43], v[104:107]
    ds_read_b64_tr_b16 v[240:241], v4 offset:33536
    v_mfma_f32_16x16x32_bf16 v[108:111], v[224:227], v[44:47], v[108:111]
    ds_read_b64_tr_b16 v[242:243], v4 offset:34560
    s_mov_b32 s23, 0x2c000
    buffer_load_dwordx4 v[36:39], v6, s[8:11], s23 offen offset:0 sc1
    s_waitcnt lgkmcnt(6)
    v_mfma_f32_16x16x32_bf16 v[112:115], v[228:231], v[40:43], v[112:115]
    ds_read_b64_tr_b16 v[244:245], v5 offset:33568
    v_mfma_f32_16x16x32_bf16 v[116:119], v[228:231], v[44:47], v[116:119]
    ds_read_b64_tr_b16 v[246:247], v5 offset:34592
    s_waitcnt lgkmcnt(6)
    v_mfma_f32_16x16x32_bf16 v[120:123], v[232:235], v[40:43], v[120:123]
    v_mfma_f32_16x16x32_bf16 v[124:127], v[232:235], v[44:47], v[124:127]
    s_barrier
    ds_read_b64_tr_b16 v[224:225], v4 offset:49152
    ds_read_b64_tr_b16 v[226:227], v4 offset:50176
    s_add_u32 s19, s19, 8192
    buffer_load_dword v12, v13, s[8:11], s19 offen sc1
    s_waitcnt lgkmcnt(6)
    v_mfma_f32_16x16x32_bf16 v[128:131], v[236:239], v[40:43], v[128:131]
    s_add_u32 s22, s24, 0x380000
    s_add_u32 m0, s20, 0x14000
    s_nop 0
    buffer_load_dwordx4 v3, s[4:7], s22 offen lds
    ds_read_b64_tr_b16 v[228:229], v5 offset:49184
    v_mfma_f32_16x16x32_bf16 v[132:135], v[236:239], v[44:47], v[132:135]
    ds_read_b64_tr_b16 v[230:231], v5 offset:50208
    s_waitcnt lgkmcnt(6)
    v_mfma_f32_16x16x32_bf16 v[136:139], v[240:243], v[40:43], v[136:139]
    ds_read_b64_tr_b16 v[232:233], v4 offset:49408
    v_mfma_f32_16x16x32_bf16 v[140:143], v[240:243], v[44:47], v[140:143]
    s_add_u32 s22, s24, 0x382000
    s_add_u32 m0, s20, 0x14400
    s_nop 0
    buffer_load_dwordx4 v3, s[4:7], s22 offen lds
    ds_read_b64_tr_b16 v[234:235], v4 offset:50432
    s_waitcnt lgkmcnt(6)
    v_mfma_f32_16x16x32_bf16 v[144:147], v[244:247], v[40:43], v[144:147]
    ds_read_b64_tr_b16 v[236:237], v5 offset:49440
    v_mfma_f32_16x16x32_bf16 v[148:151], v[244:247], v[44:47], v[148:151]
    ds_read_b64_tr_b16 v[238:239], v5 offset:50464
    s_waitcnt vmcnt(19) lgkmcnt(6)
    v_mfma_f32_16x16x32_bf16 v[88:91], v[224:227], v[48:51], v[88:91]
    ds_read_b64_tr_b16 v[240:241], v4 offset:49664
    s_waitcnt vmcnt(18)
    v_mfma_f32_16x16x32_bf16 v[92:95], v[224:227], v[52:55], v[92:95]
    ds_read_b64_tr_b16 v[242:243], v4 offset:50688
    s_waitcnt lgkmcnt(6)
    v_mfma_f32_16x16x32_bf16 v[96:99], v[228:231], v[48:51], v[96:99]
    ds_read_b64_tr_b16 v[244:245], v5 offset:49696
    s_mov_b32 s23, 0xe000
    buffer_load_dwordx4 v[40:43], v6, s[8:11], s23 offen offset:0 sc1
    v_mfma_f32_16x16x32_bf16 v[100:103], v[228:231], v[52:55], v[100:103]
    ds_read_b64_tr_b16 v[246:247], v5 offset:50720
    s_waitcnt lgkmcnt(6)
    v_mfma_f32_16x16x32_bf16 v[104:107], v[232:235], v[48:51], v[104:107]
    ds_read_b64_tr_b16 v[224:225], v4 offset:49920
    v_mfma_f32_16x16x32_bf16 v[108:111], v[232:235], v[52:55], v[108:111]
    ds_read_b64_tr_b16 v[226:227], v4 offset:50944
    s_mov_b32 s23, 0x2e000
    buffer_load_dwordx4 v[44:47], v6, s[8:11], s23 offen offset:0 sc1
    s_waitcnt lgkmcnt(6)
    v_mfma_f32_16x16x32_bf16 v[112:115], v[236:239], v[48:51], v[112:115]
    ds_read_b64_tr_b16 v[228:229], v5 offset:49952
    v_mfma_f32_16x16x32_bf16 v[116:119], v[236:239], v[52:55], v[116:119]
    ds_read_b64_tr_b16 v[230:231], v5 offset:50976
    s_waitcnt lgkmcnt(6)
    v_mfma_f32_16x16x32_bf16 v[120:123], v[240:243], v[48:51], v[120:123]
    v_mfma_f32_16x16x32_bf16 v[124:127], v[240:243], v[52:55], v[124:127]
    s_waitcnt vmcnt(15)
    s_barrier
    ds_read_b64_tr_b16 v[232:233], v7 offset:0
    ds_read_b64_tr_b16 v[234:235], v7 offset:1024
    s_waitcnt lgkmcnt(6)
    v_mfma_f32_16x16x32_bf16 v[128:131], v[244:247], v[48:51], v[128:131]
    s_add_u32 s22, s24, 0x10000
    s_add_u32 m0, s20, 0x18000
    s_nop 0
    buffer_load_dwordx4 v3, s[4:7], s22 offen lds
    ds_read_b64_tr_b16 v[236:237], v8 offset:32
    v_mfma_f32_16x16x32_bf16 v[132:135], v[244:247], v[52:55], v[132:135]
    ds_read_b64_tr_b16 v[238:239], v8 offset:1056
    s_waitcnt lgkmcnt(6)
    v_mfma_f32_16x16x32_bf16 v[136:139], v[224:227], v[48:51], v[136:139]
    ds_read_b64_tr_b16 v[240:241], v7 offset:256
    v_mfma_f32_16x16x32_bf16 v[140:143], v[224:227], v[52:55], v[140:143]
    s_add_u32 s22, s24, 0x12000
    s_add_u32 m0, s20, 0x18400
    s_nop 0
    buffer_load_dwordx4 v3, s[4:7], s22 offen lds
    ds_read_b64_tr_b16 v[242:243], v7 offset:1280
    s_waitcnt lgkmcnt(6)
    v_mfma_f32_16x16x32_bf16 v[144:147], v[228:231], v[48:51], v[144:147]
    ds_read_b64_tr_b16 v[244:245], v8 offset:288
    v_mfma_f32_16x16x32_bf16 v[148:151], v[228:231], v[52:55], v[148:151]
    ds_read_b64_tr_b16 v[246:247], v8 offset:1312
    s_waitcnt vmcnt(6)
    v_cmp_ne_u32 vcc, s28, v12
    s_cbranch_vccnz adaLN_cond__sliding_block_cached__moe_arch_mod__prompt_kernel_o27r
adaLN_cond__sliding_block_cached__moe_arch_mod__prompt_kernel_o27b:
    s_waitcnt lgkmcnt(6)
    v_mfma_f32_16x16x32_bf16 v[88:91], v[232:235], v[56:59], v[88:91]
    ds_read_b64_tr_b16 v[224:225], v7 offset:512
    v_mfma_f32_16x16x32_bf16 v[92:95], v[232:235], v[60:63], v[92:95]
    ds_read_b64_tr_b16 v[226:227], v7 offset:1536
    s_waitcnt lgkmcnt(6)
    v_mfma_f32_16x16x32_bf16 v[96:99], v[236:239], v[56:59], v[96:99]
    ds_read_b64_tr_b16 v[228:229], v8 offset:544
    s_mov_b32 s23, 0x0
    buffer_load_dwordx4 v[48:51], v6, s[8:11], s23 offen offset:1024 sc1
    v_mfma_f32_16x16x32_bf16 v[100:103], v[236:239], v[60:63], v[100:103]
    ds_read_b64_tr_b16 v[230:231], v8 offset:1568
    s_waitcnt lgkmcnt(6)
    v_mfma_f32_16x16x32_bf16 v[104:107], v[240:243], v[56:59], v[104:107]
    ds_read_b64_tr_b16 v[232:233], v7 offset:768
    v_mfma_f32_16x16x32_bf16 v[108:111], v[240:243], v[60:63], v[108:111]
    ds_read_b64_tr_b16 v[234:235], v7 offset:1792
    s_mov_b32 s23, 0x20000
    buffer_load_dwordx4 v[52:55], v6, s[8:11], s23 offen offset:1024 sc1
    s_waitcnt lgkmcnt(6)
    v_mfma_f32_16x16x32_bf16 v[112:115], v[244:247], v[56:59], v[112:115]
    ds_read_b64_tr_b16 v[236:237], v8 offset:800
    v_mfma_f32_16x16x32_bf16 v[116:119], v[244:247], v[60:63], v[116:119]
    ds_read_b64_tr_b16 v[238:239], v8 offset:1824
    s_waitcnt lgkmcnt(6)
    v_mfma_f32_16x16x32_bf16 v[120:123], v[224:227], v[56:59], v[120:123]
    v_mfma_f32_16x16x32_bf16 v[124:127], v[224:227], v[60:63], v[124:127]
    s_barrier
    ds_read_b64_tr_b16 v[240:241], v7 offset:16384
    ds_read_b64_tr_b16 v[242:243], v7 offset:17408
    s_waitcnt lgkmcnt(6)
    v_mfma_f32_16x16x32_bf16 v[128:131], v[228:231], v[56:59], v[128:131]
    s_add_u32 s22, s24, 0x90000
    s_add_u32 m0, s20, 0x1c000
    s_nop 0
    buffer_load_dwordx4 v3, s[4:7], s22 offen lds
    ds_read_b64_tr_b16 v[244:245], v8 offset:16416
    v_mfma_f32_16x16x32_bf16 v[132:135], v[228:231], v[60:63], v[132:135]
    ds_read_b64_tr_b16 v[246:247], v8 offset:17440
    s_waitcnt lgkmcnt(6)
    v_mfma_f32_16x16x32_bf16 v[136:139], v[232:235], v[56:59], v[136:139]
    ds_read_b64_tr_b16 v[224:225], v7 offset:16640
    v_mfma_f32_16x16x32_bf16 v[140:143], v[232:235], v[60:63], v[140:143]
    s_add_u32 s22, s24, 0x92000
    s_add_u32 m0, s20, 0x1c400
    s_nop 0
    buffer_load_dwordx4 v3, s[4:7], s22 offen lds
    ds_read_b64_tr_b16 v[226:227], v7 offset:17664
    s_waitcnt lgkmcnt(6)
    v_mfma_f32_16x16x32_bf16 v[144:147], v[236:239], v[56:59], v[144:147]
    ds_read_b64_tr_b16 v[228:229], v8 offset:16672
    v_mfma_f32_16x16x32_bf16 v[148:151], v[236:239], v[60:63], v[148:151]
    ds_read_b64_tr_b16 v[230:231], v8 offset:17696
    s_waitcnt lgkmcnt(6)
    v_mfma_f32_16x16x32_bf16 v[88:91], v[240:243], v[24:27], v[88:91]
    ds_read_b64_tr_b16 v[232:233], v7 offset:16896
    v_mfma_f32_16x16x32_bf16 v[92:95], v[240:243], v[28:31], v[92:95]
    ds_read_b64_tr_b16 v[234:235], v7 offset:17920
    s_waitcnt lgkmcnt(6)
    v_mfma_f32_16x16x32_bf16 v[96:99], v[244:247], v[24:27], v[96:99]
    ds_read_b64_tr_b16 v[236:237], v8 offset:16928
    s_mov_b32 s23, 0x2000
    buffer_load_dwordx4 v[56:59], v6, s[8:11], s23 offen offset:1024 sc1
    v_mfma_f32_16x16x32_bf16 v[100:103], v[244:247], v[28:31], v[100:103]
    ds_read_b64_tr_b16 v[238:239], v8 offset:17952
    s_waitcnt lgkmcnt(6)
    v_mfma_f32_16x16x32_bf16 v[104:107], v[224:227], v[24:27], v[104:107]
    ds_read_b64_tr_b16 v[240:241], v7 offset:17152
    v_mfma_f32_16x16x32_bf16 v[108:111], v[224:227], v[28:31], v[108:111]
    ds_read_b64_tr_b16 v[242:243], v7 offset:18176
    s_mov_b32 s23, 0x22000
    buffer_load_dwordx4 v[60:63], v6, s[8:11], s23 offen offset:1024 sc1
    s_waitcnt lgkmcnt(6)
    v_mfma_f32_16x16x32_bf16 v[112:115], v[228:231], v[24:27], v[112:115]
    ds_read_b64_tr_b16 v[244:245], v8 offset:17184
    v_mfma_f32_16x16x32_bf16 v[116:119], v[228:231], v[28:31], v[116:119]
    ds_read_b64_tr_b16 v[246:247], v8 offset:18208
    s_waitcnt lgkmcnt(6)
    v_mfma_f32_16x16x32_bf16 v[120:123], v[232:235], v[24:27], v[120:123]
    v_mfma_f32_16x16x32_bf16 v[124:127], v[232:235], v[28:31], v[124:127]
    s_barrier
    ds_read_b64_tr_b16 v[224:225], v4 offset:0
    ds_read_b64_tr_b16 v[226:227], v4 offset:1024
    s_waitcnt lgkmcnt(6)
    v_mfma_f32_16x16x32_bf16 v[128:131], v[236:239], v[24:27], v[128:131]
    s_add_u32 s16, s63, 0x576000
    v_mov_b32 v14, s28
    v_mov_b32 v15, 0
    s_mov_b64 exec, 1
    buffer_store_dword v14, v15, s[8:11], s16 offen sc1
    s_mov_b64 exec, -1
    s_add_u32 s22, s24, 0x110000
    s_add_u32 m0, s20, 0x20000
    s_nop 0
    buffer_load_dwordx4 v3, s[4:7], s22 offen lds
    ds_read_b64_tr_b16 v[228:229], v5 offset:32
    v_mfma_f32_16x16x32_bf16 v[132:135], v[236:239], v[28:31], v[132:135]
    ds_read_b64_tr_b16 v[230:231], v5 offset:1056
    s_waitcnt lgkmcnt(6)
    v_mfma_f32_16x16x32_bf16 v[136:139], v[240:243], v[24:27], v[136:139]
    ds_read_b64_tr_b16 v[232:233], v4 offset:256
    v_mfma_f32_16x16x32_bf16 v[140:143], v[240:243], v[28:31], v[140:143]
    s_add_u32 s22, s24, 0x112000
    s_add_u32 m0, s20, 0x20400
    s_nop 0
    buffer_load_dwordx4 v3, s[4:7], s22 offen lds
    ds_read_b64_tr_b16 v[234:235], v4 offset:1280
    s_waitcnt lgkmcnt(6)
    v_mfma_f32_16x16x32_bf16 v[144:147], v[244:247], v[24:27], v[144:147]
    ds_read_b64_tr_b16 v[236:237], v5 offset:288
    v_mfma_f32_16x16x32_bf16 v[148:151], v[244:247], v[28:31], v[148:151]
    ds_read_b64_tr_b16 v[238:239], v5 offset:1312
    s_waitcnt lgkmcnt(6)
    v_mfma_f32_16x16x32_bf16 v[88:91], v[224:227], v[32:35], v[88:91]
    ds_read_b64_tr_b16 v[240:241], v4 offset:512
    v_mfma_f32_16x16x32_bf16 v[92:95], v[224:227], v[36:39], v[92:95]
    ds_read_b64_tr_b16 v[242:243], v4 offset:1536
    s_waitcnt lgkmcnt(6)
    v_mfma_f32_16x16x32_bf16 v[96:99], v[228:231], v[32:35], v[96:99]
    ds_read_b64_tr_b16 v[244:245], v5 offset:544
    s_mov_b32 s23, 0x4000
    buffer_load_dwordx4 v[24:27], v6, s[8:11], s23 offen offset:1024 sc1
    v_mfma_f32_16x16x32_bf16 v[100:103], v[228:231], v[36:39], v[100:103]
    ds_read_b64_tr_b16 v[246:247], v5 offset:1568
    s_waitcnt lgkmcnt(6)
    v_mfma_f32_16x16x32_bf16 v[104:107], v[232:235], v[32:35], v[104:107]
    ds_read_b64_tr_b16 v[224:225], v4 offset:768
    v_mfma_f32_16x16x32_bf16 v[108:111], v[232:235], v[36:39], v[108:111]
    ds_read_b64_tr_b16 v[226:227], v4 offset:1792
    s_mov_b32 s23, 0x24000
    buffer_load_dwordx4 v[28:31], v6, s[8:11], s23 offen offset:1024 sc1
    s_waitcnt lgkmcnt(6)
    v_mfma_f32_16x16x32_bf16 v[112:115], v[236:239], v[32:35], v[112:115]
    ds_read_b64_tr_b16 v[228:229], v5 offset:800
    v_mfma_f32_16x16x32_bf16 v[116:119], v[236:239], v[36:39], v[116:119]
    ds_read_b64_tr_b16 v[230:231], v5 offset:1824
    s_waitcnt lgkmcnt(6)
    v_mfma_f32_16x16x32_bf16 v[120:123], v[240:243], v[32:35], v[120:123]
    v_mfma_f32_16x16x32_bf16 v[124:127], v[240:243], v[36:39], v[124:127]
    s_waitcnt vmcnt(15)
    s_barrier
    ds_read_b64_tr_b16 v[232:233], v4 offset:16384
    ds_read_b64_tr_b16 v[234:235], v4 offset:17408
    s_waitcnt lgkmcnt(6)
    v_mfma_f32_16x16x32_bf16 v[128:131], v[244:247], v[32:35], v[128:131]
    s_add_u32 s22, s24, 0x190000
    s_add_u32 m0, s20, 0x24000
    s_nop 0
    buffer_load_dwordx4 v3, s[4:7], s22 offen lds
    ds_read_b64_tr_b16 v[236:237], v5 offset:16416
    v_mfma_f32_16x16x32_bf16 v[132:135], v[244:247], v[36:39], v[132:135]
    ds_read_b64_tr_b16 v[238:239], v5 offset:17440
    s_waitcnt lgkmcnt(6)
    v_mfma_f32_16x16x32_bf16 v[136:139], v[224:227], v[32:35], v[136:139]
    ds_read_b64_tr_b16 v[240:241], v4 offset:16640
    v_mfma_f32_16x16x32_bf16 v[140:143], v[224:227], v[36:39], v[140:143]
    s_add_u32 s22, s24, 0x192000
    s_add_u32 m0, s20, 0x24400
    s_nop 0
    buffer_load_dwordx4 v3, s[4:7], s22 offen lds
    ds_read_b64_tr_b16 v[242:243], v4 offset:17664
    s_waitcnt lgkmcnt(6)
    v_mfma_f32_16x16x32_bf16 v[144:147], v[228:231], v[32:35], v[144:147]
    ds_read_b64_tr_b16 v[244:245], v5 offset:16672
    v_mfma_f32_16x16x32_bf16 v[148:151], v[228:231], v[36:39], v[148:151]
    ds_read_b64_tr_b16 v[246:247], v5 offset:17696
    s_waitcnt vmcnt(16) lgkmcnt(6)
    v_mfma_f32_16x16x32_bf16 v[88:91], v[232:235], v[40:43], v[88:91]
    ds_read_b64_tr_b16 v[224:225], v4 offset:16896
    s_waitcnt vmcnt(15)
    v_mfma_f32_16x16x32_bf16 v[92:95], v[232:235], v[44:47], v[92:95]
    ds_read_b64_tr_b16 v[226:227], v4 offset:17920
    s_waitcnt lgkmcnt(6)
    v_mfma_f32_16x16x32_bf16 v[96:99], v[236:239], v[40:43], v[96:99]
    ds_read_b64_tr_b16 v[228:229], v5 offset:16928
    s_mov_b32 s23, 0x6000
    buffer_load_dwordx4 v[32:35], v6, s[8:11], s23 offen offset:1024 sc1
    v_mfma_f32_16x16x32_bf16 v[100:103], v[236:239], v[44:47], v[100:103]
    ds_read_b64_tr_b16 v[230:231], v5 offset:17952
    s_waitcnt lgkmcnt(6)
    v_mfma_f32_16x16x32_bf16 v[104:107], v[240:243], v[40:43], v[104:107]
    ds_read_b64_tr_b16 v[232:233], v4 offset:17152
    v_mfma_f32_16x16x32_bf16 v[108:111], v[240:243], v[44:47], v[108:111]
    ds_read_b64_tr_b16 v[234:235], v4 offset:18176
    s_mov_b32 s23, 0x26000
    buffer_load_dwordx4 v[36:39], v6, s[8:11], s23 offen offset:1024 sc1
    s_waitcnt lgkmcnt(6)
    v_mfma_f32_16x16x32_bf16 v[112:115], v[244:247], v[40:43], v[112:115]
    ds_read_b64_tr_b16 v[236:237], v5 offset:17184
    v_mfma_f32_16x16x32_bf16 v[116:119], v[244:247], v[44:47], v[116:119]
    ds_read_b64_tr_b16 v[238:239], v5 offset:18208
    s_waitcnt lgkmcnt(6)
    v_mfma_f32_16x16x32_bf16 v[120:123], v[224:227], v[40:43], v[120:123]
    v_mfma_f32_16x16x32_bf16 v[124:127], v[224:227], v[44:47], v[124:127]
    s_waitcnt vmcnt(15)
    s_barrier
    ds_read_b64_tr_b16 v[240:241], v4 offset:32768
    ds_read_b64_tr_b16 v[242:243], v4 offset:33792
    s_waitcnt lgkmcnt(6)
    v_mfma_f32_16x16x32_bf16 v[128:131], v[228:231], v[40:43], v[128:131]
    s_add_u32 s22, s24, 0x210000
    s_add_u32 m0, s20, 0x10000
    s_nop 0
    buffer_load_dwordx4 v3, s[4:7], s22 offen lds
    ds_read_b64_tr_b16 v[244:245], v5 offset:32800
    v_mfma_f32_16x16x32_bf16 v[132:135], v[228:231], v[44:47], v[132:135]
    ds_read_b64_tr_b16 v[246:247], v5 offset:33824
    s_waitcnt lgkmcnt(6)
    v_mfma_f32_16x16x32_bf16 v[136:139], v[232:235], v[40:43], v[136:139]
    ds_read_b64_tr_b16 v[224:225], v4 offset:33024
    v_mfma_f32_16x16x32_bf16 v[140:143], v[232:235], v[44:47], v[140:143]
    s_add_u32 s22, s24, 0x212000
    s_add_u32 m0, s20, 0x10400
    s_nop 0
    buffer_load_dwordx4 v3, s[4:7], s22 offen lds
    ds_read_b64_tr_b16 v[226:227], v4 offset:34048
    s_waitcnt lgkmcnt(6)
    v_mfma_f32_16x16x32_bf16 v[144:147], v[236:239], v[40:43], v[144:147]
    ds_read_b64_tr_b16 v[228:229], v5 offset:33056
    v_mfma_f32_16x16x32_bf16 v[148:151], v[236:239], v[44:47], v[148:151]
    ds_read_b64_tr_b16 v[230:231], v5 offset:34080
    s_waitcnt vmcnt(16) lgkmcnt(6)
    v_mfma_f32_16x16x32_bf16 v[88:91], v[240:243], v[48:51], v[88:91]
    ds_read_b64_tr_b16 v[232:233], v4 offset:33280
    s_waitcnt vmcnt(15)
    v_mfma_f32_16x16x32_bf16 v[92:95], v[240:243], v[52:55], v[92:95]
    ds_read_b64_tr_b16 v[234:235], v4 offset:34304
    s_waitcnt lgkmcnt(6)
    v_mfma_f32_16x16x32_bf16 v[96:99], v[244:247], v[48:51], v[96:99]
    ds_read_b64_tr_b16 v[236:237], v5 offset:33312
    s_mov_b32 s23, 0x8000
    buffer_load_dwordx4 v[40:43], v6, s[8:11], s23 offen offset:1024 sc1
    v_mfma_f32_16x16x32_bf16 v[100:103], v[244:247], v[52:55], v[100:103]
    ds_read_b64_tr_b16 v[238:239], v5 offset:34336
    s_waitcnt lgkmcnt(6)
    v_mfma_f32_16x16x32_bf16 v[104:107], v[224:227], v[48:51], v[104:107]
    ds_read_b64_tr_b16 v[240:241], v4 offset:33536
    v_mfma_f32_16x16x32_bf16 v[108:111], v[224:227], v[52:55], v[108:111]
    ds_read_b64_tr_b16 v[242:243], v4 offset:34560
    s_mov_b32 s23, 0x28000
    buffer_load_dwordx4 v[44:47], v6, s[8:11], s23 offen offset:1024 sc1
    s_waitcnt lgkmcnt(6)
    v_mfma_f32_16x16x32_bf16 v[112:115], v[228:231], v[48:51], v[112:115]
    ds_read_b64_tr_b16 v[244:245], v5 offset:33568
    v_mfma_f32_16x16x32_bf16 v[116:119], v[228:231], v[52:55], v[116:119]
    ds_read_b64_tr_b16 v[246:247], v5 offset:34592
    s_waitcnt lgkmcnt(6)
    v_mfma_f32_16x16x32_bf16 v[120:123], v[232:235], v[48:51], v[120:123]
    v_mfma_f32_16x16x32_bf16 v[124:127], v[232:235], v[52:55], v[124:127]
    s_waitcnt vmcnt(15)
    s_barrier
    ds_read_b64_tr_b16 v[224:225], v4 offset:49152
    ds_read_b64_tr_b16 v[226:227], v4 offset:50176
    s_waitcnt lgkmcnt(6)
    v_mfma_f32_16x16x32_bf16 v[128:131], v[236:239], v[48:51], v[128:131]
    s_add_u32 s22, s24, 0x290000
    s_add_u32 m0, s20, 0x14000
    s_nop 0
    buffer_load_dwordx4 v3, s[4:7], s22 offen lds
    ds_read_b64_tr_b16 v[228:229], v5 offset:49184
    v_mfma_f32_16x16x32_bf16 v[132:135], v[236:239], v[52:55], v[132:135]
    ds_read_b64_tr_b16 v[230:231], v5 offset:50208
    s_waitcnt lgkmcnt(6)
    v_mfma_f32_16x16x32_bf16 v[136:139], v[240:243], v[48:51], v[136:139]
    ds_read_b64_tr_b16 v[232:233], v4 offset:49408
    v_mfma_f32_16x16x32_bf16 v[140:143], v[240:243], v[52:55], v[140:143]
    s_add_u32 s22, s24, 0x292000
    s_add_u32 m0, s20, 0x14400
    s_nop 0
    buffer_load_dwordx4 v3, s[4:7], s22 offen lds
    ds_read_b64_tr_b16 v[234:235], v4 offset:50432
    s_waitcnt lgkmcnt(6)
    v_mfma_f32_16x16x32_bf16 v[144:147], v[244:247], v[48:51], v[144:147]
    ds_read_b64_tr_b16 v[236:237], v5 offset:49440
    v_mfma_f32_16x16x32_bf16 v[148:151], v[244:247], v[52:55], v[148:151]
    ds_read_b64_tr_b16 v[238:239], v5 offset:50464
    s_waitcnt vmcnt(16) lgkmcnt(6)
    v_mfma_f32_16x16x32_bf16 v[88:91], v[224:227], v[56:59], v[88:91]
    ds_read_b64_tr_b16 v[240:241], v4 offset:49664
    s_waitcnt vmcnt(15)
    v_mfma_f32_16x16x32_bf16 v[92:95], v[224:227], v[60:63], v[92:95]
    ds_read_b64_tr_b16 v[242:243], v4 offset:50688
    s_waitcnt lgkmcnt(6)
    v_mfma_f32_16x16x32_bf16 v[96:99], v[228:231], v[56:59], v[96:99]
    ds_read_b64_tr_b16 v[244:245], v5 offset:49696
    s_mov_b32 s23, 0xa000
    buffer_load_dwordx4 v[48:51], v6, s[8:11], s23 offen offset:1024 sc1
    v_mfma_f32_16x16x32_bf16 v[100:103], v[228:231], v[60:63], v[100:103]
    ds_read_b64_tr_b16 v[246:247], v5 offset:50720
    s_waitcnt lgkmcnt(6)
    v_mfma_f32_16x16x32_bf16 v[104:107], v[232:235], v[56:59], v[104:107]
    ds_read_b64_tr_b16 v[224:225], v4 offset:49920
    v_mfma_f32_16x16x32_bf16 v[108:111], v[232:235], v[60:63], v[108:111]
    ds_read_b64_tr_b16 v[226:227], v4 offset:50944
    s_mov_b32 s23, 0x2a000
    buffer_load_dwordx4 v[52:55], v6, s[8:11], s23 offen offset:1024 sc1
    s_waitcnt lgkmcnt(6)
    v_mfma_f32_16x16x32_bf16 v[112:115], v[236:239], v[56:59], v[112:115]
    ds_read_b64_tr_b16 v[228:229], v5 offset:49952
    v_mfma_f32_16x16x32_bf16 v[116:119], v[236:239], v[60:63], v[116:119]
    ds_read_b64_tr_b16 v[230:231], v5 offset:50976
    s_waitcnt lgkmcnt(6)
    v_mfma_f32_16x16x32_bf16 v[120:123], v[240:243], v[56:59], v[120:123]
    v_mfma_f32_16x16x32_bf16 v[124:127], v[240:243], v[60:63], v[124:127]
    s_waitcnt vmcnt(14)
    s_barrier
    ds_read_b64_tr_b16 v[232:233], v7 offset:0
    ds_read_b64_tr_b16 v[234:235], v7 offset:1024
    s_waitcnt lgkmcnt(6)
    v_mfma_f32_16x16x32_bf16 v[128:131], v[244:247], v[56:59], v[128:131]
    s_add_u32 s22, s24, 0x310000
    s_add_u32 m0, s20, 0x18000
    s_nop 0
    buffer_load_dwordx4 v3, s[4:7], s22 offen lds
    ds_read_b64_tr_b16 v[236:237], v8 offset:32
    v_mfma_f32_16x16x32_bf16 v[132:135], v[244:247], v[60:63], v[132:135]
    ds_read_b64_tr_b16 v[238:239], v8 offset:1056
    s_waitcnt lgkmcnt(6)
    v_mfma_f32_16x16x32_bf16 v[136:139], v[224:227], v[56:59], v[136:139]
    ds_read_b64_tr_b16 v[240:241], v7 offset:256
    v_mfma_f32_16x16x32_bf16 v[140:143], v[224:227], v[60:63], v[140:143]
    s_add_u32 s22, s24, 0x312000
    s_add_u32 m0, s20, 0x18400
    s_nop 0
    buffer_load_dwordx4 v3, s[4:7], s22 offen lds
    ds_read_b64_tr_b16 v[242:243], v7 offset:1280
    s_waitcnt lgkmcnt(6)
    v_mfma_f32_16x16x32_bf16 v[144:147], v[228:231], v[56:59], v[144:147]
    ds_read_b64_tr_b16 v[244:245], v8 offset:288
    v_mfma_f32_16x16x32_bf16 v[148:151], v[228:231], v[60:63], v[148:151]
    ds_read_b64_tr_b16 v[246:247], v8 offset:1312
    s_waitcnt vmcnt(15) lgkmcnt(6)
    v_mfma_f32_16x16x32_bf16 v[88:91], v[232:235], v[24:27], v[88:91]
    ds_read_b64_tr_b16 v[224:225], v7 offset:512
    s_waitcnt vmcnt(14)
    v_mfma_f32_16x16x32_bf16 v[92:95], v[232:235], v[28:31], v[92:95]
    ds_read_b64_tr_b16 v[226:227], v7 offset:1536
    s_waitcnt lgkmcnt(6)
    v_mfma_f32_16x16x32_bf16 v[96:99], v[236:239], v[24:27], v[96:99]
    ds_read_b64_tr_b16 v[228:229], v8 offset:544
    s_mov_b32 s23, 0xc000
    buffer_load_dwordx4 v[56:59], v6, s[8:11], s23 offen offset:1024 sc1
    v_mfma_f32_16x16x32_bf16 v[100:103], v[236:239], v[28:31], v[100:103]
    ds_read_b64_tr_b16 v[230:231], v8 offset:1568
    s_waitcnt lgkmcnt(6)
    v_mfma_f32_16x16x32_bf16 v[104:107], v[240:243], v[24:27], v[104:107]
    ds_read_b64_tr_b16 v[232:233], v7 offset:768
    v_mfma_f32_16x16x32_bf16 v[108:111], v[240:243], v[28:31], v[108:111]
    ds_read_b64_tr_b16 v[234:235], v7 offset:1792
    s_mov_b32 s23, 0x2c000
    buffer_load_dwordx4 v[60:63], v6, s[8:11], s23 offen offset:1024 sc1
    s_waitcnt lgkmcnt(6)
    v_mfma_f32_16x16x32_bf16 v[112:115], v[244:247], v[24:27], v[112:115]
    ds_read_b64_tr_b16 v[236:237], v8 offset:800
    v_mfma_f32_16x16x32_bf16 v[116:119], v[244:247], v[28:31], v[116:119]
    ds_read_b64_tr_b16 v[238:239], v8 offset:1824
    s_waitcnt lgkmcnt(6)
    v_mfma_f32_16x16x32_bf16 v[120:123], v[224:227], v[24:27], v[120:123]
    v_mfma_f32_16x16x32_bf16 v[124:127], v[224:227], v[28:31], v[124:127]
    s_waitcnt vmcnt(14)
    s_barrier
    ds_read_b64_tr_b16 v[240:241], v7 offset:16384
    ds_read_b64_tr_b16 v[242:243], v7 offset:17408
    s_add_u32 s19, s19, 8192
    buffer_load_dword v12, v13, s[8:11], s19 offen sc1
    s_waitcnt lgkmcnt(6)
    v_mfma_f32_16x16x32_bf16 v[128:131], v[228:231], v[24:27], v[128:131]
    s_add_u32 s22, s24, 0x390000
    s_add_u32 m0, s20, 0x1c000
    s_nop 0
    buffer_load_dwordx4 v3, s[4:7], s22 offen lds
    ds_read_b64_tr_b16 v[244:245], v8 offset:16416
    v_mfma_f32_16x16x32_bf16 v[132:135], v[228:231], v[28:31], v[132:135]
    ds_read_b64_tr_b16 v[246:247], v8 offset:17440
    s_waitcnt lgkmcnt(6)
    v_mfma_f32_16x16x32_bf16 v[136:139], v[232:235], v[24:27], v[136:139]
    ds_read_b64_tr_b16 v[224:225], v7 offset:16640
    v_mfma_f32_16x16x32_bf16 v[140:143], v[232:235], v[28:31], v[140:143]
    s_add_u32 s22, s24, 0x392000
    s_add_u32 m0, s20, 0x1c400
    s_nop 0
    buffer_load_dwordx4 v3, s[4:7], s22 offen lds
    ds_read_b64_tr_b16 v[226:227], v7 offset:17664
    s_waitcnt lgkmcnt(6)
    v_mfma_f32_16x16x32_bf16 v[144:147], v[236:239], v[24:27], v[144:147]
    ds_read_b64_tr_b16 v[228:229], v8 offset:16672
    v_mfma_f32_16x16x32_bf16 v[148:151], v[236:239], v[28:31], v[148:151]
    ds_read_b64_tr_b16 v[230:231], v8 offset:17696
    s_waitcnt vmcnt(16) lgkmcnt(6)
    v_mfma_f32_16x16x32_bf16 v[88:91], v[240:243], v[32:35], v[88:91]
    ds_read_b64_tr_b16 v[232:233], v7 offset:16896
    s_waitcnt vmcnt(15)
    v_mfma_f32_16x16x32_bf16 v[92:95], v[240:243], v[36:39], v[92:95]
    ds_read_b64_tr_b16 v[234:235], v7 offset:17920
    s_waitcnt lgkmcnt(6)
    v_mfma_f32_16x16x32_bf16 v[96:99], v[244:247], v[32:35], v[96:99]
    ds_read_b64_tr_b16 v[236:237], v8 offset:16928
    s_mov_b32 s23, 0xe000
    buffer_load_dwordx4 v[24:27], v6, s[8:11], s23 offen offset:1024 sc1
    v_mfma_f32_16x16x32_bf16 v[100:103], v[244:247], v[36:39], v[100:103]
    ds_read_b64_tr_b16 v[238:239], v8 offset:17952
    s_waitcnt lgkmcnt(6)
    v_mfma_f32_16x16x32_bf16 v[104:107], v[224:227], v[32:35], v[104:107]
    ds_read_b64_tr_b16 v[240:241], v7 offset:17152
    v_mfma_f32_16x16x32_bf16 v[108:111], v[224:227], v[36:39], v[108:111]
    ds_read_b64_tr_b16 v[242:243], v7 offset:18176
    s_mov_b32 s23, 0x2e000
    buffer_load_dwordx4 v[28:31], v6, s[8:11], s23 offen offset:1024 sc1
    s_waitcnt lgkmcnt(6)
    v_mfma_f32_16x16x32_bf16 v[112:115], v[228:231], v[32:35], v[112:115]
    ds_read_b64_tr_b16 v[244:245], v8 offset:17184
    v_mfma_f32_16x16x32_bf16 v[116:119], v[228:231], v[36:39], v[116:119]
    ds_read_b64_tr_b16 v[246:247], v8 offset:18208
    s_waitcnt lgkmcnt(6)
    v_mfma_f32_16x16x32_bf16 v[120:123], v[232:235], v[32:35], v[120:123]
    v_mfma_f32_16x16x32_bf16 v[124:127], v[232:235], v[36:39], v[124:127]
    s_waitcnt vmcnt(15)
    s_barrier
    ds_read_b64_tr_b16 v[224:225], v4 offset:0
    ds_read_b64_tr_b16 v[226:227], v4 offset:1024
    s_waitcnt lgkmcnt(6)
    v_mfma_f32_16x16x32_bf16 v[128:131], v[236:239], v[32:35], v[128:131]
    s_add_u32 s22, s24, 0x20000
    s_add_u32 m0, s20, 0x20000
    s_nop 0
    buffer_load_dwordx4 v3, s[4:7], s22 offen lds
    ds_read_b64_tr_b16 v[228:229], v5 offset:32
    v_mfma_f32_16x16x32_bf16 v[132:135], v[236:239], v[36:39], v[132:135]
    ds_read_b64_tr_b16 v[230:231], v5 offset:1056
    s_waitcnt lgkmcnt(6)
    v_mfma_f32_16x16x32_bf16 v[136:139], v[240:243], v[32:35], v[136:139]
    ds_read_b64_tr_b16 v[232:233], v4 offset:256
    v_mfma_f32_16x16x32_bf16 v[140:143], v[240:243], v[36:39], v[140:143]
    s_add_u32 s22, s24, 0x22000
    s_add_u32 m0, s20, 0x20400
    s_nop 0
    buffer_load_dwordx4 v3, s[4:7], s22 offen lds
    ds_read_b64_tr_b16 v[234:235], v4 offset:1280
    s_waitcnt lgkmcnt(6)
    v_mfma_f32_16x16x32_bf16 v[144:147], v[244:247], v[32:35], v[144:147]
    ds_read_b64_tr_b16 v[236:237], v5 offset:288
    v_mfma_f32_16x16x32_bf16 v[148:151], v[244:247], v[36:39], v[148:151]
    ds_read_b64_tr_b16 v[238:239], v5 offset:1312
    s_waitcnt vmcnt(6)
    v_cmp_ne_u32 vcc, s28, v12
    s_cbranch_vccnz adaLN_cond__sliding_block_cached__moe_arch_mod__prompt_kernel_o28r
adaLN_cond__sliding_block_cached__moe_arch_mod__prompt_kernel_o28b:
    s_waitcnt lgkmcnt(6)
    v_mfma_f32_16x16x32_bf16 v[88:91], v[224:227], v[40:43], v[88:91]
    ds_read_b64_tr_b16 v[240:241], v4 offset:512
    v_mfma_f32_16x16x32_bf16 v[92:95], v[224:227], v[44:47], v[92:95]
    ds_read_b64_tr_b16 v[242:243], v4 offset:1536
    s_waitcnt lgkmcnt(6)
    v_mfma_f32_16x16x32_bf16 v[96:99], v[228:231], v[40:43], v[96:99]
    ds_read_b64_tr_b16 v[244:245], v5 offset:544
    s_mov_b32 s23, 0x0
    buffer_load_dwordx4 v[32:35], v6, s[8:11], s23 offen offset:2048 sc1
    v_mfma_f32_16x16x32_bf16 v[100:103], v[228:231], v[44:47], v[100:103]
    ds_read_b64_tr_b16 v[246:247], v5 offset:1568
    s_waitcnt lgkmcnt(6)
    v_mfma_f32_16x16x32_bf16 v[104:107], v[232:235], v[40:43], v[104:107]
    ds_read_b64_tr_b16 v[224:225], v4 offset:768
    v_mfma_f32_16x16x32_bf16 v[108:111], v[232:235], v[44:47], v[108:111]
    ds_read_b64_tr_b16 v[226:227], v4 offset:1792
    s_mov_b32 s23, 0x20000
    buffer_load_dwordx4 v[36:39], v6, s[8:11], s23 offen offset:2048 sc1
    s_waitcnt lgkmcnt(6)
    v_mfma_f32_16x16x32_bf16 v[112:115], v[236:239], v[40:43], v[112:115]
    ds_read_b64_tr_b16 v[228:229], v5 offset:800
    v_mfma_f32_16x16x32_bf16 v[116:119], v[236:239], v[44:47], v[116:119]
    ds_read_b64_tr_b16 v[230:231], v5 offset:1824
    s_waitcnt lgkmcnt(6)
    v_mfma_f32_16x16x32_bf16 v[120:123], v[240:243], v[40:43], v[120:123]
    v_mfma_f32_16x16x32_bf16 v[124:127], v[240:243], v[44:47], v[124:127]
    s_barrier
    ds_read_b64_tr_b16 v[232:233], v4 offset:16384
    ds_read_b64_tr_b16 v[234:235], v4 offset:17408
    s_waitcnt lgkmcnt(6)
    v_mfma_f32_16x16x32_bf16 v[128:131], v[244:247], v[40:43], v[128:131]
    s_add_u32 s22, s24, 0xa0000
    s_add_u32 m0, s20, 0x24000
    s_nop 0
    buffer_load_dwordx4 v3, s[4:7], s22 offen lds
    ds_read_b64_tr_b16 v[236:237], v5 offset:16416
    v_mfma_f32_16x16x32_bf16 v[132:135], v[244:247], v[44:47], v[132:135]
    ds_read_b64_tr_b16 v[238:239], v5 offset:17440
    s_waitcnt lgkmcnt(6)
    v_mfma_f32_16x16x32_bf16 v[136:139], v[224:227], v[40:43], v[136:139]
    ds_read_b64_tr_b16 v[240:241], v4 offset:16640
    v_mfma_f32_16x16x32_bf16 v[140:143], v[224:227], v[44:47], v[140:143]
    s_add_u32 s22, s24, 0xa2000
    s_add_u32 m0, s20, 0x24400
    s_nop 0
    buffer_load_dwordx4 v3, s[4:7], s22 offen lds
    ds_read_b64_tr_b16 v[242:243], v4 offset:17664
    s_waitcnt lgkmcnt(6)
    v_mfma_f32_16x16x32_bf16 v[144:147], v[228:231], v[40:43], v[144:147]
    ds_read_b64_tr_b16 v[244:245], v5 offset:16672
    v_mfma_f32_16x16x32_bf16 v[148:151], v[228:231], v[44:47], v[148:151]
    ds_read_b64_tr_b16 v[246:247], v5 offset:17696
    s_waitcnt lgkmcnt(6)
    v_mfma_f32_16x16x32_bf16 v[88:91], v[232:235], v[48:51], v[88:91]
    ds_read_b64_tr_b16 v[224:225], v4 offset:16896
    v_mfma_f32_16x16x32_bf16 v[92:95], v[232:235], v[52:55], v[92:95]
    ds_read_b64_tr_b16 v[226:227], v4 offset:17920
    s_waitcnt lgkmcnt(6)
    v_mfma_f32_16x16x32_bf16 v[96:99], v[236:239], v[48:51], v[96:99]
    ds_read_b64_tr_b16 v[228:229], v5 offset:16928
    s_mov_b32 s23, 0x2000
    buffer_load_dwordx4 v[40:43], v6, s[8:11], s23 offen offset:2048 sc1
    v_mfma_f32_16x16x32_bf16 v[100:103], v[236:239], v[52:55], v[100:103]
    ds_read_b64_tr_b16 v[230:231], v5 offset:17952
    s_waitcnt lgkmcnt(6)
    v_mfma_f32_16x16x32_bf16 v[104:107], v[240:243], v[48:51], v[104:107]
    ds_read_b64_tr_b16 v[232:233], v4 offset:17152
    v_mfma_f32_16x16x32_bf16 v[108:111], v[240:243], v[52:55], v[108:111]
    ds_read_b64_tr_b16 v[234:235], v4 offset:18176
    s_mov_b32 s23, 0x22000
    buffer_load_dwordx4 v[44:47], v6, s[8:11], s23 offen offset:2048 sc1
    s_waitcnt lgkmcnt(6)
    v_mfma_f32_16x16x32_bf16 v[112:115], v[244:247], v[48:51], v[112:115]
    ds_read_b64_tr_b16 v[236:237], v5 offset:17184
    v_mfma_f32_16x16x32_bf16 v[116:119], v[244:247], v[52:55], v[116:119]
    ds_read_b64_tr_b16 v[238:239], v5 offset:18208
    s_waitcnt lgkmcnt(6)
    v_mfma_f32_16x16x32_bf16 v[120:123], v[224:227], v[48:51], v[120:123]
    v_mfma_f32_16x16x32_bf16 v[124:127], v[224:227], v[52:55], v[124:127]
    s_barrier
    ds_read_b64_tr_b16 v[240:241], v4 offset:32768
    ds_read_b64_tr_b16 v[242:243], v4 offset:33792
    s_waitcnt lgkmcnt(6)
    v_mfma_f32_16x16x32_bf16 v[128:131], v[228:231], v[48:51], v[128:131]
    s_add_u32 s22, s24, 0x120000
    s_add_u32 m0, s20, 0x10000
    s_nop 0
    buffer_load_dwordx4 v3, s[4:7], s22 offen lds
    ds_read_b64_tr_b16 v[244:245], v5 offset:32800
    v_mfma_f32_16x16x32_bf16 v[132:135], v[228:231], v[52:55], v[132:135]
    ds_read_b64_tr_b16 v[246:247], v5 offset:33824
    s_waitcnt lgkmcnt(6)
    v_mfma_f32_16x16x32_bf16 v[136:139], v[232:235], v[48:51], v[136:139]
    ds_read_b64_tr_b16 v[224:225], v4 offset:33024
    v_mfma_f32_16x16x32_bf16 v[140:143], v[232:235], v[52:55], v[140:143]
    s_add_u32 s22, s24, 0x122000
    s_add_u32 m0, s20, 0x10400
    s_nop 0
    buffer_load_dwordx4 v3, s[4:7], s22 offen lds
    ds_read_b64_tr_b16 v[226:227], v4 offset:34048
    s_waitcnt lgkmcnt(6)
    v_mfma_f32_16x16x32_bf16 v[144:147], v[236:239], v[48:51], v[144:147]
    ds_read_b64_tr_b16 v[228:229], v5 offset:33056
    v_mfma_f32_16x16x32_bf16 v[148:151], v[236:239], v[52:55], v[148:151]
    ds_read_b64_tr_b16 v[230:231], v5 offset:34080
    s_waitcnt lgkmcnt(6)
    v_mfma_f32_16x16x32_bf16 v[88:91], v[240:243], v[56:59], v[88:91]
    ds_read_b64_tr_b16 v[232:233], v4 offset:33280
    v_mfma_f32_16x16x32_bf16 v[92:95], v[240:243], v[60:63], v[92:95]
    ds_read_b64_tr_b16 v[234:235], v4 offset:34304
    s_waitcnt lgkmcnt(6)
    v_mfma_f32_16x16x32_bf16 v[96:99], v[244:247], v[56:59], v[96:99]
    ds_read_b64_tr_b16 v[236:237], v5 offset:33312
    s_mov_b32 s23, 0x4000
    buffer_load_dwordx4 v[48:51], v6, s[8:11], s23 offen offset:2048 sc1
    v_mfma_f32_16x16x32_bf16 v[100:103], v[244:247], v[60:63], v[100:103]
    ds_read_b64_tr_b16 v[238:239], v5 offset:34336
    s_waitcnt lgkmcnt(6)
    v_mfma_f32_16x16x32_bf16 v[104:107], v[224:227], v[56:59], v[104:107]
    ds_read_b64_tr_b16 v[240:241], v4 offset:33536
    v_mfma_f32_16x16x32_bf16 v[108:111], v[224:227], v[60:63], v[108:111]
    ds_read_b64_tr_b16 v[242:243], v4 offset:34560
    s_mov_b32 s23, 0x24000
    buffer_load_dwordx4 v[52:55], v6, s[8:11], s23 offen offset:2048 sc1
    s_waitcnt lgkmcnt(6)
    v_mfma_f32_16x16x32_bf16 v[112:115], v[228:231], v[56:59], v[112:115]
    ds_read_b64_tr_b16 v[244:245], v5 offset:33568
    v_mfma_f32_16x16x32_bf16 v[116:119], v[228:231], v[60:63], v[116:119]
    ds_read_b64_tr_b16 v[246:247], v5 offset:34592
    s_waitcnt lgkmcnt(6)
    v_mfma_f32_16x16x32_bf16 v[120:123], v[232:235], v[56:59], v[120:123]
    v_mfma_f32_16x16x32_bf16 v[124:127], v[232:235], v[60:63], v[124:127]
    s_waitcnt vmcnt(14)
    s_barrier
    ds_read_b64_tr_b16 v[224:225], v4 offset:49152
    ds_read_b64_tr_b16 v[226:227], v4 offset:50176
    s_waitcnt lgkmcnt(6)
    v_mfma_f32_16x16x32_bf16 v[128:131], v[236:239], v[56:59], v[128:131]
    s_add_u32 s22, s24, 0x1a0000
    s_add_u32 m0, s20, 0x14000
    s_nop 0
    buffer_load_dwordx4 v3, s[4:7], s22 offen lds
    ds_read_b64_tr_b16 v[228:229], v5 offset:49184
    v_mfma_f32_16x16x32_bf16 v[132:135], v[236:239], v[60:63], v[132:135]
    ds_read_b64_tr_b16 v[230:231], v5 offset:50208
    s_waitcnt lgkmcnt(6)
    v_mfma_f32_16x16x32_bf16 v[136:139], v[240:243], v[56:59], v[136:139]
    ds_read_b64_tr_b16 v[232:233], v4 offset:49408
    v_mfma_f32_16x16x32_bf16 v[140:143], v[240:243], v[60:63], v[140:143]
    s_add_u32 s22, s24, 0x1a2000
    s_add_u32 m0, s20, 0x14400
    s_nop 0
    buffer_load_dwordx4 v3, s[4:7], s22 offen lds
    ds_read_b64_tr_b16 v[234:235], v4 offset:50432
    s_waitcnt lgkmcnt(6)
    v_mfma_f32_16x16x32_bf16 v[144:147], v[244:247], v[56:59], v[144:147]
    ds_read_b64_tr_b16 v[236:237], v5 offset:49440
    v_mfma_f32_16x16x32_bf16 v[148:151], v[244:247], v[60:63], v[148:151]
    ds_read_b64_tr_b16 v[238:239], v5 offset:50464
    s_waitcnt vmcnt(15) lgkmcnt(6)
    v_mfma_f32_16x16x32_bf16 v[88:91], v[224:227], v[24:27], v[88:91]
    ds_read_b64_tr_b16 v[240:241], v4 offset:49664
    s_waitcnt vmcnt(14)
    v_mfma_f32_16x16x32_bf16 v[92:95], v[224:227], v[28:31], v[92:95]
    ds_read_b64_tr_b16 v[242:243], v4 offset:50688
    s_waitcnt lgkmcnt(6)
    v_mfma_f32_16x16x32_bf16 v[96:99], v[228:231], v[24:27], v[96:99]
    ds_read_b64_tr_b16 v[244:245], v5 offset:49696
    s_mov_b32 s23, 0x6000
    buffer_load_dwordx4 v[56:59], v6, s[8:11], s23 offen offset:2048 sc1
    v_mfma_f32_16x16x32_bf16 v[100:103], v[228:231], v[28:31], v[100:103]
    ds_read_b64_tr_b16 v[246:247], v5 offset:50720
    s_waitcnt lgkmcnt(6)
    v_mfma_f32_16x16x32_bf16 v[104:107], v[232:235], v[24:27], v[104:107]
    ds_read_b64_tr_b16 v[224:225], v4 offset:49920
    v_mfma_f32_16x16x32_bf16 v[108:111], v[232:235], v[28:31], v[108:111]
    ds_read_b64_tr_b16 v[226:227], v4 offset:50944
    s_mov_b32 s23, 0x26000
    buffer_load_dwordx4 v[60:63], v6, s[8:11], s23 offen offset:2048 sc1
    s_waitcnt lgkmcnt(6)
    v_mfma_f32_16x16x32_bf16 v[112:115], v[236:239], v[24:27], v[112:115]
    ds_read_b64_tr_b16 v[228:229], v5 offset:49952
    v_mfma_f32_16x16x32_bf16 v[116:119], v[236:239], v[28:31], v[116:119]
    ds_read_b64_tr_b16 v[230:231], v5 offset:50976
    s_waitcnt lgkmcnt(6)
    v_mfma_f32_16x16x32_bf16 v[120:123], v[240:243], v[24:27], v[120:123]
    v_mfma_f32_16x16x32_bf16 v[124:127], v[240:243], v[28:31], v[124:127]
    s_waitcnt vmcnt(14)
    s_barrier
    ds_read_b64_tr_b16 v[232:233], v7 offset:0
    ds_read_b64_tr_b16 v[234:235], v7 offset:1024
    s_waitcnt lgkmcnt(6)
    v_mfma_f32_16x16x32_bf16 v[128:131], v[244:247], v[24:27], v[128:131]
    s_add_u32 s22, s24, 0x220000
    s_add_u32 m0, s20, 0x18000
    s_nop 0
    buffer_load_dwordx4 v3, s[4:7], s22 offen lds
    ds_read_b64_tr_b16 v[236:237], v8 offset:32
    v_mfma_f32_16x16x32_bf16 v[132:135], v[244:247], v[28:31], v[132:135]
    ds_read_b64_tr_b16 v[238:239], v8 offset:1056
    s_waitcnt lgkmcnt(6)
    v_mfma_f32_16x16x32_bf16 v[136:139], v[224:227], v[24:27], v[136:139]
    ds_read_b64_tr_b16 v[240:241], v7 offset:256
    v_mfma_f32_16x16x32_bf16 v[140:143], v[224:227], v[28:31], v[140:143]
    s_add_u32 s22, s24, 0x222000
    s_add_u32 m0, s20, 0x18400
    s_nop 0
    buffer_load_dwordx4 v3, s[4:7], s22 offen lds
    ds_read_b64_tr_b16 v[242:243], v7 offset:1280
    s_waitcnt lgkmcnt(6)
    v_mfma_f32_16x16x32_bf16 v[144:147], v[228:231], v[24:27], v[144:147]
    ds_read_b64_tr_b16 v[244:245], v8 offset:288
    v_mfma_f32_16x16x32_bf16 v[148:151], v[228:231], v[28:31], v[148:151]
    ds_read_b64_tr_b16 v[246:247], v8 offset:1312
    s_waitcnt vmcnt(15) lgkmcnt(6)
    v_mfma_f32_16x16x32_bf16 v[88:91], v[232:235], v[32:35], v[88:91]
    ds_read_b64_tr_b16 v[224:225], v7 offset:512
    s_waitcnt vmcnt(14)
    v_mfma_f32_16x16x32_bf16 v[92:95], v[232:235], v[36:39], v[92:95]
    ds_read_b64_tr_b16 v[226:227], v7 offset:1536
    s_waitcnt lgkmcnt(6)
    v_mfma_f32_16x16x32_bf16 v[96:99], v[236:239], v[32:35], v[96:99]
    ds_read_b64_tr_b16 v[228:229], v8 offset:544
    s_mov_b32 s23, 0x8000
    buffer_load_dwordx4 v[24:27], v6, s[8:11], s23 offen offset:2048 sc1
    v_mfma_f32_16x16x32_bf16 v[100:103], v[236:239], v[36:39], v[100:103]
    ds_read_b64_tr_b16 v[230:231], v8 offset:1568
    s_waitcnt lgkmcnt(6)
    v_mfma_f32_16x16x32_bf16 v[104:107], v[240:243], v[32:35], v[104:107]
    ds_read_b64_tr_b16 v[232:233], v7 offset:768
    v_mfma_f32_16x16x32_bf16 v[108:111], v[240:243], v[36:39], v[108:111]
    ds_read_b64_tr_b16 v[234:235], v7 offset:1792
    s_mov_b32 s23, 0x28000
    buffer_load_dwordx4 v[28:31], v6, s[8:11], s23 offen offset:2048 sc1
    s_mov_b32 s16, 0x544000
    buffer_load_dwordx4 v[184:187], v2, s[8:11], s16 offen sc1
    s_waitcnt lgkmcnt(6)
    v_mfma_f32_16x16x32_bf16 v[112:115], v[244:247], v[32:35], v[112:115]
    ds_read_b64_tr_b16 v[236:237], v8 offset:800
    v_mfma_f32_16x16x32_bf16 v[116:119], v[244:247], v[36:39], v[116:119]
    ds_read_b64_tr_b16 v[238:239], v8 offset:1824
    s_waitcnt lgkmcnt(6)
    v_mfma_f32_16x16x32_bf16 v[120:123], v[224:227], v[32:35], v[120:123]
    v_mfma_f32_16x16x32_bf16 v[124:127], v[224:227], v[36:39], v[124:127]
    s_waitcnt vmcnt(15)
    s_barrier
    ds_read_b64_tr_b16 v[240:241], v7 offset:16384
    ds_read_b64_tr_b16 v[242:243], v7 offset:17408
    s_waitcnt lgkmcnt(6)
    v_mfma_f32_16x16x32_bf16 v[128:131], v[228:231], v[32:35], v[128:131]
    s_add_u32 s22, s24, 0x2a0000
    s_add_u32 m0, s20, 0x1c000
    s_nop 0
    buffer_load_dwordx4 v3, s[4:7], s22 offen lds
    ds_read_b64_tr_b16 v[244:245], v8 offset:16416
    v_mfma_f32_16x16x32_bf16 v[132:135], v[228:231], v[36:39], v[132:135]
    ds_read_b64_tr_b16 v[246:247], v8 offset:17440
    s_waitcnt lgkmcnt(6)
    v_mfma_f32_16x16x32_bf16 v[136:139], v[232:235], v[32:35], v[136:139]
    ds_read_b64_tr_b16 v[224:225], v7 offset:16640
    v_mfma_f32_16x16x32_bf16 v[140:143], v[232:235], v[36:39], v[140:143]
    s_add_u32 s22, s24, 0x2a2000
    s_add_u32 m0, s20, 0x1c400
    s_nop 0
    buffer_load_dwordx4 v3, s[4:7], s22 offen lds
    ds_read_b64_tr_b16 v[226:227], v7 offset:17664
    s_waitcnt lgkmcnt(6)
    v_mfma_f32_16x16x32_bf16 v[144:147], v[236:239], v[32:35], v[144:147]
    ds_read_b64_tr_b16 v[228:229], v8 offset:16672
    v_mfma_f32_16x16x32_bf16 v[148:151], v[236:239], v[36:39], v[148:151]
    ds_read_b64_tr_b16 v[230:231], v8 offset:17696
    s_waitcnt vmcnt(16) lgkmcnt(6)
    v_mfma_f32_16x16x32_bf16 v[88:91], v[240:243], v[40:43], v[88:91]
    ds_read_b64_tr_b16 v[232:233], v7 offset:16896
    s_waitcnt vmcnt(15)
    v_mfma_f32_16x16x32_bf16 v[92:95], v[240:243], v[44:47], v[92:95]
    ds_read_b64_tr_b16 v[234:235], v7 offset:17920
    s_waitcnt lgkmcnt(6)
    v_mfma_f32_16x16x32_bf16 v[96:99], v[244:247], v[40:43], v[96:99]
    ds_read_b64_tr_b16 v[236:237], v8 offset:16928
    s_mov_b32 s23, 0xa000
    buffer_load_dwordx4 v[32:35], v6, s[8:11], s23 offen offset:2048 sc1
    v_mfma_f32_16x16x32_bf16 v[100:103], v[244:247], v[44:47], v[100:103]
    ds_read_b64_tr_b16 v[238:239], v8 offset:17952
    s_waitcnt lgkmcnt(6)
    v_mfma_f32_16x16x32_bf16 v[104:107], v[224:227], v[40:43], v[104:107]
    ds_read_b64_tr_b16 v[240:241], v7 offset:17152
    v_mfma_f32_16x16x32_bf16 v[108:111], v[224:227], v[44:47], v[108:111]
    ds_read_b64_tr_b16 v[242:243], v7 offset:18176
    s_mov_b32 s23, 0x2a000
    buffer_load_dwordx4 v[36:39], v6, s[8:11], s23 offen offset:2048 sc1
    s_waitcnt lgkmcnt(6)
    v_mfma_f32_16x16x32_bf16 v[112:115], v[228:231], v[40:43], v[112:115]
    ds_read_b64_tr_b16 v[244:245], v8 offset:17184
    v_mfma_f32_16x16x32_bf16 v[116:119], v[228:231], v[44:47], v[116:119]
    ds_read_b64_tr_b16 v[246:247], v8 offset:18208
    s_waitcnt lgkmcnt(6)
    v_mfma_f32_16x16x32_bf16 v[120:123], v[232:235], v[40:43], v[120:123]
    v_mfma_f32_16x16x32_bf16 v[124:127], v[232:235], v[44:47], v[124:127]
    s_waitcnt vmcnt(15)
    s_barrier
    ds_read_b64_tr_b16 v[224:225], v4 offset:0
    ds_read_b64_tr_b16 v[226:227], v4 offset:1024
    s_waitcnt lgkmcnt(6)
    v_mfma_f32_16x16x32_bf16 v[128:131], v[236:239], v[40:43], v[128:131]
    s_add_u32 s22, s24, 0x320000
    s_add_u32 m0, s20, 0x20000
    s_nop 0
    buffer_load_dwordx4 v3, s[4:7], s22 offen lds
    ds_read_b64_tr_b16 v[228:229], v5 offset:32
    v_mfma_f32_16x16x32_bf16 v[132:135], v[236:239], v[44:47], v[132:135]
    ds_read_b64_tr_b16 v[230:231], v5 offset:1056
    s_waitcnt lgkmcnt(6)
    v_mfma_f32_16x16x32_bf16 v[136:139], v[240:243], v[40:43], v[136:139]
    ds_read_b64_tr_b16 v[232:233], v4 offset:256
    v_mfma_f32_16x16x32_bf16 v[140:143], v[240:243], v[44:47], v[140:143]
    s_add_u32 s22, s24, 0x322000
    s_add_u32 m0, s20, 0x20400
    s_nop 0
    buffer_load_dwordx4 v3, s[4:7], s22 offen lds
    ds_read_b64_tr_b16 v[234:235], v4 offset:1280
    s_waitcnt lgkmcnt(6)
    v_mfma_f32_16x16x32_bf16 v[144:147], v[244:247], v[40:43], v[144:147]
    ds_read_b64_tr_b16 v[236:237], v5 offset:288
    v_mfma_f32_16x16x32_bf16 v[148:151], v[244:247], v[44:47], v[148:151]
    ds_read_b64_tr_b16 v[238:239], v5 offset:1312
    s_waitcnt vmcnt(16) lgkmcnt(6)
    v_mfma_f32_16x16x32_bf16 v[88:91], v[224:227], v[48:51], v[88:91]
    ds_read_b64_tr_b16 v[240:241], v4 offset:512
    s_waitcnt vmcnt(15)
    v_mfma_f32_16x16x32_bf16 v[92:95], v[224:227], v[52:55], v[92:95]
    ds_read_b64_tr_b16 v[242:243], v4 offset:1536
    s_waitcnt lgkmcnt(6)
    v_mfma_f32_16x16x32_bf16 v[96:99], v[228:231], v[48:51], v[96:99]
    ds_read_b64_tr_b16 v[244:245], v5 offset:544
    s_mov_b32 s23, 0xc000
    buffer_load_dwordx4 v[40:43], v6, s[8:11], s23 offen offset:2048 sc1
    v_mfma_f32_16x16x32_bf16 v[100:103], v[228:231], v[52:55], v[100:103]
    ds_read_b64_tr_b16 v[246:247], v5 offset:1568
    s_waitcnt lgkmcnt(6)
    v_mfma_f32_16x16x32_bf16 v[104:107], v[232:235], v[48:51], v[104:107]
    ds_read_b64_tr_b16 v[224:225], v4 offset:768
    v_mfma_f32_16x16x32_bf16 v[108:111], v[232:235], v[52:55], v[108:111]
    ds_read_b64_tr_b16 v[226:227], v4 offset:1792
    s_mov_b32 s23, 0x2c000
    buffer_load_dwordx4 v[44:47], v6, s[8:11], s23 offen offset:2048 sc1
    s_waitcnt lgkmcnt(6)
    v_mfma_f32_16x16x32_bf16 v[112:115], v[236:239], v[48:51], v[112:115]
    ds_read_b64_tr_b16 v[228:229], v5 offset:800
    v_mfma_f32_16x16x32_bf16 v[116:119], v[236:239], v[52:55], v[116:119]
    ds_read_b64_tr_b16 v[230:231], v5 offset:1824
    s_waitcnt lgkmcnt(6)
    v_mfma_f32_16x16x32_bf16 v[120:123], v[240:243], v[48:51], v[120:123]
    v_mfma_f32_16x16x32_bf16 v[124:127], v[240:243], v[52:55], v[124:127]
    s_waitcnt vmcnt(15)
    s_barrier
    ds_read_b64_tr_b16 v[232:233], v4 offset:16384
    ds_read_b64_tr_b16 v[234:235], v4 offset:17408
    s_add_u32 s19, s19, 8192
    buffer_load_dword v12, v13, s[8:11], s19 offen sc1
    s_waitcnt lgkmcnt(6)
    v_mfma_f32_16x16x32_bf16 v[128:131], v[244:247], v[48:51], v[128:131]
    s_add_u32 s22, s24, 0x3a0000
    s_add_u32 m0, s20, 0x24000
    s_nop 0
    buffer_load_dwordx4 v3, s[4:7], s22 offen lds
    ds_read_b64_tr_b16 v[236:237], v5 offset:16416
    v_mfma_f32_16x16x32_bf16 v[132:135], v[244:247], v[52:55], v[132:135]
    ds_read_b64_tr_b16 v[238:239], v5 offset:17440
    s_waitcnt lgkmcnt(6)
    v_mfma_f32_16x16x32_bf16 v[136:139], v[224:227], v[48:51], v[136:139]
    ds_read_b64_tr_b16 v[240:241], v4 offset:16640
    v_mfma_f32_16x16x32_bf16 v[140:143], v[224:227], v[52:55], v[140:143]
    s_add_u32 s22, s24, 0x3a2000
    s_add_u32 m0, s20, 0x24400
    s_nop 0
    buffer_load_dwordx4 v3, s[4:7], s22 offen lds
    ds_read_b64_tr_b16 v[242:243], v4 offset:17664
    s_waitcnt lgkmcnt(6)
    v_mfma_f32_16x16x32_bf16 v[144:147], v[228:231], v[48:51], v[144:147]
    ds_read_b64_tr_b16 v[244:245], v5 offset:16672
    v_mfma_f32_16x16x32_bf16 v[148:151], v[228:231], v[52:55], v[148:151]
    ds_read_b64_tr_b16 v[246:247], v5 offset:17696
    s_waitcnt vmcnt(17) lgkmcnt(6)
    v_mfma_f32_16x16x32_bf16 v[88:91], v[232:235], v[56:59], v[88:91]
    ds_read_b64_tr_b16 v[224:225], v4 offset:16896
    s_waitcnt vmcnt(16)
    v_mfma_f32_16x16x32_bf16 v[92:95], v[232:235], v[60:63], v[92:95]
    ds_read_b64_tr_b16 v[226:227], v4 offset:17920
    s_waitcnt lgkmcnt(6)
    v_mfma_f32_16x16x32_bf16 v[96:99], v[236:239], v[56:59], v[96:99]
    ds_read_b64_tr_b16 v[228:229], v5 offset:16928
    s_mov_b32 s23, 0xe000
    buffer_load_dwordx4 v[48:51], v6, s[8:11], s23 offen offset:2048 sc1
    v_mfma_f32_16x16x32_bf16 v[100:103], v[236:239], v[60:63], v[100:103]
    ds_read_b64_tr_b16 v[230:231], v5 offset:17952
    s_waitcnt lgkmcnt(6)
    v_mfma_f32_16x16x32_bf16 v[104:107], v[240:243], v[56:59], v[104:107]
    ds_read_b64_tr_b16 v[232:233], v4 offset:17152
    v_mfma_f32_16x16x32_bf16 v[108:111], v[240:243], v[60:63], v[108:111]
    ds_read_b64_tr_b16 v[234:235], v4 offset:18176
    s_mov_b32 s23, 0x2e000
    buffer_load_dwordx4 v[52:55], v6, s[8:11], s23 offen offset:2048 sc1
    s_waitcnt lgkmcnt(6)
    v_mfma_f32_16x16x32_bf16 v[112:115], v[244:247], v[56:59], v[112:115]
    ds_read_b64_tr_b16 v[236:237], v5 offset:17184
    v_mfma_f32_16x16x32_bf16 v[116:119], v[244:247], v[60:63], v[116:119]
    ds_read_b64_tr_b16 v[238:239], v5 offset:18208
    s_waitcnt lgkmcnt(6)
    v_mfma_f32_16x16x32_bf16 v[120:123], v[224:227], v[56:59], v[120:123]
    v_mfma_f32_16x16x32_bf16 v[124:127], v[224:227], v[60:63], v[124:127]
    s_waitcnt vmcnt(16)
    s_barrier
    ds_read_b64_tr_b16 v[240:241], v4 offset:32768
    ds_read_b64_tr_b16 v[242:243], v4 offset:33792
    s_waitcnt lgkmcnt(6)
    v_mfma_f32_16x16x32_bf16 v[128:131], v[228:231], v[56:59], v[128:131]
    s_add_u32 s22, s24, 0x30000
    s_add_u32 m0, s20, 0x10000
    s_nop 0
    buffer_load_dwordx4 v3, s[4:7], s22 offen lds
    ds_read_b64_tr_b16 v[244:245], v5 offset:32800
    v_mfma_f32_16x16x32_bf16 v[132:135], v[228:231], v[60:63], v[132:135]
    ds_read_b64_tr_b16 v[246:247], v5 offset:33824
    s_waitcnt lgkmcnt(6)
    v_mfma_f32_16x16x32_bf16 v[136:139], v[232:235], v[56:59], v[136:139]
    ds_read_b64_tr_b16 v[224:225], v4 offset:33024
    v_mfma_f32_16x16x32_bf16 v[140:143], v[232:235], v[60:63], v[140:143]
    s_add_u32 s22, s24, 0x32000
    s_add_u32 m0, s20, 0x10400
    s_nop 0
    buffer_load_dwordx4 v3, s[4:7], s22 offen lds
    ds_read_b64_tr_b16 v[226:227], v4 offset:34048
    s_waitcnt lgkmcnt(6)
    v_mfma_f32_16x16x32_bf16 v[144:147], v[236:239], v[56:59], v[144:147]
    ds_read_b64_tr_b16 v[228:229], v5 offset:33056
    v_mfma_f32_16x16x32_bf16 v[148:151], v[236:239], v[60:63], v[148:151]
    ds_read_b64_tr_b16 v[230:231], v5 offset:34080
    s_waitcnt vmcnt(6)
    v_cmp_ne_u32 vcc, s28, v12
    s_cbranch_vccnz adaLN_cond__sliding_block_cached__moe_arch_mod__prompt_kernel_o29r
adaLN_cond__sliding_block_cached__moe_arch_mod__prompt_kernel_o29b:
    s_waitcnt lgkmcnt(6)
    v_mfma_f32_16x16x32_bf16 v[88:91], v[240:243], v[24:27], v[88:91]
    ds_read_b64_tr_b16 v[232:233], v4 offset:33280
    v_mfma_f32_16x16x32_bf16 v[92:95], v[240:243], v[28:31], v[92:95]
    ds_read_b64_tr_b16 v[234:235], v4 offset:34304
    s_waitcnt lgkmcnt(6)
    v_mfma_f32_16x16x32_bf16 v[96:99], v[244:247], v[24:27], v[96:99]
    ds_read_b64_tr_b16 v[236:237], v5 offset:33312
    s_mov_b32 s23, 0x0
    buffer_load_dwordx4 v[56:59], v6, s[8:11], s23 offen offset:3072 sc1
    v_mfma_f32_16x16x32_bf16 v[100:103], v[244:247], v[28:31], v[100:103]
    ds_read_b64_tr_b16 v[238:239], v5 offset:34336
    s_waitcnt lgkmcnt(6)
    v_mfma_f32_16x16x32_bf16 v[104:107], v[224:227], v[24:27], v[104:107]
    ds_read_b64_tr_b16 v[240:241], v4 offset:33536
    v_mfma_f32_16x16x32_bf16 v[108:111], v[224:227], v[28:31], v[108:111]
    ds_read_b64_tr_b16 v[242:243], v4 offset:34560
    s_mov_b32 s23, 0x20000
    buffer_load_dwordx4 v[60:63], v6, s[8:11], s23 offen offset:3072 sc1
    v_xor_b32 v16, s28, v184
    v_xor_b32 v17, s28, v185
    v_xor_b32 v18, s28, v186
    v_xor_b32 v19, s28, v187
    v_or3_b32 v16, v16, v17, v18
    v_or_b32 v16, v16, v19
    v_cmp_ne_u32 vcc, 0, v16
    s_cbranch_vccnz adaLN_cond__sliding_block_cached__moe_arch_mod__prompt_kernel_mf10r
adaLN_cond__sliding_block_cached__moe_arch_mod__prompt_kernel_mf10b:
    s_waitcnt lgkmcnt(6)
    v_mfma_f32_16x16x32_bf16 v[112:115], v[228:231], v[24:27], v[112:115]
    ds_read_b64_tr_b16 v[244:245], v5 offset:33568
    v_mfma_f32_16x16x32_bf16 v[116:119], v[228:231], v[28:31], v[116:119]
    ds_read_b64_tr_b16 v[246:247], v5 offset:34592
    s_waitcnt lgkmcnt(6)
    v_mfma_f32_16x16x32_bf16 v[120:123], v[232:235], v[24:27], v[120:123]
    v_mfma_f32_16x16x32_bf16 v[124:127], v[232:235], v[28:31], v[124:127]
    s_barrier
    ds_read_b64_tr_b16 v[224:225], v4 offset:49152
    ds_read_b64_tr_b16 v[226:227], v4 offset:50176
    s_waitcnt lgkmcnt(6)
    v_mfma_f32_16x16x32_bf16 v[128:131], v[236:239], v[24:27], v[128:131]
    s_add_u32 s22, s24, 0xb0000
    s_add_u32 m0, s20, 0x14000
    s_nop 0
    buffer_load_dwordx4 v3, s[4:7], s22 offen lds
    ds_read_b64_tr_b16 v[228:229], v5 offset:49184
    v_mfma_f32_16x16x32_bf16 v[132:135], v[236:239], v[28:31], v[132:135]
    ds_read_b64_tr_b16 v[230:231], v5 offset:50208
    s_waitcnt lgkmcnt(6)
    v_mfma_f32_16x16x32_bf16 v[136:139], v[240:243], v[24:27], v[136:139]
    ds_read_b64_tr_b16 v[232:233], v4 offset:49408
    v_mfma_f32_16x16x32_bf16 v[140:143], v[240:243], v[28:31], v[140:143]
    s_add_u32 s22, s24, 0xb2000
    s_add_u32 m0, s20, 0x14400
    s_nop 0
    buffer_load_dwordx4 v3, s[4:7], s22 offen lds
    ds_read_b64_tr_b16 v[234:235], v4 offset:50432
    s_waitcnt lgkmcnt(6)
    v_mfma_f32_16x16x32_bf16 v[144:147], v[244:247], v[24:27], v[144:147]
    ds_read_b64_tr_b16 v[236:237], v5 offset:49440
    v_mfma_f32_16x16x32_bf16 v[148:151], v[244:247], v[28:31], v[148:151]
    ds_read_b64_tr_b16 v[238:239], v5 offset:50464
    s_waitcnt lgkmcnt(6)
    v_mfma_f32_16x16x32_bf16 v[88:91], v[224:227], v[32:35], v[88:91]
    ds_read_b64_tr_b16 v[240:241], v4 offset:49664
    v_mfma_f32_16x16x32_bf16 v[92:95], v[224:227], v[36:39], v[92:95]
    ds_read_b64_tr_b16 v[242:243], v4 offset:50688
    s_waitcnt lgkmcnt(6)
    v_mfma_f32_16x16x32_bf16 v[96:99], v[228:231], v[32:35], v[96:99]
    ds_read_b64_tr_b16 v[244:245], v5 offset:49696
    s_mov_b32 s23, 0x2000
    buffer_load_dwordx4 v[24:27], v6, s[8:11], s23 offen offset:3072 sc1
    v_mfma_f32_16x16x32_bf16 v[100:103], v[228:231], v[36:39], v[100:103]
    ds_read_b64_tr_b16 v[246:247], v5 offset:50720
    s_waitcnt lgkmcnt(6)
    v_mfma_f32_16x16x32_bf16 v[104:107], v[232:235], v[32:35], v[104:107]
    ds_read_b64_tr_b16 v[224:225], v4 offset:49920
    v_mfma_f32_16x16x32_bf16 v[108:111], v[232:235], v[36:39], v[108:111]
    ds_read_b64_tr_b16 v[226:227], v4 offset:50944
    s_mov_b32 s23, 0x22000
    buffer_load_dwordx4 v[28:31], v6, s[8:11], s23 offen offset:3072 sc1
    s_waitcnt lgkmcnt(6)
    v_mfma_f32_16x16x32_bf16 v[112:115], v[236:239], v[32:35], v[112:115]
    ds_read_b64_tr_b16 v[228:229], v5 offset:49952
    v_mfma_f32_16x16x32_bf16 v[116:119], v[236:239], v[36:39], v[116:119]
    ds_read_b64_tr_b16 v[230:231], v5 offset:50976
    s_waitcnt lgkmcnt(6)
    v_mfma_f32_16x16x32_bf16 v[120:123], v[240:243], v[32:35], v[120:123]
    v_mfma_f32_16x16x32_bf16 v[124:127], v[240:243], v[36:39], v[124:127]
    s_barrier
    ds_read_b64_tr_b16 v[232:233], v7 offset:0
    ds_read_b64_tr_b16 v[234:235], v7 offset:1024
    s_waitcnt lgkmcnt(6)
    v_mfma_f32_16x16x32_bf16 v[128:131], v[244:247], v[32:35], v[128:131]
    s_add_u32 s22, s24, 0x130000
    s_add_u32 m0, s20, 0x18000
    s_nop 0
    buffer_load_dwordx4 v3, s[4:7], s22 offen lds
    ds_read_b64_tr_b16 v[236:237], v8 offset:32
    v_mfma_f32_16x16x32_bf16 v[132:135], v[244:247], v[36:39], v[132:135]
    ds_read_b64_tr_b16 v[238:239], v8 offset:1056
    s_waitcnt lgkmcnt(6)
    v_mfma_f32_16x16x32_bf16 v[136:139], v[224:227], v[32:35], v[136:139]
    ds_read_b64_tr_b16 v[240:241], v7 offset:256
    v_mfma_f32_16x16x32_bf16 v[140:143], v[224:227], v[36:39], v[140:143]
    s_add_u32 s22, s24, 0x132000
    s_add_u32 m0, s20, 0x18400
    s_nop 0
    buffer_load_dwordx4 v3, s[4:7], s22 offen lds
    ds_read_b64_tr_b16 v[242:243], v7 offset:1280
    s_waitcnt lgkmcnt(6)
    v_mfma_f32_16x16x32_bf16 v[144:147], v[228:231], v[32:35], v[144:147]
    ds_read_b64_tr_b16 v[244:245], v8 offset:288
    v_mfma_f32_16x16x32_bf16 v[148:151], v[228:231], v[36:39], v[148:151]
    ds_read_b64_tr_b16 v[246:247], v8 offset:1312
    s_waitcnt lgkmcnt(6)
    v_mfma_f32_16x16x32_bf16 v[88:91], v[232:235], v[40:43], v[88:91]
    ds_read_b64_tr_b16 v[224:225], v7 offset:512
    v_mfma_f32_16x16x32_bf16 v[92:95], v[232:235], v[44:47], v[92:95]
    ds_read_b64_tr_b16 v[226:227], v7 offset:1536
    s_waitcnt lgkmcnt(6)
    v_mfma_f32_16x16x32_bf16 v[96:99], v[236:239], v[40:43], v[96:99]
    ds_read_b64_tr_b16 v[228:229], v8 offset:544
    s_mov_b32 s23, 0x4000
    buffer_load_dwordx4 v[32:35], v6, s[8:11], s23 offen offset:3072 sc1
    v_mfma_f32_16x16x32_bf16 v[100:103], v[236:239], v[44:47], v[100:103]
    ds_read_b64_tr_b16 v[230:231], v8 offset:1568
    s_waitcnt lgkmcnt(6)
    v_mfma_f32_16x16x32_bf16 v[104:107], v[240:243], v[40:43], v[104:107]
    ds_read_b64_tr_b16 v[232:233], v7 offset:768
    v_mfma_f32_16x16x32_bf16 v[108:111], v[240:243], v[44:47], v[108:111]
    ds_read_b64_tr_b16 v[234:235], v7 offset:1792
    s_mov_b32 s23, 0x24000
    buffer_load_dwordx4 v[36:39], v6, s[8:11], s23 offen offset:3072 sc1
    s_waitcnt lgkmcnt(6)
    v_mfma_f32_16x16x32_bf16 v[112:115], v[244:247], v[40:43], v[112:115]
    ds_read_b64_tr_b16 v[236:237], v8 offset:800
    v_mfma_f32_16x16x32_bf16 v[116:119], v[244:247], v[44:47], v[116:119]
    ds_read_b64_tr_b16 v[238:239], v8 offset:1824
    s_waitcnt lgkmcnt(6)
    v_mfma_f32_16x16x32_bf16 v[120:123], v[224:227], v[40:43], v[120:123]
    v_mfma_f32_16x16x32_bf16 v[124:127], v[224:227], v[44:47], v[124:127]
    s_waitcnt vmcnt(14)
    s_barrier
    ds_read_b64_tr_b16 v[240:241], v7 offset:16384
    ds_read_b64_tr_b16 v[242:243], v7 offset:17408
    s_waitcnt lgkmcnt(6)
    v_mfma_f32_16x16x32_bf16 v[128:131], v[228:231], v[40:43], v[128:131]
    s_add_u32 s22, s24, 0x1b0000
    s_add_u32 m0, s20, 0x1c000
    s_nop 0
    buffer_load_dwordx4 v3, s[4:7], s22 offen lds
    ds_read_b64_tr_b16 v[244:245], v8 offset:16416
    v_mfma_f32_16x16x32_bf16 v[132:135], v[228:231], v[44:47], v[132:135]
    ds_read_b64_tr_b16 v[246:247], v8 offset:17440
    s_waitcnt lgkmcnt(6)
    v_mfma_f32_16x16x32_bf16 v[136:139], v[232:235], v[40:43], v[136:139]
    ds_read_b64_tr_b16 v[224:225], v7 offset:16640
    v_mfma_f32_16x16x32_bf16 v[140:143], v[232:235], v[44:47], v[140:143]
    s_add_u32 s22, s24, 0x1b2000
    s_add_u32 m0, s20, 0x1c400
    s_nop 0
    buffer_load_dwordx4 v3, s[4:7], s22 offen lds
    ds_read_b64_tr_b16 v[226:227], v7 offset:17664
    s_waitcnt lgkmcnt(6)
    v_mfma_f32_16x16x32_bf16 v[144:147], v[236:239], v[40:43], v[144:147]
    ds_read_b64_tr_b16 v[228:229], v8 offset:16672
    v_mfma_f32_16x16x32_bf16 v[148:151], v[236:239], v[44:47], v[148:151]
    ds_read_b64_tr_b16 v[230:231], v8 offset:17696
    s_waitcnt vmcnt(15) lgkmcnt(6)
    v_mfma_f32_16x16x32_bf16 v[88:91], v[240:243], v[48:51], v[88:91]
    ds_read_b64_tr_b16 v[232:233], v7 offset:16896
    s_waitcnt vmcnt(14)
    v_mfma_f32_16x16x32_bf16 v[92:95], v[240:243], v[52:55], v[92:95]
    ds_read_b64_tr_b16 v[234:235], v7 offset:17920
    s_waitcnt lgkmcnt(6)
    v_mfma_f32_16x16x32_bf16 v[96:99], v[244:247], v[48:51], v[96:99]
    ds_read_b64_tr_b16 v[236:237], v8 offset:16928
    s_mov_b32 s23, 0x6000
    buffer_load_dwordx4 v[40:43], v6, s[8:11], s23 offen offset:3072 sc1
    v_mfma_f32_16x16x32_bf16 v[100:103], v[244:247], v[52:55], v[100:103]
    ds_read_b64_tr_b16 v[238:239], v8 offset:17952
    s_waitcnt lgkmcnt(6)
    v_mfma_f32_16x16x32_bf16 v[104:107], v[224:227], v[48:51], v[104:107]
    ds_read_b64_tr_b16 v[240:241], v7 offset:17152
    v_mfma_f32_16x16x32_bf16 v[108:111], v[224:227], v[52:55], v[108:111]
    ds_read_b64_tr_b16 v[242:243], v7 offset:18176
    s_mov_b32 s23, 0x26000
    buffer_load_dwordx4 v[44:47], v6, s[8:11], s23 offen offset:3072 sc1
    s_waitcnt lgkmcnt(6)
    v_mfma_f32_16x16x32_bf16 v[112:115], v[228:231], v[48:51], v[112:115]
    ds_read_b64_tr_b16 v[244:245], v8 offset:17184
    v_mfma_f32_16x16x32_bf16 v[116:119], v[228:231], v[52:55], v[116:119]
    ds_read_b64_tr_b16 v[246:247], v8 offset:18208
    s_waitcnt lgkmcnt(6)
    v_mfma_f32_16x16x32_bf16 v[120:123], v[232:235], v[48:51], v[120:123]
    v_mfma_f32_16x16x32_bf16 v[124:127], v[232:235], v[52:55], v[124:127]
    s_waitcnt vmcnt(14)
    s_barrier
    ds_read_b64_tr_b16 v[224:225], v4 offset:0
    ds_read_b64_tr_b16 v[226:227], v4 offset:1024
    s_waitcnt lgkmcnt(6)
    v_mfma_f32_16x16x32_bf16 v[128:131], v[236:239], v[48:51], v[128:131]
    s_add_u32 s22, s24, 0x230000
    s_add_u32 m0, s20, 0x20000
    s_nop 0
    buffer_load_dwordx4 v3, s[4:7], s22 offen lds
    ds_read_b64_tr_b16 v[228:229], v5 offset:32
    v_mfma_f32_16x16x32_bf16 v[132:135], v[236:239], v[52:55], v[132:135]
    ds_read_b64_tr_b16 v[230:231], v5 offset:1056
    s_waitcnt lgkmcnt(6)
    v_mfma_f32_16x16x32_bf16 v[136:139], v[240:243], v[48:51], v[136:139]
    ds_read_b64_tr_b16 v[232:233], v4 offset:256
    v_mfma_f32_16x16x32_bf16 v[140:143], v[240:243], v[52:55], v[140:143]
    s_add_u32 s22, s24, 0x232000
    s_add_u32 m0, s20, 0x20400
    s_nop 0
    buffer_load_dwordx4 v3, s[4:7], s22 offen lds
    ds_read_b64_tr_b16 v[234:235], v4 offset:1280
    s_waitcnt lgkmcnt(6)
    v_mfma_f32_16x16x32_bf16 v[144:147], v[244:247], v[48:51], v[144:147]
    ds_read_b64_tr_b16 v[236:237], v5 offset:288
    v_mfma_f32_16x16x32_bf16 v[148:151], v[244:247], v[52:55], v[148:151]
    ds_read_b64_tr_b16 v[238:239], v5 offset:1312
    s_waitcnt vmcnt(15) lgkmcnt(6)
    v_mfma_f32_16x16x32_bf16 v[88:91], v[224:227], v[56:59], v[88:91]
    ds_read_b64_tr_b16 v[240:241], v4 offset:512
    s_waitcnt vmcnt(14)
    v_mfma_f32_16x16x32_bf16 v[92:95], v[224:227], v[60:63], v[92:95]
    ds_read_b64_tr_b16 v[242:243], v4 offset:1536
    s_waitcnt lgkmcnt(6)
    v_mfma_f32_16x16x32_bf16 v[96:99], v[228:231], v[56:59], v[96:99]
    ds_read_b64_tr_b16 v[244:245], v5 offset:544
    s_mov_b32 s23, 0x8000
    buffer_load_dwordx4 v[48:51], v6, s[8:11], s23 offen offset:3072 sc1
    v_mfma_f32_16x16x32_bf16 v[100:103], v[228:231], v[60:63], v[100:103]
    ds_read_b64_tr_b16 v[246:247], v5 offset:1568
    s_waitcnt lgkmcnt(6)
    v_mfma_f32_16x16x32_bf16 v[104:107], v[232:235], v[56:59], v[104:107]
    ds_read_b64_tr_b16 v[224:225], v4 offset:768
    v_mfma_f32_16x16x32_bf16 v[108:111], v[232:235], v[60:63], v[108:111]
    ds_read_b64_tr_b16 v[226:227], v4 offset:1792
    s_mov_b32 s23, 0x28000
    buffer_load_dwordx4 v[52:55], v6, s[8:11], s23 offen offset:3072 sc1
    s_waitcnt lgkmcnt(6)
    v_mfma_f32_16x16x32_bf16 v[112:115], v[236:239], v[56:59], v[112:115]
    ds_read_b64_tr_b16 v[228:229], v5 offset:800
    v_mfma_f32_16x16x32_bf16 v[116:119], v[236:239], v[60:63], v[116:119]
    ds_read_b64_tr_b16 v[230:231], v5 offset:1824
    s_waitcnt lgkmcnt(6)
    v_mfma_f32_16x16x32_bf16 v[120:123], v[240:243], v[56:59], v[120:123]
    v_mfma_f32_16x16x32_bf16 v[124:127], v[240:243], v[60:63], v[124:127]
    s_waitcnt vmcnt(14)
    s_barrier
    ds_read_b64_tr_b16 v[232:233], v4 offset:16384
    ds_read_b64_tr_b16 v[234:235], v4 offset:17408
    s_waitcnt lgkmcnt(6)
    v_mfma_f32_16x16x32_bf16 v[128:131], v[244:247], v[56:59], v[128:131]
    s_add_u32 s22, s24, 0x2b0000
    s_add_u32 m0, s20, 0x24000
    s_nop 0
    buffer_load_dwordx4 v3, s[4:7], s22 offen lds
    ds_read_b64_tr_b16 v[236:237], v5 offset:16416
    v_mfma_f32_16x16x32_bf16 v[132:135], v[244:247], v[60:63], v[132:135]
    ds_read_b64_tr_b16 v[238:239], v5 offset:17440
    s_waitcnt lgkmcnt(6)
    v_mfma_f32_16x16x32_bf16 v[136:139], v[224:227], v[56:59], v[136:139]
    ds_read_b64_tr_b16 v[240:241], v4 offset:16640
    v_mfma_f32_16x16x32_bf16 v[140:143], v[224:227], v[60:63], v[140:143]
    s_add_u32 s22, s24, 0x2b2000
    s_add_u32 m0, s20, 0x24400
    s_nop 0
    buffer_load_dwordx4 v3, s[4:7], s22 offen lds
    ds_read_b64_tr_b16 v[242:243], v4 offset:17664
    s_waitcnt lgkmcnt(6)
    v_mfma_f32_16x16x32_bf16 v[144:147], v[228:231], v[56:59], v[144:147]
    ds_read_b64_tr_b16 v[244:245], v5 offset:16672
    v_mfma_f32_16x16x32_bf16 v[148:151], v[228:231], v[60:63], v[148:151]
    ds_read_b64_tr_b16 v[246:247], v5 offset:17696
    s_waitcnt vmcnt(15) lgkmcnt(6)
    v_mfma_f32_16x16x32_bf16 v[88:91], v[232:235], v[24:27], v[88:91]
    ds_read_b64_tr_b16 v[224:225], v4 offset:16896
    s_waitcnt vmcnt(14)
    v_mfma_f32_16x16x32_bf16 v[92:95], v[232:235], v[28:31], v[92:95]
    ds_read_b64_tr_b16 v[226:227], v4 offset:17920
    s_waitcnt lgkmcnt(6)
    v_mfma_f32_16x16x32_bf16 v[96:99], v[236:239], v[24:27], v[96:99]
    ds_read_b64_tr_b16 v[228:229], v5 offset:16928
    s_mov_b32 s23, 0xa000
    buffer_load_dwordx4 v[56:59], v6, s[8:11], s23 offen offset:3072 sc1
    v_mfma_f32_16x16x32_bf16 v[100:103], v[236:239], v[28:31], v[100:103]
    ds_read_b64_tr_b16 v[230:231], v5 offset:17952
    s_waitcnt lgkmcnt(6)
    v_mfma_f32_16x16x32_bf16 v[104:107], v[240:243], v[24:27], v[104:107]
    ds_read_b64_tr_b16 v[232:233], v4 offset:17152
    v_mfma_f32_16x16x32_bf16 v[108:111], v[240:243], v[28:31], v[108:111]
    ds_read_b64_tr_b16 v[234:235], v4 offset:18176
    s_mov_b32 s23, 0x2a000
    buffer_load_dwordx4 v[60:63], v6, s[8:11], s23 offen offset:3072 sc1
    s_waitcnt lgkmcnt(6)
    v_mfma_f32_16x16x32_bf16 v[112:115], v[244:247], v[24:27], v[112:115]
    ds_read_b64_tr_b16 v[236:237], v5 offset:17184
    v_mfma_f32_16x16x32_bf16 v[116:119], v[244:247], v[28:31], v[116:119]
    ds_read_b64_tr_b16 v[238:239], v5 offset:18208
    s_waitcnt lgkmcnt(6)
    v_mfma_f32_16x16x32_bf16 v[120:123], v[224:227], v[24:27], v[120:123]
    v_mfma_f32_16x16x32_bf16 v[124:127], v[224:227], v[28:31], v[124:127]
    s_waitcnt vmcnt(14)
    s_barrier
    ds_read_b64_tr_b16 v[240:241], v4 offset:32768
    ds_read_b64_tr_b16 v[242:243], v4 offset:33792
    s_waitcnt lgkmcnt(6)
    v_mfma_f32_16x16x32_bf16 v[128:131], v[228:231], v[24:27], v[128:131]
    s_add_u32 s22, s24, 0x330000
    s_add_u32 m0, s20, 0x10000
    s_nop 0
    buffer_load_dwordx4 v3, s[4:7], s22 offen lds
    ds_read_b64_tr_b16 v[244:245], v5 offset:32800
    v_mfma_f32_16x16x32_bf16 v[132:135], v[228:231], v[28:31], v[132:135]
    ds_read_b64_tr_b16 v[246:247], v5 offset:33824
    s_waitcnt lgkmcnt(6)
    v_mfma_f32_16x16x32_bf16 v[136:139], v[232:235], v[24:27], v[136:139]
    ds_read_b64_tr_b16 v[224:225], v4 offset:33024
    v_mfma_f32_16x16x32_bf16 v[140:143], v[232:235], v[28:31], v[140:143]
    s_add_u32 s22, s24, 0x332000
    s_add_u32 m0, s20, 0x10400
    s_nop 0
    buffer_load_dwordx4 v3, s[4:7], s22 offen lds
    ds_read_b64_tr_b16 v[226:227], v4 offset:34048
    s_waitcnt lgkmcnt(6)
    v_mfma_f32_16x16x32_bf16 v[144:147], v[236:239], v[24:27], v[144:147]
    ds_read_b64_tr_b16 v[228:229], v5 offset:33056
    v_mfma_f32_16x16x32_bf16 v[148:151], v[236:239], v[28:31], v[148:151]
    ds_read_b64_tr_b16 v[230:231], v5 offset:34080
    s_waitcnt vmcnt(15) lgkmcnt(6)
    v_mfma_f32_16x16x32_bf16 v[88:91], v[240:243], v[32:35], v[88:91]
    ds_read_b64_tr_b16 v[232:233], v4 offset:33280
    s_waitcnt vmcnt(14)
    v_mfma_f32_16x16x32_bf16 v[92:95], v[240:243], v[36:39], v[92:95]
    ds_read_b64_tr_b16 v[234:235], v4 offset:34304
    s_waitcnt lgkmcnt(6)
    v_mfma_f32_16x16x32_bf16 v[96:99], v[244:247], v[32:35], v[96:99]
    ds_read_b64_tr_b16 v[236:237], v5 offset:33312
    s_mov_b32 s23, 0xc000
    buffer_load_dwordx4 v[24:27], v6, s[8:11], s23 offen offset:3072 sc1
    v_mfma_f32_16x16x32_bf16 v[100:103], v[244:247], v[36:39], v[100:103]
    ds_read_b64_tr_b16 v[238:239], v5 offset:34336
    s_waitcnt lgkmcnt(6)
    v_mfma_f32_16x16x32_bf16 v[104:107], v[224:227], v[32:35], v[104:107]
    ds_read_b64_tr_b16 v[240:241], v4 offset:33536
    v_mfma_f32_16x16x32_bf16 v[108:111], v[224:227], v[36:39], v[108:111]
    ds_read_b64_tr_b16 v[242:243], v4 offset:34560
    s_mov_b32 s23, 0x2c000
    buffer_load_dwordx4 v[28:31], v6, s[8:11], s23 offen offset:3072 sc1
    v_lshrrev_b32 v16, 4, v1
    v_lshlrev_b32 v16, 3, v16
    s_lshl_b32 s16, s31, 8
    s_add_u32 s16, s16, 0x540000
    buffer_load_dwordx2 v[248:249], v16, s[8:11], s16 offen offset:0 sc1
    buffer_load_dwordx2 v[250:251], v16, s[8:11], s16 offen offset:32 sc1
    buffer_load_dwordx2 v[252:253], v16, s[8:11], s16 offen offset:64 sc1
    buffer_load_dwordx2 v[254:255], v16, s[8:11], s16 offen offset:96 sc1
    s_waitcnt lgkmcnt(6)
    v_mfma_f32_16x16x32_bf16 v[112:115], v[228:231], v[32:35], v[112:115]
    ds_read_b64_tr_b16 v[244:245], v5 offset:33568
    v_mfma_f32_16x16x32_bf16 v[116:119], v[228:231], v[36:39], v[116:119]
    ds_read_b64_tr_b16 v[246:247], v5 offset:34592
    s_waitcnt lgkmcnt(6)
    v_mfma_f32_16x16x32_bf16 v[120:123], v[232:235], v[32:35], v[120:123]
    v_mfma_f32_16x16x32_bf16 v[124:127], v[232:235], v[36:39], v[124:127]
    s_waitcnt vmcnt(18)
    s_barrier
    ds_read_b64_tr_b16 v[224:225], v4 offset:49152
    ds_read_b64_tr_b16 v[226:227], v4 offset:50176
    s_waitcnt lgkmcnt(6)
    v_mfma_f32_16x16x32_bf16 v[128:131], v[236:239], v[32:35], v[128:131]
    s_add_u32 s22, s24, 0x3b0000
    s_add_u32 m0, s20, 0x14000
    s_nop 0
    buffer_load_dwordx4 v3, s[4:7], s22 offen lds
    ds_read_b64_tr_b16 v[228:229], v5 offset:49184
    v_mfma_f32_16x16x32_bf16 v[132:135], v[236:239], v[36:39], v[132:135]
    ds_read_b64_tr_b16 v[230:231], v5 offset:50208
    s_waitcnt lgkmcnt(6)
    v_mfma_f32_16x16x32_bf16 v[136:139], v[240:243], v[32:35], v[136:139]
    ds_read_b64_tr_b16 v[232:233], v4 offset:49408
    v_mfma_f32_16x16x32_bf16 v[140:143], v[240:243], v[36:39], v[140:143]
    s_add_u32 s22, s24, 0x3b2000
    s_add_u32 m0, s20, 0x14400
    s_nop 0
    buffer_load_dwordx4 v3, s[4:7], s22 offen lds
    ds_read_b64_tr_b16 v[234:235], v4 offset:50432
    s_waitcnt lgkmcnt(6)
    v_mfma_f32_16x16x32_bf16 v[144:147], v[244:247], v[32:35], v[144:147]
    ds_read_b64_tr_b16 v[236:237], v5 offset:49440
    v_mfma_f32_16x16x32_bf16 v[148:151], v[244:247], v[36:39], v[148:151]
    ds_read_b64_tr_b16 v[238:239], v5 offset:50464
    s_waitcnt vmcnt(19) lgkmcnt(6)
    v_mfma_f32_16x16x32_bf16 v[88:91], v[224:227], v[40:43], v[88:91]
    ds_read_b64_tr_b16 v[240:241], v4 offset:49664
    s_waitcnt vmcnt(18)
    v_mfma_f32_16x16x32_bf16 v[92:95], v[224:227], v[44:47], v[92:95]
    ds_read_b64_tr_b16 v[242:243], v4 offset:50688
    s_waitcnt lgkmcnt(6)
    v_mfma_f32_16x16x32_bf16 v[96:99], v[228:231], v[40:43], v[96:99]
    ds_read_b64_tr_b16 v[244:245], v5 offset:49696
    s_mov_b32 s23, 0xe000
    buffer_load_dwordx4 v[32:35], v6, s[8:11], s23 offen offset:3072 sc1
    v_mfma_f32_16x16x32_bf16 v[100:103], v[228:231], v[44:47], v[100:103]
    ds_read_b64_tr_b16 v[246:247], v5 offset:50720
    s_waitcnt lgkmcnt(6)
    v_mfma_f32_16x16x32_bf16 v[104:107], v[232:235], v[40:43], v[104:107]
    ds_read_b64_tr_b16 v[224:225], v4 offset:49920
    v_mfma_f32_16x16x32_bf16 v[108:111], v[232:235], v[44:47], v[108:111]
    ds_read_b64_tr_b16 v[226:227], v4 offset:50944
    s_mov_b32 s23, 0x2e000
    buffer_load_dwordx4 v[36:39], v6, s[8:11], s23 offen offset:3072 sc1
    s_waitcnt lgkmcnt(6)
    v_mfma_f32_16x16x32_bf16 v[112:115], v[236:239], v[40:43], v[112:115]
    ds_read_b64_tr_b16 v[228:229], v5 offset:49952
    v_mfma_f32_16x16x32_bf16 v[116:119], v[236:239], v[44:47], v[116:119]
    ds_read_b64_tr_b16 v[230:231], v5 offset:50976
    s_waitcnt lgkmcnt(6)
    v_mfma_f32_16x16x32_bf16 v[120:123], v[240:243], v[40:43], v[120:123]
    v_mfma_f32_16x16x32_bf16 v[124:127], v[240:243], v[44:47], v[124:127]
    s_waitcnt vmcnt(18)
    s_barrier
    ds_read_b64_tr_b16 v[232:233], v7 offset:0
    ds_read_b64_tr_b16 v[234:235], v7 offset:1024
    s_waitcnt lgkmcnt(6)
    v_mfma_f32_16x16x32_bf16 v[128:131], v[244:247], v[40:43], v[128:131]
    ds_read_b64_tr_b16 v[236:237], v8 offset:32
    v_mfma_f32_16x16x32_bf16 v[132:135], v[244:247], v[44:47], v[132:135]
    ds_read_b64_tr_b16 v[238:239], v8 offset:1056
    s_waitcnt lgkmcnt(6)
    v_mfma_f32_16x16x32_bf16 v[136:139], v[224:227], v[40:43], v[136:139]
    ds_read_b64_tr_b16 v[240:241], v7 offset:256
    v_mfma_f32_16x16x32_bf16 v[140:143], v[224:227], v[44:47], v[140:143]
    ds_read_b64_tr_b16 v[242:243], v7 offset:1280
    s_waitcnt lgkmcnt(6)
    v_mfma_f32_16x16x32_bf16 v[144:147], v[228:231], v[40:43], v[144:147]
    ds_read_b64_tr_b16 v[244:245], v8 offset:288
    v_mfma_f32_16x16x32_bf16 v[148:151], v[228:231], v[44:47], v[148:151]
    ds_read_b64_tr_b16 v[246:247], v8 offset:1312
    s_waitcnt vmcnt(17) lgkmcnt(6)
    v_mfma_f32_16x16x32_bf16 v[88:91], v[232:235], v[48:51], v[88:91]
    ds_read_b64_tr_b16 v[224:225], v7 offset:512
    s_waitcnt vmcnt(16)
    v_mfma_f32_16x16x32_bf16 v[92:95], v[232:235], v[52:55], v[92:95]
    ds_read_b64_tr_b16 v[226:227], v7 offset:1536
    s_waitcnt lgkmcnt(6)
    v_mfma_f32_16x16x32_bf16 v[96:99], v[236:239], v[48:51], v[96:99]
    ds_read_b64_tr_b16 v[228:229], v8 offset:544
    v_mfma_f32_16x16x32_bf16 v[100:103], v[236:239], v[52:55], v[100:103]
    ds_read_b64_tr_b16 v[230:231], v8 offset:1568
    s_waitcnt lgkmcnt(6)
    v_mfma_f32_16x16x32_bf16 v[104:107], v[240:243], v[48:51], v[104:107]
    ds_read_b64_tr_b16 v[232:233], v7 offset:768
    v_mfma_f32_16x16x32_bf16 v[108:111], v[240:243], v[52:55], v[108:111]
    ds_read_b64_tr_b16 v[234:235], v7 offset:1792
    s_waitcnt lgkmcnt(6)
    v_mfma_f32_16x16x32_bf16 v[112:115], v[244:247], v[48:51], v[112:115]
    ds_read_b64_tr_b16 v[236:237], v8 offset:800
    v_mfma_f32_16x16x32_bf16 v[116:119], v[244:247], v[52:55], v[116:119]
    ds_read_b64_tr_b16 v[238:239], v8 offset:1824
    s_waitcnt lgkmcnt(6)
    v_mfma_f32_16x16x32_bf16 v[120:123], v[224:227], v[48:51], v[120:123]
    v_mfma_f32_16x16x32_bf16 v[124:127], v[224:227], v[52:55], v[124:127]
    s_waitcnt vmcnt(14)
    s_barrier
    ds_read_b64_tr_b16 v[240:241], v7 offset:16384
    ds_read_b64_tr_b16 v[242:243], v7 offset:17408
    s_waitcnt lgkmcnt(6)
    v_mfma_f32_16x16x32_bf16 v[128:131], v[228:231], v[48:51], v[128:131]
    ds_read_b64_tr_b16 v[244:245], v8 offset:16416
    v_mfma_f32_16x16x32_bf16 v[132:135], v[228:231], v[52:55], v[132:135]
    ds_read_b64_tr_b16 v[246:247], v8 offset:17440
    s_waitcnt lgkmcnt(6)
    v_mfma_f32_16x16x32_bf16 v[136:139], v[232:235], v[48:51], v[136:139]
    ds_read_b64_tr_b16 v[224:225], v7 offset:16640
    v_mfma_f32_16x16x32_bf16 v[140:143], v[232:235], v[52:55], v[140:143]
    ds_read_b64_tr_b16 v[226:227], v7 offset:17664
    s_waitcnt lgkmcnt(6)
    v_mfma_f32_16x16x32_bf16 v[144:147], v[236:239], v[48:51], v[144:147]
    ds_read_b64_tr_b16 v[228:229], v8 offset:16672
    v_mfma_f32_16x16x32_bf16 v[148:151], v[236:239], v[52:55], v[148:151]
    ds_read_b64_tr_b16 v[230:231], v8 offset:17696
    s_waitcnt vmcnt(13) lgkmcnt(6)
    v_mfma_f32_16x16x32_bf16 v[88:91], v[240:243], v[56:59], v[88:91]
    ds_read_b64_tr_b16 v[232:233], v7 offset:16896
    s_waitcnt vmcnt(12)
    v_mfma_f32_16x16x32_bf16 v[92:95], v[240:243], v[60:63], v[92:95]
    ds_read_b64_tr_b16 v[234:235], v7 offset:17920
    s_waitcnt lgkmcnt(6)
    v_mfma_f32_16x16x32_bf16 v[96:99], v[244:247], v[56:59], v[96:99]
    ds_read_b64_tr_b16 v[236:237], v8 offset:16928
    v_mfma_f32_16x16x32_bf16 v[100:103], v[244:247], v[60:63], v[100:103]
    ds_read_b64_tr_b16 v[238:239], v8 offset:17952
    s_waitcnt lgkmcnt(6)
    v_mfma_f32_16x16x32_bf16 v[104:107], v[224:227], v[56:59], v[104:107]
    ds_read_b64_tr_b16 v[240:241], v7 offset:17152
    v_mfma_f32_16x16x32_bf16 v[108:111], v[224:227], v[60:63], v[108:111]
    ds_read_b64_tr_b16 v[242:243], v7 offset:18176
    s_waitcnt lgkmcnt(6)
    v_mfma_f32_16x16x32_bf16 v[112:115], v[228:231], v[56:59], v[112:115]
    ds_read_b64_tr_b16 v[244:245], v8 offset:17184
    v_mfma_f32_16x16x32_bf16 v[116:119], v[228:231], v[60:63], v[116:119]
    ds_read_b64_tr_b16 v[246:247], v8 offset:18208
    s_waitcnt lgkmcnt(6)
    v_mfma_f32_16x16x32_bf16 v[120:123], v[232:235], v[56:59], v[120:123]
    v_mfma_f32_16x16x32_bf16 v[124:127], v[232:235], v[60:63], v[124:127]
    s_waitcnt vmcnt(10)
    s_barrier
    ds_read_b64_tr_b16 v[224:225], v4 offset:0
    ds_read_b64_tr_b16 v[226:227], v4 offset:1024
    s_waitcnt lgkmcnt(6)
    v_mfma_f32_16x16x32_bf16 v[128:131], v[236:239], v[56:59], v[128:131]
    ds_read_b64_tr_b16 v[228:229], v5 offset:32
    v_mfma_f32_16x16x32_bf16 v[132:135], v[236:239], v[60:63], v[132:135]
    ds_read_b64_tr_b16 v[230:231], v5 offset:1056
    s_waitcnt lgkmcnt(6)
    v_mfma_f32_16x16x32_bf16 v[136:139], v[240:243], v[56:59], v[136:139]
    ds_read_b64_tr_b16 v[232:233], v4 offset:256
    v_mfma_f32_16x16x32_bf16 v[140:143], v[240:243], v[60:63], v[140:143]
    ds_read_b64_tr_b16 v[234:235], v4 offset:1280
    s_waitcnt lgkmcnt(6)
    v_mfma_f32_16x16x32_bf16 v[144:147], v[244:247], v[56:59], v[144:147]
    ds_read_b64_tr_b16 v[236:237], v5 offset:288
    v_mfma_f32_16x16x32_bf16 v[148:151], v[244:247], v[60:63], v[148:151]
    ds_read_b64_tr_b16 v[238:239], v5 offset:1312
    s_waitcnt vmcnt(9) lgkmcnt(6)
    v_mfma_f32_16x16x32_bf16 v[88:91], v[224:227], v[24:27], v[88:91]
    ds_read_b64_tr_b16 v[240:241], v4 offset:512
    s_waitcnt vmcnt(8)
    v_mfma_f32_16x16x32_bf16 v[92:95], v[224:227], v[28:31], v[92:95]
    ds_read_b64_tr_b16 v[242:243], v4 offset:1536
    s_waitcnt lgkmcnt(6)
    v_mfma_f32_16x16x32_bf16 v[96:99], v[228:231], v[24:27], v[96:99]
    ds_read_b64_tr_b16 v[244:245], v5 offset:544
    v_mfma_f32_16x16x32_bf16 v[100:103], v[228:231], v[28:31], v[100:103]
    ds_read_b64_tr_b16 v[246:247], v5 offset:1568
    s_waitcnt lgkmcnt(6)
    v_mfma_f32_16x16x32_bf16 v[104:107], v[232:235], v[24:27], v[104:107]
    ds_read_b64_tr_b16 v[224:225], v4 offset:768
    v_mfma_f32_16x16x32_bf16 v[108:111], v[232:235], v[28:31], v[108:111]
    ds_read_b64_tr_b16 v[226:227], v4 offset:1792
    s_waitcnt lgkmcnt(6)
    v_mfma_f32_16x16x32_bf16 v[112:115], v[236:239], v[24:27], v[112:115]
    ds_read_b64_tr_b16 v[228:229], v5 offset:800
    v_mfma_f32_16x16x32_bf16 v[116:119], v[236:239], v[28:31], v[116:119]
    ds_read_b64_tr_b16 v[230:231], v5 offset:1824
    s_waitcnt lgkmcnt(6)
    v_mfma_f32_16x16x32_bf16 v[120:123], v[240:243], v[24:27], v[120:123]
    v_mfma_f32_16x16x32_bf16 v[124:127], v[240:243], v[28:31], v[124:127]
    s_waitcnt vmcnt(2)
    s_barrier
    ds_read_b64_tr_b16 v[232:233], v4 offset:16384
    ds_read_b64_tr_b16 v[234:235], v4 offset:17408
    s_waitcnt lgkmcnt(6)
    v_mfma_f32_16x16x32_bf16 v[128:131], v[244:247], v[24:27], v[128:131]
    ds_read_b64_tr_b16 v[236:237], v5 offset:16416
    v_mfma_f32_16x16x32_bf16 v[132:135], v[244:247], v[28:31], v[132:135]
    ds_read_b64_tr_b16 v[238:239], v5 offset:17440
    s_waitcnt lgkmcnt(6)
    v_mfma_f32_16x16x32_bf16 v[136:139], v[224:227], v[24:27], v[136:139]
    ds_read_b64_tr_b16 v[240:241], v4 offset:16640
    v_mfma_f32_16x16x32_bf16 v[140:143], v[224:227], v[28:31], v[140:143]
    ds_read_b64_tr_b16 v[242:243], v4 offset:17664
    s_waitcnt lgkmcnt(6)
    v_mfma_f32_16x16x32_bf16 v[144:147], v[228:231], v[24:27], v[144:147]
    ds_read_b64_tr_b16 v[244:245], v5 offset:16672
    v_mfma_f32_16x16x32_bf16 v[148:151], v[228:231], v[28:31], v[148:151]
    ds_read_b64_tr_b16 v[246:247], v5 offset:17696
    s_waitcnt vmcnt(1) lgkmcnt(6)
    v_mfma_f32_16x16x32_bf16 v[88:91], v[232:235], v[32:35], v[88:91]
    ds_read_b64_tr_b16 v[224:225], v4 offset:16896
    s_waitcnt vmcnt(0)
    v_mfma_f32_16x16x32_bf16 v[92:95], v[232:235], v[36:39], v[92:95]
    ds_read_b64_tr_b16 v[226:227], v4 offset:17920
    s_waitcnt lgkmcnt(6)
    v_mfma_f32_16x16x32_bf16 v[96:99], v[236:239], v[32:35], v[96:99]
    ds_read_b64_tr_b16 v[228:229], v5 offset:16928
    v_mfma_f32_16x16x32_bf16 v[100:103], v[236:239], v[36:39], v[100:103]
    ds_read_b64_tr_b16 v[230:231], v5 offset:17952
    s_waitcnt lgkmcnt(6)
    v_mfma_f32_16x16x32_bf16 v[104:107], v[240:243], v[32:35], v[104:107]
    ds_read_b64_tr_b16 v[232:233], v4 offset:17152
    v_mfma_f32_16x16x32_bf16 v[108:111], v[240:243], v[36:39], v[108:111]
    ds_read_b64_tr_b16 v[234:235], v4 offset:18176
    s_waitcnt lgkmcnt(6)
    v_mfma_f32_16x16x32_bf16 v[112:115], v[244:247], v[32:35], v[112:115]
    ds_read_b64_tr_b16 v[236:237], v5 offset:17184
    v_mfma_f32_16x16x32_bf16 v[116:119], v[244:247], v[36:39], v[116:119]
    ds_read_b64_tr_b16 v[238:239], v5 offset:18208
    s_waitcnt lgkmcnt(6)
    v_mfma_f32_16x16x32_bf16 v[120:123], v[224:227], v[32:35], v[120:123]
    v_mfma_f32_16x16x32_bf16 v[124:127], v[224:227], v[36:39], v[124:127]
    s_waitcnt lgkmcnt(4)
    v_mfma_f32_16x16x32_bf16 v[128:131], v[228:231], v[32:35], v[128:131]
    v_mfma_f32_16x16x32_bf16 v[132:135], v[228:231], v[36:39], v[132:135]
    s_waitcnt lgkmcnt(2)
    v_mfma_f32_16x16x32_bf16 v[136:139], v[232:235], v[32:35], v[136:139]
    v_mfma_f32_16x16x32_bf16 v[140:143], v[232:235], v[36:39], v[140:143]
    s_waitcnt lgkmcnt(0)
    v_mfma_f32_16x16x32_bf16 v[144:147], v[236:239], v[32:35], v[144:147]
    v_mfma_f32_16x16x32_bf16 v[148:151], v[236:239], v[36:39], v[148:151]
    s_lshl_b32 s16, s3, 13
    s_xor_b32 s17, s16, 0x8000
    s_add_u32 s16, s16, 0x18000
    s_add_u32 s17, s17, 0x18000
    v_add_u32 v16, s16, v2
    s_mov_b32 s16, s17
    v_add_u32 v17, s16, v2
    ds_write_b128 v16, v[120:123] offset:0
    ds_write_b128 v16, v[124:127] offset:1024
    ds_write_b128 v16, v[128:131] offset:2048
    ds_write_b128 v16, v[132:135] offset:3072
    ds_write_b128 v16, v[136:139] offset:4096
    ds_write_b128 v16, v[140:143] offset:5120
    ds_write_b128 v16, v[144:147] offset:6144
    ds_write_b128 v16, v[148:151] offset:7168
    v_lshlrev_b32 v24, 16, v248
    v_and_b32 v25, 0xffff0000, v248
    v_lshlrev_b32 v26, 16, v249
    v_and_b32 v27, 0xffff0000, v249
    v_lshlrev_b32 v28, 16, v250
    v_and_b32 v29, 0xffff0000, v250
    v_lshlrev_b32 v30, 16, v251
    v_and_b32 v31, 0xffff0000, v251
    v_lshlrev_b32 v32, 16, v252
    v_and_b32 v33, 0xffff0000, v252
    v_lshlrev_b32 v34, 16, v253
    v_and_b32 v35, 0xffff0000, v253
    v_lshlrev_b32 v36, 16, v254
    v_and_b32 v37, 0xffff0000, v254
    v_lshlrev_b32 v38, 16, v255
    v_and_b32 v39, 0xffff0000, v255
    v_and_b32 v18, 15, v1
    v_lshlrev_b32 v18, 6, v18
    v_lshrrev_b32 v19, 4, v1
    v_and_b32 v20, 1, v19
    v_lshl_add_u32 v18, v20, 5, v18
    v_lshrrev_b32 v19, 1, v19
    v_lshl_add_u32 v18, v19, 4, v18
    s_and_b32 s17, s3, 3
    s_lshl_b32 s18, s30, 2
    s_add_u32 s18, s18, s17
    s_lshl_b32 s18, s18, 16
    s_lshl_b32 s19, s15, 22
    s_add_u32 s18, s18, s19
    s_lshl_b32 s19, s31, 12
    s_add_u32 s18, s18, s19
    s_add_u32 s18, s18, 0x2000000
    s_add_u32 s19, s18, 32768
    s_waitcnt lgkmcnt(0)
    s_barrier
    ds_read_b128 v[40:43], v17 offset:0
    ds_read_b128 v[44:47], v17 offset:1024
    ds_read_b128 v[48:51], v17 offset:2048
    ds_read_b128 v[52:55], v17 offset:3072
    ds_read_b128 v[56:59], v17 offset:4096
    ds_read_b128 v[60:63], v17 offset:5120
    ds_read_b128 v[64:67], v17 offset:6144
    ds_read_b128 v[68:71], v17 offset:7168
    s_waitcnt lgkmcnt(7)
    v_pk_add_f32 v[88:89], v[88:89], v[40:41]
    v_pk_add_f32 v[90:91], v[90:91], v[42:43]
    v_pk_mul_f32 v[88:89], v[88:89], v[24:25]
    v_pk_mul_f32 v[90:91], v[90:91], v[26:27]
    v_cvt_pk_bf16_f32 v224, v88, v89
    v_cvt_pk_bf16_f32 v225, v90, v91
    s_waitcnt lgkmcnt(5)
    v_pk_add_f32 v[96:97], v[96:97], v[48:49]
    v_pk_add_f32 v[98:99], v[98:99], v[50:51]
    v_pk_mul_f32 v[96:97], v[96:97], v[28:29]
    v_pk_mul_f32 v[98:99], v[98:99], v[30:31]
    v_cvt_pk_bf16_f32 v226, v96, v97
    v_cvt_pk_bf16_f32 v227, v98, v99
    s_nop 0
    v_permlane16_swap_b32 v224, v226
    v_permlane16_swap_b32 v225, v227
    buffer_store_dwordx4 v[224:227], v18, s[8:11], s18 offen offset:0 sc1
    v_pk_add_f32 v[92:93], v[92:93], v[44:45]
    v_pk_add_f32 v[94:95], v[94:95], v[46:47]
    v_pk_mul_f32 v[92:93], v[92:93], v[24:25]
    v_pk_mul_f32 v[94:95], v[94:95], v[26:27]
    v_cvt_pk_bf16_f32 v228, v92, v93
    v_cvt_pk_bf16_f32 v229, v94, v95
    s_waitcnt lgkmcnt(4)
    v_pk_add_f32 v[100:101], v[100:101], v[52:53]
    v_pk_add_f32 v[102:103], v[102:103], v[54:55]
    v_pk_mul_f32 v[100:101], v[100:101], v[28:29]
    v_pk_mul_f32 v[102:103], v[102:103], v[30:31]
    v_cvt_pk_bf16_f32 v230, v100, v101
    v_cvt_pk_bf16_f32 v231, v102, v103
    s_nop 0
    v_permlane16_swap_b32 v228, v230
    v_permlane16_swap_b32 v229, v231
    buffer_store_dwordx4 v[228:231], v18, s[8:11], s19 offen offset:0 sc1
    s_waitcnt lgkmcnt(3)
    v_pk_add_f32 v[104:105], v[104:105], v[56:57]
    v_pk_add_f32 v[106:107], v[106:107], v[58:59]
    v_pk_mul_f32 v[104:105], v[104:105], v[32:33]
    v_pk_mul_f32 v[106:107], v[106:107], v[34:35]
    v_cvt_pk_bf16_f32 v232, v104, v105
    v_cvt_pk_bf16_f32 v233, v106, v107
    s_waitcnt lgkmcnt(1)
    v_pk_add_f32 v[112:113], v[112:113], v[64:65]
    v_pk_add_f32 v[114:115], v[114:115], v[66:67]
    v_pk_mul_f32 v[112:113], v[112:113], v[36:37]
    v_pk_mul_f32 v[114:115], v[114:115], v[38:39]
    v_cvt_pk_bf16_f32 v234, v112, v113
    v_cvt_pk_bf16_f32 v235, v114, v115
    s_nop 0
    v_permlane16_swap_b32 v232, v234
    v_permlane16_swap_b32 v233, v235
    buffer_store_dwordx4 v[232:235], v18, s[8:11], s18 offen offset:1024 sc1
    v_pk_add_f32 v[108:109], v[108:109], v[60:61]
    v_pk_add_f32 v[110:111], v[110:111], v[62:63]
    v_pk_mul_f32 v[108:109], v[108:109], v[32:33]
    v_pk_mul_f32 v[110:111], v[110:111], v[34:35]
    v_cvt_pk_bf16_f32 v236, v108, v109
    v_cvt_pk_bf16_f32 v237, v110, v111
    s_waitcnt lgkmcnt(0)
    v_pk_add_f32 v[116:117], v[116:117], v[68:69]
    v_pk_add_f32 v[118:119], v[118:119], v[70:71]
    v_pk_mul_f32 v[116:117], v[116:117], v[36:37]
    v_pk_mul_f32 v[118:119], v[118:119], v[38:39]
    v_cvt_pk_bf16_f32 v238, v116, v117
    v_cvt_pk_bf16_f32 v239, v118, v119
    s_nop 0
    v_permlane16_swap_b32 v236, v238
    v_permlane16_swap_b32 v237, v239
    buffer_store_dwordx4 v[236:239], v18, s[8:11], s19 offen offset:1024 sc1
    s_mov_b64 s[64:65], s[44:45]
    s_mov_b32 s66, 0x800
    s_mov_b32 s67, 0x20000
    s_mov_b64 s[76:77], s[32:33]
    s_mov_b32 s78, 0x400000
    s_mov_b32 s79, 0x20000
    s_mov_b64 s[68:69], s[56:57]
    s_mov_b32 s70, 0x400000
    s_mov_b32 s71, 0x20000
    s_lshl_b32 s14, s31, 1
    s_add_u32 s14, s14, s15
    s_lshl_b32 s14, s14, 3
    s_add_u32 s14, s14, s3
    s_lshl_b32 s16, s30, 7
    s_add_u32 s14, s14, s16
    s_lshl_b32 s16, s14, 11
    buffer_load_dwordx4 v[216:219], v2, s[76:79], s16 offen offset:0
    buffer_load_dwordx4 v[220:223], v2, s[76:79], s16 offen offset:1024
    s_lshl_b32 s16, s3, 10
    s_add_u32 m0, s16, 81920
    s_add_u32 s16, s16, 0x540800
    buffer_load_dwordx4 v2, s[8:11], s16 offen sc1 lds
    s_lshl_b32 s16, s30, 5
    s_lshl_b32 s17, s31, 1
    s_add_u32 s16, s16, s17
    s_add_u32 s16, s16, s15
    s_lshl_b32 s16, s16, 2
    s_add_u32 s16, s16, 0x530000
    s_cmp_eq_u32 s3, 0
    s_cselect_b32 s16, s16, 0x7ffffff0
    v_mov_b32 v16, s28
    v_mov_b32 v17, 0
    s_lshr_b32 s18, s14, 4
    s_lshl_b32 s18, s18, 15
    s_and_b32 s19, s14, 15
    s_lshl_b32 s19, s19, 6
    s_add_u32 s18, s18, s19
    s_add_u32 s18, s18, 0x2000000
    s_add_u32 s19, s18, 16384
    v_lshrrev_b32 v18, 2, v1
    v_lshlrev_b32 v18, 10, v18
    v_and_b32 v19, 3, v1
    v_lshl_add_u32 v18, v19, 4, v18
    v_add_u32 v19, 0x400000, v18
    s_lshl_b32 s25, s30, 7
    s_add_u32 s25, s25, 0x530000
    v_and_b32 v20, 15, v1
    v_lshlrev_b32 v20, 2, v20
    s_waitcnt vmcnt(3)
    s_waitcnt vmcnt(0)
    s_barrier
    s_mov_b64 exec, 1
    buffer_store_dword v16, v17, s[8:11], s16 offen sc1
    s_mov_b64 exec, -1
    v_add_u32 v16, 81920, v2
    ds_read_b128 v[184:187], v16 offset:0
    ds_read_b128 v[188:191], v16 offset:1024
    ds_read_b128 v[192:195], v16 offset:2048
    ds_read_b128 v[196:199], v16 offset:3072
    ds_read_b128 v[200:203], v16 offset:4096
    ds_read_b128 v[204:207], v16 offset:5120
    ds_read_b128 v[208:211], v16 offset:6144
    ds_read_b128 v[212:215], v16 offset:7168
    v_mov_b32 v94, 0
    v_mov_b32 v95, 0
    s_waitcnt lgkmcnt(5)
    v_lshlrev_b32 v76, 16, v192
    v_and_b32 v77, 0xffff0000, v192
    s_waitcnt lgkmcnt(1)
    v_lshlrev_b32 v78, 16, v208
    v_and_b32 v79, 0xffff0000, v208
    v_pk_mul_f32 v[60:61], v[76:77], v[78:79]
    v_lshlrev_b32 v76, 16, v184
    v_and_b32 v77, 0xffff0000, v184
    v_fmac_f32 v94, v76, v78
    v_fmac_f32 v94, v77, v79
    v_add_f32 v95, v95, v60
    v_add_f32 v95, v95, v61
    v_lshlrev_b32 v76, 16, v193
    v_and_b32 v77, 0xffff0000, v193
    v_lshlrev_b32 v78, 16, v209
    v_and_b32 v79, 0xffff0000, v209
    v_pk_mul_f32 v[62:63], v[76:77], v[78:79]
    v_lshlrev_b32 v76, 16, v185
    v_and_b32 v77, 0xffff0000, v185
    v_fmac_f32 v94, v76, v78
    v_fmac_f32 v94, v77, v79
    v_add_f32 v95, v95, v62
    v_add_f32 v95, v95, v63
    v_lshlrev_b32 v76, 16, v194
    v_and_b32 v77, 0xffff0000, v194
    v_lshlrev_b32 v78, 16, v210
    v_and_b32 v79, 0xffff0000, v210
    v_pk_mul_f32 v[64:65], v[76:77], v[78:79]
    v_lshlrev_b32 v76, 16, v186
    v_and_b32 v77, 0xffff0000, v186
    v_fmac_f32 v94, v76, v78
    v_fmac_f32 v94, v77, v79
    v_add_f32 v95, v95, v64
    v_add_f32 v95, v95, v65
    v_lshlrev_b32 v76, 16, v195
    v_and_b32 v77, 0xffff0000, v195
    v_lshlrev_b32 v78, 16, v211
    v_and_b32 v79, 0xffff0000, v211
    v_pk_mul_f32 v[66:67], v[76:77], v[78:79]
    v_lshlrev_b32 v76, 16, v187
    v_and_b32 v77, 0xffff0000, v187
    v_fmac_f32 v94, v76, v78
    v_fmac_f32 v94, v77, v79
    v_add_f32 v95, v95, v66
    v_add_f32 v95, v95, v67
    v_lshlrev_b32 v76, 16, v196
    v_and_b32 v77, 0xffff0000, v196
    s_waitcnt lgkmcnt(0)
    v_lshlrev_b32 v78, 16, v212
    v_and_b32 v79, 0xffff0000, v212
    v_pk_mul_f32 v[68:69], v[76:77], v[78:79]
    v_lshlrev_b32 v76, 16, v188
    v_and_b32 v77, 0xffff0000, v188
    v_fmac_f32 v94, v76, v78
    v_fmac_f32 v94, v77, v79
    v_add_f32 v95, v95, v68
    v_add_f32 v95, v95, v69
    v_lshlrev_b32 v76, 16, v197
    v_and_b32 v77, 0xffff0000, v197
    v_lshlrev_b32 v78, 16, v213
    v_and_b32 v79, 0xffff0000, v213
    v_pk_mul_f32 v[70:71], v[76:77], v[78:79]
    v_lshlrev_b32 v76, 16, v189
    v_and_b32 v77, 0xffff0000, v189
    v_fmac_f32 v94, v76, v78
    v_fmac_f32 v94, v77, v79
    v_add_f32 v95, v95, v70
    v_add_f32 v95, v95, v71
    v_lshlrev_b32 v76, 16, v198
    v_and_b32 v77, 0xffff0000, v198
    v_lshlrev_b32 v78, 16, v214
    v_and_b32 v79, 0xffff0000, v214
    v_pk_mul_f32 v[72:73], v[76:77], v[78:79]
    v_lshlrev_b32 v76, 16, v190
    v_and_b32 v77, 0xffff0000, v190
    v_fmac_f32 v94, v76, v78
    v_fmac_f32 v94, v77, v79
    v_add_f32 v95, v95, v72
    v_add_f32 v95, v95, v73
    v_lshlrev_b32 v76, 16, v199
    v_and_b32 v77, 0xffff0000, v199
    v_lshlrev_b32 v78, 16, v215
    v_and_b32 v79, 0xffff0000, v215
    v_pk_mul_f32 v[74:75], v[76:77], v[78:79]
    v_lshlrev_b32 v76, 16, v191
    v_and_b32 v77, 0xffff0000, v191
    v_fmac_f32 v94, v76, v78
    v_fmac_f32 v94, v77, v79
    v_add_f32 v95, v95, v74
    v_add_f32 v95, v95, v75
    v_add_f32_dpp v94, v94, v94 row_ror:1 row_mask:0xf bank_mask:0xf
    s_nop 0
    v_add_f32_dpp v95, v95, v95 row_ror:1 row_mask:0xf bank_mask:0xf
    v_add_f32_dpp v94, v94, v94 row_ror:2 row_mask:0xf bank_mask:0xf
    s_nop 0
    v_add_f32_dpp v95, v95, v95 row_ror:2 row_mask:0xf bank_mask:0xf
    v_add_f32_dpp v94, v94, v94 row_ror:4 row_mask:0xf bank_mask:0xf
    s_nop 0
    v_add_f32_dpp v95, v95, v95 row_ror:4 row_mask:0xf bank_mask:0xf
    v_add_f32_dpp v94, v94, v94 row_ror:8 row_mask:0xf bank_mask:0xf
    s_nop 0
    v_add_f32_dpp v95, v95, v95 row_ror:8 row_mask:0xf bank_mask:0xf
    v_mov_b32 v76, v94
    s_nop 1
    v_permlane16_swap_b32 v94, v76
    v_add_f32 v94, v94, v76
    v_mov_b32 v77, v95
    s_nop 1
    v_permlane16_swap_b32 v95, v77
    v_add_f32 v95, v95, v77
    v_mov_b32 v76, v94
    s_nop 1
    v_permlane32_swap_b32 v94, v76
    v_add_f32 v94, v94, v76
    v_mov_b32 v77, v95
    s_nop 1
    v_permlane32_swap_b32 v95, v77
    v_add_f32 v95, v95, v77
    v_lshlrev_b32 v28, 16, v216
    v_and_b32 v29, 0xffff0000, v216
    v_lshlrev_b32 v30, 16, v217
    v_and_b32 v31, 0xffff0000, v217
    v_lshlrev_b32 v32, 16, v218
    v_and_b32 v33, 0xffff0000, v218
    v_lshlrev_b32 v34, 16, v219
    v_and_b32 v35, 0xffff0000, v219
    v_lshlrev_b32 v36, 16, v220
    v_and_b32 v37, 0xffff0000, v220
    v_lshlrev_b32 v38, 16, v221
    v_and_b32 v39, 0xffff0000, v221
    v_lshlrev_b32 v40, 16, v222
    v_and_b32 v41, 0xffff0000, v222
    v_lshlrev_b32 v42, 16, v223
    v_and_b32 v43, 0xffff0000, v223
    s_mov_b32 s27, 0
adaLN_cond__sliding_block_cached__moe_arch_mod__prompt_kernel_a11p:
    buffer_load_dword v76, v20, s[8:11], s25 offen sc1
    s_waitcnt vmcnt(0)
    v_cmp_ne_u32 vcc, s28, v76
    s_add_u32 s27, s27, 1
    s_cmp_ge_u32 s27, 65536
    s_cbranch_scc1 adaLN_cond__sliding_block_cached__moe_arch_mod__prompt_kernel_a11g
    s_cbranch_vccnz adaLN_cond__sliding_block_cached__moe_arch_mod__prompt_kernel_a11p
adaLN_cond__sliding_block_cached__moe_arch_mod__prompt_kernel_a11g:
    buffer_load_dwordx4 v[44:47], v18, s[8:11], s18 offen sc1
    buffer_load_dwordx4 v[52:55], v19, s[8:11], s18 offen sc1
    buffer_load_dwordx4 v[48:51], v18, s[8:11], s19 offen sc1
    buffer_load_dwordx4 v[56:59], v19, s[8:11], s19 offen sc1
    v_lshlrev_b32 v21, 2, v0
    s_mov_b32 s16, 0x540800
    buffer_load_dword v106, v21, s[8:11], s16 offen sc1
    buffer_load_dword v104, v21, s[8:11], s16 offen offset:2048 sc1
    s_waitcnt vmcnt(5)
    v_lshlrev_b32 v76, 16, v44
    v_and_b32 v77, 0xffff0000, v44
    s_waitcnt vmcnt(4)
    v_lshlrev_b32 v78, 16, v52
    v_and_b32 v79, 0xffff0000, v52
    v_pk_add_f32 v[76:77], v[76:77], v[78:79]
    v_pk_add_f32 v[28:29], v[28:29], v[76:77]
    v_cvt_pk_bf16_f32 v16, v28, v29
    v_lshlrev_b32 v28, 16, v16
    v_and_b32 v29, 0xffff0000, v16
    v_lshlrev_b32 v80, 16, v45
    v_and_b32 v81, 0xffff0000, v45
    v_lshlrev_b32 v82, 16, v53
    v_and_b32 v83, 0xffff0000, v53
    v_pk_add_f32 v[80:81], v[80:81], v[82:83]
    v_pk_add_f32 v[30:31], v[30:31], v[80:81]
    v_cvt_pk_bf16_f32 v17, v30, v31
    v_lshlrev_b32 v30, 16, v17
    v_and_b32 v31, 0xffff0000, v17
    v_lshlrev_b32 v76, 16, v46
    v_and_b32 v77, 0xffff0000, v46
    v_lshlrev_b32 v78, 16, v54
    v_and_b32 v79, 0xffff0000, v54
    v_pk_add_f32 v[76:77], v[76:77], v[78:79]
    v_pk_add_f32 v[32:33], v[32:33], v[76:77]
    v_cvt_pk_bf16_f32 v16, v32, v33
    v_lshlrev_b32 v32, 16, v16
    v_and_b32 v33, 0xffff0000, v16
    v_lshlrev_b32 v80, 16, v47
    v_and_b32 v81, 0xffff0000, v47
    v_lshlrev_b32 v82, 16, v55
    v_and_b32 v83, 0xffff0000, v55
    v_pk_add_f32 v[80:81], v[80:81], v[82:83]
    v_pk_add_f32 v[34:35], v[34:35], v[80:81]
    v_cvt_pk_bf16_f32 v17, v34, v35
    v_lshlrev_b32 v34, 16, v17
    v_and_b32 v35, 0xffff0000, v17
    s_waitcnt vmcnt(3)
    v_lshlrev_b32 v76, 16, v48
    v_and_b32 v77, 0xffff0000, v48
    s_waitcnt vmcnt(2)
    v_lshlrev_b32 v78, 16, v56
    v_and_b32 v79, 0xffff0000, v56
    v_pk_add_f32 v[76:77], v[76:77], v[78:79]
    v_pk_add_f32 v[36:37], v[36:37], v[76:77]
    v_cvt_pk_bf16_f32 v16, v36, v37
    v_lshlrev_b32 v36, 16, v16
    v_and_b32 v37, 0xffff0000, v16
    v_lshlrev_b32 v80, 16, v49
    v_and_b32 v81, 0xffff0000, v49
    v_lshlrev_b32 v82, 16, v57
    v_and_b32 v83, 0xffff0000, v57
    v_pk_add_f32 v[80:81], v[80:81], v[82:83]
    v_pk_add_f32 v[38:39], v[38:39], v[80:81]
    v_cvt_pk_bf16_f32 v17, v38, v39
    v_lshlrev_b32 v38, 16, v17
    v_and_b32 v39, 0xffff0000, v17
    v_lshlrev_b32 v76, 16, v50
    v_and_b32 v77, 0xffff0000, v50
    v_lshlrev_b32 v78, 16, v58
    v_and_b32 v79, 0xffff0000, v58
    v_pk_add_f32 v[76:77], v[76:77], v[78:79]
    v_pk_add_f32 v[40:41], v[40:41], v[76:77]
    v_cvt_pk_bf16_f32 v16, v40, v41
    v_lshlrev_b32 v40, 16, v16
    v_and_b32 v41, 0xffff0000, v16
    v_lshlrev_b32 v80, 16, v51
    v_and_b32 v81, 0xffff0000, v51
    v_lshlrev_b32 v82, 16, v59
    v_and_b32 v83, 0xffff0000, v59
    v_pk_add_f32 v[80:81], v[80:81], v[82:83]
    v_pk_add_f32 v[42:43], v[42:43], v[80:81]
    v_cvt_pk_bf16_f32 v17, v42, v43
    v_lshlrev_b32 v42, 16, v17
    v_and_b32 v43, 0xffff0000, v17
    v_pk_add_f32 v[76:77], v[28:29], v[30:31]
    v_pk_mul_f32 v[78:79], v[28:29], v[28:29]
    v_pk_mul_f32 v[80:81], v[28:29], v[60:61]
    v_pk_fma_f32 v[78:79], v[30:31], v[30:31], v[78:79]
    v_pk_fma_f32 v[80:81], v[30:31], v[62:63], v[80:81]
    v_pk_add_f32 v[76:77], v[76:77], v[32:33]
    v_pk_fma_f32 v[78:79], v[32:33], v[32:33], v[78:79]
    v_pk_fma_f32 v[80:81], v[32:33], v[64:65], v[80:81]
    v_pk_add_f32 v[76:77], v[76:77], v[34:35]
    v_pk_fma_f32 v[78:79], v[34:35], v[34:35], v[78:79]
    v_pk_fma_f32 v[80:81], v[34:35], v[66:67], v[80:81]
    v_pk_add_f32 v[76:77], v[76:77], v[36:37]
    v_pk_fma_f32 v[78:79], v[36:37], v[36:37], v[78:79]
    v_pk_fma_f32 v[80:81], v[36:37], v[68:69], v[80:81]
    v_pk_add_f32 v[76:77], v[76:77], v[38:39]
    v_pk_fma_f32 v[78:79], v[38:39], v[38:39], v[78:79]
    v_pk_fma_f32 v[80:81], v[38:39], v[70:71], v[80:81]
    v_pk_add_f32 v[76:77], v[76:77], v[40:41]
    v_pk_fma_f32 v[78:79], v[40:41], v[40:41], v[78:79]
    v_pk_fma_f32 v[80:81], v[40:41], v[72:73], v[80:81]
    v_pk_add_f32 v[76:77], v[76:77], v[42:43]
    v_pk_fma_f32 v[78:79], v[42:43], v[42:43], v[78:79]
    v_pk_fma_f32 v[80:81], v[42:43], v[74:75], v[80:81]
    v_add_f32 v96, v76, v77
    v_add_f32 v97, v78, v79
    v_add_f32 v98, v80, v81
    v_add_f32_dpp v96, v96, v96 row_ror:1 row_mask:0xf bank_mask:0xf
    v_add_f32_dpp v97, v97, v97 row_ror:1 row_mask:0xf bank_mask:0xf
    v_add_f32_dpp v98, v98, v98 row_ror:1 row_mask:0xf bank_mask:0xf
    v_add_f32_dpp v96, v96, v96 row_ror:2 row_mask:0xf bank_mask:0xf
    v_add_f32_dpp v97, v97, v97 row_ror:2 row_mask:0xf bank_mask:0xf
    v_add_f32_dpp v98, v98, v98 row_ror:2 row_mask:0xf bank_mask:0xf
    v_add_f32_dpp v96, v96, v96 row_ror:4 row_mask:0xf bank_mask:0xf
    v_add_f32_dpp v97, v97, v97 row_ror:4 row_mask:0xf bank_mask:0xf
    v_add_f32_dpp v98, v98, v98 row_ror:4 row_mask:0xf bank_mask:0xf
    v_add_f32_dpp v96, v96, v96 row_ror:8 row_mask:0xf bank_mask:0xf
    v_add_f32_dpp v97, v97, v97 row_ror:8 row_mask:0xf bank_mask:0xf
    v_add_f32_dpp v98, v98, v98 row_ror:8 row_mask:0xf bank_mask:0xf
    v_mov_b32 v76, v96
    s_nop 1
    v_permlane16_swap_b32 v96, v76
    v_add_f32 v96, v96, v76
    v_mov_b32 v77, v97
    s_nop 1
    v_permlane16_swap_b32 v97, v77
    v_add_f32 v97, v97, v77
    v_mov_b32 v78, v98
    s_nop 1
    v_permlane16_swap_b32 v98, v78
    v_add_f32 v98, v98, v78
    v_mov_b32 v76, v96
    s_nop 1
    v_permlane32_swap_b32 v96, v76
    v_add_f32 v96, v96, v76
    v_mov_b32 v77, v97
    s_nop 1
    v_permlane32_swap_b32 v97, v77
    v_add_f32 v97, v97, v77
    v_mov_b32 v78, v98
    s_nop 1
    v_permlane32_swap_b32 v98, v78
    v_add_f32 v98, v98, v78
    v_mul_f32 v96, 0x3a800000, v96
    v_mul_f32 v97, 0x3a800000, v97
    v_fma_f32 v97, -v96, v96, v97
    v_max_f32 v97, 0, v97
    v_fma_f32 v98, -v96, v95, v98
    v_add_f32 v76, 0x3727c5ac, v97
    v_rsq_f32 v76, v76
    s_nop 0
    v_fma_f32 v27, v98, v76, v94
    v_cvt_pk_bf16_f32 v96, v96, v96
    v_lshlrev_b32 v96, 16, v96
    v_cvt_pk_bf16_f32 v97, v97, v97
    v_lshlrev_b32 v97, 16, v97
    v_add_f32 v97, 0x3727c5ac, v97
    v_cvt_pk_bf16_f32 v97, v97, v97
    v_lshlrev_b32 v97, 16, v97
    v_sqrt_f32 v98, v97
    s_nop 0
    v_cvt_pk_bf16_f32 v98, v98, v98
    v_lshlrev_b32 v98, 16, v98
    v_rcp_f32 v99, v98
    v_mov_b32 v25, v96
    v_mov_b32 v26, v98
    v_ashrrev_i32 v16, 31, v27
    v_or_b32 v16, 0x80000000, v16
    v_xor_b32 v24, v27, v16
    v_and_b32 v24, 0xfffff800, v24
    v_max_u32 v24, 0x800, v24
    s_sub_u32 s16, 2047, s14
    v_or_b32 v24, s16, v24
    s_lshl_b32 s16, s3, 4
    s_add_u32 s16, s16, 65536
    v_mov_b32 v16, s16
    ds_write_b128 v16, v[24:27]
    s_waitcnt lgkmcnt(0)
    s_barrier
    v_and_b32 v16, 7, v1
    v_lshlrev_b32 v16, 4, v16
    v_add_u32 v16, 65536, v16
    ds_read_b32 v76, v16
    s_waitcnt lgkmcnt(0)
    v_mov_b32 v77, v76
    s_nop 1
    v_max_u32_dpp v77, v77, v77 row_ror:1 row_mask:0xf bank_mask:0xf
    s_nop 1
    v_max_u32_dpp v77, v77, v77 row_ror:2 row_mask:0xf bank_mask:0xf
    s_nop 1
    v_max_u32_dpp v77, v77, v77 row_ror:4 row_mask:0xf bank_mask:0xf
    v_cmp_eq_u32 vcc, v76, v77
    s_ff1_i32_b64 s16, vcc
    s_lshl_b32 s16, s16, 4
    s_add_u32 s16, s16, 65536
    v_mov_b32 v16, s16
    ds_read_b128 v[24:27], v16
    s_lshl_b32 s16, s2, 4
    s_add_u32 s16, s16, 0x6e0000
    s_cmp_eq_u32 s3, 0
    s_cselect_b32 s16, s16, 0x7ffffff0
    v_mov_b32 v17, 0
    s_mov_b64 exec, 1
    s_waitcnt lgkmcnt(0)
    buffer_store_dwordx4 v[24:27], v17, s[8:11], s16 offen sc1
    s_mov_b64 exec, -1
    v_sub_f32 v44, v28, v96
    v_sub_f32 v45, v29, v96
    v_sub_f32 v46, v30, v96
    v_sub_f32 v47, v31, v96
    v_sub_f32 v48, v32, v96
    v_sub_f32 v49, v33, v96
    v_sub_f32 v50, v34, v96
    v_sub_f32 v51, v35, v96
    v_cvt_pk_bf16_f32 v16, v44, v45
    v_lshlrev_b32 v44, 16, v16
    v_and_b32 v45, 0xffff0000, v16
    v_cvt_pk_bf16_f32 v16, v46, v47
    v_lshlrev_b32 v46, 16, v16
    v_and_b32 v47, 0xffff0000, v16
    v_cvt_pk_bf16_f32 v16, v48, v49
    v_lshlrev_b32 v48, 16, v16
    v_and_b32 v49, 0xffff0000, v16
    v_cvt_pk_bf16_f32 v16, v50, v51
    v_lshlrev_b32 v50, 16, v16
    v_and_b32 v51, 0xffff0000, v16
    v_mul_f32 v52, v44, v99
    v_mul_f32 v53, v45, v99
    v_mul_f32 v54, v46, v99
    v_mul_f32 v55, v47, v99
    v_mul_f32 v56, v48, v99
    v_mul_f32 v57, v49, v99
    v_mul_f32 v58, v50, v99
    v_mul_f32 v59, v51, v99
    v_fma_f32 v44, -v52, v98, v44
    v_fma_f32 v45, -v53, v98, v45
    v_fma_f32 v46, -v54, v98, v46
    v_fma_f32 v47, -v55, v98, v47
    v_fma_f32 v48, -v56, v98, v48
    v_fma_f32 v49, -v57, v98, v49
    v_fma_f32 v50, -v58, v98, v50
    v_fma_f32 v51, -v59, v98, v51
    v_fma_f32 v44, v44, v99, v52
    v_fma_f32 v45, v45, v99, v53
    v_fma_f32 v46, v46, v99, v54
    v_fma_f32 v47, v47, v99, v55
    v_fma_f32 v48, v48, v99, v56
    v_fma_f32 v49, v49, v99, v57
    v_fma_f32 v50, v50, v99, v58
    v_fma_f32 v51, v51, v99, v59
    v_cvt_pk_bf16_f32 v16, v44, v45
    v_lshlrev_b32 v44, 16, v16
    v_and_b32 v45, 0xffff0000, v16
    v_cvt_pk_bf16_f32 v16, v46, v47
    v_lshlrev_b32 v46, 16, v16
    v_and_b32 v47, 0xffff0000, v16
    v_cvt_pk_bf16_f32 v16, v48, v49
    v_lshlrev_b32 v48, 16, v16
    v_and_b32 v49, 0xffff0000, v16
    v_cvt_pk_bf16_f32 v16, v50, v51
    v_lshlrev_b32 v50, 16, v16
    v_and_b32 v51, 0xffff0000, v16
    v_lshlrev_b32 v52, 16, v192
    v_and_b32 v53, 0xffff0000, v192
    v_lshlrev_b32 v54, 16, v193
    v_and_b32 v55, 0xffff0000, v193
    v_lshlrev_b32 v56, 16, v194
    v_and_b32 v57, 0xffff0000, v194
    v_lshlrev_b32 v58, 16, v195
    v_and_b32 v59, 0xffff0000, v195
    v_pk_mul_f32 v[44:45], v[44:45], v[52:53]
    v_pk_mul_f32 v[46:47], v[46:47], v[54:55]
    v_pk_mul_f32 v[48:49], v[48:49], v[56:57]
    v_pk_mul_f32 v[50:51], v[50:51], v[58:59]
    v_cvt_pk_bf16_f32 v16, v44, v45
    v_lshlrev_b32 v44, 16, v16
    v_and_b32 v45, 0xffff0000, v16
    v_cvt_pk_bf16_f32 v16, v46, v47
    v_lshlrev_b32 v46, 16, v16
    v_and_b32 v47, 0xffff0000, v16
    v_cvt_pk_bf16_f32 v16, v48, v49
    v_lshlrev_b32 v48, 16, v16
    v_and_b32 v49, 0xffff0000, v16
    v_cvt_pk_bf16_f32 v16, v50, v51
    v_lshlrev_b32 v50, 16, v16
    v_and_b32 v51, 0xffff0000, v16
    v_lshlrev_b32 v52, 16, v184
    v_and_b32 v53, 0xffff0000, v184
    v_lshlrev_b32 v54, 16, v185
    v_and_b32 v55, 0xffff0000, v185
    v_lshlrev_b32 v56, 16, v186
    v_and_b32 v57, 0xffff0000, v186
    v_lshlrev_b32 v58, 16, v187
    v_and_b32 v59, 0xffff0000, v187
    v_pk_add_f32 v[44:45], v[44:45], v[52:53]
    v_pk_add_f32 v[46:47], v[46:47], v[54:55]
    v_pk_add_f32 v[48:49], v[48:49], v[56:57]
    v_pk_add_f32 v[50:51], v[50:51], v[58:59]
    v_cvt_pk_bf16_f32 v16, v44, v45
    v_lshlrev_b32 v44, 16, v16
    v_and_b32 v45, 0xffff0000, v16
    v_cvt_pk_bf16_f32 v16, v46, v47
    v_lshlrev_b32 v46, 16, v16
    v_and_b32 v47, 0xffff0000, v16
    v_cvt_pk_bf16_f32 v16, v48, v49
    v_lshlrev_b32 v48, 16, v16
    v_and_b32 v49, 0xffff0000, v16
    v_cvt_pk_bf16_f32 v16, v50, v51
    v_lshlrev_b32 v50, 16, v16
    v_and_b32 v51, 0xffff0000, v16
    v_lshlrev_b32 v52, 16, v200
    v_and_b32 v53, 0xffff0000, v200
    v_lshlrev_b32 v54, 16, v201
    v_and_b32 v55, 0xffff0000, v201
    v_lshlrev_b32 v56, 16, v202
    v_and_b32 v57, 0xffff0000, v202
    v_lshlrev_b32 v58, 16, v203
    v_and_b32 v59, 0xffff0000, v203
    v_pk_mul_f32 v[44:45], v[44:45], v[52:53]
    v_pk_mul_f32 v[46:47], v[46:47], v[54:55]
    v_pk_mul_f32 v[48:49], v[48:49], v[56:57]
    v_pk_mul_f32 v[50:51], v[50:51], v[58:59]
    v_cvt_pk_bf16_f32 v16, v44, v45
    v_lshlrev_b32 v44, 16, v16
    v_and_b32 v45, 0xffff0000, v16
    v_cvt_pk_bf16_f32 v16, v46, v47
    v_lshlrev_b32 v46, 16, v16
    v_and_b32 v47, 0xffff0000, v16
    v_cvt_pk_bf16_f32 v16, v48, v49
    v_lshlrev_b32 v48, 16, v16
    v_and_b32 v49, 0xffff0000, v16
    v_cvt_pk_bf16_f32 v16, v50, v51
    v_lshlrev_b32 v50, 16, v16
    v_and_b32 v51, 0xffff0000, v16
    v_pk_add_f32 v[44:45], v[44:45], v[28:29]
    v_pk_add_f32 v[46:47], v[46:47], v[30:31]
    v_pk_add_f32 v[48:49], v[48:49], v[32:33]
    v_pk_add_f32 v[50:51], v[50:51], v[34:35]
    v_cvt_pk_bf16_f32 v28, v44, v45
    v_cvt_pk_bf16_f32 v29, v46, v47
    v_cvt_pk_bf16_f32 v30, v48, v49
    v_cvt_pk_bf16_f32 v31, v50, v51
    v_sub_f32 v44, v36, v96
    v_sub_f32 v45, v37, v96
    v_sub_f32 v46, v38, v96
    v_sub_f32 v47, v39, v96
    v_sub_f32 v48, v40, v96
    v_sub_f32 v49, v41, v96
    v_sub_f32 v50, v42, v96
    v_sub_f32 v51, v43, v96
    v_cvt_pk_bf16_f32 v16, v44, v45
    v_lshlrev_b32 v44, 16, v16
    v_and_b32 v45, 0xffff0000, v16
    v_cvt_pk_bf16_f32 v16, v46, v47
    v_lshlrev_b32 v46, 16, v16
    v_and_b32 v47, 0xffff0000, v16
    v_cvt_pk_bf16_f32 v16, v48, v49
    v_lshlrev_b32 v48, 16, v16
    v_and_b32 v49, 0xffff0000, v16
    v_cvt_pk_bf16_f32 v16, v50, v51
    v_lshlrev_b32 v50, 16, v16
    v_and_b32 v51, 0xffff0000, v16
    v_mul_f32 v52, v44, v99
    v_mul_f32 v53, v45, v99
    v_mul_f32 v54, v46, v99
    v_mul_f32 v55, v47, v99
    v_mul_f32 v56, v48, v99
    v_mul_f32 v57, v49, v99
    v_mul_f32 v58, v50, v99
    v_mul_f32 v59, v51, v99
    v_fma_f32 v44, -v52, v98, v44
    v_fma_f32 v45, -v53, v98, v45
    v_fma_f32 v46, -v54, v98, v46
    v_fma_f32 v47, -v55, v98, v47
    v_fma_f32 v48, -v56, v98, v48
    v_fma_f32 v49, -v57, v98, v49
    v_fma_f32 v50, -v58, v98, v50
    v_fma_f32 v51, -v59, v98, v51
    v_fma_f32 v44, v44, v99, v52
    v_fma_f32 v45, v45, v99, v53
    v_fma_f32 v46, v46, v99, v54
    v_fma_f32 v47, v47, v99, v55
    v_fma_f32 v48, v48, v99, v56
    v_fma_f32 v49, v49, v99, v57
    v_fma_f32 v50, v50, v99, v58
    v_fma_f32 v51, v51, v99, v59
    v_cvt_pk_bf16_f32 v16, v44, v45
    v_lshlrev_b32 v44, 16, v16
    v_and_b32 v45, 0xffff0000, v16
    v_cvt_pk_bf16_f32 v16, v46, v47
    v_lshlrev_b32 v46, 16, v16
    v_and_b32 v47, 0xffff0000, v16
    v_cvt_pk_bf16_f32 v16, v48, v49
    v_lshlrev_b32 v48, 16, v16
    v_and_b32 v49, 0xffff0000, v16
    v_cvt_pk_bf16_f32 v16, v50, v51
    v_lshlrev_b32 v50, 16, v16
    v_and_b32 v51, 0xffff0000, v16
    v_lshlrev_b32 v52, 16, v196
    v_and_b32 v53, 0xffff0000, v196
    v_lshlrev_b32 v54, 16, v197
    v_and_b32 v55, 0xffff0000, v197
    v_lshlrev_b32 v56, 16, v198
    v_and_b32 v57, 0xffff0000, v198
    v_lshlrev_b32 v58, 16, v199
    v_and_b32 v59, 0xffff0000, v199
    v_pk_mul_f32 v[44:45], v[44:45], v[52:53]
    v_pk_mul_f32 v[46:47], v[46:47], v[54:55]
    v_pk_mul_f32 v[48:49], v[48:49], v[56:57]
    v_pk_mul_f32 v[50:51], v[50:51], v[58:59]
    v_cvt_pk_bf16_f32 v16, v44, v45
    v_lshlrev_b32 v44, 16, v16
    v_and_b32 v45, 0xffff0000, v16
    v_cvt_pk_bf16_f32 v16, v46, v47
    v_lshlrev_b32 v46, 16, v16
    v_and_b32 v47, 0xffff0000, v16
    v_cvt_pk_bf16_f32 v16, v48, v49
    v_lshlrev_b32 v48, 16, v16
    v_and_b32 v49, 0xffff0000, v16
    v_cvt_pk_bf16_f32 v16, v50, v51
    v_lshlrev_b32 v50, 16, v16
    v_and_b32 v51, 0xffff0000, v16
    v_lshlrev_b32 v52, 16, v188
    v_and_b32 v53, 0xffff0000, v188
    v_lshlrev_b32 v54, 16, v189
    v_and_b32 v55, 0xffff0000, v189
    v_lshlrev_b32 v56, 16, v190
    v_and_b32 v57, 0xffff0000, v190
    v_lshlrev_b32 v58, 16, v191
    v_and_b32 v59, 0xffff0000, v191
    v_pk_add_f32 v[44:45], v[44:45], v[52:53]
    v_pk_add_f32 v[46:47], v[46:47], v[54:55]
    v_pk_add_f32 v[48:49], v[48:49], v[56:57]
    v_pk_add_f32 v[50:51], v[50:51], v[58:59]
    v_cvt_pk_bf16_f32 v16, v44, v45
    v_lshlrev_b32 v44, 16, v16
    v_and_b32 v45, 0xffff0000, v16
    v_cvt_pk_bf16_f32 v16, v46, v47
    v_lshlrev_b32 v46, 16, v16
    v_and_b32 v47, 0xffff0000, v16
    v_cvt_pk_bf16_f32 v16, v48, v49
    v_lshlrev_b32 v48, 16, v16
    v_and_b32 v49, 0xffff0000, v16
    v_cvt_pk_bf16_f32 v16, v50, v51
    v_lshlrev_b32 v50, 16, v16
    v_and_b32 v51, 0xffff0000, v16
    v_lshlrev_b32 v52, 16, v204
    v_and_b32 v53, 0xffff0000, v204
    v_lshlrev_b32 v54, 16, v205
    v_and_b32 v55, 0xffff0000, v205
    v_lshlrev_b32 v56, 16, v206
    v_and_b32 v57, 0xffff0000, v206
    v_lshlrev_b32 v58, 16, v207
    v_and_b32 v59, 0xffff0000, v207
    v_pk_mul_f32 v[44:45], v[44:45], v[52:53]
    v_pk_mul_f32 v[46:47], v[46:47], v[54:55]
    v_pk_mul_f32 v[48:49], v[48:49], v[56:57]
    v_pk_mul_f32 v[50:51], v[50:51], v[58:59]
    v_cvt_pk_bf16_f32 v16, v44, v45
    v_lshlrev_b32 v44, 16, v16
    v_and_b32 v45, 0xffff0000, v16
    v_cvt_pk_bf16_f32 v16, v46, v47
    v_lshlrev_b32 v46, 16, v16
    v_and_b32 v47, 0xffff0000, v16
    v_cvt_pk_bf16_f32 v16, v48, v49
    v_lshlrev_b32 v48, 16, v16
    v_and_b32 v49, 0xffff0000, v16
    v_cvt_pk_bf16_f32 v16, v50, v51
    v_lshlrev_b32 v50, 16, v16
    v_and_b32 v51, 0xffff0000, v16
    v_pk_add_f32 v[44:45], v[44:45], v[36:37]
    v_pk_add_f32 v[46:47], v[46:47], v[38:39]
    v_pk_add_f32 v[48:49], v[48:49], v[40:41]
    v_pk_add_f32 v[50:51], v[50:51], v[42:43]
    v_cvt_pk_bf16_f32 v36, v44, v45
    v_cvt_pk_bf16_f32 v37, v46, v47
    v_cvt_pk_bf16_f32 v38, v48, v49
    v_cvt_pk_bf16_f32 v39, v50, v51
    v_lshlrev_b32 v18, 4, v0
    s_mov_b32 s16, 0x6e0000
    s_mov_b32 s27, 0
adaLN_cond__sliding_block_cached__moe_arch_mod__prompt_kernel_w12p:
    buffer_load_dwordx4 v[24:27], v18, s[8:11], s16 offen sc1
    s_waitcnt vmcnt(0)
    v_cmp_eq_u32 vcc, 0, v24
    s_add_u32 s27, s27, 1
    s_cmp_ge_u32 s27, 65536
    s_cbranch_scc1 adaLN_cond__sliding_block_cached__moe_arch_mod__prompt_kernel_w12g
    s_cbranch_vccnz adaLN_cond__sliding_block_cached__moe_arch_mod__prompt_kernel_w12p
adaLN_cond__sliding_block_cached__moe_arch_mod__prompt_kernel_w12g:
    v_mov_b32 v76, v24
    s_nop 1
    v_max_u32_dpp v76, v76, v76 row_ror:1 row_mask:0xf bank_mask:0xf
    s_nop 1
    v_max_u32_dpp v76, v76, v76 row_ror:2 row_mask:0xf bank_mask:0xf
    s_nop 1
    v_max_u32_dpp v76, v76, v76 row_ror:4 row_mask:0xf bank_mask:0xf
    s_nop 1
    v_max_u32_dpp v76, v76, v76 row_ror:8 row_mask:0xf bank_mask:0xf
    v_mov_b32 v77, v76
    s_nop 1
    v_permlane16_swap_b32 v76, v77
    v_max_u32 v76, v76, v77
    v_mov_b32 v77, v76
    s_nop 1
    v_permlane32_swap_b32 v76, v77
    v_max_u32 v76, v76, v77
    v_cmp_eq_u32 vcc, v76, v24
    s_lshl_b32 s16, s3, 4
    s_add_u32 s16, s16, 65792
    v_mov_b32 v16, s16
    s_and_saveexec_b64 s[62:63], vcc
    ds_write_b128 v16, v[24:27]
    s_mov_b64 exec, s[62:63]
    s_waitcnt lgkmcnt(0)
    s_barrier
    v_and_b32 v16, 3, v1
    v_lshlrev_b32 v16, 4, v16
    v_add_u32 v16, 65792, v16
    ds_read_b32 v76, v16
    s_waitcnt lgkmcnt(0)
    v_mov_b32 v77, v76
    s_nop 1
    v_max_u32_dpp v77, v77, v77 row_ror:1 row_mask:0xf bank_mask:0xf
    s_nop 1
    v_max_u32_dpp v77, v77, v77 row_ror:2 row_mask:0xf bank_mask:0xf
    v_cmp_eq_u32 vcc, v76, v77
    s_ff1_i32_b64 s16, vcc
    s_lshl_b32 s16, s16, 4
    s_add_u32 s16, s16, 65792
    v_mov_b32 v16, s16
    ds_read_b128 v[24:27], v16
    s_waitcnt lgkmcnt(0)
    v_and_b32 v76, 0x7ff, v24
    v_sub_u32 v76, 2047, v76
    s_nop 0
    v_readfirstlane_b32 s12, v76
    v_rcp_f32 v103, v26
    s_lshr_b32 s18, s12, 4
    s_lshl_b32 s18, s18, 15
    s_and_b32 s19, s12, 15
    s_lshl_b32 s19, s19, 6
    s_add_u32 s18, s18, s19
    s_add_u32 s18, s18, 0x2000000
    s_add_u32 s19, s18, 0x400000
    v_lshrrev_b32 v18, 4, v0
    v_lshlrev_b32 v18, 10, v18
    v_and_b32 v19, 15, v0
    v_lshl_add_u32 v18, v19, 2, v18
    s_lshl_b32 s13, s12, 11
    buffer_load_dword v100, v18, s[8:11], s18 offen sc1
    buffer_load_dword v101, v18, s[8:11], s19 offen sc1
    buffer_load_dword v102, v21, s[76:79], s13 offen
    s_lshl_b32 s16, s14, 11
    s_cmp_lg_u32 s12, s14
    s_cselect_b32 s16, s16, 0x7ffffff0
    buffer_store_dwordx4 v[28:31], v2, s[68:71], s16 offen offset:0 sc1
    buffer_store_dwordx4 v[36:39], v2, s[68:71], s16 offen offset:1024 sc1
    s_lshl_b32 s16, s3, 13
    v_add_u32 v20, s16, v2
    s_waitcnt vmcnt(4)
    v_lshlrev_b32 v76, 16, v100
    v_and_b32 v77, 0xffff0000, v100
    s_waitcnt vmcnt(3)
    v_lshlrev_b32 v78, 16, v101
    v_and_b32 v79, 0xffff0000, v101
    v_pk_add_f32 v[76:77], v[76:77], v[78:79]
    s_waitcnt vmcnt(2)
    v_lshlrev_b32 v78, 16, v102
    v_and_b32 v79, 0xffff0000, v102
    v_pk_add_f32 v[92:93], v[78:79], v[76:77]
    v_cvt_pk_bf16_f32 v76, v92, v93
    v_lshlrev_b32 v92, 16, v76
    v_and_b32 v93, 0xffff0000, v76
    v_cvt_pk_bf16_f32 v100, v92, v93
    v_and_b32 v105, 0xffff0000, v104
    v_lshlrev_b32 v104, 16, v104
    v_and_b32 v107, 0xffff0000, v106
    v_lshlrev_b32 v106, 16, v106
    v_sub_f32 v92, v92, v25
    v_sub_f32 v93, v93, v25
    v_cvt_pk_bf16_f32 v76, v92, v93
    v_lshlrev_b32 v92, 16, v76
    v_and_b32 v93, 0xffff0000, v76
    v_mul_f32 v77, v92, v103
    v_fma_f32 v92, -v77, v26, v92
    v_fma_f32 v92, v92, v103, v77
    v_mul_f32 v77, v93, v103
    v_fma_f32 v93, -v77, v26, v93
    v_fma_f32 v93, v93, v103, v77
    v_cvt_pk_bf16_f32 v76, v92, v93
    v_lshlrev_b32 v92, 16, v76
    v_and_b32 v93, 0xffff0000, v76
    v_mul_f32 v92, v92, v104
    v_mul_f32 v93, v93, v105
    v_cvt_pk_bf16_f32 v76, v92, v93
    v_lshlrev_b32 v92, 16, v76
    v_and_b32 v93, 0xffff0000, v76
    v_add_f32 v92, v92, v106
    v_add_f32 v93, v93, v107
    v_cvt_pk_bf16_f32 v101, v92, v93
    v_add_u32 v16, 66560, v21
    ds_write_b32 v16, v101
    ds_write_b32 v16, v100 offset:2048
    s_waitcnt lgkmcnt(0)
    s_barrier
    ds_read_b128 v[60:63], v20 offset:0
    ds_read_b128 v[64:67], v20 offset:1024
    ds_read_b128 v[68:71], v20 offset:2048
    ds_read_b128 v[72:75], v20 offset:3072
    ds_read_b128 v[108:111], v20 offset:4096
    ds_read_b128 v[112:115], v20 offset:5120
    ds_read_b128 v[116:119], v20 offset:6144
    ds_read_b128 v[120:123], v20 offset:7168
    s_and_b32 s16, s3, 3
    s_lshl_b32 s16, s16, 7
    s_and_b32 s17, s29, 3
    s_lshl_b32 s17, s17, 9
    s_add_u32 s16, s16, s17
    s_add_u32 s16, s16, 66560
    v_lshrrev_b32 v16, 3, v1
    v_lshlrev_b32 v16, 4, v16
    v_add_u32 v16, s16, v16
    ds_read_b128 v[104:107], v16
    s_waitcnt lgkmcnt(0)
    v_lshlrev_b32 v76, 16, v104
    v_and_b32 v77, 0xffff, v104
    v_dot2_f32_bf16 v85, v60, v76, 0
    v_dot2_f32_bf16 v84, v60, v77, 0
    v_dot2_f32_bf16 v87, v61, v76, 0
    v_dot2_f32_bf16 v86, v61, v77, 0
    v_dot2_f32_bf16 v89, v62, v76, 0
    v_dot2_f32_bf16 v88, v62, v77, 0
    v_dot2_f32_bf16 v91, v63, v76, 0
    v_dot2_f32_bf16 v90, v63, v77, 0
    v_and_b32 v78, 0xffff0000, v104
    v_lshrrev_b32 v79, 16, v104
    v_dot2c_f32_bf16 v85, v64, v78
    v_dot2c_f32_bf16 v84, v64, v79
    v_dot2c_f32_bf16 v87, v65, v78
    v_dot2c_f32_bf16 v86, v65, v79
    v_dot2c_f32_bf16 v89, v66, v78
    v_dot2c_f32_bf16 v88, v66, v79
    v_dot2c_f32_bf16 v91, v67, v78
    v_dot2c_f32_bf16 v90, v67, v79
    v_lshlrev_b32 v80, 16, v105
    v_and_b32 v81, 0xffff, v105
    v_dot2c_f32_bf16 v85, v68, v80
    v_dot2c_f32_bf16 v84, v68, v81
    v_dot2c_f32_bf16 v87, v69, v80
    v_dot2c_f32_bf16 v86, v69, v81
    v_dot2c_f32_bf16 v89, v70, v80
    v_dot2c_f32_bf16 v88, v70, v81
    v_dot2c_f32_bf16 v91, v71, v80
    v_dot2c_f32_bf16 v90, v71, v81
    v_and_b32 v82, 0xffff0000, v105
    v_lshrrev_b32 v83, 16, v105
    v_dot2c_f32_bf16 v85, v72, v82
    v_dot2c_f32_bf16 v84, v72, v83
    v_dot2c_f32_bf16 v87, v73, v82
    v_dot2c_f32_bf16 v86, v73, v83
    v_dot2c_f32_bf16 v89, v74, v82
    v_dot2c_f32_bf16 v88, v74, v83
    v_dot2c_f32_bf16 v91, v75, v82
    v_dot2c_f32_bf16 v90, v75, v83
    v_lshlrev_b32 v76, 16, v106
    v_and_b32 v77, 0xffff, v106
    v_dot2c_f32_bf16 v85, v108, v76
    v_dot2c_f32_bf16 v84, v108, v77
    v_dot2c_f32_bf16 v87, v109, v76
    v_dot2c_f32_bf16 v86, v109, v77
    v_dot2c_f32_bf16 v89, v110, v76
    v_dot2c_f32_bf16 v88, v110, v77
    v_dot2c_f32_bf16 v91, v111, v76
    v_dot2c_f32_bf16 v90, v111, v77
    v_and_b32 v78, 0xffff0000, v106
    v_lshrrev_b32 v79, 16, v106
    v_dot2c_f32_bf16 v85, v112, v78
    v_dot2c_f32_bf16 v84, v112, v79
    v_dot2c_f32_bf16 v87, v113, v78
    v_dot2c_f32_bf16 v86, v113, v79
    v_dot2c_f32_bf16 v89, v114, v78
    v_dot2c_f32_bf16 v88, v114, v79
    v_dot2c_f32_bf16 v91, v115, v78
    v_dot2c_f32_bf16 v90, v115, v79
    v_lshlrev_b32 v80, 16, v107
    v_and_b32 v81, 0xffff, v107
    v_dot2c_f32_bf16 v85, v116, v80
    v_dot2c_f32_bf16 v84, v116, v81
    v_dot2c_f32_bf16 v87, v117, v80
    v_dot2c_f32_bf16 v86, v117, v81
    v_dot2c_f32_bf16 v89, v118, v80
    v_dot2c_f32_bf16 v88, v118, v81
    v_dot2c_f32_bf16 v91, v119, v80
    v_dot2c_f32_bf16 v90, v119, v81
    v_and_b32 v82, 0xffff0000, v107
    v_lshrrev_b32 v83, 16, v107
    v_dot2c_f32_bf16 v85, v120, v82
    v_dot2c_f32_bf16 v84, v120, v83
    v_dot2c_f32_bf16 v87, v121, v82
    v_dot2c_f32_bf16 v86, v121, v83
    v_dot2c_f32_bf16 v89, v122, v82
    v_dot2c_f32_bf16 v88, v122, v83
    v_dot2c_f32_bf16 v91, v123, v82
    v_dot2c_f32_bf16 v90, v123, v83
    s_nop 0
    v_permlane32_swap_b32 v84, v88
    v_permlane32_swap_b32 v85, v89
    v_permlane32_swap_b32 v86, v90
    v_permlane32_swap_b32 v87, v91
    v_add_f32 v84, v84, v88
    v_add_f32 v85, v85, v89
    v_add_f32 v86, v86, v90
    v_add_f32 v87, v87, v91
    s_nop 0
    v_permlane16_swap_b32 v84, v86
    v_permlane16_swap_b32 v85, v87
    v_add_f32 v84, v84, v86
    v_add_f32 v85, v85, v87
    s_nop 0
    v_add_f32_dpp v84, v84, v84 row_ror:8 row_mask:0xf bank_mask:0xf
    v_add_f32_dpp v85, v85, v85 row_ror:8 row_mask:0xf bank_mask:0xf
    v_and_b32 v16, 7, v1
    v_lshlrev_b32 v16, 5, v16
    v_lshrrev_b32 v17, 4, v1
    v_lshl_add_u32 v16, v17, 3, v16
    s_lshl_b32 s16, s3, 8
    s_add_u32 s16, s16, 70656
    v_add_u32 v16, s16, v16
    ds_write_b64 v16, v[84:85]
    s_lshr_b32 s16, s3, 2
    s_lshl_b32 s17, s16, 10
    s_add_u32 s17, s17, 70656
    v_lshlrev_b32 v17, 2, v1
    v_add_u32 v16, s17, v17
    s_and_b32 s17, s29, 3
    s_lshl_b32 s17, s17, 1
    s_add_u32 s17, s17, s16
    s_mul_i32 s17, s17, 14336
    s_lshr_b32 s16, s29, 2
    s_lshl_b32 s16, s16, 8
    s_add_u32 s17, s17, s16
    s_add_u32 s17, s17, 0x6e1000
    s_and_b32 s16, s3, 3
    s_cmp_eq_u32 s16, 0
    s_cselect_b32 s17, s17, 0x7ffffff0
    s_cmp_lt_u32 s2, 224
    s_cselect_b32 s17, s17, 0x7ffffff0
    s_waitcnt lgkmcnt(0)
    s_barrier
    ds_read_b32 v84, v16 offset:0
    ds_read_b32 v85, v16 offset:256
    ds_read_b32 v86, v16 offset:512
    ds_read_b32 v87, v16 offset:768
    s_waitcnt lgkmcnt(2)
    v_add_f32 v84, v84, v85
    s_waitcnt lgkmcnt(0)
    v_add_f32 v86, v86, v87
    v_add_f32 v84, v84, v86
    v_or_b32 v84, 1, v84
    buffer_store_dword v84, v17, s[8:11], s17 offen sc1
    s_barrier
    v_lshlrev_b32 v16, 3, v0
    v_add_u32 v17, 73728, v16
    ds_read_b64 v[84:85], v17 offset:0
    ds_read_b64 v[86:87], v17 offset:4096
    ds_read_b64 v[88:89], v17 offset:8192
    ds_read_b64 v[90:91], v17 offset:12288
    s_waitcnt lgkmcnt(2)
    v_pk_add_f32 v[84:85], v[84:85], v[86:87]
    s_waitcnt lgkmcnt(0)
    v_pk_add_f32 v[88:89], v[88:89], v[90:91]
    v_pk_add_f32 v[84:85], v[84:85], v[88:89]
    v_or_b32 v84, 1, v84
    v_or_b32 v85, 1, v85
    s_lshl_b32 s16, s29, 12
    s_add_u32 s16, s16, 0x600000
    s_cmp_lt_u32 s2, 224
    s_cselect_b32 s16, s16, 0x7ffffff0
    buffer_store_dwordx2 v[84:85], v16, s[8:11], s16 offen sc1
    s_cmp_lt_u32 s2, 224
    s_cbranch_scc1 adaLN_cond__sliding_block_cached__moe_arch_mod__prompt_kernel_end
    s_sub_u32 s16, s2, 224
    s_lshl_b32 s17, s16, 7
    s_add_u32 s17, s17, 0x600000
    v_lshrrev_b32 v16, 3, v0
    v_lshlrev_b32 v16, 12, v16
    v_and_b32 v17, 7, v0
    v_lshl_add_u32 v16, v17, 4, v16
    v_cmp_gt_u32 vcc, 256, v0
    v_bfrev_b32 v17, -2
    s_nop 0
    v_cndmask_b32 v17, v17, v16, vcc
    v_mov_b32 v19, 0
    v_cndmask_b32 v18, 1, v19, vcc
    s_lshl_b32 s18, s16, 6
    v_and_b32 v19, 31, v1
    v_lshlrev_b32 v19, 1, v19
    v_add_u32 v19, s18, v19
    s_mov_b32 s19, 0x541800
    buffer_load_ushort v95, v19, s[8:11], s19 offen sc1
    v_add_u32 v20, 66560, v19
    ds_read_u16 v96, v20
    ds_read_u16 v97, v20 offset:2048
    v_mov_b32 v94, v27
    v_cvt_pk_bf16_f32 v94, v94, v94
    v_lshlrev_b32 v94, 16, v94
    v_mul_f32 v94, 0xbfb8aa3b, v94
    v_exp_f32 v94, v94
    s_nop 0
    v_add_f32 v94, 1.0, v94
    v_rcp_f32 v94, v94
    s_nop 0
    v_cvt_pk_bf16_f32 v94, v94, v94
    v_lshlrev_b32 v94, 16, v94
    s_waitcnt vmcnt(0)
    v_lshlrev_b32 v95, 16, v95
    s_waitcnt lgkmcnt(1)
    v_lshlrev_b32 v96, 16, v96
    s_waitcnt lgkmcnt(0)
    v_lshlrev_b32 v97, 16, v97
    s_mov_b32 s27, 0
adaLN_cond__sliding_block_cached__moe_arch_mod__prompt_kernel_y13p:
    s_add_u32 s19, s17, 0x0
    buffer_load_dwordx4 v[44:47], v16, s[8:11], s19 offen sc1
    s_add_u32 s19, s17, 0x40000
    buffer_load_dwordx4 v[48:51], v16, s[8:11], s19 offen sc1
    s_add_u32 s19, s17, 0x80000
    buffer_load_dwordx4 v[52:55], v16, s[8:11], s19 offen sc1
    s_add_u32 s19, s17, 0xc0000
    buffer_load_dwordx4 v[56:59], v17, s[8:11], s19 offen sc1
    s_waitcnt vmcnt(0)
    v_min3_u32 v98, v56, v57, v58
    v_min_u32 v98, v98, v59
    v_or_b32 v98, v98, v18
    v_min3_u32 v98, v98, v44, v45
    v_min3_u32 v98, v98, v46, v47
    v_min3_u32 v98, v98, v48, v49
    v_min3_u32 v98, v98, v50, v51
    v_min3_u32 v98, v98, v52, v53
    v_min3_u32 v98, v98, v54, v55
    v_cmp_eq_u32 vcc, 0, v98
    s_add_u32 s27, s27, 1
    s_cmp_ge_u32 s27, 65536
    s_cbranch_scc1 adaLN_cond__sliding_block_cached__moe_arch_mod__prompt_kernel_y13g
    s_cbranch_vccnz adaLN_cond__sliding_block_cached__moe_arch_mod__prompt_kernel_y13p
adaLN_cond__sliding_block_cached__moe_arch_mod__prompt_kernel_y13g:
    v_pk_add_f32 v[44:45], v[44:45], v[52:53]
    v_pk_add_f32 v[46:47], v[46:47], v[54:55]
    v_pk_add_f32 v[48:49], v[48:49], v[56:57]
    v_pk_add_f32 v[50:51], v[50:51], v[58:59]
    v_pk_add_f32 v[44:45], v[44:45], v[48:49]
    v_pk_add_f32 v[46:47], v[46:47], v[50:51]
    s_nop 0
    v_add_f32_dpp v44, v44, v44 row_ror:8 row_mask:0xf bank_mask:0xf
    v_add_f32_dpp v45, v45, v45 row_ror:8 row_mask:0xf bank_mask:0xf
    v_add_f32_dpp v46, v46, v46 row_ror:8 row_mask:0xf bank_mask:0xf
    v_add_f32_dpp v47, v47, v47 row_ror:8 row_mask:0xf bank_mask:0xf
    s_nop 0
    v_permlane32_swap_b32 v44, v46
    v_permlane32_swap_b32 v45, v47
    v_add_f32 v44, v44, v46
    v_add_f32 v45, v45, v47
    s_nop 1
    v_permlane16_swap_b32 v44, v45
    v_add_f32 v44, v44, v45
    v_and_b32 v16, 7, v1
    v_lshlrev_b32 v16, 4, v16
    v_lshrrev_b32 v17, 4, v1
    v_lshl_add_u32 v16, v17, 2, v16
    s_lshl_b32 s19, s3, 7
    s_add_u32 s19, s19, 91136
    v_add_u32 v16, s19, v16
    ds_write_b32 v16, v44
    v_and_b32 v16, 31, v1
    v_lshlrev_b32 v16, 2, v16
    v_add_u32 v16, 91136, v16
    s_waitcnt lgkmcnt(0)
    s_barrier
    s_cmp_lg_u32 s3, 0
    s_cbranch_scc1 adaLN_cond__sliding_block_cached__moe_arch_mod__prompt_kernel_end
    ds_read_b32 v44, v16 offset:0
    ds_read_b32 v45, v16 offset:128
    ds_read_b32 v46, v16 offset:256
    ds_read_b32 v47, v16 offset:384
    ds_read_b32 v48, v16 offset:512
    ds_read_b32 v49, v16 offset:640
    ds_read_b32 v50, v16 offset:768
    ds_read_b32 v51, v16 offset:896
    s_waitcnt lgkmcnt(3)
    v_add_f32 v44, v44, v48
    s_waitcnt lgkmcnt(2)
    v_add_f32 v45, v45, v49
    s_waitcnt lgkmcnt(1)
    v_add_f32 v46, v46, v50
    s_waitcnt lgkmcnt(0)
    v_add_f32 v47, v47, v51
    v_add_f32 v44, v44, v46
    v_add_f32 v45, v45, v47
    v_add_f32 v44, v44, v45
    v_cvt_pk_bf16_f32 v44, v44, v44
    v_lshlrev_b32 v44, 16, v44
    v_mul_f32 v44, v44, v94
    v_cvt_pk_bf16_f32 v44, v44, v44
    v_lshlrev_b32 v44, 16, v44
    v_add_f32 v44, v44, v96
    v_cvt_pk_bf16_f32 v44, v44, v44
    v_lshlrev_b32 v44, 16, v44
    v_mul_f32 v44, v44, v95
    v_cvt_pk_bf16_f32 v44, v44, v44
    v_lshlrev_b32 v44, 16, v44
    v_add_f32 v44, v44, v97
    v_cvt_pk_bf16_f32 v44, v44, v44
    s_mov_b64 exec, 0xffffffff
    buffer_store_short v44, v19, s[68:71], s13 offen sc1
    s_branch adaLN_cond__sliding_block_cached__moe_arch_mod__prompt_kernel_end
adaLN_cond__sliding_block_cached__moe_arch_mod__prompt_kernel_roleB:
    v_mov_b32 v132, 0
    v_mov_b32 v133, 0
    v_lshrrev_b32 v16, 3, v0
    v_and_b32 v17, 7, v0
    v_mul_u32_u24 v135, 24576, v16
    v_lshl_add_u32 v135, v17, 4, v135
    v_lshlrev_b32 v136, 2, v16
    s_and_b32 s14, s2, 31
    s_lshr_b32 s15, s2, 5
    s_mul_i32 s26, s15, 1572864
    s_lshl_b32 s16, s14, 7
    s_add_u32 s26, s26, s16
    s_lshl_b32 s29, s15, 8
    v_lshlrev_b32 v137, 3, v0
    s_lshl_b32 s18, s2, 3
    s_add_u32 s18, s18, s3
    s_lshl_b32 s18, s18, 11
    v_and_b32 v18, 15, v1
    v_lshrrev_b32 v19, 4, v1
    v_lshlrev_b32 v138, 11, v18
    v_lshl_add_u32 v138, v19, 4, v138
    s_lshr_b32 s30, s2, 4
    s_and_b32 s31, s2, 15
    s_lshl_b32 s19, s30, 3
    s_add_u32 s19, s19, s3
    s_lshl_b32 s22, s19, 15
    s_lshl_b32 s23, s31, 7
    s_add_u32 s22, s22, s23
    s_lshl_b32 s23, s2, 12
    s_add_u32 s23, s23, 0x600000
    s_or_b32 s25, s2, s3
    s_cmp_eq_u32 s25, 0
    s_cselect_b32 s25, 0, 0x7ffffff0
    s_waitcnt lgkmcnt(0)
    s_mov_b64 s[64:65], s[58:59]
    s_mov_b32 s66, 0x100
    s_mov_b32 s67, 0x20000
    s_or_b32 s28, s62, 1
    v_mov_b32 v134, s28
    s_mov_b64 exec, 1
    buffer_store_dword v134, v132, s[64:67], s25 offen sc1
    s_mov_b64 exec, -1
    s_mov_b64 s[68:69], s[52:53]
    s_mov_b32 s70, 0x800
    s_mov_b32 s71, 0x20000
    s_mov_b64 s[72:73], s[54:55]
    s_mov_b32 s74, 0xc00000
    s_mov_b32 s75, 0x20000
    s_mov_b64 s[76:77], s[32:33]
    s_mov_b32 s78, 0x400000
    s_mov_b32 s79, 0x20000
    s_mov_b64 s[8:9], s[60:61]
    s_mov_b32 s10, 0x3400000
    s_mov_b32 s11, 0x20000
    buffer_load_dwordx4 v[32:35], v2, s[76:79], s18 offen offset:0
    buffer_load_dwordx4 v[36:39], v2, s[76:79], s18 offen offset:1024
    buffer_load_dword v72, v136, s[68:71], s29 offen
    buffer_load_dwordx4 v[24:27], v135, s[72:75], s26 offen
    s_add_u32 s26, s26, 12288
    buffer_load_dwordx4 v[28:31], v135, s[72:75], s26 offen
    buffer_store_dwordx2 v[132:133], v137, s[8:11], s23 offen sc1
    s_barrier
    buffer_load_dwordx4 v[40:43], v138, s[76:79], s22 offen offset:0
    buffer_load_dwordx4 v[44:47], v138, s[76:79], s22 offen offset:64
    s_mov_b32 s29, s19
    s_mov_b64 s[64:65], s[34:35]
    s_mov_b32 s66, 0x200000
    s_mov_b32 s67, 0x20000
    s_mov_b64 s[68:69], s[36:37]
    s_mov_b32 s70, 0x200000
    s_mov_b32 s71, 0x20000
    s_lshl_b32 s20, s2, 2
    s_add_u32 s20, s20, s3
    s_sub_u32 s20, s20, 4
    s_lshr_b32 s22, s20, 8
    s_bfe_u32 s23, s20, 0x40004
    s_and_b32 s24, s20, 15
    s_lshl_b32 s25, s22, 19
    s_lshl_b32 s26, s23, 13
    s_add_u32 s25, s25, s26
    s_add_u32 s25, s25, 393216
    v_and_b32 v16, 15, v1
    v_lshrrev_b32 v17, 4, v1
    s_lshl_b32 s21, s22, 17
    s_cmp_ge_u32 s24, 8
    s_cbranch_scc1 adaLN_cond__sliding_block_cached__moe_arch_mod__prompt_kernel_kvV
    v_lshlrev_b32 v18, 8, v16
    v_lshl_add_u32 v18, v17, 3, v18
    s_and_b32 s26, s24, 1
    s_lshl_b32 s26, s26, 12
    s_add_u32 s25, s25, s26
    s_lshr_b32 s26, s24, 1
    s_lshl_b32 s26, s26, 6
    s_add_u32 s25, s25, s26
    buffer_load_dwordx2 v[84:85], v18, s[64:67], s25 offen
    buffer_load_dwordx2 v[86:87], v18, s[64:67], s25 offen offset:32
    s_mov_b32 s26, 0x7ffffff0
    buffer_load_ushort v88, v18, s[64:67], s26 offen
    buffer_load_ushort v89, v18, s[64:67], s26 offen
    buffer_load_ushort v90, v18, s[64:67], s26 offen
    buffer_load_ushort v91, v18, s[64:67], s26 offen
    buffer_load_ushort v92, v18, s[64:67], s26 offen
    buffer_load_ushort v93, v18, s[64:67], s26 offen
    s_lshl_b32 s26, s23, 13
    s_add_u32 s21, s21, s26
    s_lshl_b32 s26, s24, 10
    s_add_u32 s21, s21, s26
    s_add_u32 s21, s21, 0x400000
    s_branch adaLN_cond__sliding_block_cached__moe_arch_mod__prompt_kernel_kvJ
adaLN_cond__sliding_block_cached__moe_arch_mod__prompt_kernel_kvV:
    s_bfe_u32 s26, s24, 0x20001
    s_lshl_b32 s26, s26, 6
    s_add_u32 s25, s25, s26
    s_and_b32 s26, s24, 1
    s_lshl_b32 s26, s26, 3
    s_add_u32 s25, s25, s26
    s_add_u32 s26, s25, 4096
    v_lshrrev_b32 v18, 2, v16
    v_lshlrev_b32 v18, 4, v18
    v_and_b32 v19, 3, v16
    v_lshl_add_u32 v18, v19, 1, v18
    v_lshl_add_u32 v18, v17, 10, v18
    buffer_load_ushort v88, v18, s[68:71], s25 offen offset:0
    buffer_load_ushort v89, v18, s[68:71], s25 offen offset:256
    buffer_load_ushort v90, v18, s[68:71], s25 offen offset:512
    buffer_load_ushort v91, v18, s[68:71], s25 offen offset:768
    buffer_load_ushort v92, v18, s[68:71], s26 offen offset:0
    buffer_load_ushort v93, v18, s[68:71], s26 offen offset:256
    buffer_load_ushort v94, v18, s[68:71], s26 offen offset:512
    buffer_load_ushort v95, v18, s[68:71], s26 offen offset:768
    s_bfe_u32 s26, s24, 0x20001
    s_lshl_b32 s26, s26, 15
    s_add_u32 s21, s21, s26
    s_lshl_b32 s26, s23, 11
    s_add_u32 s21, s21, s26
    s_and_b32 s26, s24, 1
    s_lshl_b32 s26, s26, 10
    s_add_u32 s21, s21, s26
    s_add_u32 s21, s21, 0x480000
adaLN_cond__sliding_block_cached__moe_arch_mod__prompt_kernel_kvJ:
    s_waitcnt vmcnt(15)
    v_lshlrev_b32 v56, 16, v32
    v_and_b32 v57, 0xffff0000, v32
    v_lshlrev_b32 v58, 16, v33
    v_and_b32 v59, 0xffff0000, v33
    v_lshlrev_b32 v60, 16, v34
    v_and_b32 v61, 0xffff0000, v34
    v_lshlrev_b32 v62, 16, v35
    v_and_b32 v63, 0xffff0000, v35
    s_waitcnt vmcnt(14)
    v_lshlrev_b32 v64, 16, v36
    v_and_b32 v65, 0xffff0000, v36
    v_lshlrev_b32 v66, 16, v37
    v_and_b32 v67, 0xffff0000, v37
    v_lshlrev_b32 v68, 16, v38
    v_and_b32 v69, 0xffff0000, v38
    v_lshlrev_b32 v70, 16, v39
    v_and_b32 v71, 0xffff0000, v39
    v_add_f32 v20, v56, v57
    v_add_f32 v21, v58, v59
    v_add_f32 v20, v20, v60
    v_add_f32 v21, v21, v61
    v_add_f32 v20, v20, v62
    v_add_f32 v21, v21, v63
    v_add_f32 v20, v20, v64
    v_add_f32 v21, v21, v65
    v_add_f32 v20, v20, v66
    v_add_f32 v21, v21, v67
    v_add_f32 v20, v20, v68
    v_add_f32 v21, v21, v69
    v_add_f32 v20, v20, v70
    v_add_f32 v21, v21, v71
    v_add_f32 v128, v20, v21
    s_nop 1
    v_add_f32_dpp v128, v128, v128 row_ror:1 row_mask:0xf bank_mask:0xf
    s_nop 1
    v_add_f32_dpp v128, v128, v128 row_ror:2 row_mask:0xf bank_mask:0xf
    s_nop 1
    v_add_f32_dpp v128, v128, v128 row_ror:4 row_mask:0xf bank_mask:0xf
    s_nop 1
    v_add_f32_dpp v128, v128, v128 row_ror:8 row_mask:0xf bank_mask:0xf
    v_mov_b32 v20, v128
    s_nop 1
    v_permlane16_swap_b32 v128, v20
    v_add_f32 v128, v128, v20
    v_mov_b32 v20, v128
    s_nop 1
    v_permlane32_swap_b32 v128, v20
    v_add_f32 v128, v128, v20
    v_mul_f32 v128, 0x3a800000, v128
    v_sub_f32 v18, v56, v128
    v_mul_f32 v20, v18, v18
    v_sub_f32 v19, v57, v128
    v_mul_f32 v21, v19, v19
    v_sub_f32 v18, v58, v128
    v_sub_f32 v19, v59, v128
    v_fmac_f32 v20, v18, v18
    v_fmac_f32 v21, v19, v19
    v_sub_f32 v18, v60, v128
    v_sub_f32 v19, v61, v128
    v_fmac_f32 v20, v18, v18
    v_fmac_f32 v21, v19, v19
    v_sub_f32 v18, v62, v128
    v_sub_f32 v19, v63, v128
    v_fmac_f32 v20, v18, v18
    v_fmac_f32 v21, v19, v19
    v_sub_f32 v18, v64, v128
    v_sub_f32 v19, v65, v128
    v_fmac_f32 v20, v18, v18
    v_fmac_f32 v21, v19, v19
    v_sub_f32 v18, v66, v128
    v_sub_f32 v19, v67, v128
    v_fmac_f32 v20, v18, v18
    v_fmac_f32 v21, v19, v19
    v_sub_f32 v18, v68, v128
    v_sub_f32 v19, v69, v128
    v_fmac_f32 v20, v18, v18
    v_fmac_f32 v21, v19, v19
    v_sub_f32 v18, v70, v128
    v_sub_f32 v19, v71, v128
    v_fmac_f32 v20, v18, v18
    v_fmac_f32 v21, v19, v19
    v_add_f32 v17, v20, v21
    s_nop 1
    v_add_f32_dpp v17, v17, v17 row_ror:1 row_mask:0xf bank_mask:0xf
    s_nop 1
    v_add_f32_dpp v17, v17, v17 row_ror:2 row_mask:0xf bank_mask:0xf
    s_nop 1
    v_add_f32_dpp v17, v17, v17 row_ror:4 row_mask:0xf bank_mask:0xf
    s_nop 1
    v_add_f32_dpp v17, v17, v17 row_ror:8 row_mask:0xf bank_mask:0xf
    v_mov_b32 v20, v17
    s_nop 1
    v_permlane16_swap_b32 v17, v20
    v_add_f32 v17, v17, v20
    v_mov_b32 v20, v17
    s_nop 1
    v_permlane32_swap_b32 v17, v20
    v_add_f32 v17, v17, v20
    v_mul_f32 v17, 0x3a800000, v17
    v_cvt_pk_bf16_f32 v128, v128, v128
    v_lshlrev_b32 v128, 16, v128
    v_cvt_pk_bf16_f32 v17, v17, v17
    v_lshlrev_b32 v17, 16, v17
    v_add_f32 v17, 0x3727c5ac, v17
    v_cvt_pk_bf16_f32 v17, v17, v17
    v_lshlrev_b32 v17, 16, v17
    v_sqrt_f32 v129, v17
    s_nop 0
    v_cvt_pk_bf16_f32 v129, v129, v129
    v_lshlrev_b32 v129, 16, v129
    v_rcp_f32 v130, v129
    s_lshl_b32 s16, s3, 4
    s_add_u32 s16, s16, 149520
    v_mov_b32 v19, s16
    ds_write_b128 v19, v[128:131]
    s_waitcnt vmcnt(13)
    v_and_b32 v73, 0xffff0000, v72
    v_lshlrev_b32 v72, 16, v72
    v_mul_f32 v16, 0xbfb8aa3b, v72
    v_exp_f32 v16, v16
    s_nop 0
    v_add_f32 v16, 1.0, v16
    v_rcp_f32 v16, v16
    s_nop 0
    v_mul_f32 v72, v72, v16
    v_mul_f32 v17, 0xbfb8aa3b, v73
    v_exp_f32 v17, v17
    s_nop 0
    v_add_f32 v17, 1.0, v17
    v_rcp_f32 v17, v17
    s_nop 0
    v_mul_f32 v73, v73, v17
    v_cvt_pk_bf16_f32 v16, v72, v73
    v_lshlrev_b32 v72, 16, v16
    v_and_b32 v73, 0xffff0000, v16
    s_lshl_b32 s16, s2, 8
    s_add_u32 s16, s16, 0x550000
    s_mov_b32 exec_lo, 0x01010101
    s_mov_b32 exec_hi, 0x01010101
    buffer_store_dword v16, v136, s[8:11], s16 offen sc1
    s_mov_b64 exec, -1
    v_lshrrev_b32 v74, 16, v72
    v_lshrrev_b32 v75, 16, v73
    s_waitcnt vmcnt(13)
    v_dot2_f32_bf16 v49, v24, v72, 0
    v_dot2_f32_bf16 v48, v24, v74, 0
    v_dot2_f32_bf16 v51, v25, v72, 0
    v_dot2_f32_bf16 v50, v25, v74, 0
    v_dot2_f32_bf16 v53, v26, v72, 0
    v_dot2_f32_bf16 v52, v26, v74, 0
    v_dot2_f32_bf16 v55, v27, v72, 0
    v_dot2_f32_bf16 v54, v27, v74, 0
    s_waitcnt vmcnt(12)
    v_dot2c_f32_bf16 v49, v28, v73
    v_dot2c_f32_bf16 v48, v28, v75
    v_dot2c_f32_bf16 v51, v29, v73
    v_dot2c_f32_bf16 v50, v29, v75
    v_dot2c_f32_bf16 v53, v30, v73
    v_dot2c_f32_bf16 v52, v30, v75
    v_dot2c_f32_bf16 v55, v31, v73
    v_dot2c_f32_bf16 v54, v31, v75
    s_nop 0
    v_permlane32_swap_b32 v48, v52
    v_permlane32_swap_b32 v49, v53
    v_permlane32_swap_b32 v50, v54
    v_permlane32_swap_b32 v51, v55
    v_add_f32 v48, v48, v52
    v_add_f32 v49, v49, v53
    v_add_f32 v50, v50, v54
    v_add_f32 v51, v51, v55
    s_nop 0
    v_permlane16_swap_b32 v48, v50
    v_permlane16_swap_b32 v49, v51
    v_add_f32 v48, v48, v50
    v_add_f32 v49, v49, v51
    s_nop 0
    v_add_f32_dpp v48, v48, v48 row_ror:8 row_mask:0xf bank_mask:0xf
    v_add_f32_dpp v49, v49, v49 row_ror:8 row_mask:0xf bank_mask:0xf
    v_and_b32 v16, 7, v1
    v_lshlrev_b32 v16, 5, v16
    v_lshrrev_b32 v17, 4, v1
    v_lshl_add_u32 v16, v17, 3, v16
    s_lshl_b32 s16, s3, 8
    s_add_u32 s16, s16, 147456
    v_add_u32 v16, s16, v16
    ds_write_b64 v16, v[48:49]
    v_mov_b32 v19, 149504
    v_and_b32 v17, 31, v1
    v_lshlrev_b32 v18, 3, v17
    v_add_u32 v18, 147456, v18
    v_lshlrev_b32 v17, 4, v17
    s_waitcnt lgkmcnt(0)
    s_barrier
    ds_read_b32 v134, v19
    ds_read_b64 v[96:97], v18 offset:0
    ds_read_b64 v[100:101], v18 offset:256
    ds_read_b64 v[104:105], v18 offset:512
    ds_read_b64 v[108:109], v18 offset:768
    ds_read_b64 v[112:113], v18 offset:1024
    ds_read_b64 v[116:117], v18 offset:1280
    ds_read_b64 v[120:121], v18 offset:1536
    ds_read_b64 v[124:125], v18 offset:1792
    s_waitcnt lgkmcnt(8)
    v_readfirstlane_b32 s28, v134
    v_and_b32 v20, 7, v1
    v_lshlrev_b32 v20, 4, v20
    v_add_u32 v21, 149520, v20
    ds_read_b128 v[128:131], v21
    s_waitcnt lgkmcnt(0)
    v_mov_b32 v131, s28
    s_lshl_b32 s16, s2, 7
    s_add_u32 s16, s16, 0x520000
    s_cmp_eq_u32 s3, 0
    s_cselect_b32 s16, s16, 0x7ffffff0
    s_mov_b64 exec, 0xff
    buffer_store_dwordx4 v[128:131], v20, s[8:11], s16 offen sc1
    s_mov_b64 exec, -1
    v_pk_add_f32 v[96:97], v[96:97], v[112:113]
    v_pk_add_f32 v[100:101], v[100:101], v[116:117]
    v_pk_add_f32 v[104:105], v[104:105], v[120:121]
    v_pk_add_f32 v[108:109], v[108:109], v[124:125]
    v_pk_add_f32 v[96:97], v[96:97], v[104:105]
    v_pk_add_f32 v[100:101], v[100:101], v[108:109]
    v_pk_add_f32 v[96:97], v[96:97], v[100:101]
    v_mov_b32 v98, s28
    v_mov_b32 v99, s28
    s_lshl_b32 s16, s14, 3
    s_add_u32 s16, s16, s15
    s_lshl_b32 s16, s16, 9
    s_add_u32 s16, s16, 0x500000
    s_cmp_eq_u32 s3, 0
    s_cselect_b32 s16, s16, 0x7ffffff0
    s_mov_b64 exec, 0xffffffff
    buffer_store_dwordx4 v[96:99], v17, s[8:11], s16 offen sc1
    s_mov_b64 exec, -1
    s_lshr_b32 s16, s3, 2
    s_lshl_b32 s16, s16, 4
    s_add_u32 s16, s16, s31
    s_lshl_b32 s16, s16, 12
    s_and_b32 s17, s3, 3
    s_lshl_b32 s17, s17, 7
    s_add_u32 s16, s16, s17
    s_add_u32 s16, s16, 0x500000
    v_lshrrev_b32 v139, 3, v1
    v_lshlrev_b32 v139, 9, v139
    v_and_b32 v16, 7, v1
    v_lshl_add_u32 v139, v16, 4, v139
    v_and_b32 v140, 15, v1
    v_lshlrev_b32 v140, 4, v140
    s_lshl_b32 s17, s29, 8
    s_add_u32 s17, s17, 0x520000
    s_waitcnt vmcnt(12)
    v_lshlrev_b32 v56, 16, v40
    v_and_b32 v57, 0xffff0000, v40
    v_lshlrev_b32 v58, 16, v41
    v_and_b32 v59, 0xffff0000, v41
    v_lshlrev_b32 v60, 16, v42
    v_and_b32 v61, 0xffff0000, v42
    v_lshlrev_b32 v62, 16, v43
    v_and_b32 v63, 0xffff0000, v43
    s_waitcnt vmcnt(11)
    v_lshlrev_b32 v64, 16, v44
    v_and_b32 v65, 0xffff0000, v44
    v_lshlrev_b32 v66, 16, v45
    v_and_b32 v67, 0xffff0000, v45
    v_lshlrev_b32 v68, 16, v46
    v_and_b32 v69, 0xffff0000, v46
    v_lshlrev_b32 v70, 16, v47
    v_and_b32 v71, 0xffff0000, v47
    v_mov_b32 v135, 2097152
    v_mul_lo_u32 v135, v135, v1
    s_mov_b64 s[76:77], s[40:41]
    s_mov_b32 s78, 0x800000
    s_mov_b32 s79, 0x20000
    s_mov_b32 s62, 0x0
    s_cmp_eq_u32 s3, 4
    s_cselect_b32 s62, s62, 0x7ffffff0
    buffer_load_dword v136, v135, s[76:79], s62 offen
    s_mov_b64 s[76:77], s[46:47]
    s_mov_b32 s78, 0x700000
    s_mov_b32 s79, 0x20000
    s_mov_b32 s62, 0x0
    s_cmp_eq_u32 s3, 4
    s_cselect_b32 s62, s62, 0x7ffffff0
    buffer_load_dword v136, v135, s[76:79], s62 offen
    s_mov_b64 s[76:77], s[48:49]
    s_mov_b32 s78, 0x700000
    s_mov_b32 s79, 0x20000
    s_mov_b32 s62, 0x0
    s_cmp_eq_u32 s3, 5
    s_cselect_b32 s62, s62, 0x7ffffff0
    buffer_load_dword v136, v135, s[76:79], s62 offen
    s_mov_b64 s[76:77], s[50:51]
    s_mov_b32 s78, 0x700000
    s_mov_b32 s79, 0x20000
    s_mov_b32 s62, 0x0
    s_cmp_eq_u32 s3, 5
    s_cselect_b32 s62, s62, 0x7ffffff0
    buffer_load_dword v136, v135, s[76:79], s62 offen
    s_mov_b64 s[76:77], s[38:39]
    s_mov_b32 s78, 0x800000
    s_mov_b32 s79, 0x20000
    s_mov_b32 s62, 0x0
    s_cmp_eq_u32 s3, 6
    s_cselect_b32 s62, s62, 0x7ffffff0
    buffer_load_dword v136, v135, s[76:79], s62 offen
    s_mov_b64 s[76:77], s[56:57]
    s_mov_b32 s78, 0x400000
    s_mov_b32 s79, 0x20000
    s_mov_b32 s62, 0x0
    s_cmp_eq_u32 s3, 6
    s_cselect_b32 s62, s62, 0x7ffffff0
    buffer_load_dword v136, v135, s[76:79], s62 offen
    s_mov_b64 s[76:77], s[54:55]
    s_mov_b32 s78, 0xc00000
    s_mov_b32 s79, 0x20000
    s_mov_b32 s62, 0x0
    s_cmp_eq_u32 s3, 7
    s_cselect_b32 s62, s62, 0x7ffffff0
    buffer_load_dword v136, v135, s[76:79], s62 offen
    s_mov_b64 s[76:77], s[44:45]
    s_mov_b32 s78, 0x800
    s_mov_b32 s79, 0x20000
    s_mov_b32 s62, 0x0
    s_cmp_eq_u32 s3, 7
    s_cselect_b32 s62, s62, 0x7ffffff0
    buffer_load_dword v136, v135, s[76:79], s62 offen
    s_mov_b32 s27, 0
adaLN_cond__sliding_block_cached__moe_arch_mod__prompt_kernel_g14p:
    buffer_load_dwordx4 v[76:79], v139, s[8:11], s16 offen sc1
    buffer_load_dwordx4 v[80:83], v140, s[8:11], s17 offen sc1
    s_waitcnt vmcnt(1)
    v_cmp_ne_u32 vcc, s28, v78
    v_cmp_ne_u32 s[62:63], s28, v79
    s_or_b64 vcc, vcc, s[62:63]
    s_waitcnt vmcnt(0)
    v_cmp_ne_u32 s[62:63], s28, v83
    s_or_b64 vcc, vcc, s[62:63]
    s_add_u32 s27, s27, 1
    s_cmp_ge_u32 s27, 65536
    s_cbranch_scc1 adaLN_cond__sliding_block_cached__moe_arch_mod__prompt_kernel_g14g
    s_cbranch_vccnz adaLN_cond__sliding_block_cached__moe_arch_mod__prompt_kernel_g14p
adaLN_cond__sliding_block_cached__moe_arch_mod__prompt_kernel_g14g:
    v_add_f32_dpp v76, v76, v76 row_ror:8 row_mask:0xf bank_mask:0xf
    v_add_f32_dpp v77, v77, v77 row_ror:8 row_mask:0xf bank_mask:0xf
    v_mov_b32 v17, v76
    s_nop 1
    v_permlane16_swap_b32 v76, v17
    v_add_f32 v76, v76, v17
    v_mov_b32 v18, v77
    s_nop 1
    v_permlane16_swap_b32 v77, v18
    v_add_f32 v77, v77, v18
    v_mov_b32 v17, v76
    s_nop 1
    v_permlane32_swap_b32 v76, v17
    v_add_f32 v76, v76, v17
    v_mov_b32 v18, v77
    s_nop 1
    v_permlane32_swap_b32 v77, v18
    v_add_f32 v77, v77, v18
    v_cvt_pk_bf16_f32 v17, v76, v77
    v_lshlrev_b32 v76, 16, v17
    v_and_b32 v77, 0xffff0000, v17
    v_add_f32 v76, 1.0, v76
    v_add_f32 v77, 1.0, v77
    v_cvt_pk_bf16_f32 v17, v76, v77
    v_lshlrev_b32 v76, 16, v17
    v_and_b32 v77, 0xffff0000, v17
    s_lshl_b32 s16, s3, 6
    s_add_u32 s16, s16, 151552
    v_lshl_add_u32 v16, v16, 3, s16
    ds_write_b64 v16, v[76:77]
    v_lshrrev_b32 v17, 4, v1
    v_lshlrev_b32 v17, 5, v17
    v_add_u32 v17, 151552, v17
    v_sub_f32 v56, v56, v80
    v_sub_f32 v57, v57, v80
    v_sub_f32 v58, v58, v80
    v_sub_f32 v59, v59, v80
    v_sub_f32 v60, v60, v80
    v_sub_f32 v61, v61, v80
    v_sub_f32 v62, v62, v80
    v_sub_f32 v63, v63, v80
    v_sub_f32 v64, v64, v80
    v_sub_f32 v65, v65, v80
    v_sub_f32 v66, v66, v80
    v_sub_f32 v67, v67, v80
    v_sub_f32 v68, v68, v80
    v_sub_f32 v69, v69, v80
    v_sub_f32 v70, v70, v80
    v_sub_f32 v71, v71, v80
    v_cvt_pk_bf16_f32 v18, v56, v57
    v_lshlrev_b32 v56, 16, v18
    v_and_b32 v57, 0xffff0000, v18
    v_cvt_pk_bf16_f32 v19, v58, v59
    v_lshlrev_b32 v58, 16, v19
    v_and_b32 v59, 0xffff0000, v19
    v_cvt_pk_bf16_f32 v18, v60, v61
    v_lshlrev_b32 v60, 16, v18
    v_and_b32 v61, 0xffff0000, v18
    v_cvt_pk_bf16_f32 v19, v62, v63
    v_lshlrev_b32 v62, 16, v19
    v_and_b32 v63, 0xffff0000, v19
    v_cvt_pk_bf16_f32 v18, v64, v65
    v_lshlrev_b32 v64, 16, v18
    v_and_b32 v65, 0xffff0000, v18
    v_cvt_pk_bf16_f32 v19, v66, v67
    v_lshlrev_b32 v66, 16, v19
    v_and_b32 v67, 0xffff0000, v19
    v_cvt_pk_bf16_f32 v18, v68, v69
    v_lshlrev_b32 v68, 16, v18
    v_and_b32 v69, 0xffff0000, v18
    v_cvt_pk_bf16_f32 v19, v70, v71
    v_lshlrev_b32 v70, 16, v19
    v_and_b32 v71, 0xffff0000, v19
    v_mul_f32 v56, v56, v82
    v_mul_f32 v57, v57, v82
    v_mul_f32 v58, v58, v82
    v_mul_f32 v59, v59, v82
    v_mul_f32 v60, v60, v82
    v_mul_f32 v61, v61, v82
    v_mul_f32 v62, v62, v82
    v_mul_f32 v63, v63, v82
    v_mul_f32 v64, v64, v82
    v_mul_f32 v65, v65, v82
    v_mul_f32 v66, v66, v82
    v_mul_f32 v67, v67, v82
    v_mul_f32 v68, v68, v82
    v_mul_f32 v69, v69, v82
    v_mul_f32 v70, v70, v82
    v_mul_f32 v71, v71, v82
    v_cvt_pk_bf16_f32 v18, v56, v57
    v_lshlrev_b32 v56, 16, v18
    v_and_b32 v57, 0xffff0000, v18
    v_cvt_pk_bf16_f32 v19, v58, v59
    v_lshlrev_b32 v58, 16, v19
    v_and_b32 v59, 0xffff0000, v19
    v_cvt_pk_bf16_f32 v18, v60, v61
    v_lshlrev_b32 v60, 16, v18
    v_and_b32 v61, 0xffff0000, v18
    v_cvt_pk_bf16_f32 v19, v62, v63
    v_lshlrev_b32 v62, 16, v19
    v_and_b32 v63, 0xffff0000, v19
    v_cvt_pk_bf16_f32 v18, v64, v65
    v_lshlrev_b32 v64, 16, v18
    v_and_b32 v65, 0xffff0000, v18
    v_cvt_pk_bf16_f32 v19, v66, v67
    v_lshlrev_b32 v66, 16, v19
    v_and_b32 v67, 0xffff0000, v19
    v_cvt_pk_bf16_f32 v18, v68, v69
    v_lshlrev_b32 v68, 16, v18
    v_and_b32 v69, 0xffff0000, v18
    v_cvt_pk_bf16_f32 v19, v70, v71
    v_lshlrev_b32 v70, 16, v19
    v_and_b32 v71, 0xffff0000, v19
    s_lshl_b32 s16, s29, 15
    s_lshl_b32 s17, s31, 11
    s_add_u32 s16, s16, s17
    s_waitcnt lgkmcnt(0)
    s_barrier
    s_cmp_lt_u32 s24, 8
    s_cbranch_scc1 adaLN_cond__sliding_block_cached__moe_arch_mod__prompt_kernel_kvS
    v_lshl_or_b32 v84, v89, 16, v88
    v_lshl_or_b32 v85, v91, 16, v90
    v_lshl_or_b32 v86, v93, 16, v92
    v_lshl_or_b32 v87, v95, 16, v94
    v_and_b32 v88, 0x7fff, v88
    v_and_b32 v89, 0x7fff, v89
    v_and_b32 v90, 0x7fff, v90
    v_and_b32 v91, 0x7fff, v91
    v_and_b32 v92, 0x7fff, v92
    v_and_b32 v93, 0x7fff, v93
    v_and_b32 v94, 0x7fff, v94
    v_and_b32 v95, 0x7fff, v95
    v_max3_u32 v88, v88, v89, v90
    v_max3_u32 v91, v91, v92, v93
    v_max3_u32 v88, v88, v94, v95
    v_max_u32 v88, v88, v91
    v_cmp_le_u32 vcc, 0x4980, v88
    v_mov_b32 v89, s28
    s_mov_b32 s26, 0x564000
    s_and_saveexec_b64 s[62:63], vcc
    buffer_store_dword v89, v132, s[8:11], s26 offen sc1
    s_mov_b64 exec, s[62:63]
adaLN_cond__sliding_block_cached__moe_arch_mod__prompt_kernel_kvS:
    buffer_store_dwordx4 v[84:87], v2, s[8:11], s21 offen sc1
    ds_read_b128 v[96:99], v17 offset:256
    ds_read_b128 v[104:107], v17 offset:0
    ds_read_b128 v[100:103], v17 offset:272
    ds_read_b128 v[108:111], v17 offset:16
    ds_read_b128 v[112:115], v17 offset:384
    ds_read_b128 v[120:123], v17 offset:128
    ds_read_b128 v[116:119], v17 offset:400
    ds_read_b128 v[124:127], v17 offset:144
    s_waitcnt lgkmcnt(7)
    v_pk_mul_f32 v[56:57], v[56:57], v[96:97]
    v_pk_mul_f32 v[58:59], v[58:59], v[98:99]
    s_waitcnt lgkmcnt(5)
    v_pk_mul_f32 v[60:61], v[60:61], v[100:101]
    v_pk_mul_f32 v[62:63], v[62:63], v[102:103]
    v_cvt_pk_bf16_f32 v18, v56, v57
    v_lshlrev_b32 v56, 16, v18
    v_and_b32 v57, 0xffff0000, v18
    v_cvt_pk_bf16_f32 v19, v58, v59
    v_lshlrev_b32 v58, 16, v19
    v_and_b32 v59, 0xffff0000, v19
    v_cvt_pk_bf16_f32 v18, v60, v61
    v_lshlrev_b32 v60, 16, v18
    v_and_b32 v61, 0xffff0000, v18
    v_cvt_pk_bf16_f32 v19, v62, v63
    v_lshlrev_b32 v62, 16, v19
    v_and_b32 v63, 0xffff0000, v19
    v_pk_add_f32 v[56:57], v[56:57], v[104:105]
    v_pk_add_f32 v[58:59], v[58:59], v[106:107]
    s_waitcnt lgkmcnt(4)
    v_pk_add_f32 v[60:61], v[60:61], v[108:109]
    v_pk_add_f32 v[62:63], v[62:63], v[110:111]
    v_cvt_pk_bf16_f32 v32, v56, v57
    v_cvt_pk_bf16_f32 v33, v58, v59
    v_cvt_pk_bf16_f32 v34, v60, v61
    v_cvt_pk_bf16_f32 v35, v62, v63
    buffer_store_dwordx4 v[32:35], v2, s[8:11], s16 offen offset:0 sc1
    s_waitcnt lgkmcnt(3)
    v_pk_mul_f32 v[64:65], v[64:65], v[112:113]
    v_pk_mul_f32 v[66:67], v[66:67], v[114:115]
    s_waitcnt lgkmcnt(1)
    v_pk_mul_f32 v[68:69], v[68:69], v[116:117]
    v_pk_mul_f32 v[70:71], v[70:71], v[118:119]
    v_cvt_pk_bf16_f32 v18, v64, v65
    v_lshlrev_b32 v64, 16, v18
    v_and_b32 v65, 0xffff0000, v18
    v_cvt_pk_bf16_f32 v19, v66, v67
    v_lshlrev_b32 v66, 16, v19
    v_and_b32 v67, 0xffff0000, v19
    v_cvt_pk_bf16_f32 v18, v68, v69
    v_lshlrev_b32 v68, 16, v18
    v_and_b32 v69, 0xffff0000, v18
    v_cvt_pk_bf16_f32 v19, v70, v71
    v_lshlrev_b32 v70, 16, v19
    v_and_b32 v71, 0xffff0000, v19
    v_pk_add_f32 v[64:65], v[64:65], v[120:121]
    v_pk_add_f32 v[66:67], v[66:67], v[122:123]
    s_waitcnt lgkmcnt(0)
    v_pk_add_f32 v[68:69], v[68:69], v[124:125]
    v_pk_add_f32 v[70:71], v[70:71], v[126:127]
    v_cvt_pk_bf16_f32 v36, v64, v65
    v_cvt_pk_bf16_f32 v37, v66, v67
    v_cvt_pk_bf16_f32 v38, v68, v69
    v_cvt_pk_bf16_f32 v39, v70, v71
    buffer_store_dwordx4 v[36:39], v2, s[8:11], s16 offen offset:1024 sc1
    s_lshl_b32 s19, s3, 16
    s_lshl_b32 s20, s3, 11
    s_lshl_b32 s16, s12, 8
    s_add_u32 s4, s38, s16
    s_addc_u32 s5, s39, 0
    s_sub_u32 s6, 0x800000, s16
    s_mov_b32 s7, 0x20000
    s_barrier
    s_add_u32 s22, s19, 0x0
    s_add_u32 m0, s20, 0x0
    s_nop 0
    buffer_load_dwordx4 v3, s[4:7], s22 offen lds
    s_add_u32 s22, s19, 0x8000
    s_add_u32 m0, s20, 0x400
    s_nop 0
    buffer_load_dwordx4 v3, s[4:7], s22 offen lds
    s_add_u32 s22, s19, 0x80000
    s_add_u32 m0, s20, 0x4000
    s_nop 0
    buffer_load_dwordx4 v3, s[4:7], s22 offen lds
    s_add_u32 s22, s19, 0x88000
    s_add_u32 m0, s20, 0x4400
    s_nop 0
    buffer_load_dwordx4 v3, s[4:7], s22 offen lds
    s_add_u32 s22, s19, 0x100000
    s_add_u32 m0, s20, 0x8000
    s_nop 0
    buffer_load_dwordx4 v3, s[4:7], s22 offen lds
    s_add_u32 s22, s19, 0x108000
    s_add_u32 m0, s20, 0x8400
    s_nop 0
    buffer_load_dwordx4 v3, s[4:7], s22 offen lds
    v_mov_b32 v134, s28
    s_lshl_b32 s16, s29, 4
    s_add_u32 s16, s16, s31
    s_lshl_b32 s16, s16, 2
    s_add_u32 s16, s16, 0x528000
    v_and_b32 v16, 31, v1
    v_lshlrev_b32 v16, 2, v16
    s_lshl_b32 s17, s13, 3
    s_add_u32 s17, s17, s3
    s_lshl_b32 s17, s17, 7
    s_add_u32 s17, s17, 0x528000
    s_waitcnt vmcnt(6)
    s_mov_b64 exec, 1
    buffer_store_dword v134, v132, s[8:11], s16 offen sc1
    s_mov_b64 exec, -1
    s_waitcnt vmcnt(0)
    s_mov_b32 s27, 0
adaLN_cond__sliding_block_cached__moe_arch_mod__prompt_kernel_h15p:
    buffer_load_dword v17, v16, s[8:11], s17 offen sc1
    s_waitcnt vmcnt(0)
    v_cmp_ne_u32 vcc, s28, v17
    s_add_u32 s27, s27, 1
    s_cmp_ge_u32 s27, 65536
    s_cbranch_scc1 adaLN_cond__sliding_block_cached__moe_arch_mod__prompt_kernel_h15g
    s_cbranch_vccnz adaLN_cond__sliding_block_cached__moe_arch_mod__prompt_kernel_h15p
adaLN_cond__sliding_block_cached__moe_arch_mod__prompt_kernel_h15g:
    s_mov_b32 s23, 0x0
    buffer_load_dwordx4 v[88:91], v7, s[8:11], s23 offen offset:0 sc1
    s_mov_b32 s23, 0x8000
    buffer_load_dwordx4 v[92:95], v7, s[8:11], s23 offen offset:0 sc1
    s_mov_b32 s23, 0x0
    buffer_load_dwordx4 v[96:99], v7, s[8:11], s23 offen offset:1024 sc1
    s_mov_b32 s23, 0x8000
    buffer_load_dwordx4 v[100:103], v7, s[8:11], s23 offen offset:1024 sc1
    s_mov_b32 s23, 0x800
    buffer_load_dwordx4 v[104:107], v7, s[8:11], s23 offen offset:0 sc1
    s_mov_b32 s23, 0x8800
    buffer_load_dwordx4 v[108:111], v7, s[8:11], s23 offen offset:0 sc1
    s_mov_b32 s23, 0x800
    buffer_load_dwordx4 v[112:115], v7, s[8:11], s23 offen offset:1024 sc1
    s_mov_b32 s23, 0x8800
    buffer_load_dwordx4 v[116:119], v7, s[8:11], s23 offen offset:1024 sc1
    s_lshr_b32 s21, s12, 3
    s_lshl_b32 s21, s21, 17
    s_add_u32 s21, s21, s20
    s_add_u32 s21, s21, 0x400000
    s_barrier
    ds_read_b64_tr_b16 v[224:225], v4 offset:0
    ds_read_b64_tr_b16 v[226:227], v4 offset:1024
    ds_read_b64_tr_b16 v[228:229], v5 offset:32
    ds_read_b64_tr_b16 v[230:231], v5 offset:1056
    ds_read_b64_tr_b16 v[232:233], v4 offset:256
    ds_read_b64_tr_b16 v[234:235], v4 offset:1280
    s_waitcnt vmcnt(7) lgkmcnt(4)
    v_mfma_f32_16x16x32_bf16 v[24:27], v[224:227], v[88:91], 0
    ds_read_b64_tr_b16 v[236:237], v5 offset:288
    s_waitcnt vmcnt(6)
    v_mfma_f32_16x16x32_bf16 v[28:31], v[224:227], v[92:95], 0
    ds_read_b64_tr_b16 v[238:239], v5 offset:1312
    s_waitcnt lgkmcnt(4)
    v_mfma_f32_16x16x32_bf16 v[32:35], v[228:231], v[88:91], 0
    ds_read_b64_tr_b16 v[240:241], v4 offset:512
    v_mfma_f32_16x16x32_bf16 v[36:39], v[228:231], v[92:95], 0
    ds_read_b64_tr_b16 v[242:243], v4 offset:1536
    s_mov_b32 s23, 0x1000
    buffer_load_dwordx4 v[120:123], v7, s[8:11], s23 offen offset:0 sc1
    s_waitcnt lgkmcnt(4)
    v_mfma_f32_16x16x32_bf16 v[40:43], v[232:235], v[88:91], 0
    ds_read_b64_tr_b16 v[244:245], v5 offset:544
    v_mfma_f32_16x16x32_bf16 v[44:47], v[232:235], v[92:95], 0
    ds_read_b64_tr_b16 v[246:247], v5 offset:1568
    s_waitcnt lgkmcnt(4)
    v_mfma_f32_16x16x32_bf16 v[48:51], v[236:239], v[88:91], 0
    ds_read_b64_tr_b16 v[224:225], v4 offset:768
    v_mfma_f32_16x16x32_bf16 v[52:55], v[236:239], v[92:95], 0
    ds_read_b64_tr_b16 v[226:227], v4 offset:1792
    s_waitcnt lgkmcnt(4)
    v_mfma_f32_16x16x32_bf16 v[56:59], v[240:243], v[88:91], 0
    ds_read_b64_tr_b16 v[228:229], v5 offset:800
    v_mfma_f32_16x16x32_bf16 v[60:63], v[240:243], v[92:95], 0
    ds_read_b64_tr_b16 v[230:231], v5 offset:1824
    s_waitcnt lgkmcnt(4)
    v_mfma_f32_16x16x32_bf16 v[64:67], v[244:247], v[88:91], 0
    ds_read_b64_tr_b16 v[232:233], v4 offset:8192
    v_mfma_f32_16x16x32_bf16 v[68:71], v[244:247], v[92:95], 0
    ds_read_b64_tr_b16 v[234:235], v4 offset:9216
    s_mov_b32 s23, 0x9000
    buffer_load_dwordx4 v[124:127], v7, s[8:11], s23 offen offset:0 sc1
    s_waitcnt lgkmcnt(4)
    v_mfma_f32_16x16x32_bf16 v[72:75], v[224:227], v[88:91], 0
    ds_read_b64_tr_b16 v[236:237], v5 offset:8224
    v_mfma_f32_16x16x32_bf16 v[76:79], v[224:227], v[92:95], 0
    ds_read_b64_tr_b16 v[238:239], v5 offset:9248
    s_waitcnt lgkmcnt(4)
    v_mfma_f32_16x16x32_bf16 v[80:83], v[228:231], v[88:91], 0
    ds_read_b64_tr_b16 v[240:241], v4 offset:8448
    v_mfma_f32_16x16x32_bf16 v[84:87], v[228:231], v[92:95], 0
    ds_read_b64_tr_b16 v[242:243], v4 offset:9472
    s_waitcnt vmcnt(7) lgkmcnt(4)
    v_mfma_f32_16x16x32_bf16 v[24:27], v[232:235], v[96:99], v[24:27]
    ds_read_b64_tr_b16 v[244:245], v5 offset:8480
    s_waitcnt vmcnt(6)
    v_mfma_f32_16x16x32_bf16 v[28:31], v[232:235], v[100:103], v[28:31]
    ds_read_b64_tr_b16 v[246:247], v5 offset:9504
    s_waitcnt lgkmcnt(4)
    v_mfma_f32_16x16x32_bf16 v[32:35], v[236:239], v[96:99], v[32:35]
    ds_read_b64_tr_b16 v[224:225], v4 offset:8704
    v_mfma_f32_16x16x32_bf16 v[36:39], v[236:239], v[100:103], v[36:39]
    ds_read_b64_tr_b16 v[226:227], v4 offset:9728
    s_mov_b32 s23, 0x1000
    buffer_load_dwordx4 v[128:131], v7, s[8:11], s23 offen offset:1024 sc1
    s_waitcnt lgkmcnt(4)
    v_mfma_f32_16x16x32_bf16 v[40:43], v[240:243], v[96:99], v[40:43]
    ds_read_b64_tr_b16 v[228:229], v5 offset:8736
    v_mfma_f32_16x16x32_bf16 v[44:47], v[240:243], v[100:103], v[44:47]
    ds_read_b64_tr_b16 v[230:231], v5 offset:9760
    s_waitcnt lgkmcnt(4)
    v_mfma_f32_16x16x32_bf16 v[48:51], v[244:247], v[96:99], v[48:51]
    ds_read_b64_tr_b16 v[232:233], v4 offset:8960
    v_mfma_f32_16x16x32_bf16 v[52:55], v[244:247], v[100:103], v[52:55]
    ds_read_b64_tr_b16 v[234:235], v4 offset:9984
    s_waitcnt lgkmcnt(4)
    v_mfma_f32_16x16x32_bf16 v[56:59], v[224:227], v[96:99], v[56:59]
    ds_read_b64_tr_b16 v[236:237], v5 offset:8992
    v_mfma_f32_16x16x32_bf16 v[60:63], v[224:227], v[100:103], v[60:63]
    ds_read_b64_tr_b16 v[238:239], v5 offset:10016
    s_waitcnt lgkmcnt(4)
    v_mfma_f32_16x16x32_bf16 v[64:67], v[228:231], v[96:99], v[64:67]
    v_mfma_f32_16x16x32_bf16 v[68:71], v[228:231], v[100:103], v[68:71]
    s_barrier
    ds_read_b64_tr_b16 v[240:241], v4 offset:16384
    ds_read_b64_tr_b16 v[242:243], v4 offset:17408
    s_mov_b32 s23, 0x9000
    buffer_load_dwordx4 v[132:135], v7, s[8:11], s23 offen offset:1024 sc1
    s_waitcnt lgkmcnt(4)
    v_mfma_f32_16x16x32_bf16 v[72:75], v[232:235], v[96:99], v[72:75]
    ds_read_b64_tr_b16 v[244:245], v5 offset:16416
    v_mfma_f32_16x16x32_bf16 v[76:79], v[232:235], v[100:103], v[76:79]
    s_add_u32 s22, s19, 0x180000
    s_add_u32 m0, s20, 0xc000
    s_nop 0
    buffer_load_dwordx4 v3, s[4:7], s22 offen lds
    ds_read_b64_tr_b16 v[246:247], v5 offset:17440
    s_waitcnt lgkmcnt(4)
    v_mfma_f32_16x16x32_bf16 v[80:83], v[236:239], v[96:99], v[80:83]
    ds_read_b64_tr_b16 v[224:225], v4 offset:16640
    v_mfma_f32_16x16x32_bf16 v[84:87], v[236:239], v[100:103], v[84:87]
    ds_read_b64_tr_b16 v[226:227], v4 offset:17664
    s_waitcnt vmcnt(8) lgkmcnt(4)
    v_mfma_f32_16x16x32_bf16 v[24:27], v[240:243], v[104:107], v[24:27]
    ds_read_b64_tr_b16 v[228:229], v5 offset:16672
    s_waitcnt vmcnt(7)
    v_mfma_f32_16x16x32_bf16 v[28:31], v[240:243], v[108:111], v[28:31]
    ds_read_b64_tr_b16 v[230:231], v5 offset:17696
    s_waitcnt lgkmcnt(4)
    v_mfma_f32_16x16x32_bf16 v[32:35], v[244:247], v[104:107], v[32:35]
    ds_read_b64_tr_b16 v[232:233], v4 offset:16896
    v_mfma_f32_16x16x32_bf16 v[36:39], v[244:247], v[108:111], v[36:39]
    ds_read_b64_tr_b16 v[234:235], v4 offset:17920
    s_mov_b32 s23, 0x1800
    buffer_load_dwordx4 v[88:91], v7, s[8:11], s23 offen offset:0 sc1
    s_waitcnt lgkmcnt(4)
    v_mfma_f32_16x16x32_bf16 v[40:43], v[224:227], v[104:107], v[40:43]
    ds_read_b64_tr_b16 v[236:237], v5 offset:16928
    v_mfma_f32_16x16x32_bf16 v[44:47], v[224:227], v[108:111], v[44:47]
    s_add_u32 s22, s19, 0x188000
    s_add_u32 m0, s20, 0xc400
    s_nop 0
    buffer_load_dwordx4 v3, s[4:7], s22 offen lds
    ds_read_b64_tr_b16 v[238:239], v5 offset:17952
    s_waitcnt lgkmcnt(4)
    v_mfma_f32_16x16x32_bf16 v[48:51], v[228:231], v[104:107], v[48:51]
    ds_read_b64_tr_b16 v[240:241], v4 offset:17152
    v_mfma_f32_16x16x32_bf16 v[52:55], v[228:231], v[108:111], v[52:55]
    ds_read_b64_tr_b16 v[242:243], v4 offset:18176
    s_waitcnt lgkmcnt(4)
    v_mfma_f32_16x16x32_bf16 v[56:59], v[232:235], v[104:107], v[56:59]
    ds_read_b64_tr_b16 v[244:245], v5 offset:17184
    v_mfma_f32_16x16x32_bf16 v[60:63], v[232:235], v[108:111], v[60:63]
    ds_read_b64_tr_b16 v[246:247], v5 offset:18208
    s_waitcnt lgkmcnt(4)
    v_mfma_f32_16x16x32_bf16 v[64:67], v[236:239], v[104:107], v[64:67]
    ds_read_b64_tr_b16 v[224:225], v4 offset:24576
    v_mfma_f32_16x16x32_bf16 v[68:71], v[236:239], v[108:111], v[68:71]
    ds_read_b64_tr_b16 v[226:227], v4 offset:25600
    s_mov_b32 s23, 0x9800
    buffer_load_dwordx4 v[92:95], v7, s[8:11], s23 offen offset:0 sc1
    s_waitcnt lgkmcnt(4)
    v_mfma_f32_16x16x32_bf16 v[72:75], v[240:243], v[104:107], v[72:75]
    ds_read_b64_tr_b16 v[228:229], v5 offset:24608
    v_mfma_f32_16x16x32_bf16 v[76:79], v[240:243], v[108:111], v[76:79]
    ds_read_b64_tr_b16 v[230:231], v5 offset:25632
    s_waitcnt lgkmcnt(4)
    v_mfma_f32_16x16x32_bf16 v[80:83], v[244:247], v[104:107], v[80:83]
    ds_read_b64_tr_b16 v[232:233], v4 offset:24832
    v_mfma_f32_16x16x32_bf16 v[84:87], v[244:247], v[108:111], v[84:87]
    ds_read_b64_tr_b16 v[234:235], v4 offset:25856
    s_waitcnt vmcnt(9) lgkmcnt(4)
    v_mfma_f32_16x16x32_bf16 v[24:27], v[224:227], v[112:115], v[24:27]
    ds_read_b64_tr_b16 v[236:237], v5 offset:24864
    s_waitcnt vmcnt(8)
    v_mfma_f32_16x16x32_bf16 v[28:31], v[224:227], v[116:119], v[28:31]
    ds_read_b64_tr_b16 v[238:239], v5 offset:25888
    s_waitcnt lgkmcnt(4)
    v_mfma_f32_16x16x32_bf16 v[32:35], v[228:231], v[112:115], v[32:35]
    ds_read_b64_tr_b16 v[240:241], v4 offset:25088
    v_mfma_f32_16x16x32_bf16 v[36:39], v[228:231], v[116:119], v[36:39]
    ds_read_b64_tr_b16 v[242:243], v4 offset:26112
    s_mov_b32 s23, 0x1800
    buffer_load_dwordx4 v[96:99], v7, s[8:11], s23 offen offset:1024 sc1
    s_waitcnt lgkmcnt(4)
    v_mfma_f32_16x16x32_bf16 v[40:43], v[232:235], v[112:115], v[40:43]
    ds_read_b64_tr_b16 v[244:245], v5 offset:25120
    v_mfma_f32_16x16x32_bf16 v[44:47], v[232:235], v[116:119], v[44:47]
    ds_read_b64_tr_b16 v[246:247], v5 offset:26144
    s_waitcnt lgkmcnt(4)
    v_mfma_f32_16x16x32_bf16 v[48:51], v[236:239], v[112:115], v[48:51]
    ds_read_b64_tr_b16 v[224:225], v4 offset:25344
    v_mfma_f32_16x16x32_bf16 v[52:55], v[236:239], v[116:119], v[52:55]
    ds_read_b64_tr_b16 v[226:227], v4 offset:26368
    s_waitcnt lgkmcnt(4)
    v_mfma_f32_16x16x32_bf16 v[56:59], v[240:243], v[112:115], v[56:59]
    ds_read_b64_tr_b16 v[228:229], v5 offset:25376
    v_mfma_f32_16x16x32_bf16 v[60:63], v[240:243], v[116:119], v[60:63]
    ds_read_b64_tr_b16 v[230:231], v5 offset:26400
    s_waitcnt lgkmcnt(4)
    v_mfma_f32_16x16x32_bf16 v[64:67], v[244:247], v[112:115], v[64:67]
    v_mfma_f32_16x16x32_bf16 v[68:71], v[244:247], v[116:119], v[68:71]
    s_barrier
    ds_read_b64_tr_b16 v[232:233], v4 offset:32768
    ds_read_b64_tr_b16 v[234:235], v4 offset:33792
    s_mov_b32 s23, 0x9800
    buffer_load_dwordx4 v[100:103], v7, s[8:11], s23 offen offset:1024 sc1
    s_waitcnt lgkmcnt(4)
    v_mfma_f32_16x16x32_bf16 v[72:75], v[224:227], v[112:115], v[72:75]
    ds_read_b64_tr_b16 v[236:237], v5 offset:32800
    v_mfma_f32_16x16x32_bf16 v[76:79], v[224:227], v[116:119], v[76:79]
    s_add_u32 s22, s19, 0x200000
    s_add_u32 m0, s20, 0x0
    s_nop 0
    buffer_load_dwordx4 v3, s[4:7], s22 offen lds
    ds_read_b64_tr_b16 v[238:239], v5 offset:33824
    s_waitcnt lgkmcnt(4)
    v_mfma_f32_16x16x32_bf16 v[80:83], v[228:231], v[112:115], v[80:83]
    ds_read_b64_tr_b16 v[240:241], v4 offset:33024
    v_mfma_f32_16x16x32_bf16 v[84:87], v[228:231], v[116:119], v[84:87]
    ds_read_b64_tr_b16 v[242:243], v4 offset:34048
    s_waitcnt vmcnt(10) lgkmcnt(4)
    v_mfma_f32_16x16x32_bf16 v[24:27], v[232:235], v[120:123], v[24:27]
    ds_read_b64_tr_b16 v[244:245], v5 offset:33056
    s_waitcnt vmcnt(9)
    v_mfma_f32_16x16x32_bf16 v[28:31], v[232:235], v[124:127], v[28:31]
    ds_read_b64_tr_b16 v[246:247], v5 offset:34080
    s_waitcnt lgkmcnt(4)
    v_mfma_f32_16x16x32_bf16 v[32:35], v[236:239], v[120:123], v[32:35]
    ds_read_b64_tr_b16 v[224:225], v4 offset:33280
    v_mfma_f32_16x16x32_bf16 v[36:39], v[236:239], v[124:127], v[36:39]
    ds_read_b64_tr_b16 v[226:227], v4 offset:34304
    s_mov_b32 s23, 0x2000
    buffer_load_dwordx4 v[104:107], v7, s[8:11], s23 offen offset:0 sc1
    s_waitcnt lgkmcnt(4)
    v_mfma_f32_16x16x32_bf16 v[40:43], v[240:243], v[120:123], v[40:43]
    ds_read_b64_tr_b16 v[228:229], v5 offset:33312
    v_mfma_f32_16x16x32_bf16 v[44:47], v[240:243], v[124:127], v[44:47]
    s_add_u32 s22, s19, 0x208000
    s_add_u32 m0, s20, 0x400
    s_nop 0
    buffer_load_dwordx4 v3, s[4:7], s22 offen lds
    ds_read_b64_tr_b16 v[230:231], v5 offset:34336
    s_waitcnt lgkmcnt(4)
    v_mfma_f32_16x16x32_bf16 v[48:51], v[244:247], v[120:123], v[48:51]
    ds_read_b64_tr_b16 v[232:233], v4 offset:33536
    v_mfma_f32_16x16x32_bf16 v[52:55], v[244:247], v[124:127], v[52:55]
    ds_read_b64_tr_b16 v[234:235], v4 offset:34560
    s_waitcnt lgkmcnt(4)
    v_mfma_f32_16x16x32_bf16 v[56:59], v[224:227], v[120:123], v[56:59]
    ds_read_b64_tr_b16 v[236:237], v5 offset:33568
    v_mfma_f32_16x16x32_bf16 v[60:63], v[224:227], v[124:127], v[60:63]
    ds_read_b64_tr_b16 v[238:239], v5 offset:34592
    s_waitcnt lgkmcnt(4)
    v_mfma_f32_16x16x32_bf16 v[64:67], v[228:231], v[120:123], v[64:67]
    ds_read_b64_tr_b16 v[240:241], v4 offset:40960
    v_mfma_f32_16x16x32_bf16 v[68:71], v[228:231], v[124:127], v[68:71]
    ds_read_b64_tr_b16 v[242:243], v4 offset:41984
    s_mov_b32 s23, 0xa000
    buffer_load_dwordx4 v[108:111], v7, s[8:11], s23 offen offset:0 sc1
    s_waitcnt lgkmcnt(4)
    v_mfma_f32_16x16x32_bf16 v[72:75], v[232:235], v[120:123], v[72:75]
    ds_read_b64_tr_b16 v[244:245], v5 offset:40992
    v_mfma_f32_16x16x32_bf16 v[76:79], v[232:235], v[124:127], v[76:79]
    ds_read_b64_tr_b16 v[246:247], v5 offset:42016
    s_waitcnt lgkmcnt(4)
    v_mfma_f32_16x16x32_bf16 v[80:83], v[236:239], v[120:123], v[80:83]
    ds_read_b64_tr_b16 v[224:225], v4 offset:41216
    v_mfma_f32_16x16x32_bf16 v[84:87], v[236:239], v[124:127], v[84:87]
    ds_read_b64_tr_b16 v[226:227], v4 offset:42240
    s_waitcnt vmcnt(11) lgkmcnt(4)
    v_mfma_f32_16x16x32_bf16 v[24:27], v[240:243], v[128:131], v[24:27]
    ds_read_b64_tr_b16 v[228:229], v5 offset:41248
    s_waitcnt vmcnt(10)
    v_mfma_f32_16x16x32_bf16 v[28:31], v[240:243], v[132:135], v[28:31]
    ds_read_b64_tr_b16 v[230:231], v5 offset:42272
    s_waitcnt lgkmcnt(4)
    v_mfma_f32_16x16x32_bf16 v[32:35], v[244:247], v[128:131], v[32:35]
    ds_read_b64_tr_b16 v[232:233], v4 offset:41472
    v_mfma_f32_16x16x32_bf16 v[36:39], v[244:247], v[132:135], v[36:39]
    ds_read_b64_tr_b16 v[234:235], v4 offset:42496
    s_mov_b32 s23, 0x2000
    buffer_load_dwordx4 v[112:115], v7, s[8:11], s23 offen offset:1024 sc1
    s_waitcnt lgkmcnt(4)
    v_mfma_f32_16x16x32_bf16 v[40:43], v[224:227], v[128:131], v[40:43]
    ds_read_b64_tr_b16 v[236:237], v5 offset:41504
    v_mfma_f32_16x16x32_bf16 v[44:47], v[224:227], v[132:135], v[44:47]
    ds_read_b64_tr_b16 v[238:239], v5 offset:42528
    s_waitcnt lgkmcnt(4)
    v_mfma_f32_16x16x32_bf16 v[48:51], v[228:231], v[128:131], v[48:51]
    ds_read_b64_tr_b16 v[240:241], v4 offset:41728
    v_mfma_f32_16x16x32_bf16 v[52:55], v[228:231], v[132:135], v[52:55]
    ds_read_b64_tr_b16 v[242:243], v4 offset:42752
    s_waitcnt lgkmcnt(4)
    v_mfma_f32_16x16x32_bf16 v[56:59], v[232:235], v[128:131], v[56:59]
    ds_read_b64_tr_b16 v[244:245], v5 offset:41760
    v_mfma_f32_16x16x32_bf16 v[60:63], v[232:235], v[132:135], v[60:63]
    ds_read_b64_tr_b16 v[246:247], v5 offset:42784
    s_waitcnt lgkmcnt(4)
    v_mfma_f32_16x16x32_bf16 v[64:67], v[236:239], v[128:131], v[64:67]
    v_mfma_f32_16x16x32_bf16 v[68:71], v[236:239], v[132:135], v[68:71]
    s_waitcnt vmcnt(8)
    s_barrier
    ds_read_b64_tr_b16 v[224:225], v4 offset:49152
    ds_read_b64_tr_b16 v[226:227], v4 offset:50176
    s_mov_b32 s23, 0xa000
    buffer_load_dwordx4 v[116:119], v7, s[8:11], s23 offen offset:1024 sc1
    s_waitcnt lgkmcnt(4)
    v_mfma_f32_16x16x32_bf16 v[72:75], v[240:243], v[128:131], v[72:75]
    ds_read_b64_tr_b16 v[228:229], v5 offset:49184
    v_mfma_f32_16x16x32_bf16 v[76:79], v[240:243], v[132:135], v[76:79]
    s_add_u32 s22, s19, 0x280000
    s_add_u32 m0, s20, 0x4000
    s_nop 0
    buffer_load_dwordx4 v3, s[4:7], s22 offen lds
    ds_read_b64_tr_b16 v[230:231], v5 offset:50208
    s_waitcnt lgkmcnt(4)
    v_mfma_f32_16x16x32_bf16 v[80:83], v[244:247], v[128:131], v[80:83]
    ds_read_b64_tr_b16 v[232:233], v4 offset:49408
    v_mfma_f32_16x16x32_bf16 v[84:87], v[244:247], v[132:135], v[84:87]
    ds_read_b64_tr_b16 v[234:235], v4 offset:50432
    s_waitcnt lgkmcnt(4)
    v_mfma_f32_16x16x32_bf16 v[24:27], v[224:227], v[88:91], v[24:27]
    ds_read_b64_tr_b16 v[236:237], v5 offset:49440
    s_waitcnt vmcnt(9)
    v_mfma_f32_16x16x32_bf16 v[28:31], v[224:227], v[92:95], v[28:31]
    ds_read_b64_tr_b16 v[238:239], v5 offset:50464
    s_waitcnt lgkmcnt(4)
    v_mfma_f32_16x16x32_bf16 v[32:35], v[228:231], v[88:91], v[32:35]
    ds_read_b64_tr_b16 v[240:241], v4 offset:49664
    v_mfma_f32_16x16x32_bf16 v[36:39], v[228:231], v[92:95], v[36:39]
    ds_read_b64_tr_b16 v[242:243], v4 offset:50688
    s_mov_b32 s23, 0x2800
    buffer_load_dwordx4 v[120:123], v7, s[8:11], s23 offen offset:0 sc1
    s_waitcnt lgkmcnt(4)
    v_mfma_f32_16x16x32_bf16 v[40:43], v[232:235], v[88:91], v[40:43]
    ds_read_b64_tr_b16 v[244:245], v5 offset:49696
    v_mfma_f32_16x16x32_bf16 v[44:47], v[232:235], v[92:95], v[44:47]
    s_add_u32 s22, s19, 0x288000
    s_add_u32 m0, s20, 0x4400
    s_nop 0
    buffer_load_dwordx4 v3, s[4:7], s22 offen lds
    ds_read_b64_tr_b16 v[246:247], v5 offset:50720
    s_waitcnt lgkmcnt(4)
    v_mfma_f32_16x16x32_bf16 v[48:51], v[236:239], v[88:91], v[48:51]
    ds_read_b64_tr_b16 v[224:225], v4 offset:49920
    v_mfma_f32_16x16x32_bf16 v[52:55], v[236:239], v[92:95], v[52:55]
    ds_read_b64_tr_b16 v[226:227], v4 offset:50944
    s_waitcnt lgkmcnt(4)
    v_mfma_f32_16x16x32_bf16 v[56:59], v[240:243], v[88:91], v[56:59]
    ds_read_b64_tr_b16 v[228:229], v5 offset:49952
    v_mfma_f32_16x16x32_bf16 v[60:63], v[240:243], v[92:95], v[60:63]
    ds_read_b64_tr_b16 v[230:231], v5 offset:50976
    s_waitcnt lgkmcnt(4)
    v_mfma_f32_16x16x32_bf16 v[64:67], v[244:247], v[88:91], v[64:67]
    ds_read_b64_tr_b16 v[232:233], v4 offset:57344
    v_mfma_f32_16x16x32_bf16 v[68:71], v[244:247], v[92:95], v[68:71]
    ds_read_b64_tr_b16 v[234:235], v4 offset:58368
    s_mov_b32 s23, 0xa800
    buffer_load_dwordx4 v[124:127], v7, s[8:11], s23 offen offset:0 sc1
    s_waitcnt lgkmcnt(4)
    v_mfma_f32_16x16x32_bf16 v[72:75], v[224:227], v[88:91], v[72:75]
    ds_read_b64_tr_b16 v[236:237], v5 offset:57376
    v_mfma_f32_16x16x32_bf16 v[76:79], v[224:227], v[92:95], v[76:79]
    ds_read_b64_tr_b16 v[238:239], v5 offset:58400
    s_waitcnt lgkmcnt(4)
    v_mfma_f32_16x16x32_bf16 v[80:83], v[228:231], v[88:91], v[80:83]
    ds_read_b64_tr_b16 v[240:241], v4 offset:57600
    v_mfma_f32_16x16x32_bf16 v[84:87], v[228:231], v[92:95], v[84:87]
    ds_read_b64_tr_b16 v[242:243], v4 offset:58624
    s_waitcnt vmcnt(11) lgkmcnt(4)
    v_mfma_f32_16x16x32_bf16 v[24:27], v[232:235], v[96:99], v[24:27]
    ds_read_b64_tr_b16 v[244:245], v5 offset:57632
    s_waitcnt vmcnt(10)
    v_mfma_f32_16x16x32_bf16 v[28:31], v[232:235], v[100:103], v[28:31]
    ds_read_b64_tr_b16 v[246:247], v5 offset:58656
    s_waitcnt lgkmcnt(4)
    v_mfma_f32_16x16x32_bf16 v[32:35], v[236:239], v[96:99], v[32:35]
    ds_read_b64_tr_b16 v[224:225], v4 offset:57856
    v_mfma_f32_16x16x32_bf16 v[36:39], v[236:239], v[100:103], v[36:39]
    ds_read_b64_tr_b16 v[226:227], v4 offset:58880
    s_mov_b32 s23, 0x2800
    buffer_load_dwordx4 v[128:131], v7, s[8:11], s23 offen offset:1024 sc1
    s_waitcnt lgkmcnt(4)
    v_mfma_f32_16x16x32_bf16 v[40:43], v[240:243], v[96:99], v[40:43]
    ds_read_b64_tr_b16 v[228:229], v5 offset:57888
    v_mfma_f32_16x16x32_bf16 v[44:47], v[240:243], v[100:103], v[44:47]
    ds_read_b64_tr_b16 v[230:231], v5 offset:58912
    s_waitcnt lgkmcnt(4)
    v_mfma_f32_16x16x32_bf16 v[48:51], v[244:247], v[96:99], v[48:51]
    ds_read_b64_tr_b16 v[232:233], v4 offset:58112
    v_mfma_f32_16x16x32_bf16 v[52:55], v[244:247], v[100:103], v[52:55]
    ds_read_b64_tr_b16 v[234:235], v4 offset:59136
    s_waitcnt lgkmcnt(4)
    v_mfma_f32_16x16x32_bf16 v[56:59], v[224:227], v[96:99], v[56:59]
    ds_read_b64_tr_b16 v[236:237], v5 offset:58144
    v_mfma_f32_16x16x32_bf16 v[60:63], v[224:227], v[100:103], v[60:63]
    ds_read_b64_tr_b16 v[238:239], v5 offset:59168
    s_waitcnt lgkmcnt(4)
    v_mfma_f32_16x16x32_bf16 v[64:67], v[228:231], v[96:99], v[64:67]
    v_mfma_f32_16x16x32_bf16 v[68:71], v[228:231], v[100:103], v[68:71]
    s_waitcnt vmcnt(8)
    s_barrier
    ds_read_b64_tr_b16 v[240:241], v4 offset:0
    ds_read_b64_tr_b16 v[242:243], v4 offset:1024
    s_mov_b32 s23, 0xa800
    buffer_load_dwordx4 v[132:135], v7, s[8:11], s23 offen offset:1024 sc1
    s_waitcnt lgkmcnt(4)
    v_mfma_f32_16x16x32_bf16 v[72:75], v[232:235], v[96:99], v[72:75]
    ds_read_b64_tr_b16 v[244:245], v5 offset:32
    v_mfma_f32_16x16x32_bf16 v[76:79], v[232:235], v[100:103], v[76:79]
    s_add_u32 s22, s19, 0x300000
    s_add_u32 m0, s20, 0x8000
    s_nop 0
    buffer_load_dwordx4 v3, s[4:7], s22 offen lds
    ds_read_b64_tr_b16 v[246:247], v5 offset:1056
    s_waitcnt lgkmcnt(4)
    v_mfma_f32_16x16x32_bf16 v[80:83], v[236:239], v[96:99], v[80:83]
    ds_read_b64_tr_b16 v[224:225], v4 offset:256
    v_mfma_f32_16x16x32_bf16 v[84:87], v[236:239], v[100:103], v[84:87]
    ds_read_b64_tr_b16 v[226:227], v4 offset:1280
    s_waitcnt lgkmcnt(4)
    v_mfma_f32_16x16x32_bf16 v[24:27], v[240:243], v[104:107], v[24:27]
    ds_read_b64_tr_b16 v[228:229], v5 offset:288
    s_waitcnt vmcnt(9)
    v_mfma_f32_16x16x32_bf16 v[28:31], v[240:243], v[108:111], v[28:31]
    ds_read_b64_tr_b16 v[230:231], v5 offset:1312
    s_waitcnt lgkmcnt(4)
    v_mfma_f32_16x16x32_bf16 v[32:35], v[244:247], v[104:107], v[32:35]
    ds_read_b64_tr_b16 v[232:233], v4 offset:512
    v_mfma_f32_16x16x32_bf16 v[36:39], v[244:247], v[108:111], v[36:39]
    ds_read_b64_tr_b16 v[234:235], v4 offset:1536
    s_mov_b32 s23, 0x3000
    buffer_load_dwordx4 v[88:91], v7, s[8:11], s23 offen offset:0 sc1
    s_waitcnt lgkmcnt(4)
    v_mfma_f32_16x16x32_bf16 v[40:43], v[224:227], v[104:107], v[40:43]
    ds_read_b64_tr_b16 v[236:237], v5 offset:544
    v_mfma_f32_16x16x32_bf16 v[44:47], v[224:227], v[108:111], v[44:47]
    s_add_u32 s22, s19, 0x308000
    s_add_u32 m0, s20, 0x8400
    s_nop 0
    buffer_load_dwordx4 v3, s[4:7], s22 offen lds
    ds_read_b64_tr_b16 v[238:239], v5 offset:1568
    s_waitcnt lgkmcnt(4)
    v_mfma_f32_16x16x32_bf16 v[48:51], v[228:231], v[104:107], v[48:51]
    ds_read_b64_tr_b16 v[240:241], v4 offset:768
    v_mfma_f32_16x16x32_bf16 v[52:55], v[228:231], v[108:111], v[52:55]
    ds_read_b64_tr_b16 v[242:243], v4 offset:1792
    s_waitcnt lgkmcnt(4)
    v_mfma_f32_16x16x32_bf16 v[56:59], v[232:235], v[104:107], v[56:59]
    ds_read_b64_tr_b16 v[244:245], v5 offset:800
    v_mfma_f32_16x16x32_bf16 v[60:63], v[232:235], v[108:111], v[60:63]
    ds_read_b64_tr_b16 v[246:247], v5 offset:1824
    s_waitcnt lgkmcnt(4)
    v_mfma_f32_16x16x32_bf16 v[64:67], v[236:239], v[104:107], v[64:67]
    ds_read_b64_tr_b16 v[224:225], v4 offset:8192
    v_mfma_f32_16x16x32_bf16 v[68:71], v[236:239], v[108:111], v[68:71]
    ds_read_b64_tr_b16 v[226:227], v4 offset:9216
    s_mov_b32 s23, 0xb000
    buffer_load_dwordx4 v[92:95], v7, s[8:11], s23 offen offset:0 sc1
    s_waitcnt lgkmcnt(4)
    v_mfma_f32_16x16x32_bf16 v[72:75], v[240:243], v[104:107], v[72:75]
    ds_read_b64_tr_b16 v[228:229], v5 offset:8224
    v_mfma_f32_16x16x32_bf16 v[76:79], v[240:243], v[108:111], v[76:79]
    ds_read_b64_tr_b16 v[230:231], v5 offset:9248
    s_waitcnt lgkmcnt(4)
    v_mfma_f32_16x16x32_bf16 v[80:83], v[244:247], v[104:107], v[80:83]
    ds_read_b64_tr_b16 v[232:233], v4 offset:8448
    v_mfma_f32_16x16x32_bf16 v[84:87], v[244:247], v[108:111], v[84:87]
    ds_read_b64_tr_b16 v[234:235], v4 offset:9472
    s_waitcnt vmcnt(11) lgkmcnt(4)
    v_mfma_f32_16x16x32_bf16 v[24:27], v[224:227], v[112:115], v[24:27]
    ds_read_b64_tr_b16 v[236:237], v5 offset:8480
    s_waitcnt vmcnt(10)
    v_mfma_f32_16x16x32_bf16 v[28:31], v[224:227], v[116:119], v[28:31]
    ds_read_b64_tr_b16 v[238:239], v5 offset:9504
    s_waitcnt lgkmcnt(4)
    v_mfma_f32_16x16x32_bf16 v[32:35], v[228:231], v[112:115], v[32:35]
    ds_read_b64_tr_b16 v[240:241], v4 offset:8704
    v_mfma_f32_16x16x32_bf16 v[36:39], v[228:231], v[116:119], v[36:39]
    ds_read_b64_tr_b16 v[242:243], v4 offset:9728
    s_mov_b32 s23, 0x3000
    buffer_load_dwordx4 v[96:99], v7, s[8:11], s23 offen offset:1024 sc1
    s_waitcnt lgkmcnt(4)
    v_mfma_f32_16x16x32_bf16 v[40:43], v[232:235], v[112:115], v[40:43]
    ds_read_b64_tr_b16 v[244:245], v5 offset:8736
    v_mfma_f32_16x16x32_bf16 v[44:47], v[232:235], v[116:119], v[44:47]
    ds_read_b64_tr_b16 v[246:247], v5 offset:9760
    s_waitcnt lgkmcnt(4)
    v_mfma_f32_16x16x32_bf16 v[48:51], v[236:239], v[112:115], v[48:51]
    ds_read_b64_tr_b16 v[224:225], v4 offset:8960
    v_mfma_f32_16x16x32_bf16 v[52:55], v[236:239], v[116:119], v[52:55]
    ds_read_b64_tr_b16 v[226:227], v4 offset:9984
    s_waitcnt lgkmcnt(4)
    v_mfma_f32_16x16x32_bf16 v[56:59], v[240:243], v[112:115], v[56:59]
    ds_read_b64_tr_b16 v[228:229], v5 offset:8992
    v_mfma_f32_16x16x32_bf16 v[60:63], v[240:243], v[116:119], v[60:63]
    ds_read_b64_tr_b16 v[230:231], v5 offset:10016
    s_waitcnt lgkmcnt(4)
    v_mfma_f32_16x16x32_bf16 v[64:67], v[244:247], v[112:115], v[64:67]
    v_mfma_f32_16x16x32_bf16 v[68:71], v[244:247], v[116:119], v[68:71]
    s_waitcnt vmcnt(8)
    s_barrier
    ds_read_b64_tr_b16 v[232:233], v4 offset:16384
    ds_read_b64_tr_b16 v[234:235], v4 offset:17408
    s_mov_b32 s23, 0xb000
    buffer_load_dwordx4 v[100:103], v7, s[8:11], s23 offen offset:1024 sc1
    s_waitcnt lgkmcnt(4)
    v_mfma_f32_16x16x32_bf16 v[72:75], v[224:227], v[112:115], v[72:75]
    ds_read_b64_tr_b16 v[236:237], v5 offset:16416
    v_mfma_f32_16x16x32_bf16 v[76:79], v[224:227], v[116:119], v[76:79]
    s_add_u32 s22, s19, 0x380000
    s_add_u32 m0, s20, 0xc000
    s_nop 0
    buffer_load_dwordx4 v3, s[4:7], s22 offen lds
    ds_read_b64_tr_b16 v[238:239], v5 offset:17440
    s_waitcnt lgkmcnt(4)
    v_mfma_f32_16x16x32_bf16 v[80:83], v[228:231], v[112:115], v[80:83]
    ds_read_b64_tr_b16 v[240:241], v4 offset:16640
    v_mfma_f32_16x16x32_bf16 v[84:87], v[228:231], v[116:119], v[84:87]
    ds_read_b64_tr_b16 v[242:243], v4 offset:17664
    s_waitcnt lgkmcnt(4)
    v_mfma_f32_16x16x32_bf16 v[24:27], v[232:235], v[120:123], v[24:27]
    ds_read_b64_tr_b16 v[244:245], v5 offset:16672
    s_waitcnt vmcnt(9)
    v_mfma_f32_16x16x32_bf16 v[28:31], v[232:235], v[124:127], v[28:31]
    ds_read_b64_tr_b16 v[246:247], v5 offset:17696
    s_waitcnt lgkmcnt(4)
    v_mfma_f32_16x16x32_bf16 v[32:35], v[236:239], v[120:123], v[32:35]
    ds_read_b64_tr_b16 v[224:225], v4 offset:16896
    v_mfma_f32_16x16x32_bf16 v[36:39], v[236:239], v[124:127], v[36:39]
    ds_read_b64_tr_b16 v[226:227], v4 offset:17920
    s_mov_b32 s23, 0x3800
    buffer_load_dwordx4 v[104:107], v7, s[8:11], s23 offen offset:0 sc1
    s_waitcnt lgkmcnt(4)
    v_mfma_f32_16x16x32_bf16 v[40:43], v[240:243], v[120:123], v[40:43]
    ds_read_b64_tr_b16 v[228:229], v5 offset:16928
    v_mfma_f32_16x16x32_bf16 v[44:47], v[240:243], v[124:127], v[44:47]
    s_add_u32 s22, s19, 0x388000
    s_add_u32 m0, s20, 0xc400
    s_nop 0
    buffer_load_dwordx4 v3, s[4:7], s22 offen lds
    ds_read_b64_tr_b16 v[230:231], v5 offset:17952
    s_waitcnt lgkmcnt(4)
    v_mfma_f32_16x16x32_bf16 v[48:51], v[244:247], v[120:123], v[48:51]
    ds_read_b64_tr_b16 v[232:233], v4 offset:17152
    v_mfma_f32_16x16x32_bf16 v[52:55], v[244:247], v[124:127], v[52:55]
    ds_read_b64_tr_b16 v[234:235], v4 offset:18176
    s_waitcnt lgkmcnt(4)
    v_mfma_f32_16x16x32_bf16 v[56:59], v[224:227], v[120:123], v[56:59]
    ds_read_b64_tr_b16 v[236:237], v5 offset:17184
    v_mfma_f32_16x16x32_bf16 v[60:63], v[224:227], v[124:127], v[60:63]
    ds_read_b64_tr_b16 v[238:239], v5 offset:18208
    s_waitcnt lgkmcnt(4)
    v_mfma_f32_16x16x32_bf16 v[64:67], v[228:231], v[120:123], v[64:67]
    ds_read_b64_tr_b16 v[240:241], v4 offset:24576
    v_mfma_f32_16x16x32_bf16 v[68:71], v[228:231], v[124:127], v[68:71]
    ds_read_b64_tr_b16 v[242:243], v4 offset:25600
    s_mov_b32 s23, 0xb800
    buffer_load_dwordx4 v[108:111], v7, s[8:11], s23 offen offset:0 sc1
    s_waitcnt lgkmcnt(4)
    v_mfma_f32_16x16x32_bf16 v[72:75], v[232:235], v[120:123], v[72:75]
    ds_read_b64_tr_b16 v[244:245], v5 offset:24608
    v_mfma_f32_16x16x32_bf16 v[76:79], v[232:235], v[124:127], v[76:79]
    ds_read_b64_tr_b16 v[246:247], v5 offset:25632
    s_waitcnt lgkmcnt(4)
    v_mfma_f32_16x16x32_bf16 v[80:83], v[236:239], v[120:123], v[80:83]
    ds_read_b64_tr_b16 v[224:225], v4 offset:24832
    v_mfma_f32_16x16x32_bf16 v[84:87], v[236:239], v[124:127], v[84:87]
    ds_read_b64_tr_b16 v[226:227], v4 offset:25856
    s_waitcnt vmcnt(11) lgkmcnt(4)
    v_mfma_f32_16x16x32_bf16 v[24:27], v[240:243], v[128:131], v[24:27]
    ds_read_b64_tr_b16 v[228:229], v5 offset:24864
    s_waitcnt vmcnt(10)
    v_mfma_f32_16x16x32_bf16 v[28:31], v[240:243], v[132:135], v[28:31]
    ds_read_b64_tr_b16 v[230:231], v5 offset:25888
    s_waitcnt lgkmcnt(4)
    v_mfma_f32_16x16x32_bf16 v[32:35], v[244:247], v[128:131], v[32:35]
    ds_read_b64_tr_b16 v[232:233], v4 offset:25088
    v_mfma_f32_16x16x32_bf16 v[36:39], v[244:247], v[132:135], v[36:39]
    ds_read_b64_tr_b16 v[234:235], v4 offset:26112
    s_mov_b32 s23, 0x3800
    buffer_load_dwordx4 v[112:115], v7, s[8:11], s23 offen offset:1024 sc1
    s_waitcnt lgkmcnt(4)
    v_mfma_f32_16x16x32_bf16 v[40:43], v[224:227], v[128:131], v[40:43]
    ds_read_b64_tr_b16 v[236:237], v5 offset:25120
    v_mfma_f32_16x16x32_bf16 v[44:47], v[224:227], v[132:135], v[44:47]
    ds_read_b64_tr_b16 v[238:239], v5 offset:26144
    s_waitcnt lgkmcnt(4)
    v_mfma_f32_16x16x32_bf16 v[48:51], v[228:231], v[128:131], v[48:51]
    ds_read_b64_tr_b16 v[240:241], v4 offset:25344
    v_mfma_f32_16x16x32_bf16 v[52:55], v[228:231], v[132:135], v[52:55]
    ds_read_b64_tr_b16 v[242:243], v4 offset:26368
    s_waitcnt lgkmcnt(4)
    v_mfma_f32_16x16x32_bf16 v[56:59], v[232:235], v[128:131], v[56:59]
    ds_read_b64_tr_b16 v[244:245], v5 offset:25376
    v_mfma_f32_16x16x32_bf16 v[60:63], v[232:235], v[132:135], v[60:63]
    ds_read_b64_tr_b16 v[246:247], v5 offset:26400
    s_waitcnt lgkmcnt(4)
    v_mfma_f32_16x16x32_bf16 v[64:67], v[236:239], v[128:131], v[64:67]
    v_mfma_f32_16x16x32_bf16 v[68:71], v[236:239], v[132:135], v[68:71]
    s_waitcnt vmcnt(8)
    s_barrier
    ds_read_b64_tr_b16 v[224:225], v4 offset:32768
    ds_read_b64_tr_b16 v[226:227], v4 offset:33792
    s_mov_b32 s23, 0xb800
    buffer_load_dwordx4 v[116:119], v7, s[8:11], s23 offen offset:1024 sc1
    s_waitcnt lgkmcnt(4)
    v_mfma_f32_16x16x32_bf16 v[72:75], v[240:243], v[128:131], v[72:75]
    ds_read_b64_tr_b16 v[228:229], v5 offset:32800
    v_mfma_f32_16x16x32_bf16 v[76:79], v[240:243], v[132:135], v[76:79]
    s_add_u32 s22, s19, 0x400000
    s_add_u32 m0, s20, 0x0
    s_nop 0
    buffer_load_dwordx4 v3, s[4:7], s22 offen lds
    ds_read_b64_tr_b16 v[230:231], v5 offset:33824
    s_waitcnt lgkmcnt(4)
    v_mfma_f32_16x16x32_bf16 v[80:83], v[244:247], v[128:131], v[80:83]
    ds_read_b64_tr_b16 v[232:233], v4 offset:33024
    v_mfma_f32_16x16x32_bf16 v[84:87], v[244:247], v[132:135], v[84:87]
    ds_read_b64_tr_b16 v[234:235], v4 offset:34048
    s_waitcnt lgkmcnt(4)
    v_mfma_f32_16x16x32_bf16 v[24:27], v[224:227], v[88:91], v[24:27]
    ds_read_b64_tr_b16 v[236:237], v5 offset:33056
    s_waitcnt vmcnt(9)
    v_mfma_f32_16x16x32_bf16 v[28:31], v[224:227], v[92:95], v[28:31]
    ds_read_b64_tr_b16 v[238:239], v5 offset:34080
    s_waitcnt lgkmcnt(4)
    v_mfma_f32_16x16x32_bf16 v[32:35], v[228:231], v[88:91], v[32:35]
    ds_read_b64_tr_b16 v[240:241], v4 offset:33280
    v_mfma_f32_16x16x32_bf16 v[36:39], v[228:231], v[92:95], v[36:39]
    ds_read_b64_tr_b16 v[242:243], v4 offset:34304
    s_mov_b32 s23, 0x4000
    buffer_load_dwordx4 v[120:123], v7, s[8:11], s23 offen offset:0 sc1
    s_waitcnt lgkmcnt(4)
    v_mfma_f32_16x16x32_bf16 v[40:43], v[232:235], v[88:91], v[40:43]
    ds_read_b64_tr_b16 v[244:245], v5 offset:33312
    v_mfma_f32_16x16x32_bf16 v[44:47], v[232:235], v[92:95], v[44:47]
    s_add_u32 s22, s19, 0x408000
    s_add_u32 m0, s20, 0x400
    s_nop 0
    buffer_load_dwordx4 v3, s[4:7], s22 offen lds
    ds_read_b64_tr_b16 v[246:247], v5 offset:34336
    s_waitcnt lgkmcnt(4)
    v_mfma_f32_16x16x32_bf16 v[48:51], v[236:239], v[88:91], v[48:51]
    ds_read_b64_tr_b16 v[224:225], v4 offset:33536
    v_mfma_f32_16x16x32_bf16 v[52:55], v[236:239], v[92:95], v[52:55]
    ds_read_b64_tr_b16 v[226:227], v4 offset:34560
    s_waitcnt lgkmcnt(4)
    v_mfma_f32_16x16x32_bf16 v[56:59], v[240:243], v[88:91], v[56:59]
    ds_read_b64_tr_b16 v[228:229], v5 offset:33568
    v_mfma_f32_16x16x32_bf16 v[60:63], v[240:243], v[92:95], v[60:63]
    ds_read_b64_tr_b16 v[230:231], v5 offset:34592
    s_waitcnt lgkmcnt(4)
    v_mfma_f32_16x16x32_bf16 v[64:67], v[244:247], v[88:91], v[64:67]
    ds_read_b64_tr_b16 v[232:233], v4 offset:40960
    v_mfma_f32_16x16x32_bf16 v[68:71], v[244:247], v[92:95], v[68:71]
    ds_read_b64_tr_b16 v[234:235], v4 offset:41984
    s_mov_b32 s23, 0xc000
    buffer_load_dwordx4 v[124:127], v7, s[8:11], s23 offen offset:0 sc1
    s_waitcnt lgkmcnt(4)
    v_mfma_f32_16x16x32_bf16 v[72:75], v[224:227], v[88:91], v[72:75]
    ds_read_b64_tr_b16 v[236:237], v5 offset:40992
    v_lshrrev_b32 v21, 4, v1
    v_lshlrev_b32 v21, 9, v21
    v_and_b32 v20, 15, v1
    v_lshl_add_u32 v21, v20, 4, v21
    s_lshr_b32 s18, s12, 3
    s_lshl_b32 s18, s18, 11
    s_add_u32 s18, s18, 0x528100
    buffer_load_dwordx4 v[12:15], v21, s[8:11], s18 offen sc1
    v_mfma_f32_16x16x32_bf16 v[76:79], v[224:227], v[92:95], v[76:79]
    ds_read_b64_tr_b16 v[238:239], v5 offset:42016
    s_waitcnt lgkmcnt(4)
    v_mfma_f32_16x16x32_bf16 v[80:83], v[228:231], v[88:91], v[80:83]
    ds_read_b64_tr_b16 v[240:241], v4 offset:41216
    v_mfma_f32_16x16x32_bf16 v[84:87], v[228:231], v[92:95], v[84:87]
    ds_read_b64_tr_b16 v[242:243], v4 offset:42240
    s_waitcnt vmcnt(12) lgkmcnt(4)
    v_mfma_f32_16x16x32_bf16 v[24:27], v[232:235], v[96:99], v[24:27]
    ds_read_b64_tr_b16 v[244:245], v5 offset:41248
    s_waitcnt vmcnt(11)
    v_mfma_f32_16x16x32_bf16 v[28:31], v[232:235], v[100:103], v[28:31]
    ds_read_b64_tr_b16 v[246:247], v5 offset:42272
    s_waitcnt lgkmcnt(4)
    v_mfma_f32_16x16x32_bf16 v[32:35], v[236:239], v[96:99], v[32:35]
    ds_read_b64_tr_b16 v[224:225], v4 offset:41472
    v_mfma_f32_16x16x32_bf16 v[36:39], v[236:239], v[100:103], v[36:39]
    ds_read_b64_tr_b16 v[226:227], v4 offset:42496
    s_mov_b32 s23, 0x4000
    buffer_load_dwordx4 v[128:131], v7, s[8:11], s23 offen offset:1024 sc1
    s_waitcnt lgkmcnt(4)
    v_mfma_f32_16x16x32_bf16 v[40:43], v[240:243], v[96:99], v[40:43]
    ds_read_b64_tr_b16 v[228:229], v5 offset:41504
    v_mfma_f32_16x16x32_bf16 v[44:47], v[240:243], v[100:103], v[44:47]
    ds_read_b64_tr_b16 v[230:231], v5 offset:42528
    s_waitcnt lgkmcnt(4)
    v_mfma_f32_16x16x32_bf16 v[48:51], v[244:247], v[96:99], v[48:51]
    ds_read_b64_tr_b16 v[232:233], v4 offset:41728
    v_mfma_f32_16x16x32_bf16 v[52:55], v[244:247], v[100:103], v[52:55]
    ds_read_b64_tr_b16 v[234:235], v4 offset:42752
    s_waitcnt lgkmcnt(4)
    v_mfma_f32_16x16x32_bf16 v[56:59], v[224:227], v[96:99], v[56:59]
    ds_read_b64_tr_b16 v[236:237], v5 offset:41760
    v_mfma_f32_16x16x32_bf16 v[60:63], v[224:227], v[100:103], v[60:63]
    ds_read_b64_tr_b16 v[238:239], v5 offset:42784
    s_waitcnt lgkmcnt(4)
    v_mfma_f32_16x16x32_bf16 v[64:67], v[228:231], v[96:99], v[64:67]
    v_mfma_f32_16x16x32_bf16 v[68:71], v[228:231], v[100:103], v[68:71]
    s_waitcnt vmcnt(9)
    s_barrier
    ds_read_b64_tr_b16 v[240:241], v4 offset:49152
    ds_read_b64_tr_b16 v[242:243], v4 offset:50176
    s_mov_b32 s23, 0xc000
    buffer_load_dwordx4 v[132:135], v7, s[8:11], s23 offen offset:1024 sc1
    s_waitcnt lgkmcnt(4)
    v_mfma_f32_16x16x32_bf16 v[72:75], v[232:235], v[96:99], v[72:75]
    ds_read_b64_tr_b16 v[244:245], v5 offset:49184
    v_mfma_f32_16x16x32_bf16 v[76:79], v[232:235], v[100:103], v[76:79]
    s_add_u32 s22, s19, 0x480000
    s_add_u32 m0, s20, 0x4000
    s_nop 0
    buffer_load_dwordx4 v3, s[4:7], s22 offen lds
    ds_read_b64_tr_b16 v[246:247], v5 offset:50208
    s_waitcnt lgkmcnt(4)
    v_mfma_f32_16x16x32_bf16 v[80:83], v[236:239], v[96:99], v[80:83]
    ds_read_b64_tr_b16 v[224:225], v4 offset:49408
    v_mfma_f32_16x16x32_bf16 v[84:87], v[236:239], v[100:103], v[84:87]
    ds_read_b64_tr_b16 v[226:227], v4 offset:50432
    s_waitcnt lgkmcnt(4)
    v_mfma_f32_16x16x32_bf16 v[24:27], v[240:243], v[104:107], v[24:27]
    ds_read_b64_tr_b16 v[228:229], v5 offset:49440
    s_waitcnt vmcnt(10)
    v_mfma_f32_16x16x32_bf16 v[28:31], v[240:243], v[108:111], v[28:31]
    ds_read_b64_tr_b16 v[230:231], v5 offset:50464
    s_waitcnt lgkmcnt(4)
    v_mfma_f32_16x16x32_bf16 v[32:35], v[244:247], v[104:107], v[32:35]
    ds_read_b64_tr_b16 v[232:233], v4 offset:49664
    v_mfma_f32_16x16x32_bf16 v[36:39], v[244:247], v[108:111], v[36:39]
    ds_read_b64_tr_b16 v[234:235], v4 offset:50688
    s_mov_b32 s23, 0x4800
    buffer_load_dwordx4 v[88:91], v7, s[8:11], s23 offen offset:0 sc1
    s_waitcnt lgkmcnt(4)
    v_mfma_f32_16x16x32_bf16 v[40:43], v[224:227], v[104:107], v[40:43]
    ds_read_b64_tr_b16 v[236:237], v5 offset:49696
    v_mfma_f32_16x16x32_bf16 v[44:47], v[224:227], v[108:111], v[44:47]
    s_add_u32 s22, s19, 0x488000
    s_add_u32 m0, s20, 0x4400
    s_nop 0
    buffer_load_dwordx4 v3, s[4:7], s22 offen lds
    ds_read_b64_tr_b16 v[238:239], v5 offset:50720
    s_waitcnt lgkmcnt(4)
    v_mfma_f32_16x16x32_bf16 v[48:51], v[228:231], v[104:107], v[48:51]
    ds_read_b64_tr_b16 v[240:241], v4 offset:49920
    v_mfma_f32_16x16x32_bf16 v[52:55], v[228:231], v[108:111], v[52:55]
    ds_read_b64_tr_b16 v[242:243], v4 offset:50944
    s_waitcnt lgkmcnt(4)
    v_mfma_f32_16x16x32_bf16 v[56:59], v[232:235], v[104:107], v[56:59]
    ds_read_b64_tr_b16 v[244:245], v5 offset:49952
    v_mfma_f32_16x16x32_bf16 v[60:63], v[232:235], v[108:111], v[60:63]
    ds_read_b64_tr_b16 v[246:247], v5 offset:50976
    s_waitcnt lgkmcnt(4)
    v_mfma_f32_16x16x32_bf16 v[64:67], v[236:239], v[104:107], v[64:67]
    ds_read_b64_tr_b16 v[224:225], v4 offset:57344
    v_mfma_f32_16x16x32_bf16 v[68:71], v[236:239], v[108:111], v[68:71]
    ds_read_b64_tr_b16 v[226:227], v4 offset:58368
    s_mov_b32 s23, 0xc800
    buffer_load_dwordx4 v[92:95], v7, s[8:11], s23 offen offset:0 sc1
    s_waitcnt lgkmcnt(4)
    v_mfma_f32_16x16x32_bf16 v[72:75], v[240:243], v[104:107], v[72:75]
    ds_read_b64_tr_b16 v[228:229], v5 offset:57376
    v_mfma_f32_16x16x32_bf16 v[76:79], v[240:243], v[108:111], v[76:79]
    ds_read_b64_tr_b16 v[230:231], v5 offset:58400
    s_waitcnt lgkmcnt(4)
    v_mfma_f32_16x16x32_bf16 v[80:83], v[244:247], v[104:107], v[80:83]
    ds_read_b64_tr_b16 v[232:233], v4 offset:57600
    v_mfma_f32_16x16x32_bf16 v[84:87], v[244:247], v[108:111], v[84:87]
    ds_read_b64_tr_b16 v[234:235], v4 offset:58624
    s_waitcnt vmcnt(12) lgkmcnt(4)
    v_mfma_f32_16x16x32_bf16 v[24:27], v[224:227], v[112:115], v[24:27]
    ds_read_b64_tr_b16 v[236:237], v5 offset:57632
    s_waitcnt vmcnt(11)
    v_mfma_f32_16x16x32_bf16 v[28:31], v[224:227], v[116:119], v[28:31]
    ds_read_b64_tr_b16 v[238:239], v5 offset:58656
    s_waitcnt lgkmcnt(4)
    v_mfma_f32_16x16x32_bf16 v[32:35], v[228:231], v[112:115], v[32:35]
    ds_read_b64_tr_b16 v[240:241], v4 offset:57856
    v_mfma_f32_16x16x32_bf16 v[36:39], v[228:231], v[116:119], v[36:39]
    ds_read_b64_tr_b16 v[242:243], v4 offset:58880
    s_mov_b32 s23, 0x4800
    buffer_load_dwordx4 v[96:99], v7, s[8:11], s23 offen offset:1024 sc1
    s_waitcnt lgkmcnt(4)
    v_mfma_f32_16x16x32_bf16 v[40:43], v[232:235], v[112:115], v[40:43]
    ds_read_b64_tr_b16 v[244:245], v5 offset:57888
    v_mfma_f32_16x16x32_bf16 v[44:47], v[232:235], v[116:119], v[44:47]
    ds_read_b64_tr_b16 v[246:247], v5 offset:58912
    s_waitcnt lgkmcnt(4)
    v_mfma_f32_16x16x32_bf16 v[48:51], v[236:239], v[112:115], v[48:51]
    ds_read_b64_tr_b16 v[224:225], v4 offset:58112
    v_mfma_f32_16x16x32_bf16 v[52:55], v[236:239], v[116:119], v[52:55]
    ds_read_b64_tr_b16 v[226:227], v4 offset:59136
    s_waitcnt lgkmcnt(4)
    v_mfma_f32_16x16x32_bf16 v[56:59], v[240:243], v[112:115], v[56:59]
    ds_read_b64_tr_b16 v[228:229], v5 offset:58144
    v_mfma_f32_16x16x32_bf16 v[60:63], v[240:243], v[116:119], v[60:63]
    ds_read_b64_tr_b16 v[230:231], v5 offset:59168
    s_waitcnt lgkmcnt(4)
    v_mfma_f32_16x16x32_bf16 v[64:67], v[244:247], v[112:115], v[64:67]
    v_mfma_f32_16x16x32_bf16 v[68:71], v[244:247], v[116:119], v[68:71]
    s_waitcnt vmcnt(9)
    s_barrier
    ds_read_b64_tr_b16 v[232:233], v4 offset:0
    ds_read_b64_tr_b16 v[234:235], v4 offset:1024
    s_mov_b32 s23, 0xc800
    buffer_load_dwordx4 v[100:103], v7, s[8:11], s23 offen offset:1024 sc1
    s_waitcnt lgkmcnt(4)
    v_mfma_f32_16x16x32_bf16 v[72:75], v[224:227], v[112:115], v[72:75]
    ds_read_b64_tr_b16 v[236:237], v5 offset:32
    v_mfma_f32_16x16x32_bf16 v[76:79], v[224:227], v[116:119], v[76:79]
    s_add_u32 s22, s19, 0x500000
    s_add_u32 m0, s20, 0x8000
    s_nop 0
    buffer_load_dwordx4 v3, s[4:7], s22 offen lds
    ds_read_b64_tr_b16 v[238:239], v5 offset:1056
    s_waitcnt lgkmcnt(4)
    v_mfma_f32_16x16x32_bf16 v[80:83], v[228:231], v[112:115], v[80:83]
    ds_read_b64_tr_b16 v[240:241], v4 offset:256
    v_mfma_f32_16x16x32_bf16 v[84:87], v[228:231], v[116:119], v[84:87]
    ds_read_b64_tr_b16 v[242:243], v4 offset:1280
    s_waitcnt lgkmcnt(4)
    v_mfma_f32_16x16x32_bf16 v[24:27], v[232:235], v[120:123], v[24:27]
    ds_read_b64_tr_b16 v[244:245], v5 offset:288
    s_waitcnt vmcnt(10)
    v_mfma_f32_16x16x32_bf16 v[28:31], v[232:235], v[124:127], v[28:31]
    ds_read_b64_tr_b16 v[246:247], v5 offset:1312
    s_waitcnt lgkmcnt(4)
    v_mfma_f32_16x16x32_bf16 v[32:35], v[236:239], v[120:123], v[32:35]
    ds_read_b64_tr_b16 v[224:225], v4 offset:512
    v_mfma_f32_16x16x32_bf16 v[36:39], v[236:239], v[124:127], v[36:39]
    ds_read_b64_tr_b16 v[226:227], v4 offset:1536
    s_mov_b32 s23, 0x5000
    buffer_load_dwordx4 v[104:107], v7, s[8:11], s23 offen offset:0 sc1
    s_waitcnt lgkmcnt(4)
    v_mfma_f32_16x16x32_bf16 v[40:43], v[240:243], v[120:123], v[40:43]
    ds_read_b64_tr_b16 v[228:229], v5 offset:544
    v_mfma_f32_16x16x32_bf16 v[44:47], v[240:243], v[124:127], v[44:47]
    s_add_u32 s22, s19, 0x508000
    s_add_u32 m0, s20, 0x8400
    s_nop 0
    buffer_load_dwordx4 v3, s[4:7], s22 offen lds
    ds_read_b64_tr_b16 v[230:231], v5 offset:1568
    s_waitcnt lgkmcnt(4)
    v_mfma_f32_16x16x32_bf16 v[48:51], v[244:247], v[120:123], v[48:51]
    ds_read_b64_tr_b16 v[232:233], v4 offset:768
    v_mfma_f32_16x16x32_bf16 v[52:55], v[244:247], v[124:127], v[52:55]
    ds_read_b64_tr_b16 v[234:235], v4 offset:1792
    s_waitcnt lgkmcnt(4)
    v_mfma_f32_16x16x32_bf16 v[56:59], v[224:227], v[120:123], v[56:59]
    ds_read_b64_tr_b16 v[236:237], v5 offset:800
    v_mfma_f32_16x16x32_bf16 v[60:63], v[224:227], v[124:127], v[60:63]
    ds_read_b64_tr_b16 v[238:239], v5 offset:1824
    s_waitcnt lgkmcnt(4)
    v_mfma_f32_16x16x32_bf16 v[64:67], v[228:231], v[120:123], v[64:67]
    ds_read_b64_tr_b16 v[240:241], v4 offset:8192
    v_mfma_f32_16x16x32_bf16 v[68:71], v[228:231], v[124:127], v[68:71]
    ds_read_b64_tr_b16 v[242:243], v4 offset:9216
    s_mov_b32 s23, 0xd000
    buffer_load_dwordx4 v[108:111], v7, s[8:11], s23 offen offset:0 sc1
    s_waitcnt lgkmcnt(4)
    v_mfma_f32_16x16x32_bf16 v[72:75], v[232:235], v[120:123], v[72:75]
    ds_read_b64_tr_b16 v[244:245], v5 offset:8224
    v_mfma_f32_16x16x32_bf16 v[76:79], v[232:235], v[124:127], v[76:79]
    ds_read_b64_tr_b16 v[246:247], v5 offset:9248
    s_waitcnt lgkmcnt(4)
    v_mfma_f32_16x16x32_bf16 v[80:83], v[236:239], v[120:123], v[80:83]
    ds_read_b64_tr_b16 v[224:225], v4 offset:8448
    v_mfma_f32_16x16x32_bf16 v[84:87], v[236:239], v[124:127], v[84:87]
    ds_read_b64_tr_b16 v[226:227], v4 offset:9472
    s_waitcnt vmcnt(11) lgkmcnt(4)
    v_mfma_f32_16x16x32_bf16 v[24:27], v[240:243], v[128:131], v[24:27]
    ds_read_b64_tr_b16 v[228:229], v5 offset:8480
    s_waitcnt vmcnt(10)
    v_mfma_f32_16x16x32_bf16 v[28:31], v[240:243], v[132:135], v[28:31]
    ds_read_b64_tr_b16 v[230:231], v5 offset:9504
    s_waitcnt lgkmcnt(4)
    v_mfma_f32_16x16x32_bf16 v[32:35], v[244:247], v[128:131], v[32:35]
    ds_read_b64_tr_b16 v[232:233], v4 offset:8704
    v_mfma_f32_16x16x32_bf16 v[36:39], v[244:247], v[132:135], v[36:39]
    ds_read_b64_tr_b16 v[234:235], v4 offset:9728
    s_mov_b32 s23, 0x5000
    buffer_load_dwordx4 v[112:115], v7, s[8:11], s23 offen offset:1024 sc1
    s_waitcnt lgkmcnt(4)
    v_mfma_f32_16x16x32_bf16 v[40:43], v[224:227], v[128:131], v[40:43]
    ds_read_b64_tr_b16 v[236:237], v5 offset:8736
    v_mfma_f32_16x16x32_bf16 v[44:47], v[224:227], v[132:135], v[44:47]
    ds_read_b64_tr_b16 v[238:239], v5 offset:9760
    s_waitcnt lgkmcnt(4)
    v_mfma_f32_16x16x32_bf16 v[48:51], v[228:231], v[128:131], v[48:51]
    ds_read_b64_tr_b16 v[240:241], v4 offset:8960
    v_mfma_f32_16x16x32_bf16 v[52:55], v[228:231], v[132:135], v[52:55]
    ds_read_b64_tr_b16 v[242:243], v4 offset:9984
    s_waitcnt lgkmcnt(4)
    v_mfma_f32_16x16x32_bf16 v[56:59], v[232:235], v[128:131], v[56:59]
    ds_read_b64_tr_b16 v[244:245], v5 offset:8992
    v_mfma_f32_16x16x32_bf16 v[60:63], v[232:235], v[132:135], v[60:63]
    ds_read_b64_tr_b16 v[246:247], v5 offset:10016
    s_waitcnt lgkmcnt(4)
    v_mfma_f32_16x16x32_bf16 v[64:67], v[236:239], v[128:131], v[64:67]
    v_mfma_f32_16x16x32_bf16 v[68:71], v[236:239], v[132:135], v[68:71]
    s_waitcnt vmcnt(8)
    s_barrier
    ds_read_b64_tr_b16 v[224:225], v4 offset:16384
    ds_read_b64_tr_b16 v[226:227], v4 offset:17408
    s_mov_b32 s23, 0xd000
    buffer_load_dwordx4 v[116:119], v7, s[8:11], s23 offen offset:1024 sc1
    s_waitcnt lgkmcnt(4)
    v_mfma_f32_16x16x32_bf16 v[72:75], v[240:243], v[128:131], v[72:75]
    ds_read_b64_tr_b16 v[228:229], v5 offset:16416
    v_mfma_f32_16x16x32_bf16 v[76:79], v[240:243], v[132:135], v[76:79]
    s_add_u32 s22, s19, 0x580000
    s_add_u32 m0, s20, 0xc000
    s_nop 0
    buffer_load_dwordx4 v3, s[4:7], s22 offen lds
    ds_read_b64_tr_b16 v[230:231], v5 offset:17440
    s_waitcnt lgkmcnt(4)
    v_mfma_f32_16x16x32_bf16 v[80:83], v[244:247], v[128:131], v[80:83]
    ds_read_b64_tr_b16 v[232:233], v4 offset:16640
    v_mfma_f32_16x16x32_bf16 v[84:87], v[244:247], v[132:135], v[84:87]
    ds_read_b64_tr_b16 v[234:235], v4 offset:17664
    s_waitcnt lgkmcnt(4)
    v_mfma_f32_16x16x32_bf16 v[24:27], v[224:227], v[88:91], v[24:27]
    ds_read_b64_tr_b16 v[236:237], v5 offset:16672
    s_waitcnt vmcnt(9)
    v_mfma_f32_16x16x32_bf16 v[28:31], v[224:227], v[92:95], v[28:31]
    ds_read_b64_tr_b16 v[238:239], v5 offset:17696
    s_waitcnt lgkmcnt(4)
    v_mfma_f32_16x16x32_bf16 v[32:35], v[228:231], v[88:91], v[32:35]
    ds_read_b64_tr_b16 v[240:241], v4 offset:16896
    v_mfma_f32_16x16x32_bf16 v[36:39], v[228:231], v[92:95], v[36:39]
    ds_read_b64_tr_b16 v[242:243], v4 offset:17920
    s_mov_b32 s23, 0x5800
    buffer_load_dwordx4 v[120:123], v7, s[8:11], s23 offen offset:0 sc1
    s_waitcnt lgkmcnt(4)
    v_mfma_f32_16x16x32_bf16 v[40:43], v[232:235], v[88:91], v[40:43]
    ds_read_b64_tr_b16 v[244:245], v5 offset:16928
    v_mfma_f32_16x16x32_bf16 v[44:47], v[232:235], v[92:95], v[44:47]
    s_add_u32 s22, s19, 0x588000
    s_add_u32 m0, s20, 0xc400
    s_nop 0
    buffer_load_dwordx4 v3, s[4:7], s22 offen lds
    ds_read_b64_tr_b16 v[246:247], v5 offset:17952
    s_waitcnt lgkmcnt(4)
    v_mfma_f32_16x16x32_bf16 v[48:51], v[236:239], v[88:91], v[48:51]
    ds_read_b64_tr_b16 v[224:225], v4 offset:17152
    v_mfma_f32_16x16x32_bf16 v[52:55], v[236:239], v[92:95], v[52:55]
    ds_read_b64_tr_b16 v[226:227], v4 offset:18176
    s_waitcnt lgkmcnt(4)
    v_mfma_f32_16x16x32_bf16 v[56:59], v[240:243], v[88:91], v[56:59]
    ds_read_b64_tr_b16 v[228:229], v5 offset:17184
    v_mfma_f32_16x16x32_bf16 v[60:63], v[240:243], v[92:95], v[60:63]
    ds_read_b64_tr_b16 v[230:231], v5 offset:18208
    s_waitcnt lgkmcnt(4)
    v_mfma_f32_16x16x32_bf16 v[64:67], v[244:247], v[88:91], v[64:67]
    ds_read_b64_tr_b16 v[232:233], v4 offset:24576
    v_mfma_f32_16x16x32_bf16 v[68:71], v[244:247], v[92:95], v[68:71]
    ds_read_b64_tr_b16 v[234:235], v4 offset:25600
    s_mov_b32 s23, 0xd800
    buffer_load_dwordx4 v[124:127], v7, s[8:11], s23 offen offset:0 sc1
    s_waitcnt lgkmcnt(4)
    v_mfma_f32_16x16x32_bf16 v[72:75], v[224:227], v[88:91], v[72:75]
    ds_read_b64_tr_b16 v[236:237], v5 offset:24608
    v_xor_b32 v8, s28, v12
    v_xor_b32 v20, s28, v13
    v_or_b32 v8, v8, v20
    v_xor_b32 v20, s28, v14
    v_or_b32 v8, v8, v20
    v_xor_b32 v20, s28, v15
    v_or_b32 v8, v8, v20
    v_cmp_ne_u32 vcc, 0, v8
    s_cbranch_vccnz adaLN_cond__sliding_block_cached__moe_arch_mod__prompt_kernel_kv16r
adaLN_cond__sliding_block_cached__moe_arch_mod__prompt_kernel_kv16b:
    v_mfma_f32_16x16x32_bf16 v[76:79], v[224:227], v[92:95], v[76:79]
    ds_read_b64_tr_b16 v[238:239], v5 offset:25632
    v_mov_b32 v20, 0
    s_mov_b32 s16, 0x564000
    buffer_load_dword v8, v20, s[8:11], s16 offen sc1
    s_waitcnt lgkmcnt(4)
    v_mfma_f32_16x16x32_bf16 v[80:83], v[228:231], v[88:91], v[80:83]
    ds_read_b64_tr_b16 v[240:241], v4 offset:24832
    v_mfma_f32_16x16x32_bf16 v[84:87], v[228:231], v[92:95], v[84:87]
    ds_read_b64_tr_b16 v[242:243], v4 offset:25856
    s_waitcnt vmcnt(12) lgkmcnt(4)
    v_mfma_f32_16x16x32_bf16 v[24:27], v[232:235], v[96:99], v[24:27]
    ds_read_b64_tr_b16 v[244:245], v5 offset:24864
    s_waitcnt vmcnt(11)
    v_mfma_f32_16x16x32_bf16 v[28:31], v[232:235], v[100:103], v[28:31]
    ds_read_b64_tr_b16 v[246:247], v5 offset:25888
    s_waitcnt lgkmcnt(4)
    v_mfma_f32_16x16x32_bf16 v[32:35], v[236:239], v[96:99], v[32:35]
    ds_read_b64_tr_b16 v[224:225], v4 offset:25088
    v_mfma_f32_16x16x32_bf16 v[36:39], v[236:239], v[100:103], v[36:39]
    ds_read_b64_tr_b16 v[226:227], v4 offset:26112
    s_mov_b32 s23, 0x5800
    buffer_load_dwordx4 v[128:131], v7, s[8:11], s23 offen offset:1024 sc1
    s_waitcnt lgkmcnt(4)
    v_mfma_f32_16x16x32_bf16 v[40:43], v[240:243], v[96:99], v[40:43]
    ds_read_b64_tr_b16 v[228:229], v5 offset:25120
    s_mov_b64 s[76:77], s[54:55]
    s_mov_b32 s78, 0xc00000
    s_mov_b32 s79, 0x20000
    v_bfe_u32 v20, v1, 2, 2
    v_lshlrev_b32 v20, 12, v20
    v_add_u32 v6, v3, v20
    s_lshr_b32 s16, s2, 5
    s_lshl_b32 s16, s16, 7
    s_lshl_b32 s17, s3, 3
    s_add_u32 s16, s16, s17
    s_mul_i32 s14, s16, 12288
    s_and_b32 s16, s2, 31
    s_lshl_b32 s16, s16, 8
    s_add_u32 s14, s14, s16
    s_add_u32 s14, s14, 4096
    v_mfma_f32_16x16x32_bf16 v[44:47], v[240:243], v[100:103], v[44:47]
    ds_read_b64_tr_b16 v[230:231], v5 offset:26144
    s_waitcnt lgkmcnt(4)
    v_mfma_f32_16x16x32_bf16 v[48:51], v[244:247], v[96:99], v[48:51]
    ds_read_b64_tr_b16 v[232:233], v4 offset:25344
    v_mfma_f32_16x16x32_bf16 v[52:55], v[244:247], v[100:103], v[52:55]
    ds_read_b64_tr_b16 v[234:235], v4 offset:26368
    s_waitcnt lgkmcnt(4)
    v_mfma_f32_16x16x32_bf16 v[56:59], v[224:227], v[96:99], v[56:59]
    ds_read_b64_tr_b16 v[236:237], v5 offset:25376
    v_mfma_f32_16x16x32_bf16 v[60:63], v[224:227], v[100:103], v[60:63]
    ds_read_b64_tr_b16 v[238:239], v5 offset:26400
    s_waitcnt lgkmcnt(4)
    v_mfma_f32_16x16x32_bf16 v[64:67], v[228:231], v[96:99], v[64:67]
    v_mfma_f32_16x16x32_bf16 v[68:71], v[228:231], v[100:103], v[68:71]
    s_waitcnt vmcnt(9)
    s_barrier
    ds_read_b64_tr_b16 v[240:241], v4 offset:32768
    ds_read_b64_tr_b16 v[242:243], v4 offset:33792
    s_mov_b32 s23, 0xd800
    buffer_load_dwordx4 v[132:135], v7, s[8:11], s23 offen offset:1024 sc1
    s_waitcnt lgkmcnt(4)
    v_mfma_f32_16x16x32_bf16 v[72:75], v[232:235], v[96:99], v[72:75]
    ds_read_b64_tr_b16 v[244:245], v5 offset:32800
    v_mfma_f32_16x16x32_bf16 v[76:79], v[232:235], v[100:103], v[76:79]
    s_add_u32 s22, s19, 0x600000
    s_add_u32 m0, s20, 0x0
    s_nop 0
    buffer_load_dwordx4 v3, s[4:7], s22 offen lds
    ds_read_b64_tr_b16 v[246:247], v5 offset:33824
    s_waitcnt lgkmcnt(4)
    v_mfma_f32_16x16x32_bf16 v[80:83], v[236:239], v[96:99], v[80:83]
    ds_read_b64_tr_b16 v[224:225], v4 offset:33024
    v_mfma_f32_16x16x32_bf16 v[84:87], v[236:239], v[100:103], v[84:87]
    ds_read_b64_tr_b16 v[226:227], v4 offset:34048
    s_waitcnt lgkmcnt(4)
    v_mfma_f32_16x16x32_bf16 v[24:27], v[240:243], v[104:107], v[24:27]
    ds_read_b64_tr_b16 v[228:229], v5 offset:33056
    s_waitcnt vmcnt(10)
    v_mfma_f32_16x16x32_bf16 v[28:31], v[240:243], v[108:111], v[28:31]
    ds_read_b64_tr_b16 v[230:231], v5 offset:34080
    s_waitcnt lgkmcnt(4)
    v_mfma_f32_16x16x32_bf16 v[32:35], v[244:247], v[104:107], v[32:35]
    ds_read_b64_tr_b16 v[232:233], v4 offset:33280
    v_mfma_f32_16x16x32_bf16 v[36:39], v[244:247], v[108:111], v[36:39]
    ds_read_b64_tr_b16 v[234:235], v4 offset:34304
    s_mov_b32 s23, 0x6000
    buffer_load_dwordx4 v[88:91], v7, s[8:11], s23 offen offset:0 sc1
    s_waitcnt lgkmcnt(4)
    v_mfma_f32_16x16x32_bf16 v[40:43], v[224:227], v[104:107], v[40:43]
    ds_read_b64_tr_b16 v[236:237], v5 offset:33312
    v_mfma_f32_16x16x32_bf16 v[44:47], v[224:227], v[108:111], v[44:47]
    s_add_u32 s22, s19, 0x608000
    s_add_u32 m0, s20, 0x400
    s_nop 0
    buffer_load_dwordx4 v3, s[4:7], s22 offen lds
    ds_read_b64_tr_b16 v[238:239], v5 offset:34336
    s_waitcnt lgkmcnt(4)
    v_mfma_f32_16x16x32_bf16 v[48:51], v[228:231], v[104:107], v[48:51]
    ds_read_b64_tr_b16 v[240:241], v4 offset:33536
    v_mfma_f32_16x16x32_bf16 v[52:55], v[228:231], v[108:111], v[52:55]
    ds_read_b64_tr_b16 v[242:243], v4 offset:34560
    s_waitcnt lgkmcnt(4)
    v_mfma_f32_16x16x32_bf16 v[56:59], v[232:235], v[104:107], v[56:59]
    ds_read_b64_tr_b16 v[244:245], v5 offset:33568
    v_mfma_f32_16x16x32_bf16 v[60:63], v[232:235], v[108:111], v[60:63]
    ds_read_b64_tr_b16 v[246:247], v5 offset:34592
    s_waitcnt lgkmcnt(4)
    v_mfma_f32_16x16x32_bf16 v[64:67], v[236:239], v[104:107], v[64:67]
    ds_read_b64_tr_b16 v[224:225], v4 offset:40960
    v_mfma_f32_16x16x32_bf16 v[68:71], v[236:239], v[108:111], v[68:71]
    ds_read_b64_tr_b16 v[226:227], v4 offset:41984
    s_mov_b32 s23, 0xe000
    buffer_load_dwordx4 v[92:95], v7, s[8:11], s23 offen offset:0 sc1
    s_waitcnt lgkmcnt(4)
    v_mfma_f32_16x16x32_bf16 v[72:75], v[240:243], v[104:107], v[72:75]
    ds_read_b64_tr_b16 v[228:229], v5 offset:40992
    v_mfma_f32_16x16x32_bf16 v[76:79], v[240:243], v[108:111], v[76:79]
    ds_read_b64_tr_b16 v[230:231], v5 offset:42016
    s_waitcnt lgkmcnt(4)
    v_mfma_f32_16x16x32_bf16 v[80:83], v[244:247], v[104:107], v[80:83]
    ds_read_b64_tr_b16 v[232:233], v4 offset:41216
    v_mfma_f32_16x16x32_bf16 v[84:87], v[244:247], v[108:111], v[84:87]
    ds_read_b64_tr_b16 v[234:235], v4 offset:42240
    s_waitcnt vmcnt(12) lgkmcnt(4)
    v_mfma_f32_16x16x32_bf16 v[24:27], v[224:227], v[112:115], v[24:27]
    ds_read_b64_tr_b16 v[236:237], v5 offset:41248
    s_add_u32 s22, s14, 0x0
    s_add_u32 m0, s20, 0x10000
    s_nop 0
    buffer_load_dwordx4 v6, s[76:79], s22 offen lds
    s_waitcnt vmcnt(12)
    v_mfma_f32_16x16x32_bf16 v[28:31], v[224:227], v[116:119], v[28:31]
    ds_read_b64_tr_b16 v[238:239], v5 offset:42272
    s_waitcnt lgkmcnt(4)
    v_mfma_f32_16x16x32_bf16 v[32:35], v[228:231], v[112:115], v[32:35]
    ds_read_b64_tr_b16 v[240:241], v4 offset:41472
    v_mfma_f32_16x16x32_bf16 v[36:39], v[228:231], v[116:119], v[36:39]
    ds_read_b64_tr_b16 v[242:243], v4 offset:42496
    s_mov_b32 s23, 0x6000
    buffer_load_dwordx4 v[96:99], v7, s[8:11], s23 offen offset:1024 sc1
    s_waitcnt lgkmcnt(4)
    v_mfma_f32_16x16x32_bf16 v[40:43], v[232:235], v[112:115], v[40:43]
    ds_read_b64_tr_b16 v[244:245], v5 offset:41504
    s_add_u32 s22, s14, 0xc000
    s_add_u32 m0, s20, 0x10400
    s_nop 0
    buffer_load_dwordx4 v6, s[76:79], s22 offen lds
    v_mfma_f32_16x16x32_bf16 v[44:47], v[232:235], v[116:119], v[44:47]
    ds_read_b64_tr_b16 v[246:247], v5 offset:42528
    s_waitcnt lgkmcnt(4)
    v_mfma_f32_16x16x32_bf16 v[48:51], v[236:239], v[112:115], v[48:51]
    ds_read_b64_tr_b16 v[224:225], v4 offset:41728
    v_mfma_f32_16x16x32_bf16 v[52:55], v[236:239], v[116:119], v[52:55]
    ds_read_b64_tr_b16 v[226:227], v4 offset:42752
    s_waitcnt lgkmcnt(4)
    v_mfma_f32_16x16x32_bf16 v[56:59], v[240:243], v[112:115], v[56:59]
    ds_read_b64_tr_b16 v[228:229], v5 offset:41760
    v_mfma_f32_16x16x32_bf16 v[60:63], v[240:243], v[116:119], v[60:63]
    ds_read_b64_tr_b16 v[230:231], v5 offset:42784
    s_waitcnt lgkmcnt(4)
    v_mfma_f32_16x16x32_bf16 v[64:67], v[244:247], v[112:115], v[64:67]
    v_mfma_f32_16x16x32_bf16 v[68:71], v[244:247], v[116:119], v[68:71]
    s_waitcnt vmcnt(11)
    s_barrier
    ds_read_b64_tr_b16 v[232:233], v4 offset:49152
    ds_read_b64_tr_b16 v[234:235], v4 offset:50176
    s_mov_b32 s23, 0xe000
    buffer_load_dwordx4 v[100:103], v7, s[8:11], s23 offen offset:1024 sc1
    s_waitcnt lgkmcnt(4)
    v_mfma_f32_16x16x32_bf16 v[72:75], v[224:227], v[112:115], v[72:75]
    ds_read_b64_tr_b16 v[236:237], v5 offset:49184
    v_mfma_f32_16x16x32_bf16 v[76:79], v[224:227], v[116:119], v[76:79]
    s_add_u32 s22, s19, 0x680000
    s_add_u32 m0, s20, 0x4000
    s_nop 0
    buffer_load_dwordx4 v3, s[4:7], s22 offen lds
    ds_read_b64_tr_b16 v[238:239], v5 offset:50208
    s_waitcnt lgkmcnt(4)
    v_mfma_f32_16x16x32_bf16 v[80:83], v[228:231], v[112:115], v[80:83]
    ds_read_b64_tr_b16 v[240:241], v4 offset:49408
    v_mfma_f32_16x16x32_bf16 v[84:87], v[228:231], v[116:119], v[84:87]
    ds_read_b64_tr_b16 v[242:243], v4 offset:50432
    s_waitcnt lgkmcnt(4)
    v_mfma_f32_16x16x32_bf16 v[24:27], v[232:235], v[120:123], v[24:27]
    ds_read_b64_tr_b16 v[244:245], v5 offset:49440
    s_waitcnt vmcnt(12)
    v_mfma_f32_16x16x32_bf16 v[28:31], v[232:235], v[124:127], v[28:31]
    ds_read_b64_tr_b16 v[246:247], v5 offset:50464
    s_waitcnt lgkmcnt(4)
    v_mfma_f32_16x16x32_bf16 v[32:35], v[236:239], v[120:123], v[32:35]
    ds_read_b64_tr_b16 v[224:225], v4 offset:49664
    v_mfma_f32_16x16x32_bf16 v[36:39], v[236:239], v[124:127], v[36:39]
    ds_read_b64_tr_b16 v[226:227], v4 offset:50688
    s_mov_b32 s23, 0x6800
    buffer_load_dwordx4 v[104:107], v7, s[8:11], s23 offen offset:0 sc1
    s_waitcnt lgkmcnt(4)
    v_mfma_f32_16x16x32_bf16 v[40:43], v[240:243], v[120:123], v[40:43]
    ds_read_b64_tr_b16 v[228:229], v5 offset:49696
    v_mfma_f32_16x16x32_bf16 v[44:47], v[240:243], v[124:127], v[44:47]
    s_add_u32 s22, s19, 0x688000
    s_add_u32 m0, s20, 0x4400
    s_nop 0
    buffer_load_dwordx4 v3, s[4:7], s22 offen lds
    ds_read_b64_tr_b16 v[230:231], v5 offset:50720
    s_waitcnt lgkmcnt(4)
    v_mfma_f32_16x16x32_bf16 v[48:51], v[244:247], v[120:123], v[48:51]
    ds_read_b64_tr_b16 v[232:233], v4 offset:49920
    v_mfma_f32_16x16x32_bf16 v[52:55], v[244:247], v[124:127], v[52:55]
    ds_read_b64_tr_b16 v[234:235], v4 offset:50944
    s_waitcnt lgkmcnt(4)
    v_mfma_f32_16x16x32_bf16 v[56:59], v[224:227], v[120:123], v[56:59]
    ds_read_b64_tr_b16 v[236:237], v5 offset:49952
    v_mfma_f32_16x16x32_bf16 v[60:63], v[224:227], v[124:127], v[60:63]
    ds_read_b64_tr_b16 v[238:239], v5 offset:50976
    s_waitcnt lgkmcnt(4)
    v_mfma_f32_16x16x32_bf16 v[64:67], v[228:231], v[120:123], v[64:67]
    ds_read_b64_tr_b16 v[240:241], v4 offset:57344
    v_mfma_f32_16x16x32_bf16 v[68:71], v[228:231], v[124:127], v[68:71]
    ds_read_b64_tr_b16 v[242:243], v4 offset:58368
    s_mov_b32 s23, 0xe800
    buffer_load_dwordx4 v[108:111], v7, s[8:11], s23 offen offset:0 sc1
    s_waitcnt lgkmcnt(4)
    v_mfma_f32_16x16x32_bf16 v[72:75], v[232:235], v[120:123], v[72:75]
    ds_read_b64_tr_b16 v[244:245], v5 offset:57376
    v_mfma_f32_16x16x32_bf16 v[76:79], v[232:235], v[124:127], v[76:79]
    ds_read_b64_tr_b16 v[246:247], v5 offset:58400
    s_waitcnt lgkmcnt(4)
    v_mfma_f32_16x16x32_bf16 v[80:83], v[236:239], v[120:123], v[80:83]
    ds_read_b64_tr_b16 v[224:225], v4 offset:57600
    v_mfma_f32_16x16x32_bf16 v[84:87], v[236:239], v[124:127], v[84:87]
    ds_read_b64_tr_b16 v[226:227], v4 offset:58624
    s_waitcnt vmcnt(13) lgkmcnt(4)
    v_mfma_f32_16x16x32_bf16 v[24:27], v[240:243], v[128:131], v[24:27]
    ds_read_b64_tr_b16 v[228:229], v5 offset:57632
    s_add_u32 s22, s14, 0xc0000
    s_add_u32 m0, s20, 0x14000
    s_nop 0
    buffer_load_dwordx4 v6, s[76:79], s22 offen lds
    s_waitcnt vmcnt(13)
    v_mfma_f32_16x16x32_bf16 v[28:31], v[240:243], v[132:135], v[28:31]
    ds_read_b64_tr_b16 v[230:231], v5 offset:58656
    s_waitcnt lgkmcnt(4)
    v_mfma_f32_16x16x32_bf16 v[32:35], v[244:247], v[128:131], v[32:35]
    ds_read_b64_tr_b16 v[232:233], v4 offset:57856
    v_mfma_f32_16x16x32_bf16 v[36:39], v[244:247], v[132:135], v[36:39]
    ds_read_b64_tr_b16 v[234:235], v4 offset:58880
    s_mov_b32 s23, 0x6800
    buffer_load_dwordx4 v[112:115], v7, s[8:11], s23 offen offset:1024 sc1
    s_waitcnt lgkmcnt(4)
    v_mfma_f32_16x16x32_bf16 v[40:43], v[224:227], v[128:131], v[40:43]
    ds_read_b64_tr_b16 v[236:237], v5 offset:57888
    s_add_u32 s22, s14, 0xcc000
    s_add_u32 m0, s20, 0x14400
    s_nop 0
    buffer_load_dwordx4 v6, s[76:79], s22 offen lds
    v_mfma_f32_16x16x32_bf16 v[44:47], v[224:227], v[132:135], v[44:47]
    ds_read_b64_tr_b16 v[238:239], v5 offset:58912
    s_waitcnt lgkmcnt(4)
    v_mfma_f32_16x16x32_bf16 v[48:51], v[228:231], v[128:131], v[48:51]
    ds_read_b64_tr_b16 v[240:241], v4 offset:58112
    v_mfma_f32_16x16x32_bf16 v[52:55], v[228:231], v[132:135], v[52:55]
    ds_read_b64_tr_b16 v[242:243], v4 offset:59136
    s_waitcnt lgkmcnt(4)
    v_mfma_f32_16x16x32_bf16 v[56:59], v[232:235], v[128:131], v[56:59]
    ds_read_b64_tr_b16 v[244:245], v5 offset:58144
    v_mfma_f32_16x16x32_bf16 v[60:63], v[232:235], v[132:135], v[60:63]
    ds_read_b64_tr_b16 v[246:247], v5 offset:59168
    s_waitcnt lgkmcnt(4)
    v_mfma_f32_16x16x32_bf16 v[64:67], v[236:239], v[128:131], v[64:67]
    v_mfma_f32_16x16x32_bf16 v[68:71], v[236:239], v[132:135], v[68:71]
    s_waitcnt vmcnt(12)
    s_barrier
    ds_read_b64_tr_b16 v[224:225], v4 offset:0
    ds_read_b64_tr_b16 v[226:227], v4 offset:1024
    s_mov_b32 s23, 0xe800
    buffer_load_dwordx4 v[116:119], v7, s[8:11], s23 offen offset:1024 sc1
    s_waitcnt lgkmcnt(4)
    v_mfma_f32_16x16x32_bf16 v[72:75], v[240:243], v[128:131], v[72:75]
    ds_read_b64_tr_b16 v[228:229], v5 offset:32
    v_mfma_f32_16x16x32_bf16 v[76:79], v[240:243], v[132:135], v[76:79]
    s_add_u32 s22, s19, 0x700000
    s_add_u32 m0, s20, 0x8000
    s_nop 0
    buffer_load_dwordx4 v3, s[4:7], s22 offen lds
    ds_read_b64_tr_b16 v[230:231], v5 offset:1056
    s_waitcnt lgkmcnt(4)
    v_mfma_f32_16x16x32_bf16 v[80:83], v[244:247], v[128:131], v[80:83]
    ds_read_b64_tr_b16 v[232:233], v4 offset:256
    v_mfma_f32_16x16x32_bf16 v[84:87], v[244:247], v[132:135], v[84:87]
    ds_read_b64_tr_b16 v[234:235], v4 offset:1280
    s_waitcnt lgkmcnt(4)
    v_mfma_f32_16x16x32_bf16 v[24:27], v[224:227], v[88:91], v[24:27]
    ds_read_b64_tr_b16 v[236:237], v5 offset:288
    s_waitcnt vmcnt(13)
    v_mfma_f32_16x16x32_bf16 v[28:31], v[224:227], v[92:95], v[28:31]
    ds_read_b64_tr_b16 v[238:239], v5 offset:1312
    s_waitcnt lgkmcnt(4)
    v_mfma_f32_16x16x32_bf16 v[32:35], v[228:231], v[88:91], v[32:35]
    ds_read_b64_tr_b16 v[240:241], v4 offset:512
    v_mfma_f32_16x16x32_bf16 v[36:39], v[228:231], v[92:95], v[36:39]
    ds_read_b64_tr_b16 v[242:243], v4 offset:1536
    s_mov_b32 s23, 0x7000
    buffer_load_dwordx4 v[120:123], v7, s[8:11], s23 offen offset:0 sc1
    s_waitcnt lgkmcnt(4)
    v_mfma_f32_16x16x32_bf16 v[40:43], v[232:235], v[88:91], v[40:43]
    ds_read_b64_tr_b16 v[244:245], v5 offset:544
    v_mfma_f32_16x16x32_bf16 v[44:47], v[232:235], v[92:95], v[44:47]
    s_add_u32 s22, s19, 0x708000
    s_add_u32 m0, s20, 0x8400
    s_nop 0
    buffer_load_dwordx4 v3, s[4:7], s22 offen lds
    ds_read_b64_tr_b16 v[246:247], v5 offset:1568
    s_waitcnt lgkmcnt(4)
    v_mfma_f32_16x16x32_bf16 v[48:51], v[236:239], v[88:91], v[48:51]
    ds_read_b64_tr_b16 v[224:225], v4 offset:768
    v_mfma_f32_16x16x32_bf16 v[52:55], v[236:239], v[92:95], v[52:55]
    ds_read_b64_tr_b16 v[226:227], v4 offset:1792
    s_waitcnt lgkmcnt(4)
    v_mfma_f32_16x16x32_bf16 v[56:59], v[240:243], v[88:91], v[56:59]
    ds_read_b64_tr_b16 v[228:229], v5 offset:800
    v_mfma_f32_16x16x32_bf16 v[60:63], v[240:243], v[92:95], v[60:63]
    ds_read_b64_tr_b16 v[230:231], v5 offset:1824
    s_waitcnt lgkmcnt(4)
    v_mfma_f32_16x16x32_bf16 v[64:67], v[244:247], v[88:91], v[64:67]
    ds_read_b64_tr_b16 v[232:233], v4 offset:8192
    v_mfma_f32_16x16x32_bf16 v[68:71], v[244:247], v[92:95], v[68:71]
    ds_read_b64_tr_b16 v[234:235], v4 offset:9216
    s_mov_b32 s23, 0xf000
    buffer_load_dwordx4 v[124:127], v7, s[8:11], s23 offen offset:0 sc1
    s_waitcnt lgkmcnt(4)
    v_mfma_f32_16x16x32_bf16 v[72:75], v[224:227], v[88:91], v[72:75]
    ds_read_b64_tr_b16 v[236:237], v5 offset:8224
    v_mfma_f32_16x16x32_bf16 v[76:79], v[224:227], v[92:95], v[76:79]
    ds_read_b64_tr_b16 v[238:239], v5 offset:9248
    s_waitcnt lgkmcnt(4)
    v_mfma_f32_16x16x32_bf16 v[80:83], v[228:231], v[88:91], v[80:83]
    ds_read_b64_tr_b16 v[240:241], v4 offset:8448
    v_mfma_f32_16x16x32_bf16 v[84:87], v[228:231], v[92:95], v[84:87]
    ds_read_b64_tr_b16 v[242:243], v4 offset:9472
    s_waitcnt vmcnt(14) lgkmcnt(4)
    v_mfma_f32_16x16x32_bf16 v[24:27], v[232:235], v[96:99], v[24:27]
    ds_read_b64_tr_b16 v[244:245], v5 offset:8480
    s_add_u32 s22, s21, 0x0
    s_add_u32 m0, s20, 0x18000
    s_nop 0
    buffer_load_dwordx4 v2, s[8:11], s22 offen sc1 lds
    s_waitcnt vmcnt(13)
    v_mfma_f32_16x16x32_bf16 v[28:31], v[232:235], v[100:103], v[28:31]
    ds_read_b64_tr_b16 v[246:247], v5 offset:9504
    s_waitcnt lgkmcnt(4)
    v_mfma_f32_16x16x32_bf16 v[32:35], v[236:239], v[96:99], v[32:35]
    ds_read_b64_tr_b16 v[224:225], v4 offset:8704
    v_mfma_f32_16x16x32_bf16 v[36:39], v[236:239], v[100:103], v[36:39]
    ds_read_b64_tr_b16 v[226:227], v4 offset:9728
    s_mov_b32 s23, 0x7000
    buffer_load_dwordx4 v[128:131], v7, s[8:11], s23 offen offset:1024 sc1
    s_waitcnt lgkmcnt(4)
    v_mfma_f32_16x16x32_bf16 v[40:43], v[240:243], v[96:99], v[40:43]
    ds_read_b64_tr_b16 v[228:229], v5 offset:8736
    s_add_u32 s22, s21, 0x400
    s_add_u32 m0, s20, 0x18400
    s_nop 0
    buffer_load_dwordx4 v2, s[8:11], s22 offen sc1 lds
    v_mfma_f32_16x16x32_bf16 v[44:47], v[240:243], v[100:103], v[44:47]
    ds_read_b64_tr_b16 v[230:231], v5 offset:9760
    s_waitcnt lgkmcnt(4)
    v_mfma_f32_16x16x32_bf16 v[48:51], v[244:247], v[96:99], v[48:51]
    ds_read_b64_tr_b16 v[232:233], v4 offset:8960
    v_mfma_f32_16x16x32_bf16 v[52:55], v[244:247], v[100:103], v[52:55]
    ds_read_b64_tr_b16 v[234:235], v4 offset:9984
    s_waitcnt lgkmcnt(4)
    v_mfma_f32_16x16x32_bf16 v[56:59], v[224:227], v[96:99], v[56:59]
    ds_read_b64_tr_b16 v[236:237], v5 offset:8992
    v_mfma_f32_16x16x32_bf16 v[60:63], v[224:227], v[100:103], v[60:63]
    ds_read_b64_tr_b16 v[238:239], v5 offset:10016
    s_waitcnt lgkmcnt(4)
    v_mfma_f32_16x16x32_bf16 v[64:67], v[228:231], v[96:99], v[64:67]
    v_mfma_f32_16x16x32_bf16 v[68:71], v[228:231], v[100:103], v[68:71]
    s_waitcnt vmcnt(12)
    s_barrier
    ds_read_b64_tr_b16 v[240:241], v4 offset:16384
    ds_read_b64_tr_b16 v[242:243], v4 offset:17408
    s_mov_b32 s23, 0xf000
    buffer_load_dwordx4 v[132:135], v7, s[8:11], s23 offen offset:1024 sc1
    s_waitcnt lgkmcnt(4)
    v_mfma_f32_16x16x32_bf16 v[72:75], v[232:235], v[96:99], v[72:75]
    ds_read_b64_tr_b16 v[244:245], v5 offset:16416
    v_mfma_f32_16x16x32_bf16 v[76:79], v[232:235], v[100:103], v[76:79]
    s_add_u32 s22, s19, 0x780000
    s_add_u32 m0, s20, 0xc000
    s_nop 0
    buffer_load_dwordx4 v3, s[4:7], s22 offen lds
    ds_read_b64_tr_b16 v[246:247], v5 offset:17440
    s_waitcnt lgkmcnt(4)
    v_mfma_f32_16x16x32_bf16 v[80:83], v[236:239], v[96:99], v[80:83]
    ds_read_b64_tr_b16 v[224:225], v4 offset:16640
    v_mfma_f32_16x16x32_bf16 v[84:87], v[236:239], v[100:103], v[84:87]
    ds_read_b64_tr_b16 v[226:227], v4 offset:17664
    s_waitcnt lgkmcnt(4)
    v_mfma_f32_16x16x32_bf16 v[24:27], v[240:243], v[104:107], v[24:27]
    ds_read_b64_tr_b16 v[228:229], v5 offset:16672
    s_waitcnt vmcnt(13)
    v_mfma_f32_16x16x32_bf16 v[28:31], v[240:243], v[108:111], v[28:31]
    ds_read_b64_tr_b16 v[230:231], v5 offset:17696
    s_waitcnt lgkmcnt(4)
    v_mfma_f32_16x16x32_bf16 v[32:35], v[244:247], v[104:107], v[32:35]
    ds_read_b64_tr_b16 v[232:233], v4 offset:16896
    v_mfma_f32_16x16x32_bf16 v[36:39], v[244:247], v[108:111], v[36:39]
    ds_read_b64_tr_b16 v[234:235], v4 offset:17920
    s_mov_b32 s23, 0x7800
    buffer_load_dwordx4 v[88:91], v7, s[8:11], s23 offen offset:0 sc1
    s_waitcnt lgkmcnt(4)
    v_mfma_f32_16x16x32_bf16 v[40:43], v[224:227], v[104:107], v[40:43]
    ds_read_b64_tr_b16 v[236:237], v5 offset:16928
    v_lshrrev_b32 v20, 4, v1
    v_lshlrev_b32 v21, 4, v20
    s_lshl_b32 s16, s2, 8
    s_add_u32 s16, s16, 0x550000
    buffer_load_dwordx4 v[136:139], v21, s[8:11], s16 offen offset:0 sc1
    buffer_load_dwordx4 v[140:143], v21, s[8:11], s16 offen offset:64 sc1
    buffer_load_dwordx4 v[144:147], v21, s[8:11], s16 offen offset:128 sc1
    buffer_load_dwordx4 v[148:151], v21, s[8:11], s16 offen offset:192 sc1
    v_lshlrev_b32 v11, 11, v20
    v_xor_b32 v20, s3, v20
    v_and_b32 v20, 1, v20
    v_lshl_add_u32 v11, v20, 5, v11
    v_bfe_u32 v20, v1, 2, 2
    v_lshl_add_u32 v11, v20, 6, v11
    v_and_b32 v20, 3, v1
    v_lshl_add_u32 v11, v20, 3, v11
    s_lshr_b32 s16, s3, 1
    s_lshl_b32 s16, s16, 8
    s_add_u32 s16, s16, 65536
    v_add_u32 v11, s16, v11
    v_mfma_f32_16x16x32_bf16 v[44:47], v[224:227], v[108:111], v[44:47]
    s_add_u32 s22, s19, 0x788000
    s_add_u32 m0, s20, 0xc400
    s_nop 0
    buffer_load_dwordx4 v3, s[4:7], s22 offen lds
    ds_read_b64_tr_b16 v[238:239], v5 offset:17952
    s_waitcnt lgkmcnt(4)
    v_mfma_f32_16x16x32_bf16 v[48:51], v[228:231], v[104:107], v[48:51]
    ds_read_b64_tr_b16 v[240:241], v4 offset:17152
    v_mfma_f32_16x16x32_bf16 v[52:55], v[228:231], v[108:111], v[52:55]
    ds_read_b64_tr_b16 v[242:243], v4 offset:18176
    s_waitcnt lgkmcnt(4)
    v_mfma_f32_16x16x32_bf16 v[56:59], v[232:235], v[104:107], v[56:59]
    ds_read_b64_tr_b16 v[244:245], v5 offset:17184
    v_mfma_f32_16x16x32_bf16 v[60:63], v[232:235], v[108:111], v[60:63]
    ds_read_b64_tr_b16 v[246:247], v5 offset:18208
    s_waitcnt lgkmcnt(4)
    v_mfma_f32_16x16x32_bf16 v[64:67], v[236:239], v[104:107], v[64:67]
    ds_read_b64_tr_b16 v[224:225], v4 offset:24576
    v_mfma_f32_16x16x32_bf16 v[68:71], v[236:239], v[108:111], v[68:71]
    ds_read_b64_tr_b16 v[226:227], v4 offset:25600
    s_mov_b32 s23, 0xf800
    buffer_load_dwordx4 v[92:95], v7, s[8:11], s23 offen offset:0 sc1
    s_waitcnt lgkmcnt(4)
    v_mfma_f32_16x16x32_bf16 v[72:75], v[240:243], v[104:107], v[72:75]
    ds_read_b64_tr_b16 v[228:229], v5 offset:24608
    v_mfma_f32_16x16x32_bf16 v[76:79], v[240:243], v[108:111], v[76:79]
    ds_read_b64_tr_b16 v[230:231], v5 offset:25632
    s_waitcnt lgkmcnt(4)
    v_mfma_f32_16x16x32_bf16 v[80:83], v[244:247], v[104:107], v[80:83]
    ds_read_b64_tr_b16 v[232:233], v4 offset:24832
    v_mfma_f32_16x16x32_bf16 v[84:87], v[244:247], v[108:111], v[84:87]
    ds_read_b64_tr_b16 v[234:235], v4 offset:25856
    s_waitcnt vmcnt(18) lgkmcnt(4)
    v_mfma_f32_16x16x32_bf16 v[24:27], v[224:227], v[112:115], v[24:27]
    ds_read_b64_tr_b16 v[236:237], v5 offset:24864
    s_add_u32 s22, s21, 0x4000
    s_add_u32 m0, s20, 0x1c000
    s_nop 0
    buffer_load_dwordx4 v2, s[8:11], s22 offen sc1 lds
    s_waitcnt vmcnt(17)
    v_mfma_f32_16x16x32_bf16 v[28:31], v[224:227], v[116:119], v[28:31]
    ds_read_b64_tr_b16 v[238:239], v5 offset:25888
    s_waitcnt lgkmcnt(4)
    v_mfma_f32_16x16x32_bf16 v[32:35], v[228:231], v[112:115], v[32:35]
    ds_read_b64_tr_b16 v[240:241], v4 offset:25088
    v_mfma_f32_16x16x32_bf16 v[36:39], v[228:231], v[116:119], v[36:39]
    ds_read_b64_tr_b16 v[242:243], v4 offset:26112
    s_mov_b32 s23, 0x7800
    buffer_load_dwordx4 v[96:99], v7, s[8:11], s23 offen offset:1024 sc1
    s_waitcnt lgkmcnt(4)
    v_mfma_f32_16x16x32_bf16 v[40:43], v[232:235], v[112:115], v[40:43]
    ds_read_b64_tr_b16 v[244:245], v5 offset:25120
    s_add_u32 s22, s21, 0x4400
    s_add_u32 m0, s20, 0x1c400
    s_nop 0
    buffer_load_dwordx4 v2, s[8:11], s22 offen sc1 lds
    v_mfma_f32_16x16x32_bf16 v[44:47], v[232:235], v[116:119], v[44:47]
    ds_read_b64_tr_b16 v[246:247], v5 offset:26144
    s_waitcnt lgkmcnt(4)
    v_mfma_f32_16x16x32_bf16 v[48:51], v[236:239], v[112:115], v[48:51]
    ds_read_b64_tr_b16 v[224:225], v4 offset:25344
    v_mfma_f32_16x16x32_bf16 v[52:55], v[236:239], v[116:119], v[52:55]
    ds_read_b64_tr_b16 v[226:227], v4 offset:26368
    s_waitcnt lgkmcnt(4)
    v_mfma_f32_16x16x32_bf16 v[56:59], v[240:243], v[112:115], v[56:59]
    ds_read_b64_tr_b16 v[228:229], v5 offset:25376
    v_mfma_f32_16x16x32_bf16 v[60:63], v[240:243], v[116:119], v[60:63]
    ds_read_b64_tr_b16 v[230:231], v5 offset:26400
    s_waitcnt lgkmcnt(4)
    v_mfma_f32_16x16x32_bf16 v[64:67], v[244:247], v[112:115], v[64:67]
    v_mfma_f32_16x16x32_bf16 v[68:71], v[244:247], v[116:119], v[68:71]
    s_waitcnt vmcnt(16)
    s_barrier
    ds_read_b64_tr_b16 v[232:233], v4 offset:32768
    ds_read_b64_tr_b16 v[234:235], v4 offset:33792
    s_mov_b32 s23, 0xf800
    buffer_load_dwordx4 v[100:103], v7, s[8:11], s23 offen offset:1024 sc1
    s_waitcnt lgkmcnt(4)
    v_mfma_f32_16x16x32_bf16 v[72:75], v[224:227], v[112:115], v[72:75]
    ds_read_b64_tr_b16 v[236:237], v5 offset:32800
    v_mfma_f32_16x16x32_bf16 v[76:79], v[224:227], v[116:119], v[76:79]
    ds_read_b64_tr_b16 v[238:239], v5 offset:33824
    s_waitcnt lgkmcnt(4)
    v_mfma_f32_16x16x32_bf16 v[80:83], v[228:231], v[112:115], v[80:83]
    ds_read_b64_tr_b16 v[240:241], v4 offset:33024
    v_mfma_f32_16x16x32_bf16 v[84:87], v[228:231], v[116:119], v[84:87]
    ds_read_b64_tr_b16 v[242:243], v4 offset:34048
    s_waitcnt lgkmcnt(4)
    v_mfma_f32_16x16x32_bf16 v[24:27], v[232:235], v[120:123], v[24:27]
    ds_read_b64_tr_b16 v[244:245], v5 offset:33056
    s_waitcnt vmcnt(16)
    v_mfma_f32_16x16x32_bf16 v[28:31], v[232:235], v[124:127], v[28:31]
    ds_read_b64_tr_b16 v[246:247], v5 offset:34080
    s_waitcnt lgkmcnt(4)
    v_mfma_f32_16x16x32_bf16 v[32:35], v[236:239], v[120:123], v[32:35]
    ds_read_b64_tr_b16 v[224:225], v4 offset:33280
    v_mfma_f32_16x16x32_bf16 v[36:39], v[236:239], v[124:127], v[36:39]
    ds_read_b64_tr_b16 v[226:227], v4 offset:34304
    s_waitcnt lgkmcnt(4)
    v_mfma_f32_16x16x32_bf16 v[40:43], v[240:243], v[120:123], v[40:43]
    ds_read_b64_tr_b16 v[228:229], v5 offset:33312
    v_mfma_f32_16x16x32_bf16 v[44:47], v[240:243], v[124:127], v[44:47]
    ds_read_b64_tr_b16 v[230:231], v5 offset:34336
    s_waitcnt lgkmcnt(4)
    v_mfma_f32_16x16x32_bf16 v[48:51], v[244:247], v[120:123], v[48:51]
    ds_read_b64_tr_b16 v[232:233], v4 offset:33536
    v_mfma_f32_16x16x32_bf16 v[52:55], v[244:247], v[124:127], v[52:55]
    ds_read_b64_tr_b16 v[234:235], v4 offset:34560
    s_waitcnt lgkmcnt(4)
    v_mfma_f32_16x16x32_bf16 v[56:59], v[224:227], v[120:123], v[56:59]
    ds_read_b64_tr_b16 v[236:237], v5 offset:33568
    v_mfma_f32_16x16x32_bf16 v[60:63], v[224:227], v[124:127], v[60:63]
    ds_read_b64_tr_b16 v[238:239], v5 offset:34592
    s_waitcnt lgkmcnt(4)
    v_mfma_f32_16x16x32_bf16 v[64:67], v[228:231], v[120:123], v[64:67]
    ds_read_b64_tr_b16 v[240:241], v4 offset:40960
    v_mfma_f32_16x16x32_bf16 v[68:71], v[228:231], v[124:127], v[68:71]
    ds_read_b64_tr_b16 v[242:243], v4 offset:41984
    s_waitcnt lgkmcnt(4)
    v_mfma_f32_16x16x32_bf16 v[72:75], v[232:235], v[120:123], v[72:75]
    ds_read_b64_tr_b16 v[244:245], v5 offset:40992
    v_mfma_f32_16x16x32_bf16 v[76:79], v[232:235], v[124:127], v[76:79]
    ds_read_b64_tr_b16 v[246:247], v5 offset:42016
    s_waitcnt lgkmcnt(4)
    v_mfma_f32_16x16x32_bf16 v[80:83], v[236:239], v[120:123], v[80:83]
    ds_read_b64_tr_b16 v[224:225], v4 offset:41216
    v_mfma_f32_16x16x32_bf16 v[84:87], v[236:239], v[124:127], v[84:87]
    ds_read_b64_tr_b16 v[226:227], v4 offset:42240
    s_waitcnt vmcnt(14) lgkmcnt(4)
    v_mfma_f32_16x16x32_bf16 v[24:27], v[240:243], v[128:131], v[24:27]
    ds_read_b64_tr_b16 v[228:229], v5 offset:41248
    s_waitcnt vmcnt(12)
    v_mfma_f32_16x16x32_bf16 v[28:31], v[240:243], v[132:135], v[28:31]
    ds_read_b64_tr_b16 v[230:231], v5 offset:42272
    s_waitcnt lgkmcnt(4)
    v_mfma_f32_16x16x32_bf16 v[32:35], v[244:247], v[128:131], v[32:35]
    ds_read_b64_tr_b16 v[232:233], v4 offset:41472
    v_mfma_f32_16x16x32_bf16 v[36:39], v[244:247], v[132:135], v[36:39]
    ds_read_b64_tr_b16 v[234:235], v4 offset:42496
    s_waitcnt lgkmcnt(4)
    v_mfma_f32_16x16x32_bf16 v[40:43], v[224:227], v[128:131], v[40:43]
    ds_read_b64_tr_b16 v[236:237], v5 offset:41504
    v_mfma_f32_16x16x32_bf16 v[44:47], v[224:227], v[132:135], v[44:47]
    ds_read_b64_tr_b16 v[238:239], v5 offset:42528
    s_waitcnt lgkmcnt(4)
    v_mfma_f32_16x16x32_bf16 v[48:51], v[228:231], v[128:131], v[48:51]
    ds_read_b64_tr_b16 v[240:241], v4 offset:41728
    v_mfma_f32_16x16x32_bf16 v[52:55], v[228:231], v[132:135], v[52:55]
    ds_read_b64_tr_b16 v[242:243], v4 offset:42752
    s_waitcnt lgkmcnt(4)
    v_mfma_f32_16x16x32_bf16 v[56:59], v[232:235], v[128:131], v[56:59]
    ds_read_b64_tr_b16 v[244:245], v5 offset:41760
    v_mfma_f32_16x16x32_bf16 v[60:63], v[232:235], v[132:135], v[60:63]
    ds_read_b64_tr_b16 v[246:247], v5 offset:42784
    s_waitcnt lgkmcnt(4)
    v_mfma_f32_16x16x32_bf16 v[64:67], v[236:239], v[128:131], v[64:67]
    v_mfma_f32_16x16x32_bf16 v[68:71], v[236:239], v[132:135], v[68:71]
    s_waitcnt vmcnt(5)
    s_barrier
    ds_read_b64_tr_b16 v[224:225], v4 offset:49152
    ds_read_b64_tr_b16 v[226:227], v4 offset:50176
    s_waitcnt lgkmcnt(4)
    v_mfma_f32_16x16x32_bf16 v[72:75], v[240:243], v[128:131], v[72:75]
    ds_read_b64_tr_b16 v[228:229], v5 offset:49184
    v_mfma_f32_16x16x32_bf16 v[76:79], v[240:243], v[132:135], v[76:79]
    ds_read_b64_tr_b16 v[230:231], v5 offset:50208
    s_waitcnt lgkmcnt(4)
    v_mfma_f32_16x16x32_bf16 v[80:83], v[244:247], v[128:131], v[80:83]
    ds_read_b64_tr_b16 v[232:233], v4 offset:49408
    v_mfma_f32_16x16x32_bf16 v[84:87], v[244:247], v[132:135], v[84:87]
    ds_read_b64_tr_b16 v[234:235], v4 offset:50432
    s_waitcnt lgkmcnt(4)
    v_mfma_f32_16x16x32_bf16 v[24:27], v[224:227], v[88:91], v[24:27]
    ds_read_b64_tr_b16 v[236:237], v5 offset:49440
    s_waitcnt vmcnt(4)
    v_mfma_f32_16x16x32_bf16 v[28:31], v[224:227], v[92:95], v[28:31]
    ds_read_b64_tr_b16 v[238:239], v5 offset:50464
    s_waitcnt lgkmcnt(4)
    v_mfma_f32_16x16x32_bf16 v[32:35], v[228:231], v[88:91], v[32:35]
    ds_read_b64_tr_b16 v[240:241], v4 offset:49664
    v_mfma_f32_16x16x32_bf16 v[36:39], v[228:231], v[92:95], v[36:39]
    ds_read_b64_tr_b16 v[242:243], v4 offset:50688
    s_waitcnt lgkmcnt(4)
    v_mfma_f32_16x16x32_bf16 v[40:43], v[232:235], v[88:91], v[40:43]
    ds_read_b64_tr_b16 v[244:245], v5 offset:49696
    v_mfma_f32_16x16x32_bf16 v[44:47], v[232:235], v[92:95], v[44:47]
    ds_read_b64_tr_b16 v[246:247], v5 offset:50720
    s_waitcnt lgkmcnt(4)
    v_mfma_f32_16x16x32_bf16 v[48:51], v[236:239], v[88:91], v[48:51]
    ds_read_b64_tr_b16 v[224:225], v4 offset:49920
    v_mfma_f32_16x16x32_bf16 v[52:55], v[236:239], v[92:95], v[52:55]
    ds_read_b64_tr_b16 v[226:227], v4 offset:50944
    s_waitcnt lgkmcnt(4)
    v_mfma_f32_16x16x32_bf16 v[56:59], v[240:243], v[88:91], v[56:59]
    ds_read_b64_tr_b16 v[228:229], v5 offset:49952
    v_mfma_f32_16x16x32_bf16 v[60:63], v[240:243], v[92:95], v[60:63]
    ds_read_b64_tr_b16 v[230:231], v5 offset:50976
    s_waitcnt lgkmcnt(4)
    v_mfma_f32_16x16x32_bf16 v[64:67], v[244:247], v[88:91], v[64:67]
    ds_read_b64_tr_b16 v[232:233], v4 offset:57344
    v_mfma_f32_16x16x32_bf16 v[68:71], v[244:247], v[92:95], v[68:71]
    ds_read_b64_tr_b16 v[234:235], v4 offset:58368
    s_waitcnt lgkmcnt(4)
    v_mfma_f32_16x16x32_bf16 v[72:75], v[224:227], v[88:91], v[72:75]
    ds_read_b64_tr_b16 v[236:237], v5 offset:57376
    v_mfma_f32_16x16x32_bf16 v[76:79], v[224:227], v[92:95], v[76:79]
    ds_read_b64_tr_b16 v[238:239], v5 offset:58400
    s_waitcnt lgkmcnt(4)
    v_mfma_f32_16x16x32_bf16 v[80:83], v[228:231], v[88:91], v[80:83]
    ds_read_b64_tr_b16 v[240:241], v4 offset:57600
    v_mfma_f32_16x16x32_bf16 v[84:87], v[228:231], v[92:95], v[84:87]
    ds_read_b64_tr_b16 v[242:243], v4 offset:58624
    s_waitcnt vmcnt(2) lgkmcnt(4)
    v_mfma_f32_16x16x32_bf16 v[24:27], v[232:235], v[96:99], v[24:27]
    ds_read_b64_tr_b16 v[244:245], v5 offset:57632
    s_waitcnt vmcnt(0)
    v_mfma_f32_16x16x32_bf16 v[28:31], v[232:235], v[100:103], v[28:31]
    ds_read_b64_tr_b16 v[246:247], v5 offset:58656
    s_waitcnt lgkmcnt(4)
    v_mfma_f32_16x16x32_bf16 v[32:35], v[236:239], v[96:99], v[32:35]
    ds_read_b64_tr_b16 v[224:225], v4 offset:57856
    v_mfma_f32_16x16x32_bf16 v[36:39], v[236:239], v[100:103], v[36:39]
    ds_read_b64_tr_b16 v[226:227], v4 offset:58880
    s_waitcnt lgkmcnt(4)
    v_mfma_f32_16x16x32_bf16 v[40:43], v[240:243], v[96:99], v[40:43]
    ds_read_b64_tr_b16 v[228:229], v5 offset:57888
    v_mfma_f32_16x16x32_bf16 v[44:47], v[240:243], v[100:103], v[44:47]
    ds_read_b64_tr_b16 v[230:231], v5 offset:58912
    s_waitcnt lgkmcnt(4)
    v_mfma_f32_16x16x32_bf16 v[48:51], v[244:247], v[96:99], v[48:51]
    ds_read_b64_tr_b16 v[232:233], v4 offset:58112
    v_mfma_f32_16x16x32_bf16 v[52:55], v[244:247], v[100:103], v[52:55]
    ds_read_b64_tr_b16 v[234:235], v4 offset:59136
    s_waitcnt lgkmcnt(4)
    v_mfma_f32_16x16x32_bf16 v[56:59], v[224:227], v[96:99], v[56:59]
    ds_read_b64_tr_b16 v[236:237], v5 offset:58144
    v_mfma_f32_16x16x32_bf16 v[60:63], v[224:227], v[100:103], v[60:63]
    ds_read_b64_tr_b16 v[238:239], v5 offset:59168
    s_waitcnt lgkmcnt(4)
    v_mfma_f32_16x16x32_bf16 v[64:67], v[228:231], v[96:99], v[64:67]
    v_mfma_f32_16x16x32_bf16 v[68:71], v[228:231], v[100:103], v[68:71]
    s_waitcnt lgkmcnt(2)
    v_mfma_f32_16x16x32_bf16 v[72:75], v[232:235], v[96:99], v[72:75]
    v_mfma_f32_16x16x32_bf16 v[76:79], v[232:235], v[100:103], v[76:79]
    s_waitcnt lgkmcnt(0)
    v_mfma_f32_16x16x32_bf16 v[80:83], v[236:239], v[96:99], v[80:83]
    v_mfma_f32_16x16x32_bf16 v[84:87], v[236:239], v[100:103], v[84:87]
    s_barrier
    s_add_u32 s22, s21, 0x8000
    s_add_u32 m0, s20, 0x20000
    s_nop 0
    buffer_load_dwordx4 v2, s[8:11], s22 offen sc1 lds
    s_add_u32 s22, s21, 0x8400
    s_add_u32 m0, s20, 0x20400
    s_nop 0
    buffer_load_dwordx4 v2, s[8:11], s22 offen sc1 lds
    s_add_u32 s22, s21, 0xc000
    s_add_u32 m0, s20, 0x24000
    s_nop 0
    buffer_load_dwordx4 v2, s[8:11], s22 offen sc1 lds
    s_add_u32 s22, s21, 0xc400
    s_add_u32 m0, s20, 0x24400
    s_nop 0
    buffer_load_dwordx4 v2, s[8:11], s22 offen sc1 lds
    ds_read_b64_tr_b16 v[88:89], v11 offset:0
    ds_read_b64_tr_b16 v[90:91], v11 offset:1024
    ds_read_b64_tr_b16 v[92:93], v11 offset:8192
    ds_read_b64_tr_b16 v[94:95], v11 offset:9216
    ds_read_b64_tr_b16 v[96:97], v11 offset:16384
    ds_read_b64_tr_b16 v[98:99], v11 offset:17408
    ds_read_b64_tr_b16 v[100:101], v11 offset:24576
    ds_read_b64_tr_b16 v[102:103], v11 offset:25600
    s_mov_b32 s23, 0x3e0293ee
    v_mul_f32 v24, s23, v24
    v_mul_f32 v25, s23, v25
    v_mul_f32 v26, s23, v26
    v_mul_f32 v27, s23, v27
    v_mul_f32 v28, s23, v28
    v_mul_f32 v29, s23, v29
    v_mul_f32 v30, s23, v30
    v_mul_f32 v31, s23, v31
    v_mul_f32 v32, s23, v32
    v_mul_f32 v33, s23, v33
    v_mul_f32 v34, s23, v34
    v_mul_f32 v35, s23, v35
    v_mul_f32 v36, s23, v36
    v_mul_f32 v37, s23, v37
    v_mul_f32 v38, s23, v38
    v_mul_f32 v39, s23, v39
    v_cvt_pk_bf16_f32 v152, v24, v25
    v_cvt_pk_bf16_f32 v153, v26, v27
    v_cvt_pk_bf16_f32 v168, v28, v29
    v_cvt_pk_bf16_f32 v169, v30, v31
    v_cvt_pk_bf16_f32 v154, v32, v33
    v_cvt_pk_bf16_f32 v155, v34, v35
    v_cvt_pk_bf16_f32 v170, v36, v37
    v_cvt_pk_bf16_f32 v171, v38, v39
    s_waitcnt lgkmcnt(6)
    v_mfma_f32_16x16x32_bf16 v[104:107], v[88:91], v[136:139], 0
    s_waitcnt lgkmcnt(4)
    v_mfma_f32_16x16x32_bf16 v[104:107], v[92:95], v[140:143], v[104:107]
    s_waitcnt lgkmcnt(2)
    v_mfma_f32_16x16x32_bf16 v[104:107], v[96:99], v[144:147], v[104:107]
    s_waitcnt lgkmcnt(0)
    v_mfma_f32_16x16x32_bf16 v[104:107], v[100:103], v[148:151], v[104:107]
    v_add_u32 v4, 0x10000, v2
    v_add_u32 v5, 0x20000, v2
    s_barrier
    ds_read_b128 v[224:227], v4 offset:32768
    ds_read_b128 v[228:231], v4 offset:33792
    ds_read_b128 v[232:235], v4 offset:34816
    ds_read_b128 v[236:239], v4 offset:35840
    v_mov_b32 v12, 0x3f803f80
    v_mov_b32 v13, 0x3f803f80
    v_mov_b32 v14, 0x3f803f80
    v_mov_b32 v15, 0x3f803f80
    s_waitcnt lgkmcnt(3)
    v_mfma_f32_16x16x32_bf16 v[184:187], v[224:227], v[152:155], 0
    v_mul_f32 v40, s23, v40
    v_mul_f32 v41, s23, v41
    v_mul_f32 v42, s23, v42
    v_mul_f32 v43, s23, v43
    v_mul_f32 v44, s23, v44
    v_mul_f32 v45, s23, v45
    v_lshrrev_b32 v20, 4, v1
    v_lshlrev_b32 v20, 4, v20
    s_lshr_b32 s16, s2, 5
    s_lshl_b32 s16, s16, 14
    s_and_b32 s17, s2, 31
    s_lshl_b32 s17, s17, 9
    s_add_u32 s16, s16, s17
    s_lshl_b32 s17, s3, 6
    s_add_u32 s16, s16, s17
    s_add_u32 s16, s16, 0x580000
    s_mov_b32 exec_lo, 0x10001
    s_mov_b32 exec_hi, 0x10001
    buffer_store_dwordx4 v[104:107], v20, s[8:11], s16 offen sc1
    s_mov_b64 exec, -1
    v_mfma_f32_16x16x32_bf16 v[188:191], v[224:227], v[168:171], 0
    ds_read_b128 v[240:243], v4 offset:36864
    v_mul_f32 v46, s23, v46
    v_mul_f32 v47, s23, v47
    v_mul_f32 v48, s23, v48
    v_mul_f32 v49, s23, v49
    v_mul_f32 v50, s23, v50
    v_mul_f32 v51, s23, v51
    s_mov_b64 s[64:65], s[46:47]
    s_mov_b32 s66, 0x700000
    s_mov_b32 s67, 0x20000
    s_mov_b64 s[68:69], s[48:49]
    s_mov_b32 s70, 0x700000
    s_mov_b32 s71, 0x20000
    s_cmp_lt_u32 s2, 224
    s_cselect_b32 s66, 7340032, 0
    s_cselect_b32 s70, 7340032, 0
    s_and_b32 s29, s2, 7
    s_mul_i32 s29, s29, 28
    s_lshr_b32 s16, s2, 3
    s_add_u32 s29, s29, s16
    s_sub_u32 s16, s3, 4
    v_lshrrev_b32 v20, 3, v1
    v_lshlrev_b32 v20, 3, v20
    s_lshl_b32 s17, s16, 6
    v_add_u32 v20, s17, v20
    s_mov_b32 s17, 7168
    v_mul_lo_u32 v11, s17, v20
    v_and_b32 v20, 7, v1
    v_lshl_add_u32 v11, v20, 4, v11
    s_and_b32 s17, s29, 3
    s_mul_i32 s18, s17, 1835008
    s_lshr_b32 s17, s29, 2
    s_lshl_b32 s17, s17, 7
    s_add_u32 s18, s18, s17
    s_lshl_b32 s15, s16, 13
    s_waitcnt lgkmcnt(3)
    v_mfma_f32_16x16x32_bf16 v[192:195], v[228:231], v[152:155], 0
    s_add_u32 s22, s21, 0x10000
    s_add_u32 m0, s20, 0x10000
    s_nop 0
    buffer_load_dwordx4 v2, s[8:11], s22 offen sc1 lds
    v_mul_f32 v52, s23, v52
    v_mul_f32 v53, s23, v53
    v_mul_f32 v54, s23, v54
    v_mul_f32 v55, s23, v55
    v_cvt_pk_bf16_f32 v156, v40, v41
    v_cvt_pk_bf16_f32 v157, v42, v43
    v_mfma_f32_16x16x32_bf16 v[196:199], v[228:231], v[168:171], 0
    ds_read_b128 v[244:247], v4 offset:37888
    v_cvt_pk_bf16_f32 v172, v44, v45
    v_cvt_pk_bf16_f32 v173, v46, v47
    v_cvt_pk_bf16_f32 v158, v48, v49
    v_cvt_pk_bf16_f32 v159, v50, v51
    v_cvt_pk_bf16_f32 v174, v52, v53
    v_cvt_pk_bf16_f32 v175, v54, v55
    s_waitcnt lgkmcnt(3)
    v_mfma_f32_16x16x32_bf16 v[184:187], v[232:235], v[156:159], v[184:187]
    v_mul_f32 v56, s23, v56
    v_mul_f32 v57, s23, v57
    v_mul_f32 v58, s23, v58
    v_mul_f32 v59, s23, v59
    v_mul_f32 v60, s23, v60
    v_mul_f32 v61, s23, v61
    v_mfma_f32_16x16x32_bf16 v[188:191], v[232:235], v[172:175], v[188:191]
    ds_read_b128 v[224:227], v4 offset:38912
    v_mul_f32 v62, s23, v62
    v_mul_f32 v63, s23, v63
    v_mul_f32 v64, s23, v64
    v_mul_f32 v65, s23, v65
    v_mul_f32 v66, s23, v66
    v_mul_f32 v67, s23, v67
    s_waitcnt lgkmcnt(3)
    v_mfma_f32_16x16x32_bf16 v[192:195], v[236:239], v[156:159], v[192:195]
    v_mul_f32 v68, s23, v68
    v_mul_f32 v69, s23, v69
    v_mul_f32 v70, s23, v70
    v_mul_f32 v71, s23, v71
    v_cvt_pk_bf16_f32 v160, v56, v57
    v_cvt_pk_bf16_f32 v161, v58, v59
    v_mfma_f32_16x16x32_bf16 v[196:199], v[236:239], v[172:175], v[196:199]
    ds_read_b128 v[228:231], v4 offset:39936
    v_cvt_pk_bf16_f32 v176, v60, v61
    v_cvt_pk_bf16_f32 v177, v62, v63
    v_cvt_pk_bf16_f32 v162, v64, v65
    v_cvt_pk_bf16_f32 v163, v66, v67
    v_cvt_pk_bf16_f32 v178, v68, v69
    v_cvt_pk_bf16_f32 v179, v70, v71
    s_waitcnt lgkmcnt(3)
    v_mfma_f32_16x16x32_bf16 v[184:187], v[240:243], v[160:163], v[184:187]
    v_mul_f32 v72, s23, v72
    v_mul_f32 v73, s23, v73
    v_mul_f32 v74, s23, v74
    v_mul_f32 v75, s23, v75
    v_mul_f32 v76, s23, v76
    v_mul_f32 v77, s23, v77
    v_mfma_f32_16x16x32_bf16 v[188:191], v[240:243], v[176:179], v[188:191]
    ds_read_b128 v[232:235], v4 offset:40960
    v_mul_f32 v78, s23, v78
    v_mul_f32 v79, s23, v79
    v_mul_f32 v80, s23, v80
    v_mul_f32 v81, s23, v81
    v_mul_f32 v82, s23, v82
    v_mul_f32 v83, s23, v83
    s_waitcnt lgkmcnt(3)
    v_mfma_f32_16x16x32_bf16 v[192:195], v[244:247], v[160:163], v[192:195]
    s_add_u32 s22, s21, 0x10400
    s_add_u32 m0, s20, 0x10400
    s_nop 0
    buffer_load_dwordx4 v2, s[8:11], s22 offen sc1 lds
    v_mul_f32 v84, s23, v84
    v_mul_f32 v85, s23, v85
    v_mul_f32 v86, s23, v86
    v_mul_f32 v87, s23, v87
    v_cvt_pk_bf16_f32 v164, v72, v73
    v_cvt_pk_bf16_f32 v165, v74, v75
    v_mfma_f32_16x16x32_bf16 v[196:199], v[244:247], v[176:179], v[196:199]
    ds_read_b128 v[236:239], v4 offset:41984
    v_cvt_pk_bf16_f32 v180, v76, v77
    v_cvt_pk_bf16_f32 v181, v78, v79
    v_cvt_pk_bf16_f32 v166, v80, v81
    v_cvt_pk_bf16_f32 v167, v82, v83
    v_cvt_pk_bf16_f32 v182, v84, v85
    v_cvt_pk_bf16_f32 v183, v86, v87
    s_waitcnt lgkmcnt(3)
    v_mfma_f32_16x16x32_bf16 v[184:187], v[224:227], v[164:167], v[184:187]
    v_mfma_f32_16x16x32_bf16 v[188:191], v[224:227], v[180:183], v[188:191]
    ds_read_b128 v[240:243], v4 offset:43008
    s_waitcnt lgkmcnt(3)
    v_mfma_f32_16x16x32_bf16 v[192:195], v[228:231], v[164:167], v[192:195]
    v_mfma_f32_16x16x32_bf16 v[196:199], v[228:231], v[180:183], v[196:199]
    ds_read_b128 v[244:247], v4 offset:44032
    s_waitcnt lgkmcnt(3)
    v_mfma_f32_16x16x32_bf16 v[200:203], v[232:235], v[152:155], 0
    v_mfma_f32_16x16x32_bf16 v[204:207], v[232:235], v[168:171], 0
    ds_read_b128 v[224:227], v4 offset:45056
    s_waitcnt lgkmcnt(3)
    v_mfma_f32_16x16x32_bf16 v[208:211], v[236:239], v[152:155], 0
    v_mfma_f32_16x16x32_bf16 v[212:215], v[236:239], v[168:171], 0
    ds_read_b128 v[228:231], v4 offset:46080
    s_waitcnt lgkmcnt(3)
    v_mfma_f32_16x16x32_bf16 v[200:203], v[240:243], v[156:159], v[200:203]
    v_mfma_f32_16x16x32_bf16 v[204:207], v[240:243], v[172:175], v[204:207]
    ds_read_b128 v[232:235], v4 offset:47104
    s_waitcnt lgkmcnt(3)
    v_mfma_f32_16x16x32_bf16 v[208:211], v[244:247], v[156:159], v[208:211]
    v_max3_f32 v16, v184, v185, v186
    v_mfma_f32_16x16x32_bf16 v[212:215], v[244:247], v[172:175], v[212:215]
    ds_read_b128 v[236:239], v4 offset:48128
    v_max3_f32 v16, v16, v187, v192
    s_waitcnt lgkmcnt(3)
    v_mfma_f32_16x16x32_bf16 v[200:203], v[224:227], v[160:163], v[200:203]
    v_max3_f32 v16, v16, v193, v194
    v_mfma_f32_16x16x32_bf16 v[204:207], v[224:227], v[176:179], v[204:207]
    s_barrier
    ds_read_b128 v[240:243], v4 offset:49152
    v_max_f32 v16, v16, v195
    s_waitcnt lgkmcnt(3)
    v_mfma_f32_16x16x32_bf16 v[208:211], v[228:231], v[160:163], v[208:211]
    v_max3_f32 v17, v188, v189, v190
    v_mfma_f32_16x16x32_bf16 v[212:215], v[228:231], v[176:179], v[212:215]
    s_add_u32 s22, s21, 0x14000
    s_add_u32 m0, s20, 0x14000
    s_nop 0
    buffer_load_dwordx4 v2, s[8:11], s22 offen sc1 lds
    ds_read_b128 v[244:247], v4 offset:50176
    v_max3_f32 v17, v17, v191, v196
    s_waitcnt lgkmcnt(3)
    v_mfma_f32_16x16x32_bf16 v[200:203], v[232:235], v[164:167], v[200:203]
    v_max3_f32 v17, v17, v197, v198
    v_mfma_f32_16x16x32_bf16 v[204:207], v[232:235], v[180:183], v[204:207]
    ds_read_b128 v[224:227], v4 offset:51200
    v_max_f32 v17, v17, v199
    s_waitcnt lgkmcnt(3)
    v_mfma_f32_16x16x32_bf16 v[208:211], v[236:239], v[164:167], v[208:211]
    s_mov_b64 s[72:73], s[40:41]
    s_mov_b32 s74, 0x800000
    s_mov_b32 s75, 0x20000
    v_lshlrev_b32 v21, 7, v1
    s_lshl_b32 s16, s2, 2
    s_add_u32 s16, s16, s3
    s_sub_u32 s16, s16, 4
    s_lshl_b32 s16, s16, 13
    buffer_load_dword v7, v21, s[72:75], s16 offen
    v_mfma_f32_16x16x32_bf16 v[212:215], v[236:239], v[180:183], v[212:215]
    ds_read_b128 v[228:231], v4 offset:52224
    v_max3_f32 v16, v16, v200, v201
    v_max3_f32 v16, v16, v202, v203
    v_max3_f32 v16, v16, v208, v209
    v_max3_f32 v16, v16, v210, v211
    v_max3_f32 v17, v17, v204, v205
    v_max3_f32 v17, v17, v206, v207
    s_nop 0
    v_max3_f32 v17, v17, v212, v213
    v_max3_f32 v17, v17, v214, v215
    v_mov_b32 v18, v16
    v_mov_b32 v19, v17
    s_nop 0
    v_permlane16_swap_b32 v16, v18
    v_permlane16_swap_b32 v17, v19
    v_max_f32 v16, v16, v18
    v_max_f32 v17, v17, v19
    v_mov_b32 v18, v16
    v_mov_b32 v19, v17
    s_nop 0
    v_permlane32_swap_b32 v16, v18
    v_permlane32_swap_b32 v17, v19
    v_max_f32 v16, v16, v18
    v_max_f32 v17, v17, v19
    v_sub_f32 v216, 0, v16
    v_sub_f32 v217, 0, v16
    v_sub_f32 v218, 0, v16
    v_sub_f32 v219, 0, v16
    v_sub_f32 v220, 0, v17
    v_sub_f32 v221, 0, v17
    v_sub_f32 v222, 0, v17
    v_sub_f32 v223, 0, v17
    v_add_f32 v184, v184, v216
    v_add_f32 v185, v185, v216
    v_exp_f32 v184, v184
    v_exp_f32 v185, v185
    v_add_f32 v186, v186, v216
    v_add_f32 v187, v187, v216
    v_exp_f32 v186, v186
    v_exp_f32 v187, v187
    v_cvt_pk_bf16_f32 v24, v184, v185
    v_add_f32 v188, v188, v220
    v_add_f32 v189, v189, v220
    v_exp_f32 v188, v188
    v_exp_f32 v189, v189
    v_cvt_pk_bf16_f32 v25, v186, v187
    v_add_f32 v190, v190, v220
    v_add_f32 v191, v191, v220
    v_exp_f32 v190, v190
    v_exp_f32 v191, v191
    v_cvt_pk_bf16_f32 v28, v188, v189
    v_add_f32 v192, v192, v216
    v_add_f32 v193, v193, v216
    v_exp_f32 v192, v192
    v_exp_f32 v193, v193
    v_cvt_pk_bf16_f32 v29, v190, v191
    v_add_f32 v194, v194, v216
    v_add_f32 v195, v195, v216
    v_exp_f32 v194, v194
    v_exp_f32 v195, v195
    v_cvt_pk_bf16_f32 v26, v192, v193
    v_add_f32 v196, v196, v220
    v_add_f32 v197, v197, v220
    v_exp_f32 v196, v196
    v_exp_f32 v197, v197
    v_cvt_pk_bf16_f32 v27, v194, v195
    v_add_f32 v198, v198, v220
    v_add_f32 v199, v199, v220
    v_exp_f32 v198, v198
    v_exp_f32 v199, v199
    v_cvt_pk_bf16_f32 v30, v196, v197
    v_cvt_pk_bf16_f32 v31, v198, v199
    s_waitcnt lgkmcnt(3)
    v_mfma_f32_16x16x32_bf16 v[184:187], v[240:243], v[152:155], v[216:219]
    v_mfma_f32_16x16x32_bf16 v[188:191], v[240:243], v[168:171], v[220:223]
    ds_read_b128 v[232:235], v4 offset:53248
    v_add_f32 v200, v200, v216
    v_add_f32 v201, v201, v216
    v_exp_f32 v200, v200
    v_mfma_f32_16x16x32_bf16 v[248:251], v[12:15], v[24:27], 0
    s_waitcnt lgkmcnt(3)
    v_mfma_f32_16x16x32_bf16 v[192:195], v[244:247], v[152:155], v[216:219]
    v_exp_f32 v201, v201
    v_add_f32 v202, v202, v216
    v_add_f32 v203, v203, v216
    v_mfma_f32_16x16x32_bf16 v[196:199], v[244:247], v[168:171], v[220:223]
    s_add_u32 s22, s21, 0x14400
    s_add_u32 m0, s20, 0x14400
    s_nop 0
    buffer_load_dwordx4 v2, s[8:11], s22 offen sc1 lds
    ds_read_b128 v[236:239], v4 offset:54272
    v_exp_f32 v202, v202
    v_exp_f32 v203, v203
    v_mfma_f32_16x16x32_bf16 v[252:255], v[12:15], v[28:31], 0
    s_waitcnt lgkmcnt(3)
    v_mfma_f32_16x16x32_bf16 v[184:187], v[224:227], v[156:159], v[184:187]
    v_cvt_pk_bf16_f32 v32, v200, v201
    v_add_f32 v204, v204, v220
    v_add_f32 v205, v205, v220
    v_mfma_f32_16x16x32_bf16 v[188:191], v[224:227], v[172:175], v[188:191]
    ds_read_b128 v[240:243], v4 offset:55296
    v_exp_f32 v204, v204
    v_exp_f32 v205, v205
    v_cvt_pk_bf16_f32 v33, v202, v203
    s_mov_b64 s[4:5], s[40:41]
    s_mov_b32 s6, 0x800000
    s_mov_b32 s7, 0x20000
    v_bfe_u32 v20, v1, 2, 2
    v_lshlrev_b32 v21, 13, v20
    v_sub_u32 v3, v3, v21
    v_lshl_add_u32 v3, v20, 11, v3
    s_and_b32 s16, s2, 1
    s_lshl_b32 s24, s16, 22
    s_lshr_b32 s16, s2, 5
    s_lshl_b32 s16, s16, 8
    s_add_u32 s24, s24, s16
    s_lshl_b32 s16, s3, 14
    s_add_u32 s24, s24, s16
    s_add_u32 s24, s24, 196608
    s_waitcnt lgkmcnt(3)
    v_mfma_f32_16x16x32_bf16 v[192:195], v[228:231], v[156:159], v[192:195]
    v_add_f32 v206, v206, v220
    v_add_f32 v207, v207, v220
    v_mfma_f32_16x16x32_bf16 v[196:199], v[228:231], v[172:175], v[196:199]
    ds_read_b128 v[244:247], v4 offset:56320
    v_exp_f32 v206, v206
    v_exp_f32 v207, v207
    v_cvt_pk_bf16_f32 v36, v204, v205
    s_waitcnt lgkmcnt(3)
    v_mfma_f32_16x16x32_bf16 v[184:187], v[232:235], v[160:163], v[184:187]
    v_add_f32 v208, v208, v216
    v_add_f32 v209, v209, v216
    v_exp_f32 v208, v208
    v_mfma_f32_16x16x32_bf16 v[188:191], v[232:235], v[176:179], v[188:191]
    ds_read_b128 v[224:227], v4 offset:57344
    v_exp_f32 v209, v209
    v_cvt_pk_bf16_f32 v37, v206, v207
    s_waitcnt lgkmcnt(3)
    v_mfma_f32_16x16x32_bf16 v[192:195], v[236:239], v[160:163], v[192:195]
    v_add_f32 v210, v210, v216
    v_add_f32 v211, v211, v216
    v_exp_f32 v210, v210
    v_mfma_f32_16x16x32_bf16 v[196:199], v[236:239], v[176:179], v[196:199]
    ds_read_b128 v[228:231], v4 offset:58368
    v_exp_f32 v211, v211
    v_cvt_pk_bf16_f32 v34, v208, v209
    v_add_f32 v212, v212, v220
    s_waitcnt lgkmcnt(3)
    v_mfma_f32_16x16x32_bf16 v[184:187], v[240:243], v[164:167], v[184:187]
    v_add_f32 v213, v213, v220
    v_exp_f32 v212, v212
    v_mfma_f32_16x16x32_bf16 v[188:191], v[240:243], v[180:183], v[188:191]
    ds_read_b128 v[232:235], v4 offset:59392
    v_exp_f32 v213, v213
    v_cvt_pk_bf16_f32 v35, v210, v211
    v_add_f32 v214, v214, v220
    s_waitcnt lgkmcnt(3)
    v_mfma_f32_16x16x32_bf16 v[192:195], v[244:247], v[164:167], v[192:195]
    v_add_f32 v215, v215, v220
    v_exp_f32 v214, v214
    v_exp_f32 v215, v215
    v_mfma_f32_16x16x32_bf16 v[196:199], v[244:247], v[180:183], v[196:199]
    ds_read_b128 v[236:239], v4 offset:60416
    v_cvt_pk_bf16_f32 v38, v212, v213
    v_cvt_pk_bf16_f32 v39, v214, v215
    s_waitcnt lgkmcnt(3)
    v_mfma_f32_16x16x32_bf16 v[200:203], v[224:227], v[152:155], v[216:219]
    v_mfma_f32_16x16x32_bf16 v[204:207], v[224:227], v[168:171], v[220:223]
    ds_read_b128 v[240:243], v4 offset:61440
    v_exp_f32 v184, v184
    v_exp_f32 v185, v185
    v_mfma_f32_16x16x32_bf16 v[248:251], v[12:15], v[32:35], v[248:251]
    s_waitcnt lgkmcnt(3)
    v_mfma_f32_16x16x32_bf16 v[208:211], v[228:231], v[152:155], v[216:219]
    v_exp_f32 v186, v186
    v_exp_f32 v187, v187
    v_mfma_f32_16x16x32_bf16 v[212:215], v[228:231], v[168:171], v[220:223]
    ds_read_b128 v[244:247], v4 offset:62464
    v_cvt_pk_bf16_f32 v40, v184, v185
    v_mfma_f32_16x16x32_bf16 v[252:255], v[12:15], v[36:39], v[252:255]
    s_waitcnt lgkmcnt(3)
    v_mfma_f32_16x16x32_bf16 v[200:203], v[232:235], v[156:159], v[200:203]
    v_exp_f32 v188, v188
    v_exp_f32 v189, v189
    v_mfma_f32_16x16x32_bf16 v[204:207], v[232:235], v[172:175], v[204:207]
    ds_read_b128 v[224:227], v4 offset:63488
    v_cvt_pk_bf16_f32 v41, v186, v187
    s_waitcnt lgkmcnt(3)
    v_mfma_f32_16x16x32_bf16 v[208:211], v[236:239], v[156:159], v[208:211]
    v_exp_f32 v190, v190
    v_exp_f32 v191, v191
    v_mfma_f32_16x16x32_bf16 v[212:215], v[236:239], v[172:175], v[212:215]
    ds_read_b128 v[228:231], v4 offset:64512
    v_cvt_pk_bf16_f32 v44, v188, v189
    v_exp_f32 v192, v192
    s_waitcnt lgkmcnt(3)
    v_mfma_f32_16x16x32_bf16 v[200:203], v[240:243], v[160:163], v[200:203]
    v_exp_f32 v193, v193
    v_mfma_f32_16x16x32_bf16 v[204:207], v[240:243], v[176:179], v[204:207]
    s_waitcnt vmcnt(8)
    s_barrier
    ds_read_b128 v[232:235], v5 offset:0
    v_cvt_pk_bf16_f32 v45, v190, v191
    v_exp_f32 v194, v194
    s_waitcnt lgkmcnt(3)
    v_mfma_f32_16x16x32_bf16 v[208:211], v[244:247], v[160:163], v[208:211]
    v_exp_f32 v195, v195
    v_mfma_f32_16x16x32_bf16 v[212:215], v[244:247], v[176:179], v[212:215]
    s_add_u32 s22, s21, 0x18000
    s_add_u32 m0, s20, 0x18000
    s_nop 0
    buffer_load_dwordx4 v2, s[8:11], s22 offen sc1 lds
    ds_read_b128 v[236:239], v5 offset:1024
    v_cvt_pk_bf16_f32 v42, v192, v193
    v_exp_f32 v196, v196
    s_waitcnt lgkmcnt(3)
    v_mfma_f32_16x16x32_bf16 v[200:203], v[224:227], v[164:167], v[200:203]
    v_exp_f32 v197, v197
    v_cvt_pk_bf16_f32 v43, v194, v195
    v_mfma_f32_16x16x32_bf16 v[204:207], v[224:227], v[180:183], v[204:207]
    ds_read_b128 v[240:243], v5 offset:2048
    v_exp_f32 v198, v198
    s_waitcnt lgkmcnt(3)
    v_mfma_f32_16x16x32_bf16 v[208:211], v[228:231], v[164:167], v[208:211]
    v_exp_f32 v199, v199
    v_cvt_pk_bf16_f32 v46, v196, v197
    v_mfma_f32_16x16x32_bf16 v[212:215], v[228:231], v[180:183], v[212:215]
    ds_read_b128 v[244:247], v5 offset:3072
    v_cvt_pk_bf16_f32 v47, v198, v199
    s_waitcnt lgkmcnt(3)
    v_mfma_f32_16x16x32_bf16 v[184:187], v[232:235], v[152:155], v[216:219]
    v_mfma_f32_16x16x32_bf16 v[188:191], v[232:235], v[168:171], v[220:223]
    ds_read_b128 v[224:227], v5 offset:4096
    v_exp_f32 v200, v200
    v_exp_f32 v201, v201
    v_mfma_f32_16x16x32_bf16 v[248:251], v[12:15], v[40:43], v[248:251]
    s_waitcnt lgkmcnt(3)
    v_mfma_f32_16x16x32_bf16 v[192:195], v[236:239], v[152:155], v[216:219]
    v_exp_f32 v202, v202
    v_exp_f32 v203, v203
    v_mfma_f32_16x16x32_bf16 v[196:199], v[236:239], v[168:171], v[220:223]
    s_add_u32 s22, s21, 0x18400
    s_add_u32 m0, s20, 0x18400
    s_nop 0
    buffer_load_dwordx4 v2, s[8:11], s22 offen sc1 lds
    ds_read_b128 v[228:231], v5 offset:5120
    v_cvt_pk_bf16_f32 v48, v200, v201
    v_mfma_f32_16x16x32_bf16 v[252:255], v[12:15], v[44:47], v[252:255]
    s_waitcnt lgkmcnt(3)
    v_mfma_f32_16x16x32_bf16 v[184:187], v[240:243], v[156:159], v[184:187]
    v_exp_f32 v204, v204
    v_exp_f32 v205, v205
    v_mfma_f32_16x16x32_bf16 v[188:191], v[240:243], v[172:175], v[188:191]
    ds_read_b128 v[232:235], v5 offset:6144
    v_cvt_pk_bf16_f32 v49, v202, v203
    s_waitcnt lgkmcnt(3)
    v_mfma_f32_16x16x32_bf16 v[192:195], v[244:247], v[156:159], v[192:195]
    v_exp_f32 v206, v206
    v_exp_f32 v207, v207
    v_mfma_f32_16x16x32_bf16 v[196:199], v[244:247], v[172:175], v[196:199]
    ds_read_b128 v[236:239], v5 offset:7168
    v_cvt_pk_bf16_f32 v52, v204, v205
    v_exp_f32 v208, v208
    s_waitcnt lgkmcnt(3)
    v_mfma_f32_16x16x32_bf16 v[184:187], v[224:227], v[160:163], v[184:187]
    v_exp_f32 v209, v209
    v_mfma_f32_16x16x32_bf16 v[188:191], v[224:227], v[176:179], v[188:191]
    ds_read_b128 v[240:243], v5 offset:8192
    v_cvt_pk_bf16_f32 v53, v206, v207
    v_exp_f32 v210, v210
    s_waitcnt lgkmcnt(3)
    v_mfma_f32_16x16x32_bf16 v[192:195], v[228:231], v[160:163], v[192:195]
    v_exp_f32 v211, v211
    v_mfma_f32_16x16x32_bf16 v[196:199], v[228:231], v[176:179], v[196:199]
    ds_read_b128 v[244:247], v5 offset:9216
    v_cvt_pk_bf16_f32 v50, v208, v209
    v_exp_f32 v212, v212
    s_waitcnt lgkmcnt(3)
    v_mfma_f32_16x16x32_bf16 v[184:187], v[232:235], v[164:167], v[184:187]
    v_exp_f32 v213, v213
    v_cvt_pk_bf16_f32 v51, v210, v211
    v_mfma_f32_16x16x32_bf16 v[188:191], v[232:235], v[180:183], v[188:191]
    ds_read_b128 v[224:227], v5 offset:10240
    v_exp_f32 v214, v214
    s_waitcnt lgkmcnt(3)
    v_mfma_f32_16x16x32_bf16 v[192:195], v[236:239], v[164:167], v[192:195]
    v_exp_f32 v215, v215
    v_cvt_pk_bf16_f32 v54, v212, v213
    v_mfma_f32_16x16x32_bf16 v[196:199], v[236:239], v[180:183], v[196:199]
    ds_read_b128 v[228:231], v5 offset:11264
    v_cvt_pk_bf16_f32 v55, v214, v215
    s_waitcnt lgkmcnt(3)
    v_mfma_f32_16x16x32_bf16 v[200:203], v[240:243], v[152:155], v[216:219]
    v_mfma_f32_16x16x32_bf16 v[204:207], v[240:243], v[168:171], v[220:223]
    ds_read_b128 v[232:235], v5 offset:12288
    v_exp_f32 v184, v184
    v_exp_f32 v185, v185
    v_mfma_f32_16x16x32_bf16 v[248:251], v[12:15], v[48:51], v[248:251]
    s_waitcnt lgkmcnt(3)
    v_mfma_f32_16x16x32_bf16 v[208:211], v[244:247], v[152:155], v[216:219]
    v_exp_f32 v186, v186
    v_exp_f32 v187, v187
    v_mfma_f32_16x16x32_bf16 v[212:215], v[244:247], v[168:171], v[220:223]
    ds_read_b128 v[236:239], v5 offset:13312
    v_cvt_pk_bf16_f32 v56, v184, v185
    v_mfma_f32_16x16x32_bf16 v[252:255], v[12:15], v[52:55], v[252:255]
    s_waitcnt lgkmcnt(3)
    v_mfma_f32_16x16x32_bf16 v[200:203], v[224:227], v[156:159], v[200:203]
    v_exp_f32 v188, v188
    v_exp_f32 v189, v189
    v_mfma_f32_16x16x32_bf16 v[204:207], v[224:227], v[172:175], v[204:207]
    ds_read_b128 v[240:243], v5 offset:14336
    v_cvt_pk_bf16_f32 v57, v186, v187
    s_waitcnt lgkmcnt(3)
    v_mfma_f32_16x16x32_bf16 v[208:211], v[228:231], v[156:159], v[208:211]
    v_exp_f32 v190, v190
    v_exp_f32 v191, v191
    s_waitcnt vmcnt(7)
    v_mfma_f32_16x16x32_bf16 v[212:215], v[228:231], v[172:175], v[212:215]
    ds_read_b128 v[244:247], v5 offset:15360
    v_cvt_pk_bf16_f32 v60, v188, v189
    v_exp_f32 v192, v192
    s_waitcnt lgkmcnt(3)
    v_mfma_f32_16x16x32_bf16 v[200:203], v[232:235], v[160:163], v[200:203]
    v_exp_f32 v193, v193
    v_mfma_f32_16x16x32_bf16 v[204:207], v[232:235], v[176:179], v[204:207]
    s_barrier
    ds_read_b128 v[224:227], v5 offset:16384
    v_cvt_pk_bf16_f32 v61, v190, v191
    v_exp_f32 v194, v194
    s_waitcnt lgkmcnt(3)
    v_mfma_f32_16x16x32_bf16 v[208:211], v[236:239], v[160:163], v[208:211]
    v_exp_f32 v195, v195
    v_mfma_f32_16x16x32_bf16 v[212:215], v[236:239], v[176:179], v[212:215]
    s_add_u32 s22, s21, 0x1c000
    s_add_u32 m0, s20, 0x1c000
    s_nop 0
    buffer_load_dwordx4 v2, s[8:11], s22 offen sc1 lds
    ds_read_b128 v[228:231], v5 offset:17408
    v_cvt_pk_bf16_f32 v58, v192, v193
    v_exp_f32 v196, v196
    s_waitcnt lgkmcnt(3)
    v_mfma_f32_16x16x32_bf16 v[200:203], v[240:243], v[164:167], v[200:203]
    v_exp_f32 v197, v197
    v_cvt_pk_bf16_f32 v59, v194, v195
    v_mfma_f32_16x16x32_bf16 v[204:207], v[240:243], v[180:183], v[204:207]
    ds_read_b128 v[232:235], v5 offset:18432
    v_exp_f32 v198, v198
    s_waitcnt lgkmcnt(3)
    v_mfma_f32_16x16x32_bf16 v[208:211], v[244:247], v[164:167], v[208:211]
    v_exp_f32 v199, v199
    v_cvt_pk_bf16_f32 v62, v196, v197
    v_mfma_f32_16x16x32_bf16 v[212:215], v[244:247], v[180:183], v[212:215]
    ds_read_b128 v[236:239], v5 offset:19456
    v_cvt_pk_bf16_f32 v63, v198, v199
    s_waitcnt lgkmcnt(3)
    v_mfma_f32_16x16x32_bf16 v[184:187], v[224:227], v[152:155], v[216:219]
    v_mfma_f32_16x16x32_bf16 v[188:191], v[224:227], v[168:171], v[220:223]
    ds_read_b128 v[240:243], v5 offset:20480
    v_exp_f32 v200, v200
    v_exp_f32 v201, v201
    v_mfma_f32_16x16x32_bf16 v[248:251], v[12:15], v[56:59], v[248:251]
    s_waitcnt lgkmcnt(3)
    v_mfma_f32_16x16x32_bf16 v[192:195], v[228:231], v[152:155], v[216:219]
    v_exp_f32 v202, v202
    v_exp_f32 v203, v203
    v_mfma_f32_16x16x32_bf16 v[196:199], v[228:231], v[168:171], v[220:223]
    s_add_u32 s22, s21, 0x1c400
    s_add_u32 m0, s20, 0x1c400
    s_nop 0
    buffer_load_dwordx4 v2, s[8:11], s22 offen sc1 lds
    ds_read_b128 v[244:247], v5 offset:21504
    v_cvt_pk_bf16_f32 v64, v200, v201
    v_mfma_f32_16x16x32_bf16 v[252:255], v[12:15], v[60:63], v[252:255]
    s_waitcnt lgkmcnt(3)
    v_mfma_f32_16x16x32_bf16 v[184:187], v[232:235], v[156:159], v[184:187]
    v_exp_f32 v204, v204
    v_exp_f32 v205, v205
    v_mfma_f32_16x16x32_bf16 v[188:191], v[232:235], v[172:175], v[188:191]
    ds_read_b128 v[224:227], v5 offset:22528
    v_cvt_pk_bf16_f32 v65, v202, v203
    s_waitcnt lgkmcnt(3)
    v_mfma_f32_16x16x32_bf16 v[192:195], v[236:239], v[156:159], v[192:195]
    v_exp_f32 v206, v206
    v_exp_f32 v207, v207
    v_mfma_f32_16x16x32_bf16 v[196:199], v[236:239], v[172:175], v[196:199]
    ds_read_b128 v[228:231], v5 offset:23552
    v_cvt_pk_bf16_f32 v68, v204, v205
    v_exp_f32 v208, v208
    s_waitcnt lgkmcnt(3)
    v_mfma_f32_16x16x32_bf16 v[184:187], v[240:243], v[160:163], v[184:187]
    v_exp_f32 v209, v209
    v_mfma_f32_16x16x32_bf16 v[188:191], v[240:243], v[176:179], v[188:191]
    ds_read_b128 v[232:235], v5 offset:24576
    v_cvt_pk_bf16_f32 v69, v206, v207
    v_exp_f32 v210, v210
    s_waitcnt lgkmcnt(3)
    v_mfma_f32_16x16x32_bf16 v[192:195], v[244:247], v[160:163], v[192:195]
    v_exp_f32 v211, v211
    v_mfma_f32_16x16x32_bf16 v[196:199], v[244:247], v[176:179], v[196:199]
    ds_read_b128 v[236:239], v5 offset:25600
    v_cvt_pk_bf16_f32 v66, v208, v209
    v_exp_f32 v212, v212
    s_waitcnt lgkmcnt(3)
    v_mfma_f32_16x16x32_bf16 v[184:187], v[224:227], v[164:167], v[184:187]
    v_exp_f32 v213, v213
    v_cvt_pk_bf16_f32 v67, v210, v211
    v_mfma_f32_16x16x32_bf16 v[188:191], v[224:227], v[180:183], v[188:191]
    ds_read_b128 v[240:243], v5 offset:26624
    v_exp_f32 v214, v214
    s_waitcnt lgkmcnt(3)
    v_mfma_f32_16x16x32_bf16 v[192:195], v[228:231], v[164:167], v[192:195]
    v_exp_f32 v215, v215
    v_cvt_pk_bf16_f32 v70, v212, v213
    v_mfma_f32_16x16x32_bf16 v[196:199], v[228:231], v[180:183], v[196:199]
    ds_read_b128 v[244:247], v5 offset:27648
    v_cvt_pk_bf16_f32 v71, v214, v215
    s_waitcnt lgkmcnt(3)
    v_mfma_f32_16x16x32_bf16 v[200:203], v[232:235], v[152:155], v[216:219]
    v_mfma_f32_16x16x32_bf16 v[204:207], v[232:235], v[168:171], v[220:223]
    ds_read_b128 v[224:227], v5 offset:28672
    v_exp_f32 v184, v184
    v_exp_f32 v185, v185
    v_mfma_f32_16x16x32_bf16 v[248:251], v[12:15], v[64:67], v[248:251]
    s_waitcnt lgkmcnt(3)
    v_mfma_f32_16x16x32_bf16 v[208:211], v[236:239], v[152:155], v[216:219]
    v_exp_f32 v186, v186
    v_exp_f32 v187, v187
    v_mfma_f32_16x16x32_bf16 v[212:215], v[236:239], v[168:171], v[220:223]
    ds_read_b128 v[228:231], v5 offset:29696
    v_cvt_pk_bf16_f32 v72, v184, v185
    v_mfma_f32_16x16x32_bf16 v[252:255], v[12:15], v[68:71], v[252:255]
    s_waitcnt lgkmcnt(3)
    v_mfma_f32_16x16x32_bf16 v[200:203], v[240:243], v[156:159], v[200:203]
    v_exp_f32 v188, v188
    v_exp_f32 v189, v189
    v_mfma_f32_16x16x32_bf16 v[204:207], v[240:243], v[172:175], v[204:207]
    ds_read_b128 v[232:235], v5 offset:30720
    v_cvt_pk_bf16_f32 v73, v186, v187
    s_waitcnt lgkmcnt(3)
    v_mfma_f32_16x16x32_bf16 v[208:211], v[244:247], v[156:159], v[208:211]
    v_exp_f32 v190, v190
    v_exp_f32 v191, v191
    v_mfma_f32_16x16x32_bf16 v[212:215], v[244:247], v[172:175], v[212:215]
    ds_read_b128 v[236:239], v5 offset:31744
    v_cvt_pk_bf16_f32 v76, v188, v189
    v_exp_f32 v192, v192
    s_waitcnt lgkmcnt(3)
    v_mfma_f32_16x16x32_bf16 v[200:203], v[224:227], v[160:163], v[200:203]
    v_exp_f32 v193, v193
    v_mfma_f32_16x16x32_bf16 v[204:207], v[224:227], v[176:179], v[204:207]
    s_waitcnt vmcnt(7)
    s_barrier
    ds_read_b128 v[240:243], v4 offset:0
    v_cvt_pk_bf16_f32 v77, v190, v191
    v_exp_f32 v194, v194
    s_waitcnt lgkmcnt(3)
    v_mfma_f32_16x16x32_bf16 v[208:211], v[228:231], v[160:163], v[208:211]
    v_exp_f32 v195, v195
    v_mfma_f32_16x16x32_bf16 v[212:215], v[228:231], v[176:179], v[212:215]
    s_add_u32 s22, s21, 0x80000
    s_add_u32 m0, s20, 0x20000
    s_nop 0
    buffer_load_dwordx4 v2, s[8:11], s22 offen sc1 lds
    ds_read_b128 v[244:247], v4 offset:1024
    v_cvt_pk_bf16_f32 v74, v192, v193
    v_exp_f32 v196, v196
    s_waitcnt lgkmcnt(3)
    v_mfma_f32_16x16x32_bf16 v[200:203], v[232:235], v[164:167], v[200:203]
    v_exp_f32 v197, v197
    v_cvt_pk_bf16_f32 v75, v194, v195
    v_mfma_f32_16x16x32_bf16 v[204:207], v[232:235], v[180:183], v[204:207]
    ds_read_b128 v[224:227], v4 offset:2048
    v_exp_f32 v198, v198
    s_waitcnt lgkmcnt(3)
    v_mfma_f32_16x16x32_bf16 v[208:211], v[236:239], v[164:167], v[208:211]
    v_exp_f32 v199, v199
    v_cvt_pk_bf16_f32 v78, v196, v197
    v_mfma_f32_16x16x32_bf16 v[212:215], v[236:239], v[180:183], v[212:215]
    ds_read_b128 v[228:231], v4 offset:3072
    v_cvt_pk_bf16_f32 v79, v198, v199
    s_waitcnt lgkmcnt(3)
    v_mfma_f32_16x16x32_bf16 v[184:187], v[240:243], v[152:155], v[216:219]
    v_mfma_f32_16x16x32_bf16 v[188:191], v[240:243], v[168:171], v[220:223]
    ds_read_b128 v[232:235], v4 offset:4096
    v_exp_f32 v200, v200
    v_exp_f32 v201, v201
    v_mfma_f32_16x16x32_bf16 v[248:251], v[12:15], v[72:75], v[248:251]
    s_waitcnt lgkmcnt(3)
    v_mfma_f32_16x16x32_bf16 v[192:195], v[244:247], v[152:155], v[216:219]
    v_exp_f32 v202, v202
    v_exp_f32 v203, v203
    v_mfma_f32_16x16x32_bf16 v[196:199], v[244:247], v[168:171], v[220:223]
    s_add_u32 s22, s21, 0x80400
    s_add_u32 m0, s20, 0x20400
    s_nop 0
    buffer_load_dwordx4 v2, s[8:11], s22 offen sc1 lds
    ds_read_b128 v[236:239], v4 offset:5120
    v_cvt_pk_bf16_f32 v80, v200, v201
    v_mfma_f32_16x16x32_bf16 v[252:255], v[12:15], v[76:79], v[252:255]
    s_waitcnt lgkmcnt(3)
    v_mfma_f32_16x16x32_bf16 v[184:187], v[224:227], v[156:159], v[184:187]
    v_exp_f32 v204, v204
    v_exp_f32 v205, v205
    s_add_u32 s22, s18, 0
    s_add_u32 m0, s15, 0
    s_nop 0
    buffer_load_dwordx4 v11, s[64:67], s22 offen lds
    v_mfma_f32_16x16x32_bf16 v[188:191], v[224:227], v[172:175], v[188:191]
    ds_read_b128 v[240:243], v4 offset:6144
    v_cvt_pk_bf16_f32 v81, v202, v203
    s_waitcnt lgkmcnt(3)
    v_mfma_f32_16x16x32_bf16 v[192:195], v[228:231], v[156:159], v[192:195]
    v_exp_f32 v206, v206
    v_exp_f32 v207, v207
    v_mfma_f32_16x16x32_bf16 v[196:199], v[228:231], v[172:175], v[196:199]
    ds_read_b128 v[244:247], v4 offset:7168
    v_cvt_pk_bf16_f32 v84, v204, v205
    v_exp_f32 v208, v208
    s_waitcnt lgkmcnt(3)
    v_mfma_f32_16x16x32_bf16 v[184:187], v[232:235], v[160:163], v[184:187]
    v_exp_f32 v209, v209
    v_mfma_f32_16x16x32_bf16 v[188:191], v[232:235], v[176:179], v[188:191]
    ds_read_b128 v[224:227], v4 offset:8192
    v_cvt_pk_bf16_f32 v85, v206, v207
    v_exp_f32 v210, v210
    s_waitcnt lgkmcnt(3)
    v_mfma_f32_16x16x32_bf16 v[192:195], v[236:239], v[160:163], v[192:195]
    v_exp_f32 v211, v211
    v_mfma_f32_16x16x32_bf16 v[196:199], v[236:239], v[176:179], v[196:199]
    ds_read_b128 v[228:231], v4 offset:9216
    v_cvt_pk_bf16_f32 v82, v208, v209
    v_exp_f32 v212, v212
    s_waitcnt lgkmcnt(3)
    v_mfma_f32_16x16x32_bf16 v[184:187], v[240:243], v[164:167], v[184:187]
    v_exp_f32 v213, v213
    v_cvt_pk_bf16_f32 v83, v210, v211
    v_mfma_f32_16x16x32_bf16 v[188:191], v[240:243], v[180:183], v[188:191]
    ds_read_b128 v[232:235], v4 offset:10240
    v_exp_f32 v214, v214
    s_waitcnt lgkmcnt(3)
    v_mfma_f32_16x16x32_bf16 v[192:195], v[244:247], v[164:167], v[192:195]
    v_exp_f32 v215, v215
    v_cvt_pk_bf16_f32 v86, v212, v213
    v_mfma_f32_16x16x32_bf16 v[196:199], v[244:247], v[180:183], v[196:199]
    ds_read_b128 v[236:239], v4 offset:11264
    v_cvt_pk_bf16_f32 v87, v214, v215
    s_waitcnt lgkmcnt(3)
    v_mfma_f32_16x16x32_bf16 v[200:203], v[224:227], v[152:155], v[216:219]
    v_mfma_f32_16x16x32_bf16 v[204:207], v[224:227], v[168:171], v[220:223]
    ds_read_b128 v[240:243], v4 offset:12288
    v_exp_f32 v184, v184
    v_exp_f32 v185, v185
    v_mfma_f32_16x16x32_bf16 v[248:251], v[12:15], v[80:83], v[248:251]
    s_waitcnt lgkmcnt(3)
    v_mfma_f32_16x16x32_bf16 v[208:211], v[228:231], v[152:155], v[216:219]
    v_exp_f32 v186, v186
    v_exp_f32 v187, v187
    v_mfma_f32_16x16x32_bf16 v[212:215], v[228:231], v[168:171], v[220:223]
    ds_read_b128 v[244:247], v4 offset:13312
    v_cvt_pk_bf16_f32 v88, v184, v185
    s_add_u32 s22, s18, 7168
    s_add_u32 m0, s15, 1024
    s_nop 0
    buffer_load_dwordx4 v11, s[64:67], s22 offen lds
    v_mfma_f32_16x16x32_bf16 v[252:255], v[12:15], v[84:87], v[252:255]
    s_waitcnt lgkmcnt(3)
    v_mfma_f32_16x16x32_bf16 v[200:203], v[232:235], v[156:159], v[200:203]
    v_exp_f32 v188, v188
    v_exp_f32 v189, v189
    v_mfma_f32_16x16x32_bf16 v[204:207], v[232:235], v[172:175], v[204:207]
    ds_read_b128 v[224:227], v4 offset:14336
    v_cvt_pk_bf16_f32 v89, v186, v187
    s_waitcnt lgkmcnt(3)
    v_mfma_f32_16x16x32_bf16 v[208:211], v[236:239], v[156:159], v[208:211]
    v_exp_f32 v190, v190
    v_exp_f32 v191, v191
    v_mfma_f32_16x16x32_bf16 v[212:215], v[236:239], v[172:175], v[212:215]
    ds_read_b128 v[228:231], v4 offset:15360
    v_cvt_pk_bf16_f32 v92, v188, v189
    v_exp_f32 v192, v192
    s_waitcnt lgkmcnt(3)
    v_mfma_f32_16x16x32_bf16 v[200:203], v[240:243], v[160:163], v[200:203]
    v_exp_f32 v193, v193
    v_mfma_f32_16x16x32_bf16 v[204:207], v[240:243], v[176:179], v[204:207]
    s_waitcnt vmcnt(8)
    s_barrier
    ds_read_b128 v[232:235], v4 offset:16384
    v_cvt_pk_bf16_f32 v93, v190, v191
    v_exp_f32 v194, v194
    s_waitcnt lgkmcnt(3)
    v_mfma_f32_16x16x32_bf16 v[208:211], v[244:247], v[160:163], v[208:211]
    v_exp_f32 v195, v195
    v_mfma_f32_16x16x32_bf16 v[212:215], v[244:247], v[176:179], v[212:215]
    s_add_u32 s22, s21, 0x84000
    s_add_u32 m0, s20, 0x24000
    s_nop 0
    buffer_load_dwordx4 v2, s[8:11], s22 offen sc1 lds
    ds_read_b128 v[236:239], v4 offset:17408
    v_cvt_pk_bf16_f32 v90, v192, v193
    v_exp_f32 v196, v196
    s_waitcnt lgkmcnt(3)
    v_mfma_f32_16x16x32_bf16 v[200:203], v[224:227], v[164:167], v[200:203]
    v_exp_f32 v197, v197
    v_cvt_pk_bf16_f32 v91, v194, v195
    v_mfma_f32_16x16x32_bf16 v[204:207], v[224:227], v[180:183], v[204:207]
    ds_read_b128 v[240:243], v4 offset:18432
    v_exp_f32 v198, v198
    s_waitcnt lgkmcnt(3)
    v_mfma_f32_16x16x32_bf16 v[208:211], v[228:231], v[164:167], v[208:211]
    v_exp_f32 v199, v199
    v_cvt_pk_bf16_f32 v94, v196, v197
    v_mfma_f32_16x16x32_bf16 v[212:215], v[228:231], v[180:183], v[212:215]
    ds_read_b128 v[244:247], v4 offset:19456
    v_cvt_pk_bf16_f32 v95, v198, v199
    s_waitcnt lgkmcnt(3)
    v_mfma_f32_16x16x32_bf16 v[184:187], v[232:235], v[152:155], v[216:219]
    v_mfma_f32_16x16x32_bf16 v[188:191], v[232:235], v[168:171], v[220:223]
    ds_read_b128 v[224:227], v4 offset:20480
    v_exp_f32 v200, v200
    v_exp_f32 v201, v201
    v_mfma_f32_16x16x32_bf16 v[248:251], v[12:15], v[88:91], v[248:251]
    s_waitcnt lgkmcnt(3)
    v_mfma_f32_16x16x32_bf16 v[192:195], v[236:239], v[152:155], v[216:219]
    v_exp_f32 v202, v202
    v_exp_f32 v203, v203
    v_mfma_f32_16x16x32_bf16 v[196:199], v[236:239], v[168:171], v[220:223]
    s_add_u32 s22, s21, 0x84400
    s_add_u32 m0, s20, 0x24400
    s_nop 0
    buffer_load_dwordx4 v2, s[8:11], s22 offen sc1 lds
    ds_read_b128 v[228:231], v4 offset:21504
    v_cvt_pk_bf16_f32 v96, v200, v201
    s_add_u32 s22, s18, 14336
    s_add_u32 m0, s15, 2048
    s_nop 0
    buffer_load_dwordx4 v11, s[64:67], s22 offen lds
    v_mfma_f32_16x16x32_bf16 v[252:255], v[12:15], v[92:95], v[252:255]
    s_waitcnt lgkmcnt(3)
    v_mfma_f32_16x16x32_bf16 v[184:187], v[240:243], v[156:159], v[184:187]
    v_exp_f32 v204, v204
    v_exp_f32 v205, v205
    v_mfma_f32_16x16x32_bf16 v[188:191], v[240:243], v[172:175], v[188:191]
    ds_read_b128 v[232:235], v4 offset:22528
    v_cvt_pk_bf16_f32 v97, v202, v203
    s_waitcnt lgkmcnt(3)
    v_mfma_f32_16x16x32_bf16 v[192:195], v[244:247], v[156:159], v[192:195]
    v_exp_f32 v206, v206
    v_exp_f32 v207, v207
    v_mfma_f32_16x16x32_bf16 v[196:199], v[244:247], v[172:175], v[196:199]
    ds_read_b128 v[236:239], v4 offset:23552
    v_cvt_pk_bf16_f32 v100, v204, v205
    v_exp_f32 v208, v208
    s_waitcnt lgkmcnt(3)
    v_mfma_f32_16x16x32_bf16 v[184:187], v[224:227], v[160:163], v[184:187]
    v_exp_f32 v209, v209
    v_mfma_f32_16x16x32_bf16 v[188:191], v[224:227], v[176:179], v[188:191]
    ds_read_b128 v[240:243], v4 offset:24576
    v_cvt_pk_bf16_f32 v101, v206, v207
    v_exp_f32 v210, v210
    s_waitcnt lgkmcnt(3)
    v_mfma_f32_16x16x32_bf16 v[192:195], v[228:231], v[160:163], v[192:195]
    v_exp_f32 v211, v211
    v_mfma_f32_16x16x32_bf16 v[196:199], v[228:231], v[176:179], v[196:199]
    ds_read_b128 v[244:247], v4 offset:25600
    v_cvt_pk_bf16_f32 v98, v208, v209
    v_exp_f32 v212, v212
    s_waitcnt lgkmcnt(3)
    v_mfma_f32_16x16x32_bf16 v[184:187], v[232:235], v[164:167], v[184:187]
    v_exp_f32 v213, v213
    v_cvt_pk_bf16_f32 v99, v210, v211
    v_mfma_f32_16x16x32_bf16 v[188:191], v[232:235], v[180:183], v[188:191]
    ds_read_b128 v[224:227], v4 offset:26624
    v_exp_f32 v214, v214
    s_waitcnt lgkmcnt(3)
    v_mfma_f32_16x16x32_bf16 v[192:195], v[236:239], v[164:167], v[192:195]
    v_exp_f32 v215, v215
    v_cvt_pk_bf16_f32 v102, v212, v213
    v_mfma_f32_16x16x32_bf16 v[196:199], v[236:239], v[180:183], v[196:199]
    ds_read_b128 v[228:231], v4 offset:27648
    v_cvt_pk_bf16_f32 v103, v214, v215
    s_waitcnt lgkmcnt(3)
    v_mfma_f32_16x16x32_bf16 v[200:203], v[240:243], v[152:155], v[216:219]
    v_mfma_f32_16x16x32_bf16 v[204:207], v[240:243], v[168:171], v[220:223]
    ds_read_b128 v[232:235], v4 offset:28672
    v_exp_f32 v184, v184
    v_exp_f32 v185, v185
    v_mfma_f32_16x16x32_bf16 v[248:251], v[12:15], v[96:99], v[248:251]
    s_waitcnt lgkmcnt(3)
    v_mfma_f32_16x16x32_bf16 v[208:211], v[244:247], v[152:155], v[216:219]
    v_exp_f32 v186, v186
    v_exp_f32 v187, v187
    s_add_u32 s22, s18, 21504
    s_add_u32 m0, s15, 3072
    s_nop 0
    buffer_load_dwordx4 v11, s[64:67], s22 offen lds
    v_mfma_f32_16x16x32_bf16 v[212:215], v[244:247], v[168:171], v[220:223]
    ds_read_b128 v[236:239], v4 offset:29696
    v_cvt_pk_bf16_f32 v104, v184, v185
    v_mfma_f32_16x16x32_bf16 v[252:255], v[12:15], v[100:103], v[252:255]
    s_waitcnt lgkmcnt(3)
    v_mfma_f32_16x16x32_bf16 v[200:203], v[224:227], v[156:159], v[200:203]
    v_exp_f32 v188, v188
    v_exp_f32 v189, v189
    v_mfma_f32_16x16x32_bf16 v[204:207], v[224:227], v[172:175], v[204:207]
    ds_read_b128 v[240:243], v4 offset:30720
    v_cvt_pk_bf16_f32 v105, v186, v187
    s_waitcnt lgkmcnt(3)
    v_mfma_f32_16x16x32_bf16 v[208:211], v[228:231], v[156:159], v[208:211]
    v_exp_f32 v190, v190
    v_exp_f32 v191, v191
    v_mfma_f32_16x16x32_bf16 v[212:215], v[228:231], v[172:175], v[212:215]
    ds_read_b128 v[244:247], v4 offset:31744
    v_cvt_pk_bf16_f32 v108, v188, v189
    v_exp_f32 v192, v192
    s_waitcnt lgkmcnt(3)
    v_mfma_f32_16x16x32_bf16 v[200:203], v[232:235], v[160:163], v[200:203]
    v_exp_f32 v193, v193
    v_mfma_f32_16x16x32_bf16 v[204:207], v[232:235], v[176:179], v[204:207]
    s_waitcnt vmcnt(10)
    s_barrier
    ds_read_b128 v[224:227], v4 offset:32768
    v_cvt_pk_bf16_f32 v109, v190, v191
    v_exp_f32 v194, v194
    s_waitcnt lgkmcnt(3)
    v_mfma_f32_16x16x32_bf16 v[208:211], v[236:239], v[160:163], v[208:211]
    v_exp_f32 v195, v195
    v_mfma_f32_16x16x32_bf16 v[212:215], v[236:239], v[176:179], v[212:215]
    s_add_u32 s22, s21, 0x88000
    s_add_u32 m0, s20, 0x10000
    s_nop 0
    buffer_load_dwordx4 v2, s[8:11], s22 offen sc1 lds
    ds_read_b128 v[228:231], v4 offset:33792
    v_cvt_pk_bf16_f32 v106, v192, v193
    v_exp_f32 v196, v196
    s_waitcnt lgkmcnt(3)
    v_mfma_f32_16x16x32_bf16 v[200:203], v[240:243], v[164:167], v[200:203]
    v_exp_f32 v197, v197
    v_cvt_pk_bf16_f32 v107, v194, v195
    v_mfma_f32_16x16x32_bf16 v[204:207], v[240:243], v[180:183], v[204:207]
    ds_read_b128 v[232:235], v4 offset:34816
    v_exp_f32 v198, v198
    s_waitcnt lgkmcnt(3)
    v_mfma_f32_16x16x32_bf16 v[208:211], v[244:247], v[164:167], v[208:211]
    v_exp_f32 v199, v199
    v_cvt_pk_bf16_f32 v110, v196, v197
    v_mfma_f32_16x16x32_bf16 v[212:215], v[244:247], v[180:183], v[212:215]
    ds_read_b128 v[236:239], v4 offset:35840
    v_cvt_pk_bf16_f32 v111, v198, v199
    s_waitcnt lgkmcnt(3)
    v_mfma_f32_16x16x32_bf16 v[184:187], v[224:227], v[152:155], v[216:219]
    v_mfma_f32_16x16x32_bf16 v[188:191], v[224:227], v[168:171], v[220:223]
    ds_read_b128 v[240:243], v4 offset:36864
    v_exp_f32 v200, v200
    v_exp_f32 v201, v201
    v_mfma_f32_16x16x32_bf16 v[248:251], v[12:15], v[104:107], v[248:251]
    s_waitcnt lgkmcnt(3)
    v_mfma_f32_16x16x32_bf16 v[192:195], v[228:231], v[152:155], v[216:219]
    v_exp_f32 v202, v202
    v_exp_f32 v203, v203
    s_add_u32 s22, s18, 28672
    s_add_u32 m0, s15, 4096
    s_nop 0
    buffer_load_dwordx4 v11, s[64:67], s22 offen lds
    v_mfma_f32_16x16x32_bf16 v[196:199], v[228:231], v[168:171], v[220:223]
    s_add_u32 s22, s21, 0x88400
    s_add_u32 m0, s20, 0x10400
    s_nop 0
    buffer_load_dwordx4 v2, s[8:11], s22 offen sc1 lds
    ds_read_b128 v[244:247], v4 offset:37888
    v_cvt_pk_bf16_f32 v112, v200, v201
    v_mfma_f32_16x16x32_bf16 v[252:255], v[12:15], v[108:111], v[252:255]
    s_waitcnt lgkmcnt(3)
    v_mfma_f32_16x16x32_bf16 v[184:187], v[232:235], v[156:159], v[184:187]
    v_exp_f32 v204, v204
    v_exp_f32 v205, v205
    v_mfma_f32_16x16x32_bf16 v[188:191], v[232:235], v[172:175], v[188:191]
    ds_read_b128 v[224:227], v4 offset:38912
    v_cvt_pk_bf16_f32 v113, v202, v203
    s_waitcnt lgkmcnt(3)
    v_mfma_f32_16x16x32_bf16 v[192:195], v[236:239], v[156:159], v[192:195]
    v_exp_f32 v206, v206
    v_exp_f32 v207, v207
    v_mfma_f32_16x16x32_bf16 v[196:199], v[236:239], v[172:175], v[196:199]
    ds_read_b128 v[228:231], v4 offset:39936
    v_cvt_pk_bf16_f32 v116, v204, v205
    v_exp_f32 v208, v208
    s_waitcnt lgkmcnt(3)
    v_mfma_f32_16x16x32_bf16 v[184:187], v[240:243], v[160:163], v[184:187]
    v_exp_f32 v209, v209
    v_mfma_f32_16x16x32_bf16 v[188:191], v[240:243], v[176:179], v[188:191]
    ds_read_b128 v[232:235], v4 offset:40960
    v_cvt_pk_bf16_f32 v117, v206, v207
    v_exp_f32 v210, v210
    s_waitcnt lgkmcnt(3)
    v_mfma_f32_16x16x32_bf16 v[192:195], v[244:247], v[160:163], v[192:195]
    v_exp_f32 v211, v211
    v_mfma_f32_16x16x32_bf16 v[196:199], v[244:247], v[176:179], v[196:199]
    ds_read_b128 v[236:239], v4 offset:41984
    v_cvt_pk_bf16_f32 v114, v208, v209
    v_exp_f32 v212, v212
    s_waitcnt lgkmcnt(3)
    v_mfma_f32_16x16x32_bf16 v[184:187], v[224:227], v[164:167], v[184:187]
    v_exp_f32 v213, v213
    v_cvt_pk_bf16_f32 v115, v210, v211
    v_mfma_f32_16x16x32_bf16 v[188:191], v[224:227], v[180:183], v[188:191]
    ds_read_b128 v[240:243], v4 offset:43008
    v_exp_f32 v214, v214
    s_waitcnt lgkmcnt(3)
    v_mfma_f32_16x16x32_bf16 v[192:195], v[228:231], v[164:167], v[192:195]
    v_exp_f32 v215, v215
    v_cvt_pk_bf16_f32 v118, v212, v213
    v_mfma_f32_16x16x32_bf16 v[196:199], v[228:231], v[180:183], v[196:199]
    ds_read_b128 v[244:247], v4 offset:44032
    v_cvt_pk_bf16_f32 v119, v214, v215
    s_waitcnt lgkmcnt(3)
    v_mfma_f32_16x16x32_bf16 v[200:203], v[232:235], v[152:155], v[216:219]
    v_mfma_f32_16x16x32_bf16 v[204:207], v[232:235], v[168:171], v[220:223]
    ds_read_b128 v[224:227], v4 offset:45056
    v_exp_f32 v184, v184
    v_exp_f32 v185, v185
    s_add_u32 s22, s18, 35840
    s_add_u32 m0, s15, 5120
    s_nop 0
    buffer_load_dwordx4 v11, s[64:67], s22 offen lds
    v_mfma_f32_16x16x32_bf16 v[248:251], v[12:15], v[112:115], v[248:251]
    s_waitcnt lgkmcnt(3)
    v_mfma_f32_16x16x32_bf16 v[208:211], v[236:239], v[152:155], v[216:219]
    v_exp_f32 v186, v186
    v_exp_f32 v187, v187
    v_mfma_f32_16x16x32_bf16 v[212:215], v[236:239], v[168:171], v[220:223]
    ds_read_b128 v[228:231], v4 offset:46080
    v_cvt_pk_bf16_f32 v120, v184, v185
    v_mfma_f32_16x16x32_bf16 v[252:255], v[12:15], v[116:119], v[252:255]
    s_waitcnt lgkmcnt(3)
    v_mfma_f32_16x16x32_bf16 v[200:203], v[240:243], v[156:159], v[200:203]
    v_exp_f32 v188, v188
    v_exp_f32 v189, v189
    v_mfma_f32_16x16x32_bf16 v[204:207], v[240:243], v[172:175], v[204:207]
    ds_read_b128 v[232:235], v4 offset:47104
    v_cvt_pk_bf16_f32 v121, v186, v187
    s_waitcnt lgkmcnt(3)
    v_mfma_f32_16x16x32_bf16 v[208:211], v[244:247], v[156:159], v[208:211]
    v_exp_f32 v190, v190
    v_exp_f32 v191, v191
    v_mfma_f32_16x16x32_bf16 v[212:215], v[244:247], v[172:175], v[212:215]
    ds_read_b128 v[236:239], v4 offset:48128
    v_cvt_pk_bf16_f32 v124, v188, v189
    v_exp_f32 v192, v192
    s_waitcnt lgkmcnt(3)
    v_mfma_f32_16x16x32_bf16 v[200:203], v[224:227], v[160:163], v[200:203]
    v_exp_f32 v193, v193
    v_mfma_f32_16x16x32_bf16 v[204:207], v[224:227], v[176:179], v[204:207]
    s_waitcnt vmcnt(12)
    s_barrier
    ds_read_b128 v[240:243], v4 offset:49152
    v_cvt_pk_bf16_f32 v125, v190, v191
    v_exp_f32 v194, v194
    s_waitcnt lgkmcnt(3)
    v_mfma_f32_16x16x32_bf16 v[208:211], v[228:231], v[160:163], v[208:211]
    v_exp_f32 v195, v195
    v_mfma_f32_16x16x32_bf16 v[212:215], v[228:231], v[176:179], v[212:215]
    s_add_u32 s22, s21, 0x8c000
    s_add_u32 m0, s20, 0x14000
    s_nop 0
    buffer_load_dwordx4 v2, s[8:11], s22 offen sc1 lds
    ds_read_b128 v[244:247], v4 offset:50176
    v_cvt_pk_bf16_f32 v122, v192, v193
    v_exp_f32 v196, v196
    s_waitcnt lgkmcnt(3)
    v_mfma_f32_16x16x32_bf16 v[200:203], v[232:235], v[164:167], v[200:203]
    v_exp_f32 v197, v197
    v_cvt_pk_bf16_f32 v123, v194, v195
    v_mfma_f32_16x16x32_bf16 v[204:207], v[232:235], v[180:183], v[204:207]
    ds_read_b128 v[224:227], v4 offset:51200
    v_exp_f32 v198, v198
    s_waitcnt lgkmcnt(3)
    v_mfma_f32_16x16x32_bf16 v[208:211], v[236:239], v[164:167], v[208:211]
    v_exp_f32 v199, v199
    v_cvt_pk_bf16_f32 v126, v196, v197
    v_mfma_f32_16x16x32_bf16 v[212:215], v[236:239], v[180:183], v[212:215]
    ds_read_b128 v[228:231], v4 offset:52224
    v_cvt_pk_bf16_f32 v127, v198, v199
    s_waitcnt lgkmcnt(3)
    v_mfma_f32_16x16x32_bf16 v[184:187], v[240:243], v[152:155], v[216:219]
    v_mfma_f32_16x16x32_bf16 v[188:191], v[240:243], v[168:171], v[220:223]
    ds_read_b128 v[232:235], v4 offset:53248
    v_exp_f32 v200, v200
    v_exp_f32 v201, v201
    s_add_u32 s22, s18, 43008
    s_add_u32 m0, s15, 6144
    s_nop 0
    buffer_load_dwordx4 v11, s[64:67], s22 offen lds
    v_mfma_f32_16x16x32_bf16 v[248:251], v[12:15], v[120:123], v[248:251]
    s_waitcnt lgkmcnt(3)
    v_mfma_f32_16x16x32_bf16 v[192:195], v[244:247], v[152:155], v[216:219]
    v_exp_f32 v202, v202
    v_exp_f32 v203, v203
    v_mfma_f32_16x16x32_bf16 v[196:199], v[244:247], v[168:171], v[220:223]
    s_add_u32 s22, s21, 0x8c400
    s_add_u32 m0, s20, 0x14400
    s_nop 0
    buffer_load_dwordx4 v2, s[8:11], s22 offen sc1 lds
    ds_read_b128 v[236:239], v4 offset:54272
    v_cvt_pk_bf16_f32 v128, v200, v201
    v_mfma_f32_16x16x32_bf16 v[252:255], v[12:15], v[124:127], v[252:255]
    s_waitcnt lgkmcnt(3)
    v_mfma_f32_16x16x32_bf16 v[184:187], v[224:227], v[156:159], v[184:187]
    v_exp_f32 v204, v204
    v_exp_f32 v205, v205
    v_mfma_f32_16x16x32_bf16 v[188:191], v[224:227], v[172:175], v[188:191]
    ds_read_b128 v[240:243], v4 offset:55296
    v_cvt_pk_bf16_f32 v129, v202, v203
    s_waitcnt lgkmcnt(3)
    v_mfma_f32_16x16x32_bf16 v[192:195], v[228:231], v[156:159], v[192:195]
    v_exp_f32 v206, v206
    v_exp_f32 v207, v207
    v_mfma_f32_16x16x32_bf16 v[196:199], v[228:231], v[172:175], v[196:199]
    ds_read_b128 v[244:247], v4 offset:56320
    v_cvt_pk_bf16_f32 v132, v204, v205
    v_exp_f32 v208, v208
    s_waitcnt lgkmcnt(3)
    v_mfma_f32_16x16x32_bf16 v[184:187], v[232:235], v[160:163], v[184:187]
    v_exp_f32 v209, v209
    v_mfma_f32_16x16x32_bf16 v[188:191], v[232:235], v[176:179], v[188:191]
    ds_read_b128 v[224:227], v4 offset:57344
    v_cvt_pk_bf16_f32 v133, v206, v207
    v_exp_f32 v210, v210
    s_waitcnt lgkmcnt(3)
    v_mfma_f32_16x16x32_bf16 v[192:195], v[236:239], v[160:163], v[192:195]
    v_exp_f32 v211, v211
    v_mfma_f32_16x16x32_bf16 v[196:199], v[236:239], v[176:179], v[196:199]
    ds_read_b128 v[228:231], v4 offset:58368
    v_cvt_pk_bf16_f32 v130, v208, v209
    v_exp_f32 v212, v212
    s_waitcnt lgkmcnt(3)
    v_mfma_f32_16x16x32_bf16 v[184:187], v[240:243], v[164:167], v[184:187]
    v_exp_f32 v213, v213
    v_cvt_pk_bf16_f32 v131, v210, v211
    v_mfma_f32_16x16x32_bf16 v[188:191], v[240:243], v[180:183], v[188:191]
    ds_read_b128 v[232:235], v4 offset:59392
    v_exp_f32 v214, v214
    s_waitcnt lgkmcnt(3)
    v_mfma_f32_16x16x32_bf16 v[192:195], v[244:247], v[164:167], v[192:195]
    v_exp_f32 v215, v215
    v_cvt_pk_bf16_f32 v134, v212, v213
    v_mfma_f32_16x16x32_bf16 v[196:199], v[244:247], v[180:183], v[196:199]
    ds_read_b128 v[236:239], v4 offset:60416
    v_cvt_pk_bf16_f32 v135, v214, v215
    s_waitcnt lgkmcnt(3)
    v_mfma_f32_16x16x32_bf16 v[200:203], v[224:227], v[152:155], v[216:219]
    s_add_u32 s22, s18, 50176
    s_add_u32 m0, s15, 7168
    s_nop 0
    buffer_load_dwordx4 v11, s[64:67], s22 offen lds
    v_mfma_f32_16x16x32_bf16 v[204:207], v[224:227], v[168:171], v[220:223]
    ds_read_b128 v[240:243], v4 offset:61440
    v_exp_f32 v184, v184
    v_exp_f32 v185, v185
    v_mfma_f32_16x16x32_bf16 v[248:251], v[12:15], v[128:131], v[248:251]
    s_waitcnt lgkmcnt(3)
    v_mfma_f32_16x16x32_bf16 v[208:211], v[228:231], v[152:155], v[216:219]
    v_exp_f32 v186, v186
    v_exp_f32 v187, v187
    v_mfma_f32_16x16x32_bf16 v[212:215], v[228:231], v[168:171], v[220:223]
    ds_read_b128 v[244:247], v4 offset:62464
    v_cvt_pk_bf16_f32 v136, v184, v185
    v_mfma_f32_16x16x32_bf16 v[252:255], v[12:15], v[132:135], v[252:255]
    s_waitcnt lgkmcnt(3)
    v_mfma_f32_16x16x32_bf16 v[200:203], v[232:235], v[156:159], v[200:203]
    v_exp_f32 v188, v188
    v_exp_f32 v189, v189
    v_mfma_f32_16x16x32_bf16 v[204:207], v[232:235], v[172:175], v[204:207]
    ds_read_b128 v[224:227], v4 offset:63488
    v_cvt_pk_bf16_f32 v137, v186, v187
    s_waitcnt lgkmcnt(3)
    v_mfma_f32_16x16x32_bf16 v[208:211], v[236:239], v[156:159], v[208:211]
    v_exp_f32 v190, v190
    v_exp_f32 v191, v191
    v_mfma_f32_16x16x32_bf16 v[212:215], v[236:239], v[172:175], v[212:215]
    ds_read_b128 v[228:231], v4 offset:64512
    v_cvt_pk_bf16_f32 v140, v188, v189
    v_exp_f32 v192, v192
    s_waitcnt lgkmcnt(3)
    v_mfma_f32_16x16x32_bf16 v[200:203], v[240:243], v[160:163], v[200:203]
    v_exp_f32 v193, v193
    v_mfma_f32_16x16x32_bf16 v[204:207], v[240:243], v[176:179], v[204:207]
    v_cvt_pk_bf16_f32 v141, v190, v191
    v_exp_f32 v194, v194
    s_waitcnt lgkmcnt(2)
    v_mfma_f32_16x16x32_bf16 v[208:211], v[244:247], v[160:163], v[208:211]
    v_exp_f32 v195, v195
    v_mfma_f32_16x16x32_bf16 v[212:215], v[244:247], v[176:179], v[212:215]
    v_cvt_pk_bf16_f32 v138, v192, v193
    v_exp_f32 v196, v196
    s_waitcnt lgkmcnt(1)
    v_mfma_f32_16x16x32_bf16 v[200:203], v[224:227], v[164:167], v[200:203]
    v_exp_f32 v197, v197
    v_cvt_pk_bf16_f32 v139, v194, v195
    v_mfma_f32_16x16x32_bf16 v[204:207], v[224:227], v[180:183], v[204:207]
    v_exp_f32 v198, v198
    s_waitcnt lgkmcnt(0)
    v_mfma_f32_16x16x32_bf16 v[208:211], v[228:231], v[164:167], v[208:211]
    v_exp_f32 v199, v199
    v_cvt_pk_bf16_f32 v142, v196, v197
    v_mfma_f32_16x16x32_bf16 v[212:215], v[228:231], v[180:183], v[212:215]
    v_cvt_pk_bf16_f32 v143, v198, v199
    s_waitcnt vmcnt(14)
    s_barrier
    ds_read_b128 v[232:235], v5 offset:0
    ds_read_b128 v[236:239], v5 offset:1024
    ds_read_b128 v[240:243], v5 offset:2048
    ds_read_b128 v[244:247], v5 offset:3072
    v_mfma_f32_16x16x32_bf16 v[248:251], v[12:15], v[136:139], v[248:251]
    v_mfma_f32_16x16x32_bf16 v[252:255], v[12:15], v[140:143], v[252:255]
    v_exp_f32 v200, v200
    v_exp_f32 v201, v201
    v_exp_f32 v202, v202
    v_exp_f32 v203, v203
    v_cvt_pk_bf16_f32 v144, v200, v201
    v_exp_f32 v204, v204
    v_exp_f32 v205, v205
    v_cvt_pk_bf16_f32 v145, v202, v203
    v_exp_f32 v206, v206
    v_exp_f32 v207, v207
    v_cvt_pk_bf16_f32 v148, v204, v205
    v_exp_f32 v208, v208
    v_exp_f32 v209, v209
    v_cvt_pk_bf16_f32 v149, v206, v207
    v_exp_f32 v210, v210
    v_exp_f32 v211, v211
    v_cvt_pk_bf16_f32 v146, v208, v209
    v_exp_f32 v212, v212
    v_exp_f32 v213, v213
    v_cvt_pk_bf16_f32 v147, v210, v211
    v_exp_f32 v214, v214
    v_exp_f32 v215, v215
    v_cvt_pk_bf16_f32 v150, v212, v213
    v_cvt_pk_bf16_f32 v151, v214, v215
    v_mfma_f32_16x16x32_bf16 v[248:251], v[12:15], v[144:147], v[248:251]
    s_nop 0
    v_mfma_f32_16x16x32_bf16 v[252:255], v[12:15], v[148:151], v[252:255]
    s_nop 5
    v_mov_b32 v9, v248
    s_nop 0
    v_mov_b32 v10, v252
    v_max_f32 v17, v9, v10
    v_readfirstlane_b32 s17, v8
    s_cmp_eq_u32 s17, s28
    s_cselect_b32 s16, 0, 0x71800000
    v_cmp_ngt_f32 vcc, s16, v17
    v_cmp_u_f32 s[76:77], v9, v10
    s_or_b64 vcc, vcc, s[76:77]
    s_cbranch_vccnz adaLN_cond__sliding_block_cached__moe_arch_mod__prompt_kernel_fixB
adaLN_cond__sliding_block_cached__moe_arch_mod__prompt_kernel_fixBb:
    v_rcp_f32 v9, v9
    v_rcp_f32 v10, v10
    s_lshl_b32 s25, s13, 3
    s_add_u32 s25, s25, s3
    s_lshl_b32 s25, s25, 18
    s_lshl_b32 s26, s12, 12
    s_add_u32 s25, s25, s26
    s_add_u32 s25, s25, 0x1000000
    s_add_u32 s26, s25, 131072
    s_lshl_b32 s63, s13, 3
    s_add_u32 s63, s63, s3
    s_lshl_b32 s63, s63, 5
    s_add_u32 s63, s63, s12
    s_lshl_b32 s63, s63, 2
    s_waitcnt lgkmcnt(3)
    v_mfma_f32_16x16x32_bf16 v[184:187], v[232:235], v[24:27], 0
    v_mfma_f32_16x16x32_bf16 v[188:191], v[232:235], v[28:31], 0
    ds_read_b128 v[224:227], v5 offset:4096
    s_waitcnt lgkmcnt(3)
    v_mfma_f32_16x16x32_bf16 v[192:195], v[236:239], v[24:27], 0
    s_add_u32 s22, s21, 0x90000
    s_add_u32 m0, s20, 0x18000
    s_nop 0
    buffer_load_dwordx4 v2, s[8:11], s22 offen sc1 lds
    v_mfma_f32_16x16x32_bf16 v[196:199], v[236:239], v[28:31], 0
    ds_read_b128 v[228:231], v5 offset:5120
    s_waitcnt lgkmcnt(3)
    v_mfma_f32_16x16x32_bf16 v[184:187], v[240:243], v[32:35], v[184:187]
    v_mfma_f32_16x16x32_bf16 v[188:191], v[240:243], v[36:39], v[188:191]
    ds_read_b128 v[232:235], v5 offset:6144
    s_waitcnt lgkmcnt(3)
    v_mfma_f32_16x16x32_bf16 v[192:195], v[244:247], v[32:35], v[192:195]
    v_mfma_f32_16x16x32_bf16 v[196:199], v[244:247], v[36:39], v[196:199]
    ds_read_b128 v[236:239], v5 offset:7168
    s_waitcnt lgkmcnt(3)
    v_mfma_f32_16x16x32_bf16 v[184:187], v[224:227], v[40:43], v[184:187]
    v_mfma_f32_16x16x32_bf16 v[188:191], v[224:227], v[44:47], v[188:191]
    ds_read_b128 v[240:243], v5 offset:8192
    s_waitcnt lgkmcnt(3)
    v_mfma_f32_16x16x32_bf16 v[192:195], v[228:231], v[40:43], v[192:195]
    s_add_u32 s22, s21, 0x90400
    s_add_u32 m0, s20, 0x18400
    s_nop 0
    buffer_load_dwordx4 v2, s[8:11], s22 offen sc1 lds
    v_mfma_f32_16x16x32_bf16 v[196:199], v[228:231], v[44:47], v[196:199]
    ds_read_b128 v[244:247], v5 offset:9216
    s_waitcnt lgkmcnt(3)
    v_mfma_f32_16x16x32_bf16 v[184:187], v[232:235], v[48:51], v[184:187]
    v_mfma_f32_16x16x32_bf16 v[188:191], v[232:235], v[52:55], v[188:191]
    ds_read_b128 v[224:227], v5 offset:10240
    s_waitcnt lgkmcnt(3)
    v_mfma_f32_16x16x32_bf16 v[192:195], v[236:239], v[48:51], v[192:195]
    v_mfma_f32_16x16x32_bf16 v[196:199], v[236:239], v[52:55], v[196:199]
    ds_read_b128 v[228:231], v5 offset:11264
    s_waitcnt lgkmcnt(3)
    v_mfma_f32_16x16x32_bf16 v[184:187], v[240:243], v[56:59], v[184:187]
    v_mfma_f32_16x16x32_bf16 v[188:191], v[240:243], v[60:63], v[188:191]
    ds_read_b128 v[232:235], v5 offset:12288
    s_waitcnt lgkmcnt(3)
    v_mfma_f32_16x16x32_bf16 v[192:195], v[244:247], v[56:59], v[192:195]
    v_mfma_f32_16x16x32_bf16 v[196:199], v[244:247], v[60:63], v[196:199]
    ds_read_b128 v[236:239], v5 offset:13312
    s_waitcnt lgkmcnt(3)
    v_mfma_f32_16x16x32_bf16 v[184:187], v[224:227], v[64:67], v[184:187]
    v_mfma_f32_16x16x32_bf16 v[188:191], v[224:227], v[68:71], v[188:191]
    ds_read_b128 v[240:243], v5 offset:14336
    s_waitcnt lgkmcnt(3)
    v_mfma_f32_16x16x32_bf16 v[192:195], v[228:231], v[64:67], v[192:195]
    v_mfma_f32_16x16x32_bf16 v[196:199], v[228:231], v[68:71], v[196:199]
    ds_read_b128 v[244:247], v5 offset:15360
    s_waitcnt lgkmcnt(3)
    v_mfma_f32_16x16x32_bf16 v[184:187], v[232:235], v[72:75], v[184:187]
    v_mfma_f32_16x16x32_bf16 v[188:191], v[232:235], v[76:79], v[188:191]
    s_waitcnt vmcnt(12)
    s_barrier
    ds_read_b128 v[224:227], v5 offset:16384
    s_waitcnt lgkmcnt(3)
    v_mfma_f32_16x16x32_bf16 v[192:195], v[236:239], v[72:75], v[192:195]
    v_mfma_f32_16x16x32_bf16 v[196:199], v[236:239], v[76:79], v[196:199]
    s_add_u32 s22, s21, 0x94000
    s_add_u32 m0, s20, 0x1c000
    s_nop 0
    buffer_load_dwordx4 v2, s[8:11], s22 offen sc1 lds
    ds_read_b128 v[228:231], v5 offset:17408
    s_waitcnt lgkmcnt(3)
    v_mfma_f32_16x16x32_bf16 v[184:187], v[240:243], v[80:83], v[184:187]
    v_mfma_f32_16x16x32_bf16 v[188:191], v[240:243], v[84:87], v[188:191]
    ds_read_b128 v[232:235], v5 offset:18432
    s_waitcnt lgkmcnt(3)
    v_mfma_f32_16x16x32_bf16 v[192:195], v[244:247], v[80:83], v[192:195]
    v_mfma_f32_16x16x32_bf16 v[196:199], v[244:247], v[84:87], v[196:199]
    ds_read_b128 v[236:239], v5 offset:19456
    s_waitcnt lgkmcnt(3)
    v_mfma_f32_16x16x32_bf16 v[184:187], v[224:227], v[88:91], v[184:187]
    v_mfma_f32_16x16x32_bf16 v[188:191], v[224:227], v[92:95], v[188:191]
    ds_read_b128 v[240:243], v5 offset:20480
    s_waitcnt lgkmcnt(3)
    v_mfma_f32_16x16x32_bf16 v[192:195], v[228:231], v[88:91], v[192:195]
    v_mfma_f32_16x16x32_bf16 v[196:199], v[228:231], v[92:95], v[196:199]
    s_add_u32 s22, s21, 0x94400
    s_add_u32 m0, s20, 0x1c400
    s_nop 0
    buffer_load_dwordx4 v2, s[8:11], s22 offen sc1 lds
    ds_read_b128 v[244:247], v5 offset:21504
    s_waitcnt lgkmcnt(3)
    v_mfma_f32_16x16x32_bf16 v[184:187], v[232:235], v[96:99], v[184:187]
    v_mfma_f32_16x16x32_bf16 v[188:191], v[232:235], v[100:103], v[188:191]
    ds_read_b128 v[224:227], v5 offset:22528
    s_waitcnt lgkmcnt(3)
    v_mfma_f32_16x16x32_bf16 v[192:195], v[236:239], v[96:99], v[192:195]
    v_mfma_f32_16x16x32_bf16 v[196:199], v[236:239], v[100:103], v[196:199]
    ds_read_b128 v[228:231], v5 offset:23552
    s_waitcnt lgkmcnt(3)
    v_mfma_f32_16x16x32_bf16 v[184:187], v[240:243], v[104:107], v[184:187]
    v_mfma_f32_16x16x32_bf16 v[188:191], v[240:243], v[108:111], v[188:191]
    ds_read_b128 v[232:235], v5 offset:24576
    s_waitcnt lgkmcnt(3)
    v_mfma_f32_16x16x32_bf16 v[192:195], v[244:247], v[104:107], v[192:195]
    v_mfma_f32_16x16x32_bf16 v[196:199], v[244:247], v[108:111], v[196:199]
    ds_read_b128 v[236:239], v5 offset:25600
    s_waitcnt lgkmcnt(3)
    v_mfma_f32_16x16x32_bf16 v[184:187], v[224:227], v[112:115], v[184:187]
    v_mfma_f32_16x16x32_bf16 v[188:191], v[224:227], v[116:119], v[188:191]
    ds_read_b128 v[240:243], v5 offset:26624
    s_waitcnt lgkmcnt(3)
    v_mfma_f32_16x16x32_bf16 v[192:195], v[228:231], v[112:115], v[192:195]
    v_mfma_f32_16x16x32_bf16 v[196:199], v[228:231], v[116:119], v[196:199]
    ds_read_b128 v[244:247], v5 offset:27648
    s_waitcnt lgkmcnt(3)
    v_mfma_f32_16x16x32_bf16 v[184:187], v[232:235], v[120:123], v[184:187]
    v_mfma_f32_16x16x32_bf16 v[188:191], v[232:235], v[124:127], v[188:191]
    ds_read_b128 v[224:227], v5 offset:28672
    s_waitcnt lgkmcnt(3)
    v_mfma_f32_16x16x32_bf16 v[192:195], v[236:239], v[120:123], v[192:195]
    v_mfma_f32_16x16x32_bf16 v[196:199], v[236:239], v[124:127], v[196:199]
    ds_read_b128 v[228:231], v5 offset:29696
    s_waitcnt lgkmcnt(3)
    v_mfma_f32_16x16x32_bf16 v[184:187], v[240:243], v[128:131], v[184:187]
    v_mfma_f32_16x16x32_bf16 v[188:191], v[240:243], v[132:135], v[188:191]
    ds_read_b128 v[232:235], v5 offset:30720
    s_waitcnt lgkmcnt(3)
    v_mfma_f32_16x16x32_bf16 v[192:195], v[244:247], v[128:131], v[192:195]
    v_mfma_f32_16x16x32_bf16 v[196:199], v[244:247], v[132:135], v[196:199]
    ds_read_b128 v[236:239], v5 offset:31744
    s_waitcnt lgkmcnt(3)
    v_mfma_f32_16x16x32_bf16 v[184:187], v[224:227], v[136:139], v[184:187]
    v_mfma_f32_16x16x32_bf16 v[188:191], v[224:227], v[140:143], v[188:191]
    s_waitcnt vmcnt(9)
    s_barrier
    ds_read_b128 v[240:243], v4 offset:0
    s_waitcnt lgkmcnt(3)
    v_mfma_f32_16x16x32_bf16 v[192:195], v[228:231], v[136:139], v[192:195]
    v_mfma_f32_16x16x32_bf16 v[196:199], v[228:231], v[140:143], v[196:199]
    s_add_u32 s22, s21, 0x98000
    s_add_u32 m0, s20, 0x20000
    s_nop 0
    buffer_load_dwordx4 v2, s[8:11], s22 offen sc1 lds
    ds_read_b128 v[244:247], v4 offset:1024
    s_waitcnt lgkmcnt(3)
    v_mfma_f32_16x16x32_bf16 v[184:187], v[232:235], v[144:147], v[184:187]
    v_mfma_f32_16x16x32_bf16 v[188:191], v[232:235], v[148:151], v[188:191]
    ds_read_b128 v[224:227], v4 offset:2048
    s_waitcnt lgkmcnt(3)
    v_mfma_f32_16x16x32_bf16 v[192:195], v[236:239], v[144:147], v[192:195]
    v_mfma_f32_16x16x32_bf16 v[196:199], v[236:239], v[148:151], v[196:199]
    ds_read_b128 v[228:231], v4 offset:3072
    s_waitcnt lgkmcnt(3)
    v_mfma_f32_16x16x32_bf16 v[200:203], v[240:243], v[24:27], 0
    v_mfma_f32_16x16x32_bf16 v[204:207], v[240:243], v[28:31], 0
    ds_read_b128 v[232:235], v4 offset:4096
    s_waitcnt lgkmcnt(3)
    v_mfma_f32_16x16x32_bf16 v[208:211], v[244:247], v[24:27], 0
    v_mfma_f32_16x16x32_bf16 v[212:215], v[244:247], v[28:31], 0
    s_add_u32 s22, s21, 0x98400
    s_add_u32 m0, s20, 0x20400
    s_nop 0
    buffer_load_dwordx4 v2, s[8:11], s22 offen sc1 lds
    ds_read_b128 v[236:239], v4 offset:5120
    v_mul_f32 v184, v184, v9
    s_waitcnt lgkmcnt(3)
    v_mfma_f32_16x16x32_bf16 v[200:203], v[224:227], v[32:35], v[200:203]
    v_mul_f32 v185, v185, v9
    v_mfma_f32_16x16x32_bf16 v[204:207], v[224:227], v[36:39], v[204:207]
    ds_read_b128 v[240:243], v4 offset:6144
    v_mul_f32 v186, v186, v9
    s_waitcnt lgkmcnt(3)
    v_mfma_f32_16x16x32_bf16 v[208:211], v[228:231], v[32:35], v[208:211]
    v_mul_f32 v187, v187, v9
    v_mfma_f32_16x16x32_bf16 v[212:215], v[228:231], v[36:39], v[212:215]
    ds_read_b128 v[244:247], v4 offset:7168
    v_mul_f32 v192, v192, v9
    s_waitcnt lgkmcnt(3)
    v_mfma_f32_16x16x32_bf16 v[200:203], v[232:235], v[40:43], v[200:203]
    v_mul_f32 v193, v193, v9
    v_mfma_f32_16x16x32_bf16 v[204:207], v[232:235], v[44:47], v[204:207]
    ds_read_b128 v[224:227], v4 offset:8192
    v_mul_f32 v194, v194, v9
    s_waitcnt lgkmcnt(3)
    v_mfma_f32_16x16x32_bf16 v[208:211], v[236:239], v[40:43], v[208:211]
    v_mul_f32 v195, v195, v9
    v_mfma_f32_16x16x32_bf16 v[212:215], v[236:239], v[44:47], v[212:215]
    ds_read_b128 v[228:231], v4 offset:9216
    v_cvt_pk_bf16_f32 v216, v184, v185
    s_waitcnt lgkmcnt(3)
    v_mfma_f32_16x16x32_bf16 v[200:203], v[240:243], v[48:51], v[200:203]
    v_cvt_pk_bf16_f32 v217, v186, v187
    v_mfma_f32_16x16x32_bf16 v[204:207], v[240:243], v[52:55], v[204:207]
    ds_read_b128 v[232:235], v4 offset:10240
    v_cvt_pk_bf16_f32 v218, v192, v193
    s_waitcnt lgkmcnt(3)
    v_mfma_f32_16x16x32_bf16 v[208:211], v[244:247], v[48:51], v[208:211]
    v_cvt_pk_bf16_f32 v219, v194, v195
    v_mfma_f32_16x16x32_bf16 v[212:215], v[244:247], v[52:55], v[212:215]
    ds_read_b128 v[236:239], v4 offset:11264
    buffer_store_dwordx4 v[216:219], v2, s[8:11], s25 offen offset:0 sc1
    s_waitcnt lgkmcnt(3)
    v_mfma_f32_16x16x32_bf16 v[200:203], v[224:227], v[56:59], v[200:203]
    v_mul_f32 v188, v188, v10
    v_mfma_f32_16x16x32_bf16 v[204:207], v[224:227], v[60:63], v[204:207]
    ds_read_b128 v[240:243], v4 offset:12288
    v_mul_f32 v189, v189, v10
    s_waitcnt lgkmcnt(3)
    v_mfma_f32_16x16x32_bf16 v[208:211], v[228:231], v[56:59], v[208:211]
    v_mul_f32 v190, v190, v10
    v_mfma_f32_16x16x32_bf16 v[212:215], v[228:231], v[60:63], v[212:215]
    ds_read_b128 v[244:247], v4 offset:13312
    v_mul_f32 v191, v191, v10
    s_waitcnt lgkmcnt(3)
    v_mfma_f32_16x16x32_bf16 v[200:203], v[232:235], v[64:67], v[200:203]
    v_mul_f32 v196, v196, v10
    v_mfma_f32_16x16x32_bf16 v[204:207], v[232:235], v[68:71], v[204:207]
    ds_read_b128 v[224:227], v4 offset:14336
    v_mul_f32 v197, v197, v10
    s_waitcnt lgkmcnt(3)
    v_mfma_f32_16x16x32_bf16 v[208:211], v[236:239], v[64:67], v[208:211]
    v_mul_f32 v198, v198, v10
    v_mfma_f32_16x16x32_bf16 v[212:215], v[236:239], v[68:71], v[212:215]
    ds_read_b128 v[228:231], v4 offset:15360
    v_mul_f32 v199, v199, v10
    s_waitcnt lgkmcnt(3)
    v_mfma_f32_16x16x32_bf16 v[200:203], v[240:243], v[72:75], v[200:203]
    v_cvt_pk_bf16_f32 v220, v188, v189
    v_mfma_f32_16x16x32_bf16 v[204:207], v[240:243], v[76:79], v[204:207]
    s_waitcnt vmcnt(8)
    s_barrier
    ds_read_b128 v[232:235], v4 offset:16384
    v_cvt_pk_bf16_f32 v221, v190, v191
    s_waitcnt lgkmcnt(3)
    v_mfma_f32_16x16x32_bf16 v[208:211], v[244:247], v[72:75], v[208:211]
    v_cvt_pk_bf16_f32 v222, v196, v197
    v_mfma_f32_16x16x32_bf16 v[212:215], v[244:247], v[76:79], v[212:215]
    s_add_u32 s22, s21, 0x9c000
    s_add_u32 m0, s20, 0x24000
    s_nop 0
    buffer_load_dwordx4 v2, s[8:11], s22 offen sc1 lds
    ds_read_b128 v[236:239], v4 offset:17408
    v_cvt_pk_bf16_f32 v223, v198, v199
    s_waitcnt lgkmcnt(3)
    v_mfma_f32_16x16x32_bf16 v[200:203], v[224:227], v[80:83], v[200:203]
    buffer_store_dwordx4 v[220:223], v2, s[8:11], s26 offen offset:0 sc1
    v_mfma_f32_16x16x32_bf16 v[204:207], v[224:227], v[84:87], v[204:207]
    ds_read_b128 v[240:243], v4 offset:18432
    s_waitcnt lgkmcnt(3)
    v_mfma_f32_16x16x32_bf16 v[208:211], v[228:231], v[80:83], v[208:211]
    v_mfma_f32_16x16x32_bf16 v[212:215], v[228:231], v[84:87], v[212:215]
    ds_read_b128 v[244:247], v4 offset:19456
    s_waitcnt lgkmcnt(3)
    v_mfma_f32_16x16x32_bf16 v[200:203], v[232:235], v[88:91], v[200:203]
    v_mfma_f32_16x16x32_bf16 v[204:207], v[232:235], v[92:95], v[204:207]
    ds_read_b128 v[224:227], v4 offset:20480
    s_waitcnt lgkmcnt(3)
    v_mfma_f32_16x16x32_bf16 v[208:211], v[236:239], v[88:91], v[208:211]
    v_mfma_f32_16x16x32_bf16 v[212:215], v[236:239], v[92:95], v[212:215]
    s_add_u32 s22, s21, 0x9c400
    s_add_u32 m0, s20, 0x24400
    s_nop 0
    buffer_load_dwordx4 v2, s[8:11], s22 offen sc1 lds
    ds_read_b128 v[228:231], v4 offset:21504
    s_waitcnt lgkmcnt(3)
    v_mfma_f32_16x16x32_bf16 v[200:203], v[240:243], v[96:99], v[200:203]
    v_mfma_f32_16x16x32_bf16 v[204:207], v[240:243], v[100:103], v[204:207]
    ds_read_b128 v[232:235], v4 offset:22528
    s_waitcnt lgkmcnt(3)
    v_mfma_f32_16x16x32_bf16 v[208:211], v[244:247], v[96:99], v[208:211]
    v_mfma_f32_16x16x32_bf16 v[212:215], v[244:247], v[100:103], v[212:215]
    ds_read_b128 v[236:239], v4 offset:23552
    s_waitcnt lgkmcnt(3)
    v_mfma_f32_16x16x32_bf16 v[200:203], v[224:227], v[104:107], v[200:203]
    v_mfma_f32_16x16x32_bf16 v[204:207], v[224:227], v[108:111], v[204:207]
    ds_read_b128 v[240:243], v4 offset:24576
    s_waitcnt lgkmcnt(3)
    v_mfma_f32_16x16x32_bf16 v[208:211], v[228:231], v[104:107], v[208:211]
    v_mfma_f32_16x16x32_bf16 v[212:215], v[228:231], v[108:111], v[212:215]
    ds_read_b128 v[244:247], v4 offset:25600
    s_waitcnt lgkmcnt(3)
    v_mfma_f32_16x16x32_bf16 v[200:203], v[232:235], v[112:115], v[200:203]
    v_mfma_f32_16x16x32_bf16 v[204:207], v[232:235], v[116:119], v[204:207]
    ds_read_b128 v[224:227], v4 offset:26624
    s_waitcnt lgkmcnt(3)
    v_mfma_f32_16x16x32_bf16 v[208:211], v[236:239], v[112:115], v[208:211]
    v_mfma_f32_16x16x32_bf16 v[212:215], v[236:239], v[116:119], v[212:215]
    ds_read_b128 v[228:231], v4 offset:27648
    s_waitcnt lgkmcnt(3)
    v_mfma_f32_16x16x32_bf16 v[200:203], v[240:243], v[120:123], v[200:203]
    v_mfma_f32_16x16x32_bf16 v[204:207], v[240:243], v[124:127], v[204:207]
    ds_read_b128 v[232:235], v4 offset:28672
    s_waitcnt lgkmcnt(3)
    v_mfma_f32_16x16x32_bf16 v[208:211], v[244:247], v[120:123], v[208:211]
    v_mfma_f32_16x16x32_bf16 v[212:215], v[244:247], v[124:127], v[212:215]
    ds_read_b128 v[236:239], v4 offset:29696
    s_waitcnt lgkmcnt(3)
    v_mfma_f32_16x16x32_bf16 v[200:203], v[224:227], v[128:131], v[200:203]
    v_mfma_f32_16x16x32_bf16 v[204:207], v[224:227], v[132:135], v[204:207]
    ds_read_b128 v[240:243], v4 offset:30720
    s_waitcnt lgkmcnt(3)
    v_mfma_f32_16x16x32_bf16 v[208:211], v[228:231], v[128:131], v[208:211]
    v_mfma_f32_16x16x32_bf16 v[212:215], v[228:231], v[132:135], v[212:215]
    ds_read_b128 v[244:247], v4 offset:31744
    s_waitcnt lgkmcnt(3)
    v_mfma_f32_16x16x32_bf16 v[200:203], v[232:235], v[136:139], v[200:203]
    s_waitcnt vmcnt(1)
    s_add_u32 s16, s63, 0x570000
    v_mov_b32 v7, s28
    v_mov_b32 v8, 0
    s_mov_b64 exec, 1
    buffer_store_dword v7, v8, s[8:11], s16 offen sc1
    s_mov_b64 exec, -1
    v_mfma_f32_16x16x32_bf16 v[204:207], v[232:235], v[140:143], v[204:207]
    s_barrier
    ds_read_b128 v[224:227], v4 offset:32768
    s_waitcnt lgkmcnt(3)
    v_mfma_f32_16x16x32_bf16 v[208:211], v[236:239], v[136:139], v[208:211]
    v_mfma_f32_16x16x32_bf16 v[212:215], v[236:239], v[140:143], v[212:215]
    s_add_u32 s22, s24, 0x0
    s_add_u32 m0, s20, 0x10000
    s_nop 0
    buffer_load_dwordx4 v3, s[4:7], s22 offen lds
    ds_read_b128 v[228:231], v4 offset:33792
    s_waitcnt lgkmcnt(3)
    v_mfma_f32_16x16x32_bf16 v[200:203], v[240:243], v[144:147], v[200:203]
    v_mfma_f32_16x16x32_bf16 v[204:207], v[240:243], v[148:151], v[204:207]
    ds_read_b128 v[232:235], v4 offset:34816
    s_waitcnt lgkmcnt(3)
    v_mfma_f32_16x16x32_bf16 v[208:211], v[244:247], v[144:147], v[208:211]
    v_mfma_f32_16x16x32_bf16 v[212:215], v[244:247], v[148:151], v[212:215]
    ds_read_b128 v[236:239], v4 offset:35840
    s_waitcnt lgkmcnt(3)
    v_mfma_f32_16x16x32_bf16 v[184:187], v[224:227], v[24:27], 0
    v_mfma_f32_16x16x32_bf16 v[188:191], v[224:227], v[28:31], 0
    ds_read_b128 v[240:243], v4 offset:36864
    s_waitcnt lgkmcnt(3)
    v_mfma_f32_16x16x32_bf16 v[192:195], v[228:231], v[24:27], 0
    v_mfma_f32_16x16x32_bf16 v[196:199], v[228:231], v[28:31], 0
    s_add_u32 s22, s24, 0x2000
    s_add_u32 m0, s20, 0x10400
    s_nop 0
    buffer_load_dwordx4 v3, s[4:7], s22 offen lds
    ds_read_b128 v[244:247], v4 offset:37888
    v_mul_f32 v200, v200, v9
    s_waitcnt lgkmcnt(3)
    v_mfma_f32_16x16x32_bf16 v[184:187], v[232:235], v[32:35], v[184:187]
    v_mul_f32 v201, v201, v9
    v_mfma_f32_16x16x32_bf16 v[188:191], v[232:235], v[36:39], v[188:191]
    ds_read_b128 v[224:227], v4 offset:38912
    v_mul_f32 v202, v202, v9
    s_waitcnt lgkmcnt(3)
    v_mfma_f32_16x16x32_bf16 v[192:195], v[236:239], v[32:35], v[192:195]
    v_mul_f32 v203, v203, v9
    v_mfma_f32_16x16x32_bf16 v[196:199], v[236:239], v[36:39], v[196:199]
    ds_read_b128 v[228:231], v4 offset:39936
    v_mul_f32 v208, v208, v9
    s_waitcnt lgkmcnt(3)
    v_mfma_f32_16x16x32_bf16 v[184:187], v[240:243], v[40:43], v[184:187]
    v_mul_f32 v209, v209, v9
    v_mfma_f32_16x16x32_bf16 v[188:191], v[240:243], v[44:47], v[188:191]
    ds_read_b128 v[232:235], v4 offset:40960
    v_mul_f32 v210, v210, v9
    s_waitcnt lgkmcnt(3)
    v_mfma_f32_16x16x32_bf16 v[192:195], v[244:247], v[40:43], v[192:195]
    v_mul_f32 v211, v211, v9
    v_mfma_f32_16x16x32_bf16 v[196:199], v[244:247], v[44:47], v[196:199]
    ds_read_b128 v[236:239], v4 offset:41984
    v_cvt_pk_bf16_f32 v216, v200, v201
    s_waitcnt lgkmcnt(3)
    v_mfma_f32_16x16x32_bf16 v[184:187], v[224:227], v[48:51], v[184:187]
    v_cvt_pk_bf16_f32 v217, v202, v203
    v_mfma_f32_16x16x32_bf16 v[188:191], v[224:227], v[52:55], v[188:191]
    ds_read_b128 v[240:243], v4 offset:43008
    v_cvt_pk_bf16_f32 v218, v208, v209
    s_waitcnt lgkmcnt(3)
    v_mfma_f32_16x16x32_bf16 v[192:195], v[228:231], v[48:51], v[192:195]
    v_cvt_pk_bf16_f32 v219, v210, v211
    v_mfma_f32_16x16x32_bf16 v[196:199], v[228:231], v[52:55], v[196:199]
    ds_read_b128 v[244:247], v4 offset:44032
    buffer_store_dwordx4 v[216:219], v2, s[8:11], s25 offen offset:1024 sc1
    s_waitcnt lgkmcnt(3)
    v_mfma_f32_16x16x32_bf16 v[184:187], v[232:235], v[56:59], v[184:187]
    v_mul_f32 v204, v204, v10
    v_mfma_f32_16x16x32_bf16 v[188:191], v[232:235], v[60:63], v[188:191]
    ds_read_b128 v[224:227], v4 offset:45056
    v_mul_f32 v205, v205, v10
    s_waitcnt lgkmcnt(3)
    v_mfma_f32_16x16x32_bf16 v[192:195], v[236:239], v[56:59], v[192:195]
    v_mul_f32 v206, v206, v10
    v_mfma_f32_16x16x32_bf16 v[196:199], v[236:239], v[60:63], v[196:199]
    ds_read_b128 v[228:231], v4 offset:46080
    v_mul_f32 v207, v207, v10
    s_waitcnt lgkmcnt(3)
    v_mfma_f32_16x16x32_bf16 v[184:187], v[240:243], v[64:67], v[184:187]
    v_mul_f32 v212, v212, v10
    v_mfma_f32_16x16x32_bf16 v[188:191], v[240:243], v[68:71], v[188:191]
    ds_read_b128 v[232:235], v4 offset:47104
    v_mul_f32 v213, v213, v10
    s_waitcnt lgkmcnt(3)
    v_mfma_f32_16x16x32_bf16 v[192:195], v[244:247], v[64:67], v[192:195]
    v_mul_f32 v214, v214, v10
    v_mfma_f32_16x16x32_bf16 v[196:199], v[244:247], v[68:71], v[196:199]
    ds_read_b128 v[236:239], v4 offset:48128
    v_mul_f32 v215, v215, v10
    s_waitcnt lgkmcnt(3)
    v_mfma_f32_16x16x32_bf16 v[184:187], v[224:227], v[72:75], v[184:187]
    v_cvt_pk_bf16_f32 v220, v204, v205
    v_mfma_f32_16x16x32_bf16 v[188:191], v[224:227], v[76:79], v[188:191]
    s_barrier
    ds_read_b128 v[240:243], v4 offset:49152
    v_cvt_pk_bf16_f32 v221, v206, v207
    s_waitcnt lgkmcnt(3)
    v_mfma_f32_16x16x32_bf16 v[192:195], v[228:231], v[72:75], v[192:195]
    v_cvt_pk_bf16_f32 v222, v212, v213
    v_mfma_f32_16x16x32_bf16 v[196:199], v[228:231], v[76:79], v[196:199]
    s_add_u32 s22, s24, 0x80000
    s_add_u32 m0, s20, 0x14000
    s_nop 0
    buffer_load_dwordx4 v3, s[4:7], s22 offen lds
    ds_read_b128 v[244:247], v4 offset:50176
    v_cvt_pk_bf16_f32 v223, v214, v215
    s_waitcnt lgkmcnt(3)
    v_mfma_f32_16x16x32_bf16 v[184:187], v[232:235], v[80:83], v[184:187]
    buffer_store_dwordx4 v[220:223], v2, s[8:11], s26 offen offset:1024 sc1
    v_mfma_f32_16x16x32_bf16 v[188:191], v[232:235], v[84:87], v[188:191]
    ds_read_b128 v[224:227], v4 offset:51200
    s_waitcnt lgkmcnt(3)
    v_mfma_f32_16x16x32_bf16 v[192:195], v[236:239], v[80:83], v[192:195]
    v_mfma_f32_16x16x32_bf16 v[196:199], v[236:239], v[84:87], v[196:199]
    ds_read_b128 v[228:231], v4 offset:52224
    s_waitcnt lgkmcnt(3)
    v_mfma_f32_16x16x32_bf16 v[184:187], v[240:243], v[88:91], v[184:187]
    v_mfma_f32_16x16x32_bf16 v[188:191], v[240:243], v[92:95], v[188:191]
    ds_read_b128 v[232:235], v4 offset:53248
    s_waitcnt lgkmcnt(3)
    v_mfma_f32_16x16x32_bf16 v[192:195], v[244:247], v[88:91], v[192:195]
    v_mfma_f32_16x16x32_bf16 v[196:199], v[244:247], v[92:95], v[196:199]
    s_add_u32 s22, s24, 0x82000
    s_add_u32 m0, s20, 0x14400
    s_nop 0
    buffer_load_dwordx4 v3, s[4:7], s22 offen lds
    ds_read_b128 v[236:239], v4 offset:54272
    s_waitcnt lgkmcnt(3)
    v_mfma_f32_16x16x32_bf16 v[184:187], v[224:227], v[96:99], v[184:187]
    v_mfma_f32_16x16x32_bf16 v[188:191], v[224:227], v[100:103], v[188:191]
    ds_read_b128 v[240:243], v4 offset:55296
    s_waitcnt lgkmcnt(3)
    v_mfma_f32_16x16x32_bf16 v[192:195], v[228:231], v[96:99], v[192:195]
    v_mfma_f32_16x16x32_bf16 v[196:199], v[228:231], v[100:103], v[196:199]
    ds_read_b128 v[244:247], v4 offset:56320
    s_waitcnt lgkmcnt(3)
    v_mfma_f32_16x16x32_bf16 v[184:187], v[232:235], v[104:107], v[184:187]
    v_mfma_f32_16x16x32_bf16 v[188:191], v[232:235], v[108:111], v[188:191]
    ds_read_b128 v[224:227], v4 offset:57344
    s_waitcnt lgkmcnt(3)
    v_mfma_f32_16x16x32_bf16 v[192:195], v[236:239], v[104:107], v[192:195]
    v_mfma_f32_16x16x32_bf16 v[196:199], v[236:239], v[108:111], v[196:199]
    ds_read_b128 v[228:231], v4 offset:58368
    s_waitcnt lgkmcnt(3)
    v_mfma_f32_16x16x32_bf16 v[184:187], v[240:243], v[112:115], v[184:187]
    v_mfma_f32_16x16x32_bf16 v[188:191], v[240:243], v[116:119], v[188:191]
    ds_read_b128 v[232:235], v4 offset:59392
    s_waitcnt lgkmcnt(3)
    v_mfma_f32_16x16x32_bf16 v[192:195], v[244:247], v[112:115], v[192:195]
    v_mfma_f32_16x16x32_bf16 v[196:199], v[244:247], v[116:119], v[196:199]
    ds_read_b128 v[236:239], v4 offset:60416
    s_waitcnt lgkmcnt(3)
    v_mfma_f32_16x16x32_bf16 v[184:187], v[224:227], v[120:123], v[184:187]
    v_mfma_f32_16x16x32_bf16 v[188:191], v[224:227], v[124:127], v[188:191]
    ds_read_b128 v[240:243], v4 offset:61440
    s_waitcnt lgkmcnt(3)
    v_mfma_f32_16x16x32_bf16 v[192:195], v[228:231], v[120:123], v[192:195]
    v_mfma_f32_16x16x32_bf16 v[196:199], v[228:231], v[124:127], v[196:199]
    ds_read_b128 v[244:247], v4 offset:62464
    s_waitcnt lgkmcnt(3)
    v_mfma_f32_16x16x32_bf16 v[184:187], v[232:235], v[128:131], v[184:187]
    v_mfma_f32_16x16x32_bf16 v[188:191], v[232:235], v[132:135], v[188:191]
    ds_read_b128 v[224:227], v4 offset:63488
    s_waitcnt lgkmcnt(3)
    v_mfma_f32_16x16x32_bf16 v[192:195], v[236:239], v[128:131], v[192:195]
    v_mfma_f32_16x16x32_bf16 v[196:199], v[236:239], v[132:135], v[196:199]
    ds_read_b128 v[228:231], v4 offset:64512
    s_waitcnt lgkmcnt(3)
    v_mfma_f32_16x16x32_bf16 v[184:187], v[240:243], v[136:139], v[184:187]
    v_mfma_f32_16x16x32_bf16 v[188:191], v[240:243], v[140:143], v[188:191]
    s_barrier
    ds_read_b128 v[232:235], v5 offset:0
    s_waitcnt lgkmcnt(3)
    v_mfma_f32_16x16x32_bf16 v[192:195], v[244:247], v[136:139], v[192:195]
    v_mfma_f32_16x16x32_bf16 v[196:199], v[244:247], v[140:143], v[196:199]
    s_add_u32 s22, s24, 0x100000
    s_add_u32 m0, s20, 0x18000
    s_nop 0
    buffer_load_dwordx4 v3, s[4:7], s22 offen lds
    ds_read_b128 v[236:239], v5 offset:1024
    s_waitcnt lgkmcnt(3)
    v_mfma_f32_16x16x32_bf16 v[184:187], v[224:227], v[144:147], v[184:187]
    v_mfma_f32_16x16x32_bf16 v[188:191], v[224:227], v[148:151], v[188:191]
    ds_read_b128 v[240:243], v5 offset:2048
    s_waitcnt lgkmcnt(3)
    v_mfma_f32_16x16x32_bf16 v[192:195], v[228:231], v[144:147], v[192:195]
    v_mfma_f32_16x16x32_bf16 v[196:199], v[228:231], v[148:151], v[196:199]
    ds_read_b128 v[244:247], v5 offset:3072
    s_waitcnt lgkmcnt(3)
    v_mfma_f32_16x16x32_bf16 v[200:203], v[232:235], v[24:27], 0
    v_mfma_f32_16x16x32_bf16 v[204:207], v[232:235], v[28:31], 0
    ds_read_b128 v[224:227], v5 offset:4096
    s_waitcnt lgkmcnt(3)
    v_mfma_f32_16x16x32_bf16 v[208:211], v[236:239], v[24:27], 0
    v_mfma_f32_16x16x32_bf16 v[212:215], v[236:239], v[28:31], 0
    s_add_u32 s22, s24, 0x102000
    s_add_u32 m0, s20, 0x18400
    s_nop 0
    buffer_load_dwordx4 v3, s[4:7], s22 offen lds
    ds_read_b128 v[228:231], v5 offset:5120
    v_mul_f32 v184, v184, v9
    s_waitcnt lgkmcnt(3)
    v_mfma_f32_16x16x32_bf16 v[200:203], v[240:243], v[32:35], v[200:203]
    v_mul_f32 v185, v185, v9
    s_bfe_u32 s30, s2, 0x20001
    s_lshl_b32 s30, s30, 2
    s_bfe_u32 s17, s2, 0x20003
    s_add_u32 s30, s30, s17
    s_lshr_b32 s31, s2, 5
    s_and_b32 s17, s3, 3
    s_lshl_b32 s19, s30, 2
    s_add_u32 s19, s19, s17
    s_and_b32 s16, s2, 1
    s_lshl_b32 s17, s19, 18
    s_lshl_b32 s23, s16, 16
    s_add_u32 s17, s17, s23
    s_add_u32 s17, s17, 0x1001000
    v_add_u32 v6, s17, v2
    s_lshl_b32 s19, s19, 7
    s_lshl_b32 s23, s16, 6
    s_add_u32 s19, s19, s23
    s_add_u32 s19, s19, 0x570000
    v_and_b32 v13, 15, v1
    v_lshlrev_b32 v13, 2, v13
    buffer_load_dword v12, v13, s[8:11], s19 offen sc1
    v_mfma_f32_16x16x32_bf16 v[204:207], v[240:243], v[36:39], v[204:207]
    ds_read_b128 v[232:235], v5 offset:6144
    v_mul_f32 v186, v186, v9
    s_waitcnt lgkmcnt(3)
    v_mfma_f32_16x16x32_bf16 v[208:211], v[244:247], v[32:35], v[208:211]
    v_mul_f32 v187, v187, v9
    v_mfma_f32_16x16x32_bf16 v[212:215], v[244:247], v[36:39], v[212:215]
    ds_read_b128 v[236:239], v5 offset:7168
    v_mul_f32 v192, v192, v9
    s_waitcnt lgkmcnt(3)
    v_mfma_f32_16x16x32_bf16 v[200:203], v[224:227], v[40:43], v[200:203]
    v_mul_f32 v193, v193, v9
    v_mfma_f32_16x16x32_bf16 v[204:207], v[224:227], v[44:47], v[204:207]
    ds_read_b128 v[240:243], v5 offset:8192
    v_mul_f32 v194, v194, v9
    s_waitcnt lgkmcnt(3)
    v_mfma_f32_16x16x32_bf16 v[208:211], v[228:231], v[40:43], v[208:211]
    v_mul_f32 v195, v195, v9
    v_mfma_f32_16x16x32_bf16 v[212:215], v[228:231], v[44:47], v[212:215]
    ds_read_b128 v[244:247], v5 offset:9216
    v_cvt_pk_bf16_f32 v216, v184, v185
    s_waitcnt lgkmcnt(3)
    v_mfma_f32_16x16x32_bf16 v[200:203], v[232:235], v[48:51], v[200:203]
    v_cvt_pk_bf16_f32 v217, v186, v187
    v_mfma_f32_16x16x32_bf16 v[204:207], v[232:235], v[52:55], v[204:207]
    ds_read_b128 v[224:227], v5 offset:10240
    v_cvt_pk_bf16_f32 v218, v192, v193
    s_waitcnt lgkmcnt(3)
    v_mfma_f32_16x16x32_bf16 v[208:211], v[236:239], v[48:51], v[208:211]
    v_cvt_pk_bf16_f32 v219, v194, v195
    v_mfma_f32_16x16x32_bf16 v[212:215], v[236:239], v[52:55], v[212:215]
    ds_read_b128 v[228:231], v5 offset:11264
    buffer_store_dwordx4 v[216:219], v2, s[8:11], s25 offen offset:2048 sc1
    s_waitcnt lgkmcnt(3)
    v_mfma_f32_16x16x32_bf16 v[200:203], v[240:243], v[56:59], v[200:203]
    v_mul_f32 v188, v188, v10
    v_mfma_f32_16x16x32_bf16 v[204:207], v[240:243], v[60:63], v[204:207]
    ds_read_b128 v[232:235], v5 offset:12288
    v_mul_f32 v189, v189, v10
    s_waitcnt lgkmcnt(3)
    v_mfma_f32_16x16x32_bf16 v[208:211], v[244:247], v[56:59], v[208:211]
    v_mul_f32 v190, v190, v10
    v_mfma_f32_16x16x32_bf16 v[212:215], v[244:247], v[60:63], v[212:215]
    ds_read_b128 v[236:239], v5 offset:13312
    v_mul_f32 v191, v191, v10
    s_waitcnt lgkmcnt(3)
    v_mfma_f32_16x16x32_bf16 v[200:203], v[224:227], v[64:67], v[200:203]
    v_mul_f32 v196, v196, v10
    v_mfma_f32_16x16x32_bf16 v[204:207], v[224:227], v[68:71], v[204:207]
    ds_read_b128 v[240:243], v5 offset:14336
    v_mul_f32 v197, v197, v10
    s_waitcnt lgkmcnt(3)
    v_mfma_f32_16x16x32_bf16 v[208:211], v[228:231], v[64:67], v[208:211]
    v_mul_f32 v198, v198, v10
    v_mfma_f32_16x16x32_bf16 v[212:215], v[228:231], v[68:71], v[212:215]
    ds_read_b128 v[244:247], v5 offset:15360
    v_mul_f32 v199, v199, v10
    s_waitcnt lgkmcnt(3)
    v_mfma_f32_16x16x32_bf16 v[200:203], v[232:235], v[72:75], v[200:203]
    v_cvt_pk_bf16_f32 v220, v188, v189
    v_mfma_f32_16x16x32_bf16 v[204:207], v[232:235], v[76:79], v[204:207]
    s_waitcnt vmcnt(11)
    s_barrier
    ds_read_b128 v[224:227], v5 offset:16384
    v_cvt_pk_bf16_f32 v221, v190, v191
    s_waitcnt lgkmcnt(3)
    v_mfma_f32_16x16x32_bf16 v[208:211], v[236:239], v[72:75], v[208:211]
    v_cvt_pk_bf16_f32 v222, v196, v197
    v_mfma_f32_16x16x32_bf16 v[212:215], v[236:239], v[76:79], v[212:215]
    s_add_u32 s22, s24, 0x180000
    s_add_u32 m0, s20, 0x1c000
    s_nop 0
    buffer_load_dwordx4 v3, s[4:7], s22 offen lds
    ds_read_b128 v[228:231], v5 offset:17408
    v_cvt_pk_bf16_f32 v223, v198, v199
    s_waitcnt lgkmcnt(3)
    v_mfma_f32_16x16x32_bf16 v[200:203], v[240:243], v[80:83], v[200:203]
    buffer_store_dwordx4 v[220:223], v2, s[8:11], s26 offen offset:2048 sc1
    s_waitcnt vmcnt(7)
    s_add_u32 s16, s63, 0x572000
    v_mov_b32 v14, s28
    v_mov_b32 v15, 0
    s_mov_b64 exec, 1
    buffer_store_dword v14, v15, s[8:11], s16 offen sc1
    s_mov_b64 exec, -1
    v_mfma_f32_16x16x32_bf16 v[204:207], v[240:243], v[84:87], v[204:207]
    ds_read_b128 v[232:235], v5 offset:18432
    s_waitcnt lgkmcnt(3)
    v_mfma_f32_16x16x32_bf16 v[208:211], v[244:247], v[80:83], v[208:211]
    v_mfma_f32_16x16x32_bf16 v[212:215], v[244:247], v[84:87], v[212:215]
    ds_read_b128 v[236:239], v5 offset:19456
    s_waitcnt lgkmcnt(3)
    v_mfma_f32_16x16x32_bf16 v[200:203], v[224:227], v[88:91], v[200:203]
    v_mfma_f32_16x16x32_bf16 v[204:207], v[224:227], v[92:95], v[204:207]
    ds_read_b128 v[240:243], v5 offset:20480
    s_waitcnt vmcnt(4)
    v_cmp_ne_u32 vcc, s28, v12
    s_cbranch_vccnz adaLN_cond__sliding_block_cached__moe_arch_mod__prompt_kernel_o17r
adaLN_cond__sliding_block_cached__moe_arch_mod__prompt_kernel_o17b:
    s_waitcnt lgkmcnt(3)
    v_mfma_f32_16x16x32_bf16 v[208:211], v[228:231], v[88:91], v[208:211]
    s_mov_b32 s23, 0x0
    buffer_load_dwordx4 v[24:27], v6, s[8:11], s23 offen offset:0 sc1
    v_mfma_f32_16x16x32_bf16 v[212:215], v[228:231], v[92:95], v[212:215]
    s_add_u32 s22, s24, 0x182000
    s_add_u32 m0, s20, 0x1c400
    s_nop 0
    buffer_load_dwordx4 v3, s[4:7], s22 offen lds
    ds_read_b128 v[244:247], v5 offset:21504
    s_waitcnt lgkmcnt(3)
    v_mfma_f32_16x16x32_bf16 v[200:203], v[232:235], v[96:99], v[200:203]
    v_mfma_f32_16x16x32_bf16 v[204:207], v[232:235], v[100:103], v[204:207]
    ds_read_b128 v[224:227], v5 offset:22528
    s_mov_b32 s23, 0x20000
    buffer_load_dwordx4 v[28:31], v6, s[8:11], s23 offen offset:0 sc1
    s_waitcnt lgkmcnt(3)
    v_mfma_f32_16x16x32_bf16 v[208:211], v[236:239], v[96:99], v[208:211]
    v_mfma_f32_16x16x32_bf16 v[212:215], v[236:239], v[100:103], v[212:215]
    ds_read_b128 v[228:231], v5 offset:23552
    s_waitcnt lgkmcnt(3)
    v_mfma_f32_16x16x32_bf16 v[200:203], v[240:243], v[104:107], v[200:203]
    v_mfma_f32_16x16x32_bf16 v[204:207], v[240:243], v[108:111], v[204:207]
    ds_read_b128 v[232:235], v5 offset:24576
    s_mov_b32 s23, 0x2000
    buffer_load_dwordx4 v[32:35], v6, s[8:11], s23 offen offset:0 sc1
    s_waitcnt lgkmcnt(3)
    v_mfma_f32_16x16x32_bf16 v[208:211], v[244:247], v[104:107], v[208:211]
    v_mfma_f32_16x16x32_bf16 v[212:215], v[244:247], v[108:111], v[212:215]
    ds_read_b128 v[236:239], v5 offset:25600
    s_waitcnt lgkmcnt(3)
    v_mfma_f32_16x16x32_bf16 v[200:203], v[224:227], v[112:115], v[200:203]
    s_mov_b32 s23, 0x22000
    buffer_load_dwordx4 v[36:39], v6, s[8:11], s23 offen offset:0 sc1
    v_mfma_f32_16x16x32_bf16 v[204:207], v[224:227], v[116:119], v[204:207]
    ds_read_b128 v[240:243], v5 offset:26624
    s_waitcnt lgkmcnt(3)
    v_mfma_f32_16x16x32_bf16 v[208:211], v[228:231], v[112:115], v[208:211]
    v_mfma_f32_16x16x32_bf16 v[212:215], v[228:231], v[116:119], v[212:215]
    ds_read_b128 v[244:247], v5 offset:27648
    s_waitcnt lgkmcnt(3)
    v_mfma_f32_16x16x32_bf16 v[200:203], v[232:235], v[120:123], v[200:203]
    s_mov_b32 s23, 0x4000
    buffer_load_dwordx4 v[40:43], v6, s[8:11], s23 offen offset:0 sc1
    v_mfma_f32_16x16x32_bf16 v[204:207], v[232:235], v[124:127], v[204:207]
    ds_read_b128 v[224:227], v5 offset:28672
    s_waitcnt lgkmcnt(3)
    v_mfma_f32_16x16x32_bf16 v[208:211], v[236:239], v[120:123], v[208:211]
    v_mfma_f32_16x16x32_bf16 v[212:215], v[236:239], v[124:127], v[212:215]
    ds_read_b128 v[228:231], v5 offset:29696
    s_waitcnt lgkmcnt(3)
    v_mfma_f32_16x16x32_bf16 v[200:203], v[240:243], v[128:131], v[200:203]
    s_mov_b32 s23, 0x24000
    buffer_load_dwordx4 v[44:47], v6, s[8:11], s23 offen offset:0 sc1
    v_mfma_f32_16x16x32_bf16 v[204:207], v[240:243], v[132:135], v[204:207]
    ds_read_b128 v[232:235], v5 offset:30720
    s_waitcnt lgkmcnt(3)
    v_mfma_f32_16x16x32_bf16 v[208:211], v[244:247], v[128:131], v[208:211]
    v_mfma_f32_16x16x32_bf16 v[212:215], v[244:247], v[132:135], v[212:215]
    ds_read_b128 v[236:239], v5 offset:31744
    s_mov_b32 s23, 0x6000
    buffer_load_dwordx4 v[48:51], v6, s[8:11], s23 offen offset:0 sc1
    s_waitcnt lgkmcnt(3)
    v_mfma_f32_16x16x32_bf16 v[200:203], v[224:227], v[136:139], v[200:203]
    v_bfe_u32 v18, v1, 2, 2
    v_lshrrev_b32 v19, 4, v1
    v_mfma_f32_16x16x32_bf16 v[204:207], v[224:227], v[140:143], v[204:207]
    v_and_b32 v17, 3, v1
    v_lshlrev_b32 v16, 11, v19
    s_waitcnt lgkmcnt(2)
    v_mfma_f32_16x16x32_bf16 v[208:211], v[228:231], v[136:139], v[208:211]
    v_lshl_add_u32 v16, v18, 6, v16
    v_lshl_add_u32 v16, v17, 3, v16
    v_mfma_f32_16x16x32_bf16 v[212:215], v[228:231], v[140:143], v[212:215]
    s_mov_b32 s23, 0x26000
    buffer_load_dwordx4 v[52:55], v6, s[8:11], s23 offen offset:0 sc1
    v_add_u32 v16, 0x12000, v16
    v_and_b32 v19, 1, v19
    s_waitcnt lgkmcnt(1)
    v_mfma_f32_16x16x32_bf16 v[200:203], v[232:235], v[144:147], v[200:203]
    v_lshlrev_b32 v19, 5, v19
    v_sub_u32 v5, v16, v19
    v_mfma_f32_16x16x32_bf16 v[204:207], v[232:235], v[148:151], v[204:207]
    v_add_u32 v4, v16, v19
    v_add_u32 v7, 0x10000, v4
    s_waitcnt lgkmcnt(0)
    v_mfma_f32_16x16x32_bf16 v[208:211], v[236:239], v[144:147], v[208:211]
    v_add_u32 v8, 0x10000, v5
    v_mfma_f32_16x16x32_bf16 v[212:215], v[236:239], v[148:151], v[212:215]
    v_mul_f32 v200, v200, v9
    v_mul_f32 v201, v201, v9
    v_mul_f32 v202, v202, v9
    v_mul_f32 v203, v203, v9
    s_nop 1
    v_mul_f32 v208, v208, v9
    v_mul_f32 v209, v209, v9
    v_mul_f32 v210, v210, v9
    v_mul_f32 v211, v211, v9
    v_cvt_pk_bf16_f32 v216, v200, v201
    v_cvt_pk_bf16_f32 v217, v202, v203
    v_cvt_pk_bf16_f32 v218, v208, v209
    v_cvt_pk_bf16_f32 v219, v210, v211
    buffer_store_dwordx4 v[216:219], v2, s[8:11], s25 offen offset:3072 sc1
    v_mul_f32 v204, v204, v10
    v_mul_f32 v205, v205, v10
    v_mul_f32 v206, v206, v10
    v_mul_f32 v207, v207, v10
    v_mul_f32 v212, v212, v10
    v_mul_f32 v213, v213, v10
    v_mul_f32 v214, v214, v10
    v_mul_f32 v215, v215, v10
    v_cvt_pk_bf16_f32 v220, v204, v205
    v_cvt_pk_bf16_f32 v221, v206, v207
    v_cvt_pk_bf16_f32 v222, v212, v213
    v_cvt_pk_bf16_f32 v223, v214, v215
    buffer_store_dwordx4 v[220:223], v2, s[8:11], s26 offen offset:3072 sc1
    s_and_b32 s15, s2, 1
    s_barrier
    ds_read_b64_tr_b16 v[224:225], v4 offset:0
    ds_read_b64_tr_b16 v[226:227], v4 offset:1024
    ds_read_b64_tr_b16 v[228:229], v5 offset:32
    ds_read_b64_tr_b16 v[230:231], v5 offset:1056
    ds_read_b64_tr_b16 v[232:233], v4 offset:256
    ds_read_b64_tr_b16 v[234:235], v4 offset:1280
    ds_read_b64_tr_b16 v[236:237], v5 offset:288
    ds_read_b64_tr_b16 v[238:239], v5 offset:1312
    s_waitcnt vmcnt(10) lgkmcnt(6)
    v_mfma_f32_16x16x32_bf16 v[88:91], v[224:227], v[24:27], 0
    ds_read_b64_tr_b16 v[240:241], v4 offset:512
    s_waitcnt vmcnt(8)
    v_mfma_f32_16x16x32_bf16 v[92:95], v[224:227], v[28:31], 0
    ds_read_b64_tr_b16 v[242:243], v4 offset:1536
    s_waitcnt lgkmcnt(6)
    v_mfma_f32_16x16x32_bf16 v[96:99], v[228:231], v[24:27], 0
    ds_read_b64_tr_b16 v[244:245], v5 offset:544
    v_mfma_f32_16x16x32_bf16 v[100:103], v[228:231], v[28:31], 0
    ds_read_b64_tr_b16 v[246:247], v5 offset:1568
    s_waitcnt lgkmcnt(6)
    v_mfma_f32_16x16x32_bf16 v[104:107], v[232:235], v[24:27], 0
    ds_read_b64_tr_b16 v[224:225], v4 offset:768
    v_mfma_f32_16x16x32_bf16 v[108:111], v[232:235], v[28:31], 0
    ds_read_b64_tr_b16 v[226:227], v4 offset:1792
    s_waitcnt lgkmcnt(6)
    v_mfma_f32_16x16x32_bf16 v[112:115], v[236:239], v[24:27], 0
    ds_read_b64_tr_b16 v[228:229], v5 offset:800
    v_mfma_f32_16x16x32_bf16 v[116:119], v[236:239], v[28:31], 0
    ds_read_b64_tr_b16 v[230:231], v5 offset:1824
    s_waitcnt lgkmcnt(6)
    v_mfma_f32_16x16x32_bf16 v[120:123], v[240:243], v[24:27], 0
    s_add_u32 s22, s24, 0x200000
    s_add_u32 m0, s20, 0x20000
    s_nop 0
    buffer_load_dwordx4 v3, s[4:7], s22 offen lds
    v_mfma_f32_16x16x32_bf16 v[124:127], v[240:243], v[28:31], 0
    s_barrier
    ds_read_b64_tr_b16 v[232:233], v4 offset:16384
    ds_read_b64_tr_b16 v[234:235], v4 offset:17408
    s_waitcnt lgkmcnt(6)
    v_mfma_f32_16x16x32_bf16 v[128:131], v[244:247], v[24:27], 0
    ds_read_b64_tr_b16 v[236:237], v5 offset:16416
    s_mov_b32 s23, 0x8000
    buffer_load_dwordx4 v[56:59], v6, s[8:11], s23 offen offset:0 sc1
    v_mfma_f32_16x16x32_bf16 v[132:135], v[244:247], v[28:31], 0
    s_add_u32 s22, s24, 0x202000
    s_add_u32 m0, s20, 0x20400
    s_nop 0
    buffer_load_dwordx4 v3, s[4:7], s22 offen lds
    ds_read_b64_tr_b16 v[238:239], v5 offset:17440
    s_waitcnt lgkmcnt(6)
    v_mfma_f32_16x16x32_bf16 v[136:139], v[224:227], v[24:27], 0
    ds_read_b64_tr_b16 v[240:241], v4 offset:16640
    v_mfma_f32_16x16x32_bf16 v[140:143], v[224:227], v[28:31], 0
    ds_read_b64_tr_b16 v[242:243], v4 offset:17664
    s_mov_b32 s23, 0x28000
    buffer_load_dwordx4 v[60:63], v6, s[8:11], s23 offen offset:0 sc1
    s_waitcnt lgkmcnt(6)
    v_mfma_f32_16x16x32_bf16 v[144:147], v[228:231], v[24:27], 0
    ds_read_b64_tr_b16 v[244:245], v5 offset:16672
    v_mfma_f32_16x16x32_bf16 v[148:151], v[228:231], v[28:31], 0
    ds_read_b64_tr_b16 v[246:247], v5 offset:17696
    s_waitcnt vmcnt(11) lgkmcnt(6)
    v_mfma_f32_16x16x32_bf16 v[88:91], v[232:235], v[32:35], v[88:91]
    ds_read_b64_tr_b16 v[224:225], v4 offset:16896
    s_waitcnt vmcnt(10)
    v_mfma_f32_16x16x32_bf16 v[92:95], v[232:235], v[36:39], v[92:95]
    s_add_u32 s22, s24, 0x280000
    s_add_u32 m0, s20, 0x24000
    s_nop 0
    buffer_load_dwordx4 v3, s[4:7], s22 offen lds
    ds_read_b64_tr_b16 v[226:227], v4 offset:17920
    s_waitcnt lgkmcnt(6)
    v_mfma_f32_16x16x32_bf16 v[96:99], v[236:239], v[32:35], v[96:99]
    ds_read_b64_tr_b16 v[228:229], v5 offset:16928
    v_mfma_f32_16x16x32_bf16 v[100:103], v[236:239], v[36:39], v[100:103]
    ds_read_b64_tr_b16 v[230:231], v5 offset:17952
    s_waitcnt lgkmcnt(6)
    v_mfma_f32_16x16x32_bf16 v[104:107], v[240:243], v[32:35], v[104:107]
    s_add_u32 s22, s24, 0x282000
    s_add_u32 m0, s20, 0x24400
    s_nop 0
    buffer_load_dwordx4 v3, s[4:7], s22 offen lds
    ds_read_b64_tr_b16 v[232:233], v4 offset:17152
    v_mfma_f32_16x16x32_bf16 v[108:111], v[240:243], v[36:39], v[108:111]
    ds_read_b64_tr_b16 v[234:235], v4 offset:18176
    s_waitcnt lgkmcnt(6)
    v_mfma_f32_16x16x32_bf16 v[112:115], v[244:247], v[32:35], v[112:115]
    ds_read_b64_tr_b16 v[236:237], v5 offset:17184
    v_mfma_f32_16x16x32_bf16 v[116:119], v[244:247], v[36:39], v[116:119]
    ds_read_b64_tr_b16 v[238:239], v5 offset:18208
    s_waitcnt lgkmcnt(6)
    v_mfma_f32_16x16x32_bf16 v[120:123], v[224:227], v[32:35], v[120:123]
    v_mfma_f32_16x16x32_bf16 v[124:127], v[224:227], v[36:39], v[124:127]
    s_barrier
    ds_read_b64_tr_b16 v[240:241], v4 offset:32768
    ds_read_b64_tr_b16 v[242:243], v4 offset:33792
    s_waitcnt lgkmcnt(6)
    v_mfma_f32_16x16x32_bf16 v[128:131], v[228:231], v[32:35], v[128:131]
    ds_read_b64_tr_b16 v[244:245], v5 offset:32800
    s_mov_b32 s23, 0xa000
    buffer_load_dwordx4 v[24:27], v6, s[8:11], s23 offen offset:0 sc1
    v_mfma_f32_16x16x32_bf16 v[132:135], v[228:231], v[36:39], v[132:135]
    ds_read_b64_tr_b16 v[246:247], v5 offset:33824
    s_waitcnt lgkmcnt(6)
    v_mfma_f32_16x16x32_bf16 v[136:139], v[232:235], v[32:35], v[136:139]
    ds_read_b64_tr_b16 v[224:225], v4 offset:33024
    v_mfma_f32_16x16x32_bf16 v[140:143], v[232:235], v[36:39], v[140:143]
    ds_read_b64_tr_b16 v[226:227], v4 offset:34048
    s_mov_b32 s23, 0x2a000
    buffer_load_dwordx4 v[28:31], v6, s[8:11], s23 offen offset:0 sc1
    s_waitcnt lgkmcnt(6)
    v_mfma_f32_16x16x32_bf16 v[144:147], v[236:239], v[32:35], v[144:147]
    s_add_u32 s16, s63, 0x574000
    v_mov_b32 v14, s28
    v_mov_b32 v15, 0
    s_mov_b64 exec, 1
    buffer_store_dword v14, v15, s[8:11], s16 offen sc1
    s_mov_b64 exec, -1
    ds_read_b64_tr_b16 v[228:229], v5 offset:33056
    v_mfma_f32_16x16x32_bf16 v[148:151], v[236:239], v[36:39], v[148:151]
    ds_read_b64_tr_b16 v[230:231], v5 offset:34080
    s_waitcnt vmcnt(14) lgkmcnt(6)
    v_mfma_f32_16x16x32_bf16 v[88:91], v[240:243], v[40:43], v[88:91]
    ds_read_b64_tr_b16 v[232:233], v4 offset:33280
    s_waitcnt vmcnt(13)
    v_mfma_f32_16x16x32_bf16 v[92:95], v[240:243], v[44:47], v[92:95]
    s_add_u32 s22, s24, 0x300000
    s_add_u32 m0, s20, 0x10000
    s_nop 0
    buffer_load_dwordx4 v3, s[4:7], s22 offen lds
    ds_read_b64_tr_b16 v[234:235], v4 offset:34304
    s_waitcnt lgkmcnt(6)
    v_mfma_f32_16x16x32_bf16 v[96:99], v[244:247], v[40:43], v[96:99]
    ds_read_b64_tr_b16 v[236:237], v5 offset:33312
    v_mfma_f32_16x16x32_bf16 v[100:103], v[244:247], v[44:47], v[100:103]
    ds_read_b64_tr_b16 v[238:239], v5 offset:34336
    s_waitcnt lgkmcnt(6)
    v_mfma_f32_16x16x32_bf16 v[104:107], v[224:227], v[40:43], v[104:107]
    s_add_u32 s22, s24, 0x302000
    s_add_u32 m0, s20, 0x10400
    s_nop 0
    buffer_load_dwordx4 v3, s[4:7], s22 offen lds
    ds_read_b64_tr_b16 v[240:241], v4 offset:33536
    v_mfma_f32_16x16x32_bf16 v[108:111], v[224:227], v[44:47], v[108:111]
    ds_read_b64_tr_b16 v[242:243], v4 offset:34560
    s_waitcnt lgkmcnt(6)
    v_mfma_f32_16x16x32_bf16 v[112:115], v[228:231], v[40:43], v[112:115]
    ds_read_b64_tr_b16 v[244:245], v5 offset:33568
    v_mfma_f32_16x16x32_bf16 v[116:119], v[228:231], v[44:47], v[116:119]
    ds_read_b64_tr_b16 v[246:247], v5 offset:34592
    s_waitcnt lgkmcnt(6)
    v_mfma_f32_16x16x32_bf16 v[120:123], v[232:235], v[40:43], v[120:123]
    v_mfma_f32_16x16x32_bf16 v[124:127], v[232:235], v[44:47], v[124:127]
    s_barrier
    ds_read_b64_tr_b16 v[224:225], v4 offset:49152
    ds_read_b64_tr_b16 v[226:227], v4 offset:50176
    s_add_u32 s19, s19, 8192
    buffer_load_dword v12, v13, s[8:11], s19 offen sc1
    s_waitcnt lgkmcnt(6)
    v_mfma_f32_16x16x32_bf16 v[128:131], v[236:239], v[40:43], v[128:131]
    ds_read_b64_tr_b16 v[228:229], v5 offset:49184
    s_mov_b32 s23, 0xc000
    buffer_load_dwordx4 v[32:35], v6, s[8:11], s23 offen offset:0 sc1
    v_mfma_f32_16x16x32_bf16 v[132:135], v[236:239], v[44:47], v[132:135]
    ds_read_b64_tr_b16 v[230:231], v5 offset:50208
    s_waitcnt lgkmcnt(6)
    v_mfma_f32_16x16x32_bf16 v[136:139], v[240:243], v[40:43], v[136:139]
    ds_read_b64_tr_b16 v[232:233], v4 offset:49408
    v_mfma_f32_16x16x32_bf16 v[140:143], v[240:243], v[44:47], v[140:143]
    ds_read_b64_tr_b16 v[234:235], v4 offset:50432
    s_mov_b32 s23, 0x2c000
    buffer_load_dwordx4 v[36:39], v6, s[8:11], s23 offen offset:0 sc1
    s_waitcnt lgkmcnt(6)
    v_mfma_f32_16x16x32_bf16 v[144:147], v[244:247], v[40:43], v[144:147]
    ds_read_b64_tr_b16 v[236:237], v5 offset:49440
    v_mfma_f32_16x16x32_bf16 v[148:151], v[244:247], v[44:47], v[148:151]
    ds_read_b64_tr_b16 v[238:239], v5 offset:50464
    s_waitcnt vmcnt(17) lgkmcnt(6)
    v_mfma_f32_16x16x32_bf16 v[88:91], v[224:227], v[48:51], v[88:91]
    ds_read_b64_tr_b16 v[240:241], v4 offset:49664
    s_waitcnt vmcnt(16)
    v_mfma_f32_16x16x32_bf16 v[92:95], v[224:227], v[52:55], v[92:95]
    s_add_u32 s22, s24, 0x380000
    s_add_u32 m0, s20, 0x14000
    s_nop 0
    buffer_load_dwordx4 v3, s[4:7], s22 offen lds
    ds_read_b64_tr_b16 v[242:243], v4 offset:50688
    s_waitcnt lgkmcnt(6)
    v_mfma_f32_16x16x32_bf16 v[96:99], v[228:231], v[48:51], v[96:99]
    ds_read_b64_tr_b16 v[244:245], v5 offset:49696
    v_mfma_f32_16x16x32_bf16 v[100:103], v[228:231], v[52:55], v[100:103]
    ds_read_b64_tr_b16 v[246:247], v5 offset:50720
    s_waitcnt lgkmcnt(6)
    v_mfma_f32_16x16x32_bf16 v[104:107], v[232:235], v[48:51], v[104:107]
    s_add_u32 s22, s24, 0x382000
    s_add_u32 m0, s20, 0x14400
    s_nop 0
    buffer_load_dwordx4 v3, s[4:7], s22 offen lds
    ds_read_b64_tr_b16 v[224:225], v4 offset:49920
    v_mfma_f32_16x16x32_bf16 v[108:111], v[232:235], v[52:55], v[108:111]
    ds_read_b64_tr_b16 v[226:227], v4 offset:50944
    s_waitcnt lgkmcnt(6)
    v_mfma_f32_16x16x32_bf16 v[112:115], v[236:239], v[48:51], v[112:115]
    ds_read_b64_tr_b16 v[228:229], v5 offset:49952
    v_mfma_f32_16x16x32_bf16 v[116:119], v[236:239], v[52:55], v[116:119]
    ds_read_b64_tr_b16 v[230:231], v5 offset:50976
    s_waitcnt lgkmcnt(6)
    v_mfma_f32_16x16x32_bf16 v[120:123], v[240:243], v[48:51], v[120:123]
    v_mfma_f32_16x16x32_bf16 v[124:127], v[240:243], v[52:55], v[124:127]
    s_waitcnt vmcnt(13)
    s_barrier
    ds_read_b64_tr_b16 v[232:233], v7 offset:0
    ds_read_b64_tr_b16 v[234:235], v7 offset:1024
    s_waitcnt lgkmcnt(6)
    v_mfma_f32_16x16x32_bf16 v[128:131], v[244:247], v[48:51], v[128:131]
    ds_read_b64_tr_b16 v[236:237], v8 offset:32
    s_mov_b32 s23, 0xe000
    buffer_load_dwordx4 v[40:43], v6, s[8:11], s23 offen offset:0 sc1
    v_mfma_f32_16x16x32_bf16 v[132:135], v[244:247], v[52:55], v[132:135]
    ds_read_b64_tr_b16 v[238:239], v8 offset:1056
    s_waitcnt lgkmcnt(6)
    v_mfma_f32_16x16x32_bf16 v[136:139], v[224:227], v[48:51], v[136:139]
    ds_read_b64_tr_b16 v[240:241], v7 offset:256
    v_mfma_f32_16x16x32_bf16 v[140:143], v[224:227], v[52:55], v[140:143]
    ds_read_b64_tr_b16 v[242:243], v7 offset:1280
    s_mov_b32 s23, 0x2e000
    buffer_load_dwordx4 v[44:47], v6, s[8:11], s23 offen offset:0 sc1
    s_waitcnt lgkmcnt(6)
    v_mfma_f32_16x16x32_bf16 v[144:147], v[228:231], v[48:51], v[144:147]
    ds_read_b64_tr_b16 v[244:245], v8 offset:288
    v_mfma_f32_16x16x32_bf16 v[148:151], v[228:231], v[52:55], v[148:151]
    ds_read_b64_tr_b16 v[246:247], v8 offset:1312
    s_waitcnt vmcnt(6)
    v_cmp_ne_u32 vcc, s28, v12
    s_cbranch_vccnz adaLN_cond__sliding_block_cached__moe_arch_mod__prompt_kernel_o218r
adaLN_cond__sliding_block_cached__moe_arch_mod__prompt_kernel_o218b:
    s_waitcnt lgkmcnt(6)
    v_mfma_f32_16x16x32_bf16 v[88:91], v[232:235], v[56:59], v[88:91]
    ds_read_b64_tr_b16 v[224:225], v7 offset:512
    v_mfma_f32_16x16x32_bf16 v[92:95], v[232:235], v[60:63], v[92:95]
    s_add_u32 s22, s24, 0x10000
    s_add_u32 m0, s20, 0x18000
    s_nop 0
    buffer_load_dwordx4 v3, s[4:7], s22 offen lds
    ds_read_b64_tr_b16 v[226:227], v7 offset:1536
    s_waitcnt lgkmcnt(6)
    v_mfma_f32_16x16x32_bf16 v[96:99], v[236:239], v[56:59], v[96:99]
    ds_read_b64_tr_b16 v[228:229], v8 offset:544
    v_mfma_f32_16x16x32_bf16 v[100:103], v[236:239], v[60:63], v[100:103]
    ds_read_b64_tr_b16 v[230:231], v8 offset:1568
    s_waitcnt lgkmcnt(6)
    v_mfma_f32_16x16x32_bf16 v[104:107], v[240:243], v[56:59], v[104:107]
    s_add_u32 s22, s24, 0x12000
    s_add_u32 m0, s20, 0x18400
    s_nop 0
    buffer_load_dwordx4 v3, s[4:7], s22 offen lds
    ds_read_b64_tr_b16 v[232:233], v7 offset:768
    v_mfma_f32_16x16x32_bf16 v[108:111], v[240:243], v[60:63], v[108:111]
    ds_read_b64_tr_b16 v[234:235], v7 offset:1792
    s_waitcnt lgkmcnt(6)
    v_mfma_f32_16x16x32_bf16 v[112:115], v[244:247], v[56:59], v[112:115]
    ds_read_b64_tr_b16 v[236:237], v8 offset:800
    v_mfma_f32_16x16x32_bf16 v[116:119], v[244:247], v[60:63], v[116:119]
    ds_read_b64_tr_b16 v[238:239], v8 offset:1824
    s_waitcnt lgkmcnt(6)
    v_mfma_f32_16x16x32_bf16 v[120:123], v[224:227], v[56:59], v[120:123]
    v_mfma_f32_16x16x32_bf16 v[124:127], v[224:227], v[60:63], v[124:127]
    s_barrier
    ds_read_b64_tr_b16 v[240:241], v7 offset:16384
    ds_read_b64_tr_b16 v[242:243], v7 offset:17408
    s_waitcnt lgkmcnt(6)
    v_mfma_f32_16x16x32_bf16 v[128:131], v[228:231], v[56:59], v[128:131]
    ds_read_b64_tr_b16 v[244:245], v8 offset:16416
    s_mov_b32 s23, 0x0
    buffer_load_dwordx4 v[48:51], v6, s[8:11], s23 offen offset:1024 sc1
    v_mfma_f32_16x16x32_bf16 v[132:135], v[228:231], v[60:63], v[132:135]
    ds_read_b64_tr_b16 v[246:247], v8 offset:17440
    s_waitcnt lgkmcnt(6)
    v_mfma_f32_16x16x32_bf16 v[136:139], v[232:235], v[56:59], v[136:139]
    ds_read_b64_tr_b16 v[224:225], v7 offset:16640
    v_mfma_f32_16x16x32_bf16 v[140:143], v[232:235], v[60:63], v[140:143]
    ds_read_b64_tr_b16 v[226:227], v7 offset:17664
    s_mov_b32 s23, 0x20000
    buffer_load_dwordx4 v[52:55], v6, s[8:11], s23 offen offset:1024 sc1
    s_waitcnt lgkmcnt(6)
    v_mfma_f32_16x16x32_bf16 v[144:147], v[236:239], v[56:59], v[144:147]
    ds_read_b64_tr_b16 v[228:229], v8 offset:16672
    v_mfma_f32_16x16x32_bf16 v[148:151], v[236:239], v[60:63], v[148:151]
    ds_read_b64_tr_b16 v[230:231], v8 offset:17696
    s_waitcnt lgkmcnt(6)
    v_mfma_f32_16x16x32_bf16 v[88:91], v[240:243], v[24:27], v[88:91]
    ds_read_b64_tr_b16 v[232:233], v7 offset:16896
    v_mfma_f32_16x16x32_bf16 v[92:95], v[240:243], v[28:31], v[92:95]
    s_add_u32 s22, s24, 0x90000
    s_add_u32 m0, s20, 0x1c000
    s_nop 0
    buffer_load_dwordx4 v3, s[4:7], s22 offen lds
    ds_read_b64_tr_b16 v[234:235], v7 offset:17920
    s_waitcnt lgkmcnt(6)
    v_mfma_f32_16x16x32_bf16 v[96:99], v[244:247], v[24:27], v[96:99]
    ds_read_b64_tr_b16 v[236:237], v8 offset:16928
    v_mfma_f32_16x16x32_bf16 v[100:103], v[244:247], v[28:31], v[100:103]
    ds_read_b64_tr_b16 v[238:239], v8 offset:17952
    s_waitcnt lgkmcnt(6)
    v_mfma_f32_16x16x32_bf16 v[104:107], v[224:227], v[24:27], v[104:107]
    s_add_u32 s22, s24, 0x92000
    s_add_u32 m0, s20, 0x1c400
    s_nop 0
    buffer_load_dwordx4 v3, s[4:7], s22 offen lds
    ds_read_b64_tr_b16 v[240:241], v7 offset:17152
    v_mfma_f32_16x16x32_bf16 v[108:111], v[224:227], v[28:31], v[108:111]
    ds_read_b64_tr_b16 v[242:243], v7 offset:18176
    s_waitcnt lgkmcnt(6)
    v_mfma_f32_16x16x32_bf16 v[112:115], v[228:231], v[24:27], v[112:115]
    ds_read_b64_tr_b16 v[244:245], v8 offset:17184
    v_mfma_f32_16x16x32_bf16 v[116:119], v[228:231], v[28:31], v[116:119]
    ds_read_b64_tr_b16 v[246:247], v8 offset:18208
    s_waitcnt lgkmcnt(6)
    v_mfma_f32_16x16x32_bf16 v[120:123], v[232:235], v[24:27], v[120:123]
    v_mfma_f32_16x16x32_bf16 v[124:127], v[232:235], v[28:31], v[124:127]
    s_barrier
    ds_read_b64_tr_b16 v[224:225], v4 offset:0
    ds_read_b64_tr_b16 v[226:227], v4 offset:1024
    s_waitcnt lgkmcnt(6)
    v_mfma_f32_16x16x32_bf16 v[128:131], v[236:239], v[24:27], v[128:131]
    s_add_u32 s16, s63, 0x576000
    v_mov_b32 v14, s28
    v_mov_b32 v15, 0
    s_mov_b64 exec, 1
    buffer_store_dword v14, v15, s[8:11], s16 offen sc1
    s_mov_b64 exec, -1
    ds_read_b64_tr_b16 v[228:229], v5 offset:32
    s_mov_b32 s23, 0x2000
    buffer_load_dwordx4 v[56:59], v6, s[8:11], s23 offen offset:1024 sc1
    v_mfma_f32_16x16x32_bf16 v[132:135], v[236:239], v[28:31], v[132:135]
    ds_read_b64_tr_b16 v[230:231], v5 offset:1056
    s_waitcnt lgkmcnt(6)
    v_mfma_f32_16x16x32_bf16 v[136:139], v[240:243], v[24:27], v[136:139]
    ds_read_b64_tr_b16 v[232:233], v4 offset:256
    v_mfma_f32_16x16x32_bf16 v[140:143], v[240:243], v[28:31], v[140:143]
    ds_read_b64_tr_b16 v[234:235], v4 offset:1280
    s_mov_b32 s23, 0x22000
    buffer_load_dwordx4 v[60:63], v6, s[8:11], s23 offen offset:1024 sc1
    s_waitcnt lgkmcnt(6)
    v_mfma_f32_16x16x32_bf16 v[144:147], v[244:247], v[24:27], v[144:147]
    ds_read_b64_tr_b16 v[236:237], v5 offset:288
    v_mfma_f32_16x16x32_bf16 v[148:151], v[244:247], v[28:31], v[148:151]
    ds_read_b64_tr_b16 v[238:239], v5 offset:1312
    s_waitcnt vmcnt(14) lgkmcnt(6)
    v_mfma_f32_16x16x32_bf16 v[88:91], v[224:227], v[32:35], v[88:91]
    ds_read_b64_tr_b16 v[240:241], v4 offset:512
    s_waitcnt vmcnt(13)
    v_mfma_f32_16x16x32_bf16 v[92:95], v[224:227], v[36:39], v[92:95]
    s_add_u32 s22, s24, 0x110000
    s_add_u32 m0, s20, 0x20000
    s_nop 0
    buffer_load_dwordx4 v3, s[4:7], s22 offen lds
    ds_read_b64_tr_b16 v[242:243], v4 offset:1536
    s_waitcnt lgkmcnt(6)
    v_mfma_f32_16x16x32_bf16 v[96:99], v[228:231], v[32:35], v[96:99]
    ds_read_b64_tr_b16 v[244:245], v5 offset:544
    v_mfma_f32_16x16x32_bf16 v[100:103], v[228:231], v[36:39], v[100:103]
    ds_read_b64_tr_b16 v[246:247], v5 offset:1568
    s_waitcnt lgkmcnt(6)
    v_mfma_f32_16x16x32_bf16 v[104:107], v[232:235], v[32:35], v[104:107]
    s_add_u32 s22, s24, 0x112000
    s_add_u32 m0, s20, 0x20400
    s_nop 0
    buffer_load_dwordx4 v3, s[4:7], s22 offen lds
    ds_read_b64_tr_b16 v[224:225], v4 offset:768
    v_mfma_f32_16x16x32_bf16 v[108:111], v[232:235], v[36:39], v[108:111]
    ds_read_b64_tr_b16 v[226:227], v4 offset:1792
    s_waitcnt lgkmcnt(6)
    v_mfma_f32_16x16x32_bf16 v[112:115], v[236:239], v[32:35], v[112:115]
    ds_read_b64_tr_b16 v[228:229], v5 offset:800
    v_mfma_f32_16x16x32_bf16 v[116:119], v[236:239], v[36:39], v[116:119]
    ds_read_b64_tr_b16 v[230:231], v5 offset:1824
    s_waitcnt lgkmcnt(6)
    v_mfma_f32_16x16x32_bf16 v[120:123], v[240:243], v[32:35], v[120:123]
    v_mfma_f32_16x16x32_bf16 v[124:127], v[240:243], v[36:39], v[124:127]
    s_waitcnt vmcnt(13)
    s_barrier
    ds_read_b64_tr_b16 v[232:233], v4 offset:16384
    ds_read_b64_tr_b16 v[234:235], v4 offset:17408
    s_waitcnt lgkmcnt(6)
    v_mfma_f32_16x16x32_bf16 v[128:131], v[244:247], v[32:35], v[128:131]
    ds_read_b64_tr_b16 v[236:237], v5 offset:16416
    s_mov_b32 s23, 0x4000
    buffer_load_dwordx4 v[24:27], v6, s[8:11], s23 offen offset:1024 sc1
    v_mfma_f32_16x16x32_bf16 v[132:135], v[244:247], v[36:39], v[132:135]
    ds_read_b64_tr_b16 v[238:239], v5 offset:17440
    s_waitcnt lgkmcnt(6)
    v_mfma_f32_16x16x32_bf16 v[136:139], v[224:227], v[32:35], v[136:139]
    ds_read_b64_tr_b16 v[240:241], v4 offset:16640
    v_mfma_f32_16x16x32_bf16 v[140:143], v[224:227], v[36:39], v[140:143]
    ds_read_b64_tr_b16 v[242:243], v4 offset:17664
    s_mov_b32 s23, 0x24000
    buffer_load_dwordx4 v[28:31], v6, s[8:11], s23 offen offset:1024 sc1
    s_waitcnt lgkmcnt(6)
    v_mfma_f32_16x16x32_bf16 v[144:147], v[228:231], v[32:35], v[144:147]
    ds_read_b64_tr_b16 v[244:245], v5 offset:16672
    v_mfma_f32_16x16x32_bf16 v[148:151], v[228:231], v[36:39], v[148:151]
    ds_read_b64_tr_b16 v[246:247], v5 offset:17696
    s_waitcnt vmcnt(14) lgkmcnt(6)
    v_mfma_f32_16x16x32_bf16 v[88:91], v[232:235], v[40:43], v[88:91]
    ds_read_b64_tr_b16 v[224:225], v4 offset:16896
    s_waitcnt vmcnt(13)
    v_mfma_f32_16x16x32_bf16 v[92:95], v[232:235], v[44:47], v[92:95]
    s_add_u32 s22, s24, 0x190000
    s_add_u32 m0, s20, 0x24000
    s_nop 0
    buffer_load_dwordx4 v3, s[4:7], s22 offen lds
    ds_read_b64_tr_b16 v[226:227], v4 offset:17920
    s_waitcnt lgkmcnt(6)
    v_mfma_f32_16x16x32_bf16 v[96:99], v[236:239], v[40:43], v[96:99]
    ds_read_b64_tr_b16 v[228:229], v5 offset:16928
    v_mfma_f32_16x16x32_bf16 v[100:103], v[236:239], v[44:47], v[100:103]
    ds_read_b64_tr_b16 v[230:231], v5 offset:17952
    s_waitcnt lgkmcnt(6)
    v_mfma_f32_16x16x32_bf16 v[104:107], v[240:243], v[40:43], v[104:107]
    s_add_u32 s22, s24, 0x192000
    s_add_u32 m0, s20, 0x24400
    s_nop 0
    buffer_load_dwordx4 v3, s[4:7], s22 offen lds
    ds_read_b64_tr_b16 v[232:233], v4 offset:17152
    v_mfma_f32_16x16x32_bf16 v[108:111], v[240:243], v[44:47], v[108:111]
    ds_read_b64_tr_b16 v[234:235], v4 offset:18176
    s_waitcnt lgkmcnt(6)
    v_mfma_f32_16x16x32_bf16 v[112:115], v[244:247], v[40:43], v[112:115]
    ds_read_b64_tr_b16 v[236:237], v5 offset:17184
    v_mfma_f32_16x16x32_bf16 v[116:119], v[244:247], v[44:47], v[116:119]
    ds_read_b64_tr_b16 v[238:239], v5 offset:18208
    s_waitcnt lgkmcnt(6)
    v_mfma_f32_16x16x32_bf16 v[120:123], v[224:227], v[40:43], v[120:123]
    v_mfma_f32_16x16x32_bf16 v[124:127], v[224:227], v[44:47], v[124:127]
    s_waitcnt vmcnt(13)
    s_barrier
    ds_read_b64_tr_b16 v[240:241], v4 offset:32768
    ds_read_b64_tr_b16 v[242:243], v4 offset:33792
    s_waitcnt lgkmcnt(6)
    v_mfma_f32_16x16x32_bf16 v[128:131], v[228:231], v[40:43], v[128:131]
    ds_read_b64_tr_b16 v[244:245], v5 offset:32800
    s_mov_b32 s23, 0x6000
    buffer_load_dwordx4 v[32:35], v6, s[8:11], s23 offen offset:1024 sc1
    v_mfma_f32_16x16x32_bf16 v[132:135], v[228:231], v[44:47], v[132:135]
    ds_read_b64_tr_b16 v[246:247], v5 offset:33824
    s_waitcnt lgkmcnt(6)
    v_mfma_f32_16x16x32_bf16 v[136:139], v[232:235], v[40:43], v[136:139]
    ds_read_b64_tr_b16 v[224:225], v4 offset:33024
    v_mfma_f32_16x16x32_bf16 v[140:143], v[232:235], v[44:47], v[140:143]
    ds_read_b64_tr_b16 v[226:227], v4 offset:34048
    s_mov_b32 s23, 0x26000
    buffer_load_dwordx4 v[36:39], v6, s[8:11], s23 offen offset:1024 sc1
    s_waitcnt lgkmcnt(6)
    v_mfma_f32_16x16x32_bf16 v[144:147], v[236:239], v[40:43], v[144:147]
    ds_read_b64_tr_b16 v[228:229], v5 offset:33056
    v_mfma_f32_16x16x32_bf16 v[148:151], v[236:239], v[44:47], v[148:151]
    ds_read_b64_tr_b16 v[230:231], v5 offset:34080
    s_waitcnt vmcnt(14) lgkmcnt(6)
    v_mfma_f32_16x16x32_bf16 v[88:91], v[240:243], v[48:51], v[88:91]
    ds_read_b64_tr_b16 v[232:233], v4 offset:33280
    s_waitcnt vmcnt(13)
    v_mfma_f32_16x16x32_bf16 v[92:95], v[240:243], v[52:55], v[92:95]
    s_add_u32 s22, s24, 0x210000
    s_add_u32 m0, s20, 0x10000
    s_nop 0
    buffer_load_dwordx4 v3, s[4:7], s22 offen lds
    ds_read_b64_tr_b16 v[234:235], v4 offset:34304
    s_waitcnt lgkmcnt(6)
    v_mfma_f32_16x16x32_bf16 v[96:99], v[244:247], v[48:51], v[96:99]
    ds_read_b64_tr_b16 v[236:237], v5 offset:33312
    v_mfma_f32_16x16x32_bf16 v[100:103], v[244:247], v[52:55], v[100:103]
    ds_read_b64_tr_b16 v[238:239], v5 offset:34336
    s_waitcnt lgkmcnt(6)
    v_mfma_f32_16x16x32_bf16 v[104:107], v[224:227], v[48:51], v[104:107]
    s_add_u32 s22, s24, 0x212000
    s_add_u32 m0, s20, 0x10400
    s_nop 0
    buffer_load_dwordx4 v3, s[4:7], s22 offen lds
    ds_read_b64_tr_b16 v[240:241], v4 offset:33536
    v_mfma_f32_16x16x32_bf16 v[108:111], v[224:227], v[52:55], v[108:111]
    ds_read_b64_tr_b16 v[242:243], v4 offset:34560
    s_waitcnt lgkmcnt(6)
    v_mfma_f32_16x16x32_bf16 v[112:115], v[228:231], v[48:51], v[112:115]
    ds_read_b64_tr_b16 v[244:245], v5 offset:33568
    v_mfma_f32_16x16x32_bf16 v[116:119], v[228:231], v[52:55], v[116:119]
    ds_read_b64_tr_b16 v[246:247], v5 offset:34592
    s_waitcnt lgkmcnt(6)
    v_mfma_f32_16x16x32_bf16 v[120:123], v[232:235], v[48:51], v[120:123]
    v_mfma_f32_16x16x32_bf16 v[124:127], v[232:235], v[52:55], v[124:127]
    s_waitcnt vmcnt(13)
    s_barrier
    ds_read_b64_tr_b16 v[224:225], v4 offset:49152
    ds_read_b64_tr_b16 v[226:227], v4 offset:50176
    s_waitcnt lgkmcnt(6)
    v_mfma_f32_16x16x32_bf16 v[128:131], v[236:239], v[48:51], v[128:131]
    ds_read_b64_tr_b16 v[228:229], v5 offset:49184
    s_mov_b32 s23, 0x8000
    buffer_load_dwordx4 v[40:43], v6, s[8:11], s23 offen offset:1024 sc1
    v_mfma_f32_16x16x32_bf16 v[132:135], v[236:239], v[52:55], v[132:135]
    ds_read_b64_tr_b16 v[230:231], v5 offset:50208
    s_waitcnt lgkmcnt(6)
    v_mfma_f32_16x16x32_bf16 v[136:139], v[240:243], v[48:51], v[136:139]
    ds_read_b64_tr_b16 v[232:233], v4 offset:49408
    v_mfma_f32_16x16x32_bf16 v[140:143], v[240:243], v[52:55], v[140:143]
    ds_read_b64_tr_b16 v[234:235], v4 offset:50432
    s_mov_b32 s23, 0x28000
    buffer_load_dwordx4 v[44:47], v6, s[8:11], s23 offen offset:1024 sc1
    s_waitcnt lgkmcnt(6)
    v_mfma_f32_16x16x32_bf16 v[144:147], v[244:247], v[48:51], v[144:147]
    ds_read_b64_tr_b16 v[236:237], v5 offset:49440
    v_mfma_f32_16x16x32_bf16 v[148:151], v[244:247], v[52:55], v[148:151]
    ds_read_b64_tr_b16 v[238:239], v5 offset:50464
    s_waitcnt vmcnt(13) lgkmcnt(6)
    v_mfma_f32_16x16x32_bf16 v[88:91], v[224:227], v[56:59], v[88:91]
    ds_read_b64_tr_b16 v[240:241], v4 offset:49664
    s_waitcnt vmcnt(12)
    v_mfma_f32_16x16x32_bf16 v[92:95], v[224:227], v[60:63], v[92:95]
    s_add_u32 s22, s24, 0x290000
    s_add_u32 m0, s20, 0x14000
    s_nop 0
    buffer_load_dwordx4 v3, s[4:7], s22 offen lds
    ds_read_b64_tr_b16 v[242:243], v4 offset:50688
    s_waitcnt lgkmcnt(6)
    v_mfma_f32_16x16x32_bf16 v[96:99], v[228:231], v[56:59], v[96:99]
    ds_read_b64_tr_b16 v[244:245], v5 offset:49696
    v_mfma_f32_16x16x32_bf16 v[100:103], v[228:231], v[60:63], v[100:103]
    ds_read_b64_tr_b16 v[246:247], v5 offset:50720
    s_waitcnt lgkmcnt(6)
    v_mfma_f32_16x16x32_bf16 v[104:107], v[232:235], v[56:59], v[104:107]
    s_add_u32 s22, s24, 0x292000
    s_add_u32 m0, s20, 0x14400
    s_nop 0
    buffer_load_dwordx4 v3, s[4:7], s22 offen lds
    ds_read_b64_tr_b16 v[224:225], v4 offset:49920
    v_mfma_f32_16x16x32_bf16 v[108:111], v[232:235], v[60:63], v[108:111]
    ds_read_b64_tr_b16 v[226:227], v4 offset:50944
    s_waitcnt lgkmcnt(6)
    v_mfma_f32_16x16x32_bf16 v[112:115], v[236:239], v[56:59], v[112:115]
    ds_read_b64_tr_b16 v[228:229], v5 offset:49952
    v_mfma_f32_16x16x32_bf16 v[116:119], v[236:239], v[60:63], v[116:119]
    ds_read_b64_tr_b16 v[230:231], v5 offset:50976
    s_waitcnt lgkmcnt(6)
    v_mfma_f32_16x16x32_bf16 v[120:123], v[240:243], v[56:59], v[120:123]
    v_mfma_f32_16x16x32_bf16 v[124:127], v[240:243], v[60:63], v[124:127]
    s_waitcnt vmcnt(12)
    s_barrier
    ds_read_b64_tr_b16 v[232:233], v7 offset:0
    ds_read_b64_tr_b16 v[234:235], v7 offset:1024
    s_waitcnt lgkmcnt(6)
    v_mfma_f32_16x16x32_bf16 v[128:131], v[244:247], v[56:59], v[128:131]
    ds_read_b64_tr_b16 v[236:237], v8 offset:32
    s_mov_b32 s23, 0xa000
    buffer_load_dwordx4 v[48:51], v6, s[8:11], s23 offen offset:1024 sc1
    v_mfma_f32_16x16x32_bf16 v[132:135], v[244:247], v[60:63], v[132:135]
    ds_read_b64_tr_b16 v[238:239], v8 offset:1056
    s_waitcnt lgkmcnt(6)
    v_mfma_f32_16x16x32_bf16 v[136:139], v[224:227], v[56:59], v[136:139]
    ds_read_b64_tr_b16 v[240:241], v7 offset:256
    v_mfma_f32_16x16x32_bf16 v[140:143], v[224:227], v[60:63], v[140:143]
    ds_read_b64_tr_b16 v[242:243], v7 offset:1280
    s_mov_b32 s23, 0x2a000
    buffer_load_dwordx4 v[52:55], v6, s[8:11], s23 offen offset:1024 sc1
    s_waitcnt lgkmcnt(6)
    v_mfma_f32_16x16x32_bf16 v[144:147], v[228:231], v[56:59], v[144:147]
    ds_read_b64_tr_b16 v[244:245], v8 offset:288
    v_mfma_f32_16x16x32_bf16 v[148:151], v[228:231], v[60:63], v[148:151]
    ds_read_b64_tr_b16 v[246:247], v8 offset:1312
    s_waitcnt vmcnt(13) lgkmcnt(6)
    v_mfma_f32_16x16x32_bf16 v[88:91], v[232:235], v[24:27], v[88:91]
    ds_read_b64_tr_b16 v[224:225], v7 offset:512
    s_waitcnt vmcnt(12)
    v_mfma_f32_16x16x32_bf16 v[92:95], v[232:235], v[28:31], v[92:95]
    s_add_u32 s22, s24, 0x310000
    s_add_u32 m0, s20, 0x18000
    s_nop 0
    buffer_load_dwordx4 v3, s[4:7], s22 offen lds
    ds_read_b64_tr_b16 v[226:227], v7 offset:1536
    s_waitcnt lgkmcnt(6)
    v_mfma_f32_16x16x32_bf16 v[96:99], v[236:239], v[24:27], v[96:99]
    ds_read_b64_tr_b16 v[228:229], v8 offset:544
    v_mfma_f32_16x16x32_bf16 v[100:103], v[236:239], v[28:31], v[100:103]
    ds_read_b64_tr_b16 v[230:231], v8 offset:1568
    s_waitcnt lgkmcnt(6)
    v_mfma_f32_16x16x32_bf16 v[104:107], v[240:243], v[24:27], v[104:107]
    s_add_u32 s22, s24, 0x312000
    s_add_u32 m0, s20, 0x18400
    s_nop 0
    buffer_load_dwordx4 v3, s[4:7], s22 offen lds
    ds_read_b64_tr_b16 v[232:233], v7 offset:768
    v_mfma_f32_16x16x32_bf16 v[108:111], v[240:243], v[28:31], v[108:111]
    ds_read_b64_tr_b16 v[234:235], v7 offset:1792
    s_waitcnt lgkmcnt(6)
    v_mfma_f32_16x16x32_bf16 v[112:115], v[244:247], v[24:27], v[112:115]
    ds_read_b64_tr_b16 v[236:237], v8 offset:800
    v_mfma_f32_16x16x32_bf16 v[116:119], v[244:247], v[28:31], v[116:119]
    ds_read_b64_tr_b16 v[238:239], v8 offset:1824
    s_waitcnt lgkmcnt(6)
    v_mfma_f32_16x16x32_bf16 v[120:123], v[224:227], v[24:27], v[120:123]
    v_mfma_f32_16x16x32_bf16 v[124:127], v[224:227], v[28:31], v[124:127]
    s_waitcnt vmcnt(12)
    s_barrier
    ds_read_b64_tr_b16 v[240:241], v7 offset:16384
    ds_read_b64_tr_b16 v[242:243], v7 offset:17408
    s_add_u32 s19, s19, 8192
    buffer_load_dword v12, v13, s[8:11], s19 offen sc1
    s_waitcnt lgkmcnt(6)
    v_mfma_f32_16x16x32_bf16 v[128:131], v[228:231], v[24:27], v[128:131]
    ds_read_b64_tr_b16 v[244:245], v8 offset:16416
    s_mov_b32 s23, 0xc000
    buffer_load_dwordx4 v[56:59], v6, s[8:11], s23 offen offset:1024 sc1
    v_mfma_f32_16x16x32_bf16 v[132:135], v[228:231], v[28:31], v[132:135]
    ds_read_b64_tr_b16 v[246:247], v8 offset:17440
    s_waitcnt lgkmcnt(6)
    v_mfma_f32_16x16x32_bf16 v[136:139], v[232:235], v[24:27], v[136:139]
    ds_read_b64_tr_b16 v[224:225], v7 offset:16640
    v_mfma_f32_16x16x32_bf16 v[140:143], v[232:235], v[28:31], v[140:143]
    ds_read_b64_tr_b16 v[226:227], v7 offset:17664
    s_mov_b32 s23, 0x2c000
    buffer_load_dwordx4 v[60:63], v6, s[8:11], s23 offen offset:1024 sc1
    s_waitcnt lgkmcnt(6)
    v_mfma_f32_16x16x32_bf16 v[144:147], v[236:239], v[24:27], v[144:147]
    ds_read_b64_tr_b16 v[228:229], v8 offset:16672
    v_mfma_f32_16x16x32_bf16 v[148:151], v[236:239], v[28:31], v[148:151]
    ds_read_b64_tr_b16 v[230:231], v8 offset:17696
    s_waitcnt vmcnt(14) lgkmcnt(6)
    v_mfma_f32_16x16x32_bf16 v[88:91], v[240:243], v[32:35], v[88:91]
    ds_read_b64_tr_b16 v[232:233], v7 offset:16896
    s_waitcnt vmcnt(13)
    v_mfma_f32_16x16x32_bf16 v[92:95], v[240:243], v[36:39], v[92:95]
    s_add_u32 s22, s24, 0x390000
    s_add_u32 m0, s20, 0x1c000
    s_nop 0
    buffer_load_dwordx4 v3, s[4:7], s22 offen lds
    ds_read_b64_tr_b16 v[234:235], v7 offset:17920
    s_waitcnt lgkmcnt(6)
    v_mfma_f32_16x16x32_bf16 v[96:99], v[244:247], v[32:35], v[96:99]
    ds_read_b64_tr_b16 v[236:237], v8 offset:16928
    v_mfma_f32_16x16x32_bf16 v[100:103], v[244:247], v[36:39], v[100:103]
    ds_read_b64_tr_b16 v[238:239], v8 offset:17952
    s_waitcnt lgkmcnt(6)
    v_mfma_f32_16x16x32_bf16 v[104:107], v[224:227], v[32:35], v[104:107]
    s_add_u32 s22, s24, 0x392000
    s_add_u32 m0, s20, 0x1c400
    s_nop 0
    buffer_load_dwordx4 v3, s[4:7], s22 offen lds
    ds_read_b64_tr_b16 v[240:241], v7 offset:17152
    v_mfma_f32_16x16x32_bf16 v[108:111], v[224:227], v[36:39], v[108:111]
    ds_read_b64_tr_b16 v[242:243], v7 offset:18176
    s_waitcnt lgkmcnt(6)
    v_mfma_f32_16x16x32_bf16 v[112:115], v[228:231], v[32:35], v[112:115]
    ds_read_b64_tr_b16 v[244:245], v8 offset:17184
    v_mfma_f32_16x16x32_bf16 v[116:119], v[228:231], v[36:39], v[116:119]
    ds_read_b64_tr_b16 v[246:247], v8 offset:18208
    s_waitcnt lgkmcnt(6)
    v_mfma_f32_16x16x32_bf16 v[120:123], v[232:235], v[32:35], v[120:123]
    v_mfma_f32_16x16x32_bf16 v[124:127], v[232:235], v[36:39], v[124:127]
    s_waitcnt vmcnt(13)
    s_barrier
    ds_read_b64_tr_b16 v[224:225], v4 offset:0
    ds_read_b64_tr_b16 v[226:227], v4 offset:1024
    s_waitcnt lgkmcnt(6)
    v_mfma_f32_16x16x32_bf16 v[128:131], v[236:239], v[32:35], v[128:131]
    ds_read_b64_tr_b16 v[228:229], v5 offset:32
    s_mov_b32 s23, 0xe000
    buffer_load_dwordx4 v[24:27], v6, s[8:11], s23 offen offset:1024 sc1
    v_mfma_f32_16x16x32_bf16 v[132:135], v[236:239], v[36:39], v[132:135]
    ds_read_b64_tr_b16 v[230:231], v5 offset:1056
    s_waitcnt lgkmcnt(6)
    v_mfma_f32_16x16x32_bf16 v[136:139], v[240:243], v[32:35], v[136:139]
    ds_read_b64_tr_b16 v[232:233], v4 offset:256
    v_mfma_f32_16x16x32_bf16 v[140:143], v[240:243], v[36:39], v[140:143]
    ds_read_b64_tr_b16 v[234:235], v4 offset:1280
    s_mov_b32 s23, 0x2e000
    buffer_load_dwordx4 v[28:31], v6, s[8:11], s23 offen offset:1024 sc1
    s_waitcnt lgkmcnt(6)
    v_mfma_f32_16x16x32_bf16 v[144:147], v[244:247], v[32:35], v[144:147]
    ds_read_b64_tr_b16 v[236:237], v5 offset:288
    v_mfma_f32_16x16x32_bf16 v[148:151], v[244:247], v[36:39], v[148:151]
    ds_read_b64_tr_b16 v[238:239], v5 offset:1312
    s_waitcnt vmcnt(6)
    v_cmp_ne_u32 vcc, s28, v12
    s_cbranch_vccnz adaLN_cond__sliding_block_cached__moe_arch_mod__prompt_kernel_o219r
adaLN_cond__sliding_block_cached__moe_arch_mod__prompt_kernel_o219b:
    s_waitcnt lgkmcnt(6)
    v_mfma_f32_16x16x32_bf16 v[88:91], v[224:227], v[40:43], v[88:91]
    ds_read_b64_tr_b16 v[240:241], v4 offset:512
    v_mfma_f32_16x16x32_bf16 v[92:95], v[224:227], v[44:47], v[92:95]
    s_add_u32 s22, s24, 0x20000
    s_add_u32 m0, s20, 0x20000
    s_nop 0
    buffer_load_dwordx4 v3, s[4:7], s22 offen lds
    ds_read_b64_tr_b16 v[242:243], v4 offset:1536
    s_waitcnt lgkmcnt(6)
    v_mfma_f32_16x16x32_bf16 v[96:99], v[228:231], v[40:43], v[96:99]
    ds_read_b64_tr_b16 v[244:245], v5 offset:544
    v_mfma_f32_16x16x32_bf16 v[100:103], v[228:231], v[44:47], v[100:103]
    ds_read_b64_tr_b16 v[246:247], v5 offset:1568
    s_waitcnt lgkmcnt(6)
    v_mfma_f32_16x16x32_bf16 v[104:107], v[232:235], v[40:43], v[104:107]
    s_add_u32 s22, s24, 0x22000
    s_add_u32 m0, s20, 0x20400
    s_nop 0
    buffer_load_dwordx4 v3, s[4:7], s22 offen lds
    ds_read_b64_tr_b16 v[224:225], v4 offset:768
    v_mfma_f32_16x16x32_bf16 v[108:111], v[232:235], v[44:47], v[108:111]
    ds_read_b64_tr_b16 v[226:227], v4 offset:1792
    s_waitcnt lgkmcnt(6)
    v_mfma_f32_16x16x32_bf16 v[112:115], v[236:239], v[40:43], v[112:115]
    ds_read_b64_tr_b16 v[228:229], v5 offset:800
    v_mfma_f32_16x16x32_bf16 v[116:119], v[236:239], v[44:47], v[116:119]
    ds_read_b64_tr_b16 v[230:231], v5 offset:1824
    s_waitcnt lgkmcnt(6)
    v_mfma_f32_16x16x32_bf16 v[120:123], v[240:243], v[40:43], v[120:123]
    v_mfma_f32_16x16x32_bf16 v[124:127], v[240:243], v[44:47], v[124:127]
    s_barrier
    ds_read_b64_tr_b16 v[232:233], v4 offset:16384
    ds_read_b64_tr_b16 v[234:235], v4 offset:17408
    s_waitcnt lgkmcnt(6)
    v_mfma_f32_16x16x32_bf16 v[128:131], v[244:247], v[40:43], v[128:131]
    ds_read_b64_tr_b16 v[236:237], v5 offset:16416
    s_mov_b32 s23, 0x0
    buffer_load_dwordx4 v[32:35], v6, s[8:11], s23 offen offset:2048 sc1
    v_mfma_f32_16x16x32_bf16 v[132:135], v[244:247], v[44:47], v[132:135]
    ds_read_b64_tr_b16 v[238:239], v5 offset:17440
    s_waitcnt lgkmcnt(6)
    v_mfma_f32_16x16x32_bf16 v[136:139], v[224:227], v[40:43], v[136:139]
    ds_read_b64_tr_b16 v[240:241], v4 offset:16640
    v_mfma_f32_16x16x32_bf16 v[140:143], v[224:227], v[44:47], v[140:143]
    ds_read_b64_tr_b16 v[242:243], v4 offset:17664
    s_mov_b32 s23, 0x20000
    buffer_load_dwordx4 v[36:39], v6, s[8:11], s23 offen offset:2048 sc1
    s_waitcnt lgkmcnt(6)
    v_mfma_f32_16x16x32_bf16 v[144:147], v[228:231], v[40:43], v[144:147]
    ds_read_b64_tr_b16 v[244:245], v5 offset:16672
    v_mfma_f32_16x16x32_bf16 v[148:151], v[228:231], v[44:47], v[148:151]
    ds_read_b64_tr_b16 v[246:247], v5 offset:17696
    s_waitcnt lgkmcnt(6)
    v_mfma_f32_16x16x32_bf16 v[88:91], v[232:235], v[48:51], v[88:91]
    ds_read_b64_tr_b16 v[224:225], v4 offset:16896
    v_mfma_f32_16x16x32_bf16 v[92:95], v[232:235], v[52:55], v[92:95]
    s_add_u32 s22, s24, 0xa0000
    s_add_u32 m0, s20, 0x24000
    s_nop 0
    buffer_load_dwordx4 v3, s[4:7], s22 offen lds
    ds_read_b64_tr_b16 v[226:227], v4 offset:17920
    s_waitcnt lgkmcnt(6)
    v_mfma_f32_16x16x32_bf16 v[96:99], v[236:239], v[48:51], v[96:99]
    ds_read_b64_tr_b16 v[228:229], v5 offset:16928
    v_mfma_f32_16x16x32_bf16 v[100:103], v[236:239], v[52:55], v[100:103]
    ds_read_b64_tr_b16 v[230:231], v5 offset:17952
    s_waitcnt lgkmcnt(6)
    v_mfma_f32_16x16x32_bf16 v[104:107], v[240:243], v[48:51], v[104:107]
    s_add_u32 s22, s24, 0xa2000
    s_add_u32 m0, s20, 0x24400
    s_nop 0
    buffer_load_dwordx4 v3, s[4:7], s22 offen lds
    ds_read_b64_tr_b16 v[232:233], v4 offset:17152
    v_mfma_f32_16x16x32_bf16 v[108:111], v[240:243], v[52:55], v[108:111]
    ds_read_b64_tr_b16 v[234:235], v4 offset:18176
    s_waitcnt lgkmcnt(6)
    v_mfma_f32_16x16x32_bf16 v[112:115], v[244:247], v[48:51], v[112:115]
    ds_read_b64_tr_b16 v[236:237], v5 offset:17184
    v_mfma_f32_16x16x32_bf16 v[116:119], v[244:247], v[52:55], v[116:119]
    ds_read_b64_tr_b16 v[238:239], v5 offset:18208
    s_waitcnt lgkmcnt(6)
    v_mfma_f32_16x16x32_bf16 v[120:123], v[224:227], v[48:51], v[120:123]
    v_mfma_f32_16x16x32_bf16 v[124:127], v[224:227], v[52:55], v[124:127]
    s_barrier
    ds_read_b64_tr_b16 v[240:241], v4 offset:32768
    ds_read_b64_tr_b16 v[242:243], v4 offset:33792
    s_waitcnt lgkmcnt(6)
    v_mfma_f32_16x16x32_bf16 v[128:131], v[228:231], v[48:51], v[128:131]
    ds_read_b64_tr_b16 v[244:245], v5 offset:32800
    s_mov_b32 s23, 0x2000
    buffer_load_dwordx4 v[40:43], v6, s[8:11], s23 offen offset:2048 sc1
    v_mfma_f32_16x16x32_bf16 v[132:135], v[228:231], v[52:55], v[132:135]
    ds_read_b64_tr_b16 v[246:247], v5 offset:33824
    s_waitcnt lgkmcnt(6)
    v_mfma_f32_16x16x32_bf16 v[136:139], v[232:235], v[48:51], v[136:139]
    ds_read_b64_tr_b16 v[224:225], v4 offset:33024
    v_mfma_f32_16x16x32_bf16 v[140:143], v[232:235], v[52:55], v[140:143]
    ds_read_b64_tr_b16 v[226:227], v4 offset:34048
    s_mov_b32 s23, 0x22000
    buffer_load_dwordx4 v[44:47], v6, s[8:11], s23 offen offset:2048 sc1
    s_waitcnt lgkmcnt(6)
    v_mfma_f32_16x16x32_bf16 v[144:147], v[236:239], v[48:51], v[144:147]
    ds_read_b64_tr_b16 v[228:229], v5 offset:33056
    v_mfma_f32_16x16x32_bf16 v[148:151], v[236:239], v[52:55], v[148:151]
    ds_read_b64_tr_b16 v[230:231], v5 offset:34080
    s_waitcnt vmcnt(13) lgkmcnt(6)
    v_mfma_f32_16x16x32_bf16 v[88:91], v[240:243], v[56:59], v[88:91]
    ds_read_b64_tr_b16 v[232:233], v4 offset:33280
    s_waitcnt vmcnt(12)
    v_mfma_f32_16x16x32_bf16 v[92:95], v[240:243], v[60:63], v[92:95]
    s_add_u32 s22, s24, 0x120000
    s_add_u32 m0, s20, 0x10000
    s_nop 0
    buffer_load_dwordx4 v3, s[4:7], s22 offen lds
    ds_read_b64_tr_b16 v[234:235], v4 offset:34304
    s_waitcnt lgkmcnt(6)
    v_mfma_f32_16x16x32_bf16 v[96:99], v[244:247], v[56:59], v[96:99]
    ds_read_b64_tr_b16 v[236:237], v5 offset:33312
    v_mfma_f32_16x16x32_bf16 v[100:103], v[244:247], v[60:63], v[100:103]
    ds_read_b64_tr_b16 v[238:239], v5 offset:34336
    s_waitcnt lgkmcnt(6)
    v_mfma_f32_16x16x32_bf16 v[104:107], v[224:227], v[56:59], v[104:107]
    s_add_u32 s22, s24, 0x122000
    s_add_u32 m0, s20, 0x10400
    s_nop 0
    buffer_load_dwordx4 v3, s[4:7], s22 offen lds
    ds_read_b64_tr_b16 v[240:241], v4 offset:33536
    v_mfma_f32_16x16x32_bf16 v[108:111], v[224:227], v[60:63], v[108:111]
    ds_read_b64_tr_b16 v[242:243], v4 offset:34560
    s_waitcnt lgkmcnt(6)
    v_mfma_f32_16x16x32_bf16 v[112:115], v[228:231], v[56:59], v[112:115]
    ds_read_b64_tr_b16 v[244:245], v5 offset:33568
    v_mfma_f32_16x16x32_bf16 v[116:119], v[228:231], v[60:63], v[116:119]
    ds_read_b64_tr_b16 v[246:247], v5 offset:34592
    s_waitcnt lgkmcnt(6)
    v_mfma_f32_16x16x32_bf16 v[120:123], v[232:235], v[56:59], v[120:123]
    v_mfma_f32_16x16x32_bf16 v[124:127], v[232:235], v[60:63], v[124:127]
    s_waitcnt vmcnt(12)
    s_barrier
    ds_read_b64_tr_b16 v[224:225], v4 offset:49152
    ds_read_b64_tr_b16 v[226:227], v4 offset:50176
    s_waitcnt lgkmcnt(6)
    v_mfma_f32_16x16x32_bf16 v[128:131], v[236:239], v[56:59], v[128:131]
    ds_read_b64_tr_b16 v[228:229], v5 offset:49184
    s_mov_b32 s23, 0x4000
    buffer_load_dwordx4 v[48:51], v6, s[8:11], s23 offen offset:2048 sc1
    v_mfma_f32_16x16x32_bf16 v[132:135], v[236:239], v[60:63], v[132:135]
    ds_read_b64_tr_b16 v[230:231], v5 offset:50208
    s_waitcnt lgkmcnt(6)
    v_mfma_f32_16x16x32_bf16 v[136:139], v[240:243], v[56:59], v[136:139]
    ds_read_b64_tr_b16 v[232:233], v4 offset:49408
    v_mfma_f32_16x16x32_bf16 v[140:143], v[240:243], v[60:63], v[140:143]
    ds_read_b64_tr_b16 v[234:235], v4 offset:50432
    s_mov_b32 s23, 0x24000
    buffer_load_dwordx4 v[52:55], v6, s[8:11], s23 offen offset:2048 sc1
    s_waitcnt lgkmcnt(6)
    v_mfma_f32_16x16x32_bf16 v[144:147], v[244:247], v[56:59], v[144:147]
    ds_read_b64_tr_b16 v[236:237], v5 offset:49440
    v_mfma_f32_16x16x32_bf16 v[148:151], v[244:247], v[60:63], v[148:151]
    ds_read_b64_tr_b16 v[238:239], v5 offset:50464
    s_waitcnt vmcnt(13) lgkmcnt(6)
    v_mfma_f32_16x16x32_bf16 v[88:91], v[224:227], v[24:27], v[88:91]
    ds_read_b64_tr_b16 v[240:241], v4 offset:49664
    s_waitcnt vmcnt(12)
    v_mfma_f32_16x16x32_bf16 v[92:95], v[224:227], v[28:31], v[92:95]
    s_add_u32 s22, s24, 0x1a0000
    s_add_u32 m0, s20, 0x14000
    s_nop 0
    buffer_load_dwordx4 v3, s[4:7], s22 offen lds
    ds_read_b64_tr_b16 v[242:243], v4 offset:50688
    s_waitcnt lgkmcnt(6)
    v_mfma_f32_16x16x32_bf16 v[96:99], v[228:231], v[24:27], v[96:99]
    ds_read_b64_tr_b16 v[244:245], v5 offset:49696
    v_mfma_f32_16x16x32_bf16 v[100:103], v[228:231], v[28:31], v[100:103]
    ds_read_b64_tr_b16 v[246:247], v5 offset:50720
    s_waitcnt lgkmcnt(6)
    v_mfma_f32_16x16x32_bf16 v[104:107], v[232:235], v[24:27], v[104:107]
    s_add_u32 s22, s24, 0x1a2000
    s_add_u32 m0, s20, 0x14400
    s_nop 0
    buffer_load_dwordx4 v3, s[4:7], s22 offen lds
    ds_read_b64_tr_b16 v[224:225], v4 offset:49920
    v_mfma_f32_16x16x32_bf16 v[108:111], v[232:235], v[28:31], v[108:111]
    ds_read_b64_tr_b16 v[226:227], v4 offset:50944
    s_waitcnt lgkmcnt(6)
    v_mfma_f32_16x16x32_bf16 v[112:115], v[236:239], v[24:27], v[112:115]
    ds_read_b64_tr_b16 v[228:229], v5 offset:49952
    v_mfma_f32_16x16x32_bf16 v[116:119], v[236:239], v[28:31], v[116:119]
    ds_read_b64_tr_b16 v[230:231], v5 offset:50976
    s_waitcnt lgkmcnt(6)
    v_mfma_f32_16x16x32_bf16 v[120:123], v[240:243], v[24:27], v[120:123]
    v_mfma_f32_16x16x32_bf16 v[124:127], v[240:243], v[28:31], v[124:127]
    s_waitcnt vmcnt(12)
    s_barrier
    ds_read_b64_tr_b16 v[232:233], v7 offset:0
    ds_read_b64_tr_b16 v[234:235], v7 offset:1024
    s_waitcnt lgkmcnt(6)
    v_mfma_f32_16x16x32_bf16 v[128:131], v[244:247], v[24:27], v[128:131]
    ds_read_b64_tr_b16 v[236:237], v8 offset:32
    s_mov_b32 s23, 0x6000
    buffer_load_dwordx4 v[56:59], v6, s[8:11], s23 offen offset:2048 sc1
    v_mfma_f32_16x16x32_bf16 v[132:135], v[244:247], v[28:31], v[132:135]
    ds_read_b64_tr_b16 v[238:239], v8 offset:1056
    s_waitcnt lgkmcnt(6)
    v_mfma_f32_16x16x32_bf16 v[136:139], v[224:227], v[24:27], v[136:139]
    ds_read_b64_tr_b16 v[240:241], v7 offset:256
    v_mfma_f32_16x16x32_bf16 v[140:143], v[224:227], v[28:31], v[140:143]
    ds_read_b64_tr_b16 v[242:243], v7 offset:1280
    s_mov_b32 s23, 0x26000
    buffer_load_dwordx4 v[60:63], v6, s[8:11], s23 offen offset:2048 sc1
    s_waitcnt lgkmcnt(6)
    v_mfma_f32_16x16x32_bf16 v[144:147], v[228:231], v[24:27], v[144:147]
    ds_read_b64_tr_b16 v[244:245], v8 offset:288
    v_mfma_f32_16x16x32_bf16 v[148:151], v[228:231], v[28:31], v[148:151]
    ds_read_b64_tr_b16 v[246:247], v8 offset:1312
    s_waitcnt vmcnt(13) lgkmcnt(6)
    v_mfma_f32_16x16x32_bf16 v[88:91], v[232:235], v[32:35], v[88:91]
    ds_read_b64_tr_b16 v[224:225], v7 offset:512
    s_waitcnt vmcnt(12)
    v_mfma_f32_16x16x32_bf16 v[92:95], v[232:235], v[36:39], v[92:95]
    s_add_u32 s22, s24, 0x220000
    s_add_u32 m0, s20, 0x18000
    s_nop 0
    buffer_load_dwordx4 v3, s[4:7], s22 offen lds
    ds_read_b64_tr_b16 v[226:227], v7 offset:1536
    s_waitcnt lgkmcnt(6)
    v_mfma_f32_16x16x32_bf16 v[96:99], v[236:239], v[32:35], v[96:99]
    ds_read_b64_tr_b16 v[228:229], v8 offset:544
    v_mfma_f32_16x16x32_bf16 v[100:103], v[236:239], v[36:39], v[100:103]
    ds_read_b64_tr_b16 v[230:231], v8 offset:1568
    s_waitcnt lgkmcnt(6)
    v_mfma_f32_16x16x32_bf16 v[104:107], v[240:243], v[32:35], v[104:107]
    s_add_u32 s22, s24, 0x222000
    s_add_u32 m0, s20, 0x18400
    s_nop 0
    buffer_load_dwordx4 v3, s[4:7], s22 offen lds
    ds_read_b64_tr_b16 v[232:233], v7 offset:768
    v_mfma_f32_16x16x32_bf16 v[108:111], v[240:243], v[36:39], v[108:111]
    ds_read_b64_tr_b16 v[234:235], v7 offset:1792
    s_mov_b32 s16, 0x544000
    buffer_load_dwordx4 v[184:187], v2, s[8:11], s16 offen sc1
    s_waitcnt lgkmcnt(6)
    v_mfma_f32_16x16x32_bf16 v[112:115], v[244:247], v[32:35], v[112:115]
    ds_read_b64_tr_b16 v[236:237], v8 offset:800
    v_mfma_f32_16x16x32_bf16 v[116:119], v[244:247], v[36:39], v[116:119]
    ds_read_b64_tr_b16 v[238:239], v8 offset:1824
    s_waitcnt lgkmcnt(6)
    v_mfma_f32_16x16x32_bf16 v[120:123], v[224:227], v[32:35], v[120:123]
    v_mfma_f32_16x16x32_bf16 v[124:127], v[224:227], v[36:39], v[124:127]
    s_waitcnt vmcnt(13)
    s_barrier
    ds_read_b64_tr_b16 v[240:241], v7 offset:16384
    ds_read_b64_tr_b16 v[242:243], v7 offset:17408
    s_waitcnt lgkmcnt(6)
    v_mfma_f32_16x16x32_bf16 v[128:131], v[228:231], v[32:35], v[128:131]
    ds_read_b64_tr_b16 v[244:245], v8 offset:16416
    s_mov_b32 s23, 0x8000
    buffer_load_dwordx4 v[24:27], v6, s[8:11], s23 offen offset:2048 sc1
    v_mfma_f32_16x16x32_bf16 v[132:135], v[228:231], v[36:39], v[132:135]
    ds_read_b64_tr_b16 v[246:247], v8 offset:17440
    s_waitcnt lgkmcnt(6)
    v_mfma_f32_16x16x32_bf16 v[136:139], v[232:235], v[32:35], v[136:139]
    ds_read_b64_tr_b16 v[224:225], v7 offset:16640
    v_mfma_f32_16x16x32_bf16 v[140:143], v[232:235], v[36:39], v[140:143]
    ds_read_b64_tr_b16 v[226:227], v7 offset:17664
    s_mov_b32 s23, 0x28000
    buffer_load_dwordx4 v[28:31], v6, s[8:11], s23 offen offset:2048 sc1
    s_waitcnt lgkmcnt(6)
    v_mfma_f32_16x16x32_bf16 v[144:147], v[236:239], v[32:35], v[144:147]
    ds_read_b64_tr_b16 v[228:229], v8 offset:16672
    v_mfma_f32_16x16x32_bf16 v[148:151], v[236:239], v[36:39], v[148:151]
    ds_read_b64_tr_b16 v[230:231], v8 offset:17696
    s_waitcnt vmcnt(14) lgkmcnt(6)
    v_mfma_f32_16x16x32_bf16 v[88:91], v[240:243], v[40:43], v[88:91]
    ds_read_b64_tr_b16 v[232:233], v7 offset:16896
    s_waitcnt vmcnt(13)
    v_mfma_f32_16x16x32_bf16 v[92:95], v[240:243], v[44:47], v[92:95]
    s_add_u32 s22, s24, 0x2a0000
    s_add_u32 m0, s20, 0x1c000
    s_nop 0
    buffer_load_dwordx4 v3, s[4:7], s22 offen lds
    ds_read_b64_tr_b16 v[234:235], v7 offset:17920
    s_waitcnt lgkmcnt(6)
    v_mfma_f32_16x16x32_bf16 v[96:99], v[244:247], v[40:43], v[96:99]
    ds_read_b64_tr_b16 v[236:237], v8 offset:16928
    v_mfma_f32_16x16x32_bf16 v[100:103], v[244:247], v[44:47], v[100:103]
    ds_read_b64_tr_b16 v[238:239], v8 offset:17952
    s_waitcnt lgkmcnt(6)
    v_mfma_f32_16x16x32_bf16 v[104:107], v[224:227], v[40:43], v[104:107]
    s_add_u32 s22, s24, 0x2a2000
    s_add_u32 m0, s20, 0x1c400
    s_nop 0
    buffer_load_dwordx4 v3, s[4:7], s22 offen lds
    ds_read_b64_tr_b16 v[240:241], v7 offset:17152
    v_mfma_f32_16x16x32_bf16 v[108:111], v[224:227], v[44:47], v[108:111]
    ds_read_b64_tr_b16 v[242:243], v7 offset:18176
    s_waitcnt lgkmcnt(6)
    v_mfma_f32_16x16x32_bf16 v[112:115], v[228:231], v[40:43], v[112:115]
    ds_read_b64_tr_b16 v[244:245], v8 offset:17184
    v_mfma_f32_16x16x32_bf16 v[116:119], v[228:231], v[44:47], v[116:119]
    ds_read_b64_tr_b16 v[246:247], v8 offset:18208
    s_waitcnt lgkmcnt(6)
    v_mfma_f32_16x16x32_bf16 v[120:123], v[232:235], v[40:43], v[120:123]
    v_mfma_f32_16x16x32_bf16 v[124:127], v[232:235], v[44:47], v[124:127]
    s_waitcnt vmcnt(13)
    s_barrier
    ds_read_b64_tr_b16 v[224:225], v4 offset:0
    ds_read_b64_tr_b16 v[226:227], v4 offset:1024
    s_waitcnt lgkmcnt(6)
    v_mfma_f32_16x16x32_bf16 v[128:131], v[236:239], v[40:43], v[128:131]
    ds_read_b64_tr_b16 v[228:229], v5 offset:32
    s_mov_b32 s23, 0xa000
    buffer_load_dwordx4 v[32:35], v6, s[8:11], s23 offen offset:2048 sc1
    v_mfma_f32_16x16x32_bf16 v[132:135], v[236:239], v[44:47], v[132:135]
    ds_read_b64_tr_b16 v[230:231], v5 offset:1056
    s_waitcnt lgkmcnt(6)
    v_mfma_f32_16x16x32_bf16 v[136:139], v[240:243], v[40:43], v[136:139]
    ds_read_b64_tr_b16 v[232:233], v4 offset:256
    v_mfma_f32_16x16x32_bf16 v[140:143], v[240:243], v[44:47], v[140:143]
    ds_read_b64_tr_b16 v[234:235], v4 offset:1280
    s_mov_b32 s23, 0x2a000
    buffer_load_dwordx4 v[36:39], v6, s[8:11], s23 offen offset:2048 sc1
    s_waitcnt lgkmcnt(6)
    v_mfma_f32_16x16x32_bf16 v[144:147], v[244:247], v[40:43], v[144:147]
    ds_read_b64_tr_b16 v[236:237], v5 offset:288
    v_mfma_f32_16x16x32_bf16 v[148:151], v[244:247], v[44:47], v[148:151]
    ds_read_b64_tr_b16 v[238:239], v5 offset:1312
    s_waitcnt vmcnt(14) lgkmcnt(6)
    v_mfma_f32_16x16x32_bf16 v[88:91], v[224:227], v[48:51], v[88:91]
    ds_read_b64_tr_b16 v[240:241], v4 offset:512
    s_waitcnt vmcnt(13)
    v_mfma_f32_16x16x32_bf16 v[92:95], v[224:227], v[52:55], v[92:95]
    s_add_u32 s22, s24, 0x320000
    s_add_u32 m0, s20, 0x20000
    s_nop 0
    buffer_load_dwordx4 v3, s[4:7], s22 offen lds
    ds_read_b64_tr_b16 v[242:243], v4 offset:1536
    s_waitcnt lgkmcnt(6)
    v_mfma_f32_16x16x32_bf16 v[96:99], v[228:231], v[48:51], v[96:99]
    ds_read_b64_tr_b16 v[244:245], v5 offset:544
    v_mfma_f32_16x16x32_bf16 v[100:103], v[228:231], v[52:55], v[100:103]
    ds_read_b64_tr_b16 v[246:247], v5 offset:1568
    s_waitcnt lgkmcnt(6)
    v_mfma_f32_16x16x32_bf16 v[104:107], v[232:235], v[48:51], v[104:107]
    s_add_u32 s22, s24, 0x322000
    s_add_u32 m0, s20, 0x20400
    s_nop 0
    buffer_load_dwordx4 v3, s[4:7], s22 offen lds
    ds_read_b64_tr_b16 v[224:225], v4 offset:768
    v_mfma_f32_16x16x32_bf16 v[108:111], v[232:235], v[52:55], v[108:111]
    ds_read_b64_tr_b16 v[226:227], v4 offset:1792
    s_waitcnt lgkmcnt(6)
    v_mfma_f32_16x16x32_bf16 v[112:115], v[236:239], v[48:51], v[112:115]
    ds_read_b64_tr_b16 v[228:229], v5 offset:800
    v_mfma_f32_16x16x32_bf16 v[116:119], v[236:239], v[52:55], v[116:119]
    ds_read_b64_tr_b16 v[230:231], v5 offset:1824
    s_waitcnt lgkmcnt(6)
    v_mfma_f32_16x16x32_bf16 v[120:123], v[240:243], v[48:51], v[120:123]
    v_mfma_f32_16x16x32_bf16 v[124:127], v[240:243], v[52:55], v[124:127]
    s_waitcnt vmcnt(13)
    s_barrier
    ds_read_b64_tr_b16 v[232:233], v4 offset:16384
    ds_read_b64_tr_b16 v[234:235], v4 offset:17408
    s_add_u32 s19, s19, 8192
    buffer_load_dword v12, v13, s[8:11], s19 offen sc1
    s_waitcnt lgkmcnt(6)
    v_mfma_f32_16x16x32_bf16 v[128:131], v[244:247], v[48:51], v[128:131]
    ds_read_b64_tr_b16 v[236:237], v5 offset:16416
    s_mov_b32 s23, 0xc000
    buffer_load_dwordx4 v[40:43], v6, s[8:11], s23 offen offset:2048 sc1
    v_mfma_f32_16x16x32_bf16 v[132:135], v[244:247], v[52:55], v[132:135]
    ds_read_b64_tr_b16 v[238:239], v5 offset:17440
    s_waitcnt lgkmcnt(6)
    v_mfma_f32_16x16x32_bf16 v[136:139], v[224:227], v[48:51], v[136:139]
    ds_read_b64_tr_b16 v[240:241], v4 offset:16640
    v_mfma_f32_16x16x32_bf16 v[140:143], v[224:227], v[52:55], v[140:143]
    ds_read_b64_tr_b16 v[242:243], v4 offset:17664
    s_mov_b32 s23, 0x2c000
    buffer_load_dwordx4 v[44:47], v6, s[8:11], s23 offen offset:2048 sc1
    s_waitcnt lgkmcnt(6)
    v_mfma_f32_16x16x32_bf16 v[144:147], v[228:231], v[48:51], v[144:147]
    ds_read_b64_tr_b16 v[244:245], v5 offset:16672
    v_mfma_f32_16x16x32_bf16 v[148:151], v[228:231], v[52:55], v[148:151]
    ds_read_b64_tr_b16 v[246:247], v5 offset:17696
    s_waitcnt vmcnt(15) lgkmcnt(6)
    v_mfma_f32_16x16x32_bf16 v[88:91], v[232:235], v[56:59], v[88:91]
    ds_read_b64_tr_b16 v[224:225], v4 offset:16896
    s_waitcnt vmcnt(14)
    v_mfma_f32_16x16x32_bf16 v[92:95], v[232:235], v[60:63], v[92:95]
    s_add_u32 s22, s24, 0x3a0000
    s_add_u32 m0, s20, 0x24000
    s_nop 0
    buffer_load_dwordx4 v3, s[4:7], s22 offen lds
    ds_read_b64_tr_b16 v[226:227], v4 offset:17920
    s_waitcnt lgkmcnt(6)
    v_mfma_f32_16x16x32_bf16 v[96:99], v[236:239], v[56:59], v[96:99]
    ds_read_b64_tr_b16 v[228:229], v5 offset:16928
    v_mfma_f32_16x16x32_bf16 v[100:103], v[236:239], v[60:63], v[100:103]
    ds_read_b64_tr_b16 v[230:231], v5 offset:17952
    s_waitcnt lgkmcnt(6)
    v_mfma_f32_16x16x32_bf16 v[104:107], v[240:243], v[56:59], v[104:107]
    s_add_u32 s22, s24, 0x3a2000
    s_add_u32 m0, s20, 0x24400
    s_nop 0
    buffer_load_dwordx4 v3, s[4:7], s22 offen lds
    ds_read_b64_tr_b16 v[232:233], v4 offset:17152
    v_mfma_f32_16x16x32_bf16 v[108:111], v[240:243], v[60:63], v[108:111]
    ds_read_b64_tr_b16 v[234:235], v4 offset:18176
    s_waitcnt lgkmcnt(6)
    v_mfma_f32_16x16x32_bf16 v[112:115], v[244:247], v[56:59], v[112:115]
    ds_read_b64_tr_b16 v[236:237], v5 offset:17184
    v_mfma_f32_16x16x32_bf16 v[116:119], v[244:247], v[60:63], v[116:119]
    ds_read_b64_tr_b16 v[238:239], v5 offset:18208
    s_waitcnt lgkmcnt(6)
    v_mfma_f32_16x16x32_bf16 v[120:123], v[224:227], v[56:59], v[120:123]
    v_mfma_f32_16x16x32_bf16 v[124:127], v[224:227], v[60:63], v[124:127]
    s_waitcnt vmcnt(14)
    s_barrier
    ds_read_b64_tr_b16 v[240:241], v4 offset:32768
    ds_read_b64_tr_b16 v[242:243], v4 offset:33792
    s_waitcnt lgkmcnt(6)
    v_mfma_f32_16x16x32_bf16 v[128:131], v[228:231], v[56:59], v[128:131]
    ds_read_b64_tr_b16 v[244:245], v5 offset:32800
    s_mov_b32 s23, 0xe000
    buffer_load_dwordx4 v[48:51], v6, s[8:11], s23 offen offset:2048 sc1
    v_mfma_f32_16x16x32_bf16 v[132:135], v[228:231], v[60:63], v[132:135]
    ds_read_b64_tr_b16 v[246:247], v5 offset:33824
    s_waitcnt lgkmcnt(6)
    v_mfma_f32_16x16x32_bf16 v[136:139], v[232:235], v[56:59], v[136:139]
    ds_read_b64_tr_b16 v[224:225], v4 offset:33024
    v_mfma_f32_16x16x32_bf16 v[140:143], v[232:235], v[60:63], v[140:143]
    ds_read_b64_tr_b16 v[226:227], v4 offset:34048
    s_mov_b32 s23, 0x2e000
    buffer_load_dwordx4 v[52:55], v6, s[8:11], s23 offen offset:2048 sc1
    s_waitcnt lgkmcnt(6)
    v_mfma_f32_16x16x32_bf16 v[144:147], v[236:239], v[56:59], v[144:147]
    ds_read_b64_tr_b16 v[228:229], v5 offset:33056
    v_mfma_f32_16x16x32_bf16 v[148:151], v[236:239], v[60:63], v[148:151]
    ds_read_b64_tr_b16 v[230:231], v5 offset:34080
    s_waitcnt vmcnt(6)
    v_cmp_ne_u32 vcc, s28, v12
    s_cbranch_vccnz adaLN_cond__sliding_block_cached__moe_arch_mod__prompt_kernel_o220r
adaLN_cond__sliding_block_cached__moe_arch_mod__prompt_kernel_o220b:
    s_waitcnt lgkmcnt(6)
    v_mfma_f32_16x16x32_bf16 v[88:91], v[240:243], v[24:27], v[88:91]
    ds_read_b64_tr_b16 v[232:233], v4 offset:33280
    v_mfma_f32_16x16x32_bf16 v[92:95], v[240:243], v[28:31], v[92:95]
    s_add_u32 s22, s24, 0x30000
    s_add_u32 m0, s20, 0x10000
    s_nop 0
    buffer_load_dwordx4 v3, s[4:7], s22 offen lds
    ds_read_b64_tr_b16 v[234:235], v4 offset:34304
    s_waitcnt lgkmcnt(6)
    v_mfma_f32_16x16x32_bf16 v[96:99], v[244:247], v[24:27], v[96:99]
    ds_read_b64_tr_b16 v[236:237], v5 offset:33312
    v_mfma_f32_16x16x32_bf16 v[100:103], v[244:247], v[28:31], v[100:103]
    ds_read_b64_tr_b16 v[238:239], v5 offset:34336
    s_waitcnt lgkmcnt(6)
    v_mfma_f32_16x16x32_bf16 v[104:107], v[224:227], v[24:27], v[104:107]
    s_add_u32 s22, s24, 0x32000
    s_add_u32 m0, s20, 0x10400
    s_nop 0
    buffer_load_dwordx4 v3, s[4:7], s22 offen lds
    ds_read_b64_tr_b16 v[240:241], v4 offset:33536
    v_mfma_f32_16x16x32_bf16 v[108:111], v[224:227], v[28:31], v[108:111]
    ds_read_b64_tr_b16 v[242:243], v4 offset:34560
    v_xor_b32 v16, s28, v184
    v_xor_b32 v17, s28, v185
    v_xor_b32 v18, s28, v186
    v_xor_b32 v19, s28, v187
    v_or3_b32 v16, v16, v17, v18
    v_or_b32 v16, v16, v19
    v_cmp_ne_u32 vcc, 0, v16
    s_cbranch_vccnz adaLN_cond__sliding_block_cached__moe_arch_mod__prompt_kernel_mf21r
adaLN_cond__sliding_block_cached__moe_arch_mod__prompt_kernel_mf21b:
    s_waitcnt lgkmcnt(6)
    v_mfma_f32_16x16x32_bf16 v[112:115], v[228:231], v[24:27], v[112:115]
    ds_read_b64_tr_b16 v[244:245], v5 offset:33568
    v_mfma_f32_16x16x32_bf16 v[116:119], v[228:231], v[28:31], v[116:119]
    ds_read_b64_tr_b16 v[246:247], v5 offset:34592
    s_waitcnt lgkmcnt(6)
    v_mfma_f32_16x16x32_bf16 v[120:123], v[232:235], v[24:27], v[120:123]
    v_mfma_f32_16x16x32_bf16 v[124:127], v[232:235], v[28:31], v[124:127]
    s_barrier
    ds_read_b64_tr_b16 v[224:225], v4 offset:49152
    ds_read_b64_tr_b16 v[226:227], v4 offset:50176
    s_waitcnt lgkmcnt(6)
    v_mfma_f32_16x16x32_bf16 v[128:131], v[236:239], v[24:27], v[128:131]
    ds_read_b64_tr_b16 v[228:229], v5 offset:49184
    s_mov_b32 s23, 0x0
    buffer_load_dwordx4 v[56:59], v6, s[8:11], s23 offen offset:3072 sc1
    v_mfma_f32_16x16x32_bf16 v[132:135], v[236:239], v[28:31], v[132:135]
    ds_read_b64_tr_b16 v[230:231], v5 offset:50208
    s_waitcnt lgkmcnt(6)
    v_mfma_f32_16x16x32_bf16 v[136:139], v[240:243], v[24:27], v[136:139]
    ds_read_b64_tr_b16 v[232:233], v4 offset:49408
    v_mfma_f32_16x16x32_bf16 v[140:143], v[240:243], v[28:31], v[140:143]
    ds_read_b64_tr_b16 v[234:235], v4 offset:50432
    s_mov_b32 s23, 0x20000
    buffer_load_dwordx4 v[60:63], v6, s[8:11], s23 offen offset:3072 sc1
    s_waitcnt lgkmcnt(6)
    v_mfma_f32_16x16x32_bf16 v[144:147], v[244:247], v[24:27], v[144:147]
    ds_read_b64_tr_b16 v[236:237], v5 offset:49440
    v_mfma_f32_16x16x32_bf16 v[148:151], v[244:247], v[28:31], v[148:151]
    ds_read_b64_tr_b16 v[238:239], v5 offset:50464
    s_waitcnt lgkmcnt(6)
    v_mfma_f32_16x16x32_bf16 v[88:91], v[224:227], v[32:35], v[88:91]
    ds_read_b64_tr_b16 v[240:241], v4 offset:49664
    v_mfma_f32_16x16x32_bf16 v[92:95], v[224:227], v[36:39], v[92:95]
    s_add_u32 s22, s24, 0xb0000
    s_add_u32 m0, s20, 0x14000
    s_nop 0
    buffer_load_dwordx4 v3, s[4:7], s22 offen lds
    ds_read_b64_tr_b16 v[242:243], v4 offset:50688
    s_waitcnt lgkmcnt(6)
    v_mfma_f32_16x16x32_bf16 v[96:99], v[228:231], v[32:35], v[96:99]
    ds_read_b64_tr_b16 v[244:245], v5 offset:49696
    v_mfma_f32_16x16x32_bf16 v[100:103], v[228:231], v[36:39], v[100:103]
    ds_read_b64_tr_b16 v[246:247], v5 offset:50720
    s_waitcnt lgkmcnt(6)
    v_mfma_f32_16x16x32_bf16 v[104:107], v[232:235], v[32:35], v[104:107]
    s_add_u32 s22, s24, 0xb2000
    s_add_u32 m0, s20, 0x14400
    s_nop 0
    buffer_load_dwordx4 v3, s[4:7], s22 offen lds
    ds_read_b64_tr_b16 v[224:225], v4 offset:49920
    v_mfma_f32_16x16x32_bf16 v[108:111], v[232:235], v[36:39], v[108:111]
    ds_read_b64_tr_b16 v[226:227], v4 offset:50944
    s_waitcnt lgkmcnt(6)
    v_mfma_f32_16x16x32_bf16 v[112:115], v[236:239], v[32:35], v[112:115]
    ds_read_b64_tr_b16 v[228:229], v5 offset:49952
    v_mfma_f32_16x16x32_bf16 v[116:119], v[236:239], v[36:39], v[116:119]
    ds_read_b64_tr_b16 v[230:231], v5 offset:50976
    s_waitcnt lgkmcnt(6)
    v_mfma_f32_16x16x32_bf16 v[120:123], v[240:243], v[32:35], v[120:123]
    v_mfma_f32_16x16x32_bf16 v[124:127], v[240:243], v[36:39], v[124:127]
    s_barrier
    ds_read_b64_tr_b16 v[232:233], v7 offset:0
    ds_read_b64_tr_b16 v[234:235], v7 offset:1024
    s_waitcnt lgkmcnt(6)
    v_mfma_f32_16x16x32_bf16 v[128:131], v[244:247], v[32:35], v[128:131]
    ds_read_b64_tr_b16 v[236:237], v8 offset:32
    s_mov_b32 s23, 0x2000
    buffer_load_dwordx4 v[24:27], v6, s[8:11], s23 offen offset:3072 sc1
    v_mfma_f32_16x16x32_bf16 v[132:135], v[244:247], v[36:39], v[132:135]
    ds_read_b64_tr_b16 v[238:239], v8 offset:1056
    s_waitcnt lgkmcnt(6)
    v_mfma_f32_16x16x32_bf16 v[136:139], v[224:227], v[32:35], v[136:139]
    ds_read_b64_tr_b16 v[240:241], v7 offset:256
    v_mfma_f32_16x16x32_bf16 v[140:143], v[224:227], v[36:39], v[140:143]
    ds_read_b64_tr_b16 v[242:243], v7 offset:1280
    s_mov_b32 s23, 0x22000
    buffer_load_dwordx4 v[28:31], v6, s[8:11], s23 offen offset:3072 sc1
    s_waitcnt lgkmcnt(6)
    v_mfma_f32_16x16x32_bf16 v[144:147], v[228:231], v[32:35], v[144:147]
    ds_read_b64_tr_b16 v[244:245], v8 offset:288
    v_mfma_f32_16x16x32_bf16 v[148:151], v[228:231], v[36:39], v[148:151]
    ds_read_b64_tr_b16 v[246:247], v8 offset:1312
    s_waitcnt vmcnt(13) lgkmcnt(6)
    v_mfma_f32_16x16x32_bf16 v[88:91], v[232:235], v[40:43], v[88:91]
    ds_read_b64_tr_b16 v[224:225], v7 offset:512
    s_waitcnt vmcnt(12)
    v_mfma_f32_16x16x32_bf16 v[92:95], v[232:235], v[44:47], v[92:95]
    s_add_u32 s22, s24, 0x130000
    s_add_u32 m0, s20, 0x18000
    s_nop 0
    buffer_load_dwordx4 v3, s[4:7], s22 offen lds
    ds_read_b64_tr_b16 v[226:227], v7 offset:1536
    s_waitcnt lgkmcnt(6)
    v_mfma_f32_16x16x32_bf16 v[96:99], v[236:239], v[40:43], v[96:99]
    ds_read_b64_tr_b16 v[228:229], v8 offset:544
    v_mfma_f32_16x16x32_bf16 v[100:103], v[236:239], v[44:47], v[100:103]
    ds_read_b64_tr_b16 v[230:231], v8 offset:1568
    s_waitcnt lgkmcnt(6)
    v_mfma_f32_16x16x32_bf16 v[104:107], v[240:243], v[40:43], v[104:107]
    s_add_u32 s22, s24, 0x132000
    s_add_u32 m0, s20, 0x18400
    s_nop 0
    buffer_load_dwordx4 v3, s[4:7], s22 offen lds
    ds_read_b64_tr_b16 v[232:233], v7 offset:768
    v_mfma_f32_16x16x32_bf16 v[108:111], v[240:243], v[44:47], v[108:111]
    ds_read_b64_tr_b16 v[234:235], v7 offset:1792
    s_waitcnt lgkmcnt(6)
    v_mfma_f32_16x16x32_bf16 v[112:115], v[244:247], v[40:43], v[112:115]
    ds_read_b64_tr_b16 v[236:237], v8 offset:800
    v_mfma_f32_16x16x32_bf16 v[116:119], v[244:247], v[44:47], v[116:119]
    ds_read_b64_tr_b16 v[238:239], v8 offset:1824
    s_waitcnt lgkmcnt(6)
    v_mfma_f32_16x16x32_bf16 v[120:123], v[224:227], v[40:43], v[120:123]
    v_mfma_f32_16x16x32_bf16 v[124:127], v[224:227], v[44:47], v[124:127]
    s_waitcnt vmcnt(12)
    s_barrier
    ds_read_b64_tr_b16 v[240:241], v7 offset:16384
    ds_read_b64_tr_b16 v[242:243], v7 offset:17408
    s_waitcnt lgkmcnt(6)
    v_mfma_f32_16x16x32_bf16 v[128:131], v[228:231], v[40:43], v[128:131]
    ds_read_b64_tr_b16 v[244:245], v8 offset:16416
    s_mov_b32 s23, 0x4000
    buffer_load_dwordx4 v[32:35], v6, s[8:11], s23 offen offset:3072 sc1
    v_mfma_f32_16x16x32_bf16 v[132:135], v[228:231], v[44:47], v[132:135]
    ds_read_b64_tr_b16 v[246:247], v8 offset:17440
    s_waitcnt lgkmcnt(6)
    v_mfma_f32_16x16x32_bf16 v[136:139], v[232:235], v[40:43], v[136:139]
    ds_read_b64_tr_b16 v[224:225], v7 offset:16640
    v_mfma_f32_16x16x32_bf16 v[140:143], v[232:235], v[44:47], v[140:143]
    ds_read_b64_tr_b16 v[226:227], v7 offset:17664
    s_mov_b32 s23, 0x24000
    buffer_load_dwordx4 v[36:39], v6, s[8:11], s23 offen offset:3072 sc1
    s_waitcnt lgkmcnt(6)
    v_mfma_f32_16x16x32_bf16 v[144:147], v[236:239], v[40:43], v[144:147]
    ds_read_b64_tr_b16 v[228:229], v8 offset:16672
    v_mfma_f32_16x16x32_bf16 v[148:151], v[236:239], v[44:47], v[148:151]
    ds_read_b64_tr_b16 v[230:231], v8 offset:17696
    s_waitcnt vmcnt(13) lgkmcnt(6)
    v_mfma_f32_16x16x32_bf16 v[88:91], v[240:243], v[48:51], v[88:91]
    ds_read_b64_tr_b16 v[232:233], v7 offset:16896
    s_waitcnt vmcnt(12)
    v_mfma_f32_16x16x32_bf16 v[92:95], v[240:243], v[52:55], v[92:95]
    s_add_u32 s22, s24, 0x1b0000
    s_add_u32 m0, s20, 0x1c000
    s_nop 0
    buffer_load_dwordx4 v3, s[4:7], s22 offen lds
    ds_read_b64_tr_b16 v[234:235], v7 offset:17920
    s_waitcnt lgkmcnt(6)
    v_mfma_f32_16x16x32_bf16 v[96:99], v[244:247], v[48:51], v[96:99]
    ds_read_b64_tr_b16 v[236:237], v8 offset:16928
    v_mfma_f32_16x16x32_bf16 v[100:103], v[244:247], v[52:55], v[100:103]
    ds_read_b64_tr_b16 v[238:239], v8 offset:17952
    s_waitcnt lgkmcnt(6)
    v_mfma_f32_16x16x32_bf16 v[104:107], v[224:227], v[48:51], v[104:107]
    s_add_u32 s22, s24, 0x1b2000
    s_add_u32 m0, s20, 0x1c400
    s_nop 0
    buffer_load_dwordx4 v3, s[4:7], s22 offen lds
    ds_read_b64_tr_b16 v[240:241], v7 offset:17152
    v_mfma_f32_16x16x32_bf16 v[108:111], v[224:227], v[52:55], v[108:111]
    ds_read_b64_tr_b16 v[242:243], v7 offset:18176
    s_waitcnt lgkmcnt(6)
    v_mfma_f32_16x16x32_bf16 v[112:115], v[228:231], v[48:51], v[112:115]
    ds_read_b64_tr_b16 v[244:245], v8 offset:17184
    v_mfma_f32_16x16x32_bf16 v[116:119], v[228:231], v[52:55], v[116:119]
    ds_read_b64_tr_b16 v[246:247], v8 offset:18208
    s_waitcnt lgkmcnt(6)
    v_mfma_f32_16x16x32_bf16 v[120:123], v[232:235], v[48:51], v[120:123]
    v_mfma_f32_16x16x32_bf16 v[124:127], v[232:235], v[52:55], v[124:127]
    s_waitcnt vmcnt(12)
    s_barrier
    ds_read_b64_tr_b16 v[224:225], v4 offset:0
    ds_read_b64_tr_b16 v[226:227], v4 offset:1024
    s_waitcnt lgkmcnt(6)
    v_mfma_f32_16x16x32_bf16 v[128:131], v[236:239], v[48:51], v[128:131]
    ds_read_b64_tr_b16 v[228:229], v5 offset:32
    s_mov_b32 s23, 0x6000
    buffer_load_dwordx4 v[40:43], v6, s[8:11], s23 offen offset:3072 sc1
    v_mfma_f32_16x16x32_bf16 v[132:135], v[236:239], v[52:55], v[132:135]
    ds_read_b64_tr_b16 v[230:231], v5 offset:1056
    s_waitcnt lgkmcnt(6)
    v_mfma_f32_16x16x32_bf16 v[136:139], v[240:243], v[48:51], v[136:139]
    ds_read_b64_tr_b16 v[232:233], v4 offset:256
    v_mfma_f32_16x16x32_bf16 v[140:143], v[240:243], v[52:55], v[140:143]
    ds_read_b64_tr_b16 v[234:235], v4 offset:1280
    s_mov_b32 s23, 0x26000
    buffer_load_dwordx4 v[44:47], v6, s[8:11], s23 offen offset:3072 sc1
    s_waitcnt lgkmcnt(6)
    v_mfma_f32_16x16x32_bf16 v[144:147], v[244:247], v[48:51], v[144:147]
    ds_read_b64_tr_b16 v[236:237], v5 offset:288
    v_mfma_f32_16x16x32_bf16 v[148:151], v[244:247], v[52:55], v[148:151]
    ds_read_b64_tr_b16 v[238:239], v5 offset:1312
    s_waitcnt vmcnt(13) lgkmcnt(6)
    v_mfma_f32_16x16x32_bf16 v[88:91], v[224:227], v[56:59], v[88:91]
    ds_read_b64_tr_b16 v[240:241], v4 offset:512
    s_waitcnt vmcnt(12)
    v_mfma_f32_16x16x32_bf16 v[92:95], v[224:227], v[60:63], v[92:95]
    s_add_u32 s22, s24, 0x230000
    s_add_u32 m0, s20, 0x20000
    s_nop 0
    buffer_load_dwordx4 v3, s[4:7], s22 offen lds
    ds_read_b64_tr_b16 v[242:243], v4 offset:1536
    s_waitcnt lgkmcnt(6)
    v_mfma_f32_16x16x32_bf16 v[96:99], v[228:231], v[56:59], v[96:99]
    ds_read_b64_tr_b16 v[244:245], v5 offset:544
    v_mfma_f32_16x16x32_bf16 v[100:103], v[228:231], v[60:63], v[100:103]
    ds_read_b64_tr_b16 v[246:247], v5 offset:1568
    s_waitcnt lgkmcnt(6)
    v_mfma_f32_16x16x32_bf16 v[104:107], v[232:235], v[56:59], v[104:107]
    s_add_u32 s22, s24, 0x232000
    s_add_u32 m0, s20, 0x20400
    s_nop 0
    buffer_load_dwordx4 v3, s[4:7], s22 offen lds
    ds_read_b64_tr_b16 v[224:225], v4 offset:768
    v_mfma_f32_16x16x32_bf16 v[108:111], v[232:235], v[60:63], v[108:111]
    ds_read_b64_tr_b16 v[226:227], v4 offset:1792
    s_waitcnt lgkmcnt(6)
    v_mfma_f32_16x16x32_bf16 v[112:115], v[236:239], v[56:59], v[112:115]
    ds_read_b64_tr_b16 v[228:229], v5 offset:800
    v_mfma_f32_16x16x32_bf16 v[116:119], v[236:239], v[60:63], v[116:119]
    ds_read_b64_tr_b16 v[230:231], v5 offset:1824
    s_waitcnt lgkmcnt(6)
    v_mfma_f32_16x16x32_bf16 v[120:123], v[240:243], v[56:59], v[120:123]
    v_mfma_f32_16x16x32_bf16 v[124:127], v[240:243], v[60:63], v[124:127]
    s_waitcnt vmcnt(12)
    s_barrier
    ds_read_b64_tr_b16 v[232:233], v4 offset:16384
    ds_read_b64_tr_b16 v[234:235], v4 offset:17408
    s_waitcnt lgkmcnt(6)
    v_mfma_f32_16x16x32_bf16 v[128:131], v[244:247], v[56:59], v[128:131]
    ds_read_b64_tr_b16 v[236:237], v5 offset:16416
    s_mov_b32 s23, 0x8000
    buffer_load_dwordx4 v[48:51], v6, s[8:11], s23 offen offset:3072 sc1
    v_mfma_f32_16x16x32_bf16 v[132:135], v[244:247], v[60:63], v[132:135]
    ds_read_b64_tr_b16 v[238:239], v5 offset:17440
    s_waitcnt lgkmcnt(6)
    v_mfma_f32_16x16x32_bf16 v[136:139], v[224:227], v[56:59], v[136:139]
    ds_read_b64_tr_b16 v[240:241], v4 offset:16640
    v_mfma_f32_16x16x32_bf16 v[140:143], v[224:227], v[60:63], v[140:143]
    ds_read_b64_tr_b16 v[242:243], v4 offset:17664
    s_mov_b32 s23, 0x28000
    buffer_load_dwordx4 v[52:55], v6, s[8:11], s23 offen offset:3072 sc1
    s_waitcnt lgkmcnt(6)
    v_mfma_f32_16x16x32_bf16 v[144:147], v[228:231], v[56:59], v[144:147]
    ds_read_b64_tr_b16 v[244:245], v5 offset:16672
    v_mfma_f32_16x16x32_bf16 v[148:151], v[228:231], v[60:63], v[148:151]
    ds_read_b64_tr_b16 v[246:247], v5 offset:17696
    s_waitcnt vmcnt(13) lgkmcnt(6)
    v_mfma_f32_16x16x32_bf16 v[88:91], v[232:235], v[24:27], v[88:91]
    ds_read_b64_tr_b16 v[224:225], v4 offset:16896
    s_waitcnt vmcnt(12)
    v_mfma_f32_16x16x32_bf16 v[92:95], v[232:235], v[28:31], v[92:95]
    s_add_u32 s22, s24, 0x2b0000
    s_add_u32 m0, s20, 0x24000
    s_nop 0
    buffer_load_dwordx4 v3, s[4:7], s22 offen lds
    ds_read_b64_tr_b16 v[226:227], v4 offset:17920
    s_waitcnt lgkmcnt(6)
    v_mfma_f32_16x16x32_bf16 v[96:99], v[236:239], v[24:27], v[96:99]
    ds_read_b64_tr_b16 v[228:229], v5 offset:16928
    v_mfma_f32_16x16x32_bf16 v[100:103], v[236:239], v[28:31], v[100:103]
    ds_read_b64_tr_b16 v[230:231], v5 offset:17952
    s_waitcnt lgkmcnt(6)
    v_mfma_f32_16x16x32_bf16 v[104:107], v[240:243], v[24:27], v[104:107]
    s_add_u32 s22, s24, 0x2b2000
    s_add_u32 m0, s20, 0x24400
    s_nop 0
    buffer_load_dwordx4 v3, s[4:7], s22 offen lds
    ds_read_b64_tr_b16 v[232:233], v4 offset:17152
    v_mfma_f32_16x16x32_bf16 v[108:111], v[240:243], v[28:31], v[108:111]
    ds_read_b64_tr_b16 v[234:235], v4 offset:18176
    s_waitcnt lgkmcnt(6)
    v_mfma_f32_16x16x32_bf16 v[112:115], v[244:247], v[24:27], v[112:115]
    ds_read_b64_tr_b16 v[236:237], v5 offset:17184
    v_mfma_f32_16x16x32_bf16 v[116:119], v[244:247], v[28:31], v[116:119]
    ds_read_b64_tr_b16 v[238:239], v5 offset:18208
    s_waitcnt lgkmcnt(6)
    v_mfma_f32_16x16x32_bf16 v[120:123], v[224:227], v[24:27], v[120:123]
    v_mfma_f32_16x16x32_bf16 v[124:127], v[224:227], v[28:31], v[124:127]
    s_waitcnt vmcnt(12)
    s_barrier
    ds_read_b64_tr_b16 v[240:241], v4 offset:32768
    ds_read_b64_tr_b16 v[242:243], v4 offset:33792
    s_waitcnt lgkmcnt(6)
    v_mfma_f32_16x16x32_bf16 v[128:131], v[228:231], v[24:27], v[128:131]
    ds_read_b64_tr_b16 v[244:245], v5 offset:32800
    s_mov_b32 s23, 0xa000
    buffer_load_dwordx4 v[56:59], v6, s[8:11], s23 offen offset:3072 sc1
    v_mfma_f32_16x16x32_bf16 v[132:135], v[228:231], v[28:31], v[132:135]
    ds_read_b64_tr_b16 v[246:247], v5 offset:33824
    s_waitcnt lgkmcnt(6)
    v_mfma_f32_16x16x32_bf16 v[136:139], v[232:235], v[24:27], v[136:139]
    ds_read_b64_tr_b16 v[224:225], v4 offset:33024
    v_mfma_f32_16x16x32_bf16 v[140:143], v[232:235], v[28:31], v[140:143]
    ds_read_b64_tr_b16 v[226:227], v4 offset:34048
    s_mov_b32 s23, 0x2a000
    buffer_load_dwordx4 v[60:63], v6, s[8:11], s23 offen offset:3072 sc1
    s_waitcnt lgkmcnt(6)
    v_mfma_f32_16x16x32_bf16 v[144:147], v[236:239], v[24:27], v[144:147]
    ds_read_b64_tr_b16 v[228:229], v5 offset:33056
    v_mfma_f32_16x16x32_bf16 v[148:151], v[236:239], v[28:31], v[148:151]
    ds_read_b64_tr_b16 v[230:231], v5 offset:34080
    s_waitcnt vmcnt(13) lgkmcnt(6)
    v_mfma_f32_16x16x32_bf16 v[88:91], v[240:243], v[32:35], v[88:91]
    ds_read_b64_tr_b16 v[232:233], v4 offset:33280
    s_waitcnt vmcnt(12)
    v_mfma_f32_16x16x32_bf16 v[92:95], v[240:243], v[36:39], v[92:95]
    s_add_u32 s22, s24, 0x330000
    s_add_u32 m0, s20, 0x10000
    s_nop 0
    buffer_load_dwordx4 v3, s[4:7], s22 offen lds
    ds_read_b64_tr_b16 v[234:235], v4 offset:34304
    s_waitcnt lgkmcnt(6)
    v_mfma_f32_16x16x32_bf16 v[96:99], v[244:247], v[32:35], v[96:99]
    ds_read_b64_tr_b16 v[236:237], v5 offset:33312
    v_mfma_f32_16x16x32_bf16 v[100:103], v[244:247], v[36:39], v[100:103]
    ds_read_b64_tr_b16 v[238:239], v5 offset:34336
    s_waitcnt lgkmcnt(6)
    v_mfma_f32_16x16x32_bf16 v[104:107], v[224:227], v[32:35], v[104:107]
    s_add_u32 s22, s24, 0x332000
    s_add_u32 m0, s20, 0x10400
    s_nop 0
    buffer_load_dwordx4 v3, s[4:7], s22 offen lds
    ds_read_b64_tr_b16 v[240:241], v4 offset:33536
    v_mfma_f32_16x16x32_bf16 v[108:111], v[224:227], v[36:39], v[108:111]
    ds_read_b64_tr_b16 v[242:243], v4 offset:34560
    v_lshrrev_b32 v16, 4, v1
    v_lshlrev_b32 v16, 3, v16
    s_lshl_b32 s16, s31, 8
    s_add_u32 s16, s16, 0x540080
    buffer_load_dwordx2 v[248:249], v16, s[8:11], s16 offen offset:0 sc1
    buffer_load_dwordx2 v[250:251], v16, s[8:11], s16 offen offset:32 sc1
    buffer_load_dwordx2 v[252:253], v16, s[8:11], s16 offen offset:64 sc1
    buffer_load_dwordx2 v[254:255], v16, s[8:11], s16 offen offset:96 sc1
    s_waitcnt lgkmcnt(6)
    v_mfma_f32_16x16x32_bf16 v[112:115], v[228:231], v[32:35], v[112:115]
    ds_read_b64_tr_b16 v[244:245], v5 offset:33568
    v_mfma_f32_16x16x32_bf16 v[116:119], v[228:231], v[36:39], v[116:119]
    ds_read_b64_tr_b16 v[246:247], v5 offset:34592
    s_waitcnt lgkmcnt(6)
    v_mfma_f32_16x16x32_bf16 v[120:123], v[232:235], v[32:35], v[120:123]
    v_mfma_f32_16x16x32_bf16 v[124:127], v[232:235], v[36:39], v[124:127]
    s_waitcnt vmcnt(16)
    s_barrier
    ds_read_b64_tr_b16 v[224:225], v4 offset:49152
    ds_read_b64_tr_b16 v[226:227], v4 offset:50176
    s_waitcnt lgkmcnt(6)
    v_mfma_f32_16x16x32_bf16 v[128:131], v[236:239], v[32:35], v[128:131]
    ds_read_b64_tr_b16 v[228:229], v5 offset:49184
    s_mov_b32 s23, 0xc000
    buffer_load_dwordx4 v[24:27], v6, s[8:11], s23 offen offset:3072 sc1
    v_mfma_f32_16x16x32_bf16 v[132:135], v[236:239], v[36:39], v[132:135]
    ds_read_b64_tr_b16 v[230:231], v5 offset:50208
    s_waitcnt lgkmcnt(6)
    v_mfma_f32_16x16x32_bf16 v[136:139], v[240:243], v[32:35], v[136:139]
    ds_read_b64_tr_b16 v[232:233], v4 offset:49408
    v_mfma_f32_16x16x32_bf16 v[140:143], v[240:243], v[36:39], v[140:143]
    ds_read_b64_tr_b16 v[234:235], v4 offset:50432
    s_mov_b32 s23, 0x2c000
    buffer_load_dwordx4 v[28:31], v6, s[8:11], s23 offen offset:3072 sc1
    s_waitcnt lgkmcnt(6)
    v_mfma_f32_16x16x32_bf16 v[144:147], v[244:247], v[32:35], v[144:147]
    ds_read_b64_tr_b16 v[236:237], v5 offset:49440
    v_mfma_f32_16x16x32_bf16 v[148:151], v[244:247], v[36:39], v[148:151]
    ds_read_b64_tr_b16 v[238:239], v5 offset:50464
    s_waitcnt vmcnt(17) lgkmcnt(6)
    v_mfma_f32_16x16x32_bf16 v[88:91], v[224:227], v[40:43], v[88:91]
    ds_read_b64_tr_b16 v[240:241], v4 offset:49664
    s_waitcnt vmcnt(16)
    v_mfma_f32_16x16x32_bf16 v[92:95], v[224:227], v[44:47], v[92:95]
    s_add_u32 s22, s24, 0x3b0000
    s_add_u32 m0, s20, 0x14000
    s_nop 0
    buffer_load_dwordx4 v3, s[4:7], s22 offen lds
    ds_read_b64_tr_b16 v[242:243], v4 offset:50688
    s_waitcnt lgkmcnt(6)
    v_mfma_f32_16x16x32_bf16 v[96:99], v[228:231], v[40:43], v[96:99]
    ds_read_b64_tr_b16 v[244:245], v5 offset:49696
    v_mfma_f32_16x16x32_bf16 v[100:103], v[228:231], v[44:47], v[100:103]
    ds_read_b64_tr_b16 v[246:247], v5 offset:50720
    s_waitcnt lgkmcnt(6)
    v_mfma_f32_16x16x32_bf16 v[104:107], v[232:235], v[40:43], v[104:107]
    s_add_u32 s22, s24, 0x3b2000
    s_add_u32 m0, s20, 0x14400
    s_nop 0
    buffer_load_dwordx4 v3, s[4:7], s22 offen lds
    ds_read_b64_tr_b16 v[224:225], v4 offset:49920
    v_mfma_f32_16x16x32_bf16 v[108:111], v[232:235], v[44:47], v[108:111]
    ds_read_b64_tr_b16 v[226:227], v4 offset:50944
    s_waitcnt lgkmcnt(6)
    v_mfma_f32_16x16x32_bf16 v[112:115], v[236:239], v[40:43], v[112:115]
    ds_read_b64_tr_b16 v[228:229], v5 offset:49952
    v_mfma_f32_16x16x32_bf16 v[116:119], v[236:239], v[44:47], v[116:119]
    ds_read_b64_tr_b16 v[230:231], v5 offset:50976
    s_waitcnt lgkmcnt(6)
    v_mfma_f32_16x16x32_bf16 v[120:123], v[240:243], v[40:43], v[120:123]
    v_mfma_f32_16x16x32_bf16 v[124:127], v[240:243], v[44:47], v[124:127]
    s_waitcnt vmcnt(16)
    s_barrier
    ds_read_b64_tr_b16 v[232:233], v7 offset:0
    ds_read_b64_tr_b16 v[234:235], v7 offset:1024
    s_waitcnt lgkmcnt(6)
    v_mfma_f32_16x16x32_bf16 v[128:131], v[244:247], v[40:43], v[128:131]
    ds_read_b64_tr_b16 v[236:237], v8 offset:32
    s_mov_b32 s23, 0xe000
    buffer_load_dwordx4 v[32:35], v6, s[8:11], s23 offen offset:3072 sc1
    v_mfma_f32_16x16x32_bf16 v[132:135], v[244:247], v[44:47], v[132:135]
    ds_read_b64_tr_b16 v[238:239], v8 offset:1056
    s_waitcnt lgkmcnt(6)
    v_mfma_f32_16x16x32_bf16 v[136:139], v[224:227], v[40:43], v[136:139]
    ds_read_b64_tr_b16 v[240:241], v7 offset:256
    v_mfma_f32_16x16x32_bf16 v[140:143], v[224:227], v[44:47], v[140:143]
    ds_read_b64_tr_b16 v[242:243], v7 offset:1280
    s_mov_b32 s23, 0x2e000
    buffer_load_dwordx4 v[36:39], v6, s[8:11], s23 offen offset:3072 sc1
    s_waitcnt lgkmcnt(6)
    v_mfma_f32_16x16x32_bf16 v[144:147], v[228:231], v[40:43], v[144:147]
    ds_read_b64_tr_b16 v[244:245], v8 offset:288
    v_mfma_f32_16x16x32_bf16 v[148:151], v[228:231], v[44:47], v[148:151]
    ds_read_b64_tr_b16 v[246:247], v8 offset:1312
    s_waitcnt vmcnt(17) lgkmcnt(6)
    v_mfma_f32_16x16x32_bf16 v[88:91], v[232:235], v[48:51], v[88:91]
    ds_read_b64_tr_b16 v[224:225], v7 offset:512
    s_waitcnt vmcnt(16)
    v_mfma_f32_16x16x32_bf16 v[92:95], v[232:235], v[52:55], v[92:95]
    ds_read_b64_tr_b16 v[226:227], v7 offset:1536
    s_waitcnt lgkmcnt(6)
    v_mfma_f32_16x16x32_bf16 v[96:99], v[236:239], v[48:51], v[96:99]
    ds_read_b64_tr_b16 v[228:229], v8 offset:544
    v_mfma_f32_16x16x32_bf16 v[100:103], v[236:239], v[52:55], v[100:103]
    ds_read_b64_tr_b16 v[230:231], v8 offset:1568
    s_waitcnt lgkmcnt(6)
    v_mfma_f32_16x16x32_bf16 v[104:107], v[240:243], v[48:51], v[104:107]
    ds_read_b64_tr_b16 v[232:233], v7 offset:768
    v_mfma_f32_16x16x32_bf16 v[108:111], v[240:243], v[52:55], v[108:111]
    ds_read_b64_tr_b16 v[234:235], v7 offset:1792
    s_waitcnt lgkmcnt(6)
    v_mfma_f32_16x16x32_bf16 v[112:115], v[244:247], v[48:51], v[112:115]
    ds_read_b64_tr_b16 v[236:237], v8 offset:800
    v_mfma_f32_16x16x32_bf16 v[116:119], v[244:247], v[52:55], v[116:119]
    ds_read_b64_tr_b16 v[238:239], v8 offset:1824
    s_waitcnt lgkmcnt(6)
    v_mfma_f32_16x16x32_bf16 v[120:123], v[224:227], v[48:51], v[120:123]
    s_mov_b64 s[72:73], s[48:49]
    s_mov_b32 s74, 0x700000
    s_mov_b32 s75, 0x20000
    s_cmp_lt_u32 s2, 224
    s_cselect_b32 s74, 7340032, 0
    s_and_b32 s16, s3, 3
    v_lshrrev_b32 v20, 3, v1
    v_lshlrev_b32 v20, 3, v20
    s_lshl_b32 s17, s16, 6
    v_add_u32 v20, s17, v20
    s_mov_b32 s17, 7168
    v_mul_lo_u32 v21, s17, v20
    v_and_b32 v20, 7, v1
    v_lshl_add_u32 v21, v20, 4, v21
    s_and_b32 s17, s29, 3
    s_mul_i32 s18, s17, 1835008
    s_lshr_b32 s17, s29, 2
    s_lshl_b32 s17, s17, 7
    s_add_u32 s18, s18, s17
    s_lshl_b32 s16, s16, 13
    s_add_u32 s22, s18, 0
    s_add_u32 m0, s16, 32768
    s_nop 0
    buffer_load_dwordx4 v21, s[72:75], s22 offen lds
    s_add_u32 s22, s18, 7168
    s_add_u32 m0, s16, 33792
    s_nop 0
    buffer_load_dwordx4 v21, s[72:75], s22 offen lds
    s_add_u32 s22, s18, 14336
    s_add_u32 m0, s16, 34816
    s_nop 0
    buffer_load_dwordx4 v21, s[72:75], s22 offen lds
    s_add_u32 s22, s18, 21504
    s_add_u32 m0, s16, 35840
    s_nop 0
    buffer_load_dwordx4 v21, s[72:75], s22 offen lds
    s_add_u32 s22, s18, 28672
    s_add_u32 m0, s16, 36864
    s_nop 0
    buffer_load_dwordx4 v21, s[72:75], s22 offen lds
    s_add_u32 s22, s18, 35840
    s_add_u32 m0, s16, 37888
    s_nop 0
    buffer_load_dwordx4 v21, s[72:75], s22 offen lds
    s_add_u32 s22, s18, 43008
    s_add_u32 m0, s16, 38912
    s_nop 0
    buffer_load_dwordx4 v21, s[72:75], s22 offen lds
    s_add_u32 s22, s18, 50176
    s_add_u32 m0, s16, 39936
    s_nop 0
    buffer_load_dwordx4 v21, s[72:75], s22 offen lds
    v_mfma_f32_16x16x32_bf16 v[124:127], v[224:227], v[52:55], v[124:127]
    s_waitcnt vmcnt(22)
    s_barrier
    ds_read_b64_tr_b16 v[240:241], v7 offset:16384
    ds_read_b64_tr_b16 v[242:243], v7 offset:17408
    s_waitcnt lgkmcnt(6)
    v_mfma_f32_16x16x32_bf16 v[128:131], v[228:231], v[48:51], v[128:131]
    ds_read_b64_tr_b16 v[244:245], v8 offset:16416
    v_mfma_f32_16x16x32_bf16 v[132:135], v[228:231], v[52:55], v[132:135]
    ds_read_b64_tr_b16 v[246:247], v8 offset:17440
    s_waitcnt lgkmcnt(6)
    v_mfma_f32_16x16x32_bf16 v[136:139], v[232:235], v[48:51], v[136:139]
    ds_read_b64_tr_b16 v[224:225], v7 offset:16640
    v_mfma_f32_16x16x32_bf16 v[140:143], v[232:235], v[52:55], v[140:143]
    ds_read_b64_tr_b16 v[226:227], v7 offset:17664
    s_waitcnt lgkmcnt(6)
    v_mfma_f32_16x16x32_bf16 v[144:147], v[236:239], v[48:51], v[144:147]
    ds_read_b64_tr_b16 v[228:229], v8 offset:16672
    v_mfma_f32_16x16x32_bf16 v[148:151], v[236:239], v[52:55], v[148:151]
    ds_read_b64_tr_b16 v[230:231], v8 offset:17696
    s_waitcnt vmcnt(21) lgkmcnt(6)
    v_mfma_f32_16x16x32_bf16 v[88:91], v[240:243], v[56:59], v[88:91]
    ds_read_b64_tr_b16 v[232:233], v7 offset:16896
    s_waitcnt vmcnt(20)
    v_mfma_f32_16x16x32_bf16 v[92:95], v[240:243], v[60:63], v[92:95]
    ds_read_b64_tr_b16 v[234:235], v7 offset:17920
    s_waitcnt lgkmcnt(6)
    v_mfma_f32_16x16x32_bf16 v[96:99], v[244:247], v[56:59], v[96:99]
    ds_read_b64_tr_b16 v[236:237], v8 offset:16928
    v_mfma_f32_16x16x32_bf16 v[100:103], v[244:247], v[60:63], v[100:103]
    ds_read_b64_tr_b16 v[238:239], v8 offset:17952
    s_waitcnt lgkmcnt(6)
    v_mfma_f32_16x16x32_bf16 v[104:107], v[224:227], v[56:59], v[104:107]
    ds_read_b64_tr_b16 v[240:241], v7 offset:17152
    v_mfma_f32_16x16x32_bf16 v[108:111], v[224:227], v[60:63], v[108:111]
    ds_read_b64_tr_b16 v[242:243], v7 offset:18176
    s_waitcnt lgkmcnt(6)
    v_mfma_f32_16x16x32_bf16 v[112:115], v[228:231], v[56:59], v[112:115]
    ds_read_b64_tr_b16 v[244:245], v8 offset:17184
    v_mfma_f32_16x16x32_bf16 v[116:119], v[228:231], v[60:63], v[116:119]
    ds_read_b64_tr_b16 v[246:247], v8 offset:18208
    s_waitcnt lgkmcnt(6)
    v_mfma_f32_16x16x32_bf16 v[120:123], v[232:235], v[56:59], v[120:123]
    v_mfma_f32_16x16x32_bf16 v[124:127], v[232:235], v[60:63], v[124:127]
    s_waitcnt vmcnt(18)
    s_barrier
    ds_read_b64_tr_b16 v[224:225], v4 offset:0
    ds_read_b64_tr_b16 v[226:227], v4 offset:1024
    s_waitcnt lgkmcnt(6)
    v_mfma_f32_16x16x32_bf16 v[128:131], v[236:239], v[56:59], v[128:131]
    ds_read_b64_tr_b16 v[228:229], v5 offset:32
    v_mfma_f32_16x16x32_bf16 v[132:135], v[236:239], v[60:63], v[132:135]
    ds_read_b64_tr_b16 v[230:231], v5 offset:1056
    s_waitcnt lgkmcnt(6)
    v_mfma_f32_16x16x32_bf16 v[136:139], v[240:243], v[56:59], v[136:139]
    ds_read_b64_tr_b16 v[232:233], v4 offset:256
    v_mfma_f32_16x16x32_bf16 v[140:143], v[240:243], v[60:63], v[140:143]
    ds_read_b64_tr_b16 v[234:235], v4 offset:1280
    s_waitcnt lgkmcnt(6)
    v_mfma_f32_16x16x32_bf16 v[144:147], v[244:247], v[56:59], v[144:147]
    ds_read_b64_tr_b16 v[236:237], v5 offset:288
    v_mfma_f32_16x16x32_bf16 v[148:151], v[244:247], v[60:63], v[148:151]
    ds_read_b64_tr_b16 v[238:239], v5 offset:1312
    s_waitcnt vmcnt(13) lgkmcnt(6)
    v_mfma_f32_16x16x32_bf16 v[88:91], v[224:227], v[24:27], v[88:91]
    ds_read_b64_tr_b16 v[240:241], v4 offset:512
    s_waitcnt vmcnt(12)
    v_mfma_f32_16x16x32_bf16 v[92:95], v[224:227], v[28:31], v[92:95]
    ds_read_b64_tr_b16 v[242:243], v4 offset:1536
    s_waitcnt lgkmcnt(6)
    v_mfma_f32_16x16x32_bf16 v[96:99], v[228:231], v[24:27], v[96:99]
    ds_read_b64_tr_b16 v[244:245], v5 offset:544
    v_mfma_f32_16x16x32_bf16 v[100:103], v[228:231], v[28:31], v[100:103]
    ds_read_b64_tr_b16 v[246:247], v5 offset:1568
    s_waitcnt lgkmcnt(6)
    v_mfma_f32_16x16x32_bf16 v[104:107], v[232:235], v[24:27], v[104:107]
    ds_read_b64_tr_b16 v[224:225], v4 offset:768
    v_mfma_f32_16x16x32_bf16 v[108:111], v[232:235], v[28:31], v[108:111]
    ds_read_b64_tr_b16 v[226:227], v4 offset:1792
    s_waitcnt lgkmcnt(6)
    v_mfma_f32_16x16x32_bf16 v[112:115], v[236:239], v[24:27], v[112:115]
    ds_read_b64_tr_b16 v[228:229], v5 offset:800
    v_mfma_f32_16x16x32_bf16 v[116:119], v[236:239], v[28:31], v[116:119]
    ds_read_b64_tr_b16 v[230:231], v5 offset:1824
    s_waitcnt lgkmcnt(6)
    v_mfma_f32_16x16x32_bf16 v[120:123], v[240:243], v[24:27], v[120:123]
    v_mfma_f32_16x16x32_bf16 v[124:127], v[240:243], v[28:31], v[124:127]
    s_waitcnt vmcnt(10)
    s_barrier
    ds_read_b64_tr_b16 v[232:233], v4 offset:16384
    ds_read_b64_tr_b16 v[234:235], v4 offset:17408
    s_waitcnt lgkmcnt(6)
    v_mfma_f32_16x16x32_bf16 v[128:131], v[244:247], v[24:27], v[128:131]
    ds_read_b64_tr_b16 v[236:237], v5 offset:16416
    v_mfma_f32_16x16x32_bf16 v[132:135], v[244:247], v[28:31], v[132:135]
    ds_read_b64_tr_b16 v[238:239], v5 offset:17440
    s_waitcnt lgkmcnt(6)
    v_mfma_f32_16x16x32_bf16 v[136:139], v[224:227], v[24:27], v[136:139]
    ds_read_b64_tr_b16 v[240:241], v4 offset:16640
    v_mfma_f32_16x16x32_bf16 v[140:143], v[224:227], v[28:31], v[140:143]
    ds_read_b64_tr_b16 v[242:243], v4 offset:17664
    s_waitcnt lgkmcnt(6)
    v_mfma_f32_16x16x32_bf16 v[144:147], v[228:231], v[24:27], v[144:147]
    ds_read_b64_tr_b16 v[244:245], v5 offset:16672
    v_mfma_f32_16x16x32_bf16 v[148:151], v[228:231], v[28:31], v[148:151]
    ds_read_b64_tr_b16 v[246:247], v5 offset:17696
    s_waitcnt vmcnt(9) lgkmcnt(6)
    v_mfma_f32_16x16x32_bf16 v[88:91], v[232:235], v[32:35], v[88:91]
    ds_read_b64_tr_b16 v[224:225], v4 offset:16896
    s_waitcnt vmcnt(8)
    v_mfma_f32_16x16x32_bf16 v[92:95], v[232:235], v[36:39], v[92:95]
    ds_read_b64_tr_b16 v[226:227], v4 offset:17920
    s_waitcnt lgkmcnt(6)
    v_mfma_f32_16x16x32_bf16 v[96:99], v[236:239], v[32:35], v[96:99]
    ds_read_b64_tr_b16 v[228:229], v5 offset:16928
    v_mfma_f32_16x16x32_bf16 v[100:103], v[236:239], v[36:39], v[100:103]
    ds_read_b64_tr_b16 v[230:231], v5 offset:17952
    s_waitcnt lgkmcnt(6)
    v_mfma_f32_16x16x32_bf16 v[104:107], v[240:243], v[32:35], v[104:107]
    ds_read_b64_tr_b16 v[232:233], v4 offset:17152
    v_mfma_f32_16x16x32_bf16 v[108:111], v[240:243], v[36:39], v[108:111]
    ds_read_b64_tr_b16 v[234:235], v4 offset:18176
    s_waitcnt lgkmcnt(6)
    v_mfma_f32_16x16x32_bf16 v[112:115], v[244:247], v[32:35], v[112:115]
    ds_read_b64_tr_b16 v[236:237], v5 offset:17184
    v_mfma_f32_16x16x32_bf16 v[116:119], v[244:247], v[36:39], v[116:119]
    ds_read_b64_tr_b16 v[238:239], v5 offset:18208
    s_waitcnt lgkmcnt(6)
    v_mfma_f32_16x16x32_bf16 v[120:123], v[224:227], v[32:35], v[120:123]
    v_mfma_f32_16x16x32_bf16 v[124:127], v[224:227], v[36:39], v[124:127]
    s_waitcnt lgkmcnt(4)
    v_mfma_f32_16x16x32_bf16 v[128:131], v[228:231], v[32:35], v[128:131]
    v_mfma_f32_16x16x32_bf16 v[132:135], v[228:231], v[36:39], v[132:135]
    s_waitcnt lgkmcnt(2)
    v_mfma_f32_16x16x32_bf16 v[136:139], v[232:235], v[32:35], v[136:139]
    v_mfma_f32_16x16x32_bf16 v[140:143], v[232:235], v[36:39], v[140:143]
    s_waitcnt lgkmcnt(0)
    v_mfma_f32_16x16x32_bf16 v[144:147], v[236:239], v[32:35], v[144:147]
    v_mfma_f32_16x16x32_bf16 v[148:151], v[236:239], v[36:39], v[148:151]
    s_lshl_b32 s16, s3, 13
    s_xor_b32 s17, s16, 0x8000
    s_add_u32 s16, s16, 0x18000
    s_add_u32 s17, s17, 0x18000
    v_add_u32 v16, s16, v2
    s_mov_b32 s16, s17
    v_add_u32 v17, s16, v2
    ds_write_b128 v16, v[88:91] offset:0
    ds_write_b128 v16, v[92:95] offset:1024
    ds_write_b128 v16, v[96:99] offset:2048
    ds_write_b128 v16, v[100:103] offset:3072
    ds_write_b128 v16, v[104:107] offset:4096
    ds_write_b128 v16, v[108:111] offset:5120
    ds_write_b128 v16, v[112:115] offset:6144
    ds_write_b128 v16, v[116:119] offset:7168
    v_lshlrev_b32 v24, 16, v248
    v_and_b32 v25, 0xffff0000, v248
    v_lshlrev_b32 v26, 16, v249
    v_and_b32 v27, 0xffff0000, v249
    v_lshlrev_b32 v28, 16, v250
    v_and_b32 v29, 0xffff0000, v250
    v_lshlrev_b32 v30, 16, v251
    v_and_b32 v31, 0xffff0000, v251
    v_lshlrev_b32 v32, 16, v252
    v_and_b32 v33, 0xffff0000, v252
    v_lshlrev_b32 v34, 16, v253
    v_and_b32 v35, 0xffff0000, v253
    v_lshlrev_b32 v36, 16, v254
    v_and_b32 v37, 0xffff0000, v254
    v_lshlrev_b32 v38, 16, v255
    v_and_b32 v39, 0xffff0000, v255
    v_and_b32 v18, 15, v1
    v_lshlrev_b32 v18, 6, v18
    v_lshrrev_b32 v19, 4, v1
    v_and_b32 v20, 1, v19
    v_lshl_add_u32 v18, v20, 5, v18
    v_lshrrev_b32 v19, 1, v19
    v_lshl_add_u32 v18, v19, 4, v18
    s_and_b32 s17, s3, 3
    s_lshl_b32 s18, s30, 2
    s_add_u32 s18, s18, s17
    s_lshl_b32 s18, s18, 16
    s_lshl_b32 s19, s15, 22
    s_add_u32 s18, s18, s19
    s_lshl_b32 s19, s31, 12
    s_add_u32 s18, s18, s19
    s_add_u32 s18, s18, 0x2000800
    s_add_u32 s19, s18, 32768
    s_waitcnt lgkmcnt(0)
    s_barrier
    ds_read_b128 v[40:43], v17 offset:0
    ds_read_b128 v[44:47], v17 offset:1024
    ds_read_b128 v[48:51], v17 offset:2048
    ds_read_b128 v[52:55], v17 offset:3072
    ds_read_b128 v[56:59], v17 offset:4096
    ds_read_b128 v[60:63], v17 offset:5120
    ds_read_b128 v[64:67], v17 offset:6144
    ds_read_b128 v[68:71], v17 offset:7168
    s_waitcnt lgkmcnt(7)
    v_pk_add_f32 v[120:121], v[120:121], v[40:41]
    v_pk_add_f32 v[122:123], v[122:123], v[42:43]
    v_pk_mul_f32 v[120:121], v[120:121], v[24:25]
    v_pk_mul_f32 v[122:123], v[122:123], v[26:27]
    v_cvt_pk_bf16_f32 v224, v120, v121
    v_cvt_pk_bf16_f32 v225, v122, v123
    s_waitcnt lgkmcnt(5)
    v_pk_add_f32 v[128:129], v[128:129], v[48:49]
    v_pk_add_f32 v[130:131], v[130:131], v[50:51]
    v_pk_mul_f32 v[128:129], v[128:129], v[28:29]
    v_pk_mul_f32 v[130:131], v[130:131], v[30:31]
    v_cvt_pk_bf16_f32 v226, v128, v129
    v_cvt_pk_bf16_f32 v227, v130, v131
    s_nop 0
    v_permlane16_swap_b32 v224, v226
    v_permlane16_swap_b32 v225, v227
    buffer_store_dwordx4 v[224:227], v18, s[8:11], s18 offen offset:0 sc1
    v_pk_add_f32 v[124:125], v[124:125], v[44:45]
    v_pk_add_f32 v[126:127], v[126:127], v[46:47]
    v_pk_mul_f32 v[124:125], v[124:125], v[24:25]
    v_pk_mul_f32 v[126:127], v[126:127], v[26:27]
    v_cvt_pk_bf16_f32 v228, v124, v125
    v_cvt_pk_bf16_f32 v229, v126, v127
    s_waitcnt lgkmcnt(4)
    v_pk_add_f32 v[132:133], v[132:133], v[52:53]
    v_pk_add_f32 v[134:135], v[134:135], v[54:55]
    v_pk_mul_f32 v[132:133], v[132:133], v[28:29]
    v_pk_mul_f32 v[134:135], v[134:135], v[30:31]
    v_cvt_pk_bf16_f32 v230, v132, v133
    v_cvt_pk_bf16_f32 v231, v134, v135
    s_nop 0
    v_permlane16_swap_b32 v228, v230
    v_permlane16_swap_b32 v229, v231
    buffer_store_dwordx4 v[228:231], v18, s[8:11], s19 offen offset:0 sc1
    s_waitcnt lgkmcnt(3)
    v_pk_add_f32 v[136:137], v[136:137], v[56:57]
    v_pk_add_f32 v[138:139], v[138:139], v[58:59]
    v_pk_mul_f32 v[136:137], v[136:137], v[32:33]
    v_pk_mul_f32 v[138:139], v[138:139], v[34:35]
    v_cvt_pk_bf16_f32 v232, v136, v137
    v_cvt_pk_bf16_f32 v233, v138, v139
    s_waitcnt lgkmcnt(1)
    v_pk_add_f32 v[144:145], v[144:145], v[64:65]
    v_pk_add_f32 v[146:147], v[146:147], v[66:67]
    v_pk_mul_f32 v[144:145], v[144:145], v[36:37]
    v_pk_mul_f32 v[146:147], v[146:147], v[38:39]
    v_cvt_pk_bf16_f32 v234, v144, v145
    v_cvt_pk_bf16_f32 v235, v146, v147
    s_nop 0
    v_permlane16_swap_b32 v232, v234
    v_permlane16_swap_b32 v233, v235
    buffer_store_dwordx4 v[232:235], v18, s[8:11], s18 offen offset:1024 sc1
    v_pk_add_f32 v[140:141], v[140:141], v[60:61]
    v_pk_add_f32 v[142:143], v[142:143], v[62:63]
    v_pk_mul_f32 v[140:141], v[140:141], v[32:33]
    v_pk_mul_f32 v[142:143], v[142:143], v[34:35]
    v_cvt_pk_bf16_f32 v236, v140, v141
    v_cvt_pk_bf16_f32 v237, v142, v143
    s_waitcnt lgkmcnt(0)
    v_pk_add_f32 v[148:149], v[148:149], v[68:69]
    v_pk_add_f32 v[150:151], v[150:151], v[70:71]
    v_pk_mul_f32 v[148:149], v[148:149], v[36:37]
    v_pk_mul_f32 v[150:151], v[150:151], v[38:39]
    v_cvt_pk_bf16_f32 v238, v148, v149
    v_cvt_pk_bf16_f32 v239, v150, v151
    s_nop 0
    v_permlane16_swap_b32 v236, v238
    v_permlane16_swap_b32 v237, v239
    buffer_store_dwordx4 v[236:239], v18, s[8:11], s19 offen offset:1024 sc1
    s_mov_b64 s[64:65], s[44:45]
    s_mov_b32 s66, 0x800
    s_mov_b32 s67, 0x20000
    s_mov_b64 s[76:77], s[32:33]
    s_mov_b32 s78, 0x400000
    s_mov_b32 s79, 0x20000
    s_mov_b64 s[68:69], s[56:57]
    s_mov_b32 s70, 0x400000
    s_mov_b32 s71, 0x20000
    s_lshl_b32 s14, s31, 1
    s_add_u32 s14, s14, s15
    s_lshl_b32 s14, s14, 3
    s_add_u32 s14, s14, s3
    s_lshl_b32 s16, s30, 7
    s_add_u32 s14, s14, s16
    s_lshl_b32 s16, s14, 11
    buffer_load_dwordx4 v[216:219], v2, s[76:79], s16 offen offset:0
    buffer_load_dwordx4 v[220:223], v2, s[76:79], s16 offen offset:1024
    s_lshl_b32 s16, s3, 10
    s_add_u32 m0, s16, 81920
    s_add_u32 s17, s16, 0x540800
    s_cmp_lt_u32 s3, 6
    s_cselect_b32 s17, s17, 0x7ffffff0
    s_sub_u32 s23, s16, 6144
    s_cmp_ge_u32 s3, 6
    s_cselect_b32 s23, s23, 0x7ffffff0
    s_cbranch_scc1 adaLN_cond__sliding_block_cached__moe_arch_mod__prompt_kernel_mlw
    buffer_load_dwordx4 v2, s[8:11], s17 offen sc1 lds
    s_branch adaLN_cond__sliding_block_cached__moe_arch_mod__prompt_kernel_mlj
adaLN_cond__sliding_block_cached__moe_arch_mod__prompt_kernel_mlw:
    buffer_load_dwordx4 v2, s[64:67], s23 offen lds
adaLN_cond__sliding_block_cached__moe_arch_mod__prompt_kernel_mlj:
    s_lshl_b32 s16, s30, 5
    s_lshl_b32 s17, s31, 1
    s_add_u32 s16, s16, s17
    s_add_u32 s16, s16, s15
    s_lshl_b32 s16, s16, 2
    s_add_u32 s16, s16, 0x530000
    s_cmp_eq_u32 s3, 0
    s_cselect_b32 s16, s16, 0x7ffffff0
    v_mov_b32 v16, s28
    v_mov_b32 v17, 0
    s_lshr_b32 s18, s14, 4
    s_lshl_b32 s18, s18, 15
    s_and_b32 s19, s14, 15
    s_lshl_b32 s19, s19, 6
    s_add_u32 s18, s18, s19
    s_add_u32 s18, s18, 0x2000000
    s_add_u32 s19, s18, 16384
    v_lshrrev_b32 v18, 2, v1
    v_lshlrev_b32 v18, 10, v18
    v_and_b32 v19, 3, v1
    v_lshl_add_u32 v18, v19, 4, v18
    v_add_u32 v19, 0x400000, v18
    s_lshl_b32 s25, s30, 7
    s_add_u32 s25, s25, 0x530000
    v_and_b32 v20, 15, v1
    v_lshlrev_b32 v20, 2, v20
    s_waitcnt vmcnt(3)
    s_waitcnt vmcnt(0)
    s_barrier
    s_mov_b64 exec, 1
    buffer_store_dword v16, v17, s[8:11], s16 offen sc1
    s_mov_b64 exec, -1
    v_add_u32 v16, 81920, v2
    ds_read_b128 v[184:187], v16 offset:0
    ds_read_b128 v[188:191], v16 offset:1024
    ds_read_b128 v[192:195], v16 offset:2048
    ds_read_b128 v[196:199], v16 offset:3072
    ds_read_b128 v[200:203], v16 offset:4096
    ds_read_b128 v[204:207], v16 offset:5120
    ds_read_b128 v[208:211], v16 offset:6144
    ds_read_b128 v[212:215], v16 offset:7168
    v_mov_b32 v94, 0
    v_mov_b32 v95, 0
    s_waitcnt lgkmcnt(5)
    v_lshlrev_b32 v76, 16, v192
    v_and_b32 v77, 0xffff0000, v192
    s_waitcnt lgkmcnt(1)
    v_lshlrev_b32 v78, 16, v208
    v_and_b32 v79, 0xffff0000, v208
    v_pk_mul_f32 v[60:61], v[76:77], v[78:79]
    v_lshlrev_b32 v76, 16, v184
    v_and_b32 v77, 0xffff0000, v184
    v_fmac_f32 v94, v76, v78
    v_fmac_f32 v94, v77, v79
    v_add_f32 v95, v95, v60
    v_add_f32 v95, v95, v61
    v_lshlrev_b32 v76, 16, v193
    v_and_b32 v77, 0xffff0000, v193
    v_lshlrev_b32 v78, 16, v209
    v_and_b32 v79, 0xffff0000, v209
    v_pk_mul_f32 v[62:63], v[76:77], v[78:79]
    v_lshlrev_b32 v76, 16, v185
    v_and_b32 v77, 0xffff0000, v185
    v_fmac_f32 v94, v76, v78
    v_fmac_f32 v94, v77, v79
    v_add_f32 v95, v95, v62
    v_add_f32 v95, v95, v63
    v_lshlrev_b32 v76, 16, v194
    v_and_b32 v77, 0xffff0000, v194
    v_lshlrev_b32 v78, 16, v210
    v_and_b32 v79, 0xffff0000, v210
    v_pk_mul_f32 v[64:65], v[76:77], v[78:79]
    v_lshlrev_b32 v76, 16, v186
    v_and_b32 v77, 0xffff0000, v186
    v_fmac_f32 v94, v76, v78
    v_fmac_f32 v94, v77, v79
    v_add_f32 v95, v95, v64
    v_add_f32 v95, v95, v65
    v_lshlrev_b32 v76, 16, v195
    v_and_b32 v77, 0xffff0000, v195
    v_lshlrev_b32 v78, 16, v211
    v_and_b32 v79, 0xffff0000, v211
    v_pk_mul_f32 v[66:67], v[76:77], v[78:79]
    v_lshlrev_b32 v76, 16, v187
    v_and_b32 v77, 0xffff0000, v187
    v_fmac_f32 v94, v76, v78
    v_fmac_f32 v94, v77, v79
    v_add_f32 v95, v95, v66
    v_add_f32 v95, v95, v67
    v_lshlrev_b32 v76, 16, v196
    v_and_b32 v77, 0xffff0000, v196
    s_waitcnt lgkmcnt(0)
    v_lshlrev_b32 v78, 16, v212
    v_and_b32 v79, 0xffff0000, v212
    v_pk_mul_f32 v[68:69], v[76:77], v[78:79]
    v_lshlrev_b32 v76, 16, v188
    v_and_b32 v77, 0xffff0000, v188
    v_fmac_f32 v94, v76, v78
    v_fmac_f32 v94, v77, v79
    v_add_f32 v95, v95, v68
    v_add_f32 v95, v95, v69
    v_lshlrev_b32 v76, 16, v197
    v_and_b32 v77, 0xffff0000, v197
    v_lshlrev_b32 v78, 16, v213
    v_and_b32 v79, 0xffff0000, v213
    v_pk_mul_f32 v[70:71], v[76:77], v[78:79]
    v_lshlrev_b32 v76, 16, v189
    v_and_b32 v77, 0xffff0000, v189
    v_fmac_f32 v94, v76, v78
    v_fmac_f32 v94, v77, v79
    v_add_f32 v95, v95, v70
    v_add_f32 v95, v95, v71
    v_lshlrev_b32 v76, 16, v198
    v_and_b32 v77, 0xffff0000, v198
    v_lshlrev_b32 v78, 16, v214
    v_and_b32 v79, 0xffff0000, v214
    v_pk_mul_f32 v[72:73], v[76:77], v[78:79]
    v_lshlrev_b32 v76, 16, v190
    v_and_b32 v77, 0xffff0000, v190
    v_fmac_f32 v94, v76, v78
    v_fmac_f32 v94, v77, v79
    v_add_f32 v95, v95, v72
    v_add_f32 v95, v95, v73
    v_lshlrev_b32 v76, 16, v199
    v_and_b32 v77, 0xffff0000, v199
    v_lshlrev_b32 v78, 16, v215
    v_and_b32 v79, 0xffff0000, v215
    v_pk_mul_f32 v[74:75], v[76:77], v[78:79]
    v_lshlrev_b32 v76, 16, v191
    v_and_b32 v77, 0xffff0000, v191
    v_fmac_f32 v94, v76, v78
    v_fmac_f32 v94, v77, v79
    v_add_f32 v95, v95, v74
    v_add_f32 v95, v95, v75
    v_add_f32_dpp v94, v94, v94 row_ror:1 row_mask:0xf bank_mask:0xf
    s_nop 0
    v_add_f32_dpp v95, v95, v95 row_ror:1 row_mask:0xf bank_mask:0xf
    v_add_f32_dpp v94, v94, v94 row_ror:2 row_mask:0xf bank_mask:0xf
    s_nop 0
    v_add_f32_dpp v95, v95, v95 row_ror:2 row_mask:0xf bank_mask:0xf
    v_add_f32_dpp v94, v94, v94 row_ror:4 row_mask:0xf bank_mask:0xf
    s_nop 0
    v_add_f32_dpp v95, v95, v95 row_ror:4 row_mask:0xf bank_mask:0xf
    v_add_f32_dpp v94, v94, v94 row_ror:8 row_mask:0xf bank_mask:0xf
    s_nop 0
    v_add_f32_dpp v95, v95, v95 row_ror:8 row_mask:0xf bank_mask:0xf
    v_mov_b32 v76, v94
    s_nop 1
    v_permlane16_swap_b32 v94, v76
    v_add_f32 v94, v94, v76
    v_mov_b32 v77, v95
    s_nop 1
    v_permlane16_swap_b32 v95, v77
    v_add_f32 v95, v95, v77
    v_mov_b32 v76, v94
    s_nop 1
    v_permlane32_swap_b32 v94, v76
    v_add_f32 v94, v94, v76
    v_mov_b32 v77, v95
    s_nop 1
    v_permlane32_swap_b32 v95, v77
    v_add_f32 v95, v95, v77
    v_lshlrev_b32 v28, 16, v216
    v_and_b32 v29, 0xffff0000, v216
    v_lshlrev_b32 v30, 16, v217
    v_and_b32 v31, 0xffff0000, v217
    v_lshlrev_b32 v32, 16, v218
    v_and_b32 v33, 0xffff0000, v218
    v_lshlrev_b32 v34, 16, v219
    v_and_b32 v35, 0xffff0000, v219
    v_lshlrev_b32 v36, 16, v220
    v_and_b32 v37, 0xffff0000, v220
    v_lshlrev_b32 v38, 16, v221
    v_and_b32 v39, 0xffff0000, v221
    v_lshlrev_b32 v40, 16, v222
    v_and_b32 v41, 0xffff0000, v222
    v_lshlrev_b32 v42, 16, v223
    v_and_b32 v43, 0xffff0000, v223
    s_mov_b32 s27, 0
adaLN_cond__sliding_block_cached__moe_arch_mod__prompt_kernel_a22p:
    buffer_load_dword v76, v20, s[8:11], s25 offen sc1
    s_waitcnt vmcnt(0)
    v_cmp_ne_u32 vcc, s28, v76
    s_add_u32 s27, s27, 1
    s_cmp_ge_u32 s27, 65536
    s_cbranch_scc1 adaLN_cond__sliding_block_cached__moe_arch_mod__prompt_kernel_a22g
    s_cbranch_vccnz adaLN_cond__sliding_block_cached__moe_arch_mod__prompt_kernel_a22p
adaLN_cond__sliding_block_cached__moe_arch_mod__prompt_kernel_a22g:
    buffer_load_dwordx4 v[44:47], v18, s[8:11], s18 offen sc1
    buffer_load_dwordx4 v[52:55], v19, s[8:11], s18 offen sc1
    buffer_load_dwordx4 v[48:51], v18, s[8:11], s19 offen sc1
    buffer_load_dwordx4 v[56:59], v19, s[8:11], s19 offen sc1
    v_lshlrev_b32 v21, 2, v0
    s_mov_b32 s16, 0x540800
    buffer_load_dword v106, v21, s[8:11], s16 offen sc1
    buffer_load_dword v104, v21, s[8:11], s16 offen offset:2048 sc1
    s_waitcnt vmcnt(5)
    v_lshlrev_b32 v76, 16, v44
    v_and_b32 v77, 0xffff0000, v44
    s_waitcnt vmcnt(4)
    v_lshlrev_b32 v78, 16, v52
    v_and_b32 v79, 0xffff0000, v52
    v_pk_add_f32 v[76:77], v[76:77], v[78:79]
    v_pk_add_f32 v[28:29], v[28:29], v[76:77]
    v_cvt_pk_bf16_f32 v16, v28, v29
    v_lshlrev_b32 v28, 16, v16
    v_and_b32 v29, 0xffff0000, v16
    v_lshlrev_b32 v80, 16, v45
    v_and_b32 v81, 0xffff0000, v45
    v_lshlrev_b32 v82, 16, v53
    v_and_b32 v83, 0xffff0000, v53
    v_pk_add_f32 v[80:81], v[80:81], v[82:83]
    v_pk_add_f32 v[30:31], v[30:31], v[80:81]
    v_cvt_pk_bf16_f32 v17, v30, v31
    v_lshlrev_b32 v30, 16, v17
    v_and_b32 v31, 0xffff0000, v17
    v_lshlrev_b32 v76, 16, v46
    v_and_b32 v77, 0xffff0000, v46
    v_lshlrev_b32 v78, 16, v54
    v_and_b32 v79, 0xffff0000, v54
    v_pk_add_f32 v[76:77], v[76:77], v[78:79]
    v_pk_add_f32 v[32:33], v[32:33], v[76:77]
    v_cvt_pk_bf16_f32 v16, v32, v33
    v_lshlrev_b32 v32, 16, v16
    v_and_b32 v33, 0xffff0000, v16
    v_lshlrev_b32 v80, 16, v47
    v_and_b32 v81, 0xffff0000, v47
    v_lshlrev_b32 v82, 16, v55
    v_and_b32 v83, 0xffff0000, v55
    v_pk_add_f32 v[80:81], v[80:81], v[82:83]
    v_pk_add_f32 v[34:35], v[34:35], v[80:81]
    v_cvt_pk_bf16_f32 v17, v34, v35
    v_lshlrev_b32 v34, 16, v17
    v_and_b32 v35, 0xffff0000, v17
    s_waitcnt vmcnt(3)
    v_lshlrev_b32 v76, 16, v48
    v_and_b32 v77, 0xffff0000, v48
    s_waitcnt vmcnt(2)
    v_lshlrev_b32 v78, 16, v56
    v_and_b32 v79, 0xffff0000, v56
    v_pk_add_f32 v[76:77], v[76:77], v[78:79]
    v_pk_add_f32 v[36:37], v[36:37], v[76:77]
    v_cvt_pk_bf16_f32 v16, v36, v37
    v_lshlrev_b32 v36, 16, v16
    v_and_b32 v37, 0xffff0000, v16
    v_lshlrev_b32 v80, 16, v49
    v_and_b32 v81, 0xffff0000, v49
    v_lshlrev_b32 v82, 16, v57
    v_and_b32 v83, 0xffff0000, v57
    v_pk_add_f32 v[80:81], v[80:81], v[82:83]
    v_pk_add_f32 v[38:39], v[38:39], v[80:81]
    v_cvt_pk_bf16_f32 v17, v38, v39
    v_lshlrev_b32 v38, 16, v17
    v_and_b32 v39, 0xffff0000, v17
    v_lshlrev_b32 v76, 16, v50
    v_and_b32 v77, 0xffff0000, v50
    v_lshlrev_b32 v78, 16, v58
    v_and_b32 v79, 0xffff0000, v58
    v_pk_add_f32 v[76:77], v[76:77], v[78:79]
    v_pk_add_f32 v[40:41], v[40:41], v[76:77]
    v_cvt_pk_bf16_f32 v16, v40, v41
    v_lshlrev_b32 v40, 16, v16
    v_and_b32 v41, 0xffff0000, v16
    v_lshlrev_b32 v80, 16, v51
    v_and_b32 v81, 0xffff0000, v51
    v_lshlrev_b32 v82, 16, v59
    v_and_b32 v83, 0xffff0000, v59
    v_pk_add_f32 v[80:81], v[80:81], v[82:83]
    v_pk_add_f32 v[42:43], v[42:43], v[80:81]
    v_cvt_pk_bf16_f32 v17, v42, v43
    v_lshlrev_b32 v42, 16, v17
    v_and_b32 v43, 0xffff0000, v17
    v_pk_add_f32 v[76:77], v[28:29], v[30:31]
    v_pk_mul_f32 v[78:79], v[28:29], v[28:29]
    v_pk_mul_f32 v[80:81], v[28:29], v[60:61]
    v_pk_fma_f32 v[78:79], v[30:31], v[30:31], v[78:79]
    v_pk_fma_f32 v[80:81], v[30:31], v[62:63], v[80:81]
    v_pk_add_f32 v[76:77], v[76:77], v[32:33]
    v_pk_fma_f32 v[78:79], v[32:33], v[32:33], v[78:79]
    v_pk_fma_f32 v[80:81], v[32:33], v[64:65], v[80:81]
    v_pk_add_f32 v[76:77], v[76:77], v[34:35]
    v_pk_fma_f32 v[78:79], v[34:35], v[34:35], v[78:79]
    v_pk_fma_f32 v[80:81], v[34:35], v[66:67], v[80:81]
    v_pk_add_f32 v[76:77], v[76:77], v[36:37]
    v_pk_fma_f32 v[78:79], v[36:37], v[36:37], v[78:79]
    v_pk_fma_f32 v[80:81], v[36:37], v[68:69], v[80:81]
    v_pk_add_f32 v[76:77], v[76:77], v[38:39]
    v_pk_fma_f32 v[78:79], v[38:39], v[38:39], v[78:79]
    v_pk_fma_f32 v[80:81], v[38:39], v[70:71], v[80:81]
    v_pk_add_f32 v[76:77], v[76:77], v[40:41]
    v_pk_fma_f32 v[78:79], v[40:41], v[40:41], v[78:79]
    v_pk_fma_f32 v[80:81], v[40:41], v[72:73], v[80:81]
    v_pk_add_f32 v[76:77], v[76:77], v[42:43]
    v_pk_fma_f32 v[78:79], v[42:43], v[42:43], v[78:79]
    v_pk_fma_f32 v[80:81], v[42:43], v[74:75], v[80:81]
    v_add_f32 v96, v76, v77
    v_add_f32 v97, v78, v79
    v_add_f32 v98, v80, v81
    v_add_f32_dpp v96, v96, v96 row_ror:1 row_mask:0xf bank_mask:0xf
    v_add_f32_dpp v97, v97, v97 row_ror:1 row_mask:0xf bank_mask:0xf
    v_add_f32_dpp v98, v98, v98 row_ror:1 row_mask:0xf bank_mask:0xf
    v_add_f32_dpp v96, v96, v96 row_ror:2 row_mask:0xf bank_mask:0xf
    v_add_f32_dpp v97, v97, v97 row_ror:2 row_mask:0xf bank_mask:0xf
    v_add_f32_dpp v98, v98, v98 row_ror:2 row_mask:0xf bank_mask:0xf
    v_add_f32_dpp v96, v96, v96 row_ror:4 row_mask:0xf bank_mask:0xf
    v_add_f32_dpp v97, v97, v97 row_ror:4 row_mask:0xf bank_mask:0xf
    v_add_f32_dpp v98, v98, v98 row_ror:4 row_mask:0xf bank_mask:0xf
    v_add_f32_dpp v96, v96, v96 row_ror:8 row_mask:0xf bank_mask:0xf
    v_add_f32_dpp v97, v97, v97 row_ror:8 row_mask:0xf bank_mask:0xf
    v_add_f32_dpp v98, v98, v98 row_ror:8 row_mask:0xf bank_mask:0xf
    v_mov_b32 v76, v96
    s_nop 1
    v_permlane16_swap_b32 v96, v76
    v_add_f32 v96, v96, v76
    v_mov_b32 v77, v97
    s_nop 1
    v_permlane16_swap_b32 v97, v77
    v_add_f32 v97, v97, v77
    v_mov_b32 v78, v98
    s_nop 1
    v_permlane16_swap_b32 v98, v78
    v_add_f32 v98, v98, v78
    v_mov_b32 v76, v96
    s_nop 1
    v_permlane32_swap_b32 v96, v76
    v_add_f32 v96, v96, v76
    v_mov_b32 v77, v97
    s_nop 1
    v_permlane32_swap_b32 v97, v77
    v_add_f32 v97, v97, v77
    v_mov_b32 v78, v98
    s_nop 1
    v_permlane32_swap_b32 v98, v78
    v_add_f32 v98, v98, v78
    v_mul_f32 v96, 0x3a800000, v96
    v_mul_f32 v97, 0x3a800000, v97
    v_fma_f32 v97, -v96, v96, v97
    v_max_f32 v97, 0, v97
    v_fma_f32 v98, -v96, v95, v98
    v_add_f32 v76, 0x3727c5ac, v97
    v_rsq_f32 v76, v76
    s_nop 0
    v_fma_f32 v27, v98, v76, v94
    v_cvt_pk_bf16_f32 v96, v96, v96
    v_lshlrev_b32 v96, 16, v96
    v_cvt_pk_bf16_f32 v97, v97, v97
    v_lshlrev_b32 v97, 16, v97
    v_add_f32 v97, 0x3727c5ac, v97
    v_cvt_pk_bf16_f32 v97, v97, v97
    v_lshlrev_b32 v97, 16, v97
    v_sqrt_f32 v98, v97
    s_nop 0
    v_cvt_pk_bf16_f32 v98, v98, v98
    v_lshlrev_b32 v98, 16, v98
    v_rcp_f32 v99, v98
    v_mov_b32 v25, v96
    v_mov_b32 v26, v98
    v_ashrrev_i32 v16, 31, v27
    v_or_b32 v16, 0x80000000, v16
    v_xor_b32 v24, v27, v16
    v_and_b32 v24, 0xfffff800, v24
    v_max_u32 v24, 0x800, v24
    s_sub_u32 s16, 2047, s14
    v_or_b32 v24, s16, v24
    s_lshl_b32 s16, s3, 4
    s_add_u32 s16, s16, 65536
    v_mov_b32 v16, s16
    ds_write_b128 v16, v[24:27]
    s_waitcnt lgkmcnt(0)
    s_barrier
    v_and_b32 v16, 7, v1
    v_lshlrev_b32 v16, 4, v16
    v_add_u32 v16, 65536, v16
    ds_read_b32 v76, v16
    s_waitcnt lgkmcnt(0)
    v_mov_b32 v77, v76
    s_nop 1
    v_max_u32_dpp v77, v77, v77 row_ror:1 row_mask:0xf bank_mask:0xf
    s_nop 1
    v_max_u32_dpp v77, v77, v77 row_ror:2 row_mask:0xf bank_mask:0xf
    s_nop 1
    v_max_u32_dpp v77, v77, v77 row_ror:4 row_mask:0xf bank_mask:0xf
    v_cmp_eq_u32 vcc, v76, v77
    s_ff1_i32_b64 s16, vcc
    s_lshl_b32 s16, s16, 4
    s_add_u32 s16, s16, 65536
    v_mov_b32 v16, s16
    ds_read_b128 v[24:27], v16
    s_lshl_b32 s16, s2, 4
    s_add_u32 s16, s16, 0x6e0000
    s_cmp_eq_u32 s3, 0
    s_cselect_b32 s16, s16, 0x7ffffff0
    v_mov_b32 v17, 0
    s_mov_b64 exec, 1
    s_waitcnt lgkmcnt(0)
    buffer_store_dwordx4 v[24:27], v17, s[8:11], s16 offen sc1
    s_mov_b64 exec, -1
    s_mov_b64 s[72:73], s[50:51]
    s_mov_b32 s74, 0x700000
    s_mov_b32 s75, 0x20000
    s_cmp_lt_u32 s2, 224
    s_cselect_b32 s74, 7340032, 0
    s_lshl_b32 s17, s29, 4
    s_sub_u32 s16, s3, 4
    s_lshl_b32 s16, s16, 2
    s_add_u32 s16, s16, s17
    s_lshl_b32 s16, s16, 11
    s_add_u32 s17, s16, 0
    buffer_load_dwordx4 v[152:155], v2, s[72:75], s17 offen offset:0
    buffer_load_dwordx4 v[156:159], v2, s[72:75], s17 offen offset:1024
    s_add_u32 s17, s16, 2048
    buffer_load_dwordx4 v[160:163], v2, s[72:75], s17 offen offset:0
    buffer_load_dwordx4 v[164:167], v2, s[72:75], s17 offen offset:1024
    s_add_u32 s17, s16, 4096
    buffer_load_dwordx4 v[168:171], v2, s[72:75], s17 offen offset:0
    buffer_load_dwordx4 v[172:175], v2, s[72:75], s17 offen offset:1024
    s_add_u32 s17, s16, 6144
    buffer_load_dwordx4 v[176:179], v2, s[72:75], s17 offen offset:0
    buffer_load_dwordx4 v[180:183], v2, s[72:75], s17 offen offset:1024
    v_sub_f32 v44, v28, v96
    v_sub_f32 v45, v29, v96
    v_sub_f32 v46, v30, v96
    v_sub_f32 v47, v31, v96
    v_sub_f32 v48, v32, v96
    v_sub_f32 v49, v33, v96
    v_sub_f32 v50, v34, v96
    v_sub_f32 v51, v35, v96
    v_cvt_pk_bf16_f32 v16, v44, v45
    v_lshlrev_b32 v44, 16, v16
    v_and_b32 v45, 0xffff0000, v16
    v_cvt_pk_bf16_f32 v16, v46, v47
    v_lshlrev_b32 v46, 16, v16
    v_and_b32 v47, 0xffff0000, v16
    v_cvt_pk_bf16_f32 v16, v48, v49
    v_lshlrev_b32 v48, 16, v16
    v_and_b32 v49, 0xffff0000, v16
    v_cvt_pk_bf16_f32 v16, v50, v51
    v_lshlrev_b32 v50, 16, v16
    v_and_b32 v51, 0xffff0000, v16
    v_mul_f32 v52, v44, v99
    v_mul_f32 v53, v45, v99
    v_mul_f32 v54, v46, v99
    v_mul_f32 v55, v47, v99
    v_mul_f32 v56, v48, v99
    v_mul_f32 v57, v49, v99
    v_mul_f32 v58, v50, v99
    v_mul_f32 v59, v51, v99
    v_fma_f32 v44, -v52, v98, v44
    v_fma_f32 v45, -v53, v98, v45
    v_fma_f32 v46, -v54, v98, v46
    v_fma_f32 v47, -v55, v98, v47
    v_fma_f32 v48, -v56, v98, v48
    v_fma_f32 v49, -v57, v98, v49
    v_fma_f32 v50, -v58, v98, v50
    v_fma_f32 v51, -v59, v98, v51
    v_fma_f32 v44, v44, v99, v52
    v_fma_f32 v45, v45, v99, v53
    v_fma_f32 v46, v46, v99, v54
    v_fma_f32 v47, v47, v99, v55
    v_fma_f32 v48, v48, v99, v56
    v_fma_f32 v49, v49, v99, v57
    v_fma_f32 v50, v50, v99, v58
    v_fma_f32 v51, v51, v99, v59
    v_cvt_pk_bf16_f32 v16, v44, v45
    v_lshlrev_b32 v44, 16, v16
    v_and_b32 v45, 0xffff0000, v16
    v_cvt_pk_bf16_f32 v16, v46, v47
    v_lshlrev_b32 v46, 16, v16
    v_and_b32 v47, 0xffff0000, v16
    v_cvt_pk_bf16_f32 v16, v48, v49
    v_lshlrev_b32 v48, 16, v16
    v_and_b32 v49, 0xffff0000, v16
    v_cvt_pk_bf16_f32 v16, v50, v51
    v_lshlrev_b32 v50, 16, v16
    v_and_b32 v51, 0xffff0000, v16
    v_lshlrev_b32 v52, 16, v192
    v_and_b32 v53, 0xffff0000, v192
    v_lshlrev_b32 v54, 16, v193
    v_and_b32 v55, 0xffff0000, v193
    v_lshlrev_b32 v56, 16, v194
    v_and_b32 v57, 0xffff0000, v194
    v_lshlrev_b32 v58, 16, v195
    v_and_b32 v59, 0xffff0000, v195
    v_pk_mul_f32 v[44:45], v[44:45], v[52:53]
    v_pk_mul_f32 v[46:47], v[46:47], v[54:55]
    v_pk_mul_f32 v[48:49], v[48:49], v[56:57]
    v_pk_mul_f32 v[50:51], v[50:51], v[58:59]
    v_cvt_pk_bf16_f32 v16, v44, v45
    v_lshlrev_b32 v44, 16, v16
    v_and_b32 v45, 0xffff0000, v16
    v_cvt_pk_bf16_f32 v16, v46, v47
    v_lshlrev_b32 v46, 16, v16
    v_and_b32 v47, 0xffff0000, v16
    v_cvt_pk_bf16_f32 v16, v48, v49
    v_lshlrev_b32 v48, 16, v16
    v_and_b32 v49, 0xffff0000, v16
    v_cvt_pk_bf16_f32 v16, v50, v51
    v_lshlrev_b32 v50, 16, v16
    v_and_b32 v51, 0xffff0000, v16
    v_lshlrev_b32 v52, 16, v184
    v_and_b32 v53, 0xffff0000, v184
    v_lshlrev_b32 v54, 16, v185
    v_and_b32 v55, 0xffff0000, v185
    v_lshlrev_b32 v56, 16, v186
    v_and_b32 v57, 0xffff0000, v186
    v_lshlrev_b32 v58, 16, v187
    v_and_b32 v59, 0xffff0000, v187
    v_pk_add_f32 v[44:45], v[44:45], v[52:53]
    v_pk_add_f32 v[46:47], v[46:47], v[54:55]
    v_pk_add_f32 v[48:49], v[48:49], v[56:57]
    v_pk_add_f32 v[50:51], v[50:51], v[58:59]
    v_cvt_pk_bf16_f32 v16, v44, v45
    v_lshlrev_b32 v44, 16, v16
    v_and_b32 v45, 0xffff0000, v16
    v_cvt_pk_bf16_f32 v16, v46, v47
    v_lshlrev_b32 v46, 16, v16
    v_and_b32 v47, 0xffff0000, v16
    v_cvt_pk_bf16_f32 v16, v48, v49
    v_lshlrev_b32 v48, 16, v16
    v_and_b32 v49, 0xffff0000, v16
    v_cvt_pk_bf16_f32 v16, v50, v51
    v_lshlrev_b32 v50, 16, v16
    v_and_b32 v51, 0xffff0000, v16
    v_lshlrev_b32 v52, 16, v200
    v_and_b32 v53, 0xffff0000, v200
    v_lshlrev_b32 v54, 16, v201
    v_and_b32 v55, 0xffff0000, v201
    v_lshlrev_b32 v56, 16, v202
    v_and_b32 v57, 0xffff0000, v202
    v_lshlrev_b32 v58, 16, v203
    v_and_b32 v59, 0xffff0000, v203
    v_pk_mul_f32 v[44:45], v[44:45], v[52:53]
    v_pk_mul_f32 v[46:47], v[46:47], v[54:55]
    v_pk_mul_f32 v[48:49], v[48:49], v[56:57]
    v_pk_mul_f32 v[50:51], v[50:51], v[58:59]
    v_cvt_pk_bf16_f32 v16, v44, v45
    v_lshlrev_b32 v44, 16, v16
    v_and_b32 v45, 0xffff0000, v16
    v_cvt_pk_bf16_f32 v16, v46, v47
    v_lshlrev_b32 v46, 16, v16
    v_and_b32 v47, 0xffff0000, v16
    v_cvt_pk_bf16_f32 v16, v48, v49
    v_lshlrev_b32 v48, 16, v16
    v_and_b32 v49, 0xffff0000, v16
    v_cvt_pk_bf16_f32 v16, v50, v51
    v_lshlrev_b32 v50, 16, v16
    v_and_b32 v51, 0xffff0000, v16
    v_pk_add_f32 v[44:45], v[44:45], v[28:29]
    v_pk_add_f32 v[46:47], v[46:47], v[30:31]
    v_pk_add_f32 v[48:49], v[48:49], v[32:33]
    v_pk_add_f32 v[50:51], v[50:51], v[34:35]
    v_cvt_pk_bf16_f32 v28, v44, v45
    v_cvt_pk_bf16_f32 v29, v46, v47
    v_cvt_pk_bf16_f32 v30, v48, v49
    v_cvt_pk_bf16_f32 v31, v50, v51
    v_sub_f32 v44, v36, v96
    v_sub_f32 v45, v37, v96
    v_sub_f32 v46, v38, v96
    v_sub_f32 v47, v39, v96
    v_sub_f32 v48, v40, v96
    v_sub_f32 v49, v41, v96
    v_sub_f32 v50, v42, v96
    v_sub_f32 v51, v43, v96
    v_cvt_pk_bf16_f32 v16, v44, v45
    v_lshlrev_b32 v44, 16, v16
    v_and_b32 v45, 0xffff0000, v16
    v_cvt_pk_bf16_f32 v16, v46, v47
    v_lshlrev_b32 v46, 16, v16
    v_and_b32 v47, 0xffff0000, v16
    v_cvt_pk_bf16_f32 v16, v48, v49
    v_lshlrev_b32 v48, 16, v16
    v_and_b32 v49, 0xffff0000, v16
    v_cvt_pk_bf16_f32 v16, v50, v51
    v_lshlrev_b32 v50, 16, v16
    v_and_b32 v51, 0xffff0000, v16
    v_mul_f32 v52, v44, v99
    v_mul_f32 v53, v45, v99
    v_mul_f32 v54, v46, v99
    v_mul_f32 v55, v47, v99
    v_mul_f32 v56, v48, v99
    v_mul_f32 v57, v49, v99
    v_mul_f32 v58, v50, v99
    v_mul_f32 v59, v51, v99
    v_fma_f32 v44, -v52, v98, v44
    v_fma_f32 v45, -v53, v98, v45
    v_fma_f32 v46, -v54, v98, v46
    v_fma_f32 v47, -v55, v98, v47
    v_fma_f32 v48, -v56, v98, v48
    v_fma_f32 v49, -v57, v98, v49
    v_fma_f32 v50, -v58, v98, v50
    v_fma_f32 v51, -v59, v98, v51
    v_fma_f32 v44, v44, v99, v52
    v_fma_f32 v45, v45, v99, v53
    v_fma_f32 v46, v46, v99, v54
    v_fma_f32 v47, v47, v99, v55
    v_fma_f32 v48, v48, v99, v56
    v_fma_f32 v49, v49, v99, v57
    v_fma_f32 v50, v50, v99, v58
    v_fma_f32 v51, v51, v99, v59
    v_cvt_pk_bf16_f32 v16, v44, v45
    v_lshlrev_b32 v44, 16, v16
    v_and_b32 v45, 0xffff0000, v16
    v_cvt_pk_bf16_f32 v16, v46, v47
    v_lshlrev_b32 v46, 16, v16
    v_and_b32 v47, 0xffff0000, v16
    v_cvt_pk_bf16_f32 v16, v48, v49
    v_lshlrev_b32 v48, 16, v16
    v_and_b32 v49, 0xffff0000, v16
    v_cvt_pk_bf16_f32 v16, v50, v51
    v_lshlrev_b32 v50, 16, v16
    v_and_b32 v51, 0xffff0000, v16
    v_lshlrev_b32 v52, 16, v196
    v_and_b32 v53, 0xffff0000, v196
    v_lshlrev_b32 v54, 16, v197
    v_and_b32 v55, 0xffff0000, v197
    v_lshlrev_b32 v56, 16, v198
    v_and_b32 v57, 0xffff0000, v198
    v_lshlrev_b32 v58, 16, v199
    v_and_b32 v59, 0xffff0000, v199
    v_pk_mul_f32 v[44:45], v[44:45], v[52:53]
    v_pk_mul_f32 v[46:47], v[46:47], v[54:55]
    v_pk_mul_f32 v[48:49], v[48:49], v[56:57]
    v_pk_mul_f32 v[50:51], v[50:51], v[58:59]
    v_cvt_pk_bf16_f32 v16, v44, v45
    v_lshlrev_b32 v44, 16, v16
    v_and_b32 v45, 0xffff0000, v16
    v_cvt_pk_bf16_f32 v16, v46, v47
    v_lshlrev_b32 v46, 16, v16
    v_and_b32 v47, 0xffff0000, v16
    v_cvt_pk_bf16_f32 v16, v48, v49
    v_lshlrev_b32 v48, 16, v16
    v_and_b32 v49, 0xffff0000, v16
    v_cvt_pk_bf16_f32 v16, v50, v51
    v_lshlrev_b32 v50, 16, v16
    v_and_b32 v51, 0xffff0000, v16
    v_lshlrev_b32 v52, 16, v188
    v_and_b32 v53, 0xffff0000, v188
    v_lshlrev_b32 v54, 16, v189
    v_and_b32 v55, 0xffff0000, v189
    v_lshlrev_b32 v56, 16, v190
    v_and_b32 v57, 0xffff0000, v190
    v_lshlrev_b32 v58, 16, v191
    v_and_b32 v59, 0xffff0000, v191
    v_pk_add_f32 v[44:45], v[44:45], v[52:53]
    v_pk_add_f32 v[46:47], v[46:47], v[54:55]
    v_pk_add_f32 v[48:49], v[48:49], v[56:57]
    v_pk_add_f32 v[50:51], v[50:51], v[58:59]
    v_cvt_pk_bf16_f32 v16, v44, v45
    v_lshlrev_b32 v44, 16, v16
    v_and_b32 v45, 0xffff0000, v16
    v_cvt_pk_bf16_f32 v16, v46, v47
    v_lshlrev_b32 v46, 16, v16
    v_and_b32 v47, 0xffff0000, v16
    v_cvt_pk_bf16_f32 v16, v48, v49
    v_lshlrev_b32 v48, 16, v16
    v_and_b32 v49, 0xffff0000, v16
    v_cvt_pk_bf16_f32 v16, v50, v51
    v_lshlrev_b32 v50, 16, v16
    v_and_b32 v51, 0xffff0000, v16
    v_lshlrev_b32 v52, 16, v204
    v_and_b32 v53, 0xffff0000, v204
    v_lshlrev_b32 v54, 16, v205
    v_and_b32 v55, 0xffff0000, v205
    v_lshlrev_b32 v56, 16, v206
    v_and_b32 v57, 0xffff0000, v206
    v_lshlrev_b32 v58, 16, v207
    v_and_b32 v59, 0xffff0000, v207
    v_pk_mul_f32 v[44:45], v[44:45], v[52:53]
    v_pk_mul_f32 v[46:47], v[46:47], v[54:55]
    v_pk_mul_f32 v[48:49], v[48:49], v[56:57]
    v_pk_mul_f32 v[50:51], v[50:51], v[58:59]
    v_cvt_pk_bf16_f32 v16, v44, v45
    v_lshlrev_b32 v44, 16, v16
    v_and_b32 v45, 0xffff0000, v16
    v_cvt_pk_bf16_f32 v16, v46, v47
    v_lshlrev_b32 v46, 16, v16
    v_and_b32 v47, 0xffff0000, v16
    v_cvt_pk_bf16_f32 v16, v48, v49
    v_lshlrev_b32 v48, 16, v16
    v_and_b32 v49, 0xffff0000, v16
    v_cvt_pk_bf16_f32 v16, v50, v51
    v_lshlrev_b32 v50, 16, v16
    v_and_b32 v51, 0xffff0000, v16
    v_pk_add_f32 v[44:45], v[44:45], v[36:37]
    v_pk_add_f32 v[46:47], v[46:47], v[38:39]
    v_pk_add_f32 v[48:49], v[48:49], v[40:41]
    v_pk_add_f32 v[50:51], v[50:51], v[42:43]
    v_cvt_pk_bf16_f32 v36, v44, v45
    v_cvt_pk_bf16_f32 v37, v46, v47
    v_cvt_pk_bf16_f32 v38, v48, v49
    v_cvt_pk_bf16_f32 v39, v50, v51
    s_barrier
    v_and_b32 v16, 3, v1
    v_lshlrev_b32 v16, 4, v16
    v_add_u32 v16, 65792, v16
    ds_read_b32 v76, v16
    s_waitcnt lgkmcnt(0)
    v_mov_b32 v77, v76
    s_nop 1
    v_max_u32_dpp v77, v77, v77 row_ror:1 row_mask:0xf bank_mask:0xf
    s_nop 1
    v_max_u32_dpp v77, v77, v77 row_ror:2 row_mask:0xf bank_mask:0xf
    v_cmp_eq_u32 vcc, v76, v77
    s_ff1_i32_b64 s16, vcc
    s_lshl_b32 s16, s16, 4
    s_add_u32 s16, s16, 65792
    v_mov_b32 v16, s16
    ds_read_b128 v[24:27], v16
    s_waitcnt lgkmcnt(0)
    v_and_b32 v76, 0x7ff, v24
    v_sub_u32 v76, 2047, v76
    s_nop 0
    v_readfirstlane_b32 s12, v76
    v_rcp_f32 v103, v26
    s_lshr_b32 s18, s12, 4
    s_lshl_b32 s18, s18, 15
    s_and_b32 s19, s12, 15
    s_lshl_b32 s19, s19, 6
    s_add_u32 s18, s18, s19
    s_add_u32 s18, s18, 0x2000000
    s_add_u32 s19, s18, 0x400000
    v_lshrrev_b32 v18, 4, v0
    v_lshlrev_b32 v18, 10, v18
    v_and_b32 v19, 15, v0
    v_lshl_add_u32 v18, v19, 2, v18
    s_lshl_b32 s13, s12, 11
    buffer_load_dword v100, v18, s[8:11], s18 offen sc1
    buffer_load_dword v101, v18, s[8:11], s19 offen sc1
    buffer_load_dword v102, v21, s[76:79], s13 offen
    s_lshl_b32 s16, s14, 11
    s_cmp_lg_u32 s12, s14
    s_cselect_b32 s16, s16, 0x7ffffff0
    buffer_store_dwordx4 v[28:31], v2, s[68:71], s16 offen offset:0 sc1
    buffer_store_dwordx4 v[36:39], v2, s[68:71], s16 offen offset:1024 sc1
    s_lshl_b32 s16, s3, 13
    v_add_u32 v20, s16, v2
    s_waitcnt vmcnt(4)
    v_lshlrev_b32 v76, 16, v100
    v_and_b32 v77, 0xffff0000, v100
    s_waitcnt vmcnt(3)
    v_lshlrev_b32 v78, 16, v101
    v_and_b32 v79, 0xffff0000, v101
    v_pk_add_f32 v[76:77], v[76:77], v[78:79]
    s_waitcnt vmcnt(2)
    v_lshlrev_b32 v78, 16, v102
    v_and_b32 v79, 0xffff0000, v102
    v_pk_add_f32 v[92:93], v[78:79], v[76:77]
    v_cvt_pk_bf16_f32 v76, v92, v93
    v_lshlrev_b32 v92, 16, v76
    v_and_b32 v93, 0xffff0000, v76
    v_cvt_pk_bf16_f32 v100, v92, v93
    v_and_b32 v105, 0xffff0000, v104
    v_lshlrev_b32 v104, 16, v104
    v_and_b32 v107, 0xffff0000, v106
    v_lshlrev_b32 v106, 16, v106
    v_sub_f32 v92, v92, v25
    v_sub_f32 v93, v93, v25
    v_cvt_pk_bf16_f32 v76, v92, v93
    v_lshlrev_b32 v92, 16, v76
    v_and_b32 v93, 0xffff0000, v76
    v_mul_f32 v77, v92, v103
    v_fma_f32 v92, -v77, v26, v92
    v_fma_f32 v92, v92, v103, v77
    v_mul_f32 v77, v93, v103
    v_fma_f32 v93, -v77, v26, v93
    v_fma_f32 v93, v93, v103, v77
    v_cvt_pk_bf16_f32 v76, v92, v93
    v_lshlrev_b32 v92, 16, v76
    v_and_b32 v93, 0xffff0000, v76
    v_mul_f32 v92, v92, v104
    v_mul_f32 v93, v93, v105
    v_cvt_pk_bf16_f32 v76, v92, v93
    v_lshlrev_b32 v92, 16, v76
    v_and_b32 v93, 0xffff0000, v76
    v_add_f32 v92, v92, v106
    v_add_f32 v93, v93, v107
    v_cvt_pk_bf16_f32 v101, v92, v93
    v_add_u32 v16, 66560, v21
    ds_write_b32 v16, v101
    ds_write_b32 v16, v100 offset:2048
    s_waitcnt lgkmcnt(0)
    s_barrier
    ds_read_b128 v[60:63], v20 offset:0
    ds_read_b128 v[64:67], v20 offset:1024
    ds_read_b128 v[68:71], v20 offset:2048
    ds_read_b128 v[72:75], v20 offset:3072
    ds_read_b128 v[108:111], v20 offset:4096
    ds_read_b128 v[112:115], v20 offset:5120
    ds_read_b128 v[116:119], v20 offset:6144
    ds_read_b128 v[120:123], v20 offset:7168
    s_and_b32 s16, s3, 3
    s_lshl_b32 s16, s16, 7
    s_and_b32 s17, s29, 3
    s_lshl_b32 s17, s17, 9
    s_add_u32 s16, s16, s17
    s_add_u32 s16, s16, 66560
    v_lshrrev_b32 v16, 3, v1
    v_lshlrev_b32 v16, 4, v16
    v_add_u32 v16, s16, v16
    ds_read_b128 v[104:107], v16
    s_waitcnt lgkmcnt(0)
    v_lshlrev_b32 v76, 16, v104
    v_and_b32 v77, 0xffff, v104
    v_dot2_f32_bf16 v85, v60, v76, 0
    v_dot2_f32_bf16 v84, v60, v77, 0
    v_dot2_f32_bf16 v87, v61, v76, 0
    v_dot2_f32_bf16 v86, v61, v77, 0
    v_dot2_f32_bf16 v89, v62, v76, 0
    v_dot2_f32_bf16 v88, v62, v77, 0
    v_dot2_f32_bf16 v91, v63, v76, 0
    v_dot2_f32_bf16 v90, v63, v77, 0
    v_and_b32 v78, 0xffff0000, v104
    v_lshrrev_b32 v79, 16, v104
    v_dot2c_f32_bf16 v85, v64, v78
    v_dot2c_f32_bf16 v84, v64, v79
    v_dot2c_f32_bf16 v87, v65, v78
    v_dot2c_f32_bf16 v86, v65, v79
    v_dot2c_f32_bf16 v89, v66, v78
    v_dot2c_f32_bf16 v88, v66, v79
    v_dot2c_f32_bf16 v91, v67, v78
    v_dot2c_f32_bf16 v90, v67, v79
    v_lshlrev_b32 v80, 16, v105
    v_and_b32 v81, 0xffff, v105
    v_dot2c_f32_bf16 v85, v68, v80
    v_dot2c_f32_bf16 v84, v68, v81
    v_dot2c_f32_bf16 v87, v69, v80
    v_dot2c_f32_bf16 v86, v69, v81
    v_dot2c_f32_bf16 v89, v70, v80
    v_dot2c_f32_bf16 v88, v70, v81
    v_dot2c_f32_bf16 v91, v71, v80
    v_dot2c_f32_bf16 v90, v71, v81
    v_and_b32 v82, 0xffff0000, v105
    v_lshrrev_b32 v83, 16, v105
    v_dot2c_f32_bf16 v85, v72, v82
    v_dot2c_f32_bf16 v84, v72, v83
    v_dot2c_f32_bf16 v87, v73, v82
    v_dot2c_f32_bf16 v86, v73, v83
    v_dot2c_f32_bf16 v89, v74, v82
    v_dot2c_f32_bf16 v88, v74, v83
    v_dot2c_f32_bf16 v91, v75, v82
    v_dot2c_f32_bf16 v90, v75, v83
    v_lshlrev_b32 v76, 16, v106
    v_and_b32 v77, 0xffff, v106
    v_dot2c_f32_bf16 v85, v108, v76
    v_dot2c_f32_bf16 v84, v108, v77
    v_dot2c_f32_bf16 v87, v109, v76
    v_dot2c_f32_bf16 v86, v109, v77
    v_dot2c_f32_bf16 v89, v110, v76
    v_dot2c_f32_bf16 v88, v110, v77
    v_dot2c_f32_bf16 v91, v111, v76
    v_dot2c_f32_bf16 v90, v111, v77
    v_and_b32 v78, 0xffff0000, v106
    v_lshrrev_b32 v79, 16, v106
    v_dot2c_f32_bf16 v85, v112, v78
    v_dot2c_f32_bf16 v84, v112, v79
    v_dot2c_f32_bf16 v87, v113, v78
    v_dot2c_f32_bf16 v86, v113, v79
    v_dot2c_f32_bf16 v89, v114, v78
    v_dot2c_f32_bf16 v88, v114, v79
    v_dot2c_f32_bf16 v91, v115, v78
    v_dot2c_f32_bf16 v90, v115, v79
    v_lshlrev_b32 v80, 16, v107
    v_and_b32 v81, 0xffff, v107
    v_dot2c_f32_bf16 v85, v116, v80
    v_dot2c_f32_bf16 v84, v116, v81
    v_dot2c_f32_bf16 v87, v117, v80
    v_dot2c_f32_bf16 v86, v117, v81
    v_dot2c_f32_bf16 v89, v118, v80
    v_dot2c_f32_bf16 v88, v118, v81
    v_dot2c_f32_bf16 v91, v119, v80
    v_dot2c_f32_bf16 v90, v119, v81
    v_and_b32 v82, 0xffff0000, v107
    v_lshrrev_b32 v83, 16, v107
    v_dot2c_f32_bf16 v85, v120, v82
    v_dot2c_f32_bf16 v84, v120, v83
    v_dot2c_f32_bf16 v87, v121, v82
    v_dot2c_f32_bf16 v86, v121, v83
    v_dot2c_f32_bf16 v89, v122, v82
    v_dot2c_f32_bf16 v88, v122, v83
    v_dot2c_f32_bf16 v91, v123, v82
    v_dot2c_f32_bf16 v90, v123, v83
    s_nop 0
    v_permlane32_swap_b32 v84, v88
    v_permlane32_swap_b32 v85, v89
    v_permlane32_swap_b32 v86, v90
    v_permlane32_swap_b32 v87, v91
    v_add_f32 v84, v84, v88
    v_add_f32 v85, v85, v89
    v_add_f32 v86, v86, v90
    v_add_f32 v87, v87, v91
    s_nop 0
    v_permlane16_swap_b32 v84, v86
    v_permlane16_swap_b32 v85, v87
    v_add_f32 v84, v84, v86
    v_add_f32 v85, v85, v87
    s_nop 0
    v_add_f32_dpp v84, v84, v84 row_ror:8 row_mask:0xf bank_mask:0xf
    v_add_f32_dpp v85, v85, v85 row_ror:8 row_mask:0xf bank_mask:0xf
    v_and_b32 v16, 7, v1
    v_lshlrev_b32 v16, 5, v16
    v_lshrrev_b32 v17, 4, v1
    v_lshl_add_u32 v16, v17, 3, v16
    s_lshl_b32 s16, s3, 8
    s_add_u32 s16, s16, 70656
    v_add_u32 v16, s16, v16
    ds_write_b64 v16, v[84:85]
    s_lshr_b32 s16, s3, 2
    s_lshl_b32 s17, s16, 10
    s_add_u32 s17, s17, 70656
    v_lshlrev_b32 v17, 2, v1
    v_add_u32 v16, s17, v17
    s_and_b32 s17, s29, 3
    s_lshl_b32 s17, s17, 1
    s_add_u32 s17, s17, s16
    s_mul_i32 s17, s17, 14336
    s_lshr_b32 s16, s29, 2
    s_lshl_b32 s16, s16, 8
    s_add_u32 s17, s17, s16
    s_add_u32 s17, s17, 0x6e1000
    s_and_b32 s16, s3, 3
    s_cmp_eq_u32 s16, 0
    s_cselect_b32 s17, s17, 0x7ffffff0
    s_cmp_lt_u32 s2, 224
    s_cselect_b32 s17, s17, 0x7ffffff0
    s_waitcnt lgkmcnt(0)
    s_barrier
    ds_read_b32 v84, v16 offset:0
    ds_read_b32 v85, v16 offset:256
    ds_read_b32 v86, v16 offset:512
    ds_read_b32 v87, v16 offset:768
    s_waitcnt lgkmcnt(2)
    v_add_f32 v84, v84, v85
    s_waitcnt lgkmcnt(0)
    v_add_f32 v86, v86, v87
    v_add_f32 v84, v84, v86
    v_or_b32 v84, 1, v84
    buffer_store_dword v84, v17, s[8:11], s17 offen sc1
    v_lshrrev_b32 v16, 4, v1
    v_mul_u32_u24 v16, 28672, v16
    v_and_b32 v17, 15, v1
    v_lshl_add_u32 v16, v17, 2, v16
    s_lshl_b32 s16, s29, 6
    s_add_u32 s16, s16, 0x6e1000
    s_add_u32 s17, s16, 14336
    s_mov_b32 s27, 0
adaLN_cond__sliding_block_cached__moe_arch_mod__prompt_kernel_gu23p:
    buffer_load_dword v84, v16, s[8:11], s16 offen sc1
    buffer_load_dword v85, v16, s[8:11], s17 offen sc1
    s_waitcnt vmcnt(0)
    v_min_u32 v86, v84, v85
    v_cmp_eq_u32 vcc, 0, v86
    s_cmp_lt_u32 s2, 224
    s_cselect_b64 s[62:63], -1, 0
    s_and_b64 vcc, vcc, s[62:63]
    s_add_u32 s27, s27, 1
    s_cmp_ge_u32 s27, 65536
    s_cbranch_scc1 adaLN_cond__sliding_block_cached__moe_arch_mod__prompt_kernel_gu23g
    s_cbranch_vccnz adaLN_cond__sliding_block_cached__moe_arch_mod__prompt_kernel_gu23p
adaLN_cond__sliding_block_cached__moe_arch_mod__prompt_kernel_gu23g:
    v_mov_b32 v86, v84
    s_nop 1
    v_permlane16_swap_b32 v84, v86
    v_add_f32 v84, v84, v86
    v_mov_b32 v87, v85
    s_nop 1
    v_permlane16_swap_b32 v85, v87
    v_add_f32 v85, v85, v87
    v_mov_b32 v86, v84
    s_nop 1
    v_permlane32_swap_b32 v84, v86
    v_add_f32 v84, v84, v86
    v_mov_b32 v87, v85
    s_nop 1
    v_permlane32_swap_b32 v85, v87
    v_add_f32 v85, v85, v87
    v_cvt_pk_bf16_f32 v86, v84, v85
    v_lshlrev_b32 v84, 16, v86
    v_and_b32 v85, 0xffff0000, v86
    v_mul_f32 v86, 0xbfb8aa3b, v84
    v_exp_f32 v86, v86
    s_nop 0
    v_add_f32 v86, 1.0, v86
    v_rcp_f32 v86, v86
    s_nop 0
    v_mul_f32 v84, v84, v86
    v_cvt_pk_bf16_f32 v84, v84, v84
    v_lshlrev_b32 v84, 16, v84
    v_mul_f32 v84, v84, v85
    v_cvt_pk_bf16_f32 v84, v84, v84
    v_lshlrev_b32 v84, 16, v84
    s_sub_u32 s16, s3, 4
    s_lshl_b32 s16, s16, 2
    s_add_u32 s17, s16, 0
    v_readlane_b32 s20, v84, s17
    s_lshr_b32 s4, s20, 16
    s_add_u32 s17, s16, 1
    v_readlane_b32 s21, v84, s17
    s_lshr_b32 s5, s21, 16
    s_add_u32 s17, s16, 2
    v_readlane_b32 s22, v84, s17
    s_lshr_b32 s6, s22, 16
    s_add_u32 s17, s16, 3
    v_readlane_b32 s23, v84, s17
    s_lshr_b32 s7, s23, 16
    v_dot2_f32_bf16 v45, v152, s20, 0
    v_dot2_f32_bf16 v44, v152, s4, 0
    v_dot2_f32_bf16 v47, v153, s20, 0
    v_dot2_f32_bf16 v46, v153, s4, 0
    v_dot2_f32_bf16 v49, v154, s20, 0
    v_dot2_f32_bf16 v48, v154, s4, 0
    v_dot2_f32_bf16 v51, v155, s20, 0
    v_dot2_f32_bf16 v50, v155, s4, 0
    v_dot2_f32_bf16 v53, v156, s20, 0
    v_dot2_f32_bf16 v52, v156, s4, 0
    v_dot2_f32_bf16 v55, v157, s20, 0
    v_dot2_f32_bf16 v54, v157, s4, 0
    v_dot2_f32_bf16 v57, v158, s20, 0
    v_dot2_f32_bf16 v56, v158, s4, 0
    v_dot2_f32_bf16 v59, v159, s20, 0
    v_dot2_f32_bf16 v58, v159, s4, 0
    v_dot2c_f32_bf16 v45, s21, v160
    v_dot2c_f32_bf16 v44, s5, v160
    v_dot2c_f32_bf16 v47, s21, v161
    v_dot2c_f32_bf16 v46, s5, v161
    v_dot2c_f32_bf16 v49, s21, v162
    v_dot2c_f32_bf16 v48, s5, v162
    v_dot2c_f32_bf16 v51, s21, v163
    v_dot2c_f32_bf16 v50, s5, v163
    v_dot2c_f32_bf16 v53, s21, v164
    v_dot2c_f32_bf16 v52, s5, v164
    v_dot2c_f32_bf16 v55, s21, v165
    v_dot2c_f32_bf16 v54, s5, v165
    v_dot2c_f32_bf16 v57, s21, v166
    v_dot2c_f32_bf16 v56, s5, v166
    v_dot2c_f32_bf16 v59, s21, v167
    v_dot2c_f32_bf16 v58, s5, v167
    v_dot2c_f32_bf16 v45, s22, v168
    v_dot2c_f32_bf16 v44, s6, v168
    v_dot2c_f32_bf16 v47, s22, v169
    v_dot2c_f32_bf16 v46, s6, v169
    v_dot2c_f32_bf16 v49, s22, v170
    v_dot2c_f32_bf16 v48, s6, v170
    v_dot2c_f32_bf16 v51, s22, v171
    v_dot2c_f32_bf16 v50, s6, v171
    v_dot2c_f32_bf16 v53, s22, v172
    v_dot2c_f32_bf16 v52, s6, v172
    v_dot2c_f32_bf16 v55, s22, v173
    v_dot2c_f32_bf16 v54, s6, v173
    v_dot2c_f32_bf16 v57, s22, v174
    v_dot2c_f32_bf16 v56, s6, v174
    v_dot2c_f32_bf16 v59, s22, v175
    v_dot2c_f32_bf16 v58, s6, v175
    v_dot2c_f32_bf16 v45, s23, v176
    v_dot2c_f32_bf16 v44, s7, v176
    v_dot2c_f32_bf16 v47, s23, v177
    v_dot2c_f32_bf16 v46, s7, v177
    v_dot2c_f32_bf16 v49, s23, v178
    v_dot2c_f32_bf16 v48, s7, v178
    v_dot2c_f32_bf16 v51, s23, v179
    v_dot2c_f32_bf16 v50, s7, v179
    v_dot2c_f32_bf16 v53, s23, v180
    v_dot2c_f32_bf16 v52, s7, v180
    v_dot2c_f32_bf16 v55, s23, v181
    v_dot2c_f32_bf16 v54, s7, v181
    v_dot2c_f32_bf16 v57, s23, v182
    v_dot2c_f32_bf16 v56, s7, v182
    v_dot2c_f32_bf16 v59, s23, v183
    v_dot2c_f32_bf16 v58, s7, v183
    s_sub_u32 s16, s3, 4
    s_lshl_b32 s16, s16, 12
    s_add_u32 s16, s16, 73728
    v_lshlrev_b32 v16, 5, v1
    v_add_u32 v16, s16, v16
    ds_write_b128 v16, v[44:47] offset:0
    ds_write_b128 v16, v[48:51] offset:16
    ds_write_b128 v16, v[52:55] offset:2048
    ds_write_b128 v16, v[56:59] offset:2064
    s_waitcnt lgkmcnt(0)
    s_barrier
    v_lshlrev_b32 v16, 3, v0
    v_add_u32 v17, 73728, v16
    ds_read_b64 v[84:85], v17 offset:0
    ds_read_b64 v[86:87], v17 offset:4096
    ds_read_b64 v[88:89], v17 offset:8192
    ds_read_b64 v[90:91], v17 offset:12288
    s_waitcnt lgkmcnt(2)
    v_pk_add_f32 v[84:85], v[84:85], v[86:87]
    s_waitcnt lgkmcnt(0)
    v_pk_add_f32 v[88:89], v[88:89], v[90:91]
    v_pk_add_f32 v[84:85], v[84:85], v[88:89]
    v_or_b32 v84, 1, v84
    v_or_b32 v85, 1, v85
    s_lshl_b32 s16, s29, 12
    s_add_u32 s16, s16, 0x600000
    s_cmp_lt_u32 s2, 224
    s_cselect_b32 s16, s16, 0x7ffffff0
    buffer_store_dwordx2 v[84:85], v16, s[8:11], s16 offen sc1
    s_cmp_lt_u32 s2, 224
    s_cbranch_scc1 adaLN_cond__sliding_block_cached__moe_arch_mod__prompt_kernel_end
    s_sub_u32 s16, s2, 224
    s_lshl_b32 s17, s16, 7
    s_add_u32 s17, s17, 0x600000
    v_lshrrev_b32 v16, 3, v0
    v_lshlrev_b32 v16, 12, v16
    v_and_b32 v17, 7, v0
    v_lshl_add_u32 v16, v17, 4, v16
    v_cmp_gt_u32 vcc, 256, v0
    v_bfrev_b32 v17, -2
    s_nop 0
    v_cndmask_b32 v17, v17, v16, vcc
    v_mov_b32 v19, 0
    v_cndmask_b32 v18, 1, v19, vcc
    s_lshl_b32 s18, s16, 6
    v_and_b32 v19, 31, v1
    v_lshlrev_b32 v19, 1, v19
    v_add_u32 v19, s18, v19
    s_mov_b32 s19, 0x541800
    buffer_load_ushort v95, v19, s[8:11], s19 offen sc1
    v_add_u32 v20, 66560, v19
    ds_read_u16 v96, v20
    ds_read_u16 v97, v20 offset:2048
    v_mov_b32 v94, v27
    v_cvt_pk_bf16_f32 v94, v94, v94
    v_lshlrev_b32 v94, 16, v94
    v_mul_f32 v94, 0xbfb8aa3b, v94
    v_exp_f32 v94, v94
    s_nop 0
    v_add_f32 v94, 1.0, v94
    v_rcp_f32 v94, v94
    s_nop 0
    v_cvt_pk_bf16_f32 v94, v94, v94
    v_lshlrev_b32 v94, 16, v94
    s_waitcnt vmcnt(0)
    v_lshlrev_b32 v95, 16, v95
    s_waitcnt lgkmcnt(1)
    v_lshlrev_b32 v96, 16, v96
    s_waitcnt lgkmcnt(0)
    v_lshlrev_b32 v97, 16, v97
    s_mov_b32 s27, 0
adaLN_cond__sliding_block_cached__moe_arch_mod__prompt_kernel_y24p:
    s_add_u32 s19, s17, 0x0
    buffer_load_dwordx4 v[44:47], v16, s[8:11], s19 offen sc1
    s_add_u32 s19, s17, 0x40000
    buffer_load_dwordx4 v[48:51], v16, s[8:11], s19 offen sc1
    s_add_u32 s19, s17, 0x80000
    buffer_load_dwordx4 v[52:55], v16, s[8:11], s19 offen sc1
    s_add_u32 s19, s17, 0xc0000
    buffer_load_dwordx4 v[56:59], v17, s[8:11], s19 offen sc1
    s_waitcnt vmcnt(0)
    v_min3_u32 v98, v56, v57, v58
    v_min_u32 v98, v98, v59
    v_or_b32 v98, v98, v18
    v_min3_u32 v98, v98, v44, v45
    v_min3_u32 v98, v98, v46, v47
    v_min3_u32 v98, v98, v48, v49
    v_min3_u32 v98, v98, v50, v51
    v_min3_u32 v98, v98, v52, v53
    v_min3_u32 v98, v98, v54, v55
    v_cmp_eq_u32 vcc, 0, v98
    s_add_u32 s27, s27, 1
    s_cmp_ge_u32 s27, 65536
    s_cbranch_scc1 adaLN_cond__sliding_block_cached__moe_arch_mod__prompt_kernel_y24g
    s_cbranch_vccnz adaLN_cond__sliding_block_cached__moe_arch_mod__prompt_kernel_y24p
adaLN_cond__sliding_block_cached__moe_arch_mod__prompt_kernel_y24g:
    v_pk_add_f32 v[44:45], v[44:45], v[52:53]
    v_pk_add_f32 v[46:47], v[46:47], v[54:55]
    v_pk_add_f32 v[48:49], v[48:49], v[56:57]
    v_pk_add_f32 v[50:51], v[50:51], v[58:59]
    v_pk_add_f32 v[44:45], v[44:45], v[48:49]
    v_pk_add_f32 v[46:47], v[46:47], v[50:51]
    s_nop 0
    v_add_f32_dpp v44, v44, v44 row_ror:8 row_mask:0xf bank_mask:0xf
    v_add_f32_dpp v45, v45, v45 row_ror:8 row_mask:0xf bank_mask:0xf
    v_add_f32_dpp v46, v46, v46 row_ror:8 row_mask:0xf bank_mask:0xf
    v_add_f32_dpp v47, v47, v47 row_ror:8 row_mask:0xf bank_mask:0xf
    s_nop 0
    v_permlane32_swap_b32 v44, v46
    v_permlane32_swap_b32 v45, v47
    v_add_f32 v44, v44, v46
    v_add_f32 v45, v45, v47
    s_nop 1
    v_permlane16_swap_b32 v44, v45
    v_add_f32 v44, v44, v45
    v_and_b32 v16, 7, v1
    v_lshlrev_b32 v16, 4, v16
    v_lshrrev_b32 v17, 4, v1
    v_lshl_add_u32 v16, v17, 2, v16
    s_lshl_b32 s19, s3, 7
    s_add_u32 s19, s19, 91136
    v_add_u32 v16, s19, v16
    ds_write_b32 v16, v44
    v_and_b32 v16, 31, v1
    v_lshlrev_b32 v16, 2, v16
    v_add_u32 v16, 91136, v16
    s_waitcnt lgkmcnt(0)
    s_barrier
    s_cmp_lg_u32 s3, 0
    s_cbranch_scc1 adaLN_cond__sliding_block_cached__moe_arch_mod__prompt_kernel_end
    ds_read_b32 v44, v16 offset:0
    ds_read_b32 v45, v16 offset:128
    ds_read_b32 v46, v16 offset:256
    ds_read_b32 v47, v16 offset:384
    ds_read_b32 v48, v16 offset:512
    ds_read_b32 v49, v16 offset:640
    ds_read_b32 v50, v16 offset:768
    ds_read_b32 v51, v16 offset:896
    s_waitcnt lgkmcnt(3)
    v_add_f32 v44, v44, v48
    s_waitcnt lgkmcnt(2)
    v_add_f32 v45, v45, v49
    s_waitcnt lgkmcnt(1)
    v_add_f32 v46, v46, v50
    s_waitcnt lgkmcnt(0)
    v_add_f32 v47, v47, v51
    v_add_f32 v44, v44, v46
    v_add_f32 v45, v45, v47
    v_add_f32 v44, v44, v45
    v_cvt_pk_bf16_f32 v44, v44, v44
    v_lshlrev_b32 v44, 16, v44
    v_mul_f32 v44, v44, v94
    v_cvt_pk_bf16_f32 v44, v44, v44
    v_lshlrev_b32 v44, 16, v44
    v_add_f32 v44, v44, v96
    v_cvt_pk_bf16_f32 v44, v44, v44
    v_lshlrev_b32 v44, 16, v44
    v_mul_f32 v44, v44, v95
    v_cvt_pk_bf16_f32 v44, v44, v44
    v_lshlrev_b32 v44, 16, v44
    v_add_f32 v44, v44, v97
    v_cvt_pk_bf16_f32 v44, v44, v44
    s_mov_b64 exec, 0xffffffff
    buffer_store_short v44, v19, s[68:71], s13 offen sc1
adaLN_cond__sliding_block_cached__moe_arch_mod__prompt_kernel_end:
    s_endpgm
adaLN_cond__sliding_block_cached__moe_arch_mod__prompt_kernel_n1r:
    s_mov_b32 s27, 0
adaLN_cond__sliding_block_cached__moe_arch_mod__prompt_kernel_n1p:
    buffer_load_dword v134, v132, s[64:67], 0 offen sc1
    s_waitcnt vmcnt(0)
    v_cmp_eq_u32 vcc, 0, v134
    s_cmp_eq_u32 s3, 0
    s_cselect_b64 s[62:63], -1, 0
    s_and_b64 vcc, vcc, s[62:63]
    s_add_u32 s27, s27, 1
    s_cmp_ge_u32 s27, 65536
    s_cbranch_scc1 adaLN_cond__sliding_block_cached__moe_arch_mod__prompt_kernel_n1g
    s_cbranch_vccnz adaLN_cond__sliding_block_cached__moe_arch_mod__prompt_kernel_n1p
adaLN_cond__sliding_block_cached__moe_arch_mod__prompt_kernel_n1g:
    s_waitcnt vmcnt(0) lgkmcnt(0)
    s_nop 15
    s_nop 3
    s_branch adaLN_cond__sliding_block_cached__moe_arch_mod__prompt_kernel_n1b
adaLN_cond__sliding_block_cached__moe_arch_mod__prompt_kernel_kv4r:
    s_waitcnt vmcnt(0) lgkmcnt(0)
    s_nop 15
    s_nop 3
    s_mov_b32 s27, 0
adaLN_cond__sliding_block_cached__moe_arch_mod__prompt_kernel_kv4p:
    buffer_load_dwordx4 v[12:15], v21, s[8:11], s18 offen sc1
    s_waitcnt vmcnt(0)
    v_xor_b32 v8, s28, v12
    v_xor_b32 v20, s28, v13
    v_or_b32 v8, v8, v20
    v_xor_b32 v20, s28, v14
    v_or_b32 v8, v8, v20
    v_xor_b32 v20, s28, v15
    v_or_b32 v8, v8, v20
    v_cmp_ne_u32 vcc, 0, v8
    s_add_u32 s27, s27, 1
    s_cmp_ge_u32 s27, 65536
    s_cbranch_scc1 adaLN_cond__sliding_block_cached__moe_arch_mod__prompt_kernel_kv4g
    s_cbranch_vccnz adaLN_cond__sliding_block_cached__moe_arch_mod__prompt_kernel_kv4p
adaLN_cond__sliding_block_cached__moe_arch_mod__prompt_kernel_kv4g:
    s_waitcnt vmcnt(0) lgkmcnt(0)
    s_nop 15
    s_nop 3
    s_branch adaLN_cond__sliding_block_cached__moe_arch_mod__prompt_kernel_kv4b
adaLN_cond__sliding_block_cached__moe_arch_mod__prompt_kernel_fixA:
    s_waitcnt vmcnt(0) lgkmcnt(0)
    s_nop 15
    s_nop 3
    s_lshr_b32 s16, s12, 3
    s_lshl_b32 s16, s16, 17
    s_add_u32 s16, s16, 0x400000
    v_add_u32 v8, s16, v2
    v_mov_b32 v16, 0xff7fffff
    v_mov_b32 v17, 0xff7fffff
    s_mov_b32 s16, 0
adaLN_cond__sliding_block_cached__moe_arch_mod__prompt_kernel_fixAm:
    s_add_u32 s17, s16, 0
    buffer_load_dwordx4 v[200:203], v8, s[8:11], s17 offen offset:0
    buffer_load_dwordx4 v[204:207], v8, s[8:11], s17 offen offset:1024
    buffer_load_dwordx4 v[208:211], v8, s[8:11], s17 offen offset:2048
    buffer_load_dwordx4 v[212:215], v8, s[8:11], s17 offen offset:3072
    s_waitcnt vmcnt(3)
    v_mfma_f32_16x16x32_bf16 v[184:187], v[200:203], v[152:155], 0
    v_mfma_f32_16x16x32_bf16 v[188:191], v[200:203], v[168:171], 0
    s_waitcnt vmcnt(2)
    v_mfma_f32_16x16x32_bf16 v[192:195], v[204:207], v[152:155], 0
    v_mfma_f32_16x16x32_bf16 v[196:199], v[204:207], v[168:171], 0
    s_waitcnt vmcnt(1)
    v_mfma_f32_16x16x32_bf16 v[184:187], v[208:211], v[156:159], v[184:187]
    v_mfma_f32_16x16x32_bf16 v[188:191], v[208:211], v[172:175], v[188:191]
    s_waitcnt vmcnt(0)
    v_mfma_f32_16x16x32_bf16 v[192:195], v[212:215], v[156:159], v[192:195]
    v_mfma_f32_16x16x32_bf16 v[196:199], v[212:215], v[172:175], v[196:199]
    s_add_u32 s17, s16, 4096
    buffer_load_dwordx4 v[200:203], v8, s[8:11], s17 offen offset:0
    buffer_load_dwordx4 v[204:207], v8, s[8:11], s17 offen offset:1024
    buffer_load_dwordx4 v[208:211], v8, s[8:11], s17 offen offset:2048
    buffer_load_dwordx4 v[212:215], v8, s[8:11], s17 offen offset:3072
    s_waitcnt vmcnt(3)
    v_mfma_f32_16x16x32_bf16 v[184:187], v[200:203], v[160:163], v[184:187]
    v_mfma_f32_16x16x32_bf16 v[188:191], v[200:203], v[176:179], v[188:191]
    s_waitcnt vmcnt(2)
    v_mfma_f32_16x16x32_bf16 v[192:195], v[204:207], v[160:163], v[192:195]
    v_mfma_f32_16x16x32_bf16 v[196:199], v[204:207], v[176:179], v[196:199]
    s_waitcnt vmcnt(1)
    v_mfma_f32_16x16x32_bf16 v[184:187], v[208:211], v[164:167], v[184:187]
    v_mfma_f32_16x16x32_bf16 v[188:191], v[208:211], v[180:183], v[188:191]
    s_waitcnt vmcnt(0)
    v_mfma_f32_16x16x32_bf16 v[192:195], v[212:215], v[164:167], v[192:195]
    v_mfma_f32_16x16x32_bf16 v[196:199], v[212:215], v[180:183], v[196:199]
    s_nop 3
    v_max3_f32 v16, v16, v184, v185
    v_max3_f32 v16, v16, v186, v187
    v_max3_f32 v17, v17, v188, v189
    v_max3_f32 v17, v17, v190, v191
    v_max3_f32 v16, v16, v192, v193
    v_max3_f32 v16, v16, v194, v195
    v_max3_f32 v17, v17, v196, v197
    v_max3_f32 v17, v17, v198, v199
    s_add_u32 s16, s16, 8192
    s_cmp_lt_u32 s16, 0x20000
    s_cbranch_scc1 adaLN_cond__sliding_block_cached__moe_arch_mod__prompt_kernel_fixAm
    v_mov_b32 v18, v16
    v_mov_b32 v19, v17
    s_nop 0
    v_permlane16_swap_b32 v16, v18
    v_permlane16_swap_b32 v17, v19
    v_max_f32 v16, v16, v18
    v_max_f32 v17, v17, v19
    v_mov_b32 v18, v16
    v_mov_b32 v19, v17
    s_nop 0
    v_permlane32_swap_b32 v16, v18
    v_permlane32_swap_b32 v17, v19
    v_max_f32 v16, v16, v18
    v_max_f32 v17, v17, v19
    v_sub_f32 v216, 0, v16
    v_sub_f32 v217, 0, v16
    v_sub_f32 v218, 0, v16
    v_sub_f32 v219, 0, v16
    v_sub_f32 v220, 0, v17
    v_sub_f32 v221, 0, v17
    v_sub_f32 v222, 0, v17
    v_sub_f32 v223, 0, v17
    s_mov_b32 s17, 0x0
    buffer_load_dwordx4 v[200:203], v8, s[8:11], s17 offen offset:0
    buffer_load_dwordx4 v[204:207], v8, s[8:11], s17 offen offset:1024
    buffer_load_dwordx4 v[208:211], v8, s[8:11], s17 offen offset:2048
    buffer_load_dwordx4 v[212:215], v8, s[8:11], s17 offen offset:3072
    s_waitcnt vmcnt(3)
    v_mfma_f32_16x16x32_bf16 v[184:187], v[200:203], v[152:155], v[216:219]
    v_mfma_f32_16x16x32_bf16 v[188:191], v[200:203], v[168:171], v[220:223]
    s_waitcnt vmcnt(2)
    v_mfma_f32_16x16x32_bf16 v[192:195], v[204:207], v[152:155], v[216:219]
    v_mfma_f32_16x16x32_bf16 v[196:199], v[204:207], v[168:171], v[220:223]
    s_waitcnt vmcnt(1)
    v_mfma_f32_16x16x32_bf16 v[184:187], v[208:211], v[156:159], v[184:187]
    v_mfma_f32_16x16x32_bf16 v[188:191], v[208:211], v[172:175], v[188:191]
    s_waitcnt vmcnt(0)
    v_mfma_f32_16x16x32_bf16 v[192:195], v[212:215], v[156:159], v[192:195]
    v_mfma_f32_16x16x32_bf16 v[196:199], v[212:215], v[172:175], v[196:199]
    s_mov_b32 s17, 0x1000
    buffer_load_dwordx4 v[200:203], v8, s[8:11], s17 offen offset:0
    buffer_load_dwordx4 v[204:207], v8, s[8:11], s17 offen offset:1024
    buffer_load_dwordx4 v[208:211], v8, s[8:11], s17 offen offset:2048
    buffer_load_dwordx4 v[212:215], v8, s[8:11], s17 offen offset:3072
    s_waitcnt vmcnt(3)
    v_mfma_f32_16x16x32_bf16 v[184:187], v[200:203], v[160:163], v[184:187]
    v_mfma_f32_16x16x32_bf16 v[188:191], v[200:203], v[176:179], v[188:191]
    s_waitcnt vmcnt(2)
    v_mfma_f32_16x16x32_bf16 v[192:195], v[204:207], v[160:163], v[192:195]
    v_mfma_f32_16x16x32_bf16 v[196:199], v[204:207], v[176:179], v[196:199]
    s_waitcnt vmcnt(1)
    v_mfma_f32_16x16x32_bf16 v[184:187], v[208:211], v[164:167], v[184:187]
    v_mfma_f32_16x16x32_bf16 v[188:191], v[208:211], v[180:183], v[188:191]
    s_waitcnt vmcnt(0)
    v_mfma_f32_16x16x32_bf16 v[192:195], v[212:215], v[164:167], v[192:195]
    v_mfma_f32_16x16x32_bf16 v[196:199], v[212:215], v[180:183], v[196:199]
    s_nop 3
    v_exp_f32 v184, v184
    v_exp_f32 v185, v185
    s_nop 0
    v_add_f32 v9, v184, v185
    v_cvt_pk_bf16_f32 v24, v184, v185
    v_exp_f32 v186, v186
    v_exp_f32 v187, v187
    v_add_f32 v9, v9, v186
    v_add_f32 v9, v9, v187
    v_cvt_pk_bf16_f32 v25, v186, v187
    v_exp_f32 v188, v188
    v_exp_f32 v189, v189
    s_nop 0
    v_add_f32 v10, v188, v189
    v_cvt_pk_bf16_f32 v28, v188, v189
    v_exp_f32 v190, v190
    v_exp_f32 v191, v191
    v_add_f32 v10, v10, v190
    v_add_f32 v10, v10, v191
    v_cvt_pk_bf16_f32 v29, v190, v191
    v_exp_f32 v192, v192
    v_exp_f32 v193, v193
    v_add_f32 v9, v9, v192
    v_add_f32 v9, v9, v193
    v_cvt_pk_bf16_f32 v26, v192, v193
    v_exp_f32 v194, v194
    v_exp_f32 v195, v195
    v_add_f32 v9, v9, v194
    v_add_f32 v9, v9, v195
    v_cvt_pk_bf16_f32 v27, v194, v195
    v_exp_f32 v196, v196
    v_exp_f32 v197, v197
    v_add_f32 v10, v10, v196
    v_add_f32 v10, v10, v197
    v_cvt_pk_bf16_f32 v30, v196, v197
    v_exp_f32 v198, v198
    v_exp_f32 v199, v199
    v_add_f32 v10, v10, v198
    v_add_f32 v10, v10, v199
    v_cvt_pk_bf16_f32 v31, v198, v199
    s_mov_b32 s17, 0x2000
    buffer_load_dwordx4 v[200:203], v8, s[8:11], s17 offen offset:0
    buffer_load_dwordx4 v[204:207], v8, s[8:11], s17 offen offset:1024
    buffer_load_dwordx4 v[208:211], v8, s[8:11], s17 offen offset:2048
    buffer_load_dwordx4 v[212:215], v8, s[8:11], s17 offen offset:3072
    s_waitcnt vmcnt(3)
    v_mfma_f32_16x16x32_bf16 v[184:187], v[200:203], v[152:155], v[216:219]
    v_mfma_f32_16x16x32_bf16 v[188:191], v[200:203], v[168:171], v[220:223]
    s_waitcnt vmcnt(2)
    v_mfma_f32_16x16x32_bf16 v[192:195], v[204:207], v[152:155], v[216:219]
    v_mfma_f32_16x16x32_bf16 v[196:199], v[204:207], v[168:171], v[220:223]
    s_waitcnt vmcnt(1)
    v_mfma_f32_16x16x32_bf16 v[184:187], v[208:211], v[156:159], v[184:187]
    v_mfma_f32_16x16x32_bf16 v[188:191], v[208:211], v[172:175], v[188:191]
    s_waitcnt vmcnt(0)
    v_mfma_f32_16x16x32_bf16 v[192:195], v[212:215], v[156:159], v[192:195]
    v_mfma_f32_16x16x32_bf16 v[196:199], v[212:215], v[172:175], v[196:199]
    s_mov_b32 s17, 0x3000
    buffer_load_dwordx4 v[200:203], v8, s[8:11], s17 offen offset:0
    buffer_load_dwordx4 v[204:207], v8, s[8:11], s17 offen offset:1024
    buffer_load_dwordx4 v[208:211], v8, s[8:11], s17 offen offset:2048
    buffer_load_dwordx4 v[212:215], v8, s[8:11], s17 offen offset:3072
    s_waitcnt vmcnt(3)
    v_mfma_f32_16x16x32_bf16 v[184:187], v[200:203], v[160:163], v[184:187]
    v_mfma_f32_16x16x32_bf16 v[188:191], v[200:203], v[176:179], v[188:191]
    s_waitcnt vmcnt(2)
    v_mfma_f32_16x16x32_bf16 v[192:195], v[204:207], v[160:163], v[192:195]
    v_mfma_f32_16x16x32_bf16 v[196:199], v[204:207], v[176:179], v[196:199]
    s_waitcnt vmcnt(1)
    v_mfma_f32_16x16x32_bf16 v[184:187], v[208:211], v[164:167], v[184:187]
    v_mfma_f32_16x16x32_bf16 v[188:191], v[208:211], v[180:183], v[188:191]
    s_waitcnt vmcnt(0)
    v_mfma_f32_16x16x32_bf16 v[192:195], v[212:215], v[164:167], v[192:195]
    v_mfma_f32_16x16x32_bf16 v[196:199], v[212:215], v[180:183], v[196:199]
    s_nop 3
    v_exp_f32 v184, v184
    v_exp_f32 v185, v185
    v_add_f32 v9, v9, v184
    v_add_f32 v9, v9, v185
    v_cvt_pk_bf16_f32 v32, v184, v185
    v_exp_f32 v186, v186
    v_exp_f32 v187, v187
    v_add_f32 v9, v9, v186
    v_add_f32 v9, v9, v187
    v_cvt_pk_bf16_f32 v33, v186, v187
    v_exp_f32 v188, v188
    v_exp_f32 v189, v189
    v_add_f32 v10, v10, v188
    v_add_f32 v10, v10, v189
    v_cvt_pk_bf16_f32 v36, v188, v189
    v_exp_f32 v190, v190
    v_exp_f32 v191, v191
    v_add_f32 v10, v10, v190
    v_add_f32 v10, v10, v191
    v_cvt_pk_bf16_f32 v37, v190, v191
    v_exp_f32 v192, v192
    v_exp_f32 v193, v193
    v_add_f32 v9, v9, v192
    v_add_f32 v9, v9, v193
    v_cvt_pk_bf16_f32 v34, v192, v193
    v_exp_f32 v194, v194
    v_exp_f32 v195, v195
    v_add_f32 v9, v9, v194
    v_add_f32 v9, v9, v195
    v_cvt_pk_bf16_f32 v35, v194, v195
    v_exp_f32 v196, v196
    v_exp_f32 v197, v197
    v_add_f32 v10, v10, v196
    v_add_f32 v10, v10, v197
    v_cvt_pk_bf16_f32 v38, v196, v197
    v_exp_f32 v198, v198
    v_exp_f32 v199, v199
    v_add_f32 v10, v10, v198
    v_add_f32 v10, v10, v199
    v_cvt_pk_bf16_f32 v39, v198, v199
    s_mov_b32 s17, 0x4000
    buffer_load_dwordx4 v[200:203], v8, s[8:11], s17 offen offset:0
    buffer_load_dwordx4 v[204:207], v8, s[8:11], s17 offen offset:1024
    buffer_load_dwordx4 v[208:211], v8, s[8:11], s17 offen offset:2048
    buffer_load_dwordx4 v[212:215], v8, s[8:11], s17 offen offset:3072
    s_waitcnt vmcnt(3)
    v_mfma_f32_16x16x32_bf16 v[184:187], v[200:203], v[152:155], v[216:219]
    v_mfma_f32_16x16x32_bf16 v[188:191], v[200:203], v[168:171], v[220:223]
    s_waitcnt vmcnt(2)
    v_mfma_f32_16x16x32_bf16 v[192:195], v[204:207], v[152:155], v[216:219]
    v_mfma_f32_16x16x32_bf16 v[196:199], v[204:207], v[168:171], v[220:223]
    s_waitcnt vmcnt(1)
    v_mfma_f32_16x16x32_bf16 v[184:187], v[208:211], v[156:159], v[184:187]
    v_mfma_f32_16x16x32_bf16 v[188:191], v[208:211], v[172:175], v[188:191]
    s_waitcnt vmcnt(0)
    v_mfma_f32_16x16x32_bf16 v[192:195], v[212:215], v[156:159], v[192:195]
    v_mfma_f32_16x16x32_bf16 v[196:199], v[212:215], v[172:175], v[196:199]
    s_mov_b32 s17, 0x5000
    buffer_load_dwordx4 v[200:203], v8, s[8:11], s17 offen offset:0
    buffer_load_dwordx4 v[204:207], v8, s[8:11], s17 offen offset:1024
    buffer_load_dwordx4 v[208:211], v8, s[8:11], s17 offen offset:2048
    buffer_load_dwordx4 v[212:215], v8, s[8:11], s17 offen offset:3072
    s_waitcnt vmcnt(3)
    v_mfma_f32_16x16x32_bf16 v[184:187], v[200:203], v[160:163], v[184:187]
    v_mfma_f32_16x16x32_bf16 v[188:191], v[200:203], v[176:179], v[188:191]
    s_waitcnt vmcnt(2)
    v_mfma_f32_16x16x32_bf16 v[192:195], v[204:207], v[160:163], v[192:195]
    v_mfma_f32_16x16x32_bf16 v[196:199], v[204:207], v[176:179], v[196:199]
    s_waitcnt vmcnt(1)
    v_mfma_f32_16x16x32_bf16 v[184:187], v[208:211], v[164:167], v[184:187]
    v_mfma_f32_16x16x32_bf16 v[188:191], v[208:211], v[180:183], v[188:191]
    s_waitcnt vmcnt(0)
    v_mfma_f32_16x16x32_bf16 v[192:195], v[212:215], v[164:167], v[192:195]
    v_mfma_f32_16x16x32_bf16 v[196:199], v[212:215], v[180:183], v[196:199]
    s_nop 3
    v_exp_f32 v184, v184
    v_exp_f32 v185, v185
    v_add_f32 v9, v9, v184
    v_add_f32 v9, v9, v185
    v_cvt_pk_bf16_f32 v40, v184, v185
    v_exp_f32 v186, v186
    v_exp_f32 v187, v187
    v_add_f32 v9, v9, v186
    v_add_f32 v9, v9, v187
    v_cvt_pk_bf16_f32 v41, v186, v187
    v_exp_f32 v188, v188
    v_exp_f32 v189, v189
    v_add_f32 v10, v10, v188
    v_add_f32 v10, v10, v189
    v_cvt_pk_bf16_f32 v44, v188, v189
    v_exp_f32 v190, v190
    v_exp_f32 v191, v191
    v_add_f32 v10, v10, v190
    v_add_f32 v10, v10, v191
    v_cvt_pk_bf16_f32 v45, v190, v191
    v_exp_f32 v192, v192
    v_exp_f32 v193, v193
    v_add_f32 v9, v9, v192
    v_add_f32 v9, v9, v193
    v_cvt_pk_bf16_f32 v42, v192, v193
    v_exp_f32 v194, v194
    v_exp_f32 v195, v195
    v_add_f32 v9, v9, v194
    v_add_f32 v9, v9, v195
    v_cvt_pk_bf16_f32 v43, v194, v195
    v_exp_f32 v196, v196
    v_exp_f32 v197, v197
    v_add_f32 v10, v10, v196
    v_add_f32 v10, v10, v197
    v_cvt_pk_bf16_f32 v46, v196, v197
    v_exp_f32 v198, v198
    v_exp_f32 v199, v199
    v_add_f32 v10, v10, v198
    v_add_f32 v10, v10, v199
    v_cvt_pk_bf16_f32 v47, v198, v199
    s_mov_b32 s17, 0x6000
    buffer_load_dwordx4 v[200:203], v8, s[8:11], s17 offen offset:0
    buffer_load_dwordx4 v[204:207], v8, s[8:11], s17 offen offset:1024
    buffer_load_dwordx4 v[208:211], v8, s[8:11], s17 offen offset:2048
    buffer_load_dwordx4 v[212:215], v8, s[8:11], s17 offen offset:3072
    s_waitcnt vmcnt(3)
    v_mfma_f32_16x16x32_bf16 v[184:187], v[200:203], v[152:155], v[216:219]
    v_mfma_f32_16x16x32_bf16 v[188:191], v[200:203], v[168:171], v[220:223]
    s_waitcnt vmcnt(2)
    v_mfma_f32_16x16x32_bf16 v[192:195], v[204:207], v[152:155], v[216:219]
    v_mfma_f32_16x16x32_bf16 v[196:199], v[204:207], v[168:171], v[220:223]
    s_waitcnt vmcnt(1)
    v_mfma_f32_16x16x32_bf16 v[184:187], v[208:211], v[156:159], v[184:187]
    v_mfma_f32_16x16x32_bf16 v[188:191], v[208:211], v[172:175], v[188:191]
    s_waitcnt vmcnt(0)
    v_mfma_f32_16x16x32_bf16 v[192:195], v[212:215], v[156:159], v[192:195]
    v_mfma_f32_16x16x32_bf16 v[196:199], v[212:215], v[172:175], v[196:199]
    s_mov_b32 s17, 0x7000
    buffer_load_dwordx4 v[200:203], v8, s[8:11], s17 offen offset:0
    buffer_load_dwordx4 v[204:207], v8, s[8:11], s17 offen offset:1024
    buffer_load_dwordx4 v[208:211], v8, s[8:11], s17 offen offset:2048
    buffer_load_dwordx4 v[212:215], v8, s[8:11], s17 offen offset:3072
    s_waitcnt vmcnt(3)
    v_mfma_f32_16x16x32_bf16 v[184:187], v[200:203], v[160:163], v[184:187]
    v_mfma_f32_16x16x32_bf16 v[188:191], v[200:203], v[176:179], v[188:191]
    s_waitcnt vmcnt(2)
    v_mfma_f32_16x16x32_bf16 v[192:195], v[204:207], v[160:163], v[192:195]
    v_mfma_f32_16x16x32_bf16 v[196:199], v[204:207], v[176:179], v[196:199]
    s_waitcnt vmcnt(1)
    v_mfma_f32_16x16x32_bf16 v[184:187], v[208:211], v[164:167], v[184:187]
    v_mfma_f32_16x16x32_bf16 v[188:191], v[208:211], v[180:183], v[188:191]
    s_waitcnt vmcnt(0)
    v_mfma_f32_16x16x32_bf16 v[192:195], v[212:215], v[164:167], v[192:195]
    v_mfma_f32_16x16x32_bf16 v[196:199], v[212:215], v[180:183], v[196:199]
    s_nop 3
    v_exp_f32 v184, v184
    v_exp_f32 v185, v185
    v_add_f32 v9, v9, v184
    v_add_f32 v9, v9, v185
    v_cvt_pk_bf16_f32 v48, v184, v185
    v_exp_f32 v186, v186
    v_exp_f32 v187, v187
    v_add_f32 v9, v9, v186
    v_add_f32 v9, v9, v187
    v_cvt_pk_bf16_f32 v49, v186, v187
    v_exp_f32 v188, v188
    v_exp_f32 v189, v189
    v_add_f32 v10, v10, v188
    v_add_f32 v10, v10, v189
    v_cvt_pk_bf16_f32 v52, v188, v189
    v_exp_f32 v190, v190
    v_exp_f32 v191, v191
    v_add_f32 v10, v10, v190
    v_add_f32 v10, v10, v191
    v_cvt_pk_bf16_f32 v53, v190, v191
    v_exp_f32 v192, v192
    v_exp_f32 v193, v193
    v_add_f32 v9, v9, v192
    v_add_f32 v9, v9, v193
    v_cvt_pk_bf16_f32 v50, v192, v193
    v_exp_f32 v194, v194
    v_exp_f32 v195, v195
    v_add_f32 v9, v9, v194
    v_add_f32 v9, v9, v195
    v_cvt_pk_bf16_f32 v51, v194, v195
    v_exp_f32 v196, v196
    v_exp_f32 v197, v197
    v_add_f32 v10, v10, v196
    v_add_f32 v10, v10, v197
    v_cvt_pk_bf16_f32 v54, v196, v197
    v_exp_f32 v198, v198
    v_exp_f32 v199, v199
    v_add_f32 v10, v10, v198
    v_add_f32 v10, v10, v199
    v_cvt_pk_bf16_f32 v55, v198, v199
    s_mov_b32 s17, 0x8000
    buffer_load_dwordx4 v[200:203], v8, s[8:11], s17 offen offset:0
    buffer_load_dwordx4 v[204:207], v8, s[8:11], s17 offen offset:1024
    buffer_load_dwordx4 v[208:211], v8, s[8:11], s17 offen offset:2048
    buffer_load_dwordx4 v[212:215], v8, s[8:11], s17 offen offset:3072
    s_waitcnt vmcnt(3)
    v_mfma_f32_16x16x32_bf16 v[184:187], v[200:203], v[152:155], v[216:219]
    v_mfma_f32_16x16x32_bf16 v[188:191], v[200:203], v[168:171], v[220:223]
    s_waitcnt vmcnt(2)
    v_mfma_f32_16x16x32_bf16 v[192:195], v[204:207], v[152:155], v[216:219]
    v_mfma_f32_16x16x32_bf16 v[196:199], v[204:207], v[168:171], v[220:223]
    s_waitcnt vmcnt(1)
    v_mfma_f32_16x16x32_bf16 v[184:187], v[208:211], v[156:159], v[184:187]
    v_mfma_f32_16x16x32_bf16 v[188:191], v[208:211], v[172:175], v[188:191]
    s_waitcnt vmcnt(0)
    v_mfma_f32_16x16x32_bf16 v[192:195], v[212:215], v[156:159], v[192:195]
    v_mfma_f32_16x16x32_bf16 v[196:199], v[212:215], v[172:175], v[196:199]
    s_mov_b32 s17, 0x9000
    buffer_load_dwordx4 v[200:203], v8, s[8:11], s17 offen offset:0
    buffer_load_dwordx4 v[204:207], v8, s[8:11], s17 offen offset:1024
    buffer_load_dwordx4 v[208:211], v8, s[8:11], s17 offen offset:2048
    buffer_load_dwordx4 v[212:215], v8, s[8:11], s17 offen offset:3072
    s_waitcnt vmcnt(3)
    v_mfma_f32_16x16x32_bf16 v[184:187], v[200:203], v[160:163], v[184:187]
    v_mfma_f32_16x16x32_bf16 v[188:191], v[200:203], v[176:179], v[188:191]
    s_waitcnt vmcnt(2)
    v_mfma_f32_16x16x32_bf16 v[192:195], v[204:207], v[160:163], v[192:195]
    v_mfma_f32_16x16x32_bf16 v[196:199], v[204:207], v[176:179], v[196:199]
    s_waitcnt vmcnt(1)
    v_mfma_f32_16x16x32_bf16 v[184:187], v[208:211], v[164:167], v[184:187]
    v_mfma_f32_16x16x32_bf16 v[188:191], v[208:211], v[180:183], v[188:191]
    s_waitcnt vmcnt(0)
    v_mfma_f32_16x16x32_bf16 v[192:195], v[212:215], v[164:167], v[192:195]
    v_mfma_f32_16x16x32_bf16 v[196:199], v[212:215], v[180:183], v[196:199]
    s_nop 3
    v_exp_f32 v184, v184
    v_exp_f32 v185, v185
    v_add_f32 v9, v9, v184
    v_add_f32 v9, v9, v185
    v_cvt_pk_bf16_f32 v56, v184, v185
    v_exp_f32 v186, v186
    v_exp_f32 v187, v187
    v_add_f32 v9, v9, v186
    v_add_f32 v9, v9, v187
    v_cvt_pk_bf16_f32 v57, v186, v187
    v_exp_f32 v188, v188
    v_exp_f32 v189, v189
    v_add_f32 v10, v10, v188
    v_add_f32 v10, v10, v189
    v_cvt_pk_bf16_f32 v60, v188, v189
    v_exp_f32 v190, v190
    v_exp_f32 v191, v191
    v_add_f32 v10, v10, v190
    v_add_f32 v10, v10, v191
    v_cvt_pk_bf16_f32 v61, v190, v191
    v_exp_f32 v192, v192
    v_exp_f32 v193, v193
    v_add_f32 v9, v9, v192
    v_add_f32 v9, v9, v193
    v_cvt_pk_bf16_f32 v58, v192, v193
    v_exp_f32 v194, v194
    v_exp_f32 v195, v195
    v_add_f32 v9, v9, v194
    v_add_f32 v9, v9, v195
    v_cvt_pk_bf16_f32 v59, v194, v195
    v_exp_f32 v196, v196
    v_exp_f32 v197, v197
    v_add_f32 v10, v10, v196
    v_add_f32 v10, v10, v197
    v_cvt_pk_bf16_f32 v62, v196, v197
    v_exp_f32 v198, v198
    v_exp_f32 v199, v199
    v_add_f32 v10, v10, v198
    v_add_f32 v10, v10, v199
    v_cvt_pk_bf16_f32 v63, v198, v199
    s_mov_b32 s17, 0xa000
    buffer_load_dwordx4 v[200:203], v8, s[8:11], s17 offen offset:0
    buffer_load_dwordx4 v[204:207], v8, s[8:11], s17 offen offset:1024
    buffer_load_dwordx4 v[208:211], v8, s[8:11], s17 offen offset:2048
    buffer_load_dwordx4 v[212:215], v8, s[8:11], s17 offen offset:3072
    s_waitcnt vmcnt(3)
    v_mfma_f32_16x16x32_bf16 v[184:187], v[200:203], v[152:155], v[216:219]
    v_mfma_f32_16x16x32_bf16 v[188:191], v[200:203], v[168:171], v[220:223]
    s_waitcnt vmcnt(2)
    v_mfma_f32_16x16x32_bf16 v[192:195], v[204:207], v[152:155], v[216:219]
    v_mfma_f32_16x16x32_bf16 v[196:199], v[204:207], v[168:171], v[220:223]
    s_waitcnt vmcnt(1)
    v_mfma_f32_16x16x32_bf16 v[184:187], v[208:211], v[156:159], v[184:187]
    v_mfma_f32_16x16x32_bf16 v[188:191], v[208:211], v[172:175], v[188:191]
    s_waitcnt vmcnt(0)
    v_mfma_f32_16x16x32_bf16 v[192:195], v[212:215], v[156:159], v[192:195]
    v_mfma_f32_16x16x32_bf16 v[196:199], v[212:215], v[172:175], v[196:199]
    s_mov_b32 s17, 0xb000
    buffer_load_dwordx4 v[200:203], v8, s[8:11], s17 offen offset:0
    buffer_load_dwordx4 v[204:207], v8, s[8:11], s17 offen offset:1024
    buffer_load_dwordx4 v[208:211], v8, s[8:11], s17 offen offset:2048
    buffer_load_dwordx4 v[212:215], v8, s[8:11], s17 offen offset:3072
    s_waitcnt vmcnt(3)
    v_mfma_f32_16x16x32_bf16 v[184:187], v[200:203], v[160:163], v[184:187]
    v_mfma_f32_16x16x32_bf16 v[188:191], v[200:203], v[176:179], v[188:191]
    s_waitcnt vmcnt(2)
    v_mfma_f32_16x16x32_bf16 v[192:195], v[204:207], v[160:163], v[192:195]
    v_mfma_f32_16x16x32_bf16 v[196:199], v[204:207], v[176:179], v[196:199]
    s_waitcnt vmcnt(1)
    v_mfma_f32_16x16x32_bf16 v[184:187], v[208:211], v[164:167], v[184:187]
    v_mfma_f32_16x16x32_bf16 v[188:191], v[208:211], v[180:183], v[188:191]
    s_waitcnt vmcnt(0)
    v_mfma_f32_16x16x32_bf16 v[192:195], v[212:215], v[164:167], v[192:195]
    v_mfma_f32_16x16x32_bf16 v[196:199], v[212:215], v[180:183], v[196:199]
    s_nop 3
    v_exp_f32 v184, v184
    v_exp_f32 v185, v185
    v_add_f32 v9, v9, v184
    v_add_f32 v9, v9, v185
    v_cvt_pk_bf16_f32 v64, v184, v185
    v_exp_f32 v186, v186
    v_exp_f32 v187, v187
    v_add_f32 v9, v9, v186
    v_add_f32 v9, v9, v187
    v_cvt_pk_bf16_f32 v65, v186, v187
    v_exp_f32 v188, v188
    v_exp_f32 v189, v189
    v_add_f32 v10, v10, v188
    v_add_f32 v10, v10, v189
    v_cvt_pk_bf16_f32 v68, v188, v189
    v_exp_f32 v190, v190
    v_exp_f32 v191, v191
    v_add_f32 v10, v10, v190
    v_add_f32 v10, v10, v191
    v_cvt_pk_bf16_f32 v69, v190, v191
    v_exp_f32 v192, v192
    v_exp_f32 v193, v193
    v_add_f32 v9, v9, v192
    v_add_f32 v9, v9, v193
    v_cvt_pk_bf16_f32 v66, v192, v193
    v_exp_f32 v194, v194
    v_exp_f32 v195, v195
    v_add_f32 v9, v9, v194
    v_add_f32 v9, v9, v195
    v_cvt_pk_bf16_f32 v67, v194, v195
    v_exp_f32 v196, v196
    v_exp_f32 v197, v197
    v_add_f32 v10, v10, v196
    v_add_f32 v10, v10, v197
    v_cvt_pk_bf16_f32 v70, v196, v197
    v_exp_f32 v198, v198
    v_exp_f32 v199, v199
    v_add_f32 v10, v10, v198
    v_add_f32 v10, v10, v199
    v_cvt_pk_bf16_f32 v71, v198, v199
    s_mov_b32 s17, 0xc000
    buffer_load_dwordx4 v[200:203], v8, s[8:11], s17 offen offset:0
    buffer_load_dwordx4 v[204:207], v8, s[8:11], s17 offen offset:1024
    buffer_load_dwordx4 v[208:211], v8, s[8:11], s17 offen offset:2048
    buffer_load_dwordx4 v[212:215], v8, s[8:11], s17 offen offset:3072
    s_waitcnt vmcnt(3)
    v_mfma_f32_16x16x32_bf16 v[184:187], v[200:203], v[152:155], v[216:219]
    v_mfma_f32_16x16x32_bf16 v[188:191], v[200:203], v[168:171], v[220:223]
    s_waitcnt vmcnt(2)
    v_mfma_f32_16x16x32_bf16 v[192:195], v[204:207], v[152:155], v[216:219]
    v_mfma_f32_16x16x32_bf16 v[196:199], v[204:207], v[168:171], v[220:223]
    s_waitcnt vmcnt(1)
    v_mfma_f32_16x16x32_bf16 v[184:187], v[208:211], v[156:159], v[184:187]
    v_mfma_f32_16x16x32_bf16 v[188:191], v[208:211], v[172:175], v[188:191]
    s_waitcnt vmcnt(0)
    v_mfma_f32_16x16x32_bf16 v[192:195], v[212:215], v[156:159], v[192:195]
    v_mfma_f32_16x16x32_bf16 v[196:199], v[212:215], v[172:175], v[196:199]
    s_mov_b32 s17, 0xd000
    buffer_load_dwordx4 v[200:203], v8, s[8:11], s17 offen offset:0
    buffer_load_dwordx4 v[204:207], v8, s[8:11], s17 offen offset:1024
    buffer_load_dwordx4 v[208:211], v8, s[8:11], s17 offen offset:2048
    buffer_load_dwordx4 v[212:215], v8, s[8:11], s17 offen offset:3072
    s_waitcnt vmcnt(3)
    v_mfma_f32_16x16x32_bf16 v[184:187], v[200:203], v[160:163], v[184:187]
    v_mfma_f32_16x16x32_bf16 v[188:191], v[200:203], v[176:179], v[188:191]
    s_waitcnt vmcnt(2)
    v_mfma_f32_16x16x32_bf16 v[192:195], v[204:207], v[160:163], v[192:195]
    v_mfma_f32_16x16x32_bf16 v[196:199], v[204:207], v[176:179], v[196:199]
    s_waitcnt vmcnt(1)
    v_mfma_f32_16x16x32_bf16 v[184:187], v[208:211], v[164:167], v[184:187]
    v_mfma_f32_16x16x32_bf16 v[188:191], v[208:211], v[180:183], v[188:191]
    s_waitcnt vmcnt(0)
    v_mfma_f32_16x16x32_bf16 v[192:195], v[212:215], v[164:167], v[192:195]
    v_mfma_f32_16x16x32_bf16 v[196:199], v[212:215], v[180:183], v[196:199]
    s_nop 3
    v_exp_f32 v184, v184
    v_exp_f32 v185, v185
    v_add_f32 v9, v9, v184
    v_add_f32 v9, v9, v185
    v_cvt_pk_bf16_f32 v72, v184, v185
    v_exp_f32 v186, v186
    v_exp_f32 v187, v187
    v_add_f32 v9, v9, v186
    v_add_f32 v9, v9, v187
    v_cvt_pk_bf16_f32 v73, v186, v187
    v_exp_f32 v188, v188
    v_exp_f32 v189, v189
    v_add_f32 v10, v10, v188
    v_add_f32 v10, v10, v189
    v_cvt_pk_bf16_f32 v76, v188, v189
    v_exp_f32 v190, v190
    v_exp_f32 v191, v191
    v_add_f32 v10, v10, v190
    v_add_f32 v10, v10, v191
    v_cvt_pk_bf16_f32 v77, v190, v191
    v_exp_f32 v192, v192
    v_exp_f32 v193, v193
    v_add_f32 v9, v9, v192
    v_add_f32 v9, v9, v193
    v_cvt_pk_bf16_f32 v74, v192, v193
    v_exp_f32 v194, v194
    v_exp_f32 v195, v195
    v_add_f32 v9, v9, v194
    v_add_f32 v9, v9, v195
    v_cvt_pk_bf16_f32 v75, v194, v195
    v_exp_f32 v196, v196
    v_exp_f32 v197, v197
    v_add_f32 v10, v10, v196
    v_add_f32 v10, v10, v197
    v_cvt_pk_bf16_f32 v78, v196, v197
    v_exp_f32 v198, v198
    v_exp_f32 v199, v199
    v_add_f32 v10, v10, v198
    v_add_f32 v10, v10, v199
    v_cvt_pk_bf16_f32 v79, v198, v199
    s_mov_b32 s17, 0xe000
    buffer_load_dwordx4 v[200:203], v8, s[8:11], s17 offen offset:0
    buffer_load_dwordx4 v[204:207], v8, s[8:11], s17 offen offset:1024
    buffer_load_dwordx4 v[208:211], v8, s[8:11], s17 offen offset:2048
    buffer_load_dwordx4 v[212:215], v8, s[8:11], s17 offen offset:3072
    s_waitcnt vmcnt(3)
    v_mfma_f32_16x16x32_bf16 v[184:187], v[200:203], v[152:155], v[216:219]
    v_mfma_f32_16x16x32_bf16 v[188:191], v[200:203], v[168:171], v[220:223]
    s_waitcnt vmcnt(2)
    v_mfma_f32_16x16x32_bf16 v[192:195], v[204:207], v[152:155], v[216:219]
    v_mfma_f32_16x16x32_bf16 v[196:199], v[204:207], v[168:171], v[220:223]
    s_waitcnt vmcnt(1)
    v_mfma_f32_16x16x32_bf16 v[184:187], v[208:211], v[156:159], v[184:187]
    v_mfma_f32_16x16x32_bf16 v[188:191], v[208:211], v[172:175], v[188:191]
    s_waitcnt vmcnt(0)
    v_mfma_f32_16x16x32_bf16 v[192:195], v[212:215], v[156:159], v[192:195]
    v_mfma_f32_16x16x32_bf16 v[196:199], v[212:215], v[172:175], v[196:199]
    s_mov_b32 s17, 0xf000
    buffer_load_dwordx4 v[200:203], v8, s[8:11], s17 offen offset:0
    buffer_load_dwordx4 v[204:207], v8, s[8:11], s17 offen offset:1024
    buffer_load_dwordx4 v[208:211], v8, s[8:11], s17 offen offset:2048
    buffer_load_dwordx4 v[212:215], v8, s[8:11], s17 offen offset:3072
    s_waitcnt vmcnt(3)
    v_mfma_f32_16x16x32_bf16 v[184:187], v[200:203], v[160:163], v[184:187]
    v_mfma_f32_16x16x32_bf16 v[188:191], v[200:203], v[176:179], v[188:191]
    s_waitcnt vmcnt(2)
    v_mfma_f32_16x16x32_bf16 v[192:195], v[204:207], v[160:163], v[192:195]
    v_mfma_f32_16x16x32_bf16 v[196:199], v[204:207], v[176:179], v[196:199]
    s_waitcnt vmcnt(1)
    v_mfma_f32_16x16x32_bf16 v[184:187], v[208:211], v[164:167], v[184:187]
    v_mfma_f32_16x16x32_bf16 v[188:191], v[208:211], v[180:183], v[188:191]
    s_waitcnt vmcnt(0)
    v_mfma_f32_16x16x32_bf16 v[192:195], v[212:215], v[164:167], v[192:195]
    v_mfma_f32_16x16x32_bf16 v[196:199], v[212:215], v[180:183], v[196:199]
    s_nop 3
    v_exp_f32 v184, v184
    v_exp_f32 v185, v185
    v_add_f32 v9, v9, v184
    v_add_f32 v9, v9, v185
    v_cvt_pk_bf16_f32 v80, v184, v185
    v_exp_f32 v186, v186
    v_exp_f32 v187, v187
    v_add_f32 v9, v9, v186
    v_add_f32 v9, v9, v187
    v_cvt_pk_bf16_f32 v81, v186, v187
    v_exp_f32 v188, v188
    v_exp_f32 v189, v189
    v_add_f32 v10, v10, v188
    v_add_f32 v10, v10, v189
    v_cvt_pk_bf16_f32 v84, v188, v189
    v_exp_f32 v190, v190
    v_exp_f32 v191, v191
    v_add_f32 v10, v10, v190
    v_add_f32 v10, v10, v191
    v_cvt_pk_bf16_f32 v85, v190, v191
    v_exp_f32 v192, v192
    v_exp_f32 v193, v193
    v_add_f32 v9, v9, v192
    v_add_f32 v9, v9, v193
    v_cvt_pk_bf16_f32 v82, v192, v193
    v_exp_f32 v194, v194
    v_exp_f32 v195, v195
    v_add_f32 v9, v9, v194
    v_add_f32 v9, v9, v195
    v_cvt_pk_bf16_f32 v83, v194, v195
    v_exp_f32 v196, v196
    v_exp_f32 v197, v197
    v_add_f32 v10, v10, v196
    v_add_f32 v10, v10, v197
    v_cvt_pk_bf16_f32 v86, v196, v197
    v_exp_f32 v198, v198
    v_exp_f32 v199, v199
    v_add_f32 v10, v10, v198
    v_add_f32 v10, v10, v199
    v_cvt_pk_bf16_f32 v87, v198, v199
    s_mov_b32 s17, 0x10000
    buffer_load_dwordx4 v[200:203], v8, s[8:11], s17 offen offset:0
    buffer_load_dwordx4 v[204:207], v8, s[8:11], s17 offen offset:1024
    buffer_load_dwordx4 v[208:211], v8, s[8:11], s17 offen offset:2048
    buffer_load_dwordx4 v[212:215], v8, s[8:11], s17 offen offset:3072
    s_waitcnt vmcnt(3)
    v_mfma_f32_16x16x32_bf16 v[184:187], v[200:203], v[152:155], v[216:219]
    v_mfma_f32_16x16x32_bf16 v[188:191], v[200:203], v[168:171], v[220:223]
    s_waitcnt vmcnt(2)
    v_mfma_f32_16x16x32_bf16 v[192:195], v[204:207], v[152:155], v[216:219]
    v_mfma_f32_16x16x32_bf16 v[196:199], v[204:207], v[168:171], v[220:223]
    s_waitcnt vmcnt(1)
    v_mfma_f32_16x16x32_bf16 v[184:187], v[208:211], v[156:159], v[184:187]
    v_mfma_f32_16x16x32_bf16 v[188:191], v[208:211], v[172:175], v[188:191]
    s_waitcnt vmcnt(0)
    v_mfma_f32_16x16x32_bf16 v[192:195], v[212:215], v[156:159], v[192:195]
    v_mfma_f32_16x16x32_bf16 v[196:199], v[212:215], v[172:175], v[196:199]
    s_mov_b32 s17, 0x11000
    buffer_load_dwordx4 v[200:203], v8, s[8:11], s17 offen offset:0
    buffer_load_dwordx4 v[204:207], v8, s[8:11], s17 offen offset:1024
    buffer_load_dwordx4 v[208:211], v8, s[8:11], s17 offen offset:2048
    buffer_load_dwordx4 v[212:215], v8, s[8:11], s17 offen offset:3072
    s_waitcnt vmcnt(3)
    v_mfma_f32_16x16x32_bf16 v[184:187], v[200:203], v[160:163], v[184:187]
    v_mfma_f32_16x16x32_bf16 v[188:191], v[200:203], v[176:179], v[188:191]
    s_waitcnt vmcnt(2)
    v_mfma_f32_16x16x32_bf16 v[192:195], v[204:207], v[160:163], v[192:195]
    v_mfma_f32_16x16x32_bf16 v[196:199], v[204:207], v[176:179], v[196:199]
    s_waitcnt vmcnt(1)
    v_mfma_f32_16x16x32_bf16 v[184:187], v[208:211], v[164:167], v[184:187]
    v_mfma_f32_16x16x32_bf16 v[188:191], v[208:211], v[180:183], v[188:191]
    s_waitcnt vmcnt(0)
    v_mfma_f32_16x16x32_bf16 v[192:195], v[212:215], v[164:167], v[192:195]
    v_mfma_f32_16x16x32_bf16 v[196:199], v[212:215], v[180:183], v[196:199]
    s_nop 3
    v_exp_f32 v184, v184
    v_exp_f32 v185, v185
    v_add_f32 v9, v9, v184
    v_add_f32 v9, v9, v185
    v_cvt_pk_bf16_f32 v88, v184, v185
    v_exp_f32 v186, v186
    v_exp_f32 v187, v187
    v_add_f32 v9, v9, v186
    v_add_f32 v9, v9, v187
    v_cvt_pk_bf16_f32 v89, v186, v187
    v_exp_f32 v188, v188
    v_exp_f32 v189, v189
    v_add_f32 v10, v10, v188
    v_add_f32 v10, v10, v189
    v_cvt_pk_bf16_f32 v92, v188, v189
    v_exp_f32 v190, v190
    v_exp_f32 v191, v191
    v_add_f32 v10, v10, v190
    v_add_f32 v10, v10, v191
    v_cvt_pk_bf16_f32 v93, v190, v191
    v_exp_f32 v192, v192
    v_exp_f32 v193, v193
    v_add_f32 v9, v9, v192
    v_add_f32 v9, v9, v193
    v_cvt_pk_bf16_f32 v90, v192, v193
    v_exp_f32 v194, v194
    v_exp_f32 v195, v195
    v_add_f32 v9, v9, v194
    v_add_f32 v9, v9, v195
    v_cvt_pk_bf16_f32 v91, v194, v195
    v_exp_f32 v196, v196
    v_exp_f32 v197, v197
    v_add_f32 v10, v10, v196
    v_add_f32 v10, v10, v197
    v_cvt_pk_bf16_f32 v94, v196, v197
    v_exp_f32 v198, v198
    v_exp_f32 v199, v199
    v_add_f32 v10, v10, v198
    v_add_f32 v10, v10, v199
    v_cvt_pk_bf16_f32 v95, v198, v199
    s_mov_b32 s17, 0x12000
    buffer_load_dwordx4 v[200:203], v8, s[8:11], s17 offen offset:0
    buffer_load_dwordx4 v[204:207], v8, s[8:11], s17 offen offset:1024
    buffer_load_dwordx4 v[208:211], v8, s[8:11], s17 offen offset:2048
    buffer_load_dwordx4 v[212:215], v8, s[8:11], s17 offen offset:3072
    s_waitcnt vmcnt(3)
    v_mfma_f32_16x16x32_bf16 v[184:187], v[200:203], v[152:155], v[216:219]
    v_mfma_f32_16x16x32_bf16 v[188:191], v[200:203], v[168:171], v[220:223]
    s_waitcnt vmcnt(2)
    v_mfma_f32_16x16x32_bf16 v[192:195], v[204:207], v[152:155], v[216:219]
    v_mfma_f32_16x16x32_bf16 v[196:199], v[204:207], v[168:171], v[220:223]
    s_waitcnt vmcnt(1)
    v_mfma_f32_16x16x32_bf16 v[184:187], v[208:211], v[156:159], v[184:187]
    v_mfma_f32_16x16x32_bf16 v[188:191], v[208:211], v[172:175], v[188:191]
    s_waitcnt vmcnt(0)
    v_mfma_f32_16x16x32_bf16 v[192:195], v[212:215], v[156:159], v[192:195]
    v_mfma_f32_16x16x32_bf16 v[196:199], v[212:215], v[172:175], v[196:199]
    s_mov_b32 s17, 0x13000
    buffer_load_dwordx4 v[200:203], v8, s[8:11], s17 offen offset:0
    buffer_load_dwordx4 v[204:207], v8, s[8:11], s17 offen offset:1024
    buffer_load_dwordx4 v[208:211], v8, s[8:11], s17 offen offset:2048
    buffer_load_dwordx4 v[212:215], v8, s[8:11], s17 offen offset:3072
    s_waitcnt vmcnt(3)
    v_mfma_f32_16x16x32_bf16 v[184:187], v[200:203], v[160:163], v[184:187]
    v_mfma_f32_16x16x32_bf16 v[188:191], v[200:203], v[176:179], v[188:191]
    s_waitcnt vmcnt(2)
    v_mfma_f32_16x16x32_bf16 v[192:195], v[204:207], v[160:163], v[192:195]
    v_mfma_f32_16x16x32_bf16 v[196:199], v[204:207], v[176:179], v[196:199]
    s_waitcnt vmcnt(1)
    v_mfma_f32_16x16x32_bf16 v[184:187], v[208:211], v[164:167], v[184:187]
    v_mfma_f32_16x16x32_bf16 v[188:191], v[208:211], v[180:183], v[188:191]
    s_waitcnt vmcnt(0)
    v_mfma_f32_16x16x32_bf16 v[192:195], v[212:215], v[164:167], v[192:195]
    v_mfma_f32_16x16x32_bf16 v[196:199], v[212:215], v[180:183], v[196:199]
    s_nop 3
    v_exp_f32 v184, v184
    v_exp_f32 v185, v185
    v_add_f32 v9, v9, v184
    v_add_f32 v9, v9, v185
    v_cvt_pk_bf16_f32 v96, v184, v185
    v_exp_f32 v186, v186
    v_exp_f32 v187, v187
    v_add_f32 v9, v9, v186
    v_add_f32 v9, v9, v187
    v_cvt_pk_bf16_f32 v97, v186, v187
    v_exp_f32 v188, v188
    v_exp_f32 v189, v189
    v_add_f32 v10, v10, v188
    v_add_f32 v10, v10, v189
    v_cvt_pk_bf16_f32 v100, v188, v189
    v_exp_f32 v190, v190
    v_exp_f32 v191, v191
    v_add_f32 v10, v10, v190
    v_add_f32 v10, v10, v191
    v_cvt_pk_bf16_f32 v101, v190, v191
    v_exp_f32 v192, v192
    v_exp_f32 v193, v193
    v_add_f32 v9, v9, v192
    v_add_f32 v9, v9, v193
    v_cvt_pk_bf16_f32 v98, v192, v193
    v_exp_f32 v194, v194
    v_exp_f32 v195, v195
    v_add_f32 v9, v9, v194
    v_add_f32 v9, v9, v195
    v_cvt_pk_bf16_f32 v99, v194, v195
    v_exp_f32 v196, v196
    v_exp_f32 v197, v197
    v_add_f32 v10, v10, v196
    v_add_f32 v10, v10, v197
    v_cvt_pk_bf16_f32 v102, v196, v197
    v_exp_f32 v198, v198
    v_exp_f32 v199, v199
    v_add_f32 v10, v10, v198
    v_add_f32 v10, v10, v199
    v_cvt_pk_bf16_f32 v103, v198, v199
    s_mov_b32 s17, 0x14000
    buffer_load_dwordx4 v[200:203], v8, s[8:11], s17 offen offset:0
    buffer_load_dwordx4 v[204:207], v8, s[8:11], s17 offen offset:1024
    buffer_load_dwordx4 v[208:211], v8, s[8:11], s17 offen offset:2048
    buffer_load_dwordx4 v[212:215], v8, s[8:11], s17 offen offset:3072
    s_waitcnt vmcnt(3)
    v_mfma_f32_16x16x32_bf16 v[184:187], v[200:203], v[152:155], v[216:219]
    v_mfma_f32_16x16x32_bf16 v[188:191], v[200:203], v[168:171], v[220:223]
    s_waitcnt vmcnt(2)
    v_mfma_f32_16x16x32_bf16 v[192:195], v[204:207], v[152:155], v[216:219]
    v_mfma_f32_16x16x32_bf16 v[196:199], v[204:207], v[168:171], v[220:223]
    s_waitcnt vmcnt(1)
    v_mfma_f32_16x16x32_bf16 v[184:187], v[208:211], v[156:159], v[184:187]
    v_mfma_f32_16x16x32_bf16 v[188:191], v[208:211], v[172:175], v[188:191]
    s_waitcnt vmcnt(0)
    v_mfma_f32_16x16x32_bf16 v[192:195], v[212:215], v[156:159], v[192:195]
    v_mfma_f32_16x16x32_bf16 v[196:199], v[212:215], v[172:175], v[196:199]
    s_mov_b32 s17, 0x15000
    buffer_load_dwordx4 v[200:203], v8, s[8:11], s17 offen offset:0
    buffer_load_dwordx4 v[204:207], v8, s[8:11], s17 offen offset:1024
    buffer_load_dwordx4 v[208:211], v8, s[8:11], s17 offen offset:2048
    buffer_load_dwordx4 v[212:215], v8, s[8:11], s17 offen offset:3072
    s_waitcnt vmcnt(3)
    v_mfma_f32_16x16x32_bf16 v[184:187], v[200:203], v[160:163], v[184:187]
    v_mfma_f32_16x16x32_bf16 v[188:191], v[200:203], v[176:179], v[188:191]
    s_waitcnt vmcnt(2)
    v_mfma_f32_16x16x32_bf16 v[192:195], v[204:207], v[160:163], v[192:195]
    v_mfma_f32_16x16x32_bf16 v[196:199], v[204:207], v[176:179], v[196:199]
    s_waitcnt vmcnt(1)
    v_mfma_f32_16x16x32_bf16 v[184:187], v[208:211], v[164:167], v[184:187]
    v_mfma_f32_16x16x32_bf16 v[188:191], v[208:211], v[180:183], v[188:191]
    s_waitcnt vmcnt(0)
    v_mfma_f32_16x16x32_bf16 v[192:195], v[212:215], v[164:167], v[192:195]
    v_mfma_f32_16x16x32_bf16 v[196:199], v[212:215], v[180:183], v[196:199]
    s_nop 3
    v_exp_f32 v184, v184
    v_exp_f32 v185, v185
    v_add_f32 v9, v9, v184
    v_add_f32 v9, v9, v185
    v_cvt_pk_bf16_f32 v104, v184, v185
    v_exp_f32 v186, v186
    v_exp_f32 v187, v187
    v_add_f32 v9, v9, v186
    v_add_f32 v9, v9, v187
    v_cvt_pk_bf16_f32 v105, v186, v187
    v_exp_f32 v188, v188
    v_exp_f32 v189, v189
    v_add_f32 v10, v10, v188
    v_add_f32 v10, v10, v189
    v_cvt_pk_bf16_f32 v108, v188, v189
    v_exp_f32 v190, v190
    v_exp_f32 v191, v191
    v_add_f32 v10, v10, v190
    v_add_f32 v10, v10, v191
    v_cvt_pk_bf16_f32 v109, v190, v191
    v_exp_f32 v192, v192
    v_exp_f32 v193, v193
    v_add_f32 v9, v9, v192
    v_add_f32 v9, v9, v193
    v_cvt_pk_bf16_f32 v106, v192, v193
    v_exp_f32 v194, v194
    v_exp_f32 v195, v195
    v_add_f32 v9, v9, v194
    v_add_f32 v9, v9, v195
    v_cvt_pk_bf16_f32 v107, v194, v195
    v_exp_f32 v196, v196
    v_exp_f32 v197, v197
    v_add_f32 v10, v10, v196
    v_add_f32 v10, v10, v197
    v_cvt_pk_bf16_f32 v110, v196, v197
    v_exp_f32 v198, v198
    v_exp_f32 v199, v199
    v_add_f32 v10, v10, v198
    v_add_f32 v10, v10, v199
    v_cvt_pk_bf16_f32 v111, v198, v199
    s_mov_b32 s17, 0x16000
    buffer_load_dwordx4 v[200:203], v8, s[8:11], s17 offen offset:0
    buffer_load_dwordx4 v[204:207], v8, s[8:11], s17 offen offset:1024
    buffer_load_dwordx4 v[208:211], v8, s[8:11], s17 offen offset:2048
    buffer_load_dwordx4 v[212:215], v8, s[8:11], s17 offen offset:3072
    s_waitcnt vmcnt(3)
    v_mfma_f32_16x16x32_bf16 v[184:187], v[200:203], v[152:155], v[216:219]
    v_mfma_f32_16x16x32_bf16 v[188:191], v[200:203], v[168:171], v[220:223]
    s_waitcnt vmcnt(2)
    v_mfma_f32_16x16x32_bf16 v[192:195], v[204:207], v[152:155], v[216:219]
    v_mfma_f32_16x16x32_bf16 v[196:199], v[204:207], v[168:171], v[220:223]
    s_waitcnt vmcnt(1)
    v_mfma_f32_16x16x32_bf16 v[184:187], v[208:211], v[156:159], v[184:187]
    v_mfma_f32_16x16x32_bf16 v[188:191], v[208:211], v[172:175], v[188:191]
    s_waitcnt vmcnt(0)
    v_mfma_f32_16x16x32_bf16 v[192:195], v[212:215], v[156:159], v[192:195]
    v_mfma_f32_16x16x32_bf16 v[196:199], v[212:215], v[172:175], v[196:199]
    s_mov_b32 s17, 0x17000
    buffer_load_dwordx4 v[200:203], v8, s[8:11], s17 offen offset:0
    buffer_load_dwordx4 v[204:207], v8, s[8:11], s17 offen offset:1024
    buffer_load_dwordx4 v[208:211], v8, s[8:11], s17 offen offset:2048
    buffer_load_dwordx4 v[212:215], v8, s[8:11], s17 offen offset:3072
    s_waitcnt vmcnt(3)
    v_mfma_f32_16x16x32_bf16 v[184:187], v[200:203], v[160:163], v[184:187]
    v_mfma_f32_16x16x32_bf16 v[188:191], v[200:203], v[176:179], v[188:191]
    s_waitcnt vmcnt(2)
    v_mfma_f32_16x16x32_bf16 v[192:195], v[204:207], v[160:163], v[192:195]
    v_mfma_f32_16x16x32_bf16 v[196:199], v[204:207], v[176:179], v[196:199]
    s_waitcnt vmcnt(1)
    v_mfma_f32_16x16x32_bf16 v[184:187], v[208:211], v[164:167], v[184:187]
    v_mfma_f32_16x16x32_bf16 v[188:191], v[208:211], v[180:183], v[188:191]
    s_waitcnt vmcnt(0)
    v_mfma_f32_16x16x32_bf16 v[192:195], v[212:215], v[164:167], v[192:195]
    v_mfma_f32_16x16x32_bf16 v[196:199], v[212:215], v[180:183], v[196:199]
    s_nop 3
    v_exp_f32 v184, v184
    v_exp_f32 v185, v185
    v_add_f32 v9, v9, v184
    v_add_f32 v9, v9, v185
    v_cvt_pk_bf16_f32 v112, v184, v185
    v_exp_f32 v186, v186
    v_exp_f32 v187, v187
    v_add_f32 v9, v9, v186
    v_add_f32 v9, v9, v187
    v_cvt_pk_bf16_f32 v113, v186, v187
    v_exp_f32 v188, v188
    v_exp_f32 v189, v189
    v_add_f32 v10, v10, v188
    v_add_f32 v10, v10, v189
    v_cvt_pk_bf16_f32 v116, v188, v189
    v_exp_f32 v190, v190
    v_exp_f32 v191, v191
    v_add_f32 v10, v10, v190
    v_add_f32 v10, v10, v191
    v_cvt_pk_bf16_f32 v117, v190, v191
    v_exp_f32 v192, v192
    v_exp_f32 v193, v193
    v_add_f32 v9, v9, v192
    v_add_f32 v9, v9, v193
    v_cvt_pk_bf16_f32 v114, v192, v193
    v_exp_f32 v194, v194
    v_exp_f32 v195, v195
    v_add_f32 v9, v9, v194
    v_add_f32 v9, v9, v195
    v_cvt_pk_bf16_f32 v115, v194, v195
    v_exp_f32 v196, v196
    v_exp_f32 v197, v197
    v_add_f32 v10, v10, v196
    v_add_f32 v10, v10, v197
    v_cvt_pk_bf16_f32 v118, v196, v197
    v_exp_f32 v198, v198
    v_exp_f32 v199, v199
    v_add_f32 v10, v10, v198
    v_add_f32 v10, v10, v199
    v_cvt_pk_bf16_f32 v119, v198, v199
    s_mov_b32 s17, 0x18000
    buffer_load_dwordx4 v[200:203], v8, s[8:11], s17 offen offset:0
    buffer_load_dwordx4 v[204:207], v8, s[8:11], s17 offen offset:1024
    buffer_load_dwordx4 v[208:211], v8, s[8:11], s17 offen offset:2048
    buffer_load_dwordx4 v[212:215], v8, s[8:11], s17 offen offset:3072
    s_waitcnt vmcnt(3)
    v_mfma_f32_16x16x32_bf16 v[184:187], v[200:203], v[152:155], v[216:219]
    v_mfma_f32_16x16x32_bf16 v[188:191], v[200:203], v[168:171], v[220:223]
    s_waitcnt vmcnt(2)
    v_mfma_f32_16x16x32_bf16 v[192:195], v[204:207], v[152:155], v[216:219]
    v_mfma_f32_16x16x32_bf16 v[196:199], v[204:207], v[168:171], v[220:223]
    s_waitcnt vmcnt(1)
    v_mfma_f32_16x16x32_bf16 v[184:187], v[208:211], v[156:159], v[184:187]
    v_mfma_f32_16x16x32_bf16 v[188:191], v[208:211], v[172:175], v[188:191]
    s_waitcnt vmcnt(0)
    v_mfma_f32_16x16x32_bf16 v[192:195], v[212:215], v[156:159], v[192:195]
    v_mfma_f32_16x16x32_bf16 v[196:199], v[212:215], v[172:175], v[196:199]
    s_mov_b32 s17, 0x19000
    buffer_load_dwordx4 v[200:203], v8, s[8:11], s17 offen offset:0
    buffer_load_dwordx4 v[204:207], v8, s[8:11], s17 offen offset:1024
    buffer_load_dwordx4 v[208:211], v8, s[8:11], s17 offen offset:2048
    buffer_load_dwordx4 v[212:215], v8, s[8:11], s17 offen offset:3072
    s_waitcnt vmcnt(3)
    v_mfma_f32_16x16x32_bf16 v[184:187], v[200:203], v[160:163], v[184:187]
    v_mfma_f32_16x16x32_bf16 v[188:191], v[200:203], v[176:179], v[188:191]
    s_waitcnt vmcnt(2)
    v_mfma_f32_16x16x32_bf16 v[192:195], v[204:207], v[160:163], v[192:195]
    v_mfma_f32_16x16x32_bf16 v[196:199], v[204:207], v[176:179], v[196:199]
    s_waitcnt vmcnt(1)
    v_mfma_f32_16x16x32_bf16 v[184:187], v[208:211], v[164:167], v[184:187]
    v_mfma_f32_16x16x32_bf16 v[188:191], v[208:211], v[180:183], v[188:191]
    s_waitcnt vmcnt(0)
    v_mfma_f32_16x16x32_bf16 v[192:195], v[212:215], v[164:167], v[192:195]
    v_mfma_f32_16x16x32_bf16 v[196:199], v[212:215], v[180:183], v[196:199]
    s_nop 3
    v_exp_f32 v184, v184
    v_exp_f32 v185, v185
    v_add_f32 v9, v9, v184
    v_add_f32 v9, v9, v185
    v_cvt_pk_bf16_f32 v120, v184, v185
    v_exp_f32 v186, v186
    v_exp_f32 v187, v187
    v_add_f32 v9, v9, v186
    v_add_f32 v9, v9, v187
    v_cvt_pk_bf16_f32 v121, v186, v187
    v_exp_f32 v188, v188
    v_exp_f32 v189, v189
    v_add_f32 v10, v10, v188
    v_add_f32 v10, v10, v189
    v_cvt_pk_bf16_f32 v124, v188, v189
    v_exp_f32 v190, v190
    v_exp_f32 v191, v191
    v_add_f32 v10, v10, v190
    v_add_f32 v10, v10, v191
    v_cvt_pk_bf16_f32 v125, v190, v191
    v_exp_f32 v192, v192
    v_exp_f32 v193, v193
    v_add_f32 v9, v9, v192
    v_add_f32 v9, v9, v193
    v_cvt_pk_bf16_f32 v122, v192, v193
    v_exp_f32 v194, v194
    v_exp_f32 v195, v195
    v_add_f32 v9, v9, v194
    v_add_f32 v9, v9, v195
    v_cvt_pk_bf16_f32 v123, v194, v195
    v_exp_f32 v196, v196
    v_exp_f32 v197, v197
    v_add_f32 v10, v10, v196
    v_add_f32 v10, v10, v197
    v_cvt_pk_bf16_f32 v126, v196, v197
    v_exp_f32 v198, v198
    v_exp_f32 v199, v199
    v_add_f32 v10, v10, v198
    v_add_f32 v10, v10, v199
    v_cvt_pk_bf16_f32 v127, v198, v199
    s_mov_b32 s17, 0x1a000
    buffer_load_dwordx4 v[200:203], v8, s[8:11], s17 offen offset:0
    buffer_load_dwordx4 v[204:207], v8, s[8:11], s17 offen offset:1024
    buffer_load_dwordx4 v[208:211], v8, s[8:11], s17 offen offset:2048
    buffer_load_dwordx4 v[212:215], v8, s[8:11], s17 offen offset:3072
    s_waitcnt vmcnt(3)
    v_mfma_f32_16x16x32_bf16 v[184:187], v[200:203], v[152:155], v[216:219]
    v_mfma_f32_16x16x32_bf16 v[188:191], v[200:203], v[168:171], v[220:223]
    s_waitcnt vmcnt(2)
    v_mfma_f32_16x16x32_bf16 v[192:195], v[204:207], v[152:155], v[216:219]
    v_mfma_f32_16x16x32_bf16 v[196:199], v[204:207], v[168:171], v[220:223]
    s_waitcnt vmcnt(1)
    v_mfma_f32_16x16x32_bf16 v[184:187], v[208:211], v[156:159], v[184:187]
    v_mfma_f32_16x16x32_bf16 v[188:191], v[208:211], v[172:175], v[188:191]
    s_waitcnt vmcnt(0)
    v_mfma_f32_16x16x32_bf16 v[192:195], v[212:215], v[156:159], v[192:195]
    v_mfma_f32_16x16x32_bf16 v[196:199], v[212:215], v[172:175], v[196:199]
    s_mov_b32 s17, 0x1b000
    buffer_load_dwordx4 v[200:203], v8, s[8:11], s17 offen offset:0
    buffer_load_dwordx4 v[204:207], v8, s[8:11], s17 offen offset:1024
    buffer_load_dwordx4 v[208:211], v8, s[8:11], s17 offen offset:2048
    buffer_load_dwordx4 v[212:215], v8, s[8:11], s17 offen offset:3072
    s_waitcnt vmcnt(3)
    v_mfma_f32_16x16x32_bf16 v[184:187], v[200:203], v[160:163], v[184:187]
    v_mfma_f32_16x16x32_bf16 v[188:191], v[200:203], v[176:179], v[188:191]
    s_waitcnt vmcnt(2)
    v_mfma_f32_16x16x32_bf16 v[192:195], v[204:207], v[160:163], v[192:195]
    v_mfma_f32_16x16x32_bf16 v[196:199], v[204:207], v[176:179], v[196:199]
    s_waitcnt vmcnt(1)
    v_mfma_f32_16x16x32_bf16 v[184:187], v[208:211], v[164:167], v[184:187]
    v_mfma_f32_16x16x32_bf16 v[188:191], v[208:211], v[180:183], v[188:191]
    s_waitcnt vmcnt(0)
    v_mfma_f32_16x16x32_bf16 v[192:195], v[212:215], v[164:167], v[192:195]
    v_mfma_f32_16x16x32_bf16 v[196:199], v[212:215], v[180:183], v[196:199]
    s_nop 3
    v_exp_f32 v184, v184
    v_exp_f32 v185, v185
    v_add_f32 v9, v9, v184
    v_add_f32 v9, v9, v185
    v_cvt_pk_bf16_f32 v128, v184, v185
    v_exp_f32 v186, v186
    v_exp_f32 v187, v187
    v_add_f32 v9, v9, v186
    v_add_f32 v9, v9, v187
    v_cvt_pk_bf16_f32 v129, v186, v187
    v_exp_f32 v188, v188
    v_exp_f32 v189, v189
    v_add_f32 v10, v10, v188
    v_add_f32 v10, v10, v189
    v_cvt_pk_bf16_f32 v132, v188, v189
    v_exp_f32 v190, v190
    v_exp_f32 v191, v191
    v_add_f32 v10, v10, v190
    v_add_f32 v10, v10, v191
    v_cvt_pk_bf16_f32 v133, v190, v191
    v_exp_f32 v192, v192
    v_exp_f32 v193, v193
    v_add_f32 v9, v9, v192
    v_add_f32 v9, v9, v193
    v_cvt_pk_bf16_f32 v130, v192, v193
    v_exp_f32 v194, v194
    v_exp_f32 v195, v195
    v_add_f32 v9, v9, v194
    v_add_f32 v9, v9, v195
    v_cvt_pk_bf16_f32 v131, v194, v195
    v_exp_f32 v196, v196
    v_exp_f32 v197, v197
    v_add_f32 v10, v10, v196
    v_add_f32 v10, v10, v197
    v_cvt_pk_bf16_f32 v134, v196, v197
    v_exp_f32 v198, v198
    v_exp_f32 v199, v199
    v_add_f32 v10, v10, v198
    v_add_f32 v10, v10, v199
    v_cvt_pk_bf16_f32 v135, v198, v199
    s_mov_b32 s17, 0x1c000
    buffer_load_dwordx4 v[200:203], v8, s[8:11], s17 offen offset:0
    buffer_load_dwordx4 v[204:207], v8, s[8:11], s17 offen offset:1024
    buffer_load_dwordx4 v[208:211], v8, s[8:11], s17 offen offset:2048
    buffer_load_dwordx4 v[212:215], v8, s[8:11], s17 offen offset:3072
    s_waitcnt vmcnt(3)
    v_mfma_f32_16x16x32_bf16 v[184:187], v[200:203], v[152:155], v[216:219]
    v_mfma_f32_16x16x32_bf16 v[188:191], v[200:203], v[168:171], v[220:223]
    s_waitcnt vmcnt(2)
    v_mfma_f32_16x16x32_bf16 v[192:195], v[204:207], v[152:155], v[216:219]
    v_mfma_f32_16x16x32_bf16 v[196:199], v[204:207], v[168:171], v[220:223]
    s_waitcnt vmcnt(1)
    v_mfma_f32_16x16x32_bf16 v[184:187], v[208:211], v[156:159], v[184:187]
    v_mfma_f32_16x16x32_bf16 v[188:191], v[208:211], v[172:175], v[188:191]
    s_waitcnt vmcnt(0)
    v_mfma_f32_16x16x32_bf16 v[192:195], v[212:215], v[156:159], v[192:195]
    v_mfma_f32_16x16x32_bf16 v[196:199], v[212:215], v[172:175], v[196:199]
    s_mov_b32 s17, 0x1d000
    buffer_load_dwordx4 v[200:203], v8, s[8:11], s17 offen offset:0
    buffer_load_dwordx4 v[204:207], v8, s[8:11], s17 offen offset:1024
    buffer_load_dwordx4 v[208:211], v8, s[8:11], s17 offen offset:2048
    buffer_load_dwordx4 v[212:215], v8, s[8:11], s17 offen offset:3072
    s_waitcnt vmcnt(3)
    v_mfma_f32_16x16x32_bf16 v[184:187], v[200:203], v[160:163], v[184:187]
    v_mfma_f32_16x16x32_bf16 v[188:191], v[200:203], v[176:179], v[188:191]
    s_waitcnt vmcnt(2)
    v_mfma_f32_16x16x32_bf16 v[192:195], v[204:207], v[160:163], v[192:195]
    v_mfma_f32_16x16x32_bf16 v[196:199], v[204:207], v[176:179], v[196:199]
    s_waitcnt vmcnt(1)
    v_mfma_f32_16x16x32_bf16 v[184:187], v[208:211], v[164:167], v[184:187]
    v_mfma_f32_16x16x32_bf16 v[188:191], v[208:211], v[180:183], v[188:191]
    s_waitcnt vmcnt(0)
    v_mfma_f32_16x16x32_bf16 v[192:195], v[212:215], v[164:167], v[192:195]
    v_mfma_f32_16x16x32_bf16 v[196:199], v[212:215], v[180:183], v[196:199]
    s_nop 3
    v_exp_f32 v184, v184
    v_exp_f32 v185, v185
    v_add_f32 v9, v9, v184
    v_add_f32 v9, v9, v185
    v_cvt_pk_bf16_f32 v136, v184, v185
    v_exp_f32 v186, v186
    v_exp_f32 v187, v187
    v_add_f32 v9, v9, v186
    v_add_f32 v9, v9, v187
    v_cvt_pk_bf16_f32 v137, v186, v187
    v_exp_f32 v188, v188
    v_exp_f32 v189, v189
    v_add_f32 v10, v10, v188
    v_add_f32 v10, v10, v189
    v_cvt_pk_bf16_f32 v140, v188, v189
    v_exp_f32 v190, v190
    v_exp_f32 v191, v191
    v_add_f32 v10, v10, v190
    v_add_f32 v10, v10, v191
    v_cvt_pk_bf16_f32 v141, v190, v191
    v_exp_f32 v192, v192
    v_exp_f32 v193, v193
    v_add_f32 v9, v9, v192
    v_add_f32 v9, v9, v193
    v_cvt_pk_bf16_f32 v138, v192, v193
    v_exp_f32 v194, v194
    v_exp_f32 v195, v195
    v_add_f32 v9, v9, v194
    v_add_f32 v9, v9, v195
    v_cvt_pk_bf16_f32 v139, v194, v195
    v_exp_f32 v196, v196
    v_exp_f32 v197, v197
    v_add_f32 v10, v10, v196
    v_add_f32 v10, v10, v197
    v_cvt_pk_bf16_f32 v142, v196, v197
    v_exp_f32 v198, v198
    v_exp_f32 v199, v199
    v_add_f32 v10, v10, v198
    v_add_f32 v10, v10, v199
    v_cvt_pk_bf16_f32 v143, v198, v199
    s_mov_b32 s17, 0x1e000
    buffer_load_dwordx4 v[200:203], v8, s[8:11], s17 offen offset:0
    buffer_load_dwordx4 v[204:207], v8, s[8:11], s17 offen offset:1024
    buffer_load_dwordx4 v[208:211], v8, s[8:11], s17 offen offset:2048
    buffer_load_dwordx4 v[212:215], v8, s[8:11], s17 offen offset:3072
    s_waitcnt vmcnt(3)
    v_mfma_f32_16x16x32_bf16 v[184:187], v[200:203], v[152:155], v[216:219]
    v_mfma_f32_16x16x32_bf16 v[188:191], v[200:203], v[168:171], v[220:223]
    s_waitcnt vmcnt(2)
    v_mfma_f32_16x16x32_bf16 v[192:195], v[204:207], v[152:155], v[216:219]
    v_mfma_f32_16x16x32_bf16 v[196:199], v[204:207], v[168:171], v[220:223]
    s_waitcnt vmcnt(1)
    v_mfma_f32_16x16x32_bf16 v[184:187], v[208:211], v[156:159], v[184:187]
    v_mfma_f32_16x16x32_bf16 v[188:191], v[208:211], v[172:175], v[188:191]
    s_waitcnt vmcnt(0)
    v_mfma_f32_16x16x32_bf16 v[192:195], v[212:215], v[156:159], v[192:195]
    v_mfma_f32_16x16x32_bf16 v[196:199], v[212:215], v[172:175], v[196:199]
    s_mov_b32 s17, 0x1f000
    buffer_load_dwordx4 v[200:203], v8, s[8:11], s17 offen offset:0
    buffer_load_dwordx4 v[204:207], v8, s[8:11], s17 offen offset:1024
    buffer_load_dwordx4 v[208:211], v8, s[8:11], s17 offen offset:2048
    buffer_load_dwordx4 v[212:215], v8, s[8:11], s17 offen offset:3072
    s_waitcnt vmcnt(3)
    v_mfma_f32_16x16x32_bf16 v[184:187], v[200:203], v[160:163], v[184:187]
    v_mfma_f32_16x16x32_bf16 v[188:191], v[200:203], v[176:179], v[188:191]
    s_waitcnt vmcnt(2)
    v_mfma_f32_16x16x32_bf16 v[192:195], v[204:207], v[160:163], v[192:195]
    v_mfma_f32_16x16x32_bf16 v[196:199], v[204:207], v[176:179], v[196:199]
    s_waitcnt vmcnt(1)
    v_mfma_f32_16x16x32_bf16 v[184:187], v[208:211], v[164:167], v[184:187]
    v_mfma_f32_16x16x32_bf16 v[188:191], v[208:211], v[180:183], v[188:191]
    s_waitcnt vmcnt(0)
    v_mfma_f32_16x16x32_bf16 v[192:195], v[212:215], v[164:167], v[192:195]
    v_mfma_f32_16x16x32_bf16 v[196:199], v[212:215], v[180:183], v[196:199]
    s_nop 3
    v_exp_f32 v184, v184
    v_exp_f32 v185, v185
    v_add_f32 v9, v9, v184
    v_add_f32 v9, v9, v185
    v_cvt_pk_bf16_f32 v144, v184, v185
    v_exp_f32 v186, v186
    v_exp_f32 v187, v187
    v_add_f32 v9, v9, v186
    v_add_f32 v9, v9, v187
    v_cvt_pk_bf16_f32 v145, v186, v187
    v_exp_f32 v188, v188
    v_exp_f32 v189, v189
    v_add_f32 v10, v10, v188
    v_add_f32 v10, v10, v189
    v_cvt_pk_bf16_f32 v148, v188, v189
    v_exp_f32 v190, v190
    v_exp_f32 v191, v191
    v_add_f32 v10, v10, v190
    v_add_f32 v10, v10, v191
    v_cvt_pk_bf16_f32 v149, v190, v191
    v_exp_f32 v192, v192
    v_exp_f32 v193, v193
    v_add_f32 v9, v9, v192
    v_add_f32 v9, v9, v193
    v_cvt_pk_bf16_f32 v146, v192, v193
    v_exp_f32 v194, v194
    v_exp_f32 v195, v195
    v_add_f32 v9, v9, v194
    v_add_f32 v9, v9, v195
    v_cvt_pk_bf16_f32 v147, v194, v195
    v_exp_f32 v196, v196
    v_exp_f32 v197, v197
    v_add_f32 v10, v10, v196
    v_add_f32 v10, v10, v197
    v_cvt_pk_bf16_f32 v150, v196, v197
    v_exp_f32 v198, v198
    v_exp_f32 v199, v199
    v_add_f32 v10, v10, v198
    v_add_f32 v10, v10, v199
    v_cvt_pk_bf16_f32 v151, v198, v199
    v_mov_b32 v16, v9
    v_mov_b32 v18, v10
    s_nop 0
    v_permlane16_swap_b32 v9, v16
    v_permlane16_swap_b32 v10, v18
    v_add_f32 v9, v9, v16
    v_add_f32 v10, v10, v18
    v_mov_b32 v16, v9
    v_mov_b32 v18, v10
    s_nop 0
    v_permlane32_swap_b32 v9, v16
    v_permlane32_swap_b32 v10, v18
    v_add_f32 v9, v9, v16
    v_add_f32 v10, v10, v18
    s_waitcnt vmcnt(0) lgkmcnt(0)
    s_nop 15
    s_nop 3
    s_branch adaLN_cond__sliding_block_cached__moe_arch_mod__prompt_kernel_fixAb
adaLN_cond__sliding_block_cached__moe_arch_mod__prompt_kernel_mp5r:
    s_waitcnt vmcnt(0) lgkmcnt(0)
    s_nop 15
    s_nop 3
    s_mov_b32 s27, 0
adaLN_cond__sliding_block_cached__moe_arch_mod__prompt_kernel_mp5p:
    buffer_load_dword v248, v250, s[8:11], s14 offen sc1
    s_waitcnt vmcnt(0)
    v_cmp_ne_u32 vcc, s28, v248
    s_add_u32 s27, s27, 1
    s_cmp_ge_u32 s27, 65536
    s_cbranch_scc1 adaLN_cond__sliding_block_cached__moe_arch_mod__prompt_kernel_mp5g
    s_cbranch_vccnz adaLN_cond__sliding_block_cached__moe_arch_mod__prompt_kernel_mp5p
adaLN_cond__sliding_block_cached__moe_arch_mod__prompt_kernel_mp5g:
    s_waitcnt vmcnt(0) lgkmcnt(0)
    s_nop 15
    s_nop 3
    s_branch adaLN_cond__sliding_block_cached__moe_arch_mod__prompt_kernel_mp5b
adaLN_cond__sliding_block_cached__moe_arch_mod__prompt_kernel_o6r:
    s_waitcnt vmcnt(0) lgkmcnt(0)
    s_nop 15
    s_nop 3
    s_mov_b32 s27, 0
adaLN_cond__sliding_block_cached__moe_arch_mod__prompt_kernel_o6p:
    buffer_load_dword v12, v13, s[8:11], s19 offen sc1
    s_waitcnt vmcnt(0)
    v_cmp_ne_u32 vcc, s28, v12
    s_add_u32 s27, s27, 1
    s_cmp_ge_u32 s27, 65536
    s_cbranch_scc1 adaLN_cond__sliding_block_cached__moe_arch_mod__prompt_kernel_o6g
    s_cbranch_vccnz adaLN_cond__sliding_block_cached__moe_arch_mod__prompt_kernel_o6p
adaLN_cond__sliding_block_cached__moe_arch_mod__prompt_kernel_o6g:
    s_waitcnt vmcnt(0) lgkmcnt(0)
    s_nop 15
    s_nop 3
    s_branch adaLN_cond__sliding_block_cached__moe_arch_mod__prompt_kernel_o6b
adaLN_cond__sliding_block_cached__moe_arch_mod__prompt_kernel_o27r:
    s_waitcnt vmcnt(0) lgkmcnt(0)
    s_nop 15
    s_nop 3
    s_mov_b32 s27, 0
adaLN_cond__sliding_block_cached__moe_arch_mod__prompt_kernel_o27p:
    buffer_load_dword v12, v13, s[8:11], s19 offen sc1
    s_waitcnt vmcnt(0)
    v_cmp_ne_u32 vcc, s28, v12
    s_add_u32 s27, s27, 1
    s_cmp_ge_u32 s27, 65536
    s_cbranch_scc1 adaLN_cond__sliding_block_cached__moe_arch_mod__prompt_kernel_o27g
    s_cbranch_vccnz adaLN_cond__sliding_block_cached__moe_arch_mod__prompt_kernel_o27p
adaLN_cond__sliding_block_cached__moe_arch_mod__prompt_kernel_o27g:
    s_waitcnt vmcnt(0) lgkmcnt(0)
    s_nop 15
    s_nop 3
    s_branch adaLN_cond__sliding_block_cached__moe_arch_mod__prompt_kernel_o27b
adaLN_cond__sliding_block_cached__moe_arch_mod__prompt_kernel_o28r:
    s_waitcnt vmcnt(0) lgkmcnt(0)
    s_nop 15
    s_nop 3
    s_mov_b32 s27, 0
adaLN_cond__sliding_block_cached__moe_arch_mod__prompt_kernel_o28p:
    buffer_load_dword v12, v13, s[8:11], s19 offen sc1
    s_waitcnt vmcnt(0)
    v_cmp_ne_u32 vcc, s28, v12
    s_add_u32 s27, s27, 1
    s_cmp_ge_u32 s27, 65536
    s_cbranch_scc1 adaLN_cond__sliding_block_cached__moe_arch_mod__prompt_kernel_o28g
    s_cbranch_vccnz adaLN_cond__sliding_block_cached__moe_arch_mod__prompt_kernel_o28p
adaLN_cond__sliding_block_cached__moe_arch_mod__prompt_kernel_o28g:
    s_waitcnt vmcnt(0) lgkmcnt(0)
    s_nop 15
    s_nop 3
    s_branch adaLN_cond__sliding_block_cached__moe_arch_mod__prompt_kernel_o28b
adaLN_cond__sliding_block_cached__moe_arch_mod__prompt_kernel_o29r:
    s_waitcnt vmcnt(0) lgkmcnt(0)
    s_nop 15
    s_nop 3
    s_mov_b32 s27, 0
adaLN_cond__sliding_block_cached__moe_arch_mod__prompt_kernel_o29p:
    buffer_load_dword v12, v13, s[8:11], s19 offen sc1
    s_waitcnt vmcnt(0)
    v_cmp_ne_u32 vcc, s28, v12
    s_add_u32 s27, s27, 1
    s_cmp_ge_u32 s27, 65536
    s_cbranch_scc1 adaLN_cond__sliding_block_cached__moe_arch_mod__prompt_kernel_o29g
    s_cbranch_vccnz adaLN_cond__sliding_block_cached__moe_arch_mod__prompt_kernel_o29p
adaLN_cond__sliding_block_cached__moe_arch_mod__prompt_kernel_o29g:
    s_waitcnt vmcnt(0) lgkmcnt(0)
    s_nop 15
    s_nop 3
    s_branch adaLN_cond__sliding_block_cached__moe_arch_mod__prompt_kernel_o29b
adaLN_cond__sliding_block_cached__moe_arch_mod__prompt_kernel_mf10r:
    s_waitcnt vmcnt(0) lgkmcnt(0)
    s_nop 15
    s_nop 3
    s_mov_b32 s27, 0
adaLN_cond__sliding_block_cached__moe_arch_mod__prompt_kernel_mf10p:
    s_mov_b32 s16, 0x544000
    buffer_load_dwordx4 v[184:187], v2, s[8:11], s16 offen sc1
    s_waitcnt vmcnt(0)
    v_xor_b32 v16, s28, v184
    v_xor_b32 v17, s28, v185
    v_xor_b32 v18, s28, v186
    v_xor_b32 v19, s28, v187
    v_or3_b32 v16, v16, v17, v18
    v_or_b32 v16, v16, v19
    v_cmp_ne_u32 vcc, 0, v16
    s_add_u32 s27, s27, 1
    s_cmp_ge_u32 s27, 65536
    s_cbranch_scc1 adaLN_cond__sliding_block_cached__moe_arch_mod__prompt_kernel_mf10g
    s_cbranch_vccnz adaLN_cond__sliding_block_cached__moe_arch_mod__prompt_kernel_mf10p
adaLN_cond__sliding_block_cached__moe_arch_mod__prompt_kernel_mf10g:
    s_waitcnt vmcnt(0) lgkmcnt(0)
    s_nop 15
    s_nop 3
    s_branch adaLN_cond__sliding_block_cached__moe_arch_mod__prompt_kernel_mf10b
adaLN_cond__sliding_block_cached__moe_arch_mod__prompt_kernel_kv16r:
    s_waitcnt vmcnt(0) lgkmcnt(0)
    s_nop 15
    s_nop 3
    s_mov_b32 s27, 0
adaLN_cond__sliding_block_cached__moe_arch_mod__prompt_kernel_kv16p:
    buffer_load_dwordx4 v[12:15], v21, s[8:11], s18 offen sc1
    s_waitcnt vmcnt(0)
    v_xor_b32 v8, s28, v12
    v_xor_b32 v20, s28, v13
    v_or_b32 v8, v8, v20
    v_xor_b32 v20, s28, v14
    v_or_b32 v8, v8, v20
    v_xor_b32 v20, s28, v15
    v_or_b32 v8, v8, v20
    v_cmp_ne_u32 vcc, 0, v8
    s_add_u32 s27, s27, 1
    s_cmp_ge_u32 s27, 65536
    s_cbranch_scc1 adaLN_cond__sliding_block_cached__moe_arch_mod__prompt_kernel_kv16g
    s_cbranch_vccnz adaLN_cond__sliding_block_cached__moe_arch_mod__prompt_kernel_kv16p
adaLN_cond__sliding_block_cached__moe_arch_mod__prompt_kernel_kv16g:
    s_waitcnt vmcnt(0) lgkmcnt(0)
    s_nop 15
    s_nop 3
    s_branch adaLN_cond__sliding_block_cached__moe_arch_mod__prompt_kernel_kv16b
adaLN_cond__sliding_block_cached__moe_arch_mod__prompt_kernel_fixB:
    s_waitcnt vmcnt(0) lgkmcnt(0)
    s_nop 15
    s_nop 3
    s_lshr_b32 s16, s12, 3
    s_lshl_b32 s16, s16, 17
    s_add_u32 s16, s16, 0x400000
    v_add_u32 v8, s16, v2
    v_mov_b32 v16, 0xff7fffff
    v_mov_b32 v17, 0xff7fffff
    s_mov_b32 s16, 0
adaLN_cond__sliding_block_cached__moe_arch_mod__prompt_kernel_fixBm:
    s_add_u32 s17, s16, 0
    buffer_load_dwordx4 v[200:203], v8, s[8:11], s17 offen offset:0
    buffer_load_dwordx4 v[204:207], v8, s[8:11], s17 offen offset:1024
    buffer_load_dwordx4 v[208:211], v8, s[8:11], s17 offen offset:2048
    buffer_load_dwordx4 v[212:215], v8, s[8:11], s17 offen offset:3072
    s_waitcnt vmcnt(3)
    v_mfma_f32_16x16x32_bf16 v[184:187], v[200:203], v[152:155], 0
    v_mfma_f32_16x16x32_bf16 v[188:191], v[200:203], v[168:171], 0
    s_waitcnt vmcnt(2)
    v_mfma_f32_16x16x32_bf16 v[192:195], v[204:207], v[152:155], 0
    v_mfma_f32_16x16x32_bf16 v[196:199], v[204:207], v[168:171], 0
    s_waitcnt vmcnt(1)
    v_mfma_f32_16x16x32_bf16 v[184:187], v[208:211], v[156:159], v[184:187]
    v_mfma_f32_16x16x32_bf16 v[188:191], v[208:211], v[172:175], v[188:191]
    s_waitcnt vmcnt(0)
    v_mfma_f32_16x16x32_bf16 v[192:195], v[212:215], v[156:159], v[192:195]
    v_mfma_f32_16x16x32_bf16 v[196:199], v[212:215], v[172:175], v[196:199]
    s_add_u32 s17, s16, 4096
    buffer_load_dwordx4 v[200:203], v8, s[8:11], s17 offen offset:0
    buffer_load_dwordx4 v[204:207], v8, s[8:11], s17 offen offset:1024
    buffer_load_dwordx4 v[208:211], v8, s[8:11], s17 offen offset:2048
    buffer_load_dwordx4 v[212:215], v8, s[8:11], s17 offen offset:3072
    s_waitcnt vmcnt(3)
    v_mfma_f32_16x16x32_bf16 v[184:187], v[200:203], v[160:163], v[184:187]
    v_mfma_f32_16x16x32_bf16 v[188:191], v[200:203], v[176:179], v[188:191]
    s_waitcnt vmcnt(2)
    v_mfma_f32_16x16x32_bf16 v[192:195], v[204:207], v[160:163], v[192:195]
    v_mfma_f32_16x16x32_bf16 v[196:199], v[204:207], v[176:179], v[196:199]
    s_waitcnt vmcnt(1)
    v_mfma_f32_16x16x32_bf16 v[184:187], v[208:211], v[164:167], v[184:187]
    v_mfma_f32_16x16x32_bf16 v[188:191], v[208:211], v[180:183], v[188:191]
    s_waitcnt vmcnt(0)
    v_mfma_f32_16x16x32_bf16 v[192:195], v[212:215], v[164:167], v[192:195]
    v_mfma_f32_16x16x32_bf16 v[196:199], v[212:215], v[180:183], v[196:199]
    s_nop 3
    v_max3_f32 v16, v16, v184, v185
    v_max3_f32 v16, v16, v186, v187
    v_max3_f32 v17, v17, v188, v189
    v_max3_f32 v17, v17, v190, v191
    v_max3_f32 v16, v16, v192, v193
    v_max3_f32 v16, v16, v194, v195
    v_max3_f32 v17, v17, v196, v197
    v_max3_f32 v17, v17, v198, v199
    s_add_u32 s16, s16, 8192
    s_cmp_lt_u32 s16, 0x20000
    s_cbranch_scc1 adaLN_cond__sliding_block_cached__moe_arch_mod__prompt_kernel_fixBm
    v_mov_b32 v18, v16
    v_mov_b32 v19, v17
    s_nop 0
    v_permlane16_swap_b32 v16, v18
    v_permlane16_swap_b32 v17, v19
    v_max_f32 v16, v16, v18
    v_max_f32 v17, v17, v19
    v_mov_b32 v18, v16
    v_mov_b32 v19, v17
    s_nop 0
    v_permlane32_swap_b32 v16, v18
    v_permlane32_swap_b32 v17, v19
    v_max_f32 v16, v16, v18
    v_max_f32 v17, v17, v19
    v_sub_f32 v216, 0, v16
    v_sub_f32 v217, 0, v16
    v_sub_f32 v218, 0, v16
    v_sub_f32 v219, 0, v16
    v_sub_f32 v220, 0, v17
    v_sub_f32 v221, 0, v17
    v_sub_f32 v222, 0, v17
    v_sub_f32 v223, 0, v17
    s_mov_b32 s17, 0x0
    buffer_load_dwordx4 v[200:203], v8, s[8:11], s17 offen offset:0
    buffer_load_dwordx4 v[204:207], v8, s[8:11], s17 offen offset:1024
    buffer_load_dwordx4 v[208:211], v8, s[8:11], s17 offen offset:2048
    buffer_load_dwordx4 v[212:215], v8, s[8:11], s17 offen offset:3072
    s_waitcnt vmcnt(3)
    v_mfma_f32_16x16x32_bf16 v[184:187], v[200:203], v[152:155], v[216:219]
    v_mfma_f32_16x16x32_bf16 v[188:191], v[200:203], v[168:171], v[220:223]
    s_waitcnt vmcnt(2)
    v_mfma_f32_16x16x32_bf16 v[192:195], v[204:207], v[152:155], v[216:219]
    v_mfma_f32_16x16x32_bf16 v[196:199], v[204:207], v[168:171], v[220:223]
    s_waitcnt vmcnt(1)
    v_mfma_f32_16x16x32_bf16 v[184:187], v[208:211], v[156:159], v[184:187]
    v_mfma_f32_16x16x32_bf16 v[188:191], v[208:211], v[172:175], v[188:191]
    s_waitcnt vmcnt(0)
    v_mfma_f32_16x16x32_bf16 v[192:195], v[212:215], v[156:159], v[192:195]
    v_mfma_f32_16x16x32_bf16 v[196:199], v[212:215], v[172:175], v[196:199]
    s_mov_b32 s17, 0x1000
    buffer_load_dwordx4 v[200:203], v8, s[8:11], s17 offen offset:0
    buffer_load_dwordx4 v[204:207], v8, s[8:11], s17 offen offset:1024
    buffer_load_dwordx4 v[208:211], v8, s[8:11], s17 offen offset:2048
    buffer_load_dwordx4 v[212:215], v8, s[8:11], s17 offen offset:3072
    s_waitcnt vmcnt(3)
    v_mfma_f32_16x16x32_bf16 v[184:187], v[200:203], v[160:163], v[184:187]
    v_mfma_f32_16x16x32_bf16 v[188:191], v[200:203], v[176:179], v[188:191]
    s_waitcnt vmcnt(2)
    v_mfma_f32_16x16x32_bf16 v[192:195], v[204:207], v[160:163], v[192:195]
    v_mfma_f32_16x16x32_bf16 v[196:199], v[204:207], v[176:179], v[196:199]
    s_waitcnt vmcnt(1)
    v_mfma_f32_16x16x32_bf16 v[184:187], v[208:211], v[164:167], v[184:187]
    v_mfma_f32_16x16x32_bf16 v[188:191], v[208:211], v[180:183], v[188:191]
    s_waitcnt vmcnt(0)
    v_mfma_f32_16x16x32_bf16 v[192:195], v[212:215], v[164:167], v[192:195]
    v_mfma_f32_16x16x32_bf16 v[196:199], v[212:215], v[180:183], v[196:199]
    s_nop 3
    v_exp_f32 v184, v184
    v_exp_f32 v185, v185
    s_nop 0
    v_add_f32 v9, v184, v185
    v_cvt_pk_bf16_f32 v24, v184, v185
    v_exp_f32 v186, v186
    v_exp_f32 v187, v187
    v_add_f32 v9, v9, v186
    v_add_f32 v9, v9, v187
    v_cvt_pk_bf16_f32 v25, v186, v187
    v_exp_f32 v188, v188
    v_exp_f32 v189, v189
    s_nop 0
    v_add_f32 v10, v188, v189
    v_cvt_pk_bf16_f32 v28, v188, v189
    v_exp_f32 v190, v190
    v_exp_f32 v191, v191
    v_add_f32 v10, v10, v190
    v_add_f32 v10, v10, v191
    v_cvt_pk_bf16_f32 v29, v190, v191
    v_exp_f32 v192, v192
    v_exp_f32 v193, v193
    v_add_f32 v9, v9, v192
    v_add_f32 v9, v9, v193
    v_cvt_pk_bf16_f32 v26, v192, v193
    v_exp_f32 v194, v194
    v_exp_f32 v195, v195
    v_add_f32 v9, v9, v194
    v_add_f32 v9, v9, v195
    v_cvt_pk_bf16_f32 v27, v194, v195
    v_exp_f32 v196, v196
    v_exp_f32 v197, v197
    v_add_f32 v10, v10, v196
    v_add_f32 v10, v10, v197
    v_cvt_pk_bf16_f32 v30, v196, v197
    v_exp_f32 v198, v198
    v_exp_f32 v199, v199
    v_add_f32 v10, v10, v198
    v_add_f32 v10, v10, v199
    v_cvt_pk_bf16_f32 v31, v198, v199
    s_mov_b32 s17, 0x2000
    buffer_load_dwordx4 v[200:203], v8, s[8:11], s17 offen offset:0
    buffer_load_dwordx4 v[204:207], v8, s[8:11], s17 offen offset:1024
    buffer_load_dwordx4 v[208:211], v8, s[8:11], s17 offen offset:2048
    buffer_load_dwordx4 v[212:215], v8, s[8:11], s17 offen offset:3072
    s_waitcnt vmcnt(3)
    v_mfma_f32_16x16x32_bf16 v[184:187], v[200:203], v[152:155], v[216:219]
    v_mfma_f32_16x16x32_bf16 v[188:191], v[200:203], v[168:171], v[220:223]
    s_waitcnt vmcnt(2)
    v_mfma_f32_16x16x32_bf16 v[192:195], v[204:207], v[152:155], v[216:219]
    v_mfma_f32_16x16x32_bf16 v[196:199], v[204:207], v[168:171], v[220:223]
    s_waitcnt vmcnt(1)
    v_mfma_f32_16x16x32_bf16 v[184:187], v[208:211], v[156:159], v[184:187]
    v_mfma_f32_16x16x32_bf16 v[188:191], v[208:211], v[172:175], v[188:191]
    s_waitcnt vmcnt(0)
    v_mfma_f32_16x16x32_bf16 v[192:195], v[212:215], v[156:159], v[192:195]
    v_mfma_f32_16x16x32_bf16 v[196:199], v[212:215], v[172:175], v[196:199]
    s_mov_b32 s17, 0x3000
    buffer_load_dwordx4 v[200:203], v8, s[8:11], s17 offen offset:0
    buffer_load_dwordx4 v[204:207], v8, s[8:11], s17 offen offset:1024
    buffer_load_dwordx4 v[208:211], v8, s[8:11], s17 offen offset:2048
    buffer_load_dwordx4 v[212:215], v8, s[8:11], s17 offen offset:3072
    s_waitcnt vmcnt(3)
    v_mfma_f32_16x16x32_bf16 v[184:187], v[200:203], v[160:163], v[184:187]
    v_mfma_f32_16x16x32_bf16 v[188:191], v[200:203], v[176:179], v[188:191]
    s_waitcnt vmcnt(2)
    v_mfma_f32_16x16x32_bf16 v[192:195], v[204:207], v[160:163], v[192:195]
    v_mfma_f32_16x16x32_bf16 v[196:199], v[204:207], v[176:179], v[196:199]
    s_waitcnt vmcnt(1)
    v_mfma_f32_16x16x32_bf16 v[184:187], v[208:211], v[164:167], v[184:187]
    v_mfma_f32_16x16x32_bf16 v[188:191], v[208:211], v[180:183], v[188:191]
    s_waitcnt vmcnt(0)
    v_mfma_f32_16x16x32_bf16 v[192:195], v[212:215], v[164:167], v[192:195]
    v_mfma_f32_16x16x32_bf16 v[196:199], v[212:215], v[180:183], v[196:199]
    s_nop 3
    v_exp_f32 v184, v184
    v_exp_f32 v185, v185
    v_add_f32 v9, v9, v184
    v_add_f32 v9, v9, v185
    v_cvt_pk_bf16_f32 v32, v184, v185
    v_exp_f32 v186, v186
    v_exp_f32 v187, v187
    v_add_f32 v9, v9, v186
    v_add_f32 v9, v9, v187
    v_cvt_pk_bf16_f32 v33, v186, v187
    v_exp_f32 v188, v188
    v_exp_f32 v189, v189
    v_add_f32 v10, v10, v188
    v_add_f32 v10, v10, v189
    v_cvt_pk_bf16_f32 v36, v188, v189
    v_exp_f32 v190, v190
    v_exp_f32 v191, v191
    v_add_f32 v10, v10, v190
    v_add_f32 v10, v10, v191
    v_cvt_pk_bf16_f32 v37, v190, v191
    v_exp_f32 v192, v192
    v_exp_f32 v193, v193
    v_add_f32 v9, v9, v192
    v_add_f32 v9, v9, v193
    v_cvt_pk_bf16_f32 v34, v192, v193
    v_exp_f32 v194, v194
    v_exp_f32 v195, v195
    v_add_f32 v9, v9, v194
    v_add_f32 v9, v9, v195
    v_cvt_pk_bf16_f32 v35, v194, v195
    v_exp_f32 v196, v196
    v_exp_f32 v197, v197
    v_add_f32 v10, v10, v196
    v_add_f32 v10, v10, v197
    v_cvt_pk_bf16_f32 v38, v196, v197
    v_exp_f32 v198, v198
    v_exp_f32 v199, v199
    v_add_f32 v10, v10, v198
    v_add_f32 v10, v10, v199
    v_cvt_pk_bf16_f32 v39, v198, v199
    s_mov_b32 s17, 0x4000
    buffer_load_dwordx4 v[200:203], v8, s[8:11], s17 offen offset:0
    buffer_load_dwordx4 v[204:207], v8, s[8:11], s17 offen offset:1024
    buffer_load_dwordx4 v[208:211], v8, s[8:11], s17 offen offset:2048
    buffer_load_dwordx4 v[212:215], v8, s[8:11], s17 offen offset:3072
    s_waitcnt vmcnt(3)
    v_mfma_f32_16x16x32_bf16 v[184:187], v[200:203], v[152:155], v[216:219]
    v_mfma_f32_16x16x32_bf16 v[188:191], v[200:203], v[168:171], v[220:223]
    s_waitcnt vmcnt(2)
    v_mfma_f32_16x16x32_bf16 v[192:195], v[204:207], v[152:155], v[216:219]
    v_mfma_f32_16x16x32_bf16 v[196:199], v[204:207], v[168:171], v[220:223]
    s_waitcnt vmcnt(1)
    v_mfma_f32_16x16x32_bf16 v[184:187], v[208:211], v[156:159], v[184:187]
    v_mfma_f32_16x16x32_bf16 v[188:191], v[208:211], v[172:175], v[188:191]
    s_waitcnt vmcnt(0)
    v_mfma_f32_16x16x32_bf16 v[192:195], v[212:215], v[156:159], v[192:195]
    v_mfma_f32_16x16x32_bf16 v[196:199], v[212:215], v[172:175], v[196:199]
    s_mov_b32 s17, 0x5000
    buffer_load_dwordx4 v[200:203], v8, s[8:11], s17 offen offset:0
    buffer_load_dwordx4 v[204:207], v8, s[8:11], s17 offen offset:1024
    buffer_load_dwordx4 v[208:211], v8, s[8:11], s17 offen offset:2048
    buffer_load_dwordx4 v[212:215], v8, s[8:11], s17 offen offset:3072
    s_waitcnt vmcnt(3)
    v_mfma_f32_16x16x32_bf16 v[184:187], v[200:203], v[160:163], v[184:187]
    v_mfma_f32_16x16x32_bf16 v[188:191], v[200:203], v[176:179], v[188:191]
    s_waitcnt vmcnt(2)
    v_mfma_f32_16x16x32_bf16 v[192:195], v[204:207], v[160:163], v[192:195]
    v_mfma_f32_16x16x32_bf16 v[196:199], v[204:207], v[176:179], v[196:199]
    s_waitcnt vmcnt(1)
    v_mfma_f32_16x16x32_bf16 v[184:187], v[208:211], v[164:167], v[184:187]
    v_mfma_f32_16x16x32_bf16 v[188:191], v[208:211], v[180:183], v[188:191]
    s_waitcnt vmcnt(0)
    v_mfma_f32_16x16x32_bf16 v[192:195], v[212:215], v[164:167], v[192:195]
    v_mfma_f32_16x16x32_bf16 v[196:199], v[212:215], v[180:183], v[196:199]
    s_nop 3
    v_exp_f32 v184, v184
    v_exp_f32 v185, v185
    v_add_f32 v9, v9, v184
    v_add_f32 v9, v9, v185
    v_cvt_pk_bf16_f32 v40, v184, v185
    v_exp_f32 v186, v186
    v_exp_f32 v187, v187
    v_add_f32 v9, v9, v186
    v_add_f32 v9, v9, v187
    v_cvt_pk_bf16_f32 v41, v186, v187
    v_exp_f32 v188, v188
    v_exp_f32 v189, v189
    v_add_f32 v10, v10, v188
    v_add_f32 v10, v10, v189
    v_cvt_pk_bf16_f32 v44, v188, v189
    v_exp_f32 v190, v190
    v_exp_f32 v191, v191
    v_add_f32 v10, v10, v190
    v_add_f32 v10, v10, v191
    v_cvt_pk_bf16_f32 v45, v190, v191
    v_exp_f32 v192, v192
    v_exp_f32 v193, v193
    v_add_f32 v9, v9, v192
    v_add_f32 v9, v9, v193
    v_cvt_pk_bf16_f32 v42, v192, v193
    v_exp_f32 v194, v194
    v_exp_f32 v195, v195
    v_add_f32 v9, v9, v194
    v_add_f32 v9, v9, v195
    v_cvt_pk_bf16_f32 v43, v194, v195
    v_exp_f32 v196, v196
    v_exp_f32 v197, v197
    v_add_f32 v10, v10, v196
    v_add_f32 v10, v10, v197
    v_cvt_pk_bf16_f32 v46, v196, v197
    v_exp_f32 v198, v198
    v_exp_f32 v199, v199
    v_add_f32 v10, v10, v198
    v_add_f32 v10, v10, v199
    v_cvt_pk_bf16_f32 v47, v198, v199
    s_mov_b32 s17, 0x6000
    buffer_load_dwordx4 v[200:203], v8, s[8:11], s17 offen offset:0
    buffer_load_dwordx4 v[204:207], v8, s[8:11], s17 offen offset:1024
    buffer_load_dwordx4 v[208:211], v8, s[8:11], s17 offen offset:2048
    buffer_load_dwordx4 v[212:215], v8, s[8:11], s17 offen offset:3072
    s_waitcnt vmcnt(3)
    v_mfma_f32_16x16x32_bf16 v[184:187], v[200:203], v[152:155], v[216:219]
    v_mfma_f32_16x16x32_bf16 v[188:191], v[200:203], v[168:171], v[220:223]
    s_waitcnt vmcnt(2)
    v_mfma_f32_16x16x32_bf16 v[192:195], v[204:207], v[152:155], v[216:219]
    v_mfma_f32_16x16x32_bf16 v[196:199], v[204:207], v[168:171], v[220:223]
    s_waitcnt vmcnt(1)
    v_mfma_f32_16x16x32_bf16 v[184:187], v[208:211], v[156:159], v[184:187]
    v_mfma_f32_16x16x32_bf16 v[188:191], v[208:211], v[172:175], v[188:191]
    s_waitcnt vmcnt(0)
    v_mfma_f32_16x16x32_bf16 v[192:195], v[212:215], v[156:159], v[192:195]
    v_mfma_f32_16x16x32_bf16 v[196:199], v[212:215], v[172:175], v[196:199]
    s_mov_b32 s17, 0x7000
    buffer_load_dwordx4 v[200:203], v8, s[8:11], s17 offen offset:0
    buffer_load_dwordx4 v[204:207], v8, s[8:11], s17 offen offset:1024
    buffer_load_dwordx4 v[208:211], v8, s[8:11], s17 offen offset:2048
    buffer_load_dwordx4 v[212:215], v8, s[8:11], s17 offen offset:3072
    s_waitcnt vmcnt(3)
    v_mfma_f32_16x16x32_bf16 v[184:187], v[200:203], v[160:163], v[184:187]
    v_mfma_f32_16x16x32_bf16 v[188:191], v[200:203], v[176:179], v[188:191]
    s_waitcnt vmcnt(2)
    v_mfma_f32_16x16x32_bf16 v[192:195], v[204:207], v[160:163], v[192:195]
    v_mfma_f32_16x16x32_bf16 v[196:199], v[204:207], v[176:179], v[196:199]
    s_waitcnt vmcnt(1)
    v_mfma_f32_16x16x32_bf16 v[184:187], v[208:211], v[164:167], v[184:187]
    v_mfma_f32_16x16x32_bf16 v[188:191], v[208:211], v[180:183], v[188:191]
    s_waitcnt vmcnt(0)
    v_mfma_f32_16x16x32_bf16 v[192:195], v[212:215], v[164:167], v[192:195]
    v_mfma_f32_16x16x32_bf16 v[196:199], v[212:215], v[180:183], v[196:199]
    s_nop 3
    v_exp_f32 v184, v184
    v_exp_f32 v185, v185
    v_add_f32 v9, v9, v184
    v_add_f32 v9, v9, v185
    v_cvt_pk_bf16_f32 v48, v184, v185
    v_exp_f32 v186, v186
    v_exp_f32 v187, v187
    v_add_f32 v9, v9, v186
    v_add_f32 v9, v9, v187
    v_cvt_pk_bf16_f32 v49, v186, v187
    v_exp_f32 v188, v188
    v_exp_f32 v189, v189
    v_add_f32 v10, v10, v188
    v_add_f32 v10, v10, v189
    v_cvt_pk_bf16_f32 v52, v188, v189
    v_exp_f32 v190, v190
    v_exp_f32 v191, v191
    v_add_f32 v10, v10, v190
    v_add_f32 v10, v10, v191
    v_cvt_pk_bf16_f32 v53, v190, v191
    v_exp_f32 v192, v192
    v_exp_f32 v193, v193
    v_add_f32 v9, v9, v192
    v_add_f32 v9, v9, v193
    v_cvt_pk_bf16_f32 v50, v192, v193
    v_exp_f32 v194, v194
    v_exp_f32 v195, v195
    v_add_f32 v9, v9, v194
    v_add_f32 v9, v9, v195
    v_cvt_pk_bf16_f32 v51, v194, v195
    v_exp_f32 v196, v196
    v_exp_f32 v197, v197
    v_add_f32 v10, v10, v196
    v_add_f32 v10, v10, v197
    v_cvt_pk_bf16_f32 v54, v196, v197
    v_exp_f32 v198, v198
    v_exp_f32 v199, v199
    v_add_f32 v10, v10, v198
    v_add_f32 v10, v10, v199
    v_cvt_pk_bf16_f32 v55, v198, v199
    s_mov_b32 s17, 0x8000
    buffer_load_dwordx4 v[200:203], v8, s[8:11], s17 offen offset:0
    buffer_load_dwordx4 v[204:207], v8, s[8:11], s17 offen offset:1024
    buffer_load_dwordx4 v[208:211], v8, s[8:11], s17 offen offset:2048
    buffer_load_dwordx4 v[212:215], v8, s[8:11], s17 offen offset:3072
    s_waitcnt vmcnt(3)
    v_mfma_f32_16x16x32_bf16 v[184:187], v[200:203], v[152:155], v[216:219]
    v_mfma_f32_16x16x32_bf16 v[188:191], v[200:203], v[168:171], v[220:223]
    s_waitcnt vmcnt(2)
    v_mfma_f32_16x16x32_bf16 v[192:195], v[204:207], v[152:155], v[216:219]
    v_mfma_f32_16x16x32_bf16 v[196:199], v[204:207], v[168:171], v[220:223]
    s_waitcnt vmcnt(1)
    v_mfma_f32_16x16x32_bf16 v[184:187], v[208:211], v[156:159], v[184:187]
    v_mfma_f32_16x16x32_bf16 v[188:191], v[208:211], v[172:175], v[188:191]
    s_waitcnt vmcnt(0)
    v_mfma_f32_16x16x32_bf16 v[192:195], v[212:215], v[156:159], v[192:195]
    v_mfma_f32_16x16x32_bf16 v[196:199], v[212:215], v[172:175], v[196:199]
    s_mov_b32 s17, 0x9000
    buffer_load_dwordx4 v[200:203], v8, s[8:11], s17 offen offset:0
    buffer_load_dwordx4 v[204:207], v8, s[8:11], s17 offen offset:1024
    buffer_load_dwordx4 v[208:211], v8, s[8:11], s17 offen offset:2048
    buffer_load_dwordx4 v[212:215], v8, s[8:11], s17 offen offset:3072
    s_waitcnt vmcnt(3)
    v_mfma_f32_16x16x32_bf16 v[184:187], v[200:203], v[160:163], v[184:187]
    v_mfma_f32_16x16x32_bf16 v[188:191], v[200:203], v[176:179], v[188:191]
    s_waitcnt vmcnt(2)
    v_mfma_f32_16x16x32_bf16 v[192:195], v[204:207], v[160:163], v[192:195]
    v_mfma_f32_16x16x32_bf16 v[196:199], v[204:207], v[176:179], v[196:199]
    s_waitcnt vmcnt(1)
    v_mfma_f32_16x16x32_bf16 v[184:187], v[208:211], v[164:167], v[184:187]
    v_mfma_f32_16x16x32_bf16 v[188:191], v[208:211], v[180:183], v[188:191]
    s_waitcnt vmcnt(0)
    v_mfma_f32_16x16x32_bf16 v[192:195], v[212:215], v[164:167], v[192:195]
    v_mfma_f32_16x16x32_bf16 v[196:199], v[212:215], v[180:183], v[196:199]
    s_nop 3
    v_exp_f32 v184, v184
    v_exp_f32 v185, v185
    v_add_f32 v9, v9, v184
    v_add_f32 v9, v9, v185
    v_cvt_pk_bf16_f32 v56, v184, v185
    v_exp_f32 v186, v186
    v_exp_f32 v187, v187
    v_add_f32 v9, v9, v186
    v_add_f32 v9, v9, v187
    v_cvt_pk_bf16_f32 v57, v186, v187
    v_exp_f32 v188, v188
    v_exp_f32 v189, v189
    v_add_f32 v10, v10, v188
    v_add_f32 v10, v10, v189
    v_cvt_pk_bf16_f32 v60, v188, v189
    v_exp_f32 v190, v190
    v_exp_f32 v191, v191
    v_add_f32 v10, v10, v190
    v_add_f32 v10, v10, v191
    v_cvt_pk_bf16_f32 v61, v190, v191
    v_exp_f32 v192, v192
    v_exp_f32 v193, v193
    v_add_f32 v9, v9, v192
    v_add_f32 v9, v9, v193
    v_cvt_pk_bf16_f32 v58, v192, v193
    v_exp_f32 v194, v194
    v_exp_f32 v195, v195
    v_add_f32 v9, v9, v194
    v_add_f32 v9, v9, v195
    v_cvt_pk_bf16_f32 v59, v194, v195
    v_exp_f32 v196, v196
    v_exp_f32 v197, v197
    v_add_f32 v10, v10, v196
    v_add_f32 v10, v10, v197
    v_cvt_pk_bf16_f32 v62, v196, v197
    v_exp_f32 v198, v198
    v_exp_f32 v199, v199
    v_add_f32 v10, v10, v198
    v_add_f32 v10, v10, v199
    v_cvt_pk_bf16_f32 v63, v198, v199
    s_mov_b32 s17, 0xa000
    buffer_load_dwordx4 v[200:203], v8, s[8:11], s17 offen offset:0
    buffer_load_dwordx4 v[204:207], v8, s[8:11], s17 offen offset:1024
    buffer_load_dwordx4 v[208:211], v8, s[8:11], s17 offen offset:2048
    buffer_load_dwordx4 v[212:215], v8, s[8:11], s17 offen offset:3072
    s_waitcnt vmcnt(3)
    v_mfma_f32_16x16x32_bf16 v[184:187], v[200:203], v[152:155], v[216:219]
    v_mfma_f32_16x16x32_bf16 v[188:191], v[200:203], v[168:171], v[220:223]
    s_waitcnt vmcnt(2)
    v_mfma_f32_16x16x32_bf16 v[192:195], v[204:207], v[152:155], v[216:219]
    v_mfma_f32_16x16x32_bf16 v[196:199], v[204:207], v[168:171], v[220:223]
    s_waitcnt vmcnt(1)
    v_mfma_f32_16x16x32_bf16 v[184:187], v[208:211], v[156:159], v[184:187]
    v_mfma_f32_16x16x32_bf16 v[188:191], v[208:211], v[172:175], v[188:191]
    s_waitcnt vmcnt(0)
    v_mfma_f32_16x16x32_bf16 v[192:195], v[212:215], v[156:159], v[192:195]
    v_mfma_f32_16x16x32_bf16 v[196:199], v[212:215], v[172:175], v[196:199]
    s_mov_b32 s17, 0xb000
    buffer_load_dwordx4 v[200:203], v8, s[8:11], s17 offen offset:0
    buffer_load_dwordx4 v[204:207], v8, s[8:11], s17 offen offset:1024
    buffer_load_dwordx4 v[208:211], v8, s[8:11], s17 offen offset:2048
    buffer_load_dwordx4 v[212:215], v8, s[8:11], s17 offen offset:3072
    s_waitcnt vmcnt(3)
    v_mfma_f32_16x16x32_bf16 v[184:187], v[200:203], v[160:163], v[184:187]
    v_mfma_f32_16x16x32_bf16 v[188:191], v[200:203], v[176:179], v[188:191]
    s_waitcnt vmcnt(2)
    v_mfma_f32_16x16x32_bf16 v[192:195], v[204:207], v[160:163], v[192:195]
    v_mfma_f32_16x16x32_bf16 v[196:199], v[204:207], v[176:179], v[196:199]
    s_waitcnt vmcnt(1)
    v_mfma_f32_16x16x32_bf16 v[184:187], v[208:211], v[164:167], v[184:187]
    v_mfma_f32_16x16x32_bf16 v[188:191], v[208:211], v[180:183], v[188:191]
    s_waitcnt vmcnt(0)
    v_mfma_f32_16x16x32_bf16 v[192:195], v[212:215], v[164:167], v[192:195]
    v_mfma_f32_16x16x32_bf16 v[196:199], v[212:215], v[180:183], v[196:199]
    s_nop 3
    v_exp_f32 v184, v184
    v_exp_f32 v185, v185
    v_add_f32 v9, v9, v184
    v_add_f32 v9, v9, v185
    v_cvt_pk_bf16_f32 v64, v184, v185
    v_exp_f32 v186, v186
    v_exp_f32 v187, v187
    v_add_f32 v9, v9, v186
    v_add_f32 v9, v9, v187
    v_cvt_pk_bf16_f32 v65, v186, v187
    v_exp_f32 v188, v188
    v_exp_f32 v189, v189
    v_add_f32 v10, v10, v188
    v_add_f32 v10, v10, v189
    v_cvt_pk_bf16_f32 v68, v188, v189
    v_exp_f32 v190, v190
    v_exp_f32 v191, v191
    v_add_f32 v10, v10, v190
    v_add_f32 v10, v10, v191
    v_cvt_pk_bf16_f32 v69, v190, v191
    v_exp_f32 v192, v192
    v_exp_f32 v193, v193
    v_add_f32 v9, v9, v192
    v_add_f32 v9, v9, v193
    v_cvt_pk_bf16_f32 v66, v192, v193
    v_exp_f32 v194, v194
    v_exp_f32 v195, v195
    v_add_f32 v9, v9, v194
    v_add_f32 v9, v9, v195
    v_cvt_pk_bf16_f32 v67, v194, v195
    v_exp_f32 v196, v196
    v_exp_f32 v197, v197
    v_add_f32 v10, v10, v196
    v_add_f32 v10, v10, v197
    v_cvt_pk_bf16_f32 v70, v196, v197
    v_exp_f32 v198, v198
    v_exp_f32 v199, v199
    v_add_f32 v10, v10, v198
    v_add_f32 v10, v10, v199
    v_cvt_pk_bf16_f32 v71, v198, v199
    s_mov_b32 s17, 0xc000
    buffer_load_dwordx4 v[200:203], v8, s[8:11], s17 offen offset:0
    buffer_load_dwordx4 v[204:207], v8, s[8:11], s17 offen offset:1024
    buffer_load_dwordx4 v[208:211], v8, s[8:11], s17 offen offset:2048
    buffer_load_dwordx4 v[212:215], v8, s[8:11], s17 offen offset:3072
    s_waitcnt vmcnt(3)
    v_mfma_f32_16x16x32_bf16 v[184:187], v[200:203], v[152:155], v[216:219]
    v_mfma_f32_16x16x32_bf16 v[188:191], v[200:203], v[168:171], v[220:223]
    s_waitcnt vmcnt(2)
    v_mfma_f32_16x16x32_bf16 v[192:195], v[204:207], v[152:155], v[216:219]
    v_mfma_f32_16x16x32_bf16 v[196:199], v[204:207], v[168:171], v[220:223]
    s_waitcnt vmcnt(1)
    v_mfma_f32_16x16x32_bf16 v[184:187], v[208:211], v[156:159], v[184:187]
    v_mfma_f32_16x16x32_bf16 v[188:191], v[208:211], v[172:175], v[188:191]
    s_waitcnt vmcnt(0)
    v_mfma_f32_16x16x32_bf16 v[192:195], v[212:215], v[156:159], v[192:195]
    v_mfma_f32_16x16x32_bf16 v[196:199], v[212:215], v[172:175], v[196:199]
    s_mov_b32 s17, 0xd000
    buffer_load_dwordx4 v[200:203], v8, s[8:11], s17 offen offset:0
    buffer_load_dwordx4 v[204:207], v8, s[8:11], s17 offen offset:1024
    buffer_load_dwordx4 v[208:211], v8, s[8:11], s17 offen offset:2048
    buffer_load_dwordx4 v[212:215], v8, s[8:11], s17 offen offset:3072
    s_waitcnt vmcnt(3)
    v_mfma_f32_16x16x32_bf16 v[184:187], v[200:203], v[160:163], v[184:187]
    v_mfma_f32_16x16x32_bf16 v[188:191], v[200:203], v[176:179], v[188:191]
    s_waitcnt vmcnt(2)
    v_mfma_f32_16x16x32_bf16 v[192:195], v[204:207], v[160:163], v[192:195]
    v_mfma_f32_16x16x32_bf16 v[196:199], v[204:207], v[176:179], v[196:199]
    s_waitcnt vmcnt(1)
    v_mfma_f32_16x16x32_bf16 v[184:187], v[208:211], v[164:167], v[184:187]
    v_mfma_f32_16x16x32_bf16 v[188:191], v[208:211], v[180:183], v[188:191]
    s_waitcnt vmcnt(0)
    v_mfma_f32_16x16x32_bf16 v[192:195], v[212:215], v[164:167], v[192:195]
    v_mfma_f32_16x16x32_bf16 v[196:199], v[212:215], v[180:183], v[196:199]
    s_nop 3
    v_exp_f32 v184, v184
    v_exp_f32 v185, v185
    v_add_f32 v9, v9, v184
    v_add_f32 v9, v9, v185
    v_cvt_pk_bf16_f32 v72, v184, v185
    v_exp_f32 v186, v186
    v_exp_f32 v187, v187
    v_add_f32 v9, v9, v186
    v_add_f32 v9, v9, v187
    v_cvt_pk_bf16_f32 v73, v186, v187
    v_exp_f32 v188, v188
    v_exp_f32 v189, v189
    v_add_f32 v10, v10, v188
    v_add_f32 v10, v10, v189
    v_cvt_pk_bf16_f32 v76, v188, v189
    v_exp_f32 v190, v190
    v_exp_f32 v191, v191
    v_add_f32 v10, v10, v190
    v_add_f32 v10, v10, v191
    v_cvt_pk_bf16_f32 v77, v190, v191
    v_exp_f32 v192, v192
    v_exp_f32 v193, v193
    v_add_f32 v9, v9, v192
    v_add_f32 v9, v9, v193
    v_cvt_pk_bf16_f32 v74, v192, v193
    v_exp_f32 v194, v194
    v_exp_f32 v195, v195
    v_add_f32 v9, v9, v194
    v_add_f32 v9, v9, v195
    v_cvt_pk_bf16_f32 v75, v194, v195
    v_exp_f32 v196, v196
    v_exp_f32 v197, v197
    v_add_f32 v10, v10, v196
    v_add_f32 v10, v10, v197
    v_cvt_pk_bf16_f32 v78, v196, v197
    v_exp_f32 v198, v198
    v_exp_f32 v199, v199
    v_add_f32 v10, v10, v198
    v_add_f32 v10, v10, v199
    v_cvt_pk_bf16_f32 v79, v198, v199
    s_mov_b32 s17, 0xe000
    buffer_load_dwordx4 v[200:203], v8, s[8:11], s17 offen offset:0
    buffer_load_dwordx4 v[204:207], v8, s[8:11], s17 offen offset:1024
    buffer_load_dwordx4 v[208:211], v8, s[8:11], s17 offen offset:2048
    buffer_load_dwordx4 v[212:215], v8, s[8:11], s17 offen offset:3072
    s_waitcnt vmcnt(3)
    v_mfma_f32_16x16x32_bf16 v[184:187], v[200:203], v[152:155], v[216:219]
    v_mfma_f32_16x16x32_bf16 v[188:191], v[200:203], v[168:171], v[220:223]
    s_waitcnt vmcnt(2)
    v_mfma_f32_16x16x32_bf16 v[192:195], v[204:207], v[152:155], v[216:219]
    v_mfma_f32_16x16x32_bf16 v[196:199], v[204:207], v[168:171], v[220:223]
    s_waitcnt vmcnt(1)
    v_mfma_f32_16x16x32_bf16 v[184:187], v[208:211], v[156:159], v[184:187]
    v_mfma_f32_16x16x32_bf16 v[188:191], v[208:211], v[172:175], v[188:191]
    s_waitcnt vmcnt(0)
    v_mfma_f32_16x16x32_bf16 v[192:195], v[212:215], v[156:159], v[192:195]
    v_mfma_f32_16x16x32_bf16 v[196:199], v[212:215], v[172:175], v[196:199]
    s_mov_b32 s17, 0xf000
    buffer_load_dwordx4 v[200:203], v8, s[8:11], s17 offen offset:0
    buffer_load_dwordx4 v[204:207], v8, s[8:11], s17 offen offset:1024
    buffer_load_dwordx4 v[208:211], v8, s[8:11], s17 offen offset:2048
    buffer_load_dwordx4 v[212:215], v8, s[8:11], s17 offen offset:3072
    s_waitcnt vmcnt(3)
    v_mfma_f32_16x16x32_bf16 v[184:187], v[200:203], v[160:163], v[184:187]
    v_mfma_f32_16x16x32_bf16 v[188:191], v[200:203], v[176:179], v[188:191]
    s_waitcnt vmcnt(2)
    v_mfma_f32_16x16x32_bf16 v[192:195], v[204:207], v[160:163], v[192:195]
    v_mfma_f32_16x16x32_bf16 v[196:199], v[204:207], v[176:179], v[196:199]
    s_waitcnt vmcnt(1)
    v_mfma_f32_16x16x32_bf16 v[184:187], v[208:211], v[164:167], v[184:187]
    v_mfma_f32_16x16x32_bf16 v[188:191], v[208:211], v[180:183], v[188:191]
    s_waitcnt vmcnt(0)
    v_mfma_f32_16x16x32_bf16 v[192:195], v[212:215], v[164:167], v[192:195]
    v_mfma_f32_16x16x32_bf16 v[196:199], v[212:215], v[180:183], v[196:199]
    s_nop 3
    v_exp_f32 v184, v184
    v_exp_f32 v185, v185
    v_add_f32 v9, v9, v184
    v_add_f32 v9, v9, v185
    v_cvt_pk_bf16_f32 v80, v184, v185
    v_exp_f32 v186, v186
    v_exp_f32 v187, v187
    v_add_f32 v9, v9, v186
    v_add_f32 v9, v9, v187
    v_cvt_pk_bf16_f32 v81, v186, v187
    v_exp_f32 v188, v188
    v_exp_f32 v189, v189
    v_add_f32 v10, v10, v188
    v_add_f32 v10, v10, v189
    v_cvt_pk_bf16_f32 v84, v188, v189
    v_exp_f32 v190, v190
    v_exp_f32 v191, v191
    v_add_f32 v10, v10, v190
    v_add_f32 v10, v10, v191
    v_cvt_pk_bf16_f32 v85, v190, v191
    v_exp_f32 v192, v192
    v_exp_f32 v193, v193
    v_add_f32 v9, v9, v192
    v_add_f32 v9, v9, v193
    v_cvt_pk_bf16_f32 v82, v192, v193
    v_exp_f32 v194, v194
    v_exp_f32 v195, v195
    v_add_f32 v9, v9, v194
    v_add_f32 v9, v9, v195
    v_cvt_pk_bf16_f32 v83, v194, v195
    v_exp_f32 v196, v196
    v_exp_f32 v197, v197
    v_add_f32 v10, v10, v196
    v_add_f32 v10, v10, v197
    v_cvt_pk_bf16_f32 v86, v196, v197
    v_exp_f32 v198, v198
    v_exp_f32 v199, v199
    v_add_f32 v10, v10, v198
    v_add_f32 v10, v10, v199
    v_cvt_pk_bf16_f32 v87, v198, v199
    s_mov_b32 s17, 0x10000
    buffer_load_dwordx4 v[200:203], v8, s[8:11], s17 offen offset:0
    buffer_load_dwordx4 v[204:207], v8, s[8:11], s17 offen offset:1024
    buffer_load_dwordx4 v[208:211], v8, s[8:11], s17 offen offset:2048
    buffer_load_dwordx4 v[212:215], v8, s[8:11], s17 offen offset:3072
    s_waitcnt vmcnt(3)
    v_mfma_f32_16x16x32_bf16 v[184:187], v[200:203], v[152:155], v[216:219]
    v_mfma_f32_16x16x32_bf16 v[188:191], v[200:203], v[168:171], v[220:223]
    s_waitcnt vmcnt(2)
    v_mfma_f32_16x16x32_bf16 v[192:195], v[204:207], v[152:155], v[216:219]
    v_mfma_f32_16x16x32_bf16 v[196:199], v[204:207], v[168:171], v[220:223]
    s_waitcnt vmcnt(1)
    v_mfma_f32_16x16x32_bf16 v[184:187], v[208:211], v[156:159], v[184:187]
    v_mfma_f32_16x16x32_bf16 v[188:191], v[208:211], v[172:175], v[188:191]
    s_waitcnt vmcnt(0)
    v_mfma_f32_16x16x32_bf16 v[192:195], v[212:215], v[156:159], v[192:195]
    v_mfma_f32_16x16x32_bf16 v[196:199], v[212:215], v[172:175], v[196:199]
    s_mov_b32 s17, 0x11000
    buffer_load_dwordx4 v[200:203], v8, s[8:11], s17 offen offset:0
    buffer_load_dwordx4 v[204:207], v8, s[8:11], s17 offen offset:1024
    buffer_load_dwordx4 v[208:211], v8, s[8:11], s17 offen offset:2048
    buffer_load_dwordx4 v[212:215], v8, s[8:11], s17 offen offset:3072
    s_waitcnt vmcnt(3)
    v_mfma_f32_16x16x32_bf16 v[184:187], v[200:203], v[160:163], v[184:187]
    v_mfma_f32_16x16x32_bf16 v[188:191], v[200:203], v[176:179], v[188:191]
    s_waitcnt vmcnt(2)
    v_mfma_f32_16x16x32_bf16 v[192:195], v[204:207], v[160:163], v[192:195]
    v_mfma_f32_16x16x32_bf16 v[196:199], v[204:207], v[176:179], v[196:199]
    s_waitcnt vmcnt(1)
    v_mfma_f32_16x16x32_bf16 v[184:187], v[208:211], v[164:167], v[184:187]
    v_mfma_f32_16x16x32_bf16 v[188:191], v[208:211], v[180:183], v[188:191]
    s_waitcnt vmcnt(0)
    v_mfma_f32_16x16x32_bf16 v[192:195], v[212:215], v[164:167], v[192:195]
    v_mfma_f32_16x16x32_bf16 v[196:199], v[212:215], v[180:183], v[196:199]
    s_nop 3
    v_exp_f32 v184, v184
    v_exp_f32 v185, v185
    v_add_f32 v9, v9, v184
    v_add_f32 v9, v9, v185
    v_cvt_pk_bf16_f32 v88, v184, v185
    v_exp_f32 v186, v186
    v_exp_f32 v187, v187
    v_add_f32 v9, v9, v186
    v_add_f32 v9, v9, v187
    v_cvt_pk_bf16_f32 v89, v186, v187
    v_exp_f32 v188, v188
    v_exp_f32 v189, v189
    v_add_f32 v10, v10, v188
    v_add_f32 v10, v10, v189
    v_cvt_pk_bf16_f32 v92, v188, v189
    v_exp_f32 v190, v190
    v_exp_f32 v191, v191
    v_add_f32 v10, v10, v190
    v_add_f32 v10, v10, v191
    v_cvt_pk_bf16_f32 v93, v190, v191
    v_exp_f32 v192, v192
    v_exp_f32 v193, v193
    v_add_f32 v9, v9, v192
    v_add_f32 v9, v9, v193
    v_cvt_pk_bf16_f32 v90, v192, v193
    v_exp_f32 v194, v194
    v_exp_f32 v195, v195
    v_add_f32 v9, v9, v194
    v_add_f32 v9, v9, v195
    v_cvt_pk_bf16_f32 v91, v194, v195
    v_exp_f32 v196, v196
    v_exp_f32 v197, v197
    v_add_f32 v10, v10, v196
    v_add_f32 v10, v10, v197
    v_cvt_pk_bf16_f32 v94, v196, v197
    v_exp_f32 v198, v198
    v_exp_f32 v199, v199
    v_add_f32 v10, v10, v198
    v_add_f32 v10, v10, v199
    v_cvt_pk_bf16_f32 v95, v198, v199
    s_mov_b32 s17, 0x12000
    buffer_load_dwordx4 v[200:203], v8, s[8:11], s17 offen offset:0
    buffer_load_dwordx4 v[204:207], v8, s[8:11], s17 offen offset:1024
    buffer_load_dwordx4 v[208:211], v8, s[8:11], s17 offen offset:2048
    buffer_load_dwordx4 v[212:215], v8, s[8:11], s17 offen offset:3072
    s_waitcnt vmcnt(3)
    v_mfma_f32_16x16x32_bf16 v[184:187], v[200:203], v[152:155], v[216:219]
    v_mfma_f32_16x16x32_bf16 v[188:191], v[200:203], v[168:171], v[220:223]
    s_waitcnt vmcnt(2)
    v_mfma_f32_16x16x32_bf16 v[192:195], v[204:207], v[152:155], v[216:219]
    v_mfma_f32_16x16x32_bf16 v[196:199], v[204:207], v[168:171], v[220:223]
    s_waitcnt vmcnt(1)
    v_mfma_f32_16x16x32_bf16 v[184:187], v[208:211], v[156:159], v[184:187]
    v_mfma_f32_16x16x32_bf16 v[188:191], v[208:211], v[172:175], v[188:191]
    s_waitcnt vmcnt(0)
    v_mfma_f32_16x16x32_bf16 v[192:195], v[212:215], v[156:159], v[192:195]
    v_mfma_f32_16x16x32_bf16 v[196:199], v[212:215], v[172:175], v[196:199]
    s_mov_b32 s17, 0x13000
    buffer_load_dwordx4 v[200:203], v8, s[8:11], s17 offen offset:0
    buffer_load_dwordx4 v[204:207], v8, s[8:11], s17 offen offset:1024
    buffer_load_dwordx4 v[208:211], v8, s[8:11], s17 offen offset:2048
    buffer_load_dwordx4 v[212:215], v8, s[8:11], s17 offen offset:3072
    s_waitcnt vmcnt(3)
    v_mfma_f32_16x16x32_bf16 v[184:187], v[200:203], v[160:163], v[184:187]
    v_mfma_f32_16x16x32_bf16 v[188:191], v[200:203], v[176:179], v[188:191]
    s_waitcnt vmcnt(2)
    v_mfma_f32_16x16x32_bf16 v[192:195], v[204:207], v[160:163], v[192:195]
    v_mfma_f32_16x16x32_bf16 v[196:199], v[204:207], v[176:179], v[196:199]
    s_waitcnt vmcnt(1)
    v_mfma_f32_16x16x32_bf16 v[184:187], v[208:211], v[164:167], v[184:187]
    v_mfma_f32_16x16x32_bf16 v[188:191], v[208:211], v[180:183], v[188:191]
    s_waitcnt vmcnt(0)
    v_mfma_f32_16x16x32_bf16 v[192:195], v[212:215], v[164:167], v[192:195]
    v_mfma_f32_16x16x32_bf16 v[196:199], v[212:215], v[180:183], v[196:199]
    s_nop 3
    v_exp_f32 v184, v184
    v_exp_f32 v185, v185
    v_add_f32 v9, v9, v184
    v_add_f32 v9, v9, v185
    v_cvt_pk_bf16_f32 v96, v184, v185
    v_exp_f32 v186, v186
    v_exp_f32 v187, v187
    v_add_f32 v9, v9, v186
    v_add_f32 v9, v9, v187
    v_cvt_pk_bf16_f32 v97, v186, v187
    v_exp_f32 v188, v188
    v_exp_f32 v189, v189
    v_add_f32 v10, v10, v188
    v_add_f32 v10, v10, v189
    v_cvt_pk_bf16_f32 v100, v188, v189
    v_exp_f32 v190, v190
    v_exp_f32 v191, v191
    v_add_f32 v10, v10, v190
    v_add_f32 v10, v10, v191
    v_cvt_pk_bf16_f32 v101, v190, v191
    v_exp_f32 v192, v192
    v_exp_f32 v193, v193
    v_add_f32 v9, v9, v192
    v_add_f32 v9, v9, v193
    v_cvt_pk_bf16_f32 v98, v192, v193
    v_exp_f32 v194, v194
    v_exp_f32 v195, v195
    v_add_f32 v9, v9, v194
    v_add_f32 v9, v9, v195
    v_cvt_pk_bf16_f32 v99, v194, v195
    v_exp_f32 v196, v196
    v_exp_f32 v197, v197
    v_add_f32 v10, v10, v196
    v_add_f32 v10, v10, v197
    v_cvt_pk_bf16_f32 v102, v196, v197
    v_exp_f32 v198, v198
    v_exp_f32 v199, v199
    v_add_f32 v10, v10, v198
    v_add_f32 v10, v10, v199
    v_cvt_pk_bf16_f32 v103, v198, v199
    s_mov_b32 s17, 0x14000
    buffer_load_dwordx4 v[200:203], v8, s[8:11], s17 offen offset:0
    buffer_load_dwordx4 v[204:207], v8, s[8:11], s17 offen offset:1024
    buffer_load_dwordx4 v[208:211], v8, s[8:11], s17 offen offset:2048
    buffer_load_dwordx4 v[212:215], v8, s[8:11], s17 offen offset:3072
    s_waitcnt vmcnt(3)
    v_mfma_f32_16x16x32_bf16 v[184:187], v[200:203], v[152:155], v[216:219]
    v_mfma_f32_16x16x32_bf16 v[188:191], v[200:203], v[168:171], v[220:223]
    s_waitcnt vmcnt(2)
    v_mfma_f32_16x16x32_bf16 v[192:195], v[204:207], v[152:155], v[216:219]
    v_mfma_f32_16x16x32_bf16 v[196:199], v[204:207], v[168:171], v[220:223]
    s_waitcnt vmcnt(1)
    v_mfma_f32_16x16x32_bf16 v[184:187], v[208:211], v[156:159], v[184:187]
    v_mfma_f32_16x16x32_bf16 v[188:191], v[208:211], v[172:175], v[188:191]
    s_waitcnt vmcnt(0)
    v_mfma_f32_16x16x32_bf16 v[192:195], v[212:215], v[156:159], v[192:195]
    v_mfma_f32_16x16x32_bf16 v[196:199], v[212:215], v[172:175], v[196:199]
    s_mov_b32 s17, 0x15000
    buffer_load_dwordx4 v[200:203], v8, s[8:11], s17 offen offset:0
    buffer_load_dwordx4 v[204:207], v8, s[8:11], s17 offen offset:1024
    buffer_load_dwordx4 v[208:211], v8, s[8:11], s17 offen offset:2048
    buffer_load_dwordx4 v[212:215], v8, s[8:11], s17 offen offset:3072
    s_waitcnt vmcnt(3)
    v_mfma_f32_16x16x32_bf16 v[184:187], v[200:203], v[160:163], v[184:187]
    v_mfma_f32_16x16x32_bf16 v[188:191], v[200:203], v[176:179], v[188:191]
    s_waitcnt vmcnt(2)
    v_mfma_f32_16x16x32_bf16 v[192:195], v[204:207], v[160:163], v[192:195]
    v_mfma_f32_16x16x32_bf16 v[196:199], v[204:207], v[176:179], v[196:199]
    s_waitcnt vmcnt(1)
    v_mfma_f32_16x16x32_bf16 v[184:187], v[208:211], v[164:167], v[184:187]
    v_mfma_f32_16x16x32_bf16 v[188:191], v[208:211], v[180:183], v[188:191]
    s_waitcnt vmcnt(0)
    v_mfma_f32_16x16x32_bf16 v[192:195], v[212:215], v[164:167], v[192:195]
    v_mfma_f32_16x16x32_bf16 v[196:199], v[212:215], v[180:183], v[196:199]
    s_nop 3
    v_exp_f32 v184, v184
    v_exp_f32 v185, v185
    v_add_f32 v9, v9, v184
    v_add_f32 v9, v9, v185
    v_cvt_pk_bf16_f32 v104, v184, v185
    v_exp_f32 v186, v186
    v_exp_f32 v187, v187
    v_add_f32 v9, v9, v186
    v_add_f32 v9, v9, v187
    v_cvt_pk_bf16_f32 v105, v186, v187
    v_exp_f32 v188, v188
    v_exp_f32 v189, v189
    v_add_f32 v10, v10, v188
    v_add_f32 v10, v10, v189
    v_cvt_pk_bf16_f32 v108, v188, v189
    v_exp_f32 v190, v190
    v_exp_f32 v191, v191
    v_add_f32 v10, v10, v190
    v_add_f32 v10, v10, v191
    v_cvt_pk_bf16_f32 v109, v190, v191
    v_exp_f32 v192, v192
    v_exp_f32 v193, v193
    v_add_f32 v9, v9, v192
    v_add_f32 v9, v9, v193
    v_cvt_pk_bf16_f32 v106, v192, v193
    v_exp_f32 v194, v194
    v_exp_f32 v195, v195
    v_add_f32 v9, v9, v194
    v_add_f32 v9, v9, v195
    v_cvt_pk_bf16_f32 v107, v194, v195
    v_exp_f32 v196, v196
    v_exp_f32 v197, v197
    v_add_f32 v10, v10, v196
    v_add_f32 v10, v10, v197
    v_cvt_pk_bf16_f32 v110, v196, v197
    v_exp_f32 v198, v198
    v_exp_f32 v199, v199
    v_add_f32 v10, v10, v198
    v_add_f32 v10, v10, v199
    v_cvt_pk_bf16_f32 v111, v198, v199
    s_mov_b32 s17, 0x16000
    buffer_load_dwordx4 v[200:203], v8, s[8:11], s17 offen offset:0
    buffer_load_dwordx4 v[204:207], v8, s[8:11], s17 offen offset:1024
    buffer_load_dwordx4 v[208:211], v8, s[8:11], s17 offen offset:2048
    buffer_load_dwordx4 v[212:215], v8, s[8:11], s17 offen offset:3072
    s_waitcnt vmcnt(3)
    v_mfma_f32_16x16x32_bf16 v[184:187], v[200:203], v[152:155], v[216:219]
    v_mfma_f32_16x16x32_bf16 v[188:191], v[200:203], v[168:171], v[220:223]
    s_waitcnt vmcnt(2)
    v_mfma_f32_16x16x32_bf16 v[192:195], v[204:207], v[152:155], v[216:219]
    v_mfma_f32_16x16x32_bf16 v[196:199], v[204:207], v[168:171], v[220:223]
    s_waitcnt vmcnt(1)
    v_mfma_f32_16x16x32_bf16 v[184:187], v[208:211], v[156:159], v[184:187]
    v_mfma_f32_16x16x32_bf16 v[188:191], v[208:211], v[172:175], v[188:191]
    s_waitcnt vmcnt(0)
    v_mfma_f32_16x16x32_bf16 v[192:195], v[212:215], v[156:159], v[192:195]
    v_mfma_f32_16x16x32_bf16 v[196:199], v[212:215], v[172:175], v[196:199]
    s_mov_b32 s17, 0x17000
    buffer_load_dwordx4 v[200:203], v8, s[8:11], s17 offen offset:0
    buffer_load_dwordx4 v[204:207], v8, s[8:11], s17 offen offset:1024
    buffer_load_dwordx4 v[208:211], v8, s[8:11], s17 offen offset:2048
    buffer_load_dwordx4 v[212:215], v8, s[8:11], s17 offen offset:3072
    s_waitcnt vmcnt(3)
    v_mfma_f32_16x16x32_bf16 v[184:187], v[200:203], v[160:163], v[184:187]
    v_mfma_f32_16x16x32_bf16 v[188:191], v[200:203], v[176:179], v[188:191]
    s_waitcnt vmcnt(2)
    v_mfma_f32_16x16x32_bf16 v[192:195], v[204:207], v[160:163], v[192:195]
    v_mfma_f32_16x16x32_bf16 v[196:199], v[204:207], v[176:179], v[196:199]
    s_waitcnt vmcnt(1)
    v_mfma_f32_16x16x32_bf16 v[184:187], v[208:211], v[164:167], v[184:187]
    v_mfma_f32_16x16x32_bf16 v[188:191], v[208:211], v[180:183], v[188:191]
    s_waitcnt vmcnt(0)
    v_mfma_f32_16x16x32_bf16 v[192:195], v[212:215], v[164:167], v[192:195]
    v_mfma_f32_16x16x32_bf16 v[196:199], v[212:215], v[180:183], v[196:199]
    s_nop 3
    v_exp_f32 v184, v184
    v_exp_f32 v185, v185
    v_add_f32 v9, v9, v184
    v_add_f32 v9, v9, v185
    v_cvt_pk_bf16_f32 v112, v184, v185
    v_exp_f32 v186, v186
    v_exp_f32 v187, v187
    v_add_f32 v9, v9, v186
    v_add_f32 v9, v9, v187
    v_cvt_pk_bf16_f32 v113, v186, v187
    v_exp_f32 v188, v188
    v_exp_f32 v189, v189
    v_add_f32 v10, v10, v188
    v_add_f32 v10, v10, v189
    v_cvt_pk_bf16_f32 v116, v188, v189
    v_exp_f32 v190, v190
    v_exp_f32 v191, v191
    v_add_f32 v10, v10, v190
    v_add_f32 v10, v10, v191
    v_cvt_pk_bf16_f32 v117, v190, v191
    v_exp_f32 v192, v192
    v_exp_f32 v193, v193
    v_add_f32 v9, v9, v192
    v_add_f32 v9, v9, v193
    v_cvt_pk_bf16_f32 v114, v192, v193
    v_exp_f32 v194, v194
    v_exp_f32 v195, v195
    v_add_f32 v9, v9, v194
    v_add_f32 v9, v9, v195
    v_cvt_pk_bf16_f32 v115, v194, v195
    v_exp_f32 v196, v196
    v_exp_f32 v197, v197
    v_add_f32 v10, v10, v196
    v_add_f32 v10, v10, v197
    v_cvt_pk_bf16_f32 v118, v196, v197
    v_exp_f32 v198, v198
    v_exp_f32 v199, v199
    v_add_f32 v10, v10, v198
    v_add_f32 v10, v10, v199
    v_cvt_pk_bf16_f32 v119, v198, v199
    s_mov_b32 s17, 0x18000
    buffer_load_dwordx4 v[200:203], v8, s[8:11], s17 offen offset:0
    buffer_load_dwordx4 v[204:207], v8, s[8:11], s17 offen offset:1024
    buffer_load_dwordx4 v[208:211], v8, s[8:11], s17 offen offset:2048
    buffer_load_dwordx4 v[212:215], v8, s[8:11], s17 offen offset:3072
    s_waitcnt vmcnt(3)
    v_mfma_f32_16x16x32_bf16 v[184:187], v[200:203], v[152:155], v[216:219]
    v_mfma_f32_16x16x32_bf16 v[188:191], v[200:203], v[168:171], v[220:223]
    s_waitcnt vmcnt(2)
    v_mfma_f32_16x16x32_bf16 v[192:195], v[204:207], v[152:155], v[216:219]
    v_mfma_f32_16x16x32_bf16 v[196:199], v[204:207], v[168:171], v[220:223]
    s_waitcnt vmcnt(1)
    v_mfma_f32_16x16x32_bf16 v[184:187], v[208:211], v[156:159], v[184:187]
    v_mfma_f32_16x16x32_bf16 v[188:191], v[208:211], v[172:175], v[188:191]
    s_waitcnt vmcnt(0)
    v_mfma_f32_16x16x32_bf16 v[192:195], v[212:215], v[156:159], v[192:195]
    v_mfma_f32_16x16x32_bf16 v[196:199], v[212:215], v[172:175], v[196:199]
    s_mov_b32 s17, 0x19000
    buffer_load_dwordx4 v[200:203], v8, s[8:11], s17 offen offset:0
    buffer_load_dwordx4 v[204:207], v8, s[8:11], s17 offen offset:1024
    buffer_load_dwordx4 v[208:211], v8, s[8:11], s17 offen offset:2048
    buffer_load_dwordx4 v[212:215], v8, s[8:11], s17 offen offset:3072
    s_waitcnt vmcnt(3)
    v_mfma_f32_16x16x32_bf16 v[184:187], v[200:203], v[160:163], v[184:187]
    v_mfma_f32_16x16x32_bf16 v[188:191], v[200:203], v[176:179], v[188:191]
    s_waitcnt vmcnt(2)
    v_mfma_f32_16x16x32_bf16 v[192:195], v[204:207], v[160:163], v[192:195]
    v_mfma_f32_16x16x32_bf16 v[196:199], v[204:207], v[176:179], v[196:199]
    s_waitcnt vmcnt(1)
    v_mfma_f32_16x16x32_bf16 v[184:187], v[208:211], v[164:167], v[184:187]
    v_mfma_f32_16x16x32_bf16 v[188:191], v[208:211], v[180:183], v[188:191]
    s_waitcnt vmcnt(0)
    v_mfma_f32_16x16x32_bf16 v[192:195], v[212:215], v[164:167], v[192:195]
    v_mfma_f32_16x16x32_bf16 v[196:199], v[212:215], v[180:183], v[196:199]
    s_nop 3
    v_exp_f32 v184, v184
    v_exp_f32 v185, v185
    v_add_f32 v9, v9, v184
    v_add_f32 v9, v9, v185
    v_cvt_pk_bf16_f32 v120, v184, v185
    v_exp_f32 v186, v186
    v_exp_f32 v187, v187
    v_add_f32 v9, v9, v186
    v_add_f32 v9, v9, v187
    v_cvt_pk_bf16_f32 v121, v186, v187
    v_exp_f32 v188, v188
    v_exp_f32 v189, v189
    v_add_f32 v10, v10, v188
    v_add_f32 v10, v10, v189
    v_cvt_pk_bf16_f32 v124, v188, v189
    v_exp_f32 v190, v190
    v_exp_f32 v191, v191
    v_add_f32 v10, v10, v190
    v_add_f32 v10, v10, v191
    v_cvt_pk_bf16_f32 v125, v190, v191
    v_exp_f32 v192, v192
    v_exp_f32 v193, v193
    v_add_f32 v9, v9, v192
    v_add_f32 v9, v9, v193
    v_cvt_pk_bf16_f32 v122, v192, v193
    v_exp_f32 v194, v194
    v_exp_f32 v195, v195
    v_add_f32 v9, v9, v194
    v_add_f32 v9, v9, v195
    v_cvt_pk_bf16_f32 v123, v194, v195
    v_exp_f32 v196, v196
    v_exp_f32 v197, v197
    v_add_f32 v10, v10, v196
    v_add_f32 v10, v10, v197
    v_cvt_pk_bf16_f32 v126, v196, v197
    v_exp_f32 v198, v198
    v_exp_f32 v199, v199
    v_add_f32 v10, v10, v198
    v_add_f32 v10, v10, v199
    v_cvt_pk_bf16_f32 v127, v198, v199
    s_mov_b32 s17, 0x1a000
    buffer_load_dwordx4 v[200:203], v8, s[8:11], s17 offen offset:0
    buffer_load_dwordx4 v[204:207], v8, s[8:11], s17 offen offset:1024
    buffer_load_dwordx4 v[208:211], v8, s[8:11], s17 offen offset:2048
    buffer_load_dwordx4 v[212:215], v8, s[8:11], s17 offen offset:3072
    s_waitcnt vmcnt(3)
    v_mfma_f32_16x16x32_bf16 v[184:187], v[200:203], v[152:155], v[216:219]
    v_mfma_f32_16x16x32_bf16 v[188:191], v[200:203], v[168:171], v[220:223]
    s_waitcnt vmcnt(2)
    v_mfma_f32_16x16x32_bf16 v[192:195], v[204:207], v[152:155], v[216:219]
    v_mfma_f32_16x16x32_bf16 v[196:199], v[204:207], v[168:171], v[220:223]
    s_waitcnt vmcnt(1)
    v_mfma_f32_16x16x32_bf16 v[184:187], v[208:211], v[156:159], v[184:187]
    v_mfma_f32_16x16x32_bf16 v[188:191], v[208:211], v[172:175], v[188:191]
    s_waitcnt vmcnt(0)
    v_mfma_f32_16x16x32_bf16 v[192:195], v[212:215], v[156:159], v[192:195]
    v_mfma_f32_16x16x32_bf16 v[196:199], v[212:215], v[172:175], v[196:199]
    s_mov_b32 s17, 0x1b000
    buffer_load_dwordx4 v[200:203], v8, s[8:11], s17 offen offset:0
    buffer_load_dwordx4 v[204:207], v8, s[8:11], s17 offen offset:1024
    buffer_load_dwordx4 v[208:211], v8, s[8:11], s17 offen offset:2048
    buffer_load_dwordx4 v[212:215], v8, s[8:11], s17 offen offset:3072
    s_waitcnt vmcnt(3)
    v_mfma_f32_16x16x32_bf16 v[184:187], v[200:203], v[160:163], v[184:187]
    v_mfma_f32_16x16x32_bf16 v[188:191], v[200:203], v[176:179], v[188:191]
    s_waitcnt vmcnt(2)
    v_mfma_f32_16x16x32_bf16 v[192:195], v[204:207], v[160:163], v[192:195]
    v_mfma_f32_16x16x32_bf16 v[196:199], v[204:207], v[176:179], v[196:199]
    s_waitcnt vmcnt(1)
    v_mfma_f32_16x16x32_bf16 v[184:187], v[208:211], v[164:167], v[184:187]
    v_mfma_f32_16x16x32_bf16 v[188:191], v[208:211], v[180:183], v[188:191]
    s_waitcnt vmcnt(0)
    v_mfma_f32_16x16x32_bf16 v[192:195], v[212:215], v[164:167], v[192:195]
    v_mfma_f32_16x16x32_bf16 v[196:199], v[212:215], v[180:183], v[196:199]
    s_nop 3
    v_exp_f32 v184, v184
    v_exp_f32 v185, v185
    v_add_f32 v9, v9, v184
    v_add_f32 v9, v9, v185
    v_cvt_pk_bf16_f32 v128, v184, v185
    v_exp_f32 v186, v186
    v_exp_f32 v187, v187
    v_add_f32 v9, v9, v186
    v_add_f32 v9, v9, v187
    v_cvt_pk_bf16_f32 v129, v186, v187
    v_exp_f32 v188, v188
    v_exp_f32 v189, v189
    v_add_f32 v10, v10, v188
    v_add_f32 v10, v10, v189
    v_cvt_pk_bf16_f32 v132, v188, v189
    v_exp_f32 v190, v190
    v_exp_f32 v191, v191
    v_add_f32 v10, v10, v190
    v_add_f32 v10, v10, v191
    v_cvt_pk_bf16_f32 v133, v190, v191
    v_exp_f32 v192, v192
    v_exp_f32 v193, v193
    v_add_f32 v9, v9, v192
    v_add_f32 v9, v9, v193
    v_cvt_pk_bf16_f32 v130, v192, v193
    v_exp_f32 v194, v194
    v_exp_f32 v195, v195
    v_add_f32 v9, v9, v194
    v_add_f32 v9, v9, v195
    v_cvt_pk_bf16_f32 v131, v194, v195
    v_exp_f32 v196, v196
    v_exp_f32 v197, v197
    v_add_f32 v10, v10, v196
    v_add_f32 v10, v10, v197
    v_cvt_pk_bf16_f32 v134, v196, v197
    v_exp_f32 v198, v198
    v_exp_f32 v199, v199
    v_add_f32 v10, v10, v198
    v_add_f32 v10, v10, v199
    v_cvt_pk_bf16_f32 v135, v198, v199
    s_mov_b32 s17, 0x1c000
    buffer_load_dwordx4 v[200:203], v8, s[8:11], s17 offen offset:0
    buffer_load_dwordx4 v[204:207], v8, s[8:11], s17 offen offset:1024
    buffer_load_dwordx4 v[208:211], v8, s[8:11], s17 offen offset:2048
    buffer_load_dwordx4 v[212:215], v8, s[8:11], s17 offen offset:3072
    s_waitcnt vmcnt(3)
    v_mfma_f32_16x16x32_bf16 v[184:187], v[200:203], v[152:155], v[216:219]
    v_mfma_f32_16x16x32_bf16 v[188:191], v[200:203], v[168:171], v[220:223]
    s_waitcnt vmcnt(2)
    v_mfma_f32_16x16x32_bf16 v[192:195], v[204:207], v[152:155], v[216:219]
    v_mfma_f32_16x16x32_bf16 v[196:199], v[204:207], v[168:171], v[220:223]
    s_waitcnt vmcnt(1)
    v_mfma_f32_16x16x32_bf16 v[184:187], v[208:211], v[156:159], v[184:187]
    v_mfma_f32_16x16x32_bf16 v[188:191], v[208:211], v[172:175], v[188:191]
    s_waitcnt vmcnt(0)
    v_mfma_f32_16x16x32_bf16 v[192:195], v[212:215], v[156:159], v[192:195]
    v_mfma_f32_16x16x32_bf16 v[196:199], v[212:215], v[172:175], v[196:199]
    s_mov_b32 s17, 0x1d000
    buffer_load_dwordx4 v[200:203], v8, s[8:11], s17 offen offset:0
    buffer_load_dwordx4 v[204:207], v8, s[8:11], s17 offen offset:1024
    buffer_load_dwordx4 v[208:211], v8, s[8:11], s17 offen offset:2048
    buffer_load_dwordx4 v[212:215], v8, s[8:11], s17 offen offset:3072
    s_waitcnt vmcnt(3)
    v_mfma_f32_16x16x32_bf16 v[184:187], v[200:203], v[160:163], v[184:187]
    v_mfma_f32_16x16x32_bf16 v[188:191], v[200:203], v[176:179], v[188:191]
    s_waitcnt vmcnt(2)
    v_mfma_f32_16x16x32_bf16 v[192:195], v[204:207], v[160:163], v[192:195]
    v_mfma_f32_16x16x32_bf16 v[196:199], v[204:207], v[176:179], v[196:199]
    s_waitcnt vmcnt(1)
    v_mfma_f32_16x16x32_bf16 v[184:187], v[208:211], v[164:167], v[184:187]
    v_mfma_f32_16x16x32_bf16 v[188:191], v[208:211], v[180:183], v[188:191]
    s_waitcnt vmcnt(0)
    v_mfma_f32_16x16x32_bf16 v[192:195], v[212:215], v[164:167], v[192:195]
    v_mfma_f32_16x16x32_bf16 v[196:199], v[212:215], v[180:183], v[196:199]
    s_nop 3
    v_exp_f32 v184, v184
    v_exp_f32 v185, v185
    v_add_f32 v9, v9, v184
    v_add_f32 v9, v9, v185
    v_cvt_pk_bf16_f32 v136, v184, v185
    v_exp_f32 v186, v186
    v_exp_f32 v187, v187
    v_add_f32 v9, v9, v186
    v_add_f32 v9, v9, v187
    v_cvt_pk_bf16_f32 v137, v186, v187
    v_exp_f32 v188, v188
    v_exp_f32 v189, v189
    v_add_f32 v10, v10, v188
    v_add_f32 v10, v10, v189
    v_cvt_pk_bf16_f32 v140, v188, v189
    v_exp_f32 v190, v190
    v_exp_f32 v191, v191
    v_add_f32 v10, v10, v190
    v_add_f32 v10, v10, v191
    v_cvt_pk_bf16_f32 v141, v190, v191
    v_exp_f32 v192, v192
    v_exp_f32 v193, v193
    v_add_f32 v9, v9, v192
    v_add_f32 v9, v9, v193
    v_cvt_pk_bf16_f32 v138, v192, v193
    v_exp_f32 v194, v194
    v_exp_f32 v195, v195
    v_add_f32 v9, v9, v194
    v_add_f32 v9, v9, v195
    v_cvt_pk_bf16_f32 v139, v194, v195
    v_exp_f32 v196, v196
    v_exp_f32 v197, v197
    v_add_f32 v10, v10, v196
    v_add_f32 v10, v10, v197
    v_cvt_pk_bf16_f32 v142, v196, v197
    v_exp_f32 v198, v198
    v_exp_f32 v199, v199
    v_add_f32 v10, v10, v198
    v_add_f32 v10, v10, v199
    v_cvt_pk_bf16_f32 v143, v198, v199
    s_mov_b32 s17, 0x1e000
    buffer_load_dwordx4 v[200:203], v8, s[8:11], s17 offen offset:0
    buffer_load_dwordx4 v[204:207], v8, s[8:11], s17 offen offset:1024
    buffer_load_dwordx4 v[208:211], v8, s[8:11], s17 offen offset:2048
    buffer_load_dwordx4 v[212:215], v8, s[8:11], s17 offen offset:3072
    s_waitcnt vmcnt(3)
    v_mfma_f32_16x16x32_bf16 v[184:187], v[200:203], v[152:155], v[216:219]
    v_mfma_f32_16x16x32_bf16 v[188:191], v[200:203], v[168:171], v[220:223]
    s_waitcnt vmcnt(2)
    v_mfma_f32_16x16x32_bf16 v[192:195], v[204:207], v[152:155], v[216:219]
    v_mfma_f32_16x16x32_bf16 v[196:199], v[204:207], v[168:171], v[220:223]
    s_waitcnt vmcnt(1)
    v_mfma_f32_16x16x32_bf16 v[184:187], v[208:211], v[156:159], v[184:187]
    v_mfma_f32_16x16x32_bf16 v[188:191], v[208:211], v[172:175], v[188:191]
    s_waitcnt vmcnt(0)
    v_mfma_f32_16x16x32_bf16 v[192:195], v[212:215], v[156:159], v[192:195]
    v_mfma_f32_16x16x32_bf16 v[196:199], v[212:215], v[172:175], v[196:199]
    s_mov_b32 s17, 0x1f000
    buffer_load_dwordx4 v[200:203], v8, s[8:11], s17 offen offset:0
    buffer_load_dwordx4 v[204:207], v8, s[8:11], s17 offen offset:1024
    buffer_load_dwordx4 v[208:211], v8, s[8:11], s17 offen offset:2048
    buffer_load_dwordx4 v[212:215], v8, s[8:11], s17 offen offset:3072
    s_waitcnt vmcnt(3)
    v_mfma_f32_16x16x32_bf16 v[184:187], v[200:203], v[160:163], v[184:187]
    v_mfma_f32_16x16x32_bf16 v[188:191], v[200:203], v[176:179], v[188:191]
    s_waitcnt vmcnt(2)
    v_mfma_f32_16x16x32_bf16 v[192:195], v[204:207], v[160:163], v[192:195]
    v_mfma_f32_16x16x32_bf16 v[196:199], v[204:207], v[176:179], v[196:199]
    s_waitcnt vmcnt(1)
    v_mfma_f32_16x16x32_bf16 v[184:187], v[208:211], v[164:167], v[184:187]
    v_mfma_f32_16x16x32_bf16 v[188:191], v[208:211], v[180:183], v[188:191]
    s_waitcnt vmcnt(0)
    v_mfma_f32_16x16x32_bf16 v[192:195], v[212:215], v[164:167], v[192:195]
    v_mfma_f32_16x16x32_bf16 v[196:199], v[212:215], v[180:183], v[196:199]
    s_nop 3
    v_exp_f32 v184, v184
    v_exp_f32 v185, v185
    v_add_f32 v9, v9, v184
    v_add_f32 v9, v9, v185
    v_cvt_pk_bf16_f32 v144, v184, v185
    v_exp_f32 v186, v186
    v_exp_f32 v187, v187
    v_add_f32 v9, v9, v186
    v_add_f32 v9, v9, v187
    v_cvt_pk_bf16_f32 v145, v186, v187
    v_exp_f32 v188, v188
    v_exp_f32 v189, v189
    v_add_f32 v10, v10, v188
    v_add_f32 v10, v10, v189
    v_cvt_pk_bf16_f32 v148, v188, v189
    v_exp_f32 v190, v190
    v_exp_f32 v191, v191
    v_add_f32 v10, v10, v190
    v_add_f32 v10, v10, v191
    v_cvt_pk_bf16_f32 v149, v190, v191
    v_exp_f32 v192, v192
    v_exp_f32 v193, v193
    v_add_f32 v9, v9, v192
    v_add_f32 v9, v9, v193
    v_cvt_pk_bf16_f32 v146, v192, v193
    v_exp_f32 v194, v194
    v_exp_f32 v195, v195
    v_add_f32 v9, v9, v194
    v_add_f32 v9, v9, v195
    v_cvt_pk_bf16_f32 v147, v194, v195
    v_exp_f32 v196, v196
    v_exp_f32 v197, v197
    v_add_f32 v10, v10, v196
    v_add_f32 v10, v10, v197
    v_cvt_pk_bf16_f32 v150, v196, v197
    v_exp_f32 v198, v198
    v_exp_f32 v199, v199
    v_add_f32 v10, v10, v198
    v_add_f32 v10, v10, v199
    v_cvt_pk_bf16_f32 v151, v198, v199
    v_mov_b32 v16, v9
    v_mov_b32 v18, v10
    s_nop 0
    v_permlane16_swap_b32 v9, v16
    v_permlane16_swap_b32 v10, v18
    v_add_f32 v9, v9, v16
    v_add_f32 v10, v10, v18
    v_mov_b32 v16, v9
    v_mov_b32 v18, v10
    s_nop 0
    v_permlane32_swap_b32 v9, v16
    v_permlane32_swap_b32 v10, v18
    v_add_f32 v9, v9, v16
    v_add_f32 v10, v10, v18
    s_waitcnt vmcnt(0) lgkmcnt(0)
    s_nop 15
    s_nop 3
    s_branch adaLN_cond__sliding_block_cached__moe_arch_mod__prompt_kernel_fixBb
adaLN_cond__sliding_block_cached__moe_arch_mod__prompt_kernel_o17r:
    s_waitcnt vmcnt(0) lgkmcnt(0)
    s_nop 15
    s_nop 3
    s_mov_b32 s27, 0
adaLN_cond__sliding_block_cached__moe_arch_mod__prompt_kernel_o17p:
    buffer_load_dword v12, v13, s[8:11], s19 offen sc1
    s_waitcnt vmcnt(0)
    v_cmp_ne_u32 vcc, s28, v12
    s_add_u32 s27, s27, 1
    s_cmp_ge_u32 s27, 65536
    s_cbranch_scc1 adaLN_cond__sliding_block_cached__moe_arch_mod__prompt_kernel_o17g
    s_cbranch_vccnz adaLN_cond__sliding_block_cached__moe_arch_mod__prompt_kernel_o17p
adaLN_cond__sliding_block_cached__moe_arch_mod__prompt_kernel_o17g:
    s_waitcnt vmcnt(0) lgkmcnt(0)
    s_nop 15
    s_nop 3
    s_branch adaLN_cond__sliding_block_cached__moe_arch_mod__prompt_kernel_o17b
adaLN_cond__sliding_block_cached__moe_arch_mod__prompt_kernel_o218r:
    s_waitcnt vmcnt(0) lgkmcnt(0)
    s_nop 15
    s_nop 3
    s_mov_b32 s27, 0
adaLN_cond__sliding_block_cached__moe_arch_mod__prompt_kernel_o218p:
    buffer_load_dword v12, v13, s[8:11], s19 offen sc1
    s_waitcnt vmcnt(0)
    v_cmp_ne_u32 vcc, s28, v12
    s_add_u32 s27, s27, 1
    s_cmp_ge_u32 s27, 65536
    s_cbranch_scc1 adaLN_cond__sliding_block_cached__moe_arch_mod__prompt_kernel_o218g
    s_cbranch_vccnz adaLN_cond__sliding_block_cached__moe_arch_mod__prompt_kernel_o218p
adaLN_cond__sliding_block_cached__moe_arch_mod__prompt_kernel_o218g:
    s_waitcnt vmcnt(0) lgkmcnt(0)
    s_nop 15
    s_nop 3
    s_branch adaLN_cond__sliding_block_cached__moe_arch_mod__prompt_kernel_o218b
adaLN_cond__sliding_block_cached__moe_arch_mod__prompt_kernel_o219r:
    s_waitcnt vmcnt(0) lgkmcnt(0)
    s_nop 15
    s_nop 3
    s_mov_b32 s27, 0
adaLN_cond__sliding_block_cached__moe_arch_mod__prompt_kernel_o219p:
    buffer_load_dword v12, v13, s[8:11], s19 offen sc1
    s_waitcnt vmcnt(0)
    v_cmp_ne_u32 vcc, s28, v12
    s_add_u32 s27, s27, 1
    s_cmp_ge_u32 s27, 65536
    s_cbranch_scc1 adaLN_cond__sliding_block_cached__moe_arch_mod__prompt_kernel_o219g
    s_cbranch_vccnz adaLN_cond__sliding_block_cached__moe_arch_mod__prompt_kernel_o219p
adaLN_cond__sliding_block_cached__moe_arch_mod__prompt_kernel_o219g:
    s_waitcnt vmcnt(0) lgkmcnt(0)
    s_nop 15
    s_nop 3
    s_branch adaLN_cond__sliding_block_cached__moe_arch_mod__prompt_kernel_o219b
adaLN_cond__sliding_block_cached__moe_arch_mod__prompt_kernel_o220r:
    s_waitcnt vmcnt(0) lgkmcnt(0)
    s_nop 15
    s_nop 3
    s_mov_b32 s27, 0
adaLN_cond__sliding_block_cached__moe_arch_mod__prompt_kernel_o220p:
    buffer_load_dword v12, v13, s[8:11], s19 offen sc1
    s_waitcnt vmcnt(0)
    v_cmp_ne_u32 vcc, s28, v12
    s_add_u32 s27, s27, 1
    s_cmp_ge_u32 s27, 65536
    s_cbranch_scc1 adaLN_cond__sliding_block_cached__moe_arch_mod__prompt_kernel_o220g
    s_cbranch_vccnz adaLN_cond__sliding_block_cached__moe_arch_mod__prompt_kernel_o220p
adaLN_cond__sliding_block_cached__moe_arch_mod__prompt_kernel_o220g:
    s_waitcnt vmcnt(0) lgkmcnt(0)
    s_nop 15
    s_nop 3
    s_branch adaLN_cond__sliding_block_cached__moe_arch_mod__prompt_kernel_o220b
adaLN_cond__sliding_block_cached__moe_arch_mod__prompt_kernel_mf21r:
    s_waitcnt vmcnt(0) lgkmcnt(0)
    s_nop 15
    s_nop 3
    s_mov_b32 s27, 0
adaLN_cond__sliding_block_cached__moe_arch_mod__prompt_kernel_mf21p:
    s_mov_b32 s16, 0x544000
    buffer_load_dwordx4 v[184:187], v2, s[8:11], s16 offen sc1
    s_waitcnt vmcnt(0)
    v_xor_b32 v16, s28, v184
    v_xor_b32 v17, s28, v185
    v_xor_b32 v18, s28, v186
    v_xor_b32 v19, s28, v187
    v_or3_b32 v16, v16, v17, v18
    v_or_b32 v16, v16, v19
    v_cmp_ne_u32 vcc, 0, v16
    s_add_u32 s27, s27, 1
    s_cmp_ge_u32 s27, 65536
    s_cbranch_scc1 adaLN_cond__sliding_block_cached__moe_arch_mod__prompt_kernel_mf21g
    s_cbranch_vccnz adaLN_cond__sliding_block_cached__moe_arch_mod__prompt_kernel_mf21p
adaLN_cond__sliding_block_cached__moe_arch_mod__prompt_kernel_mf21g:
    s_waitcnt vmcnt(0) lgkmcnt(0)
    s_nop 15
    s_nop 3
    s_branch adaLN_cond__sliding_block_cached__moe_arch_mod__prompt_kernel_mf21b
adaLN_cond__sliding_block_cached__moe_arch_mod__prompt_kernel_codeend:
    s_endpgm
.section .rodata,"a"
.p2align 6
.amdhsa_kernel adaLN_cond__sliding_block_cached__moe_arch_mod__prompt_kernel
  .amdhsa_next_free_vgpr 256
  .amdhsa_next_free_sgpr 80
  .amdhsa_accum_offset 256
  .amdhsa_group_segment_fixed_size 0
  .amdhsa_kernarg_size 120
  .amdhsa_user_sgpr_count 2
  .amdhsa_user_sgpr_kernarg_segment_ptr 1
  .amdhsa_system_sgpr_workgroup_id_x 1
  .amdhsa_float_denorm_mode_32 3
.end_amdhsa_kernel
```

```asm
; @launch grid=(256,1,1) block=(512,1,1) lds=163840
.amdgcn_target "amdgcn-amd-amdhsa--gfx950"
.text
.globl adaLN_cond__sliding_block_cached__moe_arch_mod__prompt_kernel
.p2align 8
.type adaLN_cond__sliding_block_cached__moe_arch_mod__prompt_kernel,@function
adaLN_cond__sliding_block_cached__moe_arch_mod__prompt_kernel:
    s_cmp_ge_u32 s2, 256
    s_cbranch_scc1 adaLN_cond__sliding_block_cached__moe_arch_mod__prompt_kernel_end
    s_getpc_b64 s[76:77]
adaLN_cond__sliding_block_cached__moe_arch_mod__prompt_kernel_pc0:
    s_sub_u32 s76, s76, adaLN_cond__sliding_block_cached__moe_arch_mod__prompt_kernel_pc0-adaLN_cond__sliding_block_cached__moe_arch_mod__prompt_kernel
    s_subb_u32 s77, s77, 0
    v_and_b32 v16, 63, v0
    v_lshlrev_b32 v16, 7, v16
    v_lshrrev_b32 v17, 6, v0
    s_lshr_b32 s62, s2, 3
    s_lshl_b32 s62, s62, 13
    v_lshlrev_b32 v18, 13, v17
    v_mov_b32 v19, s62
    v_cmp_eq_u32 vcc, 7, v17
    s_nop 1
    v_cndmask_b32 v18, v18, v19, vcc
    v_add_u32 v16, v16, v18
    v_min_u32 v16, adaLN_cond__sliding_block_cached__moe_arch_mod__prompt_kernel_codeend-adaLN_cond__sliding_block_cached__moe_arch_mod__prompt_kernel-4, v16
    v_mov_b32 v25, s77
    v_add_co_u32 v24, vcc, s76, v16
    s_nop 1
    v_addc_co_u32 v25, vcc, 0, v25, vcc
    v_cmp_gt_u32 vcc, 2, v17
    v_cmp_eq_u32 s[62:63], 7, v17
    s_or_b64 vcc, vcc, s[62:63]
    s_and_saveexec_b64 s[62:63], vcc
    s_cbranch_execz adaLN_cond__sliding_block_cached__moe_arch_mod__prompt_kernel_nocp0
    global_load_dword v26, v[24:25], off
adaLN_cond__sliding_block_cached__moe_arch_mod__prompt_kernel_nocp0:
    s_mov_b64 exec, s[62:63]
    s_load_dwordx4 s[56:59], s[0:1], 96
    s_load_dwordx2 s[60:61], s[0:1], 112
    s_load_dwordx8 s[48:55], s[0:1], 64
    s_load_dwordx16 s[32:47], s[0:1], 0
    s_memrealtime s[62:63]
    v_lshrrev_b32 v16, 6, v0
    v_and_b32 v1, 63, v0
    v_readfirstlane_b32 s3, v16
    v_lshlrev_b32 v2, 4, v1
    s_and_b32 s12, s2, 3
    s_lshl_b32 s12, s12, 3
    s_bfe_u32 s13, s2, 0x30003
    s_add_u32 s12, s12, s13
    s_bfe_u32 s13, s2, 0x10002
    s_lshl_b32 s13, s13, 2
    s_lshr_b32 s14, s2, 6
    s_add_u32 s13, s13, s14
    v_bfe_u32 v16, v1, 2, 2
    v_lshrrev_b32 v17, 4, v1
    v_and_b32 v18, 3, v1
    v_lshlrev_b32 v19, 6, v17
    v_lshl_add_u32 v19, v18, 4, v19
    v_lshl_add_u32 v3, v16, 13, v19
    s_and_b32 s14, s3, 1
    s_lshl_b32 s14, s14, 5
    v_xor_b32 v3, s14, v3
    v_lshlrev_b32 v4, 11, v17
    v_lshl_add_u32 v4, v16, 6, v4
    v_lshl_add_u32 v4, v18, 3, v4
    v_and_b32 v20, 1, v17
    v_lshlrev_b32 v20, 5, v20
    v_sub_u32 v5, v4, v20
    v_add_u32 v4, v4, v20
    s_lshl_b32 s14, s13, 3
    s_add_u32 s14, s14, s3
    s_lshl_b32 s14, s14, 16
    v_add_u32 v7, s14, v2
    s_cmp_ge_u32 s3, 4
    s_cbranch_scc1 adaLN_cond__sliding_block_cached__moe_arch_mod__prompt_kernel_roleB
    v_mov_b32 v132, 0
    v_mov_b32 v133, 0
    v_lshrrev_b32 v16, 3, v0
    v_and_b32 v17, 7, v0
    v_mul_u32_u24 v135, 24576, v16
    v_lshl_add_u32 v135, v17, 4, v135
    v_lshlrev_b32 v136, 2, v16
    s_and_b32 s14, s2, 31
    s_lshr_b32 s15, s2, 5
    s_mul_i32 s26, s15, 1572864
    s_lshl_b32 s16, s14, 7
    s_add_u32 s26, s26, s16
    s_lshl_b32 s29, s15, 8
    v_lshlrev_b32 v137, 3, v0
    s_lshl_b32 s18, s2, 3
    s_add_u32 s18, s18, s3
    s_lshl_b32 s18, s18, 11
    v_and_b32 v18, 15, v1
    v_lshrrev_b32 v19, 4, v1
    v_lshlrev_b32 v138, 11, v18
    v_lshl_add_u32 v138, v19, 4, v138
    s_lshr_b32 s30, s2, 4
    s_and_b32 s31, s2, 15
    s_lshl_b32 s19, s30, 3
    s_add_u32 s19, s19, s3
    s_lshl_b32 s22, s19, 15
    s_lshl_b32 s23, s31, 7
    s_add_u32 s22, s22, s23
    s_lshl_b32 s23, s2, 12
    s_add_u32 s23, s23, 0x600000
    s_or_b32 s25, s2, s3
    s_cmp_eq_u32 s25, 0
    s_cselect_b32 s25, 0, 0x7ffffff0
    s_waitcnt lgkmcnt(0)
    s_mov_b64 s[64:65], s[58:59]
    s_mov_b32 s66, 0x100
    s_mov_b32 s67, 0x20000
    s_or_b32 s28, s62, 1
    v_mov_b32 v134, s28
    s_mov_b64 exec, 1
    buffer_store_dword v134, v132, s[64:67], s25 offen sc1
    s_mov_b64 exec, -1
    s_mov_b64 s[68:69], s[52:53]
    s_mov_b32 s70, 0x800
    s_mov_b32 s71, 0x20000
    s_mov_b64 s[72:73], s[54:55]
    s_mov_b32 s74, 0xc00000
    s_mov_b32 s75, 0x20000
    s_mov_b64 s[76:77], s[32:33]
    s_mov_b32 s78, 0x400000
    s_mov_b32 s79, 0x20000
    s_mov_b64 s[8:9], s[60:61]
    s_mov_b32 s10, 0x3400000
    s_mov_b32 s11, 0x20000
    buffer_load_dwordx4 v[32:35], v2, s[76:79], s18 offen offset:0
    buffer_load_dwordx4 v[36:39], v2, s[76:79], s18 offen offset:1024
    buffer_load_dword v72, v136, s[68:71], s29 offen
    buffer_load_dwordx4 v[24:27], v135, s[72:75], s26 offen
    s_add_u32 s26, s26, 12288
    buffer_load_dwordx4 v[28:31], v135, s[72:75], s26 offen
    s_cmp_eq_u32 s3, 0
    s_cselect_b32 s25, 0, 0x7ffffff0
    buffer_load_dword v134, v132, s[64:67], s25 offen sc1
    buffer_store_dwordx2 v[132:133], v137, s[8:11], s23 offen sc1
    s_barrier
    buffer_load_dwordx4 v[40:43], v138, s[76:79], s22 offen offset:0
    buffer_load_dwordx4 v[44:47], v138, s[76:79], s22 offen offset:64
    s_mov_b32 s29, s19
    s_waitcnt vmcnt(8)
    v_lshlrev_b32 v56, 16, v32
    v_and_b32 v57, 0xffff0000, v32
    v_lshlrev_b32 v58, 16, v33
    v_and_b32 v59, 0xffff0000, v33
    v_lshlrev_b32 v60, 16, v34
    v_and_b32 v61, 0xffff0000, v34
    v_lshlrev_b32 v62, 16, v35
    v_and_b32 v63, 0xffff0000, v35
    s_waitcnt vmcnt(7)
    v_lshlrev_b32 v64, 16, v36
    v_and_b32 v65, 0xffff0000, v36
    v_lshlrev_b32 v66, 16, v37
    v_and_b32 v67, 0xffff0000, v37
    v_lshlrev_b32 v68, 16, v38
    v_and_b32 v69, 0xffff0000, v38
    v_lshlrev_b32 v70, 16, v39
    v_and_b32 v71, 0xffff0000, v39
    v_add_f32 v20, v56, v57
    v_add_f32 v21, v58, v59
    v_add_f32 v20, v20, v60
    v_add_f32 v21, v21, v61
    v_add_f32 v20, v20, v62
    v_add_f32 v21, v21, v63
    v_add_f32 v20, v20, v64
    v_add_f32 v21, v21, v65
    v_add_f32 v20, v20, v66
    v_add_f32 v21, v21, v67
    v_add_f32 v20, v20, v68
    v_add_f32 v21, v21, v69
    v_add_f32 v20, v20, v70
    v_add_f32 v21, v21, v71
    v_add_f32 v128, v20, v21
    s_nop 1
    v_add_f32_dpp v128, v128, v128 row_ror:1 row_mask:0xf bank_mask:0xf
    s_nop 1
    v_add_f32_dpp v128, v128, v128 row_ror:2 row_mask:0xf bank_mask:0xf
    s_nop 1
    v_add_f32_dpp v128, v128, v128 row_ror:4 row_mask:0xf bank_mask:0xf
    s_nop 1
    v_add_f32_dpp v128, v128, v128 row_ror:8 row_mask:0xf bank_mask:0xf
    v_mov_b32 v20, v128
    s_nop 1
    v_permlane16_swap_b32 v128, v20
    v_add_f32 v128, v128, v20
    v_mov_b32 v20, v128
    s_nop 1
    v_permlane32_swap_b32 v128, v20
    v_add_f32 v128, v128, v20
    v_mul_f32 v128, 0x3a800000, v128
    v_sub_f32 v18, v56, v128
    v_mul_f32 v20, v18, v18
    v_sub_f32 v19, v57, v128
    v_mul_f32 v21, v19, v19
    v_sub_f32 v18, v58, v128
    v_sub_f32 v19, v59, v128
    v_fmac_f32 v20, v18, v18
    v_fmac_f32 v21, v19, v19
    v_sub_f32 v18, v60, v128
    v_sub_f32 v19, v61, v128
    v_fmac_f32 v20, v18, v18
    v_fmac_f32 v21, v19, v19
    v_sub_f32 v18, v62, v128
    v_sub_f32 v19, v63, v128
    v_fmac_f32 v20, v18, v18
    v_fmac_f32 v21, v19, v19
    v_sub_f32 v18, v64, v128
    v_sub_f32 v19, v65, v128
    v_fmac_f32 v20, v18, v18
    v_fmac_f32 v21, v19, v19
    v_sub_f32 v18, v66, v128
    v_sub_f32 v19, v67, v128
    v_fmac_f32 v20, v18, v18
    v_fmac_f32 v21, v19, v19
    v_sub_f32 v18, v68, v128
    v_sub_f32 v19, v69, v128
    v_fmac_f32 v20, v18, v18
    v_fmac_f32 v21, v19, v19
    v_sub_f32 v18, v70, v128
    v_sub_f32 v19, v71, v128
    v_fmac_f32 v20, v18, v18
    v_fmac_f32 v21, v19, v19
    v_add_f32 v17, v20, v21
    s_nop 1
    v_add_f32_dpp v17, v17, v17 row_ror:1 row_mask:0xf bank_mask:0xf
    s_nop 1
    v_add_f32_dpp v17, v17, v17 row_ror:2 row_mask:0xf bank_mask:0xf
    s_nop 1
    v_add_f32_dpp v17, v17, v17 row_ror:4 row_mask:0xf bank_mask:0xf
    s_nop 1
    v_add_f32_dpp v17, v17, v17 row_ror:8 row_mask:0xf bank_mask:0xf
    v_mov_b32 v20, v17
    s_nop 1
    v_permlane16_swap_b32 v17, v20
    v_add_f32 v17, v17, v20
    v_mov_b32 v20, v17
    s_nop 1
    v_permlane32_swap_b32 v17, v20
    v_add_f32 v17, v17, v20
    v_mul_f32 v17, 0x3a800000, v17
    v_cvt_pk_bf16_f32 v128, v128, v128
    v_lshlrev_b32 v128, 16, v128
    v_cvt_pk_bf16_f32 v17, v17, v17
    v_lshlrev_b32 v17, 16, v17
    v_add_f32 v17, 0x3727c5ac, v17
    v_cvt_pk_bf16_f32 v17, v17, v17
    v_lshlrev_b32 v17, 16, v17
    v_sqrt_f32 v129, v17
    s_nop 0
    v_cvt_pk_bf16_f32 v129, v129, v129
    v_lshlrev_b32 v129, 16, v129
    v_rcp_f32 v130, v129
    s_lshl_b32 s16, s3, 4
    s_add_u32 s16, s16, 149520
    v_mov_b32 v19, s16
    ds_write_b128 v19, v[128:131]
    s_waitcnt vmcnt(6)
    v_and_b32 v73, 0xffff0000, v72
    v_lshlrev_b32 v72, 16, v72
    v_mul_f32 v16, 0xbfb8aa3b, v72
    v_exp_f32 v16, v16
    s_nop 0
    v_add_f32 v16, 1.0, v16
    v_rcp_f32 v16, v16
    s_nop 0
    v_mul_f32 v72, v72, v16
    v_mul_f32 v17, 0xbfb8aa3b, v73
    v_exp_f32 v17, v17
    s_nop 0
    v_add_f32 v17, 1.0, v17
    v_rcp_f32 v17, v17
    s_nop 0
    v_mul_f32 v73, v73, v17
    v_cvt_pk_bf16_f32 v16, v72, v73
    v_lshlrev_b32 v72, 16, v16
    v_and_b32 v73, 0xffff0000, v16
    s_lshl_b32 s16, s2, 8
    s_add_u32 s16, s16, 0x550000
    s_mov_b32 exec_lo, 0x01010101
    s_mov_b32 exec_hi, 0x01010101
    buffer_store_dword v16, v136, s[8:11], s16 offen sc1
    s_mov_b64 exec, -1
    v_lshrrev_b32 v74, 16, v72
    v_lshrrev_b32 v75, 16, v73
    s_waitcnt vmcnt(6)
    v_dot2_f32_bf16 v49, v24, v72, 0
    v_dot2_f32_bf16 v48, v24, v74, 0
    v_dot2_f32_bf16 v51, v25, v72, 0
    v_dot2_f32_bf16 v50, v25, v74, 0
    v_dot2_f32_bf16 v53, v26, v72, 0
    v_dot2_f32_bf16 v52, v26, v74, 0
    v_dot2_f32_bf16 v55, v27, v72, 0
    v_dot2_f32_bf16 v54, v27, v74, 0
    s_waitcnt vmcnt(5)
    v_dot2c_f32_bf16 v49, v28, v73
    v_dot2c_f32_bf16 v48, v28, v75
    v_dot2c_f32_bf16 v51, v29, v73
    v_dot2c_f32_bf16 v50, v29, v75
    v_dot2c_f32_bf16 v53, v30, v73
    v_dot2c_f32_bf16 v52, v30, v75
    v_dot2c_f32_bf16 v55, v31, v73
    v_dot2c_f32_bf16 v54, v31, v75
    s_nop 0
    v_permlane32_swap_b32 v48, v52
    v_permlane32_swap_b32 v49, v53
    v_permlane32_swap_b32 v50, v54
    v_permlane32_swap_b32 v51, v55
    v_add_f32 v48, v48, v52
    v_add_f32 v49, v49, v53
    v_add_f32 v50, v50, v54
    v_add_f32 v51, v51, v55
    s_nop 0
    v_permlane16_swap_b32 v48, v50
    v_permlane16_swap_b32 v49, v51
    v_add_f32 v48, v48, v50
    v_add_f32 v49, v49, v51
    s_nop 0
    v_add_f32_dpp v48, v48, v48 row_ror:8 row_mask:0xf bank_mask:0xf
    v_add_f32_dpp v49, v49, v49 row_ror:8 row_mask:0xf bank_mask:0xf
    v_and_b32 v16, 7, v1
    v_lshlrev_b32 v16, 5, v16
    v_lshrrev_b32 v17, 4, v1
    v_lshl_add_u32 v16, v17, 3, v16
    s_lshl_b32 s16, s3, 8
    s_add_u32 s16, s16, 147456
    v_add_u32 v16, s16, v16
    ds_write_b64 v16, v[48:49]
    s_waitcnt vmcnt(4)
    v_cmp_eq_u32 vcc, 0, v134
    s_cmp_eq_u32 s3, 0
    s_cselect_b64 s[62:63], -1, 0
    s_and_b64 vcc, vcc, s[62:63]
    s_cbranch_vccnz adaLN_cond__sliding_block_cached__moe_arch_mod__prompt_kernel_n1r
adaLN_cond__sliding_block_cached__moe_arch_mod__prompt_kernel_n1b:
    v_mov_b32 v19, 149504
    s_cmp_eq_u32 s3, 0
    s_cselect_b64 exec, 1, 0
    ds_write_b32 v19, v134
    s_mov_b64 exec, -1
    v_mov_b32 v19, 149504
    v_and_b32 v17, 31, v1
    v_lshlrev_b32 v18, 3, v17
    v_add_u32 v18, 147456, v18
    v_lshlrev_b32 v17, 4, v17
    s_waitcnt lgkmcnt(0)
    s_barrier
    ds_read_b32 v134, v19
    ds_read_b64 v[96:97], v18 offset:0
    ds_read_b64 v[100:101], v18 offset:256
    ds_read_b64 v[104:105], v18 offset:512
    ds_read_b64 v[108:109], v18 offset:768
    ds_read_b64 v[112:113], v18 offset:1024
    ds_read_b64 v[116:117], v18 offset:1280
    ds_read_b64 v[120:121], v18 offset:1536
    ds_read_b64 v[124:125], v18 offset:1792
    s_waitcnt lgkmcnt(8)
    v_readfirstlane_b32 s28, v134
    v_and_b32 v20, 7, v1
    v_lshlrev_b32 v20, 4, v20
    v_add_u32 v21, 149520, v20
    ds_read_b128 v[128:131], v21
    s_waitcnt lgkmcnt(0)
    v_mov_b32 v131, s28
    s_lshl_b32 s16, s2, 7
    s_add_u32 s16, s16, 0x520000
    s_cmp_eq_u32 s3, 0
    s_cselect_b32 s16, s16, 0x7ffffff0
    s_mov_b64 exec, 0xff
    buffer_store_dwordx4 v[128:131], v20, s[8:11], s16 offen sc1
    s_mov_b64 exec, -1
    v_pk_add_f32 v[96:97], v[96:97], v[112:113]
    v_pk_add_f32 v[100:101], v[100:101], v[116:117]
    v_pk_add_f32 v[104:105], v[104:105], v[120:121]
    v_pk_add_f32 v[108:109], v[108:109], v[124:125]
    v_pk_add_f32 v[96:97], v[96:97], v[104:105]
    v_pk_add_f32 v[100:101], v[100:101], v[108:109]
    v_pk_add_f32 v[96:97], v[96:97], v[100:101]
    v_mov_b32 v98, s28
    v_mov_b32 v99, s28
    s_lshl_b32 s16, s14, 3
    s_add_u32 s16, s16, s15
    s_lshl_b32 s16, s16, 9
    s_add_u32 s16, s16, 0x500000
    s_cmp_eq_u32 s3, 0
    s_cselect_b32 s16, s16, 0x7ffffff0
    s_mov_b64 exec, 0xffffffff
    buffer_store_dwordx4 v[96:99], v17, s[8:11], s16 offen sc1
    s_mov_b64 exec, -1
    s_lshr_b32 s16, s3, 2
    s_lshl_b32 s16, s16, 4
    s_add_u32 s16, s16, s31
    s_lshl_b32 s16, s16, 12
    s_and_b32 s17, s3, 3
    s_lshl_b32 s17, s17, 7
    s_add_u32 s16, s16, s17
    s_add_u32 s16, s16, 0x500000
    v_lshrrev_b32 v139, 3, v1
    v_lshlrev_b32 v139, 9, v139
    v_and_b32 v16, 7, v1
    v_lshl_add_u32 v139, v16, 4, v139
    v_and_b32 v140, 15, v1
    v_lshlrev_b32 v140, 4, v140
    s_lshl_b32 s17, s29, 8
    s_add_u32 s17, s17, 0x520000
    s_waitcnt vmcnt(4)
    v_lshlrev_b32 v56, 16, v40
    v_and_b32 v57, 0xffff0000, v40
    v_lshlrev_b32 v58, 16, v41
    v_and_b32 v59, 0xffff0000, v41
    v_lshlrev_b32 v60, 16, v42
    v_and_b32 v61, 0xffff0000, v42
    v_lshlrev_b32 v62, 16, v43
    v_and_b32 v63, 0xffff0000, v43
    s_waitcnt vmcnt(3)
    v_lshlrev_b32 v64, 16, v44
    v_and_b32 v65, 0xffff0000, v44
    v_lshlrev_b32 v66, 16, v45
    v_and_b32 v67, 0xffff0000, v45
    v_lshlrev_b32 v68, 16, v46
    v_and_b32 v69, 0xffff0000, v46
    v_lshlrev_b32 v70, 16, v47
    v_and_b32 v71, 0xffff0000, v47
    s_mov_b32 s27, 0
adaLN_cond__sliding_block_cached__moe_arch_mod__prompt_kernel_g2p:
    buffer_load_dwordx4 v[76:79], v139, s[8:11], s16 offen sc1
    buffer_load_dwordx4 v[80:83], v140, s[8:11], s17 offen sc1
    s_waitcnt vmcnt(1)
    v_cmp_ne_u32 vcc, s28, v78
    v_cmp_ne_u32 s[62:63], s28, v79
    s_or_b64 vcc, vcc, s[62:63]
    s_waitcnt vmcnt(0)
    v_cmp_ne_u32 s[62:63], s28, v83
    s_or_b64 vcc, vcc, s[62:63]
    s_add_u32 s27, s27, 1
    s_cmp_ge_u32 s27, 65536
    s_cbranch_scc1 adaLN_cond__sliding_block_cached__moe_arch_mod__prompt_kernel_g2g
    s_cbranch_vccnz adaLN_cond__sliding_block_cached__moe_arch_mod__prompt_kernel_g2p
adaLN_cond__sliding_block_cached__moe_arch_mod__prompt_kernel_g2g:
    v_add_f32_dpp v76, v76, v76 row_ror:8 row_mask:0xf bank_mask:0xf
    v_add_f32_dpp v77, v77, v77 row_ror:8 row_mask:0xf bank_mask:0xf
    v_mov_b32 v17, v76
    s_nop 1
    v_permlane16_swap_b32 v76, v17
    v_add_f32 v76, v76, v17
    v_mov_b32 v18, v77
    s_nop 1
    v_permlane16_swap_b32 v77, v18
    v_add_f32 v77, v77, v18
    v_mov_b32 v17, v76
    s_nop 1
    v_permlane32_swap_b32 v76, v17
    v_add_f32 v76, v76, v17
    v_mov_b32 v18, v77
    s_nop 1
    v_permlane32_swap_b32 v77, v18
    v_add_f32 v77, v77, v18
    v_cvt_pk_bf16_f32 v17, v76, v77
    v_lshlrev_b32 v76, 16, v17
    v_and_b32 v77, 0xffff0000, v17
    v_add_f32 v76, 0, v76
    v_add_f32 v77, 0, v77
    s_lshl_b32 s16, s3, 6
    s_add_u32 s16, s16, 151552
    v_lshl_add_u32 v16, v16, 3, s16
    ds_write_b64 v16, v[76:77]
    v_lshrrev_b32 v17, 4, v1
    v_lshlrev_b32 v17, 5, v17
    v_add_u32 v17, 151552, v17
    v_sub_f32 v56, v56, v80
    v_sub_f32 v57, v57, v80
    v_sub_f32 v58, v58, v80
    v_sub_f32 v59, v59, v80
    v_sub_f32 v60, v60, v80
    v_sub_f32 v61, v61, v80
    v_sub_f32 v62, v62, v80
    v_sub_f32 v63, v63, v80
    v_sub_f32 v64, v64, v80
    v_sub_f32 v65, v65, v80
    v_sub_f32 v66, v66, v80
    v_sub_f32 v67, v67, v80
    v_sub_f32 v68, v68, v80
    v_sub_f32 v69, v69, v80
    v_sub_f32 v70, v70, v80
    v_sub_f32 v71, v71, v80
    v_cvt_pk_bf16_f32 v18, v56, v57
    v_lshlrev_b32 v56, 16, v18
    v_and_b32 v57, 0xffff0000, v18
    v_cvt_pk_bf16_f32 v19, v58, v59
    v_lshlrev_b32 v58, 16, v19
    v_and_b32 v59, 0xffff0000, v19
    v_cvt_pk_bf16_f32 v18, v60, v61
    v_lshlrev_b32 v60, 16, v18
    v_and_b32 v61, 0xffff0000, v18
    v_cvt_pk_bf16_f32 v19, v62, v63
    v_lshlrev_b32 v62, 16, v19
    v_and_b32 v63, 0xffff0000, v19
    v_cvt_pk_bf16_f32 v18, v64, v65
    v_lshlrev_b32 v64, 16, v18
    v_and_b32 v65, 0xffff0000, v18
    v_cvt_pk_bf16_f32 v19, v66, v67
    v_lshlrev_b32 v66, 16, v19
    v_and_b32 v67, 0xffff0000, v19
    v_cvt_pk_bf16_f32 v18, v68, v69
    v_lshlrev_b32 v68, 16, v18
    v_and_b32 v69, 0xffff0000, v18
    v_cvt_pk_bf16_f32 v19, v70, v71
    v_lshlrev_b32 v70, 16, v19
    v_and_b32 v71, 0xffff0000, v19
    v_mul_f32 v56, v56, v82
    v_mul_f32 v57, v57, v82
    v_mul_f32 v58, v58, v82
    v_mul_f32 v59, v59, v82
    v_mul_f32 v60, v60, v82
    v_mul_f32 v61, v61, v82
    v_mul_f32 v62, v62, v82
    v_mul_f32 v63, v63, v82
    v_mul_f32 v64, v64, v82
    v_mul_f32 v65, v65, v82
    v_mul_f32 v66, v66, v82
    v_mul_f32 v67, v67, v82
    v_mul_f32 v68, v68, v82
    v_mul_f32 v69, v69, v82
    v_mul_f32 v70, v70, v82
    v_mul_f32 v71, v71, v82
    v_cvt_pk_bf16_f32 v18, v56, v57
    v_lshlrev_b32 v56, 16, v18
    v_and_b32 v57, 0xffff0000, v18
    v_cvt_pk_bf16_f32 v19, v58, v59
    v_lshlrev_b32 v58, 16, v19
    v_and_b32 v59, 0xffff0000, v19
    v_cvt_pk_bf16_f32 v18, v60, v61
    v_lshlrev_b32 v60, 16, v18
    v_and_b32 v61, 0xffff0000, v18
    v_cvt_pk_bf16_f32 v19, v62, v63
    v_lshlrev_b32 v62, 16, v19
    v_and_b32 v63, 0xffff0000, v19
    v_cvt_pk_bf16_f32 v18, v64, v65
    v_lshlrev_b32 v64, 16, v18
    v_and_b32 v65, 0xffff0000, v18
    v_cvt_pk_bf16_f32 v19, v66, v67
    v_lshlrev_b32 v66, 16, v19
    v_and_b32 v67, 0xffff0000, v19
    v_cvt_pk_bf16_f32 v18, v68, v69
    v_lshlrev_b32 v68, 16, v18
    v_and_b32 v69, 0xffff0000, v18
    v_cvt_pk_bf16_f32 v19, v70, v71
    v_lshlrev_b32 v70, 16, v19
    v_and_b32 v71, 0xffff0000, v19
    s_lshl_b32 s16, s29, 15
    s_lshl_b32 s17, s31, 11
    s_add_u32 s16, s16, s17
    s_waitcnt lgkmcnt(0)
    s_barrier
    ds_read_b128 v[96:99], v17 offset:256
    ds_read_b128 v[104:107], v17 offset:0
    ds_read_b128 v[100:103], v17 offset:272
    ds_read_b128 v[108:111], v17 offset:16
    ds_read_b128 v[112:115], v17 offset:384
    ds_read_b128 v[120:123], v17 offset:128
    ds_read_b128 v[116:119], v17 offset:400
    ds_read_b128 v[124:127], v17 offset:144
    s_waitcnt lgkmcnt(7)
    v_pk_mul_f32 v[56:57], v[56:57], v[96:97]
    v_pk_mul_f32 v[58:59], v[58:59], v[98:99]
    s_waitcnt lgkmcnt(5)
    v_pk_mul_f32 v[60:61], v[60:61], v[100:101]
    v_pk_mul_f32 v[62:63], v[62:63], v[102:103]
    v_cvt_pk_bf16_f32 v18, v56, v57
    v_lshlrev_b32 v56, 16, v18
    v_and_b32 v57, 0xffff0000, v18
    v_cvt_pk_bf16_f32 v19, v58, v59
    v_lshlrev_b32 v58, 16, v19
    v_and_b32 v59, 0xffff0000, v19
    v_cvt_pk_bf16_f32 v18, v60, v61
    v_lshlrev_b32 v60, 16, v18
    v_and_b32 v61, 0xffff0000, v18
    v_cvt_pk_bf16_f32 v19, v62, v63
    v_lshlrev_b32 v62, 16, v19
    v_and_b32 v63, 0xffff0000, v19
    v_pk_add_f32 v[56:57], v[56:57], v[104:105]
    v_pk_add_f32 v[58:59], v[58:59], v[106:107]
    s_waitcnt lgkmcnt(4)
    v_pk_add_f32 v[60:61], v[60:61], v[108:109]
    v_pk_add_f32 v[62:63], v[62:63], v[110:111]
    v_cvt_pk_bf16_f32 v32, v56, v57
    v_cvt_pk_bf16_f32 v33, v58, v59
    v_cvt_pk_bf16_f32 v34, v60, v61
    v_cvt_pk_bf16_f32 v35, v62, v63
    buffer_store_dwordx4 v[32:35], v2, s[8:11], s16 offen offset:0 sc1
    s_waitcnt lgkmcnt(3)
    v_pk_mul_f32 v[64:65], v[64:65], v[112:113]
    v_pk_mul_f32 v[66:67], v[66:67], v[114:115]
    s_waitcnt lgkmcnt(1)
    v_pk_mul_f32 v[68:69], v[68:69], v[116:117]
    v_pk_mul_f32 v[70:71], v[70:71], v[118:119]
    v_cvt_pk_bf16_f32 v18, v64, v65
    v_lshlrev_b32 v64, 16, v18
    v_and_b32 v65, 0xffff0000, v18
    v_cvt_pk_bf16_f32 v19, v66, v67
    v_lshlrev_b32 v66, 16, v19
    v_and_b32 v67, 0xffff0000, v19
    v_cvt_pk_bf16_f32 v18, v68, v69
    v_lshlrev_b32 v68, 16, v18
    v_and_b32 v69, 0xffff0000, v18
    v_cvt_pk_bf16_f32 v19, v70, v71
    v_lshlrev_b32 v70, 16, v19
    v_and_b32 v71, 0xffff0000, v19
    v_pk_add_f32 v[64:65], v[64:65], v[120:121]
    v_pk_add_f32 v[66:67], v[66:67], v[122:123]
    s_waitcnt lgkmcnt(0)
    v_pk_add_f32 v[68:69], v[68:69], v[124:125]
    v_pk_add_f32 v[70:71], v[70:71], v[126:127]
    v_cvt_pk_bf16_f32 v36, v64, v65
    v_cvt_pk_bf16_f32 v37, v66, v67
    v_cvt_pk_bf16_f32 v38, v68, v69
    v_cvt_pk_bf16_f32 v39, v70, v71
    buffer_store_dwordx4 v[36:39], v2, s[8:11], s16 offen offset:1024 sc1
    s_lshl_b32 s19, s3, 16
    s_lshl_b32 s20, s3, 11
    s_lshl_b32 s16, s12, 8
    s_add_u32 s4, s38, s16
    s_addc_u32 s5, s39, 0
    s_sub_u32 s6, 0x800000, s16
    s_mov_b32 s7, 0x20000
    s_barrier
    s_add_u32 s22, s19, 0x0
    s_add_u32 m0, s20, 0x0
    s_nop 0
    buffer_load_dwordx4 v3, s[4:7], s22 offen lds
    s_add_u32 s22, s19, 0x8000
    s_add_u32 m0, s20, 0x400
    s_nop 0
    buffer_load_dwordx4 v3, s[4:7], s22 offen lds
    s_add_u32 s22, s19, 0x80000
    s_add_u32 m0, s20, 0x4000
    s_nop 0
    buffer_load_dwordx4 v3, s[4:7], s22 offen lds
    s_add_u32 s22, s19, 0x88000
    s_add_u32 m0, s20, 0x4400
    s_nop 0
    buffer_load_dwordx4 v3, s[4:7], s22 offen lds
    s_add_u32 s22, s19, 0x100000
    s_add_u32 m0, s20, 0x8000
    s_nop 0
    buffer_load_dwordx4 v3, s[4:7], s22 offen lds
    s_add_u32 s22, s19, 0x108000
    s_add_u32 m0, s20, 0x8400
    s_nop 0
    buffer_load_dwordx4 v3, s[4:7], s22 offen lds
    v_mov_b32 v134, s28
    s_lshl_b32 s16, s29, 4
    s_add_u32 s16, s16, s31
    s_lshl_b32 s16, s16, 2
    s_add_u32 s16, s16, 0x528000
    v_and_b32 v16, 31, v1
    v_lshlrev_b32 v16, 2, v16
    s_lshl_b32 s17, s13, 3
    s_add_u32 s17, s17, s3
    s_lshl_b32 s17, s17, 7
    s_add_u32 s17, s17, 0x528000
    s_waitcnt vmcnt(6)
    s_mov_b64 exec, 1
    buffer_store_dword v134, v132, s[8:11], s16 offen sc1
    s_mov_b64 exec, -1
    s_waitcnt vmcnt(0)
    s_mov_b32 s27, 0
adaLN_cond__sliding_block_cached__moe_arch_mod__prompt_kernel_h3p:
    buffer_load_dword v17, v16, s[8:11], s17 offen sc1
    s_waitcnt vmcnt(0)
    v_cmp_ne_u32 vcc, s28, v17
    s_add_u32 s27, s27, 1
    s_cmp_ge_u32 s27, 65536
    s_cbranch_scc1 adaLN_cond__sliding_block_cached__moe_arch_mod__prompt_kernel_h3g
    s_cbranch_vccnz adaLN_cond__sliding_block_cached__moe_arch_mod__prompt_kernel_h3p
adaLN_cond__sliding_block_cached__moe_arch_mod__prompt_kernel_h3g:
    s_mov_b32 s23, 0x0
    buffer_load_dwordx4 v[88:91], v7, s[8:11], s23 offen offset:0 sc1
    s_mov_b32 s23, 0x8000
    buffer_load_dwordx4 v[92:95], v7, s[8:11], s23 offen offset:0 sc1
    s_mov_b32 s23, 0x0
    buffer_load_dwordx4 v[96:99], v7, s[8:11], s23 offen offset:1024 sc1
    s_mov_b32 s23, 0x8000
    buffer_load_dwordx4 v[100:103], v7, s[8:11], s23 offen offset:1024 sc1
    s_mov_b32 s23, 0x800
    buffer_load_dwordx4 v[104:107], v7, s[8:11], s23 offen offset:0 sc1
    s_mov_b32 s23, 0x8800
    buffer_load_dwordx4 v[108:111], v7, s[8:11], s23 offen offset:0 sc1
    s_mov_b32 s23, 0x800
    buffer_load_dwordx4 v[112:115], v7, s[8:11], s23 offen offset:1024 sc1
    s_mov_b32 s23, 0x8800
    buffer_load_dwordx4 v[116:119], v7, s[8:11], s23 offen offset:1024 sc1
    s_lshr_b32 s21, s12, 3
    s_lshl_b32 s21, s21, 17
    s_add_u32 s21, s21, s20
    s_add_u32 s21, s21, 0x400000
    s_barrier
    ds_read_b64_tr_b16 v[224:225], v4 offset:0
    ds_read_b64_tr_b16 v[226:227], v4 offset:1024
    ds_read_b64_tr_b16 v[228:229], v5 offset:32
    ds_read_b64_tr_b16 v[230:231], v5 offset:1056
    ds_read_b64_tr_b16 v[232:233], v4 offset:256
    ds_read_b64_tr_b16 v[234:235], v4 offset:1280
    s_waitcnt vmcnt(7) lgkmcnt(4)
    v_mfma_f32_16x16x32_bf16 v[24:27], v[224:227], v[88:91], 0
    ds_read_b64_tr_b16 v[236:237], v5 offset:288
    s_waitcnt vmcnt(6)
    v_mfma_f32_16x16x32_bf16 v[28:31], v[224:227], v[92:95], 0
    ds_read_b64_tr_b16 v[238:239], v5 offset:1312
    s_waitcnt lgkmcnt(4)
    v_mfma_f32_16x16x32_bf16 v[32:35], v[228:231], v[88:91], 0
    ds_read_b64_tr_b16 v[240:241], v4 offset:512
    v_mfma_f32_16x16x32_bf16 v[36:39], v[228:231], v[92:95], 0
    ds_read_b64_tr_b16 v[242:243], v4 offset:1536
    s_mov_b32 s23, 0x1000
    buffer_load_dwordx4 v[120:123], v7, s[8:11], s23 offen offset:0 sc1
    s_waitcnt lgkmcnt(4)
    v_mfma_f32_16x16x32_bf16 v[40:43], v[232:235], v[88:91], 0
    ds_read_b64_tr_b16 v[244:245], v5 offset:544
    v_mfma_f32_16x16x32_bf16 v[44:47], v[232:235], v[92:95], 0
    ds_read_b64_tr_b16 v[246:247], v5 offset:1568
    s_waitcnt lgkmcnt(4)
    v_mfma_f32_16x16x32_bf16 v[48:51], v[236:239], v[88:91], 0
    ds_read_b64_tr_b16 v[224:225], v4 offset:768
    v_mfma_f32_16x16x32_bf16 v[52:55], v[236:239], v[92:95], 0
    ds_read_b64_tr_b16 v[226:227], v4 offset:1792
    s_waitcnt lgkmcnt(4)
    v_mfma_f32_16x16x32_bf16 v[56:59], v[240:243], v[88:91], 0
    ds_read_b64_tr_b16 v[228:229], v5 offset:800
    v_mfma_f32_16x16x32_bf16 v[60:63], v[240:243], v[92:95], 0
    ds_read_b64_tr_b16 v[230:231], v5 offset:1824
    s_waitcnt lgkmcnt(4)
    v_mfma_f32_16x16x32_bf16 v[64:67], v[244:247], v[88:91], 0
    ds_read_b64_tr_b16 v[232:233], v4 offset:8192
    v_mfma_f32_16x16x32_bf16 v[68:71], v[244:247], v[92:95], 0
    ds_read_b64_tr_b16 v[234:235], v4 offset:9216
    s_mov_b32 s23, 0x9000
    buffer_load_dwordx4 v[124:127], v7, s[8:11], s23 offen offset:0 sc1
    s_waitcnt lgkmcnt(4)
    v_mfma_f32_16x16x32_bf16 v[72:75], v[224:227], v[88:91], 0
    ds_read_b64_tr_b16 v[236:237], v5 offset:8224
    v_mfma_f32_16x16x32_bf16 v[76:79], v[224:227], v[92:95], 0
    ds_read_b64_tr_b16 v[238:239], v5 offset:9248
    s_waitcnt lgkmcnt(4)
    v_mfma_f32_16x16x32_bf16 v[80:83], v[228:231], v[88:91], 0
    ds_read_b64_tr_b16 v[240:241], v4 offset:8448
    v_mfma_f32_16x16x32_bf16 v[84:87], v[228:231], v[92:95], 0
    ds_read_b64_tr_b16 v[242:243], v4 offset:9472
    s_waitcnt vmcnt(7) lgkmcnt(4)
    v_mfma_f32_16x16x32_bf16 v[24:27], v[232:235], v[96:99], v[24:27]
    ds_read_b64_tr_b16 v[244:245], v5 offset:8480
    s_waitcnt vmcnt(6)
    v_mfma_f32_16x16x32_bf16 v[28:31], v[232:235], v[100:103], v[28:31]
    ds_read_b64_tr_b16 v[246:247], v5 offset:9504
    s_waitcnt lgkmcnt(4)
    v_mfma_f32_16x16x32_bf16 v[32:35], v[236:239], v[96:99], v[32:35]
    ds_read_b64_tr_b16 v[224:225], v4 offset:8704
    v_mfma_f32_16x16x32_bf16 v[36:39], v[236:239], v[100:103], v[36:39]
    ds_read_b64_tr_b16 v[226:227], v4 offset:9728
    s_mov_b32 s23, 0x1000
    buffer_load_dwordx4 v[128:131], v7, s[8:11], s23 offen offset:1024 sc1
    s_waitcnt lgkmcnt(4)
    v_mfma_f32_16x16x32_bf16 v[40:43], v[240:243], v[96:99], v[40:43]
    ds_read_b64_tr_b16 v[228:229], v5 offset:8736
    v_mfma_f32_16x16x32_bf16 v[44:47], v[240:243], v[100:103], v[44:47]
    ds_read_b64_tr_b16 v[230:231], v5 offset:9760
    s_waitcnt lgkmcnt(4)
    v_mfma_f32_16x16x32_bf16 v[48:51], v[244:247], v[96:99], v[48:51]
    ds_read_b64_tr_b16 v[232:233], v4 offset:8960
    v_mfma_f32_16x16x32_bf16 v[52:55], v[244:247], v[100:103], v[52:55]
    ds_read_b64_tr_b16 v[234:235], v4 offset:9984
    s_waitcnt lgkmcnt(4)
    v_mfma_f32_16x16x32_bf16 v[56:59], v[224:227], v[96:99], v[56:59]
    ds_read_b64_tr_b16 v[236:237], v5 offset:8992
    v_mfma_f32_16x16x32_bf16 v[60:63], v[224:227], v[100:103], v[60:63]
    ds_read_b64_tr_b16 v[238:239], v5 offset:10016
    s_waitcnt lgkmcnt(4)
    v_mfma_f32_16x16x32_bf16 v[64:67], v[228:231], v[96:99], v[64:67]
    v_mfma_f32_16x16x32_bf16 v[68:71], v[228:231], v[100:103], v[68:71]
    s_barrier
    ds_read_b64_tr_b16 v[240:241], v4 offset:16384
    ds_read_b64_tr_b16 v[242:243], v4 offset:17408
    s_mov_b32 s23, 0x9000
    buffer_load_dwordx4 v[132:135], v7, s[8:11], s23 offen offset:1024 sc1
    s_waitcnt lgkmcnt(4)
    v_mfma_f32_16x16x32_bf16 v[72:75], v[232:235], v[96:99], v[72:75]
    ds_read_b64_tr_b16 v[244:245], v5 offset:16416
    v_mfma_f32_16x16x32_bf16 v[76:79], v[232:235], v[100:103], v[76:79]
    s_add_u32 s22, s19, 0x180000
    s_add_u32 m0, s20, 0xc000
    s_nop 0
    buffer_load_dwordx4 v3, s[4:7], s22 offen lds
    ds_read_b64_tr_b16 v[246:247], v5 offset:17440
    s_waitcnt lgkmcnt(4)
    v_mfma_f32_16x16x32_bf16 v[80:83], v[236:239], v[96:99], v[80:83]
    ds_read_b64_tr_b16 v[224:225], v4 offset:16640
    v_mfma_f32_16x16x32_bf16 v[84:87], v[236:239], v[100:103], v[84:87]
    ds_read_b64_tr_b16 v[226:227], v4 offset:17664
    s_waitcnt vmcnt(8) lgkmcnt(4)
    v_mfma_f32_16x16x32_bf16 v[24:27], v[240:243], v[104:107], v[24:27]
    ds_read_b64_tr_b16 v[228:229], v5 offset:16672
    s_waitcnt vmcnt(7)
    v_mfma_f32_16x16x32_bf16 v[28:31], v[240:243], v[108:111], v[28:31]
    ds_read_b64_tr_b16 v[230:231], v5 offset:17696
    s_waitcnt lgkmcnt(4)
    v_mfma_f32_16x16x32_bf16 v[32:35], v[244:247], v[104:107], v[32:35]
    ds_read_b64_tr_b16 v[232:233], v4 offset:16896
    v_mfma_f32_16x16x32_bf16 v[36:39], v[244:247], v[108:111], v[36:39]
    ds_read_b64_tr_b16 v[234:235], v4 offset:17920
    s_mov_b32 s23, 0x1800
    buffer_load_dwordx4 v[88:91], v7, s[8:11], s23 offen offset:0 sc1
    s_waitcnt lgkmcnt(4)
    v_mfma_f32_16x16x32_bf16 v[40:43], v[224:227], v[104:107], v[40:43]
    ds_read_b64_tr_b16 v[236:237], v5 offset:16928
    v_mfma_f32_16x16x32_bf16 v[44:47], v[224:227], v[108:111], v[44:47]
    s_add_u32 s22, s19, 0x188000
    s_add_u32 m0, s20, 0xc400
    s_nop 0
    buffer_load_dwordx4 v3, s[4:7], s22 offen lds
    ds_read_b64_tr_b16 v[238:239], v5 offset:17952
    s_waitcnt lgkmcnt(4)
    v_mfma_f32_16x16x32_bf16 v[48:51], v[228:231], v[104:107], v[48:51]
    ds_read_b64_tr_b16 v[240:241], v4 offset:17152
    v_mfma_f32_16x16x32_bf16 v[52:55], v[228:231], v[108:111], v[52:55]
    ds_read_b64_tr_b16 v[242:243], v4 offset:18176
    s_waitcnt lgkmcnt(4)
    v_mfma_f32_16x16x32_bf16 v[56:59], v[232:235], v[104:107], v[56:59]
    ds_read_b64_tr_b16 v[244:245], v5 offset:17184
    v_mfma_f32_16x16x32_bf16 v[60:63], v[232:235], v[108:111], v[60:63]
    ds_read_b64_tr_b16 v[246:247], v5 offset:18208
    s_waitcnt lgkmcnt(4)
    v_mfma_f32_16x16x32_bf16 v[64:67], v[236:239], v[104:107], v[64:67]
    ds_read_b64_tr_b16 v[224:225], v4 offset:24576
    v_mfma_f32_16x16x32_bf16 v[68:71], v[236:239], v[108:111], v[68:71]
    ds_read_b64_tr_b16 v[226:227], v4 offset:25600
    s_mov_b32 s23, 0x9800
    buffer_load_dwordx4 v[92:95], v7, s[8:11], s23 offen offset:0 sc1
    s_waitcnt lgkmcnt(4)
    v_mfma_f32_16x16x32_bf16 v[72:75], v[240:243], v[104:107], v[72:75]
    ds_read_b64_tr_b16 v[228:229], v5 offset:24608
    v_mfma_f32_16x16x32_bf16 v[76:79], v[240:243], v[108:111], v[76:79]
    ds_read_b64_tr_b16 v[230:231], v5 offset:25632
    s_waitcnt lgkmcnt(4)
    v_mfma_f32_16x16x32_bf16 v[80:83], v[244:247], v[104:107], v[80:83]
    ds_read_b64_tr_b16 v[232:233], v4 offset:24832
    v_mfma_f32_16x16x32_bf16 v[84:87], v[244:247], v[108:111], v[84:87]
    ds_read_b64_tr_b16 v[234:235], v4 offset:25856
    s_waitcnt vmcnt(9) lgkmcnt(4)
    v_mfma_f32_16x16x32_bf16 v[24:27], v[224:227], v[112:115], v[24:27]
    ds_read_b64_tr_b16 v[236:237], v5 offset:24864
    s_waitcnt vmcnt(8)
    v_mfma_f32_16x16x32_bf16 v[28:31], v[224:227], v[116:119], v[28:31]
    ds_read_b64_tr_b16 v[238:239], v5 offset:25888
    s_waitcnt lgkmcnt(4)
    v_mfma_f32_16x16x32_bf16 v[32:35], v[228:231], v[112:115], v[32:35]
    ds_read_b64_tr_b16 v[240:241], v4 offset:25088
    v_mfma_f32_16x16x32_bf16 v[36:39], v[228:231], v[116:119], v[36:39]
    ds_read_b64_tr_b16 v[242:243], v4 offset:26112
    s_mov_b32 s23, 0x1800
    buffer_load_dwordx4 v[96:99], v7, s[8:11], s23 offen offset:1024 sc1
    s_waitcnt lgkmcnt(4)
    v_mfma_f32_16x16x32_bf16 v[40:43], v[232:235], v[112:115], v[40:43]
    ds_read_b64_tr_b16 v[244:245], v5 offset:25120
    v_mfma_f32_16x16x32_bf16 v[44:47], v[232:235], v[116:119], v[44:47]
    ds_read_b64_tr_b16 v[246:247], v5 offset:26144
    s_waitcnt lgkmcnt(4)
    v_mfma_f32_16x16x32_bf16 v[48:51], v[236:239], v[112:115], v[48:51]
    ds_read_b64_tr_b16 v[224:225], v4 offset:25344
    v_mfma_f32_16x16x32_bf16 v[52:55], v[236:239], v[116:119], v[52:55]
    ds_read_b64_tr_b16 v[226:227], v4 offset:26368
    s_waitcnt lgkmcnt(4)
    v_mfma_f32_16x16x32_bf16 v[56:59], v[240:243], v[112:115], v[56:59]
    ds_read_b64_tr_b16 v[228:229], v5 offset:25376
    v_mfma_f32_16x16x32_bf16 v[60:63], v[240:243], v[116:119], v[60:63]
    ds_read_b64_tr_b16 v[230:231], v5 offset:26400
    s_waitcnt lgkmcnt(4)
    v_mfma_f32_16x16x32_bf16 v[64:67], v[244:247], v[112:115], v[64:67]
    v_mfma_f32_16x16x32_bf16 v[68:71], v[244:247], v[116:119], v[68:71]
    s_barrier
    ds_read_b64_tr_b16 v[232:233], v4 offset:32768
    ds_read_b64_tr_b16 v[234:235], v4 offset:33792
    s_mov_b32 s23, 0x9800
    buffer_load_dwordx4 v[100:103], v7, s[8:11], s23 offen offset:1024 sc1
    s_waitcnt lgkmcnt(4)
    v_mfma_f32_16x16x32_bf16 v[72:75], v[224:227], v[112:115], v[72:75]
    ds_read_b64_tr_b16 v[236:237], v5 offset:32800
    v_mfma_f32_16x16x32_bf16 v[76:79], v[224:227], v[116:119], v[76:79]
    s_add_u32 s22, s19, 0x200000
    s_add_u32 m0, s20, 0x0
    s_nop 0
    buffer_load_dwordx4 v3, s[4:7], s22 offen lds
    ds_read_b64_tr_b16 v[238:239], v5 offset:33824
    s_waitcnt lgkmcnt(4)
    v_mfma_f32_16x16x32_bf16 v[80:83], v[228:231], v[112:115], v[80:83]
    ds_read_b64_tr_b16 v[240:241], v4 offset:33024
    v_mfma_f32_16x16x32_bf16 v[84:87], v[228:231], v[116:119], v[84:87]
    ds_read_b64_tr_b16 v[242:243], v4 offset:34048
    s_waitcnt vmcnt(10) lgkmcnt(4)
    v_mfma_f32_16x16x32_bf16 v[24:27], v[232:235], v[120:123], v[24:27]
    ds_read_b64_tr_b16 v[244:245], v5 offset:33056
    s_waitcnt vmcnt(9)
    v_mfma_f32_16x16x32_bf16 v[28:31], v[232:235], v[124:127], v[28:31]
    ds_read_b64_tr_b16 v[246:247], v5 offset:34080
    s_waitcnt lgkmcnt(4)
    v_mfma_f32_16x16x32_bf16 v[32:35], v[236:239], v[120:123], v[32:35]
    ds_read_b64_tr_b16 v[224:225], v4 offset:33280
    v_mfma_f32_16x16x32_bf16 v[36:39], v[236:239], v[124:127], v[36:39]
    ds_read_b64_tr_b16 v[226:227], v4 offset:34304
    s_mov_b32 s23, 0x2000
    buffer_load_dwordx4 v[104:107], v7, s[8:11], s23 offen offset:0 sc1
    s_waitcnt lgkmcnt(4)
    v_mfma_f32_16x16x32_bf16 v[40:43], v[240:243], v[120:123], v[40:43]
    ds_read_b64_tr_b16 v[228:229], v5 offset:33312
    v_mfma_f32_16x16x32_bf16 v[44:47], v[240:243], v[124:127], v[44:47]
    s_add_u32 s22, s19, 0x208000
    s_add_u32 m0, s20, 0x400
    s_nop 0
    buffer_load_dwordx4 v3, s[4:7], s22 offen lds
    ds_read_b64_tr_b16 v[230:231], v5 offset:34336
    s_waitcnt lgkmcnt(4)
    v_mfma_f32_16x16x32_bf16 v[48:51], v[244:247], v[120:123], v[48:51]
    ds_read_b64_tr_b16 v[232:233], v4 offset:33536
    v_mfma_f32_16x16x32_bf16 v[52:55], v[244:247], v[124:127], v[52:55]
    ds_read_b64_tr_b16 v[234:235], v4 offset:34560
    s_waitcnt lgkmcnt(4)
    v_mfma_f32_16x16x32_bf16 v[56:59], v[224:227], v[120:123], v[56:59]
    ds_read_b64_tr_b16 v[236:237], v5 offset:33568
    v_mfma_f32_16x16x32_bf16 v[60:63], v[224:227], v[124:127], v[60:63]
    ds_read_b64_tr_b16 v[238:239], v5 offset:34592
    s_waitcnt lgkmcnt(4)
    v_mfma_f32_16x16x32_bf16 v[64:67], v[228:231], v[120:123], v[64:67]
    ds_read_b64_tr_b16 v[240:241], v4 offset:40960
    v_mfma_f32_16x16x32_bf16 v[68:71], v[228:231], v[124:127], v[68:71]
    ds_read_b64_tr_b16 v[242:243], v4 offset:41984
    s_mov_b32 s23, 0xa000
    buffer_load_dwordx4 v[108:111], v7, s[8:11], s23 offen offset:0 sc1
    s_waitcnt lgkmcnt(4)
    v_mfma_f32_16x16x32_bf16 v[72:75], v[232:235], v[120:123], v[72:75]
    ds_read_b64_tr_b16 v[244:245], v5 offset:40992
    v_mfma_f32_16x16x32_bf16 v[76:79], v[232:235], v[124:127], v[76:79]
    ds_read_b64_tr_b16 v[246:247], v5 offset:42016
    s_waitcnt lgkmcnt(4)
    v_mfma_f32_16x16x32_bf16 v[80:83], v[236:239], v[120:123], v[80:83]
    ds_read_b64_tr_b16 v[224:225], v4 offset:41216
    v_mfma_f32_16x16x32_bf16 v[84:87], v[236:239], v[124:127], v[84:87]
    ds_read_b64_tr_b16 v[226:227], v4 offset:42240
    s_waitcnt vmcnt(11) lgkmcnt(4)
    v_mfma_f32_16x16x32_bf16 v[24:27], v[240:243], v[128:131], v[24:27]
    ds_read_b64_tr_b16 v[228:229], v5 offset:41248
    s_waitcnt vmcnt(10)
    v_mfma_f32_16x16x32_bf16 v[28:31], v[240:243], v[132:135], v[28:31]
    ds_read_b64_tr_b16 v[230:231], v5 offset:42272
    s_waitcnt lgkmcnt(4)
    v_mfma_f32_16x16x32_bf16 v[32:35], v[244:247], v[128:131], v[32:35]
    ds_read_b64_tr_b16 v[232:233], v4 offset:41472
    v_mfma_f32_16x16x32_bf16 v[36:39], v[244:247], v[132:135], v[36:39]
    ds_read_b64_tr_b16 v[234:235], v4 offset:42496
    s_mov_b32 s23, 0x2000
    buffer_load_dwordx4 v[112:115], v7, s[8:11], s23 offen offset:1024 sc1
    s_waitcnt lgkmcnt(4)
    v_mfma_f32_16x16x32_bf16 v[40:43], v[224:227], v[128:131], v[40:43]
    ds_read_b64_tr_b16 v[236:237], v5 offset:41504
    v_mfma_f32_16x16x32_bf16 v[44:47], v[224:227], v[132:135], v[44:47]
    ds_read_b64_tr_b16 v[238:239], v5 offset:42528
    s_waitcnt lgkmcnt(4)
    v_mfma_f32_16x16x32_bf16 v[48:51], v[228:231], v[128:131], v[48:51]
    ds_read_b64_tr_b16 v[240:241], v4 offset:41728
    v_mfma_f32_16x16x32_bf16 v[52:55], v[228:231], v[132:135], v[52:55]
    ds_read_b64_tr_b16 v[242:243], v4 offset:42752
    s_waitcnt lgkmcnt(4)
    v_mfma_f32_16x16x32_bf16 v[56:59], v[232:235], v[128:131], v[56:59]
    ds_read_b64_tr_b16 v[244:245], v5 offset:41760
    v_mfma_f32_16x16x32_bf16 v[60:63], v[232:235], v[132:135], v[60:63]
    ds_read_b64_tr_b16 v[246:247], v5 offset:42784
    s_waitcnt lgkmcnt(4)
    v_mfma_f32_16x16x32_bf16 v[64:67], v[236:239], v[128:131], v[64:67]
    v_mfma_f32_16x16x32_bf16 v[68:71], v[236:239], v[132:135], v[68:71]
    s_waitcnt vmcnt(8)
    s_barrier
    ds_read_b64_tr_b16 v[224:225], v4 offset:49152
    ds_read_b64_tr_b16 v[226:227], v4 offset:50176
    s_mov_b32 s23, 0xa000
    buffer_load_dwordx4 v[116:119], v7, s[8:11], s23 offen offset:1024 sc1
    s_waitcnt lgkmcnt(4)
    v_mfma_f32_16x16x32_bf16 v[72:75], v[240:243], v[128:131], v[72:75]
    ds_read_b64_tr_b16 v[228:229], v5 offset:49184
    v_mfma_f32_16x16x32_bf16 v[76:79], v[240:243], v[132:135], v[76:79]
    s_add_u32 s22, s19, 0x280000
    s_add_u32 m0, s20, 0x4000
    s_nop 0
    buffer_load_dwordx4 v3, s[4:7], s22 offen lds
    ds_read_b64_tr_b16 v[230:231], v5 offset:50208
    s_waitcnt lgkmcnt(4)
    v_mfma_f32_16x16x32_bf16 v[80:83], v[244:247], v[128:131], v[80:83]
    ds_read_b64_tr_b16 v[232:233], v4 offset:49408
    v_mfma_f32_16x16x32_bf16 v[84:87], v[244:247], v[132:135], v[84:87]
    ds_read_b64_tr_b16 v[234:235], v4 offset:50432
    s_waitcnt lgkmcnt(4)
    v_mfma_f32_16x16x32_bf16 v[24:27], v[224:227], v[88:91], v[24:27]
    ds_read_b64_tr_b16 v[236:237], v5 offset:49440
    s_waitcnt vmcnt(9)
    v_mfma_f32_16x16x32_bf16 v[28:31], v[224:227], v[92:95], v[28:31]
    ds_read_b64_tr_b16 v[238:239], v5 offset:50464
    s_waitcnt lgkmcnt(4)
    v_mfma_f32_16x16x32_bf16 v[32:35], v[228:231], v[88:91], v[32:35]
    ds_read_b64_tr_b16 v[240:241], v4 offset:49664
    v_mfma_f32_16x16x32_bf16 v[36:39], v[228:231], v[92:95], v[36:39]
    ds_read_b64_tr_b16 v[242:243], v4 offset:50688
    s_mov_b32 s23, 0x2800
    buffer_load_dwordx4 v[120:123], v7, s[8:11], s23 offen offset:0 sc1
    s_waitcnt lgkmcnt(4)
    v_mfma_f32_16x16x32_bf16 v[40:43], v[232:235], v[88:91], v[40:43]
    ds_read_b64_tr_b16 v[244:245], v5 offset:49696
    v_mfma_f32_16x16x32_bf16 v[44:47], v[232:235], v[92:95], v[44:47]
    s_add_u32 s22, s19, 0x288000
    s_add_u32 m0, s20, 0x4400
    s_nop 0
    buffer_load_dwordx4 v3, s[4:7], s22 offen lds
    ds_read_b64_tr_b16 v[246:247], v5 offset:50720
    s_waitcnt lgkmcnt(4)
    v_mfma_f32_16x16x32_bf16 v[48:51], v[236:239], v[88:91], v[48:51]
    ds_read_b64_tr_b16 v[224:225], v4 offset:49920
    v_mfma_f32_16x16x32_bf16 v[52:55], v[236:239], v[92:95], v[52:55]
    ds_read_b64_tr_b16 v[226:227], v4 offset:50944
    s_waitcnt lgkmcnt(4)
    v_mfma_f32_16x16x32_bf16 v[56:59], v[240:243], v[88:91], v[56:59]
    ds_read_b64_tr_b16 v[228:229], v5 offset:49952
    v_mfma_f32_16x16x32_bf16 v[60:63], v[240:243], v[92:95], v[60:63]
    ds_read_b64_tr_b16 v[230:231], v5 offset:50976
    s_waitcnt lgkmcnt(4)
    v_mfma_f32_16x16x32_bf16 v[64:67], v[244:247], v[88:91], v[64:67]
    ds_read_b64_tr_b16 v[232:233], v4 offset:57344
    v_mfma_f32_16x16x32_bf16 v[68:71], v[244:247], v[92:95], v[68:71]
    ds_read_b64_tr_b16 v[234:235], v4 offset:58368
    s_mov_b32 s23, 0xa800
    buffer_load_dwordx4 v[124:127], v7, s[8:11], s23 offen offset:0 sc1
    s_waitcnt lgkmcnt(4)
    v_mfma_f32_16x16x32_bf16 v[72:75], v[224:227], v[88:91], v[72:75]
    ds_read_b64_tr_b16 v[236:237], v5 offset:57376
    v_mfma_f32_16x16x32_bf16 v[76:79], v[224:227], v[92:95], v[76:79]
    ds_read_b64_tr_b16 v[238:239], v5 offset:58400
    s_waitcnt lgkmcnt(4)
    v_mfma_f32_16x16x32_bf16 v[80:83], v[228:231], v[88:91], v[80:83]
    ds_read_b64_tr_b16 v[240:241], v4 offset:57600
    v_mfma_f32_16x16x32_bf16 v[84:87], v[228:231], v[92:95], v[84:87]
    ds_read_b64_tr_b16 v[242:243], v4 offset:58624
    s_waitcnt vmcnt(11) lgkmcnt(4)
    v_mfma_f32_16x16x32_bf16 v[24:27], v[232:235], v[96:99], v[24:27]
    ds_read_b64_tr_b16 v[244:245], v5 offset:57632
    s_waitcnt vmcnt(10)
    v_mfma_f32_16x16x32_bf16 v[28:31], v[232:235], v[100:103], v[28:31]
    ds_read_b64_tr_b16 v[246:247], v5 offset:58656
    s_waitcnt lgkmcnt(4)
    v_mfma_f32_16x16x32_bf16 v[32:35], v[236:239], v[96:99], v[32:35]
    ds_read_b64_tr_b16 v[224:225], v4 offset:57856
    v_mfma_f32_16x16x32_bf16 v[36:39], v[236:239], v[100:103], v[36:39]
    ds_read_b64_tr_b16 v[226:227], v4 offset:58880
    s_mov_b32 s23, 0x2800
    buffer_load_dwordx4 v[128:131], v7, s[8:11], s23 offen offset:1024 sc1
    s_waitcnt lgkmcnt(4)
    v_mfma_f32_16x16x32_bf16 v[40:43], v[240:243], v[96:99], v[40:43]
    ds_read_b64_tr_b16 v[228:229], v5 offset:57888
    v_mfma_f32_16x16x32_bf16 v[44:47], v[240:243], v[100:103], v[44:47]
    ds_read_b64_tr_b16 v[230:231], v5 offset:58912
    s_waitcnt lgkmcnt(4)
    v_mfma_f32_16x16x32_bf16 v[48:51], v[244:247], v[96:99], v[48:51]
    ds_read_b64_tr_b16 v[232:233], v4 offset:58112
    v_mfma_f32_16x16x32_bf16 v[52:55], v[244:247], v[100:103], v[52:55]
    ds_read_b64_tr_b16 v[234:235], v4 offset:59136
    s_waitcnt lgkmcnt(4)
    v_mfma_f32_16x16x32_bf16 v[56:59], v[224:227], v[96:99], v[56:59]
    ds_read_b64_tr_b16 v[236:237], v5 offset:58144
    v_mfma_f32_16x16x32_bf16 v[60:63], v[224:227], v[100:103], v[60:63]
    ds_read_b64_tr_b16 v[238:239], v5 offset:59168
    s_waitcnt lgkmcnt(4)
    v_mfma_f32_16x16x32_bf16 v[64:67], v[228:231], v[96:99], v[64:67]
    v_mfma_f32_16x16x32_bf16 v[68:71], v[228:231], v[100:103], v[68:71]
    s_waitcnt vmcnt(8)
    s_barrier
    ds_read_b64_tr_b16 v[240:241], v4 offset:0
    ds_read_b64_tr_b16 v[242:243], v4 offset:1024
    s_mov_b32 s23, 0xa800
    buffer_load_dwordx4 v[132:135], v7, s[8:11], s23 offen offset:1024 sc1
    s_waitcnt lgkmcnt(4)
    v_mfma_f32_16x16x32_bf16 v[72:75], v[232:235], v[96:99], v[72:75]
    ds_read_b64_tr_b16 v[244:245], v5 offset:32
    v_mfma_f32_16x16x32_bf16 v[76:79], v[232:235], v[100:103], v[76:79]
    s_add_u32 s22, s19, 0x300000
    s_add_u32 m0, s20, 0x8000
    s_nop 0
    buffer_load_dwordx4 v3, s[4:7], s22 offen lds
    ds_read_b64_tr_b16 v[246:247], v5 offset:1056
    s_waitcnt lgkmcnt(4)
    v_mfma_f32_16x16x32_bf16 v[80:83], v[236:239], v[96:99], v[80:83]
    ds_read_b64_tr_b16 v[224:225], v4 offset:256
    v_mfma_f32_16x16x32_bf16 v[84:87], v[236:239], v[100:103], v[84:87]
    ds_read_b64_tr_b16 v[226:227], v4 offset:1280
    s_waitcnt lgkmcnt(4)
    v_mfma_f32_16x16x32_bf16 v[24:27], v[240:243], v[104:107], v[24:27]
    ds_read_b64_tr_b16 v[228:229], v5 offset:288
    s_waitcnt vmcnt(9)
    v_mfma_f32_16x16x32_bf16 v[28:31], v[240:243], v[108:111], v[28:31]
    ds_read_b64_tr_b16 v[230:231], v5 offset:1312
    s_waitcnt lgkmcnt(4)
    v_mfma_f32_16x16x32_bf16 v[32:35], v[244:247], v[104:107], v[32:35]
    ds_read_b64_tr_b16 v[232:233], v4 offset:512
    v_mfma_f32_16x16x32_bf16 v[36:39], v[244:247], v[108:111], v[36:39]
    ds_read_b64_tr_b16 v[234:235], v4 offset:1536
    s_mov_b32 s23, 0x3000
    buffer_load_dwordx4 v[88:91], v7, s[8:11], s23 offen offset:0 sc1
    s_waitcnt lgkmcnt(4)
    v_mfma_f32_16x16x32_bf16 v[40:43], v[224:227], v[104:107], v[40:43]
    ds_read_b64_tr_b16 v[236:237], v5 offset:544
    v_mfma_f32_16x16x32_bf16 v[44:47], v[224:227], v[108:111], v[44:47]
    s_add_u32 s22, s19, 0x308000
    s_add_u32 m0, s20, 0x8400
    s_nop 0
    buffer_load_dwordx4 v3, s[4:7], s22 offen lds
    ds_read_b64_tr_b16 v[238:239], v5 offset:1568
    s_waitcnt lgkmcnt(4)
    v_mfma_f32_16x16x32_bf16 v[48:51], v[228:231], v[104:107], v[48:51]
    ds_read_b64_tr_b16 v[240:241], v4 offset:768
    v_mfma_f32_16x16x32_bf16 v[52:55], v[228:231], v[108:111], v[52:55]
    ds_read_b64_tr_b16 v[242:243], v4 offset:1792
    s_waitcnt lgkmcnt(4)
    v_mfma_f32_16x16x32_bf16 v[56:59], v[232:235], v[104:107], v[56:59]
    ds_read_b64_tr_b16 v[244:245], v5 offset:800
    v_mfma_f32_16x16x32_bf16 v[60:63], v[232:235], v[108:111], v[60:63]
    ds_read_b64_tr_b16 v[246:247], v5 offset:1824
    s_waitcnt lgkmcnt(4)
    v_mfma_f32_16x16x32_bf16 v[64:67], v[236:239], v[104:107], v[64:67]
    ds_read_b64_tr_b16 v[224:225], v4 offset:8192
    v_mfma_f32_16x16x32_bf16 v[68:71], v[236:239], v[108:111], v[68:71]
    ds_read_b64_tr_b16 v[226:227], v4 offset:9216
    s_mov_b32 s23, 0xb000
    buffer_load_dwordx4 v[92:95], v7, s[8:11], s23 offen offset:0 sc1
    s_waitcnt lgkmcnt(4)
    v_mfma_f32_16x16x32_bf16 v[72:75], v[240:243], v[104:107], v[72:75]
    ds_read_b64_tr_b16 v[228:229], v5 offset:8224
    v_mfma_f32_16x16x32_bf16 v[76:79], v[240:243], v[108:111], v[76:79]
    ds_read_b64_tr_b16 v[230:231], v5 offset:9248
    s_waitcnt lgkmcnt(4)
    v_mfma_f32_16x16x32_bf16 v[80:83], v[244:247], v[104:107], v[80:83]
    ds_read_b64_tr_b16 v[232:233], v4 offset:8448
    v_mfma_f32_16x16x32_bf16 v[84:87], v[244:247], v[108:111], v[84:87]
    ds_read_b64_tr_b16 v[234:235], v4 offset:9472
    s_waitcnt vmcnt(11) lgkmcnt(4)
    v_mfma_f32_16x16x32_bf16 v[24:27], v[224:227], v[112:115], v[24:27]
    ds_read_b64_tr_b16 v[236:237], v5 offset:8480
    s_waitcnt vmcnt(10)
    v_mfma_f32_16x16x32_bf16 v[28:31], v[224:227], v[116:119], v[28:31]
    ds_read_b64_tr_b16 v[238:239], v5 offset:9504
    s_waitcnt lgkmcnt(4)
    v_mfma_f32_16x16x32_bf16 v[32:35], v[228:231], v[112:115], v[32:35]
    ds_read_b64_tr_b16 v[240:241], v4 offset:8704
    v_mfma_f32_16x16x32_bf16 v[36:39], v[228:231], v[116:119], v[36:39]
    ds_read_b64_tr_b16 v[242:243], v4 offset:9728
    s_mov_b32 s23, 0x3000
    buffer_load_dwordx4 v[96:99], v7, s[8:11], s23 offen offset:1024 sc1
    s_waitcnt lgkmcnt(4)
    v_mfma_f32_16x16x32_bf16 v[40:43], v[232:235], v[112:115], v[40:43]
    ds_read_b64_tr_b16 v[244:245], v5 offset:8736
    v_mfma_f32_16x16x32_bf16 v[44:47], v[232:235], v[116:119], v[44:47]
    ds_read_b64_tr_b16 v[246:247], v5 offset:9760
    s_waitcnt lgkmcnt(4)
    v_mfma_f32_16x16x32_bf16 v[48:51], v[236:239], v[112:115], v[48:51]
    ds_read_b64_tr_b16 v[224:225], v4 offset:8960
    v_mfma_f32_16x16x32_bf16 v[52:55], v[236:239], v[116:119], v[52:55]
    ds_read_b64_tr_b16 v[226:227], v4 offset:9984
    s_waitcnt lgkmcnt(4)
    v_mfma_f32_16x16x32_bf16 v[56:59], v[240:243], v[112:115], v[56:59]
    ds_read_b64_tr_b16 v[228:229], v5 offset:8992
    v_mfma_f32_16x16x32_bf16 v[60:63], v[240:243], v[116:119], v[60:63]
    ds_read_b64_tr_b16 v[230:231], v5 offset:10016
    s_waitcnt lgkmcnt(4)
    v_mfma_f32_16x16x32_bf16 v[64:67], v[244:247], v[112:115], v[64:67]
    v_mfma_f32_16x16x32_bf16 v[68:71], v[244:247], v[116:119], v[68:71]
    s_waitcnt vmcnt(8)
    s_barrier
    ds_read_b64_tr_b16 v[232:233], v4 offset:16384
    ds_read_b64_tr_b16 v[234:235], v4 offset:17408
    s_mov_b32 s23, 0xb000
    buffer_load_dwordx4 v[100:103], v7, s[8:11], s23 offen offset:1024 sc1
    s_waitcnt lgkmcnt(4)
    v_mfma_f32_16x16x32_bf16 v[72:75], v[224:227], v[112:115], v[72:75]
    ds_read_b64_tr_b16 v[236:237], v5 offset:16416
    v_mfma_f32_16x16x32_bf16 v[76:79], v[224:227], v[116:119], v[76:79]
    s_add_u32 s22, s19, 0x380000
    s_add_u32 m0, s20, 0xc000
    s_nop 0
    buffer_load_dwordx4 v3, s[4:7], s22 offen lds
    ds_read_b64_tr_b16 v[238:239], v5 offset:17440
    s_waitcnt lgkmcnt(4)
    v_mfma_f32_16x16x32_bf16 v[80:83], v[228:231], v[112:115], v[80:83]
    ds_read_b64_tr_b16 v[240:241], v4 offset:16640
    v_mfma_f32_16x16x32_bf16 v[84:87], v[228:231], v[116:119], v[84:87]
    ds_read_b64_tr_b16 v[242:243], v4 offset:17664
    s_waitcnt lgkmcnt(4)
    v_mfma_f32_16x16x32_bf16 v[24:27], v[232:235], v[120:123], v[24:27]
    ds_read_b64_tr_b16 v[244:245], v5 offset:16672
    s_waitcnt vmcnt(9)
    v_mfma_f32_16x16x32_bf16 v[28:31], v[232:235], v[124:127], v[28:31]
    ds_read_b64_tr_b16 v[246:247], v5 offset:17696
    s_waitcnt lgkmcnt(4)
    v_mfma_f32_16x16x32_bf16 v[32:35], v[236:239], v[120:123], v[32:35]
    ds_read_b64_tr_b16 v[224:225], v4 offset:16896
    v_mfma_f32_16x16x32_bf16 v[36:39], v[236:239], v[124:127], v[36:39]
    ds_read_b64_tr_b16 v[226:227], v4 offset:17920
    s_mov_b32 s23, 0x3800
    buffer_load_dwordx4 v[104:107], v7, s[8:11], s23 offen offset:0 sc1
    s_waitcnt lgkmcnt(4)
    v_mfma_f32_16x16x32_bf16 v[40:43], v[240:243], v[120:123], v[40:43]
    ds_read_b64_tr_b16 v[228:229], v5 offset:16928
    v_mfma_f32_16x16x32_bf16 v[44:47], v[240:243], v[124:127], v[44:47]
    s_add_u32 s22, s19, 0x388000
    s_add_u32 m0, s20, 0xc400
    s_nop 0
    buffer_load_dwordx4 v3, s[4:7], s22 offen lds
    ds_read_b64_tr_b16 v[230:231], v5 offset:17952
    s_waitcnt lgkmcnt(4)
    v_mfma_f32_16x16x32_bf16 v[48:51], v[244:247], v[120:123], v[48:51]
    ds_read_b64_tr_b16 v[232:233], v4 offset:17152
    v_mfma_f32_16x16x32_bf16 v[52:55], v[244:247], v[124:127], v[52:55]
    ds_read_b64_tr_b16 v[234:235], v4 offset:18176
    s_waitcnt lgkmcnt(4)
    v_mfma_f32_16x16x32_bf16 v[56:59], v[224:227], v[120:123], v[56:59]
    ds_read_b64_tr_b16 v[236:237], v5 offset:17184
    v_mfma_f32_16x16x32_bf16 v[60:63], v[224:227], v[124:127], v[60:63]
    ds_read_b64_tr_b16 v[238:239], v5 offset:18208
    s_waitcnt lgkmcnt(4)
    v_mfma_f32_16x16x32_bf16 v[64:67], v[228:231], v[120:123], v[64:67]
    ds_read_b64_tr_b16 v[240:241], v4 offset:24576
    v_mfma_f32_16x16x32_bf16 v[68:71], v[228:231], v[124:127], v[68:71]
    ds_read_b64_tr_b16 v[242:243], v4 offset:25600
    s_mov_b32 s23, 0xb800
    buffer_load_dwordx4 v[108:111], v7, s[8:11], s23 offen offset:0 sc1
    s_waitcnt lgkmcnt(4)
    v_mfma_f32_16x16x32_bf16 v[72:75], v[232:235], v[120:123], v[72:75]
    ds_read_b64_tr_b16 v[244:245], v5 offset:24608
    v_mfma_f32_16x16x32_bf16 v[76:79], v[232:235], v[124:127], v[76:79]
    ds_read_b64_tr_b16 v[246:247], v5 offset:25632
    s_waitcnt lgkmcnt(4)
    v_mfma_f32_16x16x32_bf16 v[80:83], v[236:239], v[120:123], v[80:83]
    ds_read_b64_tr_b16 v[224:225], v4 offset:24832
    v_mfma_f32_16x16x32_bf16 v[84:87], v[236:239], v[124:127], v[84:87]
    ds_read_b64_tr_b16 v[226:227], v4 offset:25856
    s_waitcnt vmcnt(11) lgkmcnt(4)
    v_mfma_f32_16x16x32_bf16 v[24:27], v[240:243], v[128:131], v[24:27]
    ds_read_b64_tr_b16 v[228:229], v5 offset:24864
    s_waitcnt vmcnt(10)
    v_mfma_f32_16x16x32_bf16 v[28:31], v[240:243], v[132:135], v[28:31]
    ds_read_b64_tr_b16 v[230:231], v5 offset:25888
    s_waitcnt lgkmcnt(4)
    v_mfma_f32_16x16x32_bf16 v[32:35], v[244:247], v[128:131], v[32:35]
    ds_read_b64_tr_b16 v[232:233], v4 offset:25088
    v_mfma_f32_16x16x32_bf16 v[36:39], v[244:247], v[132:135], v[36:39]
    ds_read_b64_tr_b16 v[234:235], v4 offset:26112
    s_mov_b32 s23, 0x3800
    buffer_load_dwordx4 v[112:115], v7, s[8:11], s23 offen offset:1024 sc1
    s_waitcnt lgkmcnt(4)
    v_mfma_f32_16x16x32_bf16 v[40:43], v[224:227], v[128:131], v[40:43]
    ds_read_b64_tr_b16 v[236:237], v5 offset:25120
    v_mfma_f32_16x16x32_bf16 v[44:47], v[224:227], v[132:135], v[44:47]
    ds_read_b64_tr_b16 v[238:239], v5 offset:26144
    s_waitcnt lgkmcnt(4)
    v_mfma_f32_16x16x32_bf16 v[48:51], v[228:231], v[128:131], v[48:51]
    ds_read_b64_tr_b16 v[240:241], v4 offset:25344
    v_mfma_f32_16x16x32_bf16 v[52:55], v[228:231], v[132:135], v[52:55]
    ds_read_b64_tr_b16 v[242:243], v4 offset:26368
    s_waitcnt lgkmcnt(4)
    v_mfma_f32_16x16x32_bf16 v[56:59], v[232:235], v[128:131], v[56:59]
    ds_read_b64_tr_b16 v[244:245], v5 offset:25376
    v_mfma_f32_16x16x32_bf16 v[60:63], v[232:235], v[132:135], v[60:63]
    ds_read_b64_tr_b16 v[246:247], v5 offset:26400
    s_waitcnt lgkmcnt(4)
    v_mfma_f32_16x16x32_bf16 v[64:67], v[236:239], v[128:131], v[64:67]
    v_mfma_f32_16x16x32_bf16 v[68:71], v[236:239], v[132:135], v[68:71]
    s_waitcnt vmcnt(8)
    s_barrier
    ds_read_b64_tr_b16 v[224:225], v4 offset:32768
    ds_read_b64_tr_b16 v[226:227], v4 offset:33792
    s_mov_b32 s23, 0xb800
    buffer_load_dwordx4 v[116:119], v7, s[8:11], s23 offen offset:1024 sc1
    s_waitcnt lgkmcnt(4)
    v_mfma_f32_16x16x32_bf16 v[72:75], v[240:243], v[128:131], v[72:75]
    ds_read_b64_tr_b16 v[228:229], v5 offset:32800
    v_mfma_f32_16x16x32_bf16 v[76:79], v[240:243], v[132:135], v[76:79]
    s_add_u32 s22, s19, 0x400000
    s_add_u32 m0, s20, 0x0
    s_nop 0
    buffer_load_dwordx4 v3, s[4:7], s22 offen lds
    ds_read_b64_tr_b16 v[230:231], v5 offset:33824
    s_waitcnt lgkmcnt(4)
    v_mfma_f32_16x16x32_bf16 v[80:83], v[244:247], v[128:131], v[80:83]
    ds_read_b64_tr_b16 v[232:233], v4 offset:33024
    v_mfma_f32_16x16x32_bf16 v[84:87], v[244:247], v[132:135], v[84:87]
    ds_read_b64_tr_b16 v[234:235], v4 offset:34048
    s_waitcnt lgkmcnt(4)
    v_mfma_f32_16x16x32_bf16 v[24:27], v[224:227], v[88:91], v[24:27]
    ds_read_b64_tr_b16 v[236:237], v5 offset:33056
    s_waitcnt vmcnt(9)
    v_mfma_f32_16x16x32_bf16 v[28:31], v[224:227], v[92:95], v[28:31]
    ds_read_b64_tr_b16 v[238:239], v5 offset:34080
    s_waitcnt lgkmcnt(4)
    v_mfma_f32_16x16x32_bf16 v[32:35], v[228:231], v[88:91], v[32:35]
    ds_read_b64_tr_b16 v[240:241], v4 offset:33280
    v_mfma_f32_16x16x32_bf16 v[36:39], v[228:231], v[92:95], v[36:39]
    ds_read_b64_tr_b16 v[242:243], v4 offset:34304
    s_mov_b32 s23, 0x4000
    buffer_load_dwordx4 v[120:123], v7, s[8:11], s23 offen offset:0 sc1
    s_waitcnt lgkmcnt(4)
    v_mfma_f32_16x16x32_bf16 v[40:43], v[232:235], v[88:91], v[40:43]
    ds_read_b64_tr_b16 v[244:245], v5 offset:33312
    v_mfma_f32_16x16x32_bf16 v[44:47], v[232:235], v[92:95], v[44:47]
    s_add_u32 s22, s19, 0x408000
    s_add_u32 m0, s20, 0x400
    s_nop 0
    buffer_load_dwordx4 v3, s[4:7], s22 offen lds
    ds_read_b64_tr_b16 v[246:247], v5 offset:34336
    s_waitcnt lgkmcnt(4)
    v_mfma_f32_16x16x32_bf16 v[48:51], v[236:239], v[88:91], v[48:51]
    ds_read_b64_tr_b16 v[224:225], v4 offset:33536
    v_mfma_f32_16x16x32_bf16 v[52:55], v[236:239], v[92:95], v[52:55]
    ds_read_b64_tr_b16 v[226:227], v4 offset:34560
    s_waitcnt lgkmcnt(4)
    v_mfma_f32_16x16x32_bf16 v[56:59], v[240:243], v[88:91], v[56:59]
    ds_read_b64_tr_b16 v[228:229], v5 offset:33568
    v_mfma_f32_16x16x32_bf16 v[60:63], v[240:243], v[92:95], v[60:63]
    ds_read_b64_tr_b16 v[230:231], v5 offset:34592
    s_waitcnt lgkmcnt(4)
    v_mfma_f32_16x16x32_bf16 v[64:67], v[244:247], v[88:91], v[64:67]
    ds_read_b64_tr_b16 v[232:233], v4 offset:40960
    v_mfma_f32_16x16x32_bf16 v[68:71], v[244:247], v[92:95], v[68:71]
    ds_read_b64_tr_b16 v[234:235], v4 offset:41984
    s_mov_b32 s23, 0xc000
    buffer_load_dwordx4 v[124:127], v7, s[8:11], s23 offen offset:0 sc1
    s_waitcnt lgkmcnt(4)
    v_mfma_f32_16x16x32_bf16 v[72:75], v[224:227], v[88:91], v[72:75]
    ds_read_b64_tr_b16 v[236:237], v5 offset:40992
    v_lshrrev_b32 v21, 4, v1
    v_lshlrev_b32 v21, 9, v21
    v_and_b32 v20, 15, v1
    v_lshl_add_u32 v21, v20, 4, v21
    s_lshr_b32 s18, s12, 3
    s_lshl_b32 s18, s18, 11
    s_add_u32 s18, s18, 0x528100
    buffer_load_dwordx4 v[12:15], v21, s[8:11], s18 offen sc1
    v_mfma_f32_16x16x32_bf16 v[76:79], v[224:227], v[92:95], v[76:79]
    ds_read_b64_tr_b16 v[238:239], v5 offset:42016
    s_waitcnt lgkmcnt(4)
    v_mfma_f32_16x16x32_bf16 v[80:83], v[228:231], v[88:91], v[80:83]
    ds_read_b64_tr_b16 v[240:241], v4 offset:41216
    v_mfma_f32_16x16x32_bf16 v[84:87], v[228:231], v[92:95], v[84:87]
    ds_read_b64_tr_b16 v[242:243], v4 offset:42240
    s_waitcnt vmcnt(12) lgkmcnt(4)
    v_mfma_f32_16x16x32_bf16 v[24:27], v[232:235], v[96:99], v[24:27]
    ds_read_b64_tr_b16 v[244:245], v5 offset:41248
    s_waitcnt vmcnt(11)
    v_mfma_f32_16x16x32_bf16 v[28:31], v[232:235], v[100:103], v[28:31]
    ds_read_b64_tr_b16 v[246:247], v5 offset:42272
    s_waitcnt lgkmcnt(4)
    v_mfma_f32_16x16x32_bf16 v[32:35], v[236:239], v[96:99], v[32:35]
    ds_read_b64_tr_b16 v[224:225], v4 offset:41472
    v_mfma_f32_16x16x32_bf16 v[36:39], v[236:239], v[100:103], v[36:39]
    ds_read_b64_tr_b16 v[226:227], v4 offset:42496
    s_mov_b32 s23, 0x4000
    buffer_load_dwordx4 v[128:131], v7, s[8:11], s23 offen offset:1024 sc1
    s_waitcnt lgkmcnt(4)
    v_mfma_f32_16x16x32_bf16 v[40:43], v[240:243], v[96:99], v[40:43]
    ds_read_b64_tr_b16 v[228:229], v5 offset:41504
    v_mfma_f32_16x16x32_bf16 v[44:47], v[240:243], v[100:103], v[44:47]
    ds_read_b64_tr_b16 v[230:231], v5 offset:42528
    s_waitcnt lgkmcnt(4)
    v_mfma_f32_16x16x32_bf16 v[48:51], v[244:247], v[96:99], v[48:51]
    ds_read_b64_tr_b16 v[232:233], v4 offset:41728
    v_mfma_f32_16x16x32_bf16 v[52:55], v[244:247], v[100:103], v[52:55]
    ds_read_b64_tr_b16 v[234:235], v4 offset:42752
    s_waitcnt lgkmcnt(4)
    v_mfma_f32_16x16x32_bf16 v[56:59], v[224:227], v[96:99], v[56:59]
    ds_read_b64_tr_b16 v[236:237], v5 offset:41760
    v_mfma_f32_16x16x32_bf16 v[60:63], v[224:227], v[100:103], v[60:63]
    ds_read_b64_tr_b16 v[238:239], v5 offset:42784
    s_waitcnt lgkmcnt(4)
    v_mfma_f32_16x16x32_bf16 v[64:67], v[228:231], v[96:99], v[64:67]
    v_mfma_f32_16x16x32_bf16 v[68:71], v[228:231], v[100:103], v[68:71]
    s_waitcnt vmcnt(9)
    s_barrier
    ds_read_b64_tr_b16 v[240:241], v4 offset:49152
    ds_read_b64_tr_b16 v[242:243], v4 offset:50176
    s_mov_b32 s23, 0xc000
    buffer_load_dwordx4 v[132:135], v7, s[8:11], s23 offen offset:1024 sc1
    s_waitcnt lgkmcnt(4)
    v_mfma_f32_16x16x32_bf16 v[72:75], v[232:235], v[96:99], v[72:75]
    ds_read_b64_tr_b16 v[244:245], v5 offset:49184
    v_mfma_f32_16x16x32_bf16 v[76:79], v[232:235], v[100:103], v[76:79]
    s_add_u32 s22, s19, 0x480000
    s_add_u32 m0, s20, 0x4000
    s_nop 0
    buffer_load_dwordx4 v3, s[4:7], s22 offen lds
    ds_read_b64_tr_b16 v[246:247], v5 offset:50208
    s_waitcnt lgkmcnt(4)
    v_mfma_f32_16x16x32_bf16 v[80:83], v[236:239], v[96:99], v[80:83]
    ds_read_b64_tr_b16 v[224:225], v4 offset:49408
    v_mfma_f32_16x16x32_bf16 v[84:87], v[236:239], v[100:103], v[84:87]
    ds_read_b64_tr_b16 v[226:227], v4 offset:50432
    s_waitcnt lgkmcnt(4)
    v_mfma_f32_16x16x32_bf16 v[24:27], v[240:243], v[104:107], v[24:27]
    ds_read_b64_tr_b16 v[228:229], v5 offset:49440
    s_waitcnt vmcnt(10)
    v_mfma_f32_16x16x32_bf16 v[28:31], v[240:243], v[108:111], v[28:31]
    ds_read_b64_tr_b16 v[230:231], v5 offset:50464
    s_waitcnt lgkmcnt(4)
    v_mfma_f32_16x16x32_bf16 v[32:35], v[244:247], v[104:107], v[32:35]
    ds_read_b64_tr_b16 v[232:233], v4 offset:49664
    v_mfma_f32_16x16x32_bf16 v[36:39], v[244:247], v[108:111], v[36:39]
    ds_read_b64_tr_b16 v[234:235], v4 offset:50688
    s_mov_b32 s23, 0x4800
    buffer_load_dwordx4 v[88:91], v7, s[8:11], s23 offen offset:0 sc1
    s_waitcnt lgkmcnt(4)
    v_mfma_f32_16x16x32_bf16 v[40:43], v[224:227], v[104:107], v[40:43]
    ds_read_b64_tr_b16 v[236:237], v5 offset:49696
    v_mfma_f32_16x16x32_bf16 v[44:47], v[224:227], v[108:111], v[44:47]
    s_add_u32 s22, s19, 0x488000
    s_add_u32 m0, s20, 0x4400
    s_nop 0
    buffer_load_dwordx4 v3, s[4:7], s22 offen lds
    ds_read_b64_tr_b16 v[238:239], v5 offset:50720
    s_waitcnt lgkmcnt(4)
    v_mfma_f32_16x16x32_bf16 v[48:51], v[228:231], v[104:107], v[48:51]
    ds_read_b64_tr_b16 v[240:241], v4 offset:49920
    v_mfma_f32_16x16x32_bf16 v[52:55], v[228:231], v[108:111], v[52:55]
    ds_read_b64_tr_b16 v[242:243], v4 offset:50944
    s_waitcnt lgkmcnt(4)
    v_mfma_f32_16x16x32_bf16 v[56:59], v[232:235], v[104:107], v[56:59]
    ds_read_b64_tr_b16 v[244:245], v5 offset:49952
    v_mfma_f32_16x16x32_bf16 v[60:63], v[232:235], v[108:111], v[60:63]
    ds_read_b64_tr_b16 v[246:247], v5 offset:50976
    s_waitcnt lgkmcnt(4)
    v_mfma_f32_16x16x32_bf16 v[64:67], v[236:239], v[104:107], v[64:67]
    ds_read_b64_tr_b16 v[224:225], v4 offset:57344
    v_mfma_f32_16x16x32_bf16 v[68:71], v[236:239], v[108:111], v[68:71]
    ds_read_b64_tr_b16 v[226:227], v4 offset:58368
    s_mov_b32 s23, 0xc800
    buffer_load_dwordx4 v[92:95], v7, s[8:11], s23 offen offset:0 sc1
    s_waitcnt lgkmcnt(4)
    v_mfma_f32_16x16x32_bf16 v[72:75], v[240:243], v[104:107], v[72:75]
    ds_read_b64_tr_b16 v[228:229], v5 offset:57376
    v_mfma_f32_16x16x32_bf16 v[76:79], v[240:243], v[108:111], v[76:79]
    ds_read_b64_tr_b16 v[230:231], v5 offset:58400
    s_waitcnt lgkmcnt(4)
    v_mfma_f32_16x16x32_bf16 v[80:83], v[244:247], v[104:107], v[80:83]
    ds_read_b64_tr_b16 v[232:233], v4 offset:57600
    v_mfma_f32_16x16x32_bf16 v[84:87], v[244:247], v[108:111], v[84:87]
    ds_read_b64_tr_b16 v[234:235], v4 offset:58624
    s_waitcnt vmcnt(12) lgkmcnt(4)
    v_mfma_f32_16x16x32_bf16 v[24:27], v[224:227], v[112:115], v[24:27]
    ds_read_b64_tr_b16 v[236:237], v5 offset:57632
    s_waitcnt vmcnt(11)
    v_mfma_f32_16x16x32_bf16 v[28:31], v[224:227], v[116:119], v[28:31]
    ds_read_b64_tr_b16 v[238:239], v5 offset:58656
    s_waitcnt lgkmcnt(4)
    v_mfma_f32_16x16x32_bf16 v[32:35], v[228:231], v[112:115], v[32:35]
    ds_read_b64_tr_b16 v[240:241], v4 offset:57856
    v_mfma_f32_16x16x32_bf16 v[36:39], v[228:231], v[116:119], v[36:39]
    ds_read_b64_tr_b16 v[242:243], v4 offset:58880
    s_mov_b32 s23, 0x4800
    buffer_load_dwordx4 v[96:99], v7, s[8:11], s23 offen offset:1024 sc1
    s_waitcnt lgkmcnt(4)
    v_mfma_f32_16x16x32_bf16 v[40:43], v[232:235], v[112:115], v[40:43]
    ds_read_b64_tr_b16 v[244:245], v5 offset:57888
    v_mfma_f32_16x16x32_bf16 v[44:47], v[232:235], v[116:119], v[44:47]
    ds_read_b64_tr_b16 v[246:247], v5 offset:58912
    s_waitcnt lgkmcnt(4)
    v_mfma_f32_16x16x32_bf16 v[48:51], v[236:239], v[112:115], v[48:51]
    ds_read_b64_tr_b16 v[224:225], v4 offset:58112
    v_mfma_f32_16x16x32_bf16 v[52:55], v[236:239], v[116:119], v[52:55]
    ds_read_b64_tr_b16 v[226:227], v4 offset:59136
    s_waitcnt lgkmcnt(4)
    v_mfma_f32_16x16x32_bf16 v[56:59], v[240:243], v[112:115], v[56:59]
    ds_read_b64_tr_b16 v[228:229], v5 offset:58144
    v_mfma_f32_16x16x32_bf16 v[60:63], v[240:243], v[116:119], v[60:63]
    ds_read_b64_tr_b16 v[230:231], v5 offset:59168
    s_waitcnt lgkmcnt(4)
    v_mfma_f32_16x16x32_bf16 v[64:67], v[244:247], v[112:115], v[64:67]
    v_mfma_f32_16x16x32_bf16 v[68:71], v[244:247], v[116:119], v[68:71]
    s_waitcnt vmcnt(9)
    s_barrier
    ds_read_b64_tr_b16 v[232:233], v4 offset:0
    ds_read_b64_tr_b16 v[234:235], v4 offset:1024
    s_mov_b32 s23, 0xc800
    buffer_load_dwordx4 v[100:103], v7, s[8:11], s23 offen offset:1024 sc1
    s_waitcnt lgkmcnt(4)
    v_mfma_f32_16x16x32_bf16 v[72:75], v[224:227], v[112:115], v[72:75]
    ds_read_b64_tr_b16 v[236:237], v5 offset:32
    v_mfma_f32_16x16x32_bf16 v[76:79], v[224:227], v[116:119], v[76:79]
    s_add_u32 s22, s19, 0x500000
    s_add_u32 m0, s20, 0x8000
    s_nop 0
    buffer_load_dwordx4 v3, s[4:7], s22 offen lds
    ds_read_b64_tr_b16 v[238:239], v5 offset:1056
    s_waitcnt lgkmcnt(4)
    v_mfma_f32_16x16x32_bf16 v[80:83], v[228:231], v[112:115], v[80:83]
    ds_read_b64_tr_b16 v[240:241], v4 offset:256
    v_mfma_f32_16x16x32_bf16 v[84:87], v[228:231], v[116:119], v[84:87]
    ds_read_b64_tr_b16 v[242:243], v4 offset:1280
    s_waitcnt lgkmcnt(4)
    v_mfma_f32_16x16x32_bf16 v[24:27], v[232:235], v[120:123], v[24:27]
    ds_read_b64_tr_b16 v[244:245], v5 offset:288
    s_waitcnt vmcnt(10)
    v_mfma_f32_16x16x32_bf16 v[28:31], v[232:235], v[124:127], v[28:31]
    ds_read_b64_tr_b16 v[246:247], v5 offset:1312
    s_waitcnt lgkmcnt(4)
    v_mfma_f32_16x16x32_bf16 v[32:35], v[236:239], v[120:123], v[32:35]
    ds_read_b64_tr_b16 v[224:225], v4 offset:512
    v_mfma_f32_16x16x32_bf16 v[36:39], v[236:239], v[124:127], v[36:39]
    ds_read_b64_tr_b16 v[226:227], v4 offset:1536
    s_mov_b32 s23, 0x5000
    buffer_load_dwordx4 v[104:107], v7, s[8:11], s23 offen offset:0 sc1
    s_waitcnt lgkmcnt(4)
    v_mfma_f32_16x16x32_bf16 v[40:43], v[240:243], v[120:123], v[40:43]
    ds_read_b64_tr_b16 v[228:229], v5 offset:544
    v_mfma_f32_16x16x32_bf16 v[44:47], v[240:243], v[124:127], v[44:47]
    s_add_u32 s22, s19, 0x508000
    s_add_u32 m0, s20, 0x8400
    s_nop 0
    buffer_load_dwordx4 v3, s[4:7], s22 offen lds
    ds_read_b64_tr_b16 v[230:231], v5 offset:1568
    s_waitcnt lgkmcnt(4)
    v_mfma_f32_16x16x32_bf16 v[48:51], v[244:247], v[120:123], v[48:51]
    ds_read_b64_tr_b16 v[232:233], v4 offset:768
    v_mfma_f32_16x16x32_bf16 v[52:55], v[244:247], v[124:127], v[52:55]
    ds_read_b64_tr_b16 v[234:235], v4 offset:1792
    s_waitcnt lgkmcnt(4)
    v_mfma_f32_16x16x32_bf16 v[56:59], v[224:227], v[120:123], v[56:59]
    ds_read_b64_tr_b16 v[236:237], v5 offset:800
    v_mfma_f32_16x16x32_bf16 v[60:63], v[224:227], v[124:127], v[60:63]
    ds_read_b64_tr_b16 v[238:239], v5 offset:1824
    s_waitcnt lgkmcnt(4)
    v_mfma_f32_16x16x32_bf16 v[64:67], v[228:231], v[120:123], v[64:67]
    ds_read_b64_tr_b16 v[240:241], v4 offset:8192
    v_mfma_f32_16x16x32_bf16 v[68:71], v[228:231], v[124:127], v[68:71]
    ds_read_b64_tr_b16 v[242:243], v4 offset:9216
    s_mov_b32 s23, 0xd000
    buffer_load_dwordx4 v[108:111], v7, s[8:11], s23 offen offset:0 sc1
    s_waitcnt lgkmcnt(4)
    v_mfma_f32_16x16x32_bf16 v[72:75], v[232:235], v[120:123], v[72:75]
    ds_read_b64_tr_b16 v[244:245], v5 offset:8224
    v_mfma_f32_16x16x32_bf16 v[76:79], v[232:235], v[124:127], v[76:79]
    ds_read_b64_tr_b16 v[246:247], v5 offset:9248
    s_waitcnt lgkmcnt(4)
    v_mfma_f32_16x16x32_bf16 v[80:83], v[236:239], v[120:123], v[80:83]
    ds_read_b64_tr_b16 v[224:225], v4 offset:8448
    v_mfma_f32_16x16x32_bf16 v[84:87], v[236:239], v[124:127], v[84:87]
    ds_read_b64_tr_b16 v[226:227], v4 offset:9472
    s_waitcnt vmcnt(11) lgkmcnt(4)
    v_mfma_f32_16x16x32_bf16 v[24:27], v[240:243], v[128:131], v[24:27]
    ds_read_b64_tr_b16 v[228:229], v5 offset:8480
    s_waitcnt vmcnt(10)
    v_mfma_f32_16x16x32_bf16 v[28:31], v[240:243], v[132:135], v[28:31]
    ds_read_b64_tr_b16 v[230:231], v5 offset:9504
    s_waitcnt lgkmcnt(4)
    v_mfma_f32_16x16x32_bf16 v[32:35], v[244:247], v[128:131], v[32:35]
    ds_read_b64_tr_b16 v[232:233], v4 offset:8704
    v_mfma_f32_16x16x32_bf16 v[36:39], v[244:247], v[132:135], v[36:39]
    ds_read_b64_tr_b16 v[234:235], v4 offset:9728
    s_mov_b32 s23, 0x5000
    buffer_load_dwordx4 v[112:115], v7, s[8:11], s23 offen offset:1024 sc1
    s_waitcnt lgkmcnt(4)
    v_mfma_f32_16x16x32_bf16 v[40:43], v[224:227], v[128:131], v[40:43]
    ds_read_b64_tr_b16 v[236:237], v5 offset:8736
    v_mfma_f32_16x16x32_bf16 v[44:47], v[224:227], v[132:135], v[44:47]
    ds_read_b64_tr_b16 v[238:239], v5 offset:9760
    s_waitcnt lgkmcnt(4)
    v_mfma_f32_16x16x32_bf16 v[48:51], v[228:231], v[128:131], v[48:51]
    ds_read_b64_tr_b16 v[240:241], v4 offset:8960
    v_mfma_f32_16x16x32_bf16 v[52:55], v[228:231], v[132:135], v[52:55]
    ds_read_b64_tr_b16 v[242:243], v4 offset:9984
    s_waitcnt lgkmcnt(4)
    v_mfma_f32_16x16x32_bf16 v[56:59], v[232:235], v[128:131], v[56:59]
    ds_read_b64_tr_b16 v[244:245], v5 offset:8992
    v_mfma_f32_16x16x32_bf16 v[60:63], v[232:235], v[132:135], v[60:63]
    ds_read_b64_tr_b16 v[246:247], v5 offset:10016
    s_waitcnt lgkmcnt(4)
    v_mfma_f32_16x16x32_bf16 v[64:67], v[236:239], v[128:131], v[64:67]
    v_mfma_f32_16x16x32_bf16 v[68:71], v[236:239], v[132:135], v[68:71]
    s_waitcnt vmcnt(8)
    s_barrier
    ds_read_b64_tr_b16 v[224:225], v4 offset:16384
    ds_read_b64_tr_b16 v[226:227], v4 offset:17408
    s_mov_b32 s23, 0xd000
    buffer_load_dwordx4 v[116:119], v7, s[8:11], s23 offen offset:1024 sc1
    s_waitcnt lgkmcnt(4)
    v_mfma_f32_16x16x32_bf16 v[72:75], v[240:243], v[128:131], v[72:75]
    ds_read_b64_tr_b16 v[228:229], v5 offset:16416
    v_mfma_f32_16x16x32_bf16 v[76:79], v[240:243], v[132:135], v[76:79]
    s_add_u32 s22, s19, 0x580000
    s_add_u32 m0, s20, 0xc000
    s_nop 0
    buffer_load_dwordx4 v3, s[4:7], s22 offen lds
    ds_read_b64_tr_b16 v[230:231], v5 offset:17440
    s_waitcnt lgkmcnt(4)
    v_mfma_f32_16x16x32_bf16 v[80:83], v[244:247], v[128:131], v[80:83]
    ds_read_b64_tr_b16 v[232:233], v4 offset:16640
    v_mfma_f32_16x16x32_bf16 v[84:87], v[244:247], v[132:135], v[84:87]
    ds_read_b64_tr_b16 v[234:235], v4 offset:17664
    s_waitcnt lgkmcnt(4)
    v_mfma_f32_16x16x32_bf16 v[24:27], v[224:227], v[88:91], v[24:27]
    ds_read_b64_tr_b16 v[236:237], v5 offset:16672
    s_waitcnt vmcnt(9)
    v_mfma_f32_16x16x32_bf16 v[28:31], v[224:227], v[92:95], v[28:31]
    ds_read_b64_tr_b16 v[238:239], v5 offset:17696
    s_waitcnt lgkmcnt(4)
    v_mfma_f32_16x16x32_bf16 v[32:35], v[228:231], v[88:91], v[32:35]
    ds_read_b64_tr_b16 v[240:241], v4 offset:16896
    v_mfma_f32_16x16x32_bf16 v[36:39], v[228:231], v[92:95], v[36:39]
    ds_read_b64_tr_b16 v[242:243], v4 offset:17920
    s_mov_b32 s23, 0x5800
    buffer_load_dwordx4 v[120:123], v7, s[8:11], s23 offen offset:0 sc1
    s_waitcnt lgkmcnt(4)
    v_mfma_f32_16x16x32_bf16 v[40:43], v[232:235], v[88:91], v[40:43]
    ds_read_b64_tr_b16 v[244:245], v5 offset:16928
    v_mfma_f32_16x16x32_bf16 v[44:47], v[232:235], v[92:95], v[44:47]
    s_add_u32 s22, s19, 0x588000
    s_add_u32 m0, s20, 0xc400
    s_nop 0
    buffer_load_dwordx4 v3, s[4:7], s22 offen lds
    ds_read_b64_tr_b16 v[246:247], v5 offset:17952
    s_waitcnt lgkmcnt(4)
    v_mfma_f32_16x16x32_bf16 v[48:51], v[236:239], v[88:91], v[48:51]
    ds_read_b64_tr_b16 v[224:225], v4 offset:17152
    v_mfma_f32_16x16x32_bf16 v[52:55], v[236:239], v[92:95], v[52:55]
    ds_read_b64_tr_b16 v[226:227], v4 offset:18176
    s_waitcnt lgkmcnt(4)
    v_mfma_f32_16x16x32_bf16 v[56:59], v[240:243], v[88:91], v[56:59]
    ds_read_b64_tr_b16 v[228:229], v5 offset:17184
    v_mfma_f32_16x16x32_bf16 v[60:63], v[240:243], v[92:95], v[60:63]
    ds_read_b64_tr_b16 v[230:231], v5 offset:18208
    s_waitcnt lgkmcnt(4)
    v_mfma_f32_16x16x32_bf16 v[64:67], v[244:247], v[88:91], v[64:67]
    ds_read_b64_tr_b16 v[232:233], v4 offset:24576
    v_mfma_f32_16x16x32_bf16 v[68:71], v[244:247], v[92:95], v[68:71]
    ds_read_b64_tr_b16 v[234:235], v4 offset:25600
    s_mov_b32 s23, 0xd800
    buffer_load_dwordx4 v[124:127], v7, s[8:11], s23 offen offset:0 sc1
    s_waitcnt lgkmcnt(4)
    v_mfma_f32_16x16x32_bf16 v[72:75], v[224:227], v[88:91], v[72:75]
    ds_read_b64_tr_b16 v[236:237], v5 offset:24608
    v_xor_b32 v8, s28, v12
    v_xor_b32 v20, s28, v13
    v_or_b32 v8, v8, v20
    v_xor_b32 v20, s28, v14
    v_or_b32 v8, v8, v20
    v_xor_b32 v20, s28, v15
    v_or_b32 v8, v8, v20
    v_cmp_ne_u32 vcc, 0, v8
    s_cbranch_vccnz adaLN_cond__sliding_block_cached__moe_arch_mod__prompt_kernel_kv4r
adaLN_cond__sliding_block_cached__moe_arch_mod__prompt_kernel_kv4b:
    v_mfma_f32_16x16x32_bf16 v[76:79], v[224:227], v[92:95], v[76:79]
    ds_read_b64_tr_b16 v[238:239], v5 offset:25632
    v_mov_b32 v20, 0
    s_mov_b32 s16, 0x564000
    buffer_load_dword v8, v20, s[8:11], s16 offen sc1
    s_waitcnt lgkmcnt(4)
    v_mfma_f32_16x16x32_bf16 v[80:83], v[228:231], v[88:91], v[80:83]
    ds_read_b64_tr_b16 v[240:241], v4 offset:24832
    v_mfma_f32_16x16x32_bf16 v[84:87], v[228:231], v[92:95], v[84:87]
    ds_read_b64_tr_b16 v[242:243], v4 offset:25856
    s_waitcnt vmcnt(12) lgkmcnt(4)
    v_mfma_f32_16x16x32_bf16 v[24:27], v[232:235], v[96:99], v[24:27]
    ds_read_b64_tr_b16 v[244:245], v5 offset:24864
    s_waitcnt vmcnt(11)
    v_mfma_f32_16x16x32_bf16 v[28:31], v[232:235], v[100:103], v[28:31]
    ds_read_b64_tr_b16 v[246:247], v5 offset:25888
    s_waitcnt lgkmcnt(4)
    v_mfma_f32_16x16x32_bf16 v[32:35], v[236:239], v[96:99], v[32:35]
    ds_read_b64_tr_b16 v[224:225], v4 offset:25088
    v_mfma_f32_16x16x32_bf16 v[36:39], v[236:239], v[100:103], v[36:39]
    ds_read_b64_tr_b16 v[226:227], v4 offset:26112
    s_mov_b32 s23, 0x5800
    buffer_load_dwordx4 v[128:131], v7, s[8:11], s23 offen offset:1024 sc1
    s_waitcnt lgkmcnt(4)
    v_mfma_f32_16x16x32_bf16 v[40:43], v[240:243], v[96:99], v[40:43]
    ds_read_b64_tr_b16 v[228:229], v5 offset:25120
    v_mfma_f32_16x16x32_bf16 v[44:47], v[240:243], v[100:103], v[44:47]
    ds_read_b64_tr_b16 v[230:231], v5 offset:26144
    s_waitcnt lgkmcnt(4)
    v_mfma_f32_16x16x32_bf16 v[48:51], v[244:247], v[96:99], v[48:51]
    ds_read_b64_tr_b16 v[232:233], v4 offset:25344
    v_mfma_f32_16x16x32_bf16 v[52:55], v[244:247], v[100:103], v[52:55]
    ds_read_b64_tr_b16 v[234:235], v4 offset:26368
    s_waitcnt lgkmcnt(4)
    v_mfma_f32_16x16x32_bf16 v[56:59], v[224:227], v[96:99], v[56:59]
    ds_read_b64_tr_b16 v[236:237], v5 offset:25376
    v_mfma_f32_16x16x32_bf16 v[60:63], v[224:227], v[100:103], v[60:63]
    ds_read_b64_tr_b16 v[238:239], v5 offset:26400
    s_waitcnt lgkmcnt(4)
    v_mfma_f32_16x16x32_bf16 v[64:67], v[228:231], v[96:99], v[64:67]
    v_mfma_f32_16x16x32_bf16 v[68:71], v[228:231], v[100:103], v[68:71]
    s_waitcnt vmcnt(9)
    s_barrier
    ds_read_b64_tr_b16 v[240:241], v4 offset:32768
    ds_read_b64_tr_b16 v[242:243], v4 offset:33792
    s_mov_b32 s23, 0xd800
    buffer_load_dwordx4 v[132:135], v7, s[8:11], s23 offen offset:1024 sc1
    s_waitcnt lgkmcnt(4)
    v_mfma_f32_16x16x32_bf16 v[72:75], v[232:235], v[96:99], v[72:75]
    ds_read_b64_tr_b16 v[244:245], v5 offset:32800
    v_mfma_f32_16x16x32_bf16 v[76:79], v[232:235], v[100:103], v[76:79]
    s_add_u32 s22, s19, 0x600000
    s_add_u32 m0, s20, 0x0
    s_nop 0
    buffer_load_dwordx4 v3, s[4:7], s22 offen lds
    ds_read_b64_tr_b16 v[246:247], v5 offset:33824
    s_waitcnt lgkmcnt(4)
    v_mfma_f32_16x16x32_bf16 v[80:83], v[236:239], v[96:99], v[80:83]
    ds_read_b64_tr_b16 v[224:225], v4 offset:33024
    v_mfma_f32_16x16x32_bf16 v[84:87], v[236:239], v[100:103], v[84:87]
    ds_read_b64_tr_b16 v[226:227], v4 offset:34048
    s_waitcnt lgkmcnt(4)
    v_mfma_f32_16x16x32_bf16 v[24:27], v[240:243], v[104:107], v[24:27]
    ds_read_b64_tr_b16 v[228:229], v5 offset:33056
    s_waitcnt vmcnt(10)
    v_mfma_f32_16x16x32_bf16 v[28:31], v[240:243], v[108:111], v[28:31]
    ds_read_b64_tr_b16 v[230:231], v5 offset:34080
    s_waitcnt lgkmcnt(4)
    v_mfma_f32_16x16x32_bf16 v[32:35], v[244:247], v[104:107], v[32:35]
    ds_read_b64_tr_b16 v[232:233], v4 offset:33280
    v_mfma_f32_16x16x32_bf16 v[36:39], v[244:247], v[108:111], v[36:39]
    ds_read_b64_tr_b16 v[234:235], v4 offset:34304
    s_mov_b32 s23, 0x6000
    buffer_load_dwordx4 v[88:91], v7, s[8:11], s23 offen offset:0 sc1
    s_waitcnt lgkmcnt(4)
    v_mfma_f32_16x16x32_bf16 v[40:43], v[224:227], v[104:107], v[40:43]
    ds_read_b64_tr_b16 v[236:237], v5 offset:33312
    v_mfma_f32_16x16x32_bf16 v[44:47], v[224:227], v[108:111], v[44:47]
    s_add_u32 s22, s19, 0x608000
    s_add_u32 m0, s20, 0x400
    s_nop 0
    buffer_load_dwordx4 v3, s[4:7], s22 offen lds
    ds_read_b64_tr_b16 v[238:239], v5 offset:34336
    s_waitcnt lgkmcnt(4)
    v_mfma_f32_16x16x32_bf16 v[48:51], v[228:231], v[104:107], v[48:51]
    ds_read_b64_tr_b16 v[240:241], v4 offset:33536
    v_mfma_f32_16x16x32_bf16 v[52:55], v[228:231], v[108:111], v[52:55]
    ds_read_b64_tr_b16 v[242:243], v4 offset:34560
    s_waitcnt lgkmcnt(4)
    v_mfma_f32_16x16x32_bf16 v[56:59], v[232:235], v[104:107], v[56:59]
    ds_read_b64_tr_b16 v[244:245], v5 offset:33568
    v_mfma_f32_16x16x32_bf16 v[60:63], v[232:235], v[108:111], v[60:63]
    ds_read_b64_tr_b16 v[246:247], v5 offset:34592
    s_waitcnt lgkmcnt(4)
    v_mfma_f32_16x16x32_bf16 v[64:67], v[236:239], v[104:107], v[64:67]
    ds_read_b64_tr_b16 v[224:225], v4 offset:40960
    v_mfma_f32_16x16x32_bf16 v[68:71], v[236:239], v[108:111], v[68:71]
    ds_read_b64_tr_b16 v[226:227], v4 offset:41984
    s_mov_b32 s23, 0xe000
    buffer_load_dwordx4 v[92:95], v7, s[8:11], s23 offen offset:0 sc1
    s_waitcnt lgkmcnt(4)
    v_mfma_f32_16x16x32_bf16 v[72:75], v[240:243], v[104:107], v[72:75]
    ds_read_b64_tr_b16 v[228:229], v5 offset:40992
    v_mfma_f32_16x16x32_bf16 v[76:79], v[240:243], v[108:111], v[76:79]
    ds_read_b64_tr_b16 v[230:231], v5 offset:42016
    s_waitcnt lgkmcnt(4)
    v_mfma_f32_16x16x32_bf16 v[80:83], v[244:247], v[104:107], v[80:83]
    ds_read_b64_tr_b16 v[232:233], v4 offset:41216
    v_mfma_f32_16x16x32_bf16 v[84:87], v[244:247], v[108:111], v[84:87]
    ds_read_b64_tr_b16 v[234:235], v4 offset:42240
    s_waitcnt vmcnt(12) lgkmcnt(4)
    v_mfma_f32_16x16x32_bf16 v[24:27], v[224:227], v[112:115], v[24:27]
    ds_read_b64_tr_b16 v[236:237], v5 offset:41248
    s_add_u32 s22, s21, 0x0
    s_add_u32 m0, s20, 0x10000
    s_nop 0
    buffer_load_dwordx4 v2, s[8:11], s22 offen sc1 lds
    s_waitcnt vmcnt(12)
    v_mfma_f32_16x16x32_bf16 v[28:31], v[224:227], v[116:119], v[28:31]
    ds_read_b64_tr_b16 v[238:239], v5 offset:42272
    s_waitcnt lgkmcnt(4)
    v_mfma_f32_16x16x32_bf16 v[32:35], v[228:231], v[112:115], v[32:35]
    ds_read_b64_tr_b16 v[240:241], v4 offset:41472
    v_mfma_f32_16x16x32_bf16 v[36:39], v[228:231], v[116:119], v[36:39]
    ds_read_b64_tr_b16 v[242:243], v4 offset:42496
    s_mov_b32 s23, 0x6000
    buffer_load_dwordx4 v[96:99], v7, s[8:11], s23 offen offset:1024 sc1
    s_waitcnt lgkmcnt(4)
    v_mfma_f32_16x16x32_bf16 v[40:43], v[232:235], v[112:115], v[40:43]
    ds_read_b64_tr_b16 v[244:245], v5 offset:41504
    s_add_u32 s22, s21, 0x400
    s_add_u32 m0, s20, 0x10400
    s_nop 0
    buffer_load_dwordx4 v2, s[8:11], s22 offen sc1 lds
    v_mfma_f32_16x16x32_bf16 v[44:47], v[232:235], v[116:119], v[44:47]
    ds_read_b64_tr_b16 v[246:247], v5 offset:42528
    s_waitcnt lgkmcnt(4)
    v_mfma_f32_16x16x32_bf16 v[48:51], v[236:239], v[112:115], v[48:51]
    ds_read_b64_tr_b16 v[224:225], v4 offset:41728
    v_mfma_f32_16x16x32_bf16 v[52:55], v[236:239], v[116:119], v[52:55]
    ds_read_b64_tr_b16 v[226:227], v4 offset:42752
    s_waitcnt lgkmcnt(4)
    v_mfma_f32_16x16x32_bf16 v[56:59], v[240:243], v[112:115], v[56:59]
    ds_read_b64_tr_b16 v[228:229], v5 offset:41760
    v_mfma_f32_16x16x32_bf16 v[60:63], v[240:243], v[116:119], v[60:63]
    ds_read_b64_tr_b16 v[230:231], v5 offset:42784
    s_waitcnt lgkmcnt(4)
    v_mfma_f32_16x16x32_bf16 v[64:67], v[244:247], v[112:115], v[64:67]
    v_mfma_f32_16x16x32_bf16 v[68:71], v[244:247], v[116:119], v[68:71]
    s_waitcnt vmcnt(11)
    s_barrier
    ds_read_b64_tr_b16 v[232:233], v4 offset:49152
    ds_read_b64_tr_b16 v[234:235], v4 offset:50176
    s_mov_b32 s23, 0xe000
    buffer_load_dwordx4 v[100:103], v7, s[8:11], s23 offen offset:1024 sc1
    s_waitcnt lgkmcnt(4)
    v_mfma_f32_16x16x32_bf16 v[72:75], v[224:227], v[112:115], v[72:75]
    ds_read_b64_tr_b16 v[236:237], v5 offset:49184
    v_mfma_f32_16x16x32_bf16 v[76:79], v[224:227], v[116:119], v[76:79]
    s_add_u32 s22, s19, 0x680000
    s_add_u32 m0, s20, 0x4000
    s_nop 0
    buffer_load_dwordx4 v3, s[4:7], s22 offen lds
    ds_read_b64_tr_b16 v[238:239], v5 offset:50208
    s_waitcnt lgkmcnt(4)
    v_mfma_f32_16x16x32_bf16 v[80:83], v[228:231], v[112:115], v[80:83]
    ds_read_b64_tr_b16 v[240:241], v4 offset:49408
    v_mfma_f32_16x16x32_bf16 v[84:87], v[228:231], v[116:119], v[84:87]
    ds_read_b64_tr_b16 v[242:243], v4 offset:50432
    s_waitcnt lgkmcnt(4)
    v_mfma_f32_16x16x32_bf16 v[24:27], v[232:235], v[120:123], v[24:27]
    ds_read_b64_tr_b16 v[244:245], v5 offset:49440
    s_waitcnt vmcnt(12)
    v_mfma_f32_16x16x32_bf16 v[28:31], v[232:235], v[124:127], v[28:31]
    ds_read_b64_tr_b16 v[246:247], v5 offset:50464
    s_waitcnt lgkmcnt(4)
    v_mfma_f32_16x16x32_bf16 v[32:35], v[236:239], v[120:123], v[32:35]
    ds_read_b64_tr_b16 v[224:225], v4 offset:49664
    v_mfma_f32_16x16x32_bf16 v[36:39], v[236:239], v[124:127], v[36:39]
    ds_read_b64_tr_b16 v[226:227], v4 offset:50688
    s_mov_b32 s23, 0x6800
    buffer_load_dwordx4 v[104:107], v7, s[8:11], s23 offen offset:0 sc1
    s_waitcnt lgkmcnt(4)
    v_mfma_f32_16x16x32_bf16 v[40:43], v[240:243], v[120:123], v[40:43]
    ds_read_b64_tr_b16 v[228:229], v5 offset:49696
    v_mfma_f32_16x16x32_bf16 v[44:47], v[240:243], v[124:127], v[44:47]
    s_add_u32 s22, s19, 0x688000
    s_add_u32 m0, s20, 0x4400
    s_nop 0
    buffer_load_dwordx4 v3, s[4:7], s22 offen lds
    ds_read_b64_tr_b16 v[230:231], v5 offset:50720
    s_waitcnt lgkmcnt(4)
    v_mfma_f32_16x16x32_bf16 v[48:51], v[244:247], v[120:123], v[48:51]
    ds_read_b64_tr_b16 v[232:233], v4 offset:49920
    v_mfma_f32_16x16x32_bf16 v[52:55], v[244:247], v[124:127], v[52:55]
    ds_read_b64_tr_b16 v[234:235], v4 offset:50944
    s_waitcnt lgkmcnt(4)
    v_mfma_f32_16x16x32_bf16 v[56:59], v[224:227], v[120:123], v[56:59]
    ds_read_b64_tr_b16 v[236:237], v5 offset:49952
    v_mfma_f32_16x16x32_bf16 v[60:63], v[224:227], v[124:127], v[60:63]
    ds_read_b64_tr_b16 v[238:239], v5 offset:50976
    s_waitcnt lgkmcnt(4)
    v_mfma_f32_16x16x32_bf16 v[64:67], v[228:231], v[120:123], v[64:67]
    ds_read_b64_tr_b16 v[240:241], v4 offset:57344
    v_mfma_f32_16x16x32_bf16 v[68:71], v[228:231], v[124:127], v[68:71]
    ds_read_b64_tr_b16 v[242:243], v4 offset:58368
    s_mov_b32 s23, 0xe800
    buffer_load_dwordx4 v[108:111], v7, s[8:11], s23 offen offset:0 sc1
    s_waitcnt lgkmcnt(4)
    v_mfma_f32_16x16x32_bf16 v[72:75], v[232:235], v[120:123], v[72:75]
    ds_read_b64_tr_b16 v[244:245], v5 offset:57376
    v_mfma_f32_16x16x32_bf16 v[76:79], v[232:235], v[124:127], v[76:79]
    ds_read_b64_tr_b16 v[246:247], v5 offset:58400
    s_waitcnt lgkmcnt(4)
    v_mfma_f32_16x16x32_bf16 v[80:83], v[236:239], v[120:123], v[80:83]
    ds_read_b64_tr_b16 v[224:225], v4 offset:57600
    v_mfma_f32_16x16x32_bf16 v[84:87], v[236:239], v[124:127], v[84:87]
    ds_read_b64_tr_b16 v[226:227], v4 offset:58624
    s_waitcnt vmcnt(13) lgkmcnt(4)
    v_mfma_f32_16x16x32_bf16 v[24:27], v[240:243], v[128:131], v[24:27]
    ds_read_b64_tr_b16 v[228:229], v5 offset:57632
    s_add_u32 s22, s21, 0x4000
    s_add_u32 m0, s20, 0x14000
    s_nop 0
    buffer_load_dwordx4 v2, s[8:11], s22 offen sc1 lds
    s_waitcnt vmcnt(13)
    v_mfma_f32_16x16x32_bf16 v[28:31], v[240:243], v[132:135], v[28:31]
    ds_read_b64_tr_b16 v[230:231], v5 offset:58656
    s_waitcnt lgkmcnt(4)
    v_mfma_f32_16x16x32_bf16 v[32:35], v[244:247], v[128:131], v[32:35]
    ds_read_b64_tr_b16 v[232:233], v4 offset:57856
    v_mfma_f32_16x16x32_bf16 v[36:39], v[244:247], v[132:135], v[36:39]
    ds_read_b64_tr_b16 v[234:235], v4 offset:58880
    s_mov_b32 s23, 0x6800
    buffer_load_dwordx4 v[112:115], v7, s[8:11], s23 offen offset:1024 sc1
    s_waitcnt lgkmcnt(4)
    v_mfma_f32_16x16x32_bf16 v[40:43], v[224:227], v[128:131], v[40:43]
    ds_read_b64_tr_b16 v[236:237], v5 offset:57888
    s_add_u32 s22, s21, 0x4400
    s_add_u32 m0, s20, 0x14400
    s_nop 0
    buffer_load_dwordx4 v2, s[8:11], s22 offen sc1 lds
    v_mfma_f32_16x16x32_bf16 v[44:47], v[224:227], v[132:135], v[44:47]
    ds_read_b64_tr_b16 v[238:239], v5 offset:58912
    s_waitcnt lgkmcnt(4)
    v_mfma_f32_16x16x32_bf16 v[48:51], v[228:231], v[128:131], v[48:51]
    ds_read_b64_tr_b16 v[240:241], v4 offset:58112
    v_mfma_f32_16x16x32_bf16 v[52:55], v[228:231], v[132:135], v[52:55]
    ds_read_b64_tr_b16 v[242:243], v4 offset:59136
    s_waitcnt lgkmcnt(4)
    v_mfma_f32_16x16x32_bf16 v[56:59], v[232:235], v[128:131], v[56:59]
    ds_read_b64_tr_b16 v[244:245], v5 offset:58144
    v_mfma_f32_16x16x32_bf16 v[60:63], v[232:235], v[132:135], v[60:63]
    ds_read_b64_tr_b16 v[246:247], v5 offset:59168
    s_waitcnt lgkmcnt(4)
    v_mfma_f32_16x16x32_bf16 v[64:67], v[236:239], v[128:131], v[64:67]
    v_mfma_f32_16x16x32_bf16 v[68:71], v[236:239], v[132:135], v[68:71]
    s_waitcnt vmcnt(12)
    s_barrier
    ds_read_b64_tr_b16 v[224:225], v4 offset:0
    ds_read_b64_tr_b16 v[226:227], v4 offset:1024
    s_mov_b32 s23, 0xe800
    buffer_load_dwordx4 v[116:119], v7, s[8:11], s23 offen offset:1024 sc1
    s_waitcnt lgkmcnt(4)
    v_mfma_f32_16x16x32_bf16 v[72:75], v[240:243], v[128:131], v[72:75]
    ds_read_b64_tr_b16 v[228:229], v5 offset:32
    v_mfma_f32_16x16x32_bf16 v[76:79], v[240:243], v[132:135], v[76:79]
    s_add_u32 s22, s19, 0x700000
    s_add_u32 m0, s20, 0x8000
    s_nop 0
    buffer_load_dwordx4 v3, s[4:7], s22 offen lds
    ds_read_b64_tr_b16 v[230:231], v5 offset:1056
    s_waitcnt lgkmcnt(4)
    v_mfma_f32_16x16x32_bf16 v[80:83], v[244:247], v[128:131], v[80:83]
    ds_read_b64_tr_b16 v[232:233], v4 offset:256
    v_mfma_f32_16x16x32_bf16 v[84:87], v[244:247], v[132:135], v[84:87]
    ds_read_b64_tr_b16 v[234:235], v4 offset:1280
    s_waitcnt lgkmcnt(4)
    v_mfma_f32_16x16x32_bf16 v[24:27], v[224:227], v[88:91], v[24:27]
    ds_read_b64_tr_b16 v[236:237], v5 offset:288
    s_waitcnt vmcnt(13)
    v_mfma_f32_16x16x32_bf16 v[28:31], v[224:227], v[92:95], v[28:31]
    ds_read_b64_tr_b16 v[238:239], v5 offset:1312
    s_waitcnt lgkmcnt(4)
    v_mfma_f32_16x16x32_bf16 v[32:35], v[228:231], v[88:91], v[32:35]
    ds_read_b64_tr_b16 v[240:241], v4 offset:512
    v_mfma_f32_16x16x32_bf16 v[36:39], v[228:231], v[92:95], v[36:39]
    ds_read_b64_tr_b16 v[242:243], v4 offset:1536
    s_mov_b32 s23, 0x7000
    buffer_load_dwordx4 v[120:123], v7, s[8:11], s23 offen offset:0 sc1
    s_waitcnt lgkmcnt(4)
    v_mfma_f32_16x16x32_bf16 v[40:43], v[232:235], v[88:91], v[40:43]
    ds_read_b64_tr_b16 v[244:245], v5 offset:544
    v_mfma_f32_16x16x32_bf16 v[44:47], v[232:235], v[92:95], v[44:47]
    s_add_u32 s22, s19, 0x708000
    s_add_u32 m0, s20, 0x8400
    s_nop 0
    buffer_load_dwordx4 v3, s[4:7], s22 offen lds
    ds_read_b64_tr_b16 v[246:247], v5 offset:1568
    s_waitcnt lgkmcnt(4)
    v_mfma_f32_16x16x32_bf16 v[48:51], v[236:239], v[88:91], v[48:51]
    ds_read_b64_tr_b16 v[224:225], v4 offset:768
    v_mfma_f32_16x16x32_bf16 v[52:55], v[236:239], v[92:95], v[52:55]
    ds_read_b64_tr_b16 v[226:227], v4 offset:1792
    s_waitcnt lgkmcnt(4)
    v_mfma_f32_16x16x32_bf16 v[56:59], v[240:243], v[88:91], v[56:59]
    ds_read_b64_tr_b16 v[228:229], v5 offset:800
    v_mfma_f32_16x16x32_bf16 v[60:63], v[240:243], v[92:95], v[60:63]
    ds_read_b64_tr_b16 v[230:231], v5 offset:1824
    s_waitcnt lgkmcnt(4)
    v_mfma_f32_16x16x32_bf16 v[64:67], v[244:247], v[88:91], v[64:67]
    ds_read_b64_tr_b16 v[232:233], v4 offset:8192
    v_mfma_f32_16x16x32_bf16 v[68:71], v[244:247], v[92:95], v[68:71]
    ds_read_b64_tr_b16 v[234:235], v4 offset:9216
    s_mov_b32 s23, 0xf000
    buffer_load_dwordx4 v[124:127], v7, s[8:11], s23 offen offset:0 sc1
    s_waitcnt lgkmcnt(4)
    v_mfma_f32_16x16x32_bf16 v[72:75], v[224:227], v[88:91], v[72:75]
    ds_read_b64_tr_b16 v[236:237], v5 offset:8224
    v_mfma_f32_16x16x32_bf16 v[76:79], v[224:227], v[92:95], v[76:79]
    ds_read_b64_tr_b16 v[238:239], v5 offset:9248
    s_waitcnt lgkmcnt(4)
    v_mfma_f32_16x16x32_bf16 v[80:83], v[228:231], v[88:91], v[80:83]
    ds_read_b64_tr_b16 v[240:241], v4 offset:8448
    v_mfma_f32_16x16x32_bf16 v[84:87], v[228:231], v[92:95], v[84:87]
    ds_read_b64_tr_b16 v[242:243], v4 offset:9472
    s_waitcnt vmcnt(14) lgkmcnt(4)
    v_mfma_f32_16x16x32_bf16 v[24:27], v[232:235], v[96:99], v[24:27]
    ds_read_b64_tr_b16 v[244:245], v5 offset:8480
    s_add_u32 s22, s21, 0x8000
    s_add_u32 m0, s20, 0x18000
    s_nop 0
    buffer_load_dwordx4 v2, s[8:11], s22 offen sc1 lds
    s_waitcnt vmcnt(13)
    v_mfma_f32_16x16x32_bf16 v[28:31], v[232:235], v[100:103], v[28:31]
    ds_read_b64_tr_b16 v[246:247], v5 offset:9504
    s_waitcnt lgkmcnt(4)
    v_mfma_f32_16x16x32_bf16 v[32:35], v[236:239], v[96:99], v[32:35]
    ds_read_b64_tr_b16 v[224:225], v4 offset:8704
    v_mfma_f32_16x16x32_bf16 v[36:39], v[236:239], v[100:103], v[36:39]
    ds_read_b64_tr_b16 v[226:227], v4 offset:9728
    s_mov_b32 s23, 0x7000
    buffer_load_dwordx4 v[128:131], v7, s[8:11], s23 offen offset:1024 sc1
    s_waitcnt lgkmcnt(4)
    v_mfma_f32_16x16x32_bf16 v[40:43], v[240:243], v[96:99], v[40:43]
    ds_read_b64_tr_b16 v[228:229], v5 offset:8736
    s_add_u32 s22, s21, 0x8400
    s_add_u32 m0, s20, 0x18400
    s_nop 0
    buffer_load_dwordx4 v2, s[8:11], s22 offen sc1 lds
    v_mfma_f32_16x16x32_bf16 v[44:47], v[240:243], v[100:103], v[44:47]
    ds_read_b64_tr_b16 v[230:231], v5 offset:9760
    s_waitcnt lgkmcnt(4)
    v_mfma_f32_16x16x32_bf16 v[48:51], v[244:247], v[96:99], v[48:51]
    ds_read_b64_tr_b16 v[232:233], v4 offset:8960
    v_mfma_f32_16x16x32_bf16 v[52:55], v[244:247], v[100:103], v[52:55]
    ds_read_b64_tr_b16 v[234:235], v4 offset:9984
    s_waitcnt lgkmcnt(4)
    v_mfma_f32_16x16x32_bf16 v[56:59], v[224:227], v[96:99], v[56:59]
    ds_read_b64_tr_b16 v[236:237], v5 offset:8992
    v_mfma_f32_16x16x32_bf16 v[60:63], v[224:227], v[100:103], v[60:63]
    ds_read_b64_tr_b16 v[238:239], v5 offset:10016
    s_waitcnt lgkmcnt(4)
    v_mfma_f32_16x16x32_bf16 v[64:67], v[228:231], v[96:99], v[64:67]
    v_mfma_f32_16x16x32_bf16 v[68:71], v[228:231], v[100:103], v[68:71]
    s_waitcnt vmcnt(12)
    s_barrier
    ds_read_b64_tr_b16 v[240:241], v4 offset:16384
    ds_read_b64_tr_b16 v[242:243], v4 offset:17408
    s_mov_b32 s23, 0xf000
    buffer_load_dwordx4 v[132:135], v7, s[8:11], s23 offen offset:1024 sc1
    s_waitcnt lgkmcnt(4)
    v_mfma_f32_16x16x32_bf16 v[72:75], v[232:235], v[96:99], v[72:75]
    ds_read_b64_tr_b16 v[244:245], v5 offset:16416
    v_mfma_f32_16x16x32_bf16 v[76:79], v[232:235], v[100:103], v[76:79]
    s_add_u32 s22, s19, 0x780000
    s_add_u32 m0, s20, 0xc000
    s_nop 0
    buffer_load_dwordx4 v3, s[4:7], s22 offen lds
    ds_read_b64_tr_b16 v[246:247], v5 offset:17440
    s_waitcnt lgkmcnt(4)
    v_mfma_f32_16x16x32_bf16 v[80:83], v[236:239], v[96:99], v[80:83]
    ds_read_b64_tr_b16 v[224:225], v4 offset:16640
    v_mfma_f32_16x16x32_bf16 v[84:87], v[236:239], v[100:103], v[84:87]
    ds_read_b64_tr_b16 v[226:227], v4 offset:17664
    s_waitcnt lgkmcnt(4)
    v_mfma_f32_16x16x32_bf16 v[24:27], v[240:243], v[104:107], v[24:27]
    ds_read_b64_tr_b16 v[228:229], v5 offset:16672
    s_waitcnt vmcnt(13)
    v_mfma_f32_16x16x32_bf16 v[28:31], v[240:243], v[108:111], v[28:31]
    ds_read_b64_tr_b16 v[230:231], v5 offset:17696
    s_waitcnt lgkmcnt(4)
    v_mfma_f32_16x16x32_bf16 v[32:35], v[244:247], v[104:107], v[32:35]
    ds_read_b64_tr_b16 v[232:233], v4 offset:16896
    v_mfma_f32_16x16x32_bf16 v[36:39], v[244:247], v[108:111], v[36:39]
    ds_read_b64_tr_b16 v[234:235], v4 offset:17920
    s_mov_b32 s23, 0x7800
    buffer_load_dwordx4 v[88:91], v7, s[8:11], s23 offen offset:0 sc1
    s_waitcnt lgkmcnt(4)
    v_mfma_f32_16x16x32_bf16 v[40:43], v[224:227], v[104:107], v[40:43]
    ds_read_b64_tr_b16 v[236:237], v5 offset:16928
    v_mfma_f32_16x16x32_bf16 v[44:47], v[224:227], v[108:111], v[44:47]
    s_add_u32 s22, s19, 0x788000
    s_add_u32 m0, s20, 0xc400
    s_nop 0
    buffer_load_dwordx4 v3, s[4:7], s22 offen lds
    ds_read_b64_tr_b16 v[238:239], v5 offset:17952
    s_waitcnt lgkmcnt(4)
    v_mfma_f32_16x16x32_bf16 v[48:51], v[228:231], v[104:107], v[48:51]
    ds_read_b64_tr_b16 v[240:241], v4 offset:17152
    v_mfma_f32_16x16x32_bf16 v[52:55], v[228:231], v[108:111], v[52:55]
    ds_read_b64_tr_b16 v[242:243], v4 offset:18176
    s_waitcnt lgkmcnt(4)
    v_mfma_f32_16x16x32_bf16 v[56:59], v[232:235], v[104:107], v[56:59]
    ds_read_b64_tr_b16 v[244:245], v5 offset:17184
    v_mfma_f32_16x16x32_bf16 v[60:63], v[232:235], v[108:111], v[60:63]
    ds_read_b64_tr_b16 v[246:247], v5 offset:18208
    s_waitcnt lgkmcnt(4)
    v_mfma_f32_16x16x32_bf16 v[64:67], v[236:239], v[104:107], v[64:67]
    ds_read_b64_tr_b16 v[224:225], v4 offset:24576
    v_mfma_f32_16x16x32_bf16 v[68:71], v[236:239], v[108:111], v[68:71]
    ds_read_b64_tr_b16 v[226:227], v4 offset:25600
    s_mov_b32 s23, 0xf800
    buffer_load_dwordx4 v[92:95], v7, s[8:11], s23 offen offset:0 sc1
    s_waitcnt lgkmcnt(4)
    v_mfma_f32_16x16x32_bf16 v[72:75], v[240:243], v[104:107], v[72:75]
    ds_read_b64_tr_b16 v[228:229], v5 offset:24608
    v_mfma_f32_16x16x32_bf16 v[76:79], v[240:243], v[108:111], v[76:79]
    ds_read_b64_tr_b16 v[230:231], v5 offset:25632
    s_waitcnt lgkmcnt(4)
    v_mfma_f32_16x16x32_bf16 v[80:83], v[244:247], v[104:107], v[80:83]
    ds_read_b64_tr_b16 v[232:233], v4 offset:24832
    v_mfma_f32_16x16x32_bf16 v[84:87], v[244:247], v[108:111], v[84:87]
    ds_read_b64_tr_b16 v[234:235], v4 offset:25856
    s_waitcnt vmcnt(14) lgkmcnt(4)
    v_mfma_f32_16x16x32_bf16 v[24:27], v[224:227], v[112:115], v[24:27]
    ds_read_b64_tr_b16 v[236:237], v5 offset:24864
    s_add_u32 s22, s21, 0xc000
    s_add_u32 m0, s20, 0x1c000
    s_nop 0
    buffer_load_dwordx4 v2, s[8:11], s22 offen sc1 lds
    s_waitcnt vmcnt(13)
    v_mfma_f32_16x16x32_bf16 v[28:31], v[224:227], v[116:119], v[28:31]
    ds_read_b64_tr_b16 v[238:239], v5 offset:25888
    s_waitcnt lgkmcnt(4)
    v_mfma_f32_16x16x32_bf16 v[32:35], v[228:231], v[112:115], v[32:35]
    ds_read_b64_tr_b16 v[240:241], v4 offset:25088
    v_mfma_f32_16x16x32_bf16 v[36:39], v[228:231], v[116:119], v[36:39]
    ds_read_b64_tr_b16 v[242:243], v4 offset:26112
    s_mov_b32 s23, 0x7800
    buffer_load_dwordx4 v[96:99], v7, s[8:11], s23 offen offset:1024 sc1
    s_waitcnt lgkmcnt(4)
    v_mfma_f32_16x16x32_bf16 v[40:43], v[232:235], v[112:115], v[40:43]
    ds_read_b64_tr_b16 v[244:245], v5 offset:25120
    s_add_u32 s22, s21, 0xc400
    s_add_u32 m0, s20, 0x1c400
    s_nop 0
    buffer_load_dwordx4 v2, s[8:11], s22 offen sc1 lds
    v_mfma_f32_16x16x32_bf16 v[44:47], v[232:235], v[116:119], v[44:47]
    ds_read_b64_tr_b16 v[246:247], v5 offset:26144
    s_waitcnt lgkmcnt(4)
    v_mfma_f32_16x16x32_bf16 v[48:51], v[236:239], v[112:115], v[48:51]
    ds_read_b64_tr_b16 v[224:225], v4 offset:25344
    v_mfma_f32_16x16x32_bf16 v[52:55], v[236:239], v[116:119], v[52:55]
    ds_read_b64_tr_b16 v[226:227], v4 offset:26368
    s_waitcnt lgkmcnt(4)
    v_mfma_f32_16x16x32_bf16 v[56:59], v[240:243], v[112:115], v[56:59]
    ds_read_b64_tr_b16 v[228:229], v5 offset:25376
    v_mfma_f32_16x16x32_bf16 v[60:63], v[240:243], v[116:119], v[60:63]
    ds_read_b64_tr_b16 v[230:231], v5 offset:26400
    s_waitcnt lgkmcnt(4)
    v_mfma_f32_16x16x32_bf16 v[64:67], v[244:247], v[112:115], v[64:67]
    v_mfma_f32_16x16x32_bf16 v[68:71], v[244:247], v[116:119], v[68:71]
    s_waitcnt vmcnt(12)
    s_barrier
    ds_read_b64_tr_b16 v[232:233], v4 offset:32768
    ds_read_b64_tr_b16 v[234:235], v4 offset:33792
    s_mov_b32 s23, 0xf800
    buffer_load_dwordx4 v[100:103], v7, s[8:11], s23 offen offset:1024 sc1
    s_waitcnt lgkmcnt(4)
    v_mfma_f32_16x16x32_bf16 v[72:75], v[224:227], v[112:115], v[72:75]
    ds_read_b64_tr_b16 v[236:237], v5 offset:32800
    v_mfma_f32_16x16x32_bf16 v[76:79], v[224:227], v[116:119], v[76:79]
    ds_read_b64_tr_b16 v[238:239], v5 offset:33824
    s_waitcnt lgkmcnt(4)
    v_mfma_f32_16x16x32_bf16 v[80:83], v[228:231], v[112:115], v[80:83]
    ds_read_b64_tr_b16 v[240:241], v4 offset:33024
    v_mfma_f32_16x16x32_bf16 v[84:87], v[228:231], v[116:119], v[84:87]
    ds_read_b64_tr_b16 v[242:243], v4 offset:34048
    s_waitcnt lgkmcnt(4)
    v_mfma_f32_16x16x32_bf16 v[24:27], v[232:235], v[120:123], v[24:27]
    ds_read_b64_tr_b16 v[244:245], v5 offset:33056
    s_waitcnt vmcnt(12)
    v_mfma_f32_16x16x32_bf16 v[28:31], v[232:235], v[124:127], v[28:31]
    ds_read_b64_tr_b16 v[246:247], v5 offset:34080
    s_waitcnt lgkmcnt(4)
    v_mfma_f32_16x16x32_bf16 v[32:35], v[236:239], v[120:123], v[32:35]
    ds_read_b64_tr_b16 v[224:225], v4 offset:33280
    v_mfma_f32_16x16x32_bf16 v[36:39], v[236:239], v[124:127], v[36:39]
    ds_read_b64_tr_b16 v[226:227], v4 offset:34304
    s_waitcnt lgkmcnt(4)
    v_mfma_f32_16x16x32_bf16 v[40:43], v[240:243], v[120:123], v[40:43]
    ds_read_b64_tr_b16 v[228:229], v5 offset:33312
    v_mfma_f32_16x16x32_bf16 v[44:47], v[240:243], v[124:127], v[44:47]
    ds_read_b64_tr_b16 v[230:231], v5 offset:34336
    s_waitcnt lgkmcnt(4)
    v_mfma_f32_16x16x32_bf16 v[48:51], v[244:247], v[120:123], v[48:51]
    ds_read_b64_tr_b16 v[232:233], v4 offset:33536
    v_mfma_f32_16x16x32_bf16 v[52:55], v[244:247], v[124:127], v[52:55]
    ds_read_b64_tr_b16 v[234:235], v4 offset:34560
    s_waitcnt lgkmcnt(4)
    v_mfma_f32_16x16x32_bf16 v[56:59], v[224:227], v[120:123], v[56:59]
    ds_read_b64_tr_b16 v[236:237], v5 offset:33568
    v_mfma_f32_16x16x32_bf16 v[60:63], v[224:227], v[124:127], v[60:63]
    ds_read_b64_tr_b16 v[238:239], v5 offset:34592
    s_waitcnt lgkmcnt(4)
    v_mfma_f32_16x16x32_bf16 v[64:67], v[228:231], v[120:123], v[64:67]
    ds_read_b64_tr_b16 v[240:241], v4 offset:40960
    v_mfma_f32_16x16x32_bf16 v[68:71], v[228:231], v[124:127], v[68:71]
    ds_read_b64_tr_b16 v[242:243], v4 offset:41984
    s_waitcnt lgkmcnt(4)
    v_mfma_f32_16x16x32_bf16 v[72:75], v[232:235], v[120:123], v[72:75]
    ds_read_b64_tr_b16 v[244:245], v5 offset:40992
    v_mfma_f32_16x16x32_bf16 v[76:79], v[232:235], v[124:127], v[76:79]
    ds_read_b64_tr_b16 v[246:247], v5 offset:42016
    s_waitcnt lgkmcnt(4)
    v_mfma_f32_16x16x32_bf16 v[80:83], v[236:239], v[120:123], v[80:83]
    ds_read_b64_tr_b16 v[224:225], v4 offset:41216
    v_mfma_f32_16x16x32_bf16 v[84:87], v[236:239], v[124:127], v[84:87]
    ds_read_b64_tr_b16 v[226:227], v4 offset:42240
    s_waitcnt vmcnt(10) lgkmcnt(4)
    v_mfma_f32_16x16x32_bf16 v[24:27], v[240:243], v[128:131], v[24:27]
    ds_read_b64_tr_b16 v[228:229], v5 offset:41248
    s_waitcnt vmcnt(8)
    v_mfma_f32_16x16x32_bf16 v[28:31], v[240:243], v[132:135], v[28:31]
    ds_read_b64_tr_b16 v[230:231], v5 offset:42272
    s_waitcnt lgkmcnt(4)
    v_mfma_f32_16x16x32_bf16 v[32:35], v[244:247], v[128:131], v[32:35]
    ds_read_b64_tr_b16 v[232:233], v4 offset:41472
    v_mfma_f32_16x16x32_bf16 v[36:39], v[244:247], v[132:135], v[36:39]
    ds_read_b64_tr_b16 v[234:235], v4 offset:42496
    s_waitcnt lgkmcnt(4)
    v_mfma_f32_16x16x32_bf16 v[40:43], v[224:227], v[128:131], v[40:43]
    ds_read_b64_tr_b16 v[236:237], v5 offset:41504
    v_mfma_f32_16x16x32_bf16 v[44:47], v[224:227], v[132:135], v[44:47]
    ds_read_b64_tr_b16 v[238:239], v5 offset:42528
    s_waitcnt lgkmcnt(4)
    v_mfma_f32_16x16x32_bf16 v[48:51], v[228:231], v[128:131], v[48:51]
    ds_read_b64_tr_b16 v[240:241], v4 offset:41728
    v_mfma_f32_16x16x32_bf16 v[52:55], v[228:231], v[132:135], v[52:55]
    ds_read_b64_tr_b16 v[242:243], v4 offset:42752
    s_waitcnt lgkmcnt(4)
    v_mfma_f32_16x16x32_bf16 v[56:59], v[232:235], v[128:131], v[56:59]
    ds_read_b64_tr_b16 v[244:245], v5 offset:41760
    v_mfma_f32_16x16x32_bf16 v[60:63], v[232:235], v[132:135], v[60:63]
    ds_read_b64_tr_b16 v[246:247], v5 offset:42784
    s_waitcnt lgkmcnt(4)
    v_mfma_f32_16x16x32_bf16 v[64:67], v[236:239], v[128:131], v[64:67]
    v_mfma_f32_16x16x32_bf16 v[68:71], v[236:239], v[132:135], v[68:71]
    s_waitcnt vmcnt(5)
    s_barrier
    ds_read_b64_tr_b16 v[224:225], v4 offset:49152
    ds_read_b64_tr_b16 v[226:227], v4 offset:50176
    s_waitcnt lgkmcnt(4)
    v_mfma_f32_16x16x32_bf16 v[72:75], v[240:243], v[128:131], v[72:75]
    ds_read_b64_tr_b16 v[228:229], v5 offset:49184
    v_mfma_f32_16x16x32_bf16 v[76:79], v[240:243], v[132:135], v[76:79]
    ds_read_b64_tr_b16 v[230:231], v5 offset:50208
    s_waitcnt lgkmcnt(4)
    v_mfma_f32_16x16x32_bf16 v[80:83], v[244:247], v[128:131], v[80:83]
    ds_read_b64_tr_b16 v[232:233], v4 offset:49408
    v_mfma_f32_16x16x32_bf16 v[84:87], v[244:247], v[132:135], v[84:87]
    ds_read_b64_tr_b16 v[234:235], v4 offset:50432
    s_waitcnt lgkmcnt(4)
    v_mfma_f32_16x16x32_bf16 v[24:27], v[224:227], v[88:91], v[24:27]
    ds_read_b64_tr_b16 v[236:237], v5 offset:49440
    s_waitcnt vmcnt(4)
    v_mfma_f32_16x16x32_bf16 v[28:31], v[224:227], v[92:95], v[28:31]
    ds_read_b64_tr_b16 v[238:239], v5 offset:50464
    s_waitcnt lgkmcnt(4)
    v_mfma_f32_16x16x32_bf16 v[32:35], v[228:231], v[88:91], v[32:35]
    ds_read_b64_tr_b16 v[240:241], v4 offset:49664
    v_mfma_f32_16x16x32_bf16 v[36:39], v[228:231], v[92:95], v[36:39]
    ds_read_b64_tr_b16 v[242:243], v4 offset:50688
    s_waitcnt lgkmcnt(4)
    v_mfma_f32_16x16x32_bf16 v[40:43], v[232:235], v[88:91], v[40:43]
    ds_read_b64_tr_b16 v[244:245], v5 offset:49696
    v_mfma_f32_16x16x32_bf16 v[44:47], v[232:235], v[92:95], v[44:47]
    ds_read_b64_tr_b16 v[246:247], v5 offset:50720
    s_waitcnt lgkmcnt(4)
    v_mfma_f32_16x16x32_bf16 v[48:51], v[236:239], v[88:91], v[48:51]
    ds_read_b64_tr_b16 v[224:225], v4 offset:49920
    v_mfma_f32_16x16x32_bf16 v[52:55], v[236:239], v[92:95], v[52:55]
    ds_read_b64_tr_b16 v[226:227], v4 offset:50944
    s_waitcnt lgkmcnt(4)
    v_mfma_f32_16x16x32_bf16 v[56:59], v[240:243], v[88:91], v[56:59]
    ds_read_b64_tr_b16 v[228:229], v5 offset:49952
    v_mfma_f32_16x16x32_bf16 v[60:63], v[240:243], v[92:95], v[60:63]
    ds_read_b64_tr_b16 v[230:231], v5 offset:50976
    s_waitcnt lgkmcnt(4)
    v_mfma_f32_16x16x32_bf16 v[64:67], v[244:247], v[88:91], v[64:67]
    ds_read_b64_tr_b16 v[232:233], v4 offset:57344
    v_mfma_f32_16x16x32_bf16 v[68:71], v[244:247], v[92:95], v[68:71]
    ds_read_b64_tr_b16 v[234:235], v4 offset:58368
    s_waitcnt lgkmcnt(4)
    v_mfma_f32_16x16x32_bf16 v[72:75], v[224:227], v[88:91], v[72:75]
    ds_read_b64_tr_b16 v[236:237], v5 offset:57376
    v_mfma_f32_16x16x32_bf16 v[76:79], v[224:227], v[92:95], v[76:79]
    ds_read_b64_tr_b16 v[238:239], v5 offset:58400
    s_waitcnt lgkmcnt(4)
    v_mfma_f32_16x16x32_bf16 v[80:83], v[228:231], v[88:91], v[80:83]
    ds_read_b64_tr_b16 v[240:241], v4 offset:57600
    v_mfma_f32_16x16x32_bf16 v[84:87], v[228:231], v[92:95], v[84:87]
    ds_read_b64_tr_b16 v[242:243], v4 offset:58624
    s_waitcnt vmcnt(2) lgkmcnt(4)
    v_mfma_f32_16x16x32_bf16 v[24:27], v[232:235], v[96:99], v[24:27]
    ds_read_b64_tr_b16 v[244:245], v5 offset:57632
    s_waitcnt vmcnt(0)
    v_mfma_f32_16x16x32_bf16 v[28:31], v[232:235], v[100:103], v[28:31]
    ds_read_b64_tr_b16 v[246:247], v5 offset:58656
    s_waitcnt lgkmcnt(4)
    v_mfma_f32_16x16x32_bf16 v[32:35], v[236:239], v[96:99], v[32:35]
    ds_read_b64_tr_b16 v[224:225], v4 offset:57856
    v_mfma_f32_16x16x32_bf16 v[36:39], v[236:239], v[100:103], v[36:39]
    ds_read_b64_tr_b16 v[226:227], v4 offset:58880
    s_waitcnt lgkmcnt(4)
    v_mfma_f32_16x16x32_bf16 v[40:43], v[240:243], v[96:99], v[40:43]
    ds_read_b64_tr_b16 v[228:229], v5 offset:57888
    v_mfma_f32_16x16x32_bf16 v[44:47], v[240:243], v[100:103], v[44:47]
    ds_read_b64_tr_b16 v[230:231], v5 offset:58912
    s_waitcnt lgkmcnt(4)
    v_mfma_f32_16x16x32_bf16 v[48:51], v[244:247], v[96:99], v[48:51]
    ds_read_b64_tr_b16 v[232:233], v4 offset:58112
    v_mfma_f32_16x16x32_bf16 v[52:55], v[244:247], v[100:103], v[52:55]
    ds_read_b64_tr_b16 v[234:235], v4 offset:59136
    s_waitcnt lgkmcnt(4)
    v_mfma_f32_16x16x32_bf16 v[56:59], v[224:227], v[96:99], v[56:59]
    ds_read_b64_tr_b16 v[236:237], v5 offset:58144
    v_mfma_f32_16x16x32_bf16 v[60:63], v[224:227], v[100:103], v[60:63]
    ds_read_b64_tr_b16 v[238:239], v5 offset:59168
    s_waitcnt lgkmcnt(4)
    v_mfma_f32_16x16x32_bf16 v[64:67], v[228:231], v[96:99], v[64:67]
    v_mfma_f32_16x16x32_bf16 v[68:71], v[228:231], v[100:103], v[68:71]
    s_waitcnt lgkmcnt(2)
    v_mfma_f32_16x16x32_bf16 v[72:75], v[232:235], v[96:99], v[72:75]
    v_mfma_f32_16x16x32_bf16 v[76:79], v[232:235], v[100:103], v[76:79]
    s_waitcnt lgkmcnt(0)
    v_mfma_f32_16x16x32_bf16 v[80:83], v[236:239], v[96:99], v[80:83]
    v_mfma_f32_16x16x32_bf16 v[84:87], v[236:239], v[100:103], v[84:87]
    s_mov_b32 s23, 0x3e0293ee
    v_mul_f32 v24, s23, v24
    v_mul_f32 v25, s23, v25
    v_mul_f32 v26, s23, v26
    v_mul_f32 v27, s23, v27
    v_mul_f32 v28, s23, v28
    v_mul_f32 v29, s23, v29
    v_mul_f32 v30, s23, v30
    v_mul_f32 v31, s23, v31
    v_mul_f32 v32, s23, v32
    v_mul_f32 v33, s23, v33
    v_mul_f32 v34, s23, v34
    v_mul_f32 v35, s23, v35
    v_mul_f32 v36, s23, v36
    v_mul_f32 v37, s23, v37
    v_mul_f32 v38, s23, v38
    v_mul_f32 v39, s23, v39
    v_cvt_pk_bf16_f32 v152, v24, v25
    v_cvt_pk_bf16_f32 v153, v26, v27
    v_cvt_pk_bf16_f32 v168, v28, v29
    v_cvt_pk_bf16_f32 v169, v30, v31
    v_cvt_pk_bf16_f32 v154, v32, v33
    v_cvt_pk_bf16_f32 v155, v34, v35
    v_cvt_pk_bf16_f32 v170, v36, v37
    v_cvt_pk_bf16_f32 v171, v38, v39
    v_add_u32 v4, 0x10000, v2
    v_add_u32 v5, 0x20000, v2
    s_barrier
    ds_read_b128 v[224:227], v4 offset:0
    ds_read_b128 v[228:231], v4 offset:1024
    ds_read_b128 v[232:235], v4 offset:2048
    ds_read_b128 v[236:239], v4 offset:3072
    v_mov_b32 v12, 0x3f803f80
    v_mov_b32 v13, 0x3f803f80
    v_mov_b32 v14, 0x3f803f80
    v_mov_b32 v15, 0x3f803f80
    s_waitcnt lgkmcnt(3)
    v_mfma_f32_16x16x32_bf16 v[184:187], v[224:227], v[152:155], 0
    v_mul_f32 v40, s23, v40
    v_mul_f32 v41, s23, v41
    v_mul_f32 v42, s23, v42
    v_mul_f32 v43, s23, v43
    v_mul_f32 v44, s23, v44
    v_mul_f32 v45, s23, v45
    v_mfma_f32_16x16x32_bf16 v[188:191], v[224:227], v[168:171], 0
    ds_read_b128 v[240:243], v4 offset:4096
    v_mul_f32 v46, s23, v46
    v_mul_f32 v47, s23, v47
    v_mul_f32 v48, s23, v48
    v_mul_f32 v49, s23, v49
    v_mul_f32 v50, s23, v50
    v_mul_f32 v51, s23, v51
    s_and_b32 s29, s2, 7
    s_mul_i32 s29, s29, 28
    s_lshr_b32 s16, s2, 3
    s_add_u32 s29, s29, s16
    s_waitcnt lgkmcnt(3)
    v_mfma_f32_16x16x32_bf16 v[192:195], v[228:231], v[152:155], 0
    s_add_u32 s22, s21, 0x10000
    s_add_u32 m0, s20, 0x20000
    s_nop 0
    buffer_load_dwordx4 v2, s[8:11], s22 offen sc1 lds
    v_mul_f32 v52, s23, v52
    v_mul_f32 v53, s23, v53
    v_mul_f32 v54, s23, v54
    v_mul_f32 v55, s23, v55
    v_cvt_pk_bf16_f32 v156, v40, v41
    v_cvt_pk_bf16_f32 v157, v42, v43
    s_mov_b64 s[76:77], s[54:55]
    s_mov_b32 s78, 0xc00000
    s_mov_b32 s79, 0x20000
    v_bfe_u32 v20, v1, 2, 2
    v_lshlrev_b32 v20, 12, v20
    v_add_u32 v6, v3, v20
    s_lshr_b32 s16, s2, 5
    s_lshl_b32 s16, s16, 7
    s_lshl_b32 s17, s3, 3
    s_add_u32 s16, s16, s17
    s_mul_i32 s14, s16, 12288
    s_and_b32 s16, s2, 31
    s_lshl_b32 s16, s16, 8
    s_add_u32 s14, s14, s16
    s_add_u32 s14, s14, 4096
    v_mfma_f32_16x16x32_bf16 v[196:199], v[228:231], v[168:171], 0
    ds_read_b128 v[244:247], v4 offset:5120
    v_cvt_pk_bf16_f32 v172, v44, v45
    v_cvt_pk_bf16_f32 v173, v46, v47
    v_cvt_pk_bf16_f32 v158, v48, v49
    v_cvt_pk_bf16_f32 v159, v50, v51
    v_cvt_pk_bf16_f32 v174, v52, v53
    v_cvt_pk_bf16_f32 v175, v54, v55
    s_waitcnt lgkmcnt(3)
    v_mfma_f32_16x16x32_bf16 v[184:187], v[232:235], v[156:159], v[184:187]
    v_mul_f32 v56, s23, v56
    v_mul_f32 v57, s23, v57
    v_mul_f32 v58, s23, v58
    v_mul_f32 v59, s23, v59
    v_mul_f32 v60, s23, v60
    v_mul_f32 v61, s23, v61
    v_mfma_f32_16x16x32_bf16 v[188:191], v[232:235], v[172:175], v[188:191]
    ds_read_b128 v[224:227], v4 offset:6144
    v_mul_f32 v62, s23, v62
    v_mul_f32 v63, s23, v63
    v_mul_f32 v64, s23, v64
    v_mul_f32 v65, s23, v65
    v_mul_f32 v66, s23, v66
    v_mul_f32 v67, s23, v67
    s_waitcnt lgkmcnt(3)
    v_mfma_f32_16x16x32_bf16 v[192:195], v[236:239], v[156:159], v[192:195]
    v_mul_f32 v68, s23, v68
    v_mul_f32 v69, s23, v69
    v_mul_f32 v70, s23, v70
    v_mul_f32 v71, s23, v71
    v_cvt_pk_bf16_f32 v160, v56, v57
    v_cvt_pk_bf16_f32 v161, v58, v59
    v_mfma_f32_16x16x32_bf16 v[196:199], v[236:239], v[172:175], v[196:199]
    ds_read_b128 v[228:231], v4 offset:7168
    v_cvt_pk_bf16_f32 v176, v60, v61
    v_cvt_pk_bf16_f32 v177, v62, v63
    v_cvt_pk_bf16_f32 v162, v64, v65
    v_cvt_pk_bf16_f32 v163, v66, v67
    v_cvt_pk_bf16_f32 v178, v68, v69
    v_cvt_pk_bf16_f32 v179, v70, v71
    s_waitcnt lgkmcnt(3)
    v_mfma_f32_16x16x32_bf16 v[184:187], v[240:243], v[160:163], v[184:187]
    v_mul_f32 v72, s23, v72
    v_mul_f32 v73, s23, v73
    v_mul_f32 v74, s23, v74
    v_mul_f32 v75, s23, v75
    v_mul_f32 v76, s23, v76
    v_mul_f32 v77, s23, v77
    v_mfma_f32_16x16x32_bf16 v[188:191], v[240:243], v[176:179], v[188:191]
    ds_read_b128 v[232:235], v4 offset:8192
    v_mul_f32 v78, s23, v78
    v_mul_f32 v79, s23, v79
    v_mul_f32 v80, s23, v80
    v_mul_f32 v81, s23, v81
    v_mul_f32 v82, s23, v82
    v_mul_f32 v83, s23, v83
    s_waitcnt lgkmcnt(3)
    v_mfma_f32_16x16x32_bf16 v[192:195], v[244:247], v[160:163], v[192:195]
    s_add_u32 s22, s21, 0x10400
    s_add_u32 m0, s20, 0x20400
    s_nop 0
    buffer_load_dwordx4 v2, s[8:11], s22 offen sc1 lds
    v_mul_f32 v84, s23, v84
    v_mul_f32 v85, s23, v85
    v_mul_f32 v86, s23, v86
    v_mul_f32 v87, s23, v87
    v_cvt_pk_bf16_f32 v164, v72, v73
    v_cvt_pk_bf16_f32 v165, v74, v75
    v_mfma_f32_16x16x32_bf16 v[196:199], v[244:247], v[176:179], v[196:199]
    ds_read_b128 v[236:239], v4 offset:9216
    v_cvt_pk_bf16_f32 v180, v76, v77
    v_cvt_pk_bf16_f32 v181, v78, v79
    v_cvt_pk_bf16_f32 v166, v80, v81
    v_cvt_pk_bf16_f32 v167, v82, v83
    v_cvt_pk_bf16_f32 v182, v84, v85
    v_cvt_pk_bf16_f32 v183, v86, v87
    s_waitcnt lgkmcnt(3)
    v_mfma_f32_16x16x32_bf16 v[184:187], v[224:227], v[164:167], v[184:187]
    v_mfma_f32_16x16x32_bf16 v[188:191], v[224:227], v[180:183], v[188:191]
    ds_read_b128 v[240:243], v4 offset:10240
    s_waitcnt lgkmcnt(3)
    v_mfma_f32_16x16x32_bf16 v[192:195], v[228:231], v[164:167], v[192:195]
    v_mfma_f32_16x16x32_bf16 v[196:199], v[228:231], v[180:183], v[196:199]
    ds_read_b128 v[244:247], v4 offset:11264
    s_waitcnt lgkmcnt(3)
    v_mfma_f32_16x16x32_bf16 v[200:203], v[232:235], v[152:155], 0
    v_mfma_f32_16x16x32_bf16 v[204:207], v[232:235], v[168:171], 0
    ds_read_b128 v[224:227], v4 offset:12288
    s_waitcnt lgkmcnt(3)
    v_mfma_f32_16x16x32_bf16 v[208:211], v[236:239], v[152:155], 0
    v_mfma_f32_16x16x32_bf16 v[212:215], v[236:239], v[168:171], 0
    ds_read_b128 v[228:231], v4 offset:13312
    s_waitcnt lgkmcnt(3)
    v_mfma_f32_16x16x32_bf16 v[200:203], v[240:243], v[156:159], v[200:203]
    v_mfma_f32_16x16x32_bf16 v[204:207], v[240:243], v[172:175], v[204:207]
    ds_read_b128 v[232:235], v4 offset:14336
    s_waitcnt lgkmcnt(3)
    v_mfma_f32_16x16x32_bf16 v[208:211], v[244:247], v[156:159], v[208:211]
    v_max3_f32 v16, v184, v185, v186
    v_mfma_f32_16x16x32_bf16 v[212:215], v[244:247], v[172:175], v[212:215]
    ds_read_b128 v[236:239], v4 offset:15360
    v_max3_f32 v16, v16, v187, v192
    s_waitcnt lgkmcnt(3)
    v_mfma_f32_16x16x32_bf16 v[200:203], v[224:227], v[160:163], v[200:203]
    v_max3_f32 v16, v16, v193, v194
    v_mfma_f32_16x16x32_bf16 v[204:207], v[224:227], v[176:179], v[204:207]
    s_barrier
    ds_read_b128 v[240:243], v4 offset:16384
    v_max_f32 v16, v16, v195
    s_waitcnt lgkmcnt(3)
    v_mfma_f32_16x16x32_bf16 v[208:211], v[228:231], v[160:163], v[208:211]
    v_max3_f32 v17, v188, v189, v190
    v_mfma_f32_16x16x32_bf16 v[212:215], v[228:231], v[176:179], v[212:215]
    s_add_u32 s22, s21, 0x14000
    s_add_u32 m0, s20, 0x24000
    s_nop 0
    buffer_load_dwordx4 v2, s[8:11], s22 offen sc1 lds
    ds_read_b128 v[244:247], v4 offset:17408
    v_max3_f32 v17, v17, v191, v196
    s_waitcnt lgkmcnt(3)
    v_mfma_f32_16x16x32_bf16 v[200:203], v[232:235], v[164:167], v[200:203]
    v_max3_f32 v17, v17, v197, v198
    v_mfma_f32_16x16x32_bf16 v[204:207], v[232:235], v[180:183], v[204:207]
    ds_read_b128 v[224:227], v4 offset:18432
    v_max_f32 v17, v17, v199
    s_waitcnt lgkmcnt(3)
    v_mfma_f32_16x16x32_bf16 v[208:211], v[236:239], v[164:167], v[208:211]
    v_mfma_f32_16x16x32_bf16 v[212:215], v[236:239], v[180:183], v[212:215]
    ds_read_b128 v[228:231], v4 offset:19456
    v_max3_f32 v16, v16, v200, v201
    v_max3_f32 v16, v16, v202, v203
    s_nop 3
    v_max3_f32 v16, v16, v208, v209
    v_max3_f32 v16, v16, v210, v211
    v_max3_f32 v17, v17, v204, v205
    v_max3_f32 v17, v17, v206, v207
    v_max3_f32 v17, v17, v212, v213
    v_max3_f32 v17, v17, v214, v215
    v_mov_b32 v18, v16
    v_mov_b32 v19, v17
    s_nop 0
    v_permlane16_swap_b32 v16, v18
    v_permlane16_swap_b32 v17, v19
    v_max_f32 v16, v16, v18
    v_max_f32 v17, v17, v19
    v_mov_b32 v18, v16
    v_mov_b32 v19, v17
    s_nop 0
    v_permlane32_swap_b32 v16, v18
    v_permlane32_swap_b32 v17, v19
    v_max_f32 v16, v16, v18
    v_max_f32 v17, v17, v19
    v_sub_f32 v216, 0, v16
    v_sub_f32 v217, 0, v16
    v_sub_f32 v218, 0, v16
    v_sub_f32 v219, 0, v16
    v_sub_f32 v220, 0, v17
    v_sub_f32 v221, 0, v17
    v_sub_f32 v222, 0, v17
    v_sub_f32 v223, 0, v17
    v_add_f32 v184, v184, v216
    v_add_f32 v185, v185, v216
    v_exp_f32 v184, v184
    v_exp_f32 v185, v185
    v_add_f32 v186, v186, v216
    v_add_f32 v187, v187, v216
    v_exp_f32 v186, v186
    v_exp_f32 v187, v187
    v_cvt_pk_bf16_f32 v24, v184, v185
    v_add_f32 v188, v188, v220
    v_add_f32 v189, v189, v220
    v_exp_f32 v188, v188
    v_exp_f32 v189, v189
    v_cvt_pk_bf16_f32 v25, v186, v187
    v_add_f32 v190, v190, v220
    v_add_f32 v191, v191, v220
    v_exp_f32 v190, v190
    v_exp_f32 v191, v191
    v_cvt_pk_bf16_f32 v28, v188, v189
    v_add_f32 v192, v192, v216
    v_add_f32 v193, v193, v216
    v_exp_f32 v192, v192
    v_exp_f32 v193, v193
    v_cvt_pk_bf16_f32 v29, v190, v191
    v_add_f32 v194, v194, v216
    v_add_f32 v195, v195, v216
    v_exp_f32 v194, v194
    v_exp_f32 v195, v195
    v_cvt_pk_bf16_f32 v26, v192, v193
    v_add_f32 v196, v196, v220
    v_add_f32 v197, v197, v220
    v_exp_f32 v196, v196
    v_exp_f32 v197, v197
    v_cvt_pk_bf16_f32 v27, v194, v195
    v_add_f32 v198, v198, v220
    v_add_f32 v199, v199, v220
    v_exp_f32 v198, v198
    v_exp_f32 v199, v199
    v_cvt_pk_bf16_f32 v30, v196, v197
    v_cvt_pk_bf16_f32 v31, v198, v199
    s_waitcnt lgkmcnt(3)
    v_mfma_f32_16x16x32_bf16 v[184:187], v[240:243], v[152:155], v[216:219]
    v_mfma_f32_16x16x32_bf16 v[188:191], v[240:243], v[168:171], v[220:223]
    ds_read_b128 v[232:235], v4 offset:20480
    v_add_f32 v200, v200, v216
    v_add_f32 v201, v201, v216
    v_exp_f32 v200, v200
    v_mfma_f32_16x16x32_bf16 v[248:251], v[12:15], v[24:27], 0
    s_waitcnt lgkmcnt(3)
    v_mfma_f32_16x16x32_bf16 v[192:195], v[244:247], v[152:155], v[216:219]
    v_exp_f32 v201, v201
    v_add_f32 v202, v202, v216
    v_add_f32 v203, v203, v216
    v_mfma_f32_16x16x32_bf16 v[196:199], v[244:247], v[168:171], v[220:223]
    s_add_u32 s22, s21, 0x14400
    s_add_u32 m0, s20, 0x24400
    s_nop 0
    buffer_load_dwordx4 v2, s[8:11], s22 offen sc1 lds
    ds_read_b128 v[236:239], v4 offset:21504
    v_exp_f32 v202, v202
    v_exp_f32 v203, v203
    v_mfma_f32_16x16x32_bf16 v[252:255], v[12:15], v[28:31], 0
    s_waitcnt lgkmcnt(3)
    v_mfma_f32_16x16x32_bf16 v[184:187], v[224:227], v[156:159], v[184:187]
    v_cvt_pk_bf16_f32 v32, v200, v201
    v_add_f32 v204, v204, v220
    v_add_f32 v205, v205, v220
    v_mfma_f32_16x16x32_bf16 v[188:191], v[224:227], v[172:175], v[188:191]
    ds_read_b128 v[240:243], v4 offset:22528
    v_exp_f32 v204, v204
    v_exp_f32 v205, v205
    v_cvt_pk_bf16_f32 v33, v202, v203
    s_mov_b64 s[4:5], s[40:41]
    s_mov_b32 s6, 0x800000
    s_mov_b32 s7, 0x20000
    v_bfe_u32 v20, v1, 2, 2
    v_lshlrev_b32 v21, 13, v20
    v_sub_u32 v3, v3, v21
    v_lshl_add_u32 v3, v20, 11, v3
    s_and_b32 s16, s2, 1
    s_lshl_b32 s24, s16, 22
    s_lshr_b32 s16, s2, 5
    s_lshl_b32 s16, s16, 8
    s_add_u32 s24, s24, s16
    s_lshl_b32 s16, s3, 14
    s_add_u32 s24, s24, s16
    s_waitcnt lgkmcnt(3)
    v_mfma_f32_16x16x32_bf16 v[192:195], v[228:231], v[156:159], v[192:195]
    v_add_f32 v206, v206, v220
    v_add_f32 v207, v207, v220
    v_mfma_f32_16x16x32_bf16 v[196:199], v[228:231], v[172:175], v[196:199]
    ds_read_b128 v[244:247], v4 offset:23552
    v_exp_f32 v206, v206
    v_exp_f32 v207, v207
    v_cvt_pk_bf16_f32 v36, v204, v205
    s_waitcnt lgkmcnt(3)
    v_mfma_f32_16x16x32_bf16 v[184:187], v[232:235], v[160:163], v[184:187]
    v_add_f32 v208, v208, v216
    v_add_f32 v209, v209, v216
    v_exp_f32 v208, v208
    v_mfma_f32_16x16x32_bf16 v[188:191], v[232:235], v[176:179], v[188:191]
    ds_read_b128 v[224:227], v4 offset:24576
    v_exp_f32 v209, v209
    v_cvt_pk_bf16_f32 v37, v206, v207
    s_waitcnt lgkmcnt(3)
    v_mfma_f32_16x16x32_bf16 v[192:195], v[236:239], v[160:163], v[192:195]
    v_add_f32 v210, v210, v216
    v_add_f32 v211, v211, v216
    v_exp_f32 v210, v210
    v_mfma_f32_16x16x32_bf16 v[196:199], v[236:239], v[176:179], v[196:199]
    ds_read_b128 v[228:231], v4 offset:25600
    v_exp_f32 v211, v211
    v_cvt_pk_bf16_f32 v34, v208, v209
    v_add_f32 v212, v212, v220
    s_waitcnt lgkmcnt(3)
    v_mfma_f32_16x16x32_bf16 v[184:187], v[240:243], v[164:167], v[184:187]
    v_add_f32 v213, v213, v220
    v_exp_f32 v212, v212
    v_mfma_f32_16x16x32_bf16 v[188:191], v[240:243], v[180:183], v[188:191]
    ds_read_b128 v[232:235], v4 offset:26624
    v_exp_f32 v213, v213
    v_cvt_pk_bf16_f32 v35, v210, v211
    v_add_f32 v214, v214, v220
    s_waitcnt lgkmcnt(3)
    v_mfma_f32_16x16x32_bf16 v[192:195], v[244:247], v[164:167], v[192:195]
    v_add_f32 v215, v215, v220
    v_exp_f32 v214, v214
    v_exp_f32 v215, v215
    v_mfma_f32_16x16x32_bf16 v[196:199], v[244:247], v[180:183], v[196:199]
    ds_read_b128 v[236:239], v4 offset:27648
    v_cvt_pk_bf16_f32 v38, v212, v213
    v_cvt_pk_bf16_f32 v39, v214, v215
    s_waitcnt lgkmcnt(3)
    v_mfma_f32_16x16x32_bf16 v[200:203], v[224:227], v[152:155], v[216:219]
    v_mfma_f32_16x16x32_bf16 v[204:207], v[224:227], v[168:171], v[220:223]
    ds_read_b128 v[240:243], v4 offset:28672
    v_exp_f32 v184, v184
    v_exp_f32 v185, v185
    v_mfma_f32_16x16x32_bf16 v[248:251], v[12:15], v[32:35], v[248:251]
    s_waitcnt lgkmcnt(3)
    v_mfma_f32_16x16x32_bf16 v[208:211], v[228:231], v[152:155], v[216:219]
    v_exp_f32 v186, v186
    v_exp_f32 v187, v187
    v_mfma_f32_16x16x32_bf16 v[212:215], v[228:231], v[168:171], v[220:223]
    ds_read_b128 v[244:247], v4 offset:29696
    v_cvt_pk_bf16_f32 v40, v184, v185
    v_mfma_f32_16x16x32_bf16 v[252:255], v[12:15], v[36:39], v[252:255]
    s_waitcnt lgkmcnt(3)
    v_mfma_f32_16x16x32_bf16 v[200:203], v[232:235], v[156:159], v[200:203]
    v_exp_f32 v188, v188
    v_exp_f32 v189, v189
    v_mfma_f32_16x16x32_bf16 v[204:207], v[232:235], v[172:175], v[204:207]
    ds_read_b128 v[224:227], v4 offset:30720
    v_cvt_pk_bf16_f32 v41, v186, v187
    s_waitcnt lgkmcnt(3)
    v_mfma_f32_16x16x32_bf16 v[208:211], v[236:239], v[156:159], v[208:211]
    v_exp_f32 v190, v190
    v_exp_f32 v191, v191
    v_mfma_f32_16x16x32_bf16 v[212:215], v[236:239], v[172:175], v[212:215]
    ds_read_b128 v[228:231], v4 offset:31744
    v_cvt_pk_bf16_f32 v44, v188, v189
    v_exp_f32 v192, v192
    s_waitcnt lgkmcnt(3)
    v_mfma_f32_16x16x32_bf16 v[200:203], v[240:243], v[160:163], v[200:203]
    v_exp_f32 v193, v193
    v_mfma_f32_16x16x32_bf16 v[204:207], v[240:243], v[176:179], v[204:207]
    s_barrier
    ds_read_b128 v[232:235], v4 offset:32768
    v_cvt_pk_bf16_f32 v45, v190, v191
    v_exp_f32 v194, v194
    s_waitcnt lgkmcnt(3)
    v_mfma_f32_16x16x32_bf16 v[208:211], v[244:247], v[160:163], v[208:211]
    v_exp_f32 v195, v195
    v_mfma_f32_16x16x32_bf16 v[212:215], v[244:247], v[176:179], v[212:215]
    s_add_u32 s22, s21, 0x18000
    s_add_u32 m0, s20, 0x10000
    s_nop 0
    buffer_load_dwordx4 v2, s[8:11], s22 offen sc1 lds
    ds_read_b128 v[236:239], v4 offset:33792
    v_cvt_pk_bf16_f32 v42, v192, v193
    v_exp_f32 v196, v196
    s_waitcnt lgkmcnt(3)
    v_mfma_f32_16x16x32_bf16 v[200:203], v[224:227], v[164:167], v[200:203]
    v_exp_f32 v197, v197
    v_cvt_pk_bf16_f32 v43, v194, v195
    v_mfma_f32_16x16x32_bf16 v[204:207], v[224:227], v[180:183], v[204:207]
    ds_read_b128 v[240:243], v4 offset:34816
    v_exp_f32 v198, v198
    s_waitcnt lgkmcnt(3)
    v_mfma_f32_16x16x32_bf16 v[208:211], v[228:231], v[164:167], v[208:211]
    v_exp_f32 v199, v199
    v_cvt_pk_bf16_f32 v46, v196, v197
    v_mfma_f32_16x16x32_bf16 v[212:215], v[228:231], v[180:183], v[212:215]
    ds_read_b128 v[244:247], v4 offset:35840
    v_cvt_pk_bf16_f32 v47, v198, v199
    s_waitcnt lgkmcnt(3)
    v_mfma_f32_16x16x32_bf16 v[184:187], v[232:235], v[152:155], v[216:219]
    v_mfma_f32_16x16x32_bf16 v[188:191], v[232:235], v[168:171], v[220:223]
    ds_read_b128 v[224:227], v4 offset:36864
    v_exp_f32 v200, v200
    v_exp_f32 v201, v201
    v_mfma_f32_16x16x32_bf16 v[248:251], v[12:15], v[40:43], v[248:251]
    s_waitcnt lgkmcnt(3)
    v_mfma_f32_16x16x32_bf16 v[192:195], v[236:239], v[152:155], v[216:219]
    v_exp_f32 v202, v202
    v_exp_f32 v203, v203
    v_mfma_f32_16x16x32_bf16 v[196:199], v[236:239], v[168:171], v[220:223]
    s_add_u32 s22, s21, 0x18400
    s_add_u32 m0, s20, 0x10400
    s_nop 0
    buffer_load_dwordx4 v2, s[8:11], s22 offen sc1 lds
    ds_read_b128 v[228:231], v4 offset:37888
    v_cvt_pk_bf16_f32 v48, v200, v201
    v_mfma_f32_16x16x32_bf16 v[252:255], v[12:15], v[44:47], v[252:255]
    s_waitcnt lgkmcnt(3)
    v_mfma_f32_16x16x32_bf16 v[184:187], v[240:243], v[156:159], v[184:187]
    v_exp_f32 v204, v204
    v_exp_f32 v205, v205
    v_mfma_f32_16x16x32_bf16 v[188:191], v[240:243], v[172:175], v[188:191]
    ds_read_b128 v[232:235], v4 offset:38912
    v_cvt_pk_bf16_f32 v49, v202, v203
    s_waitcnt lgkmcnt(3)
    v_mfma_f32_16x16x32_bf16 v[192:195], v[244:247], v[156:159], v[192:195]
    v_exp_f32 v206, v206
    v_exp_f32 v207, v207
    v_mfma_f32_16x16x32_bf16 v[196:199], v[244:247], v[172:175], v[196:199]
    ds_read_b128 v[236:239], v4 offset:39936
    v_cvt_pk_bf16_f32 v52, v204, v205
    v_exp_f32 v208, v208
    s_waitcnt lgkmcnt(3)
    v_mfma_f32_16x16x32_bf16 v[184:187], v[224:227], v[160:163], v[184:187]
    v_exp_f32 v209, v209
    v_mfma_f32_16x16x32_bf16 v[188:191], v[224:227], v[176:179], v[188:191]
    ds_read_b128 v[240:243], v4 offset:40960
    v_cvt_pk_bf16_f32 v53, v206, v207
    v_exp_f32 v210, v210
    s_waitcnt lgkmcnt(3)
    v_mfma_f32_16x16x32_bf16 v[192:195], v[228:231], v[160:163], v[192:195]
    v_exp_f32 v211, v211
    v_mfma_f32_16x16x32_bf16 v[196:199], v[228:231], v[176:179], v[196:199]
    ds_read_b128 v[244:247], v4 offset:41984
    v_cvt_pk_bf16_f32 v50, v208, v209
    v_exp_f32 v212, v212
    s_waitcnt lgkmcnt(3)
    v_mfma_f32_16x16x32_bf16 v[184:187], v[232:235], v[164:167], v[184:187]
    v_exp_f32 v213, v213
    v_cvt_pk_bf16_f32 v51, v210, v211
    v_mfma_f32_16x16x32_bf16 v[188:191], v[232:235], v[180:183], v[188:191]
    ds_read_b128 v[224:227], v4 offset:43008
    v_exp_f32 v214, v214
    s_waitcnt lgkmcnt(3)
    v_mfma_f32_16x16x32_bf16 v[192:195], v[236:239], v[164:167], v[192:195]
    v_exp_f32 v215, v215
    v_cvt_pk_bf16_f32 v54, v212, v213
    v_mfma_f32_16x16x32_bf16 v[196:199], v[236:239], v[180:183], v[196:199]
    ds_read_b128 v[228:231], v4 offset:44032
    v_cvt_pk_bf16_f32 v55, v214, v215
    s_waitcnt lgkmcnt(3)
    v_mfma_f32_16x16x32_bf16 v[200:203], v[240:243], v[152:155], v[216:219]
    v_mfma_f32_16x16x32_bf16 v[204:207], v[240:243], v[168:171], v[220:223]
    ds_read_b128 v[232:235], v4 offset:45056
    v_exp_f32 v184, v184
    v_exp_f32 v185, v185
    v_mfma_f32_16x16x32_bf16 v[248:251], v[12:15], v[48:51], v[248:251]
    s_waitcnt lgkmcnt(3)
    v_mfma_f32_16x16x32_bf16 v[208:211], v[244:247], v[152:155], v[216:219]
    v_exp_f32 v186, v186
    v_exp_f32 v187, v187
    v_mfma_f32_16x16x32_bf16 v[212:215], v[244:247], v[168:171], v[220:223]
    ds_read_b128 v[236:239], v4 offset:46080
    v_cvt_pk_bf16_f32 v56, v184, v185
    v_mfma_f32_16x16x32_bf16 v[252:255], v[12:15], v[52:55], v[252:255]
    s_waitcnt lgkmcnt(3)
    v_mfma_f32_16x16x32_bf16 v[200:203], v[224:227], v[156:159], v[200:203]
    v_exp_f32 v188, v188
    v_exp_f32 v189, v189
    v_mfma_f32_16x16x32_bf16 v[204:207], v[224:227], v[172:175], v[204:207]
    ds_read_b128 v[240:243], v4 offset:47104
    v_cvt_pk_bf16_f32 v57, v186, v187
    s_waitcnt lgkmcnt(3)
    v_mfma_f32_16x16x32_bf16 v[208:211], v[228:231], v[156:159], v[208:211]
    v_exp_f32 v190, v190
    v_exp_f32 v191, v191
    v_mfma_f32_16x16x32_bf16 v[212:215], v[228:231], v[172:175], v[212:215]
    ds_read_b128 v[244:247], v4 offset:48128
    v_cvt_pk_bf16_f32 v60, v188, v189
    v_exp_f32 v192, v192
    s_waitcnt lgkmcnt(3)
    v_mfma_f32_16x16x32_bf16 v[200:203], v[232:235], v[160:163], v[200:203]
    v_exp_f32 v193, v193
    v_mfma_f32_16x16x32_bf16 v[204:207], v[232:235], v[176:179], v[204:207]
    s_barrier
    ds_read_b128 v[224:227], v4 offset:49152
    v_cvt_pk_bf16_f32 v61, v190, v191
    v_exp_f32 v194, v194
    s_waitcnt lgkmcnt(3)
    v_mfma_f32_16x16x32_bf16 v[208:211], v[236:239], v[160:163], v[208:211]
    v_exp_f32 v195, v195
    v_mfma_f32_16x16x32_bf16 v[212:215], v[236:239], v[176:179], v[212:215]
    s_add_u32 s22, s21, 0x1c000
    s_add_u32 m0, s20, 0x14000
    s_nop 0
    buffer_load_dwordx4 v2, s[8:11], s22 offen sc1 lds
    ds_read_b128 v[228:231], v4 offset:50176
    v_cvt_pk_bf16_f32 v58, v192, v193
    v_exp_f32 v196, v196
    s_waitcnt lgkmcnt(3)
    v_mfma_f32_16x16x32_bf16 v[200:203], v[240:243], v[164:167], v[200:203]
    v_exp_f32 v197, v197
    v_cvt_pk_bf16_f32 v59, v194, v195
    v_mfma_f32_16x16x32_bf16 v[204:207], v[240:243], v[180:183], v[204:207]
    ds_read_b128 v[232:235], v4 offset:51200
    v_exp_f32 v198, v198
    s_waitcnt lgkmcnt(3)
    v_mfma_f32_16x16x32_bf16 v[208:211], v[244:247], v[164:167], v[208:211]
    v_exp_f32 v199, v199
    v_cvt_pk_bf16_f32 v62, v196, v197
    v_mfma_f32_16x16x32_bf16 v[212:215], v[244:247], v[180:183], v[212:215]
    ds_read_b128 v[236:239], v4 offset:52224
    v_cvt_pk_bf16_f32 v63, v198, v199
    s_waitcnt lgkmcnt(3)
    v_mfma_f32_16x16x32_bf16 v[184:187], v[224:227], v[152:155], v[216:219]
    v_mfma_f32_16x16x32_bf16 v[188:191], v[224:227], v[168:171], v[220:223]
    ds_read_b128 v[240:243], v4 offset:53248
    v_exp_f32 v200, v200
    v_exp_f32 v201, v201
    v_mfma_f32_16x16x32_bf16 v[248:251], v[12:15], v[56:59], v[248:251]
    s_waitcnt lgkmcnt(3)
    v_mfma_f32_16x16x32_bf16 v[192:195], v[228:231], v[152:155], v[216:219]
    v_exp_f32 v202, v202
    v_exp_f32 v203, v203
    v_mfma_f32_16x16x32_bf16 v[196:199], v[228:231], v[168:171], v[220:223]
    s_add_u32 s22, s21, 0x1c400
    s_add_u32 m0, s20, 0x14400
    s_nop 0
    buffer_load_dwordx4 v2, s[8:11], s22 offen sc1 lds
    ds_read_b128 v[244:247], v4 offset:54272
    v_cvt_pk_bf16_f32 v64, v200, v201
    v_mfma_f32_16x16x32_bf16 v[252:255], v[12:15], v[60:63], v[252:255]
    s_waitcnt lgkmcnt(3)
    v_mfma_f32_16x16x32_bf16 v[184:187], v[232:235], v[156:159], v[184:187]
    v_exp_f32 v204, v204
    v_exp_f32 v205, v205
    v_mfma_f32_16x16x32_bf16 v[188:191], v[232:235], v[172:175], v[188:191]
    ds_read_b128 v[224:227], v4 offset:55296
    v_cvt_pk_bf16_f32 v65, v202, v203
    s_waitcnt lgkmcnt(3)
    v_mfma_f32_16x16x32_bf16 v[192:195], v[236:239], v[156:159], v[192:195]
    v_exp_f32 v206, v206
    v_exp_f32 v207, v207
    v_mfma_f32_16x16x32_bf16 v[196:199], v[236:239], v[172:175], v[196:199]
    ds_read_b128 v[228:231], v4 offset:56320
    v_cvt_pk_bf16_f32 v68, v204, v205
    v_exp_f32 v208, v208
    s_waitcnt lgkmcnt(3)
    v_mfma_f32_16x16x32_bf16 v[184:187], v[240:243], v[160:163], v[184:187]
    v_exp_f32 v209, v209
    v_mfma_f32_16x16x32_bf16 v[188:191], v[240:243], v[176:179], v[188:191]
    ds_read_b128 v[232:235], v4 offset:57344
    v_cvt_pk_bf16_f32 v69, v206, v207
    v_exp_f32 v210, v210
    s_waitcnt lgkmcnt(3)
    v_mfma_f32_16x16x32_bf16 v[192:195], v[244:247], v[160:163], v[192:195]
    v_exp_f32 v211, v211
    v_mfma_f32_16x16x32_bf16 v[196:199], v[244:247], v[176:179], v[196:199]
    ds_read_b128 v[236:239], v4 offset:58368
    v_cvt_pk_bf16_f32 v66, v208, v209
    v_exp_f32 v212, v212
    s_waitcnt lgkmcnt(3)
    v_mfma_f32_16x16x32_bf16 v[184:187], v[224:227], v[164:167], v[184:187]
    v_exp_f32 v213, v213
    v_cvt_pk_bf16_f32 v67, v210, v211
    v_mfma_f32_16x16x32_bf16 v[188:191], v[224:227], v[180:183], v[188:191]
    ds_read_b128 v[240:243], v4 offset:59392
    v_exp_f32 v214, v214
    s_waitcnt lgkmcnt(3)
    v_mfma_f32_16x16x32_bf16 v[192:195], v[228:231], v[164:167], v[192:195]
    v_exp_f32 v215, v215
    v_cvt_pk_bf16_f32 v70, v212, v213
    v_mfma_f32_16x16x32_bf16 v[196:199], v[228:231], v[180:183], v[196:199]
    ds_read_b128 v[244:247], v4 offset:60416
    v_cvt_pk_bf16_f32 v71, v214, v215
    s_waitcnt lgkmcnt(3)
    v_mfma_f32_16x16x32_bf16 v[200:203], v[232:235], v[152:155], v[216:219]
    v_mfma_f32_16x16x32_bf16 v[204:207], v[232:235], v[168:171], v[220:223]
    ds_read_b128 v[224:227], v4 offset:61440
    v_exp_f32 v184, v184
    v_exp_f32 v185, v185
    v_mfma_f32_16x16x32_bf16 v[248:251], v[12:15], v[64:67], v[248:251]
    s_waitcnt lgkmcnt(3)
    v_mfma_f32_16x16x32_bf16 v[208:211], v[236:239], v[152:155], v[216:219]
    v_exp_f32 v186, v186
    v_exp_f32 v187, v187
    v_mfma_f32_16x16x32_bf16 v[212:215], v[236:239], v[168:171], v[220:223]
    ds_read_b128 v[228:231], v4 offset:62464
    v_cvt_pk_bf16_f32 v72, v184, v185
    v_mfma_f32_16x16x32_bf16 v[252:255], v[12:15], v[68:71], v[252:255]
    s_waitcnt lgkmcnt(3)
    v_mfma_f32_16x16x32_bf16 v[200:203], v[240:243], v[156:159], v[200:203]
    v_exp_f32 v188, v188
    v_exp_f32 v189, v189
    v_mfma_f32_16x16x32_bf16 v[204:207], v[240:243], v[172:175], v[204:207]
    ds_read_b128 v[232:235], v4 offset:63488
    v_cvt_pk_bf16_f32 v73, v186, v187
    s_waitcnt lgkmcnt(3)
    v_mfma_f32_16x16x32_bf16 v[208:211], v[244:247], v[156:159], v[208:211]
    v_exp_f32 v190, v190
    v_exp_f32 v191, v191
    v_mfma_f32_16x16x32_bf16 v[212:215], v[244:247], v[172:175], v[212:215]
    ds_read_b128 v[236:239], v4 offset:64512
    v_cvt_pk_bf16_f32 v76, v188, v189
    v_exp_f32 v192, v192
    s_waitcnt lgkmcnt(3)
    v_mfma_f32_16x16x32_bf16 v[200:203], v[224:227], v[160:163], v[200:203]
    v_exp_f32 v193, v193
    v_mfma_f32_16x16x32_bf16 v[204:207], v[224:227], v[176:179], v[204:207]
    s_waitcnt vmcnt(6)
    s_barrier
    ds_read_b128 v[240:243], v5 offset:0
    v_cvt_pk_bf16_f32 v77, v190, v191
    v_exp_f32 v194, v194
    s_waitcnt lgkmcnt(3)
    v_mfma_f32_16x16x32_bf16 v[208:211], v[228:231], v[160:163], v[208:211]
    v_exp_f32 v195, v195
    v_mfma_f32_16x16x32_bf16 v[212:215], v[228:231], v[176:179], v[212:215]
    s_add_u32 s22, s21, 0x80000
    s_add_u32 m0, s20, 0x18000
    s_nop 0
    buffer_load_dwordx4 v2, s[8:11], s22 offen sc1 lds
    ds_read_b128 v[244:247], v5 offset:1024
    v_cvt_pk_bf16_f32 v74, v192, v193
    v_exp_f32 v196, v196
    s_waitcnt lgkmcnt(3)
    v_mfma_f32_16x16x32_bf16 v[200:203], v[232:235], v[164:167], v[200:203]
    v_exp_f32 v197, v197
    v_cvt_pk_bf16_f32 v75, v194, v195
    v_mfma_f32_16x16x32_bf16 v[204:207], v[232:235], v[180:183], v[204:207]
    ds_read_b128 v[224:227], v5 offset:2048
    v_exp_f32 v198, v198
    s_waitcnt lgkmcnt(3)
    v_mfma_f32_16x16x32_bf16 v[208:211], v[236:239], v[164:167], v[208:211]
    v_exp_f32 v199, v199
    v_cvt_pk_bf16_f32 v78, v196, v197
    v_mfma_f32_16x16x32_bf16 v[212:215], v[236:239], v[180:183], v[212:215]
    ds_read_b128 v[228:231], v5 offset:3072
    v_cvt_pk_bf16_f32 v79, v198, v199
    s_waitcnt lgkmcnt(3)
    v_mfma_f32_16x16x32_bf16 v[184:187], v[240:243], v[152:155], v[216:219]
    v_mfma_f32_16x16x32_bf16 v[188:191], v[240:243], v[168:171], v[220:223]
    ds_read_b128 v[232:235], v5 offset:4096
    v_exp_f32 v200, v200
    v_exp_f32 v201, v201
    v_mfma_f32_16x16x32_bf16 v[248:251], v[12:15], v[72:75], v[248:251]
    s_waitcnt lgkmcnt(3)
    v_mfma_f32_16x16x32_bf16 v[192:195], v[244:247], v[152:155], v[216:219]
    v_exp_f32 v202, v202
    v_exp_f32 v203, v203
    v_mfma_f32_16x16x32_bf16 v[196:199], v[244:247], v[168:171], v[220:223]
    s_add_u32 s22, s21, 0x80400
    s_add_u32 m0, s20, 0x18400
    s_nop 0
    buffer_load_dwordx4 v2, s[8:11], s22 offen sc1 lds
    ds_read_b128 v[236:239], v5 offset:5120
    v_cvt_pk_bf16_f32 v80, v200, v201
    v_mfma_f32_16x16x32_bf16 v[252:255], v[12:15], v[76:79], v[252:255]
    s_waitcnt lgkmcnt(3)
    v_mfma_f32_16x16x32_bf16 v[184:187], v[224:227], v[156:159], v[184:187]
    v_exp_f32 v204, v204
    v_exp_f32 v205, v205
    v_mfma_f32_16x16x32_bf16 v[188:191], v[224:227], v[172:175], v[188:191]
    ds_read_b128 v[240:243], v5 offset:6144
    v_cvt_pk_bf16_f32 v81, v202, v203
    s_waitcnt lgkmcnt(3)
    v_mfma_f32_16x16x32_bf16 v[192:195], v[228:231], v[156:159], v[192:195]
    v_exp_f32 v206, v206
    v_exp_f32 v207, v207
    v_mfma_f32_16x16x32_bf16 v[196:199], v[228:231], v[172:175], v[196:199]
    ds_read_b128 v[244:247], v5 offset:7168
    v_cvt_pk_bf16_f32 v84, v204, v205
    v_exp_f32 v208, v208
    s_waitcnt lgkmcnt(3)
    v_mfma_f32_16x16x32_bf16 v[184:187], v[232:235], v[160:163], v[184:187]
    v_exp_f32 v209, v209
    v_mfma_f32_16x16x32_bf16 v[188:191], v[232:235], v[176:179], v[188:191]
    ds_read_b128 v[224:227], v5 offset:8192
    v_cvt_pk_bf16_f32 v85, v206, v207
    v_exp_f32 v210, v210
    s_waitcnt lgkmcnt(3)
    v_mfma_f32_16x16x32_bf16 v[192:195], v[236:239], v[160:163], v[192:195]
    v_exp_f32 v211, v211
    v_mfma_f32_16x16x32_bf16 v[196:199], v[236:239], v[176:179], v[196:199]
    ds_read_b128 v[228:231], v5 offset:9216
    v_cvt_pk_bf16_f32 v82, v208, v209
    v_exp_f32 v212, v212
    s_waitcnt lgkmcnt(3)
    v_mfma_f32_16x16x32_bf16 v[184:187], v[240:243], v[164:167], v[184:187]
    v_exp_f32 v213, v213
    v_cvt_pk_bf16_f32 v83, v210, v211
    v_mfma_f32_16x16x32_bf16 v[188:191], v[240:243], v[180:183], v[188:191]
    ds_read_b128 v[232:235], v5 offset:10240
    v_exp_f32 v214, v214
    s_waitcnt lgkmcnt(3)
    v_mfma_f32_16x16x32_bf16 v[192:195], v[244:247], v[164:167], v[192:195]
    v_exp_f32 v215, v215
    v_cvt_pk_bf16_f32 v86, v212, v213
    v_mfma_f32_16x16x32_bf16 v[196:199], v[244:247], v[180:183], v[196:199]
    ds_read_b128 v[236:239], v5 offset:11264
    v_cvt_pk_bf16_f32 v87, v214, v215
    s_waitcnt lgkmcnt(3)
    v_mfma_f32_16x16x32_bf16 v[200:203], v[224:227], v[152:155], v[216:219]
    v_mfma_f32_16x16x32_bf16 v[204:207], v[224:227], v[168:171], v[220:223]
    ds_read_b128 v[240:243], v5 offset:12288
    v_exp_f32 v184, v184
    v_exp_f32 v185, v185
    v_mfma_f32_16x16x32_bf16 v[248:251], v[12:15], v[80:83], v[248:251]
    s_waitcnt lgkmcnt(3)
    v_mfma_f32_16x16x32_bf16 v[208:211], v[228:231], v[152:155], v[216:219]
    v_exp_f32 v186, v186
    v_exp_f32 v187, v187
    v_mfma_f32_16x16x32_bf16 v[212:215], v[228:231], v[168:171], v[220:223]
    ds_read_b128 v[244:247], v5 offset:13312
    v_cvt_pk_bf16_f32 v88, v184, v185
    v_mfma_f32_16x16x32_bf16 v[252:255], v[12:15], v[84:87], v[252:255]
    s_waitcnt lgkmcnt(3)
    v_mfma_f32_16x16x32_bf16 v[200:203], v[232:235], v[156:159], v[200:203]
    v_exp_f32 v188, v188
    v_exp_f32 v189, v189
    v_mfma_f32_16x16x32_bf16 v[204:207], v[232:235], v[172:175], v[204:207]
    ds_read_b128 v[224:227], v5 offset:14336
    v_cvt_pk_bf16_f32 v89, v186, v187
    s_waitcnt lgkmcnt(3)
    v_mfma_f32_16x16x32_bf16 v[208:211], v[236:239], v[156:159], v[208:211]
    v_exp_f32 v190, v190
    v_exp_f32 v191, v191
    v_mfma_f32_16x16x32_bf16 v[212:215], v[236:239], v[172:175], v[212:215]
    ds_read_b128 v[228:231], v5 offset:15360
    v_cvt_pk_bf16_f32 v92, v188, v189
    v_exp_f32 v192, v192
    s_waitcnt lgkmcnt(3)
    v_mfma_f32_16x16x32_bf16 v[200:203], v[240:243], v[160:163], v[200:203]
    v_exp_f32 v193, v193
    v_mfma_f32_16x16x32_bf16 v[204:207], v[240:243], v[176:179], v[204:207]
    s_waitcnt vmcnt(6)
    s_barrier
    ds_read_b128 v[232:235], v5 offset:16384
    v_cvt_pk_bf16_f32 v93, v190, v191
    v_exp_f32 v194, v194
    s_waitcnt lgkmcnt(3)
    v_mfma_f32_16x16x32_bf16 v[208:211], v[244:247], v[160:163], v[208:211]
    v_exp_f32 v195, v195
    v_mfma_f32_16x16x32_bf16 v[212:215], v[244:247], v[176:179], v[212:215]
    s_add_u32 s22, s21, 0x84000
    s_add_u32 m0, s20, 0x1c000
    s_nop 0
    buffer_load_dwordx4 v2, s[8:11], s22 offen sc1 lds
    ds_read_b128 v[236:239], v5 offset:17408
    v_cvt_pk_bf16_f32 v90, v192, v193
    v_exp_f32 v196, v196
    s_waitcnt lgkmcnt(3)
    v_mfma_f32_16x16x32_bf16 v[200:203], v[224:227], v[164:167], v[200:203]
    v_exp_f32 v197, v197
    v_cvt_pk_bf16_f32 v91, v194, v195
    v_mfma_f32_16x16x32_bf16 v[204:207], v[224:227], v[180:183], v[204:207]
    ds_read_b128 v[240:243], v5 offset:18432
    v_exp_f32 v198, v198
    s_waitcnt lgkmcnt(3)
    v_mfma_f32_16x16x32_bf16 v[208:211], v[228:231], v[164:167], v[208:211]
    v_exp_f32 v199, v199
    v_cvt_pk_bf16_f32 v94, v196, v197
    v_mfma_f32_16x16x32_bf16 v[212:215], v[228:231], v[180:183], v[212:215]
    ds_read_b128 v[244:247], v5 offset:19456
    v_cvt_pk_bf16_f32 v95, v198, v199
    s_waitcnt lgkmcnt(3)
    v_mfma_f32_16x16x32_bf16 v[184:187], v[232:235], v[152:155], v[216:219]
    v_mfma_f32_16x16x32_bf16 v[188:191], v[232:235], v[168:171], v[220:223]
    ds_read_b128 v[224:227], v5 offset:20480
    v_exp_f32 v200, v200
    v_exp_f32 v201, v201
    v_mfma_f32_16x16x32_bf16 v[248:251], v[12:15], v[88:91], v[248:251]
    s_waitcnt lgkmcnt(3)
    v_mfma_f32_16x16x32_bf16 v[192:195], v[236:239], v[152:155], v[216:219]
    v_exp_f32 v202, v202
    v_exp_f32 v203, v203
    v_mfma_f32_16x16x32_bf16 v[196:199], v[236:239], v[168:171], v[220:223]
    s_add_u32 s22, s21, 0x84400
    s_add_u32 m0, s20, 0x1c400
    s_nop 0
    buffer_load_dwordx4 v2, s[8:11], s22 offen sc1 lds
    ds_read_b128 v[228:231], v5 offset:21504
    v_cvt_pk_bf16_f32 v96, v200, v201
    v_mfma_f32_16x16x32_bf16 v[252:255], v[12:15], v[92:95], v[252:255]
    s_waitcnt lgkmcnt(3)
    v_mfma_f32_16x16x32_bf16 v[184:187], v[240:243], v[156:159], v[184:187]
    v_exp_f32 v204, v204
    v_exp_f32 v205, v205
    v_mfma_f32_16x16x32_bf16 v[188:191], v[240:243], v[172:175], v[188:191]
    ds_read_b128 v[232:235], v5 offset:22528
    v_cvt_pk_bf16_f32 v97, v202, v203
    s_waitcnt lgkmcnt(3)
    v_mfma_f32_16x16x32_bf16 v[192:195], v[244:247], v[156:159], v[192:195]
    v_exp_f32 v206, v206
    v_exp_f32 v207, v207
    v_mfma_f32_16x16x32_bf16 v[196:199], v[244:247], v[172:175], v[196:199]
    ds_read_b128 v[236:239], v5 offset:23552
    v_cvt_pk_bf16_f32 v100, v204, v205
    v_exp_f32 v208, v208
    s_waitcnt lgkmcnt(3)
    v_mfma_f32_16x16x32_bf16 v[184:187], v[224:227], v[160:163], v[184:187]
    v_exp_f32 v209, v209
    v_mfma_f32_16x16x32_bf16 v[188:191], v[224:227], v[176:179], v[188:191]
    ds_read_b128 v[240:243], v5 offset:24576
    v_cvt_pk_bf16_f32 v101, v206, v207
    v_exp_f32 v210, v210
    s_waitcnt lgkmcnt(3)
    v_mfma_f32_16x16x32_bf16 v[192:195], v[228:231], v[160:163], v[192:195]
    v_exp_f32 v211, v211
    v_mfma_f32_16x16x32_bf16 v[196:199], v[228:231], v[176:179], v[196:199]
    ds_read_b128 v[244:247], v5 offset:25600
    v_cvt_pk_bf16_f32 v98, v208, v209
    v_exp_f32 v212, v212
    s_waitcnt lgkmcnt(3)
    v_mfma_f32_16x16x32_bf16 v[184:187], v[232:235], v[164:167], v[184:187]
    v_exp_f32 v213, v213
    v_cvt_pk_bf16_f32 v99, v210, v211
    v_mfma_f32_16x16x32_bf16 v[188:191], v[232:235], v[180:183], v[188:191]
    ds_read_b128 v[224:227], v5 offset:26624
    v_exp_f32 v214, v214
    s_waitcnt lgkmcnt(3)
    v_mfma_f32_16x16x32_bf16 v[192:195], v[236:239], v[164:167], v[192:195]
    v_exp_f32 v215, v215
    v_cvt_pk_bf16_f32 v102, v212, v213
    v_mfma_f32_16x16x32_bf16 v[196:199], v[236:239], v[180:183], v[196:199]
    ds_read_b128 v[228:231], v5 offset:27648
    v_cvt_pk_bf16_f32 v103, v214, v215
    s_waitcnt lgkmcnt(3)
    v_mfma_f32_16x16x32_bf16 v[200:203], v[240:243], v[152:155], v[216:219]
    v_mfma_f32_16x16x32_bf16 v[204:207], v[240:243], v[168:171], v[220:223]
    ds_read_b128 v[232:235], v5 offset:28672
    v_exp_f32 v184, v184
    v_exp_f32 v185, v185
    v_mfma_f32_16x16x32_bf16 v[248:251], v[12:15], v[96:99], v[248:251]
    s_waitcnt lgkmcnt(3)
    v_mfma_f32_16x16x32_bf16 v[208:211], v[244:247], v[152:155], v[216:219]
    v_exp_f32 v186, v186
    v_exp_f32 v187, v187
    v_mfma_f32_16x16x32_bf16 v[212:215], v[244:247], v[168:171], v[220:223]
    ds_read_b128 v[236:239], v5 offset:29696
    v_cvt_pk_bf16_f32 v104, v184, v185
    v_mfma_f32_16x16x32_bf16 v[252:255], v[12:15], v[100:103], v[252:255]
    s_waitcnt lgkmcnt(3)
    v_mfma_f32_16x16x32_bf16 v[200:203], v[224:227], v[156:159], v[200:203]
    v_exp_f32 v188, v188
    v_exp_f32 v189, v189
    v_mfma_f32_16x16x32_bf16 v[204:207], v[224:227], v[172:175], v[204:207]
    ds_read_b128 v[240:243], v5 offset:30720
    v_cvt_pk_bf16_f32 v105, v186, v187
    s_waitcnt lgkmcnt(3)
    v_mfma_f32_16x16x32_bf16 v[208:211], v[228:231], v[156:159], v[208:211]
    v_exp_f32 v190, v190
    v_exp_f32 v191, v191
    v_mfma_f32_16x16x32_bf16 v[212:215], v[228:231], v[172:175], v[212:215]
    ds_read_b128 v[244:247], v5 offset:31744
    v_cvt_pk_bf16_f32 v108, v188, v189
    v_exp_f32 v192, v192
    s_waitcnt lgkmcnt(3)
    v_mfma_f32_16x16x32_bf16 v[200:203], v[232:235], v[160:163], v[200:203]
    v_exp_f32 v193, v193
    v_mfma_f32_16x16x32_bf16 v[204:207], v[232:235], v[176:179], v[204:207]
    s_waitcnt vmcnt(6)
    s_barrier
    ds_read_b128 v[224:227], v4 offset:0
    v_cvt_pk_bf16_f32 v109, v190, v191
    v_exp_f32 v194, v194
    s_waitcnt lgkmcnt(3)
    v_mfma_f32_16x16x32_bf16 v[208:211], v[236:239], v[160:163], v[208:211]
    v_exp_f32 v195, v195
    v_mfma_f32_16x16x32_bf16 v[212:215], v[236:239], v[176:179], v[212:215]
    s_add_u32 s22, s21, 0x88000
    s_add_u32 m0, s20, 0x20000
    s_nop 0
    buffer_load_dwordx4 v2, s[8:11], s22 offen sc1 lds
    ds_read_b128 v[228:231], v4 offset:1024
    v_cvt_pk_bf16_f32 v106, v192, v193
    v_exp_f32 v196, v196
    s_waitcnt lgkmcnt(3)
    v_mfma_f32_16x16x32_bf16 v[200:203], v[240:243], v[164:167], v[200:203]
    v_exp_f32 v197, v197
    v_cvt_pk_bf16_f32 v107, v194, v195
    v_mfma_f32_16x16x32_bf16 v[204:207], v[240:243], v[180:183], v[204:207]
    ds_read_b128 v[232:235], v4 offset:2048
    v_exp_f32 v198, v198
    s_waitcnt lgkmcnt(3)
    v_mfma_f32_16x16x32_bf16 v[208:211], v[244:247], v[164:167], v[208:211]
    v_exp_f32 v199, v199
    v_cvt_pk_bf16_f32 v110, v196, v197
    v_mfma_f32_16x16x32_bf16 v[212:215], v[244:247], v[180:183], v[212:215]
    ds_read_b128 v[236:239], v4 offset:3072
    v_cvt_pk_bf16_f32 v111, v198, v199
    s_waitcnt lgkmcnt(3)
    v_mfma_f32_16x16x32_bf16 v[184:187], v[224:227], v[152:155], v[216:219]
    v_mfma_f32_16x16x32_bf16 v[188:191], v[224:227], v[168:171], v[220:223]
    ds_read_b128 v[240:243], v4 offset:4096
    v_exp_f32 v200, v200
    v_exp_f32 v201, v201
    v_mfma_f32_16x16x32_bf16 v[248:251], v[12:15], v[104:107], v[248:251]
    s_waitcnt lgkmcnt(3)
    v_mfma_f32_16x16x32_bf16 v[192:195], v[228:231], v[152:155], v[216:219]
    v_exp_f32 v202, v202
    v_exp_f32 v203, v203
    v_mfma_f32_16x16x32_bf16 v[196:199], v[228:231], v[168:171], v[220:223]
    s_add_u32 s22, s21, 0x88400
    s_add_u32 m0, s20, 0x20400
    s_nop 0
    buffer_load_dwordx4 v2, s[8:11], s22 offen sc1 lds
    ds_read_b128 v[244:247], v4 offset:5120
    v_cvt_pk_bf16_f32 v112, v200, v201
    v_mfma_f32_16x16x32_bf16 v[252:255], v[12:15], v[108:111], v[252:255]
    s_waitcnt lgkmcnt(3)
    v_mfma_f32_16x16x32_bf16 v[184:187], v[232:235], v[156:159], v[184:187]
    v_exp_f32 v204, v204
    v_exp_f32 v205, v205
    v_mfma_f32_16x16x32_bf16 v[188:191], v[232:235], v[172:175], v[188:191]
    ds_read_b128 v[224:227], v4 offset:6144
    v_cvt_pk_bf16_f32 v113, v202, v203
    s_waitcnt lgkmcnt(3)
    v_mfma_f32_16x16x32_bf16 v[192:195], v[236:239], v[156:159], v[192:195]
    v_exp_f32 v206, v206
    v_exp_f32 v207, v207
    v_mfma_f32_16x16x32_bf16 v[196:199], v[236:239], v[172:175], v[196:199]
    ds_read_b128 v[228:231], v4 offset:7168
    v_cvt_pk_bf16_f32 v116, v204, v205
    v_exp_f32 v208, v208
    s_waitcnt lgkmcnt(3)
    v_mfma_f32_16x16x32_bf16 v[184:187], v[240:243], v[160:163], v[184:187]
    v_exp_f32 v209, v209
    v_mfma_f32_16x16x32_bf16 v[188:191], v[240:243], v[176:179], v[188:191]
    ds_read_b128 v[232:235], v4 offset:8192
    v_cvt_pk_bf16_f32 v117, v206, v207
    v_exp_f32 v210, v210
    s_waitcnt lgkmcnt(3)
    v_mfma_f32_16x16x32_bf16 v[192:195], v[244:247], v[160:163], v[192:195]
    v_exp_f32 v211, v211
    v_mfma_f32_16x16x32_bf16 v[196:199], v[244:247], v[176:179], v[196:199]
    ds_read_b128 v[236:239], v4 offset:9216
    v_cvt_pk_bf16_f32 v114, v208, v209
    v_exp_f32 v212, v212
    s_waitcnt lgkmcnt(3)
    v_mfma_f32_16x16x32_bf16 v[184:187], v[224:227], v[164:167], v[184:187]
    v_exp_f32 v213, v213
    v_cvt_pk_bf16_f32 v115, v210, v211
    v_mfma_f32_16x16x32_bf16 v[188:191], v[224:227], v[180:183], v[188:191]
    ds_read_b128 v[240:243], v4 offset:10240
    v_exp_f32 v214, v214
    s_waitcnt lgkmcnt(3)
    v_mfma_f32_16x16x32_bf16 v[192:195], v[228:231], v[164:167], v[192:195]
    v_exp_f32 v215, v215
    v_cvt_pk_bf16_f32 v118, v212, v213
    v_mfma_f32_16x16x32_bf16 v[196:199], v[228:231], v[180:183], v[196:199]
    ds_read_b128 v[244:247], v4 offset:11264
    v_cvt_pk_bf16_f32 v119, v214, v215
    s_waitcnt lgkmcnt(3)
    v_mfma_f32_16x16x32_bf16 v[200:203], v[232:235], v[152:155], v[216:219]
    v_mfma_f32_16x16x32_bf16 v[204:207], v[232:235], v[168:171], v[220:223]
    ds_read_b128 v[224:227], v4 offset:12288
    v_exp_f32 v184, v184
    v_exp_f32 v185, v185
    v_mfma_f32_16x16x32_bf16 v[248:251], v[12:15], v[112:115], v[248:251]
    s_waitcnt lgkmcnt(3)
    v_mfma_f32_16x16x32_bf16 v[208:211], v[236:239], v[152:155], v[216:219]
    v_exp_f32 v186, v186
    v_exp_f32 v187, v187
    v_mfma_f32_16x16x32_bf16 v[212:215], v[236:239], v[168:171], v[220:223]
    ds_read_b128 v[228:231], v4 offset:13312
    v_cvt_pk_bf16_f32 v120, v184, v185
    v_mfma_f32_16x16x32_bf16 v[252:255], v[12:15], v[116:119], v[252:255]
    s_waitcnt lgkmcnt(3)
    v_mfma_f32_16x16x32_bf16 v[200:203], v[240:243], v[156:159], v[200:203]
    v_exp_f32 v188, v188
    v_exp_f32 v189, v189
    v_mfma_f32_16x16x32_bf16 v[204:207], v[240:243], v[172:175], v[204:207]
    ds_read_b128 v[232:235], v4 offset:14336
    v_cvt_pk_bf16_f32 v121, v186, v187
    s_waitcnt lgkmcnt(3)
    v_mfma_f32_16x16x32_bf16 v[208:211], v[244:247], v[156:159], v[208:211]
    v_exp_f32 v190, v190
    v_exp_f32 v191, v191
    v_mfma_f32_16x16x32_bf16 v[212:215], v[244:247], v[172:175], v[212:215]
    ds_read_b128 v[236:239], v4 offset:15360
    v_cvt_pk_bf16_f32 v124, v188, v189
    v_exp_f32 v192, v192
    s_waitcnt lgkmcnt(3)
    v_mfma_f32_16x16x32_bf16 v[200:203], v[224:227], v[160:163], v[200:203]
    v_exp_f32 v193, v193
    v_mfma_f32_16x16x32_bf16 v[204:207], v[224:227], v[176:179], v[204:207]
    s_waitcnt vmcnt(6)
    s_barrier
    ds_read_b128 v[240:243], v4 offset:16384
    v_cvt_pk_bf16_f32 v125, v190, v191
    v_exp_f32 v194, v194
    s_waitcnt lgkmcnt(3)
    v_mfma_f32_16x16x32_bf16 v[208:211], v[228:231], v[160:163], v[208:211]
    v_exp_f32 v195, v195
    v_mfma_f32_16x16x32_bf16 v[212:215], v[228:231], v[176:179], v[212:215]
    s_add_u32 s22, s21, 0x8c000
    s_add_u32 m0, s20, 0x24000
    s_nop 0
    buffer_load_dwordx4 v2, s[8:11], s22 offen sc1 lds
    ds_read_b128 v[244:247], v4 offset:17408
    v_cvt_pk_bf16_f32 v122, v192, v193
    v_exp_f32 v196, v196
    s_waitcnt lgkmcnt(3)
    v_mfma_f32_16x16x32_bf16 v[200:203], v[232:235], v[164:167], v[200:203]
    v_exp_f32 v197, v197
    v_cvt_pk_bf16_f32 v123, v194, v195
    v_mfma_f32_16x16x32_bf16 v[204:207], v[232:235], v[180:183], v[204:207]
    ds_read_b128 v[224:227], v4 offset:18432
    v_exp_f32 v198, v198
    s_waitcnt lgkmcnt(3)
    v_mfma_f32_16x16x32_bf16 v[208:211], v[236:239], v[164:167], v[208:211]
    v_exp_f32 v199, v199
    v_cvt_pk_bf16_f32 v126, v196, v197
    v_mfma_f32_16x16x32_bf16 v[212:215], v[236:239], v[180:183], v[212:215]
    ds_read_b128 v[228:231], v4 offset:19456
    v_cvt_pk_bf16_f32 v127, v198, v199
    s_waitcnt lgkmcnt(3)
    v_mfma_f32_16x16x32_bf16 v[184:187], v[240:243], v[152:155], v[216:219]
    v_mfma_f32_16x16x32_bf16 v[188:191], v[240:243], v[168:171], v[220:223]
    ds_read_b128 v[232:235], v4 offset:20480
    v_exp_f32 v200, v200
    v_exp_f32 v201, v201
    v_mfma_f32_16x16x32_bf16 v[248:251], v[12:15], v[120:123], v[248:251]
    s_waitcnt lgkmcnt(3)
    v_mfma_f32_16x16x32_bf16 v[192:195], v[244:247], v[152:155], v[216:219]
    v_exp_f32 v202, v202
    v_exp_f32 v203, v203
    v_mfma_f32_16x16x32_bf16 v[196:199], v[244:247], v[168:171], v[220:223]
    s_add_u32 s22, s21, 0x8c400
    s_add_u32 m0, s20, 0x24400
    s_nop 0
    buffer_load_dwordx4 v2, s[8:11], s22 offen sc1 lds
    ds_read_b128 v[236:239], v4 offset:21504
    v_cvt_pk_bf16_f32 v128, v200, v201
    v_mfma_f32_16x16x32_bf16 v[252:255], v[12:15], v[124:127], v[252:255]
    s_waitcnt lgkmcnt(3)
    v_mfma_f32_16x16x32_bf16 v[184:187], v[224:227], v[156:159], v[184:187]
    v_exp_f32 v204, v204
    v_exp_f32 v205, v205
    v_mfma_f32_16x16x32_bf16 v[188:191], v[224:227], v[172:175], v[188:191]
    ds_read_b128 v[240:243], v4 offset:22528
    v_cvt_pk_bf16_f32 v129, v202, v203
    s_waitcnt lgkmcnt(3)
    v_mfma_f32_16x16x32_bf16 v[192:195], v[228:231], v[156:159], v[192:195]
    v_exp_f32 v206, v206
    v_exp_f32 v207, v207
    v_mfma_f32_16x16x32_bf16 v[196:199], v[228:231], v[172:175], v[196:199]
    ds_read_b128 v[244:247], v4 offset:23552
    v_cvt_pk_bf16_f32 v132, v204, v205
    v_exp_f32 v208, v208
    s_waitcnt lgkmcnt(3)
    v_mfma_f32_16x16x32_bf16 v[184:187], v[232:235], v[160:163], v[184:187]
    v_exp_f32 v209, v209
    v_mfma_f32_16x16x32_bf16 v[188:191], v[232:235], v[176:179], v[188:191]
    ds_read_b128 v[224:227], v4 offset:24576
    v_cvt_pk_bf16_f32 v133, v206, v207
    v_exp_f32 v210, v210
    s_waitcnt lgkmcnt(3)
    v_mfma_f32_16x16x32_bf16 v[192:195], v[236:239], v[160:163], v[192:195]
    v_exp_f32 v211, v211
    v_mfma_f32_16x16x32_bf16 v[196:199], v[236:239], v[176:179], v[196:199]
    ds_read_b128 v[228:231], v4 offset:25600
    v_cvt_pk_bf16_f32 v130, v208, v209
    v_exp_f32 v212, v212
    s_waitcnt lgkmcnt(3)
    v_mfma_f32_16x16x32_bf16 v[184:187], v[240:243], v[164:167], v[184:187]
    v_exp_f32 v213, v213
    v_cvt_pk_bf16_f32 v131, v210, v211
    v_mfma_f32_16x16x32_bf16 v[188:191], v[240:243], v[180:183], v[188:191]
    ds_read_b128 v[232:235], v4 offset:26624
    v_exp_f32 v214, v214
    s_waitcnt lgkmcnt(3)
    v_mfma_f32_16x16x32_bf16 v[192:195], v[244:247], v[164:167], v[192:195]
    v_exp_f32 v215, v215
    v_cvt_pk_bf16_f32 v134, v212, v213
    v_mfma_f32_16x16x32_bf16 v[196:199], v[244:247], v[180:183], v[196:199]
    ds_read_b128 v[236:239], v4 offset:27648
    v_cvt_pk_bf16_f32 v135, v214, v215
    s_waitcnt lgkmcnt(3)
    v_mfma_f32_16x16x32_bf16 v[200:203], v[224:227], v[152:155], v[216:219]
    v_mfma_f32_16x16x32_bf16 v[204:207], v[224:227], v[168:171], v[220:223]
    ds_read_b128 v[240:243], v4 offset:28672
    v_exp_f32 v184, v184
    v_exp_f32 v185, v185
    v_mfma_f32_16x16x32_bf16 v[248:251], v[12:15], v[128:131], v[248:251]
    s_waitcnt lgkmcnt(3)
    v_mfma_f32_16x16x32_bf16 v[208:211], v[228:231], v[152:155], v[216:219]
    v_exp_f32 v186, v186
    v_exp_f32 v187, v187
    v_mfma_f32_16x16x32_bf16 v[212:215], v[228:231], v[168:171], v[220:223]
    ds_read_b128 v[244:247], v4 offset:29696
    v_cvt_pk_bf16_f32 v136, v184, v185
    v_mfma_f32_16x16x32_bf16 v[252:255], v[12:15], v[132:135], v[252:255]
    s_waitcnt lgkmcnt(3)
    v_mfma_f32_16x16x32_bf16 v[200:203], v[232:235], v[156:159], v[200:203]
    v_exp_f32 v188, v188
    v_exp_f32 v189, v189
    v_mfma_f32_16x16x32_bf16 v[204:207], v[232:235], v[172:175], v[204:207]
    ds_read_b128 v[224:227], v4 offset:30720
    v_cvt_pk_bf16_f32 v137, v186, v187
    s_waitcnt lgkmcnt(3)
    v_mfma_f32_16x16x32_bf16 v[208:211], v[236:239], v[156:159], v[208:211]
    v_exp_f32 v190, v190
    v_exp_f32 v191, v191
    v_mfma_f32_16x16x32_bf16 v[212:215], v[236:239], v[172:175], v[212:215]
    ds_read_b128 v[228:231], v4 offset:31744
    v_cvt_pk_bf16_f32 v140, v188, v189
    v_exp_f32 v192, v192
    s_waitcnt lgkmcnt(3)
    v_mfma_f32_16x16x32_bf16 v[200:203], v[240:243], v[160:163], v[200:203]
    v_exp_f32 v193, v193
    v_mfma_f32_16x16x32_bf16 v[204:207], v[240:243], v[176:179], v[204:207]
    v_cvt_pk_bf16_f32 v141, v190, v191
    v_exp_f32 v194, v194
    s_waitcnt lgkmcnt(2)
    v_mfma_f32_16x16x32_bf16 v[208:211], v[244:247], v[160:163], v[208:211]
    v_exp_f32 v195, v195
    v_mfma_f32_16x16x32_bf16 v[212:215], v[244:247], v[176:179], v[212:215]
    v_cvt_pk_bf16_f32 v138, v192, v193
    v_exp_f32 v196, v196
    s_waitcnt lgkmcnt(1)
    v_mfma_f32_16x16x32_bf16 v[200:203], v[224:227], v[164:167], v[200:203]
    v_exp_f32 v197, v197
    v_cvt_pk_bf16_f32 v139, v194, v195
    v_mfma_f32_16x16x32_bf16 v[204:207], v[224:227], v[180:183], v[204:207]
    v_exp_f32 v198, v198
    s_waitcnt lgkmcnt(0)
    v_mfma_f32_16x16x32_bf16 v[208:211], v[228:231], v[164:167], v[208:211]
    v_exp_f32 v199, v199
    v_cvt_pk_bf16_f32 v142, v196, v197
    v_mfma_f32_16x16x32_bf16 v[212:215], v[228:231], v[180:183], v[212:215]
    v_cvt_pk_bf16_f32 v143, v198, v199
    s_waitcnt vmcnt(6)
    s_barrier
    ds_read_b128 v[232:235], v4 offset:32768
    ds_read_b128 v[236:239], v4 offset:33792
    ds_read_b128 v[240:243], v4 offset:34816
    ds_read_b128 v[244:247], v4 offset:35840
    v_mfma_f32_16x16x32_bf16 v[248:251], v[12:15], v[136:139], v[248:251]
    v_mfma_f32_16x16x32_bf16 v[252:255], v[12:15], v[140:143], v[252:255]
    v_exp_f32 v200, v200
    v_exp_f32 v201, v201
    v_exp_f32 v202, v202
    v_exp_f32 v203, v203
    v_cvt_pk_bf16_f32 v144, v200, v201
    v_exp_f32 v204, v204
    v_exp_f32 v205, v205
    v_cvt_pk_bf16_f32 v145, v202, v203
    v_exp_f32 v206, v206
    v_exp_f32 v207, v207
    v_cvt_pk_bf16_f32 v148, v204, v205
    v_exp_f32 v208, v208
    v_exp_f32 v209, v209
    v_cvt_pk_bf16_f32 v149, v206, v207
    v_exp_f32 v210, v210
    v_exp_f32 v211, v211
    v_cvt_pk_bf16_f32 v146, v208, v209
    v_exp_f32 v212, v212
    v_exp_f32 v213, v213
    v_cvt_pk_bf16_f32 v147, v210, v211
    v_exp_f32 v214, v214
    v_exp_f32 v215, v215
    v_cvt_pk_bf16_f32 v150, v212, v213
    v_cvt_pk_bf16_f32 v151, v214, v215
    v_mfma_f32_16x16x32_bf16 v[248:251], v[12:15], v[144:147], v[248:251]
    s_nop 0
    v_mfma_f32_16x16x32_bf16 v[252:255], v[12:15], v[148:151], v[252:255]
    s_nop 5
    v_mov_b32 v9, v248
    s_nop 0
    v_mov_b32 v10, v252
    v_max_f32 v17, v9, v10
    v_readfirstlane_b32 s17, v8
    s_cmp_eq_u32 s17, s28
    s_cselect_b32 s16, 0, 0x71800000
    v_cmp_ngt_f32 vcc, s16, v17
    v_cmp_u_f32 s[76:77], v9, v10
    s_or_b64 vcc, vcc, s[76:77]
    s_cbranch_vccnz adaLN_cond__sliding_block_cached__moe_arch_mod__prompt_kernel_fixA
adaLN_cond__sliding_block_cached__moe_arch_mod__prompt_kernel_fixAb:
    v_rcp_f32 v9, v9
    v_rcp_f32 v10, v10
    s_lshl_b32 s25, s13, 3
    s_add_u32 s25, s25, s3
    s_lshl_b32 s25, s25, 18
    s_lshl_b32 s26, s12, 12
    s_add_u32 s25, s25, s26
    s_add_u32 s25, s25, 0x1000000
    s_add_u32 s26, s25, 131072
    s_lshl_b32 s63, s13, 3
    s_add_u32 s63, s63, s3
    s_lshl_b32 s63, s63, 5
    s_add_u32 s63, s63, s12
    s_lshl_b32 s63, s63, 2
    s_waitcnt lgkmcnt(3)
    v_mfma_f32_16x16x32_bf16 v[184:187], v[232:235], v[24:27], 0
    s_mov_b64 s[76:77], s[54:55]
    s_mov_b32 s78, 0xc00000
    s_mov_b32 s79, 0x20000
    v_mfma_f32_16x16x32_bf16 v[188:191], v[232:235], v[28:31], 0
    ds_read_b128 v[224:227], v4 offset:36864
    s_waitcnt lgkmcnt(3)
    v_mfma_f32_16x16x32_bf16 v[192:195], v[236:239], v[24:27], 0
    s_add_u32 s22, s14, 0x0
    s_add_u32 m0, s20, 0x10000
    s_nop 0
    buffer_load_dwordx4 v6, s[76:79], s22 offen lds
    v_mfma_f32_16x16x32_bf16 v[196:199], v[236:239], v[28:31], 0
    ds_read_b128 v[228:231], v4 offset:37888
    s_waitcnt lgkmcnt(3)
    v_mfma_f32_16x16x32_bf16 v[184:187], v[240:243], v[32:35], v[184:187]
    v_mfma_f32_16x16x32_bf16 v[188:191], v[240:243], v[36:39], v[188:191]
    ds_read_b128 v[232:235], v4 offset:38912
    s_waitcnt lgkmcnt(3)
    v_mfma_f32_16x16x32_bf16 v[192:195], v[244:247], v[32:35], v[192:195]
    v_mfma_f32_16x16x32_bf16 v[196:199], v[244:247], v[36:39], v[196:199]
    ds_read_b128 v[236:239], v4 offset:39936
    s_waitcnt lgkmcnt(3)
    v_mfma_f32_16x16x32_bf16 v[184:187], v[224:227], v[40:43], v[184:187]
    v_mfma_f32_16x16x32_bf16 v[188:191], v[224:227], v[44:47], v[188:191]
    ds_read_b128 v[240:243], v4 offset:40960
    s_waitcnt lgkmcnt(3)
    v_mfma_f32_16x16x32_bf16 v[192:195], v[228:231], v[40:43], v[192:195]
    s_add_u32 s22, s14, 0xc000
    s_add_u32 m0, s20, 0x10400
    s_nop 0
    buffer_load_dwordx4 v6, s[76:79], s22 offen lds
    v_mfma_f32_16x16x32_bf16 v[196:199], v[228:231], v[44:47], v[196:199]
    ds_read_b128 v[244:247], v4 offset:41984
    s_waitcnt lgkmcnt(3)
    v_mfma_f32_16x16x32_bf16 v[184:187], v[232:235], v[48:51], v[184:187]
    v_mfma_f32_16x16x32_bf16 v[188:191], v[232:235], v[52:55], v[188:191]
    ds_read_b128 v[224:227], v4 offset:43008
    s_waitcnt lgkmcnt(3)
    v_mfma_f32_16x16x32_bf16 v[192:195], v[236:239], v[48:51], v[192:195]
    v_mfma_f32_16x16x32_bf16 v[196:199], v[236:239], v[52:55], v[196:199]
    ds_read_b128 v[228:231], v4 offset:44032
    s_waitcnt lgkmcnt(3)
    v_mfma_f32_16x16x32_bf16 v[184:187], v[240:243], v[56:59], v[184:187]
    v_mfma_f32_16x16x32_bf16 v[188:191], v[240:243], v[60:63], v[188:191]
    ds_read_b128 v[232:235], v4 offset:45056
    s_waitcnt lgkmcnt(3)
    v_mfma_f32_16x16x32_bf16 v[192:195], v[244:247], v[56:59], v[192:195]
    v_mfma_f32_16x16x32_bf16 v[196:199], v[244:247], v[60:63], v[196:199]
    ds_read_b128 v[236:239], v4 offset:46080
    s_waitcnt lgkmcnt(3)
    v_mfma_f32_16x16x32_bf16 v[184:187], v[224:227], v[64:67], v[184:187]
    v_mfma_f32_16x16x32_bf16 v[188:191], v[224:227], v[68:71], v[188:191]
    ds_read_b128 v[240:243], v4 offset:47104
    s_waitcnt lgkmcnt(3)
    v_mfma_f32_16x16x32_bf16 v[192:195], v[228:231], v[64:67], v[192:195]
    v_mfma_f32_16x16x32_bf16 v[196:199], v[228:231], v[68:71], v[196:199]
    ds_read_b128 v[244:247], v4 offset:48128
    s_waitcnt lgkmcnt(3)
    v_mfma_f32_16x16x32_bf16 v[184:187], v[232:235], v[72:75], v[184:187]
    v_mfma_f32_16x16x32_bf16 v[188:191], v[232:235], v[76:79], v[188:191]
    s_waitcnt vmcnt(6)
    s_barrier
    ds_read_b128 v[224:227], v4 offset:49152
    s_waitcnt lgkmcnt(3)
    v_mfma_f32_16x16x32_bf16 v[192:195], v[236:239], v[72:75], v[192:195]
    v_mfma_f32_16x16x32_bf16 v[196:199], v[236:239], v[76:79], v[196:199]
    s_add_u32 s22, s14, 0xc0000
    s_add_u32 m0, s20, 0x14000
    s_nop 0
    buffer_load_dwordx4 v6, s[76:79], s22 offen lds
    ds_read_b128 v[228:231], v4 offset:50176
    s_waitcnt lgkmcnt(3)
    v_mfma_f32_16x16x32_bf16 v[184:187], v[240:243], v[80:83], v[184:187]
    v_mfma_f32_16x16x32_bf16 v[188:191], v[240:243], v[84:87], v[188:191]
    ds_read_b128 v[232:235], v4 offset:51200
    s_waitcnt lgkmcnt(3)
    v_mfma_f32_16x16x32_bf16 v[192:195], v[244:247], v[80:83], v[192:195]
    v_mfma_f32_16x16x32_bf16 v[196:199], v[244:247], v[84:87], v[196:199]
    ds_read_b128 v[236:239], v4 offset:52224
    s_waitcnt lgkmcnt(3)
    v_mfma_f32_16x16x32_bf16 v[184:187], v[224:227], v[88:91], v[184:187]
    v_mfma_f32_16x16x32_bf16 v[188:191], v[224:227], v[92:95], v[188:191]
    ds_read_b128 v[240:243], v4 offset:53248
    s_waitcnt lgkmcnt(3)
    v_mfma_f32_16x16x32_bf16 v[192:195], v[228:231], v[88:91], v[192:195]
    v_mfma_f32_16x16x32_bf16 v[196:199], v[228:231], v[92:95], v[196:199]
    s_add_u32 s22, s14, 0xcc000
    s_add_u32 m0, s20, 0x14400
    s_nop 0
    buffer_load_dwordx4 v6, s[76:79], s22 offen lds
    ds_read_b128 v[244:247], v4 offset:54272
    s_waitcnt lgkmcnt(3)
    v_mfma_f32_16x16x32_bf16 v[184:187], v[232:235], v[96:99], v[184:187]
    v_mfma_f32_16x16x32_bf16 v[188:191], v[232:235], v[100:103], v[188:191]
    ds_read_b128 v[224:227], v4 offset:55296
    s_waitcnt lgkmcnt(3)
    v_mfma_f32_16x16x32_bf16 v[192:195], v[236:239], v[96:99], v[192:195]
    v_mfma_f32_16x16x32_bf16 v[196:199], v[236:239], v[100:103], v[196:199]
    ds_read_b128 v[228:231], v4 offset:56320
    s_waitcnt lgkmcnt(3)
    v_mfma_f32_16x16x32_bf16 v[184:187], v[240:243], v[104:107], v[184:187]
    v_mfma_f32_16x16x32_bf16 v[188:191], v[240:243], v[108:111], v[188:191]
    ds_read_b128 v[232:235], v4 offset:57344
    s_waitcnt lgkmcnt(3)
    v_mfma_f32_16x16x32_bf16 v[192:195], v[244:247], v[104:107], v[192:195]
    v_mfma_f32_16x16x32_bf16 v[196:199], v[244:247], v[108:111], v[196:199]
    ds_read_b128 v[236:239], v4 offset:58368
    s_waitcnt lgkmcnt(3)
    v_mfma_f32_16x16x32_bf16 v[184:187], v[224:227], v[112:115], v[184:187]
    v_mfma_f32_16x16x32_bf16 v[188:191], v[224:227], v[116:119], v[188:191]
    ds_read_b128 v[240:243], v4 offset:59392
    s_waitcnt lgkmcnt(3)
    v_mfma_f32_16x16x32_bf16 v[192:195], v[228:231], v[112:115], v[192:195]
    v_mfma_f32_16x16x32_bf16 v[196:199], v[228:231], v[116:119], v[196:199]
    ds_read_b128 v[244:247], v4 offset:60416
    s_waitcnt lgkmcnt(3)
    v_mfma_f32_16x16x32_bf16 v[184:187], v[232:235], v[120:123], v[184:187]
    v_mfma_f32_16x16x32_bf16 v[188:191], v[232:235], v[124:127], v[188:191]
    ds_read_b128 v[224:227], v4 offset:61440
    s_waitcnt lgkmcnt(3)
    v_mfma_f32_16x16x32_bf16 v[192:195], v[236:239], v[120:123], v[192:195]
    v_mfma_f32_16x16x32_bf16 v[196:199], v[236:239], v[124:127], v[196:199]
    ds_read_b128 v[228:231], v4 offset:62464
    s_waitcnt lgkmcnt(3)
    v_mfma_f32_16x16x32_bf16 v[184:187], v[240:243], v[128:131], v[184:187]
    v_mfma_f32_16x16x32_bf16 v[188:191], v[240:243], v[132:135], v[188:191]
    ds_read_b128 v[232:235], v4 offset:63488
    s_waitcnt lgkmcnt(3)
    v_mfma_f32_16x16x32_bf16 v[192:195], v[244:247], v[128:131], v[192:195]
    v_mfma_f32_16x16x32_bf16 v[196:199], v[244:247], v[132:135], v[196:199]
    ds_read_b128 v[236:239], v4 offset:64512
    s_waitcnt lgkmcnt(3)
    v_mfma_f32_16x16x32_bf16 v[184:187], v[224:227], v[136:139], v[184:187]
    v_mfma_f32_16x16x32_bf16 v[188:191], v[224:227], v[140:143], v[188:191]
    s_waitcnt vmcnt(6)
    s_barrier
    ds_read_b128 v[240:243], v5 offset:0
    s_waitcnt lgkmcnt(3)
    v_mfma_f32_16x16x32_bf16 v[192:195], v[228:231], v[136:139], v[192:195]
    v_mfma_f32_16x16x32_bf16 v[196:199], v[228:231], v[140:143], v[196:199]
    s_add_u32 s22, s21, 0x90000
    s_add_u32 m0, s20, 0x18000
    s_nop 0
    buffer_load_dwordx4 v2, s[8:11], s22 offen sc1 lds
    ds_read_b128 v[244:247], v5 offset:1024
    s_waitcnt lgkmcnt(3)
    v_mfma_f32_16x16x32_bf16 v[184:187], v[232:235], v[144:147], v[184:187]
    v_mfma_f32_16x16x32_bf16 v[188:191], v[232:235], v[148:151], v[188:191]
    ds_read_b128 v[224:227], v5 offset:2048
    s_waitcnt lgkmcnt(3)
    v_mfma_f32_16x16x32_bf16 v[192:195], v[236:239], v[144:147], v[192:195]
    v_mfma_f32_16x16x32_bf16 v[196:199], v[236:239], v[148:151], v[196:199]
    ds_read_b128 v[228:231], v5 offset:3072
    s_waitcnt lgkmcnt(3)
    v_mfma_f32_16x16x32_bf16 v[200:203], v[240:243], v[24:27], 0
    v_mfma_f32_16x16x32_bf16 v[204:207], v[240:243], v[28:31], 0
    ds_read_b128 v[232:235], v5 offset:4096
    s_waitcnt lgkmcnt(3)
    v_mfma_f32_16x16x32_bf16 v[208:211], v[244:247], v[24:27], 0
    v_mfma_f32_16x16x32_bf16 v[212:215], v[244:247], v[28:31], 0
    s_add_u32 s22, s21, 0x90400
    s_add_u32 m0, s20, 0x18400
    s_nop 0
    buffer_load_dwordx4 v2, s[8:11], s22 offen sc1 lds
    ds_read_b128 v[236:239], v5 offset:5120
    v_mul_f32 v184, v184, v9
    s_waitcnt lgkmcnt(3)
    v_mfma_f32_16x16x32_bf16 v[200:203], v[224:227], v[32:35], v[200:203]
    v_mul_f32 v185, v185, v9
    v_mfma_f32_16x16x32_bf16 v[204:207], v[224:227], v[36:39], v[204:207]
    ds_read_b128 v[240:243], v5 offset:6144
    v_mul_f32 v186, v186, v9
    s_waitcnt lgkmcnt(3)
    v_mfma_f32_16x16x32_bf16 v[208:211], v[228:231], v[32:35], v[208:211]
    v_mul_f32 v187, v187, v9
    v_mfma_f32_16x16x32_bf16 v[212:215], v[228:231], v[36:39], v[212:215]
    ds_read_b128 v[244:247], v5 offset:7168
    v_mul_f32 v192, v192, v9
    s_waitcnt lgkmcnt(3)
    v_mfma_f32_16x16x32_bf16 v[200:203], v[232:235], v[40:43], v[200:203]
    v_mul_f32 v193, v193, v9
    v_mfma_f32_16x16x32_bf16 v[204:207], v[232:235], v[44:47], v[204:207]
    ds_read_b128 v[224:227], v5 offset:8192
    v_mul_f32 v194, v194, v9
    s_waitcnt lgkmcnt(3)
    v_mfma_f32_16x16x32_bf16 v[208:211], v[236:239], v[40:43], v[208:211]
    v_mul_f32 v195, v195, v9
    v_mfma_f32_16x16x32_bf16 v[212:215], v[236:239], v[44:47], v[212:215]
    ds_read_b128 v[228:231], v5 offset:9216
    v_cvt_pk_bf16_f32 v216, v184, v185
    s_waitcnt lgkmcnt(3)
    v_mfma_f32_16x16x32_bf16 v[200:203], v[240:243], v[48:51], v[200:203]
    v_cvt_pk_bf16_f32 v217, v186, v187
    v_mfma_f32_16x16x32_bf16 v[204:207], v[240:243], v[52:55], v[204:207]
    ds_read_b128 v[232:235], v5 offset:10240
    v_cvt_pk_bf16_f32 v218, v192, v193
    s_waitcnt lgkmcnt(3)
    v_mfma_f32_16x16x32_bf16 v[208:211], v[244:247], v[48:51], v[208:211]
    v_cvt_pk_bf16_f32 v219, v194, v195
    v_mfma_f32_16x16x32_bf16 v[212:215], v[244:247], v[52:55], v[212:215]
    ds_read_b128 v[236:239], v5 offset:11264
    buffer_store_dwordx4 v[216:219], v2, s[8:11], s25 offen offset:0 sc1
    s_waitcnt lgkmcnt(3)
    v_mfma_f32_16x16x32_bf16 v[200:203], v[224:227], v[56:59], v[200:203]
    v_mul_f32 v188, v188, v10
    v_mfma_f32_16x16x32_bf16 v[204:207], v[224:227], v[60:63], v[204:207]
    ds_read_b128 v[240:243], v5 offset:12288
    v_mul_f32 v189, v189, v10
    s_waitcnt lgkmcnt(3)
    v_mfma_f32_16x16x32_bf16 v[208:211], v[228:231], v[56:59], v[208:211]
    v_mul_f32 v190, v190, v10
    v_mfma_f32_16x16x32_bf16 v[212:215], v[228:231], v[60:63], v[212:215]
    ds_read_b128 v[244:247], v5 offset:13312
    v_mul_f32 v191, v191, v10
    s_waitcnt lgkmcnt(3)
    v_mfma_f32_16x16x32_bf16 v[200:203], v[232:235], v[64:67], v[200:203]
    v_mul_f32 v196, v196, v10
    v_mfma_f32_16x16x32_bf16 v[204:207], v[232:235], v[68:71], v[204:207]
    ds_read_b128 v[224:227], v5 offset:14336
    v_mul_f32 v197, v197, v10
    s_waitcnt lgkmcnt(3)
    v_mfma_f32_16x16x32_bf16 v[208:211], v[236:239], v[64:67], v[208:211]
    v_mul_f32 v198, v198, v10
    v_mfma_f32_16x16x32_bf16 v[212:215], v[236:239], v[68:71], v[212:215]
    ds_read_b128 v[228:231], v5 offset:15360
    v_mul_f32 v199, v199, v10
    s_waitcnt lgkmcnt(3)
    v_mfma_f32_16x16x32_bf16 v[200:203], v[240:243], v[72:75], v[200:203]
    v_cvt_pk_bf16_f32 v220, v188, v189
    v_mfma_f32_16x16x32_bf16 v[204:207], v[240:243], v[76:79], v[204:207]
    s_waitcnt vmcnt(7)
    s_barrier
    ds_read_b128 v[232:235], v5 offset:16384
    v_cvt_pk_bf16_f32 v221, v190, v191
    s_waitcnt lgkmcnt(3)
    v_mfma_f32_16x16x32_bf16 v[208:211], v[244:247], v[72:75], v[208:211]
    v_cvt_pk_bf16_f32 v222, v196, v197
    v_mfma_f32_16x16x32_bf16 v[212:215], v[244:247], v[76:79], v[212:215]
    s_add_u32 s22, s21, 0x94000
    s_add_u32 m0, s20, 0x1c000
    s_nop 0
    buffer_load_dwordx4 v2, s[8:11], s22 offen sc1 lds
    ds_read_b128 v[236:239], v5 offset:17408
    v_cvt_pk_bf16_f32 v223, v198, v199
    s_waitcnt lgkmcnt(3)
    v_mfma_f32_16x16x32_bf16 v[200:203], v[224:227], v[80:83], v[200:203]
    buffer_store_dwordx4 v[220:223], v2, s[8:11], s26 offen offset:0 sc1
    v_mfma_f32_16x16x32_bf16 v[204:207], v[224:227], v[84:87], v[204:207]
    ds_read_b128 v[240:243], v5 offset:18432
    s_waitcnt lgkmcnt(3)
    v_mfma_f32_16x16x32_bf16 v[208:211], v[228:231], v[80:83], v[208:211]
    v_mfma_f32_16x16x32_bf16 v[212:215], v[228:231], v[84:87], v[212:215]
    ds_read_b128 v[244:247], v5 offset:19456
    s_waitcnt lgkmcnt(3)
    v_mfma_f32_16x16x32_bf16 v[200:203], v[232:235], v[88:91], v[200:203]
    v_lshrrev_b32 v20, 4, v1
    v_lshlrev_b32 v21, 4, v20
    s_lshl_b32 s16, s2, 8
    s_add_u32 s16, s16, 0x550000
    buffer_load_dwordx4 v[152:155], v21, s[8:11], s16 offen offset:0 sc1
    buffer_load_dwordx4 v[156:159], v21, s[8:11], s16 offen offset:64 sc1
    buffer_load_dwordx4 v[160:163], v21, s[8:11], s16 offen offset:128 sc1
    buffer_load_dwordx4 v[164:167], v21, s[8:11], s16 offen offset:192 sc1
    v_lshlrev_b32 v11, 11, v20
    v_xor_b32 v20, s3, v20
    v_and_b32 v20, 1, v20
    v_lshl_add_u32 v11, v20, 5, v11
    v_bfe_u32 v20, v1, 2, 2
    v_lshl_add_u32 v11, v20, 6, v11
    v_and_b32 v20, 3, v1
    v_lshl_add_u32 v11, v20, 3, v11
    s_lshr_b32 s16, s3, 1
    s_lshl_b32 s16, s16, 8
    s_add_u32 s16, s16, 65536
    v_add_u32 v11, s16, v11
    v_mfma_f32_16x16x32_bf16 v[204:207], v[232:235], v[92:95], v[204:207]
    ds_read_b128 v[224:227], v5 offset:20480
    s_waitcnt lgkmcnt(3)
    v_mfma_f32_16x16x32_bf16 v[208:211], v[236:239], v[88:91], v[208:211]
    v_mfma_f32_16x16x32_bf16 v[212:215], v[236:239], v[92:95], v[212:215]
    s_add_u32 s22, s21, 0x94400
    s_add_u32 m0, s20, 0x1c400
    s_nop 0
    buffer_load_dwordx4 v2, s[8:11], s22 offen sc1 lds
    ds_read_b128 v[228:231], v5 offset:21504
    s_waitcnt lgkmcnt(3)
    v_mfma_f32_16x16x32_bf16 v[200:203], v[240:243], v[96:99], v[200:203]
    v_mfma_f32_16x16x32_bf16 v[204:207], v[240:243], v[100:103], v[204:207]
    ds_read_b128 v[232:235], v5 offset:22528
    s_waitcnt lgkmcnt(3)
    v_mfma_f32_16x16x32_bf16 v[208:211], v[244:247], v[96:99], v[208:211]
    v_mfma_f32_16x16x32_bf16 v[212:215], v[244:247], v[100:103], v[212:215]
    ds_read_b128 v[236:239], v5 offset:23552
    s_waitcnt lgkmcnt(3)
    v_mfma_f32_16x16x32_bf16 v[200:203], v[224:227], v[104:107], v[200:203]
    v_mfma_f32_16x16x32_bf16 v[204:207], v[224:227], v[108:111], v[204:207]
    ds_read_b128 v[240:243], v5 offset:24576
    s_waitcnt lgkmcnt(3)
    v_mfma_f32_16x16x32_bf16 v[208:211], v[228:231], v[104:107], v[208:211]
    v_mfma_f32_16x16x32_bf16 v[212:215], v[228:231], v[108:111], v[212:215]
    ds_read_b128 v[244:247], v5 offset:25600
    s_waitcnt lgkmcnt(3)
    v_mfma_f32_16x16x32_bf16 v[200:203], v[232:235], v[112:115], v[200:203]
    v_mfma_f32_16x16x32_bf16 v[204:207], v[232:235], v[116:119], v[204:207]
    ds_read_b128 v[224:227], v5 offset:26624
    s_waitcnt lgkmcnt(3)
    v_mfma_f32_16x16x32_bf16 v[208:211], v[236:239], v[112:115], v[208:211]
    v_mfma_f32_16x16x32_bf16 v[212:215], v[236:239], v[116:119], v[212:215]
    ds_read_b128 v[228:231], v5 offset:27648
    s_waitcnt lgkmcnt(3)
    v_mfma_f32_16x16x32_bf16 v[200:203], v[240:243], v[120:123], v[200:203]
    v_mfma_f32_16x16x32_bf16 v[204:207], v[240:243], v[124:127], v[204:207]
    ds_read_b128 v[232:235], v5 offset:28672
    s_waitcnt lgkmcnt(3)
    v_mfma_f32_16x16x32_bf16 v[208:211], v[244:247], v[120:123], v[208:211]
    v_mfma_f32_16x16x32_bf16 v[212:215], v[244:247], v[124:127], v[212:215]
    ds_read_b128 v[236:239], v5 offset:29696
    s_waitcnt lgkmcnt(3)
    v_mfma_f32_16x16x32_bf16 v[200:203], v[224:227], v[128:131], v[200:203]
    v_mfma_f32_16x16x32_bf16 v[204:207], v[224:227], v[132:135], v[204:207]
    ds_read_b128 v[240:243], v5 offset:30720
    s_waitcnt lgkmcnt(3)
    v_mfma_f32_16x16x32_bf16 v[208:211], v[228:231], v[128:131], v[208:211]
    v_mfma_f32_16x16x32_bf16 v[212:215], v[228:231], v[132:135], v[212:215]
    ds_read_b128 v[244:247], v5 offset:31744
    s_waitcnt lgkmcnt(3)
    v_mfma_f32_16x16x32_bf16 v[200:203], v[232:235], v[136:139], v[200:203]
    s_waitcnt vmcnt(5)
    s_add_u32 s16, s63, 0x570000
    v_mov_b32 v7, s28
    v_mov_b32 v8, 0
    s_mov_b64 exec, 1
    buffer_store_dword v7, v8, s[8:11], s16 offen sc1
    s_mov_b64 exec, -1
    v_mfma_f32_16x16x32_bf16 v[204:207], v[232:235], v[140:143], v[204:207]
    s_barrier
    ds_read_b128 v[224:227], v4 offset:32768
    s_waitcnt lgkmcnt(3)
    v_mfma_f32_16x16x32_bf16 v[208:211], v[236:239], v[136:139], v[208:211]
    v_mfma_f32_16x16x32_bf16 v[212:215], v[236:239], v[140:143], v[212:215]
    s_add_u32 s22, s21, 0x98000
    s_add_u32 m0, s20, 0x20000
    s_nop 0
    buffer_load_dwordx4 v2, s[8:11], s22 offen sc1 lds
    ds_read_b128 v[228:231], v4 offset:33792
    s_waitcnt lgkmcnt(3)
    v_mfma_f32_16x16x32_bf16 v[200:203], v[240:243], v[144:147], v[200:203]
    ds_read_b64_tr_b16 v[168:169], v11 offset:0
    ds_read_b64_tr_b16 v[170:171], v11 offset:1024
    ds_read_b64_tr_b16 v[172:173], v11 offset:8192
    ds_read_b64_tr_b16 v[174:175], v11 offset:9216
    ds_read_b64_tr_b16 v[176:177], v11 offset:16384
    ds_read_b64_tr_b16 v[178:179], v11 offset:17408
    ds_read_b64_tr_b16 v[180:181], v11 offset:24576
    ds_read_b64_tr_b16 v[182:183], v11 offset:25600
    v_mfma_f32_16x16x32_bf16 v[204:207], v[240:243], v[148:151], v[204:207]
    ds_read_b128 v[232:235], v4 offset:34816
    s_waitcnt lgkmcnt(11)
    v_mfma_f32_16x16x32_bf16 v[208:211], v[244:247], v[144:147], v[208:211]
    v_mfma_f32_16x16x32_bf16 v[212:215], v[244:247], v[148:151], v[212:215]
    ds_read_b128 v[236:239], v4 offset:35840
    s_waitcnt lgkmcnt(11)
    v_mfma_f32_16x16x32_bf16 v[184:187], v[224:227], v[24:27], 0
    v_mfma_f32_16x16x32_bf16 v[188:191], v[224:227], v[28:31], 0
    ds_read_b128 v[240:243], v4 offset:36864
    s_waitcnt lgkmcnt(11)
    v_mfma_f32_16x16x32_bf16 v[192:195], v[228:231], v[24:27], 0
    v_mfma_f32_16x16x32_bf16 v[196:199], v[228:231], v[28:31], 0
    s_add_u32 s22, s21, 0x98400
    s_add_u32 m0, s20, 0x20400
    s_nop 0
    buffer_load_dwordx4 v2, s[8:11], s22 offen sc1 lds
    ds_read_b128 v[244:247], v4 offset:37888
    v_mul_f32 v200, v200, v9
    s_waitcnt lgkmcnt(3)
    v_mfma_f32_16x16x32_bf16 v[184:187], v[232:235], v[32:35], v[184:187]
    v_mul_f32 v201, v201, v9
    v_mfma_f32_16x16x32_bf16 v[188:191], v[232:235], v[36:39], v[188:191]
    ds_read_b128 v[224:227], v4 offset:38912
    v_mul_f32 v202, v202, v9
    s_waitcnt lgkmcnt(3)
    v_mfma_f32_16x16x32_bf16 v[192:195], v[236:239], v[32:35], v[192:195]
    v_mul_f32 v203, v203, v9
    s_waitcnt vmcnt(7)
    v_mfma_f32_16x16x32_bf16 v[248:251], v[168:171], v[152:155], 0
    s_waitcnt vmcnt(6)
    v_mfma_f32_16x16x32_bf16 v[248:251], v[172:175], v[156:159], v[248:251]
    s_waitcnt vmcnt(5)
    v_mfma_f32_16x16x32_bf16 v[248:251], v[176:179], v[160:163], v[248:251]
    s_waitcnt vmcnt(4)
    v_mfma_f32_16x16x32_bf16 v[248:251], v[180:183], v[164:167], v[248:251]
    v_mfma_f32_16x16x32_bf16 v[196:199], v[236:239], v[36:39], v[196:199]
    ds_read_b128 v[228:231], v4 offset:39936
    v_mul_f32 v208, v208, v9
    s_waitcnt lgkmcnt(3)
    v_mfma_f32_16x16x32_bf16 v[184:187], v[240:243], v[40:43], v[184:187]
    v_mul_f32 v209, v209, v9
    v_mfma_f32_16x16x32_bf16 v[188:191], v[240:243], v[44:47], v[188:191]
    ds_read_b128 v[232:235], v4 offset:40960
    v_mul_f32 v210, v210, v9
    s_waitcnt lgkmcnt(3)
    v_mfma_f32_16x16x32_bf16 v[192:195], v[244:247], v[40:43], v[192:195]
    v_mul_f32 v211, v211, v9
    v_mfma_f32_16x16x32_bf16 v[196:199], v[244:247], v[44:47], v[196:199]
    ds_read_b128 v[236:239], v4 offset:41984
    v_cvt_pk_bf16_f32 v216, v200, v201
    s_waitcnt lgkmcnt(3)
    v_mfma_f32_16x16x32_bf16 v[184:187], v[224:227], v[48:51], v[184:187]
    v_cvt_pk_bf16_f32 v217, v202, v203
    v_mfma_f32_16x16x32_bf16 v[188:191], v[224:227], v[52:55], v[188:191]
    ds_read_b128 v[240:243], v4 offset:43008
    v_cvt_pk_bf16_f32 v218, v208, v209
    s_waitcnt lgkmcnt(3)
    v_mfma_f32_16x16x32_bf16 v[192:195], v[228:231], v[48:51], v[192:195]
    v_cvt_pk_bf16_f32 v219, v210, v211
    v_mfma_f32_16x16x32_bf16 v[196:199], v[228:231], v[52:55], v[196:199]
    ds_read_b128 v[244:247], v4 offset:44032
    buffer_store_dwordx4 v[216:219], v2, s[8:11], s25 offen offset:1024 sc1
    s_waitcnt lgkmcnt(3)
    v_mfma_f32_16x16x32_bf16 v[184:187], v[232:235], v[56:59], v[184:187]
    v_mul_f32 v204, v204, v10
    v_mfma_f32_16x16x32_bf16 v[188:191], v[232:235], v[60:63], v[188:191]
    ds_read_b128 v[224:227], v4 offset:45056
    v_mul_f32 v205, v205, v10
    s_waitcnt lgkmcnt(3)
    v_mfma_f32_16x16x32_bf16 v[192:195], v[236:239], v[56:59], v[192:195]
    v_mul_f32 v206, v206, v10
    v_lshrrev_b32 v20, 4, v1
    v_lshlrev_b32 v20, 4, v20
    s_lshr_b32 s16, s2, 5
    s_lshl_b32 s16, s16, 14
    s_and_b32 s17, s2, 31
    s_lshl_b32 s17, s17, 9
    s_add_u32 s16, s16, s17
    s_lshl_b32 s17, s3, 6
    s_add_u32 s16, s16, s17
    s_add_u32 s16, s16, 0x580000
    s_mov_b32 exec_lo, 0x10001
    s_mov_b32 exec_hi, 0x10001
    buffer_store_dwordx4 v[248:251], v20, s[8:11], s16 offen sc1
    s_mov_b64 exec, -1
    v_mfma_f32_16x16x32_bf16 v[196:199], v[236:239], v[60:63], v[196:199]
    ds_read_b128 v[228:231], v4 offset:46080
    v_mul_f32 v207, v207, v10
    s_waitcnt lgkmcnt(3)
    v_mfma_f32_16x16x32_bf16 v[184:187], v[240:243], v[64:67], v[184:187]
    v_mul_f32 v212, v212, v10
    v_mfma_f32_16x16x32_bf16 v[188:191], v[240:243], v[68:71], v[188:191]
    ds_read_b128 v[232:235], v4 offset:47104
    v_mul_f32 v213, v213, v10
    s_waitcnt lgkmcnt(3)
    v_mfma_f32_16x16x32_bf16 v[192:195], v[244:247], v[64:67], v[192:195]
    v_mul_f32 v214, v214, v10
    v_mfma_f32_16x16x32_bf16 v[196:199], v[244:247], v[68:71], v[196:199]
    ds_read_b128 v[236:239], v4 offset:48128
    v_mul_f32 v215, v215, v10
    s_waitcnt lgkmcnt(3)
    v_mfma_f32_16x16x32_bf16 v[184:187], v[224:227], v[72:75], v[184:187]
    v_cvt_pk_bf16_f32 v220, v204, v205
    v_mfma_f32_16x16x32_bf16 v[188:191], v[224:227], v[76:79], v[188:191]
    s_waitcnt vmcnt(5)
    s_barrier
    ds_read_b128 v[240:243], v4 offset:49152
    v_cvt_pk_bf16_f32 v221, v206, v207
    s_waitcnt lgkmcnt(3)
    v_mfma_f32_16x16x32_bf16 v[192:195], v[228:231], v[72:75], v[192:195]
    v_cvt_pk_bf16_f32 v222, v212, v213
    v_mfma_f32_16x16x32_bf16 v[196:199], v[228:231], v[76:79], v[196:199]
    s_add_u32 s22, s21, 0x9c000
    s_add_u32 m0, s20, 0x24000
    s_nop 0
    buffer_load_dwordx4 v2, s[8:11], s22 offen sc1 lds
    ds_read_b128 v[244:247], v4 offset:50176
    v_cvt_pk_bf16_f32 v223, v214, v215
    s_waitcnt lgkmcnt(3)
    v_mfma_f32_16x16x32_bf16 v[184:187], v[232:235], v[80:83], v[184:187]
    buffer_store_dwordx4 v[220:223], v2, s[8:11], s26 offen offset:1024 sc1
    v_mfma_f32_16x16x32_bf16 v[188:191], v[232:235], v[84:87], v[188:191]
    ds_read_b128 v[224:227], v4 offset:51200
    s_waitcnt lgkmcnt(3)
    v_mfma_f32_16x16x32_bf16 v[192:195], v[236:239], v[80:83], v[192:195]
    v_mfma_f32_16x16x32_bf16 v[196:199], v[236:239], v[84:87], v[196:199]
    s_add_u32 s22, s21, 0x9c400
    s_add_u32 m0, s20, 0x24400
    s_nop 0
    buffer_load_dwordx4 v2, s[8:11], s22 offen sc1 lds
    ds_read_b128 v[228:231], v4 offset:52224
    s_waitcnt lgkmcnt(3)
    v_mfma_f32_16x16x32_bf16 v[184:187], v[240:243], v[88:91], v[184:187]
    v_mfma_f32_16x16x32_bf16 v[188:191], v[240:243], v[92:95], v[188:191]
    ds_read_b128 v[232:235], v4 offset:53248
    s_waitcnt lgkmcnt(3)
    v_mfma_f32_16x16x32_bf16 v[192:195], v[244:247], v[88:91], v[192:195]
    v_mfma_f32_16x16x32_bf16 v[196:199], v[244:247], v[92:95], v[196:199]
    s_add_u32 s22, s24, 0x0
    s_add_u32 m0, s20, 0x10000
    s_nop 0
    buffer_load_dwordx4 v3, s[4:7], s22 offen lds
    ds_read_b128 v[236:239], v4 offset:54272
    s_waitcnt lgkmcnt(3)
    v_mfma_f32_16x16x32_bf16 v[184:187], v[224:227], v[96:99], v[184:187]
    v_mfma_f32_16x16x32_bf16 v[188:191], v[224:227], v[100:103], v[188:191]
    ds_read_b128 v[240:243], v4 offset:55296
    s_waitcnt lgkmcnt(3)
    v_mfma_f32_16x16x32_bf16 v[192:195], v[228:231], v[96:99], v[192:195]
    v_mfma_f32_16x16x32_bf16 v[196:199], v[228:231], v[100:103], v[196:199]
    s_add_u32 s22, s24, 0x2000
    s_add_u32 m0, s20, 0x10400
    s_nop 0
    buffer_load_dwordx4 v3, s[4:7], s22 offen lds
    ds_read_b128 v[244:247], v4 offset:56320
    s_waitcnt lgkmcnt(3)
    v_mfma_f32_16x16x32_bf16 v[184:187], v[232:235], v[104:107], v[184:187]
    v_mfma_f32_16x16x32_bf16 v[188:191], v[232:235], v[108:111], v[188:191]
    ds_read_b128 v[224:227], v4 offset:57344
    s_waitcnt lgkmcnt(3)
    v_mfma_f32_16x16x32_bf16 v[192:195], v[236:239], v[104:107], v[192:195]
    v_mfma_f32_16x16x32_bf16 v[196:199], v[236:239], v[108:111], v[196:199]
    ds_read_b128 v[228:231], v4 offset:58368
    s_waitcnt lgkmcnt(3)
    v_mfma_f32_16x16x32_bf16 v[184:187], v[240:243], v[112:115], v[184:187]
    v_mfma_f32_16x16x32_bf16 v[188:191], v[240:243], v[116:119], v[188:191]
    ds_read_b128 v[232:235], v4 offset:59392
    s_waitcnt lgkmcnt(3)
    v_mfma_f32_16x16x32_bf16 v[192:195], v[244:247], v[112:115], v[192:195]
    v_mfma_f32_16x16x32_bf16 v[196:199], v[244:247], v[116:119], v[196:199]
    ds_read_b128 v[236:239], v4 offset:60416
    s_waitcnt lgkmcnt(3)
    v_mfma_f32_16x16x32_bf16 v[184:187], v[224:227], v[120:123], v[184:187]
    v_mfma_f32_16x16x32_bf16 v[188:191], v[224:227], v[124:127], v[188:191]
    ds_read_b128 v[240:243], v4 offset:61440
    s_waitcnt lgkmcnt(3)
    v_mfma_f32_16x16x32_bf16 v[192:195], v[228:231], v[120:123], v[192:195]
    v_mfma_f32_16x16x32_bf16 v[196:199], v[228:231], v[124:127], v[196:199]
    ds_read_b128 v[244:247], v4 offset:62464
    s_waitcnt lgkmcnt(3)
    v_mfma_f32_16x16x32_bf16 v[184:187], v[232:235], v[128:131], v[184:187]
    v_mfma_f32_16x16x32_bf16 v[188:191], v[232:235], v[132:135], v[188:191]
    ds_read_b128 v[224:227], v4 offset:63488
    s_waitcnt lgkmcnt(3)
    v_mfma_f32_16x16x32_bf16 v[192:195], v[236:239], v[128:131], v[192:195]
    v_mfma_f32_16x16x32_bf16 v[196:199], v[236:239], v[132:135], v[196:199]
    ds_read_b128 v[228:231], v4 offset:64512
    s_waitcnt lgkmcnt(3)
    v_mfma_f32_16x16x32_bf16 v[184:187], v[240:243], v[136:139], v[184:187]
    v_mfma_f32_16x16x32_bf16 v[188:191], v[240:243], v[140:143], v[188:191]
    s_waitcnt vmcnt(7)
    s_barrier
    ds_read_b128 v[232:235], v5 offset:0
    s_waitcnt lgkmcnt(3)
    v_mfma_f32_16x16x32_bf16 v[192:195], v[244:247], v[136:139], v[192:195]
    v_mfma_f32_16x16x32_bf16 v[196:199], v[244:247], v[140:143], v[196:199]
    s_add_u32 s22, s24, 0x80000
    s_add_u32 m0, s20, 0x14000
    s_nop 0
    buffer_load_dwordx4 v3, s[4:7], s22 offen lds
    ds_read_b128 v[236:239], v5 offset:1024
    s_waitcnt lgkmcnt(3)
    v_mfma_f32_16x16x32_bf16 v[184:187], v[224:227], v[144:147], v[184:187]
    v_mfma_f32_16x16x32_bf16 v[188:191], v[224:227], v[148:151], v[188:191]
    ds_read_b128 v[240:243], v5 offset:2048
    s_waitcnt lgkmcnt(3)
    v_mfma_f32_16x16x32_bf16 v[192:195], v[228:231], v[144:147], v[192:195]
    v_mfma_f32_16x16x32_bf16 v[196:199], v[228:231], v[148:151], v[196:199]
    s_add_u32 s22, s24, 0x82000
    s_add_u32 m0, s20, 0x14400
    s_nop 0
    buffer_load_dwordx4 v3, s[4:7], s22 offen lds
    ds_read_b128 v[244:247], v5 offset:3072
    s_waitcnt lgkmcnt(3)
    v_mfma_f32_16x16x32_bf16 v[200:203], v[232:235], v[24:27], 0
    v_mfma_f32_16x16x32_bf16 v[204:207], v[232:235], v[28:31], 0
    ds_read_b128 v[224:227], v5 offset:4096
    s_waitcnt lgkmcnt(3)
    v_mfma_f32_16x16x32_bf16 v[208:211], v[236:239], v[24:27], 0
    v_mfma_f32_16x16x32_bf16 v[212:215], v[236:239], v[28:31], 0
    s_add_u32 s22, s24, 0x100000
    s_add_u32 m0, s20, 0x18000
    s_nop 0
    buffer_load_dwordx4 v3, s[4:7], s22 offen lds
    ds_read_b128 v[228:231], v5 offset:5120
    v_mul_f32 v184, v184, v9
    s_waitcnt lgkmcnt(3)
    v_mfma_f32_16x16x32_bf16 v[200:203], v[240:243], v[32:35], v[200:203]
    v_mul_f32 v185, v185, v9
    s_bfe_u32 s30, s2, 0x20001
    s_lshl_b32 s30, s30, 2
    s_bfe_u32 s17, s2, 0x20003
    s_add_u32 s30, s30, s17
    s_lshr_b32 s31, s2, 5
    s_and_b32 s17, s3, 3
    s_lshl_b32 s19, s30, 2
    s_add_u32 s19, s19, s17
    s_and_b32 s16, s2, 1
    s_lshl_b32 s17, s19, 18
    s_lshl_b32 s23, s16, 16
    s_add_u32 s17, s17, s23
    s_add_u32 s17, s17, 0x1000000
    v_add_u32 v6, s17, v2
    s_lshl_b32 s19, s19, 7
    s_lshl_b32 s23, s16, 6
    s_add_u32 s19, s19, s23
    s_add_u32 s19, s19, 0x570000
    v_and_b32 v13, 15, v1
    v_lshlrev_b32 v13, 2, v13
    buffer_load_dword v12, v13, s[8:11], s19 offen sc1
    v_mfma_f32_16x16x32_bf16 v[204:207], v[240:243], v[36:39], v[204:207]
    ds_read_b128 v[232:235], v5 offset:6144
    v_mul_f32 v186, v186, v9
    s_waitcnt lgkmcnt(3)
    v_mfma_f32_16x16x32_bf16 v[208:211], v[244:247], v[32:35], v[208:211]
    v_mul_f32 v187, v187, v9
    v_mfma_f32_16x16x32_bf16 v[212:215], v[244:247], v[36:39], v[212:215]
    s_add_u32 s22, s24, 0x102000
    s_add_u32 m0, s20, 0x18400
    s_nop 0
    buffer_load_dwordx4 v3, s[4:7], s22 offen lds
    ds_read_b128 v[236:239], v5 offset:7168
    v_mul_f32 v192, v192, v9
    s_waitcnt lgkmcnt(3)
    v_mfma_f32_16x16x32_bf16 v[200:203], v[224:227], v[40:43], v[200:203]
    v_mul_f32 v193, v193, v9
    v_mfma_f32_16x16x32_bf16 v[204:207], v[224:227], v[44:47], v[204:207]
    ds_read_b128 v[240:243], v5 offset:8192
    v_mul_f32 v194, v194, v9
    s_waitcnt lgkmcnt(3)
    v_mfma_f32_16x16x32_bf16 v[208:211], v[228:231], v[40:43], v[208:211]
    v_mul_f32 v195, v195, v9
    v_mfma_f32_16x16x32_bf16 v[212:215], v[228:231], v[44:47], v[212:215]
    ds_read_b128 v[244:247], v5 offset:9216
    v_cvt_pk_bf16_f32 v216, v184, v185
    s_waitcnt lgkmcnt(3)
    v_mfma_f32_16x16x32_bf16 v[200:203], v[232:235], v[48:51], v[200:203]
    v_cvt_pk_bf16_f32 v217, v186, v187
    v_mfma_f32_16x16x32_bf16 v[204:207], v[232:235], v[52:55], v[204:207]
    ds_read_b128 v[224:227], v5 offset:10240
    v_cvt_pk_bf16_f32 v218, v192, v193
    s_waitcnt lgkmcnt(3)
    v_mfma_f32_16x16x32_bf16 v[208:211], v[236:239], v[48:51], v[208:211]
    v_cvt_pk_bf16_f32 v219, v194, v195
    v_mfma_f32_16x16x32_bf16 v[212:215], v[236:239], v[52:55], v[212:215]
    ds_read_b128 v[228:231], v5 offset:11264
    buffer_store_dwordx4 v[216:219], v2, s[8:11], s25 offen offset:2048 sc1
    s_waitcnt lgkmcnt(3)
    v_mfma_f32_16x16x32_bf16 v[200:203], v[240:243], v[56:59], v[200:203]
    v_mul_f32 v188, v188, v10
    v_mfma_f32_16x16x32_bf16 v[204:207], v[240:243], v[60:63], v[204:207]
    ds_read_b128 v[232:235], v5 offset:12288
    v_mul_f32 v189, v189, v10
    s_waitcnt lgkmcnt(3)
    v_mfma_f32_16x16x32_bf16 v[208:211], v[244:247], v[56:59], v[208:211]
    v_mul_f32 v190, v190, v10
    v_mfma_f32_16x16x32_bf16 v[212:215], v[244:247], v[60:63], v[212:215]
    ds_read_b128 v[236:239], v5 offset:13312
    v_mul_f32 v191, v191, v10
    s_waitcnt lgkmcnt(3)
    v_mfma_f32_16x16x32_bf16 v[200:203], v[224:227], v[64:67], v[200:203]
    v_mul_f32 v196, v196, v10
    s_waitcnt vmcnt(11)
    v_mfma_f32_16x16x32_bf16 v[204:207], v[224:227], v[68:71], v[204:207]
    ds_read_b128 v[240:243], v5 offset:14336
    v_mul_f32 v197, v197, v10
    s_waitcnt lgkmcnt(3)
    v_mfma_f32_16x16x32_bf16 v[208:211], v[228:231], v[64:67], v[208:211]
    v_mul_f32 v198, v198, v10
    v_mfma_f32_16x16x32_bf16 v[212:215], v[228:231], v[68:71], v[212:215]
    ds_read_b128 v[244:247], v5 offset:15360
    v_mul_f32 v199, v199, v10
    s_waitcnt lgkmcnt(3)
    v_mfma_f32_16x16x32_bf16 v[200:203], v[232:235], v[72:75], v[200:203]
    v_cvt_pk_bf16_f32 v220, v188, v189
    v_mfma_f32_16x16x32_bf16 v[204:207], v[232:235], v[76:79], v[204:207]
    s_waitcnt vmcnt(8)
    s_barrier
    ds_read_b128 v[224:227], v5 offset:16384
    v_cvt_pk_bf16_f32 v221, v190, v191
    s_waitcnt lgkmcnt(3)
    v_mfma_f32_16x16x32_bf16 v[208:211], v[236:239], v[72:75], v[208:211]
    v_cvt_pk_bf16_f32 v222, v196, v197
    v_mfma_f32_16x16x32_bf16 v[212:215], v[236:239], v[76:79], v[212:215]
    s_add_u32 s22, s24, 0x180000
    s_add_u32 m0, s20, 0x1c000
    s_nop 0
    buffer_load_dwordx4 v3, s[4:7], s22 offen lds
    ds_read_b128 v[228:231], v5 offset:17408
    v_cvt_pk_bf16_f32 v223, v198, v199
    v_mov_b32 v20, s28
    v_mov_b32 v21, 0
    s_lshl_b32 s16, s2, 2
    s_add_u32 s16, s16, 0x560000
    s_cmp_eq_u32 s3, 0
    s_cselect_b32 s16, s16, 0x7ffffff0
    s_mov_b64 exec, 1
    buffer_store_dword v20, v21, s[8:11], s16 offen sc1
    s_mov_b64 exec, -1
    s_waitcnt lgkmcnt(3)
    v_mfma_f32_16x16x32_bf16 v[200:203], v[240:243], v[80:83], v[200:203]
    buffer_store_dwordx4 v[220:223], v2, s[8:11], s26 offen offset:2048 sc1
    s_add_u32 s16, s63, 0x572000
    v_mov_b32 v14, s28
    v_mov_b32 v15, 0
    s_mov_b64 exec, 1
    buffer_store_dword v14, v15, s[8:11], s16 offen sc1
    s_mov_b64 exec, -1
    v_mfma_f32_16x16x32_bf16 v[204:207], v[240:243], v[84:87], v[204:207]
    ds_read_b128 v[232:235], v5 offset:18432
    s_waitcnt lgkmcnt(3)
    v_mfma_f32_16x16x32_bf16 v[208:211], v[244:247], v[80:83], v[208:211]
    v_mfma_f32_16x16x32_bf16 v[212:215], v[244:247], v[84:87], v[212:215]
    ds_read_b128 v[236:239], v5 offset:19456
    s_waitcnt lgkmcnt(3)
    v_mfma_f32_16x16x32_bf16 v[200:203], v[224:227], v[88:91], v[200:203]
    v_mfma_f32_16x16x32_bf16 v[204:207], v[224:227], v[92:95], v[204:207]
    ds_read_b128 v[240:243], v5 offset:20480
    s_waitcnt vmcnt(6)
    v_cmp_ne_u32 vcc, s28, v12
    s_cbranch_vccnz adaLN_cond__sliding_block_cached__moe_arch_mod__prompt_kernel_o5r
adaLN_cond__sliding_block_cached__moe_arch_mod__prompt_kernel_o5b:
    s_waitcnt lgkmcnt(3)
    v_mfma_f32_16x16x32_bf16 v[208:211], v[228:231], v[88:91], v[208:211]
    s_mov_b32 s23, 0x0
    buffer_load_dwordx4 v[24:27], v6, s[8:11], s23 offen offset:0 sc1
    v_mfma_f32_16x16x32_bf16 v[212:215], v[228:231], v[92:95], v[212:215]
    s_add_u32 s22, s24, 0x182000
    s_add_u32 m0, s20, 0x1c400
    s_nop 0
    buffer_load_dwordx4 v3, s[4:7], s22 offen lds
    ds_read_b128 v[244:247], v5 offset:21504
    s_waitcnt lgkmcnt(3)
    v_mfma_f32_16x16x32_bf16 v[200:203], v[232:235], v[96:99], v[200:203]
    v_mfma_f32_16x16x32_bf16 v[204:207], v[232:235], v[100:103], v[204:207]
    ds_read_b128 v[224:227], v5 offset:22528
    s_mov_b32 s23, 0x20000
    buffer_load_dwordx4 v[28:31], v6, s[8:11], s23 offen offset:0 sc1
    s_waitcnt lgkmcnt(3)
    v_mfma_f32_16x16x32_bf16 v[208:211], v[236:239], v[96:99], v[208:211]
    v_mfma_f32_16x16x32_bf16 v[212:215], v[236:239], v[100:103], v[212:215]
    ds_read_b128 v[228:231], v5 offset:23552
    s_waitcnt lgkmcnt(3)
    v_mfma_f32_16x16x32_bf16 v[200:203], v[240:243], v[104:107], v[200:203]
    v_mfma_f32_16x16x32_bf16 v[204:207], v[240:243], v[108:111], v[204:207]
    ds_read_b128 v[232:235], v5 offset:24576
    s_mov_b32 s23, 0x2000
    buffer_load_dwordx4 v[32:35], v6, s[8:11], s23 offen offset:0 sc1
    s_waitcnt lgkmcnt(3)
    v_mfma_f32_16x16x32_bf16 v[208:211], v[244:247], v[104:107], v[208:211]
    v_mfma_f32_16x16x32_bf16 v[212:215], v[244:247], v[108:111], v[212:215]
    ds_read_b128 v[236:239], v5 offset:25600
    s_waitcnt lgkmcnt(3)
    v_mfma_f32_16x16x32_bf16 v[200:203], v[224:227], v[112:115], v[200:203]
    s_mov_b32 s23, 0x22000
    buffer_load_dwordx4 v[36:39], v6, s[8:11], s23 offen offset:0 sc1
    v_mfma_f32_16x16x32_bf16 v[204:207], v[224:227], v[116:119], v[204:207]
    ds_read_b128 v[240:243], v5 offset:26624
    s_waitcnt lgkmcnt(3)
    v_mfma_f32_16x16x32_bf16 v[208:211], v[228:231], v[112:115], v[208:211]
    v_mfma_f32_16x16x32_bf16 v[212:215], v[228:231], v[116:119], v[212:215]
    ds_read_b128 v[244:247], v5 offset:27648
    s_waitcnt lgkmcnt(3)
    v_mfma_f32_16x16x32_bf16 v[200:203], v[232:235], v[120:123], v[200:203]
    s_mov_b32 s23, 0x4000
    buffer_load_dwordx4 v[40:43], v6, s[8:11], s23 offen offset:0 sc1
    v_mfma_f32_16x16x32_bf16 v[204:207], v[232:235], v[124:127], v[204:207]
    ds_read_b128 v[224:227], v5 offset:28672
    s_waitcnt lgkmcnt(3)
    v_mfma_f32_16x16x32_bf16 v[208:211], v[236:239], v[120:123], v[208:211]
    v_mfma_f32_16x16x32_bf16 v[212:215], v[236:239], v[124:127], v[212:215]
    ds_read_b128 v[228:231], v5 offset:29696
    s_waitcnt lgkmcnt(3)
    v_mfma_f32_16x16x32_bf16 v[200:203], v[240:243], v[128:131], v[200:203]
    s_mov_b32 s23, 0x24000
    buffer_load_dwordx4 v[44:47], v6, s[8:11], s23 offen offset:0 sc1
    v_mfma_f32_16x16x32_bf16 v[204:207], v[240:243], v[132:135], v[204:207]
    ds_read_b128 v[232:235], v5 offset:30720
    s_waitcnt lgkmcnt(3)
    v_mfma_f32_16x16x32_bf16 v[208:211], v[244:247], v[128:131], v[208:211]
    v_mfma_f32_16x16x32_bf16 v[212:215], v[244:247], v[132:135], v[212:215]
    ds_read_b128 v[236:239], v5 offset:31744
    s_mov_b32 s23, 0x6000
    buffer_load_dwordx4 v[48:51], v6, s[8:11], s23 offen offset:0 sc1
    s_waitcnt lgkmcnt(3)
    v_mfma_f32_16x16x32_bf16 v[200:203], v[224:227], v[136:139], v[200:203]
    v_bfe_u32 v18, v1, 2, 2
    v_lshrrev_b32 v19, 4, v1
    v_mfma_f32_16x16x32_bf16 v[204:207], v[224:227], v[140:143], v[204:207]
    v_and_b32 v17, 3, v1
    v_lshlrev_b32 v16, 11, v19
    s_waitcnt lgkmcnt(2)
    v_mfma_f32_16x16x32_bf16 v[208:211], v[228:231], v[136:139], v[208:211]
    v_lshl_add_u32 v16, v18, 6, v16
    v_lshl_add_u32 v16, v17, 3, v16
    v_mfma_f32_16x16x32_bf16 v[212:215], v[228:231], v[140:143], v[212:215]
    s_mov_b32 s23, 0x26000
    buffer_load_dwordx4 v[52:55], v6, s[8:11], s23 offen offset:0 sc1
    v_add_u32 v16, 0x10000, v16
    v_and_b32 v19, 1, v19
    s_waitcnt lgkmcnt(1)
    v_mfma_f32_16x16x32_bf16 v[200:203], v[232:235], v[144:147], v[200:203]
    v_lshlrev_b32 v19, 5, v19
    v_sub_u32 v5, v16, v19
    v_mfma_f32_16x16x32_bf16 v[204:207], v[232:235], v[148:151], v[204:207]
    v_add_u32 v4, v16, v19
    v_add_u32 v7, 0x10000, v4
    s_waitcnt lgkmcnt(0)
    v_mfma_f32_16x16x32_bf16 v[208:211], v[236:239], v[144:147], v[208:211]
    v_add_u32 v8, 0x10000, v5
    v_mfma_f32_16x16x32_bf16 v[212:215], v[236:239], v[148:151], v[212:215]
    v_mul_f32 v200, v200, v9
    v_mul_f32 v201, v201, v9
    v_mul_f32 v202, v202, v9
    v_mul_f32 v203, v203, v9
    s_nop 1
    v_mul_f32 v208, v208, v9
    v_mul_f32 v209, v209, v9
    v_mul_f32 v210, v210, v9
    v_mul_f32 v211, v211, v9
    v_cvt_pk_bf16_f32 v216, v200, v201
    v_cvt_pk_bf16_f32 v217, v202, v203
    v_cvt_pk_bf16_f32 v218, v208, v209
    v_cvt_pk_bf16_f32 v219, v210, v211
    buffer_store_dwordx4 v[216:219], v2, s[8:11], s25 offen offset:3072 sc1
    v_mul_f32 v204, v204, v10
    v_mul_f32 v205, v205, v10
    v_mul_f32 v206, v206, v10
    v_mul_f32 v207, v207, v10
    v_mul_f32 v212, v212, v10
    v_mul_f32 v213, v213, v10
    v_mul_f32 v214, v214, v10
    v_mul_f32 v215, v215, v10
    v_cvt_pk_bf16_f32 v220, v204, v205
    v_cvt_pk_bf16_f32 v221, v206, v207
    v_cvt_pk_bf16_f32 v222, v212, v213
    v_cvt_pk_bf16_f32 v223, v214, v215
    buffer_store_dwordx4 v[220:223], v2, s[8:11], s26 offen offset:3072 sc1
    s_and_b32 s15, s2, 1
    s_barrier
    ds_read_b64_tr_b16 v[224:225], v4 offset:0
    ds_read_b64_tr_b16 v[226:227], v4 offset:1024
    ds_read_b64_tr_b16 v[228:229], v5 offset:32
    ds_read_b64_tr_b16 v[230:231], v5 offset:1056
    ds_read_b64_tr_b16 v[232:233], v4 offset:256
    ds_read_b64_tr_b16 v[234:235], v4 offset:1280
    ds_read_b64_tr_b16 v[236:237], v5 offset:288
    ds_read_b64_tr_b16 v[238:239], v5 offset:1312
    s_waitcnt vmcnt(10) lgkmcnt(6)
    v_mfma_f32_16x16x32_bf16 v[88:91], v[224:227], v[24:27], 0
    ds_read_b64_tr_b16 v[240:241], v4 offset:512
    s_waitcnt vmcnt(8)
    v_mfma_f32_16x16x32_bf16 v[92:95], v[224:227], v[28:31], 0
    s_add_u32 s22, s24, 0x200000
    s_add_u32 m0, s20, 0x20000
    s_nop 0
    buffer_load_dwordx4 v3, s[4:7], s22 offen lds
    ds_read_b64_tr_b16 v[242:243], v4 offset:1536
    s_waitcnt lgkmcnt(6)
    v_mfma_f32_16x16x32_bf16 v[96:99], v[228:231], v[24:27], 0
    ds_read_b64_tr_b16 v[244:245], v5 offset:544
    s_mov_b32 s23, 0x8000
    buffer_load_dwordx4 v[56:59], v6, s[8:11], s23 offen offset:0 sc1
    v_mfma_f32_16x16x32_bf16 v[100:103], v[228:231], v[28:31], 0
    ds_read_b64_tr_b16 v[246:247], v5 offset:1568
    s_waitcnt lgkmcnt(6)
    v_mfma_f32_16x16x32_bf16 v[104:107], v[232:235], v[24:27], 0
    s_add_u32 s22, s24, 0x202000
    s_add_u32 m0, s20, 0x20400
    s_nop 0
    buffer_load_dwordx4 v3, s[4:7], s22 offen lds
    ds_read_b64_tr_b16 v[224:225], v4 offset:768
    v_mfma_f32_16x16x32_bf16 v[108:111], v[232:235], v[28:31], 0
    ds_read_b64_tr_b16 v[226:227], v4 offset:1792
    s_mov_b32 s23, 0x28000
    buffer_load_dwordx4 v[60:63], v6, s[8:11], s23 offen offset:0 sc1
    s_waitcnt lgkmcnt(6)
    v_mfma_f32_16x16x32_bf16 v[112:115], v[236:239], v[24:27], 0
    ds_read_b64_tr_b16 v[228:229], v5 offset:800
    v_mfma_f32_16x16x32_bf16 v[116:119], v[236:239], v[28:31], 0
    ds_read_b64_tr_b16 v[230:231], v5 offset:1824
    s_waitcnt lgkmcnt(6)
    v_mfma_f32_16x16x32_bf16 v[120:123], v[240:243], v[24:27], 0
    v_mfma_f32_16x16x32_bf16 v[124:127], v[240:243], v[28:31], 0
    s_barrier
    ds_read_b64_tr_b16 v[232:233], v4 offset:16384
    ds_read_b64_tr_b16 v[234:235], v4 offset:17408
    s_waitcnt lgkmcnt(6)
    v_mfma_f32_16x16x32_bf16 v[128:131], v[244:247], v[24:27], 0
    s_add_u32 s22, s24, 0x280000
    s_add_u32 m0, s20, 0x24000
    s_nop 0
    buffer_load_dwordx4 v3, s[4:7], s22 offen lds
    ds_read_b64_tr_b16 v[236:237], v5 offset:16416
    v_mfma_f32_16x16x32_bf16 v[132:135], v[244:247], v[28:31], 0
    ds_read_b64_tr_b16 v[238:239], v5 offset:17440
    s_waitcnt lgkmcnt(6)
    v_mfma_f32_16x16x32_bf16 v[136:139], v[224:227], v[24:27], 0
    ds_read_b64_tr_b16 v[240:241], v4 offset:16640
    v_mfma_f32_16x16x32_bf16 v[140:143], v[224:227], v[28:31], 0
    s_add_u32 s22, s24, 0x282000
    s_add_u32 m0, s20, 0x24400
    s_nop 0
    buffer_load_dwordx4 v3, s[4:7], s22 offen lds
    ds_read_b64_tr_b16 v[242:243], v4 offset:17664
    s_waitcnt lgkmcnt(6)
    v_mfma_f32_16x16x32_bf16 v[144:147], v[228:231], v[24:27], 0
    ds_read_b64_tr_b16 v[244:245], v5 offset:16672
    v_mfma_f32_16x16x32_bf16 v[148:151], v[228:231], v[28:31], 0
    ds_read_b64_tr_b16 v[246:247], v5 offset:17696
    s_waitcnt vmcnt(13) lgkmcnt(6)
    v_mfma_f32_16x16x32_bf16 v[88:91], v[232:235], v[32:35], v[88:91]
    ds_read_b64_tr_b16 v[224:225], v4 offset:16896
    s_waitcnt vmcnt(12)
    v_mfma_f32_16x16x32_bf16 v[92:95], v[232:235], v[36:39], v[92:95]
    ds_read_b64_tr_b16 v[226:227], v4 offset:17920
    s_waitcnt lgkmcnt(6)
    v_mfma_f32_16x16x32_bf16 v[96:99], v[236:239], v[32:35], v[96:99]
    ds_read_b64_tr_b16 v[228:229], v5 offset:16928
    s_mov_b32 s23, 0xa000
    buffer_load_dwordx4 v[24:27], v6, s[8:11], s23 offen offset:0 sc1
    v_mfma_f32_16x16x32_bf16 v[100:103], v[236:239], v[36:39], v[100:103]
    ds_read_b64_tr_b16 v[230:231], v5 offset:17952
    s_waitcnt lgkmcnt(6)
    v_mfma_f32_16x16x32_bf16 v[104:107], v[240:243], v[32:35], v[104:107]
    v_and_b32 v250, 7, v1
    v_lshlrev_b32 v250, 7, v250
    s_lshr_b32 s14, s2, 3
    s_lshl_b32 s14, s14, 2
    s_add_u32 s14, s14, 0x560000
    buffer_load_dword v248, v250, s[8:11], s14 offen sc1
    ds_read_b64_tr_b16 v[232:233], v4 offset:17152
    v_mfma_f32_16x16x32_bf16 v[108:111], v[240:243], v[36:39], v[108:111]
    ds_read_b64_tr_b16 v[234:235], v4 offset:18176
    s_mov_b32 s23, 0x2a000
    buffer_load_dwordx4 v[28:31], v6, s[8:11], s23 offen offset:0 sc1
    s_waitcnt lgkmcnt(6)
    v_mfma_f32_16x16x32_bf16 v[112:115], v[244:247], v[32:35], v[112:115]
    ds_read_b64_tr_b16 v[236:237], v5 offset:17184
    v_mfma_f32_16x16x32_bf16 v[116:119], v[244:247], v[36:39], v[116:119]
    ds_read_b64_tr_b16 v[238:239], v5 offset:18208
    s_waitcnt lgkmcnt(6)
    v_mfma_f32_16x16x32_bf16 v[120:123], v[224:227], v[32:35], v[120:123]
    v_mfma_f32_16x16x32_bf16 v[124:127], v[224:227], v[36:39], v[124:127]
    s_barrier
    ds_read_b64_tr_b16 v[240:241], v4 offset:32768
    ds_read_b64_tr_b16 v[242:243], v4 offset:33792
    s_waitcnt lgkmcnt(6)
    v_mfma_f32_16x16x32_bf16 v[128:131], v[228:231], v[32:35], v[128:131]
    s_add_u32 s22, s24, 0x300000
    s_add_u32 m0, s20, 0x10000
    s_nop 0
    buffer_load_dwordx4 v3, s[4:7], s22 offen lds
    ds_read_b64_tr_b16 v[244:245], v5 offset:32800
    v_mfma_f32_16x16x32_bf16 v[132:135], v[228:231], v[36:39], v[132:135]
    ds_read_b64_tr_b16 v[246:247], v5 offset:33824
    s_waitcnt lgkmcnt(6)
    v_mfma_f32_16x16x32_bf16 v[136:139], v[232:235], v[32:35], v[136:139]
    ds_read_b64_tr_b16 v[224:225], v4 offset:33024
    v_mfma_f32_16x16x32_bf16 v[140:143], v[232:235], v[36:39], v[140:143]
    s_add_u32 s22, s24, 0x302000
    s_add_u32 m0, s20, 0x10400
    s_nop 0
    buffer_load_dwordx4 v3, s[4:7], s22 offen lds
    ds_read_b64_tr_b16 v[226:227], v4 offset:34048
    s_waitcnt lgkmcnt(6)
    v_mfma_f32_16x16x32_bf16 v[144:147], v[236:239], v[32:35], v[144:147]
    s_add_u32 s16, s63, 0x574000
    v_mov_b32 v14, s28
    v_mov_b32 v15, 0
    s_mov_b64 exec, 1
    buffer_store_dword v14, v15, s[8:11], s16 offen sc1
    s_mov_b64 exec, -1
    ds_read_b64_tr_b16 v[228:229], v5 offset:33056
    v_mfma_f32_16x16x32_bf16 v[148:151], v[236:239], v[36:39], v[148:151]
    ds_read_b64_tr_b16 v[230:231], v5 offset:34080
    s_waitcnt vmcnt(17) lgkmcnt(6)
    v_mfma_f32_16x16x32_bf16 v[88:91], v[240:243], v[40:43], v[88:91]
    ds_read_b64_tr_b16 v[232:233], v4 offset:33280
    s_waitcnt vmcnt(16)
    v_mfma_f32_16x16x32_bf16 v[92:95], v[240:243], v[44:47], v[92:95]
    ds_read_b64_tr_b16 v[234:235], v4 offset:34304
    s_waitcnt lgkmcnt(6)
    v_mfma_f32_16x16x32_bf16 v[96:99], v[244:247], v[40:43], v[96:99]
    ds_read_b64_tr_b16 v[236:237], v5 offset:33312
    s_mov_b32 s23, 0xc000
    buffer_load_dwordx4 v[32:35], v6, s[8:11], s23 offen offset:0 sc1
    v_mfma_f32_16x16x32_bf16 v[100:103], v[244:247], v[44:47], v[100:103]
    ds_read_b64_tr_b16 v[238:239], v5 offset:34336
    s_waitcnt lgkmcnt(6)
    v_mfma_f32_16x16x32_bf16 v[104:107], v[224:227], v[40:43], v[104:107]
    ds_read_b64_tr_b16 v[240:241], v4 offset:33536
    v_mfma_f32_16x16x32_bf16 v[108:111], v[224:227], v[44:47], v[108:111]
    ds_read_b64_tr_b16 v[242:243], v4 offset:34560
    s_mov_b32 s23, 0x2c000
    buffer_load_dwordx4 v[36:39], v6, s[8:11], s23 offen offset:0 sc1
    s_waitcnt lgkmcnt(6)
    v_mfma_f32_16x16x32_bf16 v[112:115], v[228:231], v[40:43], v[112:115]
    ds_read_b64_tr_b16 v[244:245], v5 offset:33568
    v_mfma_f32_16x16x32_bf16 v[116:119], v[228:231], v[44:47], v[116:119]
    ds_read_b64_tr_b16 v[246:247], v5 offset:34592
    s_waitcnt lgkmcnt(6)
    v_mfma_f32_16x16x32_bf16 v[120:123], v[232:235], v[40:43], v[120:123]
    v_mfma_f32_16x16x32_bf16 v[124:127], v[232:235], v[44:47], v[124:127]
    s_barrier
    ds_read_b64_tr_b16 v[224:225], v4 offset:49152
    ds_read_b64_tr_b16 v[226:227], v4 offset:50176
    s_add_u32 s19, s19, 8192
    buffer_load_dword v12, v13, s[8:11], s19 offen sc1
    s_waitcnt lgkmcnt(6)
    v_mfma_f32_16x16x32_bf16 v[128:131], v[236:239], v[40:43], v[128:131]
    s_add_u32 s22, s24, 0x380000
    s_add_u32 m0, s20, 0x14000
    s_nop 0
    buffer_load_dwordx4 v3, s[4:7], s22 offen lds
    ds_read_b64_tr_b16 v[228:229], v5 offset:49184
    v_mfma_f32_16x16x32_bf16 v[132:135], v[236:239], v[44:47], v[132:135]
    ds_read_b64_tr_b16 v[230:231], v5 offset:50208
    s_waitcnt lgkmcnt(6)
    v_mfma_f32_16x16x32_bf16 v[136:139], v[240:243], v[40:43], v[136:139]
    ds_read_b64_tr_b16 v[232:233], v4 offset:49408
    v_mfma_f32_16x16x32_bf16 v[140:143], v[240:243], v[44:47], v[140:143]
    s_add_u32 s22, s24, 0x382000
    s_add_u32 m0, s20, 0x14400
    s_nop 0
    buffer_load_dwordx4 v3, s[4:7], s22 offen lds
    ds_read_b64_tr_b16 v[234:235], v4 offset:50432
    s_waitcnt lgkmcnt(6)
    v_mfma_f32_16x16x32_bf16 v[144:147], v[244:247], v[40:43], v[144:147]
    ds_read_b64_tr_b16 v[236:237], v5 offset:49440
    v_mfma_f32_16x16x32_bf16 v[148:151], v[244:247], v[44:47], v[148:151]
    ds_read_b64_tr_b16 v[238:239], v5 offset:50464
    s_waitcnt vmcnt(20) lgkmcnt(6)
    v_mfma_f32_16x16x32_bf16 v[88:91], v[224:227], v[48:51], v[88:91]
    ds_read_b64_tr_b16 v[240:241], v4 offset:49664
    s_waitcnt vmcnt(19)
    v_mfma_f32_16x16x32_bf16 v[92:95], v[224:227], v[52:55], v[92:95]
    ds_read_b64_tr_b16 v[242:243], v4 offset:50688
    s_waitcnt lgkmcnt(6)
    v_mfma_f32_16x16x32_bf16 v[96:99], v[228:231], v[48:51], v[96:99]
    ds_read_b64_tr_b16 v[244:245], v5 offset:49696
    s_mov_b32 s23, 0xe000
    buffer_load_dwordx4 v[40:43], v6, s[8:11], s23 offen offset:0 sc1
    v_mfma_f32_16x16x32_bf16 v[100:103], v[228:231], v[52:55], v[100:103]
    ds_read_b64_tr_b16 v[246:247], v5 offset:50720
    s_waitcnt lgkmcnt(6)
    v_mfma_f32_16x16x32_bf16 v[104:107], v[232:235], v[48:51], v[104:107]
    ds_read_b64_tr_b16 v[224:225], v4 offset:49920
    v_mfma_f32_16x16x32_bf16 v[108:111], v[232:235], v[52:55], v[108:111]
    ds_read_b64_tr_b16 v[226:227], v4 offset:50944
    s_mov_b32 s23, 0x2e000
    buffer_load_dwordx4 v[44:47], v6, s[8:11], s23 offen offset:0 sc1
    s_waitcnt lgkmcnt(6)
    v_mfma_f32_16x16x32_bf16 v[112:115], v[236:239], v[48:51], v[112:115]
    ds_read_b64_tr_b16 v[228:229], v5 offset:49952
    v_mfma_f32_16x16x32_bf16 v[116:119], v[236:239], v[52:55], v[116:119]
    ds_read_b64_tr_b16 v[230:231], v5 offset:50976
    s_waitcnt lgkmcnt(6)
    v_mfma_f32_16x16x32_bf16 v[120:123], v[240:243], v[48:51], v[120:123]
    v_mfma_f32_16x16x32_bf16 v[124:127], v[240:243], v[52:55], v[124:127]
    s_waitcnt vmcnt(16)
    s_barrier
    ds_read_b64_tr_b16 v[232:233], v7 offset:0
    ds_read_b64_tr_b16 v[234:235], v7 offset:1024
    s_waitcnt lgkmcnt(6)
    v_mfma_f32_16x16x32_bf16 v[128:131], v[244:247], v[48:51], v[128:131]
    s_add_u32 s22, s24, 0x10000
    s_add_u32 m0, s20, 0x18000
    s_nop 0
    buffer_load_dwordx4 v3, s[4:7], s22 offen lds
    ds_read_b64_tr_b16 v[236:237], v8 offset:32
    v_mfma_f32_16x16x32_bf16 v[132:135], v[244:247], v[52:55], v[132:135]
    ds_read_b64_tr_b16 v[238:239], v8 offset:1056
    s_waitcnt lgkmcnt(6)
    v_mfma_f32_16x16x32_bf16 v[136:139], v[224:227], v[48:51], v[136:139]
    s_waitcnt vmcnt(12)
    v_cmp_ne_u32 vcc, s28, v248
    s_cbranch_vccnz adaLN_cond__sliding_block_cached__moe_arch_mod__prompt_kernel_mp6r
adaLN_cond__sliding_block_cached__moe_arch_mod__prompt_kernel_mp6b:
    ds_read_b64_tr_b16 v[240:241], v7 offset:256
    v_mfma_f32_16x16x32_bf16 v[140:143], v[224:227], v[52:55], v[140:143]
    v_lshrrev_b32 v250, 4, v1
    v_lshlrev_b32 v250, 14, v250
    v_and_b32 v253, 15, v1
    v_lshl_add_u32 v250, v253, 2, v250
    s_lshl_b32 s14, s2, 6
    s_add_u32 s14, s14, 0x580000
    buffer_load_dword v249, v250, s[8:11], s14 offen sc1
    s_add_u32 s14, s14, 0x10000
    buffer_load_dword v254, v250, s[8:11], s14 offen sc1
    s_add_u32 s22, s24, 0x12000
    s_add_u32 m0, s20, 0x18400
    s_nop 0
    buffer_load_dwordx4 v3, s[4:7], s22 offen lds
    ds_read_b64_tr_b16 v[242:243], v7 offset:1280
    s_waitcnt lgkmcnt(6)
    v_mfma_f32_16x16x32_bf16 v[144:147], v[228:231], v[48:51], v[144:147]
    ds_read_b64_tr_b16 v[244:245], v8 offset:288
    v_mfma_f32_16x16x32_bf16 v[148:151], v[228:231], v[52:55], v[148:151]
    ds_read_b64_tr_b16 v[246:247], v8 offset:1312
    s_waitcnt vmcnt(8)
    v_cmp_ne_u32 vcc, s28, v12
    s_cbranch_vccnz adaLN_cond__sliding_block_cached__moe_arch_mod__prompt_kernel_o27r
adaLN_cond__sliding_block_cached__moe_arch_mod__prompt_kernel_o27b:
    s_waitcnt lgkmcnt(6)
    v_mfma_f32_16x16x32_bf16 v[88:91], v[232:235], v[56:59], v[88:91]
    ds_read_b64_tr_b16 v[224:225], v7 offset:512
    v_mfma_f32_16x16x32_bf16 v[92:95], v[232:235], v[60:63], v[92:95]
    ds_read_b64_tr_b16 v[226:227], v7 offset:1536
    s_waitcnt lgkmcnt(6)
    v_mfma_f32_16x16x32_bf16 v[96:99], v[236:239], v[56:59], v[96:99]
    ds_read_b64_tr_b16 v[228:229], v8 offset:544
    s_mov_b32 s23, 0x0
    buffer_load_dwordx4 v[48:51], v6, s[8:11], s23 offen offset:1024 sc1
    v_mfma_f32_16x16x32_bf16 v[100:103], v[236:239], v[60:63], v[100:103]
    ds_read_b64_tr_b16 v[230:231], v8 offset:1568
    s_waitcnt lgkmcnt(6)
    v_mfma_f32_16x16x32_bf16 v[104:107], v[240:243], v[56:59], v[104:107]
    ds_read_b64_tr_b16 v[232:233], v7 offset:768
    v_mfma_f32_16x16x32_bf16 v[108:111], v[240:243], v[60:63], v[108:111]
    ds_read_b64_tr_b16 v[234:235], v7 offset:1792
    s_mov_b32 s23, 0x20000
    buffer_load_dwordx4 v[52:55], v6, s[8:11], s23 offen offset:1024 sc1
    s_waitcnt lgkmcnt(6)
    v_mfma_f32_16x16x32_bf16 v[112:115], v[244:247], v[56:59], v[112:115]
    ds_read_b64_tr_b16 v[236:237], v8 offset:800
    v_mfma_f32_16x16x32_bf16 v[116:119], v[244:247], v[60:63], v[116:119]
    ds_read_b64_tr_b16 v[238:239], v8 offset:1824
    s_waitcnt lgkmcnt(6)
    v_mfma_f32_16x16x32_bf16 v[120:123], v[224:227], v[56:59], v[120:123]
    v_mfma_f32_16x16x32_bf16 v[124:127], v[224:227], v[60:63], v[124:127]
    s_barrier
    ds_read_b64_tr_b16 v[240:241], v7 offset:16384
    ds_read_b64_tr_b16 v[242:243], v7 offset:17408
    s_waitcnt lgkmcnt(6)
    v_mfma_f32_16x16x32_bf16 v[128:131], v[228:231], v[56:59], v[128:131]
    s_add_u32 s22, s24, 0x90000
    s_add_u32 m0, s20, 0x1c000
    s_nop 0
    buffer_load_dwordx4 v3, s[4:7], s22 offen lds
    ds_read_b64_tr_b16 v[244:245], v8 offset:16416
    v_mfma_f32_16x16x32_bf16 v[132:135], v[228:231], v[60:63], v[132:135]
    ds_read_b64_tr_b16 v[246:247], v8 offset:17440
    s_waitcnt lgkmcnt(6)
    v_mfma_f32_16x16x32_bf16 v[136:139], v[232:235], v[56:59], v[136:139]
    ds_read_b64_tr_b16 v[224:225], v7 offset:16640
    v_mfma_f32_16x16x32_bf16 v[140:143], v[232:235], v[60:63], v[140:143]
    s_add_u32 s22, s24, 0x92000
    s_add_u32 m0, s20, 0x1c400
    s_nop 0
    buffer_load_dwordx4 v3, s[4:7], s22 offen lds
    ds_read_b64_tr_b16 v[226:227], v7 offset:17664
    s_waitcnt lgkmcnt(6)
    v_mfma_f32_16x16x32_bf16 v[144:147], v[236:239], v[56:59], v[144:147]
    ds_read_b64_tr_b16 v[228:229], v8 offset:16672
    v_mfma_f32_16x16x32_bf16 v[148:151], v[236:239], v[60:63], v[148:151]
    ds_read_b64_tr_b16 v[230:231], v8 offset:17696
    s_waitcnt lgkmcnt(6)
    v_mfma_f32_16x16x32_bf16 v[88:91], v[240:243], v[24:27], v[88:91]
    ds_read_b64_tr_b16 v[232:233], v7 offset:16896
    v_mfma_f32_16x16x32_bf16 v[92:95], v[240:243], v[28:31], v[92:95]
    ds_read_b64_tr_b16 v[234:235], v7 offset:17920
    s_waitcnt lgkmcnt(6)
    v_mfma_f32_16x16x32_bf16 v[96:99], v[244:247], v[24:27], v[96:99]
    ds_read_b64_tr_b16 v[236:237], v8 offset:16928
    s_mov_b32 s23, 0x2000
    buffer_load_dwordx4 v[56:59], v6, s[8:11], s23 offen offset:1024 sc1
    v_mfma_f32_16x16x32_bf16 v[100:103], v[244:247], v[28:31], v[100:103]
    ds_read_b64_tr_b16 v[238:239], v8 offset:17952
    s_waitcnt lgkmcnt(6)
    v_mfma_f32_16x16x32_bf16 v[104:107], v[224:227], v[24:27], v[104:107]
    s_waitcnt vmcnt(6)
    v_add_f32 v249, v249, v254
    v_mov_b32 v250, v249
    s_nop 1
    v_permlane16_swap_b32 v249, v250
    v_add_f32 v249, v249, v250
    v_mov_b32 v250, v249
    s_nop 1
    v_permlane32_swap_b32 v249, v250
    v_add_f32 v249, v249, v250
    v_cvt_pk_bf16_f32 v249, v249, v249
    v_lshlrev_b32 v249, 16, v249
    s_lshr_b32 s14, s2, 6
    s_cmp_eq_u32 s14, 2
    s_cselect_b32 s14, 1.0, 0
    v_add_f32 v249, s14, v249
    v_cvt_pk_bf16_f32 v249, v249, v249
    v_lshlrev_b32 v253, 1, v253
    s_lshl_b32 s14, s2, 5
    s_add_u32 s14, s14, 0x540000
    s_cmp_eq_u32 s3, 0
    s_cselect_b32 s14, s14, 0x7ffffff0
    s_mov_b64 exec, 0xffff
    buffer_store_short v249, v253, s[8:11], s14 offen sc1
    s_mov_b64 exec, -1
    ds_read_b64_tr_b16 v[240:241], v7 offset:17152
    v_mfma_f32_16x16x32_bf16 v[108:111], v[224:227], v[28:31], v[108:111]
    ds_read_b64_tr_b16 v[242:243], v7 offset:18176
    s_mov_b32 s23, 0x22000
    buffer_load_dwordx4 v[60:63], v6, s[8:11], s23 offen offset:1024 sc1
    s_waitcnt lgkmcnt(6)
    v_mfma_f32_16x16x32_bf16 v[112:115], v[228:231], v[24:27], v[112:115]
    ds_read_b64_tr_b16 v[244:245], v8 offset:17184
    v_mfma_f32_16x16x32_bf16 v[116:119], v[228:231], v[28:31], v[116:119]
    ds_read_b64_tr_b16 v[246:247], v8 offset:18208
    s_waitcnt lgkmcnt(6)
    v_mfma_f32_16x16x32_bf16 v[120:123], v[232:235], v[24:27], v[120:123]
    v_mfma_f32_16x16x32_bf16 v[124:127], v[232:235], v[28:31], v[124:127]
    s_barrier
    ds_read_b64_tr_b16 v[224:225], v4 offset:0
    ds_read_b64_tr_b16 v[226:227], v4 offset:1024
    s_waitcnt lgkmcnt(6)
    v_mfma_f32_16x16x32_bf16 v[128:131], v[236:239], v[24:27], v[128:131]
    s_add_u32 s16, s63, 0x576000
    v_mov_b32 v14, s28
    v_mov_b32 v15, 0
    s_mov_b64 exec, 1
    buffer_store_dword v14, v15, s[8:11], s16 offen sc1
    s_mov_b64 exec, -1
    s_add_u32 s22, s24, 0x110000
    s_add_u32 m0, s20, 0x20000
    s_nop 0
    buffer_load_dwordx4 v3, s[4:7], s22 offen lds
    ds_read_b64_tr_b16 v[228:229], v5 offset:32
    v_mfma_f32_16x16x32_bf16 v[132:135], v[236:239], v[28:31], v[132:135]
    ds_read_b64_tr_b16 v[230:231], v5 offset:1056
    s_waitcnt lgkmcnt(6)
    v_mfma_f32_16x16x32_bf16 v[136:139], v[240:243], v[24:27], v[136:139]
    ds_read_b64_tr_b16 v[232:233], v4 offset:256
    v_mfma_f32_16x16x32_bf16 v[140:143], v[240:243], v[28:31], v[140:143]
    s_add_u32 s22, s24, 0x112000
    s_add_u32 m0, s20, 0x20400
    s_nop 0
    buffer_load_dwordx4 v3, s[4:7], s22 offen lds
    ds_read_b64_tr_b16 v[234:235], v4 offset:1280
    s_waitcnt lgkmcnt(6)
    v_mfma_f32_16x16x32_bf16 v[144:147], v[244:247], v[24:27], v[144:147]
    ds_read_b64_tr_b16 v[236:237], v5 offset:288
    v_mfma_f32_16x16x32_bf16 v[148:151], v[244:247], v[28:31], v[148:151]
    ds_read_b64_tr_b16 v[238:239], v5 offset:1312
    s_waitcnt lgkmcnt(6)
    v_mfma_f32_16x16x32_bf16 v[88:91], v[224:227], v[32:35], v[88:91]
    ds_read_b64_tr_b16 v[240:241], v4 offset:512
    v_mfma_f32_16x16x32_bf16 v[92:95], v[224:227], v[36:39], v[92:95]
    ds_read_b64_tr_b16 v[242:243], v4 offset:1536
    s_waitcnt lgkmcnt(6)
    v_mfma_f32_16x16x32_bf16 v[96:99], v[228:231], v[32:35], v[96:99]
    ds_read_b64_tr_b16 v[244:245], v5 offset:544
    s_mov_b32 s23, 0x4000
    buffer_load_dwordx4 v[24:27], v6, s[8:11], s23 offen offset:1024 sc1
    v_mfma_f32_16x16x32_bf16 v[100:103], v[228:231], v[36:39], v[100:103]
    ds_read_b64_tr_b16 v[246:247], v5 offset:1568
    s_waitcnt lgkmcnt(6)
    v_mfma_f32_16x16x32_bf16 v[104:107], v[232:235], v[32:35], v[104:107]
    ds_read_b64_tr_b16 v[224:225], v4 offset:768
    v_mfma_f32_16x16x32_bf16 v[108:111], v[232:235], v[36:39], v[108:111]
    ds_read_b64_tr_b16 v[226:227], v4 offset:1792
    s_mov_b32 s23, 0x24000
    buffer_load_dwordx4 v[28:31], v6, s[8:11], s23 offen offset:1024 sc1
    s_waitcnt lgkmcnt(6)
    v_mfma_f32_16x16x32_bf16 v[112:115], v[236:239], v[32:35], v[112:115]
    ds_read_b64_tr_b16 v[228:229], v5 offset:800
    v_mfma_f32_16x16x32_bf16 v[116:119], v[236:239], v[36:39], v[116:119]
    ds_read_b64_tr_b16 v[230:231], v5 offset:1824
    s_waitcnt lgkmcnt(6)
    v_mfma_f32_16x16x32_bf16 v[120:123], v[240:243], v[32:35], v[120:123]
    v_mfma_f32_16x16x32_bf16 v[124:127], v[240:243], v[36:39], v[124:127]
    s_barrier
    ds_read_b64_tr_b16 v[232:233], v4 offset:16384
    ds_read_b64_tr_b16 v[234:235], v4 offset:17408
    s_waitcnt lgkmcnt(6)
    v_mfma_f32_16x16x32_bf16 v[128:131], v[244:247], v[32:35], v[128:131]
    s_add_u32 s22, s24, 0x190000
    s_add_u32 m0, s20, 0x24000
    s_nop 0
    buffer_load_dwordx4 v3, s[4:7], s22 offen lds
    ds_read_b64_tr_b16 v[236:237], v5 offset:16416
    v_mfma_f32_16x16x32_bf16 v[132:135], v[244:247], v[36:39], v[132:135]
    ds_read_b64_tr_b16 v[238:239], v5 offset:17440
    s_waitcnt lgkmcnt(6)
    v_mfma_f32_16x16x32_bf16 v[136:139], v[224:227], v[32:35], v[136:139]
    ds_read_b64_tr_b16 v[240:241], v4 offset:16640
    v_mfma_f32_16x16x32_bf16 v[140:143], v[224:227], v[36:39], v[140:143]
    s_add_u32 s22, s24, 0x192000
    s_add_u32 m0, s20, 0x24400
    s_nop 0
    buffer_load_dwordx4 v3, s[4:7], s22 offen lds
    ds_read_b64_tr_b16 v[242:243], v4 offset:17664
    s_waitcnt lgkmcnt(6)
    v_mfma_f32_16x16x32_bf16 v[144:147], v[228:231], v[32:35], v[144:147]
    ds_read_b64_tr_b16 v[244:245], v5 offset:16672
    v_mfma_f32_16x16x32_bf16 v[148:151], v[228:231], v[36:39], v[148:151]
    ds_read_b64_tr_b16 v[246:247], v5 offset:17696
    s_waitcnt lgkmcnt(6)
    v_mfma_f32_16x16x32_bf16 v[88:91], v[232:235], v[40:43], v[88:91]
    ds_read_b64_tr_b16 v[224:225], v4 offset:16896
    v_mfma_f32_16x16x32_bf16 v[92:95], v[232:235], v[44:47], v[92:95]
    ds_read_b64_tr_b16 v[226:227], v4 offset:17920
    s_waitcnt lgkmcnt(6)
    v_mfma_f32_16x16x32_bf16 v[96:99], v[236:239], v[40:43], v[96:99]
    ds_read_b64_tr_b16 v[228:229], v5 offset:16928
    s_mov_b32 s23, 0x6000
    buffer_load_dwordx4 v[32:35], v6, s[8:11], s23 offen offset:1024 sc1
    v_mfma_f32_16x16x32_bf16 v[100:103], v[236:239], v[44:47], v[100:103]
    ds_read_b64_tr_b16 v[230:231], v5 offset:17952
    s_waitcnt lgkmcnt(6)
    v_mfma_f32_16x16x32_bf16 v[104:107], v[240:243], v[40:43], v[104:107]
    ds_read_b64_tr_b16 v[232:233], v4 offset:17152
    v_mfma_f32_16x16x32_bf16 v[108:111], v[240:243], v[44:47], v[108:111]
    ds_read_b64_tr_b16 v[234:235], v4 offset:18176
    s_mov_b32 s23, 0x26000
    buffer_load_dwordx4 v[36:39], v6, s[8:11], s23 offen offset:1024 sc1
    s_waitcnt lgkmcnt(6)
    v_mfma_f32_16x16x32_bf16 v[112:115], v[244:247], v[40:43], v[112:115]
    ds_read_b64_tr_b16 v[236:237], v5 offset:17184
    v_mfma_f32_16x16x32_bf16 v[116:119], v[244:247], v[44:47], v[116:119]
    ds_read_b64_tr_b16 v[238:239], v5 offset:18208
    s_waitcnt lgkmcnt(6)
    v_mfma_f32_16x16x32_bf16 v[120:123], v[224:227], v[40:43], v[120:123]
    v_mfma_f32_16x16x32_bf16 v[124:127], v[224:227], v[44:47], v[124:127]
    s_waitcnt vmcnt(16)
    s_barrier
    ds_read_b64_tr_b16 v[240:241], v4 offset:32768
    ds_read_b64_tr_b16 v[242:243], v4 offset:33792
    s_waitcnt lgkmcnt(6)
    v_mfma_f32_16x16x32_bf16 v[128:131], v[228:231], v[40:43], v[128:131]
    s_add_u32 s22, s24, 0x210000
    s_add_u32 m0, s20, 0x10000
    s_nop 0
    buffer_load_dwordx4 v3, s[4:7], s22 offen lds
    ds_read_b64_tr_b16 v[244:245], v5 offset:32800
    v_mfma_f32_16x16x32_bf16 v[132:135], v[228:231], v[44:47], v[132:135]
    ds_read_b64_tr_b16 v[246:247], v5 offset:33824
    s_waitcnt lgkmcnt(6)
    v_mfma_f32_16x16x32_bf16 v[136:139], v[232:235], v[40:43], v[136:139]
    ds_read_b64_tr_b16 v[224:225], v4 offset:33024
    v_mfma_f32_16x16x32_bf16 v[140:143], v[232:235], v[44:47], v[140:143]
    s_add_u32 s22, s24, 0x212000
    s_add_u32 m0, s20, 0x10400
    s_nop 0
    buffer_load_dwordx4 v3, s[4:7], s22 offen lds
    ds_read_b64_tr_b16 v[226:227], v4 offset:34048
    s_waitcnt lgkmcnt(6)
    v_mfma_f32_16x16x32_bf16 v[144:147], v[236:239], v[40:43], v[144:147]
    ds_read_b64_tr_b16 v[228:229], v5 offset:33056
    v_mfma_f32_16x16x32_bf16 v[148:151], v[236:239], v[44:47], v[148:151]
    ds_read_b64_tr_b16 v[230:231], v5 offset:34080
    s_waitcnt vmcnt(17) lgkmcnt(6)
    v_mfma_f32_16x16x32_bf16 v[88:91], v[240:243], v[48:51], v[88:91]
    ds_read_b64_tr_b16 v[232:233], v4 offset:33280
    s_waitcnt vmcnt(16)
    v_mfma_f32_16x16x32_bf16 v[92:95], v[240:243], v[52:55], v[92:95]
    ds_read_b64_tr_b16 v[234:235], v4 offset:34304
    s_waitcnt lgkmcnt(6)
    v_mfma_f32_16x16x32_bf16 v[96:99], v[244:247], v[48:51], v[96:99]
    ds_read_b64_tr_b16 v[236:237], v5 offset:33312
    s_mov_b32 s23, 0x8000
    buffer_load_dwordx4 v[40:43], v6, s[8:11], s23 offen offset:1024 sc1
    v_mfma_f32_16x16x32_bf16 v[100:103], v[244:247], v[52:55], v[100:103]
    ds_read_b64_tr_b16 v[238:239], v5 offset:34336
    s_waitcnt lgkmcnt(6)
    v_mfma_f32_16x16x32_bf16 v[104:107], v[224:227], v[48:51], v[104:107]
    ds_read_b64_tr_b16 v[240:241], v4 offset:33536
    v_mfma_f32_16x16x32_bf16 v[108:111], v[224:227], v[52:55], v[108:111]
    ds_read_b64_tr_b16 v[242:243], v4 offset:34560
    s_mov_b32 s23, 0x28000
    buffer_load_dwordx4 v[44:47], v6, s[8:11], s23 offen offset:1024 sc1
    s_waitcnt lgkmcnt(6)
    v_mfma_f32_16x16x32_bf16 v[112:115], v[228:231], v[48:51], v[112:115]
    ds_read_b64_tr_b16 v[244:245], v5 offset:33568
    v_mfma_f32_16x16x32_bf16 v[116:119], v[228:231], v[52:55], v[116:119]
    ds_read_b64_tr_b16 v[246:247], v5 offset:34592
    s_waitcnt lgkmcnt(6)
    v_mfma_f32_16x16x32_bf16 v[120:123], v[232:235], v[48:51], v[120:123]
    v_mfma_f32_16x16x32_bf16 v[124:127], v[232:235], v[52:55], v[124:127]
    s_waitcnt vmcnt(16)
    s_barrier
    ds_read_b64_tr_b16 v[224:225], v4 offset:49152
    ds_read_b64_tr_b16 v[226:227], v4 offset:50176
    s_waitcnt lgkmcnt(6)
    v_mfma_f32_16x16x32_bf16 v[128:131], v[236:239], v[48:51], v[128:131]
    s_add_u32 s22, s24, 0x290000
    s_add_u32 m0, s20, 0x14000
    s_nop 0
    buffer_load_dwordx4 v3, s[4:7], s22 offen lds
    ds_read_b64_tr_b16 v[228:229], v5 offset:49184
    v_mfma_f32_16x16x32_bf16 v[132:135], v[236:239], v[52:55], v[132:135]
    ds_read_b64_tr_b16 v[230:231], v5 offset:50208
    s_waitcnt lgkmcnt(6)
    v_mfma_f32_16x16x32_bf16 v[136:139], v[240:243], v[48:51], v[136:139]
    ds_read_b64_tr_b16 v[232:233], v4 offset:49408
    v_mfma_f32_16x16x32_bf16 v[140:143], v[240:243], v[52:55], v[140:143]
    s_add_u32 s22, s24, 0x292000
    s_add_u32 m0, s20, 0x14400
    s_nop 0
    buffer_load_dwordx4 v3, s[4:7], s22 offen lds
    ds_read_b64_tr_b16 v[234:235], v4 offset:50432
    s_waitcnt lgkmcnt(6)
    v_mfma_f32_16x16x32_bf16 v[144:147], v[244:247], v[48:51], v[144:147]
    ds_read_b64_tr_b16 v[236:237], v5 offset:49440
    v_mfma_f32_16x16x32_bf16 v[148:151], v[244:247], v[52:55], v[148:151]
    ds_read_b64_tr_b16 v[238:239], v5 offset:50464
    s_waitcnt vmcnt(17) lgkmcnt(6)
    v_mfma_f32_16x16x32_bf16 v[88:91], v[224:227], v[56:59], v[88:91]
    ds_read_b64_tr_b16 v[240:241], v4 offset:49664
    s_waitcnt vmcnt(15)
    v_mfma_f32_16x16x32_bf16 v[92:95], v[224:227], v[60:63], v[92:95]
    ds_read_b64_tr_b16 v[242:243], v4 offset:50688
    s_waitcnt lgkmcnt(6)
    v_mfma_f32_16x16x32_bf16 v[96:99], v[228:231], v[56:59], v[96:99]
    ds_read_b64_tr_b16 v[244:245], v5 offset:49696
    s_mov_b32 s23, 0xa000
    buffer_load_dwordx4 v[48:51], v6, s[8:11], s23 offen offset:1024 sc1
    v_mfma_f32_16x16x32_bf16 v[100:103], v[228:231], v[60:63], v[100:103]
    ds_read_b64_tr_b16 v[246:247], v5 offset:50720
    s_waitcnt lgkmcnt(6)
    v_mfma_f32_16x16x32_bf16 v[104:107], v[232:235], v[56:59], v[104:107]
    ds_read_b64_tr_b16 v[224:225], v4 offset:49920
    v_mfma_f32_16x16x32_bf16 v[108:111], v[232:235], v[60:63], v[108:111]
    ds_read_b64_tr_b16 v[226:227], v4 offset:50944
    s_mov_b32 s23, 0x2a000
    buffer_load_dwordx4 v[52:55], v6, s[8:11], s23 offen offset:1024 sc1
    s_waitcnt lgkmcnt(6)
    v_mfma_f32_16x16x32_bf16 v[112:115], v[236:239], v[56:59], v[112:115]
    ds_read_b64_tr_b16 v[228:229], v5 offset:49952
    v_mfma_f32_16x16x32_bf16 v[116:119], v[236:239], v[60:63], v[116:119]
    ds_read_b64_tr_b16 v[230:231], v5 offset:50976
    s_waitcnt lgkmcnt(6)
    v_mfma_f32_16x16x32_bf16 v[120:123], v[240:243], v[56:59], v[120:123]
    v_mfma_f32_16x16x32_bf16 v[124:127], v[240:243], v[60:63], v[124:127]
    s_waitcnt vmcnt(14)
    s_barrier
    ds_read_b64_tr_b16 v[232:233], v7 offset:0
    ds_read_b64_tr_b16 v[234:235], v7 offset:1024
    s_waitcnt lgkmcnt(6)
    v_mfma_f32_16x16x32_bf16 v[128:131], v[244:247], v[56:59], v[128:131]
    s_add_u32 s22, s24, 0x310000
    s_add_u32 m0, s20, 0x18000
    s_nop 0
    buffer_load_dwordx4 v3, s[4:7], s22 offen lds
    ds_read_b64_tr_b16 v[236:237], v8 offset:32
    v_mfma_f32_16x16x32_bf16 v[132:135], v[244:247], v[60:63], v[132:135]
    ds_read_b64_tr_b16 v[238:239], v8 offset:1056
    s_waitcnt lgkmcnt(6)
    v_mfma_f32_16x16x32_bf16 v[136:139], v[224:227], v[56:59], v[136:139]
    ds_read_b64_tr_b16 v[240:241], v7 offset:256
    v_mfma_f32_16x16x32_bf16 v[140:143], v[224:227], v[60:63], v[140:143]
    s_add_u32 s22, s24, 0x312000
    s_add_u32 m0, s20, 0x18400
    s_nop 0
    buffer_load_dwordx4 v3, s[4:7], s22 offen lds
    ds_read_b64_tr_b16 v[242:243], v7 offset:1280
    s_waitcnt lgkmcnt(6)
    v_mfma_f32_16x16x32_bf16 v[144:147], v[228:231], v[56:59], v[144:147]
    ds_read_b64_tr_b16 v[244:245], v8 offset:288
    v_mfma_f32_16x16x32_bf16 v[148:151], v[228:231], v[60:63], v[148:151]
    ds_read_b64_tr_b16 v[246:247], v8 offset:1312
    s_waitcnt vmcnt(15) lgkmcnt(6)
    v_mfma_f32_16x16x32_bf16 v[88:91], v[232:235], v[24:27], v[88:91]
    ds_read_b64_tr_b16 v[224:225], v7 offset:512
    s_waitcnt vmcnt(14)
    v_mfma_f32_16x16x32_bf16 v[92:95], v[232:235], v[28:31], v[92:95]
    ds_read_b64_tr_b16 v[226:227], v7 offset:1536
    s_waitcnt lgkmcnt(6)
    v_mfma_f32_16x16x32_bf16 v[96:99], v[236:239], v[24:27], v[96:99]
    ds_read_b64_tr_b16 v[228:229], v8 offset:544
    s_mov_b32 s23, 0xc000
    buffer_load_dwordx4 v[56:59], v6, s[8:11], s23 offen offset:1024 sc1
    v_mfma_f32_16x16x32_bf16 v[100:103], v[236:239], v[28:31], v[100:103]
    ds_read_b64_tr_b16 v[230:231], v8 offset:1568
    s_waitcnt lgkmcnt(6)
    v_mfma_f32_16x16x32_bf16 v[104:107], v[240:243], v[24:27], v[104:107]
    ds_read_b64_tr_b16 v[232:233], v7 offset:768
    v_mfma_f32_16x16x32_bf16 v[108:111], v[240:243], v[28:31], v[108:111]
    ds_read_b64_tr_b16 v[234:235], v7 offset:1792
    s_mov_b32 s23, 0x2c000
    buffer_load_dwordx4 v[60:63], v6, s[8:11], s23 offen offset:1024 sc1
    s_waitcnt lgkmcnt(6)
    v_mfma_f32_16x16x32_bf16 v[112:115], v[244:247], v[24:27], v[112:115]
    ds_read_b64_tr_b16 v[236:237], v8 offset:800
    v_mfma_f32_16x16x32_bf16 v[116:119], v[244:247], v[28:31], v[116:119]
    ds_read_b64_tr_b16 v[238:239], v8 offset:1824
    s_waitcnt lgkmcnt(6)
    v_mfma_f32_16x16x32_bf16 v[120:123], v[224:227], v[24:27], v[120:123]
    v_mfma_f32_16x16x32_bf16 v[124:127], v[224:227], v[28:31], v[124:127]
    s_waitcnt vmcnt(14)
    s_barrier
    ds_read_b64_tr_b16 v[240:241], v7 offset:16384
    ds_read_b64_tr_b16 v[242:243], v7 offset:17408
    s_add_u32 s19, s19, 8192
    buffer_load_dword v12, v13, s[8:11], s19 offen sc1
    s_waitcnt lgkmcnt(6)
    v_mfma_f32_16x16x32_bf16 v[128:131], v[228:231], v[24:27], v[128:131]
    s_add_u32 s22, s24, 0x390000
    s_add_u32 m0, s20, 0x1c000
    s_nop 0
    buffer_load_dwordx4 v3, s[4:7], s22 offen lds
    ds_read_b64_tr_b16 v[244:245], v8 offset:16416
    v_mfma_f32_16x16x32_bf16 v[132:135], v[228:231], v[28:31], v[132:135]
    ds_read_b64_tr_b16 v[246:247], v8 offset:17440
    s_waitcnt lgkmcnt(6)
    v_mfma_f32_16x16x32_bf16 v[136:139], v[232:235], v[24:27], v[136:139]
    ds_read_b64_tr_b16 v[224:225], v7 offset:16640
    v_mfma_f32_16x16x32_bf16 v[140:143], v[232:235], v[28:31], v[140:143]
    s_add_u32 s22, s24, 0x392000
    s_add_u32 m0, s20, 0x1c400
    s_nop 0
    buffer_load_dwordx4 v3, s[4:7], s22 offen lds
    ds_read_b64_tr_b16 v[226:227], v7 offset:17664
    s_waitcnt lgkmcnt(6)
    v_mfma_f32_16x16x32_bf16 v[144:147], v[236:239], v[24:27], v[144:147]
    ds_read_b64_tr_b16 v[228:229], v8 offset:16672
    v_mfma_f32_16x16x32_bf16 v[148:151], v[236:239], v[28:31], v[148:151]
    ds_read_b64_tr_b16 v[230:231], v8 offset:17696
    s_waitcnt vmcnt(16) lgkmcnt(6)
    v_mfma_f32_16x16x32_bf16 v[88:91], v[240:243], v[32:35], v[88:91]
    ds_read_b64_tr_b16 v[232:233], v7 offset:16896
    s_waitcnt vmcnt(15)
    v_mfma_f32_16x16x32_bf16 v[92:95], v[240:243], v[36:39], v[92:95]
    ds_read_b64_tr_b16 v[234:235], v7 offset:17920
    s_waitcnt lgkmcnt(6)
    v_mfma_f32_16x16x32_bf16 v[96:99], v[244:247], v[32:35], v[96:99]
    ds_read_b64_tr_b16 v[236:237], v8 offset:16928
    s_mov_b32 s23, 0xe000
    buffer_load_dwordx4 v[24:27], v6, s[8:11], s23 offen offset:1024 sc1
    v_mfma_f32_16x16x32_bf16 v[100:103], v[244:247], v[36:39], v[100:103]
    ds_read_b64_tr_b16 v[238:239], v8 offset:17952
    s_waitcnt lgkmcnt(6)
    v_mfma_f32_16x16x32_bf16 v[104:107], v[224:227], v[32:35], v[104:107]
    ds_read_b64_tr_b16 v[240:241], v7 offset:17152
    v_mfma_f32_16x16x32_bf16 v[108:111], v[224:227], v[36:39], v[108:111]
    ds_read_b64_tr_b16 v[242:243], v7 offset:18176
    s_mov_b32 s23, 0x2e000
    buffer_load_dwordx4 v[28:31], v6, s[8:11], s23 offen offset:1024 sc1
    s_waitcnt lgkmcnt(6)
    v_mfma_f32_16x16x32_bf16 v[112:115], v[228:231], v[32:35], v[112:115]
    ds_read_b64_tr_b16 v[244:245], v8 offset:17184
    v_mfma_f32_16x16x32_bf16 v[116:119], v[228:231], v[36:39], v[116:119]
    ds_read_b64_tr_b16 v[246:247], v8 offset:18208
    s_waitcnt lgkmcnt(6)
    v_mfma_f32_16x16x32_bf16 v[120:123], v[232:235], v[32:35], v[120:123]
    v_mfma_f32_16x16x32_bf16 v[124:127], v[232:235], v[36:39], v[124:127]
    s_waitcnt vmcnt(15)
    s_barrier
    ds_read_b64_tr_b16 v[224:225], v4 offset:0
    ds_read_b64_tr_b16 v[226:227], v4 offset:1024
    s_waitcnt lgkmcnt(6)
    v_mfma_f32_16x16x32_bf16 v[128:131], v[236:239], v[32:35], v[128:131]
    s_add_u32 s22, s24, 0x20000
    s_add_u32 m0, s20, 0x20000
    s_nop 0
    buffer_load_dwordx4 v3, s[4:7], s22 offen lds
    ds_read_b64_tr_b16 v[228:229], v5 offset:32
    v_mfma_f32_16x16x32_bf16 v[132:135], v[236:239], v[36:39], v[132:135]
    ds_read_b64_tr_b16 v[230:231], v5 offset:1056
    s_waitcnt lgkmcnt(6)
    v_mfma_f32_16x16x32_bf16 v[136:139], v[240:243], v[32:35], v[136:139]
    ds_read_b64_tr_b16 v[232:233], v4 offset:256
    v_mfma_f32_16x16x32_bf16 v[140:143], v[240:243], v[36:39], v[140:143]
    s_add_u32 s22, s24, 0x22000
    s_add_u32 m0, s20, 0x20400
    s_nop 0
    buffer_load_dwordx4 v3, s[4:7], s22 offen lds
    ds_read_b64_tr_b16 v[234:235], v4 offset:1280
    s_waitcnt lgkmcnt(6)
    v_mfma_f32_16x16x32_bf16 v[144:147], v[244:247], v[32:35], v[144:147]
    ds_read_b64_tr_b16 v[236:237], v5 offset:288
    v_mfma_f32_16x16x32_bf16 v[148:151], v[244:247], v[36:39], v[148:151]
    ds_read_b64_tr_b16 v[238:239], v5 offset:1312
    s_waitcnt vmcnt(6)
    v_cmp_ne_u32 vcc, s28, v12
    s_cbranch_vccnz adaLN_cond__sliding_block_cached__moe_arch_mod__prompt_kernel_o28r
adaLN_cond__sliding_block_cached__moe_arch_mod__prompt_kernel_o28b:
    s_waitcnt lgkmcnt(6)
    v_mfma_f32_16x16x32_bf16 v[88:91], v[224:227], v[40:43], v[88:91]
    ds_read_b64_tr_b16 v[240:241], v4 offset:512
    v_mfma_f32_16x16x32_bf16 v[92:95], v[224:227], v[44:47], v[92:95]
    ds_read_b64_tr_b16 v[242:243], v4 offset:1536
    s_waitcnt lgkmcnt(6)
    v_mfma_f32_16x16x32_bf16 v[96:99], v[228:231], v[40:43], v[96:99]
    ds_read_b64_tr_b16 v[244:245], v5 offset:544
    s_mov_b32 s23, 0x0
    buffer_load_dwordx4 v[32:35], v6, s[8:11], s23 offen offset:2048 sc1
    v_mfma_f32_16x16x32_bf16 v[100:103], v[228:231], v[44:47], v[100:103]
    ds_read_b64_tr_b16 v[246:247], v5 offset:1568
    s_waitcnt lgkmcnt(6)
    v_mfma_f32_16x16x32_bf16 v[104:107], v[232:235], v[40:43], v[104:107]
    ds_read_b64_tr_b16 v[224:225], v4 offset:768
    v_mfma_f32_16x16x32_bf16 v[108:111], v[232:235], v[44:47], v[108:111]
    ds_read_b64_tr_b16 v[226:227], v4 offset:1792
    s_mov_b32 s23, 0x20000
    buffer_load_dwordx4 v[36:39], v6, s[8:11], s23 offen offset:2048 sc1
    s_waitcnt lgkmcnt(6)
    v_mfma_f32_16x16x32_bf16 v[112:115], v[236:239], v[40:43], v[112:115]
    ds_read_b64_tr_b16 v[228:229], v5 offset:800
    v_mfma_f32_16x16x32_bf16 v[116:119], v[236:239], v[44:47], v[116:119]
    ds_read_b64_tr_b16 v[230:231], v5 offset:1824
    s_waitcnt lgkmcnt(6)
    v_mfma_f32_16x16x32_bf16 v[120:123], v[240:243], v[40:43], v[120:123]
    v_mfma_f32_16x16x32_bf16 v[124:127], v[240:243], v[44:47], v[124:127]
    s_barrier
    ds_read_b64_tr_b16 v[232:233], v4 offset:16384
    ds_read_b64_tr_b16 v[234:235], v4 offset:17408
    s_waitcnt lgkmcnt(6)
    v_mfma_f32_16x16x32_bf16 v[128:131], v[244:247], v[40:43], v[128:131]
    s_add_u32 s22, s24, 0xa0000
    s_add_u32 m0, s20, 0x24000
    s_nop 0
    buffer_load_dwordx4 v3, s[4:7], s22 offen lds
    ds_read_b64_tr_b16 v[236:237], v5 offset:16416
    v_mfma_f32_16x16x32_bf16 v[132:135], v[244:247], v[44:47], v[132:135]
    ds_read_b64_tr_b16 v[238:239], v5 offset:17440
    s_waitcnt lgkmcnt(6)
    v_mfma_f32_16x16x32_bf16 v[136:139], v[224:227], v[40:43], v[136:139]
    ds_read_b64_tr_b16 v[240:241], v4 offset:16640
    v_mfma_f32_16x16x32_bf16 v[140:143], v[224:227], v[44:47], v[140:143]
    s_add_u32 s22, s24, 0xa2000
    s_add_u32 m0, s20, 0x24400
    s_nop 0
    buffer_load_dwordx4 v3, s[4:7], s22 offen lds
    ds_read_b64_tr_b16 v[242:243], v4 offset:17664
    s_waitcnt lgkmcnt(6)
    v_mfma_f32_16x16x32_bf16 v[144:147], v[228:231], v[40:43], v[144:147]
    ds_read_b64_tr_b16 v[244:245], v5 offset:16672
    v_mfma_f32_16x16x32_bf16 v[148:151], v[228:231], v[44:47], v[148:151]
    ds_read_b64_tr_b16 v[246:247], v5 offset:17696
    s_waitcnt lgkmcnt(6)
    v_mfma_f32_16x16x32_bf16 v[88:91], v[232:235], v[48:51], v[88:91]
    ds_read_b64_tr_b16 v[224:225], v4 offset:16896
    v_mfma_f32_16x16x32_bf16 v[92:95], v[232:235], v[52:55], v[92:95]
    ds_read_b64_tr_b16 v[226:227], v4 offset:17920
    s_waitcnt lgkmcnt(6)
    v_mfma_f32_16x16x32_bf16 v[96:99], v[236:239], v[48:51], v[96:99]
    ds_read_b64_tr_b16 v[228:229], v5 offset:16928
    s_mov_b32 s23, 0x2000
    buffer_load_dwordx4 v[40:43], v6, s[8:11], s23 offen offset:2048 sc1
    v_mfma_f32_16x16x32_bf16 v[100:103], v[236:239], v[52:55], v[100:103]
    ds_read_b64_tr_b16 v[230:231], v5 offset:17952
    s_waitcnt lgkmcnt(6)
    v_mfma_f32_16x16x32_bf16 v[104:107], v[240:243], v[48:51], v[104:107]
    ds_read_b64_tr_b16 v[232:233], v4 offset:17152
    v_mfma_f32_16x16x32_bf16 v[108:111], v[240:243], v[52:55], v[108:111]
    ds_read_b64_tr_b16 v[234:235], v4 offset:18176
    s_mov_b32 s23, 0x22000
    buffer_load_dwordx4 v[44:47], v6, s[8:11], s23 offen offset:2048 sc1
    s_waitcnt lgkmcnt(6)
    v_mfma_f32_16x16x32_bf16 v[112:115], v[244:247], v[48:51], v[112:115]
    ds_read_b64_tr_b16 v[236:237], v5 offset:17184
    v_mfma_f32_16x16x32_bf16 v[116:119], v[244:247], v[52:55], v[116:119]
    ds_read_b64_tr_b16 v[238:239], v5 offset:18208
    s_waitcnt lgkmcnt(6)
    v_mfma_f32_16x16x32_bf16 v[120:123], v[224:227], v[48:51], v[120:123]
    v_mfma_f32_16x16x32_bf16 v[124:127], v[224:227], v[52:55], v[124:127]
    s_barrier
    ds_read_b64_tr_b16 v[240:241], v4 offset:32768
    ds_read_b64_tr_b16 v[242:243], v4 offset:33792
    s_waitcnt lgkmcnt(6)
    v_mfma_f32_16x16x32_bf16 v[128:131], v[228:231], v[48:51], v[128:131]
    s_add_u32 s22, s24, 0x120000
    s_add_u32 m0, s20, 0x10000
    s_nop 0
    buffer_load_dwordx4 v3, s[4:7], s22 offen lds
    ds_read_b64_tr_b16 v[244:245], v5 offset:32800
    v_mfma_f32_16x16x32_bf16 v[132:135], v[228:231], v[52:55], v[132:135]
    ds_read_b64_tr_b16 v[246:247], v5 offset:33824
    s_waitcnt lgkmcnt(6)
    v_mfma_f32_16x16x32_bf16 v[136:139], v[232:235], v[48:51], v[136:139]
    ds_read_b64_tr_b16 v[224:225], v4 offset:33024
    v_mfma_f32_16x16x32_bf16 v[140:143], v[232:235], v[52:55], v[140:143]
    s_add_u32 s22, s24, 0x122000
    s_add_u32 m0, s20, 0x10400
    s_nop 0
    buffer_load_dwordx4 v3, s[4:7], s22 offen lds
    ds_read_b64_tr_b16 v[226:227], v4 offset:34048
    s_waitcnt lgkmcnt(6)
    v_mfma_f32_16x16x32_bf16 v[144:147], v[236:239], v[48:51], v[144:147]
    ds_read_b64_tr_b16 v[228:229], v5 offset:33056
    v_mfma_f32_16x16x32_bf16 v[148:151], v[236:239], v[52:55], v[148:151]
    ds_read_b64_tr_b16 v[230:231], v5 offset:34080
    s_waitcnt lgkmcnt(6)
    v_mfma_f32_16x16x32_bf16 v[88:91], v[240:243], v[56:59], v[88:91]
    ds_read_b64_tr_b16 v[232:233], v4 offset:33280
    v_mfma_f32_16x16x32_bf16 v[92:95], v[240:243], v[60:63], v[92:95]
    ds_read_b64_tr_b16 v[234:235], v4 offset:34304
    s_waitcnt lgkmcnt(6)
    v_mfma_f32_16x16x32_bf16 v[96:99], v[244:247], v[56:59], v[96:99]
    ds_read_b64_tr_b16 v[236:237], v5 offset:33312
    s_mov_b32 s23, 0x4000
    buffer_load_dwordx4 v[48:51], v6, s[8:11], s23 offen offset:2048 sc1
    v_mfma_f32_16x16x32_bf16 v[100:103], v[244:247], v[60:63], v[100:103]
    ds_read_b64_tr_b16 v[238:239], v5 offset:34336
    s_waitcnt lgkmcnt(6)
    v_mfma_f32_16x16x32_bf16 v[104:107], v[224:227], v[56:59], v[104:107]
    ds_read_b64_tr_b16 v[240:241], v4 offset:33536
    v_mfma_f32_16x16x32_bf16 v[108:111], v[224:227], v[60:63], v[108:111]
    ds_read_b64_tr_b16 v[242:243], v4 offset:34560
    s_mov_b32 s23, 0x24000
    buffer_load_dwordx4 v[52:55], v6, s[8:11], s23 offen offset:2048 sc1
    s_waitcnt lgkmcnt(6)
    v_mfma_f32_16x16x32_bf16 v[112:115], v[228:231], v[56:59], v[112:115]
    ds_read_b64_tr_b16 v[244:245], v5 offset:33568
    v_mfma_f32_16x16x32_bf16 v[116:119], v[228:231], v[60:63], v[116:119]
    ds_read_b64_tr_b16 v[246:247], v5 offset:34592
    s_waitcnt lgkmcnt(6)
    v_mfma_f32_16x16x32_bf16 v[120:123], v[232:235], v[56:59], v[120:123]
    v_mfma_f32_16x16x32_bf16 v[124:127], v[232:235], v[60:63], v[124:127]
    s_waitcnt vmcnt(14)
    s_barrier
    ds_read_b64_tr_b16 v[224:225], v4 offset:49152
    ds_read_b64_tr_b16 v[226:227], v4 offset:50176
    s_waitcnt lgkmcnt(6)
    v_mfma_f32_16x16x32_bf16 v[128:131], v[236:239], v[56:59], v[128:131]
    s_add_u32 s22, s24, 0x1a0000
    s_add_u32 m0, s20, 0x14000
    s_nop 0
    buffer_load_dwordx4 v3, s[4:7], s22 offen lds
    ds_read_b64_tr_b16 v[228:229], v5 offset:49184
    v_mfma_f32_16x16x32_bf16 v[132:135], v[236:239], v[60:63], v[132:135]
    ds_read_b64_tr_b16 v[230:231], v5 offset:50208
    s_waitcnt lgkmcnt(6)
    v_mfma_f32_16x16x32_bf16 v[136:139], v[240:243], v[56:59], v[136:139]
    ds_read_b64_tr_b16 v[232:233], v4 offset:49408
    v_mfma_f32_16x16x32_bf16 v[140:143], v[240:243], v[60:63], v[140:143]
    s_add_u32 s22, s24, 0x1a2000
    s_add_u32 m0, s20, 0x14400
    s_nop 0
    buffer_load_dwordx4 v3, s[4:7], s22 offen lds
    ds_read_b64_tr_b16 v[234:235], v4 offset:50432
    s_waitcnt lgkmcnt(6)
    v_mfma_f32_16x16x32_bf16 v[144:147], v[244:247], v[56:59], v[144:147]
    ds_read_b64_tr_b16 v[236:237], v5 offset:49440
    v_mfma_f32_16x16x32_bf16 v[148:151], v[244:247], v[60:63], v[148:151]
    ds_read_b64_tr_b16 v[238:239], v5 offset:50464
    s_waitcnt vmcnt(15) lgkmcnt(6)
    v_mfma_f32_16x16x32_bf16 v[88:91], v[224:227], v[24:27], v[88:91]
    ds_read_b64_tr_b16 v[240:241], v4 offset:49664
    s_waitcnt vmcnt(14)
    v_mfma_f32_16x16x32_bf16 v[92:95], v[224:227], v[28:31], v[92:95]
    ds_read_b64_tr_b16 v[242:243], v4 offset:50688
    s_waitcnt lgkmcnt(6)
    v_mfma_f32_16x16x32_bf16 v[96:99], v[228:231], v[24:27], v[96:99]
    ds_read_b64_tr_b16 v[244:245], v5 offset:49696
    s_mov_b32 s23, 0x6000
    buffer_load_dwordx4 v[56:59], v6, s[8:11], s23 offen offset:2048 sc1
    v_mfma_f32_16x16x32_bf16 v[100:103], v[228:231], v[28:31], v[100:103]
    ds_read_b64_tr_b16 v[246:247], v5 offset:50720
    s_waitcnt lgkmcnt(6)
    v_mfma_f32_16x16x32_bf16 v[104:107], v[232:235], v[24:27], v[104:107]
    ds_read_b64_tr_b16 v[224:225], v4 offset:49920
    v_mfma_f32_16x16x32_bf16 v[108:111], v[232:235], v[28:31], v[108:111]
    ds_read_b64_tr_b16 v[226:227], v4 offset:50944
    s_mov_b32 s23, 0x26000
    buffer_load_dwordx4 v[60:63], v6, s[8:11], s23 offen offset:2048 sc1
    s_waitcnt lgkmcnt(6)
    v_mfma_f32_16x16x32_bf16 v[112:115], v[236:239], v[24:27], v[112:115]
    ds_read_b64_tr_b16 v[228:229], v5 offset:49952
    v_mfma_f32_16x16x32_bf16 v[116:119], v[236:239], v[28:31], v[116:119]
    ds_read_b64_tr_b16 v[230:231], v5 offset:50976
    s_waitcnt lgkmcnt(6)
    v_mfma_f32_16x16x32_bf16 v[120:123], v[240:243], v[24:27], v[120:123]
    v_mfma_f32_16x16x32_bf16 v[124:127], v[240:243], v[28:31], v[124:127]
    s_waitcnt vmcnt(14)
    s_barrier
    ds_read_b64_tr_b16 v[232:233], v7 offset:0
    ds_read_b64_tr_b16 v[234:235], v7 offset:1024
    s_waitcnt lgkmcnt(6)
    v_mfma_f32_16x16x32_bf16 v[128:131], v[244:247], v[24:27], v[128:131]
    s_add_u32 s22, s24, 0x220000
    s_add_u32 m0, s20, 0x18000
    s_nop 0
    buffer_load_dwordx4 v3, s[4:7], s22 offen lds
    ds_read_b64_tr_b16 v[236:237], v8 offset:32
    v_mfma_f32_16x16x32_bf16 v[132:135], v[244:247], v[28:31], v[132:135]
    ds_read_b64_tr_b16 v[238:239], v8 offset:1056
    s_waitcnt lgkmcnt(6)
    v_mfma_f32_16x16x32_bf16 v[136:139], v[224:227], v[24:27], v[136:139]
    ds_read_b64_tr_b16 v[240:241], v7 offset:256
    v_mfma_f32_16x16x32_bf16 v[140:143], v[224:227], v[28:31], v[140:143]
    s_add_u32 s22, s24, 0x222000
    s_add_u32 m0, s20, 0x18400
    s_nop 0
    buffer_load_dwordx4 v3, s[4:7], s22 offen lds
    ds_read_b64_tr_b16 v[242:243], v7 offset:1280
    s_waitcnt lgkmcnt(6)
    v_mfma_f32_16x16x32_bf16 v[144:147], v[228:231], v[24:27], v[144:147]
    ds_read_b64_tr_b16 v[244:245], v8 offset:288
    v_mfma_f32_16x16x32_bf16 v[148:151], v[228:231], v[28:31], v[148:151]
    ds_read_b64_tr_b16 v[246:247], v8 offset:1312
    s_waitcnt vmcnt(15) lgkmcnt(6)
    v_mfma_f32_16x16x32_bf16 v[88:91], v[232:235], v[32:35], v[88:91]
    ds_read_b64_tr_b16 v[224:225], v7 offset:512
    s_waitcnt vmcnt(14)
    v_mfma_f32_16x16x32_bf16 v[92:95], v[232:235], v[36:39], v[92:95]
    ds_read_b64_tr_b16 v[226:227], v7 offset:1536
    s_waitcnt lgkmcnt(6)
    v_mfma_f32_16x16x32_bf16 v[96:99], v[236:239], v[32:35], v[96:99]
    ds_read_b64_tr_b16 v[228:229], v8 offset:544
    s_mov_b32 s23, 0x8000
    buffer_load_dwordx4 v[24:27], v6, s[8:11], s23 offen offset:2048 sc1
    v_mfma_f32_16x16x32_bf16 v[100:103], v[236:239], v[36:39], v[100:103]
    ds_read_b64_tr_b16 v[230:231], v8 offset:1568
    s_waitcnt lgkmcnt(6)
    v_mfma_f32_16x16x32_bf16 v[104:107], v[240:243], v[32:35], v[104:107]
    ds_read_b64_tr_b16 v[232:233], v7 offset:768
    v_mfma_f32_16x16x32_bf16 v[108:111], v[240:243], v[36:39], v[108:111]
    ds_read_b64_tr_b16 v[234:235], v7 offset:1792
    s_mov_b32 s23, 0x28000
    buffer_load_dwordx4 v[28:31], v6, s[8:11], s23 offen offset:2048 sc1
    s_waitcnt lgkmcnt(6)
    v_mfma_f32_16x16x32_bf16 v[112:115], v[244:247], v[32:35], v[112:115]
    ds_read_b64_tr_b16 v[236:237], v8 offset:800
    v_mfma_f32_16x16x32_bf16 v[116:119], v[244:247], v[36:39], v[116:119]
    ds_read_b64_tr_b16 v[238:239], v8 offset:1824
    s_waitcnt lgkmcnt(6)
    v_mfma_f32_16x16x32_bf16 v[120:123], v[224:227], v[32:35], v[120:123]
    v_mfma_f32_16x16x32_bf16 v[124:127], v[224:227], v[36:39], v[124:127]
    s_waitcnt vmcnt(14)
    s_barrier
    ds_read_b64_tr_b16 v[240:241], v7 offset:16384
    ds_read_b64_tr_b16 v[242:243], v7 offset:17408
    s_waitcnt lgkmcnt(6)
    v_mfma_f32_16x16x32_bf16 v[128:131], v[228:231], v[32:35], v[128:131]
    s_add_u32 s22, s24, 0x2a0000
    s_add_u32 m0, s20, 0x1c000
    s_nop 0
    buffer_load_dwordx4 v3, s[4:7], s22 offen lds
    ds_read_b64_tr_b16 v[244:245], v8 offset:16416
    v_mfma_f32_16x16x32_bf16 v[132:135], v[228:231], v[36:39], v[132:135]
    ds_read_b64_tr_b16 v[246:247], v8 offset:17440
    s_waitcnt lgkmcnt(6)
    v_mfma_f32_16x16x32_bf16 v[136:139], v[232:235], v[32:35], v[136:139]
    ds_read_b64_tr_b16 v[224:225], v7 offset:16640
    v_mfma_f32_16x16x32_bf16 v[140:143], v[232:235], v[36:39], v[140:143]
    s_add_u32 s22, s24, 0x2a2000
    s_add_u32 m0, s20, 0x1c400
    s_nop 0
    buffer_load_dwordx4 v3, s[4:7], s22 offen lds
    ds_read_b64_tr_b16 v[226:227], v7 offset:17664
    s_waitcnt lgkmcnt(6)
    v_mfma_f32_16x16x32_bf16 v[144:147], v[236:239], v[32:35], v[144:147]
    ds_read_b64_tr_b16 v[228:229], v8 offset:16672
    v_mfma_f32_16x16x32_bf16 v[148:151], v[236:239], v[36:39], v[148:151]
    ds_read_b64_tr_b16 v[230:231], v8 offset:17696
    s_waitcnt vmcnt(15) lgkmcnt(6)
    v_mfma_f32_16x16x32_bf16 v[88:91], v[240:243], v[40:43], v[88:91]
    ds_read_b64_tr_b16 v[232:233], v7 offset:16896
    s_waitcnt vmcnt(14)
    v_mfma_f32_16x16x32_bf16 v[92:95], v[240:243], v[44:47], v[92:95]
    ds_read_b64_tr_b16 v[234:235], v7 offset:17920
    s_waitcnt lgkmcnt(6)
    v_mfma_f32_16x16x32_bf16 v[96:99], v[244:247], v[40:43], v[96:99]
    ds_read_b64_tr_b16 v[236:237], v8 offset:16928
    s_mov_b32 s23, 0xa000
    buffer_load_dwordx4 v[32:35], v6, s[8:11], s23 offen offset:2048 sc1
    v_mfma_f32_16x16x32_bf16 v[100:103], v[244:247], v[44:47], v[100:103]
    ds_read_b64_tr_b16 v[238:239], v8 offset:17952
    s_waitcnt lgkmcnt(6)
    v_mfma_f32_16x16x32_bf16 v[104:107], v[224:227], v[40:43], v[104:107]
    ds_read_b64_tr_b16 v[240:241], v7 offset:17152
    v_mfma_f32_16x16x32_bf16 v[108:111], v[224:227], v[44:47], v[108:111]
    ds_read_b64_tr_b16 v[242:243], v7 offset:18176
    s_mov_b32 s23, 0x2a000
    buffer_load_dwordx4 v[36:39], v6, s[8:11], s23 offen offset:2048 sc1
    s_waitcnt lgkmcnt(6)
    v_mfma_f32_16x16x32_bf16 v[112:115], v[228:231], v[40:43], v[112:115]
    ds_read_b64_tr_b16 v[244:245], v8 offset:17184
    v_mfma_f32_16x16x32_bf16 v[116:119], v[228:231], v[44:47], v[116:119]
    ds_read_b64_tr_b16 v[246:247], v8 offset:18208
    s_waitcnt lgkmcnt(6)
    v_mfma_f32_16x16x32_bf16 v[120:123], v[232:235], v[40:43], v[120:123]
    v_mfma_f32_16x16x32_bf16 v[124:127], v[232:235], v[44:47], v[124:127]
    s_waitcnt vmcnt(14)
    s_barrier
    ds_read_b64_tr_b16 v[224:225], v4 offset:0
    ds_read_b64_tr_b16 v[226:227], v4 offset:1024
    s_waitcnt lgkmcnt(6)
    v_mfma_f32_16x16x32_bf16 v[128:131], v[236:239], v[40:43], v[128:131]
    s_add_u32 s22, s24, 0x320000
    s_add_u32 m0, s20, 0x20000
    s_nop 0
    buffer_load_dwordx4 v3, s[4:7], s22 offen lds
    ds_read_b64_tr_b16 v[228:229], v5 offset:32
    v_mfma_f32_16x16x32_bf16 v[132:135], v[236:239], v[44:47], v[132:135]
    ds_read_b64_tr_b16 v[230:231], v5 offset:1056
    s_waitcnt lgkmcnt(6)
    v_mfma_f32_16x16x32_bf16 v[136:139], v[240:243], v[40:43], v[136:139]
    ds_read_b64_tr_b16 v[232:233], v4 offset:256
    v_mfma_f32_16x16x32_bf16 v[140:143], v[240:243], v[44:47], v[140:143]
    s_add_u32 s22, s24, 0x322000
    s_add_u32 m0, s20, 0x20400
    s_nop 0
    buffer_load_dwordx4 v3, s[4:7], s22 offen lds
    ds_read_b64_tr_b16 v[234:235], v4 offset:1280
    s_waitcnt lgkmcnt(6)
    v_mfma_f32_16x16x32_bf16 v[144:147], v[244:247], v[40:43], v[144:147]
    ds_read_b64_tr_b16 v[236:237], v5 offset:288
    v_mfma_f32_16x16x32_bf16 v[148:151], v[244:247], v[44:47], v[148:151]
    ds_read_b64_tr_b16 v[238:239], v5 offset:1312
    s_waitcnt vmcnt(15) lgkmcnt(6)
    v_mfma_f32_16x16x32_bf16 v[88:91], v[224:227], v[48:51], v[88:91]
    v_mov_b32 v248, s28
    v_mov_b32 v249, 0
    s_lshl_b32 s14, s2, 2
    s_add_u32 s14, s14, 0x544000
    s_cmp_eq_u32 s3, 0
    s_cselect_b32 s14, s14, 0x7ffffff0
    s_mov_b64 exec, 1
    buffer_store_dword v248, v249, s[8:11], s14 offen sc1
    s_mov_b64 exec, -1
    ds_read_b64_tr_b16 v[240:241], v4 offset:512
    s_waitcnt vmcnt(15)
    v_mfma_f32_16x16x32_bf16 v[92:95], v[224:227], v[52:55], v[92:95]
    ds_read_b64_tr_b16 v[242:243], v4 offset:1536
    s_waitcnt lgkmcnt(6)
    v_mfma_f32_16x16x32_bf16 v[96:99], v[228:231], v[48:51], v[96:99]
    ds_read_b64_tr_b16 v[244:245], v5 offset:544
    s_mov_b32 s23, 0xc000
    buffer_load_dwordx4 v[40:43], v6, s[8:11], s23 offen offset:2048 sc1
    v_mfma_f32_16x16x32_bf16 v[100:103], v[228:231], v[52:55], v[100:103]
    ds_read_b64_tr_b16 v[246:247], v5 offset:1568
    s_waitcnt lgkmcnt(6)
    v_mfma_f32_16x16x32_bf16 v[104:107], v[232:235], v[48:51], v[104:107]
    ds_read_b64_tr_b16 v[224:225], v4 offset:768
    v_mfma_f32_16x16x32_bf16 v[108:111], v[232:235], v[52:55], v[108:111]
    ds_read_b64_tr_b16 v[226:227], v4 offset:1792
    s_mov_b32 s23, 0x2c000
    buffer_load_dwordx4 v[44:47], v6, s[8:11], s23 offen offset:2048 sc1
    s_waitcnt lgkmcnt(6)
    v_mfma_f32_16x16x32_bf16 v[112:115], v[236:239], v[48:51], v[112:115]
    ds_read_b64_tr_b16 v[228:229], v5 offset:800
    v_mfma_f32_16x16x32_bf16 v[116:119], v[236:239], v[52:55], v[116:119]
    ds_read_b64_tr_b16 v[230:231], v5 offset:1824
    s_waitcnt lgkmcnt(6)
    v_mfma_f32_16x16x32_bf16 v[120:123], v[240:243], v[48:51], v[120:123]
    v_mfma_f32_16x16x32_bf16 v[124:127], v[240:243], v[52:55], v[124:127]
    s_waitcnt vmcnt(15)
    s_barrier
    ds_read_b64_tr_b16 v[232:233], v4 offset:16384
    ds_read_b64_tr_b16 v[234:235], v4 offset:17408
    s_add_u32 s19, s19, 8192
    buffer_load_dword v12, v13, s[8:11], s19 offen sc1
    s_waitcnt lgkmcnt(6)
    v_mfma_f32_16x16x32_bf16 v[128:131], v[244:247], v[48:51], v[128:131]
    s_add_u32 s22, s24, 0x3a0000
    s_add_u32 m0, s20, 0x24000
    s_nop 0
    buffer_load_dwordx4 v3, s[4:7], s22 offen lds
    ds_read_b64_tr_b16 v[236:237], v5 offset:16416
    v_mfma_f32_16x16x32_bf16 v[132:135], v[244:247], v[52:55], v[132:135]
    ds_read_b64_tr_b16 v[238:239], v5 offset:17440
    s_waitcnt lgkmcnt(6)
    v_mfma_f32_16x16x32_bf16 v[136:139], v[224:227], v[48:51], v[136:139]
    ds_read_b64_tr_b16 v[240:241], v4 offset:16640
    v_mfma_f32_16x16x32_bf16 v[140:143], v[224:227], v[52:55], v[140:143]
    s_add_u32 s22, s24, 0x3a2000
    s_add_u32 m0, s20, 0x24400
    s_nop 0
    buffer_load_dwordx4 v3, s[4:7], s22 offen lds
    ds_read_b64_tr_b16 v[242:243], v4 offset:17664
    s_waitcnt lgkmcnt(6)
    v_mfma_f32_16x16x32_bf16 v[144:147], v[228:231], v[48:51], v[144:147]
    ds_read_b64_tr_b16 v[244:245], v5 offset:16672
    v_mfma_f32_16x16x32_bf16 v[148:151], v[228:231], v[52:55], v[148:151]
    ds_read_b64_tr_b16 v[246:247], v5 offset:17696
    s_waitcnt vmcnt(17) lgkmcnt(6)
    v_mfma_f32_16x16x32_bf16 v[88:91], v[232:235], v[56:59], v[88:91]
    ds_read_b64_tr_b16 v[224:225], v4 offset:16896
    s_waitcnt vmcnt(16)
    v_mfma_f32_16x16x32_bf16 v[92:95], v[232:235], v[60:63], v[92:95]
    ds_read_b64_tr_b16 v[226:227], v4 offset:17920
    s_waitcnt lgkmcnt(6)
    v_mfma_f32_16x16x32_bf16 v[96:99], v[236:239], v[56:59], v[96:99]
    ds_read_b64_tr_b16 v[228:229], v5 offset:16928
    s_mov_b32 s23, 0xe000
    buffer_load_dwordx4 v[48:51], v6, s[8:11], s23 offen offset:2048 sc1
    v_mfma_f32_16x16x32_bf16 v[100:103], v[236:239], v[60:63], v[100:103]
    ds_read_b64_tr_b16 v[230:231], v5 offset:17952
    s_waitcnt lgkmcnt(6)
    v_mfma_f32_16x16x32_bf16 v[104:107], v[240:243], v[56:59], v[104:107]
    ds_read_b64_tr_b16 v[232:233], v4 offset:17152
    v_mfma_f32_16x16x32_bf16 v[108:111], v[240:243], v[60:63], v[108:111]
    ds_read_b64_tr_b16 v[234:235], v4 offset:18176
    s_mov_b32 s23, 0x2e000
    buffer_load_dwordx4 v[52:55], v6, s[8:11], s23 offen offset:2048 sc1
    s_waitcnt lgkmcnt(6)
    v_mfma_f32_16x16x32_bf16 v[112:115], v[244:247], v[56:59], v[112:115]
    ds_read_b64_tr_b16 v[236:237], v5 offset:17184
    v_mfma_f32_16x16x32_bf16 v[116:119], v[244:247], v[60:63], v[116:119]
    ds_read_b64_tr_b16 v[238:239], v5 offset:18208
    s_waitcnt lgkmcnt(6)
    v_mfma_f32_16x16x32_bf16 v[120:123], v[224:227], v[56:59], v[120:123]
    v_mfma_f32_16x16x32_bf16 v[124:127], v[224:227], v[60:63], v[124:127]
    s_waitcnt vmcnt(16)
    s_barrier
    ds_read_b64_tr_b16 v[240:241], v4 offset:32768
    ds_read_b64_tr_b16 v[242:243], v4 offset:33792
    s_waitcnt lgkmcnt(6)
    v_mfma_f32_16x16x32_bf16 v[128:131], v[228:231], v[56:59], v[128:131]
    s_add_u32 s22, s24, 0x30000
    s_add_u32 m0, s20, 0x10000
    s_nop 0
    buffer_load_dwordx4 v3, s[4:7], s22 offen lds
    ds_read_b64_tr_b16 v[244:245], v5 offset:32800
    v_mfma_f32_16x16x32_bf16 v[132:135], v[228:231], v[60:63], v[132:135]
    ds_read_b64_tr_b16 v[246:247], v5 offset:33824
    s_waitcnt lgkmcnt(6)
    v_mfma_f32_16x16x32_bf16 v[136:139], v[232:235], v[56:59], v[136:139]
    ds_read_b64_tr_b16 v[224:225], v4 offset:33024
    v_mfma_f32_16x16x32_bf16 v[140:143], v[232:235], v[60:63], v[140:143]
    s_add_u32 s22, s24, 0x32000
    s_add_u32 m0, s20, 0x10400
    s_nop 0
    buffer_load_dwordx4 v3, s[4:7], s22 offen lds
    ds_read_b64_tr_b16 v[226:227], v4 offset:34048
    s_waitcnt lgkmcnt(6)
    v_mfma_f32_16x16x32_bf16 v[144:147], v[236:239], v[56:59], v[144:147]
    ds_read_b64_tr_b16 v[228:229], v5 offset:33056
    v_mfma_f32_16x16x32_bf16 v[148:151], v[236:239], v[60:63], v[148:151]
    ds_read_b64_tr_b16 v[230:231], v5 offset:34080
    s_waitcnt vmcnt(6)
    v_cmp_ne_u32 vcc, s28, v12
    s_cbranch_vccnz adaLN_cond__sliding_block_cached__moe_arch_mod__prompt_kernel_o29r
adaLN_cond__sliding_block_cached__moe_arch_mod__prompt_kernel_o29b:
    s_waitcnt lgkmcnt(6)
    v_mfma_f32_16x16x32_bf16 v[88:91], v[240:243], v[24:27], v[88:91]
    ds_read_b64_tr_b16 v[232:233], v4 offset:33280
    v_mfma_f32_16x16x32_bf16 v[92:95], v[240:243], v[28:31], v[92:95]
    ds_read_b64_tr_b16 v[234:235], v4 offset:34304
    s_waitcnt lgkmcnt(6)
    v_mfma_f32_16x16x32_bf16 v[96:99], v[244:247], v[24:27], v[96:99]
    ds_read_b64_tr_b16 v[236:237], v5 offset:33312
    s_mov_b32 s23, 0x0
    buffer_load_dwordx4 v[56:59], v6, s[8:11], s23 offen offset:3072 sc1
    v_mfma_f32_16x16x32_bf16 v[100:103], v[244:247], v[28:31], v[100:103]
    ds_read_b64_tr_b16 v[238:239], v5 offset:34336
    s_waitcnt lgkmcnt(6)
    v_mfma_f32_16x16x32_bf16 v[104:107], v[224:227], v[24:27], v[104:107]
    ds_read_b64_tr_b16 v[240:241], v4 offset:33536
    v_mfma_f32_16x16x32_bf16 v[108:111], v[224:227], v[28:31], v[108:111]
    ds_read_b64_tr_b16 v[242:243], v4 offset:34560
    s_mov_b32 s23, 0x20000
    buffer_load_dwordx4 v[60:63], v6, s[8:11], s23 offen offset:3072 sc1
    s_waitcnt lgkmcnt(6)
    v_mfma_f32_16x16x32_bf16 v[112:115], v[228:231], v[24:27], v[112:115]
    ds_read_b64_tr_b16 v[244:245], v5 offset:33568
    v_mfma_f32_16x16x32_bf16 v[116:119], v[228:231], v[28:31], v[116:119]
    ds_read_b64_tr_b16 v[246:247], v5 offset:34592
    s_waitcnt lgkmcnt(6)
    v_mfma_f32_16x16x32_bf16 v[120:123], v[232:235], v[24:27], v[120:123]
    v_mfma_f32_16x16x32_bf16 v[124:127], v[232:235], v[28:31], v[124:127]
    s_barrier
    ds_read_b64_tr_b16 v[224:225], v4 offset:49152
    ds_read_b64_tr_b16 v[226:227], v4 offset:50176
    s_waitcnt lgkmcnt(6)
    v_mfma_f32_16x16x32_bf16 v[128:131], v[236:239], v[24:27], v[128:131]
    s_add_u32 s22, s24, 0xb0000
    s_add_u32 m0, s20, 0x14000
    s_nop 0
    buffer_load_dwordx4 v3, s[4:7], s22 offen lds
    ds_read_b64_tr_b16 v[228:229], v5 offset:49184
    v_mfma_f32_16x16x32_bf16 v[132:135], v[236:239], v[28:31], v[132:135]
    ds_read_b64_tr_b16 v[230:231], v5 offset:50208
    s_waitcnt lgkmcnt(6)
    v_mfma_f32_16x16x32_bf16 v[136:139], v[240:243], v[24:27], v[136:139]
    ds_read_b64_tr_b16 v[232:233], v4 offset:49408
    v_mfma_f32_16x16x32_bf16 v[140:143], v[240:243], v[28:31], v[140:143]
    s_add_u32 s22, s24, 0xb2000
    s_add_u32 m0, s20, 0x14400
    s_nop 0
    buffer_load_dwordx4 v3, s[4:7], s22 offen lds
    ds_read_b64_tr_b16 v[234:235], v4 offset:50432
    s_waitcnt lgkmcnt(6)
    v_mfma_f32_16x16x32_bf16 v[144:147], v[244:247], v[24:27], v[144:147]
    ds_read_b64_tr_b16 v[236:237], v5 offset:49440
    v_mfma_f32_16x16x32_bf16 v[148:151], v[244:247], v[28:31], v[148:151]
    ds_read_b64_tr_b16 v[238:239], v5 offset:50464
    s_waitcnt lgkmcnt(6)
    v_mfma_f32_16x16x32_bf16 v[88:91], v[224:227], v[32:35], v[88:91]
    ds_read_b64_tr_b16 v[240:241], v4 offset:49664
    v_mfma_f32_16x16x32_bf16 v[92:95], v[224:227], v[36:39], v[92:95]
    ds_read_b64_tr_b16 v[242:243], v4 offset:50688
    s_waitcnt lgkmcnt(6)
    v_mfma_f32_16x16x32_bf16 v[96:99], v[228:231], v[32:35], v[96:99]
    ds_read_b64_tr_b16 v[244:245], v5 offset:49696
    s_mov_b32 s23, 0x2000
    buffer_load_dwordx4 v[24:27], v6, s[8:11], s23 offen offset:3072 sc1
    v_mfma_f32_16x16x32_bf16 v[100:103], v[228:231], v[36:39], v[100:103]
    ds_read_b64_tr_b16 v[246:247], v5 offset:50720
    s_waitcnt lgkmcnt(6)
    v_mfma_f32_16x16x32_bf16 v[104:107], v[232:235], v[32:35], v[104:107]
    ds_read_b64_tr_b16 v[224:225], v4 offset:49920
    v_mfma_f32_16x16x32_bf16 v[108:111], v[232:235], v[36:39], v[108:111]
    ds_read_b64_tr_b16 v[226:227], v4 offset:50944
    s_mov_b32 s23, 0x22000
    buffer_load_dwordx4 v[28:31], v6, s[8:11], s23 offen offset:3072 sc1
    s_waitcnt lgkmcnt(6)
    v_mfma_f32_16x16x32_bf16 v[112:115], v[236:239], v[32:35], v[112:115]
    ds_read_b64_tr_b16 v[228:229], v5 offset:49952
    v_mfma_f32_16x16x32_bf16 v[116:119], v[236:239], v[36:39], v[116:119]
    ds_read_b64_tr_b16 v[230:231], v5 offset:50976
    s_waitcnt lgkmcnt(6)
    v_mfma_f32_16x16x32_bf16 v[120:123], v[240:243], v[32:35], v[120:123]
    v_mfma_f32_16x16x32_bf16 v[124:127], v[240:243], v[36:39], v[124:127]
    s_barrier
    ds_read_b64_tr_b16 v[232:233], v7 offset:0
    ds_read_b64_tr_b16 v[234:235], v7 offset:1024
    s_waitcnt lgkmcnt(6)
    v_mfma_f32_16x16x32_bf16 v[128:131], v[244:247], v[32:35], v[128:131]
    s_add_u32 s22, s24, 0x130000
    s_add_u32 m0, s20, 0x18000
    s_nop 0
    buffer_load_dwordx4 v3, s[4:7], s22 offen lds
    ds_read_b64_tr_b16 v[236:237], v8 offset:32
    v_mfma_f32_16x16x32_bf16 v[132:135], v[244:247], v[36:39], v[132:135]
    ds_read_b64_tr_b16 v[238:239], v8 offset:1056
    s_waitcnt lgkmcnt(6)
    v_mfma_f32_16x16x32_bf16 v[136:139], v[224:227], v[32:35], v[136:139]
    ds_read_b64_tr_b16 v[240:241], v7 offset:256
    v_mfma_f32_16x16x32_bf16 v[140:143], v[224:227], v[36:39], v[140:143]
    s_add_u32 s22, s24, 0x132000
    s_add_u32 m0, s20, 0x18400
    s_nop 0
    buffer_load_dwordx4 v3, s[4:7], s22 offen lds
    ds_read_b64_tr_b16 v[242:243], v7 offset:1280
    s_waitcnt lgkmcnt(6)
    v_mfma_f32_16x16x32_bf16 v[144:147], v[228:231], v[32:35], v[144:147]
    ds_read_b64_tr_b16 v[244:245], v8 offset:288
    v_mfma_f32_16x16x32_bf16 v[148:151], v[228:231], v[36:39], v[148:151]
    ds_read_b64_tr_b16 v[246:247], v8 offset:1312
    s_waitcnt lgkmcnt(6)
    v_mfma_f32_16x16x32_bf16 v[88:91], v[232:235], v[40:43], v[88:91]
    ds_read_b64_tr_b16 v[224:225], v7 offset:512
    v_mfma_f32_16x16x32_bf16 v[92:95], v[232:235], v[44:47], v[92:95]
    ds_read_b64_tr_b16 v[226:227], v7 offset:1536
    s_waitcnt lgkmcnt(6)
    v_mfma_f32_16x16x32_bf16 v[96:99], v[236:239], v[40:43], v[96:99]
    ds_read_b64_tr_b16 v[228:229], v8 offset:544
    s_mov_b32 s23, 0x4000
    buffer_load_dwordx4 v[32:35], v6, s[8:11], s23 offen offset:3072 sc1
    v_mfma_f32_16x16x32_bf16 v[100:103], v[236:239], v[44:47], v[100:103]
    ds_read_b64_tr_b16 v[230:231], v8 offset:1568
    s_waitcnt lgkmcnt(6)
    v_mfma_f32_16x16x32_bf16 v[104:107], v[240:243], v[40:43], v[104:107]
    ds_read_b64_tr_b16 v[232:233], v7 offset:768
    v_mfma_f32_16x16x32_bf16 v[108:111], v[240:243], v[44:47], v[108:111]
    ds_read_b64_tr_b16 v[234:235], v7 offset:1792
    s_mov_b32 s23, 0x24000
    buffer_load_dwordx4 v[36:39], v6, s[8:11], s23 offen offset:3072 sc1
    s_waitcnt lgkmcnt(6)
    v_mfma_f32_16x16x32_bf16 v[112:115], v[244:247], v[40:43], v[112:115]
    ds_read_b64_tr_b16 v[236:237], v8 offset:800
    v_mfma_f32_16x16x32_bf16 v[116:119], v[244:247], v[44:47], v[116:119]
    ds_read_b64_tr_b16 v[238:239], v8 offset:1824
    s_waitcnt lgkmcnt(6)
    v_mfma_f32_16x16x32_bf16 v[120:123], v[224:227], v[40:43], v[120:123]
    v_mfma_f32_16x16x32_bf16 v[124:127], v[224:227], v[44:47], v[124:127]
    s_waitcnt vmcnt(14)
    s_barrier
    ds_read_b64_tr_b16 v[240:241], v7 offset:16384
    ds_read_b64_tr_b16 v[242:243], v7 offset:17408
    s_waitcnt lgkmcnt(6)
    v_mfma_f32_16x16x32_bf16 v[128:131], v[228:231], v[40:43], v[128:131]
    s_add_u32 s22, s24, 0x1b0000
    s_add_u32 m0, s20, 0x1c000
    s_nop 0
    buffer_load_dwordx4 v3, s[4:7], s22 offen lds
    ds_read_b64_tr_b16 v[244:245], v8 offset:16416
    v_mfma_f32_16x16x32_bf16 v[132:135], v[228:231], v[44:47], v[132:135]
    ds_read_b64_tr_b16 v[246:247], v8 offset:17440
    s_waitcnt lgkmcnt(6)
    v_mfma_f32_16x16x32_bf16 v[136:139], v[232:235], v[40:43], v[136:139]
    ds_read_b64_tr_b16 v[224:225], v7 offset:16640
    v_mfma_f32_16x16x32_bf16 v[140:143], v[232:235], v[44:47], v[140:143]
    s_add_u32 s22, s24, 0x1b2000
    s_add_u32 m0, s20, 0x1c400
    s_nop 0
    buffer_load_dwordx4 v3, s[4:7], s22 offen lds
    ds_read_b64_tr_b16 v[226:227], v7 offset:17664
    s_waitcnt lgkmcnt(6)
    v_mfma_f32_16x16x32_bf16 v[144:147], v[236:239], v[40:43], v[144:147]
    ds_read_b64_tr_b16 v[228:229], v8 offset:16672
    v_mfma_f32_16x16x32_bf16 v[148:151], v[236:239], v[44:47], v[148:151]
    ds_read_b64_tr_b16 v[230:231], v8 offset:17696
    s_waitcnt vmcnt(15) lgkmcnt(6)
    v_mfma_f32_16x16x32_bf16 v[88:91], v[240:243], v[48:51], v[88:91]
    ds_read_b64_tr_b16 v[232:233], v7 offset:16896
    s_waitcnt vmcnt(14)
    v_mfma_f32_16x16x32_bf16 v[92:95], v[240:243], v[52:55], v[92:95]
    ds_read_b64_tr_b16 v[234:235], v7 offset:17920
    s_waitcnt lgkmcnt(6)
    v_mfma_f32_16x16x32_bf16 v[96:99], v[244:247], v[48:51], v[96:99]
    ds_read_b64_tr_b16 v[236:237], v8 offset:16928
    s_mov_b32 s23, 0x6000
    buffer_load_dwordx4 v[40:43], v6, s[8:11], s23 offen offset:3072 sc1
    v_mfma_f32_16x16x32_bf16 v[100:103], v[244:247], v[52:55], v[100:103]
    ds_read_b64_tr_b16 v[238:239], v8 offset:17952
    s_waitcnt lgkmcnt(6)
    v_mfma_f32_16x16x32_bf16 v[104:107], v[224:227], v[48:51], v[104:107]
    ds_read_b64_tr_b16 v[240:241], v7 offset:17152
    v_mfma_f32_16x16x32_bf16 v[108:111], v[224:227], v[52:55], v[108:111]
    ds_read_b64_tr_b16 v[242:243], v7 offset:18176
    s_mov_b32 s23, 0x26000
    buffer_load_dwordx4 v[44:47], v6, s[8:11], s23 offen offset:3072 sc1
    s_waitcnt lgkmcnt(6)
    v_mfma_f32_16x16x32_bf16 v[112:115], v[228:231], v[48:51], v[112:115]
    ds_read_b64_tr_b16 v[244:245], v8 offset:17184
    v_mfma_f32_16x16x32_bf16 v[116:119], v[228:231], v[52:55], v[116:119]
    ds_read_b64_tr_b16 v[246:247], v8 offset:18208
    s_waitcnt lgkmcnt(6)
    v_mfma_f32_16x16x32_bf16 v[120:123], v[232:235], v[48:51], v[120:123]
    v_mfma_f32_16x16x32_bf16 v[124:127], v[232:235], v[52:55], v[124:127]
    s_waitcnt vmcnt(14)
    s_barrier
    ds_read_b64_tr_b16 v[224:225], v4 offset:0
    ds_read_b64_tr_b16 v[226:227], v4 offset:1024
    s_waitcnt lgkmcnt(6)
    v_mfma_f32_16x16x32_bf16 v[128:131], v[236:239], v[48:51], v[128:131]
    s_add_u32 s22, s24, 0x230000
    s_add_u32 m0, s20, 0x20000
    s_nop 0
    buffer_load_dwordx4 v3, s[4:7], s22 offen lds
    ds_read_b64_tr_b16 v[228:229], v5 offset:32
    v_mfma_f32_16x16x32_bf16 v[132:135], v[236:239], v[52:55], v[132:135]
    ds_read_b64_tr_b16 v[230:231], v5 offset:1056
    s_waitcnt lgkmcnt(6)
    v_mfma_f32_16x16x32_bf16 v[136:139], v[240:243], v[48:51], v[136:139]
    ds_read_b64_tr_b16 v[232:233], v4 offset:256
    v_mfma_f32_16x16x32_bf16 v[140:143], v[240:243], v[52:55], v[140:143]
    s_add_u32 s22, s24, 0x232000
    s_add_u32 m0, s20, 0x20400
    s_nop 0
    buffer_load_dwordx4 v3, s[4:7], s22 offen lds
    ds_read_b64_tr_b16 v[234:235], v4 offset:1280
    s_waitcnt lgkmcnt(6)
    v_mfma_f32_16x16x32_bf16 v[144:147], v[244:247], v[48:51], v[144:147]
    ds_read_b64_tr_b16 v[236:237], v5 offset:288
    v_mfma_f32_16x16x32_bf16 v[148:151], v[244:247], v[52:55], v[148:151]
    ds_read_b64_tr_b16 v[238:239], v5 offset:1312
    s_waitcnt vmcnt(15) lgkmcnt(6)
    v_mfma_f32_16x16x32_bf16 v[88:91], v[224:227], v[56:59], v[88:91]
    ds_read_b64_tr_b16 v[240:241], v4 offset:512
    s_waitcnt vmcnt(14)
    v_mfma_f32_16x16x32_bf16 v[92:95], v[224:227], v[60:63], v[92:95]
    ds_read_b64_tr_b16 v[242:243], v4 offset:1536
    s_waitcnt lgkmcnt(6)
    v_mfma_f32_16x16x32_bf16 v[96:99], v[228:231], v[56:59], v[96:99]
    ds_read_b64_tr_b16 v[244:245], v5 offset:544
    s_mov_b32 s23, 0x8000
    buffer_load_dwordx4 v[48:51], v6, s[8:11], s23 offen offset:3072 sc1
    v_mfma_f32_16x16x32_bf16 v[100:103], v[228:231], v[60:63], v[100:103]
    ds_read_b64_tr_b16 v[246:247], v5 offset:1568
    s_waitcnt lgkmcnt(6)
    v_mfma_f32_16x16x32_bf16 v[104:107], v[232:235], v[56:59], v[104:107]
    ds_read_b64_tr_b16 v[224:225], v4 offset:768
    v_mfma_f32_16x16x32_bf16 v[108:111], v[232:235], v[60:63], v[108:111]
    ds_read_b64_tr_b16 v[226:227], v4 offset:1792
    s_mov_b32 s23, 0x28000
    buffer_load_dwordx4 v[52:55], v6, s[8:11], s23 offen offset:3072 sc1
    s_waitcnt lgkmcnt(6)
    v_mfma_f32_16x16x32_bf16 v[112:115], v[236:239], v[56:59], v[112:115]
    ds_read_b64_tr_b16 v[228:229], v5 offset:800
    v_mfma_f32_16x16x32_bf16 v[116:119], v[236:239], v[60:63], v[116:119]
    ds_read_b64_tr_b16 v[230:231], v5 offset:1824
    s_waitcnt lgkmcnt(6)
    v_mfma_f32_16x16x32_bf16 v[120:123], v[240:243], v[56:59], v[120:123]
    v_mfma_f32_16x16x32_bf16 v[124:127], v[240:243], v[60:63], v[124:127]
    s_waitcnt vmcnt(14)
    s_barrier
    ds_read_b64_tr_b16 v[232:233], v4 offset:16384
    ds_read_b64_tr_b16 v[234:235], v4 offset:17408
    s_waitcnt lgkmcnt(6)
    v_mfma_f32_16x16x32_bf16 v[128:131], v[244:247], v[56:59], v[128:131]
    s_add_u32 s22, s24, 0x2b0000
    s_add_u32 m0, s20, 0x24000
    s_nop 0
    buffer_load_dwordx4 v3, s[4:7], s22 offen lds
    ds_read_b64_tr_b16 v[236:237], v5 offset:16416
    v_mfma_f32_16x16x32_bf16 v[132:135], v[244:247], v[60:63], v[132:135]
    ds_read_b64_tr_b16 v[238:239], v5 offset:17440
    s_waitcnt lgkmcnt(6)
    v_mfma_f32_16x16x32_bf16 v[136:139], v[224:227], v[56:59], v[136:139]
    ds_read_b64_tr_b16 v[240:241], v4 offset:16640
    v_mfma_f32_16x16x32_bf16 v[140:143], v[224:227], v[60:63], v[140:143]
    s_add_u32 s22, s24, 0x2b2000
    s_add_u32 m0, s20, 0x24400
    s_nop 0
    buffer_load_dwordx4 v3, s[4:7], s22 offen lds
    ds_read_b64_tr_b16 v[242:243], v4 offset:17664
    s_waitcnt lgkmcnt(6)
    v_mfma_f32_16x16x32_bf16 v[144:147], v[228:231], v[56:59], v[144:147]
    ds_read_b64_tr_b16 v[244:245], v5 offset:16672
    v_mfma_f32_16x16x32_bf16 v[148:151], v[228:231], v[60:63], v[148:151]
    ds_read_b64_tr_b16 v[246:247], v5 offset:17696
    s_waitcnt vmcnt(15) lgkmcnt(6)
    v_mfma_f32_16x16x32_bf16 v[88:91], v[232:235], v[24:27], v[88:91]
    ds_read_b64_tr_b16 v[224:225], v4 offset:16896
    s_waitcnt vmcnt(14)
    v_mfma_f32_16x16x32_bf16 v[92:95], v[232:235], v[28:31], v[92:95]
    ds_read_b64_tr_b16 v[226:227], v4 offset:17920
    s_waitcnt lgkmcnt(6)
    v_mfma_f32_16x16x32_bf16 v[96:99], v[236:239], v[24:27], v[96:99]
    ds_read_b64_tr_b16 v[228:229], v5 offset:16928
    s_mov_b32 s23, 0xa000
    buffer_load_dwordx4 v[56:59], v6, s[8:11], s23 offen offset:3072 sc1
    v_mfma_f32_16x16x32_bf16 v[100:103], v[236:239], v[28:31], v[100:103]
    ds_read_b64_tr_b16 v[230:231], v5 offset:17952
    s_waitcnt lgkmcnt(6)
    v_mfma_f32_16x16x32_bf16 v[104:107], v[240:243], v[24:27], v[104:107]
    ds_read_b64_tr_b16 v[232:233], v4 offset:17152
    v_mfma_f32_16x16x32_bf16 v[108:111], v[240:243], v[28:31], v[108:111]
    ds_read_b64_tr_b16 v[234:235], v4 offset:18176
    s_mov_b32 s23, 0x2a000
    buffer_load_dwordx4 v[60:63], v6, s[8:11], s23 offen offset:3072 sc1
    s_mov_b32 s16, 0x544000
    buffer_load_dwordx4 v[184:187], v2, s[8:11], s16 offen sc1
    s_waitcnt lgkmcnt(6)
    v_mfma_f32_16x16x32_bf16 v[112:115], v[244:247], v[24:27], v[112:115]
    ds_read_b64_tr_b16 v[236:237], v5 offset:17184
    v_mfma_f32_16x16x32_bf16 v[116:119], v[244:247], v[28:31], v[116:119]
    ds_read_b64_tr_b16 v[238:239], v5 offset:18208
    s_waitcnt lgkmcnt(6)
    v_mfma_f32_16x16x32_bf16 v[120:123], v[224:227], v[24:27], v[120:123]
    v_mfma_f32_16x16x32_bf16 v[124:127], v[224:227], v[28:31], v[124:127]
    s_waitcnt vmcnt(15)
    s_barrier
    ds_read_b64_tr_b16 v[240:241], v4 offset:32768
    ds_read_b64_tr_b16 v[242:243], v4 offset:33792
    s_waitcnt lgkmcnt(6)
    v_mfma_f32_16x16x32_bf16 v[128:131], v[228:231], v[24:27], v[128:131]
    s_add_u32 s22, s24, 0x330000
    s_add_u32 m0, s20, 0x10000
    s_nop 0
    buffer_load_dwordx4 v3, s[4:7], s22 offen lds
    ds_read_b64_tr_b16 v[244:245], v5 offset:32800
    v_mfma_f32_16x16x32_bf16 v[132:135], v[228:231], v[28:31], v[132:135]
    ds_read_b64_tr_b16 v[246:247], v5 offset:33824
    s_waitcnt lgkmcnt(6)
    v_mfma_f32_16x16x32_bf16 v[136:139], v[232:235], v[24:27], v[136:139]
    ds_read_b64_tr_b16 v[224:225], v4 offset:33024
    v_mfma_f32_16x16x32_bf16 v[140:143], v[232:235], v[28:31], v[140:143]
    s_add_u32 s22, s24, 0x332000
    s_add_u32 m0, s20, 0x10400
    s_nop 0
    buffer_load_dwordx4 v3, s[4:7], s22 offen lds
    ds_read_b64_tr_b16 v[226:227], v4 offset:34048
    s_waitcnt lgkmcnt(6)
    v_mfma_f32_16x16x32_bf16 v[144:147], v[236:239], v[24:27], v[144:147]
    ds_read_b64_tr_b16 v[228:229], v5 offset:33056
    v_mfma_f32_16x16x32_bf16 v[148:151], v[236:239], v[28:31], v[148:151]
    ds_read_b64_tr_b16 v[230:231], v5 offset:34080
    s_waitcnt vmcnt(16) lgkmcnt(6)
    v_mfma_f32_16x16x32_bf16 v[88:91], v[240:243], v[32:35], v[88:91]
    ds_read_b64_tr_b16 v[232:233], v4 offset:33280
    s_waitcnt vmcnt(15)
    v_mfma_f32_16x16x32_bf16 v[92:95], v[240:243], v[36:39], v[92:95]
    ds_read_b64_tr_b16 v[234:235], v4 offset:34304
    s_waitcnt lgkmcnt(6)
    v_mfma_f32_16x16x32_bf16 v[96:99], v[244:247], v[32:35], v[96:99]
    ds_read_b64_tr_b16 v[236:237], v5 offset:33312
    s_mov_b32 s23, 0xc000
    buffer_load_dwordx4 v[24:27], v6, s[8:11], s23 offen offset:3072 sc1
    v_mfma_f32_16x16x32_bf16 v[100:103], v[244:247], v[36:39], v[100:103]
    ds_read_b64_tr_b16 v[238:239], v5 offset:34336
    s_waitcnt lgkmcnt(6)
    v_mfma_f32_16x16x32_bf16 v[104:107], v[224:227], v[32:35], v[104:107]
    ds_read_b64_tr_b16 v[240:241], v4 offset:33536
    v_mfma_f32_16x16x32_bf16 v[108:111], v[224:227], v[36:39], v[108:111]
    ds_read_b64_tr_b16 v[242:243], v4 offset:34560
    s_mov_b32 s23, 0x2c000
    buffer_load_dwordx4 v[28:31], v6, s[8:11], s23 offen offset:3072 sc1
    s_waitcnt vmcnt(4)
    v_xor_b32 v16, s28, v184
    v_xor_b32 v17, s28, v185
    v_xor_b32 v18, s28, v186
    v_xor_b32 v19, s28, v187
    v_or3_b32 v16, v16, v17, v18
    v_or_b32 v16, v16, v19
    v_cmp_ne_u32 vcc, 0, v16
    s_cbranch_vccnz adaLN_cond__sliding_block_cached__moe_arch_mod__prompt_kernel_mf10r
adaLN_cond__sliding_block_cached__moe_arch_mod__prompt_kernel_mf10b:
    s_waitcnt lgkmcnt(6)
    v_mfma_f32_16x16x32_bf16 v[112:115], v[228:231], v[32:35], v[112:115]
    ds_read_b64_tr_b16 v[244:245], v5 offset:33568
    v_mfma_f32_16x16x32_bf16 v[116:119], v[228:231], v[36:39], v[116:119]
    ds_read_b64_tr_b16 v[246:247], v5 offset:34592
    s_waitcnt lgkmcnt(6)
    v_mfma_f32_16x16x32_bf16 v[120:123], v[232:235], v[32:35], v[120:123]
    v_mfma_f32_16x16x32_bf16 v[124:127], v[232:235], v[36:39], v[124:127]
    s_barrier
    ds_read_b64_tr_b16 v[224:225], v4 offset:49152
    ds_read_b64_tr_b16 v[226:227], v4 offset:50176
    s_waitcnt lgkmcnt(6)
    v_mfma_f32_16x16x32_bf16 v[128:131], v[236:239], v[32:35], v[128:131]
    s_add_u32 s22, s24, 0x3b0000
    s_add_u32 m0, s20, 0x14000
    s_nop 0
    buffer_load_dwordx4 v3, s[4:7], s22 offen lds
    ds_read_b64_tr_b16 v[228:229], v5 offset:49184
    v_mfma_f32_16x16x32_bf16 v[132:135], v[236:239], v[36:39], v[132:135]
    ds_read_b64_tr_b16 v[230:231], v5 offset:50208
    s_waitcnt lgkmcnt(6)
    v_mfma_f32_16x16x32_bf16 v[136:139], v[240:243], v[32:35], v[136:139]
    ds_read_b64_tr_b16 v[232:233], v4 offset:49408
    v_mfma_f32_16x16x32_bf16 v[140:143], v[240:243], v[36:39], v[140:143]
    s_add_u32 s22, s24, 0x3b2000
    s_add_u32 m0, s20, 0x14400
    s_nop 0
    buffer_load_dwordx4 v3, s[4:7], s22 offen lds
    ds_read_b64_tr_b16 v[234:235], v4 offset:50432
    s_waitcnt lgkmcnt(6)
    v_mfma_f32_16x16x32_bf16 v[144:147], v[244:247], v[32:35], v[144:147]
    ds_read_b64_tr_b16 v[236:237], v5 offset:49440
    v_mfma_f32_16x16x32_bf16 v[148:151], v[244:247], v[36:39], v[148:151]
    ds_read_b64_tr_b16 v[238:239], v5 offset:50464
    s_waitcnt lgkmcnt(6)
    v_mfma_f32_16x16x32_bf16 v[88:91], v[224:227], v[40:43], v[88:91]
    ds_read_b64_tr_b16 v[240:241], v4 offset:49664
    v_mfma_f32_16x16x32_bf16 v[92:95], v[224:227], v[44:47], v[92:95]
    ds_read_b64_tr_b16 v[242:243], v4 offset:50688
    s_waitcnt lgkmcnt(6)
    v_mfma_f32_16x16x32_bf16 v[96:99], v[228:231], v[40:43], v[96:99]
    ds_read_b64_tr_b16 v[244:245], v5 offset:49696
    s_mov_b32 s23, 0xe000
    buffer_load_dwordx4 v[32:35], v6, s[8:11], s23 offen offset:3072 sc1
    v_mfma_f32_16x16x32_bf16 v[100:103], v[228:231], v[44:47], v[100:103]
    ds_read_b64_tr_b16 v[246:247], v5 offset:50720
    s_waitcnt lgkmcnt(6)
    v_mfma_f32_16x16x32_bf16 v[104:107], v[232:235], v[40:43], v[104:107]
    ds_read_b64_tr_b16 v[224:225], v4 offset:49920
    v_mfma_f32_16x16x32_bf16 v[108:111], v[232:235], v[44:47], v[108:111]
    ds_read_b64_tr_b16 v[226:227], v4 offset:50944
    s_mov_b32 s23, 0x2e000
    buffer_load_dwordx4 v[36:39], v6, s[8:11], s23 offen offset:3072 sc1
    v_lshrrev_b32 v16, 4, v1
    v_lshlrev_b32 v16, 3, v16
    s_lshl_b32 s16, s31, 8
    s_add_u32 s16, s16, 0x540000
    buffer_load_dwordx2 v[248:249], v16, s[8:11], s16 offen offset:0 sc1
    buffer_load_dwordx2 v[250:251], v16, s[8:11], s16 offen offset:32 sc1
    buffer_load_dwordx2 v[252:253], v16, s[8:11], s16 offen offset:64 sc1
    buffer_load_dwordx2 v[254:255], v16, s[8:11], s16 offen offset:96 sc1
    s_waitcnt lgkmcnt(6)
    v_mfma_f32_16x16x32_bf16 v[112:115], v[236:239], v[40:43], v[112:115]
    ds_read_b64_tr_b16 v[228:229], v5 offset:49952
    v_mfma_f32_16x16x32_bf16 v[116:119], v[236:239], v[44:47], v[116:119]
    ds_read_b64_tr_b16 v[230:231], v5 offset:50976
    s_waitcnt lgkmcnt(6)
    v_mfma_f32_16x16x32_bf16 v[120:123], v[240:243], v[40:43], v[120:123]
    v_mfma_f32_16x16x32_bf16 v[124:127], v[240:243], v[44:47], v[124:127]
    s_barrier
    ds_read_b64_tr_b16 v[232:233], v7 offset:0
    ds_read_b64_tr_b16 v[234:235], v7 offset:1024
    s_waitcnt lgkmcnt(6)
    v_mfma_f32_16x16x32_bf16 v[128:131], v[244:247], v[40:43], v[128:131]
    ds_read_b64_tr_b16 v[236:237], v8 offset:32
    v_mfma_f32_16x16x32_bf16 v[132:135], v[244:247], v[44:47], v[132:135]
    ds_read_b64_tr_b16 v[238:239], v8 offset:1056
    s_waitcnt lgkmcnt(6)
    v_mfma_f32_16x16x32_bf16 v[136:139], v[224:227], v[40:43], v[136:139]
    ds_read_b64_tr_b16 v[240:241], v7 offset:256
    v_mfma_f32_16x16x32_bf16 v[140:143], v[224:227], v[44:47], v[140:143]
    ds_read_b64_tr_b16 v[242:243], v7 offset:1280
    s_waitcnt lgkmcnt(6)
    v_mfma_f32_16x16x32_bf16 v[144:147], v[228:231], v[40:43], v[144:147]
    ds_read_b64_tr_b16 v[244:245], v8 offset:288
    v_mfma_f32_16x16x32_bf16 v[148:151], v[228:231], v[44:47], v[148:151]
    ds_read_b64_tr_b16 v[246:247], v8 offset:1312
    s_waitcnt lgkmcnt(6)
    v_mfma_f32_16x16x32_bf16 v[88:91], v[232:235], v[48:51], v[88:91]
    ds_read_b64_tr_b16 v[224:225], v7 offset:512
    v_mfma_f32_16x16x32_bf16 v[92:95], v[232:235], v[52:55], v[92:95]
    ds_read_b64_tr_b16 v[226:227], v7 offset:1536
    s_waitcnt lgkmcnt(6)
    v_mfma_f32_16x16x32_bf16 v[96:99], v[236:239], v[48:51], v[96:99]
    ds_read_b64_tr_b16 v[228:229], v8 offset:544
    v_mfma_f32_16x16x32_bf16 v[100:103], v[236:239], v[52:55], v[100:103]
    ds_read_b64_tr_b16 v[230:231], v8 offset:1568
    s_waitcnt lgkmcnt(6)
    v_mfma_f32_16x16x32_bf16 v[104:107], v[240:243], v[48:51], v[104:107]
    ds_read_b64_tr_b16 v[232:233], v7 offset:768
    v_mfma_f32_16x16x32_bf16 v[108:111], v[240:243], v[52:55], v[108:111]
    ds_read_b64_tr_b16 v[234:235], v7 offset:1792
    s_waitcnt lgkmcnt(6)
    v_mfma_f32_16x16x32_bf16 v[112:115], v[244:247], v[48:51], v[112:115]
    ds_read_b64_tr_b16 v[236:237], v8 offset:800
    v_mfma_f32_16x16x32_bf16 v[116:119], v[244:247], v[52:55], v[116:119]
    ds_read_b64_tr_b16 v[238:239], v8 offset:1824
    s_waitcnt lgkmcnt(6)
    v_mfma_f32_16x16x32_bf16 v[120:123], v[224:227], v[48:51], v[120:123]
    v_mfma_f32_16x16x32_bf16 v[124:127], v[224:227], v[52:55], v[124:127]
    s_barrier
    ds_read_b64_tr_b16 v[240:241], v7 offset:16384
    ds_read_b64_tr_b16 v[242:243], v7 offset:17408
    s_waitcnt lgkmcnt(6)
    v_mfma_f32_16x16x32_bf16 v[128:131], v[228:231], v[48:51], v[128:131]
    ds_read_b64_tr_b16 v[244:245], v8 offset:16416
    v_mfma_f32_16x16x32_bf16 v[132:135], v[228:231], v[52:55], v[132:135]
    ds_read_b64_tr_b16 v[246:247], v8 offset:17440
    s_waitcnt lgkmcnt(6)
    v_mfma_f32_16x16x32_bf16 v[136:139], v[232:235], v[48:51], v[136:139]
    ds_read_b64_tr_b16 v[224:225], v7 offset:16640
    v_mfma_f32_16x16x32_bf16 v[140:143], v[232:235], v[52:55], v[140:143]
    ds_read_b64_tr_b16 v[226:227], v7 offset:17664
    s_waitcnt lgkmcnt(6)
    v_mfma_f32_16x16x32_bf16 v[144:147], v[236:239], v[48:51], v[144:147]
    ds_read_b64_tr_b16 v[228:229], v8 offset:16672
    v_mfma_f32_16x16x32_bf16 v[148:151], v[236:239], v[52:55], v[148:151]
    ds_read_b64_tr_b16 v[230:231], v8 offset:17696
    s_waitcnt lgkmcnt(6)
    v_mfma_f32_16x16x32_bf16 v[88:91], v[240:243], v[56:59], v[88:91]
    ds_read_b64_tr_b16 v[232:233], v7 offset:16896
    v_mfma_f32_16x16x32_bf16 v[92:95], v[240:243], v[60:63], v[92:95]
    ds_read_b64_tr_b16 v[234:235], v7 offset:17920
    s_waitcnt lgkmcnt(6)
    v_mfma_f32_16x16x32_bf16 v[96:99], v[244:247], v[56:59], v[96:99]
    ds_read_b64_tr_b16 v[236:237], v8 offset:16928
    v_mfma_f32_16x16x32_bf16 v[100:103], v[244:247], v[60:63], v[100:103]
    ds_read_b64_tr_b16 v[238:239], v8 offset:17952
    s_waitcnt lgkmcnt(6)
    v_mfma_f32_16x16x32_bf16 v[104:107], v[224:227], v[56:59], v[104:107]
    ds_read_b64_tr_b16 v[240:241], v7 offset:17152
    v_mfma_f32_16x16x32_bf16 v[108:111], v[224:227], v[60:63], v[108:111]
    ds_read_b64_tr_b16 v[242:243], v7 offset:18176
    s_waitcnt lgkmcnt(6)
    v_mfma_f32_16x16x32_bf16 v[112:115], v[228:231], v[56:59], v[112:115]
    ds_read_b64_tr_b16 v[244:245], v8 offset:17184
    v_mfma_f32_16x16x32_bf16 v[116:119], v[228:231], v[60:63], v[116:119]
    ds_read_b64_tr_b16 v[246:247], v8 offset:18208
    s_waitcnt lgkmcnt(6)
    v_mfma_f32_16x16x32_bf16 v[120:123], v[232:235], v[56:59], v[120:123]
    v_mfma_f32_16x16x32_bf16 v[124:127], v[232:235], v[60:63], v[124:127]
    s_waitcnt vmcnt(10)
    s_barrier
    ds_read_b64_tr_b16 v[224:225], v4 offset:0
    ds_read_b64_tr_b16 v[226:227], v4 offset:1024
    s_waitcnt lgkmcnt(6)
    v_mfma_f32_16x16x32_bf16 v[128:131], v[236:239], v[56:59], v[128:131]
    ds_read_b64_tr_b16 v[228:229], v5 offset:32
    v_mfma_f32_16x16x32_bf16 v[132:135], v[236:239], v[60:63], v[132:135]
    ds_read_b64_tr_b16 v[230:231], v5 offset:1056
    s_waitcnt lgkmcnt(6)
    v_mfma_f32_16x16x32_bf16 v[136:139], v[240:243], v[56:59], v[136:139]
    ds_read_b64_tr_b16 v[232:233], v4 offset:256
    v_mfma_f32_16x16x32_bf16 v[140:143], v[240:243], v[60:63], v[140:143]
    ds_read_b64_tr_b16 v[234:235], v4 offset:1280
    s_waitcnt lgkmcnt(6)
    v_mfma_f32_16x16x32_bf16 v[144:147], v[244:247], v[56:59], v[144:147]
    ds_read_b64_tr_b16 v[236:237], v5 offset:288
    v_mfma_f32_16x16x32_bf16 v[148:151], v[244:247], v[60:63], v[148:151]
    ds_read_b64_tr_b16 v[238:239], v5 offset:1312
    s_waitcnt vmcnt(9) lgkmcnt(6)
    v_mfma_f32_16x16x32_bf16 v[88:91], v[224:227], v[24:27], v[88:91]
    ds_read_b64_tr_b16 v[240:241], v4 offset:512
    s_waitcnt vmcnt(8)
    v_mfma_f32_16x16x32_bf16 v[92:95], v[224:227], v[28:31], v[92:95]
    ds_read_b64_tr_b16 v[242:243], v4 offset:1536
    s_waitcnt lgkmcnt(6)
    v_mfma_f32_16x16x32_bf16 v[96:99], v[228:231], v[24:27], v[96:99]
    ds_read_b64_tr_b16 v[244:245], v5 offset:544
    v_mfma_f32_16x16x32_bf16 v[100:103], v[228:231], v[28:31], v[100:103]
    ds_read_b64_tr_b16 v[246:247], v5 offset:1568
    s_waitcnt lgkmcnt(6)
    v_mfma_f32_16x16x32_bf16 v[104:107], v[232:235], v[24:27], v[104:107]
    ds_read_b64_tr_b16 v[224:225], v4 offset:768
    v_mfma_f32_16x16x32_bf16 v[108:111], v[232:235], v[28:31], v[108:111]
    ds_read_b64_tr_b16 v[226:227], v4 offset:1792
    s_waitcnt lgkmcnt(6)
    v_mfma_f32_16x16x32_bf16 v[112:115], v[236:239], v[24:27], v[112:115]
    ds_read_b64_tr_b16 v[228:229], v5 offset:800
    v_mfma_f32_16x16x32_bf16 v[116:119], v[236:239], v[28:31], v[116:119]
    ds_read_b64_tr_b16 v[230:231], v5 offset:1824
    s_waitcnt lgkmcnt(6)
    v_mfma_f32_16x16x32_bf16 v[120:123], v[240:243], v[24:27], v[120:123]
    v_mfma_f32_16x16x32_bf16 v[124:127], v[240:243], v[28:31], v[124:127]
    s_waitcnt vmcnt(6)
    s_barrier
    ds_read_b64_tr_b16 v[232:233], v4 offset:16384
    ds_read_b64_tr_b16 v[234:235], v4 offset:17408
    s_waitcnt lgkmcnt(6)
    v_mfma_f32_16x16x32_bf16 v[128:131], v[244:247], v[24:27], v[128:131]
    ds_read_b64_tr_b16 v[236:237], v5 offset:16416
    v_mfma_f32_16x16x32_bf16 v[132:135], v[244:247], v[28:31], v[132:135]
    ds_read_b64_tr_b16 v[238:239], v5 offset:17440
    s_waitcnt lgkmcnt(6)
    v_mfma_f32_16x16x32_bf16 v[136:139], v[224:227], v[24:27], v[136:139]
    ds_read_b64_tr_b16 v[240:241], v4 offset:16640
    v_mfma_f32_16x16x32_bf16 v[140:143], v[224:227], v[28:31], v[140:143]
    ds_read_b64_tr_b16 v[242:243], v4 offset:17664
    s_waitcnt lgkmcnt(6)
    v_mfma_f32_16x16x32_bf16 v[144:147], v[228:231], v[24:27], v[144:147]
    ds_read_b64_tr_b16 v[244:245], v5 offset:16672
    v_mfma_f32_16x16x32_bf16 v[148:151], v[228:231], v[28:31], v[148:151]
    ds_read_b64_tr_b16 v[246:247], v5 offset:17696
    s_waitcnt vmcnt(5) lgkmcnt(6)
    v_mfma_f32_16x16x32_bf16 v[88:91], v[232:235], v[32:35], v[88:91]
    ds_read_b64_tr_b16 v[224:225], v4 offset:16896
    s_waitcnt vmcnt(4)
    v_mfma_f32_16x16x32_bf16 v[92:95], v[232:235], v[36:39], v[92:95]
    ds_read_b64_tr_b16 v[226:227], v4 offset:17920
    s_waitcnt lgkmcnt(6)
    v_mfma_f32_16x16x32_bf16 v[96:99], v[236:239], v[32:35], v[96:99]
    ds_read_b64_tr_b16 v[228:229], v5 offset:16928
    v_mfma_f32_16x16x32_bf16 v[100:103], v[236:239], v[36:39], v[100:103]
    ds_read_b64_tr_b16 v[230:231], v5 offset:17952
    s_waitcnt lgkmcnt(6)
    v_mfma_f32_16x16x32_bf16 v[104:107], v[240:243], v[32:35], v[104:107]
    ds_read_b64_tr_b16 v[232:233], v4 offset:17152
    v_mfma_f32_16x16x32_bf16 v[108:111], v[240:243], v[36:39], v[108:111]
    ds_read_b64_tr_b16 v[234:235], v4 offset:18176
    s_waitcnt lgkmcnt(6)
    v_mfma_f32_16x16x32_bf16 v[112:115], v[244:247], v[32:35], v[112:115]
    ds_read_b64_tr_b16 v[236:237], v5 offset:17184
    v_mfma_f32_16x16x32_bf16 v[116:119], v[244:247], v[36:39], v[116:119]
    ds_read_b64_tr_b16 v[238:239], v5 offset:18208
    s_waitcnt lgkmcnt(6)
    v_mfma_f32_16x16x32_bf16 v[120:123], v[224:227], v[32:35], v[120:123]
    v_mfma_f32_16x16x32_bf16 v[124:127], v[224:227], v[36:39], v[124:127]
    s_waitcnt lgkmcnt(4)
    v_mfma_f32_16x16x32_bf16 v[128:131], v[228:231], v[32:35], v[128:131]
    v_mfma_f32_16x16x32_bf16 v[132:135], v[228:231], v[36:39], v[132:135]
    s_waitcnt lgkmcnt(2)
    v_mfma_f32_16x16x32_bf16 v[136:139], v[232:235], v[32:35], v[136:139]
    v_mfma_f32_16x16x32_bf16 v[140:143], v[232:235], v[36:39], v[140:143]
    s_waitcnt lgkmcnt(0)
    v_mfma_f32_16x16x32_bf16 v[144:147], v[236:239], v[32:35], v[144:147]
    v_mfma_f32_16x16x32_bf16 v[148:151], v[236:239], v[36:39], v[148:151]
    s_lshl_b32 s16, s3, 13
    s_xor_b32 s17, s16, 0x8000
    s_add_u32 s16, s16, 0x18000
    s_add_u32 s17, s17, 0x18000
    v_add_u32 v16, s16, v2
    s_mov_b32 s16, s17
    v_add_u32 v17, s16, v2
    ds_write_b128 v16, v[120:123] offset:0
    ds_write_b128 v16, v[124:127] offset:1024
    ds_write_b128 v16, v[128:131] offset:2048
    ds_write_b128 v16, v[132:135] offset:3072
    ds_write_b128 v16, v[136:139] offset:4096
    ds_write_b128 v16, v[140:143] offset:5120
    ds_write_b128 v16, v[144:147] offset:6144
    ds_write_b128 v16, v[148:151] offset:7168
    s_waitcnt vmcnt(3)
    v_lshlrev_b32 v24, 16, v248
    v_and_b32 v25, 0xffff0000, v248
    v_lshlrev_b32 v26, 16, v249
    v_and_b32 v27, 0xffff0000, v249
    s_waitcnt vmcnt(2)
    v_lshlrev_b32 v28, 16, v250
    v_and_b32 v29, 0xffff0000, v250
    v_lshlrev_b32 v30, 16, v251
    v_and_b32 v31, 0xffff0000, v251
    s_waitcnt vmcnt(1)
    v_lshlrev_b32 v32, 16, v252
    v_and_b32 v33, 0xffff0000, v252
    v_lshlrev_b32 v34, 16, v253
    v_and_b32 v35, 0xffff0000, v253
    s_waitcnt vmcnt(0)
    v_lshlrev_b32 v36, 16, v254
    v_and_b32 v37, 0xffff0000, v254
    v_lshlrev_b32 v38, 16, v255
    v_and_b32 v39, 0xffff0000, v255
    v_and_b32 v18, 15, v1
    v_lshlrev_b32 v18, 6, v18
    v_lshrrev_b32 v19, 4, v1
    v_and_b32 v20, 1, v19
    v_lshl_add_u32 v18, v20, 5, v18
    v_lshrrev_b32 v19, 1, v19
    v_lshl_add_u32 v18, v19, 4, v18
    s_and_b32 s17, s3, 3
    s_lshl_b32 s18, s30, 2
    s_add_u32 s18, s18, s17
    s_lshl_b32 s18, s18, 16
    s_lshl_b32 s19, s15, 22
    s_add_u32 s18, s18, s19
    s_lshl_b32 s19, s31, 12
    s_add_u32 s18, s18, s19
    s_add_u32 s18, s18, 0x2000000
    s_add_u32 s19, s18, 32768
    s_waitcnt lgkmcnt(0)
    s_barrier
    ds_read_b128 v[40:43], v17 offset:0
    ds_read_b128 v[44:47], v17 offset:1024
    ds_read_b128 v[48:51], v17 offset:2048
    ds_read_b128 v[52:55], v17 offset:3072
    ds_read_b128 v[56:59], v17 offset:4096
    ds_read_b128 v[60:63], v17 offset:5120
    ds_read_b128 v[64:67], v17 offset:6144
    ds_read_b128 v[68:71], v17 offset:7168
    s_waitcnt lgkmcnt(7)
    v_pk_add_f32 v[88:89], v[88:89], v[40:41]
    v_pk_add_f32 v[90:91], v[90:91], v[42:43]
    v_pk_mul_f32 v[88:89], v[88:89], v[24:25]
    v_pk_mul_f32 v[90:91], v[90:91], v[26:27]
    v_cvt_pk_bf16_f32 v224, v88, v89
    v_cvt_pk_bf16_f32 v225, v90, v91
    s_waitcnt lgkmcnt(5)
    v_pk_add_f32 v[96:97], v[96:97], v[48:49]
    v_pk_add_f32 v[98:99], v[98:99], v[50:51]
    v_pk_mul_f32 v[96:97], v[96:97], v[28:29]
    v_pk_mul_f32 v[98:99], v[98:99], v[30:31]
    v_cvt_pk_bf16_f32 v226, v96, v97
    v_cvt_pk_bf16_f32 v227, v98, v99
    s_nop 0
    v_permlane16_swap_b32 v224, v226
    v_permlane16_swap_b32 v225, v227
    buffer_store_dwordx4 v[224:227], v18, s[8:11], s18 offen offset:0 sc1
    v_pk_add_f32 v[92:93], v[92:93], v[44:45]
    v_pk_add_f32 v[94:95], v[94:95], v[46:47]
    v_pk_mul_f32 v[92:93], v[92:93], v[24:25]
    v_pk_mul_f32 v[94:95], v[94:95], v[26:27]
    v_cvt_pk_bf16_f32 v228, v92, v93
    v_cvt_pk_bf16_f32 v229, v94, v95
    s_waitcnt lgkmcnt(4)
    v_pk_add_f32 v[100:101], v[100:101], v[52:53]
    v_pk_add_f32 v[102:103], v[102:103], v[54:55]
    v_pk_mul_f32 v[100:101], v[100:101], v[28:29]
    v_pk_mul_f32 v[102:103], v[102:103], v[30:31]
    v_cvt_pk_bf16_f32 v230, v100, v101
    v_cvt_pk_bf16_f32 v231, v102, v103
    s_nop 0
    v_permlane16_swap_b32 v228, v230
    v_permlane16_swap_b32 v229, v231
    buffer_store_dwordx4 v[228:231], v18, s[8:11], s19 offen offset:0 sc1
    s_waitcnt lgkmcnt(3)
    v_pk_add_f32 v[104:105], v[104:105], v[56:57]
    v_pk_add_f32 v[106:107], v[106:107], v[58:59]
    v_pk_mul_f32 v[104:105], v[104:105], v[32:33]
    v_pk_mul_f32 v[106:107], v[106:107], v[34:35]
    v_cvt_pk_bf16_f32 v232, v104, v105
    v_cvt_pk_bf16_f32 v233, v106, v107
    s_waitcnt lgkmcnt(1)
    v_pk_add_f32 v[112:113], v[112:113], v[64:65]
    v_pk_add_f32 v[114:115], v[114:115], v[66:67]
    v_pk_mul_f32 v[112:113], v[112:113], v[36:37]
    v_pk_mul_f32 v[114:115], v[114:115], v[38:39]
    v_cvt_pk_bf16_f32 v234, v112, v113
    v_cvt_pk_bf16_f32 v235, v114, v115
    s_nop 0
    v_permlane16_swap_b32 v232, v234
    v_permlane16_swap_b32 v233, v235
    buffer_store_dwordx4 v[232:235], v18, s[8:11], s18 offen offset:1024 sc1
    v_pk_add_f32 v[108:109], v[108:109], v[60:61]
    v_pk_add_f32 v[110:111], v[110:111], v[62:63]
    v_pk_mul_f32 v[108:109], v[108:109], v[32:33]
    v_pk_mul_f32 v[110:111], v[110:111], v[34:35]
    v_cvt_pk_bf16_f32 v236, v108, v109
    v_cvt_pk_bf16_f32 v237, v110, v111
    s_waitcnt lgkmcnt(0)
    v_pk_add_f32 v[116:117], v[116:117], v[68:69]
    v_pk_add_f32 v[118:119], v[118:119], v[70:71]
    v_pk_mul_f32 v[116:117], v[116:117], v[36:37]
    v_pk_mul_f32 v[118:119], v[118:119], v[38:39]
    v_cvt_pk_bf16_f32 v238, v116, v117
    v_cvt_pk_bf16_f32 v239, v118, v119
    s_nop 0
    v_permlane16_swap_b32 v236, v238
    v_permlane16_swap_b32 v237, v239
    buffer_store_dwordx4 v[236:239], v18, s[8:11], s19 offen offset:1024 sc1
    s_mov_b64 s[64:65], s[44:45]
    s_mov_b32 s66, 0x800
    s_mov_b32 s67, 0x20000
    s_mov_b64 s[76:77], s[32:33]
    s_mov_b32 s78, 0x400000
    s_mov_b32 s79, 0x20000
    s_mov_b64 s[68:69], s[56:57]
    s_mov_b32 s70, 0x400000
    s_mov_b32 s71, 0x20000
    s_lshl_b32 s14, s31, 1
    s_add_u32 s14, s14, s15
    s_lshl_b32 s14, s14, 3
    s_add_u32 s14, s14, s3
    s_lshl_b32 s16, s30, 7
    s_add_u32 s14, s14, s16
    s_lshl_b32 s16, s14, 11
    buffer_load_dwordx4 v[216:219], v2, s[76:79], s16 offen offset:0
    buffer_load_dwordx4 v[220:223], v2, s[76:79], s16 offen offset:1024
    s_lshl_b32 s16, s3, 10
    s_add_u32 m0, s16, 81920
    s_add_u32 s16, s16, 0x540800
    buffer_load_dwordx4 v2, s[8:11], s16 offen sc1 lds
    s_lshl_b32 s16, s30, 5
    s_lshl_b32 s17, s31, 1
    s_add_u32 s16, s16, s17
    s_add_u32 s16, s16, s15
    s_lshl_b32 s16, s16, 2
    s_add_u32 s16, s16, 0x530000
    s_cmp_eq_u32 s3, 0
    s_cselect_b32 s16, s16, 0x7ffffff0
    v_mov_b32 v16, s28
    v_mov_b32 v17, 0
    s_lshr_b32 s18, s14, 4
    s_lshl_b32 s18, s18, 15
    s_and_b32 s19, s14, 15
    s_lshl_b32 s19, s19, 6
    s_add_u32 s18, s18, s19
    s_add_u32 s18, s18, 0x2000000
    s_add_u32 s19, s18, 16384
    v_lshrrev_b32 v18, 2, v1
    v_lshlrev_b32 v18, 10, v18
    v_and_b32 v19, 3, v1
    v_lshl_add_u32 v18, v19, 4, v18
    v_add_u32 v19, 0x400000, v18
    s_lshl_b32 s25, s30, 7
    s_add_u32 s25, s25, 0x530000
    v_and_b32 v20, 15, v1
    v_lshlrev_b32 v20, 2, v20
    s_waitcnt vmcnt(3)
    s_waitcnt vmcnt(0)
    s_barrier
    s_mov_b64 exec, 1
    buffer_store_dword v16, v17, s[8:11], s16 offen sc1
    s_mov_b64 exec, -1
    v_add_u32 v16, 81920, v2
    ds_read_b128 v[184:187], v16 offset:0
    ds_read_b128 v[188:191], v16 offset:1024
    ds_read_b128 v[192:195], v16 offset:2048
    ds_read_b128 v[196:199], v16 offset:3072
    ds_read_b128 v[200:203], v16 offset:4096
    ds_read_b128 v[204:207], v16 offset:5120
    ds_read_b128 v[208:211], v16 offset:6144
    ds_read_b128 v[212:215], v16 offset:7168
    v_mov_b32 v94, 0
    v_mov_b32 v95, 0
    s_waitcnt lgkmcnt(5)
    v_lshlrev_b32 v76, 16, v192
    v_and_b32 v77, 0xffff0000, v192
    s_waitcnt lgkmcnt(1)
    v_lshlrev_b32 v78, 16, v208
    v_and_b32 v79, 0xffff0000, v208
    v_pk_mul_f32 v[60:61], v[76:77], v[78:79]
    v_lshlrev_b32 v76, 16, v184
    v_and_b32 v77, 0xffff0000, v184
    v_fmac_f32 v94, v76, v78
    v_fmac_f32 v94, v77, v79
    v_add_f32 v95, v95, v60
    v_add_f32 v95, v95, v61
    v_lshlrev_b32 v76, 16, v193
    v_and_b32 v77, 0xffff0000, v193
    v_lshlrev_b32 v78, 16, v209
    v_and_b32 v79, 0xffff0000, v209
    v_pk_mul_f32 v[62:63], v[76:77], v[78:79]
    v_lshlrev_b32 v76, 16, v185
    v_and_b32 v77, 0xffff0000, v185
    v_fmac_f32 v94, v76, v78
    v_fmac_f32 v94, v77, v79
    v_add_f32 v95, v95, v62
    v_add_f32 v95, v95, v63
    v_lshlrev_b32 v76, 16, v194
    v_and_b32 v77, 0xffff0000, v194
    v_lshlrev_b32 v78, 16, v210
    v_and_b32 v79, 0xffff0000, v210
    v_pk_mul_f32 v[64:65], v[76:77], v[78:79]
    v_lshlrev_b32 v76, 16, v186
    v_and_b32 v77, 0xffff0000, v186
    v_fmac_f32 v94, v76, v78
    v_fmac_f32 v94, v77, v79
    v_add_f32 v95, v95, v64
    v_add_f32 v95, v95, v65
    v_lshlrev_b32 v76, 16, v195
    v_and_b32 v77, 0xffff0000, v195
    v_lshlrev_b32 v78, 16, v211
    v_and_b32 v79, 0xffff0000, v211
    v_pk_mul_f32 v[66:67], v[76:77], v[78:79]
    v_lshlrev_b32 v76, 16, v187
    v_and_b32 v77, 0xffff0000, v187
    v_fmac_f32 v94, v76, v78
    v_fmac_f32 v94, v77, v79
    v_add_f32 v95, v95, v66
    v_add_f32 v95, v95, v67
    v_lshlrev_b32 v76, 16, v196
    v_and_b32 v77, 0xffff0000, v196
    s_waitcnt lgkmcnt(0)
    v_lshlrev_b32 v78, 16, v212
    v_and_b32 v79, 0xffff0000, v212
    v_pk_mul_f32 v[68:69], v[76:77], v[78:79]
    v_lshlrev_b32 v76, 16, v188
    v_and_b32 v77, 0xffff0000, v188
    v_fmac_f32 v94, v76, v78
    v_fmac_f32 v94, v77, v79
    v_add_f32 v95, v95, v68
    v_add_f32 v95, v95, v69
    v_lshlrev_b32 v76, 16, v197
    v_and_b32 v77, 0xffff0000, v197
    v_lshlrev_b32 v78, 16, v213
    v_and_b32 v79, 0xffff0000, v213
    v_pk_mul_f32 v[70:71], v[76:77], v[78:79]
    v_lshlrev_b32 v76, 16, v189
    v_and_b32 v77, 0xffff0000, v189
    v_fmac_f32 v94, v76, v78
    v_fmac_f32 v94, v77, v79
    v_add_f32 v95, v95, v70
    v_add_f32 v95, v95, v71
    v_lshlrev_b32 v76, 16, v198
    v_and_b32 v77, 0xffff0000, v198
    v_lshlrev_b32 v78, 16, v214
    v_and_b32 v79, 0xffff0000, v214
    v_pk_mul_f32 v[72:73], v[76:77], v[78:79]
    v_lshlrev_b32 v76, 16, v190
    v_and_b32 v77, 0xffff0000, v190
    v_fmac_f32 v94, v76, v78
    v_fmac_f32 v94, v77, v79
    v_add_f32 v95, v95, v72
    v_add_f32 v95, v95, v73
    v_lshlrev_b32 v76, 16, v199
    v_and_b32 v77, 0xffff0000, v199
    v_lshlrev_b32 v78, 16, v215
    v_and_b32 v79, 0xffff0000, v215
    v_pk_mul_f32 v[74:75], v[76:77], v[78:79]
    v_lshlrev_b32 v76, 16, v191
    v_and_b32 v77, 0xffff0000, v191
    v_fmac_f32 v94, v76, v78
    v_fmac_f32 v94, v77, v79
    v_add_f32 v95, v95, v74
    v_add_f32 v95, v95, v75
    v_add_f32_dpp v94, v94, v94 row_ror:1 row_mask:0xf bank_mask:0xf
    s_nop 0
    v_add_f32_dpp v95, v95, v95 row_ror:1 row_mask:0xf bank_mask:0xf
    v_add_f32_dpp v94, v94, v94 row_ror:2 row_mask:0xf bank_mask:0xf
    s_nop 0
    v_add_f32_dpp v95, v95, v95 row_ror:2 row_mask:0xf bank_mask:0xf
    v_add_f32_dpp v94, v94, v94 row_ror:4 row_mask:0xf bank_mask:0xf
    s_nop 0
    v_add_f32_dpp v95, v95, v95 row_ror:4 row_mask:0xf bank_mask:0xf
    v_add_f32_dpp v94, v94, v94 row_ror:8 row_mask:0xf bank_mask:0xf
    s_nop 0
    v_add_f32_dpp v95, v95, v95 row_ror:8 row_mask:0xf bank_mask:0xf
    v_mov_b32 v76, v94
    s_nop 1
    v_permlane16_swap_b32 v94, v76
    v_add_f32 v94, v94, v76
    v_mov_b32 v77, v95
    s_nop 1
    v_permlane16_swap_b32 v95, v77
    v_add_f32 v95, v95, v77
    v_mov_b32 v76, v94
    s_nop 1
    v_permlane32_swap_b32 v94, v76
    v_add_f32 v94, v94, v76
    v_mov_b32 v77, v95
    s_nop 1
    v_permlane32_swap_b32 v95, v77
    v_add_f32 v95, v95, v77
    v_lshlrev_b32 v28, 16, v216
    v_and_b32 v29, 0xffff0000, v216
    v_lshlrev_b32 v30, 16, v217
    v_and_b32 v31, 0xffff0000, v217
    v_lshlrev_b32 v32, 16, v218
    v_and_b32 v33, 0xffff0000, v218
    v_lshlrev_b32 v34, 16, v219
    v_and_b32 v35, 0xffff0000, v219
    v_lshlrev_b32 v36, 16, v220
    v_and_b32 v37, 0xffff0000, v220
    v_lshlrev_b32 v38, 16, v221
    v_and_b32 v39, 0xffff0000, v221
    v_lshlrev_b32 v40, 16, v222
    v_and_b32 v41, 0xffff0000, v222
    v_lshlrev_b32 v42, 16, v223
    v_and_b32 v43, 0xffff0000, v223
    s_mov_b32 s27, 0
adaLN_cond__sliding_block_cached__moe_arch_mod__prompt_kernel_a11p:
    buffer_load_dword v76, v20, s[8:11], s25 offen sc1
    s_waitcnt vmcnt(0)
    v_cmp_ne_u32 vcc, s28, v76
    s_add_u32 s27, s27, 1
    s_cmp_ge_u32 s27, 65536
    s_cbranch_scc1 adaLN_cond__sliding_block_cached__moe_arch_mod__prompt_kernel_a11g
    s_cbranch_vccnz adaLN_cond__sliding_block_cached__moe_arch_mod__prompt_kernel_a11p
adaLN_cond__sliding_block_cached__moe_arch_mod__prompt_kernel_a11g:
    buffer_load_dwordx4 v[44:47], v18, s[8:11], s18 offen sc1
    buffer_load_dwordx4 v[52:55], v19, s[8:11], s18 offen sc1
    buffer_load_dwordx4 v[48:51], v18, s[8:11], s19 offen sc1
    buffer_load_dwordx4 v[56:59], v19, s[8:11], s19 offen sc1
    v_lshlrev_b32 v21, 2, v0
    s_mov_b32 s16, 0x540800
    buffer_load_dword v106, v21, s[8:11], s16 offen sc1
    buffer_load_dword v104, v21, s[8:11], s16 offen offset:2048 sc1
    s_waitcnt vmcnt(5)
    v_lshlrev_b32 v76, 16, v44
    v_and_b32 v77, 0xffff0000, v44
    s_waitcnt vmcnt(4)
    v_lshlrev_b32 v78, 16, v52
    v_and_b32 v79, 0xffff0000, v52
    v_pk_add_f32 v[76:77], v[76:77], v[78:79]
    v_pk_add_f32 v[28:29], v[28:29], v[76:77]
    v_cvt_pk_bf16_f32 v16, v28, v29
    v_lshlrev_b32 v28, 16, v16
    v_and_b32 v29, 0xffff0000, v16
    v_lshlrev_b32 v80, 16, v45
    v_and_b32 v81, 0xffff0000, v45
    v_lshlrev_b32 v82, 16, v53
    v_and_b32 v83, 0xffff0000, v53
    v_pk_add_f32 v[80:81], v[80:81], v[82:83]
    v_pk_add_f32 v[30:31], v[30:31], v[80:81]
    v_cvt_pk_bf16_f32 v17, v30, v31
    v_lshlrev_b32 v30, 16, v17
    v_and_b32 v31, 0xffff0000, v17
    v_lshlrev_b32 v76, 16, v46
    v_and_b32 v77, 0xffff0000, v46
    v_lshlrev_b32 v78, 16, v54
    v_and_b32 v79, 0xffff0000, v54
    v_pk_add_f32 v[76:77], v[76:77], v[78:79]
    v_pk_add_f32 v[32:33], v[32:33], v[76:77]
    v_cvt_pk_bf16_f32 v16, v32, v33
    v_lshlrev_b32 v32, 16, v16
    v_and_b32 v33, 0xffff0000, v16
    v_lshlrev_b32 v80, 16, v47
    v_and_b32 v81, 0xffff0000, v47
    v_lshlrev_b32 v82, 16, v55
    v_and_b32 v83, 0xffff0000, v55
    v_pk_add_f32 v[80:81], v[80:81], v[82:83]
    v_pk_add_f32 v[34:35], v[34:35], v[80:81]
    v_cvt_pk_bf16_f32 v17, v34, v35
    v_lshlrev_b32 v34, 16, v17
    v_and_b32 v35, 0xffff0000, v17
    s_waitcnt vmcnt(3)
    v_lshlrev_b32 v76, 16, v48
    v_and_b32 v77, 0xffff0000, v48
    s_waitcnt vmcnt(2)
    v_lshlrev_b32 v78, 16, v56
    v_and_b32 v79, 0xffff0000, v56
    v_pk_add_f32 v[76:77], v[76:77], v[78:79]
    v_pk_add_f32 v[36:37], v[36:37], v[76:77]
    v_cvt_pk_bf16_f32 v16, v36, v37
    v_lshlrev_b32 v36, 16, v16
    v_and_b32 v37, 0xffff0000, v16
    v_lshlrev_b32 v80, 16, v49
    v_and_b32 v81, 0xffff0000, v49
    v_lshlrev_b32 v82, 16, v57
    v_and_b32 v83, 0xffff0000, v57
    v_pk_add_f32 v[80:81], v[80:81], v[82:83]
    v_pk_add_f32 v[38:39], v[38:39], v[80:81]
    v_cvt_pk_bf16_f32 v17, v38, v39
    v_lshlrev_b32 v38, 16, v17
    v_and_b32 v39, 0xffff0000, v17
    v_lshlrev_b32 v76, 16, v50
    v_and_b32 v77, 0xffff0000, v50
    v_lshlrev_b32 v78, 16, v58
    v_and_b32 v79, 0xffff0000, v58
    v_pk_add_f32 v[76:77], v[76:77], v[78:79]
    v_pk_add_f32 v[40:41], v[40:41], v[76:77]
    v_cvt_pk_bf16_f32 v16, v40, v41
    v_lshlrev_b32 v40, 16, v16
    v_and_b32 v41, 0xffff0000, v16
    v_lshlrev_b32 v80, 16, v51
    v_and_b32 v81, 0xffff0000, v51
    v_lshlrev_b32 v82, 16, v59
    v_and_b32 v83, 0xffff0000, v59
    v_pk_add_f32 v[80:81], v[80:81], v[82:83]
    v_pk_add_f32 v[42:43], v[42:43], v[80:81]
    v_cvt_pk_bf16_f32 v17, v42, v43
    v_lshlrev_b32 v42, 16, v17
    v_and_b32 v43, 0xffff0000, v17
    v_pk_add_f32 v[76:77], v[28:29], v[30:31]
    v_pk_mul_f32 v[78:79], v[28:29], v[28:29]
    v_pk_mul_f32 v[80:81], v[28:29], v[60:61]
    v_pk_fma_f32 v[78:79], v[30:31], v[30:31], v[78:79]
    v_pk_fma_f32 v[80:81], v[30:31], v[62:63], v[80:81]
    v_pk_add_f32 v[76:77], v[76:77], v[32:33]
    v_pk_fma_f32 v[78:79], v[32:33], v[32:33], v[78:79]
    v_pk_fma_f32 v[80:81], v[32:33], v[64:65], v[80:81]
    v_pk_add_f32 v[76:77], v[76:77], v[34:35]
    v_pk_fma_f32 v[78:79], v[34:35], v[34:35], v[78:79]
    v_pk_fma_f32 v[80:81], v[34:35], v[66:67], v[80:81]
    v_pk_add_f32 v[76:77], v[76:77], v[36:37]
    v_pk_fma_f32 v[78:79], v[36:37], v[36:37], v[78:79]
    v_pk_fma_f32 v[80:81], v[36:37], v[68:69], v[80:81]
    v_pk_add_f32 v[76:77], v[76:77], v[38:39]
    v_pk_fma_f32 v[78:79], v[38:39], v[38:39], v[78:79]
    v_pk_fma_f32 v[80:81], v[38:39], v[70:71], v[80:81]
    v_pk_add_f32 v[76:77], v[76:77], v[40:41]
    v_pk_fma_f32 v[78:79], v[40:41], v[40:41], v[78:79]
    v_pk_fma_f32 v[80:81], v[40:41], v[72:73], v[80:81]
    v_pk_add_f32 v[76:77], v[76:77], v[42:43]
    v_pk_fma_f32 v[78:79], v[42:43], v[42:43], v[78:79]
    v_pk_fma_f32 v[80:81], v[42:43], v[74:75], v[80:81]
    v_add_f32 v96, v76, v77
    v_add_f32 v97, v78, v79
    v_add_f32 v98, v80, v81
    v_add_f32_dpp v96, v96, v96 row_ror:1 row_mask:0xf bank_mask:0xf
    v_add_f32_dpp v97, v97, v97 row_ror:1 row_mask:0xf bank_mask:0xf
    v_add_f32_dpp v98, v98, v98 row_ror:1 row_mask:0xf bank_mask:0xf
    v_add_f32_dpp v96, v96, v96 row_ror:2 row_mask:0xf bank_mask:0xf
    v_add_f32_dpp v97, v97, v97 row_ror:2 row_mask:0xf bank_mask:0xf
    v_add_f32_dpp v98, v98, v98 row_ror:2 row_mask:0xf bank_mask:0xf
    v_add_f32_dpp v96, v96, v96 row_ror:4 row_mask:0xf bank_mask:0xf
    v_add_f32_dpp v97, v97, v97 row_ror:4 row_mask:0xf bank_mask:0xf
    v_add_f32_dpp v98, v98, v98 row_ror:4 row_mask:0xf bank_mask:0xf
    v_add_f32_dpp v96, v96, v96 row_ror:8 row_mask:0xf bank_mask:0xf
    v_add_f32_dpp v97, v97, v97 row_ror:8 row_mask:0xf bank_mask:0xf
    v_add_f32_dpp v98, v98, v98 row_ror:8 row_mask:0xf bank_mask:0xf
    v_mov_b32 v76, v96
    s_nop 1
    v_permlane16_swap_b32 v96, v76
    v_add_f32 v96, v96, v76
    v_mov_b32 v77, v97
    s_nop 1
    v_permlane16_swap_b32 v97, v77
    v_add_f32 v97, v97, v77
    v_mov_b32 v78, v98
    s_nop 1
    v_permlane16_swap_b32 v98, v78
    v_add_f32 v98, v98, v78
    v_mov_b32 v76, v96
    s_nop 1
    v_permlane32_swap_b32 v96, v76
    v_add_f32 v96, v96, v76
    v_mov_b32 v77, v97
    s_nop 1
    v_permlane32_swap_b32 v97, v77
    v_add_f32 v97, v97, v77
    v_mov_b32 v78, v98
    s_nop 1
    v_permlane32_swap_b32 v98, v78
    v_add_f32 v98, v98, v78
    v_mul_f32 v96, 0x3a800000, v96
    v_mul_f32 v97, 0x3a800000, v97
    v_fma_f32 v97, -v96, v96, v97
    v_max_f32 v97, 0, v97
    v_fma_f32 v98, -v96, v95, v98
    v_add_f32 v76, 0x3727c5ac, v97
    v_rsq_f32 v76, v76
    s_nop 0
    v_fma_f32 v27, v98, v76, v94
    v_cvt_pk_bf16_f32 v96, v96, v96
    v_lshlrev_b32 v96, 16, v96
    v_cvt_pk_bf16_f32 v97, v97, v97
    v_lshlrev_b32 v97, 16, v97
    v_add_f32 v97, 0x3727c5ac, v97
    v_cvt_pk_bf16_f32 v97, v97, v97
    v_lshlrev_b32 v97, 16, v97
    v_sqrt_f32 v98, v97
    s_nop 0
    v_cvt_pk_bf16_f32 v98, v98, v98
    v_lshlrev_b32 v98, 16, v98
    v_rcp_f32 v99, v98
    v_mov_b32 v25, v96
    v_mov_b32 v26, v98
    v_ashrrev_i32 v16, 31, v27
    v_or_b32 v16, 0x80000000, v16
    v_xor_b32 v24, v27, v16
    v_and_b32 v24, 0xfffff800, v24
    v_max_u32 v24, 0x800, v24
    s_sub_u32 s16, 2047, s14
    v_or_b32 v24, s16, v24
    s_lshl_b32 s16, s3, 4
    s_add_u32 s16, s16, 65536
    v_mov_b32 v16, s16
    ds_write_b128 v16, v[24:27]
    s_waitcnt lgkmcnt(0)
    s_barrier
    v_and_b32 v16, 7, v1
    v_lshlrev_b32 v16, 4, v16
    v_add_u32 v16, 65536, v16
    ds_read_b32 v76, v16
    s_waitcnt lgkmcnt(0)
    v_mov_b32 v77, v76
    s_nop 1
    v_max_u32_dpp v77, v77, v77 row_ror:1 row_mask:0xf bank_mask:0xf
    s_nop 1
    v_max_u32_dpp v77, v77, v77 row_ror:2 row_mask:0xf bank_mask:0xf
    s_nop 1
    v_max_u32_dpp v77, v77, v77 row_ror:4 row_mask:0xf bank_mask:0xf
    v_cmp_eq_u32 vcc, v76, v77
    s_ff1_i32_b64 s16, vcc
    s_lshl_b32 s16, s16, 4
    s_add_u32 s16, s16, 65536
    v_mov_b32 v16, s16
    ds_read_b128 v[24:27], v16
    s_lshl_b32 s16, s2, 4
    s_add_u32 s16, s16, 0x6e0000
    s_cmp_eq_u32 s3, 0
    s_cselect_b32 s16, s16, 0x7ffffff0
    v_mov_b32 v17, 0
    s_mov_b64 exec, 1
    s_waitcnt lgkmcnt(0)
    buffer_store_dwordx4 v[24:27], v17, s[8:11], s16 offen sc1
    s_mov_b64 exec, -1
    v_sub_f32 v44, v28, v96
    v_sub_f32 v45, v29, v96
    v_sub_f32 v46, v30, v96
    v_sub_f32 v47, v31, v96
    v_sub_f32 v48, v32, v96
    v_sub_f32 v49, v33, v96
    v_sub_f32 v50, v34, v96
    v_sub_f32 v51, v35, v96
    v_cvt_pk_bf16_f32 v16, v44, v45
    v_lshlrev_b32 v44, 16, v16
    v_and_b32 v45, 0xffff0000, v16
    v_cvt_pk_bf16_f32 v16, v46, v47
    v_lshlrev_b32 v46, 16, v16
    v_and_b32 v47, 0xffff0000, v16
    v_cvt_pk_bf16_f32 v16, v48, v49
    v_lshlrev_b32 v48, 16, v16
    v_and_b32 v49, 0xffff0000, v16
    v_cvt_pk_bf16_f32 v16, v50, v51
    v_lshlrev_b32 v50, 16, v16
    v_and_b32 v51, 0xffff0000, v16
    v_mul_f32 v52, v44, v99
    v_mul_f32 v53, v45, v99
    v_mul_f32 v54, v46, v99
    v_mul_f32 v55, v47, v99
    v_mul_f32 v56, v48, v99
    v_mul_f32 v57, v49, v99
    v_mul_f32 v58, v50, v99
    v_mul_f32 v59, v51, v99
    v_fma_f32 v44, -v52, v98, v44
    v_fma_f32 v45, -v53, v98, v45
    v_fma_f32 v46, -v54, v98, v46
    v_fma_f32 v47, -v55, v98, v47
    v_fma_f32 v48, -v56, v98, v48
    v_fma_f32 v49, -v57, v98, v49
    v_fma_f32 v50, -v58, v98, v50
    v_fma_f32 v51, -v59, v98, v51
    v_fma_f32 v44, v44, v99, v52
    v_fma_f32 v45, v45, v99, v53
    v_fma_f32 v46, v46, v99, v54
    v_fma_f32 v47, v47, v99, v55
    v_fma_f32 v48, v48, v99, v56
    v_fma_f32 v49, v49, v99, v57
    v_fma_f32 v50, v50, v99, v58
    v_fma_f32 v51, v51, v99, v59
    v_cvt_pk_bf16_f32 v16, v44, v45
    v_lshlrev_b32 v44, 16, v16
    v_and_b32 v45, 0xffff0000, v16
    v_cvt_pk_bf16_f32 v16, v46, v47
    v_lshlrev_b32 v46, 16, v16
    v_and_b32 v47, 0xffff0000, v16
    v_cvt_pk_bf16_f32 v16, v48, v49
    v_lshlrev_b32 v48, 16, v16
    v_and_b32 v49, 0xffff0000, v16
    v_cvt_pk_bf16_f32 v16, v50, v51
    v_lshlrev_b32 v50, 16, v16
    v_and_b32 v51, 0xffff0000, v16
    v_lshlrev_b32 v52, 16, v192
    v_and_b32 v53, 0xffff0000, v192
    v_lshlrev_b32 v54, 16, v193
    v_and_b32 v55, 0xffff0000, v193
    v_lshlrev_b32 v56, 16, v194
    v_and_b32 v57, 0xffff0000, v194
    v_lshlrev_b32 v58, 16, v195
    v_and_b32 v59, 0xffff0000, v195
    v_pk_mul_f32 v[44:45], v[44:45], v[52:53]
    v_pk_mul_f32 v[46:47], v[46:47], v[54:55]
    v_pk_mul_f32 v[48:49], v[48:49], v[56:57]
    v_pk_mul_f32 v[50:51], v[50:51], v[58:59]
    v_cvt_pk_bf16_f32 v16, v44, v45
    v_lshlrev_b32 v44, 16, v16
    v_and_b32 v45, 0xffff0000, v16
    v_cvt_pk_bf16_f32 v16, v46, v47
    v_lshlrev_b32 v46, 16, v16
    v_and_b32 v47, 0xffff0000, v16
    v_cvt_pk_bf16_f32 v16, v48, v49
    v_lshlrev_b32 v48, 16, v16
    v_and_b32 v49, 0xffff0000, v16
    v_cvt_pk_bf16_f32 v16, v50, v51
    v_lshlrev_b32 v50, 16, v16
    v_and_b32 v51, 0xffff0000, v16
    v_lshlrev_b32 v52, 16, v184
    v_and_b32 v53, 0xffff0000, v184
    v_lshlrev_b32 v54, 16, v185
    v_and_b32 v55, 0xffff0000, v185
    v_lshlrev_b32 v56, 16, v186
    v_and_b32 v57, 0xffff0000, v186
    v_lshlrev_b32 v58, 16, v187
    v_and_b32 v59, 0xffff0000, v187
    v_pk_add_f32 v[44:45], v[44:45], v[52:53]
    v_pk_add_f32 v[46:47], v[46:47], v[54:55]
    v_pk_add_f32 v[48:49], v[48:49], v[56:57]
    v_pk_add_f32 v[50:51], v[50:51], v[58:59]
    v_cvt_pk_bf16_f32 v16, v44, v45
    v_lshlrev_b32 v44, 16, v16
    v_and_b32 v45, 0xffff0000, v16
    v_cvt_pk_bf16_f32 v16, v46, v47
    v_lshlrev_b32 v46, 16, v16
    v_and_b32 v47, 0xffff0000, v16
    v_cvt_pk_bf16_f32 v16, v48, v49
    v_lshlrev_b32 v48, 16, v16
    v_and_b32 v49, 0xffff0000, v16
    v_cvt_pk_bf16_f32 v16, v50, v51
    v_lshlrev_b32 v50, 16, v16
    v_and_b32 v51, 0xffff0000, v16
    v_lshlrev_b32 v52, 16, v200
    v_and_b32 v53, 0xffff0000, v200
    v_lshlrev_b32 v54, 16, v201
    v_and_b32 v55, 0xffff0000, v201
    v_lshlrev_b32 v56, 16, v202
    v_and_b32 v57, 0xffff0000, v202
    v_lshlrev_b32 v58, 16, v203
    v_and_b32 v59, 0xffff0000, v203
    v_pk_mul_f32 v[44:45], v[44:45], v[52:53]
    v_pk_mul_f32 v[46:47], v[46:47], v[54:55]
    v_pk_mul_f32 v[48:49], v[48:49], v[56:57]
    v_pk_mul_f32 v[50:51], v[50:51], v[58:59]
    v_cvt_pk_bf16_f32 v16, v44, v45
    v_lshlrev_b32 v44, 16, v16
    v_and_b32 v45, 0xffff0000, v16
    v_cvt_pk_bf16_f32 v16, v46, v47
    v_lshlrev_b32 v46, 16, v16
    v_and_b32 v47, 0xffff0000, v16
    v_cvt_pk_bf16_f32 v16, v48, v49
    v_lshlrev_b32 v48, 16, v16
    v_and_b32 v49, 0xffff0000, v16
    v_cvt_pk_bf16_f32 v16, v50, v51
    v_lshlrev_b32 v50, 16, v16
    v_and_b32 v51, 0xffff0000, v16
    v_pk_add_f32 v[44:45], v[44:45], v[28:29]
    v_pk_add_f32 v[46:47], v[46:47], v[30:31]
    v_pk_add_f32 v[48:49], v[48:49], v[32:33]
    v_pk_add_f32 v[50:51], v[50:51], v[34:35]
    v_cvt_pk_bf16_f32 v28, v44, v45
    v_cvt_pk_bf16_f32 v29, v46, v47
    v_cvt_pk_bf16_f32 v30, v48, v49
    v_cvt_pk_bf16_f32 v31, v50, v51
    v_sub_f32 v44, v36, v96
    v_sub_f32 v45, v37, v96
    v_sub_f32 v46, v38, v96
    v_sub_f32 v47, v39, v96
    v_sub_f32 v48, v40, v96
    v_sub_f32 v49, v41, v96
    v_sub_f32 v50, v42, v96
    v_sub_f32 v51, v43, v96
    v_cvt_pk_bf16_f32 v16, v44, v45
    v_lshlrev_b32 v44, 16, v16
    v_and_b32 v45, 0xffff0000, v16
    v_cvt_pk_bf16_f32 v16, v46, v47
    v_lshlrev_b32 v46, 16, v16
    v_and_b32 v47, 0xffff0000, v16
    v_cvt_pk_bf16_f32 v16, v48, v49
    v_lshlrev_b32 v48, 16, v16
    v_and_b32 v49, 0xffff0000, v16
    v_cvt_pk_bf16_f32 v16, v50, v51
    v_lshlrev_b32 v50, 16, v16
    v_and_b32 v51, 0xffff0000, v16
    v_mul_f32 v52, v44, v99
    v_mul_f32 v53, v45, v99
    v_mul_f32 v54, v46, v99
    v_mul_f32 v55, v47, v99
    v_mul_f32 v56, v48, v99
    v_mul_f32 v57, v49, v99
    v_mul_f32 v58, v50, v99
    v_mul_f32 v59, v51, v99
    v_fma_f32 v44, -v52, v98, v44
    v_fma_f32 v45, -v53, v98, v45
    v_fma_f32 v46, -v54, v98, v46
    v_fma_f32 v47, -v55, v98, v47
    v_fma_f32 v48, -v56, v98, v48
    v_fma_f32 v49, -v57, v98, v49
    v_fma_f32 v50, -v58, v98, v50
    v_fma_f32 v51, -v59, v98, v51
    v_fma_f32 v44, v44, v99, v52
    v_fma_f32 v45, v45, v99, v53
    v_fma_f32 v46, v46, v99, v54
    v_fma_f32 v47, v47, v99, v55
    v_fma_f32 v48, v48, v99, v56
    v_fma_f32 v49, v49, v99, v57
    v_fma_f32 v50, v50, v99, v58
    v_fma_f32 v51, v51, v99, v59
    v_cvt_pk_bf16_f32 v16, v44, v45
    v_lshlrev_b32 v44, 16, v16
    v_and_b32 v45, 0xffff0000, v16
    v_cvt_pk_bf16_f32 v16, v46, v47
    v_lshlrev_b32 v46, 16, v16
    v_and_b32 v47, 0xffff0000, v16
    v_cvt_pk_bf16_f32 v16, v48, v49
    v_lshlrev_b32 v48, 16, v16
    v_and_b32 v49, 0xffff0000, v16
    v_cvt_pk_bf16_f32 v16, v50, v51
    v_lshlrev_b32 v50, 16, v16
    v_and_b32 v51, 0xffff0000, v16
    v_lshlrev_b32 v52, 16, v196
    v_and_b32 v53, 0xffff0000, v196
    v_lshlrev_b32 v54, 16, v197
    v_and_b32 v55, 0xffff0000, v197
    v_lshlrev_b32 v56, 16, v198
    v_and_b32 v57, 0xffff0000, v198
    v_lshlrev_b32 v58, 16, v199
    v_and_b32 v59, 0xffff0000, v199
    v_pk_mul_f32 v[44:45], v[44:45], v[52:53]
    v_pk_mul_f32 v[46:47], v[46:47], v[54:55]
    v_pk_mul_f32 v[48:49], v[48:49], v[56:57]
    v_pk_mul_f32 v[50:51], v[50:51], v[58:59]
    v_cvt_pk_bf16_f32 v16, v44, v45
    v_lshlrev_b32 v44, 16, v16
    v_and_b32 v45, 0xffff0000, v16
    v_cvt_pk_bf16_f32 v16, v46, v47
    v_lshlrev_b32 v46, 16, v16
    v_and_b32 v47, 0xffff0000, v16
    v_cvt_pk_bf16_f32 v16, v48, v49
    v_lshlrev_b32 v48, 16, v16
    v_and_b32 v49, 0xffff0000, v16
    v_cvt_pk_bf16_f32 v16, v50, v51
    v_lshlrev_b32 v50, 16, v16
    v_and_b32 v51, 0xffff0000, v16
    v_lshlrev_b32 v52, 16, v188
    v_and_b32 v53, 0xffff0000, v188
    v_lshlrev_b32 v54, 16, v189
    v_and_b32 v55, 0xffff0000, v189
    v_lshlrev_b32 v56, 16, v190
    v_and_b32 v57, 0xffff0000, v190
    v_lshlrev_b32 v58, 16, v191
    v_and_b32 v59, 0xffff0000, v191
    v_pk_add_f32 v[44:45], v[44:45], v[52:53]
    v_pk_add_f32 v[46:47], v[46:47], v[54:55]
    v_pk_add_f32 v[48:49], v[48:49], v[56:57]
    v_pk_add_f32 v[50:51], v[50:51], v[58:59]
    v_cvt_pk_bf16_f32 v16, v44, v45
    v_lshlrev_b32 v44, 16, v16
    v_and_b32 v45, 0xffff0000, v16
    v_cvt_pk_bf16_f32 v16, v46, v47
    v_lshlrev_b32 v46, 16, v16
    v_and_b32 v47, 0xffff0000, v16
    v_cvt_pk_bf16_f32 v16, v48, v49
    v_lshlrev_b32 v48, 16, v16
    v_and_b32 v49, 0xffff0000, v16
    v_cvt_pk_bf16_f32 v16, v50, v51
    v_lshlrev_b32 v50, 16, v16
    v_and_b32 v51, 0xffff0000, v16
    v_lshlrev_b32 v52, 16, v204
    v_and_b32 v53, 0xffff0000, v204
    v_lshlrev_b32 v54, 16, v205
    v_and_b32 v55, 0xffff0000, v205
    v_lshlrev_b32 v56, 16, v206
    v_and_b32 v57, 0xffff0000, v206
    v_lshlrev_b32 v58, 16, v207
    v_and_b32 v59, 0xffff0000, v207
    v_pk_mul_f32 v[44:45], v[44:45], v[52:53]
    v_pk_mul_f32 v[46:47], v[46:47], v[54:55]
    v_pk_mul_f32 v[48:49], v[48:49], v[56:57]
    v_pk_mul_f32 v[50:51], v[50:51], v[58:59]
    v_cvt_pk_bf16_f32 v16, v44, v45
    v_lshlrev_b32 v44, 16, v16
    v_and_b32 v45, 0xffff0000, v16
    v_cvt_pk_bf16_f32 v16, v46, v47
    v_lshlrev_b32 v46, 16, v16
    v_and_b32 v47, 0xffff0000, v16
    v_cvt_pk_bf16_f32 v16, v48, v49
    v_lshlrev_b32 v48, 16, v16
    v_and_b32 v49, 0xffff0000, v16
    v_cvt_pk_bf16_f32 v16, v50, v51
    v_lshlrev_b32 v50, 16, v16
    v_and_b32 v51, 0xffff0000, v16
    v_pk_add_f32 v[44:45], v[44:45], v[36:37]
    v_pk_add_f32 v[46:47], v[46:47], v[38:39]
    v_pk_add_f32 v[48:49], v[48:49], v[40:41]
    v_pk_add_f32 v[50:51], v[50:51], v[42:43]
    v_cvt_pk_bf16_f32 v36, v44, v45
    v_cvt_pk_bf16_f32 v37, v46, v47
    v_cvt_pk_bf16_f32 v38, v48, v49
    v_cvt_pk_bf16_f32 v39, v50, v51
    v_lshlrev_b32 v18, 4, v0
    s_mov_b32 s16, 0x6e0000
    s_mov_b32 s27, 0
adaLN_cond__sliding_block_cached__moe_arch_mod__prompt_kernel_w12p:
    buffer_load_dwordx4 v[24:27], v18, s[8:11], s16 offen sc1
    s_waitcnt vmcnt(0)
    v_cmp_eq_u32 vcc, 0, v24
    s_add_u32 s27, s27, 1
    s_cmp_ge_u32 s27, 65536
    s_cbranch_scc1 adaLN_cond__sliding_block_cached__moe_arch_mod__prompt_kernel_w12g
    s_cbranch_vccnz adaLN_cond__sliding_block_cached__moe_arch_mod__prompt_kernel_w12p
adaLN_cond__sliding_block_cached__moe_arch_mod__prompt_kernel_w12g:
    v_mov_b32 v76, v24
    s_nop 1
    v_max_u32_dpp v76, v76, v76 row_ror:1 row_mask:0xf bank_mask:0xf
    s_nop 1
    v_max_u32_dpp v76, v76, v76 row_ror:2 row_mask:0xf bank_mask:0xf
    s_nop 1
    v_max_u32_dpp v76, v76, v76 row_ror:4 row_mask:0xf bank_mask:0xf
    s_nop 1
    v_max_u32_dpp v76, v76, v76 row_ror:8 row_mask:0xf bank_mask:0xf
    v_mov_b32 v77, v76
    s_nop 1
    v_permlane16_swap_b32 v76, v77
    v_max_u32 v76, v76, v77
    v_mov_b32 v77, v76
    s_nop 1
    v_permlane32_swap_b32 v76, v77
    v_max_u32 v76, v76, v77
    v_cmp_eq_u32 vcc, v76, v24
    s_lshl_b32 s16, s3, 4
    s_add_u32 s16, s16, 65792
    v_mov_b32 v16, s16
    s_and_saveexec_b64 s[62:63], vcc
    ds_write_b128 v16, v[24:27]
    s_mov_b64 exec, s[62:63]
    s_waitcnt lgkmcnt(0)
    s_barrier
    v_and_b32 v16, 3, v1
    v_lshlrev_b32 v16, 4, v16
    v_add_u32 v16, 65792, v16
    ds_read_b32 v76, v16
    s_waitcnt lgkmcnt(0)
    v_mov_b32 v77, v76
    s_nop 1
    v_max_u32_dpp v77, v77, v77 row_ror:1 row_mask:0xf bank_mask:0xf
    s_nop 1
    v_max_u32_dpp v77, v77, v77 row_ror:2 row_mask:0xf bank_mask:0xf
    v_cmp_eq_u32 vcc, v76, v77
    s_ff1_i32_b64 s16, vcc
    s_lshl_b32 s16, s16, 4
    s_add_u32 s16, s16, 65792
    v_mov_b32 v16, s16
    ds_read_b128 v[24:27], v16
    s_waitcnt lgkmcnt(0)
    v_and_b32 v76, 0x7ff, v24
    v_sub_u32 v76, 2047, v76
    s_nop 0
    v_readfirstlane_b32 s12, v76
    v_rcp_f32 v103, v26
    s_lshr_b32 s18, s12, 4
    s_lshl_b32 s18, s18, 15
    s_and_b32 s19, s12, 15
    s_lshl_b32 s19, s19, 6
    s_add_u32 s18, s18, s19
    s_add_u32 s18, s18, 0x2000000
    s_add_u32 s19, s18, 0x400000
    v_lshrrev_b32 v18, 4, v0
    v_lshlrev_b32 v18, 10, v18
    v_and_b32 v19, 15, v0
    v_lshl_add_u32 v18, v19, 2, v18
    s_lshl_b32 s13, s12, 11
    buffer_load_dword v100, v18, s[8:11], s18 offen sc1
    buffer_load_dword v101, v18, s[8:11], s19 offen sc1
    buffer_load_dword v102, v21, s[76:79], s13 offen
    s_lshl_b32 s16, s14, 11
    s_cmp_lg_u32 s12, s14
    s_cselect_b32 s16, s16, 0x7ffffff0
    buffer_store_dwordx4 v[28:31], v2, s[68:71], s16 offen offset:0 sc1
    buffer_store_dwordx4 v[36:39], v2, s[68:71], s16 offen offset:1024 sc1
    s_lshl_b32 s16, s3, 13
    v_add_u32 v20, s16, v2
    s_waitcnt vmcnt(4)
    v_lshlrev_b32 v76, 16, v100
    v_and_b32 v77, 0xffff0000, v100
    s_waitcnt vmcnt(3)
    v_lshlrev_b32 v78, 16, v101
    v_and_b32 v79, 0xffff0000, v101
    v_pk_add_f32 v[76:77], v[76:77], v[78:79]
    s_waitcnt vmcnt(2)
    v_lshlrev_b32 v78, 16, v102
    v_and_b32 v79, 0xffff0000, v102
    v_pk_add_f32 v[92:93], v[78:79], v[76:77]
    v_cvt_pk_bf16_f32 v76, v92, v93
    v_lshlrev_b32 v92, 16, v76
    v_and_b32 v93, 0xffff0000, v76
    v_cvt_pk_bf16_f32 v100, v92, v93
    v_and_b32 v105, 0xffff0000, v104
    v_lshlrev_b32 v104, 16, v104
    v_and_b32 v107, 0xffff0000, v106
    v_lshlrev_b32 v106, 16, v106
    v_sub_f32 v92, v92, v25
    v_sub_f32 v93, v93, v25
    v_cvt_pk_bf16_f32 v76, v92, v93
    v_lshlrev_b32 v92, 16, v76
    v_and_b32 v93, 0xffff0000, v76
    v_mul_f32 v77, v92, v103
    v_fma_f32 v92, -v77, v26, v92
    v_fma_f32 v92, v92, v103, v77
    v_mul_f32 v77, v93, v103
    v_fma_f32 v93, -v77, v26, v93
    v_fma_f32 v93, v93, v103, v77
    v_cvt_pk_bf16_f32 v76, v92, v93
    v_lshlrev_b32 v92, 16, v76
    v_and_b32 v93, 0xffff0000, v76
    v_mul_f32 v92, v92, v104
    v_mul_f32 v93, v93, v105
    v_cvt_pk_bf16_f32 v76, v92, v93
    v_lshlrev_b32 v92, 16, v76
    v_and_b32 v93, 0xffff0000, v76
    v_add_f32 v92, v92, v106
    v_add_f32 v93, v93, v107
    v_cvt_pk_bf16_f32 v101, v92, v93
    v_add_u32 v16, 66560, v21
    ds_write_b32 v16, v101
    ds_write_b32 v16, v100 offset:2048
    s_waitcnt lgkmcnt(0)
    s_barrier
    ds_read_b128 v[60:63], v20 offset:0
    ds_read_b128 v[64:67], v20 offset:1024
    ds_read_b128 v[68:71], v20 offset:2048
    ds_read_b128 v[72:75], v20 offset:3072
    ds_read_b128 v[108:111], v20 offset:4096
    ds_read_b128 v[112:115], v20 offset:5120
    ds_read_b128 v[116:119], v20 offset:6144
    ds_read_b128 v[120:123], v20 offset:7168
    s_and_b32 s16, s3, 3
    s_lshl_b32 s16, s16, 7
    s_and_b32 s17, s29, 3
    s_lshl_b32 s17, s17, 9
    s_add_u32 s16, s16, s17
    s_add_u32 s16, s16, 66560
    v_lshrrev_b32 v16, 3, v1
    v_lshlrev_b32 v16, 4, v16
    v_add_u32 v16, s16, v16
    ds_read_b128 v[104:107], v16
    s_waitcnt lgkmcnt(0)
    v_lshlrev_b32 v76, 16, v104
    v_and_b32 v77, 0xffff, v104
    v_dot2_f32_bf16 v85, v60, v76, 0
    v_dot2_f32_bf16 v84, v60, v77, 0
    v_dot2_f32_bf16 v87, v61, v76, 0
    v_dot2_f32_bf16 v86, v61, v77, 0
    v_dot2_f32_bf16 v89, v62, v76, 0
    v_dot2_f32_bf16 v88, v62, v77, 0
    v_dot2_f32_bf16 v91, v63, v76, 0
    v_dot2_f32_bf16 v90, v63, v77, 0
    v_and_b32 v78, 0xffff0000, v104
    v_lshrrev_b32 v79, 16, v104
    v_dot2c_f32_bf16 v85, v64, v78
    v_dot2c_f32_bf16 v84, v64, v79
    v_dot2c_f32_bf16 v87, v65, v78
    v_dot2c_f32_bf16 v86, v65, v79
    v_dot2c_f32_bf16 v89, v66, v78
    v_dot2c_f32_bf16 v88, v66, v79
    v_dot2c_f32_bf16 v91, v67, v78
    v_dot2c_f32_bf16 v90, v67, v79
    v_lshlrev_b32 v80, 16, v105
    v_and_b32 v81, 0xffff, v105
    v_dot2c_f32_bf16 v85, v68, v80
    v_dot2c_f32_bf16 v84, v68, v81
    v_dot2c_f32_bf16 v87, v69, v80
    v_dot2c_f32_bf16 v86, v69, v81
    v_dot2c_f32_bf16 v89, v70, v80
    v_dot2c_f32_bf16 v88, v70, v81
    v_dot2c_f32_bf16 v91, v71, v80
    v_dot2c_f32_bf16 v90, v71, v81
    v_and_b32 v82, 0xffff0000, v105
    v_lshrrev_b32 v83, 16, v105
    v_dot2c_f32_bf16 v85, v72, v82
    v_dot2c_f32_bf16 v84, v72, v83
    v_dot2c_f32_bf16 v87, v73, v82
    v_dot2c_f32_bf16 v86, v73, v83
    v_dot2c_f32_bf16 v89, v74, v82
    v_dot2c_f32_bf16 v88, v74, v83
    v_dot2c_f32_bf16 v91, v75, v82
    v_dot2c_f32_bf16 v90, v75, v83
    v_lshlrev_b32 v76, 16, v106
    v_and_b32 v77, 0xffff, v106
    v_dot2c_f32_bf16 v85, v108, v76
    v_dot2c_f32_bf16 v84, v108, v77
    v_dot2c_f32_bf16 v87, v109, v76
    v_dot2c_f32_bf16 v86, v109, v77
    v_dot2c_f32_bf16 v89, v110, v76
    v_dot2c_f32_bf16 v88, v110, v77
    v_dot2c_f32_bf16 v91, v111, v76
    v_dot2c_f32_bf16 v90, v111, v77
    v_and_b32 v78, 0xffff0000, v106
    v_lshrrev_b32 v79, 16, v106
    v_dot2c_f32_bf16 v85, v112, v78
    v_dot2c_f32_bf16 v84, v112, v79
    v_dot2c_f32_bf16 v87, v113, v78
    v_dot2c_f32_bf16 v86, v113, v79
    v_dot2c_f32_bf16 v89, v114, v78
    v_dot2c_f32_bf16 v88, v114, v79
    v_dot2c_f32_bf16 v91, v115, v78
    v_dot2c_f32_bf16 v90, v115, v79
    v_lshlrev_b32 v80, 16, v107
    v_and_b32 v81, 0xffff, v107
    v_dot2c_f32_bf16 v85, v116, v80
    v_dot2c_f32_bf16 v84, v116, v81
    v_dot2c_f32_bf16 v87, v117, v80
    v_dot2c_f32_bf16 v86, v117, v81
    v_dot2c_f32_bf16 v89, v118, v80
    v_dot2c_f32_bf16 v88, v118, v81
    v_dot2c_f32_bf16 v91, v119, v80
    v_dot2c_f32_bf16 v90, v119, v81
    v_and_b32 v82, 0xffff0000, v107
    v_lshrrev_b32 v83, 16, v107
    v_dot2c_f32_bf16 v85, v120, v82
    v_dot2c_f32_bf16 v84, v120, v83
    v_dot2c_f32_bf16 v87, v121, v82
    v_dot2c_f32_bf16 v86, v121, v83
    v_dot2c_f32_bf16 v89, v122, v82
    v_dot2c_f32_bf16 v88, v122, v83
    v_dot2c_f32_bf16 v91, v123, v82
    v_dot2c_f32_bf16 v90, v123, v83
    s_nop 0
    v_permlane32_swap_b32 v84, v88
    v_permlane32_swap_b32 v85, v89
    v_permlane32_swap_b32 v86, v90
    v_permlane32_swap_b32 v87, v91
    v_add_f32 v84, v84, v88
    v_add_f32 v85, v85, v89
    v_add_f32 v86, v86, v90
    v_add_f32 v87, v87, v91
    s_nop 0
    v_permlane16_swap_b32 v84, v86
    v_permlane16_swap_b32 v85, v87
    v_add_f32 v84, v84, v86
    v_add_f32 v85, v85, v87
    s_nop 0
    v_add_f32_dpp v84, v84, v84 row_ror:8 row_mask:0xf bank_mask:0xf
    v_add_f32_dpp v85, v85, v85 row_ror:8 row_mask:0xf bank_mask:0xf
    v_and_b32 v16, 7, v1
    v_lshlrev_b32 v16, 5, v16
    v_lshrrev_b32 v17, 4, v1
    v_lshl_add_u32 v16, v17, 3, v16
    s_lshl_b32 s16, s3, 8
    s_add_u32 s16, s16, 70656
    v_add_u32 v16, s16, v16
    ds_write_b64 v16, v[84:85]
    s_lshr_b32 s16, s3, 2
    s_lshl_b32 s17, s16, 10
    s_add_u32 s17, s17, 70656
    v_lshlrev_b32 v17, 2, v1
    v_add_u32 v16, s17, v17
    s_and_b32 s17, s29, 3
    s_lshl_b32 s17, s17, 1
    s_add_u32 s17, s17, s16
    s_mul_i32 s17, s17, 14336
    s_lshr_b32 s16, s29, 2
    s_lshl_b32 s16, s16, 8
    s_add_u32 s17, s17, s16
    s_add_u32 s17, s17, 0x6e1000
    s_and_b32 s16, s3, 3
    s_cmp_eq_u32 s16, 0
    s_cselect_b32 s17, s17, 0x7ffffff0
    s_cmp_lt_u32 s2, 224
    s_cselect_b32 s17, s17, 0x7ffffff0
    s_waitcnt lgkmcnt(0)
    s_barrier
    ds_read_b32 v84, v16 offset:0
    ds_read_b32 v85, v16 offset:256
    ds_read_b32 v86, v16 offset:512
    ds_read_b32 v87, v16 offset:768
    s_waitcnt lgkmcnt(2)
    v_add_f32 v84, v84, v85
    s_waitcnt lgkmcnt(0)
    v_add_f32 v86, v86, v87
    v_add_f32 v84, v84, v86
    v_or_b32 v84, 1, v84
    buffer_store_dword v84, v17, s[8:11], s17 offen sc1
    s_barrier
    v_lshlrev_b32 v16, 3, v0
    v_add_u32 v17, 73728, v16
    ds_read_b64 v[84:85], v17 offset:0
    ds_read_b64 v[86:87], v17 offset:4096
    ds_read_b64 v[88:89], v17 offset:8192
    ds_read_b64 v[90:91], v17 offset:12288
    s_waitcnt lgkmcnt(2)
    v_pk_add_f32 v[84:85], v[84:85], v[86:87]
    s_waitcnt lgkmcnt(0)
    v_pk_add_f32 v[88:89], v[88:89], v[90:91]
    v_pk_add_f32 v[84:85], v[84:85], v[88:89]
    v_or_b32 v84, 1, v84
    v_or_b32 v85, 1, v85
    s_lshl_b32 s16, s29, 12
    s_add_u32 s16, s16, 0x600000
    s_cmp_lt_u32 s2, 224
    s_cselect_b32 s16, s16, 0x7ffffff0
    buffer_store_dwordx2 v[84:85], v16, s[8:11], s16 offen sc1
    s_cmp_lt_u32 s2, 224
    s_cbranch_scc1 adaLN_cond__sliding_block_cached__moe_arch_mod__prompt_kernel_end
    s_sub_u32 s16, s2, 224
    s_lshl_b32 s17, s16, 7
    s_add_u32 s17, s17, 0x600000
    v_lshrrev_b32 v16, 3, v0
    v_lshlrev_b32 v16, 12, v16
    v_and_b32 v17, 7, v0
    v_lshl_add_u32 v16, v17, 4, v16
    v_cmp_gt_u32 vcc, 256, v0
    v_bfrev_b32 v17, -2
    s_nop 0
    v_cndmask_b32 v17, v17, v16, vcc
    v_mov_b32 v19, 0
    v_cndmask_b32 v18, 1, v19, vcc
    s_lshl_b32 s18, s16, 6
    v_and_b32 v19, 31, v1
    v_lshlrev_b32 v19, 1, v19
    v_add_u32 v19, s18, v19
    s_mov_b32 s19, 0x541800
    buffer_load_ushort v95, v19, s[8:11], s19 offen sc1
    v_add_u32 v20, 66560, v19
    ds_read_u16 v96, v20
    ds_read_u16 v97, v20 offset:2048
    v_mov_b32 v94, v27
    v_cvt_pk_bf16_f32 v94, v94, v94
    v_lshlrev_b32 v94, 16, v94
    v_mul_f32 v94, 0xbfb8aa3b, v94
    v_exp_f32 v94, v94
    s_nop 0
    v_add_f32 v94, 1.0, v94
    v_rcp_f32 v94, v94
    s_nop 0
    v_cvt_pk_bf16_f32 v94, v94, v94
    v_lshlrev_b32 v94, 16, v94
    s_waitcnt vmcnt(0)
    v_lshlrev_b32 v95, 16, v95
    s_waitcnt lgkmcnt(1)
    v_lshlrev_b32 v96, 16, v96
    s_waitcnt lgkmcnt(0)
    v_lshlrev_b32 v97, 16, v97
    s_mov_b32 s27, 0
adaLN_cond__sliding_block_cached__moe_arch_mod__prompt_kernel_y13p:
    s_add_u32 s19, s17, 0x0
    buffer_load_dwordx4 v[44:47], v16, s[8:11], s19 offen sc1
    s_add_u32 s19, s17, 0x40000
    buffer_load_dwordx4 v[48:51], v16, s[8:11], s19 offen sc1
    s_add_u32 s19, s17, 0x80000
    buffer_load_dwordx4 v[52:55], v16, s[8:11], s19 offen sc1
    s_add_u32 s19, s17, 0xc0000
    buffer_load_dwordx4 v[56:59], v17, s[8:11], s19 offen sc1
    s_waitcnt vmcnt(0)
    v_min3_u32 v98, v56, v57, v58
    v_min_u32 v98, v98, v59
    v_or_b32 v98, v98, v18
    v_min3_u32 v98, v98, v44, v45
    v_min3_u32 v98, v98, v46, v47
    v_min3_u32 v98, v98, v48, v49
    v_min3_u32 v98, v98, v50, v51
    v_min3_u32 v98, v98, v52, v53
    v_min3_u32 v98, v98, v54, v55
    v_cmp_eq_u32 vcc, 0, v98
    s_add_u32 s27, s27, 1
    s_cmp_ge_u32 s27, 65536
    s_cbranch_scc1 adaLN_cond__sliding_block_cached__moe_arch_mod__prompt_kernel_y13g
    s_cbranch_vccnz adaLN_cond__sliding_block_cached__moe_arch_mod__prompt_kernel_y13p
adaLN_cond__sliding_block_cached__moe_arch_mod__prompt_kernel_y13g:
    v_pk_add_f32 v[44:45], v[44:45], v[52:53]
    v_pk_add_f32 v[46:47], v[46:47], v[54:55]
    v_pk_add_f32 v[48:49], v[48:49], v[56:57]
    v_pk_add_f32 v[50:51], v[50:51], v[58:59]
    v_pk_add_f32 v[44:45], v[44:45], v[48:49]
    v_pk_add_f32 v[46:47], v[46:47], v[50:51]
    s_nop 0
    v_add_f32_dpp v44, v44, v44 row_ror:8 row_mask:0xf bank_mask:0xf
    v_add_f32_dpp v45, v45, v45 row_ror:8 row_mask:0xf bank_mask:0xf
    v_add_f32_dpp v46, v46, v46 row_ror:8 row_mask:0xf bank_mask:0xf
    v_add_f32_dpp v47, v47, v47 row_ror:8 row_mask:0xf bank_mask:0xf
    s_nop 0
    v_permlane32_swap_b32 v44, v46
    v_permlane32_swap_b32 v45, v47
    v_add_f32 v44, v44, v46
    v_add_f32 v45, v45, v47
    s_nop 1
    v_permlane16_swap_b32 v44, v45
    v_add_f32 v44, v44, v45
    v_and_b32 v16, 7, v1
    v_lshlrev_b32 v16, 4, v16
    v_lshrrev_b32 v17, 4, v1
    v_lshl_add_u32 v16, v17, 2, v16
    s_lshl_b32 s19, s3, 7
    s_add_u32 s19, s19, 91136
    v_add_u32 v16, s19, v16
    ds_write_b32 v16, v44
    v_and_b32 v16, 31, v1
    v_lshlrev_b32 v16, 2, v16
    v_add_u32 v16, 91136, v16
    s_waitcnt lgkmcnt(0)
    s_barrier
    s_cmp_lg_u32 s3, 0
    s_cbranch_scc1 adaLN_cond__sliding_block_cached__moe_arch_mod__prompt_kernel_end
    ds_read_b32 v44, v16 offset:0
    ds_read_b32 v45, v16 offset:128
    ds_read_b32 v46, v16 offset:256
    ds_read_b32 v47, v16 offset:384
    ds_read_b32 v48, v16 offset:512
    ds_read_b32 v49, v16 offset:640
    ds_read_b32 v50, v16 offset:768
    ds_read_b32 v51, v16 offset:896
    s_waitcnt lgkmcnt(3)
    v_add_f32 v44, v44, v48
    s_waitcnt lgkmcnt(2)
    v_add_f32 v45, v45, v49
    s_waitcnt lgkmcnt(1)
    v_add_f32 v46, v46, v50
    s_waitcnt lgkmcnt(0)
    v_add_f32 v47, v47, v51
    v_add_f32 v44, v44, v46
    v_add_f32 v45, v45, v47
    v_add_f32 v44, v44, v45
    v_cvt_pk_bf16_f32 v44, v44, v44
    v_lshlrev_b32 v44, 16, v44
    v_mul_f32 v44, v44, v94
    v_cvt_pk_bf16_f32 v44, v44, v44
    v_lshlrev_b32 v44, 16, v44
    v_add_f32 v44, v44, v96
    v_cvt_pk_bf16_f32 v44, v44, v44
    v_lshlrev_b32 v44, 16, v44
    v_mul_f32 v44, v44, v95
    v_cvt_pk_bf16_f32 v44, v44, v44
    v_lshlrev_b32 v44, 16, v44
    v_add_f32 v44, v44, v97
    v_cvt_pk_bf16_f32 v44, v44, v44
    s_mov_b64 exec, 0xffffffff
    buffer_store_short v44, v19, s[68:71], s13 offen sc1
    s_branch adaLN_cond__sliding_block_cached__moe_arch_mod__prompt_kernel_end
adaLN_cond__sliding_block_cached__moe_arch_mod__prompt_kernel_roleB:
    v_mov_b32 v132, 0
    v_mov_b32 v133, 0
    v_lshrrev_b32 v16, 3, v0
    v_and_b32 v17, 7, v0
    v_mul_u32_u24 v135, 24576, v16
    v_lshl_add_u32 v135, v17, 4, v135
    v_lshlrev_b32 v136, 2, v16
    s_and_b32 s14, s2, 31
    s_lshr_b32 s15, s2, 5
    s_mul_i32 s26, s15, 1572864
    s_lshl_b32 s16, s14, 7
    s_add_u32 s26, s26, s16
    s_lshl_b32 s29, s15, 8
    v_lshlrev_b32 v137, 3, v0
    s_lshl_b32 s18, s2, 3
    s_add_u32 s18, s18, s3
    s_lshl_b32 s18, s18, 11
    v_and_b32 v18, 15, v1
    v_lshrrev_b32 v19, 4, v1
    v_lshlrev_b32 v138, 11, v18
    v_lshl_add_u32 v138, v19, 4, v138
    s_lshr_b32 s30, s2, 4
    s_and_b32 s31, s2, 15
    s_lshl_b32 s19, s30, 3
    s_add_u32 s19, s19, s3
    s_lshl_b32 s22, s19, 15
    s_lshl_b32 s23, s31, 7
    s_add_u32 s22, s22, s23
    s_lshl_b32 s23, s2, 12
    s_add_u32 s23, s23, 0x600000
    s_or_b32 s25, s2, s3
    s_cmp_eq_u32 s25, 0
    s_cselect_b32 s25, 0, 0x7ffffff0
    s_waitcnt lgkmcnt(0)
    s_mov_b64 s[64:65], s[58:59]
    s_mov_b32 s66, 0x100
    s_mov_b32 s67, 0x20000
    s_or_b32 s28, s62, 1
    v_mov_b32 v134, s28
    s_mov_b64 exec, 1
    buffer_store_dword v134, v132, s[64:67], s25 offen sc1
    s_mov_b64 exec, -1
    s_mov_b64 s[68:69], s[52:53]
    s_mov_b32 s70, 0x800
    s_mov_b32 s71, 0x20000
    s_mov_b64 s[72:73], s[54:55]
    s_mov_b32 s74, 0xc00000
    s_mov_b32 s75, 0x20000
    s_mov_b64 s[76:77], s[32:33]
    s_mov_b32 s78, 0x400000
    s_mov_b32 s79, 0x20000
    s_mov_b64 s[8:9], s[60:61]
    s_mov_b32 s10, 0x3400000
    s_mov_b32 s11, 0x20000
    buffer_load_dwordx4 v[32:35], v2, s[76:79], s18 offen offset:0
    buffer_load_dwordx4 v[36:39], v2, s[76:79], s18 offen offset:1024
    buffer_load_dword v72, v136, s[68:71], s29 offen
    buffer_load_dwordx4 v[24:27], v135, s[72:75], s26 offen
    s_add_u32 s26, s26, 12288
    buffer_load_dwordx4 v[28:31], v135, s[72:75], s26 offen
    buffer_store_dwordx2 v[132:133], v137, s[8:11], s23 offen sc1
    s_barrier
    buffer_load_dwordx4 v[40:43], v138, s[76:79], s22 offen offset:0
    buffer_load_dwordx4 v[44:47], v138, s[76:79], s22 offen offset:64
    s_mov_b32 s29, s19
    s_mov_b64 s[64:65], s[34:35]
    s_mov_b32 s66, 0x200000
    s_mov_b32 s67, 0x20000
    s_mov_b64 s[68:69], s[36:37]
    s_mov_b32 s70, 0x200000
    s_mov_b32 s71, 0x20000
    s_lshl_b32 s20, s2, 2
    s_add_u32 s20, s20, s3
    s_sub_u32 s20, s20, 4
    s_lshr_b32 s22, s20, 8
    s_bfe_u32 s23, s20, 0x40004
    s_and_b32 s24, s20, 15
    s_lshl_b32 s25, s22, 19
    s_lshl_b32 s26, s23, 13
    s_add_u32 s25, s25, s26
    s_add_u32 s25, s25, 393216
    v_and_b32 v16, 15, v1
    v_lshrrev_b32 v17, 4, v1
    s_lshl_b32 s21, s22, 17
    s_cmp_ge_u32 s24, 8
    s_cbranch_scc1 adaLN_cond__sliding_block_cached__moe_arch_mod__prompt_kernel_kvV
    v_lshlrev_b32 v18, 8, v16
    v_lshl_add_u32 v18, v17, 3, v18
    s_and_b32 s26, s24, 1
    s_lshl_b32 s26, s26, 12
    s_add_u32 s25, s25, s26
    s_lshr_b32 s26, s24, 1
    s_lshl_b32 s26, s26, 6
    s_add_u32 s25, s25, s26
    buffer_load_dwordx2 v[84:85], v18, s[64:67], s25 offen
    buffer_load_dwordx2 v[86:87], v18, s[64:67], s25 offen offset:32
    s_mov_b32 s26, 0x7ffffff0
    buffer_load_ushort v88, v18, s[64:67], s26 offen
    buffer_load_ushort v89, v18, s[64:67], s26 offen
    buffer_load_ushort v90, v18, s[64:67], s26 offen
    buffer_load_ushort v91, v18, s[64:67], s26 offen
    buffer_load_ushort v92, v18, s[64:67], s26 offen
    buffer_load_ushort v93, v18, s[64:67], s26 offen
    s_lshl_b32 s26, s23, 13
    s_add_u32 s21, s21, s26
    s_lshl_b32 s26, s24, 10
    s_add_u32 s21, s21, s26
    s_add_u32 s21, s21, 0x400000
    s_branch adaLN_cond__sliding_block_cached__moe_arch_mod__prompt_kernel_kvJ
adaLN_cond__sliding_block_cached__moe_arch_mod__prompt_kernel_kvV:
    s_bfe_u32 s26, s24, 0x20001
    s_lshl_b32 s26, s26, 6
    s_add_u32 s25, s25, s26
    s_and_b32 s26, s24, 1
    s_lshl_b32 s26, s26, 3
    s_add_u32 s25, s25, s26
    s_add_u32 s26, s25, 4096
    v_lshrrev_b32 v18, 2, v16
    v_lshlrev_b32 v18, 4, v18
    v_and_b32 v19, 3, v16
    v_lshl_add_u32 v18, v19, 1, v18
    v_lshl_add_u32 v18, v17, 10, v18
    buffer_load_ushort v88, v18, s[68:71], s25 offen offset:0
    buffer_load_ushort v89, v18, s[68:71], s25 offen offset:256
    buffer_load_ushort v90, v18, s[68:71], s25 offen offset:512
    buffer_load_ushort v91, v18, s[68:71], s25 offen offset:768
    buffer_load_ushort v92, v18, s[68:71], s26 offen offset:0
    buffer_load_ushort v93, v18, s[68:71], s26 offen offset:256
    buffer_load_ushort v94, v18, s[68:71], s26 offen offset:512
    buffer_load_ushort v95, v18, s[68:71], s26 offen offset:768
    s_bfe_u32 s26, s24, 0x20001
    s_lshl_b32 s26, s26, 15
    s_add_u32 s21, s21, s26
    s_lshl_b32 s26, s23, 11
    s_add_u32 s21, s21, s26
    s_and_b32 s26, s24, 1
    s_lshl_b32 s26, s26, 10
    s_add_u32 s21, s21, s26
    s_add_u32 s21, s21, 0x480000
adaLN_cond__sliding_block_cached__moe_arch_mod__prompt_kernel_kvJ:
    s_waitcnt vmcnt(15)
    v_lshlrev_b32 v56, 16, v32
    v_and_b32 v57, 0xffff0000, v32
    v_lshlrev_b32 v58, 16, v33
    v_and_b32 v59, 0xffff0000, v33
    v_lshlrev_b32 v60, 16, v34
    v_and_b32 v61, 0xffff0000, v34
    v_lshlrev_b32 v62, 16, v35
    v_and_b32 v63, 0xffff0000, v35
    s_waitcnt vmcnt(14)
    v_lshlrev_b32 v64, 16, v36
    v_and_b32 v65, 0xffff0000, v36
    v_lshlrev_b32 v66, 16, v37
    v_and_b32 v67, 0xffff0000, v37
    v_lshlrev_b32 v68, 16, v38
    v_and_b32 v69, 0xffff0000, v38
    v_lshlrev_b32 v70, 16, v39
    v_and_b32 v71, 0xffff0000, v39
    v_add_f32 v20, v56, v57
    v_add_f32 v21, v58, v59
    v_add_f32 v20, v20, v60
    v_add_f32 v21, v21, v61
    v_add_f32 v20, v20, v62
    v_add_f32 v21, v21, v63
    v_add_f32 v20, v20, v64
    v_add_f32 v21, v21, v65
    v_add_f32 v20, v20, v66
    v_add_f32 v21, v21, v67
    v_add_f32 v20, v20, v68
    v_add_f32 v21, v21, v69
    v_add_f32 v20, v20, v70
    v_add_f32 v21, v21, v71
    v_add_f32 v128, v20, v21
    s_nop 1
    v_add_f32_dpp v128, v128, v128 row_ror:1 row_mask:0xf bank_mask:0xf
    s_nop 1
    v_add_f32_dpp v128, v128, v128 row_ror:2 row_mask:0xf bank_mask:0xf
    s_nop 1
    v_add_f32_dpp v128, v128, v128 row_ror:4 row_mask:0xf bank_mask:0xf
    s_nop 1
    v_add_f32_dpp v128, v128, v128 row_ror:8 row_mask:0xf bank_mask:0xf
    v_mov_b32 v20, v128
    s_nop 1
    v_permlane16_swap_b32 v128, v20
    v_add_f32 v128, v128, v20
    v_mov_b32 v20, v128
    s_nop 1
    v_permlane32_swap_b32 v128, v20
    v_add_f32 v128, v128, v20
    v_mul_f32 v128, 0x3a800000, v128
    v_sub_f32 v18, v56, v128
    v_mul_f32 v20, v18, v18
    v_sub_f32 v19, v57, v128
    v_mul_f32 v21, v19, v19
    v_sub_f32 v18, v58, v128
    v_sub_f32 v19, v59, v128
    v_fmac_f32 v20, v18, v18
    v_fmac_f32 v21, v19, v19
    v_sub_f32 v18, v60, v128
    v_sub_f32 v19, v61, v128
    v_fmac_f32 v20, v18, v18
    v_fmac_f32 v21, v19, v19
    v_sub_f32 v18, v62, v128
    v_sub_f32 v19, v63, v128
    v_fmac_f32 v20, v18, v18
    v_fmac_f32 v21, v19, v19
    v_sub_f32 v18, v64, v128
    v_sub_f32 v19, v65, v128
    v_fmac_f32 v20, v18, v18
    v_fmac_f32 v21, v19, v19
    v_sub_f32 v18, v66, v128
    v_sub_f32 v19, v67, v128
    v_fmac_f32 v20, v18, v18
    v_fmac_f32 v21, v19, v19
    v_sub_f32 v18, v68, v128
    v_sub_f32 v19, v69, v128
    v_fmac_f32 v20, v18, v18
    v_fmac_f32 v21, v19, v19
    v_sub_f32 v18, v70, v128
    v_sub_f32 v19, v71, v128
    v_fmac_f32 v20, v18, v18
    v_fmac_f32 v21, v19, v19
    v_add_f32 v17, v20, v21
    s_nop 1
    v_add_f32_dpp v17, v17, v17 row_ror:1 row_mask:0xf bank_mask:0xf
    s_nop 1
    v_add_f32_dpp v17, v17, v17 row_ror:2 row_mask:0xf bank_mask:0xf
    s_nop 1
    v_add_f32_dpp v17, v17, v17 row_ror:4 row_mask:0xf bank_mask:0xf
    s_nop 1
    v_add_f32_dpp v17, v17, v17 row_ror:8 row_mask:0xf bank_mask:0xf
    v_mov_b32 v20, v17
    s_nop 1
    v_permlane16_swap_b32 v17, v20
    v_add_f32 v17, v17, v20
    v_mov_b32 v20, v17
    s_nop 1
    v_permlane32_swap_b32 v17, v20
    v_add_f32 v17, v17, v20
    v_mul_f32 v17, 0x3a800000, v17
    v_cvt_pk_bf16_f32 v128, v128, v128
    v_lshlrev_b32 v128, 16, v128
    v_cvt_pk_bf16_f32 v17, v17, v17
    v_lshlrev_b32 v17, 16, v17
    v_add_f32 v17, 0x3727c5ac, v17
    v_cvt_pk_bf16_f32 v17, v17, v17
    v_lshlrev_b32 v17, 16, v17
    v_sqrt_f32 v129, v17
    s_nop 0
    v_cvt_pk_bf16_f32 v129, v129, v129
    v_lshlrev_b32 v129, 16, v129
    v_rcp_f32 v130, v129
    s_lshl_b32 s16, s3, 4
    s_add_u32 s16, s16, 149520
    v_mov_b32 v19, s16
    ds_write_b128 v19, v[128:131]
    s_waitcnt vmcnt(13)
    v_and_b32 v73, 0xffff0000, v72
    v_lshlrev_b32 v72, 16, v72
    v_mul_f32 v16, 0xbfb8aa3b, v72
    v_exp_f32 v16, v16
    s_nop 0
    v_add_f32 v16, 1.0, v16
    v_rcp_f32 v16, v16
    s_nop 0
    v_mul_f32 v72, v72, v16
    v_mul_f32 v17, 0xbfb8aa3b, v73
    v_exp_f32 v17, v17
    s_nop 0
    v_add_f32 v17, 1.0, v17
    v_rcp_f32 v17, v17
    s_nop 0
    v_mul_f32 v73, v73, v17
    v_cvt_pk_bf16_f32 v16, v72, v73
    v_lshlrev_b32 v72, 16, v16
    v_and_b32 v73, 0xffff0000, v16
    s_lshl_b32 s16, s2, 8
    s_add_u32 s16, s16, 0x550000
    s_mov_b32 exec_lo, 0x01010101
    s_mov_b32 exec_hi, 0x01010101
    buffer_store_dword v16, v136, s[8:11], s16 offen sc1
    s_mov_b64 exec, -1
    v_lshrrev_b32 v74, 16, v72
    v_lshrrev_b32 v75, 16, v73
    s_waitcnt vmcnt(13)
    v_dot2_f32_bf16 v49, v24, v72, 0
    v_dot2_f32_bf16 v48, v24, v74, 0
    v_dot2_f32_bf16 v51, v25, v72, 0
    v_dot2_f32_bf16 v50, v25, v74, 0
    v_dot2_f32_bf16 v53, v26, v72, 0
    v_dot2_f32_bf16 v52, v26, v74, 0
    v_dot2_f32_bf16 v55, v27, v72, 0
    v_dot2_f32_bf16 v54, v27, v74, 0
    s_waitcnt vmcnt(12)
    v_dot2c_f32_bf16 v49, v28, v73
    v_dot2c_f32_bf16 v48, v28, v75
    v_dot2c_f32_bf16 v51, v29, v73
    v_dot2c_f32_bf16 v50, v29, v75
    v_dot2c_f32_bf16 v53, v30, v73
    v_dot2c_f32_bf16 v52, v30, v75
    v_dot2c_f32_bf16 v55, v31, v73
    v_dot2c_f32_bf16 v54, v31, v75
    s_nop 0
    v_permlane32_swap_b32 v48, v52
    v_permlane32_swap_b32 v49, v53
    v_permlane32_swap_b32 v50, v54
    v_permlane32_swap_b32 v51, v55
    v_add_f32 v48, v48, v52
    v_add_f32 v49, v49, v53
    v_add_f32 v50, v50, v54
    v_add_f32 v51, v51, v55
    s_nop 0
    v_permlane16_swap_b32 v48, v50
    v_permlane16_swap_b32 v49, v51
    v_add_f32 v48, v48, v50
    v_add_f32 v49, v49, v51
    s_nop 0
    v_add_f32_dpp v48, v48, v48 row_ror:8 row_mask:0xf bank_mask:0xf
    v_add_f32_dpp v49, v49, v49 row_ror:8 row_mask:0xf bank_mask:0xf
    v_and_b32 v16, 7, v1
    v_lshlrev_b32 v16, 5, v16
    v_lshrrev_b32 v17, 4, v1
    v_lshl_add_u32 v16, v17, 3, v16
    s_lshl_b32 s16, s3, 8
    s_add_u32 s16, s16, 147456
    v_add_u32 v16, s16, v16
    ds_write_b64 v16, v[48:49]
    v_mov_b32 v19, 149504
    v_and_b32 v17, 31, v1
    v_lshlrev_b32 v18, 3, v17
    v_add_u32 v18, 147456, v18
    v_lshlrev_b32 v17, 4, v17
    s_waitcnt lgkmcnt(0)
    s_barrier
    ds_read_b32 v134, v19
    ds_read_b64 v[96:97], v18 offset:0
    ds_read_b64 v[100:101], v18 offset:256
    ds_read_b64 v[104:105], v18 offset:512
    ds_read_b64 v[108:109], v18 offset:768
    ds_read_b64 v[112:113], v18 offset:1024
    ds_read_b64 v[116:117], v18 offset:1280
    ds_read_b64 v[120:121], v18 offset:1536
    ds_read_b64 v[124:125], v18 offset:1792
    s_waitcnt lgkmcnt(8)
    v_readfirstlane_b32 s28, v134
    v_and_b32 v20, 7, v1
    v_lshlrev_b32 v20, 4, v20
    v_add_u32 v21, 149520, v20
    ds_read_b128 v[128:131], v21
    s_waitcnt lgkmcnt(0)
    v_mov_b32 v131, s28
    s_lshl_b32 s16, s2, 7
    s_add_u32 s16, s16, 0x520000
    s_cmp_eq_u32 s3, 0
    s_cselect_b32 s16, s16, 0x7ffffff0
    s_mov_b64 exec, 0xff
    buffer_store_dwordx4 v[128:131], v20, s[8:11], s16 offen sc1
    s_mov_b64 exec, -1
    v_pk_add_f32 v[96:97], v[96:97], v[112:113]
    v_pk_add_f32 v[100:101], v[100:101], v[116:117]
    v_pk_add_f32 v[104:105], v[104:105], v[120:121]
    v_pk_add_f32 v[108:109], v[108:109], v[124:125]
    v_pk_add_f32 v[96:97], v[96:97], v[104:105]
    v_pk_add_f32 v[100:101], v[100:101], v[108:109]
    v_pk_add_f32 v[96:97], v[96:97], v[100:101]
    v_mov_b32 v98, s28
    v_mov_b32 v99, s28
    s_lshl_b32 s16, s14, 3
    s_add_u32 s16, s16, s15
    s_lshl_b32 s16, s16, 9
    s_add_u32 s16, s16, 0x500000
    s_cmp_eq_u32 s3, 0
    s_cselect_b32 s16, s16, 0x7ffffff0
    s_mov_b64 exec, 0xffffffff
    buffer_store_dwordx4 v[96:99], v17, s[8:11], s16 offen sc1
    s_mov_b64 exec, -1
    s_lshr_b32 s16, s3, 2
    s_lshl_b32 s16, s16, 4
    s_add_u32 s16, s16, s31
    s_lshl_b32 s16, s16, 12
    s_and_b32 s17, s3, 3
    s_lshl_b32 s17, s17, 7
    s_add_u32 s16, s16, s17
    s_add_u32 s16, s16, 0x500000
    v_lshrrev_b32 v139, 3, v1
    v_lshlrev_b32 v139, 9, v139
    v_and_b32 v16, 7, v1
    v_lshl_add_u32 v139, v16, 4, v139
    v_and_b32 v140, 15, v1
    v_lshlrev_b32 v140, 4, v140
    s_lshl_b32 s17, s29, 8
    s_add_u32 s17, s17, 0x520000
    s_waitcnt vmcnt(12)
    v_lshlrev_b32 v56, 16, v40
    v_and_b32 v57, 0xffff0000, v40
    v_lshlrev_b32 v58, 16, v41
    v_and_b32 v59, 0xffff0000, v41
    v_lshlrev_b32 v60, 16, v42
    v_and_b32 v61, 0xffff0000, v42
    v_lshlrev_b32 v62, 16, v43
    v_and_b32 v63, 0xffff0000, v43
    s_waitcnt vmcnt(11)
    v_lshlrev_b32 v64, 16, v44
    v_and_b32 v65, 0xffff0000, v44
    v_lshlrev_b32 v66, 16, v45
    v_and_b32 v67, 0xffff0000, v45
    v_lshlrev_b32 v68, 16, v46
    v_and_b32 v69, 0xffff0000, v46
    v_lshlrev_b32 v70, 16, v47
    v_and_b32 v71, 0xffff0000, v47
    v_mov_b32 v135, 2097152
    v_mul_lo_u32 v135, v135, v1
    s_mov_b64 s[76:77], s[40:41]
    s_mov_b32 s78, 0x800000
    s_mov_b32 s79, 0x20000
    s_mov_b32 s62, 0x0
    s_cmp_eq_u32 s3, 4
    s_cselect_b32 s62, s62, 0x7ffffff0
    buffer_load_dword v136, v135, s[76:79], s62 offen
    s_mov_b64 s[76:77], s[46:47]
    s_mov_b32 s78, 0x700000
    s_mov_b32 s79, 0x20000
    s_mov_b32 s62, 0x0
    s_cmp_eq_u32 s3, 4
    s_cselect_b32 s62, s62, 0x7ffffff0
    buffer_load_dword v136, v135, s[76:79], s62 offen
    s_mov_b64 s[76:77], s[48:49]
    s_mov_b32 s78, 0x700000
    s_mov_b32 s79, 0x20000
    s_mov_b32 s62, 0x0
    s_cmp_eq_u32 s3, 5
    s_cselect_b32 s62, s62, 0x7ffffff0
    buffer_load_dword v136, v135, s[76:79], s62 offen
    s_mov_b64 s[76:77], s[50:51]
    s_mov_b32 s78, 0x700000
    s_mov_b32 s79, 0x20000
    s_mov_b32 s62, 0x0
    s_cmp_eq_u32 s3, 5
    s_cselect_b32 s62, s62, 0x7ffffff0
    buffer_load_dword v136, v135, s[76:79], s62 offen
    s_mov_b64 s[76:77], s[38:39]
    s_mov_b32 s78, 0x800000
    s_mov_b32 s79, 0x20000
    s_mov_b32 s62, 0x0
    s_cmp_eq_u32 s3, 6
    s_cselect_b32 s62, s62, 0x7ffffff0
    buffer_load_dword v136, v135, s[76:79], s62 offen
    s_mov_b64 s[76:77], s[56:57]
    s_mov_b32 s78, 0x400000
    s_mov_b32 s79, 0x20000
    s_mov_b32 s62, 0x0
    s_cmp_eq_u32 s3, 6
    s_cselect_b32 s62, s62, 0x7ffffff0
    buffer_load_dword v136, v135, s[76:79], s62 offen
    s_mov_b64 s[76:77], s[54:55]
    s_mov_b32 s78, 0xc00000
    s_mov_b32 s79, 0x20000
    s_mov_b32 s62, 0x0
    s_cmp_eq_u32 s3, 7
    s_cselect_b32 s62, s62, 0x7ffffff0
    buffer_load_dword v136, v135, s[76:79], s62 offen
    s_mov_b64 s[76:77], s[44:45]
    s_mov_b32 s78, 0x800
    s_mov_b32 s79, 0x20000
    s_mov_b32 s62, 0x0
    s_cmp_eq_u32 s3, 7
    s_cselect_b32 s62, s62, 0x7ffffff0
    buffer_load_dword v136, v135, s[76:79], s62 offen
    s_mov_b32 s27, 0
adaLN_cond__sliding_block_cached__moe_arch_mod__prompt_kernel_g14p:
    buffer_load_dwordx4 v[76:79], v139, s[8:11], s16 offen sc1
    buffer_load_dwordx4 v[80:83], v140, s[8:11], s17 offen sc1
    s_waitcnt vmcnt(1)
    v_cmp_ne_u32 vcc, s28, v78
    v_cmp_ne_u32 s[62:63], s28, v79
    s_or_b64 vcc, vcc, s[62:63]
    s_waitcnt vmcnt(0)
    v_cmp_ne_u32 s[62:63], s28, v83
    s_or_b64 vcc, vcc, s[62:63]
    s_add_u32 s27, s27, 1
    s_cmp_ge_u32 s27, 65536
    s_cbranch_scc1 adaLN_cond__sliding_block_cached__moe_arch_mod__prompt_kernel_g14g
    s_cbranch_vccnz adaLN_cond__sliding_block_cached__moe_arch_mod__prompt_kernel_g14p
adaLN_cond__sliding_block_cached__moe_arch_mod__prompt_kernel_g14g:
    v_add_f32_dpp v76, v76, v76 row_ror:8 row_mask:0xf bank_mask:0xf
    v_add_f32_dpp v77, v77, v77 row_ror:8 row_mask:0xf bank_mask:0xf
    v_mov_b32 v17, v76
    s_nop 1
    v_permlane16_swap_b32 v76, v17
    v_add_f32 v76, v76, v17
    v_mov_b32 v18, v77
    s_nop 1
    v_permlane16_swap_b32 v77, v18
    v_add_f32 v77, v77, v18
    v_mov_b32 v17, v76
    s_nop 1
    v_permlane32_swap_b32 v76, v17
    v_add_f32 v76, v76, v17
    v_mov_b32 v18, v77
    s_nop 1
    v_permlane32_swap_b32 v77, v18
    v_add_f32 v77, v77, v18
    v_cvt_pk_bf16_f32 v17, v76, v77
    v_lshlrev_b32 v76, 16, v17
    v_and_b32 v77, 0xffff0000, v17
    v_add_f32 v76, 1.0, v76
    v_add_f32 v77, 1.0, v77
    v_cvt_pk_bf16_f32 v17, v76, v77
    v_lshlrev_b32 v76, 16, v17
    v_and_b32 v77, 0xffff0000, v17
    s_lshl_b32 s16, s3, 6
    s_add_u32 s16, s16, 151552
    v_lshl_add_u32 v16, v16, 3, s16
    ds_write_b64 v16, v[76:77]
    v_lshrrev_b32 v17, 4, v1
    v_lshlrev_b32 v17, 5, v17
    v_add_u32 v17, 151552, v17
    v_sub_f32 v56, v56, v80
    v_sub_f32 v57, v57, v80
    v_sub_f32 v58, v58, v80
    v_sub_f32 v59, v59, v80
    v_sub_f32 v60, v60, v80
    v_sub_f32 v61, v61, v80
    v_sub_f32 v62, v62, v80
    v_sub_f32 v63, v63, v80
    v_sub_f32 v64, v64, v80
    v_sub_f32 v65, v65, v80
    v_sub_f32 v66, v66, v80
    v_sub_f32 v67, v67, v80
    v_sub_f32 v68, v68, v80
    v_sub_f32 v69, v69, v80
    v_sub_f32 v70, v70, v80
    v_sub_f32 v71, v71, v80
    v_cvt_pk_bf16_f32 v18, v56, v57
    v_lshlrev_b32 v56, 16, v18
    v_and_b32 v57, 0xffff0000, v18
    v_cvt_pk_bf16_f32 v19, v58, v59
    v_lshlrev_b32 v58, 16, v19
    v_and_b32 v59, 0xffff0000, v19
    v_cvt_pk_bf16_f32 v18, v60, v61
    v_lshlrev_b32 v60, 16, v18
    v_and_b32 v61, 0xffff0000, v18
    v_cvt_pk_bf16_f32 v19, v62, v63
    v_lshlrev_b32 v62, 16, v19
    v_and_b32 v63, 0xffff0000, v19
    v_cvt_pk_bf16_f32 v18, v64, v65
    v_lshlrev_b32 v64, 16, v18
    v_and_b32 v65, 0xffff0000, v18
    v_cvt_pk_bf16_f32 v19, v66, v67
    v_lshlrev_b32 v66, 16, v19
    v_and_b32 v67, 0xffff0000, v19
    v_cvt_pk_bf16_f32 v18, v68, v69
    v_lshlrev_b32 v68, 16, v18
    v_and_b32 v69, 0xffff0000, v18
    v_cvt_pk_bf16_f32 v19, v70, v71
    v_lshlrev_b32 v70, 16, v19
    v_and_b32 v71, 0xffff0000, v19
    v_mul_f32 v56, v56, v82
    v_mul_f32 v57, v57, v82
    v_mul_f32 v58, v58, v82
    v_mul_f32 v59, v59, v82
    v_mul_f32 v60, v60, v82
    v_mul_f32 v61, v61, v82
    v_mul_f32 v62, v62, v82
    v_mul_f32 v63, v63, v82
    v_mul_f32 v64, v64, v82
    v_mul_f32 v65, v65, v82
    v_mul_f32 v66, v66, v82
    v_mul_f32 v67, v67, v82
    v_mul_f32 v68, v68, v82
    v_mul_f32 v69, v69, v82
    v_mul_f32 v70, v70, v82
    v_mul_f32 v71, v71, v82
    v_cvt_pk_bf16_f32 v18, v56, v57
    v_lshlrev_b32 v56, 16, v18
    v_and_b32 v57, 0xffff0000, v18
    v_cvt_pk_bf16_f32 v19, v58, v59
    v_lshlrev_b32 v58, 16, v19
    v_and_b32 v59, 0xffff0000, v19
    v_cvt_pk_bf16_f32 v18, v60, v61
    v_lshlrev_b32 v60, 16, v18
    v_and_b32 v61, 0xffff0000, v18
    v_cvt_pk_bf16_f32 v19, v62, v63
    v_lshlrev_b32 v62, 16, v19
    v_and_b32 v63, 0xffff0000, v19
    v_cvt_pk_bf16_f32 v18, v64, v65
    v_lshlrev_b32 v64, 16, v18
    v_and_b32 v65, 0xffff0000, v18
    v_cvt_pk_bf16_f32 v19, v66, v67
    v_lshlrev_b32 v66, 16, v19
    v_and_b32 v67, 0xffff0000, v19
    v_cvt_pk_bf16_f32 v18, v68, v69
    v_lshlrev_b32 v68, 16, v18
    v_and_b32 v69, 0xffff0000, v18
    v_cvt_pk_bf16_f32 v19, v70, v71
    v_lshlrev_b32 v70, 16, v19
    v_and_b32 v71, 0xffff0000, v19
    s_lshl_b32 s16, s29, 15
    s_lshl_b32 s17, s31, 11
    s_add_u32 s16, s16, s17
    s_waitcnt lgkmcnt(0)
    s_barrier
    s_cmp_lt_u32 s24, 8
    s_cbranch_scc1 adaLN_cond__sliding_block_cached__moe_arch_mod__prompt_kernel_kvS
    v_lshl_or_b32 v84, v89, 16, v88
    v_lshl_or_b32 v85, v91, 16, v90
    v_lshl_or_b32 v86, v93, 16, v92
    v_lshl_or_b32 v87, v95, 16, v94
    v_and_b32 v88, 0x7fff, v88
    v_and_b32 v89, 0x7fff, v89
    v_and_b32 v90, 0x7fff, v90
    v_and_b32 v91, 0x7fff, v91
    v_and_b32 v92, 0x7fff, v92
    v_and_b32 v93, 0x7fff, v93
    v_and_b32 v94, 0x7fff, v94
    v_and_b32 v95, 0x7fff, v95
    v_max3_u32 v88, v88, v89, v90
    v_max3_u32 v91, v91, v92, v93
    v_max3_u32 v88, v88, v94, v95
    v_max_u32 v88, v88, v91
    v_cmp_le_u32 vcc, 0x4980, v88
    v_mov_b32 v89, s28
    s_mov_b32 s26, 0x564000
    s_and_saveexec_b64 s[62:63], vcc
    buffer_store_dword v89, v132, s[8:11], s26 offen sc1
    s_mov_b64 exec, s[62:63]
adaLN_cond__sliding_block_cached__moe_arch_mod__prompt_kernel_kvS:
    buffer_store_dwordx4 v[84:87], v2, s[8:11], s21 offen sc1
    ds_read_b128 v[96:99], v17 offset:256
    ds_read_b128 v[104:107], v17 offset:0
    ds_read_b128 v[100:103], v17 offset:272
    ds_read_b128 v[108:111], v17 offset:16
    ds_read_b128 v[112:115], v17 offset:384
    ds_read_b128 v[120:123], v17 offset:128
    ds_read_b128 v[116:119], v17 offset:400
    ds_read_b128 v[124:127], v17 offset:144
    s_waitcnt lgkmcnt(7)
    v_pk_mul_f32 v[56:57], v[56:57], v[96:97]
    v_pk_mul_f32 v[58:59], v[58:59], v[98:99]
    s_waitcnt lgkmcnt(5)
    v_pk_mul_f32 v[60:61], v[60:61], v[100:101]
    v_pk_mul_f32 v[62:63], v[62:63], v[102:103]
    v_cvt_pk_bf16_f32 v18, v56, v57
    v_lshlrev_b32 v56, 16, v18
    v_and_b32 v57, 0xffff0000, v18
    v_cvt_pk_bf16_f32 v19, v58, v59
    v_lshlrev_b32 v58, 16, v19
    v_and_b32 v59, 0xffff0000, v19
    v_cvt_pk_bf16_f32 v18, v60, v61
    v_lshlrev_b32 v60, 16, v18
    v_and_b32 v61, 0xffff0000, v18
    v_cvt_pk_bf16_f32 v19, v62, v63
    v_lshlrev_b32 v62, 16, v19
    v_and_b32 v63, 0xffff0000, v19
    v_pk_add_f32 v[56:57], v[56:57], v[104:105]
    v_pk_add_f32 v[58:59], v[58:59], v[106:107]
    s_waitcnt lgkmcnt(4)
    v_pk_add_f32 v[60:61], v[60:61], v[108:109]
    v_pk_add_f32 v[62:63], v[62:63], v[110:111]
    v_cvt_pk_bf16_f32 v32, v56, v57
    v_cvt_pk_bf16_f32 v33, v58, v59
    v_cvt_pk_bf16_f32 v34, v60, v61
    v_cvt_pk_bf16_f32 v35, v62, v63
    buffer_store_dwordx4 v[32:35], v2, s[8:11], s16 offen offset:0 sc1
    s_waitcnt lgkmcnt(3)
    v_pk_mul_f32 v[64:65], v[64:65], v[112:113]
    v_pk_mul_f32 v[66:67], v[66:67], v[114:115]
    s_waitcnt lgkmcnt(1)
    v_pk_mul_f32 v[68:69], v[68:69], v[116:117]
    v_pk_mul_f32 v[70:71], v[70:71], v[118:119]
    v_cvt_pk_bf16_f32 v18, v64, v65
    v_lshlrev_b32 v64, 16, v18
    v_and_b32 v65, 0xffff0000, v18
    v_cvt_pk_bf16_f32 v19, v66, v67
    v_lshlrev_b32 v66, 16, v19
    v_and_b32 v67, 0xffff0000, v19
    v_cvt_pk_bf16_f32 v18, v68, v69
    v_lshlrev_b32 v68, 16, v18
    v_and_b32 v69, 0xffff0000, v18
    v_cvt_pk_bf16_f32 v19, v70, v71
    v_lshlrev_b32 v70, 16, v19
    v_and_b32 v71, 0xffff0000, v19
    v_pk_add_f32 v[64:65], v[64:65], v[120:121]
    v_pk_add_f32 v[66:67], v[66:67], v[122:123]
    s_waitcnt lgkmcnt(0)
    v_pk_add_f32 v[68:69], v[68:69], v[124:125]
    v_pk_add_f32 v[70:71], v[70:71], v[126:127]
    v_cvt_pk_bf16_f32 v36, v64, v65
    v_cvt_pk_bf16_f32 v37, v66, v67
    v_cvt_pk_bf16_f32 v38, v68, v69
    v_cvt_pk_bf16_f32 v39, v70, v71
    buffer_store_dwordx4 v[36:39], v2, s[8:11], s16 offen offset:1024 sc1
    s_lshl_b32 s19, s3, 16
    s_lshl_b32 s20, s3, 11
    s_lshl_b32 s16, s12, 8
    s_add_u32 s4, s38, s16
    s_addc_u32 s5, s39, 0
    s_sub_u32 s6, 0x800000, s16
    s_mov_b32 s7, 0x20000
    s_barrier
    s_add_u32 s22, s19, 0x0
    s_add_u32 m0, s20, 0x0
    s_nop 0
    buffer_load_dwordx4 v3, s[4:7], s22 offen lds
    s_add_u32 s22, s19, 0x8000
    s_add_u32 m0, s20, 0x400
    s_nop 0
    buffer_load_dwordx4 v3, s[4:7], s22 offen lds
    s_add_u32 s22, s19, 0x80000
    s_add_u32 m0, s20, 0x4000
    s_nop 0
    buffer_load_dwordx4 v3, s[4:7], s22 offen lds
    s_add_u32 s22, s19, 0x88000
    s_add_u32 m0, s20, 0x4400
    s_nop 0
    buffer_load_dwordx4 v3, s[4:7], s22 offen lds
    s_add_u32 s22, s19, 0x100000
    s_add_u32 m0, s20, 0x8000
    s_nop 0
    buffer_load_dwordx4 v3, s[4:7], s22 offen lds
    s_add_u32 s22, s19, 0x108000
    s_add_u32 m0, s20, 0x8400
    s_nop 0
    buffer_load_dwordx4 v3, s[4:7], s22 offen lds
    v_mov_b32 v134, s28
    s_lshl_b32 s16, s29, 4
    s_add_u32 s16, s16, s31
    s_lshl_b32 s16, s16, 2
    s_add_u32 s16, s16, 0x528000
    v_and_b32 v16, 31, v1
    v_lshlrev_b32 v16, 2, v16
    s_lshl_b32 s17, s13, 3
    s_add_u32 s17, s17, s3
    s_lshl_b32 s17, s17, 7
    s_add_u32 s17, s17, 0x528000
    s_waitcnt vmcnt(6)
    s_mov_b64 exec, 1
    buffer_store_dword v134, v132, s[8:11], s16 offen sc1
    s_mov_b64 exec, -1
    s_waitcnt vmcnt(0)
    s_mov_b32 s27, 0
adaLN_cond__sliding_block_cached__moe_arch_mod__prompt_kernel_h15p:
    buffer_load_dword v17, v16, s[8:11], s17 offen sc1
    s_waitcnt vmcnt(0)
    v_cmp_ne_u32 vcc, s28, v17
    s_add_u32 s27, s27, 1
    s_cmp_ge_u32 s27, 65536
    s_cbranch_scc1 adaLN_cond__sliding_block_cached__moe_arch_mod__prompt_kernel_h15g
    s_cbranch_vccnz adaLN_cond__sliding_block_cached__moe_arch_mod__prompt_kernel_h15p
adaLN_cond__sliding_block_cached__moe_arch_mod__prompt_kernel_h15g:
    s_mov_b32 s23, 0x0
    buffer_load_dwordx4 v[88:91], v7, s[8:11], s23 offen offset:0 sc1
    s_mov_b32 s23, 0x8000
    buffer_load_dwordx4 v[92:95], v7, s[8:11], s23 offen offset:0 sc1
    s_mov_b32 s23, 0x0
    buffer_load_dwordx4 v[96:99], v7, s[8:11], s23 offen offset:1024 sc1
    s_mov_b32 s23, 0x8000
    buffer_load_dwordx4 v[100:103], v7, s[8:11], s23 offen offset:1024 sc1
    s_mov_b32 s23, 0x800
    buffer_load_dwordx4 v[104:107], v7, s[8:11], s23 offen offset:0 sc1
    s_mov_b32 s23, 0x8800
    buffer_load_dwordx4 v[108:111], v7, s[8:11], s23 offen offset:0 sc1
    s_mov_b32 s23, 0x800
    buffer_load_dwordx4 v[112:115], v7, s[8:11], s23 offen offset:1024 sc1
    s_mov_b32 s23, 0x8800
    buffer_load_dwordx4 v[116:119], v7, s[8:11], s23 offen offset:1024 sc1
    s_lshr_b32 s21, s12, 3
    s_lshl_b32 s21, s21, 17
    s_add_u32 s21, s21, s20
    s_add_u32 s21, s21, 0x400000
    s_barrier
    ds_read_b64_tr_b16 v[224:225], v4 offset:0
    ds_read_b64_tr_b16 v[226:227], v4 offset:1024
    ds_read_b64_tr_b16 v[228:229], v5 offset:32
    ds_read_b64_tr_b16 v[230:231], v5 offset:1056
    ds_read_b64_tr_b16 v[232:233], v4 offset:256
    ds_read_b64_tr_b16 v[234:235], v4 offset:1280
    s_waitcnt vmcnt(7) lgkmcnt(4)
    v_mfma_f32_16x16x32_bf16 v[24:27], v[224:227], v[88:91], 0
    ds_read_b64_tr_b16 v[236:237], v5 offset:288
    s_waitcnt vmcnt(6)
    v_mfma_f32_16x16x32_bf16 v[28:31], v[224:227], v[92:95], 0
    ds_read_b64_tr_b16 v[238:239], v5 offset:1312
    s_waitcnt lgkmcnt(4)
    v_mfma_f32_16x16x32_bf16 v[32:35], v[228:231], v[88:91], 0
    ds_read_b64_tr_b16 v[240:241], v4 offset:512
    v_mfma_f32_16x16x32_bf16 v[36:39], v[228:231], v[92:95], 0
    ds_read_b64_tr_b16 v[242:243], v4 offset:1536
    s_mov_b32 s23, 0x1000
    buffer_load_dwordx4 v[120:123], v7, s[8:11], s23 offen offset:0 sc1
    s_waitcnt lgkmcnt(4)
    v_mfma_f32_16x16x32_bf16 v[40:43], v[232:235], v[88:91], 0
    ds_read_b64_tr_b16 v[244:245], v5 offset:544
    v_mfma_f32_16x16x32_bf16 v[44:47], v[232:235], v[92:95], 0
    ds_read_b64_tr_b16 v[246:247], v5 offset:1568
    s_waitcnt lgkmcnt(4)
    v_mfma_f32_16x16x32_bf16 v[48:51], v[236:239], v[88:91], 0
    ds_read_b64_tr_b16 v[224:225], v4 offset:768
    v_mfma_f32_16x16x32_bf16 v[52:55], v[236:239], v[92:95], 0
    ds_read_b64_tr_b16 v[226:227], v4 offset:1792
    s_waitcnt lgkmcnt(4)
    v_mfma_f32_16x16x32_bf16 v[56:59], v[240:243], v[88:91], 0
    ds_read_b64_tr_b16 v[228:229], v5 offset:800
    v_mfma_f32_16x16x32_bf16 v[60:63], v[240:243], v[92:95], 0
    ds_read_b64_tr_b16 v[230:231], v5 offset:1824
    s_waitcnt lgkmcnt(4)
    v_mfma_f32_16x16x32_bf16 v[64:67], v[244:247], v[88:91], 0
    ds_read_b64_tr_b16 v[232:233], v4 offset:8192
    v_mfma_f32_16x16x32_bf16 v[68:71], v[244:247], v[92:95], 0
    ds_read_b64_tr_b16 v[234:235], v4 offset:9216
    s_mov_b32 s23, 0x9000
    buffer_load_dwordx4 v[124:127], v7, s[8:11], s23 offen offset:0 sc1
    s_waitcnt lgkmcnt(4)
    v_mfma_f32_16x16x32_bf16 v[72:75], v[224:227], v[88:91], 0
    ds_read_b64_tr_b16 v[236:237], v5 offset:8224
    v_mfma_f32_16x16x32_bf16 v[76:79], v[224:227], v[92:95], 0
    ds_read_b64_tr_b16 v[238:239], v5 offset:9248
    s_waitcnt lgkmcnt(4)
    v_mfma_f32_16x16x32_bf16 v[80:83], v[228:231], v[88:91], 0
    ds_read_b64_tr_b16 v[240:241], v4 offset:8448
    v_mfma_f32_16x16x32_bf16 v[84:87], v[228:231], v[92:95], 0
    ds_read_b64_tr_b16 v[242:243], v4 offset:9472
    s_waitcnt vmcnt(7) lgkmcnt(4)
    v_mfma_f32_16x16x32_bf16 v[24:27], v[232:235], v[96:99], v[24:27]
    ds_read_b64_tr_b16 v[244:245], v5 offset:8480
    s_waitcnt vmcnt(6)
    v_mfma_f32_16x16x32_bf16 v[28:31], v[232:235], v[100:103], v[28:31]
    ds_read_b64_tr_b16 v[246:247], v5 offset:9504
    s_waitcnt lgkmcnt(4)
    v_mfma_f32_16x16x32_bf16 v[32:35], v[236:239], v[96:99], v[32:35]
    ds_read_b64_tr_b16 v[224:225], v4 offset:8704
    v_mfma_f32_16x16x32_bf16 v[36:39], v[236:239], v[100:103], v[36:39]
    ds_read_b64_tr_b16 v[226:227], v4 offset:9728
    s_mov_b32 s23, 0x1000
    buffer_load_dwordx4 v[128:131], v7, s[8:11], s23 offen offset:1024 sc1
    s_waitcnt lgkmcnt(4)
    v_mfma_f32_16x16x32_bf16 v[40:43], v[240:243], v[96:99], v[40:43]
    ds_read_b64_tr_b16 v[228:229], v5 offset:8736
    v_mfma_f32_16x16x32_bf16 v[44:47], v[240:243], v[100:103], v[44:47]
    ds_read_b64_tr_b16 v[230:231], v5 offset:9760
    s_waitcnt lgkmcnt(4)
    v_mfma_f32_16x16x32_bf16 v[48:51], v[244:247], v[96:99], v[48:51]
    ds_read_b64_tr_b16 v[232:233], v4 offset:8960
    v_mfma_f32_16x16x32_bf16 v[52:55], v[244:247], v[100:103], v[52:55]
    ds_read_b64_tr_b16 v[234:235], v4 offset:9984
    s_waitcnt lgkmcnt(4)
    v_mfma_f32_16x16x32_bf16 v[56:59], v[224:227], v[96:99], v[56:59]
    ds_read_b64_tr_b16 v[236:237], v5 offset:8992
    v_mfma_f32_16x16x32_bf16 v[60:63], v[224:227], v[100:103], v[60:63]
    ds_read_b64_tr_b16 v[238:239], v5 offset:10016
    s_waitcnt lgkmcnt(4)
    v_mfma_f32_16x16x32_bf16 v[64:67], v[228:231], v[96:99], v[64:67]
    v_mfma_f32_16x16x32_bf16 v[68:71], v[228:231], v[100:103], v[68:71]
    s_barrier
    ds_read_b64_tr_b16 v[240:241], v4 offset:16384
    ds_read_b64_tr_b16 v[242:243], v4 offset:17408
    s_mov_b32 s23, 0x9000
    buffer_load_dwordx4 v[132:135], v7, s[8:11], s23 offen offset:1024 sc1
    s_waitcnt lgkmcnt(4)
    v_mfma_f32_16x16x32_bf16 v[72:75], v[232:235], v[96:99], v[72:75]
    ds_read_b64_tr_b16 v[244:245], v5 offset:16416
    v_mfma_f32_16x16x32_bf16 v[76:79], v[232:235], v[100:103], v[76:79]
    s_add_u32 s22, s19, 0x180000
    s_add_u32 m0, s20, 0xc000
    s_nop 0
    buffer_load_dwordx4 v3, s[4:7], s22 offen lds
    ds_read_b64_tr_b16 v[246:247], v5 offset:17440
    s_waitcnt lgkmcnt(4)
    v_mfma_f32_16x16x32_bf16 v[80:83], v[236:239], v[96:99], v[80:83]
    ds_read_b64_tr_b16 v[224:225], v4 offset:16640
    v_mfma_f32_16x16x32_bf16 v[84:87], v[236:239], v[100:103], v[84:87]
    ds_read_b64_tr_b16 v[226:227], v4 offset:17664
    s_waitcnt vmcnt(8) lgkmcnt(4)
    v_mfma_f32_16x16x32_bf16 v[24:27], v[240:243], v[104:107], v[24:27]
    ds_read_b64_tr_b16 v[228:229], v5 offset:16672
    s_waitcnt vmcnt(7)
    v_mfma_f32_16x16x32_bf16 v[28:31], v[240:243], v[108:111], v[28:31]
    ds_read_b64_tr_b16 v[230:231], v5 offset:17696
    s_waitcnt lgkmcnt(4)
    v_mfma_f32_16x16x32_bf16 v[32:35], v[244:247], v[104:107], v[32:35]
    ds_read_b64_tr_b16 v[232:233], v4 offset:16896
    v_mfma_f32_16x16x32_bf16 v[36:39], v[244:247], v[108:111], v[36:39]
    ds_read_b64_tr_b16 v[234:235], v4 offset:17920
    s_mov_b32 s23, 0x1800
    buffer_load_dwordx4 v[88:91], v7, s[8:11], s23 offen offset:0 sc1
    s_waitcnt lgkmcnt(4)
    v_mfma_f32_16x16x32_bf16 v[40:43], v[224:227], v[104:107], v[40:43]
    ds_read_b64_tr_b16 v[236:237], v5 offset:16928
    v_mfma_f32_16x16x32_bf16 v[44:47], v[224:227], v[108:111], v[44:47]
    s_add_u32 s22, s19, 0x188000
    s_add_u32 m0, s20, 0xc400
    s_nop 0
    buffer_load_dwordx4 v3, s[4:7], s22 offen lds
    ds_read_b64_tr_b16 v[238:239], v5 offset:17952
    s_waitcnt lgkmcnt(4)
    v_mfma_f32_16x16x32_bf16 v[48:51], v[228:231], v[104:107], v[48:51]
    ds_read_b64_tr_b16 v[240:241], v4 offset:17152
    v_mfma_f32_16x16x32_bf16 v[52:55], v[228:231], v[108:111], v[52:55]
    ds_read_b64_tr_b16 v[242:243], v4 offset:18176
    s_waitcnt lgkmcnt(4)
    v_mfma_f32_16x16x32_bf16 v[56:59], v[232:235], v[104:107], v[56:59]
    ds_read_b64_tr_b16 v[244:245], v5 offset:17184
    v_mfma_f32_16x16x32_bf16 v[60:63], v[232:235], v[108:111], v[60:63]
    ds_read_b64_tr_b16 v[246:247], v5 offset:18208
    s_waitcnt lgkmcnt(4)
    v_mfma_f32_16x16x32_bf16 v[64:67], v[236:239], v[104:107], v[64:67]
    ds_read_b64_tr_b16 v[224:225], v4 offset:24576
    v_mfma_f32_16x16x32_bf16 v[68:71], v[236:239], v[108:111], v[68:71]
    ds_read_b64_tr_b16 v[226:227], v4 offset:25600
    s_mov_b32 s23, 0x9800
    buffer_load_dwordx4 v[92:95], v7, s[8:11], s23 offen offset:0 sc1
    s_waitcnt lgkmcnt(4)
    v_mfma_f32_16x16x32_bf16 v[72:75], v[240:243], v[104:107], v[72:75]
    ds_read_b64_tr_b16 v[228:229], v5 offset:24608
    v_mfma_f32_16x16x32_bf16 v[76:79], v[240:243], v[108:111], v[76:79]
    ds_read_b64_tr_b16 v[230:231], v5 offset:25632
    s_waitcnt lgkmcnt(4)
    v_mfma_f32_16x16x32_bf16 v[80:83], v[244:247], v[104:107], v[80:83]
    ds_read_b64_tr_b16 v[232:233], v4 offset:24832
    v_mfma_f32_16x16x32_bf16 v[84:87], v[244:247], v[108:111], v[84:87]
    ds_read_b64_tr_b16 v[234:235], v4 offset:25856
    s_waitcnt vmcnt(9) lgkmcnt(4)
    v_mfma_f32_16x16x32_bf16 v[24:27], v[224:227], v[112:115], v[24:27]
    ds_read_b64_tr_b16 v[236:237], v5 offset:24864
    s_waitcnt vmcnt(8)
    v_mfma_f32_16x16x32_bf16 v[28:31], v[224:227], v[116:119], v[28:31]
    ds_read_b64_tr_b16 v[238:239], v5 offset:25888
    s_waitcnt lgkmcnt(4)
    v_mfma_f32_16x16x32_bf16 v[32:35], v[228:231], v[112:115], v[32:35]
    ds_read_b64_tr_b16 v[240:241], v4 offset:25088
    v_mfma_f32_16x16x32_bf16 v[36:39], v[228:231], v[116:119], v[36:39]
    ds_read_b64_tr_b16 v[242:243], v4 offset:26112
    s_mov_b32 s23, 0x1800
    buffer_load_dwordx4 v[96:99], v7, s[8:11], s23 offen offset:1024 sc1
    s_waitcnt lgkmcnt(4)
    v_mfma_f32_16x16x32_bf16 v[40:43], v[232:235], v[112:115], v[40:43]
    ds_read_b64_tr_b16 v[244:245], v5 offset:25120
    v_mfma_f32_16x16x32_bf16 v[44:47], v[232:235], v[116:119], v[44:47]
    ds_read_b64_tr_b16 v[246:247], v5 offset:26144
    s_waitcnt lgkmcnt(4)
    v_mfma_f32_16x16x32_bf16 v[48:51], v[236:239], v[112:115], v[48:51]
    ds_read_b64_tr_b16 v[224:225], v4 offset:25344
    v_mfma_f32_16x16x32_bf16 v[52:55], v[236:239], v[116:119], v[52:55]
    ds_read_b64_tr_b16 v[226:227], v4 offset:26368
    s_waitcnt lgkmcnt(4)
    v_mfma_f32_16x16x32_bf16 v[56:59], v[240:243], v[112:115], v[56:59]
    ds_read_b64_tr_b16 v[228:229], v5 offset:25376
    v_mfma_f32_16x16x32_bf16 v[60:63], v[240:243], v[116:119], v[60:63]
    ds_read_b64_tr_b16 v[230:231], v5 offset:26400
    s_waitcnt lgkmcnt(4)
    v_mfma_f32_16x16x32_bf16 v[64:67], v[244:247], v[112:115], v[64:67]
    v_mfma_f32_16x16x32_bf16 v[68:71], v[244:247], v[116:119], v[68:71]
    s_barrier
    ds_read_b64_tr_b16 v[232:233], v4 offset:32768
    ds_read_b64_tr_b16 v[234:235], v4 offset:33792
    s_mov_b32 s23, 0x9800
    buffer_load_dwordx4 v[100:103], v7, s[8:11], s23 offen offset:1024 sc1
    s_waitcnt lgkmcnt(4)
    v_mfma_f32_16x16x32_bf16 v[72:75], v[224:227], v[112:115], v[72:75]
    ds_read_b64_tr_b16 v[236:237], v5 offset:32800
    v_mfma_f32_16x16x32_bf16 v[76:79], v[224:227], v[116:119], v[76:79]
    s_add_u32 s22, s19, 0x200000
    s_add_u32 m0, s20, 0x0
    s_nop 0
    buffer_load_dwordx4 v3, s[4:7], s22 offen lds
    ds_read_b64_tr_b16 v[238:239], v5 offset:33824
    s_waitcnt lgkmcnt(4)
    v_mfma_f32_16x16x32_bf16 v[80:83], v[228:231], v[112:115], v[80:83]
    ds_read_b64_tr_b16 v[240:241], v4 offset:33024
    v_mfma_f32_16x16x32_bf16 v[84:87], v[228:231], v[116:119], v[84:87]
    ds_read_b64_tr_b16 v[242:243], v4 offset:34048
    s_waitcnt vmcnt(10) lgkmcnt(4)
    v_mfma_f32_16x16x32_bf16 v[24:27], v[232:235], v[120:123], v[24:27]
    ds_read_b64_tr_b16 v[244:245], v5 offset:33056
    s_waitcnt vmcnt(9)
    v_mfma_f32_16x16x32_bf16 v[28:31], v[232:235], v[124:127], v[28:31]
    ds_read_b64_tr_b16 v[246:247], v5 offset:34080
    s_waitcnt lgkmcnt(4)
    v_mfma_f32_16x16x32_bf16 v[32:35], v[236:239], v[120:123], v[32:35]
    ds_read_b64_tr_b16 v[224:225], v4 offset:33280
    v_mfma_f32_16x16x32_bf16 v[36:39], v[236:239], v[124:127], v[36:39]
    ds_read_b64_tr_b16 v[226:227], v4 offset:34304
    s_mov_b32 s23, 0x2000
    buffer_load_dwordx4 v[104:107], v7, s[8:11], s23 offen offset:0 sc1
    s_waitcnt lgkmcnt(4)
    v_mfma_f32_16x16x32_bf16 v[40:43], v[240:243], v[120:123], v[40:43]
    ds_read_b64_tr_b16 v[228:229], v5 offset:33312
    v_mfma_f32_16x16x32_bf16 v[44:47], v[240:243], v[124:127], v[44:47]
    s_add_u32 s22, s19, 0x208000
    s_add_u32 m0, s20, 0x400
    s_nop 0
    buffer_load_dwordx4 v3, s[4:7], s22 offen lds
    ds_read_b64_tr_b16 v[230:231], v5 offset:34336
    s_waitcnt lgkmcnt(4)
    v_mfma_f32_16x16x32_bf16 v[48:51], v[244:247], v[120:123], v[48:51]
    ds_read_b64_tr_b16 v[232:233], v4 offset:33536
    v_mfma_f32_16x16x32_bf16 v[52:55], v[244:247], v[124:127], v[52:55]
    ds_read_b64_tr_b16 v[234:235], v4 offset:34560
    s_waitcnt lgkmcnt(4)
    v_mfma_f32_16x16x32_bf16 v[56:59], v[224:227], v[120:123], v[56:59]
    ds_read_b64_tr_b16 v[236:237], v5 offset:33568
    v_mfma_f32_16x16x32_bf16 v[60:63], v[224:227], v[124:127], v[60:63]
    ds_read_b64_tr_b16 v[238:239], v5 offset:34592
    s_waitcnt lgkmcnt(4)
    v_mfma_f32_16x16x32_bf16 v[64:67], v[228:231], v[120:123], v[64:67]
    ds_read_b64_tr_b16 v[240:241], v4 offset:40960
    v_mfma_f32_16x16x32_bf16 v[68:71], v[228:231], v[124:127], v[68:71]
    ds_read_b64_tr_b16 v[242:243], v4 offset:41984
    s_mov_b32 s23, 0xa000
    buffer_load_dwordx4 v[108:111], v7, s[8:11], s23 offen offset:0 sc1
    s_waitcnt lgkmcnt(4)
    v_mfma_f32_16x16x32_bf16 v[72:75], v[232:235], v[120:123], v[72:75]
    ds_read_b64_tr_b16 v[244:245], v5 offset:40992
    v_mfma_f32_16x16x32_bf16 v[76:79], v[232:235], v[124:127], v[76:79]
    ds_read_b64_tr_b16 v[246:247], v5 offset:42016
    s_waitcnt lgkmcnt(4)
    v_mfma_f32_16x16x32_bf16 v[80:83], v[236:239], v[120:123], v[80:83]
    ds_read_b64_tr_b16 v[224:225], v4 offset:41216
    v_mfma_f32_16x16x32_bf16 v[84:87], v[236:239], v[124:127], v[84:87]
    ds_read_b64_tr_b16 v[226:227], v4 offset:42240
    s_waitcnt vmcnt(11) lgkmcnt(4)
    v_mfma_f32_16x16x32_bf16 v[24:27], v[240:243], v[128:131], v[24:27]
    ds_read_b64_tr_b16 v[228:229], v5 offset:41248
    s_waitcnt vmcnt(10)
    v_mfma_f32_16x16x32_bf16 v[28:31], v[240:243], v[132:135], v[28:31]
    ds_read_b64_tr_b16 v[230:231], v5 offset:42272
    s_waitcnt lgkmcnt(4)
    v_mfma_f32_16x16x32_bf16 v[32:35], v[244:247], v[128:131], v[32:35]
    ds_read_b64_tr_b16 v[232:233], v4 offset:41472
    v_mfma_f32_16x16x32_bf16 v[36:39], v[244:247], v[132:135], v[36:39]
    ds_read_b64_tr_b16 v[234:235], v4 offset:42496
    s_mov_b32 s23, 0x2000
    buffer_load_dwordx4 v[112:115], v7, s[8:11], s23 offen offset:1024 sc1
    s_waitcnt lgkmcnt(4)
    v_mfma_f32_16x16x32_bf16 v[40:43], v[224:227], v[128:131], v[40:43]
    ds_read_b64_tr_b16 v[236:237], v5 offset:41504
    v_mfma_f32_16x16x32_bf16 v[44:47], v[224:227], v[132:135], v[44:47]
    ds_read_b64_tr_b16 v[238:239], v5 offset:42528
    s_waitcnt lgkmcnt(4)
    v_mfma_f32_16x16x32_bf16 v[48:51], v[228:231], v[128:131], v[48:51]
    ds_read_b64_tr_b16 v[240:241], v4 offset:41728
    v_mfma_f32_16x16x32_bf16 v[52:55], v[228:231], v[132:135], v[52:55]
    ds_read_b64_tr_b16 v[242:243], v4 offset:42752
    s_waitcnt lgkmcnt(4)
    v_mfma_f32_16x16x32_bf16 v[56:59], v[232:235], v[128:131], v[56:59]
    ds_read_b64_tr_b16 v[244:245], v5 offset:41760
    v_mfma_f32_16x16x32_bf16 v[60:63], v[232:235], v[132:135], v[60:63]
    ds_read_b64_tr_b16 v[246:247], v5 offset:42784
    s_waitcnt lgkmcnt(4)
    v_mfma_f32_16x16x32_bf16 v[64:67], v[236:239], v[128:131], v[64:67]
    v_mfma_f32_16x16x32_bf16 v[68:71], v[236:239], v[132:135], v[68:71]
    s_waitcnt vmcnt(8)
    s_barrier
    ds_read_b64_tr_b16 v[224:225], v4 offset:49152
    ds_read_b64_tr_b16 v[226:227], v4 offset:50176
    s_mov_b32 s23, 0xa000
    buffer_load_dwordx4 v[116:119], v7, s[8:11], s23 offen offset:1024 sc1
    s_waitcnt lgkmcnt(4)
    v_mfma_f32_16x16x32_bf16 v[72:75], v[240:243], v[128:131], v[72:75]
    ds_read_b64_tr_b16 v[228:229], v5 offset:49184
    v_mfma_f32_16x16x32_bf16 v[76:79], v[240:243], v[132:135], v[76:79]
    s_add_u32 s22, s19, 0x280000
    s_add_u32 m0, s20, 0x4000
    s_nop 0
    buffer_load_dwordx4 v3, s[4:7], s22 offen lds
    ds_read_b64_tr_b16 v[230:231], v5 offset:50208
    s_waitcnt lgkmcnt(4)
    v_mfma_f32_16x16x32_bf16 v[80:83], v[244:247], v[128:131], v[80:83]
    ds_read_b64_tr_b16 v[232:233], v4 offset:49408
    v_mfma_f32_16x16x32_bf16 v[84:87], v[244:247], v[132:135], v[84:87]
    ds_read_b64_tr_b16 v[234:235], v4 offset:50432
    s_waitcnt lgkmcnt(4)
    v_mfma_f32_16x16x32_bf16 v[24:27], v[224:227], v[88:91], v[24:27]
    ds_read_b64_tr_b16 v[236:237], v5 offset:49440
    s_waitcnt vmcnt(9)
    v_mfma_f32_16x16x32_bf16 v[28:31], v[224:227], v[92:95], v[28:31]
    ds_read_b64_tr_b16 v[238:239], v5 offset:50464
    s_waitcnt lgkmcnt(4)
    v_mfma_f32_16x16x32_bf16 v[32:35], v[228:231], v[88:91], v[32:35]
    ds_read_b64_tr_b16 v[240:241], v4 offset:49664
    v_mfma_f32_16x16x32_bf16 v[36:39], v[228:231], v[92:95], v[36:39]
    ds_read_b64_tr_b16 v[242:243], v4 offset:50688
    s_mov_b32 s23, 0x2800
    buffer_load_dwordx4 v[120:123], v7, s[8:11], s23 offen offset:0 sc1
    s_waitcnt lgkmcnt(4)
    v_mfma_f32_16x16x32_bf16 v[40:43], v[232:235], v[88:91], v[40:43]
    ds_read_b64_tr_b16 v[244:245], v5 offset:49696
    v_mfma_f32_16x16x32_bf16 v[44:47], v[232:235], v[92:95], v[44:47]
    s_add_u32 s22, s19, 0x288000
    s_add_u32 m0, s20, 0x4400
    s_nop 0
    buffer_load_dwordx4 v3, s[4:7], s22 offen lds
    ds_read_b64_tr_b16 v[246:247], v5 offset:50720
    s_waitcnt lgkmcnt(4)
    v_mfma_f32_16x16x32_bf16 v[48:51], v[236:239], v[88:91], v[48:51]
    ds_read_b64_tr_b16 v[224:225], v4 offset:49920
    v_mfma_f32_16x16x32_bf16 v[52:55], v[236:239], v[92:95], v[52:55]
    ds_read_b64_tr_b16 v[226:227], v4 offset:50944
    s_waitcnt lgkmcnt(4)
    v_mfma_f32_16x16x32_bf16 v[56:59], v[240:243], v[88:91], v[56:59]
    ds_read_b64_tr_b16 v[228:229], v5 offset:49952
    v_mfma_f32_16x16x32_bf16 v[60:63], v[240:243], v[92:95], v[60:63]
    ds_read_b64_tr_b16 v[230:231], v5 offset:50976
    s_waitcnt lgkmcnt(4)
    v_mfma_f32_16x16x32_bf16 v[64:67], v[244:247], v[88:91], v[64:67]
    ds_read_b64_tr_b16 v[232:233], v4 offset:57344
    v_mfma_f32_16x16x32_bf16 v[68:71], v[244:247], v[92:95], v[68:71]
    ds_read_b64_tr_b16 v[234:235], v4 offset:58368
    s_mov_b32 s23, 0xa800
    buffer_load_dwordx4 v[124:127], v7, s[8:11], s23 offen offset:0 sc1
    s_waitcnt lgkmcnt(4)
    v_mfma_f32_16x16x32_bf16 v[72:75], v[224:227], v[88:91], v[72:75]
    ds_read_b64_tr_b16 v[236:237], v5 offset:57376
    v_mfma_f32_16x16x32_bf16 v[76:79], v[224:227], v[92:95], v[76:79]
    ds_read_b64_tr_b16 v[238:239], v5 offset:58400
    s_waitcnt lgkmcnt(4)
    v_mfma_f32_16x16x32_bf16 v[80:83], v[228:231], v[88:91], v[80:83]
    ds_read_b64_tr_b16 v[240:241], v4 offset:57600
    v_mfma_f32_16x16x32_bf16 v[84:87], v[228:231], v[92:95], v[84:87]
    ds_read_b64_tr_b16 v[242:243], v4 offset:58624
    s_waitcnt vmcnt(11) lgkmcnt(4)
    v_mfma_f32_16x16x32_bf16 v[24:27], v[232:235], v[96:99], v[24:27]
    ds_read_b64_tr_b16 v[244:245], v5 offset:57632
    s_waitcnt vmcnt(10)
    v_mfma_f32_16x16x32_bf16 v[28:31], v[232:235], v[100:103], v[28:31]
    ds_read_b64_tr_b16 v[246:247], v5 offset:58656
    s_waitcnt lgkmcnt(4)
    v_mfma_f32_16x16x32_bf16 v[32:35], v[236:239], v[96:99], v[32:35]
    ds_read_b64_tr_b16 v[224:225], v4 offset:57856
    v_mfma_f32_16x16x32_bf16 v[36:39], v[236:239], v[100:103], v[36:39]
    ds_read_b64_tr_b16 v[226:227], v4 offset:58880
    s_mov_b32 s23, 0x2800
    buffer_load_dwordx4 v[128:131], v7, s[8:11], s23 offen offset:1024 sc1
    s_waitcnt lgkmcnt(4)
    v_mfma_f32_16x16x32_bf16 v[40:43], v[240:243], v[96:99], v[40:43]
    ds_read_b64_tr_b16 v[228:229], v5 offset:57888
    v_mfma_f32_16x16x32_bf16 v[44:47], v[240:243], v[100:103], v[44:47]
    ds_read_b64_tr_b16 v[230:231], v5 offset:58912
    s_waitcnt lgkmcnt(4)
    v_mfma_f32_16x16x32_bf16 v[48:51], v[244:247], v[96:99], v[48:51]
    ds_read_b64_tr_b16 v[232:233], v4 offset:58112
    v_mfma_f32_16x16x32_bf16 v[52:55], v[244:247], v[100:103], v[52:55]
    ds_read_b64_tr_b16 v[234:235], v4 offset:59136
    s_waitcnt lgkmcnt(4)
    v_mfma_f32_16x16x32_bf16 v[56:59], v[224:227], v[96:99], v[56:59]
    ds_read_b64_tr_b16 v[236:237], v5 offset:58144
    v_mfma_f32_16x16x32_bf16 v[60:63], v[224:227], v[100:103], v[60:63]
    ds_read_b64_tr_b16 v[238:239], v5 offset:59168
    s_waitcnt lgkmcnt(4)
    v_mfma_f32_16x16x32_bf16 v[64:67], v[228:231], v[96:99], v[64:67]
    v_mfma_f32_16x16x32_bf16 v[68:71], v[228:231], v[100:103], v[68:71]
    s_waitcnt vmcnt(8)
    s_barrier
    ds_read_b64_tr_b16 v[240:241], v4 offset:0
    ds_read_b64_tr_b16 v[242:243], v4 offset:1024
    s_mov_b32 s23, 0xa800
    buffer_load_dwordx4 v[132:135], v7, s[8:11], s23 offen offset:1024 sc1
    s_waitcnt lgkmcnt(4)
    v_mfma_f32_16x16x32_bf16 v[72:75], v[232:235], v[96:99], v[72:75]
    ds_read_b64_tr_b16 v[244:245], v5 offset:32
    v_mfma_f32_16x16x32_bf16 v[76:79], v[232:235], v[100:103], v[76:79]
    s_add_u32 s22, s19, 0x300000
    s_add_u32 m0, s20, 0x8000
    s_nop 0
    buffer_load_dwordx4 v3, s[4:7], s22 offen lds
    ds_read_b64_tr_b16 v[246:247], v5 offset:1056
    s_waitcnt lgkmcnt(4)
    v_mfma_f32_16x16x32_bf16 v[80:83], v[236:239], v[96:99], v[80:83]
    ds_read_b64_tr_b16 v[224:225], v4 offset:256
    v_mfma_f32_16x16x32_bf16 v[84:87], v[236:239], v[100:103], v[84:87]
    ds_read_b64_tr_b16 v[226:227], v4 offset:1280
    s_waitcnt lgkmcnt(4)
    v_mfma_f32_16x16x32_bf16 v[24:27], v[240:243], v[104:107], v[24:27]
    ds_read_b64_tr_b16 v[228:229], v5 offset:288
    s_waitcnt vmcnt(9)
    v_mfma_f32_16x16x32_bf16 v[28:31], v[240:243], v[108:111], v[28:31]
    ds_read_b64_tr_b16 v[230:231], v5 offset:1312
    s_waitcnt lgkmcnt(4)
    v_mfma_f32_16x16x32_bf16 v[32:35], v[244:247], v[104:107], v[32:35]
    ds_read_b64_tr_b16 v[232:233], v4 offset:512
    v_mfma_f32_16x16x32_bf16 v[36:39], v[244:247], v[108:111], v[36:39]
    ds_read_b64_tr_b16 v[234:235], v4 offset:1536
    s_mov_b32 s23, 0x3000
    buffer_load_dwordx4 v[88:91], v7, s[8:11], s23 offen offset:0 sc1
    s_waitcnt lgkmcnt(4)
    v_mfma_f32_16x16x32_bf16 v[40:43], v[224:227], v[104:107], v[40:43]
    ds_read_b64_tr_b16 v[236:237], v5 offset:544
    v_mfma_f32_16x16x32_bf16 v[44:47], v[224:227], v[108:111], v[44:47]
    s_add_u32 s22, s19, 0x308000
    s_add_u32 m0, s20, 0x8400
    s_nop 0
    buffer_load_dwordx4 v3, s[4:7], s22 offen lds
    ds_read_b64_tr_b16 v[238:239], v5 offset:1568
    s_waitcnt lgkmcnt(4)
    v_mfma_f32_16x16x32_bf16 v[48:51], v[228:231], v[104:107], v[48:51]
    ds_read_b64_tr_b16 v[240:241], v4 offset:768
    v_mfma_f32_16x16x32_bf16 v[52:55], v[228:231], v[108:111], v[52:55]
    ds_read_b64_tr_b16 v[242:243], v4 offset:1792
    s_waitcnt lgkmcnt(4)
    v_mfma_f32_16x16x32_bf16 v[56:59], v[232:235], v[104:107], v[56:59]
    ds_read_b64_tr_b16 v[244:245], v5 offset:800
    v_mfma_f32_16x16x32_bf16 v[60:63], v[232:235], v[108:111], v[60:63]
    ds_read_b64_tr_b16 v[246:247], v5 offset:1824
    s_waitcnt lgkmcnt(4)
    v_mfma_f32_16x16x32_bf16 v[64:67], v[236:239], v[104:107], v[64:67]
    ds_read_b64_tr_b16 v[224:225], v4 offset:8192
    v_mfma_f32_16x16x32_bf16 v[68:71], v[236:239], v[108:111], v[68:71]
    ds_read_b64_tr_b16 v[226:227], v4 offset:9216
    s_mov_b32 s23, 0xb000
    buffer_load_dwordx4 v[92:95], v7, s[8:11], s23 offen offset:0 sc1
    s_waitcnt lgkmcnt(4)
    v_mfma_f32_16x16x32_bf16 v[72:75], v[240:243], v[104:107], v[72:75]
    ds_read_b64_tr_b16 v[228:229], v5 offset:8224
    v_mfma_f32_16x16x32_bf16 v[76:79], v[240:243], v[108:111], v[76:79]
    ds_read_b64_tr_b16 v[230:231], v5 offset:9248
    s_waitcnt lgkmcnt(4)
    v_mfma_f32_16x16x32_bf16 v[80:83], v[244:247], v[104:107], v[80:83]
    ds_read_b64_tr_b16 v[232:233], v4 offset:8448
    v_mfma_f32_16x16x32_bf16 v[84:87], v[244:247], v[108:111], v[84:87]
    ds_read_b64_tr_b16 v[234:235], v4 offset:9472
    s_waitcnt vmcnt(11) lgkmcnt(4)
    v_mfma_f32_16x16x32_bf16 v[24:27], v[224:227], v[112:115], v[24:27]
    ds_read_b64_tr_b16 v[236:237], v5 offset:8480
    s_waitcnt vmcnt(10)
    v_mfma_f32_16x16x32_bf16 v[28:31], v[224:227], v[116:119], v[28:31]
    ds_read_b64_tr_b16 v[238:239], v5 offset:9504
    s_waitcnt lgkmcnt(4)
    v_mfma_f32_16x16x32_bf16 v[32:35], v[228:231], v[112:115], v[32:35]
    ds_read_b64_tr_b16 v[240:241], v4 offset:8704
    v_mfma_f32_16x16x32_bf16 v[36:39], v[228:231], v[116:119], v[36:39]
    ds_read_b64_tr_b16 v[242:243], v4 offset:9728
    s_mov_b32 s23, 0x3000
    buffer_load_dwordx4 v[96:99], v7, s[8:11], s23 offen offset:1024 sc1
    s_waitcnt lgkmcnt(4)
    v_mfma_f32_16x16x32_bf16 v[40:43], v[232:235], v[112:115], v[40:43]
    ds_read_b64_tr_b16 v[244:245], v5 offset:8736
    v_mfma_f32_16x16x32_bf16 v[44:47], v[232:235], v[116:119], v[44:47]
    ds_read_b64_tr_b16 v[246:247], v5 offset:9760
    s_waitcnt lgkmcnt(4)
    v_mfma_f32_16x16x32_bf16 v[48:51], v[236:239], v[112:115], v[48:51]
    ds_read_b64_tr_b16 v[224:225], v4 offset:8960
    v_mfma_f32_16x16x32_bf16 v[52:55], v[236:239], v[116:119], v[52:55]
    ds_read_b64_tr_b16 v[226:227], v4 offset:9984
    s_waitcnt lgkmcnt(4)
    v_mfma_f32_16x16x32_bf16 v[56:59], v[240:243], v[112:115], v[56:59]
    ds_read_b64_tr_b16 v[228:229], v5 offset:8992
    v_mfma_f32_16x16x32_bf16 v[60:63], v[240:243], v[116:119], v[60:63]
    ds_read_b64_tr_b16 v[230:231], v5 offset:10016
    s_waitcnt lgkmcnt(4)
    v_mfma_f32_16x16x32_bf16 v[64:67], v[244:247], v[112:115], v[64:67]
    v_mfma_f32_16x16x32_bf16 v[68:71], v[244:247], v[116:119], v[68:71]
    s_waitcnt vmcnt(8)
    s_barrier
    ds_read_b64_tr_b16 v[232:233], v4 offset:16384
    ds_read_b64_tr_b16 v[234:235], v4 offset:17408
    s_mov_b32 s23, 0xb000
    buffer_load_dwordx4 v[100:103], v7, s[8:11], s23 offen offset:1024 sc1
    s_waitcnt lgkmcnt(4)
    v_mfma_f32_16x16x32_bf16 v[72:75], v[224:227], v[112:115], v[72:75]
    ds_read_b64_tr_b16 v[236:237], v5 offset:16416
    v_mfma_f32_16x16x32_bf16 v[76:79], v[224:227], v[116:119], v[76:79]
    s_add_u32 s22, s19, 0x380000
    s_add_u32 m0, s20, 0xc000
    s_nop 0
    buffer_load_dwordx4 v3, s[4:7], s22 offen lds
    ds_read_b64_tr_b16 v[238:239], v5 offset:17440
    s_waitcnt lgkmcnt(4)
    v_mfma_f32_16x16x32_bf16 v[80:83], v[228:231], v[112:115], v[80:83]
    ds_read_b64_tr_b16 v[240:241], v4 offset:16640
    v_mfma_f32_16x16x32_bf16 v[84:87], v[228:231], v[116:119], v[84:87]
    ds_read_b64_tr_b16 v[242:243], v4 offset:17664
    s_waitcnt lgkmcnt(4)
    v_mfma_f32_16x16x32_bf16 v[24:27], v[232:235], v[120:123], v[24:27]
    ds_read_b64_tr_b16 v[244:245], v5 offset:16672
    s_waitcnt vmcnt(9)
    v_mfma_f32_16x16x32_bf16 v[28:31], v[232:235], v[124:127], v[28:31]
    ds_read_b64_tr_b16 v[246:247], v5 offset:17696
    s_waitcnt lgkmcnt(4)
    v_mfma_f32_16x16x32_bf16 v[32:35], v[236:239], v[120:123], v[32:35]
    ds_read_b64_tr_b16 v[224:225], v4 offset:16896
    v_mfma_f32_16x16x32_bf16 v[36:39], v[236:239], v[124:127], v[36:39]
    ds_read_b64_tr_b16 v[226:227], v4 offset:17920
    s_mov_b32 s23, 0x3800
    buffer_load_dwordx4 v[104:107], v7, s[8:11], s23 offen offset:0 sc1
    s_waitcnt lgkmcnt(4)
    v_mfma_f32_16x16x32_bf16 v[40:43], v[240:243], v[120:123], v[40:43]
    ds_read_b64_tr_b16 v[228:229], v5 offset:16928
    v_mfma_f32_16x16x32_bf16 v[44:47], v[240:243], v[124:127], v[44:47]
    s_add_u32 s22, s19, 0x388000
    s_add_u32 m0, s20, 0xc400
    s_nop 0
    buffer_load_dwordx4 v3, s[4:7], s22 offen lds
    ds_read_b64_tr_b16 v[230:231], v5 offset:17952
    s_waitcnt lgkmcnt(4)
    v_mfma_f32_16x16x32_bf16 v[48:51], v[244:247], v[120:123], v[48:51]
    ds_read_b64_tr_b16 v[232:233], v4 offset:17152
    v_mfma_f32_16x16x32_bf16 v[52:55], v[244:247], v[124:127], v[52:55]
    ds_read_b64_tr_b16 v[234:235], v4 offset:18176
    s_waitcnt lgkmcnt(4)
    v_mfma_f32_16x16x32_bf16 v[56:59], v[224:227], v[120:123], v[56:59]
    ds_read_b64_tr_b16 v[236:237], v5 offset:17184
    v_mfma_f32_16x16x32_bf16 v[60:63], v[224:227], v[124:127], v[60:63]
    ds_read_b64_tr_b16 v[238:239], v5 offset:18208
    s_waitcnt lgkmcnt(4)
    v_mfma_f32_16x16x32_bf16 v[64:67], v[228:231], v[120:123], v[64:67]
    ds_read_b64_tr_b16 v[240:241], v4 offset:24576
    v_mfma_f32_16x16x32_bf16 v[68:71], v[228:231], v[124:127], v[68:71]
    ds_read_b64_tr_b16 v[242:243], v4 offset:25600
    s_mov_b32 s23, 0xb800
    buffer_load_dwordx4 v[108:111], v7, s[8:11], s23 offen offset:0 sc1
    s_waitcnt lgkmcnt(4)
    v_mfma_f32_16x16x32_bf16 v[72:75], v[232:235], v[120:123], v[72:75]
    ds_read_b64_tr_b16 v[244:245], v5 offset:24608
    v_mfma_f32_16x16x32_bf16 v[76:79], v[232:235], v[124:127], v[76:79]
    ds_read_b64_tr_b16 v[246:247], v5 offset:25632
    s_waitcnt lgkmcnt(4)
    v_mfma_f32_16x16x32_bf16 v[80:83], v[236:239], v[120:123], v[80:83]
    ds_read_b64_tr_b16 v[224:225], v4 offset:24832
    v_mfma_f32_16x16x32_bf16 v[84:87], v[236:239], v[124:127], v[84:87]
    ds_read_b64_tr_b16 v[226:227], v4 offset:25856
    s_waitcnt vmcnt(11) lgkmcnt(4)
    v_mfma_f32_16x16x32_bf16 v[24:27], v[240:243], v[128:131], v[24:27]
    ds_read_b64_tr_b16 v[228:229], v5 offset:24864
    s_waitcnt vmcnt(10)
    v_mfma_f32_16x16x32_bf16 v[28:31], v[240:243], v[132:135], v[28:31]
    ds_read_b64_tr_b16 v[230:231], v5 offset:25888
    s_waitcnt lgkmcnt(4)
    v_mfma_f32_16x16x32_bf16 v[32:35], v[244:247], v[128:131], v[32:35]
    ds_read_b64_tr_b16 v[232:233], v4 offset:25088
    v_mfma_f32_16x16x32_bf16 v[36:39], v[244:247], v[132:135], v[36:39]
    ds_read_b64_tr_b16 v[234:235], v4 offset:26112
    s_mov_b32 s23, 0x3800
    buffer_load_dwordx4 v[112:115], v7, s[8:11], s23 offen offset:1024 sc1
    s_waitcnt lgkmcnt(4)
    v_mfma_f32_16x16x32_bf16 v[40:43], v[224:227], v[128:131], v[40:43]
    ds_read_b64_tr_b16 v[236:237], v5 offset:25120
    v_mfma_f32_16x16x32_bf16 v[44:47], v[224:227], v[132:135], v[44:47]
    ds_read_b64_tr_b16 v[238:239], v5 offset:26144
    s_waitcnt lgkmcnt(4)
    v_mfma_f32_16x16x32_bf16 v[48:51], v[228:231], v[128:131], v[48:51]
    ds_read_b64_tr_b16 v[240:241], v4 offset:25344
    v_mfma_f32_16x16x32_bf16 v[52:55], v[228:231], v[132:135], v[52:55]
    ds_read_b64_tr_b16 v[242:243], v4 offset:26368
    s_waitcnt lgkmcnt(4)
    v_mfma_f32_16x16x32_bf16 v[56:59], v[232:235], v[128:131], v[56:59]
    ds_read_b64_tr_b16 v[244:245], v5 offset:25376
    v_mfma_f32_16x16x32_bf16 v[60:63], v[232:235], v[132:135], v[60:63]
    ds_read_b64_tr_b16 v[246:247], v5 offset:26400
    s_waitcnt lgkmcnt(4)
    v_mfma_f32_16x16x32_bf16 v[64:67], v[236:239], v[128:131], v[64:67]
    v_mfma_f32_16x16x32_bf16 v[68:71], v[236:239], v[132:135], v[68:71]
    s_waitcnt vmcnt(8)
    s_barrier
    ds_read_b64_tr_b16 v[224:225], v4 offset:32768
    ds_read_b64_tr_b16 v[226:227], v4 offset:33792
    s_mov_b32 s23, 0xb800
    buffer_load_dwordx4 v[116:119], v7, s[8:11], s23 offen offset:1024 sc1
    s_waitcnt lgkmcnt(4)
    v_mfma_f32_16x16x32_bf16 v[72:75], v[240:243], v[128:131], v[72:75]
    ds_read_b64_tr_b16 v[228:229], v5 offset:32800
    v_mfma_f32_16x16x32_bf16 v[76:79], v[240:243], v[132:135], v[76:79]
    s_add_u32 s22, s19, 0x400000
    s_add_u32 m0, s20, 0x0
    s_nop 0
    buffer_load_dwordx4 v3, s[4:7], s22 offen lds
    ds_read_b64_tr_b16 v[230:231], v5 offset:33824
    s_waitcnt lgkmcnt(4)
    v_mfma_f32_16x16x32_bf16 v[80:83], v[244:247], v[128:131], v[80:83]
    ds_read_b64_tr_b16 v[232:233], v4 offset:33024
    v_mfma_f32_16x16x32_bf16 v[84:87], v[244:247], v[132:135], v[84:87]
    ds_read_b64_tr_b16 v[234:235], v4 offset:34048
    s_waitcnt lgkmcnt(4)
    v_mfma_f32_16x16x32_bf16 v[24:27], v[224:227], v[88:91], v[24:27]
    ds_read_b64_tr_b16 v[236:237], v5 offset:33056
    s_waitcnt vmcnt(9)
    v_mfma_f32_16x16x32_bf16 v[28:31], v[224:227], v[92:95], v[28:31]
    ds_read_b64_tr_b16 v[238:239], v5 offset:34080
    s_waitcnt lgkmcnt(4)
    v_mfma_f32_16x16x32_bf16 v[32:35], v[228:231], v[88:91], v[32:35]
    ds_read_b64_tr_b16 v[240:241], v4 offset:33280
    v_mfma_f32_16x16x32_bf16 v[36:39], v[228:231], v[92:95], v[36:39]
    ds_read_b64_tr_b16 v[242:243], v4 offset:34304
    s_mov_b32 s23, 0x4000
    buffer_load_dwordx4 v[120:123], v7, s[8:11], s23 offen offset:0 sc1
    s_waitcnt lgkmcnt(4)
    v_mfma_f32_16x16x32_bf16 v[40:43], v[232:235], v[88:91], v[40:43]
    ds_read_b64_tr_b16 v[244:245], v5 offset:33312
    v_mfma_f32_16x16x32_bf16 v[44:47], v[232:235], v[92:95], v[44:47]
    s_add_u32 s22, s19, 0x408000
    s_add_u32 m0, s20, 0x400
    s_nop 0
    buffer_load_dwordx4 v3, s[4:7], s22 offen lds
    ds_read_b64_tr_b16 v[246:247], v5 offset:34336
    s_waitcnt lgkmcnt(4)
    v_mfma_f32_16x16x32_bf16 v[48:51], v[236:239], v[88:91], v[48:51]
    ds_read_b64_tr_b16 v[224:225], v4 offset:33536
    v_mfma_f32_16x16x32_bf16 v[52:55], v[236:239], v[92:95], v[52:55]
    ds_read_b64_tr_b16 v[226:227], v4 offset:34560
    s_waitcnt lgkmcnt(4)
    v_mfma_f32_16x16x32_bf16 v[56:59], v[240:243], v[88:91], v[56:59]
    ds_read_b64_tr_b16 v[228:229], v5 offset:33568
    v_mfma_f32_16x16x32_bf16 v[60:63], v[240:243], v[92:95], v[60:63]
    ds_read_b64_tr_b16 v[230:231], v5 offset:34592
    s_waitcnt lgkmcnt(4)
    v_mfma_f32_16x16x32_bf16 v[64:67], v[244:247], v[88:91], v[64:67]
    ds_read_b64_tr_b16 v[232:233], v4 offset:40960
    v_mfma_f32_16x16x32_bf16 v[68:71], v[244:247], v[92:95], v[68:71]
    ds_read_b64_tr_b16 v[234:235], v4 offset:41984
    s_mov_b32 s23, 0xc000
    buffer_load_dwordx4 v[124:127], v7, s[8:11], s23 offen offset:0 sc1
    s_waitcnt lgkmcnt(4)
    v_mfma_f32_16x16x32_bf16 v[72:75], v[224:227], v[88:91], v[72:75]
    ds_read_b64_tr_b16 v[236:237], v5 offset:40992
    v_lshrrev_b32 v21, 4, v1
    v_lshlrev_b32 v21, 9, v21
    v_and_b32 v20, 15, v1
    v_lshl_add_u32 v21, v20, 4, v21
    s_lshr_b32 s18, s12, 3
    s_lshl_b32 s18, s18, 11
    s_add_u32 s18, s18, 0x528100
    buffer_load_dwordx4 v[12:15], v21, s[8:11], s18 offen sc1
    v_mfma_f32_16x16x32_bf16 v[76:79], v[224:227], v[92:95], v[76:79]
    ds_read_b64_tr_b16 v[238:239], v5 offset:42016
    s_waitcnt lgkmcnt(4)
    v_mfma_f32_16x16x32_bf16 v[80:83], v[228:231], v[88:91], v[80:83]
    ds_read_b64_tr_b16 v[240:241], v4 offset:41216
    v_mfma_f32_16x16x32_bf16 v[84:87], v[228:231], v[92:95], v[84:87]
    ds_read_b64_tr_b16 v[242:243], v4 offset:42240
    s_waitcnt vmcnt(12) lgkmcnt(4)
    v_mfma_f32_16x16x32_bf16 v[24:27], v[232:235], v[96:99], v[24:27]
    ds_read_b64_tr_b16 v[244:245], v5 offset:41248
    s_waitcnt vmcnt(11)
    v_mfma_f32_16x16x32_bf16 v[28:31], v[232:235], v[100:103], v[28:31]
    ds_read_b64_tr_b16 v[246:247], v5 offset:42272
    s_waitcnt lgkmcnt(4)
    v_mfma_f32_16x16x32_bf16 v[32:35], v[236:239], v[96:99], v[32:35]
    ds_read_b64_tr_b16 v[224:225], v4 offset:41472
    v_mfma_f32_16x16x32_bf16 v[36:39], v[236:239], v[100:103], v[36:39]
    ds_read_b64_tr_b16 v[226:227], v4 offset:42496
    s_mov_b32 s23, 0x4000
    buffer_load_dwordx4 v[128:131], v7, s[8:11], s23 offen offset:1024 sc1
    s_waitcnt lgkmcnt(4)
    v_mfma_f32_16x16x32_bf16 v[40:43], v[240:243], v[96:99], v[40:43]
    ds_read_b64_tr_b16 v[228:229], v5 offset:41504
    v_mfma_f32_16x16x32_bf16 v[44:47], v[240:243], v[100:103], v[44:47]
    ds_read_b64_tr_b16 v[230:231], v5 offset:42528
    s_waitcnt lgkmcnt(4)
    v_mfma_f32_16x16x32_bf16 v[48:51], v[244:247], v[96:99], v[48:51]
    ds_read_b64_tr_b16 v[232:233], v4 offset:41728
    v_mfma_f32_16x16x32_bf16 v[52:55], v[244:247], v[100:103], v[52:55]
    ds_read_b64_tr_b16 v[234:235], v4 offset:42752
    s_waitcnt lgkmcnt(4)
    v_mfma_f32_16x16x32_bf16 v[56:59], v[224:227], v[96:99], v[56:59]
    ds_read_b64_tr_b16 v[236:237], v5 offset:41760
    v_mfma_f32_16x16x32_bf16 v[60:63], v[224:227], v[100:103], v[60:63]
    ds_read_b64_tr_b16 v[238:239], v5 offset:42784
    s_waitcnt lgkmcnt(4)
    v_mfma_f32_16x16x32_bf16 v[64:67], v[228:231], v[96:99], v[64:67]
    v_mfma_f32_16x16x32_bf16 v[68:71], v[228:231], v[100:103], v[68:71]
    s_waitcnt vmcnt(9)
    s_barrier
    ds_read_b64_tr_b16 v[240:241], v4 offset:49152
    ds_read_b64_tr_b16 v[242:243], v4 offset:50176
    s_mov_b32 s23, 0xc000
    buffer_load_dwordx4 v[132:135], v7, s[8:11], s23 offen offset:1024 sc1
    s_waitcnt lgkmcnt(4)
    v_mfma_f32_16x16x32_bf16 v[72:75], v[232:235], v[96:99], v[72:75]
    ds_read_b64_tr_b16 v[244:245], v5 offset:49184
    v_mfma_f32_16x16x32_bf16 v[76:79], v[232:235], v[100:103], v[76:79]
    s_add_u32 s22, s19, 0x480000
    s_add_u32 m0, s20, 0x4000
    s_nop 0
    buffer_load_dwordx4 v3, s[4:7], s22 offen lds
    ds_read_b64_tr_b16 v[246:247], v5 offset:50208
    s_waitcnt lgkmcnt(4)
    v_mfma_f32_16x16x32_bf16 v[80:83], v[236:239], v[96:99], v[80:83]
    ds_read_b64_tr_b16 v[224:225], v4 offset:49408
    v_mfma_f32_16x16x32_bf16 v[84:87], v[236:239], v[100:103], v[84:87]
    ds_read_b64_tr_b16 v[226:227], v4 offset:50432
    s_waitcnt lgkmcnt(4)
    v_mfma_f32_16x16x32_bf16 v[24:27], v[240:243], v[104:107], v[24:27]
    ds_read_b64_tr_b16 v[228:229], v5 offset:49440
    s_waitcnt vmcnt(10)
    v_mfma_f32_16x16x32_bf16 v[28:31], v[240:243], v[108:111], v[28:31]
    ds_read_b64_tr_b16 v[230:231], v5 offset:50464
    s_waitcnt lgkmcnt(4)
    v_mfma_f32_16x16x32_bf16 v[32:35], v[244:247], v[104:107], v[32:35]
    ds_read_b64_tr_b16 v[232:233], v4 offset:49664
    v_mfma_f32_16x16x32_bf16 v[36:39], v[244:247], v[108:111], v[36:39]
    ds_read_b64_tr_b16 v[234:235], v4 offset:50688
    s_mov_b32 s23, 0x4800
    buffer_load_dwordx4 v[88:91], v7, s[8:11], s23 offen offset:0 sc1
    s_waitcnt lgkmcnt(4)
    v_mfma_f32_16x16x32_bf16 v[40:43], v[224:227], v[104:107], v[40:43]
    ds_read_b64_tr_b16 v[236:237], v5 offset:49696
    v_mfma_f32_16x16x32_bf16 v[44:47], v[224:227], v[108:111], v[44:47]
    s_add_u32 s22, s19, 0x488000
    s_add_u32 m0, s20, 0x4400
    s_nop 0
    buffer_load_dwordx4 v3, s[4:7], s22 offen lds
    ds_read_b64_tr_b16 v[238:239], v5 offset:50720
    s_waitcnt lgkmcnt(4)
    v_mfma_f32_16x16x32_bf16 v[48:51], v[228:231], v[104:107], v[48:51]
    ds_read_b64_tr_b16 v[240:241], v4 offset:49920
    v_mfma_f32_16x16x32_bf16 v[52:55], v[228:231], v[108:111], v[52:55]
    ds_read_b64_tr_b16 v[242:243], v4 offset:50944
    s_waitcnt lgkmcnt(4)
    v_mfma_f32_16x16x32_bf16 v[56:59], v[232:235], v[104:107], v[56:59]
    ds_read_b64_tr_b16 v[244:245], v5 offset:49952
    v_mfma_f32_16x16x32_bf16 v[60:63], v[232:235], v[108:111], v[60:63]
    ds_read_b64_tr_b16 v[246:247], v5 offset:50976
    s_waitcnt lgkmcnt(4)
    v_mfma_f32_16x16x32_bf16 v[64:67], v[236:239], v[104:107], v[64:67]
    ds_read_b64_tr_b16 v[224:225], v4 offset:57344
    v_mfma_f32_16x16x32_bf16 v[68:71], v[236:239], v[108:111], v[68:71]
    ds_read_b64_tr_b16 v[226:227], v4 offset:58368
    s_mov_b32 s23, 0xc800
    buffer_load_dwordx4 v[92:95], v7, s[8:11], s23 offen offset:0 sc1
    s_waitcnt lgkmcnt(4)
    v_mfma_f32_16x16x32_bf16 v[72:75], v[240:243], v[104:107], v[72:75]
    ds_read_b64_tr_b16 v[228:229], v5 offset:57376
    v_mfma_f32_16x16x32_bf16 v[76:79], v[240:243], v[108:111], v[76:79]
    ds_read_b64_tr_b16 v[230:231], v5 offset:58400
    s_waitcnt lgkmcnt(4)
    v_mfma_f32_16x16x32_bf16 v[80:83], v[244:247], v[104:107], v[80:83]
    ds_read_b64_tr_b16 v[232:233], v4 offset:57600
    v_mfma_f32_16x16x32_bf16 v[84:87], v[244:247], v[108:111], v[84:87]
    ds_read_b64_tr_b16 v[234:235], v4 offset:58624
    s_waitcnt vmcnt(12) lgkmcnt(4)
    v_mfma_f32_16x16x32_bf16 v[24:27], v[224:227], v[112:115], v[24:27]
    ds_read_b64_tr_b16 v[236:237], v5 offset:57632
    s_waitcnt vmcnt(11)
    v_mfma_f32_16x16x32_bf16 v[28:31], v[224:227], v[116:119], v[28:31]
    ds_read_b64_tr_b16 v[238:239], v5 offset:58656
    s_waitcnt lgkmcnt(4)
    v_mfma_f32_16x16x32_bf16 v[32:35], v[228:231], v[112:115], v[32:35]
    ds_read_b64_tr_b16 v[240:241], v4 offset:57856
    v_mfma_f32_16x16x32_bf16 v[36:39], v[228:231], v[116:119], v[36:39]
    ds_read_b64_tr_b16 v[242:243], v4 offset:58880
    s_mov_b32 s23, 0x4800
    buffer_load_dwordx4 v[96:99], v7, s[8:11], s23 offen offset:1024 sc1
    s_waitcnt lgkmcnt(4)
    v_mfma_f32_16x16x32_bf16 v[40:43], v[232:235], v[112:115], v[40:43]
    ds_read_b64_tr_b16 v[244:245], v5 offset:57888
    v_mfma_f32_16x16x32_bf16 v[44:47], v[232:235], v[116:119], v[44:47]
    ds_read_b64_tr_b16 v[246:247], v5 offset:58912
    s_waitcnt lgkmcnt(4)
    v_mfma_f32_16x16x32_bf16 v[48:51], v[236:239], v[112:115], v[48:51]
    ds_read_b64_tr_b16 v[224:225], v4 offset:58112
    v_mfma_f32_16x16x32_bf16 v[52:55], v[236:239], v[116:119], v[52:55]
    ds_read_b64_tr_b16 v[226:227], v4 offset:59136
    s_waitcnt lgkmcnt(4)
    v_mfma_f32_16x16x32_bf16 v[56:59], v[240:243], v[112:115], v[56:59]
    ds_read_b64_tr_b16 v[228:229], v5 offset:58144
    v_mfma_f32_16x16x32_bf16 v[60:63], v[240:243], v[116:119], v[60:63]
    ds_read_b64_tr_b16 v[230:231], v5 offset:59168
    s_waitcnt lgkmcnt(4)
    v_mfma_f32_16x16x32_bf16 v[64:67], v[244:247], v[112:115], v[64:67]
    v_mfma_f32_16x16x32_bf16 v[68:71], v[244:247], v[116:119], v[68:71]
    s_waitcnt vmcnt(9)
    s_barrier
    ds_read_b64_tr_b16 v[232:233], v4 offset:0
    ds_read_b64_tr_b16 v[234:235], v4 offset:1024
    s_mov_b32 s23, 0xc800
    buffer_load_dwordx4 v[100:103], v7, s[8:11], s23 offen offset:1024 sc1
    s_waitcnt lgkmcnt(4)
    v_mfma_f32_16x16x32_bf16 v[72:75], v[224:227], v[112:115], v[72:75]
    ds_read_b64_tr_b16 v[236:237], v5 offset:32
    v_mfma_f32_16x16x32_bf16 v[76:79], v[224:227], v[116:119], v[76:79]
    s_add_u32 s22, s19, 0x500000
    s_add_u32 m0, s20, 0x8000
    s_nop 0
    buffer_load_dwordx4 v3, s[4:7], s22 offen lds
    ds_read_b64_tr_b16 v[238:239], v5 offset:1056
    s_waitcnt lgkmcnt(4)
    v_mfma_f32_16x16x32_bf16 v[80:83], v[228:231], v[112:115], v[80:83]
    ds_read_b64_tr_b16 v[240:241], v4 offset:256
    v_mfma_f32_16x16x32_bf16 v[84:87], v[228:231], v[116:119], v[84:87]
    ds_read_b64_tr_b16 v[242:243], v4 offset:1280
    s_waitcnt lgkmcnt(4)
    v_mfma_f32_16x16x32_bf16 v[24:27], v[232:235], v[120:123], v[24:27]
    ds_read_b64_tr_b16 v[244:245], v5 offset:288
    s_waitcnt vmcnt(10)
    v_mfma_f32_16x16x32_bf16 v[28:31], v[232:235], v[124:127], v[28:31]
    ds_read_b64_tr_b16 v[246:247], v5 offset:1312
    s_waitcnt lgkmcnt(4)
    v_mfma_f32_16x16x32_bf16 v[32:35], v[236:239], v[120:123], v[32:35]
    ds_read_b64_tr_b16 v[224:225], v4 offset:512
    v_mfma_f32_16x16x32_bf16 v[36:39], v[236:239], v[124:127], v[36:39]
    ds_read_b64_tr_b16 v[226:227], v4 offset:1536
    s_mov_b32 s23, 0x5000
    buffer_load_dwordx4 v[104:107], v7, s[8:11], s23 offen offset:0 sc1
    s_waitcnt lgkmcnt(4)
    v_mfma_f32_16x16x32_bf16 v[40:43], v[240:243], v[120:123], v[40:43]
    ds_read_b64_tr_b16 v[228:229], v5 offset:544
    v_mfma_f32_16x16x32_bf16 v[44:47], v[240:243], v[124:127], v[44:47]
    s_add_u32 s22, s19, 0x508000
    s_add_u32 m0, s20, 0x8400
    s_nop 0
    buffer_load_dwordx4 v3, s[4:7], s22 offen lds
    ds_read_b64_tr_b16 v[230:231], v5 offset:1568
    s_waitcnt lgkmcnt(4)
    v_mfma_f32_16x16x32_bf16 v[48:51], v[244:247], v[120:123], v[48:51]
    ds_read_b64_tr_b16 v[232:233], v4 offset:768
    v_mfma_f32_16x16x32_bf16 v[52:55], v[244:247], v[124:127], v[52:55]
    ds_read_b64_tr_b16 v[234:235], v4 offset:1792
    s_waitcnt lgkmcnt(4)
    v_mfma_f32_16x16x32_bf16 v[56:59], v[224:227], v[120:123], v[56:59]
    ds_read_b64_tr_b16 v[236:237], v5 offset:800
    v_mfma_f32_16x16x32_bf16 v[60:63], v[224:227], v[124:127], v[60:63]
    ds_read_b64_tr_b16 v[238:239], v5 offset:1824
    s_waitcnt lgkmcnt(4)
    v_mfma_f32_16x16x32_bf16 v[64:67], v[228:231], v[120:123], v[64:67]
    ds_read_b64_tr_b16 v[240:241], v4 offset:8192
    v_mfma_f32_16x16x32_bf16 v[68:71], v[228:231], v[124:127], v[68:71]
    ds_read_b64_tr_b16 v[242:243], v4 offset:9216
    s_mov_b32 s23, 0xd000
    buffer_load_dwordx4 v[108:111], v7, s[8:11], s23 offen offset:0 sc1
    s_waitcnt lgkmcnt(4)
    v_mfma_f32_16x16x32_bf16 v[72:75], v[232:235], v[120:123], v[72:75]
    ds_read_b64_tr_b16 v[244:245], v5 offset:8224
    v_mfma_f32_16x16x32_bf16 v[76:79], v[232:235], v[124:127], v[76:79]
    ds_read_b64_tr_b16 v[246:247], v5 offset:9248
    s_waitcnt lgkmcnt(4)
    v_mfma_f32_16x16x32_bf16 v[80:83], v[236:239], v[120:123], v[80:83]
    ds_read_b64_tr_b16 v[224:225], v4 offset:8448
    v_mfma_f32_16x16x32_bf16 v[84:87], v[236:239], v[124:127], v[84:87]
    ds_read_b64_tr_b16 v[226:227], v4 offset:9472
    s_waitcnt vmcnt(11) lgkmcnt(4)
    v_mfma_f32_16x16x32_bf16 v[24:27], v[240:243], v[128:131], v[24:27]
    ds_read_b64_tr_b16 v[228:229], v5 offset:8480
    s_waitcnt vmcnt(10)
    v_mfma_f32_16x16x32_bf16 v[28:31], v[240:243], v[132:135], v[28:31]
    ds_read_b64_tr_b16 v[230:231], v5 offset:9504
    s_waitcnt lgkmcnt(4)
    v_mfma_f32_16x16x32_bf16 v[32:35], v[244:247], v[128:131], v[32:35]
    ds_read_b64_tr_b16 v[232:233], v4 offset:8704
    v_mfma_f32_16x16x32_bf16 v[36:39], v[244:247], v[132:135], v[36:39]
    ds_read_b64_tr_b16 v[234:235], v4 offset:9728
    s_mov_b32 s23, 0x5000
    buffer_load_dwordx4 v[112:115], v7, s[8:11], s23 offen offset:1024 sc1
    s_waitcnt lgkmcnt(4)
    v_mfma_f32_16x16x32_bf16 v[40:43], v[224:227], v[128:131], v[40:43]
    ds_read_b64_tr_b16 v[236:237], v5 offset:8736
    v_mfma_f32_16x16x32_bf16 v[44:47], v[224:227], v[132:135], v[44:47]
    ds_read_b64_tr_b16 v[238:239], v5 offset:9760
    s_waitcnt lgkmcnt(4)
    v_mfma_f32_16x16x32_bf16 v[48:51], v[228:231], v[128:131], v[48:51]
    ds_read_b64_tr_b16 v[240:241], v4 offset:8960
    v_mfma_f32_16x16x32_bf16 v[52:55], v[228:231], v[132:135], v[52:55]
    ds_read_b64_tr_b16 v[242:243], v4 offset:9984
    s_waitcnt lgkmcnt(4)
    v_mfma_f32_16x16x32_bf16 v[56:59], v[232:235], v[128:131], v[56:59]
    ds_read_b64_tr_b16 v[244:245], v5 offset:8992
    v_mfma_f32_16x16x32_bf16 v[60:63], v[232:235], v[132:135], v[60:63]
    ds_read_b64_tr_b16 v[246:247], v5 offset:10016
    s_waitcnt lgkmcnt(4)
    v_mfma_f32_16x16x32_bf16 v[64:67], v[236:239], v[128:131], v[64:67]
    v_mfma_f32_16x16x32_bf16 v[68:71], v[236:239], v[132:135], v[68:71]
    s_waitcnt vmcnt(8)
    s_barrier
    ds_read_b64_tr_b16 v[224:225], v4 offset:16384
    ds_read_b64_tr_b16 v[226:227], v4 offset:17408
    s_mov_b32 s23, 0xd000
    buffer_load_dwordx4 v[116:119], v7, s[8:11], s23 offen offset:1024 sc1
    s_waitcnt lgkmcnt(4)
    v_mfma_f32_16x16x32_bf16 v[72:75], v[240:243], v[128:131], v[72:75]
    ds_read_b64_tr_b16 v[228:229], v5 offset:16416
    v_mfma_f32_16x16x32_bf16 v[76:79], v[240:243], v[132:135], v[76:79]
    s_add_u32 s22, s19, 0x580000
    s_add_u32 m0, s20, 0xc000
    s_nop 0
    buffer_load_dwordx4 v3, s[4:7], s22 offen lds
    ds_read_b64_tr_b16 v[230:231], v5 offset:17440
    s_waitcnt lgkmcnt(4)
    v_mfma_f32_16x16x32_bf16 v[80:83], v[244:247], v[128:131], v[80:83]
    ds_read_b64_tr_b16 v[232:233], v4 offset:16640
    v_mfma_f32_16x16x32_bf16 v[84:87], v[244:247], v[132:135], v[84:87]
    ds_read_b64_tr_b16 v[234:235], v4 offset:17664
    s_waitcnt lgkmcnt(4)
    v_mfma_f32_16x16x32_bf16 v[24:27], v[224:227], v[88:91], v[24:27]
    ds_read_b64_tr_b16 v[236:237], v5 offset:16672
    s_waitcnt vmcnt(9)
    v_mfma_f32_16x16x32_bf16 v[28:31], v[224:227], v[92:95], v[28:31]
    ds_read_b64_tr_b16 v[238:239], v5 offset:17696
    s_waitcnt lgkmcnt(4)
    v_mfma_f32_16x16x32_bf16 v[32:35], v[228:231], v[88:91], v[32:35]
    ds_read_b64_tr_b16 v[240:241], v4 offset:16896
    v_mfma_f32_16x16x32_bf16 v[36:39], v[228:231], v[92:95], v[36:39]
    ds_read_b64_tr_b16 v[242:243], v4 offset:17920
    s_mov_b32 s23, 0x5800
    buffer_load_dwordx4 v[120:123], v7, s[8:11], s23 offen offset:0 sc1
    s_waitcnt lgkmcnt(4)
    v_mfma_f32_16x16x32_bf16 v[40:43], v[232:235], v[88:91], v[40:43]
    ds_read_b64_tr_b16 v[244:245], v5 offset:16928
    v_mfma_f32_16x16x32_bf16 v[44:47], v[232:235], v[92:95], v[44:47]
    s_add_u32 s22, s19, 0x588000
    s_add_u32 m0, s20, 0xc400
    s_nop 0
    buffer_load_dwordx4 v3, s[4:7], s22 offen lds
    ds_read_b64_tr_b16 v[246:247], v5 offset:17952
    s_waitcnt lgkmcnt(4)
    v_mfma_f32_16x16x32_bf16 v[48:51], v[236:239], v[88:91], v[48:51]
    ds_read_b64_tr_b16 v[224:225], v4 offset:17152
    v_mfma_f32_16x16x32_bf16 v[52:55], v[236:239], v[92:95], v[52:55]
    ds_read_b64_tr_b16 v[226:227], v4 offset:18176
    s_waitcnt lgkmcnt(4)
    v_mfma_f32_16x16x32_bf16 v[56:59], v[240:243], v[88:91], v[56:59]
    ds_read_b64_tr_b16 v[228:229], v5 offset:17184
    v_mfma_f32_16x16x32_bf16 v[60:63], v[240:243], v[92:95], v[60:63]
    ds_read_b64_tr_b16 v[230:231], v5 offset:18208
    s_waitcnt lgkmcnt(4)
    v_mfma_f32_16x16x32_bf16 v[64:67], v[244:247], v[88:91], v[64:67]
    ds_read_b64_tr_b16 v[232:233], v4 offset:24576
    v_mfma_f32_16x16x32_bf16 v[68:71], v[244:247], v[92:95], v[68:71]
    ds_read_b64_tr_b16 v[234:235], v4 offset:25600
    s_mov_b32 s23, 0xd800
    buffer_load_dwordx4 v[124:127], v7, s[8:11], s23 offen offset:0 sc1
    s_waitcnt lgkmcnt(4)
    v_mfma_f32_16x16x32_bf16 v[72:75], v[224:227], v[88:91], v[72:75]
    ds_read_b64_tr_b16 v[236:237], v5 offset:24608
    v_xor_b32 v8, s28, v12
    v_xor_b32 v20, s28, v13
    v_or_b32 v8, v8, v20
    v_xor_b32 v20, s28, v14
    v_or_b32 v8, v8, v20
    v_xor_b32 v20, s28, v15
    v_or_b32 v8, v8, v20
    v_cmp_ne_u32 vcc, 0, v8
    s_cbranch_vccnz adaLN_cond__sliding_block_cached__moe_arch_mod__prompt_kernel_kv16r
adaLN_cond__sliding_block_cached__moe_arch_mod__prompt_kernel_kv16b:
    v_mfma_f32_16x16x32_bf16 v[76:79], v[224:227], v[92:95], v[76:79]
    ds_read_b64_tr_b16 v[238:239], v5 offset:25632
    v_mov_b32 v20, 0
    s_mov_b32 s16, 0x564000
    buffer_load_dword v8, v20, s[8:11], s16 offen sc1
    s_waitcnt lgkmcnt(4)
    v_mfma_f32_16x16x32_bf16 v[80:83], v[228:231], v[88:91], v[80:83]
    ds_read_b64_tr_b16 v[240:241], v4 offset:24832
    v_mfma_f32_16x16x32_bf16 v[84:87], v[228:231], v[92:95], v[84:87]
    ds_read_b64_tr_b16 v[242:243], v4 offset:25856
    s_waitcnt vmcnt(12) lgkmcnt(4)
    v_mfma_f32_16x16x32_bf16 v[24:27], v[232:235], v[96:99], v[24:27]
    ds_read_b64_tr_b16 v[244:245], v5 offset:24864
    s_waitcnt vmcnt(11)
    v_mfma_f32_16x16x32_bf16 v[28:31], v[232:235], v[100:103], v[28:31]
    ds_read_b64_tr_b16 v[246:247], v5 offset:25888
    s_waitcnt lgkmcnt(4)
    v_mfma_f32_16x16x32_bf16 v[32:35], v[236:239], v[96:99], v[32:35]
    ds_read_b64_tr_b16 v[224:225], v4 offset:25088
    v_mfma_f32_16x16x32_bf16 v[36:39], v[236:239], v[100:103], v[36:39]
    ds_read_b64_tr_b16 v[226:227], v4 offset:26112
    s_mov_b32 s23, 0x5800
    buffer_load_dwordx4 v[128:131], v7, s[8:11], s23 offen offset:1024 sc1
    s_waitcnt lgkmcnt(4)
    v_mfma_f32_16x16x32_bf16 v[40:43], v[240:243], v[96:99], v[40:43]
    ds_read_b64_tr_b16 v[228:229], v5 offset:25120
    v_mfma_f32_16x16x32_bf16 v[44:47], v[240:243], v[100:103], v[44:47]
    ds_read_b64_tr_b16 v[230:231], v5 offset:26144
    s_waitcnt lgkmcnt(4)
    v_mfma_f32_16x16x32_bf16 v[48:51], v[244:247], v[96:99], v[48:51]
    ds_read_b64_tr_b16 v[232:233], v4 offset:25344
    v_mfma_f32_16x16x32_bf16 v[52:55], v[244:247], v[100:103], v[52:55]
    ds_read_b64_tr_b16 v[234:235], v4 offset:26368
    s_waitcnt lgkmcnt(4)
    v_mfma_f32_16x16x32_bf16 v[56:59], v[224:227], v[96:99], v[56:59]
    ds_read_b64_tr_b16 v[236:237], v5 offset:25376
    v_mfma_f32_16x16x32_bf16 v[60:63], v[224:227], v[100:103], v[60:63]
    ds_read_b64_tr_b16 v[238:239], v5 offset:26400
    s_waitcnt lgkmcnt(4)
    v_mfma_f32_16x16x32_bf16 v[64:67], v[228:231], v[96:99], v[64:67]
    v_mfma_f32_16x16x32_bf16 v[68:71], v[228:231], v[100:103], v[68:71]
    s_waitcnt vmcnt(9)
    s_barrier
    ds_read_b64_tr_b16 v[240:241], v4 offset:32768
    ds_read_b64_tr_b16 v[242:243], v4 offset:33792
    s_mov_b32 s23, 0xd800
    buffer_load_dwordx4 v[132:135], v7, s[8:11], s23 offen offset:1024 sc1
    s_waitcnt lgkmcnt(4)
    v_mfma_f32_16x16x32_bf16 v[72:75], v[232:235], v[96:99], v[72:75]
    ds_read_b64_tr_b16 v[244:245], v5 offset:32800
    v_mfma_f32_16x16x32_bf16 v[76:79], v[232:235], v[100:103], v[76:79]
    s_add_u32 s22, s19, 0x600000
    s_add_u32 m0, s20, 0x0
    s_nop 0
    buffer_load_dwordx4 v3, s[4:7], s22 offen lds
    ds_read_b64_tr_b16 v[246:247], v5 offset:33824
    s_waitcnt lgkmcnt(4)
    v_mfma_f32_16x16x32_bf16 v[80:83], v[236:239], v[96:99], v[80:83]
    ds_read_b64_tr_b16 v[224:225], v4 offset:33024
    v_mfma_f32_16x16x32_bf16 v[84:87], v[236:239], v[100:103], v[84:87]
    ds_read_b64_tr_b16 v[226:227], v4 offset:34048
    s_waitcnt lgkmcnt(4)
    v_mfma_f32_16x16x32_bf16 v[24:27], v[240:243], v[104:107], v[24:27]
    ds_read_b64_tr_b16 v[228:229], v5 offset:33056
    s_waitcnt vmcnt(10)
    v_mfma_f32_16x16x32_bf16 v[28:31], v[240:243], v[108:111], v[28:31]
    ds_read_b64_tr_b16 v[230:231], v5 offset:34080
    s_waitcnt lgkmcnt(4)
    v_mfma_f32_16x16x32_bf16 v[32:35], v[244:247], v[104:107], v[32:35]
    ds_read_b64_tr_b16 v[232:233], v4 offset:33280
    v_mfma_f32_16x16x32_bf16 v[36:39], v[244:247], v[108:111], v[36:39]
    ds_read_b64_tr_b16 v[234:235], v4 offset:34304
    s_mov_b32 s23, 0x6000
    buffer_load_dwordx4 v[88:91], v7, s[8:11], s23 offen offset:0 sc1
    s_waitcnt lgkmcnt(4)
    v_mfma_f32_16x16x32_bf16 v[40:43], v[224:227], v[104:107], v[40:43]
    ds_read_b64_tr_b16 v[236:237], v5 offset:33312
    v_mfma_f32_16x16x32_bf16 v[44:47], v[224:227], v[108:111], v[44:47]
    s_add_u32 s22, s19, 0x608000
    s_add_u32 m0, s20, 0x400
    s_nop 0
    buffer_load_dwordx4 v3, s[4:7], s22 offen lds
    ds_read_b64_tr_b16 v[238:239], v5 offset:34336
    s_waitcnt lgkmcnt(4)
    v_mfma_f32_16x16x32_bf16 v[48:51], v[228:231], v[104:107], v[48:51]
    ds_read_b64_tr_b16 v[240:241], v4 offset:33536
    v_mfma_f32_16x16x32_bf16 v[52:55], v[228:231], v[108:111], v[52:55]
    ds_read_b64_tr_b16 v[242:243], v4 offset:34560
    s_waitcnt lgkmcnt(4)
    v_mfma_f32_16x16x32_bf16 v[56:59], v[232:235], v[104:107], v[56:59]
    ds_read_b64_tr_b16 v[244:245], v5 offset:33568
    v_mfma_f32_16x16x32_bf16 v[60:63], v[232:235], v[108:111], v[60:63]
    ds_read_b64_tr_b16 v[246:247], v5 offset:34592
    s_waitcnt lgkmcnt(4)
    v_mfma_f32_16x16x32_bf16 v[64:67], v[236:239], v[104:107], v[64:67]
    ds_read_b64_tr_b16 v[224:225], v4 offset:40960
    v_mfma_f32_16x16x32_bf16 v[68:71], v[236:239], v[108:111], v[68:71]
    ds_read_b64_tr_b16 v[226:227], v4 offset:41984
    s_mov_b32 s23, 0xe000
    buffer_load_dwordx4 v[92:95], v7, s[8:11], s23 offen offset:0 sc1
    s_waitcnt lgkmcnt(4)
    v_mfma_f32_16x16x32_bf16 v[72:75], v[240:243], v[104:107], v[72:75]
    ds_read_b64_tr_b16 v[228:229], v5 offset:40992
    v_mfma_f32_16x16x32_bf16 v[76:79], v[240:243], v[108:111], v[76:79]
    ds_read_b64_tr_b16 v[230:231], v5 offset:42016
    s_waitcnt lgkmcnt(4)
    v_mfma_f32_16x16x32_bf16 v[80:83], v[244:247], v[104:107], v[80:83]
    ds_read_b64_tr_b16 v[232:233], v4 offset:41216
    v_mfma_f32_16x16x32_bf16 v[84:87], v[244:247], v[108:111], v[84:87]
    ds_read_b64_tr_b16 v[234:235], v4 offset:42240
    s_waitcnt vmcnt(12) lgkmcnt(4)
    v_mfma_f32_16x16x32_bf16 v[24:27], v[224:227], v[112:115], v[24:27]
    ds_read_b64_tr_b16 v[236:237], v5 offset:41248
    s_add_u32 s22, s21, 0x0
    s_add_u32 m0, s20, 0x10000
    s_nop 0
    buffer_load_dwordx4 v2, s[8:11], s22 offen sc1 lds
    s_waitcnt vmcnt(12)
    v_mfma_f32_16x16x32_bf16 v[28:31], v[224:227], v[116:119], v[28:31]
    ds_read_b64_tr_b16 v[238:239], v5 offset:42272
    s_waitcnt lgkmcnt(4)
    v_mfma_f32_16x16x32_bf16 v[32:35], v[228:231], v[112:115], v[32:35]
    ds_read_b64_tr_b16 v[240:241], v4 offset:41472
    v_mfma_f32_16x16x32_bf16 v[36:39], v[228:231], v[116:119], v[36:39]
    ds_read_b64_tr_b16 v[242:243], v4 offset:42496
    s_mov_b32 s23, 0x6000
    buffer_load_dwordx4 v[96:99], v7, s[8:11], s23 offen offset:1024 sc1
    s_waitcnt lgkmcnt(4)
    v_mfma_f32_16x16x32_bf16 v[40:43], v[232:235], v[112:115], v[40:43]
    ds_read_b64_tr_b16 v[244:245], v5 offset:41504
    s_add_u32 s22, s21, 0x400
    s_add_u32 m0, s20, 0x10400
    s_nop 0
    buffer_load_dwordx4 v2, s[8:11], s22 offen sc1 lds
    v_mfma_f32_16x16x32_bf16 v[44:47], v[232:235], v[116:119], v[44:47]
    ds_read_b64_tr_b16 v[246:247], v5 offset:42528
    s_waitcnt lgkmcnt(4)
    v_mfma_f32_16x16x32_bf16 v[48:51], v[236:239], v[112:115], v[48:51]
    ds_read_b64_tr_b16 v[224:225], v4 offset:41728
    v_mfma_f32_16x16x32_bf16 v[52:55], v[236:239], v[116:119], v[52:55]
    ds_read_b64_tr_b16 v[226:227], v4 offset:42752
    s_waitcnt lgkmcnt(4)
    v_mfma_f32_16x16x32_bf16 v[56:59], v[240:243], v[112:115], v[56:59]
    ds_read_b64_tr_b16 v[228:229], v5 offset:41760
    v_mfma_f32_16x16x32_bf16 v[60:63], v[240:243], v[116:119], v[60:63]
    ds_read_b64_tr_b16 v[230:231], v5 offset:42784
    s_waitcnt lgkmcnt(4)
    v_mfma_f32_16x16x32_bf16 v[64:67], v[244:247], v[112:115], v[64:67]
    v_mfma_f32_16x16x32_bf16 v[68:71], v[244:247], v[116:119], v[68:71]
    s_waitcnt vmcnt(11)
    s_barrier
    ds_read_b64_tr_b16 v[232:233], v4 offset:49152
    ds_read_b64_tr_b16 v[234:235], v4 offset:50176
    s_mov_b32 s23, 0xe000
    buffer_load_dwordx4 v[100:103], v7, s[8:11], s23 offen offset:1024 sc1
    s_waitcnt lgkmcnt(4)
    v_mfma_f32_16x16x32_bf16 v[72:75], v[224:227], v[112:115], v[72:75]
    ds_read_b64_tr_b16 v[236:237], v5 offset:49184
    v_mfma_f32_16x16x32_bf16 v[76:79], v[224:227], v[116:119], v[76:79]
    s_add_u32 s22, s19, 0x680000
    s_add_u32 m0, s20, 0x4000
    s_nop 0
    buffer_load_dwordx4 v3, s[4:7], s22 offen lds
    ds_read_b64_tr_b16 v[238:239], v5 offset:50208
    s_waitcnt lgkmcnt(4)
    v_mfma_f32_16x16x32_bf16 v[80:83], v[228:231], v[112:115], v[80:83]
    ds_read_b64_tr_b16 v[240:241], v4 offset:49408
    v_mfma_f32_16x16x32_bf16 v[84:87], v[228:231], v[116:119], v[84:87]
    ds_read_b64_tr_b16 v[242:243], v4 offset:50432
    s_waitcnt lgkmcnt(4)
    v_mfma_f32_16x16x32_bf16 v[24:27], v[232:235], v[120:123], v[24:27]
    ds_read_b64_tr_b16 v[244:245], v5 offset:49440
    s_waitcnt vmcnt(12)
    v_mfma_f32_16x16x32_bf16 v[28:31], v[232:235], v[124:127], v[28:31]
    ds_read_b64_tr_b16 v[246:247], v5 offset:50464
    s_waitcnt lgkmcnt(4)
    v_mfma_f32_16x16x32_bf16 v[32:35], v[236:239], v[120:123], v[32:35]
    ds_read_b64_tr_b16 v[224:225], v4 offset:49664
    v_mfma_f32_16x16x32_bf16 v[36:39], v[236:239], v[124:127], v[36:39]
    ds_read_b64_tr_b16 v[226:227], v4 offset:50688
    s_mov_b32 s23, 0x6800
    buffer_load_dwordx4 v[104:107], v7, s[8:11], s23 offen offset:0 sc1
    s_waitcnt lgkmcnt(4)
    v_mfma_f32_16x16x32_bf16 v[40:43], v[240:243], v[120:123], v[40:43]
    ds_read_b64_tr_b16 v[228:229], v5 offset:49696
    v_mfma_f32_16x16x32_bf16 v[44:47], v[240:243], v[124:127], v[44:47]
    s_add_u32 s22, s19, 0x688000
    s_add_u32 m0, s20, 0x4400
    s_nop 0
    buffer_load_dwordx4 v3, s[4:7], s22 offen lds
    ds_read_b64_tr_b16 v[230:231], v5 offset:50720
    s_waitcnt lgkmcnt(4)
    v_mfma_f32_16x16x32_bf16 v[48:51], v[244:247], v[120:123], v[48:51]
    ds_read_b64_tr_b16 v[232:233], v4 offset:49920
    v_mfma_f32_16x16x32_bf16 v[52:55], v[244:247], v[124:127], v[52:55]
    ds_read_b64_tr_b16 v[234:235], v4 offset:50944
    s_waitcnt lgkmcnt(4)
    v_mfma_f32_16x16x32_bf16 v[56:59], v[224:227], v[120:123], v[56:59]
    ds_read_b64_tr_b16 v[236:237], v5 offset:49952
    v_mfma_f32_16x16x32_bf16 v[60:63], v[224:227], v[124:127], v[60:63]
    ds_read_b64_tr_b16 v[238:239], v5 offset:50976
    s_waitcnt lgkmcnt(4)
    v_mfma_f32_16x16x32_bf16 v[64:67], v[228:231], v[120:123], v[64:67]
    ds_read_b64_tr_b16 v[240:241], v4 offset:57344
    v_mfma_f32_16x16x32_bf16 v[68:71], v[228:231], v[124:127], v[68:71]
    ds_read_b64_tr_b16 v[242:243], v4 offset:58368
    s_mov_b32 s23, 0xe800
    buffer_load_dwordx4 v[108:111], v7, s[8:11], s23 offen offset:0 sc1
    s_waitcnt lgkmcnt(4)
    v_mfma_f32_16x16x32_bf16 v[72:75], v[232:235], v[120:123], v[72:75]
    ds_read_b64_tr_b16 v[244:245], v5 offset:57376
    v_mfma_f32_16x16x32_bf16 v[76:79], v[232:235], v[124:127], v[76:79]
    ds_read_b64_tr_b16 v[246:247], v5 offset:58400
    s_waitcnt lgkmcnt(4)
    v_mfma_f32_16x16x32_bf16 v[80:83], v[236:239], v[120:123], v[80:83]
    ds_read_b64_tr_b16 v[224:225], v4 offset:57600
    v_mfma_f32_16x16x32_bf16 v[84:87], v[236:239], v[124:127], v[84:87]
    ds_read_b64_tr_b16 v[226:227], v4 offset:58624
    s_waitcnt vmcnt(13) lgkmcnt(4)
    v_mfma_f32_16x16x32_bf16 v[24:27], v[240:243], v[128:131], v[24:27]
    ds_read_b64_tr_b16 v[228:229], v5 offset:57632
    s_add_u32 s22, s21, 0x4000
    s_add_u32 m0, s20, 0x14000
    s_nop 0
    buffer_load_dwordx4 v2, s[8:11], s22 offen sc1 lds
    s_waitcnt vmcnt(13)
    v_mfma_f32_16x16x32_bf16 v[28:31], v[240:243], v[132:135], v[28:31]
    ds_read_b64_tr_b16 v[230:231], v5 offset:58656
    s_waitcnt lgkmcnt(4)
    v_mfma_f32_16x16x32_bf16 v[32:35], v[244:247], v[128:131], v[32:35]
    ds_read_b64_tr_b16 v[232:233], v4 offset:57856
    v_mfma_f32_16x16x32_bf16 v[36:39], v[244:247], v[132:135], v[36:39]
    ds_read_b64_tr_b16 v[234:235], v4 offset:58880
    s_mov_b32 s23, 0x6800
    buffer_load_dwordx4 v[112:115], v7, s[8:11], s23 offen offset:1024 sc1
    s_waitcnt lgkmcnt(4)
    v_mfma_f32_16x16x32_bf16 v[40:43], v[224:227], v[128:131], v[40:43]
    ds_read_b64_tr_b16 v[236:237], v5 offset:57888
    s_add_u32 s22, s21, 0x4400
    s_add_u32 m0, s20, 0x14400
    s_nop 0
    buffer_load_dwordx4 v2, s[8:11], s22 offen sc1 lds
    v_mfma_f32_16x16x32_bf16 v[44:47], v[224:227], v[132:135], v[44:47]
    ds_read_b64_tr_b16 v[238:239], v5 offset:58912
    s_waitcnt lgkmcnt(4)
    v_mfma_f32_16x16x32_bf16 v[48:51], v[228:231], v[128:131], v[48:51]
    ds_read_b64_tr_b16 v[240:241], v4 offset:58112
    v_mfma_f32_16x16x32_bf16 v[52:55], v[228:231], v[132:135], v[52:55]
    ds_read_b64_tr_b16 v[242:243], v4 offset:59136
    s_waitcnt lgkmcnt(4)
    v_mfma_f32_16x16x32_bf16 v[56:59], v[232:235], v[128:131], v[56:59]
    ds_read_b64_tr_b16 v[244:245], v5 offset:58144
    v_mfma_f32_16x16x32_bf16 v[60:63], v[232:235], v[132:135], v[60:63]
    ds_read_b64_tr_b16 v[246:247], v5 offset:59168
    s_waitcnt lgkmcnt(4)
    v_mfma_f32_16x16x32_bf16 v[64:67], v[236:239], v[128:131], v[64:67]
    v_mfma_f32_16x16x32_bf16 v[68:71], v[236:239], v[132:135], v[68:71]
    s_waitcnt vmcnt(12)
    s_barrier
    ds_read_b64_tr_b16 v[224:225], v4 offset:0
    ds_read_b64_tr_b16 v[226:227], v4 offset:1024
    s_mov_b32 s23, 0xe800
    buffer_load_dwordx4 v[116:119], v7, s[8:11], s23 offen offset:1024 sc1
    s_waitcnt lgkmcnt(4)
    v_mfma_f32_16x16x32_bf16 v[72:75], v[240:243], v[128:131], v[72:75]
    ds_read_b64_tr_b16 v[228:229], v5 offset:32
    v_mfma_f32_16x16x32_bf16 v[76:79], v[240:243], v[132:135], v[76:79]
    s_add_u32 s22, s19, 0x700000
    s_add_u32 m0, s20, 0x8000
    s_nop 0
    buffer_load_dwordx4 v3, s[4:7], s22 offen lds
    ds_read_b64_tr_b16 v[230:231], v5 offset:1056
    s_waitcnt lgkmcnt(4)
    v_mfma_f32_16x16x32_bf16 v[80:83], v[244:247], v[128:131], v[80:83]
    ds_read_b64_tr_b16 v[232:233], v4 offset:256
    v_mfma_f32_16x16x32_bf16 v[84:87], v[244:247], v[132:135], v[84:87]
    ds_read_b64_tr_b16 v[234:235], v4 offset:1280
    s_waitcnt lgkmcnt(4)
    v_mfma_f32_16x16x32_bf16 v[24:27], v[224:227], v[88:91], v[24:27]
    ds_read_b64_tr_b16 v[236:237], v5 offset:288
    s_waitcnt vmcnt(13)
    v_mfma_f32_16x16x32_bf16 v[28:31], v[224:227], v[92:95], v[28:31]
    ds_read_b64_tr_b16 v[238:239], v5 offset:1312
    s_waitcnt lgkmcnt(4)
    v_mfma_f32_16x16x32_bf16 v[32:35], v[228:231], v[88:91], v[32:35]
    ds_read_b64_tr_b16 v[240:241], v4 offset:512
    v_mfma_f32_16x16x32_bf16 v[36:39], v[228:231], v[92:95], v[36:39]
    ds_read_b64_tr_b16 v[242:243], v4 offset:1536
    s_mov_b32 s23, 0x7000
    buffer_load_dwordx4 v[120:123], v7, s[8:11], s23 offen offset:0 sc1
    s_waitcnt lgkmcnt(4)
    v_mfma_f32_16x16x32_bf16 v[40:43], v[232:235], v[88:91], v[40:43]
    ds_read_b64_tr_b16 v[244:245], v5 offset:544
    v_mfma_f32_16x16x32_bf16 v[44:47], v[232:235], v[92:95], v[44:47]
    s_add_u32 s22, s19, 0x708000
    s_add_u32 m0, s20, 0x8400
    s_nop 0
    buffer_load_dwordx4 v3, s[4:7], s22 offen lds
    ds_read_b64_tr_b16 v[246:247], v5 offset:1568
    s_waitcnt lgkmcnt(4)
    v_mfma_f32_16x16x32_bf16 v[48:51], v[236:239], v[88:91], v[48:51]
    ds_read_b64_tr_b16 v[224:225], v4 offset:768
    v_mfma_f32_16x16x32_bf16 v[52:55], v[236:239], v[92:95], v[52:55]
    ds_read_b64_tr_b16 v[226:227], v4 offset:1792
    s_waitcnt lgkmcnt(4)
    v_mfma_f32_16x16x32_bf16 v[56:59], v[240:243], v[88:91], v[56:59]
    ds_read_b64_tr_b16 v[228:229], v5 offset:800
    v_mfma_f32_16x16x32_bf16 v[60:63], v[240:243], v[92:95], v[60:63]
    ds_read_b64_tr_b16 v[230:231], v5 offset:1824
    s_waitcnt lgkmcnt(4)
    v_mfma_f32_16x16x32_bf16 v[64:67], v[244:247], v[88:91], v[64:67]
    ds_read_b64_tr_b16 v[232:233], v4 offset:8192
    v_mfma_f32_16x16x32_bf16 v[68:71], v[244:247], v[92:95], v[68:71]
    ds_read_b64_tr_b16 v[234:235], v4 offset:9216
    s_mov_b32 s23, 0xf000
    buffer_load_dwordx4 v[124:127], v7, s[8:11], s23 offen offset:0 sc1
    s_waitcnt lgkmcnt(4)
    v_mfma_f32_16x16x32_bf16 v[72:75], v[224:227], v[88:91], v[72:75]
    ds_read_b64_tr_b16 v[236:237], v5 offset:8224
    v_mfma_f32_16x16x32_bf16 v[76:79], v[224:227], v[92:95], v[76:79]
    ds_read_b64_tr_b16 v[238:239], v5 offset:9248
    s_waitcnt lgkmcnt(4)
    v_mfma_f32_16x16x32_bf16 v[80:83], v[228:231], v[88:91], v[80:83]
    ds_read_b64_tr_b16 v[240:241], v4 offset:8448
    v_mfma_f32_16x16x32_bf16 v[84:87], v[228:231], v[92:95], v[84:87]
    ds_read_b64_tr_b16 v[242:243], v4 offset:9472
    s_waitcnt vmcnt(14) lgkmcnt(4)
    v_mfma_f32_16x16x32_bf16 v[24:27], v[232:235], v[96:99], v[24:27]
    ds_read_b64_tr_b16 v[244:245], v5 offset:8480
    s_add_u32 s22, s21, 0x8000
    s_add_u32 m0, s20, 0x18000
    s_nop 0
    buffer_load_dwordx4 v2, s[8:11], s22 offen sc1 lds
    s_waitcnt vmcnt(13)
    v_mfma_f32_16x16x32_bf16 v[28:31], v[232:235], v[100:103], v[28:31]
    ds_read_b64_tr_b16 v[246:247], v5 offset:9504
    s_waitcnt lgkmcnt(4)
    v_mfma_f32_16x16x32_bf16 v[32:35], v[236:239], v[96:99], v[32:35]
    ds_read_b64_tr_b16 v[224:225], v4 offset:8704
    v_mfma_f32_16x16x32_bf16 v[36:39], v[236:239], v[100:103], v[36:39]
    ds_read_b64_tr_b16 v[226:227], v4 offset:9728
    s_mov_b32 s23, 0x7000
    buffer_load_dwordx4 v[128:131], v7, s[8:11], s23 offen offset:1024 sc1
    s_waitcnt lgkmcnt(4)
    v_mfma_f32_16x16x32_bf16 v[40:43], v[240:243], v[96:99], v[40:43]
    ds_read_b64_tr_b16 v[228:229], v5 offset:8736
    s_add_u32 s22, s21, 0x8400
    s_add_u32 m0, s20, 0x18400
    s_nop 0
    buffer_load_dwordx4 v2, s[8:11], s22 offen sc1 lds
    v_mfma_f32_16x16x32_bf16 v[44:47], v[240:243], v[100:103], v[44:47]
    ds_read_b64_tr_b16 v[230:231], v5 offset:9760
    s_waitcnt lgkmcnt(4)
    v_mfma_f32_16x16x32_bf16 v[48:51], v[244:247], v[96:99], v[48:51]
    ds_read_b64_tr_b16 v[232:233], v4 offset:8960
    v_mfma_f32_16x16x32_bf16 v[52:55], v[244:247], v[100:103], v[52:55]
    ds_read_b64_tr_b16 v[234:235], v4 offset:9984
    s_waitcnt lgkmcnt(4)
    v_mfma_f32_16x16x32_bf16 v[56:59], v[224:227], v[96:99], v[56:59]
    ds_read_b64_tr_b16 v[236:237], v5 offset:8992
    v_mfma_f32_16x16x32_bf16 v[60:63], v[224:227], v[100:103], v[60:63]
    ds_read_b64_tr_b16 v[238:239], v5 offset:10016
    s_waitcnt lgkmcnt(4)
    v_mfma_f32_16x16x32_bf16 v[64:67], v[228:231], v[96:99], v[64:67]
    v_mfma_f32_16x16x32_bf16 v[68:71], v[228:231], v[100:103], v[68:71]
    s_waitcnt vmcnt(12)
    s_barrier
    ds_read_b64_tr_b16 v[240:241], v4 offset:16384
    ds_read_b64_tr_b16 v[242:243], v4 offset:17408
    s_mov_b32 s23, 0xf000
    buffer_load_dwordx4 v[132:135], v7, s[8:11], s23 offen offset:1024 sc1
    s_waitcnt lgkmcnt(4)
    v_mfma_f32_16x16x32_bf16 v[72:75], v[232:235], v[96:99], v[72:75]
    ds_read_b64_tr_b16 v[244:245], v5 offset:16416
    v_mfma_f32_16x16x32_bf16 v[76:79], v[232:235], v[100:103], v[76:79]
    s_add_u32 s22, s19, 0x780000
    s_add_u32 m0, s20, 0xc000
    s_nop 0
    buffer_load_dwordx4 v3, s[4:7], s22 offen lds
    ds_read_b64_tr_b16 v[246:247], v5 offset:17440
    s_waitcnt lgkmcnt(4)
    v_mfma_f32_16x16x32_bf16 v[80:83], v[236:239], v[96:99], v[80:83]
    ds_read_b64_tr_b16 v[224:225], v4 offset:16640
    v_mfma_f32_16x16x32_bf16 v[84:87], v[236:239], v[100:103], v[84:87]
    ds_read_b64_tr_b16 v[226:227], v4 offset:17664
    s_waitcnt lgkmcnt(4)
    v_mfma_f32_16x16x32_bf16 v[24:27], v[240:243], v[104:107], v[24:27]
    ds_read_b64_tr_b16 v[228:229], v5 offset:16672
    s_waitcnt vmcnt(13)
    v_mfma_f32_16x16x32_bf16 v[28:31], v[240:243], v[108:111], v[28:31]
    ds_read_b64_tr_b16 v[230:231], v5 offset:17696
    s_waitcnt lgkmcnt(4)
    v_mfma_f32_16x16x32_bf16 v[32:35], v[244:247], v[104:107], v[32:35]
    ds_read_b64_tr_b16 v[232:233], v4 offset:16896
    v_mfma_f32_16x16x32_bf16 v[36:39], v[244:247], v[108:111], v[36:39]
    ds_read_b64_tr_b16 v[234:235], v4 offset:17920
    s_mov_b32 s23, 0x7800
    buffer_load_dwordx4 v[88:91], v7, s[8:11], s23 offen offset:0 sc1
    s_waitcnt lgkmcnt(4)
    v_mfma_f32_16x16x32_bf16 v[40:43], v[224:227], v[104:107], v[40:43]
    ds_read_b64_tr_b16 v[236:237], v5 offset:16928
    v_mfma_f32_16x16x32_bf16 v[44:47], v[224:227], v[108:111], v[44:47]
    s_add_u32 s22, s19, 0x788000
    s_add_u32 m0, s20, 0xc400
    s_nop 0
    buffer_load_dwordx4 v3, s[4:7], s22 offen lds
    ds_read_b64_tr_b16 v[238:239], v5 offset:17952
    s_waitcnt lgkmcnt(4)
    v_mfma_f32_16x16x32_bf16 v[48:51], v[228:231], v[104:107], v[48:51]
    ds_read_b64_tr_b16 v[240:241], v4 offset:17152
    v_mfma_f32_16x16x32_bf16 v[52:55], v[228:231], v[108:111], v[52:55]
    ds_read_b64_tr_b16 v[242:243], v4 offset:18176
    s_waitcnt lgkmcnt(4)
    v_mfma_f32_16x16x32_bf16 v[56:59], v[232:235], v[104:107], v[56:59]
    ds_read_b64_tr_b16 v[244:245], v5 offset:17184
    v_mfma_f32_16x16x32_bf16 v[60:63], v[232:235], v[108:111], v[60:63]
    ds_read_b64_tr_b16 v[246:247], v5 offset:18208
    s_waitcnt lgkmcnt(4)
    v_mfma_f32_16x16x32_bf16 v[64:67], v[236:239], v[104:107], v[64:67]
    ds_read_b64_tr_b16 v[224:225], v4 offset:24576
    v_mfma_f32_16x16x32_bf16 v[68:71], v[236:239], v[108:111], v[68:71]
    ds_read_b64_tr_b16 v[226:227], v4 offset:25600
    s_mov_b32 s23, 0xf800
    buffer_load_dwordx4 v[92:95], v7, s[8:11], s23 offen offset:0 sc1
    s_waitcnt lgkmcnt(4)
    v_mfma_f32_16x16x32_bf16 v[72:75], v[240:243], v[104:107], v[72:75]
    ds_read_b64_tr_b16 v[228:229], v5 offset:24608
    v_mfma_f32_16x16x32_bf16 v[76:79], v[240:243], v[108:111], v[76:79]
    ds_read_b64_tr_b16 v[230:231], v5 offset:25632
    s_waitcnt lgkmcnt(4)
    v_mfma_f32_16x16x32_bf16 v[80:83], v[244:247], v[104:107], v[80:83]
    ds_read_b64_tr_b16 v[232:233], v4 offset:24832
    v_mfma_f32_16x16x32_bf16 v[84:87], v[244:247], v[108:111], v[84:87]
    ds_read_b64_tr_b16 v[234:235], v4 offset:25856
    s_waitcnt vmcnt(14) lgkmcnt(4)
    v_mfma_f32_16x16x32_bf16 v[24:27], v[224:227], v[112:115], v[24:27]
    ds_read_b64_tr_b16 v[236:237], v5 offset:24864
    s_add_u32 s22, s21, 0xc000
    s_add_u32 m0, s20, 0x1c000
    s_nop 0
    buffer_load_dwordx4 v2, s[8:11], s22 offen sc1 lds
    s_waitcnt vmcnt(13)
    v_mfma_f32_16x16x32_bf16 v[28:31], v[224:227], v[116:119], v[28:31]
    ds_read_b64_tr_b16 v[238:239], v5 offset:25888
    s_waitcnt lgkmcnt(4)
    v_mfma_f32_16x16x32_bf16 v[32:35], v[228:231], v[112:115], v[32:35]
    ds_read_b64_tr_b16 v[240:241], v4 offset:25088
    v_mfma_f32_16x16x32_bf16 v[36:39], v[228:231], v[116:119], v[36:39]
    ds_read_b64_tr_b16 v[242:243], v4 offset:26112
    s_mov_b32 s23, 0x7800
    buffer_load_dwordx4 v[96:99], v7, s[8:11], s23 offen offset:1024 sc1
    s_waitcnt lgkmcnt(4)
    v_mfma_f32_16x16x32_bf16 v[40:43], v[232:235], v[112:115], v[40:43]
    ds_read_b64_tr_b16 v[244:245], v5 offset:25120
    s_add_u32 s22, s21, 0xc400
    s_add_u32 m0, s20, 0x1c400
    s_nop 0
    buffer_load_dwordx4 v2, s[8:11], s22 offen sc1 lds
    v_mfma_f32_16x16x32_bf16 v[44:47], v[232:235], v[116:119], v[44:47]
    ds_read_b64_tr_b16 v[246:247], v5 offset:26144
    s_waitcnt lgkmcnt(4)
    v_mfma_f32_16x16x32_bf16 v[48:51], v[236:239], v[112:115], v[48:51]
    ds_read_b64_tr_b16 v[224:225], v4 offset:25344
    v_mfma_f32_16x16x32_bf16 v[52:55], v[236:239], v[116:119], v[52:55]
    ds_read_b64_tr_b16 v[226:227], v4 offset:26368
    s_waitcnt lgkmcnt(4)
    v_mfma_f32_16x16x32_bf16 v[56:59], v[240:243], v[112:115], v[56:59]
    ds_read_b64_tr_b16 v[228:229], v5 offset:25376
    v_mfma_f32_16x16x32_bf16 v[60:63], v[240:243], v[116:119], v[60:63]
    ds_read_b64_tr_b16 v[230:231], v5 offset:26400
    s_waitcnt lgkmcnt(4)
    v_mfma_f32_16x16x32_bf16 v[64:67], v[244:247], v[112:115], v[64:67]
    v_mfma_f32_16x16x32_bf16 v[68:71], v[244:247], v[116:119], v[68:71]
    s_waitcnt vmcnt(12)
    s_barrier
    ds_read_b64_tr_b16 v[232:233], v4 offset:32768
    ds_read_b64_tr_b16 v[234:235], v4 offset:33792
    s_mov_b32 s23, 0xf800
    buffer_load_dwordx4 v[100:103], v7, s[8:11], s23 offen offset:1024 sc1
    s_waitcnt lgkmcnt(4)
    v_mfma_f32_16x16x32_bf16 v[72:75], v[224:227], v[112:115], v[72:75]
    ds_read_b64_tr_b16 v[236:237], v5 offset:32800
    v_mfma_f32_16x16x32_bf16 v[76:79], v[224:227], v[116:119], v[76:79]
    ds_read_b64_tr_b16 v[238:239], v5 offset:33824
    s_waitcnt lgkmcnt(4)
    v_mfma_f32_16x16x32_bf16 v[80:83], v[228:231], v[112:115], v[80:83]
    ds_read_b64_tr_b16 v[240:241], v4 offset:33024
    v_mfma_f32_16x16x32_bf16 v[84:87], v[228:231], v[116:119], v[84:87]
    ds_read_b64_tr_b16 v[242:243], v4 offset:34048
    s_waitcnt lgkmcnt(4)
    v_mfma_f32_16x16x32_bf16 v[24:27], v[232:235], v[120:123], v[24:27]
    ds_read_b64_tr_b16 v[244:245], v5 offset:33056
    s_waitcnt vmcnt(12)
    v_mfma_f32_16x16x32_bf16 v[28:31], v[232:235], v[124:127], v[28:31]
    ds_read_b64_tr_b16 v[246:247], v5 offset:34080
    s_waitcnt lgkmcnt(4)
    v_mfma_f32_16x16x32_bf16 v[32:35], v[236:239], v[120:123], v[32:35]
    ds_read_b64_tr_b16 v[224:225], v4 offset:33280
    v_mfma_f32_16x16x32_bf16 v[36:39], v[236:239], v[124:127], v[36:39]
    ds_read_b64_tr_b16 v[226:227], v4 offset:34304
    s_waitcnt lgkmcnt(4)
    v_mfma_f32_16x16x32_bf16 v[40:43], v[240:243], v[120:123], v[40:43]
    ds_read_b64_tr_b16 v[228:229], v5 offset:33312
    v_mfma_f32_16x16x32_bf16 v[44:47], v[240:243], v[124:127], v[44:47]
    ds_read_b64_tr_b16 v[230:231], v5 offset:34336
    s_waitcnt lgkmcnt(4)
    v_mfma_f32_16x16x32_bf16 v[48:51], v[244:247], v[120:123], v[48:51]
    ds_read_b64_tr_b16 v[232:233], v4 offset:33536
    v_mfma_f32_16x16x32_bf16 v[52:55], v[244:247], v[124:127], v[52:55]
    ds_read_b64_tr_b16 v[234:235], v4 offset:34560
    s_waitcnt lgkmcnt(4)
    v_mfma_f32_16x16x32_bf16 v[56:59], v[224:227], v[120:123], v[56:59]
    ds_read_b64_tr_b16 v[236:237], v5 offset:33568
    v_mfma_f32_16x16x32_bf16 v[60:63], v[224:227], v[124:127], v[60:63]
    ds_read_b64_tr_b16 v[238:239], v5 offset:34592
    s_waitcnt lgkmcnt(4)
    v_mfma_f32_16x16x32_bf16 v[64:67], v[228:231], v[120:123], v[64:67]
    ds_read_b64_tr_b16 v[240:241], v4 offset:40960
    v_mfma_f32_16x16x32_bf16 v[68:71], v[228:231], v[124:127], v[68:71]
    ds_read_b64_tr_b16 v[242:243], v4 offset:41984
    s_waitcnt lgkmcnt(4)
    v_mfma_f32_16x16x32_bf16 v[72:75], v[232:235], v[120:123], v[72:75]
    ds_read_b64_tr_b16 v[244:245], v5 offset:40992
    v_mfma_f32_16x16x32_bf16 v[76:79], v[232:235], v[124:127], v[76:79]
    ds_read_b64_tr_b16 v[246:247], v5 offset:42016
    s_waitcnt lgkmcnt(4)
    v_mfma_f32_16x16x32_bf16 v[80:83], v[236:239], v[120:123], v[80:83]
    ds_read_b64_tr_b16 v[224:225], v4 offset:41216
    v_mfma_f32_16x16x32_bf16 v[84:87], v[236:239], v[124:127], v[84:87]
    ds_read_b64_tr_b16 v[226:227], v4 offset:42240
    s_waitcnt vmcnt(10) lgkmcnt(4)
    v_mfma_f32_16x16x32_bf16 v[24:27], v[240:243], v[128:131], v[24:27]
    ds_read_b64_tr_b16 v[228:229], v5 offset:41248
    s_waitcnt vmcnt(8)
    v_mfma_f32_16x16x32_bf16 v[28:31], v[240:243], v[132:135], v[28:31]
    ds_read_b64_tr_b16 v[230:231], v5 offset:42272
    s_waitcnt lgkmcnt(4)
    v_mfma_f32_16x16x32_bf16 v[32:35], v[244:247], v[128:131], v[32:35]
    ds_read_b64_tr_b16 v[232:233], v4 offset:41472
    v_mfma_f32_16x16x32_bf16 v[36:39], v[244:247], v[132:135], v[36:39]
    ds_read_b64_tr_b16 v[234:235], v4 offset:42496
    s_waitcnt lgkmcnt(4)
    v_mfma_f32_16x16x32_bf16 v[40:43], v[224:227], v[128:131], v[40:43]
    ds_read_b64_tr_b16 v[236:237], v5 offset:41504
    v_mfma_f32_16x16x32_bf16 v[44:47], v[224:227], v[132:135], v[44:47]
    ds_read_b64_tr_b16 v[238:239], v5 offset:42528
    s_waitcnt lgkmcnt(4)
    v_mfma_f32_16x16x32_bf16 v[48:51], v[228:231], v[128:131], v[48:51]
    ds_read_b64_tr_b16 v[240:241], v4 offset:41728
    v_mfma_f32_16x16x32_bf16 v[52:55], v[228:231], v[132:135], v[52:55]
    ds_read_b64_tr_b16 v[242:243], v4 offset:42752
    s_waitcnt lgkmcnt(4)
    v_mfma_f32_16x16x32_bf16 v[56:59], v[232:235], v[128:131], v[56:59]
    ds_read_b64_tr_b16 v[244:245], v5 offset:41760
    v_mfma_f32_16x16x32_bf16 v[60:63], v[232:235], v[132:135], v[60:63]
    ds_read_b64_tr_b16 v[246:247], v5 offset:42784
    s_waitcnt lgkmcnt(4)
    v_mfma_f32_16x16x32_bf16 v[64:67], v[236:239], v[128:131], v[64:67]
    v_mfma_f32_16x16x32_bf16 v[68:71], v[236:239], v[132:135], v[68:71]
    s_waitcnt vmcnt(5)
    s_barrier
    ds_read_b64_tr_b16 v[224:225], v4 offset:49152
    ds_read_b64_tr_b16 v[226:227], v4 offset:50176
    s_waitcnt lgkmcnt(4)
    v_mfma_f32_16x16x32_bf16 v[72:75], v[240:243], v[128:131], v[72:75]
    ds_read_b64_tr_b16 v[228:229], v5 offset:49184
    v_mfma_f32_16x16x32_bf16 v[76:79], v[240:243], v[132:135], v[76:79]
    ds_read_b64_tr_b16 v[230:231], v5 offset:50208
    s_waitcnt lgkmcnt(4)
    v_mfma_f32_16x16x32_bf16 v[80:83], v[244:247], v[128:131], v[80:83]
    ds_read_b64_tr_b16 v[232:233], v4 offset:49408
    v_mfma_f32_16x16x32_bf16 v[84:87], v[244:247], v[132:135], v[84:87]
    ds_read_b64_tr_b16 v[234:235], v4 offset:50432
    s_waitcnt lgkmcnt(4)
    v_mfma_f32_16x16x32_bf16 v[24:27], v[224:227], v[88:91], v[24:27]
    ds_read_b64_tr_b16 v[236:237], v5 offset:49440
    s_waitcnt vmcnt(4)
    v_mfma_f32_16x16x32_bf16 v[28:31], v[224:227], v[92:95], v[28:31]
    ds_read_b64_tr_b16 v[238:239], v5 offset:50464
    s_waitcnt lgkmcnt(4)
    v_mfma_f32_16x16x32_bf16 v[32:35], v[228:231], v[88:91], v[32:35]
    ds_read_b64_tr_b16 v[240:241], v4 offset:49664
    v_mfma_f32_16x16x32_bf16 v[36:39], v[228:231], v[92:95], v[36:39]
    ds_read_b64_tr_b16 v[242:243], v4 offset:50688
    s_waitcnt lgkmcnt(4)
    v_mfma_f32_16x16x32_bf16 v[40:43], v[232:235], v[88:91], v[40:43]
    ds_read_b64_tr_b16 v[244:245], v5 offset:49696
    v_mfma_f32_16x16x32_bf16 v[44:47], v[232:235], v[92:95], v[44:47]
    ds_read_b64_tr_b16 v[246:247], v5 offset:50720
    s_waitcnt lgkmcnt(4)
    v_mfma_f32_16x16x32_bf16 v[48:51], v[236:239], v[88:91], v[48:51]
    ds_read_b64_tr_b16 v[224:225], v4 offset:49920
    v_mfma_f32_16x16x32_bf16 v[52:55], v[236:239], v[92:95], v[52:55]
    ds_read_b64_tr_b16 v[226:227], v4 offset:50944
    s_waitcnt lgkmcnt(4)
    v_mfma_f32_16x16x32_bf16 v[56:59], v[240:243], v[88:91], v[56:59]
    ds_read_b64_tr_b16 v[228:229], v5 offset:49952
    v_mfma_f32_16x16x32_bf16 v[60:63], v[240:243], v[92:95], v[60:63]
    ds_read_b64_tr_b16 v[230:231], v5 offset:50976
    s_waitcnt lgkmcnt(4)
    v_mfma_f32_16x16x32_bf16 v[64:67], v[244:247], v[88:91], v[64:67]
    ds_read_b64_tr_b16 v[232:233], v4 offset:57344
    v_mfma_f32_16x16x32_bf16 v[68:71], v[244:247], v[92:95], v[68:71]
    ds_read_b64_tr_b16 v[234:235], v4 offset:58368
    s_waitcnt lgkmcnt(4)
    v_mfma_f32_16x16x32_bf16 v[72:75], v[224:227], v[88:91], v[72:75]
    ds_read_b64_tr_b16 v[236:237], v5 offset:57376
    v_mfma_f32_16x16x32_bf16 v[76:79], v[224:227], v[92:95], v[76:79]
    ds_read_b64_tr_b16 v[238:239], v5 offset:58400
    s_waitcnt lgkmcnt(4)
    v_mfma_f32_16x16x32_bf16 v[80:83], v[228:231], v[88:91], v[80:83]
    ds_read_b64_tr_b16 v[240:241], v4 offset:57600
    v_mfma_f32_16x16x32_bf16 v[84:87], v[228:231], v[92:95], v[84:87]
    ds_read_b64_tr_b16 v[242:243], v4 offset:58624
    s_waitcnt vmcnt(2) lgkmcnt(4)
    v_mfma_f32_16x16x32_bf16 v[24:27], v[232:235], v[96:99], v[24:27]
    ds_read_b64_tr_b16 v[244:245], v5 offset:57632
    s_waitcnt vmcnt(0)
    v_mfma_f32_16x16x32_bf16 v[28:31], v[232:235], v[100:103], v[28:31]
    ds_read_b64_tr_b16 v[246:247], v5 offset:58656
    s_waitcnt lgkmcnt(4)
    v_mfma_f32_16x16x32_bf16 v[32:35], v[236:239], v[96:99], v[32:35]
    ds_read_b64_tr_b16 v[224:225], v4 offset:57856
    v_mfma_f32_16x16x32_bf16 v[36:39], v[236:239], v[100:103], v[36:39]
    ds_read_b64_tr_b16 v[226:227], v4 offset:58880
    s_waitcnt lgkmcnt(4)
    v_mfma_f32_16x16x32_bf16 v[40:43], v[240:243], v[96:99], v[40:43]
    ds_read_b64_tr_b16 v[228:229], v5 offset:57888
    v_mfma_f32_16x16x32_bf16 v[44:47], v[240:243], v[100:103], v[44:47]
    ds_read_b64_tr_b16 v[230:231], v5 offset:58912
    s_waitcnt lgkmcnt(4)
    v_mfma_f32_16x16x32_bf16 v[48:51], v[244:247], v[96:99], v[48:51]
    ds_read_b64_tr_b16 v[232:233], v4 offset:58112
    v_mfma_f32_16x16x32_bf16 v[52:55], v[244:247], v[100:103], v[52:55]
    ds_read_b64_tr_b16 v[234:235], v4 offset:59136
    s_waitcnt lgkmcnt(4)
    v_mfma_f32_16x16x32_bf16 v[56:59], v[224:227], v[96:99], v[56:59]
    ds_read_b64_tr_b16 v[236:237], v5 offset:58144
    v_mfma_f32_16x16x32_bf16 v[60:63], v[224:227], v[100:103], v[60:63]
    ds_read_b64_tr_b16 v[238:239], v5 offset:59168
    s_waitcnt lgkmcnt(4)
    v_mfma_f32_16x16x32_bf16 v[64:67], v[228:231], v[96:99], v[64:67]
    v_mfma_f32_16x16x32_bf16 v[68:71], v[228:231], v[100:103], v[68:71]
    s_waitcnt lgkmcnt(2)
    v_mfma_f32_16x16x32_bf16 v[72:75], v[232:235], v[96:99], v[72:75]
    v_mfma_f32_16x16x32_bf16 v[76:79], v[232:235], v[100:103], v[76:79]
    s_waitcnt lgkmcnt(0)
    v_mfma_f32_16x16x32_bf16 v[80:83], v[236:239], v[96:99], v[80:83]
    v_mfma_f32_16x16x32_bf16 v[84:87], v[236:239], v[100:103], v[84:87]
    s_mov_b32 s23, 0x3e0293ee
    v_mul_f32 v24, s23, v24
    v_mul_f32 v25, s23, v25
    v_mul_f32 v26, s23, v26
    v_mul_f32 v27, s23, v27
    v_mul_f32 v28, s23, v28
    v_mul_f32 v29, s23, v29
    v_mul_f32 v30, s23, v30
    v_mul_f32 v31, s23, v31
    v_mul_f32 v32, s23, v32
    v_mul_f32 v33, s23, v33
    v_mul_f32 v34, s23, v34
    v_mul_f32 v35, s23, v35
    v_mul_f32 v36, s23, v36
    v_mul_f32 v37, s23, v37
    v_mul_f32 v38, s23, v38
    v_mul_f32 v39, s23, v39
    v_cvt_pk_bf16_f32 v152, v24, v25
    v_cvt_pk_bf16_f32 v153, v26, v27
    v_cvt_pk_bf16_f32 v168, v28, v29
    v_cvt_pk_bf16_f32 v169, v30, v31
    v_cvt_pk_bf16_f32 v154, v32, v33
    v_cvt_pk_bf16_f32 v155, v34, v35
    v_cvt_pk_bf16_f32 v170, v36, v37
    v_cvt_pk_bf16_f32 v171, v38, v39
    v_add_u32 v4, 0x10000, v2
    v_add_u32 v5, 0x20000, v2
    s_barrier
    ds_read_b128 v[224:227], v4 offset:0
    ds_read_b128 v[228:231], v4 offset:1024
    ds_read_b128 v[232:235], v4 offset:2048
    ds_read_b128 v[236:239], v4 offset:3072
    v_mov_b32 v12, 0x3f803f80
    v_mov_b32 v13, 0x3f803f80
    v_mov_b32 v14, 0x3f803f80
    v_mov_b32 v15, 0x3f803f80
    s_waitcnt lgkmcnt(3)
    v_mfma_f32_16x16x32_bf16 v[184:187], v[224:227], v[152:155], 0
    v_mul_f32 v40, s23, v40
    v_mul_f32 v41, s23, v41
    v_mul_f32 v42, s23, v42
    v_mul_f32 v43, s23, v43
    v_mul_f32 v44, s23, v44
    v_mul_f32 v45, s23, v45
    v_mfma_f32_16x16x32_bf16 v[188:191], v[224:227], v[168:171], 0
    ds_read_b128 v[240:243], v4 offset:4096
    v_mul_f32 v46, s23, v46
    v_mul_f32 v47, s23, v47
    v_mul_f32 v48, s23, v48
    v_mul_f32 v49, s23, v49
    v_mul_f32 v50, s23, v50
    v_mul_f32 v51, s23, v51
    s_mov_b64 s[64:65], s[46:47]
    s_mov_b32 s66, 0x700000
    s_mov_b32 s67, 0x20000
    s_mov_b64 s[68:69], s[48:49]
    s_mov_b32 s70, 0x700000
    s_mov_b32 s71, 0x20000
    s_cmp_lt_u32 s2, 224
    s_cselect_b32 s66, 7340032, 0
    s_cselect_b32 s70, 7340032, 0
    s_and_b32 s29, s2, 7
    s_mul_i32 s29, s29, 28
    s_lshr_b32 s16, s2, 3
    s_add_u32 s29, s29, s16
    s_sub_u32 s16, s3, 4
    v_lshrrev_b32 v20, 3, v1
    v_lshlrev_b32 v20, 3, v20
    s_lshl_b32 s17, s16, 6
    v_add_u32 v20, s17, v20
    s_mov_b32 s17, 7168
    v_mul_lo_u32 v11, s17, v20
    v_and_b32 v20, 7, v1
    v_lshl_add_u32 v11, v20, 4, v11
    s_and_b32 s17, s29, 3
    s_mul_i32 s18, s17, 1835008
    s_lshr_b32 s17, s29, 2
    s_lshl_b32 s17, s17, 7
    s_add_u32 s18, s18, s17
    s_lshl_b32 s15, s16, 13
    s_waitcnt lgkmcnt(3)
    v_mfma_f32_16x16x32_bf16 v[192:195], v[228:231], v[152:155], 0
    s_add_u32 s22, s21, 0x10000
    s_add_u32 m0, s20, 0x20000
    s_nop 0
    buffer_load_dwordx4 v2, s[8:11], s22 offen sc1 lds
    v_mul_f32 v52, s23, v52
    v_mul_f32 v53, s23, v53
    v_mul_f32 v54, s23, v54
    v_mul_f32 v55, s23, v55
    v_cvt_pk_bf16_f32 v156, v40, v41
    v_cvt_pk_bf16_f32 v157, v42, v43
    s_mov_b64 s[76:77], s[54:55]
    s_mov_b32 s78, 0xc00000
    s_mov_b32 s79, 0x20000
    v_bfe_u32 v20, v1, 2, 2
    v_lshlrev_b32 v20, 12, v20
    v_add_u32 v6, v3, v20
    s_lshr_b32 s16, s2, 5
    s_lshl_b32 s16, s16, 7
    s_lshl_b32 s17, s3, 3
    s_add_u32 s16, s16, s17
    s_mul_i32 s14, s16, 12288
    s_and_b32 s16, s2, 31
    s_lshl_b32 s16, s16, 8
    s_add_u32 s14, s14, s16
    s_add_u32 s14, s14, 4096
    v_mfma_f32_16x16x32_bf16 v[196:199], v[228:231], v[168:171], 0
    ds_read_b128 v[244:247], v4 offset:5120
    v_cvt_pk_bf16_f32 v172, v44, v45
    v_cvt_pk_bf16_f32 v173, v46, v47
    v_cvt_pk_bf16_f32 v158, v48, v49
    v_cvt_pk_bf16_f32 v159, v50, v51
    v_cvt_pk_bf16_f32 v174, v52, v53
    v_cvt_pk_bf16_f32 v175, v54, v55
    s_waitcnt lgkmcnt(3)
    v_mfma_f32_16x16x32_bf16 v[184:187], v[232:235], v[156:159], v[184:187]
    v_mul_f32 v56, s23, v56
    v_mul_f32 v57, s23, v57
    v_mul_f32 v58, s23, v58
    v_mul_f32 v59, s23, v59
    v_mul_f32 v60, s23, v60
    v_mul_f32 v61, s23, v61
    v_mfma_f32_16x16x32_bf16 v[188:191], v[232:235], v[172:175], v[188:191]
    ds_read_b128 v[224:227], v4 offset:6144
    v_mul_f32 v62, s23, v62
    v_mul_f32 v63, s23, v63
    v_mul_f32 v64, s23, v64
    v_mul_f32 v65, s23, v65
    v_mul_f32 v66, s23, v66
    v_mul_f32 v67, s23, v67
    s_waitcnt lgkmcnt(3)
    v_mfma_f32_16x16x32_bf16 v[192:195], v[236:239], v[156:159], v[192:195]
    v_mul_f32 v68, s23, v68
    v_mul_f32 v69, s23, v69
    v_mul_f32 v70, s23, v70
    v_mul_f32 v71, s23, v71
    v_cvt_pk_bf16_f32 v160, v56, v57
    v_cvt_pk_bf16_f32 v161, v58, v59
    v_mfma_f32_16x16x32_bf16 v[196:199], v[236:239], v[172:175], v[196:199]
    ds_read_b128 v[228:231], v4 offset:7168
    v_cvt_pk_bf16_f32 v176, v60, v61
    v_cvt_pk_bf16_f32 v177, v62, v63
    v_cvt_pk_bf16_f32 v162, v64, v65
    v_cvt_pk_bf16_f32 v163, v66, v67
    v_cvt_pk_bf16_f32 v178, v68, v69
    v_cvt_pk_bf16_f32 v179, v70, v71
    s_waitcnt lgkmcnt(3)
    v_mfma_f32_16x16x32_bf16 v[184:187], v[240:243], v[160:163], v[184:187]
    v_mul_f32 v72, s23, v72
    v_mul_f32 v73, s23, v73
    v_mul_f32 v74, s23, v74
    v_mul_f32 v75, s23, v75
    v_mul_f32 v76, s23, v76
    v_mul_f32 v77, s23, v77
    v_mfma_f32_16x16x32_bf16 v[188:191], v[240:243], v[176:179], v[188:191]
    ds_read_b128 v[232:235], v4 offset:8192
    v_mul_f32 v78, s23, v78
    v_mul_f32 v79, s23, v79
    v_mul_f32 v80, s23, v80
    v_mul_f32 v81, s23, v81
    v_mul_f32 v82, s23, v82
    v_mul_f32 v83, s23, v83
    s_waitcnt lgkmcnt(3)
    v_mfma_f32_16x16x32_bf16 v[192:195], v[244:247], v[160:163], v[192:195]
    s_add_u32 s22, s21, 0x10400
    s_add_u32 m0, s20, 0x20400
    s_nop 0
    buffer_load_dwordx4 v2, s[8:11], s22 offen sc1 lds
    v_mul_f32 v84, s23, v84
    v_mul_f32 v85, s23, v85
    v_mul_f32 v86, s23, v86
    v_mul_f32 v87, s23, v87
    v_cvt_pk_bf16_f32 v164, v72, v73
    v_cvt_pk_bf16_f32 v165, v74, v75
    v_mfma_f32_16x16x32_bf16 v[196:199], v[244:247], v[176:179], v[196:199]
    ds_read_b128 v[236:239], v4 offset:9216
    v_cvt_pk_bf16_f32 v180, v76, v77
    v_cvt_pk_bf16_f32 v181, v78, v79
    v_cvt_pk_bf16_f32 v166, v80, v81
    v_cvt_pk_bf16_f32 v167, v82, v83
    v_cvt_pk_bf16_f32 v182, v84, v85
    v_cvt_pk_bf16_f32 v183, v86, v87
    s_waitcnt lgkmcnt(3)
    v_mfma_f32_16x16x32_bf16 v[184:187], v[224:227], v[164:167], v[184:187]
    v_mfma_f32_16x16x32_bf16 v[188:191], v[224:227], v[180:183], v[188:191]
    ds_read_b128 v[240:243], v4 offset:10240
    s_waitcnt lgkmcnt(3)
    v_mfma_f32_16x16x32_bf16 v[192:195], v[228:231], v[164:167], v[192:195]
    v_mfma_f32_16x16x32_bf16 v[196:199], v[228:231], v[180:183], v[196:199]
    ds_read_b128 v[244:247], v4 offset:11264
    s_waitcnt lgkmcnt(3)
    v_mfma_f32_16x16x32_bf16 v[200:203], v[232:235], v[152:155], 0
    v_mfma_f32_16x16x32_bf16 v[204:207], v[232:235], v[168:171], 0
    ds_read_b128 v[224:227], v4 offset:12288
    s_waitcnt lgkmcnt(3)
    v_mfma_f32_16x16x32_bf16 v[208:211], v[236:239], v[152:155], 0
    v_mfma_f32_16x16x32_bf16 v[212:215], v[236:239], v[168:171], 0
    ds_read_b128 v[228:231], v4 offset:13312
    s_waitcnt lgkmcnt(3)
    v_mfma_f32_16x16x32_bf16 v[200:203], v[240:243], v[156:159], v[200:203]
    v_mfma_f32_16x16x32_bf16 v[204:207], v[240:243], v[172:175], v[204:207]
    ds_read_b128 v[232:235], v4 offset:14336
    s_waitcnt lgkmcnt(3)
    v_mfma_f32_16x16x32_bf16 v[208:211], v[244:247], v[156:159], v[208:211]
    v_max3_f32 v16, v184, v185, v186
    v_mfma_f32_16x16x32_bf16 v[212:215], v[244:247], v[172:175], v[212:215]
    ds_read_b128 v[236:239], v4 offset:15360
    v_max3_f32 v16, v16, v187, v192
    s_waitcnt lgkmcnt(3)
    v_mfma_f32_16x16x32_bf16 v[200:203], v[224:227], v[160:163], v[200:203]
    v_max3_f32 v16, v16, v193, v194
    v_mfma_f32_16x16x32_bf16 v[204:207], v[224:227], v[176:179], v[204:207]
    s_barrier
    ds_read_b128 v[240:243], v4 offset:16384
    v_max_f32 v16, v16, v195
    s_waitcnt lgkmcnt(3)
    v_mfma_f32_16x16x32_bf16 v[208:211], v[228:231], v[160:163], v[208:211]
    v_max3_f32 v17, v188, v189, v190
    v_mfma_f32_16x16x32_bf16 v[212:215], v[228:231], v[176:179], v[212:215]
    s_add_u32 s22, s21, 0x14000
    s_add_u32 m0, s20, 0x24000
    s_nop 0
    buffer_load_dwordx4 v2, s[8:11], s22 offen sc1 lds
    ds_read_b128 v[244:247], v4 offset:17408
    v_max3_f32 v17, v17, v191, v196
    s_waitcnt lgkmcnt(3)
    v_mfma_f32_16x16x32_bf16 v[200:203], v[232:235], v[164:167], v[200:203]
    v_max3_f32 v17, v17, v197, v198
    v_mfma_f32_16x16x32_bf16 v[204:207], v[232:235], v[180:183], v[204:207]
    ds_read_b128 v[224:227], v4 offset:18432
    v_max_f32 v17, v17, v199
    s_waitcnt lgkmcnt(3)
    v_mfma_f32_16x16x32_bf16 v[208:211], v[236:239], v[164:167], v[208:211]
    s_mov_b64 s[72:73], s[40:41]
    s_mov_b32 s74, 0x800000
    s_mov_b32 s75, 0x20000
    v_lshlrev_b32 v21, 7, v1
    s_lshl_b32 s16, s2, 2
    s_add_u32 s16, s16, s3
    s_sub_u32 s16, s16, 4
    s_lshl_b32 s16, s16, 13
    buffer_load_dword v7, v21, s[72:75], s16 offen
    v_mfma_f32_16x16x32_bf16 v[212:215], v[236:239], v[180:183], v[212:215]
    ds_read_b128 v[228:231], v4 offset:19456
    v_max3_f32 v16, v16, v200, v201
    v_max3_f32 v16, v16, v202, v203
    v_max3_f32 v16, v16, v208, v209
    v_max3_f32 v16, v16, v210, v211
    v_max3_f32 v17, v17, v204, v205
    v_max3_f32 v17, v17, v206, v207
    s_nop 0
    v_max3_f32 v17, v17, v212, v213
    v_max3_f32 v17, v17, v214, v215
    v_mov_b32 v18, v16
    v_mov_b32 v19, v17
    s_nop 0
    v_permlane16_swap_b32 v16, v18
    v_permlane16_swap_b32 v17, v19
    v_max_f32 v16, v16, v18
    v_max_f32 v17, v17, v19
    v_mov_b32 v18, v16
    v_mov_b32 v19, v17
    s_nop 0
    v_permlane32_swap_b32 v16, v18
    v_permlane32_swap_b32 v17, v19
    v_max_f32 v16, v16, v18
    v_max_f32 v17, v17, v19
    v_sub_f32 v216, 0, v16
    v_sub_f32 v217, 0, v16
    v_sub_f32 v218, 0, v16
    v_sub_f32 v219, 0, v16
    v_sub_f32 v220, 0, v17
    v_sub_f32 v221, 0, v17
    v_sub_f32 v222, 0, v17
    v_sub_f32 v223, 0, v17
    v_add_f32 v184, v184, v216
    v_add_f32 v185, v185, v216
    v_exp_f32 v184, v184
    v_exp_f32 v185, v185
    v_add_f32 v186, v186, v216
    v_add_f32 v187, v187, v216
    v_exp_f32 v186, v186
    v_exp_f32 v187, v187
    v_cvt_pk_bf16_f32 v24, v184, v185
    v_add_f32 v188, v188, v220
    v_add_f32 v189, v189, v220
    v_exp_f32 v188, v188
    v_exp_f32 v189, v189
    v_cvt_pk_bf16_f32 v25, v186, v187
    v_add_f32 v190, v190, v220
    v_add_f32 v191, v191, v220
    v_exp_f32 v190, v190
    v_exp_f32 v191, v191
    v_cvt_pk_bf16_f32 v28, v188, v189
    v_add_f32 v192, v192, v216
    v_add_f32 v193, v193, v216
    v_exp_f32 v192, v192
    v_exp_f32 v193, v193
    v_cvt_pk_bf16_f32 v29, v190, v191
    v_add_f32 v194, v194, v216
    v_add_f32 v195, v195, v216
    v_exp_f32 v194, v194
    v_exp_f32 v195, v195
    v_cvt_pk_bf16_f32 v26, v192, v193
    v_add_f32 v196, v196, v220
    v_add_f32 v197, v197, v220
    v_exp_f32 v196, v196
    v_exp_f32 v197, v197
    v_cvt_pk_bf16_f32 v27, v194, v195
    v_add_f32 v198, v198, v220
    v_add_f32 v199, v199, v220
    v_exp_f32 v198, v198
    v_exp_f32 v199, v199
    v_cvt_pk_bf16_f32 v30, v196, v197
    v_cvt_pk_bf16_f32 v31, v198, v199
    s_waitcnt lgkmcnt(3)
    v_mfma_f32_16x16x32_bf16 v[184:187], v[240:243], v[152:155], v[216:219]
    v_mfma_f32_16x16x32_bf16 v[188:191], v[240:243], v[168:171], v[220:223]
    ds_read_b128 v[232:235], v4 offset:20480
    v_add_f32 v200, v200, v216
    v_add_f32 v201, v201, v216
    v_exp_f32 v200, v200
    v_mfma_f32_16x16x32_bf16 v[248:251], v[12:15], v[24:27], 0
    s_waitcnt lgkmcnt(3)
    v_mfma_f32_16x16x32_bf16 v[192:195], v[244:247], v[152:155], v[216:219]
    v_exp_f32 v201, v201
    v_add_f32 v202, v202, v216
    v_add_f32 v203, v203, v216
    v_mfma_f32_16x16x32_bf16 v[196:199], v[244:247], v[168:171], v[220:223]
    s_add_u32 s22, s21, 0x14400
    s_add_u32 m0, s20, 0x24400
    s_nop 0
    buffer_load_dwordx4 v2, s[8:11], s22 offen sc1 lds
    ds_read_b128 v[236:239], v4 offset:21504
    v_exp_f32 v202, v202
    v_exp_f32 v203, v203
    v_mfma_f32_16x16x32_bf16 v[252:255], v[12:15], v[28:31], 0
    s_waitcnt lgkmcnt(3)
    v_mfma_f32_16x16x32_bf16 v[184:187], v[224:227], v[156:159], v[184:187]
    v_cvt_pk_bf16_f32 v32, v200, v201
    v_add_f32 v204, v204, v220
    v_add_f32 v205, v205, v220
    v_mfma_f32_16x16x32_bf16 v[188:191], v[224:227], v[172:175], v[188:191]
    ds_read_b128 v[240:243], v4 offset:22528
    v_exp_f32 v204, v204
    v_exp_f32 v205, v205
    v_cvt_pk_bf16_f32 v33, v202, v203
    s_mov_b64 s[4:5], s[40:41]
    s_mov_b32 s6, 0x800000
    s_mov_b32 s7, 0x20000
    v_bfe_u32 v20, v1, 2, 2
    v_lshlrev_b32 v21, 13, v20
    v_sub_u32 v3, v3, v21
    v_lshl_add_u32 v3, v20, 11, v3
    s_and_b32 s16, s2, 1
    s_lshl_b32 s24, s16, 22
    s_lshr_b32 s16, s2, 5
    s_lshl_b32 s16, s16, 8
    s_add_u32 s24, s24, s16
    s_lshl_b32 s16, s3, 14
    s_add_u32 s24, s24, s16
    s_add_u32 s24, s24, 196608
    s_waitcnt lgkmcnt(3)
    v_mfma_f32_16x16x32_bf16 v[192:195], v[228:231], v[156:159], v[192:195]
    v_add_f32 v206, v206, v220
    v_add_f32 v207, v207, v220
    v_mfma_f32_16x16x32_bf16 v[196:199], v[228:231], v[172:175], v[196:199]
    ds_read_b128 v[244:247], v4 offset:23552
    v_exp_f32 v206, v206
    v_exp_f32 v207, v207
    v_cvt_pk_bf16_f32 v36, v204, v205
    s_waitcnt lgkmcnt(3)
    v_mfma_f32_16x16x32_bf16 v[184:187], v[232:235], v[160:163], v[184:187]
    v_add_f32 v208, v208, v216
    v_add_f32 v209, v209, v216
    v_exp_f32 v208, v208
    v_mfma_f32_16x16x32_bf16 v[188:191], v[232:235], v[176:179], v[188:191]
    ds_read_b128 v[224:227], v4 offset:24576
    v_exp_f32 v209, v209
    v_cvt_pk_bf16_f32 v37, v206, v207
    s_waitcnt lgkmcnt(3)
    v_mfma_f32_16x16x32_bf16 v[192:195], v[236:239], v[160:163], v[192:195]
    v_add_f32 v210, v210, v216
    v_add_f32 v211, v211, v216
    v_exp_f32 v210, v210
    v_mfma_f32_16x16x32_bf16 v[196:199], v[236:239], v[176:179], v[196:199]
    ds_read_b128 v[228:231], v4 offset:25600
    v_exp_f32 v211, v211
    v_cvt_pk_bf16_f32 v34, v208, v209
    v_add_f32 v212, v212, v220
    s_waitcnt lgkmcnt(3)
    v_mfma_f32_16x16x32_bf16 v[184:187], v[240:243], v[164:167], v[184:187]
    v_add_f32 v213, v213, v220
    v_exp_f32 v212, v212
    v_mfma_f32_16x16x32_bf16 v[188:191], v[240:243], v[180:183], v[188:191]
    ds_read_b128 v[232:235], v4 offset:26624
    v_exp_f32 v213, v213
    v_cvt_pk_bf16_f32 v35, v210, v211
    v_add_f32 v214, v214, v220
    s_waitcnt lgkmcnt(3)
    v_mfma_f32_16x16x32_bf16 v[192:195], v[244:247], v[164:167], v[192:195]
    v_add_f32 v215, v215, v220
    v_exp_f32 v214, v214
    v_exp_f32 v215, v215
    v_mfma_f32_16x16x32_bf16 v[196:199], v[244:247], v[180:183], v[196:199]
    ds_read_b128 v[236:239], v4 offset:27648
    v_cvt_pk_bf16_f32 v38, v212, v213
    v_cvt_pk_bf16_f32 v39, v214, v215
    s_waitcnt lgkmcnt(3)
    v_mfma_f32_16x16x32_bf16 v[200:203], v[224:227], v[152:155], v[216:219]
    v_mfma_f32_16x16x32_bf16 v[204:207], v[224:227], v[168:171], v[220:223]
    ds_read_b128 v[240:243], v4 offset:28672
    v_exp_f32 v184, v184
    v_exp_f32 v185, v185
    v_mfma_f32_16x16x32_bf16 v[248:251], v[12:15], v[32:35], v[248:251]
    s_waitcnt lgkmcnt(3)
    v_mfma_f32_16x16x32_bf16 v[208:211], v[228:231], v[152:155], v[216:219]
    v_exp_f32 v186, v186
    v_exp_f32 v187, v187
    v_mfma_f32_16x16x32_bf16 v[212:215], v[228:231], v[168:171], v[220:223]
    ds_read_b128 v[244:247], v4 offset:29696
    v_cvt_pk_bf16_f32 v40, v184, v185
    v_mfma_f32_16x16x32_bf16 v[252:255], v[12:15], v[36:39], v[252:255]
    s_waitcnt lgkmcnt(3)
    v_mfma_f32_16x16x32_bf16 v[200:203], v[232:235], v[156:159], v[200:203]
    v_exp_f32 v188, v188
    v_exp_f32 v189, v189
    v_mfma_f32_16x16x32_bf16 v[204:207], v[232:235], v[172:175], v[204:207]
    ds_read_b128 v[224:227], v4 offset:30720
    v_cvt_pk_bf16_f32 v41, v186, v187
    s_waitcnt lgkmcnt(3)
    v_mfma_f32_16x16x32_bf16 v[208:211], v[236:239], v[156:159], v[208:211]
    v_exp_f32 v190, v190
    v_exp_f32 v191, v191
    v_mfma_f32_16x16x32_bf16 v[212:215], v[236:239], v[172:175], v[212:215]
    ds_read_b128 v[228:231], v4 offset:31744
    v_cvt_pk_bf16_f32 v44, v188, v189
    v_exp_f32 v192, v192
    s_waitcnt lgkmcnt(3)
    v_mfma_f32_16x16x32_bf16 v[200:203], v[240:243], v[160:163], v[200:203]
    v_exp_f32 v193, v193
    v_mfma_f32_16x16x32_bf16 v[204:207], v[240:243], v[176:179], v[204:207]
    s_barrier
    ds_read_b128 v[232:235], v4 offset:32768
    v_cvt_pk_bf16_f32 v45, v190, v191
    v_exp_f32 v194, v194
    s_waitcnt lgkmcnt(3)
    v_mfma_f32_16x16x32_bf16 v[208:211], v[244:247], v[160:163], v[208:211]
    v_exp_f32 v195, v195
    v_mfma_f32_16x16x32_bf16 v[212:215], v[244:247], v[176:179], v[212:215]
    s_add_u32 s22, s21, 0x18000
    s_add_u32 m0, s20, 0x10000
    s_nop 0
    buffer_load_dwordx4 v2, s[8:11], s22 offen sc1 lds
    ds_read_b128 v[236:239], v4 offset:33792
    v_cvt_pk_bf16_f32 v42, v192, v193
    v_exp_f32 v196, v196
    s_waitcnt lgkmcnt(3)
    v_mfma_f32_16x16x32_bf16 v[200:203], v[224:227], v[164:167], v[200:203]
    v_exp_f32 v197, v197
    v_cvt_pk_bf16_f32 v43, v194, v195
    v_mfma_f32_16x16x32_bf16 v[204:207], v[224:227], v[180:183], v[204:207]
    ds_read_b128 v[240:243], v4 offset:34816
    v_exp_f32 v198, v198
    s_waitcnt lgkmcnt(3)
    v_mfma_f32_16x16x32_bf16 v[208:211], v[228:231], v[164:167], v[208:211]
    v_exp_f32 v199, v199
    v_cvt_pk_bf16_f32 v46, v196, v197
    v_mfma_f32_16x16x32_bf16 v[212:215], v[228:231], v[180:183], v[212:215]
    ds_read_b128 v[244:247], v4 offset:35840
    v_cvt_pk_bf16_f32 v47, v198, v199
    s_waitcnt lgkmcnt(3)
    v_mfma_f32_16x16x32_bf16 v[184:187], v[232:235], v[152:155], v[216:219]
    v_mfma_f32_16x16x32_bf16 v[188:191], v[232:235], v[168:171], v[220:223]
    ds_read_b128 v[224:227], v4 offset:36864
    v_exp_f32 v200, v200
    v_exp_f32 v201, v201
    v_mfma_f32_16x16x32_bf16 v[248:251], v[12:15], v[40:43], v[248:251]
    s_waitcnt lgkmcnt(3)
    v_mfma_f32_16x16x32_bf16 v[192:195], v[236:239], v[152:155], v[216:219]
    v_exp_f32 v202, v202
    v_exp_f32 v203, v203
    v_mfma_f32_16x16x32_bf16 v[196:199], v[236:239], v[168:171], v[220:223]
    s_add_u32 s22, s21, 0x18400
    s_add_u32 m0, s20, 0x10400
    s_nop 0
    buffer_load_dwordx4 v2, s[8:11], s22 offen sc1 lds
    ds_read_b128 v[228:231], v4 offset:37888
    v_cvt_pk_bf16_f32 v48, v200, v201
    v_mfma_f32_16x16x32_bf16 v[252:255], v[12:15], v[44:47], v[252:255]
    s_waitcnt lgkmcnt(3)
    v_mfma_f32_16x16x32_bf16 v[184:187], v[240:243], v[156:159], v[184:187]
    v_exp_f32 v204, v204
    v_exp_f32 v205, v205
    v_mfma_f32_16x16x32_bf16 v[188:191], v[240:243], v[172:175], v[188:191]
    ds_read_b128 v[232:235], v4 offset:38912
    v_cvt_pk_bf16_f32 v49, v202, v203
    s_waitcnt lgkmcnt(3)
    v_mfma_f32_16x16x32_bf16 v[192:195], v[244:247], v[156:159], v[192:195]
    v_exp_f32 v206, v206
    v_exp_f32 v207, v207
    v_mfma_f32_16x16x32_bf16 v[196:199], v[244:247], v[172:175], v[196:199]
    ds_read_b128 v[236:239], v4 offset:39936
    v_cvt_pk_bf16_f32 v52, v204, v205
    v_exp_f32 v208, v208
    s_waitcnt lgkmcnt(3)
    v_mfma_f32_16x16x32_bf16 v[184:187], v[224:227], v[160:163], v[184:187]
    v_exp_f32 v209, v209
    v_mfma_f32_16x16x32_bf16 v[188:191], v[224:227], v[176:179], v[188:191]
    ds_read_b128 v[240:243], v4 offset:40960
    v_cvt_pk_bf16_f32 v53, v206, v207
    v_exp_f32 v210, v210
    s_waitcnt lgkmcnt(3)
    v_mfma_f32_16x16x32_bf16 v[192:195], v[228:231], v[160:163], v[192:195]
    v_exp_f32 v211, v211
    v_mfma_f32_16x16x32_bf16 v[196:199], v[228:231], v[176:179], v[196:199]
    ds_read_b128 v[244:247], v4 offset:41984
    v_cvt_pk_bf16_f32 v50, v208, v209
    v_exp_f32 v212, v212
    s_waitcnt lgkmcnt(3)
    v_mfma_f32_16x16x32_bf16 v[184:187], v[232:235], v[164:167], v[184:187]
    v_exp_f32 v213, v213
    v_cvt_pk_bf16_f32 v51, v210, v211
    v_mfma_f32_16x16x32_bf16 v[188:191], v[232:235], v[180:183], v[188:191]
    ds_read_b128 v[224:227], v4 offset:43008
    v_exp_f32 v214, v214
    s_waitcnt lgkmcnt(3)
    v_mfma_f32_16x16x32_bf16 v[192:195], v[236:239], v[164:167], v[192:195]
    v_exp_f32 v215, v215
    v_cvt_pk_bf16_f32 v54, v212, v213
    v_mfma_f32_16x16x32_bf16 v[196:199], v[236:239], v[180:183], v[196:199]
    ds_read_b128 v[228:231], v4 offset:44032
    v_cvt_pk_bf16_f32 v55, v214, v215
    s_waitcnt lgkmcnt(3)
    v_mfma_f32_16x16x32_bf16 v[200:203], v[240:243], v[152:155], v[216:219]
    v_mfma_f32_16x16x32_bf16 v[204:207], v[240:243], v[168:171], v[220:223]
    ds_read_b128 v[232:235], v4 offset:45056
    v_exp_f32 v184, v184
    v_exp_f32 v185, v185
    v_mfma_f32_16x16x32_bf16 v[248:251], v[12:15], v[48:51], v[248:251]
    s_waitcnt lgkmcnt(3)
    v_mfma_f32_16x16x32_bf16 v[208:211], v[244:247], v[152:155], v[216:219]
    v_exp_f32 v186, v186
    v_exp_f32 v187, v187
    v_mfma_f32_16x16x32_bf16 v[212:215], v[244:247], v[168:171], v[220:223]
    ds_read_b128 v[236:239], v4 offset:46080
    v_cvt_pk_bf16_f32 v56, v184, v185
    v_mfma_f32_16x16x32_bf16 v[252:255], v[12:15], v[52:55], v[252:255]
    s_waitcnt lgkmcnt(3)
    v_mfma_f32_16x16x32_bf16 v[200:203], v[224:227], v[156:159], v[200:203]
    v_exp_f32 v188, v188
    v_exp_f32 v189, v189
    v_mfma_f32_16x16x32_bf16 v[204:207], v[224:227], v[172:175], v[204:207]
    ds_read_b128 v[240:243], v4 offset:47104
    v_cvt_pk_bf16_f32 v57, v186, v187
    s_waitcnt lgkmcnt(3)
    v_mfma_f32_16x16x32_bf16 v[208:211], v[228:231], v[156:159], v[208:211]
    v_exp_f32 v190, v190
    v_exp_f32 v191, v191
    v_mfma_f32_16x16x32_bf16 v[212:215], v[228:231], v[172:175], v[212:215]
    ds_read_b128 v[244:247], v4 offset:48128
    v_cvt_pk_bf16_f32 v60, v188, v189
    v_exp_f32 v192, v192
    s_waitcnt lgkmcnt(3)
    v_mfma_f32_16x16x32_bf16 v[200:203], v[232:235], v[160:163], v[200:203]
    v_exp_f32 v193, v193
    v_mfma_f32_16x16x32_bf16 v[204:207], v[232:235], v[176:179], v[204:207]
    s_barrier
    ds_read_b128 v[224:227], v4 offset:49152
    v_cvt_pk_bf16_f32 v61, v190, v191
    v_exp_f32 v194, v194
    s_waitcnt lgkmcnt(3)
    v_mfma_f32_16x16x32_bf16 v[208:211], v[236:239], v[160:163], v[208:211]
    v_exp_f32 v195, v195
    v_mfma_f32_16x16x32_bf16 v[212:215], v[236:239], v[176:179], v[212:215]
    s_add_u32 s22, s21, 0x1c000
    s_add_u32 m0, s20, 0x14000
    s_nop 0
    buffer_load_dwordx4 v2, s[8:11], s22 offen sc1 lds
    ds_read_b128 v[228:231], v4 offset:50176
    v_cvt_pk_bf16_f32 v58, v192, v193
    v_exp_f32 v196, v196
    s_waitcnt lgkmcnt(3)
    v_mfma_f32_16x16x32_bf16 v[200:203], v[240:243], v[164:167], v[200:203]
    v_exp_f32 v197, v197
    v_cvt_pk_bf16_f32 v59, v194, v195
    v_mfma_f32_16x16x32_bf16 v[204:207], v[240:243], v[180:183], v[204:207]
    ds_read_b128 v[232:235], v4 offset:51200
    v_exp_f32 v198, v198
    s_waitcnt lgkmcnt(3)
    v_mfma_f32_16x16x32_bf16 v[208:211], v[244:247], v[164:167], v[208:211]
    v_exp_f32 v199, v199
    v_cvt_pk_bf16_f32 v62, v196, v197
    v_mfma_f32_16x16x32_bf16 v[212:215], v[244:247], v[180:183], v[212:215]
    ds_read_b128 v[236:239], v4 offset:52224
    v_cvt_pk_bf16_f32 v63, v198, v199
    s_waitcnt lgkmcnt(3)
    v_mfma_f32_16x16x32_bf16 v[184:187], v[224:227], v[152:155], v[216:219]
    v_mfma_f32_16x16x32_bf16 v[188:191], v[224:227], v[168:171], v[220:223]
    ds_read_b128 v[240:243], v4 offset:53248
    v_exp_f32 v200, v200
    v_exp_f32 v201, v201
    v_mfma_f32_16x16x32_bf16 v[248:251], v[12:15], v[56:59], v[248:251]
    s_waitcnt lgkmcnt(3)
    v_mfma_f32_16x16x32_bf16 v[192:195], v[228:231], v[152:155], v[216:219]
    v_exp_f32 v202, v202
    v_exp_f32 v203, v203
    v_mfma_f32_16x16x32_bf16 v[196:199], v[228:231], v[168:171], v[220:223]
    s_add_u32 s22, s21, 0x1c400
    s_add_u32 m0, s20, 0x14400
    s_nop 0
    buffer_load_dwordx4 v2, s[8:11], s22 offen sc1 lds
    ds_read_b128 v[244:247], v4 offset:54272
    v_cvt_pk_bf16_f32 v64, v200, v201
    v_mfma_f32_16x16x32_bf16 v[252:255], v[12:15], v[60:63], v[252:255]
    s_waitcnt lgkmcnt(3)
    v_mfma_f32_16x16x32_bf16 v[184:187], v[232:235], v[156:159], v[184:187]
    v_exp_f32 v204, v204
    v_exp_f32 v205, v205
    v_mfma_f32_16x16x32_bf16 v[188:191], v[232:235], v[172:175], v[188:191]
    ds_read_b128 v[224:227], v4 offset:55296
    v_cvt_pk_bf16_f32 v65, v202, v203
    s_waitcnt lgkmcnt(3)
    v_mfma_f32_16x16x32_bf16 v[192:195], v[236:239], v[156:159], v[192:195]
    v_exp_f32 v206, v206
    v_exp_f32 v207, v207
    v_mfma_f32_16x16x32_bf16 v[196:199], v[236:239], v[172:175], v[196:199]
    ds_read_b128 v[228:231], v4 offset:56320
    v_cvt_pk_bf16_f32 v68, v204, v205
    v_exp_f32 v208, v208
    s_waitcnt lgkmcnt(3)
    v_mfma_f32_16x16x32_bf16 v[184:187], v[240:243], v[160:163], v[184:187]
    v_exp_f32 v209, v209
    v_mfma_f32_16x16x32_bf16 v[188:191], v[240:243], v[176:179], v[188:191]
    ds_read_b128 v[232:235], v4 offset:57344
    v_cvt_pk_bf16_f32 v69, v206, v207
    v_exp_f32 v210, v210
    s_waitcnt lgkmcnt(3)
    v_mfma_f32_16x16x32_bf16 v[192:195], v[244:247], v[160:163], v[192:195]
    v_exp_f32 v211, v211
    v_mfma_f32_16x16x32_bf16 v[196:199], v[244:247], v[176:179], v[196:199]
    ds_read_b128 v[236:239], v4 offset:58368
    v_cvt_pk_bf16_f32 v66, v208, v209
    v_exp_f32 v212, v212
    s_waitcnt lgkmcnt(3)
    v_mfma_f32_16x16x32_bf16 v[184:187], v[224:227], v[164:167], v[184:187]
    v_exp_f32 v213, v213
    v_cvt_pk_bf16_f32 v67, v210, v211
    v_mfma_f32_16x16x32_bf16 v[188:191], v[224:227], v[180:183], v[188:191]
    ds_read_b128 v[240:243], v4 offset:59392
    v_exp_f32 v214, v214
    s_waitcnt lgkmcnt(3)
    v_mfma_f32_16x16x32_bf16 v[192:195], v[228:231], v[164:167], v[192:195]
    v_exp_f32 v215, v215
    v_cvt_pk_bf16_f32 v70, v212, v213
    v_mfma_f32_16x16x32_bf16 v[196:199], v[228:231], v[180:183], v[196:199]
    ds_read_b128 v[244:247], v4 offset:60416
    v_cvt_pk_bf16_f32 v71, v214, v215
    s_waitcnt lgkmcnt(3)
    v_mfma_f32_16x16x32_bf16 v[200:203], v[232:235], v[152:155], v[216:219]
    v_mfma_f32_16x16x32_bf16 v[204:207], v[232:235], v[168:171], v[220:223]
    ds_read_b128 v[224:227], v4 offset:61440
    v_exp_f32 v184, v184
    v_exp_f32 v185, v185
    v_mfma_f32_16x16x32_bf16 v[248:251], v[12:15], v[64:67], v[248:251]
    s_waitcnt lgkmcnt(3)
    v_mfma_f32_16x16x32_bf16 v[208:211], v[236:239], v[152:155], v[216:219]
    v_exp_f32 v186, v186
    v_exp_f32 v187, v187
    v_mfma_f32_16x16x32_bf16 v[212:215], v[236:239], v[168:171], v[220:223]
    ds_read_b128 v[228:231], v4 offset:62464
    v_cvt_pk_bf16_f32 v72, v184, v185
    v_mfma_f32_16x16x32_bf16 v[252:255], v[12:15], v[68:71], v[252:255]
    s_waitcnt lgkmcnt(3)
    v_mfma_f32_16x16x32_bf16 v[200:203], v[240:243], v[156:159], v[200:203]
    v_exp_f32 v188, v188
    v_exp_f32 v189, v189
    v_mfma_f32_16x16x32_bf16 v[204:207], v[240:243], v[172:175], v[204:207]
    ds_read_b128 v[232:235], v4 offset:63488
    v_cvt_pk_bf16_f32 v73, v186, v187
    s_waitcnt lgkmcnt(3)
    v_mfma_f32_16x16x32_bf16 v[208:211], v[244:247], v[156:159], v[208:211]
    v_exp_f32 v190, v190
    v_exp_f32 v191, v191
    v_mfma_f32_16x16x32_bf16 v[212:215], v[244:247], v[172:175], v[212:215]
    ds_read_b128 v[236:239], v4 offset:64512
    v_cvt_pk_bf16_f32 v76, v188, v189
    v_exp_f32 v192, v192
    s_waitcnt lgkmcnt(3)
    v_mfma_f32_16x16x32_bf16 v[200:203], v[224:227], v[160:163], v[200:203]
    v_exp_f32 v193, v193
    v_mfma_f32_16x16x32_bf16 v[204:207], v[224:227], v[176:179], v[204:207]
    s_waitcnt vmcnt(7)
    s_barrier
    ds_read_b128 v[240:243], v5 offset:0
    v_cvt_pk_bf16_f32 v77, v190, v191
    v_exp_f32 v194, v194
    s_waitcnt lgkmcnt(3)
    v_mfma_f32_16x16x32_bf16 v[208:211], v[228:231], v[160:163], v[208:211]
    v_exp_f32 v195, v195
    v_mfma_f32_16x16x32_bf16 v[212:215], v[228:231], v[176:179], v[212:215]
    s_add_u32 s22, s21, 0x80000
    s_add_u32 m0, s20, 0x18000
    s_nop 0
    buffer_load_dwordx4 v2, s[8:11], s22 offen sc1 lds
    ds_read_b128 v[244:247], v5 offset:1024
    v_cvt_pk_bf16_f32 v74, v192, v193
    v_exp_f32 v196, v196
    s_waitcnt lgkmcnt(3)
    v_mfma_f32_16x16x32_bf16 v[200:203], v[232:235], v[164:167], v[200:203]
    v_exp_f32 v197, v197
    v_cvt_pk_bf16_f32 v75, v194, v195
    v_mfma_f32_16x16x32_bf16 v[204:207], v[232:235], v[180:183], v[204:207]
    ds_read_b128 v[224:227], v5 offset:2048
    v_exp_f32 v198, v198
    s_waitcnt lgkmcnt(3)
    v_mfma_f32_16x16x32_bf16 v[208:211], v[236:239], v[164:167], v[208:211]
    v_exp_f32 v199, v199
    v_cvt_pk_bf16_f32 v78, v196, v197
    v_mfma_f32_16x16x32_bf16 v[212:215], v[236:239], v[180:183], v[212:215]
    ds_read_b128 v[228:231], v5 offset:3072
    v_cvt_pk_bf16_f32 v79, v198, v199
    s_waitcnt lgkmcnt(3)
    v_mfma_f32_16x16x32_bf16 v[184:187], v[240:243], v[152:155], v[216:219]
    v_mfma_f32_16x16x32_bf16 v[188:191], v[240:243], v[168:171], v[220:223]
    ds_read_b128 v[232:235], v5 offset:4096
    v_exp_f32 v200, v200
    v_exp_f32 v201, v201
    v_mfma_f32_16x16x32_bf16 v[248:251], v[12:15], v[72:75], v[248:251]
    s_waitcnt lgkmcnt(3)
    v_mfma_f32_16x16x32_bf16 v[192:195], v[244:247], v[152:155], v[216:219]
    v_exp_f32 v202, v202
    v_exp_f32 v203, v203
    v_mfma_f32_16x16x32_bf16 v[196:199], v[244:247], v[168:171], v[220:223]
    s_add_u32 s22, s21, 0x80400
    s_add_u32 m0, s20, 0x18400
    s_nop 0
    buffer_load_dwordx4 v2, s[8:11], s22 offen sc1 lds
    ds_read_b128 v[236:239], v5 offset:5120
    v_cvt_pk_bf16_f32 v80, v200, v201
    v_mfma_f32_16x16x32_bf16 v[252:255], v[12:15], v[76:79], v[252:255]
    s_waitcnt lgkmcnt(3)
    v_mfma_f32_16x16x32_bf16 v[184:187], v[224:227], v[156:159], v[184:187]
    v_exp_f32 v204, v204
    v_exp_f32 v205, v205
    s_add_u32 s22, s18, 0
    s_add_u32 m0, s15, 0
    s_nop 0
    buffer_load_dwordx4 v11, s[64:67], s22 offen lds
    v_mfma_f32_16x16x32_bf16 v[188:191], v[224:227], v[172:175], v[188:191]
    ds_read_b128 v[240:243], v5 offset:6144
    v_cvt_pk_bf16_f32 v81, v202, v203
    s_waitcnt lgkmcnt(3)
    v_mfma_f32_16x16x32_bf16 v[192:195], v[228:231], v[156:159], v[192:195]
    v_exp_f32 v206, v206
    v_exp_f32 v207, v207
    v_mfma_f32_16x16x32_bf16 v[196:199], v[228:231], v[172:175], v[196:199]
    ds_read_b128 v[244:247], v5 offset:7168
    v_cvt_pk_bf16_f32 v84, v204, v205
    v_exp_f32 v208, v208
    s_waitcnt lgkmcnt(3)
    v_mfma_f32_16x16x32_bf16 v[184:187], v[232:235], v[160:163], v[184:187]
    v_exp_f32 v209, v209
    v_mfma_f32_16x16x32_bf16 v[188:191], v[232:235], v[176:179], v[188:191]
    ds_read_b128 v[224:227], v5 offset:8192
    v_cvt_pk_bf16_f32 v85, v206, v207
    v_exp_f32 v210, v210
    s_waitcnt lgkmcnt(3)
    v_mfma_f32_16x16x32_bf16 v[192:195], v[236:239], v[160:163], v[192:195]
    v_exp_f32 v211, v211
    v_mfma_f32_16x16x32_bf16 v[196:199], v[236:239], v[176:179], v[196:199]
    ds_read_b128 v[228:231], v5 offset:9216
    v_cvt_pk_bf16_f32 v82, v208, v209
    v_exp_f32 v212, v212
    s_waitcnt lgkmcnt(3)
    v_mfma_f32_16x16x32_bf16 v[184:187], v[240:243], v[164:167], v[184:187]
    v_exp_f32 v213, v213
    v_cvt_pk_bf16_f32 v83, v210, v211
    v_mfma_f32_16x16x32_bf16 v[188:191], v[240:243], v[180:183], v[188:191]
    ds_read_b128 v[232:235], v5 offset:10240
    v_exp_f32 v214, v214
    s_waitcnt lgkmcnt(3)
    v_mfma_f32_16x16x32_bf16 v[192:195], v[244:247], v[164:167], v[192:195]
    v_exp_f32 v215, v215
    v_cvt_pk_bf16_f32 v86, v212, v213
    v_mfma_f32_16x16x32_bf16 v[196:199], v[244:247], v[180:183], v[196:199]
    ds_read_b128 v[236:239], v5 offset:11264
    v_cvt_pk_bf16_f32 v87, v214, v215
    s_waitcnt lgkmcnt(3)
    v_mfma_f32_16x16x32_bf16 v[200:203], v[224:227], v[152:155], v[216:219]
    v_mfma_f32_16x16x32_bf16 v[204:207], v[224:227], v[168:171], v[220:223]
    ds_read_b128 v[240:243], v5 offset:12288
    v_exp_f32 v184, v184
    v_exp_f32 v185, v185
    v_mfma_f32_16x16x32_bf16 v[248:251], v[12:15], v[80:83], v[248:251]
    s_waitcnt lgkmcnt(3)
    v_mfma_f32_16x16x32_bf16 v[208:211], v[228:231], v[152:155], v[216:219]
    v_exp_f32 v186, v186
    v_exp_f32 v187, v187
    v_mfma_f32_16x16x32_bf16 v[212:215], v[228:231], v[168:171], v[220:223]
    ds_read_b128 v[244:247], v5 offset:13312
    v_cvt_pk_bf16_f32 v88, v184, v185
    s_add_u32 s22, s18, 7168
    s_add_u32 m0, s15, 1024
    s_nop 0
    buffer_load_dwordx4 v11, s[64:67], s22 offen lds
    v_mfma_f32_16x16x32_bf16 v[252:255], v[12:15], v[84:87], v[252:255]
    s_waitcnt lgkmcnt(3)
    v_mfma_f32_16x16x32_bf16 v[200:203], v[232:235], v[156:159], v[200:203]
    v_exp_f32 v188, v188
    v_exp_f32 v189, v189
    v_mfma_f32_16x16x32_bf16 v[204:207], v[232:235], v[172:175], v[204:207]
    ds_read_b128 v[224:227], v5 offset:14336
    v_cvt_pk_bf16_f32 v89, v186, v187
    s_waitcnt lgkmcnt(3)
    v_mfma_f32_16x16x32_bf16 v[208:211], v[236:239], v[156:159], v[208:211]
    v_exp_f32 v190, v190
    v_exp_f32 v191, v191
    v_mfma_f32_16x16x32_bf16 v[212:215], v[236:239], v[172:175], v[212:215]
    ds_read_b128 v[228:231], v5 offset:15360
    v_cvt_pk_bf16_f32 v92, v188, v189
    v_exp_f32 v192, v192
    s_waitcnt lgkmcnt(3)
    v_mfma_f32_16x16x32_bf16 v[200:203], v[240:243], v[160:163], v[200:203]
    v_exp_f32 v193, v193
    v_mfma_f32_16x16x32_bf16 v[204:207], v[240:243], v[176:179], v[204:207]
    s_waitcnt vmcnt(8)
    s_barrier
    ds_read_b128 v[232:235], v5 offset:16384
    v_cvt_pk_bf16_f32 v93, v190, v191
    v_exp_f32 v194, v194
    s_waitcnt lgkmcnt(3)
    v_mfma_f32_16x16x32_bf16 v[208:211], v[244:247], v[160:163], v[208:211]
    v_exp_f32 v195, v195
    v_mfma_f32_16x16x32_bf16 v[212:215], v[244:247], v[176:179], v[212:215]
    s_add_u32 s22, s21, 0x84000
    s_add_u32 m0, s20, 0x1c000
    s_nop 0
    buffer_load_dwordx4 v2, s[8:11], s22 offen sc1 lds
    ds_read_b128 v[236:239], v5 offset:17408
    v_cvt_pk_bf16_f32 v90, v192, v193
    v_exp_f32 v196, v196
    s_waitcnt lgkmcnt(3)
    v_mfma_f32_16x16x32_bf16 v[200:203], v[224:227], v[164:167], v[200:203]
    v_exp_f32 v197, v197
    v_cvt_pk_bf16_f32 v91, v194, v195
    v_mfma_f32_16x16x32_bf16 v[204:207], v[224:227], v[180:183], v[204:207]
    ds_read_b128 v[240:243], v5 offset:18432
    v_exp_f32 v198, v198
    s_waitcnt lgkmcnt(3)
    v_mfma_f32_16x16x32_bf16 v[208:211], v[228:231], v[164:167], v[208:211]
    v_exp_f32 v199, v199
    v_cvt_pk_bf16_f32 v94, v196, v197
    v_mfma_f32_16x16x32_bf16 v[212:215], v[228:231], v[180:183], v[212:215]
    ds_read_b128 v[244:247], v5 offset:19456
    v_cvt_pk_bf16_f32 v95, v198, v199
    s_waitcnt lgkmcnt(3)
    v_mfma_f32_16x16x32_bf16 v[184:187], v[232:235], v[152:155], v[216:219]
    v_mfma_f32_16x16x32_bf16 v[188:191], v[232:235], v[168:171], v[220:223]
    ds_read_b128 v[224:227], v5 offset:20480
    v_exp_f32 v200, v200
    v_exp_f32 v201, v201
    v_mfma_f32_16x16x32_bf16 v[248:251], v[12:15], v[88:91], v[248:251]
    s_waitcnt lgkmcnt(3)
    v_mfma_f32_16x16x32_bf16 v[192:195], v[236:239], v[152:155], v[216:219]
    v_exp_f32 v202, v202
    v_exp_f32 v203, v203
    v_mfma_f32_16x16x32_bf16 v[196:199], v[236:239], v[168:171], v[220:223]
    s_add_u32 s22, s21, 0x84400
    s_add_u32 m0, s20, 0x1c400
    s_nop 0
    buffer_load_dwordx4 v2, s[8:11], s22 offen sc1 lds
    ds_read_b128 v[228:231], v5 offset:21504
    v_cvt_pk_bf16_f32 v96, v200, v201
    s_add_u32 s22, s18, 14336
    s_add_u32 m0, s15, 2048
    s_nop 0
    buffer_load_dwordx4 v11, s[64:67], s22 offen lds
    v_mfma_f32_16x16x32_bf16 v[252:255], v[12:15], v[92:95], v[252:255]
    s_waitcnt lgkmcnt(3)
    v_mfma_f32_16x16x32_bf16 v[184:187], v[240:243], v[156:159], v[184:187]
    v_exp_f32 v204, v204
    v_exp_f32 v205, v205
    v_mfma_f32_16x16x32_bf16 v[188:191], v[240:243], v[172:175], v[188:191]
    ds_read_b128 v[232:235], v5 offset:22528
    v_cvt_pk_bf16_f32 v97, v202, v203
    s_waitcnt lgkmcnt(3)
    v_mfma_f32_16x16x32_bf16 v[192:195], v[244:247], v[156:159], v[192:195]
    v_exp_f32 v206, v206
    v_exp_f32 v207, v207
    v_mfma_f32_16x16x32_bf16 v[196:199], v[244:247], v[172:175], v[196:199]
    ds_read_b128 v[236:239], v5 offset:23552
    v_cvt_pk_bf16_f32 v100, v204, v205
    v_exp_f32 v208, v208
    s_waitcnt lgkmcnt(3)
    v_mfma_f32_16x16x32_bf16 v[184:187], v[224:227], v[160:163], v[184:187]
    v_exp_f32 v209, v209
    v_mfma_f32_16x16x32_bf16 v[188:191], v[224:227], v[176:179], v[188:191]
    ds_read_b128 v[240:243], v5 offset:24576
    v_cvt_pk_bf16_f32 v101, v206, v207
    v_exp_f32 v210, v210
    s_waitcnt lgkmcnt(3)
    v_mfma_f32_16x16x32_bf16 v[192:195], v[228:231], v[160:163], v[192:195]
    v_exp_f32 v211, v211
    v_mfma_f32_16x16x32_bf16 v[196:199], v[228:231], v[176:179], v[196:199]
    ds_read_b128 v[244:247], v5 offset:25600
    v_cvt_pk_bf16_f32 v98, v208, v209
    v_exp_f32 v212, v212
    s_waitcnt lgkmcnt(3)
    v_mfma_f32_16x16x32_bf16 v[184:187], v[232:235], v[164:167], v[184:187]
    v_exp_f32 v213, v213
    v_cvt_pk_bf16_f32 v99, v210, v211
    v_mfma_f32_16x16x32_bf16 v[188:191], v[232:235], v[180:183], v[188:191]
    ds_read_b128 v[224:227], v5 offset:26624
    v_exp_f32 v214, v214
    s_waitcnt lgkmcnt(3)
    v_mfma_f32_16x16x32_bf16 v[192:195], v[236:239], v[164:167], v[192:195]
    v_exp_f32 v215, v215
    v_cvt_pk_bf16_f32 v102, v212, v213
    v_mfma_f32_16x16x32_bf16 v[196:199], v[236:239], v[180:183], v[196:199]
    ds_read_b128 v[228:231], v5 offset:27648
    v_cvt_pk_bf16_f32 v103, v214, v215
    s_waitcnt lgkmcnt(3)
    v_mfma_f32_16x16x32_bf16 v[200:203], v[240:243], v[152:155], v[216:219]
    v_mfma_f32_16x16x32_bf16 v[204:207], v[240:243], v[168:171], v[220:223]
    ds_read_b128 v[232:235], v5 offset:28672
    v_exp_f32 v184, v184
    v_exp_f32 v185, v185
    v_mfma_f32_16x16x32_bf16 v[248:251], v[12:15], v[96:99], v[248:251]
    s_waitcnt lgkmcnt(3)
    v_mfma_f32_16x16x32_bf16 v[208:211], v[244:247], v[152:155], v[216:219]
    v_exp_f32 v186, v186
    v_exp_f32 v187, v187
    s_add_u32 s22, s18, 21504
    s_add_u32 m0, s15, 3072
    s_nop 0
    buffer_load_dwordx4 v11, s[64:67], s22 offen lds
    v_mfma_f32_16x16x32_bf16 v[212:215], v[244:247], v[168:171], v[220:223]
    ds_read_b128 v[236:239], v5 offset:29696
    v_cvt_pk_bf16_f32 v104, v184, v185
    v_mfma_f32_16x16x32_bf16 v[252:255], v[12:15], v[100:103], v[252:255]
    s_waitcnt lgkmcnt(3)
    v_mfma_f32_16x16x32_bf16 v[200:203], v[224:227], v[156:159], v[200:203]
    v_exp_f32 v188, v188
    v_exp_f32 v189, v189
    v_mfma_f32_16x16x32_bf16 v[204:207], v[224:227], v[172:175], v[204:207]
    ds_read_b128 v[240:243], v5 offset:30720
    v_cvt_pk_bf16_f32 v105, v186, v187
    s_waitcnt lgkmcnt(3)
    v_mfma_f32_16x16x32_bf16 v[208:211], v[228:231], v[156:159], v[208:211]
    v_exp_f32 v190, v190
    v_exp_f32 v191, v191
    v_mfma_f32_16x16x32_bf16 v[212:215], v[228:231], v[172:175], v[212:215]
    ds_read_b128 v[244:247], v5 offset:31744
    v_cvt_pk_bf16_f32 v108, v188, v189
    v_exp_f32 v192, v192
    s_waitcnt lgkmcnt(3)
    v_mfma_f32_16x16x32_bf16 v[200:203], v[232:235], v[160:163], v[200:203]
    v_exp_f32 v193, v193
    v_mfma_f32_16x16x32_bf16 v[204:207], v[232:235], v[176:179], v[204:207]
    s_waitcnt vmcnt(10)
    s_barrier
    ds_read_b128 v[224:227], v4 offset:0
    v_cvt_pk_bf16_f32 v109, v190, v191
    v_exp_f32 v194, v194
    s_waitcnt lgkmcnt(3)
    v_mfma_f32_16x16x32_bf16 v[208:211], v[236:239], v[160:163], v[208:211]
    v_exp_f32 v195, v195
    v_mfma_f32_16x16x32_bf16 v[212:215], v[236:239], v[176:179], v[212:215]
    s_add_u32 s22, s21, 0x88000
    s_add_u32 m0, s20, 0x20000
    s_nop 0
    buffer_load_dwordx4 v2, s[8:11], s22 offen sc1 lds
    ds_read_b128 v[228:231], v4 offset:1024
    v_cvt_pk_bf16_f32 v106, v192, v193
    v_exp_f32 v196, v196
    s_waitcnt lgkmcnt(3)
    v_mfma_f32_16x16x32_bf16 v[200:203], v[240:243], v[164:167], v[200:203]
    v_exp_f32 v197, v197
    v_cvt_pk_bf16_f32 v107, v194, v195
    v_mfma_f32_16x16x32_bf16 v[204:207], v[240:243], v[180:183], v[204:207]
    ds_read_b128 v[232:235], v4 offset:2048
    v_exp_f32 v198, v198
    s_waitcnt lgkmcnt(3)
    v_mfma_f32_16x16x32_bf16 v[208:211], v[244:247], v[164:167], v[208:211]
    v_exp_f32 v199, v199
    v_cvt_pk_bf16_f32 v110, v196, v197
    v_mfma_f32_16x16x32_bf16 v[212:215], v[244:247], v[180:183], v[212:215]
    ds_read_b128 v[236:239], v4 offset:3072
    v_cvt_pk_bf16_f32 v111, v198, v199
    s_waitcnt lgkmcnt(3)
    v_mfma_f32_16x16x32_bf16 v[184:187], v[224:227], v[152:155], v[216:219]
    v_mfma_f32_16x16x32_bf16 v[188:191], v[224:227], v[168:171], v[220:223]
    ds_read_b128 v[240:243], v4 offset:4096
    v_exp_f32 v200, v200
    v_exp_f32 v201, v201
    v_mfma_f32_16x16x32_bf16 v[248:251], v[12:15], v[104:107], v[248:251]
    s_waitcnt lgkmcnt(3)
    v_mfma_f32_16x16x32_bf16 v[192:195], v[228:231], v[152:155], v[216:219]
    v_exp_f32 v202, v202
    v_exp_f32 v203, v203
    s_add_u32 s22, s18, 28672
    s_add_u32 m0, s15, 4096
    s_nop 0
    buffer_load_dwordx4 v11, s[64:67], s22 offen lds
    v_mfma_f32_16x16x32_bf16 v[196:199], v[228:231], v[168:171], v[220:223]
    s_add_u32 s22, s21, 0x88400
    s_add_u32 m0, s20, 0x20400
    s_nop 0
    buffer_load_dwordx4 v2, s[8:11], s22 offen sc1 lds
    ds_read_b128 v[244:247], v4 offset:5120
    v_cvt_pk_bf16_f32 v112, v200, v201
    v_mfma_f32_16x16x32_bf16 v[252:255], v[12:15], v[108:111], v[252:255]
    s_waitcnt lgkmcnt(3)
    v_mfma_f32_16x16x32_bf16 v[184:187], v[232:235], v[156:159], v[184:187]
    v_exp_f32 v204, v204
    v_exp_f32 v205, v205
    v_mfma_f32_16x16x32_bf16 v[188:191], v[232:235], v[172:175], v[188:191]
    ds_read_b128 v[224:227], v4 offset:6144
    v_cvt_pk_bf16_f32 v113, v202, v203
    s_waitcnt lgkmcnt(3)
    v_mfma_f32_16x16x32_bf16 v[192:195], v[236:239], v[156:159], v[192:195]
    v_exp_f32 v206, v206
    v_exp_f32 v207, v207
    v_mfma_f32_16x16x32_bf16 v[196:199], v[236:239], v[172:175], v[196:199]
    ds_read_b128 v[228:231], v4 offset:7168
    v_cvt_pk_bf16_f32 v116, v204, v205
    v_exp_f32 v208, v208
    s_waitcnt lgkmcnt(3)
    v_mfma_f32_16x16x32_bf16 v[184:187], v[240:243], v[160:163], v[184:187]
    v_exp_f32 v209, v209
    v_mfma_f32_16x16x32_bf16 v[188:191], v[240:243], v[176:179], v[188:191]
    ds_read_b128 v[232:235], v4 offset:8192
    v_cvt_pk_bf16_f32 v117, v206, v207
    v_exp_f32 v210, v210
    s_waitcnt lgkmcnt(3)
    v_mfma_f32_16x16x32_bf16 v[192:195], v[244:247], v[160:163], v[192:195]
    v_exp_f32 v211, v211
    v_mfma_f32_16x16x32_bf16 v[196:199], v[244:247], v[176:179], v[196:199]
    ds_read_b128 v[236:239], v4 offset:9216
    v_cvt_pk_bf16_f32 v114, v208, v209
    v_exp_f32 v212, v212
    s_waitcnt lgkmcnt(3)
    v_mfma_f32_16x16x32_bf16 v[184:187], v[224:227], v[164:167], v[184:187]
    v_exp_f32 v213, v213
    v_cvt_pk_bf16_f32 v115, v210, v211
    v_mfma_f32_16x16x32_bf16 v[188:191], v[224:227], v[180:183], v[188:191]
    ds_read_b128 v[240:243], v4 offset:10240
    v_exp_f32 v214, v214
    s_waitcnt lgkmcnt(3)
    v_mfma_f32_16x16x32_bf16 v[192:195], v[228:231], v[164:167], v[192:195]
    v_exp_f32 v215, v215
    v_cvt_pk_bf16_f32 v118, v212, v213
    v_mfma_f32_16x16x32_bf16 v[196:199], v[228:231], v[180:183], v[196:199]
    ds_read_b128 v[244:247], v4 offset:11264
    v_cvt_pk_bf16_f32 v119, v214, v215
    s_waitcnt lgkmcnt(3)
    v_mfma_f32_16x16x32_bf16 v[200:203], v[232:235], v[152:155], v[216:219]
    v_mfma_f32_16x16x32_bf16 v[204:207], v[232:235], v[168:171], v[220:223]
    ds_read_b128 v[224:227], v4 offset:12288
    v_exp_f32 v184, v184
    v_exp_f32 v185, v185
    s_add_u32 s22, s18, 35840
    s_add_u32 m0, s15, 5120
    s_nop 0
    buffer_load_dwordx4 v11, s[64:67], s22 offen lds
    v_mfma_f32_16x16x32_bf16 v[248:251], v[12:15], v[112:115], v[248:251]
    s_waitcnt lgkmcnt(3)
    v_mfma_f32_16x16x32_bf16 v[208:211], v[236:239], v[152:155], v[216:219]
    v_exp_f32 v186, v186
    v_exp_f32 v187, v187
    v_mfma_f32_16x16x32_bf16 v[212:215], v[236:239], v[168:171], v[220:223]
    ds_read_b128 v[228:231], v4 offset:13312
    v_cvt_pk_bf16_f32 v120, v184, v185
    v_mfma_f32_16x16x32_bf16 v[252:255], v[12:15], v[116:119], v[252:255]
    s_waitcnt lgkmcnt(3)
    v_mfma_f32_16x16x32_bf16 v[200:203], v[240:243], v[156:159], v[200:203]
    v_exp_f32 v188, v188
    v_exp_f32 v189, v189
    v_mfma_f32_16x16x32_bf16 v[204:207], v[240:243], v[172:175], v[204:207]
    ds_read_b128 v[232:235], v4 offset:14336
    v_cvt_pk_bf16_f32 v121, v186, v187
    s_waitcnt lgkmcnt(3)
    v_mfma_f32_16x16x32_bf16 v[208:211], v[244:247], v[156:159], v[208:211]
    v_exp_f32 v190, v190
    v_exp_f32 v191, v191
    v_mfma_f32_16x16x32_bf16 v[212:215], v[244:247], v[172:175], v[212:215]
    ds_read_b128 v[236:239], v4 offset:15360
    v_cvt_pk_bf16_f32 v124, v188, v189
    v_exp_f32 v192, v192
    s_waitcnt lgkmcnt(3)
    v_mfma_f32_16x16x32_bf16 v[200:203], v[224:227], v[160:163], v[200:203]
    v_exp_f32 v193, v193
    v_mfma_f32_16x16x32_bf16 v[204:207], v[224:227], v[176:179], v[204:207]
    s_waitcnt vmcnt(12)
    s_barrier
    ds_read_b128 v[240:243], v4 offset:16384
    v_cvt_pk_bf16_f32 v125, v190, v191
    v_exp_f32 v194, v194
    s_waitcnt lgkmcnt(3)
    v_mfma_f32_16x16x32_bf16 v[208:211], v[228:231], v[160:163], v[208:211]
    v_exp_f32 v195, v195
    v_mfma_f32_16x16x32_bf16 v[212:215], v[228:231], v[176:179], v[212:215]
    s_add_u32 s22, s21, 0x8c000
    s_add_u32 m0, s20, 0x24000
    s_nop 0
    buffer_load_dwordx4 v2, s[8:11], s22 offen sc1 lds
    ds_read_b128 v[244:247], v4 offset:17408
    v_cvt_pk_bf16_f32 v122, v192, v193
    v_exp_f32 v196, v196
    s_waitcnt lgkmcnt(3)
    v_mfma_f32_16x16x32_bf16 v[200:203], v[232:235], v[164:167], v[200:203]
    v_exp_f32 v197, v197
    v_cvt_pk_bf16_f32 v123, v194, v195
    v_mfma_f32_16x16x32_bf16 v[204:207], v[232:235], v[180:183], v[204:207]
    ds_read_b128 v[224:227], v4 offset:18432
    v_exp_f32 v198, v198
    s_waitcnt lgkmcnt(3)
    v_mfma_f32_16x16x32_bf16 v[208:211], v[236:239], v[164:167], v[208:211]
    v_exp_f32 v199, v199
    v_cvt_pk_bf16_f32 v126, v196, v197
    v_mfma_f32_16x16x32_bf16 v[212:215], v[236:239], v[180:183], v[212:215]
    ds_read_b128 v[228:231], v4 offset:19456
    v_cvt_pk_bf16_f32 v127, v198, v199
    s_waitcnt lgkmcnt(3)
    v_mfma_f32_16x16x32_bf16 v[184:187], v[240:243], v[152:155], v[216:219]
    v_mfma_f32_16x16x32_bf16 v[188:191], v[240:243], v[168:171], v[220:223]
    ds_read_b128 v[232:235], v4 offset:20480
    v_exp_f32 v200, v200
    v_exp_f32 v201, v201
    s_add_u32 s22, s18, 43008
    s_add_u32 m0, s15, 6144
    s_nop 0
    buffer_load_dwordx4 v11, s[64:67], s22 offen lds
    v_mfma_f32_16x16x32_bf16 v[248:251], v[12:15], v[120:123], v[248:251]
    s_waitcnt lgkmcnt(3)
    v_mfma_f32_16x16x32_bf16 v[192:195], v[244:247], v[152:155], v[216:219]
    v_exp_f32 v202, v202
    v_exp_f32 v203, v203
    v_mfma_f32_16x16x32_bf16 v[196:199], v[244:247], v[168:171], v[220:223]
    s_add_u32 s22, s21, 0x8c400
    s_add_u32 m0, s20, 0x24400
    s_nop 0
    buffer_load_dwordx4 v2, s[8:11], s22 offen sc1 lds
    ds_read_b128 v[236:239], v4 offset:21504
    v_cvt_pk_bf16_f32 v128, v200, v201
    v_mfma_f32_16x16x32_bf16 v[252:255], v[12:15], v[124:127], v[252:255]
    s_waitcnt lgkmcnt(3)
    v_mfma_f32_16x16x32_bf16 v[184:187], v[224:227], v[156:159], v[184:187]
    v_exp_f32 v204, v204
    v_exp_f32 v205, v205
    v_mfma_f32_16x16x32_bf16 v[188:191], v[224:227], v[172:175], v[188:191]
    ds_read_b128 v[240:243], v4 offset:22528
    v_cvt_pk_bf16_f32 v129, v202, v203
    s_waitcnt lgkmcnt(3)
    v_mfma_f32_16x16x32_bf16 v[192:195], v[228:231], v[156:159], v[192:195]
    v_exp_f32 v206, v206
    v_exp_f32 v207, v207
    v_mfma_f32_16x16x32_bf16 v[196:199], v[228:231], v[172:175], v[196:199]
    ds_read_b128 v[244:247], v4 offset:23552
    v_cvt_pk_bf16_f32 v132, v204, v205
    v_exp_f32 v208, v208
    s_waitcnt lgkmcnt(3)
    v_mfma_f32_16x16x32_bf16 v[184:187], v[232:235], v[160:163], v[184:187]
    v_exp_f32 v209, v209
    v_mfma_f32_16x16x32_bf16 v[188:191], v[232:235], v[176:179], v[188:191]
    ds_read_b128 v[224:227], v4 offset:24576
    v_cvt_pk_bf16_f32 v133, v206, v207
    v_exp_f32 v210, v210
    s_waitcnt lgkmcnt(3)
    v_mfma_f32_16x16x32_bf16 v[192:195], v[236:239], v[160:163], v[192:195]
    v_exp_f32 v211, v211
    v_mfma_f32_16x16x32_bf16 v[196:199], v[236:239], v[176:179], v[196:199]
    ds_read_b128 v[228:231], v4 offset:25600
    v_cvt_pk_bf16_f32 v130, v208, v209
    v_exp_f32 v212, v212
    s_waitcnt lgkmcnt(3)
    v_mfma_f32_16x16x32_bf16 v[184:187], v[240:243], v[164:167], v[184:187]
    v_exp_f32 v213, v213
    v_cvt_pk_bf16_f32 v131, v210, v211
    v_mfma_f32_16x16x32_bf16 v[188:191], v[240:243], v[180:183], v[188:191]
    ds_read_b128 v[232:235], v4 offset:26624
    v_exp_f32 v214, v214
    s_waitcnt lgkmcnt(3)
    v_mfma_f32_16x16x32_bf16 v[192:195], v[244:247], v[164:167], v[192:195]
    v_exp_f32 v215, v215
    v_cvt_pk_bf16_f32 v134, v212, v213
    v_mfma_f32_16x16x32_bf16 v[196:199], v[244:247], v[180:183], v[196:199]
    ds_read_b128 v[236:239], v4 offset:27648
    v_cvt_pk_bf16_f32 v135, v214, v215
    s_waitcnt lgkmcnt(3)
    v_mfma_f32_16x16x32_bf16 v[200:203], v[224:227], v[152:155], v[216:219]
    s_add_u32 s22, s18, 50176
    s_add_u32 m0, s15, 7168
    s_nop 0
    buffer_load_dwordx4 v11, s[64:67], s22 offen lds
    v_mfma_f32_16x16x32_bf16 v[204:207], v[224:227], v[168:171], v[220:223]
    ds_read_b128 v[240:243], v4 offset:28672
    v_exp_f32 v184, v184
    v_exp_f32 v185, v185
    v_mfma_f32_16x16x32_bf16 v[248:251], v[12:15], v[128:131], v[248:251]
    s_waitcnt lgkmcnt(3)
    v_mfma_f32_16x16x32_bf16 v[208:211], v[228:231], v[152:155], v[216:219]
    v_exp_f32 v186, v186
    v_exp_f32 v187, v187
    v_mfma_f32_16x16x32_bf16 v[212:215], v[228:231], v[168:171], v[220:223]
    ds_read_b128 v[244:247], v4 offset:29696
    v_cvt_pk_bf16_f32 v136, v184, v185
    v_mfma_f32_16x16x32_bf16 v[252:255], v[12:15], v[132:135], v[252:255]
    s_waitcnt lgkmcnt(3)
    v_mfma_f32_16x16x32_bf16 v[200:203], v[232:235], v[156:159], v[200:203]
    v_exp_f32 v188, v188
    v_exp_f32 v189, v189
    v_mfma_f32_16x16x32_bf16 v[204:207], v[232:235], v[172:175], v[204:207]
    ds_read_b128 v[224:227], v4 offset:30720
    v_cvt_pk_bf16_f32 v137, v186, v187
    s_waitcnt lgkmcnt(3)
    v_mfma_f32_16x16x32_bf16 v[208:211], v[236:239], v[156:159], v[208:211]
    v_exp_f32 v190, v190
    v_exp_f32 v191, v191
    v_mfma_f32_16x16x32_bf16 v[212:215], v[236:239], v[172:175], v[212:215]
    ds_read_b128 v[228:231], v4 offset:31744
    v_cvt_pk_bf16_f32 v140, v188, v189
    v_exp_f32 v192, v192
    s_waitcnt lgkmcnt(3)
    v_mfma_f32_16x16x32_bf16 v[200:203], v[240:243], v[160:163], v[200:203]
    v_exp_f32 v193, v193
    v_mfma_f32_16x16x32_bf16 v[204:207], v[240:243], v[176:179], v[204:207]
    v_cvt_pk_bf16_f32 v141, v190, v191
    v_exp_f32 v194, v194
    s_waitcnt lgkmcnt(2)
    v_mfma_f32_16x16x32_bf16 v[208:211], v[244:247], v[160:163], v[208:211]
    v_exp_f32 v195, v195
    v_mfma_f32_16x16x32_bf16 v[212:215], v[244:247], v[176:179], v[212:215]
    v_cvt_pk_bf16_f32 v138, v192, v193
    v_exp_f32 v196, v196
    s_waitcnt lgkmcnt(1)
    v_mfma_f32_16x16x32_bf16 v[200:203], v[224:227], v[164:167], v[200:203]
    v_exp_f32 v197, v197
    v_cvt_pk_bf16_f32 v139, v194, v195
    v_mfma_f32_16x16x32_bf16 v[204:207], v[224:227], v[180:183], v[204:207]
    v_exp_f32 v198, v198
    s_waitcnt lgkmcnt(0)
    v_mfma_f32_16x16x32_bf16 v[208:211], v[228:231], v[164:167], v[208:211]
    v_exp_f32 v199, v199
    v_cvt_pk_bf16_f32 v142, v196, v197
    v_mfma_f32_16x16x32_bf16 v[212:215], v[228:231], v[180:183], v[212:215]
    v_cvt_pk_bf16_f32 v143, v198, v199
    s_waitcnt vmcnt(14)
    s_barrier
    ds_read_b128 v[232:235], v4 offset:32768
    ds_read_b128 v[236:239], v4 offset:33792
    ds_read_b128 v[240:243], v4 offset:34816
    ds_read_b128 v[244:247], v4 offset:35840
    v_mfma_f32_16x16x32_bf16 v[248:251], v[12:15], v[136:139], v[248:251]
    v_mfma_f32_16x16x32_bf16 v[252:255], v[12:15], v[140:143], v[252:255]
    v_exp_f32 v200, v200
    v_exp_f32 v201, v201
    v_exp_f32 v202, v202
    v_exp_f32 v203, v203
    v_cvt_pk_bf16_f32 v144, v200, v201
    v_exp_f32 v204, v204
    v_exp_f32 v205, v205
    v_cvt_pk_bf16_f32 v145, v202, v203
    v_exp_f32 v206, v206
    v_exp_f32 v207, v207
    v_cvt_pk_bf16_f32 v148, v204, v205
    v_exp_f32 v208, v208
    v_exp_f32 v209, v209
    v_cvt_pk_bf16_f32 v149, v206, v207
    v_exp_f32 v210, v210
    v_exp_f32 v211, v211
    v_cvt_pk_bf16_f32 v146, v208, v209
    v_exp_f32 v212, v212
    v_exp_f32 v213, v213
    v_cvt_pk_bf16_f32 v147, v210, v211
    v_exp_f32 v214, v214
    v_exp_f32 v215, v215
    v_cvt_pk_bf16_f32 v150, v212, v213
    v_cvt_pk_bf16_f32 v151, v214, v215
    v_mfma_f32_16x16x32_bf16 v[248:251], v[12:15], v[144:147], v[248:251]
    s_nop 0
    v_mfma_f32_16x16x32_bf16 v[252:255], v[12:15], v[148:151], v[252:255]
    s_nop 5
    v_mov_b32 v9, v248
    s_nop 0
    v_mov_b32 v10, v252
    v_max_f32 v17, v9, v10
    v_readfirstlane_b32 s17, v8
    s_cmp_eq_u32 s17, s28
    s_cselect_b32 s16, 0, 0x71800000
    v_cmp_ngt_f32 vcc, s16, v17
    v_cmp_u_f32 s[76:77], v9, v10
    s_or_b64 vcc, vcc, s[76:77]
    s_cbranch_vccnz adaLN_cond__sliding_block_cached__moe_arch_mod__prompt_kernel_fixB
adaLN_cond__sliding_block_cached__moe_arch_mod__prompt_kernel_fixBb:
    v_rcp_f32 v9, v9
    v_rcp_f32 v10, v10
    s_lshl_b32 s25, s13, 3
    s_add_u32 s25, s25, s3
    s_lshl_b32 s25, s25, 18
    s_lshl_b32 s26, s12, 12
    s_add_u32 s25, s25, s26
    s_add_u32 s25, s25, 0x1000000
    s_add_u32 s26, s25, 131072
    s_lshl_b32 s63, s13, 3
    s_add_u32 s63, s63, s3
    s_lshl_b32 s63, s63, 5
    s_add_u32 s63, s63, s12
    s_lshl_b32 s63, s63, 2
    s_waitcnt lgkmcnt(3)
    v_mfma_f32_16x16x32_bf16 v[184:187], v[232:235], v[24:27], 0
    s_mov_b64 s[76:77], s[54:55]
    s_mov_b32 s78, 0xc00000
    s_mov_b32 s79, 0x20000
    v_mfma_f32_16x16x32_bf16 v[188:191], v[232:235], v[28:31], 0
    ds_read_b128 v[224:227], v4 offset:36864
    s_waitcnt lgkmcnt(3)
    v_mfma_f32_16x16x32_bf16 v[192:195], v[236:239], v[24:27], 0
    s_add_u32 s22, s14, 0x0
    s_add_u32 m0, s20, 0x10000
    s_nop 0
    buffer_load_dwordx4 v6, s[76:79], s22 offen lds
    v_mfma_f32_16x16x32_bf16 v[196:199], v[236:239], v[28:31], 0
    ds_read_b128 v[228:231], v4 offset:37888
    s_waitcnt lgkmcnt(3)
    v_mfma_f32_16x16x32_bf16 v[184:187], v[240:243], v[32:35], v[184:187]
    v_mfma_f32_16x16x32_bf16 v[188:191], v[240:243], v[36:39], v[188:191]
    ds_read_b128 v[232:235], v4 offset:38912
    s_waitcnt lgkmcnt(3)
    v_mfma_f32_16x16x32_bf16 v[192:195], v[244:247], v[32:35], v[192:195]
    v_mfma_f32_16x16x32_bf16 v[196:199], v[244:247], v[36:39], v[196:199]
    ds_read_b128 v[236:239], v4 offset:39936
    s_waitcnt lgkmcnt(3)
    v_mfma_f32_16x16x32_bf16 v[184:187], v[224:227], v[40:43], v[184:187]
    v_mfma_f32_16x16x32_bf16 v[188:191], v[224:227], v[44:47], v[188:191]
    ds_read_b128 v[240:243], v4 offset:40960
    s_waitcnt lgkmcnt(3)
    v_mfma_f32_16x16x32_bf16 v[192:195], v[228:231], v[40:43], v[192:195]
    s_add_u32 s22, s14, 0xc000
    s_add_u32 m0, s20, 0x10400
    s_nop 0
    buffer_load_dwordx4 v6, s[76:79], s22 offen lds
    v_mfma_f32_16x16x32_bf16 v[196:199], v[228:231], v[44:47], v[196:199]
    ds_read_b128 v[244:247], v4 offset:41984
    s_waitcnt lgkmcnt(3)
    v_mfma_f32_16x16x32_bf16 v[184:187], v[232:235], v[48:51], v[184:187]
    v_mfma_f32_16x16x32_bf16 v[188:191], v[232:235], v[52:55], v[188:191]
    ds_read_b128 v[224:227], v4 offset:43008
    s_waitcnt lgkmcnt(3)
    v_mfma_f32_16x16x32_bf16 v[192:195], v[236:239], v[48:51], v[192:195]
    v_mfma_f32_16x16x32_bf16 v[196:199], v[236:239], v[52:55], v[196:199]
    ds_read_b128 v[228:231], v4 offset:44032
    s_waitcnt lgkmcnt(3)
    v_mfma_f32_16x16x32_bf16 v[184:187], v[240:243], v[56:59], v[184:187]
    v_mfma_f32_16x16x32_bf16 v[188:191], v[240:243], v[60:63], v[188:191]
    ds_read_b128 v[232:235], v4 offset:45056
    s_waitcnt lgkmcnt(3)
    v_mfma_f32_16x16x32_bf16 v[192:195], v[244:247], v[56:59], v[192:195]
    v_mfma_f32_16x16x32_bf16 v[196:199], v[244:247], v[60:63], v[196:199]
    ds_read_b128 v[236:239], v4 offset:46080
    s_waitcnt lgkmcnt(3)
    v_mfma_f32_16x16x32_bf16 v[184:187], v[224:227], v[64:67], v[184:187]
    v_mfma_f32_16x16x32_bf16 v[188:191], v[224:227], v[68:71], v[188:191]
    ds_read_b128 v[240:243], v4 offset:47104
    s_waitcnt lgkmcnt(3)
    v_mfma_f32_16x16x32_bf16 v[192:195], v[228:231], v[64:67], v[192:195]
    v_mfma_f32_16x16x32_bf16 v[196:199], v[228:231], v[68:71], v[196:199]
    ds_read_b128 v[244:247], v4 offset:48128
    s_waitcnt lgkmcnt(3)
    v_mfma_f32_16x16x32_bf16 v[184:187], v[232:235], v[72:75], v[184:187]
    v_mfma_f32_16x16x32_bf16 v[188:191], v[232:235], v[76:79], v[188:191]
    s_waitcnt vmcnt(12)
    s_barrier
    ds_read_b128 v[224:227], v4 offset:49152
    s_waitcnt lgkmcnt(3)
    v_mfma_f32_16x16x32_bf16 v[192:195], v[236:239], v[72:75], v[192:195]
    v_mfma_f32_16x16x32_bf16 v[196:199], v[236:239], v[76:79], v[196:199]
    s_add_u32 s22, s14, 0xc0000
    s_add_u32 m0, s20, 0x14000
    s_nop 0
    buffer_load_dwordx4 v6, s[76:79], s22 offen lds
    ds_read_b128 v[228:231], v4 offset:50176
    s_waitcnt lgkmcnt(3)
    v_mfma_f32_16x16x32_bf16 v[184:187], v[240:243], v[80:83], v[184:187]
    v_mfma_f32_16x16x32_bf16 v[188:191], v[240:243], v[84:87], v[188:191]
    ds_read_b128 v[232:235], v4 offset:51200
    s_waitcnt lgkmcnt(3)
    v_mfma_f32_16x16x32_bf16 v[192:195], v[244:247], v[80:83], v[192:195]
    v_mfma_f32_16x16x32_bf16 v[196:199], v[244:247], v[84:87], v[196:199]
    ds_read_b128 v[236:239], v4 offset:52224
    s_waitcnt lgkmcnt(3)
    v_mfma_f32_16x16x32_bf16 v[184:187], v[224:227], v[88:91], v[184:187]
    v_mfma_f32_16x16x32_bf16 v[188:191], v[224:227], v[92:95], v[188:191]
    ds_read_b128 v[240:243], v4 offset:53248
    s_waitcnt lgkmcnt(3)
    v_mfma_f32_16x16x32_bf16 v[192:195], v[228:231], v[88:91], v[192:195]
    v_mfma_f32_16x16x32_bf16 v[196:199], v[228:231], v[92:95], v[196:199]
    s_add_u32 s22, s14, 0xcc000
    s_add_u32 m0, s20, 0x14400
    s_nop 0
    buffer_load_dwordx4 v6, s[76:79], s22 offen lds
    ds_read_b128 v[244:247], v4 offset:54272
    s_waitcnt lgkmcnt(3)
    v_mfma_f32_16x16x32_bf16 v[184:187], v[232:235], v[96:99], v[184:187]
    v_mfma_f32_16x16x32_bf16 v[188:191], v[232:235], v[100:103], v[188:191]
    ds_read_b128 v[224:227], v4 offset:55296
    s_waitcnt lgkmcnt(3)
    v_mfma_f32_16x16x32_bf16 v[192:195], v[236:239], v[96:99], v[192:195]
    v_mfma_f32_16x16x32_bf16 v[196:199], v[236:239], v[100:103], v[196:199]
    ds_read_b128 v[228:231], v4 offset:56320
    s_waitcnt lgkmcnt(3)
    v_mfma_f32_16x16x32_bf16 v[184:187], v[240:243], v[104:107], v[184:187]
    v_mfma_f32_16x16x32_bf16 v[188:191], v[240:243], v[108:111], v[188:191]
    ds_read_b128 v[232:235], v4 offset:57344
    s_waitcnt lgkmcnt(3)
    v_mfma_f32_16x16x32_bf16 v[192:195], v[244:247], v[104:107], v[192:195]
    v_mfma_f32_16x16x32_bf16 v[196:199], v[244:247], v[108:111], v[196:199]
    ds_read_b128 v[236:239], v4 offset:58368
    s_waitcnt lgkmcnt(3)
    v_mfma_f32_16x16x32_bf16 v[184:187], v[224:227], v[112:115], v[184:187]
    v_mfma_f32_16x16x32_bf16 v[188:191], v[224:227], v[116:119], v[188:191]
    ds_read_b128 v[240:243], v4 offset:59392
    s_waitcnt lgkmcnt(3)
    v_mfma_f32_16x16x32_bf16 v[192:195], v[228:231], v[112:115], v[192:195]
    v_mfma_f32_16x16x32_bf16 v[196:199], v[228:231], v[116:119], v[196:199]
    ds_read_b128 v[244:247], v4 offset:60416
    s_waitcnt lgkmcnt(3)
    v_mfma_f32_16x16x32_bf16 v[184:187], v[232:235], v[120:123], v[184:187]
    v_mfma_f32_16x16x32_bf16 v[188:191], v[232:235], v[124:127], v[188:191]
    ds_read_b128 v[224:227], v4 offset:61440
    s_waitcnt lgkmcnt(3)
    v_mfma_f32_16x16x32_bf16 v[192:195], v[236:239], v[120:123], v[192:195]
    v_mfma_f32_16x16x32_bf16 v[196:199], v[236:239], v[124:127], v[196:199]
    ds_read_b128 v[228:231], v4 offset:62464
    s_waitcnt lgkmcnt(3)
    v_mfma_f32_16x16x32_bf16 v[184:187], v[240:243], v[128:131], v[184:187]
    v_mfma_f32_16x16x32_bf16 v[188:191], v[240:243], v[132:135], v[188:191]
    ds_read_b128 v[232:235], v4 offset:63488
    s_waitcnt lgkmcnt(3)
    v_mfma_f32_16x16x32_bf16 v[192:195], v[244:247], v[128:131], v[192:195]
    v_mfma_f32_16x16x32_bf16 v[196:199], v[244:247], v[132:135], v[196:199]
    ds_read_b128 v[236:239], v4 offset:64512
    s_waitcnt lgkmcnt(3)
    v_mfma_f32_16x16x32_bf16 v[184:187], v[224:227], v[136:139], v[184:187]
    v_mfma_f32_16x16x32_bf16 v[188:191], v[224:227], v[140:143], v[188:191]
    s_waitcnt vmcnt(9)
    s_barrier
    ds_read_b128 v[240:243], v5 offset:0
    s_waitcnt lgkmcnt(3)
    v_mfma_f32_16x16x32_bf16 v[192:195], v[228:231], v[136:139], v[192:195]
    v_mfma_f32_16x16x32_bf16 v[196:199], v[228:231], v[140:143], v[196:199]
    s_add_u32 s22, s21, 0x90000
    s_add_u32 m0, s20, 0x18000
    s_nop 0
    buffer_load_dwordx4 v2, s[8:11], s22 offen sc1 lds
    ds_read_b128 v[244:247], v5 offset:1024
    s_waitcnt lgkmcnt(3)
    v_mfma_f32_16x16x32_bf16 v[184:187], v[232:235], v[144:147], v[184:187]
    v_mfma_f32_16x16x32_bf16 v[188:191], v[232:235], v[148:151], v[188:191]
    ds_read_b128 v[224:227], v5 offset:2048
    s_waitcnt lgkmcnt(3)
    v_mfma_f32_16x16x32_bf16 v[192:195], v[236:239], v[144:147], v[192:195]
    v_mfma_f32_16x16x32_bf16 v[196:199], v[236:239], v[148:151], v[196:199]
    ds_read_b128 v[228:231], v5 offset:3072
    s_waitcnt lgkmcnt(3)
    v_mfma_f32_16x16x32_bf16 v[200:203], v[240:243], v[24:27], 0
    v_mfma_f32_16x16x32_bf16 v[204:207], v[240:243], v[28:31], 0
    ds_read_b128 v[232:235], v5 offset:4096
    s_waitcnt lgkmcnt(3)
    v_mfma_f32_16x16x32_bf16 v[208:211], v[244:247], v[24:27], 0
    v_mfma_f32_16x16x32_bf16 v[212:215], v[244:247], v[28:31], 0
    s_add_u32 s22, s21, 0x90400
    s_add_u32 m0, s20, 0x18400
    s_nop 0
    buffer_load_dwordx4 v2, s[8:11], s22 offen sc1 lds
    ds_read_b128 v[236:239], v5 offset:5120
    v_mul_f32 v184, v184, v9
    s_waitcnt lgkmcnt(3)
    v_mfma_f32_16x16x32_bf16 v[200:203], v[224:227], v[32:35], v[200:203]
    v_mul_f32 v185, v185, v9
    v_mfma_f32_16x16x32_bf16 v[204:207], v[224:227], v[36:39], v[204:207]
    ds_read_b128 v[240:243], v5 offset:6144
    v_mul_f32 v186, v186, v9
    s_waitcnt lgkmcnt(3)
    v_mfma_f32_16x16x32_bf16 v[208:211], v[228:231], v[32:35], v[208:211]
    v_mul_f32 v187, v187, v9
    v_mfma_f32_16x16x32_bf16 v[212:215], v[228:231], v[36:39], v[212:215]
    ds_read_b128 v[244:247], v5 offset:7168
    v_mul_f32 v192, v192, v9
    s_waitcnt lgkmcnt(3)
    v_mfma_f32_16x16x32_bf16 v[200:203], v[232:235], v[40:43], v[200:203]
    v_mul_f32 v193, v193, v9
    v_mfma_f32_16x16x32_bf16 v[204:207], v[232:235], v[44:47], v[204:207]
    ds_read_b128 v[224:227], v5 offset:8192
    v_mul_f32 v194, v194, v9
    s_waitcnt lgkmcnt(3)
    v_mfma_f32_16x16x32_bf16 v[208:211], v[236:239], v[40:43], v[208:211]
    v_mul_f32 v195, v195, v9
    v_mfma_f32_16x16x32_bf16 v[212:215], v[236:239], v[44:47], v[212:215]
    ds_read_b128 v[228:231], v5 offset:9216
    v_cvt_pk_bf16_f32 v216, v184, v185
    s_waitcnt lgkmcnt(3)
    v_mfma_f32_16x16x32_bf16 v[200:203], v[240:243], v[48:51], v[200:203]
    v_cvt_pk_bf16_f32 v217, v186, v187
    v_mfma_f32_16x16x32_bf16 v[204:207], v[240:243], v[52:55], v[204:207]
    ds_read_b128 v[232:235], v5 offset:10240
    v_cvt_pk_bf16_f32 v218, v192, v193
    s_waitcnt lgkmcnt(3)
    v_mfma_f32_16x16x32_bf16 v[208:211], v[244:247], v[48:51], v[208:211]
    v_cvt_pk_bf16_f32 v219, v194, v195
    v_mfma_f32_16x16x32_bf16 v[212:215], v[244:247], v[52:55], v[212:215]
    ds_read_b128 v[236:239], v5 offset:11264
    buffer_store_dwordx4 v[216:219], v2, s[8:11], s25 offen offset:0 sc1
    s_waitcnt lgkmcnt(3)
    v_mfma_f32_16x16x32_bf16 v[200:203], v[224:227], v[56:59], v[200:203]
    v_mul_f32 v188, v188, v10
    v_mfma_f32_16x16x32_bf16 v[204:207], v[224:227], v[60:63], v[204:207]
    ds_read_b128 v[240:243], v5 offset:12288
    v_mul_f32 v189, v189, v10
    s_waitcnt lgkmcnt(3)
    v_mfma_f32_16x16x32_bf16 v[208:211], v[228:231], v[56:59], v[208:211]
    v_mul_f32 v190, v190, v10
    v_mfma_f32_16x16x32_bf16 v[212:215], v[228:231], v[60:63], v[212:215]
    ds_read_b128 v[244:247], v5 offset:13312
    v_mul_f32 v191, v191, v10
    s_waitcnt lgkmcnt(3)
    v_mfma_f32_16x16x32_bf16 v[200:203], v[232:235], v[64:67], v[200:203]
    v_mul_f32 v196, v196, v10
    v_mfma_f32_16x16x32_bf16 v[204:207], v[232:235], v[68:71], v[204:207]
    ds_read_b128 v[224:227], v5 offset:14336
    v_mul_f32 v197, v197, v10
    s_waitcnt lgkmcnt(3)
    v_mfma_f32_16x16x32_bf16 v[208:211], v[236:239], v[64:67], v[208:211]
    v_mul_f32 v198, v198, v10
    v_mfma_f32_16x16x32_bf16 v[212:215], v[236:239], v[68:71], v[212:215]
    ds_read_b128 v[228:231], v5 offset:15360
    v_mul_f32 v199, v199, v10
    s_waitcnt lgkmcnt(3)
    v_mfma_f32_16x16x32_bf16 v[200:203], v[240:243], v[72:75], v[200:203]
    v_cvt_pk_bf16_f32 v220, v188, v189
    v_mfma_f32_16x16x32_bf16 v[204:207], v[240:243], v[76:79], v[204:207]
    s_waitcnt vmcnt(8)
    s_barrier
    ds_read_b128 v[232:235], v5 offset:16384
    v_cvt_pk_bf16_f32 v221, v190, v191
    s_waitcnt lgkmcnt(3)
    v_mfma_f32_16x16x32_bf16 v[208:211], v[244:247], v[72:75], v[208:211]
    v_cvt_pk_bf16_f32 v222, v196, v197
    v_mfma_f32_16x16x32_bf16 v[212:215], v[244:247], v[76:79], v[212:215]
    s_add_u32 s22, s21, 0x94000
    s_add_u32 m0, s20, 0x1c000
    s_nop 0
    buffer_load_dwordx4 v2, s[8:11], s22 offen sc1 lds
    ds_read_b128 v[236:239], v5 offset:17408
    v_cvt_pk_bf16_f32 v223, v198, v199
    s_waitcnt lgkmcnt(3)
    v_mfma_f32_16x16x32_bf16 v[200:203], v[224:227], v[80:83], v[200:203]
    buffer_store_dwordx4 v[220:223], v2, s[8:11], s26 offen offset:0 sc1
    v_mfma_f32_16x16x32_bf16 v[204:207], v[224:227], v[84:87], v[204:207]
    ds_read_b128 v[240:243], v5 offset:18432
    s_waitcnt lgkmcnt(3)
    v_mfma_f32_16x16x32_bf16 v[208:211], v[228:231], v[80:83], v[208:211]
    v_mfma_f32_16x16x32_bf16 v[212:215], v[228:231], v[84:87], v[212:215]
    ds_read_b128 v[244:247], v5 offset:19456
    s_waitcnt lgkmcnt(3)
    v_mfma_f32_16x16x32_bf16 v[200:203], v[232:235], v[88:91], v[200:203]
    v_lshrrev_b32 v20, 4, v1
    v_lshlrev_b32 v21, 4, v20
    s_lshl_b32 s16, s2, 8
    s_add_u32 s16, s16, 0x550000
    buffer_load_dwordx4 v[152:155], v21, s[8:11], s16 offen offset:0 sc1
    buffer_load_dwordx4 v[156:159], v21, s[8:11], s16 offen offset:64 sc1
    buffer_load_dwordx4 v[160:163], v21, s[8:11], s16 offen offset:128 sc1
    buffer_load_dwordx4 v[164:167], v21, s[8:11], s16 offen offset:192 sc1
    v_lshlrev_b32 v11, 11, v20
    v_xor_b32 v20, s3, v20
    v_and_b32 v20, 1, v20
    v_lshl_add_u32 v11, v20, 5, v11
    v_bfe_u32 v20, v1, 2, 2
    v_lshl_add_u32 v11, v20, 6, v11
    v_and_b32 v20, 3, v1
    v_lshl_add_u32 v11, v20, 3, v11
    s_lshr_b32 s16, s3, 1
    s_lshl_b32 s16, s16, 8
    s_add_u32 s16, s16, 65536
    v_add_u32 v11, s16, v11
    v_mfma_f32_16x16x32_bf16 v[204:207], v[232:235], v[92:95], v[204:207]
    ds_read_b128 v[224:227], v5 offset:20480
    s_waitcnt lgkmcnt(3)
    v_mfma_f32_16x16x32_bf16 v[208:211], v[236:239], v[88:91], v[208:211]
    v_mfma_f32_16x16x32_bf16 v[212:215], v[236:239], v[92:95], v[212:215]
    s_add_u32 s22, s21, 0x94400
    s_add_u32 m0, s20, 0x1c400
    s_nop 0
    buffer_load_dwordx4 v2, s[8:11], s22 offen sc1 lds
    ds_read_b128 v[228:231], v5 offset:21504
    s_waitcnt lgkmcnt(3)
    v_mfma_f32_16x16x32_bf16 v[200:203], v[240:243], v[96:99], v[200:203]
    v_mfma_f32_16x16x32_bf16 v[204:207], v[240:243], v[100:103], v[204:207]
    ds_read_b128 v[232:235], v5 offset:22528
    s_waitcnt lgkmcnt(3)
    v_mfma_f32_16x16x32_bf16 v[208:211], v[244:247], v[96:99], v[208:211]
    v_mfma_f32_16x16x32_bf16 v[212:215], v[244:247], v[100:103], v[212:215]
    ds_read_b128 v[236:239], v5 offset:23552
    s_waitcnt lgkmcnt(3)
    v_mfma_f32_16x16x32_bf16 v[200:203], v[224:227], v[104:107], v[200:203]
    v_mfma_f32_16x16x32_bf16 v[204:207], v[224:227], v[108:111], v[204:207]
    ds_read_b128 v[240:243], v5 offset:24576
    s_waitcnt lgkmcnt(3)
    v_mfma_f32_16x16x32_bf16 v[208:211], v[228:231], v[104:107], v[208:211]
    v_mfma_f32_16x16x32_bf16 v[212:215], v[228:231], v[108:111], v[212:215]
    ds_read_b128 v[244:247], v5 offset:25600
    s_waitcnt lgkmcnt(3)
    v_mfma_f32_16x16x32_bf16 v[200:203], v[232:235], v[112:115], v[200:203]
    v_mfma_f32_16x16x32_bf16 v[204:207], v[232:235], v[116:119], v[204:207]
    ds_read_b128 v[224:227], v5 offset:26624
    s_waitcnt lgkmcnt(3)
    v_mfma_f32_16x16x32_bf16 v[208:211], v[236:239], v[112:115], v[208:211]
    v_mfma_f32_16x16x32_bf16 v[212:215], v[236:239], v[116:119], v[212:215]
    ds_read_b128 v[228:231], v5 offset:27648
    s_waitcnt lgkmcnt(3)
    v_mfma_f32_16x16x32_bf16 v[200:203], v[240:243], v[120:123], v[200:203]
    v_mfma_f32_16x16x32_bf16 v[204:207], v[240:243], v[124:127], v[204:207]
    ds_read_b128 v[232:235], v5 offset:28672
    s_waitcnt lgkmcnt(3)
    v_mfma_f32_16x16x32_bf16 v[208:211], v[244:247], v[120:123], v[208:211]
    v_mfma_f32_16x16x32_bf16 v[212:215], v[244:247], v[124:127], v[212:215]
    ds_read_b128 v[236:239], v5 offset:29696
    s_waitcnt lgkmcnt(3)
    v_mfma_f32_16x16x32_bf16 v[200:203], v[224:227], v[128:131], v[200:203]
    v_mfma_f32_16x16x32_bf16 v[204:207], v[224:227], v[132:135], v[204:207]
    ds_read_b128 v[240:243], v5 offset:30720
    s_waitcnt lgkmcnt(3)
    v_mfma_f32_16x16x32_bf16 v[208:211], v[228:231], v[128:131], v[208:211]
    v_mfma_f32_16x16x32_bf16 v[212:215], v[228:231], v[132:135], v[212:215]
    ds_read_b128 v[244:247], v5 offset:31744
    s_waitcnt lgkmcnt(3)
    v_mfma_f32_16x16x32_bf16 v[200:203], v[232:235], v[136:139], v[200:203]
    s_waitcnt vmcnt(5)
    s_add_u32 s16, s63, 0x570000
    v_mov_b32 v7, s28
    v_mov_b32 v8, 0
    s_mov_b64 exec, 1
    buffer_store_dword v7, v8, s[8:11], s16 offen sc1
    s_mov_b64 exec, -1
    v_mfma_f32_16x16x32_bf16 v[204:207], v[232:235], v[140:143], v[204:207]
    s_barrier
    ds_read_b128 v[224:227], v4 offset:32768
    s_waitcnt lgkmcnt(3)
    v_mfma_f32_16x16x32_bf16 v[208:211], v[236:239], v[136:139], v[208:211]
    v_mfma_f32_16x16x32_bf16 v[212:215], v[236:239], v[140:143], v[212:215]
    s_add_u32 s22, s21, 0x98000
    s_add_u32 m0, s20, 0x20000
    s_nop 0
    buffer_load_dwordx4 v2, s[8:11], s22 offen sc1 lds
    ds_read_b128 v[228:231], v4 offset:33792
    s_waitcnt lgkmcnt(3)
    v_mfma_f32_16x16x32_bf16 v[200:203], v[240:243], v[144:147], v[200:203]
    ds_read_b64_tr_b16 v[168:169], v11 offset:0
    ds_read_b64_tr_b16 v[170:171], v11 offset:1024
    ds_read_b64_tr_b16 v[172:173], v11 offset:8192
    ds_read_b64_tr_b16 v[174:175], v11 offset:9216
    ds_read_b64_tr_b16 v[176:177], v11 offset:16384
    ds_read_b64_tr_b16 v[178:179], v11 offset:17408
    ds_read_b64_tr_b16 v[180:181], v11 offset:24576
    ds_read_b64_tr_b16 v[182:183], v11 offset:25600
    v_mfma_f32_16x16x32_bf16 v[204:207], v[240:243], v[148:151], v[204:207]
    ds_read_b128 v[232:235], v4 offset:34816
    s_waitcnt lgkmcnt(11)
    v_mfma_f32_16x16x32_bf16 v[208:211], v[244:247], v[144:147], v[208:211]
    v_mfma_f32_16x16x32_bf16 v[212:215], v[244:247], v[148:151], v[212:215]
    ds_read_b128 v[236:239], v4 offset:35840
    s_waitcnt lgkmcnt(11)
    v_mfma_f32_16x16x32_bf16 v[184:187], v[224:227], v[24:27], 0
    v_mfma_f32_16x16x32_bf16 v[188:191], v[224:227], v[28:31], 0
    ds_read_b128 v[240:243], v4 offset:36864
    s_waitcnt lgkmcnt(11)
    v_mfma_f32_16x16x32_bf16 v[192:195], v[228:231], v[24:27], 0
    v_mfma_f32_16x16x32_bf16 v[196:199], v[228:231], v[28:31], 0
    s_add_u32 s22, s21, 0x98400
    s_add_u32 m0, s20, 0x20400
    s_nop 0
    buffer_load_dwordx4 v2, s[8:11], s22 offen sc1 lds
    ds_read_b128 v[244:247], v4 offset:37888
    v_mul_f32 v200, v200, v9
    s_waitcnt lgkmcnt(3)
    v_mfma_f32_16x16x32_bf16 v[184:187], v[232:235], v[32:35], v[184:187]
    v_mul_f32 v201, v201, v9
    v_mfma_f32_16x16x32_bf16 v[188:191], v[232:235], v[36:39], v[188:191]
    ds_read_b128 v[224:227], v4 offset:38912
    v_mul_f32 v202, v202, v9
    s_waitcnt lgkmcnt(3)
    v_mfma_f32_16x16x32_bf16 v[192:195], v[236:239], v[32:35], v[192:195]
    v_mul_f32 v203, v203, v9
    s_waitcnt vmcnt(7)
    v_mfma_f32_16x16x32_bf16 v[248:251], v[168:171], v[152:155], 0
    s_waitcnt vmcnt(6)
    v_mfma_f32_16x16x32_bf16 v[248:251], v[172:175], v[156:159], v[248:251]
    s_waitcnt vmcnt(5)
    v_mfma_f32_16x16x32_bf16 v[248:251], v[176:179], v[160:163], v[248:251]
    s_waitcnt vmcnt(4)
    v_mfma_f32_16x16x32_bf16 v[248:251], v[180:183], v[164:167], v[248:251]
    v_mfma_f32_16x16x32_bf16 v[196:199], v[236:239], v[36:39], v[196:199]
    ds_read_b128 v[228:231], v4 offset:39936
    v_mul_f32 v208, v208, v9
    s_waitcnt lgkmcnt(3)
    v_mfma_f32_16x16x32_bf16 v[184:187], v[240:243], v[40:43], v[184:187]
    v_mul_f32 v209, v209, v9
    v_mfma_f32_16x16x32_bf16 v[188:191], v[240:243], v[44:47], v[188:191]
    ds_read_b128 v[232:235], v4 offset:40960
    v_mul_f32 v210, v210, v9
    s_waitcnt lgkmcnt(3)
    v_mfma_f32_16x16x32_bf16 v[192:195], v[244:247], v[40:43], v[192:195]
    v_mul_f32 v211, v211, v9
    v_mfma_f32_16x16x32_bf16 v[196:199], v[244:247], v[44:47], v[196:199]
    ds_read_b128 v[236:239], v4 offset:41984
    v_cvt_pk_bf16_f32 v216, v200, v201
    s_waitcnt lgkmcnt(3)
    v_mfma_f32_16x16x32_bf16 v[184:187], v[224:227], v[48:51], v[184:187]
    v_cvt_pk_bf16_f32 v217, v202, v203
    v_mfma_f32_16x16x32_bf16 v[188:191], v[224:227], v[52:55], v[188:191]
    ds_read_b128 v[240:243], v4 offset:43008
    v_cvt_pk_bf16_f32 v218, v208, v209
    s_waitcnt lgkmcnt(3)
    v_mfma_f32_16x16x32_bf16 v[192:195], v[228:231], v[48:51], v[192:195]
    v_cvt_pk_bf16_f32 v219, v210, v211
    v_mfma_f32_16x16x32_bf16 v[196:199], v[228:231], v[52:55], v[196:199]
    ds_read_b128 v[244:247], v4 offset:44032
    buffer_store_dwordx4 v[216:219], v2, s[8:11], s25 offen offset:1024 sc1
    s_waitcnt lgkmcnt(3)
    v_mfma_f32_16x16x32_bf16 v[184:187], v[232:235], v[56:59], v[184:187]
    v_mul_f32 v204, v204, v10
    v_mfma_f32_16x16x32_bf16 v[188:191], v[232:235], v[60:63], v[188:191]
    ds_read_b128 v[224:227], v4 offset:45056
    v_mul_f32 v205, v205, v10
    s_waitcnt lgkmcnt(3)
    v_mfma_f32_16x16x32_bf16 v[192:195], v[236:239], v[56:59], v[192:195]
    v_mul_f32 v206, v206, v10
    v_lshrrev_b32 v20, 4, v1
    v_lshlrev_b32 v20, 4, v20
    s_lshr_b32 s16, s2, 5
    s_lshl_b32 s16, s16, 14
    s_and_b32 s17, s2, 31
    s_lshl_b32 s17, s17, 9
    s_add_u32 s16, s16, s17
    s_lshl_b32 s17, s3, 6
    s_add_u32 s16, s16, s17
    s_add_u32 s16, s16, 0x580000
    s_mov_b32 exec_lo, 0x10001
    s_mov_b32 exec_hi, 0x10001
    buffer_store_dwordx4 v[248:251], v20, s[8:11], s16 offen sc1
    s_mov_b64 exec, -1
    v_mfma_f32_16x16x32_bf16 v[196:199], v[236:239], v[60:63], v[196:199]
    ds_read_b128 v[228:231], v4 offset:46080
    v_mul_f32 v207, v207, v10
    s_waitcnt lgkmcnt(3)
    v_mfma_f32_16x16x32_bf16 v[184:187], v[240:243], v[64:67], v[184:187]
    v_mul_f32 v212, v212, v10
    v_mfma_f32_16x16x32_bf16 v[188:191], v[240:243], v[68:71], v[188:191]
    ds_read_b128 v[232:235], v4 offset:47104
    v_mul_f32 v213, v213, v10
    s_waitcnt lgkmcnt(3)
    v_mfma_f32_16x16x32_bf16 v[192:195], v[244:247], v[64:67], v[192:195]
    v_mul_f32 v214, v214, v10
    v_mfma_f32_16x16x32_bf16 v[196:199], v[244:247], v[68:71], v[196:199]
    ds_read_b128 v[236:239], v4 offset:48128
    v_mul_f32 v215, v215, v10
    s_waitcnt lgkmcnt(3)
    v_mfma_f32_16x16x32_bf16 v[184:187], v[224:227], v[72:75], v[184:187]
    v_cvt_pk_bf16_f32 v220, v204, v205
    v_mfma_f32_16x16x32_bf16 v[188:191], v[224:227], v[76:79], v[188:191]
    s_waitcnt vmcnt(5)
    s_barrier
    ds_read_b128 v[240:243], v4 offset:49152
    v_cvt_pk_bf16_f32 v221, v206, v207
    s_waitcnt lgkmcnt(3)
    v_mfma_f32_16x16x32_bf16 v[192:195], v[228:231], v[72:75], v[192:195]
    v_cvt_pk_bf16_f32 v222, v212, v213
    v_mfma_f32_16x16x32_bf16 v[196:199], v[228:231], v[76:79], v[196:199]
    s_add_u32 s22, s21, 0x9c000
    s_add_u32 m0, s20, 0x24000
    s_nop 0
    buffer_load_dwordx4 v2, s[8:11], s22 offen sc1 lds
    ds_read_b128 v[244:247], v4 offset:50176
    v_cvt_pk_bf16_f32 v223, v214, v215
    s_waitcnt lgkmcnt(3)
    v_mfma_f32_16x16x32_bf16 v[184:187], v[232:235], v[80:83], v[184:187]
    buffer_store_dwordx4 v[220:223], v2, s[8:11], s26 offen offset:1024 sc1
    v_mfma_f32_16x16x32_bf16 v[188:191], v[232:235], v[84:87], v[188:191]
    ds_read_b128 v[224:227], v4 offset:51200
    s_waitcnt lgkmcnt(3)
    v_mfma_f32_16x16x32_bf16 v[192:195], v[236:239], v[80:83], v[192:195]
    v_mfma_f32_16x16x32_bf16 v[196:199], v[236:239], v[84:87], v[196:199]
    s_add_u32 s22, s21, 0x9c400
    s_add_u32 m0, s20, 0x24400
    s_nop 0
    buffer_load_dwordx4 v2, s[8:11], s22 offen sc1 lds
    ds_read_b128 v[228:231], v4 offset:52224
    s_waitcnt lgkmcnt(3)
    v_mfma_f32_16x16x32_bf16 v[184:187], v[240:243], v[88:91], v[184:187]
    v_mfma_f32_16x16x32_bf16 v[188:191], v[240:243], v[92:95], v[188:191]
    ds_read_b128 v[232:235], v4 offset:53248
    s_waitcnt lgkmcnt(3)
    v_mfma_f32_16x16x32_bf16 v[192:195], v[244:247], v[88:91], v[192:195]
    v_mfma_f32_16x16x32_bf16 v[196:199], v[244:247], v[92:95], v[196:199]
    s_add_u32 s22, s24, 0x0
    s_add_u32 m0, s20, 0x10000
    s_nop 0
    buffer_load_dwordx4 v3, s[4:7], s22 offen lds
    ds_read_b128 v[236:239], v4 offset:54272
    s_waitcnt lgkmcnt(3)
    v_mfma_f32_16x16x32_bf16 v[184:187], v[224:227], v[96:99], v[184:187]
    v_mfma_f32_16x16x32_bf16 v[188:191], v[224:227], v[100:103], v[188:191]
    ds_read_b128 v[240:243], v4 offset:55296
    s_waitcnt lgkmcnt(3)
    v_mfma_f32_16x16x32_bf16 v[192:195], v[228:231], v[96:99], v[192:195]
    v_mfma_f32_16x16x32_bf16 v[196:199], v[228:231], v[100:103], v[196:199]
    s_add_u32 s22, s24, 0x2000
    s_add_u32 m0, s20, 0x10400
    s_nop 0
    buffer_load_dwordx4 v3, s[4:7], s22 offen lds
    ds_read_b128 v[244:247], v4 offset:56320
    s_waitcnt lgkmcnt(3)
    v_mfma_f32_16x16x32_bf16 v[184:187], v[232:235], v[104:107], v[184:187]
    v_mfma_f32_16x16x32_bf16 v[188:191], v[232:235], v[108:111], v[188:191]
    ds_read_b128 v[224:227], v4 offset:57344
    s_waitcnt lgkmcnt(3)
    v_mfma_f32_16x16x32_bf16 v[192:195], v[236:239], v[104:107], v[192:195]
    v_mfma_f32_16x16x32_bf16 v[196:199], v[236:239], v[108:111], v[196:199]
    ds_read_b128 v[228:231], v4 offset:58368
    s_waitcnt lgkmcnt(3)
    v_mfma_f32_16x16x32_bf16 v[184:187], v[240:243], v[112:115], v[184:187]
    v_mfma_f32_16x16x32_bf16 v[188:191], v[240:243], v[116:119], v[188:191]
    ds_read_b128 v[232:235], v4 offset:59392
    s_waitcnt lgkmcnt(3)
    v_mfma_f32_16x16x32_bf16 v[192:195], v[244:247], v[112:115], v[192:195]
    v_mfma_f32_16x16x32_bf16 v[196:199], v[244:247], v[116:119], v[196:199]
    ds_read_b128 v[236:239], v4 offset:60416
    s_waitcnt lgkmcnt(3)
    v_mfma_f32_16x16x32_bf16 v[184:187], v[224:227], v[120:123], v[184:187]
    v_mfma_f32_16x16x32_bf16 v[188:191], v[224:227], v[124:127], v[188:191]
    ds_read_b128 v[240:243], v4 offset:61440
    s_waitcnt lgkmcnt(3)
    v_mfma_f32_16x16x32_bf16 v[192:195], v[228:231], v[120:123], v[192:195]
    v_mfma_f32_16x16x32_bf16 v[196:199], v[228:231], v[124:127], v[196:199]
    ds_read_b128 v[244:247], v4 offset:62464
    s_waitcnt lgkmcnt(3)
    v_mfma_f32_16x16x32_bf16 v[184:187], v[232:235], v[128:131], v[184:187]
    v_mfma_f32_16x16x32_bf16 v[188:191], v[232:235], v[132:135], v[188:191]
    ds_read_b128 v[224:227], v4 offset:63488
    s_waitcnt lgkmcnt(3)
    v_mfma_f32_16x16x32_bf16 v[192:195], v[236:239], v[128:131], v[192:195]
    v_mfma_f32_16x16x32_bf16 v[196:199], v[236:239], v[132:135], v[196:199]
    ds_read_b128 v[228:231], v4 offset:64512
    s_waitcnt lgkmcnt(3)
    v_mfma_f32_16x16x32_bf16 v[184:187], v[240:243], v[136:139], v[184:187]
    v_mfma_f32_16x16x32_bf16 v[188:191], v[240:243], v[140:143], v[188:191]
    s_waitcnt vmcnt(7)
    s_barrier
    ds_read_b128 v[232:235], v5 offset:0
    s_waitcnt lgkmcnt(3)
    v_mfma_f32_16x16x32_bf16 v[192:195], v[244:247], v[136:139], v[192:195]
    v_mfma_f32_16x16x32_bf16 v[196:199], v[244:247], v[140:143], v[196:199]
    s_add_u32 s22, s24, 0x80000
    s_add_u32 m0, s20, 0x14000
    s_nop 0
    buffer_load_dwordx4 v3, s[4:7], s22 offen lds
    ds_read_b128 v[236:239], v5 offset:1024
    s_waitcnt lgkmcnt(3)
    v_mfma_f32_16x16x32_bf16 v[184:187], v[224:227], v[144:147], v[184:187]
    v_mfma_f32_16x16x32_bf16 v[188:191], v[224:227], v[148:151], v[188:191]
    ds_read_b128 v[240:243], v5 offset:2048
    s_waitcnt lgkmcnt(3)
    v_mfma_f32_16x16x32_bf16 v[192:195], v[228:231], v[144:147], v[192:195]
    v_mfma_f32_16x16x32_bf16 v[196:199], v[228:231], v[148:151], v[196:199]
    s_add_u32 s22, s24, 0x82000
    s_add_u32 m0, s20, 0x14400
    s_nop 0
    buffer_load_dwordx4 v3, s[4:7], s22 offen lds
    ds_read_b128 v[244:247], v5 offset:3072
    s_waitcnt lgkmcnt(3)
    v_mfma_f32_16x16x32_bf16 v[200:203], v[232:235], v[24:27], 0
    v_mfma_f32_16x16x32_bf16 v[204:207], v[232:235], v[28:31], 0
    ds_read_b128 v[224:227], v5 offset:4096
    s_waitcnt lgkmcnt(3)
    v_mfma_f32_16x16x32_bf16 v[208:211], v[236:239], v[24:27], 0
    v_mfma_f32_16x16x32_bf16 v[212:215], v[236:239], v[28:31], 0
    s_add_u32 s22, s24, 0x100000
    s_add_u32 m0, s20, 0x18000
    s_nop 0
    buffer_load_dwordx4 v3, s[4:7], s22 offen lds
    ds_read_b128 v[228:231], v5 offset:5120
    v_mul_f32 v184, v184, v9
    s_waitcnt lgkmcnt(3)
    v_mfma_f32_16x16x32_bf16 v[200:203], v[240:243], v[32:35], v[200:203]
    v_mul_f32 v185, v185, v9
    s_bfe_u32 s30, s2, 0x20001
    s_lshl_b32 s30, s30, 2
    s_bfe_u32 s17, s2, 0x20003
    s_add_u32 s30, s30, s17
    s_lshr_b32 s31, s2, 5
    s_and_b32 s17, s3, 3
    s_lshl_b32 s19, s30, 2
    s_add_u32 s19, s19, s17
    s_and_b32 s16, s2, 1
    s_lshl_b32 s17, s19, 18
    s_lshl_b32 s23, s16, 16
    s_add_u32 s17, s17, s23
    s_add_u32 s17, s17, 0x1001000
    v_add_u32 v6, s17, v2
    s_lshl_b32 s19, s19, 7
    s_lshl_b32 s23, s16, 6
    s_add_u32 s19, s19, s23
    s_add_u32 s19, s19, 0x570000
    v_and_b32 v13, 15, v1
    v_lshlrev_b32 v13, 2, v13
    buffer_load_dword v12, v13, s[8:11], s19 offen sc1
    v_mfma_f32_16x16x32_bf16 v[204:207], v[240:243], v[36:39], v[204:207]
    ds_read_b128 v[232:235], v5 offset:6144
    v_mul_f32 v186, v186, v9
    s_waitcnt lgkmcnt(3)
    v_mfma_f32_16x16x32_bf16 v[208:211], v[244:247], v[32:35], v[208:211]
    v_mul_f32 v187, v187, v9
    v_mfma_f32_16x16x32_bf16 v[212:215], v[244:247], v[36:39], v[212:215]
    s_add_u32 s22, s24, 0x102000
    s_add_u32 m0, s20, 0x18400
    s_nop 0
    buffer_load_dwordx4 v3, s[4:7], s22 offen lds
    ds_read_b128 v[236:239], v5 offset:7168
    v_mul_f32 v192, v192, v9
    s_waitcnt lgkmcnt(3)
    v_mfma_f32_16x16x32_bf16 v[200:203], v[224:227], v[40:43], v[200:203]
    v_mul_f32 v193, v193, v9
    v_mfma_f32_16x16x32_bf16 v[204:207], v[224:227], v[44:47], v[204:207]
    ds_read_b128 v[240:243], v5 offset:8192
    v_mul_f32 v194, v194, v9
    s_waitcnt lgkmcnt(3)
    v_mfma_f32_16x16x32_bf16 v[208:211], v[228:231], v[40:43], v[208:211]
    v_mul_f32 v195, v195, v9
    v_mfma_f32_16x16x32_bf16 v[212:215], v[228:231], v[44:47], v[212:215]
    ds_read_b128 v[244:247], v5 offset:9216
    v_cvt_pk_bf16_f32 v216, v184, v185
    s_waitcnt lgkmcnt(3)
    v_mfma_f32_16x16x32_bf16 v[200:203], v[232:235], v[48:51], v[200:203]
    v_cvt_pk_bf16_f32 v217, v186, v187
    v_mfma_f32_16x16x32_bf16 v[204:207], v[232:235], v[52:55], v[204:207]
    ds_read_b128 v[224:227], v5 offset:10240
    v_cvt_pk_bf16_f32 v218, v192, v193
    s_waitcnt lgkmcnt(3)
    v_mfma_f32_16x16x32_bf16 v[208:211], v[236:239], v[48:51], v[208:211]
    v_cvt_pk_bf16_f32 v219, v194, v195
    v_mfma_f32_16x16x32_bf16 v[212:215], v[236:239], v[52:55], v[212:215]
    ds_read_b128 v[228:231], v5 offset:11264
    buffer_store_dwordx4 v[216:219], v2, s[8:11], s25 offen offset:2048 sc1
    s_waitcnt lgkmcnt(3)
    v_mfma_f32_16x16x32_bf16 v[200:203], v[240:243], v[56:59], v[200:203]
    v_mul_f32 v188, v188, v10
    v_mfma_f32_16x16x32_bf16 v[204:207], v[240:243], v[60:63], v[204:207]
    ds_read_b128 v[232:235], v5 offset:12288
    v_mul_f32 v189, v189, v10
    s_waitcnt lgkmcnt(3)
    v_mfma_f32_16x16x32_bf16 v[208:211], v[244:247], v[56:59], v[208:211]
    v_mul_f32 v190, v190, v10
    v_mfma_f32_16x16x32_bf16 v[212:215], v[244:247], v[60:63], v[212:215]
    ds_read_b128 v[236:239], v5 offset:13312
    v_mul_f32 v191, v191, v10
    s_waitcnt lgkmcnt(3)
    v_mfma_f32_16x16x32_bf16 v[200:203], v[224:227], v[64:67], v[200:203]
    v_mul_f32 v196, v196, v10
    s_waitcnt vmcnt(11)
    v_mfma_f32_16x16x32_bf16 v[204:207], v[224:227], v[68:71], v[204:207]
    ds_read_b128 v[240:243], v5 offset:14336
    v_mul_f32 v197, v197, v10
    s_waitcnt lgkmcnt(3)
    v_mfma_f32_16x16x32_bf16 v[208:211], v[228:231], v[64:67], v[208:211]
    v_mul_f32 v198, v198, v10
    v_mfma_f32_16x16x32_bf16 v[212:215], v[228:231], v[68:71], v[212:215]
    ds_read_b128 v[244:247], v5 offset:15360
    v_mul_f32 v199, v199, v10
    s_waitcnt lgkmcnt(3)
    v_mfma_f32_16x16x32_bf16 v[200:203], v[232:235], v[72:75], v[200:203]
    v_cvt_pk_bf16_f32 v220, v188, v189
    v_mfma_f32_16x16x32_bf16 v[204:207], v[232:235], v[76:79], v[204:207]
    s_waitcnt vmcnt(8)
    s_barrier
    ds_read_b128 v[224:227], v5 offset:16384
    v_cvt_pk_bf16_f32 v221, v190, v191
    s_waitcnt lgkmcnt(3)
    v_mfma_f32_16x16x32_bf16 v[208:211], v[236:239], v[72:75], v[208:211]
    v_cvt_pk_bf16_f32 v222, v196, v197
    v_mfma_f32_16x16x32_bf16 v[212:215], v[236:239], v[76:79], v[212:215]
    s_add_u32 s22, s24, 0x180000
    s_add_u32 m0, s20, 0x1c000
    s_nop 0
    buffer_load_dwordx4 v3, s[4:7], s22 offen lds
    ds_read_b128 v[228:231], v5 offset:17408
    v_cvt_pk_bf16_f32 v223, v198, v199
    s_waitcnt lgkmcnt(3)
    v_mfma_f32_16x16x32_bf16 v[200:203], v[240:243], v[80:83], v[200:203]
    buffer_store_dwordx4 v[220:223], v2, s[8:11], s26 offen offset:2048 sc1
    s_add_u32 s16, s63, 0x572000
    v_mov_b32 v14, s28
    v_mov_b32 v15, 0
    s_mov_b64 exec, 1
    buffer_store_dword v14, v15, s[8:11], s16 offen sc1
    s_mov_b64 exec, -1
    v_mfma_f32_16x16x32_bf16 v[204:207], v[240:243], v[84:87], v[204:207]
    ds_read_b128 v[232:235], v5 offset:18432
    s_waitcnt lgkmcnt(3)
    v_mfma_f32_16x16x32_bf16 v[208:211], v[244:247], v[80:83], v[208:211]
    v_mfma_f32_16x16x32_bf16 v[212:215], v[244:247], v[84:87], v[212:215]
    ds_read_b128 v[236:239], v5 offset:19456
    s_waitcnt lgkmcnt(3)
    v_mfma_f32_16x16x32_bf16 v[200:203], v[224:227], v[88:91], v[200:203]
    v_mfma_f32_16x16x32_bf16 v[204:207], v[224:227], v[92:95], v[204:207]
    ds_read_b128 v[240:243], v5 offset:20480
    s_waitcnt vmcnt(5)
    v_cmp_ne_u32 vcc, s28, v12
    s_cbranch_vccnz adaLN_cond__sliding_block_cached__moe_arch_mod__prompt_kernel_o17r
adaLN_cond__sliding_block_cached__moe_arch_mod__prompt_kernel_o17b:
    s_waitcnt lgkmcnt(3)
    v_mfma_f32_16x16x32_bf16 v[208:211], v[228:231], v[88:91], v[208:211]
    s_mov_b32 s23, 0x0
    buffer_load_dwordx4 v[24:27], v6, s[8:11], s23 offen offset:0 sc1
    v_mfma_f32_16x16x32_bf16 v[212:215], v[228:231], v[92:95], v[212:215]
    s_add_u32 s22, s24, 0x182000
    s_add_u32 m0, s20, 0x1c400
    s_nop 0
    buffer_load_dwordx4 v3, s[4:7], s22 offen lds
    ds_read_b128 v[244:247], v5 offset:21504
    s_waitcnt lgkmcnt(3)
    v_mfma_f32_16x16x32_bf16 v[200:203], v[232:235], v[96:99], v[200:203]
    v_mfma_f32_16x16x32_bf16 v[204:207], v[232:235], v[100:103], v[204:207]
    ds_read_b128 v[224:227], v5 offset:22528
    s_mov_b32 s23, 0x20000
    buffer_load_dwordx4 v[28:31], v6, s[8:11], s23 offen offset:0 sc1
    s_waitcnt lgkmcnt(3)
    v_mfma_f32_16x16x32_bf16 v[208:211], v[236:239], v[96:99], v[208:211]
    v_mfma_f32_16x16x32_bf16 v[212:215], v[236:239], v[100:103], v[212:215]
    ds_read_b128 v[228:231], v5 offset:23552
    s_waitcnt lgkmcnt(3)
    v_mfma_f32_16x16x32_bf16 v[200:203], v[240:243], v[104:107], v[200:203]
    v_mfma_f32_16x16x32_bf16 v[204:207], v[240:243], v[108:111], v[204:207]
    ds_read_b128 v[232:235], v5 offset:24576
    s_mov_b32 s23, 0x2000
    buffer_load_dwordx4 v[32:35], v6, s[8:11], s23 offen offset:0 sc1
    s_waitcnt lgkmcnt(3)
    v_mfma_f32_16x16x32_bf16 v[208:211], v[244:247], v[104:107], v[208:211]
    v_mfma_f32_16x16x32_bf16 v[212:215], v[244:247], v[108:111], v[212:215]
    ds_read_b128 v[236:239], v5 offset:25600
    s_waitcnt lgkmcnt(3)
    v_mfma_f32_16x16x32_bf16 v[200:203], v[224:227], v[112:115], v[200:203]
    s_mov_b32 s23, 0x22000
    buffer_load_dwordx4 v[36:39], v6, s[8:11], s23 offen offset:0 sc1
    v_mfma_f32_16x16x32_bf16 v[204:207], v[224:227], v[116:119], v[204:207]
    ds_read_b128 v[240:243], v5 offset:26624
    s_waitcnt lgkmcnt(3)
    v_mfma_f32_16x16x32_bf16 v[208:211], v[228:231], v[112:115], v[208:211]
    v_mfma_f32_16x16x32_bf16 v[212:215], v[228:231], v[116:119], v[212:215]
    ds_read_b128 v[244:247], v5 offset:27648
    s_waitcnt lgkmcnt(3)
    v_mfma_f32_16x16x32_bf16 v[200:203], v[232:235], v[120:123], v[200:203]
    s_mov_b32 s23, 0x4000
    buffer_load_dwordx4 v[40:43], v6, s[8:11], s23 offen offset:0 sc1
    v_mfma_f32_16x16x32_bf16 v[204:207], v[232:235], v[124:127], v[204:207]
    ds_read_b128 v[224:227], v5 offset:28672
    s_waitcnt lgkmcnt(3)
    v_mfma_f32_16x16x32_bf16 v[208:211], v[236:239], v[120:123], v[208:211]
    v_mfma_f32_16x16x32_bf16 v[212:215], v[236:239], v[124:127], v[212:215]
    ds_read_b128 v[228:231], v5 offset:29696
    s_waitcnt lgkmcnt(3)
    v_mfma_f32_16x16x32_bf16 v[200:203], v[240:243], v[128:131], v[200:203]
    s_mov_b32 s23, 0x24000
    buffer_load_dwordx4 v[44:47], v6, s[8:11], s23 offen offset:0 sc1
    v_mfma_f32_16x16x32_bf16 v[204:207], v[240:243], v[132:135], v[204:207]
    ds_read_b128 v[232:235], v5 offset:30720
    s_waitcnt lgkmcnt(3)
    v_mfma_f32_16x16x32_bf16 v[208:211], v[244:247], v[128:131], v[208:211]
    v_mfma_f32_16x16x32_bf16 v[212:215], v[244:247], v[132:135], v[212:215]
    ds_read_b128 v[236:239], v5 offset:31744
    s_mov_b32 s23, 0x6000
    buffer_load_dwordx4 v[48:51], v6, s[8:11], s23 offen offset:0 sc1
    s_waitcnt lgkmcnt(3)
    v_mfma_f32_16x16x32_bf16 v[200:203], v[224:227], v[136:139], v[200:203]
    v_bfe_u32 v18, v1, 2, 2
    v_lshrrev_b32 v19, 4, v1
    v_mfma_f32_16x16x32_bf16 v[204:207], v[224:227], v[140:143], v[204:207]
    v_and_b32 v17, 3, v1
    v_lshlrev_b32 v16, 11, v19
    s_waitcnt lgkmcnt(2)
    v_mfma_f32_16x16x32_bf16 v[208:211], v[228:231], v[136:139], v[208:211]
    v_lshl_add_u32 v16, v18, 6, v16
    v_lshl_add_u32 v16, v17, 3, v16
    v_mfma_f32_16x16x32_bf16 v[212:215], v[228:231], v[140:143], v[212:215]
    s_mov_b32 s23, 0x26000
    buffer_load_dwordx4 v[52:55], v6, s[8:11], s23 offen offset:0 sc1
    v_add_u32 v16, 0x12000, v16
    v_and_b32 v19, 1, v19
    s_waitcnt lgkmcnt(1)
    v_mfma_f32_16x16x32_bf16 v[200:203], v[232:235], v[144:147], v[200:203]
    v_lshlrev_b32 v19, 5, v19
    v_sub_u32 v5, v16, v19
    v_mfma_f32_16x16x32_bf16 v[204:207], v[232:235], v[148:151], v[204:207]
    v_add_u32 v4, v16, v19
    v_add_u32 v7, 0x10000, v4
    s_waitcnt lgkmcnt(0)
    v_mfma_f32_16x16x32_bf16 v[208:211], v[236:239], v[144:147], v[208:211]
    v_add_u32 v8, 0x10000, v5
    v_mfma_f32_16x16x32_bf16 v[212:215], v[236:239], v[148:151], v[212:215]
    v_mul_f32 v200, v200, v9
    v_mul_f32 v201, v201, v9
    v_mul_f32 v202, v202, v9
    v_mul_f32 v203, v203, v9
    s_nop 1
    v_mul_f32 v208, v208, v9
    v_mul_f32 v209, v209, v9
    v_mul_f32 v210, v210, v9
    v_mul_f32 v211, v211, v9
    v_cvt_pk_bf16_f32 v216, v200, v201
    v_cvt_pk_bf16_f32 v217, v202, v203
    v_cvt_pk_bf16_f32 v218, v208, v209
    v_cvt_pk_bf16_f32 v219, v210, v211
    buffer_store_dwordx4 v[216:219], v2, s[8:11], s25 offen offset:3072 sc1
    v_mul_f32 v204, v204, v10
    v_mul_f32 v205, v205, v10
    v_mul_f32 v206, v206, v10
    v_mul_f32 v207, v207, v10
    v_mul_f32 v212, v212, v10
    v_mul_f32 v213, v213, v10
    v_mul_f32 v214, v214, v10
    v_mul_f32 v215, v215, v10
    v_cvt_pk_bf16_f32 v220, v204, v205
    v_cvt_pk_bf16_f32 v221, v206, v207
    v_cvt_pk_bf16_f32 v222, v212, v213
    v_cvt_pk_bf16_f32 v223, v214, v215
    buffer_store_dwordx4 v[220:223], v2, s[8:11], s26 offen offset:3072 sc1
    s_and_b32 s15, s2, 1
    s_barrier
    ds_read_b64_tr_b16 v[224:225], v4 offset:0
    ds_read_b64_tr_b16 v[226:227], v4 offset:1024
    ds_read_b64_tr_b16 v[228:229], v5 offset:32
    ds_read_b64_tr_b16 v[230:231], v5 offset:1056
    ds_read_b64_tr_b16 v[232:233], v4 offset:256
    ds_read_b64_tr_b16 v[234:235], v4 offset:1280
    ds_read_b64_tr_b16 v[236:237], v5 offset:288
    ds_read_b64_tr_b16 v[238:239], v5 offset:1312
    s_waitcnt vmcnt(10) lgkmcnt(6)
    v_mfma_f32_16x16x32_bf16 v[88:91], v[224:227], v[24:27], 0
    ds_read_b64_tr_b16 v[240:241], v4 offset:512
    s_waitcnt vmcnt(8)
    v_mfma_f32_16x16x32_bf16 v[92:95], v[224:227], v[28:31], 0
    ds_read_b64_tr_b16 v[242:243], v4 offset:1536
    s_waitcnt lgkmcnt(6)
    v_mfma_f32_16x16x32_bf16 v[96:99], v[228:231], v[24:27], 0
    ds_read_b64_tr_b16 v[244:245], v5 offset:544
    v_mfma_f32_16x16x32_bf16 v[100:103], v[228:231], v[28:31], 0
    ds_read_b64_tr_b16 v[246:247], v5 offset:1568
    s_waitcnt lgkmcnt(6)
    v_mfma_f32_16x16x32_bf16 v[104:107], v[232:235], v[24:27], 0
    ds_read_b64_tr_b16 v[224:225], v4 offset:768
    v_mfma_f32_16x16x32_bf16 v[108:111], v[232:235], v[28:31], 0
    ds_read_b64_tr_b16 v[226:227], v4 offset:1792
    s_waitcnt lgkmcnt(6)
    v_mfma_f32_16x16x32_bf16 v[112:115], v[236:239], v[24:27], 0
    ds_read_b64_tr_b16 v[228:229], v5 offset:800
    v_mfma_f32_16x16x32_bf16 v[116:119], v[236:239], v[28:31], 0
    ds_read_b64_tr_b16 v[230:231], v5 offset:1824
    s_waitcnt lgkmcnt(6)
    v_mfma_f32_16x16x32_bf16 v[120:123], v[240:243], v[24:27], 0
    s_add_u32 s22, s24, 0x200000
    s_add_u32 m0, s20, 0x20000
    s_nop 0
    buffer_load_dwordx4 v3, s[4:7], s22 offen lds
    v_mfma_f32_16x16x32_bf16 v[124:127], v[240:243], v[28:31], 0
    s_barrier
    ds_read_b64_tr_b16 v[232:233], v4 offset:16384
    ds_read_b64_tr_b16 v[234:235], v4 offset:17408
    s_waitcnt lgkmcnt(6)
    v_mfma_f32_16x16x32_bf16 v[128:131], v[244:247], v[24:27], 0
    ds_read_b64_tr_b16 v[236:237], v5 offset:16416
    s_mov_b32 s23, 0x8000
    buffer_load_dwordx4 v[56:59], v6, s[8:11], s23 offen offset:0 sc1
    v_mfma_f32_16x16x32_bf16 v[132:135], v[244:247], v[28:31], 0
    s_add_u32 s22, s24, 0x202000
    s_add_u32 m0, s20, 0x20400
    s_nop 0
    buffer_load_dwordx4 v3, s[4:7], s22 offen lds
    ds_read_b64_tr_b16 v[238:239], v5 offset:17440
    s_waitcnt lgkmcnt(6)
    v_mfma_f32_16x16x32_bf16 v[136:139], v[224:227], v[24:27], 0
    ds_read_b64_tr_b16 v[240:241], v4 offset:16640
    v_mfma_f32_16x16x32_bf16 v[140:143], v[224:227], v[28:31], 0
    ds_read_b64_tr_b16 v[242:243], v4 offset:17664
    s_mov_b32 s23, 0x28000
    buffer_load_dwordx4 v[60:63], v6, s[8:11], s23 offen offset:0 sc1
    s_waitcnt lgkmcnt(6)
    v_mfma_f32_16x16x32_bf16 v[144:147], v[228:231], v[24:27], 0
    ds_read_b64_tr_b16 v[244:245], v5 offset:16672
    v_mfma_f32_16x16x32_bf16 v[148:151], v[228:231], v[28:31], 0
    ds_read_b64_tr_b16 v[246:247], v5 offset:17696
    s_waitcnt vmcnt(11) lgkmcnt(6)
    v_mfma_f32_16x16x32_bf16 v[88:91], v[232:235], v[32:35], v[88:91]
    ds_read_b64_tr_b16 v[224:225], v4 offset:16896
    s_waitcnt vmcnt(10)
    v_mfma_f32_16x16x32_bf16 v[92:95], v[232:235], v[36:39], v[92:95]
    s_add_u32 s22, s24, 0x280000
    s_add_u32 m0, s20, 0x24000
    s_nop 0
    buffer_load_dwordx4 v3, s[4:7], s22 offen lds
    ds_read_b64_tr_b16 v[226:227], v4 offset:17920
    s_waitcnt lgkmcnt(6)
    v_mfma_f32_16x16x32_bf16 v[96:99], v[236:239], v[32:35], v[96:99]
    ds_read_b64_tr_b16 v[228:229], v5 offset:16928
    v_mfma_f32_16x16x32_bf16 v[100:103], v[236:239], v[36:39], v[100:103]
    ds_read_b64_tr_b16 v[230:231], v5 offset:17952
    s_waitcnt lgkmcnt(6)
    v_mfma_f32_16x16x32_bf16 v[104:107], v[240:243], v[32:35], v[104:107]
    s_add_u32 s22, s24, 0x282000
    s_add_u32 m0, s20, 0x24400
    s_nop 0
    buffer_load_dwordx4 v3, s[4:7], s22 offen lds
    ds_read_b64_tr_b16 v[232:233], v4 offset:17152
    v_mfma_f32_16x16x32_bf16 v[108:111], v[240:243], v[36:39], v[108:111]
    ds_read_b64_tr_b16 v[234:235], v4 offset:18176
    s_waitcnt lgkmcnt(6)
    v_mfma_f32_16x16x32_bf16 v[112:115], v[244:247], v[32:35], v[112:115]
    ds_read_b64_tr_b16 v[236:237], v5 offset:17184
    v_mfma_f32_16x16x32_bf16 v[116:119], v[244:247], v[36:39], v[116:119]
    ds_read_b64_tr_b16 v[238:239], v5 offset:18208
    s_waitcnt lgkmcnt(6)
    v_mfma_f32_16x16x32_bf16 v[120:123], v[224:227], v[32:35], v[120:123]
    v_mfma_f32_16x16x32_bf16 v[124:127], v[224:227], v[36:39], v[124:127]
    s_barrier
    ds_read_b64_tr_b16 v[240:241], v4 offset:32768
    ds_read_b64_tr_b16 v[242:243], v4 offset:33792
    s_waitcnt lgkmcnt(6)
    v_mfma_f32_16x16x32_bf16 v[128:131], v[228:231], v[32:35], v[128:131]
    ds_read_b64_tr_b16 v[244:245], v5 offset:32800
    s_mov_b32 s23, 0xa000
    buffer_load_dwordx4 v[24:27], v6, s[8:11], s23 offen offset:0 sc1
    v_mfma_f32_16x16x32_bf16 v[132:135], v[228:231], v[36:39], v[132:135]
    ds_read_b64_tr_b16 v[246:247], v5 offset:33824
    s_waitcnt lgkmcnt(6)
    v_mfma_f32_16x16x32_bf16 v[136:139], v[232:235], v[32:35], v[136:139]
    ds_read_b64_tr_b16 v[224:225], v4 offset:33024
    v_mfma_f32_16x16x32_bf16 v[140:143], v[232:235], v[36:39], v[140:143]
    ds_read_b64_tr_b16 v[226:227], v4 offset:34048
    s_mov_b32 s23, 0x2a000
    buffer_load_dwordx4 v[28:31], v6, s[8:11], s23 offen offset:0 sc1
    s_waitcnt lgkmcnt(6)
    v_mfma_f32_16x16x32_bf16 v[144:147], v[236:239], v[32:35], v[144:147]
    s_add_u32 s16, s63, 0x574000
    v_mov_b32 v14, s28
    v_mov_b32 v15, 0
    s_mov_b64 exec, 1
    buffer_store_dword v14, v15, s[8:11], s16 offen sc1
    s_mov_b64 exec, -1
    ds_read_b64_tr_b16 v[228:229], v5 offset:33056
    v_mfma_f32_16x16x32_bf16 v[148:151], v[236:239], v[36:39], v[148:151]
    ds_read_b64_tr_b16 v[230:231], v5 offset:34080
    s_waitcnt vmcnt(14) lgkmcnt(6)
    v_mfma_f32_16x16x32_bf16 v[88:91], v[240:243], v[40:43], v[88:91]
    ds_read_b64_tr_b16 v[232:233], v4 offset:33280
    s_waitcnt vmcnt(13)
    v_mfma_f32_16x16x32_bf16 v[92:95], v[240:243], v[44:47], v[92:95]
    s_add_u32 s22, s24, 0x300000
    s_add_u32 m0, s20, 0x10000
    s_nop 0
    buffer_load_dwordx4 v3, s[4:7], s22 offen lds
    ds_read_b64_tr_b16 v[234:235], v4 offset:34304
    s_waitcnt lgkmcnt(6)
    v_mfma_f32_16x16x32_bf16 v[96:99], v[244:247], v[40:43], v[96:99]
    ds_read_b64_tr_b16 v[236:237], v5 offset:33312
    v_mfma_f32_16x16x32_bf16 v[100:103], v[244:247], v[44:47], v[100:103]
    ds_read_b64_tr_b16 v[238:239], v5 offset:34336
    s_waitcnt lgkmcnt(6)
    v_mfma_f32_16x16x32_bf16 v[104:107], v[224:227], v[40:43], v[104:107]
    s_add_u32 s22, s24, 0x302000
    s_add_u32 m0, s20, 0x10400
    s_nop 0
    buffer_load_dwordx4 v3, s[4:7], s22 offen lds
    ds_read_b64_tr_b16 v[240:241], v4 offset:33536
    v_mfma_f32_16x16x32_bf16 v[108:111], v[224:227], v[44:47], v[108:111]
    ds_read_b64_tr_b16 v[242:243], v4 offset:34560
    s_waitcnt lgkmcnt(6)
    v_mfma_f32_16x16x32_bf16 v[112:115], v[228:231], v[40:43], v[112:115]
    ds_read_b64_tr_b16 v[244:245], v5 offset:33568
    v_mfma_f32_16x16x32_bf16 v[116:119], v[228:231], v[44:47], v[116:119]
    ds_read_b64_tr_b16 v[246:247], v5 offset:34592
    s_waitcnt lgkmcnt(6)
    v_mfma_f32_16x16x32_bf16 v[120:123], v[232:235], v[40:43], v[120:123]
    v_mfma_f32_16x16x32_bf16 v[124:127], v[232:235], v[44:47], v[124:127]
    s_barrier
    ds_read_b64_tr_b16 v[224:225], v4 offset:49152
    ds_read_b64_tr_b16 v[226:227], v4 offset:50176
    s_add_u32 s19, s19, 8192
    buffer_load_dword v12, v13, s[8:11], s19 offen sc1
    s_waitcnt lgkmcnt(6)
    v_mfma_f32_16x16x32_bf16 v[128:131], v[236:239], v[40:43], v[128:131]
    ds_read_b64_tr_b16 v[228:229], v5 offset:49184
    s_mov_b32 s23, 0xc000
    buffer_load_dwordx4 v[32:35], v6, s[8:11], s23 offen offset:0 sc1
    v_mfma_f32_16x16x32_bf16 v[132:135], v[236:239], v[44:47], v[132:135]
    ds_read_b64_tr_b16 v[230:231], v5 offset:50208
    s_waitcnt lgkmcnt(6)
    v_mfma_f32_16x16x32_bf16 v[136:139], v[240:243], v[40:43], v[136:139]
    ds_read_b64_tr_b16 v[232:233], v4 offset:49408
    v_mfma_f32_16x16x32_bf16 v[140:143], v[240:243], v[44:47], v[140:143]
    ds_read_b64_tr_b16 v[234:235], v4 offset:50432
    s_mov_b32 s23, 0x2c000
    buffer_load_dwordx4 v[36:39], v6, s[8:11], s23 offen offset:0 sc1
    s_waitcnt lgkmcnt(6)
    v_mfma_f32_16x16x32_bf16 v[144:147], v[244:247], v[40:43], v[144:147]
    ds_read_b64_tr_b16 v[236:237], v5 offset:49440
    v_mfma_f32_16x16x32_bf16 v[148:151], v[244:247], v[44:47], v[148:151]
    ds_read_b64_tr_b16 v[238:239], v5 offset:50464
    s_waitcnt vmcnt(17) lgkmcnt(6)
    v_mfma_f32_16x16x32_bf16 v[88:91], v[224:227], v[48:51], v[88:91]
    ds_read_b64_tr_b16 v[240:241], v4 offset:49664
    s_waitcnt vmcnt(16)
    v_mfma_f32_16x16x32_bf16 v[92:95], v[224:227], v[52:55], v[92:95]
    s_add_u32 s22, s24, 0x380000
    s_add_u32 m0, s20, 0x14000
    s_nop 0
    buffer_load_dwordx4 v3, s[4:7], s22 offen lds
    ds_read_b64_tr_b16 v[242:243], v4 offset:50688
    s_waitcnt lgkmcnt(6)
    v_mfma_f32_16x16x32_bf16 v[96:99], v[228:231], v[48:51], v[96:99]
    ds_read_b64_tr_b16 v[244:245], v5 offset:49696
    v_mfma_f32_16x16x32_bf16 v[100:103], v[228:231], v[52:55], v[100:103]
    ds_read_b64_tr_b16 v[246:247], v5 offset:50720
    s_waitcnt lgkmcnt(6)
    v_mfma_f32_16x16x32_bf16 v[104:107], v[232:235], v[48:51], v[104:107]
    s_add_u32 s22, s24, 0x382000
    s_add_u32 m0, s20, 0x14400
    s_nop 0
    buffer_load_dwordx4 v3, s[4:7], s22 offen lds
    ds_read_b64_tr_b16 v[224:225], v4 offset:49920
    v_mfma_f32_16x16x32_bf16 v[108:111], v[232:235], v[52:55], v[108:111]
    ds_read_b64_tr_b16 v[226:227], v4 offset:50944
    s_waitcnt lgkmcnt(6)
    v_mfma_f32_16x16x32_bf16 v[112:115], v[236:239], v[48:51], v[112:115]
    ds_read_b64_tr_b16 v[228:229], v5 offset:49952
    v_mfma_f32_16x16x32_bf16 v[116:119], v[236:239], v[52:55], v[116:119]
    ds_read_b64_tr_b16 v[230:231], v5 offset:50976
    s_waitcnt lgkmcnt(6)
    v_mfma_f32_16x16x32_bf16 v[120:123], v[240:243], v[48:51], v[120:123]
    v_mfma_f32_16x16x32_bf16 v[124:127], v[240:243], v[52:55], v[124:127]
    s_waitcnt vmcnt(13)
    s_barrier
    ds_read_b64_tr_b16 v[232:233], v7 offset:0
    ds_read_b64_tr_b16 v[234:235], v7 offset:1024
    s_waitcnt lgkmcnt(6)
    v_mfma_f32_16x16x32_bf16 v[128:131], v[244:247], v[48:51], v[128:131]
    ds_read_b64_tr_b16 v[236:237], v8 offset:32
    s_mov_b32 s23, 0xe000
    buffer_load_dwordx4 v[40:43], v6, s[8:11], s23 offen offset:0 sc1
    v_mfma_f32_16x16x32_bf16 v[132:135], v[244:247], v[52:55], v[132:135]
    ds_read_b64_tr_b16 v[238:239], v8 offset:1056
    s_waitcnt lgkmcnt(6)
    v_mfma_f32_16x16x32_bf16 v[136:139], v[224:227], v[48:51], v[136:139]
    ds_read_b64_tr_b16 v[240:241], v7 offset:256
    v_mfma_f32_16x16x32_bf16 v[140:143], v[224:227], v[52:55], v[140:143]
    ds_read_b64_tr_b16 v[242:243], v7 offset:1280
    s_mov_b32 s23, 0x2e000
    buffer_load_dwordx4 v[44:47], v6, s[8:11], s23 offen offset:0 sc1
    s_waitcnt lgkmcnt(6)
    v_mfma_f32_16x16x32_bf16 v[144:147], v[228:231], v[48:51], v[144:147]
    ds_read_b64_tr_b16 v[244:245], v8 offset:288
    v_mfma_f32_16x16x32_bf16 v[148:151], v[228:231], v[52:55], v[148:151]
    ds_read_b64_tr_b16 v[246:247], v8 offset:1312
    s_waitcnt vmcnt(6)
    v_cmp_ne_u32 vcc, s28, v12
    s_cbranch_vccnz adaLN_cond__sliding_block_cached__moe_arch_mod__prompt_kernel_o218r
adaLN_cond__sliding_block_cached__moe_arch_mod__prompt_kernel_o218b:
    s_waitcnt lgkmcnt(6)
    v_mfma_f32_16x16x32_bf16 v[88:91], v[232:235], v[56:59], v[88:91]
    ds_read_b64_tr_b16 v[224:225], v7 offset:512
    v_mfma_f32_16x16x32_bf16 v[92:95], v[232:235], v[60:63], v[92:95]
    s_add_u32 s22, s24, 0x10000
    s_add_u32 m0, s20, 0x18000
    s_nop 0
    buffer_load_dwordx4 v3, s[4:7], s22 offen lds
    ds_read_b64_tr_b16 v[226:227], v7 offset:1536
    s_waitcnt lgkmcnt(6)
    v_mfma_f32_16x16x32_bf16 v[96:99], v[236:239], v[56:59], v[96:99]
    ds_read_b64_tr_b16 v[228:229], v8 offset:544
    v_mfma_f32_16x16x32_bf16 v[100:103], v[236:239], v[60:63], v[100:103]
    ds_read_b64_tr_b16 v[230:231], v8 offset:1568
    s_waitcnt lgkmcnt(6)
    v_mfma_f32_16x16x32_bf16 v[104:107], v[240:243], v[56:59], v[104:107]
    s_add_u32 s22, s24, 0x12000
    s_add_u32 m0, s20, 0x18400
    s_nop 0
    buffer_load_dwordx4 v3, s[4:7], s22 offen lds
    ds_read_b64_tr_b16 v[232:233], v7 offset:768
    v_mfma_f32_16x16x32_bf16 v[108:111], v[240:243], v[60:63], v[108:111]
    ds_read_b64_tr_b16 v[234:235], v7 offset:1792
    s_waitcnt lgkmcnt(6)
    v_mfma_f32_16x16x32_bf16 v[112:115], v[244:247], v[56:59], v[112:115]
    ds_read_b64_tr_b16 v[236:237], v8 offset:800
    v_mfma_f32_16x16x32_bf16 v[116:119], v[244:247], v[60:63], v[116:119]
    ds_read_b64_tr_b16 v[238:239], v8 offset:1824
    s_waitcnt lgkmcnt(6)
    v_mfma_f32_16x16x32_bf16 v[120:123], v[224:227], v[56:59], v[120:123]
    v_mfma_f32_16x16x32_bf16 v[124:127], v[224:227], v[60:63], v[124:127]
    s_barrier
    ds_read_b64_tr_b16 v[240:241], v7 offset:16384
    ds_read_b64_tr_b16 v[242:243], v7 offset:17408
    s_waitcnt lgkmcnt(6)
    v_mfma_f32_16x16x32_bf16 v[128:131], v[228:231], v[56:59], v[128:131]
    ds_read_b64_tr_b16 v[244:245], v8 offset:16416
    s_mov_b32 s23, 0x0
    buffer_load_dwordx4 v[48:51], v6, s[8:11], s23 offen offset:1024 sc1
    v_mfma_f32_16x16x32_bf16 v[132:135], v[228:231], v[60:63], v[132:135]
    ds_read_b64_tr_b16 v[246:247], v8 offset:17440
    s_waitcnt lgkmcnt(6)
    v_mfma_f32_16x16x32_bf16 v[136:139], v[232:235], v[56:59], v[136:139]
    ds_read_b64_tr_b16 v[224:225], v7 offset:16640
    v_mfma_f32_16x16x32_bf16 v[140:143], v[232:235], v[60:63], v[140:143]
    ds_read_b64_tr_b16 v[226:227], v7 offset:17664
    s_mov_b32 s23, 0x20000
    buffer_load_dwordx4 v[52:55], v6, s[8:11], s23 offen offset:1024 sc1
    s_waitcnt lgkmcnt(6)
    v_mfma_f32_16x16x32_bf16 v[144:147], v[236:239], v[56:59], v[144:147]
    ds_read_b64_tr_b16 v[228:229], v8 offset:16672
    v_mfma_f32_16x16x32_bf16 v[148:151], v[236:239], v[60:63], v[148:151]
    ds_read_b64_tr_b16 v[230:231], v8 offset:17696
    s_waitcnt lgkmcnt(6)
    v_mfma_f32_16x16x32_bf16 v[88:91], v[240:243], v[24:27], v[88:91]
    ds_read_b64_tr_b16 v[232:233], v7 offset:16896
    v_mfma_f32_16x16x32_bf16 v[92:95], v[240:243], v[28:31], v[92:95]
    s_add_u32 s22, s24, 0x90000
    s_add_u32 m0, s20, 0x1c000
    s_nop 0
    buffer_load_dwordx4 v3, s[4:7], s22 offen lds
    ds_read_b64_tr_b16 v[234:235], v7 offset:17920
    s_waitcnt lgkmcnt(6)
    v_mfma_f32_16x16x32_bf16 v[96:99], v[244:247], v[24:27], v[96:99]
    ds_read_b64_tr_b16 v[236:237], v8 offset:16928
    v_mfma_f32_16x16x32_bf16 v[100:103], v[244:247], v[28:31], v[100:103]
    ds_read_b64_tr_b16 v[238:239], v8 offset:17952
    s_waitcnt lgkmcnt(6)
    v_mfma_f32_16x16x32_bf16 v[104:107], v[224:227], v[24:27], v[104:107]
    s_add_u32 s22, s24, 0x92000
    s_add_u32 m0, s20, 0x1c400
    s_nop 0
    buffer_load_dwordx4 v3, s[4:7], s22 offen lds
    ds_read_b64_tr_b16 v[240:241], v7 offset:17152
    v_mfma_f32_16x16x32_bf16 v[108:111], v[224:227], v[28:31], v[108:111]
    ds_read_b64_tr_b16 v[242:243], v7 offset:18176
    s_waitcnt lgkmcnt(6)
    v_mfma_f32_16x16x32_bf16 v[112:115], v[228:231], v[24:27], v[112:115]
    ds_read_b64_tr_b16 v[244:245], v8 offset:17184
    v_mfma_f32_16x16x32_bf16 v[116:119], v[228:231], v[28:31], v[116:119]
    ds_read_b64_tr_b16 v[246:247], v8 offset:18208
    s_waitcnt lgkmcnt(6)
    v_mfma_f32_16x16x32_bf16 v[120:123], v[232:235], v[24:27], v[120:123]
    v_mfma_f32_16x16x32_bf16 v[124:127], v[232:235], v[28:31], v[124:127]
    s_barrier
    ds_read_b64_tr_b16 v[224:225], v4 offset:0
    ds_read_b64_tr_b16 v[226:227], v4 offset:1024
    s_waitcnt lgkmcnt(6)
    v_mfma_f32_16x16x32_bf16 v[128:131], v[236:239], v[24:27], v[128:131]
    s_add_u32 s16, s63, 0x576000
    v_mov_b32 v14, s28
    v_mov_b32 v15, 0
    s_mov_b64 exec, 1
    buffer_store_dword v14, v15, s[8:11], s16 offen sc1
    s_mov_b64 exec, -1
    ds_read_b64_tr_b16 v[228:229], v5 offset:32
    s_mov_b32 s23, 0x2000
    buffer_load_dwordx4 v[56:59], v6, s[8:11], s23 offen offset:1024 sc1
    v_mfma_f32_16x16x32_bf16 v[132:135], v[236:239], v[28:31], v[132:135]
    ds_read_b64_tr_b16 v[230:231], v5 offset:1056
    s_waitcnt lgkmcnt(6)
    v_mfma_f32_16x16x32_bf16 v[136:139], v[240:243], v[24:27], v[136:139]
    ds_read_b64_tr_b16 v[232:233], v4 offset:256
    v_mfma_f32_16x16x32_bf16 v[140:143], v[240:243], v[28:31], v[140:143]
    ds_read_b64_tr_b16 v[234:235], v4 offset:1280
    s_mov_b32 s23, 0x22000
    buffer_load_dwordx4 v[60:63], v6, s[8:11], s23 offen offset:1024 sc1
    s_waitcnt lgkmcnt(6)
    v_mfma_f32_16x16x32_bf16 v[144:147], v[244:247], v[24:27], v[144:147]
    ds_read_b64_tr_b16 v[236:237], v5 offset:288
    v_mfma_f32_16x16x32_bf16 v[148:151], v[244:247], v[28:31], v[148:151]
    ds_read_b64_tr_b16 v[238:239], v5 offset:1312
    s_waitcnt vmcnt(14) lgkmcnt(6)
    v_mfma_f32_16x16x32_bf16 v[88:91], v[224:227], v[32:35], v[88:91]
    ds_read_b64_tr_b16 v[240:241], v4 offset:512
    s_waitcnt vmcnt(13)
    v_mfma_f32_16x16x32_bf16 v[92:95], v[224:227], v[36:39], v[92:95]
    s_add_u32 s22, s24, 0x110000
    s_add_u32 m0, s20, 0x20000
    s_nop 0
    buffer_load_dwordx4 v3, s[4:7], s22 offen lds
    ds_read_b64_tr_b16 v[242:243], v4 offset:1536
    s_waitcnt lgkmcnt(6)
    v_mfma_f32_16x16x32_bf16 v[96:99], v[228:231], v[32:35], v[96:99]
    ds_read_b64_tr_b16 v[244:245], v5 offset:544
    v_mfma_f32_16x16x32_bf16 v[100:103], v[228:231], v[36:39], v[100:103]
    ds_read_b64_tr_b16 v[246:247], v5 offset:1568
    s_waitcnt lgkmcnt(6)
    v_mfma_f32_16x16x32_bf16 v[104:107], v[232:235], v[32:35], v[104:107]
    s_add_u32 s22, s24, 0x112000
    s_add_u32 m0, s20, 0x20400
    s_nop 0
    buffer_load_dwordx4 v3, s[4:7], s22 offen lds
    ds_read_b64_tr_b16 v[224:225], v4 offset:768
    v_mfma_f32_16x16x32_bf16 v[108:111], v[232:235], v[36:39], v[108:111]
    ds_read_b64_tr_b16 v[226:227], v4 offset:1792
    s_waitcnt lgkmcnt(6)
    v_mfma_f32_16x16x32_bf16 v[112:115], v[236:239], v[32:35], v[112:115]
    ds_read_b64_tr_b16 v[228:229], v5 offset:800
    v_mfma_f32_16x16x32_bf16 v[116:119], v[236:239], v[36:39], v[116:119]
    ds_read_b64_tr_b16 v[230:231], v5 offset:1824
    s_waitcnt lgkmcnt(6)
    v_mfma_f32_16x16x32_bf16 v[120:123], v[240:243], v[32:35], v[120:123]
    v_mfma_f32_16x16x32_bf16 v[124:127], v[240:243], v[36:39], v[124:127]
    s_waitcnt vmcnt(13)
    s_barrier
    ds_read_b64_tr_b16 v[232:233], v4 offset:16384
    ds_read_b64_tr_b16 v[234:235], v4 offset:17408
    s_waitcnt lgkmcnt(6)
    v_mfma_f32_16x16x32_bf16 v[128:131], v[244:247], v[32:35], v[128:131]
    ds_read_b64_tr_b16 v[236:237], v5 offset:16416
    s_mov_b32 s23, 0x4000
    buffer_load_dwordx4 v[24:27], v6, s[8:11], s23 offen offset:1024 sc1
    v_mfma_f32_16x16x32_bf16 v[132:135], v[244:247], v[36:39], v[132:135]
    ds_read_b64_tr_b16 v[238:239], v5 offset:17440
    s_waitcnt lgkmcnt(6)
    v_mfma_f32_16x16x32_bf16 v[136:139], v[224:227], v[32:35], v[136:139]
    ds_read_b64_tr_b16 v[240:241], v4 offset:16640
    v_mfma_f32_16x16x32_bf16 v[140:143], v[224:227], v[36:39], v[140:143]
    ds_read_b64_tr_b16 v[242:243], v4 offset:17664
    s_mov_b32 s23, 0x24000
    buffer_load_dwordx4 v[28:31], v6, s[8:11], s23 offen offset:1024 sc1
    s_waitcnt lgkmcnt(6)
    v_mfma_f32_16x16x32_bf16 v[144:147], v[228:231], v[32:35], v[144:147]
    ds_read_b64_tr_b16 v[244:245], v5 offset:16672
    v_mfma_f32_16x16x32_bf16 v[148:151], v[228:231], v[36:39], v[148:151]
    ds_read_b64_tr_b16 v[246:247], v5 offset:17696
    s_waitcnt vmcnt(14) lgkmcnt(6)
    v_mfma_f32_16x16x32_bf16 v[88:91], v[232:235], v[40:43], v[88:91]
    ds_read_b64_tr_b16 v[224:225], v4 offset:16896
    s_waitcnt vmcnt(13)
    v_mfma_f32_16x16x32_bf16 v[92:95], v[232:235], v[44:47], v[92:95]
    s_add_u32 s22, s24, 0x190000
    s_add_u32 m0, s20, 0x24000
    s_nop 0
    buffer_load_dwordx4 v3, s[4:7], s22 offen lds
    ds_read_b64_tr_b16 v[226:227], v4 offset:17920
    s_waitcnt lgkmcnt(6)
    v_mfma_f32_16x16x32_bf16 v[96:99], v[236:239], v[40:43], v[96:99]
    ds_read_b64_tr_b16 v[228:229], v5 offset:16928
    v_mfma_f32_16x16x32_bf16 v[100:103], v[236:239], v[44:47], v[100:103]
    ds_read_b64_tr_b16 v[230:231], v5 offset:17952
    s_waitcnt lgkmcnt(6)
    v_mfma_f32_16x16x32_bf16 v[104:107], v[240:243], v[40:43], v[104:107]
    s_add_u32 s22, s24, 0x192000
    s_add_u32 m0, s20, 0x24400
    s_nop 0
    buffer_load_dwordx4 v3, s[4:7], s22 offen lds
    ds_read_b64_tr_b16 v[232:233], v4 offset:17152
    v_mfma_f32_16x16x32_bf16 v[108:111], v[240:243], v[44:47], v[108:111]
    ds_read_b64_tr_b16 v[234:235], v4 offset:18176
    s_waitcnt lgkmcnt(6)
    v_mfma_f32_16x16x32_bf16 v[112:115], v[244:247], v[40:43], v[112:115]
    ds_read_b64_tr_b16 v[236:237], v5 offset:17184
    v_mfma_f32_16x16x32_bf16 v[116:119], v[244:247], v[44:47], v[116:119]
    ds_read_b64_tr_b16 v[238:239], v5 offset:18208
    s_waitcnt lgkmcnt(6)
    v_mfma_f32_16x16x32_bf16 v[120:123], v[224:227], v[40:43], v[120:123]
    v_mfma_f32_16x16x32_bf16 v[124:127], v[224:227], v[44:47], v[124:127]
    s_waitcnt vmcnt(13)
    s_barrier
    ds_read_b64_tr_b16 v[240:241], v4 offset:32768
    ds_read_b64_tr_b16 v[242:243], v4 offset:33792
    s_waitcnt lgkmcnt(6)
    v_mfma_f32_16x16x32_bf16 v[128:131], v[228:231], v[40:43], v[128:131]
    ds_read_b64_tr_b16 v[244:245], v5 offset:32800
    s_mov_b32 s23, 0x6000
    buffer_load_dwordx4 v[32:35], v6, s[8:11], s23 offen offset:1024 sc1
    v_mfma_f32_16x16x32_bf16 v[132:135], v[228:231], v[44:47], v[132:135]
    ds_read_b64_tr_b16 v[246:247], v5 offset:33824
    s_waitcnt lgkmcnt(6)
    v_mfma_f32_16x16x32_bf16 v[136:139], v[232:235], v[40:43], v[136:139]
    ds_read_b64_tr_b16 v[224:225], v4 offset:33024
    v_mfma_f32_16x16x32_bf16 v[140:143], v[232:235], v[44:47], v[140:143]
    ds_read_b64_tr_b16 v[226:227], v4 offset:34048
    s_mov_b32 s23, 0x26000
    buffer_load_dwordx4 v[36:39], v6, s[8:11], s23 offen offset:1024 sc1
    s_waitcnt lgkmcnt(6)
    v_mfma_f32_16x16x32_bf16 v[144:147], v[236:239], v[40:43], v[144:147]
    ds_read_b64_tr_b16 v[228:229], v5 offset:33056
    v_mfma_f32_16x16x32_bf16 v[148:151], v[236:239], v[44:47], v[148:151]
    ds_read_b64_tr_b16 v[230:231], v5 offset:34080
    s_waitcnt vmcnt(14) lgkmcnt(6)
    v_mfma_f32_16x16x32_bf16 v[88:91], v[240:243], v[48:51], v[88:91]
    ds_read_b64_tr_b16 v[232:233], v4 offset:33280
    s_waitcnt vmcnt(13)
    v_mfma_f32_16x16x32_bf16 v[92:95], v[240:243], v[52:55], v[92:95]
    s_add_u32 s22, s24, 0x210000
    s_add_u32 m0, s20, 0x10000
    s_nop 0
    buffer_load_dwordx4 v3, s[4:7], s22 offen lds
    ds_read_b64_tr_b16 v[234:235], v4 offset:34304
    s_waitcnt lgkmcnt(6)
    v_mfma_f32_16x16x32_bf16 v[96:99], v[244:247], v[48:51], v[96:99]
    ds_read_b64_tr_b16 v[236:237], v5 offset:33312
    v_mfma_f32_16x16x32_bf16 v[100:103], v[244:247], v[52:55], v[100:103]
    ds_read_b64_tr_b16 v[238:239], v5 offset:34336
    s_waitcnt lgkmcnt(6)
    v_mfma_f32_16x16x32_bf16 v[104:107], v[224:227], v[48:51], v[104:107]
    s_add_u32 s22, s24, 0x212000
    s_add_u32 m0, s20, 0x10400
    s_nop 0
    buffer_load_dwordx4 v3, s[4:7], s22 offen lds
    ds_read_b64_tr_b16 v[240:241], v4 offset:33536
    v_mfma_f32_16x16x32_bf16 v[108:111], v[224:227], v[52:55], v[108:111]
    ds_read_b64_tr_b16 v[242:243], v4 offset:34560
    s_waitcnt lgkmcnt(6)
    v_mfma_f32_16x16x32_bf16 v[112:115], v[228:231], v[48:51], v[112:115]
    ds_read_b64_tr_b16 v[244:245], v5 offset:33568
    v_mfma_f32_16x16x32_bf16 v[116:119], v[228:231], v[52:55], v[116:119]
    ds_read_b64_tr_b16 v[246:247], v5 offset:34592
    s_waitcnt lgkmcnt(6)
    v_mfma_f32_16x16x32_bf16 v[120:123], v[232:235], v[48:51], v[120:123]
    v_mfma_f32_16x16x32_bf16 v[124:127], v[232:235], v[52:55], v[124:127]
    s_waitcnt vmcnt(13)
    s_barrier
    ds_read_b64_tr_b16 v[224:225], v4 offset:49152
    ds_read_b64_tr_b16 v[226:227], v4 offset:50176
    s_waitcnt lgkmcnt(6)
    v_mfma_f32_16x16x32_bf16 v[128:131], v[236:239], v[48:51], v[128:131]
    ds_read_b64_tr_b16 v[228:229], v5 offset:49184
    s_mov_b32 s23, 0x8000
    buffer_load_dwordx4 v[40:43], v6, s[8:11], s23 offen offset:1024 sc1
    v_mfma_f32_16x16x32_bf16 v[132:135], v[236:239], v[52:55], v[132:135]
    ds_read_b64_tr_b16 v[230:231], v5 offset:50208
    s_waitcnt lgkmcnt(6)
    v_mfma_f32_16x16x32_bf16 v[136:139], v[240:243], v[48:51], v[136:139]
    ds_read_b64_tr_b16 v[232:233], v4 offset:49408
    v_mfma_f32_16x16x32_bf16 v[140:143], v[240:243], v[52:55], v[140:143]
    ds_read_b64_tr_b16 v[234:235], v4 offset:50432
    s_mov_b32 s23, 0x28000
    buffer_load_dwordx4 v[44:47], v6, s[8:11], s23 offen offset:1024 sc1
    s_waitcnt lgkmcnt(6)
    v_mfma_f32_16x16x32_bf16 v[144:147], v[244:247], v[48:51], v[144:147]
    ds_read_b64_tr_b16 v[236:237], v5 offset:49440
    v_mfma_f32_16x16x32_bf16 v[148:151], v[244:247], v[52:55], v[148:151]
    ds_read_b64_tr_b16 v[238:239], v5 offset:50464
    s_waitcnt vmcnt(13) lgkmcnt(6)
    v_mfma_f32_16x16x32_bf16 v[88:91], v[224:227], v[56:59], v[88:91]
    ds_read_b64_tr_b16 v[240:241], v4 offset:49664
    s_waitcnt vmcnt(12)
    v_mfma_f32_16x16x32_bf16 v[92:95], v[224:227], v[60:63], v[92:95]
    s_add_u32 s22, s24, 0x290000
    s_add_u32 m0, s20, 0x14000
    s_nop 0
    buffer_load_dwordx4 v3, s[4:7], s22 offen lds
    ds_read_b64_tr_b16 v[242:243], v4 offset:50688
    s_waitcnt lgkmcnt(6)
    v_mfma_f32_16x16x32_bf16 v[96:99], v[228:231], v[56:59], v[96:99]
    ds_read_b64_tr_b16 v[244:245], v5 offset:49696
    v_mfma_f32_16x16x32_bf16 v[100:103], v[228:231], v[60:63], v[100:103]
    ds_read_b64_tr_b16 v[246:247], v5 offset:50720
    s_waitcnt lgkmcnt(6)
    v_mfma_f32_16x16x32_bf16 v[104:107], v[232:235], v[56:59], v[104:107]
    s_add_u32 s22, s24, 0x292000
    s_add_u32 m0, s20, 0x14400
    s_nop 0
    buffer_load_dwordx4 v3, s[4:7], s22 offen lds
    ds_read_b64_tr_b16 v[224:225], v4 offset:49920
    v_mfma_f32_16x16x32_bf16 v[108:111], v[232:235], v[60:63], v[108:111]
    ds_read_b64_tr_b16 v[226:227], v4 offset:50944
    s_waitcnt lgkmcnt(6)
    v_mfma_f32_16x16x32_bf16 v[112:115], v[236:239], v[56:59], v[112:115]
    ds_read_b64_tr_b16 v[228:229], v5 offset:49952
    v_mfma_f32_16x16x32_bf16 v[116:119], v[236:239], v[60:63], v[116:119]
    ds_read_b64_tr_b16 v[230:231], v5 offset:50976
    s_waitcnt lgkmcnt(6)
    v_mfma_f32_16x16x32_bf16 v[120:123], v[240:243], v[56:59], v[120:123]
    v_mfma_f32_16x16x32_bf16 v[124:127], v[240:243], v[60:63], v[124:127]
    s_waitcnt vmcnt(12)
    s_barrier
    ds_read_b64_tr_b16 v[232:233], v7 offset:0
    ds_read_b64_tr_b16 v[234:235], v7 offset:1024
    s_waitcnt lgkmcnt(6)
    v_mfma_f32_16x16x32_bf16 v[128:131], v[244:247], v[56:59], v[128:131]
    ds_read_b64_tr_b16 v[236:237], v8 offset:32
    s_mov_b32 s23, 0xa000
    buffer_load_dwordx4 v[48:51], v6, s[8:11], s23 offen offset:1024 sc1
    v_mfma_f32_16x16x32_bf16 v[132:135], v[244:247], v[60:63], v[132:135]
    ds_read_b64_tr_b16 v[238:239], v8 offset:1056
    s_waitcnt lgkmcnt(6)
    v_mfma_f32_16x16x32_bf16 v[136:139], v[224:227], v[56:59], v[136:139]
    ds_read_b64_tr_b16 v[240:241], v7 offset:256
    v_mfma_f32_16x16x32_bf16 v[140:143], v[224:227], v[60:63], v[140:143]
    ds_read_b64_tr_b16 v[242:243], v7 offset:1280
    s_mov_b32 s23, 0x2a000
    buffer_load_dwordx4 v[52:55], v6, s[8:11], s23 offen offset:1024 sc1
    s_waitcnt lgkmcnt(6)
    v_mfma_f32_16x16x32_bf16 v[144:147], v[228:231], v[56:59], v[144:147]
    ds_read_b64_tr_b16 v[244:245], v8 offset:288
    v_mfma_f32_16x16x32_bf16 v[148:151], v[228:231], v[60:63], v[148:151]
    ds_read_b64_tr_b16 v[246:247], v8 offset:1312
    s_waitcnt vmcnt(13) lgkmcnt(6)
    v_mfma_f32_16x16x32_bf16 v[88:91], v[232:235], v[24:27], v[88:91]
    ds_read_b64_tr_b16 v[224:225], v7 offset:512
    s_waitcnt vmcnt(12)
    v_mfma_f32_16x16x32_bf16 v[92:95], v[232:235], v[28:31], v[92:95]
    s_add_u32 s22, s24, 0x310000
    s_add_u32 m0, s20, 0x18000
    s_nop 0
    buffer_load_dwordx4 v3, s[4:7], s22 offen lds
    ds_read_b64_tr_b16 v[226:227], v7 offset:1536
    s_waitcnt lgkmcnt(6)
    v_mfma_f32_16x16x32_bf16 v[96:99], v[236:239], v[24:27], v[96:99]
    ds_read_b64_tr_b16 v[228:229], v8 offset:544
    v_mfma_f32_16x16x32_bf16 v[100:103], v[236:239], v[28:31], v[100:103]
    ds_read_b64_tr_b16 v[230:231], v8 offset:1568
    s_waitcnt lgkmcnt(6)
    v_mfma_f32_16x16x32_bf16 v[104:107], v[240:243], v[24:27], v[104:107]
    s_add_u32 s22, s24, 0x312000
    s_add_u32 m0, s20, 0x18400
    s_nop 0
    buffer_load_dwordx4 v3, s[4:7], s22 offen lds
    ds_read_b64_tr_b16 v[232:233], v7 offset:768
    v_mfma_f32_16x16x32_bf16 v[108:111], v[240:243], v[28:31], v[108:111]
    ds_read_b64_tr_b16 v[234:235], v7 offset:1792
    s_waitcnt lgkmcnt(6)
    v_mfma_f32_16x16x32_bf16 v[112:115], v[244:247], v[24:27], v[112:115]
    ds_read_b64_tr_b16 v[236:237], v8 offset:800
    v_mfma_f32_16x16x32_bf16 v[116:119], v[244:247], v[28:31], v[116:119]
    ds_read_b64_tr_b16 v[238:239], v8 offset:1824
    s_waitcnt lgkmcnt(6)
    v_mfma_f32_16x16x32_bf16 v[120:123], v[224:227], v[24:27], v[120:123]
    v_mfma_f32_16x16x32_bf16 v[124:127], v[224:227], v[28:31], v[124:127]
    s_waitcnt vmcnt(12)
    s_barrier
    ds_read_b64_tr_b16 v[240:241], v7 offset:16384
    ds_read_b64_tr_b16 v[242:243], v7 offset:17408
    s_add_u32 s19, s19, 8192
    buffer_load_dword v12, v13, s[8:11], s19 offen sc1
    s_waitcnt lgkmcnt(6)
    v_mfma_f32_16x16x32_bf16 v[128:131], v[228:231], v[24:27], v[128:131]
    ds_read_b64_tr_b16 v[244:245], v8 offset:16416
    s_mov_b32 s23, 0xc000
    buffer_load_dwordx4 v[56:59], v6, s[8:11], s23 offen offset:1024 sc1
    v_mfma_f32_16x16x32_bf16 v[132:135], v[228:231], v[28:31], v[132:135]
    ds_read_b64_tr_b16 v[246:247], v8 offset:17440
    s_waitcnt lgkmcnt(6)
    v_mfma_f32_16x16x32_bf16 v[136:139], v[232:235], v[24:27], v[136:139]
    ds_read_b64_tr_b16 v[224:225], v7 offset:16640
    v_mfma_f32_16x16x32_bf16 v[140:143], v[232:235], v[28:31], v[140:143]
    ds_read_b64_tr_b16 v[226:227], v7 offset:17664
    s_mov_b32 s23, 0x2c000
    buffer_load_dwordx4 v[60:63], v6, s[8:11], s23 offen offset:1024 sc1
    s_waitcnt lgkmcnt(6)
    v_mfma_f32_16x16x32_bf16 v[144:147], v[236:239], v[24:27], v[144:147]
    ds_read_b64_tr_b16 v[228:229], v8 offset:16672
    v_mfma_f32_16x16x32_bf16 v[148:151], v[236:239], v[28:31], v[148:151]
    ds_read_b64_tr_b16 v[230:231], v8 offset:17696
    s_waitcnt vmcnt(14) lgkmcnt(6)
    v_mfma_f32_16x16x32_bf16 v[88:91], v[240:243], v[32:35], v[88:91]
    ds_read_b64_tr_b16 v[232:233], v7 offset:16896
    s_waitcnt vmcnt(13)
    v_mfma_f32_16x16x32_bf16 v[92:95], v[240:243], v[36:39], v[92:95]
    s_add_u32 s22, s24, 0x390000
    s_add_u32 m0, s20, 0x1c000
    s_nop 0
    buffer_load_dwordx4 v3, s[4:7], s22 offen lds
    ds_read_b64_tr_b16 v[234:235], v7 offset:17920
    s_waitcnt lgkmcnt(6)
    v_mfma_f32_16x16x32_bf16 v[96:99], v[244:247], v[32:35], v[96:99]
    ds_read_b64_tr_b16 v[236:237], v8 offset:16928
    v_mfma_f32_16x16x32_bf16 v[100:103], v[244:247], v[36:39], v[100:103]
    ds_read_b64_tr_b16 v[238:239], v8 offset:17952
    s_waitcnt lgkmcnt(6)
    v_mfma_f32_16x16x32_bf16 v[104:107], v[224:227], v[32:35], v[104:107]
    s_add_u32 s22, s24, 0x392000
    s_add_u32 m0, s20, 0x1c400
    s_nop 0
    buffer_load_dwordx4 v3, s[4:7], s22 offen lds
    ds_read_b64_tr_b16 v[240:241], v7 offset:17152
    v_mfma_f32_16x16x32_bf16 v[108:111], v[224:227], v[36:39], v[108:111]
    ds_read_b64_tr_b16 v[242:243], v7 offset:18176
    s_waitcnt lgkmcnt(6)
    v_mfma_f32_16x16x32_bf16 v[112:115], v[228:231], v[32:35], v[112:115]
    ds_read_b64_tr_b16 v[244:245], v8 offset:17184
    v_mfma_f32_16x16x32_bf16 v[116:119], v[228:231], v[36:39], v[116:119]
    ds_read_b64_tr_b16 v[246:247], v8 offset:18208
    s_waitcnt lgkmcnt(6)
    v_mfma_f32_16x16x32_bf16 v[120:123], v[232:235], v[32:35], v[120:123]
    v_mfma_f32_16x16x32_bf16 v[124:127], v[232:235], v[36:39], v[124:127]
    s_waitcnt vmcnt(13)
    s_barrier
    ds_read_b64_tr_b16 v[224:225], v4 offset:0
    ds_read_b64_tr_b16 v[226:227], v4 offset:1024
    s_waitcnt lgkmcnt(6)
    v_mfma_f32_16x16x32_bf16 v[128:131], v[236:239], v[32:35], v[128:131]
    ds_read_b64_tr_b16 v[228:229], v5 offset:32
    s_mov_b32 s23, 0xe000
    buffer_load_dwordx4 v[24:27], v6, s[8:11], s23 offen offset:1024 sc1
    v_mfma_f32_16x16x32_bf16 v[132:135], v[236:239], v[36:39], v[132:135]
    ds_read_b64_tr_b16 v[230:231], v5 offset:1056
    s_waitcnt lgkmcnt(6)
    v_mfma_f32_16x16x32_bf16 v[136:139], v[240:243], v[32:35], v[136:139]
    ds_read_b64_tr_b16 v[232:233], v4 offset:256
    v_mfma_f32_16x16x32_bf16 v[140:143], v[240:243], v[36:39], v[140:143]
    ds_read_b64_tr_b16 v[234:235], v4 offset:1280
    s_mov_b32 s23, 0x2e000
    buffer_load_dwordx4 v[28:31], v6, s[8:11], s23 offen offset:1024 sc1
    s_waitcnt lgkmcnt(6)
    v_mfma_f32_16x16x32_bf16 v[144:147], v[244:247], v[32:35], v[144:147]
    ds_read_b64_tr_b16 v[236:237], v5 offset:288
    v_mfma_f32_16x16x32_bf16 v[148:151], v[244:247], v[36:39], v[148:151]
    ds_read_b64_tr_b16 v[238:239], v5 offset:1312
    s_waitcnt vmcnt(6)
    v_cmp_ne_u32 vcc, s28, v12
    s_cbranch_vccnz adaLN_cond__sliding_block_cached__moe_arch_mod__prompt_kernel_o219r
adaLN_cond__sliding_block_cached__moe_arch_mod__prompt_kernel_o219b:
    s_waitcnt lgkmcnt(6)
    v_mfma_f32_16x16x32_bf16 v[88:91], v[224:227], v[40:43], v[88:91]
    ds_read_b64_tr_b16 v[240:241], v4 offset:512
    v_mfma_f32_16x16x32_bf16 v[92:95], v[224:227], v[44:47], v[92:95]
    s_add_u32 s22, s24, 0x20000
    s_add_u32 m0, s20, 0x20000
    s_nop 0
    buffer_load_dwordx4 v3, s[4:7], s22 offen lds
    ds_read_b64_tr_b16 v[242:243], v4 offset:1536
    s_waitcnt lgkmcnt(6)
    v_mfma_f32_16x16x32_bf16 v[96:99], v[228:231], v[40:43], v[96:99]
    ds_read_b64_tr_b16 v[244:245], v5 offset:544
    v_mfma_f32_16x16x32_bf16 v[100:103], v[228:231], v[44:47], v[100:103]
    ds_read_b64_tr_b16 v[246:247], v5 offset:1568
    s_waitcnt lgkmcnt(6)
    v_mfma_f32_16x16x32_bf16 v[104:107], v[232:235], v[40:43], v[104:107]
    s_add_u32 s22, s24, 0x22000
    s_add_u32 m0, s20, 0x20400
    s_nop 0
    buffer_load_dwordx4 v3, s[4:7], s22 offen lds
    ds_read_b64_tr_b16 v[224:225], v4 offset:768
    v_mfma_f32_16x16x32_bf16 v[108:111], v[232:235], v[44:47], v[108:111]
    ds_read_b64_tr_b16 v[226:227], v4 offset:1792
    s_waitcnt lgkmcnt(6)
    v_mfma_f32_16x16x32_bf16 v[112:115], v[236:239], v[40:43], v[112:115]
    ds_read_b64_tr_b16 v[228:229], v5 offset:800
    v_mfma_f32_16x16x32_bf16 v[116:119], v[236:239], v[44:47], v[116:119]
    ds_read_b64_tr_b16 v[230:231], v5 offset:1824
    s_waitcnt lgkmcnt(6)
    v_mfma_f32_16x16x32_bf16 v[120:123], v[240:243], v[40:43], v[120:123]
    v_mfma_f32_16x16x32_bf16 v[124:127], v[240:243], v[44:47], v[124:127]
    s_barrier
    ds_read_b64_tr_b16 v[232:233], v4 offset:16384
    ds_read_b64_tr_b16 v[234:235], v4 offset:17408
    s_waitcnt lgkmcnt(6)
    v_mfma_f32_16x16x32_bf16 v[128:131], v[244:247], v[40:43], v[128:131]
    ds_read_b64_tr_b16 v[236:237], v5 offset:16416
    s_mov_b32 s23, 0x0
    buffer_load_dwordx4 v[32:35], v6, s[8:11], s23 offen offset:2048 sc1
    v_mfma_f32_16x16x32_bf16 v[132:135], v[244:247], v[44:47], v[132:135]
    ds_read_b64_tr_b16 v[238:239], v5 offset:17440
    s_waitcnt lgkmcnt(6)
    v_mfma_f32_16x16x32_bf16 v[136:139], v[224:227], v[40:43], v[136:139]
    ds_read_b64_tr_b16 v[240:241], v4 offset:16640
    v_mfma_f32_16x16x32_bf16 v[140:143], v[224:227], v[44:47], v[140:143]
    ds_read_b64_tr_b16 v[242:243], v4 offset:17664
    s_mov_b32 s23, 0x20000
    buffer_load_dwordx4 v[36:39], v6, s[8:11], s23 offen offset:2048 sc1
    s_waitcnt lgkmcnt(6)
    v_mfma_f32_16x16x32_bf16 v[144:147], v[228:231], v[40:43], v[144:147]
    ds_read_b64_tr_b16 v[244:245], v5 offset:16672
    v_mfma_f32_16x16x32_bf16 v[148:151], v[228:231], v[44:47], v[148:151]
    ds_read_b64_tr_b16 v[246:247], v5 offset:17696
    s_waitcnt lgkmcnt(6)
    v_mfma_f32_16x16x32_bf16 v[88:91], v[232:235], v[48:51], v[88:91]
    ds_read_b64_tr_b16 v[224:225], v4 offset:16896
    v_mfma_f32_16x16x32_bf16 v[92:95], v[232:235], v[52:55], v[92:95]
    s_add_u32 s22, s24, 0xa0000
    s_add_u32 m0, s20, 0x24000
    s_nop 0
    buffer_load_dwordx4 v3, s[4:7], s22 offen lds
    ds_read_b64_tr_b16 v[226:227], v4 offset:17920
    s_waitcnt lgkmcnt(6)
    v_mfma_f32_16x16x32_bf16 v[96:99], v[236:239], v[48:51], v[96:99]
    ds_read_b64_tr_b16 v[228:229], v5 offset:16928
    v_mfma_f32_16x16x32_bf16 v[100:103], v[236:239], v[52:55], v[100:103]
    ds_read_b64_tr_b16 v[230:231], v5 offset:17952
    s_waitcnt lgkmcnt(6)
    v_mfma_f32_16x16x32_bf16 v[104:107], v[240:243], v[48:51], v[104:107]
    s_add_u32 s22, s24, 0xa2000
    s_add_u32 m0, s20, 0x24400
    s_nop 0
    buffer_load_dwordx4 v3, s[4:7], s22 offen lds
    ds_read_b64_tr_b16 v[232:233], v4 offset:17152
    v_mfma_f32_16x16x32_bf16 v[108:111], v[240:243], v[52:55], v[108:111]
    ds_read_b64_tr_b16 v[234:235], v4 offset:18176
    s_waitcnt lgkmcnt(6)
    v_mfma_f32_16x16x32_bf16 v[112:115], v[244:247], v[48:51], v[112:115]
    ds_read_b64_tr_b16 v[236:237], v5 offset:17184
    v_mfma_f32_16x16x32_bf16 v[116:119], v[244:247], v[52:55], v[116:119]
    ds_read_b64_tr_b16 v[238:239], v5 offset:18208
    s_waitcnt lgkmcnt(6)
    v_mfma_f32_16x16x32_bf16 v[120:123], v[224:227], v[48:51], v[120:123]
    v_mfma_f32_16x16x32_bf16 v[124:127], v[224:227], v[52:55], v[124:127]
    s_barrier
    ds_read_b64_tr_b16 v[240:241], v4 offset:32768
    ds_read_b64_tr_b16 v[242:243], v4 offset:33792
    s_waitcnt lgkmcnt(6)
    v_mfma_f32_16x16x32_bf16 v[128:131], v[228:231], v[48:51], v[128:131]
    ds_read_b64_tr_b16 v[244:245], v5 offset:32800
    s_mov_b32 s23, 0x2000
    buffer_load_dwordx4 v[40:43], v6, s[8:11], s23 offen offset:2048 sc1
    v_mfma_f32_16x16x32_bf16 v[132:135], v[228:231], v[52:55], v[132:135]
    ds_read_b64_tr_b16 v[246:247], v5 offset:33824
    s_waitcnt lgkmcnt(6)
    v_mfma_f32_16x16x32_bf16 v[136:139], v[232:235], v[48:51], v[136:139]
    ds_read_b64_tr_b16 v[224:225], v4 offset:33024
    v_mfma_f32_16x16x32_bf16 v[140:143], v[232:235], v[52:55], v[140:143]
    ds_read_b64_tr_b16 v[226:227], v4 offset:34048
    s_mov_b32 s23, 0x22000
    buffer_load_dwordx4 v[44:47], v6, s[8:11], s23 offen offset:2048 sc1
    s_waitcnt lgkmcnt(6)
    v_mfma_f32_16x16x32_bf16 v[144:147], v[236:239], v[48:51], v[144:147]
    ds_read_b64_tr_b16 v[228:229], v5 offset:33056
    v_mfma_f32_16x16x32_bf16 v[148:151], v[236:239], v[52:55], v[148:151]
    ds_read_b64_tr_b16 v[230:231], v5 offset:34080
    s_waitcnt vmcnt(13) lgkmcnt(6)
    v_mfma_f32_16x16x32_bf16 v[88:91], v[240:243], v[56:59], v[88:91]
    ds_read_b64_tr_b16 v[232:233], v4 offset:33280
    s_waitcnt vmcnt(12)
    v_mfma_f32_16x16x32_bf16 v[92:95], v[240:243], v[60:63], v[92:95]
    s_add_u32 s22, s24, 0x120000
    s_add_u32 m0, s20, 0x10000
    s_nop 0
    buffer_load_dwordx4 v3, s[4:7], s22 offen lds
    ds_read_b64_tr_b16 v[234:235], v4 offset:34304
    s_waitcnt lgkmcnt(6)
    v_mfma_f32_16x16x32_bf16 v[96:99], v[244:247], v[56:59], v[96:99]
    ds_read_b64_tr_b16 v[236:237], v5 offset:33312
    v_mfma_f32_16x16x32_bf16 v[100:103], v[244:247], v[60:63], v[100:103]
    ds_read_b64_tr_b16 v[238:239], v5 offset:34336
    s_waitcnt lgkmcnt(6)
    v_mfma_f32_16x16x32_bf16 v[104:107], v[224:227], v[56:59], v[104:107]
    s_add_u32 s22, s24, 0x122000
    s_add_u32 m0, s20, 0x10400
    s_nop 0
    buffer_load_dwordx4 v3, s[4:7], s22 offen lds
    ds_read_b64_tr_b16 v[240:241], v4 offset:33536
    v_mfma_f32_16x16x32_bf16 v[108:111], v[224:227], v[60:63], v[108:111]
    ds_read_b64_tr_b16 v[242:243], v4 offset:34560
    s_waitcnt lgkmcnt(6)
    v_mfma_f32_16x16x32_bf16 v[112:115], v[228:231], v[56:59], v[112:115]
    ds_read_b64_tr_b16 v[244:245], v5 offset:33568
    v_mfma_f32_16x16x32_bf16 v[116:119], v[228:231], v[60:63], v[116:119]
    ds_read_b64_tr_b16 v[246:247], v5 offset:34592
    s_waitcnt lgkmcnt(6)
    v_mfma_f32_16x16x32_bf16 v[120:123], v[232:235], v[56:59], v[120:123]
    v_mfma_f32_16x16x32_bf16 v[124:127], v[232:235], v[60:63], v[124:127]
    s_waitcnt vmcnt(12)
    s_barrier
    ds_read_b64_tr_b16 v[224:225], v4 offset:49152
    ds_read_b64_tr_b16 v[226:227], v4 offset:50176
    s_waitcnt lgkmcnt(6)
    v_mfma_f32_16x16x32_bf16 v[128:131], v[236:239], v[56:59], v[128:131]
    ds_read_b64_tr_b16 v[228:229], v5 offset:49184
    s_mov_b32 s23, 0x4000
    buffer_load_dwordx4 v[48:51], v6, s[8:11], s23 offen offset:2048 sc1
    v_mfma_f32_16x16x32_bf16 v[132:135], v[236:239], v[60:63], v[132:135]
    ds_read_b64_tr_b16 v[230:231], v5 offset:50208
    s_waitcnt lgkmcnt(6)
    v_mfma_f32_16x16x32_bf16 v[136:139], v[240:243], v[56:59], v[136:139]
    ds_read_b64_tr_b16 v[232:233], v4 offset:49408
    v_mfma_f32_16x16x32_bf16 v[140:143], v[240:243], v[60:63], v[140:143]
    ds_read_b64_tr_b16 v[234:235], v4 offset:50432
    s_mov_b32 s23, 0x24000
    buffer_load_dwordx4 v[52:55], v6, s[8:11], s23 offen offset:2048 sc1
    s_waitcnt lgkmcnt(6)
    v_mfma_f32_16x16x32_bf16 v[144:147], v[244:247], v[56:59], v[144:147]
    ds_read_b64_tr_b16 v[236:237], v5 offset:49440
    v_mfma_f32_16x16x32_bf16 v[148:151], v[244:247], v[60:63], v[148:151]
    ds_read_b64_tr_b16 v[238:239], v5 offset:50464
    s_waitcnt vmcnt(13) lgkmcnt(6)
    v_mfma_f32_16x16x32_bf16 v[88:91], v[224:227], v[24:27], v[88:91]
    ds_read_b64_tr_b16 v[240:241], v4 offset:49664
    s_waitcnt vmcnt(12)
    v_mfma_f32_16x16x32_bf16 v[92:95], v[224:227], v[28:31], v[92:95]
    s_add_u32 s22, s24, 0x1a0000
    s_add_u32 m0, s20, 0x14000
    s_nop 0
    buffer_load_dwordx4 v3, s[4:7], s22 offen lds
    ds_read_b64_tr_b16 v[242:243], v4 offset:50688
    s_waitcnt lgkmcnt(6)
    v_mfma_f32_16x16x32_bf16 v[96:99], v[228:231], v[24:27], v[96:99]
    ds_read_b64_tr_b16 v[244:245], v5 offset:49696
    v_mfma_f32_16x16x32_bf16 v[100:103], v[228:231], v[28:31], v[100:103]
    ds_read_b64_tr_b16 v[246:247], v5 offset:50720
    s_waitcnt lgkmcnt(6)
    v_mfma_f32_16x16x32_bf16 v[104:107], v[232:235], v[24:27], v[104:107]
    s_add_u32 s22, s24, 0x1a2000
    s_add_u32 m0, s20, 0x14400
    s_nop 0
    buffer_load_dwordx4 v3, s[4:7], s22 offen lds
    ds_read_b64_tr_b16 v[224:225], v4 offset:49920
    v_mfma_f32_16x16x32_bf16 v[108:111], v[232:235], v[28:31], v[108:111]
    ds_read_b64_tr_b16 v[226:227], v4 offset:50944
    s_waitcnt lgkmcnt(6)
    v_mfma_f32_16x16x32_bf16 v[112:115], v[236:239], v[24:27], v[112:115]
    ds_read_b64_tr_b16 v[228:229], v5 offset:49952
    v_mfma_f32_16x16x32_bf16 v[116:119], v[236:239], v[28:31], v[116:119]
    ds_read_b64_tr_b16 v[230:231], v5 offset:50976
    s_waitcnt lgkmcnt(6)
    v_mfma_f32_16x16x32_bf16 v[120:123], v[240:243], v[24:27], v[120:123]
    v_mfma_f32_16x16x32_bf16 v[124:127], v[240:243], v[28:31], v[124:127]
    s_waitcnt vmcnt(12)
    s_barrier
    ds_read_b64_tr_b16 v[232:233], v7 offset:0
    ds_read_b64_tr_b16 v[234:235], v7 offset:1024
    s_waitcnt lgkmcnt(6)
    v_mfma_f32_16x16x32_bf16 v[128:131], v[244:247], v[24:27], v[128:131]
    ds_read_b64_tr_b16 v[236:237], v8 offset:32
    s_mov_b32 s23, 0x6000
    buffer_load_dwordx4 v[56:59], v6, s[8:11], s23 offen offset:2048 sc1
    v_mfma_f32_16x16x32_bf16 v[132:135], v[244:247], v[28:31], v[132:135]
    ds_read_b64_tr_b16 v[238:239], v8 offset:1056
    s_waitcnt lgkmcnt(6)
    v_mfma_f32_16x16x32_bf16 v[136:139], v[224:227], v[24:27], v[136:139]
    ds_read_b64_tr_b16 v[240:241], v7 offset:256
    v_mfma_f32_16x16x32_bf16 v[140:143], v[224:227], v[28:31], v[140:143]
    ds_read_b64_tr_b16 v[242:243], v7 offset:1280
    s_mov_b32 s23, 0x26000
    buffer_load_dwordx4 v[60:63], v6, s[8:11], s23 offen offset:2048 sc1
    s_waitcnt lgkmcnt(6)
    v_mfma_f32_16x16x32_bf16 v[144:147], v[228:231], v[24:27], v[144:147]
    ds_read_b64_tr_b16 v[244:245], v8 offset:288
    v_mfma_f32_16x16x32_bf16 v[148:151], v[228:231], v[28:31], v[148:151]
    ds_read_b64_tr_b16 v[246:247], v8 offset:1312
    s_waitcnt vmcnt(13) lgkmcnt(6)
    v_mfma_f32_16x16x32_bf16 v[88:91], v[232:235], v[32:35], v[88:91]
    ds_read_b64_tr_b16 v[224:225], v7 offset:512
    s_waitcnt vmcnt(12)
    v_mfma_f32_16x16x32_bf16 v[92:95], v[232:235], v[36:39], v[92:95]
    s_add_u32 s22, s24, 0x220000
    s_add_u32 m0, s20, 0x18000
    s_nop 0
    buffer_load_dwordx4 v3, s[4:7], s22 offen lds
    ds_read_b64_tr_b16 v[226:227], v7 offset:1536
    s_waitcnt lgkmcnt(6)
    v_mfma_f32_16x16x32_bf16 v[96:99], v[236:239], v[32:35], v[96:99]
    ds_read_b64_tr_b16 v[228:229], v8 offset:544
    v_mfma_f32_16x16x32_bf16 v[100:103], v[236:239], v[36:39], v[100:103]
    ds_read_b64_tr_b16 v[230:231], v8 offset:1568
    s_waitcnt lgkmcnt(6)
    v_mfma_f32_16x16x32_bf16 v[104:107], v[240:243], v[32:35], v[104:107]
    s_add_u32 s22, s24, 0x222000
    s_add_u32 m0, s20, 0x18400
    s_nop 0
    buffer_load_dwordx4 v3, s[4:7], s22 offen lds
    ds_read_b64_tr_b16 v[232:233], v7 offset:768
    v_mfma_f32_16x16x32_bf16 v[108:111], v[240:243], v[36:39], v[108:111]
    ds_read_b64_tr_b16 v[234:235], v7 offset:1792
    s_waitcnt lgkmcnt(6)
    v_mfma_f32_16x16x32_bf16 v[112:115], v[244:247], v[32:35], v[112:115]
    ds_read_b64_tr_b16 v[236:237], v8 offset:800
    v_mfma_f32_16x16x32_bf16 v[116:119], v[244:247], v[36:39], v[116:119]
    ds_read_b64_tr_b16 v[238:239], v8 offset:1824
    s_waitcnt lgkmcnt(6)
    v_mfma_f32_16x16x32_bf16 v[120:123], v[224:227], v[32:35], v[120:123]
    v_mfma_f32_16x16x32_bf16 v[124:127], v[224:227], v[36:39], v[124:127]
    s_waitcnt vmcnt(12)
    s_barrier
    ds_read_b64_tr_b16 v[240:241], v7 offset:16384
    ds_read_b64_tr_b16 v[242:243], v7 offset:17408
    s_waitcnt lgkmcnt(6)
    v_mfma_f32_16x16x32_bf16 v[128:131], v[228:231], v[32:35], v[128:131]
    ds_read_b64_tr_b16 v[244:245], v8 offset:16416
    s_mov_b32 s23, 0x8000
    buffer_load_dwordx4 v[24:27], v6, s[8:11], s23 offen offset:2048 sc1
    v_mfma_f32_16x16x32_bf16 v[132:135], v[228:231], v[36:39], v[132:135]
    ds_read_b64_tr_b16 v[246:247], v8 offset:17440
    s_waitcnt lgkmcnt(6)
    v_mfma_f32_16x16x32_bf16 v[136:139], v[232:235], v[32:35], v[136:139]
    ds_read_b64_tr_b16 v[224:225], v7 offset:16640
    v_mfma_f32_16x16x32_bf16 v[140:143], v[232:235], v[36:39], v[140:143]
    ds_read_b64_tr_b16 v[226:227], v7 offset:17664
    s_mov_b32 s23, 0x28000
    buffer_load_dwordx4 v[28:31], v6, s[8:11], s23 offen offset:2048 sc1
    s_waitcnt lgkmcnt(6)
    v_mfma_f32_16x16x32_bf16 v[144:147], v[236:239], v[32:35], v[144:147]
    ds_read_b64_tr_b16 v[228:229], v8 offset:16672
    v_mfma_f32_16x16x32_bf16 v[148:151], v[236:239], v[36:39], v[148:151]
    ds_read_b64_tr_b16 v[230:231], v8 offset:17696
    s_waitcnt vmcnt(13) lgkmcnt(6)
    v_mfma_f32_16x16x32_bf16 v[88:91], v[240:243], v[40:43], v[88:91]
    ds_read_b64_tr_b16 v[232:233], v7 offset:16896
    s_waitcnt vmcnt(12)
    v_mfma_f32_16x16x32_bf16 v[92:95], v[240:243], v[44:47], v[92:95]
    s_add_u32 s22, s24, 0x2a0000
    s_add_u32 m0, s20, 0x1c000
    s_nop 0
    buffer_load_dwordx4 v3, s[4:7], s22 offen lds
    ds_read_b64_tr_b16 v[234:235], v7 offset:17920
    s_waitcnt lgkmcnt(6)
    v_mfma_f32_16x16x32_bf16 v[96:99], v[244:247], v[40:43], v[96:99]
    ds_read_b64_tr_b16 v[236:237], v8 offset:16928
    v_mfma_f32_16x16x32_bf16 v[100:103], v[244:247], v[44:47], v[100:103]
    ds_read_b64_tr_b16 v[238:239], v8 offset:17952
    s_waitcnt lgkmcnt(6)
    v_mfma_f32_16x16x32_bf16 v[104:107], v[224:227], v[40:43], v[104:107]
    s_add_u32 s22, s24, 0x2a2000
    s_add_u32 m0, s20, 0x1c400
    s_nop 0
    buffer_load_dwordx4 v3, s[4:7], s22 offen lds
    ds_read_b64_tr_b16 v[240:241], v7 offset:17152
    v_mfma_f32_16x16x32_bf16 v[108:111], v[224:227], v[44:47], v[108:111]
    ds_read_b64_tr_b16 v[242:243], v7 offset:18176
    s_waitcnt lgkmcnt(6)
    v_mfma_f32_16x16x32_bf16 v[112:115], v[228:231], v[40:43], v[112:115]
    ds_read_b64_tr_b16 v[244:245], v8 offset:17184
    v_mfma_f32_16x16x32_bf16 v[116:119], v[228:231], v[44:47], v[116:119]
    ds_read_b64_tr_b16 v[246:247], v8 offset:18208
    s_waitcnt lgkmcnt(6)
    v_mfma_f32_16x16x32_bf16 v[120:123], v[232:235], v[40:43], v[120:123]
    v_mfma_f32_16x16x32_bf16 v[124:127], v[232:235], v[44:47], v[124:127]
    s_waitcnt vmcnt(12)
    s_barrier
    ds_read_b64_tr_b16 v[224:225], v4 offset:0
    ds_read_b64_tr_b16 v[226:227], v4 offset:1024
    s_waitcnt lgkmcnt(6)
    v_mfma_f32_16x16x32_bf16 v[128:131], v[236:239], v[40:43], v[128:131]
    ds_read_b64_tr_b16 v[228:229], v5 offset:32
    s_mov_b32 s23, 0xa000
    buffer_load_dwordx4 v[32:35], v6, s[8:11], s23 offen offset:2048 sc1
    v_mfma_f32_16x16x32_bf16 v[132:135], v[236:239], v[44:47], v[132:135]
    ds_read_b64_tr_b16 v[230:231], v5 offset:1056
    s_waitcnt lgkmcnt(6)
    v_mfma_f32_16x16x32_bf16 v[136:139], v[240:243], v[40:43], v[136:139]
    ds_read_b64_tr_b16 v[232:233], v4 offset:256
    v_mfma_f32_16x16x32_bf16 v[140:143], v[240:243], v[44:47], v[140:143]
    ds_read_b64_tr_b16 v[234:235], v4 offset:1280
    s_mov_b32 s23, 0x2a000
    buffer_load_dwordx4 v[36:39], v6, s[8:11], s23 offen offset:2048 sc1
    s_waitcnt lgkmcnt(6)
    v_mfma_f32_16x16x32_bf16 v[144:147], v[244:247], v[40:43], v[144:147]
    ds_read_b64_tr_b16 v[236:237], v5 offset:288
    v_mfma_f32_16x16x32_bf16 v[148:151], v[244:247], v[44:47], v[148:151]
    ds_read_b64_tr_b16 v[238:239], v5 offset:1312
    s_waitcnt vmcnt(13) lgkmcnt(6)
    v_mfma_f32_16x16x32_bf16 v[88:91], v[224:227], v[48:51], v[88:91]
    ds_read_b64_tr_b16 v[240:241], v4 offset:512
    s_waitcnt vmcnt(12)
    v_mfma_f32_16x16x32_bf16 v[92:95], v[224:227], v[52:55], v[92:95]
    s_add_u32 s22, s24, 0x320000
    s_add_u32 m0, s20, 0x20000
    s_nop 0
    buffer_load_dwordx4 v3, s[4:7], s22 offen lds
    ds_read_b64_tr_b16 v[242:243], v4 offset:1536
    s_waitcnt lgkmcnt(6)
    v_mfma_f32_16x16x32_bf16 v[96:99], v[228:231], v[48:51], v[96:99]
    ds_read_b64_tr_b16 v[244:245], v5 offset:544
    v_mfma_f32_16x16x32_bf16 v[100:103], v[228:231], v[52:55], v[100:103]
    ds_read_b64_tr_b16 v[246:247], v5 offset:1568
    s_waitcnt lgkmcnt(6)
    v_mfma_f32_16x16x32_bf16 v[104:107], v[232:235], v[48:51], v[104:107]
    s_add_u32 s22, s24, 0x322000
    s_add_u32 m0, s20, 0x20400
    s_nop 0
    buffer_load_dwordx4 v3, s[4:7], s22 offen lds
    ds_read_b64_tr_b16 v[224:225], v4 offset:768
    v_mfma_f32_16x16x32_bf16 v[108:111], v[232:235], v[52:55], v[108:111]
    ds_read_b64_tr_b16 v[226:227], v4 offset:1792
    s_waitcnt lgkmcnt(6)
    v_mfma_f32_16x16x32_bf16 v[112:115], v[236:239], v[48:51], v[112:115]
    ds_read_b64_tr_b16 v[228:229], v5 offset:800
    v_mfma_f32_16x16x32_bf16 v[116:119], v[236:239], v[52:55], v[116:119]
    ds_read_b64_tr_b16 v[230:231], v5 offset:1824
    s_waitcnt lgkmcnt(6)
    v_mfma_f32_16x16x32_bf16 v[120:123], v[240:243], v[48:51], v[120:123]
    v_mfma_f32_16x16x32_bf16 v[124:127], v[240:243], v[52:55], v[124:127]
    s_waitcnt vmcnt(12)
    s_barrier
    ds_read_b64_tr_b16 v[232:233], v4 offset:16384
    ds_read_b64_tr_b16 v[234:235], v4 offset:17408
    s_add_u32 s19, s19, 8192
    buffer_load_dword v12, v13, s[8:11], s19 offen sc1
    s_waitcnt lgkmcnt(6)
    v_mfma_f32_16x16x32_bf16 v[128:131], v[244:247], v[48:51], v[128:131]
    ds_read_b64_tr_b16 v[236:237], v5 offset:16416
    s_mov_b32 s23, 0xc000
    buffer_load_dwordx4 v[40:43], v6, s[8:11], s23 offen offset:2048 sc1
    v_mfma_f32_16x16x32_bf16 v[132:135], v[244:247], v[52:55], v[132:135]
    ds_read_b64_tr_b16 v[238:239], v5 offset:17440
    s_waitcnt lgkmcnt(6)
    v_mfma_f32_16x16x32_bf16 v[136:139], v[224:227], v[48:51], v[136:139]
    ds_read_b64_tr_b16 v[240:241], v4 offset:16640
    v_mfma_f32_16x16x32_bf16 v[140:143], v[224:227], v[52:55], v[140:143]
    ds_read_b64_tr_b16 v[242:243], v4 offset:17664
    s_mov_b32 s23, 0x2c000
    buffer_load_dwordx4 v[44:47], v6, s[8:11], s23 offen offset:2048 sc1
    s_waitcnt lgkmcnt(6)
    v_mfma_f32_16x16x32_bf16 v[144:147], v[228:231], v[48:51], v[144:147]
    ds_read_b64_tr_b16 v[244:245], v5 offset:16672
    v_mfma_f32_16x16x32_bf16 v[148:151], v[228:231], v[52:55], v[148:151]
    ds_read_b64_tr_b16 v[246:247], v5 offset:17696
    s_waitcnt vmcnt(14) lgkmcnt(6)
    v_mfma_f32_16x16x32_bf16 v[88:91], v[232:235], v[56:59], v[88:91]
    ds_read_b64_tr_b16 v[224:225], v4 offset:16896
    s_waitcnt vmcnt(13)
    v_mfma_f32_16x16x32_bf16 v[92:95], v[232:235], v[60:63], v[92:95]
    s_add_u32 s22, s24, 0x3a0000
    s_add_u32 m0, s20, 0x24000
    s_nop 0
    buffer_load_dwordx4 v3, s[4:7], s22 offen lds
    ds_read_b64_tr_b16 v[226:227], v4 offset:17920
    s_waitcnt lgkmcnt(6)
    v_mfma_f32_16x16x32_bf16 v[96:99], v[236:239], v[56:59], v[96:99]
    ds_read_b64_tr_b16 v[228:229], v5 offset:16928
    v_mfma_f32_16x16x32_bf16 v[100:103], v[236:239], v[60:63], v[100:103]
    ds_read_b64_tr_b16 v[230:231], v5 offset:17952
    s_waitcnt lgkmcnt(6)
    v_mfma_f32_16x16x32_bf16 v[104:107], v[240:243], v[56:59], v[104:107]
    s_add_u32 s22, s24, 0x3a2000
    s_add_u32 m0, s20, 0x24400
    s_nop 0
    buffer_load_dwordx4 v3, s[4:7], s22 offen lds
    ds_read_b64_tr_b16 v[232:233], v4 offset:17152
    v_mfma_f32_16x16x32_bf16 v[108:111], v[240:243], v[60:63], v[108:111]
    ds_read_b64_tr_b16 v[234:235], v4 offset:18176
    s_waitcnt lgkmcnt(6)
    v_mfma_f32_16x16x32_bf16 v[112:115], v[244:247], v[56:59], v[112:115]
    ds_read_b64_tr_b16 v[236:237], v5 offset:17184
    v_mfma_f32_16x16x32_bf16 v[116:119], v[244:247], v[60:63], v[116:119]
    ds_read_b64_tr_b16 v[238:239], v5 offset:18208
    s_waitcnt lgkmcnt(6)
    v_mfma_f32_16x16x32_bf16 v[120:123], v[224:227], v[56:59], v[120:123]
    v_mfma_f32_16x16x32_bf16 v[124:127], v[224:227], v[60:63], v[124:127]
    s_waitcnt vmcnt(13)
    s_barrier
    ds_read_b64_tr_b16 v[240:241], v4 offset:32768
    ds_read_b64_tr_b16 v[242:243], v4 offset:33792
    s_waitcnt lgkmcnt(6)
    v_mfma_f32_16x16x32_bf16 v[128:131], v[228:231], v[56:59], v[128:131]
    ds_read_b64_tr_b16 v[244:245], v5 offset:32800
    s_mov_b32 s23, 0xe000
    buffer_load_dwordx4 v[48:51], v6, s[8:11], s23 offen offset:2048 sc1
    v_mfma_f32_16x16x32_bf16 v[132:135], v[228:231], v[60:63], v[132:135]
    ds_read_b64_tr_b16 v[246:247], v5 offset:33824
    s_waitcnt lgkmcnt(6)
    v_mfma_f32_16x16x32_bf16 v[136:139], v[232:235], v[56:59], v[136:139]
    ds_read_b64_tr_b16 v[224:225], v4 offset:33024
    v_mfma_f32_16x16x32_bf16 v[140:143], v[232:235], v[60:63], v[140:143]
    ds_read_b64_tr_b16 v[226:227], v4 offset:34048
    s_mov_b32 s23, 0x2e000
    buffer_load_dwordx4 v[52:55], v6, s[8:11], s23 offen offset:2048 sc1
    s_waitcnt lgkmcnt(6)
    v_mfma_f32_16x16x32_bf16 v[144:147], v[236:239], v[56:59], v[144:147]
    ds_read_b64_tr_b16 v[228:229], v5 offset:33056
    v_mfma_f32_16x16x32_bf16 v[148:151], v[236:239], v[60:63], v[148:151]
    ds_read_b64_tr_b16 v[230:231], v5 offset:34080
    s_waitcnt vmcnt(6)
    v_cmp_ne_u32 vcc, s28, v12
    s_cbranch_vccnz adaLN_cond__sliding_block_cached__moe_arch_mod__prompt_kernel_o220r
adaLN_cond__sliding_block_cached__moe_arch_mod__prompt_kernel_o220b:
    s_waitcnt lgkmcnt(6)
    v_mfma_f32_16x16x32_bf16 v[88:91], v[240:243], v[24:27], v[88:91]
    ds_read_b64_tr_b16 v[232:233], v4 offset:33280
    v_mfma_f32_16x16x32_bf16 v[92:95], v[240:243], v[28:31], v[92:95]
    s_add_u32 s22, s24, 0x30000
    s_add_u32 m0, s20, 0x10000
    s_nop 0
    buffer_load_dwordx4 v3, s[4:7], s22 offen lds
    ds_read_b64_tr_b16 v[234:235], v4 offset:34304
    s_waitcnt lgkmcnt(6)
    v_mfma_f32_16x16x32_bf16 v[96:99], v[244:247], v[24:27], v[96:99]
    ds_read_b64_tr_b16 v[236:237], v5 offset:33312
    v_mfma_f32_16x16x32_bf16 v[100:103], v[244:247], v[28:31], v[100:103]
    ds_read_b64_tr_b16 v[238:239], v5 offset:34336
    s_waitcnt lgkmcnt(6)
    v_mfma_f32_16x16x32_bf16 v[104:107], v[224:227], v[24:27], v[104:107]
    s_add_u32 s22, s24, 0x32000
    s_add_u32 m0, s20, 0x10400
    s_nop 0
    buffer_load_dwordx4 v3, s[4:7], s22 offen lds
    ds_read_b64_tr_b16 v[240:241], v4 offset:33536
    v_mfma_f32_16x16x32_bf16 v[108:111], v[224:227], v[28:31], v[108:111]
    ds_read_b64_tr_b16 v[242:243], v4 offset:34560
    s_waitcnt lgkmcnt(6)
    v_mfma_f32_16x16x32_bf16 v[112:115], v[228:231], v[24:27], v[112:115]
    ds_read_b64_tr_b16 v[244:245], v5 offset:33568
    v_mfma_f32_16x16x32_bf16 v[116:119], v[228:231], v[28:31], v[116:119]
    ds_read_b64_tr_b16 v[246:247], v5 offset:34592
    s_waitcnt lgkmcnt(6)
    v_mfma_f32_16x16x32_bf16 v[120:123], v[232:235], v[24:27], v[120:123]
    v_mfma_f32_16x16x32_bf16 v[124:127], v[232:235], v[28:31], v[124:127]
    s_barrier
    ds_read_b64_tr_b16 v[224:225], v4 offset:49152
    ds_read_b64_tr_b16 v[226:227], v4 offset:50176
    s_waitcnt lgkmcnt(6)
    v_mfma_f32_16x16x32_bf16 v[128:131], v[236:239], v[24:27], v[128:131]
    ds_read_b64_tr_b16 v[228:229], v5 offset:49184
    s_mov_b32 s23, 0x0
    buffer_load_dwordx4 v[56:59], v6, s[8:11], s23 offen offset:3072 sc1
    v_mfma_f32_16x16x32_bf16 v[132:135], v[236:239], v[28:31], v[132:135]
    ds_read_b64_tr_b16 v[230:231], v5 offset:50208
    s_waitcnt lgkmcnt(6)
    v_mfma_f32_16x16x32_bf16 v[136:139], v[240:243], v[24:27], v[136:139]
    ds_read_b64_tr_b16 v[232:233], v4 offset:49408
    v_mfma_f32_16x16x32_bf16 v[140:143], v[240:243], v[28:31], v[140:143]
    ds_read_b64_tr_b16 v[234:235], v4 offset:50432
    s_mov_b32 s23, 0x20000
    buffer_load_dwordx4 v[60:63], v6, s[8:11], s23 offen offset:3072 sc1
    s_waitcnt lgkmcnt(6)
    v_mfma_f32_16x16x32_bf16 v[144:147], v[244:247], v[24:27], v[144:147]
    ds_read_b64_tr_b16 v[236:237], v5 offset:49440
    v_mfma_f32_16x16x32_bf16 v[148:151], v[244:247], v[28:31], v[148:151]
    ds_read_b64_tr_b16 v[238:239], v5 offset:50464
    s_waitcnt lgkmcnt(6)
    v_mfma_f32_16x16x32_bf16 v[88:91], v[224:227], v[32:35], v[88:91]
    ds_read_b64_tr_b16 v[240:241], v4 offset:49664
    v_mfma_f32_16x16x32_bf16 v[92:95], v[224:227], v[36:39], v[92:95]
    s_add_u32 s22, s24, 0xb0000
    s_add_u32 m0, s20, 0x14000
    s_nop 0
    buffer_load_dwordx4 v3, s[4:7], s22 offen lds
    ds_read_b64_tr_b16 v[242:243], v4 offset:50688
    s_waitcnt lgkmcnt(6)
    v_mfma_f32_16x16x32_bf16 v[96:99], v[228:231], v[32:35], v[96:99]
    ds_read_b64_tr_b16 v[244:245], v5 offset:49696
    v_mfma_f32_16x16x32_bf16 v[100:103], v[228:231], v[36:39], v[100:103]
    ds_read_b64_tr_b16 v[246:247], v5 offset:50720
    s_waitcnt lgkmcnt(6)
    v_mfma_f32_16x16x32_bf16 v[104:107], v[232:235], v[32:35], v[104:107]
    s_add_u32 s22, s24, 0xb2000
    s_add_u32 m0, s20, 0x14400
    s_nop 0
    buffer_load_dwordx4 v3, s[4:7], s22 offen lds
    ds_read_b64_tr_b16 v[224:225], v4 offset:49920
    v_mfma_f32_16x16x32_bf16 v[108:111], v[232:235], v[36:39], v[108:111]
    ds_read_b64_tr_b16 v[226:227], v4 offset:50944
    s_waitcnt lgkmcnt(6)
    v_mfma_f32_16x16x32_bf16 v[112:115], v[236:239], v[32:35], v[112:115]
    ds_read_b64_tr_b16 v[228:229], v5 offset:49952
    v_mfma_f32_16x16x32_bf16 v[116:119], v[236:239], v[36:39], v[116:119]
    ds_read_b64_tr_b16 v[230:231], v5 offset:50976
    s_waitcnt lgkmcnt(6)
    v_mfma_f32_16x16x32_bf16 v[120:123], v[240:243], v[32:35], v[120:123]
    v_mfma_f32_16x16x32_bf16 v[124:127], v[240:243], v[36:39], v[124:127]
    s_barrier
    ds_read_b64_tr_b16 v[232:233], v7 offset:0
    ds_read_b64_tr_b16 v[234:235], v7 offset:1024
    s_waitcnt lgkmcnt(6)
    v_mfma_f32_16x16x32_bf16 v[128:131], v[244:247], v[32:35], v[128:131]
    ds_read_b64_tr_b16 v[236:237], v8 offset:32
    s_mov_b32 s23, 0x2000
    buffer_load_dwordx4 v[24:27], v6, s[8:11], s23 offen offset:3072 sc1
    v_mfma_f32_16x16x32_bf16 v[132:135], v[244:247], v[36:39], v[132:135]
    ds_read_b64_tr_b16 v[238:239], v8 offset:1056
    s_waitcnt lgkmcnt(6)
    v_mfma_f32_16x16x32_bf16 v[136:139], v[224:227], v[32:35], v[136:139]
    ds_read_b64_tr_b16 v[240:241], v7 offset:256
    v_mfma_f32_16x16x32_bf16 v[140:143], v[224:227], v[36:39], v[140:143]
    ds_read_b64_tr_b16 v[242:243], v7 offset:1280
    s_mov_b32 s23, 0x22000
    buffer_load_dwordx4 v[28:31], v6, s[8:11], s23 offen offset:3072 sc1
    s_waitcnt lgkmcnt(6)
    v_mfma_f32_16x16x32_bf16 v[144:147], v[228:231], v[32:35], v[144:147]
    ds_read_b64_tr_b16 v[244:245], v8 offset:288
    v_mfma_f32_16x16x32_bf16 v[148:151], v[228:231], v[36:39], v[148:151]
    ds_read_b64_tr_b16 v[246:247], v8 offset:1312
    s_waitcnt vmcnt(13) lgkmcnt(6)
    v_mfma_f32_16x16x32_bf16 v[88:91], v[232:235], v[40:43], v[88:91]
    ds_read_b64_tr_b16 v[224:225], v7 offset:512
    s_waitcnt vmcnt(12)
    v_mfma_f32_16x16x32_bf16 v[92:95], v[232:235], v[44:47], v[92:95]
    s_add_u32 s22, s24, 0x130000
    s_add_u32 m0, s20, 0x18000
    s_nop 0
    buffer_load_dwordx4 v3, s[4:7], s22 offen lds
    ds_read_b64_tr_b16 v[226:227], v7 offset:1536
    s_waitcnt lgkmcnt(6)
    v_mfma_f32_16x16x32_bf16 v[96:99], v[236:239], v[40:43], v[96:99]
    ds_read_b64_tr_b16 v[228:229], v8 offset:544
    v_mfma_f32_16x16x32_bf16 v[100:103], v[236:239], v[44:47], v[100:103]
    ds_read_b64_tr_b16 v[230:231], v8 offset:1568
    s_waitcnt lgkmcnt(6)
    v_mfma_f32_16x16x32_bf16 v[104:107], v[240:243], v[40:43], v[104:107]
    s_add_u32 s22, s24, 0x132000
    s_add_u32 m0, s20, 0x18400
    s_nop 0
    buffer_load_dwordx4 v3, s[4:7], s22 offen lds
    ds_read_b64_tr_b16 v[232:233], v7 offset:768
    v_mfma_f32_16x16x32_bf16 v[108:111], v[240:243], v[44:47], v[108:111]
    ds_read_b64_tr_b16 v[234:235], v7 offset:1792
    s_waitcnt lgkmcnt(6)
    v_mfma_f32_16x16x32_bf16 v[112:115], v[244:247], v[40:43], v[112:115]
    ds_read_b64_tr_b16 v[236:237], v8 offset:800
    v_mfma_f32_16x16x32_bf16 v[116:119], v[244:247], v[44:47], v[116:119]
    ds_read_b64_tr_b16 v[238:239], v8 offset:1824
    s_waitcnt lgkmcnt(6)
    v_mfma_f32_16x16x32_bf16 v[120:123], v[224:227], v[40:43], v[120:123]
    v_mfma_f32_16x16x32_bf16 v[124:127], v[224:227], v[44:47], v[124:127]
    s_waitcnt vmcnt(12)
    s_barrier
    ds_read_b64_tr_b16 v[240:241], v7 offset:16384
    ds_read_b64_tr_b16 v[242:243], v7 offset:17408
    s_waitcnt lgkmcnt(6)
    v_mfma_f32_16x16x32_bf16 v[128:131], v[228:231], v[40:43], v[128:131]
    ds_read_b64_tr_b16 v[244:245], v8 offset:16416
    s_mov_b32 s23, 0x4000
    buffer_load_dwordx4 v[32:35], v6, s[8:11], s23 offen offset:3072 sc1
    v_mfma_f32_16x16x32_bf16 v[132:135], v[228:231], v[44:47], v[132:135]
    ds_read_b64_tr_b16 v[246:247], v8 offset:17440
    s_waitcnt lgkmcnt(6)
    v_mfma_f32_16x16x32_bf16 v[136:139], v[232:235], v[40:43], v[136:139]
    ds_read_b64_tr_b16 v[224:225], v7 offset:16640
    v_mfma_f32_16x16x32_bf16 v[140:143], v[232:235], v[44:47], v[140:143]
    ds_read_b64_tr_b16 v[226:227], v7 offset:17664
    s_mov_b32 s23, 0x24000
    buffer_load_dwordx4 v[36:39], v6, s[8:11], s23 offen offset:3072 sc1
    s_waitcnt lgkmcnt(6)
    v_mfma_f32_16x16x32_bf16 v[144:147], v[236:239], v[40:43], v[144:147]
    ds_read_b64_tr_b16 v[228:229], v8 offset:16672
    v_mfma_f32_16x16x32_bf16 v[148:151], v[236:239], v[44:47], v[148:151]
    ds_read_b64_tr_b16 v[230:231], v8 offset:17696
    s_waitcnt vmcnt(13) lgkmcnt(6)
    v_mfma_f32_16x16x32_bf16 v[88:91], v[240:243], v[48:51], v[88:91]
    ds_read_b64_tr_b16 v[232:233], v7 offset:16896
    s_waitcnt vmcnt(12)
    v_mfma_f32_16x16x32_bf16 v[92:95], v[240:243], v[52:55], v[92:95]
    s_add_u32 s22, s24, 0x1b0000
    s_add_u32 m0, s20, 0x1c000
    s_nop 0
    buffer_load_dwordx4 v3, s[4:7], s22 offen lds
    ds_read_b64_tr_b16 v[234:235], v7 offset:17920
    s_waitcnt lgkmcnt(6)
    v_mfma_f32_16x16x32_bf16 v[96:99], v[244:247], v[48:51], v[96:99]
    ds_read_b64_tr_b16 v[236:237], v8 offset:16928
    v_mfma_f32_16x16x32_bf16 v[100:103], v[244:247], v[52:55], v[100:103]
    ds_read_b64_tr_b16 v[238:239], v8 offset:17952
    s_waitcnt lgkmcnt(6)
    v_mfma_f32_16x16x32_bf16 v[104:107], v[224:227], v[48:51], v[104:107]
    s_add_u32 s22, s24, 0x1b2000
    s_add_u32 m0, s20, 0x1c400
    s_nop 0
    buffer_load_dwordx4 v3, s[4:7], s22 offen lds
    ds_read_b64_tr_b16 v[240:241], v7 offset:17152
    v_mfma_f32_16x16x32_bf16 v[108:111], v[224:227], v[52:55], v[108:111]
    ds_read_b64_tr_b16 v[242:243], v7 offset:18176
    s_waitcnt lgkmcnt(6)
    v_mfma_f32_16x16x32_bf16 v[112:115], v[228:231], v[48:51], v[112:115]
    ds_read_b64_tr_b16 v[244:245], v8 offset:17184
    v_mfma_f32_16x16x32_bf16 v[116:119], v[228:231], v[52:55], v[116:119]
    ds_read_b64_tr_b16 v[246:247], v8 offset:18208
    s_waitcnt lgkmcnt(6)
    v_mfma_f32_16x16x32_bf16 v[120:123], v[232:235], v[48:51], v[120:123]
    v_mfma_f32_16x16x32_bf16 v[124:127], v[232:235], v[52:55], v[124:127]
    s_waitcnt vmcnt(12)
    s_barrier
    ds_read_b64_tr_b16 v[224:225], v4 offset:0
    ds_read_b64_tr_b16 v[226:227], v4 offset:1024
    s_waitcnt lgkmcnt(6)
    v_mfma_f32_16x16x32_bf16 v[128:131], v[236:239], v[48:51], v[128:131]
    ds_read_b64_tr_b16 v[228:229], v5 offset:32
    s_mov_b32 s23, 0x6000
    buffer_load_dwordx4 v[40:43], v6, s[8:11], s23 offen offset:3072 sc1
    v_mfma_f32_16x16x32_bf16 v[132:135], v[236:239], v[52:55], v[132:135]
    ds_read_b64_tr_b16 v[230:231], v5 offset:1056
    s_waitcnt lgkmcnt(6)
    v_mfma_f32_16x16x32_bf16 v[136:139], v[240:243], v[48:51], v[136:139]
    ds_read_b64_tr_b16 v[232:233], v4 offset:256
    v_mfma_f32_16x16x32_bf16 v[140:143], v[240:243], v[52:55], v[140:143]
    ds_read_b64_tr_b16 v[234:235], v4 offset:1280
    s_mov_b32 s23, 0x26000
    buffer_load_dwordx4 v[44:47], v6, s[8:11], s23 offen offset:3072 sc1
    s_waitcnt lgkmcnt(6)
    v_mfma_f32_16x16x32_bf16 v[144:147], v[244:247], v[48:51], v[144:147]
    ds_read_b64_tr_b16 v[236:237], v5 offset:288
    v_mfma_f32_16x16x32_bf16 v[148:151], v[244:247], v[52:55], v[148:151]
    ds_read_b64_tr_b16 v[238:239], v5 offset:1312
    s_waitcnt vmcnt(13) lgkmcnt(6)
    v_mfma_f32_16x16x32_bf16 v[88:91], v[224:227], v[56:59], v[88:91]
    ds_read_b64_tr_b16 v[240:241], v4 offset:512
    s_waitcnt vmcnt(12)
    v_mfma_f32_16x16x32_bf16 v[92:95], v[224:227], v[60:63], v[92:95]
    s_add_u32 s22, s24, 0x230000
    s_add_u32 m0, s20, 0x20000
    s_nop 0
    buffer_load_dwordx4 v3, s[4:7], s22 offen lds
    ds_read_b64_tr_b16 v[242:243], v4 offset:1536
    s_waitcnt lgkmcnt(6)
    v_mfma_f32_16x16x32_bf16 v[96:99], v[228:231], v[56:59], v[96:99]
    ds_read_b64_tr_b16 v[244:245], v5 offset:544
    v_mfma_f32_16x16x32_bf16 v[100:103], v[228:231], v[60:63], v[100:103]
    ds_read_b64_tr_b16 v[246:247], v5 offset:1568
    s_waitcnt lgkmcnt(6)
    v_mfma_f32_16x16x32_bf16 v[104:107], v[232:235], v[56:59], v[104:107]
    s_add_u32 s22, s24, 0x232000
    s_add_u32 m0, s20, 0x20400
    s_nop 0
    buffer_load_dwordx4 v3, s[4:7], s22 offen lds
    ds_read_b64_tr_b16 v[224:225], v4 offset:768
    v_mfma_f32_16x16x32_bf16 v[108:111], v[232:235], v[60:63], v[108:111]
    ds_read_b64_tr_b16 v[226:227], v4 offset:1792
    s_waitcnt lgkmcnt(6)
    v_mfma_f32_16x16x32_bf16 v[112:115], v[236:239], v[56:59], v[112:115]
    ds_read_b64_tr_b16 v[228:229], v5 offset:800
    v_mfma_f32_16x16x32_bf16 v[116:119], v[236:239], v[60:63], v[116:119]
    ds_read_b64_tr_b16 v[230:231], v5 offset:1824
    s_waitcnt lgkmcnt(6)
    v_mfma_f32_16x16x32_bf16 v[120:123], v[240:243], v[56:59], v[120:123]
    v_mfma_f32_16x16x32_bf16 v[124:127], v[240:243], v[60:63], v[124:127]
    s_waitcnt vmcnt(12)
    s_barrier
    ds_read_b64_tr_b16 v[232:233], v4 offset:16384
    ds_read_b64_tr_b16 v[234:235], v4 offset:17408
    s_waitcnt lgkmcnt(6)
    v_mfma_f32_16x16x32_bf16 v[128:131], v[244:247], v[56:59], v[128:131]
    ds_read_b64_tr_b16 v[236:237], v5 offset:16416
    s_mov_b32 s23, 0x8000
    buffer_load_dwordx4 v[48:51], v6, s[8:11], s23 offen offset:3072 sc1
    v_mfma_f32_16x16x32_bf16 v[132:135], v[244:247], v[60:63], v[132:135]
    ds_read_b64_tr_b16 v[238:239], v5 offset:17440
    s_waitcnt lgkmcnt(6)
    v_mfma_f32_16x16x32_bf16 v[136:139], v[224:227], v[56:59], v[136:139]
    ds_read_b64_tr_b16 v[240:241], v4 offset:16640
    v_mfma_f32_16x16x32_bf16 v[140:143], v[224:227], v[60:63], v[140:143]
    ds_read_b64_tr_b16 v[242:243], v4 offset:17664
    s_mov_b32 s23, 0x28000
    buffer_load_dwordx4 v[52:55], v6, s[8:11], s23 offen offset:3072 sc1
    s_waitcnt lgkmcnt(6)
    v_mfma_f32_16x16x32_bf16 v[144:147], v[228:231], v[56:59], v[144:147]
    ds_read_b64_tr_b16 v[244:245], v5 offset:16672
    v_mfma_f32_16x16x32_bf16 v[148:151], v[228:231], v[60:63], v[148:151]
    ds_read_b64_tr_b16 v[246:247], v5 offset:17696
    s_waitcnt vmcnt(13) lgkmcnt(6)
    v_mfma_f32_16x16x32_bf16 v[88:91], v[232:235], v[24:27], v[88:91]
    ds_read_b64_tr_b16 v[224:225], v4 offset:16896
    s_waitcnt vmcnt(12)
    v_mfma_f32_16x16x32_bf16 v[92:95], v[232:235], v[28:31], v[92:95]
    s_add_u32 s22, s24, 0x2b0000
    s_add_u32 m0, s20, 0x24000
    s_nop 0
    buffer_load_dwordx4 v3, s[4:7], s22 offen lds
    ds_read_b64_tr_b16 v[226:227], v4 offset:17920
    s_waitcnt lgkmcnt(6)
    v_mfma_f32_16x16x32_bf16 v[96:99], v[236:239], v[24:27], v[96:99]
    ds_read_b64_tr_b16 v[228:229], v5 offset:16928
    v_mfma_f32_16x16x32_bf16 v[100:103], v[236:239], v[28:31], v[100:103]
    ds_read_b64_tr_b16 v[230:231], v5 offset:17952
    s_waitcnt lgkmcnt(6)
    v_mfma_f32_16x16x32_bf16 v[104:107], v[240:243], v[24:27], v[104:107]
    s_add_u32 s22, s24, 0x2b2000
    s_add_u32 m0, s20, 0x24400
    s_nop 0
    buffer_load_dwordx4 v3, s[4:7], s22 offen lds
    ds_read_b64_tr_b16 v[232:233], v4 offset:17152
    v_mfma_f32_16x16x32_bf16 v[108:111], v[240:243], v[28:31], v[108:111]
    ds_read_b64_tr_b16 v[234:235], v4 offset:18176
    s_mov_b32 s16, 0x544000
    buffer_load_dwordx4 v[184:187], v2, s[8:11], s16 offen sc1
    s_waitcnt lgkmcnt(6)
    v_mfma_f32_16x16x32_bf16 v[112:115], v[244:247], v[24:27], v[112:115]
    ds_read_b64_tr_b16 v[236:237], v5 offset:17184
    v_mfma_f32_16x16x32_bf16 v[116:119], v[244:247], v[28:31], v[116:119]
    ds_read_b64_tr_b16 v[238:239], v5 offset:18208
    s_waitcnt lgkmcnt(6)
    v_mfma_f32_16x16x32_bf16 v[120:123], v[224:227], v[24:27], v[120:123]
    v_mfma_f32_16x16x32_bf16 v[124:127], v[224:227], v[28:31], v[124:127]
    s_waitcnt vmcnt(13)
    s_barrier
    ds_read_b64_tr_b16 v[240:241], v4 offset:32768
    ds_read_b64_tr_b16 v[242:243], v4 offset:33792
    s_waitcnt lgkmcnt(6)
    v_mfma_f32_16x16x32_bf16 v[128:131], v[228:231], v[24:27], v[128:131]
    ds_read_b64_tr_b16 v[244:245], v5 offset:32800
    s_mov_b32 s23, 0xa000
    buffer_load_dwordx4 v[56:59], v6, s[8:11], s23 offen offset:3072 sc1
    v_mfma_f32_16x16x32_bf16 v[132:135], v[228:231], v[28:31], v[132:135]
    ds_read_b64_tr_b16 v[246:247], v5 offset:33824
    s_waitcnt lgkmcnt(6)
    v_mfma_f32_16x16x32_bf16 v[136:139], v[232:235], v[24:27], v[136:139]
    ds_read_b64_tr_b16 v[224:225], v4 offset:33024
    v_mfma_f32_16x16x32_bf16 v[140:143], v[232:235], v[28:31], v[140:143]
    ds_read_b64_tr_b16 v[226:227], v4 offset:34048
    s_mov_b32 s23, 0x2a000
    buffer_load_dwordx4 v[60:63], v6, s[8:11], s23 offen offset:3072 sc1
    s_waitcnt lgkmcnt(6)
    v_mfma_f32_16x16x32_bf16 v[144:147], v[236:239], v[24:27], v[144:147]
    ds_read_b64_tr_b16 v[228:229], v5 offset:33056
    v_mfma_f32_16x16x32_bf16 v[148:151], v[236:239], v[28:31], v[148:151]
    ds_read_b64_tr_b16 v[230:231], v5 offset:34080
    s_waitcnt vmcnt(14) lgkmcnt(6)
    v_mfma_f32_16x16x32_bf16 v[88:91], v[240:243], v[32:35], v[88:91]
    ds_read_b64_tr_b16 v[232:233], v4 offset:33280
    s_waitcnt vmcnt(13)
    v_mfma_f32_16x16x32_bf16 v[92:95], v[240:243], v[36:39], v[92:95]
    s_add_u32 s22, s24, 0x330000
    s_add_u32 m0, s20, 0x10000
    s_nop 0
    buffer_load_dwordx4 v3, s[4:7], s22 offen lds
    ds_read_b64_tr_b16 v[234:235], v4 offset:34304
    s_waitcnt lgkmcnt(6)
    v_mfma_f32_16x16x32_bf16 v[96:99], v[244:247], v[32:35], v[96:99]
    ds_read_b64_tr_b16 v[236:237], v5 offset:33312
    v_mfma_f32_16x16x32_bf16 v[100:103], v[244:247], v[36:39], v[100:103]
    ds_read_b64_tr_b16 v[238:239], v5 offset:34336
    s_waitcnt lgkmcnt(6)
    v_mfma_f32_16x16x32_bf16 v[104:107], v[224:227], v[32:35], v[104:107]
    s_add_u32 s22, s24, 0x332000
    s_add_u32 m0, s20, 0x10400
    s_nop 0
    buffer_load_dwordx4 v3, s[4:7], s22 offen lds
    ds_read_b64_tr_b16 v[240:241], v4 offset:33536
    v_mfma_f32_16x16x32_bf16 v[108:111], v[224:227], v[36:39], v[108:111]
    ds_read_b64_tr_b16 v[242:243], v4 offset:34560
    s_waitcnt vmcnt(4)
    v_xor_b32 v16, s28, v184
    v_xor_b32 v17, s28, v185
    v_xor_b32 v18, s28, v186
    v_xor_b32 v19, s28, v187
    v_or3_b32 v16, v16, v17, v18
    v_or_b32 v16, v16, v19
    v_cmp_ne_u32 vcc, 0, v16
    s_cbranch_vccnz adaLN_cond__sliding_block_cached__moe_arch_mod__prompt_kernel_mf21r
adaLN_cond__sliding_block_cached__moe_arch_mod__prompt_kernel_mf21b:
    s_waitcnt lgkmcnt(6)
    v_mfma_f32_16x16x32_bf16 v[112:115], v[228:231], v[32:35], v[112:115]
    ds_read_b64_tr_b16 v[244:245], v5 offset:33568
    v_mfma_f32_16x16x32_bf16 v[116:119], v[228:231], v[36:39], v[116:119]
    ds_read_b64_tr_b16 v[246:247], v5 offset:34592
    s_waitcnt lgkmcnt(6)
    v_mfma_f32_16x16x32_bf16 v[120:123], v[232:235], v[32:35], v[120:123]
    v_mfma_f32_16x16x32_bf16 v[124:127], v[232:235], v[36:39], v[124:127]
    s_barrier
    ds_read_b64_tr_b16 v[224:225], v4 offset:49152
    ds_read_b64_tr_b16 v[226:227], v4 offset:50176
    s_waitcnt lgkmcnt(6)
    v_mfma_f32_16x16x32_bf16 v[128:131], v[236:239], v[32:35], v[128:131]
    ds_read_b64_tr_b16 v[228:229], v5 offset:49184
    s_mov_b32 s23, 0xc000
    buffer_load_dwordx4 v[24:27], v6, s[8:11], s23 offen offset:3072 sc1
    v_mfma_f32_16x16x32_bf16 v[132:135], v[236:239], v[36:39], v[132:135]
    ds_read_b64_tr_b16 v[230:231], v5 offset:50208
    s_waitcnt lgkmcnt(6)
    v_mfma_f32_16x16x32_bf16 v[136:139], v[240:243], v[32:35], v[136:139]
    ds_read_b64_tr_b16 v[232:233], v4 offset:49408
    v_mfma_f32_16x16x32_bf16 v[140:143], v[240:243], v[36:39], v[140:143]
    ds_read_b64_tr_b16 v[234:235], v4 offset:50432
    s_mov_b32 s23, 0x2c000
    buffer_load_dwordx4 v[28:31], v6, s[8:11], s23 offen offset:3072 sc1
    s_waitcnt lgkmcnt(6)
    v_mfma_f32_16x16x32_bf16 v[144:147], v[244:247], v[32:35], v[144:147]
    ds_read_b64_tr_b16 v[236:237], v5 offset:49440
    v_mfma_f32_16x16x32_bf16 v[148:151], v[244:247], v[36:39], v[148:151]
    ds_read_b64_tr_b16 v[238:239], v5 offset:50464
    s_waitcnt lgkmcnt(6)
    v_mfma_f32_16x16x32_bf16 v[88:91], v[224:227], v[40:43], v[88:91]
    ds_read_b64_tr_b16 v[240:241], v4 offset:49664
    v_mfma_f32_16x16x32_bf16 v[92:95], v[224:227], v[44:47], v[92:95]
    s_add_u32 s22, s24, 0x3b0000
    s_add_u32 m0, s20, 0x14000
    s_nop 0
    buffer_load_dwordx4 v3, s[4:7], s22 offen lds
    ds_read_b64_tr_b16 v[242:243], v4 offset:50688
    s_waitcnt lgkmcnt(6)
    v_mfma_f32_16x16x32_bf16 v[96:99], v[228:231], v[40:43], v[96:99]
    ds_read_b64_tr_b16 v[244:245], v5 offset:49696
    v_mfma_f32_16x16x32_bf16 v[100:103], v[228:231], v[44:47], v[100:103]
    ds_read_b64_tr_b16 v[246:247], v5 offset:50720
    s_waitcnt lgkmcnt(6)
    v_mfma_f32_16x16x32_bf16 v[104:107], v[232:235], v[40:43], v[104:107]
    s_add_u32 s22, s24, 0x3b2000
    s_add_u32 m0, s20, 0x14400
    s_nop 0
    buffer_load_dwordx4 v3, s[4:7], s22 offen lds
    ds_read_b64_tr_b16 v[224:225], v4 offset:49920
    v_mfma_f32_16x16x32_bf16 v[108:111], v[232:235], v[44:47], v[108:111]
    ds_read_b64_tr_b16 v[226:227], v4 offset:50944
    v_lshrrev_b32 v16, 4, v1
    v_lshlrev_b32 v16, 3, v16
    s_lshl_b32 s16, s31, 8
    s_add_u32 s16, s16, 0x540080
    buffer_load_dwordx2 v[248:249], v16, s[8:11], s16 offen offset:0 sc1
    buffer_load_dwordx2 v[250:251], v16, s[8:11], s16 offen offset:32 sc1
    buffer_load_dwordx2 v[252:253], v16, s[8:11], s16 offen offset:64 sc1
    buffer_load_dwordx2 v[254:255], v16, s[8:11], s16 offen offset:96 sc1
    s_waitcnt lgkmcnt(6)
    v_mfma_f32_16x16x32_bf16 v[112:115], v[236:239], v[40:43], v[112:115]
    ds_read_b64_tr_b16 v[228:229], v5 offset:49952
    v_mfma_f32_16x16x32_bf16 v[116:119], v[236:239], v[44:47], v[116:119]
    ds_read_b64_tr_b16 v[230:231], v5 offset:50976
    s_waitcnt lgkmcnt(6)
    v_mfma_f32_16x16x32_bf16 v[120:123], v[240:243], v[40:43], v[120:123]
    v_mfma_f32_16x16x32_bf16 v[124:127], v[240:243], v[44:47], v[124:127]
    s_barrier
    ds_read_b64_tr_b16 v[232:233], v7 offset:0
    ds_read_b64_tr_b16 v[234:235], v7 offset:1024
    s_waitcnt lgkmcnt(6)
    v_mfma_f32_16x16x32_bf16 v[128:131], v[244:247], v[40:43], v[128:131]
    ds_read_b64_tr_b16 v[236:237], v8 offset:32
    s_mov_b32 s23, 0xe000
    buffer_load_dwordx4 v[32:35], v6, s[8:11], s23 offen offset:3072 sc1
    v_mfma_f32_16x16x32_bf16 v[132:135], v[244:247], v[44:47], v[132:135]
    ds_read_b64_tr_b16 v[238:239], v8 offset:1056
    s_waitcnt lgkmcnt(6)
    v_mfma_f32_16x16x32_bf16 v[136:139], v[224:227], v[40:43], v[136:139]
    ds_read_b64_tr_b16 v[240:241], v7 offset:256
    v_mfma_f32_16x16x32_bf16 v[140:143], v[224:227], v[44:47], v[140:143]
    ds_read_b64_tr_b16 v[242:243], v7 offset:1280
    s_mov_b32 s23, 0x2e000
    buffer_load_dwordx4 v[36:39], v6, s[8:11], s23 offen offset:3072 sc1
    s_waitcnt lgkmcnt(6)
    v_mfma_f32_16x16x32_bf16 v[144:147], v[228:231], v[40:43], v[144:147]
    ds_read_b64_tr_b16 v[244:245], v8 offset:288
    v_mfma_f32_16x16x32_bf16 v[148:151], v[228:231], v[44:47], v[148:151]
    ds_read_b64_tr_b16 v[246:247], v8 offset:1312
    s_waitcnt lgkmcnt(6)
    v_mfma_f32_16x16x32_bf16 v[88:91], v[232:235], v[48:51], v[88:91]
    ds_read_b64_tr_b16 v[224:225], v7 offset:512
    v_mfma_f32_16x16x32_bf16 v[92:95], v[232:235], v[52:55], v[92:95]
    ds_read_b64_tr_b16 v[226:227], v7 offset:1536
    s_waitcnt lgkmcnt(6)
    v_mfma_f32_16x16x32_bf16 v[96:99], v[236:239], v[48:51], v[96:99]
    ds_read_b64_tr_b16 v[228:229], v8 offset:544
    v_mfma_f32_16x16x32_bf16 v[100:103], v[236:239], v[52:55], v[100:103]
    ds_read_b64_tr_b16 v[230:231], v8 offset:1568
    s_waitcnt lgkmcnt(6)
    v_mfma_f32_16x16x32_bf16 v[104:107], v[240:243], v[48:51], v[104:107]
    ds_read_b64_tr_b16 v[232:233], v7 offset:768
    v_mfma_f32_16x16x32_bf16 v[108:111], v[240:243], v[52:55], v[108:111]
    ds_read_b64_tr_b16 v[234:235], v7 offset:1792
    s_waitcnt lgkmcnt(6)
    v_mfma_f32_16x16x32_bf16 v[112:115], v[244:247], v[48:51], v[112:115]
    ds_read_b64_tr_b16 v[236:237], v8 offset:800
    v_mfma_f32_16x16x32_bf16 v[116:119], v[244:247], v[52:55], v[116:119]
    ds_read_b64_tr_b16 v[238:239], v8 offset:1824
    s_waitcnt lgkmcnt(6)
    v_mfma_f32_16x16x32_bf16 v[120:123], v[224:227], v[48:51], v[120:123]
    s_mov_b64 s[72:73], s[48:49]
    s_mov_b32 s74, 0x700000
    s_mov_b32 s75, 0x20000
    s_cmp_lt_u32 s2, 224
    s_cselect_b32 s74, 7340032, 0
    s_and_b32 s16, s3, 3
    v_lshrrev_b32 v20, 3, v1
    v_lshlrev_b32 v20, 3, v20
    s_lshl_b32 s17, s16, 6
    v_add_u32 v20, s17, v20
    s_mov_b32 s17, 7168
    v_mul_lo_u32 v21, s17, v20
    v_and_b32 v20, 7, v1
    v_lshl_add_u32 v21, v20, 4, v21
    s_and_b32 s17, s29, 3
    s_mul_i32 s18, s17, 1835008
    s_lshr_b32 s17, s29, 2
    s_lshl_b32 s17, s17, 7
    s_add_u32 s18, s18, s17
    s_lshl_b32 s16, s16, 13
    s_add_u32 s22, s18, 0
    s_add_u32 m0, s16, 32768
    s_nop 0
    buffer_load_dwordx4 v21, s[72:75], s22 offen lds
    s_add_u32 s22, s18, 7168
    s_add_u32 m0, s16, 33792
    s_nop 0
    buffer_load_dwordx4 v21, s[72:75], s22 offen lds
    s_add_u32 s22, s18, 14336
    s_add_u32 m0, s16, 34816
    s_nop 0
    buffer_load_dwordx4 v21, s[72:75], s22 offen lds
    s_add_u32 s22, s18, 21504
    s_add_u32 m0, s16, 35840
    s_nop 0
    buffer_load_dwordx4 v21, s[72:75], s22 offen lds
    s_add_u32 s22, s18, 28672
    s_add_u32 m0, s16, 36864
    s_nop 0
    buffer_load_dwordx4 v21, s[72:75], s22 offen lds
    s_add_u32 s22, s18, 35840
    s_add_u32 m0, s16, 37888
    s_nop 0
    buffer_load_dwordx4 v21, s[72:75], s22 offen lds
    s_add_u32 s22, s18, 43008
    s_add_u32 m0, s16, 38912
    s_nop 0
    buffer_load_dwordx4 v21, s[72:75], s22 offen lds
    s_add_u32 s22, s18, 50176
    s_add_u32 m0, s16, 39936
    s_nop 0
    buffer_load_dwordx4 v21, s[72:75], s22 offen lds
    v_mfma_f32_16x16x32_bf16 v[124:127], v[224:227], v[52:55], v[124:127]
    s_barrier
    ds_read_b64_tr_b16 v[240:241], v7 offset:16384
    ds_read_b64_tr_b16 v[242:243], v7 offset:17408
    s_waitcnt lgkmcnt(6)
    v_mfma_f32_16x16x32_bf16 v[128:131], v[228:231], v[48:51], v[128:131]
    ds_read_b64_tr_b16 v[244:245], v8 offset:16416
    v_mfma_f32_16x16x32_bf16 v[132:135], v[228:231], v[52:55], v[132:135]
    ds_read_b64_tr_b16 v[246:247], v8 offset:17440
    s_waitcnt lgkmcnt(6)
    v_mfma_f32_16x16x32_bf16 v[136:139], v[232:235], v[48:51], v[136:139]
    ds_read_b64_tr_b16 v[224:225], v7 offset:16640
    v_mfma_f32_16x16x32_bf16 v[140:143], v[232:235], v[52:55], v[140:143]
    ds_read_b64_tr_b16 v[226:227], v7 offset:17664
    s_waitcnt lgkmcnt(6)
    v_mfma_f32_16x16x32_bf16 v[144:147], v[236:239], v[48:51], v[144:147]
    ds_read_b64_tr_b16 v[228:229], v8 offset:16672
    v_mfma_f32_16x16x32_bf16 v[148:151], v[236:239], v[52:55], v[148:151]
    ds_read_b64_tr_b16 v[230:231], v8 offset:17696
    s_waitcnt vmcnt(21) lgkmcnt(6)
    v_mfma_f32_16x16x32_bf16 v[88:91], v[240:243], v[56:59], v[88:91]
    ds_read_b64_tr_b16 v[232:233], v7 offset:16896
    s_waitcnt vmcnt(20)
    v_mfma_f32_16x16x32_bf16 v[92:95], v[240:243], v[60:63], v[92:95]
    ds_read_b64_tr_b16 v[234:235], v7 offset:17920
    s_waitcnt lgkmcnt(6)
    v_mfma_f32_16x16x32_bf16 v[96:99], v[244:247], v[56:59], v[96:99]
    ds_read_b64_tr_b16 v[236:237], v8 offset:16928
    v_mfma_f32_16x16x32_bf16 v[100:103], v[244:247], v[60:63], v[100:103]
    ds_read_b64_tr_b16 v[238:239], v8 offset:17952
    s_waitcnt lgkmcnt(6)
    v_mfma_f32_16x16x32_bf16 v[104:107], v[224:227], v[56:59], v[104:107]
    ds_read_b64_tr_b16 v[240:241], v7 offset:17152
    v_mfma_f32_16x16x32_bf16 v[108:111], v[224:227], v[60:63], v[108:111]
    ds_read_b64_tr_b16 v[242:243], v7 offset:18176
    s_waitcnt lgkmcnt(6)
    v_mfma_f32_16x16x32_bf16 v[112:115], v[228:231], v[56:59], v[112:115]
    ds_read_b64_tr_b16 v[244:245], v8 offset:17184
    v_mfma_f32_16x16x32_bf16 v[116:119], v[228:231], v[60:63], v[116:119]
    ds_read_b64_tr_b16 v[246:247], v8 offset:18208
    s_waitcnt lgkmcnt(6)
    v_mfma_f32_16x16x32_bf16 v[120:123], v[232:235], v[56:59], v[120:123]
    v_mfma_f32_16x16x32_bf16 v[124:127], v[232:235], v[60:63], v[124:127]
    s_waitcnt vmcnt(18)
    s_barrier
    ds_read_b64_tr_b16 v[224:225], v4 offset:0
    ds_read_b64_tr_b16 v[226:227], v4 offset:1024
    s_waitcnt lgkmcnt(6)
    v_mfma_f32_16x16x32_bf16 v[128:131], v[236:239], v[56:59], v[128:131]
    ds_read_b64_tr_b16 v[228:229], v5 offset:32
    v_mfma_f32_16x16x32_bf16 v[132:135], v[236:239], v[60:63], v[132:135]
    ds_read_b64_tr_b16 v[230:231], v5 offset:1056
    s_waitcnt lgkmcnt(6)
    v_mfma_f32_16x16x32_bf16 v[136:139], v[240:243], v[56:59], v[136:139]
    ds_read_b64_tr_b16 v[232:233], v4 offset:256
    v_mfma_f32_16x16x32_bf16 v[140:143], v[240:243], v[60:63], v[140:143]
    ds_read_b64_tr_b16 v[234:235], v4 offset:1280
    s_waitcnt lgkmcnt(6)
    v_mfma_f32_16x16x32_bf16 v[144:147], v[244:247], v[56:59], v[144:147]
    ds_read_b64_tr_b16 v[236:237], v5 offset:288
    v_mfma_f32_16x16x32_bf16 v[148:151], v[244:247], v[60:63], v[148:151]
    ds_read_b64_tr_b16 v[238:239], v5 offset:1312
    s_waitcnt vmcnt(17) lgkmcnt(6)
    v_mfma_f32_16x16x32_bf16 v[88:91], v[224:227], v[24:27], v[88:91]
    ds_read_b64_tr_b16 v[240:241], v4 offset:512
    s_waitcnt vmcnt(16)
    v_mfma_f32_16x16x32_bf16 v[92:95], v[224:227], v[28:31], v[92:95]
    ds_read_b64_tr_b16 v[242:243], v4 offset:1536
    s_waitcnt lgkmcnt(6)
    v_mfma_f32_16x16x32_bf16 v[96:99], v[228:231], v[24:27], v[96:99]
    ds_read_b64_tr_b16 v[244:245], v5 offset:544
    v_mfma_f32_16x16x32_bf16 v[100:103], v[228:231], v[28:31], v[100:103]
    ds_read_b64_tr_b16 v[246:247], v5 offset:1568
    s_waitcnt lgkmcnt(6)
    v_mfma_f32_16x16x32_bf16 v[104:107], v[232:235], v[24:27], v[104:107]
    ds_read_b64_tr_b16 v[224:225], v4 offset:768
    v_mfma_f32_16x16x32_bf16 v[108:111], v[232:235], v[28:31], v[108:111]
    ds_read_b64_tr_b16 v[226:227], v4 offset:1792
    s_waitcnt lgkmcnt(6)
    v_mfma_f32_16x16x32_bf16 v[112:115], v[236:239], v[24:27], v[112:115]
    ds_read_b64_tr_b16 v[228:229], v5 offset:800
    v_mfma_f32_16x16x32_bf16 v[116:119], v[236:239], v[28:31], v[116:119]
    ds_read_b64_tr_b16 v[230:231], v5 offset:1824
    s_waitcnt lgkmcnt(6)
    v_mfma_f32_16x16x32_bf16 v[120:123], v[240:243], v[24:27], v[120:123]
    v_mfma_f32_16x16x32_bf16 v[124:127], v[240:243], v[28:31], v[124:127]
    s_waitcnt vmcnt(14)
    s_barrier
    ds_read_b64_tr_b16 v[232:233], v4 offset:16384
    ds_read_b64_tr_b16 v[234:235], v4 offset:17408
    s_waitcnt lgkmcnt(6)
    v_mfma_f32_16x16x32_bf16 v[128:131], v[244:247], v[24:27], v[128:131]
    ds_read_b64_tr_b16 v[236:237], v5 offset:16416
    v_mfma_f32_16x16x32_bf16 v[132:135], v[244:247], v[28:31], v[132:135]
    ds_read_b64_tr_b16 v[238:239], v5 offset:17440
    s_waitcnt lgkmcnt(6)
    v_mfma_f32_16x16x32_bf16 v[136:139], v[224:227], v[24:27], v[136:139]
    ds_read_b64_tr_b16 v[240:241], v4 offset:16640
    v_mfma_f32_16x16x32_bf16 v[140:143], v[224:227], v[28:31], v[140:143]
    ds_read_b64_tr_b16 v[242:243], v4 offset:17664
    s_waitcnt lgkmcnt(6)
    v_mfma_f32_16x16x32_bf16 v[144:147], v[228:231], v[24:27], v[144:147]
    ds_read_b64_tr_b16 v[244:245], v5 offset:16672
    v_mfma_f32_16x16x32_bf16 v[148:151], v[228:231], v[28:31], v[148:151]
    ds_read_b64_tr_b16 v[246:247], v5 offset:17696
    s_waitcnt vmcnt(9) lgkmcnt(6)
    v_mfma_f32_16x16x32_bf16 v[88:91], v[232:235], v[32:35], v[88:91]
    ds_read_b64_tr_b16 v[224:225], v4 offset:16896
    s_waitcnt vmcnt(8)
    v_mfma_f32_16x16x32_bf16 v[92:95], v[232:235], v[36:39], v[92:95]
    ds_read_b64_tr_b16 v[226:227], v4 offset:17920
    s_waitcnt lgkmcnt(6)
    v_mfma_f32_16x16x32_bf16 v[96:99], v[236:239], v[32:35], v[96:99]
    ds_read_b64_tr_b16 v[228:229], v5 offset:16928
    v_mfma_f32_16x16x32_bf16 v[100:103], v[236:239], v[36:39], v[100:103]
    ds_read_b64_tr_b16 v[230:231], v5 offset:17952
    s_waitcnt lgkmcnt(6)
    v_mfma_f32_16x16x32_bf16 v[104:107], v[240:243], v[32:35], v[104:107]
    ds_read_b64_tr_b16 v[232:233], v4 offset:17152
    v_mfma_f32_16x16x32_bf16 v[108:111], v[240:243], v[36:39], v[108:111]
    ds_read_b64_tr_b16 v[234:235], v4 offset:18176
    s_waitcnt lgkmcnt(6)
    v_mfma_f32_16x16x32_bf16 v[112:115], v[244:247], v[32:35], v[112:115]
    ds_read_b64_tr_b16 v[236:237], v5 offset:17184
    v_mfma_f32_16x16x32_bf16 v[116:119], v[244:247], v[36:39], v[116:119]
    ds_read_b64_tr_b16 v[238:239], v5 offset:18208
    s_waitcnt lgkmcnt(6)
    v_mfma_f32_16x16x32_bf16 v[120:123], v[224:227], v[32:35], v[120:123]
    v_mfma_f32_16x16x32_bf16 v[124:127], v[224:227], v[36:39], v[124:127]
    s_waitcnt lgkmcnt(4)
    v_mfma_f32_16x16x32_bf16 v[128:131], v[228:231], v[32:35], v[128:131]
    v_mfma_f32_16x16x32_bf16 v[132:135], v[228:231], v[36:39], v[132:135]
    s_waitcnt lgkmcnt(2)
    v_mfma_f32_16x16x32_bf16 v[136:139], v[232:235], v[32:35], v[136:139]
    v_mfma_f32_16x16x32_bf16 v[140:143], v[232:235], v[36:39], v[140:143]
    s_waitcnt lgkmcnt(0)
    v_mfma_f32_16x16x32_bf16 v[144:147], v[236:239], v[32:35], v[144:147]
    v_mfma_f32_16x16x32_bf16 v[148:151], v[236:239], v[36:39], v[148:151]
    s_lshl_b32 s16, s3, 13
    s_xor_b32 s17, s16, 0x8000
    s_add_u32 s16, s16, 0x18000
    s_add_u32 s17, s17, 0x18000
    v_add_u32 v16, s16, v2
    s_mov_b32 s16, s17
    v_add_u32 v17, s16, v2
    ds_write_b128 v16, v[88:91] offset:0
    ds_write_b128 v16, v[92:95] offset:1024
    ds_write_b128 v16, v[96:99] offset:2048
    ds_write_b128 v16, v[100:103] offset:3072
    ds_write_b128 v16, v[104:107] offset:4096
    ds_write_b128 v16, v[108:111] offset:5120
    ds_write_b128 v16, v[112:115] offset:6144
    ds_write_b128 v16, v[116:119] offset:7168
    v_lshlrev_b32 v24, 16, v248
    v_and_b32 v25, 0xffff0000, v248
    v_lshlrev_b32 v26, 16, v249
    v_and_b32 v27, 0xffff0000, v249
    v_lshlrev_b32 v28, 16, v250
    v_and_b32 v29, 0xffff0000, v250
    v_lshlrev_b32 v30, 16, v251
    v_and_b32 v31, 0xffff0000, v251
    v_lshlrev_b32 v32, 16, v252
    v_and_b32 v33, 0xffff0000, v252
    v_lshlrev_b32 v34, 16, v253
    v_and_b32 v35, 0xffff0000, v253
    v_lshlrev_b32 v36, 16, v254
    v_and_b32 v37, 0xffff0000, v254
    v_lshlrev_b32 v38, 16, v255
    v_and_b32 v39, 0xffff0000, v255
    v_and_b32 v18, 15, v1
    v_lshlrev_b32 v18, 6, v18
    v_lshrrev_b32 v19, 4, v1
    v_and_b32 v20, 1, v19
    v_lshl_add_u32 v18, v20, 5, v18
    v_lshrrev_b32 v19, 1, v19
    v_lshl_add_u32 v18, v19, 4, v18
    s_and_b32 s17, s3, 3
    s_lshl_b32 s18, s30, 2
    s_add_u32 s18, s18, s17
    s_lshl_b32 s18, s18, 16
    s_lshl_b32 s19, s15, 22
    s_add_u32 s18, s18, s19
    s_lshl_b32 s19, s31, 12
    s_add_u32 s18, s18, s19
    s_add_u32 s18, s18, 0x2000800
    s_add_u32 s19, s18, 32768
    s_waitcnt lgkmcnt(0)
    s_barrier
    ds_read_b128 v[40:43], v17 offset:0
    ds_read_b128 v[44:47], v17 offset:1024
    ds_read_b128 v[48:51], v17 offset:2048
    ds_read_b128 v[52:55], v17 offset:3072
    ds_read_b128 v[56:59], v17 offset:4096
    ds_read_b128 v[60:63], v17 offset:5120
    ds_read_b128 v[64:67], v17 offset:6144
    ds_read_b128 v[68:71], v17 offset:7168
    s_waitcnt lgkmcnt(7)
    v_pk_add_f32 v[120:121], v[120:121], v[40:41]
    v_pk_add_f32 v[122:123], v[122:123], v[42:43]
    v_pk_mul_f32 v[120:121], v[120:121], v[24:25]
    v_pk_mul_f32 v[122:123], v[122:123], v[26:27]
    v_cvt_pk_bf16_f32 v224, v120, v121
    v_cvt_pk_bf16_f32 v225, v122, v123
    s_waitcnt lgkmcnt(5)
    v_pk_add_f32 v[128:129], v[128:129], v[48:49]
    v_pk_add_f32 v[130:131], v[130:131], v[50:51]
    v_pk_mul_f32 v[128:129], v[128:129], v[28:29]
    v_pk_mul_f32 v[130:131], v[130:131], v[30:31]
    v_cvt_pk_bf16_f32 v226, v128, v129
    v_cvt_pk_bf16_f32 v227, v130, v131
    s_nop 0
    v_permlane16_swap_b32 v224, v226
    v_permlane16_swap_b32 v225, v227
    buffer_store_dwordx4 v[224:227], v18, s[8:11], s18 offen offset:0 sc1
    v_pk_add_f32 v[124:125], v[124:125], v[44:45]
    v_pk_add_f32 v[126:127], v[126:127], v[46:47]
    v_pk_mul_f32 v[124:125], v[124:125], v[24:25]
    v_pk_mul_f32 v[126:127], v[126:127], v[26:27]
    v_cvt_pk_bf16_f32 v228, v124, v125
    v_cvt_pk_bf16_f32 v229, v126, v127
    s_waitcnt lgkmcnt(4)
    v_pk_add_f32 v[132:133], v[132:133], v[52:53]
    v_pk_add_f32 v[134:135], v[134:135], v[54:55]
    v_pk_mul_f32 v[132:133], v[132:133], v[28:29]
    v_pk_mul_f32 v[134:135], v[134:135], v[30:31]
    v_cvt_pk_bf16_f32 v230, v132, v133
    v_cvt_pk_bf16_f32 v231, v134, v135
    s_nop 0
    v_permlane16_swap_b32 v228, v230
    v_permlane16_swap_b32 v229, v231
    buffer_store_dwordx4 v[228:231], v18, s[8:11], s19 offen offset:0 sc1
    s_waitcnt lgkmcnt(3)
    v_pk_add_f32 v[136:137], v[136:137], v[56:57]
    v_pk_add_f32 v[138:139], v[138:139], v[58:59]
    v_pk_mul_f32 v[136:137], v[136:137], v[32:33]
    v_pk_mul_f32 v[138:139], v[138:139], v[34:35]
    v_cvt_pk_bf16_f32 v232, v136, v137
    v_cvt_pk_bf16_f32 v233, v138, v139
    s_waitcnt lgkmcnt(1)
    v_pk_add_f32 v[144:145], v[144:145], v[64:65]
    v_pk_add_f32 v[146:147], v[146:147], v[66:67]
    v_pk_mul_f32 v[144:145], v[144:145], v[36:37]
    v_pk_mul_f32 v[146:147], v[146:147], v[38:39]
    v_cvt_pk_bf16_f32 v234, v144, v145
    v_cvt_pk_bf16_f32 v235, v146, v147
    s_nop 0
    v_permlane16_swap_b32 v232, v234
    v_permlane16_swap_b32 v233, v235
    buffer_store_dwordx4 v[232:235], v18, s[8:11], s18 offen offset:1024 sc1
    v_pk_add_f32 v[140:141], v[140:141], v[60:61]
    v_pk_add_f32 v[142:143], v[142:143], v[62:63]
    v_pk_mul_f32 v[140:141], v[140:141], v[32:33]
    v_pk_mul_f32 v[142:143], v[142:143], v[34:35]
    v_cvt_pk_bf16_f32 v236, v140, v141
    v_cvt_pk_bf16_f32 v237, v142, v143
    s_waitcnt lgkmcnt(0)
    v_pk_add_f32 v[148:149], v[148:149], v[68:69]
    v_pk_add_f32 v[150:151], v[150:151], v[70:71]
    v_pk_mul_f32 v[148:149], v[148:149], v[36:37]
    v_pk_mul_f32 v[150:151], v[150:151], v[38:39]
    v_cvt_pk_bf16_f32 v238, v148, v149
    v_cvt_pk_bf16_f32 v239, v150, v151
    s_nop 0
    v_permlane16_swap_b32 v236, v238
    v_permlane16_swap_b32 v237, v239
    buffer_store_dwordx4 v[236:239], v18, s[8:11], s19 offen offset:1024 sc1
    s_mov_b64 s[64:65], s[44:45]
    s_mov_b32 s66, 0x800
    s_mov_b32 s67, 0x20000
    s_mov_b64 s[76:77], s[32:33]
    s_mov_b32 s78, 0x400000
    s_mov_b32 s79, 0x20000
    s_mov_b64 s[68:69], s[56:57]
    s_mov_b32 s70, 0x400000
    s_mov_b32 s71, 0x20000
    s_lshl_b32 s14, s31, 1
    s_add_u32 s14, s14, s15
    s_lshl_b32 s14, s14, 3
    s_add_u32 s14, s14, s3
    s_lshl_b32 s16, s30, 7
    s_add_u32 s14, s14, s16
    s_lshl_b32 s16, s14, 11
    buffer_load_dwordx4 v[216:219], v2, s[76:79], s16 offen offset:0
    buffer_load_dwordx4 v[220:223], v2, s[76:79], s16 offen offset:1024
    s_lshl_b32 s16, s3, 10
    s_add_u32 m0, s16, 81920
    s_add_u32 s17, s16, 0x540800
    s_cmp_lt_u32 s3, 6
    s_cselect_b32 s17, s17, 0x7ffffff0
    s_sub_u32 s23, s16, 6144
    s_cmp_ge_u32 s3, 6
    s_cselect_b32 s23, s23, 0x7ffffff0
    s_cbranch_scc1 adaLN_cond__sliding_block_cached__moe_arch_mod__prompt_kernel_mlw
    buffer_load_dwordx4 v2, s[8:11], s17 offen sc1 lds
    s_branch adaLN_cond__sliding_block_cached__moe_arch_mod__prompt_kernel_mlj
adaLN_cond__sliding_block_cached__moe_arch_mod__prompt_kernel_mlw:
    buffer_load_dwordx4 v2, s[64:67], s23 offen lds
adaLN_cond__sliding_block_cached__moe_arch_mod__prompt_kernel_mlj:
    s_lshl_b32 s16, s30, 5
    s_lshl_b32 s17, s31, 1
    s_add_u32 s16, s16, s17
    s_add_u32 s16, s16, s15
    s_lshl_b32 s16, s16, 2
    s_add_u32 s16, s16, 0x530000
    s_cmp_eq_u32 s3, 0
    s_cselect_b32 s16, s16, 0x7ffffff0
    v_mov_b32 v16, s28
    v_mov_b32 v17, 0
    s_lshr_b32 s18, s14, 4
    s_lshl_b32 s18, s18, 15
    s_and_b32 s19, s14, 15
    s_lshl_b32 s19, s19, 6
    s_add_u32 s18, s18, s19
    s_add_u32 s18, s18, 0x2000000
    s_add_u32 s19, s18, 16384
    v_lshrrev_b32 v18, 2, v1
    v_lshlrev_b32 v18, 10, v18
    v_and_b32 v19, 3, v1
    v_lshl_add_u32 v18, v19, 4, v18
    v_add_u32 v19, 0x400000, v18
    s_lshl_b32 s25, s30, 7
    s_add_u32 s25, s25, 0x530000
    v_and_b32 v20, 15, v1
    v_lshlrev_b32 v20, 2, v20
    s_waitcnt vmcnt(3)
    s_waitcnt vmcnt(0)
    s_barrier
    s_mov_b64 exec, 1
    buffer_store_dword v16, v17, s[8:11], s16 offen sc1
    s_mov_b64 exec, -1
    v_add_u32 v16, 81920, v2
    ds_read_b128 v[184:187], v16 offset:0
    ds_read_b128 v[188:191], v16 offset:1024
    ds_read_b128 v[192:195], v16 offset:2048
    ds_read_b128 v[196:199], v16 offset:3072
    ds_read_b128 v[200:203], v16 offset:4096
    ds_read_b128 v[204:207], v16 offset:5120
    ds_read_b128 v[208:211], v16 offset:6144
    ds_read_b128 v[212:215], v16 offset:7168
    v_mov_b32 v94, 0
    v_mov_b32 v95, 0
    s_waitcnt lgkmcnt(5)
    v_lshlrev_b32 v76, 16, v192
    v_and_b32 v77, 0xffff0000, v192
    s_waitcnt lgkmcnt(1)
    v_lshlrev_b32 v78, 16, v208
    v_and_b32 v79, 0xffff0000, v208
    v_pk_mul_f32 v[60:61], v[76:77], v[78:79]
    v_lshlrev_b32 v76, 16, v184
    v_and_b32 v77, 0xffff0000, v184
    v_fmac_f32 v94, v76, v78
    v_fmac_f32 v94, v77, v79
    v_add_f32 v95, v95, v60
    v_add_f32 v95, v95, v61
    v_lshlrev_b32 v76, 16, v193
    v_and_b32 v77, 0xffff0000, v193
    v_lshlrev_b32 v78, 16, v209
    v_and_b32 v79, 0xffff0000, v209
    v_pk_mul_f32 v[62:63], v[76:77], v[78:79]
    v_lshlrev_b32 v76, 16, v185
    v_and_b32 v77, 0xffff0000, v185
    v_fmac_f32 v94, v76, v78
    v_fmac_f32 v94, v77, v79
    v_add_f32 v95, v95, v62
    v_add_f32 v95, v95, v63
    v_lshlrev_b32 v76, 16, v194
    v_and_b32 v77, 0xffff0000, v194
    v_lshlrev_b32 v78, 16, v210
    v_and_b32 v79, 0xffff0000, v210
    v_pk_mul_f32 v[64:65], v[76:77], v[78:79]
    v_lshlrev_b32 v76, 16, v186
    v_and_b32 v77, 0xffff0000, v186
    v_fmac_f32 v94, v76, v78
    v_fmac_f32 v94, v77, v79
    v_add_f32 v95, v95, v64
    v_add_f32 v95, v95, v65
    v_lshlrev_b32 v76, 16, v195
    v_and_b32 v77, 0xffff0000, v195
    v_lshlrev_b32 v78, 16, v211
    v_and_b32 v79, 0xffff0000, v211
    v_pk_mul_f32 v[66:67], v[76:77], v[78:79]
    v_lshlrev_b32 v76, 16, v187
    v_and_b32 v77, 0xffff0000, v187
    v_fmac_f32 v94, v76, v78
    v_fmac_f32 v94, v77, v79
    v_add_f32 v95, v95, v66
    v_add_f32 v95, v95, v67
    v_lshlrev_b32 v76, 16, v196
    v_and_b32 v77, 0xffff0000, v196
    s_waitcnt lgkmcnt(0)
    v_lshlrev_b32 v78, 16, v212
    v_and_b32 v79, 0xffff0000, v212
    v_pk_mul_f32 v[68:69], v[76:77], v[78:79]
    v_lshlrev_b32 v76, 16, v188
    v_and_b32 v77, 0xffff0000, v188
    v_fmac_f32 v94, v76, v78
    v_fmac_f32 v94, v77, v79
    v_add_f32 v95, v95, v68
    v_add_f32 v95, v95, v69
    v_lshlrev_b32 v76, 16, v197
    v_and_b32 v77, 0xffff0000, v197
    v_lshlrev_b32 v78, 16, v213
    v_and_b32 v79, 0xffff0000, v213
    v_pk_mul_f32 v[70:71], v[76:77], v[78:79]
    v_lshlrev_b32 v76, 16, v189
    v_and_b32 v77, 0xffff0000, v189
    v_fmac_f32 v94, v76, v78
    v_fmac_f32 v94, v77, v79
    v_add_f32 v95, v95, v70
    v_add_f32 v95, v95, v71
    v_lshlrev_b32 v76, 16, v198
    v_and_b32 v77, 0xffff0000, v198
    v_lshlrev_b32 v78, 16, v214
    v_and_b32 v79, 0xffff0000, v214
    v_pk_mul_f32 v[72:73], v[76:77], v[78:79]
    v_lshlrev_b32 v76, 16, v190
    v_and_b32 v77, 0xffff0000, v190
    v_fmac_f32 v94, v76, v78
    v_fmac_f32 v94, v77, v79
    v_add_f32 v95, v95, v72
    v_add_f32 v95, v95, v73
    v_lshlrev_b32 v76, 16, v199
    v_and_b32 v77, 0xffff0000, v199
    v_lshlrev_b32 v78, 16, v215
    v_and_b32 v79, 0xffff0000, v215
    v_pk_mul_f32 v[74:75], v[76:77], v[78:79]
    v_lshlrev_b32 v76, 16, v191
    v_and_b32 v77, 0xffff0000, v191
    v_fmac_f32 v94, v76, v78
    v_fmac_f32 v94, v77, v79
    v_add_f32 v95, v95, v74
    v_add_f32 v95, v95, v75
    v_add_f32_dpp v94, v94, v94 row_ror:1 row_mask:0xf bank_mask:0xf
    s_nop 0
    v_add_f32_dpp v95, v95, v95 row_ror:1 row_mask:0xf bank_mask:0xf
    v_add_f32_dpp v94, v94, v94 row_ror:2 row_mask:0xf bank_mask:0xf
    s_nop 0
    v_add_f32_dpp v95, v95, v95 row_ror:2 row_mask:0xf bank_mask:0xf
    v_add_f32_dpp v94, v94, v94 row_ror:4 row_mask:0xf bank_mask:0xf
    s_nop 0
    v_add_f32_dpp v95, v95, v95 row_ror:4 row_mask:0xf bank_mask:0xf
    v_add_f32_dpp v94, v94, v94 row_ror:8 row_mask:0xf bank_mask:0xf
    s_nop 0
    v_add_f32_dpp v95, v95, v95 row_ror:8 row_mask:0xf bank_mask:0xf
    v_mov_b32 v76, v94
    s_nop 1
    v_permlane16_swap_b32 v94, v76
    v_add_f32 v94, v94, v76
    v_mov_b32 v77, v95
    s_nop 1
    v_permlane16_swap_b32 v95, v77
    v_add_f32 v95, v95, v77
    v_mov_b32 v76, v94
    s_nop 1
    v_permlane32_swap_b32 v94, v76
    v_add_f32 v94, v94, v76
    v_mov_b32 v77, v95
    s_nop 1
    v_permlane32_swap_b32 v95, v77
    v_add_f32 v95, v95, v77
    v_lshlrev_b32 v28, 16, v216
    v_and_b32 v29, 0xffff0000, v216
    v_lshlrev_b32 v30, 16, v217
    v_and_b32 v31, 0xffff0000, v217
    v_lshlrev_b32 v32, 16, v218
    v_and_b32 v33, 0xffff0000, v218
    v_lshlrev_b32 v34, 16, v219
    v_and_b32 v35, 0xffff0000, v219
    v_lshlrev_b32 v36, 16, v220
    v_and_b32 v37, 0xffff0000, v220
    v_lshlrev_b32 v38, 16, v221
    v_and_b32 v39, 0xffff0000, v221
    v_lshlrev_b32 v40, 16, v222
    v_and_b32 v41, 0xffff0000, v222
    v_lshlrev_b32 v42, 16, v223
    v_and_b32 v43, 0xffff0000, v223
    s_mov_b32 s27, 0
adaLN_cond__sliding_block_cached__moe_arch_mod__prompt_kernel_a22p:
    buffer_load_dword v76, v20, s[8:11], s25 offen sc1
    s_waitcnt vmcnt(0)
    v_cmp_ne_u32 vcc, s28, v76
    s_add_u32 s27, s27, 1
    s_cmp_ge_u32 s27, 65536
    s_cbranch_scc1 adaLN_cond__sliding_block_cached__moe_arch_mod__prompt_kernel_a22g
    s_cbranch_vccnz adaLN_cond__sliding_block_cached__moe_arch_mod__prompt_kernel_a22p
adaLN_cond__sliding_block_cached__moe_arch_mod__prompt_kernel_a22g:
    buffer_load_dwordx4 v[44:47], v18, s[8:11], s18 offen sc1
    buffer_load_dwordx4 v[52:55], v19, s[8:11], s18 offen sc1
    buffer_load_dwordx4 v[48:51], v18, s[8:11], s19 offen sc1
    buffer_load_dwordx4 v[56:59], v19, s[8:11], s19 offen sc1
    v_lshlrev_b32 v21, 2, v0
    s_mov_b32 s16, 0x540800
    buffer_load_dword v106, v21, s[8:11], s16 offen sc1
    buffer_load_dword v104, v21, s[8:11], s16 offen offset:2048 sc1
    s_waitcnt vmcnt(5)
    v_lshlrev_b32 v76, 16, v44
    v_and_b32 v77, 0xffff0000, v44
    s_waitcnt vmcnt(4)
    v_lshlrev_b32 v78, 16, v52
    v_and_b32 v79, 0xffff0000, v52
    v_pk_add_f32 v[76:77], v[76:77], v[78:79]
    v_pk_add_f32 v[28:29], v[28:29], v[76:77]
    v_cvt_pk_bf16_f32 v16, v28, v29
    v_lshlrev_b32 v28, 16, v16
    v_and_b32 v29, 0xffff0000, v16
    v_lshlrev_b32 v80, 16, v45
    v_and_b32 v81, 0xffff0000, v45
    v_lshlrev_b32 v82, 16, v53
    v_and_b32 v83, 0xffff0000, v53
    v_pk_add_f32 v[80:81], v[80:81], v[82:83]
    v_pk_add_f32 v[30:31], v[30:31], v[80:81]
    v_cvt_pk_bf16_f32 v17, v30, v31
    v_lshlrev_b32 v30, 16, v17
    v_and_b32 v31, 0xffff0000, v17
    v_lshlrev_b32 v76, 16, v46
    v_and_b32 v77, 0xffff0000, v46
    v_lshlrev_b32 v78, 16, v54
    v_and_b32 v79, 0xffff0000, v54
    v_pk_add_f32 v[76:77], v[76:77], v[78:79]
    v_pk_add_f32 v[32:33], v[32:33], v[76:77]
    v_cvt_pk_bf16_f32 v16, v32, v33
    v_lshlrev_b32 v32, 16, v16
    v_and_b32 v33, 0xffff0000, v16
    v_lshlrev_b32 v80, 16, v47
    v_and_b32 v81, 0xffff0000, v47
    v_lshlrev_b32 v82, 16, v55
    v_and_b32 v83, 0xffff0000, v55
    v_pk_add_f32 v[80:81], v[80:81], v[82:83]
    v_pk_add_f32 v[34:35], v[34:35], v[80:81]
    v_cvt_pk_bf16_f32 v17, v34, v35
    v_lshlrev_b32 v34, 16, v17
    v_and_b32 v35, 0xffff0000, v17
    s_waitcnt vmcnt(3)
    v_lshlrev_b32 v76, 16, v48
    v_and_b32 v77, 0xffff0000, v48
    s_waitcnt vmcnt(2)
    v_lshlrev_b32 v78, 16, v56
    v_and_b32 v79, 0xffff0000, v56
    v_pk_add_f32 v[76:77], v[76:77], v[78:79]
    v_pk_add_f32 v[36:37], v[36:37], v[76:77]
    v_cvt_pk_bf16_f32 v16, v36, v37
    v_lshlrev_b32 v36, 16, v16
    v_and_b32 v37, 0xffff0000, v16
    v_lshlrev_b32 v80, 16, v49
    v_and_b32 v81, 0xffff0000, v49
    v_lshlrev_b32 v82, 16, v57
    v_and_b32 v83, 0xffff0000, v57
    v_pk_add_f32 v[80:81], v[80:81], v[82:83]
    v_pk_add_f32 v[38:39], v[38:39], v[80:81]
    v_cvt_pk_bf16_f32 v17, v38, v39
    v_lshlrev_b32 v38, 16, v17
    v_and_b32 v39, 0xffff0000, v17
    v_lshlrev_b32 v76, 16, v50
    v_and_b32 v77, 0xffff0000, v50
    v_lshlrev_b32 v78, 16, v58
    v_and_b32 v79, 0xffff0000, v58
    v_pk_add_f32 v[76:77], v[76:77], v[78:79]
    v_pk_add_f32 v[40:41], v[40:41], v[76:77]
    v_cvt_pk_bf16_f32 v16, v40, v41
    v_lshlrev_b32 v40, 16, v16
    v_and_b32 v41, 0xffff0000, v16
    v_lshlrev_b32 v80, 16, v51
    v_and_b32 v81, 0xffff0000, v51
    v_lshlrev_b32 v82, 16, v59
    v_and_b32 v83, 0xffff0000, v59
    v_pk_add_f32 v[80:81], v[80:81], v[82:83]
    v_pk_add_f32 v[42:43], v[42:43], v[80:81]
    v_cvt_pk_bf16_f32 v17, v42, v43
    v_lshlrev_b32 v42, 16, v17
    v_and_b32 v43, 0xffff0000, v17
    v_pk_add_f32 v[76:77], v[28:29], v[30:31]
    v_pk_mul_f32 v[78:79], v[28:29], v[28:29]
    v_pk_mul_f32 v[80:81], v[28:29], v[60:61]
    v_pk_fma_f32 v[78:79], v[30:31], v[30:31], v[78:79]
    v_pk_fma_f32 v[80:81], v[30:31], v[62:63], v[80:81]
    v_pk_add_f32 v[76:77], v[76:77], v[32:33]
    v_pk_fma_f32 v[78:79], v[32:33], v[32:33], v[78:79]
    v_pk_fma_f32 v[80:81], v[32:33], v[64:65], v[80:81]
    v_pk_add_f32 v[76:77], v[76:77], v[34:35]
    v_pk_fma_f32 v[78:79], v[34:35], v[34:35], v[78:79]
    v_pk_fma_f32 v[80:81], v[34:35], v[66:67], v[80:81]
    v_pk_add_f32 v[76:77], v[76:77], v[36:37]
    v_pk_fma_f32 v[78:79], v[36:37], v[36:37], v[78:79]
    v_pk_fma_f32 v[80:81], v[36:37], v[68:69], v[80:81]
    v_pk_add_f32 v[76:77], v[76:77], v[38:39]
    v_pk_fma_f32 v[78:79], v[38:39], v[38:39], v[78:79]
    v_pk_fma_f32 v[80:81], v[38:39], v[70:71], v[80:81]
    v_pk_add_f32 v[76:77], v[76:77], v[40:41]
    v_pk_fma_f32 v[78:79], v[40:41], v[40:41], v[78:79]
    v_pk_fma_f32 v[80:81], v[40:41], v[72:73], v[80:81]
    v_pk_add_f32 v[76:77], v[76:77], v[42:43]
    v_pk_fma_f32 v[78:79], v[42:43], v[42:43], v[78:79]
    v_pk_fma_f32 v[80:81], v[42:43], v[74:75], v[80:81]
    v_add_f32 v96, v76, v77
    v_add_f32 v97, v78, v79
    v_add_f32 v98, v80, v81
    v_add_f32_dpp v96, v96, v96 row_ror:1 row_mask:0xf bank_mask:0xf
    v_add_f32_dpp v97, v97, v97 row_ror:1 row_mask:0xf bank_mask:0xf
    v_add_f32_dpp v98, v98, v98 row_ror:1 row_mask:0xf bank_mask:0xf
    v_add_f32_dpp v96, v96, v96 row_ror:2 row_mask:0xf bank_mask:0xf
    v_add_f32_dpp v97, v97, v97 row_ror:2 row_mask:0xf bank_mask:0xf
    v_add_f32_dpp v98, v98, v98 row_ror:2 row_mask:0xf bank_mask:0xf
    v_add_f32_dpp v96, v96, v96 row_ror:4 row_mask:0xf bank_mask:0xf
    v_add_f32_dpp v97, v97, v97 row_ror:4 row_mask:0xf bank_mask:0xf
    v_add_f32_dpp v98, v98, v98 row_ror:4 row_mask:0xf bank_mask:0xf
    v_add_f32_dpp v96, v96, v96 row_ror:8 row_mask:0xf bank_mask:0xf
    v_add_f32_dpp v97, v97, v97 row_ror:8 row_mask:0xf bank_mask:0xf
    v_add_f32_dpp v98, v98, v98 row_ror:8 row_mask:0xf bank_mask:0xf
    v_mov_b32 v76, v96
    s_nop 1
    v_permlane16_swap_b32 v96, v76
    v_add_f32 v96, v96, v76
    v_mov_b32 v77, v97
    s_nop 1
    v_permlane16_swap_b32 v97, v77
    v_add_f32 v97, v97, v77
    v_mov_b32 v78, v98
    s_nop 1
    v_permlane16_swap_b32 v98, v78
    v_add_f32 v98, v98, v78
    v_mov_b32 v76, v96
    s_nop 1
    v_permlane32_swap_b32 v96, v76
    v_add_f32 v96, v96, v76
    v_mov_b32 v77, v97
    s_nop 1
    v_permlane32_swap_b32 v97, v77
    v_add_f32 v97, v97, v77
    v_mov_b32 v78, v98
    s_nop 1
    v_permlane32_swap_b32 v98, v78
    v_add_f32 v98, v98, v78
    v_mul_f32 v96, 0x3a800000, v96
    v_mul_f32 v97, 0x3a800000, v97
    v_fma_f32 v97, -v96, v96, v97
    v_max_f32 v97, 0, v97
    v_fma_f32 v98, -v96, v95, v98
    v_add_f32 v76, 0x3727c5ac, v97
    v_rsq_f32 v76, v76
    s_nop 0
    v_fma_f32 v27, v98, v76, v94
    v_cvt_pk_bf16_f32 v96, v96, v96
    v_lshlrev_b32 v96, 16, v96
    v_cvt_pk_bf16_f32 v97, v97, v97
    v_lshlrev_b32 v97, 16, v97
    v_add_f32 v97, 0x3727c5ac, v97
    v_cvt_pk_bf16_f32 v97, v97, v97
    v_lshlrev_b32 v97, 16, v97
    v_sqrt_f32 v98, v97
    s_nop 0
    v_cvt_pk_bf16_f32 v98, v98, v98
    v_lshlrev_b32 v98, 16, v98
    v_rcp_f32 v99, v98
    v_mov_b32 v25, v96
    v_mov_b32 v26, v98
    v_ashrrev_i32 v16, 31, v27
    v_or_b32 v16, 0x80000000, v16
    v_xor_b32 v24, v27, v16
    v_and_b32 v24, 0xfffff800, v24
    v_max_u32 v24, 0x800, v24
    s_sub_u32 s16, 2047, s14
    v_or_b32 v24, s16, v24
    s_lshl_b32 s16, s3, 4
    s_add_u32 s16, s16, 65536
    v_mov_b32 v16, s16
    ds_write_b128 v16, v[24:27]
    s_waitcnt lgkmcnt(0)
    s_barrier
    v_and_b32 v16, 7, v1
    v_lshlrev_b32 v16, 4, v16
    v_add_u32 v16, 65536, v16
    ds_read_b32 v76, v16
    s_waitcnt lgkmcnt(0)
    v_mov_b32 v77, v76
    s_nop 1
    v_max_u32_dpp v77, v77, v77 row_ror:1 row_mask:0xf bank_mask:0xf
    s_nop 1
    v_max_u32_dpp v77, v77, v77 row_ror:2 row_mask:0xf bank_mask:0xf
    s_nop 1
    v_max_u32_dpp v77, v77, v77 row_ror:4 row_mask:0xf bank_mask:0xf
    v_cmp_eq_u32 vcc, v76, v77
    s_ff1_i32_b64 s16, vcc
    s_lshl_b32 s16, s16, 4
    s_add_u32 s16, s16, 65536
    v_mov_b32 v16, s16
    ds_read_b128 v[24:27], v16
    s_lshl_b32 s16, s2, 4
    s_add_u32 s16, s16, 0x6e0000
    s_cmp_eq_u32 s3, 0
    s_cselect_b32 s16, s16, 0x7ffffff0
    v_mov_b32 v17, 0
    s_mov_b64 exec, 1
    s_waitcnt lgkmcnt(0)
    buffer_store_dwordx4 v[24:27], v17, s[8:11], s16 offen sc1
    s_mov_b64 exec, -1
    s_mov_b64 s[72:73], s[50:51]
    s_mov_b32 s74, 0x700000
    s_mov_b32 s75, 0x20000
    s_cmp_lt_u32 s2, 224
    s_cselect_b32 s74, 7340032, 0
    s_lshl_b32 s17, s29, 4
    s_sub_u32 s16, s3, 4
    s_lshl_b32 s16, s16, 2
    s_add_u32 s16, s16, s17
    s_lshl_b32 s16, s16, 11
    s_add_u32 s17, s16, 0
    buffer_load_dwordx4 v[152:155], v2, s[72:75], s17 offen offset:0
    buffer_load_dwordx4 v[156:159], v2, s[72:75], s17 offen offset:1024
    s_add_u32 s17, s16, 2048
    buffer_load_dwordx4 v[160:163], v2, s[72:75], s17 offen offset:0
    buffer_load_dwordx4 v[164:167], v2, s[72:75], s17 offen offset:1024
    s_add_u32 s17, s16, 4096
    buffer_load_dwordx4 v[168:171], v2, s[72:75], s17 offen offset:0
    buffer_load_dwordx4 v[172:175], v2, s[72:75], s17 offen offset:1024
    s_add_u32 s17, s16, 6144
    buffer_load_dwordx4 v[176:179], v2, s[72:75], s17 offen offset:0
    buffer_load_dwordx4 v[180:183], v2, s[72:75], s17 offen offset:1024
    v_sub_f32 v44, v28, v96
    v_sub_f32 v45, v29, v96
    v_sub_f32 v46, v30, v96
    v_sub_f32 v47, v31, v96
    v_sub_f32 v48, v32, v96
    v_sub_f32 v49, v33, v96
    v_sub_f32 v50, v34, v96
    v_sub_f32 v51, v35, v96
    v_cvt_pk_bf16_f32 v16, v44, v45
    v_lshlrev_b32 v44, 16, v16
    v_and_b32 v45, 0xffff0000, v16
    v_cvt_pk_bf16_f32 v16, v46, v47
    v_lshlrev_b32 v46, 16, v16
    v_and_b32 v47, 0xffff0000, v16
    v_cvt_pk_bf16_f32 v16, v48, v49
    v_lshlrev_b32 v48, 16, v16
    v_and_b32 v49, 0xffff0000, v16
    v_cvt_pk_bf16_f32 v16, v50, v51
    v_lshlrev_b32 v50, 16, v16
    v_and_b32 v51, 0xffff0000, v16
    v_mul_f32 v52, v44, v99
    v_mul_f32 v53, v45, v99
    v_mul_f32 v54, v46, v99
    v_mul_f32 v55, v47, v99
    v_mul_f32 v56, v48, v99
    v_mul_f32 v57, v49, v99
    v_mul_f32 v58, v50, v99
    v_mul_f32 v59, v51, v99
    v_fma_f32 v44, -v52, v98, v44
    v_fma_f32 v45, -v53, v98, v45
    v_fma_f32 v46, -v54, v98, v46
    v_fma_f32 v47, -v55, v98, v47
    v_fma_f32 v48, -v56, v98, v48
    v_fma_f32 v49, -v57, v98, v49
    v_fma_f32 v50, -v58, v98, v50
    v_fma_f32 v51, -v59, v98, v51
    v_fma_f32 v44, v44, v99, v52
    v_fma_f32 v45, v45, v99, v53
    v_fma_f32 v46, v46, v99, v54
    v_fma_f32 v47, v47, v99, v55
    v_fma_f32 v48, v48, v99, v56
    v_fma_f32 v49, v49, v99, v57
    v_fma_f32 v50, v50, v99, v58
    v_fma_f32 v51, v51, v99, v59
    v_cvt_pk_bf16_f32 v16, v44, v45
    v_lshlrev_b32 v44, 16, v16
    v_and_b32 v45, 0xffff0000, v16
    v_cvt_pk_bf16_f32 v16, v46, v47
    v_lshlrev_b32 v46, 16, v16
    v_and_b32 v47, 0xffff0000, v16
    v_cvt_pk_bf16_f32 v16, v48, v49
    v_lshlrev_b32 v48, 16, v16
    v_and_b32 v49, 0xffff0000, v16
    v_cvt_pk_bf16_f32 v16, v50, v51
    v_lshlrev_b32 v50, 16, v16
    v_and_b32 v51, 0xffff0000, v16
    v_lshlrev_b32 v52, 16, v192
    v_and_b32 v53, 0xffff0000, v192
    v_lshlrev_b32 v54, 16, v193
    v_and_b32 v55, 0xffff0000, v193
    v_lshlrev_b32 v56, 16, v194
    v_and_b32 v57, 0xffff0000, v194
    v_lshlrev_b32 v58, 16, v195
    v_and_b32 v59, 0xffff0000, v195
    v_pk_mul_f32 v[44:45], v[44:45], v[52:53]
    v_pk_mul_f32 v[46:47], v[46:47], v[54:55]
    v_pk_mul_f32 v[48:49], v[48:49], v[56:57]
    v_pk_mul_f32 v[50:51], v[50:51], v[58:59]
    v_cvt_pk_bf16_f32 v16, v44, v45
    v_lshlrev_b32 v44, 16, v16
    v_and_b32 v45, 0xffff0000, v16
    v_cvt_pk_bf16_f32 v16, v46, v47
    v_lshlrev_b32 v46, 16, v16
    v_and_b32 v47, 0xffff0000, v16
    v_cvt_pk_bf16_f32 v16, v48, v49
    v_lshlrev_b32 v48, 16, v16
    v_and_b32 v49, 0xffff0000, v16
    v_cvt_pk_bf16_f32 v16, v50, v51
    v_lshlrev_b32 v50, 16, v16
    v_and_b32 v51, 0xffff0000, v16
    v_lshlrev_b32 v52, 16, v184
    v_and_b32 v53, 0xffff0000, v184
    v_lshlrev_b32 v54, 16, v185
    v_and_b32 v55, 0xffff0000, v185
    v_lshlrev_b32 v56, 16, v186
    v_and_b32 v57, 0xffff0000, v186
    v_lshlrev_b32 v58, 16, v187
    v_and_b32 v59, 0xffff0000, v187
    v_pk_add_f32 v[44:45], v[44:45], v[52:53]
    v_pk_add_f32 v[46:47], v[46:47], v[54:55]
    v_pk_add_f32 v[48:49], v[48:49], v[56:57]
    v_pk_add_f32 v[50:51], v[50:51], v[58:59]
    v_cvt_pk_bf16_f32 v16, v44, v45
    v_lshlrev_b32 v44, 16, v16
    v_and_b32 v45, 0xffff0000, v16
    v_cvt_pk_bf16_f32 v16, v46, v47
    v_lshlrev_b32 v46, 16, v16
    v_and_b32 v47, 0xffff0000, v16
    v_cvt_pk_bf16_f32 v16, v48, v49
    v_lshlrev_b32 v48, 16, v16
    v_and_b32 v49, 0xffff0000, v16
    v_cvt_pk_bf16_f32 v16, v50, v51
    v_lshlrev_b32 v50, 16, v16
    v_and_b32 v51, 0xffff0000, v16
    v_lshlrev_b32 v52, 16, v200
    v_and_b32 v53, 0xffff0000, v200
    v_lshlrev_b32 v54, 16, v201
    v_and_b32 v55, 0xffff0000, v201
    v_lshlrev_b32 v56, 16, v202
    v_and_b32 v57, 0xffff0000, v202
    v_lshlrev_b32 v58, 16, v203
    v_and_b32 v59, 0xffff0000, v203
    v_pk_mul_f32 v[44:45], v[44:45], v[52:53]
    v_pk_mul_f32 v[46:47], v[46:47], v[54:55]
    v_pk_mul_f32 v[48:49], v[48:49], v[56:57]
    v_pk_mul_f32 v[50:51], v[50:51], v[58:59]
    v_cvt_pk_bf16_f32 v16, v44, v45
    v_lshlrev_b32 v44, 16, v16
    v_and_b32 v45, 0xffff0000, v16
    v_cvt_pk_bf16_f32 v16, v46, v47
    v_lshlrev_b32 v46, 16, v16
    v_and_b32 v47, 0xffff0000, v16
    v_cvt_pk_bf16_f32 v16, v48, v49
    v_lshlrev_b32 v48, 16, v16
    v_and_b32 v49, 0xffff0000, v16
    v_cvt_pk_bf16_f32 v16, v50, v51
    v_lshlrev_b32 v50, 16, v16
    v_and_b32 v51, 0xffff0000, v16
    v_pk_add_f32 v[44:45], v[44:45], v[28:29]
    v_pk_add_f32 v[46:47], v[46:47], v[30:31]
    v_pk_add_f32 v[48:49], v[48:49], v[32:33]
    v_pk_add_f32 v[50:51], v[50:51], v[34:35]
    v_cvt_pk_bf16_f32 v28, v44, v45
    v_cvt_pk_bf16_f32 v29, v46, v47
    v_cvt_pk_bf16_f32 v30, v48, v49
    v_cvt_pk_bf16_f32 v31, v50, v51
    v_sub_f32 v44, v36, v96
    v_sub_f32 v45, v37, v96
    v_sub_f32 v46, v38, v96
    v_sub_f32 v47, v39, v96
    v_sub_f32 v48, v40, v96
    v_sub_f32 v49, v41, v96
    v_sub_f32 v50, v42, v96
    v_sub_f32 v51, v43, v96
    v_cvt_pk_bf16_f32 v16, v44, v45
    v_lshlrev_b32 v44, 16, v16
    v_and_b32 v45, 0xffff0000, v16
    v_cvt_pk_bf16_f32 v16, v46, v47
    v_lshlrev_b32 v46, 16, v16
    v_and_b32 v47, 0xffff0000, v16
    v_cvt_pk_bf16_f32 v16, v48, v49
    v_lshlrev_b32 v48, 16, v16
    v_and_b32 v49, 0xffff0000, v16
    v_cvt_pk_bf16_f32 v16, v50, v51
    v_lshlrev_b32 v50, 16, v16
    v_and_b32 v51, 0xffff0000, v16
    v_mul_f32 v52, v44, v99
    v_mul_f32 v53, v45, v99
    v_mul_f32 v54, v46, v99
    v_mul_f32 v55, v47, v99
    v_mul_f32 v56, v48, v99
    v_mul_f32 v57, v49, v99
    v_mul_f32 v58, v50, v99
    v_mul_f32 v59, v51, v99
    v_fma_f32 v44, -v52, v98, v44
    v_fma_f32 v45, -v53, v98, v45
    v_fma_f32 v46, -v54, v98, v46
    v_fma_f32 v47, -v55, v98, v47
    v_fma_f32 v48, -v56, v98, v48
    v_fma_f32 v49, -v57, v98, v49
    v_fma_f32 v50, -v58, v98, v50
    v_fma_f32 v51, -v59, v98, v51
    v_fma_f32 v44, v44, v99, v52
    v_fma_f32 v45, v45, v99, v53
    v_fma_f32 v46, v46, v99, v54
    v_fma_f32 v47, v47, v99, v55
    v_fma_f32 v48, v48, v99, v56
    v_fma_f32 v49, v49, v99, v57
    v_fma_f32 v50, v50, v99, v58
    v_fma_f32 v51, v51, v99, v59
    v_cvt_pk_bf16_f32 v16, v44, v45
    v_lshlrev_b32 v44, 16, v16
    v_and_b32 v45, 0xffff0000, v16
    v_cvt_pk_bf16_f32 v16, v46, v47
    v_lshlrev_b32 v46, 16, v16
    v_and_b32 v47, 0xffff0000, v16
    v_cvt_pk_bf16_f32 v16, v48, v49
    v_lshlrev_b32 v48, 16, v16
    v_and_b32 v49, 0xffff0000, v16
    v_cvt_pk_bf16_f32 v16, v50, v51
    v_lshlrev_b32 v50, 16, v16
    v_and_b32 v51, 0xffff0000, v16
    v_lshlrev_b32 v52, 16, v196
    v_and_b32 v53, 0xffff0000, v196
    v_lshlrev_b32 v54, 16, v197
    v_and_b32 v55, 0xffff0000, v197
    v_lshlrev_b32 v56, 16, v198
    v_and_b32 v57, 0xffff0000, v198
    v_lshlrev_b32 v58, 16, v199
    v_and_b32 v59, 0xffff0000, v199
    v_pk_mul_f32 v[44:45], v[44:45], v[52:53]
    v_pk_mul_f32 v[46:47], v[46:47], v[54:55]
    v_pk_mul_f32 v[48:49], v[48:49], v[56:57]
    v_pk_mul_f32 v[50:51], v[50:51], v[58:59]
    v_cvt_pk_bf16_f32 v16, v44, v45
    v_lshlrev_b32 v44, 16, v16
    v_and_b32 v45, 0xffff0000, v16
    v_cvt_pk_bf16_f32 v16, v46, v47
    v_lshlrev_b32 v46, 16, v16
    v_and_b32 v47, 0xffff0000, v16
    v_cvt_pk_bf16_f32 v16, v48, v49
    v_lshlrev_b32 v48, 16, v16
    v_and_b32 v49, 0xffff0000, v16
    v_cvt_pk_bf16_f32 v16, v50, v51
    v_lshlrev_b32 v50, 16, v16
    v_and_b32 v51, 0xffff0000, v16
    v_lshlrev_b32 v52, 16, v188
    v_and_b32 v53, 0xffff0000, v188
    v_lshlrev_b32 v54, 16, v189
    v_and_b32 v55, 0xffff0000, v189
    v_lshlrev_b32 v56, 16, v190
    v_and_b32 v57, 0xffff0000, v190
    v_lshlrev_b32 v58, 16, v191
    v_and_b32 v59, 0xffff0000, v191
    v_pk_add_f32 v[44:45], v[44:45], v[52:53]
    v_pk_add_f32 v[46:47], v[46:47], v[54:55]
    v_pk_add_f32 v[48:49], v[48:49], v[56:57]
    v_pk_add_f32 v[50:51], v[50:51], v[58:59]
    v_cvt_pk_bf16_f32 v16, v44, v45
    v_lshlrev_b32 v44, 16, v16
    v_and_b32 v45, 0xffff0000, v16
    v_cvt_pk_bf16_f32 v16, v46, v47
    v_lshlrev_b32 v46, 16, v16
    v_and_b32 v47, 0xffff0000, v16
    v_cvt_pk_bf16_f32 v16, v48, v49
    v_lshlrev_b32 v48, 16, v16
    v_and_b32 v49, 0xffff0000, v16
    v_cvt_pk_bf16_f32 v16, v50, v51
    v_lshlrev_b32 v50, 16, v16
    v_and_b32 v51, 0xffff0000, v16
    v_lshlrev_b32 v52, 16, v204
    v_and_b32 v53, 0xffff0000, v204
    v_lshlrev_b32 v54, 16, v205
    v_and_b32 v55, 0xffff0000, v205
    v_lshlrev_b32 v56, 16, v206
    v_and_b32 v57, 0xffff0000, v206
    v_lshlrev_b32 v58, 16, v207
    v_and_b32 v59, 0xffff0000, v207
    v_pk_mul_f32 v[44:45], v[44:45], v[52:53]
    v_pk_mul_f32 v[46:47], v[46:47], v[54:55]
    v_pk_mul_f32 v[48:49], v[48:49], v[56:57]
    v_pk_mul_f32 v[50:51], v[50:51], v[58:59]
    v_cvt_pk_bf16_f32 v16, v44, v45
    v_lshlrev_b32 v44, 16, v16
    v_and_b32 v45, 0xffff0000, v16
    v_cvt_pk_bf16_f32 v16, v46, v47
    v_lshlrev_b32 v46, 16, v16
    v_and_b32 v47, 0xffff0000, v16
    v_cvt_pk_bf16_f32 v16, v48, v49
    v_lshlrev_b32 v48, 16, v16
    v_and_b32 v49, 0xffff0000, v16
    v_cvt_pk_bf16_f32 v16, v50, v51
    v_lshlrev_b32 v50, 16, v16
    v_and_b32 v51, 0xffff0000, v16
    v_pk_add_f32 v[44:45], v[44:45], v[36:37]
    v_pk_add_f32 v[46:47], v[46:47], v[38:39]
    v_pk_add_f32 v[48:49], v[48:49], v[40:41]
    v_pk_add_f32 v[50:51], v[50:51], v[42:43]
    v_cvt_pk_bf16_f32 v36, v44, v45
    v_cvt_pk_bf16_f32 v37, v46, v47
    v_cvt_pk_bf16_f32 v38, v48, v49
    v_cvt_pk_bf16_f32 v39, v50, v51
    s_barrier
    v_and_b32 v16, 3, v1
    v_lshlrev_b32 v16, 4, v16
    v_add_u32 v16, 65792, v16
    ds_read_b32 v76, v16
    s_waitcnt lgkmcnt(0)
    v_mov_b32 v77, v76
    s_nop 1
    v_max_u32_dpp v77, v77, v77 row_ror:1 row_mask:0xf bank_mask:0xf
    s_nop 1
    v_max_u32_dpp v77, v77, v77 row_ror:2 row_mask:0xf bank_mask:0xf
    v_cmp_eq_u32 vcc, v76, v77
    s_ff1_i32_b64 s16, vcc
    s_lshl_b32 s16, s16, 4
    s_add_u32 s16, s16, 65792
    v_mov_b32 v16, s16
    ds_read_b128 v[24:27], v16
    s_waitcnt lgkmcnt(0)
    v_and_b32 v76, 0x7ff, v24
    v_sub_u32 v76, 2047, v76
    s_nop 0
    v_readfirstlane_b32 s12, v76
    v_rcp_f32 v103, v26
    s_lshr_b32 s18, s12, 4
    s_lshl_b32 s18, s18, 15
    s_and_b32 s19, s12, 15
    s_lshl_b32 s19, s19, 6
    s_add_u32 s18, s18, s19
    s_add_u32 s18, s18, 0x2000000
    s_add_u32 s19, s18, 0x400000
    v_lshrrev_b32 v18, 4, v0
    v_lshlrev_b32 v18, 10, v18
    v_and_b32 v19, 15, v0
    v_lshl_add_u32 v18, v19, 2, v18
    s_lshl_b32 s13, s12, 11
    buffer_load_dword v100, v18, s[8:11], s18 offen sc1
    buffer_load_dword v101, v18, s[8:11], s19 offen sc1
    buffer_load_dword v102, v21, s[76:79], s13 offen
    s_lshl_b32 s16, s14, 11
    s_cmp_lg_u32 s12, s14
    s_cselect_b32 s16, s16, 0x7ffffff0
    buffer_store_dwordx4 v[28:31], v2, s[68:71], s16 offen offset:0 sc1
    buffer_store_dwordx4 v[36:39], v2, s[68:71], s16 offen offset:1024 sc1
    s_lshl_b32 s16, s3, 13
    v_add_u32 v20, s16, v2
    s_waitcnt vmcnt(4)
    v_lshlrev_b32 v76, 16, v100
    v_and_b32 v77, 0xffff0000, v100
    s_waitcnt vmcnt(3)
    v_lshlrev_b32 v78, 16, v101
    v_and_b32 v79, 0xffff0000, v101
    v_pk_add_f32 v[76:77], v[76:77], v[78:79]
    s_waitcnt vmcnt(2)
    v_lshlrev_b32 v78, 16, v102
    v_and_b32 v79, 0xffff0000, v102
    v_pk_add_f32 v[92:93], v[78:79], v[76:77]
    v_cvt_pk_bf16_f32 v76, v92, v93
    v_lshlrev_b32 v92, 16, v76
    v_and_b32 v93, 0xffff0000, v76
    v_cvt_pk_bf16_f32 v100, v92, v93
    v_and_b32 v105, 0xffff0000, v104
    v_lshlrev_b32 v104, 16, v104
    v_and_b32 v107, 0xffff0000, v106
    v_lshlrev_b32 v106, 16, v106
    v_sub_f32 v92, v92, v25
    v_sub_f32 v93, v93, v25
    v_cvt_pk_bf16_f32 v76, v92, v93
    v_lshlrev_b32 v92, 16, v76
    v_and_b32 v93, 0xffff0000, v76
    v_mul_f32 v77, v92, v103
    v_fma_f32 v92, -v77, v26, v92
    v_fma_f32 v92, v92, v103, v77
    v_mul_f32 v77, v93, v103
    v_fma_f32 v93, -v77, v26, v93
    v_fma_f32 v93, v93, v103, v77
    v_cvt_pk_bf16_f32 v76, v92, v93
    v_lshlrev_b32 v92, 16, v76
    v_and_b32 v93, 0xffff0000, v76
    v_mul_f32 v92, v92, v104
    v_mul_f32 v93, v93, v105
    v_cvt_pk_bf16_f32 v76, v92, v93
    v_lshlrev_b32 v92, 16, v76
    v_and_b32 v93, 0xffff0000, v76
    v_add_f32 v92, v92, v106
    v_add_f32 v93, v93, v107
    v_cvt_pk_bf16_f32 v101, v92, v93
    v_add_u32 v16, 66560, v21
    ds_write_b32 v16, v101
    ds_write_b32 v16, v100 offset:2048
    s_waitcnt lgkmcnt(0)
    s_barrier
    ds_read_b128 v[60:63], v20 offset:0
    ds_read_b128 v[64:67], v20 offset:1024
    ds_read_b128 v[68:71], v20 offset:2048
    ds_read_b128 v[72:75], v20 offset:3072
    ds_read_b128 v[108:111], v20 offset:4096
    ds_read_b128 v[112:115], v20 offset:5120
    ds_read_b128 v[116:119], v20 offset:6144
    ds_read_b128 v[120:123], v20 offset:7168
    s_and_b32 s16, s3, 3
    s_lshl_b32 s16, s16, 7
    s_and_b32 s17, s29, 3
    s_lshl_b32 s17, s17, 9
    s_add_u32 s16, s16, s17
    s_add_u32 s16, s16, 66560
    v_lshrrev_b32 v16, 3, v1
    v_lshlrev_b32 v16, 4, v16
    v_add_u32 v16, s16, v16
    ds_read_b128 v[104:107], v16
    s_waitcnt lgkmcnt(0)
    v_lshlrev_b32 v76, 16, v104
    v_and_b32 v77, 0xffff, v104
    v_dot2_f32_bf16 v85, v60, v76, 0
    v_dot2_f32_bf16 v84, v60, v77, 0
    v_dot2_f32_bf16 v87, v61, v76, 0
    v_dot2_f32_bf16 v86, v61, v77, 0
    v_dot2_f32_bf16 v89, v62, v76, 0
    v_dot2_f32_bf16 v88, v62, v77, 0
    v_dot2_f32_bf16 v91, v63, v76, 0
    v_dot2_f32_bf16 v90, v63, v77, 0
    v_and_b32 v78, 0xffff0000, v104
    v_lshrrev_b32 v79, 16, v104
    v_dot2c_f32_bf16 v85, v64, v78
    v_dot2c_f32_bf16 v84, v64, v79
    v_dot2c_f32_bf16 v87, v65, v78
    v_dot2c_f32_bf16 v86, v65, v79
    v_dot2c_f32_bf16 v89, v66, v78
    v_dot2c_f32_bf16 v88, v66, v79
    v_dot2c_f32_bf16 v91, v67, v78
    v_dot2c_f32_bf16 v90, v67, v79
    v_lshlrev_b32 v80, 16, v105
    v_and_b32 v81, 0xffff, v105
    v_dot2c_f32_bf16 v85, v68, v80
    v_dot2c_f32_bf16 v84, v68, v81
    v_dot2c_f32_bf16 v87, v69, v80
    v_dot2c_f32_bf16 v86, v69, v81
    v_dot2c_f32_bf16 v89, v70, v80
    v_dot2c_f32_bf16 v88, v70, v81
    v_dot2c_f32_bf16 v91, v71, v80
    v_dot2c_f32_bf16 v90, v71, v81
    v_and_b32 v82, 0xffff0000, v105
    v_lshrrev_b32 v83, 16, v105
    v_dot2c_f32_bf16 v85, v72, v82
    v_dot2c_f32_bf16 v84, v72, v83
    v_dot2c_f32_bf16 v87, v73, v82
    v_dot2c_f32_bf16 v86, v73, v83
    v_dot2c_f32_bf16 v89, v74, v82
    v_dot2c_f32_bf16 v88, v74, v83
    v_dot2c_f32_bf16 v91, v75, v82
    v_dot2c_f32_bf16 v90, v75, v83
    v_lshlrev_b32 v76, 16, v106
    v_and_b32 v77, 0xffff, v106
    v_dot2c_f32_bf16 v85, v108, v76
    v_dot2c_f32_bf16 v84, v108, v77
    v_dot2c_f32_bf16 v87, v109, v76
    v_dot2c_f32_bf16 v86, v109, v77
    v_dot2c_f32_bf16 v89, v110, v76
    v_dot2c_f32_bf16 v88, v110, v77
    v_dot2c_f32_bf16 v91, v111, v76
    v_dot2c_f32_bf16 v90, v111, v77
    v_and_b32 v78, 0xffff0000, v106
    v_lshrrev_b32 v79, 16, v106
    v_dot2c_f32_bf16 v85, v112, v78
    v_dot2c_f32_bf16 v84, v112, v79
    v_dot2c_f32_bf16 v87, v113, v78
    v_dot2c_f32_bf16 v86, v113, v79
    v_dot2c_f32_bf16 v89, v114, v78
    v_dot2c_f32_bf16 v88, v114, v79
    v_dot2c_f32_bf16 v91, v115, v78
    v_dot2c_f32_bf16 v90, v115, v79
    v_lshlrev_b32 v80, 16, v107
    v_and_b32 v81, 0xffff, v107
    v_dot2c_f32_bf16 v85, v116, v80
    v_dot2c_f32_bf16 v84, v116, v81
    v_dot2c_f32_bf16 v87, v117, v80
    v_dot2c_f32_bf16 v86, v117, v81
    v_dot2c_f32_bf16 v89, v118, v80
    v_dot2c_f32_bf16 v88, v118, v81
    v_dot2c_f32_bf16 v91, v119, v80
    v_dot2c_f32_bf16 v90, v119, v81
    v_and_b32 v82, 0xffff0000, v107
    v_lshrrev_b32 v83, 16, v107
    v_dot2c_f32_bf16 v85, v120, v82
    v_dot2c_f32_bf16 v84, v120, v83
    v_dot2c_f32_bf16 v87, v121, v82
    v_dot2c_f32_bf16 v86, v121, v83
    v_dot2c_f32_bf16 v89, v122, v82
    v_dot2c_f32_bf16 v88, v122, v83
    v_dot2c_f32_bf16 v91, v123, v82
    v_dot2c_f32_bf16 v90, v123, v83
    s_nop 0
    v_permlane32_swap_b32 v84, v88
    v_permlane32_swap_b32 v85, v89
    v_permlane32_swap_b32 v86, v90
    v_permlane32_swap_b32 v87, v91
    v_add_f32 v84, v84, v88
    v_add_f32 v85, v85, v89
    v_add_f32 v86, v86, v90
    v_add_f32 v87, v87, v91
    s_nop 0
    v_permlane16_swap_b32 v84, v86
    v_permlane16_swap_b32 v85, v87
    v_add_f32 v84, v84, v86
    v_add_f32 v85, v85, v87
    s_nop 0
    v_add_f32_dpp v84, v84, v84 row_ror:8 row_mask:0xf bank_mask:0xf
    v_add_f32_dpp v85, v85, v85 row_ror:8 row_mask:0xf bank_mask:0xf
    v_and_b32 v16, 7, v1
    v_lshlrev_b32 v16, 5, v16
    v_lshrrev_b32 v17, 4, v1
    v_lshl_add_u32 v16, v17, 3, v16
    s_lshl_b32 s16, s3, 8
    s_add_u32 s16, s16, 70656
    v_add_u32 v16, s16, v16
    ds_write_b64 v16, v[84:85]
    s_lshr_b32 s16, s3, 2
    s_lshl_b32 s17, s16, 10
    s_add_u32 s17, s17, 70656
    v_lshlrev_b32 v17, 2, v1
    v_add_u32 v16, s17, v17
    s_and_b32 s17, s29, 3
    s_lshl_b32 s17, s17, 1
    s_add_u32 s17, s17, s16
    s_mul_i32 s17, s17, 14336
    s_lshr_b32 s16, s29, 2
    s_lshl_b32 s16, s16, 8
    s_add_u32 s17, s17, s16
    s_add_u32 s17, s17, 0x6e1000
    s_and_b32 s16, s3, 3
    s_cmp_eq_u32 s16, 0
    s_cselect_b32 s17, s17, 0x7ffffff0
    s_cmp_lt_u32 s2, 224
    s_cselect_b32 s17, s17, 0x7ffffff0
    s_waitcnt lgkmcnt(0)
    s_barrier
    ds_read_b32 v84, v16 offset:0
    ds_read_b32 v85, v16 offset:256
    ds_read_b32 v86, v16 offset:512
    ds_read_b32 v87, v16 offset:768
    s_waitcnt lgkmcnt(2)
    v_add_f32 v84, v84, v85
    s_waitcnt lgkmcnt(0)
    v_add_f32 v86, v86, v87
    v_add_f32 v84, v84, v86
    v_or_b32 v84, 1, v84
    buffer_store_dword v84, v17, s[8:11], s17 offen sc1
    v_lshrrev_b32 v16, 4, v1
    v_mul_u32_u24 v16, 28672, v16
    v_and_b32 v17, 15, v1
    v_lshl_add_u32 v16, v17, 2, v16
    s_lshl_b32 s16, s29, 6
    s_add_u32 s16, s16, 0x6e1000
    s_add_u32 s17, s16, 14336
    s_mov_b32 s27, 0
adaLN_cond__sliding_block_cached__moe_arch_mod__prompt_kernel_gu23p:
    buffer_load_dword v84, v16, s[8:11], s16 offen sc1
    buffer_load_dword v85, v16, s[8:11], s17 offen sc1
    s_waitcnt vmcnt(0)
    v_min_u32 v86, v84, v85
    v_cmp_eq_u32 vcc, 0, v86
    s_cmp_lt_u32 s2, 224
    s_cselect_b64 s[62:63], -1, 0
    s_and_b64 vcc, vcc, s[62:63]
    s_add_u32 s27, s27, 1
    s_cmp_ge_u32 s27, 65536
    s_cbranch_scc1 adaLN_cond__sliding_block_cached__moe_arch_mod__prompt_kernel_gu23g
    s_cbranch_vccnz adaLN_cond__sliding_block_cached__moe_arch_mod__prompt_kernel_gu23p
adaLN_cond__sliding_block_cached__moe_arch_mod__prompt_kernel_gu23g:
    v_mov_b32 v86, v84
    s_nop 1
    v_permlane16_swap_b32 v84, v86
    v_add_f32 v84, v84, v86
    v_mov_b32 v87, v85
    s_nop 1
    v_permlane16_swap_b32 v85, v87
    v_add_f32 v85, v85, v87
    v_mov_b32 v86, v84
    s_nop 1
    v_permlane32_swap_b32 v84, v86
    v_add_f32 v84, v84, v86
    v_mov_b32 v87, v85
    s_nop 1
    v_permlane32_swap_b32 v85, v87
    v_add_f32 v85, v85, v87
    v_cvt_pk_bf16_f32 v86, v84, v85
    v_lshlrev_b32 v84, 16, v86
    v_and_b32 v85, 0xffff0000, v86
    v_mul_f32 v86, 0xbfb8aa3b, v84
    v_exp_f32 v86, v86
    s_nop 0
    v_add_f32 v86, 1.0, v86
    v_rcp_f32 v86, v86
    s_nop 0
    v_mul_f32 v84, v84, v86
    v_cvt_pk_bf16_f32 v84, v84, v84
    v_lshlrev_b32 v84, 16, v84
    v_mul_f32 v84, v84, v85
    v_cvt_pk_bf16_f32 v84, v84, v84
    v_lshlrev_b32 v84, 16, v84
    s_sub_u32 s16, s3, 4
    s_lshl_b32 s16, s16, 2
    s_add_u32 s17, s16, 0
    v_readlane_b32 s20, v84, s17
    s_lshr_b32 s4, s20, 16
    s_add_u32 s17, s16, 1
    v_readlane_b32 s21, v84, s17
    s_lshr_b32 s5, s21, 16
    s_add_u32 s17, s16, 2
    v_readlane_b32 s22, v84, s17
    s_lshr_b32 s6, s22, 16
    s_add_u32 s17, s16, 3
    v_readlane_b32 s23, v84, s17
    s_lshr_b32 s7, s23, 16
    v_dot2_f32_bf16 v45, v152, s20, 0
    v_dot2_f32_bf16 v44, v152, s4, 0
    v_dot2_f32_bf16 v47, v153, s20, 0
    v_dot2_f32_bf16 v46, v153, s4, 0
    v_dot2_f32_bf16 v49, v154, s20, 0
    v_dot2_f32_bf16 v48, v154, s4, 0
    v_dot2_f32_bf16 v51, v155, s20, 0
    v_dot2_f32_bf16 v50, v155, s4, 0
    v_dot2_f32_bf16 v53, v156, s20, 0
    v_dot2_f32_bf16 v52, v156, s4, 0
    v_dot2_f32_bf16 v55, v157, s20, 0
    v_dot2_f32_bf16 v54, v157, s4, 0
    v_dot2_f32_bf16 v57, v158, s20, 0
    v_dot2_f32_bf16 v56, v158, s4, 0
    v_dot2_f32_bf16 v59, v159, s20, 0
    v_dot2_f32_bf16 v58, v159, s4, 0
    v_dot2c_f32_bf16 v45, s21, v160
    v_dot2c_f32_bf16 v44, s5, v160
    v_dot2c_f32_bf16 v47, s21, v161
    v_dot2c_f32_bf16 v46, s5, v161
    v_dot2c_f32_bf16 v49, s21, v162
    v_dot2c_f32_bf16 v48, s5, v162
    v_dot2c_f32_bf16 v51, s21, v163
    v_dot2c_f32_bf16 v50, s5, v163
    v_dot2c_f32_bf16 v53, s21, v164
    v_dot2c_f32_bf16 v52, s5, v164
    v_dot2c_f32_bf16 v55, s21, v165
    v_dot2c_f32_bf16 v54, s5, v165
    v_dot2c_f32_bf16 v57, s21, v166
    v_dot2c_f32_bf16 v56, s5, v166
    v_dot2c_f32_bf16 v59, s21, v167
    v_dot2c_f32_bf16 v58, s5, v167
    v_dot2c_f32_bf16 v45, s22, v168
    v_dot2c_f32_bf16 v44, s6, v168
    v_dot2c_f32_bf16 v47, s22, v169
    v_dot2c_f32_bf16 v46, s6, v169
    v_dot2c_f32_bf16 v49, s22, v170
    v_dot2c_f32_bf16 v48, s6, v170
    v_dot2c_f32_bf16 v51, s22, v171
    v_dot2c_f32_bf16 v50, s6, v171
    v_dot2c_f32_bf16 v53, s22, v172
    v_dot2c_f32_bf16 v52, s6, v172
    v_dot2c_f32_bf16 v55, s22, v173
    v_dot2c_f32_bf16 v54, s6, v173
    v_dot2c_f32_bf16 v57, s22, v174
    v_dot2c_f32_bf16 v56, s6, v174
    v_dot2c_f32_bf16 v59, s22, v175
    v_dot2c_f32_bf16 v58, s6, v175
    v_dot2c_f32_bf16 v45, s23, v176
    v_dot2c_f32_bf16 v44, s7, v176
    v_dot2c_f32_bf16 v47, s23, v177
    v_dot2c_f32_bf16 v46, s7, v177
    v_dot2c_f32_bf16 v49, s23, v178
    v_dot2c_f32_bf16 v48, s7, v178
    v_dot2c_f32_bf16 v51, s23, v179
    v_dot2c_f32_bf16 v50, s7, v179
    v_dot2c_f32_bf16 v53, s23, v180
    v_dot2c_f32_bf16 v52, s7, v180
    v_dot2c_f32_bf16 v55, s23, v181
    v_dot2c_f32_bf16 v54, s7, v181
    v_dot2c_f32_bf16 v57, s23, v182
    v_dot2c_f32_bf16 v56, s7, v182
    v_dot2c_f32_bf16 v59, s23, v183
    v_dot2c_f32_bf16 v58, s7, v183
    s_sub_u32 s16, s3, 4
    s_lshl_b32 s16, s16, 12
    s_add_u32 s16, s16, 73728
    v_lshlrev_b32 v16, 5, v1
    v_add_u32 v16, s16, v16
    ds_write_b128 v16, v[44:47] offset:0
    ds_write_b128 v16, v[48:51] offset:16
    ds_write_b128 v16, v[52:55] offset:2048
    ds_write_b128 v16, v[56:59] offset:2064
    s_waitcnt lgkmcnt(0)
    s_barrier
    v_lshlrev_b32 v16, 3, v0
    v_add_u32 v17, 73728, v16
    ds_read_b64 v[84:85], v17 offset:0
    ds_read_b64 v[86:87], v17 offset:4096
    ds_read_b64 v[88:89], v17 offset:8192
    ds_read_b64 v[90:91], v17 offset:12288
    s_waitcnt lgkmcnt(2)
    v_pk_add_f32 v[84:85], v[84:85], v[86:87]
    s_waitcnt lgkmcnt(0)
    v_pk_add_f32 v[88:89], v[88:89], v[90:91]
    v_pk_add_f32 v[84:85], v[84:85], v[88:89]
    v_or_b32 v84, 1, v84
    v_or_b32 v85, 1, v85
    s_lshl_b32 s16, s29, 12
    s_add_u32 s16, s16, 0x600000
    s_cmp_lt_u32 s2, 224
    s_cselect_b32 s16, s16, 0x7ffffff0
    buffer_store_dwordx2 v[84:85], v16, s[8:11], s16 offen sc1
    s_cmp_lt_u32 s2, 224
    s_cbranch_scc1 adaLN_cond__sliding_block_cached__moe_arch_mod__prompt_kernel_end
    s_sub_u32 s16, s2, 224
    s_lshl_b32 s17, s16, 7
    s_add_u32 s17, s17, 0x600000
    v_lshrrev_b32 v16, 3, v0
    v_lshlrev_b32 v16, 12, v16
    v_and_b32 v17, 7, v0
    v_lshl_add_u32 v16, v17, 4, v16
    v_cmp_gt_u32 vcc, 256, v0
    v_bfrev_b32 v17, -2
    s_nop 0
    v_cndmask_b32 v17, v17, v16, vcc
    v_mov_b32 v19, 0
    v_cndmask_b32 v18, 1, v19, vcc
    s_lshl_b32 s18, s16, 6
    v_and_b32 v19, 31, v1
    v_lshlrev_b32 v19, 1, v19
    v_add_u32 v19, s18, v19
    s_mov_b32 s19, 0x541800
    buffer_load_ushort v95, v19, s[8:11], s19 offen sc1
    v_add_u32 v20, 66560, v19
    ds_read_u16 v96, v20
    ds_read_u16 v97, v20 offset:2048
    v_mov_b32 v94, v27
    v_cvt_pk_bf16_f32 v94, v94, v94
    v_lshlrev_b32 v94, 16, v94
    v_mul_f32 v94, 0xbfb8aa3b, v94
    v_exp_f32 v94, v94
    s_nop 0
    v_add_f32 v94, 1.0, v94
    v_rcp_f32 v94, v94
    s_nop 0
    v_cvt_pk_bf16_f32 v94, v94, v94
    v_lshlrev_b32 v94, 16, v94
    s_waitcnt vmcnt(0)
    v_lshlrev_b32 v95, 16, v95
    s_waitcnt lgkmcnt(1)
    v_lshlrev_b32 v96, 16, v96
    s_waitcnt lgkmcnt(0)
    v_lshlrev_b32 v97, 16, v97
    s_mov_b32 s27, 0
adaLN_cond__sliding_block_cached__moe_arch_mod__prompt_kernel_y24p:
    s_add_u32 s19, s17, 0x0
    buffer_load_dwordx4 v[44:47], v16, s[8:11], s19 offen sc1
    s_add_u32 s19, s17, 0x40000
    buffer_load_dwordx4 v[48:51], v16, s[8:11], s19 offen sc1
    s_add_u32 s19, s17, 0x80000
    buffer_load_dwordx4 v[52:55], v16, s[8:11], s19 offen sc1
    s_add_u32 s19, s17, 0xc0000
    buffer_load_dwordx4 v[56:59], v17, s[8:11], s19 offen sc1
    s_waitcnt vmcnt(0)
    v_min3_u32 v98, v56, v57, v58
    v_min_u32 v98, v98, v59
    v_or_b32 v98, v98, v18
    v_min3_u32 v98, v98, v44, v45
    v_min3_u32 v98, v98, v46, v47
    v_min3_u32 v98, v98, v48, v49
    v_min3_u32 v98, v98, v50, v51
    v_min3_u32 v98, v98, v52, v53
    v_min3_u32 v98, v98, v54, v55
    v_cmp_eq_u32 vcc, 0, v98
    s_add_u32 s27, s27, 1
    s_cmp_ge_u32 s27, 65536
    s_cbranch_scc1 adaLN_cond__sliding_block_cached__moe_arch_mod__prompt_kernel_y24g
    s_cbranch_vccnz adaLN_cond__sliding_block_cached__moe_arch_mod__prompt_kernel_y24p
adaLN_cond__sliding_block_cached__moe_arch_mod__prompt_kernel_y24g:
    v_pk_add_f32 v[44:45], v[44:45], v[52:53]
    v_pk_add_f32 v[46:47], v[46:47], v[54:55]
    v_pk_add_f32 v[48:49], v[48:49], v[56:57]
    v_pk_add_f32 v[50:51], v[50:51], v[58:59]
    v_pk_add_f32 v[44:45], v[44:45], v[48:49]
    v_pk_add_f32 v[46:47], v[46:47], v[50:51]
    s_nop 0
    v_add_f32_dpp v44, v44, v44 row_ror:8 row_mask:0xf bank_mask:0xf
    v_add_f32_dpp v45, v45, v45 row_ror:8 row_mask:0xf bank_mask:0xf
    v_add_f32_dpp v46, v46, v46 row_ror:8 row_mask:0xf bank_mask:0xf
    v_add_f32_dpp v47, v47, v47 row_ror:8 row_mask:0xf bank_mask:0xf
    s_nop 0
    v_permlane32_swap_b32 v44, v46
    v_permlane32_swap_b32 v45, v47
    v_add_f32 v44, v44, v46
    v_add_f32 v45, v45, v47
    s_nop 1
    v_permlane16_swap_b32 v44, v45
    v_add_f32 v44, v44, v45
    v_and_b32 v16, 7, v1
    v_lshlrev_b32 v16, 4, v16
    v_lshrrev_b32 v17, 4, v1
    v_lshl_add_u32 v16, v17, 2, v16
    s_lshl_b32 s19, s3, 7
    s_add_u32 s19, s19, 91136
    v_add_u32 v16, s19, v16
    ds_write_b32 v16, v44
    v_and_b32 v16, 31, v1
    v_lshlrev_b32 v16, 2, v16
    v_add_u32 v16, 91136, v16
    s_waitcnt lgkmcnt(0)
    s_barrier
    s_cmp_lg_u32 s3, 0
    s_cbranch_scc1 adaLN_cond__sliding_block_cached__moe_arch_mod__prompt_kernel_end
    ds_read_b32 v44, v16 offset:0
    ds_read_b32 v45, v16 offset:128
    ds_read_b32 v46, v16 offset:256
    ds_read_b32 v47, v16 offset:384
    ds_read_b32 v48, v16 offset:512
    ds_read_b32 v49, v16 offset:640
    ds_read_b32 v50, v16 offset:768
    ds_read_b32 v51, v16 offset:896
    s_waitcnt lgkmcnt(3)
    v_add_f32 v44, v44, v48
    s_waitcnt lgkmcnt(2)
    v_add_f32 v45, v45, v49
    s_waitcnt lgkmcnt(1)
    v_add_f32 v46, v46, v50
    s_waitcnt lgkmcnt(0)
    v_add_f32 v47, v47, v51
    v_add_f32 v44, v44, v46
    v_add_f32 v45, v45, v47
    v_add_f32 v44, v44, v45
    v_cvt_pk_bf16_f32 v44, v44, v44
    v_lshlrev_b32 v44, 16, v44
    v_mul_f32 v44, v44, v94
    v_cvt_pk_bf16_f32 v44, v44, v44
    v_lshlrev_b32 v44, 16, v44
    v_add_f32 v44, v44, v96
    v_cvt_pk_bf16_f32 v44, v44, v44
    v_lshlrev_b32 v44, 16, v44
    v_mul_f32 v44, v44, v95
    v_cvt_pk_bf16_f32 v44, v44, v44
    v_lshlrev_b32 v44, 16, v44
    v_add_f32 v44, v44, v97
    v_cvt_pk_bf16_f32 v44, v44, v44
    s_mov_b64 exec, 0xffffffff
    buffer_store_short v44, v19, s[68:71], s13 offen sc1
adaLN_cond__sliding_block_cached__moe_arch_mod__prompt_kernel_end:
    s_endpgm
adaLN_cond__sliding_block_cached__moe_arch_mod__prompt_kernel_n1r:
    s_mov_b32 s27, 0
adaLN_cond__sliding_block_cached__moe_arch_mod__prompt_kernel_n1p:
    buffer_load_dword v134, v132, s[64:67], 0 offen sc1
    s_waitcnt vmcnt(0)
    v_cmp_eq_u32 vcc, 0, v134
    s_cmp_eq_u32 s3, 0
    s_cselect_b64 s[62:63], -1, 0
    s_and_b64 vcc, vcc, s[62:63]
    s_add_u32 s27, s27, 1
    s_cmp_ge_u32 s27, 65536
    s_cbranch_scc1 adaLN_cond__sliding_block_cached__moe_arch_mod__prompt_kernel_n1g
    s_cbranch_vccnz adaLN_cond__sliding_block_cached__moe_arch_mod__prompt_kernel_n1p
adaLN_cond__sliding_block_cached__moe_arch_mod__prompt_kernel_n1g:
    s_waitcnt vmcnt(0) lgkmcnt(0)
    s_nop 15
    s_nop 3
    s_branch adaLN_cond__sliding_block_cached__moe_arch_mod__prompt_kernel_n1b
adaLN_cond__sliding_block_cached__moe_arch_mod__prompt_kernel_kv4r:
    s_waitcnt vmcnt(0) lgkmcnt(0)
    s_nop 15
    s_nop 3
    s_mov_b32 s27, 0
adaLN_cond__sliding_block_cached__moe_arch_mod__prompt_kernel_kv4p:
    buffer_load_dwordx4 v[12:15], v21, s[8:11], s18 offen sc1
    s_waitcnt vmcnt(0)
    v_xor_b32 v8, s28, v12
    v_xor_b32 v20, s28, v13
    v_or_b32 v8, v8, v20
    v_xor_b32 v20, s28, v14
    v_or_b32 v8, v8, v20
    v_xor_b32 v20, s28, v15
    v_or_b32 v8, v8, v20
    v_cmp_ne_u32 vcc, 0, v8
    s_add_u32 s27, s27, 1
    s_cmp_ge_u32 s27, 65536
    s_cbranch_scc1 adaLN_cond__sliding_block_cached__moe_arch_mod__prompt_kernel_kv4g
    s_cbranch_vccnz adaLN_cond__sliding_block_cached__moe_arch_mod__prompt_kernel_kv4p
adaLN_cond__sliding_block_cached__moe_arch_mod__prompt_kernel_kv4g:
    s_waitcnt vmcnt(0) lgkmcnt(0)
    s_nop 15
    s_nop 3
    s_branch adaLN_cond__sliding_block_cached__moe_arch_mod__prompt_kernel_kv4b
adaLN_cond__sliding_block_cached__moe_arch_mod__prompt_kernel_fixA:
    s_waitcnt vmcnt(0) lgkmcnt(0)
    s_nop 15
    s_nop 3
    s_lshr_b32 s16, s12, 3
    s_lshl_b32 s16, s16, 17
    s_add_u32 s16, s16, 0x400000
    v_add_u32 v8, s16, v2
    v_mov_b32 v16, 0xff7fffff
    v_mov_b32 v17, 0xff7fffff
    s_mov_b32 s16, 0
adaLN_cond__sliding_block_cached__moe_arch_mod__prompt_kernel_fixAm:
    s_add_u32 s17, s16, 0
    buffer_load_dwordx4 v[200:203], v8, s[8:11], s17 offen offset:0
    buffer_load_dwordx4 v[204:207], v8, s[8:11], s17 offen offset:1024
    buffer_load_dwordx4 v[208:211], v8, s[8:11], s17 offen offset:2048
    buffer_load_dwordx4 v[212:215], v8, s[8:11], s17 offen offset:3072
    s_waitcnt vmcnt(3)
    v_mfma_f32_16x16x32_bf16 v[184:187], v[200:203], v[152:155], 0
    v_mfma_f32_16x16x32_bf16 v[188:191], v[200:203], v[168:171], 0
    s_waitcnt vmcnt(2)
    v_mfma_f32_16x16x32_bf16 v[192:195], v[204:207], v[152:155], 0
    v_mfma_f32_16x16x32_bf16 v[196:199], v[204:207], v[168:171], 0
    s_waitcnt vmcnt(1)
    v_mfma_f32_16x16x32_bf16 v[184:187], v[208:211], v[156:159], v[184:187]
    v_mfma_f32_16x16x32_bf16 v[188:191], v[208:211], v[172:175], v[188:191]
    s_waitcnt vmcnt(0)
    v_mfma_f32_16x16x32_bf16 v[192:195], v[212:215], v[156:159], v[192:195]
    v_mfma_f32_16x16x32_bf16 v[196:199], v[212:215], v[172:175], v[196:199]
    s_add_u32 s17, s16, 4096
    buffer_load_dwordx4 v[200:203], v8, s[8:11], s17 offen offset:0
    buffer_load_dwordx4 v[204:207], v8, s[8:11], s17 offen offset:1024
    buffer_load_dwordx4 v[208:211], v8, s[8:11], s17 offen offset:2048
    buffer_load_dwordx4 v[212:215], v8, s[8:11], s17 offen offset:3072
    s_waitcnt vmcnt(3)
    v_mfma_f32_16x16x32_bf16 v[184:187], v[200:203], v[160:163], v[184:187]
    v_mfma_f32_16x16x32_bf16 v[188:191], v[200:203], v[176:179], v[188:191]
    s_waitcnt vmcnt(2)
    v_mfma_f32_16x16x32_bf16 v[192:195], v[204:207], v[160:163], v[192:195]
    v_mfma_f32_16x16x32_bf16 v[196:199], v[204:207], v[176:179], v[196:199]
    s_waitcnt vmcnt(1)
    v_mfma_f32_16x16x32_bf16 v[184:187], v[208:211], v[164:167], v[184:187]
    v_mfma_f32_16x16x32_bf16 v[188:191], v[208:211], v[180:183], v[188:191]
    s_waitcnt vmcnt(0)
    v_mfma_f32_16x16x32_bf16 v[192:195], v[212:215], v[164:167], v[192:195]
    v_mfma_f32_16x16x32_bf16 v[196:199], v[212:215], v[180:183], v[196:199]
    s_nop 3
    v_max3_f32 v16, v16, v184, v185
    v_max3_f32 v16, v16, v186, v187
    v_max3_f32 v17, v17, v188, v189
    v_max3_f32 v17, v17, v190, v191
    v_max3_f32 v16, v16, v192, v193
    v_max3_f32 v16, v16, v194, v195
    v_max3_f32 v17, v17, v196, v197
    v_max3_f32 v17, v17, v198, v199
    s_add_u32 s16, s16, 8192
    s_cmp_lt_u32 s16, 0x20000
    s_cbranch_scc1 adaLN_cond__sliding_block_cached__moe_arch_mod__prompt_kernel_fixAm
    v_mov_b32 v18, v16
    v_mov_b32 v19, v17
    s_nop 0
    v_permlane16_swap_b32 v16, v18
    v_permlane16_swap_b32 v17, v19
    v_max_f32 v16, v16, v18
    v_max_f32 v17, v17, v19
    v_mov_b32 v18, v16
    v_mov_b32 v19, v17
    s_nop 0
    v_permlane32_swap_b32 v16, v18
    v_permlane32_swap_b32 v17, v19
    v_max_f32 v16, v16, v18
    v_max_f32 v17, v17, v19
    v_sub_f32 v216, 0, v16
    v_sub_f32 v217, 0, v16
    v_sub_f32 v218, 0, v16
    v_sub_f32 v219, 0, v16
    v_sub_f32 v220, 0, v17
    v_sub_f32 v221, 0, v17
    v_sub_f32 v222, 0, v17
    v_sub_f32 v223, 0, v17
    s_mov_b32 s17, 0x0
    buffer_load_dwordx4 v[200:203], v8, s[8:11], s17 offen offset:0
    buffer_load_dwordx4 v[204:207], v8, s[8:11], s17 offen offset:1024
    buffer_load_dwordx4 v[208:211], v8, s[8:11], s17 offen offset:2048
    buffer_load_dwordx4 v[212:215], v8, s[8:11], s17 offen offset:3072
    s_waitcnt vmcnt(3)
    v_mfma_f32_16x16x32_bf16 v[184:187], v[200:203], v[152:155], v[216:219]
    v_mfma_f32_16x16x32_bf16 v[188:191], v[200:203], v[168:171], v[220:223]
    s_waitcnt vmcnt(2)
    v_mfma_f32_16x16x32_bf16 v[192:195], v[204:207], v[152:155], v[216:219]
    v_mfma_f32_16x16x32_bf16 v[196:199], v[204:207], v[168:171], v[220:223]
    s_waitcnt vmcnt(1)
    v_mfma_f32_16x16x32_bf16 v[184:187], v[208:211], v[156:159], v[184:187]
    v_mfma_f32_16x16x32_bf16 v[188:191], v[208:211], v[172:175], v[188:191]
    s_waitcnt vmcnt(0)
    v_mfma_f32_16x16x32_bf16 v[192:195], v[212:215], v[156:159], v[192:195]
    v_mfma_f32_16x16x32_bf16 v[196:199], v[212:215], v[172:175], v[196:199]
    s_mov_b32 s17, 0x1000
    buffer_load_dwordx4 v[200:203], v8, s[8:11], s17 offen offset:0
    buffer_load_dwordx4 v[204:207], v8, s[8:11], s17 offen offset:1024
    buffer_load_dwordx4 v[208:211], v8, s[8:11], s17 offen offset:2048
    buffer_load_dwordx4 v[212:215], v8, s[8:11], s17 offen offset:3072
    s_waitcnt vmcnt(3)
    v_mfma_f32_16x16x32_bf16 v[184:187], v[200:203], v[160:163], v[184:187]
    v_mfma_f32_16x16x32_bf16 v[188:191], v[200:203], v[176:179], v[188:191]
    s_waitcnt vmcnt(2)
    v_mfma_f32_16x16x32_bf16 v[192:195], v[204:207], v[160:163], v[192:195]
    v_mfma_f32_16x16x32_bf16 v[196:199], v[204:207], v[176:179], v[196:199]
    s_waitcnt vmcnt(1)
    v_mfma_f32_16x16x32_bf16 v[184:187], v[208:211], v[164:167], v[184:187]
    v_mfma_f32_16x16x32_bf16 v[188:191], v[208:211], v[180:183], v[188:191]
    s_waitcnt vmcnt(0)
    v_mfma_f32_16x16x32_bf16 v[192:195], v[212:215], v[164:167], v[192:195]
    v_mfma_f32_16x16x32_bf16 v[196:199], v[212:215], v[180:183], v[196:199]
    s_nop 3
    v_exp_f32 v184, v184
    v_exp_f32 v185, v185
    s_nop 0
    v_add_f32 v9, v184, v185
    v_cvt_pk_bf16_f32 v24, v184, v185
    v_exp_f32 v186, v186
    v_exp_f32 v187, v187
    v_add_f32 v9, v9, v186
    v_add_f32 v9, v9, v187
    v_cvt_pk_bf16_f32 v25, v186, v187
    v_exp_f32 v188, v188
    v_exp_f32 v189, v189
    s_nop 0
    v_add_f32 v10, v188, v189
    v_cvt_pk_bf16_f32 v28, v188, v189
    v_exp_f32 v190, v190
    v_exp_f32 v191, v191
    v_add_f32 v10, v10, v190
    v_add_f32 v10, v10, v191
    v_cvt_pk_bf16_f32 v29, v190, v191
    v_exp_f32 v192, v192
    v_exp_f32 v193, v193
    v_add_f32 v9, v9, v192
    v_add_f32 v9, v9, v193
    v_cvt_pk_bf16_f32 v26, v192, v193
    v_exp_f32 v194, v194
    v_exp_f32 v195, v195
    v_add_f32 v9, v9, v194
    v_add_f32 v9, v9, v195
    v_cvt_pk_bf16_f32 v27, v194, v195
    v_exp_f32 v196, v196
    v_exp_f32 v197, v197
    v_add_f32 v10, v10, v196
    v_add_f32 v10, v10, v197
    v_cvt_pk_bf16_f32 v30, v196, v197
    v_exp_f32 v198, v198
    v_exp_f32 v199, v199
    v_add_f32 v10, v10, v198
    v_add_f32 v10, v10, v199
    v_cvt_pk_bf16_f32 v31, v198, v199
    s_mov_b32 s17, 0x2000
    buffer_load_dwordx4 v[200:203], v8, s[8:11], s17 offen offset:0
    buffer_load_dwordx4 v[204:207], v8, s[8:11], s17 offen offset:1024
    buffer_load_dwordx4 v[208:211], v8, s[8:11], s17 offen offset:2048
    buffer_load_dwordx4 v[212:215], v8, s[8:11], s17 offen offset:3072
    s_waitcnt vmcnt(3)
    v_mfma_f32_16x16x32_bf16 v[184:187], v[200:203], v[152:155], v[216:219]
    v_mfma_f32_16x16x32_bf16 v[188:191], v[200:203], v[168:171], v[220:223]
    s_waitcnt vmcnt(2)
    v_mfma_f32_16x16x32_bf16 v[192:195], v[204:207], v[152:155], v[216:219]
    v_mfma_f32_16x16x32_bf16 v[196:199], v[204:207], v[168:171], v[220:223]
    s_waitcnt vmcnt(1)
    v_mfma_f32_16x16x32_bf16 v[184:187], v[208:211], v[156:159], v[184:187]
    v_mfma_f32_16x16x32_bf16 v[188:191], v[208:211], v[172:175], v[188:191]
    s_waitcnt vmcnt(0)
    v_mfma_f32_16x16x32_bf16 v[192:195], v[212:215], v[156:159], v[192:195]
    v_mfma_f32_16x16x32_bf16 v[196:199], v[212:215], v[172:175], v[196:199]
    s_mov_b32 s17, 0x3000
    buffer_load_dwordx4 v[200:203], v8, s[8:11], s17 offen offset:0
    buffer_load_dwordx4 v[204:207], v8, s[8:11], s17 offen offset:1024
    buffer_load_dwordx4 v[208:211], v8, s[8:11], s17 offen offset:2048
    buffer_load_dwordx4 v[212:215], v8, s[8:11], s17 offen offset:3072
    s_waitcnt vmcnt(3)
    v_mfma_f32_16x16x32_bf16 v[184:187], v[200:203], v[160:163], v[184:187]
    v_mfma_f32_16x16x32_bf16 v[188:191], v[200:203], v[176:179], v[188:191]
    s_waitcnt vmcnt(2)
    v_mfma_f32_16x16x32_bf16 v[192:195], v[204:207], v[160:163], v[192:195]
    v_mfma_f32_16x16x32_bf16 v[196:199], v[204:207], v[176:179], v[196:199]
    s_waitcnt vmcnt(1)
    v_mfma_f32_16x16x32_bf16 v[184:187], v[208:211], v[164:167], v[184:187]
    v_mfma_f32_16x16x32_bf16 v[188:191], v[208:211], v[180:183], v[188:191]
    s_waitcnt vmcnt(0)
    v_mfma_f32_16x16x32_bf16 v[192:195], v[212:215], v[164:167], v[192:195]
    v_mfma_f32_16x16x32_bf16 v[196:199], v[212:215], v[180:183], v[196:199]
    s_nop 3
    v_exp_f32 v184, v184
    v_exp_f32 v185, v185
    v_add_f32 v9, v9, v184
    v_add_f32 v9, v9, v185
    v_cvt_pk_bf16_f32 v32, v184, v185
    v_exp_f32 v186, v186
    v_exp_f32 v187, v187
    v_add_f32 v9, v9, v186
    v_add_f32 v9, v9, v187
    v_cvt_pk_bf16_f32 v33, v186, v187
    v_exp_f32 v188, v188
    v_exp_f32 v189, v189
    v_add_f32 v10, v10, v188
    v_add_f32 v10, v10, v189
    v_cvt_pk_bf16_f32 v36, v188, v189
    v_exp_f32 v190, v190
    v_exp_f32 v191, v191
    v_add_f32 v10, v10, v190
    v_add_f32 v10, v10, v191
    v_cvt_pk_bf16_f32 v37, v190, v191
    v_exp_f32 v192, v192
    v_exp_f32 v193, v193
    v_add_f32 v9, v9, v192
    v_add_f32 v9, v9, v193
    v_cvt_pk_bf16_f32 v34, v192, v193
    v_exp_f32 v194, v194
    v_exp_f32 v195, v195
    v_add_f32 v9, v9, v194
    v_add_f32 v9, v9, v195
    v_cvt_pk_bf16_f32 v35, v194, v195
    v_exp_f32 v196, v196
    v_exp_f32 v197, v197
    v_add_f32 v10, v10, v196
    v_add_f32 v10, v10, v197
    v_cvt_pk_bf16_f32 v38, v196, v197
    v_exp_f32 v198, v198
    v_exp_f32 v199, v199
    v_add_f32 v10, v10, v198
    v_add_f32 v10, v10, v199
    v_cvt_pk_bf16_f32 v39, v198, v199
    s_mov_b32 s17, 0x4000
    buffer_load_dwordx4 v[200:203], v8, s[8:11], s17 offen offset:0
    buffer_load_dwordx4 v[204:207], v8, s[8:11], s17 offen offset:1024
    buffer_load_dwordx4 v[208:211], v8, s[8:11], s17 offen offset:2048
    buffer_load_dwordx4 v[212:215], v8, s[8:11], s17 offen offset:3072
    s_waitcnt vmcnt(3)
    v_mfma_f32_16x16x32_bf16 v[184:187], v[200:203], v[152:155], v[216:219]
    v_mfma_f32_16x16x32_bf16 v[188:191], v[200:203], v[168:171], v[220:223]
    s_waitcnt vmcnt(2)
    v_mfma_f32_16x16x32_bf16 v[192:195], v[204:207], v[152:155], v[216:219]
    v_mfma_f32_16x16x32_bf16 v[196:199], v[204:207], v[168:171], v[220:223]
    s_waitcnt vmcnt(1)
    v_mfma_f32_16x16x32_bf16 v[184:187], v[208:211], v[156:159], v[184:187]
    v_mfma_f32_16x16x32_bf16 v[188:191], v[208:211], v[172:175], v[188:191]
    s_waitcnt vmcnt(0)
    v_mfma_f32_16x16x32_bf16 v[192:195], v[212:215], v[156:159], v[192:195]
    v_mfma_f32_16x16x32_bf16 v[196:199], v[212:215], v[172:175], v[196:199]
    s_mov_b32 s17, 0x5000
    buffer_load_dwordx4 v[200:203], v8, s[8:11], s17 offen offset:0
    buffer_load_dwordx4 v[204:207], v8, s[8:11], s17 offen offset:1024
    buffer_load_dwordx4 v[208:211], v8, s[8:11], s17 offen offset:2048
    buffer_load_dwordx4 v[212:215], v8, s[8:11], s17 offen offset:3072
    s_waitcnt vmcnt(3)
    v_mfma_f32_16x16x32_bf16 v[184:187], v[200:203], v[160:163], v[184:187]
    v_mfma_f32_16x16x32_bf16 v[188:191], v[200:203], v[176:179], v[188:191]
    s_waitcnt vmcnt(2)
    v_mfma_f32_16x16x32_bf16 v[192:195], v[204:207], v[160:163], v[192:195]
    v_mfma_f32_16x16x32_bf16 v[196:199], v[204:207], v[176:179], v[196:199]
    s_waitcnt vmcnt(1)
    v_mfma_f32_16x16x32_bf16 v[184:187], v[208:211], v[164:167], v[184:187]
    v_mfma_f32_16x16x32_bf16 v[188:191], v[208:211], v[180:183], v[188:191]
    s_waitcnt vmcnt(0)
    v_mfma_f32_16x16x32_bf16 v[192:195], v[212:215], v[164:167], v[192:195]
    v_mfma_f32_16x16x32_bf16 v[196:199], v[212:215], v[180:183], v[196:199]
    s_nop 3
    v_exp_f32 v184, v184
    v_exp_f32 v185, v185
    v_add_f32 v9, v9, v184
    v_add_f32 v9, v9, v185
    v_cvt_pk_bf16_f32 v40, v184, v185
    v_exp_f32 v186, v186
    v_exp_f32 v187, v187
    v_add_f32 v9, v9, v186
    v_add_f32 v9, v9, v187
    v_cvt_pk_bf16_f32 v41, v186, v187
    v_exp_f32 v188, v188
    v_exp_f32 v189, v189
    v_add_f32 v10, v10, v188
    v_add_f32 v10, v10, v189
    v_cvt_pk_bf16_f32 v44, v188, v189
    v_exp_f32 v190, v190
    v_exp_f32 v191, v191
    v_add_f32 v10, v10, v190
    v_add_f32 v10, v10, v191
    v_cvt_pk_bf16_f32 v45, v190, v191
    v_exp_f32 v192, v192
    v_exp_f32 v193, v193
    v_add_f32 v9, v9, v192
    v_add_f32 v9, v9, v193
    v_cvt_pk_bf16_f32 v42, v192, v193
    v_exp_f32 v194, v194
    v_exp_f32 v195, v195
    v_add_f32 v9, v9, v194
    v_add_f32 v9, v9, v195
    v_cvt_pk_bf16_f32 v43, v194, v195
    v_exp_f32 v196, v196
    v_exp_f32 v197, v197
    v_add_f32 v10, v10, v196
    v_add_f32 v10, v10, v197
    v_cvt_pk_bf16_f32 v46, v196, v197
    v_exp_f32 v198, v198
    v_exp_f32 v199, v199
    v_add_f32 v10, v10, v198
    v_add_f32 v10, v10, v199
    v_cvt_pk_bf16_f32 v47, v198, v199
    s_mov_b32 s17, 0x6000
    buffer_load_dwordx4 v[200:203], v8, s[8:11], s17 offen offset:0
    buffer_load_dwordx4 v[204:207], v8, s[8:11], s17 offen offset:1024
    buffer_load_dwordx4 v[208:211], v8, s[8:11], s17 offen offset:2048
    buffer_load_dwordx4 v[212:215], v8, s[8:11], s17 offen offset:3072
    s_waitcnt vmcnt(3)
    v_mfma_f32_16x16x32_bf16 v[184:187], v[200:203], v[152:155], v[216:219]
    v_mfma_f32_16x16x32_bf16 v[188:191], v[200:203], v[168:171], v[220:223]
    s_waitcnt vmcnt(2)
    v_mfma_f32_16x16x32_bf16 v[192:195], v[204:207], v[152:155], v[216:219]
    v_mfma_f32_16x16x32_bf16 v[196:199], v[204:207], v[168:171], v[220:223]
    s_waitcnt vmcnt(1)
    v_mfma_f32_16x16x32_bf16 v[184:187], v[208:211], v[156:159], v[184:187]
    v_mfma_f32_16x16x32_bf16 v[188:191], v[208:211], v[172:175], v[188:191]
    s_waitcnt vmcnt(0)
    v_mfma_f32_16x16x32_bf16 v[192:195], v[212:215], v[156:159], v[192:195]
    v_mfma_f32_16x16x32_bf16 v[196:199], v[212:215], v[172:175], v[196:199]
    s_mov_b32 s17, 0x7000
    buffer_load_dwordx4 v[200:203], v8, s[8:11], s17 offen offset:0
    buffer_load_dwordx4 v[204:207], v8, s[8:11], s17 offen offset:1024
    buffer_load_dwordx4 v[208:211], v8, s[8:11], s17 offen offset:2048
    buffer_load_dwordx4 v[212:215], v8, s[8:11], s17 offen offset:3072
    s_waitcnt vmcnt(3)
    v_mfma_f32_16x16x32_bf16 v[184:187], v[200:203], v[160:163], v[184:187]
    v_mfma_f32_16x16x32_bf16 v[188:191], v[200:203], v[176:179], v[188:191]
    s_waitcnt vmcnt(2)
    v_mfma_f32_16x16x32_bf16 v[192:195], v[204:207], v[160:163], v[192:195]
    v_mfma_f32_16x16x32_bf16 v[196:199], v[204:207], v[176:179], v[196:199]
    s_waitcnt vmcnt(1)
    v_mfma_f32_16x16x32_bf16 v[184:187], v[208:211], v[164:167], v[184:187]
    v_mfma_f32_16x16x32_bf16 v[188:191], v[208:211], v[180:183], v[188:191]
    s_waitcnt vmcnt(0)
    v_mfma_f32_16x16x32_bf16 v[192:195], v[212:215], v[164:167], v[192:195]
    v_mfma_f32_16x16x32_bf16 v[196:199], v[212:215], v[180:183], v[196:199]
    s_nop 3
    v_exp_f32 v184, v184
    v_exp_f32 v185, v185
    v_add_f32 v9, v9, v184
    v_add_f32 v9, v9, v185
    v_cvt_pk_bf16_f32 v48, v184, v185
    v_exp_f32 v186, v186
    v_exp_f32 v187, v187
    v_add_f32 v9, v9, v186
    v_add_f32 v9, v9, v187
    v_cvt_pk_bf16_f32 v49, v186, v187
    v_exp_f32 v188, v188
    v_exp_f32 v189, v189
    v_add_f32 v10, v10, v188
    v_add_f32 v10, v10, v189
    v_cvt_pk_bf16_f32 v52, v188, v189
    v_exp_f32 v190, v190
    v_exp_f32 v191, v191
    v_add_f32 v10, v10, v190
    v_add_f32 v10, v10, v191
    v_cvt_pk_bf16_f32 v53, v190, v191
    v_exp_f32 v192, v192
    v_exp_f32 v193, v193
    v_add_f32 v9, v9, v192
    v_add_f32 v9, v9, v193
    v_cvt_pk_bf16_f32 v50, v192, v193
    v_exp_f32 v194, v194
    v_exp_f32 v195, v195
    v_add_f32 v9, v9, v194
    v_add_f32 v9, v9, v195
    v_cvt_pk_bf16_f32 v51, v194, v195
    v_exp_f32 v196, v196
    v_exp_f32 v197, v197
    v_add_f32 v10, v10, v196
    v_add_f32 v10, v10, v197
    v_cvt_pk_bf16_f32 v54, v196, v197
    v_exp_f32 v198, v198
    v_exp_f32 v199, v199
    v_add_f32 v10, v10, v198
    v_add_f32 v10, v10, v199
    v_cvt_pk_bf16_f32 v55, v198, v199
    s_mov_b32 s17, 0x8000
    buffer_load_dwordx4 v[200:203], v8, s[8:11], s17 offen offset:0
    buffer_load_dwordx4 v[204:207], v8, s[8:11], s17 offen offset:1024
    buffer_load_dwordx4 v[208:211], v8, s[8:11], s17 offen offset:2048
    buffer_load_dwordx4 v[212:215], v8, s[8:11], s17 offen offset:3072
    s_waitcnt vmcnt(3)
    v_mfma_f32_16x16x32_bf16 v[184:187], v[200:203], v[152:155], v[216:219]
    v_mfma_f32_16x16x32_bf16 v[188:191], v[200:203], v[168:171], v[220:223]
    s_waitcnt vmcnt(2)
    v_mfma_f32_16x16x32_bf16 v[192:195], v[204:207], v[152:155], v[216:219]
    v_mfma_f32_16x16x32_bf16 v[196:199], v[204:207], v[168:171], v[220:223]
    s_waitcnt vmcnt(1)
    v_mfma_f32_16x16x32_bf16 v[184:187], v[208:211], v[156:159], v[184:187]
    v_mfma_f32_16x16x32_bf16 v[188:191], v[208:211], v[172:175], v[188:191]
    s_waitcnt vmcnt(0)
    v_mfma_f32_16x16x32_bf16 v[192:195], v[212:215], v[156:159], v[192:195]
    v_mfma_f32_16x16x32_bf16 v[196:199], v[212:215], v[172:175], v[196:199]
    s_mov_b32 s17, 0x9000
    buffer_load_dwordx4 v[200:203], v8, s[8:11], s17 offen offset:0
    buffer_load_dwordx4 v[204:207], v8, s[8:11], s17 offen offset:1024
    buffer_load_dwordx4 v[208:211], v8, s[8:11], s17 offen offset:2048
    buffer_load_dwordx4 v[212:215], v8, s[8:11], s17 offen offset:3072
    s_waitcnt vmcnt(3)
    v_mfma_f32_16x16x32_bf16 v[184:187], v[200:203], v[160:163], v[184:187]
    v_mfma_f32_16x16x32_bf16 v[188:191], v[200:203], v[176:179], v[188:191]
    s_waitcnt vmcnt(2)
    v_mfma_f32_16x16x32_bf16 v[192:195], v[204:207], v[160:163], v[192:195]
    v_mfma_f32_16x16x32_bf16 v[196:199], v[204:207], v[176:179], v[196:199]
    s_waitcnt vmcnt(1)
    v_mfma_f32_16x16x32_bf16 v[184:187], v[208:211], v[164:167], v[184:187]
    v_mfma_f32_16x16x32_bf16 v[188:191], v[208:211], v[180:183], v[188:191]
    s_waitcnt vmcnt(0)
    v_mfma_f32_16x16x32_bf16 v[192:195], v[212:215], v[164:167], v[192:195]
    v_mfma_f32_16x16x32_bf16 v[196:199], v[212:215], v[180:183], v[196:199]
    s_nop 3
    v_exp_f32 v184, v184
    v_exp_f32 v185, v185
    v_add_f32 v9, v9, v184
    v_add_f32 v9, v9, v185
    v_cvt_pk_bf16_f32 v56, v184, v185
    v_exp_f32 v186, v186
    v_exp_f32 v187, v187
    v_add_f32 v9, v9, v186
    v_add_f32 v9, v9, v187
    v_cvt_pk_bf16_f32 v57, v186, v187
    v_exp_f32 v188, v188
    v_exp_f32 v189, v189
    v_add_f32 v10, v10, v188
    v_add_f32 v10, v10, v189
    v_cvt_pk_bf16_f32 v60, v188, v189
    v_exp_f32 v190, v190
    v_exp_f32 v191, v191
    v_add_f32 v10, v10, v190
    v_add_f32 v10, v10, v191
    v_cvt_pk_bf16_f32 v61, v190, v191
    v_exp_f32 v192, v192
    v_exp_f32 v193, v193
    v_add_f32 v9, v9, v192
    v_add_f32 v9, v9, v193
    v_cvt_pk_bf16_f32 v58, v192, v193
    v_exp_f32 v194, v194
    v_exp_f32 v195, v195
    v_add_f32 v9, v9, v194
    v_add_f32 v9, v9, v195
    v_cvt_pk_bf16_f32 v59, v194, v195
    v_exp_f32 v196, v196
    v_exp_f32 v197, v197
    v_add_f32 v10, v10, v196
    v_add_f32 v10, v10, v197
    v_cvt_pk_bf16_f32 v62, v196, v197
    v_exp_f32 v198, v198
    v_exp_f32 v199, v199
    v_add_f32 v10, v10, v198
    v_add_f32 v10, v10, v199
    v_cvt_pk_bf16_f32 v63, v198, v199
    s_mov_b32 s17, 0xa000
    buffer_load_dwordx4 v[200:203], v8, s[8:11], s17 offen offset:0
    buffer_load_dwordx4 v[204:207], v8, s[8:11], s17 offen offset:1024
    buffer_load_dwordx4 v[208:211], v8, s[8:11], s17 offen offset:2048
    buffer_load_dwordx4 v[212:215], v8, s[8:11], s17 offen offset:3072
    s_waitcnt vmcnt(3)
    v_mfma_f32_16x16x32_bf16 v[184:187], v[200:203], v[152:155], v[216:219]
    v_mfma_f32_16x16x32_bf16 v[188:191], v[200:203], v[168:171], v[220:223]
    s_waitcnt vmcnt(2)
    v_mfma_f32_16x16x32_bf16 v[192:195], v[204:207], v[152:155], v[216:219]
    v_mfma_f32_16x16x32_bf16 v[196:199], v[204:207], v[168:171], v[220:223]
    s_waitcnt vmcnt(1)
    v_mfma_f32_16x16x32_bf16 v[184:187], v[208:211], v[156:159], v[184:187]
    v_mfma_f32_16x16x32_bf16 v[188:191], v[208:211], v[172:175], v[188:191]
    s_waitcnt vmcnt(0)
    v_mfma_f32_16x16x32_bf16 v[192:195], v[212:215], v[156:159], v[192:195]
    v_mfma_f32_16x16x32_bf16 v[196:199], v[212:215], v[172:175], v[196:199]
    s_mov_b32 s17, 0xb000
    buffer_load_dwordx4 v[200:203], v8, s[8:11], s17 offen offset:0
    buffer_load_dwordx4 v[204:207], v8, s[8:11], s17 offen offset:1024
    buffer_load_dwordx4 v[208:211], v8, s[8:11], s17 offen offset:2048
    buffer_load_dwordx4 v[212:215], v8, s[8:11], s17 offen offset:3072
    s_waitcnt vmcnt(3)
    v_mfma_f32_16x16x32_bf16 v[184:187], v[200:203], v[160:163], v[184:187]
    v_mfma_f32_16x16x32_bf16 v[188:191], v[200:203], v[176:179], v[188:191]
    s_waitcnt vmcnt(2)
    v_mfma_f32_16x16x32_bf16 v[192:195], v[204:207], v[160:163], v[192:195]
    v_mfma_f32_16x16x32_bf16 v[196:199], v[204:207], v[176:179], v[196:199]
    s_waitcnt vmcnt(1)
    v_mfma_f32_16x16x32_bf16 v[184:187], v[208:211], v[164:167], v[184:187]
    v_mfma_f32_16x16x32_bf16 v[188:191], v[208:211], v[180:183], v[188:191]
    s_waitcnt vmcnt(0)
    v_mfma_f32_16x16x32_bf16 v[192:195], v[212:215], v[164:167], v[192:195]
    v_mfma_f32_16x16x32_bf16 v[196:199], v[212:215], v[180:183], v[196:199]
    s_nop 3
    v_exp_f32 v184, v184
    v_exp_f32 v185, v185
    v_add_f32 v9, v9, v184
    v_add_f32 v9, v9, v185
    v_cvt_pk_bf16_f32 v64, v184, v185
    v_exp_f32 v186, v186
    v_exp_f32 v187, v187
    v_add_f32 v9, v9, v186
    v_add_f32 v9, v9, v187
    v_cvt_pk_bf16_f32 v65, v186, v187
    v_exp_f32 v188, v188
    v_exp_f32 v189, v189
    v_add_f32 v10, v10, v188
    v_add_f32 v10, v10, v189
    v_cvt_pk_bf16_f32 v68, v188, v189
    v_exp_f32 v190, v190
    v_exp_f32 v191, v191
    v_add_f32 v10, v10, v190
    v_add_f32 v10, v10, v191
    v_cvt_pk_bf16_f32 v69, v190, v191
    v_exp_f32 v192, v192
    v_exp_f32 v193, v193
    v_add_f32 v9, v9, v192
    v_add_f32 v9, v9, v193
    v_cvt_pk_bf16_f32 v66, v192, v193
    v_exp_f32 v194, v194
    v_exp_f32 v195, v195
    v_add_f32 v9, v9, v194
    v_add_f32 v9, v9, v195
    v_cvt_pk_bf16_f32 v67, v194, v195
    v_exp_f32 v196, v196
    v_exp_f32 v197, v197
    v_add_f32 v10, v10, v196
    v_add_f32 v10, v10, v197
    v_cvt_pk_bf16_f32 v70, v196, v197
    v_exp_f32 v198, v198
    v_exp_f32 v199, v199
    v_add_f32 v10, v10, v198
    v_add_f32 v10, v10, v199
    v_cvt_pk_bf16_f32 v71, v198, v199
    s_mov_b32 s17, 0xc000
    buffer_load_dwordx4 v[200:203], v8, s[8:11], s17 offen offset:0
    buffer_load_dwordx4 v[204:207], v8, s[8:11], s17 offen offset:1024
    buffer_load_dwordx4 v[208:211], v8, s[8:11], s17 offen offset:2048
    buffer_load_dwordx4 v[212:215], v8, s[8:11], s17 offen offset:3072
    s_waitcnt vmcnt(3)
    v_mfma_f32_16x16x32_bf16 v[184:187], v[200:203], v[152:155], v[216:219]
    v_mfma_f32_16x16x32_bf16 v[188:191], v[200:203], v[168:171], v[220:223]
    s_waitcnt vmcnt(2)
    v_mfma_f32_16x16x32_bf16 v[192:195], v[204:207], v[152:155], v[216:219]
    v_mfma_f32_16x16x32_bf16 v[196:199], v[204:207], v[168:171], v[220:223]
    s_waitcnt vmcnt(1)
    v_mfma_f32_16x16x32_bf16 v[184:187], v[208:211], v[156:159], v[184:187]
    v_mfma_f32_16x16x32_bf16 v[188:191], v[208:211], v[172:175], v[188:191]
    s_waitcnt vmcnt(0)
    v_mfma_f32_16x16x32_bf16 v[192:195], v[212:215], v[156:159], v[192:195]
    v_mfma_f32_16x16x32_bf16 v[196:199], v[212:215], v[172:175], v[196:199]
    s_mov_b32 s17, 0xd000
    buffer_load_dwordx4 v[200:203], v8, s[8:11], s17 offen offset:0
    buffer_load_dwordx4 v[204:207], v8, s[8:11], s17 offen offset:1024
    buffer_load_dwordx4 v[208:211], v8, s[8:11], s17 offen offset:2048
    buffer_load_dwordx4 v[212:215], v8, s[8:11], s17 offen offset:3072
    s_waitcnt vmcnt(3)
    v_mfma_f32_16x16x32_bf16 v[184:187], v[200:203], v[160:163], v[184:187]
    v_mfma_f32_16x16x32_bf16 v[188:191], v[200:203], v[176:179], v[188:191]
    s_waitcnt vmcnt(2)
    v_mfma_f32_16x16x32_bf16 v[192:195], v[204:207], v[160:163], v[192:195]
    v_mfma_f32_16x16x32_bf16 v[196:199], v[204:207], v[176:179], v[196:199]
    s_waitcnt vmcnt(1)
    v_mfma_f32_16x16x32_bf16 v[184:187], v[208:211], v[164:167], v[184:187]
    v_mfma_f32_16x16x32_bf16 v[188:191], v[208:211], v[180:183], v[188:191]
    s_waitcnt vmcnt(0)
    v_mfma_f32_16x16x32_bf16 v[192:195], v[212:215], v[164:167], v[192:195]
    v_mfma_f32_16x16x32_bf16 v[196:199], v[212:215], v[180:183], v[196:199]
    s_nop 3
    v_exp_f32 v184, v184
    v_exp_f32 v185, v185
    v_add_f32 v9, v9, v184
    v_add_f32 v9, v9, v185
    v_cvt_pk_bf16_f32 v72, v184, v185
    v_exp_f32 v186, v186
    v_exp_f32 v187, v187
    v_add_f32 v9, v9, v186
    v_add_f32 v9, v9, v187
    v_cvt_pk_bf16_f32 v73, v186, v187
    v_exp_f32 v188, v188
    v_exp_f32 v189, v189
    v_add_f32 v10, v10, v188
    v_add_f32 v10, v10, v189
    v_cvt_pk_bf16_f32 v76, v188, v189
    v_exp_f32 v190, v190
    v_exp_f32 v191, v191
    v_add_f32 v10, v10, v190
    v_add_f32 v10, v10, v191
    v_cvt_pk_bf16_f32 v77, v190, v191
    v_exp_f32 v192, v192
    v_exp_f32 v193, v193
    v_add_f32 v9, v9, v192
    v_add_f32 v9, v9, v193
    v_cvt_pk_bf16_f32 v74, v192, v193
    v_exp_f32 v194, v194
    v_exp_f32 v195, v195
    v_add_f32 v9, v9, v194
    v_add_f32 v9, v9, v195
    v_cvt_pk_bf16_f32 v75, v194, v195
    v_exp_f32 v196, v196
    v_exp_f32 v197, v197
    v_add_f32 v10, v10, v196
    v_add_f32 v10, v10, v197
    v_cvt_pk_bf16_f32 v78, v196, v197
    v_exp_f32 v198, v198
    v_exp_f32 v199, v199
    v_add_f32 v10, v10, v198
    v_add_f32 v10, v10, v199
    v_cvt_pk_bf16_f32 v79, v198, v199
    s_mov_b32 s17, 0xe000
    buffer_load_dwordx4 v[200:203], v8, s[8:11], s17 offen offset:0
    buffer_load_dwordx4 v[204:207], v8, s[8:11], s17 offen offset:1024
    buffer_load_dwordx4 v[208:211], v8, s[8:11], s17 offen offset:2048
    buffer_load_dwordx4 v[212:215], v8, s[8:11], s17 offen offset:3072
    s_waitcnt vmcnt(3)
    v_mfma_f32_16x16x32_bf16 v[184:187], v[200:203], v[152:155], v[216:219]
    v_mfma_f32_16x16x32_bf16 v[188:191], v[200:203], v[168:171], v[220:223]
    s_waitcnt vmcnt(2)
    v_mfma_f32_16x16x32_bf16 v[192:195], v[204:207], v[152:155], v[216:219]
    v_mfma_f32_16x16x32_bf16 v[196:199], v[204:207], v[168:171], v[220:223]
    s_waitcnt vmcnt(1)
    v_mfma_f32_16x16x32_bf16 v[184:187], v[208:211], v[156:159], v[184:187]
    v_mfma_f32_16x16x32_bf16 v[188:191], v[208:211], v[172:175], v[188:191]
    s_waitcnt vmcnt(0)
    v_mfma_f32_16x16x32_bf16 v[192:195], v[212:215], v[156:159], v[192:195]
    v_mfma_f32_16x16x32_bf16 v[196:199], v[212:215], v[172:175], v[196:199]
    s_mov_b32 s17, 0xf000
    buffer_load_dwordx4 v[200:203], v8, s[8:11], s17 offen offset:0
    buffer_load_dwordx4 v[204:207], v8, s[8:11], s17 offen offset:1024
    buffer_load_dwordx4 v[208:211], v8, s[8:11], s17 offen offset:2048
    buffer_load_dwordx4 v[212:215], v8, s[8:11], s17 offen offset:3072
    s_waitcnt vmcnt(3)
    v_mfma_f32_16x16x32_bf16 v[184:187], v[200:203], v[160:163], v[184:187]
    v_mfma_f32_16x16x32_bf16 v[188:191], v[200:203], v[176:179], v[188:191]
    s_waitcnt vmcnt(2)
    v_mfma_f32_16x16x32_bf16 v[192:195], v[204:207], v[160:163], v[192:195]
    v_mfma_f32_16x16x32_bf16 v[196:199], v[204:207], v[176:179], v[196:199]
    s_waitcnt vmcnt(1)
    v_mfma_f32_16x16x32_bf16 v[184:187], v[208:211], v[164:167], v[184:187]
    v_mfma_f32_16x16x32_bf16 v[188:191], v[208:211], v[180:183], v[188:191]
    s_waitcnt vmcnt(0)
    v_mfma_f32_16x16x32_bf16 v[192:195], v[212:215], v[164:167], v[192:195]
    v_mfma_f32_16x16x32_bf16 v[196:199], v[212:215], v[180:183], v[196:199]
    s_nop 3
    v_exp_f32 v184, v184
    v_exp_f32 v185, v185
    v_add_f32 v9, v9, v184
    v_add_f32 v9, v9, v185
    v_cvt_pk_bf16_f32 v80, v184, v185
    v_exp_f32 v186, v186
    v_exp_f32 v187, v187
    v_add_f32 v9, v9, v186
    v_add_f32 v9, v9, v187
    v_cvt_pk_bf16_f32 v81, v186, v187
    v_exp_f32 v188, v188
    v_exp_f32 v189, v189
    v_add_f32 v10, v10, v188
    v_add_f32 v10, v10, v189
    v_cvt_pk_bf16_f32 v84, v188, v189
    v_exp_f32 v190, v190
    v_exp_f32 v191, v191
    v_add_f32 v10, v10, v190
    v_add_f32 v10, v10, v191
    v_cvt_pk_bf16_f32 v85, v190, v191
    v_exp_f32 v192, v192
    v_exp_f32 v193, v193
    v_add_f32 v9, v9, v192
    v_add_f32 v9, v9, v193
    v_cvt_pk_bf16_f32 v82, v192, v193
    v_exp_f32 v194, v194
    v_exp_f32 v195, v195
    v_add_f32 v9, v9, v194
    v_add_f32 v9, v9, v195
    v_cvt_pk_bf16_f32 v83, v194, v195
    v_exp_f32 v196, v196
    v_exp_f32 v197, v197
    v_add_f32 v10, v10, v196
    v_add_f32 v10, v10, v197
    v_cvt_pk_bf16_f32 v86, v196, v197
    v_exp_f32 v198, v198
    v_exp_f32 v199, v199
    v_add_f32 v10, v10, v198
    v_add_f32 v10, v10, v199
    v_cvt_pk_bf16_f32 v87, v198, v199
    s_mov_b32 s17, 0x10000
    buffer_load_dwordx4 v[200:203], v8, s[8:11], s17 offen offset:0
    buffer_load_dwordx4 v[204:207], v8, s[8:11], s17 offen offset:1024
    buffer_load_dwordx4 v[208:211], v8, s[8:11], s17 offen offset:2048
    buffer_load_dwordx4 v[212:215], v8, s[8:11], s17 offen offset:3072
    s_waitcnt vmcnt(3)
    v_mfma_f32_16x16x32_bf16 v[184:187], v[200:203], v[152:155], v[216:219]
    v_mfma_f32_16x16x32_bf16 v[188:191], v[200:203], v[168:171], v[220:223]
    s_waitcnt vmcnt(2)
    v_mfma_f32_16x16x32_bf16 v[192:195], v[204:207], v[152:155], v[216:219]
    v_mfma_f32_16x16x32_bf16 v[196:199], v[204:207], v[168:171], v[220:223]
    s_waitcnt vmcnt(1)
    v_mfma_f32_16x16x32_bf16 v[184:187], v[208:211], v[156:159], v[184:187]
    v_mfma_f32_16x16x32_bf16 v[188:191], v[208:211], v[172:175], v[188:191]
    s_waitcnt vmcnt(0)
    v_mfma_f32_16x16x32_bf16 v[192:195], v[212:215], v[156:159], v[192:195]
    v_mfma_f32_16x16x32_bf16 v[196:199], v[212:215], v[172:175], v[196:199]
    s_mov_b32 s17, 0x11000
    buffer_load_dwordx4 v[200:203], v8, s[8:11], s17 offen offset:0
    buffer_load_dwordx4 v[204:207], v8, s[8:11], s17 offen offset:1024
    buffer_load_dwordx4 v[208:211], v8, s[8:11], s17 offen offset:2048
    buffer_load_dwordx4 v[212:215], v8, s[8:11], s17 offen offset:3072
    s_waitcnt vmcnt(3)
    v_mfma_f32_16x16x32_bf16 v[184:187], v[200:203], v[160:163], v[184:187]
    v_mfma_f32_16x16x32_bf16 v[188:191], v[200:203], v[176:179], v[188:191]
    s_waitcnt vmcnt(2)
    v_mfma_f32_16x16x32_bf16 v[192:195], v[204:207], v[160:163], v[192:195]
    v_mfma_f32_16x16x32_bf16 v[196:199], v[204:207], v[176:179], v[196:199]
    s_waitcnt vmcnt(1)
    v_mfma_f32_16x16x32_bf16 v[184:187], v[208:211], v[164:167], v[184:187]
    v_mfma_f32_16x16x32_bf16 v[188:191], v[208:211], v[180:183], v[188:191]
    s_waitcnt vmcnt(0)
    v_mfma_f32_16x16x32_bf16 v[192:195], v[212:215], v[164:167], v[192:195]
    v_mfma_f32_16x16x32_bf16 v[196:199], v[212:215], v[180:183], v[196:199]
    s_nop 3
    v_exp_f32 v184, v184
    v_exp_f32 v185, v185
    v_add_f32 v9, v9, v184
    v_add_f32 v9, v9, v185
    v_cvt_pk_bf16_f32 v88, v184, v185
    v_exp_f32 v186, v186
    v_exp_f32 v187, v187
    v_add_f32 v9, v9, v186
    v_add_f32 v9, v9, v187
    v_cvt_pk_bf16_f32 v89, v186, v187
    v_exp_f32 v188, v188
    v_exp_f32 v189, v189
    v_add_f32 v10, v10, v188
    v_add_f32 v10, v10, v189
    v_cvt_pk_bf16_f32 v92, v188, v189
    v_exp_f32 v190, v190
    v_exp_f32 v191, v191
    v_add_f32 v10, v10, v190
    v_add_f32 v10, v10, v191
    v_cvt_pk_bf16_f32 v93, v190, v191
    v_exp_f32 v192, v192
    v_exp_f32 v193, v193
    v_add_f32 v9, v9, v192
    v_add_f32 v9, v9, v193
    v_cvt_pk_bf16_f32 v90, v192, v193
    v_exp_f32 v194, v194
    v_exp_f32 v195, v195
    v_add_f32 v9, v9, v194
    v_add_f32 v9, v9, v195
    v_cvt_pk_bf16_f32 v91, v194, v195
    v_exp_f32 v196, v196
    v_exp_f32 v197, v197
    v_add_f32 v10, v10, v196
    v_add_f32 v10, v10, v197
    v_cvt_pk_bf16_f32 v94, v196, v197
    v_exp_f32 v198, v198
    v_exp_f32 v199, v199
    v_add_f32 v10, v10, v198
    v_add_f32 v10, v10, v199
    v_cvt_pk_bf16_f32 v95, v198, v199
    s_mov_b32 s17, 0x12000
    buffer_load_dwordx4 v[200:203], v8, s[8:11], s17 offen offset:0
    buffer_load_dwordx4 v[204:207], v8, s[8:11], s17 offen offset:1024
    buffer_load_dwordx4 v[208:211], v8, s[8:11], s17 offen offset:2048
    buffer_load_dwordx4 v[212:215], v8, s[8:11], s17 offen offset:3072
    s_waitcnt vmcnt(3)
    v_mfma_f32_16x16x32_bf16 v[184:187], v[200:203], v[152:155], v[216:219]
    v_mfma_f32_16x16x32_bf16 v[188:191], v[200:203], v[168:171], v[220:223]
    s_waitcnt vmcnt(2)
    v_mfma_f32_16x16x32_bf16 v[192:195], v[204:207], v[152:155], v[216:219]
    v_mfma_f32_16x16x32_bf16 v[196:199], v[204:207], v[168:171], v[220:223]
    s_waitcnt vmcnt(1)
    v_mfma_f32_16x16x32_bf16 v[184:187], v[208:211], v[156:159], v[184:187]
    v_mfma_f32_16x16x32_bf16 v[188:191], v[208:211], v[172:175], v[188:191]
    s_waitcnt vmcnt(0)
    v_mfma_f32_16x16x32_bf16 v[192:195], v[212:215], v[156:159], v[192:195]
    v_mfma_f32_16x16x32_bf16 v[196:199], v[212:215], v[172:175], v[196:199]
    s_mov_b32 s17, 0x13000
    buffer_load_dwordx4 v[200:203], v8, s[8:11], s17 offen offset:0
    buffer_load_dwordx4 v[204:207], v8, s[8:11], s17 offen offset:1024
    buffer_load_dwordx4 v[208:211], v8, s[8:11], s17 offen offset:2048
    buffer_load_dwordx4 v[212:215], v8, s[8:11], s17 offen offset:3072
    s_waitcnt vmcnt(3)
    v_mfma_f32_16x16x32_bf16 v[184:187], v[200:203], v[160:163], v[184:187]
    v_mfma_f32_16x16x32_bf16 v[188:191], v[200:203], v[176:179], v[188:191]
    s_waitcnt vmcnt(2)
    v_mfma_f32_16x16x32_bf16 v[192:195], v[204:207], v[160:163], v[192:195]
    v_mfma_f32_16x16x32_bf16 v[196:199], v[204:207], v[176:179], v[196:199]
    s_waitcnt vmcnt(1)
    v_mfma_f32_16x16x32_bf16 v[184:187], v[208:211], v[164:167], v[184:187]
    v_mfma_f32_16x16x32_bf16 v[188:191], v[208:211], v[180:183], v[188:191]
    s_waitcnt vmcnt(0)
    v_mfma_f32_16x16x32_bf16 v[192:195], v[212:215], v[164:167], v[192:195]
    v_mfma_f32_16x16x32_bf16 v[196:199], v[212:215], v[180:183], v[196:199]
    s_nop 3
    v_exp_f32 v184, v184
    v_exp_f32 v185, v185
    v_add_f32 v9, v9, v184
    v_add_f32 v9, v9, v185
    v_cvt_pk_bf16_f32 v96, v184, v185
    v_exp_f32 v186, v186
    v_exp_f32 v187, v187
    v_add_f32 v9, v9, v186
    v_add_f32 v9, v9, v187
    v_cvt_pk_bf16_f32 v97, v186, v187
    v_exp_f32 v188, v188
    v_exp_f32 v189, v189
    v_add_f32 v10, v10, v188
    v_add_f32 v10, v10, v189
    v_cvt_pk_bf16_f32 v100, v188, v189
    v_exp_f32 v190, v190
    v_exp_f32 v191, v191
    v_add_f32 v10, v10, v190
    v_add_f32 v10, v10, v191
    v_cvt_pk_bf16_f32 v101, v190, v191
    v_exp_f32 v192, v192
    v_exp_f32 v193, v193
    v_add_f32 v9, v9, v192
    v_add_f32 v9, v9, v193
    v_cvt_pk_bf16_f32 v98, v192, v193
    v_exp_f32 v194, v194
    v_exp_f32 v195, v195
    v_add_f32 v9, v9, v194
    v_add_f32 v9, v9, v195
    v_cvt_pk_bf16_f32 v99, v194, v195
    v_exp_f32 v196, v196
    v_exp_f32 v197, v197
    v_add_f32 v10, v10, v196
    v_add_f32 v10, v10, v197
    v_cvt_pk_bf16_f32 v102, v196, v197
    v_exp_f32 v198, v198
    v_exp_f32 v199, v199
    v_add_f32 v10, v10, v198
    v_add_f32 v10, v10, v199
    v_cvt_pk_bf16_f32 v103, v198, v199
    s_mov_b32 s17, 0x14000
    buffer_load_dwordx4 v[200:203], v8, s[8:11], s17 offen offset:0
    buffer_load_dwordx4 v[204:207], v8, s[8:11], s17 offen offset:1024
    buffer_load_dwordx4 v[208:211], v8, s[8:11], s17 offen offset:2048
    buffer_load_dwordx4 v[212:215], v8, s[8:11], s17 offen offset:3072
    s_waitcnt vmcnt(3)
    v_mfma_f32_16x16x32_bf16 v[184:187], v[200:203], v[152:155], v[216:219]
    v_mfma_f32_16x16x32_bf16 v[188:191], v[200:203], v[168:171], v[220:223]
    s_waitcnt vmcnt(2)
    v_mfma_f32_16x16x32_bf16 v[192:195], v[204:207], v[152:155], v[216:219]
    v_mfma_f32_16x16x32_bf16 v[196:199], v[204:207], v[168:171], v[220:223]
    s_waitcnt vmcnt(1)
    v_mfma_f32_16x16x32_bf16 v[184:187], v[208:211], v[156:159], v[184:187]
    v_mfma_f32_16x16x32_bf16 v[188:191], v[208:211], v[172:175], v[188:191]
    s_waitcnt vmcnt(0)
    v_mfma_f32_16x16x32_bf16 v[192:195], v[212:215], v[156:159], v[192:195]
    v_mfma_f32_16x16x32_bf16 v[196:199], v[212:215], v[172:175], v[196:199]
    s_mov_b32 s17, 0x15000
    buffer_load_dwordx4 v[200:203], v8, s[8:11], s17 offen offset:0
    buffer_load_dwordx4 v[204:207], v8, s[8:11], s17 offen offset:1024
    buffer_load_dwordx4 v[208:211], v8, s[8:11], s17 offen offset:2048
    buffer_load_dwordx4 v[212:215], v8, s[8:11], s17 offen offset:3072
    s_waitcnt vmcnt(3)
    v_mfma_f32_16x16x32_bf16 v[184:187], v[200:203], v[160:163], v[184:187]
    v_mfma_f32_16x16x32_bf16 v[188:191], v[200:203], v[176:179], v[188:191]
    s_waitcnt vmcnt(2)
    v_mfma_f32_16x16x32_bf16 v[192:195], v[204:207], v[160:163], v[192:195]
    v_mfma_f32_16x16x32_bf16 v[196:199], v[204:207], v[176:179], v[196:199]
    s_waitcnt vmcnt(1)
    v_mfma_f32_16x16x32_bf16 v[184:187], v[208:211], v[164:167], v[184:187]
    v_mfma_f32_16x16x32_bf16 v[188:191], v[208:211], v[180:183], v[188:191]
    s_waitcnt vmcnt(0)
    v_mfma_f32_16x16x32_bf16 v[192:195], v[212:215], v[164:167], v[192:195]
    v_mfma_f32_16x16x32_bf16 v[196:199], v[212:215], v[180:183], v[196:199]
    s_nop 3
    v_exp_f32 v184, v184
    v_exp_f32 v185, v185
    v_add_f32 v9, v9, v184
    v_add_f32 v9, v9, v185
    v_cvt_pk_bf16_f32 v104, v184, v185
    v_exp_f32 v186, v186
    v_exp_f32 v187, v187
    v_add_f32 v9, v9, v186
    v_add_f32 v9, v9, v187
    v_cvt_pk_bf16_f32 v105, v186, v187
    v_exp_f32 v188, v188
    v_exp_f32 v189, v189
    v_add_f32 v10, v10, v188
    v_add_f32 v10, v10, v189
    v_cvt_pk_bf16_f32 v108, v188, v189
    v_exp_f32 v190, v190
    v_exp_f32 v191, v191
    v_add_f32 v10, v10, v190
    v_add_f32 v10, v10, v191
    v_cvt_pk_bf16_f32 v109, v190, v191
    v_exp_f32 v192, v192
    v_exp_f32 v193, v193
    v_add_f32 v9, v9, v192
    v_add_f32 v9, v9, v193
    v_cvt_pk_bf16_f32 v106, v192, v193
    v_exp_f32 v194, v194
    v_exp_f32 v195, v195
    v_add_f32 v9, v9, v194
    v_add_f32 v9, v9, v195
    v_cvt_pk_bf16_f32 v107, v194, v195
    v_exp_f32 v196, v196
    v_exp_f32 v197, v197
    v_add_f32 v10, v10, v196
    v_add_f32 v10, v10, v197
    v_cvt_pk_bf16_f32 v110, v196, v197
    v_exp_f32 v198, v198
    v_exp_f32 v199, v199
    v_add_f32 v10, v10, v198
    v_add_f32 v10, v10, v199
    v_cvt_pk_bf16_f32 v111, v198, v199
    s_mov_b32 s17, 0x16000
    buffer_load_dwordx4 v[200:203], v8, s[8:11], s17 offen offset:0
    buffer_load_dwordx4 v[204:207], v8, s[8:11], s17 offen offset:1024
    buffer_load_dwordx4 v[208:211], v8, s[8:11], s17 offen offset:2048
    buffer_load_dwordx4 v[212:215], v8, s[8:11], s17 offen offset:3072
    s_waitcnt vmcnt(3)
    v_mfma_f32_16x16x32_bf16 v[184:187], v[200:203], v[152:155], v[216:219]
    v_mfma_f32_16x16x32_bf16 v[188:191], v[200:203], v[168:171], v[220:223]
    s_waitcnt vmcnt(2)
    v_mfma_f32_16x16x32_bf16 v[192:195], v[204:207], v[152:155], v[216:219]
    v_mfma_f32_16x16x32_bf16 v[196:199], v[204:207], v[168:171], v[220:223]
    s_waitcnt vmcnt(1)
    v_mfma_f32_16x16x32_bf16 v[184:187], v[208:211], v[156:159], v[184:187]
    v_mfma_f32_16x16x32_bf16 v[188:191], v[208:211], v[172:175], v[188:191]
    s_waitcnt vmcnt(0)
    v_mfma_f32_16x16x32_bf16 v[192:195], v[212:215], v[156:159], v[192:195]
    v_mfma_f32_16x16x32_bf16 v[196:199], v[212:215], v[172:175], v[196:199]
    s_mov_b32 s17, 0x17000
    buffer_load_dwordx4 v[200:203], v8, s[8:11], s17 offen offset:0
    buffer_load_dwordx4 v[204:207], v8, s[8:11], s17 offen offset:1024
    buffer_load_dwordx4 v[208:211], v8, s[8:11], s17 offen offset:2048
    buffer_load_dwordx4 v[212:215], v8, s[8:11], s17 offen offset:3072
    s_waitcnt vmcnt(3)
    v_mfma_f32_16x16x32_bf16 v[184:187], v[200:203], v[160:163], v[184:187]
    v_mfma_f32_16x16x32_bf16 v[188:191], v[200:203], v[176:179], v[188:191]
    s_waitcnt vmcnt(2)
    v_mfma_f32_16x16x32_bf16 v[192:195], v[204:207], v[160:163], v[192:195]
    v_mfma_f32_16x16x32_bf16 v[196:199], v[204:207], v[176:179], v[196:199]
    s_waitcnt vmcnt(1)
    v_mfma_f32_16x16x32_bf16 v[184:187], v[208:211], v[164:167], v[184:187]
    v_mfma_f32_16x16x32_bf16 v[188:191], v[208:211], v[180:183], v[188:191]
    s_waitcnt vmcnt(0)
    v_mfma_f32_16x16x32_bf16 v[192:195], v[212:215], v[164:167], v[192:195]
    v_mfma_f32_16x16x32_bf16 v[196:199], v[212:215], v[180:183], v[196:199]
    s_nop 3
    v_exp_f32 v184, v184
    v_exp_f32 v185, v185
    v_add_f32 v9, v9, v184
    v_add_f32 v9, v9, v185
    v_cvt_pk_bf16_f32 v112, v184, v185
    v_exp_f32 v186, v186
    v_exp_f32 v187, v187
    v_add_f32 v9, v9, v186
    v_add_f32 v9, v9, v187
    v_cvt_pk_bf16_f32 v113, v186, v187
    v_exp_f32 v188, v188
    v_exp_f32 v189, v189
    v_add_f32 v10, v10, v188
    v_add_f32 v10, v10, v189
    v_cvt_pk_bf16_f32 v116, v188, v189
    v_exp_f32 v190, v190
    v_exp_f32 v191, v191
    v_add_f32 v10, v10, v190
    v_add_f32 v10, v10, v191
    v_cvt_pk_bf16_f32 v117, v190, v191
    v_exp_f32 v192, v192
    v_exp_f32 v193, v193
    v_add_f32 v9, v9, v192
    v_add_f32 v9, v9, v193
    v_cvt_pk_bf16_f32 v114, v192, v193
    v_exp_f32 v194, v194
    v_exp_f32 v195, v195
    v_add_f32 v9, v9, v194
    v_add_f32 v9, v9, v195
    v_cvt_pk_bf16_f32 v115, v194, v195
    v_exp_f32 v196, v196
    v_exp_f32 v197, v197
    v_add_f32 v10, v10, v196
    v_add_f32 v10, v10, v197
    v_cvt_pk_bf16_f32 v118, v196, v197
    v_exp_f32 v198, v198
    v_exp_f32 v199, v199
    v_add_f32 v10, v10, v198
    v_add_f32 v10, v10, v199
    v_cvt_pk_bf16_f32 v119, v198, v199
    s_mov_b32 s17, 0x18000
    buffer_load_dwordx4 v[200:203], v8, s[8:11], s17 offen offset:0
    buffer_load_dwordx4 v[204:207], v8, s[8:11], s17 offen offset:1024
    buffer_load_dwordx4 v[208:211], v8, s[8:11], s17 offen offset:2048
    buffer_load_dwordx4 v[212:215], v8, s[8:11], s17 offen offset:3072
    s_waitcnt vmcnt(3)
    v_mfma_f32_16x16x32_bf16 v[184:187], v[200:203], v[152:155], v[216:219]
    v_mfma_f32_16x16x32_bf16 v[188:191], v[200:203], v[168:171], v[220:223]
    s_waitcnt vmcnt(2)
    v_mfma_f32_16x16x32_bf16 v[192:195], v[204:207], v[152:155], v[216:219]
    v_mfma_f32_16x16x32_bf16 v[196:199], v[204:207], v[168:171], v[220:223]
    s_waitcnt vmcnt(1)
    v_mfma_f32_16x16x32_bf16 v[184:187], v[208:211], v[156:159], v[184:187]
    v_mfma_f32_16x16x32_bf16 v[188:191], v[208:211], v[172:175], v[188:191]
    s_waitcnt vmcnt(0)
    v_mfma_f32_16x16x32_bf16 v[192:195], v[212:215], v[156:159], v[192:195]
    v_mfma_f32_16x16x32_bf16 v[196:199], v[212:215], v[172:175], v[196:199]
    s_mov_b32 s17, 0x19000
    buffer_load_dwordx4 v[200:203], v8, s[8:11], s17 offen offset:0
    buffer_load_dwordx4 v[204:207], v8, s[8:11], s17 offen offset:1024
    buffer_load_dwordx4 v[208:211], v8, s[8:11], s17 offen offset:2048
    buffer_load_dwordx4 v[212:215], v8, s[8:11], s17 offen offset:3072
    s_waitcnt vmcnt(3)
    v_mfma_f32_16x16x32_bf16 v[184:187], v[200:203], v[160:163], v[184:187]
    v_mfma_f32_16x16x32_bf16 v[188:191], v[200:203], v[176:179], v[188:191]
    s_waitcnt vmcnt(2)
    v_mfma_f32_16x16x32_bf16 v[192:195], v[204:207], v[160:163], v[192:195]
    v_mfma_f32_16x16x32_bf16 v[196:199], v[204:207], v[176:179], v[196:199]
    s_waitcnt vmcnt(1)
    v_mfma_f32_16x16x32_bf16 v[184:187], v[208:211], v[164:167], v[184:187]
    v_mfma_f32_16x16x32_bf16 v[188:191], v[208:211], v[180:183], v[188:191]
    s_waitcnt vmcnt(0)
    v_mfma_f32_16x16x32_bf16 v[192:195], v[212:215], v[164:167], v[192:195]
    v_mfma_f32_16x16x32_bf16 v[196:199], v[212:215], v[180:183], v[196:199]
    s_nop 3
    v_exp_f32 v184, v184
    v_exp_f32 v185, v185
    v_add_f32 v9, v9, v184
    v_add_f32 v9, v9, v185
    v_cvt_pk_bf16_f32 v120, v184, v185
    v_exp_f32 v186, v186
    v_exp_f32 v187, v187
    v_add_f32 v9, v9, v186
    v_add_f32 v9, v9, v187
    v_cvt_pk_bf16_f32 v121, v186, v187
    v_exp_f32 v188, v188
    v_exp_f32 v189, v189
    v_add_f32 v10, v10, v188
    v_add_f32 v10, v10, v189
    v_cvt_pk_bf16_f32 v124, v188, v189
    v_exp_f32 v190, v190
    v_exp_f32 v191, v191
    v_add_f32 v10, v10, v190
    v_add_f32 v10, v10, v191
    v_cvt_pk_bf16_f32 v125, v190, v191
    v_exp_f32 v192, v192
    v_exp_f32 v193, v193
    v_add_f32 v9, v9, v192
    v_add_f32 v9, v9, v193
    v_cvt_pk_bf16_f32 v122, v192, v193
    v_exp_f32 v194, v194
    v_exp_f32 v195, v195
    v_add_f32 v9, v9, v194
    v_add_f32 v9, v9, v195
    v_cvt_pk_bf16_f32 v123, v194, v195
    v_exp_f32 v196, v196
    v_exp_f32 v197, v197
    v_add_f32 v10, v10, v196
    v_add_f32 v10, v10, v197
    v_cvt_pk_bf16_f32 v126, v196, v197
    v_exp_f32 v198, v198
    v_exp_f32 v199, v199
    v_add_f32 v10, v10, v198
    v_add_f32 v10, v10, v199
    v_cvt_pk_bf16_f32 v127, v198, v199
    s_mov_b32 s17, 0x1a000
    buffer_load_dwordx4 v[200:203], v8, s[8:11], s17 offen offset:0
    buffer_load_dwordx4 v[204:207], v8, s[8:11], s17 offen offset:1024
    buffer_load_dwordx4 v[208:211], v8, s[8:11], s17 offen offset:2048
    buffer_load_dwordx4 v[212:215], v8, s[8:11], s17 offen offset:3072
    s_waitcnt vmcnt(3)
    v_mfma_f32_16x16x32_bf16 v[184:187], v[200:203], v[152:155], v[216:219]
    v_mfma_f32_16x16x32_bf16 v[188:191], v[200:203], v[168:171], v[220:223]
    s_waitcnt vmcnt(2)
    v_mfma_f32_16x16x32_bf16 v[192:195], v[204:207], v[152:155], v[216:219]
    v_mfma_f32_16x16x32_bf16 v[196:199], v[204:207], v[168:171], v[220:223]
    s_waitcnt vmcnt(1)
    v_mfma_f32_16x16x32_bf16 v[184:187], v[208:211], v[156:159], v[184:187]
    v_mfma_f32_16x16x32_bf16 v[188:191], v[208:211], v[172:175], v[188:191]
    s_waitcnt vmcnt(0)
    v_mfma_f32_16x16x32_bf16 v[192:195], v[212:215], v[156:159], v[192:195]
    v_mfma_f32_16x16x32_bf16 v[196:199], v[212:215], v[172:175], v[196:199]
    s_mov_b32 s17, 0x1b000
    buffer_load_dwordx4 v[200:203], v8, s[8:11], s17 offen offset:0
    buffer_load_dwordx4 v[204:207], v8, s[8:11], s17 offen offset:1024
    buffer_load_dwordx4 v[208:211], v8, s[8:11], s17 offen offset:2048
    buffer_load_dwordx4 v[212:215], v8, s[8:11], s17 offen offset:3072
    s_waitcnt vmcnt(3)
    v_mfma_f32_16x16x32_bf16 v[184:187], v[200:203], v[160:163], v[184:187]
    v_mfma_f32_16x16x32_bf16 v[188:191], v[200:203], v[176:179], v[188:191]
    s_waitcnt vmcnt(2)
    v_mfma_f32_16x16x32_bf16 v[192:195], v[204:207], v[160:163], v[192:195]
    v_mfma_f32_16x16x32_bf16 v[196:199], v[204:207], v[176:179], v[196:199]
    s_waitcnt vmcnt(1)
    v_mfma_f32_16x16x32_bf16 v[184:187], v[208:211], v[164:167], v[184:187]
    v_mfma_f32_16x16x32_bf16 v[188:191], v[208:211], v[180:183], v[188:191]
    s_waitcnt vmcnt(0)
    v_mfma_f32_16x16x32_bf16 v[192:195], v[212:215], v[164:167], v[192:195]
    v_mfma_f32_16x16x32_bf16 v[196:199], v[212:215], v[180:183], v[196:199]
    s_nop 3
    v_exp_f32 v184, v184
    v_exp_f32 v185, v185
    v_add_f32 v9, v9, v184
    v_add_f32 v9, v9, v185
    v_cvt_pk_bf16_f32 v128, v184, v185
    v_exp_f32 v186, v186
    v_exp_f32 v187, v187
    v_add_f32 v9, v9, v186
    v_add_f32 v9, v9, v187
    v_cvt_pk_bf16_f32 v129, v186, v187
    v_exp_f32 v188, v188
    v_exp_f32 v189, v189
    v_add_f32 v10, v10, v188
    v_add_f32 v10, v10, v189
    v_cvt_pk_bf16_f32 v132, v188, v189
    v_exp_f32 v190, v190
    v_exp_f32 v191, v191
    v_add_f32 v10, v10, v190
    v_add_f32 v10, v10, v191
    v_cvt_pk_bf16_f32 v133, v190, v191
    v_exp_f32 v192, v192
    v_exp_f32 v193, v193
    v_add_f32 v9, v9, v192
    v_add_f32 v9, v9, v193
    v_cvt_pk_bf16_f32 v130, v192, v193
    v_exp_f32 v194, v194
    v_exp_f32 v195, v195
    v_add_f32 v9, v9, v194
    v_add_f32 v9, v9, v195
    v_cvt_pk_bf16_f32 v131, v194, v195
    v_exp_f32 v196, v196
    v_exp_f32 v197, v197
    v_add_f32 v10, v10, v196
    v_add_f32 v10, v10, v197
    v_cvt_pk_bf16_f32 v134, v196, v197
    v_exp_f32 v198, v198
    v_exp_f32 v199, v199
    v_add_f32 v10, v10, v198
    v_add_f32 v10, v10, v199
    v_cvt_pk_bf16_f32 v135, v198, v199
    s_mov_b32 s17, 0x1c000
    buffer_load_dwordx4 v[200:203], v8, s[8:11], s17 offen offset:0
    buffer_load_dwordx4 v[204:207], v8, s[8:11], s17 offen offset:1024
    buffer_load_dwordx4 v[208:211], v8, s[8:11], s17 offen offset:2048
    buffer_load_dwordx4 v[212:215], v8, s[8:11], s17 offen offset:3072
    s_waitcnt vmcnt(3)
    v_mfma_f32_16x16x32_bf16 v[184:187], v[200:203], v[152:155], v[216:219]
    v_mfma_f32_16x16x32_bf16 v[188:191], v[200:203], v[168:171], v[220:223]
    s_waitcnt vmcnt(2)
    v_mfma_f32_16x16x32_bf16 v[192:195], v[204:207], v[152:155], v[216:219]
    v_mfma_f32_16x16x32_bf16 v[196:199], v[204:207], v[168:171], v[220:223]
    s_waitcnt vmcnt(1)
    v_mfma_f32_16x16x32_bf16 v[184:187], v[208:211], v[156:159], v[184:187]
    v_mfma_f32_16x16x32_bf16 v[188:191], v[208:211], v[172:175], v[188:191]
    s_waitcnt vmcnt(0)
    v_mfma_f32_16x16x32_bf16 v[192:195], v[212:215], v[156:159], v[192:195]
    v_mfma_f32_16x16x32_bf16 v[196:199], v[212:215], v[172:175], v[196:199]
    s_mov_b32 s17, 0x1d000
    buffer_load_dwordx4 v[200:203], v8, s[8:11], s17 offen offset:0
    buffer_load_dwordx4 v[204:207], v8, s[8:11], s17 offen offset:1024
    buffer_load_dwordx4 v[208:211], v8, s[8:11], s17 offen offset:2048
    buffer_load_dwordx4 v[212:215], v8, s[8:11], s17 offen offset:3072
    s_waitcnt vmcnt(3)
    v_mfma_f32_16x16x32_bf16 v[184:187], v[200:203], v[160:163], v[184:187]
    v_mfma_f32_16x16x32_bf16 v[188:191], v[200:203], v[176:179], v[188:191]
    s_waitcnt vmcnt(2)
    v_mfma_f32_16x16x32_bf16 v[192:195], v[204:207], v[160:163], v[192:195]
    v_mfma_f32_16x16x32_bf16 v[196:199], v[204:207], v[176:179], v[196:199]
    s_waitcnt vmcnt(1)
    v_mfma_f32_16x16x32_bf16 v[184:187], v[208:211], v[164:167], v[184:187]
    v_mfma_f32_16x16x32_bf16 v[188:191], v[208:211], v[180:183], v[188:191]
    s_waitcnt vmcnt(0)
    v_mfma_f32_16x16x32_bf16 v[192:195], v[212:215], v[164:167], v[192:195]
    v_mfma_f32_16x16x32_bf16 v[196:199], v[212:215], v[180:183], v[196:199]
    s_nop 3
    v_exp_f32 v184, v184
    v_exp_f32 v185, v185
    v_add_f32 v9, v9, v184
    v_add_f32 v9, v9, v185
    v_cvt_pk_bf16_f32 v136, v184, v185
    v_exp_f32 v186, v186
    v_exp_f32 v187, v187
    v_add_f32 v9, v9, v186
    v_add_f32 v9, v9, v187
    v_cvt_pk_bf16_f32 v137, v186, v187
    v_exp_f32 v188, v188
    v_exp_f32 v189, v189
    v_add_f32 v10, v10, v188
    v_add_f32 v10, v10, v189
    v_cvt_pk_bf16_f32 v140, v188, v189
    v_exp_f32 v190, v190
    v_exp_f32 v191, v191
    v_add_f32 v10, v10, v190
    v_add_f32 v10, v10, v191
    v_cvt_pk_bf16_f32 v141, v190, v191
    v_exp_f32 v192, v192
    v_exp_f32 v193, v193
    v_add_f32 v9, v9, v192
    v_add_f32 v9, v9, v193
    v_cvt_pk_bf16_f32 v138, v192, v193
    v_exp_f32 v194, v194
    v_exp_f32 v195, v195
    v_add_f32 v9, v9, v194
    v_add_f32 v9, v9, v195
    v_cvt_pk_bf16_f32 v139, v194, v195
    v_exp_f32 v196, v196
    v_exp_f32 v197, v197
    v_add_f32 v10, v10, v196
    v_add_f32 v10, v10, v197
    v_cvt_pk_bf16_f32 v142, v196, v197
    v_exp_f32 v198, v198
    v_exp_f32 v199, v199
    v_add_f32 v10, v10, v198
    v_add_f32 v10, v10, v199
    v_cvt_pk_bf16_f32 v143, v198, v199
    s_mov_b32 s17, 0x1e000
    buffer_load_dwordx4 v[200:203], v8, s[8:11], s17 offen offset:0
    buffer_load_dwordx4 v[204:207], v8, s[8:11], s17 offen offset:1024
    buffer_load_dwordx4 v[208:211], v8, s[8:11], s17 offen offset:2048
    buffer_load_dwordx4 v[212:215], v8, s[8:11], s17 offen offset:3072
    s_waitcnt vmcnt(3)
    v_mfma_f32_16x16x32_bf16 v[184:187], v[200:203], v[152:155], v[216:219]
    v_mfma_f32_16x16x32_bf16 v[188:191], v[200:203], v[168:171], v[220:223]
    s_waitcnt vmcnt(2)
    v_mfma_f32_16x16x32_bf16 v[192:195], v[204:207], v[152:155], v[216:219]
    v_mfma_f32_16x16x32_bf16 v[196:199], v[204:207], v[168:171], v[220:223]
    s_waitcnt vmcnt(1)
    v_mfma_f32_16x16x32_bf16 v[184:187], v[208:211], v[156:159], v[184:187]
    v_mfma_f32_16x16x32_bf16 v[188:191], v[208:211], v[172:175], v[188:191]
    s_waitcnt vmcnt(0)
    v_mfma_f32_16x16x32_bf16 v[192:195], v[212:215], v[156:159], v[192:195]
    v_mfma_f32_16x16x32_bf16 v[196:199], v[212:215], v[172:175], v[196:199]
    s_mov_b32 s17, 0x1f000
    buffer_load_dwordx4 v[200:203], v8, s[8:11], s17 offen offset:0
    buffer_load_dwordx4 v[204:207], v8, s[8:11], s17 offen offset:1024
    buffer_load_dwordx4 v[208:211], v8, s[8:11], s17 offen offset:2048
    buffer_load_dwordx4 v[212:215], v8, s[8:11], s17 offen offset:3072
    s_waitcnt vmcnt(3)
    v_mfma_f32_16x16x32_bf16 v[184:187], v[200:203], v[160:163], v[184:187]
    v_mfma_f32_16x16x32_bf16 v[188:191], v[200:203], v[176:179], v[188:191]
    s_waitcnt vmcnt(2)
    v_mfma_f32_16x16x32_bf16 v[192:195], v[204:207], v[160:163], v[192:195]
    v_mfma_f32_16x16x32_bf16 v[196:199], v[204:207], v[176:179], v[196:199]
    s_waitcnt vmcnt(1)
    v_mfma_f32_16x16x32_bf16 v[184:187], v[208:211], v[164:167], v[184:187]
    v_mfma_f32_16x16x32_bf16 v[188:191], v[208:211], v[180:183], v[188:191]
    s_waitcnt vmcnt(0)
    v_mfma_f32_16x16x32_bf16 v[192:195], v[212:215], v[164:167], v[192:195]
    v_mfma_f32_16x16x32_bf16 v[196:199], v[212:215], v[180:183], v[196:199]
    s_nop 3
    v_exp_f32 v184, v184
    v_exp_f32 v185, v185
    v_add_f32 v9, v9, v184
    v_add_f32 v9, v9, v185
    v_cvt_pk_bf16_f32 v144, v184, v185
    v_exp_f32 v186, v186
    v_exp_f32 v187, v187
    v_add_f32 v9, v9, v186
    v_add_f32 v9, v9, v187
    v_cvt_pk_bf16_f32 v145, v186, v187
    v_exp_f32 v188, v188
    v_exp_f32 v189, v189
    v_add_f32 v10, v10, v188
    v_add_f32 v10, v10, v189
    v_cvt_pk_bf16_f32 v148, v188, v189
    v_exp_f32 v190, v190
    v_exp_f32 v191, v191
    v_add_f32 v10, v10, v190
    v_add_f32 v10, v10, v191
    v_cvt_pk_bf16_f32 v149, v190, v191
    v_exp_f32 v192, v192
    v_exp_f32 v193, v193
    v_add_f32 v9, v9, v192
    v_add_f32 v9, v9, v193
    v_cvt_pk_bf16_f32 v146, v192, v193
    v_exp_f32 v194, v194
    v_exp_f32 v195, v195
    v_add_f32 v9, v9, v194
    v_add_f32 v9, v9, v195
    v_cvt_pk_bf16_f32 v147, v194, v195
    v_exp_f32 v196, v196
    v_exp_f32 v197, v197
    v_add_f32 v10, v10, v196
    v_add_f32 v10, v10, v197
    v_cvt_pk_bf16_f32 v150, v196, v197
    v_exp_f32 v198, v198
    v_exp_f32 v199, v199
    v_add_f32 v10, v10, v198
    v_add_f32 v10, v10, v199
    v_cvt_pk_bf16_f32 v151, v198, v199
    v_mov_b32 v16, v9
    v_mov_b32 v18, v10
    s_nop 0
    v_permlane16_swap_b32 v9, v16
    v_permlane16_swap_b32 v10, v18
    v_add_f32 v9, v9, v16
    v_add_f32 v10, v10, v18
    v_mov_b32 v16, v9
    v_mov_b32 v18, v10
    s_nop 0
    v_permlane32_swap_b32 v9, v16
    v_permlane32_swap_b32 v10, v18
    v_add_f32 v9, v9, v16
    v_add_f32 v10, v10, v18
    s_waitcnt vmcnt(0) lgkmcnt(0)
    s_nop 15
    s_nop 3
    s_branch adaLN_cond__sliding_block_cached__moe_arch_mod__prompt_kernel_fixAb
adaLN_cond__sliding_block_cached__moe_arch_mod__prompt_kernel_o5r:
    s_waitcnt vmcnt(0) lgkmcnt(0)
    s_nop 15
    s_nop 3
    s_mov_b32 s27, 0
adaLN_cond__sliding_block_cached__moe_arch_mod__prompt_kernel_o5p:
    buffer_load_dword v12, v13, s[8:11], s19 offen sc1
    s_waitcnt vmcnt(0)
    v_cmp_ne_u32 vcc, s28, v12
    s_add_u32 s27, s27, 1
    s_cmp_ge_u32 s27, 65536
    s_cbranch_scc1 adaLN_cond__sliding_block_cached__moe_arch_mod__prompt_kernel_o5g
    s_cbranch_vccnz adaLN_cond__sliding_block_cached__moe_arch_mod__prompt_kernel_o5p
adaLN_cond__sliding_block_cached__moe_arch_mod__prompt_kernel_o5g:
    s_waitcnt vmcnt(0) lgkmcnt(0)
    s_nop 15
    s_nop 3
    s_branch adaLN_cond__sliding_block_cached__moe_arch_mod__prompt_kernel_o5b
adaLN_cond__sliding_block_cached__moe_arch_mod__prompt_kernel_mp6r:
    s_waitcnt vmcnt(0) lgkmcnt(0)
    s_nop 15
    s_nop 3
    s_mov_b32 s27, 0
adaLN_cond__sliding_block_cached__moe_arch_mod__prompt_kernel_mp6p:
    buffer_load_dword v248, v250, s[8:11], s14 offen sc1
    s_waitcnt vmcnt(0)
    v_cmp_ne_u32 vcc, s28, v248
    s_add_u32 s27, s27, 1
    s_cmp_ge_u32 s27, 65536
    s_cbranch_scc1 adaLN_cond__sliding_block_cached__moe_arch_mod__prompt_kernel_mp6g
    s_cbranch_vccnz adaLN_cond__sliding_block_cached__moe_arch_mod__prompt_kernel_mp6p
adaLN_cond__sliding_block_cached__moe_arch_mod__prompt_kernel_mp6g:
    s_waitcnt vmcnt(0) lgkmcnt(0)
    s_nop 15
    s_nop 3
    s_branch adaLN_cond__sliding_block_cached__moe_arch_mod__prompt_kernel_mp6b
adaLN_cond__sliding_block_cached__moe_arch_mod__prompt_kernel_o27r:
    s_waitcnt vmcnt(0) lgkmcnt(0)
    s_nop 15
    s_nop 3
    s_mov_b32 s27, 0
adaLN_cond__sliding_block_cached__moe_arch_mod__prompt_kernel_o27p:
    buffer_load_dword v12, v13, s[8:11], s19 offen sc1
    s_waitcnt vmcnt(0)
    v_cmp_ne_u32 vcc, s28, v12
    s_add_u32 s27, s27, 1
    s_cmp_ge_u32 s27, 65536
    s_cbranch_scc1 adaLN_cond__sliding_block_cached__moe_arch_mod__prompt_kernel_o27g
    s_cbranch_vccnz adaLN_cond__sliding_block_cached__moe_arch_mod__prompt_kernel_o27p
adaLN_cond__sliding_block_cached__moe_arch_mod__prompt_kernel_o27g:
    s_waitcnt vmcnt(0) lgkmcnt(0)
    s_nop 15
    s_nop 3
    s_branch adaLN_cond__sliding_block_cached__moe_arch_mod__prompt_kernel_o27b
adaLN_cond__sliding_block_cached__moe_arch_mod__prompt_kernel_o28r:
    s_waitcnt vmcnt(0) lgkmcnt(0)
    s_nop 15
    s_nop 3
    s_mov_b32 s27, 0
adaLN_cond__sliding_block_cached__moe_arch_mod__prompt_kernel_o28p:
    buffer_load_dword v12, v13, s[8:11], s19 offen sc1
    s_waitcnt vmcnt(0)
    v_cmp_ne_u32 vcc, s28, v12
    s_add_u32 s27, s27, 1
    s_cmp_ge_u32 s27, 65536
    s_cbranch_scc1 adaLN_cond__sliding_block_cached__moe_arch_mod__prompt_kernel_o28g
    s_cbranch_vccnz adaLN_cond__sliding_block_cached__moe_arch_mod__prompt_kernel_o28p
adaLN_cond__sliding_block_cached__moe_arch_mod__prompt_kernel_o28g:
    s_waitcnt vmcnt(0) lgkmcnt(0)
    s_nop 15
    s_nop 3
    s_branch adaLN_cond__sliding_block_cached__moe_arch_mod__prompt_kernel_o28b
adaLN_cond__sliding_block_cached__moe_arch_mod__prompt_kernel_o29r:
    s_waitcnt vmcnt(0) lgkmcnt(0)
    s_nop 15
    s_nop 3
    s_mov_b32 s27, 0
adaLN_cond__sliding_block_cached__moe_arch_mod__prompt_kernel_o29p:
    buffer_load_dword v12, v13, s[8:11], s19 offen sc1
    s_waitcnt vmcnt(0)
    v_cmp_ne_u32 vcc, s28, v12
    s_add_u32 s27, s27, 1
    s_cmp_ge_u32 s27, 65536
    s_cbranch_scc1 adaLN_cond__sliding_block_cached__moe_arch_mod__prompt_kernel_o29g
    s_cbranch_vccnz adaLN_cond__sliding_block_cached__moe_arch_mod__prompt_kernel_o29p
adaLN_cond__sliding_block_cached__moe_arch_mod__prompt_kernel_o29g:
    s_waitcnt vmcnt(0) lgkmcnt(0)
    s_nop 15
    s_nop 3
    s_branch adaLN_cond__sliding_block_cached__moe_arch_mod__prompt_kernel_o29b
adaLN_cond__sliding_block_cached__moe_arch_mod__prompt_kernel_mf10r:
    s_waitcnt vmcnt(0) lgkmcnt(0)
    s_nop 15
    s_nop 3
    s_mov_b32 s27, 0
adaLN_cond__sliding_block_cached__moe_arch_mod__prompt_kernel_mf10p:
    s_mov_b32 s16, 0x544000
    buffer_load_dwordx4 v[184:187], v2, s[8:11], s16 offen sc1
    s_waitcnt vmcnt(0)
    v_xor_b32 v16, s28, v184
    v_xor_b32 v17, s28, v185
    v_xor_b32 v18, s28, v186
    v_xor_b32 v19, s28, v187
    v_or3_b32 v16, v16, v17, v18
    v_or_b32 v16, v16, v19
    v_cmp_ne_u32 vcc, 0, v16
    s_add_u32 s27, s27, 1
    s_cmp_ge_u32 s27, 65536
    s_cbranch_scc1 adaLN_cond__sliding_block_cached__moe_arch_mod__prompt_kernel_mf10g
    s_cbranch_vccnz adaLN_cond__sliding_block_cached__moe_arch_mod__prompt_kernel_mf10p
adaLN_cond__sliding_block_cached__moe_arch_mod__prompt_kernel_mf10g:
    s_waitcnt vmcnt(0) lgkmcnt(0)
    s_nop 15
    s_nop 3
    s_branch adaLN_cond__sliding_block_cached__moe_arch_mod__prompt_kernel_mf10b
adaLN_cond__sliding_block_cached__moe_arch_mod__prompt_kernel_kv16r:
    s_waitcnt vmcnt(0) lgkmcnt(0)
    s_nop 15
    s_nop 3
    s_mov_b32 s27, 0
adaLN_cond__sliding_block_cached__moe_arch_mod__prompt_kernel_kv16p:
    buffer_load_dwordx4 v[12:15], v21, s[8:11], s18 offen sc1
    s_waitcnt vmcnt(0)
    v_xor_b32 v8, s28, v12
    v_xor_b32 v20, s28, v13
    v_or_b32 v8, v8, v20
    v_xor_b32 v20, s28, v14
    v_or_b32 v8, v8, v20
    v_xor_b32 v20, s28, v15
    v_or_b32 v8, v8, v20
    v_cmp_ne_u32 vcc, 0, v8
    s_add_u32 s27, s27, 1
    s_cmp_ge_u32 s27, 65536
    s_cbranch_scc1 adaLN_cond__sliding_block_cached__moe_arch_mod__prompt_kernel_kv16g
    s_cbranch_vccnz adaLN_cond__sliding_block_cached__moe_arch_mod__prompt_kernel_kv16p
adaLN_cond__sliding_block_cached__moe_arch_mod__prompt_kernel_kv16g:
    s_waitcnt vmcnt(0) lgkmcnt(0)
    s_nop 15
    s_nop 3
    s_branch adaLN_cond__sliding_block_cached__moe_arch_mod__prompt_kernel_kv16b
adaLN_cond__sliding_block_cached__moe_arch_mod__prompt_kernel_fixB:
    s_waitcnt vmcnt(0) lgkmcnt(0)
    s_nop 15
    s_nop 3
    s_lshr_b32 s16, s12, 3
    s_lshl_b32 s16, s16, 17
    s_add_u32 s16, s16, 0x400000
    v_add_u32 v8, s16, v2
    v_mov_b32 v16, 0xff7fffff
    v_mov_b32 v17, 0xff7fffff
    s_mov_b32 s16, 0
adaLN_cond__sliding_block_cached__moe_arch_mod__prompt_kernel_fixBm:
    s_add_u32 s17, s16, 0
    buffer_load_dwordx4 v[200:203], v8, s[8:11], s17 offen offset:0
    buffer_load_dwordx4 v[204:207], v8, s[8:11], s17 offen offset:1024
    buffer_load_dwordx4 v[208:211], v8, s[8:11], s17 offen offset:2048
    buffer_load_dwordx4 v[212:215], v8, s[8:11], s17 offen offset:3072
    s_waitcnt vmcnt(3)
    v_mfma_f32_16x16x32_bf16 v[184:187], v[200:203], v[152:155], 0
    v_mfma_f32_16x16x32_bf16 v[188:191], v[200:203], v[168:171], 0
    s_waitcnt vmcnt(2)
    v_mfma_f32_16x16x32_bf16 v[192:195], v[204:207], v[152:155], 0
    v_mfma_f32_16x16x32_bf16 v[196:199], v[204:207], v[168:171], 0
    s_waitcnt vmcnt(1)
    v_mfma_f32_16x16x32_bf16 v[184:187], v[208:211], v[156:159], v[184:187]
    v_mfma_f32_16x16x32_bf16 v[188:191], v[208:211], v[172:175], v[188:191]
    s_waitcnt vmcnt(0)
    v_mfma_f32_16x16x32_bf16 v[192:195], v[212:215], v[156:159], v[192:195]
    v_mfma_f32_16x16x32_bf16 v[196:199], v[212:215], v[172:175], v[196:199]
    s_add_u32 s17, s16, 4096
    buffer_load_dwordx4 v[200:203], v8, s[8:11], s17 offen offset:0
    buffer_load_dwordx4 v[204:207], v8, s[8:11], s17 offen offset:1024
    buffer_load_dwordx4 v[208:211], v8, s[8:11], s17 offen offset:2048
    buffer_load_dwordx4 v[212:215], v8, s[8:11], s17 offen offset:3072
    s_waitcnt vmcnt(3)
    v_mfma_f32_16x16x32_bf16 v[184:187], v[200:203], v[160:163], v[184:187]
    v_mfma_f32_16x16x32_bf16 v[188:191], v[200:203], v[176:179], v[188:191]
    s_waitcnt vmcnt(2)
    v_mfma_f32_16x16x32_bf16 v[192:195], v[204:207], v[160:163], v[192:195]
    v_mfma_f32_16x16x32_bf16 v[196:199], v[204:207], v[176:179], v[196:199]
    s_waitcnt vmcnt(1)
    v_mfma_f32_16x16x32_bf16 v[184:187], v[208:211], v[164:167], v[184:187]
    v_mfma_f32_16x16x32_bf16 v[188:191], v[208:211], v[180:183], v[188:191]
    s_waitcnt vmcnt(0)
    v_mfma_f32_16x16x32_bf16 v[192:195], v[212:215], v[164:167], v[192:195]
    v_mfma_f32_16x16x32_bf16 v[196:199], v[212:215], v[180:183], v[196:199]
    s_nop 3
    v_max3_f32 v16, v16, v184, v185
    v_max3_f32 v16, v16, v186, v187
    v_max3_f32 v17, v17, v188, v189
    v_max3_f32 v17, v17, v190, v191
    v_max3_f32 v16, v16, v192, v193
    v_max3_f32 v16, v16, v194, v195
    v_max3_f32 v17, v17, v196, v197
    v_max3_f32 v17, v17, v198, v199
    s_add_u32 s16, s16, 8192
    s_cmp_lt_u32 s16, 0x20000
    s_cbranch_scc1 adaLN_cond__sliding_block_cached__moe_arch_mod__prompt_kernel_fixBm
    v_mov_b32 v18, v16
    v_mov_b32 v19, v17
    s_nop 0
    v_permlane16_swap_b32 v16, v18
    v_permlane16_swap_b32 v17, v19
    v_max_f32 v16, v16, v18
    v_max_f32 v17, v17, v19
    v_mov_b32 v18, v16
    v_mov_b32 v19, v17
    s_nop 0
    v_permlane32_swap_b32 v16, v18
    v_permlane32_swap_b32 v17, v19
    v_max_f32 v16, v16, v18
    v_max_f32 v17, v17, v19
    v_sub_f32 v216, 0, v16
    v_sub_f32 v217, 0, v16
    v_sub_f32 v218, 0, v16
    v_sub_f32 v219, 0, v16
    v_sub_f32 v220, 0, v17
    v_sub_f32 v221, 0, v17
    v_sub_f32 v222, 0, v17
    v_sub_f32 v223, 0, v17
    s_mov_b32 s17, 0x0
    buffer_load_dwordx4 v[200:203], v8, s[8:11], s17 offen offset:0
    buffer_load_dwordx4 v[204:207], v8, s[8:11], s17 offen offset:1024
    buffer_load_dwordx4 v[208:211], v8, s[8:11], s17 offen offset:2048
    buffer_load_dwordx4 v[212:215], v8, s[8:11], s17 offen offset:3072
    s_waitcnt vmcnt(3)
    v_mfma_f32_16x16x32_bf16 v[184:187], v[200:203], v[152:155], v[216:219]
    v_mfma_f32_16x16x32_bf16 v[188:191], v[200:203], v[168:171], v[220:223]
    s_waitcnt vmcnt(2)
    v_mfma_f32_16x16x32_bf16 v[192:195], v[204:207], v[152:155], v[216:219]
    v_mfma_f32_16x16x32_bf16 v[196:199], v[204:207], v[168:171], v[220:223]
    s_waitcnt vmcnt(1)
    v_mfma_f32_16x16x32_bf16 v[184:187], v[208:211], v[156:159], v[184:187]
    v_mfma_f32_16x16x32_bf16 v[188:191], v[208:211], v[172:175], v[188:191]
    s_waitcnt vmcnt(0)
    v_mfma_f32_16x16x32_bf16 v[192:195], v[212:215], v[156:159], v[192:195]
    v_mfma_f32_16x16x32_bf16 v[196:199], v[212:215], v[172:175], v[196:199]
    s_mov_b32 s17, 0x1000
    buffer_load_dwordx4 v[200:203], v8, s[8:11], s17 offen offset:0
    buffer_load_dwordx4 v[204:207], v8, s[8:11], s17 offen offset:1024
    buffer_load_dwordx4 v[208:211], v8, s[8:11], s17 offen offset:2048
    buffer_load_dwordx4 v[212:215], v8, s[8:11], s17 offen offset:3072
    s_waitcnt vmcnt(3)
    v_mfma_f32_16x16x32_bf16 v[184:187], v[200:203], v[160:163], v[184:187]
    v_mfma_f32_16x16x32_bf16 v[188:191], v[200:203], v[176:179], v[188:191]
    s_waitcnt vmcnt(2)
    v_mfma_f32_16x16x32_bf16 v[192:195], v[204:207], v[160:163], v[192:195]
    v_mfma_f32_16x16x32_bf16 v[196:199], v[204:207], v[176:179], v[196:199]
    s_waitcnt vmcnt(1)
    v_mfma_f32_16x16x32_bf16 v[184:187], v[208:211], v[164:167], v[184:187]
    v_mfma_f32_16x16x32_bf16 v[188:191], v[208:211], v[180:183], v[188:191]
    s_waitcnt vmcnt(0)
    v_mfma_f32_16x16x32_bf16 v[192:195], v[212:215], v[164:167], v[192:195]
    v_mfma_f32_16x16x32_bf16 v[196:199], v[212:215], v[180:183], v[196:199]
    s_nop 3
    v_exp_f32 v184, v184
    v_exp_f32 v185, v185
    s_nop 0
    v_add_f32 v9, v184, v185
    v_cvt_pk_bf16_f32 v24, v184, v185
    v_exp_f32 v186, v186
    v_exp_f32 v187, v187
    v_add_f32 v9, v9, v186
    v_add_f32 v9, v9, v187
    v_cvt_pk_bf16_f32 v25, v186, v187
    v_exp_f32 v188, v188
    v_exp_f32 v189, v189
    s_nop 0
    v_add_f32 v10, v188, v189
    v_cvt_pk_bf16_f32 v28, v188, v189
    v_exp_f32 v190, v190
    v_exp_f32 v191, v191
    v_add_f32 v10, v10, v190
    v_add_f32 v10, v10, v191
    v_cvt_pk_bf16_f32 v29, v190, v191
    v_exp_f32 v192, v192
    v_exp_f32 v193, v193
    v_add_f32 v9, v9, v192
    v_add_f32 v9, v9, v193
    v_cvt_pk_bf16_f32 v26, v192, v193
    v_exp_f32 v194, v194
    v_exp_f32 v195, v195
    v_add_f32 v9, v9, v194
    v_add_f32 v9, v9, v195
    v_cvt_pk_bf16_f32 v27, v194, v195
    v_exp_f32 v196, v196
    v_exp_f32 v197, v197
    v_add_f32 v10, v10, v196
    v_add_f32 v10, v10, v197
    v_cvt_pk_bf16_f32 v30, v196, v197
    v_exp_f32 v198, v198
    v_exp_f32 v199, v199
    v_add_f32 v10, v10, v198
    v_add_f32 v10, v10, v199
    v_cvt_pk_bf16_f32 v31, v198, v199
    s_mov_b32 s17, 0x2000
    buffer_load_dwordx4 v[200:203], v8, s[8:11], s17 offen offset:0
    buffer_load_dwordx4 v[204:207], v8, s[8:11], s17 offen offset:1024
    buffer_load_dwordx4 v[208:211], v8, s[8:11], s17 offen offset:2048
    buffer_load_dwordx4 v[212:215], v8, s[8:11], s17 offen offset:3072
    s_waitcnt vmcnt(3)
    v_mfma_f32_16x16x32_bf16 v[184:187], v[200:203], v[152:155], v[216:219]
    v_mfma_f32_16x16x32_bf16 v[188:191], v[200:203], v[168:171], v[220:223]
    s_waitcnt vmcnt(2)
    v_mfma_f32_16x16x32_bf16 v[192:195], v[204:207], v[152:155], v[216:219]
    v_mfma_f32_16x16x32_bf16 v[196:199], v[204:207], v[168:171], v[220:223]
    s_waitcnt vmcnt(1)
    v_mfma_f32_16x16x32_bf16 v[184:187], v[208:211], v[156:159], v[184:187]
    v_mfma_f32_16x16x32_bf16 v[188:191], v[208:211], v[172:175], v[188:191]
    s_waitcnt vmcnt(0)
    v_mfma_f32_16x16x32_bf16 v[192:195], v[212:215], v[156:159], v[192:195]
    v_mfma_f32_16x16x32_bf16 v[196:199], v[212:215], v[172:175], v[196:199]
    s_mov_b32 s17, 0x3000
    buffer_load_dwordx4 v[200:203], v8, s[8:11], s17 offen offset:0
    buffer_load_dwordx4 v[204:207], v8, s[8:11], s17 offen offset:1024
    buffer_load_dwordx4 v[208:211], v8, s[8:11], s17 offen offset:2048
    buffer_load_dwordx4 v[212:215], v8, s[8:11], s17 offen offset:3072
    s_waitcnt vmcnt(3)
    v_mfma_f32_16x16x32_bf16 v[184:187], v[200:203], v[160:163], v[184:187]
    v_mfma_f32_16x16x32_bf16 v[188:191], v[200:203], v[176:179], v[188:191]
    s_waitcnt vmcnt(2)
    v_mfma_f32_16x16x32_bf16 v[192:195], v[204:207], v[160:163], v[192:195]
    v_mfma_f32_16x16x32_bf16 v[196:199], v[204:207], v[176:179], v[196:199]
    s_waitcnt vmcnt(1)
    v_mfma_f32_16x16x32_bf16 v[184:187], v[208:211], v[164:167], v[184:187]
    v_mfma_f32_16x16x32_bf16 v[188:191], v[208:211], v[180:183], v[188:191]
    s_waitcnt vmcnt(0)
    v_mfma_f32_16x16x32_bf16 v[192:195], v[212:215], v[164:167], v[192:195]
    v_mfma_f32_16x16x32_bf16 v[196:199], v[212:215], v[180:183], v[196:199]
    s_nop 3
    v_exp_f32 v184, v184
    v_exp_f32 v185, v185
    v_add_f32 v9, v9, v184
    v_add_f32 v9, v9, v185
    v_cvt_pk_bf16_f32 v32, v184, v185
    v_exp_f32 v186, v186
    v_exp_f32 v187, v187
    v_add_f32 v9, v9, v186
    v_add_f32 v9, v9, v187
    v_cvt_pk_bf16_f32 v33, v186, v187
    v_exp_f32 v188, v188
    v_exp_f32 v189, v189
    v_add_f32 v10, v10, v188
    v_add_f32 v10, v10, v189
    v_cvt_pk_bf16_f32 v36, v188, v189
    v_exp_f32 v190, v190
    v_exp_f32 v191, v191
    v_add_f32 v10, v10, v190
    v_add_f32 v10, v10, v191
    v_cvt_pk_bf16_f32 v37, v190, v191
    v_exp_f32 v192, v192
    v_exp_f32 v193, v193
    v_add_f32 v9, v9, v192
    v_add_f32 v9, v9, v193
    v_cvt_pk_bf16_f32 v34, v192, v193
    v_exp_f32 v194, v194
    v_exp_f32 v195, v195
    v_add_f32 v9, v9, v194
    v_add_f32 v9, v9, v195
    v_cvt_pk_bf16_f32 v35, v194, v195
    v_exp_f32 v196, v196
    v_exp_f32 v197, v197
    v_add_f32 v10, v10, v196
    v_add_f32 v10, v10, v197
    v_cvt_pk_bf16_f32 v38, v196, v197
    v_exp_f32 v198, v198
    v_exp_f32 v199, v199
    v_add_f32 v10, v10, v198
    v_add_f32 v10, v10, v199
    v_cvt_pk_bf16_f32 v39, v198, v199
    s_mov_b32 s17, 0x4000
    buffer_load_dwordx4 v[200:203], v8, s[8:11], s17 offen offset:0
    buffer_load_dwordx4 v[204:207], v8, s[8:11], s17 offen offset:1024
    buffer_load_dwordx4 v[208:211], v8, s[8:11], s17 offen offset:2048
    buffer_load_dwordx4 v[212:215], v8, s[8:11], s17 offen offset:3072
    s_waitcnt vmcnt(3)
    v_mfma_f32_16x16x32_bf16 v[184:187], v[200:203], v[152:155], v[216:219]
    v_mfma_f32_16x16x32_bf16 v[188:191], v[200:203], v[168:171], v[220:223]
    s_waitcnt vmcnt(2)
    v_mfma_f32_16x16x32_bf16 v[192:195], v[204:207], v[152:155], v[216:219]
    v_mfma_f32_16x16x32_bf16 v[196:199], v[204:207], v[168:171], v[220:223]
    s_waitcnt vmcnt(1)
    v_mfma_f32_16x16x32_bf16 v[184:187], v[208:211], v[156:159], v[184:187]
    v_mfma_f32_16x16x32_bf16 v[188:191], v[208:211], v[172:175], v[188:191]
    s_waitcnt vmcnt(0)
    v_mfma_f32_16x16x32_bf16 v[192:195], v[212:215], v[156:159], v[192:195]
    v_mfma_f32_16x16x32_bf16 v[196:199], v[212:215], v[172:175], v[196:199]
    s_mov_b32 s17, 0x5000
    buffer_load_dwordx4 v[200:203], v8, s[8:11], s17 offen offset:0
    buffer_load_dwordx4 v[204:207], v8, s[8:11], s17 offen offset:1024
    buffer_load_dwordx4 v[208:211], v8, s[8:11], s17 offen offset:2048
    buffer_load_dwordx4 v[212:215], v8, s[8:11], s17 offen offset:3072
    s_waitcnt vmcnt(3)
    v_mfma_f32_16x16x32_bf16 v[184:187], v[200:203], v[160:163], v[184:187]
    v_mfma_f32_16x16x32_bf16 v[188:191], v[200:203], v[176:179], v[188:191]
    s_waitcnt vmcnt(2)
    v_mfma_f32_16x16x32_bf16 v[192:195], v[204:207], v[160:163], v[192:195]
    v_mfma_f32_16x16x32_bf16 v[196:199], v[204:207], v[176:179], v[196:199]
    s_waitcnt vmcnt(1)
    v_mfma_f32_16x16x32_bf16 v[184:187], v[208:211], v[164:167], v[184:187]
    v_mfma_f32_16x16x32_bf16 v[188:191], v[208:211], v[180:183], v[188:191]
    s_waitcnt vmcnt(0)
    v_mfma_f32_16x16x32_bf16 v[192:195], v[212:215], v[164:167], v[192:195]
    v_mfma_f32_16x16x32_bf16 v[196:199], v[212:215], v[180:183], v[196:199]
    s_nop 3
    v_exp_f32 v184, v184
    v_exp_f32 v185, v185
    v_add_f32 v9, v9, v184
    v_add_f32 v9, v9, v185
    v_cvt_pk_bf16_f32 v40, v184, v185
    v_exp_f32 v186, v186
    v_exp_f32 v187, v187
    v_add_f32 v9, v9, v186
    v_add_f32 v9, v9, v187
    v_cvt_pk_bf16_f32 v41, v186, v187
    v_exp_f32 v188, v188
    v_exp_f32 v189, v189
    v_add_f32 v10, v10, v188
    v_add_f32 v10, v10, v189
    v_cvt_pk_bf16_f32 v44, v188, v189
    v_exp_f32 v190, v190
    v_exp_f32 v191, v191
    v_add_f32 v10, v10, v190
    v_add_f32 v10, v10, v191
    v_cvt_pk_bf16_f32 v45, v190, v191
    v_exp_f32 v192, v192
    v_exp_f32 v193, v193
    v_add_f32 v9, v9, v192
    v_add_f32 v9, v9, v193
    v_cvt_pk_bf16_f32 v42, v192, v193
    v_exp_f32 v194, v194
    v_exp_f32 v195, v195
    v_add_f32 v9, v9, v194
    v_add_f32 v9, v9, v195
    v_cvt_pk_bf16_f32 v43, v194, v195
    v_exp_f32 v196, v196
    v_exp_f32 v197, v197
    v_add_f32 v10, v10, v196
    v_add_f32 v10, v10, v197
    v_cvt_pk_bf16_f32 v46, v196, v197
    v_exp_f32 v198, v198
    v_exp_f32 v199, v199
    v_add_f32 v10, v10, v198
    v_add_f32 v10, v10, v199
    v_cvt_pk_bf16_f32 v47, v198, v199
    s_mov_b32 s17, 0x6000
    buffer_load_dwordx4 v[200:203], v8, s[8:11], s17 offen offset:0
    buffer_load_dwordx4 v[204:207], v8, s[8:11], s17 offen offset:1024
    buffer_load_dwordx4 v[208:211], v8, s[8:11], s17 offen offset:2048
    buffer_load_dwordx4 v[212:215], v8, s[8:11], s17 offen offset:3072
    s_waitcnt vmcnt(3)
    v_mfma_f32_16x16x32_bf16 v[184:187], v[200:203], v[152:155], v[216:219]
    v_mfma_f32_16x16x32_bf16 v[188:191], v[200:203], v[168:171], v[220:223]
    s_waitcnt vmcnt(2)
    v_mfma_f32_16x16x32_bf16 v[192:195], v[204:207], v[152:155], v[216:219]
    v_mfma_f32_16x16x32_bf16 v[196:199], v[204:207], v[168:171], v[220:223]
    s_waitcnt vmcnt(1)
    v_mfma_f32_16x16x32_bf16 v[184:187], v[208:211], v[156:159], v[184:187]
    v_mfma_f32_16x16x32_bf16 v[188:191], v[208:211], v[172:175], v[188:191]
    s_waitcnt vmcnt(0)
    v_mfma_f32_16x16x32_bf16 v[192:195], v[212:215], v[156:159], v[192:195]
    v_mfma_f32_16x16x32_bf16 v[196:199], v[212:215], v[172:175], v[196:199]
    s_mov_b32 s17, 0x7000
    buffer_load_dwordx4 v[200:203], v8, s[8:11], s17 offen offset:0
    buffer_load_dwordx4 v[204:207], v8, s[8:11], s17 offen offset:1024
    buffer_load_dwordx4 v[208:211], v8, s[8:11], s17 offen offset:2048
    buffer_load_dwordx4 v[212:215], v8, s[8:11], s17 offen offset:3072
    s_waitcnt vmcnt(3)
    v_mfma_f32_16x16x32_bf16 v[184:187], v[200:203], v[160:163], v[184:187]
    v_mfma_f32_16x16x32_bf16 v[188:191], v[200:203], v[176:179], v[188:191]
    s_waitcnt vmcnt(2)
    v_mfma_f32_16x16x32_bf16 v[192:195], v[204:207], v[160:163], v[192:195]
    v_mfma_f32_16x16x32_bf16 v[196:199], v[204:207], v[176:179], v[196:199]
    s_waitcnt vmcnt(1)
    v_mfma_f32_16x16x32_bf16 v[184:187], v[208:211], v[164:167], v[184:187]
    v_mfma_f32_16x16x32_bf16 v[188:191], v[208:211], v[180:183], v[188:191]
    s_waitcnt vmcnt(0)
    v_mfma_f32_16x16x32_bf16 v[192:195], v[212:215], v[164:167], v[192:195]
    v_mfma_f32_16x16x32_bf16 v[196:199], v[212:215], v[180:183], v[196:199]
    s_nop 3
    v_exp_f32 v184, v184
    v_exp_f32 v185, v185
    v_add_f32 v9, v9, v184
    v_add_f32 v9, v9, v185
    v_cvt_pk_bf16_f32 v48, v184, v185
    v_exp_f32 v186, v186
    v_exp_f32 v187, v187
    v_add_f32 v9, v9, v186
    v_add_f32 v9, v9, v187
    v_cvt_pk_bf16_f32 v49, v186, v187
    v_exp_f32 v188, v188
    v_exp_f32 v189, v189
    v_add_f32 v10, v10, v188
    v_add_f32 v10, v10, v189
    v_cvt_pk_bf16_f32 v52, v188, v189
    v_exp_f32 v190, v190
    v_exp_f32 v191, v191
    v_add_f32 v10, v10, v190
    v_add_f32 v10, v10, v191
    v_cvt_pk_bf16_f32 v53, v190, v191
    v_exp_f32 v192, v192
    v_exp_f32 v193, v193
    v_add_f32 v9, v9, v192
    v_add_f32 v9, v9, v193
    v_cvt_pk_bf16_f32 v50, v192, v193
    v_exp_f32 v194, v194
    v_exp_f32 v195, v195
    v_add_f32 v9, v9, v194
    v_add_f32 v9, v9, v195
    v_cvt_pk_bf16_f32 v51, v194, v195
    v_exp_f32 v196, v196
    v_exp_f32 v197, v197
    v_add_f32 v10, v10, v196
    v_add_f32 v10, v10, v197
    v_cvt_pk_bf16_f32 v54, v196, v197
    v_exp_f32 v198, v198
    v_exp_f32 v199, v199
    v_add_f32 v10, v10, v198
    v_add_f32 v10, v10, v199
    v_cvt_pk_bf16_f32 v55, v198, v199
    s_mov_b32 s17, 0x8000
    buffer_load_dwordx4 v[200:203], v8, s[8:11], s17 offen offset:0
    buffer_load_dwordx4 v[204:207], v8, s[8:11], s17 offen offset:1024
    buffer_load_dwordx4 v[208:211], v8, s[8:11], s17 offen offset:2048
    buffer_load_dwordx4 v[212:215], v8, s[8:11], s17 offen offset:3072
    s_waitcnt vmcnt(3)
    v_mfma_f32_16x16x32_bf16 v[184:187], v[200:203], v[152:155], v[216:219]
    v_mfma_f32_16x16x32_bf16 v[188:191], v[200:203], v[168:171], v[220:223]
    s_waitcnt vmcnt(2)
    v_mfma_f32_16x16x32_bf16 v[192:195], v[204:207], v[152:155], v[216:219]
    v_mfma_f32_16x16x32_bf16 v[196:199], v[204:207], v[168:171], v[220:223]
    s_waitcnt vmcnt(1)
    v_mfma_f32_16x16x32_bf16 v[184:187], v[208:211], v[156:159], v[184:187]
    v_mfma_f32_16x16x32_bf16 v[188:191], v[208:211], v[172:175], v[188:191]
    s_waitcnt vmcnt(0)
    v_mfma_f32_16x16x32_bf16 v[192:195], v[212:215], v[156:159], v[192:195]
    v_mfma_f32_16x16x32_bf16 v[196:199], v[212:215], v[172:175], v[196:199]
    s_mov_b32 s17, 0x9000
    buffer_load_dwordx4 v[200:203], v8, s[8:11], s17 offen offset:0
    buffer_load_dwordx4 v[204:207], v8, s[8:11], s17 offen offset:1024
    buffer_load_dwordx4 v[208:211], v8, s[8:11], s17 offen offset:2048
    buffer_load_dwordx4 v[212:215], v8, s[8:11], s17 offen offset:3072
    s_waitcnt vmcnt(3)
    v_mfma_f32_16x16x32_bf16 v[184:187], v[200:203], v[160:163], v[184:187]
    v_mfma_f32_16x16x32_bf16 v[188:191], v[200:203], v[176:179], v[188:191]
    s_waitcnt vmcnt(2)
    v_mfma_f32_16x16x32_bf16 v[192:195], v[204:207], v[160:163], v[192:195]
    v_mfma_f32_16x16x32_bf16 v[196:199], v[204:207], v[176:179], v[196:199]
    s_waitcnt vmcnt(1)
    v_mfma_f32_16x16x32_bf16 v[184:187], v[208:211], v[164:167], v[184:187]
    v_mfma_f32_16x16x32_bf16 v[188:191], v[208:211], v[180:183], v[188:191]
    s_waitcnt vmcnt(0)
    v_mfma_f32_16x16x32_bf16 v[192:195], v[212:215], v[164:167], v[192:195]
    v_mfma_f32_16x16x32_bf16 v[196:199], v[212:215], v[180:183], v[196:199]
    s_nop 3
    v_exp_f32 v184, v184
    v_exp_f32 v185, v185
    v_add_f32 v9, v9, v184
    v_add_f32 v9, v9, v185
    v_cvt_pk_bf16_f32 v56, v184, v185
    v_exp_f32 v186, v186
    v_exp_f32 v187, v187
    v_add_f32 v9, v9, v186
    v_add_f32 v9, v9, v187
    v_cvt_pk_bf16_f32 v57, v186, v187
    v_exp_f32 v188, v188
    v_exp_f32 v189, v189
    v_add_f32 v10, v10, v188
    v_add_f32 v10, v10, v189
    v_cvt_pk_bf16_f32 v60, v188, v189
    v_exp_f32 v190, v190
    v_exp_f32 v191, v191
    v_add_f32 v10, v10, v190
    v_add_f32 v10, v10, v191
    v_cvt_pk_bf16_f32 v61, v190, v191
    v_exp_f32 v192, v192
    v_exp_f32 v193, v193
    v_add_f32 v9, v9, v192
    v_add_f32 v9, v9, v193
    v_cvt_pk_bf16_f32 v58, v192, v193
    v_exp_f32 v194, v194
    v_exp_f32 v195, v195
    v_add_f32 v9, v9, v194
    v_add_f32 v9, v9, v195
    v_cvt_pk_bf16_f32 v59, v194, v195
    v_exp_f32 v196, v196
    v_exp_f32 v197, v197
    v_add_f32 v10, v10, v196
    v_add_f32 v10, v10, v197
    v_cvt_pk_bf16_f32 v62, v196, v197
    v_exp_f32 v198, v198
    v_exp_f32 v199, v199
    v_add_f32 v10, v10, v198
    v_add_f32 v10, v10, v199
    v_cvt_pk_bf16_f32 v63, v198, v199
    s_mov_b32 s17, 0xa000
    buffer_load_dwordx4 v[200:203], v8, s[8:11], s17 offen offset:0
    buffer_load_dwordx4 v[204:207], v8, s[8:11], s17 offen offset:1024
    buffer_load_dwordx4 v[208:211], v8, s[8:11], s17 offen offset:2048
    buffer_load_dwordx4 v[212:215], v8, s[8:11], s17 offen offset:3072
    s_waitcnt vmcnt(3)
    v_mfma_f32_16x16x32_bf16 v[184:187], v[200:203], v[152:155], v[216:219]
    v_mfma_f32_16x16x32_bf16 v[188:191], v[200:203], v[168:171], v[220:223]
    s_waitcnt vmcnt(2)
    v_mfma_f32_16x16x32_bf16 v[192:195], v[204:207], v[152:155], v[216:219]
    v_mfma_f32_16x16x32_bf16 v[196:199], v[204:207], v[168:171], v[220:223]
    s_waitcnt vmcnt(1)
    v_mfma_f32_16x16x32_bf16 v[184:187], v[208:211], v[156:159], v[184:187]
    v_mfma_f32_16x16x32_bf16 v[188:191], v[208:211], v[172:175], v[188:191]
    s_waitcnt vmcnt(0)
    v_mfma_f32_16x16x32_bf16 v[192:195], v[212:215], v[156:159], v[192:195]
    v_mfma_f32_16x16x32_bf16 v[196:199], v[212:215], v[172:175], v[196:199]
    s_mov_b32 s17, 0xb000
    buffer_load_dwordx4 v[200:203], v8, s[8:11], s17 offen offset:0
    buffer_load_dwordx4 v[204:207], v8, s[8:11], s17 offen offset:1024
    buffer_load_dwordx4 v[208:211], v8, s[8:11], s17 offen offset:2048
    buffer_load_dwordx4 v[212:215], v8, s[8:11], s17 offen offset:3072
    s_waitcnt vmcnt(3)
    v_mfma_f32_16x16x32_bf16 v[184:187], v[200:203], v[160:163], v[184:187]
    v_mfma_f32_16x16x32_bf16 v[188:191], v[200:203], v[176:179], v[188:191]
    s_waitcnt vmcnt(2)
    v_mfma_f32_16x16x32_bf16 v[192:195], v[204:207], v[160:163], v[192:195]
    v_mfma_f32_16x16x32_bf16 v[196:199], v[204:207], v[176:179], v[196:199]
    s_waitcnt vmcnt(1)
    v_mfma_f32_16x16x32_bf16 v[184:187], v[208:211], v[164:167], v[184:187]
    v_mfma_f32_16x16x32_bf16 v[188:191], v[208:211], v[180:183], v[188:191]
    s_waitcnt vmcnt(0)
    v_mfma_f32_16x16x32_bf16 v[192:195], v[212:215], v[164:167], v[192:195]
    v_mfma_f32_16x16x32_bf16 v[196:199], v[212:215], v[180:183], v[196:199]
    s_nop 3
    v_exp_f32 v184, v184
    v_exp_f32 v185, v185
    v_add_f32 v9, v9, v184
    v_add_f32 v9, v9, v185
    v_cvt_pk_bf16_f32 v64, v184, v185
    v_exp_f32 v186, v186
    v_exp_f32 v187, v187
    v_add_f32 v9, v9, v186
    v_add_f32 v9, v9, v187
    v_cvt_pk_bf16_f32 v65, v186, v187
    v_exp_f32 v188, v188
    v_exp_f32 v189, v189
    v_add_f32 v10, v10, v188
    v_add_f32 v10, v10, v189
    v_cvt_pk_bf16_f32 v68, v188, v189
    v_exp_f32 v190, v190
    v_exp_f32 v191, v191
    v_add_f32 v10, v10, v190
    v_add_f32 v10, v10, v191
    v_cvt_pk_bf16_f32 v69, v190, v191
    v_exp_f32 v192, v192
    v_exp_f32 v193, v193
    v_add_f32 v9, v9, v192
    v_add_f32 v9, v9, v193
    v_cvt_pk_bf16_f32 v66, v192, v193
    v_exp_f32 v194, v194
    v_exp_f32 v195, v195
    v_add_f32 v9, v9, v194
    v_add_f32 v9, v9, v195
    v_cvt_pk_bf16_f32 v67, v194, v195
    v_exp_f32 v196, v196
    v_exp_f32 v197, v197
    v_add_f32 v10, v10, v196
    v_add_f32 v10, v10, v197
    v_cvt_pk_bf16_f32 v70, v196, v197
    v_exp_f32 v198, v198
    v_exp_f32 v199, v199
    v_add_f32 v10, v10, v198
    v_add_f32 v10, v10, v199
    v_cvt_pk_bf16_f32 v71, v198, v199
    s_mov_b32 s17, 0xc000
    buffer_load_dwordx4 v[200:203], v8, s[8:11], s17 offen offset:0
    buffer_load_dwordx4 v[204:207], v8, s[8:11], s17 offen offset:1024
    buffer_load_dwordx4 v[208:211], v8, s[8:11], s17 offen offset:2048
    buffer_load_dwordx4 v[212:215], v8, s[8:11], s17 offen offset:3072
    s_waitcnt vmcnt(3)
    v_mfma_f32_16x16x32_bf16 v[184:187], v[200:203], v[152:155], v[216:219]
    v_mfma_f32_16x16x32_bf16 v[188:191], v[200:203], v[168:171], v[220:223]
    s_waitcnt vmcnt(2)
    v_mfma_f32_16x16x32_bf16 v[192:195], v[204:207], v[152:155], v[216:219]
    v_mfma_f32_16x16x32_bf16 v[196:199], v[204:207], v[168:171], v[220:223]
    s_waitcnt vmcnt(1)
    v_mfma_f32_16x16x32_bf16 v[184:187], v[208:211], v[156:159], v[184:187]
    v_mfma_f32_16x16x32_bf16 v[188:191], v[208:211], v[172:175], v[188:191]
    s_waitcnt vmcnt(0)
    v_mfma_f32_16x16x32_bf16 v[192:195], v[212:215], v[156:159], v[192:195]
    v_mfma_f32_16x16x32_bf16 v[196:199], v[212:215], v[172:175], v[196:199]
    s_mov_b32 s17, 0xd000
    buffer_load_dwordx4 v[200:203], v8, s[8:11], s17 offen offset:0
    buffer_load_dwordx4 v[204:207], v8, s[8:11], s17 offen offset:1024
    buffer_load_dwordx4 v[208:211], v8, s[8:11], s17 offen offset:2048
    buffer_load_dwordx4 v[212:215], v8, s[8:11], s17 offen offset:3072
    s_waitcnt vmcnt(3)
    v_mfma_f32_16x16x32_bf16 v[184:187], v[200:203], v[160:163], v[184:187]
    v_mfma_f32_16x16x32_bf16 v[188:191], v[200:203], v[176:179], v[188:191]
    s_waitcnt vmcnt(2)
    v_mfma_f32_16x16x32_bf16 v[192:195], v[204:207], v[160:163], v[192:195]
    v_mfma_f32_16x16x32_bf16 v[196:199], v[204:207], v[176:179], v[196:199]
    s_waitcnt vmcnt(1)
    v_mfma_f32_16x16x32_bf16 v[184:187], v[208:211], v[164:167], v[184:187]
    v_mfma_f32_16x16x32_bf16 v[188:191], v[208:211], v[180:183], v[188:191]
    s_waitcnt vmcnt(0)
    v_mfma_f32_16x16x32_bf16 v[192:195], v[212:215], v[164:167], v[192:195]
    v_mfma_f32_16x16x32_bf16 v[196:199], v[212:215], v[180:183], v[196:199]
    s_nop 3
    v_exp_f32 v184, v184
    v_exp_f32 v185, v185
    v_add_f32 v9, v9, v184
    v_add_f32 v9, v9, v185
    v_cvt_pk_bf16_f32 v72, v184, v185
    v_exp_f32 v186, v186
    v_exp_f32 v187, v187
    v_add_f32 v9, v9, v186
    v_add_f32 v9, v9, v187
    v_cvt_pk_bf16_f32 v73, v186, v187
    v_exp_f32 v188, v188
    v_exp_f32 v189, v189
    v_add_f32 v10, v10, v188
    v_add_f32 v10, v10, v189
    v_cvt_pk_bf16_f32 v76, v188, v189
    v_exp_f32 v190, v190
    v_exp_f32 v191, v191
    v_add_f32 v10, v10, v190
    v_add_f32 v10, v10, v191
    v_cvt_pk_bf16_f32 v77, v190, v191
    v_exp_f32 v192, v192
    v_exp_f32 v193, v193
    v_add_f32 v9, v9, v192
    v_add_f32 v9, v9, v193
    v_cvt_pk_bf16_f32 v74, v192, v193
    v_exp_f32 v194, v194
    v_exp_f32 v195, v195
    v_add_f32 v9, v9, v194
    v_add_f32 v9, v9, v195
    v_cvt_pk_bf16_f32 v75, v194, v195
    v_exp_f32 v196, v196
    v_exp_f32 v197, v197
    v_add_f32 v10, v10, v196
    v_add_f32 v10, v10, v197
    v_cvt_pk_bf16_f32 v78, v196, v197
    v_exp_f32 v198, v198
    v_exp_f32 v199, v199
    v_add_f32 v10, v10, v198
    v_add_f32 v10, v10, v199
    v_cvt_pk_bf16_f32 v79, v198, v199
    s_mov_b32 s17, 0xe000
    buffer_load_dwordx4 v[200:203], v8, s[8:11], s17 offen offset:0
    buffer_load_dwordx4 v[204:207], v8, s[8:11], s17 offen offset:1024
    buffer_load_dwordx4 v[208:211], v8, s[8:11], s17 offen offset:2048
    buffer_load_dwordx4 v[212:215], v8, s[8:11], s17 offen offset:3072
    s_waitcnt vmcnt(3)
    v_mfma_f32_16x16x32_bf16 v[184:187], v[200:203], v[152:155], v[216:219]
    v_mfma_f32_16x16x32_bf16 v[188:191], v[200:203], v[168:171], v[220:223]
    s_waitcnt vmcnt(2)
    v_mfma_f32_16x16x32_bf16 v[192:195], v[204:207], v[152:155], v[216:219]
    v_mfma_f32_16x16x32_bf16 v[196:199], v[204:207], v[168:171], v[220:223]
    s_waitcnt vmcnt(1)
    v_mfma_f32_16x16x32_bf16 v[184:187], v[208:211], v[156:159], v[184:187]
    v_mfma_f32_16x16x32_bf16 v[188:191], v[208:211], v[172:175], v[188:191]
    s_waitcnt vmcnt(0)
    v_mfma_f32_16x16x32_bf16 v[192:195], v[212:215], v[156:159], v[192:195]
    v_mfma_f32_16x16x32_bf16 v[196:199], v[212:215], v[172:175], v[196:199]
    s_mov_b32 s17, 0xf000
    buffer_load_dwordx4 v[200:203], v8, s[8:11], s17 offen offset:0
    buffer_load_dwordx4 v[204:207], v8, s[8:11], s17 offen offset:1024
    buffer_load_dwordx4 v[208:211], v8, s[8:11], s17 offen offset:2048
    buffer_load_dwordx4 v[212:215], v8, s[8:11], s17 offen offset:3072
    s_waitcnt vmcnt(3)
    v_mfma_f32_16x16x32_bf16 v[184:187], v[200:203], v[160:163], v[184:187]
    v_mfma_f32_16x16x32_bf16 v[188:191], v[200:203], v[176:179], v[188:191]
    s_waitcnt vmcnt(2)
    v_mfma_f32_16x16x32_bf16 v[192:195], v[204:207], v[160:163], v[192:195]
    v_mfma_f32_16x16x32_bf16 v[196:199], v[204:207], v[176:179], v[196:199]
    s_waitcnt vmcnt(1)
    v_mfma_f32_16x16x32_bf16 v[184:187], v[208:211], v[164:167], v[184:187]
    v_mfma_f32_16x16x32_bf16 v[188:191], v[208:211], v[180:183], v[188:191]
    s_waitcnt vmcnt(0)
    v_mfma_f32_16x16x32_bf16 v[192:195], v[212:215], v[164:167], v[192:195]
    v_mfma_f32_16x16x32_bf16 v[196:199], v[212:215], v[180:183], v[196:199]
    s_nop 3
    v_exp_f32 v184, v184
    v_exp_f32 v185, v185
    v_add_f32 v9, v9, v184
    v_add_f32 v9, v9, v185
    v_cvt_pk_bf16_f32 v80, v184, v185
    v_exp_f32 v186, v186
    v_exp_f32 v187, v187
    v_add_f32 v9, v9, v186
    v_add_f32 v9, v9, v187
    v_cvt_pk_bf16_f32 v81, v186, v187
    v_exp_f32 v188, v188
    v_exp_f32 v189, v189
    v_add_f32 v10, v10, v188
    v_add_f32 v10, v10, v189
    v_cvt_pk_bf16_f32 v84, v188, v189
    v_exp_f32 v190, v190
    v_exp_f32 v191, v191
    v_add_f32 v10, v10, v190
    v_add_f32 v10, v10, v191
    v_cvt_pk_bf16_f32 v85, v190, v191
    v_exp_f32 v192, v192
    v_exp_f32 v193, v193
    v_add_f32 v9, v9, v192
    v_add_f32 v9, v9, v193
    v_cvt_pk_bf16_f32 v82, v192, v193
    v_exp_f32 v194, v194
    v_exp_f32 v195, v195
    v_add_f32 v9, v9, v194
    v_add_f32 v9, v9, v195
    v_cvt_pk_bf16_f32 v83, v194, v195
    v_exp_f32 v196, v196
    v_exp_f32 v197, v197
    v_add_f32 v10, v10, v196
    v_add_f32 v10, v10, v197
    v_cvt_pk_bf16_f32 v86, v196, v197
    v_exp_f32 v198, v198
    v_exp_f32 v199, v199
    v_add_f32 v10, v10, v198
    v_add_f32 v10, v10, v199
    v_cvt_pk_bf16_f32 v87, v198, v199
    s_mov_b32 s17, 0x10000
    buffer_load_dwordx4 v[200:203], v8, s[8:11], s17 offen offset:0
    buffer_load_dwordx4 v[204:207], v8, s[8:11], s17 offen offset:1024
    buffer_load_dwordx4 v[208:211], v8, s[8:11], s17 offen offset:2048
    buffer_load_dwordx4 v[212:215], v8, s[8:11], s17 offen offset:3072
    s_waitcnt vmcnt(3)
    v_mfma_f32_16x16x32_bf16 v[184:187], v[200:203], v[152:155], v[216:219]
    v_mfma_f32_16x16x32_bf16 v[188:191], v[200:203], v[168:171], v[220:223]
    s_waitcnt vmcnt(2)
    v_mfma_f32_16x16x32_bf16 v[192:195], v[204:207], v[152:155], v[216:219]
    v_mfma_f32_16x16x32_bf16 v[196:199], v[204:207], v[168:171], v[220:223]
    s_waitcnt vmcnt(1)
    v_mfma_f32_16x16x32_bf16 v[184:187], v[208:211], v[156:159], v[184:187]
    v_mfma_f32_16x16x32_bf16 v[188:191], v[208:211], v[172:175], v[188:191]
    s_waitcnt vmcnt(0)
    v_mfma_f32_16x16x32_bf16 v[192:195], v[212:215], v[156:159], v[192:195]
    v_mfma_f32_16x16x32_bf16 v[196:199], v[212:215], v[172:175], v[196:199]
    s_mov_b32 s17, 0x11000
    buffer_load_dwordx4 v[200:203], v8, s[8:11], s17 offen offset:0
    buffer_load_dwordx4 v[204:207], v8, s[8:11], s17 offen offset:1024
    buffer_load_dwordx4 v[208:211], v8, s[8:11], s17 offen offset:2048
    buffer_load_dwordx4 v[212:215], v8, s[8:11], s17 offen offset:3072
    s_waitcnt vmcnt(3)
    v_mfma_f32_16x16x32_bf16 v[184:187], v[200:203], v[160:163], v[184:187]
    v_mfma_f32_16x16x32_bf16 v[188:191], v[200:203], v[176:179], v[188:191]
    s_waitcnt vmcnt(2)
    v_mfma_f32_16x16x32_bf16 v[192:195], v[204:207], v[160:163], v[192:195]
    v_mfma_f32_16x16x32_bf16 v[196:199], v[204:207], v[176:179], v[196:199]
    s_waitcnt vmcnt(1)
    v_mfma_f32_16x16x32_bf16 v[184:187], v[208:211], v[164:167], v[184:187]
    v_mfma_f32_16x16x32_bf16 v[188:191], v[208:211], v[180:183], v[188:191]
    s_waitcnt vmcnt(0)
    v_mfma_f32_16x16x32_bf16 v[192:195], v[212:215], v[164:167], v[192:195]
    v_mfma_f32_16x16x32_bf16 v[196:199], v[212:215], v[180:183], v[196:199]
    s_nop 3
    v_exp_f32 v184, v184
    v_exp_f32 v185, v185
    v_add_f32 v9, v9, v184
    v_add_f32 v9, v9, v185
    v_cvt_pk_bf16_f32 v88, v184, v185
    v_exp_f32 v186, v186
    v_exp_f32 v187, v187
    v_add_f32 v9, v9, v186
    v_add_f32 v9, v9, v187
    v_cvt_pk_bf16_f32 v89, v186, v187
    v_exp_f32 v188, v188
    v_exp_f32 v189, v189
    v_add_f32 v10, v10, v188
    v_add_f32 v10, v10, v189
    v_cvt_pk_bf16_f32 v92, v188, v189
    v_exp_f32 v190, v190
    v_exp_f32 v191, v191
    v_add_f32 v10, v10, v190
    v_add_f32 v10, v10, v191
    v_cvt_pk_bf16_f32 v93, v190, v191
    v_exp_f32 v192, v192
    v_exp_f32 v193, v193
    v_add_f32 v9, v9, v192
    v_add_f32 v9, v9, v193
    v_cvt_pk_bf16_f32 v90, v192, v193
    v_exp_f32 v194, v194
    v_exp_f32 v195, v195
    v_add_f32 v9, v9, v194
    v_add_f32 v9, v9, v195
    v_cvt_pk_bf16_f32 v91, v194, v195
    v_exp_f32 v196, v196
    v_exp_f32 v197, v197
    v_add_f32 v10, v10, v196
    v_add_f32 v10, v10, v197
    v_cvt_pk_bf16_f32 v94, v196, v197
    v_exp_f32 v198, v198
    v_exp_f32 v199, v199
    v_add_f32 v10, v10, v198
    v_add_f32 v10, v10, v199
    v_cvt_pk_bf16_f32 v95, v198, v199
    s_mov_b32 s17, 0x12000
    buffer_load_dwordx4 v[200:203], v8, s[8:11], s17 offen offset:0
    buffer_load_dwordx4 v[204:207], v8, s[8:11], s17 offen offset:1024
    buffer_load_dwordx4 v[208:211], v8, s[8:11], s17 offen offset:2048
    buffer_load_dwordx4 v[212:215], v8, s[8:11], s17 offen offset:3072
    s_waitcnt vmcnt(3)
    v_mfma_f32_16x16x32_bf16 v[184:187], v[200:203], v[152:155], v[216:219]
    v_mfma_f32_16x16x32_bf16 v[188:191], v[200:203], v[168:171], v[220:223]
    s_waitcnt vmcnt(2)
    v_mfma_f32_16x16x32_bf16 v[192:195], v[204:207], v[152:155], v[216:219]
    v_mfma_f32_16x16x32_bf16 v[196:199], v[204:207], v[168:171], v[220:223]
    s_waitcnt vmcnt(1)
    v_mfma_f32_16x16x32_bf16 v[184:187], v[208:211], v[156:159], v[184:187]
    v_mfma_f32_16x16x32_bf16 v[188:191], v[208:211], v[172:175], v[188:191]
    s_waitcnt vmcnt(0)
    v_mfma_f32_16x16x32_bf16 v[192:195], v[212:215], v[156:159], v[192:195]
    v_mfma_f32_16x16x32_bf16 v[196:199], v[212:215], v[172:175], v[196:199]
    s_mov_b32 s17, 0x13000
    buffer_load_dwordx4 v[200:203], v8, s[8:11], s17 offen offset:0
    buffer_load_dwordx4 v[204:207], v8, s[8:11], s17 offen offset:1024
    buffer_load_dwordx4 v[208:211], v8, s[8:11], s17 offen offset:2048
    buffer_load_dwordx4 v[212:215], v8, s[8:11], s17 offen offset:3072
    s_waitcnt vmcnt(3)
    v_mfma_f32_16x16x32_bf16 v[184:187], v[200:203], v[160:163], v[184:187]
    v_mfma_f32_16x16x32_bf16 v[188:191], v[200:203], v[176:179], v[188:191]
    s_waitcnt vmcnt(2)
    v_mfma_f32_16x16x32_bf16 v[192:195], v[204:207], v[160:163], v[192:195]
    v_mfma_f32_16x16x32_bf16 v[196:199], v[204:207], v[176:179], v[196:199]
    s_waitcnt vmcnt(1)
    v_mfma_f32_16x16x32_bf16 v[184:187], v[208:211], v[164:167], v[184:187]
    v_mfma_f32_16x16x32_bf16 v[188:191], v[208:211], v[180:183], v[188:191]
    s_waitcnt vmcnt(0)
    v_mfma_f32_16x16x32_bf16 v[192:195], v[212:215], v[164:167], v[192:195]
    v_mfma_f32_16x16x32_bf16 v[196:199], v[212:215], v[180:183], v[196:199]
    s_nop 3
    v_exp_f32 v184, v184
    v_exp_f32 v185, v185
    v_add_f32 v9, v9, v184
    v_add_f32 v9, v9, v185
    v_cvt_pk_bf16_f32 v96, v184, v185
    v_exp_f32 v186, v186
    v_exp_f32 v187, v187
    v_add_f32 v9, v9, v186
    v_add_f32 v9, v9, v187
    v_cvt_pk_bf16_f32 v97, v186, v187
    v_exp_f32 v188, v188
    v_exp_f32 v189, v189
    v_add_f32 v10, v10, v188
    v_add_f32 v10, v10, v189
    v_cvt_pk_bf16_f32 v100, v188, v189
    v_exp_f32 v190, v190
    v_exp_f32 v191, v191
    v_add_f32 v10, v10, v190
    v_add_f32 v10, v10, v191
    v_cvt_pk_bf16_f32 v101, v190, v191
    v_exp_f32 v192, v192
    v_exp_f32 v193, v193
    v_add_f32 v9, v9, v192
    v_add_f32 v9, v9, v193
    v_cvt_pk_bf16_f32 v98, v192, v193
    v_exp_f32 v194, v194
    v_exp_f32 v195, v195
    v_add_f32 v9, v9, v194
    v_add_f32 v9, v9, v195
    v_cvt_pk_bf16_f32 v99, v194, v195
    v_exp_f32 v196, v196
    v_exp_f32 v197, v197
    v_add_f32 v10, v10, v196
    v_add_f32 v10, v10, v197
    v_cvt_pk_bf16_f32 v102, v196, v197
    v_exp_f32 v198, v198
    v_exp_f32 v199, v199
    v_add_f32 v10, v10, v198
    v_add_f32 v10, v10, v199
    v_cvt_pk_bf16_f32 v103, v198, v199
    s_mov_b32 s17, 0x14000
    buffer_load_dwordx4 v[200:203], v8, s[8:11], s17 offen offset:0
    buffer_load_dwordx4 v[204:207], v8, s[8:11], s17 offen offset:1024
    buffer_load_dwordx4 v[208:211], v8, s[8:11], s17 offen offset:2048
    buffer_load_dwordx4 v[212:215], v8, s[8:11], s17 offen offset:3072
    s_waitcnt vmcnt(3)
    v_mfma_f32_16x16x32_bf16 v[184:187], v[200:203], v[152:155], v[216:219]
    v_mfma_f32_16x16x32_bf16 v[188:191], v[200:203], v[168:171], v[220:223]
    s_waitcnt vmcnt(2)
    v_mfma_f32_16x16x32_bf16 v[192:195], v[204:207], v[152:155], v[216:219]
    v_mfma_f32_16x16x32_bf16 v[196:199], v[204:207], v[168:171], v[220:223]
    s_waitcnt vmcnt(1)
    v_mfma_f32_16x16x32_bf16 v[184:187], v[208:211], v[156:159], v[184:187]
    v_mfma_f32_16x16x32_bf16 v[188:191], v[208:211], v[172:175], v[188:191]
    s_waitcnt vmcnt(0)
    v_mfma_f32_16x16x32_bf16 v[192:195], v[212:215], v[156:159], v[192:195]
    v_mfma_f32_16x16x32_bf16 v[196:199], v[212:215], v[172:175], v[196:199]
    s_mov_b32 s17, 0x15000
    buffer_load_dwordx4 v[200:203], v8, s[8:11], s17 offen offset:0
    buffer_load_dwordx4 v[204:207], v8, s[8:11], s17 offen offset:1024
    buffer_load_dwordx4 v[208:211], v8, s[8:11], s17 offen offset:2048
    buffer_load_dwordx4 v[212:215], v8, s[8:11], s17 offen offset:3072
    s_waitcnt vmcnt(3)
    v_mfma_f32_16x16x32_bf16 v[184:187], v[200:203], v[160:163], v[184:187]
    v_mfma_f32_16x16x32_bf16 v[188:191], v[200:203], v[176:179], v[188:191]
    s_waitcnt vmcnt(2)
    v_mfma_f32_16x16x32_bf16 v[192:195], v[204:207], v[160:163], v[192:195]
    v_mfma_f32_16x16x32_bf16 v[196:199], v[204:207], v[176:179], v[196:199]
    s_waitcnt vmcnt(1)
    v_mfma_f32_16x16x32_bf16 v[184:187], v[208:211], v[164:167], v[184:187]
    v_mfma_f32_16x16x32_bf16 v[188:191], v[208:211], v[180:183], v[188:191]
    s_waitcnt vmcnt(0)
    v_mfma_f32_16x16x32_bf16 v[192:195], v[212:215], v[164:167], v[192:195]
    v_mfma_f32_16x16x32_bf16 v[196:199], v[212:215], v[180:183], v[196:199]
    s_nop 3
    v_exp_f32 v184, v184
    v_exp_f32 v185, v185
    v_add_f32 v9, v9, v184
    v_add_f32 v9, v9, v185
    v_cvt_pk_bf16_f32 v104, v184, v185
    v_exp_f32 v186, v186
    v_exp_f32 v187, v187
    v_add_f32 v9, v9, v186
    v_add_f32 v9, v9, v187
    v_cvt_pk_bf16_f32 v105, v186, v187
    v_exp_f32 v188, v188
    v_exp_f32 v189, v189
    v_add_f32 v10, v10, v188
    v_add_f32 v10, v10, v189
    v_cvt_pk_bf16_f32 v108, v188, v189
    v_exp_f32 v190, v190
    v_exp_f32 v191, v191
    v_add_f32 v10, v10, v190
    v_add_f32 v10, v10, v191
    v_cvt_pk_bf16_f32 v109, v190, v191
    v_exp_f32 v192, v192
    v_exp_f32 v193, v193
    v_add_f32 v9, v9, v192
    v_add_f32 v9, v9, v193
    v_cvt_pk_bf16_f32 v106, v192, v193
    v_exp_f32 v194, v194
    v_exp_f32 v195, v195
    v_add_f32 v9, v9, v194
    v_add_f32 v9, v9, v195
    v_cvt_pk_bf16_f32 v107, v194, v195
    v_exp_f32 v196, v196
    v_exp_f32 v197, v197
    v_add_f32 v10, v10, v196
    v_add_f32 v10, v10, v197
    v_cvt_pk_bf16_f32 v110, v196, v197
    v_exp_f32 v198, v198
    v_exp_f32 v199, v199
    v_add_f32 v10, v10, v198
    v_add_f32 v10, v10, v199
    v_cvt_pk_bf16_f32 v111, v198, v199
    s_mov_b32 s17, 0x16000
    buffer_load_dwordx4 v[200:203], v8, s[8:11], s17 offen offset:0
    buffer_load_dwordx4 v[204:207], v8, s[8:11], s17 offen offset:1024
    buffer_load_dwordx4 v[208:211], v8, s[8:11], s17 offen offset:2048
    buffer_load_dwordx4 v[212:215], v8, s[8:11], s17 offen offset:3072
    s_waitcnt vmcnt(3)
    v_mfma_f32_16x16x32_bf16 v[184:187], v[200:203], v[152:155], v[216:219]
    v_mfma_f32_16x16x32_bf16 v[188:191], v[200:203], v[168:171], v[220:223]
    s_waitcnt vmcnt(2)
    v_mfma_f32_16x16x32_bf16 v[192:195], v[204:207], v[152:155], v[216:219]
    v_mfma_f32_16x16x32_bf16 v[196:199], v[204:207], v[168:171], v[220:223]
    s_waitcnt vmcnt(1)
    v_mfma_f32_16x16x32_bf16 v[184:187], v[208:211], v[156:159], v[184:187]
    v_mfma_f32_16x16x32_bf16 v[188:191], v[208:211], v[172:175], v[188:191]
    s_waitcnt vmcnt(0)
    v_mfma_f32_16x16x32_bf16 v[192:195], v[212:215], v[156:159], v[192:195]
    v_mfma_f32_16x16x32_bf16 v[196:199], v[212:215], v[172:175], v[196:199]
    s_mov_b32 s17, 0x17000
    buffer_load_dwordx4 v[200:203], v8, s[8:11], s17 offen offset:0
    buffer_load_dwordx4 v[204:207], v8, s[8:11], s17 offen offset:1024
    buffer_load_dwordx4 v[208:211], v8, s[8:11], s17 offen offset:2048
    buffer_load_dwordx4 v[212:215], v8, s[8:11], s17 offen offset:3072
    s_waitcnt vmcnt(3)
    v_mfma_f32_16x16x32_bf16 v[184:187], v[200:203], v[160:163], v[184:187]
    v_mfma_f32_16x16x32_bf16 v[188:191], v[200:203], v[176:179], v[188:191]
    s_waitcnt vmcnt(2)
    v_mfma_f32_16x16x32_bf16 v[192:195], v[204:207], v[160:163], v[192:195]
    v_mfma_f32_16x16x32_bf16 v[196:199], v[204:207], v[176:179], v[196:199]
    s_waitcnt vmcnt(1)
    v_mfma_f32_16x16x32_bf16 v[184:187], v[208:211], v[164:167], v[184:187]
    v_mfma_f32_16x16x32_bf16 v[188:191], v[208:211], v[180:183], v[188:191]
    s_waitcnt vmcnt(0)
    v_mfma_f32_16x16x32_bf16 v[192:195], v[212:215], v[164:167], v[192:195]
    v_mfma_f32_16x16x32_bf16 v[196:199], v[212:215], v[180:183], v[196:199]
    s_nop 3
    v_exp_f32 v184, v184
    v_exp_f32 v185, v185
    v_add_f32 v9, v9, v184
    v_add_f32 v9, v9, v185
    v_cvt_pk_bf16_f32 v112, v184, v185
    v_exp_f32 v186, v186
    v_exp_f32 v187, v187
    v_add_f32 v9, v9, v186
    v_add_f32 v9, v9, v187
    v_cvt_pk_bf16_f32 v113, v186, v187
    v_exp_f32 v188, v188
    v_exp_f32 v189, v189
    v_add_f32 v10, v10, v188
    v_add_f32 v10, v10, v189
    v_cvt_pk_bf16_f32 v116, v188, v189
    v_exp_f32 v190, v190
    v_exp_f32 v191, v191
    v_add_f32 v10, v10, v190
    v_add_f32 v10, v10, v191
    v_cvt_pk_bf16_f32 v117, v190, v191
    v_exp_f32 v192, v192
    v_exp_f32 v193, v193
    v_add_f32 v9, v9, v192
    v_add_f32 v9, v9, v193
    v_cvt_pk_bf16_f32 v114, v192, v193
    v_exp_f32 v194, v194
    v_exp_f32 v195, v195
    v_add_f32 v9, v9, v194
    v_add_f32 v9, v9, v195
    v_cvt_pk_bf16_f32 v115, v194, v195
    v_exp_f32 v196, v196
    v_exp_f32 v197, v197
    v_add_f32 v10, v10, v196
    v_add_f32 v10, v10, v197
    v_cvt_pk_bf16_f32 v118, v196, v197
    v_exp_f32 v198, v198
    v_exp_f32 v199, v199
    v_add_f32 v10, v10, v198
    v_add_f32 v10, v10, v199
    v_cvt_pk_bf16_f32 v119, v198, v199
    s_mov_b32 s17, 0x18000
    buffer_load_dwordx4 v[200:203], v8, s[8:11], s17 offen offset:0
    buffer_load_dwordx4 v[204:207], v8, s[8:11], s17 offen offset:1024
    buffer_load_dwordx4 v[208:211], v8, s[8:11], s17 offen offset:2048
    buffer_load_dwordx4 v[212:215], v8, s[8:11], s17 offen offset:3072
    s_waitcnt vmcnt(3)
    v_mfma_f32_16x16x32_bf16 v[184:187], v[200:203], v[152:155], v[216:219]
    v_mfma_f32_16x16x32_bf16 v[188:191], v[200:203], v[168:171], v[220:223]
    s_waitcnt vmcnt(2)
    v_mfma_f32_16x16x32_bf16 v[192:195], v[204:207], v[152:155], v[216:219]
    v_mfma_f32_16x16x32_bf16 v[196:199], v[204:207], v[168:171], v[220:223]
    s_waitcnt vmcnt(1)
    v_mfma_f32_16x16x32_bf16 v[184:187], v[208:211], v[156:159], v[184:187]
    v_mfma_f32_16x16x32_bf16 v[188:191], v[208:211], v[172:175], v[188:191]
    s_waitcnt vmcnt(0)
    v_mfma_f32_16x16x32_bf16 v[192:195], v[212:215], v[156:159], v[192:195]
    v_mfma_f32_16x16x32_bf16 v[196:199], v[212:215], v[172:175], v[196:199]
    s_mov_b32 s17, 0x19000
    buffer_load_dwordx4 v[200:203], v8, s[8:11], s17 offen offset:0
    buffer_load_dwordx4 v[204:207], v8, s[8:11], s17 offen offset:1024
    buffer_load_dwordx4 v[208:211], v8, s[8:11], s17 offen offset:2048
    buffer_load_dwordx4 v[212:215], v8, s[8:11], s17 offen offset:3072
    s_waitcnt vmcnt(3)
    v_mfma_f32_16x16x32_bf16 v[184:187], v[200:203], v[160:163], v[184:187]
    v_mfma_f32_16x16x32_bf16 v[188:191], v[200:203], v[176:179], v[188:191]
    s_waitcnt vmcnt(2)
    v_mfma_f32_16x16x32_bf16 v[192:195], v[204:207], v[160:163], v[192:195]
    v_mfma_f32_16x16x32_bf16 v[196:199], v[204:207], v[176:179], v[196:199]
    s_waitcnt vmcnt(1)
    v_mfma_f32_16x16x32_bf16 v[184:187], v[208:211], v[164:167], v[184:187]
    v_mfma_f32_16x16x32_bf16 v[188:191], v[208:211], v[180:183], v[188:191]
    s_waitcnt vmcnt(0)
    v_mfma_f32_16x16x32_bf16 v[192:195], v[212:215], v[164:167], v[192:195]
    v_mfma_f32_16x16x32_bf16 v[196:199], v[212:215], v[180:183], v[196:199]
    s_nop 3
    v_exp_f32 v184, v184
    v_exp_f32 v185, v185
    v_add_f32 v9, v9, v184
    v_add_f32 v9, v9, v185
    v_cvt_pk_bf16_f32 v120, v184, v185
    v_exp_f32 v186, v186
    v_exp_f32 v187, v187
    v_add_f32 v9, v9, v186
    v_add_f32 v9, v9, v187
    v_cvt_pk_bf16_f32 v121, v186, v187
    v_exp_f32 v188, v188
    v_exp_f32 v189, v189
    v_add_f32 v10, v10, v188
    v_add_f32 v10, v10, v189
    v_cvt_pk_bf16_f32 v124, v188, v189
    v_exp_f32 v190, v190
    v_exp_f32 v191, v191
    v_add_f32 v10, v10, v190
    v_add_f32 v10, v10, v191
    v_cvt_pk_bf16_f32 v125, v190, v191
    v_exp_f32 v192, v192
    v_exp_f32 v193, v193
    v_add_f32 v9, v9, v192
    v_add_f32 v9, v9, v193
    v_cvt_pk_bf16_f32 v122, v192, v193
    v_exp_f32 v194, v194
    v_exp_f32 v195, v195
    v_add_f32 v9, v9, v194
    v_add_f32 v9, v9, v195
    v_cvt_pk_bf16_f32 v123, v194, v195
    v_exp_f32 v196, v196
    v_exp_f32 v197, v197
    v_add_f32 v10, v10, v196
    v_add_f32 v10, v10, v197
    v_cvt_pk_bf16_f32 v126, v196, v197
    v_exp_f32 v198, v198
    v_exp_f32 v199, v199
    v_add_f32 v10, v10, v198
    v_add_f32 v10, v10, v199
    v_cvt_pk_bf16_f32 v127, v198, v199
    s_mov_b32 s17, 0x1a000
    buffer_load_dwordx4 v[200:203], v8, s[8:11], s17 offen offset:0
    buffer_load_dwordx4 v[204:207], v8, s[8:11], s17 offen offset:1024
    buffer_load_dwordx4 v[208:211], v8, s[8:11], s17 offen offset:2048
    buffer_load_dwordx4 v[212:215], v8, s[8:11], s17 offen offset:3072
    s_waitcnt vmcnt(3)
    v_mfma_f32_16x16x32_bf16 v[184:187], v[200:203], v[152:155], v[216:219]
    v_mfma_f32_16x16x32_bf16 v[188:191], v[200:203], v[168:171], v[220:223]
    s_waitcnt vmcnt(2)
    v_mfma_f32_16x16x32_bf16 v[192:195], v[204:207], v[152:155], v[216:219]
    v_mfma_f32_16x16x32_bf16 v[196:199], v[204:207], v[168:171], v[220:223]
    s_waitcnt vmcnt(1)
    v_mfma_f32_16x16x32_bf16 v[184:187], v[208:211], v[156:159], v[184:187]
    v_mfma_f32_16x16x32_bf16 v[188:191], v[208:211], v[172:175], v[188:191]
    s_waitcnt vmcnt(0)
    v_mfma_f32_16x16x32_bf16 v[192:195], v[212:215], v[156:159], v[192:195]
    v_mfma_f32_16x16x32_bf16 v[196:199], v[212:215], v[172:175], v[196:199]
    s_mov_b32 s17, 0x1b000
    buffer_load_dwordx4 v[200:203], v8, s[8:11], s17 offen offset:0
    buffer_load_dwordx4 v[204:207], v8, s[8:11], s17 offen offset:1024
    buffer_load_dwordx4 v[208:211], v8, s[8:11], s17 offen offset:2048
    buffer_load_dwordx4 v[212:215], v8, s[8:11], s17 offen offset:3072
    s_waitcnt vmcnt(3)
    v_mfma_f32_16x16x32_bf16 v[184:187], v[200:203], v[160:163], v[184:187]
    v_mfma_f32_16x16x32_bf16 v[188:191], v[200:203], v[176:179], v[188:191]
    s_waitcnt vmcnt(2)
    v_mfma_f32_16x16x32_bf16 v[192:195], v[204:207], v[160:163], v[192:195]
    v_mfma_f32_16x16x32_bf16 v[196:199], v[204:207], v[176:179], v[196:199]
    s_waitcnt vmcnt(1)
    v_mfma_f32_16x16x32_bf16 v[184:187], v[208:211], v[164:167], v[184:187]
    v_mfma_f32_16x16x32_bf16 v[188:191], v[208:211], v[180:183], v[188:191]
    s_waitcnt vmcnt(0)
    v_mfma_f32_16x16x32_bf16 v[192:195], v[212:215], v[164:167], v[192:195]
    v_mfma_f32_16x16x32_bf16 v[196:199], v[212:215], v[180:183], v[196:199]
    s_nop 3
    v_exp_f32 v184, v184
    v_exp_f32 v185, v185
    v_add_f32 v9, v9, v184
    v_add_f32 v9, v9, v185
    v_cvt_pk_bf16_f32 v128, v184, v185
    v_exp_f32 v186, v186
    v_exp_f32 v187, v187
    v_add_f32 v9, v9, v186
    v_add_f32 v9, v9, v187
    v_cvt_pk_bf16_f32 v129, v186, v187
    v_exp_f32 v188, v188
    v_exp_f32 v189, v189
    v_add_f32 v10, v10, v188
    v_add_f32 v10, v10, v189
    v_cvt_pk_bf16_f32 v132, v188, v189
    v_exp_f32 v190, v190
    v_exp_f32 v191, v191
    v_add_f32 v10, v10, v190
    v_add_f32 v10, v10, v191
    v_cvt_pk_bf16_f32 v133, v190, v191
    v_exp_f32 v192, v192
    v_exp_f32 v193, v193
    v_add_f32 v9, v9, v192
    v_add_f32 v9, v9, v193
    v_cvt_pk_bf16_f32 v130, v192, v193
    v_exp_f32 v194, v194
    v_exp_f32 v195, v195
    v_add_f32 v9, v9, v194
    v_add_f32 v9, v9, v195
    v_cvt_pk_bf16_f32 v131, v194, v195
    v_exp_f32 v196, v196
    v_exp_f32 v197, v197
    v_add_f32 v10, v10, v196
    v_add_f32 v10, v10, v197
    v_cvt_pk_bf16_f32 v134, v196, v197
    v_exp_f32 v198, v198
    v_exp_f32 v199, v199
    v_add_f32 v10, v10, v198
    v_add_f32 v10, v10, v199
    v_cvt_pk_bf16_f32 v135, v198, v199
    s_mov_b32 s17, 0x1c000
    buffer_load_dwordx4 v[200:203], v8, s[8:11], s17 offen offset:0
    buffer_load_dwordx4 v[204:207], v8, s[8:11], s17 offen offset:1024
    buffer_load_dwordx4 v[208:211], v8, s[8:11], s17 offen offset:2048
    buffer_load_dwordx4 v[212:215], v8, s[8:11], s17 offen offset:3072
    s_waitcnt vmcnt(3)
    v_mfma_f32_16x16x32_bf16 v[184:187], v[200:203], v[152:155], v[216:219]
    v_mfma_f32_16x16x32_bf16 v[188:191], v[200:203], v[168:171], v[220:223]
    s_waitcnt vmcnt(2)
    v_mfma_f32_16x16x32_bf16 v[192:195], v[204:207], v[152:155], v[216:219]
    v_mfma_f32_16x16x32_bf16 v[196:199], v[204:207], v[168:171], v[220:223]
    s_waitcnt vmcnt(1)
    v_mfma_f32_16x16x32_bf16 v[184:187], v[208:211], v[156:159], v[184:187]
    v_mfma_f32_16x16x32_bf16 v[188:191], v[208:211], v[172:175], v[188:191]
    s_waitcnt vmcnt(0)
    v_mfma_f32_16x16x32_bf16 v[192:195], v[212:215], v[156:159], v[192:195]
    v_mfma_f32_16x16x32_bf16 v[196:199], v[212:215], v[172:175], v[196:199]
    s_mov_b32 s17, 0x1d000
    buffer_load_dwordx4 v[200:203], v8, s[8:11], s17 offen offset:0
    buffer_load_dwordx4 v[204:207], v8, s[8:11], s17 offen offset:1024
    buffer_load_dwordx4 v[208:211], v8, s[8:11], s17 offen offset:2048
    buffer_load_dwordx4 v[212:215], v8, s[8:11], s17 offen offset:3072
    s_waitcnt vmcnt(3)
    v_mfma_f32_16x16x32_bf16 v[184:187], v[200:203], v[160:163], v[184:187]
    v_mfma_f32_16x16x32_bf16 v[188:191], v[200:203], v[176:179], v[188:191]
    s_waitcnt vmcnt(2)
    v_mfma_f32_16x16x32_bf16 v[192:195], v[204:207], v[160:163], v[192:195]
    v_mfma_f32_16x16x32_bf16 v[196:199], v[204:207], v[176:179], v[196:199]
    s_waitcnt vmcnt(1)
    v_mfma_f32_16x16x32_bf16 v[184:187], v[208:211], v[164:167], v[184:187]
    v_mfma_f32_16x16x32_bf16 v[188:191], v[208:211], v[180:183], v[188:191]
    s_waitcnt vmcnt(0)
    v_mfma_f32_16x16x32_bf16 v[192:195], v[212:215], v[164:167], v[192:195]
    v_mfma_f32_16x16x32_bf16 v[196:199], v[212:215], v[180:183], v[196:199]
    s_nop 3
    v_exp_f32 v184, v184
    v_exp_f32 v185, v185
    v_add_f32 v9, v9, v184
    v_add_f32 v9, v9, v185
    v_cvt_pk_bf16_f32 v136, v184, v185
    v_exp_f32 v186, v186
    v_exp_f32 v187, v187
    v_add_f32 v9, v9, v186
    v_add_f32 v9, v9, v187
    v_cvt_pk_bf16_f32 v137, v186, v187
    v_exp_f32 v188, v188
    v_exp_f32 v189, v189
    v_add_f32 v10, v10, v188
    v_add_f32 v10, v10, v189
    v_cvt_pk_bf16_f32 v140, v188, v189
    v_exp_f32 v190, v190
    v_exp_f32 v191, v191
    v_add_f32 v10, v10, v190
    v_add_f32 v10, v10, v191
    v_cvt_pk_bf16_f32 v141, v190, v191
    v_exp_f32 v192, v192
    v_exp_f32 v193, v193
    v_add_f32 v9, v9, v192
    v_add_f32 v9, v9, v193
    v_cvt_pk_bf16_f32 v138, v192, v193
    v_exp_f32 v194, v194
    v_exp_f32 v195, v195
    v_add_f32 v9, v9, v194
    v_add_f32 v9, v9, v195
    v_cvt_pk_bf16_f32 v139, v194, v195
    v_exp_f32 v196, v196
    v_exp_f32 v197, v197
    v_add_f32 v10, v10, v196
    v_add_f32 v10, v10, v197
    v_cvt_pk_bf16_f32 v142, v196, v197
    v_exp_f32 v198, v198
    v_exp_f32 v199, v199
    v_add_f32 v10, v10, v198
    v_add_f32 v10, v10, v199
    v_cvt_pk_bf16_f32 v143, v198, v199
    s_mov_b32 s17, 0x1e000
    buffer_load_dwordx4 v[200:203], v8, s[8:11], s17 offen offset:0
    buffer_load_dwordx4 v[204:207], v8, s[8:11], s17 offen offset:1024
    buffer_load_dwordx4 v[208:211], v8, s[8:11], s17 offen offset:2048
    buffer_load_dwordx4 v[212:215], v8, s[8:11], s17 offen offset:3072
    s_waitcnt vmcnt(3)
    v_mfma_f32_16x16x32_bf16 v[184:187], v[200:203], v[152:155], v[216:219]
    v_mfma_f32_16x16x32_bf16 v[188:191], v[200:203], v[168:171], v[220:223]
    s_waitcnt vmcnt(2)
    v_mfma_f32_16x16x32_bf16 v[192:195], v[204:207], v[152:155], v[216:219]
    v_mfma_f32_16x16x32_bf16 v[196:199], v[204:207], v[168:171], v[220:223]
    s_waitcnt vmcnt(1)
    v_mfma_f32_16x16x32_bf16 v[184:187], v[208:211], v[156:159], v[184:187]
    v_mfma_f32_16x16x32_bf16 v[188:191], v[208:211], v[172:175], v[188:191]
    s_waitcnt vmcnt(0)
    v_mfma_f32_16x16x32_bf16 v[192:195], v[212:215], v[156:159], v[192:195]
    v_mfma_f32_16x16x32_bf16 v[196:199], v[212:215], v[172:175], v[196:199]
    s_mov_b32 s17, 0x1f000
    buffer_load_dwordx4 v[200:203], v8, s[8:11], s17 offen offset:0
    buffer_load_dwordx4 v[204:207], v8, s[8:11], s17 offen offset:1024
    buffer_load_dwordx4 v[208:211], v8, s[8:11], s17 offen offset:2048
    buffer_load_dwordx4 v[212:215], v8, s[8:11], s17 offen offset:3072
    s_waitcnt vmcnt(3)
    v_mfma_f32_16x16x32_bf16 v[184:187], v[200:203], v[160:163], v[184:187]
    v_mfma_f32_16x16x32_bf16 v[188:191], v[200:203], v[176:179], v[188:191]
    s_waitcnt vmcnt(2)
    v_mfma_f32_16x16x32_bf16 v[192:195], v[204:207], v[160:163], v[192:195]
    v_mfma_f32_16x16x32_bf16 v[196:199], v[204:207], v[176:179], v[196:199]
    s_waitcnt vmcnt(1)
    v_mfma_f32_16x16x32_bf16 v[184:187], v[208:211], v[164:167], v[184:187]
    v_mfma_f32_16x16x32_bf16 v[188:191], v[208:211], v[180:183], v[188:191]
    s_waitcnt vmcnt(0)
    v_mfma_f32_16x16x32_bf16 v[192:195], v[212:215], v[164:167], v[192:195]
    v_mfma_f32_16x16x32_bf16 v[196:199], v[212:215], v[180:183], v[196:199]
    s_nop 3
    v_exp_f32 v184, v184
    v_exp_f32 v185, v185
    v_add_f32 v9, v9, v184
    v_add_f32 v9, v9, v185
    v_cvt_pk_bf16_f32 v144, v184, v185
    v_exp_f32 v186, v186
    v_exp_f32 v187, v187
    v_add_f32 v9, v9, v186
    v_add_f32 v9, v9, v187
    v_cvt_pk_bf16_f32 v145, v186, v187
    v_exp_f32 v188, v188
    v_exp_f32 v189, v189
    v_add_f32 v10, v10, v188
    v_add_f32 v10, v10, v189
    v_cvt_pk_bf16_f32 v148, v188, v189
    v_exp_f32 v190, v190
    v_exp_f32 v191, v191
    v_add_f32 v10, v10, v190
    v_add_f32 v10, v10, v191
    v_cvt_pk_bf16_f32 v149, v190, v191
    v_exp_f32 v192, v192
    v_exp_f32 v193, v193
    v_add_f32 v9, v9, v192
    v_add_f32 v9, v9, v193
    v_cvt_pk_bf16_f32 v146, v192, v193
    v_exp_f32 v194, v194
    v_exp_f32 v195, v195
    v_add_f32 v9, v9, v194
    v_add_f32 v9, v9, v195
    v_cvt_pk_bf16_f32 v147, v194, v195
    v_exp_f32 v196, v196
    v_exp_f32 v197, v197
    v_add_f32 v10, v10, v196
    v_add_f32 v10, v10, v197
    v_cvt_pk_bf16_f32 v150, v196, v197
    v_exp_f32 v198, v198
    v_exp_f32 v199, v199
    v_add_f32 v10, v10, v198
    v_add_f32 v10, v10, v199
    v_cvt_pk_bf16_f32 v151, v198, v199
    v_mov_b32 v16, v9
    v_mov_b32 v18, v10
    s_nop 0
    v_permlane16_swap_b32 v9, v16
    v_permlane16_swap_b32 v10, v18
    v_add_f32 v9, v9, v16
    v_add_f32 v10, v10, v18
    v_mov_b32 v16, v9
    v_mov_b32 v18, v10
    s_nop 0
    v_permlane32_swap_b32 v9, v16
    v_permlane32_swap_b32 v10, v18
    v_add_f32 v9, v9, v16
    v_add_f32 v10, v10, v18
    s_waitcnt vmcnt(0) lgkmcnt(0)
    s_nop 15
    s_nop 3
    s_branch adaLN_cond__sliding_block_cached__moe_arch_mod__prompt_kernel_fixBb
adaLN_cond__sliding_block_cached__moe_arch_mod__prompt_kernel_o17r:
    s_waitcnt vmcnt(0) lgkmcnt(0)
    s_nop 15
    s_nop 3
    s_mov_b32 s27, 0
adaLN_cond__sliding_block_cached__moe_arch_mod__prompt_kernel_o17p:
    buffer_load_dword v12, v13, s[8:11], s19 offen sc1
    s_waitcnt vmcnt(0)
    v_cmp_ne_u32 vcc, s28, v12
    s_add_u32 s27, s27, 1
    s_cmp_ge_u32 s27, 65536
    s_cbranch_scc1 adaLN_cond__sliding_block_cached__moe_arch_mod__prompt_kernel_o17g
    s_cbranch_vccnz adaLN_cond__sliding_block_cached__moe_arch_mod__prompt_kernel_o17p
adaLN_cond__sliding_block_cached__moe_arch_mod__prompt_kernel_o17g:
    s_waitcnt vmcnt(0) lgkmcnt(0)
    s_nop 15
    s_nop 3
    s_branch adaLN_cond__sliding_block_cached__moe_arch_mod__prompt_kernel_o17b
adaLN_cond__sliding_block_cached__moe_arch_mod__prompt_kernel_o218r:
    s_waitcnt vmcnt(0) lgkmcnt(0)
    s_nop 15
    s_nop 3
    s_mov_b32 s27, 0
adaLN_cond__sliding_block_cached__moe_arch_mod__prompt_kernel_o218p:
    buffer_load_dword v12, v13, s[8:11], s19 offen sc1
    s_waitcnt vmcnt(0)
    v_cmp_ne_u32 vcc, s28, v12
    s_add_u32 s27, s27, 1
    s_cmp_ge_u32 s27, 65536
    s_cbranch_scc1 adaLN_cond__sliding_block_cached__moe_arch_mod__prompt_kernel_o218g
    s_cbranch_vccnz adaLN_cond__sliding_block_cached__moe_arch_mod__prompt_kernel_o218p
adaLN_cond__sliding_block_cached__moe_arch_mod__prompt_kernel_o218g:
    s_waitcnt vmcnt(0) lgkmcnt(0)
    s_nop 15
    s_nop 3
    s_branch adaLN_cond__sliding_block_cached__moe_arch_mod__prompt_kernel_o218b
adaLN_cond__sliding_block_cached__moe_arch_mod__prompt_kernel_o219r:
    s_waitcnt vmcnt(0) lgkmcnt(0)
    s_nop 15
    s_nop 3
    s_mov_b32 s27, 0
adaLN_cond__sliding_block_cached__moe_arch_mod__prompt_kernel_o219p:
    buffer_load_dword v12, v13, s[8:11], s19 offen sc1
    s_waitcnt vmcnt(0)
    v_cmp_ne_u32 vcc, s28, v12
    s_add_u32 s27, s27, 1
    s_cmp_ge_u32 s27, 65536
    s_cbranch_scc1 adaLN_cond__sliding_block_cached__moe_arch_mod__prompt_kernel_o219g
    s_cbranch_vccnz adaLN_cond__sliding_block_cached__moe_arch_mod__prompt_kernel_o219p
adaLN_cond__sliding_block_cached__moe_arch_mod__prompt_kernel_o219g:
    s_waitcnt vmcnt(0) lgkmcnt(0)
    s_nop 15
    s_nop 3
    s_branch adaLN_cond__sliding_block_cached__moe_arch_mod__prompt_kernel_o219b
adaLN_cond__sliding_block_cached__moe_arch_mod__prompt_kernel_o220r:
    s_waitcnt vmcnt(0) lgkmcnt(0)
    s_nop 15
    s_nop 3
    s_mov_b32 s27, 0
adaLN_cond__sliding_block_cached__moe_arch_mod__prompt_kernel_o220p:
    buffer_load_dword v12, v13, s[8:11], s19 offen sc1
    s_waitcnt vmcnt(0)
    v_cmp_ne_u32 vcc, s28, v12
    s_add_u32 s27, s27, 1
    s_cmp_ge_u32 s27, 65536
    s_cbranch_scc1 adaLN_cond__sliding_block_cached__moe_arch_mod__prompt_kernel_o220g
    s_cbranch_vccnz adaLN_cond__sliding_block_cached__moe_arch_mod__prompt_kernel_o220p
adaLN_cond__sliding_block_cached__moe_arch_mod__prompt_kernel_o220g:
    s_waitcnt vmcnt(0) lgkmcnt(0)
    s_nop 15
    s_nop 3
    s_branch adaLN_cond__sliding_block_cached__moe_arch_mod__prompt_kernel_o220b
adaLN_cond__sliding_block_cached__moe_arch_mod__prompt_kernel_mf21r:
    s_waitcnt vmcnt(0) lgkmcnt(0)
    s_nop 15
    s_nop 3
    s_mov_b32 s27, 0
adaLN_cond__sliding_block_cached__moe_arch_mod__prompt_kernel_mf21p:
    s_mov_b32 s16, 0x544000
    buffer_load_dwordx4 v[184:187], v2, s[8:11], s16 offen sc1
    s_waitcnt vmcnt(0)
    v_xor_b32 v16, s28, v184
    v_xor_b32 v17, s28, v185
    v_xor_b32 v18, s28, v186
    v_xor_b32 v19, s28, v187
    v_or3_b32 v16, v16, v17, v18
    v_or_b32 v16, v16, v19
    v_cmp_ne_u32 vcc, 0, v16
    s_add_u32 s27, s27, 1
    s_cmp_ge_u32 s27, 65536
    s_cbranch_scc1 adaLN_cond__sliding_block_cached__moe_arch_mod__prompt_kernel_mf21g
    s_cbranch_vccnz adaLN_cond__sliding_block_cached__moe_arch_mod__prompt_kernel_mf21p
adaLN_cond__sliding_block_cached__moe_arch_mod__prompt_kernel_mf21g:
    s_waitcnt vmcnt(0) lgkmcnt(0)
    s_nop 15
    s_nop 3
    s_branch adaLN_cond__sliding_block_cached__moe_arch_mod__prompt_kernel_mf21b
adaLN_cond__sliding_block_cached__moe_arch_mod__prompt_kernel_codeend:
    s_endpgm
.section .rodata,"a"
.p2align 6
.amdhsa_kernel adaLN_cond__sliding_block_cached__moe_arch_mod__prompt_kernel
  .amdhsa_next_free_vgpr 256
  .amdhsa_next_free_sgpr 80
  .amdhsa_accum_offset 256
  .amdhsa_group_segment_fixed_size 0
  .amdhsa_kernarg_size 120
  .amdhsa_user_sgpr_count 2
  .amdhsa_user_sgpr_kernarg_segment_ptr 1
  .amdhsa_system_sgpr_workgroup_id_x 1
  .amdhsa_float_denorm_mode_32 3
.end_amdhsa_kernel
```

```asm
; @launch grid=(256,1,1) block=(512,1,1) lds=163840
.amdgcn_target "amdgcn-amd-amdhsa--gfx950"
.text
.globl adaLN_cond__sliding_block_cached__moe_arch_mod__prompt_kernel
.p2align 8
.type adaLN_cond__sliding_block_cached__moe_arch_mod__prompt_kernel,@function
adaLN_cond__sliding_block_cached__moe_arch_mod__prompt_kernel:
    s_cmp_ge_u32 s2, 256
    s_cbranch_scc1 adaLN_cond__sliding_block_cached__moe_arch_mod__prompt_kernel_end
    s_getpc_b64 s[76:77]
adaLN_cond__sliding_block_cached__moe_arch_mod__prompt_kernel_pc0:
    s_sub_u32 s76, s76, adaLN_cond__sliding_block_cached__moe_arch_mod__prompt_kernel_pc0-adaLN_cond__sliding_block_cached__moe_arch_mod__prompt_kernel
    s_subb_u32 s77, s77, 0
    v_and_b32 v16, 63, v0
    v_lshlrev_b32 v16, 7, v16
    v_lshrrev_b32 v17, 6, v0
    s_lshr_b32 s62, s2, 3
    s_lshl_b32 s62, s62, 13
    v_lshlrev_b32 v18, 13, v17
    v_mov_b32 v19, s62
    v_cmp_eq_u32 vcc, 7, v17
    s_nop 1
    v_cndmask_b32 v18, v18, v19, vcc
    v_add_u32 v16, v16, v18
    v_min_u32 v16, adaLN_cond__sliding_block_cached__moe_arch_mod__prompt_kernel_codeend-adaLN_cond__sliding_block_cached__moe_arch_mod__prompt_kernel-4, v16
    v_mov_b32 v25, s77
    v_add_co_u32 v24, vcc, s76, v16
    s_nop 1
    v_addc_co_u32 v25, vcc, 0, v25, vcc
    v_cmp_gt_u32 vcc, 2, v17
    v_cmp_eq_u32 s[62:63], 7, v17
    s_or_b64 vcc, vcc, s[62:63]
    s_and_saveexec_b64 s[62:63], vcc
    s_cbranch_execz adaLN_cond__sliding_block_cached__moe_arch_mod__prompt_kernel_nocp0
    global_load_dword v26, v[24:25], off
adaLN_cond__sliding_block_cached__moe_arch_mod__prompt_kernel_nocp0:
    s_mov_b64 exec, s[62:63]
    s_load_dwordx4 s[56:59], s[0:1], 96
    s_load_dwordx2 s[60:61], s[0:1], 112
    s_load_dwordx8 s[48:55], s[0:1], 64
    s_load_dwordx16 s[32:47], s[0:1], 0
    s_memrealtime s[62:63]
    v_lshrrev_b32 v16, 6, v0
    v_and_b32 v1, 63, v0
    v_readfirstlane_b32 s3, v16
    v_lshlrev_b32 v2, 4, v1
    s_and_b32 s12, s2, 3
    s_lshl_b32 s12, s12, 3
    s_bfe_u32 s13, s2, 0x30003
    s_add_u32 s12, s12, s13
    s_bfe_u32 s13, s2, 0x10002
    s_lshl_b32 s13, s13, 2
    s_lshr_b32 s14, s2, 6
    s_add_u32 s13, s13, s14
    v_bfe_u32 v16, v1, 2, 2
    v_lshrrev_b32 v17, 4, v1
    v_and_b32 v18, 3, v1
    v_lshlrev_b32 v19, 6, v17
    v_lshl_add_u32 v19, v18, 4, v19
    v_lshl_add_u32 v3, v16, 13, v19
    s_and_b32 s14, s3, 1
    s_lshl_b32 s14, s14, 5
    v_xor_b32 v3, s14, v3
    v_lshlrev_b32 v4, 11, v17
    v_lshl_add_u32 v4, v16, 6, v4
    v_lshl_add_u32 v4, v18, 3, v4
    v_and_b32 v20, 1, v17
    v_lshlrev_b32 v20, 5, v20
    v_sub_u32 v5, v4, v20
    v_add_u32 v4, v4, v20
    s_lshl_b32 s14, s13, 3
    s_add_u32 s14, s14, s3
    s_lshl_b32 s14, s14, 16
    v_add_u32 v7, s14, v2
    s_cmp_ge_u32 s3, 4
    s_cbranch_scc1 adaLN_cond__sliding_block_cached__moe_arch_mod__prompt_kernel_roleB
    v_mov_b32 v132, 0
    v_mov_b32 v133, 0
    v_lshrrev_b32 v16, 3, v0
    v_and_b32 v17, 7, v0
    v_mul_u32_u24 v135, 24576, v16
    v_lshl_add_u32 v135, v17, 4, v135
    v_lshlrev_b32 v136, 2, v16
    s_and_b32 s14, s2, 31
    s_lshr_b32 s15, s2, 5
    s_mul_i32 s26, s15, 1572864
    s_lshl_b32 s16, s14, 7
    s_add_u32 s26, s26, s16
    s_lshl_b32 s29, s15, 8
    v_lshlrev_b32 v137, 3, v0
    s_lshl_b32 s18, s2, 3
    s_add_u32 s18, s18, s3
    s_lshl_b32 s18, s18, 11
    v_and_b32 v18, 15, v1
    v_lshrrev_b32 v19, 4, v1
    v_lshlrev_b32 v138, 11, v18
    v_lshl_add_u32 v138, v19, 4, v138
    s_lshr_b32 s30, s2, 4
    s_and_b32 s31, s2, 15
    s_lshl_b32 s19, s30, 3
    s_add_u32 s19, s19, s3
    s_lshl_b32 s22, s19, 15
    s_lshl_b32 s23, s31, 7
    s_add_u32 s22, s22, s23
    s_lshl_b32 s23, s2, 12
    s_add_u32 s23, s23, 0x600000
    s_or_b32 s25, s2, s3
    s_cmp_eq_u32 s25, 0
    s_cselect_b32 s25, 0, 0x7ffffff0
    s_waitcnt lgkmcnt(0)
    s_mov_b64 s[64:65], s[58:59]
    s_mov_b32 s66, 0x100
    s_mov_b32 s67, 0x20000
    s_or_b32 s28, s62, 1
    v_mov_b32 v134, s28
    s_mov_b64 exec, 1
    buffer_store_dword v134, v132, s[64:67], s25 offen sc1
    s_mov_b64 exec, -1
    s_mov_b64 s[68:69], s[52:53]
    s_mov_b32 s70, 0x800
    s_mov_b32 s71, 0x20000
    s_mov_b64 s[72:73], s[54:55]
    s_mov_b32 s74, 0xc00000
    s_mov_b32 s75, 0x20000
    s_mov_b64 s[76:77], s[32:33]
    s_mov_b32 s78, 0x400000
    s_mov_b32 s79, 0x20000
    s_mov_b64 s[8:9], s[60:61]
    s_mov_b32 s10, 0x3400000
    s_mov_b32 s11, 0x20000
    buffer_load_dwordx4 v[32:35], v2, s[76:79], s18 offen offset:0
    buffer_load_dwordx4 v[36:39], v2, s[76:79], s18 offen offset:1024
    buffer_load_dword v72, v136, s[68:71], s29 offen
    buffer_load_dwordx4 v[24:27], v135, s[72:75], s26 offen
    s_add_u32 s26, s26, 12288
    buffer_load_dwordx4 v[28:31], v135, s[72:75], s26 offen
    s_cmp_eq_u32 s3, 0
    s_cselect_b32 s25, 0, 0x7ffffff0
    buffer_load_dword v134, v132, s[64:67], s25 offen sc1
    buffer_store_dwordx2 v[132:133], v137, s[8:11], s23 offen sc1
    s_barrier
    buffer_load_dwordx4 v[40:43], v138, s[76:79], s22 offen offset:0
    buffer_load_dwordx4 v[44:47], v138, s[76:79], s22 offen offset:64
    s_mov_b32 s29, s19
    s_waitcnt vmcnt(8)
    v_lshlrev_b32 v56, 16, v32
    v_and_b32 v57, 0xffff0000, v32
    v_lshlrev_b32 v58, 16, v33
    v_and_b32 v59, 0xffff0000, v33
    v_lshlrev_b32 v60, 16, v34
    v_and_b32 v61, 0xffff0000, v34
    v_lshlrev_b32 v62, 16, v35
    v_and_b32 v63, 0xffff0000, v35
    s_waitcnt vmcnt(7)
    v_lshlrev_b32 v64, 16, v36
    v_and_b32 v65, 0xffff0000, v36
    v_lshlrev_b32 v66, 16, v37
    v_and_b32 v67, 0xffff0000, v37
    v_lshlrev_b32 v68, 16, v38
    v_and_b32 v69, 0xffff0000, v38
    v_lshlrev_b32 v70, 16, v39
    v_and_b32 v71, 0xffff0000, v39
    v_add_f32 v20, v56, v57
    v_add_f32 v21, v58, v59
    v_add_f32 v20, v20, v60
    v_add_f32 v21, v21, v61
    v_add_f32 v20, v20, v62
    v_add_f32 v21, v21, v63
    v_add_f32 v20, v20, v64
    v_add_f32 v21, v21, v65
    v_add_f32 v20, v20, v66
    v_add_f32 v21, v21, v67
    v_add_f32 v20, v20, v68
    v_add_f32 v21, v21, v69
    v_add_f32 v20, v20, v70
    v_add_f32 v21, v21, v71
    v_add_f32 v128, v20, v21
    s_nop 1
    v_add_f32_dpp v128, v128, v128 row_ror:1 row_mask:0xf bank_mask:0xf
    s_nop 1
    v_add_f32_dpp v128, v128, v128 row_ror:2 row_mask:0xf bank_mask:0xf
    s_nop 1
    v_add_f32_dpp v128, v128, v128 row_ror:4 row_mask:0xf bank_mask:0xf
    s_nop 1
    v_add_f32_dpp v128, v128, v128 row_ror:8 row_mask:0xf bank_mask:0xf
    v_mov_b32 v20, v128
    s_nop 1
    v_permlane16_swap_b32 v128, v20
    v_add_f32 v128, v128, v20
    v_mov_b32 v20, v128
    s_nop 1
    v_permlane32_swap_b32 v128, v20
    v_add_f32 v128, v128, v20
    v_mul_f32 v128, 0x3a800000, v128
    v_sub_f32 v18, v56, v128
    v_mul_f32 v20, v18, v18
    v_sub_f32 v19, v57, v128
    v_mul_f32 v21, v19, v19
    v_sub_f32 v18, v58, v128
    v_sub_f32 v19, v59, v128
    v_fmac_f32 v20, v18, v18
    v_fmac_f32 v21, v19, v19
    v_sub_f32 v18, v60, v128
    v_sub_f32 v19, v61, v128
    v_fmac_f32 v20, v18, v18
    v_fmac_f32 v21, v19, v19
    v_sub_f32 v18, v62, v128
    v_sub_f32 v19, v63, v128
    v_fmac_f32 v20, v18, v18
    v_fmac_f32 v21, v19, v19
    v_sub_f32 v18, v64, v128
    v_sub_f32 v19, v65, v128
    v_fmac_f32 v20, v18, v18
    v_fmac_f32 v21, v19, v19
    v_sub_f32 v18, v66, v128
    v_sub_f32 v19, v67, v128
    v_fmac_f32 v20, v18, v18
    v_fmac_f32 v21, v19, v19
    v_sub_f32 v18, v68, v128
    v_sub_f32 v19, v69, v128
    v_fmac_f32 v20, v18, v18
    v_fmac_f32 v21, v19, v19
    v_sub_f32 v18, v70, v128
    v_sub_f32 v19, v71, v128
    v_fmac_f32 v20, v18, v18
    v_fmac_f32 v21, v19, v19
    v_add_f32 v17, v20, v21
    s_nop 1
    v_add_f32_dpp v17, v17, v17 row_ror:1 row_mask:0xf bank_mask:0xf
    s_nop 1
    v_add_f32_dpp v17, v17, v17 row_ror:2 row_mask:0xf bank_mask:0xf
    s_nop 1
    v_add_f32_dpp v17, v17, v17 row_ror:4 row_mask:0xf bank_mask:0xf
    s_nop 1
    v_add_f32_dpp v17, v17, v17 row_ror:8 row_mask:0xf bank_mask:0xf
    v_mov_b32 v20, v17
    s_nop 1
    v_permlane16_swap_b32 v17, v20
    v_add_f32 v17, v17, v20
    v_mov_b32 v20, v17
    s_nop 1
    v_permlane32_swap_b32 v17, v20
    v_add_f32 v17, v17, v20
    v_mul_f32 v17, 0x3a800000, v17
    v_cvt_pk_bf16_f32 v128, v128, v128
    v_lshlrev_b32 v128, 16, v128
    v_cvt_pk_bf16_f32 v17, v17, v17
    v_lshlrev_b32 v17, 16, v17
    v_add_f32 v17, 0x3727c5ac, v17
    v_cvt_pk_bf16_f32 v17, v17, v17
    v_lshlrev_b32 v17, 16, v17
    v_sqrt_f32 v129, v17
    s_nop 0
    v_cvt_pk_bf16_f32 v129, v129, v129
    v_lshlrev_b32 v129, 16, v129
    v_rcp_f32 v130, v129
    s_lshl_b32 s16, s3, 4
    s_add_u32 s16, s16, 149520
    v_mov_b32 v19, s16
    ds_write_b128 v19, v[128:131]
    s_waitcnt vmcnt(6)
    v_and_b32 v73, 0xffff0000, v72
    v_lshlrev_b32 v72, 16, v72
    v_mul_f32 v16, 0xbfb8aa3b, v72
    v_exp_f32 v16, v16
    s_nop 0
    v_add_f32 v16, 1.0, v16
    v_rcp_f32 v16, v16
    s_nop 0
    v_mul_f32 v72, v72, v16
    v_mul_f32 v17, 0xbfb8aa3b, v73
    v_exp_f32 v17, v17
    s_nop 0
    v_add_f32 v17, 1.0, v17
    v_rcp_f32 v17, v17
    s_nop 0
    v_mul_f32 v73, v73, v17
    v_cvt_pk_bf16_f32 v16, v72, v73
    v_lshlrev_b32 v72, 16, v16
    v_and_b32 v73, 0xffff0000, v16
    s_lshl_b32 s16, s2, 8
    s_add_u32 s16, s16, 0x550000
    s_mov_b32 exec_lo, 0x01010101
    s_mov_b32 exec_hi, 0x01010101
    buffer_store_dword v16, v136, s[8:11], s16 offen sc1
    s_mov_b64 exec, -1
    v_lshrrev_b32 v74, 16, v72
    v_lshrrev_b32 v75, 16, v73
    s_waitcnt vmcnt(6)
    v_dot2_f32_bf16 v49, v24, v72, 0
    v_dot2_f32_bf16 v48, v24, v74, 0
    v_dot2_f32_bf16 v51, v25, v72, 0
    v_dot2_f32_bf16 v50, v25, v74, 0
    v_dot2_f32_bf16 v53, v26, v72, 0
    v_dot2_f32_bf16 v52, v26, v74, 0
    v_dot2_f32_bf16 v55, v27, v72, 0
    v_dot2_f32_bf16 v54, v27, v74, 0
    s_waitcnt vmcnt(5)
    v_dot2c_f32_bf16 v49, v28, v73
    v_dot2c_f32_bf16 v48, v28, v75
    v_dot2c_f32_bf16 v51, v29, v73
    v_dot2c_f32_bf16 v50, v29, v75
    v_dot2c_f32_bf16 v53, v30, v73
    v_dot2c_f32_bf16 v52, v30, v75
    v_dot2c_f32_bf16 v55, v31, v73
    v_dot2c_f32_bf16 v54, v31, v75
    s_nop 0
    v_permlane32_swap_b32 v48, v52
    v_permlane32_swap_b32 v49, v53
    v_permlane32_swap_b32 v50, v54
    v_permlane32_swap_b32 v51, v55
    v_add_f32 v48, v48, v52
    v_add_f32 v49, v49, v53
    v_add_f32 v50, v50, v54
    v_add_f32 v51, v51, v55
    s_nop 0
    v_permlane16_swap_b32 v48, v50
    v_permlane16_swap_b32 v49, v51
    v_add_f32 v48, v48, v50
    v_add_f32 v49, v49, v51
    s_nop 0
    v_add_f32_dpp v48, v48, v48 row_ror:8 row_mask:0xf bank_mask:0xf
    v_add_f32_dpp v49, v49, v49 row_ror:8 row_mask:0xf bank_mask:0xf
    v_and_b32 v16, 7, v1
    v_lshlrev_b32 v16, 5, v16
    v_lshrrev_b32 v17, 4, v1
    v_lshl_add_u32 v16, v17, 3, v16
    s_lshl_b32 s16, s3, 8
    s_add_u32 s16, s16, 147456
    v_add_u32 v16, s16, v16
    ds_write_b64 v16, v[48:49]
    s_waitcnt vmcnt(4)
    v_cmp_eq_u32 vcc, 0, v134
    s_cmp_eq_u32 s3, 0
    s_cselect_b64 s[62:63], -1, 0
    s_and_b64 vcc, vcc, s[62:63]
    s_cbranch_vccnz adaLN_cond__sliding_block_cached__moe_arch_mod__prompt_kernel_n1r
adaLN_cond__sliding_block_cached__moe_arch_mod__prompt_kernel_n1b:
    v_mov_b32 v19, 149504
    s_cmp_eq_u32 s3, 0
    s_cselect_b64 exec, 1, 0
    ds_write_b32 v19, v134
    s_mov_b64 exec, -1
    v_mov_b32 v19, 149504
    v_and_b32 v17, 31, v1
    v_lshlrev_b32 v18, 3, v17
    v_add_u32 v18, 147456, v18
    v_lshlrev_b32 v17, 4, v17
    s_waitcnt lgkmcnt(0)
    s_barrier
    ds_read_b32 v134, v19
    ds_read_b64 v[96:97], v18 offset:0
    ds_read_b64 v[100:101], v18 offset:256
    ds_read_b64 v[104:105], v18 offset:512
    ds_read_b64 v[108:109], v18 offset:768
    ds_read_b64 v[112:113], v18 offset:1024
    ds_read_b64 v[116:117], v18 offset:1280
    ds_read_b64 v[120:121], v18 offset:1536
    ds_read_b64 v[124:125], v18 offset:1792
    s_waitcnt lgkmcnt(8)
    v_readfirstlane_b32 s28, v134
    v_and_b32 v20, 7, v1
    v_lshlrev_b32 v20, 4, v20
    v_add_u32 v21, 149520, v20
    ds_read_b128 v[128:131], v21
    s_waitcnt lgkmcnt(0)
    v_mov_b32 v131, s28
    s_lshl_b32 s16, s2, 7
    s_add_u32 s16, s16, 0x520000
    s_cmp_eq_u32 s3, 0
    s_cselect_b32 s16, s16, 0x7ffffff0
    s_mov_b64 exec, 0xff
    buffer_store_dwordx4 v[128:131], v20, s[8:11], s16 offen sc1
    s_mov_b64 exec, -1
    v_pk_add_f32 v[96:97], v[96:97], v[112:113]
    v_pk_add_f32 v[100:101], v[100:101], v[116:117]
    v_pk_add_f32 v[104:105], v[104:105], v[120:121]
    v_pk_add_f32 v[108:109], v[108:109], v[124:125]
    v_pk_add_f32 v[96:97], v[96:97], v[104:105]
    v_pk_add_f32 v[100:101], v[100:101], v[108:109]
    v_pk_add_f32 v[96:97], v[96:97], v[100:101]
    v_mov_b32 v98, s28
    v_mov_b32 v99, s28
    s_lshl_b32 s16, s14, 3
    s_add_u32 s16, s16, s15
    s_lshl_b32 s16, s16, 9
    s_add_u32 s16, s16, 0x500000
    s_cmp_eq_u32 s3, 0
    s_cselect_b32 s16, s16, 0x7ffffff0
    s_mov_b64 exec, 0xffffffff
    buffer_store_dwordx4 v[96:99], v17, s[8:11], s16 offen sc1
    s_mov_b64 exec, -1
    s_lshr_b32 s16, s3, 2
    s_lshl_b32 s16, s16, 4
    s_add_u32 s16, s16, s31
    s_lshl_b32 s16, s16, 12
    s_and_b32 s17, s3, 3
    s_lshl_b32 s17, s17, 7
    s_add_u32 s16, s16, s17
    s_add_u32 s16, s16, 0x500000
    v_lshrrev_b32 v139, 3, v1
    v_lshlrev_b32 v139, 9, v139
    v_and_b32 v16, 7, v1
    v_lshl_add_u32 v139, v16, 4, v139
    v_and_b32 v140, 15, v1
    v_lshlrev_b32 v140, 4, v140
    s_lshl_b32 s17, s29, 8
    s_add_u32 s17, s17, 0x520000
    s_waitcnt vmcnt(4)
    v_lshlrev_b32 v56, 16, v40
    v_and_b32 v57, 0xffff0000, v40
    v_lshlrev_b32 v58, 16, v41
    v_and_b32 v59, 0xffff0000, v41
    v_lshlrev_b32 v60, 16, v42
    v_and_b32 v61, 0xffff0000, v42
    v_lshlrev_b32 v62, 16, v43
    v_and_b32 v63, 0xffff0000, v43
    s_waitcnt vmcnt(3)
    v_lshlrev_b32 v64, 16, v44
    v_and_b32 v65, 0xffff0000, v44
    v_lshlrev_b32 v66, 16, v45
    v_and_b32 v67, 0xffff0000, v45
    v_lshlrev_b32 v68, 16, v46
    v_and_b32 v69, 0xffff0000, v46
    v_lshlrev_b32 v70, 16, v47
    v_and_b32 v71, 0xffff0000, v47
    s_mov_b32 s27, 0
adaLN_cond__sliding_block_cached__moe_arch_mod__prompt_kernel_g2p:
    buffer_load_dwordx4 v[76:79], v139, s[8:11], s16 offen sc1
    buffer_load_dwordx4 v[80:83], v140, s[8:11], s17 offen sc1
    s_waitcnt vmcnt(1)
    v_cmp_ne_u32 vcc, s28, v78
    v_cmp_ne_u32 s[62:63], s28, v79
    s_or_b64 vcc, vcc, s[62:63]
    s_waitcnt vmcnt(0)
    v_cmp_ne_u32 s[62:63], s28, v83
    s_or_b64 vcc, vcc, s[62:63]
    s_add_u32 s27, s27, 1
    s_cmp_ge_u32 s27, 65536
    s_cbranch_scc1 adaLN_cond__sliding_block_cached__moe_arch_mod__prompt_kernel_g2g
    s_cbranch_vccnz adaLN_cond__sliding_block_cached__moe_arch_mod__prompt_kernel_g2p
adaLN_cond__sliding_block_cached__moe_arch_mod__prompt_kernel_g2g:
    v_add_f32_dpp v76, v76, v76 row_ror:8 row_mask:0xf bank_mask:0xf
    v_add_f32_dpp v77, v77, v77 row_ror:8 row_mask:0xf bank_mask:0xf
    v_mov_b32 v17, v76
    s_nop 1
    v_permlane16_swap_b32 v76, v17
    v_add_f32 v76, v76, v17
    v_mov_b32 v18, v77
    s_nop 1
    v_permlane16_swap_b32 v77, v18
    v_add_f32 v77, v77, v18
    v_mov_b32 v17, v76
    s_nop 1
    v_permlane32_swap_b32 v76, v17
    v_add_f32 v76, v76, v17
    v_mov_b32 v18, v77
    s_nop 1
    v_permlane32_swap_b32 v77, v18
    v_add_f32 v77, v77, v18
    v_cvt_pk_bf16_f32 v17, v76, v77
    v_lshlrev_b32 v76, 16, v17
    v_and_b32 v77, 0xffff0000, v17
    v_add_f32 v76, 0, v76
    v_add_f32 v77, 0, v77
    s_lshl_b32 s16, s3, 6
    s_add_u32 s16, s16, 151552
    v_lshl_add_u32 v16, v16, 3, s16
    ds_write_b64 v16, v[76:77]
    v_lshrrev_b32 v17, 4, v1
    v_lshlrev_b32 v17, 5, v17
    v_add_u32 v17, 151552, v17
    v_sub_f32 v56, v56, v80
    v_sub_f32 v57, v57, v80
    v_sub_f32 v58, v58, v80
    v_sub_f32 v59, v59, v80
    v_sub_f32 v60, v60, v80
    v_sub_f32 v61, v61, v80
    v_sub_f32 v62, v62, v80
    v_sub_f32 v63, v63, v80
    v_sub_f32 v64, v64, v80
    v_sub_f32 v65, v65, v80
    v_sub_f32 v66, v66, v80
    v_sub_f32 v67, v67, v80
    v_sub_f32 v68, v68, v80
    v_sub_f32 v69, v69, v80
    v_sub_f32 v70, v70, v80
    v_sub_f32 v71, v71, v80
    v_cvt_pk_bf16_f32 v18, v56, v57
    v_lshlrev_b32 v56, 16, v18
    v_and_b32 v57, 0xffff0000, v18
    v_cvt_pk_bf16_f32 v19, v58, v59
    v_lshlrev_b32 v58, 16, v19
    v_and_b32 v59, 0xffff0000, v19
    v_cvt_pk_bf16_f32 v18, v60, v61
    v_lshlrev_b32 v60, 16, v18
    v_and_b32 v61, 0xffff0000, v18
    v_cvt_pk_bf16_f32 v19, v62, v63
    v_lshlrev_b32 v62, 16, v19
    v_and_b32 v63, 0xffff0000, v19
    v_cvt_pk_bf16_f32 v18, v64, v65
    v_lshlrev_b32 v64, 16, v18
    v_and_b32 v65, 0xffff0000, v18
    v_cvt_pk_bf16_f32 v19, v66, v67
    v_lshlrev_b32 v66, 16, v19
    v_and_b32 v67, 0xffff0000, v19
    v_cvt_pk_bf16_f32 v18, v68, v69
    v_lshlrev_b32 v68, 16, v18
    v_and_b32 v69, 0xffff0000, v18
    v_cvt_pk_bf16_f32 v19, v70, v71
    v_lshlrev_b32 v70, 16, v19
    v_and_b32 v71, 0xffff0000, v19
    v_mul_f32 v56, v56, v82
    v_mul_f32 v57, v57, v82
    v_mul_f32 v58, v58, v82
    v_mul_f32 v59, v59, v82
    v_mul_f32 v60, v60, v82
    v_mul_f32 v61, v61, v82
    v_mul_f32 v62, v62, v82
    v_mul_f32 v63, v63, v82
    v_mul_f32 v64, v64, v82
    v_mul_f32 v65, v65, v82
    v_mul_f32 v66, v66, v82
    v_mul_f32 v67, v67, v82
    v_mul_f32 v68, v68, v82
    v_mul_f32 v69, v69, v82
    v_mul_f32 v70, v70, v82
    v_mul_f32 v71, v71, v82
    v_cvt_pk_bf16_f32 v18, v56, v57
    v_lshlrev_b32 v56, 16, v18
    v_and_b32 v57, 0xffff0000, v18
    v_cvt_pk_bf16_f32 v19, v58, v59
    v_lshlrev_b32 v58, 16, v19
    v_and_b32 v59, 0xffff0000, v19
    v_cvt_pk_bf16_f32 v18, v60, v61
    v_lshlrev_b32 v60, 16, v18
    v_and_b32 v61, 0xffff0000, v18
    v_cvt_pk_bf16_f32 v19, v62, v63
    v_lshlrev_b32 v62, 16, v19
    v_and_b32 v63, 0xffff0000, v19
    v_cvt_pk_bf16_f32 v18, v64, v65
    v_lshlrev_b32 v64, 16, v18
    v_and_b32 v65, 0xffff0000, v18
    v_cvt_pk_bf16_f32 v19, v66, v67
    v_lshlrev_b32 v66, 16, v19
    v_and_b32 v67, 0xffff0000, v19
    v_cvt_pk_bf16_f32 v18, v68, v69
    v_lshlrev_b32 v68, 16, v18
    v_and_b32 v69, 0xffff0000, v18
    v_cvt_pk_bf16_f32 v19, v70, v71
    v_lshlrev_b32 v70, 16, v19
    v_and_b32 v71, 0xffff0000, v19
    s_lshl_b32 s16, s29, 15
    s_lshl_b32 s17, s31, 11
    s_add_u32 s16, s16, s17
    s_waitcnt lgkmcnt(0)
    s_barrier
    ds_read_b128 v[96:99], v17 offset:256
    ds_read_b128 v[104:107], v17 offset:0
    ds_read_b128 v[100:103], v17 offset:272
    ds_read_b128 v[108:111], v17 offset:16
    ds_read_b128 v[112:115], v17 offset:384
    ds_read_b128 v[120:123], v17 offset:128
    ds_read_b128 v[116:119], v17 offset:400
    ds_read_b128 v[124:127], v17 offset:144
    s_waitcnt lgkmcnt(7)
    v_pk_mul_f32 v[56:57], v[56:57], v[96:97]
    v_pk_mul_f32 v[58:59], v[58:59], v[98:99]
    s_waitcnt lgkmcnt(5)
    v_pk_mul_f32 v[60:61], v[60:61], v[100:101]
    v_pk_mul_f32 v[62:63], v[62:63], v[102:103]
    v_cvt_pk_bf16_f32 v18, v56, v57
    v_lshlrev_b32 v56, 16, v18
    v_and_b32 v57, 0xffff0000, v18
    v_cvt_pk_bf16_f32 v19, v58, v59
    v_lshlrev_b32 v58, 16, v19
    v_and_b32 v59, 0xffff0000, v19
    v_cvt_pk_bf16_f32 v18, v60, v61
    v_lshlrev_b32 v60, 16, v18
    v_and_b32 v61, 0xffff0000, v18
    v_cvt_pk_bf16_f32 v19, v62, v63
    v_lshlrev_b32 v62, 16, v19
    v_and_b32 v63, 0xffff0000, v19
    v_pk_add_f32 v[56:57], v[56:57], v[104:105]
    v_pk_add_f32 v[58:59], v[58:59], v[106:107]
    s_waitcnt lgkmcnt(4)
    v_pk_add_f32 v[60:61], v[60:61], v[108:109]
    v_pk_add_f32 v[62:63], v[62:63], v[110:111]
    v_cvt_pk_bf16_f32 v32, v56, v57
    v_cvt_pk_bf16_f32 v33, v58, v59
    v_cvt_pk_bf16_f32 v34, v60, v61
    v_cvt_pk_bf16_f32 v35, v62, v63
    buffer_store_dwordx4 v[32:35], v2, s[8:11], s16 offen offset:0 sc1
    s_waitcnt lgkmcnt(3)
    v_pk_mul_f32 v[64:65], v[64:65], v[112:113]
    v_pk_mul_f32 v[66:67], v[66:67], v[114:115]
    s_waitcnt lgkmcnt(1)
    v_pk_mul_f32 v[68:69], v[68:69], v[116:117]
    v_pk_mul_f32 v[70:71], v[70:71], v[118:119]
    v_cvt_pk_bf16_f32 v18, v64, v65
    v_lshlrev_b32 v64, 16, v18
    v_and_b32 v65, 0xffff0000, v18
    v_cvt_pk_bf16_f32 v19, v66, v67
    v_lshlrev_b32 v66, 16, v19
    v_and_b32 v67, 0xffff0000, v19
    v_cvt_pk_bf16_f32 v18, v68, v69
    v_lshlrev_b32 v68, 16, v18
    v_and_b32 v69, 0xffff0000, v18
    v_cvt_pk_bf16_f32 v19, v70, v71
    v_lshlrev_b32 v70, 16, v19
    v_and_b32 v71, 0xffff0000, v19
    v_pk_add_f32 v[64:65], v[64:65], v[120:121]
    v_pk_add_f32 v[66:67], v[66:67], v[122:123]
    s_waitcnt lgkmcnt(0)
    v_pk_add_f32 v[68:69], v[68:69], v[124:125]
    v_pk_add_f32 v[70:71], v[70:71], v[126:127]
    v_cvt_pk_bf16_f32 v36, v64, v65
    v_cvt_pk_bf16_f32 v37, v66, v67
    v_cvt_pk_bf16_f32 v38, v68, v69
    v_cvt_pk_bf16_f32 v39, v70, v71
    buffer_store_dwordx4 v[36:39], v2, s[8:11], s16 offen offset:1024 sc1
    s_lshl_b32 s19, s3, 16
    s_lshl_b32 s20, s3, 11
    s_lshl_b32 s16, s12, 8
    s_add_u32 s4, s38, s16
    s_addc_u32 s5, s39, 0
    s_sub_u32 s6, 0x800000, s16
    s_mov_b32 s7, 0x20000
    s_barrier
    s_add_u32 s22, s19, 0x0
    s_add_u32 m0, s20, 0x0
    s_nop 0
    buffer_load_dwordx4 v3, s[4:7], s22 offen lds
    s_add_u32 s22, s19, 0x8000
    s_add_u32 m0, s20, 0x400
    s_nop 0
    buffer_load_dwordx4 v3, s[4:7], s22 offen lds
    s_add_u32 s22, s19, 0x80000
    s_add_u32 m0, s20, 0x4000
    s_nop 0
    buffer_load_dwordx4 v3, s[4:7], s22 offen lds
    s_add_u32 s22, s19, 0x88000
    s_add_u32 m0, s20, 0x4400
    s_nop 0
    buffer_load_dwordx4 v3, s[4:7], s22 offen lds
    s_add_u32 s22, s19, 0x100000
    s_add_u32 m0, s20, 0x8000
    s_nop 0
    buffer_load_dwordx4 v3, s[4:7], s22 offen lds
    s_add_u32 s22, s19, 0x108000
    s_add_u32 m0, s20, 0x8400
    s_nop 0
    buffer_load_dwordx4 v3, s[4:7], s22 offen lds
    v_mov_b32 v134, s28
    s_lshl_b32 s16, s29, 4
    s_add_u32 s16, s16, s31
    s_lshl_b32 s16, s16, 2
    s_add_u32 s16, s16, 0x528000
    v_and_b32 v16, 31, v1
    v_lshlrev_b32 v16, 2, v16
    s_lshl_b32 s17, s13, 3
    s_add_u32 s17, s17, s3
    s_lshl_b32 s17, s17, 7
    s_add_u32 s17, s17, 0x528000
    s_waitcnt vmcnt(6)
    s_mov_b64 exec, 1
    buffer_store_dword v134, v132, s[8:11], s16 offen sc1
    s_mov_b64 exec, -1
    s_waitcnt vmcnt(0)
    s_mov_b32 s27, 0
adaLN_cond__sliding_block_cached__moe_arch_mod__prompt_kernel_h3p:
    buffer_load_dword v17, v16, s[8:11], s17 offen sc1
    s_waitcnt vmcnt(0)
    v_cmp_ne_u32 vcc, s28, v17
    s_add_u32 s27, s27, 1
    s_cmp_ge_u32 s27, 65536
    s_cbranch_scc1 adaLN_cond__sliding_block_cached__moe_arch_mod__prompt_kernel_h3g
    s_cbranch_vccnz adaLN_cond__sliding_block_cached__moe_arch_mod__prompt_kernel_h3p
adaLN_cond__sliding_block_cached__moe_arch_mod__prompt_kernel_h3g:
    s_mov_b32 s23, 0x0
    buffer_load_dwordx4 v[88:91], v7, s[8:11], s23 offen offset:0 sc1
    s_mov_b32 s23, 0x8000
    buffer_load_dwordx4 v[92:95], v7, s[8:11], s23 offen offset:0 sc1
    s_mov_b32 s23, 0x0
    buffer_load_dwordx4 v[96:99], v7, s[8:11], s23 offen offset:1024 sc1
    s_mov_b32 s23, 0x8000
    buffer_load_dwordx4 v[100:103], v7, s[8:11], s23 offen offset:1024 sc1
    s_mov_b32 s23, 0x800
    buffer_load_dwordx4 v[104:107], v7, s[8:11], s23 offen offset:0 sc1
    s_mov_b32 s23, 0x8800
    buffer_load_dwordx4 v[108:111], v7, s[8:11], s23 offen offset:0 sc1
    s_mov_b32 s23, 0x800
    buffer_load_dwordx4 v[112:115], v7, s[8:11], s23 offen offset:1024 sc1
    s_mov_b32 s23, 0x8800
    buffer_load_dwordx4 v[116:119], v7, s[8:11], s23 offen offset:1024 sc1
    s_mov_b32 s23, 0x1000
    buffer_load_dwordx4 v[120:123], v7, s[8:11], s23 offen offset:0 sc1
    s_mov_b32 s23, 0x9000
    buffer_load_dwordx4 v[124:127], v7, s[8:11], s23 offen offset:0 sc1
    s_mov_b32 s23, 0x1000
    buffer_load_dwordx4 v[128:131], v7, s[8:11], s23 offen offset:1024 sc1
    s_mov_b32 s23, 0x9000
    buffer_load_dwordx4 v[132:135], v7, s[8:11], s23 offen offset:1024 sc1
    s_lshr_b32 s21, s12, 3
    s_lshl_b32 s21, s21, 17
    s_add_u32 s21, s21, s20
    s_add_u32 s21, s21, 0x400000
    s_barrier
    ds_read_b64_tr_b16 v[224:225], v4 offset:0
    ds_read_b64_tr_b16 v[226:227], v4 offset:1024
    ds_read_b64_tr_b16 v[228:229], v5 offset:32
    ds_read_b64_tr_b16 v[230:231], v5 offset:1056
    ds_read_b64_tr_b16 v[232:233], v4 offset:256
    ds_read_b64_tr_b16 v[234:235], v4 offset:1280
    s_waitcnt vmcnt(11) lgkmcnt(4)
    v_mfma_f32_16x16x32_bf16 v[24:27], v[224:227], v[88:91], 0
    ds_read_b64_tr_b16 v[236:237], v5 offset:288
    s_waitcnt vmcnt(10)
    v_mfma_f32_16x16x32_bf16 v[28:31], v[224:227], v[92:95], 0
    ds_read_b64_tr_b16 v[238:239], v5 offset:1312
    s_waitcnt lgkmcnt(4)
    v_mfma_f32_16x16x32_bf16 v[32:35], v[228:231], v[88:91], 0
    ds_read_b64_tr_b16 v[240:241], v4 offset:512
    v_mfma_f32_16x16x32_bf16 v[36:39], v[228:231], v[92:95], 0
    ds_read_b64_tr_b16 v[242:243], v4 offset:1536
    s_mov_b32 s23, 0x1800
    buffer_load_dwordx4 v[136:139], v7, s[8:11], s23 offen offset:0 sc1
    s_waitcnt lgkmcnt(4)
    v_mfma_f32_16x16x32_bf16 v[40:43], v[232:235], v[88:91], 0
    ds_read_b64_tr_b16 v[244:245], v5 offset:544
    v_mfma_f32_16x16x32_bf16 v[44:47], v[232:235], v[92:95], 0
    ds_read_b64_tr_b16 v[246:247], v5 offset:1568
    s_waitcnt lgkmcnt(4)
    v_mfma_f32_16x16x32_bf16 v[48:51], v[236:239], v[88:91], 0
    ds_read_b64_tr_b16 v[224:225], v4 offset:768
    v_mfma_f32_16x16x32_bf16 v[52:55], v[236:239], v[92:95], 0
    ds_read_b64_tr_b16 v[226:227], v4 offset:1792
    s_waitcnt lgkmcnt(4)
    v_mfma_f32_16x16x32_bf16 v[56:59], v[240:243], v[88:91], 0
    ds_read_b64_tr_b16 v[228:229], v5 offset:800
    v_mfma_f32_16x16x32_bf16 v[60:63], v[240:243], v[92:95], 0
    ds_read_b64_tr_b16 v[230:231], v5 offset:1824
    s_waitcnt lgkmcnt(4)
    v_mfma_f32_16x16x32_bf16 v[64:67], v[244:247], v[88:91], 0
    ds_read_b64_tr_b16 v[232:233], v4 offset:8192
    v_mfma_f32_16x16x32_bf16 v[68:71], v[244:247], v[92:95], 0
    ds_read_b64_tr_b16 v[234:235], v4 offset:9216
    s_mov_b32 s23, 0x9800
    buffer_load_dwordx4 v[140:143], v7, s[8:11], s23 offen offset:0 sc1
    s_waitcnt lgkmcnt(4)
    v_mfma_f32_16x16x32_bf16 v[72:75], v[224:227], v[88:91], 0
    ds_read_b64_tr_b16 v[236:237], v5 offset:8224
    v_mfma_f32_16x16x32_bf16 v[76:79], v[224:227], v[92:95], 0
    ds_read_b64_tr_b16 v[238:239], v5 offset:9248
    s_waitcnt lgkmcnt(4)
    v_mfma_f32_16x16x32_bf16 v[80:83], v[228:231], v[88:91], 0
    ds_read_b64_tr_b16 v[240:241], v4 offset:8448
    v_mfma_f32_16x16x32_bf16 v[84:87], v[228:231], v[92:95], 0
    ds_read_b64_tr_b16 v[242:243], v4 offset:9472
    s_waitcnt vmcnt(11) lgkmcnt(4)
    v_mfma_f32_16x16x32_bf16 v[24:27], v[232:235], v[96:99], v[24:27]
    ds_read_b64_tr_b16 v[244:245], v5 offset:8480
    s_waitcnt vmcnt(10)
    v_mfma_f32_16x16x32_bf16 v[28:31], v[232:235], v[100:103], v[28:31]
    ds_read_b64_tr_b16 v[246:247], v5 offset:9504
    s_waitcnt lgkmcnt(4)
    v_mfma_f32_16x16x32_bf16 v[32:35], v[236:239], v[96:99], v[32:35]
    ds_read_b64_tr_b16 v[224:225], v4 offset:8704
    v_mfma_f32_16x16x32_bf16 v[36:39], v[236:239], v[100:103], v[36:39]
    ds_read_b64_tr_b16 v[226:227], v4 offset:9728
    s_mov_b32 s23, 0x1800
    buffer_load_dwordx4 v[144:147], v7, s[8:11], s23 offen offset:1024 sc1
    s_waitcnt lgkmcnt(4)
    v_mfma_f32_16x16x32_bf16 v[40:43], v[240:243], v[96:99], v[40:43]
    ds_read_b64_tr_b16 v[228:229], v5 offset:8736
    v_mfma_f32_16x16x32_bf16 v[44:47], v[240:243], v[100:103], v[44:47]
    ds_read_b64_tr_b16 v[230:231], v5 offset:9760
    s_waitcnt lgkmcnt(4)
    v_mfma_f32_16x16x32_bf16 v[48:51], v[244:247], v[96:99], v[48:51]
    ds_read_b64_tr_b16 v[232:233], v4 offset:8960
    v_mfma_f32_16x16x32_bf16 v[52:55], v[244:247], v[100:103], v[52:55]
    ds_read_b64_tr_b16 v[234:235], v4 offset:9984
    s_waitcnt lgkmcnt(4)
    v_mfma_f32_16x16x32_bf16 v[56:59], v[224:227], v[96:99], v[56:59]
    ds_read_b64_tr_b16 v[236:237], v5 offset:8992
    v_mfma_f32_16x16x32_bf16 v[60:63], v[224:227], v[100:103], v[60:63]
    ds_read_b64_tr_b16 v[238:239], v5 offset:10016
    s_waitcnt lgkmcnt(4)
    v_mfma_f32_16x16x32_bf16 v[64:67], v[228:231], v[96:99], v[64:67]
    v_mfma_f32_16x16x32_bf16 v[68:71], v[228:231], v[100:103], v[68:71]
    s_barrier
    ds_read_b64_tr_b16 v[240:241], v4 offset:16384
    ds_read_b64_tr_b16 v[242:243], v4 offset:17408
    s_mov_b32 s23, 0x9800
    buffer_load_dwordx4 v[148:151], v7, s[8:11], s23 offen offset:1024 sc1
    s_waitcnt lgkmcnt(4)
    v_mfma_f32_16x16x32_bf16 v[72:75], v[232:235], v[96:99], v[72:75]
    ds_read_b64_tr_b16 v[244:245], v5 offset:16416
    v_mfma_f32_16x16x32_bf16 v[76:79], v[232:235], v[100:103], v[76:79]
    s_add_u32 s22, s19, 0x180000
    s_add_u32 m0, s20, 0xc000
    s_nop 0
    buffer_load_dwordx4 v3, s[4:7], s22 offen lds
    ds_read_b64_tr_b16 v[246:247], v5 offset:17440
    s_waitcnt lgkmcnt(4)
    v_mfma_f32_16x16x32_bf16 v[80:83], v[236:239], v[96:99], v[80:83]
    ds_read_b64_tr_b16 v[224:225], v4 offset:16640
    v_mfma_f32_16x16x32_bf16 v[84:87], v[236:239], v[100:103], v[84:87]
    ds_read_b64_tr_b16 v[226:227], v4 offset:17664
    s_waitcnt vmcnt(12) lgkmcnt(4)
    v_mfma_f32_16x16x32_bf16 v[24:27], v[240:243], v[104:107], v[24:27]
    ds_read_b64_tr_b16 v[228:229], v5 offset:16672
    s_waitcnt vmcnt(11)
    v_mfma_f32_16x16x32_bf16 v[28:31], v[240:243], v[108:111], v[28:31]
    ds_read_b64_tr_b16 v[230:231], v5 offset:17696
    s_waitcnt lgkmcnt(4)
    v_mfma_f32_16x16x32_bf16 v[32:35], v[244:247], v[104:107], v[32:35]
    ds_read_b64_tr_b16 v[232:233], v4 offset:16896
    v_mfma_f32_16x16x32_bf16 v[36:39], v[244:247], v[108:111], v[36:39]
    ds_read_b64_tr_b16 v[234:235], v4 offset:17920
    s_mov_b32 s23, 0x2000
    buffer_load_dwordx4 v[88:91], v7, s[8:11], s23 offen offset:0 sc1
    s_waitcnt lgkmcnt(4)
    v_mfma_f32_16x16x32_bf16 v[40:43], v[224:227], v[104:107], v[40:43]
    ds_read_b64_tr_b16 v[236:237], v5 offset:16928
    v_mfma_f32_16x16x32_bf16 v[44:47], v[224:227], v[108:111], v[44:47]
    s_add_u32 s22, s19, 0x188000
    s_add_u32 m0, s20, 0xc400
    s_nop 0
    buffer_load_dwordx4 v3, s[4:7], s22 offen lds
    ds_read_b64_tr_b16 v[238:239], v5 offset:17952
    s_waitcnt lgkmcnt(4)
    v_mfma_f32_16x16x32_bf16 v[48:51], v[228:231], v[104:107], v[48:51]
    ds_read_b64_tr_b16 v[240:241], v4 offset:17152
    v_mfma_f32_16x16x32_bf16 v[52:55], v[228:231], v[108:111], v[52:55]
    ds_read_b64_tr_b16 v[242:243], v4 offset:18176
    s_waitcnt lgkmcnt(4)
    v_mfma_f32_16x16x32_bf16 v[56:59], v[232:235], v[104:107], v[56:59]
    ds_read_b64_tr_b16 v[244:245], v5 offset:17184
    v_mfma_f32_16x16x32_bf16 v[60:63], v[232:235], v[108:111], v[60:63]
    ds_read_b64_tr_b16 v[246:247], v5 offset:18208
    s_waitcnt lgkmcnt(4)
    v_mfma_f32_16x16x32_bf16 v[64:67], v[236:239], v[104:107], v[64:67]
    ds_read_b64_tr_b16 v[224:225], v4 offset:24576
    v_mfma_f32_16x16x32_bf16 v[68:71], v[236:239], v[108:111], v[68:71]
    ds_read_b64_tr_b16 v[226:227], v4 offset:25600
    s_mov_b32 s23, 0xa000
    buffer_load_dwordx4 v[92:95], v7, s[8:11], s23 offen offset:0 sc1
    s_waitcnt lgkmcnt(4)
    v_mfma_f32_16x16x32_bf16 v[72:75], v[240:243], v[104:107], v[72:75]
    ds_read_b64_tr_b16 v[228:229], v5 offset:24608
    v_mfma_f32_16x16x32_bf16 v[76:79], v[240:243], v[108:111], v[76:79]
    ds_read_b64_tr_b16 v[230:231], v5 offset:25632
    s_waitcnt lgkmcnt(4)
    v_mfma_f32_16x16x32_bf16 v[80:83], v[244:247], v[104:107], v[80:83]
    ds_read_b64_tr_b16 v[232:233], v4 offset:24832
    v_mfma_f32_16x16x32_bf16 v[84:87], v[244:247], v[108:111], v[84:87]
    ds_read_b64_tr_b16 v[234:235], v4 offset:25856
    s_waitcnt vmcnt(13) lgkmcnt(4)
    v_mfma_f32_16x16x32_bf16 v[24:27], v[224:227], v[112:115], v[24:27]
    ds_read_b64_tr_b16 v[236:237], v5 offset:24864
    s_waitcnt vmcnt(12)
    v_mfma_f32_16x16x32_bf16 v[28:31], v[224:227], v[116:119], v[28:31]
    ds_read_b64_tr_b16 v[238:239], v5 offset:25888
    s_waitcnt lgkmcnt(4)
    v_mfma_f32_16x16x32_bf16 v[32:35], v[228:231], v[112:115], v[32:35]
    ds_read_b64_tr_b16 v[240:241], v4 offset:25088
    v_mfma_f32_16x16x32_bf16 v[36:39], v[228:231], v[116:119], v[36:39]
    ds_read_b64_tr_b16 v[242:243], v4 offset:26112
    s_mov_b32 s23, 0x2000
    buffer_load_dwordx4 v[96:99], v7, s[8:11], s23 offen offset:1024 sc1
    s_waitcnt lgkmcnt(4)
    v_mfma_f32_16x16x32_bf16 v[40:43], v[232:235], v[112:115], v[40:43]
    ds_read_b64_tr_b16 v[244:245], v5 offset:25120
    v_mfma_f32_16x16x32_bf16 v[44:47], v[232:235], v[116:119], v[44:47]
    ds_read_b64_tr_b16 v[246:247], v5 offset:26144
    s_waitcnt lgkmcnt(4)
    v_mfma_f32_16x16x32_bf16 v[48:51], v[236:239], v[112:115], v[48:51]
    ds_read_b64_tr_b16 v[224:225], v4 offset:25344
    v_mfma_f32_16x16x32_bf16 v[52:55], v[236:239], v[116:119], v[52:55]
    ds_read_b64_tr_b16 v[226:227], v4 offset:26368
    s_waitcnt lgkmcnt(4)
    v_mfma_f32_16x16x32_bf16 v[56:59], v[240:243], v[112:115], v[56:59]
    ds_read_b64_tr_b16 v[228:229], v5 offset:25376
    v_mfma_f32_16x16x32_bf16 v[60:63], v[240:243], v[116:119], v[60:63]
    ds_read_b64_tr_b16 v[230:231], v5 offset:26400
    s_waitcnt lgkmcnt(4)
    v_mfma_f32_16x16x32_bf16 v[64:67], v[244:247], v[112:115], v[64:67]
    v_mfma_f32_16x16x32_bf16 v[68:71], v[244:247], v[116:119], v[68:71]
    s_barrier
    ds_read_b64_tr_b16 v[232:233], v4 offset:32768
    ds_read_b64_tr_b16 v[234:235], v4 offset:33792
    s_mov_b32 s23, 0xa000
    buffer_load_dwordx4 v[100:103], v7, s[8:11], s23 offen offset:1024 sc1
    s_waitcnt lgkmcnt(4)
    v_mfma_f32_16x16x32_bf16 v[72:75], v[224:227], v[112:115], v[72:75]
    ds_read_b64_tr_b16 v[236:237], v5 offset:32800
    v_mfma_f32_16x16x32_bf16 v[76:79], v[224:227], v[116:119], v[76:79]
    s_add_u32 s22, s19, 0x200000
    s_add_u32 m0, s20, 0x0
    s_nop 0
    buffer_load_dwordx4 v3, s[4:7], s22 offen lds
    ds_read_b64_tr_b16 v[238:239], v5 offset:33824
    s_waitcnt lgkmcnt(4)
    v_mfma_f32_16x16x32_bf16 v[80:83], v[228:231], v[112:115], v[80:83]
    ds_read_b64_tr_b16 v[240:241], v4 offset:33024
    v_mfma_f32_16x16x32_bf16 v[84:87], v[228:231], v[116:119], v[84:87]
    ds_read_b64_tr_b16 v[242:243], v4 offset:34048
    s_waitcnt vmcnt(14) lgkmcnt(4)
    v_mfma_f32_16x16x32_bf16 v[24:27], v[232:235], v[120:123], v[24:27]
    ds_read_b64_tr_b16 v[244:245], v5 offset:33056
    s_waitcnt vmcnt(13)
    v_mfma_f32_16x16x32_bf16 v[28:31], v[232:235], v[124:127], v[28:31]
    ds_read_b64_tr_b16 v[246:247], v5 offset:34080
    s_waitcnt lgkmcnt(4)
    v_mfma_f32_16x16x32_bf16 v[32:35], v[236:239], v[120:123], v[32:35]
    ds_read_b64_tr_b16 v[224:225], v4 offset:33280
    v_mfma_f32_16x16x32_bf16 v[36:39], v[236:239], v[124:127], v[36:39]
    ds_read_b64_tr_b16 v[226:227], v4 offset:34304
    s_mov_b32 s23, 0x2800
    buffer_load_dwordx4 v[104:107], v7, s[8:11], s23 offen offset:0 sc1
    s_waitcnt lgkmcnt(4)
    v_mfma_f32_16x16x32_bf16 v[40:43], v[240:243], v[120:123], v[40:43]
    ds_read_b64_tr_b16 v[228:229], v5 offset:33312
    v_mfma_f32_16x16x32_bf16 v[44:47], v[240:243], v[124:127], v[44:47]
    s_add_u32 s22, s19, 0x208000
    s_add_u32 m0, s20, 0x400
    s_nop 0
    buffer_load_dwordx4 v3, s[4:7], s22 offen lds
    ds_read_b64_tr_b16 v[230:231], v5 offset:34336
    s_waitcnt lgkmcnt(4)
    v_mfma_f32_16x16x32_bf16 v[48:51], v[244:247], v[120:123], v[48:51]
    ds_read_b64_tr_b16 v[232:233], v4 offset:33536
    v_mfma_f32_16x16x32_bf16 v[52:55], v[244:247], v[124:127], v[52:55]
    ds_read_b64_tr_b16 v[234:235], v4 offset:34560
    s_waitcnt lgkmcnt(4)
    v_mfma_f32_16x16x32_bf16 v[56:59], v[224:227], v[120:123], v[56:59]
    ds_read_b64_tr_b16 v[236:237], v5 offset:33568
    v_mfma_f32_16x16x32_bf16 v[60:63], v[224:227], v[124:127], v[60:63]
    ds_read_b64_tr_b16 v[238:239], v5 offset:34592
    s_waitcnt lgkmcnt(4)
    v_mfma_f32_16x16x32_bf16 v[64:67], v[228:231], v[120:123], v[64:67]
    ds_read_b64_tr_b16 v[240:241], v4 offset:40960
    v_mfma_f32_16x16x32_bf16 v[68:71], v[228:231], v[124:127], v[68:71]
    ds_read_b64_tr_b16 v[242:243], v4 offset:41984
    s_mov_b32 s23, 0xa800
    buffer_load_dwordx4 v[108:111], v7, s[8:11], s23 offen offset:0 sc1
    s_waitcnt lgkmcnt(4)
    v_mfma_f32_16x16x32_bf16 v[72:75], v[232:235], v[120:123], v[72:75]
    ds_read_b64_tr_b16 v[244:245], v5 offset:40992
    v_mfma_f32_16x16x32_bf16 v[76:79], v[232:235], v[124:127], v[76:79]
    ds_read_b64_tr_b16 v[246:247], v5 offset:42016
    s_waitcnt lgkmcnt(4)
    v_mfma_f32_16x16x32_bf16 v[80:83], v[236:239], v[120:123], v[80:83]
    ds_read_b64_tr_b16 v[224:225], v4 offset:41216
    v_mfma_f32_16x16x32_bf16 v[84:87], v[236:239], v[124:127], v[84:87]
    ds_read_b64_tr_b16 v[226:227], v4 offset:42240
    s_waitcnt vmcnt(15) lgkmcnt(4)
    v_mfma_f32_16x16x32_bf16 v[24:27], v[240:243], v[128:131], v[24:27]
    ds_read_b64_tr_b16 v[228:229], v5 offset:41248
    s_waitcnt vmcnt(14)
    v_mfma_f32_16x16x32_bf16 v[28:31], v[240:243], v[132:135], v[28:31]
    ds_read_b64_tr_b16 v[230:231], v5 offset:42272
    s_waitcnt lgkmcnt(4)
    v_mfma_f32_16x16x32_bf16 v[32:35], v[244:247], v[128:131], v[32:35]
    ds_read_b64_tr_b16 v[232:233], v4 offset:41472
    v_mfma_f32_16x16x32_bf16 v[36:39], v[244:247], v[132:135], v[36:39]
    ds_read_b64_tr_b16 v[234:235], v4 offset:42496
    s_mov_b32 s23, 0x2800
    buffer_load_dwordx4 v[112:115], v7, s[8:11], s23 offen offset:1024 sc1
    s_waitcnt lgkmcnt(4)
    v_mfma_f32_16x16x32_bf16 v[40:43], v[224:227], v[128:131], v[40:43]
    ds_read_b64_tr_b16 v[236:237], v5 offset:41504
    v_mfma_f32_16x16x32_bf16 v[44:47], v[224:227], v[132:135], v[44:47]
    ds_read_b64_tr_b16 v[238:239], v5 offset:42528
    s_waitcnt lgkmcnt(4)
    v_mfma_f32_16x16x32_bf16 v[48:51], v[228:231], v[128:131], v[48:51]
    ds_read_b64_tr_b16 v[240:241], v4 offset:41728
    v_mfma_f32_16x16x32_bf16 v[52:55], v[228:231], v[132:135], v[52:55]
    ds_read_b64_tr_b16 v[242:243], v4 offset:42752
    s_waitcnt lgkmcnt(4)
    v_mfma_f32_16x16x32_bf16 v[56:59], v[232:235], v[128:131], v[56:59]
    ds_read_b64_tr_b16 v[244:245], v5 offset:41760
    v_mfma_f32_16x16x32_bf16 v[60:63], v[232:235], v[132:135], v[60:63]
    ds_read_b64_tr_b16 v[246:247], v5 offset:42784
    s_waitcnt lgkmcnt(4)
    v_mfma_f32_16x16x32_bf16 v[64:67], v[236:239], v[128:131], v[64:67]
    v_mfma_f32_16x16x32_bf16 v[68:71], v[236:239], v[132:135], v[68:71]
    s_waitcnt vmcnt(8)
    s_barrier
    ds_read_b64_tr_b16 v[224:225], v4 offset:49152
    ds_read_b64_tr_b16 v[226:227], v4 offset:50176
    s_mov_b32 s23, 0xa800
    buffer_load_dwordx4 v[116:119], v7, s[8:11], s23 offen offset:1024 sc1
    s_waitcnt lgkmcnt(4)
    v_mfma_f32_16x16x32_bf16 v[72:75], v[240:243], v[128:131], v[72:75]
    ds_read_b64_tr_b16 v[228:229], v5 offset:49184
    v_mfma_f32_16x16x32_bf16 v[76:79], v[240:243], v[132:135], v[76:79]
    s_add_u32 s22, s19, 0x280000
    s_add_u32 m0, s20, 0x4000
    s_nop 0
    buffer_load_dwordx4 v3, s[4:7], s22 offen lds
    ds_read_b64_tr_b16 v[230:231], v5 offset:50208
    s_waitcnt lgkmcnt(4)
    v_mfma_f32_16x16x32_bf16 v[80:83], v[244:247], v[128:131], v[80:83]
    ds_read_b64_tr_b16 v[232:233], v4 offset:49408
    v_mfma_f32_16x16x32_bf16 v[84:87], v[244:247], v[132:135], v[84:87]
    ds_read_b64_tr_b16 v[234:235], v4 offset:50432
    s_waitcnt lgkmcnt(4)
    v_mfma_f32_16x16x32_bf16 v[24:27], v[224:227], v[136:139], v[24:27]
    ds_read_b64_tr_b16 v[236:237], v5 offset:49440
    v_mfma_f32_16x16x32_bf16 v[28:31], v[224:227], v[140:143], v[28:31]
    ds_read_b64_tr_b16 v[238:239], v5 offset:50464
    s_waitcnt lgkmcnt(4)
    v_mfma_f32_16x16x32_bf16 v[32:35], v[228:231], v[136:139], v[32:35]
    ds_read_b64_tr_b16 v[240:241], v4 offset:49664
    v_mfma_f32_16x16x32_bf16 v[36:39], v[228:231], v[140:143], v[36:39]
    ds_read_b64_tr_b16 v[242:243], v4 offset:50688
    s_mov_b32 s23, 0x3000
    buffer_load_dwordx4 v[120:123], v7, s[8:11], s23 offen offset:0 sc1
    s_waitcnt lgkmcnt(4)
    v_mfma_f32_16x16x32_bf16 v[40:43], v[232:235], v[136:139], v[40:43]
    ds_read_b64_tr_b16 v[244:245], v5 offset:49696
    v_mfma_f32_16x16x32_bf16 v[44:47], v[232:235], v[140:143], v[44:47]
    s_add_u32 s22, s19, 0x288000
    s_add_u32 m0, s20, 0x4400
    s_nop 0
    buffer_load_dwordx4 v3, s[4:7], s22 offen lds
    ds_read_b64_tr_b16 v[246:247], v5 offset:50720
    s_waitcnt lgkmcnt(4)
    v_mfma_f32_16x16x32_bf16 v[48:51], v[236:239], v[136:139], v[48:51]
    ds_read_b64_tr_b16 v[224:225], v4 offset:49920
    v_mfma_f32_16x16x32_bf16 v[52:55], v[236:239], v[140:143], v[52:55]
    ds_read_b64_tr_b16 v[226:227], v4 offset:50944
    s_waitcnt lgkmcnt(4)
    v_mfma_f32_16x16x32_bf16 v[56:59], v[240:243], v[136:139], v[56:59]
    ds_read_b64_tr_b16 v[228:229], v5 offset:49952
    v_mfma_f32_16x16x32_bf16 v[60:63], v[240:243], v[140:143], v[60:63]
    ds_read_b64_tr_b16 v[230:231], v5 offset:50976
    s_waitcnt lgkmcnt(4)
    v_mfma_f32_16x16x32_bf16 v[64:67], v[244:247], v[136:139], v[64:67]
    ds_read_b64_tr_b16 v[232:233], v4 offset:57344
    v_mfma_f32_16x16x32_bf16 v[68:71], v[244:247], v[140:143], v[68:71]
    ds_read_b64_tr_b16 v[234:235], v4 offset:58368
    s_mov_b32 s23, 0xb000
    buffer_load_dwordx4 v[124:127], v7, s[8:11], s23 offen offset:0 sc1
    s_waitcnt lgkmcnt(4)
    v_mfma_f32_16x16x32_bf16 v[72:75], v[224:227], v[136:139], v[72:75]
    ds_read_b64_tr_b16 v[236:237], v5 offset:57376
    v_mfma_f32_16x16x32_bf16 v[76:79], v[224:227], v[140:143], v[76:79]
    ds_read_b64_tr_b16 v[238:239], v5 offset:58400
    s_waitcnt lgkmcnt(4)
    v_mfma_f32_16x16x32_bf16 v[80:83], v[228:231], v[136:139], v[80:83]
    ds_read_b64_tr_b16 v[240:241], v4 offset:57600
    v_mfma_f32_16x16x32_bf16 v[84:87], v[228:231], v[140:143], v[84:87]
    ds_read_b64_tr_b16 v[242:243], v4 offset:58624
    s_waitcnt lgkmcnt(4)
    v_mfma_f32_16x16x32_bf16 v[24:27], v[232:235], v[144:147], v[24:27]
    ds_read_b64_tr_b16 v[244:245], v5 offset:57632
    v_mfma_f32_16x16x32_bf16 v[28:31], v[232:235], v[148:151], v[28:31]
    ds_read_b64_tr_b16 v[246:247], v5 offset:58656
    s_waitcnt lgkmcnt(4)
    v_mfma_f32_16x16x32_bf16 v[32:35], v[236:239], v[144:147], v[32:35]
    ds_read_b64_tr_b16 v[224:225], v4 offset:57856
    v_mfma_f32_16x16x32_bf16 v[36:39], v[236:239], v[148:151], v[36:39]
    ds_read_b64_tr_b16 v[226:227], v4 offset:58880
    s_mov_b32 s23, 0x3000
    buffer_load_dwordx4 v[128:131], v7, s[8:11], s23 offen offset:1024 sc1
    s_waitcnt lgkmcnt(4)
    v_mfma_f32_16x16x32_bf16 v[40:43], v[240:243], v[144:147], v[40:43]
    ds_read_b64_tr_b16 v[228:229], v5 offset:57888
    v_mfma_f32_16x16x32_bf16 v[44:47], v[240:243], v[148:151], v[44:47]
    ds_read_b64_tr_b16 v[230:231], v5 offset:58912
    s_waitcnt lgkmcnt(4)
    v_mfma_f32_16x16x32_bf16 v[48:51], v[244:247], v[144:147], v[48:51]
    ds_read_b64_tr_b16 v[232:233], v4 offset:58112
    v_mfma_f32_16x16x32_bf16 v[52:55], v[244:247], v[148:151], v[52:55]
    ds_read_b64_tr_b16 v[234:235], v4 offset:59136
    s_waitcnt lgkmcnt(4)
    v_mfma_f32_16x16x32_bf16 v[56:59], v[224:227], v[144:147], v[56:59]
    ds_read_b64_tr_b16 v[236:237], v5 offset:58144
    v_mfma_f32_16x16x32_bf16 v[60:63], v[224:227], v[148:151], v[60:63]
    ds_read_b64_tr_b16 v[238:239], v5 offset:59168
    s_waitcnt lgkmcnt(4)
    v_mfma_f32_16x16x32_bf16 v[64:67], v[228:231], v[144:147], v[64:67]
    v_mfma_f32_16x16x32_bf16 v[68:71], v[228:231], v[148:151], v[68:71]
    s_waitcnt vmcnt(8)
    s_barrier
    ds_read_b64_tr_b16 v[240:241], v4 offset:0
    ds_read_b64_tr_b16 v[242:243], v4 offset:1024
    s_mov_b32 s23, 0xb000
    buffer_load_dwordx4 v[132:135], v7, s[8:11], s23 offen offset:1024 sc1
    s_waitcnt lgkmcnt(4)
    v_mfma_f32_16x16x32_bf16 v[72:75], v[232:235], v[144:147], v[72:75]
    ds_read_b64_tr_b16 v[244:245], v5 offset:32
    v_mfma_f32_16x16x32_bf16 v[76:79], v[232:235], v[148:151], v[76:79]
    s_add_u32 s22, s19, 0x300000
    s_add_u32 m0, s20, 0x8000
    s_nop 0
    buffer_load_dwordx4 v3, s[4:7], s22 offen lds
    ds_read_b64_tr_b16 v[246:247], v5 offset:1056
    s_waitcnt lgkmcnt(4)
    v_mfma_f32_16x16x32_bf16 v[80:83], v[236:239], v[144:147], v[80:83]
    ds_read_b64_tr_b16 v[224:225], v4 offset:256
    v_mfma_f32_16x16x32_bf16 v[84:87], v[236:239], v[148:151], v[84:87]
    ds_read_b64_tr_b16 v[226:227], v4 offset:1280
    s_waitcnt lgkmcnt(4)
    v_mfma_f32_16x16x32_bf16 v[24:27], v[240:243], v[88:91], v[24:27]
    ds_read_b64_tr_b16 v[228:229], v5 offset:288
    v_mfma_f32_16x16x32_bf16 v[28:31], v[240:243], v[92:95], v[28:31]
    ds_read_b64_tr_b16 v[230:231], v5 offset:1312
    s_waitcnt lgkmcnt(4)
    v_mfma_f32_16x16x32_bf16 v[32:35], v[244:247], v[88:91], v[32:35]
    ds_read_b64_tr_b16 v[232:233], v4 offset:512
    v_mfma_f32_16x16x32_bf16 v[36:39], v[244:247], v[92:95], v[36:39]
    ds_read_b64_tr_b16 v[234:235], v4 offset:1536
    s_mov_b32 s23, 0x3800
    buffer_load_dwordx4 v[136:139], v7, s[8:11], s23 offen offset:0 sc1
    s_waitcnt lgkmcnt(4)
    v_mfma_f32_16x16x32_bf16 v[40:43], v[224:227], v[88:91], v[40:43]
    ds_read_b64_tr_b16 v[236:237], v5 offset:544
    v_mfma_f32_16x16x32_bf16 v[44:47], v[224:227], v[92:95], v[44:47]
    s_add_u32 s22, s19, 0x308000
    s_add_u32 m0, s20, 0x8400
    s_nop 0
    buffer_load_dwordx4 v3, s[4:7], s22 offen lds
    ds_read_b64_tr_b16 v[238:239], v5 offset:1568
    s_waitcnt lgkmcnt(4)
    v_mfma_f32_16x16x32_bf16 v[48:51], v[228:231], v[88:91], v[48:51]
    ds_read_b64_tr_b16 v[240:241], v4 offset:768
    v_mfma_f32_16x16x32_bf16 v[52:55], v[228:231], v[92:95], v[52:55]
    ds_read_b64_tr_b16 v[242:243], v4 offset:1792
    s_waitcnt lgkmcnt(4)
    v_mfma_f32_16x16x32_bf16 v[56:59], v[232:235], v[88:91], v[56:59]
    ds_read_b64_tr_b16 v[244:245], v5 offset:800
    v_mfma_f32_16x16x32_bf16 v[60:63], v[232:235], v[92:95], v[60:63]
    ds_read_b64_tr_b16 v[246:247], v5 offset:1824
    s_waitcnt lgkmcnt(4)
    v_mfma_f32_16x16x32_bf16 v[64:67], v[236:239], v[88:91], v[64:67]
    ds_read_b64_tr_b16 v[224:225], v4 offset:8192
    v_mfma_f32_16x16x32_bf16 v[68:71], v[236:239], v[92:95], v[68:71]
    ds_read_b64_tr_b16 v[226:227], v4 offset:9216
    s_mov_b32 s23, 0xb800
    buffer_load_dwordx4 v[140:143], v7, s[8:11], s23 offen offset:0 sc1
    s_waitcnt lgkmcnt(4)
    v_mfma_f32_16x16x32_bf16 v[72:75], v[240:243], v[88:91], v[72:75]
    ds_read_b64_tr_b16 v[228:229], v5 offset:8224
    v_mfma_f32_16x16x32_bf16 v[76:79], v[240:243], v[92:95], v[76:79]
    ds_read_b64_tr_b16 v[230:231], v5 offset:9248
    s_waitcnt lgkmcnt(4)
    v_mfma_f32_16x16x32_bf16 v[80:83], v[244:247], v[88:91], v[80:83]
    ds_read_b64_tr_b16 v[232:233], v4 offset:8448
    v_mfma_f32_16x16x32_bf16 v[84:87], v[244:247], v[92:95], v[84:87]
    ds_read_b64_tr_b16 v[234:235], v4 offset:9472
    s_waitcnt lgkmcnt(4)
    v_mfma_f32_16x16x32_bf16 v[24:27], v[224:227], v[96:99], v[24:27]
    ds_read_b64_tr_b16 v[236:237], v5 offset:8480
    v_mfma_f32_16x16x32_bf16 v[28:31], v[224:227], v[100:103], v[28:31]
    ds_read_b64_tr_b16 v[238:239], v5 offset:9504
    s_waitcnt lgkmcnt(4)
    v_mfma_f32_16x16x32_bf16 v[32:35], v[228:231], v[96:99], v[32:35]
    ds_read_b64_tr_b16 v[240:241], v4 offset:8704
    v_mfma_f32_16x16x32_bf16 v[36:39], v[228:231], v[100:103], v[36:39]
    ds_read_b64_tr_b16 v[242:243], v4 offset:9728
    s_mov_b32 s23, 0x3800
    buffer_load_dwordx4 v[144:147], v7, s[8:11], s23 offen offset:1024 sc1
    s_waitcnt lgkmcnt(4)
    v_mfma_f32_16x16x32_bf16 v[40:43], v[232:235], v[96:99], v[40:43]
    ds_read_b64_tr_b16 v[244:245], v5 offset:8736
    v_mfma_f32_16x16x32_bf16 v[44:47], v[232:235], v[100:103], v[44:47]
    ds_read_b64_tr_b16 v[246:247], v5 offset:9760
    s_waitcnt lgkmcnt(4)
    v_mfma_f32_16x16x32_bf16 v[48:51], v[236:239], v[96:99], v[48:51]
    ds_read_b64_tr_b16 v[224:225], v4 offset:8960
    v_mfma_f32_16x16x32_bf16 v[52:55], v[236:239], v[100:103], v[52:55]
    ds_read_b64_tr_b16 v[226:227], v4 offset:9984
    s_waitcnt lgkmcnt(4)
    v_mfma_f32_16x16x32_bf16 v[56:59], v[240:243], v[96:99], v[56:59]
    ds_read_b64_tr_b16 v[228:229], v5 offset:8992
    v_mfma_f32_16x16x32_bf16 v[60:63], v[240:243], v[100:103], v[60:63]
    ds_read_b64_tr_b16 v[230:231], v5 offset:10016
    s_waitcnt lgkmcnt(4)
    v_mfma_f32_16x16x32_bf16 v[64:67], v[244:247], v[96:99], v[64:67]
    v_mfma_f32_16x16x32_bf16 v[68:71], v[244:247], v[100:103], v[68:71]
    s_waitcnt vmcnt(8)
    s_barrier
    ds_read_b64_tr_b16 v[232:233], v4 offset:16384
    ds_read_b64_tr_b16 v[234:235], v4 offset:17408
    s_mov_b32 s23, 0xb800
    buffer_load_dwordx4 v[148:151], v7, s[8:11], s23 offen offset:1024 sc1
    s_waitcnt lgkmcnt(4)
    v_mfma_f32_16x16x32_bf16 v[72:75], v[224:227], v[96:99], v[72:75]
    ds_read_b64_tr_b16 v[236:237], v5 offset:16416
    v_mfma_f32_16x16x32_bf16 v[76:79], v[224:227], v[100:103], v[76:79]
    s_add_u32 s22, s19, 0x380000
    s_add_u32 m0, s20, 0xc000
    s_nop 0
    buffer_load_dwordx4 v3, s[4:7], s22 offen lds
    ds_read_b64_tr_b16 v[238:239], v5 offset:17440
    s_waitcnt lgkmcnt(4)
    v_mfma_f32_16x16x32_bf16 v[80:83], v[228:231], v[96:99], v[80:83]
    ds_read_b64_tr_b16 v[240:241], v4 offset:16640
    v_mfma_f32_16x16x32_bf16 v[84:87], v[228:231], v[100:103], v[84:87]
    ds_read_b64_tr_b16 v[242:243], v4 offset:17664
    s_waitcnt lgkmcnt(4)
    v_mfma_f32_16x16x32_bf16 v[24:27], v[232:235], v[104:107], v[24:27]
    ds_read_b64_tr_b16 v[244:245], v5 offset:16672
    v_mfma_f32_16x16x32_bf16 v[28:31], v[232:235], v[108:111], v[28:31]
    ds_read_b64_tr_b16 v[246:247], v5 offset:17696
    s_waitcnt lgkmcnt(4)
    v_mfma_f32_16x16x32_bf16 v[32:35], v[236:239], v[104:107], v[32:35]
    ds_read_b64_tr_b16 v[224:225], v4 offset:16896
    v_mfma_f32_16x16x32_bf16 v[36:39], v[236:239], v[108:111], v[36:39]
    ds_read_b64_tr_b16 v[226:227], v4 offset:17920
    s_mov_b32 s23, 0x4000
    buffer_load_dwordx4 v[88:91], v7, s[8:11], s23 offen offset:0 sc1
    s_waitcnt lgkmcnt(4)
    v_mfma_f32_16x16x32_bf16 v[40:43], v[240:243], v[104:107], v[40:43]
    ds_read_b64_tr_b16 v[228:229], v5 offset:16928
    v_mfma_f32_16x16x32_bf16 v[44:47], v[240:243], v[108:111], v[44:47]
    s_add_u32 s22, s19, 0x388000
    s_add_u32 m0, s20, 0xc400
    s_nop 0
    buffer_load_dwordx4 v3, s[4:7], s22 offen lds
    ds_read_b64_tr_b16 v[230:231], v5 offset:17952
    s_waitcnt lgkmcnt(4)
    v_mfma_f32_16x16x32_bf16 v[48:51], v[244:247], v[104:107], v[48:51]
    ds_read_b64_tr_b16 v[232:233], v4 offset:17152
    v_mfma_f32_16x16x32_bf16 v[52:55], v[244:247], v[108:111], v[52:55]
    ds_read_b64_tr_b16 v[234:235], v4 offset:18176
    s_waitcnt lgkmcnt(4)
    v_mfma_f32_16x16x32_bf16 v[56:59], v[224:227], v[104:107], v[56:59]
    ds_read_b64_tr_b16 v[236:237], v5 offset:17184
    v_mfma_f32_16x16x32_bf16 v[60:63], v[224:227], v[108:111], v[60:63]
    ds_read_b64_tr_b16 v[238:239], v5 offset:18208
    s_waitcnt lgkmcnt(4)
    v_mfma_f32_16x16x32_bf16 v[64:67], v[228:231], v[104:107], v[64:67]
    ds_read_b64_tr_b16 v[240:241], v4 offset:24576
    v_mfma_f32_16x16x32_bf16 v[68:71], v[228:231], v[108:111], v[68:71]
    ds_read_b64_tr_b16 v[242:243], v4 offset:25600
    s_mov_b32 s23, 0xc000
    buffer_load_dwordx4 v[92:95], v7, s[8:11], s23 offen offset:0 sc1
    s_waitcnt lgkmcnt(4)
    v_mfma_f32_16x16x32_bf16 v[72:75], v[232:235], v[104:107], v[72:75]
    ds_read_b64_tr_b16 v[244:245], v5 offset:24608
    v_mfma_f32_16x16x32_bf16 v[76:79], v[232:235], v[108:111], v[76:79]
    ds_read_b64_tr_b16 v[246:247], v5 offset:25632
    s_waitcnt lgkmcnt(4)
    v_mfma_f32_16x16x32_bf16 v[80:83], v[236:239], v[104:107], v[80:83]
    ds_read_b64_tr_b16 v[224:225], v4 offset:24832
    v_mfma_f32_16x16x32_bf16 v[84:87], v[236:239], v[108:111], v[84:87]
    ds_read_b64_tr_b16 v[226:227], v4 offset:25856
    s_waitcnt lgkmcnt(4)
    v_mfma_f32_16x16x32_bf16 v[24:27], v[240:243], v[112:115], v[24:27]
    ds_read_b64_tr_b16 v[228:229], v5 offset:24864
    v_mfma_f32_16x16x32_bf16 v[28:31], v[240:243], v[116:119], v[28:31]
    ds_read_b64_tr_b16 v[230:231], v5 offset:25888
    s_waitcnt lgkmcnt(4)
    v_mfma_f32_16x16x32_bf16 v[32:35], v[244:247], v[112:115], v[32:35]
    ds_read_b64_tr_b16 v[232:233], v4 offset:25088
    v_mfma_f32_16x16x32_bf16 v[36:39], v[244:247], v[116:119], v[36:39]
    ds_read_b64_tr_b16 v[234:235], v4 offset:26112
    s_mov_b32 s23, 0x4000
    buffer_load_dwordx4 v[96:99], v7, s[8:11], s23 offen offset:1024 sc1
    s_waitcnt lgkmcnt(4)
    v_mfma_f32_16x16x32_bf16 v[40:43], v[224:227], v[112:115], v[40:43]
    ds_read_b64_tr_b16 v[236:237], v5 offset:25120
    v_mfma_f32_16x16x32_bf16 v[44:47], v[224:227], v[116:119], v[44:47]
    ds_read_b64_tr_b16 v[238:239], v5 offset:26144
    s_waitcnt lgkmcnt(4)
    v_mfma_f32_16x16x32_bf16 v[48:51], v[228:231], v[112:115], v[48:51]
    ds_read_b64_tr_b16 v[240:241], v4 offset:25344
    v_mfma_f32_16x16x32_bf16 v[52:55], v[228:231], v[116:119], v[52:55]
    ds_read_b64_tr_b16 v[242:243], v4 offset:26368
    s_waitcnt lgkmcnt(4)
    v_mfma_f32_16x16x32_bf16 v[56:59], v[232:235], v[112:115], v[56:59]
    ds_read_b64_tr_b16 v[244:245], v5 offset:25376
    v_mfma_f32_16x16x32_bf16 v[60:63], v[232:235], v[116:119], v[60:63]
    ds_read_b64_tr_b16 v[246:247], v5 offset:26400
    s_waitcnt lgkmcnt(4)
    v_mfma_f32_16x16x32_bf16 v[64:67], v[236:239], v[112:115], v[64:67]
    v_mfma_f32_16x16x32_bf16 v[68:71], v[236:239], v[116:119], v[68:71]
    s_waitcnt vmcnt(8)
    s_barrier
    ds_read_b64_tr_b16 v[224:225], v4 offset:32768
    ds_read_b64_tr_b16 v[226:227], v4 offset:33792
    s_mov_b32 s23, 0xc000
    buffer_load_dwordx4 v[100:103], v7, s[8:11], s23 offen offset:1024 sc1
    s_waitcnt lgkmcnt(4)
    v_mfma_f32_16x16x32_bf16 v[72:75], v[240:243], v[112:115], v[72:75]
    ds_read_b64_tr_b16 v[228:229], v5 offset:32800
    v_mfma_f32_16x16x32_bf16 v[76:79], v[240:243], v[116:119], v[76:79]
    s_add_u32 s22, s19, 0x400000
    s_add_u32 m0, s20, 0x0
    s_nop 0
    buffer_load_dwordx4 v3, s[4:7], s22 offen lds
    ds_read_b64_tr_b16 v[230:231], v5 offset:33824
    s_waitcnt lgkmcnt(4)
    v_mfma_f32_16x16x32_bf16 v[80:83], v[244:247], v[112:115], v[80:83]
    ds_read_b64_tr_b16 v[232:233], v4 offset:33024
    v_mfma_f32_16x16x32_bf16 v[84:87], v[244:247], v[116:119], v[84:87]
    ds_read_b64_tr_b16 v[234:235], v4 offset:34048
    s_waitcnt lgkmcnt(4)
    v_mfma_f32_16x16x32_bf16 v[24:27], v[224:227], v[120:123], v[24:27]
    ds_read_b64_tr_b16 v[236:237], v5 offset:33056
    v_mfma_f32_16x16x32_bf16 v[28:31], v[224:227], v[124:127], v[28:31]
    ds_read_b64_tr_b16 v[238:239], v5 offset:34080
    s_waitcnt lgkmcnt(4)
    v_mfma_f32_16x16x32_bf16 v[32:35], v[228:231], v[120:123], v[32:35]
    ds_read_b64_tr_b16 v[240:241], v4 offset:33280
    v_mfma_f32_16x16x32_bf16 v[36:39], v[228:231], v[124:127], v[36:39]
    ds_read_b64_tr_b16 v[242:243], v4 offset:34304
    s_mov_b32 s23, 0x4800
    buffer_load_dwordx4 v[104:107], v7, s[8:11], s23 offen offset:0 sc1
    s_waitcnt lgkmcnt(4)
    v_mfma_f32_16x16x32_bf16 v[40:43], v[232:235], v[120:123], v[40:43]
    ds_read_b64_tr_b16 v[244:245], v5 offset:33312
    v_mfma_f32_16x16x32_bf16 v[44:47], v[232:235], v[124:127], v[44:47]
    s_add_u32 s22, s19, 0x408000
    s_add_u32 m0, s20, 0x400
    s_nop 0
    buffer_load_dwordx4 v3, s[4:7], s22 offen lds
    ds_read_b64_tr_b16 v[246:247], v5 offset:34336
    s_waitcnt lgkmcnt(4)
    v_mfma_f32_16x16x32_bf16 v[48:51], v[236:239], v[120:123], v[48:51]
    ds_read_b64_tr_b16 v[224:225], v4 offset:33536
    v_mfma_f32_16x16x32_bf16 v[52:55], v[236:239], v[124:127], v[52:55]
    ds_read_b64_tr_b16 v[226:227], v4 offset:34560
    s_waitcnt lgkmcnt(4)
    v_mfma_f32_16x16x32_bf16 v[56:59], v[240:243], v[120:123], v[56:59]
    ds_read_b64_tr_b16 v[228:229], v5 offset:33568
    v_mfma_f32_16x16x32_bf16 v[60:63], v[240:243], v[124:127], v[60:63]
    ds_read_b64_tr_b16 v[230:231], v5 offset:34592
    s_waitcnt lgkmcnt(4)
    v_mfma_f32_16x16x32_bf16 v[64:67], v[244:247], v[120:123], v[64:67]
    ds_read_b64_tr_b16 v[232:233], v4 offset:40960
    v_mfma_f32_16x16x32_bf16 v[68:71], v[244:247], v[124:127], v[68:71]
    ds_read_b64_tr_b16 v[234:235], v4 offset:41984
    s_mov_b32 s23, 0xc800
    buffer_load_dwordx4 v[108:111], v7, s[8:11], s23 offen offset:0 sc1
    s_waitcnt lgkmcnt(4)
    v_mfma_f32_16x16x32_bf16 v[72:75], v[224:227], v[120:123], v[72:75]
    ds_read_b64_tr_b16 v[236:237], v5 offset:40992
    v_lshrrev_b32 v21, 4, v1
    v_lshlrev_b32 v21, 9, v21
    v_and_b32 v20, 15, v1
    v_lshl_add_u32 v21, v20, 4, v21
    s_lshr_b32 s18, s12, 3
    s_lshl_b32 s18, s18, 11
    s_add_u32 s18, s18, 0x528100
    buffer_load_dwordx4 v[12:15], v21, s[8:11], s18 offen sc1
    v_mfma_f32_16x16x32_bf16 v[76:79], v[224:227], v[124:127], v[76:79]
    ds_read_b64_tr_b16 v[238:239], v5 offset:42016
    s_waitcnt lgkmcnt(4)
    v_mfma_f32_16x16x32_bf16 v[80:83], v[228:231], v[120:123], v[80:83]
    ds_read_b64_tr_b16 v[240:241], v4 offset:41216
    v_mfma_f32_16x16x32_bf16 v[84:87], v[228:231], v[124:127], v[84:87]
    ds_read_b64_tr_b16 v[242:243], v4 offset:42240
    s_waitcnt lgkmcnt(4)
    v_mfma_f32_16x16x32_bf16 v[24:27], v[232:235], v[128:131], v[24:27]
    ds_read_b64_tr_b16 v[244:245], v5 offset:41248
    v_mfma_f32_16x16x32_bf16 v[28:31], v[232:235], v[132:135], v[28:31]
    ds_read_b64_tr_b16 v[246:247], v5 offset:42272
    s_waitcnt lgkmcnt(4)
    v_mfma_f32_16x16x32_bf16 v[32:35], v[236:239], v[128:131], v[32:35]
    ds_read_b64_tr_b16 v[224:225], v4 offset:41472
    v_mfma_f32_16x16x32_bf16 v[36:39], v[236:239], v[132:135], v[36:39]
    ds_read_b64_tr_b16 v[226:227], v4 offset:42496
    s_mov_b32 s23, 0x4800
    buffer_load_dwordx4 v[112:115], v7, s[8:11], s23 offen offset:1024 sc1
    s_waitcnt lgkmcnt(4)
    v_mfma_f32_16x16x32_bf16 v[40:43], v[240:243], v[128:131], v[40:43]
    ds_read_b64_tr_b16 v[228:229], v5 offset:41504
    v_mfma_f32_16x16x32_bf16 v[44:47], v[240:243], v[132:135], v[44:47]
    ds_read_b64_tr_b16 v[230:231], v5 offset:42528
    s_waitcnt lgkmcnt(4)
    v_mfma_f32_16x16x32_bf16 v[48:51], v[244:247], v[128:131], v[48:51]
    ds_read_b64_tr_b16 v[232:233], v4 offset:41728
    v_mfma_f32_16x16x32_bf16 v[52:55], v[244:247], v[132:135], v[52:55]
    ds_read_b64_tr_b16 v[234:235], v4 offset:42752
    s_waitcnt lgkmcnt(4)
    v_mfma_f32_16x16x32_bf16 v[56:59], v[224:227], v[128:131], v[56:59]
    ds_read_b64_tr_b16 v[236:237], v5 offset:41760
    v_mfma_f32_16x16x32_bf16 v[60:63], v[224:227], v[132:135], v[60:63]
    ds_read_b64_tr_b16 v[238:239], v5 offset:42784
    s_waitcnt lgkmcnt(4)
    v_mfma_f32_16x16x32_bf16 v[64:67], v[228:231], v[128:131], v[64:67]
    v_mfma_f32_16x16x32_bf16 v[68:71], v[228:231], v[132:135], v[68:71]
    s_waitcnt vmcnt(9)
    s_barrier
    ds_read_b64_tr_b16 v[240:241], v4 offset:49152
    ds_read_b64_tr_b16 v[242:243], v4 offset:50176
    s_mov_b32 s23, 0xc800
    buffer_load_dwordx4 v[116:119], v7, s[8:11], s23 offen offset:1024 sc1
    s_waitcnt lgkmcnt(4)
    v_mfma_f32_16x16x32_bf16 v[72:75], v[232:235], v[128:131], v[72:75]
    ds_read_b64_tr_b16 v[244:245], v5 offset:49184
    v_mfma_f32_16x16x32_bf16 v[76:79], v[232:235], v[132:135], v[76:79]
    s_add_u32 s22, s19, 0x480000
    s_add_u32 m0, s20, 0x4000
    s_nop 0
    buffer_load_dwordx4 v3, s[4:7], s22 offen lds
    ds_read_b64_tr_b16 v[246:247], v5 offset:50208
    s_waitcnt lgkmcnt(4)
    v_mfma_f32_16x16x32_bf16 v[80:83], v[236:239], v[128:131], v[80:83]
    ds_read_b64_tr_b16 v[224:225], v4 offset:49408
    v_mfma_f32_16x16x32_bf16 v[84:87], v[236:239], v[132:135], v[84:87]
    ds_read_b64_tr_b16 v[226:227], v4 offset:50432
    s_waitcnt lgkmcnt(4)
    v_mfma_f32_16x16x32_bf16 v[24:27], v[240:243], v[136:139], v[24:27]
    ds_read_b64_tr_b16 v[228:229], v5 offset:49440
    v_mfma_f32_16x16x32_bf16 v[28:31], v[240:243], v[140:143], v[28:31]
    ds_read_b64_tr_b16 v[230:231], v5 offset:50464
    s_waitcnt lgkmcnt(4)
    v_mfma_f32_16x16x32_bf16 v[32:35], v[244:247], v[136:139], v[32:35]
    ds_read_b64_tr_b16 v[232:233], v4 offset:49664
    v_mfma_f32_16x16x32_bf16 v[36:39], v[244:247], v[140:143], v[36:39]
    ds_read_b64_tr_b16 v[234:235], v4 offset:50688
    s_mov_b32 s23, 0x5000
    buffer_load_dwordx4 v[120:123], v7, s[8:11], s23 offen offset:0 sc1
    s_waitcnt lgkmcnt(4)
    v_mfma_f32_16x16x32_bf16 v[40:43], v[224:227], v[136:139], v[40:43]
    ds_read_b64_tr_b16 v[236:237], v5 offset:49696
    v_mfma_f32_16x16x32_bf16 v[44:47], v[224:227], v[140:143], v[44:47]
    s_add_u32 s22, s19, 0x488000
    s_add_u32 m0, s20, 0x4400
    s_nop 0
    buffer_load_dwordx4 v3, s[4:7], s22 offen lds
    ds_read_b64_tr_b16 v[238:239], v5 offset:50720
    s_waitcnt lgkmcnt(4)
    v_mfma_f32_16x16x32_bf16 v[48:51], v[228:231], v[136:139], v[48:51]
    ds_read_b64_tr_b16 v[240:241], v4 offset:49920
    v_mfma_f32_16x16x32_bf16 v[52:55], v[228:231], v[140:143], v[52:55]
    ds_read_b64_tr_b16 v[242:243], v4 offset:50944
    s_waitcnt lgkmcnt(4)
    v_mfma_f32_16x16x32_bf16 v[56:59], v[232:235], v[136:139], v[56:59]
    ds_read_b64_tr_b16 v[244:245], v5 offset:49952
    v_mfma_f32_16x16x32_bf16 v[60:63], v[232:235], v[140:143], v[60:63]
    ds_read_b64_tr_b16 v[246:247], v5 offset:50976
    s_waitcnt lgkmcnt(4)
    v_mfma_f32_16x16x32_bf16 v[64:67], v[236:239], v[136:139], v[64:67]
    ds_read_b64_tr_b16 v[224:225], v4 offset:57344
    v_mfma_f32_16x16x32_bf16 v[68:71], v[236:239], v[140:143], v[68:71]
    ds_read_b64_tr_b16 v[226:227], v4 offset:58368
    s_mov_b32 s23, 0xd000
    buffer_load_dwordx4 v[124:127], v7, s[8:11], s23 offen offset:0 sc1
    s_waitcnt lgkmcnt(4)
    v_mfma_f32_16x16x32_bf16 v[72:75], v[240:243], v[136:139], v[72:75]
    ds_read_b64_tr_b16 v[228:229], v5 offset:57376
    v_mfma_f32_16x16x32_bf16 v[76:79], v[240:243], v[140:143], v[76:79]
    ds_read_b64_tr_b16 v[230:231], v5 offset:58400
    s_waitcnt lgkmcnt(4)
    v_mfma_f32_16x16x32_bf16 v[80:83], v[244:247], v[136:139], v[80:83]
    ds_read_b64_tr_b16 v[232:233], v4 offset:57600
    v_mfma_f32_16x16x32_bf16 v[84:87], v[244:247], v[140:143], v[84:87]
    ds_read_b64_tr_b16 v[234:235], v4 offset:58624
    s_waitcnt lgkmcnt(4)
    v_mfma_f32_16x16x32_bf16 v[24:27], v[224:227], v[144:147], v[24:27]
    ds_read_b64_tr_b16 v[236:237], v5 offset:57632
    v_mfma_f32_16x16x32_bf16 v[28:31], v[224:227], v[148:151], v[28:31]
    ds_read_b64_tr_b16 v[238:239], v5 offset:58656
    s_waitcnt lgkmcnt(4)
    v_mfma_f32_16x16x32_bf16 v[32:35], v[228:231], v[144:147], v[32:35]
    ds_read_b64_tr_b16 v[240:241], v4 offset:57856
    v_mfma_f32_16x16x32_bf16 v[36:39], v[228:231], v[148:151], v[36:39]
    ds_read_b64_tr_b16 v[242:243], v4 offset:58880
    s_mov_b32 s23, 0x5000
    buffer_load_dwordx4 v[128:131], v7, s[8:11], s23 offen offset:1024 sc1
    s_waitcnt lgkmcnt(4)
    v_mfma_f32_16x16x32_bf16 v[40:43], v[232:235], v[144:147], v[40:43]
    ds_read_b64_tr_b16 v[244:245], v5 offset:57888
    v_mfma_f32_16x16x32_bf16 v[44:47], v[232:235], v[148:151], v[44:47]
    ds_read_b64_tr_b16 v[246:247], v5 offset:58912
    s_waitcnt lgkmcnt(4)
    v_mfma_f32_16x16x32_bf16 v[48:51], v[236:239], v[144:147], v[48:51]
    ds_read_b64_tr_b16 v[224:225], v4 offset:58112
    v_mfma_f32_16x16x32_bf16 v[52:55], v[236:239], v[148:151], v[52:55]
    ds_read_b64_tr_b16 v[226:227], v4 offset:59136
    s_waitcnt lgkmcnt(4)
    v_mfma_f32_16x16x32_bf16 v[56:59], v[240:243], v[144:147], v[56:59]
    ds_read_b64_tr_b16 v[228:229], v5 offset:58144
    v_mfma_f32_16x16x32_bf16 v[60:63], v[240:243], v[148:151], v[60:63]
    ds_read_b64_tr_b16 v[230:231], v5 offset:59168
    s_waitcnt lgkmcnt(4)
    v_mfma_f32_16x16x32_bf16 v[64:67], v[244:247], v[144:147], v[64:67]
    v_mfma_f32_16x16x32_bf16 v[68:71], v[244:247], v[148:151], v[68:71]
    s_waitcnt vmcnt(9)
    s_barrier
    ds_read_b64_tr_b16 v[232:233], v4 offset:0
    ds_read_b64_tr_b16 v[234:235], v4 offset:1024
    s_mov_b32 s23, 0xd000
    buffer_load_dwordx4 v[132:135], v7, s[8:11], s23 offen offset:1024 sc1
    s_waitcnt lgkmcnt(4)
    v_mfma_f32_16x16x32_bf16 v[72:75], v[224:227], v[144:147], v[72:75]
    ds_read_b64_tr_b16 v[236:237], v5 offset:32
    v_mfma_f32_16x16x32_bf16 v[76:79], v[224:227], v[148:151], v[76:79]
    s_add_u32 s22, s19, 0x500000
    s_add_u32 m0, s20, 0x8000
    s_nop 0
    buffer_load_dwordx4 v3, s[4:7], s22 offen lds
    ds_read_b64_tr_b16 v[238:239], v5 offset:1056
    s_waitcnt lgkmcnt(4)
    v_mfma_f32_16x16x32_bf16 v[80:83], v[228:231], v[144:147], v[80:83]
    ds_read_b64_tr_b16 v[240:241], v4 offset:256
    v_mfma_f32_16x16x32_bf16 v[84:87], v[228:231], v[148:151], v[84:87]
    ds_read_b64_tr_b16 v[242:243], v4 offset:1280
    s_waitcnt lgkmcnt(4)
    v_mfma_f32_16x16x32_bf16 v[24:27], v[232:235], v[88:91], v[24:27]
    ds_read_b64_tr_b16 v[244:245], v5 offset:288
    v_mfma_f32_16x16x32_bf16 v[28:31], v[232:235], v[92:95], v[28:31]
    ds_read_b64_tr_b16 v[246:247], v5 offset:1312
    s_waitcnt lgkmcnt(4)
    v_mfma_f32_16x16x32_bf16 v[32:35], v[236:239], v[88:91], v[32:35]
    ds_read_b64_tr_b16 v[224:225], v4 offset:512
    v_mfma_f32_16x16x32_bf16 v[36:39], v[236:239], v[92:95], v[36:39]
    ds_read_b64_tr_b16 v[226:227], v4 offset:1536
    s_mov_b32 s23, 0x5800
    buffer_load_dwordx4 v[136:139], v7, s[8:11], s23 offen offset:0 sc1
    s_waitcnt lgkmcnt(4)
    v_mfma_f32_16x16x32_bf16 v[40:43], v[240:243], v[88:91], v[40:43]
    ds_read_b64_tr_b16 v[228:229], v5 offset:544
    v_mfma_f32_16x16x32_bf16 v[44:47], v[240:243], v[92:95], v[44:47]
    s_add_u32 s22, s19, 0x508000
    s_add_u32 m0, s20, 0x8400
    s_nop 0
    buffer_load_dwordx4 v3, s[4:7], s22 offen lds
    ds_read_b64_tr_b16 v[230:231], v5 offset:1568
    s_waitcnt lgkmcnt(4)
    v_mfma_f32_16x16x32_bf16 v[48:51], v[244:247], v[88:91], v[48:51]
    ds_read_b64_tr_b16 v[232:233], v4 offset:768
    v_mfma_f32_16x16x32_bf16 v[52:55], v[244:247], v[92:95], v[52:55]
    ds_read_b64_tr_b16 v[234:235], v4 offset:1792
    s_waitcnt lgkmcnt(4)
    v_mfma_f32_16x16x32_bf16 v[56:59], v[224:227], v[88:91], v[56:59]
    ds_read_b64_tr_b16 v[236:237], v5 offset:800
    v_mfma_f32_16x16x32_bf16 v[60:63], v[224:227], v[92:95], v[60:63]
    ds_read_b64_tr_b16 v[238:239], v5 offset:1824
    s_waitcnt lgkmcnt(4)
    v_mfma_f32_16x16x32_bf16 v[64:67], v[228:231], v[88:91], v[64:67]
    ds_read_b64_tr_b16 v[240:241], v4 offset:8192
    v_mfma_f32_16x16x32_bf16 v[68:71], v[228:231], v[92:95], v[68:71]
    ds_read_b64_tr_b16 v[242:243], v4 offset:9216
    s_mov_b32 s23, 0xd800
    buffer_load_dwordx4 v[140:143], v7, s[8:11], s23 offen offset:0 sc1
    s_waitcnt lgkmcnt(4)
    v_mfma_f32_16x16x32_bf16 v[72:75], v[232:235], v[88:91], v[72:75]
    ds_read_b64_tr_b16 v[244:245], v5 offset:8224
    v_mfma_f32_16x16x32_bf16 v[76:79], v[232:235], v[92:95], v[76:79]
    ds_read_b64_tr_b16 v[246:247], v5 offset:9248
    s_waitcnt lgkmcnt(4)
    v_mfma_f32_16x16x32_bf16 v[80:83], v[236:239], v[88:91], v[80:83]
    ds_read_b64_tr_b16 v[224:225], v4 offset:8448
    v_mfma_f32_16x16x32_bf16 v[84:87], v[236:239], v[92:95], v[84:87]
    ds_read_b64_tr_b16 v[226:227], v4 offset:9472
    s_waitcnt lgkmcnt(4)
    v_mfma_f32_16x16x32_bf16 v[24:27], v[240:243], v[96:99], v[24:27]
    ds_read_b64_tr_b16 v[228:229], v5 offset:8480
    v_mfma_f32_16x16x32_bf16 v[28:31], v[240:243], v[100:103], v[28:31]
    ds_read_b64_tr_b16 v[230:231], v5 offset:9504
    s_waitcnt lgkmcnt(4)
    v_mfma_f32_16x16x32_bf16 v[32:35], v[244:247], v[96:99], v[32:35]
    ds_read_b64_tr_b16 v[232:233], v4 offset:8704
    v_mfma_f32_16x16x32_bf16 v[36:39], v[244:247], v[100:103], v[36:39]
    ds_read_b64_tr_b16 v[234:235], v4 offset:9728
    s_mov_b32 s23, 0x5800
    buffer_load_dwordx4 v[144:147], v7, s[8:11], s23 offen offset:1024 sc1
    s_waitcnt lgkmcnt(4)
    v_mfma_f32_16x16x32_bf16 v[40:43], v[224:227], v[96:99], v[40:43]
    ds_read_b64_tr_b16 v[236:237], v5 offset:8736
    v_mfma_f32_16x16x32_bf16 v[44:47], v[224:227], v[100:103], v[44:47]
    ds_read_b64_tr_b16 v[238:239], v5 offset:9760
    s_waitcnt lgkmcnt(4)
    v_mfma_f32_16x16x32_bf16 v[48:51], v[228:231], v[96:99], v[48:51]
    ds_read_b64_tr_b16 v[240:241], v4 offset:8960
    v_mfma_f32_16x16x32_bf16 v[52:55], v[228:231], v[100:103], v[52:55]
    ds_read_b64_tr_b16 v[242:243], v4 offset:9984
    s_waitcnt lgkmcnt(4)
    v_mfma_f32_16x16x32_bf16 v[56:59], v[232:235], v[96:99], v[56:59]
    ds_read_b64_tr_b16 v[244:245], v5 offset:8992
    v_mfma_f32_16x16x32_bf16 v[60:63], v[232:235], v[100:103], v[60:63]
    ds_read_b64_tr_b16 v[246:247], v5 offset:10016
    s_waitcnt lgkmcnt(4)
    v_mfma_f32_16x16x32_bf16 v[64:67], v[236:239], v[96:99], v[64:67]
    v_mfma_f32_16x16x32_bf16 v[68:71], v[236:239], v[100:103], v[68:71]
    s_waitcnt vmcnt(8)
    s_barrier
    ds_read_b64_tr_b16 v[224:225], v4 offset:16384
    ds_read_b64_tr_b16 v[226:227], v4 offset:17408
    s_mov_b32 s23, 0xd800
    buffer_load_dwordx4 v[148:151], v7, s[8:11], s23 offen offset:1024 sc1
    s_waitcnt lgkmcnt(4)
    v_mfma_f32_16x16x32_bf16 v[72:75], v[240:243], v[96:99], v[72:75]
    ds_read_b64_tr_b16 v[228:229], v5 offset:16416
    v_mfma_f32_16x16x32_bf16 v[76:79], v[240:243], v[100:103], v[76:79]
    s_add_u32 s22, s19, 0x580000
    s_add_u32 m0, s20, 0xc000
    s_nop 0
    buffer_load_dwordx4 v3, s[4:7], s22 offen lds
    ds_read_b64_tr_b16 v[230:231], v5 offset:17440
    s_waitcnt lgkmcnt(4)
    v_mfma_f32_16x16x32_bf16 v[80:83], v[244:247], v[96:99], v[80:83]
    ds_read_b64_tr_b16 v[232:233], v4 offset:16640
    v_mfma_f32_16x16x32_bf16 v[84:87], v[244:247], v[100:103], v[84:87]
    ds_read_b64_tr_b16 v[234:235], v4 offset:17664
    s_waitcnt lgkmcnt(4)
    v_mfma_f32_16x16x32_bf16 v[24:27], v[224:227], v[104:107], v[24:27]
    ds_read_b64_tr_b16 v[236:237], v5 offset:16672
    v_mfma_f32_16x16x32_bf16 v[28:31], v[224:227], v[108:111], v[28:31]
    ds_read_b64_tr_b16 v[238:239], v5 offset:17696
    s_waitcnt lgkmcnt(4)
    v_mfma_f32_16x16x32_bf16 v[32:35], v[228:231], v[104:107], v[32:35]
    ds_read_b64_tr_b16 v[240:241], v4 offset:16896
    v_mfma_f32_16x16x32_bf16 v[36:39], v[228:231], v[108:111], v[36:39]
    ds_read_b64_tr_b16 v[242:243], v4 offset:17920
    s_mov_b32 s23, 0x6000
    buffer_load_dwordx4 v[88:91], v7, s[8:11], s23 offen offset:0 sc1
    s_waitcnt lgkmcnt(4)
    v_mfma_f32_16x16x32_bf16 v[40:43], v[232:235], v[104:107], v[40:43]
    ds_read_b64_tr_b16 v[244:245], v5 offset:16928
    v_mfma_f32_16x16x32_bf16 v[44:47], v[232:235], v[108:111], v[44:47]
    s_add_u32 s22, s19, 0x588000
    s_add_u32 m0, s20, 0xc400
    s_nop 0
    buffer_load_dwordx4 v3, s[4:7], s22 offen lds
    ds_read_b64_tr_b16 v[246:247], v5 offset:17952
    s_waitcnt lgkmcnt(4)
    v_mfma_f32_16x16x32_bf16 v[48:51], v[236:239], v[104:107], v[48:51]
    ds_read_b64_tr_b16 v[224:225], v4 offset:17152
    v_mfma_f32_16x16x32_bf16 v[52:55], v[236:239], v[108:111], v[52:55]
    ds_read_b64_tr_b16 v[226:227], v4 offset:18176
    s_waitcnt lgkmcnt(4)
    v_mfma_f32_16x16x32_bf16 v[56:59], v[240:243], v[104:107], v[56:59]
    ds_read_b64_tr_b16 v[228:229], v5 offset:17184
    v_mfma_f32_16x16x32_bf16 v[60:63], v[240:243], v[108:111], v[60:63]
    ds_read_b64_tr_b16 v[230:231], v5 offset:18208
    s_waitcnt lgkmcnt(4)
    v_mfma_f32_16x16x32_bf16 v[64:67], v[244:247], v[104:107], v[64:67]
    ds_read_b64_tr_b16 v[232:233], v4 offset:24576
    v_mfma_f32_16x16x32_bf16 v[68:71], v[244:247], v[108:111], v[68:71]
    ds_read_b64_tr_b16 v[234:235], v4 offset:25600
    s_mov_b32 s23, 0xe000
    buffer_load_dwordx4 v[92:95], v7, s[8:11], s23 offen offset:0 sc1
    s_waitcnt lgkmcnt(4)
    v_mfma_f32_16x16x32_bf16 v[72:75], v[224:227], v[104:107], v[72:75]
    ds_read_b64_tr_b16 v[236:237], v5 offset:24608
    v_xor_b32 v8, s28, v12
    v_xor_b32 v20, s28, v13
    v_or_b32 v8, v8, v20
    v_xor_b32 v20, s28, v14
    v_or_b32 v8, v8, v20
    v_xor_b32 v20, s28, v15
    v_or_b32 v8, v8, v20
    v_cmp_ne_u32 vcc, 0, v8
    s_cbranch_vccnz adaLN_cond__sliding_block_cached__moe_arch_mod__prompt_kernel_kv4r
adaLN_cond__sliding_block_cached__moe_arch_mod__prompt_kernel_kv4b:
    v_mfma_f32_16x16x32_bf16 v[76:79], v[224:227], v[108:111], v[76:79]
    ds_read_b64_tr_b16 v[238:239], v5 offset:25632
    v_mov_b32 v20, 0
    s_mov_b32 s16, 0x564000
    buffer_load_dword v8, v20, s[8:11], s16 offen sc1
    s_waitcnt lgkmcnt(4)
    v_mfma_f32_16x16x32_bf16 v[80:83], v[228:231], v[104:107], v[80:83]
    ds_read_b64_tr_b16 v[240:241], v4 offset:24832
    v_mfma_f32_16x16x32_bf16 v[84:87], v[228:231], v[108:111], v[84:87]
    ds_read_b64_tr_b16 v[242:243], v4 offset:25856
    s_waitcnt lgkmcnt(4)
    v_mfma_f32_16x16x32_bf16 v[24:27], v[232:235], v[112:115], v[24:27]
    ds_read_b64_tr_b16 v[244:245], v5 offset:24864
    v_mfma_f32_16x16x32_bf16 v[28:31], v[232:235], v[116:119], v[28:31]
    ds_read_b64_tr_b16 v[246:247], v5 offset:25888
    s_waitcnt lgkmcnt(4)
    v_mfma_f32_16x16x32_bf16 v[32:35], v[236:239], v[112:115], v[32:35]
    ds_read_b64_tr_b16 v[224:225], v4 offset:25088
    v_mfma_f32_16x16x32_bf16 v[36:39], v[236:239], v[116:119], v[36:39]
    ds_read_b64_tr_b16 v[226:227], v4 offset:26112
    s_mov_b32 s23, 0x6000
    buffer_load_dwordx4 v[96:99], v7, s[8:11], s23 offen offset:1024 sc1
    s_waitcnt lgkmcnt(4)
    v_mfma_f32_16x16x32_bf16 v[40:43], v[240:243], v[112:115], v[40:43]
    ds_read_b64_tr_b16 v[228:229], v5 offset:25120
    v_mfma_f32_16x16x32_bf16 v[44:47], v[240:243], v[116:119], v[44:47]
    ds_read_b64_tr_b16 v[230:231], v5 offset:26144
    s_waitcnt lgkmcnt(4)
    v_mfma_f32_16x16x32_bf16 v[48:51], v[244:247], v[112:115], v[48:51]
    ds_read_b64_tr_b16 v[232:233], v4 offset:25344
    v_mfma_f32_16x16x32_bf16 v[52:55], v[244:247], v[116:119], v[52:55]
    ds_read_b64_tr_b16 v[234:235], v4 offset:26368
    s_waitcnt lgkmcnt(4)
    v_mfma_f32_16x16x32_bf16 v[56:59], v[224:227], v[112:115], v[56:59]
    ds_read_b64_tr_b16 v[236:237], v5 offset:25376
    v_mfma_f32_16x16x32_bf16 v[60:63], v[224:227], v[116:119], v[60:63]
    ds_read_b64_tr_b16 v[238:239], v5 offset:26400
    s_waitcnt lgkmcnt(4)
    v_mfma_f32_16x16x32_bf16 v[64:67], v[228:231], v[112:115], v[64:67]
    v_mfma_f32_16x16x32_bf16 v[68:71], v[228:231], v[116:119], v[68:71]
    s_waitcnt vmcnt(9)
    s_barrier
    ds_read_b64_tr_b16 v[240:241], v4 offset:32768
    ds_read_b64_tr_b16 v[242:243], v4 offset:33792
    s_mov_b32 s23, 0xe000
    buffer_load_dwordx4 v[100:103], v7, s[8:11], s23 offen offset:1024 sc1
    s_waitcnt lgkmcnt(4)
    v_mfma_f32_16x16x32_bf16 v[72:75], v[232:235], v[112:115], v[72:75]
    ds_read_b64_tr_b16 v[244:245], v5 offset:32800
    v_mfma_f32_16x16x32_bf16 v[76:79], v[232:235], v[116:119], v[76:79]
    s_add_u32 s22, s19, 0x600000
    s_add_u32 m0, s20, 0x0
    s_nop 0
    buffer_load_dwordx4 v3, s[4:7], s22 offen lds
    ds_read_b64_tr_b16 v[246:247], v5 offset:33824
    s_waitcnt lgkmcnt(4)
    v_mfma_f32_16x16x32_bf16 v[80:83], v[236:239], v[112:115], v[80:83]
    ds_read_b64_tr_b16 v[224:225], v4 offset:33024
    v_mfma_f32_16x16x32_bf16 v[84:87], v[236:239], v[116:119], v[84:87]
    ds_read_b64_tr_b16 v[226:227], v4 offset:34048
    s_waitcnt lgkmcnt(4)
    v_mfma_f32_16x16x32_bf16 v[24:27], v[240:243], v[120:123], v[24:27]
    ds_read_b64_tr_b16 v[228:229], v5 offset:33056
    v_mfma_f32_16x16x32_bf16 v[28:31], v[240:243], v[124:127], v[28:31]
    ds_read_b64_tr_b16 v[230:231], v5 offset:34080
    s_waitcnt lgkmcnt(4)
    v_mfma_f32_16x16x32_bf16 v[32:35], v[244:247], v[120:123], v[32:35]
    ds_read_b64_tr_b16 v[232:233], v4 offset:33280
    v_mfma_f32_16x16x32_bf16 v[36:39], v[244:247], v[124:127], v[36:39]
    ds_read_b64_tr_b16 v[234:235], v4 offset:34304
    s_mov_b32 s23, 0x6800
    buffer_load_dwordx4 v[104:107], v7, s[8:11], s23 offen offset:0 sc1
    s_waitcnt lgkmcnt(4)
    v_mfma_f32_16x16x32_bf16 v[40:43], v[224:227], v[120:123], v[40:43]
    ds_read_b64_tr_b16 v[236:237], v5 offset:33312
    v_mfma_f32_16x16x32_bf16 v[44:47], v[224:227], v[124:127], v[44:47]
    s_add_u32 s22, s19, 0x608000
    s_add_u32 m0, s20, 0x400
    s_nop 0
    buffer_load_dwordx4 v3, s[4:7], s22 offen lds
    ds_read_b64_tr_b16 v[238:239], v5 offset:34336
    s_waitcnt lgkmcnt(4)
    v_mfma_f32_16x16x32_bf16 v[48:51], v[228:231], v[120:123], v[48:51]
    ds_read_b64_tr_b16 v[240:241], v4 offset:33536
    v_mfma_f32_16x16x32_bf16 v[52:55], v[228:231], v[124:127], v[52:55]
    ds_read_b64_tr_b16 v[242:243], v4 offset:34560
    s_waitcnt lgkmcnt(4)
    v_mfma_f32_16x16x32_bf16 v[56:59], v[232:235], v[120:123], v[56:59]
    ds_read_b64_tr_b16 v[244:245], v5 offset:33568
    v_mfma_f32_16x16x32_bf16 v[60:63], v[232:235], v[124:127], v[60:63]
    ds_read_b64_tr_b16 v[246:247], v5 offset:34592
    s_waitcnt lgkmcnt(4)
    v_mfma_f32_16x16x32_bf16 v[64:67], v[236:239], v[120:123], v[64:67]
    ds_read_b64_tr_b16 v[224:225], v4 offset:40960
    v_mfma_f32_16x16x32_bf16 v[68:71], v[236:239], v[124:127], v[68:71]
    ds_read_b64_tr_b16 v[226:227], v4 offset:41984
    s_mov_b32 s23, 0xe800
    buffer_load_dwordx4 v[108:111], v7, s[8:11], s23 offen offset:0 sc1
    s_waitcnt lgkmcnt(4)
    v_mfma_f32_16x16x32_bf16 v[72:75], v[240:243], v[120:123], v[72:75]
    ds_read_b64_tr_b16 v[228:229], v5 offset:40992
    v_mfma_f32_16x16x32_bf16 v[76:79], v[240:243], v[124:127], v[76:79]
    ds_read_b64_tr_b16 v[230:231], v5 offset:42016
    s_waitcnt lgkmcnt(4)
    v_mfma_f32_16x16x32_bf16 v[80:83], v[244:247], v[120:123], v[80:83]
    ds_read_b64_tr_b16 v[232:233], v4 offset:41216
    v_mfma_f32_16x16x32_bf16 v[84:87], v[244:247], v[124:127], v[84:87]
    ds_read_b64_tr_b16 v[234:235], v4 offset:42240
    s_waitcnt lgkmcnt(4)
    v_mfma_f32_16x16x32_bf16 v[24:27], v[224:227], v[128:131], v[24:27]
    ds_read_b64_tr_b16 v[236:237], v5 offset:41248
    s_add_u32 s22, s21, 0x0
    s_add_u32 m0, s20, 0x10000
    s_nop 0
    buffer_load_dwordx4 v2, s[8:11], s22 offen sc1 lds
    v_mfma_f32_16x16x32_bf16 v[28:31], v[224:227], v[132:135], v[28:31]
    ds_read_b64_tr_b16 v[238:239], v5 offset:42272
    s_waitcnt lgkmcnt(4)
    v_mfma_f32_16x16x32_bf16 v[32:35], v[228:231], v[128:131], v[32:35]
    ds_read_b64_tr_b16 v[240:241], v4 offset:41472
    v_mfma_f32_16x16x32_bf16 v[36:39], v[228:231], v[132:135], v[36:39]
    ds_read_b64_tr_b16 v[242:243], v4 offset:42496
    s_mov_b32 s23, 0x6800
    buffer_load_dwordx4 v[112:115], v7, s[8:11], s23 offen offset:1024 sc1
    s_waitcnt lgkmcnt(4)
    v_mfma_f32_16x16x32_bf16 v[40:43], v[232:235], v[128:131], v[40:43]
    ds_read_b64_tr_b16 v[244:245], v5 offset:41504
    s_add_u32 s22, s21, 0x400
    s_add_u32 m0, s20, 0x10400
    s_nop 0
    buffer_load_dwordx4 v2, s[8:11], s22 offen sc1 lds
    v_mfma_f32_16x16x32_bf16 v[44:47], v[232:235], v[132:135], v[44:47]
    ds_read_b64_tr_b16 v[246:247], v5 offset:42528
    s_waitcnt lgkmcnt(4)
    v_mfma_f32_16x16x32_bf16 v[48:51], v[236:239], v[128:131], v[48:51]
    ds_read_b64_tr_b16 v[224:225], v4 offset:41728
    v_mfma_f32_16x16x32_bf16 v[52:55], v[236:239], v[132:135], v[52:55]
    ds_read_b64_tr_b16 v[226:227], v4 offset:42752
    s_waitcnt lgkmcnt(4)
    v_mfma_f32_16x16x32_bf16 v[56:59], v[240:243], v[128:131], v[56:59]
    ds_read_b64_tr_b16 v[228:229], v5 offset:41760
    v_mfma_f32_16x16x32_bf16 v[60:63], v[240:243], v[132:135], v[60:63]
    ds_read_b64_tr_b16 v[230:231], v5 offset:42784
    s_waitcnt lgkmcnt(4)
    v_mfma_f32_16x16x32_bf16 v[64:67], v[244:247], v[128:131], v[64:67]
    v_mfma_f32_16x16x32_bf16 v[68:71], v[244:247], v[132:135], v[68:71]
    s_waitcnt vmcnt(11)
    s_barrier
    ds_read_b64_tr_b16 v[232:233], v4 offset:49152
    ds_read_b64_tr_b16 v[234:235], v4 offset:50176
    s_mov_b32 s23, 0xe800
    buffer_load_dwordx4 v[116:119], v7, s[8:11], s23 offen offset:1024 sc1
    s_waitcnt lgkmcnt(4)
    v_mfma_f32_16x16x32_bf16 v[72:75], v[224:227], v[128:131], v[72:75]
    ds_read_b64_tr_b16 v[236:237], v5 offset:49184
    v_mfma_f32_16x16x32_bf16 v[76:79], v[224:227], v[132:135], v[76:79]
    s_add_u32 s22, s19, 0x680000
    s_add_u32 m0, s20, 0x4000
    s_nop 0
    buffer_load_dwordx4 v3, s[4:7], s22 offen lds
    ds_read_b64_tr_b16 v[238:239], v5 offset:50208
    s_waitcnt lgkmcnt(4)
    v_mfma_f32_16x16x32_bf16 v[80:83], v[228:231], v[128:131], v[80:83]
    ds_read_b64_tr_b16 v[240:241], v4 offset:49408
    v_mfma_f32_16x16x32_bf16 v[84:87], v[228:231], v[132:135], v[84:87]
    ds_read_b64_tr_b16 v[242:243], v4 offset:50432
    s_waitcnt lgkmcnt(4)
    v_mfma_f32_16x16x32_bf16 v[24:27], v[232:235], v[136:139], v[24:27]
    ds_read_b64_tr_b16 v[244:245], v5 offset:49440
    v_mfma_f32_16x16x32_bf16 v[28:31], v[232:235], v[140:143], v[28:31]
    ds_read_b64_tr_b16 v[246:247], v5 offset:50464
    s_waitcnt lgkmcnt(4)
    v_mfma_f32_16x16x32_bf16 v[32:35], v[236:239], v[136:139], v[32:35]
    ds_read_b64_tr_b16 v[224:225], v4 offset:49664
    v_mfma_f32_16x16x32_bf16 v[36:39], v[236:239], v[140:143], v[36:39]
    ds_read_b64_tr_b16 v[226:227], v4 offset:50688
    s_mov_b32 s23, 0x7000
    buffer_load_dwordx4 v[120:123], v7, s[8:11], s23 offen offset:0 sc1
    s_waitcnt lgkmcnt(4)
    v_mfma_f32_16x16x32_bf16 v[40:43], v[240:243], v[136:139], v[40:43]
    ds_read_b64_tr_b16 v[228:229], v5 offset:49696
    v_mfma_f32_16x16x32_bf16 v[44:47], v[240:243], v[140:143], v[44:47]
    s_add_u32 s22, s19, 0x688000
    s_add_u32 m0, s20, 0x4400
    s_nop 0
    buffer_load_dwordx4 v3, s[4:7], s22 offen lds
    ds_read_b64_tr_b16 v[230:231], v5 offset:50720
    s_waitcnt lgkmcnt(4)
    v_mfma_f32_16x16x32_bf16 v[48:51], v[244:247], v[136:139], v[48:51]
    ds_read_b64_tr_b16 v[232:233], v4 offset:49920
    v_mfma_f32_16x16x32_bf16 v[52:55], v[244:247], v[140:143], v[52:55]
    ds_read_b64_tr_b16 v[234:235], v4 offset:50944
    s_waitcnt lgkmcnt(4)
    v_mfma_f32_16x16x32_bf16 v[56:59], v[224:227], v[136:139], v[56:59]
    ds_read_b64_tr_b16 v[236:237], v5 offset:49952
    v_mfma_f32_16x16x32_bf16 v[60:63], v[224:227], v[140:143], v[60:63]
    ds_read_b64_tr_b16 v[238:239], v5 offset:50976
    s_waitcnt lgkmcnt(4)
    v_mfma_f32_16x16x32_bf16 v[64:67], v[228:231], v[136:139], v[64:67]
    ds_read_b64_tr_b16 v[240:241], v4 offset:57344
    v_mfma_f32_16x16x32_bf16 v[68:71], v[228:231], v[140:143], v[68:71]
    ds_read_b64_tr_b16 v[242:243], v4 offset:58368
    s_mov_b32 s23, 0xf000
    buffer_load_dwordx4 v[124:127], v7, s[8:11], s23 offen offset:0 sc1
    s_waitcnt lgkmcnt(4)
    v_mfma_f32_16x16x32_bf16 v[72:75], v[232:235], v[136:139], v[72:75]
    ds_read_b64_tr_b16 v[244:245], v5 offset:57376
    v_mfma_f32_16x16x32_bf16 v[76:79], v[232:235], v[140:143], v[76:79]
    ds_read_b64_tr_b16 v[246:247], v5 offset:58400
    s_waitcnt lgkmcnt(4)
    v_mfma_f32_16x16x32_bf16 v[80:83], v[236:239], v[136:139], v[80:83]
    ds_read_b64_tr_b16 v[224:225], v4 offset:57600
    v_mfma_f32_16x16x32_bf16 v[84:87], v[236:239], v[140:143], v[84:87]
    ds_read_b64_tr_b16 v[226:227], v4 offset:58624
    s_waitcnt lgkmcnt(4)
    v_mfma_f32_16x16x32_bf16 v[24:27], v[240:243], v[144:147], v[24:27]
    ds_read_b64_tr_b16 v[228:229], v5 offset:57632
    s_add_u32 s22, s21, 0x4000
    s_add_u32 m0, s20, 0x14000
    s_nop 0
    buffer_load_dwordx4 v2, s[8:11], s22 offen sc1 lds
    v_mfma_f32_16x16x32_bf16 v[28:31], v[240:243], v[148:151], v[28:31]
    ds_read_b64_tr_b16 v[230:231], v5 offset:58656
    s_waitcnt lgkmcnt(4)
    v_mfma_f32_16x16x32_bf16 v[32:35], v[244:247], v[144:147], v[32:35]
    ds_read_b64_tr_b16 v[232:233], v4 offset:57856
    v_mfma_f32_16x16x32_bf16 v[36:39], v[244:247], v[148:151], v[36:39]
    ds_read_b64_tr_b16 v[234:235], v4 offset:58880
    s_mov_b32 s23, 0x7000
    buffer_load_dwordx4 v[128:131], v7, s[8:11], s23 offen offset:1024 sc1
    s_waitcnt lgkmcnt(4)
    v_mfma_f32_16x16x32_bf16 v[40:43], v[224:227], v[144:147], v[40:43]
    ds_read_b64_tr_b16 v[236:237], v5 offset:57888
    s_add_u32 s22, s21, 0x4400
    s_add_u32 m0, s20, 0x14400
    s_nop 0
    buffer_load_dwordx4 v2, s[8:11], s22 offen sc1 lds
    v_mfma_f32_16x16x32_bf16 v[44:47], v[224:227], v[148:151], v[44:47]
    ds_read_b64_tr_b16 v[238:239], v5 offset:58912
    s_waitcnt lgkmcnt(4)
    v_mfma_f32_16x16x32_bf16 v[48:51], v[228:231], v[144:147], v[48:51]
    ds_read_b64_tr_b16 v[240:241], v4 offset:58112
    v_mfma_f32_16x16x32_bf16 v[52:55], v[228:231], v[148:151], v[52:55]
    ds_read_b64_tr_b16 v[242:243], v4 offset:59136
    s_waitcnt lgkmcnt(4)
    v_mfma_f32_16x16x32_bf16 v[56:59], v[232:235], v[144:147], v[56:59]
    ds_read_b64_tr_b16 v[244:245], v5 offset:58144
    v_mfma_f32_16x16x32_bf16 v[60:63], v[232:235], v[148:151], v[60:63]
    ds_read_b64_tr_b16 v[246:247], v5 offset:59168
    s_waitcnt lgkmcnt(4)
    v_mfma_f32_16x16x32_bf16 v[64:67], v[236:239], v[144:147], v[64:67]
    v_mfma_f32_16x16x32_bf16 v[68:71], v[236:239], v[148:151], v[68:71]
    s_waitcnt vmcnt(12)
    s_barrier
    ds_read_b64_tr_b16 v[224:225], v4 offset:0
    ds_read_b64_tr_b16 v[226:227], v4 offset:1024
    s_mov_b32 s23, 0xf000
    buffer_load_dwordx4 v[132:135], v7, s[8:11], s23 offen offset:1024 sc1
    s_waitcnt lgkmcnt(4)
    v_mfma_f32_16x16x32_bf16 v[72:75], v[240:243], v[144:147], v[72:75]
    ds_read_b64_tr_b16 v[228:229], v5 offset:32
    v_mfma_f32_16x16x32_bf16 v[76:79], v[240:243], v[148:151], v[76:79]
    s_add_u32 s22, s19, 0x700000
    s_add_u32 m0, s20, 0x8000
    s_nop 0
    buffer_load_dwordx4 v3, s[4:7], s22 offen lds
    ds_read_b64_tr_b16 v[230:231], v5 offset:1056
    s_waitcnt lgkmcnt(4)
    v_mfma_f32_16x16x32_bf16 v[80:83], v[244:247], v[144:147], v[80:83]
    ds_read_b64_tr_b16 v[232:233], v4 offset:256
    v_mfma_f32_16x16x32_bf16 v[84:87], v[244:247], v[148:151], v[84:87]
    ds_read_b64_tr_b16 v[234:235], v4 offset:1280
    s_waitcnt lgkmcnt(4)
    v_mfma_f32_16x16x32_bf16 v[24:27], v[224:227], v[88:91], v[24:27]
    ds_read_b64_tr_b16 v[236:237], v5 offset:288
    v_mfma_f32_16x16x32_bf16 v[28:31], v[224:227], v[92:95], v[28:31]
    ds_read_b64_tr_b16 v[238:239], v5 offset:1312
    s_waitcnt lgkmcnt(4)
    v_mfma_f32_16x16x32_bf16 v[32:35], v[228:231], v[88:91], v[32:35]
    ds_read_b64_tr_b16 v[240:241], v4 offset:512
    v_mfma_f32_16x16x32_bf16 v[36:39], v[228:231], v[92:95], v[36:39]
    ds_read_b64_tr_b16 v[242:243], v4 offset:1536
    s_mov_b32 s23, 0x7800
    buffer_load_dwordx4 v[136:139], v7, s[8:11], s23 offen offset:0 sc1
    s_waitcnt lgkmcnt(4)
    v_mfma_f32_16x16x32_bf16 v[40:43], v[232:235], v[88:91], v[40:43]
    ds_read_b64_tr_b16 v[244:245], v5 offset:544
    v_mfma_f32_16x16x32_bf16 v[44:47], v[232:235], v[92:95], v[44:47]
    s_add_u32 s22, s19, 0x708000
    s_add_u32 m0, s20, 0x8400
    s_nop 0
    buffer_load_dwordx4 v3, s[4:7], s22 offen lds
    ds_read_b64_tr_b16 v[246:247], v5 offset:1568
    s_waitcnt lgkmcnt(4)
    v_mfma_f32_16x16x32_bf16 v[48:51], v[236:239], v[88:91], v[48:51]
    ds_read_b64_tr_b16 v[224:225], v4 offset:768
    v_mfma_f32_16x16x32_bf16 v[52:55], v[236:239], v[92:95], v[52:55]
    ds_read_b64_tr_b16 v[226:227], v4 offset:1792
    s_waitcnt lgkmcnt(4)
    v_mfma_f32_16x16x32_bf16 v[56:59], v[240:243], v[88:91], v[56:59]
    ds_read_b64_tr_b16 v[228:229], v5 offset:800
    v_mfma_f32_16x16x32_bf16 v[60:63], v[240:243], v[92:95], v[60:63]
    ds_read_b64_tr_b16 v[230:231], v5 offset:1824
    s_waitcnt lgkmcnt(4)
    v_mfma_f32_16x16x32_bf16 v[64:67], v[244:247], v[88:91], v[64:67]
    ds_read_b64_tr_b16 v[232:233], v4 offset:8192
    v_mfma_f32_16x16x32_bf16 v[68:71], v[244:247], v[92:95], v[68:71]
    ds_read_b64_tr_b16 v[234:235], v4 offset:9216
    s_mov_b32 s23, 0xf800
    buffer_load_dwordx4 v[140:143], v7, s[8:11], s23 offen offset:0 sc1
    s_waitcnt lgkmcnt(4)
    v_mfma_f32_16x16x32_bf16 v[72:75], v[224:227], v[88:91], v[72:75]
    ds_read_b64_tr_b16 v[236:237], v5 offset:8224
    v_mfma_f32_16x16x32_bf16 v[76:79], v[224:227], v[92:95], v[76:79]
    ds_read_b64_tr_b16 v[238:239], v5 offset:9248
    s_waitcnt lgkmcnt(4)
    v_mfma_f32_16x16x32_bf16 v[80:83], v[228:231], v[88:91], v[80:83]
    ds_read_b64_tr_b16 v[240:241], v4 offset:8448
    v_mfma_f32_16x16x32_bf16 v[84:87], v[228:231], v[92:95], v[84:87]
    ds_read_b64_tr_b16 v[242:243], v4 offset:9472
    s_waitcnt lgkmcnt(4)
    v_mfma_f32_16x16x32_bf16 v[24:27], v[232:235], v[96:99], v[24:27]
    ds_read_b64_tr_b16 v[244:245], v5 offset:8480
    s_add_u32 s22, s21, 0x8000
    s_add_u32 m0, s20, 0x18000
    s_nop 0
    buffer_load_dwordx4 v2, s[8:11], s22 offen sc1 lds
    v_mfma_f32_16x16x32_bf16 v[28:31], v[232:235], v[100:103], v[28:31]
    ds_read_b64_tr_b16 v[246:247], v5 offset:9504
    s_waitcnt lgkmcnt(4)
    v_mfma_f32_16x16x32_bf16 v[32:35], v[236:239], v[96:99], v[32:35]
    ds_read_b64_tr_b16 v[224:225], v4 offset:8704
    v_mfma_f32_16x16x32_bf16 v[36:39], v[236:239], v[100:103], v[36:39]
    ds_read_b64_tr_b16 v[226:227], v4 offset:9728
    s_mov_b32 s23, 0x7800
    buffer_load_dwordx4 v[144:147], v7, s[8:11], s23 offen offset:1024 sc1
    s_waitcnt lgkmcnt(4)
    v_mfma_f32_16x16x32_bf16 v[40:43], v[240:243], v[96:99], v[40:43]
    ds_read_b64_tr_b16 v[228:229], v5 offset:8736
    s_add_u32 s22, s21, 0x8400
    s_add_u32 m0, s20, 0x18400
    s_nop 0
    buffer_load_dwordx4 v2, s[8:11], s22 offen sc1 lds
    v_mfma_f32_16x16x32_bf16 v[44:47], v[240:243], v[100:103], v[44:47]
    ds_read_b64_tr_b16 v[230:231], v5 offset:9760
    s_waitcnt lgkmcnt(4)
    v_mfma_f32_16x16x32_bf16 v[48:51], v[244:247], v[96:99], v[48:51]
    ds_read_b64_tr_b16 v[232:233], v4 offset:8960
    v_mfma_f32_16x16x32_bf16 v[52:55], v[244:247], v[100:103], v[52:55]
    ds_read_b64_tr_b16 v[234:235], v4 offset:9984
    s_waitcnt lgkmcnt(4)
    v_mfma_f32_16x16x32_bf16 v[56:59], v[224:227], v[96:99], v[56:59]
    ds_read_b64_tr_b16 v[236:237], v5 offset:8992
    v_mfma_f32_16x16x32_bf16 v[60:63], v[224:227], v[100:103], v[60:63]
    ds_read_b64_tr_b16 v[238:239], v5 offset:10016
    s_waitcnt lgkmcnt(4)
    v_mfma_f32_16x16x32_bf16 v[64:67], v[228:231], v[96:99], v[64:67]
    v_mfma_f32_16x16x32_bf16 v[68:71], v[228:231], v[100:103], v[68:71]
    s_waitcnt vmcnt(12)
    s_barrier
    ds_read_b64_tr_b16 v[240:241], v4 offset:16384
    ds_read_b64_tr_b16 v[242:243], v4 offset:17408
    s_mov_b32 s23, 0xf800
    buffer_load_dwordx4 v[148:151], v7, s[8:11], s23 offen offset:1024 sc1
    s_waitcnt lgkmcnt(4)
    v_mfma_f32_16x16x32_bf16 v[72:75], v[232:235], v[96:99], v[72:75]
    ds_read_b64_tr_b16 v[244:245], v5 offset:16416
    v_mfma_f32_16x16x32_bf16 v[76:79], v[232:235], v[100:103], v[76:79]
    s_add_u32 s22, s19, 0x780000
    s_add_u32 m0, s20, 0xc000
    s_nop 0
    buffer_load_dwordx4 v3, s[4:7], s22 offen lds
    ds_read_b64_tr_b16 v[246:247], v5 offset:17440
    s_waitcnt lgkmcnt(4)
    v_mfma_f32_16x16x32_bf16 v[80:83], v[236:239], v[96:99], v[80:83]
    ds_read_b64_tr_b16 v[224:225], v4 offset:16640
    v_mfma_f32_16x16x32_bf16 v[84:87], v[236:239], v[100:103], v[84:87]
    ds_read_b64_tr_b16 v[226:227], v4 offset:17664
    s_waitcnt lgkmcnt(4)
    v_mfma_f32_16x16x32_bf16 v[24:27], v[240:243], v[104:107], v[24:27]
    ds_read_b64_tr_b16 v[228:229], v5 offset:16672
    v_mfma_f32_16x16x32_bf16 v[28:31], v[240:243], v[108:111], v[28:31]
    ds_read_b64_tr_b16 v[230:231], v5 offset:17696
    s_waitcnt lgkmcnt(4)
    v_mfma_f32_16x16x32_bf16 v[32:35], v[244:247], v[104:107], v[32:35]
    ds_read_b64_tr_b16 v[232:233], v4 offset:16896
    v_mfma_f32_16x16x32_bf16 v[36:39], v[244:247], v[108:111], v[36:39]
    ds_read_b64_tr_b16 v[234:235], v4 offset:17920
    s_waitcnt lgkmcnt(4)
    v_mfma_f32_16x16x32_bf16 v[40:43], v[224:227], v[104:107], v[40:43]
    ds_read_b64_tr_b16 v[236:237], v5 offset:16928
    v_mfma_f32_16x16x32_bf16 v[44:47], v[224:227], v[108:111], v[44:47]
    s_add_u32 s22, s19, 0x788000
    s_add_u32 m0, s20, 0xc400
    s_nop 0
    buffer_load_dwordx4 v3, s[4:7], s22 offen lds
    ds_read_b64_tr_b16 v[238:239], v5 offset:17952
    s_waitcnt lgkmcnt(4)
    v_mfma_f32_16x16x32_bf16 v[48:51], v[228:231], v[104:107], v[48:51]
    ds_read_b64_tr_b16 v[240:241], v4 offset:17152
    v_mfma_f32_16x16x32_bf16 v[52:55], v[228:231], v[108:111], v[52:55]
    ds_read_b64_tr_b16 v[242:243], v4 offset:18176
    s_waitcnt lgkmcnt(4)
    v_mfma_f32_16x16x32_bf16 v[56:59], v[232:235], v[104:107], v[56:59]
    ds_read_b64_tr_b16 v[244:245], v5 offset:17184
    v_mfma_f32_16x16x32_bf16 v[60:63], v[232:235], v[108:111], v[60:63]
    ds_read_b64_tr_b16 v[246:247], v5 offset:18208
    s_waitcnt lgkmcnt(4)
    v_mfma_f32_16x16x32_bf16 v[64:67], v[236:239], v[104:107], v[64:67]
    ds_read_b64_tr_b16 v[224:225], v4 offset:24576
    v_mfma_f32_16x16x32_bf16 v[68:71], v[236:239], v[108:111], v[68:71]
    ds_read_b64_tr_b16 v[226:227], v4 offset:25600
    s_waitcnt lgkmcnt(4)
    v_mfma_f32_16x16x32_bf16 v[72:75], v[240:243], v[104:107], v[72:75]
    ds_read_b64_tr_b16 v[228:229], v5 offset:24608
    v_mfma_f32_16x16x32_bf16 v[76:79], v[240:243], v[108:111], v[76:79]
    ds_read_b64_tr_b16 v[230:231], v5 offset:25632
    s_waitcnt lgkmcnt(4)
    v_mfma_f32_16x16x32_bf16 v[80:83], v[244:247], v[104:107], v[80:83]
    ds_read_b64_tr_b16 v[232:233], v4 offset:24832
    v_mfma_f32_16x16x32_bf16 v[84:87], v[244:247], v[108:111], v[84:87]
    ds_read_b64_tr_b16 v[234:235], v4 offset:25856
    s_waitcnt lgkmcnt(4)
    v_mfma_f32_16x16x32_bf16 v[24:27], v[224:227], v[112:115], v[24:27]
    ds_read_b64_tr_b16 v[236:237], v5 offset:24864
    s_add_u32 s22, s21, 0xc000
    s_add_u32 m0, s20, 0x1c000
    s_nop 0
    buffer_load_dwordx4 v2, s[8:11], s22 offen sc1 lds
    v_mfma_f32_16x16x32_bf16 v[28:31], v[224:227], v[116:119], v[28:31]
    ds_read_b64_tr_b16 v[238:239], v5 offset:25888
    s_waitcnt lgkmcnt(4)
    v_mfma_f32_16x16x32_bf16 v[32:35], v[228:231], v[112:115], v[32:35]
    ds_read_b64_tr_b16 v[240:241], v4 offset:25088
    v_mfma_f32_16x16x32_bf16 v[36:39], v[228:231], v[116:119], v[36:39]
    ds_read_b64_tr_b16 v[242:243], v4 offset:26112
    s_waitcnt lgkmcnt(4)
    v_mfma_f32_16x16x32_bf16 v[40:43], v[232:235], v[112:115], v[40:43]
    ds_read_b64_tr_b16 v[244:245], v5 offset:25120
    s_add_u32 s22, s21, 0xc400
    s_add_u32 m0, s20, 0x1c400
    s_nop 0
    buffer_load_dwordx4 v2, s[8:11], s22 offen sc1 lds
    v_mfma_f32_16x16x32_bf16 v[44:47], v[232:235], v[116:119], v[44:47]
    ds_read_b64_tr_b16 v[246:247], v5 offset:26144
    s_waitcnt lgkmcnt(4)
    v_mfma_f32_16x16x32_bf16 v[48:51], v[236:239], v[112:115], v[48:51]
    ds_read_b64_tr_b16 v[224:225], v4 offset:25344
    v_mfma_f32_16x16x32_bf16 v[52:55], v[236:239], v[116:119], v[52:55]
    ds_read_b64_tr_b16 v[226:227], v4 offset:26368
    s_waitcnt lgkmcnt(4)
    v_mfma_f32_16x16x32_bf16 v[56:59], v[240:243], v[112:115], v[56:59]
    ds_read_b64_tr_b16 v[228:229], v5 offset:25376
    v_mfma_f32_16x16x32_bf16 v[60:63], v[240:243], v[116:119], v[60:63]
    ds_read_b64_tr_b16 v[230:231], v5 offset:26400
    s_waitcnt lgkmcnt(4)
    v_mfma_f32_16x16x32_bf16 v[64:67], v[244:247], v[112:115], v[64:67]
    v_mfma_f32_16x16x32_bf16 v[68:71], v[244:247], v[116:119], v[68:71]
    s_waitcnt vmcnt(9)
    s_barrier
    ds_read_b64_tr_b16 v[232:233], v4 offset:32768
    ds_read_b64_tr_b16 v[234:235], v4 offset:33792
    s_waitcnt lgkmcnt(4)
    v_mfma_f32_16x16x32_bf16 v[72:75], v[224:227], v[112:115], v[72:75]
    ds_read_b64_tr_b16 v[236:237], v5 offset:32800
    v_mfma_f32_16x16x32_bf16 v[76:79], v[224:227], v[116:119], v[76:79]
    ds_read_b64_tr_b16 v[238:239], v5 offset:33824
    s_waitcnt lgkmcnt(4)
    v_mfma_f32_16x16x32_bf16 v[80:83], v[228:231], v[112:115], v[80:83]
    ds_read_b64_tr_b16 v[240:241], v4 offset:33024
    v_mfma_f32_16x16x32_bf16 v[84:87], v[228:231], v[116:119], v[84:87]
    ds_read_b64_tr_b16 v[242:243], v4 offset:34048
    s_waitcnt lgkmcnt(4)
    v_mfma_f32_16x16x32_bf16 v[24:27], v[232:235], v[120:123], v[24:27]
    ds_read_b64_tr_b16 v[244:245], v5 offset:33056
    v_mfma_f32_16x16x32_bf16 v[28:31], v[232:235], v[124:127], v[28:31]
    ds_read_b64_tr_b16 v[246:247], v5 offset:34080
    s_waitcnt lgkmcnt(4)
    v_mfma_f32_16x16x32_bf16 v[32:35], v[236:239], v[120:123], v[32:35]
    ds_read_b64_tr_b16 v[224:225], v4 offset:33280
    v_mfma_f32_16x16x32_bf16 v[36:39], v[236:239], v[124:127], v[36:39]
    ds_read_b64_tr_b16 v[226:227], v4 offset:34304
    s_waitcnt lgkmcnt(4)
    v_mfma_f32_16x16x32_bf16 v[40:43], v[240:243], v[120:123], v[40:43]
    ds_read_b64_tr_b16 v[228:229], v5 offset:33312
    v_mfma_f32_16x16x32_bf16 v[44:47], v[240:243], v[124:127], v[44:47]
    ds_read_b64_tr_b16 v[230:231], v5 offset:34336
    s_waitcnt lgkmcnt(4)
    v_mfma_f32_16x16x32_bf16 v[48:51], v[244:247], v[120:123], v[48:51]
    ds_read_b64_tr_b16 v[232:233], v4 offset:33536
    v_mfma_f32_16x16x32_bf16 v[52:55], v[244:247], v[124:127], v[52:55]
    ds_read_b64_tr_b16 v[234:235], v4 offset:34560
    s_waitcnt lgkmcnt(4)
    v_mfma_f32_16x16x32_bf16 v[56:59], v[224:227], v[120:123], v[56:59]
    ds_read_b64_tr_b16 v[236:237], v5 offset:33568
    v_mfma_f32_16x16x32_bf16 v[60:63], v[224:227], v[124:127], v[60:63]
    ds_read_b64_tr_b16 v[238:239], v5 offset:34592
    s_waitcnt lgkmcnt(4)
    v_mfma_f32_16x16x32_bf16 v[64:67], v[228:231], v[120:123], v[64:67]
    ds_read_b64_tr_b16 v[240:241], v4 offset:40960
    v_mfma_f32_16x16x32_bf16 v[68:71], v[228:231], v[124:127], v[68:71]
    ds_read_b64_tr_b16 v[242:243], v4 offset:41984
    s_waitcnt lgkmcnt(4)
    v_mfma_f32_16x16x32_bf16 v[72:75], v[232:235], v[120:123], v[72:75]
    ds_read_b64_tr_b16 v[244:245], v5 offset:40992
    v_mfma_f32_16x16x32_bf16 v[76:79], v[232:235], v[124:127], v[76:79]
    ds_read_b64_tr_b16 v[246:247], v5 offset:42016
    s_waitcnt lgkmcnt(4)
    v_mfma_f32_16x16x32_bf16 v[80:83], v[236:239], v[120:123], v[80:83]
    ds_read_b64_tr_b16 v[224:225], v4 offset:41216
    v_mfma_f32_16x16x32_bf16 v[84:87], v[236:239], v[124:127], v[84:87]
    ds_read_b64_tr_b16 v[226:227], v4 offset:42240
    s_waitcnt lgkmcnt(4)
    v_mfma_f32_16x16x32_bf16 v[24:27], v[240:243], v[128:131], v[24:27]
    ds_read_b64_tr_b16 v[228:229], v5 offset:41248
    v_mfma_f32_16x16x32_bf16 v[28:31], v[240:243], v[132:135], v[28:31]
    ds_read_b64_tr_b16 v[230:231], v5 offset:42272
    s_waitcnt lgkmcnt(4)
    v_mfma_f32_16x16x32_bf16 v[32:35], v[244:247], v[128:131], v[32:35]
    ds_read_b64_tr_b16 v[232:233], v4 offset:41472
    v_mfma_f32_16x16x32_bf16 v[36:39], v[244:247], v[132:135], v[36:39]
    ds_read_b64_tr_b16 v[234:235], v4 offset:42496
    s_waitcnt lgkmcnt(4)
    v_mfma_f32_16x16x32_bf16 v[40:43], v[224:227], v[128:131], v[40:43]
    ds_read_b64_tr_b16 v[236:237], v5 offset:41504
    v_mfma_f32_16x16x32_bf16 v[44:47], v[224:227], v[132:135], v[44:47]
    ds_read_b64_tr_b16 v[238:239], v5 offset:42528
    s_waitcnt lgkmcnt(4)
    v_mfma_f32_16x16x32_bf16 v[48:51], v[228:231], v[128:131], v[48:51]
    ds_read_b64_tr_b16 v[240:241], v4 offset:41728
    v_mfma_f32_16x16x32_bf16 v[52:55], v[228:231], v[132:135], v[52:55]
    ds_read_b64_tr_b16 v[242:243], v4 offset:42752
    s_waitcnt lgkmcnt(4)
    v_mfma_f32_16x16x32_bf16 v[56:59], v[232:235], v[128:131], v[56:59]
    ds_read_b64_tr_b16 v[244:245], v5 offset:41760
    v_mfma_f32_16x16x32_bf16 v[60:63], v[232:235], v[132:135], v[60:63]
    ds_read_b64_tr_b16 v[246:247], v5 offset:42784
    s_waitcnt lgkmcnt(4)
    v_mfma_f32_16x16x32_bf16 v[64:67], v[236:239], v[128:131], v[64:67]
    v_mfma_f32_16x16x32_bf16 v[68:71], v[236:239], v[132:135], v[68:71]
    s_waitcnt vmcnt(2)
    s_barrier
    ds_read_b64_tr_b16 v[224:225], v4 offset:49152
    ds_read_b64_tr_b16 v[226:227], v4 offset:50176
    s_waitcnt lgkmcnt(4)
    v_mfma_f32_16x16x32_bf16 v[72:75], v[240:243], v[128:131], v[72:75]
    ds_read_b64_tr_b16 v[228:229], v5 offset:49184
    v_mfma_f32_16x16x32_bf16 v[76:79], v[240:243], v[132:135], v[76:79]
    ds_read_b64_tr_b16 v[230:231], v5 offset:50208
    s_waitcnt lgkmcnt(4)
    v_mfma_f32_16x16x32_bf16 v[80:83], v[244:247], v[128:131], v[80:83]
    ds_read_b64_tr_b16 v[232:233], v4 offset:49408
    v_mfma_f32_16x16x32_bf16 v[84:87], v[244:247], v[132:135], v[84:87]
    ds_read_b64_tr_b16 v[234:235], v4 offset:50432
    s_waitcnt lgkmcnt(4)
    v_mfma_f32_16x16x32_bf16 v[24:27], v[224:227], v[136:139], v[24:27]
    ds_read_b64_tr_b16 v[236:237], v5 offset:49440
    v_mfma_f32_16x16x32_bf16 v[28:31], v[224:227], v[140:143], v[28:31]
    ds_read_b64_tr_b16 v[238:239], v5 offset:50464
    s_waitcnt lgkmcnt(4)
    v_mfma_f32_16x16x32_bf16 v[32:35], v[228:231], v[136:139], v[32:35]
    ds_read_b64_tr_b16 v[240:241], v4 offset:49664
    v_mfma_f32_16x16x32_bf16 v[36:39], v[228:231], v[140:143], v[36:39]
    ds_read_b64_tr_b16 v[242:243], v4 offset:50688
    s_waitcnt lgkmcnt(4)
    v_mfma_f32_16x16x32_bf16 v[40:43], v[232:235], v[136:139], v[40:43]
    ds_read_b64_tr_b16 v[244:245], v5 offset:49696
    v_mfma_f32_16x16x32_bf16 v[44:47], v[232:235], v[140:143], v[44:47]
    ds_read_b64_tr_b16 v[246:247], v5 offset:50720
    s_waitcnt lgkmcnt(4)
    v_mfma_f32_16x16x32_bf16 v[48:51], v[236:239], v[136:139], v[48:51]
    ds_read_b64_tr_b16 v[224:225], v4 offset:49920
    v_mfma_f32_16x16x32_bf16 v[52:55], v[236:239], v[140:143], v[52:55]
    ds_read_b64_tr_b16 v[226:227], v4 offset:50944
    s_waitcnt lgkmcnt(4)
    v_mfma_f32_16x16x32_bf16 v[56:59], v[240:243], v[136:139], v[56:59]
    ds_read_b64_tr_b16 v[228:229], v5 offset:49952
    v_mfma_f32_16x16x32_bf16 v[60:63], v[240:243], v[140:143], v[60:63]
    ds_read_b64_tr_b16 v[230:231], v5 offset:50976
    s_waitcnt lgkmcnt(4)
    v_mfma_f32_16x16x32_bf16 v[64:67], v[244:247], v[136:139], v[64:67]
    ds_read_b64_tr_b16 v[232:233], v4 offset:57344
    v_mfma_f32_16x16x32_bf16 v[68:71], v[244:247], v[140:143], v[68:71]
    ds_read_b64_tr_b16 v[234:235], v4 offset:58368
    s_waitcnt lgkmcnt(4)
    v_mfma_f32_16x16x32_bf16 v[72:75], v[224:227], v[136:139], v[72:75]
    ds_read_b64_tr_b16 v[236:237], v5 offset:57376
    v_mfma_f32_16x16x32_bf16 v[76:79], v[224:227], v[140:143], v[76:79]
    ds_read_b64_tr_b16 v[238:239], v5 offset:58400
    s_waitcnt lgkmcnt(4)
    v_mfma_f32_16x16x32_bf16 v[80:83], v[228:231], v[136:139], v[80:83]
    ds_read_b64_tr_b16 v[240:241], v4 offset:57600
    v_mfma_f32_16x16x32_bf16 v[84:87], v[228:231], v[140:143], v[84:87]
    ds_read_b64_tr_b16 v[242:243], v4 offset:58624
    s_waitcnt lgkmcnt(4)
    v_mfma_f32_16x16x32_bf16 v[24:27], v[232:235], v[144:147], v[24:27]
    ds_read_b64_tr_b16 v[244:245], v5 offset:57632
    v_mfma_f32_16x16x32_bf16 v[28:31], v[232:235], v[148:151], v[28:31]
    ds_read_b64_tr_b16 v[246:247], v5 offset:58656
    s_waitcnt lgkmcnt(4)
    v_mfma_f32_16x16x32_bf16 v[32:35], v[236:239], v[144:147], v[32:35]
    ds_read_b64_tr_b16 v[224:225], v4 offset:57856
    v_mfma_f32_16x16x32_bf16 v[36:39], v[236:239], v[148:151], v[36:39]
    ds_read_b64_tr_b16 v[226:227], v4 offset:58880
    s_waitcnt lgkmcnt(4)
    v_mfma_f32_16x16x32_bf16 v[40:43], v[240:243], v[144:147], v[40:43]
    ds_read_b64_tr_b16 v[228:229], v5 offset:57888
    v_mfma_f32_16x16x32_bf16 v[44:47], v[240:243], v[148:151], v[44:47]
    ds_read_b64_tr_b16 v[230:231], v5 offset:58912
    s_waitcnt lgkmcnt(4)
    v_mfma_f32_16x16x32_bf16 v[48:51], v[244:247], v[144:147], v[48:51]
    ds_read_b64_tr_b16 v[232:233], v4 offset:58112
    v_mfma_f32_16x16x32_bf16 v[52:55], v[244:247], v[148:151], v[52:55]
    ds_read_b64_tr_b16 v[234:235], v4 offset:59136
    s_waitcnt lgkmcnt(4)
    v_mfma_f32_16x16x32_bf16 v[56:59], v[224:227], v[144:147], v[56:59]
    ds_read_b64_tr_b16 v[236:237], v5 offset:58144
    v_mfma_f32_16x16x32_bf16 v[60:63], v[224:227], v[148:151], v[60:63]
    ds_read_b64_tr_b16 v[238:239], v5 offset:59168
    s_waitcnt lgkmcnt(4)
    v_mfma_f32_16x16x32_bf16 v[64:67], v[228:231], v[144:147], v[64:67]
    v_mfma_f32_16x16x32_bf16 v[68:71], v[228:231], v[148:151], v[68:71]
    s_waitcnt lgkmcnt(2)
    v_mfma_f32_16x16x32_bf16 v[72:75], v[232:235], v[144:147], v[72:75]
    v_mfma_f32_16x16x32_bf16 v[76:79], v[232:235], v[148:151], v[76:79]
    s_waitcnt lgkmcnt(0)
    v_mfma_f32_16x16x32_bf16 v[80:83], v[236:239], v[144:147], v[80:83]
    v_mfma_f32_16x16x32_bf16 v[84:87], v[236:239], v[148:151], v[84:87]
    s_mov_b32 s23, 0x3e0293ee
    v_mul_f32 v24, s23, v24
    v_mul_f32 v25, s23, v25
    v_mul_f32 v26, s23, v26
    v_mul_f32 v27, s23, v27
    v_mul_f32 v28, s23, v28
    v_mul_f32 v29, s23, v29
    v_mul_f32 v30, s23, v30
    v_mul_f32 v31, s23, v31
    v_mul_f32 v32, s23, v32
    v_mul_f32 v33, s23, v33
    v_mul_f32 v34, s23, v34
    v_mul_f32 v35, s23, v35
    v_mul_f32 v36, s23, v36
    v_mul_f32 v37, s23, v37
    v_mul_f32 v38, s23, v38
    v_mul_f32 v39, s23, v39
    v_cvt_pk_bf16_f32 v152, v24, v25
    v_cvt_pk_bf16_f32 v153, v26, v27
    v_cvt_pk_bf16_f32 v168, v28, v29
    v_cvt_pk_bf16_f32 v169, v30, v31
    v_cvt_pk_bf16_f32 v154, v32, v33
    v_cvt_pk_bf16_f32 v155, v34, v35
    v_cvt_pk_bf16_f32 v170, v36, v37
    v_cvt_pk_bf16_f32 v171, v38, v39
    v_add_u32 v4, 0x10000, v2
    v_add_u32 v5, 0x20000, v2
    s_barrier
    ds_read_b128 v[224:227], v4 offset:0
    ds_read_b128 v[228:231], v4 offset:1024
    ds_read_b128 v[232:235], v4 offset:2048
    ds_read_b128 v[236:239], v4 offset:3072
    v_mov_b32 v12, 0x3f803f80
    v_mov_b32 v13, 0x3f803f80
    v_mov_b32 v14, 0x3f803f80
    v_mov_b32 v15, 0x3f803f80
    s_waitcnt lgkmcnt(3)
    v_mfma_f32_16x16x32_bf16 v[184:187], v[224:227], v[152:155], 0
    v_mul_f32 v40, s23, v40
    v_mul_f32 v41, s23, v41
    v_mul_f32 v42, s23, v42
    v_mul_f32 v43, s23, v43
    v_mul_f32 v44, s23, v44
    v_mul_f32 v45, s23, v45
    v_mfma_f32_16x16x32_bf16 v[188:191], v[224:227], v[168:171], 0
    ds_read_b128 v[240:243], v4 offset:4096
    v_mul_f32 v46, s23, v46
    v_mul_f32 v47, s23, v47
    v_mul_f32 v48, s23, v48
    v_mul_f32 v49, s23, v49
    v_mul_f32 v50, s23, v50
    v_mul_f32 v51, s23, v51
    s_and_b32 s29, s2, 7
    s_mul_i32 s29, s29, 28
    s_lshr_b32 s16, s2, 3
    s_add_u32 s29, s29, s16
    s_waitcnt lgkmcnt(3)
    v_mfma_f32_16x16x32_bf16 v[192:195], v[228:231], v[152:155], 0
    s_add_u32 s22, s21, 0x10000
    s_add_u32 m0, s20, 0x20000
    s_nop 0
    buffer_load_dwordx4 v2, s[8:11], s22 offen sc1 lds
    v_mul_f32 v52, s23, v52
    v_mul_f32 v53, s23, v53
    v_mul_f32 v54, s23, v54
    v_mul_f32 v55, s23, v55
    v_cvt_pk_bf16_f32 v156, v40, v41
    v_cvt_pk_bf16_f32 v157, v42, v43
    s_mov_b64 s[76:77], s[54:55]
    s_mov_b32 s78, 0xc00000
    s_mov_b32 s79, 0x20000
    v_bfe_u32 v20, v1, 2, 2
    v_lshlrev_b32 v20, 12, v20
    v_add_u32 v6, v3, v20
    s_lshr_b32 s16, s2, 5
    s_lshl_b32 s16, s16, 7
    s_lshl_b32 s17, s3, 3
    s_add_u32 s16, s16, s17
    s_mul_i32 s14, s16, 12288
    s_and_b32 s16, s2, 31
    s_lshl_b32 s16, s16, 8
    s_add_u32 s14, s14, s16
    s_add_u32 s14, s14, 4096
    v_mfma_f32_16x16x32_bf16 v[196:199], v[228:231], v[168:171], 0
    ds_read_b128 v[244:247], v4 offset:5120
    v_cvt_pk_bf16_f32 v172, v44, v45
    v_cvt_pk_bf16_f32 v173, v46, v47
    v_cvt_pk_bf16_f32 v158, v48, v49
    v_cvt_pk_bf16_f32 v159, v50, v51
    v_cvt_pk_bf16_f32 v174, v52, v53
    v_cvt_pk_bf16_f32 v175, v54, v55
    s_waitcnt lgkmcnt(3)
    v_mfma_f32_16x16x32_bf16 v[184:187], v[232:235], v[156:159], v[184:187]
    v_mul_f32 v56, s23, v56
    v_mul_f32 v57, s23, v57
    v_mul_f32 v58, s23, v58
    v_mul_f32 v59, s23, v59
    v_mul_f32 v60, s23, v60
    v_mul_f32 v61, s23, v61
    v_mfma_f32_16x16x32_bf16 v[188:191], v[232:235], v[172:175], v[188:191]
    ds_read_b128 v[224:227], v4 offset:6144
    v_mul_f32 v62, s23, v62
    v_mul_f32 v63, s23, v63
    v_mul_f32 v64, s23, v64
    v_mul_f32 v65, s23, v65
    v_mul_f32 v66, s23, v66
    v_mul_f32 v67, s23, v67
    s_waitcnt lgkmcnt(3)
    v_mfma_f32_16x16x32_bf16 v[192:195], v[236:239], v[156:159], v[192:195]
    v_mul_f32 v68, s23, v68
    v_mul_f32 v69, s23, v69
    v_mul_f32 v70, s23, v70
    v_mul_f32 v71, s23, v71
    v_cvt_pk_bf16_f32 v160, v56, v57
    v_cvt_pk_bf16_f32 v161, v58, v59
    v_mfma_f32_16x16x32_bf16 v[196:199], v[236:239], v[172:175], v[196:199]
    ds_read_b128 v[228:231], v4 offset:7168
    v_cvt_pk_bf16_f32 v176, v60, v61
    v_cvt_pk_bf16_f32 v177, v62, v63
    v_cvt_pk_bf16_f32 v162, v64, v65
    v_cvt_pk_bf16_f32 v163, v66, v67
    v_cvt_pk_bf16_f32 v178, v68, v69
    v_cvt_pk_bf16_f32 v179, v70, v71
    s_waitcnt lgkmcnt(3)
    v_mfma_f32_16x16x32_bf16 v[184:187], v[240:243], v[160:163], v[184:187]
    v_mul_f32 v72, s23, v72
    v_mul_f32 v73, s23, v73
    v_mul_f32 v74, s23, v74
    v_mul_f32 v75, s23, v75
    v_mul_f32 v76, s23, v76
    v_mul_f32 v77, s23, v77
    v_mfma_f32_16x16x32_bf16 v[188:191], v[240:243], v[176:179], v[188:191]
    ds_read_b128 v[232:235], v4 offset:8192
    v_mul_f32 v78, s23, v78
    v_mul_f32 v79, s23, v79
    v_mul_f32 v80, s23, v80
    v_mul_f32 v81, s23, v81
    v_mul_f32 v82, s23, v82
    v_mul_f32 v83, s23, v83
    s_waitcnt lgkmcnt(3)
    v_mfma_f32_16x16x32_bf16 v[192:195], v[244:247], v[160:163], v[192:195]
    s_add_u32 s22, s21, 0x10400
    s_add_u32 m0, s20, 0x20400
    s_nop 0
    buffer_load_dwordx4 v2, s[8:11], s22 offen sc1 lds
    v_mul_f32 v84, s23, v84
    v_mul_f32 v85, s23, v85
    v_mul_f32 v86, s23, v86
    v_mul_f32 v87, s23, v87
    v_cvt_pk_bf16_f32 v164, v72, v73
    v_cvt_pk_bf16_f32 v165, v74, v75
    v_mfma_f32_16x16x32_bf16 v[196:199], v[244:247], v[176:179], v[196:199]
    ds_read_b128 v[236:239], v4 offset:9216
    v_cvt_pk_bf16_f32 v180, v76, v77
    v_cvt_pk_bf16_f32 v181, v78, v79
    v_cvt_pk_bf16_f32 v166, v80, v81
    v_cvt_pk_bf16_f32 v167, v82, v83
    v_cvt_pk_bf16_f32 v182, v84, v85
    v_cvt_pk_bf16_f32 v183, v86, v87
    s_waitcnt lgkmcnt(3)
    v_mfma_f32_16x16x32_bf16 v[184:187], v[224:227], v[164:167], v[184:187]
    v_mfma_f32_16x16x32_bf16 v[188:191], v[224:227], v[180:183], v[188:191]
    ds_read_b128 v[240:243], v4 offset:10240
    s_waitcnt lgkmcnt(3)
    v_mfma_f32_16x16x32_bf16 v[192:195], v[228:231], v[164:167], v[192:195]
    v_mfma_f32_16x16x32_bf16 v[196:199], v[228:231], v[180:183], v[196:199]
    ds_read_b128 v[244:247], v4 offset:11264
    s_waitcnt lgkmcnt(3)
    v_mfma_f32_16x16x32_bf16 v[200:203], v[232:235], v[152:155], 0
    v_mfma_f32_16x16x32_bf16 v[204:207], v[232:235], v[168:171], 0
    ds_read_b128 v[224:227], v4 offset:12288
    s_waitcnt lgkmcnt(3)
    v_mfma_f32_16x16x32_bf16 v[208:211], v[236:239], v[152:155], 0
    v_mfma_f32_16x16x32_bf16 v[212:215], v[236:239], v[168:171], 0
    ds_read_b128 v[228:231], v4 offset:13312
    s_waitcnt lgkmcnt(3)
    v_mfma_f32_16x16x32_bf16 v[200:203], v[240:243], v[156:159], v[200:203]
    v_mfma_f32_16x16x32_bf16 v[204:207], v[240:243], v[172:175], v[204:207]
    ds_read_b128 v[232:235], v4 offset:14336
    s_waitcnt lgkmcnt(3)
    v_mfma_f32_16x16x32_bf16 v[208:211], v[244:247], v[156:159], v[208:211]
    v_max3_f32 v16, v184, v185, v186
    v_mfma_f32_16x16x32_bf16 v[212:215], v[244:247], v[172:175], v[212:215]
    ds_read_b128 v[236:239], v4 offset:15360
    v_max3_f32 v16, v16, v187, v192
    s_waitcnt lgkmcnt(3)
    v_mfma_f32_16x16x32_bf16 v[200:203], v[224:227], v[160:163], v[200:203]
    v_max3_f32 v16, v16, v193, v194
    v_mfma_f32_16x16x32_bf16 v[204:207], v[224:227], v[176:179], v[204:207]
    s_barrier
    ds_read_b128 v[240:243], v4 offset:16384
    v_max_f32 v16, v16, v195
    s_waitcnt lgkmcnt(3)
    v_mfma_f32_16x16x32_bf16 v[208:211], v[228:231], v[160:163], v[208:211]
    v_max3_f32 v17, v188, v189, v190
    v_mfma_f32_16x16x32_bf16 v[212:215], v[228:231], v[176:179], v[212:215]
    s_add_u32 s22, s21, 0x14000
    s_add_u32 m0, s20, 0x24000
    s_nop 0
    buffer_load_dwordx4 v2, s[8:11], s22 offen sc1 lds
    ds_read_b128 v[244:247], v4 offset:17408
    v_max3_f32 v17, v17, v191, v196
    s_waitcnt lgkmcnt(3)
    v_mfma_f32_16x16x32_bf16 v[200:203], v[232:235], v[164:167], v[200:203]
    v_max3_f32 v17, v17, v197, v198
    v_mfma_f32_16x16x32_bf16 v[204:207], v[232:235], v[180:183], v[204:207]
    ds_read_b128 v[224:227], v4 offset:18432
    v_max_f32 v17, v17, v199
    s_waitcnt lgkmcnt(3)
    v_mfma_f32_16x16x32_bf16 v[208:211], v[236:239], v[164:167], v[208:211]
    v_mfma_f32_16x16x32_bf16 v[212:215], v[236:239], v[180:183], v[212:215]
    ds_read_b128 v[228:231], v4 offset:19456
    v_max3_f32 v16, v16, v200, v201
    v_max3_f32 v16, v16, v202, v203
    s_nop 3
    v_max3_f32 v16, v16, v208, v209
    v_max3_f32 v16, v16, v210, v211
    v_max3_f32 v17, v17, v204, v205
    v_max3_f32 v17, v17, v206, v207
    v_max3_f32 v17, v17, v212, v213
    v_max3_f32 v17, v17, v214, v215
    v_mov_b32 v18, v16
    v_mov_b32 v19, v17
    s_nop 0
    v_permlane16_swap_b32 v16, v18
    v_permlane16_swap_b32 v17, v19
    v_max_f32 v16, v16, v18
    v_max_f32 v17, v17, v19
    v_mov_b32 v18, v16
    v_mov_b32 v19, v17
    s_nop 0
    v_permlane32_swap_b32 v16, v18
    v_permlane32_swap_b32 v17, v19
    v_max_f32 v16, v16, v18
    v_max_f32 v17, v17, v19
    v_sub_f32 v216, 0, v16
    v_sub_f32 v217, 0, v16
    v_sub_f32 v218, 0, v16
    v_sub_f32 v219, 0, v16
    v_sub_f32 v220, 0, v17
    v_sub_f32 v221, 0, v17
    v_sub_f32 v222, 0, v17
    v_sub_f32 v223, 0, v17
    v_add_f32 v184, v184, v216
    v_add_f32 v185, v185, v216
    v_exp_f32 v184, v184
    v_exp_f32 v185, v185
    v_add_f32 v186, v186, v216
    v_add_f32 v187, v187, v216
    v_exp_f32 v186, v186
    v_exp_f32 v187, v187
    v_cvt_pk_bf16_f32 v24, v184, v185
    v_add_f32 v188, v188, v220
    v_add_f32 v189, v189, v220
    v_exp_f32 v188, v188
    v_exp_f32 v189, v189
    v_cvt_pk_bf16_f32 v25, v186, v187
    v_add_f32 v190, v190, v220
    v_add_f32 v191, v191, v220
    v_exp_f32 v190, v190
    v_exp_f32 v191, v191
    v_cvt_pk_bf16_f32 v28, v188, v189
    v_add_f32 v192, v192, v216
    v_add_f32 v193, v193, v216
    v_exp_f32 v192, v192
    v_exp_f32 v193, v193
    v_cvt_pk_bf16_f32 v29, v190, v191
    v_add_f32 v194, v194, v216
    v_add_f32 v195, v195, v216
    v_exp_f32 v194, v194
    v_exp_f32 v195, v195
    v_cvt_pk_bf16_f32 v26, v192, v193
    v_add_f32 v196, v196, v220
    v_add_f32 v197, v197, v220
    v_exp_f32 v196, v196
    v_exp_f32 v197, v197
    v_cvt_pk_bf16_f32 v27, v194, v195
    v_add_f32 v198, v198, v220
    v_add_f32 v199, v199, v220
    v_exp_f32 v198, v198
    v_exp_f32 v199, v199
    v_cvt_pk_bf16_f32 v30, v196, v197
    v_cvt_pk_bf16_f32 v31, v198, v199
    s_waitcnt lgkmcnt(3)
    v_mfma_f32_16x16x32_bf16 v[184:187], v[240:243], v[152:155], v[216:219]
    v_mfma_f32_16x16x32_bf16 v[188:191], v[240:243], v[168:171], v[220:223]
    ds_read_b128 v[232:235], v4 offset:20480
    v_add_f32 v200, v200, v216
    v_add_f32 v201, v201, v216
    v_exp_f32 v200, v200
    v_mfma_f32_16x16x32_bf16 v[248:251], v[12:15], v[24:27], 0
    s_waitcnt lgkmcnt(3)
    v_mfma_f32_16x16x32_bf16 v[192:195], v[244:247], v[152:155], v[216:219]
    v_exp_f32 v201, v201
    v_add_f32 v202, v202, v216
    v_add_f32 v203, v203, v216
    v_mfma_f32_16x16x32_bf16 v[196:199], v[244:247], v[168:171], v[220:223]
    s_add_u32 s22, s21, 0x14400
    s_add_u32 m0, s20, 0x24400
    s_nop 0
    buffer_load_dwordx4 v2, s[8:11], s22 offen sc1 lds
    ds_read_b128 v[236:239], v4 offset:21504
    v_exp_f32 v202, v202
    v_exp_f32 v203, v203
    v_mfma_f32_16x16x32_bf16 v[252:255], v[12:15], v[28:31], 0
    s_waitcnt lgkmcnt(3)
    v_mfma_f32_16x16x32_bf16 v[184:187], v[224:227], v[156:159], v[184:187]
    v_cvt_pk_bf16_f32 v32, v200, v201
    v_add_f32 v204, v204, v220
    v_add_f32 v205, v205, v220
    v_mfma_f32_16x16x32_bf16 v[188:191], v[224:227], v[172:175], v[188:191]
    ds_read_b128 v[240:243], v4 offset:22528
    v_exp_f32 v204, v204
    v_exp_f32 v205, v205
    v_cvt_pk_bf16_f32 v33, v202, v203
    s_mov_b64 s[4:5], s[40:41]
    s_mov_b32 s6, 0x800000
    s_mov_b32 s7, 0x20000
    v_bfe_u32 v20, v1, 2, 2
    v_lshlrev_b32 v21, 13, v20
    v_sub_u32 v3, v3, v21
    v_lshl_add_u32 v3, v20, 11, v3
    s_and_b32 s16, s2, 1
    s_lshl_b32 s24, s16, 22
    s_lshr_b32 s16, s2, 5
    s_lshl_b32 s16, s16, 8
    s_add_u32 s24, s24, s16
    s_lshl_b32 s16, s3, 14
    s_add_u32 s24, s24, s16
    s_waitcnt lgkmcnt(3)
    v_mfma_f32_16x16x32_bf16 v[192:195], v[228:231], v[156:159], v[192:195]
    v_add_f32 v206, v206, v220
    v_add_f32 v207, v207, v220
    v_mfma_f32_16x16x32_bf16 v[196:199], v[228:231], v[172:175], v[196:199]
    ds_read_b128 v[244:247], v4 offset:23552
    v_exp_f32 v206, v206
    v_exp_f32 v207, v207
    v_cvt_pk_bf16_f32 v36, v204, v205
    s_waitcnt lgkmcnt(3)
    v_mfma_f32_16x16x32_bf16 v[184:187], v[232:235], v[160:163], v[184:187]
    v_add_f32 v208, v208, v216
    v_add_f32 v209, v209, v216
    v_exp_f32 v208, v208
    v_mfma_f32_16x16x32_bf16 v[188:191], v[232:235], v[176:179], v[188:191]
    ds_read_b128 v[224:227], v4 offset:24576
    v_exp_f32 v209, v209
    v_cvt_pk_bf16_f32 v37, v206, v207
    s_waitcnt lgkmcnt(3)
    v_mfma_f32_16x16x32_bf16 v[192:195], v[236:239], v[160:163], v[192:195]
    v_add_f32 v210, v210, v216
    v_add_f32 v211, v211, v216
    v_exp_f32 v210, v210
    v_mfma_f32_16x16x32_bf16 v[196:199], v[236:239], v[176:179], v[196:199]
    ds_read_b128 v[228:231], v4 offset:25600
    v_exp_f32 v211, v211
    v_cvt_pk_bf16_f32 v34, v208, v209
    v_add_f32 v212, v212, v220
    s_waitcnt lgkmcnt(3)
    v_mfma_f32_16x16x32_bf16 v[184:187], v[240:243], v[164:167], v[184:187]
    v_add_f32 v213, v213, v220
    v_exp_f32 v212, v212
    v_mfma_f32_16x16x32_bf16 v[188:191], v[240:243], v[180:183], v[188:191]
    ds_read_b128 v[232:235], v4 offset:26624
    v_exp_f32 v213, v213
    v_cvt_pk_bf16_f32 v35, v210, v211
    v_add_f32 v214, v214, v220
    s_waitcnt lgkmcnt(3)
    v_mfma_f32_16x16x32_bf16 v[192:195], v[244:247], v[164:167], v[192:195]
    v_add_f32 v215, v215, v220
    v_exp_f32 v214, v214
    v_exp_f32 v215, v215
    v_mfma_f32_16x16x32_bf16 v[196:199], v[244:247], v[180:183], v[196:199]
    ds_read_b128 v[236:239], v4 offset:27648
    v_cvt_pk_bf16_f32 v38, v212, v213
    v_cvt_pk_bf16_f32 v39, v214, v215
    s_waitcnt lgkmcnt(3)
    v_mfma_f32_16x16x32_bf16 v[200:203], v[224:227], v[152:155], v[216:219]
    v_mfma_f32_16x16x32_bf16 v[204:207], v[224:227], v[168:171], v[220:223]
    ds_read_b128 v[240:243], v4 offset:28672
    v_exp_f32 v184, v184
    v_exp_f32 v185, v185
    v_mfma_f32_16x16x32_bf16 v[248:251], v[12:15], v[32:35], v[248:251]
    s_waitcnt lgkmcnt(3)
    v_mfma_f32_16x16x32_bf16 v[208:211], v[228:231], v[152:155], v[216:219]
    v_exp_f32 v186, v186
    v_exp_f32 v187, v187
    v_mfma_f32_16x16x32_bf16 v[212:215], v[228:231], v[168:171], v[220:223]
    ds_read_b128 v[244:247], v4 offset:29696
    v_cvt_pk_bf16_f32 v40, v184, v185
    v_mfma_f32_16x16x32_bf16 v[252:255], v[12:15], v[36:39], v[252:255]
    s_waitcnt lgkmcnt(3)
    v_mfma_f32_16x16x32_bf16 v[200:203], v[232:235], v[156:159], v[200:203]
    v_exp_f32 v188, v188
    v_exp_f32 v189, v189
    v_mfma_f32_16x16x32_bf16 v[204:207], v[232:235], v[172:175], v[204:207]
    ds_read_b128 v[224:227], v4 offset:30720
    v_cvt_pk_bf16_f32 v41, v186, v187
    s_waitcnt lgkmcnt(3)
    v_mfma_f32_16x16x32_bf16 v[208:211], v[236:239], v[156:159], v[208:211]
    v_exp_f32 v190, v190
    v_exp_f32 v191, v191
    v_mfma_f32_16x16x32_bf16 v[212:215], v[236:239], v[172:175], v[212:215]
    ds_read_b128 v[228:231], v4 offset:31744
    v_cvt_pk_bf16_f32 v44, v188, v189
    v_exp_f32 v192, v192
    s_waitcnt lgkmcnt(3)
    v_mfma_f32_16x16x32_bf16 v[200:203], v[240:243], v[160:163], v[200:203]
    v_exp_f32 v193, v193
    v_mfma_f32_16x16x32_bf16 v[204:207], v[240:243], v[176:179], v[204:207]
    s_barrier
    ds_read_b128 v[232:235], v4 offset:32768
    v_cvt_pk_bf16_f32 v45, v190, v191
    v_exp_f32 v194, v194
    s_waitcnt lgkmcnt(3)
    v_mfma_f32_16x16x32_bf16 v[208:211], v[244:247], v[160:163], v[208:211]
    v_exp_f32 v195, v195
    v_mfma_f32_16x16x32_bf16 v[212:215], v[244:247], v[176:179], v[212:215]
    s_add_u32 s22, s21, 0x18000
    s_add_u32 m0, s20, 0x10000
    s_nop 0
    buffer_load_dwordx4 v2, s[8:11], s22 offen sc1 lds
    ds_read_b128 v[236:239], v4 offset:33792
    v_cvt_pk_bf16_f32 v42, v192, v193
    v_exp_f32 v196, v196
    s_waitcnt lgkmcnt(3)
    v_mfma_f32_16x16x32_bf16 v[200:203], v[224:227], v[164:167], v[200:203]
    v_exp_f32 v197, v197
    v_cvt_pk_bf16_f32 v43, v194, v195
    v_mfma_f32_16x16x32_bf16 v[204:207], v[224:227], v[180:183], v[204:207]
    ds_read_b128 v[240:243], v4 offset:34816
    v_exp_f32 v198, v198
    s_waitcnt lgkmcnt(3)
    v_mfma_f32_16x16x32_bf16 v[208:211], v[228:231], v[164:167], v[208:211]
    v_exp_f32 v199, v199
    v_cvt_pk_bf16_f32 v46, v196, v197
    v_mfma_f32_16x16x32_bf16 v[212:215], v[228:231], v[180:183], v[212:215]
    ds_read_b128 v[244:247], v4 offset:35840
    v_cvt_pk_bf16_f32 v47, v198, v199
    s_waitcnt lgkmcnt(3)
    v_mfma_f32_16x16x32_bf16 v[184:187], v[232:235], v[152:155], v[216:219]
    v_mfma_f32_16x16x32_bf16 v[188:191], v[232:235], v[168:171], v[220:223]
    ds_read_b128 v[224:227], v4 offset:36864
    v_exp_f32 v200, v200
    v_exp_f32 v201, v201
    v_mfma_f32_16x16x32_bf16 v[248:251], v[12:15], v[40:43], v[248:251]
    s_waitcnt lgkmcnt(3)
    v_mfma_f32_16x16x32_bf16 v[192:195], v[236:239], v[152:155], v[216:219]
    v_exp_f32 v202, v202
    v_exp_f32 v203, v203
    v_mfma_f32_16x16x32_bf16 v[196:199], v[236:239], v[168:171], v[220:223]
    s_add_u32 s22, s21, 0x18400
    s_add_u32 m0, s20, 0x10400
    s_nop 0
    buffer_load_dwordx4 v2, s[8:11], s22 offen sc1 lds
    ds_read_b128 v[228:231], v4 offset:37888
    v_cvt_pk_bf16_f32 v48, v200, v201
    v_mfma_f32_16x16x32_bf16 v[252:255], v[12:15], v[44:47], v[252:255]
    s_waitcnt lgkmcnt(3)
    v_mfma_f32_16x16x32_bf16 v[184:187], v[240:243], v[156:159], v[184:187]
    v_exp_f32 v204, v204
    v_exp_f32 v205, v205
    v_mfma_f32_16x16x32_bf16 v[188:191], v[240:243], v[172:175], v[188:191]
    ds_read_b128 v[232:235], v4 offset:38912
    v_cvt_pk_bf16_f32 v49, v202, v203
    s_waitcnt lgkmcnt(3)
    v_mfma_f32_16x16x32_bf16 v[192:195], v[244:247], v[156:159], v[192:195]
    v_exp_f32 v206, v206
    v_exp_f32 v207, v207
    v_mfma_f32_16x16x32_bf16 v[196:199], v[244:247], v[172:175], v[196:199]
    ds_read_b128 v[236:239], v4 offset:39936
    v_cvt_pk_bf16_f32 v52, v204, v205
    v_exp_f32 v208, v208
    s_waitcnt lgkmcnt(3)
    v_mfma_f32_16x16x32_bf16 v[184:187], v[224:227], v[160:163], v[184:187]
    v_exp_f32 v209, v209
    v_mfma_f32_16x16x32_bf16 v[188:191], v[224:227], v[176:179], v[188:191]
    ds_read_b128 v[240:243], v4 offset:40960
    v_cvt_pk_bf16_f32 v53, v206, v207
    v_exp_f32 v210, v210
    s_waitcnt lgkmcnt(3)
    v_mfma_f32_16x16x32_bf16 v[192:195], v[228:231], v[160:163], v[192:195]
    v_exp_f32 v211, v211
    v_mfma_f32_16x16x32_bf16 v[196:199], v[228:231], v[176:179], v[196:199]
    ds_read_b128 v[244:247], v4 offset:41984
    v_cvt_pk_bf16_f32 v50, v208, v209
    v_exp_f32 v212, v212
    s_waitcnt lgkmcnt(3)
    v_mfma_f32_16x16x32_bf16 v[184:187], v[232:235], v[164:167], v[184:187]
    v_exp_f32 v213, v213
    v_cvt_pk_bf16_f32 v51, v210, v211
    v_mfma_f32_16x16x32_bf16 v[188:191], v[232:235], v[180:183], v[188:191]
    ds_read_b128 v[224:227], v4 offset:43008
    v_exp_f32 v214, v214
    s_waitcnt lgkmcnt(3)
    v_mfma_f32_16x16x32_bf16 v[192:195], v[236:239], v[164:167], v[192:195]
    v_exp_f32 v215, v215
    v_cvt_pk_bf16_f32 v54, v212, v213
    v_mfma_f32_16x16x32_bf16 v[196:199], v[236:239], v[180:183], v[196:199]
    ds_read_b128 v[228:231], v4 offset:44032
    v_cvt_pk_bf16_f32 v55, v214, v215
    s_waitcnt lgkmcnt(3)
    v_mfma_f32_16x16x32_bf16 v[200:203], v[240:243], v[152:155], v[216:219]
    v_mfma_f32_16x16x32_bf16 v[204:207], v[240:243], v[168:171], v[220:223]
    ds_read_b128 v[232:235], v4 offset:45056
    v_exp_f32 v184, v184
    v_exp_f32 v185, v185
    v_mfma_f32_16x16x32_bf16 v[248:251], v[12:15], v[48:51], v[248:251]
    s_waitcnt lgkmcnt(3)
    v_mfma_f32_16x16x32_bf16 v[208:211], v[244:247], v[152:155], v[216:219]
    v_exp_f32 v186, v186
    v_exp_f32 v187, v187
    v_mfma_f32_16x16x32_bf16 v[212:215], v[244:247], v[168:171], v[220:223]
    ds_read_b128 v[236:239], v4 offset:46080
    v_cvt_pk_bf16_f32 v56, v184, v185
    v_mfma_f32_16x16x32_bf16 v[252:255], v[12:15], v[52:55], v[252:255]
    s_waitcnt lgkmcnt(3)
    v_mfma_f32_16x16x32_bf16 v[200:203], v[224:227], v[156:159], v[200:203]
    v_exp_f32 v188, v188
    v_exp_f32 v189, v189
    v_mfma_f32_16x16x32_bf16 v[204:207], v[224:227], v[172:175], v[204:207]
    ds_read_b128 v[240:243], v4 offset:47104
    v_cvt_pk_bf16_f32 v57, v186, v187
    s_waitcnt lgkmcnt(3)
    v_mfma_f32_16x16x32_bf16 v[208:211], v[228:231], v[156:159], v[208:211]
    v_exp_f32 v190, v190
    v_exp_f32 v191, v191
    v_mfma_f32_16x16x32_bf16 v[212:215], v[228:231], v[172:175], v[212:215]
    ds_read_b128 v[244:247], v4 offset:48128
    v_cvt_pk_bf16_f32 v60, v188, v189
    v_exp_f32 v192, v192
    s_waitcnt lgkmcnt(3)
    v_mfma_f32_16x16x32_bf16 v[200:203], v[232:235], v[160:163], v[200:203]
    v_exp_f32 v193, v193
    v_mfma_f32_16x16x32_bf16 v[204:207], v[232:235], v[176:179], v[204:207]
    s_waitcnt vmcnt(6)
    s_barrier
    ds_read_b128 v[224:227], v4 offset:49152
    v_cvt_pk_bf16_f32 v61, v190, v191
    v_exp_f32 v194, v194
    s_waitcnt lgkmcnt(3)
    v_mfma_f32_16x16x32_bf16 v[208:211], v[236:239], v[160:163], v[208:211]
    v_exp_f32 v195, v195
    v_mfma_f32_16x16x32_bf16 v[212:215], v[236:239], v[176:179], v[212:215]
    s_add_u32 s22, s21, 0x1c000
    s_add_u32 m0, s20, 0x14000
    s_nop 0
    buffer_load_dwordx4 v2, s[8:11], s22 offen sc1 lds
    ds_read_b128 v[228:231], v4 offset:50176
    v_cvt_pk_bf16_f32 v58, v192, v193
    v_exp_f32 v196, v196
    s_waitcnt lgkmcnt(3)
    v_mfma_f32_16x16x32_bf16 v[200:203], v[240:243], v[164:167], v[200:203]
    v_exp_f32 v197, v197
    v_cvt_pk_bf16_f32 v59, v194, v195
    v_mfma_f32_16x16x32_bf16 v[204:207], v[240:243], v[180:183], v[204:207]
    ds_read_b128 v[232:235], v4 offset:51200
    v_exp_f32 v198, v198
    s_waitcnt lgkmcnt(3)
    v_mfma_f32_16x16x32_bf16 v[208:211], v[244:247], v[164:167], v[208:211]
    v_exp_f32 v199, v199
    v_cvt_pk_bf16_f32 v62, v196, v197
    v_mfma_f32_16x16x32_bf16 v[212:215], v[244:247], v[180:183], v[212:215]
    ds_read_b128 v[236:239], v4 offset:52224
    v_cvt_pk_bf16_f32 v63, v198, v199
    s_waitcnt lgkmcnt(3)
    v_mfma_f32_16x16x32_bf16 v[184:187], v[224:227], v[152:155], v[216:219]
    v_mfma_f32_16x16x32_bf16 v[188:191], v[224:227], v[168:171], v[220:223]
    ds_read_b128 v[240:243], v4 offset:53248
    v_exp_f32 v200, v200
    v_exp_f32 v201, v201
    v_mfma_f32_16x16x32_bf16 v[248:251], v[12:15], v[56:59], v[248:251]
    s_waitcnt lgkmcnt(3)
    v_mfma_f32_16x16x32_bf16 v[192:195], v[228:231], v[152:155], v[216:219]
    v_exp_f32 v202, v202
    v_exp_f32 v203, v203
    v_mfma_f32_16x16x32_bf16 v[196:199], v[228:231], v[168:171], v[220:223]
    s_add_u32 s22, s21, 0x1c400
    s_add_u32 m0, s20, 0x14400
    s_nop 0
    buffer_load_dwordx4 v2, s[8:11], s22 offen sc1 lds
    ds_read_b128 v[244:247], v4 offset:54272
    v_cvt_pk_bf16_f32 v64, v200, v201
    v_mfma_f32_16x16x32_bf16 v[252:255], v[12:15], v[60:63], v[252:255]
    s_waitcnt lgkmcnt(3)
    v_mfma_f32_16x16x32_bf16 v[184:187], v[232:235], v[156:159], v[184:187]
    v_exp_f32 v204, v204
    v_exp_f32 v205, v205
    v_mfma_f32_16x16x32_bf16 v[188:191], v[232:235], v[172:175], v[188:191]
    ds_read_b128 v[224:227], v4 offset:55296
    v_cvt_pk_bf16_f32 v65, v202, v203
    s_waitcnt lgkmcnt(3)
    v_mfma_f32_16x16x32_bf16 v[192:195], v[236:239], v[156:159], v[192:195]
    v_exp_f32 v206, v206
    v_exp_f32 v207, v207
    v_mfma_f32_16x16x32_bf16 v[196:199], v[236:239], v[172:175], v[196:199]
    ds_read_b128 v[228:231], v4 offset:56320
    v_cvt_pk_bf16_f32 v68, v204, v205
    v_exp_f32 v208, v208
    s_waitcnt lgkmcnt(3)
    v_mfma_f32_16x16x32_bf16 v[184:187], v[240:243], v[160:163], v[184:187]
    v_exp_f32 v209, v209
    v_mfma_f32_16x16x32_bf16 v[188:191], v[240:243], v[176:179], v[188:191]
    ds_read_b128 v[232:235], v4 offset:57344
    v_cvt_pk_bf16_f32 v69, v206, v207
    v_exp_f32 v210, v210
    s_waitcnt lgkmcnt(3)
    v_mfma_f32_16x16x32_bf16 v[192:195], v[244:247], v[160:163], v[192:195]
    v_exp_f32 v211, v211
    v_mfma_f32_16x16x32_bf16 v[196:199], v[244:247], v[176:179], v[196:199]
    ds_read_b128 v[236:239], v4 offset:58368
    v_cvt_pk_bf16_f32 v66, v208, v209
    v_exp_f32 v212, v212
    s_waitcnt lgkmcnt(3)
    v_mfma_f32_16x16x32_bf16 v[184:187], v[224:227], v[164:167], v[184:187]
    v_exp_f32 v213, v213
    v_cvt_pk_bf16_f32 v67, v210, v211
    v_mfma_f32_16x16x32_bf16 v[188:191], v[224:227], v[180:183], v[188:191]
    ds_read_b128 v[240:243], v4 offset:59392
    v_exp_f32 v214, v214
    s_waitcnt lgkmcnt(3)
    v_mfma_f32_16x16x32_bf16 v[192:195], v[228:231], v[164:167], v[192:195]
    v_exp_f32 v215, v215
    v_cvt_pk_bf16_f32 v70, v212, v213
    v_mfma_f32_16x16x32_bf16 v[196:199], v[228:231], v[180:183], v[196:199]
    ds_read_b128 v[244:247], v4 offset:60416
    v_cvt_pk_bf16_f32 v71, v214, v215
    s_waitcnt lgkmcnt(3)
    v_mfma_f32_16x16x32_bf16 v[200:203], v[232:235], v[152:155], v[216:219]
    v_mfma_f32_16x16x32_bf16 v[204:207], v[232:235], v[168:171], v[220:223]
    ds_read_b128 v[224:227], v4 offset:61440
    v_exp_f32 v184, v184
    v_exp_f32 v185, v185
    v_mfma_f32_16x16x32_bf16 v[248:251], v[12:15], v[64:67], v[248:251]
    s_waitcnt lgkmcnt(3)
    v_mfma_f32_16x16x32_bf16 v[208:211], v[236:239], v[152:155], v[216:219]
    v_exp_f32 v186, v186
    v_exp_f32 v187, v187
    v_mfma_f32_16x16x32_bf16 v[212:215], v[236:239], v[168:171], v[220:223]
    ds_read_b128 v[228:231], v4 offset:62464
    v_cvt_pk_bf16_f32 v72, v184, v185
    v_mfma_f32_16x16x32_bf16 v[252:255], v[12:15], v[68:71], v[252:255]
    s_waitcnt lgkmcnt(3)
    v_mfma_f32_16x16x32_bf16 v[200:203], v[240:243], v[156:159], v[200:203]
    v_exp_f32 v188, v188
    v_exp_f32 v189, v189
    v_mfma_f32_16x16x32_bf16 v[204:207], v[240:243], v[172:175], v[204:207]
    ds_read_b128 v[232:235], v4 offset:63488
    v_cvt_pk_bf16_f32 v73, v186, v187
    s_waitcnt lgkmcnt(3)
    v_mfma_f32_16x16x32_bf16 v[208:211], v[244:247], v[156:159], v[208:211]
    v_exp_f32 v190, v190
    v_exp_f32 v191, v191
    v_mfma_f32_16x16x32_bf16 v[212:215], v[244:247], v[172:175], v[212:215]
    ds_read_b128 v[236:239], v4 offset:64512
    v_cvt_pk_bf16_f32 v76, v188, v189
    v_exp_f32 v192, v192
    s_waitcnt lgkmcnt(3)
    v_mfma_f32_16x16x32_bf16 v[200:203], v[224:227], v[160:163], v[200:203]
    v_exp_f32 v193, v193
    v_mfma_f32_16x16x32_bf16 v[204:207], v[224:227], v[176:179], v[204:207]
    s_waitcnt vmcnt(6)
    s_barrier
    ds_read_b128 v[240:243], v5 offset:0
    v_cvt_pk_bf16_f32 v77, v190, v191
    v_exp_f32 v194, v194
    s_waitcnt lgkmcnt(3)
    v_mfma_f32_16x16x32_bf16 v[208:211], v[228:231], v[160:163], v[208:211]
    v_exp_f32 v195, v195
    v_mfma_f32_16x16x32_bf16 v[212:215], v[228:231], v[176:179], v[212:215]
    s_add_u32 s22, s21, 0x80000
    s_add_u32 m0, s20, 0x18000
    s_nop 0
    buffer_load_dwordx4 v2, s[8:11], s22 offen sc1 lds
    ds_read_b128 v[244:247], v5 offset:1024
    v_cvt_pk_bf16_f32 v74, v192, v193
    v_exp_f32 v196, v196
    s_waitcnt lgkmcnt(3)
    v_mfma_f32_16x16x32_bf16 v[200:203], v[232:235], v[164:167], v[200:203]
    v_exp_f32 v197, v197
    v_cvt_pk_bf16_f32 v75, v194, v195
    v_mfma_f32_16x16x32_bf16 v[204:207], v[232:235], v[180:183], v[204:207]
    ds_read_b128 v[224:227], v5 offset:2048
    v_exp_f32 v198, v198
    s_waitcnt lgkmcnt(3)
    v_mfma_f32_16x16x32_bf16 v[208:211], v[236:239], v[164:167], v[208:211]
    v_exp_f32 v199, v199
    v_cvt_pk_bf16_f32 v78, v196, v197
    v_mfma_f32_16x16x32_bf16 v[212:215], v[236:239], v[180:183], v[212:215]
    ds_read_b128 v[228:231], v5 offset:3072
    v_cvt_pk_bf16_f32 v79, v198, v199
    s_waitcnt lgkmcnt(3)
    v_mfma_f32_16x16x32_bf16 v[184:187], v[240:243], v[152:155], v[216:219]
    v_mfma_f32_16x16x32_bf16 v[188:191], v[240:243], v[168:171], v[220:223]
    ds_read_b128 v[232:235], v5 offset:4096
    v_exp_f32 v200, v200
    v_exp_f32 v201, v201
    v_mfma_f32_16x16x32_bf16 v[248:251], v[12:15], v[72:75], v[248:251]
    s_waitcnt lgkmcnt(3)
    v_mfma_f32_16x16x32_bf16 v[192:195], v[244:247], v[152:155], v[216:219]
    v_exp_f32 v202, v202
    v_exp_f32 v203, v203
    v_mfma_f32_16x16x32_bf16 v[196:199], v[244:247], v[168:171], v[220:223]
    s_add_u32 s22, s21, 0x80400
    s_add_u32 m0, s20, 0x18400
    s_nop 0
    buffer_load_dwordx4 v2, s[8:11], s22 offen sc1 lds
    ds_read_b128 v[236:239], v5 offset:5120
    v_cvt_pk_bf16_f32 v80, v200, v201
    v_mfma_f32_16x16x32_bf16 v[252:255], v[12:15], v[76:79], v[252:255]
    s_waitcnt lgkmcnt(3)
    v_mfma_f32_16x16x32_bf16 v[184:187], v[224:227], v[156:159], v[184:187]
    v_exp_f32 v204, v204
    v_exp_f32 v205, v205
    v_mfma_f32_16x16x32_bf16 v[188:191], v[224:227], v[172:175], v[188:191]
    ds_read_b128 v[240:243], v5 offset:6144
    v_cvt_pk_bf16_f32 v81, v202, v203
    s_waitcnt lgkmcnt(3)
    v_mfma_f32_16x16x32_bf16 v[192:195], v[228:231], v[156:159], v[192:195]
    v_exp_f32 v206, v206
    v_exp_f32 v207, v207
    v_mfma_f32_16x16x32_bf16 v[196:199], v[228:231], v[172:175], v[196:199]
    ds_read_b128 v[244:247], v5 offset:7168
    v_cvt_pk_bf16_f32 v84, v204, v205
    v_exp_f32 v208, v208
    s_waitcnt lgkmcnt(3)
    v_mfma_f32_16x16x32_bf16 v[184:187], v[232:235], v[160:163], v[184:187]
    v_exp_f32 v209, v209
    v_mfma_f32_16x16x32_bf16 v[188:191], v[232:235], v[176:179], v[188:191]
    ds_read_b128 v[224:227], v5 offset:8192
    v_cvt_pk_bf16_f32 v85, v206, v207
    v_exp_f32 v210, v210
    s_waitcnt lgkmcnt(3)
    v_mfma_f32_16x16x32_bf16 v[192:195], v[236:239], v[160:163], v[192:195]
    v_exp_f32 v211, v211
    v_mfma_f32_16x16x32_bf16 v[196:199], v[236:239], v[176:179], v[196:199]
    ds_read_b128 v[228:231], v5 offset:9216
    v_cvt_pk_bf16_f32 v82, v208, v209
    v_exp_f32 v212, v212
    s_waitcnt lgkmcnt(3)
    v_mfma_f32_16x16x32_bf16 v[184:187], v[240:243], v[164:167], v[184:187]
    v_exp_f32 v213, v213
    v_cvt_pk_bf16_f32 v83, v210, v211
    v_mfma_f32_16x16x32_bf16 v[188:191], v[240:243], v[180:183], v[188:191]
    ds_read_b128 v[232:235], v5 offset:10240
    v_exp_f32 v214, v214
    s_waitcnt lgkmcnt(3)
    v_mfma_f32_16x16x32_bf16 v[192:195], v[244:247], v[164:167], v[192:195]
    v_exp_f32 v215, v215
    v_cvt_pk_bf16_f32 v86, v212, v213
    v_mfma_f32_16x16x32_bf16 v[196:199], v[244:247], v[180:183], v[196:199]
    ds_read_b128 v[236:239], v5 offset:11264
    v_cvt_pk_bf16_f32 v87, v214, v215
    s_waitcnt lgkmcnt(3)
    v_mfma_f32_16x16x32_bf16 v[200:203], v[224:227], v[152:155], v[216:219]
    v_mfma_f32_16x16x32_bf16 v[204:207], v[224:227], v[168:171], v[220:223]
    ds_read_b128 v[240:243], v5 offset:12288
    v_exp_f32 v184, v184
    v_exp_f32 v185, v185
    v_mfma_f32_16x16x32_bf16 v[248:251], v[12:15], v[80:83], v[248:251]
    s_waitcnt lgkmcnt(3)
    v_mfma_f32_16x16x32_bf16 v[208:211], v[228:231], v[152:155], v[216:219]
    v_exp_f32 v186, v186
    v_exp_f32 v187, v187
    v_mfma_f32_16x16x32_bf16 v[212:215], v[228:231], v[168:171], v[220:223]
    ds_read_b128 v[244:247], v5 offset:13312
    v_cvt_pk_bf16_f32 v88, v184, v185
    v_mfma_f32_16x16x32_bf16 v[252:255], v[12:15], v[84:87], v[252:255]
    s_waitcnt lgkmcnt(3)
    v_mfma_f32_16x16x32_bf16 v[200:203], v[232:235], v[156:159], v[200:203]
    v_exp_f32 v188, v188
    v_exp_f32 v189, v189
    v_mfma_f32_16x16x32_bf16 v[204:207], v[232:235], v[172:175], v[204:207]
    ds_read_b128 v[224:227], v5 offset:14336
    v_cvt_pk_bf16_f32 v89, v186, v187
    s_waitcnt lgkmcnt(3)
    v_mfma_f32_16x16x32_bf16 v[208:211], v[236:239], v[156:159], v[208:211]
    v_exp_f32 v190, v190
    v_exp_f32 v191, v191
    v_mfma_f32_16x16x32_bf16 v[212:215], v[236:239], v[172:175], v[212:215]
    ds_read_b128 v[228:231], v5 offset:15360
    v_cvt_pk_bf16_f32 v92, v188, v189
    v_exp_f32 v192, v192
    s_waitcnt lgkmcnt(3)
    v_mfma_f32_16x16x32_bf16 v[200:203], v[240:243], v[160:163], v[200:203]
    v_exp_f32 v193, v193
    v_mfma_f32_16x16x32_bf16 v[204:207], v[240:243], v[176:179], v[204:207]
    s_waitcnt vmcnt(6)
    s_barrier
    ds_read_b128 v[232:235], v5 offset:16384
    v_cvt_pk_bf16_f32 v93, v190, v191
    v_exp_f32 v194, v194
    s_waitcnt lgkmcnt(3)
    v_mfma_f32_16x16x32_bf16 v[208:211], v[244:247], v[160:163], v[208:211]
    v_exp_f32 v195, v195
    v_mfma_f32_16x16x32_bf16 v[212:215], v[244:247], v[176:179], v[212:215]
    s_add_u32 s22, s21, 0x84000
    s_add_u32 m0, s20, 0x1c000
    s_nop 0
    buffer_load_dwordx4 v2, s[8:11], s22 offen sc1 lds
    ds_read_b128 v[236:239], v5 offset:17408
    v_cvt_pk_bf16_f32 v90, v192, v193
    v_exp_f32 v196, v196
    s_waitcnt lgkmcnt(3)
    v_mfma_f32_16x16x32_bf16 v[200:203], v[224:227], v[164:167], v[200:203]
    v_exp_f32 v197, v197
    v_cvt_pk_bf16_f32 v91, v194, v195
    v_mfma_f32_16x16x32_bf16 v[204:207], v[224:227], v[180:183], v[204:207]
    ds_read_b128 v[240:243], v5 offset:18432
    v_exp_f32 v198, v198
    s_waitcnt lgkmcnt(3)
    v_mfma_f32_16x16x32_bf16 v[208:211], v[228:231], v[164:167], v[208:211]
    v_exp_f32 v199, v199
    v_cvt_pk_bf16_f32 v94, v196, v197
    v_mfma_f32_16x16x32_bf16 v[212:215], v[228:231], v[180:183], v[212:215]
    ds_read_b128 v[244:247], v5 offset:19456
    v_cvt_pk_bf16_f32 v95, v198, v199
    s_waitcnt lgkmcnt(3)
    v_mfma_f32_16x16x32_bf16 v[184:187], v[232:235], v[152:155], v[216:219]
    v_mfma_f32_16x16x32_bf16 v[188:191], v[232:235], v[168:171], v[220:223]
    ds_read_b128 v[224:227], v5 offset:20480
    v_exp_f32 v200, v200
    v_exp_f32 v201, v201
    v_mfma_f32_16x16x32_bf16 v[248:251], v[12:15], v[88:91], v[248:251]
    s_waitcnt lgkmcnt(3)
    v_mfma_f32_16x16x32_bf16 v[192:195], v[236:239], v[152:155], v[216:219]
    v_exp_f32 v202, v202
    v_exp_f32 v203, v203
    v_mfma_f32_16x16x32_bf16 v[196:199], v[236:239], v[168:171], v[220:223]
    s_add_u32 s22, s21, 0x84400
    s_add_u32 m0, s20, 0x1c400
    s_nop 0
    buffer_load_dwordx4 v2, s[8:11], s22 offen sc1 lds
    ds_read_b128 v[228:231], v5 offset:21504
    v_cvt_pk_bf16_f32 v96, v200, v201
    v_mfma_f32_16x16x32_bf16 v[252:255], v[12:15], v[92:95], v[252:255]
    s_waitcnt lgkmcnt(3)
    v_mfma_f32_16x16x32_bf16 v[184:187], v[240:243], v[156:159], v[184:187]
    v_exp_f32 v204, v204
    v_exp_f32 v205, v205
    v_mfma_f32_16x16x32_bf16 v[188:191], v[240:243], v[172:175], v[188:191]
    ds_read_b128 v[232:235], v5 offset:22528
    v_cvt_pk_bf16_f32 v97, v202, v203
    s_waitcnt lgkmcnt(3)
    v_mfma_f32_16x16x32_bf16 v[192:195], v[244:247], v[156:159], v[192:195]
    v_exp_f32 v206, v206
    v_exp_f32 v207, v207
    v_mfma_f32_16x16x32_bf16 v[196:199], v[244:247], v[172:175], v[196:199]
    ds_read_b128 v[236:239], v5 offset:23552
    v_cvt_pk_bf16_f32 v100, v204, v205
    v_exp_f32 v208, v208
    s_waitcnt lgkmcnt(3)
    v_mfma_f32_16x16x32_bf16 v[184:187], v[224:227], v[160:163], v[184:187]
    v_exp_f32 v209, v209
    v_mfma_f32_16x16x32_bf16 v[188:191], v[224:227], v[176:179], v[188:191]
    ds_read_b128 v[240:243], v5 offset:24576
    v_cvt_pk_bf16_f32 v101, v206, v207
    v_exp_f32 v210, v210
    s_waitcnt lgkmcnt(3)
    v_mfma_f32_16x16x32_bf16 v[192:195], v[228:231], v[160:163], v[192:195]
    v_exp_f32 v211, v211
    v_mfma_f32_16x16x32_bf16 v[196:199], v[228:231], v[176:179], v[196:199]
    ds_read_b128 v[244:247], v5 offset:25600
    v_cvt_pk_bf16_f32 v98, v208, v209
    v_exp_f32 v212, v212
    s_waitcnt lgkmcnt(3)
    v_mfma_f32_16x16x32_bf16 v[184:187], v[232:235], v[164:167], v[184:187]
    v_exp_f32 v213, v213
    v_cvt_pk_bf16_f32 v99, v210, v211
    v_mfma_f32_16x16x32_bf16 v[188:191], v[232:235], v[180:183], v[188:191]
    ds_read_b128 v[224:227], v5 offset:26624
    v_exp_f32 v214, v214
    s_waitcnt lgkmcnt(3)
    v_mfma_f32_16x16x32_bf16 v[192:195], v[236:239], v[164:167], v[192:195]
    v_exp_f32 v215, v215
    v_cvt_pk_bf16_f32 v102, v212, v213
    v_mfma_f32_16x16x32_bf16 v[196:199], v[236:239], v[180:183], v[196:199]
    ds_read_b128 v[228:231], v5 offset:27648
    v_cvt_pk_bf16_f32 v103, v214, v215
    s_waitcnt lgkmcnt(3)
    v_mfma_f32_16x16x32_bf16 v[200:203], v[240:243], v[152:155], v[216:219]
    v_mfma_f32_16x16x32_bf16 v[204:207], v[240:243], v[168:171], v[220:223]
    ds_read_b128 v[232:235], v5 offset:28672
    v_exp_f32 v184, v184
    v_exp_f32 v185, v185
    v_mfma_f32_16x16x32_bf16 v[248:251], v[12:15], v[96:99], v[248:251]
    s_waitcnt lgkmcnt(3)
    v_mfma_f32_16x16x32_bf16 v[208:211], v[244:247], v[152:155], v[216:219]
    v_exp_f32 v186, v186
    v_exp_f32 v187, v187
    v_mfma_f32_16x16x32_bf16 v[212:215], v[244:247], v[168:171], v[220:223]
    ds_read_b128 v[236:239], v5 offset:29696
    v_cvt_pk_bf16_f32 v104, v184, v185
    v_mfma_f32_16x16x32_bf16 v[252:255], v[12:15], v[100:103], v[252:255]
    s_waitcnt lgkmcnt(3)
    v_mfma_f32_16x16x32_bf16 v[200:203], v[224:227], v[156:159], v[200:203]
    v_exp_f32 v188, v188
    v_exp_f32 v189, v189
    v_mfma_f32_16x16x32_bf16 v[204:207], v[224:227], v[172:175], v[204:207]
    ds_read_b128 v[240:243], v5 offset:30720
    v_cvt_pk_bf16_f32 v105, v186, v187
    s_waitcnt lgkmcnt(3)
    v_mfma_f32_16x16x32_bf16 v[208:211], v[228:231], v[156:159], v[208:211]
    v_exp_f32 v190, v190
    v_exp_f32 v191, v191
    v_mfma_f32_16x16x32_bf16 v[212:215], v[228:231], v[172:175], v[212:215]
    ds_read_b128 v[244:247], v5 offset:31744
    v_cvt_pk_bf16_f32 v108, v188, v189
    v_exp_f32 v192, v192
    s_waitcnt lgkmcnt(3)
    v_mfma_f32_16x16x32_bf16 v[200:203], v[232:235], v[160:163], v[200:203]
    v_exp_f32 v193, v193
    v_mfma_f32_16x16x32_bf16 v[204:207], v[232:235], v[176:179], v[204:207]
    s_waitcnt vmcnt(6)
    s_barrier
    ds_read_b128 v[224:227], v4 offset:0
    v_cvt_pk_bf16_f32 v109, v190, v191
    v_exp_f32 v194, v194
    s_waitcnt lgkmcnt(3)
    v_mfma_f32_16x16x32_bf16 v[208:211], v[236:239], v[160:163], v[208:211]
    v_exp_f32 v195, v195
    v_mfma_f32_16x16x32_bf16 v[212:215], v[236:239], v[176:179], v[212:215]
    s_add_u32 s22, s21, 0x88000
    s_add_u32 m0, s20, 0x20000
    s_nop 0
    buffer_load_dwordx4 v2, s[8:11], s22 offen sc1 lds
    ds_read_b128 v[228:231], v4 offset:1024
    v_cvt_pk_bf16_f32 v106, v192, v193
    v_exp_f32 v196, v196
    s_waitcnt lgkmcnt(3)
    v_mfma_f32_16x16x32_bf16 v[200:203], v[240:243], v[164:167], v[200:203]
    v_exp_f32 v197, v197
    v_cvt_pk_bf16_f32 v107, v194, v195
    v_mfma_f32_16x16x32_bf16 v[204:207], v[240:243], v[180:183], v[204:207]
    ds_read_b128 v[232:235], v4 offset:2048
    v_exp_f32 v198, v198
    s_waitcnt lgkmcnt(3)
    v_mfma_f32_16x16x32_bf16 v[208:211], v[244:247], v[164:167], v[208:211]
    v_exp_f32 v199, v199
    v_cvt_pk_bf16_f32 v110, v196, v197
    v_mfma_f32_16x16x32_bf16 v[212:215], v[244:247], v[180:183], v[212:215]
    ds_read_b128 v[236:239], v4 offset:3072
    v_cvt_pk_bf16_f32 v111, v198, v199
    s_waitcnt lgkmcnt(3)
    v_mfma_f32_16x16x32_bf16 v[184:187], v[224:227], v[152:155], v[216:219]
    v_mfma_f32_16x16x32_bf16 v[188:191], v[224:227], v[168:171], v[220:223]
    ds_read_b128 v[240:243], v4 offset:4096
    v_exp_f32 v200, v200
    v_exp_f32 v201, v201
    v_mfma_f32_16x16x32_bf16 v[248:251], v[12:15], v[104:107], v[248:251]
    s_waitcnt lgkmcnt(3)
    v_mfma_f32_16x16x32_bf16 v[192:195], v[228:231], v[152:155], v[216:219]
    v_exp_f32 v202, v202
    v_exp_f32 v203, v203
    v_mfma_f32_16x16x32_bf16 v[196:199], v[228:231], v[168:171], v[220:223]
    s_add_u32 s22, s21, 0x88400
    s_add_u32 m0, s20, 0x20400
    s_nop 0
    buffer_load_dwordx4 v2, s[8:11], s22 offen sc1 lds
    ds_read_b128 v[244:247], v4 offset:5120
    v_cvt_pk_bf16_f32 v112, v200, v201
    v_mfma_f32_16x16x32_bf16 v[252:255], v[12:15], v[108:111], v[252:255]
    s_waitcnt lgkmcnt(3)
    v_mfma_f32_16x16x32_bf16 v[184:187], v[232:235], v[156:159], v[184:187]
    v_exp_f32 v204, v204
    v_exp_f32 v205, v205
    v_mfma_f32_16x16x32_bf16 v[188:191], v[232:235], v[172:175], v[188:191]
    ds_read_b128 v[224:227], v4 offset:6144
    v_cvt_pk_bf16_f32 v113, v202, v203
    s_waitcnt lgkmcnt(3)
    v_mfma_f32_16x16x32_bf16 v[192:195], v[236:239], v[156:159], v[192:195]
    v_exp_f32 v206, v206
    v_exp_f32 v207, v207
    v_mfma_f32_16x16x32_bf16 v[196:199], v[236:239], v[172:175], v[196:199]
    ds_read_b128 v[228:231], v4 offset:7168
    v_cvt_pk_bf16_f32 v116, v204, v205
    v_exp_f32 v208, v208
    s_waitcnt lgkmcnt(3)
    v_mfma_f32_16x16x32_bf16 v[184:187], v[240:243], v[160:163], v[184:187]
    v_exp_f32 v209, v209
    v_mfma_f32_16x16x32_bf16 v[188:191], v[240:243], v[176:179], v[188:191]
    ds_read_b128 v[232:235], v4 offset:8192
    v_cvt_pk_bf16_f32 v117, v206, v207
    v_exp_f32 v210, v210
    s_waitcnt lgkmcnt(3)
    v_mfma_f32_16x16x32_bf16 v[192:195], v[244:247], v[160:163], v[192:195]
    v_exp_f32 v211, v211
    v_mfma_f32_16x16x32_bf16 v[196:199], v[244:247], v[176:179], v[196:199]
    ds_read_b128 v[236:239], v4 offset:9216
    v_cvt_pk_bf16_f32 v114, v208, v209
    v_exp_f32 v212, v212
    s_waitcnt lgkmcnt(3)
    v_mfma_f32_16x16x32_bf16 v[184:187], v[224:227], v[164:167], v[184:187]
    v_exp_f32 v213, v213
    v_cvt_pk_bf16_f32 v115, v210, v211
    v_mfma_f32_16x16x32_bf16 v[188:191], v[224:227], v[180:183], v[188:191]
    ds_read_b128 v[240:243], v4 offset:10240
    v_exp_f32 v214, v214
    s_waitcnt lgkmcnt(3)
    v_mfma_f32_16x16x32_bf16 v[192:195], v[228:231], v[164:167], v[192:195]
    v_exp_f32 v215, v215
    v_cvt_pk_bf16_f32 v118, v212, v213
    v_mfma_f32_16x16x32_bf16 v[196:199], v[228:231], v[180:183], v[196:199]
    ds_read_b128 v[244:247], v4 offset:11264
    v_cvt_pk_bf16_f32 v119, v214, v215
    s_waitcnt lgkmcnt(3)
    v_mfma_f32_16x16x32_bf16 v[200:203], v[232:235], v[152:155], v[216:219]
    v_mfma_f32_16x16x32_bf16 v[204:207], v[232:235], v[168:171], v[220:223]
    ds_read_b128 v[224:227], v4 offset:12288
    v_exp_f32 v184, v184
    v_exp_f32 v185, v185
    v_mfma_f32_16x16x32_bf16 v[248:251], v[12:15], v[112:115], v[248:251]
    s_waitcnt lgkmcnt(3)
    v_mfma_f32_16x16x32_bf16 v[208:211], v[236:239], v[152:155], v[216:219]
    v_exp_f32 v186, v186
    v_exp_f32 v187, v187
    v_mfma_f32_16x16x32_bf16 v[212:215], v[236:239], v[168:171], v[220:223]
    ds_read_b128 v[228:231], v4 offset:13312
    v_cvt_pk_bf16_f32 v120, v184, v185
    v_mfma_f32_16x16x32_bf16 v[252:255], v[12:15], v[116:119], v[252:255]
    s_waitcnt lgkmcnt(3)
    v_mfma_f32_16x16x32_bf16 v[200:203], v[240:243], v[156:159], v[200:203]
    v_exp_f32 v188, v188
    v_exp_f32 v189, v189
    v_mfma_f32_16x16x32_bf16 v[204:207], v[240:243], v[172:175], v[204:207]
    ds_read_b128 v[232:235], v4 offset:14336
    v_cvt_pk_bf16_f32 v121, v186, v187
    s_waitcnt lgkmcnt(3)
    v_mfma_f32_16x16x32_bf16 v[208:211], v[244:247], v[156:159], v[208:211]
    v_exp_f32 v190, v190
    v_exp_f32 v191, v191
    v_mfma_f32_16x16x32_bf16 v[212:215], v[244:247], v[172:175], v[212:215]
    ds_read_b128 v[236:239], v4 offset:15360
    v_cvt_pk_bf16_f32 v124, v188, v189
    v_exp_f32 v192, v192
    s_waitcnt lgkmcnt(3)
    v_mfma_f32_16x16x32_bf16 v[200:203], v[224:227], v[160:163], v[200:203]
    v_exp_f32 v193, v193
    v_mfma_f32_16x16x32_bf16 v[204:207], v[224:227], v[176:179], v[204:207]
    s_waitcnt vmcnt(6)
    s_barrier
    ds_read_b128 v[240:243], v4 offset:16384
    v_cvt_pk_bf16_f32 v125, v190, v191
    v_exp_f32 v194, v194
    s_waitcnt lgkmcnt(3)
    v_mfma_f32_16x16x32_bf16 v[208:211], v[228:231], v[160:163], v[208:211]
    v_exp_f32 v195, v195
    v_mfma_f32_16x16x32_bf16 v[212:215], v[228:231], v[176:179], v[212:215]
    s_add_u32 s22, s21, 0x8c000
    s_add_u32 m0, s20, 0x24000
    s_nop 0
    buffer_load_dwordx4 v2, s[8:11], s22 offen sc1 lds
    ds_read_b128 v[244:247], v4 offset:17408
    v_cvt_pk_bf16_f32 v122, v192, v193
    v_exp_f32 v196, v196
    s_waitcnt lgkmcnt(3)
    v_mfma_f32_16x16x32_bf16 v[200:203], v[232:235], v[164:167], v[200:203]
    v_exp_f32 v197, v197
    v_cvt_pk_bf16_f32 v123, v194, v195
    v_mfma_f32_16x16x32_bf16 v[204:207], v[232:235], v[180:183], v[204:207]
    ds_read_b128 v[224:227], v4 offset:18432
    v_exp_f32 v198, v198
    s_waitcnt lgkmcnt(3)
    v_mfma_f32_16x16x32_bf16 v[208:211], v[236:239], v[164:167], v[208:211]
    v_exp_f32 v199, v199
    v_cvt_pk_bf16_f32 v126, v196, v197
    v_mfma_f32_16x16x32_bf16 v[212:215], v[236:239], v[180:183], v[212:215]
    ds_read_b128 v[228:231], v4 offset:19456
    v_cvt_pk_bf16_f32 v127, v198, v199
    s_waitcnt lgkmcnt(3)
    v_mfma_f32_16x16x32_bf16 v[184:187], v[240:243], v[152:155], v[216:219]
    v_mfma_f32_16x16x32_bf16 v[188:191], v[240:243], v[168:171], v[220:223]
    ds_read_b128 v[232:235], v4 offset:20480
    v_exp_f32 v200, v200
    v_exp_f32 v201, v201
    v_mfma_f32_16x16x32_bf16 v[248:251], v[12:15], v[120:123], v[248:251]
    s_waitcnt lgkmcnt(3)
    v_mfma_f32_16x16x32_bf16 v[192:195], v[244:247], v[152:155], v[216:219]
    v_exp_f32 v202, v202
    v_exp_f32 v203, v203
    v_mfma_f32_16x16x32_bf16 v[196:199], v[244:247], v[168:171], v[220:223]
    s_add_u32 s22, s21, 0x8c400
    s_add_u32 m0, s20, 0x24400
    s_nop 0
    buffer_load_dwordx4 v2, s[8:11], s22 offen sc1 lds
    ds_read_b128 v[236:239], v4 offset:21504
    v_cvt_pk_bf16_f32 v128, v200, v201
    v_mfma_f32_16x16x32_bf16 v[252:255], v[12:15], v[124:127], v[252:255]
    s_waitcnt lgkmcnt(3)
    v_mfma_f32_16x16x32_bf16 v[184:187], v[224:227], v[156:159], v[184:187]
    v_exp_f32 v204, v204
    v_exp_f32 v205, v205
    v_mfma_f32_16x16x32_bf16 v[188:191], v[224:227], v[172:175], v[188:191]
    ds_read_b128 v[240:243], v4 offset:22528
    v_cvt_pk_bf16_f32 v129, v202, v203
    s_waitcnt lgkmcnt(3)
    v_mfma_f32_16x16x32_bf16 v[192:195], v[228:231], v[156:159], v[192:195]
    v_exp_f32 v206, v206
    v_exp_f32 v207, v207
    v_mfma_f32_16x16x32_bf16 v[196:199], v[228:231], v[172:175], v[196:199]
    ds_read_b128 v[244:247], v4 offset:23552
    v_cvt_pk_bf16_f32 v132, v204, v205
    v_exp_f32 v208, v208
    s_waitcnt lgkmcnt(3)
    v_mfma_f32_16x16x32_bf16 v[184:187], v[232:235], v[160:163], v[184:187]
    v_exp_f32 v209, v209
    v_mfma_f32_16x16x32_bf16 v[188:191], v[232:235], v[176:179], v[188:191]
    ds_read_b128 v[224:227], v4 offset:24576
    v_cvt_pk_bf16_f32 v133, v206, v207
    v_exp_f32 v210, v210
    s_waitcnt lgkmcnt(3)
    v_mfma_f32_16x16x32_bf16 v[192:195], v[236:239], v[160:163], v[192:195]
    v_exp_f32 v211, v211
    v_mfma_f32_16x16x32_bf16 v[196:199], v[236:239], v[176:179], v[196:199]
    ds_read_b128 v[228:231], v4 offset:25600
    v_cvt_pk_bf16_f32 v130, v208, v209
    v_exp_f32 v212, v212
    s_waitcnt lgkmcnt(3)
    v_mfma_f32_16x16x32_bf16 v[184:187], v[240:243], v[164:167], v[184:187]
    v_exp_f32 v213, v213
    v_cvt_pk_bf16_f32 v131, v210, v211
    v_mfma_f32_16x16x32_bf16 v[188:191], v[240:243], v[180:183], v[188:191]
    ds_read_b128 v[232:235], v4 offset:26624
    v_exp_f32 v214, v214
    s_waitcnt lgkmcnt(3)
    v_mfma_f32_16x16x32_bf16 v[192:195], v[244:247], v[164:167], v[192:195]
    v_exp_f32 v215, v215
    v_cvt_pk_bf16_f32 v134, v212, v213
    v_mfma_f32_16x16x32_bf16 v[196:199], v[244:247], v[180:183], v[196:199]
    ds_read_b128 v[236:239], v4 offset:27648
    v_cvt_pk_bf16_f32 v135, v214, v215
    s_waitcnt lgkmcnt(3)
    v_mfma_f32_16x16x32_bf16 v[200:203], v[224:227], v[152:155], v[216:219]
    v_mfma_f32_16x16x32_bf16 v[204:207], v[224:227], v[168:171], v[220:223]
    ds_read_b128 v[240:243], v4 offset:28672
    v_exp_f32 v184, v184
    v_exp_f32 v185, v185
    v_mfma_f32_16x16x32_bf16 v[248:251], v[12:15], v[128:131], v[248:251]
    s_waitcnt lgkmcnt(3)
    v_mfma_f32_16x16x32_bf16 v[208:211], v[228:231], v[152:155], v[216:219]
    v_exp_f32 v186, v186
    v_exp_f32 v187, v187
    v_mfma_f32_16x16x32_bf16 v[212:215], v[228:231], v[168:171], v[220:223]
    ds_read_b128 v[244:247], v4 offset:29696
    v_cvt_pk_bf16_f32 v136, v184, v185
    v_mfma_f32_16x16x32_bf16 v[252:255], v[12:15], v[132:135], v[252:255]
    s_waitcnt lgkmcnt(3)
    v_mfma_f32_16x16x32_bf16 v[200:203], v[232:235], v[156:159], v[200:203]
    v_exp_f32 v188, v188
    v_exp_f32 v189, v189
    v_mfma_f32_16x16x32_bf16 v[204:207], v[232:235], v[172:175], v[204:207]
    ds_read_b128 v[224:227], v4 offset:30720
    v_cvt_pk_bf16_f32 v137, v186, v187
    s_waitcnt lgkmcnt(3)
    v_mfma_f32_16x16x32_bf16 v[208:211], v[236:239], v[156:159], v[208:211]
    v_exp_f32 v190, v190
    v_exp_f32 v191, v191
    v_mfma_f32_16x16x32_bf16 v[212:215], v[236:239], v[172:175], v[212:215]
    ds_read_b128 v[228:231], v4 offset:31744
    v_cvt_pk_bf16_f32 v140, v188, v189
    v_exp_f32 v192, v192
    s_waitcnt lgkmcnt(3)
    v_mfma_f32_16x16x32_bf16 v[200:203], v[240:243], v[160:163], v[200:203]
    v_exp_f32 v193, v193
    v_mfma_f32_16x16x32_bf16 v[204:207], v[240:243], v[176:179], v[204:207]
    v_cvt_pk_bf16_f32 v141, v190, v191
    v_exp_f32 v194, v194
    s_waitcnt lgkmcnt(2)
    v_mfma_f32_16x16x32_bf16 v[208:211], v[244:247], v[160:163], v[208:211]
    v_exp_f32 v195, v195
    v_mfma_f32_16x16x32_bf16 v[212:215], v[244:247], v[176:179], v[212:215]
    v_cvt_pk_bf16_f32 v138, v192, v193
    v_exp_f32 v196, v196
    s_waitcnt lgkmcnt(1)
    v_mfma_f32_16x16x32_bf16 v[200:203], v[224:227], v[164:167], v[200:203]
    v_exp_f32 v197, v197
    v_cvt_pk_bf16_f32 v139, v194, v195
    v_mfma_f32_16x16x32_bf16 v[204:207], v[224:227], v[180:183], v[204:207]
    v_exp_f32 v198, v198
    s_waitcnt lgkmcnt(0)
    v_mfma_f32_16x16x32_bf16 v[208:211], v[228:231], v[164:167], v[208:211]
    v_exp_f32 v199, v199
    v_cvt_pk_bf16_f32 v142, v196, v197
    v_mfma_f32_16x16x32_bf16 v[212:215], v[228:231], v[180:183], v[212:215]
    v_cvt_pk_bf16_f32 v143, v198, v199
    s_waitcnt vmcnt(6)
    s_barrier
    ds_read_b128 v[232:235], v4 offset:32768
    ds_read_b128 v[236:239], v4 offset:33792
    ds_read_b128 v[240:243], v4 offset:34816
    ds_read_b128 v[244:247], v4 offset:35840
    v_mfma_f32_16x16x32_bf16 v[248:251], v[12:15], v[136:139], v[248:251]
    v_mfma_f32_16x16x32_bf16 v[252:255], v[12:15], v[140:143], v[252:255]
    v_exp_f32 v200, v200
    v_exp_f32 v201, v201
    v_exp_f32 v202, v202
    v_exp_f32 v203, v203
    v_cvt_pk_bf16_f32 v144, v200, v201
    v_exp_f32 v204, v204
    v_exp_f32 v205, v205
    v_cvt_pk_bf16_f32 v145, v202, v203
    v_exp_f32 v206, v206
    v_exp_f32 v207, v207
    v_cvt_pk_bf16_f32 v148, v204, v205
    v_exp_f32 v208, v208
    v_exp_f32 v209, v209
    v_cvt_pk_bf16_f32 v149, v206, v207
    v_exp_f32 v210, v210
    v_exp_f32 v211, v211
    v_cvt_pk_bf16_f32 v146, v208, v209
    v_exp_f32 v212, v212
    v_exp_f32 v213, v213
    v_cvt_pk_bf16_f32 v147, v210, v211
    v_exp_f32 v214, v214
    v_exp_f32 v215, v215
    v_cvt_pk_bf16_f32 v150, v212, v213
    v_cvt_pk_bf16_f32 v151, v214, v215
    v_mfma_f32_16x16x32_bf16 v[248:251], v[12:15], v[144:147], v[248:251]
    s_nop 0
    v_mfma_f32_16x16x32_bf16 v[252:255], v[12:15], v[148:151], v[252:255]
    s_nop 5
    v_mov_b32 v9, v248
    s_nop 0
    v_mov_b32 v10, v252
    v_max_f32 v17, v9, v10
    v_readfirstlane_b32 s17, v8
    s_cmp_eq_u32 s17, s28
    s_cselect_b32 s16, 0, 0x71800000
    v_cmp_ngt_f32 vcc, s16, v17
    v_cmp_u_f32 s[76:77], v9, v10
    s_or_b64 vcc, vcc, s[76:77]
    s_cbranch_vccnz adaLN_cond__sliding_block_cached__moe_arch_mod__prompt_kernel_fixA
adaLN_cond__sliding_block_cached__moe_arch_mod__prompt_kernel_fixAb:
    v_rcp_f32 v9, v9
    v_rcp_f32 v10, v10
    s_lshl_b32 s25, s13, 3
    s_add_u32 s25, s25, s3
    s_lshl_b32 s25, s25, 18
    s_lshl_b32 s26, s12, 12
    s_add_u32 s25, s25, s26
    s_add_u32 s25, s25, 0x1000000
    s_add_u32 s26, s25, 131072
    s_lshl_b32 s63, s13, 3
    s_add_u32 s63, s63, s3
    s_lshl_b32 s63, s63, 5
    s_add_u32 s63, s63, s12
    s_lshl_b32 s63, s63, 2
    s_waitcnt lgkmcnt(3)
    v_mfma_f32_16x16x32_bf16 v[184:187], v[232:235], v[24:27], 0
    s_mov_b64 s[76:77], s[54:55]
    s_mov_b32 s78, 0xc00000
    s_mov_b32 s79, 0x20000
    v_mfma_f32_16x16x32_bf16 v[188:191], v[232:235], v[28:31], 0
    ds_read_b128 v[224:227], v4 offset:36864
    s_waitcnt lgkmcnt(3)
    v_mfma_f32_16x16x32_bf16 v[192:195], v[236:239], v[24:27], 0
    s_add_u32 s22, s14, 0x0
    s_add_u32 m0, s20, 0x10000
    s_nop 0
    buffer_load_dwordx4 v6, s[76:79], s22 offen lds
    v_mfma_f32_16x16x32_bf16 v[196:199], v[236:239], v[28:31], 0
    ds_read_b128 v[228:231], v4 offset:37888
    s_waitcnt lgkmcnt(3)
    v_mfma_f32_16x16x32_bf16 v[184:187], v[240:243], v[32:35], v[184:187]
    v_mfma_f32_16x16x32_bf16 v[188:191], v[240:243], v[36:39], v[188:191]
    ds_read_b128 v[232:235], v4 offset:38912
    s_waitcnt lgkmcnt(3)
    v_mfma_f32_16x16x32_bf16 v[192:195], v[244:247], v[32:35], v[192:195]
    v_mfma_f32_16x16x32_bf16 v[196:199], v[244:247], v[36:39], v[196:199]
    ds_read_b128 v[236:239], v4 offset:39936
    s_waitcnt lgkmcnt(3)
    v_mfma_f32_16x16x32_bf16 v[184:187], v[224:227], v[40:43], v[184:187]
    v_mfma_f32_16x16x32_bf16 v[188:191], v[224:227], v[44:47], v[188:191]
    ds_read_b128 v[240:243], v4 offset:40960
    s_waitcnt lgkmcnt(3)
    v_mfma_f32_16x16x32_bf16 v[192:195], v[228:231], v[40:43], v[192:195]
    s_add_u32 s22, s14, 0xc000
    s_add_u32 m0, s20, 0x10400
    s_nop 0
    buffer_load_dwordx4 v6, s[76:79], s22 offen lds
    v_mfma_f32_16x16x32_bf16 v[196:199], v[228:231], v[44:47], v[196:199]
    ds_read_b128 v[244:247], v4 offset:41984
    s_waitcnt lgkmcnt(3)
    v_mfma_f32_16x16x32_bf16 v[184:187], v[232:235], v[48:51], v[184:187]
    v_mfma_f32_16x16x32_bf16 v[188:191], v[232:235], v[52:55], v[188:191]
    ds_read_b128 v[224:227], v4 offset:43008
    s_waitcnt lgkmcnt(3)
    v_mfma_f32_16x16x32_bf16 v[192:195], v[236:239], v[48:51], v[192:195]
    v_mfma_f32_16x16x32_bf16 v[196:199], v[236:239], v[52:55], v[196:199]
    ds_read_b128 v[228:231], v4 offset:44032
    s_waitcnt lgkmcnt(3)
    v_mfma_f32_16x16x32_bf16 v[184:187], v[240:243], v[56:59], v[184:187]
    v_mfma_f32_16x16x32_bf16 v[188:191], v[240:243], v[60:63], v[188:191]
    ds_read_b128 v[232:235], v4 offset:45056
    s_waitcnt lgkmcnt(3)
    v_mfma_f32_16x16x32_bf16 v[192:195], v[244:247], v[56:59], v[192:195]
    v_mfma_f32_16x16x32_bf16 v[196:199], v[244:247], v[60:63], v[196:199]
    ds_read_b128 v[236:239], v4 offset:46080
    s_waitcnt lgkmcnt(3)
    v_mfma_f32_16x16x32_bf16 v[184:187], v[224:227], v[64:67], v[184:187]
    v_mfma_f32_16x16x32_bf16 v[188:191], v[224:227], v[68:71], v[188:191]
    ds_read_b128 v[240:243], v4 offset:47104
    s_waitcnt lgkmcnt(3)
    v_mfma_f32_16x16x32_bf16 v[192:195], v[228:231], v[64:67], v[192:195]
    v_mfma_f32_16x16x32_bf16 v[196:199], v[228:231], v[68:71], v[196:199]
    ds_read_b128 v[244:247], v4 offset:48128
    s_waitcnt lgkmcnt(3)
    v_mfma_f32_16x16x32_bf16 v[184:187], v[232:235], v[72:75], v[184:187]
    v_mfma_f32_16x16x32_bf16 v[188:191], v[232:235], v[76:79], v[188:191]
    s_waitcnt vmcnt(6)
    s_barrier
    ds_read_b128 v[224:227], v4 offset:49152
    s_waitcnt lgkmcnt(3)
    v_mfma_f32_16x16x32_bf16 v[192:195], v[236:239], v[72:75], v[192:195]
    v_mfma_f32_16x16x32_bf16 v[196:199], v[236:239], v[76:79], v[196:199]
    s_add_u32 s22, s14, 0xc0000
    s_add_u32 m0, s20, 0x14000
    s_nop 0
    buffer_load_dwordx4 v6, s[76:79], s22 offen lds
    ds_read_b128 v[228:231], v4 offset:50176
    s_waitcnt lgkmcnt(3)
    v_mfma_f32_16x16x32_bf16 v[184:187], v[240:243], v[80:83], v[184:187]
    v_mfma_f32_16x16x32_bf16 v[188:191], v[240:243], v[84:87], v[188:191]
    ds_read_b128 v[232:235], v4 offset:51200
    s_waitcnt lgkmcnt(3)
    v_mfma_f32_16x16x32_bf16 v[192:195], v[244:247], v[80:83], v[192:195]
    v_mfma_f32_16x16x32_bf16 v[196:199], v[244:247], v[84:87], v[196:199]
    ds_read_b128 v[236:239], v4 offset:52224
    s_waitcnt lgkmcnt(3)
    v_mfma_f32_16x16x32_bf16 v[184:187], v[224:227], v[88:91], v[184:187]
    v_mfma_f32_16x16x32_bf16 v[188:191], v[224:227], v[92:95], v[188:191]
    ds_read_b128 v[240:243], v4 offset:53248
    s_waitcnt lgkmcnt(3)
    v_mfma_f32_16x16x32_bf16 v[192:195], v[228:231], v[88:91], v[192:195]
    v_mfma_f32_16x16x32_bf16 v[196:199], v[228:231], v[92:95], v[196:199]
    s_add_u32 s22, s14, 0xcc000
    s_add_u32 m0, s20, 0x14400
    s_nop 0
    buffer_load_dwordx4 v6, s[76:79], s22 offen lds
    ds_read_b128 v[244:247], v4 offset:54272
    s_waitcnt lgkmcnt(3)
    v_mfma_f32_16x16x32_bf16 v[184:187], v[232:235], v[96:99], v[184:187]
    v_mfma_f32_16x16x32_bf16 v[188:191], v[232:235], v[100:103], v[188:191]
    ds_read_b128 v[224:227], v4 offset:55296
    s_waitcnt lgkmcnt(3)
    v_mfma_f32_16x16x32_bf16 v[192:195], v[236:239], v[96:99], v[192:195]
    v_mfma_f32_16x16x32_bf16 v[196:199], v[236:239], v[100:103], v[196:199]
    ds_read_b128 v[228:231], v4 offset:56320
    s_waitcnt lgkmcnt(3)
    v_mfma_f32_16x16x32_bf16 v[184:187], v[240:243], v[104:107], v[184:187]
    v_mfma_f32_16x16x32_bf16 v[188:191], v[240:243], v[108:111], v[188:191]
    ds_read_b128 v[232:235], v4 offset:57344
    s_waitcnt lgkmcnt(3)
    v_mfma_f32_16x16x32_bf16 v[192:195], v[244:247], v[104:107], v[192:195]
    v_mfma_f32_16x16x32_bf16 v[196:199], v[244:247], v[108:111], v[196:199]
    ds_read_b128 v[236:239], v4 offset:58368
    s_waitcnt lgkmcnt(3)
    v_mfma_f32_16x16x32_bf16 v[184:187], v[224:227], v[112:115], v[184:187]
    v_mfma_f32_16x16x32_bf16 v[188:191], v[224:227], v[116:119], v[188:191]
    ds_read_b128 v[240:243], v4 offset:59392
    s_waitcnt lgkmcnt(3)
    v_mfma_f32_16x16x32_bf16 v[192:195], v[228:231], v[112:115], v[192:195]
    v_mfma_f32_16x16x32_bf16 v[196:199], v[228:231], v[116:119], v[196:199]
    ds_read_b128 v[244:247], v4 offset:60416
    s_waitcnt lgkmcnt(3)
    v_mfma_f32_16x16x32_bf16 v[184:187], v[232:235], v[120:123], v[184:187]
    v_mfma_f32_16x16x32_bf16 v[188:191], v[232:235], v[124:127], v[188:191]
    ds_read_b128 v[224:227], v4 offset:61440
    s_waitcnt lgkmcnt(3)
    v_mfma_f32_16x16x32_bf16 v[192:195], v[236:239], v[120:123], v[192:195]
    v_mfma_f32_16x16x32_bf16 v[196:199], v[236:239], v[124:127], v[196:199]
    ds_read_b128 v[228:231], v4 offset:62464
    s_waitcnt lgkmcnt(3)
    v_mfma_f32_16x16x32_bf16 v[184:187], v[240:243], v[128:131], v[184:187]
    v_mfma_f32_16x16x32_bf16 v[188:191], v[240:243], v[132:135], v[188:191]
    ds_read_b128 v[232:235], v4 offset:63488
    s_waitcnt lgkmcnt(3)
    v_mfma_f32_16x16x32_bf16 v[192:195], v[244:247], v[128:131], v[192:195]
    v_mfma_f32_16x16x32_bf16 v[196:199], v[244:247], v[132:135], v[196:199]
    ds_read_b128 v[236:239], v4 offset:64512
    s_waitcnt lgkmcnt(3)
    v_mfma_f32_16x16x32_bf16 v[184:187], v[224:227], v[136:139], v[184:187]
    v_mfma_f32_16x16x32_bf16 v[188:191], v[224:227], v[140:143], v[188:191]
    s_waitcnt vmcnt(6)
    s_barrier
    ds_read_b128 v[240:243], v5 offset:0
    s_waitcnt lgkmcnt(3)
    v_mfma_f32_16x16x32_bf16 v[192:195], v[228:231], v[136:139], v[192:195]
    v_mfma_f32_16x16x32_bf16 v[196:199], v[228:231], v[140:143], v[196:199]
    s_add_u32 s22, s21, 0x90000
    s_add_u32 m0, s20, 0x18000
    s_nop 0
    buffer_load_dwordx4 v2, s[8:11], s22 offen sc1 lds
    ds_read_b128 v[244:247], v5 offset:1024
    s_waitcnt lgkmcnt(3)
    v_mfma_f32_16x16x32_bf16 v[184:187], v[232:235], v[144:147], v[184:187]
    v_mfma_f32_16x16x32_bf16 v[188:191], v[232:235], v[148:151], v[188:191]
    ds_read_b128 v[224:227], v5 offset:2048
    s_waitcnt lgkmcnt(3)
    v_mfma_f32_16x16x32_bf16 v[192:195], v[236:239], v[144:147], v[192:195]
    v_mfma_f32_16x16x32_bf16 v[196:199], v[236:239], v[148:151], v[196:199]
    ds_read_b128 v[228:231], v5 offset:3072
    s_waitcnt lgkmcnt(3)
    v_mfma_f32_16x16x32_bf16 v[200:203], v[240:243], v[24:27], 0
    v_mfma_f32_16x16x32_bf16 v[204:207], v[240:243], v[28:31], 0
    ds_read_b128 v[232:235], v5 offset:4096
    s_waitcnt lgkmcnt(3)
    v_mfma_f32_16x16x32_bf16 v[208:211], v[244:247], v[24:27], 0
    v_mfma_f32_16x16x32_bf16 v[212:215], v[244:247], v[28:31], 0
    s_add_u32 s22, s21, 0x90400
    s_add_u32 m0, s20, 0x18400
    s_nop 0
    buffer_load_dwordx4 v2, s[8:11], s22 offen sc1 lds
    ds_read_b128 v[236:239], v5 offset:5120
    v_mul_f32 v184, v184, v9
    s_waitcnt lgkmcnt(3)
    v_mfma_f32_16x16x32_bf16 v[200:203], v[224:227], v[32:35], v[200:203]
    v_mul_f32 v185, v185, v9
    v_mfma_f32_16x16x32_bf16 v[204:207], v[224:227], v[36:39], v[204:207]
    ds_read_b128 v[240:243], v5 offset:6144
    v_mul_f32 v186, v186, v9
    s_waitcnt lgkmcnt(3)
    v_mfma_f32_16x16x32_bf16 v[208:211], v[228:231], v[32:35], v[208:211]
    v_mul_f32 v187, v187, v9
    v_mfma_f32_16x16x32_bf16 v[212:215], v[228:231], v[36:39], v[212:215]
    ds_read_b128 v[244:247], v5 offset:7168
    v_mul_f32 v192, v192, v9
    s_waitcnt lgkmcnt(3)
    v_mfma_f32_16x16x32_bf16 v[200:203], v[232:235], v[40:43], v[200:203]
    v_mul_f32 v193, v193, v9
    v_mfma_f32_16x16x32_bf16 v[204:207], v[232:235], v[44:47], v[204:207]
    ds_read_b128 v[224:227], v5 offset:8192
    v_mul_f32 v194, v194, v9
    s_waitcnt lgkmcnt(3)
    v_mfma_f32_16x16x32_bf16 v[208:211], v[236:239], v[40:43], v[208:211]
    v_mul_f32 v195, v195, v9
    v_mfma_f32_16x16x32_bf16 v[212:215], v[236:239], v[44:47], v[212:215]
    ds_read_b128 v[228:231], v5 offset:9216
    v_cvt_pk_bf16_f32 v216, v184, v185
    s_waitcnt lgkmcnt(3)
    v_mfma_f32_16x16x32_bf16 v[200:203], v[240:243], v[48:51], v[200:203]
    v_cvt_pk_bf16_f32 v217, v186, v187
    v_mfma_f32_16x16x32_bf16 v[204:207], v[240:243], v[52:55], v[204:207]
    ds_read_b128 v[232:235], v5 offset:10240
    v_cvt_pk_bf16_f32 v218, v192, v193
    s_waitcnt lgkmcnt(3)
    v_mfma_f32_16x16x32_bf16 v[208:211], v[244:247], v[48:51], v[208:211]
    v_cvt_pk_bf16_f32 v219, v194, v195
    v_mfma_f32_16x16x32_bf16 v[212:215], v[244:247], v[52:55], v[212:215]
    ds_read_b128 v[236:239], v5 offset:11264
    buffer_store_dwordx4 v[216:219], v2, s[8:11], s25 offen offset:0 sc1
    s_waitcnt lgkmcnt(3)
    v_mfma_f32_16x16x32_bf16 v[200:203], v[224:227], v[56:59], v[200:203]
    v_mul_f32 v188, v188, v10
    v_mfma_f32_16x16x32_bf16 v[204:207], v[224:227], v[60:63], v[204:207]
    ds_read_b128 v[240:243], v5 offset:12288
    v_mul_f32 v189, v189, v10
    s_waitcnt lgkmcnt(3)
    v_mfma_f32_16x16x32_bf16 v[208:211], v[228:231], v[56:59], v[208:211]
    v_mul_f32 v190, v190, v10
    v_mfma_f32_16x16x32_bf16 v[212:215], v[228:231], v[60:63], v[212:215]
    ds_read_b128 v[244:247], v5 offset:13312
    v_mul_f32 v191, v191, v10
    s_waitcnt lgkmcnt(3)
    v_mfma_f32_16x16x32_bf16 v[200:203], v[232:235], v[64:67], v[200:203]
    v_mul_f32 v196, v196, v10
    v_mfma_f32_16x16x32_bf16 v[204:207], v[232:235], v[68:71], v[204:207]
    ds_read_b128 v[224:227], v5 offset:14336
    v_mul_f32 v197, v197, v10
    s_waitcnt lgkmcnt(3)
    v_mfma_f32_16x16x32_bf16 v[208:211], v[236:239], v[64:67], v[208:211]
    v_mul_f32 v198, v198, v10
    v_mfma_f32_16x16x32_bf16 v[212:215], v[236:239], v[68:71], v[212:215]
    ds_read_b128 v[228:231], v5 offset:15360
    v_mul_f32 v199, v199, v10
    s_waitcnt lgkmcnt(3)
    v_mfma_f32_16x16x32_bf16 v[200:203], v[240:243], v[72:75], v[200:203]
    v_cvt_pk_bf16_f32 v220, v188, v189
    v_mfma_f32_16x16x32_bf16 v[204:207], v[240:243], v[76:79], v[204:207]
    s_waitcnt vmcnt(7)
    s_barrier
    ds_read_b128 v[232:235], v5 offset:16384
    v_cvt_pk_bf16_f32 v221, v190, v191
    s_waitcnt lgkmcnt(3)
    v_mfma_f32_16x16x32_bf16 v[208:211], v[244:247], v[72:75], v[208:211]
    v_cvt_pk_bf16_f32 v222, v196, v197
    v_mfma_f32_16x16x32_bf16 v[212:215], v[244:247], v[76:79], v[212:215]
    s_add_u32 s22, s21, 0x94000
    s_add_u32 m0, s20, 0x1c000
    s_nop 0
    buffer_load_dwordx4 v2, s[8:11], s22 offen sc1 lds
    ds_read_b128 v[236:239], v5 offset:17408
    v_cvt_pk_bf16_f32 v223, v198, v199
    s_waitcnt lgkmcnt(3)
    v_mfma_f32_16x16x32_bf16 v[200:203], v[224:227], v[80:83], v[200:203]
    buffer_store_dwordx4 v[220:223], v2, s[8:11], s26 offen offset:0 sc1
    v_mfma_f32_16x16x32_bf16 v[204:207], v[224:227], v[84:87], v[204:207]
    ds_read_b128 v[240:243], v5 offset:18432
    s_waitcnt lgkmcnt(3)
    v_mfma_f32_16x16x32_bf16 v[208:211], v[228:231], v[80:83], v[208:211]
    v_mfma_f32_16x16x32_bf16 v[212:215], v[228:231], v[84:87], v[212:215]
    ds_read_b128 v[244:247], v5 offset:19456
    s_waitcnt lgkmcnt(3)
    v_mfma_f32_16x16x32_bf16 v[200:203], v[232:235], v[88:91], v[200:203]
    v_lshrrev_b32 v20, 4, v1
    v_lshlrev_b32 v21, 4, v20
    s_lshl_b32 s16, s2, 8
    s_add_u32 s16, s16, 0x550000
    buffer_load_dwordx4 v[152:155], v21, s[8:11], s16 offen offset:0 sc1
    buffer_load_dwordx4 v[156:159], v21, s[8:11], s16 offen offset:64 sc1
    buffer_load_dwordx4 v[160:163], v21, s[8:11], s16 offen offset:128 sc1
    buffer_load_dwordx4 v[164:167], v21, s[8:11], s16 offen offset:192 sc1
    v_lshlrev_b32 v11, 11, v20
    v_xor_b32 v20, s3, v20
    v_and_b32 v20, 1, v20
    v_lshl_add_u32 v11, v20, 5, v11
    v_bfe_u32 v20, v1, 2, 2
    v_lshl_add_u32 v11, v20, 6, v11
    v_and_b32 v20, 3, v1
    v_lshl_add_u32 v11, v20, 3, v11
    s_lshr_b32 s16, s3, 1
    s_lshl_b32 s16, s16, 8
    s_add_u32 s16, s16, 65536
    v_add_u32 v11, s16, v11
    v_mfma_f32_16x16x32_bf16 v[204:207], v[232:235], v[92:95], v[204:207]
    ds_read_b128 v[224:227], v5 offset:20480
    s_waitcnt lgkmcnt(3)
    v_mfma_f32_16x16x32_bf16 v[208:211], v[236:239], v[88:91], v[208:211]
    v_mfma_f32_16x16x32_bf16 v[212:215], v[236:239], v[92:95], v[212:215]
    s_add_u32 s22, s21, 0x94400
    s_add_u32 m0, s20, 0x1c400
    s_nop 0
    buffer_load_dwordx4 v2, s[8:11], s22 offen sc1 lds
    ds_read_b128 v[228:231], v5 offset:21504
    s_waitcnt lgkmcnt(3)
    v_mfma_f32_16x16x32_bf16 v[200:203], v[240:243], v[96:99], v[200:203]
    v_mfma_f32_16x16x32_bf16 v[204:207], v[240:243], v[100:103], v[204:207]
    ds_read_b128 v[232:235], v5 offset:22528
    s_waitcnt lgkmcnt(3)
    v_mfma_f32_16x16x32_bf16 v[208:211], v[244:247], v[96:99], v[208:211]
    v_mfma_f32_16x16x32_bf16 v[212:215], v[244:247], v[100:103], v[212:215]
    ds_read_b128 v[236:239], v5 offset:23552
    s_waitcnt lgkmcnt(3)
    v_mfma_f32_16x16x32_bf16 v[200:203], v[224:227], v[104:107], v[200:203]
    v_mfma_f32_16x16x32_bf16 v[204:207], v[224:227], v[108:111], v[204:207]
    ds_read_b128 v[240:243], v5 offset:24576
    s_waitcnt lgkmcnt(3)
    v_mfma_f32_16x16x32_bf16 v[208:211], v[228:231], v[104:107], v[208:211]
    v_mfma_f32_16x16x32_bf16 v[212:215], v[228:231], v[108:111], v[212:215]
    ds_read_b128 v[244:247], v5 offset:25600
    s_waitcnt lgkmcnt(3)
    v_mfma_f32_16x16x32_bf16 v[200:203], v[232:235], v[112:115], v[200:203]
    v_mfma_f32_16x16x32_bf16 v[204:207], v[232:235], v[116:119], v[204:207]
    ds_read_b128 v[224:227], v5 offset:26624
    s_waitcnt lgkmcnt(3)
    v_mfma_f32_16x16x32_bf16 v[208:211], v[236:239], v[112:115], v[208:211]
    v_mfma_f32_16x16x32_bf16 v[212:215], v[236:239], v[116:119], v[212:215]
    ds_read_b128 v[228:231], v5 offset:27648
    s_waitcnt lgkmcnt(3)
    v_mfma_f32_16x16x32_bf16 v[200:203], v[240:243], v[120:123], v[200:203]
    v_mfma_f32_16x16x32_bf16 v[204:207], v[240:243], v[124:127], v[204:207]
    ds_read_b128 v[232:235], v5 offset:28672
    s_waitcnt lgkmcnt(3)
    v_mfma_f32_16x16x32_bf16 v[208:211], v[244:247], v[120:123], v[208:211]
    v_mfma_f32_16x16x32_bf16 v[212:215], v[244:247], v[124:127], v[212:215]
    ds_read_b128 v[236:239], v5 offset:29696
    s_waitcnt lgkmcnt(3)
    v_mfma_f32_16x16x32_bf16 v[200:203], v[224:227], v[128:131], v[200:203]
    v_mfma_f32_16x16x32_bf16 v[204:207], v[224:227], v[132:135], v[204:207]
    ds_read_b128 v[240:243], v5 offset:30720
    s_waitcnt lgkmcnt(3)
    v_mfma_f32_16x16x32_bf16 v[208:211], v[228:231], v[128:131], v[208:211]
    v_mfma_f32_16x16x32_bf16 v[212:215], v[228:231], v[132:135], v[212:215]
    ds_read_b128 v[244:247], v5 offset:31744
    s_waitcnt lgkmcnt(3)
    v_mfma_f32_16x16x32_bf16 v[200:203], v[232:235], v[136:139], v[200:203]
    s_waitcnt vmcnt(5)
    s_add_u32 s16, s63, 0x570000
    v_mov_b32 v7, s28
    v_mov_b32 v8, 0
    s_mov_b64 exec, 1
    buffer_store_dword v7, v8, s[8:11], s16 offen sc1
    s_mov_b64 exec, -1
    v_mfma_f32_16x16x32_bf16 v[204:207], v[232:235], v[140:143], v[204:207]
    s_barrier
    ds_read_b128 v[224:227], v4 offset:32768
    s_waitcnt lgkmcnt(3)
    v_mfma_f32_16x16x32_bf16 v[208:211], v[236:239], v[136:139], v[208:211]
    v_mfma_f32_16x16x32_bf16 v[212:215], v[236:239], v[140:143], v[212:215]
    s_add_u32 s22, s21, 0x98000
    s_add_u32 m0, s20, 0x20000
    s_nop 0
    buffer_load_dwordx4 v2, s[8:11], s22 offen sc1 lds
    ds_read_b128 v[228:231], v4 offset:33792
    s_waitcnt lgkmcnt(3)
    v_mfma_f32_16x16x32_bf16 v[200:203], v[240:243], v[144:147], v[200:203]
    ds_read_b64_tr_b16 v[168:169], v11 offset:0
    ds_read_b64_tr_b16 v[170:171], v11 offset:1024
    ds_read_b64_tr_b16 v[172:173], v11 offset:8192
    ds_read_b64_tr_b16 v[174:175], v11 offset:9216
    ds_read_b64_tr_b16 v[176:177], v11 offset:16384
    ds_read_b64_tr_b16 v[178:179], v11 offset:17408
    ds_read_b64_tr_b16 v[180:181], v11 offset:24576
    ds_read_b64_tr_b16 v[182:183], v11 offset:25600
    v_mfma_f32_16x16x32_bf16 v[204:207], v[240:243], v[148:151], v[204:207]
    ds_read_b128 v[232:235], v4 offset:34816
    s_waitcnt lgkmcnt(11)
    v_mfma_f32_16x16x32_bf16 v[208:211], v[244:247], v[144:147], v[208:211]
    v_mfma_f32_16x16x32_bf16 v[212:215], v[244:247], v[148:151], v[212:215]
    ds_read_b128 v[236:239], v4 offset:35840
    s_waitcnt lgkmcnt(11)
    v_mfma_f32_16x16x32_bf16 v[184:187], v[224:227], v[24:27], 0
    v_mfma_f32_16x16x32_bf16 v[188:191], v[224:227], v[28:31], 0
    ds_read_b128 v[240:243], v4 offset:36864
    s_waitcnt lgkmcnt(11)
    v_mfma_f32_16x16x32_bf16 v[192:195], v[228:231], v[24:27], 0
    v_mfma_f32_16x16x32_bf16 v[196:199], v[228:231], v[28:31], 0
    s_add_u32 s22, s21, 0x98400
    s_add_u32 m0, s20, 0x20400
    s_nop 0
    buffer_load_dwordx4 v2, s[8:11], s22 offen sc1 lds
    ds_read_b128 v[244:247], v4 offset:37888
    v_mul_f32 v200, v200, v9
    s_waitcnt lgkmcnt(3)
    v_mfma_f32_16x16x32_bf16 v[184:187], v[232:235], v[32:35], v[184:187]
    v_mul_f32 v201, v201, v9
    v_mfma_f32_16x16x32_bf16 v[188:191], v[232:235], v[36:39], v[188:191]
    ds_read_b128 v[224:227], v4 offset:38912
    v_mul_f32 v202, v202, v9
    s_waitcnt lgkmcnt(3)
    v_mfma_f32_16x16x32_bf16 v[192:195], v[236:239], v[32:35], v[192:195]
    v_mul_f32 v203, v203, v9
    s_waitcnt vmcnt(7)
    v_mfma_f32_16x16x32_bf16 v[248:251], v[168:171], v[152:155], 0
    s_waitcnt vmcnt(6)
    v_mfma_f32_16x16x32_bf16 v[248:251], v[172:175], v[156:159], v[248:251]
    s_waitcnt vmcnt(5)
    v_mfma_f32_16x16x32_bf16 v[248:251], v[176:179], v[160:163], v[248:251]
    s_waitcnt vmcnt(4)
    v_mfma_f32_16x16x32_bf16 v[248:251], v[180:183], v[164:167], v[248:251]
    v_mfma_f32_16x16x32_bf16 v[196:199], v[236:239], v[36:39], v[196:199]
    ds_read_b128 v[228:231], v4 offset:39936
    v_mul_f32 v208, v208, v9
    s_waitcnt lgkmcnt(3)
    v_mfma_f32_16x16x32_bf16 v[184:187], v[240:243], v[40:43], v[184:187]
    v_mul_f32 v209, v209, v9
    v_mfma_f32_16x16x32_bf16 v[188:191], v[240:243], v[44:47], v[188:191]
    ds_read_b128 v[232:235], v4 offset:40960
    v_mul_f32 v210, v210, v9
    s_waitcnt lgkmcnt(3)
    v_mfma_f32_16x16x32_bf16 v[192:195], v[244:247], v[40:43], v[192:195]
    v_mul_f32 v211, v211, v9
    v_mfma_f32_16x16x32_bf16 v[196:199], v[244:247], v[44:47], v[196:199]
    ds_read_b128 v[236:239], v4 offset:41984
    v_cvt_pk_bf16_f32 v216, v200, v201
    s_waitcnt lgkmcnt(3)
    v_mfma_f32_16x16x32_bf16 v[184:187], v[224:227], v[48:51], v[184:187]
    v_cvt_pk_bf16_f32 v217, v202, v203
    v_mfma_f32_16x16x32_bf16 v[188:191], v[224:227], v[52:55], v[188:191]
    ds_read_b128 v[240:243], v4 offset:43008
    v_cvt_pk_bf16_f32 v218, v208, v209
    s_waitcnt lgkmcnt(3)
    v_mfma_f32_16x16x32_bf16 v[192:195], v[228:231], v[48:51], v[192:195]
    v_cvt_pk_bf16_f32 v219, v210, v211
    v_mfma_f32_16x16x32_bf16 v[196:199], v[228:231], v[52:55], v[196:199]
    ds_read_b128 v[244:247], v4 offset:44032
    buffer_store_dwordx4 v[216:219], v2, s[8:11], s25 offen offset:1024 sc1
    s_waitcnt lgkmcnt(3)
    v_mfma_f32_16x16x32_bf16 v[184:187], v[232:235], v[56:59], v[184:187]
    v_mul_f32 v204, v204, v10
    v_mfma_f32_16x16x32_bf16 v[188:191], v[232:235], v[60:63], v[188:191]
    ds_read_b128 v[224:227], v4 offset:45056
    v_mul_f32 v205, v205, v10
    s_waitcnt lgkmcnt(3)
    v_mfma_f32_16x16x32_bf16 v[192:195], v[236:239], v[56:59], v[192:195]
    v_mul_f32 v206, v206, v10
    v_lshrrev_b32 v20, 4, v1
    v_lshlrev_b32 v20, 4, v20
    s_lshr_b32 s16, s2, 5
    s_lshl_b32 s16, s16, 14
    s_and_b32 s17, s2, 31
    s_lshl_b32 s17, s17, 9
    s_add_u32 s16, s16, s17
    s_lshl_b32 s17, s3, 6
    s_add_u32 s16, s16, s17
    s_add_u32 s16, s16, 0x580000
    s_mov_b32 exec_lo, 0x10001
    s_mov_b32 exec_hi, 0x10001
    buffer_store_dwordx4 v[248:251], v20, s[8:11], s16 offen sc1
    s_mov_b64 exec, -1
    v_mfma_f32_16x16x32_bf16 v[196:199], v[236:239], v[60:63], v[196:199]
    ds_read_b128 v[228:231], v4 offset:46080
    v_mul_f32 v207, v207, v10
    s_waitcnt lgkmcnt(3)
    v_mfma_f32_16x16x32_bf16 v[184:187], v[240:243], v[64:67], v[184:187]
    v_mul_f32 v212, v212, v10
    v_mfma_f32_16x16x32_bf16 v[188:191], v[240:243], v[68:71], v[188:191]
    ds_read_b128 v[232:235], v4 offset:47104
    v_mul_f32 v213, v213, v10
    s_waitcnt lgkmcnt(3)
    v_mfma_f32_16x16x32_bf16 v[192:195], v[244:247], v[64:67], v[192:195]
    v_mul_f32 v214, v214, v10
    v_mfma_f32_16x16x32_bf16 v[196:199], v[244:247], v[68:71], v[196:199]
    ds_read_b128 v[236:239], v4 offset:48128
    v_mul_f32 v215, v215, v10
    s_waitcnt lgkmcnt(3)
    v_mfma_f32_16x16x32_bf16 v[184:187], v[224:227], v[72:75], v[184:187]
    v_cvt_pk_bf16_f32 v220, v204, v205
    v_mfma_f32_16x16x32_bf16 v[188:191], v[224:227], v[76:79], v[188:191]
    s_waitcnt vmcnt(5)
    s_barrier
    ds_read_b128 v[240:243], v4 offset:49152
    v_cvt_pk_bf16_f32 v221, v206, v207
    s_waitcnt lgkmcnt(3)
    v_mfma_f32_16x16x32_bf16 v[192:195], v[228:231], v[72:75], v[192:195]
    v_cvt_pk_bf16_f32 v222, v212, v213
    v_mfma_f32_16x16x32_bf16 v[196:199], v[228:231], v[76:79], v[196:199]
    s_add_u32 s22, s21, 0x9c000
    s_add_u32 m0, s20, 0x24000
    s_nop 0
    buffer_load_dwordx4 v2, s[8:11], s22 offen sc1 lds
    ds_read_b128 v[244:247], v4 offset:50176
    v_cvt_pk_bf16_f32 v223, v214, v215
    s_waitcnt lgkmcnt(3)
    v_mfma_f32_16x16x32_bf16 v[184:187], v[232:235], v[80:83], v[184:187]
    buffer_store_dwordx4 v[220:223], v2, s[8:11], s26 offen offset:1024 sc1
    v_mfma_f32_16x16x32_bf16 v[188:191], v[232:235], v[84:87], v[188:191]
    ds_read_b128 v[224:227], v4 offset:51200
    s_waitcnt lgkmcnt(3)
    v_mfma_f32_16x16x32_bf16 v[192:195], v[236:239], v[80:83], v[192:195]
    v_mfma_f32_16x16x32_bf16 v[196:199], v[236:239], v[84:87], v[196:199]
    s_add_u32 s22, s21, 0x9c400
    s_add_u32 m0, s20, 0x24400
    s_nop 0
    buffer_load_dwordx4 v2, s[8:11], s22 offen sc1 lds
    ds_read_b128 v[228:231], v4 offset:52224
    s_waitcnt lgkmcnt(3)
    v_mfma_f32_16x16x32_bf16 v[184:187], v[240:243], v[88:91], v[184:187]
    v_mfma_f32_16x16x32_bf16 v[188:191], v[240:243], v[92:95], v[188:191]
    ds_read_b128 v[232:235], v4 offset:53248
    s_waitcnt lgkmcnt(3)
    v_mfma_f32_16x16x32_bf16 v[192:195], v[244:247], v[88:91], v[192:195]
    v_mfma_f32_16x16x32_bf16 v[196:199], v[244:247], v[92:95], v[196:199]
    s_add_u32 s22, s24, 0x0
    s_add_u32 m0, s20, 0x10000
    s_nop 0
    buffer_load_dwordx4 v3, s[4:7], s22 offen lds
    ds_read_b128 v[236:239], v4 offset:54272
    s_waitcnt lgkmcnt(3)
    v_mfma_f32_16x16x32_bf16 v[184:187], v[224:227], v[96:99], v[184:187]
    v_mfma_f32_16x16x32_bf16 v[188:191], v[224:227], v[100:103], v[188:191]
    ds_read_b128 v[240:243], v4 offset:55296
    s_waitcnt lgkmcnt(3)
    v_mfma_f32_16x16x32_bf16 v[192:195], v[228:231], v[96:99], v[192:195]
    v_mfma_f32_16x16x32_bf16 v[196:199], v[228:231], v[100:103], v[196:199]
    s_add_u32 s22, s24, 0x2000
    s_add_u32 m0, s20, 0x10400
    s_nop 0
    buffer_load_dwordx4 v3, s[4:7], s22 offen lds
    ds_read_b128 v[244:247], v4 offset:56320
    s_waitcnt lgkmcnt(3)
    v_mfma_f32_16x16x32_bf16 v[184:187], v[232:235], v[104:107], v[184:187]
    v_mfma_f32_16x16x32_bf16 v[188:191], v[232:235], v[108:111], v[188:191]
    ds_read_b128 v[224:227], v4 offset:57344
    s_waitcnt lgkmcnt(3)
    v_mfma_f32_16x16x32_bf16 v[192:195], v[236:239], v[104:107], v[192:195]
    v_mfma_f32_16x16x32_bf16 v[196:199], v[236:239], v[108:111], v[196:199]
    ds_read_b128 v[228:231], v4 offset:58368
    s_waitcnt lgkmcnt(3)
    v_mfma_f32_16x16x32_bf16 v[184:187], v[240:243], v[112:115], v[184:187]
    v_mfma_f32_16x16x32_bf16 v[188:191], v[240:243], v[116:119], v[188:191]
    ds_read_b128 v[232:235], v4 offset:59392
    s_waitcnt lgkmcnt(3)
    v_mfma_f32_16x16x32_bf16 v[192:195], v[244:247], v[112:115], v[192:195]
    v_mfma_f32_16x16x32_bf16 v[196:199], v[244:247], v[116:119], v[196:199]
    ds_read_b128 v[236:239], v4 offset:60416
    s_waitcnt lgkmcnt(3)
    v_mfma_f32_16x16x32_bf16 v[184:187], v[224:227], v[120:123], v[184:187]
    v_mfma_f32_16x16x32_bf16 v[188:191], v[224:227], v[124:127], v[188:191]
    ds_read_b128 v[240:243], v4 offset:61440
    s_waitcnt lgkmcnt(3)
    v_mfma_f32_16x16x32_bf16 v[192:195], v[228:231], v[120:123], v[192:195]
    v_mfma_f32_16x16x32_bf16 v[196:199], v[228:231], v[124:127], v[196:199]
    ds_read_b128 v[244:247], v4 offset:62464
    s_waitcnt lgkmcnt(3)
    v_mfma_f32_16x16x32_bf16 v[184:187], v[232:235], v[128:131], v[184:187]
    v_mfma_f32_16x16x32_bf16 v[188:191], v[232:235], v[132:135], v[188:191]
    ds_read_b128 v[224:227], v4 offset:63488
    s_waitcnt lgkmcnt(3)
    v_mfma_f32_16x16x32_bf16 v[192:195], v[236:239], v[128:131], v[192:195]
    v_mfma_f32_16x16x32_bf16 v[196:199], v[236:239], v[132:135], v[196:199]
    ds_read_b128 v[228:231], v4 offset:64512
    s_waitcnt lgkmcnt(3)
    v_mfma_f32_16x16x32_bf16 v[184:187], v[240:243], v[136:139], v[184:187]
    v_mfma_f32_16x16x32_bf16 v[188:191], v[240:243], v[140:143], v[188:191]
    s_waitcnt vmcnt(7)
    s_barrier
    ds_read_b128 v[232:235], v5 offset:0
    s_waitcnt lgkmcnt(3)
    v_mfma_f32_16x16x32_bf16 v[192:195], v[244:247], v[136:139], v[192:195]
    v_mfma_f32_16x16x32_bf16 v[196:199], v[244:247], v[140:143], v[196:199]
    s_add_u32 s22, s24, 0x80000
    s_add_u32 m0, s20, 0x14000
    s_nop 0
    buffer_load_dwordx4 v3, s[4:7], s22 offen lds
    ds_read_b128 v[236:239], v5 offset:1024
    s_waitcnt lgkmcnt(3)
    v_mfma_f32_16x16x32_bf16 v[184:187], v[224:227], v[144:147], v[184:187]
    v_mfma_f32_16x16x32_bf16 v[188:191], v[224:227], v[148:151], v[188:191]
    ds_read_b128 v[240:243], v5 offset:2048
    s_waitcnt lgkmcnt(3)
    v_mfma_f32_16x16x32_bf16 v[192:195], v[228:231], v[144:147], v[192:195]
    v_mfma_f32_16x16x32_bf16 v[196:199], v[228:231], v[148:151], v[196:199]
    s_add_u32 s22, s24, 0x82000
    s_add_u32 m0, s20, 0x14400
    s_nop 0
    buffer_load_dwordx4 v3, s[4:7], s22 offen lds
    ds_read_b128 v[244:247], v5 offset:3072
    s_waitcnt lgkmcnt(3)
    v_mfma_f32_16x16x32_bf16 v[200:203], v[232:235], v[24:27], 0
    v_mfma_f32_16x16x32_bf16 v[204:207], v[232:235], v[28:31], 0
    ds_read_b128 v[224:227], v5 offset:4096
    s_waitcnt lgkmcnt(3)
    v_mfma_f32_16x16x32_bf16 v[208:211], v[236:239], v[24:27], 0
    v_mfma_f32_16x16x32_bf16 v[212:215], v[236:239], v[28:31], 0
    s_add_u32 s22, s24, 0x100000
    s_add_u32 m0, s20, 0x18000
    s_nop 0
    buffer_load_dwordx4 v3, s[4:7], s22 offen lds
    ds_read_b128 v[228:231], v5 offset:5120
    v_mul_f32 v184, v184, v9
    s_waitcnt lgkmcnt(3)
    v_mfma_f32_16x16x32_bf16 v[200:203], v[240:243], v[32:35], v[200:203]
    v_mul_f32 v185, v185, v9
    s_bfe_u32 s30, s2, 0x20001
    s_lshl_b32 s30, s30, 2
    s_bfe_u32 s17, s2, 0x20003
    s_add_u32 s30, s30, s17
    s_lshr_b32 s31, s2, 5
    s_and_b32 s17, s3, 3
    s_lshl_b32 s19, s30, 2
    s_add_u32 s19, s19, s17
    s_and_b32 s16, s2, 1
    s_lshl_b32 s17, s19, 18
    s_lshl_b32 s23, s16, 16
    s_add_u32 s17, s17, s23
    s_add_u32 s17, s17, 0x1000000
    v_add_u32 v6, s17, v2
    s_lshl_b32 s19, s19, 7
    s_lshl_b32 s23, s16, 6
    s_add_u32 s19, s19, s23
    s_add_u32 s19, s19, 0x570000
    v_and_b32 v13, 15, v1
    v_lshlrev_b32 v13, 2, v13
    buffer_load_dword v12, v13, s[8:11], s19 offen sc1
    v_mfma_f32_16x16x32_bf16 v[204:207], v[240:243], v[36:39], v[204:207]
    ds_read_b128 v[232:235], v5 offset:6144
    v_mul_f32 v186, v186, v9
    s_waitcnt lgkmcnt(3)
    v_mfma_f32_16x16x32_bf16 v[208:211], v[244:247], v[32:35], v[208:211]
    v_mul_f32 v187, v187, v9
    v_mfma_f32_16x16x32_bf16 v[212:215], v[244:247], v[36:39], v[212:215]
    s_add_u32 s22, s24, 0x102000
    s_add_u32 m0, s20, 0x18400
    s_nop 0
    buffer_load_dwordx4 v3, s[4:7], s22 offen lds
    ds_read_b128 v[236:239], v5 offset:7168
    v_mul_f32 v192, v192, v9
    s_waitcnt lgkmcnt(3)
    v_mfma_f32_16x16x32_bf16 v[200:203], v[224:227], v[40:43], v[200:203]
    v_mul_f32 v193, v193, v9
    v_mfma_f32_16x16x32_bf16 v[204:207], v[224:227], v[44:47], v[204:207]
    ds_read_b128 v[240:243], v5 offset:8192
    v_mul_f32 v194, v194, v9
    s_waitcnt lgkmcnt(3)
    v_mfma_f32_16x16x32_bf16 v[208:211], v[228:231], v[40:43], v[208:211]
    v_mul_f32 v195, v195, v9
    v_mfma_f32_16x16x32_bf16 v[212:215], v[228:231], v[44:47], v[212:215]
    ds_read_b128 v[244:247], v5 offset:9216
    v_cvt_pk_bf16_f32 v216, v184, v185
    s_waitcnt lgkmcnt(3)
    v_mfma_f32_16x16x32_bf16 v[200:203], v[232:235], v[48:51], v[200:203]
    v_cvt_pk_bf16_f32 v217, v186, v187
    v_mfma_f32_16x16x32_bf16 v[204:207], v[232:235], v[52:55], v[204:207]
    ds_read_b128 v[224:227], v5 offset:10240
    v_cvt_pk_bf16_f32 v218, v192, v193
    s_waitcnt lgkmcnt(3)
    v_mfma_f32_16x16x32_bf16 v[208:211], v[236:239], v[48:51], v[208:211]
    v_cvt_pk_bf16_f32 v219, v194, v195
    v_mfma_f32_16x16x32_bf16 v[212:215], v[236:239], v[52:55], v[212:215]
    ds_read_b128 v[228:231], v5 offset:11264
    buffer_store_dwordx4 v[216:219], v2, s[8:11], s25 offen offset:2048 sc1
    s_waitcnt lgkmcnt(3)
    v_mfma_f32_16x16x32_bf16 v[200:203], v[240:243], v[56:59], v[200:203]
    v_mul_f32 v188, v188, v10
    v_mfma_f32_16x16x32_bf16 v[204:207], v[240:243], v[60:63], v[204:207]
    ds_read_b128 v[232:235], v5 offset:12288
    v_mul_f32 v189, v189, v10
    s_waitcnt lgkmcnt(3)
    v_mfma_f32_16x16x32_bf16 v[208:211], v[244:247], v[56:59], v[208:211]
    v_mul_f32 v190, v190, v10
    v_mfma_f32_16x16x32_bf16 v[212:215], v[244:247], v[60:63], v[212:215]
    ds_read_b128 v[236:239], v5 offset:13312
    v_mul_f32 v191, v191, v10
    s_waitcnt lgkmcnt(3)
    v_mfma_f32_16x16x32_bf16 v[200:203], v[224:227], v[64:67], v[200:203]
    v_mul_f32 v196, v196, v10
    s_waitcnt vmcnt(11)
    v_mfma_f32_16x16x32_bf16 v[204:207], v[224:227], v[68:71], v[204:207]
    ds_read_b128 v[240:243], v5 offset:14336
    v_mul_f32 v197, v197, v10
    s_waitcnt lgkmcnt(3)
    v_mfma_f32_16x16x32_bf16 v[208:211], v[228:231], v[64:67], v[208:211]
    v_mul_f32 v198, v198, v10
    v_mfma_f32_16x16x32_bf16 v[212:215], v[228:231], v[68:71], v[212:215]
    ds_read_b128 v[244:247], v5 offset:15360
    v_mul_f32 v199, v199, v10
    s_waitcnt lgkmcnt(3)
    v_mfma_f32_16x16x32_bf16 v[200:203], v[232:235], v[72:75], v[200:203]
    v_cvt_pk_bf16_f32 v220, v188, v189
    v_mfma_f32_16x16x32_bf16 v[204:207], v[232:235], v[76:79], v[204:207]
    s_waitcnt vmcnt(8)
    s_barrier
    ds_read_b128 v[224:227], v5 offset:16384
    v_cvt_pk_bf16_f32 v221, v190, v191
    s_waitcnt lgkmcnt(3)
    v_mfma_f32_16x16x32_bf16 v[208:211], v[236:239], v[72:75], v[208:211]
    v_cvt_pk_bf16_f32 v222, v196, v197
    v_mfma_f32_16x16x32_bf16 v[212:215], v[236:239], v[76:79], v[212:215]
    s_add_u32 s22, s24, 0x180000
    s_add_u32 m0, s20, 0x1c000
    s_nop 0
    buffer_load_dwordx4 v3, s[4:7], s22 offen lds
    ds_read_b128 v[228:231], v5 offset:17408
    v_cvt_pk_bf16_f32 v223, v198, v199
    v_mov_b32 v20, s28
    v_mov_b32 v21, 0
    s_lshl_b32 s16, s2, 2
    s_add_u32 s16, s16, 0x560000
    s_cmp_eq_u32 s3, 0
    s_cselect_b32 s16, s16, 0x7ffffff0
    s_mov_b64 exec, 1
    buffer_store_dword v20, v21, s[8:11], s16 offen sc1
    s_mov_b64 exec, -1
    s_waitcnt lgkmcnt(3)
    v_mfma_f32_16x16x32_bf16 v[200:203], v[240:243], v[80:83], v[200:203]
    buffer_store_dwordx4 v[220:223], v2, s[8:11], s26 offen offset:2048 sc1
    s_add_u32 s16, s63, 0x572000
    v_mov_b32 v14, s28
    v_mov_b32 v15, 0
    s_mov_b64 exec, 1
    buffer_store_dword v14, v15, s[8:11], s16 offen sc1
    s_mov_b64 exec, -1
    v_mfma_f32_16x16x32_bf16 v[204:207], v[240:243], v[84:87], v[204:207]
    ds_read_b128 v[232:235], v5 offset:18432
    s_waitcnt lgkmcnt(3)
    v_mfma_f32_16x16x32_bf16 v[208:211], v[244:247], v[80:83], v[208:211]
    v_mfma_f32_16x16x32_bf16 v[212:215], v[244:247], v[84:87], v[212:215]
    ds_read_b128 v[236:239], v5 offset:19456
    s_waitcnt lgkmcnt(3)
    v_mfma_f32_16x16x32_bf16 v[200:203], v[224:227], v[88:91], v[200:203]
    v_mfma_f32_16x16x32_bf16 v[204:207], v[224:227], v[92:95], v[204:207]
    ds_read_b128 v[240:243], v5 offset:20480
    s_waitcnt vmcnt(6)
    v_cmp_ne_u32 vcc, s28, v12
    s_cbranch_vccnz adaLN_cond__sliding_block_cached__moe_arch_mod__prompt_kernel_o5r
adaLN_cond__sliding_block_cached__moe_arch_mod__prompt_kernel_o5b:
    s_waitcnt lgkmcnt(3)
    v_mfma_f32_16x16x32_bf16 v[208:211], v[228:231], v[88:91], v[208:211]
    s_mov_b32 s23, 0x0
    buffer_load_dwordx4 v[24:27], v6, s[8:11], s23 offen offset:0 sc1
    v_mfma_f32_16x16x32_bf16 v[212:215], v[228:231], v[92:95], v[212:215]
    s_add_u32 s22, s24, 0x182000
    s_add_u32 m0, s20, 0x1c400
    s_nop 0
    buffer_load_dwordx4 v3, s[4:7], s22 offen lds
    ds_read_b128 v[244:247], v5 offset:21504
    s_waitcnt lgkmcnt(3)
    v_mfma_f32_16x16x32_bf16 v[200:203], v[232:235], v[96:99], v[200:203]
    v_mfma_f32_16x16x32_bf16 v[204:207], v[232:235], v[100:103], v[204:207]
    ds_read_b128 v[224:227], v5 offset:22528
    s_mov_b32 s23, 0x20000
    buffer_load_dwordx4 v[28:31], v6, s[8:11], s23 offen offset:0 sc1
    s_waitcnt lgkmcnt(3)
    v_mfma_f32_16x16x32_bf16 v[208:211], v[236:239], v[96:99], v[208:211]
    v_mfma_f32_16x16x32_bf16 v[212:215], v[236:239], v[100:103], v[212:215]
    ds_read_b128 v[228:231], v5 offset:23552
    s_waitcnt lgkmcnt(3)
    v_mfma_f32_16x16x32_bf16 v[200:203], v[240:243], v[104:107], v[200:203]
    v_mfma_f32_16x16x32_bf16 v[204:207], v[240:243], v[108:111], v[204:207]
    ds_read_b128 v[232:235], v5 offset:24576
    s_mov_b32 s23, 0x2000
    buffer_load_dwordx4 v[32:35], v6, s[8:11], s23 offen offset:0 sc1
    s_waitcnt lgkmcnt(3)
    v_mfma_f32_16x16x32_bf16 v[208:211], v[244:247], v[104:107], v[208:211]
    v_mfma_f32_16x16x32_bf16 v[212:215], v[244:247], v[108:111], v[212:215]
    ds_read_b128 v[236:239], v5 offset:25600
    s_waitcnt lgkmcnt(3)
    v_mfma_f32_16x16x32_bf16 v[200:203], v[224:227], v[112:115], v[200:203]
    s_mov_b32 s23, 0x22000
    buffer_load_dwordx4 v[36:39], v6, s[8:11], s23 offen offset:0 sc1
    v_mfma_f32_16x16x32_bf16 v[204:207], v[224:227], v[116:119], v[204:207]
    ds_read_b128 v[240:243], v5 offset:26624
    s_waitcnt lgkmcnt(3)
    v_mfma_f32_16x16x32_bf16 v[208:211], v[228:231], v[112:115], v[208:211]
    v_mfma_f32_16x16x32_bf16 v[212:215], v[228:231], v[116:119], v[212:215]
    ds_read_b128 v[244:247], v5 offset:27648
    s_waitcnt lgkmcnt(3)
    v_mfma_f32_16x16x32_bf16 v[200:203], v[232:235], v[120:123], v[200:203]
    s_mov_b32 s23, 0x4000
    buffer_load_dwordx4 v[40:43], v6, s[8:11], s23 offen offset:0 sc1
    v_mfma_f32_16x16x32_bf16 v[204:207], v[232:235], v[124:127], v[204:207]
    ds_read_b128 v[224:227], v5 offset:28672
    s_waitcnt lgkmcnt(3)
    v_mfma_f32_16x16x32_bf16 v[208:211], v[236:239], v[120:123], v[208:211]
    v_mfma_f32_16x16x32_bf16 v[212:215], v[236:239], v[124:127], v[212:215]
    ds_read_b128 v[228:231], v5 offset:29696
    s_waitcnt lgkmcnt(3)
    v_mfma_f32_16x16x32_bf16 v[200:203], v[240:243], v[128:131], v[200:203]
    s_mov_b32 s23, 0x24000
    buffer_load_dwordx4 v[44:47], v6, s[8:11], s23 offen offset:0 sc1
    v_mfma_f32_16x16x32_bf16 v[204:207], v[240:243], v[132:135], v[204:207]
    ds_read_b128 v[232:235], v5 offset:30720
    s_waitcnt lgkmcnt(3)
    v_mfma_f32_16x16x32_bf16 v[208:211], v[244:247], v[128:131], v[208:211]
    v_mfma_f32_16x16x32_bf16 v[212:215], v[244:247], v[132:135], v[212:215]
    ds_read_b128 v[236:239], v5 offset:31744
    s_mov_b32 s23, 0x6000
    buffer_load_dwordx4 v[48:51], v6, s[8:11], s23 offen offset:0 sc1
    s_waitcnt lgkmcnt(3)
    v_mfma_f32_16x16x32_bf16 v[200:203], v[224:227], v[136:139], v[200:203]
    v_bfe_u32 v18, v1, 2, 2
    v_lshrrev_b32 v19, 4, v1
    v_mfma_f32_16x16x32_bf16 v[204:207], v[224:227], v[140:143], v[204:207]
    v_and_b32 v17, 3, v1
    v_lshlrev_b32 v16, 11, v19
    s_waitcnt lgkmcnt(2)
    v_mfma_f32_16x16x32_bf16 v[208:211], v[228:231], v[136:139], v[208:211]
    v_lshl_add_u32 v16, v18, 6, v16
    v_lshl_add_u32 v16, v17, 3, v16
    v_mfma_f32_16x16x32_bf16 v[212:215], v[228:231], v[140:143], v[212:215]
    s_mov_b32 s23, 0x26000
    buffer_load_dwordx4 v[52:55], v6, s[8:11], s23 offen offset:0 sc1
    v_add_u32 v16, 0x10000, v16
    v_and_b32 v19, 1, v19
    s_waitcnt lgkmcnt(1)
    v_mfma_f32_16x16x32_bf16 v[200:203], v[232:235], v[144:147], v[200:203]
    v_lshlrev_b32 v19, 5, v19
    v_sub_u32 v5, v16, v19
    v_mfma_f32_16x16x32_bf16 v[204:207], v[232:235], v[148:151], v[204:207]
    v_add_u32 v4, v16, v19
    v_add_u32 v7, 0x10000, v4
    s_waitcnt lgkmcnt(0)
    v_mfma_f32_16x16x32_bf16 v[208:211], v[236:239], v[144:147], v[208:211]
    v_add_u32 v8, 0x10000, v5
    v_mfma_f32_16x16x32_bf16 v[212:215], v[236:239], v[148:151], v[212:215]
    v_mul_f32 v200, v200, v9
    v_mul_f32 v201, v201, v9
    v_mul_f32 v202, v202, v9
    v_mul_f32 v203, v203, v9
    s_nop 1
    v_mul_f32 v208, v208, v9
    v_mul_f32 v209, v209, v9
    v_mul_f32 v210, v210, v9
    v_mul_f32 v211, v211, v9
    v_cvt_pk_bf16_f32 v216, v200, v201
    v_cvt_pk_bf16_f32 v217, v202, v203
    v_cvt_pk_bf16_f32 v218, v208, v209
    v_cvt_pk_bf16_f32 v219, v210, v211
    buffer_store_dwordx4 v[216:219], v2, s[8:11], s25 offen offset:3072 sc1
    v_mul_f32 v204, v204, v10
    v_mul_f32 v205, v205, v10
    v_mul_f32 v206, v206, v10
    v_mul_f32 v207, v207, v10
    v_mul_f32 v212, v212, v10
    v_mul_f32 v213, v213, v10
    v_mul_f32 v214, v214, v10
    v_mul_f32 v215, v215, v10
    v_cvt_pk_bf16_f32 v220, v204, v205
    v_cvt_pk_bf16_f32 v221, v206, v207
    v_cvt_pk_bf16_f32 v222, v212, v213
    v_cvt_pk_bf16_f32 v223, v214, v215
    buffer_store_dwordx4 v[220:223], v2, s[8:11], s26 offen offset:3072 sc1
    s_and_b32 s15, s2, 1
    s_barrier
    ds_read_b64_tr_b16 v[224:225], v4 offset:0
    ds_read_b64_tr_b16 v[226:227], v4 offset:1024
    ds_read_b64_tr_b16 v[228:229], v5 offset:32
    ds_read_b64_tr_b16 v[230:231], v5 offset:1056
    ds_read_b64_tr_b16 v[232:233], v4 offset:256
    ds_read_b64_tr_b16 v[234:235], v4 offset:1280
    ds_read_b64_tr_b16 v[236:237], v5 offset:288
    ds_read_b64_tr_b16 v[238:239], v5 offset:1312
    s_waitcnt vmcnt(10) lgkmcnt(6)
    v_mfma_f32_16x16x32_bf16 v[88:91], v[224:227], v[24:27], 0
    ds_read_b64_tr_b16 v[240:241], v4 offset:512
    s_waitcnt vmcnt(8)
    v_mfma_f32_16x16x32_bf16 v[92:95], v[224:227], v[28:31], 0
    s_add_u32 s22, s24, 0x200000
    s_add_u32 m0, s20, 0x20000
    s_nop 0
    buffer_load_dwordx4 v3, s[4:7], s22 offen lds
    ds_read_b64_tr_b16 v[242:243], v4 offset:1536
    s_waitcnt lgkmcnt(6)
    v_mfma_f32_16x16x32_bf16 v[96:99], v[228:231], v[24:27], 0
    ds_read_b64_tr_b16 v[244:245], v5 offset:544
    s_mov_b32 s23, 0x8000
    buffer_load_dwordx4 v[56:59], v6, s[8:11], s23 offen offset:0 sc1
    v_mfma_f32_16x16x32_bf16 v[100:103], v[228:231], v[28:31], 0
    ds_read_b64_tr_b16 v[246:247], v5 offset:1568
    s_waitcnt lgkmcnt(6)
    v_mfma_f32_16x16x32_bf16 v[104:107], v[232:235], v[24:27], 0
    s_add_u32 s22, s24, 0x202000
    s_add_u32 m0, s20, 0x20400
    s_nop 0
    buffer_load_dwordx4 v3, s[4:7], s22 offen lds
    ds_read_b64_tr_b16 v[224:225], v4 offset:768
    v_mfma_f32_16x16x32_bf16 v[108:111], v[232:235], v[28:31], 0
    ds_read_b64_tr_b16 v[226:227], v4 offset:1792
    s_mov_b32 s23, 0x28000
    buffer_load_dwordx4 v[60:63], v6, s[8:11], s23 offen offset:0 sc1
    s_waitcnt lgkmcnt(6)
    v_mfma_f32_16x16x32_bf16 v[112:115], v[236:239], v[24:27], 0
    ds_read_b64_tr_b16 v[228:229], v5 offset:800
    v_mfma_f32_16x16x32_bf16 v[116:119], v[236:239], v[28:31], 0
    ds_read_b64_tr_b16 v[230:231], v5 offset:1824
    s_waitcnt lgkmcnt(6)
    v_mfma_f32_16x16x32_bf16 v[120:123], v[240:243], v[24:27], 0
    v_mfma_f32_16x16x32_bf16 v[124:127], v[240:243], v[28:31], 0
    s_barrier
    ds_read_b64_tr_b16 v[232:233], v4 offset:16384
    ds_read_b64_tr_b16 v[234:235], v4 offset:17408
    s_waitcnt lgkmcnt(6)
    v_mfma_f32_16x16x32_bf16 v[128:131], v[244:247], v[24:27], 0
    s_add_u32 s22, s24, 0x280000
    s_add_u32 m0, s20, 0x24000
    s_nop 0
    buffer_load_dwordx4 v3, s[4:7], s22 offen lds
    ds_read_b64_tr_b16 v[236:237], v5 offset:16416
    v_mfma_f32_16x16x32_bf16 v[132:135], v[244:247], v[28:31], 0
    ds_read_b64_tr_b16 v[238:239], v5 offset:17440
    s_waitcnt lgkmcnt(6)
    v_mfma_f32_16x16x32_bf16 v[136:139], v[224:227], v[24:27], 0
    ds_read_b64_tr_b16 v[240:241], v4 offset:16640
    v_mfma_f32_16x16x32_bf16 v[140:143], v[224:227], v[28:31], 0
    s_add_u32 s22, s24, 0x282000
    s_add_u32 m0, s20, 0x24400
    s_nop 0
    buffer_load_dwordx4 v3, s[4:7], s22 offen lds
    ds_read_b64_tr_b16 v[242:243], v4 offset:17664
    s_waitcnt lgkmcnt(6)
    v_mfma_f32_16x16x32_bf16 v[144:147], v[228:231], v[24:27], 0
    ds_read_b64_tr_b16 v[244:245], v5 offset:16672
    v_mfma_f32_16x16x32_bf16 v[148:151], v[228:231], v[28:31], 0
    ds_read_b64_tr_b16 v[246:247], v5 offset:17696
    s_waitcnt vmcnt(13) lgkmcnt(6)
    v_mfma_f32_16x16x32_bf16 v[88:91], v[232:235], v[32:35], v[88:91]
    ds_read_b64_tr_b16 v[224:225], v4 offset:16896
    s_waitcnt vmcnt(12)
    v_mfma_f32_16x16x32_bf16 v[92:95], v[232:235], v[36:39], v[92:95]
    ds_read_b64_tr_b16 v[226:227], v4 offset:17920
    s_waitcnt lgkmcnt(6)
    v_mfma_f32_16x16x32_bf16 v[96:99], v[236:239], v[32:35], v[96:99]
    ds_read_b64_tr_b16 v[228:229], v5 offset:16928
    s_mov_b32 s23, 0xa000
    buffer_load_dwordx4 v[24:27], v6, s[8:11], s23 offen offset:0 sc1
    v_mfma_f32_16x16x32_bf16 v[100:103], v[236:239], v[36:39], v[100:103]
    ds_read_b64_tr_b16 v[230:231], v5 offset:17952
    s_waitcnt lgkmcnt(6)
    v_mfma_f32_16x16x32_bf16 v[104:107], v[240:243], v[32:35], v[104:107]
    v_and_b32 v250, 7, v1
    v_lshlrev_b32 v250, 7, v250
    s_lshr_b32 s14, s2, 3
    s_lshl_b32 s14, s14, 2
    s_add_u32 s14, s14, 0x560000
    buffer_load_dword v248, v250, s[8:11], s14 offen sc1
    ds_read_b64_tr_b16 v[232:233], v4 offset:17152
    v_mfma_f32_16x16x32_bf16 v[108:111], v[240:243], v[36:39], v[108:111]
    ds_read_b64_tr_b16 v[234:235], v4 offset:18176
    s_mov_b32 s23, 0x2a000
    buffer_load_dwordx4 v[28:31], v6, s[8:11], s23 offen offset:0 sc1
    s_waitcnt lgkmcnt(6)
    v_mfma_f32_16x16x32_bf16 v[112:115], v[244:247], v[32:35], v[112:115]
    ds_read_b64_tr_b16 v[236:237], v5 offset:17184
    v_mfma_f32_16x16x32_bf16 v[116:119], v[244:247], v[36:39], v[116:119]
    ds_read_b64_tr_b16 v[238:239], v5 offset:18208
    s_waitcnt lgkmcnt(6)
    v_mfma_f32_16x16x32_bf16 v[120:123], v[224:227], v[32:35], v[120:123]
    v_mfma_f32_16x16x32_bf16 v[124:127], v[224:227], v[36:39], v[124:127]
    s_barrier
    ds_read_b64_tr_b16 v[240:241], v4 offset:32768
    ds_read_b64_tr_b16 v[242:243], v4 offset:33792
    s_waitcnt lgkmcnt(6)
    v_mfma_f32_16x16x32_bf16 v[128:131], v[228:231], v[32:35], v[128:131]
    s_add_u32 s22, s24, 0x300000
    s_add_u32 m0, s20, 0x10000
    s_nop 0
    buffer_load_dwordx4 v3, s[4:7], s22 offen lds
    ds_read_b64_tr_b16 v[244:245], v5 offset:32800
    v_mfma_f32_16x16x32_bf16 v[132:135], v[228:231], v[36:39], v[132:135]
    ds_read_b64_tr_b16 v[246:247], v5 offset:33824
    s_waitcnt lgkmcnt(6)
    v_mfma_f32_16x16x32_bf16 v[136:139], v[232:235], v[32:35], v[136:139]
    ds_read_b64_tr_b16 v[224:225], v4 offset:33024
    v_mfma_f32_16x16x32_bf16 v[140:143], v[232:235], v[36:39], v[140:143]
    s_add_u32 s22, s24, 0x302000
    s_add_u32 m0, s20, 0x10400
    s_nop 0
    buffer_load_dwordx4 v3, s[4:7], s22 offen lds
    ds_read_b64_tr_b16 v[226:227], v4 offset:34048
    s_waitcnt lgkmcnt(6)
    v_mfma_f32_16x16x32_bf16 v[144:147], v[236:239], v[32:35], v[144:147]
    s_add_u32 s16, s63, 0x574000
    v_mov_b32 v14, s28
    v_mov_b32 v15, 0
    s_mov_b64 exec, 1
    buffer_store_dword v14, v15, s[8:11], s16 offen sc1
    s_mov_b64 exec, -1
    ds_read_b64_tr_b16 v[228:229], v5 offset:33056
    v_mfma_f32_16x16x32_bf16 v[148:151], v[236:239], v[36:39], v[148:151]
    ds_read_b64_tr_b16 v[230:231], v5 offset:34080
    s_waitcnt vmcnt(17) lgkmcnt(6)
    v_mfma_f32_16x16x32_bf16 v[88:91], v[240:243], v[40:43], v[88:91]
    ds_read_b64_tr_b16 v[232:233], v4 offset:33280
    s_waitcnt vmcnt(16)
    v_mfma_f32_16x16x32_bf16 v[92:95], v[240:243], v[44:47], v[92:95]
    ds_read_b64_tr_b16 v[234:235], v4 offset:34304
    s_waitcnt lgkmcnt(6)
    v_mfma_f32_16x16x32_bf16 v[96:99], v[244:247], v[40:43], v[96:99]
    ds_read_b64_tr_b16 v[236:237], v5 offset:33312
    s_mov_b32 s23, 0xc000
    buffer_load_dwordx4 v[32:35], v6, s[8:11], s23 offen offset:0 sc1
    v_mfma_f32_16x16x32_bf16 v[100:103], v[244:247], v[44:47], v[100:103]
    ds_read_b64_tr_b16 v[238:239], v5 offset:34336
    s_waitcnt lgkmcnt(6)
    v_mfma_f32_16x16x32_bf16 v[104:107], v[224:227], v[40:43], v[104:107]
    ds_read_b64_tr_b16 v[240:241], v4 offset:33536
    v_mfma_f32_16x16x32_bf16 v[108:111], v[224:227], v[44:47], v[108:111]
    ds_read_b64_tr_b16 v[242:243], v4 offset:34560
    s_mov_b32 s23, 0x2c000
    buffer_load_dwordx4 v[36:39], v6, s[8:11], s23 offen offset:0 sc1
    s_waitcnt lgkmcnt(6)
    v_mfma_f32_16x16x32_bf16 v[112:115], v[228:231], v[40:43], v[112:115]
    ds_read_b64_tr_b16 v[244:245], v5 offset:33568
    v_mfma_f32_16x16x32_bf16 v[116:119], v[228:231], v[44:47], v[116:119]
    ds_read_b64_tr_b16 v[246:247], v5 offset:34592
    s_waitcnt lgkmcnt(6)
    v_mfma_f32_16x16x32_bf16 v[120:123], v[232:235], v[40:43], v[120:123]
    v_mfma_f32_16x16x32_bf16 v[124:127], v[232:235], v[44:47], v[124:127]
    s_barrier
    ds_read_b64_tr_b16 v[224:225], v4 offset:49152
    ds_read_b64_tr_b16 v[226:227], v4 offset:50176
    s_add_u32 s19, s19, 8192
    buffer_load_dword v12, v13, s[8:11], s19 offen sc1
    s_waitcnt lgkmcnt(6)
    v_mfma_f32_16x16x32_bf16 v[128:131], v[236:239], v[40:43], v[128:131]
    s_add_u32 s22, s24, 0x380000
    s_add_u32 m0, s20, 0x14000
    s_nop 0
    buffer_load_dwordx4 v3, s[4:7], s22 offen lds
    ds_read_b64_tr_b16 v[228:229], v5 offset:49184
    v_mfma_f32_16x16x32_bf16 v[132:135], v[236:239], v[44:47], v[132:135]
    ds_read_b64_tr_b16 v[230:231], v5 offset:50208
    s_waitcnt lgkmcnt(6)
    v_mfma_f32_16x16x32_bf16 v[136:139], v[240:243], v[40:43], v[136:139]
    ds_read_b64_tr_b16 v[232:233], v4 offset:49408
    v_mfma_f32_16x16x32_bf16 v[140:143], v[240:243], v[44:47], v[140:143]
    s_add_u32 s22, s24, 0x382000
    s_add_u32 m0, s20, 0x14400
    s_nop 0
    buffer_load_dwordx4 v3, s[4:7], s22 offen lds
    ds_read_b64_tr_b16 v[234:235], v4 offset:50432
    s_waitcnt lgkmcnt(6)
    v_mfma_f32_16x16x32_bf16 v[144:147], v[244:247], v[40:43], v[144:147]
    ds_read_b64_tr_b16 v[236:237], v5 offset:49440
    v_mfma_f32_16x16x32_bf16 v[148:151], v[244:247], v[44:47], v[148:151]
    ds_read_b64_tr_b16 v[238:239], v5 offset:50464
    s_waitcnt vmcnt(20) lgkmcnt(6)
    v_mfma_f32_16x16x32_bf16 v[88:91], v[224:227], v[48:51], v[88:91]
    ds_read_b64_tr_b16 v[240:241], v4 offset:49664
    s_waitcnt vmcnt(19)
    v_mfma_f32_16x16x32_bf16 v[92:95], v[224:227], v[52:55], v[92:95]
    ds_read_b64_tr_b16 v[242:243], v4 offset:50688
    s_waitcnt lgkmcnt(6)
    v_mfma_f32_16x16x32_bf16 v[96:99], v[228:231], v[48:51], v[96:99]
    ds_read_b64_tr_b16 v[244:245], v5 offset:49696
    s_mov_b32 s23, 0xe000
    buffer_load_dwordx4 v[40:43], v6, s[8:11], s23 offen offset:0 sc1
    v_mfma_f32_16x16x32_bf16 v[100:103], v[228:231], v[52:55], v[100:103]
    ds_read_b64_tr_b16 v[246:247], v5 offset:50720
    s_waitcnt lgkmcnt(6)
    v_mfma_f32_16x16x32_bf16 v[104:107], v[232:235], v[48:51], v[104:107]
    ds_read_b64_tr_b16 v[224:225], v4 offset:49920
    v_mfma_f32_16x16x32_bf16 v[108:111], v[232:235], v[52:55], v[108:111]
    ds_read_b64_tr_b16 v[226:227], v4 offset:50944
    s_mov_b32 s23, 0x2e000
    buffer_load_dwordx4 v[44:47], v6, s[8:11], s23 offen offset:0 sc1
    s_waitcnt lgkmcnt(6)
    v_mfma_f32_16x16x32_bf16 v[112:115], v[236:239], v[48:51], v[112:115]
    ds_read_b64_tr_b16 v[228:229], v5 offset:49952
    v_mfma_f32_16x16x32_bf16 v[116:119], v[236:239], v[52:55], v[116:119]
    ds_read_b64_tr_b16 v[230:231], v5 offset:50976
    s_waitcnt lgkmcnt(6)
    v_mfma_f32_16x16x32_bf16 v[120:123], v[240:243], v[48:51], v[120:123]
    v_mfma_f32_16x16x32_bf16 v[124:127], v[240:243], v[52:55], v[124:127]
    s_waitcnt vmcnt(16)
    s_barrier
    ds_read_b64_tr_b16 v[232:233], v7 offset:0
    ds_read_b64_tr_b16 v[234:235], v7 offset:1024
    s_waitcnt lgkmcnt(6)
    v_mfma_f32_16x16x32_bf16 v[128:131], v[244:247], v[48:51], v[128:131]
    s_add_u32 s22, s24, 0x10000
    s_add_u32 m0, s20, 0x18000
    s_nop 0
    buffer_load_dwordx4 v3, s[4:7], s22 offen lds
    ds_read_b64_tr_b16 v[236:237], v8 offset:32
    v_mfma_f32_16x16x32_bf16 v[132:135], v[244:247], v[52:55], v[132:135]
    ds_read_b64_tr_b16 v[238:239], v8 offset:1056
    s_waitcnt lgkmcnt(6)
    v_mfma_f32_16x16x32_bf16 v[136:139], v[224:227], v[48:51], v[136:139]
    s_waitcnt vmcnt(12)
    v_cmp_ne_u32 vcc, s28, v248
    s_cbranch_vccnz adaLN_cond__sliding_block_cached__moe_arch_mod__prompt_kernel_mp6r
adaLN_cond__sliding_block_cached__moe_arch_mod__prompt_kernel_mp6b:
    ds_read_b64_tr_b16 v[240:241], v7 offset:256
    v_mfma_f32_16x16x32_bf16 v[140:143], v[224:227], v[52:55], v[140:143]
    v_lshrrev_b32 v250, 4, v1
    v_lshlrev_b32 v250, 14, v250
    v_and_b32 v253, 15, v1
    v_lshl_add_u32 v250, v253, 2, v250
    s_lshl_b32 s14, s2, 6
    s_add_u32 s14, s14, 0x580000
    buffer_load_dword v249, v250, s[8:11], s14 offen sc1
    s_add_u32 s14, s14, 0x10000
    buffer_load_dword v254, v250, s[8:11], s14 offen sc1
    s_add_u32 s22, s24, 0x12000
    s_add_u32 m0, s20, 0x18400
    s_nop 0
    buffer_load_dwordx4 v3, s[4:7], s22 offen lds
    ds_read_b64_tr_b16 v[242:243], v7 offset:1280
    s_waitcnt lgkmcnt(6)
    v_mfma_f32_16x16x32_bf16 v[144:147], v[228:231], v[48:51], v[144:147]
    ds_read_b64_tr_b16 v[244:245], v8 offset:288
    v_mfma_f32_16x16x32_bf16 v[148:151], v[228:231], v[52:55], v[148:151]
    ds_read_b64_tr_b16 v[246:247], v8 offset:1312
    s_waitcnt vmcnt(8)
    v_cmp_ne_u32 vcc, s28, v12
    s_cbranch_vccnz adaLN_cond__sliding_block_cached__moe_arch_mod__prompt_kernel_o27r
adaLN_cond__sliding_block_cached__moe_arch_mod__prompt_kernel_o27b:
    s_waitcnt lgkmcnt(6)
    v_mfma_f32_16x16x32_bf16 v[88:91], v[232:235], v[56:59], v[88:91]
    ds_read_b64_tr_b16 v[224:225], v7 offset:512
    v_mfma_f32_16x16x32_bf16 v[92:95], v[232:235], v[60:63], v[92:95]
    ds_read_b64_tr_b16 v[226:227], v7 offset:1536
    s_waitcnt lgkmcnt(6)
    v_mfma_f32_16x16x32_bf16 v[96:99], v[236:239], v[56:59], v[96:99]
    ds_read_b64_tr_b16 v[228:229], v8 offset:544
    s_mov_b32 s23, 0x0
    buffer_load_dwordx4 v[48:51], v6, s[8:11], s23 offen offset:1024 sc1
    v_mfma_f32_16x16x32_bf16 v[100:103], v[236:239], v[60:63], v[100:103]
    ds_read_b64_tr_b16 v[230:231], v8 offset:1568
    s_waitcnt lgkmcnt(6)
    v_mfma_f32_16x16x32_bf16 v[104:107], v[240:243], v[56:59], v[104:107]
    ds_read_b64_tr_b16 v[232:233], v7 offset:768
    v_mfma_f32_16x16x32_bf16 v[108:111], v[240:243], v[60:63], v[108:111]
    ds_read_b64_tr_b16 v[234:235], v7 offset:1792
    s_mov_b32 s23, 0x20000
    buffer_load_dwordx4 v[52:55], v6, s[8:11], s23 offen offset:1024 sc1
    s_waitcnt lgkmcnt(6)
    v_mfma_f32_16x16x32_bf16 v[112:115], v[244:247], v[56:59], v[112:115]
    ds_read_b64_tr_b16 v[236:237], v8 offset:800
    v_mfma_f32_16x16x32_bf16 v[116:119], v[244:247], v[60:63], v[116:119]
    ds_read_b64_tr_b16 v[238:239], v8 offset:1824
    s_waitcnt lgkmcnt(6)
    v_mfma_f32_16x16x32_bf16 v[120:123], v[224:227], v[56:59], v[120:123]
    v_mfma_f32_16x16x32_bf16 v[124:127], v[224:227], v[60:63], v[124:127]
    s_barrier
    ds_read_b64_tr_b16 v[240:241], v7 offset:16384
    ds_read_b64_tr_b16 v[242:243], v7 offset:17408
    s_waitcnt lgkmcnt(6)
    v_mfma_f32_16x16x32_bf16 v[128:131], v[228:231], v[56:59], v[128:131]
    s_add_u32 s22, s24, 0x90000
    s_add_u32 m0, s20, 0x1c000
    s_nop 0
    buffer_load_dwordx4 v3, s[4:7], s22 offen lds
    ds_read_b64_tr_b16 v[244:245], v8 offset:16416
    v_mfma_f32_16x16x32_bf16 v[132:135], v[228:231], v[60:63], v[132:135]
    ds_read_b64_tr_b16 v[246:247], v8 offset:17440
    s_waitcnt lgkmcnt(6)
    v_mfma_f32_16x16x32_bf16 v[136:139], v[232:235], v[56:59], v[136:139]
    ds_read_b64_tr_b16 v[224:225], v7 offset:16640
    v_mfma_f32_16x16x32_bf16 v[140:143], v[232:235], v[60:63], v[140:143]
    s_add_u32 s22, s24, 0x92000
    s_add_u32 m0, s20, 0x1c400
    s_nop 0
    buffer_load_dwordx4 v3, s[4:7], s22 offen lds
    ds_read_b64_tr_b16 v[226:227], v7 offset:17664
    s_waitcnt lgkmcnt(6)
    v_mfma_f32_16x16x32_bf16 v[144:147], v[236:239], v[56:59], v[144:147]
    ds_read_b64_tr_b16 v[228:229], v8 offset:16672
    v_mfma_f32_16x16x32_bf16 v[148:151], v[236:239], v[60:63], v[148:151]
    ds_read_b64_tr_b16 v[230:231], v8 offset:17696
    s_waitcnt lgkmcnt(6)
    v_mfma_f32_16x16x32_bf16 v[88:91], v[240:243], v[24:27], v[88:91]
    ds_read_b64_tr_b16 v[232:233], v7 offset:16896
    v_mfma_f32_16x16x32_bf16 v[92:95], v[240:243], v[28:31], v[92:95]
    ds_read_b64_tr_b16 v[234:235], v7 offset:17920
    s_waitcnt lgkmcnt(6)
    v_mfma_f32_16x16x32_bf16 v[96:99], v[244:247], v[24:27], v[96:99]
    ds_read_b64_tr_b16 v[236:237], v8 offset:16928
    s_mov_b32 s23, 0x2000
    buffer_load_dwordx4 v[56:59], v6, s[8:11], s23 offen offset:1024 sc1
    v_mfma_f32_16x16x32_bf16 v[100:103], v[244:247], v[28:31], v[100:103]
    ds_read_b64_tr_b16 v[238:239], v8 offset:17952
    s_waitcnt lgkmcnt(6)
    v_mfma_f32_16x16x32_bf16 v[104:107], v[224:227], v[24:27], v[104:107]
    s_waitcnt vmcnt(6)
    v_add_f32 v249, v249, v254
    v_mov_b32 v250, v249
    s_nop 1
    v_permlane16_swap_b32 v249, v250
    v_add_f32 v249, v249, v250
    v_mov_b32 v250, v249
    s_nop 1
    v_permlane32_swap_b32 v249, v250
    v_add_f32 v249, v249, v250
    v_cvt_pk_bf16_f32 v249, v249, v249
    v_lshlrev_b32 v249, 16, v249
    s_lshr_b32 s14, s2, 6
    s_cmp_eq_u32 s14, 2
    s_cselect_b32 s14, 1.0, 0
    v_add_f32 v249, s14, v249
    v_cvt_pk_bf16_f32 v249, v249, v249
    v_lshlrev_b32 v253, 1, v253
    s_lshl_b32 s14, s2, 5
    s_add_u32 s14, s14, 0x540000
    s_cmp_eq_u32 s3, 0
    s_cselect_b32 s14, s14, 0x7ffffff0
    s_mov_b64 exec, 0xffff
    buffer_store_short v249, v253, s[8:11], s14 offen sc1
    s_mov_b64 exec, -1
    ds_read_b64_tr_b16 v[240:241], v7 offset:17152
    v_mfma_f32_16x16x32_bf16 v[108:111], v[224:227], v[28:31], v[108:111]
    ds_read_b64_tr_b16 v[242:243], v7 offset:18176
    s_mov_b32 s23, 0x22000
    buffer_load_dwordx4 v[60:63], v6, s[8:11], s23 offen offset:1024 sc1
    s_waitcnt lgkmcnt(6)
    v_mfma_f32_16x16x32_bf16 v[112:115], v[228:231], v[24:27], v[112:115]
    ds_read_b64_tr_b16 v[244:245], v8 offset:17184
    v_mfma_f32_16x16x32_bf16 v[116:119], v[228:231], v[28:31], v[116:119]
    ds_read_b64_tr_b16 v[246:247], v8 offset:18208
    s_waitcnt lgkmcnt(6)
    v_mfma_f32_16x16x32_bf16 v[120:123], v[232:235], v[24:27], v[120:123]
    v_mfma_f32_16x16x32_bf16 v[124:127], v[232:235], v[28:31], v[124:127]
    s_barrier
    ds_read_b64_tr_b16 v[224:225], v4 offset:0
    ds_read_b64_tr_b16 v[226:227], v4 offset:1024
    s_waitcnt lgkmcnt(6)
    v_mfma_f32_16x16x32_bf16 v[128:131], v[236:239], v[24:27], v[128:131]
    s_add_u32 s16, s63, 0x576000
    v_mov_b32 v14, s28
    v_mov_b32 v15, 0
    s_mov_b64 exec, 1
    buffer_store_dword v14, v15, s[8:11], s16 offen sc1
    s_mov_b64 exec, -1
    s_add_u32 s22, s24, 0x110000
    s_add_u32 m0, s20, 0x20000
    s_nop 0
    buffer_load_dwordx4 v3, s[4:7], s22 offen lds
    ds_read_b64_tr_b16 v[228:229], v5 offset:32
    v_mfma_f32_16x16x32_bf16 v[132:135], v[236:239], v[28:31], v[132:135]
    ds_read_b64_tr_b16 v[230:231], v5 offset:1056
    s_waitcnt lgkmcnt(6)
    v_mfma_f32_16x16x32_bf16 v[136:139], v[240:243], v[24:27], v[136:139]
    ds_read_b64_tr_b16 v[232:233], v4 offset:256
    v_mfma_f32_16x16x32_bf16 v[140:143], v[240:243], v[28:31], v[140:143]
    s_add_u32 s22, s24, 0x112000
    s_add_u32 m0, s20, 0x20400
    s_nop 0
    buffer_load_dwordx4 v3, s[4:7], s22 offen lds
    ds_read_b64_tr_b16 v[234:235], v4 offset:1280
    s_waitcnt lgkmcnt(6)
    v_mfma_f32_16x16x32_bf16 v[144:147], v[244:247], v[24:27], v[144:147]
    ds_read_b64_tr_b16 v[236:237], v5 offset:288
    v_mfma_f32_16x16x32_bf16 v[148:151], v[244:247], v[28:31], v[148:151]
    ds_read_b64_tr_b16 v[238:239], v5 offset:1312
    s_waitcnt lgkmcnt(6)
    v_mfma_f32_16x16x32_bf16 v[88:91], v[224:227], v[32:35], v[88:91]
    ds_read_b64_tr_b16 v[240:241], v4 offset:512
    v_mfma_f32_16x16x32_bf16 v[92:95], v[224:227], v[36:39], v[92:95]
    ds_read_b64_tr_b16 v[242:243], v4 offset:1536
    s_waitcnt lgkmcnt(6)
    v_mfma_f32_16x16x32_bf16 v[96:99], v[228:231], v[32:35], v[96:99]
    ds_read_b64_tr_b16 v[244:245], v5 offset:544
    s_mov_b32 s23, 0x4000
    buffer_load_dwordx4 v[24:27], v6, s[8:11], s23 offen offset:1024 sc1
    v_mfma_f32_16x16x32_bf16 v[100:103], v[228:231], v[36:39], v[100:103]
    ds_read_b64_tr_b16 v[246:247], v5 offset:1568
    s_waitcnt lgkmcnt(6)
    v_mfma_f32_16x16x32_bf16 v[104:107], v[232:235], v[32:35], v[104:107]
    ds_read_b64_tr_b16 v[224:225], v4 offset:768
    v_mfma_f32_16x16x32_bf16 v[108:111], v[232:235], v[36:39], v[108:111]
    ds_read_b64_tr_b16 v[226:227], v4 offset:1792
    s_mov_b32 s23, 0x24000
    buffer_load_dwordx4 v[28:31], v6, s[8:11], s23 offen offset:1024 sc1
    s_waitcnt lgkmcnt(6)
    v_mfma_f32_16x16x32_bf16 v[112:115], v[236:239], v[32:35], v[112:115]
    ds_read_b64_tr_b16 v[228:229], v5 offset:800
    v_mfma_f32_16x16x32_bf16 v[116:119], v[236:239], v[36:39], v[116:119]
    ds_read_b64_tr_b16 v[230:231], v5 offset:1824
    s_waitcnt lgkmcnt(6)
    v_mfma_f32_16x16x32_bf16 v[120:123], v[240:243], v[32:35], v[120:123]
    v_mfma_f32_16x16x32_bf16 v[124:127], v[240:243], v[36:39], v[124:127]
    s_barrier
    ds_read_b64_tr_b16 v[232:233], v4 offset:16384
    ds_read_b64_tr_b16 v[234:235], v4 offset:17408
    s_waitcnt lgkmcnt(6)
    v_mfma_f32_16x16x32_bf16 v[128:131], v[244:247], v[32:35], v[128:131]
    s_add_u32 s22, s24, 0x190000
    s_add_u32 m0, s20, 0x24000
    s_nop 0
    buffer_load_dwordx4 v3, s[4:7], s22 offen lds
    ds_read_b64_tr_b16 v[236:237], v5 offset:16416
    v_mfma_f32_16x16x32_bf16 v[132:135], v[244:247], v[36:39], v[132:135]
    ds_read_b64_tr_b16 v[238:239], v5 offset:17440
    s_waitcnt lgkmcnt(6)
    v_mfma_f32_16x16x32_bf16 v[136:139], v[224:227], v[32:35], v[136:139]
    ds_read_b64_tr_b16 v[240:241], v4 offset:16640
    v_mfma_f32_16x16x32_bf16 v[140:143], v[224:227], v[36:39], v[140:143]
    s_add_u32 s22, s24, 0x192000
    s_add_u32 m0, s20, 0x24400
    s_nop 0
    buffer_load_dwordx4 v3, s[4:7], s22 offen lds
    ds_read_b64_tr_b16 v[242:243], v4 offset:17664
    s_waitcnt lgkmcnt(6)
    v_mfma_f32_16x16x32_bf16 v[144:147], v[228:231], v[32:35], v[144:147]
    ds_read_b64_tr_b16 v[244:245], v5 offset:16672
    v_mfma_f32_16x16x32_bf16 v[148:151], v[228:231], v[36:39], v[148:151]
    ds_read_b64_tr_b16 v[246:247], v5 offset:17696
    s_waitcnt lgkmcnt(6)
    v_mfma_f32_16x16x32_bf16 v[88:91], v[232:235], v[40:43], v[88:91]
    ds_read_b64_tr_b16 v[224:225], v4 offset:16896
    v_mfma_f32_16x16x32_bf16 v[92:95], v[232:235], v[44:47], v[92:95]
    ds_read_b64_tr_b16 v[226:227], v4 offset:17920
    s_waitcnt lgkmcnt(6)
    v_mfma_f32_16x16x32_bf16 v[96:99], v[236:239], v[40:43], v[96:99]
    ds_read_b64_tr_b16 v[228:229], v5 offset:16928
    s_mov_b32 s23, 0x6000
    buffer_load_dwordx4 v[32:35], v6, s[8:11], s23 offen offset:1024 sc1
    v_mfma_f32_16x16x32_bf16 v[100:103], v[236:239], v[44:47], v[100:103]
    ds_read_b64_tr_b16 v[230:231], v5 offset:17952
    s_waitcnt lgkmcnt(6)
    v_mfma_f32_16x16x32_bf16 v[104:107], v[240:243], v[40:43], v[104:107]
    ds_read_b64_tr_b16 v[232:233], v4 offset:17152
    v_mfma_f32_16x16x32_bf16 v[108:111], v[240:243], v[44:47], v[108:111]
    ds_read_b64_tr_b16 v[234:235], v4 offset:18176
    s_mov_b32 s23, 0x26000
    buffer_load_dwordx4 v[36:39], v6, s[8:11], s23 offen offset:1024 sc1
    s_waitcnt lgkmcnt(6)
    v_mfma_f32_16x16x32_bf16 v[112:115], v[244:247], v[40:43], v[112:115]
    ds_read_b64_tr_b16 v[236:237], v5 offset:17184
    v_mfma_f32_16x16x32_bf16 v[116:119], v[244:247], v[44:47], v[116:119]
    ds_read_b64_tr_b16 v[238:239], v5 offset:18208
    s_waitcnt lgkmcnt(6)
    v_mfma_f32_16x16x32_bf16 v[120:123], v[224:227], v[40:43], v[120:123]
    v_mfma_f32_16x16x32_bf16 v[124:127], v[224:227], v[44:47], v[124:127]
    s_waitcnt vmcnt(16)
    s_barrier
    ds_read_b64_tr_b16 v[240:241], v4 offset:32768
    ds_read_b64_tr_b16 v[242:243], v4 offset:33792
    s_waitcnt lgkmcnt(6)
    v_mfma_f32_16x16x32_bf16 v[128:131], v[228:231], v[40:43], v[128:131]
    s_add_u32 s22, s24, 0x210000
    s_add_u32 m0, s20, 0x10000
    s_nop 0
    buffer_load_dwordx4 v3, s[4:7], s22 offen lds
    ds_read_b64_tr_b16 v[244:245], v5 offset:32800
    v_mfma_f32_16x16x32_bf16 v[132:135], v[228:231], v[44:47], v[132:135]
    ds_read_b64_tr_b16 v[246:247], v5 offset:33824
    s_waitcnt lgkmcnt(6)
    v_mfma_f32_16x16x32_bf16 v[136:139], v[232:235], v[40:43], v[136:139]
    ds_read_b64_tr_b16 v[224:225], v4 offset:33024
    v_mfma_f32_16x16x32_bf16 v[140:143], v[232:235], v[44:47], v[140:143]
    s_add_u32 s22, s24, 0x212000
    s_add_u32 m0, s20, 0x10400
    s_nop 0
    buffer_load_dwordx4 v3, s[4:7], s22 offen lds
    ds_read_b64_tr_b16 v[226:227], v4 offset:34048
    s_waitcnt lgkmcnt(6)
    v_mfma_f32_16x16x32_bf16 v[144:147], v[236:239], v[40:43], v[144:147]
    ds_read_b64_tr_b16 v[228:229], v5 offset:33056
    v_mfma_f32_16x16x32_bf16 v[148:151], v[236:239], v[44:47], v[148:151]
    ds_read_b64_tr_b16 v[230:231], v5 offset:34080
    s_waitcnt vmcnt(17) lgkmcnt(6)
    v_mfma_f32_16x16x32_bf16 v[88:91], v[240:243], v[48:51], v[88:91]
    ds_read_b64_tr_b16 v[232:233], v4 offset:33280
    s_waitcnt vmcnt(16)
    v_mfma_f32_16x16x32_bf16 v[92:95], v[240:243], v[52:55], v[92:95]
    ds_read_b64_tr_b16 v[234:235], v4 offset:34304
    s_waitcnt lgkmcnt(6)
    v_mfma_f32_16x16x32_bf16 v[96:99], v[244:247], v[48:51], v[96:99]
    ds_read_b64_tr_b16 v[236:237], v5 offset:33312
    s_mov_b32 s23, 0x8000
    buffer_load_dwordx4 v[40:43], v6, s[8:11], s23 offen offset:1024 sc1
    v_mfma_f32_16x16x32_bf16 v[100:103], v[244:247], v[52:55], v[100:103]
    ds_read_b64_tr_b16 v[238:239], v5 offset:34336
    s_waitcnt lgkmcnt(6)
    v_mfma_f32_16x16x32_bf16 v[104:107], v[224:227], v[48:51], v[104:107]
    ds_read_b64_tr_b16 v[240:241], v4 offset:33536
    v_mfma_f32_16x16x32_bf16 v[108:111], v[224:227], v[52:55], v[108:111]
    ds_read_b64_tr_b16 v[242:243], v4 offset:34560
    s_mov_b32 s23, 0x28000
    buffer_load_dwordx4 v[44:47], v6, s[8:11], s23 offen offset:1024 sc1
    s_waitcnt lgkmcnt(6)
    v_mfma_f32_16x16x32_bf16 v[112:115], v[228:231], v[48:51], v[112:115]
    ds_read_b64_tr_b16 v[244:245], v5 offset:33568
    v_mfma_f32_16x16x32_bf16 v[116:119], v[228:231], v[52:55], v[116:119]
    ds_read_b64_tr_b16 v[246:247], v5 offset:34592
    s_waitcnt lgkmcnt(6)
    v_mfma_f32_16x16x32_bf16 v[120:123], v[232:235], v[48:51], v[120:123]
    v_mfma_f32_16x16x32_bf16 v[124:127], v[232:235], v[52:55], v[124:127]
    s_waitcnt vmcnt(16)
    s_barrier
    ds_read_b64_tr_b16 v[224:225], v4 offset:49152
    ds_read_b64_tr_b16 v[226:227], v4 offset:50176
    s_waitcnt lgkmcnt(6)
    v_mfma_f32_16x16x32_bf16 v[128:131], v[236:239], v[48:51], v[128:131]
    s_add_u32 s22, s24, 0x290000
    s_add_u32 m0, s20, 0x14000
    s_nop 0
    buffer_load_dwordx4 v3, s[4:7], s22 offen lds
    ds_read_b64_tr_b16 v[228:229], v5 offset:49184
    v_mfma_f32_16x16x32_bf16 v[132:135], v[236:239], v[52:55], v[132:135]
    ds_read_b64_tr_b16 v[230:231], v5 offset:50208
    s_waitcnt lgkmcnt(6)
    v_mfma_f32_16x16x32_bf16 v[136:139], v[240:243], v[48:51], v[136:139]
    ds_read_b64_tr_b16 v[232:233], v4 offset:49408
    v_mfma_f32_16x16x32_bf16 v[140:143], v[240:243], v[52:55], v[140:143]
    s_add_u32 s22, s24, 0x292000
    s_add_u32 m0, s20, 0x14400
    s_nop 0
    buffer_load_dwordx4 v3, s[4:7], s22 offen lds
    ds_read_b64_tr_b16 v[234:235], v4 offset:50432
    s_waitcnt lgkmcnt(6)
    v_mfma_f32_16x16x32_bf16 v[144:147], v[244:247], v[48:51], v[144:147]
    ds_read_b64_tr_b16 v[236:237], v5 offset:49440
    v_mfma_f32_16x16x32_bf16 v[148:151], v[244:247], v[52:55], v[148:151]
    ds_read_b64_tr_b16 v[238:239], v5 offset:50464
    s_waitcnt vmcnt(17) lgkmcnt(6)
    v_mfma_f32_16x16x32_bf16 v[88:91], v[224:227], v[56:59], v[88:91]
    ds_read_b64_tr_b16 v[240:241], v4 offset:49664
    s_waitcnt vmcnt(15)
    v_mfma_f32_16x16x32_bf16 v[92:95], v[224:227], v[60:63], v[92:95]
    ds_read_b64_tr_b16 v[242:243], v4 offset:50688
    s_waitcnt lgkmcnt(6)
    v_mfma_f32_16x16x32_bf16 v[96:99], v[228:231], v[56:59], v[96:99]
    ds_read_b64_tr_b16 v[244:245], v5 offset:49696
    s_mov_b32 s23, 0xa000
    buffer_load_dwordx4 v[48:51], v6, s[8:11], s23 offen offset:1024 sc1
    v_mfma_f32_16x16x32_bf16 v[100:103], v[228:231], v[60:63], v[100:103]
    ds_read_b64_tr_b16 v[246:247], v5 offset:50720
    s_waitcnt lgkmcnt(6)
    v_mfma_f32_16x16x32_bf16 v[104:107], v[232:235], v[56:59], v[104:107]
    ds_read_b64_tr_b16 v[224:225], v4 offset:49920
    v_mfma_f32_16x16x32_bf16 v[108:111], v[232:235], v[60:63], v[108:111]
    ds_read_b64_tr_b16 v[226:227], v4 offset:50944
    s_mov_b32 s23, 0x2a000
    buffer_load_dwordx4 v[52:55], v6, s[8:11], s23 offen offset:1024 sc1
    s_waitcnt lgkmcnt(6)
    v_mfma_f32_16x16x32_bf16 v[112:115], v[236:239], v[56:59], v[112:115]
    ds_read_b64_tr_b16 v[228:229], v5 offset:49952
    v_mfma_f32_16x16x32_bf16 v[116:119], v[236:239], v[60:63], v[116:119]
    ds_read_b64_tr_b16 v[230:231], v5 offset:50976
    s_waitcnt lgkmcnt(6)
    v_mfma_f32_16x16x32_bf16 v[120:123], v[240:243], v[56:59], v[120:123]
    v_mfma_f32_16x16x32_bf16 v[124:127], v[240:243], v[60:63], v[124:127]
    s_waitcnt vmcnt(14)
    s_barrier
    ds_read_b64_tr_b16 v[232:233], v7 offset:0
    ds_read_b64_tr_b16 v[234:235], v7 offset:1024
    s_waitcnt lgkmcnt(6)
    v_mfma_f32_16x16x32_bf16 v[128:131], v[244:247], v[56:59], v[128:131]
    s_add_u32 s22, s24, 0x310000
    s_add_u32 m0, s20, 0x18000
    s_nop 0
    buffer_load_dwordx4 v3, s[4:7], s22 offen lds
    ds_read_b64_tr_b16 v[236:237], v8 offset:32
    v_mfma_f32_16x16x32_bf16 v[132:135], v[244:247], v[60:63], v[132:135]
    ds_read_b64_tr_b16 v[238:239], v8 offset:1056
    s_waitcnt lgkmcnt(6)
    v_mfma_f32_16x16x32_bf16 v[136:139], v[224:227], v[56:59], v[136:139]
    ds_read_b64_tr_b16 v[240:241], v7 offset:256
    v_mfma_f32_16x16x32_bf16 v[140:143], v[224:227], v[60:63], v[140:143]
    s_add_u32 s22, s24, 0x312000
    s_add_u32 m0, s20, 0x18400
    s_nop 0
    buffer_load_dwordx4 v3, s[4:7], s22 offen lds
    ds_read_b64_tr_b16 v[242:243], v7 offset:1280
    s_waitcnt lgkmcnt(6)
    v_mfma_f32_16x16x32_bf16 v[144:147], v[228:231], v[56:59], v[144:147]
    ds_read_b64_tr_b16 v[244:245], v8 offset:288
    v_mfma_f32_16x16x32_bf16 v[148:151], v[228:231], v[60:63], v[148:151]
    ds_read_b64_tr_b16 v[246:247], v8 offset:1312
    s_waitcnt vmcnt(15) lgkmcnt(6)
    v_mfma_f32_16x16x32_bf16 v[88:91], v[232:235], v[24:27], v[88:91]
    ds_read_b64_tr_b16 v[224:225], v7 offset:512
    s_waitcnt vmcnt(14)
    v_mfma_f32_16x16x32_bf16 v[92:95], v[232:235], v[28:31], v[92:95]
    ds_read_b64_tr_b16 v[226:227], v7 offset:1536
    s_waitcnt lgkmcnt(6)
    v_mfma_f32_16x16x32_bf16 v[96:99], v[236:239], v[24:27], v[96:99]
    ds_read_b64_tr_b16 v[228:229], v8 offset:544
    s_mov_b32 s23, 0xc000
    buffer_load_dwordx4 v[56:59], v6, s[8:11], s23 offen offset:1024 sc1
    v_mfma_f32_16x16x32_bf16 v[100:103], v[236:239], v[28:31], v[100:103]
    ds_read_b64_tr_b16 v[230:231], v8 offset:1568
    s_waitcnt lgkmcnt(6)
    v_mfma_f32_16x16x32_bf16 v[104:107], v[240:243], v[24:27], v[104:107]
    ds_read_b64_tr_b16 v[232:233], v7 offset:768
    v_mfma_f32_16x16x32_bf16 v[108:111], v[240:243], v[28:31], v[108:111]
    ds_read_b64_tr_b16 v[234:235], v7 offset:1792
    s_mov_b32 s23, 0x2c000
    buffer_load_dwordx4 v[60:63], v6, s[8:11], s23 offen offset:1024 sc1
    s_waitcnt lgkmcnt(6)
    v_mfma_f32_16x16x32_bf16 v[112:115], v[244:247], v[24:27], v[112:115]
    ds_read_b64_tr_b16 v[236:237], v8 offset:800
    v_mfma_f32_16x16x32_bf16 v[116:119], v[244:247], v[28:31], v[116:119]
    ds_read_b64_tr_b16 v[238:239], v8 offset:1824
    s_waitcnt lgkmcnt(6)
    v_mfma_f32_16x16x32_bf16 v[120:123], v[224:227], v[24:27], v[120:123]
    v_mfma_f32_16x16x32_bf16 v[124:127], v[224:227], v[28:31], v[124:127]
    s_waitcnt vmcnt(14)
    s_barrier
    ds_read_b64_tr_b16 v[240:241], v7 offset:16384
    ds_read_b64_tr_b16 v[242:243], v7 offset:17408
    s_add_u32 s19, s19, 8192
    buffer_load_dword v12, v13, s[8:11], s19 offen sc1
    s_waitcnt lgkmcnt(6)
    v_mfma_f32_16x16x32_bf16 v[128:131], v[228:231], v[24:27], v[128:131]
    s_add_u32 s22, s24, 0x390000
    s_add_u32 m0, s20, 0x1c000
    s_nop 0
    buffer_load_dwordx4 v3, s[4:7], s22 offen lds
    ds_read_b64_tr_b16 v[244:245], v8 offset:16416
    v_mfma_f32_16x16x32_bf16 v[132:135], v[228:231], v[28:31], v[132:135]
    ds_read_b64_tr_b16 v[246:247], v8 offset:17440
    s_waitcnt lgkmcnt(6)
    v_mfma_f32_16x16x32_bf16 v[136:139], v[232:235], v[24:27], v[136:139]
    ds_read_b64_tr_b16 v[224:225], v7 offset:16640
    v_mfma_f32_16x16x32_bf16 v[140:143], v[232:235], v[28:31], v[140:143]
    s_add_u32 s22, s24, 0x392000
    s_add_u32 m0, s20, 0x1c400
    s_nop 0
    buffer_load_dwordx4 v3, s[4:7], s22 offen lds
    ds_read_b64_tr_b16 v[226:227], v7 offset:17664
    s_waitcnt lgkmcnt(6)
    v_mfma_f32_16x16x32_bf16 v[144:147], v[236:239], v[24:27], v[144:147]
    ds_read_b64_tr_b16 v[228:229], v8 offset:16672
    v_mfma_f32_16x16x32_bf16 v[148:151], v[236:239], v[28:31], v[148:151]
    ds_read_b64_tr_b16 v[230:231], v8 offset:17696
    s_waitcnt vmcnt(16) lgkmcnt(6)
    v_mfma_f32_16x16x32_bf16 v[88:91], v[240:243], v[32:35], v[88:91]
    ds_read_b64_tr_b16 v[232:233], v7 offset:16896
    s_waitcnt vmcnt(15)
    v_mfma_f32_16x16x32_bf16 v[92:95], v[240:243], v[36:39], v[92:95]
    ds_read_b64_tr_b16 v[234:235], v7 offset:17920
    s_waitcnt lgkmcnt(6)
    v_mfma_f32_16x16x32_bf16 v[96:99], v[244:247], v[32:35], v[96:99]
    ds_read_b64_tr_b16 v[236:237], v8 offset:16928
    s_mov_b32 s23, 0xe000
    buffer_load_dwordx4 v[24:27], v6, s[8:11], s23 offen offset:1024 sc1
    v_mfma_f32_16x16x32_bf16 v[100:103], v[244:247], v[36:39], v[100:103]
    ds_read_b64_tr_b16 v[238:239], v8 offset:17952
    s_waitcnt lgkmcnt(6)
    v_mfma_f32_16x16x32_bf16 v[104:107], v[224:227], v[32:35], v[104:107]
    ds_read_b64_tr_b16 v[240:241], v7 offset:17152
    v_mfma_f32_16x16x32_bf16 v[108:111], v[224:227], v[36:39], v[108:111]
    ds_read_b64_tr_b16 v[242:243], v7 offset:18176
    s_mov_b32 s23, 0x2e000
    buffer_load_dwordx4 v[28:31], v6, s[8:11], s23 offen offset:1024 sc1
    s_waitcnt lgkmcnt(6)
    v_mfma_f32_16x16x32_bf16 v[112:115], v[228:231], v[32:35], v[112:115]
    ds_read_b64_tr_b16 v[244:245], v8 offset:17184
    v_mfma_f32_16x16x32_bf16 v[116:119], v[228:231], v[36:39], v[116:119]
    ds_read_b64_tr_b16 v[246:247], v8 offset:18208
    s_waitcnt lgkmcnt(6)
    v_mfma_f32_16x16x32_bf16 v[120:123], v[232:235], v[32:35], v[120:123]
    v_mfma_f32_16x16x32_bf16 v[124:127], v[232:235], v[36:39], v[124:127]
    s_waitcnt vmcnt(15)
    s_barrier
    ds_read_b64_tr_b16 v[224:225], v4 offset:0
    ds_read_b64_tr_b16 v[226:227], v4 offset:1024
    s_waitcnt lgkmcnt(6)
    v_mfma_f32_16x16x32_bf16 v[128:131], v[236:239], v[32:35], v[128:131]
    s_add_u32 s22, s24, 0x20000
    s_add_u32 m0, s20, 0x20000
    s_nop 0
    buffer_load_dwordx4 v3, s[4:7], s22 offen lds
    ds_read_b64_tr_b16 v[228:229], v5 offset:32
    v_mfma_f32_16x16x32_bf16 v[132:135], v[236:239], v[36:39], v[132:135]
    ds_read_b64_tr_b16 v[230:231], v5 offset:1056
    s_waitcnt lgkmcnt(6)
    v_mfma_f32_16x16x32_bf16 v[136:139], v[240:243], v[32:35], v[136:139]
    ds_read_b64_tr_b16 v[232:233], v4 offset:256
    v_mfma_f32_16x16x32_bf16 v[140:143], v[240:243], v[36:39], v[140:143]
    s_add_u32 s22, s24, 0x22000
    s_add_u32 m0, s20, 0x20400
    s_nop 0
    buffer_load_dwordx4 v3, s[4:7], s22 offen lds
    ds_read_b64_tr_b16 v[234:235], v4 offset:1280
    s_waitcnt lgkmcnt(6)
    v_mfma_f32_16x16x32_bf16 v[144:147], v[244:247], v[32:35], v[144:147]
    ds_read_b64_tr_b16 v[236:237], v5 offset:288
    v_mfma_f32_16x16x32_bf16 v[148:151], v[244:247], v[36:39], v[148:151]
    ds_read_b64_tr_b16 v[238:239], v5 offset:1312
    s_waitcnt vmcnt(6)
    v_cmp_ne_u32 vcc, s28, v12
    s_cbranch_vccnz adaLN_cond__sliding_block_cached__moe_arch_mod__prompt_kernel_o28r
adaLN_cond__sliding_block_cached__moe_arch_mod__prompt_kernel_o28b:
    s_waitcnt lgkmcnt(6)
    v_mfma_f32_16x16x32_bf16 v[88:91], v[224:227], v[40:43], v[88:91]
    ds_read_b64_tr_b16 v[240:241], v4 offset:512
    v_mfma_f32_16x16x32_bf16 v[92:95], v[224:227], v[44:47], v[92:95]
    ds_read_b64_tr_b16 v[242:243], v4 offset:1536
    s_waitcnt lgkmcnt(6)
    v_mfma_f32_16x16x32_bf16 v[96:99], v[228:231], v[40:43], v[96:99]
    ds_read_b64_tr_b16 v[244:245], v5 offset:544
    s_mov_b32 s23, 0x0
    buffer_load_dwordx4 v[32:35], v6, s[8:11], s23 offen offset:2048 sc1
    v_mfma_f32_16x16x32_bf16 v[100:103], v[228:231], v[44:47], v[100:103]
    ds_read_b64_tr_b16 v[246:247], v5 offset:1568
    s_waitcnt lgkmcnt(6)
    v_mfma_f32_16x16x32_bf16 v[104:107], v[232:235], v[40:43], v[104:107]
    ds_read_b64_tr_b16 v[224:225], v4 offset:768
    v_mfma_f32_16x16x32_bf16 v[108:111], v[232:235], v[44:47], v[108:111]
    ds_read_b64_tr_b16 v[226:227], v4 offset:1792
    s_mov_b32 s23, 0x20000
    buffer_load_dwordx4 v[36:39], v6, s[8:11], s23 offen offset:2048 sc1
    s_waitcnt lgkmcnt(6)
    v_mfma_f32_16x16x32_bf16 v[112:115], v[236:239], v[40:43], v[112:115]
    ds_read_b64_tr_b16 v[228:229], v5 offset:800
    v_mfma_f32_16x16x32_bf16 v[116:119], v[236:239], v[44:47], v[116:119]
    ds_read_b64_tr_b16 v[230:231], v5 offset:1824
    s_waitcnt lgkmcnt(6)
    v_mfma_f32_16x16x32_bf16 v[120:123], v[240:243], v[40:43], v[120:123]
    v_mfma_f32_16x16x32_bf16 v[124:127], v[240:243], v[44:47], v[124:127]
    s_barrier
    ds_read_b64_tr_b16 v[232:233], v4 offset:16384
    ds_read_b64_tr_b16 v[234:235], v4 offset:17408
    s_waitcnt lgkmcnt(6)
    v_mfma_f32_16x16x32_bf16 v[128:131], v[244:247], v[40:43], v[128:131]
    s_add_u32 s22, s24, 0xa0000
    s_add_u32 m0, s20, 0x24000
    s_nop 0
    buffer_load_dwordx4 v3, s[4:7], s22 offen lds
    ds_read_b64_tr_b16 v[236:237], v5 offset:16416
    v_mfma_f32_16x16x32_bf16 v[132:135], v[244:247], v[44:47], v[132:135]
    ds_read_b64_tr_b16 v[238:239], v5 offset:17440
    s_waitcnt lgkmcnt(6)
    v_mfma_f32_16x16x32_bf16 v[136:139], v[224:227], v[40:43], v[136:139]
    ds_read_b64_tr_b16 v[240:241], v4 offset:16640
    v_mfma_f32_16x16x32_bf16 v[140:143], v[224:227], v[44:47], v[140:143]
    s_add_u32 s22, s24, 0xa2000
    s_add_u32 m0, s20, 0x24400
    s_nop 0
    buffer_load_dwordx4 v3, s[4:7], s22 offen lds
    ds_read_b64_tr_b16 v[242:243], v4 offset:17664
    s_waitcnt lgkmcnt(6)
    v_mfma_f32_16x16x32_bf16 v[144:147], v[228:231], v[40:43], v[144:147]
    ds_read_b64_tr_b16 v[244:245], v5 offset:16672
    v_mfma_f32_16x16x32_bf16 v[148:151], v[228:231], v[44:47], v[148:151]
    ds_read_b64_tr_b16 v[246:247], v5 offset:17696
    s_waitcnt lgkmcnt(6)
    v_mfma_f32_16x16x32_bf16 v[88:91], v[232:235], v[48:51], v[88:91]
    ds_read_b64_tr_b16 v[224:225], v4 offset:16896
    v_mfma_f32_16x16x32_bf16 v[92:95], v[232:235], v[52:55], v[92:95]
    ds_read_b64_tr_b16 v[226:227], v4 offset:17920
    s_waitcnt lgkmcnt(6)
    v_mfma_f32_16x16x32_bf16 v[96:99], v[236:239], v[48:51], v[96:99]
    ds_read_b64_tr_b16 v[228:229], v5 offset:16928
    s_mov_b32 s23, 0x2000
    buffer_load_dwordx4 v[40:43], v6, s[8:11], s23 offen offset:2048 sc1
    v_mfma_f32_16x16x32_bf16 v[100:103], v[236:239], v[52:55], v[100:103]
    ds_read_b64_tr_b16 v[230:231], v5 offset:17952
    s_waitcnt lgkmcnt(6)
    v_mfma_f32_16x16x32_bf16 v[104:107], v[240:243], v[48:51], v[104:107]
    ds_read_b64_tr_b16 v[232:233], v4 offset:17152
    v_mfma_f32_16x16x32_bf16 v[108:111], v[240:243], v[52:55], v[108:111]
    ds_read_b64_tr_b16 v[234:235], v4 offset:18176
    s_mov_b32 s23, 0x22000
    buffer_load_dwordx4 v[44:47], v6, s[8:11], s23 offen offset:2048 sc1
    s_waitcnt lgkmcnt(6)
    v_mfma_f32_16x16x32_bf16 v[112:115], v[244:247], v[48:51], v[112:115]
    ds_read_b64_tr_b16 v[236:237], v5 offset:17184
    v_mfma_f32_16x16x32_bf16 v[116:119], v[244:247], v[52:55], v[116:119]
    ds_read_b64_tr_b16 v[238:239], v5 offset:18208
    s_waitcnt lgkmcnt(6)
    v_mfma_f32_16x16x32_bf16 v[120:123], v[224:227], v[48:51], v[120:123]
    v_mfma_f32_16x16x32_bf16 v[124:127], v[224:227], v[52:55], v[124:127]
    s_barrier
    ds_read_b64_tr_b16 v[240:241], v4 offset:32768
    ds_read_b64_tr_b16 v[242:243], v4 offset:33792
    s_waitcnt lgkmcnt(6)
    v_mfma_f32_16x16x32_bf16 v[128:131], v[228:231], v[48:51], v[128:131]
    s_add_u32 s22, s24, 0x120000
    s_add_u32 m0, s20, 0x10000
    s_nop 0
    buffer_load_dwordx4 v3, s[4:7], s22 offen lds
    ds_read_b64_tr_b16 v[244:245], v5 offset:32800
    v_mfma_f32_16x16x32_bf16 v[132:135], v[228:231], v[52:55], v[132:135]
    ds_read_b64_tr_b16 v[246:247], v5 offset:33824
    s_waitcnt lgkmcnt(6)
    v_mfma_f32_16x16x32_bf16 v[136:139], v[232:235], v[48:51], v[136:139]
    ds_read_b64_tr_b16 v[224:225], v4 offset:33024
    v_mfma_f32_16x16x32_bf16 v[140:143], v[232:235], v[52:55], v[140:143]
    s_add_u32 s22, s24, 0x122000
    s_add_u32 m0, s20, 0x10400
    s_nop 0
    buffer_load_dwordx4 v3, s[4:7], s22 offen lds
    ds_read_b64_tr_b16 v[226:227], v4 offset:34048
    s_waitcnt lgkmcnt(6)
    v_mfma_f32_16x16x32_bf16 v[144:147], v[236:239], v[48:51], v[144:147]
    ds_read_b64_tr_b16 v[228:229], v5 offset:33056
    v_mfma_f32_16x16x32_bf16 v[148:151], v[236:239], v[52:55], v[148:151]
    ds_read_b64_tr_b16 v[230:231], v5 offset:34080
    s_waitcnt lgkmcnt(6)
    v_mfma_f32_16x16x32_bf16 v[88:91], v[240:243], v[56:59], v[88:91]
    ds_read_b64_tr_b16 v[232:233], v4 offset:33280
    v_mfma_f32_16x16x32_bf16 v[92:95], v[240:243], v[60:63], v[92:95]
    ds_read_b64_tr_b16 v[234:235], v4 offset:34304
    s_waitcnt lgkmcnt(6)
    v_mfma_f32_16x16x32_bf16 v[96:99], v[244:247], v[56:59], v[96:99]
    ds_read_b64_tr_b16 v[236:237], v5 offset:33312
    s_mov_b32 s23, 0x4000
    buffer_load_dwordx4 v[48:51], v6, s[8:11], s23 offen offset:2048 sc1
    v_mfma_f32_16x16x32_bf16 v[100:103], v[244:247], v[60:63], v[100:103]
    ds_read_b64_tr_b16 v[238:239], v5 offset:34336
    s_waitcnt lgkmcnt(6)
    v_mfma_f32_16x16x32_bf16 v[104:107], v[224:227], v[56:59], v[104:107]
    ds_read_b64_tr_b16 v[240:241], v4 offset:33536
    v_mfma_f32_16x16x32_bf16 v[108:111], v[224:227], v[60:63], v[108:111]
    ds_read_b64_tr_b16 v[242:243], v4 offset:34560
    s_mov_b32 s23, 0x24000
    buffer_load_dwordx4 v[52:55], v6, s[8:11], s23 offen offset:2048 sc1
    s_waitcnt lgkmcnt(6)
    v_mfma_f32_16x16x32_bf16 v[112:115], v[228:231], v[56:59], v[112:115]
    ds_read_b64_tr_b16 v[244:245], v5 offset:33568
    v_mfma_f32_16x16x32_bf16 v[116:119], v[228:231], v[60:63], v[116:119]
    ds_read_b64_tr_b16 v[246:247], v5 offset:34592
    s_waitcnt lgkmcnt(6)
    v_mfma_f32_16x16x32_bf16 v[120:123], v[232:235], v[56:59], v[120:123]
    v_mfma_f32_16x16x32_bf16 v[124:127], v[232:235], v[60:63], v[124:127]
    s_waitcnt vmcnt(14)
    s_barrier
    ds_read_b64_tr_b16 v[224:225], v4 offset:49152
    ds_read_b64_tr_b16 v[226:227], v4 offset:50176
    s_waitcnt lgkmcnt(6)
    v_mfma_f32_16x16x32_bf16 v[128:131], v[236:239], v[56:59], v[128:131]
    s_add_u32 s22, s24, 0x1a0000
    s_add_u32 m0, s20, 0x14000
    s_nop 0
    buffer_load_dwordx4 v3, s[4:7], s22 offen lds
    ds_read_b64_tr_b16 v[228:229], v5 offset:49184
    v_mfma_f32_16x16x32_bf16 v[132:135], v[236:239], v[60:63], v[132:135]
    ds_read_b64_tr_b16 v[230:231], v5 offset:50208
    s_waitcnt lgkmcnt(6)
    v_mfma_f32_16x16x32_bf16 v[136:139], v[240:243], v[56:59], v[136:139]
    ds_read_b64_tr_b16 v[232:233], v4 offset:49408
    v_mfma_f32_16x16x32_bf16 v[140:143], v[240:243], v[60:63], v[140:143]
    s_add_u32 s22, s24, 0x1a2000
    s_add_u32 m0, s20, 0x14400
    s_nop 0
    buffer_load_dwordx4 v3, s[4:7], s22 offen lds
    ds_read_b64_tr_b16 v[234:235], v4 offset:50432
    s_waitcnt lgkmcnt(6)
    v_mfma_f32_16x16x32_bf16 v[144:147], v[244:247], v[56:59], v[144:147]
    ds_read_b64_tr_b16 v[236:237], v5 offset:49440
    v_mfma_f32_16x16x32_bf16 v[148:151], v[244:247], v[60:63], v[148:151]
    ds_read_b64_tr_b16 v[238:239], v5 offset:50464
    s_waitcnt vmcnt(15) lgkmcnt(6)
    v_mfma_f32_16x16x32_bf16 v[88:91], v[224:227], v[24:27], v[88:91]
    ds_read_b64_tr_b16 v[240:241], v4 offset:49664
    s_waitcnt vmcnt(14)
    v_mfma_f32_16x16x32_bf16 v[92:95], v[224:227], v[28:31], v[92:95]
    ds_read_b64_tr_b16 v[242:243], v4 offset:50688
    s_waitcnt lgkmcnt(6)
    v_mfma_f32_16x16x32_bf16 v[96:99], v[228:231], v[24:27], v[96:99]
    ds_read_b64_tr_b16 v[244:245], v5 offset:49696
    s_mov_b32 s23, 0x6000
    buffer_load_dwordx4 v[56:59], v6, s[8:11], s23 offen offset:2048 sc1
    v_mfma_f32_16x16x32_bf16 v[100:103], v[228:231], v[28:31], v[100:103]
    ds_read_b64_tr_b16 v[246:247], v5 offset:50720
    s_waitcnt lgkmcnt(6)
    v_mfma_f32_16x16x32_bf16 v[104:107], v[232:235], v[24:27], v[104:107]
    ds_read_b64_tr_b16 v[224:225], v4 offset:49920
    v_mfma_f32_16x16x32_bf16 v[108:111], v[232:235], v[28:31], v[108:111]
    ds_read_b64_tr_b16 v[226:227], v4 offset:50944
    s_mov_b32 s23, 0x26000
    buffer_load_dwordx4 v[60:63], v6, s[8:11], s23 offen offset:2048 sc1
    s_waitcnt lgkmcnt(6)
    v_mfma_f32_16x16x32_bf16 v[112:115], v[236:239], v[24:27], v[112:115]
    ds_read_b64_tr_b16 v[228:229], v5 offset:49952
    v_mfma_f32_16x16x32_bf16 v[116:119], v[236:239], v[28:31], v[116:119]
    ds_read_b64_tr_b16 v[230:231], v5 offset:50976
    s_waitcnt lgkmcnt(6)
    v_mfma_f32_16x16x32_bf16 v[120:123], v[240:243], v[24:27], v[120:123]
    v_mfma_f32_16x16x32_bf16 v[124:127], v[240:243], v[28:31], v[124:127]
    s_waitcnt vmcnt(14)
    s_barrier
    ds_read_b64_tr_b16 v[232:233], v7 offset:0
    ds_read_b64_tr_b16 v[234:235], v7 offset:1024
    s_waitcnt lgkmcnt(6)
    v_mfma_f32_16x16x32_bf16 v[128:131], v[244:247], v[24:27], v[128:131]
    s_add_u32 s22, s24, 0x220000
    s_add_u32 m0, s20, 0x18000
    s_nop 0
    buffer_load_dwordx4 v3, s[4:7], s22 offen lds
    ds_read_b64_tr_b16 v[236:237], v8 offset:32
    v_mfma_f32_16x16x32_bf16 v[132:135], v[244:247], v[28:31], v[132:135]
    ds_read_b64_tr_b16 v[238:239], v8 offset:1056
    s_waitcnt lgkmcnt(6)
    v_mfma_f32_16x16x32_bf16 v[136:139], v[224:227], v[24:27], v[136:139]
    ds_read_b64_tr_b16 v[240:241], v7 offset:256
    v_mfma_f32_16x16x32_bf16 v[140:143], v[224:227], v[28:31], v[140:143]
    s_add_u32 s22, s24, 0x222000
    s_add_u32 m0, s20, 0x18400
    s_nop 0
    buffer_load_dwordx4 v3, s[4:7], s22 offen lds
    ds_read_b64_tr_b16 v[242:243], v7 offset:1280
    s_waitcnt lgkmcnt(6)
    v_mfma_f32_16x16x32_bf16 v[144:147], v[228:231], v[24:27], v[144:147]
    ds_read_b64_tr_b16 v[244:245], v8 offset:288
    v_mfma_f32_16x16x32_bf16 v[148:151], v[228:231], v[28:31], v[148:151]
    ds_read_b64_tr_b16 v[246:247], v8 offset:1312
    s_waitcnt vmcnt(15) lgkmcnt(6)
    v_mfma_f32_16x16x32_bf16 v[88:91], v[232:235], v[32:35], v[88:91]
    ds_read_b64_tr_b16 v[224:225], v7 offset:512
    s_waitcnt vmcnt(14)
    v_mfma_f32_16x16x32_bf16 v[92:95], v[232:235], v[36:39], v[92:95]
    ds_read_b64_tr_b16 v[226:227], v7 offset:1536
    s_waitcnt lgkmcnt(6)
    v_mfma_f32_16x16x32_bf16 v[96:99], v[236:239], v[32:35], v[96:99]
    ds_read_b64_tr_b16 v[228:229], v8 offset:544
    s_mov_b32 s23, 0x8000
    buffer_load_dwordx4 v[24:27], v6, s[8:11], s23 offen offset:2048 sc1
    v_mfma_f32_16x16x32_bf16 v[100:103], v[236:239], v[36:39], v[100:103]
    ds_read_b64_tr_b16 v[230:231], v8 offset:1568
    s_waitcnt lgkmcnt(6)
    v_mfma_f32_16x16x32_bf16 v[104:107], v[240:243], v[32:35], v[104:107]
    ds_read_b64_tr_b16 v[232:233], v7 offset:768
    v_mfma_f32_16x16x32_bf16 v[108:111], v[240:243], v[36:39], v[108:111]
    ds_read_b64_tr_b16 v[234:235], v7 offset:1792
    s_mov_b32 s23, 0x28000
    buffer_load_dwordx4 v[28:31], v6, s[8:11], s23 offen offset:2048 sc1
    s_waitcnt lgkmcnt(6)
    v_mfma_f32_16x16x32_bf16 v[112:115], v[244:247], v[32:35], v[112:115]
    ds_read_b64_tr_b16 v[236:237], v8 offset:800
    v_mfma_f32_16x16x32_bf16 v[116:119], v[244:247], v[36:39], v[116:119]
    ds_read_b64_tr_b16 v[238:239], v8 offset:1824
    s_waitcnt lgkmcnt(6)
    v_mfma_f32_16x16x32_bf16 v[120:123], v[224:227], v[32:35], v[120:123]
    v_mfma_f32_16x16x32_bf16 v[124:127], v[224:227], v[36:39], v[124:127]
    s_waitcnt vmcnt(14)
    s_barrier
    ds_read_b64_tr_b16 v[240:241], v7 offset:16384
    ds_read_b64_tr_b16 v[242:243], v7 offset:17408
    s_waitcnt lgkmcnt(6)
    v_mfma_f32_16x16x32_bf16 v[128:131], v[228:231], v[32:35], v[128:131]
    s_add_u32 s22, s24, 0x2a0000
    s_add_u32 m0, s20, 0x1c000
    s_nop 0
    buffer_load_dwordx4 v3, s[4:7], s22 offen lds
    ds_read_b64_tr_b16 v[244:245], v8 offset:16416
    v_mfma_f32_16x16x32_bf16 v[132:135], v[228:231], v[36:39], v[132:135]
    ds_read_b64_tr_b16 v[246:247], v8 offset:17440
    s_waitcnt lgkmcnt(6)
    v_mfma_f32_16x16x32_bf16 v[136:139], v[232:235], v[32:35], v[136:139]
    ds_read_b64_tr_b16 v[224:225], v7 offset:16640
    v_mfma_f32_16x16x32_bf16 v[140:143], v[232:235], v[36:39], v[140:143]
    s_add_u32 s22, s24, 0x2a2000
    s_add_u32 m0, s20, 0x1c400
    s_nop 0
    buffer_load_dwordx4 v3, s[4:7], s22 offen lds
    ds_read_b64_tr_b16 v[226:227], v7 offset:17664
    s_waitcnt lgkmcnt(6)
    v_mfma_f32_16x16x32_bf16 v[144:147], v[236:239], v[32:35], v[144:147]
    ds_read_b64_tr_b16 v[228:229], v8 offset:16672
    v_mfma_f32_16x16x32_bf16 v[148:151], v[236:239], v[36:39], v[148:151]
    ds_read_b64_tr_b16 v[230:231], v8 offset:17696
    s_waitcnt vmcnt(15) lgkmcnt(6)
    v_mfma_f32_16x16x32_bf16 v[88:91], v[240:243], v[40:43], v[88:91]
    ds_read_b64_tr_b16 v[232:233], v7 offset:16896
    s_waitcnt vmcnt(14)
    v_mfma_f32_16x16x32_bf16 v[92:95], v[240:243], v[44:47], v[92:95]
    ds_read_b64_tr_b16 v[234:235], v7 offset:17920
    s_waitcnt lgkmcnt(6)
    v_mfma_f32_16x16x32_bf16 v[96:99], v[244:247], v[40:43], v[96:99]
    ds_read_b64_tr_b16 v[236:237], v8 offset:16928
    s_mov_b32 s23, 0xa000
    buffer_load_dwordx4 v[32:35], v6, s[8:11], s23 offen offset:2048 sc1
    v_mfma_f32_16x16x32_bf16 v[100:103], v[244:247], v[44:47], v[100:103]
    ds_read_b64_tr_b16 v[238:239], v8 offset:17952
    s_waitcnt lgkmcnt(6)
    v_mfma_f32_16x16x32_bf16 v[104:107], v[224:227], v[40:43], v[104:107]
    ds_read_b64_tr_b16 v[240:241], v7 offset:17152
    v_mfma_f32_16x16x32_bf16 v[108:111], v[224:227], v[44:47], v[108:111]
    ds_read_b64_tr_b16 v[242:243], v7 offset:18176
    s_mov_b32 s23, 0x2a000
    buffer_load_dwordx4 v[36:39], v6, s[8:11], s23 offen offset:2048 sc1
    s_waitcnt lgkmcnt(6)
    v_mfma_f32_16x16x32_bf16 v[112:115], v[228:231], v[40:43], v[112:115]
    ds_read_b64_tr_b16 v[244:245], v8 offset:17184
    v_mfma_f32_16x16x32_bf16 v[116:119], v[228:231], v[44:47], v[116:119]
    ds_read_b64_tr_b16 v[246:247], v8 offset:18208
    s_waitcnt lgkmcnt(6)
    v_mfma_f32_16x16x32_bf16 v[120:123], v[232:235], v[40:43], v[120:123]
    v_mfma_f32_16x16x32_bf16 v[124:127], v[232:235], v[44:47], v[124:127]
    s_waitcnt vmcnt(14)
    s_barrier
    ds_read_b64_tr_b16 v[224:225], v4 offset:0
    ds_read_b64_tr_b16 v[226:227], v4 offset:1024
    s_waitcnt lgkmcnt(6)
    v_mfma_f32_16x16x32_bf16 v[128:131], v[236:239], v[40:43], v[128:131]
    s_add_u32 s22, s24, 0x320000
    s_add_u32 m0, s20, 0x20000
    s_nop 0
    buffer_load_dwordx4 v3, s[4:7], s22 offen lds
    ds_read_b64_tr_b16 v[228:229], v5 offset:32
    v_mfma_f32_16x16x32_bf16 v[132:135], v[236:239], v[44:47], v[132:135]
    ds_read_b64_tr_b16 v[230:231], v5 offset:1056
    s_waitcnt lgkmcnt(6)
    v_mfma_f32_16x16x32_bf16 v[136:139], v[240:243], v[40:43], v[136:139]
    ds_read_b64_tr_b16 v[232:233], v4 offset:256
    v_mfma_f32_16x16x32_bf16 v[140:143], v[240:243], v[44:47], v[140:143]
    s_add_u32 s22, s24, 0x322000
    s_add_u32 m0, s20, 0x20400
    s_nop 0
    buffer_load_dwordx4 v3, s[4:7], s22 offen lds
    ds_read_b64_tr_b16 v[234:235], v4 offset:1280
    s_waitcnt lgkmcnt(6)
    v_mfma_f32_16x16x32_bf16 v[144:147], v[244:247], v[40:43], v[144:147]
    ds_read_b64_tr_b16 v[236:237], v5 offset:288
    v_mfma_f32_16x16x32_bf16 v[148:151], v[244:247], v[44:47], v[148:151]
    ds_read_b64_tr_b16 v[238:239], v5 offset:1312
    s_waitcnt vmcnt(15) lgkmcnt(6)
    v_mfma_f32_16x16x32_bf16 v[88:91], v[224:227], v[48:51], v[88:91]
    v_mov_b32 v248, s28
    v_mov_b32 v249, 0
    s_lshl_b32 s14, s2, 2
    s_add_u32 s14, s14, 0x544000
    s_cmp_eq_u32 s3, 0
    s_cselect_b32 s14, s14, 0x7ffffff0
    s_mov_b64 exec, 1
    buffer_store_dword v248, v249, s[8:11], s14 offen sc1
    s_mov_b64 exec, -1
    ds_read_b64_tr_b16 v[240:241], v4 offset:512
    s_waitcnt vmcnt(15)
    v_mfma_f32_16x16x32_bf16 v[92:95], v[224:227], v[52:55], v[92:95]
    ds_read_b64_tr_b16 v[242:243], v4 offset:1536
    s_waitcnt lgkmcnt(6)
    v_mfma_f32_16x16x32_bf16 v[96:99], v[228:231], v[48:51], v[96:99]
    ds_read_b64_tr_b16 v[244:245], v5 offset:544
    s_mov_b32 s23, 0xc000
    buffer_load_dwordx4 v[40:43], v6, s[8:11], s23 offen offset:2048 sc1
    v_mfma_f32_16x16x32_bf16 v[100:103], v[228:231], v[52:55], v[100:103]
    ds_read_b64_tr_b16 v[246:247], v5 offset:1568
    s_waitcnt lgkmcnt(6)
    v_mfma_f32_16x16x32_bf16 v[104:107], v[232:235], v[48:51], v[104:107]
    ds_read_b64_tr_b16 v[224:225], v4 offset:768
    v_mfma_f32_16x16x32_bf16 v[108:111], v[232:235], v[52:55], v[108:111]
    ds_read_b64_tr_b16 v[226:227], v4 offset:1792
    s_mov_b32 s23, 0x2c000
    buffer_load_dwordx4 v[44:47], v6, s[8:11], s23 offen offset:2048 sc1
    s_waitcnt lgkmcnt(6)
    v_mfma_f32_16x16x32_bf16 v[112:115], v[236:239], v[48:51], v[112:115]
    ds_read_b64_tr_b16 v[228:229], v5 offset:800
    v_mfma_f32_16x16x32_bf16 v[116:119], v[236:239], v[52:55], v[116:119]
    ds_read_b64_tr_b16 v[230:231], v5 offset:1824
    s_waitcnt lgkmcnt(6)
    v_mfma_f32_16x16x32_bf16 v[120:123], v[240:243], v[48:51], v[120:123]
    v_mfma_f32_16x16x32_bf16 v[124:127], v[240:243], v[52:55], v[124:127]
    s_waitcnt vmcnt(15)
    s_barrier
    ds_read_b64_tr_b16 v[232:233], v4 offset:16384
    ds_read_b64_tr_b16 v[234:235], v4 offset:17408
    s_add_u32 s19, s19, 8192
    buffer_load_dword v12, v13, s[8:11], s19 offen sc1
    s_waitcnt lgkmcnt(6)
    v_mfma_f32_16x16x32_bf16 v[128:131], v[244:247], v[48:51], v[128:131]
    s_add_u32 s22, s24, 0x3a0000
    s_add_u32 m0, s20, 0x24000
    s_nop 0
    buffer_load_dwordx4 v3, s[4:7], s22 offen lds
    ds_read_b64_tr_b16 v[236:237], v5 offset:16416
    v_mfma_f32_16x16x32_bf16 v[132:135], v[244:247], v[52:55], v[132:135]
    ds_read_b64_tr_b16 v[238:239], v5 offset:17440
    s_waitcnt lgkmcnt(6)
    v_mfma_f32_16x16x32_bf16 v[136:139], v[224:227], v[48:51], v[136:139]
    ds_read_b64_tr_b16 v[240:241], v4 offset:16640
    v_mfma_f32_16x16x32_bf16 v[140:143], v[224:227], v[52:55], v[140:143]
    s_add_u32 s22, s24, 0x3a2000
    s_add_u32 m0, s20, 0x24400
    s_nop 0
    buffer_load_dwordx4 v3, s[4:7], s22 offen lds
    ds_read_b64_tr_b16 v[242:243], v4 offset:17664
    s_waitcnt lgkmcnt(6)
    v_mfma_f32_16x16x32_bf16 v[144:147], v[228:231], v[48:51], v[144:147]
    ds_read_b64_tr_b16 v[244:245], v5 offset:16672
    v_mfma_f32_16x16x32_bf16 v[148:151], v[228:231], v[52:55], v[148:151]
    ds_read_b64_tr_b16 v[246:247], v5 offset:17696
    s_waitcnt vmcnt(17) lgkmcnt(6)
    v_mfma_f32_16x16x32_bf16 v[88:91], v[232:235], v[56:59], v[88:91]
    ds_read_b64_tr_b16 v[224:225], v4 offset:16896
    s_waitcnt vmcnt(16)
    v_mfma_f32_16x16x32_bf16 v[92:95], v[232:235], v[60:63], v[92:95]
    ds_read_b64_tr_b16 v[226:227], v4 offset:17920
    s_waitcnt lgkmcnt(6)
    v_mfma_f32_16x16x32_bf16 v[96:99], v[236:239], v[56:59], v[96:99]
    ds_read_b64_tr_b16 v[228:229], v5 offset:16928
    s_mov_b32 s23, 0xe000
    buffer_load_dwordx4 v[48:51], v6, s[8:11], s23 offen offset:2048 sc1
    v_mfma_f32_16x16x32_bf16 v[100:103], v[236:239], v[60:63], v[100:103]
    ds_read_b64_tr_b16 v[230:231], v5 offset:17952
    s_waitcnt lgkmcnt(6)
    v_mfma_f32_16x16x32_bf16 v[104:107], v[240:243], v[56:59], v[104:107]
    ds_read_b64_tr_b16 v[232:233], v4 offset:17152
    v_mfma_f32_16x16x32_bf16 v[108:111], v[240:243], v[60:63], v[108:111]
    ds_read_b64_tr_b16 v[234:235], v4 offset:18176
    s_mov_b32 s23, 0x2e000
    buffer_load_dwordx4 v[52:55], v6, s[8:11], s23 offen offset:2048 sc1
    s_waitcnt lgkmcnt(6)
    v_mfma_f32_16x16x32_bf16 v[112:115], v[244:247], v[56:59], v[112:115]
    ds_read_b64_tr_b16 v[236:237], v5 offset:17184
    v_mfma_f32_16x16x32_bf16 v[116:119], v[244:247], v[60:63], v[116:119]
    ds_read_b64_tr_b16 v[238:239], v5 offset:18208
    s_waitcnt lgkmcnt(6)
    v_mfma_f32_16x16x32_bf16 v[120:123], v[224:227], v[56:59], v[120:123]
    v_mfma_f32_16x16x32_bf16 v[124:127], v[224:227], v[60:63], v[124:127]
    s_waitcnt vmcnt(16)
    s_barrier
    ds_read_b64_tr_b16 v[240:241], v4 offset:32768
    ds_read_b64_tr_b16 v[242:243], v4 offset:33792
    s_waitcnt lgkmcnt(6)
    v_mfma_f32_16x16x32_bf16 v[128:131], v[228:231], v[56:59], v[128:131]
    s_add_u32 s22, s24, 0x30000
    s_add_u32 m0, s20, 0x10000
    s_nop 0
    buffer_load_dwordx4 v3, s[4:7], s22 offen lds
    ds_read_b64_tr_b16 v[244:245], v5 offset:32800
    v_mfma_f32_16x16x32_bf16 v[132:135], v[228:231], v[60:63], v[132:135]
    ds_read_b64_tr_b16 v[246:247], v5 offset:33824
    s_waitcnt lgkmcnt(6)
    v_mfma_f32_16x16x32_bf16 v[136:139], v[232:235], v[56:59], v[136:139]
    ds_read_b64_tr_b16 v[224:225], v4 offset:33024
    v_mfma_f32_16x16x32_bf16 v[140:143], v[232:235], v[60:63], v[140:143]
    s_add_u32 s22, s24, 0x32000
    s_add_u32 m0, s20, 0x10400
    s_nop 0
    buffer_load_dwordx4 v3, s[4:7], s22 offen lds
    ds_read_b64_tr_b16 v[226:227], v4 offset:34048
    s_waitcnt lgkmcnt(6)
    v_mfma_f32_16x16x32_bf16 v[144:147], v[236:239], v[56:59], v[144:147]
    ds_read_b64_tr_b16 v[228:229], v5 offset:33056
    v_mfma_f32_16x16x32_bf16 v[148:151], v[236:239], v[60:63], v[148:151]
    ds_read_b64_tr_b16 v[230:231], v5 offset:34080
    s_waitcnt vmcnt(6)
    v_cmp_ne_u32 vcc, s28, v12
    s_cbranch_vccnz adaLN_cond__sliding_block_cached__moe_arch_mod__prompt_kernel_o29r
adaLN_cond__sliding_block_cached__moe_arch_mod__prompt_kernel_o29b:
    s_waitcnt lgkmcnt(6)
    v_mfma_f32_16x16x32_bf16 v[88:91], v[240:243], v[24:27], v[88:91]
    ds_read_b64_tr_b16 v[232:233], v4 offset:33280
    v_mfma_f32_16x16x32_bf16 v[92:95], v[240:243], v[28:31], v[92:95]
    ds_read_b64_tr_b16 v[234:235], v4 offset:34304
    s_waitcnt lgkmcnt(6)
    v_mfma_f32_16x16x32_bf16 v[96:99], v[244:247], v[24:27], v[96:99]
    ds_read_b64_tr_b16 v[236:237], v5 offset:33312
    s_mov_b32 s23, 0x0
    buffer_load_dwordx4 v[56:59], v6, s[8:11], s23 offen offset:3072 sc1
    v_mfma_f32_16x16x32_bf16 v[100:103], v[244:247], v[28:31], v[100:103]
    ds_read_b64_tr_b16 v[238:239], v5 offset:34336
    s_waitcnt lgkmcnt(6)
    v_mfma_f32_16x16x32_bf16 v[104:107], v[224:227], v[24:27], v[104:107]
    ds_read_b64_tr_b16 v[240:241], v4 offset:33536
    v_mfma_f32_16x16x32_bf16 v[108:111], v[224:227], v[28:31], v[108:111]
    ds_read_b64_tr_b16 v[242:243], v4 offset:34560
    s_mov_b32 s23, 0x20000
    buffer_load_dwordx4 v[60:63], v6, s[8:11], s23 offen offset:3072 sc1
    s_waitcnt lgkmcnt(6)
    v_mfma_f32_16x16x32_bf16 v[112:115], v[228:231], v[24:27], v[112:115]
    ds_read_b64_tr_b16 v[244:245], v5 offset:33568
    v_mfma_f32_16x16x32_bf16 v[116:119], v[228:231], v[28:31], v[116:119]
    ds_read_b64_tr_b16 v[246:247], v5 offset:34592
    s_waitcnt lgkmcnt(6)
    v_mfma_f32_16x16x32_bf16 v[120:123], v[232:235], v[24:27], v[120:123]
    v_mfma_f32_16x16x32_bf16 v[124:127], v[232:235], v[28:31], v[124:127]
    s_barrier
    ds_read_b64_tr_b16 v[224:225], v4 offset:49152
    ds_read_b64_tr_b16 v[226:227], v4 offset:50176
    s_waitcnt lgkmcnt(6)
    v_mfma_f32_16x16x32_bf16 v[128:131], v[236:239], v[24:27], v[128:131]
    s_add_u32 s22, s24, 0xb0000
    s_add_u32 m0, s20, 0x14000
    s_nop 0
    buffer_load_dwordx4 v3, s[4:7], s22 offen lds
    ds_read_b64_tr_b16 v[228:229], v5 offset:49184
    v_mfma_f32_16x16x32_bf16 v[132:135], v[236:239], v[28:31], v[132:135]
    ds_read_b64_tr_b16 v[230:231], v5 offset:50208
    s_waitcnt lgkmcnt(6)
    v_mfma_f32_16x16x32_bf16 v[136:139], v[240:243], v[24:27], v[136:139]
    ds_read_b64_tr_b16 v[232:233], v4 offset:49408
    v_mfma_f32_16x16x32_bf16 v[140:143], v[240:243], v[28:31], v[140:143]
    s_add_u32 s22, s24, 0xb2000
    s_add_u32 m0, s20, 0x14400
    s_nop 0
    buffer_load_dwordx4 v3, s[4:7], s22 offen lds
    ds_read_b64_tr_b16 v[234:235], v4 offset:50432
    s_waitcnt lgkmcnt(6)
    v_mfma_f32_16x16x32_bf16 v[144:147], v[244:247], v[24:27], v[144:147]
    ds_read_b64_tr_b16 v[236:237], v5 offset:49440
    v_mfma_f32_16x16x32_bf16 v[148:151], v[244:247], v[28:31], v[148:151]
    ds_read_b64_tr_b16 v[238:239], v5 offset:50464
    s_waitcnt lgkmcnt(6)
    v_mfma_f32_16x16x32_bf16 v[88:91], v[224:227], v[32:35], v[88:91]
    ds_read_b64_tr_b16 v[240:241], v4 offset:49664
    v_mfma_f32_16x16x32_bf16 v[92:95], v[224:227], v[36:39], v[92:95]
    ds_read_b64_tr_b16 v[242:243], v4 offset:50688
    s_waitcnt lgkmcnt(6)
    v_mfma_f32_16x16x32_bf16 v[96:99], v[228:231], v[32:35], v[96:99]
    ds_read_b64_tr_b16 v[244:245], v5 offset:49696
    s_mov_b32 s23, 0x2000
    buffer_load_dwordx4 v[24:27], v6, s[8:11], s23 offen offset:3072 sc1
    v_mfma_f32_16x16x32_bf16 v[100:103], v[228:231], v[36:39], v[100:103]
    ds_read_b64_tr_b16 v[246:247], v5 offset:50720
    s_waitcnt lgkmcnt(6)
    v_mfma_f32_16x16x32_bf16 v[104:107], v[232:235], v[32:35], v[104:107]
    ds_read_b64_tr_b16 v[224:225], v4 offset:49920
    v_mfma_f32_16x16x32_bf16 v[108:111], v[232:235], v[36:39], v[108:111]
    ds_read_b64_tr_b16 v[226:227], v4 offset:50944
    s_mov_b32 s23, 0x22000
    buffer_load_dwordx4 v[28:31], v6, s[8:11], s23 offen offset:3072 sc1
    s_waitcnt lgkmcnt(6)
    v_mfma_f32_16x16x32_bf16 v[112:115], v[236:239], v[32:35], v[112:115]
    ds_read_b64_tr_b16 v[228:229], v5 offset:49952
    v_mfma_f32_16x16x32_bf16 v[116:119], v[236:239], v[36:39], v[116:119]
    ds_read_b64_tr_b16 v[230:231], v5 offset:50976
    s_waitcnt lgkmcnt(6)
    v_mfma_f32_16x16x32_bf16 v[120:123], v[240:243], v[32:35], v[120:123]
    v_mfma_f32_16x16x32_bf16 v[124:127], v[240:243], v[36:39], v[124:127]
    s_barrier
    ds_read_b64_tr_b16 v[232:233], v7 offset:0
    ds_read_b64_tr_b16 v[234:235], v7 offset:1024
    s_waitcnt lgkmcnt(6)
    v_mfma_f32_16x16x32_bf16 v[128:131], v[244:247], v[32:35], v[128:131]
    s_add_u32 s22, s24, 0x130000
    s_add_u32 m0, s20, 0x18000
    s_nop 0
    buffer_load_dwordx4 v3, s[4:7], s22 offen lds
    ds_read_b64_tr_b16 v[236:237], v8 offset:32
    v_mfma_f32_16x16x32_bf16 v[132:135], v[244:247], v[36:39], v[132:135]
    ds_read_b64_tr_b16 v[238:239], v8 offset:1056
    s_waitcnt lgkmcnt(6)
    v_mfma_f32_16x16x32_bf16 v[136:139], v[224:227], v[32:35], v[136:139]
    ds_read_b64_tr_b16 v[240:241], v7 offset:256
    v_mfma_f32_16x16x32_bf16 v[140:143], v[224:227], v[36:39], v[140:143]
    s_add_u32 s22, s24, 0x132000
    s_add_u32 m0, s20, 0x18400
    s_nop 0
    buffer_load_dwordx4 v3, s[4:7], s22 offen lds
    ds_read_b64_tr_b16 v[242:243], v7 offset:1280
    s_waitcnt lgkmcnt(6)
    v_mfma_f32_16x16x32_bf16 v[144:147], v[228:231], v[32:35], v[144:147]
    ds_read_b64_tr_b16 v[244:245], v8 offset:288
    v_mfma_f32_16x16x32_bf16 v[148:151], v[228:231], v[36:39], v[148:151]
    ds_read_b64_tr_b16 v[246:247], v8 offset:1312
    s_waitcnt lgkmcnt(6)
    v_mfma_f32_16x16x32_bf16 v[88:91], v[232:235], v[40:43], v[88:91]
    ds_read_b64_tr_b16 v[224:225], v7 offset:512
    v_mfma_f32_16x16x32_bf16 v[92:95], v[232:235], v[44:47], v[92:95]
    ds_read_b64_tr_b16 v[226:227], v7 offset:1536
    s_waitcnt lgkmcnt(6)
    v_mfma_f32_16x16x32_bf16 v[96:99], v[236:239], v[40:43], v[96:99]
    ds_read_b64_tr_b16 v[228:229], v8 offset:544
    s_mov_b32 s23, 0x4000
    buffer_load_dwordx4 v[32:35], v6, s[8:11], s23 offen offset:3072 sc1
    v_mfma_f32_16x16x32_bf16 v[100:103], v[236:239], v[44:47], v[100:103]
    ds_read_b64_tr_b16 v[230:231], v8 offset:1568
    s_waitcnt lgkmcnt(6)
    v_mfma_f32_16x16x32_bf16 v[104:107], v[240:243], v[40:43], v[104:107]
    ds_read_b64_tr_b16 v[232:233], v7 offset:768
    v_mfma_f32_16x16x32_bf16 v[108:111], v[240:243], v[44:47], v[108:111]
    ds_read_b64_tr_b16 v[234:235], v7 offset:1792
    s_mov_b32 s23, 0x24000
    buffer_load_dwordx4 v[36:39], v6, s[8:11], s23 offen offset:3072 sc1
    s_waitcnt lgkmcnt(6)
    v_mfma_f32_16x16x32_bf16 v[112:115], v[244:247], v[40:43], v[112:115]
    ds_read_b64_tr_b16 v[236:237], v8 offset:800
    v_mfma_f32_16x16x32_bf16 v[116:119], v[244:247], v[44:47], v[116:119]
    ds_read_b64_tr_b16 v[238:239], v8 offset:1824
    s_waitcnt lgkmcnt(6)
    v_mfma_f32_16x16x32_bf16 v[120:123], v[224:227], v[40:43], v[120:123]
    v_mfma_f32_16x16x32_bf16 v[124:127], v[224:227], v[44:47], v[124:127]
    s_waitcnt vmcnt(14)
    s_barrier
    ds_read_b64_tr_b16 v[240:241], v7 offset:16384
    ds_read_b64_tr_b16 v[242:243], v7 offset:17408
    s_waitcnt lgkmcnt(6)
    v_mfma_f32_16x16x32_bf16 v[128:131], v[228:231], v[40:43], v[128:131]
    s_add_u32 s22, s24, 0x1b0000
    s_add_u32 m0, s20, 0x1c000
    s_nop 0
    buffer_load_dwordx4 v3, s[4:7], s22 offen lds
    ds_read_b64_tr_b16 v[244:245], v8 offset:16416
    v_mfma_f32_16x16x32_bf16 v[132:135], v[228:231], v[44:47], v[132:135]
    ds_read_b64_tr_b16 v[246:247], v8 offset:17440
    s_waitcnt lgkmcnt(6)
    v_mfma_f32_16x16x32_bf16 v[136:139], v[232:235], v[40:43], v[136:139]
    ds_read_b64_tr_b16 v[224:225], v7 offset:16640
    v_mfma_f32_16x16x32_bf16 v[140:143], v[232:235], v[44:47], v[140:143]
    s_add_u32 s22, s24, 0x1b2000
    s_add_u32 m0, s20, 0x1c400
    s_nop 0
    buffer_load_dwordx4 v3, s[4:7], s22 offen lds
    ds_read_b64_tr_b16 v[226:227], v7 offset:17664
    s_waitcnt lgkmcnt(6)
    v_mfma_f32_16x16x32_bf16 v[144:147], v[236:239], v[40:43], v[144:147]
    ds_read_b64_tr_b16 v[228:229], v8 offset:16672
    v_mfma_f32_16x16x32_bf16 v[148:151], v[236:239], v[44:47], v[148:151]
    ds_read_b64_tr_b16 v[230:231], v8 offset:17696
    s_waitcnt vmcnt(15) lgkmcnt(6)
    v_mfma_f32_16x16x32_bf16 v[88:91], v[240:243], v[48:51], v[88:91]
    ds_read_b64_tr_b16 v[232:233], v7 offset:16896
    s_waitcnt vmcnt(14)
    v_mfma_f32_16x16x32_bf16 v[92:95], v[240:243], v[52:55], v[92:95]
    ds_read_b64_tr_b16 v[234:235], v7 offset:17920
    s_waitcnt lgkmcnt(6)
    v_mfma_f32_16x16x32_bf16 v[96:99], v[244:247], v[48:51], v[96:99]
    ds_read_b64_tr_b16 v[236:237], v8 offset:16928
    s_mov_b32 s23, 0x6000
    buffer_load_dwordx4 v[40:43], v6, s[8:11], s23 offen offset:3072 sc1
    v_mfma_f32_16x16x32_bf16 v[100:103], v[244:247], v[52:55], v[100:103]
    ds_read_b64_tr_b16 v[238:239], v8 offset:17952
    s_waitcnt lgkmcnt(6)
    v_mfma_f32_16x16x32_bf16 v[104:107], v[224:227], v[48:51], v[104:107]
    ds_read_b64_tr_b16 v[240:241], v7 offset:17152
    v_mfma_f32_16x16x32_bf16 v[108:111], v[224:227], v[52:55], v[108:111]
    ds_read_b64_tr_b16 v[242:243], v7 offset:18176
    s_mov_b32 s23, 0x26000
    buffer_load_dwordx4 v[44:47], v6, s[8:11], s23 offen offset:3072 sc1
    s_waitcnt lgkmcnt(6)
    v_mfma_f32_16x16x32_bf16 v[112:115], v[228:231], v[48:51], v[112:115]
    ds_read_b64_tr_b16 v[244:245], v8 offset:17184
    v_mfma_f32_16x16x32_bf16 v[116:119], v[228:231], v[52:55], v[116:119]
    ds_read_b64_tr_b16 v[246:247], v8 offset:18208
    s_waitcnt lgkmcnt(6)
    v_mfma_f32_16x16x32_bf16 v[120:123], v[232:235], v[48:51], v[120:123]
    v_mfma_f32_16x16x32_bf16 v[124:127], v[232:235], v[52:55], v[124:127]
    s_waitcnt vmcnt(14)
    s_barrier
    ds_read_b64_tr_b16 v[224:225], v4 offset:0
    ds_read_b64_tr_b16 v[226:227], v4 offset:1024
    s_waitcnt lgkmcnt(6)
    v_mfma_f32_16x16x32_bf16 v[128:131], v[236:239], v[48:51], v[128:131]
    s_add_u32 s22, s24, 0x230000
    s_add_u32 m0, s20, 0x20000
    s_nop 0
    buffer_load_dwordx4 v3, s[4:7], s22 offen lds
    ds_read_b64_tr_b16 v[228:229], v5 offset:32
    v_mfma_f32_16x16x32_bf16 v[132:135], v[236:239], v[52:55], v[132:135]
    ds_read_b64_tr_b16 v[230:231], v5 offset:1056
    s_waitcnt lgkmcnt(6)
    v_mfma_f32_16x16x32_bf16 v[136:139], v[240:243], v[48:51], v[136:139]
    ds_read_b64_tr_b16 v[232:233], v4 offset:256
    v_mfma_f32_16x16x32_bf16 v[140:143], v[240:243], v[52:55], v[140:143]
    s_add_u32 s22, s24, 0x232000
    s_add_u32 m0, s20, 0x20400
    s_nop 0
    buffer_load_dwordx4 v3, s[4:7], s22 offen lds
    ds_read_b64_tr_b16 v[234:235], v4 offset:1280
    s_waitcnt lgkmcnt(6)
    v_mfma_f32_16x16x32_bf16 v[144:147], v[244:247], v[48:51], v[144:147]
    ds_read_b64_tr_b16 v[236:237], v5 offset:288
    v_mfma_f32_16x16x32_bf16 v[148:151], v[244:247], v[52:55], v[148:151]
    ds_read_b64_tr_b16 v[238:239], v5 offset:1312
    s_waitcnt vmcnt(15) lgkmcnt(6)
    v_mfma_f32_16x16x32_bf16 v[88:91], v[224:227], v[56:59], v[88:91]
    ds_read_b64_tr_b16 v[240:241], v4 offset:512
    s_waitcnt vmcnt(14)
    v_mfma_f32_16x16x32_bf16 v[92:95], v[224:227], v[60:63], v[92:95]
    ds_read_b64_tr_b16 v[242:243], v4 offset:1536
    s_waitcnt lgkmcnt(6)
    v_mfma_f32_16x16x32_bf16 v[96:99], v[228:231], v[56:59], v[96:99]
    ds_read_b64_tr_b16 v[244:245], v5 offset:544
    s_mov_b32 s23, 0x8000
    buffer_load_dwordx4 v[48:51], v6, s[8:11], s23 offen offset:3072 sc1
    v_mfma_f32_16x16x32_bf16 v[100:103], v[228:231], v[60:63], v[100:103]
    ds_read_b64_tr_b16 v[246:247], v5 offset:1568
    s_waitcnt lgkmcnt(6)
    v_mfma_f32_16x16x32_bf16 v[104:107], v[232:235], v[56:59], v[104:107]
    ds_read_b64_tr_b16 v[224:225], v4 offset:768
    v_mfma_f32_16x16x32_bf16 v[108:111], v[232:235], v[60:63], v[108:111]
    ds_read_b64_tr_b16 v[226:227], v4 offset:1792
    s_mov_b32 s23, 0x28000
    buffer_load_dwordx4 v[52:55], v6, s[8:11], s23 offen offset:3072 sc1
    s_waitcnt lgkmcnt(6)
    v_mfma_f32_16x16x32_bf16 v[112:115], v[236:239], v[56:59], v[112:115]
    ds_read_b64_tr_b16 v[228:229], v5 offset:800
    v_mfma_f32_16x16x32_bf16 v[116:119], v[236:239], v[60:63], v[116:119]
    ds_read_b64_tr_b16 v[230:231], v5 offset:1824
    s_waitcnt lgkmcnt(6)
    v_mfma_f32_16x16x32_bf16 v[120:123], v[240:243], v[56:59], v[120:123]
    v_mfma_f32_16x16x32_bf16 v[124:127], v[240:243], v[60:63], v[124:127]
    s_waitcnt vmcnt(14)
    s_barrier
    ds_read_b64_tr_b16 v[232:233], v4 offset:16384
    ds_read_b64_tr_b16 v[234:235], v4 offset:17408
    s_waitcnt lgkmcnt(6)
    v_mfma_f32_16x16x32_bf16 v[128:131], v[244:247], v[56:59], v[128:131]
    s_add_u32 s22, s24, 0x2b0000
    s_add_u32 m0, s20, 0x24000
    s_nop 0
    buffer_load_dwordx4 v3, s[4:7], s22 offen lds
    ds_read_b64_tr_b16 v[236:237], v5 offset:16416
    v_mfma_f32_16x16x32_bf16 v[132:135], v[244:247], v[60:63], v[132:135]
    ds_read_b64_tr_b16 v[238:239], v5 offset:17440
    s_waitcnt lgkmcnt(6)
    v_mfma_f32_16x16x32_bf16 v[136:139], v[224:227], v[56:59], v[136:139]
    ds_read_b64_tr_b16 v[240:241], v4 offset:16640
    v_mfma_f32_16x16x32_bf16 v[140:143], v[224:227], v[60:63], v[140:143]
    s_add_u32 s22, s24, 0x2b2000
    s_add_u32 m0, s20, 0x24400
    s_nop 0
    buffer_load_dwordx4 v3, s[4:7], s22 offen lds
    ds_read_b64_tr_b16 v[242:243], v4 offset:17664
    s_waitcnt lgkmcnt(6)
    v_mfma_f32_16x16x32_bf16 v[144:147], v[228:231], v[56:59], v[144:147]
    ds_read_b64_tr_b16 v[244:245], v5 offset:16672
    v_mfma_f32_16x16x32_bf16 v[148:151], v[228:231], v[60:63], v[148:151]
    ds_read_b64_tr_b16 v[246:247], v5 offset:17696
    s_waitcnt vmcnt(15) lgkmcnt(6)
    v_mfma_f32_16x16x32_bf16 v[88:91], v[232:235], v[24:27], v[88:91]
    ds_read_b64_tr_b16 v[224:225], v4 offset:16896
    s_waitcnt vmcnt(14)
    v_mfma_f32_16x16x32_bf16 v[92:95], v[232:235], v[28:31], v[92:95]
    ds_read_b64_tr_b16 v[226:227], v4 offset:17920
    s_waitcnt lgkmcnt(6)
    v_mfma_f32_16x16x32_bf16 v[96:99], v[236:239], v[24:27], v[96:99]
    ds_read_b64_tr_b16 v[228:229], v5 offset:16928
    s_mov_b32 s23, 0xa000
    buffer_load_dwordx4 v[56:59], v6, s[8:11], s23 offen offset:3072 sc1
    v_mfma_f32_16x16x32_bf16 v[100:103], v[236:239], v[28:31], v[100:103]
    ds_read_b64_tr_b16 v[230:231], v5 offset:17952
    s_waitcnt lgkmcnt(6)
    v_mfma_f32_16x16x32_bf16 v[104:107], v[240:243], v[24:27], v[104:107]
    ds_read_b64_tr_b16 v[232:233], v4 offset:17152
    v_mfma_f32_16x16x32_bf16 v[108:111], v[240:243], v[28:31], v[108:111]
    ds_read_b64_tr_b16 v[234:235], v4 offset:18176
    s_mov_b32 s23, 0x2a000
    buffer_load_dwordx4 v[60:63], v6, s[8:11], s23 offen offset:3072 sc1
    s_mov_b32 s16, 0x544000
    buffer_load_dwordx4 v[184:187], v2, s[8:11], s16 offen sc1
    s_waitcnt lgkmcnt(6)
    v_mfma_f32_16x16x32_bf16 v[112:115], v[244:247], v[24:27], v[112:115]
    ds_read_b64_tr_b16 v[236:237], v5 offset:17184
    v_mfma_f32_16x16x32_bf16 v[116:119], v[244:247], v[28:31], v[116:119]
    ds_read_b64_tr_b16 v[238:239], v5 offset:18208
    s_waitcnt lgkmcnt(6)
    v_mfma_f32_16x16x32_bf16 v[120:123], v[224:227], v[24:27], v[120:123]
    v_mfma_f32_16x16x32_bf16 v[124:127], v[224:227], v[28:31], v[124:127]
    s_waitcnt vmcnt(15)
    s_barrier
    ds_read_b64_tr_b16 v[240:241], v4 offset:32768
    ds_read_b64_tr_b16 v[242:243], v4 offset:33792
    s_waitcnt lgkmcnt(6)
    v_mfma_f32_16x16x32_bf16 v[128:131], v[228:231], v[24:27], v[128:131]
    s_add_u32 s22, s24, 0x330000
    s_add_u32 m0, s20, 0x10000
    s_nop 0
    buffer_load_dwordx4 v3, s[4:7], s22 offen lds
    ds_read_b64_tr_b16 v[244:245], v5 offset:32800
    v_mfma_f32_16x16x32_bf16 v[132:135], v[228:231], v[28:31], v[132:135]
    ds_read_b64_tr_b16 v[246:247], v5 offset:33824
    s_waitcnt lgkmcnt(6)
    v_mfma_f32_16x16x32_bf16 v[136:139], v[232:235], v[24:27], v[136:139]
    ds_read_b64_tr_b16 v[224:225], v4 offset:33024
    v_mfma_f32_16x16x32_bf16 v[140:143], v[232:235], v[28:31], v[140:143]
    s_add_u32 s22, s24, 0x332000
    s_add_u32 m0, s20, 0x10400
    s_nop 0
    buffer_load_dwordx4 v3, s[4:7], s22 offen lds
    ds_read_b64_tr_b16 v[226:227], v4 offset:34048
    s_waitcnt lgkmcnt(6)
    v_mfma_f32_16x16x32_bf16 v[144:147], v[236:239], v[24:27], v[144:147]
    ds_read_b64_tr_b16 v[228:229], v5 offset:33056
    v_mfma_f32_16x16x32_bf16 v[148:151], v[236:239], v[28:31], v[148:151]
    ds_read_b64_tr_b16 v[230:231], v5 offset:34080
    s_waitcnt vmcnt(16) lgkmcnt(6)
    v_mfma_f32_16x16x32_bf16 v[88:91], v[240:243], v[32:35], v[88:91]
    ds_read_b64_tr_b16 v[232:233], v4 offset:33280
    s_waitcnt vmcnt(15)
    v_mfma_f32_16x16x32_bf16 v[92:95], v[240:243], v[36:39], v[92:95]
    ds_read_b64_tr_b16 v[234:235], v4 offset:34304
    s_waitcnt lgkmcnt(6)
    v_mfma_f32_16x16x32_bf16 v[96:99], v[244:247], v[32:35], v[96:99]
    ds_read_b64_tr_b16 v[236:237], v5 offset:33312
    s_mov_b32 s23, 0xc000
    buffer_load_dwordx4 v[24:27], v6, s[8:11], s23 offen offset:3072 sc1
    v_mfma_f32_16x16x32_bf16 v[100:103], v[244:247], v[36:39], v[100:103]
    ds_read_b64_tr_b16 v[238:239], v5 offset:34336
    s_waitcnt lgkmcnt(6)
    v_mfma_f32_16x16x32_bf16 v[104:107], v[224:227], v[32:35], v[104:107]
    ds_read_b64_tr_b16 v[240:241], v4 offset:33536
    v_mfma_f32_16x16x32_bf16 v[108:111], v[224:227], v[36:39], v[108:111]
    ds_read_b64_tr_b16 v[242:243], v4 offset:34560
    s_mov_b32 s23, 0x2c000
    buffer_load_dwordx4 v[28:31], v6, s[8:11], s23 offen offset:3072 sc1
    s_waitcnt vmcnt(4)
    v_xor_b32 v16, s28, v184
    v_xor_b32 v17, s28, v185
    v_xor_b32 v18, s28, v186
    v_xor_b32 v19, s28, v187
    v_or3_b32 v16, v16, v17, v18
    v_or_b32 v16, v16, v19
    v_cmp_ne_u32 vcc, 0, v16
    s_cbranch_vccnz adaLN_cond__sliding_block_cached__moe_arch_mod__prompt_kernel_mf10r
adaLN_cond__sliding_block_cached__moe_arch_mod__prompt_kernel_mf10b:
    s_waitcnt lgkmcnt(6)
    v_mfma_f32_16x16x32_bf16 v[112:115], v[228:231], v[32:35], v[112:115]
    ds_read_b64_tr_b16 v[244:245], v5 offset:33568
    v_mfma_f32_16x16x32_bf16 v[116:119], v[228:231], v[36:39], v[116:119]
    ds_read_b64_tr_b16 v[246:247], v5 offset:34592
    s_waitcnt lgkmcnt(6)
    v_mfma_f32_16x16x32_bf16 v[120:123], v[232:235], v[32:35], v[120:123]
    v_mfma_f32_16x16x32_bf16 v[124:127], v[232:235], v[36:39], v[124:127]
    s_barrier
    ds_read_b64_tr_b16 v[224:225], v4 offset:49152
    ds_read_b64_tr_b16 v[226:227], v4 offset:50176
    s_waitcnt lgkmcnt(6)
    v_mfma_f32_16x16x32_bf16 v[128:131], v[236:239], v[32:35], v[128:131]
    s_add_u32 s22, s24, 0x3b0000
    s_add_u32 m0, s20, 0x14000
    s_nop 0
    buffer_load_dwordx4 v3, s[4:7], s22 offen lds
    ds_read_b64_tr_b16 v[228:229], v5 offset:49184
    v_mfma_f32_16x16x32_bf16 v[132:135], v[236:239], v[36:39], v[132:135]
    ds_read_b64_tr_b16 v[230:231], v5 offset:50208
    s_waitcnt lgkmcnt(6)
    v_mfma_f32_16x16x32_bf16 v[136:139], v[240:243], v[32:35], v[136:139]
    ds_read_b64_tr_b16 v[232:233], v4 offset:49408
    v_mfma_f32_16x16x32_bf16 v[140:143], v[240:243], v[36:39], v[140:143]
    s_add_u32 s22, s24, 0x3b2000
    s_add_u32 m0, s20, 0x14400
    s_nop 0
    buffer_load_dwordx4 v3, s[4:7], s22 offen lds
    ds_read_b64_tr_b16 v[234:235], v4 offset:50432
    s_waitcnt lgkmcnt(6)
    v_mfma_f32_16x16x32_bf16 v[144:147], v[244:247], v[32:35], v[144:147]
    ds_read_b64_tr_b16 v[236:237], v5 offset:49440
    v_mfma_f32_16x16x32_bf16 v[148:151], v[244:247], v[36:39], v[148:151]
    ds_read_b64_tr_b16 v[238:239], v5 offset:50464
    s_waitcnt lgkmcnt(6)
    v_mfma_f32_16x16x32_bf16 v[88:91], v[224:227], v[40:43], v[88:91]
    ds_read_b64_tr_b16 v[240:241], v4 offset:49664
    v_mfma_f32_16x16x32_bf16 v[92:95], v[224:227], v[44:47], v[92:95]
    ds_read_b64_tr_b16 v[242:243], v4 offset:50688
    s_waitcnt lgkmcnt(6)
    v_mfma_f32_16x16x32_bf16 v[96:99], v[228:231], v[40:43], v[96:99]
    ds_read_b64_tr_b16 v[244:245], v5 offset:49696
    s_mov_b32 s23, 0xe000
    buffer_load_dwordx4 v[32:35], v6, s[8:11], s23 offen offset:3072 sc1
    v_mfma_f32_16x16x32_bf16 v[100:103], v[228:231], v[44:47], v[100:103]
    ds_read_b64_tr_b16 v[246:247], v5 offset:50720
    s_waitcnt lgkmcnt(6)
    v_mfma_f32_16x16x32_bf16 v[104:107], v[232:235], v[40:43], v[104:107]
    ds_read_b64_tr_b16 v[224:225], v4 offset:49920
    v_mfma_f32_16x16x32_bf16 v[108:111], v[232:235], v[44:47], v[108:111]
    ds_read_b64_tr_b16 v[226:227], v4 offset:50944
    s_mov_b32 s23, 0x2e000
    buffer_load_dwordx4 v[36:39], v6, s[8:11], s23 offen offset:3072 sc1
    v_lshrrev_b32 v16, 4, v1
    v_lshlrev_b32 v16, 3, v16
    s_lshl_b32 s16, s31, 8
    s_add_u32 s16, s16, 0x540000
    buffer_load_dwordx2 v[248:249], v16, s[8:11], s16 offen offset:0 sc1
    buffer_load_dwordx2 v[250:251], v16, s[8:11], s16 offen offset:32 sc1
    buffer_load_dwordx2 v[252:253], v16, s[8:11], s16 offen offset:64 sc1
    buffer_load_dwordx2 v[254:255], v16, s[8:11], s16 offen offset:96 sc1
    s_waitcnt lgkmcnt(6)
    v_mfma_f32_16x16x32_bf16 v[112:115], v[236:239], v[40:43], v[112:115]
    ds_read_b64_tr_b16 v[228:229], v5 offset:49952
    v_mfma_f32_16x16x32_bf16 v[116:119], v[236:239], v[44:47], v[116:119]
    ds_read_b64_tr_b16 v[230:231], v5 offset:50976
    s_waitcnt lgkmcnt(6)
    v_mfma_f32_16x16x32_bf16 v[120:123], v[240:243], v[40:43], v[120:123]
    v_mfma_f32_16x16x32_bf16 v[124:127], v[240:243], v[44:47], v[124:127]
    s_barrier
    ds_read_b64_tr_b16 v[232:233], v7 offset:0
    ds_read_b64_tr_b16 v[234:235], v7 offset:1024
    s_waitcnt lgkmcnt(6)
    v_mfma_f32_16x16x32_bf16 v[128:131], v[244:247], v[40:43], v[128:131]
    ds_read_b64_tr_b16 v[236:237], v8 offset:32
    v_mfma_f32_16x16x32_bf16 v[132:135], v[244:247], v[44:47], v[132:135]
    ds_read_b64_tr_b16 v[238:239], v8 offset:1056
    s_waitcnt lgkmcnt(6)
    v_mfma_f32_16x16x32_bf16 v[136:139], v[224:227], v[40:43], v[136:139]
    ds_read_b64_tr_b16 v[240:241], v7 offset:256
    v_mfma_f32_16x16x32_bf16 v[140:143], v[224:227], v[44:47], v[140:143]
    ds_read_b64_tr_b16 v[242:243], v7 offset:1280
    s_waitcnt lgkmcnt(6)
    v_mfma_f32_16x16x32_bf16 v[144:147], v[228:231], v[40:43], v[144:147]
    ds_read_b64_tr_b16 v[244:245], v8 offset:288
    v_mfma_f32_16x16x32_bf16 v[148:151], v[228:231], v[44:47], v[148:151]
    ds_read_b64_tr_b16 v[246:247], v8 offset:1312
    s_waitcnt lgkmcnt(6)
    v_mfma_f32_16x16x32_bf16 v[88:91], v[232:235], v[48:51], v[88:91]
    ds_read_b64_tr_b16 v[224:225], v7 offset:512
    v_mfma_f32_16x16x32_bf16 v[92:95], v[232:235], v[52:55], v[92:95]
    ds_read_b64_tr_b16 v[226:227], v7 offset:1536
    s_waitcnt lgkmcnt(6)
    v_mfma_f32_16x16x32_bf16 v[96:99], v[236:239], v[48:51], v[96:99]
    ds_read_b64_tr_b16 v[228:229], v8 offset:544
    v_mfma_f32_16x16x32_bf16 v[100:103], v[236:239], v[52:55], v[100:103]
    ds_read_b64_tr_b16 v[230:231], v8 offset:1568
    s_waitcnt lgkmcnt(6)
    v_mfma_f32_16x16x32_bf16 v[104:107], v[240:243], v[48:51], v[104:107]
    ds_read_b64_tr_b16 v[232:233], v7 offset:768
    v_mfma_f32_16x16x32_bf16 v[108:111], v[240:243], v[52:55], v[108:111]
    ds_read_b64_tr_b16 v[234:235], v7 offset:1792
    s_waitcnt lgkmcnt(6)
    v_mfma_f32_16x16x32_bf16 v[112:115], v[244:247], v[48:51], v[112:115]
    ds_read_b64_tr_b16 v[236:237], v8 offset:800
    v_mfma_f32_16x16x32_bf16 v[116:119], v[244:247], v[52:55], v[116:119]
    ds_read_b64_tr_b16 v[238:239], v8 offset:1824
    s_waitcnt lgkmcnt(6)
    v_mfma_f32_16x16x32_bf16 v[120:123], v[224:227], v[48:51], v[120:123]
    v_mfma_f32_16x16x32_bf16 v[124:127], v[224:227], v[52:55], v[124:127]
    s_barrier
    ds_read_b64_tr_b16 v[240:241], v7 offset:16384
    ds_read_b64_tr_b16 v[242:243], v7 offset:17408
    s_waitcnt lgkmcnt(6)
    v_mfma_f32_16x16x32_bf16 v[128:131], v[228:231], v[48:51], v[128:131]
    ds_read_b64_tr_b16 v[244:245], v8 offset:16416
    v_mfma_f32_16x16x32_bf16 v[132:135], v[228:231], v[52:55], v[132:135]
    ds_read_b64_tr_b16 v[246:247], v8 offset:17440
    s_waitcnt lgkmcnt(6)
    v_mfma_f32_16x16x32_bf16 v[136:139], v[232:235], v[48:51], v[136:139]
    ds_read_b64_tr_b16 v[224:225], v7 offset:16640
    v_mfma_f32_16x16x32_bf16 v[140:143], v[232:235], v[52:55], v[140:143]
    ds_read_b64_tr_b16 v[226:227], v7 offset:17664
    s_waitcnt lgkmcnt(6)
    v_mfma_f32_16x16x32_bf16 v[144:147], v[236:239], v[48:51], v[144:147]
    ds_read_b64_tr_b16 v[228:229], v8 offset:16672
    v_mfma_f32_16x16x32_bf16 v[148:151], v[236:239], v[52:55], v[148:151]
    ds_read_b64_tr_b16 v[230:231], v8 offset:17696
    s_waitcnt lgkmcnt(6)
    v_mfma_f32_16x16x32_bf16 v[88:91], v[240:243], v[56:59], v[88:91]
    ds_read_b64_tr_b16 v[232:233], v7 offset:16896
    v_mfma_f32_16x16x32_bf16 v[92:95], v[240:243], v[60:63], v[92:95]
    ds_read_b64_tr_b16 v[234:235], v7 offset:17920
    s_waitcnt lgkmcnt(6)
    v_mfma_f32_16x16x32_bf16 v[96:99], v[244:247], v[56:59], v[96:99]
    ds_read_b64_tr_b16 v[236:237], v8 offset:16928
    v_mfma_f32_16x16x32_bf16 v[100:103], v[244:247], v[60:63], v[100:103]
    ds_read_b64_tr_b16 v[238:239], v8 offset:17952
    s_waitcnt lgkmcnt(6)
    v_mfma_f32_16x16x32_bf16 v[104:107], v[224:227], v[56:59], v[104:107]
    ds_read_b64_tr_b16 v[240:241], v7 offset:17152
    v_mfma_f32_16x16x32_bf16 v[108:111], v[224:227], v[60:63], v[108:111]
    ds_read_b64_tr_b16 v[242:243], v7 offset:18176
    s_waitcnt lgkmcnt(6)
    v_mfma_f32_16x16x32_bf16 v[112:115], v[228:231], v[56:59], v[112:115]
    ds_read_b64_tr_b16 v[244:245], v8 offset:17184
    v_mfma_f32_16x16x32_bf16 v[116:119], v[228:231], v[60:63], v[116:119]
    ds_read_b64_tr_b16 v[246:247], v8 offset:18208
    s_waitcnt lgkmcnt(6)
    v_mfma_f32_16x16x32_bf16 v[120:123], v[232:235], v[56:59], v[120:123]
    v_mfma_f32_16x16x32_bf16 v[124:127], v[232:235], v[60:63], v[124:127]
    s_waitcnt vmcnt(10)
    s_barrier
    ds_read_b64_tr_b16 v[224:225], v4 offset:0
    ds_read_b64_tr_b16 v[226:227], v4 offset:1024
    s_waitcnt lgkmcnt(6)
    v_mfma_f32_16x16x32_bf16 v[128:131], v[236:239], v[56:59], v[128:131]
    ds_read_b64_tr_b16 v[228:229], v5 offset:32
    v_mfma_f32_16x16x32_bf16 v[132:135], v[236:239], v[60:63], v[132:135]
    ds_read_b64_tr_b16 v[230:231], v5 offset:1056
    s_waitcnt lgkmcnt(6)
    v_mfma_f32_16x16x32_bf16 v[136:139], v[240:243], v[56:59], v[136:139]
    ds_read_b64_tr_b16 v[232:233], v4 offset:256
    v_mfma_f32_16x16x32_bf16 v[140:143], v[240:243], v[60:63], v[140:143]
    ds_read_b64_tr_b16 v[234:235], v4 offset:1280
    s_waitcnt lgkmcnt(6)
    v_mfma_f32_16x16x32_bf16 v[144:147], v[244:247], v[56:59], v[144:147]
    ds_read_b64_tr_b16 v[236:237], v5 offset:288
    v_mfma_f32_16x16x32_bf16 v[148:151], v[244:247], v[60:63], v[148:151]
    ds_read_b64_tr_b16 v[238:239], v5 offset:1312
    s_waitcnt vmcnt(9) lgkmcnt(6)
    v_mfma_f32_16x16x32_bf16 v[88:91], v[224:227], v[24:27], v[88:91]
    ds_read_b64_tr_b16 v[240:241], v4 offset:512
    s_waitcnt vmcnt(8)
    v_mfma_f32_16x16x32_bf16 v[92:95], v[224:227], v[28:31], v[92:95]
    ds_read_b64_tr_b16 v[242:243], v4 offset:1536
    s_waitcnt lgkmcnt(6)
    v_mfma_f32_16x16x32_bf16 v[96:99], v[228:231], v[24:27], v[96:99]
    ds_read_b64_tr_b16 v[244:245], v5 offset:544
    v_mfma_f32_16x16x32_bf16 v[100:103], v[228:231], v[28:31], v[100:103]
    ds_read_b64_tr_b16 v[246:247], v5 offset:1568
    s_waitcnt lgkmcnt(6)
    v_mfma_f32_16x16x32_bf16 v[104:107], v[232:235], v[24:27], v[104:107]
    ds_read_b64_tr_b16 v[224:225], v4 offset:768
    v_mfma_f32_16x16x32_bf16 v[108:111], v[232:235], v[28:31], v[108:111]
    ds_read_b64_tr_b16 v[226:227], v4 offset:1792
    s_waitcnt lgkmcnt(6)
    v_mfma_f32_16x16x32_bf16 v[112:115], v[236:239], v[24:27], v[112:115]
    ds_read_b64_tr_b16 v[228:229], v5 offset:800
    v_mfma_f32_16x16x32_bf16 v[116:119], v[236:239], v[28:31], v[116:119]
    ds_read_b64_tr_b16 v[230:231], v5 offset:1824
    s_waitcnt lgkmcnt(6)
    v_mfma_f32_16x16x32_bf16 v[120:123], v[240:243], v[24:27], v[120:123]
    v_mfma_f32_16x16x32_bf16 v[124:127], v[240:243], v[28:31], v[124:127]
    s_waitcnt vmcnt(6)
    s_barrier
    ds_read_b64_tr_b16 v[232:233], v4 offset:16384
    ds_read_b64_tr_b16 v[234:235], v4 offset:17408
    s_waitcnt lgkmcnt(6)
    v_mfma_f32_16x16x32_bf16 v[128:131], v[244:247], v[24:27], v[128:131]
    ds_read_b64_tr_b16 v[236:237], v5 offset:16416
    v_mfma_f32_16x16x32_bf16 v[132:135], v[244:247], v[28:31], v[132:135]
    ds_read_b64_tr_b16 v[238:239], v5 offset:17440
    s_waitcnt lgkmcnt(6)
    v_mfma_f32_16x16x32_bf16 v[136:139], v[224:227], v[24:27], v[136:139]
    ds_read_b64_tr_b16 v[240:241], v4 offset:16640
    v_mfma_f32_16x16x32_bf16 v[140:143], v[224:227], v[28:31], v[140:143]
    ds_read_b64_tr_b16 v[242:243], v4 offset:17664
    s_waitcnt lgkmcnt(6)
    v_mfma_f32_16x16x32_bf16 v[144:147], v[228:231], v[24:27], v[144:147]
    ds_read_b64_tr_b16 v[244:245], v5 offset:16672
    v_mfma_f32_16x16x32_bf16 v[148:151], v[228:231], v[28:31], v[148:151]
    ds_read_b64_tr_b16 v[246:247], v5 offset:17696
    s_waitcnt vmcnt(5) lgkmcnt(6)
    v_mfma_f32_16x16x32_bf16 v[88:91], v[232:235], v[32:35], v[88:91]
    ds_read_b64_tr_b16 v[224:225], v4 offset:16896
    s_waitcnt vmcnt(4)
    v_mfma_f32_16x16x32_bf16 v[92:95], v[232:235], v[36:39], v[92:95]
    ds_read_b64_tr_b16 v[226:227], v4 offset:17920
    s_waitcnt lgkmcnt(6)
    v_mfma_f32_16x16x32_bf16 v[96:99], v[236:239], v[32:35], v[96:99]
    ds_read_b64_tr_b16 v[228:229], v5 offset:16928
    v_mfma_f32_16x16x32_bf16 v[100:103], v[236:239], v[36:39], v[100:103]
    ds_read_b64_tr_b16 v[230:231], v5 offset:17952
    s_waitcnt lgkmcnt(6)
    v_mfma_f32_16x16x32_bf16 v[104:107], v[240:243], v[32:35], v[104:107]
    ds_read_b64_tr_b16 v[232:233], v4 offset:17152
    v_mfma_f32_16x16x32_bf16 v[108:111], v[240:243], v[36:39], v[108:111]
    ds_read_b64_tr_b16 v[234:235], v4 offset:18176
    s_waitcnt lgkmcnt(6)
    v_mfma_f32_16x16x32_bf16 v[112:115], v[244:247], v[32:35], v[112:115]
    ds_read_b64_tr_b16 v[236:237], v5 offset:17184
    v_mfma_f32_16x16x32_bf16 v[116:119], v[244:247], v[36:39], v[116:119]
    ds_read_b64_tr_b16 v[238:239], v5 offset:18208
    s_waitcnt lgkmcnt(6)
    v_mfma_f32_16x16x32_bf16 v[120:123], v[224:227], v[32:35], v[120:123]
    v_mfma_f32_16x16x32_bf16 v[124:127], v[224:227], v[36:39], v[124:127]
    s_waitcnt lgkmcnt(4)
    v_mfma_f32_16x16x32_bf16 v[128:131], v[228:231], v[32:35], v[128:131]
    v_mfma_f32_16x16x32_bf16 v[132:135], v[228:231], v[36:39], v[132:135]
    s_waitcnt lgkmcnt(2)
    v_mfma_f32_16x16x32_bf16 v[136:139], v[232:235], v[32:35], v[136:139]
    v_mfma_f32_16x16x32_bf16 v[140:143], v[232:235], v[36:39], v[140:143]
    s_waitcnt lgkmcnt(0)
    v_mfma_f32_16x16x32_bf16 v[144:147], v[236:239], v[32:35], v[144:147]
    v_mfma_f32_16x16x32_bf16 v[148:151], v[236:239], v[36:39], v[148:151]
    s_lshl_b32 s16, s3, 13
    s_xor_b32 s17, s16, 0x8000
    s_add_u32 s16, s16, 0x18000
    s_add_u32 s17, s17, 0x18000
    v_add_u32 v16, s16, v2
    s_mov_b32 s16, s17
    v_add_u32 v17, s16, v2
    ds_write_b128 v16, v[120:123] offset:0
    ds_write_b128 v16, v[124:127] offset:1024
    ds_write_b128 v16, v[128:131] offset:2048
    ds_write_b128 v16, v[132:135] offset:3072
    ds_write_b128 v16, v[136:139] offset:4096
    ds_write_b128 v16, v[140:143] offset:5120
    ds_write_b128 v16, v[144:147] offset:6144
    ds_write_b128 v16, v[148:151] offset:7168
    s_waitcnt vmcnt(3)
    v_lshlrev_b32 v24, 16, v248
    v_and_b32 v25, 0xffff0000, v248
    v_lshlrev_b32 v26, 16, v249
    v_and_b32 v27, 0xffff0000, v249
    s_waitcnt vmcnt(2)
    v_lshlrev_b32 v28, 16, v250
    v_and_b32 v29, 0xffff0000, v250
    v_lshlrev_b32 v30, 16, v251
    v_and_b32 v31, 0xffff0000, v251
    s_waitcnt vmcnt(1)
    v_lshlrev_b32 v32, 16, v252
    v_and_b32 v33, 0xffff0000, v252
    v_lshlrev_b32 v34, 16, v253
    v_and_b32 v35, 0xffff0000, v253
    s_waitcnt vmcnt(0)
    v_lshlrev_b32 v36, 16, v254
    v_and_b32 v37, 0xffff0000, v254
    v_lshlrev_b32 v38, 16, v255
    v_and_b32 v39, 0xffff0000, v255
    v_and_b32 v18, 15, v1
    v_lshlrev_b32 v18, 6, v18
    v_lshrrev_b32 v19, 4, v1
    v_and_b32 v20, 1, v19
    v_lshl_add_u32 v18, v20, 5, v18
    v_lshrrev_b32 v19, 1, v19
    v_lshl_add_u32 v18, v19, 4, v18
    s_and_b32 s17, s3, 3
    s_lshl_b32 s18, s30, 2
    s_add_u32 s18, s18, s17
    s_lshl_b32 s18, s18, 16
    s_lshl_b32 s19, s15, 22
    s_add_u32 s18, s18, s19
    s_lshl_b32 s19, s31, 12
    s_add_u32 s18, s18, s19
    s_add_u32 s18, s18, 0x2000000
    s_add_u32 s19, s18, 32768
    s_waitcnt lgkmcnt(0)
    s_barrier
    ds_read_b128 v[40:43], v17 offset:0
    ds_read_b128 v[44:47], v17 offset:1024
    ds_read_b128 v[48:51], v17 offset:2048
    ds_read_b128 v[52:55], v17 offset:3072
    ds_read_b128 v[56:59], v17 offset:4096
    ds_read_b128 v[60:63], v17 offset:5120
    ds_read_b128 v[64:67], v17 offset:6144
    ds_read_b128 v[68:71], v17 offset:7168
    s_waitcnt lgkmcnt(7)
    v_pk_add_f32 v[88:89], v[88:89], v[40:41]
    v_pk_add_f32 v[90:91], v[90:91], v[42:43]
    v_pk_mul_f32 v[88:89], v[88:89], v[24:25]
    v_pk_mul_f32 v[90:91], v[90:91], v[26:27]
    v_cvt_pk_bf16_f32 v224, v88, v89
    v_cvt_pk_bf16_f32 v225, v90, v91
    s_waitcnt lgkmcnt(5)
    v_pk_add_f32 v[96:97], v[96:97], v[48:49]
    v_pk_add_f32 v[98:99], v[98:99], v[50:51]
    v_pk_mul_f32 v[96:97], v[96:97], v[28:29]
    v_pk_mul_f32 v[98:99], v[98:99], v[30:31]
    v_cvt_pk_bf16_f32 v226, v96, v97
    v_cvt_pk_bf16_f32 v227, v98, v99
    s_nop 0
    v_permlane16_swap_b32 v224, v226
    v_permlane16_swap_b32 v225, v227
    buffer_store_dwordx4 v[224:227], v18, s[8:11], s18 offen offset:0 sc1
    v_pk_add_f32 v[92:93], v[92:93], v[44:45]
    v_pk_add_f32 v[94:95], v[94:95], v[46:47]
    v_pk_mul_f32 v[92:93], v[92:93], v[24:25]
    v_pk_mul_f32 v[94:95], v[94:95], v[26:27]
    v_cvt_pk_bf16_f32 v228, v92, v93
    v_cvt_pk_bf16_f32 v229, v94, v95
    s_waitcnt lgkmcnt(4)
    v_pk_add_f32 v[100:101], v[100:101], v[52:53]
    v_pk_add_f32 v[102:103], v[102:103], v[54:55]
    v_pk_mul_f32 v[100:101], v[100:101], v[28:29]
    v_pk_mul_f32 v[102:103], v[102:103], v[30:31]
    v_cvt_pk_bf16_f32 v230, v100, v101
    v_cvt_pk_bf16_f32 v231, v102, v103
    s_nop 0
    v_permlane16_swap_b32 v228, v230
    v_permlane16_swap_b32 v229, v231
    buffer_store_dwordx4 v[228:231], v18, s[8:11], s19 offen offset:0 sc1
    s_waitcnt lgkmcnt(3)
    v_pk_add_f32 v[104:105], v[104:105], v[56:57]
    v_pk_add_f32 v[106:107], v[106:107], v[58:59]
    v_pk_mul_f32 v[104:105], v[104:105], v[32:33]
    v_pk_mul_f32 v[106:107], v[106:107], v[34:35]
    v_cvt_pk_bf16_f32 v232, v104, v105
    v_cvt_pk_bf16_f32 v233, v106, v107
    s_waitcnt lgkmcnt(1)
    v_pk_add_f32 v[112:113], v[112:113], v[64:65]
    v_pk_add_f32 v[114:115], v[114:115], v[66:67]
    v_pk_mul_f32 v[112:113], v[112:113], v[36:37]
    v_pk_mul_f32 v[114:115], v[114:115], v[38:39]
    v_cvt_pk_bf16_f32 v234, v112, v113
    v_cvt_pk_bf16_f32 v235, v114, v115
    s_nop 0
    v_permlane16_swap_b32 v232, v234
    v_permlane16_swap_b32 v233, v235
    buffer_store_dwordx4 v[232:235], v18, s[8:11], s18 offen offset:1024 sc1
    v_pk_add_f32 v[108:109], v[108:109], v[60:61]
    v_pk_add_f32 v[110:111], v[110:111], v[62:63]
    v_pk_mul_f32 v[108:109], v[108:109], v[32:33]
    v_pk_mul_f32 v[110:111], v[110:111], v[34:35]
    v_cvt_pk_bf16_f32 v236, v108, v109
    v_cvt_pk_bf16_f32 v237, v110, v111
    s_waitcnt lgkmcnt(0)
    v_pk_add_f32 v[116:117], v[116:117], v[68:69]
    v_pk_add_f32 v[118:119], v[118:119], v[70:71]
    v_pk_mul_f32 v[116:117], v[116:117], v[36:37]
    v_pk_mul_f32 v[118:119], v[118:119], v[38:39]
    v_cvt_pk_bf16_f32 v238, v116, v117
    v_cvt_pk_bf16_f32 v239, v118, v119
    s_nop 0
    v_permlane16_swap_b32 v236, v238
    v_permlane16_swap_b32 v237, v239
    buffer_store_dwordx4 v[236:239], v18, s[8:11], s19 offen offset:1024 sc1
    s_mov_b64 s[64:65], s[44:45]
    s_mov_b32 s66, 0x800
    s_mov_b32 s67, 0x20000
    s_mov_b64 s[76:77], s[32:33]
    s_mov_b32 s78, 0x400000
    s_mov_b32 s79, 0x20000
    s_mov_b64 s[68:69], s[56:57]
    s_mov_b32 s70, 0x400000
    s_mov_b32 s71, 0x20000
    s_lshl_b32 s14, s31, 1
    s_add_u32 s14, s14, s15
    s_lshl_b32 s14, s14, 3
    s_add_u32 s14, s14, s3
    s_lshl_b32 s16, s30, 7
    s_add_u32 s14, s14, s16
    s_lshl_b32 s16, s14, 11
    buffer_load_dwordx4 v[216:219], v2, s[76:79], s16 offen offset:0
    buffer_load_dwordx4 v[220:223], v2, s[76:79], s16 offen offset:1024
    s_lshl_b32 s16, s3, 10
    s_add_u32 m0, s16, 81920
    s_add_u32 s16, s16, 0x540800
    buffer_load_dwordx4 v2, s[8:11], s16 offen sc1 lds
    s_lshl_b32 s16, s30, 5
    s_lshl_b32 s17, s31, 1
    s_add_u32 s16, s16, s17
    s_add_u32 s16, s16, s15
    s_lshl_b32 s16, s16, 2
    s_add_u32 s16, s16, 0x530000
    s_cmp_eq_u32 s3, 0
    s_cselect_b32 s16, s16, 0x7ffffff0
    v_mov_b32 v16, s28
    v_mov_b32 v17, 0
    s_lshr_b32 s18, s14, 4
    s_lshl_b32 s18, s18, 15
    s_and_b32 s19, s14, 15
    s_lshl_b32 s19, s19, 6
    s_add_u32 s18, s18, s19
    s_add_u32 s18, s18, 0x2000000
    s_add_u32 s19, s18, 16384
    v_lshrrev_b32 v18, 2, v1
    v_lshlrev_b32 v18, 10, v18
    v_and_b32 v19, 3, v1
    v_lshl_add_u32 v18, v19, 4, v18
    v_add_u32 v19, 0x400000, v18
    s_lshl_b32 s25, s30, 7
    s_add_u32 s25, s25, 0x530000
    v_and_b32 v20, 15, v1
    v_lshlrev_b32 v20, 2, v20
    s_waitcnt vmcnt(3)
    s_waitcnt vmcnt(0)
    s_barrier
    s_mov_b64 exec, 1
    buffer_store_dword v16, v17, s[8:11], s16 offen sc1
    s_mov_b64 exec, -1
    v_add_u32 v16, 81920, v2
    ds_read_b128 v[184:187], v16 offset:0
    ds_read_b128 v[188:191], v16 offset:1024
    ds_read_b128 v[192:195], v16 offset:2048
    ds_read_b128 v[196:199], v16 offset:3072
    ds_read_b128 v[200:203], v16 offset:4096
    ds_read_b128 v[204:207], v16 offset:5120
    ds_read_b128 v[208:211], v16 offset:6144
    ds_read_b128 v[212:215], v16 offset:7168
    v_mov_b32 v94, 0
    v_mov_b32 v95, 0
    s_waitcnt lgkmcnt(5)
    v_lshlrev_b32 v76, 16, v192
    v_and_b32 v77, 0xffff0000, v192
    s_waitcnt lgkmcnt(1)
    v_lshlrev_b32 v78, 16, v208
    v_and_b32 v79, 0xffff0000, v208
    v_pk_mul_f32 v[60:61], v[76:77], v[78:79]
    v_lshlrev_b32 v76, 16, v184
    v_and_b32 v77, 0xffff0000, v184
    v_fmac_f32 v94, v76, v78
    v_fmac_f32 v94, v77, v79
    v_add_f32 v95, v95, v60
    v_add_f32 v95, v95, v61
    v_lshlrev_b32 v76, 16, v193
    v_and_b32 v77, 0xffff0000, v193
    v_lshlrev_b32 v78, 16, v209
    v_and_b32 v79, 0xffff0000, v209
    v_pk_mul_f32 v[62:63], v[76:77], v[78:79]
    v_lshlrev_b32 v76, 16, v185
    v_and_b32 v77, 0xffff0000, v185
    v_fmac_f32 v94, v76, v78
    v_fmac_f32 v94, v77, v79
    v_add_f32 v95, v95, v62
    v_add_f32 v95, v95, v63
    v_lshlrev_b32 v76, 16, v194
    v_and_b32 v77, 0xffff0000, v194
    v_lshlrev_b32 v78, 16, v210
    v_and_b32 v79, 0xffff0000, v210
    v_pk_mul_f32 v[64:65], v[76:77], v[78:79]
    v_lshlrev_b32 v76, 16, v186
    v_and_b32 v77, 0xffff0000, v186
    v_fmac_f32 v94, v76, v78
    v_fmac_f32 v94, v77, v79
    v_add_f32 v95, v95, v64
    v_add_f32 v95, v95, v65
    v_lshlrev_b32 v76, 16, v195
    v_and_b32 v77, 0xffff0000, v195
    v_lshlrev_b32 v78, 16, v211
    v_and_b32 v79, 0xffff0000, v211
    v_pk_mul_f32 v[66:67], v[76:77], v[78:79]
    v_lshlrev_b32 v76, 16, v187
    v_and_b32 v77, 0xffff0000, v187
    v_fmac_f32 v94, v76, v78
    v_fmac_f32 v94, v77, v79
    v_add_f32 v95, v95, v66
    v_add_f32 v95, v95, v67
    v_lshlrev_b32 v76, 16, v196
    v_and_b32 v77, 0xffff0000, v196
    s_waitcnt lgkmcnt(0)
    v_lshlrev_b32 v78, 16, v212
    v_and_b32 v79, 0xffff0000, v212
    v_pk_mul_f32 v[68:69], v[76:77], v[78:79]
    v_lshlrev_b32 v76, 16, v188
    v_and_b32 v77, 0xffff0000, v188
    v_fmac_f32 v94, v76, v78
    v_fmac_f32 v94, v77, v79
    v_add_f32 v95, v95, v68
    v_add_f32 v95, v95, v69
    v_lshlrev_b32 v76, 16, v197
    v_and_b32 v77, 0xffff0000, v197
    v_lshlrev_b32 v78, 16, v213
    v_and_b32 v79, 0xffff0000, v213
    v_pk_mul_f32 v[70:71], v[76:77], v[78:79]
    v_lshlrev_b32 v76, 16, v189
    v_and_b32 v77, 0xffff0000, v189
    v_fmac_f32 v94, v76, v78
    v_fmac_f32 v94, v77, v79
    v_add_f32 v95, v95, v70
    v_add_f32 v95, v95, v71
    v_lshlrev_b32 v76, 16, v198
    v_and_b32 v77, 0xffff0000, v198
    v_lshlrev_b32 v78, 16, v214
    v_and_b32 v79, 0xffff0000, v214
    v_pk_mul_f32 v[72:73], v[76:77], v[78:79]
    v_lshlrev_b32 v76, 16, v190
    v_and_b32 v77, 0xffff0000, v190
    v_fmac_f32 v94, v76, v78
    v_fmac_f32 v94, v77, v79
    v_add_f32 v95, v95, v72
    v_add_f32 v95, v95, v73
    v_lshlrev_b32 v76, 16, v199
    v_and_b32 v77, 0xffff0000, v199
    v_lshlrev_b32 v78, 16, v215
    v_and_b32 v79, 0xffff0000, v215
    v_pk_mul_f32 v[74:75], v[76:77], v[78:79]
    v_lshlrev_b32 v76, 16, v191
    v_and_b32 v77, 0xffff0000, v191
    v_fmac_f32 v94, v76, v78
    v_fmac_f32 v94, v77, v79
    v_add_f32 v95, v95, v74
    v_add_f32 v95, v95, v75
    v_add_f32_dpp v94, v94, v94 row_ror:1 row_mask:0xf bank_mask:0xf
    s_nop 0
    v_add_f32_dpp v95, v95, v95 row_ror:1 row_mask:0xf bank_mask:0xf
    v_add_f32_dpp v94, v94, v94 row_ror:2 row_mask:0xf bank_mask:0xf
    s_nop 0
    v_add_f32_dpp v95, v95, v95 row_ror:2 row_mask:0xf bank_mask:0xf
    v_add_f32_dpp v94, v94, v94 row_ror:4 row_mask:0xf bank_mask:0xf
    s_nop 0
    v_add_f32_dpp v95, v95, v95 row_ror:4 row_mask:0xf bank_mask:0xf
    v_add_f32_dpp v94, v94, v94 row_ror:8 row_mask:0xf bank_mask:0xf
    s_nop 0
    v_add_f32_dpp v95, v95, v95 row_ror:8 row_mask:0xf bank_mask:0xf
    v_mov_b32 v76, v94
    s_nop 1
    v_permlane16_swap_b32 v94, v76
    v_add_f32 v94, v94, v76
    v_mov_b32 v77, v95
    s_nop 1
    v_permlane16_swap_b32 v95, v77
    v_add_f32 v95, v95, v77
    v_mov_b32 v76, v94
    s_nop 1
    v_permlane32_swap_b32 v94, v76
    v_add_f32 v94, v94, v76
    v_mov_b32 v77, v95
    s_nop 1
    v_permlane32_swap_b32 v95, v77
    v_add_f32 v95, v95, v77
    v_lshlrev_b32 v28, 16, v216
    v_and_b32 v29, 0xffff0000, v216
    v_lshlrev_b32 v30, 16, v217
    v_and_b32 v31, 0xffff0000, v217
    v_lshlrev_b32 v32, 16, v218
    v_and_b32 v33, 0xffff0000, v218
    v_lshlrev_b32 v34, 16, v219
    v_and_b32 v35, 0xffff0000, v219
    v_lshlrev_b32 v36, 16, v220
    v_and_b32 v37, 0xffff0000, v220
    v_lshlrev_b32 v38, 16, v221
    v_and_b32 v39, 0xffff0000, v221
    v_lshlrev_b32 v40, 16, v222
    v_and_b32 v41, 0xffff0000, v222
    v_lshlrev_b32 v42, 16, v223
    v_and_b32 v43, 0xffff0000, v223
    s_mov_b32 s27, 0
adaLN_cond__sliding_block_cached__moe_arch_mod__prompt_kernel_a11p:
    buffer_load_dword v76, v20, s[8:11], s25 offen sc1
    s_waitcnt vmcnt(0)
    v_cmp_ne_u32 vcc, s28, v76
    s_add_u32 s27, s27, 1
    s_cmp_ge_u32 s27, 65536
    s_cbranch_scc1 adaLN_cond__sliding_block_cached__moe_arch_mod__prompt_kernel_a11g
    s_cbranch_vccnz adaLN_cond__sliding_block_cached__moe_arch_mod__prompt_kernel_a11p
adaLN_cond__sliding_block_cached__moe_arch_mod__prompt_kernel_a11g:
    buffer_load_dwordx4 v[44:47], v18, s[8:11], s18 offen sc1
    buffer_load_dwordx4 v[52:55], v19, s[8:11], s18 offen sc1
    buffer_load_dwordx4 v[48:51], v18, s[8:11], s19 offen sc1
    buffer_load_dwordx4 v[56:59], v19, s[8:11], s19 offen sc1
    v_lshlrev_b32 v21, 2, v0
    s_mov_b32 s16, 0x540800
    buffer_load_dword v106, v21, s[8:11], s16 offen sc1
    buffer_load_dword v104, v21, s[8:11], s16 offen offset:2048 sc1
    s_waitcnt vmcnt(5)
    v_lshlrev_b32 v76, 16, v44
    v_and_b32 v77, 0xffff0000, v44
    s_waitcnt vmcnt(4)
    v_lshlrev_b32 v78, 16, v52
    v_and_b32 v79, 0xffff0000, v52
    v_pk_add_f32 v[76:77], v[76:77], v[78:79]
    v_pk_add_f32 v[28:29], v[28:29], v[76:77]
    v_cvt_pk_bf16_f32 v16, v28, v29
    v_lshlrev_b32 v28, 16, v16
    v_and_b32 v29, 0xffff0000, v16
    v_lshlrev_b32 v80, 16, v45
    v_and_b32 v81, 0xffff0000, v45
    v_lshlrev_b32 v82, 16, v53
    v_and_b32 v83, 0xffff0000, v53
    v_pk_add_f32 v[80:81], v[80:81], v[82:83]
    v_pk_add_f32 v[30:31], v[30:31], v[80:81]
    v_cvt_pk_bf16_f32 v17, v30, v31
    v_lshlrev_b32 v30, 16, v17
    v_and_b32 v31, 0xffff0000, v17
    v_lshlrev_b32 v76, 16, v46
    v_and_b32 v77, 0xffff0000, v46
    v_lshlrev_b32 v78, 16, v54
    v_and_b32 v79, 0xffff0000, v54
    v_pk_add_f32 v[76:77], v[76:77], v[78:79]
    v_pk_add_f32 v[32:33], v[32:33], v[76:77]
    v_cvt_pk_bf16_f32 v16, v32, v33
    v_lshlrev_b32 v32, 16, v16
    v_and_b32 v33, 0xffff0000, v16
    v_lshlrev_b32 v80, 16, v47
    v_and_b32 v81, 0xffff0000, v47
    v_lshlrev_b32 v82, 16, v55
    v_and_b32 v83, 0xffff0000, v55
    v_pk_add_f32 v[80:81], v[80:81], v[82:83]
    v_pk_add_f32 v[34:35], v[34:35], v[80:81]
    v_cvt_pk_bf16_f32 v17, v34, v35
    v_lshlrev_b32 v34, 16, v17
    v_and_b32 v35, 0xffff0000, v17
    s_waitcnt vmcnt(3)
    v_lshlrev_b32 v76, 16, v48
    v_and_b32 v77, 0xffff0000, v48
    s_waitcnt vmcnt(2)
    v_lshlrev_b32 v78, 16, v56
    v_and_b32 v79, 0xffff0000, v56
    v_pk_add_f32 v[76:77], v[76:77], v[78:79]
    v_pk_add_f32 v[36:37], v[36:37], v[76:77]
    v_cvt_pk_bf16_f32 v16, v36, v37
    v_lshlrev_b32 v36, 16, v16
    v_and_b32 v37, 0xffff0000, v16
    v_lshlrev_b32 v80, 16, v49
    v_and_b32 v81, 0xffff0000, v49
    v_lshlrev_b32 v82, 16, v57
    v_and_b32 v83, 0xffff0000, v57
    v_pk_add_f32 v[80:81], v[80:81], v[82:83]
    v_pk_add_f32 v[38:39], v[38:39], v[80:81]
    v_cvt_pk_bf16_f32 v17, v38, v39
    v_lshlrev_b32 v38, 16, v17
    v_and_b32 v39, 0xffff0000, v17
    v_lshlrev_b32 v76, 16, v50
    v_and_b32 v77, 0xffff0000, v50
    v_lshlrev_b32 v78, 16, v58
    v_and_b32 v79, 0xffff0000, v58
    v_pk_add_f32 v[76:77], v[76:77], v[78:79]
    v_pk_add_f32 v[40:41], v[40:41], v[76:77]
    v_cvt_pk_bf16_f32 v16, v40, v41
    v_lshlrev_b32 v40, 16, v16
    v_and_b32 v41, 0xffff0000, v16
    v_lshlrev_b32 v80, 16, v51
    v_and_b32 v81, 0xffff0000, v51
    v_lshlrev_b32 v82, 16, v59
    v_and_b32 v83, 0xffff0000, v59
    v_pk_add_f32 v[80:81], v[80:81], v[82:83]
    v_pk_add_f32 v[42:43], v[42:43], v[80:81]
    v_cvt_pk_bf16_f32 v17, v42, v43
    v_lshlrev_b32 v42, 16, v17
    v_and_b32 v43, 0xffff0000, v17
    v_pk_add_f32 v[76:77], v[28:29], v[30:31]
    v_pk_mul_f32 v[78:79], v[28:29], v[28:29]
    v_pk_mul_f32 v[80:81], v[28:29], v[60:61]
    v_pk_fma_f32 v[78:79], v[30:31], v[30:31], v[78:79]
    v_pk_fma_f32 v[80:81], v[30:31], v[62:63], v[80:81]
    v_pk_add_f32 v[76:77], v[76:77], v[32:33]
    v_pk_fma_f32 v[78:79], v[32:33], v[32:33], v[78:79]
    v_pk_fma_f32 v[80:81], v[32:33], v[64:65], v[80:81]
    v_pk_add_f32 v[76:77], v[76:77], v[34:35]
    v_pk_fma_f32 v[78:79], v[34:35], v[34:35], v[78:79]
    v_pk_fma_f32 v[80:81], v[34:35], v[66:67], v[80:81]
    v_pk_add_f32 v[76:77], v[76:77], v[36:37]
    v_pk_fma_f32 v[78:79], v[36:37], v[36:37], v[78:79]
    v_pk_fma_f32 v[80:81], v[36:37], v[68:69], v[80:81]
    v_pk_add_f32 v[76:77], v[76:77], v[38:39]
    v_pk_fma_f32 v[78:79], v[38:39], v[38:39], v[78:79]
    v_pk_fma_f32 v[80:81], v[38:39], v[70:71], v[80:81]
    v_pk_add_f32 v[76:77], v[76:77], v[40:41]
    v_pk_fma_f32 v[78:79], v[40:41], v[40:41], v[78:79]
    v_pk_fma_f32 v[80:81], v[40:41], v[72:73], v[80:81]
    v_pk_add_f32 v[76:77], v[76:77], v[42:43]
    v_pk_fma_f32 v[78:79], v[42:43], v[42:43], v[78:79]
    v_pk_fma_f32 v[80:81], v[42:43], v[74:75], v[80:81]
    v_add_f32 v96, v76, v77
    v_add_f32 v97, v78, v79
    v_add_f32 v98, v80, v81
    v_add_f32_dpp v96, v96, v96 row_ror:1 row_mask:0xf bank_mask:0xf
    v_add_f32_dpp v97, v97, v97 row_ror:1 row_mask:0xf bank_mask:0xf
    v_add_f32_dpp v98, v98, v98 row_ror:1 row_mask:0xf bank_mask:0xf
    v_add_f32_dpp v96, v96, v96 row_ror:2 row_mask:0xf bank_mask:0xf
    v_add_f32_dpp v97, v97, v97 row_ror:2 row_mask:0xf bank_mask:0xf
    v_add_f32_dpp v98, v98, v98 row_ror:2 row_mask:0xf bank_mask:0xf
    v_add_f32_dpp v96, v96, v96 row_ror:4 row_mask:0xf bank_mask:0xf
    v_add_f32_dpp v97, v97, v97 row_ror:4 row_mask:0xf bank_mask:0xf
    v_add_f32_dpp v98, v98, v98 row_ror:4 row_mask:0xf bank_mask:0xf
    v_add_f32_dpp v96, v96, v96 row_ror:8 row_mask:0xf bank_mask:0xf
    v_add_f32_dpp v97, v97, v97 row_ror:8 row_mask:0xf bank_mask:0xf
    v_add_f32_dpp v98, v98, v98 row_ror:8 row_mask:0xf bank_mask:0xf
    v_mov_b32 v76, v96
    s_nop 1
    v_permlane16_swap_b32 v96, v76
    v_add_f32 v96, v96, v76
    v_mov_b32 v77, v97
    s_nop 1
    v_permlane16_swap_b32 v97, v77
    v_add_f32 v97, v97, v77
    v_mov_b32 v78, v98
    s_nop 1
    v_permlane16_swap_b32 v98, v78
    v_add_f32 v98, v98, v78
    v_mov_b32 v76, v96
    s_nop 1
    v_permlane32_swap_b32 v96, v76
    v_add_f32 v96, v96, v76
    v_mov_b32 v77, v97
    s_nop 1
    v_permlane32_swap_b32 v97, v77
    v_add_f32 v97, v97, v77
    v_mov_b32 v78, v98
    s_nop 1
    v_permlane32_swap_b32 v98, v78
    v_add_f32 v98, v98, v78
    v_mul_f32 v96, 0x3a800000, v96
    v_mul_f32 v97, 0x3a800000, v97
    v_fma_f32 v97, -v96, v96, v97
    v_max_f32 v97, 0, v97
    v_fma_f32 v98, -v96, v95, v98
    v_add_f32 v76, 0x3727c5ac, v97
    v_rsq_f32 v76, v76
    s_nop 0
    v_fma_f32 v27, v98, v76, v94
    v_cvt_pk_bf16_f32 v96, v96, v96
    v_lshlrev_b32 v96, 16, v96
    v_cvt_pk_bf16_f32 v97, v97, v97
    v_lshlrev_b32 v97, 16, v97
    v_add_f32 v97, 0x3727c5ac, v97
    v_cvt_pk_bf16_f32 v97, v97, v97
    v_lshlrev_b32 v97, 16, v97
    v_sqrt_f32 v98, v97
    s_nop 0
    v_cvt_pk_bf16_f32 v98, v98, v98
    v_lshlrev_b32 v98, 16, v98
    v_rcp_f32 v99, v98
    v_mov_b32 v25, v96
    v_mov_b32 v26, v98
    v_ashrrev_i32 v16, 31, v27
    v_or_b32 v16, 0x80000000, v16
    v_xor_b32 v24, v27, v16
    v_and_b32 v24, 0xfffff800, v24
    v_max_u32 v24, 0x800, v24
    s_sub_u32 s16, 2047, s14
    v_or_b32 v24, s16, v24
    s_lshl_b32 s16, s3, 4
    s_add_u32 s16, s16, 65536
    v_mov_b32 v16, s16
    ds_write_b128 v16, v[24:27]
    s_waitcnt lgkmcnt(0)
    s_barrier
    v_and_b32 v16, 7, v1
    v_lshlrev_b32 v16, 4, v16
    v_add_u32 v16, 65536, v16
    ds_read_b32 v76, v16
    s_waitcnt lgkmcnt(0)
    v_mov_b32 v77, v76
    s_nop 1
    v_max_u32_dpp v77, v77, v77 row_ror:1 row_mask:0xf bank_mask:0xf
    s_nop 1
    v_max_u32_dpp v77, v77, v77 row_ror:2 row_mask:0xf bank_mask:0xf
    s_nop 1
    v_max_u32_dpp v77, v77, v77 row_ror:4 row_mask:0xf bank_mask:0xf
    v_cmp_eq_u32 vcc, v76, v77
    s_ff1_i32_b64 s16, vcc
    s_lshl_b32 s16, s16, 4
    s_add_u32 s16, s16, 65536
    v_mov_b32 v16, s16
    ds_read_b128 v[24:27], v16
    s_lshl_b32 s16, s2, 4
    s_add_u32 s16, s16, 0x6e0000
    s_cmp_eq_u32 s3, 0
    s_cselect_b32 s16, s16, 0x7ffffff0
    v_mov_b32 v17, 0
    s_mov_b64 exec, 1
    s_waitcnt lgkmcnt(0)
    buffer_store_dwordx4 v[24:27], v17, s[8:11], s16 offen sc1
    s_mov_b64 exec, -1
    v_sub_f32 v44, v28, v96
    v_sub_f32 v45, v29, v96
    v_sub_f32 v46, v30, v96
    v_sub_f32 v47, v31, v96
    v_sub_f32 v48, v32, v96
    v_sub_f32 v49, v33, v96
    v_sub_f32 v50, v34, v96
    v_sub_f32 v51, v35, v96
    v_cvt_pk_bf16_f32 v16, v44, v45
    v_lshlrev_b32 v44, 16, v16
    v_and_b32 v45, 0xffff0000, v16
    v_cvt_pk_bf16_f32 v16, v46, v47
    v_lshlrev_b32 v46, 16, v16
    v_and_b32 v47, 0xffff0000, v16
    v_cvt_pk_bf16_f32 v16, v48, v49
    v_lshlrev_b32 v48, 16, v16
    v_and_b32 v49, 0xffff0000, v16
    v_cvt_pk_bf16_f32 v16, v50, v51
    v_lshlrev_b32 v50, 16, v16
    v_and_b32 v51, 0xffff0000, v16
    v_mul_f32 v52, v44, v99
    v_mul_f32 v53, v45, v99
    v_mul_f32 v54, v46, v99
    v_mul_f32 v55, v47, v99
    v_mul_f32 v56, v48, v99
    v_mul_f32 v57, v49, v99
    v_mul_f32 v58, v50, v99
    v_mul_f32 v59, v51, v99
    v_fma_f32 v44, -v52, v98, v44
    v_fma_f32 v45, -v53, v98, v45
    v_fma_f32 v46, -v54, v98, v46
    v_fma_f32 v47, -v55, v98, v47
    v_fma_f32 v48, -v56, v98, v48
    v_fma_f32 v49, -v57, v98, v49
    v_fma_f32 v50, -v58, v98, v50
    v_fma_f32 v51, -v59, v98, v51
    v_fma_f32 v44, v44, v99, v52
    v_fma_f32 v45, v45, v99, v53
    v_fma_f32 v46, v46, v99, v54
    v_fma_f32 v47, v47, v99, v55
    v_fma_f32 v48, v48, v99, v56
    v_fma_f32 v49, v49, v99, v57
    v_fma_f32 v50, v50, v99, v58
    v_fma_f32 v51, v51, v99, v59
    v_cvt_pk_bf16_f32 v16, v44, v45
    v_lshlrev_b32 v44, 16, v16
    v_and_b32 v45, 0xffff0000, v16
    v_cvt_pk_bf16_f32 v16, v46, v47
    v_lshlrev_b32 v46, 16, v16
    v_and_b32 v47, 0xffff0000, v16
    v_cvt_pk_bf16_f32 v16, v48, v49
    v_lshlrev_b32 v48, 16, v16
    v_and_b32 v49, 0xffff0000, v16
    v_cvt_pk_bf16_f32 v16, v50, v51
    v_lshlrev_b32 v50, 16, v16
    v_and_b32 v51, 0xffff0000, v16
    v_lshlrev_b32 v52, 16, v192
    v_and_b32 v53, 0xffff0000, v192
    v_lshlrev_b32 v54, 16, v193
    v_and_b32 v55, 0xffff0000, v193
    v_lshlrev_b32 v56, 16, v194
    v_and_b32 v57, 0xffff0000, v194
    v_lshlrev_b32 v58, 16, v195
    v_and_b32 v59, 0xffff0000, v195
    v_pk_mul_f32 v[44:45], v[44:45], v[52:53]
    v_pk_mul_f32 v[46:47], v[46:47], v[54:55]
    v_pk_mul_f32 v[48:49], v[48:49], v[56:57]
    v_pk_mul_f32 v[50:51], v[50:51], v[58:59]
    v_cvt_pk_bf16_f32 v16, v44, v45
    v_lshlrev_b32 v44, 16, v16
    v_and_b32 v45, 0xffff0000, v16
    v_cvt_pk_bf16_f32 v16, v46, v47
    v_lshlrev_b32 v46, 16, v16
    v_and_b32 v47, 0xffff0000, v16
    v_cvt_pk_bf16_f32 v16, v48, v49
    v_lshlrev_b32 v48, 16, v16
    v_and_b32 v49, 0xffff0000, v16
    v_cvt_pk_bf16_f32 v16, v50, v51
    v_lshlrev_b32 v50, 16, v16
    v_and_b32 v51, 0xffff0000, v16
    v_lshlrev_b32 v52, 16, v184
    v_and_b32 v53, 0xffff0000, v184
    v_lshlrev_b32 v54, 16, v185
    v_and_b32 v55, 0xffff0000, v185
    v_lshlrev_b32 v56, 16, v186
    v_and_b32 v57, 0xffff0000, v186
    v_lshlrev_b32 v58, 16, v187
    v_and_b32 v59, 0xffff0000, v187
    v_pk_add_f32 v[44:45], v[44:45], v[52:53]
    v_pk_add_f32 v[46:47], v[46:47], v[54:55]
    v_pk_add_f32 v[48:49], v[48:49], v[56:57]
    v_pk_add_f32 v[50:51], v[50:51], v[58:59]
    v_cvt_pk_bf16_f32 v16, v44, v45
    v_lshlrev_b32 v44, 16, v16
    v_and_b32 v45, 0xffff0000, v16
    v_cvt_pk_bf16_f32 v16, v46, v47
    v_lshlrev_b32 v46, 16, v16
    v_and_b32 v47, 0xffff0000, v16
    v_cvt_pk_bf16_f32 v16, v48, v49
    v_lshlrev_b32 v48, 16, v16
    v_and_b32 v49, 0xffff0000, v16
    v_cvt_pk_bf16_f32 v16, v50, v51
    v_lshlrev_b32 v50, 16, v16
    v_and_b32 v51, 0xffff0000, v16
    v_lshlrev_b32 v52, 16, v200
    v_and_b32 v53, 0xffff0000, v200
    v_lshlrev_b32 v54, 16, v201
    v_and_b32 v55, 0xffff0000, v201
    v_lshlrev_b32 v56, 16, v202
    v_and_b32 v57, 0xffff0000, v202
    v_lshlrev_b32 v58, 16, v203
    v_and_b32 v59, 0xffff0000, v203
    v_pk_mul_f32 v[44:45], v[44:45], v[52:53]
    v_pk_mul_f32 v[46:47], v[46:47], v[54:55]
    v_pk_mul_f32 v[48:49], v[48:49], v[56:57]
    v_pk_mul_f32 v[50:51], v[50:51], v[58:59]
    v_cvt_pk_bf16_f32 v16, v44, v45
    v_lshlrev_b32 v44, 16, v16
    v_and_b32 v45, 0xffff0000, v16
    v_cvt_pk_bf16_f32 v16, v46, v47
    v_lshlrev_b32 v46, 16, v16
    v_and_b32 v47, 0xffff0000, v16
    v_cvt_pk_bf16_f32 v16, v48, v49
    v_lshlrev_b32 v48, 16, v16
    v_and_b32 v49, 0xffff0000, v16
    v_cvt_pk_bf16_f32 v16, v50, v51
    v_lshlrev_b32 v50, 16, v16
    v_and_b32 v51, 0xffff0000, v16
    v_pk_add_f32 v[44:45], v[44:45], v[28:29]
    v_pk_add_f32 v[46:47], v[46:47], v[30:31]
    v_pk_add_f32 v[48:49], v[48:49], v[32:33]
    v_pk_add_f32 v[50:51], v[50:51], v[34:35]
    v_cvt_pk_bf16_f32 v28, v44, v45
    v_cvt_pk_bf16_f32 v29, v46, v47
    v_cvt_pk_bf16_f32 v30, v48, v49
    v_cvt_pk_bf16_f32 v31, v50, v51
    v_sub_f32 v44, v36, v96
    v_sub_f32 v45, v37, v96
    v_sub_f32 v46, v38, v96
    v_sub_f32 v47, v39, v96
    v_sub_f32 v48, v40, v96
    v_sub_f32 v49, v41, v96
    v_sub_f32 v50, v42, v96
    v_sub_f32 v51, v43, v96
    v_cvt_pk_bf16_f32 v16, v44, v45
    v_lshlrev_b32 v44, 16, v16
    v_and_b32 v45, 0xffff0000, v16
    v_cvt_pk_bf16_f32 v16, v46, v47
    v_lshlrev_b32 v46, 16, v16
    v_and_b32 v47, 0xffff0000, v16
    v_cvt_pk_bf16_f32 v16, v48, v49
    v_lshlrev_b32 v48, 16, v16
    v_and_b32 v49, 0xffff0000, v16
    v_cvt_pk_bf16_f32 v16, v50, v51
    v_lshlrev_b32 v50, 16, v16
    v_and_b32 v51, 0xffff0000, v16
    v_mul_f32 v52, v44, v99
    v_mul_f32 v53, v45, v99
    v_mul_f32 v54, v46, v99
    v_mul_f32 v55, v47, v99
    v_mul_f32 v56, v48, v99
    v_mul_f32 v57, v49, v99
    v_mul_f32 v58, v50, v99
    v_mul_f32 v59, v51, v99
    v_fma_f32 v44, -v52, v98, v44
    v_fma_f32 v45, -v53, v98, v45
    v_fma_f32 v46, -v54, v98, v46
    v_fma_f32 v47, -v55, v98, v47
    v_fma_f32 v48, -v56, v98, v48
    v_fma_f32 v49, -v57, v98, v49
    v_fma_f32 v50, -v58, v98, v50
    v_fma_f32 v51, -v59, v98, v51
    v_fma_f32 v44, v44, v99, v52
    v_fma_f32 v45, v45, v99, v53
    v_fma_f32 v46, v46, v99, v54
    v_fma_f32 v47, v47, v99, v55
    v_fma_f32 v48, v48, v99, v56
    v_fma_f32 v49, v49, v99, v57
    v_fma_f32 v50, v50, v99, v58
    v_fma_f32 v51, v51, v99, v59
    v_cvt_pk_bf16_f32 v16, v44, v45
    v_lshlrev_b32 v44, 16, v16
    v_and_b32 v45, 0xffff0000, v16
    v_cvt_pk_bf16_f32 v16, v46, v47
    v_lshlrev_b32 v46, 16, v16
    v_and_b32 v47, 0xffff0000, v16
    v_cvt_pk_bf16_f32 v16, v48, v49
    v_lshlrev_b32 v48, 16, v16
    v_and_b32 v49, 0xffff0000, v16
    v_cvt_pk_bf16_f32 v16, v50, v51
    v_lshlrev_b32 v50, 16, v16
    v_and_b32 v51, 0xffff0000, v16
    v_lshlrev_b32 v52, 16, v196
    v_and_b32 v53, 0xffff0000, v196
    v_lshlrev_b32 v54, 16, v197
    v_and_b32 v55, 0xffff0000, v197
    v_lshlrev_b32 v56, 16, v198
    v_and_b32 v57, 0xffff0000, v198
    v_lshlrev_b32 v58, 16, v199
    v_and_b32 v59, 0xffff0000, v199
    v_pk_mul_f32 v[44:45], v[44:45], v[52:53]
    v_pk_mul_f32 v[46:47], v[46:47], v[54:55]
    v_pk_mul_f32 v[48:49], v[48:49], v[56:57]
    v_pk_mul_f32 v[50:51], v[50:51], v[58:59]
    v_cvt_pk_bf16_f32 v16, v44, v45
    v_lshlrev_b32 v44, 16, v16
    v_and_b32 v45, 0xffff0000, v16
    v_cvt_pk_bf16_f32 v16, v46, v47
    v_lshlrev_b32 v46, 16, v16
    v_and_b32 v47, 0xffff0000, v16
    v_cvt_pk_bf16_f32 v16, v48, v49
    v_lshlrev_b32 v48, 16, v16
    v_and_b32 v49, 0xffff0000, v16
    v_cvt_pk_bf16_f32 v16, v50, v51
    v_lshlrev_b32 v50, 16, v16
    v_and_b32 v51, 0xffff0000, v16
    v_lshlrev_b32 v52, 16, v188
    v_and_b32 v53, 0xffff0000, v188
    v_lshlrev_b32 v54, 16, v189
    v_and_b32 v55, 0xffff0000, v189
    v_lshlrev_b32 v56, 16, v190
    v_and_b32 v57, 0xffff0000, v190
    v_lshlrev_b32 v58, 16, v191
    v_and_b32 v59, 0xffff0000, v191
    v_pk_add_f32 v[44:45], v[44:45], v[52:53]
    v_pk_add_f32 v[46:47], v[46:47], v[54:55]
    v_pk_add_f32 v[48:49], v[48:49], v[56:57]
    v_pk_add_f32 v[50:51], v[50:51], v[58:59]
    v_cvt_pk_bf16_f32 v16, v44, v45
    v_lshlrev_b32 v44, 16, v16
    v_and_b32 v45, 0xffff0000, v16
    v_cvt_pk_bf16_f32 v16, v46, v47
    v_lshlrev_b32 v46, 16, v16
    v_and_b32 v47, 0xffff0000, v16
    v_cvt_pk_bf16_f32 v16, v48, v49
    v_lshlrev_b32 v48, 16, v16
    v_and_b32 v49, 0xffff0000, v16
    v_cvt_pk_bf16_f32 v16, v50, v51
    v_lshlrev_b32 v50, 16, v16
    v_and_b32 v51, 0xffff0000, v16
    v_lshlrev_b32 v52, 16, v204
    v_and_b32 v53, 0xffff0000, v204
    v_lshlrev_b32 v54, 16, v205
    v_and_b32 v55, 0xffff0000, v205
    v_lshlrev_b32 v56, 16, v206
    v_and_b32 v57, 0xffff0000, v206
    v_lshlrev_b32 v58, 16, v207
    v_and_b32 v59, 0xffff0000, v207
    v_pk_mul_f32 v[44:45], v[44:45], v[52:53]
    v_pk_mul_f32 v[46:47], v[46:47], v[54:55]
    v_pk_mul_f32 v[48:49], v[48:49], v[56:57]
    v_pk_mul_f32 v[50:51], v[50:51], v[58:59]
    v_cvt_pk_bf16_f32 v16, v44, v45
    v_lshlrev_b32 v44, 16, v16
    v_and_b32 v45, 0xffff0000, v16
    v_cvt_pk_bf16_f32 v16, v46, v47
    v_lshlrev_b32 v46, 16, v16
    v_and_b32 v47, 0xffff0000, v16
    v_cvt_pk_bf16_f32 v16, v48, v49
    v_lshlrev_b32 v48, 16, v16
    v_and_b32 v49, 0xffff0000, v16
    v_cvt_pk_bf16_f32 v16, v50, v51
    v_lshlrev_b32 v50, 16, v16
    v_and_b32 v51, 0xffff0000, v16
    v_pk_add_f32 v[44:45], v[44:45], v[36:37]
    v_pk_add_f32 v[46:47], v[46:47], v[38:39]
    v_pk_add_f32 v[48:49], v[48:49], v[40:41]
    v_pk_add_f32 v[50:51], v[50:51], v[42:43]
    v_cvt_pk_bf16_f32 v36, v44, v45
    v_cvt_pk_bf16_f32 v37, v46, v47
    v_cvt_pk_bf16_f32 v38, v48, v49
    v_cvt_pk_bf16_f32 v39, v50, v51
    v_lshlrev_b32 v18, 4, v0
    s_mov_b32 s16, 0x6e0000
    s_mov_b32 s27, 0
adaLN_cond__sliding_block_cached__moe_arch_mod__prompt_kernel_w12p:
    buffer_load_dwordx4 v[24:27], v18, s[8:11], s16 offen sc1
    s_waitcnt vmcnt(0)
    v_cmp_eq_u32 vcc, 0, v24
    s_add_u32 s27, s27, 1
    s_cmp_ge_u32 s27, 65536
    s_cbranch_scc1 adaLN_cond__sliding_block_cached__moe_arch_mod__prompt_kernel_w12g
    s_cbranch_vccnz adaLN_cond__sliding_block_cached__moe_arch_mod__prompt_kernel_w12p
adaLN_cond__sliding_block_cached__moe_arch_mod__prompt_kernel_w12g:
    v_mov_b32 v76, v24
    s_nop 1
    v_max_u32_dpp v76, v76, v76 row_ror:1 row_mask:0xf bank_mask:0xf
    s_nop 1
    v_max_u32_dpp v76, v76, v76 row_ror:2 row_mask:0xf bank_mask:0xf
    s_nop 1
    v_max_u32_dpp v76, v76, v76 row_ror:4 row_mask:0xf bank_mask:0xf
    s_nop 1
    v_max_u32_dpp v76, v76, v76 row_ror:8 row_mask:0xf bank_mask:0xf
    v_mov_b32 v77, v76
    s_nop 1
    v_permlane16_swap_b32 v76, v77
    v_max_u32 v76, v76, v77
    v_mov_b32 v77, v76
    s_nop 1
    v_permlane32_swap_b32 v76, v77
    v_max_u32 v76, v76, v77
    v_cmp_eq_u32 vcc, v76, v24
    s_lshl_b32 s16, s3, 4
    s_add_u32 s16, s16, 65792
    v_mov_b32 v16, s16
    s_and_saveexec_b64 s[62:63], vcc
    ds_write_b128 v16, v[24:27]
    s_mov_b64 exec, s[62:63]
    s_waitcnt lgkmcnt(0)
    s_barrier
    v_and_b32 v16, 3, v1
    v_lshlrev_b32 v16, 4, v16
    v_add_u32 v16, 65792, v16
    ds_read_b32 v76, v16
    s_waitcnt lgkmcnt(0)
    v_mov_b32 v77, v76
    s_nop 1
    v_max_u32_dpp v77, v77, v77 row_ror:1 row_mask:0xf bank_mask:0xf
    s_nop 1
    v_max_u32_dpp v77, v77, v77 row_ror:2 row_mask:0xf bank_mask:0xf
    v_cmp_eq_u32 vcc, v76, v77
    s_ff1_i32_b64 s16, vcc
    s_lshl_b32 s16, s16, 4
    s_add_u32 s16, s16, 65792
    v_mov_b32 v16, s16
    ds_read_b128 v[24:27], v16
    s_waitcnt lgkmcnt(0)
    v_and_b32 v76, 0x7ff, v24
    v_sub_u32 v76, 2047, v76
    s_nop 0
    v_readfirstlane_b32 s12, v76
    v_rcp_f32 v103, v26
    s_lshr_b32 s18, s12, 4
    s_lshl_b32 s18, s18, 15
    s_and_b32 s19, s12, 15
    s_lshl_b32 s19, s19, 6
    s_add_u32 s18, s18, s19
    s_add_u32 s18, s18, 0x2000000
    s_add_u32 s19, s18, 0x400000
    v_lshrrev_b32 v18, 4, v0
    v_lshlrev_b32 v18, 10, v18
    v_and_b32 v19, 15, v0
    v_lshl_add_u32 v18, v19, 2, v18
    s_lshl_b32 s13, s12, 11
    buffer_load_dword v100, v18, s[8:11], s18 offen sc1
    buffer_load_dword v101, v18, s[8:11], s19 offen sc1
    buffer_load_dword v102, v21, s[76:79], s13 offen
    s_lshl_b32 s16, s14, 11
    s_cmp_lg_u32 s12, s14
    s_cselect_b32 s16, s16, 0x7ffffff0
    buffer_store_dwordx4 v[28:31], v2, s[68:71], s16 offen offset:0 sc1
    buffer_store_dwordx4 v[36:39], v2, s[68:71], s16 offen offset:1024 sc1
    s_lshl_b32 s16, s3, 13
    v_add_u32 v20, s16, v2
    s_waitcnt vmcnt(4)
    v_lshlrev_b32 v76, 16, v100
    v_and_b32 v77, 0xffff0000, v100
    s_waitcnt vmcnt(3)
    v_lshlrev_b32 v78, 16, v101
    v_and_b32 v79, 0xffff0000, v101
    v_pk_add_f32 v[76:77], v[76:77], v[78:79]
    s_waitcnt vmcnt(2)
    v_lshlrev_b32 v78, 16, v102
    v_and_b32 v79, 0xffff0000, v102
    v_pk_add_f32 v[92:93], v[78:79], v[76:77]
    v_cvt_pk_bf16_f32 v76, v92, v93
    v_lshlrev_b32 v92, 16, v76
    v_and_b32 v93, 0xffff0000, v76
    v_cvt_pk_bf16_f32 v100, v92, v93
    v_and_b32 v105, 0xffff0000, v104
    v_lshlrev_b32 v104, 16, v104
    v_and_b32 v107, 0xffff0000, v106
    v_lshlrev_b32 v106, 16, v106
    v_sub_f32 v92, v92, v25
    v_sub_f32 v93, v93, v25
    v_cvt_pk_bf16_f32 v76, v92, v93
    v_lshlrev_b32 v92, 16, v76
    v_and_b32 v93, 0xffff0000, v76
    v_mul_f32 v77, v92, v103
    v_fma_f32 v92, -v77, v26, v92
    v_fma_f32 v92, v92, v103, v77
    v_mul_f32 v77, v93, v103
    v_fma_f32 v93, -v77, v26, v93
    v_fma_f32 v93, v93, v103, v77
    v_cvt_pk_bf16_f32 v76, v92, v93
    v_lshlrev_b32 v92, 16, v76
    v_and_b32 v93, 0xffff0000, v76
    v_mul_f32 v92, v92, v104
    v_mul_f32 v93, v93, v105
    v_cvt_pk_bf16_f32 v76, v92, v93
    v_lshlrev_b32 v92, 16, v76
    v_and_b32 v93, 0xffff0000, v76
    v_add_f32 v92, v92, v106
    v_add_f32 v93, v93, v107
    v_cvt_pk_bf16_f32 v101, v92, v93
    v_add_u32 v16, 66560, v21
    ds_write_b32 v16, v101
    ds_write_b32 v16, v100 offset:2048
    s_waitcnt lgkmcnt(0)
    s_barrier
    ds_read_b128 v[60:63], v20 offset:0
    ds_read_b128 v[64:67], v20 offset:1024
    ds_read_b128 v[68:71], v20 offset:2048
    ds_read_b128 v[72:75], v20 offset:3072
    ds_read_b128 v[108:111], v20 offset:4096
    ds_read_b128 v[112:115], v20 offset:5120
    ds_read_b128 v[116:119], v20 offset:6144
    ds_read_b128 v[120:123], v20 offset:7168
    s_and_b32 s16, s3, 3
    s_lshl_b32 s16, s16, 7
    s_and_b32 s17, s29, 3
    s_lshl_b32 s17, s17, 9
    s_add_u32 s16, s16, s17
    s_add_u32 s16, s16, 66560
    v_lshrrev_b32 v16, 3, v1
    v_lshlrev_b32 v16, 4, v16
    v_add_u32 v16, s16, v16
    ds_read_b128 v[104:107], v16
    s_waitcnt lgkmcnt(0)
    v_lshlrev_b32 v76, 16, v104
    v_and_b32 v77, 0xffff, v104
    v_dot2_f32_bf16 v85, v60, v76, 0
    v_dot2_f32_bf16 v84, v60, v77, 0
    v_dot2_f32_bf16 v87, v61, v76, 0
    v_dot2_f32_bf16 v86, v61, v77, 0
    v_dot2_f32_bf16 v89, v62, v76, 0
    v_dot2_f32_bf16 v88, v62, v77, 0
    v_dot2_f32_bf16 v91, v63, v76, 0
    v_dot2_f32_bf16 v90, v63, v77, 0
    v_and_b32 v78, 0xffff0000, v104
    v_lshrrev_b32 v79, 16, v104
    v_dot2c_f32_bf16 v85, v64, v78
    v_dot2c_f32_bf16 v84, v64, v79
    v_dot2c_f32_bf16 v87, v65, v78
    v_dot2c_f32_bf16 v86, v65, v79
    v_dot2c_f32_bf16 v89, v66, v78
    v_dot2c_f32_bf16 v88, v66, v79
    v_dot2c_f32_bf16 v91, v67, v78
    v_dot2c_f32_bf16 v90, v67, v79
    v_lshlrev_b32 v80, 16, v105
    v_and_b32 v81, 0xffff, v105
    v_dot2c_f32_bf16 v85, v68, v80
    v_dot2c_f32_bf16 v84, v68, v81
    v_dot2c_f32_bf16 v87, v69, v80
    v_dot2c_f32_bf16 v86, v69, v81
    v_dot2c_f32_bf16 v89, v70, v80
    v_dot2c_f32_bf16 v88, v70, v81
    v_dot2c_f32_bf16 v91, v71, v80
    v_dot2c_f32_bf16 v90, v71, v81
    v_and_b32 v82, 0xffff0000, v105
    v_lshrrev_b32 v83, 16, v105
    v_dot2c_f32_bf16 v85, v72, v82
    v_dot2c_f32_bf16 v84, v72, v83
    v_dot2c_f32_bf16 v87, v73, v82
    v_dot2c_f32_bf16 v86, v73, v83
    v_dot2c_f32_bf16 v89, v74, v82
    v_dot2c_f32_bf16 v88, v74, v83
    v_dot2c_f32_bf16 v91, v75, v82
    v_dot2c_f32_bf16 v90, v75, v83
    v_lshlrev_b32 v76, 16, v106
    v_and_b32 v77, 0xffff, v106
    v_dot2c_f32_bf16 v85, v108, v76
    v_dot2c_f32_bf16 v84, v108, v77
    v_dot2c_f32_bf16 v87, v109, v76
    v_dot2c_f32_bf16 v86, v109, v77
    v_dot2c_f32_bf16 v89, v110, v76
    v_dot2c_f32_bf16 v88, v110, v77
    v_dot2c_f32_bf16 v91, v111, v76
    v_dot2c_f32_bf16 v90, v111, v77
    v_and_b32 v78, 0xffff0000, v106
    v_lshrrev_b32 v79, 16, v106
    v_dot2c_f32_bf16 v85, v112, v78
    v_dot2c_f32_bf16 v84, v112, v79
    v_dot2c_f32_bf16 v87, v113, v78
    v_dot2c_f32_bf16 v86, v113, v79
    v_dot2c_f32_bf16 v89, v114, v78
    v_dot2c_f32_bf16 v88, v114, v79
    v_dot2c_f32_bf16 v91, v115, v78
    v_dot2c_f32_bf16 v90, v115, v79
    v_lshlrev_b32 v80, 16, v107
    v_and_b32 v81, 0xffff, v107
    v_dot2c_f32_bf16 v85, v116, v80
    v_dot2c_f32_bf16 v84, v116, v81
    v_dot2c_f32_bf16 v87, v117, v80
    v_dot2c_f32_bf16 v86, v117, v81
    v_dot2c_f32_bf16 v89, v118, v80
    v_dot2c_f32_bf16 v88, v118, v81
    v_dot2c_f32_bf16 v91, v119, v80
    v_dot2c_f32_bf16 v90, v119, v81
    v_and_b32 v82, 0xffff0000, v107
    v_lshrrev_b32 v83, 16, v107
    v_dot2c_f32_bf16 v85, v120, v82
    v_dot2c_f32_bf16 v84, v120, v83
    v_dot2c_f32_bf16 v87, v121, v82
    v_dot2c_f32_bf16 v86, v121, v83
    v_dot2c_f32_bf16 v89, v122, v82
    v_dot2c_f32_bf16 v88, v122, v83
    v_dot2c_f32_bf16 v91, v123, v82
    v_dot2c_f32_bf16 v90, v123, v83
    s_nop 0
    v_permlane32_swap_b32 v84, v88
    v_permlane32_swap_b32 v85, v89
    v_permlane32_swap_b32 v86, v90
    v_permlane32_swap_b32 v87, v91
    v_add_f32 v84, v84, v88
    v_add_f32 v85, v85, v89
    v_add_f32 v86, v86, v90
    v_add_f32 v87, v87, v91
    s_nop 0
    v_permlane16_swap_b32 v84, v86
    v_permlane16_swap_b32 v85, v87
    v_add_f32 v84, v84, v86
    v_add_f32 v85, v85, v87
    s_nop 0
    v_add_f32_dpp v84, v84, v84 row_ror:8 row_mask:0xf bank_mask:0xf
    v_add_f32_dpp v85, v85, v85 row_ror:8 row_mask:0xf bank_mask:0xf
    v_and_b32 v16, 7, v1
    v_lshlrev_b32 v16, 5, v16
    v_lshrrev_b32 v17, 4, v1
    v_lshl_add_u32 v16, v17, 3, v16
    s_lshl_b32 s16, s3, 8
    s_add_u32 s16, s16, 70656
    v_add_u32 v16, s16, v16
    ds_write_b64 v16, v[84:85]
    s_lshr_b32 s16, s3, 2
    s_lshl_b32 s17, s16, 10
    s_add_u32 s17, s17, 70656
    v_lshlrev_b32 v17, 2, v1
    v_add_u32 v16, s17, v17
    s_and_b32 s17, s29, 3
    s_lshl_b32 s17, s17, 1
    s_add_u32 s17, s17, s16
    s_mul_i32 s17, s17, 14336
    s_lshr_b32 s16, s29, 2
    s_lshl_b32 s16, s16, 8
    s_add_u32 s17, s17, s16
    s_add_u32 s17, s17, 0x6e1000
    s_and_b32 s16, s3, 3
    s_cmp_eq_u32 s16, 0
    s_cselect_b32 s17, s17, 0x7ffffff0
    s_cmp_lt_u32 s2, 224
    s_cselect_b32 s17, s17, 0x7ffffff0
    s_waitcnt lgkmcnt(0)
    s_barrier
    ds_read_b32 v84, v16 offset:0
    ds_read_b32 v85, v16 offset:256
    ds_read_b32 v86, v16 offset:512
    ds_read_b32 v87, v16 offset:768
    s_waitcnt lgkmcnt(2)
    v_add_f32 v84, v84, v85
    s_waitcnt lgkmcnt(0)
    v_add_f32 v86, v86, v87
    v_add_f32 v84, v84, v86
    v_or_b32 v84, 1, v84
    buffer_store_dword v84, v17, s[8:11], s17 offen sc1
    s_barrier
    v_lshlrev_b32 v16, 3, v0
    v_add_u32 v17, 73728, v16
    ds_read_b64 v[84:85], v17 offset:0
    ds_read_b64 v[86:87], v17 offset:4096
    ds_read_b64 v[88:89], v17 offset:8192
    ds_read_b64 v[90:91], v17 offset:12288
    s_waitcnt lgkmcnt(2)
    v_pk_add_f32 v[84:85], v[84:85], v[86:87]
    s_waitcnt lgkmcnt(0)
    v_pk_add_f32 v[88:89], v[88:89], v[90:91]
    v_pk_add_f32 v[84:85], v[84:85], v[88:89]
    v_or_b32 v84, 1, v84
    v_or_b32 v85, 1, v85
    s_lshl_b32 s16, s29, 12
    s_add_u32 s16, s16, 0x600000
    s_cmp_lt_u32 s2, 224
    s_cselect_b32 s16, s16, 0x7ffffff0
    buffer_store_dwordx2 v[84:85], v16, s[8:11], s16 offen sc1
    s_cmp_lt_u32 s2, 224
    s_cbranch_scc1 adaLN_cond__sliding_block_cached__moe_arch_mod__prompt_kernel_end
    s_sub_u32 s16, s2, 224
    s_lshl_b32 s17, s16, 7
    s_add_u32 s17, s17, 0x600000
    v_lshrrev_b32 v16, 3, v0
    v_lshlrev_b32 v16, 12, v16
    v_and_b32 v17, 7, v0
    v_lshl_add_u32 v16, v17, 4, v16
    v_cmp_gt_u32 vcc, 256, v0
    v_bfrev_b32 v17, -2
    s_nop 0
    v_cndmask_b32 v17, v17, v16, vcc
    v_mov_b32 v19, 0
    v_cndmask_b32 v18, 1, v19, vcc
    s_lshl_b32 s18, s16, 6
    v_and_b32 v19, 31, v1
    v_lshlrev_b32 v19, 1, v19
    v_add_u32 v19, s18, v19
    s_mov_b32 s19, 0x541800
    buffer_load_ushort v95, v19, s[8:11], s19 offen sc1
    v_add_u32 v20, 66560, v19
    ds_read_u16 v96, v20
    ds_read_u16 v97, v20 offset:2048
    v_mov_b32 v94, v27
    v_cvt_pk_bf16_f32 v94, v94, v94
    v_lshlrev_b32 v94, 16, v94
    v_mul_f32 v94, 0xbfb8aa3b, v94
    v_exp_f32 v94, v94
    s_nop 0
    v_add_f32 v94, 1.0, v94
    v_rcp_f32 v94, v94
    s_nop 0
    v_cvt_pk_bf16_f32 v94, v94, v94
    v_lshlrev_b32 v94, 16, v94
    s_waitcnt vmcnt(0)
    v_lshlrev_b32 v95, 16, v95
    s_waitcnt lgkmcnt(1)
    v_lshlrev_b32 v96, 16, v96
    s_waitcnt lgkmcnt(0)
    v_lshlrev_b32 v97, 16, v97
    s_mov_b32 s27, 0
adaLN_cond__sliding_block_cached__moe_arch_mod__prompt_kernel_y13p:
    s_add_u32 s19, s17, 0x0
    buffer_load_dwordx4 v[44:47], v16, s[8:11], s19 offen sc1
    s_add_u32 s19, s17, 0x40000
    buffer_load_dwordx4 v[48:51], v16, s[8:11], s19 offen sc1
    s_add_u32 s19, s17, 0x80000
    buffer_load_dwordx4 v[52:55], v16, s[8:11], s19 offen sc1
    s_add_u32 s19, s17, 0xc0000
    buffer_load_dwordx4 v[56:59], v17, s[8:11], s19 offen sc1
    s_waitcnt vmcnt(0)
    v_min3_u32 v98, v56, v57, v58
    v_min_u32 v98, v98, v59
    v_or_b32 v98, v98, v18
    v_min3_u32 v98, v98, v44, v45
    v_min3_u32 v98, v98, v46, v47
    v_min3_u32 v98, v98, v48, v49
    v_min3_u32 v98, v98, v50, v51
    v_min3_u32 v98, v98, v52, v53
    v_min3_u32 v98, v98, v54, v55
    v_cmp_eq_u32 vcc, 0, v98
    s_add_u32 s27, s27, 1
    s_cmp_ge_u32 s27, 65536
    s_cbranch_scc1 adaLN_cond__sliding_block_cached__moe_arch_mod__prompt_kernel_y13g
    s_cbranch_vccnz adaLN_cond__sliding_block_cached__moe_arch_mod__prompt_kernel_y13p
adaLN_cond__sliding_block_cached__moe_arch_mod__prompt_kernel_y13g:
    v_pk_add_f32 v[44:45], v[44:45], v[52:53]
    v_pk_add_f32 v[46:47], v[46:47], v[54:55]
    v_pk_add_f32 v[48:49], v[48:49], v[56:57]
    v_pk_add_f32 v[50:51], v[50:51], v[58:59]
    v_pk_add_f32 v[44:45], v[44:45], v[48:49]
    v_pk_add_f32 v[46:47], v[46:47], v[50:51]
    s_nop 0
    v_add_f32_dpp v44, v44, v44 row_ror:8 row_mask:0xf bank_mask:0xf
    v_add_f32_dpp v45, v45, v45 row_ror:8 row_mask:0xf bank_mask:0xf
    v_add_f32_dpp v46, v46, v46 row_ror:8 row_mask:0xf bank_mask:0xf
    v_add_f32_dpp v47, v47, v47 row_ror:8 row_mask:0xf bank_mask:0xf
    s_nop 0
    v_permlane32_swap_b32 v44, v46
    v_permlane32_swap_b32 v45, v47
    v_add_f32 v44, v44, v46
    v_add_f32 v45, v45, v47
    s_nop 1
    v_permlane16_swap_b32 v44, v45
    v_add_f32 v44, v44, v45
    v_and_b32 v16, 7, v1
    v_lshlrev_b32 v16, 4, v16
    v_lshrrev_b32 v17, 4, v1
    v_lshl_add_u32 v16, v17, 2, v16
    s_lshl_b32 s19, s3, 7
    s_add_u32 s19, s19, 91136
    v_add_u32 v16, s19, v16
    ds_write_b32 v16, v44
    v_and_b32 v16, 31, v1
    v_lshlrev_b32 v16, 2, v16
    v_add_u32 v16, 91136, v16
    s_waitcnt lgkmcnt(0)
    s_barrier
    s_cmp_lg_u32 s3, 0
    s_cbranch_scc1 adaLN_cond__sliding_block_cached__moe_arch_mod__prompt_kernel_end
    ds_read_b32 v44, v16 offset:0
    ds_read_b32 v45, v16 offset:128
    ds_read_b32 v46, v16 offset:256
    ds_read_b32 v47, v16 offset:384
    ds_read_b32 v48, v16 offset:512
    ds_read_b32 v49, v16 offset:640
    ds_read_b32 v50, v16 offset:768
    ds_read_b32 v51, v16 offset:896
    s_waitcnt lgkmcnt(3)
    v_add_f32 v44, v44, v48
    s_waitcnt lgkmcnt(2)
    v_add_f32 v45, v45, v49
    s_waitcnt lgkmcnt(1)
    v_add_f32 v46, v46, v50
    s_waitcnt lgkmcnt(0)
    v_add_f32 v47, v47, v51
    v_add_f32 v44, v44, v46
    v_add_f32 v45, v45, v47
    v_add_f32 v44, v44, v45
    v_cvt_pk_bf16_f32 v44, v44, v44
    v_lshlrev_b32 v44, 16, v44
    v_mul_f32 v44, v44, v94
    v_cvt_pk_bf16_f32 v44, v44, v44
    v_lshlrev_b32 v44, 16, v44
    v_add_f32 v44, v44, v96
    v_cvt_pk_bf16_f32 v44, v44, v44
    v_lshlrev_b32 v44, 16, v44
    v_mul_f32 v44, v44, v95
    v_cvt_pk_bf16_f32 v44, v44, v44
    v_lshlrev_b32 v44, 16, v44
    v_add_f32 v44, v44, v97
    v_cvt_pk_bf16_f32 v44, v44, v44
    s_mov_b64 exec, 0xffffffff
    buffer_store_short v44, v19, s[68:71], s13 offen sc1
    s_branch adaLN_cond__sliding_block_cached__moe_arch_mod__prompt_kernel_end
adaLN_cond__sliding_block_cached__moe_arch_mod__prompt_kernel_roleB:
    v_mov_b32 v132, 0
    v_mov_b32 v133, 0
    v_lshrrev_b32 v16, 3, v0
    v_and_b32 v17, 7, v0
    v_mul_u32_u24 v135, 24576, v16
    v_lshl_add_u32 v135, v17, 4, v135
    v_lshlrev_b32 v136, 2, v16
    s_and_b32 s14, s2, 31
    s_lshr_b32 s15, s2, 5
    s_mul_i32 s26, s15, 1572864
    s_lshl_b32 s16, s14, 7
    s_add_u32 s26, s26, s16
    s_lshl_b32 s29, s15, 8
    v_lshlrev_b32 v137, 3, v0
    s_lshl_b32 s18, s2, 3
    s_add_u32 s18, s18, s3
    s_lshl_b32 s18, s18, 11
    v_and_b32 v18, 15, v1
    v_lshrrev_b32 v19, 4, v1
    v_lshlrev_b32 v138, 11, v18
    v_lshl_add_u32 v138, v19, 4, v138
    s_lshr_b32 s30, s2, 4
    s_and_b32 s31, s2, 15
    s_lshl_b32 s19, s30, 3
    s_add_u32 s19, s19, s3
    s_lshl_b32 s22, s19, 15
    s_lshl_b32 s23, s31, 7
    s_add_u32 s22, s22, s23
    s_lshl_b32 s23, s2, 12
    s_add_u32 s23, s23, 0x600000
    s_or_b32 s25, s2, s3
    s_cmp_eq_u32 s25, 0
    s_cselect_b32 s25, 0, 0x7ffffff0
    s_waitcnt lgkmcnt(0)
    s_mov_b64 s[64:65], s[58:59]
    s_mov_b32 s66, 0x100
    s_mov_b32 s67, 0x20000
    s_or_b32 s28, s62, 1
    v_mov_b32 v134, s28
    s_mov_b64 exec, 1
    buffer_store_dword v134, v132, s[64:67], s25 offen sc1
    s_mov_b64 exec, -1
    s_mov_b64 s[68:69], s[52:53]
    s_mov_b32 s70, 0x800
    s_mov_b32 s71, 0x20000
    s_mov_b64 s[72:73], s[54:55]
    s_mov_b32 s74, 0xc00000
    s_mov_b32 s75, 0x20000
    s_mov_b64 s[76:77], s[32:33]
    s_mov_b32 s78, 0x400000
    s_mov_b32 s79, 0x20000
    s_mov_b64 s[8:9], s[60:61]
    s_mov_b32 s10, 0x3400000
    s_mov_b32 s11, 0x20000
    buffer_load_dwordx4 v[32:35], v2, s[76:79], s18 offen offset:0
    buffer_load_dwordx4 v[36:39], v2, s[76:79], s18 offen offset:1024
    buffer_load_dword v72, v136, s[68:71], s29 offen
    buffer_load_dwordx4 v[24:27], v135, s[72:75], s26 offen
    s_add_u32 s26, s26, 12288
    buffer_load_dwordx4 v[28:31], v135, s[72:75], s26 offen
    buffer_store_dwordx2 v[132:133], v137, s[8:11], s23 offen sc1
    s_barrier
    buffer_load_dwordx4 v[40:43], v138, s[76:79], s22 offen offset:0
    buffer_load_dwordx4 v[44:47], v138, s[76:79], s22 offen offset:64
    s_mov_b32 s29, s19
    s_mov_b64 s[64:65], s[34:35]
    s_mov_b32 s66, 0x200000
    s_mov_b32 s67, 0x20000
    s_mov_b64 s[68:69], s[36:37]
    s_mov_b32 s70, 0x200000
    s_mov_b32 s71, 0x20000
    s_lshl_b32 s20, s2, 2
    s_add_u32 s20, s20, s3
    s_sub_u32 s20, s20, 4
    s_lshr_b32 s22, s20, 8
    s_bfe_u32 s23, s20, 0x40004
    s_and_b32 s24, s20, 15
    s_lshl_b32 s25, s22, 19
    s_lshl_b32 s26, s23, 13
    s_add_u32 s25, s25, s26
    s_add_u32 s25, s25, 393216
    v_and_b32 v16, 15, v1
    v_lshrrev_b32 v17, 4, v1
    s_lshl_b32 s21, s22, 17
    s_cmp_ge_u32 s24, 8
    s_cbranch_scc1 adaLN_cond__sliding_block_cached__moe_arch_mod__prompt_kernel_kvV
    v_lshlrev_b32 v18, 8, v16
    v_lshl_add_u32 v18, v17, 3, v18
    s_and_b32 s26, s24, 1
    s_lshl_b32 s26, s26, 12
    s_add_u32 s25, s25, s26
    s_lshr_b32 s26, s24, 1
    s_lshl_b32 s26, s26, 6
    s_add_u32 s25, s25, s26
    buffer_load_dwordx2 v[84:85], v18, s[64:67], s25 offen
    buffer_load_dwordx2 v[86:87], v18, s[64:67], s25 offen offset:32
    s_mov_b32 s26, 0x7ffffff0
    buffer_load_ushort v88, v18, s[64:67], s26 offen
    buffer_load_ushort v89, v18, s[64:67], s26 offen
    buffer_load_ushort v90, v18, s[64:67], s26 offen
    buffer_load_ushort v91, v18, s[64:67], s26 offen
    buffer_load_ushort v92, v18, s[64:67], s26 offen
    buffer_load_ushort v93, v18, s[64:67], s26 offen
    s_lshl_b32 s26, s23, 13
    s_add_u32 s21, s21, s26
    s_lshl_b32 s26, s24, 10
    s_add_u32 s21, s21, s26
    s_add_u32 s21, s21, 0x400000
    s_branch adaLN_cond__sliding_block_cached__moe_arch_mod__prompt_kernel_kvJ
adaLN_cond__sliding_block_cached__moe_arch_mod__prompt_kernel_kvV:
    s_bfe_u32 s26, s24, 0x20001
    s_lshl_b32 s26, s26, 6
    s_add_u32 s25, s25, s26
    s_and_b32 s26, s24, 1
    s_lshl_b32 s26, s26, 3
    s_add_u32 s25, s25, s26
    s_add_u32 s26, s25, 4096
    v_lshrrev_b32 v18, 2, v16
    v_lshlrev_b32 v18, 4, v18
    v_and_b32 v19, 3, v16
    v_lshl_add_u32 v18, v19, 1, v18
    v_lshl_add_u32 v18, v17, 10, v18
    buffer_load_ushort v88, v18, s[68:71], s25 offen offset:0
    buffer_load_ushort v89, v18, s[68:71], s25 offen offset:256
    buffer_load_ushort v90, v18, s[68:71], s25 offen offset:512
    buffer_load_ushort v91, v18, s[68:71], s25 offen offset:768
    buffer_load_ushort v92, v18, s[68:71], s26 offen offset:0
    buffer_load_ushort v93, v18, s[68:71], s26 offen offset:256
    buffer_load_ushort v94, v18, s[68:71], s26 offen offset:512
    buffer_load_ushort v95, v18, s[68:71], s26 offen offset:768
    s_bfe_u32 s26, s24, 0x20001
    s_lshl_b32 s26, s26, 15
    s_add_u32 s21, s21, s26
    s_lshl_b32 s26, s23, 11
    s_add_u32 s21, s21, s26
    s_and_b32 s26, s24, 1
    s_lshl_b32 s26, s26, 10
    s_add_u32 s21, s21, s26
    s_add_u32 s21, s21, 0x480000
adaLN_cond__sliding_block_cached__moe_arch_mod__prompt_kernel_kvJ:
    s_waitcnt vmcnt(15)
    v_lshlrev_b32 v56, 16, v32
    v_and_b32 v57, 0xffff0000, v32
    v_lshlrev_b32 v58, 16, v33
    v_and_b32 v59, 0xffff0000, v33
    v_lshlrev_b32 v60, 16, v34
    v_and_b32 v61, 0xffff0000, v34
    v_lshlrev_b32 v62, 16, v35
    v_and_b32 v63, 0xffff0000, v35
    s_waitcnt vmcnt(14)
    v_lshlrev_b32 v64, 16, v36
    v_and_b32 v65, 0xffff0000, v36
    v_lshlrev_b32 v66, 16, v37
    v_and_b32 v67, 0xffff0000, v37
    v_lshlrev_b32 v68, 16, v38
    v_and_b32 v69, 0xffff0000, v38
    v_lshlrev_b32 v70, 16, v39
    v_and_b32 v71, 0xffff0000, v39
    v_add_f32 v20, v56, v57
    v_add_f32 v21, v58, v59
    v_add_f32 v20, v20, v60
    v_add_f32 v21, v21, v61
    v_add_f32 v20, v20, v62
    v_add_f32 v21, v21, v63
    v_add_f32 v20, v20, v64
    v_add_f32 v21, v21, v65
    v_add_f32 v20, v20, v66
    v_add_f32 v21, v21, v67
    v_add_f32 v20, v20, v68
    v_add_f32 v21, v21, v69
    v_add_f32 v20, v20, v70
    v_add_f32 v21, v21, v71
    v_add_f32 v128, v20, v21
    s_nop 1
    v_add_f32_dpp v128, v128, v128 row_ror:1 row_mask:0xf bank_mask:0xf
    s_nop 1
    v_add_f32_dpp v128, v128, v128 row_ror:2 row_mask:0xf bank_mask:0xf
    s_nop 1
    v_add_f32_dpp v128, v128, v128 row_ror:4 row_mask:0xf bank_mask:0xf
    s_nop 1
    v_add_f32_dpp v128, v128, v128 row_ror:8 row_mask:0xf bank_mask:0xf
    v_mov_b32 v20, v128
    s_nop 1
    v_permlane16_swap_b32 v128, v20
    v_add_f32 v128, v128, v20
    v_mov_b32 v20, v128
    s_nop 1
    v_permlane32_swap_b32 v128, v20
    v_add_f32 v128, v128, v20
    v_mul_f32 v128, 0x3a800000, v128
    v_sub_f32 v18, v56, v128
    v_mul_f32 v20, v18, v18
    v_sub_f32 v19, v57, v128
    v_mul_f32 v21, v19, v19
    v_sub_f32 v18, v58, v128
    v_sub_f32 v19, v59, v128
    v_fmac_f32 v20, v18, v18
    v_fmac_f32 v21, v19, v19
    v_sub_f32 v18, v60, v128
    v_sub_f32 v19, v61, v128
    v_fmac_f32 v20, v18, v18
    v_fmac_f32 v21, v19, v19
    v_sub_f32 v18, v62, v128
    v_sub_f32 v19, v63, v128
    v_fmac_f32 v20, v18, v18
    v_fmac_f32 v21, v19, v19
    v_sub_f32 v18, v64, v128
    v_sub_f32 v19, v65, v128
    v_fmac_f32 v20, v18, v18
    v_fmac_f32 v21, v19, v19
    v_sub_f32 v18, v66, v128
    v_sub_f32 v19, v67, v128
    v_fmac_f32 v20, v18, v18
    v_fmac_f32 v21, v19, v19
    v_sub_f32 v18, v68, v128
    v_sub_f32 v19, v69, v128
    v_fmac_f32 v20, v18, v18
    v_fmac_f32 v21, v19, v19
    v_sub_f32 v18, v70, v128
    v_sub_f32 v19, v71, v128
    v_fmac_f32 v20, v18, v18
    v_fmac_f32 v21, v19, v19
    v_add_f32 v17, v20, v21
    s_nop 1
    v_add_f32_dpp v17, v17, v17 row_ror:1 row_mask:0xf bank_mask:0xf
    s_nop 1
    v_add_f32_dpp v17, v17, v17 row_ror:2 row_mask:0xf bank_mask:0xf
    s_nop 1
    v_add_f32_dpp v17, v17, v17 row_ror:4 row_mask:0xf bank_mask:0xf
    s_nop 1
    v_add_f32_dpp v17, v17, v17 row_ror:8 row_mask:0xf bank_mask:0xf
    v_mov_b32 v20, v17
    s_nop 1
    v_permlane16_swap_b32 v17, v20
    v_add_f32 v17, v17, v20
    v_mov_b32 v20, v17
    s_nop 1
    v_permlane32_swap_b32 v17, v20
    v_add_f32 v17, v17, v20
    v_mul_f32 v17, 0x3a800000, v17
    v_cvt_pk_bf16_f32 v128, v128, v128
    v_lshlrev_b32 v128, 16, v128
    v_cvt_pk_bf16_f32 v17, v17, v17
    v_lshlrev_b32 v17, 16, v17
    v_add_f32 v17, 0x3727c5ac, v17
    v_cvt_pk_bf16_f32 v17, v17, v17
    v_lshlrev_b32 v17, 16, v17
    v_sqrt_f32 v129, v17
    s_nop 0
    v_cvt_pk_bf16_f32 v129, v129, v129
    v_lshlrev_b32 v129, 16, v129
    v_rcp_f32 v130, v129
    s_lshl_b32 s16, s3, 4
    s_add_u32 s16, s16, 149520
    v_mov_b32 v19, s16
    ds_write_b128 v19, v[128:131]
    s_waitcnt vmcnt(13)
    v_and_b32 v73, 0xffff0000, v72
    v_lshlrev_b32 v72, 16, v72
    v_mul_f32 v16, 0xbfb8aa3b, v72
    v_exp_f32 v16, v16
    s_nop 0
    v_add_f32 v16, 1.0, v16
    v_rcp_f32 v16, v16
    s_nop 0
    v_mul_f32 v72, v72, v16
    v_mul_f32 v17, 0xbfb8aa3b, v73
    v_exp_f32 v17, v17
    s_nop 0
    v_add_f32 v17, 1.0, v17
    v_rcp_f32 v17, v17
    s_nop 0
    v_mul_f32 v73, v73, v17
    v_cvt_pk_bf16_f32 v16, v72, v73
    v_lshlrev_b32 v72, 16, v16
    v_and_b32 v73, 0xffff0000, v16
    s_lshl_b32 s16, s2, 8
    s_add_u32 s16, s16, 0x550000
    s_mov_b32 exec_lo, 0x01010101
    s_mov_b32 exec_hi, 0x01010101
    buffer_store_dword v16, v136, s[8:11], s16 offen sc1
    s_mov_b64 exec, -1
    v_lshrrev_b32 v74, 16, v72
    v_lshrrev_b32 v75, 16, v73
    s_waitcnt vmcnt(13)
    v_dot2_f32_bf16 v49, v24, v72, 0
    v_dot2_f32_bf16 v48, v24, v74, 0
    v_dot2_f32_bf16 v51, v25, v72, 0
    v_dot2_f32_bf16 v50, v25, v74, 0
    v_dot2_f32_bf16 v53, v26, v72, 0
    v_dot2_f32_bf16 v52, v26, v74, 0
    v_dot2_f32_bf16 v55, v27, v72, 0
    v_dot2_f32_bf16 v54, v27, v74, 0
    s_waitcnt vmcnt(12)
    v_dot2c_f32_bf16 v49, v28, v73
    v_dot2c_f32_bf16 v48, v28, v75
    v_dot2c_f32_bf16 v51, v29, v73
    v_dot2c_f32_bf16 v50, v29, v75
    v_dot2c_f32_bf16 v53, v30, v73
    v_dot2c_f32_bf16 v52, v30, v75
    v_dot2c_f32_bf16 v55, v31, v73
    v_dot2c_f32_bf16 v54, v31, v75
    s_nop 0
    v_permlane32_swap_b32 v48, v52
    v_permlane32_swap_b32 v49, v53
    v_permlane32_swap_b32 v50, v54
    v_permlane32_swap_b32 v51, v55
    v_add_f32 v48, v48, v52
    v_add_f32 v49, v49, v53
    v_add_f32 v50, v50, v54
    v_add_f32 v51, v51, v55
    s_nop 0
    v_permlane16_swap_b32 v48, v50
    v_permlane16_swap_b32 v49, v51
    v_add_f32 v48, v48, v50
    v_add_f32 v49, v49, v51
    s_nop 0
    v_add_f32_dpp v48, v48, v48 row_ror:8 row_mask:0xf bank_mask:0xf
    v_add_f32_dpp v49, v49, v49 row_ror:8 row_mask:0xf bank_mask:0xf
    v_and_b32 v16, 7, v1
    v_lshlrev_b32 v16, 5, v16
    v_lshrrev_b32 v17, 4, v1
    v_lshl_add_u32 v16, v17, 3, v16
    s_lshl_b32 s16, s3, 8
    s_add_u32 s16, s16, 147456
    v_add_u32 v16, s16, v16
    ds_write_b64 v16, v[48:49]
    v_mov_b32 v19, 149504
    v_and_b32 v17, 31, v1
    v_lshlrev_b32 v18, 3, v17
    v_add_u32 v18, 147456, v18
    v_lshlrev_b32 v17, 4, v17
    s_waitcnt lgkmcnt(0)
    s_barrier
    ds_read_b32 v134, v19
    ds_read_b64 v[96:97], v18 offset:0
    ds_read_b64 v[100:101], v18 offset:256
    ds_read_b64 v[104:105], v18 offset:512
    ds_read_b64 v[108:109], v18 offset:768
    ds_read_b64 v[112:113], v18 offset:1024
    ds_read_b64 v[116:117], v18 offset:1280
    ds_read_b64 v[120:121], v18 offset:1536
    ds_read_b64 v[124:125], v18 offset:1792
    s_waitcnt lgkmcnt(8)
    v_readfirstlane_b32 s28, v134
    v_and_b32 v20, 7, v1
    v_lshlrev_b32 v20, 4, v20
    v_add_u32 v21, 149520, v20
    ds_read_b128 v[128:131], v21
    s_waitcnt lgkmcnt(0)
    v_mov_b32 v131, s28
    s_lshl_b32 s16, s2, 7
    s_add_u32 s16, s16, 0x520000
    s_cmp_eq_u32 s3, 0
    s_cselect_b32 s16, s16, 0x7ffffff0
    s_mov_b64 exec, 0xff
    buffer_store_dwordx4 v[128:131], v20, s[8:11], s16 offen sc1
    s_mov_b64 exec, -1
    v_pk_add_f32 v[96:97], v[96:97], v[112:113]
    v_pk_add_f32 v[100:101], v[100:101], v[116:117]
    v_pk_add_f32 v[104:105], v[104:105], v[120:121]
    v_pk_add_f32 v[108:109], v[108:109], v[124:125]
    v_pk_add_f32 v[96:97], v[96:97], v[104:105]
    v_pk_add_f32 v[100:101], v[100:101], v[108:109]
    v_pk_add_f32 v[96:97], v[96:97], v[100:101]
    v_mov_b32 v98, s28
    v_mov_b32 v99, s28
    s_lshl_b32 s16, s14, 3
    s_add_u32 s16, s16, s15
    s_lshl_b32 s16, s16, 9
    s_add_u32 s16, s16, 0x500000
    s_cmp_eq_u32 s3, 0
    s_cselect_b32 s16, s16, 0x7ffffff0
    s_mov_b64 exec, 0xffffffff
    buffer_store_dwordx4 v[96:99], v17, s[8:11], s16 offen sc1
    s_mov_b64 exec, -1
    s_lshr_b32 s16, s3, 2
    s_lshl_b32 s16, s16, 4
    s_add_u32 s16, s16, s31
    s_lshl_b32 s16, s16, 12
    s_and_b32 s17, s3, 3
    s_lshl_b32 s17, s17, 7
    s_add_u32 s16, s16, s17
    s_add_u32 s16, s16, 0x500000
    v_lshrrev_b32 v139, 3, v1
    v_lshlrev_b32 v139, 9, v139
    v_and_b32 v16, 7, v1
    v_lshl_add_u32 v139, v16, 4, v139
    v_and_b32 v140, 15, v1
    v_lshlrev_b32 v140, 4, v140
    s_lshl_b32 s17, s29, 8
    s_add_u32 s17, s17, 0x520000
    s_waitcnt vmcnt(12)
    v_lshlrev_b32 v56, 16, v40
    v_and_b32 v57, 0xffff0000, v40
    v_lshlrev_b32 v58, 16, v41
    v_and_b32 v59, 0xffff0000, v41
    v_lshlrev_b32 v60, 16, v42
    v_and_b32 v61, 0xffff0000, v42
    v_lshlrev_b32 v62, 16, v43
    v_and_b32 v63, 0xffff0000, v43
    s_waitcnt vmcnt(11)
    v_lshlrev_b32 v64, 16, v44
    v_and_b32 v65, 0xffff0000, v44
    v_lshlrev_b32 v66, 16, v45
    v_and_b32 v67, 0xffff0000, v45
    v_lshlrev_b32 v68, 16, v46
    v_and_b32 v69, 0xffff0000, v46
    v_lshlrev_b32 v70, 16, v47
    v_and_b32 v71, 0xffff0000, v47
    v_mov_b32 v135, 2097152
    v_mul_lo_u32 v135, v135, v1
    s_mov_b64 s[76:77], s[40:41]
    s_mov_b32 s78, 0x800000
    s_mov_b32 s79, 0x20000
    s_mov_b32 s62, 0x0
    s_cmp_eq_u32 s3, 4
    s_cselect_b32 s62, s62, 0x7ffffff0
    buffer_load_dword v136, v135, s[76:79], s62 offen
    s_mov_b64 s[76:77], s[46:47]
    s_mov_b32 s78, 0x700000
    s_mov_b32 s79, 0x20000
    s_mov_b32 s62, 0x0
    s_cmp_eq_u32 s3, 4
    s_cselect_b32 s62, s62, 0x7ffffff0
    buffer_load_dword v136, v135, s[76:79], s62 offen
    s_mov_b64 s[76:77], s[48:49]
    s_mov_b32 s78, 0x700000
    s_mov_b32 s79, 0x20000
    s_mov_b32 s62, 0x0
    s_cmp_eq_u32 s3, 5
    s_cselect_b32 s62, s62, 0x7ffffff0
    buffer_load_dword v136, v135, s[76:79], s62 offen
    s_mov_b64 s[76:77], s[50:51]
    s_mov_b32 s78, 0x700000
    s_mov_b32 s79, 0x20000
    s_mov_b32 s62, 0x0
    s_cmp_eq_u32 s3, 5
    s_cselect_b32 s62, s62, 0x7ffffff0
    buffer_load_dword v136, v135, s[76:79], s62 offen
    s_mov_b64 s[76:77], s[38:39]
    s_mov_b32 s78, 0x800000
    s_mov_b32 s79, 0x20000
    s_mov_b32 s62, 0x0
    s_cmp_eq_u32 s3, 6
    s_cselect_b32 s62, s62, 0x7ffffff0
    buffer_load_dword v136, v135, s[76:79], s62 offen
    s_mov_b64 s[76:77], s[56:57]
    s_mov_b32 s78, 0x400000
    s_mov_b32 s79, 0x20000
    s_mov_b32 s62, 0x0
    s_cmp_eq_u32 s3, 6
    s_cselect_b32 s62, s62, 0x7ffffff0
    buffer_load_dword v136, v135, s[76:79], s62 offen
    s_mov_b64 s[76:77], s[54:55]
    s_mov_b32 s78, 0xc00000
    s_mov_b32 s79, 0x20000
    s_mov_b32 s62, 0x0
    s_cmp_eq_u32 s3, 7
    s_cselect_b32 s62, s62, 0x7ffffff0
    buffer_load_dword v136, v135, s[76:79], s62 offen
    s_mov_b64 s[76:77], s[44:45]
    s_mov_b32 s78, 0x800
    s_mov_b32 s79, 0x20000
    s_mov_b32 s62, 0x0
    s_cmp_eq_u32 s3, 7
    s_cselect_b32 s62, s62, 0x7ffffff0
    buffer_load_dword v136, v135, s[76:79], s62 offen
    s_mov_b32 s27, 0
adaLN_cond__sliding_block_cached__moe_arch_mod__prompt_kernel_g14p:
    buffer_load_dwordx4 v[76:79], v139, s[8:11], s16 offen sc1
    buffer_load_dwordx4 v[80:83], v140, s[8:11], s17 offen sc1
    s_waitcnt vmcnt(1)
    v_cmp_ne_u32 vcc, s28, v78
    v_cmp_ne_u32 s[62:63], s28, v79
    s_or_b64 vcc, vcc, s[62:63]
    s_waitcnt vmcnt(0)
    v_cmp_ne_u32 s[62:63], s28, v83
    s_or_b64 vcc, vcc, s[62:63]
    s_add_u32 s27, s27, 1
    s_cmp_ge_u32 s27, 65536
    s_cbranch_scc1 adaLN_cond__sliding_block_cached__moe_arch_mod__prompt_kernel_g14g
    s_cbranch_vccnz adaLN_cond__sliding_block_cached__moe_arch_mod__prompt_kernel_g14p
adaLN_cond__sliding_block_cached__moe_arch_mod__prompt_kernel_g14g:
    v_add_f32_dpp v76, v76, v76 row_ror:8 row_mask:0xf bank_mask:0xf
    v_add_f32_dpp v77, v77, v77 row_ror:8 row_mask:0xf bank_mask:0xf
    v_mov_b32 v17, v76
    s_nop 1
    v_permlane16_swap_b32 v76, v17
    v_add_f32 v76, v76, v17
    v_mov_b32 v18, v77
    s_nop 1
    v_permlane16_swap_b32 v77, v18
    v_add_f32 v77, v77, v18
    v_mov_b32 v17, v76
    s_nop 1
    v_permlane32_swap_b32 v76, v17
    v_add_f32 v76, v76, v17
    v_mov_b32 v18, v77
    s_nop 1
    v_permlane32_swap_b32 v77, v18
    v_add_f32 v77, v77, v18
    v_cvt_pk_bf16_f32 v17, v76, v77
    v_lshlrev_b32 v76, 16, v17
    v_and_b32 v77, 0xffff0000, v17
    v_add_f32 v76, 1.0, v76
    v_add_f32 v77, 1.0, v77
    v_cvt_pk_bf16_f32 v17, v76, v77
    v_lshlrev_b32 v76, 16, v17
    v_and_b32 v77, 0xffff0000, v17
    s_lshl_b32 s16, s3, 6
    s_add_u32 s16, s16, 151552
    v_lshl_add_u32 v16, v16, 3, s16
    ds_write_b64 v16, v[76:77]
    v_lshrrev_b32 v17, 4, v1
    v_lshlrev_b32 v17, 5, v17
    v_add_u32 v17, 151552, v17
    v_sub_f32 v56, v56, v80
    v_sub_f32 v57, v57, v80
    v_sub_f32 v58, v58, v80
    v_sub_f32 v59, v59, v80
    v_sub_f32 v60, v60, v80
    v_sub_f32 v61, v61, v80
    v_sub_f32 v62, v62, v80
    v_sub_f32 v63, v63, v80
    v_sub_f32 v64, v64, v80
    v_sub_f32 v65, v65, v80
    v_sub_f32 v66, v66, v80
    v_sub_f32 v67, v67, v80
    v_sub_f32 v68, v68, v80
    v_sub_f32 v69, v69, v80
    v_sub_f32 v70, v70, v80
    v_sub_f32 v71, v71, v80
    v_cvt_pk_bf16_f32 v18, v56, v57
    v_lshlrev_b32 v56, 16, v18
    v_and_b32 v57, 0xffff0000, v18
    v_cvt_pk_bf16_f32 v19, v58, v59
    v_lshlrev_b32 v58, 16, v19
    v_and_b32 v59, 0xffff0000, v19
    v_cvt_pk_bf16_f32 v18, v60, v61
    v_lshlrev_b32 v60, 16, v18
    v_and_b32 v61, 0xffff0000, v18
    v_cvt_pk_bf16_f32 v19, v62, v63
    v_lshlrev_b32 v62, 16, v19
    v_and_b32 v63, 0xffff0000, v19
    v_cvt_pk_bf16_f32 v18, v64, v65
    v_lshlrev_b32 v64, 16, v18
    v_and_b32 v65, 0xffff0000, v18
    v_cvt_pk_bf16_f32 v19, v66, v67
    v_lshlrev_b32 v66, 16, v19
    v_and_b32 v67, 0xffff0000, v19
    v_cvt_pk_bf16_f32 v18, v68, v69
    v_lshlrev_b32 v68, 16, v18
    v_and_b32 v69, 0xffff0000, v18
    v_cvt_pk_bf16_f32 v19, v70, v71
    v_lshlrev_b32 v70, 16, v19
    v_and_b32 v71, 0xffff0000, v19
    v_mul_f32 v56, v56, v82
    v_mul_f32 v57, v57, v82
    v_mul_f32 v58, v58, v82
    v_mul_f32 v59, v59, v82
    v_mul_f32 v60, v60, v82
    v_mul_f32 v61, v61, v82
    v_mul_f32 v62, v62, v82
    v_mul_f32 v63, v63, v82
    v_mul_f32 v64, v64, v82
    v_mul_f32 v65, v65, v82
    v_mul_f32 v66, v66, v82
    v_mul_f32 v67, v67, v82
    v_mul_f32 v68, v68, v82
    v_mul_f32 v69, v69, v82
    v_mul_f32 v70, v70, v82
    v_mul_f32 v71, v71, v82
    v_cvt_pk_bf16_f32 v18, v56, v57
    v_lshlrev_b32 v56, 16, v18
    v_and_b32 v57, 0xffff0000, v18
    v_cvt_pk_bf16_f32 v19, v58, v59
    v_lshlrev_b32 v58, 16, v19
    v_and_b32 v59, 0xffff0000, v19
    v_cvt_pk_bf16_f32 v18, v60, v61
    v_lshlrev_b32 v60, 16, v18
    v_and_b32 v61, 0xffff0000, v18
    v_cvt_pk_bf16_f32 v19, v62, v63
    v_lshlrev_b32 v62, 16, v19
    v_and_b32 v63, 0xffff0000, v19
    v_cvt_pk_bf16_f32 v18, v64, v65
    v_lshlrev_b32 v64, 16, v18
    v_and_b32 v65, 0xffff0000, v18
    v_cvt_pk_bf16_f32 v19, v66, v67
    v_lshlrev_b32 v66, 16, v19
    v_and_b32 v67, 0xffff0000, v19
    v_cvt_pk_bf16_f32 v18, v68, v69
    v_lshlrev_b32 v68, 16, v18
    v_and_b32 v69, 0xffff0000, v18
    v_cvt_pk_bf16_f32 v19, v70, v71
    v_lshlrev_b32 v70, 16, v19
    v_and_b32 v71, 0xffff0000, v19
    s_lshl_b32 s16, s29, 15
    s_lshl_b32 s17, s31, 11
    s_add_u32 s16, s16, s17
    s_waitcnt lgkmcnt(0)
    s_barrier
    s_cmp_lt_u32 s24, 8
    s_cbranch_scc1 adaLN_cond__sliding_block_cached__moe_arch_mod__prompt_kernel_kvS
    v_lshl_or_b32 v84, v89, 16, v88
    v_lshl_or_b32 v85, v91, 16, v90
    v_lshl_or_b32 v86, v93, 16, v92
    v_lshl_or_b32 v87, v95, 16, v94
    v_and_b32 v88, 0x7fff, v88
    v_and_b32 v89, 0x7fff, v89
    v_and_b32 v90, 0x7fff, v90
    v_and_b32 v91, 0x7fff, v91
    v_and_b32 v92, 0x7fff, v92
    v_and_b32 v93, 0x7fff, v93
    v_and_b32 v94, 0x7fff, v94
    v_and_b32 v95, 0x7fff, v95
    v_max3_u32 v88, v88, v89, v90
    v_max3_u32 v91, v91, v92, v93
    v_max3_u32 v88, v88, v94, v95
    v_max_u32 v88, v88, v91
    v_cmp_le_u32 vcc, 0x4980, v88
    v_mov_b32 v89, s28
    s_mov_b32 s26, 0x564000
    s_and_saveexec_b64 s[62:63], vcc
    buffer_store_dword v89, v132, s[8:11], s26 offen sc1
    s_mov_b64 exec, s[62:63]
adaLN_cond__sliding_block_cached__moe_arch_mod__prompt_kernel_kvS:
    buffer_store_dwordx4 v[84:87], v2, s[8:11], s21 offen sc1
    ds_read_b128 v[96:99], v17 offset:256
    ds_read_b128 v[104:107], v17 offset:0
    ds_read_b128 v[100:103], v17 offset:272
    ds_read_b128 v[108:111], v17 offset:16
    ds_read_b128 v[112:115], v17 offset:384
    ds_read_b128 v[120:123], v17 offset:128
    ds_read_b128 v[116:119], v17 offset:400
    ds_read_b128 v[124:127], v17 offset:144
    s_waitcnt lgkmcnt(7)
    v_pk_mul_f32 v[56:57], v[56:57], v[96:97]
    v_pk_mul_f32 v[58:59], v[58:59], v[98:99]
    s_waitcnt lgkmcnt(5)
    v_pk_mul_f32 v[60:61], v[60:61], v[100:101]
    v_pk_mul_f32 v[62:63], v[62:63], v[102:103]
    v_cvt_pk_bf16_f32 v18, v56, v57
    v_lshlrev_b32 v56, 16, v18
    v_and_b32 v57, 0xffff0000, v18
    v_cvt_pk_bf16_f32 v19, v58, v59
    v_lshlrev_b32 v58, 16, v19
    v_and_b32 v59, 0xffff0000, v19
    v_cvt_pk_bf16_f32 v18, v60, v61
    v_lshlrev_b32 v60, 16, v18
    v_and_b32 v61, 0xffff0000, v18
    v_cvt_pk_bf16_f32 v19, v62, v63
    v_lshlrev_b32 v62, 16, v19
    v_and_b32 v63, 0xffff0000, v19
    v_pk_add_f32 v[56:57], v[56:57], v[104:105]
    v_pk_add_f32 v[58:59], v[58:59], v[106:107]
    s_waitcnt lgkmcnt(4)
    v_pk_add_f32 v[60:61], v[60:61], v[108:109]
    v_pk_add_f32 v[62:63], v[62:63], v[110:111]
    v_cvt_pk_bf16_f32 v32, v56, v57
    v_cvt_pk_bf16_f32 v33, v58, v59
    v_cvt_pk_bf16_f32 v34, v60, v61
    v_cvt_pk_bf16_f32 v35, v62, v63
    buffer_store_dwordx4 v[32:35], v2, s[8:11], s16 offen offset:0 sc1
    s_waitcnt lgkmcnt(3)
    v_pk_mul_f32 v[64:65], v[64:65], v[112:113]
    v_pk_mul_f32 v[66:67], v[66:67], v[114:115]
    s_waitcnt lgkmcnt(1)
    v_pk_mul_f32 v[68:69], v[68:69], v[116:117]
    v_pk_mul_f32 v[70:71], v[70:71], v[118:119]
    v_cvt_pk_bf16_f32 v18, v64, v65
    v_lshlrev_b32 v64, 16, v18
    v_and_b32 v65, 0xffff0000, v18
    v_cvt_pk_bf16_f32 v19, v66, v67
    v_lshlrev_b32 v66, 16, v19
    v_and_b32 v67, 0xffff0000, v19
    v_cvt_pk_bf16_f32 v18, v68, v69
    v_lshlrev_b32 v68, 16, v18
    v_and_b32 v69, 0xffff0000, v18
    v_cvt_pk_bf16_f32 v19, v70, v71
    v_lshlrev_b32 v70, 16, v19
    v_and_b32 v71, 0xffff0000, v19
    v_pk_add_f32 v[64:65], v[64:65], v[120:121]
    v_pk_add_f32 v[66:67], v[66:67], v[122:123]
    s_waitcnt lgkmcnt(0)
    v_pk_add_f32 v[68:69], v[68:69], v[124:125]
    v_pk_add_f32 v[70:71], v[70:71], v[126:127]
    v_cvt_pk_bf16_f32 v36, v64, v65
    v_cvt_pk_bf16_f32 v37, v66, v67
    v_cvt_pk_bf16_f32 v38, v68, v69
    v_cvt_pk_bf16_f32 v39, v70, v71
    buffer_store_dwordx4 v[36:39], v2, s[8:11], s16 offen offset:1024 sc1
    s_lshl_b32 s19, s3, 16
    s_lshl_b32 s20, s3, 11
    s_lshl_b32 s16, s12, 8
    s_add_u32 s4, s38, s16
    s_addc_u32 s5, s39, 0
    s_sub_u32 s6, 0x800000, s16
    s_mov_b32 s7, 0x20000
    s_barrier
    s_add_u32 s22, s19, 0x0
    s_add_u32 m0, s20, 0x0
    s_nop 0
    buffer_load_dwordx4 v3, s[4:7], s22 offen lds
    s_add_u32 s22, s19, 0x8000
    s_add_u32 m0, s20, 0x400
    s_nop 0
    buffer_load_dwordx4 v3, s[4:7], s22 offen lds
    s_add_u32 s22, s19, 0x80000
    s_add_u32 m0, s20, 0x4000
    s_nop 0
    buffer_load_dwordx4 v3, s[4:7], s22 offen lds
    s_add_u32 s22, s19, 0x88000
    s_add_u32 m0, s20, 0x4400
    s_nop 0
    buffer_load_dwordx4 v3, s[4:7], s22 offen lds
    s_add_u32 s22, s19, 0x100000
    s_add_u32 m0, s20, 0x8000
    s_nop 0
    buffer_load_dwordx4 v3, s[4:7], s22 offen lds
    s_add_u32 s22, s19, 0x108000
    s_add_u32 m0, s20, 0x8400
    s_nop 0
    buffer_load_dwordx4 v3, s[4:7], s22 offen lds
    v_mov_b32 v134, s28
    s_lshl_b32 s16, s29, 4
    s_add_u32 s16, s16, s31
    s_lshl_b32 s16, s16, 2
    s_add_u32 s16, s16, 0x528000
    v_and_b32 v16, 31, v1
    v_lshlrev_b32 v16, 2, v16
    s_lshl_b32 s17, s13, 3
    s_add_u32 s17, s17, s3
    s_lshl_b32 s17, s17, 7
    s_add_u32 s17, s17, 0x528000
    s_waitcnt vmcnt(6)
    s_mov_b64 exec, 1
    buffer_store_dword v134, v132, s[8:11], s16 offen sc1
    s_mov_b64 exec, -1
    s_waitcnt vmcnt(0)
    s_mov_b32 s27, 0
adaLN_cond__sliding_block_cached__moe_arch_mod__prompt_kernel_h15p:
    buffer_load_dword v17, v16, s[8:11], s17 offen sc1
    s_waitcnt vmcnt(0)
    v_cmp_ne_u32 vcc, s28, v17
    s_add_u32 s27, s27, 1
    s_cmp_ge_u32 s27, 65536
    s_cbranch_scc1 adaLN_cond__sliding_block_cached__moe_arch_mod__prompt_kernel_h15g
    s_cbranch_vccnz adaLN_cond__sliding_block_cached__moe_arch_mod__prompt_kernel_h15p
adaLN_cond__sliding_block_cached__moe_arch_mod__prompt_kernel_h15g:
    s_mov_b32 s23, 0x0
    buffer_load_dwordx4 v[88:91], v7, s[8:11], s23 offen offset:0 sc1
    s_mov_b32 s23, 0x8000
    buffer_load_dwordx4 v[92:95], v7, s[8:11], s23 offen offset:0 sc1
    s_mov_b32 s23, 0x0
    buffer_load_dwordx4 v[96:99], v7, s[8:11], s23 offen offset:1024 sc1
    s_mov_b32 s23, 0x8000
    buffer_load_dwordx4 v[100:103], v7, s[8:11], s23 offen offset:1024 sc1
    s_mov_b32 s23, 0x800
    buffer_load_dwordx4 v[104:107], v7, s[8:11], s23 offen offset:0 sc1
    s_mov_b32 s23, 0x8800
    buffer_load_dwordx4 v[108:111], v7, s[8:11], s23 offen offset:0 sc1
    s_mov_b32 s23, 0x800
    buffer_load_dwordx4 v[112:115], v7, s[8:11], s23 offen offset:1024 sc1
    s_mov_b32 s23, 0x8800
    buffer_load_dwordx4 v[116:119], v7, s[8:11], s23 offen offset:1024 sc1
    s_mov_b32 s23, 0x1000
    buffer_load_dwordx4 v[120:123], v7, s[8:11], s23 offen offset:0 sc1
    s_mov_b32 s23, 0x9000
    buffer_load_dwordx4 v[124:127], v7, s[8:11], s23 offen offset:0 sc1
    s_mov_b32 s23, 0x1000
    buffer_load_dwordx4 v[128:131], v7, s[8:11], s23 offen offset:1024 sc1
    s_mov_b32 s23, 0x9000
    buffer_load_dwordx4 v[132:135], v7, s[8:11], s23 offen offset:1024 sc1
    s_lshr_b32 s21, s12, 3
    s_lshl_b32 s21, s21, 17
    s_add_u32 s21, s21, s20
    s_add_u32 s21, s21, 0x400000
    s_barrier
    ds_read_b64_tr_b16 v[224:225], v4 offset:0
    ds_read_b64_tr_b16 v[226:227], v4 offset:1024
    ds_read_b64_tr_b16 v[228:229], v5 offset:32
    ds_read_b64_tr_b16 v[230:231], v5 offset:1056
    ds_read_b64_tr_b16 v[232:233], v4 offset:256
    ds_read_b64_tr_b16 v[234:235], v4 offset:1280
    s_waitcnt vmcnt(11) lgkmcnt(4)
    v_mfma_f32_16x16x32_bf16 v[24:27], v[224:227], v[88:91], 0
    ds_read_b64_tr_b16 v[236:237], v5 offset:288
    s_waitcnt vmcnt(10)
    v_mfma_f32_16x16x32_bf16 v[28:31], v[224:227], v[92:95], 0
    ds_read_b64_tr_b16 v[238:239], v5 offset:1312
    s_waitcnt lgkmcnt(4)
    v_mfma_f32_16x16x32_bf16 v[32:35], v[228:231], v[88:91], 0
    ds_read_b64_tr_b16 v[240:241], v4 offset:512
    v_mfma_f32_16x16x32_bf16 v[36:39], v[228:231], v[92:95], 0
    ds_read_b64_tr_b16 v[242:243], v4 offset:1536
    s_mov_b32 s23, 0x1800
    buffer_load_dwordx4 v[136:139], v7, s[8:11], s23 offen offset:0 sc1
    s_waitcnt lgkmcnt(4)
    v_mfma_f32_16x16x32_bf16 v[40:43], v[232:235], v[88:91], 0
    ds_read_b64_tr_b16 v[244:245], v5 offset:544
    v_mfma_f32_16x16x32_bf16 v[44:47], v[232:235], v[92:95], 0
    ds_read_b64_tr_b16 v[246:247], v5 offset:1568
    s_waitcnt lgkmcnt(4)
    v_mfma_f32_16x16x32_bf16 v[48:51], v[236:239], v[88:91], 0
    ds_read_b64_tr_b16 v[224:225], v4 offset:768
    v_mfma_f32_16x16x32_bf16 v[52:55], v[236:239], v[92:95], 0
    ds_read_b64_tr_b16 v[226:227], v4 offset:1792
    s_waitcnt lgkmcnt(4)
    v_mfma_f32_16x16x32_bf16 v[56:59], v[240:243], v[88:91], 0
    ds_read_b64_tr_b16 v[228:229], v5 offset:800
    v_mfma_f32_16x16x32_bf16 v[60:63], v[240:243], v[92:95], 0
    ds_read_b64_tr_b16 v[230:231], v5 offset:1824
    s_waitcnt lgkmcnt(4)
    v_mfma_f32_16x16x32_bf16 v[64:67], v[244:247], v[88:91], 0
    ds_read_b64_tr_b16 v[232:233], v4 offset:8192
    v_mfma_f32_16x16x32_bf16 v[68:71], v[244:247], v[92:95], 0
    ds_read_b64_tr_b16 v[234:235], v4 offset:9216
    s_mov_b32 s23, 0x9800
    buffer_load_dwordx4 v[140:143], v7, s[8:11], s23 offen offset:0 sc1
    s_waitcnt lgkmcnt(4)
    v_mfma_f32_16x16x32_bf16 v[72:75], v[224:227], v[88:91], 0
    ds_read_b64_tr_b16 v[236:237], v5 offset:8224
    v_mfma_f32_16x16x32_bf16 v[76:79], v[224:227], v[92:95], 0
    ds_read_b64_tr_b16 v[238:239], v5 offset:9248
    s_waitcnt lgkmcnt(4)
    v_mfma_f32_16x16x32_bf16 v[80:83], v[228:231], v[88:91], 0
    ds_read_b64_tr_b16 v[240:241], v4 offset:8448
    v_mfma_f32_16x16x32_bf16 v[84:87], v[228:231], v[92:95], 0
    ds_read_b64_tr_b16 v[242:243], v4 offset:9472
    s_waitcnt vmcnt(11) lgkmcnt(4)
    v_mfma_f32_16x16x32_bf16 v[24:27], v[232:235], v[96:99], v[24:27]
    ds_read_b64_tr_b16 v[244:245], v5 offset:8480
    s_waitcnt vmcnt(10)
    v_mfma_f32_16x16x32_bf16 v[28:31], v[232:235], v[100:103], v[28:31]
    ds_read_b64_tr_b16 v[246:247], v5 offset:9504
    s_waitcnt lgkmcnt(4)
    v_mfma_f32_16x16x32_bf16 v[32:35], v[236:239], v[96:99], v[32:35]
    ds_read_b64_tr_b16 v[224:225], v4 offset:8704
    v_mfma_f32_16x16x32_bf16 v[36:39], v[236:239], v[100:103], v[36:39]
    ds_read_b64_tr_b16 v[226:227], v4 offset:9728
    s_mov_b32 s23, 0x1800
    buffer_load_dwordx4 v[144:147], v7, s[8:11], s23 offen offset:1024 sc1
    s_waitcnt lgkmcnt(4)
    v_mfma_f32_16x16x32_bf16 v[40:43], v[240:243], v[96:99], v[40:43]
    ds_read_b64_tr_b16 v[228:229], v5 offset:8736
    v_mfma_f32_16x16x32_bf16 v[44:47], v[240:243], v[100:103], v[44:47]
    ds_read_b64_tr_b16 v[230:231], v5 offset:9760
    s_waitcnt lgkmcnt(4)
    v_mfma_f32_16x16x32_bf16 v[48:51], v[244:247], v[96:99], v[48:51]
    ds_read_b64_tr_b16 v[232:233], v4 offset:8960
    v_mfma_f32_16x16x32_bf16 v[52:55], v[244:247], v[100:103], v[52:55]
    ds_read_b64_tr_b16 v[234:235], v4 offset:9984
    s_waitcnt lgkmcnt(4)
    v_mfma_f32_16x16x32_bf16 v[56:59], v[224:227], v[96:99], v[56:59]
    ds_read_b64_tr_b16 v[236:237], v5 offset:8992
    v_mfma_f32_16x16x32_bf16 v[60:63], v[224:227], v[100:103], v[60:63]
    ds_read_b64_tr_b16 v[238:239], v5 offset:10016
    s_waitcnt lgkmcnt(4)
    v_mfma_f32_16x16x32_bf16 v[64:67], v[228:231], v[96:99], v[64:67]
    v_mfma_f32_16x16x32_bf16 v[68:71], v[228:231], v[100:103], v[68:71]
    s_barrier
    ds_read_b64_tr_b16 v[240:241], v4 offset:16384
    ds_read_b64_tr_b16 v[242:243], v4 offset:17408
    s_mov_b32 s23, 0x9800
    buffer_load_dwordx4 v[148:151], v7, s[8:11], s23 offen offset:1024 sc1
    s_waitcnt lgkmcnt(4)
    v_mfma_f32_16x16x32_bf16 v[72:75], v[232:235], v[96:99], v[72:75]
    ds_read_b64_tr_b16 v[244:245], v5 offset:16416
    v_mfma_f32_16x16x32_bf16 v[76:79], v[232:235], v[100:103], v[76:79]
    s_add_u32 s22, s19, 0x180000
    s_add_u32 m0, s20, 0xc000
    s_nop 0
    buffer_load_dwordx4 v3, s[4:7], s22 offen lds
    ds_read_b64_tr_b16 v[246:247], v5 offset:17440
    s_waitcnt lgkmcnt(4)
    v_mfma_f32_16x16x32_bf16 v[80:83], v[236:239], v[96:99], v[80:83]
    ds_read_b64_tr_b16 v[224:225], v4 offset:16640
    v_mfma_f32_16x16x32_bf16 v[84:87], v[236:239], v[100:103], v[84:87]
    ds_read_b64_tr_b16 v[226:227], v4 offset:17664
    s_waitcnt vmcnt(12) lgkmcnt(4)
    v_mfma_f32_16x16x32_bf16 v[24:27], v[240:243], v[104:107], v[24:27]
    ds_read_b64_tr_b16 v[228:229], v5 offset:16672
    s_waitcnt vmcnt(11)
    v_mfma_f32_16x16x32_bf16 v[28:31], v[240:243], v[108:111], v[28:31]
    ds_read_b64_tr_b16 v[230:231], v5 offset:17696
    s_waitcnt lgkmcnt(4)
    v_mfma_f32_16x16x32_bf16 v[32:35], v[244:247], v[104:107], v[32:35]
    ds_read_b64_tr_b16 v[232:233], v4 offset:16896
    v_mfma_f32_16x16x32_bf16 v[36:39], v[244:247], v[108:111], v[36:39]
    ds_read_b64_tr_b16 v[234:235], v4 offset:17920
    s_mov_b32 s23, 0x2000
    buffer_load_dwordx4 v[88:91], v7, s[8:11], s23 offen offset:0 sc1
    s_waitcnt lgkmcnt(4)
    v_mfma_f32_16x16x32_bf16 v[40:43], v[224:227], v[104:107], v[40:43]
    ds_read_b64_tr_b16 v[236:237], v5 offset:16928
    v_mfma_f32_16x16x32_bf16 v[44:47], v[224:227], v[108:111], v[44:47]
    s_add_u32 s22, s19, 0x188000
    s_add_u32 m0, s20, 0xc400
    s_nop 0
    buffer_load_dwordx4 v3, s[4:7], s22 offen lds
    ds_read_b64_tr_b16 v[238:239], v5 offset:17952
    s_waitcnt lgkmcnt(4)
    v_mfma_f32_16x16x32_bf16 v[48:51], v[228:231], v[104:107], v[48:51]
    ds_read_b64_tr_b16 v[240:241], v4 offset:17152
    v_mfma_f32_16x16x32_bf16 v[52:55], v[228:231], v[108:111], v[52:55]
    ds_read_b64_tr_b16 v[242:243], v4 offset:18176
    s_waitcnt lgkmcnt(4)
    v_mfma_f32_16x16x32_bf16 v[56:59], v[232:235], v[104:107], v[56:59]
    ds_read_b64_tr_b16 v[244:245], v5 offset:17184
    v_mfma_f32_16x16x32_bf16 v[60:63], v[232:235], v[108:111], v[60:63]
    ds_read_b64_tr_b16 v[246:247], v5 offset:18208
    s_waitcnt lgkmcnt(4)
    v_mfma_f32_16x16x32_bf16 v[64:67], v[236:239], v[104:107], v[64:67]
    ds_read_b64_tr_b16 v[224:225], v4 offset:24576
    v_mfma_f32_16x16x32_bf16 v[68:71], v[236:239], v[108:111], v[68:71]
    ds_read_b64_tr_b16 v[226:227], v4 offset:25600
    s_mov_b32 s23, 0xa000
    buffer_load_dwordx4 v[92:95], v7, s[8:11], s23 offen offset:0 sc1
    s_waitcnt lgkmcnt(4)
    v_mfma_f32_16x16x32_bf16 v[72:75], v[240:243], v[104:107], v[72:75]
    ds_read_b64_tr_b16 v[228:229], v5 offset:24608
    v_mfma_f32_16x16x32_bf16 v[76:79], v[240:243], v[108:111], v[76:79]
    ds_read_b64_tr_b16 v[230:231], v5 offset:25632
    s_waitcnt lgkmcnt(4)
    v_mfma_f32_16x16x32_bf16 v[80:83], v[244:247], v[104:107], v[80:83]
    ds_read_b64_tr_b16 v[232:233], v4 offset:24832
    v_mfma_f32_16x16x32_bf16 v[84:87], v[244:247], v[108:111], v[84:87]
    ds_read_b64_tr_b16 v[234:235], v4 offset:25856
    s_waitcnt vmcnt(13) lgkmcnt(4)
    v_mfma_f32_16x16x32_bf16 v[24:27], v[224:227], v[112:115], v[24:27]
    ds_read_b64_tr_b16 v[236:237], v5 offset:24864
    s_waitcnt vmcnt(12)
    v_mfma_f32_16x16x32_bf16 v[28:31], v[224:227], v[116:119], v[28:31]
    ds_read_b64_tr_b16 v[238:239], v5 offset:25888
    s_waitcnt lgkmcnt(4)
    v_mfma_f32_16x16x32_bf16 v[32:35], v[228:231], v[112:115], v[32:35]
    ds_read_b64_tr_b16 v[240:241], v4 offset:25088
    v_mfma_f32_16x16x32_bf16 v[36:39], v[228:231], v[116:119], v[36:39]
    ds_read_b64_tr_b16 v[242:243], v4 offset:26112
    s_mov_b32 s23, 0x2000
    buffer_load_dwordx4 v[96:99], v7, s[8:11], s23 offen offset:1024 sc1
    s_waitcnt lgkmcnt(4)
    v_mfma_f32_16x16x32_bf16 v[40:43], v[232:235], v[112:115], v[40:43]
    ds_read_b64_tr_b16 v[244:245], v5 offset:25120
    v_mfma_f32_16x16x32_bf16 v[44:47], v[232:235], v[116:119], v[44:47]
    ds_read_b64_tr_b16 v[246:247], v5 offset:26144
    s_waitcnt lgkmcnt(4)
    v_mfma_f32_16x16x32_bf16 v[48:51], v[236:239], v[112:115], v[48:51]
    ds_read_b64_tr_b16 v[224:225], v4 offset:25344
    v_mfma_f32_16x16x32_bf16 v[52:55], v[236:239], v[116:119], v[52:55]
    ds_read_b64_tr_b16 v[226:227], v4 offset:26368
    s_waitcnt lgkmcnt(4)
    v_mfma_f32_16x16x32_bf16 v[56:59], v[240:243], v[112:115], v[56:59]
    ds_read_b64_tr_b16 v[228:229], v5 offset:25376
    v_mfma_f32_16x16x32_bf16 v[60:63], v[240:243], v[116:119], v[60:63]
    ds_read_b64_tr_b16 v[230:231], v5 offset:26400
    s_waitcnt lgkmcnt(4)
    v_mfma_f32_16x16x32_bf16 v[64:67], v[244:247], v[112:115], v[64:67]
    v_mfma_f32_16x16x32_bf16 v[68:71], v[244:247], v[116:119], v[68:71]
    s_barrier
    ds_read_b64_tr_b16 v[232:233], v4 offset:32768
    ds_read_b64_tr_b16 v[234:235], v4 offset:33792
    s_mov_b32 s23, 0xa000
    buffer_load_dwordx4 v[100:103], v7, s[8:11], s23 offen offset:1024 sc1
    s_waitcnt lgkmcnt(4)
    v_mfma_f32_16x16x32_bf16 v[72:75], v[224:227], v[112:115], v[72:75]
    ds_read_b64_tr_b16 v[236:237], v5 offset:32800
    v_mfma_f32_16x16x32_bf16 v[76:79], v[224:227], v[116:119], v[76:79]
    s_add_u32 s22, s19, 0x200000
    s_add_u32 m0, s20, 0x0
    s_nop 0
    buffer_load_dwordx4 v3, s[4:7], s22 offen lds
    ds_read_b64_tr_b16 v[238:239], v5 offset:33824
    s_waitcnt lgkmcnt(4)
    v_mfma_f32_16x16x32_bf16 v[80:83], v[228:231], v[112:115], v[80:83]
    ds_read_b64_tr_b16 v[240:241], v4 offset:33024
    v_mfma_f32_16x16x32_bf16 v[84:87], v[228:231], v[116:119], v[84:87]
    ds_read_b64_tr_b16 v[242:243], v4 offset:34048
    s_waitcnt vmcnt(14) lgkmcnt(4)
    v_mfma_f32_16x16x32_bf16 v[24:27], v[232:235], v[120:123], v[24:27]
    ds_read_b64_tr_b16 v[244:245], v5 offset:33056
    s_waitcnt vmcnt(13)
    v_mfma_f32_16x16x32_bf16 v[28:31], v[232:235], v[124:127], v[28:31]
    ds_read_b64_tr_b16 v[246:247], v5 offset:34080
    s_waitcnt lgkmcnt(4)
    v_mfma_f32_16x16x32_bf16 v[32:35], v[236:239], v[120:123], v[32:35]
    ds_read_b64_tr_b16 v[224:225], v4 offset:33280
    v_mfma_f32_16x16x32_bf16 v[36:39], v[236:239], v[124:127], v[36:39]
    ds_read_b64_tr_b16 v[226:227], v4 offset:34304
    s_mov_b32 s23, 0x2800
    buffer_load_dwordx4 v[104:107], v7, s[8:11], s23 offen offset:0 sc1
    s_waitcnt lgkmcnt(4)
    v_mfma_f32_16x16x32_bf16 v[40:43], v[240:243], v[120:123], v[40:43]
    ds_read_b64_tr_b16 v[228:229], v5 offset:33312
    v_mfma_f32_16x16x32_bf16 v[44:47], v[240:243], v[124:127], v[44:47]
    s_add_u32 s22, s19, 0x208000
    s_add_u32 m0, s20, 0x400
    s_nop 0
    buffer_load_dwordx4 v3, s[4:7], s22 offen lds
    ds_read_b64_tr_b16 v[230:231], v5 offset:34336
    s_waitcnt lgkmcnt(4)
    v_mfma_f32_16x16x32_bf16 v[48:51], v[244:247], v[120:123], v[48:51]
    ds_read_b64_tr_b16 v[232:233], v4 offset:33536
    v_mfma_f32_16x16x32_bf16 v[52:55], v[244:247], v[124:127], v[52:55]
    ds_read_b64_tr_b16 v[234:235], v4 offset:34560
    s_waitcnt lgkmcnt(4)
    v_mfma_f32_16x16x32_bf16 v[56:59], v[224:227], v[120:123], v[56:59]
    ds_read_b64_tr_b16 v[236:237], v5 offset:33568
    v_mfma_f32_16x16x32_bf16 v[60:63], v[224:227], v[124:127], v[60:63]
    ds_read_b64_tr_b16 v[238:239], v5 offset:34592
    s_waitcnt lgkmcnt(4)
    v_mfma_f32_16x16x32_bf16 v[64:67], v[228:231], v[120:123], v[64:67]
    ds_read_b64_tr_b16 v[240:241], v4 offset:40960
    v_mfma_f32_16x16x32_bf16 v[68:71], v[228:231], v[124:127], v[68:71]
    ds_read_b64_tr_b16 v[242:243], v4 offset:41984
    s_mov_b32 s23, 0xa800
    buffer_load_dwordx4 v[108:111], v7, s[8:11], s23 offen offset:0 sc1
    s_waitcnt lgkmcnt(4)
    v_mfma_f32_16x16x32_bf16 v[72:75], v[232:235], v[120:123], v[72:75]
    ds_read_b64_tr_b16 v[244:245], v5 offset:40992
    v_mfma_f32_16x16x32_bf16 v[76:79], v[232:235], v[124:127], v[76:79]
    ds_read_b64_tr_b16 v[246:247], v5 offset:42016
    s_waitcnt lgkmcnt(4)
    v_mfma_f32_16x16x32_bf16 v[80:83], v[236:239], v[120:123], v[80:83]
    ds_read_b64_tr_b16 v[224:225], v4 offset:41216
    v_mfma_f32_16x16x32_bf16 v[84:87], v[236:239], v[124:127], v[84:87]
    ds_read_b64_tr_b16 v[226:227], v4 offset:42240
    s_waitcnt vmcnt(15) lgkmcnt(4)
    v_mfma_f32_16x16x32_bf16 v[24:27], v[240:243], v[128:131], v[24:27]
    ds_read_b64_tr_b16 v[228:229], v5 offset:41248
    s_waitcnt vmcnt(14)
    v_mfma_f32_16x16x32_bf16 v[28:31], v[240:243], v[132:135], v[28:31]
    ds_read_b64_tr_b16 v[230:231], v5 offset:42272
    s_waitcnt lgkmcnt(4)
    v_mfma_f32_16x16x32_bf16 v[32:35], v[244:247], v[128:131], v[32:35]
    ds_read_b64_tr_b16 v[232:233], v4 offset:41472
    v_mfma_f32_16x16x32_bf16 v[36:39], v[244:247], v[132:135], v[36:39]
    ds_read_b64_tr_b16 v[234:235], v4 offset:42496
    s_mov_b32 s23, 0x2800
    buffer_load_dwordx4 v[112:115], v7, s[8:11], s23 offen offset:1024 sc1
    s_waitcnt lgkmcnt(4)
    v_mfma_f32_16x16x32_bf16 v[40:43], v[224:227], v[128:131], v[40:43]
    ds_read_b64_tr_b16 v[236:237], v5 offset:41504
    v_mfma_f32_16x16x32_bf16 v[44:47], v[224:227], v[132:135], v[44:47]
    ds_read_b64_tr_b16 v[238:239], v5 offset:42528
    s_waitcnt lgkmcnt(4)
    v_mfma_f32_16x16x32_bf16 v[48:51], v[228:231], v[128:131], v[48:51]
    ds_read_b64_tr_b16 v[240:241], v4 offset:41728
    v_mfma_f32_16x16x32_bf16 v[52:55], v[228:231], v[132:135], v[52:55]
    ds_read_b64_tr_b16 v[242:243], v4 offset:42752
    s_waitcnt lgkmcnt(4)
    v_mfma_f32_16x16x32_bf16 v[56:59], v[232:235], v[128:131], v[56:59]
    ds_read_b64_tr_b16 v[244:245], v5 offset:41760
    v_mfma_f32_16x16x32_bf16 v[60:63], v[232:235], v[132:135], v[60:63]
    ds_read_b64_tr_b16 v[246:247], v5 offset:42784
    s_waitcnt lgkmcnt(4)
    v_mfma_f32_16x16x32_bf16 v[64:67], v[236:239], v[128:131], v[64:67]
    v_mfma_f32_16x16x32_bf16 v[68:71], v[236:239], v[132:135], v[68:71]
    s_waitcnt vmcnt(8)
    s_barrier
    ds_read_b64_tr_b16 v[224:225], v4 offset:49152
    ds_read_b64_tr_b16 v[226:227], v4 offset:50176
    s_mov_b32 s23, 0xa800
    buffer_load_dwordx4 v[116:119], v7, s[8:11], s23 offen offset:1024 sc1
    s_waitcnt lgkmcnt(4)
    v_mfma_f32_16x16x32_bf16 v[72:75], v[240:243], v[128:131], v[72:75]
    ds_read_b64_tr_b16 v[228:229], v5 offset:49184
    v_mfma_f32_16x16x32_bf16 v[76:79], v[240:243], v[132:135], v[76:79]
    s_add_u32 s22, s19, 0x280000
    s_add_u32 m0, s20, 0x4000
    s_nop 0
    buffer_load_dwordx4 v3, s[4:7], s22 offen lds
    ds_read_b64_tr_b16 v[230:231], v5 offset:50208
    s_waitcnt lgkmcnt(4)
    v_mfma_f32_16x16x32_bf16 v[80:83], v[244:247], v[128:131], v[80:83]
    ds_read_b64_tr_b16 v[232:233], v4 offset:49408
    v_mfma_f32_16x16x32_bf16 v[84:87], v[244:247], v[132:135], v[84:87]
    ds_read_b64_tr_b16 v[234:235], v4 offset:50432
    s_waitcnt lgkmcnt(4)
    v_mfma_f32_16x16x32_bf16 v[24:27], v[224:227], v[136:139], v[24:27]
    ds_read_b64_tr_b16 v[236:237], v5 offset:49440
    v_mfma_f32_16x16x32_bf16 v[28:31], v[224:227], v[140:143], v[28:31]
    ds_read_b64_tr_b16 v[238:239], v5 offset:50464
    s_waitcnt lgkmcnt(4)
    v_mfma_f32_16x16x32_bf16 v[32:35], v[228:231], v[136:139], v[32:35]
    ds_read_b64_tr_b16 v[240:241], v4 offset:49664
    v_mfma_f32_16x16x32_bf16 v[36:39], v[228:231], v[140:143], v[36:39]
    ds_read_b64_tr_b16 v[242:243], v4 offset:50688
    s_mov_b32 s23, 0x3000
    buffer_load_dwordx4 v[120:123], v7, s[8:11], s23 offen offset:0 sc1
    s_waitcnt lgkmcnt(4)
    v_mfma_f32_16x16x32_bf16 v[40:43], v[232:235], v[136:139], v[40:43]
    ds_read_b64_tr_b16 v[244:245], v5 offset:49696
    v_mfma_f32_16x16x32_bf16 v[44:47], v[232:235], v[140:143], v[44:47]
    s_add_u32 s22, s19, 0x288000
    s_add_u32 m0, s20, 0x4400
    s_nop 0
    buffer_load_dwordx4 v3, s[4:7], s22 offen lds
    ds_read_b64_tr_b16 v[246:247], v5 offset:50720
    s_waitcnt lgkmcnt(4)
    v_mfma_f32_16x16x32_bf16 v[48:51], v[236:239], v[136:139], v[48:51]
    ds_read_b64_tr_b16 v[224:225], v4 offset:49920
    v_mfma_f32_16x16x32_bf16 v[52:55], v[236:239], v[140:143], v[52:55]
    ds_read_b64_tr_b16 v[226:227], v4 offset:50944
    s_waitcnt lgkmcnt(4)
    v_mfma_f32_16x16x32_bf16 v[56:59], v[240:243], v[136:139], v[56:59]
    ds_read_b64_tr_b16 v[228:229], v5 offset:49952
    v_mfma_f32_16x16x32_bf16 v[60:63], v[240:243], v[140:143], v[60:63]
    ds_read_b64_tr_b16 v[230:231], v5 offset:50976
    s_waitcnt lgkmcnt(4)
    v_mfma_f32_16x16x32_bf16 v[64:67], v[244:247], v[136:139], v[64:67]
    ds_read_b64_tr_b16 v[232:233], v4 offset:57344
    v_mfma_f32_16x16x32_bf16 v[68:71], v[244:247], v[140:143], v[68:71]
    ds_read_b64_tr_b16 v[234:235], v4 offset:58368
    s_mov_b32 s23, 0xb000
    buffer_load_dwordx4 v[124:127], v7, s[8:11], s23 offen offset:0 sc1
    s_waitcnt lgkmcnt(4)
    v_mfma_f32_16x16x32_bf16 v[72:75], v[224:227], v[136:139], v[72:75]
    ds_read_b64_tr_b16 v[236:237], v5 offset:57376
    v_mfma_f32_16x16x32_bf16 v[76:79], v[224:227], v[140:143], v[76:79]
    ds_read_b64_tr_b16 v[238:239], v5 offset:58400
    s_waitcnt lgkmcnt(4)
    v_mfma_f32_16x16x32_bf16 v[80:83], v[228:231], v[136:139], v[80:83]
    ds_read_b64_tr_b16 v[240:241], v4 offset:57600
    v_mfma_f32_16x16x32_bf16 v[84:87], v[228:231], v[140:143], v[84:87]
    ds_read_b64_tr_b16 v[242:243], v4 offset:58624
    s_waitcnt lgkmcnt(4)
    v_mfma_f32_16x16x32_bf16 v[24:27], v[232:235], v[144:147], v[24:27]
    ds_read_b64_tr_b16 v[244:245], v5 offset:57632
    v_mfma_f32_16x16x32_bf16 v[28:31], v[232:235], v[148:151], v[28:31]
    ds_read_b64_tr_b16 v[246:247], v5 offset:58656
    s_waitcnt lgkmcnt(4)
    v_mfma_f32_16x16x32_bf16 v[32:35], v[236:239], v[144:147], v[32:35]
    ds_read_b64_tr_b16 v[224:225], v4 offset:57856
    v_mfma_f32_16x16x32_bf16 v[36:39], v[236:239], v[148:151], v[36:39]
    ds_read_b64_tr_b16 v[226:227], v4 offset:58880
    s_mov_b32 s23, 0x3000
    buffer_load_dwordx4 v[128:131], v7, s[8:11], s23 offen offset:1024 sc1
    s_waitcnt lgkmcnt(4)
    v_mfma_f32_16x16x32_bf16 v[40:43], v[240:243], v[144:147], v[40:43]
    ds_read_b64_tr_b16 v[228:229], v5 offset:57888
    v_mfma_f32_16x16x32_bf16 v[44:47], v[240:243], v[148:151], v[44:47]
    ds_read_b64_tr_b16 v[230:231], v5 offset:58912
    s_waitcnt lgkmcnt(4)
    v_mfma_f32_16x16x32_bf16 v[48:51], v[244:247], v[144:147], v[48:51]
    ds_read_b64_tr_b16 v[232:233], v4 offset:58112
    v_mfma_f32_16x16x32_bf16 v[52:55], v[244:247], v[148:151], v[52:55]
    ds_read_b64_tr_b16 v[234:235], v4 offset:59136
    s_waitcnt lgkmcnt(4)
    v_mfma_f32_16x16x32_bf16 v[56:59], v[224:227], v[144:147], v[56:59]
    ds_read_b64_tr_b16 v[236:237], v5 offset:58144
    v_mfma_f32_16x16x32_bf16 v[60:63], v[224:227], v[148:151], v[60:63]
    ds_read_b64_tr_b16 v[238:239], v5 offset:59168
    s_waitcnt lgkmcnt(4)
    v_mfma_f32_16x16x32_bf16 v[64:67], v[228:231], v[144:147], v[64:67]
    v_mfma_f32_16x16x32_bf16 v[68:71], v[228:231], v[148:151], v[68:71]
    s_waitcnt vmcnt(8)
    s_barrier
    ds_read_b64_tr_b16 v[240:241], v4 offset:0
    ds_read_b64_tr_b16 v[242:243], v4 offset:1024
    s_mov_b32 s23, 0xb000
    buffer_load_dwordx4 v[132:135], v7, s[8:11], s23 offen offset:1024 sc1
    s_waitcnt lgkmcnt(4)
    v_mfma_f32_16x16x32_bf16 v[72:75], v[232:235], v[144:147], v[72:75]
    ds_read_b64_tr_b16 v[244:245], v5 offset:32
    v_mfma_f32_16x16x32_bf16 v[76:79], v[232:235], v[148:151], v[76:79]
    s_add_u32 s22, s19, 0x300000
    s_add_u32 m0, s20, 0x8000
    s_nop 0
    buffer_load_dwordx4 v3, s[4:7], s22 offen lds
    ds_read_b64_tr_b16 v[246:247], v5 offset:1056
    s_waitcnt lgkmcnt(4)
    v_mfma_f32_16x16x32_bf16 v[80:83], v[236:239], v[144:147], v[80:83]
    ds_read_b64_tr_b16 v[224:225], v4 offset:256
    v_mfma_f32_16x16x32_bf16 v[84:87], v[236:239], v[148:151], v[84:87]
    ds_read_b64_tr_b16 v[226:227], v4 offset:1280
    s_waitcnt lgkmcnt(4)
    v_mfma_f32_16x16x32_bf16 v[24:27], v[240:243], v[88:91], v[24:27]
    ds_read_b64_tr_b16 v[228:229], v5 offset:288
    v_mfma_f32_16x16x32_bf16 v[28:31], v[240:243], v[92:95], v[28:31]
    ds_read_b64_tr_b16 v[230:231], v5 offset:1312
    s_waitcnt lgkmcnt(4)
    v_mfma_f32_16x16x32_bf16 v[32:35], v[244:247], v[88:91], v[32:35]
    ds_read_b64_tr_b16 v[232:233], v4 offset:512
    v_mfma_f32_16x16x32_bf16 v[36:39], v[244:247], v[92:95], v[36:39]
    ds_read_b64_tr_b16 v[234:235], v4 offset:1536
    s_mov_b32 s23, 0x3800
    buffer_load_dwordx4 v[136:139], v7, s[8:11], s23 offen offset:0 sc1
    s_waitcnt lgkmcnt(4)
    v_mfma_f32_16x16x32_bf16 v[40:43], v[224:227], v[88:91], v[40:43]
    ds_read_b64_tr_b16 v[236:237], v5 offset:544
    v_mfma_f32_16x16x32_bf16 v[44:47], v[224:227], v[92:95], v[44:47]
    s_add_u32 s22, s19, 0x308000
    s_add_u32 m0, s20, 0x8400
    s_nop 0
    buffer_load_dwordx4 v3, s[4:7], s22 offen lds
    ds_read_b64_tr_b16 v[238:239], v5 offset:1568
    s_waitcnt lgkmcnt(4)
    v_mfma_f32_16x16x32_bf16 v[48:51], v[228:231], v[88:91], v[48:51]
    ds_read_b64_tr_b16 v[240:241], v4 offset:768
    v_mfma_f32_16x16x32_bf16 v[52:55], v[228:231], v[92:95], v[52:55]
    ds_read_b64_tr_b16 v[242:243], v4 offset:1792
    s_waitcnt lgkmcnt(4)
    v_mfma_f32_16x16x32_bf16 v[56:59], v[232:235], v[88:91], v[56:59]
    ds_read_b64_tr_b16 v[244:245], v5 offset:800
    v_mfma_f32_16x16x32_bf16 v[60:63], v[232:235], v[92:95], v[60:63]
    ds_read_b64_tr_b16 v[246:247], v5 offset:1824
    s_waitcnt lgkmcnt(4)
    v_mfma_f32_16x16x32_bf16 v[64:67], v[236:239], v[88:91], v[64:67]
    ds_read_b64_tr_b16 v[224:225], v4 offset:8192
    v_mfma_f32_16x16x32_bf16 v[68:71], v[236:239], v[92:95], v[68:71]
    ds_read_b64_tr_b16 v[226:227], v4 offset:9216
    s_mov_b32 s23, 0xb800
    buffer_load_dwordx4 v[140:143], v7, s[8:11], s23 offen offset:0 sc1
    s_waitcnt lgkmcnt(4)
    v_mfma_f32_16x16x32_bf16 v[72:75], v[240:243], v[88:91], v[72:75]
    ds_read_b64_tr_b16 v[228:229], v5 offset:8224
    v_mfma_f32_16x16x32_bf16 v[76:79], v[240:243], v[92:95], v[76:79]
    ds_read_b64_tr_b16 v[230:231], v5 offset:9248
    s_waitcnt lgkmcnt(4)
    v_mfma_f32_16x16x32_bf16 v[80:83], v[244:247], v[88:91], v[80:83]
    ds_read_b64_tr_b16 v[232:233], v4 offset:8448
    v_mfma_f32_16x16x32_bf16 v[84:87], v[244:247], v[92:95], v[84:87]
    ds_read_b64_tr_b16 v[234:235], v4 offset:9472
    s_waitcnt lgkmcnt(4)
    v_mfma_f32_16x16x32_bf16 v[24:27], v[224:227], v[96:99], v[24:27]
    ds_read_b64_tr_b16 v[236:237], v5 offset:8480
    v_mfma_f32_16x16x32_bf16 v[28:31], v[224:227], v[100:103], v[28:31]
    ds_read_b64_tr_b16 v[238:239], v5 offset:9504
    s_waitcnt lgkmcnt(4)
    v_mfma_f32_16x16x32_bf16 v[32:35], v[228:231], v[96:99], v[32:35]
    ds_read_b64_tr_b16 v[240:241], v4 offset:8704
    v_mfma_f32_16x16x32_bf16 v[36:39], v[228:231], v[100:103], v[36:39]
    ds_read_b64_tr_b16 v[242:243], v4 offset:9728
    s_mov_b32 s23, 0x3800
    buffer_load_dwordx4 v[144:147], v7, s[8:11], s23 offen offset:1024 sc1
    s_waitcnt lgkmcnt(4)
    v_mfma_f32_16x16x32_bf16 v[40:43], v[232:235], v[96:99], v[40:43]
    ds_read_b64_tr_b16 v[244:245], v5 offset:8736
    v_mfma_f32_16x16x32_bf16 v[44:47], v[232:235], v[100:103], v[44:47]
    ds_read_b64_tr_b16 v[246:247], v5 offset:9760
    s_waitcnt lgkmcnt(4)
    v_mfma_f32_16x16x32_bf16 v[48:51], v[236:239], v[96:99], v[48:51]
    ds_read_b64_tr_b16 v[224:225], v4 offset:8960
    v_mfma_f32_16x16x32_bf16 v[52:55], v[236:239], v[100:103], v[52:55]
    ds_read_b64_tr_b16 v[226:227], v4 offset:9984
    s_waitcnt lgkmcnt(4)
    v_mfma_f32_16x16x32_bf16 v[56:59], v[240:243], v[96:99], v[56:59]
    ds_read_b64_tr_b16 v[228:229], v5 offset:8992
    v_mfma_f32_16x16x32_bf16 v[60:63], v[240:243], v[100:103], v[60:63]
    ds_read_b64_tr_b16 v[230:231], v5 offset:10016
    s_waitcnt lgkmcnt(4)
    v_mfma_f32_16x16x32_bf16 v[64:67], v[244:247], v[96:99], v[64:67]
    v_mfma_f32_16x16x32_bf16 v[68:71], v[244:247], v[100:103], v[68:71]
    s_waitcnt vmcnt(8)
    s_barrier
    ds_read_b64_tr_b16 v[232:233], v4 offset:16384
    ds_read_b64_tr_b16 v[234:235], v4 offset:17408
    s_mov_b32 s23, 0xb800
    buffer_load_dwordx4 v[148:151], v7, s[8:11], s23 offen offset:1024 sc1
    s_waitcnt lgkmcnt(4)
    v_mfma_f32_16x16x32_bf16 v[72:75], v[224:227], v[96:99], v[72:75]
    ds_read_b64_tr_b16 v[236:237], v5 offset:16416
    v_mfma_f32_16x16x32_bf16 v[76:79], v[224:227], v[100:103], v[76:79]
    s_add_u32 s22, s19, 0x380000
    s_add_u32 m0, s20, 0xc000
    s_nop 0
    buffer_load_dwordx4 v3, s[4:7], s22 offen lds
    ds_read_b64_tr_b16 v[238:239], v5 offset:17440
    s_waitcnt lgkmcnt(4)
    v_mfma_f32_16x16x32_bf16 v[80:83], v[228:231], v[96:99], v[80:83]
    ds_read_b64_tr_b16 v[240:241], v4 offset:16640
    v_mfma_f32_16x16x32_bf16 v[84:87], v[228:231], v[100:103], v[84:87]
    ds_read_b64_tr_b16 v[242:243], v4 offset:17664
    s_waitcnt lgkmcnt(4)
    v_mfma_f32_16x16x32_bf16 v[24:27], v[232:235], v[104:107], v[24:27]
    ds_read_b64_tr_b16 v[244:245], v5 offset:16672
    v_mfma_f32_16x16x32_bf16 v[28:31], v[232:235], v[108:111], v[28:31]
    ds_read_b64_tr_b16 v[246:247], v5 offset:17696
    s_waitcnt lgkmcnt(4)
    v_mfma_f32_16x16x32_bf16 v[32:35], v[236:239], v[104:107], v[32:35]
    ds_read_b64_tr_b16 v[224:225], v4 offset:16896
    v_mfma_f32_16x16x32_bf16 v[36:39], v[236:239], v[108:111], v[36:39]
    ds_read_b64_tr_b16 v[226:227], v4 offset:17920
    s_mov_b32 s23, 0x4000
    buffer_load_dwordx4 v[88:91], v7, s[8:11], s23 offen offset:0 sc1
    s_waitcnt lgkmcnt(4)
    v_mfma_f32_16x16x32_bf16 v[40:43], v[240:243], v[104:107], v[40:43]
    ds_read_b64_tr_b16 v[228:229], v5 offset:16928
    v_mfma_f32_16x16x32_bf16 v[44:47], v[240:243], v[108:111], v[44:47]
    s_add_u32 s22, s19, 0x388000
    s_add_u32 m0, s20, 0xc400
    s_nop 0
    buffer_load_dwordx4 v3, s[4:7], s22 offen lds
    ds_read_b64_tr_b16 v[230:231], v5 offset:17952
    s_waitcnt lgkmcnt(4)
    v_mfma_f32_16x16x32_bf16 v[48:51], v[244:247], v[104:107], v[48:51]
    ds_read_b64_tr_b16 v[232:233], v4 offset:17152
    v_mfma_f32_16x16x32_bf16 v[52:55], v[244:247], v[108:111], v[52:55]
    ds_read_b64_tr_b16 v[234:235], v4 offset:18176
    s_waitcnt lgkmcnt(4)
    v_mfma_f32_16x16x32_bf16 v[56:59], v[224:227], v[104:107], v[56:59]
    ds_read_b64_tr_b16 v[236:237], v5 offset:17184
    v_mfma_f32_16x16x32_bf16 v[60:63], v[224:227], v[108:111], v[60:63]
    ds_read_b64_tr_b16 v[238:239], v5 offset:18208
    s_waitcnt lgkmcnt(4)
    v_mfma_f32_16x16x32_bf16 v[64:67], v[228:231], v[104:107], v[64:67]
    ds_read_b64_tr_b16 v[240:241], v4 offset:24576
    v_mfma_f32_16x16x32_bf16 v[68:71], v[228:231], v[108:111], v[68:71]
    ds_read_b64_tr_b16 v[242:243], v4 offset:25600
    s_mov_b32 s23, 0xc000
    buffer_load_dwordx4 v[92:95], v7, s[8:11], s23 offen offset:0 sc1
    s_waitcnt lgkmcnt(4)
    v_mfma_f32_16x16x32_bf16 v[72:75], v[232:235], v[104:107], v[72:75]
    ds_read_b64_tr_b16 v[244:245], v5 offset:24608
    v_mfma_f32_16x16x32_bf16 v[76:79], v[232:235], v[108:111], v[76:79]
    ds_read_b64_tr_b16 v[246:247], v5 offset:25632
    s_waitcnt lgkmcnt(4)
    v_mfma_f32_16x16x32_bf16 v[80:83], v[236:239], v[104:107], v[80:83]
    ds_read_b64_tr_b16 v[224:225], v4 offset:24832
    v_mfma_f32_16x16x32_bf16 v[84:87], v[236:239], v[108:111], v[84:87]
    ds_read_b64_tr_b16 v[226:227], v4 offset:25856
    s_waitcnt lgkmcnt(4)
    v_mfma_f32_16x16x32_bf16 v[24:27], v[240:243], v[112:115], v[24:27]
    ds_read_b64_tr_b16 v[228:229], v5 offset:24864
    v_mfma_f32_16x16x32_bf16 v[28:31], v[240:243], v[116:119], v[28:31]
    ds_read_b64_tr_b16 v[230:231], v5 offset:25888
    s_waitcnt lgkmcnt(4)
    v_mfma_f32_16x16x32_bf16 v[32:35], v[244:247], v[112:115], v[32:35]
    ds_read_b64_tr_b16 v[232:233], v4 offset:25088
    v_mfma_f32_16x16x32_bf16 v[36:39], v[244:247], v[116:119], v[36:39]
    ds_read_b64_tr_b16 v[234:235], v4 offset:26112
    s_mov_b32 s23, 0x4000
    buffer_load_dwordx4 v[96:99], v7, s[8:11], s23 offen offset:1024 sc1
    s_waitcnt lgkmcnt(4)
    v_mfma_f32_16x16x32_bf16 v[40:43], v[224:227], v[112:115], v[40:43]
    ds_read_b64_tr_b16 v[236:237], v5 offset:25120
    v_mfma_f32_16x16x32_bf16 v[44:47], v[224:227], v[116:119], v[44:47]
    ds_read_b64_tr_b16 v[238:239], v5 offset:26144
    s_waitcnt lgkmcnt(4)
    v_mfma_f32_16x16x32_bf16 v[48:51], v[228:231], v[112:115], v[48:51]
    ds_read_b64_tr_b16 v[240:241], v4 offset:25344
    v_mfma_f32_16x16x32_bf16 v[52:55], v[228:231], v[116:119], v[52:55]
    ds_read_b64_tr_b16 v[242:243], v4 offset:26368
    s_waitcnt lgkmcnt(4)
    v_mfma_f32_16x16x32_bf16 v[56:59], v[232:235], v[112:115], v[56:59]
    ds_read_b64_tr_b16 v[244:245], v5 offset:25376
    v_mfma_f32_16x16x32_bf16 v[60:63], v[232:235], v[116:119], v[60:63]
    ds_read_b64_tr_b16 v[246:247], v5 offset:26400
    s_waitcnt lgkmcnt(4)
    v_mfma_f32_16x16x32_bf16 v[64:67], v[236:239], v[112:115], v[64:67]
    v_mfma_f32_16x16x32_bf16 v[68:71], v[236:239], v[116:119], v[68:71]
    s_waitcnt vmcnt(8)
    s_barrier
    ds_read_b64_tr_b16 v[224:225], v4 offset:32768
    ds_read_b64_tr_b16 v[226:227], v4 offset:33792
    s_mov_b32 s23, 0xc000
    buffer_load_dwordx4 v[100:103], v7, s[8:11], s23 offen offset:1024 sc1
    s_waitcnt lgkmcnt(4)
    v_mfma_f32_16x16x32_bf16 v[72:75], v[240:243], v[112:115], v[72:75]
    ds_read_b64_tr_b16 v[228:229], v5 offset:32800
    v_mfma_f32_16x16x32_bf16 v[76:79], v[240:243], v[116:119], v[76:79]
    s_add_u32 s22, s19, 0x400000
    s_add_u32 m0, s20, 0x0
    s_nop 0
    buffer_load_dwordx4 v3, s[4:7], s22 offen lds
    ds_read_b64_tr_b16 v[230:231], v5 offset:33824
    s_waitcnt lgkmcnt(4)
    v_mfma_f32_16x16x32_bf16 v[80:83], v[244:247], v[112:115], v[80:83]
    ds_read_b64_tr_b16 v[232:233], v4 offset:33024
    v_mfma_f32_16x16x32_bf16 v[84:87], v[244:247], v[116:119], v[84:87]
    ds_read_b64_tr_b16 v[234:235], v4 offset:34048
    s_waitcnt lgkmcnt(4)
    v_mfma_f32_16x16x32_bf16 v[24:27], v[224:227], v[120:123], v[24:27]
    ds_read_b64_tr_b16 v[236:237], v5 offset:33056
    v_mfma_f32_16x16x32_bf16 v[28:31], v[224:227], v[124:127], v[28:31]
    ds_read_b64_tr_b16 v[238:239], v5 offset:34080
    s_waitcnt lgkmcnt(4)
    v_mfma_f32_16x16x32_bf16 v[32:35], v[228:231], v[120:123], v[32:35]
    ds_read_b64_tr_b16 v[240:241], v4 offset:33280
    v_mfma_f32_16x16x32_bf16 v[36:39], v[228:231], v[124:127], v[36:39]
    ds_read_b64_tr_b16 v[242:243], v4 offset:34304
    s_mov_b32 s23, 0x4800
    buffer_load_dwordx4 v[104:107], v7, s[8:11], s23 offen offset:0 sc1
    s_waitcnt lgkmcnt(4)
    v_mfma_f32_16x16x32_bf16 v[40:43], v[232:235], v[120:123], v[40:43]
    ds_read_b64_tr_b16 v[244:245], v5 offset:33312
    v_mfma_f32_16x16x32_bf16 v[44:47], v[232:235], v[124:127], v[44:47]
    s_add_u32 s22, s19, 0x408000
    s_add_u32 m0, s20, 0x400
    s_nop 0
    buffer_load_dwordx4 v3, s[4:7], s22 offen lds
    ds_read_b64_tr_b16 v[246:247], v5 offset:34336
    s_waitcnt lgkmcnt(4)
    v_mfma_f32_16x16x32_bf16 v[48:51], v[236:239], v[120:123], v[48:51]
    ds_read_b64_tr_b16 v[224:225], v4 offset:33536
    v_mfma_f32_16x16x32_bf16 v[52:55], v[236:239], v[124:127], v[52:55]
    ds_read_b64_tr_b16 v[226:227], v4 offset:34560
    s_waitcnt lgkmcnt(4)
    v_mfma_f32_16x16x32_bf16 v[56:59], v[240:243], v[120:123], v[56:59]
    ds_read_b64_tr_b16 v[228:229], v5 offset:33568
    v_mfma_f32_16x16x32_bf16 v[60:63], v[240:243], v[124:127], v[60:63]
    ds_read_b64_tr_b16 v[230:231], v5 offset:34592
    s_waitcnt lgkmcnt(4)
    v_mfma_f32_16x16x32_bf16 v[64:67], v[244:247], v[120:123], v[64:67]
    ds_read_b64_tr_b16 v[232:233], v4 offset:40960
    v_mfma_f32_16x16x32_bf16 v[68:71], v[244:247], v[124:127], v[68:71]
    ds_read_b64_tr_b16 v[234:235], v4 offset:41984
    s_mov_b32 s23, 0xc800
    buffer_load_dwordx4 v[108:111], v7, s[8:11], s23 offen offset:0 sc1
    s_waitcnt lgkmcnt(4)
    v_mfma_f32_16x16x32_bf16 v[72:75], v[224:227], v[120:123], v[72:75]
    ds_read_b64_tr_b16 v[236:237], v5 offset:40992
    v_lshrrev_b32 v21, 4, v1
    v_lshlrev_b32 v21, 9, v21
    v_and_b32 v20, 15, v1
    v_lshl_add_u32 v21, v20, 4, v21
    s_lshr_b32 s18, s12, 3
    s_lshl_b32 s18, s18, 11
    s_add_u32 s18, s18, 0x528100
    buffer_load_dwordx4 v[12:15], v21, s[8:11], s18 offen sc1
    v_mfma_f32_16x16x32_bf16 v[76:79], v[224:227], v[124:127], v[76:79]
    ds_read_b64_tr_b16 v[238:239], v5 offset:42016
    s_waitcnt lgkmcnt(4)
    v_mfma_f32_16x16x32_bf16 v[80:83], v[228:231], v[120:123], v[80:83]
    ds_read_b64_tr_b16 v[240:241], v4 offset:41216
    v_mfma_f32_16x16x32_bf16 v[84:87], v[228:231], v[124:127], v[84:87]
    ds_read_b64_tr_b16 v[242:243], v4 offset:42240
    s_waitcnt lgkmcnt(4)
    v_mfma_f32_16x16x32_bf16 v[24:27], v[232:235], v[128:131], v[24:27]
    ds_read_b64_tr_b16 v[244:245], v5 offset:41248
    v_mfma_f32_16x16x32_bf16 v[28:31], v[232:235], v[132:135], v[28:31]
    ds_read_b64_tr_b16 v[246:247], v5 offset:42272
    s_waitcnt lgkmcnt(4)
    v_mfma_f32_16x16x32_bf16 v[32:35], v[236:239], v[128:131], v[32:35]
    ds_read_b64_tr_b16 v[224:225], v4 offset:41472
    v_mfma_f32_16x16x32_bf16 v[36:39], v[236:239], v[132:135], v[36:39]
    ds_read_b64_tr_b16 v[226:227], v4 offset:42496
    s_mov_b32 s23, 0x4800
    buffer_load_dwordx4 v[112:115], v7, s[8:11], s23 offen offset:1024 sc1
    s_waitcnt lgkmcnt(4)
    v_mfma_f32_16x16x32_bf16 v[40:43], v[240:243], v[128:131], v[40:43]
    ds_read_b64_tr_b16 v[228:229], v5 offset:41504
    v_mfma_f32_16x16x32_bf16 v[44:47], v[240:243], v[132:135], v[44:47]
    ds_read_b64_tr_b16 v[230:231], v5 offset:42528
    s_waitcnt lgkmcnt(4)
    v_mfma_f32_16x16x32_bf16 v[48:51], v[244:247], v[128:131], v[48:51]
    ds_read_b64_tr_b16 v[232:233], v4 offset:41728
    v_mfma_f32_16x16x32_bf16 v[52:55], v[244:247], v[132:135], v[52:55]
    ds_read_b64_tr_b16 v[234:235], v4 offset:42752
    s_waitcnt lgkmcnt(4)
    v_mfma_f32_16x16x32_bf16 v[56:59], v[224:227], v[128:131], v[56:59]
    ds_read_b64_tr_b16 v[236:237], v5 offset:41760
    v_mfma_f32_16x16x32_bf16 v[60:63], v[224:227], v[132:135], v[60:63]
    ds_read_b64_tr_b16 v[238:239], v5 offset:42784
    s_waitcnt lgkmcnt(4)
    v_mfma_f32_16x16x32_bf16 v[64:67], v[228:231], v[128:131], v[64:67]
    v_mfma_f32_16x16x32_bf16 v[68:71], v[228:231], v[132:135], v[68:71]
    s_waitcnt vmcnt(9)
    s_barrier
    ds_read_b64_tr_b16 v[240:241], v4 offset:49152
    ds_read_b64_tr_b16 v[242:243], v4 offset:50176
    s_mov_b32 s23, 0xc800
    buffer_load_dwordx4 v[116:119], v7, s[8:11], s23 offen offset:1024 sc1
    s_waitcnt lgkmcnt(4)
    v_mfma_f32_16x16x32_bf16 v[72:75], v[232:235], v[128:131], v[72:75]
    ds_read_b64_tr_b16 v[244:245], v5 offset:49184
    v_mfma_f32_16x16x32_bf16 v[76:79], v[232:235], v[132:135], v[76:79]
    s_add_u32 s22, s19, 0x480000
    s_add_u32 m0, s20, 0x4000
    s_nop 0
    buffer_load_dwordx4 v3, s[4:7], s22 offen lds
    ds_read_b64_tr_b16 v[246:247], v5 offset:50208
    s_waitcnt lgkmcnt(4)
    v_mfma_f32_16x16x32_bf16 v[80:83], v[236:239], v[128:131], v[80:83]
    ds_read_b64_tr_b16 v[224:225], v4 offset:49408
    v_mfma_f32_16x16x32_bf16 v[84:87], v[236:239], v[132:135], v[84:87]
    ds_read_b64_tr_b16 v[226:227], v4 offset:50432
    s_waitcnt lgkmcnt(4)
    v_mfma_f32_16x16x32_bf16 v[24:27], v[240:243], v[136:139], v[24:27]
    ds_read_b64_tr_b16 v[228:229], v5 offset:49440
    v_mfma_f32_16x16x32_bf16 v[28:31], v[240:243], v[140:143], v[28:31]
    ds_read_b64_tr_b16 v[230:231], v5 offset:50464
    s_waitcnt lgkmcnt(4)
    v_mfma_f32_16x16x32_bf16 v[32:35], v[244:247], v[136:139], v[32:35]
    ds_read_b64_tr_b16 v[232:233], v4 offset:49664
    v_mfma_f32_16x16x32_bf16 v[36:39], v[244:247], v[140:143], v[36:39]
    ds_read_b64_tr_b16 v[234:235], v4 offset:50688
    s_mov_b32 s23, 0x5000
    buffer_load_dwordx4 v[120:123], v7, s[8:11], s23 offen offset:0 sc1
    s_waitcnt lgkmcnt(4)
    v_mfma_f32_16x16x32_bf16 v[40:43], v[224:227], v[136:139], v[40:43]
    ds_read_b64_tr_b16 v[236:237], v5 offset:49696
    v_mfma_f32_16x16x32_bf16 v[44:47], v[224:227], v[140:143], v[44:47]
    s_add_u32 s22, s19, 0x488000
    s_add_u32 m0, s20, 0x4400
    s_nop 0
    buffer_load_dwordx4 v3, s[4:7], s22 offen lds
    ds_read_b64_tr_b16 v[238:239], v5 offset:50720
    s_waitcnt lgkmcnt(4)
    v_mfma_f32_16x16x32_bf16 v[48:51], v[228:231], v[136:139], v[48:51]
    ds_read_b64_tr_b16 v[240:241], v4 offset:49920
    v_mfma_f32_16x16x32_bf16 v[52:55], v[228:231], v[140:143], v[52:55]
    ds_read_b64_tr_b16 v[242:243], v4 offset:50944
    s_waitcnt lgkmcnt(4)
    v_mfma_f32_16x16x32_bf16 v[56:59], v[232:235], v[136:139], v[56:59]
    ds_read_b64_tr_b16 v[244:245], v5 offset:49952
    v_mfma_f32_16x16x32_bf16 v[60:63], v[232:235], v[140:143], v[60:63]
    ds_read_b64_tr_b16 v[246:247], v5 offset:50976
    s_waitcnt lgkmcnt(4)
    v_mfma_f32_16x16x32_bf16 v[64:67], v[236:239], v[136:139], v[64:67]
    ds_read_b64_tr_b16 v[224:225], v4 offset:57344
    v_mfma_f32_16x16x32_bf16 v[68:71], v[236:239], v[140:143], v[68:71]
    ds_read_b64_tr_b16 v[226:227], v4 offset:58368
    s_mov_b32 s23, 0xd000
    buffer_load_dwordx4 v[124:127], v7, s[8:11], s23 offen offset:0 sc1
    s_waitcnt lgkmcnt(4)
    v_mfma_f32_16x16x32_bf16 v[72:75], v[240:243], v[136:139], v[72:75]
    ds_read_b64_tr_b16 v[228:229], v5 offset:57376
    v_mfma_f32_16x16x32_bf16 v[76:79], v[240:243], v[140:143], v[76:79]
    ds_read_b64_tr_b16 v[230:231], v5 offset:58400
    s_waitcnt lgkmcnt(4)
    v_mfma_f32_16x16x32_bf16 v[80:83], v[244:247], v[136:139], v[80:83]
    ds_read_b64_tr_b16 v[232:233], v4 offset:57600
    v_mfma_f32_16x16x32_bf16 v[84:87], v[244:247], v[140:143], v[84:87]
    ds_read_b64_tr_b16 v[234:235], v4 offset:58624
    s_waitcnt lgkmcnt(4)
    v_mfma_f32_16x16x32_bf16 v[24:27], v[224:227], v[144:147], v[24:27]
    ds_read_b64_tr_b16 v[236:237], v5 offset:57632
    v_mfma_f32_16x16x32_bf16 v[28:31], v[224:227], v[148:151], v[28:31]
    ds_read_b64_tr_b16 v[238:239], v5 offset:58656
    s_waitcnt lgkmcnt(4)
    v_mfma_f32_16x16x32_bf16 v[32:35], v[228:231], v[144:147], v[32:35]
    ds_read_b64_tr_b16 v[240:241], v4 offset:57856
    v_mfma_f32_16x16x32_bf16 v[36:39], v[228:231], v[148:151], v[36:39]
    ds_read_b64_tr_b16 v[242:243], v4 offset:58880
    s_mov_b32 s23, 0x5000
    buffer_load_dwordx4 v[128:131], v7, s[8:11], s23 offen offset:1024 sc1
    s_waitcnt lgkmcnt(4)
    v_mfma_f32_16x16x32_bf16 v[40:43], v[232:235], v[144:147], v[40:43]
    ds_read_b64_tr_b16 v[244:245], v5 offset:57888
    v_mfma_f32_16x16x32_bf16 v[44:47], v[232:235], v[148:151], v[44:47]
    ds_read_b64_tr_b16 v[246:247], v5 offset:58912
    s_waitcnt lgkmcnt(4)
    v_mfma_f32_16x16x32_bf16 v[48:51], v[236:239], v[144:147], v[48:51]
    ds_read_b64_tr_b16 v[224:225], v4 offset:58112
    v_mfma_f32_16x16x32_bf16 v[52:55], v[236:239], v[148:151], v[52:55]
    ds_read_b64_tr_b16 v[226:227], v4 offset:59136
    s_waitcnt lgkmcnt(4)
    v_mfma_f32_16x16x32_bf16 v[56:59], v[240:243], v[144:147], v[56:59]
    ds_read_b64_tr_b16 v[228:229], v5 offset:58144
    v_mfma_f32_16x16x32_bf16 v[60:63], v[240:243], v[148:151], v[60:63]
    ds_read_b64_tr_b16 v[230:231], v5 offset:59168
    s_waitcnt lgkmcnt(4)
    v_mfma_f32_16x16x32_bf16 v[64:67], v[244:247], v[144:147], v[64:67]
    v_mfma_f32_16x16x32_bf16 v[68:71], v[244:247], v[148:151], v[68:71]
    s_waitcnt vmcnt(9)
    s_barrier
    ds_read_b64_tr_b16 v[232:233], v4 offset:0
    ds_read_b64_tr_b16 v[234:235], v4 offset:1024
    s_mov_b32 s23, 0xd000
    buffer_load_dwordx4 v[132:135], v7, s[8:11], s23 offen offset:1024 sc1
    s_waitcnt lgkmcnt(4)
    v_mfma_f32_16x16x32_bf16 v[72:75], v[224:227], v[144:147], v[72:75]
    ds_read_b64_tr_b16 v[236:237], v5 offset:32
    v_mfma_f32_16x16x32_bf16 v[76:79], v[224:227], v[148:151], v[76:79]
    s_add_u32 s22, s19, 0x500000
    s_add_u32 m0, s20, 0x8000
    s_nop 0
    buffer_load_dwordx4 v3, s[4:7], s22 offen lds
    ds_read_b64_tr_b16 v[238:239], v5 offset:1056
    s_waitcnt lgkmcnt(4)
    v_mfma_f32_16x16x32_bf16 v[80:83], v[228:231], v[144:147], v[80:83]
    ds_read_b64_tr_b16 v[240:241], v4 offset:256
    v_mfma_f32_16x16x32_bf16 v[84:87], v[228:231], v[148:151], v[84:87]
    ds_read_b64_tr_b16 v[242:243], v4 offset:1280
    s_waitcnt lgkmcnt(4)
    v_mfma_f32_16x16x32_bf16 v[24:27], v[232:235], v[88:91], v[24:27]
    ds_read_b64_tr_b16 v[244:245], v5 offset:288
    v_mfma_f32_16x16x32_bf16 v[28:31], v[232:235], v[92:95], v[28:31]
    ds_read_b64_tr_b16 v[246:247], v5 offset:1312
    s_waitcnt lgkmcnt(4)
    v_mfma_f32_16x16x32_bf16 v[32:35], v[236:239], v[88:91], v[32:35]
    ds_read_b64_tr_b16 v[224:225], v4 offset:512
    v_mfma_f32_16x16x32_bf16 v[36:39], v[236:239], v[92:95], v[36:39]
    ds_read_b64_tr_b16 v[226:227], v4 offset:1536
    s_mov_b32 s23, 0x5800
    buffer_load_dwordx4 v[136:139], v7, s[8:11], s23 offen offset:0 sc1
    s_waitcnt lgkmcnt(4)
    v_mfma_f32_16x16x32_bf16 v[40:43], v[240:243], v[88:91], v[40:43]
    ds_read_b64_tr_b16 v[228:229], v5 offset:544
    v_mfma_f32_16x16x32_bf16 v[44:47], v[240:243], v[92:95], v[44:47]
    s_add_u32 s22, s19, 0x508000
    s_add_u32 m0, s20, 0x8400
    s_nop 0
    buffer_load_dwordx4 v3, s[4:7], s22 offen lds
    ds_read_b64_tr_b16 v[230:231], v5 offset:1568
    s_waitcnt lgkmcnt(4)
    v_mfma_f32_16x16x32_bf16 v[48:51], v[244:247], v[88:91], v[48:51]
    ds_read_b64_tr_b16 v[232:233], v4 offset:768
    v_mfma_f32_16x16x32_bf16 v[52:55], v[244:247], v[92:95], v[52:55]
    ds_read_b64_tr_b16 v[234:235], v4 offset:1792
    s_waitcnt lgkmcnt(4)
    v_mfma_f32_16x16x32_bf16 v[56:59], v[224:227], v[88:91], v[56:59]
    ds_read_b64_tr_b16 v[236:237], v5 offset:800
    v_mfma_f32_16x16x32_bf16 v[60:63], v[224:227], v[92:95], v[60:63]
    ds_read_b64_tr_b16 v[238:239], v5 offset:1824
    s_waitcnt lgkmcnt(4)
    v_mfma_f32_16x16x32_bf16 v[64:67], v[228:231], v[88:91], v[64:67]
    ds_read_b64_tr_b16 v[240:241], v4 offset:8192
    v_mfma_f32_16x16x32_bf16 v[68:71], v[228:231], v[92:95], v[68:71]
    ds_read_b64_tr_b16 v[242:243], v4 offset:9216
    s_mov_b32 s23, 0xd800
    buffer_load_dwordx4 v[140:143], v7, s[8:11], s23 offen offset:0 sc1
    s_waitcnt lgkmcnt(4)
    v_mfma_f32_16x16x32_bf16 v[72:75], v[232:235], v[88:91], v[72:75]
    ds_read_b64_tr_b16 v[244:245], v5 offset:8224
    v_mfma_f32_16x16x32_bf16 v[76:79], v[232:235], v[92:95], v[76:79]
    ds_read_b64_tr_b16 v[246:247], v5 offset:9248
    s_waitcnt lgkmcnt(4)
    v_mfma_f32_16x16x32_bf16 v[80:83], v[236:239], v[88:91], v[80:83]
    ds_read_b64_tr_b16 v[224:225], v4 offset:8448
    v_mfma_f32_16x16x32_bf16 v[84:87], v[236:239], v[92:95], v[84:87]
    ds_read_b64_tr_b16 v[226:227], v4 offset:9472
    s_waitcnt lgkmcnt(4)
    v_mfma_f32_16x16x32_bf16 v[24:27], v[240:243], v[96:99], v[24:27]
    ds_read_b64_tr_b16 v[228:229], v5 offset:8480
    v_mfma_f32_16x16x32_bf16 v[28:31], v[240:243], v[100:103], v[28:31]
    ds_read_b64_tr_b16 v[230:231], v5 offset:9504
    s_waitcnt lgkmcnt(4)
    v_mfma_f32_16x16x32_bf16 v[32:35], v[244:247], v[96:99], v[32:35]
    ds_read_b64_tr_b16 v[232:233], v4 offset:8704
    v_mfma_f32_16x16x32_bf16 v[36:39], v[244:247], v[100:103], v[36:39]
    ds_read_b64_tr_b16 v[234:235], v4 offset:9728
    s_mov_b32 s23, 0x5800
    buffer_load_dwordx4 v[144:147], v7, s[8:11], s23 offen offset:1024 sc1
    s_waitcnt lgkmcnt(4)
    v_mfma_f32_16x16x32_bf16 v[40:43], v[224:227], v[96:99], v[40:43]
    ds_read_b64_tr_b16 v[236:237], v5 offset:8736
    v_mfma_f32_16x16x32_bf16 v[44:47], v[224:227], v[100:103], v[44:47]
    ds_read_b64_tr_b16 v[238:239], v5 offset:9760
    s_waitcnt lgkmcnt(4)
    v_mfma_f32_16x16x32_bf16 v[48:51], v[228:231], v[96:99], v[48:51]
    ds_read_b64_tr_b16 v[240:241], v4 offset:8960
    v_mfma_f32_16x16x32_bf16 v[52:55], v[228:231], v[100:103], v[52:55]
    ds_read_b64_tr_b16 v[242:243], v4 offset:9984
    s_waitcnt lgkmcnt(4)
    v_mfma_f32_16x16x32_bf16 v[56:59], v[232:235], v[96:99], v[56:59]
    ds_read_b64_tr_b16 v[244:245], v5 offset:8992
    v_mfma_f32_16x16x32_bf16 v[60:63], v[232:235], v[100:103], v[60:63]
    ds_read_b64_tr_b16 v[246:247], v5 offset:10016
    s_waitcnt lgkmcnt(4)
    v_mfma_f32_16x16x32_bf16 v[64:67], v[236:239], v[96:99], v[64:67]
    v_mfma_f32_16x16x32_bf16 v[68:71], v[236:239], v[100:103], v[68:71]
    s_waitcnt vmcnt(8)
    s_barrier
    ds_read_b64_tr_b16 v[224:225], v4 offset:16384
    ds_read_b64_tr_b16 v[226:227], v4 offset:17408
    s_mov_b32 s23, 0xd800
    buffer_load_dwordx4 v[148:151], v7, s[8:11], s23 offen offset:1024 sc1
    s_waitcnt lgkmcnt(4)
    v_mfma_f32_16x16x32_bf16 v[72:75], v[240:243], v[96:99], v[72:75]
    ds_read_b64_tr_b16 v[228:229], v5 offset:16416
    v_mfma_f32_16x16x32_bf16 v[76:79], v[240:243], v[100:103], v[76:79]
    s_add_u32 s22, s19, 0x580000
    s_add_u32 m0, s20, 0xc000
    s_nop 0
    buffer_load_dwordx4 v3, s[4:7], s22 offen lds
    ds_read_b64_tr_b16 v[230:231], v5 offset:17440
    s_waitcnt lgkmcnt(4)
    v_mfma_f32_16x16x32_bf16 v[80:83], v[244:247], v[96:99], v[80:83]
    ds_read_b64_tr_b16 v[232:233], v4 offset:16640
    v_mfma_f32_16x16x32_bf16 v[84:87], v[244:247], v[100:103], v[84:87]
    ds_read_b64_tr_b16 v[234:235], v4 offset:17664
    s_waitcnt lgkmcnt(4)
    v_mfma_f32_16x16x32_bf16 v[24:27], v[224:227], v[104:107], v[24:27]
    ds_read_b64_tr_b16 v[236:237], v5 offset:16672
    v_mfma_f32_16x16x32_bf16 v[28:31], v[224:227], v[108:111], v[28:31]
    ds_read_b64_tr_b16 v[238:239], v5 offset:17696
    s_waitcnt lgkmcnt(4)
    v_mfma_f32_16x16x32_bf16 v[32:35], v[228:231], v[104:107], v[32:35]
    ds_read_b64_tr_b16 v[240:241], v4 offset:16896
    v_mfma_f32_16x16x32_bf16 v[36:39], v[228:231], v[108:111], v[36:39]
    ds_read_b64_tr_b16 v[242:243], v4 offset:17920
    s_mov_b32 s23, 0x6000
    buffer_load_dwordx4 v[88:91], v7, s[8:11], s23 offen offset:0 sc1
    s_waitcnt lgkmcnt(4)
    v_mfma_f32_16x16x32_bf16 v[40:43], v[232:235], v[104:107], v[40:43]
    ds_read_b64_tr_b16 v[244:245], v5 offset:16928
    v_mfma_f32_16x16x32_bf16 v[44:47], v[232:235], v[108:111], v[44:47]
    s_add_u32 s22, s19, 0x588000
    s_add_u32 m0, s20, 0xc400
    s_nop 0
    buffer_load_dwordx4 v3, s[4:7], s22 offen lds
    ds_read_b64_tr_b16 v[246:247], v5 offset:17952
    s_waitcnt lgkmcnt(4)
    v_mfma_f32_16x16x32_bf16 v[48:51], v[236:239], v[104:107], v[48:51]
    ds_read_b64_tr_b16 v[224:225], v4 offset:17152
    v_mfma_f32_16x16x32_bf16 v[52:55], v[236:239], v[108:111], v[52:55]
    ds_read_b64_tr_b16 v[226:227], v4 offset:18176
    s_waitcnt lgkmcnt(4)
    v_mfma_f32_16x16x32_bf16 v[56:59], v[240:243], v[104:107], v[56:59]
    ds_read_b64_tr_b16 v[228:229], v5 offset:17184
    v_mfma_f32_16x16x32_bf16 v[60:63], v[240:243], v[108:111], v[60:63]
    ds_read_b64_tr_b16 v[230:231], v5 offset:18208
    s_waitcnt lgkmcnt(4)
    v_mfma_f32_16x16x32_bf16 v[64:67], v[244:247], v[104:107], v[64:67]
    ds_read_b64_tr_b16 v[232:233], v4 offset:24576
    v_mfma_f32_16x16x32_bf16 v[68:71], v[244:247], v[108:111], v[68:71]
    ds_read_b64_tr_b16 v[234:235], v4 offset:25600
    s_mov_b32 s23, 0xe000
    buffer_load_dwordx4 v[92:95], v7, s[8:11], s23 offen offset:0 sc1
    s_waitcnt lgkmcnt(4)
    v_mfma_f32_16x16x32_bf16 v[72:75], v[224:227], v[104:107], v[72:75]
    ds_read_b64_tr_b16 v[236:237], v5 offset:24608
    v_xor_b32 v8, s28, v12
    v_xor_b32 v20, s28, v13
    v_or_b32 v8, v8, v20
    v_xor_b32 v20, s28, v14
    v_or_b32 v8, v8, v20
    v_xor_b32 v20, s28, v15
    v_or_b32 v8, v8, v20
    v_cmp_ne_u32 vcc, 0, v8
    s_cbranch_vccnz adaLN_cond__sliding_block_cached__moe_arch_mod__prompt_kernel_kv16r
adaLN_cond__sliding_block_cached__moe_arch_mod__prompt_kernel_kv16b:
    v_mfma_f32_16x16x32_bf16 v[76:79], v[224:227], v[108:111], v[76:79]
    ds_read_b64_tr_b16 v[238:239], v5 offset:25632
    v_mov_b32 v20, 0
    s_mov_b32 s16, 0x564000
    buffer_load_dword v8, v20, s[8:11], s16 offen sc1
    s_waitcnt lgkmcnt(4)
    v_mfma_f32_16x16x32_bf16 v[80:83], v[228:231], v[104:107], v[80:83]
    ds_read_b64_tr_b16 v[240:241], v4 offset:24832
    v_mfma_f32_16x16x32_bf16 v[84:87], v[228:231], v[108:111], v[84:87]
    ds_read_b64_tr_b16 v[242:243], v4 offset:25856
    s_waitcnt lgkmcnt(4)
    v_mfma_f32_16x16x32_bf16 v[24:27], v[232:235], v[112:115], v[24:27]
    ds_read_b64_tr_b16 v[244:245], v5 offset:24864
    v_mfma_f32_16x16x32_bf16 v[28:31], v[232:235], v[116:119], v[28:31]
    ds_read_b64_tr_b16 v[246:247], v5 offset:25888
    s_waitcnt lgkmcnt(4)
    v_mfma_f32_16x16x32_bf16 v[32:35], v[236:239], v[112:115], v[32:35]
    ds_read_b64_tr_b16 v[224:225], v4 offset:25088
    v_mfma_f32_16x16x32_bf16 v[36:39], v[236:239], v[116:119], v[36:39]
    ds_read_b64_tr_b16 v[226:227], v4 offset:26112
    s_mov_b32 s23, 0x6000
    buffer_load_dwordx4 v[96:99], v7, s[8:11], s23 offen offset:1024 sc1
    s_waitcnt lgkmcnt(4)
    v_mfma_f32_16x16x32_bf16 v[40:43], v[240:243], v[112:115], v[40:43]
    ds_read_b64_tr_b16 v[228:229], v5 offset:25120
    v_mfma_f32_16x16x32_bf16 v[44:47], v[240:243], v[116:119], v[44:47]
    ds_read_b64_tr_b16 v[230:231], v5 offset:26144
    s_waitcnt lgkmcnt(4)
    v_mfma_f32_16x16x32_bf16 v[48:51], v[244:247], v[112:115], v[48:51]
    ds_read_b64_tr_b16 v[232:233], v4 offset:25344
    v_mfma_f32_16x16x32_bf16 v[52:55], v[244:247], v[116:119], v[52:55]
    ds_read_b64_tr_b16 v[234:235], v4 offset:26368
    s_waitcnt lgkmcnt(4)
    v_mfma_f32_16x16x32_bf16 v[56:59], v[224:227], v[112:115], v[56:59]
    ds_read_b64_tr_b16 v[236:237], v5 offset:25376
    v_mfma_f32_16x16x32_bf16 v[60:63], v[224:227], v[116:119], v[60:63]
    ds_read_b64_tr_b16 v[238:239], v5 offset:26400
    s_waitcnt lgkmcnt(4)
    v_mfma_f32_16x16x32_bf16 v[64:67], v[228:231], v[112:115], v[64:67]
    v_mfma_f32_16x16x32_bf16 v[68:71], v[228:231], v[116:119], v[68:71]
    s_waitcnt vmcnt(9)
    s_barrier
    ds_read_b64_tr_b16 v[240:241], v4 offset:32768
    ds_read_b64_tr_b16 v[242:243], v4 offset:33792
    s_mov_b32 s23, 0xe000
    buffer_load_dwordx4 v[100:103], v7, s[8:11], s23 offen offset:1024 sc1
    s_waitcnt lgkmcnt(4)
    v_mfma_f32_16x16x32_bf16 v[72:75], v[232:235], v[112:115], v[72:75]
    ds_read_b64_tr_b16 v[244:245], v5 offset:32800
    v_mfma_f32_16x16x32_bf16 v[76:79], v[232:235], v[116:119], v[76:79]
    s_add_u32 s22, s19, 0x600000
    s_add_u32 m0, s20, 0x0
    s_nop 0
    buffer_load_dwordx4 v3, s[4:7], s22 offen lds
    ds_read_b64_tr_b16 v[246:247], v5 offset:33824
    s_waitcnt lgkmcnt(4)
    v_mfma_f32_16x16x32_bf16 v[80:83], v[236:239], v[112:115], v[80:83]
    ds_read_b64_tr_b16 v[224:225], v4 offset:33024
    v_mfma_f32_16x16x32_bf16 v[84:87], v[236:239], v[116:119], v[84:87]
    ds_read_b64_tr_b16 v[226:227], v4 offset:34048
    s_waitcnt lgkmcnt(4)
    v_mfma_f32_16x16x32_bf16 v[24:27], v[240:243], v[120:123], v[24:27]
    ds_read_b64_tr_b16 v[228:229], v5 offset:33056
    v_mfma_f32_16x16x32_bf16 v[28:31], v[240:243], v[124:127], v[28:31]
    ds_read_b64_tr_b16 v[230:231], v5 offset:34080
    s_waitcnt lgkmcnt(4)
    v_mfma_f32_16x16x32_bf16 v[32:35], v[244:247], v[120:123], v[32:35]
    ds_read_b64_tr_b16 v[232:233], v4 offset:33280
    v_mfma_f32_16x16x32_bf16 v[36:39], v[244:247], v[124:127], v[36:39]
    ds_read_b64_tr_b16 v[234:235], v4 offset:34304
    s_mov_b32 s23, 0x6800
    buffer_load_dwordx4 v[104:107], v7, s[8:11], s23 offen offset:0 sc1
    s_waitcnt lgkmcnt(4)
    v_mfma_f32_16x16x32_bf16 v[40:43], v[224:227], v[120:123], v[40:43]
    ds_read_b64_tr_b16 v[236:237], v5 offset:33312
    v_mfma_f32_16x16x32_bf16 v[44:47], v[224:227], v[124:127], v[44:47]
    s_add_u32 s22, s19, 0x608000
    s_add_u32 m0, s20, 0x400
    s_nop 0
    buffer_load_dwordx4 v3, s[4:7], s22 offen lds
    ds_read_b64_tr_b16 v[238:239], v5 offset:34336
    s_waitcnt lgkmcnt(4)
    v_mfma_f32_16x16x32_bf16 v[48:51], v[228:231], v[120:123], v[48:51]
    ds_read_b64_tr_b16 v[240:241], v4 offset:33536
    v_mfma_f32_16x16x32_bf16 v[52:55], v[228:231], v[124:127], v[52:55]
    ds_read_b64_tr_b16 v[242:243], v4 offset:34560
    s_waitcnt lgkmcnt(4)
    v_mfma_f32_16x16x32_bf16 v[56:59], v[232:235], v[120:123], v[56:59]
    ds_read_b64_tr_b16 v[244:245], v5 offset:33568
    v_mfma_f32_16x16x32_bf16 v[60:63], v[232:235], v[124:127], v[60:63]
    ds_read_b64_tr_b16 v[246:247], v5 offset:34592
    s_waitcnt lgkmcnt(4)
    v_mfma_f32_16x16x32_bf16 v[64:67], v[236:239], v[120:123], v[64:67]
    ds_read_b64_tr_b16 v[224:225], v4 offset:40960
    v_mfma_f32_16x16x32_bf16 v[68:71], v[236:239], v[124:127], v[68:71]
    ds_read_b64_tr_b16 v[226:227], v4 offset:41984
    s_mov_b32 s23, 0xe800
    buffer_load_dwordx4 v[108:111], v7, s[8:11], s23 offen offset:0 sc1
    s_waitcnt lgkmcnt(4)
    v_mfma_f32_16x16x32_bf16 v[72:75], v[240:243], v[120:123], v[72:75]
    ds_read_b64_tr_b16 v[228:229], v5 offset:40992
    v_mfma_f32_16x16x32_bf16 v[76:79], v[240:243], v[124:127], v[76:79]
    ds_read_b64_tr_b16 v[230:231], v5 offset:42016
    s_waitcnt lgkmcnt(4)
    v_mfma_f32_16x16x32_bf16 v[80:83], v[244:247], v[120:123], v[80:83]
    ds_read_b64_tr_b16 v[232:233], v4 offset:41216
    v_mfma_f32_16x16x32_bf16 v[84:87], v[244:247], v[124:127], v[84:87]
    ds_read_b64_tr_b16 v[234:235], v4 offset:42240
    s_waitcnt lgkmcnt(4)
    v_mfma_f32_16x16x32_bf16 v[24:27], v[224:227], v[128:131], v[24:27]
    ds_read_b64_tr_b16 v[236:237], v5 offset:41248
    s_add_u32 s22, s21, 0x0
    s_add_u32 m0, s20, 0x10000
    s_nop 0
    buffer_load_dwordx4 v2, s[8:11], s22 offen sc1 lds
    v_mfma_f32_16x16x32_bf16 v[28:31], v[224:227], v[132:135], v[28:31]
    ds_read_b64_tr_b16 v[238:239], v5 offset:42272
    s_waitcnt lgkmcnt(4)
    v_mfma_f32_16x16x32_bf16 v[32:35], v[228:231], v[128:131], v[32:35]
    ds_read_b64_tr_b16 v[240:241], v4 offset:41472
    v_mfma_f32_16x16x32_bf16 v[36:39], v[228:231], v[132:135], v[36:39]
    ds_read_b64_tr_b16 v[242:243], v4 offset:42496
    s_mov_b32 s23, 0x6800
    buffer_load_dwordx4 v[112:115], v7, s[8:11], s23 offen offset:1024 sc1
    s_waitcnt lgkmcnt(4)
    v_mfma_f32_16x16x32_bf16 v[40:43], v[232:235], v[128:131], v[40:43]
    ds_read_b64_tr_b16 v[244:245], v5 offset:41504
    s_add_u32 s22, s21, 0x400
    s_add_u32 m0, s20, 0x10400
    s_nop 0
    buffer_load_dwordx4 v2, s[8:11], s22 offen sc1 lds
    v_mfma_f32_16x16x32_bf16 v[44:47], v[232:235], v[132:135], v[44:47]
    ds_read_b64_tr_b16 v[246:247], v5 offset:42528
    s_waitcnt lgkmcnt(4)
    v_mfma_f32_16x16x32_bf16 v[48:51], v[236:239], v[128:131], v[48:51]
    ds_read_b64_tr_b16 v[224:225], v4 offset:41728
    v_mfma_f32_16x16x32_bf16 v[52:55], v[236:239], v[132:135], v[52:55]
    ds_read_b64_tr_b16 v[226:227], v4 offset:42752
    s_waitcnt lgkmcnt(4)
    v_mfma_f32_16x16x32_bf16 v[56:59], v[240:243], v[128:131], v[56:59]
    ds_read_b64_tr_b16 v[228:229], v5 offset:41760
    v_mfma_f32_16x16x32_bf16 v[60:63], v[240:243], v[132:135], v[60:63]
    ds_read_b64_tr_b16 v[230:231], v5 offset:42784
    s_waitcnt lgkmcnt(4)
    v_mfma_f32_16x16x32_bf16 v[64:67], v[244:247], v[128:131], v[64:67]
    v_mfma_f32_16x16x32_bf16 v[68:71], v[244:247], v[132:135], v[68:71]
    s_waitcnt vmcnt(11)
    s_barrier
    ds_read_b64_tr_b16 v[232:233], v4 offset:49152
    ds_read_b64_tr_b16 v[234:235], v4 offset:50176
    s_mov_b32 s23, 0xe800
    buffer_load_dwordx4 v[116:119], v7, s[8:11], s23 offen offset:1024 sc1
    s_waitcnt lgkmcnt(4)
    v_mfma_f32_16x16x32_bf16 v[72:75], v[224:227], v[128:131], v[72:75]
    ds_read_b64_tr_b16 v[236:237], v5 offset:49184
    v_mfma_f32_16x16x32_bf16 v[76:79], v[224:227], v[132:135], v[76:79]
    s_add_u32 s22, s19, 0x680000
    s_add_u32 m0, s20, 0x4000
    s_nop 0
    buffer_load_dwordx4 v3, s[4:7], s22 offen lds
    ds_read_b64_tr_b16 v[238:239], v5 offset:50208
    s_waitcnt lgkmcnt(4)
    v_mfma_f32_16x16x32_bf16 v[80:83], v[228:231], v[128:131], v[80:83]
    ds_read_b64_tr_b16 v[240:241], v4 offset:49408
    v_mfma_f32_16x16x32_bf16 v[84:87], v[228:231], v[132:135], v[84:87]
    ds_read_b64_tr_b16 v[242:243], v4 offset:50432
    s_waitcnt lgkmcnt(4)
    v_mfma_f32_16x16x32_bf16 v[24:27], v[232:235], v[136:139], v[24:27]
    ds_read_b64_tr_b16 v[244:245], v5 offset:49440
    v_mfma_f32_16x16x32_bf16 v[28:31], v[232:235], v[140:143], v[28:31]
    ds_read_b64_tr_b16 v[246:247], v5 offset:50464
    s_waitcnt lgkmcnt(4)
    v_mfma_f32_16x16x32_bf16 v[32:35], v[236:239], v[136:139], v[32:35]
    ds_read_b64_tr_b16 v[224:225], v4 offset:49664
    v_mfma_f32_16x16x32_bf16 v[36:39], v[236:239], v[140:143], v[36:39]
    ds_read_b64_tr_b16 v[226:227], v4 offset:50688
    s_mov_b32 s23, 0x7000
    buffer_load_dwordx4 v[120:123], v7, s[8:11], s23 offen offset:0 sc1
    s_waitcnt lgkmcnt(4)
    v_mfma_f32_16x16x32_bf16 v[40:43], v[240:243], v[136:139], v[40:43]
    ds_read_b64_tr_b16 v[228:229], v5 offset:49696
    v_mfma_f32_16x16x32_bf16 v[44:47], v[240:243], v[140:143], v[44:47]
    s_add_u32 s22, s19, 0x688000
    s_add_u32 m0, s20, 0x4400
    s_nop 0
    buffer_load_dwordx4 v3, s[4:7], s22 offen lds
    ds_read_b64_tr_b16 v[230:231], v5 offset:50720
    s_waitcnt lgkmcnt(4)
    v_mfma_f32_16x16x32_bf16 v[48:51], v[244:247], v[136:139], v[48:51]
    ds_read_b64_tr_b16 v[232:233], v4 offset:49920
    v_mfma_f32_16x16x32_bf16 v[52:55], v[244:247], v[140:143], v[52:55]
    ds_read_b64_tr_b16 v[234:235], v4 offset:50944
    s_waitcnt lgkmcnt(4)
    v_mfma_f32_16x16x32_bf16 v[56:59], v[224:227], v[136:139], v[56:59]
    ds_read_b64_tr_b16 v[236:237], v5 offset:49952
    v_mfma_f32_16x16x32_bf16 v[60:63], v[224:227], v[140:143], v[60:63]
    ds_read_b64_tr_b16 v[238:239], v5 offset:50976
    s_waitcnt lgkmcnt(4)
    v_mfma_f32_16x16x32_bf16 v[64:67], v[228:231], v[136:139], v[64:67]
    ds_read_b64_tr_b16 v[240:241], v4 offset:57344
    v_mfma_f32_16x16x32_bf16 v[68:71], v[228:231], v[140:143], v[68:71]
    ds_read_b64_tr_b16 v[242:243], v4 offset:58368
    s_mov_b32 s23, 0xf000
    buffer_load_dwordx4 v[124:127], v7, s[8:11], s23 offen offset:0 sc1
    s_waitcnt lgkmcnt(4)
    v_mfma_f32_16x16x32_bf16 v[72:75], v[232:235], v[136:139], v[72:75]
    ds_read_b64_tr_b16 v[244:245], v5 offset:57376
    v_mfma_f32_16x16x32_bf16 v[76:79], v[232:235], v[140:143], v[76:79]
    ds_read_b64_tr_b16 v[246:247], v5 offset:58400
    s_waitcnt lgkmcnt(4)
    v_mfma_f32_16x16x32_bf16 v[80:83], v[236:239], v[136:139], v[80:83]
    ds_read_b64_tr_b16 v[224:225], v4 offset:57600
    v_mfma_f32_16x16x32_bf16 v[84:87], v[236:239], v[140:143], v[84:87]
    ds_read_b64_tr_b16 v[226:227], v4 offset:58624
    s_waitcnt lgkmcnt(4)
    v_mfma_f32_16x16x32_bf16 v[24:27], v[240:243], v[144:147], v[24:27]
    ds_read_b64_tr_b16 v[228:229], v5 offset:57632
    s_add_u32 s22, s21, 0x4000
    s_add_u32 m0, s20, 0x14000
    s_nop 0
    buffer_load_dwordx4 v2, s[8:11], s22 offen sc1 lds
    v_mfma_f32_16x16x32_bf16 v[28:31], v[240:243], v[148:151], v[28:31]
    ds_read_b64_tr_b16 v[230:231], v5 offset:58656
    s_waitcnt lgkmcnt(4)
    v_mfma_f32_16x16x32_bf16 v[32:35], v[244:247], v[144:147], v[32:35]
    ds_read_b64_tr_b16 v[232:233], v4 offset:57856
    v_mfma_f32_16x16x32_bf16 v[36:39], v[244:247], v[148:151], v[36:39]
    ds_read_b64_tr_b16 v[234:235], v4 offset:58880
    s_mov_b32 s23, 0x7000
    buffer_load_dwordx4 v[128:131], v7, s[8:11], s23 offen offset:1024 sc1
    s_waitcnt lgkmcnt(4)
    v_mfma_f32_16x16x32_bf16 v[40:43], v[224:227], v[144:147], v[40:43]
    ds_read_b64_tr_b16 v[236:237], v5 offset:57888
    s_add_u32 s22, s21, 0x4400
    s_add_u32 m0, s20, 0x14400
    s_nop 0
    buffer_load_dwordx4 v2, s[8:11], s22 offen sc1 lds
    v_mfma_f32_16x16x32_bf16 v[44:47], v[224:227], v[148:151], v[44:47]
    ds_read_b64_tr_b16 v[238:239], v5 offset:58912
    s_waitcnt lgkmcnt(4)
    v_mfma_f32_16x16x32_bf16 v[48:51], v[228:231], v[144:147], v[48:51]
    ds_read_b64_tr_b16 v[240:241], v4 offset:58112
    v_mfma_f32_16x16x32_bf16 v[52:55], v[228:231], v[148:151], v[52:55]
    ds_read_b64_tr_b16 v[242:243], v4 offset:59136
    s_waitcnt lgkmcnt(4)
    v_mfma_f32_16x16x32_bf16 v[56:59], v[232:235], v[144:147], v[56:59]
    ds_read_b64_tr_b16 v[244:245], v5 offset:58144
    v_mfma_f32_16x16x32_bf16 v[60:63], v[232:235], v[148:151], v[60:63]
    ds_read_b64_tr_b16 v[246:247], v5 offset:59168
    s_waitcnt lgkmcnt(4)
    v_mfma_f32_16x16x32_bf16 v[64:67], v[236:239], v[144:147], v[64:67]
    v_mfma_f32_16x16x32_bf16 v[68:71], v[236:239], v[148:151], v[68:71]
    s_waitcnt vmcnt(12)
    s_barrier
    ds_read_b64_tr_b16 v[224:225], v4 offset:0
    ds_read_b64_tr_b16 v[226:227], v4 offset:1024
    s_mov_b32 s23, 0xf000
    buffer_load_dwordx4 v[132:135], v7, s[8:11], s23 offen offset:1024 sc1
    s_waitcnt lgkmcnt(4)
    v_mfma_f32_16x16x32_bf16 v[72:75], v[240:243], v[144:147], v[72:75]
    ds_read_b64_tr_b16 v[228:229], v5 offset:32
    v_mfma_f32_16x16x32_bf16 v[76:79], v[240:243], v[148:151], v[76:79]
    s_add_u32 s22, s19, 0x700000
    s_add_u32 m0, s20, 0x8000
    s_nop 0
    buffer_load_dwordx4 v3, s[4:7], s22 offen lds
    ds_read_b64_tr_b16 v[230:231], v5 offset:1056
    s_waitcnt lgkmcnt(4)
    v_mfma_f32_16x16x32_bf16 v[80:83], v[244:247], v[144:147], v[80:83]
    ds_read_b64_tr_b16 v[232:233], v4 offset:256
    v_mfma_f32_16x16x32_bf16 v[84:87], v[244:247], v[148:151], v[84:87]
    ds_read_b64_tr_b16 v[234:235], v4 offset:1280
    s_waitcnt lgkmcnt(4)
    v_mfma_f32_16x16x32_bf16 v[24:27], v[224:227], v[88:91], v[24:27]
    ds_read_b64_tr_b16 v[236:237], v5 offset:288
    v_mfma_f32_16x16x32_bf16 v[28:31], v[224:227], v[92:95], v[28:31]
    ds_read_b64_tr_b16 v[238:239], v5 offset:1312
    s_waitcnt lgkmcnt(4)
    v_mfma_f32_16x16x32_bf16 v[32:35], v[228:231], v[88:91], v[32:35]
    ds_read_b64_tr_b16 v[240:241], v4 offset:512
    v_mfma_f32_16x16x32_bf16 v[36:39], v[228:231], v[92:95], v[36:39]
    ds_read_b64_tr_b16 v[242:243], v4 offset:1536
    s_mov_b32 s23, 0x7800
    buffer_load_dwordx4 v[136:139], v7, s[8:11], s23 offen offset:0 sc1
    s_waitcnt lgkmcnt(4)
    v_mfma_f32_16x16x32_bf16 v[40:43], v[232:235], v[88:91], v[40:43]
    ds_read_b64_tr_b16 v[244:245], v5 offset:544
    v_mfma_f32_16x16x32_bf16 v[44:47], v[232:235], v[92:95], v[44:47]
    s_add_u32 s22, s19, 0x708000
    s_add_u32 m0, s20, 0x8400
    s_nop 0
    buffer_load_dwordx4 v3, s[4:7], s22 offen lds
    ds_read_b64_tr_b16 v[246:247], v5 offset:1568
    s_waitcnt lgkmcnt(4)
    v_mfma_f32_16x16x32_bf16 v[48:51], v[236:239], v[88:91], v[48:51]
    ds_read_b64_tr_b16 v[224:225], v4 offset:768
    v_mfma_f32_16x16x32_bf16 v[52:55], v[236:239], v[92:95], v[52:55]
    ds_read_b64_tr_b16 v[226:227], v4 offset:1792
    s_waitcnt lgkmcnt(4)
    v_mfma_f32_16x16x32_bf16 v[56:59], v[240:243], v[88:91], v[56:59]
    ds_read_b64_tr_b16 v[228:229], v5 offset:800
    v_mfma_f32_16x16x32_bf16 v[60:63], v[240:243], v[92:95], v[60:63]
    ds_read_b64_tr_b16 v[230:231], v5 offset:1824
    s_waitcnt lgkmcnt(4)
    v_mfma_f32_16x16x32_bf16 v[64:67], v[244:247], v[88:91], v[64:67]
    ds_read_b64_tr_b16 v[232:233], v4 offset:8192
    v_mfma_f32_16x16x32_bf16 v[68:71], v[244:247], v[92:95], v[68:71]
    ds_read_b64_tr_b16 v[234:235], v4 offset:9216
    s_mov_b32 s23, 0xf800
    buffer_load_dwordx4 v[140:143], v7, s[8:11], s23 offen offset:0 sc1
    s_waitcnt lgkmcnt(4)
    v_mfma_f32_16x16x32_bf16 v[72:75], v[224:227], v[88:91], v[72:75]
    ds_read_b64_tr_b16 v[236:237], v5 offset:8224
    v_mfma_f32_16x16x32_bf16 v[76:79], v[224:227], v[92:95], v[76:79]
    ds_read_b64_tr_b16 v[238:239], v5 offset:9248
    s_waitcnt lgkmcnt(4)
    v_mfma_f32_16x16x32_bf16 v[80:83], v[228:231], v[88:91], v[80:83]
    ds_read_b64_tr_b16 v[240:241], v4 offset:8448
    v_mfma_f32_16x16x32_bf16 v[84:87], v[228:231], v[92:95], v[84:87]
    ds_read_b64_tr_b16 v[242:243], v4 offset:9472
    s_waitcnt lgkmcnt(4)
    v_mfma_f32_16x16x32_bf16 v[24:27], v[232:235], v[96:99], v[24:27]
    ds_read_b64_tr_b16 v[244:245], v5 offset:8480
    s_add_u32 s22, s21, 0x8000
    s_add_u32 m0, s20, 0x18000
    s_nop 0
    buffer_load_dwordx4 v2, s[8:11], s22 offen sc1 lds
    v_mfma_f32_16x16x32_bf16 v[28:31], v[232:235], v[100:103], v[28:31]
    ds_read_b64_tr_b16 v[246:247], v5 offset:9504
    s_waitcnt lgkmcnt(4)
    v_mfma_f32_16x16x32_bf16 v[32:35], v[236:239], v[96:99], v[32:35]
    ds_read_b64_tr_b16 v[224:225], v4 offset:8704
    v_mfma_f32_16x16x32_bf16 v[36:39], v[236:239], v[100:103], v[36:39]
    ds_read_b64_tr_b16 v[226:227], v4 offset:9728
    s_mov_b32 s23, 0x7800
    buffer_load_dwordx4 v[144:147], v7, s[8:11], s23 offen offset:1024 sc1
    s_waitcnt lgkmcnt(4)
    v_mfma_f32_16x16x32_bf16 v[40:43], v[240:243], v[96:99], v[40:43]
    ds_read_b64_tr_b16 v[228:229], v5 offset:8736
    s_add_u32 s22, s21, 0x8400
    s_add_u32 m0, s20, 0x18400
    s_nop 0
    buffer_load_dwordx4 v2, s[8:11], s22 offen sc1 lds
    v_mfma_f32_16x16x32_bf16 v[44:47], v[240:243], v[100:103], v[44:47]
    ds_read_b64_tr_b16 v[230:231], v5 offset:9760
    s_waitcnt lgkmcnt(4)
    v_mfma_f32_16x16x32_bf16 v[48:51], v[244:247], v[96:99], v[48:51]
    ds_read_b64_tr_b16 v[232:233], v4 offset:8960
    v_mfma_f32_16x16x32_bf16 v[52:55], v[244:247], v[100:103], v[52:55]
    ds_read_b64_tr_b16 v[234:235], v4 offset:9984
    s_waitcnt lgkmcnt(4)
    v_mfma_f32_16x16x32_bf16 v[56:59], v[224:227], v[96:99], v[56:59]
    ds_read_b64_tr_b16 v[236:237], v5 offset:8992
    v_mfma_f32_16x16x32_bf16 v[60:63], v[224:227], v[100:103], v[60:63]
    ds_read_b64_tr_b16 v[238:239], v5 offset:10016
    s_waitcnt lgkmcnt(4)
    v_mfma_f32_16x16x32_bf16 v[64:67], v[228:231], v[96:99], v[64:67]
    v_mfma_f32_16x16x32_bf16 v[68:71], v[228:231], v[100:103], v[68:71]
    s_waitcnt vmcnt(12)
    s_barrier
    ds_read_b64_tr_b16 v[240:241], v4 offset:16384
    ds_read_b64_tr_b16 v[242:243], v4 offset:17408
    s_mov_b32 s23, 0xf800
    buffer_load_dwordx4 v[148:151], v7, s[8:11], s23 offen offset:1024 sc1
    s_waitcnt lgkmcnt(4)
    v_mfma_f32_16x16x32_bf16 v[72:75], v[232:235], v[96:99], v[72:75]
    ds_read_b64_tr_b16 v[244:245], v5 offset:16416
    v_mfma_f32_16x16x32_bf16 v[76:79], v[232:235], v[100:103], v[76:79]
    s_add_u32 s22, s19, 0x780000
    s_add_u32 m0, s20, 0xc000
    s_nop 0
    buffer_load_dwordx4 v3, s[4:7], s22 offen lds
    ds_read_b64_tr_b16 v[246:247], v5 offset:17440
    s_waitcnt lgkmcnt(4)
    v_mfma_f32_16x16x32_bf16 v[80:83], v[236:239], v[96:99], v[80:83]
    ds_read_b64_tr_b16 v[224:225], v4 offset:16640
    v_mfma_f32_16x16x32_bf16 v[84:87], v[236:239], v[100:103], v[84:87]
    ds_read_b64_tr_b16 v[226:227], v4 offset:17664
    s_waitcnt lgkmcnt(4)
    v_mfma_f32_16x16x32_bf16 v[24:27], v[240:243], v[104:107], v[24:27]
    ds_read_b64_tr_b16 v[228:229], v5 offset:16672
    v_mfma_f32_16x16x32_bf16 v[28:31], v[240:243], v[108:111], v[28:31]
    ds_read_b64_tr_b16 v[230:231], v5 offset:17696
    s_waitcnt lgkmcnt(4)
    v_mfma_f32_16x16x32_bf16 v[32:35], v[244:247], v[104:107], v[32:35]
    ds_read_b64_tr_b16 v[232:233], v4 offset:16896
    v_mfma_f32_16x16x32_bf16 v[36:39], v[244:247], v[108:111], v[36:39]
    ds_read_b64_tr_b16 v[234:235], v4 offset:17920
    s_waitcnt lgkmcnt(4)
    v_mfma_f32_16x16x32_bf16 v[40:43], v[224:227], v[104:107], v[40:43]
    ds_read_b64_tr_b16 v[236:237], v5 offset:16928
    v_mfma_f32_16x16x32_bf16 v[44:47], v[224:227], v[108:111], v[44:47]
    s_add_u32 s22, s19, 0x788000
    s_add_u32 m0, s20, 0xc400
    s_nop 0
    buffer_load_dwordx4 v3, s[4:7], s22 offen lds
    ds_read_b64_tr_b16 v[238:239], v5 offset:17952
    s_waitcnt lgkmcnt(4)
    v_mfma_f32_16x16x32_bf16 v[48:51], v[228:231], v[104:107], v[48:51]
    ds_read_b64_tr_b16 v[240:241], v4 offset:17152
    v_mfma_f32_16x16x32_bf16 v[52:55], v[228:231], v[108:111], v[52:55]
    ds_read_b64_tr_b16 v[242:243], v4 offset:18176
    s_waitcnt lgkmcnt(4)
    v_mfma_f32_16x16x32_bf16 v[56:59], v[232:235], v[104:107], v[56:59]
    ds_read_b64_tr_b16 v[244:245], v5 offset:17184
    v_mfma_f32_16x16x32_bf16 v[60:63], v[232:235], v[108:111], v[60:63]
    ds_read_b64_tr_b16 v[246:247], v5 offset:18208
    s_waitcnt lgkmcnt(4)
    v_mfma_f32_16x16x32_bf16 v[64:67], v[236:239], v[104:107], v[64:67]
    ds_read_b64_tr_b16 v[224:225], v4 offset:24576
    v_mfma_f32_16x16x32_bf16 v[68:71], v[236:239], v[108:111], v[68:71]
    ds_read_b64_tr_b16 v[226:227], v4 offset:25600
    s_waitcnt lgkmcnt(4)
    v_mfma_f32_16x16x32_bf16 v[72:75], v[240:243], v[104:107], v[72:75]
    ds_read_b64_tr_b16 v[228:229], v5 offset:24608
    v_mfma_f32_16x16x32_bf16 v[76:79], v[240:243], v[108:111], v[76:79]
    ds_read_b64_tr_b16 v[230:231], v5 offset:25632
    s_waitcnt lgkmcnt(4)
    v_mfma_f32_16x16x32_bf16 v[80:83], v[244:247], v[104:107], v[80:83]
    ds_read_b64_tr_b16 v[232:233], v4 offset:24832
    v_mfma_f32_16x16x32_bf16 v[84:87], v[244:247], v[108:111], v[84:87]
    ds_read_b64_tr_b16 v[234:235], v4 offset:25856
    s_waitcnt lgkmcnt(4)
    v_mfma_f32_16x16x32_bf16 v[24:27], v[224:227], v[112:115], v[24:27]
    ds_read_b64_tr_b16 v[236:237], v5 offset:24864
    s_add_u32 s22, s21, 0xc000
    s_add_u32 m0, s20, 0x1c000
    s_nop 0
    buffer_load_dwordx4 v2, s[8:11], s22 offen sc1 lds
    v_mfma_f32_16x16x32_bf16 v[28:31], v[224:227], v[116:119], v[28:31]
    ds_read_b64_tr_b16 v[238:239], v5 offset:25888
    s_waitcnt lgkmcnt(4)
    v_mfma_f32_16x16x32_bf16 v[32:35], v[228:231], v[112:115], v[32:35]
    ds_read_b64_tr_b16 v[240:241], v4 offset:25088
    v_mfma_f32_16x16x32_bf16 v[36:39], v[228:231], v[116:119], v[36:39]
    ds_read_b64_tr_b16 v[242:243], v4 offset:26112
    s_waitcnt lgkmcnt(4)
    v_mfma_f32_16x16x32_bf16 v[40:43], v[232:235], v[112:115], v[40:43]
    ds_read_b64_tr_b16 v[244:245], v5 offset:25120
    s_add_u32 s22, s21, 0xc400
    s_add_u32 m0, s20, 0x1c400
    s_nop 0
    buffer_load_dwordx4 v2, s[8:11], s22 offen sc1 lds
    v_mfma_f32_16x16x32_bf16 v[44:47], v[232:235], v[116:119], v[44:47]
    ds_read_b64_tr_b16 v[246:247], v5 offset:26144
    s_waitcnt lgkmcnt(4)
    v_mfma_f32_16x16x32_bf16 v[48:51], v[236:239], v[112:115], v[48:51]
    ds_read_b64_tr_b16 v[224:225], v4 offset:25344
    v_mfma_f32_16x16x32_bf16 v[52:55], v[236:239], v[116:119], v[52:55]
    ds_read_b64_tr_b16 v[226:227], v4 offset:26368
    s_waitcnt lgkmcnt(4)
    v_mfma_f32_16x16x32_bf16 v[56:59], v[240:243], v[112:115], v[56:59]
    ds_read_b64_tr_b16 v[228:229], v5 offset:25376
    v_mfma_f32_16x16x32_bf16 v[60:63], v[240:243], v[116:119], v[60:63]
    ds_read_b64_tr_b16 v[230:231], v5 offset:26400
    s_waitcnt lgkmcnt(4)
    v_mfma_f32_16x16x32_bf16 v[64:67], v[244:247], v[112:115], v[64:67]
    v_mfma_f32_16x16x32_bf16 v[68:71], v[244:247], v[116:119], v[68:71]
    s_waitcnt vmcnt(9)
    s_barrier
    ds_read_b64_tr_b16 v[232:233], v4 offset:32768
    ds_read_b64_tr_b16 v[234:235], v4 offset:33792
    s_waitcnt lgkmcnt(4)
    v_mfma_f32_16x16x32_bf16 v[72:75], v[224:227], v[112:115], v[72:75]
    ds_read_b64_tr_b16 v[236:237], v5 offset:32800
    v_mfma_f32_16x16x32_bf16 v[76:79], v[224:227], v[116:119], v[76:79]
    ds_read_b64_tr_b16 v[238:239], v5 offset:33824
    s_waitcnt lgkmcnt(4)
    v_mfma_f32_16x16x32_bf16 v[80:83], v[228:231], v[112:115], v[80:83]
    ds_read_b64_tr_b16 v[240:241], v4 offset:33024
    v_mfma_f32_16x16x32_bf16 v[84:87], v[228:231], v[116:119], v[84:87]
    ds_read_b64_tr_b16 v[242:243], v4 offset:34048
    s_waitcnt lgkmcnt(4)
    v_mfma_f32_16x16x32_bf16 v[24:27], v[232:235], v[120:123], v[24:27]
    ds_read_b64_tr_b16 v[244:245], v5 offset:33056
    v_mfma_f32_16x16x32_bf16 v[28:31], v[232:235], v[124:127], v[28:31]
    ds_read_b64_tr_b16 v[246:247], v5 offset:34080
    s_waitcnt lgkmcnt(4)
    v_mfma_f32_16x16x32_bf16 v[32:35], v[236:239], v[120:123], v[32:35]
    ds_read_b64_tr_b16 v[224:225], v4 offset:33280
    v_mfma_f32_16x16x32_bf16 v[36:39], v[236:239], v[124:127], v[36:39]
    ds_read_b64_tr_b16 v[226:227], v4 offset:34304
    s_waitcnt lgkmcnt(4)
    v_mfma_f32_16x16x32_bf16 v[40:43], v[240:243], v[120:123], v[40:43]
    ds_read_b64_tr_b16 v[228:229], v5 offset:33312
    v_mfma_f32_16x16x32_bf16 v[44:47], v[240:243], v[124:127], v[44:47]
    ds_read_b64_tr_b16 v[230:231], v5 offset:34336
    s_waitcnt lgkmcnt(4)
    v_mfma_f32_16x16x32_bf16 v[48:51], v[244:247], v[120:123], v[48:51]
    ds_read_b64_tr_b16 v[232:233], v4 offset:33536
    v_mfma_f32_16x16x32_bf16 v[52:55], v[244:247], v[124:127], v[52:55]
    ds_read_b64_tr_b16 v[234:235], v4 offset:34560
    s_waitcnt lgkmcnt(4)
    v_mfma_f32_16x16x32_bf16 v[56:59], v[224:227], v[120:123], v[56:59]
    ds_read_b64_tr_b16 v[236:237], v5 offset:33568
    v_mfma_f32_16x16x32_bf16 v[60:63], v[224:227], v[124:127], v[60:63]
    ds_read_b64_tr_b16 v[238:239], v5 offset:34592
    s_waitcnt lgkmcnt(4)
    v_mfma_f32_16x16x32_bf16 v[64:67], v[228:231], v[120:123], v[64:67]
    ds_read_b64_tr_b16 v[240:241], v4 offset:40960
    v_mfma_f32_16x16x32_bf16 v[68:71], v[228:231], v[124:127], v[68:71]
    ds_read_b64_tr_b16 v[242:243], v4 offset:41984
    s_waitcnt lgkmcnt(4)
    v_mfma_f32_16x16x32_bf16 v[72:75], v[232:235], v[120:123], v[72:75]
    ds_read_b64_tr_b16 v[244:245], v5 offset:40992
    v_mfma_f32_16x16x32_bf16 v[76:79], v[232:235], v[124:127], v[76:79]
    ds_read_b64_tr_b16 v[246:247], v5 offset:42016
    s_waitcnt lgkmcnt(4)
    v_mfma_f32_16x16x32_bf16 v[80:83], v[236:239], v[120:123], v[80:83]
    ds_read_b64_tr_b16 v[224:225], v4 offset:41216
    v_mfma_f32_16x16x32_bf16 v[84:87], v[236:239], v[124:127], v[84:87]
    ds_read_b64_tr_b16 v[226:227], v4 offset:42240
    s_waitcnt lgkmcnt(4)
    v_mfma_f32_16x16x32_bf16 v[24:27], v[240:243], v[128:131], v[24:27]
    ds_read_b64_tr_b16 v[228:229], v5 offset:41248
    v_mfma_f32_16x16x32_bf16 v[28:31], v[240:243], v[132:135], v[28:31]
    ds_read_b64_tr_b16 v[230:231], v5 offset:42272
    s_waitcnt lgkmcnt(4)
    v_mfma_f32_16x16x32_bf16 v[32:35], v[244:247], v[128:131], v[32:35]
    ds_read_b64_tr_b16 v[232:233], v4 offset:41472
    v_mfma_f32_16x16x32_bf16 v[36:39], v[244:247], v[132:135], v[36:39]
    ds_read_b64_tr_b16 v[234:235], v4 offset:42496
    s_waitcnt lgkmcnt(4)
    v_mfma_f32_16x16x32_bf16 v[40:43], v[224:227], v[128:131], v[40:43]
    ds_read_b64_tr_b16 v[236:237], v5 offset:41504
    v_mfma_f32_16x16x32_bf16 v[44:47], v[224:227], v[132:135], v[44:47]
    ds_read_b64_tr_b16 v[238:239], v5 offset:42528
    s_waitcnt lgkmcnt(4)
    v_mfma_f32_16x16x32_bf16 v[48:51], v[228:231], v[128:131], v[48:51]
    ds_read_b64_tr_b16 v[240:241], v4 offset:41728
    v_mfma_f32_16x16x32_bf16 v[52:55], v[228:231], v[132:135], v[52:55]
    ds_read_b64_tr_b16 v[242:243], v4 offset:42752
    s_waitcnt lgkmcnt(4)
    v_mfma_f32_16x16x32_bf16 v[56:59], v[232:235], v[128:131], v[56:59]
    ds_read_b64_tr_b16 v[244:245], v5 offset:41760
    v_mfma_f32_16x16x32_bf16 v[60:63], v[232:235], v[132:135], v[60:63]
    ds_read_b64_tr_b16 v[246:247], v5 offset:42784
    s_waitcnt lgkmcnt(4)
    v_mfma_f32_16x16x32_bf16 v[64:67], v[236:239], v[128:131], v[64:67]
    v_mfma_f32_16x16x32_bf16 v[68:71], v[236:239], v[132:135], v[68:71]
    s_waitcnt vmcnt(2)
    s_barrier
    ds_read_b64_tr_b16 v[224:225], v4 offset:49152
    ds_read_b64_tr_b16 v[226:227], v4 offset:50176
    s_waitcnt lgkmcnt(4)
    v_mfma_f32_16x16x32_bf16 v[72:75], v[240:243], v[128:131], v[72:75]
    ds_read_b64_tr_b16 v[228:229], v5 offset:49184
    v_mfma_f32_16x16x32_bf16 v[76:79], v[240:243], v[132:135], v[76:79]
    ds_read_b64_tr_b16 v[230:231], v5 offset:50208
    s_waitcnt lgkmcnt(4)
    v_mfma_f32_16x16x32_bf16 v[80:83], v[244:247], v[128:131], v[80:83]
    ds_read_b64_tr_b16 v[232:233], v4 offset:49408
    v_mfma_f32_16x16x32_bf16 v[84:87], v[244:247], v[132:135], v[84:87]
    ds_read_b64_tr_b16 v[234:235], v4 offset:50432
    s_waitcnt lgkmcnt(4)
    v_mfma_f32_16x16x32_bf16 v[24:27], v[224:227], v[136:139], v[24:27]
    ds_read_b64_tr_b16 v[236:237], v5 offset:49440
    v_mfma_f32_16x16x32_bf16 v[28:31], v[224:227], v[140:143], v[28:31]
    ds_read_b64_tr_b16 v[238:239], v5 offset:50464
    s_waitcnt lgkmcnt(4)
    v_mfma_f32_16x16x32_bf16 v[32:35], v[228:231], v[136:139], v[32:35]
    ds_read_b64_tr_b16 v[240:241], v4 offset:49664
    v_mfma_f32_16x16x32_bf16 v[36:39], v[228:231], v[140:143], v[36:39]
    ds_read_b64_tr_b16 v[242:243], v4 offset:50688
    s_waitcnt lgkmcnt(4)
    v_mfma_f32_16x16x32_bf16 v[40:43], v[232:235], v[136:139], v[40:43]
    ds_read_b64_tr_b16 v[244:245], v5 offset:49696
    v_mfma_f32_16x16x32_bf16 v[44:47], v[232:235], v[140:143], v[44:47]
    ds_read_b64_tr_b16 v[246:247], v5 offset:50720
    s_waitcnt lgkmcnt(4)
    v_mfma_f32_16x16x32_bf16 v[48:51], v[236:239], v[136:139], v[48:51]
    ds_read_b64_tr_b16 v[224:225], v4 offset:49920
    v_mfma_f32_16x16x32_bf16 v[52:55], v[236:239], v[140:143], v[52:55]
    ds_read_b64_tr_b16 v[226:227], v4 offset:50944
    s_waitcnt lgkmcnt(4)
    v_mfma_f32_16x16x32_bf16 v[56:59], v[240:243], v[136:139], v[56:59]
    ds_read_b64_tr_b16 v[228:229], v5 offset:49952
    v_mfma_f32_16x16x32_bf16 v[60:63], v[240:243], v[140:143], v[60:63]
    ds_read_b64_tr_b16 v[230:231], v5 offset:50976
    s_waitcnt lgkmcnt(4)
    v_mfma_f32_16x16x32_bf16 v[64:67], v[244:247], v[136:139], v[64:67]
    ds_read_b64_tr_b16 v[232:233], v4 offset:57344
    v_mfma_f32_16x16x32_bf16 v[68:71], v[244:247], v[140:143], v[68:71]
    ds_read_b64_tr_b16 v[234:235], v4 offset:58368
    s_waitcnt lgkmcnt(4)
    v_mfma_f32_16x16x32_bf16 v[72:75], v[224:227], v[136:139], v[72:75]
    ds_read_b64_tr_b16 v[236:237], v5 offset:57376
    v_mfma_f32_16x16x32_bf16 v[76:79], v[224:227], v[140:143], v[76:79]
    ds_read_b64_tr_b16 v[238:239], v5 offset:58400
    s_waitcnt lgkmcnt(4)
    v_mfma_f32_16x16x32_bf16 v[80:83], v[228:231], v[136:139], v[80:83]
    ds_read_b64_tr_b16 v[240:241], v4 offset:57600
    v_mfma_f32_16x16x32_bf16 v[84:87], v[228:231], v[140:143], v[84:87]
    ds_read_b64_tr_b16 v[242:243], v4 offset:58624
    s_waitcnt lgkmcnt(4)
    v_mfma_f32_16x16x32_bf16 v[24:27], v[232:235], v[144:147], v[24:27]
    ds_read_b64_tr_b16 v[244:245], v5 offset:57632
    v_mfma_f32_16x16x32_bf16 v[28:31], v[232:235], v[148:151], v[28:31]
    ds_read_b64_tr_b16 v[246:247], v5 offset:58656
    s_waitcnt lgkmcnt(4)
    v_mfma_f32_16x16x32_bf16 v[32:35], v[236:239], v[144:147], v[32:35]
    ds_read_b64_tr_b16 v[224:225], v4 offset:57856
    v_mfma_f32_16x16x32_bf16 v[36:39], v[236:239], v[148:151], v[36:39]
    ds_read_b64_tr_b16 v[226:227], v4 offset:58880
    s_waitcnt lgkmcnt(4)
    v_mfma_f32_16x16x32_bf16 v[40:43], v[240:243], v[144:147], v[40:43]
    ds_read_b64_tr_b16 v[228:229], v5 offset:57888
    v_mfma_f32_16x16x32_bf16 v[44:47], v[240:243], v[148:151], v[44:47]
    ds_read_b64_tr_b16 v[230:231], v5 offset:58912
    s_waitcnt lgkmcnt(4)
    v_mfma_f32_16x16x32_bf16 v[48:51], v[244:247], v[144:147], v[48:51]
    ds_read_b64_tr_b16 v[232:233], v4 offset:58112
    v_mfma_f32_16x16x32_bf16 v[52:55], v[244:247], v[148:151], v[52:55]
    ds_read_b64_tr_b16 v[234:235], v4 offset:59136
    s_waitcnt lgkmcnt(4)
    v_mfma_f32_16x16x32_bf16 v[56:59], v[224:227], v[144:147], v[56:59]
    ds_read_b64_tr_b16 v[236:237], v5 offset:58144
    v_mfma_f32_16x16x32_bf16 v[60:63], v[224:227], v[148:151], v[60:63]
    ds_read_b64_tr_b16 v[238:239], v5 offset:59168
    s_waitcnt lgkmcnt(4)
    v_mfma_f32_16x16x32_bf16 v[64:67], v[228:231], v[144:147], v[64:67]
    v_mfma_f32_16x16x32_bf16 v[68:71], v[228:231], v[148:151], v[68:71]
    s_waitcnt lgkmcnt(2)
    v_mfma_f32_16x16x32_bf16 v[72:75], v[232:235], v[144:147], v[72:75]
    v_mfma_f32_16x16x32_bf16 v[76:79], v[232:235], v[148:151], v[76:79]
    s_waitcnt lgkmcnt(0)
    v_mfma_f32_16x16x32_bf16 v[80:83], v[236:239], v[144:147], v[80:83]
    v_mfma_f32_16x16x32_bf16 v[84:87], v[236:239], v[148:151], v[84:87]
    s_mov_b32 s23, 0x3e0293ee
    v_mul_f32 v24, s23, v24
    v_mul_f32 v25, s23, v25
    v_mul_f32 v26, s23, v26
    v_mul_f32 v27, s23, v27
    v_mul_f32 v28, s23, v28
    v_mul_f32 v29, s23, v29
    v_mul_f32 v30, s23, v30
    v_mul_f32 v31, s23, v31
    v_mul_f32 v32, s23, v32
    v_mul_f32 v33, s23, v33
    v_mul_f32 v34, s23, v34
    v_mul_f32 v35, s23, v35
    v_mul_f32 v36, s23, v36
    v_mul_f32 v37, s23, v37
    v_mul_f32 v38, s23, v38
    v_mul_f32 v39, s23, v39
    v_cvt_pk_bf16_f32 v152, v24, v25
    v_cvt_pk_bf16_f32 v153, v26, v27
    v_cvt_pk_bf16_f32 v168, v28, v29
    v_cvt_pk_bf16_f32 v169, v30, v31
    v_cvt_pk_bf16_f32 v154, v32, v33
    v_cvt_pk_bf16_f32 v155, v34, v35
    v_cvt_pk_bf16_f32 v170, v36, v37
    v_cvt_pk_bf16_f32 v171, v38, v39
    v_add_u32 v4, 0x10000, v2
    v_add_u32 v5, 0x20000, v2
    s_barrier
    ds_read_b128 v[224:227], v4 offset:0
    ds_read_b128 v[228:231], v4 offset:1024
    ds_read_b128 v[232:235], v4 offset:2048
    ds_read_b128 v[236:239], v4 offset:3072
    v_mov_b32 v12, 0x3f803f80
    v_mov_b32 v13, 0x3f803f80
    v_mov_b32 v14, 0x3f803f80
    v_mov_b32 v15, 0x3f803f80
    s_waitcnt lgkmcnt(3)
    v_mfma_f32_16x16x32_bf16 v[184:187], v[224:227], v[152:155], 0
    v_mul_f32 v40, s23, v40
    v_mul_f32 v41, s23, v41
    v_mul_f32 v42, s23, v42
    v_mul_f32 v43, s23, v43
    v_mul_f32 v44, s23, v44
    v_mul_f32 v45, s23, v45
    v_mfma_f32_16x16x32_bf16 v[188:191], v[224:227], v[168:171], 0
    ds_read_b128 v[240:243], v4 offset:4096
    v_mul_f32 v46, s23, v46
    v_mul_f32 v47, s23, v47
    v_mul_f32 v48, s23, v48
    v_mul_f32 v49, s23, v49
    v_mul_f32 v50, s23, v50
    v_mul_f32 v51, s23, v51
    s_mov_b64 s[64:65], s[46:47]
    s_mov_b32 s66, 0x700000
    s_mov_b32 s67, 0x20000
    s_mov_b64 s[68:69], s[48:49]
    s_mov_b32 s70, 0x700000
    s_mov_b32 s71, 0x20000
    s_cmp_lt_u32 s2, 224
    s_cselect_b32 s66, 7340032, 0
    s_cselect_b32 s70, 7340032, 0
    s_and_b32 s29, s2, 7
    s_mul_i32 s29, s29, 28
    s_lshr_b32 s16, s2, 3
    s_add_u32 s29, s29, s16
    s_sub_u32 s16, s3, 4
    v_lshrrev_b32 v20, 3, v1
    v_lshlrev_b32 v20, 3, v20
    s_lshl_b32 s17, s16, 6
    v_add_u32 v20, s17, v20
    s_mov_b32 s17, 7168
    v_mul_lo_u32 v11, s17, v20
    v_and_b32 v20, 7, v1
    v_lshl_add_u32 v11, v20, 4, v11
    s_and_b32 s17, s29, 3
    s_mul_i32 s18, s17, 1835008
    s_lshr_b32 s17, s29, 2
    s_lshl_b32 s17, s17, 7
    s_add_u32 s18, s18, s17
    s_lshl_b32 s15, s16, 13
    s_waitcnt lgkmcnt(3)
    v_mfma_f32_16x16x32_bf16 v[192:195], v[228:231], v[152:155], 0
    s_add_u32 s22, s21, 0x10000
    s_add_u32 m0, s20, 0x20000
    s_nop 0
    buffer_load_dwordx4 v2, s[8:11], s22 offen sc1 lds
    v_mul_f32 v52, s23, v52
    v_mul_f32 v53, s23, v53
    v_mul_f32 v54, s23, v54
    v_mul_f32 v55, s23, v55
    v_cvt_pk_bf16_f32 v156, v40, v41
    v_cvt_pk_bf16_f32 v157, v42, v43
    s_mov_b64 s[76:77], s[54:55]
    s_mov_b32 s78, 0xc00000
    s_mov_b32 s79, 0x20000
    v_bfe_u32 v20, v1, 2, 2
    v_lshlrev_b32 v20, 12, v20
    v_add_u32 v6, v3, v20
    s_lshr_b32 s16, s2, 5
    s_lshl_b32 s16, s16, 7
    s_lshl_b32 s17, s3, 3
    s_add_u32 s16, s16, s17
    s_mul_i32 s14, s16, 12288
    s_and_b32 s16, s2, 31
    s_lshl_b32 s16, s16, 8
    s_add_u32 s14, s14, s16
    s_add_u32 s14, s14, 4096
    v_mfma_f32_16x16x32_bf16 v[196:199], v[228:231], v[168:171], 0
    ds_read_b128 v[244:247], v4 offset:5120
    v_cvt_pk_bf16_f32 v172, v44, v45
    v_cvt_pk_bf16_f32 v173, v46, v47
    v_cvt_pk_bf16_f32 v158, v48, v49
    v_cvt_pk_bf16_f32 v159, v50, v51
    v_cvt_pk_bf16_f32 v174, v52, v53
    v_cvt_pk_bf16_f32 v175, v54, v55
    s_waitcnt lgkmcnt(3)
    v_mfma_f32_16x16x32_bf16 v[184:187], v[232:235], v[156:159], v[184:187]
    v_mul_f32 v56, s23, v56
    v_mul_f32 v57, s23, v57
    v_mul_f32 v58, s23, v58
    v_mul_f32 v59, s23, v59
    v_mul_f32 v60, s23, v60
    v_mul_f32 v61, s23, v61
    v_mfma_f32_16x16x32_bf16 v[188:191], v[232:235], v[172:175], v[188:191]
    ds_read_b128 v[224:227], v4 offset:6144
    v_mul_f32 v62, s23, v62
    v_mul_f32 v63, s23, v63
    v_mul_f32 v64, s23, v64
    v_mul_f32 v65, s23, v65
    v_mul_f32 v66, s23, v66
    v_mul_f32 v67, s23, v67
    s_waitcnt lgkmcnt(3)
    v_mfma_f32_16x16x32_bf16 v[192:195], v[236:239], v[156:159], v[192:195]
    v_mul_f32 v68, s23, v68
    v_mul_f32 v69, s23, v69
    v_mul_f32 v70, s23, v70
    v_mul_f32 v71, s23, v71
    v_cvt_pk_bf16_f32 v160, v56, v57
    v_cvt_pk_bf16_f32 v161, v58, v59
    v_mfma_f32_16x16x32_bf16 v[196:199], v[236:239], v[172:175], v[196:199]
    ds_read_b128 v[228:231], v4 offset:7168
    v_cvt_pk_bf16_f32 v176, v60, v61
    v_cvt_pk_bf16_f32 v177, v62, v63
    v_cvt_pk_bf16_f32 v162, v64, v65
    v_cvt_pk_bf16_f32 v163, v66, v67
    v_cvt_pk_bf16_f32 v178, v68, v69
    v_cvt_pk_bf16_f32 v179, v70, v71
    s_waitcnt lgkmcnt(3)
    v_mfma_f32_16x16x32_bf16 v[184:187], v[240:243], v[160:163], v[184:187]
    v_mul_f32 v72, s23, v72
    v_mul_f32 v73, s23, v73
    v_mul_f32 v74, s23, v74
    v_mul_f32 v75, s23, v75
    v_mul_f32 v76, s23, v76
    v_mul_f32 v77, s23, v77
    v_mfma_f32_16x16x32_bf16 v[188:191], v[240:243], v[176:179], v[188:191]
    ds_read_b128 v[232:235], v4 offset:8192
    v_mul_f32 v78, s23, v78
    v_mul_f32 v79, s23, v79
    v_mul_f32 v80, s23, v80
    v_mul_f32 v81, s23, v81
    v_mul_f32 v82, s23, v82
    v_mul_f32 v83, s23, v83
    s_waitcnt lgkmcnt(3)
    v_mfma_f32_16x16x32_bf16 v[192:195], v[244:247], v[160:163], v[192:195]
    s_add_u32 s22, s21, 0x10400
    s_add_u32 m0, s20, 0x20400
    s_nop 0
    buffer_load_dwordx4 v2, s[8:11], s22 offen sc1 lds
    v_mul_f32 v84, s23, v84
    v_mul_f32 v85, s23, v85
    v_mul_f32 v86, s23, v86
    v_mul_f32 v87, s23, v87
    v_cvt_pk_bf16_f32 v164, v72, v73
    v_cvt_pk_bf16_f32 v165, v74, v75
    v_mfma_f32_16x16x32_bf16 v[196:199], v[244:247], v[176:179], v[196:199]
    ds_read_b128 v[236:239], v4 offset:9216
    v_cvt_pk_bf16_f32 v180, v76, v77
    v_cvt_pk_bf16_f32 v181, v78, v79
    v_cvt_pk_bf16_f32 v166, v80, v81
    v_cvt_pk_bf16_f32 v167, v82, v83
    v_cvt_pk_bf16_f32 v182, v84, v85
    v_cvt_pk_bf16_f32 v183, v86, v87
    s_waitcnt lgkmcnt(3)
    v_mfma_f32_16x16x32_bf16 v[184:187], v[224:227], v[164:167], v[184:187]
    v_mfma_f32_16x16x32_bf16 v[188:191], v[224:227], v[180:183], v[188:191]
    ds_read_b128 v[240:243], v4 offset:10240
    s_waitcnt lgkmcnt(3)
    v_mfma_f32_16x16x32_bf16 v[192:195], v[228:231], v[164:167], v[192:195]
    v_mfma_f32_16x16x32_bf16 v[196:199], v[228:231], v[180:183], v[196:199]
    ds_read_b128 v[244:247], v4 offset:11264
    s_waitcnt lgkmcnt(3)
    v_mfma_f32_16x16x32_bf16 v[200:203], v[232:235], v[152:155], 0
    v_mfma_f32_16x16x32_bf16 v[204:207], v[232:235], v[168:171], 0
    ds_read_b128 v[224:227], v4 offset:12288
    s_waitcnt lgkmcnt(3)
    v_mfma_f32_16x16x32_bf16 v[208:211], v[236:239], v[152:155], 0
    v_mfma_f32_16x16x32_bf16 v[212:215], v[236:239], v[168:171], 0
    ds_read_b128 v[228:231], v4 offset:13312
    s_waitcnt lgkmcnt(3)
    v_mfma_f32_16x16x32_bf16 v[200:203], v[240:243], v[156:159], v[200:203]
    v_mfma_f32_16x16x32_bf16 v[204:207], v[240:243], v[172:175], v[204:207]
    ds_read_b128 v[232:235], v4 offset:14336
    s_waitcnt lgkmcnt(3)
    v_mfma_f32_16x16x32_bf16 v[208:211], v[244:247], v[156:159], v[208:211]
    v_max3_f32 v16, v184, v185, v186
    v_mfma_f32_16x16x32_bf16 v[212:215], v[244:247], v[172:175], v[212:215]
    ds_read_b128 v[236:239], v4 offset:15360
    v_max3_f32 v16, v16, v187, v192
    s_waitcnt lgkmcnt(3)
    v_mfma_f32_16x16x32_bf16 v[200:203], v[224:227], v[160:163], v[200:203]
    v_max3_f32 v16, v16, v193, v194
    v_mfma_f32_16x16x32_bf16 v[204:207], v[224:227], v[176:179], v[204:207]
    s_barrier
    ds_read_b128 v[240:243], v4 offset:16384
    v_max_f32 v16, v16, v195
    s_waitcnt lgkmcnt(3)
    v_mfma_f32_16x16x32_bf16 v[208:211], v[228:231], v[160:163], v[208:211]
    v_max3_f32 v17, v188, v189, v190
    v_mfma_f32_16x16x32_bf16 v[212:215], v[228:231], v[176:179], v[212:215]
    s_add_u32 s22, s21, 0x14000
    s_add_u32 m0, s20, 0x24000
    s_nop 0
    buffer_load_dwordx4 v2, s[8:11], s22 offen sc1 lds
    ds_read_b128 v[244:247], v4 offset:17408
    v_max3_f32 v17, v17, v191, v196
    s_waitcnt lgkmcnt(3)
    v_mfma_f32_16x16x32_bf16 v[200:203], v[232:235], v[164:167], v[200:203]
    v_max3_f32 v17, v17, v197, v198
    v_mfma_f32_16x16x32_bf16 v[204:207], v[232:235], v[180:183], v[204:207]
    ds_read_b128 v[224:227], v4 offset:18432
    v_max_f32 v17, v17, v199
    s_waitcnt lgkmcnt(3)
    v_mfma_f32_16x16x32_bf16 v[208:211], v[236:239], v[164:167], v[208:211]
    s_mov_b64 s[72:73], s[40:41]
    s_mov_b32 s74, 0x800000
    s_mov_b32 s75, 0x20000
    v_lshlrev_b32 v21, 7, v1
    s_lshl_b32 s16, s2, 2
    s_add_u32 s16, s16, s3
    s_sub_u32 s16, s16, 4
    s_lshl_b32 s16, s16, 13
    buffer_load_dword v7, v21, s[72:75], s16 offen
    v_mfma_f32_16x16x32_bf16 v[212:215], v[236:239], v[180:183], v[212:215]
    ds_read_b128 v[228:231], v4 offset:19456
    v_max3_f32 v16, v16, v200, v201
    v_max3_f32 v16, v16, v202, v203
    v_max3_f32 v16, v16, v208, v209
    v_max3_f32 v16, v16, v210, v211
    v_max3_f32 v17, v17, v204, v205
    v_max3_f32 v17, v17, v206, v207
    s_nop 0
    v_max3_f32 v17, v17, v212, v213
    v_max3_f32 v17, v17, v214, v215
    v_mov_b32 v18, v16
    v_mov_b32 v19, v17
    s_nop 0
    v_permlane16_swap_b32 v16, v18
    v_permlane16_swap_b32 v17, v19
    v_max_f32 v16, v16, v18
    v_max_f32 v17, v17, v19
    v_mov_b32 v18, v16
    v_mov_b32 v19, v17
    s_nop 0
    v_permlane32_swap_b32 v16, v18
    v_permlane32_swap_b32 v17, v19
    v_max_f32 v16, v16, v18
    v_max_f32 v17, v17, v19
    v_sub_f32 v216, 0, v16
    v_sub_f32 v217, 0, v16
    v_sub_f32 v218, 0, v16
    v_sub_f32 v219, 0, v16
    v_sub_f32 v220, 0, v17
    v_sub_f32 v221, 0, v17
    v_sub_f32 v222, 0, v17
    v_sub_f32 v223, 0, v17
    v_add_f32 v184, v184, v216
    v_add_f32 v185, v185, v216
    v_exp_f32 v184, v184
    v_exp_f32 v185, v185
    v_add_f32 v186, v186, v216
    v_add_f32 v187, v187, v216
    v_exp_f32 v186, v186
    v_exp_f32 v187, v187
    v_cvt_pk_bf16_f32 v24, v184, v185
    v_add_f32 v188, v188, v220
    v_add_f32 v189, v189, v220
    v_exp_f32 v188, v188
    v_exp_f32 v189, v189
    v_cvt_pk_bf16_f32 v25, v186, v187
    v_add_f32 v190, v190, v220
    v_add_f32 v191, v191, v220
    v_exp_f32 v190, v190
    v_exp_f32 v191, v191
    v_cvt_pk_bf16_f32 v28, v188, v189
    v_add_f32 v192, v192, v216
    v_add_f32 v193, v193, v216
    v_exp_f32 v192, v192
    v_exp_f32 v193, v193
    v_cvt_pk_bf16_f32 v29, v190, v191
    v_add_f32 v194, v194, v216
    v_add_f32 v195, v195, v216
    v_exp_f32 v194, v194
    v_exp_f32 v195, v195
    v_cvt_pk_bf16_f32 v26, v192, v193
    v_add_f32 v196, v196, v220
    v_add_f32 v197, v197, v220
    v_exp_f32 v196, v196
    v_exp_f32 v197, v197
    v_cvt_pk_bf16_f32 v27, v194, v195
    v_add_f32 v198, v198, v220
    v_add_f32 v199, v199, v220
    v_exp_f32 v198, v198
    v_exp_f32 v199, v199
    v_cvt_pk_bf16_f32 v30, v196, v197
    v_cvt_pk_bf16_f32 v31, v198, v199
    s_waitcnt lgkmcnt(3)
    v_mfma_f32_16x16x32_bf16 v[184:187], v[240:243], v[152:155], v[216:219]
    v_mfma_f32_16x16x32_bf16 v[188:191], v[240:243], v[168:171], v[220:223]
    ds_read_b128 v[232:235], v4 offset:20480
    v_add_f32 v200, v200, v216
    v_add_f32 v201, v201, v216
    v_exp_f32 v200, v200
    v_mfma_f32_16x16x32_bf16 v[248:251], v[12:15], v[24:27], 0
    s_waitcnt lgkmcnt(3)
    v_mfma_f32_16x16x32_bf16 v[192:195], v[244:247], v[152:155], v[216:219]
    v_exp_f32 v201, v201
    v_add_f32 v202, v202, v216
    v_add_f32 v203, v203, v216
    v_mfma_f32_16x16x32_bf16 v[196:199], v[244:247], v[168:171], v[220:223]
    s_add_u32 s22, s21, 0x14400
    s_add_u32 m0, s20, 0x24400
    s_nop 0
    buffer_load_dwordx4 v2, s[8:11], s22 offen sc1 lds
    ds_read_b128 v[236:239], v4 offset:21504
    v_exp_f32 v202, v202
    v_exp_f32 v203, v203
    v_mfma_f32_16x16x32_bf16 v[252:255], v[12:15], v[28:31], 0
    s_waitcnt lgkmcnt(3)
    v_mfma_f32_16x16x32_bf16 v[184:187], v[224:227], v[156:159], v[184:187]
    v_cvt_pk_bf16_f32 v32, v200, v201
    v_add_f32 v204, v204, v220
    v_add_f32 v205, v205, v220
    v_mfma_f32_16x16x32_bf16 v[188:191], v[224:227], v[172:175], v[188:191]
    ds_read_b128 v[240:243], v4 offset:22528
    v_exp_f32 v204, v204
    v_exp_f32 v205, v205
    v_cvt_pk_bf16_f32 v33, v202, v203
    s_mov_b64 s[4:5], s[40:41]
    s_mov_b32 s6, 0x800000
    s_mov_b32 s7, 0x20000
    v_bfe_u32 v20, v1, 2, 2
    v_lshlrev_b32 v21, 13, v20
    v_sub_u32 v3, v3, v21
    v_lshl_add_u32 v3, v20, 11, v3
    s_and_b32 s16, s2, 1
    s_lshl_b32 s24, s16, 22
    s_lshr_b32 s16, s2, 5
    s_lshl_b32 s16, s16, 8
    s_add_u32 s24, s24, s16
    s_lshl_b32 s16, s3, 14
    s_add_u32 s24, s24, s16
    s_add_u32 s24, s24, 196608
    s_waitcnt lgkmcnt(3)
    v_mfma_f32_16x16x32_bf16 v[192:195], v[228:231], v[156:159], v[192:195]
    v_add_f32 v206, v206, v220
    v_add_f32 v207, v207, v220
    v_mfma_f32_16x16x32_bf16 v[196:199], v[228:231], v[172:175], v[196:199]
    ds_read_b128 v[244:247], v4 offset:23552
    v_exp_f32 v206, v206
    v_exp_f32 v207, v207
    v_cvt_pk_bf16_f32 v36, v204, v205
    s_waitcnt lgkmcnt(3)
    v_mfma_f32_16x16x32_bf16 v[184:187], v[232:235], v[160:163], v[184:187]
    v_add_f32 v208, v208, v216
    v_add_f32 v209, v209, v216
    v_exp_f32 v208, v208
    v_mfma_f32_16x16x32_bf16 v[188:191], v[232:235], v[176:179], v[188:191]
    ds_read_b128 v[224:227], v4 offset:24576
    v_exp_f32 v209, v209
    v_cvt_pk_bf16_f32 v37, v206, v207
    s_waitcnt lgkmcnt(3)
    v_mfma_f32_16x16x32_bf16 v[192:195], v[236:239], v[160:163], v[192:195]
    v_add_f32 v210, v210, v216
    v_add_f32 v211, v211, v216
    v_exp_f32 v210, v210
    v_mfma_f32_16x16x32_bf16 v[196:199], v[236:239], v[176:179], v[196:199]
    ds_read_b128 v[228:231], v4 offset:25600
    v_exp_f32 v211, v211
    v_cvt_pk_bf16_f32 v34, v208, v209
    v_add_f32 v212, v212, v220
    s_waitcnt lgkmcnt(3)
    v_mfma_f32_16x16x32_bf16 v[184:187], v[240:243], v[164:167], v[184:187]
    v_add_f32 v213, v213, v220
    v_exp_f32 v212, v212
    v_mfma_f32_16x16x32_bf16 v[188:191], v[240:243], v[180:183], v[188:191]
    ds_read_b128 v[232:235], v4 offset:26624
    v_exp_f32 v213, v213
    v_cvt_pk_bf16_f32 v35, v210, v211
    v_add_f32 v214, v214, v220
    s_waitcnt lgkmcnt(3)
    v_mfma_f32_16x16x32_bf16 v[192:195], v[244:247], v[164:167], v[192:195]
    v_add_f32 v215, v215, v220
    v_exp_f32 v214, v214
    v_exp_f32 v215, v215
    v_mfma_f32_16x16x32_bf16 v[196:199], v[244:247], v[180:183], v[196:199]
    ds_read_b128 v[236:239], v4 offset:27648
    v_cvt_pk_bf16_f32 v38, v212, v213
    v_cvt_pk_bf16_f32 v39, v214, v215
    s_waitcnt lgkmcnt(3)
    v_mfma_f32_16x16x32_bf16 v[200:203], v[224:227], v[152:155], v[216:219]
    v_mfma_f32_16x16x32_bf16 v[204:207], v[224:227], v[168:171], v[220:223]
    ds_read_b128 v[240:243], v4 offset:28672
    v_exp_f32 v184, v184
    v_exp_f32 v185, v185
    v_mfma_f32_16x16x32_bf16 v[248:251], v[12:15], v[32:35], v[248:251]
    s_waitcnt lgkmcnt(3)
    v_mfma_f32_16x16x32_bf16 v[208:211], v[228:231], v[152:155], v[216:219]
    v_exp_f32 v186, v186
    v_exp_f32 v187, v187
    v_mfma_f32_16x16x32_bf16 v[212:215], v[228:231], v[168:171], v[220:223]
    ds_read_b128 v[244:247], v4 offset:29696
    v_cvt_pk_bf16_f32 v40, v184, v185
    v_mfma_f32_16x16x32_bf16 v[252:255], v[12:15], v[36:39], v[252:255]
    s_waitcnt lgkmcnt(3)
    v_mfma_f32_16x16x32_bf16 v[200:203], v[232:235], v[156:159], v[200:203]
    v_exp_f32 v188, v188
    v_exp_f32 v189, v189
    v_mfma_f32_16x16x32_bf16 v[204:207], v[232:235], v[172:175], v[204:207]
    ds_read_b128 v[224:227], v4 offset:30720
    v_cvt_pk_bf16_f32 v41, v186, v187
    s_waitcnt lgkmcnt(3)
    v_mfma_f32_16x16x32_bf16 v[208:211], v[236:239], v[156:159], v[208:211]
    v_exp_f32 v190, v190
    v_exp_f32 v191, v191
    v_mfma_f32_16x16x32_bf16 v[212:215], v[236:239], v[172:175], v[212:215]
    ds_read_b128 v[228:231], v4 offset:31744
    v_cvt_pk_bf16_f32 v44, v188, v189
    v_exp_f32 v192, v192
    s_waitcnt lgkmcnt(3)
    v_mfma_f32_16x16x32_bf16 v[200:203], v[240:243], v[160:163], v[200:203]
    v_exp_f32 v193, v193
    v_mfma_f32_16x16x32_bf16 v[204:207], v[240:243], v[176:179], v[204:207]
    s_barrier
    ds_read_b128 v[232:235], v4 offset:32768
    v_cvt_pk_bf16_f32 v45, v190, v191
    v_exp_f32 v194, v194
    s_waitcnt lgkmcnt(3)
    v_mfma_f32_16x16x32_bf16 v[208:211], v[244:247], v[160:163], v[208:211]
    v_exp_f32 v195, v195
    v_mfma_f32_16x16x32_bf16 v[212:215], v[244:247], v[176:179], v[212:215]
    s_add_u32 s22, s21, 0x18000
    s_add_u32 m0, s20, 0x10000
    s_nop 0
    buffer_load_dwordx4 v2, s[8:11], s22 offen sc1 lds
    ds_read_b128 v[236:239], v4 offset:33792
    v_cvt_pk_bf16_f32 v42, v192, v193
    v_exp_f32 v196, v196
    s_waitcnt lgkmcnt(3)
    v_mfma_f32_16x16x32_bf16 v[200:203], v[224:227], v[164:167], v[200:203]
    v_exp_f32 v197, v197
    v_cvt_pk_bf16_f32 v43, v194, v195
    v_mfma_f32_16x16x32_bf16 v[204:207], v[224:227], v[180:183], v[204:207]
    ds_read_b128 v[240:243], v4 offset:34816
    v_exp_f32 v198, v198
    s_waitcnt lgkmcnt(3)
    v_mfma_f32_16x16x32_bf16 v[208:211], v[228:231], v[164:167], v[208:211]
    v_exp_f32 v199, v199
    v_cvt_pk_bf16_f32 v46, v196, v197
    v_mfma_f32_16x16x32_bf16 v[212:215], v[228:231], v[180:183], v[212:215]
    ds_read_b128 v[244:247], v4 offset:35840
    v_cvt_pk_bf16_f32 v47, v198, v199
    s_waitcnt lgkmcnt(3)
    v_mfma_f32_16x16x32_bf16 v[184:187], v[232:235], v[152:155], v[216:219]
    v_mfma_f32_16x16x32_bf16 v[188:191], v[232:235], v[168:171], v[220:223]
    ds_read_b128 v[224:227], v4 offset:36864
    v_exp_f32 v200, v200
    v_exp_f32 v201, v201
    v_mfma_f32_16x16x32_bf16 v[248:251], v[12:15], v[40:43], v[248:251]
    s_waitcnt lgkmcnt(3)
    v_mfma_f32_16x16x32_bf16 v[192:195], v[236:239], v[152:155], v[216:219]
    v_exp_f32 v202, v202
    v_exp_f32 v203, v203
    v_mfma_f32_16x16x32_bf16 v[196:199], v[236:239], v[168:171], v[220:223]
    s_add_u32 s22, s21, 0x18400
    s_add_u32 m0, s20, 0x10400
    s_nop 0
    buffer_load_dwordx4 v2, s[8:11], s22 offen sc1 lds
    ds_read_b128 v[228:231], v4 offset:37888
    v_cvt_pk_bf16_f32 v48, v200, v201
    v_mfma_f32_16x16x32_bf16 v[252:255], v[12:15], v[44:47], v[252:255]
    s_waitcnt lgkmcnt(3)
    v_mfma_f32_16x16x32_bf16 v[184:187], v[240:243], v[156:159], v[184:187]
    v_exp_f32 v204, v204
    v_exp_f32 v205, v205
    v_mfma_f32_16x16x32_bf16 v[188:191], v[240:243], v[172:175], v[188:191]
    ds_read_b128 v[232:235], v4 offset:38912
    v_cvt_pk_bf16_f32 v49, v202, v203
    s_waitcnt lgkmcnt(3)
    v_mfma_f32_16x16x32_bf16 v[192:195], v[244:247], v[156:159], v[192:195]
    v_exp_f32 v206, v206
    v_exp_f32 v207, v207
    v_mfma_f32_16x16x32_bf16 v[196:199], v[244:247], v[172:175], v[196:199]
    ds_read_b128 v[236:239], v4 offset:39936
    v_cvt_pk_bf16_f32 v52, v204, v205
    v_exp_f32 v208, v208
    s_waitcnt lgkmcnt(3)
    v_mfma_f32_16x16x32_bf16 v[184:187], v[224:227], v[160:163], v[184:187]
    v_exp_f32 v209, v209
    v_mfma_f32_16x16x32_bf16 v[188:191], v[224:227], v[176:179], v[188:191]
    ds_read_b128 v[240:243], v4 offset:40960
    v_cvt_pk_bf16_f32 v53, v206, v207
    v_exp_f32 v210, v210
    s_waitcnt lgkmcnt(3)
    v_mfma_f32_16x16x32_bf16 v[192:195], v[228:231], v[160:163], v[192:195]
    v_exp_f32 v211, v211
    v_mfma_f32_16x16x32_bf16 v[196:199], v[228:231], v[176:179], v[196:199]
    ds_read_b128 v[244:247], v4 offset:41984
    v_cvt_pk_bf16_f32 v50, v208, v209
    v_exp_f32 v212, v212
    s_waitcnt lgkmcnt(3)
    v_mfma_f32_16x16x32_bf16 v[184:187], v[232:235], v[164:167], v[184:187]
    v_exp_f32 v213, v213
    v_cvt_pk_bf16_f32 v51, v210, v211
    v_mfma_f32_16x16x32_bf16 v[188:191], v[232:235], v[180:183], v[188:191]
    ds_read_b128 v[224:227], v4 offset:43008
    v_exp_f32 v214, v214
    s_waitcnt lgkmcnt(3)
    v_mfma_f32_16x16x32_bf16 v[192:195], v[236:239], v[164:167], v[192:195]
    v_exp_f32 v215, v215
    v_cvt_pk_bf16_f32 v54, v212, v213
    v_mfma_f32_16x16x32_bf16 v[196:199], v[236:239], v[180:183], v[196:199]
    ds_read_b128 v[228:231], v4 offset:44032
    v_cvt_pk_bf16_f32 v55, v214, v215
    s_waitcnt lgkmcnt(3)
    v_mfma_f32_16x16x32_bf16 v[200:203], v[240:243], v[152:155], v[216:219]
    v_mfma_f32_16x16x32_bf16 v[204:207], v[240:243], v[168:171], v[220:223]
    ds_read_b128 v[232:235], v4 offset:45056
    v_exp_f32 v184, v184
    v_exp_f32 v185, v185
    v_mfma_f32_16x16x32_bf16 v[248:251], v[12:15], v[48:51], v[248:251]
    s_waitcnt lgkmcnt(3)
    v_mfma_f32_16x16x32_bf16 v[208:211], v[244:247], v[152:155], v[216:219]
    v_exp_f32 v186, v186
    v_exp_f32 v187, v187
    v_mfma_f32_16x16x32_bf16 v[212:215], v[244:247], v[168:171], v[220:223]
    ds_read_b128 v[236:239], v4 offset:46080
    v_cvt_pk_bf16_f32 v56, v184, v185
    v_mfma_f32_16x16x32_bf16 v[252:255], v[12:15], v[52:55], v[252:255]
    s_waitcnt lgkmcnt(3)
    v_mfma_f32_16x16x32_bf16 v[200:203], v[224:227], v[156:159], v[200:203]
    v_exp_f32 v188, v188
    v_exp_f32 v189, v189
    v_mfma_f32_16x16x32_bf16 v[204:207], v[224:227], v[172:175], v[204:207]
    ds_read_b128 v[240:243], v4 offset:47104
    v_cvt_pk_bf16_f32 v57, v186, v187
    s_waitcnt lgkmcnt(3)
    v_mfma_f32_16x16x32_bf16 v[208:211], v[228:231], v[156:159], v[208:211]
    v_exp_f32 v190, v190
    v_exp_f32 v191, v191
    v_mfma_f32_16x16x32_bf16 v[212:215], v[228:231], v[172:175], v[212:215]
    ds_read_b128 v[244:247], v4 offset:48128
    v_cvt_pk_bf16_f32 v60, v188, v189
    v_exp_f32 v192, v192
    s_waitcnt lgkmcnt(3)
    v_mfma_f32_16x16x32_bf16 v[200:203], v[232:235], v[160:163], v[200:203]
    v_exp_f32 v193, v193
    v_mfma_f32_16x16x32_bf16 v[204:207], v[232:235], v[176:179], v[204:207]
    s_waitcnt vmcnt(7)
    s_barrier
    ds_read_b128 v[224:227], v4 offset:49152
    v_cvt_pk_bf16_f32 v61, v190, v191
    v_exp_f32 v194, v194
    s_waitcnt lgkmcnt(3)
    v_mfma_f32_16x16x32_bf16 v[208:211], v[236:239], v[160:163], v[208:211]
    v_exp_f32 v195, v195
    v_mfma_f32_16x16x32_bf16 v[212:215], v[236:239], v[176:179], v[212:215]
    s_add_u32 s22, s21, 0x1c000
    s_add_u32 m0, s20, 0x14000
    s_nop 0
    buffer_load_dwordx4 v2, s[8:11], s22 offen sc1 lds
    ds_read_b128 v[228:231], v4 offset:50176
    v_cvt_pk_bf16_f32 v58, v192, v193
    v_exp_f32 v196, v196
    s_waitcnt lgkmcnt(3)
    v_mfma_f32_16x16x32_bf16 v[200:203], v[240:243], v[164:167], v[200:203]
    v_exp_f32 v197, v197
    v_cvt_pk_bf16_f32 v59, v194, v195
    v_mfma_f32_16x16x32_bf16 v[204:207], v[240:243], v[180:183], v[204:207]
    ds_read_b128 v[232:235], v4 offset:51200
    v_exp_f32 v198, v198
    s_waitcnt lgkmcnt(3)
    v_mfma_f32_16x16x32_bf16 v[208:211], v[244:247], v[164:167], v[208:211]
    v_exp_f32 v199, v199
    v_cvt_pk_bf16_f32 v62, v196, v197
    v_mfma_f32_16x16x32_bf16 v[212:215], v[244:247], v[180:183], v[212:215]
    ds_read_b128 v[236:239], v4 offset:52224
    v_cvt_pk_bf16_f32 v63, v198, v199
    s_waitcnt lgkmcnt(3)
    v_mfma_f32_16x16x32_bf16 v[184:187], v[224:227], v[152:155], v[216:219]
    v_mfma_f32_16x16x32_bf16 v[188:191], v[224:227], v[168:171], v[220:223]
    ds_read_b128 v[240:243], v4 offset:53248
    v_exp_f32 v200, v200
    v_exp_f32 v201, v201
    v_mfma_f32_16x16x32_bf16 v[248:251], v[12:15], v[56:59], v[248:251]
    s_waitcnt lgkmcnt(3)
    v_mfma_f32_16x16x32_bf16 v[192:195], v[228:231], v[152:155], v[216:219]
    v_exp_f32 v202, v202
    v_exp_f32 v203, v203
    v_mfma_f32_16x16x32_bf16 v[196:199], v[228:231], v[168:171], v[220:223]
    s_add_u32 s22, s21, 0x1c400
    s_add_u32 m0, s20, 0x14400
    s_nop 0
    buffer_load_dwordx4 v2, s[8:11], s22 offen sc1 lds
    ds_read_b128 v[244:247], v4 offset:54272
    v_cvt_pk_bf16_f32 v64, v200, v201
    v_mfma_f32_16x16x32_bf16 v[252:255], v[12:15], v[60:63], v[252:255]
    s_waitcnt lgkmcnt(3)
    v_mfma_f32_16x16x32_bf16 v[184:187], v[232:235], v[156:159], v[184:187]
    v_exp_f32 v204, v204
    v_exp_f32 v205, v205
    v_mfma_f32_16x16x32_bf16 v[188:191], v[232:235], v[172:175], v[188:191]
    ds_read_b128 v[224:227], v4 offset:55296
    v_cvt_pk_bf16_f32 v65, v202, v203
    s_waitcnt lgkmcnt(3)
    v_mfma_f32_16x16x32_bf16 v[192:195], v[236:239], v[156:159], v[192:195]
    v_exp_f32 v206, v206
    v_exp_f32 v207, v207
    v_mfma_f32_16x16x32_bf16 v[196:199], v[236:239], v[172:175], v[196:199]
    ds_read_b128 v[228:231], v4 offset:56320
    v_cvt_pk_bf16_f32 v68, v204, v205
    v_exp_f32 v208, v208
    s_waitcnt lgkmcnt(3)
    v_mfma_f32_16x16x32_bf16 v[184:187], v[240:243], v[160:163], v[184:187]
    v_exp_f32 v209, v209
    v_mfma_f32_16x16x32_bf16 v[188:191], v[240:243], v[176:179], v[188:191]
    ds_read_b128 v[232:235], v4 offset:57344
    v_cvt_pk_bf16_f32 v69, v206, v207
    v_exp_f32 v210, v210
    s_waitcnt lgkmcnt(3)
    v_mfma_f32_16x16x32_bf16 v[192:195], v[244:247], v[160:163], v[192:195]
    v_exp_f32 v211, v211
    v_mfma_f32_16x16x32_bf16 v[196:199], v[244:247], v[176:179], v[196:199]
    ds_read_b128 v[236:239], v4 offset:58368
    v_cvt_pk_bf16_f32 v66, v208, v209
    v_exp_f32 v212, v212
    s_waitcnt lgkmcnt(3)
    v_mfma_f32_16x16x32_bf16 v[184:187], v[224:227], v[164:167], v[184:187]
    v_exp_f32 v213, v213
    v_cvt_pk_bf16_f32 v67, v210, v211
    v_mfma_f32_16x16x32_bf16 v[188:191], v[224:227], v[180:183], v[188:191]
    ds_read_b128 v[240:243], v4 offset:59392
    v_exp_f32 v214, v214
    s_waitcnt lgkmcnt(3)
    v_mfma_f32_16x16x32_bf16 v[192:195], v[228:231], v[164:167], v[192:195]
    v_exp_f32 v215, v215
    v_cvt_pk_bf16_f32 v70, v212, v213
    v_mfma_f32_16x16x32_bf16 v[196:199], v[228:231], v[180:183], v[196:199]
    ds_read_b128 v[244:247], v4 offset:60416
    v_cvt_pk_bf16_f32 v71, v214, v215
    s_waitcnt lgkmcnt(3)
    v_mfma_f32_16x16x32_bf16 v[200:203], v[232:235], v[152:155], v[216:219]
    v_mfma_f32_16x16x32_bf16 v[204:207], v[232:235], v[168:171], v[220:223]
    ds_read_b128 v[224:227], v4 offset:61440
    v_exp_f32 v184, v184
    v_exp_f32 v185, v185
    v_mfma_f32_16x16x32_bf16 v[248:251], v[12:15], v[64:67], v[248:251]
    s_waitcnt lgkmcnt(3)
    v_mfma_f32_16x16x32_bf16 v[208:211], v[236:239], v[152:155], v[216:219]
    v_exp_f32 v186, v186
    v_exp_f32 v187, v187
    v_mfma_f32_16x16x32_bf16 v[212:215], v[236:239], v[168:171], v[220:223]
    ds_read_b128 v[228:231], v4 offset:62464
    v_cvt_pk_bf16_f32 v72, v184, v185
    v_mfma_f32_16x16x32_bf16 v[252:255], v[12:15], v[68:71], v[252:255]
    s_waitcnt lgkmcnt(3)
    v_mfma_f32_16x16x32_bf16 v[200:203], v[240:243], v[156:159], v[200:203]
    v_exp_f32 v188, v188
    v_exp_f32 v189, v189
    v_mfma_f32_16x16x32_bf16 v[204:207], v[240:243], v[172:175], v[204:207]
    ds_read_b128 v[232:235], v4 offset:63488
    v_cvt_pk_bf16_f32 v73, v186, v187
    s_waitcnt lgkmcnt(3)
    v_mfma_f32_16x16x32_bf16 v[208:211], v[244:247], v[156:159], v[208:211]
    v_exp_f32 v190, v190
    v_exp_f32 v191, v191
    v_mfma_f32_16x16x32_bf16 v[212:215], v[244:247], v[172:175], v[212:215]
    ds_read_b128 v[236:239], v4 offset:64512
    v_cvt_pk_bf16_f32 v76, v188, v189
    v_exp_f32 v192, v192
    s_waitcnt lgkmcnt(3)
    v_mfma_f32_16x16x32_bf16 v[200:203], v[224:227], v[160:163], v[200:203]
    v_exp_f32 v193, v193
    v_mfma_f32_16x16x32_bf16 v[204:207], v[224:227], v[176:179], v[204:207]
    s_waitcnt vmcnt(7)
    s_barrier
    ds_read_b128 v[240:243], v5 offset:0
    v_cvt_pk_bf16_f32 v77, v190, v191
    v_exp_f32 v194, v194
    s_waitcnt lgkmcnt(3)
    v_mfma_f32_16x16x32_bf16 v[208:211], v[228:231], v[160:163], v[208:211]
    v_exp_f32 v195, v195
    v_mfma_f32_16x16x32_bf16 v[212:215], v[228:231], v[176:179], v[212:215]
    s_add_u32 s22, s21, 0x80000
    s_add_u32 m0, s20, 0x18000
    s_nop 0
    buffer_load_dwordx4 v2, s[8:11], s22 offen sc1 lds
    ds_read_b128 v[244:247], v5 offset:1024
    v_cvt_pk_bf16_f32 v74, v192, v193
    v_exp_f32 v196, v196
    s_waitcnt lgkmcnt(3)
    v_mfma_f32_16x16x32_bf16 v[200:203], v[232:235], v[164:167], v[200:203]
    v_exp_f32 v197, v197
    v_cvt_pk_bf16_f32 v75, v194, v195
    v_mfma_f32_16x16x32_bf16 v[204:207], v[232:235], v[180:183], v[204:207]
    ds_read_b128 v[224:227], v5 offset:2048
    v_exp_f32 v198, v198
    s_waitcnt lgkmcnt(3)
    v_mfma_f32_16x16x32_bf16 v[208:211], v[236:239], v[164:167], v[208:211]
    v_exp_f32 v199, v199
    v_cvt_pk_bf16_f32 v78, v196, v197
    v_mfma_f32_16x16x32_bf16 v[212:215], v[236:239], v[180:183], v[212:215]
    ds_read_b128 v[228:231], v5 offset:3072
    v_cvt_pk_bf16_f32 v79, v198, v199
    s_waitcnt lgkmcnt(3)
    v_mfma_f32_16x16x32_bf16 v[184:187], v[240:243], v[152:155], v[216:219]
    v_mfma_f32_16x16x32_bf16 v[188:191], v[240:243], v[168:171], v[220:223]
    ds_read_b128 v[232:235], v5 offset:4096
    v_exp_f32 v200, v200
    v_exp_f32 v201, v201
    v_mfma_f32_16x16x32_bf16 v[248:251], v[12:15], v[72:75], v[248:251]
    s_waitcnt lgkmcnt(3)
    v_mfma_f32_16x16x32_bf16 v[192:195], v[244:247], v[152:155], v[216:219]
    v_exp_f32 v202, v202
    v_exp_f32 v203, v203
    v_mfma_f32_16x16x32_bf16 v[196:199], v[244:247], v[168:171], v[220:223]
    s_add_u32 s22, s21, 0x80400
    s_add_u32 m0, s20, 0x18400
    s_nop 0
    buffer_load_dwordx4 v2, s[8:11], s22 offen sc1 lds
    ds_read_b128 v[236:239], v5 offset:5120
    v_cvt_pk_bf16_f32 v80, v200, v201
    v_mfma_f32_16x16x32_bf16 v[252:255], v[12:15], v[76:79], v[252:255]
    s_waitcnt lgkmcnt(3)
    v_mfma_f32_16x16x32_bf16 v[184:187], v[224:227], v[156:159], v[184:187]
    v_exp_f32 v204, v204
    v_exp_f32 v205, v205
    s_add_u32 s22, s18, 0
    s_add_u32 m0, s15, 0
    s_nop 0
    buffer_load_dwordx4 v11, s[64:67], s22 offen lds
    v_mfma_f32_16x16x32_bf16 v[188:191], v[224:227], v[172:175], v[188:191]
    ds_read_b128 v[240:243], v5 offset:6144
    v_cvt_pk_bf16_f32 v81, v202, v203
    s_waitcnt lgkmcnt(3)
    v_mfma_f32_16x16x32_bf16 v[192:195], v[228:231], v[156:159], v[192:195]
    v_exp_f32 v206, v206
    v_exp_f32 v207, v207
    v_mfma_f32_16x16x32_bf16 v[196:199], v[228:231], v[172:175], v[196:199]
    ds_read_b128 v[244:247], v5 offset:7168
    v_cvt_pk_bf16_f32 v84, v204, v205
    v_exp_f32 v208, v208
    s_waitcnt lgkmcnt(3)
    v_mfma_f32_16x16x32_bf16 v[184:187], v[232:235], v[160:163], v[184:187]
    v_exp_f32 v209, v209
    v_mfma_f32_16x16x32_bf16 v[188:191], v[232:235], v[176:179], v[188:191]
    ds_read_b128 v[224:227], v5 offset:8192
    v_cvt_pk_bf16_f32 v85, v206, v207
    v_exp_f32 v210, v210
    s_waitcnt lgkmcnt(3)
    v_mfma_f32_16x16x32_bf16 v[192:195], v[236:239], v[160:163], v[192:195]
    v_exp_f32 v211, v211
    v_mfma_f32_16x16x32_bf16 v[196:199], v[236:239], v[176:179], v[196:199]
    ds_read_b128 v[228:231], v5 offset:9216
    v_cvt_pk_bf16_f32 v82, v208, v209
    v_exp_f32 v212, v212
    s_waitcnt lgkmcnt(3)
    v_mfma_f32_16x16x32_bf16 v[184:187], v[240:243], v[164:167], v[184:187]
    v_exp_f32 v213, v213
    v_cvt_pk_bf16_f32 v83, v210, v211
    v_mfma_f32_16x16x32_bf16 v[188:191], v[240:243], v[180:183], v[188:191]
    ds_read_b128 v[232:235], v5 offset:10240
    v_exp_f32 v214, v214
    s_waitcnt lgkmcnt(3)
    v_mfma_f32_16x16x32_bf16 v[192:195], v[244:247], v[164:167], v[192:195]
    v_exp_f32 v215, v215
    v_cvt_pk_bf16_f32 v86, v212, v213
    v_mfma_f32_16x16x32_bf16 v[196:199], v[244:247], v[180:183], v[196:199]
    ds_read_b128 v[236:239], v5 offset:11264
    v_cvt_pk_bf16_f32 v87, v214, v215
    s_waitcnt lgkmcnt(3)
    v_mfma_f32_16x16x32_bf16 v[200:203], v[224:227], v[152:155], v[216:219]
    v_mfma_f32_16x16x32_bf16 v[204:207], v[224:227], v[168:171], v[220:223]
    ds_read_b128 v[240:243], v5 offset:12288
    v_exp_f32 v184, v184
    v_exp_f32 v185, v185
    v_mfma_f32_16x16x32_bf16 v[248:251], v[12:15], v[80:83], v[248:251]
    s_waitcnt lgkmcnt(3)
    v_mfma_f32_16x16x32_bf16 v[208:211], v[228:231], v[152:155], v[216:219]
    v_exp_f32 v186, v186
    v_exp_f32 v187, v187
    v_mfma_f32_16x16x32_bf16 v[212:215], v[228:231], v[168:171], v[220:223]
    ds_read_b128 v[244:247], v5 offset:13312
    v_cvt_pk_bf16_f32 v88, v184, v185
    s_add_u32 s22, s18, 7168
    s_add_u32 m0, s15, 1024
    s_nop 0
    buffer_load_dwordx4 v11, s[64:67], s22 offen lds
    v_mfma_f32_16x16x32_bf16 v[252:255], v[12:15], v[84:87], v[252:255]
    s_waitcnt lgkmcnt(3)
    v_mfma_f32_16x16x32_bf16 v[200:203], v[232:235], v[156:159], v[200:203]
    v_exp_f32 v188, v188
    v_exp_f32 v189, v189
    v_mfma_f32_16x16x32_bf16 v[204:207], v[232:235], v[172:175], v[204:207]
    ds_read_b128 v[224:227], v5 offset:14336
    v_cvt_pk_bf16_f32 v89, v186, v187
    s_waitcnt lgkmcnt(3)
    v_mfma_f32_16x16x32_bf16 v[208:211], v[236:239], v[156:159], v[208:211]
    v_exp_f32 v190, v190
    v_exp_f32 v191, v191
    v_mfma_f32_16x16x32_bf16 v[212:215], v[236:239], v[172:175], v[212:215]
    ds_read_b128 v[228:231], v5 offset:15360
    v_cvt_pk_bf16_f32 v92, v188, v189
    v_exp_f32 v192, v192
    s_waitcnt lgkmcnt(3)
    v_mfma_f32_16x16x32_bf16 v[200:203], v[240:243], v[160:163], v[200:203]
    v_exp_f32 v193, v193
    v_mfma_f32_16x16x32_bf16 v[204:207], v[240:243], v[176:179], v[204:207]
    s_waitcnt vmcnt(8)
    s_barrier
    ds_read_b128 v[232:235], v5 offset:16384
    v_cvt_pk_bf16_f32 v93, v190, v191
    v_exp_f32 v194, v194
    s_waitcnt lgkmcnt(3)
    v_mfma_f32_16x16x32_bf16 v[208:211], v[244:247], v[160:163], v[208:211]
    v_exp_f32 v195, v195
    v_mfma_f32_16x16x32_bf16 v[212:215], v[244:247], v[176:179], v[212:215]
    s_add_u32 s22, s21, 0x84000
    s_add_u32 m0, s20, 0x1c000
    s_nop 0
    buffer_load_dwordx4 v2, s[8:11], s22 offen sc1 lds
    ds_read_b128 v[236:239], v5 offset:17408
    v_cvt_pk_bf16_f32 v90, v192, v193
    v_exp_f32 v196, v196
    s_waitcnt lgkmcnt(3)
    v_mfma_f32_16x16x32_bf16 v[200:203], v[224:227], v[164:167], v[200:203]
    v_exp_f32 v197, v197
    v_cvt_pk_bf16_f32 v91, v194, v195
    v_mfma_f32_16x16x32_bf16 v[204:207], v[224:227], v[180:183], v[204:207]
    ds_read_b128 v[240:243], v5 offset:18432
    v_exp_f32 v198, v198
    s_waitcnt lgkmcnt(3)
    v_mfma_f32_16x16x32_bf16 v[208:211], v[228:231], v[164:167], v[208:211]
    v_exp_f32 v199, v199
    v_cvt_pk_bf16_f32 v94, v196, v197
    v_mfma_f32_16x16x32_bf16 v[212:215], v[228:231], v[180:183], v[212:215]
    ds_read_b128 v[244:247], v5 offset:19456
    v_cvt_pk_bf16_f32 v95, v198, v199
    s_waitcnt lgkmcnt(3)
    v_mfma_f32_16x16x32_bf16 v[184:187], v[232:235], v[152:155], v[216:219]
    v_mfma_f32_16x16x32_bf16 v[188:191], v[232:235], v[168:171], v[220:223]
    ds_read_b128 v[224:227], v5 offset:20480
    v_exp_f32 v200, v200
    v_exp_f32 v201, v201
    v_mfma_f32_16x16x32_bf16 v[248:251], v[12:15], v[88:91], v[248:251]
    s_waitcnt lgkmcnt(3)
    v_mfma_f32_16x16x32_bf16 v[192:195], v[236:239], v[152:155], v[216:219]
    v_exp_f32 v202, v202
    v_exp_f32 v203, v203
    v_mfma_f32_16x16x32_bf16 v[196:199], v[236:239], v[168:171], v[220:223]
    s_add_u32 s22, s21, 0x84400
    s_add_u32 m0, s20, 0x1c400
    s_nop 0
    buffer_load_dwordx4 v2, s[8:11], s22 offen sc1 lds
    ds_read_b128 v[228:231], v5 offset:21504
    v_cvt_pk_bf16_f32 v96, v200, v201
    s_add_u32 s22, s18, 14336
    s_add_u32 m0, s15, 2048
    s_nop 0
    buffer_load_dwordx4 v11, s[64:67], s22 offen lds
    v_mfma_f32_16x16x32_bf16 v[252:255], v[12:15], v[92:95], v[252:255]
    s_waitcnt lgkmcnt(3)
    v_mfma_f32_16x16x32_bf16 v[184:187], v[240:243], v[156:159], v[184:187]
    v_exp_f32 v204, v204
    v_exp_f32 v205, v205
    v_mfma_f32_16x16x32_bf16 v[188:191], v[240:243], v[172:175], v[188:191]
    ds_read_b128 v[232:235], v5 offset:22528
    v_cvt_pk_bf16_f32 v97, v202, v203
    s_waitcnt lgkmcnt(3)
    v_mfma_f32_16x16x32_bf16 v[192:195], v[244:247], v[156:159], v[192:195]
    v_exp_f32 v206, v206
    v_exp_f32 v207, v207
    v_mfma_f32_16x16x32_bf16 v[196:199], v[244:247], v[172:175], v[196:199]
    ds_read_b128 v[236:239], v5 offset:23552
    v_cvt_pk_bf16_f32 v100, v204, v205
    v_exp_f32 v208, v208
    s_waitcnt lgkmcnt(3)
    v_mfma_f32_16x16x32_bf16 v[184:187], v[224:227], v[160:163], v[184:187]
    v_exp_f32 v209, v209
    v_mfma_f32_16x16x32_bf16 v[188:191], v[224:227], v[176:179], v[188:191]
    ds_read_b128 v[240:243], v5 offset:24576
    v_cvt_pk_bf16_f32 v101, v206, v207
    v_exp_f32 v210, v210
    s_waitcnt lgkmcnt(3)
    v_mfma_f32_16x16x32_bf16 v[192:195], v[228:231], v[160:163], v[192:195]
    v_exp_f32 v211, v211
    v_mfma_f32_16x16x32_bf16 v[196:199], v[228:231], v[176:179], v[196:199]
    ds_read_b128 v[244:247], v5 offset:25600
    v_cvt_pk_bf16_f32 v98, v208, v209
    v_exp_f32 v212, v212
    s_waitcnt lgkmcnt(3)
    v_mfma_f32_16x16x32_bf16 v[184:187], v[232:235], v[164:167], v[184:187]
    v_exp_f32 v213, v213
    v_cvt_pk_bf16_f32 v99, v210, v211
    v_mfma_f32_16x16x32_bf16 v[188:191], v[232:235], v[180:183], v[188:191]
    ds_read_b128 v[224:227], v5 offset:26624
    v_exp_f32 v214, v214
    s_waitcnt lgkmcnt(3)
    v_mfma_f32_16x16x32_bf16 v[192:195], v[236:239], v[164:167], v[192:195]
    v_exp_f32 v215, v215
    v_cvt_pk_bf16_f32 v102, v212, v213
    v_mfma_f32_16x16x32_bf16 v[196:199], v[236:239], v[180:183], v[196:199]
    ds_read_b128 v[228:231], v5 offset:27648
    v_cvt_pk_bf16_f32 v103, v214, v215
    s_waitcnt lgkmcnt(3)
    v_mfma_f32_16x16x32_bf16 v[200:203], v[240:243], v[152:155], v[216:219]
    v_mfma_f32_16x16x32_bf16 v[204:207], v[240:243], v[168:171], v[220:223]
    ds_read_b128 v[232:235], v5 offset:28672
    v_exp_f32 v184, v184
    v_exp_f32 v185, v185
    v_mfma_f32_16x16x32_bf16 v[248:251], v[12:15], v[96:99], v[248:251]
    s_waitcnt lgkmcnt(3)
    v_mfma_f32_16x16x32_bf16 v[208:211], v[244:247], v[152:155], v[216:219]
    v_exp_f32 v186, v186
    v_exp_f32 v187, v187
    s_add_u32 s22, s18, 21504
    s_add_u32 m0, s15, 3072
    s_nop 0
    buffer_load_dwordx4 v11, s[64:67], s22 offen lds
    v_mfma_f32_16x16x32_bf16 v[212:215], v[244:247], v[168:171], v[220:223]
    ds_read_b128 v[236:239], v5 offset:29696
    v_cvt_pk_bf16_f32 v104, v184, v185
    v_mfma_f32_16x16x32_bf16 v[252:255], v[12:15], v[100:103], v[252:255]
    s_waitcnt lgkmcnt(3)
    v_mfma_f32_16x16x32_bf16 v[200:203], v[224:227], v[156:159], v[200:203]
    v_exp_f32 v188, v188
    v_exp_f32 v189, v189
    v_mfma_f32_16x16x32_bf16 v[204:207], v[224:227], v[172:175], v[204:207]
    ds_read_b128 v[240:243], v5 offset:30720
    v_cvt_pk_bf16_f32 v105, v186, v187
    s_waitcnt lgkmcnt(3)
    v_mfma_f32_16x16x32_bf16 v[208:211], v[228:231], v[156:159], v[208:211]
    v_exp_f32 v190, v190
    v_exp_f32 v191, v191
    v_mfma_f32_16x16x32_bf16 v[212:215], v[228:231], v[172:175], v[212:215]
    ds_read_b128 v[244:247], v5 offset:31744
    v_cvt_pk_bf16_f32 v108, v188, v189
    v_exp_f32 v192, v192
    s_waitcnt lgkmcnt(3)
    v_mfma_f32_16x16x32_bf16 v[200:203], v[232:235], v[160:163], v[200:203]
    v_exp_f32 v193, v193
    v_mfma_f32_16x16x32_bf16 v[204:207], v[232:235], v[176:179], v[204:207]
    s_waitcnt vmcnt(10)
    s_barrier
    ds_read_b128 v[224:227], v4 offset:0
    v_cvt_pk_bf16_f32 v109, v190, v191
    v_exp_f32 v194, v194
    s_waitcnt lgkmcnt(3)
    v_mfma_f32_16x16x32_bf16 v[208:211], v[236:239], v[160:163], v[208:211]
    v_exp_f32 v195, v195
    v_mfma_f32_16x16x32_bf16 v[212:215], v[236:239], v[176:179], v[212:215]
    s_add_u32 s22, s21, 0x88000
    s_add_u32 m0, s20, 0x20000
    s_nop 0
    buffer_load_dwordx4 v2, s[8:11], s22 offen sc1 lds
    ds_read_b128 v[228:231], v4 offset:1024
    v_cvt_pk_bf16_f32 v106, v192, v193
    v_exp_f32 v196, v196
    s_waitcnt lgkmcnt(3)
    v_mfma_f32_16x16x32_bf16 v[200:203], v[240:243], v[164:167], v[200:203]
    v_exp_f32 v197, v197
    v_cvt_pk_bf16_f32 v107, v194, v195
    v_mfma_f32_16x16x32_bf16 v[204:207], v[240:243], v[180:183], v[204:207]
    ds_read_b128 v[232:235], v4 offset:2048
    v_exp_f32 v198, v198
    s_waitcnt lgkmcnt(3)
    v_mfma_f32_16x16x32_bf16 v[208:211], v[244:247], v[164:167], v[208:211]
    v_exp_f32 v199, v199
    v_cvt_pk_bf16_f32 v110, v196, v197
    v_mfma_f32_16x16x32_bf16 v[212:215], v[244:247], v[180:183], v[212:215]
    ds_read_b128 v[236:239], v4 offset:3072
    v_cvt_pk_bf16_f32 v111, v198, v199
    s_waitcnt lgkmcnt(3)
    v_mfma_f32_16x16x32_bf16 v[184:187], v[224:227], v[152:155], v[216:219]
    v_mfma_f32_16x16x32_bf16 v[188:191], v[224:227], v[168:171], v[220:223]
    ds_read_b128 v[240:243], v4 offset:4096
    v_exp_f32 v200, v200
    v_exp_f32 v201, v201
    v_mfma_f32_16x16x32_bf16 v[248:251], v[12:15], v[104:107], v[248:251]
    s_waitcnt lgkmcnt(3)
    v_mfma_f32_16x16x32_bf16 v[192:195], v[228:231], v[152:155], v[216:219]
    v_exp_f32 v202, v202
    v_exp_f32 v203, v203
    s_add_u32 s22, s18, 28672
    s_add_u32 m0, s15, 4096
    s_nop 0
    buffer_load_dwordx4 v11, s[64:67], s22 offen lds
    v_mfma_f32_16x16x32_bf16 v[196:199], v[228:231], v[168:171], v[220:223]
    s_add_u32 s22, s21, 0x88400
    s_add_u32 m0, s20, 0x20400
    s_nop 0
    buffer_load_dwordx4 v2, s[8:11], s22 offen sc1 lds
    ds_read_b128 v[244:247], v4 offset:5120
    v_cvt_pk_bf16_f32 v112, v200, v201
    v_mfma_f32_16x16x32_bf16 v[252:255], v[12:15], v[108:111], v[252:255]
    s_waitcnt lgkmcnt(3)
    v_mfma_f32_16x16x32_bf16 v[184:187], v[232:235], v[156:159], v[184:187]
    v_exp_f32 v204, v204
    v_exp_f32 v205, v205
    v_mfma_f32_16x16x32_bf16 v[188:191], v[232:235], v[172:175], v[188:191]
    ds_read_b128 v[224:227], v4 offset:6144
    v_cvt_pk_bf16_f32 v113, v202, v203
    s_waitcnt lgkmcnt(3)
    v_mfma_f32_16x16x32_bf16 v[192:195], v[236:239], v[156:159], v[192:195]
    v_exp_f32 v206, v206
    v_exp_f32 v207, v207
    v_mfma_f32_16x16x32_bf16 v[196:199], v[236:239], v[172:175], v[196:199]
    ds_read_b128 v[228:231], v4 offset:7168
    v_cvt_pk_bf16_f32 v116, v204, v205
    v_exp_f32 v208, v208
    s_waitcnt lgkmcnt(3)
    v_mfma_f32_16x16x32_bf16 v[184:187], v[240:243], v[160:163], v[184:187]
    v_exp_f32 v209, v209
    v_mfma_f32_16x16x32_bf16 v[188:191], v[240:243], v[176:179], v[188:191]
    ds_read_b128 v[232:235], v4 offset:8192
    v_cvt_pk_bf16_f32 v117, v206, v207
    v_exp_f32 v210, v210
    s_waitcnt lgkmcnt(3)
    v_mfma_f32_16x16x32_bf16 v[192:195], v[244:247], v[160:163], v[192:195]
    v_exp_f32 v211, v211
    v_mfma_f32_16x16x32_bf16 v[196:199], v[244:247], v[176:179], v[196:199]
    ds_read_b128 v[236:239], v4 offset:9216
    v_cvt_pk_bf16_f32 v114, v208, v209
    v_exp_f32 v212, v212
    s_waitcnt lgkmcnt(3)
    v_mfma_f32_16x16x32_bf16 v[184:187], v[224:227], v[164:167], v[184:187]
    v_exp_f32 v213, v213
    v_cvt_pk_bf16_f32 v115, v210, v211
    v_mfma_f32_16x16x32_bf16 v[188:191], v[224:227], v[180:183], v[188:191]
    ds_read_b128 v[240:243], v4 offset:10240
    v_exp_f32 v214, v214
    s_waitcnt lgkmcnt(3)
    v_mfma_f32_16x16x32_bf16 v[192:195], v[228:231], v[164:167], v[192:195]
    v_exp_f32 v215, v215
    v_cvt_pk_bf16_f32 v118, v212, v213
    v_mfma_f32_16x16x32_bf16 v[196:199], v[228:231], v[180:183], v[196:199]
    ds_read_b128 v[244:247], v4 offset:11264
    v_cvt_pk_bf16_f32 v119, v214, v215
    s_waitcnt lgkmcnt(3)
    v_mfma_f32_16x16x32_bf16 v[200:203], v[232:235], v[152:155], v[216:219]
    v_mfma_f32_16x16x32_bf16 v[204:207], v[232:235], v[168:171], v[220:223]
    ds_read_b128 v[224:227], v4 offset:12288
    v_exp_f32 v184, v184
    v_exp_f32 v185, v185
    s_add_u32 s22, s18, 35840
    s_add_u32 m0, s15, 5120
    s_nop 0
    buffer_load_dwordx4 v11, s[64:67], s22 offen lds
    v_mfma_f32_16x16x32_bf16 v[248:251], v[12:15], v[112:115], v[248:251]
    s_waitcnt lgkmcnt(3)
    v_mfma_f32_16x16x32_bf16 v[208:211], v[236:239], v[152:155], v[216:219]
    v_exp_f32 v186, v186
    v_exp_f32 v187, v187
    v_mfma_f32_16x16x32_bf16 v[212:215], v[236:239], v[168:171], v[220:223]
    ds_read_b128 v[228:231], v4 offset:13312
    v_cvt_pk_bf16_f32 v120, v184, v185
    v_mfma_f32_16x16x32_bf16 v[252:255], v[12:15], v[116:119], v[252:255]
    s_waitcnt lgkmcnt(3)
    v_mfma_f32_16x16x32_bf16 v[200:203], v[240:243], v[156:159], v[200:203]
    v_exp_f32 v188, v188
    v_exp_f32 v189, v189
    v_mfma_f32_16x16x32_bf16 v[204:207], v[240:243], v[172:175], v[204:207]
    ds_read_b128 v[232:235], v4 offset:14336
    v_cvt_pk_bf16_f32 v121, v186, v187
    s_waitcnt lgkmcnt(3)
    v_mfma_f32_16x16x32_bf16 v[208:211], v[244:247], v[156:159], v[208:211]
    v_exp_f32 v190, v190
    v_exp_f32 v191, v191
    v_mfma_f32_16x16x32_bf16 v[212:215], v[244:247], v[172:175], v[212:215]
    ds_read_b128 v[236:239], v4 offset:15360
    v_cvt_pk_bf16_f32 v124, v188, v189
    v_exp_f32 v192, v192
    s_waitcnt lgkmcnt(3)
    v_mfma_f32_16x16x32_bf16 v[200:203], v[224:227], v[160:163], v[200:203]
    v_exp_f32 v193, v193
    v_mfma_f32_16x16x32_bf16 v[204:207], v[224:227], v[176:179], v[204:207]
    s_waitcnt vmcnt(12)
    s_barrier
    ds_read_b128 v[240:243], v4 offset:16384
    v_cvt_pk_bf16_f32 v125, v190, v191
    v_exp_f32 v194, v194
    s_waitcnt lgkmcnt(3)
    v_mfma_f32_16x16x32_bf16 v[208:211], v[228:231], v[160:163], v[208:211]
    v_exp_f32 v195, v195
    v_mfma_f32_16x16x32_bf16 v[212:215], v[228:231], v[176:179], v[212:215]
    s_add_u32 s22, s21, 0x8c000
    s_add_u32 m0, s20, 0x24000
    s_nop 0
    buffer_load_dwordx4 v2, s[8:11], s22 offen sc1 lds
    ds_read_b128 v[244:247], v4 offset:17408
    v_cvt_pk_bf16_f32 v122, v192, v193
    v_exp_f32 v196, v196
    s_waitcnt lgkmcnt(3)
    v_mfma_f32_16x16x32_bf16 v[200:203], v[232:235], v[164:167], v[200:203]
    v_exp_f32 v197, v197
    v_cvt_pk_bf16_f32 v123, v194, v195
    v_mfma_f32_16x16x32_bf16 v[204:207], v[232:235], v[180:183], v[204:207]
    ds_read_b128 v[224:227], v4 offset:18432
    v_exp_f32 v198, v198
    s_waitcnt lgkmcnt(3)
    v_mfma_f32_16x16x32_bf16 v[208:211], v[236:239], v[164:167], v[208:211]
    v_exp_f32 v199, v199
    v_cvt_pk_bf16_f32 v126, v196, v197
    v_mfma_f32_16x16x32_bf16 v[212:215], v[236:239], v[180:183], v[212:215]
    ds_read_b128 v[228:231], v4 offset:19456
    v_cvt_pk_bf16_f32 v127, v198, v199
    s_waitcnt lgkmcnt(3)
    v_mfma_f32_16x16x32_bf16 v[184:187], v[240:243], v[152:155], v[216:219]
    v_mfma_f32_16x16x32_bf16 v[188:191], v[240:243], v[168:171], v[220:223]
    ds_read_b128 v[232:235], v4 offset:20480
    v_exp_f32 v200, v200
    v_exp_f32 v201, v201
    s_add_u32 s22, s18, 43008
    s_add_u32 m0, s15, 6144
    s_nop 0
    buffer_load_dwordx4 v11, s[64:67], s22 offen lds
    v_mfma_f32_16x16x32_bf16 v[248:251], v[12:15], v[120:123], v[248:251]
    s_waitcnt lgkmcnt(3)
    v_mfma_f32_16x16x32_bf16 v[192:195], v[244:247], v[152:155], v[216:219]
    v_exp_f32 v202, v202
    v_exp_f32 v203, v203
    v_mfma_f32_16x16x32_bf16 v[196:199], v[244:247], v[168:171], v[220:223]
    s_add_u32 s22, s21, 0x8c400
    s_add_u32 m0, s20, 0x24400
    s_nop 0
    buffer_load_dwordx4 v2, s[8:11], s22 offen sc1 lds
    ds_read_b128 v[236:239], v4 offset:21504
    v_cvt_pk_bf16_f32 v128, v200, v201
    v_mfma_f32_16x16x32_bf16 v[252:255], v[12:15], v[124:127], v[252:255]
    s_waitcnt lgkmcnt(3)
    v_mfma_f32_16x16x32_bf16 v[184:187], v[224:227], v[156:159], v[184:187]
    v_exp_f32 v204, v204
    v_exp_f32 v205, v205
    v_mfma_f32_16x16x32_bf16 v[188:191], v[224:227], v[172:175], v[188:191]
    ds_read_b128 v[240:243], v4 offset:22528
    v_cvt_pk_bf16_f32 v129, v202, v203
    s_waitcnt lgkmcnt(3)
    v_mfma_f32_16x16x32_bf16 v[192:195], v[228:231], v[156:159], v[192:195]
    v_exp_f32 v206, v206
    v_exp_f32 v207, v207
    v_mfma_f32_16x16x32_bf16 v[196:199], v[228:231], v[172:175], v[196:199]
    ds_read_b128 v[244:247], v4 offset:23552
    v_cvt_pk_bf16_f32 v132, v204, v205
    v_exp_f32 v208, v208
    s_waitcnt lgkmcnt(3)
    v_mfma_f32_16x16x32_bf16 v[184:187], v[232:235], v[160:163], v[184:187]
    v_exp_f32 v209, v209
    v_mfma_f32_16x16x32_bf16 v[188:191], v[232:235], v[176:179], v[188:191]
    ds_read_b128 v[224:227], v4 offset:24576
    v_cvt_pk_bf16_f32 v133, v206, v207
    v_exp_f32 v210, v210
    s_waitcnt lgkmcnt(3)
    v_mfma_f32_16x16x32_bf16 v[192:195], v[236:239], v[160:163], v[192:195]
    v_exp_f32 v211, v211
    v_mfma_f32_16x16x32_bf16 v[196:199], v[236:239], v[176:179], v[196:199]
    ds_read_b128 v[228:231], v4 offset:25600
    v_cvt_pk_bf16_f32 v130, v208, v209
    v_exp_f32 v212, v212
    s_waitcnt lgkmcnt(3)
    v_mfma_f32_16x16x32_bf16 v[184:187], v[240:243], v[164:167], v[184:187]
    v_exp_f32 v213, v213
    v_cvt_pk_bf16_f32 v131, v210, v211
    v_mfma_f32_16x16x32_bf16 v[188:191], v[240:243], v[180:183], v[188:191]
    ds_read_b128 v[232:235], v4 offset:26624
    v_exp_f32 v214, v214
    s_waitcnt lgkmcnt(3)
    v_mfma_f32_16x16x32_bf16 v[192:195], v[244:247], v[164:167], v[192:195]
    v_exp_f32 v215, v215
    v_cvt_pk_bf16_f32 v134, v212, v213
    v_mfma_f32_16x16x32_bf16 v[196:199], v[244:247], v[180:183], v[196:199]
    ds_read_b128 v[236:239], v4 offset:27648
    v_cvt_pk_bf16_f32 v135, v214, v215
    s_waitcnt lgkmcnt(3)
    v_mfma_f32_16x16x32_bf16 v[200:203], v[224:227], v[152:155], v[216:219]
    s_add_u32 s22, s18, 50176
    s_add_u32 m0, s15, 7168
    s_nop 0
    buffer_load_dwordx4 v11, s[64:67], s22 offen lds
    v_mfma_f32_16x16x32_bf16 v[204:207], v[224:227], v[168:171], v[220:223]
    ds_read_b128 v[240:243], v4 offset:28672
    v_exp_f32 v184, v184
    v_exp_f32 v185, v185
    v_mfma_f32_16x16x32_bf16 v[248:251], v[12:15], v[128:131], v[248:251]
    s_waitcnt lgkmcnt(3)
    v_mfma_f32_16x16x32_bf16 v[208:211], v[228:231], v[152:155], v[216:219]
    v_exp_f32 v186, v186
    v_exp_f32 v187, v187
    v_mfma_f32_16x16x32_bf16 v[212:215], v[228:231], v[168:171], v[220:223]
    ds_read_b128 v[244:247], v4 offset:29696
    v_cvt_pk_bf16_f32 v136, v184, v185
    v_mfma_f32_16x16x32_bf16 v[252:255], v[12:15], v[132:135], v[252:255]
    s_waitcnt lgkmcnt(3)
    v_mfma_f32_16x16x32_bf16 v[200:203], v[232:235], v[156:159], v[200:203]
    v_exp_f32 v188, v188
    v_exp_f32 v189, v189
    v_mfma_f32_16x16x32_bf16 v[204:207], v[232:235], v[172:175], v[204:207]
    ds_read_b128 v[224:227], v4 offset:30720
    v_cvt_pk_bf16_f32 v137, v186, v187
    s_waitcnt lgkmcnt(3)
    v_mfma_f32_16x16x32_bf16 v[208:211], v[236:239], v[156:159], v[208:211]
    v_exp_f32 v190, v190
    v_exp_f32 v191, v191
    v_mfma_f32_16x16x32_bf16 v[212:215], v[236:239], v[172:175], v[212:215]
    ds_read_b128 v[228:231], v4 offset:31744
    v_cvt_pk_bf16_f32 v140, v188, v189
    v_exp_f32 v192, v192
    s_waitcnt lgkmcnt(3)
    v_mfma_f32_16x16x32_bf16 v[200:203], v[240:243], v[160:163], v[200:203]
    v_exp_f32 v193, v193
    v_mfma_f32_16x16x32_bf16 v[204:207], v[240:243], v[176:179], v[204:207]
    v_cvt_pk_bf16_f32 v141, v190, v191
    v_exp_f32 v194, v194
    s_waitcnt lgkmcnt(2)
    v_mfma_f32_16x16x32_bf16 v[208:211], v[244:247], v[160:163], v[208:211]
    v_exp_f32 v195, v195
    v_mfma_f32_16x16x32_bf16 v[212:215], v[244:247], v[176:179], v[212:215]
    v_cvt_pk_bf16_f32 v138, v192, v193
    v_exp_f32 v196, v196
    s_waitcnt lgkmcnt(1)
    v_mfma_f32_16x16x32_bf16 v[200:203], v[224:227], v[164:167], v[200:203]
    v_exp_f32 v197, v197
    v_cvt_pk_bf16_f32 v139, v194, v195
    v_mfma_f32_16x16x32_bf16 v[204:207], v[224:227], v[180:183], v[204:207]
    v_exp_f32 v198, v198
    s_waitcnt lgkmcnt(0)
    v_mfma_f32_16x16x32_bf16 v[208:211], v[228:231], v[164:167], v[208:211]
    v_exp_f32 v199, v199
    v_cvt_pk_bf16_f32 v142, v196, v197
    v_mfma_f32_16x16x32_bf16 v[212:215], v[228:231], v[180:183], v[212:215]
    v_cvt_pk_bf16_f32 v143, v198, v199
    s_waitcnt vmcnt(14)
    s_barrier
    ds_read_b128 v[232:235], v4 offset:32768
    ds_read_b128 v[236:239], v4 offset:33792
    ds_read_b128 v[240:243], v4 offset:34816
    ds_read_b128 v[244:247], v4 offset:35840
    v_mfma_f32_16x16x32_bf16 v[248:251], v[12:15], v[136:139], v[248:251]
    v_mfma_f32_16x16x32_bf16 v[252:255], v[12:15], v[140:143], v[252:255]
    v_exp_f32 v200, v200
    v_exp_f32 v201, v201
    v_exp_f32 v202, v202
    v_exp_f32 v203, v203
    v_cvt_pk_bf16_f32 v144, v200, v201
    v_exp_f32 v204, v204
    v_exp_f32 v205, v205
    v_cvt_pk_bf16_f32 v145, v202, v203
    v_exp_f32 v206, v206
    v_exp_f32 v207, v207
    v_cvt_pk_bf16_f32 v148, v204, v205
    v_exp_f32 v208, v208
    v_exp_f32 v209, v209
    v_cvt_pk_bf16_f32 v149, v206, v207
    v_exp_f32 v210, v210
    v_exp_f32 v211, v211
    v_cvt_pk_bf16_f32 v146, v208, v209
    v_exp_f32 v212, v212
    v_exp_f32 v213, v213
    v_cvt_pk_bf16_f32 v147, v210, v211
    v_exp_f32 v214, v214
    v_exp_f32 v215, v215
    v_cvt_pk_bf16_f32 v150, v212, v213
    v_cvt_pk_bf16_f32 v151, v214, v215
    v_mfma_f32_16x16x32_bf16 v[248:251], v[12:15], v[144:147], v[248:251]
    s_nop 0
    v_mfma_f32_16x16x32_bf16 v[252:255], v[12:15], v[148:151], v[252:255]
    s_nop 5
    v_mov_b32 v9, v248
    s_nop 0
    v_mov_b32 v10, v252
    v_max_f32 v17, v9, v10
    v_readfirstlane_b32 s17, v8
    s_cmp_eq_u32 s17, s28
    s_cselect_b32 s16, 0, 0x71800000
    v_cmp_ngt_f32 vcc, s16, v17
    v_cmp_u_f32 s[76:77], v9, v10
    s_or_b64 vcc, vcc, s[76:77]
    s_cbranch_vccnz adaLN_cond__sliding_block_cached__moe_arch_mod__prompt_kernel_fixB
adaLN_cond__sliding_block_cached__moe_arch_mod__prompt_kernel_fixBb:
    v_rcp_f32 v9, v9
    v_rcp_f32 v10, v10
    s_lshl_b32 s25, s13, 3
    s_add_u32 s25, s25, s3
    s_lshl_b32 s25, s25, 18
    s_lshl_b32 s26, s12, 12
    s_add_u32 s25, s25, s26
    s_add_u32 s25, s25, 0x1000000
    s_add_u32 s26, s25, 131072
    s_lshl_b32 s63, s13, 3
    s_add_u32 s63, s63, s3
    s_lshl_b32 s63, s63, 5
    s_add_u32 s63, s63, s12
    s_lshl_b32 s63, s63, 2
    s_waitcnt lgkmcnt(3)
    v_mfma_f32_16x16x32_bf16 v[184:187], v[232:235], v[24:27], 0
    s_mov_b64 s[76:77], s[54:55]
    s_mov_b32 s78, 0xc00000
    s_mov_b32 s79, 0x20000
    v_mfma_f32_16x16x32_bf16 v[188:191], v[232:235], v[28:31], 0
    ds_read_b128 v[224:227], v4 offset:36864
    s_waitcnt lgkmcnt(3)
    v_mfma_f32_16x16x32_bf16 v[192:195], v[236:239], v[24:27], 0
    s_add_u32 s22, s14, 0x0
    s_add_u32 m0, s20, 0x10000
    s_nop 0
    buffer_load_dwordx4 v6, s[76:79], s22 offen lds
    v_mfma_f32_16x16x32_bf16 v[196:199], v[236:239], v[28:31], 0
    ds_read_b128 v[228:231], v4 offset:37888
    s_waitcnt lgkmcnt(3)
    v_mfma_f32_16x16x32_bf16 v[184:187], v[240:243], v[32:35], v[184:187]
    v_mfma_f32_16x16x32_bf16 v[188:191], v[240:243], v[36:39], v[188:191]
    ds_read_b128 v[232:235], v4 offset:38912
    s_waitcnt lgkmcnt(3)
    v_mfma_f32_16x16x32_bf16 v[192:195], v[244:247], v[32:35], v[192:195]
    v_mfma_f32_16x16x32_bf16 v[196:199], v[244:247], v[36:39], v[196:199]
    ds_read_b128 v[236:239], v4 offset:39936
    s_waitcnt lgkmcnt(3)
    v_mfma_f32_16x16x32_bf16 v[184:187], v[224:227], v[40:43], v[184:187]
    v_mfma_f32_16x16x32_bf16 v[188:191], v[224:227], v[44:47], v[188:191]
    ds_read_b128 v[240:243], v4 offset:40960
    s_waitcnt lgkmcnt(3)
    v_mfma_f32_16x16x32_bf16 v[192:195], v[228:231], v[40:43], v[192:195]
    s_add_u32 s22, s14, 0xc000
    s_add_u32 m0, s20, 0x10400
    s_nop 0
    buffer_load_dwordx4 v6, s[76:79], s22 offen lds
    v_mfma_f32_16x16x32_bf16 v[196:199], v[228:231], v[44:47], v[196:199]
    ds_read_b128 v[244:247], v4 offset:41984
    s_waitcnt lgkmcnt(3)
    v_mfma_f32_16x16x32_bf16 v[184:187], v[232:235], v[48:51], v[184:187]
    v_mfma_f32_16x16x32_bf16 v[188:191], v[232:235], v[52:55], v[188:191]
    ds_read_b128 v[224:227], v4 offset:43008
    s_waitcnt lgkmcnt(3)
    v_mfma_f32_16x16x32_bf16 v[192:195], v[236:239], v[48:51], v[192:195]
    v_mfma_f32_16x16x32_bf16 v[196:199], v[236:239], v[52:55], v[196:199]
    ds_read_b128 v[228:231], v4 offset:44032
    s_waitcnt lgkmcnt(3)
    v_mfma_f32_16x16x32_bf16 v[184:187], v[240:243], v[56:59], v[184:187]
    v_mfma_f32_16x16x32_bf16 v[188:191], v[240:243], v[60:63], v[188:191]
    ds_read_b128 v[232:235], v4 offset:45056
    s_waitcnt lgkmcnt(3)
    v_mfma_f32_16x16x32_bf16 v[192:195], v[244:247], v[56:59], v[192:195]
    v_mfma_f32_16x16x32_bf16 v[196:199], v[244:247], v[60:63], v[196:199]
    ds_read_b128 v[236:239], v4 offset:46080
    s_waitcnt lgkmcnt(3)
    v_mfma_f32_16x16x32_bf16 v[184:187], v[224:227], v[64:67], v[184:187]
    v_mfma_f32_16x16x32_bf16 v[188:191], v[224:227], v[68:71], v[188:191]
    ds_read_b128 v[240:243], v4 offset:47104
    s_waitcnt lgkmcnt(3)
    v_mfma_f32_16x16x32_bf16 v[192:195], v[228:231], v[64:67], v[192:195]
    v_mfma_f32_16x16x32_bf16 v[196:199], v[228:231], v[68:71], v[196:199]
    ds_read_b128 v[244:247], v4 offset:48128
    s_waitcnt lgkmcnt(3)
    v_mfma_f32_16x16x32_bf16 v[184:187], v[232:235], v[72:75], v[184:187]
    v_mfma_f32_16x16x32_bf16 v[188:191], v[232:235], v[76:79], v[188:191]
    s_waitcnt vmcnt(12)
    s_barrier
    ds_read_b128 v[224:227], v4 offset:49152
    s_waitcnt lgkmcnt(3)
    v_mfma_f32_16x16x32_bf16 v[192:195], v[236:239], v[72:75], v[192:195]
    v_mfma_f32_16x16x32_bf16 v[196:199], v[236:239], v[76:79], v[196:199]
    s_add_u32 s22, s14, 0xc0000
    s_add_u32 m0, s20, 0x14000
    s_nop 0
    buffer_load_dwordx4 v6, s[76:79], s22 offen lds
    ds_read_b128 v[228:231], v4 offset:50176
    s_waitcnt lgkmcnt(3)
    v_mfma_f32_16x16x32_bf16 v[184:187], v[240:243], v[80:83], v[184:187]
    v_mfma_f32_16x16x32_bf16 v[188:191], v[240:243], v[84:87], v[188:191]
    ds_read_b128 v[232:235], v4 offset:51200
    s_waitcnt lgkmcnt(3)
    v_mfma_f32_16x16x32_bf16 v[192:195], v[244:247], v[80:83], v[192:195]
    v_mfma_f32_16x16x32_bf16 v[196:199], v[244:247], v[84:87], v[196:199]
    ds_read_b128 v[236:239], v4 offset:52224
    s_waitcnt lgkmcnt(3)
    v_mfma_f32_16x16x32_bf16 v[184:187], v[224:227], v[88:91], v[184:187]
    v_mfma_f32_16x16x32_bf16 v[188:191], v[224:227], v[92:95], v[188:191]
    ds_read_b128 v[240:243], v4 offset:53248
    s_waitcnt lgkmcnt(3)
    v_mfma_f32_16x16x32_bf16 v[192:195], v[228:231], v[88:91], v[192:195]
    v_mfma_f32_16x16x32_bf16 v[196:199], v[228:231], v[92:95], v[196:199]
    s_add_u32 s22, s14, 0xcc000
    s_add_u32 m0, s20, 0x14400
    s_nop 0
    buffer_load_dwordx4 v6, s[76:79], s22 offen lds
    ds_read_b128 v[244:247], v4 offset:54272
    s_waitcnt lgkmcnt(3)
    v_mfma_f32_16x16x32_bf16 v[184:187], v[232:235], v[96:99], v[184:187]
    v_mfma_f32_16x16x32_bf16 v[188:191], v[232:235], v[100:103], v[188:191]
    ds_read_b128 v[224:227], v4 offset:55296
    s_waitcnt lgkmcnt(3)
    v_mfma_f32_16x16x32_bf16 v[192:195], v[236:239], v[96:99], v[192:195]
    v_mfma_f32_16x16x32_bf16 v[196:199], v[236:239], v[100:103], v[196:199]
    ds_read_b128 v[228:231], v4 offset:56320
    s_waitcnt lgkmcnt(3)
    v_mfma_f32_16x16x32_bf16 v[184:187], v[240:243], v[104:107], v[184:187]
    v_mfma_f32_16x16x32_bf16 v[188:191], v[240:243], v[108:111], v[188:191]
    ds_read_b128 v[232:235], v4 offset:57344
    s_waitcnt lgkmcnt(3)
    v_mfma_f32_16x16x32_bf16 v[192:195], v[244:247], v[104:107], v[192:195]
    v_mfma_f32_16x16x32_bf16 v[196:199], v[244:247], v[108:111], v[196:199]
    ds_read_b128 v[236:239], v4 offset:58368
    s_waitcnt lgkmcnt(3)
    v_mfma_f32_16x16x32_bf16 v[184:187], v[224:227], v[112:115], v[184:187]
    v_mfma_f32_16x16x32_bf16 v[188:191], v[224:227], v[116:119], v[188:191]
    ds_read_b128 v[240:243], v4 offset:59392
    s_waitcnt lgkmcnt(3)
    v_mfma_f32_16x16x32_bf16 v[192:195], v[228:231], v[112:115], v[192:195]
    v_mfma_f32_16x16x32_bf16 v[196:199], v[228:231], v[116:119], v[196:199]
    ds_read_b128 v[244:247], v4 offset:60416
    s_waitcnt lgkmcnt(3)
    v_mfma_f32_16x16x32_bf16 v[184:187], v[232:235], v[120:123], v[184:187]
    v_mfma_f32_16x16x32_bf16 v[188:191], v[232:235], v[124:127], v[188:191]
    ds_read_b128 v[224:227], v4 offset:61440
    s_waitcnt lgkmcnt(3)
    v_mfma_f32_16x16x32_bf16 v[192:195], v[236:239], v[120:123], v[192:195]
    v_mfma_f32_16x16x32_bf16 v[196:199], v[236:239], v[124:127], v[196:199]
    ds_read_b128 v[228:231], v4 offset:62464
    s_waitcnt lgkmcnt(3)
    v_mfma_f32_16x16x32_bf16 v[184:187], v[240:243], v[128:131], v[184:187]
    v_mfma_f32_16x16x32_bf16 v[188:191], v[240:243], v[132:135], v[188:191]
    ds_read_b128 v[232:235], v4 offset:63488
    s_waitcnt lgkmcnt(3)
    v_mfma_f32_16x16x32_bf16 v[192:195], v[244:247], v[128:131], v[192:195]
    v_mfma_f32_16x16x32_bf16 v[196:199], v[244:247], v[132:135], v[196:199]
    ds_read_b128 v[236:239], v4 offset:64512
    s_waitcnt lgkmcnt(3)
    v_mfma_f32_16x16x32_bf16 v[184:187], v[224:227], v[136:139], v[184:187]
    v_mfma_f32_16x16x32_bf16 v[188:191], v[224:227], v[140:143], v[188:191]
    s_waitcnt vmcnt(9)
    s_barrier
    ds_read_b128 v[240:243], v5 offset:0
    s_waitcnt lgkmcnt(3)
    v_mfma_f32_16x16x32_bf16 v[192:195], v[228:231], v[136:139], v[192:195]
    v_mfma_f32_16x16x32_bf16 v[196:199], v[228:231], v[140:143], v[196:199]
    s_add_u32 s22, s21, 0x90000
    s_add_u32 m0, s20, 0x18000
    s_nop 0
    buffer_load_dwordx4 v2, s[8:11], s22 offen sc1 lds
    ds_read_b128 v[244:247], v5 offset:1024
    s_waitcnt lgkmcnt(3)
    v_mfma_f32_16x16x32_bf16 v[184:187], v[232:235], v[144:147], v[184:187]
    v_mfma_f32_16x16x32_bf16 v[188:191], v[232:235], v[148:151], v[188:191]
    ds_read_b128 v[224:227], v5 offset:2048
    s_waitcnt lgkmcnt(3)
    v_mfma_f32_16x16x32_bf16 v[192:195], v[236:239], v[144:147], v[192:195]
    v_mfma_f32_16x16x32_bf16 v[196:199], v[236:239], v[148:151], v[196:199]
    ds_read_b128 v[228:231], v5 offset:3072
    s_waitcnt lgkmcnt(3)
    v_mfma_f32_16x16x32_bf16 v[200:203], v[240:243], v[24:27], 0
    v_mfma_f32_16x16x32_bf16 v[204:207], v[240:243], v[28:31], 0
    ds_read_b128 v[232:235], v5 offset:4096
    s_waitcnt lgkmcnt(3)
    v_mfma_f32_16x16x32_bf16 v[208:211], v[244:247], v[24:27], 0
    v_mfma_f32_16x16x32_bf16 v[212:215], v[244:247], v[28:31], 0
    s_add_u32 s22, s21, 0x90400
    s_add_u32 m0, s20, 0x18400
    s_nop 0
    buffer_load_dwordx4 v2, s[8:11], s22 offen sc1 lds
    ds_read_b128 v[236:239], v5 offset:5120
    v_mul_f32 v184, v184, v9
    s_waitcnt lgkmcnt(3)
    v_mfma_f32_16x16x32_bf16 v[200:203], v[224:227], v[32:35], v[200:203]
    v_mul_f32 v185, v185, v9
    v_mfma_f32_16x16x32_bf16 v[204:207], v[224:227], v[36:39], v[204:207]
    ds_read_b128 v[240:243], v5 offset:6144
    v_mul_f32 v186, v186, v9
    s_waitcnt lgkmcnt(3)
    v_mfma_f32_16x16x32_bf16 v[208:211], v[228:231], v[32:35], v[208:211]
    v_mul_f32 v187, v187, v9
    v_mfma_f32_16x16x32_bf16 v[212:215], v[228:231], v[36:39], v[212:215]
    ds_read_b128 v[244:247], v5 offset:7168
    v_mul_f32 v192, v192, v9
    s_waitcnt lgkmcnt(3)
    v_mfma_f32_16x16x32_bf16 v[200:203], v[232:235], v[40:43], v[200:203]
    v_mul_f32 v193, v193, v9
    v_mfma_f32_16x16x32_bf16 v[204:207], v[232:235], v[44:47], v[204:207]
    ds_read_b128 v[224:227], v5 offset:8192
    v_mul_f32 v194, v194, v9
    s_waitcnt lgkmcnt(3)
    v_mfma_f32_16x16x32_bf16 v[208:211], v[236:239], v[40:43], v[208:211]
    v_mul_f32 v195, v195, v9
    v_mfma_f32_16x16x32_bf16 v[212:215], v[236:239], v[44:47], v[212:215]
    ds_read_b128 v[228:231], v5 offset:9216
    v_cvt_pk_bf16_f32 v216, v184, v185
    s_waitcnt lgkmcnt(3)
    v_mfma_f32_16x16x32_bf16 v[200:203], v[240:243], v[48:51], v[200:203]
    v_cvt_pk_bf16_f32 v217, v186, v187
    v_mfma_f32_16x16x32_bf16 v[204:207], v[240:243], v[52:55], v[204:207]
    ds_read_b128 v[232:235], v5 offset:10240
    v_cvt_pk_bf16_f32 v218, v192, v193
    s_waitcnt lgkmcnt(3)
    v_mfma_f32_16x16x32_bf16 v[208:211], v[244:247], v[48:51], v[208:211]
    v_cvt_pk_bf16_f32 v219, v194, v195
    v_mfma_f32_16x16x32_bf16 v[212:215], v[244:247], v[52:55], v[212:215]
    ds_read_b128 v[236:239], v5 offset:11264
    buffer_store_dwordx4 v[216:219], v2, s[8:11], s25 offen offset:0 sc1
    s_waitcnt lgkmcnt(3)
    v_mfma_f32_16x16x32_bf16 v[200:203], v[224:227], v[56:59], v[200:203]
    v_mul_f32 v188, v188, v10
    v_mfma_f32_16x16x32_bf16 v[204:207], v[224:227], v[60:63], v[204:207]
    ds_read_b128 v[240:243], v5 offset:12288
    v_mul_f32 v189, v189, v10
    s_waitcnt lgkmcnt(3)
    v_mfma_f32_16x16x32_bf16 v[208:211], v[228:231], v[56:59], v[208:211]
    v_mul_f32 v190, v190, v10
    v_mfma_f32_16x16x32_bf16 v[212:215], v[228:231], v[60:63], v[212:215]
    ds_read_b128 v[244:247], v5 offset:13312
    v_mul_f32 v191, v191, v10
    s_waitcnt lgkmcnt(3)
    v_mfma_f32_16x16x32_bf16 v[200:203], v[232:235], v[64:67], v[200:203]
    v_mul_f32 v196, v196, v10
    v_mfma_f32_16x16x32_bf16 v[204:207], v[232:235], v[68:71], v[204:207]
    ds_read_b128 v[224:227], v5 offset:14336
    v_mul_f32 v197, v197, v10
    s_waitcnt lgkmcnt(3)
    v_mfma_f32_16x16x32_bf16 v[208:211], v[236:239], v[64:67], v[208:211]
    v_mul_f32 v198, v198, v10
    v_mfma_f32_16x16x32_bf16 v[212:215], v[236:239], v[68:71], v[212:215]
    ds_read_b128 v[228:231], v5 offset:15360
    v_mul_f32 v199, v199, v10
    s_waitcnt lgkmcnt(3)
    v_mfma_f32_16x16x32_bf16 v[200:203], v[240:243], v[72:75], v[200:203]
    v_cvt_pk_bf16_f32 v220, v188, v189
    v_mfma_f32_16x16x32_bf16 v[204:207], v[240:243], v[76:79], v[204:207]
    s_waitcnt vmcnt(8)
    s_barrier
    ds_read_b128 v[232:235], v5 offset:16384
    v_cvt_pk_bf16_f32 v221, v190, v191
    s_waitcnt lgkmcnt(3)
    v_mfma_f32_16x16x32_bf16 v[208:211], v[244:247], v[72:75], v[208:211]
    v_cvt_pk_bf16_f32 v222, v196, v197
    v_mfma_f32_16x16x32_bf16 v[212:215], v[244:247], v[76:79], v[212:215]
    s_add_u32 s22, s21, 0x94000
    s_add_u32 m0, s20, 0x1c000
    s_nop 0
    buffer_load_dwordx4 v2, s[8:11], s22 offen sc1 lds
    ds_read_b128 v[236:239], v5 offset:17408
    v_cvt_pk_bf16_f32 v223, v198, v199
    s_waitcnt lgkmcnt(3)
    v_mfma_f32_16x16x32_bf16 v[200:203], v[224:227], v[80:83], v[200:203]
    buffer_store_dwordx4 v[220:223], v2, s[8:11], s26 offen offset:0 sc1
    v_mfma_f32_16x16x32_bf16 v[204:207], v[224:227], v[84:87], v[204:207]
    ds_read_b128 v[240:243], v5 offset:18432
    s_waitcnt lgkmcnt(3)
    v_mfma_f32_16x16x32_bf16 v[208:211], v[228:231], v[80:83], v[208:211]
    v_mfma_f32_16x16x32_bf16 v[212:215], v[228:231], v[84:87], v[212:215]
    ds_read_b128 v[244:247], v5 offset:19456
    s_waitcnt lgkmcnt(3)
    v_mfma_f32_16x16x32_bf16 v[200:203], v[232:235], v[88:91], v[200:203]
    v_lshrrev_b32 v20, 4, v1
    v_lshlrev_b32 v21, 4, v20
    s_lshl_b32 s16, s2, 8
    s_add_u32 s16, s16, 0x550000
    buffer_load_dwordx4 v[152:155], v21, s[8:11], s16 offen offset:0 sc1
    buffer_load_dwordx4 v[156:159], v21, s[8:11], s16 offen offset:64 sc1
    buffer_load_dwordx4 v[160:163], v21, s[8:11], s16 offen offset:128 sc1
    buffer_load_dwordx4 v[164:167], v21, s[8:11], s16 offen offset:192 sc1
    v_lshlrev_b32 v11, 11, v20
    v_xor_b32 v20, s3, v20
    v_and_b32 v20, 1, v20
    v_lshl_add_u32 v11, v20, 5, v11
    v_bfe_u32 v20, v1, 2, 2
    v_lshl_add_u32 v11, v20, 6, v11
    v_and_b32 v20, 3, v1
    v_lshl_add_u32 v11, v20, 3, v11
    s_lshr_b32 s16, s3, 1
    s_lshl_b32 s16, s16, 8
    s_add_u32 s16, s16, 65536
    v_add_u32 v11, s16, v11
    v_mfma_f32_16x16x32_bf16 v[204:207], v[232:235], v[92:95], v[204:207]
    ds_read_b128 v[224:227], v5 offset:20480
    s_waitcnt lgkmcnt(3)
    v_mfma_f32_16x16x32_bf16 v[208:211], v[236:239], v[88:91], v[208:211]
    v_mfma_f32_16x16x32_bf16 v[212:215], v[236:239], v[92:95], v[212:215]
    s_add_u32 s22, s21, 0x94400
    s_add_u32 m0, s20, 0x1c400
    s_nop 0
    buffer_load_dwordx4 v2, s[8:11], s22 offen sc1 lds
    ds_read_b128 v[228:231], v5 offset:21504
    s_waitcnt lgkmcnt(3)
    v_mfma_f32_16x16x32_bf16 v[200:203], v[240:243], v[96:99], v[200:203]
    v_mfma_f32_16x16x32_bf16 v[204:207], v[240:243], v[100:103], v[204:207]
    ds_read_b128 v[232:235], v5 offset:22528
    s_waitcnt lgkmcnt(3)
    v_mfma_f32_16x16x32_bf16 v[208:211], v[244:247], v[96:99], v[208:211]
    v_mfma_f32_16x16x32_bf16 v[212:215], v[244:247], v[100:103], v[212:215]
    ds_read_b128 v[236:239], v5 offset:23552
    s_waitcnt lgkmcnt(3)
    v_mfma_f32_16x16x32_bf16 v[200:203], v[224:227], v[104:107], v[200:203]
    v_mfma_f32_16x16x32_bf16 v[204:207], v[224:227], v[108:111], v[204:207]
    ds_read_b128 v[240:243], v5 offset:24576
    s_waitcnt lgkmcnt(3)
    v_mfma_f32_16x16x32_bf16 v[208:211], v[228:231], v[104:107], v[208:211]
    v_mfma_f32_16x16x32_bf16 v[212:215], v[228:231], v[108:111], v[212:215]
    ds_read_b128 v[244:247], v5 offset:25600
    s_waitcnt lgkmcnt(3)
    v_mfma_f32_16x16x32_bf16 v[200:203], v[232:235], v[112:115], v[200:203]
    v_mfma_f32_16x16x32_bf16 v[204:207], v[232:235], v[116:119], v[204:207]
    ds_read_b128 v[224:227], v5 offset:26624
    s_waitcnt lgkmcnt(3)
    v_mfma_f32_16x16x32_bf16 v[208:211], v[236:239], v[112:115], v[208:211]
    v_mfma_f32_16x16x32_bf16 v[212:215], v[236:239], v[116:119], v[212:215]
    ds_read_b128 v[228:231], v5 offset:27648
    s_waitcnt lgkmcnt(3)
    v_mfma_f32_16x16x32_bf16 v[200:203], v[240:243], v[120:123], v[200:203]
    v_mfma_f32_16x16x32_bf16 v[204:207], v[240:243], v[124:127], v[204:207]
    ds_read_b128 v[232:235], v5 offset:28672
    s_waitcnt lgkmcnt(3)
    v_mfma_f32_16x16x32_bf16 v[208:211], v[244:247], v[120:123], v[208:211]
    v_mfma_f32_16x16x32_bf16 v[212:215], v[244:247], v[124:127], v[212:215]
    ds_read_b128 v[236:239], v5 offset:29696
    s_waitcnt lgkmcnt(3)
    v_mfma_f32_16x16x32_bf16 v[200:203], v[224:227], v[128:131], v[200:203]
    v_mfma_f32_16x16x32_bf16 v[204:207], v[224:227], v[132:135], v[204:207]
    ds_read_b128 v[240:243], v5 offset:30720
    s_waitcnt lgkmcnt(3)
    v_mfma_f32_16x16x32_bf16 v[208:211], v[228:231], v[128:131], v[208:211]
    v_mfma_f32_16x16x32_bf16 v[212:215], v[228:231], v[132:135], v[212:215]
    ds_read_b128 v[244:247], v5 offset:31744
    s_waitcnt lgkmcnt(3)
    v_mfma_f32_16x16x32_bf16 v[200:203], v[232:235], v[136:139], v[200:203]
    s_waitcnt vmcnt(5)
    s_add_u32 s16, s63, 0x570000
    v_mov_b32 v7, s28
    v_mov_b32 v8, 0
    s_mov_b64 exec, 1
    buffer_store_dword v7, v8, s[8:11], s16 offen sc1
    s_mov_b64 exec, -1
    v_mfma_f32_16x16x32_bf16 v[204:207], v[232:235], v[140:143], v[204:207]
    s_barrier
    ds_read_b128 v[224:227], v4 offset:32768
    s_waitcnt lgkmcnt(3)
    v_mfma_f32_16x16x32_bf16 v[208:211], v[236:239], v[136:139], v[208:211]
    v_mfma_f32_16x16x32_bf16 v[212:215], v[236:239], v[140:143], v[212:215]
    s_add_u32 s22, s21, 0x98000
    s_add_u32 m0, s20, 0x20000
    s_nop 0
    buffer_load_dwordx4 v2, s[8:11], s22 offen sc1 lds
    ds_read_b128 v[228:231], v4 offset:33792
    s_waitcnt lgkmcnt(3)
    v_mfma_f32_16x16x32_bf16 v[200:203], v[240:243], v[144:147], v[200:203]
    ds_read_b64_tr_b16 v[168:169], v11 offset:0
    ds_read_b64_tr_b16 v[170:171], v11 offset:1024
    ds_read_b64_tr_b16 v[172:173], v11 offset:8192
    ds_read_b64_tr_b16 v[174:175], v11 offset:9216
    ds_read_b64_tr_b16 v[176:177], v11 offset:16384
    ds_read_b64_tr_b16 v[178:179], v11 offset:17408
    ds_read_b64_tr_b16 v[180:181], v11 offset:24576
    ds_read_b64_tr_b16 v[182:183], v11 offset:25600
    v_mfma_f32_16x16x32_bf16 v[204:207], v[240:243], v[148:151], v[204:207]
    ds_read_b128 v[232:235], v4 offset:34816
    s_waitcnt lgkmcnt(11)
    v_mfma_f32_16x16x32_bf16 v[208:211], v[244:247], v[144:147], v[208:211]
    v_mfma_f32_16x16x32_bf16 v[212:215], v[244:247], v[148:151], v[212:215]
    ds_read_b128 v[236:239], v4 offset:35840
    s_waitcnt lgkmcnt(11)
    v_mfma_f32_16x16x32_bf16 v[184:187], v[224:227], v[24:27], 0
    v_mfma_f32_16x16x32_bf16 v[188:191], v[224:227], v[28:31], 0
    ds_read_b128 v[240:243], v4 offset:36864
    s_waitcnt lgkmcnt(11)
    v_mfma_f32_16x16x32_bf16 v[192:195], v[228:231], v[24:27], 0
    v_mfma_f32_16x16x32_bf16 v[196:199], v[228:231], v[28:31], 0
    s_add_u32 s22, s21, 0x98400
    s_add_u32 m0, s20, 0x20400
    s_nop 0
    buffer_load_dwordx4 v2, s[8:11], s22 offen sc1 lds
    ds_read_b128 v[244:247], v4 offset:37888
    v_mul_f32 v200, v200, v9
    s_waitcnt lgkmcnt(3)
    v_mfma_f32_16x16x32_bf16 v[184:187], v[232:235], v[32:35], v[184:187]
    v_mul_f32 v201, v201, v9
    v_mfma_f32_16x16x32_bf16 v[188:191], v[232:235], v[36:39], v[188:191]
    ds_read_b128 v[224:227], v4 offset:38912
    v_mul_f32 v202, v202, v9
    s_waitcnt lgkmcnt(3)
    v_mfma_f32_16x16x32_bf16 v[192:195], v[236:239], v[32:35], v[192:195]
    v_mul_f32 v203, v203, v9
    s_waitcnt vmcnt(7)
    v_mfma_f32_16x16x32_bf16 v[248:251], v[168:171], v[152:155], 0
    s_waitcnt vmcnt(6)
    v_mfma_f32_16x16x32_bf16 v[248:251], v[172:175], v[156:159], v[248:251]
    s_waitcnt vmcnt(5)
    v_mfma_f32_16x16x32_bf16 v[248:251], v[176:179], v[160:163], v[248:251]
    s_waitcnt vmcnt(4)
    v_mfma_f32_16x16x32_bf16 v[248:251], v[180:183], v[164:167], v[248:251]
    v_mfma_f32_16x16x32_bf16 v[196:199], v[236:239], v[36:39], v[196:199]
    ds_read_b128 v[228:231], v4 offset:39936
    v_mul_f32 v208, v208, v9
    s_waitcnt lgkmcnt(3)
    v_mfma_f32_16x16x32_bf16 v[184:187], v[240:243], v[40:43], v[184:187]
    v_mul_f32 v209, v209, v9
    v_mfma_f32_16x16x32_bf16 v[188:191], v[240:243], v[44:47], v[188:191]
    ds_read_b128 v[232:235], v4 offset:40960
    v_mul_f32 v210, v210, v9
    s_waitcnt lgkmcnt(3)
    v_mfma_f32_16x16x32_bf16 v[192:195], v[244:247], v[40:43], v[192:195]
    v_mul_f32 v211, v211, v9
    v_mfma_f32_16x16x32_bf16 v[196:199], v[244:247], v[44:47], v[196:199]
    ds_read_b128 v[236:239], v4 offset:41984
    v_cvt_pk_bf16_f32 v216, v200, v201
    s_waitcnt lgkmcnt(3)
    v_mfma_f32_16x16x32_bf16 v[184:187], v[224:227], v[48:51], v[184:187]
    v_cvt_pk_bf16_f32 v217, v202, v203
    v_mfma_f32_16x16x32_bf16 v[188:191], v[224:227], v[52:55], v[188:191]
    ds_read_b128 v[240:243], v4 offset:43008
    v_cvt_pk_bf16_f32 v218, v208, v209
    s_waitcnt lgkmcnt(3)
    v_mfma_f32_16x16x32_bf16 v[192:195], v[228:231], v[48:51], v[192:195]
    v_cvt_pk_bf16_f32 v219, v210, v211
    v_mfma_f32_16x16x32_bf16 v[196:199], v[228:231], v[52:55], v[196:199]
    ds_read_b128 v[244:247], v4 offset:44032
    buffer_store_dwordx4 v[216:219], v2, s[8:11], s25 offen offset:1024 sc1
    s_waitcnt lgkmcnt(3)
    v_mfma_f32_16x16x32_bf16 v[184:187], v[232:235], v[56:59], v[184:187]
    v_mul_f32 v204, v204, v10
    v_mfma_f32_16x16x32_bf16 v[188:191], v[232:235], v[60:63], v[188:191]
    ds_read_b128 v[224:227], v4 offset:45056
    v_mul_f32 v205, v205, v10
    s_waitcnt lgkmcnt(3)
    v_mfma_f32_16x16x32_bf16 v[192:195], v[236:239], v[56:59], v[192:195]
    v_mul_f32 v206, v206, v10
    v_lshrrev_b32 v20, 4, v1
    v_lshlrev_b32 v20, 4, v20
    s_lshr_b32 s16, s2, 5
    s_lshl_b32 s16, s16, 14
    s_and_b32 s17, s2, 31
    s_lshl_b32 s17, s17, 9
    s_add_u32 s16, s16, s17
    s_lshl_b32 s17, s3, 6
    s_add_u32 s16, s16, s17
    s_add_u32 s16, s16, 0x580000
    s_mov_b32 exec_lo, 0x10001
    s_mov_b32 exec_hi, 0x10001
    buffer_store_dwordx4 v[248:251], v20, s[8:11], s16 offen sc1
    s_mov_b64 exec, -1
    v_mfma_f32_16x16x32_bf16 v[196:199], v[236:239], v[60:63], v[196:199]
    ds_read_b128 v[228:231], v4 offset:46080
    v_mul_f32 v207, v207, v10
    s_waitcnt lgkmcnt(3)
    v_mfma_f32_16x16x32_bf16 v[184:187], v[240:243], v[64:67], v[184:187]
    v_mul_f32 v212, v212, v10
    v_mfma_f32_16x16x32_bf16 v[188:191], v[240:243], v[68:71], v[188:191]
    ds_read_b128 v[232:235], v4 offset:47104
    v_mul_f32 v213, v213, v10
    s_waitcnt lgkmcnt(3)
    v_mfma_f32_16x16x32_bf16 v[192:195], v[244:247], v[64:67], v[192:195]
    v_mul_f32 v214, v214, v10
    v_mfma_f32_16x16x32_bf16 v[196:199], v[244:247], v[68:71], v[196:199]
    ds_read_b128 v[236:239], v4 offset:48128
    v_mul_f32 v215, v215, v10
    s_waitcnt lgkmcnt(3)
    v_mfma_f32_16x16x32_bf16 v[184:187], v[224:227], v[72:75], v[184:187]
    v_cvt_pk_bf16_f32 v220, v204, v205
    v_mfma_f32_16x16x32_bf16 v[188:191], v[224:227], v[76:79], v[188:191]
    s_waitcnt vmcnt(5)
    s_barrier
    ds_read_b128 v[240:243], v4 offset:49152
    v_cvt_pk_bf16_f32 v221, v206, v207
    s_waitcnt lgkmcnt(3)
    v_mfma_f32_16x16x32_bf16 v[192:195], v[228:231], v[72:75], v[192:195]
    v_cvt_pk_bf16_f32 v222, v212, v213
    v_mfma_f32_16x16x32_bf16 v[196:199], v[228:231], v[76:79], v[196:199]
    s_add_u32 s22, s21, 0x9c000
    s_add_u32 m0, s20, 0x24000
    s_nop 0
    buffer_load_dwordx4 v2, s[8:11], s22 offen sc1 lds
    ds_read_b128 v[244:247], v4 offset:50176
    v_cvt_pk_bf16_f32 v223, v214, v215
    s_waitcnt lgkmcnt(3)
    v_mfma_f32_16x16x32_bf16 v[184:187], v[232:235], v[80:83], v[184:187]
    buffer_store_dwordx4 v[220:223], v2, s[8:11], s26 offen offset:1024 sc1
    v_mfma_f32_16x16x32_bf16 v[188:191], v[232:235], v[84:87], v[188:191]
    ds_read_b128 v[224:227], v4 offset:51200
    s_waitcnt lgkmcnt(3)
    v_mfma_f32_16x16x32_bf16 v[192:195], v[236:239], v[80:83], v[192:195]
    v_mfma_f32_16x16x32_bf16 v[196:199], v[236:239], v[84:87], v[196:199]
    s_add_u32 s22, s21, 0x9c400
    s_add_u32 m0, s20, 0x24400
    s_nop 0
    buffer_load_dwordx4 v2, s[8:11], s22 offen sc1 lds
    ds_read_b128 v[228:231], v4 offset:52224
    s_waitcnt lgkmcnt(3)
    v_mfma_f32_16x16x32_bf16 v[184:187], v[240:243], v[88:91], v[184:187]
    v_mfma_f32_16x16x32_bf16 v[188:191], v[240:243], v[92:95], v[188:191]
    ds_read_b128 v[232:235], v4 offset:53248
    s_waitcnt lgkmcnt(3)
    v_mfma_f32_16x16x32_bf16 v[192:195], v[244:247], v[88:91], v[192:195]
    v_mfma_f32_16x16x32_bf16 v[196:199], v[244:247], v[92:95], v[196:199]
    s_add_u32 s22, s24, 0x0
    s_add_u32 m0, s20, 0x10000
    s_nop 0
    buffer_load_dwordx4 v3, s[4:7], s22 offen lds
    ds_read_b128 v[236:239], v4 offset:54272
    s_waitcnt lgkmcnt(3)
    v_mfma_f32_16x16x32_bf16 v[184:187], v[224:227], v[96:99], v[184:187]
    v_mfma_f32_16x16x32_bf16 v[188:191], v[224:227], v[100:103], v[188:191]
    ds_read_b128 v[240:243], v4 offset:55296
    s_waitcnt lgkmcnt(3)
    v_mfma_f32_16x16x32_bf16 v[192:195], v[228:231], v[96:99], v[192:195]
    v_mfma_f32_16x16x32_bf16 v[196:199], v[228:231], v[100:103], v[196:199]
    s_add_u32 s22, s24, 0x2000
    s_add_u32 m0, s20, 0x10400
    s_nop 0
    buffer_load_dwordx4 v3, s[4:7], s22 offen lds
    ds_read_b128 v[244:247], v4 offset:56320
    s_waitcnt lgkmcnt(3)
    v_mfma_f32_16x16x32_bf16 v[184:187], v[232:235], v[104:107], v[184:187]
    v_mfma_f32_16x16x32_bf16 v[188:191], v[232:235], v[108:111], v[188:191]
    ds_read_b128 v[224:227], v4 offset:57344
    s_waitcnt lgkmcnt(3)
    v_mfma_f32_16x16x32_bf16 v[192:195], v[236:239], v[104:107], v[192:195]
    v_mfma_f32_16x16x32_bf16 v[196:199], v[236:239], v[108:111], v[196:199]
    ds_read_b128 v[228:231], v4 offset:58368
    s_waitcnt lgkmcnt(3)
    v_mfma_f32_16x16x32_bf16 v[184:187], v[240:243], v[112:115], v[184:187]
    v_mfma_f32_16x16x32_bf16 v[188:191], v[240:243], v[116:119], v[188:191]
    ds_read_b128 v[232:235], v4 offset:59392
    s_waitcnt lgkmcnt(3)
    v_mfma_f32_16x16x32_bf16 v[192:195], v[244:247], v[112:115], v[192:195]
    v_mfma_f32_16x16x32_bf16 v[196:199], v[244:247], v[116:119], v[196:199]
    ds_read_b128 v[236:239], v4 offset:60416
    s_waitcnt lgkmcnt(3)
    v_mfma_f32_16x16x32_bf16 v[184:187], v[224:227], v[120:123], v[184:187]
    v_mfma_f32_16x16x32_bf16 v[188:191], v[224:227], v[124:127], v[188:191]
    ds_read_b128 v[240:243], v4 offset:61440
    s_waitcnt lgkmcnt(3)
    v_mfma_f32_16x16x32_bf16 v[192:195], v[228:231], v[120:123], v[192:195]
    v_mfma_f32_16x16x32_bf16 v[196:199], v[228:231], v[124:127], v[196:199]
    ds_read_b128 v[244:247], v4 offset:62464
    s_waitcnt lgkmcnt(3)
    v_mfma_f32_16x16x32_bf16 v[184:187], v[232:235], v[128:131], v[184:187]
    v_mfma_f32_16x16x32_bf16 v[188:191], v[232:235], v[132:135], v[188:191]
    ds_read_b128 v[224:227], v4 offset:63488
    s_waitcnt lgkmcnt(3)
    v_mfma_f32_16x16x32_bf16 v[192:195], v[236:239], v[128:131], v[192:195]
    v_mfma_f32_16x16x32_bf16 v[196:199], v[236:239], v[132:135], v[196:199]
    ds_read_b128 v[228:231], v4 offset:64512
    s_waitcnt lgkmcnt(3)
    v_mfma_f32_16x16x32_bf16 v[184:187], v[240:243], v[136:139], v[184:187]
    v_mfma_f32_16x16x32_bf16 v[188:191], v[240:243], v[140:143], v[188:191]
    s_waitcnt vmcnt(7)
    s_barrier
    ds_read_b128 v[232:235], v5 offset:0
    s_waitcnt lgkmcnt(3)
    v_mfma_f32_16x16x32_bf16 v[192:195], v[244:247], v[136:139], v[192:195]
    v_mfma_f32_16x16x32_bf16 v[196:199], v[244:247], v[140:143], v[196:199]
    s_add_u32 s22, s24, 0x80000
    s_add_u32 m0, s20, 0x14000
    s_nop 0
    buffer_load_dwordx4 v3, s[4:7], s22 offen lds
    ds_read_b128 v[236:239], v5 offset:1024
    s_waitcnt lgkmcnt(3)
    v_mfma_f32_16x16x32_bf16 v[184:187], v[224:227], v[144:147], v[184:187]
    v_mfma_f32_16x16x32_bf16 v[188:191], v[224:227], v[148:151], v[188:191]
    ds_read_b128 v[240:243], v5 offset:2048
    s_waitcnt lgkmcnt(3)
    v_mfma_f32_16x16x32_bf16 v[192:195], v[228:231], v[144:147], v[192:195]
    v_mfma_f32_16x16x32_bf16 v[196:199], v[228:231], v[148:151], v[196:199]
    s_add_u32 s22, s24, 0x82000
    s_add_u32 m0, s20, 0x14400
    s_nop 0
    buffer_load_dwordx4 v3, s[4:7], s22 offen lds
    ds_read_b128 v[244:247], v5 offset:3072
    s_waitcnt lgkmcnt(3)
    v_mfma_f32_16x16x32_bf16 v[200:203], v[232:235], v[24:27], 0
    v_mfma_f32_16x16x32_bf16 v[204:207], v[232:235], v[28:31], 0
    ds_read_b128 v[224:227], v5 offset:4096
    s_waitcnt lgkmcnt(3)
    v_mfma_f32_16x16x32_bf16 v[208:211], v[236:239], v[24:27], 0
    v_mfma_f32_16x16x32_bf16 v[212:215], v[236:239], v[28:31], 0
    s_add_u32 s22, s24, 0x100000
    s_add_u32 m0, s20, 0x18000
    s_nop 0
    buffer_load_dwordx4 v3, s[4:7], s22 offen lds
    ds_read_b128 v[228:231], v5 offset:5120
    v_mul_f32 v184, v184, v9
    s_waitcnt lgkmcnt(3)
    v_mfma_f32_16x16x32_bf16 v[200:203], v[240:243], v[32:35], v[200:203]
    v_mul_f32 v185, v185, v9
    s_bfe_u32 s30, s2, 0x20001
    s_lshl_b32 s30, s30, 2
    s_bfe_u32 s17, s2, 0x20003
    s_add_u32 s30, s30, s17
    s_lshr_b32 s31, s2, 5
    s_and_b32 s17, s3, 3
    s_lshl_b32 s19, s30, 2
    s_add_u32 s19, s19, s17
    s_and_b32 s16, s2, 1
    s_lshl_b32 s17, s19, 18
    s_lshl_b32 s23, s16, 16
    s_add_u32 s17, s17, s23
    s_add_u32 s17, s17, 0x1001000
    v_add_u32 v6, s17, v2
    s_lshl_b32 s19, s19, 7
    s_lshl_b32 s23, s16, 6
    s_add_u32 s19, s19, s23
    s_add_u32 s19, s19, 0x570000
    v_and_b32 v13, 15, v1
    v_lshlrev_b32 v13, 2, v13
    buffer_load_dword v12, v13, s[8:11], s19 offen sc1
    v_mfma_f32_16x16x32_bf16 v[204:207], v[240:243], v[36:39], v[204:207]
    ds_read_b128 v[232:235], v5 offset:6144
    v_mul_f32 v186, v186, v9
    s_waitcnt lgkmcnt(3)
    v_mfma_f32_16x16x32_bf16 v[208:211], v[244:247], v[32:35], v[208:211]
    v_mul_f32 v187, v187, v9
    v_mfma_f32_16x16x32_bf16 v[212:215], v[244:247], v[36:39], v[212:215]
    s_add_u32 s22, s24, 0x102000
    s_add_u32 m0, s20, 0x18400
    s_nop 0
    buffer_load_dwordx4 v3, s[4:7], s22 offen lds
    ds_read_b128 v[236:239], v5 offset:7168
    v_mul_f32 v192, v192, v9
    s_waitcnt lgkmcnt(3)
    v_mfma_f32_16x16x32_bf16 v[200:203], v[224:227], v[40:43], v[200:203]
    v_mul_f32 v193, v193, v9
    v_mfma_f32_16x16x32_bf16 v[204:207], v[224:227], v[44:47], v[204:207]
    ds_read_b128 v[240:243], v5 offset:8192
    v_mul_f32 v194, v194, v9
    s_waitcnt lgkmcnt(3)
    v_mfma_f32_16x16x32_bf16 v[208:211], v[228:231], v[40:43], v[208:211]
    v_mul_f32 v195, v195, v9
    v_mfma_f32_16x16x32_bf16 v[212:215], v[228:231], v[44:47], v[212:215]
    ds_read_b128 v[244:247], v5 offset:9216
    v_cvt_pk_bf16_f32 v216, v184, v185
    s_waitcnt lgkmcnt(3)
    v_mfma_f32_16x16x32_bf16 v[200:203], v[232:235], v[48:51], v[200:203]
    v_cvt_pk_bf16_f32 v217, v186, v187
    v_mfma_f32_16x16x32_bf16 v[204:207], v[232:235], v[52:55], v[204:207]
    ds_read_b128 v[224:227], v5 offset:10240
    v_cvt_pk_bf16_f32 v218, v192, v193
    s_waitcnt lgkmcnt(3)
    v_mfma_f32_16x16x32_bf16 v[208:211], v[236:239], v[48:51], v[208:211]
    v_cvt_pk_bf16_f32 v219, v194, v195
    v_mfma_f32_16x16x32_bf16 v[212:215], v[236:239], v[52:55], v[212:215]
    ds_read_b128 v[228:231], v5 offset:11264
    buffer_store_dwordx4 v[216:219], v2, s[8:11], s25 offen offset:2048 sc1
    s_waitcnt lgkmcnt(3)
    v_mfma_f32_16x16x32_bf16 v[200:203], v[240:243], v[56:59], v[200:203]
    v_mul_f32 v188, v188, v10
    v_mfma_f32_16x16x32_bf16 v[204:207], v[240:243], v[60:63], v[204:207]
    ds_read_b128 v[232:235], v5 offset:12288
    v_mul_f32 v189, v189, v10
    s_waitcnt lgkmcnt(3)
    v_mfma_f32_16x16x32_bf16 v[208:211], v[244:247], v[56:59], v[208:211]
    v_mul_f32 v190, v190, v10
    v_mfma_f32_16x16x32_bf16 v[212:215], v[244:247], v[60:63], v[212:215]
    ds_read_b128 v[236:239], v5 offset:13312
    v_mul_f32 v191, v191, v10
    s_waitcnt lgkmcnt(3)
    v_mfma_f32_16x16x32_bf16 v[200:203], v[224:227], v[64:67], v[200:203]
    v_mul_f32 v196, v196, v10
    s_waitcnt vmcnt(11)
    v_mfma_f32_16x16x32_bf16 v[204:207], v[224:227], v[68:71], v[204:207]
    ds_read_b128 v[240:243], v5 offset:14336
    v_mul_f32 v197, v197, v10
    s_waitcnt lgkmcnt(3)
    v_mfma_f32_16x16x32_bf16 v[208:211], v[228:231], v[64:67], v[208:211]
    v_mul_f32 v198, v198, v10
    v_mfma_f32_16x16x32_bf16 v[212:215], v[228:231], v[68:71], v[212:215]
    ds_read_b128 v[244:247], v5 offset:15360
    v_mul_f32 v199, v199, v10
    s_waitcnt lgkmcnt(3)
    v_mfma_f32_16x16x32_bf16 v[200:203], v[232:235], v[72:75], v[200:203]
    v_cvt_pk_bf16_f32 v220, v188, v189
    v_mfma_f32_16x16x32_bf16 v[204:207], v[232:235], v[76:79], v[204:207]
    s_waitcnt vmcnt(8)
    s_barrier
    ds_read_b128 v[224:227], v5 offset:16384
    v_cvt_pk_bf16_f32 v221, v190, v191
    s_waitcnt lgkmcnt(3)
    v_mfma_f32_16x16x32_bf16 v[208:211], v[236:239], v[72:75], v[208:211]
    v_cvt_pk_bf16_f32 v222, v196, v197
    v_mfma_f32_16x16x32_bf16 v[212:215], v[236:239], v[76:79], v[212:215]
    s_add_u32 s22, s24, 0x180000
    s_add_u32 m0, s20, 0x1c000
    s_nop 0
    buffer_load_dwordx4 v3, s[4:7], s22 offen lds
    ds_read_b128 v[228:231], v5 offset:17408
    v_cvt_pk_bf16_f32 v223, v198, v199
    s_waitcnt lgkmcnt(3)
    v_mfma_f32_16x16x32_bf16 v[200:203], v[240:243], v[80:83], v[200:203]
    buffer_store_dwordx4 v[220:223], v2, s[8:11], s26 offen offset:2048 sc1
    s_add_u32 s16, s63, 0x572000
    v_mov_b32 v14, s28
    v_mov_b32 v15, 0
    s_mov_b64 exec, 1
    buffer_store_dword v14, v15, s[8:11], s16 offen sc1
    s_mov_b64 exec, -1
    v_mfma_f32_16x16x32_bf16 v[204:207], v[240:243], v[84:87], v[204:207]
    ds_read_b128 v[232:235], v5 offset:18432
    s_waitcnt lgkmcnt(3)
    v_mfma_f32_16x16x32_bf16 v[208:211], v[244:247], v[80:83], v[208:211]
    v_mfma_f32_16x16x32_bf16 v[212:215], v[244:247], v[84:87], v[212:215]
    ds_read_b128 v[236:239], v5 offset:19456
    s_waitcnt lgkmcnt(3)
    v_mfma_f32_16x16x32_bf16 v[200:203], v[224:227], v[88:91], v[200:203]
    v_mfma_f32_16x16x32_bf16 v[204:207], v[224:227], v[92:95], v[204:207]
    ds_read_b128 v[240:243], v5 offset:20480
    s_waitcnt vmcnt(5)
    v_cmp_ne_u32 vcc, s28, v12
    s_cbranch_vccnz adaLN_cond__sliding_block_cached__moe_arch_mod__prompt_kernel_o17r
adaLN_cond__sliding_block_cached__moe_arch_mod__prompt_kernel_o17b:
    s_waitcnt lgkmcnt(3)
    v_mfma_f32_16x16x32_bf16 v[208:211], v[228:231], v[88:91], v[208:211]
    s_mov_b32 s23, 0x0
    buffer_load_dwordx4 v[24:27], v6, s[8:11], s23 offen offset:0 sc1
    v_mfma_f32_16x16x32_bf16 v[212:215], v[228:231], v[92:95], v[212:215]
    s_add_u32 s22, s24, 0x182000
    s_add_u32 m0, s20, 0x1c400
    s_nop 0
    buffer_load_dwordx4 v3, s[4:7], s22 offen lds
    ds_read_b128 v[244:247], v5 offset:21504
    s_waitcnt lgkmcnt(3)
    v_mfma_f32_16x16x32_bf16 v[200:203], v[232:235], v[96:99], v[200:203]
    v_mfma_f32_16x16x32_bf16 v[204:207], v[232:235], v[100:103], v[204:207]
    ds_read_b128 v[224:227], v5 offset:22528
    s_mov_b32 s23, 0x20000
    buffer_load_dwordx4 v[28:31], v6, s[8:11], s23 offen offset:0 sc1
    s_waitcnt lgkmcnt(3)
    v_mfma_f32_16x16x32_bf16 v[208:211], v[236:239], v[96:99], v[208:211]
    v_mfma_f32_16x16x32_bf16 v[212:215], v[236:239], v[100:103], v[212:215]
    ds_read_b128 v[228:231], v5 offset:23552
    s_waitcnt lgkmcnt(3)
    v_mfma_f32_16x16x32_bf16 v[200:203], v[240:243], v[104:107], v[200:203]
    v_mfma_f32_16x16x32_bf16 v[204:207], v[240:243], v[108:111], v[204:207]
    ds_read_b128 v[232:235], v5 offset:24576
    s_mov_b32 s23, 0x2000
    buffer_load_dwordx4 v[32:35], v6, s[8:11], s23 offen offset:0 sc1
    s_waitcnt lgkmcnt(3)
    v_mfma_f32_16x16x32_bf16 v[208:211], v[244:247], v[104:107], v[208:211]
    v_mfma_f32_16x16x32_bf16 v[212:215], v[244:247], v[108:111], v[212:215]
    ds_read_b128 v[236:239], v5 offset:25600
    s_waitcnt lgkmcnt(3)
    v_mfma_f32_16x16x32_bf16 v[200:203], v[224:227], v[112:115], v[200:203]
    s_mov_b32 s23, 0x22000
    buffer_load_dwordx4 v[36:39], v6, s[8:11], s23 offen offset:0 sc1
    v_mfma_f32_16x16x32_bf16 v[204:207], v[224:227], v[116:119], v[204:207]
    ds_read_b128 v[240:243], v5 offset:26624
    s_waitcnt lgkmcnt(3)
    v_mfma_f32_16x16x32_bf16 v[208:211], v[228:231], v[112:115], v[208:211]
    v_mfma_f32_16x16x32_bf16 v[212:215], v[228:231], v[116:119], v[212:215]
    ds_read_b128 v[244:247], v5 offset:27648
    s_waitcnt lgkmcnt(3)
    v_mfma_f32_16x16x32_bf16 v[200:203], v[232:235], v[120:123], v[200:203]
    s_mov_b32 s23, 0x4000
    buffer_load_dwordx4 v[40:43], v6, s[8:11], s23 offen offset:0 sc1
    v_mfma_f32_16x16x32_bf16 v[204:207], v[232:235], v[124:127], v[204:207]
    ds_read_b128 v[224:227], v5 offset:28672
    s_waitcnt lgkmcnt(3)
    v_mfma_f32_16x16x32_bf16 v[208:211], v[236:239], v[120:123], v[208:211]
    v_mfma_f32_16x16x32_bf16 v[212:215], v[236:239], v[124:127], v[212:215]
    ds_read_b128 v[228:231], v5 offset:29696
    s_waitcnt lgkmcnt(3)
    v_mfma_f32_16x16x32_bf16 v[200:203], v[240:243], v[128:131], v[200:203]
    s_mov_b32 s23, 0x24000
    buffer_load_dwordx4 v[44:47], v6, s[8:11], s23 offen offset:0 sc1
    v_mfma_f32_16x16x32_bf16 v[204:207], v[240:243], v[132:135], v[204:207]
    ds_read_b128 v[232:235], v5 offset:30720
    s_waitcnt lgkmcnt(3)
    v_mfma_f32_16x16x32_bf16 v[208:211], v[244:247], v[128:131], v[208:211]
    v_mfma_f32_16x16x32_bf16 v[212:215], v[244:247], v[132:135], v[212:215]
    ds_read_b128 v[236:239], v5 offset:31744
    s_mov_b32 s23, 0x6000
    buffer_load_dwordx4 v[48:51], v6, s[8:11], s23 offen offset:0 sc1
    s_waitcnt lgkmcnt(3)
    v_mfma_f32_16x16x32_bf16 v[200:203], v[224:227], v[136:139], v[200:203]
    v_bfe_u32 v18, v1, 2, 2
    v_lshrrev_b32 v19, 4, v1
    v_mfma_f32_16x16x32_bf16 v[204:207], v[224:227], v[140:143], v[204:207]
    v_and_b32 v17, 3, v1
    v_lshlrev_b32 v16, 11, v19
    s_waitcnt lgkmcnt(2)
    v_mfma_f32_16x16x32_bf16 v[208:211], v[228:231], v[136:139], v[208:211]
    v_lshl_add_u32 v16, v18, 6, v16
    v_lshl_add_u32 v16, v17, 3, v16
    v_mfma_f32_16x16x32_bf16 v[212:215], v[228:231], v[140:143], v[212:215]
    s_mov_b32 s23, 0x26000
    buffer_load_dwordx4 v[52:55], v6, s[8:11], s23 offen offset:0 sc1
    v_add_u32 v16, 0x12000, v16
    v_and_b32 v19, 1, v19
    s_waitcnt lgkmcnt(1)
    v_mfma_f32_16x16x32_bf16 v[200:203], v[232:235], v[144:147], v[200:203]
    v_lshlrev_b32 v19, 5, v19
    v_sub_u32 v5, v16, v19
    v_mfma_f32_16x16x32_bf16 v[204:207], v[232:235], v[148:151], v[204:207]
    v_add_u32 v4, v16, v19
    v_add_u32 v7, 0x10000, v4
    s_waitcnt lgkmcnt(0)
    v_mfma_f32_16x16x32_bf16 v[208:211], v[236:239], v[144:147], v[208:211]
    v_add_u32 v8, 0x10000, v5
    v_mfma_f32_16x16x32_bf16 v[212:215], v[236:239], v[148:151], v[212:215]
    v_mul_f32 v200, v200, v9
    v_mul_f32 v201, v201, v9
    v_mul_f32 v202, v202, v9
    v_mul_f32 v203, v203, v9
    s_nop 1
    v_mul_f32 v208, v208, v9
    v_mul_f32 v209, v209, v9
    v_mul_f32 v210, v210, v9
    v_mul_f32 v211, v211, v9
    v_cvt_pk_bf16_f32 v216, v200, v201
    v_cvt_pk_bf16_f32 v217, v202, v203
    v_cvt_pk_bf16_f32 v218, v208, v209
    v_cvt_pk_bf16_f32 v219, v210, v211
    buffer_store_dwordx4 v[216:219], v2, s[8:11], s25 offen offset:3072 sc1
    v_mul_f32 v204, v204, v10
    v_mul_f32 v205, v205, v10
    v_mul_f32 v206, v206, v10
    v_mul_f32 v207, v207, v10
    v_mul_f32 v212, v212, v10
    v_mul_f32 v213, v213, v10
    v_mul_f32 v214, v214, v10
    v_mul_f32 v215, v215, v10
    v_cvt_pk_bf16_f32 v220, v204, v205
    v_cvt_pk_bf16_f32 v221, v206, v207
    v_cvt_pk_bf16_f32 v222, v212, v213
    v_cvt_pk_bf16_f32 v223, v214, v215
    buffer_store_dwordx4 v[220:223], v2, s[8:11], s26 offen offset:3072 sc1
    s_and_b32 s15, s2, 1
    s_barrier
    ds_read_b64_tr_b16 v[224:225], v4 offset:0
    ds_read_b64_tr_b16 v[226:227], v4 offset:1024
    ds_read_b64_tr_b16 v[228:229], v5 offset:32
    ds_read_b64_tr_b16 v[230:231], v5 offset:1056
    ds_read_b64_tr_b16 v[232:233], v4 offset:256
    ds_read_b64_tr_b16 v[234:235], v4 offset:1280
    ds_read_b64_tr_b16 v[236:237], v5 offset:288
    ds_read_b64_tr_b16 v[238:239], v5 offset:1312
    s_waitcnt vmcnt(10) lgkmcnt(6)
    v_mfma_f32_16x16x32_bf16 v[88:91], v[224:227], v[24:27], 0
    ds_read_b64_tr_b16 v[240:241], v4 offset:512
    s_waitcnt vmcnt(8)
    v_mfma_f32_16x16x32_bf16 v[92:95], v[224:227], v[28:31], 0
    ds_read_b64_tr_b16 v[242:243], v4 offset:1536
    s_waitcnt lgkmcnt(6)
    v_mfma_f32_16x16x32_bf16 v[96:99], v[228:231], v[24:27], 0
    ds_read_b64_tr_b16 v[244:245], v5 offset:544
    v_mfma_f32_16x16x32_bf16 v[100:103], v[228:231], v[28:31], 0
    ds_read_b64_tr_b16 v[246:247], v5 offset:1568
    s_waitcnt lgkmcnt(6)
    v_mfma_f32_16x16x32_bf16 v[104:107], v[232:235], v[24:27], 0
    ds_read_b64_tr_b16 v[224:225], v4 offset:768
    v_mfma_f32_16x16x32_bf16 v[108:111], v[232:235], v[28:31], 0
    ds_read_b64_tr_b16 v[226:227], v4 offset:1792
    s_waitcnt lgkmcnt(6)
    v_mfma_f32_16x16x32_bf16 v[112:115], v[236:239], v[24:27], 0
    ds_read_b64_tr_b16 v[228:229], v5 offset:800
    v_mfma_f32_16x16x32_bf16 v[116:119], v[236:239], v[28:31], 0
    ds_read_b64_tr_b16 v[230:231], v5 offset:1824
    s_waitcnt lgkmcnt(6)
    v_mfma_f32_16x16x32_bf16 v[120:123], v[240:243], v[24:27], 0
    s_add_u32 s22, s24, 0x200000
    s_add_u32 m0, s20, 0x20000
    s_nop 0
    buffer_load_dwordx4 v3, s[4:7], s22 offen lds
    v_mfma_f32_16x16x32_bf16 v[124:127], v[240:243], v[28:31], 0
    s_barrier
    ds_read_b64_tr_b16 v[232:233], v4 offset:16384
    ds_read_b64_tr_b16 v[234:235], v4 offset:17408
    s_waitcnt lgkmcnt(6)
    v_mfma_f32_16x16x32_bf16 v[128:131], v[244:247], v[24:27], 0
    ds_read_b64_tr_b16 v[236:237], v5 offset:16416
    s_mov_b32 s23, 0x8000
    buffer_load_dwordx4 v[56:59], v6, s[8:11], s23 offen offset:0 sc1
    v_mfma_f32_16x16x32_bf16 v[132:135], v[244:247], v[28:31], 0
    s_add_u32 s22, s24, 0x202000
    s_add_u32 m0, s20, 0x20400
    s_nop 0
    buffer_load_dwordx4 v3, s[4:7], s22 offen lds
    ds_read_b64_tr_b16 v[238:239], v5 offset:17440
    s_waitcnt lgkmcnt(6)
    v_mfma_f32_16x16x32_bf16 v[136:139], v[224:227], v[24:27], 0
    ds_read_b64_tr_b16 v[240:241], v4 offset:16640
    v_mfma_f32_16x16x32_bf16 v[140:143], v[224:227], v[28:31], 0
    ds_read_b64_tr_b16 v[242:243], v4 offset:17664
    s_mov_b32 s23, 0x28000
    buffer_load_dwordx4 v[60:63], v6, s[8:11], s23 offen offset:0 sc1
    s_waitcnt lgkmcnt(6)
    v_mfma_f32_16x16x32_bf16 v[144:147], v[228:231], v[24:27], 0
    ds_read_b64_tr_b16 v[244:245], v5 offset:16672
    v_mfma_f32_16x16x32_bf16 v[148:151], v[228:231], v[28:31], 0
    ds_read_b64_tr_b16 v[246:247], v5 offset:17696
    s_waitcnt vmcnt(11) lgkmcnt(6)
    v_mfma_f32_16x16x32_bf16 v[88:91], v[232:235], v[32:35], v[88:91]
    ds_read_b64_tr_b16 v[224:225], v4 offset:16896
    s_waitcnt vmcnt(10)
    v_mfma_f32_16x16x32_bf16 v[92:95], v[232:235], v[36:39], v[92:95]
    s_add_u32 s22, s24, 0x280000
    s_add_u32 m0, s20, 0x24000
    s_nop 0
    buffer_load_dwordx4 v3, s[4:7], s22 offen lds
    ds_read_b64_tr_b16 v[226:227], v4 offset:17920
    s_waitcnt lgkmcnt(6)
    v_mfma_f32_16x16x32_bf16 v[96:99], v[236:239], v[32:35], v[96:99]
    ds_read_b64_tr_b16 v[228:229], v5 offset:16928
    v_mfma_f32_16x16x32_bf16 v[100:103], v[236:239], v[36:39], v[100:103]
    ds_read_b64_tr_b16 v[230:231], v5 offset:17952
    s_waitcnt lgkmcnt(6)
    v_mfma_f32_16x16x32_bf16 v[104:107], v[240:243], v[32:35], v[104:107]
    s_add_u32 s22, s24, 0x282000
    s_add_u32 m0, s20, 0x24400
    s_nop 0
    buffer_load_dwordx4 v3, s[4:7], s22 offen lds
    ds_read_b64_tr_b16 v[232:233], v4 offset:17152
    v_mfma_f32_16x16x32_bf16 v[108:111], v[240:243], v[36:39], v[108:111]
    ds_read_b64_tr_b16 v[234:235], v4 offset:18176
    s_waitcnt lgkmcnt(6)
    v_mfma_f32_16x16x32_bf16 v[112:115], v[244:247], v[32:35], v[112:115]
    ds_read_b64_tr_b16 v[236:237], v5 offset:17184
    v_mfma_f32_16x16x32_bf16 v[116:119], v[244:247], v[36:39], v[116:119]
    ds_read_b64_tr_b16 v[238:239], v5 offset:18208
    s_waitcnt lgkmcnt(6)
    v_mfma_f32_16x16x32_bf16 v[120:123], v[224:227], v[32:35], v[120:123]
    v_mfma_f32_16x16x32_bf16 v[124:127], v[224:227], v[36:39], v[124:127]
    s_barrier
    ds_read_b64_tr_b16 v[240:241], v4 offset:32768
    ds_read_b64_tr_b16 v[242:243], v4 offset:33792
    s_waitcnt lgkmcnt(6)
    v_mfma_f32_16x16x32_bf16 v[128:131], v[228:231], v[32:35], v[128:131]
    ds_read_b64_tr_b16 v[244:245], v5 offset:32800
    s_mov_b32 s23, 0xa000
    buffer_load_dwordx4 v[24:27], v6, s[8:11], s23 offen offset:0 sc1
    v_mfma_f32_16x16x32_bf16 v[132:135], v[228:231], v[36:39], v[132:135]
    ds_read_b64_tr_b16 v[246:247], v5 offset:33824
    s_waitcnt lgkmcnt(6)
    v_mfma_f32_16x16x32_bf16 v[136:139], v[232:235], v[32:35], v[136:139]
    ds_read_b64_tr_b16 v[224:225], v4 offset:33024
    v_mfma_f32_16x16x32_bf16 v[140:143], v[232:235], v[36:39], v[140:143]
    ds_read_b64_tr_b16 v[226:227], v4 offset:34048
    s_mov_b32 s23, 0x2a000
    buffer_load_dwordx4 v[28:31], v6, s[8:11], s23 offen offset:0 sc1
    s_waitcnt lgkmcnt(6)
    v_mfma_f32_16x16x32_bf16 v[144:147], v[236:239], v[32:35], v[144:147]
    s_add_u32 s16, s63, 0x574000
    v_mov_b32 v14, s28
    v_mov_b32 v15, 0
    s_mov_b64 exec, 1
    buffer_store_dword v14, v15, s[8:11], s16 offen sc1
    s_mov_b64 exec, -1
    ds_read_b64_tr_b16 v[228:229], v5 offset:33056
    v_mfma_f32_16x16x32_bf16 v[148:151], v[236:239], v[36:39], v[148:151]
    ds_read_b64_tr_b16 v[230:231], v5 offset:34080
    s_waitcnt vmcnt(14) lgkmcnt(6)
    v_mfma_f32_16x16x32_bf16 v[88:91], v[240:243], v[40:43], v[88:91]
    ds_read_b64_tr_b16 v[232:233], v4 offset:33280
    s_waitcnt vmcnt(13)
    v_mfma_f32_16x16x32_bf16 v[92:95], v[240:243], v[44:47], v[92:95]
    s_add_u32 s22, s24, 0x300000
    s_add_u32 m0, s20, 0x10000
    s_nop 0
    buffer_load_dwordx4 v3, s[4:7], s22 offen lds
    ds_read_b64_tr_b16 v[234:235], v4 offset:34304
    s_waitcnt lgkmcnt(6)
    v_mfma_f32_16x16x32_bf16 v[96:99], v[244:247], v[40:43], v[96:99]
    ds_read_b64_tr_b16 v[236:237], v5 offset:33312
    v_mfma_f32_16x16x32_bf16 v[100:103], v[244:247], v[44:47], v[100:103]
    ds_read_b64_tr_b16 v[238:239], v5 offset:34336
    s_waitcnt lgkmcnt(6)
    v_mfma_f32_16x16x32_bf16 v[104:107], v[224:227], v[40:43], v[104:107]
    s_add_u32 s22, s24, 0x302000
    s_add_u32 m0, s20, 0x10400
    s_nop 0
    buffer_load_dwordx4 v3, s[4:7], s22 offen lds
    ds_read_b64_tr_b16 v[240:241], v4 offset:33536
    v_mfma_f32_16x16x32_bf16 v[108:111], v[224:227], v[44:47], v[108:111]
    ds_read_b64_tr_b16 v[242:243], v4 offset:34560
    s_waitcnt lgkmcnt(6)
    v_mfma_f32_16x16x32_bf16 v[112:115], v[228:231], v[40:43], v[112:115]
    ds_read_b64_tr_b16 v[244:245], v5 offset:33568
    v_mfma_f32_16x16x32_bf16 v[116:119], v[228:231], v[44:47], v[116:119]
    ds_read_b64_tr_b16 v[246:247], v5 offset:34592
    s_waitcnt lgkmcnt(6)
    v_mfma_f32_16x16x32_bf16 v[120:123], v[232:235], v[40:43], v[120:123]
    v_mfma_f32_16x16x32_bf16 v[124:127], v[232:235], v[44:47], v[124:127]
    s_barrier
    ds_read_b64_tr_b16 v[224:225], v4 offset:49152
    ds_read_b64_tr_b16 v[226:227], v4 offset:50176
    s_add_u32 s19, s19, 8192
    buffer_load_dword v12, v13, s[8:11], s19 offen sc1
    s_waitcnt lgkmcnt(6)
    v_mfma_f32_16x16x32_bf16 v[128:131], v[236:239], v[40:43], v[128:131]
    ds_read_b64_tr_b16 v[228:229], v5 offset:49184
    s_mov_b32 s23, 0xc000
    buffer_load_dwordx4 v[32:35], v6, s[8:11], s23 offen offset:0 sc1
    v_mfma_f32_16x16x32_bf16 v[132:135], v[236:239], v[44:47], v[132:135]
    ds_read_b64_tr_b16 v[230:231], v5 offset:50208
    s_waitcnt lgkmcnt(6)
    v_mfma_f32_16x16x32_bf16 v[136:139], v[240:243], v[40:43], v[136:139]
    ds_read_b64_tr_b16 v[232:233], v4 offset:49408
    v_mfma_f32_16x16x32_bf16 v[140:143], v[240:243], v[44:47], v[140:143]
    ds_read_b64_tr_b16 v[234:235], v4 offset:50432
    s_mov_b32 s23, 0x2c000
    buffer_load_dwordx4 v[36:39], v6, s[8:11], s23 offen offset:0 sc1
    s_waitcnt lgkmcnt(6)
    v_mfma_f32_16x16x32_bf16 v[144:147], v[244:247], v[40:43], v[144:147]
    ds_read_b64_tr_b16 v[236:237], v5 offset:49440
    v_mfma_f32_16x16x32_bf16 v[148:151], v[244:247], v[44:47], v[148:151]
    ds_read_b64_tr_b16 v[238:239], v5 offset:50464
    s_waitcnt vmcnt(17) lgkmcnt(6)
    v_mfma_f32_16x16x32_bf16 v[88:91], v[224:227], v[48:51], v[88:91]
    ds_read_b64_tr_b16 v[240:241], v4 offset:49664
    s_waitcnt vmcnt(16)
    v_mfma_f32_16x16x32_bf16 v[92:95], v[224:227], v[52:55], v[92:95]
    s_add_u32 s22, s24, 0x380000
    s_add_u32 m0, s20, 0x14000
    s_nop 0
    buffer_load_dwordx4 v3, s[4:7], s22 offen lds
    ds_read_b64_tr_b16 v[242:243], v4 offset:50688
    s_waitcnt lgkmcnt(6)
    v_mfma_f32_16x16x32_bf16 v[96:99], v[228:231], v[48:51], v[96:99]
    ds_read_b64_tr_b16 v[244:245], v5 offset:49696
    v_mfma_f32_16x16x32_bf16 v[100:103], v[228:231], v[52:55], v[100:103]
    ds_read_b64_tr_b16 v[246:247], v5 offset:50720
    s_waitcnt lgkmcnt(6)
    v_mfma_f32_16x16x32_bf16 v[104:107], v[232:235], v[48:51], v[104:107]
    s_add_u32 s22, s24, 0x382000
    s_add_u32 m0, s20, 0x14400
    s_nop 0
    buffer_load_dwordx4 v3, s[4:7], s22 offen lds
    ds_read_b64_tr_b16 v[224:225], v4 offset:49920
    v_mfma_f32_16x16x32_bf16 v[108:111], v[232:235], v[52:55], v[108:111]
    ds_read_b64_tr_b16 v[226:227], v4 offset:50944
    s_waitcnt lgkmcnt(6)
    v_mfma_f32_16x16x32_bf16 v[112:115], v[236:239], v[48:51], v[112:115]
    ds_read_b64_tr_b16 v[228:229], v5 offset:49952
    v_mfma_f32_16x16x32_bf16 v[116:119], v[236:239], v[52:55], v[116:119]
    ds_read_b64_tr_b16 v[230:231], v5 offset:50976
    s_waitcnt lgkmcnt(6)
    v_mfma_f32_16x16x32_bf16 v[120:123], v[240:243], v[48:51], v[120:123]
    v_mfma_f32_16x16x32_bf16 v[124:127], v[240:243], v[52:55], v[124:127]
    s_waitcnt vmcnt(13)
    s_barrier
    ds_read_b64_tr_b16 v[232:233], v7 offset:0
    ds_read_b64_tr_b16 v[234:235], v7 offset:1024
    s_waitcnt lgkmcnt(6)
    v_mfma_f32_16x16x32_bf16 v[128:131], v[244:247], v[48:51], v[128:131]
    ds_read_b64_tr_b16 v[236:237], v8 offset:32
    s_mov_b32 s23, 0xe000
    buffer_load_dwordx4 v[40:43], v6, s[8:11], s23 offen offset:0 sc1
    v_mfma_f32_16x16x32_bf16 v[132:135], v[244:247], v[52:55], v[132:135]
    ds_read_b64_tr_b16 v[238:239], v8 offset:1056
    s_waitcnt lgkmcnt(6)
    v_mfma_f32_16x16x32_bf16 v[136:139], v[224:227], v[48:51], v[136:139]
    ds_read_b64_tr_b16 v[240:241], v7 offset:256
    v_mfma_f32_16x16x32_bf16 v[140:143], v[224:227], v[52:55], v[140:143]
    ds_read_b64_tr_b16 v[242:243], v7 offset:1280
    s_mov_b32 s23, 0x2e000
    buffer_load_dwordx4 v[44:47], v6, s[8:11], s23 offen offset:0 sc1
    s_waitcnt lgkmcnt(6)
    v_mfma_f32_16x16x32_bf16 v[144:147], v[228:231], v[48:51], v[144:147]
    ds_read_b64_tr_b16 v[244:245], v8 offset:288
    v_mfma_f32_16x16x32_bf16 v[148:151], v[228:231], v[52:55], v[148:151]
    ds_read_b64_tr_b16 v[246:247], v8 offset:1312
    s_waitcnt vmcnt(6)
    v_cmp_ne_u32 vcc, s28, v12
    s_cbranch_vccnz adaLN_cond__sliding_block_cached__moe_arch_mod__prompt_kernel_o218r
adaLN_cond__sliding_block_cached__moe_arch_mod__prompt_kernel_o218b:
    s_waitcnt lgkmcnt(6)
    v_mfma_f32_16x16x32_bf16 v[88:91], v[232:235], v[56:59], v[88:91]
    ds_read_b64_tr_b16 v[224:225], v7 offset:512
    v_mfma_f32_16x16x32_bf16 v[92:95], v[232:235], v[60:63], v[92:95]
    s_add_u32 s22, s24, 0x10000
    s_add_u32 m0, s20, 0x18000
    s_nop 0
    buffer_load_dwordx4 v3, s[4:7], s22 offen lds
    ds_read_b64_tr_b16 v[226:227], v7 offset:1536
    s_waitcnt lgkmcnt(6)
    v_mfma_f32_16x16x32_bf16 v[96:99], v[236:239], v[56:59], v[96:99]
    ds_read_b64_tr_b16 v[228:229], v8 offset:544
    v_mfma_f32_16x16x32_bf16 v[100:103], v[236:239], v[60:63], v[100:103]
    ds_read_b64_tr_b16 v[230:231], v8 offset:1568
    s_waitcnt lgkmcnt(6)
    v_mfma_f32_16x16x32_bf16 v[104:107], v[240:243], v[56:59], v[104:107]
    s_add_u32 s22, s24, 0x12000
    s_add_u32 m0, s20, 0x18400
    s_nop 0
    buffer_load_dwordx4 v3, s[4:7], s22 offen lds
    ds_read_b64_tr_b16 v[232:233], v7 offset:768
    v_mfma_f32_16x16x32_bf16 v[108:111], v[240:243], v[60:63], v[108:111]
    ds_read_b64_tr_b16 v[234:235], v7 offset:1792
    s_waitcnt lgkmcnt(6)
    v_mfma_f32_16x16x32_bf16 v[112:115], v[244:247], v[56:59], v[112:115]
    ds_read_b64_tr_b16 v[236:237], v8 offset:800
    v_mfma_f32_16x16x32_bf16 v[116:119], v[244:247], v[60:63], v[116:119]
    ds_read_b64_tr_b16 v[238:239], v8 offset:1824
    s_waitcnt lgkmcnt(6)
    v_mfma_f32_16x16x32_bf16 v[120:123], v[224:227], v[56:59], v[120:123]
    v_mfma_f32_16x16x32_bf16 v[124:127], v[224:227], v[60:63], v[124:127]
    s_barrier
    ds_read_b64_tr_b16 v[240:241], v7 offset:16384
    ds_read_b64_tr_b16 v[242:243], v7 offset:17408
    s_waitcnt lgkmcnt(6)
    v_mfma_f32_16x16x32_bf16 v[128:131], v[228:231], v[56:59], v[128:131]
    ds_read_b64_tr_b16 v[244:245], v8 offset:16416
    s_mov_b32 s23, 0x0
    buffer_load_dwordx4 v[48:51], v6, s[8:11], s23 offen offset:1024 sc1
    v_mfma_f32_16x16x32_bf16 v[132:135], v[228:231], v[60:63], v[132:135]
    ds_read_b64_tr_b16 v[246:247], v8 offset:17440
    s_waitcnt lgkmcnt(6)
    v_mfma_f32_16x16x32_bf16 v[136:139], v[232:235], v[56:59], v[136:139]
    ds_read_b64_tr_b16 v[224:225], v7 offset:16640
    v_mfma_f32_16x16x32_bf16 v[140:143], v[232:235], v[60:63], v[140:143]
    ds_read_b64_tr_b16 v[226:227], v7 offset:17664
    s_mov_b32 s23, 0x20000
    buffer_load_dwordx4 v[52:55], v6, s[8:11], s23 offen offset:1024 sc1
    s_waitcnt lgkmcnt(6)
    v_mfma_f32_16x16x32_bf16 v[144:147], v[236:239], v[56:59], v[144:147]
    ds_read_b64_tr_b16 v[228:229], v8 offset:16672
    v_mfma_f32_16x16x32_bf16 v[148:151], v[236:239], v[60:63], v[148:151]
    ds_read_b64_tr_b16 v[230:231], v8 offset:17696
    s_waitcnt lgkmcnt(6)
    v_mfma_f32_16x16x32_bf16 v[88:91], v[240:243], v[24:27], v[88:91]
    ds_read_b64_tr_b16 v[232:233], v7 offset:16896
    v_mfma_f32_16x16x32_bf16 v[92:95], v[240:243], v[28:31], v[92:95]
    s_add_u32 s22, s24, 0x90000
    s_add_u32 m0, s20, 0x1c000
    s_nop 0
    buffer_load_dwordx4 v3, s[4:7], s22 offen lds
    ds_read_b64_tr_b16 v[234:235], v7 offset:17920
    s_waitcnt lgkmcnt(6)
    v_mfma_f32_16x16x32_bf16 v[96:99], v[244:247], v[24:27], v[96:99]
    ds_read_b64_tr_b16 v[236:237], v8 offset:16928
    v_mfma_f32_16x16x32_bf16 v[100:103], v[244:247], v[28:31], v[100:103]
    ds_read_b64_tr_b16 v[238:239], v8 offset:17952
    s_waitcnt lgkmcnt(6)
    v_mfma_f32_16x16x32_bf16 v[104:107], v[224:227], v[24:27], v[104:107]
    s_add_u32 s22, s24, 0x92000
    s_add_u32 m0, s20, 0x1c400
    s_nop 0
    buffer_load_dwordx4 v3, s[4:7], s22 offen lds
    ds_read_b64_tr_b16 v[240:241], v7 offset:17152
    v_mfma_f32_16x16x32_bf16 v[108:111], v[224:227], v[28:31], v[108:111]
    ds_read_b64_tr_b16 v[242:243], v7 offset:18176
    s_waitcnt lgkmcnt(6)
    v_mfma_f32_16x16x32_bf16 v[112:115], v[228:231], v[24:27], v[112:115]
    ds_read_b64_tr_b16 v[244:245], v8 offset:17184
    v_mfma_f32_16x16x32_bf16 v[116:119], v[228:231], v[28:31], v[116:119]
    ds_read_b64_tr_b16 v[246:247], v8 offset:18208
    s_waitcnt lgkmcnt(6)
    v_mfma_f32_16x16x32_bf16 v[120:123], v[232:235], v[24:27], v[120:123]
    v_mfma_f32_16x16x32_bf16 v[124:127], v[232:235], v[28:31], v[124:127]
    s_barrier
    ds_read_b64_tr_b16 v[224:225], v4 offset:0
    ds_read_b64_tr_b16 v[226:227], v4 offset:1024
    s_waitcnt lgkmcnt(6)
    v_mfma_f32_16x16x32_bf16 v[128:131], v[236:239], v[24:27], v[128:131]
    s_add_u32 s16, s63, 0x576000
    v_mov_b32 v14, s28
    v_mov_b32 v15, 0
    s_mov_b64 exec, 1
    buffer_store_dword v14, v15, s[8:11], s16 offen sc1
    s_mov_b64 exec, -1
    ds_read_b64_tr_b16 v[228:229], v5 offset:32
    s_mov_b32 s23, 0x2000
    buffer_load_dwordx4 v[56:59], v6, s[8:11], s23 offen offset:1024 sc1
    v_mfma_f32_16x16x32_bf16 v[132:135], v[236:239], v[28:31], v[132:135]
    ds_read_b64_tr_b16 v[230:231], v5 offset:1056
    s_waitcnt lgkmcnt(6)
    v_mfma_f32_16x16x32_bf16 v[136:139], v[240:243], v[24:27], v[136:139]
    ds_read_b64_tr_b16 v[232:233], v4 offset:256
    v_mfma_f32_16x16x32_bf16 v[140:143], v[240:243], v[28:31], v[140:143]
    ds_read_b64_tr_b16 v[234:235], v4 offset:1280
    s_mov_b32 s23, 0x22000
    buffer_load_dwordx4 v[60:63], v6, s[8:11], s23 offen offset:1024 sc1
    s_waitcnt lgkmcnt(6)
    v_mfma_f32_16x16x32_bf16 v[144:147], v[244:247], v[24:27], v[144:147]
    ds_read_b64_tr_b16 v[236:237], v5 offset:288
    v_mfma_f32_16x16x32_bf16 v[148:151], v[244:247], v[28:31], v[148:151]
    ds_read_b64_tr_b16 v[238:239], v5 offset:1312
    s_waitcnt vmcnt(14) lgkmcnt(6)
    v_mfma_f32_16x16x32_bf16 v[88:91], v[224:227], v[32:35], v[88:91]
    ds_read_b64_tr_b16 v[240:241], v4 offset:512
    s_waitcnt vmcnt(13)
    v_mfma_f32_16x16x32_bf16 v[92:95], v[224:227], v[36:39], v[92:95]
    s_add_u32 s22, s24, 0x110000
    s_add_u32 m0, s20, 0x20000
    s_nop 0
    buffer_load_dwordx4 v3, s[4:7], s22 offen lds
    ds_read_b64_tr_b16 v[242:243], v4 offset:1536
    s_waitcnt lgkmcnt(6)
    v_mfma_f32_16x16x32_bf16 v[96:99], v[228:231], v[32:35], v[96:99]
    ds_read_b64_tr_b16 v[244:245], v5 offset:544
    v_mfma_f32_16x16x32_bf16 v[100:103], v[228:231], v[36:39], v[100:103]
    ds_read_b64_tr_b16 v[246:247], v5 offset:1568
    s_waitcnt lgkmcnt(6)
    v_mfma_f32_16x16x32_bf16 v[104:107], v[232:235], v[32:35], v[104:107]
    s_add_u32 s22, s24, 0x112000
    s_add_u32 m0, s20, 0x20400
    s_nop 0
    buffer_load_dwordx4 v3, s[4:7], s22 offen lds
    ds_read_b64_tr_b16 v[224:225], v4 offset:768
    v_mfma_f32_16x16x32_bf16 v[108:111], v[232:235], v[36:39], v[108:111]
    ds_read_b64_tr_b16 v[226:227], v4 offset:1792
    s_waitcnt lgkmcnt(6)
    v_mfma_f32_16x16x32_bf16 v[112:115], v[236:239], v[32:35], v[112:115]
    ds_read_b64_tr_b16 v[228:229], v5 offset:800
    v_mfma_f32_16x16x32_bf16 v[116:119], v[236:239], v[36:39], v[116:119]
    ds_read_b64_tr_b16 v[230:231], v5 offset:1824
    s_waitcnt lgkmcnt(6)
    v_mfma_f32_16x16x32_bf16 v[120:123], v[240:243], v[32:35], v[120:123]
    v_mfma_f32_16x16x32_bf16 v[124:127], v[240:243], v[36:39], v[124:127]
    s_waitcnt vmcnt(13)
    s_barrier
    ds_read_b64_tr_b16 v[232:233], v4 offset:16384
    ds_read_b64_tr_b16 v[234:235], v4 offset:17408
    s_waitcnt lgkmcnt(6)
    v_mfma_f32_16x16x32_bf16 v[128:131], v[244:247], v[32:35], v[128:131]
    ds_read_b64_tr_b16 v[236:237], v5 offset:16416
    s_mov_b32 s23, 0x4000
    buffer_load_dwordx4 v[24:27], v6, s[8:11], s23 offen offset:1024 sc1
    v_mfma_f32_16x16x32_bf16 v[132:135], v[244:247], v[36:39], v[132:135]
    ds_read_b64_tr_b16 v[238:239], v5 offset:17440
    s_waitcnt lgkmcnt(6)
    v_mfma_f32_16x16x32_bf16 v[136:139], v[224:227], v[32:35], v[136:139]
    ds_read_b64_tr_b16 v[240:241], v4 offset:16640
    v_mfma_f32_16x16x32_bf16 v[140:143], v[224:227], v[36:39], v[140:143]
    ds_read_b64_tr_b16 v[242:243], v4 offset:17664
    s_mov_b32 s23, 0x24000
    buffer_load_dwordx4 v[28:31], v6, s[8:11], s23 offen offset:1024 sc1
    s_waitcnt lgkmcnt(6)
    v_mfma_f32_16x16x32_bf16 v[144:147], v[228:231], v[32:35], v[144:147]
    ds_read_b64_tr_b16 v[244:245], v5 offset:16672
    v_mfma_f32_16x16x32_bf16 v[148:151], v[228:231], v[36:39], v[148:151]
    ds_read_b64_tr_b16 v[246:247], v5 offset:17696
    s_waitcnt vmcnt(14) lgkmcnt(6)
    v_mfma_f32_16x16x32_bf16 v[88:91], v[232:235], v[40:43], v[88:91]
    ds_read_b64_tr_b16 v[224:225], v4 offset:16896
    s_waitcnt vmcnt(13)
    v_mfma_f32_16x16x32_bf16 v[92:95], v[232:235], v[44:47], v[92:95]
    s_add_u32 s22, s24, 0x190000
    s_add_u32 m0, s20, 0x24000
    s_nop 0
    buffer_load_dwordx4 v3, s[4:7], s22 offen lds
    ds_read_b64_tr_b16 v[226:227], v4 offset:17920
    s_waitcnt lgkmcnt(6)
    v_mfma_f32_16x16x32_bf16 v[96:99], v[236:239], v[40:43], v[96:99]
    ds_read_b64_tr_b16 v[228:229], v5 offset:16928
    v_mfma_f32_16x16x32_bf16 v[100:103], v[236:239], v[44:47], v[100:103]
    ds_read_b64_tr_b16 v[230:231], v5 offset:17952
    s_waitcnt lgkmcnt(6)
    v_mfma_f32_16x16x32_bf16 v[104:107], v[240:243], v[40:43], v[104:107]
    s_add_u32 s22, s24, 0x192000
    s_add_u32 m0, s20, 0x24400
    s_nop 0
    buffer_load_dwordx4 v3, s[4:7], s22 offen lds
    ds_read_b64_tr_b16 v[232:233], v4 offset:17152
    v_mfma_f32_16x16x32_bf16 v[108:111], v[240:243], v[44:47], v[108:111]
    ds_read_b64_tr_b16 v[234:235], v4 offset:18176
    s_waitcnt lgkmcnt(6)
    v_mfma_f32_16x16x32_bf16 v[112:115], v[244:247], v[40:43], v[112:115]
    ds_read_b64_tr_b16 v[236:237], v5 offset:17184
    v_mfma_f32_16x16x32_bf16 v[116:119], v[244:247], v[44:47], v[116:119]
    ds_read_b64_tr_b16 v[238:239], v5 offset:18208
    s_waitcnt lgkmcnt(6)
    v_mfma_f32_16x16x32_bf16 v[120:123], v[224:227], v[40:43], v[120:123]
    v_mfma_f32_16x16x32_bf16 v[124:127], v[224:227], v[44:47], v[124:127]
    s_waitcnt vmcnt(13)
    s_barrier
    ds_read_b64_tr_b16 v[240:241], v4 offset:32768
    ds_read_b64_tr_b16 v[242:243], v4 offset:33792
    s_waitcnt lgkmcnt(6)
    v_mfma_f32_16x16x32_bf16 v[128:131], v[228:231], v[40:43], v[128:131]
    ds_read_b64_tr_b16 v[244:245], v5 offset:32800
    s_mov_b32 s23, 0x6000
    buffer_load_dwordx4 v[32:35], v6, s[8:11], s23 offen offset:1024 sc1
    v_mfma_f32_16x16x32_bf16 v[132:135], v[228:231], v[44:47], v[132:135]
    ds_read_b64_tr_b16 v[246:247], v5 offset:33824
    s_waitcnt lgkmcnt(6)
    v_mfma_f32_16x16x32_bf16 v[136:139], v[232:235], v[40:43], v[136:139]
    ds_read_b64_tr_b16 v[224:225], v4 offset:33024
    v_mfma_f32_16x16x32_bf16 v[140:143], v[232:235], v[44:47], v[140:143]
    ds_read_b64_tr_b16 v[226:227], v4 offset:34048
    s_mov_b32 s23, 0x26000
    buffer_load_dwordx4 v[36:39], v6, s[8:11], s23 offen offset:1024 sc1
    s_waitcnt lgkmcnt(6)
    v_mfma_f32_16x16x32_bf16 v[144:147], v[236:239], v[40:43], v[144:147]
    ds_read_b64_tr_b16 v[228:229], v5 offset:33056
    v_mfma_f32_16x16x32_bf16 v[148:151], v[236:239], v[44:47], v[148:151]
    ds_read_b64_tr_b16 v[230:231], v5 offset:34080
    s_waitcnt vmcnt(14) lgkmcnt(6)
    v_mfma_f32_16x16x32_bf16 v[88:91], v[240:243], v[48:51], v[88:91]
    ds_read_b64_tr_b16 v[232:233], v4 offset:33280
    s_waitcnt vmcnt(13)
    v_mfma_f32_16x16x32_bf16 v[92:95], v[240:243], v[52:55], v[92:95]
    s_add_u32 s22, s24, 0x210000
    s_add_u32 m0, s20, 0x10000
    s_nop 0
    buffer_load_dwordx4 v3, s[4:7], s22 offen lds
    ds_read_b64_tr_b16 v[234:235], v4 offset:34304
    s_waitcnt lgkmcnt(6)
    v_mfma_f32_16x16x32_bf16 v[96:99], v[244:247], v[48:51], v[96:99]
    ds_read_b64_tr_b16 v[236:237], v5 offset:33312
    v_mfma_f32_16x16x32_bf16 v[100:103], v[244:247], v[52:55], v[100:103]
    ds_read_b64_tr_b16 v[238:239], v5 offset:34336
    s_waitcnt lgkmcnt(6)
    v_mfma_f32_16x16x32_bf16 v[104:107], v[224:227], v[48:51], v[104:107]
    s_add_u32 s22, s24, 0x212000
    s_add_u32 m0, s20, 0x10400
    s_nop 0
    buffer_load_dwordx4 v3, s[4:7], s22 offen lds
    ds_read_b64_tr_b16 v[240:241], v4 offset:33536
    v_mfma_f32_16x16x32_bf16 v[108:111], v[224:227], v[52:55], v[108:111]
    ds_read_b64_tr_b16 v[242:243], v4 offset:34560
    s_waitcnt lgkmcnt(6)
    v_mfma_f32_16x16x32_bf16 v[112:115], v[228:231], v[48:51], v[112:115]
    ds_read_b64_tr_b16 v[244:245], v5 offset:33568
    v_mfma_f32_16x16x32_bf16 v[116:119], v[228:231], v[52:55], v[116:119]
    ds_read_b64_tr_b16 v[246:247], v5 offset:34592
    s_waitcnt lgkmcnt(6)
    v_mfma_f32_16x16x32_bf16 v[120:123], v[232:235], v[48:51], v[120:123]
    v_mfma_f32_16x16x32_bf16 v[124:127], v[232:235], v[52:55], v[124:127]
    s_waitcnt vmcnt(13)
    s_barrier
    ds_read_b64_tr_b16 v[224:225], v4 offset:49152
    ds_read_b64_tr_b16 v[226:227], v4 offset:50176
    s_waitcnt lgkmcnt(6)
    v_mfma_f32_16x16x32_bf16 v[128:131], v[236:239], v[48:51], v[128:131]
    ds_read_b64_tr_b16 v[228:229], v5 offset:49184
    s_mov_b32 s23, 0x8000
    buffer_load_dwordx4 v[40:43], v6, s[8:11], s23 offen offset:1024 sc1
    v_mfma_f32_16x16x32_bf16 v[132:135], v[236:239], v[52:55], v[132:135]
    ds_read_b64_tr_b16 v[230:231], v5 offset:50208
    s_waitcnt lgkmcnt(6)
    v_mfma_f32_16x16x32_bf16 v[136:139], v[240:243], v[48:51], v[136:139]
    ds_read_b64_tr_b16 v[232:233], v4 offset:49408
    v_mfma_f32_16x16x32_bf16 v[140:143], v[240:243], v[52:55], v[140:143]
    ds_read_b64_tr_b16 v[234:235], v4 offset:50432
    s_mov_b32 s23, 0x28000
    buffer_load_dwordx4 v[44:47], v6, s[8:11], s23 offen offset:1024 sc1
    s_waitcnt lgkmcnt(6)
    v_mfma_f32_16x16x32_bf16 v[144:147], v[244:247], v[48:51], v[144:147]
    ds_read_b64_tr_b16 v[236:237], v5 offset:49440
    v_mfma_f32_16x16x32_bf16 v[148:151], v[244:247], v[52:55], v[148:151]
    ds_read_b64_tr_b16 v[238:239], v5 offset:50464
    s_waitcnt vmcnt(13) lgkmcnt(6)
    v_mfma_f32_16x16x32_bf16 v[88:91], v[224:227], v[56:59], v[88:91]
    ds_read_b64_tr_b16 v[240:241], v4 offset:49664
    s_waitcnt vmcnt(12)
    v_mfma_f32_16x16x32_bf16 v[92:95], v[224:227], v[60:63], v[92:95]
    s_add_u32 s22, s24, 0x290000
    s_add_u32 m0, s20, 0x14000
    s_nop 0
    buffer_load_dwordx4 v3, s[4:7], s22 offen lds
    ds_read_b64_tr_b16 v[242:243], v4 offset:50688
    s_waitcnt lgkmcnt(6)
    v_mfma_f32_16x16x32_bf16 v[96:99], v[228:231], v[56:59], v[96:99]
    ds_read_b64_tr_b16 v[244:245], v5 offset:49696
    v_mfma_f32_16x16x32_bf16 v[100:103], v[228:231], v[60:63], v[100:103]
    ds_read_b64_tr_b16 v[246:247], v5 offset:50720
    s_waitcnt lgkmcnt(6)
    v_mfma_f32_16x16x32_bf16 v[104:107], v[232:235], v[56:59], v[104:107]
    s_add_u32 s22, s24, 0x292000
    s_add_u32 m0, s20, 0x14400
    s_nop 0
    buffer_load_dwordx4 v3, s[4:7], s22 offen lds
    ds_read_b64_tr_b16 v[224:225], v4 offset:49920
    v_mfma_f32_16x16x32_bf16 v[108:111], v[232:235], v[60:63], v[108:111]
    ds_read_b64_tr_b16 v[226:227], v4 offset:50944
    s_waitcnt lgkmcnt(6)
    v_mfma_f32_16x16x32_bf16 v[112:115], v[236:239], v[56:59], v[112:115]
    ds_read_b64_tr_b16 v[228:229], v5 offset:49952
    v_mfma_f32_16x16x32_bf16 v[116:119], v[236:239], v[60:63], v[116:119]
    ds_read_b64_tr_b16 v[230:231], v5 offset:50976
    s_waitcnt lgkmcnt(6)
    v_mfma_f32_16x16x32_bf16 v[120:123], v[240:243], v[56:59], v[120:123]
    v_mfma_f32_16x16x32_bf16 v[124:127], v[240:243], v[60:63], v[124:127]
    s_waitcnt vmcnt(12)
    s_barrier
    ds_read_b64_tr_b16 v[232:233], v7 offset:0
    ds_read_b64_tr_b16 v[234:235], v7 offset:1024
    s_waitcnt lgkmcnt(6)
    v_mfma_f32_16x16x32_bf16 v[128:131], v[244:247], v[56:59], v[128:131]
    ds_read_b64_tr_b16 v[236:237], v8 offset:32
    s_mov_b32 s23, 0xa000
    buffer_load_dwordx4 v[48:51], v6, s[8:11], s23 offen offset:1024 sc1
    v_mfma_f32_16x16x32_bf16 v[132:135], v[244:247], v[60:63], v[132:135]
    ds_read_b64_tr_b16 v[238:239], v8 offset:1056
    s_waitcnt lgkmcnt(6)
    v_mfma_f32_16x16x32_bf16 v[136:139], v[224:227], v[56:59], v[136:139]
    ds_read_b64_tr_b16 v[240:241], v7 offset:256
    v_mfma_f32_16x16x32_bf16 v[140:143], v[224:227], v[60:63], v[140:143]
    ds_read_b64_tr_b16 v[242:243], v7 offset:1280
    s_mov_b32 s23, 0x2a000
    buffer_load_dwordx4 v[52:55], v6, s[8:11], s23 offen offset:1024 sc1
    s_waitcnt lgkmcnt(6)
    v_mfma_f32_16x16x32_bf16 v[144:147], v[228:231], v[56:59], v[144:147]
    ds_read_b64_tr_b16 v[244:245], v8 offset:288
    v_mfma_f32_16x16x32_bf16 v[148:151], v[228:231], v[60:63], v[148:151]
    ds_read_b64_tr_b16 v[246:247], v8 offset:1312
    s_waitcnt vmcnt(13) lgkmcnt(6)
    v_mfma_f32_16x16x32_bf16 v[88:91], v[232:235], v[24:27], v[88:91]
    ds_read_b64_tr_b16 v[224:225], v7 offset:512
    s_waitcnt vmcnt(12)
    v_mfma_f32_16x16x32_bf16 v[92:95], v[232:235], v[28:31], v[92:95]
    s_add_u32 s22, s24, 0x310000
    s_add_u32 m0, s20, 0x18000
    s_nop 0
    buffer_load_dwordx4 v3, s[4:7], s22 offen lds
    ds_read_b64_tr_b16 v[226:227], v7 offset:1536
    s_waitcnt lgkmcnt(6)
    v_mfma_f32_16x16x32_bf16 v[96:99], v[236:239], v[24:27], v[96:99]
    ds_read_b64_tr_b16 v[228:229], v8 offset:544
    v_mfma_f32_16x16x32_bf16 v[100:103], v[236:239], v[28:31], v[100:103]
    ds_read_b64_tr_b16 v[230:231], v8 offset:1568
    s_waitcnt lgkmcnt(6)
    v_mfma_f32_16x16x32_bf16 v[104:107], v[240:243], v[24:27], v[104:107]
    s_add_u32 s22, s24, 0x312000
    s_add_u32 m0, s20, 0x18400
    s_nop 0
    buffer_load_dwordx4 v3, s[4:7], s22 offen lds
    ds_read_b64_tr_b16 v[232:233], v7 offset:768
    v_mfma_f32_16x16x32_bf16 v[108:111], v[240:243], v[28:31], v[108:111]
    ds_read_b64_tr_b16 v[234:235], v7 offset:1792
    s_waitcnt lgkmcnt(6)
    v_mfma_f32_16x16x32_bf16 v[112:115], v[244:247], v[24:27], v[112:115]
    ds_read_b64_tr_b16 v[236:237], v8 offset:800
    v_mfma_f32_16x16x32_bf16 v[116:119], v[244:247], v[28:31], v[116:119]
    ds_read_b64_tr_b16 v[238:239], v8 offset:1824
    s_waitcnt lgkmcnt(6)
    v_mfma_f32_16x16x32_bf16 v[120:123], v[224:227], v[24:27], v[120:123]
    v_mfma_f32_16x16x32_bf16 v[124:127], v[224:227], v[28:31], v[124:127]
    s_waitcnt vmcnt(12)
    s_barrier
    ds_read_b64_tr_b16 v[240:241], v7 offset:16384
    ds_read_b64_tr_b16 v[242:243], v7 offset:17408
    s_add_u32 s19, s19, 8192
    buffer_load_dword v12, v13, s[8:11], s19 offen sc1
    s_waitcnt lgkmcnt(6)
    v_mfma_f32_16x16x32_bf16 v[128:131], v[228:231], v[24:27], v[128:131]
    ds_read_b64_tr_b16 v[244:245], v8 offset:16416
    s_mov_b32 s23, 0xc000
    buffer_load_dwordx4 v[56:59], v6, s[8:11], s23 offen offset:1024 sc1
    v_mfma_f32_16x16x32_bf16 v[132:135], v[228:231], v[28:31], v[132:135]
    ds_read_b64_tr_b16 v[246:247], v8 offset:17440
    s_waitcnt lgkmcnt(6)
    v_mfma_f32_16x16x32_bf16 v[136:139], v[232:235], v[24:27], v[136:139]
    ds_read_b64_tr_b16 v[224:225], v7 offset:16640
    v_mfma_f32_16x16x32_bf16 v[140:143], v[232:235], v[28:31], v[140:143]
    ds_read_b64_tr_b16 v[226:227], v7 offset:17664
    s_mov_b32 s23, 0x2c000
    buffer_load_dwordx4 v[60:63], v6, s[8:11], s23 offen offset:1024 sc1
    s_waitcnt lgkmcnt(6)
    v_mfma_f32_16x16x32_bf16 v[144:147], v[236:239], v[24:27], v[144:147]
    ds_read_b64_tr_b16 v[228:229], v8 offset:16672
    v_mfma_f32_16x16x32_bf16 v[148:151], v[236:239], v[28:31], v[148:151]
    ds_read_b64_tr_b16 v[230:231], v8 offset:17696
    s_waitcnt vmcnt(14) lgkmcnt(6)
    v_mfma_f32_16x16x32_bf16 v[88:91], v[240:243], v[32:35], v[88:91]
    ds_read_b64_tr_b16 v[232:233], v7 offset:16896
    s_waitcnt vmcnt(13)
    v_mfma_f32_16x16x32_bf16 v[92:95], v[240:243], v[36:39], v[92:95]
    s_add_u32 s22, s24, 0x390000
    s_add_u32 m0, s20, 0x1c000
    s_nop 0
    buffer_load_dwordx4 v3, s[4:7], s22 offen lds
    ds_read_b64_tr_b16 v[234:235], v7 offset:17920
    s_waitcnt lgkmcnt(6)
    v_mfma_f32_16x16x32_bf16 v[96:99], v[244:247], v[32:35], v[96:99]
    ds_read_b64_tr_b16 v[236:237], v8 offset:16928
    v_mfma_f32_16x16x32_bf16 v[100:103], v[244:247], v[36:39], v[100:103]
    ds_read_b64_tr_b16 v[238:239], v8 offset:17952
    s_waitcnt lgkmcnt(6)
    v_mfma_f32_16x16x32_bf16 v[104:107], v[224:227], v[32:35], v[104:107]
    s_add_u32 s22, s24, 0x392000
    s_add_u32 m0, s20, 0x1c400
    s_nop 0
    buffer_load_dwordx4 v3, s[4:7], s22 offen lds
    ds_read_b64_tr_b16 v[240:241], v7 offset:17152
    v_mfma_f32_16x16x32_bf16 v[108:111], v[224:227], v[36:39], v[108:111]
    ds_read_b64_tr_b16 v[242:243], v7 offset:18176
    s_waitcnt lgkmcnt(6)
    v_mfma_f32_16x16x32_bf16 v[112:115], v[228:231], v[32:35], v[112:115]
    ds_read_b64_tr_b16 v[244:245], v8 offset:17184
    v_mfma_f32_16x16x32_bf16 v[116:119], v[228:231], v[36:39], v[116:119]
    ds_read_b64_tr_b16 v[246:247], v8 offset:18208
    s_waitcnt lgkmcnt(6)
    v_mfma_f32_16x16x32_bf16 v[120:123], v[232:235], v[32:35], v[120:123]
    v_mfma_f32_16x16x32_bf16 v[124:127], v[232:235], v[36:39], v[124:127]
    s_waitcnt vmcnt(13)
    s_barrier
    ds_read_b64_tr_b16 v[224:225], v4 offset:0
    ds_read_b64_tr_b16 v[226:227], v4 offset:1024
    s_waitcnt lgkmcnt(6)
    v_mfma_f32_16x16x32_bf16 v[128:131], v[236:239], v[32:35], v[128:131]
    ds_read_b64_tr_b16 v[228:229], v5 offset:32
    s_mov_b32 s23, 0xe000
    buffer_load_dwordx4 v[24:27], v6, s[8:11], s23 offen offset:1024 sc1
    v_mfma_f32_16x16x32_bf16 v[132:135], v[236:239], v[36:39], v[132:135]
    ds_read_b64_tr_b16 v[230:231], v5 offset:1056
    s_waitcnt lgkmcnt(6)
    v_mfma_f32_16x16x32_bf16 v[136:139], v[240:243], v[32:35], v[136:139]
    ds_read_b64_tr_b16 v[232:233], v4 offset:256
    v_mfma_f32_16x16x32_bf16 v[140:143], v[240:243], v[36:39], v[140:143]
    ds_read_b64_tr_b16 v[234:235], v4 offset:1280
    s_mov_b32 s23, 0x2e000
    buffer_load_dwordx4 v[28:31], v6, s[8:11], s23 offen offset:1024 sc1
    s_waitcnt lgkmcnt(6)
    v_mfma_f32_16x16x32_bf16 v[144:147], v[244:247], v[32:35], v[144:147]
    ds_read_b64_tr_b16 v[236:237], v5 offset:288
    v_mfma_f32_16x16x32_bf16 v[148:151], v[244:247], v[36:39], v[148:151]
    ds_read_b64_tr_b16 v[238:239], v5 offset:1312
    s_waitcnt vmcnt(6)
    v_cmp_ne_u32 vcc, s28, v12
    s_cbranch_vccnz adaLN_cond__sliding_block_cached__moe_arch_mod__prompt_kernel_o219r
adaLN_cond__sliding_block_cached__moe_arch_mod__prompt_kernel_o219b:
    s_waitcnt lgkmcnt(6)
    v_mfma_f32_16x16x32_bf16 v[88:91], v[224:227], v[40:43], v[88:91]
    ds_read_b64_tr_b16 v[240:241], v4 offset:512
    v_mfma_f32_16x16x32_bf16 v[92:95], v[224:227], v[44:47], v[92:95]
    s_add_u32 s22, s24, 0x20000
    s_add_u32 m0, s20, 0x20000
    s_nop 0
    buffer_load_dwordx4 v3, s[4:7], s22 offen lds
    ds_read_b64_tr_b16 v[242:243], v4 offset:1536
    s_waitcnt lgkmcnt(6)
    v_mfma_f32_16x16x32_bf16 v[96:99], v[228:231], v[40:43], v[96:99]
    ds_read_b64_tr_b16 v[244:245], v5 offset:544
    v_mfma_f32_16x16x32_bf16 v[100:103], v[228:231], v[44:47], v[100:103]
    ds_read_b64_tr_b16 v[246:247], v5 offset:1568
    s_waitcnt lgkmcnt(6)
    v_mfma_f32_16x16x32_bf16 v[104:107], v[232:235], v[40:43], v[104:107]
    s_add_u32 s22, s24, 0x22000
    s_add_u32 m0, s20, 0x20400
    s_nop 0
    buffer_load_dwordx4 v3, s[4:7], s22 offen lds
    ds_read_b64_tr_b16 v[224:225], v4 offset:768
    v_mfma_f32_16x16x32_bf16 v[108:111], v[232:235], v[44:47], v[108:111]
    ds_read_b64_tr_b16 v[226:227], v4 offset:1792
    s_waitcnt lgkmcnt(6)
    v_mfma_f32_16x16x32_bf16 v[112:115], v[236:239], v[40:43], v[112:115]
    ds_read_b64_tr_b16 v[228:229], v5 offset:800
    v_mfma_f32_16x16x32_bf16 v[116:119], v[236:239], v[44:47], v[116:119]
    ds_read_b64_tr_b16 v[230:231], v5 offset:1824
    s_waitcnt lgkmcnt(6)
    v_mfma_f32_16x16x32_bf16 v[120:123], v[240:243], v[40:43], v[120:123]
    v_mfma_f32_16x16x32_bf16 v[124:127], v[240:243], v[44:47], v[124:127]
    s_barrier
    ds_read_b64_tr_b16 v[232:233], v4 offset:16384
    ds_read_b64_tr_b16 v[234:235], v4 offset:17408
    s_waitcnt lgkmcnt(6)
    v_mfma_f32_16x16x32_bf16 v[128:131], v[244:247], v[40:43], v[128:131]
    ds_read_b64_tr_b16 v[236:237], v5 offset:16416
    s_mov_b32 s23, 0x0
    buffer_load_dwordx4 v[32:35], v6, s[8:11], s23 offen offset:2048 sc1
    v_mfma_f32_16x16x32_bf16 v[132:135], v[244:247], v[44:47], v[132:135]
    ds_read_b64_tr_b16 v[238:239], v5 offset:17440
    s_waitcnt lgkmcnt(6)
    v_mfma_f32_16x16x32_bf16 v[136:139], v[224:227], v[40:43], v[136:139]
    ds_read_b64_tr_b16 v[240:241], v4 offset:16640
    v_mfma_f32_16x16x32_bf16 v[140:143], v[224:227], v[44:47], v[140:143]
    ds_read_b64_tr_b16 v[242:243], v4 offset:17664
    s_mov_b32 s23, 0x20000
    buffer_load_dwordx4 v[36:39], v6, s[8:11], s23 offen offset:2048 sc1
    s_waitcnt lgkmcnt(6)
    v_mfma_f32_16x16x32_bf16 v[144:147], v[228:231], v[40:43], v[144:147]
    ds_read_b64_tr_b16 v[244:245], v5 offset:16672
    v_mfma_f32_16x16x32_bf16 v[148:151], v[228:231], v[44:47], v[148:151]
    ds_read_b64_tr_b16 v[246:247], v5 offset:17696
    s_waitcnt lgkmcnt(6)
    v_mfma_f32_16x16x32_bf16 v[88:91], v[232:235], v[48:51], v[88:91]
    ds_read_b64_tr_b16 v[224:225], v4 offset:16896
    v_mfma_f32_16x16x32_bf16 v[92:95], v[232:235], v[52:55], v[92:95]
    s_add_u32 s22, s24, 0xa0000
    s_add_u32 m0, s20, 0x24000
    s_nop 0
    buffer_load_dwordx4 v3, s[4:7], s22 offen lds
    ds_read_b64_tr_b16 v[226:227], v4 offset:17920
    s_waitcnt lgkmcnt(6)
    v_mfma_f32_16x16x32_bf16 v[96:99], v[236:239], v[48:51], v[96:99]
    ds_read_b64_tr_b16 v[228:229], v5 offset:16928
    v_mfma_f32_16x16x32_bf16 v[100:103], v[236:239], v[52:55], v[100:103]
    ds_read_b64_tr_b16 v[230:231], v5 offset:17952
    s_waitcnt lgkmcnt(6)
    v_mfma_f32_16x16x32_bf16 v[104:107], v[240:243], v[48:51], v[104:107]
    s_add_u32 s22, s24, 0xa2000
    s_add_u32 m0, s20, 0x24400
    s_nop 0
    buffer_load_dwordx4 v3, s[4:7], s22 offen lds
    ds_read_b64_tr_b16 v[232:233], v4 offset:17152
    v_mfma_f32_16x16x32_bf16 v[108:111], v[240:243], v[52:55], v[108:111]
    ds_read_b64_tr_b16 v[234:235], v4 offset:18176
    s_waitcnt lgkmcnt(6)
    v_mfma_f32_16x16x32_bf16 v[112:115], v[244:247], v[48:51], v[112:115]
    ds_read_b64_tr_b16 v[236:237], v5 offset:17184
    v_mfma_f32_16x16x32_bf16 v[116:119], v[244:247], v[52:55], v[116:119]
    ds_read_b64_tr_b16 v[238:239], v5 offset:18208
    s_waitcnt lgkmcnt(6)
    v_mfma_f32_16x16x32_bf16 v[120:123], v[224:227], v[48:51], v[120:123]
    v_mfma_f32_16x16x32_bf16 v[124:127], v[224:227], v[52:55], v[124:127]
    s_barrier
    ds_read_b64_tr_b16 v[240:241], v4 offset:32768
    ds_read_b64_tr_b16 v[242:243], v4 offset:33792
    s_waitcnt lgkmcnt(6)
    v_mfma_f32_16x16x32_bf16 v[128:131], v[228:231], v[48:51], v[128:131]
    ds_read_b64_tr_b16 v[244:245], v5 offset:32800
    s_mov_b32 s23, 0x2000
    buffer_load_dwordx4 v[40:43], v6, s[8:11], s23 offen offset:2048 sc1
    v_mfma_f32_16x16x32_bf16 v[132:135], v[228:231], v[52:55], v[132:135]
    ds_read_b64_tr_b16 v[246:247], v5 offset:33824
    s_waitcnt lgkmcnt(6)
    v_mfma_f32_16x16x32_bf16 v[136:139], v[232:235], v[48:51], v[136:139]
    ds_read_b64_tr_b16 v[224:225], v4 offset:33024
    v_mfma_f32_16x16x32_bf16 v[140:143], v[232:235], v[52:55], v[140:143]
    ds_read_b64_tr_b16 v[226:227], v4 offset:34048
    s_mov_b32 s23, 0x22000
    buffer_load_dwordx4 v[44:47], v6, s[8:11], s23 offen offset:2048 sc1
    s_waitcnt lgkmcnt(6)
    v_mfma_f32_16x16x32_bf16 v[144:147], v[236:239], v[48:51], v[144:147]
    ds_read_b64_tr_b16 v[228:229], v5 offset:33056
    v_mfma_f32_16x16x32_bf16 v[148:151], v[236:239], v[52:55], v[148:151]
    ds_read_b64_tr_b16 v[230:231], v5 offset:34080
    s_waitcnt vmcnt(13) lgkmcnt(6)
    v_mfma_f32_16x16x32_bf16 v[88:91], v[240:243], v[56:59], v[88:91]
    ds_read_b64_tr_b16 v[232:233], v4 offset:33280
    s_waitcnt vmcnt(12)
    v_mfma_f32_16x16x32_bf16 v[92:95], v[240:243], v[60:63], v[92:95]
    s_add_u32 s22, s24, 0x120000
    s_add_u32 m0, s20, 0x10000
    s_nop 0
    buffer_load_dwordx4 v3, s[4:7], s22 offen lds
    ds_read_b64_tr_b16 v[234:235], v4 offset:34304
    s_waitcnt lgkmcnt(6)
    v_mfma_f32_16x16x32_bf16 v[96:99], v[244:247], v[56:59], v[96:99]
    ds_read_b64_tr_b16 v[236:237], v5 offset:33312
    v_mfma_f32_16x16x32_bf16 v[100:103], v[244:247], v[60:63], v[100:103]
    ds_read_b64_tr_b16 v[238:239], v5 offset:34336
    s_waitcnt lgkmcnt(6)
    v_mfma_f32_16x16x32_bf16 v[104:107], v[224:227], v[56:59], v[104:107]
    s_add_u32 s22, s24, 0x122000
    s_add_u32 m0, s20, 0x10400
    s_nop 0
    buffer_load_dwordx4 v3, s[4:7], s22 offen lds
    ds_read_b64_tr_b16 v[240:241], v4 offset:33536
    v_mfma_f32_16x16x32_bf16 v[108:111], v[224:227], v[60:63], v[108:111]
    ds_read_b64_tr_b16 v[242:243], v4 offset:34560
    s_waitcnt lgkmcnt(6)
    v_mfma_f32_16x16x32_bf16 v[112:115], v[228:231], v[56:59], v[112:115]
    ds_read_b64_tr_b16 v[244:245], v5 offset:33568
    v_mfma_f32_16x16x32_bf16 v[116:119], v[228:231], v[60:63], v[116:119]
    ds_read_b64_tr_b16 v[246:247], v5 offset:34592
    s_waitcnt lgkmcnt(6)
    v_mfma_f32_16x16x32_bf16 v[120:123], v[232:235], v[56:59], v[120:123]
    v_mfma_f32_16x16x32_bf16 v[124:127], v[232:235], v[60:63], v[124:127]
    s_waitcnt vmcnt(12)
    s_barrier
    ds_read_b64_tr_b16 v[224:225], v4 offset:49152
    ds_read_b64_tr_b16 v[226:227], v4 offset:50176
    s_waitcnt lgkmcnt(6)
    v_mfma_f32_16x16x32_bf16 v[128:131], v[236:239], v[56:59], v[128:131]
    ds_read_b64_tr_b16 v[228:229], v5 offset:49184
    s_mov_b32 s23, 0x4000
    buffer_load_dwordx4 v[48:51], v6, s[8:11], s23 offen offset:2048 sc1
    v_mfma_f32_16x16x32_bf16 v[132:135], v[236:239], v[60:63], v[132:135]
    ds_read_b64_tr_b16 v[230:231], v5 offset:50208
    s_waitcnt lgkmcnt(6)
    v_mfma_f32_16x16x32_bf16 v[136:139], v[240:243], v[56:59], v[136:139]
    ds_read_b64_tr_b16 v[232:233], v4 offset:49408
    v_mfma_f32_16x16x32_bf16 v[140:143], v[240:243], v[60:63], v[140:143]
    ds_read_b64_tr_b16 v[234:235], v4 offset:50432
    s_mov_b32 s23, 0x24000
    buffer_load_dwordx4 v[52:55], v6, s[8:11], s23 offen offset:2048 sc1
    s_waitcnt lgkmcnt(6)
    v_mfma_f32_16x16x32_bf16 v[144:147], v[244:247], v[56:59], v[144:147]
    ds_read_b64_tr_b16 v[236:237], v5 offset:49440
    v_mfma_f32_16x16x32_bf16 v[148:151], v[244:247], v[60:63], v[148:151]
    ds_read_b64_tr_b16 v[238:239], v5 offset:50464
    s_waitcnt vmcnt(13) lgkmcnt(6)
    v_mfma_f32_16x16x32_bf16 v[88:91], v[224:227], v[24:27], v[88:91]
    ds_read_b64_tr_b16 v[240:241], v4 offset:49664
    s_waitcnt vmcnt(12)
    v_mfma_f32_16x16x32_bf16 v[92:95], v[224:227], v[28:31], v[92:95]
    s_add_u32 s22, s24, 0x1a0000
    s_add_u32 m0, s20, 0x14000
    s_nop 0
    buffer_load_dwordx4 v3, s[4:7], s22 offen lds
    ds_read_b64_tr_b16 v[242:243], v4 offset:50688
    s_waitcnt lgkmcnt(6)
    v_mfma_f32_16x16x32_bf16 v[96:99], v[228:231], v[24:27], v[96:99]
    ds_read_b64_tr_b16 v[244:245], v5 offset:49696
    v_mfma_f32_16x16x32_bf16 v[100:103], v[228:231], v[28:31], v[100:103]
    ds_read_b64_tr_b16 v[246:247], v5 offset:50720
    s_waitcnt lgkmcnt(6)
    v_mfma_f32_16x16x32_bf16 v[104:107], v[232:235], v[24:27], v[104:107]
    s_add_u32 s22, s24, 0x1a2000
    s_add_u32 m0, s20, 0x14400
    s_nop 0
    buffer_load_dwordx4 v3, s[4:7], s22 offen lds
    ds_read_b64_tr_b16 v[224:225], v4 offset:49920
    v_mfma_f32_16x16x32_bf16 v[108:111], v[232:235], v[28:31], v[108:111]
    ds_read_b64_tr_b16 v[226:227], v4 offset:50944
    s_waitcnt lgkmcnt(6)
    v_mfma_f32_16x16x32_bf16 v[112:115], v[236:239], v[24:27], v[112:115]
    ds_read_b64_tr_b16 v[228:229], v5 offset:49952
    v_mfma_f32_16x16x32_bf16 v[116:119], v[236:239], v[28:31], v[116:119]
    ds_read_b64_tr_b16 v[230:231], v5 offset:50976
    s_waitcnt lgkmcnt(6)
    v_mfma_f32_16x16x32_bf16 v[120:123], v[240:243], v[24:27], v[120:123]
    v_mfma_f32_16x16x32_bf16 v[124:127], v[240:243], v[28:31], v[124:127]
    s_waitcnt vmcnt(12)
    s_barrier
    ds_read_b64_tr_b16 v[232:233], v7 offset:0
    ds_read_b64_tr_b16 v[234:235], v7 offset:1024
    s_waitcnt lgkmcnt(6)
    v_mfma_f32_16x16x32_bf16 v[128:131], v[244:247], v[24:27], v[128:131]
    ds_read_b64_tr_b16 v[236:237], v8 offset:32
    s_mov_b32 s23, 0x6000
    buffer_load_dwordx4 v[56:59], v6, s[8:11], s23 offen offset:2048 sc1
    v_mfma_f32_16x16x32_bf16 v[132:135], v[244:247], v[28:31], v[132:135]
    ds_read_b64_tr_b16 v[238:239], v8 offset:1056
    s_waitcnt lgkmcnt(6)
    v_mfma_f32_16x16x32_bf16 v[136:139], v[224:227], v[24:27], v[136:139]
    ds_read_b64_tr_b16 v[240:241], v7 offset:256
    v_mfma_f32_16x16x32_bf16 v[140:143], v[224:227], v[28:31], v[140:143]
    ds_read_b64_tr_b16 v[242:243], v7 offset:1280
    s_mov_b32 s23, 0x26000
    buffer_load_dwordx4 v[60:63], v6, s[8:11], s23 offen offset:2048 sc1
    s_waitcnt lgkmcnt(6)
    v_mfma_f32_16x16x32_bf16 v[144:147], v[228:231], v[24:27], v[144:147]
    ds_read_b64_tr_b16 v[244:245], v8 offset:288
    v_mfma_f32_16x16x32_bf16 v[148:151], v[228:231], v[28:31], v[148:151]
    ds_read_b64_tr_b16 v[246:247], v8 offset:1312
    s_waitcnt vmcnt(13) lgkmcnt(6)
    v_mfma_f32_16x16x32_bf16 v[88:91], v[232:235], v[32:35], v[88:91]
    ds_read_b64_tr_b16 v[224:225], v7 offset:512
    s_waitcnt vmcnt(12)
    v_mfma_f32_16x16x32_bf16 v[92:95], v[232:235], v[36:39], v[92:95]
    s_add_u32 s22, s24, 0x220000
    s_add_u32 m0, s20, 0x18000
    s_nop 0
    buffer_load_dwordx4 v3, s[4:7], s22 offen lds
    ds_read_b64_tr_b16 v[226:227], v7 offset:1536
    s_waitcnt lgkmcnt(6)
    v_mfma_f32_16x16x32_bf16 v[96:99], v[236:239], v[32:35], v[96:99]
    ds_read_b64_tr_b16 v[228:229], v8 offset:544
    v_mfma_f32_16x16x32_bf16 v[100:103], v[236:239], v[36:39], v[100:103]
    ds_read_b64_tr_b16 v[230:231], v8 offset:1568
    s_waitcnt lgkmcnt(6)
    v_mfma_f32_16x16x32_bf16 v[104:107], v[240:243], v[32:35], v[104:107]
    s_add_u32 s22, s24, 0x222000
    s_add_u32 m0, s20, 0x18400
    s_nop 0
    buffer_load_dwordx4 v3, s[4:7], s22 offen lds
    ds_read_b64_tr_b16 v[232:233], v7 offset:768
    v_mfma_f32_16x16x32_bf16 v[108:111], v[240:243], v[36:39], v[108:111]
    ds_read_b64_tr_b16 v[234:235], v7 offset:1792
    s_waitcnt lgkmcnt(6)
    v_mfma_f32_16x16x32_bf16 v[112:115], v[244:247], v[32:35], v[112:115]
    ds_read_b64_tr_b16 v[236:237], v8 offset:800
    v_mfma_f32_16x16x32_bf16 v[116:119], v[244:247], v[36:39], v[116:119]
    ds_read_b64_tr_b16 v[238:239], v8 offset:1824
    s_waitcnt lgkmcnt(6)
    v_mfma_f32_16x16x32_bf16 v[120:123], v[224:227], v[32:35], v[120:123]
    v_mfma_f32_16x16x32_bf16 v[124:127], v[224:227], v[36:39], v[124:127]
    s_waitcnt vmcnt(12)
    s_barrier
    ds_read_b64_tr_b16 v[240:241], v7 offset:16384
    ds_read_b64_tr_b16 v[242:243], v7 offset:17408
    s_waitcnt lgkmcnt(6)
    v_mfma_f32_16x16x32_bf16 v[128:131], v[228:231], v[32:35], v[128:131]
    ds_read_b64_tr_b16 v[244:245], v8 offset:16416
    s_mov_b32 s23, 0x8000
    buffer_load_dwordx4 v[24:27], v6, s[8:11], s23 offen offset:2048 sc1
    v_mfma_f32_16x16x32_bf16 v[132:135], v[228:231], v[36:39], v[132:135]
    ds_read_b64_tr_b16 v[246:247], v8 offset:17440
    s_waitcnt lgkmcnt(6)
    v_mfma_f32_16x16x32_bf16 v[136:139], v[232:235], v[32:35], v[136:139]
    ds_read_b64_tr_b16 v[224:225], v7 offset:16640
    v_mfma_f32_16x16x32_bf16 v[140:143], v[232:235], v[36:39], v[140:143]
    ds_read_b64_tr_b16 v[226:227], v7 offset:17664
    s_mov_b32 s23, 0x28000
    buffer_load_dwordx4 v[28:31], v6, s[8:11], s23 offen offset:2048 sc1
    s_waitcnt lgkmcnt(6)
    v_mfma_f32_16x16x32_bf16 v[144:147], v[236:239], v[32:35], v[144:147]
    ds_read_b64_tr_b16 v[228:229], v8 offset:16672
    v_mfma_f32_16x16x32_bf16 v[148:151], v[236:239], v[36:39], v[148:151]
    ds_read_b64_tr_b16 v[230:231], v8 offset:17696
    s_waitcnt vmcnt(13) lgkmcnt(6)
    v_mfma_f32_16x16x32_bf16 v[88:91], v[240:243], v[40:43], v[88:91]
    ds_read_b64_tr_b16 v[232:233], v7 offset:16896
    s_waitcnt vmcnt(12)
    v_mfma_f32_16x16x32_bf16 v[92:95], v[240:243], v[44:47], v[92:95]
    s_add_u32 s22, s24, 0x2a0000
    s_add_u32 m0, s20, 0x1c000
    s_nop 0
    buffer_load_dwordx4 v3, s[4:7], s22 offen lds
    ds_read_b64_tr_b16 v[234:235], v7 offset:17920
    s_waitcnt lgkmcnt(6)
    v_mfma_f32_16x16x32_bf16 v[96:99], v[244:247], v[40:43], v[96:99]
    ds_read_b64_tr_b16 v[236:237], v8 offset:16928
    v_mfma_f32_16x16x32_bf16 v[100:103], v[244:247], v[44:47], v[100:103]
    ds_read_b64_tr_b16 v[238:239], v8 offset:17952
    s_waitcnt lgkmcnt(6)
    v_mfma_f32_16x16x32_bf16 v[104:107], v[224:227], v[40:43], v[104:107]
    s_add_u32 s22, s24, 0x2a2000
    s_add_u32 m0, s20, 0x1c400
    s_nop 0
    buffer_load_dwordx4 v3, s[4:7], s22 offen lds
    ds_read_b64_tr_b16 v[240:241], v7 offset:17152
    v_mfma_f32_16x16x32_bf16 v[108:111], v[224:227], v[44:47], v[108:111]
    ds_read_b64_tr_b16 v[242:243], v7 offset:18176
    s_waitcnt lgkmcnt(6)
    v_mfma_f32_16x16x32_bf16 v[112:115], v[228:231], v[40:43], v[112:115]
    ds_read_b64_tr_b16 v[244:245], v8 offset:17184
    v_mfma_f32_16x16x32_bf16 v[116:119], v[228:231], v[44:47], v[116:119]
    ds_read_b64_tr_b16 v[246:247], v8 offset:18208
    s_waitcnt lgkmcnt(6)
    v_mfma_f32_16x16x32_bf16 v[120:123], v[232:235], v[40:43], v[120:123]
    v_mfma_f32_16x16x32_bf16 v[124:127], v[232:235], v[44:47], v[124:127]
    s_waitcnt vmcnt(12)
    s_barrier
    ds_read_b64_tr_b16 v[224:225], v4 offset:0
    ds_read_b64_tr_b16 v[226:227], v4 offset:1024
    s_waitcnt lgkmcnt(6)
    v_mfma_f32_16x16x32_bf16 v[128:131], v[236:239], v[40:43], v[128:131]
    ds_read_b64_tr_b16 v[228:229], v5 offset:32
    s_mov_b32 s23, 0xa000
    buffer_load_dwordx4 v[32:35], v6, s[8:11], s23 offen offset:2048 sc1
    v_mfma_f32_16x16x32_bf16 v[132:135], v[236:239], v[44:47], v[132:135]
    ds_read_b64_tr_b16 v[230:231], v5 offset:1056
    s_waitcnt lgkmcnt(6)
    v_mfma_f32_16x16x32_bf16 v[136:139], v[240:243], v[40:43], v[136:139]
    ds_read_b64_tr_b16 v[232:233], v4 offset:256
    v_mfma_f32_16x16x32_bf16 v[140:143], v[240:243], v[44:47], v[140:143]
    ds_read_b64_tr_b16 v[234:235], v4 offset:1280
    s_mov_b32 s23, 0x2a000
    buffer_load_dwordx4 v[36:39], v6, s[8:11], s23 offen offset:2048 sc1
    s_waitcnt lgkmcnt(6)
    v_mfma_f32_16x16x32_bf16 v[144:147], v[244:247], v[40:43], v[144:147]
    ds_read_b64_tr_b16 v[236:237], v5 offset:288
    v_mfma_f32_16x16x32_bf16 v[148:151], v[244:247], v[44:47], v[148:151]
    ds_read_b64_tr_b16 v[238:239], v5 offset:1312
    s_waitcnt vmcnt(13) lgkmcnt(6)
    v_mfma_f32_16x16x32_bf16 v[88:91], v[224:227], v[48:51], v[88:91]
    ds_read_b64_tr_b16 v[240:241], v4 offset:512
    s_waitcnt vmcnt(12)
    v_mfma_f32_16x16x32_bf16 v[92:95], v[224:227], v[52:55], v[92:95]
    s_add_u32 s22, s24, 0x320000
    s_add_u32 m0, s20, 0x20000
    s_nop 0
    buffer_load_dwordx4 v3, s[4:7], s22 offen lds
    ds_read_b64_tr_b16 v[242:243], v4 offset:1536
    s_waitcnt lgkmcnt(6)
    v_mfma_f32_16x16x32_bf16 v[96:99], v[228:231], v[48:51], v[96:99]
    ds_read_b64_tr_b16 v[244:245], v5 offset:544
    v_mfma_f32_16x16x32_bf16 v[100:103], v[228:231], v[52:55], v[100:103]
    ds_read_b64_tr_b16 v[246:247], v5 offset:1568
    s_waitcnt lgkmcnt(6)
    v_mfma_f32_16x16x32_bf16 v[104:107], v[232:235], v[48:51], v[104:107]
    s_add_u32 s22, s24, 0x322000
    s_add_u32 m0, s20, 0x20400
    s_nop 0
    buffer_load_dwordx4 v3, s[4:7], s22 offen lds
    ds_read_b64_tr_b16 v[224:225], v4 offset:768
    v_mfma_f32_16x16x32_bf16 v[108:111], v[232:235], v[52:55], v[108:111]
    ds_read_b64_tr_b16 v[226:227], v4 offset:1792
    s_waitcnt lgkmcnt(6)
    v_mfma_f32_16x16x32_bf16 v[112:115], v[236:239], v[48:51], v[112:115]
    ds_read_b64_tr_b16 v[228:229], v5 offset:800
    v_mfma_f32_16x16x32_bf16 v[116:119], v[236:239], v[52:55], v[116:119]
    ds_read_b64_tr_b16 v[230:231], v5 offset:1824
    s_waitcnt lgkmcnt(6)
    v_mfma_f32_16x16x32_bf16 v[120:123], v[240:243], v[48:51], v[120:123]
    v_mfma_f32_16x16x32_bf16 v[124:127], v[240:243], v[52:55], v[124:127]
    s_waitcnt vmcnt(12)
    s_barrier
    ds_read_b64_tr_b16 v[232:233], v4 offset:16384
    ds_read_b64_tr_b16 v[234:235], v4 offset:17408
    s_add_u32 s19, s19, 8192
    buffer_load_dword v12, v13, s[8:11], s19 offen sc1
    s_waitcnt lgkmcnt(6)
    v_mfma_f32_16x16x32_bf16 v[128:131], v[244:247], v[48:51], v[128:131]
    ds_read_b64_tr_b16 v[236:237], v5 offset:16416
    s_mov_b32 s23, 0xc000
    buffer_load_dwordx4 v[40:43], v6, s[8:11], s23 offen offset:2048 sc1
    v_mfma_f32_16x16x32_bf16 v[132:135], v[244:247], v[52:55], v[132:135]
    ds_read_b64_tr_b16 v[238:239], v5 offset:17440
    s_waitcnt lgkmcnt(6)
    v_mfma_f32_16x16x32_bf16 v[136:139], v[224:227], v[48:51], v[136:139]
    ds_read_b64_tr_b16 v[240:241], v4 offset:16640
    v_mfma_f32_16x16x32_bf16 v[140:143], v[224:227], v[52:55], v[140:143]
    ds_read_b64_tr_b16 v[242:243], v4 offset:17664
    s_mov_b32 s23, 0x2c000
    buffer_load_dwordx4 v[44:47], v6, s[8:11], s23 offen offset:2048 sc1
    s_waitcnt lgkmcnt(6)
    v_mfma_f32_16x16x32_bf16 v[144:147], v[228:231], v[48:51], v[144:147]
    ds_read_b64_tr_b16 v[244:245], v5 offset:16672
    v_mfma_f32_16x16x32_bf16 v[148:151], v[228:231], v[52:55], v[148:151]
    ds_read_b64_tr_b16 v[246:247], v5 offset:17696
    s_waitcnt vmcnt(14) lgkmcnt(6)
    v_mfma_f32_16x16x32_bf16 v[88:91], v[232:235], v[56:59], v[88:91]
    ds_read_b64_tr_b16 v[224:225], v4 offset:16896
    s_waitcnt vmcnt(13)
    v_mfma_f32_16x16x32_bf16 v[92:95], v[232:235], v[60:63], v[92:95]
    s_add_u32 s22, s24, 0x3a0000
    s_add_u32 m0, s20, 0x24000
    s_nop 0
    buffer_load_dwordx4 v3, s[4:7], s22 offen lds
    ds_read_b64_tr_b16 v[226:227], v4 offset:17920
    s_waitcnt lgkmcnt(6)
    v_mfma_f32_16x16x32_bf16 v[96:99], v[236:239], v[56:59], v[96:99]
    ds_read_b64_tr_b16 v[228:229], v5 offset:16928
    v_mfma_f32_16x16x32_bf16 v[100:103], v[236:239], v[60:63], v[100:103]
    ds_read_b64_tr_b16 v[230:231], v5 offset:17952
    s_waitcnt lgkmcnt(6)
    v_mfma_f32_16x16x32_bf16 v[104:107], v[240:243], v[56:59], v[104:107]
    s_add_u32 s22, s24, 0x3a2000
    s_add_u32 m0, s20, 0x24400
    s_nop 0
    buffer_load_dwordx4 v3, s[4:7], s22 offen lds
    ds_read_b64_tr_b16 v[232:233], v4 offset:17152
    v_mfma_f32_16x16x32_bf16 v[108:111], v[240:243], v[60:63], v[108:111]
    ds_read_b64_tr_b16 v[234:235], v4 offset:18176
    s_waitcnt lgkmcnt(6)
    v_mfma_f32_16x16x32_bf16 v[112:115], v[244:247], v[56:59], v[112:115]
    ds_read_b64_tr_b16 v[236:237], v5 offset:17184
    v_mfma_f32_16x16x32_bf16 v[116:119], v[244:247], v[60:63], v[116:119]
    ds_read_b64_tr_b16 v[238:239], v5 offset:18208
    s_waitcnt lgkmcnt(6)
    v_mfma_f32_16x16x32_bf16 v[120:123], v[224:227], v[56:59], v[120:123]
    v_mfma_f32_16x16x32_bf16 v[124:127], v[224:227], v[60:63], v[124:127]
    s_waitcnt vmcnt(13)
    s_barrier
    ds_read_b64_tr_b16 v[240:241], v4 offset:32768
    ds_read_b64_tr_b16 v[242:243], v4 offset:33792
    s_waitcnt lgkmcnt(6)
    v_mfma_f32_16x16x32_bf16 v[128:131], v[228:231], v[56:59], v[128:131]
    ds_read_b64_tr_b16 v[244:245], v5 offset:32800
    s_mov_b32 s23, 0xe000
    buffer_load_dwordx4 v[48:51], v6, s[8:11], s23 offen offset:2048 sc1
    v_mfma_f32_16x16x32_bf16 v[132:135], v[228:231], v[60:63], v[132:135]
    ds_read_b64_tr_b16 v[246:247], v5 offset:33824
    s_waitcnt lgkmcnt(6)
    v_mfma_f32_16x16x32_bf16 v[136:139], v[232:235], v[56:59], v[136:139]
    ds_read_b64_tr_b16 v[224:225], v4 offset:33024
    v_mfma_f32_16x16x32_bf16 v[140:143], v[232:235], v[60:63], v[140:143]
    ds_read_b64_tr_b16 v[226:227], v4 offset:34048
    s_mov_b32 s23, 0x2e000
    buffer_load_dwordx4 v[52:55], v6, s[8:11], s23 offen offset:2048 sc1
    s_waitcnt lgkmcnt(6)
    v_mfma_f32_16x16x32_bf16 v[144:147], v[236:239], v[56:59], v[144:147]
    ds_read_b64_tr_b16 v[228:229], v5 offset:33056
    v_mfma_f32_16x16x32_bf16 v[148:151], v[236:239], v[60:63], v[148:151]
    ds_read_b64_tr_b16 v[230:231], v5 offset:34080
    s_waitcnt vmcnt(6)
    v_cmp_ne_u32 vcc, s28, v12
    s_cbranch_vccnz adaLN_cond__sliding_block_cached__moe_arch_mod__prompt_kernel_o220r
adaLN_cond__sliding_block_cached__moe_arch_mod__prompt_kernel_o220b:
    s_waitcnt lgkmcnt(6)
    v_mfma_f32_16x16x32_bf16 v[88:91], v[240:243], v[24:27], v[88:91]
    ds_read_b64_tr_b16 v[232:233], v4 offset:33280
    v_mfma_f32_16x16x32_bf16 v[92:95], v[240:243], v[28:31], v[92:95]
    s_add_u32 s22, s24, 0x30000
    s_add_u32 m0, s20, 0x10000
    s_nop 0
    buffer_load_dwordx4 v3, s[4:7], s22 offen lds
    ds_read_b64_tr_b16 v[234:235], v4 offset:34304
    s_waitcnt lgkmcnt(6)
    v_mfma_f32_16x16x32_bf16 v[96:99], v[244:247], v[24:27], v[96:99]
    ds_read_b64_tr_b16 v[236:237], v5 offset:33312
    v_mfma_f32_16x16x32_bf16 v[100:103], v[244:247], v[28:31], v[100:103]
    ds_read_b64_tr_b16 v[238:239], v5 offset:34336
    s_waitcnt lgkmcnt(6)
    v_mfma_f32_16x16x32_bf16 v[104:107], v[224:227], v[24:27], v[104:107]
    s_add_u32 s22, s24, 0x32000
    s_add_u32 m0, s20, 0x10400
    s_nop 0
    buffer_load_dwordx4 v3, s[4:7], s22 offen lds
    ds_read_b64_tr_b16 v[240:241], v4 offset:33536
    v_mfma_f32_16x16x32_bf16 v[108:111], v[224:227], v[28:31], v[108:111]
    ds_read_b64_tr_b16 v[242:243], v4 offset:34560
    s_waitcnt lgkmcnt(6)
    v_mfma_f32_16x16x32_bf16 v[112:115], v[228:231], v[24:27], v[112:115]
    ds_read_b64_tr_b16 v[244:245], v5 offset:33568
    v_mfma_f32_16x16x32_bf16 v[116:119], v[228:231], v[28:31], v[116:119]
    ds_read_b64_tr_b16 v[246:247], v5 offset:34592
    s_waitcnt lgkmcnt(6)
    v_mfma_f32_16x16x32_bf16 v[120:123], v[232:235], v[24:27], v[120:123]
    v_mfma_f32_16x16x32_bf16 v[124:127], v[232:235], v[28:31], v[124:127]
    s_barrier
    ds_read_b64_tr_b16 v[224:225], v4 offset:49152
    ds_read_b64_tr_b16 v[226:227], v4 offset:50176
    s_waitcnt lgkmcnt(6)
    v_mfma_f32_16x16x32_bf16 v[128:131], v[236:239], v[24:27], v[128:131]
    ds_read_b64_tr_b16 v[228:229], v5 offset:49184
    s_mov_b32 s23, 0x0
    buffer_load_dwordx4 v[56:59], v6, s[8:11], s23 offen offset:3072 sc1
    v_mfma_f32_16x16x32_bf16 v[132:135], v[236:239], v[28:31], v[132:135]
    ds_read_b64_tr_b16 v[230:231], v5 offset:50208
    s_waitcnt lgkmcnt(6)
    v_mfma_f32_16x16x32_bf16 v[136:139], v[240:243], v[24:27], v[136:139]
    ds_read_b64_tr_b16 v[232:233], v4 offset:49408
    v_mfma_f32_16x16x32_bf16 v[140:143], v[240:243], v[28:31], v[140:143]
    ds_read_b64_tr_b16 v[234:235], v4 offset:50432
    s_mov_b32 s23, 0x20000
    buffer_load_dwordx4 v[60:63], v6, s[8:11], s23 offen offset:3072 sc1
    s_waitcnt lgkmcnt(6)
    v_mfma_f32_16x16x32_bf16 v[144:147], v[244:247], v[24:27], v[144:147]
    ds_read_b64_tr_b16 v[236:237], v5 offset:49440
    v_mfma_f32_16x16x32_bf16 v[148:151], v[244:247], v[28:31], v[148:151]
    ds_read_b64_tr_b16 v[238:239], v5 offset:50464
    s_waitcnt lgkmcnt(6)
    v_mfma_f32_16x16x32_bf16 v[88:91], v[224:227], v[32:35], v[88:91]
    ds_read_b64_tr_b16 v[240:241], v4 offset:49664
    v_mfma_f32_16x16x32_bf16 v[92:95], v[224:227], v[36:39], v[92:95]
    s_add_u32 s22, s24, 0xb0000
    s_add_u32 m0, s20, 0x14000
    s_nop 0
    buffer_load_dwordx4 v3, s[4:7], s22 offen lds
    ds_read_b64_tr_b16 v[242:243], v4 offset:50688
    s_waitcnt lgkmcnt(6)
    v_mfma_f32_16x16x32_bf16 v[96:99], v[228:231], v[32:35], v[96:99]
    ds_read_b64_tr_b16 v[244:245], v5 offset:49696
    v_mfma_f32_16x16x32_bf16 v[100:103], v[228:231], v[36:39], v[100:103]
    ds_read_b64_tr_b16 v[246:247], v5 offset:50720
    s_waitcnt lgkmcnt(6)
    v_mfma_f32_16x16x32_bf16 v[104:107], v[232:235], v[32:35], v[104:107]
    s_add_u32 s22, s24, 0xb2000
    s_add_u32 m0, s20, 0x14400
    s_nop 0
    buffer_load_dwordx4 v3, s[4:7], s22 offen lds
    ds_read_b64_tr_b16 v[224:225], v4 offset:49920
    v_mfma_f32_16x16x32_bf16 v[108:111], v[232:235], v[36:39], v[108:111]
    ds_read_b64_tr_b16 v[226:227], v4 offset:50944
    s_waitcnt lgkmcnt(6)
    v_mfma_f32_16x16x32_bf16 v[112:115], v[236:239], v[32:35], v[112:115]
    ds_read_b64_tr_b16 v[228:229], v5 offset:49952
    v_mfma_f32_16x16x32_bf16 v[116:119], v[236:239], v[36:39], v[116:119]
    ds_read_b64_tr_b16 v[230:231], v5 offset:50976
    s_waitcnt lgkmcnt(6)
    v_mfma_f32_16x16x32_bf16 v[120:123], v[240:243], v[32:35], v[120:123]
    v_mfma_f32_16x16x32_bf16 v[124:127], v[240:243], v[36:39], v[124:127]
    s_barrier
    ds_read_b64_tr_b16 v[232:233], v7 offset:0
    ds_read_b64_tr_b16 v[234:235], v7 offset:1024
    s_waitcnt lgkmcnt(6)
    v_mfma_f32_16x16x32_bf16 v[128:131], v[244:247], v[32:35], v[128:131]
    ds_read_b64_tr_b16 v[236:237], v8 offset:32
    s_mov_b32 s23, 0x2000
    buffer_load_dwordx4 v[24:27], v6, s[8:11], s23 offen offset:3072 sc1
    v_mfma_f32_16x16x32_bf16 v[132:135], v[244:247], v[36:39], v[132:135]
    ds_read_b64_tr_b16 v[238:239], v8 offset:1056
    s_waitcnt lgkmcnt(6)
    v_mfma_f32_16x16x32_bf16 v[136:139], v[224:227], v[32:35], v[136:139]
    ds_read_b64_tr_b16 v[240:241], v7 offset:256
    v_mfma_f32_16x16x32_bf16 v[140:143], v[224:227], v[36:39], v[140:143]
    ds_read_b64_tr_b16 v[242:243], v7 offset:1280
    s_mov_b32 s23, 0x22000
    buffer_load_dwordx4 v[28:31], v6, s[8:11], s23 offen offset:3072 sc1
    s_waitcnt lgkmcnt(6)
    v_mfma_f32_16x16x32_bf16 v[144:147], v[228:231], v[32:35], v[144:147]
    ds_read_b64_tr_b16 v[244:245], v8 offset:288
    v_mfma_f32_16x16x32_bf16 v[148:151], v[228:231], v[36:39], v[148:151]
    ds_read_b64_tr_b16 v[246:247], v8 offset:1312
    s_waitcnt vmcnt(13) lgkmcnt(6)
    v_mfma_f32_16x16x32_bf16 v[88:91], v[232:235], v[40:43], v[88:91]
    ds_read_b64_tr_b16 v[224:225], v7 offset:512
    s_waitcnt vmcnt(12)
    v_mfma_f32_16x16x32_bf16 v[92:95], v[232:235], v[44:47], v[92:95]
    s_add_u32 s22, s24, 0x130000
    s_add_u32 m0, s20, 0x18000
    s_nop 0
    buffer_load_dwordx4 v3, s[4:7], s22 offen lds
    ds_read_b64_tr_b16 v[226:227], v7 offset:1536
    s_waitcnt lgkmcnt(6)
    v_mfma_f32_16x16x32_bf16 v[96:99], v[236:239], v[40:43], v[96:99]
    ds_read_b64_tr_b16 v[228:229], v8 offset:544
    v_mfma_f32_16x16x32_bf16 v[100:103], v[236:239], v[44:47], v[100:103]
    ds_read_b64_tr_b16 v[230:231], v8 offset:1568
    s_waitcnt lgkmcnt(6)
    v_mfma_f32_16x16x32_bf16 v[104:107], v[240:243], v[40:43], v[104:107]
    s_add_u32 s22, s24, 0x132000
    s_add_u32 m0, s20, 0x18400
    s_nop 0
    buffer_load_dwordx4 v3, s[4:7], s22 offen lds
    ds_read_b64_tr_b16 v[232:233], v7 offset:768
    v_mfma_f32_16x16x32_bf16 v[108:111], v[240:243], v[44:47], v[108:111]
    ds_read_b64_tr_b16 v[234:235], v7 offset:1792
    s_waitcnt lgkmcnt(6)
    v_mfma_f32_16x16x32_bf16 v[112:115], v[244:247], v[40:43], v[112:115]
    ds_read_b64_tr_b16 v[236:237], v8 offset:800
    v_mfma_f32_16x16x32_bf16 v[116:119], v[244:247], v[44:47], v[116:119]
    ds_read_b64_tr_b16 v[238:239], v8 offset:1824
    s_waitcnt lgkmcnt(6)
    v_mfma_f32_16x16x32_bf16 v[120:123], v[224:227], v[40:43], v[120:123]
    v_mfma_f32_16x16x32_bf16 v[124:127], v[224:227], v[44:47], v[124:127]
    s_waitcnt vmcnt(12)
    s_barrier
    ds_read_b64_tr_b16 v[240:241], v7 offset:16384
    ds_read_b64_tr_b16 v[242:243], v7 offset:17408
    s_waitcnt lgkmcnt(6)
    v_mfma_f32_16x16x32_bf16 v[128:131], v[228:231], v[40:43], v[128:131]
    ds_read_b64_tr_b16 v[244:245], v8 offset:16416
    s_mov_b32 s23, 0x4000
    buffer_load_dwordx4 v[32:35], v6, s[8:11], s23 offen offset:3072 sc1
    v_mfma_f32_16x16x32_bf16 v[132:135], v[228:231], v[44:47], v[132:135]
    ds_read_b64_tr_b16 v[246:247], v8 offset:17440
    s_waitcnt lgkmcnt(6)
    v_mfma_f32_16x16x32_bf16 v[136:139], v[232:235], v[40:43], v[136:139]
    ds_read_b64_tr_b16 v[224:225], v7 offset:16640
    v_mfma_f32_16x16x32_bf16 v[140:143], v[232:235], v[44:47], v[140:143]
    ds_read_b64_tr_b16 v[226:227], v7 offset:17664
    s_mov_b32 s23, 0x24000
    buffer_load_dwordx4 v[36:39], v6, s[8:11], s23 offen offset:3072 sc1
    s_waitcnt lgkmcnt(6)
    v_mfma_f32_16x16x32_bf16 v[144:147], v[236:239], v[40:43], v[144:147]
    ds_read_b64_tr_b16 v[228:229], v8 offset:16672
    v_mfma_f32_16x16x32_bf16 v[148:151], v[236:239], v[44:47], v[148:151]
    ds_read_b64_tr_b16 v[230:231], v8 offset:17696
    s_waitcnt vmcnt(13) lgkmcnt(6)
    v_mfma_f32_16x16x32_bf16 v[88:91], v[240:243], v[48:51], v[88:91]
    ds_read_b64_tr_b16 v[232:233], v7 offset:16896
    s_waitcnt vmcnt(12)
    v_mfma_f32_16x16x32_bf16 v[92:95], v[240:243], v[52:55], v[92:95]
    s_add_u32 s22, s24, 0x1b0000
    s_add_u32 m0, s20, 0x1c000
    s_nop 0
    buffer_load_dwordx4 v3, s[4:7], s22 offen lds
    ds_read_b64_tr_b16 v[234:235], v7 offset:17920
    s_waitcnt lgkmcnt(6)
    v_mfma_f32_16x16x32_bf16 v[96:99], v[244:247], v[48:51], v[96:99]
    ds_read_b64_tr_b16 v[236:237], v8 offset:16928
    v_mfma_f32_16x16x32_bf16 v[100:103], v[244:247], v[52:55], v[100:103]
    ds_read_b64_tr_b16 v[238:239], v8 offset:17952
    s_waitcnt lgkmcnt(6)
    v_mfma_f32_16x16x32_bf16 v[104:107], v[224:227], v[48:51], v[104:107]
    s_add_u32 s22, s24, 0x1b2000
    s_add_u32 m0, s20, 0x1c400
    s_nop 0
    buffer_load_dwordx4 v3, s[4:7], s22 offen lds
    ds_read_b64_tr_b16 v[240:241], v7 offset:17152
    v_mfma_f32_16x16x32_bf16 v[108:111], v[224:227], v[52:55], v[108:111]
    ds_read_b64_tr_b16 v[242:243], v7 offset:18176
    s_waitcnt lgkmcnt(6)
    v_mfma_f32_16x16x32_bf16 v[112:115], v[228:231], v[48:51], v[112:115]
    ds_read_b64_tr_b16 v[244:245], v8 offset:17184
    v_mfma_f32_16x16x32_bf16 v[116:119], v[228:231], v[52:55], v[116:119]
    ds_read_b64_tr_b16 v[246:247], v8 offset:18208
    s_waitcnt lgkmcnt(6)
    v_mfma_f32_16x16x32_bf16 v[120:123], v[232:235], v[48:51], v[120:123]
    v_mfma_f32_16x16x32_bf16 v[124:127], v[232:235], v[52:55], v[124:127]
    s_waitcnt vmcnt(12)
    s_barrier
    ds_read_b64_tr_b16 v[224:225], v4 offset:0
    ds_read_b64_tr_b16 v[226:227], v4 offset:1024
    s_waitcnt lgkmcnt(6)
    v_mfma_f32_16x16x32_bf16 v[128:131], v[236:239], v[48:51], v[128:131]
    ds_read_b64_tr_b16 v[228:229], v5 offset:32
    s_mov_b32 s23, 0x6000
    buffer_load_dwordx4 v[40:43], v6, s[8:11], s23 offen offset:3072 sc1
    v_mfma_f32_16x16x32_bf16 v[132:135], v[236:239], v[52:55], v[132:135]
    ds_read_b64_tr_b16 v[230:231], v5 offset:1056
    s_waitcnt lgkmcnt(6)
    v_mfma_f32_16x16x32_bf16 v[136:139], v[240:243], v[48:51], v[136:139]
    ds_read_b64_tr_b16 v[232:233], v4 offset:256
    v_mfma_f32_16x16x32_bf16 v[140:143], v[240:243], v[52:55], v[140:143]
    ds_read_b64_tr_b16 v[234:235], v4 offset:1280
    s_mov_b32 s23, 0x26000
    buffer_load_dwordx4 v[44:47], v6, s[8:11], s23 offen offset:3072 sc1
    s_waitcnt lgkmcnt(6)
    v_mfma_f32_16x16x32_bf16 v[144:147], v[244:247], v[48:51], v[144:147]
    ds_read_b64_tr_b16 v[236:237], v5 offset:288
    v_mfma_f32_16x16x32_bf16 v[148:151], v[244:247], v[52:55], v[148:151]
    ds_read_b64_tr_b16 v[238:239], v5 offset:1312
    s_waitcnt vmcnt(13) lgkmcnt(6)
    v_mfma_f32_16x16x32_bf16 v[88:91], v[224:227], v[56:59], v[88:91]
    ds_read_b64_tr_b16 v[240:241], v4 offset:512
    s_waitcnt vmcnt(12)
    v_mfma_f32_16x16x32_bf16 v[92:95], v[224:227], v[60:63], v[92:95]
    s_add_u32 s22, s24, 0x230000
    s_add_u32 m0, s20, 0x20000
    s_nop 0
    buffer_load_dwordx4 v3, s[4:7], s22 offen lds
    ds_read_b64_tr_b16 v[242:243], v4 offset:1536
    s_waitcnt lgkmcnt(6)
    v_mfma_f32_16x16x32_bf16 v[96:99], v[228:231], v[56:59], v[96:99]
    ds_read_b64_tr_b16 v[244:245], v5 offset:544
    v_mfma_f32_16x16x32_bf16 v[100:103], v[228:231], v[60:63], v[100:103]
    ds_read_b64_tr_b16 v[246:247], v5 offset:1568
    s_waitcnt lgkmcnt(6)
    v_mfma_f32_16x16x32_bf16 v[104:107], v[232:235], v[56:59], v[104:107]
    s_add_u32 s22, s24, 0x232000
    s_add_u32 m0, s20, 0x20400
    s_nop 0
    buffer_load_dwordx4 v3, s[4:7], s22 offen lds
    ds_read_b64_tr_b16 v[224:225], v4 offset:768
    v_mfma_f32_16x16x32_bf16 v[108:111], v[232:235], v[60:63], v[108:111]
    ds_read_b64_tr_b16 v[226:227], v4 offset:1792
    s_waitcnt lgkmcnt(6)
    v_mfma_f32_16x16x32_bf16 v[112:115], v[236:239], v[56:59], v[112:115]
    ds_read_b64_tr_b16 v[228:229], v5 offset:800
    v_mfma_f32_16x16x32_bf16 v[116:119], v[236:239], v[60:63], v[116:119]
    ds_read_b64_tr_b16 v[230:231], v5 offset:1824
    s_waitcnt lgkmcnt(6)
    v_mfma_f32_16x16x32_bf16 v[120:123], v[240:243], v[56:59], v[120:123]
    v_mfma_f32_16x16x32_bf16 v[124:127], v[240:243], v[60:63], v[124:127]
    s_waitcnt vmcnt(12)
    s_barrier
    ds_read_b64_tr_b16 v[232:233], v4 offset:16384
    ds_read_b64_tr_b16 v[234:235], v4 offset:17408
    s_waitcnt lgkmcnt(6)
    v_mfma_f32_16x16x32_bf16 v[128:131], v[244:247], v[56:59], v[128:131]
    ds_read_b64_tr_b16 v[236:237], v5 offset:16416
    s_mov_b32 s23, 0x8000
    buffer_load_dwordx4 v[48:51], v6, s[8:11], s23 offen offset:3072 sc1
    v_mfma_f32_16x16x32_bf16 v[132:135], v[244:247], v[60:63], v[132:135]
    ds_read_b64_tr_b16 v[238:239], v5 offset:17440
    s_waitcnt lgkmcnt(6)
    v_mfma_f32_16x16x32_bf16 v[136:139], v[224:227], v[56:59], v[136:139]
    ds_read_b64_tr_b16 v[240:241], v4 offset:16640
    v_mfma_f32_16x16x32_bf16 v[140:143], v[224:227], v[60:63], v[140:143]
    ds_read_b64_tr_b16 v[242:243], v4 offset:17664
    s_mov_b32 s23, 0x28000
    buffer_load_dwordx4 v[52:55], v6, s[8:11], s23 offen offset:3072 sc1
    s_waitcnt lgkmcnt(6)
    v_mfma_f32_16x16x32_bf16 v[144:147], v[228:231], v[56:59], v[144:147]
    ds_read_b64_tr_b16 v[244:245], v5 offset:16672
    v_mfma_f32_16x16x32_bf16 v[148:151], v[228:231], v[60:63], v[148:151]
    ds_read_b64_tr_b16 v[246:247], v5 offset:17696
    s_waitcnt vmcnt(13) lgkmcnt(6)
    v_mfma_f32_16x16x32_bf16 v[88:91], v[232:235], v[24:27], v[88:91]
    ds_read_b64_tr_b16 v[224:225], v4 offset:16896
    s_waitcnt vmcnt(12)
    v_mfma_f32_16x16x32_bf16 v[92:95], v[232:235], v[28:31], v[92:95]
    s_add_u32 s22, s24, 0x2b0000
    s_add_u32 m0, s20, 0x24000
    s_nop 0
    buffer_load_dwordx4 v3, s[4:7], s22 offen lds
    ds_read_b64_tr_b16 v[226:227], v4 offset:17920
    s_waitcnt lgkmcnt(6)
    v_mfma_f32_16x16x32_bf16 v[96:99], v[236:239], v[24:27], v[96:99]
    ds_read_b64_tr_b16 v[228:229], v5 offset:16928
    v_mfma_f32_16x16x32_bf16 v[100:103], v[236:239], v[28:31], v[100:103]
    ds_read_b64_tr_b16 v[230:231], v5 offset:17952
    s_waitcnt lgkmcnt(6)
    v_mfma_f32_16x16x32_bf16 v[104:107], v[240:243], v[24:27], v[104:107]
    s_add_u32 s22, s24, 0x2b2000
    s_add_u32 m0, s20, 0x24400
    s_nop 0
    buffer_load_dwordx4 v3, s[4:7], s22 offen lds
    ds_read_b64_tr_b16 v[232:233], v4 offset:17152
    v_mfma_f32_16x16x32_bf16 v[108:111], v[240:243], v[28:31], v[108:111]
    ds_read_b64_tr_b16 v[234:235], v4 offset:18176
    s_mov_b32 s16, 0x544000
    buffer_load_dwordx4 v[184:187], v2, s[8:11], s16 offen sc1
    s_waitcnt lgkmcnt(6)
    v_mfma_f32_16x16x32_bf16 v[112:115], v[244:247], v[24:27], v[112:115]
    ds_read_b64_tr_b16 v[236:237], v5 offset:17184
    v_mfma_f32_16x16x32_bf16 v[116:119], v[244:247], v[28:31], v[116:119]
    ds_read_b64_tr_b16 v[238:239], v5 offset:18208
    s_waitcnt lgkmcnt(6)
    v_mfma_f32_16x16x32_bf16 v[120:123], v[224:227], v[24:27], v[120:123]
    v_mfma_f32_16x16x32_bf16 v[124:127], v[224:227], v[28:31], v[124:127]
    s_waitcnt vmcnt(13)
    s_barrier
    ds_read_b64_tr_b16 v[240:241], v4 offset:32768
    ds_read_b64_tr_b16 v[242:243], v4 offset:33792
    s_waitcnt lgkmcnt(6)
    v_mfma_f32_16x16x32_bf16 v[128:131], v[228:231], v[24:27], v[128:131]
    ds_read_b64_tr_b16 v[244:245], v5 offset:32800
    s_mov_b32 s23, 0xa000
    buffer_load_dwordx4 v[56:59], v6, s[8:11], s23 offen offset:3072 sc1
    v_mfma_f32_16x16x32_bf16 v[132:135], v[228:231], v[28:31], v[132:135]
    ds_read_b64_tr_b16 v[246:247], v5 offset:33824
    s_waitcnt lgkmcnt(6)
    v_mfma_f32_16x16x32_bf16 v[136:139], v[232:235], v[24:27], v[136:139]
    ds_read_b64_tr_b16 v[224:225], v4 offset:33024
    v_mfma_f32_16x16x32_bf16 v[140:143], v[232:235], v[28:31], v[140:143]
    ds_read_b64_tr_b16 v[226:227], v4 offset:34048
    s_mov_b32 s23, 0x2a000
    buffer_load_dwordx4 v[60:63], v6, s[8:11], s23 offen offset:3072 sc1
    s_waitcnt lgkmcnt(6)
    v_mfma_f32_16x16x32_bf16 v[144:147], v[236:239], v[24:27], v[144:147]
    ds_read_b64_tr_b16 v[228:229], v5 offset:33056
    v_mfma_f32_16x16x32_bf16 v[148:151], v[236:239], v[28:31], v[148:151]
    ds_read_b64_tr_b16 v[230:231], v5 offset:34080
    s_waitcnt vmcnt(14) lgkmcnt(6)
    v_mfma_f32_16x16x32_bf16 v[88:91], v[240:243], v[32:35], v[88:91]
    ds_read_b64_tr_b16 v[232:233], v4 offset:33280
    s_waitcnt vmcnt(13)
    v_mfma_f32_16x16x32_bf16 v[92:95], v[240:243], v[36:39], v[92:95]
    s_add_u32 s22, s24, 0x330000
    s_add_u32 m0, s20, 0x10000
    s_nop 0
    buffer_load_dwordx4 v3, s[4:7], s22 offen lds
    ds_read_b64_tr_b16 v[234:235], v4 offset:34304
    s_waitcnt lgkmcnt(6)
    v_mfma_f32_16x16x32_bf16 v[96:99], v[244:247], v[32:35], v[96:99]
    ds_read_b64_tr_b16 v[236:237], v5 offset:33312
    v_mfma_f32_16x16x32_bf16 v[100:103], v[244:247], v[36:39], v[100:103]
    ds_read_b64_tr_b16 v[238:239], v5 offset:34336
    s_waitcnt lgkmcnt(6)
    v_mfma_f32_16x16x32_bf16 v[104:107], v[224:227], v[32:35], v[104:107]
    s_add_u32 s22, s24, 0x332000
    s_add_u32 m0, s20, 0x10400
    s_nop 0
    buffer_load_dwordx4 v3, s[4:7], s22 offen lds
    ds_read_b64_tr_b16 v[240:241], v4 offset:33536
    v_mfma_f32_16x16x32_bf16 v[108:111], v[224:227], v[36:39], v[108:111]
    ds_read_b64_tr_b16 v[242:243], v4 offset:34560
    s_waitcnt vmcnt(4)
    v_xor_b32 v16, s28, v184
    v_xor_b32 v17, s28, v185
    v_xor_b32 v18, s28, v186
    v_xor_b32 v19, s28, v187
    v_or3_b32 v16, v16, v17, v18
    v_or_b32 v16, v16, v19
    v_cmp_ne_u32 vcc, 0, v16
    s_cbranch_vccnz adaLN_cond__sliding_block_cached__moe_arch_mod__prompt_kernel_mf21r
adaLN_cond__sliding_block_cached__moe_arch_mod__prompt_kernel_mf21b:
    s_waitcnt lgkmcnt(6)
    v_mfma_f32_16x16x32_bf16 v[112:115], v[228:231], v[32:35], v[112:115]
    ds_read_b64_tr_b16 v[244:245], v5 offset:33568
    v_mfma_f32_16x16x32_bf16 v[116:119], v[228:231], v[36:39], v[116:119]
    ds_read_b64_tr_b16 v[246:247], v5 offset:34592
    s_waitcnt lgkmcnt(6)
    v_mfma_f32_16x16x32_bf16 v[120:123], v[232:235], v[32:35], v[120:123]
    v_mfma_f32_16x16x32_bf16 v[124:127], v[232:235], v[36:39], v[124:127]
    s_barrier
    ds_read_b64_tr_b16 v[224:225], v4 offset:49152
    ds_read_b64_tr_b16 v[226:227], v4 offset:50176
    s_waitcnt lgkmcnt(6)
    v_mfma_f32_16x16x32_bf16 v[128:131], v[236:239], v[32:35], v[128:131]
    ds_read_b64_tr_b16 v[228:229], v5 offset:49184
    s_mov_b32 s23, 0xc000
    buffer_load_dwordx4 v[24:27], v6, s[8:11], s23 offen offset:3072 sc1
    v_mfma_f32_16x16x32_bf16 v[132:135], v[236:239], v[36:39], v[132:135]
    ds_read_b64_tr_b16 v[230:231], v5 offset:50208
    s_waitcnt lgkmcnt(6)
    v_mfma_f32_16x16x32_bf16 v[136:139], v[240:243], v[32:35], v[136:139]
    ds_read_b64_tr_b16 v[232:233], v4 offset:49408
    v_mfma_f32_16x16x32_bf16 v[140:143], v[240:243], v[36:39], v[140:143]
    ds_read_b64_tr_b16 v[234:235], v4 offset:50432
    s_mov_b32 s23, 0x2c000
    buffer_load_dwordx4 v[28:31], v6, s[8:11], s23 offen offset:3072 sc1
    s_waitcnt lgkmcnt(6)
    v_mfma_f32_16x16x32_bf16 v[144:147], v[244:247], v[32:35], v[144:147]
    ds_read_b64_tr_b16 v[236:237], v5 offset:49440
    v_mfma_f32_16x16x32_bf16 v[148:151], v[244:247], v[36:39], v[148:151]
    ds_read_b64_tr_b16 v[238:239], v5 offset:50464
    s_waitcnt lgkmcnt(6)
    v_mfma_f32_16x16x32_bf16 v[88:91], v[224:227], v[40:43], v[88:91]
    ds_read_b64_tr_b16 v[240:241], v4 offset:49664
    v_mfma_f32_16x16x32_bf16 v[92:95], v[224:227], v[44:47], v[92:95]
    s_add_u32 s22, s24, 0x3b0000
    s_add_u32 m0, s20, 0x14000
    s_nop 0
    buffer_load_dwordx4 v3, s[4:7], s22 offen lds
    ds_read_b64_tr_b16 v[242:243], v4 offset:50688
    s_waitcnt lgkmcnt(6)
    v_mfma_f32_16x16x32_bf16 v[96:99], v[228:231], v[40:43], v[96:99]
    ds_read_b64_tr_b16 v[244:245], v5 offset:49696
    v_mfma_f32_16x16x32_bf16 v[100:103], v[228:231], v[44:47], v[100:103]
    ds_read_b64_tr_b16 v[246:247], v5 offset:50720
    s_waitcnt lgkmcnt(6)
    v_mfma_f32_16x16x32_bf16 v[104:107], v[232:235], v[40:43], v[104:107]
    s_add_u32 s22, s24, 0x3b2000
    s_add_u32 m0, s20, 0x14400
    s_nop 0
    buffer_load_dwordx4 v3, s[4:7], s22 offen lds
    ds_read_b64_tr_b16 v[224:225], v4 offset:49920
    v_mfma_f32_16x16x32_bf16 v[108:111], v[232:235], v[44:47], v[108:111]
    ds_read_b64_tr_b16 v[226:227], v4 offset:50944
    v_lshrrev_b32 v16, 4, v1
    v_lshlrev_b32 v16, 3, v16
    s_lshl_b32 s16, s31, 8
    s_add_u32 s16, s16, 0x540080
    buffer_load_dwordx2 v[248:249], v16, s[8:11], s16 offen offset:0 sc1
    buffer_load_dwordx2 v[250:251], v16, s[8:11], s16 offen offset:32 sc1
    buffer_load_dwordx2 v[252:253], v16, s[8:11], s16 offen offset:64 sc1
    buffer_load_dwordx2 v[254:255], v16, s[8:11], s16 offen offset:96 sc1
    s_waitcnt lgkmcnt(6)
    v_mfma_f32_16x16x32_bf16 v[112:115], v[236:239], v[40:43], v[112:115]
    ds_read_b64_tr_b16 v[228:229], v5 offset:49952
    v_mfma_f32_16x16x32_bf16 v[116:119], v[236:239], v[44:47], v[116:119]
    ds_read_b64_tr_b16 v[230:231], v5 offset:50976
    s_waitcnt lgkmcnt(6)
    v_mfma_f32_16x16x32_bf16 v[120:123], v[240:243], v[40:43], v[120:123]
    v_mfma_f32_16x16x32_bf16 v[124:127], v[240:243], v[44:47], v[124:127]
    s_barrier
    ds_read_b64_tr_b16 v[232:233], v7 offset:0
    ds_read_b64_tr_b16 v[234:235], v7 offset:1024
    s_waitcnt lgkmcnt(6)
    v_mfma_f32_16x16x32_bf16 v[128:131], v[244:247], v[40:43], v[128:131]
    ds_read_b64_tr_b16 v[236:237], v8 offset:32
    s_mov_b32 s23, 0xe000
    buffer_load_dwordx4 v[32:35], v6, s[8:11], s23 offen offset:3072 sc1
    v_mfma_f32_16x16x32_bf16 v[132:135], v[244:247], v[44:47], v[132:135]
    ds_read_b64_tr_b16 v[238:239], v8 offset:1056
    s_waitcnt lgkmcnt(6)
    v_mfma_f32_16x16x32_bf16 v[136:139], v[224:227], v[40:43], v[136:139]
    ds_read_b64_tr_b16 v[240:241], v7 offset:256
    v_mfma_f32_16x16x32_bf16 v[140:143], v[224:227], v[44:47], v[140:143]
    ds_read_b64_tr_b16 v[242:243], v7 offset:1280
    s_mov_b32 s23, 0x2e000
    buffer_load_dwordx4 v[36:39], v6, s[8:11], s23 offen offset:3072 sc1
    s_waitcnt lgkmcnt(6)
    v_mfma_f32_16x16x32_bf16 v[144:147], v[228:231], v[40:43], v[144:147]
    ds_read_b64_tr_b16 v[244:245], v8 offset:288
    v_mfma_f32_16x16x32_bf16 v[148:151], v[228:231], v[44:47], v[148:151]
    ds_read_b64_tr_b16 v[246:247], v8 offset:1312
    s_waitcnt lgkmcnt(6)
    v_mfma_f32_16x16x32_bf16 v[88:91], v[232:235], v[48:51], v[88:91]
    ds_read_b64_tr_b16 v[224:225], v7 offset:512
    v_mfma_f32_16x16x32_bf16 v[92:95], v[232:235], v[52:55], v[92:95]
    ds_read_b64_tr_b16 v[226:227], v7 offset:1536
    s_waitcnt lgkmcnt(6)
    v_mfma_f32_16x16x32_bf16 v[96:99], v[236:239], v[48:51], v[96:99]
    ds_read_b64_tr_b16 v[228:229], v8 offset:544
    v_mfma_f32_16x16x32_bf16 v[100:103], v[236:239], v[52:55], v[100:103]
    ds_read_b64_tr_b16 v[230:231], v8 offset:1568
    s_waitcnt lgkmcnt(6)
    v_mfma_f32_16x16x32_bf16 v[104:107], v[240:243], v[48:51], v[104:107]
    ds_read_b64_tr_b16 v[232:233], v7 offset:768
    v_mfma_f32_16x16x32_bf16 v[108:111], v[240:243], v[52:55], v[108:111]
    ds_read_b64_tr_b16 v[234:235], v7 offset:1792
    s_waitcnt lgkmcnt(6)
    v_mfma_f32_16x16x32_bf16 v[112:115], v[244:247], v[48:51], v[112:115]
    ds_read_b64_tr_b16 v[236:237], v8 offset:800
    v_mfma_f32_16x16x32_bf16 v[116:119], v[244:247], v[52:55], v[116:119]
    ds_read_b64_tr_b16 v[238:239], v8 offset:1824
    s_waitcnt lgkmcnt(6)
    v_mfma_f32_16x16x32_bf16 v[120:123], v[224:227], v[48:51], v[120:123]
    s_mov_b64 s[72:73], s[48:49]
    s_mov_b32 s74, 0x700000
    s_mov_b32 s75, 0x20000
    s_cmp_lt_u32 s2, 224
    s_cselect_b32 s74, 7340032, 0
    s_and_b32 s16, s3, 3
    v_lshrrev_b32 v20, 3, v1
    v_lshlrev_b32 v20, 3, v20
    s_lshl_b32 s17, s16, 6
    v_add_u32 v20, s17, v20
    s_mov_b32 s17, 7168
    v_mul_lo_u32 v21, s17, v20
    v_and_b32 v20, 7, v1
    v_lshl_add_u32 v21, v20, 4, v21
    s_and_b32 s17, s29, 3
    s_mul_i32 s18, s17, 1835008
    s_lshr_b32 s17, s29, 2
    s_lshl_b32 s17, s17, 7
    s_add_u32 s18, s18, s17
    s_lshl_b32 s16, s16, 13
    s_add_u32 s22, s18, 0
    s_add_u32 m0, s16, 32768
    s_nop 0
    buffer_load_dwordx4 v21, s[72:75], s22 offen lds
    s_add_u32 s22, s18, 7168
    s_add_u32 m0, s16, 33792
    s_nop 0
    buffer_load_dwordx4 v21, s[72:75], s22 offen lds
    s_add_u32 s22, s18, 14336
    s_add_u32 m0, s16, 34816
    s_nop 0
    buffer_load_dwordx4 v21, s[72:75], s22 offen lds
    s_add_u32 s22, s18, 21504
    s_add_u32 m0, s16, 35840
    s_nop 0
    buffer_load_dwordx4 v21, s[72:75], s22 offen lds
    s_add_u32 s22, s18, 28672
    s_add_u32 m0, s16, 36864
    s_nop 0
    buffer_load_dwordx4 v21, s[72:75], s22 offen lds
    s_add_u32 s22, s18, 35840
    s_add_u32 m0, s16, 37888
    s_nop 0
    buffer_load_dwordx4 v21, s[72:75], s22 offen lds
    s_add_u32 s22, s18, 43008
    s_add_u32 m0, s16, 38912
    s_nop 0
    buffer_load_dwordx4 v21, s[72:75], s22 offen lds
    s_add_u32 s22, s18, 50176
    s_add_u32 m0, s16, 39936
    s_nop 0
    buffer_load_dwordx4 v21, s[72:75], s22 offen lds
    v_mfma_f32_16x16x32_bf16 v[124:127], v[224:227], v[52:55], v[124:127]
    s_barrier
    ds_read_b64_tr_b16 v[240:241], v7 offset:16384
    ds_read_b64_tr_b16 v[242:243], v7 offset:17408
    s_waitcnt lgkmcnt(6)
    v_mfma_f32_16x16x32_bf16 v[128:131], v[228:231], v[48:51], v[128:131]
    ds_read_b64_tr_b16 v[244:245], v8 offset:16416
    v_mfma_f32_16x16x32_bf16 v[132:135], v[228:231], v[52:55], v[132:135]
    ds_read_b64_tr_b16 v[246:247], v8 offset:17440
    s_waitcnt lgkmcnt(6)
    v_mfma_f32_16x16x32_bf16 v[136:139], v[232:235], v[48:51], v[136:139]
    ds_read_b64_tr_b16 v[224:225], v7 offset:16640
    v_mfma_f32_16x16x32_bf16 v[140:143], v[232:235], v[52:55], v[140:143]
    ds_read_b64_tr_b16 v[226:227], v7 offset:17664
    s_waitcnt lgkmcnt(6)
    v_mfma_f32_16x16x32_bf16 v[144:147], v[236:239], v[48:51], v[144:147]
    ds_read_b64_tr_b16 v[228:229], v8 offset:16672
    v_mfma_f32_16x16x32_bf16 v[148:151], v[236:239], v[52:55], v[148:151]
    ds_read_b64_tr_b16 v[230:231], v8 offset:17696
    s_waitcnt vmcnt(21) lgkmcnt(6)
    v_mfma_f32_16x16x32_bf16 v[88:91], v[240:243], v[56:59], v[88:91]
    ds_read_b64_tr_b16 v[232:233], v7 offset:16896
    s_waitcnt vmcnt(20)
    v_mfma_f32_16x16x32_bf16 v[92:95], v[240:243], v[60:63], v[92:95]
    ds_read_b64_tr_b16 v[234:235], v7 offset:17920
    s_waitcnt lgkmcnt(6)
    v_mfma_f32_16x16x32_bf16 v[96:99], v[244:247], v[56:59], v[96:99]
    ds_read_b64_tr_b16 v[236:237], v8 offset:16928
    v_mfma_f32_16x16x32_bf16 v[100:103], v[244:247], v[60:63], v[100:103]
    ds_read_b64_tr_b16 v[238:239], v8 offset:17952
    s_waitcnt lgkmcnt(6)
    v_mfma_f32_16x16x32_bf16 v[104:107], v[224:227], v[56:59], v[104:107]
    ds_read_b64_tr_b16 v[240:241], v7 offset:17152
    v_mfma_f32_16x16x32_bf16 v[108:111], v[224:227], v[60:63], v[108:111]
    ds_read_b64_tr_b16 v[242:243], v7 offset:18176
    s_waitcnt lgkmcnt(6)
    v_mfma_f32_16x16x32_bf16 v[112:115], v[228:231], v[56:59], v[112:115]
    ds_read_b64_tr_b16 v[244:245], v8 offset:17184
    v_mfma_f32_16x16x32_bf16 v[116:119], v[228:231], v[60:63], v[116:119]
    ds_read_b64_tr_b16 v[246:247], v8 offset:18208
    s_waitcnt lgkmcnt(6)
    v_mfma_f32_16x16x32_bf16 v[120:123], v[232:235], v[56:59], v[120:123]
    v_mfma_f32_16x16x32_bf16 v[124:127], v[232:235], v[60:63], v[124:127]
    s_waitcnt vmcnt(18)
    s_barrier
    ds_read_b64_tr_b16 v[224:225], v4 offset:0
    ds_read_b64_tr_b16 v[226:227], v4 offset:1024
    s_waitcnt lgkmcnt(6)
    v_mfma_f32_16x16x32_bf16 v[128:131], v[236:239], v[56:59], v[128:131]
    ds_read_b64_tr_b16 v[228:229], v5 offset:32
    v_mfma_f32_16x16x32_bf16 v[132:135], v[236:239], v[60:63], v[132:135]
    ds_read_b64_tr_b16 v[230:231], v5 offset:1056
    s_waitcnt lgkmcnt(6)
    v_mfma_f32_16x16x32_bf16 v[136:139], v[240:243], v[56:59], v[136:139]
    ds_read_b64_tr_b16 v[232:233], v4 offset:256
    v_mfma_f32_16x16x32_bf16 v[140:143], v[240:243], v[60:63], v[140:143]
    ds_read_b64_tr_b16 v[234:235], v4 offset:1280
    s_waitcnt lgkmcnt(6)
    v_mfma_f32_16x16x32_bf16 v[144:147], v[244:247], v[56:59], v[144:147]
    ds_read_b64_tr_b16 v[236:237], v5 offset:288
    v_mfma_f32_16x16x32_bf16 v[148:151], v[244:247], v[60:63], v[148:151]
    ds_read_b64_tr_b16 v[238:239], v5 offset:1312
    s_waitcnt vmcnt(17) lgkmcnt(6)
    v_mfma_f32_16x16x32_bf16 v[88:91], v[224:227], v[24:27], v[88:91]
    ds_read_b64_tr_b16 v[240:241], v4 offset:512
    s_waitcnt vmcnt(16)
    v_mfma_f32_16x16x32_bf16 v[92:95], v[224:227], v[28:31], v[92:95]
    ds_read_b64_tr_b16 v[242:243], v4 offset:1536
    s_waitcnt lgkmcnt(6)
    v_mfma_f32_16x16x32_bf16 v[96:99], v[228:231], v[24:27], v[96:99]
    ds_read_b64_tr_b16 v[244:245], v5 offset:544
    v_mfma_f32_16x16x32_bf16 v[100:103], v[228:231], v[28:31], v[100:103]
    ds_read_b64_tr_b16 v[246:247], v5 offset:1568
    s_waitcnt lgkmcnt(6)
    v_mfma_f32_16x16x32_bf16 v[104:107], v[232:235], v[24:27], v[104:107]
    ds_read_b64_tr_b16 v[224:225], v4 offset:768
    v_mfma_f32_16x16x32_bf16 v[108:111], v[232:235], v[28:31], v[108:111]
    ds_read_b64_tr_b16 v[226:227], v4 offset:1792
    s_waitcnt lgkmcnt(6)
    v_mfma_f32_16x16x32_bf16 v[112:115], v[236:239], v[24:27], v[112:115]
    ds_read_b64_tr_b16 v[228:229], v5 offset:800
    v_mfma_f32_16x16x32_bf16 v[116:119], v[236:239], v[28:31], v[116:119]
    ds_read_b64_tr_b16 v[230:231], v5 offset:1824
    s_waitcnt lgkmcnt(6)
    v_mfma_f32_16x16x32_bf16 v[120:123], v[240:243], v[24:27], v[120:123]
    v_mfma_f32_16x16x32_bf16 v[124:127], v[240:243], v[28:31], v[124:127]
    s_waitcnt vmcnt(14)
    s_barrier
    ds_read_b64_tr_b16 v[232:233], v4 offset:16384
    ds_read_b64_tr_b16 v[234:235], v4 offset:17408
    s_waitcnt lgkmcnt(6)
    v_mfma_f32_16x16x32_bf16 v[128:131], v[244:247], v[24:27], v[128:131]
    ds_read_b64_tr_b16 v[236:237], v5 offset:16416
    v_mfma_f32_16x16x32_bf16 v[132:135], v[244:247], v[28:31], v[132:135]
    ds_read_b64_tr_b16 v[238:239], v5 offset:17440
    s_waitcnt lgkmcnt(6)
    v_mfma_f32_16x16x32_bf16 v[136:139], v[224:227], v[24:27], v[136:139]
    ds_read_b64_tr_b16 v[240:241], v4 offset:16640
    v_mfma_f32_16x16x32_bf16 v[140:143], v[224:227], v[28:31], v[140:143]
    ds_read_b64_tr_b16 v[242:243], v4 offset:17664
    s_waitcnt lgkmcnt(6)
    v_mfma_f32_16x16x32_bf16 v[144:147], v[228:231], v[24:27], v[144:147]
    ds_read_b64_tr_b16 v[244:245], v5 offset:16672
    v_mfma_f32_16x16x32_bf16 v[148:151], v[228:231], v[28:31], v[148:151]
    ds_read_b64_tr_b16 v[246:247], v5 offset:17696
    s_waitcnt vmcnt(9) lgkmcnt(6)
    v_mfma_f32_16x16x32_bf16 v[88:91], v[232:235], v[32:35], v[88:91]
    ds_read_b64_tr_b16 v[224:225], v4 offset:16896
    s_waitcnt vmcnt(8)
    v_mfma_f32_16x16x32_bf16 v[92:95], v[232:235], v[36:39], v[92:95]
    ds_read_b64_tr_b16 v[226:227], v4 offset:17920
    s_waitcnt lgkmcnt(6)
    v_mfma_f32_16x16x32_bf16 v[96:99], v[236:239], v[32:35], v[96:99]
    ds_read_b64_tr_b16 v[228:229], v5 offset:16928
    v_mfma_f32_16x16x32_bf16 v[100:103], v[236:239], v[36:39], v[100:103]
    ds_read_b64_tr_b16 v[230:231], v5 offset:17952
    s_waitcnt lgkmcnt(6)
    v_mfma_f32_16x16x32_bf16 v[104:107], v[240:243], v[32:35], v[104:107]
    ds_read_b64_tr_b16 v[232:233], v4 offset:17152
    v_mfma_f32_16x16x32_bf16 v[108:111], v[240:243], v[36:39], v[108:111]
    ds_read_b64_tr_b16 v[234:235], v4 offset:18176
    s_waitcnt lgkmcnt(6)
    v_mfma_f32_16x16x32_bf16 v[112:115], v[244:247], v[32:35], v[112:115]
    ds_read_b64_tr_b16 v[236:237], v5 offset:17184
    v_mfma_f32_16x16x32_bf16 v[116:119], v[244:247], v[36:39], v[116:119]
    ds_read_b64_tr_b16 v[238:239], v5 offset:18208
    s_waitcnt lgkmcnt(6)
    v_mfma_f32_16x16x32_bf16 v[120:123], v[224:227], v[32:35], v[120:123]
    v_mfma_f32_16x16x32_bf16 v[124:127], v[224:227], v[36:39], v[124:127]
    s_waitcnt lgkmcnt(4)
    v_mfma_f32_16x16x32_bf16 v[128:131], v[228:231], v[32:35], v[128:131]
    v_mfma_f32_16x16x32_bf16 v[132:135], v[228:231], v[36:39], v[132:135]
    s_waitcnt lgkmcnt(2)
    v_mfma_f32_16x16x32_bf16 v[136:139], v[232:235], v[32:35], v[136:139]
    v_mfma_f32_16x16x32_bf16 v[140:143], v[232:235], v[36:39], v[140:143]
    s_waitcnt lgkmcnt(0)
    v_mfma_f32_16x16x32_bf16 v[144:147], v[236:239], v[32:35], v[144:147]
    v_mfma_f32_16x16x32_bf16 v[148:151], v[236:239], v[36:39], v[148:151]
    s_lshl_b32 s16, s3, 13
    s_xor_b32 s17, s16, 0x8000
    s_add_u32 s16, s16, 0x18000
    s_add_u32 s17, s17, 0x18000
    v_add_u32 v16, s16, v2
    s_mov_b32 s16, s17
    v_add_u32 v17, s16, v2
    ds_write_b128 v16, v[88:91] offset:0
    ds_write_b128 v16, v[92:95] offset:1024
    ds_write_b128 v16, v[96:99] offset:2048
    ds_write_b128 v16, v[100:103] offset:3072
    ds_write_b128 v16, v[104:107] offset:4096
    ds_write_b128 v16, v[108:111] offset:5120
    ds_write_b128 v16, v[112:115] offset:6144
    ds_write_b128 v16, v[116:119] offset:7168
    v_lshlrev_b32 v24, 16, v248
    v_and_b32 v25, 0xffff0000, v248
    v_lshlrev_b32 v26, 16, v249
    v_and_b32 v27, 0xffff0000, v249
    v_lshlrev_b32 v28, 16, v250
    v_and_b32 v29, 0xffff0000, v250
    v_lshlrev_b32 v30, 16, v251
    v_and_b32 v31, 0xffff0000, v251
    v_lshlrev_b32 v32, 16, v252
    v_and_b32 v33, 0xffff0000, v252
    v_lshlrev_b32 v34, 16, v253
    v_and_b32 v35, 0xffff0000, v253
    v_lshlrev_b32 v36, 16, v254
    v_and_b32 v37, 0xffff0000, v254
    v_lshlrev_b32 v38, 16, v255
    v_and_b32 v39, 0xffff0000, v255
    v_and_b32 v18, 15, v1
    v_lshlrev_b32 v18, 6, v18
    v_lshrrev_b32 v19, 4, v1
    v_and_b32 v20, 1, v19
    v_lshl_add_u32 v18, v20, 5, v18
    v_lshrrev_b32 v19, 1, v19
    v_lshl_add_u32 v18, v19, 4, v18
    s_and_b32 s17, s3, 3
    s_lshl_b32 s18, s30, 2
    s_add_u32 s18, s18, s17
    s_lshl_b32 s18, s18, 16
    s_lshl_b32 s19, s15, 22
    s_add_u32 s18, s18, s19
    s_lshl_b32 s19, s31, 12
    s_add_u32 s18, s18, s19
    s_add_u32 s18, s18, 0x2000800
    s_add_u32 s19, s18, 32768
    s_waitcnt lgkmcnt(0)
    s_barrier
    ds_read_b128 v[40:43], v17 offset:0
    ds_read_b128 v[44:47], v17 offset:1024
    ds_read_b128 v[48:51], v17 offset:2048
    ds_read_b128 v[52:55], v17 offset:3072
    ds_read_b128 v[56:59], v17 offset:4096
    ds_read_b128 v[60:63], v17 offset:5120
    ds_read_b128 v[64:67], v17 offset:6144
    ds_read_b128 v[68:71], v17 offset:7168
    s_waitcnt lgkmcnt(7)
    v_pk_add_f32 v[120:121], v[120:121], v[40:41]
    v_pk_add_f32 v[122:123], v[122:123], v[42:43]
    v_pk_mul_f32 v[120:121], v[120:121], v[24:25]
    v_pk_mul_f32 v[122:123], v[122:123], v[26:27]
    v_cvt_pk_bf16_f32 v224, v120, v121
    v_cvt_pk_bf16_f32 v225, v122, v123
    s_waitcnt lgkmcnt(5)
    v_pk_add_f32 v[128:129], v[128:129], v[48:49]
    v_pk_add_f32 v[130:131], v[130:131], v[50:51]
    v_pk_mul_f32 v[128:129], v[128:129], v[28:29]
    v_pk_mul_f32 v[130:131], v[130:131], v[30:31]
    v_cvt_pk_bf16_f32 v226, v128, v129
    v_cvt_pk_bf16_f32 v227, v130, v131
    s_nop 0
    v_permlane16_swap_b32 v224, v226
    v_permlane16_swap_b32 v225, v227
    buffer_store_dwordx4 v[224:227], v18, s[8:11], s18 offen offset:0 sc1
    v_pk_add_f32 v[124:125], v[124:125], v[44:45]
    v_pk_add_f32 v[126:127], v[126:127], v[46:47]
    v_pk_mul_f32 v[124:125], v[124:125], v[24:25]
    v_pk_mul_f32 v[126:127], v[126:127], v[26:27]
    v_cvt_pk_bf16_f32 v228, v124, v125
    v_cvt_pk_bf16_f32 v229, v126, v127
    s_waitcnt lgkmcnt(4)
    v_pk_add_f32 v[132:133], v[132:133], v[52:53]
    v_pk_add_f32 v[134:135], v[134:135], v[54:55]
    v_pk_mul_f32 v[132:133], v[132:133], v[28:29]
    v_pk_mul_f32 v[134:135], v[134:135], v[30:31]
    v_cvt_pk_bf16_f32 v230, v132, v133
    v_cvt_pk_bf16_f32 v231, v134, v135
    s_nop 0
    v_permlane16_swap_b32 v228, v230
    v_permlane16_swap_b32 v229, v231
    buffer_store_dwordx4 v[228:231], v18, s[8:11], s19 offen offset:0 sc1
    s_waitcnt lgkmcnt(3)
    v_pk_add_f32 v[136:137], v[136:137], v[56:57]
    v_pk_add_f32 v[138:139], v[138:139], v[58:59]
    v_pk_mul_f32 v[136:137], v[136:137], v[32:33]
    v_pk_mul_f32 v[138:139], v[138:139], v[34:35]
    v_cvt_pk_bf16_f32 v232, v136, v137
    v_cvt_pk_bf16_f32 v233, v138, v139
    s_waitcnt lgkmcnt(1)
    v_pk_add_f32 v[144:145], v[144:145], v[64:65]
    v_pk_add_f32 v[146:147], v[146:147], v[66:67]
    v_pk_mul_f32 v[144:145], v[144:145], v[36:37]
    v_pk_mul_f32 v[146:147], v[146:147], v[38:39]
    v_cvt_pk_bf16_f32 v234, v144, v145
    v_cvt_pk_bf16_f32 v235, v146, v147
    s_nop 0
    v_permlane16_swap_b32 v232, v234
    v_permlane16_swap_b32 v233, v235
    buffer_store_dwordx4 v[232:235], v18, s[8:11], s18 offen offset:1024 sc1
    v_pk_add_f32 v[140:141], v[140:141], v[60:61]
    v_pk_add_f32 v[142:143], v[142:143], v[62:63]
    v_pk_mul_f32 v[140:141], v[140:141], v[32:33]
    v_pk_mul_f32 v[142:143], v[142:143], v[34:35]
    v_cvt_pk_bf16_f32 v236, v140, v141
    v_cvt_pk_bf16_f32 v237, v142, v143
    s_waitcnt lgkmcnt(0)
    v_pk_add_f32 v[148:149], v[148:149], v[68:69]
    v_pk_add_f32 v[150:151], v[150:151], v[70:71]
    v_pk_mul_f32 v[148:149], v[148:149], v[36:37]
    v_pk_mul_f32 v[150:151], v[150:151], v[38:39]
    v_cvt_pk_bf16_f32 v238, v148, v149
    v_cvt_pk_bf16_f32 v239, v150, v151
    s_nop 0
    v_permlane16_swap_b32 v236, v238
    v_permlane16_swap_b32 v237, v239
    buffer_store_dwordx4 v[236:239], v18, s[8:11], s19 offen offset:1024 sc1
    s_mov_b64 s[64:65], s[44:45]
    s_mov_b32 s66, 0x800
    s_mov_b32 s67, 0x20000
    s_mov_b64 s[76:77], s[32:33]
    s_mov_b32 s78, 0x400000
    s_mov_b32 s79, 0x20000
    s_mov_b64 s[68:69], s[56:57]
    s_mov_b32 s70, 0x400000
    s_mov_b32 s71, 0x20000
    s_lshl_b32 s14, s31, 1
    s_add_u32 s14, s14, s15
    s_lshl_b32 s14, s14, 3
    s_add_u32 s14, s14, s3
    s_lshl_b32 s16, s30, 7
    s_add_u32 s14, s14, s16
    s_lshl_b32 s16, s14, 11
    buffer_load_dwordx4 v[216:219], v2, s[76:79], s16 offen offset:0
    buffer_load_dwordx4 v[220:223], v2, s[76:79], s16 offen offset:1024
    s_lshl_b32 s16, s3, 10
    s_add_u32 m0, s16, 81920
    s_add_u32 s17, s16, 0x540800
    s_cmp_lt_u32 s3, 6
    s_cselect_b32 s17, s17, 0x7ffffff0
    s_sub_u32 s23, s16, 6144
    s_cmp_ge_u32 s3, 6
    s_cselect_b32 s23, s23, 0x7ffffff0
    s_cbranch_scc1 adaLN_cond__sliding_block_cached__moe_arch_mod__prompt_kernel_mlw
    buffer_load_dwordx4 v2, s[8:11], s17 offen sc1 lds
    s_branch adaLN_cond__sliding_block_cached__moe_arch_mod__prompt_kernel_mlj
adaLN_cond__sliding_block_cached__moe_arch_mod__prompt_kernel_mlw:
    buffer_load_dwordx4 v2, s[64:67], s23 offen lds
adaLN_cond__sliding_block_cached__moe_arch_mod__prompt_kernel_mlj:
    s_lshl_b32 s16, s30, 5
    s_lshl_b32 s17, s31, 1
    s_add_u32 s16, s16, s17
    s_add_u32 s16, s16, s15
    s_lshl_b32 s16, s16, 2
    s_add_u32 s16, s16, 0x530000
    s_cmp_eq_u32 s3, 0
    s_cselect_b32 s16, s16, 0x7ffffff0
    v_mov_b32 v16, s28
    v_mov_b32 v17, 0
    s_lshr_b32 s18, s14, 4
    s_lshl_b32 s18, s18, 15
    s_and_b32 s19, s14, 15
    s_lshl_b32 s19, s19, 6
    s_add_u32 s18, s18, s19
    s_add_u32 s18, s18, 0x2000000
    s_add_u32 s19, s18, 16384
    v_lshrrev_b32 v18, 2, v1
    v_lshlrev_b32 v18, 10, v18
    v_and_b32 v19, 3, v1
    v_lshl_add_u32 v18, v19, 4, v18
    v_add_u32 v19, 0x400000, v18
    s_lshl_b32 s25, s30, 7
    s_add_u32 s25, s25, 0x530000
    v_and_b32 v20, 15, v1
    v_lshlrev_b32 v20, 2, v20
    s_waitcnt vmcnt(3)
    s_waitcnt vmcnt(0)
    s_barrier
    s_mov_b64 exec, 1
    buffer_store_dword v16, v17, s[8:11], s16 offen sc1
    s_mov_b64 exec, -1
    v_add_u32 v16, 81920, v2
    ds_read_b128 v[184:187], v16 offset:0
    ds_read_b128 v[188:191], v16 offset:1024
    ds_read_b128 v[192:195], v16 offset:2048
    ds_read_b128 v[196:199], v16 offset:3072
    ds_read_b128 v[200:203], v16 offset:4096
    ds_read_b128 v[204:207], v16 offset:5120
    ds_read_b128 v[208:211], v16 offset:6144
    ds_read_b128 v[212:215], v16 offset:7168
    v_mov_b32 v94, 0
    v_mov_b32 v95, 0
    s_waitcnt lgkmcnt(5)
    v_lshlrev_b32 v76, 16, v192
    v_and_b32 v77, 0xffff0000, v192
    s_waitcnt lgkmcnt(1)
    v_lshlrev_b32 v78, 16, v208
    v_and_b32 v79, 0xffff0000, v208
    v_pk_mul_f32 v[60:61], v[76:77], v[78:79]
    v_lshlrev_b32 v76, 16, v184
    v_and_b32 v77, 0xffff0000, v184
    v_fmac_f32 v94, v76, v78
    v_fmac_f32 v94, v77, v79
    v_add_f32 v95, v95, v60
    v_add_f32 v95, v95, v61
    v_lshlrev_b32 v76, 16, v193
    v_and_b32 v77, 0xffff0000, v193
    v_lshlrev_b32 v78, 16, v209
    v_and_b32 v79, 0xffff0000, v209
    v_pk_mul_f32 v[62:63], v[76:77], v[78:79]
    v_lshlrev_b32 v76, 16, v185
    v_and_b32 v77, 0xffff0000, v185
    v_fmac_f32 v94, v76, v78
    v_fmac_f32 v94, v77, v79
    v_add_f32 v95, v95, v62
    v_add_f32 v95, v95, v63
    v_lshlrev_b32 v76, 16, v194
    v_and_b32 v77, 0xffff0000, v194
    v_lshlrev_b32 v78, 16, v210
    v_and_b32 v79, 0xffff0000, v210
    v_pk_mul_f32 v[64:65], v[76:77], v[78:79]
    v_lshlrev_b32 v76, 16, v186
    v_and_b32 v77, 0xffff0000, v186
    v_fmac_f32 v94, v76, v78
    v_fmac_f32 v94, v77, v79
    v_add_f32 v95, v95, v64
    v_add_f32 v95, v95, v65
    v_lshlrev_b32 v76, 16, v195
    v_and_b32 v77, 0xffff0000, v195
    v_lshlrev_b32 v78, 16, v211
    v_and_b32 v79, 0xffff0000, v211
    v_pk_mul_f32 v[66:67], v[76:77], v[78:79]
    v_lshlrev_b32 v76, 16, v187
    v_and_b32 v77, 0xffff0000, v187
    v_fmac_f32 v94, v76, v78
    v_fmac_f32 v94, v77, v79
    v_add_f32 v95, v95, v66
    v_add_f32 v95, v95, v67
    v_lshlrev_b32 v76, 16, v196
    v_and_b32 v77, 0xffff0000, v196
    s_waitcnt lgkmcnt(0)
    v_lshlrev_b32 v78, 16, v212
    v_and_b32 v79, 0xffff0000, v212
    v_pk_mul_f32 v[68:69], v[76:77], v[78:79]
    v_lshlrev_b32 v76, 16, v188
    v_and_b32 v77, 0xffff0000, v188
    v_fmac_f32 v94, v76, v78
    v_fmac_f32 v94, v77, v79
    v_add_f32 v95, v95, v68
    v_add_f32 v95, v95, v69
    v_lshlrev_b32 v76, 16, v197
    v_and_b32 v77, 0xffff0000, v197
    v_lshlrev_b32 v78, 16, v213
    v_and_b32 v79, 0xffff0000, v213
    v_pk_mul_f32 v[70:71], v[76:77], v[78:79]
    v_lshlrev_b32 v76, 16, v189
    v_and_b32 v77, 0xffff0000, v189
    v_fmac_f32 v94, v76, v78
    v_fmac_f32 v94, v77, v79
    v_add_f32 v95, v95, v70
    v_add_f32 v95, v95, v71
    v_lshlrev_b32 v76, 16, v198
    v_and_b32 v77, 0xffff0000, v198
    v_lshlrev_b32 v78, 16, v214
    v_and_b32 v79, 0xffff0000, v214
    v_pk_mul_f32 v[72:73], v[76:77], v[78:79]
    v_lshlrev_b32 v76, 16, v190
    v_and_b32 v77, 0xffff0000, v190
    v_fmac_f32 v94, v76, v78
    v_fmac_f32 v94, v77, v79
    v_add_f32 v95, v95, v72
    v_add_f32 v95, v95, v73
    v_lshlrev_b32 v76, 16, v199
    v_and_b32 v77, 0xffff0000, v199
    v_lshlrev_b32 v78, 16, v215
    v_and_b32 v79, 0xffff0000, v215
    v_pk_mul_f32 v[74:75], v[76:77], v[78:79]
    v_lshlrev_b32 v76, 16, v191
    v_and_b32 v77, 0xffff0000, v191
    v_fmac_f32 v94, v76, v78
    v_fmac_f32 v94, v77, v79
    v_add_f32 v95, v95, v74
    v_add_f32 v95, v95, v75
    v_add_f32_dpp v94, v94, v94 row_ror:1 row_mask:0xf bank_mask:0xf
    s_nop 0
    v_add_f32_dpp v95, v95, v95 row_ror:1 row_mask:0xf bank_mask:0xf
    v_add_f32_dpp v94, v94, v94 row_ror:2 row_mask:0xf bank_mask:0xf
    s_nop 0
    v_add_f32_dpp v95, v95, v95 row_ror:2 row_mask:0xf bank_mask:0xf
    v_add_f32_dpp v94, v94, v94 row_ror:4 row_mask:0xf bank_mask:0xf
    s_nop 0
    v_add_f32_dpp v95, v95, v95 row_ror:4 row_mask:0xf bank_mask:0xf
    v_add_f32_dpp v94, v94, v94 row_ror:8 row_mask:0xf bank_mask:0xf
    s_nop 0
    v_add_f32_dpp v95, v95, v95 row_ror:8 row_mask:0xf bank_mask:0xf
    v_mov_b32 v76, v94
    s_nop 1
    v_permlane16_swap_b32 v94, v76
    v_add_f32 v94, v94, v76
    v_mov_b32 v77, v95
    s_nop 1
    v_permlane16_swap_b32 v95, v77
    v_add_f32 v95, v95, v77
    v_mov_b32 v76, v94
    s_nop 1
    v_permlane32_swap_b32 v94, v76
    v_add_f32 v94, v94, v76
    v_mov_b32 v77, v95
    s_nop 1
    v_permlane32_swap_b32 v95, v77
    v_add_f32 v95, v95, v77
    v_lshlrev_b32 v28, 16, v216
    v_and_b32 v29, 0xffff0000, v216
    v_lshlrev_b32 v30, 16, v217
    v_and_b32 v31, 0xffff0000, v217
    v_lshlrev_b32 v32, 16, v218
    v_and_b32 v33, 0xffff0000, v218
    v_lshlrev_b32 v34, 16, v219
    v_and_b32 v35, 0xffff0000, v219
    v_lshlrev_b32 v36, 16, v220
    v_and_b32 v37, 0xffff0000, v220
    v_lshlrev_b32 v38, 16, v221
    v_and_b32 v39, 0xffff0000, v221
    v_lshlrev_b32 v40, 16, v222
    v_and_b32 v41, 0xffff0000, v222
    v_lshlrev_b32 v42, 16, v223
    v_and_b32 v43, 0xffff0000, v223
    s_mov_b32 s27, 0
adaLN_cond__sliding_block_cached__moe_arch_mod__prompt_kernel_a22p:
    buffer_load_dword v76, v20, s[8:11], s25 offen sc1
    s_waitcnt vmcnt(0)
    v_cmp_ne_u32 vcc, s28, v76
    s_add_u32 s27, s27, 1
    s_cmp_ge_u32 s27, 65536
    s_cbranch_scc1 adaLN_cond__sliding_block_cached__moe_arch_mod__prompt_kernel_a22g
    s_cbranch_vccnz adaLN_cond__sliding_block_cached__moe_arch_mod__prompt_kernel_a22p
adaLN_cond__sliding_block_cached__moe_arch_mod__prompt_kernel_a22g:
    buffer_load_dwordx4 v[44:47], v18, s[8:11], s18 offen sc1
    buffer_load_dwordx4 v[52:55], v19, s[8:11], s18 offen sc1
    buffer_load_dwordx4 v[48:51], v18, s[8:11], s19 offen sc1
    buffer_load_dwordx4 v[56:59], v19, s[8:11], s19 offen sc1
    v_lshlrev_b32 v21, 2, v0
    s_mov_b32 s16, 0x540800
    buffer_load_dword v106, v21, s[8:11], s16 offen sc1
    buffer_load_dword v104, v21, s[8:11], s16 offen offset:2048 sc1
    s_waitcnt vmcnt(5)
    v_lshlrev_b32 v76, 16, v44
    v_and_b32 v77, 0xffff0000, v44
    s_waitcnt vmcnt(4)
    v_lshlrev_b32 v78, 16, v52
    v_and_b32 v79, 0xffff0000, v52
    v_pk_add_f32 v[76:77], v[76:77], v[78:79]
    v_pk_add_f32 v[28:29], v[28:29], v[76:77]
    v_cvt_pk_bf16_f32 v16, v28, v29
    v_lshlrev_b32 v28, 16, v16
    v_and_b32 v29, 0xffff0000, v16
    v_lshlrev_b32 v80, 16, v45
    v_and_b32 v81, 0xffff0000, v45
    v_lshlrev_b32 v82, 16, v53
    v_and_b32 v83, 0xffff0000, v53
    v_pk_add_f32 v[80:81], v[80:81], v[82:83]
    v_pk_add_f32 v[30:31], v[30:31], v[80:81]
    v_cvt_pk_bf16_f32 v17, v30, v31
    v_lshlrev_b32 v30, 16, v17
    v_and_b32 v31, 0xffff0000, v17
    v_lshlrev_b32 v76, 16, v46
    v_and_b32 v77, 0xffff0000, v46
    v_lshlrev_b32 v78, 16, v54
    v_and_b32 v79, 0xffff0000, v54
    v_pk_add_f32 v[76:77], v[76:77], v[78:79]
    v_pk_add_f32 v[32:33], v[32:33], v[76:77]
    v_cvt_pk_bf16_f32 v16, v32, v33
    v_lshlrev_b32 v32, 16, v16
    v_and_b32 v33, 0xffff0000, v16
    v_lshlrev_b32 v80, 16, v47
    v_and_b32 v81, 0xffff0000, v47
    v_lshlrev_b32 v82, 16, v55
    v_and_b32 v83, 0xffff0000, v55
    v_pk_add_f32 v[80:81], v[80:81], v[82:83]
    v_pk_add_f32 v[34:35], v[34:35], v[80:81]
    v_cvt_pk_bf16_f32 v17, v34, v35
    v_lshlrev_b32 v34, 16, v17
    v_and_b32 v35, 0xffff0000, v17
    s_waitcnt vmcnt(3)
    v_lshlrev_b32 v76, 16, v48
    v_and_b32 v77, 0xffff0000, v48
    s_waitcnt vmcnt(2)
    v_lshlrev_b32 v78, 16, v56
    v_and_b32 v79, 0xffff0000, v56
    v_pk_add_f32 v[76:77], v[76:77], v[78:79]
    v_pk_add_f32 v[36:37], v[36:37], v[76:77]
    v_cvt_pk_bf16_f32 v16, v36, v37
    v_lshlrev_b32 v36, 16, v16
    v_and_b32 v37, 0xffff0000, v16
    v_lshlrev_b32 v80, 16, v49
    v_and_b32 v81, 0xffff0000, v49
    v_lshlrev_b32 v82, 16, v57
    v_and_b32 v83, 0xffff0000, v57
    v_pk_add_f32 v[80:81], v[80:81], v[82:83]
    v_pk_add_f32 v[38:39], v[38:39], v[80:81]
    v_cvt_pk_bf16_f32 v17, v38, v39
    v_lshlrev_b32 v38, 16, v17
    v_and_b32 v39, 0xffff0000, v17
    v_lshlrev_b32 v76, 16, v50
    v_and_b32 v77, 0xffff0000, v50
    v_lshlrev_b32 v78, 16, v58
    v_and_b32 v79, 0xffff0000, v58
    v_pk_add_f32 v[76:77], v[76:77], v[78:79]
    v_pk_add_f32 v[40:41], v[40:41], v[76:77]
    v_cvt_pk_bf16_f32 v16, v40, v41
    v_lshlrev_b32 v40, 16, v16
    v_and_b32 v41, 0xffff0000, v16
    v_lshlrev_b32 v80, 16, v51
    v_and_b32 v81, 0xffff0000, v51
    v_lshlrev_b32 v82, 16, v59
    v_and_b32 v83, 0xffff0000, v59
    v_pk_add_f32 v[80:81], v[80:81], v[82:83]
    v_pk_add_f32 v[42:43], v[42:43], v[80:81]
    v_cvt_pk_bf16_f32 v17, v42, v43
    v_lshlrev_b32 v42, 16, v17
    v_and_b32 v43, 0xffff0000, v17
    v_pk_add_f32 v[76:77], v[28:29], v[30:31]
    v_pk_mul_f32 v[78:79], v[28:29], v[28:29]
    v_pk_mul_f32 v[80:81], v[28:29], v[60:61]
    v_pk_fma_f32 v[78:79], v[30:31], v[30:31], v[78:79]
    v_pk_fma_f32 v[80:81], v[30:31], v[62:63], v[80:81]
    v_pk_add_f32 v[76:77], v[76:77], v[32:33]
    v_pk_fma_f32 v[78:79], v[32:33], v[32:33], v[78:79]
    v_pk_fma_f32 v[80:81], v[32:33], v[64:65], v[80:81]
    v_pk_add_f32 v[76:77], v[76:77], v[34:35]
    v_pk_fma_f32 v[78:79], v[34:35], v[34:35], v[78:79]
    v_pk_fma_f32 v[80:81], v[34:35], v[66:67], v[80:81]
    v_pk_add_f32 v[76:77], v[76:77], v[36:37]
    v_pk_fma_f32 v[78:79], v[36:37], v[36:37], v[78:79]
    v_pk_fma_f32 v[80:81], v[36:37], v[68:69], v[80:81]
    v_pk_add_f32 v[76:77], v[76:77], v[38:39]
    v_pk_fma_f32 v[78:79], v[38:39], v[38:39], v[78:79]
    v_pk_fma_f32 v[80:81], v[38:39], v[70:71], v[80:81]
    v_pk_add_f32 v[76:77], v[76:77], v[40:41]
    v_pk_fma_f32 v[78:79], v[40:41], v[40:41], v[78:79]
    v_pk_fma_f32 v[80:81], v[40:41], v[72:73], v[80:81]
    v_pk_add_f32 v[76:77], v[76:77], v[42:43]
    v_pk_fma_f32 v[78:79], v[42:43], v[42:43], v[78:79]
    v_pk_fma_f32 v[80:81], v[42:43], v[74:75], v[80:81]
    v_add_f32 v96, v76, v77
    v_add_f32 v97, v78, v79
    v_add_f32 v98, v80, v81
    v_add_f32_dpp v96, v96, v96 row_ror:1 row_mask:0xf bank_mask:0xf
    v_add_f32_dpp v97, v97, v97 row_ror:1 row_mask:0xf bank_mask:0xf
    v_add_f32_dpp v98, v98, v98 row_ror:1 row_mask:0xf bank_mask:0xf
    v_add_f32_dpp v96, v96, v96 row_ror:2 row_mask:0xf bank_mask:0xf
    v_add_f32_dpp v97, v97, v97 row_ror:2 row_mask:0xf bank_mask:0xf
    v_add_f32_dpp v98, v98, v98 row_ror:2 row_mask:0xf bank_mask:0xf
    v_add_f32_dpp v96, v96, v96 row_ror:4 row_mask:0xf bank_mask:0xf
    v_add_f32_dpp v97, v97, v97 row_ror:4 row_mask:0xf bank_mask:0xf
    v_add_f32_dpp v98, v98, v98 row_ror:4 row_mask:0xf bank_mask:0xf
    v_add_f32_dpp v96, v96, v96 row_ror:8 row_mask:0xf bank_mask:0xf
    v_add_f32_dpp v97, v97, v97 row_ror:8 row_mask:0xf bank_mask:0xf
    v_add_f32_dpp v98, v98, v98 row_ror:8 row_mask:0xf bank_mask:0xf
    v_mov_b32 v76, v96
    s_nop 1
    v_permlane16_swap_b32 v96, v76
    v_add_f32 v96, v96, v76
    v_mov_b32 v77, v97
    s_nop 1
    v_permlane16_swap_b32 v97, v77
    v_add_f32 v97, v97, v77
    v_mov_b32 v78, v98
    s_nop 1
    v_permlane16_swap_b32 v98, v78
    v_add_f32 v98, v98, v78
    v_mov_b32 v76, v96
    s_nop 1
    v_permlane32_swap_b32 v96, v76
    v_add_f32 v96, v96, v76
    v_mov_b32 v77, v97
    s_nop 1
    v_permlane32_swap_b32 v97, v77
    v_add_f32 v97, v97, v77
    v_mov_b32 v78, v98
    s_nop 1
    v_permlane32_swap_b32 v98, v78
    v_add_f32 v98, v98, v78
    v_mul_f32 v96, 0x3a800000, v96
    v_mul_f32 v97, 0x3a800000, v97
    v_fma_f32 v97, -v96, v96, v97
    v_max_f32 v97, 0, v97
    v_fma_f32 v98, -v96, v95, v98
    v_add_f32 v76, 0x3727c5ac, v97
    v_rsq_f32 v76, v76
    s_nop 0
    v_fma_f32 v27, v98, v76, v94
    v_cvt_pk_bf16_f32 v96, v96, v96
    v_lshlrev_b32 v96, 16, v96
    v_cvt_pk_bf16_f32 v97, v97, v97
    v_lshlrev_b32 v97, 16, v97
    v_add_f32 v97, 0x3727c5ac, v97
    v_cvt_pk_bf16_f32 v97, v97, v97
    v_lshlrev_b32 v97, 16, v97
    v_sqrt_f32 v98, v97
    s_nop 0
    v_cvt_pk_bf16_f32 v98, v98, v98
    v_lshlrev_b32 v98, 16, v98
    v_rcp_f32 v99, v98
    v_mov_b32 v25, v96
    v_mov_b32 v26, v98
    v_ashrrev_i32 v16, 31, v27
    v_or_b32 v16, 0x80000000, v16
    v_xor_b32 v24, v27, v16
    v_and_b32 v24, 0xfffff800, v24
    v_max_u32 v24, 0x800, v24
    s_sub_u32 s16, 2047, s14
    v_or_b32 v24, s16, v24
    s_lshl_b32 s16, s3, 4
    s_add_u32 s16, s16, 65536
    v_mov_b32 v16, s16
    ds_write_b128 v16, v[24:27]
    s_waitcnt lgkmcnt(0)
    s_barrier
    v_and_b32 v16, 7, v1
    v_lshlrev_b32 v16, 4, v16
    v_add_u32 v16, 65536, v16
    ds_read_b32 v76, v16
    s_waitcnt lgkmcnt(0)
    v_mov_b32 v77, v76
    s_nop 1
    v_max_u32_dpp v77, v77, v77 row_ror:1 row_mask:0xf bank_mask:0xf
    s_nop 1
    v_max_u32_dpp v77, v77, v77 row_ror:2 row_mask:0xf bank_mask:0xf
    s_nop 1
    v_max_u32_dpp v77, v77, v77 row_ror:4 row_mask:0xf bank_mask:0xf
    v_cmp_eq_u32 vcc, v76, v77
    s_ff1_i32_b64 s16, vcc
    s_lshl_b32 s16, s16, 4
    s_add_u32 s16, s16, 65536
    v_mov_b32 v16, s16
    ds_read_b128 v[24:27], v16
    s_lshl_b32 s16, s2, 4
    s_add_u32 s16, s16, 0x6e0000
    s_cmp_eq_u32 s3, 0
    s_cselect_b32 s16, s16, 0x7ffffff0
    v_mov_b32 v17, 0
    s_mov_b64 exec, 1
    s_waitcnt lgkmcnt(0)
    buffer_store_dwordx4 v[24:27], v17, s[8:11], s16 offen sc1
    s_mov_b64 exec, -1
    s_mov_b64 s[72:73], s[50:51]
    s_mov_b32 s74, 0x700000
    s_mov_b32 s75, 0x20000
    s_cmp_lt_u32 s2, 224
    s_cselect_b32 s74, 7340032, 0
    s_lshl_b32 s17, s29, 4
    s_sub_u32 s16, s3, 4
    s_lshl_b32 s16, s16, 2
    s_add_u32 s16, s16, s17
    s_lshl_b32 s16, s16, 11
    s_add_u32 s17, s16, 0
    buffer_load_dwordx4 v[152:155], v2, s[72:75], s17 offen offset:0
    buffer_load_dwordx4 v[156:159], v2, s[72:75], s17 offen offset:1024
    s_add_u32 s17, s16, 2048
    buffer_load_dwordx4 v[160:163], v2, s[72:75], s17 offen offset:0
    buffer_load_dwordx4 v[164:167], v2, s[72:75], s17 offen offset:1024
    s_add_u32 s17, s16, 4096
    buffer_load_dwordx4 v[168:171], v2, s[72:75], s17 offen offset:0
    buffer_load_dwordx4 v[172:175], v2, s[72:75], s17 offen offset:1024
    s_add_u32 s17, s16, 6144
    buffer_load_dwordx4 v[176:179], v2, s[72:75], s17 offen offset:0
    buffer_load_dwordx4 v[180:183], v2, s[72:75], s17 offen offset:1024
    v_sub_f32 v44, v28, v96
    v_sub_f32 v45, v29, v96
    v_sub_f32 v46, v30, v96
    v_sub_f32 v47, v31, v96
    v_sub_f32 v48, v32, v96
    v_sub_f32 v49, v33, v96
    v_sub_f32 v50, v34, v96
    v_sub_f32 v51, v35, v96
    v_cvt_pk_bf16_f32 v16, v44, v45
    v_lshlrev_b32 v44, 16, v16
    v_and_b32 v45, 0xffff0000, v16
    v_cvt_pk_bf16_f32 v16, v46, v47
    v_lshlrev_b32 v46, 16, v16
    v_and_b32 v47, 0xffff0000, v16
    v_cvt_pk_bf16_f32 v16, v48, v49
    v_lshlrev_b32 v48, 16, v16
    v_and_b32 v49, 0xffff0000, v16
    v_cvt_pk_bf16_f32 v16, v50, v51
    v_lshlrev_b32 v50, 16, v16
    v_and_b32 v51, 0xffff0000, v16
    v_mul_f32 v52, v44, v99
    v_mul_f32 v53, v45, v99
    v_mul_f32 v54, v46, v99
    v_mul_f32 v55, v47, v99
    v_mul_f32 v56, v48, v99
    v_mul_f32 v57, v49, v99
    v_mul_f32 v58, v50, v99
    v_mul_f32 v59, v51, v99
    v_fma_f32 v44, -v52, v98, v44
    v_fma_f32 v45, -v53, v98, v45
    v_fma_f32 v46, -v54, v98, v46
    v_fma_f32 v47, -v55, v98, v47
    v_fma_f32 v48, -v56, v98, v48
    v_fma_f32 v49, -v57, v98, v49
    v_fma_f32 v50, -v58, v98, v50
    v_fma_f32 v51, -v59, v98, v51
    v_fma_f32 v44, v44, v99, v52
    v_fma_f32 v45, v45, v99, v53
    v_fma_f32 v46, v46, v99, v54
    v_fma_f32 v47, v47, v99, v55
    v_fma_f32 v48, v48, v99, v56
    v_fma_f32 v49, v49, v99, v57
    v_fma_f32 v50, v50, v99, v58
    v_fma_f32 v51, v51, v99, v59
    v_cvt_pk_bf16_f32 v16, v44, v45
    v_lshlrev_b32 v44, 16, v16
    v_and_b32 v45, 0xffff0000, v16
    v_cvt_pk_bf16_f32 v16, v46, v47
    v_lshlrev_b32 v46, 16, v16
    v_and_b32 v47, 0xffff0000, v16
    v_cvt_pk_bf16_f32 v16, v48, v49
    v_lshlrev_b32 v48, 16, v16
    v_and_b32 v49, 0xffff0000, v16
    v_cvt_pk_bf16_f32 v16, v50, v51
    v_lshlrev_b32 v50, 16, v16
    v_and_b32 v51, 0xffff0000, v16
    v_lshlrev_b32 v52, 16, v192
    v_and_b32 v53, 0xffff0000, v192
    v_lshlrev_b32 v54, 16, v193
    v_and_b32 v55, 0xffff0000, v193
    v_lshlrev_b32 v56, 16, v194
    v_and_b32 v57, 0xffff0000, v194
    v_lshlrev_b32 v58, 16, v195
    v_and_b32 v59, 0xffff0000, v195
    v_pk_mul_f32 v[44:45], v[44:45], v[52:53]
    v_pk_mul_f32 v[46:47], v[46:47], v[54:55]
    v_pk_mul_f32 v[48:49], v[48:49], v[56:57]
    v_pk_mul_f32 v[50:51], v[50:51], v[58:59]
    v_cvt_pk_bf16_f32 v16, v44, v45
    v_lshlrev_b32 v44, 16, v16
    v_and_b32 v45, 0xffff0000, v16
    v_cvt_pk_bf16_f32 v16, v46, v47
    v_lshlrev_b32 v46, 16, v16
    v_and_b32 v47, 0xffff0000, v16
    v_cvt_pk_bf16_f32 v16, v48, v49
    v_lshlrev_b32 v48, 16, v16
    v_and_b32 v49, 0xffff0000, v16
    v_cvt_pk_bf16_f32 v16, v50, v51
    v_lshlrev_b32 v50, 16, v16
    v_and_b32 v51, 0xffff0000, v16
    v_lshlrev_b32 v52, 16, v184
    v_and_b32 v53, 0xffff0000, v184
    v_lshlrev_b32 v54, 16, v185
    v_and_b32 v55, 0xffff0000, v185
    v_lshlrev_b32 v56, 16, v186
    v_and_b32 v57, 0xffff0000, v186
    v_lshlrev_b32 v58, 16, v187
    v_and_b32 v59, 0xffff0000, v187
    v_pk_add_f32 v[44:45], v[44:45], v[52:53]
    v_pk_add_f32 v[46:47], v[46:47], v[54:55]
    v_pk_add_f32 v[48:49], v[48:49], v[56:57]
    v_pk_add_f32 v[50:51], v[50:51], v[58:59]
    v_cvt_pk_bf16_f32 v16, v44, v45
    v_lshlrev_b32 v44, 16, v16
    v_and_b32 v45, 0xffff0000, v16
    v_cvt_pk_bf16_f32 v16, v46, v47
    v_lshlrev_b32 v46, 16, v16
    v_and_b32 v47, 0xffff0000, v16
    v_cvt_pk_bf16_f32 v16, v48, v49
    v_lshlrev_b32 v48, 16, v16
    v_and_b32 v49, 0xffff0000, v16
    v_cvt_pk_bf16_f32 v16, v50, v51
    v_lshlrev_b32 v50, 16, v16
    v_and_b32 v51, 0xffff0000, v16
    v_lshlrev_b32 v52, 16, v200
    v_and_b32 v53, 0xffff0000, v200
    v_lshlrev_b32 v54, 16, v201
    v_and_b32 v55, 0xffff0000, v201
    v_lshlrev_b32 v56, 16, v202
    v_and_b32 v57, 0xffff0000, v202
    v_lshlrev_b32 v58, 16, v203
    v_and_b32 v59, 0xffff0000, v203
    v_pk_mul_f32 v[44:45], v[44:45], v[52:53]
    v_pk_mul_f32 v[46:47], v[46:47], v[54:55]
    v_pk_mul_f32 v[48:49], v[48:49], v[56:57]
    v_pk_mul_f32 v[50:51], v[50:51], v[58:59]
    v_cvt_pk_bf16_f32 v16, v44, v45
    v_lshlrev_b32 v44, 16, v16
    v_and_b32 v45, 0xffff0000, v16
    v_cvt_pk_bf16_f32 v16, v46, v47
    v_lshlrev_b32 v46, 16, v16
    v_and_b32 v47, 0xffff0000, v16
    v_cvt_pk_bf16_f32 v16, v48, v49
    v_lshlrev_b32 v48, 16, v16
    v_and_b32 v49, 0xffff0000, v16
    v_cvt_pk_bf16_f32 v16, v50, v51
    v_lshlrev_b32 v50, 16, v16
    v_and_b32 v51, 0xffff0000, v16
    v_pk_add_f32 v[44:45], v[44:45], v[28:29]
    v_pk_add_f32 v[46:47], v[46:47], v[30:31]
    v_pk_add_f32 v[48:49], v[48:49], v[32:33]
    v_pk_add_f32 v[50:51], v[50:51], v[34:35]
    v_cvt_pk_bf16_f32 v28, v44, v45
    v_cvt_pk_bf16_f32 v29, v46, v47
    v_cvt_pk_bf16_f32 v30, v48, v49
    v_cvt_pk_bf16_f32 v31, v50, v51
    v_sub_f32 v44, v36, v96
    v_sub_f32 v45, v37, v96
    v_sub_f32 v46, v38, v96
    v_sub_f32 v47, v39, v96
    v_sub_f32 v48, v40, v96
    v_sub_f32 v49, v41, v96
    v_sub_f32 v50, v42, v96
    v_sub_f32 v51, v43, v96
    v_cvt_pk_bf16_f32 v16, v44, v45
    v_lshlrev_b32 v44, 16, v16
    v_and_b32 v45, 0xffff0000, v16
    v_cvt_pk_bf16_f32 v16, v46, v47
    v_lshlrev_b32 v46, 16, v16
    v_and_b32 v47, 0xffff0000, v16
    v_cvt_pk_bf16_f32 v16, v48, v49
    v_lshlrev_b32 v48, 16, v16
    v_and_b32 v49, 0xffff0000, v16
    v_cvt_pk_bf16_f32 v16, v50, v51
    v_lshlrev_b32 v50, 16, v16
    v_and_b32 v51, 0xffff0000, v16
    v_mul_f32 v52, v44, v99
    v_mul_f32 v53, v45, v99
    v_mul_f32 v54, v46, v99
    v_mul_f32 v55, v47, v99
    v_mul_f32 v56, v48, v99
    v_mul_f32 v57, v49, v99
    v_mul_f32 v58, v50, v99
    v_mul_f32 v59, v51, v99
    v_fma_f32 v44, -v52, v98, v44
    v_fma_f32 v45, -v53, v98, v45
    v_fma_f32 v46, -v54, v98, v46
    v_fma_f32 v47, -v55, v98, v47
    v_fma_f32 v48, -v56, v98, v48
    v_fma_f32 v49, -v57, v98, v49
    v_fma_f32 v50, -v58, v98, v50
    v_fma_f32 v51, -v59, v98, v51
    v_fma_f32 v44, v44, v99, v52
    v_fma_f32 v45, v45, v99, v53
    v_fma_f32 v46, v46, v99, v54
    v_fma_f32 v47, v47, v99, v55
    v_fma_f32 v48, v48, v99, v56
    v_fma_f32 v49, v49, v99, v57
    v_fma_f32 v50, v50, v99, v58
    v_fma_f32 v51, v51, v99, v59
    v_cvt_pk_bf16_f32 v16, v44, v45
    v_lshlrev_b32 v44, 16, v16
    v_and_b32 v45, 0xffff0000, v16
    v_cvt_pk_bf16_f32 v16, v46, v47
    v_lshlrev_b32 v46, 16, v16
    v_and_b32 v47, 0xffff0000, v16
    v_cvt_pk_bf16_f32 v16, v48, v49
    v_lshlrev_b32 v48, 16, v16
    v_and_b32 v49, 0xffff0000, v16
    v_cvt_pk_bf16_f32 v16, v50, v51
    v_lshlrev_b32 v50, 16, v16
    v_and_b32 v51, 0xffff0000, v16
    v_lshlrev_b32 v52, 16, v196
    v_and_b32 v53, 0xffff0000, v196
    v_lshlrev_b32 v54, 16, v197
    v_and_b32 v55, 0xffff0000, v197
    v_lshlrev_b32 v56, 16, v198
    v_and_b32 v57, 0xffff0000, v198
    v_lshlrev_b32 v58, 16, v199
    v_and_b32 v59, 0xffff0000, v199
    v_pk_mul_f32 v[44:45], v[44:45], v[52:53]
    v_pk_mul_f32 v[46:47], v[46:47], v[54:55]
    v_pk_mul_f32 v[48:49], v[48:49], v[56:57]
    v_pk_mul_f32 v[50:51], v[50:51], v[58:59]
    v_cvt_pk_bf16_f32 v16, v44, v45
    v_lshlrev_b32 v44, 16, v16
    v_and_b32 v45, 0xffff0000, v16
    v_cvt_pk_bf16_f32 v16, v46, v47
    v_lshlrev_b32 v46, 16, v16
    v_and_b32 v47, 0xffff0000, v16
    v_cvt_pk_bf16_f32 v16, v48, v49
    v_lshlrev_b32 v48, 16, v16
    v_and_b32 v49, 0xffff0000, v16
    v_cvt_pk_bf16_f32 v16, v50, v51
    v_lshlrev_b32 v50, 16, v16
    v_and_b32 v51, 0xffff0000, v16
    v_lshlrev_b32 v52, 16, v188
    v_and_b32 v53, 0xffff0000, v188
    v_lshlrev_b32 v54, 16, v189
    v_and_b32 v55, 0xffff0000, v189
    v_lshlrev_b32 v56, 16, v190
    v_and_b32 v57, 0xffff0000, v190
    v_lshlrev_b32 v58, 16, v191
    v_and_b32 v59, 0xffff0000, v191
    v_pk_add_f32 v[44:45], v[44:45], v[52:53]
    v_pk_add_f32 v[46:47], v[46:47], v[54:55]
    v_pk_add_f32 v[48:49], v[48:49], v[56:57]
    v_pk_add_f32 v[50:51], v[50:51], v[58:59]
    v_cvt_pk_bf16_f32 v16, v44, v45
    v_lshlrev_b32 v44, 16, v16
    v_and_b32 v45, 0xffff0000, v16
    v_cvt_pk_bf16_f32 v16, v46, v47
    v_lshlrev_b32 v46, 16, v16
    v_and_b32 v47, 0xffff0000, v16
    v_cvt_pk_bf16_f32 v16, v48, v49
    v_lshlrev_b32 v48, 16, v16
    v_and_b32 v49, 0xffff0000, v16
    v_cvt_pk_bf16_f32 v16, v50, v51
    v_lshlrev_b32 v50, 16, v16
    v_and_b32 v51, 0xffff0000, v16
    v_lshlrev_b32 v52, 16, v204
    v_and_b32 v53, 0xffff0000, v204
    v_lshlrev_b32 v54, 16, v205
    v_and_b32 v55, 0xffff0000, v205
    v_lshlrev_b32 v56, 16, v206
    v_and_b32 v57, 0xffff0000, v206
    v_lshlrev_b32 v58, 16, v207
    v_and_b32 v59, 0xffff0000, v207
    v_pk_mul_f32 v[44:45], v[44:45], v[52:53]
    v_pk_mul_f32 v[46:47], v[46:47], v[54:55]
    v_pk_mul_f32 v[48:49], v[48:49], v[56:57]
    v_pk_mul_f32 v[50:51], v[50:51], v[58:59]
    v_cvt_pk_bf16_f32 v16, v44, v45
    v_lshlrev_b32 v44, 16, v16
    v_and_b32 v45, 0xffff0000, v16
    v_cvt_pk_bf16_f32 v16, v46, v47
    v_lshlrev_b32 v46, 16, v16
    v_and_b32 v47, 0xffff0000, v16
    v_cvt_pk_bf16_f32 v16, v48, v49
    v_lshlrev_b32 v48, 16, v16
    v_and_b32 v49, 0xffff0000, v16
    v_cvt_pk_bf16_f32 v16, v50, v51
    v_lshlrev_b32 v50, 16, v16
    v_and_b32 v51, 0xffff0000, v16
    v_pk_add_f32 v[44:45], v[44:45], v[36:37]
    v_pk_add_f32 v[46:47], v[46:47], v[38:39]
    v_pk_add_f32 v[48:49], v[48:49], v[40:41]
    v_pk_add_f32 v[50:51], v[50:51], v[42:43]
    v_cvt_pk_bf16_f32 v36, v44, v45
    v_cvt_pk_bf16_f32 v37, v46, v47
    v_cvt_pk_bf16_f32 v38, v48, v49
    v_cvt_pk_bf16_f32 v39, v50, v51
    s_barrier
    v_and_b32 v16, 3, v1
    v_lshlrev_b32 v16, 4, v16
    v_add_u32 v16, 65792, v16
    ds_read_b32 v76, v16
    s_waitcnt lgkmcnt(0)
    v_mov_b32 v77, v76
    s_nop 1
    v_max_u32_dpp v77, v77, v77 row_ror:1 row_mask:0xf bank_mask:0xf
    s_nop 1
    v_max_u32_dpp v77, v77, v77 row_ror:2 row_mask:0xf bank_mask:0xf
    v_cmp_eq_u32 vcc, v76, v77
    s_ff1_i32_b64 s16, vcc
    s_lshl_b32 s16, s16, 4
    s_add_u32 s16, s16, 65792
    v_mov_b32 v16, s16
    ds_read_b128 v[24:27], v16
    s_waitcnt lgkmcnt(0)
    v_and_b32 v76, 0x7ff, v24
    v_sub_u32 v76, 2047, v76
    s_nop 0
    v_readfirstlane_b32 s12, v76
    v_rcp_f32 v103, v26
    s_lshr_b32 s18, s12, 4
    s_lshl_b32 s18, s18, 15
    s_and_b32 s19, s12, 15
    s_lshl_b32 s19, s19, 6
    s_add_u32 s18, s18, s19
    s_add_u32 s18, s18, 0x2000000
    s_add_u32 s19, s18, 0x400000
    v_lshrrev_b32 v18, 4, v0
    v_lshlrev_b32 v18, 10, v18
    v_and_b32 v19, 15, v0
    v_lshl_add_u32 v18, v19, 2, v18
    s_lshl_b32 s13, s12, 11
    buffer_load_dword v100, v18, s[8:11], s18 offen sc1
    buffer_load_dword v101, v18, s[8:11], s19 offen sc1
    buffer_load_dword v102, v21, s[76:79], s13 offen
    s_lshl_b32 s16, s14, 11
    s_cmp_lg_u32 s12, s14
    s_cselect_b32 s16, s16, 0x7ffffff0
    buffer_store_dwordx4 v[28:31], v2, s[68:71], s16 offen offset:0 sc1
    buffer_store_dwordx4 v[36:39], v2, s[68:71], s16 offen offset:1024 sc1
    s_lshl_b32 s16, s3, 13
    v_add_u32 v20, s16, v2
    s_waitcnt vmcnt(4)
    v_lshlrev_b32 v76, 16, v100
    v_and_b32 v77, 0xffff0000, v100
    s_waitcnt vmcnt(3)
    v_lshlrev_b32 v78, 16, v101
    v_and_b32 v79, 0xffff0000, v101
    v_pk_add_f32 v[76:77], v[76:77], v[78:79]
    s_waitcnt vmcnt(2)
    v_lshlrev_b32 v78, 16, v102
    v_and_b32 v79, 0xffff0000, v102
    v_pk_add_f32 v[92:93], v[78:79], v[76:77]
    v_cvt_pk_bf16_f32 v76, v92, v93
    v_lshlrev_b32 v92, 16, v76
    v_and_b32 v93, 0xffff0000, v76
    v_cvt_pk_bf16_f32 v100, v92, v93
    v_and_b32 v105, 0xffff0000, v104
    v_lshlrev_b32 v104, 16, v104
    v_and_b32 v107, 0xffff0000, v106
    v_lshlrev_b32 v106, 16, v106
    v_sub_f32 v92, v92, v25
    v_sub_f32 v93, v93, v25
    v_cvt_pk_bf16_f32 v76, v92, v93
    v_lshlrev_b32 v92, 16, v76
    v_and_b32 v93, 0xffff0000, v76
    v_mul_f32 v77, v92, v103
    v_fma_f32 v92, -v77, v26, v92
    v_fma_f32 v92, v92, v103, v77
    v_mul_f32 v77, v93, v103
    v_fma_f32 v93, -v77, v26, v93
    v_fma_f32 v93, v93, v103, v77
    v_cvt_pk_bf16_f32 v76, v92, v93
    v_lshlrev_b32 v92, 16, v76
    v_and_b32 v93, 0xffff0000, v76
    v_mul_f32 v92, v92, v104
    v_mul_f32 v93, v93, v105
    v_cvt_pk_bf16_f32 v76, v92, v93
    v_lshlrev_b32 v92, 16, v76
    v_and_b32 v93, 0xffff0000, v76
    v_add_f32 v92, v92, v106
    v_add_f32 v93, v93, v107
    v_cvt_pk_bf16_f32 v101, v92, v93
    v_add_u32 v16, 66560, v21
    ds_write_b32 v16, v101
    ds_write_b32 v16, v100 offset:2048
    s_waitcnt lgkmcnt(0)
    s_barrier
    ds_read_b128 v[60:63], v20 offset:0
    ds_read_b128 v[64:67], v20 offset:1024
    ds_read_b128 v[68:71], v20 offset:2048
    ds_read_b128 v[72:75], v20 offset:3072
    ds_read_b128 v[108:111], v20 offset:4096
    ds_read_b128 v[112:115], v20 offset:5120
    ds_read_b128 v[116:119], v20 offset:6144
    ds_read_b128 v[120:123], v20 offset:7168
    s_and_b32 s16, s3, 3
    s_lshl_b32 s16, s16, 7
    s_and_b32 s17, s29, 3
    s_lshl_b32 s17, s17, 9
    s_add_u32 s16, s16, s17
    s_add_u32 s16, s16, 66560
    v_lshrrev_b32 v16, 3, v1
    v_lshlrev_b32 v16, 4, v16
    v_add_u32 v16, s16, v16
    ds_read_b128 v[104:107], v16
    s_waitcnt lgkmcnt(0)
    v_lshlrev_b32 v76, 16, v104
    v_and_b32 v77, 0xffff, v104
    v_dot2_f32_bf16 v85, v60, v76, 0
    v_dot2_f32_bf16 v84, v60, v77, 0
    v_dot2_f32_bf16 v87, v61, v76, 0
    v_dot2_f32_bf16 v86, v61, v77, 0
    v_dot2_f32_bf16 v89, v62, v76, 0
    v_dot2_f32_bf16 v88, v62, v77, 0
    v_dot2_f32_bf16 v91, v63, v76, 0
    v_dot2_f32_bf16 v90, v63, v77, 0
    v_and_b32 v78, 0xffff0000, v104
    v_lshrrev_b32 v79, 16, v104
    v_dot2c_f32_bf16 v85, v64, v78
    v_dot2c_f32_bf16 v84, v64, v79
    v_dot2c_f32_bf16 v87, v65, v78
    v_dot2c_f32_bf16 v86, v65, v79
    v_dot2c_f32_bf16 v89, v66, v78
    v_dot2c_f32_bf16 v88, v66, v79
    v_dot2c_f32_bf16 v91, v67, v78
    v_dot2c_f32_bf16 v90, v67, v79
    v_lshlrev_b32 v80, 16, v105
    v_and_b32 v81, 0xffff, v105
    v_dot2c_f32_bf16 v85, v68, v80
    v_dot2c_f32_bf16 v84, v68, v81
    v_dot2c_f32_bf16 v87, v69, v80
    v_dot2c_f32_bf16 v86, v69, v81
    v_dot2c_f32_bf16 v89, v70, v80
    v_dot2c_f32_bf16 v88, v70, v81
    v_dot2c_f32_bf16 v91, v71, v80
    v_dot2c_f32_bf16 v90, v71, v81
    v_and_b32 v82, 0xffff0000, v105
    v_lshrrev_b32 v83, 16, v105
    v_dot2c_f32_bf16 v85, v72, v82
    v_dot2c_f32_bf16 v84, v72, v83
    v_dot2c_f32_bf16 v87, v73, v82
    v_dot2c_f32_bf16 v86, v73, v83
    v_dot2c_f32_bf16 v89, v74, v82
    v_dot2c_f32_bf16 v88, v74, v83
    v_dot2c_f32_bf16 v91, v75, v82
    v_dot2c_f32_bf16 v90, v75, v83
    v_lshlrev_b32 v76, 16, v106
    v_and_b32 v77, 0xffff, v106
    v_dot2c_f32_bf16 v85, v108, v76
    v_dot2c_f32_bf16 v84, v108, v77
    v_dot2c_f32_bf16 v87, v109, v76
    v_dot2c_f32_bf16 v86, v109, v77
    v_dot2c_f32_bf16 v89, v110, v76
    v_dot2c_f32_bf16 v88, v110, v77
    v_dot2c_f32_bf16 v91, v111, v76
    v_dot2c_f32_bf16 v90, v111, v77
    v_and_b32 v78, 0xffff0000, v106
    v_lshrrev_b32 v79, 16, v106
    v_dot2c_f32_bf16 v85, v112, v78
    v_dot2c_f32_bf16 v84, v112, v79
    v_dot2c_f32_bf16 v87, v113, v78
    v_dot2c_f32_bf16 v86, v113, v79
    v_dot2c_f32_bf16 v89, v114, v78
    v_dot2c_f32_bf16 v88, v114, v79
    v_dot2c_f32_bf16 v91, v115, v78
    v_dot2c_f32_bf16 v90, v115, v79
    v_lshlrev_b32 v80, 16, v107
    v_and_b32 v81, 0xffff, v107
    v_dot2c_f32_bf16 v85, v116, v80
    v_dot2c_f32_bf16 v84, v116, v81
    v_dot2c_f32_bf16 v87, v117, v80
    v_dot2c_f32_bf16 v86, v117, v81
    v_dot2c_f32_bf16 v89, v118, v80
    v_dot2c_f32_bf16 v88, v118, v81
    v_dot2c_f32_bf16 v91, v119, v80
    v_dot2c_f32_bf16 v90, v119, v81
    v_and_b32 v82, 0xffff0000, v107
    v_lshrrev_b32 v83, 16, v107
    v_dot2c_f32_bf16 v85, v120, v82
    v_dot2c_f32_bf16 v84, v120, v83
    v_dot2c_f32_bf16 v87, v121, v82
    v_dot2c_f32_bf16 v86, v121, v83
    v_dot2c_f32_bf16 v89, v122, v82
    v_dot2c_f32_bf16 v88, v122, v83
    v_dot2c_f32_bf16 v91, v123, v82
    v_dot2c_f32_bf16 v90, v123, v83
    s_nop 0
    v_permlane32_swap_b32 v84, v88
    v_permlane32_swap_b32 v85, v89
    v_permlane32_swap_b32 v86, v90
    v_permlane32_swap_b32 v87, v91
    v_add_f32 v84, v84, v88
    v_add_f32 v85, v85, v89
    v_add_f32 v86, v86, v90
    v_add_f32 v87, v87, v91
    s_nop 0
    v_permlane16_swap_b32 v84, v86
    v_permlane16_swap_b32 v85, v87
    v_add_f32 v84, v84, v86
    v_add_f32 v85, v85, v87
    s_nop 0
    v_add_f32_dpp v84, v84, v84 row_ror:8 row_mask:0xf bank_mask:0xf
    v_add_f32_dpp v85, v85, v85 row_ror:8 row_mask:0xf bank_mask:0xf
    v_and_b32 v16, 7, v1
    v_lshlrev_b32 v16, 5, v16
    v_lshrrev_b32 v17, 4, v1
    v_lshl_add_u32 v16, v17, 3, v16
    s_lshl_b32 s16, s3, 8
    s_add_u32 s16, s16, 70656
    v_add_u32 v16, s16, v16
    ds_write_b64 v16, v[84:85]
    s_lshr_b32 s16, s3, 2
    s_lshl_b32 s17, s16, 10
    s_add_u32 s17, s17, 70656
    v_lshlrev_b32 v17, 2, v1
    v_add_u32 v16, s17, v17
    s_and_b32 s17, s29, 3
    s_lshl_b32 s17, s17, 1
    s_add_u32 s17, s17, s16
    s_mul_i32 s17, s17, 14336
    s_lshr_b32 s16, s29, 2
    s_lshl_b32 s16, s16, 8
    s_add_u32 s17, s17, s16
    s_add_u32 s17, s17, 0x6e1000
    s_and_b32 s16, s3, 3
    s_cmp_eq_u32 s16, 0
    s_cselect_b32 s17, s17, 0x7ffffff0
    s_cmp_lt_u32 s2, 224
    s_cselect_b32 s17, s17, 0x7ffffff0
    s_waitcnt lgkmcnt(0)
    s_barrier
    ds_read_b32 v84, v16 offset:0
    ds_read_b32 v85, v16 offset:256
    ds_read_b32 v86, v16 offset:512
    ds_read_b32 v87, v16 offset:768
    s_waitcnt lgkmcnt(2)
    v_add_f32 v84, v84, v85
    s_waitcnt lgkmcnt(0)
    v_add_f32 v86, v86, v87
    v_add_f32 v84, v84, v86
    v_or_b32 v84, 1, v84
    buffer_store_dword v84, v17, s[8:11], s17 offen sc1
    v_lshrrev_b32 v16, 4, v1
    v_mul_u32_u24 v16, 28672, v16
    v_and_b32 v17, 15, v1
    v_lshl_add_u32 v16, v17, 2, v16
    s_lshl_b32 s16, s29, 6
    s_add_u32 s16, s16, 0x6e1000
    s_add_u32 s17, s16, 14336
    s_mov_b32 s27, 0
adaLN_cond__sliding_block_cached__moe_arch_mod__prompt_kernel_gu23p:
    buffer_load_dword v84, v16, s[8:11], s16 offen sc1
    buffer_load_dword v85, v16, s[8:11], s17 offen sc1
    s_waitcnt vmcnt(0)
    v_min_u32 v86, v84, v85
    v_cmp_eq_u32 vcc, 0, v86
    s_cmp_lt_u32 s2, 224
    s_cselect_b64 s[62:63], -1, 0
    s_and_b64 vcc, vcc, s[62:63]
    s_add_u32 s27, s27, 1
    s_cmp_ge_u32 s27, 65536
    s_cbranch_scc1 adaLN_cond__sliding_block_cached__moe_arch_mod__prompt_kernel_gu23g
    s_cbranch_vccnz adaLN_cond__sliding_block_cached__moe_arch_mod__prompt_kernel_gu23p
adaLN_cond__sliding_block_cached__moe_arch_mod__prompt_kernel_gu23g:
    v_mov_b32 v86, v84
    s_nop 1
    v_permlane16_swap_b32 v84, v86
    v_add_f32 v84, v84, v86
    v_mov_b32 v87, v85
    s_nop 1
    v_permlane16_swap_b32 v85, v87
    v_add_f32 v85, v85, v87
    v_mov_b32 v86, v84
    s_nop 1
    v_permlane32_swap_b32 v84, v86
    v_add_f32 v84, v84, v86
    v_mov_b32 v87, v85
    s_nop 1
    v_permlane32_swap_b32 v85, v87
    v_add_f32 v85, v85, v87
    v_cvt_pk_bf16_f32 v86, v84, v85
    v_lshlrev_b32 v84, 16, v86
    v_and_b32 v85, 0xffff0000, v86
    v_mul_f32 v86, 0xbfb8aa3b, v84
    v_exp_f32 v86, v86
    s_nop 0
    v_add_f32 v86, 1.0, v86
    v_rcp_f32 v86, v86
    s_nop 0
    v_mul_f32 v84, v84, v86
    v_cvt_pk_bf16_f32 v84, v84, v84
    v_lshlrev_b32 v84, 16, v84
    v_mul_f32 v84, v84, v85
    v_cvt_pk_bf16_f32 v84, v84, v84
    v_lshlrev_b32 v84, 16, v84
    s_sub_u32 s16, s3, 4
    s_lshl_b32 s16, s16, 2
    s_add_u32 s17, s16, 0
    v_readlane_b32 s20, v84, s17
    s_lshr_b32 s4, s20, 16
    s_add_u32 s17, s16, 1
    v_readlane_b32 s21, v84, s17
    s_lshr_b32 s5, s21, 16
    s_add_u32 s17, s16, 2
    v_readlane_b32 s22, v84, s17
    s_lshr_b32 s6, s22, 16
    s_add_u32 s17, s16, 3
    v_readlane_b32 s23, v84, s17
    s_lshr_b32 s7, s23, 16
    v_dot2_f32_bf16 v45, v152, s20, 0
    v_dot2_f32_bf16 v44, v152, s4, 0
    v_dot2_f32_bf16 v47, v153, s20, 0
    v_dot2_f32_bf16 v46, v153, s4, 0
    v_dot2_f32_bf16 v49, v154, s20, 0
    v_dot2_f32_bf16 v48, v154, s4, 0
    v_dot2_f32_bf16 v51, v155, s20, 0
    v_dot2_f32_bf16 v50, v155, s4, 0
    v_dot2_f32_bf16 v53, v156, s20, 0
    v_dot2_f32_bf16 v52, v156, s4, 0
    v_dot2_f32_bf16 v55, v157, s20, 0
    v_dot2_f32_bf16 v54, v157, s4, 0
    v_dot2_f32_bf16 v57, v158, s20, 0
    v_dot2_f32_bf16 v56, v158, s4, 0
    v_dot2_f32_bf16 v59, v159, s20, 0
    v_dot2_f32_bf16 v58, v159, s4, 0
    v_dot2c_f32_bf16 v45, s21, v160
    v_dot2c_f32_bf16 v44, s5, v160
    v_dot2c_f32_bf16 v47, s21, v161
    v_dot2c_f32_bf16 v46, s5, v161
    v_dot2c_f32_bf16 v49, s21, v162
    v_dot2c_f32_bf16 v48, s5, v162
    v_dot2c_f32_bf16 v51, s21, v163
    v_dot2c_f32_bf16 v50, s5, v163
    v_dot2c_f32_bf16 v53, s21, v164
    v_dot2c_f32_bf16 v52, s5, v164
    v_dot2c_f32_bf16 v55, s21, v165
    v_dot2c_f32_bf16 v54, s5, v165
    v_dot2c_f32_bf16 v57, s21, v166
    v_dot2c_f32_bf16 v56, s5, v166
    v_dot2c_f32_bf16 v59, s21, v167
    v_dot2c_f32_bf16 v58, s5, v167
    v_dot2c_f32_bf16 v45, s22, v168
    v_dot2c_f32_bf16 v44, s6, v168
    v_dot2c_f32_bf16 v47, s22, v169
    v_dot2c_f32_bf16 v46, s6, v169
    v_dot2c_f32_bf16 v49, s22, v170
    v_dot2c_f32_bf16 v48, s6, v170
    v_dot2c_f32_bf16 v51, s22, v171
    v_dot2c_f32_bf16 v50, s6, v171
    v_dot2c_f32_bf16 v53, s22, v172
    v_dot2c_f32_bf16 v52, s6, v172
    v_dot2c_f32_bf16 v55, s22, v173
    v_dot2c_f32_bf16 v54, s6, v173
    v_dot2c_f32_bf16 v57, s22, v174
    v_dot2c_f32_bf16 v56, s6, v174
    v_dot2c_f32_bf16 v59, s22, v175
    v_dot2c_f32_bf16 v58, s6, v175
    v_dot2c_f32_bf16 v45, s23, v176
    v_dot2c_f32_bf16 v44, s7, v176
    v_dot2c_f32_bf16 v47, s23, v177
    v_dot2c_f32_bf16 v46, s7, v177
    v_dot2c_f32_bf16 v49, s23, v178
    v_dot2c_f32_bf16 v48, s7, v178
    v_dot2c_f32_bf16 v51, s23, v179
    v_dot2c_f32_bf16 v50, s7, v179
    v_dot2c_f32_bf16 v53, s23, v180
    v_dot2c_f32_bf16 v52, s7, v180
    v_dot2c_f32_bf16 v55, s23, v181
    v_dot2c_f32_bf16 v54, s7, v181
    v_dot2c_f32_bf16 v57, s23, v182
    v_dot2c_f32_bf16 v56, s7, v182
    v_dot2c_f32_bf16 v59, s23, v183
    v_dot2c_f32_bf16 v58, s7, v183
    s_sub_u32 s16, s3, 4
    s_lshl_b32 s16, s16, 12
    s_add_u32 s16, s16, 73728
    v_lshlrev_b32 v16, 5, v1
    v_add_u32 v16, s16, v16
    ds_write_b128 v16, v[44:47] offset:0
    ds_write_b128 v16, v[48:51] offset:16
    ds_write_b128 v16, v[52:55] offset:2048
    ds_write_b128 v16, v[56:59] offset:2064
    s_waitcnt lgkmcnt(0)
    s_barrier
    v_lshlrev_b32 v16, 3, v0
    v_add_u32 v17, 73728, v16
    ds_read_b64 v[84:85], v17 offset:0
    ds_read_b64 v[86:87], v17 offset:4096
    ds_read_b64 v[88:89], v17 offset:8192
    ds_read_b64 v[90:91], v17 offset:12288
    s_waitcnt lgkmcnt(2)
    v_pk_add_f32 v[84:85], v[84:85], v[86:87]
    s_waitcnt lgkmcnt(0)
    v_pk_add_f32 v[88:89], v[88:89], v[90:91]
    v_pk_add_f32 v[84:85], v[84:85], v[88:89]
    v_or_b32 v84, 1, v84
    v_or_b32 v85, 1, v85
    s_lshl_b32 s16, s29, 12
    s_add_u32 s16, s16, 0x600000
    s_cmp_lt_u32 s2, 224
    s_cselect_b32 s16, s16, 0x7ffffff0
    buffer_store_dwordx2 v[84:85], v16, s[8:11], s16 offen sc1
    s_cmp_lt_u32 s2, 224
    s_cbranch_scc1 adaLN_cond__sliding_block_cached__moe_arch_mod__prompt_kernel_end
    s_sub_u32 s16, s2, 224
    s_lshl_b32 s17, s16, 7
    s_add_u32 s17, s17, 0x600000
    v_lshrrev_b32 v16, 3, v0
    v_lshlrev_b32 v16, 12, v16
    v_and_b32 v17, 7, v0
    v_lshl_add_u32 v16, v17, 4, v16
    v_cmp_gt_u32 vcc, 256, v0
    v_bfrev_b32 v17, -2
    s_nop 0
    v_cndmask_b32 v17, v17, v16, vcc
    v_mov_b32 v19, 0
    v_cndmask_b32 v18, 1, v19, vcc
    s_lshl_b32 s18, s16, 6
    v_and_b32 v19, 31, v1
    v_lshlrev_b32 v19, 1, v19
    v_add_u32 v19, s18, v19
    s_mov_b32 s19, 0x541800
    buffer_load_ushort v95, v19, s[8:11], s19 offen sc1
    v_add_u32 v20, 66560, v19
    ds_read_u16 v96, v20
    ds_read_u16 v97, v20 offset:2048
    v_mov_b32 v94, v27
    v_cvt_pk_bf16_f32 v94, v94, v94
    v_lshlrev_b32 v94, 16, v94
    v_mul_f32 v94, 0xbfb8aa3b, v94
    v_exp_f32 v94, v94
    s_nop 0
    v_add_f32 v94, 1.0, v94
    v_rcp_f32 v94, v94
    s_nop 0
    v_cvt_pk_bf16_f32 v94, v94, v94
    v_lshlrev_b32 v94, 16, v94
    s_waitcnt vmcnt(0)
    v_lshlrev_b32 v95, 16, v95
    s_waitcnt lgkmcnt(1)
    v_lshlrev_b32 v96, 16, v96
    s_waitcnt lgkmcnt(0)
    v_lshlrev_b32 v97, 16, v97
    s_mov_b32 s27, 0
adaLN_cond__sliding_block_cached__moe_arch_mod__prompt_kernel_y24p:
    s_add_u32 s19, s17, 0x0
    buffer_load_dwordx4 v[44:47], v16, s[8:11], s19 offen sc1
    s_add_u32 s19, s17, 0x40000
    buffer_load_dwordx4 v[48:51], v16, s[8:11], s19 offen sc1
    s_add_u32 s19, s17, 0x80000
    buffer_load_dwordx4 v[52:55], v16, s[8:11], s19 offen sc1
    s_add_u32 s19, s17, 0xc0000
    buffer_load_dwordx4 v[56:59], v17, s[8:11], s19 offen sc1
    s_waitcnt vmcnt(0)
    v_min3_u32 v98, v56, v57, v58
    v_min_u32 v98, v98, v59
    v_or_b32 v98, v98, v18
    v_min3_u32 v98, v98, v44, v45
    v_min3_u32 v98, v98, v46, v47
    v_min3_u32 v98, v98, v48, v49
    v_min3_u32 v98, v98, v50, v51
    v_min3_u32 v98, v98, v52, v53
    v_min3_u32 v98, v98, v54, v55
    v_cmp_eq_u32 vcc, 0, v98
    s_add_u32 s27, s27, 1
    s_cmp_ge_u32 s27, 65536
    s_cbranch_scc1 adaLN_cond__sliding_block_cached__moe_arch_mod__prompt_kernel_y24g
    s_cbranch_vccnz adaLN_cond__sliding_block_cached__moe_arch_mod__prompt_kernel_y24p
adaLN_cond__sliding_block_cached__moe_arch_mod__prompt_kernel_y24g:
    v_pk_add_f32 v[44:45], v[44:45], v[52:53]
    v_pk_add_f32 v[46:47], v[46:47], v[54:55]
    v_pk_add_f32 v[48:49], v[48:49], v[56:57]
    v_pk_add_f32 v[50:51], v[50:51], v[58:59]
    v_pk_add_f32 v[44:45], v[44:45], v[48:49]
    v_pk_add_f32 v[46:47], v[46:47], v[50:51]
    s_nop 0
    v_add_f32_dpp v44, v44, v44 row_ror:8 row_mask:0xf bank_mask:0xf
    v_add_f32_dpp v45, v45, v45 row_ror:8 row_mask:0xf bank_mask:0xf
    v_add_f32_dpp v46, v46, v46 row_ror:8 row_mask:0xf bank_mask:0xf
    v_add_f32_dpp v47, v47, v47 row_ror:8 row_mask:0xf bank_mask:0xf
    s_nop 0
    v_permlane32_swap_b32 v44, v46
    v_permlane32_swap_b32 v45, v47
    v_add_f32 v44, v44, v46
    v_add_f32 v45, v45, v47
    s_nop 1
    v_permlane16_swap_b32 v44, v45
    v_add_f32 v44, v44, v45
    v_and_b32 v16, 7, v1
    v_lshlrev_b32 v16, 4, v16
    v_lshrrev_b32 v17, 4, v1
    v_lshl_add_u32 v16, v17, 2, v16
    s_lshl_b32 s19, s3, 7
    s_add_u32 s19, s19, 91136
    v_add_u32 v16, s19, v16
    ds_write_b32 v16, v44
    v_and_b32 v16, 31, v1
    v_lshlrev_b32 v16, 2, v16
    v_add_u32 v16, 91136, v16
    s_waitcnt lgkmcnt(0)
    s_barrier
    s_cmp_lg_u32 s3, 0
    s_cbranch_scc1 adaLN_cond__sliding_block_cached__moe_arch_mod__prompt_kernel_end
    ds_read_b32 v44, v16 offset:0
    ds_read_b32 v45, v16 offset:128
    ds_read_b32 v46, v16 offset:256
    ds_read_b32 v47, v16 offset:384
    ds_read_b32 v48, v16 offset:512
    ds_read_b32 v49, v16 offset:640
    ds_read_b32 v50, v16 offset:768
    ds_read_b32 v51, v16 offset:896
    s_waitcnt lgkmcnt(3)
    v_add_f32 v44, v44, v48
    s_waitcnt lgkmcnt(2)
    v_add_f32 v45, v45, v49
    s_waitcnt lgkmcnt(1)
    v_add_f32 v46, v46, v50
    s_waitcnt lgkmcnt(0)
    v_add_f32 v47, v47, v51
    v_add_f32 v44, v44, v46
    v_add_f32 v45, v45, v47
    v_add_f32 v44, v44, v45
    v_cvt_pk_bf16_f32 v44, v44, v44
    v_lshlrev_b32 v44, 16, v44
    v_mul_f32 v44, v44, v94
    v_cvt_pk_bf16_f32 v44, v44, v44
    v_lshlrev_b32 v44, 16, v44
    v_add_f32 v44, v44, v96
    v_cvt_pk_bf16_f32 v44, v44, v44
    v_lshlrev_b32 v44, 16, v44
    v_mul_f32 v44, v44, v95
    v_cvt_pk_bf16_f32 v44, v44, v44
    v_lshlrev_b32 v44, 16, v44
    v_add_f32 v44, v44, v97
    v_cvt_pk_bf16_f32 v44, v44, v44
    s_mov_b64 exec, 0xffffffff
    buffer_store_short v44, v19, s[68:71], s13 offen sc1
adaLN_cond__sliding_block_cached__moe_arch_mod__prompt_kernel_end:
    s_endpgm
adaLN_cond__sliding_block_cached__moe_arch_mod__prompt_kernel_n1r:
    s_mov_b32 s27, 0
adaLN_cond__sliding_block_cached__moe_arch_mod__prompt_kernel_n1p:
    buffer_load_dword v134, v132, s[64:67], 0 offen sc1
    s_waitcnt vmcnt(0)
    v_cmp_eq_u32 vcc, 0, v134
    s_cmp_eq_u32 s3, 0
    s_cselect_b64 s[62:63], -1, 0
    s_and_b64 vcc, vcc, s[62:63]
    s_add_u32 s27, s27, 1
    s_cmp_ge_u32 s27, 65536
    s_cbranch_scc1 adaLN_cond__sliding_block_cached__moe_arch_mod__prompt_kernel_n1g
    s_cbranch_vccnz adaLN_cond__sliding_block_cached__moe_arch_mod__prompt_kernel_n1p
adaLN_cond__sliding_block_cached__moe_arch_mod__prompt_kernel_n1g:
    s_waitcnt vmcnt(0) lgkmcnt(0)
    s_nop 15
    s_nop 3
    s_branch adaLN_cond__sliding_block_cached__moe_arch_mod__prompt_kernel_n1b
adaLN_cond__sliding_block_cached__moe_arch_mod__prompt_kernel_kv4r:
    s_waitcnt vmcnt(0) lgkmcnt(0)
    s_nop 15
    s_nop 3
    s_mov_b32 s27, 0
adaLN_cond__sliding_block_cached__moe_arch_mod__prompt_kernel_kv4p:
    buffer_load_dwordx4 v[12:15], v21, s[8:11], s18 offen sc1
    s_waitcnt vmcnt(0)
    v_xor_b32 v8, s28, v12
    v_xor_b32 v20, s28, v13
    v_or_b32 v8, v8, v20
    v_xor_b32 v20, s28, v14
    v_or_b32 v8, v8, v20
    v_xor_b32 v20, s28, v15
    v_or_b32 v8, v8, v20
    v_cmp_ne_u32 vcc, 0, v8
    s_add_u32 s27, s27, 1
    s_cmp_ge_u32 s27, 65536
    s_cbranch_scc1 adaLN_cond__sliding_block_cached__moe_arch_mod__prompt_kernel_kv4g
    s_cbranch_vccnz adaLN_cond__sliding_block_cached__moe_arch_mod__prompt_kernel_kv4p
adaLN_cond__sliding_block_cached__moe_arch_mod__prompt_kernel_kv4g:
    s_waitcnt vmcnt(0) lgkmcnt(0)
    s_nop 15
    s_nop 3
    s_branch adaLN_cond__sliding_block_cached__moe_arch_mod__prompt_kernel_kv4b
adaLN_cond__sliding_block_cached__moe_arch_mod__prompt_kernel_fixA:
    s_waitcnt vmcnt(0) lgkmcnt(0)
    s_nop 15
    s_nop 3
    s_lshr_b32 s16, s12, 3
    s_lshl_b32 s16, s16, 17
    s_add_u32 s16, s16, 0x400000
    v_add_u32 v8, s16, v2
    v_mov_b32 v16, 0xff7fffff
    v_mov_b32 v17, 0xff7fffff
    s_mov_b32 s16, 0
adaLN_cond__sliding_block_cached__moe_arch_mod__prompt_kernel_fixAm:
    s_add_u32 s17, s16, 0
    buffer_load_dwordx4 v[200:203], v8, s[8:11], s17 offen offset:0
    buffer_load_dwordx4 v[204:207], v8, s[8:11], s17 offen offset:1024
    buffer_load_dwordx4 v[208:211], v8, s[8:11], s17 offen offset:2048
    buffer_load_dwordx4 v[212:215], v8, s[8:11], s17 offen offset:3072
    s_waitcnt vmcnt(3)
    v_mfma_f32_16x16x32_bf16 v[184:187], v[200:203], v[152:155], 0
    v_mfma_f32_16x16x32_bf16 v[188:191], v[200:203], v[168:171], 0
    s_waitcnt vmcnt(2)
    v_mfma_f32_16x16x32_bf16 v[192:195], v[204:207], v[152:155], 0
    v_mfma_f32_16x16x32_bf16 v[196:199], v[204:207], v[168:171], 0
    s_waitcnt vmcnt(1)
    v_mfma_f32_16x16x32_bf16 v[184:187], v[208:211], v[156:159], v[184:187]
    v_mfma_f32_16x16x32_bf16 v[188:191], v[208:211], v[172:175], v[188:191]
    s_waitcnt vmcnt(0)
    v_mfma_f32_16x16x32_bf16 v[192:195], v[212:215], v[156:159], v[192:195]
    v_mfma_f32_16x16x32_bf16 v[196:199], v[212:215], v[172:175], v[196:199]
    s_add_u32 s17, s16, 4096
    buffer_load_dwordx4 v[200:203], v8, s[8:11], s17 offen offset:0
    buffer_load_dwordx4 v[204:207], v8, s[8:11], s17 offen offset:1024
    buffer_load_dwordx4 v[208:211], v8, s[8:11], s17 offen offset:2048
    buffer_load_dwordx4 v[212:215], v8, s[8:11], s17 offen offset:3072
    s_waitcnt vmcnt(3)
    v_mfma_f32_16x16x32_bf16 v[184:187], v[200:203], v[160:163], v[184:187]
    v_mfma_f32_16x16x32_bf16 v[188:191], v[200:203], v[176:179], v[188:191]
    s_waitcnt vmcnt(2)
    v_mfma_f32_16x16x32_bf16 v[192:195], v[204:207], v[160:163], v[192:195]
    v_mfma_f32_16x16x32_bf16 v[196:199], v[204:207], v[176:179], v[196:199]
    s_waitcnt vmcnt(1)
    v_mfma_f32_16x16x32_bf16 v[184:187], v[208:211], v[164:167], v[184:187]
    v_mfma_f32_16x16x32_bf16 v[188:191], v[208:211], v[180:183], v[188:191]
    s_waitcnt vmcnt(0)
    v_mfma_f32_16x16x32_bf16 v[192:195], v[212:215], v[164:167], v[192:195]
    v_mfma_f32_16x16x32_bf16 v[196:199], v[212:215], v[180:183], v[196:199]
    s_nop 3
    v_max3_f32 v16, v16, v184, v185
    v_max3_f32 v16, v16, v186, v187
    v_max3_f32 v17, v17, v188, v189
    v_max3_f32 v17, v17, v190, v191
    v_max3_f32 v16, v16, v192, v193
    v_max3_f32 v16, v16, v194, v195
    v_max3_f32 v17, v17, v196, v197
    v_max3_f32 v17, v17, v198, v199
    s_add_u32 s16, s16, 8192
    s_cmp_lt_u32 s16, 0x20000
    s_cbranch_scc1 adaLN_cond__sliding_block_cached__moe_arch_mod__prompt_kernel_fixAm
    v_mov_b32 v18, v16
    v_mov_b32 v19, v17
    s_nop 0
    v_permlane16_swap_b32 v16, v18
    v_permlane16_swap_b32 v17, v19
    v_max_f32 v16, v16, v18
    v_max_f32 v17, v17, v19
    v_mov_b32 v18, v16
    v_mov_b32 v19, v17
    s_nop 0
    v_permlane32_swap_b32 v16, v18
    v_permlane32_swap_b32 v17, v19
    v_max_f32 v16, v16, v18
    v_max_f32 v17, v17, v19
    v_sub_f32 v216, 0, v16
    v_sub_f32 v217, 0, v16
    v_sub_f32 v218, 0, v16
    v_sub_f32 v219, 0, v16
    v_sub_f32 v220, 0, v17
    v_sub_f32 v221, 0, v17
    v_sub_f32 v222, 0, v17
    v_sub_f32 v223, 0, v17
    s_mov_b32 s17, 0x0
    buffer_load_dwordx4 v[200:203], v8, s[8:11], s17 offen offset:0
    buffer_load_dwordx4 v[204:207], v8, s[8:11], s17 offen offset:1024
    buffer_load_dwordx4 v[208:211], v8, s[8:11], s17 offen offset:2048
    buffer_load_dwordx4 v[212:215], v8, s[8:11], s17 offen offset:3072
    s_waitcnt vmcnt(3)
    v_mfma_f32_16x16x32_bf16 v[184:187], v[200:203], v[152:155], v[216:219]
    v_mfma_f32_16x16x32_bf16 v[188:191], v[200:203], v[168:171], v[220:223]
    s_waitcnt vmcnt(2)
    v_mfma_f32_16x16x32_bf16 v[192:195], v[204:207], v[152:155], v[216:219]
    v_mfma_f32_16x16x32_bf16 v[196:199], v[204:207], v[168:171], v[220:223]
    s_waitcnt vmcnt(1)
    v_mfma_f32_16x16x32_bf16 v[184:187], v[208:211], v[156:159], v[184:187]
    v_mfma_f32_16x16x32_bf16 v[188:191], v[208:211], v[172:175], v[188:191]
    s_waitcnt vmcnt(0)
    v_mfma_f32_16x16x32_bf16 v[192:195], v[212:215], v[156:159], v[192:195]
    v_mfma_f32_16x16x32_bf16 v[196:199], v[212:215], v[172:175], v[196:199]
    s_mov_b32 s17, 0x1000
    buffer_load_dwordx4 v[200:203], v8, s[8:11], s17 offen offset:0
    buffer_load_dwordx4 v[204:207], v8, s[8:11], s17 offen offset:1024
    buffer_load_dwordx4 v[208:211], v8, s[8:11], s17 offen offset:2048
    buffer_load_dwordx4 v[212:215], v8, s[8:11], s17 offen offset:3072
    s_waitcnt vmcnt(3)
    v_mfma_f32_16x16x32_bf16 v[184:187], v[200:203], v[160:163], v[184:187]
    v_mfma_f32_16x16x32_bf16 v[188:191], v[200:203], v[176:179], v[188:191]
    s_waitcnt vmcnt(2)
    v_mfma_f32_16x16x32_bf16 v[192:195], v[204:207], v[160:163], v[192:195]
    v_mfma_f32_16x16x32_bf16 v[196:199], v[204:207], v[176:179], v[196:199]
    s_waitcnt vmcnt(1)
    v_mfma_f32_16x16x32_bf16 v[184:187], v[208:211], v[164:167], v[184:187]
    v_mfma_f32_16x16x32_bf16 v[188:191], v[208:211], v[180:183], v[188:191]
    s_waitcnt vmcnt(0)
    v_mfma_f32_16x16x32_bf16 v[192:195], v[212:215], v[164:167], v[192:195]
    v_mfma_f32_16x16x32_bf16 v[196:199], v[212:215], v[180:183], v[196:199]
    s_nop 3
    v_exp_f32 v184, v184
    v_exp_f32 v185, v185
    s_nop 0
    v_add_f32 v9, v184, v185
    v_cvt_pk_bf16_f32 v24, v184, v185
    v_exp_f32 v186, v186
    v_exp_f32 v187, v187
    v_add_f32 v9, v9, v186
    v_add_f32 v9, v9, v187
    v_cvt_pk_bf16_f32 v25, v186, v187
    v_exp_f32 v188, v188
    v_exp_f32 v189, v189
    s_nop 0
    v_add_f32 v10, v188, v189
    v_cvt_pk_bf16_f32 v28, v188, v189
    v_exp_f32 v190, v190
    v_exp_f32 v191, v191
    v_add_f32 v10, v10, v190
    v_add_f32 v10, v10, v191
    v_cvt_pk_bf16_f32 v29, v190, v191
    v_exp_f32 v192, v192
    v_exp_f32 v193, v193
    v_add_f32 v9, v9, v192
    v_add_f32 v9, v9, v193
    v_cvt_pk_bf16_f32 v26, v192, v193
    v_exp_f32 v194, v194
    v_exp_f32 v195, v195
    v_add_f32 v9, v9, v194
    v_add_f32 v9, v9, v195
    v_cvt_pk_bf16_f32 v27, v194, v195
    v_exp_f32 v196, v196
    v_exp_f32 v197, v197
    v_add_f32 v10, v10, v196
    v_add_f32 v10, v10, v197
    v_cvt_pk_bf16_f32 v30, v196, v197
    v_exp_f32 v198, v198
    v_exp_f32 v199, v199
    v_add_f32 v10, v10, v198
    v_add_f32 v10, v10, v199
    v_cvt_pk_bf16_f32 v31, v198, v199
    s_mov_b32 s17, 0x2000
    buffer_load_dwordx4 v[200:203], v8, s[8:11], s17 offen offset:0
    buffer_load_dwordx4 v[204:207], v8, s[8:11], s17 offen offset:1024
    buffer_load_dwordx4 v[208:211], v8, s[8:11], s17 offen offset:2048
    buffer_load_dwordx4 v[212:215], v8, s[8:11], s17 offen offset:3072
    s_waitcnt vmcnt(3)
    v_mfma_f32_16x16x32_bf16 v[184:187], v[200:203], v[152:155], v[216:219]
    v_mfma_f32_16x16x32_bf16 v[188:191], v[200:203], v[168:171], v[220:223]
    s_waitcnt vmcnt(2)
    v_mfma_f32_16x16x32_bf16 v[192:195], v[204:207], v[152:155], v[216:219]
    v_mfma_f32_16x16x32_bf16 v[196:199], v[204:207], v[168:171], v[220:223]
    s_waitcnt vmcnt(1)
    v_mfma_f32_16x16x32_bf16 v[184:187], v[208:211], v[156:159], v[184:187]
    v_mfma_f32_16x16x32_bf16 v[188:191], v[208:211], v[172:175], v[188:191]
    s_waitcnt vmcnt(0)
    v_mfma_f32_16x16x32_bf16 v[192:195], v[212:215], v[156:159], v[192:195]
    v_mfma_f32_16x16x32_bf16 v[196:199], v[212:215], v[172:175], v[196:199]
    s_mov_b32 s17, 0x3000
    buffer_load_dwordx4 v[200:203], v8, s[8:11], s17 offen offset:0
    buffer_load_dwordx4 v[204:207], v8, s[8:11], s17 offen offset:1024
    buffer_load_dwordx4 v[208:211], v8, s[8:11], s17 offen offset:2048
    buffer_load_dwordx4 v[212:215], v8, s[8:11], s17 offen offset:3072
    s_waitcnt vmcnt(3)
    v_mfma_f32_16x16x32_bf16 v[184:187], v[200:203], v[160:163], v[184:187]
    v_mfma_f32_16x16x32_bf16 v[188:191], v[200:203], v[176:179], v[188:191]
    s_waitcnt vmcnt(2)
    v_mfma_f32_16x16x32_bf16 v[192:195], v[204:207], v[160:163], v[192:195]
    v_mfma_f32_16x16x32_bf16 v[196:199], v[204:207], v[176:179], v[196:199]
    s_waitcnt vmcnt(1)
    v_mfma_f32_16x16x32_bf16 v[184:187], v[208:211], v[164:167], v[184:187]
    v_mfma_f32_16x16x32_bf16 v[188:191], v[208:211], v[180:183], v[188:191]
    s_waitcnt vmcnt(0)
    v_mfma_f32_16x16x32_bf16 v[192:195], v[212:215], v[164:167], v[192:195]
    v_mfma_f32_16x16x32_bf16 v[196:199], v[212:215], v[180:183], v[196:199]
    s_nop 3
    v_exp_f32 v184, v184
    v_exp_f32 v185, v185
    v_add_f32 v9, v9, v184
    v_add_f32 v9, v9, v185
    v_cvt_pk_bf16_f32 v32, v184, v185
    v_exp_f32 v186, v186
    v_exp_f32 v187, v187
    v_add_f32 v9, v9, v186
    v_add_f32 v9, v9, v187
    v_cvt_pk_bf16_f32 v33, v186, v187
    v_exp_f32 v188, v188
    v_exp_f32 v189, v189
    v_add_f32 v10, v10, v188
    v_add_f32 v10, v10, v189
    v_cvt_pk_bf16_f32 v36, v188, v189
    v_exp_f32 v190, v190
    v_exp_f32 v191, v191
    v_add_f32 v10, v10, v190
    v_add_f32 v10, v10, v191
    v_cvt_pk_bf16_f32 v37, v190, v191
    v_exp_f32 v192, v192
    v_exp_f32 v193, v193
    v_add_f32 v9, v9, v192
    v_add_f32 v9, v9, v193
    v_cvt_pk_bf16_f32 v34, v192, v193
    v_exp_f32 v194, v194
    v_exp_f32 v195, v195
    v_add_f32 v9, v9, v194
    v_add_f32 v9, v9, v195
    v_cvt_pk_bf16_f32 v35, v194, v195
    v_exp_f32 v196, v196
    v_exp_f32 v197, v197
    v_add_f32 v10, v10, v196
    v_add_f32 v10, v10, v197
    v_cvt_pk_bf16_f32 v38, v196, v197
    v_exp_f32 v198, v198
    v_exp_f32 v199, v199
    v_add_f32 v10, v10, v198
    v_add_f32 v10, v10, v199
    v_cvt_pk_bf16_f32 v39, v198, v199
    s_mov_b32 s17, 0x4000
    buffer_load_dwordx4 v[200:203], v8, s[8:11], s17 offen offset:0
    buffer_load_dwordx4 v[204:207], v8, s[8:11], s17 offen offset:1024
    buffer_load_dwordx4 v[208:211], v8, s[8:11], s17 offen offset:2048
    buffer_load_dwordx4 v[212:215], v8, s[8:11], s17 offen offset:3072
    s_waitcnt vmcnt(3)
    v_mfma_f32_16x16x32_bf16 v[184:187], v[200:203], v[152:155], v[216:219]
    v_mfma_f32_16x16x32_bf16 v[188:191], v[200:203], v[168:171], v[220:223]
    s_waitcnt vmcnt(2)
    v_mfma_f32_16x16x32_bf16 v[192:195], v[204:207], v[152:155], v[216:219]
    v_mfma_f32_16x16x32_bf16 v[196:199], v[204:207], v[168:171], v[220:223]
    s_waitcnt vmcnt(1)
    v_mfma_f32_16x16x32_bf16 v[184:187], v[208:211], v[156:159], v[184:187]
    v_mfma_f32_16x16x32_bf16 v[188:191], v[208:211], v[172:175], v[188:191]
    s_waitcnt vmcnt(0)
    v_mfma_f32_16x16x32_bf16 v[192:195], v[212:215], v[156:159], v[192:195]
    v_mfma_f32_16x16x32_bf16 v[196:199], v[212:215], v[172:175], v[196:199]
    s_mov_b32 s17, 0x5000
    buffer_load_dwordx4 v[200:203], v8, s[8:11], s17 offen offset:0
    buffer_load_dwordx4 v[204:207], v8, s[8:11], s17 offen offset:1024
    buffer_load_dwordx4 v[208:211], v8, s[8:11], s17 offen offset:2048
    buffer_load_dwordx4 v[212:215], v8, s[8:11], s17 offen offset:3072
    s_waitcnt vmcnt(3)
    v_mfma_f32_16x16x32_bf16 v[184:187], v[200:203], v[160:163], v[184:187]
    v_mfma_f32_16x16x32_bf16 v[188:191], v[200:203], v[176:179], v[188:191]
    s_waitcnt vmcnt(2)
    v_mfma_f32_16x16x32_bf16 v[192:195], v[204:207], v[160:163], v[192:195]
    v_mfma_f32_16x16x32_bf16 v[196:199], v[204:207], v[176:179], v[196:199]
    s_waitcnt vmcnt(1)
    v_mfma_f32_16x16x32_bf16 v[184:187], v[208:211], v[164:167], v[184:187]
    v_mfma_f32_16x16x32_bf16 v[188:191], v[208:211], v[180:183], v[188:191]
    s_waitcnt vmcnt(0)
    v_mfma_f32_16x16x32_bf16 v[192:195], v[212:215], v[164:167], v[192:195]
    v_mfma_f32_16x16x32_bf16 v[196:199], v[212:215], v[180:183], v[196:199]
    s_nop 3
    v_exp_f32 v184, v184
    v_exp_f32 v185, v185
    v_add_f32 v9, v9, v184
    v_add_f32 v9, v9, v185
    v_cvt_pk_bf16_f32 v40, v184, v185
    v_exp_f32 v186, v186
    v_exp_f32 v187, v187
    v_add_f32 v9, v9, v186
    v_add_f32 v9, v9, v187
    v_cvt_pk_bf16_f32 v41, v186, v187
    v_exp_f32 v188, v188
    v_exp_f32 v189, v189
    v_add_f32 v10, v10, v188
    v_add_f32 v10, v10, v189
    v_cvt_pk_bf16_f32 v44, v188, v189
    v_exp_f32 v190, v190
    v_exp_f32 v191, v191
    v_add_f32 v10, v10, v190
    v_add_f32 v10, v10, v191
    v_cvt_pk_bf16_f32 v45, v190, v191
    v_exp_f32 v192, v192
    v_exp_f32 v193, v193
    v_add_f32 v9, v9, v192
    v_add_f32 v9, v9, v193
    v_cvt_pk_bf16_f32 v42, v192, v193
    v_exp_f32 v194, v194
    v_exp_f32 v195, v195
    v_add_f32 v9, v9, v194
    v_add_f32 v9, v9, v195
    v_cvt_pk_bf16_f32 v43, v194, v195
    v_exp_f32 v196, v196
    v_exp_f32 v197, v197
    v_add_f32 v10, v10, v196
    v_add_f32 v10, v10, v197
    v_cvt_pk_bf16_f32 v46, v196, v197
    v_exp_f32 v198, v198
    v_exp_f32 v199, v199
    v_add_f32 v10, v10, v198
    v_add_f32 v10, v10, v199
    v_cvt_pk_bf16_f32 v47, v198, v199
    s_mov_b32 s17, 0x6000
    buffer_load_dwordx4 v[200:203], v8, s[8:11], s17 offen offset:0
    buffer_load_dwordx4 v[204:207], v8, s[8:11], s17 offen offset:1024
    buffer_load_dwordx4 v[208:211], v8, s[8:11], s17 offen offset:2048
    buffer_load_dwordx4 v[212:215], v8, s[8:11], s17 offen offset:3072
    s_waitcnt vmcnt(3)
    v_mfma_f32_16x16x32_bf16 v[184:187], v[200:203], v[152:155], v[216:219]
    v_mfma_f32_16x16x32_bf16 v[188:191], v[200:203], v[168:171], v[220:223]
    s_waitcnt vmcnt(2)
    v_mfma_f32_16x16x32_bf16 v[192:195], v[204:207], v[152:155], v[216:219]
    v_mfma_f32_16x16x32_bf16 v[196:199], v[204:207], v[168:171], v[220:223]
    s_waitcnt vmcnt(1)
    v_mfma_f32_16x16x32_bf16 v[184:187], v[208:211], v[156:159], v[184:187]
    v_mfma_f32_16x16x32_bf16 v[188:191], v[208:211], v[172:175], v[188:191]
    s_waitcnt vmcnt(0)
    v_mfma_f32_16x16x32_bf16 v[192:195], v[212:215], v[156:159], v[192:195]
    v_mfma_f32_16x16x32_bf16 v[196:199], v[212:215], v[172:175], v[196:199]
    s_mov_b32 s17, 0x7000
    buffer_load_dwordx4 v[200:203], v8, s[8:11], s17 offen offset:0
    buffer_load_dwordx4 v[204:207], v8, s[8:11], s17 offen offset:1024
    buffer_load_dwordx4 v[208:211], v8, s[8:11], s17 offen offset:2048
    buffer_load_dwordx4 v[212:215], v8, s[8:11], s17 offen offset:3072
    s_waitcnt vmcnt(3)
    v_mfma_f32_16x16x32_bf16 v[184:187], v[200:203], v[160:163], v[184:187]
    v_mfma_f32_16x16x32_bf16 v[188:191], v[200:203], v[176:179], v[188:191]
    s_waitcnt vmcnt(2)
    v_mfma_f32_16x16x32_bf16 v[192:195], v[204:207], v[160:163], v[192:195]
    v_mfma_f32_16x16x32_bf16 v[196:199], v[204:207], v[176:179], v[196:199]
    s_waitcnt vmcnt(1)
    v_mfma_f32_16x16x32_bf16 v[184:187], v[208:211], v[164:167], v[184:187]
    v_mfma_f32_16x16x32_bf16 v[188:191], v[208:211], v[180:183], v[188:191]
    s_waitcnt vmcnt(0)
    v_mfma_f32_16x16x32_bf16 v[192:195], v[212:215], v[164:167], v[192:195]
    v_mfma_f32_16x16x32_bf16 v[196:199], v[212:215], v[180:183], v[196:199]
    s_nop 3
    v_exp_f32 v184, v184
    v_exp_f32 v185, v185
    v_add_f32 v9, v9, v184
    v_add_f32 v9, v9, v185
    v_cvt_pk_bf16_f32 v48, v184, v185
    v_exp_f32 v186, v186
    v_exp_f32 v187, v187
    v_add_f32 v9, v9, v186
    v_add_f32 v9, v9, v187
    v_cvt_pk_bf16_f32 v49, v186, v187
    v_exp_f32 v188, v188
    v_exp_f32 v189, v189
    v_add_f32 v10, v10, v188
    v_add_f32 v10, v10, v189
    v_cvt_pk_bf16_f32 v52, v188, v189
    v_exp_f32 v190, v190
    v_exp_f32 v191, v191
    v_add_f32 v10, v10, v190
    v_add_f32 v10, v10, v191
    v_cvt_pk_bf16_f32 v53, v190, v191
    v_exp_f32 v192, v192
    v_exp_f32 v193, v193
    v_add_f32 v9, v9, v192
    v_add_f32 v9, v9, v193
    v_cvt_pk_bf16_f32 v50, v192, v193
    v_exp_f32 v194, v194
    v_exp_f32 v195, v195
    v_add_f32 v9, v9, v194
    v_add_f32 v9, v9, v195
    v_cvt_pk_bf16_f32 v51, v194, v195
    v_exp_f32 v196, v196
    v_exp_f32 v197, v197
    v_add_f32 v10, v10, v196
    v_add_f32 v10, v10, v197
    v_cvt_pk_bf16_f32 v54, v196, v197
    v_exp_f32 v198, v198
    v_exp_f32 v199, v199
    v_add_f32 v10, v10, v198
    v_add_f32 v10, v10, v199
    v_cvt_pk_bf16_f32 v55, v198, v199
    s_mov_b32 s17, 0x8000
    buffer_load_dwordx4 v[200:203], v8, s[8:11], s17 offen offset:0
    buffer_load_dwordx4 v[204:207], v8, s[8:11], s17 offen offset:1024
    buffer_load_dwordx4 v[208:211], v8, s[8:11], s17 offen offset:2048
    buffer_load_dwordx4 v[212:215], v8, s[8:11], s17 offen offset:3072
    s_waitcnt vmcnt(3)
    v_mfma_f32_16x16x32_bf16 v[184:187], v[200:203], v[152:155], v[216:219]
    v_mfma_f32_16x16x32_bf16 v[188:191], v[200:203], v[168:171], v[220:223]
    s_waitcnt vmcnt(2)
    v_mfma_f32_16x16x32_bf16 v[192:195], v[204:207], v[152:155], v[216:219]
    v_mfma_f32_16x16x32_bf16 v[196:199], v[204:207], v[168:171], v[220:223]
    s_waitcnt vmcnt(1)
    v_mfma_f32_16x16x32_bf16 v[184:187], v[208:211], v[156:159], v[184:187]
    v_mfma_f32_16x16x32_bf16 v[188:191], v[208:211], v[172:175], v[188:191]
    s_waitcnt vmcnt(0)
    v_mfma_f32_16x16x32_bf16 v[192:195], v[212:215], v[156:159], v[192:195]
    v_mfma_f32_16x16x32_bf16 v[196:199], v[212:215], v[172:175], v[196:199]
    s_mov_b32 s17, 0x9000
    buffer_load_dwordx4 v[200:203], v8, s[8:11], s17 offen offset:0
    buffer_load_dwordx4 v[204:207], v8, s[8:11], s17 offen offset:1024
    buffer_load_dwordx4 v[208:211], v8, s[8:11], s17 offen offset:2048
    buffer_load_dwordx4 v[212:215], v8, s[8:11], s17 offen offset:3072
    s_waitcnt vmcnt(3)
    v_mfma_f32_16x16x32_bf16 v[184:187], v[200:203], v[160:163], v[184:187]
    v_mfma_f32_16x16x32_bf16 v[188:191], v[200:203], v[176:179], v[188:191]
    s_waitcnt vmcnt(2)
    v_mfma_f32_16x16x32_bf16 v[192:195], v[204:207], v[160:163], v[192:195]
    v_mfma_f32_16x16x32_bf16 v[196:199], v[204:207], v[176:179], v[196:199]
    s_waitcnt vmcnt(1)
    v_mfma_f32_16x16x32_bf16 v[184:187], v[208:211], v[164:167], v[184:187]
    v_mfma_f32_16x16x32_bf16 v[188:191], v[208:211], v[180:183], v[188:191]
    s_waitcnt vmcnt(0)
    v_mfma_f32_16x16x32_bf16 v[192:195], v[212:215], v[164:167], v[192:195]
    v_mfma_f32_16x16x32_bf16 v[196:199], v[212:215], v[180:183], v[196:199]
    s_nop 3
    v_exp_f32 v184, v184
    v_exp_f32 v185, v185
    v_add_f32 v9, v9, v184
    v_add_f32 v9, v9, v185
    v_cvt_pk_bf16_f32 v56, v184, v185
    v_exp_f32 v186, v186
    v_exp_f32 v187, v187
    v_add_f32 v9, v9, v186
    v_add_f32 v9, v9, v187
    v_cvt_pk_bf16_f32 v57, v186, v187
    v_exp_f32 v188, v188
    v_exp_f32 v189, v189
    v_add_f32 v10, v10, v188
    v_add_f32 v10, v10, v189
    v_cvt_pk_bf16_f32 v60, v188, v189
    v_exp_f32 v190, v190
    v_exp_f32 v191, v191
    v_add_f32 v10, v10, v190
    v_add_f32 v10, v10, v191
    v_cvt_pk_bf16_f32 v61, v190, v191
    v_exp_f32 v192, v192
    v_exp_f32 v193, v193
    v_add_f32 v9, v9, v192
    v_add_f32 v9, v9, v193
    v_cvt_pk_bf16_f32 v58, v192, v193
    v_exp_f32 v194, v194
    v_exp_f32 v195, v195
    v_add_f32 v9, v9, v194
    v_add_f32 v9, v9, v195
    v_cvt_pk_bf16_f32 v59, v194, v195
    v_exp_f32 v196, v196
    v_exp_f32 v197, v197
    v_add_f32 v10, v10, v196
    v_add_f32 v10, v10, v197
    v_cvt_pk_bf16_f32 v62, v196, v197
    v_exp_f32 v198, v198
    v_exp_f32 v199, v199
    v_add_f32 v10, v10, v198
    v_add_f32 v10, v10, v199
    v_cvt_pk_bf16_f32 v63, v198, v199
    s_mov_b32 s17, 0xa000
    buffer_load_dwordx4 v[200:203], v8, s[8:11], s17 offen offset:0
    buffer_load_dwordx4 v[204:207], v8, s[8:11], s17 offen offset:1024
    buffer_load_dwordx4 v[208:211], v8, s[8:11], s17 offen offset:2048
    buffer_load_dwordx4 v[212:215], v8, s[8:11], s17 offen offset:3072
    s_waitcnt vmcnt(3)
    v_mfma_f32_16x16x32_bf16 v[184:187], v[200:203], v[152:155], v[216:219]
    v_mfma_f32_16x16x32_bf16 v[188:191], v[200:203], v[168:171], v[220:223]
    s_waitcnt vmcnt(2)
    v_mfma_f32_16x16x32_bf16 v[192:195], v[204:207], v[152:155], v[216:219]
    v_mfma_f32_16x16x32_bf16 v[196:199], v[204:207], v[168:171], v[220:223]
    s_waitcnt vmcnt(1)
    v_mfma_f32_16x16x32_bf16 v[184:187], v[208:211], v[156:159], v[184:187]
    v_mfma_f32_16x16x32_bf16 v[188:191], v[208:211], v[172:175], v[188:191]
    s_waitcnt vmcnt(0)
    v_mfma_f32_16x16x32_bf16 v[192:195], v[212:215], v[156:159], v[192:195]
    v_mfma_f32_16x16x32_bf16 v[196:199], v[212:215], v[172:175], v[196:199]
    s_mov_b32 s17, 0xb000
    buffer_load_dwordx4 v[200:203], v8, s[8:11], s17 offen offset:0
    buffer_load_dwordx4 v[204:207], v8, s[8:11], s17 offen offset:1024
    buffer_load_dwordx4 v[208:211], v8, s[8:11], s17 offen offset:2048
    buffer_load_dwordx4 v[212:215], v8, s[8:11], s17 offen offset:3072
    s_waitcnt vmcnt(3)
    v_mfma_f32_16x16x32_bf16 v[184:187], v[200:203], v[160:163], v[184:187]
    v_mfma_f32_16x16x32_bf16 v[188:191], v[200:203], v[176:179], v[188:191]
    s_waitcnt vmcnt(2)
    v_mfma_f32_16x16x32_bf16 v[192:195], v[204:207], v[160:163], v[192:195]
    v_mfma_f32_16x16x32_bf16 v[196:199], v[204:207], v[176:179], v[196:199]
    s_waitcnt vmcnt(1)
    v_mfma_f32_16x16x32_bf16 v[184:187], v[208:211], v[164:167], v[184:187]
    v_mfma_f32_16x16x32_bf16 v[188:191], v[208:211], v[180:183], v[188:191]
    s_waitcnt vmcnt(0)
    v_mfma_f32_16x16x32_bf16 v[192:195], v[212:215], v[164:167], v[192:195]
    v_mfma_f32_16x16x32_bf16 v[196:199], v[212:215], v[180:183], v[196:199]
    s_nop 3
    v_exp_f32 v184, v184
    v_exp_f32 v185, v185
    v_add_f32 v9, v9, v184
    v_add_f32 v9, v9, v185
    v_cvt_pk_bf16_f32 v64, v184, v185
    v_exp_f32 v186, v186
    v_exp_f32 v187, v187
    v_add_f32 v9, v9, v186
    v_add_f32 v9, v9, v187
    v_cvt_pk_bf16_f32 v65, v186, v187
    v_exp_f32 v188, v188
    v_exp_f32 v189, v189
    v_add_f32 v10, v10, v188
    v_add_f32 v10, v10, v189
    v_cvt_pk_bf16_f32 v68, v188, v189
    v_exp_f32 v190, v190
    v_exp_f32 v191, v191
    v_add_f32 v10, v10, v190
    v_add_f32 v10, v10, v191
    v_cvt_pk_bf16_f32 v69, v190, v191
    v_exp_f32 v192, v192
    v_exp_f32 v193, v193
    v_add_f32 v9, v9, v192
    v_add_f32 v9, v9, v193
    v_cvt_pk_bf16_f32 v66, v192, v193
    v_exp_f32 v194, v194
    v_exp_f32 v195, v195
    v_add_f32 v9, v9, v194
    v_add_f32 v9, v9, v195
    v_cvt_pk_bf16_f32 v67, v194, v195
    v_exp_f32 v196, v196
    v_exp_f32 v197, v197
    v_add_f32 v10, v10, v196
    v_add_f32 v10, v10, v197
    v_cvt_pk_bf16_f32 v70, v196, v197
    v_exp_f32 v198, v198
    v_exp_f32 v199, v199
    v_add_f32 v10, v10, v198
    v_add_f32 v10, v10, v199
    v_cvt_pk_bf16_f32 v71, v198, v199
    s_mov_b32 s17, 0xc000
    buffer_load_dwordx4 v[200:203], v8, s[8:11], s17 offen offset:0
    buffer_load_dwordx4 v[204:207], v8, s[8:11], s17 offen offset:1024
    buffer_load_dwordx4 v[208:211], v8, s[8:11], s17 offen offset:2048
    buffer_load_dwordx4 v[212:215], v8, s[8:11], s17 offen offset:3072
    s_waitcnt vmcnt(3)
    v_mfma_f32_16x16x32_bf16 v[184:187], v[200:203], v[152:155], v[216:219]
    v_mfma_f32_16x16x32_bf16 v[188:191], v[200:203], v[168:171], v[220:223]
    s_waitcnt vmcnt(2)
    v_mfma_f32_16x16x32_bf16 v[192:195], v[204:207], v[152:155], v[216:219]
    v_mfma_f32_16x16x32_bf16 v[196:199], v[204:207], v[168:171], v[220:223]
    s_waitcnt vmcnt(1)
    v_mfma_f32_16x16x32_bf16 v[184:187], v[208:211], v[156:159], v[184:187]
    v_mfma_f32_16x16x32_bf16 v[188:191], v[208:211], v[172:175], v[188:191]
    s_waitcnt vmcnt(0)
    v_mfma_f32_16x16x32_bf16 v[192:195], v[212:215], v[156:159], v[192:195]
    v_mfma_f32_16x16x32_bf16 v[196:199], v[212:215], v[172:175], v[196:199]
    s_mov_b32 s17, 0xd000
    buffer_load_dwordx4 v[200:203], v8, s[8:11], s17 offen offset:0
    buffer_load_dwordx4 v[204:207], v8, s[8:11], s17 offen offset:1024
    buffer_load_dwordx4 v[208:211], v8, s[8:11], s17 offen offset:2048
    buffer_load_dwordx4 v[212:215], v8, s[8:11], s17 offen offset:3072
    s_waitcnt vmcnt(3)
    v_mfma_f32_16x16x32_bf16 v[184:187], v[200:203], v[160:163], v[184:187]
    v_mfma_f32_16x16x32_bf16 v[188:191], v[200:203], v[176:179], v[188:191]
    s_waitcnt vmcnt(2)
    v_mfma_f32_16x16x32_bf16 v[192:195], v[204:207], v[160:163], v[192:195]
    v_mfma_f32_16x16x32_bf16 v[196:199], v[204:207], v[176:179], v[196:199]
    s_waitcnt vmcnt(1)
    v_mfma_f32_16x16x32_bf16 v[184:187], v[208:211], v[164:167], v[184:187]
    v_mfma_f32_16x16x32_bf16 v[188:191], v[208:211], v[180:183], v[188:191]
    s_waitcnt vmcnt(0)
    v_mfma_f32_16x16x32_bf16 v[192:195], v[212:215], v[164:167], v[192:195]
    v_mfma_f32_16x16x32_bf16 v[196:199], v[212:215], v[180:183], v[196:199]
    s_nop 3
    v_exp_f32 v184, v184
    v_exp_f32 v185, v185
    v_add_f32 v9, v9, v184
    v_add_f32 v9, v9, v185
    v_cvt_pk_bf16_f32 v72, v184, v185
    v_exp_f32 v186, v186
    v_exp_f32 v187, v187
    v_add_f32 v9, v9, v186
    v_add_f32 v9, v9, v187
    v_cvt_pk_bf16_f32 v73, v186, v187
    v_exp_f32 v188, v188
    v_exp_f32 v189, v189
    v_add_f32 v10, v10, v188
    v_add_f32 v10, v10, v189
    v_cvt_pk_bf16_f32 v76, v188, v189
    v_exp_f32 v190, v190
    v_exp_f32 v191, v191
    v_add_f32 v10, v10, v190
    v_add_f32 v10, v10, v191
    v_cvt_pk_bf16_f32 v77, v190, v191
    v_exp_f32 v192, v192
    v_exp_f32 v193, v193
    v_add_f32 v9, v9, v192
    v_add_f32 v9, v9, v193
    v_cvt_pk_bf16_f32 v74, v192, v193
    v_exp_f32 v194, v194
    v_exp_f32 v195, v195
    v_add_f32 v9, v9, v194
    v_add_f32 v9, v9, v195
    v_cvt_pk_bf16_f32 v75, v194, v195
    v_exp_f32 v196, v196
    v_exp_f32 v197, v197
    v_add_f32 v10, v10, v196
    v_add_f32 v10, v10, v197
    v_cvt_pk_bf16_f32 v78, v196, v197
    v_exp_f32 v198, v198
    v_exp_f32 v199, v199
    v_add_f32 v10, v10, v198
    v_add_f32 v10, v10, v199
    v_cvt_pk_bf16_f32 v79, v198, v199
    s_mov_b32 s17, 0xe000
    buffer_load_dwordx4 v[200:203], v8, s[8:11], s17 offen offset:0
    buffer_load_dwordx4 v[204:207], v8, s[8:11], s17 offen offset:1024
    buffer_load_dwordx4 v[208:211], v8, s[8:11], s17 offen offset:2048
    buffer_load_dwordx4 v[212:215], v8, s[8:11], s17 offen offset:3072
    s_waitcnt vmcnt(3)
    v_mfma_f32_16x16x32_bf16 v[184:187], v[200:203], v[152:155], v[216:219]
    v_mfma_f32_16x16x32_bf16 v[188:191], v[200:203], v[168:171], v[220:223]
    s_waitcnt vmcnt(2)
    v_mfma_f32_16x16x32_bf16 v[192:195], v[204:207], v[152:155], v[216:219]
    v_mfma_f32_16x16x32_bf16 v[196:199], v[204:207], v[168:171], v[220:223]
    s_waitcnt vmcnt(1)
    v_mfma_f32_16x16x32_bf16 v[184:187], v[208:211], v[156:159], v[184:187]
    v_mfma_f32_16x16x32_bf16 v[188:191], v[208:211], v[172:175], v[188:191]
    s_waitcnt vmcnt(0)
    v_mfma_f32_16x16x32_bf16 v[192:195], v[212:215], v[156:159], v[192:195]
    v_mfma_f32_16x16x32_bf16 v[196:199], v[212:215], v[172:175], v[196:199]
    s_mov_b32 s17, 0xf000
    buffer_load_dwordx4 v[200:203], v8, s[8:11], s17 offen offset:0
    buffer_load_dwordx4 v[204:207], v8, s[8:11], s17 offen offset:1024
    buffer_load_dwordx4 v[208:211], v8, s[8:11], s17 offen offset:2048
    buffer_load_dwordx4 v[212:215], v8, s[8:11], s17 offen offset:3072
    s_waitcnt vmcnt(3)
    v_mfma_f32_16x16x32_bf16 v[184:187], v[200:203], v[160:163], v[184:187]
    v_mfma_f32_16x16x32_bf16 v[188:191], v[200:203], v[176:179], v[188:191]
    s_waitcnt vmcnt(2)
    v_mfma_f32_16x16x32_bf16 v[192:195], v[204:207], v[160:163], v[192:195]
    v_mfma_f32_16x16x32_bf16 v[196:199], v[204:207], v[176:179], v[196:199]
    s_waitcnt vmcnt(1)
    v_mfma_f32_16x16x32_bf16 v[184:187], v[208:211], v[164:167], v[184:187]
    v_mfma_f32_16x16x32_bf16 v[188:191], v[208:211], v[180:183], v[188:191]
    s_waitcnt vmcnt(0)
    v_mfma_f32_16x16x32_bf16 v[192:195], v[212:215], v[164:167], v[192:195]
    v_mfma_f32_16x16x32_bf16 v[196:199], v[212:215], v[180:183], v[196:199]
    s_nop 3
    v_exp_f32 v184, v184
    v_exp_f32 v185, v185
    v_add_f32 v9, v9, v184
    v_add_f32 v9, v9, v185
    v_cvt_pk_bf16_f32 v80, v184, v185
    v_exp_f32 v186, v186
    v_exp_f32 v187, v187
    v_add_f32 v9, v9, v186
    v_add_f32 v9, v9, v187
    v_cvt_pk_bf16_f32 v81, v186, v187
    v_exp_f32 v188, v188
    v_exp_f32 v189, v189
    v_add_f32 v10, v10, v188
    v_add_f32 v10, v10, v189
    v_cvt_pk_bf16_f32 v84, v188, v189
    v_exp_f32 v190, v190
    v_exp_f32 v191, v191
    v_add_f32 v10, v10, v190
    v_add_f32 v10, v10, v191
    v_cvt_pk_bf16_f32 v85, v190, v191
    v_exp_f32 v192, v192
    v_exp_f32 v193, v193
    v_add_f32 v9, v9, v192
    v_add_f32 v9, v9, v193
    v_cvt_pk_bf16_f32 v82, v192, v193
    v_exp_f32 v194, v194
    v_exp_f32 v195, v195
    v_add_f32 v9, v9, v194
    v_add_f32 v9, v9, v195
    v_cvt_pk_bf16_f32 v83, v194, v195
    v_exp_f32 v196, v196
    v_exp_f32 v197, v197
    v_add_f32 v10, v10, v196
    v_add_f32 v10, v10, v197
    v_cvt_pk_bf16_f32 v86, v196, v197
    v_exp_f32 v198, v198
    v_exp_f32 v199, v199
    v_add_f32 v10, v10, v198
    v_add_f32 v10, v10, v199
    v_cvt_pk_bf16_f32 v87, v198, v199
    s_mov_b32 s17, 0x10000
    buffer_load_dwordx4 v[200:203], v8, s[8:11], s17 offen offset:0
    buffer_load_dwordx4 v[204:207], v8, s[8:11], s17 offen offset:1024
    buffer_load_dwordx4 v[208:211], v8, s[8:11], s17 offen offset:2048
    buffer_load_dwordx4 v[212:215], v8, s[8:11], s17 offen offset:3072
    s_waitcnt vmcnt(3)
    v_mfma_f32_16x16x32_bf16 v[184:187], v[200:203], v[152:155], v[216:219]
    v_mfma_f32_16x16x32_bf16 v[188:191], v[200:203], v[168:171], v[220:223]
    s_waitcnt vmcnt(2)
    v_mfma_f32_16x16x32_bf16 v[192:195], v[204:207], v[152:155], v[216:219]
    v_mfma_f32_16x16x32_bf16 v[196:199], v[204:207], v[168:171], v[220:223]
    s_waitcnt vmcnt(1)
    v_mfma_f32_16x16x32_bf16 v[184:187], v[208:211], v[156:159], v[184:187]
    v_mfma_f32_16x16x32_bf16 v[188:191], v[208:211], v[172:175], v[188:191]
    s_waitcnt vmcnt(0)
    v_mfma_f32_16x16x32_bf16 v[192:195], v[212:215], v[156:159], v[192:195]
    v_mfma_f32_16x16x32_bf16 v[196:199], v[212:215], v[172:175], v[196:199]
    s_mov_b32 s17, 0x11000
    buffer_load_dwordx4 v[200:203], v8, s[8:11], s17 offen offset:0
    buffer_load_dwordx4 v[204:207], v8, s[8:11], s17 offen offset:1024
    buffer_load_dwordx4 v[208:211], v8, s[8:11], s17 offen offset:2048
    buffer_load_dwordx4 v[212:215], v8, s[8:11], s17 offen offset:3072
    s_waitcnt vmcnt(3)
    v_mfma_f32_16x16x32_bf16 v[184:187], v[200:203], v[160:163], v[184:187]
    v_mfma_f32_16x16x32_bf16 v[188:191], v[200:203], v[176:179], v[188:191]
    s_waitcnt vmcnt(2)
    v_mfma_f32_16x16x32_bf16 v[192:195], v[204:207], v[160:163], v[192:195]
    v_mfma_f32_16x16x32_bf16 v[196:199], v[204:207], v[176:179], v[196:199]
    s_waitcnt vmcnt(1)
    v_mfma_f32_16x16x32_bf16 v[184:187], v[208:211], v[164:167], v[184:187]
    v_mfma_f32_16x16x32_bf16 v[188:191], v[208:211], v[180:183], v[188:191]
    s_waitcnt vmcnt(0)
    v_mfma_f32_16x16x32_bf16 v[192:195], v[212:215], v[164:167], v[192:195]
    v_mfma_f32_16x16x32_bf16 v[196:199], v[212:215], v[180:183], v[196:199]
    s_nop 3
    v_exp_f32 v184, v184
    v_exp_f32 v185, v185
    v_add_f32 v9, v9, v184
    v_add_f32 v9, v9, v185
    v_cvt_pk_bf16_f32 v88, v184, v185
    v_exp_f32 v186, v186
    v_exp_f32 v187, v187
    v_add_f32 v9, v9, v186
    v_add_f32 v9, v9, v187
    v_cvt_pk_bf16_f32 v89, v186, v187
    v_exp_f32 v188, v188
    v_exp_f32 v189, v189
    v_add_f32 v10, v10, v188
    v_add_f32 v10, v10, v189
    v_cvt_pk_bf16_f32 v92, v188, v189
    v_exp_f32 v190, v190
    v_exp_f32 v191, v191
    v_add_f32 v10, v10, v190
    v_add_f32 v10, v10, v191
    v_cvt_pk_bf16_f32 v93, v190, v191
    v_exp_f32 v192, v192
    v_exp_f32 v193, v193
    v_add_f32 v9, v9, v192
    v_add_f32 v9, v9, v193
    v_cvt_pk_bf16_f32 v90, v192, v193
    v_exp_f32 v194, v194
    v_exp_f32 v195, v195
    v_add_f32 v9, v9, v194
    v_add_f32 v9, v9, v195
    v_cvt_pk_bf16_f32 v91, v194, v195
    v_exp_f32 v196, v196
    v_exp_f32 v197, v197
    v_add_f32 v10, v10, v196
    v_add_f32 v10, v10, v197
    v_cvt_pk_bf16_f32 v94, v196, v197
    v_exp_f32 v198, v198
    v_exp_f32 v199, v199
    v_add_f32 v10, v10, v198
    v_add_f32 v10, v10, v199
    v_cvt_pk_bf16_f32 v95, v198, v199
    s_mov_b32 s17, 0x12000
    buffer_load_dwordx4 v[200:203], v8, s[8:11], s17 offen offset:0
    buffer_load_dwordx4 v[204:207], v8, s[8:11], s17 offen offset:1024
    buffer_load_dwordx4 v[208:211], v8, s[8:11], s17 offen offset:2048
    buffer_load_dwordx4 v[212:215], v8, s[8:11], s17 offen offset:3072
    s_waitcnt vmcnt(3)
    v_mfma_f32_16x16x32_bf16 v[184:187], v[200:203], v[152:155], v[216:219]
    v_mfma_f32_16x16x32_bf16 v[188:191], v[200:203], v[168:171], v[220:223]
    s_waitcnt vmcnt(2)
    v_mfma_f32_16x16x32_bf16 v[192:195], v[204:207], v[152:155], v[216:219]
    v_mfma_f32_16x16x32_bf16 v[196:199], v[204:207], v[168:171], v[220:223]
    s_waitcnt vmcnt(1)
    v_mfma_f32_16x16x32_bf16 v[184:187], v[208:211], v[156:159], v[184:187]
    v_mfma_f32_16x16x32_bf16 v[188:191], v[208:211], v[172:175], v[188:191]
    s_waitcnt vmcnt(0)
    v_mfma_f32_16x16x32_bf16 v[192:195], v[212:215], v[156:159], v[192:195]
    v_mfma_f32_16x16x32_bf16 v[196:199], v[212:215], v[172:175], v[196:199]
    s_mov_b32 s17, 0x13000
    buffer_load_dwordx4 v[200:203], v8, s[8:11], s17 offen offset:0
    buffer_load_dwordx4 v[204:207], v8, s[8:11], s17 offen offset:1024
    buffer_load_dwordx4 v[208:211], v8, s[8:11], s17 offen offset:2048
    buffer_load_dwordx4 v[212:215], v8, s[8:11], s17 offen offset:3072
    s_waitcnt vmcnt(3)
    v_mfma_f32_16x16x32_bf16 v[184:187], v[200:203], v[160:163], v[184:187]
    v_mfma_f32_16x16x32_bf16 v[188:191], v[200:203], v[176:179], v[188:191]
    s_waitcnt vmcnt(2)
    v_mfma_f32_16x16x32_bf16 v[192:195], v[204:207], v[160:163], v[192:195]
    v_mfma_f32_16x16x32_bf16 v[196:199], v[204:207], v[176:179], v[196:199]
    s_waitcnt vmcnt(1)
    v_mfma_f32_16x16x32_bf16 v[184:187], v[208:211], v[164:167], v[184:187]
    v_mfma_f32_16x16x32_bf16 v[188:191], v[208:211], v[180:183], v[188:191]
    s_waitcnt vmcnt(0)
    v_mfma_f32_16x16x32_bf16 v[192:195], v[212:215], v[164:167], v[192:195]
    v_mfma_f32_16x16x32_bf16 v[196:199], v[212:215], v[180:183], v[196:199]
    s_nop 3
    v_exp_f32 v184, v184
    v_exp_f32 v185, v185
    v_add_f32 v9, v9, v184
    v_add_f32 v9, v9, v185
    v_cvt_pk_bf16_f32 v96, v184, v185
    v_exp_f32 v186, v186
    v_exp_f32 v187, v187
    v_add_f32 v9, v9, v186
    v_add_f32 v9, v9, v187
    v_cvt_pk_bf16_f32 v97, v186, v187
    v_exp_f32 v188, v188
    v_exp_f32 v189, v189
    v_add_f32 v10, v10, v188
    v_add_f32 v10, v10, v189
    v_cvt_pk_bf16_f32 v100, v188, v189
    v_exp_f32 v190, v190
    v_exp_f32 v191, v191
    v_add_f32 v10, v10, v190
    v_add_f32 v10, v10, v191
    v_cvt_pk_bf16_f32 v101, v190, v191
    v_exp_f32 v192, v192
    v_exp_f32 v193, v193
    v_add_f32 v9, v9, v192
    v_add_f32 v9, v9, v193
    v_cvt_pk_bf16_f32 v98, v192, v193
    v_exp_f32 v194, v194
    v_exp_f32 v195, v195
    v_add_f32 v9, v9, v194
    v_add_f32 v9, v9, v195
    v_cvt_pk_bf16_f32 v99, v194, v195
    v_exp_f32 v196, v196
    v_exp_f32 v197, v197
    v_add_f32 v10, v10, v196
    v_add_f32 v10, v10, v197
    v_cvt_pk_bf16_f32 v102, v196, v197
    v_exp_f32 v198, v198
    v_exp_f32 v199, v199
    v_add_f32 v10, v10, v198
    v_add_f32 v10, v10, v199
    v_cvt_pk_bf16_f32 v103, v198, v199
    s_mov_b32 s17, 0x14000
    buffer_load_dwordx4 v[200:203], v8, s[8:11], s17 offen offset:0
    buffer_load_dwordx4 v[204:207], v8, s[8:11], s17 offen offset:1024
    buffer_load_dwordx4 v[208:211], v8, s[8:11], s17 offen offset:2048
    buffer_load_dwordx4 v[212:215], v8, s[8:11], s17 offen offset:3072
    s_waitcnt vmcnt(3)
    v_mfma_f32_16x16x32_bf16 v[184:187], v[200:203], v[152:155], v[216:219]
    v_mfma_f32_16x16x32_bf16 v[188:191], v[200:203], v[168:171], v[220:223]
    s_waitcnt vmcnt(2)
    v_mfma_f32_16x16x32_bf16 v[192:195], v[204:207], v[152:155], v[216:219]
    v_mfma_f32_16x16x32_bf16 v[196:199], v[204:207], v[168:171], v[220:223]
    s_waitcnt vmcnt(1)
    v_mfma_f32_16x16x32_bf16 v[184:187], v[208:211], v[156:159], v[184:187]
    v_mfma_f32_16x16x32_bf16 v[188:191], v[208:211], v[172:175], v[188:191]
    s_waitcnt vmcnt(0)
    v_mfma_f32_16x16x32_bf16 v[192:195], v[212:215], v[156:159], v[192:195]
    v_mfma_f32_16x16x32_bf16 v[196:199], v[212:215], v[172:175], v[196:199]
    s_mov_b32 s17, 0x15000
    buffer_load_dwordx4 v[200:203], v8, s[8:11], s17 offen offset:0
    buffer_load_dwordx4 v[204:207], v8, s[8:11], s17 offen offset:1024
    buffer_load_dwordx4 v[208:211], v8, s[8:11], s17 offen offset:2048
    buffer_load_dwordx4 v[212:215], v8, s[8:11], s17 offen offset:3072
    s_waitcnt vmcnt(3)
    v_mfma_f32_16x16x32_bf16 v[184:187], v[200:203], v[160:163], v[184:187]
    v_mfma_f32_16x16x32_bf16 v[188:191], v[200:203], v[176:179], v[188:191]
    s_waitcnt vmcnt(2)
    v_mfma_f32_16x16x32_bf16 v[192:195], v[204:207], v[160:163], v[192:195]
    v_mfma_f32_16x16x32_bf16 v[196:199], v[204:207], v[176:179], v[196:199]
    s_waitcnt vmcnt(1)
    v_mfma_f32_16x16x32_bf16 v[184:187], v[208:211], v[164:167], v[184:187]
    v_mfma_f32_16x16x32_bf16 v[188:191], v[208:211], v[180:183], v[188:191]
    s_waitcnt vmcnt(0)
    v_mfma_f32_16x16x32_bf16 v[192:195], v[212:215], v[164:167], v[192:195]
    v_mfma_f32_16x16x32_bf16 v[196:199], v[212:215], v[180:183], v[196:199]
    s_nop 3
    v_exp_f32 v184, v184
    v_exp_f32 v185, v185
    v_add_f32 v9, v9, v184
    v_add_f32 v9, v9, v185
    v_cvt_pk_bf16_f32 v104, v184, v185
    v_exp_f32 v186, v186
    v_exp_f32 v187, v187
    v_add_f32 v9, v9, v186
    v_add_f32 v9, v9, v187
    v_cvt_pk_bf16_f32 v105, v186, v187
    v_exp_f32 v188, v188
    v_exp_f32 v189, v189
    v_add_f32 v10, v10, v188
    v_add_f32 v10, v10, v189
    v_cvt_pk_bf16_f32 v108, v188, v189
    v_exp_f32 v190, v190
    v_exp_f32 v191, v191
    v_add_f32 v10, v10, v190
    v_add_f32 v10, v10, v191
    v_cvt_pk_bf16_f32 v109, v190, v191
    v_exp_f32 v192, v192
    v_exp_f32 v193, v193
    v_add_f32 v9, v9, v192
    v_add_f32 v9, v9, v193
    v_cvt_pk_bf16_f32 v106, v192, v193
    v_exp_f32 v194, v194
    v_exp_f32 v195, v195
    v_add_f32 v9, v9, v194
    v_add_f32 v9, v9, v195
    v_cvt_pk_bf16_f32 v107, v194, v195
    v_exp_f32 v196, v196
    v_exp_f32 v197, v197
    v_add_f32 v10, v10, v196
    v_add_f32 v10, v10, v197
    v_cvt_pk_bf16_f32 v110, v196, v197
    v_exp_f32 v198, v198
    v_exp_f32 v199, v199
    v_add_f32 v10, v10, v198
    v_add_f32 v10, v10, v199
    v_cvt_pk_bf16_f32 v111, v198, v199
    s_mov_b32 s17, 0x16000
    buffer_load_dwordx4 v[200:203], v8, s[8:11], s17 offen offset:0
    buffer_load_dwordx4 v[204:207], v8, s[8:11], s17 offen offset:1024
    buffer_load_dwordx4 v[208:211], v8, s[8:11], s17 offen offset:2048
    buffer_load_dwordx4 v[212:215], v8, s[8:11], s17 offen offset:3072
    s_waitcnt vmcnt(3)
    v_mfma_f32_16x16x32_bf16 v[184:187], v[200:203], v[152:155], v[216:219]
    v_mfma_f32_16x16x32_bf16 v[188:191], v[200:203], v[168:171], v[220:223]
    s_waitcnt vmcnt(2)
    v_mfma_f32_16x16x32_bf16 v[192:195], v[204:207], v[152:155], v[216:219]
    v_mfma_f32_16x16x32_bf16 v[196:199], v[204:207], v[168:171], v[220:223]
    s_waitcnt vmcnt(1)
    v_mfma_f32_16x16x32_bf16 v[184:187], v[208:211], v[156:159], v[184:187]
    v_mfma_f32_16x16x32_bf16 v[188:191], v[208:211], v[172:175], v[188:191]
    s_waitcnt vmcnt(0)
    v_mfma_f32_16x16x32_bf16 v[192:195], v[212:215], v[156:159], v[192:195]
    v_mfma_f32_16x16x32_bf16 v[196:199], v[212:215], v[172:175], v[196:199]
    s_mov_b32 s17, 0x17000
    buffer_load_dwordx4 v[200:203], v8, s[8:11], s17 offen offset:0
    buffer_load_dwordx4 v[204:207], v8, s[8:11], s17 offen offset:1024
    buffer_load_dwordx4 v[208:211], v8, s[8:11], s17 offen offset:2048
    buffer_load_dwordx4 v[212:215], v8, s[8:11], s17 offen offset:3072
    s_waitcnt vmcnt(3)
    v_mfma_f32_16x16x32_bf16 v[184:187], v[200:203], v[160:163], v[184:187]
    v_mfma_f32_16x16x32_bf16 v[188:191], v[200:203], v[176:179], v[188:191]
    s_waitcnt vmcnt(2)
    v_mfma_f32_16x16x32_bf16 v[192:195], v[204:207], v[160:163], v[192:195]
    v_mfma_f32_16x16x32_bf16 v[196:199], v[204:207], v[176:179], v[196:199]
    s_waitcnt vmcnt(1)
    v_mfma_f32_16x16x32_bf16 v[184:187], v[208:211], v[164:167], v[184:187]
    v_mfma_f32_16x16x32_bf16 v[188:191], v[208:211], v[180:183], v[188:191]
    s_waitcnt vmcnt(0)
    v_mfma_f32_16x16x32_bf16 v[192:195], v[212:215], v[164:167], v[192:195]
    v_mfma_f32_16x16x32_bf16 v[196:199], v[212:215], v[180:183], v[196:199]
    s_nop 3
    v_exp_f32 v184, v184
    v_exp_f32 v185, v185
    v_add_f32 v9, v9, v184
    v_add_f32 v9, v9, v185
    v_cvt_pk_bf16_f32 v112, v184, v185
    v_exp_f32 v186, v186
    v_exp_f32 v187, v187
    v_add_f32 v9, v9, v186
    v_add_f32 v9, v9, v187
    v_cvt_pk_bf16_f32 v113, v186, v187
    v_exp_f32 v188, v188
    v_exp_f32 v189, v189
    v_add_f32 v10, v10, v188
    v_add_f32 v10, v10, v189
    v_cvt_pk_bf16_f32 v116, v188, v189
    v_exp_f32 v190, v190
    v_exp_f32 v191, v191
    v_add_f32 v10, v10, v190
    v_add_f32 v10, v10, v191
    v_cvt_pk_bf16_f32 v117, v190, v191
    v_exp_f32 v192, v192
    v_exp_f32 v193, v193
    v_add_f32 v9, v9, v192
    v_add_f32 v9, v9, v193
    v_cvt_pk_bf16_f32 v114, v192, v193
    v_exp_f32 v194, v194
    v_exp_f32 v195, v195
    v_add_f32 v9, v9, v194
    v_add_f32 v9, v9, v195
    v_cvt_pk_bf16_f32 v115, v194, v195
    v_exp_f32 v196, v196
    v_exp_f32 v197, v197
    v_add_f32 v10, v10, v196
    v_add_f32 v10, v10, v197
    v_cvt_pk_bf16_f32 v118, v196, v197
    v_exp_f32 v198, v198
    v_exp_f32 v199, v199
    v_add_f32 v10, v10, v198
    v_add_f32 v10, v10, v199
    v_cvt_pk_bf16_f32 v119, v198, v199
    s_mov_b32 s17, 0x18000
    buffer_load_dwordx4 v[200:203], v8, s[8:11], s17 offen offset:0
    buffer_load_dwordx4 v[204:207], v8, s[8:11], s17 offen offset:1024
    buffer_load_dwordx4 v[208:211], v8, s[8:11], s17 offen offset:2048
    buffer_load_dwordx4 v[212:215], v8, s[8:11], s17 offen offset:3072
    s_waitcnt vmcnt(3)
    v_mfma_f32_16x16x32_bf16 v[184:187], v[200:203], v[152:155], v[216:219]
    v_mfma_f32_16x16x32_bf16 v[188:191], v[200:203], v[168:171], v[220:223]
    s_waitcnt vmcnt(2)
    v_mfma_f32_16x16x32_bf16 v[192:195], v[204:207], v[152:155], v[216:219]
    v_mfma_f32_16x16x32_bf16 v[196:199], v[204:207], v[168:171], v[220:223]
    s_waitcnt vmcnt(1)
    v_mfma_f32_16x16x32_bf16 v[184:187], v[208:211], v[156:159], v[184:187]
    v_mfma_f32_16x16x32_bf16 v[188:191], v[208:211], v[172:175], v[188:191]
    s_waitcnt vmcnt(0)
    v_mfma_f32_16x16x32_bf16 v[192:195], v[212:215], v[156:159], v[192:195]
    v_mfma_f32_16x16x32_bf16 v[196:199], v[212:215], v[172:175], v[196:199]
    s_mov_b32 s17, 0x19000
    buffer_load_dwordx4 v[200:203], v8, s[8:11], s17 offen offset:0
    buffer_load_dwordx4 v[204:207], v8, s[8:11], s17 offen offset:1024
    buffer_load_dwordx4 v[208:211], v8, s[8:11], s17 offen offset:2048
    buffer_load_dwordx4 v[212:215], v8, s[8:11], s17 offen offset:3072
    s_waitcnt vmcnt(3)
    v_mfma_f32_16x16x32_bf16 v[184:187], v[200:203], v[160:163], v[184:187]
    v_mfma_f32_16x16x32_bf16 v[188:191], v[200:203], v[176:179], v[188:191]
    s_waitcnt vmcnt(2)
    v_mfma_f32_16x16x32_bf16 v[192:195], v[204:207], v[160:163], v[192:195]
    v_mfma_f32_16x16x32_bf16 v[196:199], v[204:207], v[176:179], v[196:199]
    s_waitcnt vmcnt(1)
    v_mfma_f32_16x16x32_bf16 v[184:187], v[208:211], v[164:167], v[184:187]
    v_mfma_f32_16x16x32_bf16 v[188:191], v[208:211], v[180:183], v[188:191]
    s_waitcnt vmcnt(0)
    v_mfma_f32_16x16x32_bf16 v[192:195], v[212:215], v[164:167], v[192:195]
    v_mfma_f32_16x16x32_bf16 v[196:199], v[212:215], v[180:183], v[196:199]
    s_nop 3
    v_exp_f32 v184, v184
    v_exp_f32 v185, v185
    v_add_f32 v9, v9, v184
    v_add_f32 v9, v9, v185
    v_cvt_pk_bf16_f32 v120, v184, v185
    v_exp_f32 v186, v186
    v_exp_f32 v187, v187
    v_add_f32 v9, v9, v186
    v_add_f32 v9, v9, v187
    v_cvt_pk_bf16_f32 v121, v186, v187
    v_exp_f32 v188, v188
    v_exp_f32 v189, v189
    v_add_f32 v10, v10, v188
    v_add_f32 v10, v10, v189
    v_cvt_pk_bf16_f32 v124, v188, v189
    v_exp_f32 v190, v190
    v_exp_f32 v191, v191
    v_add_f32 v10, v10, v190
    v_add_f32 v10, v10, v191
    v_cvt_pk_bf16_f32 v125, v190, v191
    v_exp_f32 v192, v192
    v_exp_f32 v193, v193
    v_add_f32 v9, v9, v192
    v_add_f32 v9, v9, v193
    v_cvt_pk_bf16_f32 v122, v192, v193
    v_exp_f32 v194, v194
    v_exp_f32 v195, v195
    v_add_f32 v9, v9, v194
    v_add_f32 v9, v9, v195
    v_cvt_pk_bf16_f32 v123, v194, v195
    v_exp_f32 v196, v196
    v_exp_f32 v197, v197
    v_add_f32 v10, v10, v196
    v_add_f32 v10, v10, v197
    v_cvt_pk_bf16_f32 v126, v196, v197
    v_exp_f32 v198, v198
    v_exp_f32 v199, v199
    v_add_f32 v10, v10, v198
    v_add_f32 v10, v10, v199
    v_cvt_pk_bf16_f32 v127, v198, v199
    s_mov_b32 s17, 0x1a000
    buffer_load_dwordx4 v[200:203], v8, s[8:11], s17 offen offset:0
    buffer_load_dwordx4 v[204:207], v8, s[8:11], s17 offen offset:1024
    buffer_load_dwordx4 v[208:211], v8, s[8:11], s17 offen offset:2048
    buffer_load_dwordx4 v[212:215], v8, s[8:11], s17 offen offset:3072
    s_waitcnt vmcnt(3)
    v_mfma_f32_16x16x32_bf16 v[184:187], v[200:203], v[152:155], v[216:219]
    v_mfma_f32_16x16x32_bf16 v[188:191], v[200:203], v[168:171], v[220:223]
    s_waitcnt vmcnt(2)
    v_mfma_f32_16x16x32_bf16 v[192:195], v[204:207], v[152:155], v[216:219]
    v_mfma_f32_16x16x32_bf16 v[196:199], v[204:207], v[168:171], v[220:223]
    s_waitcnt vmcnt(1)
    v_mfma_f32_16x16x32_bf16 v[184:187], v[208:211], v[156:159], v[184:187]
    v_mfma_f32_16x16x32_bf16 v[188:191], v[208:211], v[172:175], v[188:191]
    s_waitcnt vmcnt(0)
    v_mfma_f32_16x16x32_bf16 v[192:195], v[212:215], v[156:159], v[192:195]
    v_mfma_f32_16x16x32_bf16 v[196:199], v[212:215], v[172:175], v[196:199]
    s_mov_b32 s17, 0x1b000
    buffer_load_dwordx4 v[200:203], v8, s[8:11], s17 offen offset:0
    buffer_load_dwordx4 v[204:207], v8, s[8:11], s17 offen offset:1024
    buffer_load_dwordx4 v[208:211], v8, s[8:11], s17 offen offset:2048
    buffer_load_dwordx4 v[212:215], v8, s[8:11], s17 offen offset:3072
    s_waitcnt vmcnt(3)
    v_mfma_f32_16x16x32_bf16 v[184:187], v[200:203], v[160:163], v[184:187]
    v_mfma_f32_16x16x32_bf16 v[188:191], v[200:203], v[176:179], v[188:191]
    s_waitcnt vmcnt(2)
    v_mfma_f32_16x16x32_bf16 v[192:195], v[204:207], v[160:163], v[192:195]
    v_mfma_f32_16x16x32_bf16 v[196:199], v[204:207], v[176:179], v[196:199]
    s_waitcnt vmcnt(1)
    v_mfma_f32_16x16x32_bf16 v[184:187], v[208:211], v[164:167], v[184:187]
    v_mfma_f32_16x16x32_bf16 v[188:191], v[208:211], v[180:183], v[188:191]
    s_waitcnt vmcnt(0)
    v_mfma_f32_16x16x32_bf16 v[192:195], v[212:215], v[164:167], v[192:195]
    v_mfma_f32_16x16x32_bf16 v[196:199], v[212:215], v[180:183], v[196:199]
    s_nop 3
    v_exp_f32 v184, v184
    v_exp_f32 v185, v185
    v_add_f32 v9, v9, v184
    v_add_f32 v9, v9, v185
    v_cvt_pk_bf16_f32 v128, v184, v185
    v_exp_f32 v186, v186
    v_exp_f32 v187, v187
    v_add_f32 v9, v9, v186
    v_add_f32 v9, v9, v187
    v_cvt_pk_bf16_f32 v129, v186, v187
    v_exp_f32 v188, v188
    v_exp_f32 v189, v189
    v_add_f32 v10, v10, v188
    v_add_f32 v10, v10, v189
    v_cvt_pk_bf16_f32 v132, v188, v189
    v_exp_f32 v190, v190
    v_exp_f32 v191, v191
    v_add_f32 v10, v10, v190
    v_add_f32 v10, v10, v191
    v_cvt_pk_bf16_f32 v133, v190, v191
    v_exp_f32 v192, v192
    v_exp_f32 v193, v193
    v_add_f32 v9, v9, v192
    v_add_f32 v9, v9, v193
    v_cvt_pk_bf16_f32 v130, v192, v193
    v_exp_f32 v194, v194
    v_exp_f32 v195, v195
    v_add_f32 v9, v9, v194
    v_add_f32 v9, v9, v195
    v_cvt_pk_bf16_f32 v131, v194, v195
    v_exp_f32 v196, v196
    v_exp_f32 v197, v197
    v_add_f32 v10, v10, v196
    v_add_f32 v10, v10, v197
    v_cvt_pk_bf16_f32 v134, v196, v197
    v_exp_f32 v198, v198
    v_exp_f32 v199, v199
    v_add_f32 v10, v10, v198
    v_add_f32 v10, v10, v199
    v_cvt_pk_bf16_f32 v135, v198, v199
    s_mov_b32 s17, 0x1c000
    buffer_load_dwordx4 v[200:203], v8, s[8:11], s17 offen offset:0
    buffer_load_dwordx4 v[204:207], v8, s[8:11], s17 offen offset:1024
    buffer_load_dwordx4 v[208:211], v8, s[8:11], s17 offen offset:2048
    buffer_load_dwordx4 v[212:215], v8, s[8:11], s17 offen offset:3072
    s_waitcnt vmcnt(3)
    v_mfma_f32_16x16x32_bf16 v[184:187], v[200:203], v[152:155], v[216:219]
    v_mfma_f32_16x16x32_bf16 v[188:191], v[200:203], v[168:171], v[220:223]
    s_waitcnt vmcnt(2)
    v_mfma_f32_16x16x32_bf16 v[192:195], v[204:207], v[152:155], v[216:219]
    v_mfma_f32_16x16x32_bf16 v[196:199], v[204:207], v[168:171], v[220:223]
    s_waitcnt vmcnt(1)
    v_mfma_f32_16x16x32_bf16 v[184:187], v[208:211], v[156:159], v[184:187]
    v_mfma_f32_16x16x32_bf16 v[188:191], v[208:211], v[172:175], v[188:191]
    s_waitcnt vmcnt(0)
    v_mfma_f32_16x16x32_bf16 v[192:195], v[212:215], v[156:159], v[192:195]
    v_mfma_f32_16x16x32_bf16 v[196:199], v[212:215], v[172:175], v[196:199]
    s_mov_b32 s17, 0x1d000
    buffer_load_dwordx4 v[200:203], v8, s[8:11], s17 offen offset:0
    buffer_load_dwordx4 v[204:207], v8, s[8:11], s17 offen offset:1024
    buffer_load_dwordx4 v[208:211], v8, s[8:11], s17 offen offset:2048
    buffer_load_dwordx4 v[212:215], v8, s[8:11], s17 offen offset:3072
    s_waitcnt vmcnt(3)
    v_mfma_f32_16x16x32_bf16 v[184:187], v[200:203], v[160:163], v[184:187]
    v_mfma_f32_16x16x32_bf16 v[188:191], v[200:203], v[176:179], v[188:191]
    s_waitcnt vmcnt(2)
    v_mfma_f32_16x16x32_bf16 v[192:195], v[204:207], v[160:163], v[192:195]
    v_mfma_f32_16x16x32_bf16 v[196:199], v[204:207], v[176:179], v[196:199]
    s_waitcnt vmcnt(1)
    v_mfma_f32_16x16x32_bf16 v[184:187], v[208:211], v[164:167], v[184:187]
    v_mfma_f32_16x16x32_bf16 v[188:191], v[208:211], v[180:183], v[188:191]
    s_waitcnt vmcnt(0)
    v_mfma_f32_16x16x32_bf16 v[192:195], v[212:215], v[164:167], v[192:195]
    v_mfma_f32_16x16x32_bf16 v[196:199], v[212:215], v[180:183], v[196:199]
    s_nop 3
    v_exp_f32 v184, v184
    v_exp_f32 v185, v185
    v_add_f32 v9, v9, v184
    v_add_f32 v9, v9, v185
    v_cvt_pk_bf16_f32 v136, v184, v185
    v_exp_f32 v186, v186
    v_exp_f32 v187, v187
    v_add_f32 v9, v9, v186
    v_add_f32 v9, v9, v187
    v_cvt_pk_bf16_f32 v137, v186, v187
    v_exp_f32 v188, v188
    v_exp_f32 v189, v189
    v_add_f32 v10, v10, v188
    v_add_f32 v10, v10, v189
    v_cvt_pk_bf16_f32 v140, v188, v189
    v_exp_f32 v190, v190
    v_exp_f32 v191, v191
    v_add_f32 v10, v10, v190
    v_add_f32 v10, v10, v191
    v_cvt_pk_bf16_f32 v141, v190, v191
    v_exp_f32 v192, v192
    v_exp_f32 v193, v193
    v_add_f32 v9, v9, v192
    v_add_f32 v9, v9, v193
    v_cvt_pk_bf16_f32 v138, v192, v193
    v_exp_f32 v194, v194
    v_exp_f32 v195, v195
    v_add_f32 v9, v9, v194
    v_add_f32 v9, v9, v195
    v_cvt_pk_bf16_f32 v139, v194, v195
    v_exp_f32 v196, v196
    v_exp_f32 v197, v197
    v_add_f32 v10, v10, v196
    v_add_f32 v10, v10, v197
    v_cvt_pk_bf16_f32 v142, v196, v197
    v_exp_f32 v198, v198
    v_exp_f32 v199, v199
    v_add_f32 v10, v10, v198
    v_add_f32 v10, v10, v199
    v_cvt_pk_bf16_f32 v143, v198, v199
    s_mov_b32 s17, 0x1e000
    buffer_load_dwordx4 v[200:203], v8, s[8:11], s17 offen offset:0
    buffer_load_dwordx4 v[204:207], v8, s[8:11], s17 offen offset:1024
    buffer_load_dwordx4 v[208:211], v8, s[8:11], s17 offen offset:2048
    buffer_load_dwordx4 v[212:215], v8, s[8:11], s17 offen offset:3072
    s_waitcnt vmcnt(3)
    v_mfma_f32_16x16x32_bf16 v[184:187], v[200:203], v[152:155], v[216:219]
    v_mfma_f32_16x16x32_bf16 v[188:191], v[200:203], v[168:171], v[220:223]
    s_waitcnt vmcnt(2)
    v_mfma_f32_16x16x32_bf16 v[192:195], v[204:207], v[152:155], v[216:219]
    v_mfma_f32_16x16x32_bf16 v[196:199], v[204:207], v[168:171], v[220:223]
    s_waitcnt vmcnt(1)
    v_mfma_f32_16x16x32_bf16 v[184:187], v[208:211], v[156:159], v[184:187]
    v_mfma_f32_16x16x32_bf16 v[188:191], v[208:211], v[172:175], v[188:191]
    s_waitcnt vmcnt(0)
    v_mfma_f32_16x16x32_bf16 v[192:195], v[212:215], v[156:159], v[192:195]
    v_mfma_f32_16x16x32_bf16 v[196:199], v[212:215], v[172:175], v[196:199]
    s_mov_b32 s17, 0x1f000
    buffer_load_dwordx4 v[200:203], v8, s[8:11], s17 offen offset:0
    buffer_load_dwordx4 v[204:207], v8, s[8:11], s17 offen offset:1024
    buffer_load_dwordx4 v[208:211], v8, s[8:11], s17 offen offset:2048
    buffer_load_dwordx4 v[212:215], v8, s[8:11], s17 offen offset:3072
    s_waitcnt vmcnt(3)
    v_mfma_f32_16x16x32_bf16 v[184:187], v[200:203], v[160:163], v[184:187]
    v_mfma_f32_16x16x32_bf16 v[188:191], v[200:203], v[176:179], v[188:191]
    s_waitcnt vmcnt(2)
    v_mfma_f32_16x16x32_bf16 v[192:195], v[204:207], v[160:163], v[192:195]
    v_mfma_f32_16x16x32_bf16 v[196:199], v[204:207], v[176:179], v[196:199]
    s_waitcnt vmcnt(1)
    v_mfma_f32_16x16x32_bf16 v[184:187], v[208:211], v[164:167], v[184:187]
    v_mfma_f32_16x16x32_bf16 v[188:191], v[208:211], v[180:183], v[188:191]
    s_waitcnt vmcnt(0)
    v_mfma_f32_16x16x32_bf16 v[192:195], v[212:215], v[164:167], v[192:195]
    v_mfma_f32_16x16x32_bf16 v[196:199], v[212:215], v[180:183], v[196:199]
    s_nop 3
    v_exp_f32 v184, v184
    v_exp_f32 v185, v185
    v_add_f32 v9, v9, v184
    v_add_f32 v9, v9, v185
    v_cvt_pk_bf16_f32 v144, v184, v185
    v_exp_f32 v186, v186
    v_exp_f32 v187, v187
    v_add_f32 v9, v9, v186
    v_add_f32 v9, v9, v187
    v_cvt_pk_bf16_f32 v145, v186, v187
    v_exp_f32 v188, v188
    v_exp_f32 v189, v189
    v_add_f32 v10, v10, v188
    v_add_f32 v10, v10, v189
    v_cvt_pk_bf16_f32 v148, v188, v189
    v_exp_f32 v190, v190
    v_exp_f32 v191, v191
    v_add_f32 v10, v10, v190
    v_add_f32 v10, v10, v191
    v_cvt_pk_bf16_f32 v149, v190, v191
    v_exp_f32 v192, v192
    v_exp_f32 v193, v193
    v_add_f32 v9, v9, v192
    v_add_f32 v9, v9, v193
    v_cvt_pk_bf16_f32 v146, v192, v193
    v_exp_f32 v194, v194
    v_exp_f32 v195, v195
    v_add_f32 v9, v9, v194
    v_add_f32 v9, v9, v195
    v_cvt_pk_bf16_f32 v147, v194, v195
    v_exp_f32 v196, v196
    v_exp_f32 v197, v197
    v_add_f32 v10, v10, v196
    v_add_f32 v10, v10, v197
    v_cvt_pk_bf16_f32 v150, v196, v197
    v_exp_f32 v198, v198
    v_exp_f32 v199, v199
    v_add_f32 v10, v10, v198
    v_add_f32 v10, v10, v199
    v_cvt_pk_bf16_f32 v151, v198, v199
    v_mov_b32 v16, v9
    v_mov_b32 v18, v10
    s_nop 0
    v_permlane16_swap_b32 v9, v16
    v_permlane16_swap_b32 v10, v18
    v_add_f32 v9, v9, v16
    v_add_f32 v10, v10, v18
    v_mov_b32 v16, v9
    v_mov_b32 v18, v10
    s_nop 0
    v_permlane32_swap_b32 v9, v16
    v_permlane32_swap_b32 v10, v18
    v_add_f32 v9, v9, v16
    v_add_f32 v10, v10, v18
    s_waitcnt vmcnt(0) lgkmcnt(0)
    s_nop 15
    s_nop 3
    s_branch adaLN_cond__sliding_block_cached__moe_arch_mod__prompt_kernel_fixAb
adaLN_cond__sliding_block_cached__moe_arch_mod__prompt_kernel_o5r:
    s_waitcnt vmcnt(0) lgkmcnt(0)
    s_nop 15
    s_nop 3
    s_mov_b32 s27, 0
adaLN_cond__sliding_block_cached__moe_arch_mod__prompt_kernel_o5p:
    buffer_load_dword v12, v13, s[8:11], s19 offen sc1
    s_waitcnt vmcnt(0)
    v_cmp_ne_u32 vcc, s28, v12
    s_add_u32 s27, s27, 1
    s_cmp_ge_u32 s27, 65536
    s_cbranch_scc1 adaLN_cond__sliding_block_cached__moe_arch_mod__prompt_kernel_o5g
    s_cbranch_vccnz adaLN_cond__sliding_block_cached__moe_arch_mod__prompt_kernel_o5p
adaLN_cond__sliding_block_cached__moe_arch_mod__prompt_kernel_o5g:
    s_waitcnt vmcnt(0) lgkmcnt(0)
    s_nop 15
    s_nop 3
    s_branch adaLN_cond__sliding_block_cached__moe_arch_mod__prompt_kernel_o5b
adaLN_cond__sliding_block_cached__moe_arch_mod__prompt_kernel_mp6r:
    s_waitcnt vmcnt(0) lgkmcnt(0)
    s_nop 15
    s_nop 3
    s_mov_b32 s27, 0
adaLN_cond__sliding_block_cached__moe_arch_mod__prompt_kernel_mp6p:
    buffer_load_dword v248, v250, s[8:11], s14 offen sc1
    s_waitcnt vmcnt(0)
    v_cmp_ne_u32 vcc, s28, v248
    s_add_u32 s27, s27, 1
    s_cmp_ge_u32 s27, 65536
    s_cbranch_scc1 adaLN_cond__sliding_block_cached__moe_arch_mod__prompt_kernel_mp6g
    s_cbranch_vccnz adaLN_cond__sliding_block_cached__moe_arch_mod__prompt_kernel_mp6p
adaLN_cond__sliding_block_cached__moe_arch_mod__prompt_kernel_mp6g:
    s_waitcnt vmcnt(0) lgkmcnt(0)
    s_nop 15
    s_nop 3
    s_branch adaLN_cond__sliding_block_cached__moe_arch_mod__prompt_kernel_mp6b
adaLN_cond__sliding_block_cached__moe_arch_mod__prompt_kernel_o27r:
    s_waitcnt vmcnt(0) lgkmcnt(0)
    s_nop 15
    s_nop 3
    s_mov_b32 s27, 0
adaLN_cond__sliding_block_cached__moe_arch_mod__prompt_kernel_o27p:
    buffer_load_dword v12, v13, s[8:11], s19 offen sc1
    s_waitcnt vmcnt(0)
    v_cmp_ne_u32 vcc, s28, v12
    s_add_u32 s27, s27, 1
    s_cmp_ge_u32 s27, 65536
    s_cbranch_scc1 adaLN_cond__sliding_block_cached__moe_arch_mod__prompt_kernel_o27g
    s_cbranch_vccnz adaLN_cond__sliding_block_cached__moe_arch_mod__prompt_kernel_o27p
adaLN_cond__sliding_block_cached__moe_arch_mod__prompt_kernel_o27g:
    s_waitcnt vmcnt(0) lgkmcnt(0)
    s_nop 15
    s_nop 3
    s_branch adaLN_cond__sliding_block_cached__moe_arch_mod__prompt_kernel_o27b
adaLN_cond__sliding_block_cached__moe_arch_mod__prompt_kernel_o28r:
    s_waitcnt vmcnt(0) lgkmcnt(0)
    s_nop 15
    s_nop 3
    s_mov_b32 s27, 0
adaLN_cond__sliding_block_cached__moe_arch_mod__prompt_kernel_o28p:
    buffer_load_dword v12, v13, s[8:11], s19 offen sc1
    s_waitcnt vmcnt(0)
    v_cmp_ne_u32 vcc, s28, v12
    s_add_u32 s27, s27, 1
    s_cmp_ge_u32 s27, 65536
    s_cbranch_scc1 adaLN_cond__sliding_block_cached__moe_arch_mod__prompt_kernel_o28g
    s_cbranch_vccnz adaLN_cond__sliding_block_cached__moe_arch_mod__prompt_kernel_o28p
adaLN_cond__sliding_block_cached__moe_arch_mod__prompt_kernel_o28g:
    s_waitcnt vmcnt(0) lgkmcnt(0)
    s_nop 15
    s_nop 3
    s_branch adaLN_cond__sliding_block_cached__moe_arch_mod__prompt_kernel_o28b
adaLN_cond__sliding_block_cached__moe_arch_mod__prompt_kernel_o29r:
    s_waitcnt vmcnt(0) lgkmcnt(0)
    s_nop 15
    s_nop 3
    s_mov_b32 s27, 0
adaLN_cond__sliding_block_cached__moe_arch_mod__prompt_kernel_o29p:
    buffer_load_dword v12, v13, s[8:11], s19 offen sc1
    s_waitcnt vmcnt(0)
    v_cmp_ne_u32 vcc, s28, v12
    s_add_u32 s27, s27, 1
    s_cmp_ge_u32 s27, 65536
    s_cbranch_scc1 adaLN_cond__sliding_block_cached__moe_arch_mod__prompt_kernel_o29g
    s_cbranch_vccnz adaLN_cond__sliding_block_cached__moe_arch_mod__prompt_kernel_o29p
adaLN_cond__sliding_block_cached__moe_arch_mod__prompt_kernel_o29g:
    s_waitcnt vmcnt(0) lgkmcnt(0)
    s_nop 15
    s_nop 3
    s_branch adaLN_cond__sliding_block_cached__moe_arch_mod__prompt_kernel_o29b
adaLN_cond__sliding_block_cached__moe_arch_mod__prompt_kernel_mf10r:
    s_waitcnt vmcnt(0) lgkmcnt(0)
    s_nop 15
    s_nop 3
    s_mov_b32 s27, 0
adaLN_cond__sliding_block_cached__moe_arch_mod__prompt_kernel_mf10p:
    s_mov_b32 s16, 0x544000
    buffer_load_dwordx4 v[184:187], v2, s[8:11], s16 offen sc1
    s_waitcnt vmcnt(0)
    v_xor_b32 v16, s28, v184
    v_xor_b32 v17, s28, v185
    v_xor_b32 v18, s28, v186
    v_xor_b32 v19, s28, v187
    v_or3_b32 v16, v16, v17, v18
    v_or_b32 v16, v16, v19
    v_cmp_ne_u32 vcc, 0, v16
    s_add_u32 s27, s27, 1
    s_cmp_ge_u32 s27, 65536
    s_cbranch_scc1 adaLN_cond__sliding_block_cached__moe_arch_mod__prompt_kernel_mf10g
    s_cbranch_vccnz adaLN_cond__sliding_block_cached__moe_arch_mod__prompt_kernel_mf10p
adaLN_cond__sliding_block_cached__moe_arch_mod__prompt_kernel_mf10g:
    s_waitcnt vmcnt(0) lgkmcnt(0)
    s_nop 15
    s_nop 3
    s_branch adaLN_cond__sliding_block_cached__moe_arch_mod__prompt_kernel_mf10b
adaLN_cond__sliding_block_cached__moe_arch_mod__prompt_kernel_kv16r:
    s_waitcnt vmcnt(0) lgkmcnt(0)
    s_nop 15
    s_nop 3
    s_mov_b32 s27, 0
adaLN_cond__sliding_block_cached__moe_arch_mod__prompt_kernel_kv16p:
    buffer_load_dwordx4 v[12:15], v21, s[8:11], s18 offen sc1
    s_waitcnt vmcnt(0)
    v_xor_b32 v8, s28, v12
    v_xor_b32 v20, s28, v13
    v_or_b32 v8, v8, v20
    v_xor_b32 v20, s28, v14
    v_or_b32 v8, v8, v20
    v_xor_b32 v20, s28, v15
    v_or_b32 v8, v8, v20
    v_cmp_ne_u32 vcc, 0, v8
    s_add_u32 s27, s27, 1
    s_cmp_ge_u32 s27, 65536
    s_cbranch_scc1 adaLN_cond__sliding_block_cached__moe_arch_mod__prompt_kernel_kv16g
    s_cbranch_vccnz adaLN_cond__sliding_block_cached__moe_arch_mod__prompt_kernel_kv16p
adaLN_cond__sliding_block_cached__moe_arch_mod__prompt_kernel_kv16g:
    s_waitcnt vmcnt(0) lgkmcnt(0)
    s_nop 15
    s_nop 3
    s_branch adaLN_cond__sliding_block_cached__moe_arch_mod__prompt_kernel_kv16b
adaLN_cond__sliding_block_cached__moe_arch_mod__prompt_kernel_fixB:
    s_waitcnt vmcnt(0) lgkmcnt(0)
    s_nop 15
    s_nop 3
    s_lshr_b32 s16, s12, 3
    s_lshl_b32 s16, s16, 17
    s_add_u32 s16, s16, 0x400000
    v_add_u32 v8, s16, v2
    v_mov_b32 v16, 0xff7fffff
    v_mov_b32 v17, 0xff7fffff
    s_mov_b32 s16, 0
adaLN_cond__sliding_block_cached__moe_arch_mod__prompt_kernel_fixBm:
    s_add_u32 s17, s16, 0
    buffer_load_dwordx4 v[200:203], v8, s[8:11], s17 offen offset:0
    buffer_load_dwordx4 v[204:207], v8, s[8:11], s17 offen offset:1024
    buffer_load_dwordx4 v[208:211], v8, s[8:11], s17 offen offset:2048
    buffer_load_dwordx4 v[212:215], v8, s[8:11], s17 offen offset:3072
    s_waitcnt vmcnt(3)
    v_mfma_f32_16x16x32_bf16 v[184:187], v[200:203], v[152:155], 0
    v_mfma_f32_16x16x32_bf16 v[188:191], v[200:203], v[168:171], 0
    s_waitcnt vmcnt(2)
    v_mfma_f32_16x16x32_bf16 v[192:195], v[204:207], v[152:155], 0
    v_mfma_f32_16x16x32_bf16 v[196:199], v[204:207], v[168:171], 0
    s_waitcnt vmcnt(1)
    v_mfma_f32_16x16x32_bf16 v[184:187], v[208:211], v[156:159], v[184:187]
    v_mfma_f32_16x16x32_bf16 v[188:191], v[208:211], v[172:175], v[188:191]
    s_waitcnt vmcnt(0)
    v_mfma_f32_16x16x32_bf16 v[192:195], v[212:215], v[156:159], v[192:195]
    v_mfma_f32_16x16x32_bf16 v[196:199], v[212:215], v[172:175], v[196:199]
    s_add_u32 s17, s16, 4096
    buffer_load_dwordx4 v[200:203], v8, s[8:11], s17 offen offset:0
    buffer_load_dwordx4 v[204:207], v8, s[8:11], s17 offen offset:1024
    buffer_load_dwordx4 v[208:211], v8, s[8:11], s17 offen offset:2048
    buffer_load_dwordx4 v[212:215], v8, s[8:11], s17 offen offset:3072
    s_waitcnt vmcnt(3)
    v_mfma_f32_16x16x32_bf16 v[184:187], v[200:203], v[160:163], v[184:187]
    v_mfma_f32_16x16x32_bf16 v[188:191], v[200:203], v[176:179], v[188:191]
    s_waitcnt vmcnt(2)
    v_mfma_f32_16x16x32_bf16 v[192:195], v[204:207], v[160:163], v[192:195]
    v_mfma_f32_16x16x32_bf16 v[196:199], v[204:207], v[176:179], v[196:199]
    s_waitcnt vmcnt(1)
    v_mfma_f32_16x16x32_bf16 v[184:187], v[208:211], v[164:167], v[184:187]
    v_mfma_f32_16x16x32_bf16 v[188:191], v[208:211], v[180:183], v[188:191]
    s_waitcnt vmcnt(0)
    v_mfma_f32_16x16x32_bf16 v[192:195], v[212:215], v[164:167], v[192:195]
    v_mfma_f32_16x16x32_bf16 v[196:199], v[212:215], v[180:183], v[196:199]
    s_nop 3
    v_max3_f32 v16, v16, v184, v185
    v_max3_f32 v16, v16, v186, v187
    v_max3_f32 v17, v17, v188, v189
    v_max3_f32 v17, v17, v190, v191
    v_max3_f32 v16, v16, v192, v193
    v_max3_f32 v16, v16, v194, v195
    v_max3_f32 v17, v17, v196, v197
    v_max3_f32 v17, v17, v198, v199
    s_add_u32 s16, s16, 8192
    s_cmp_lt_u32 s16, 0x20000
    s_cbranch_scc1 adaLN_cond__sliding_block_cached__moe_arch_mod__prompt_kernel_fixBm
    v_mov_b32 v18, v16
    v_mov_b32 v19, v17
    s_nop 0
    v_permlane16_swap_b32 v16, v18
    v_permlane16_swap_b32 v17, v19
    v_max_f32 v16, v16, v18
    v_max_f32 v17, v17, v19
    v_mov_b32 v18, v16
    v_mov_b32 v19, v17
    s_nop 0
    v_permlane32_swap_b32 v16, v18
    v_permlane32_swap_b32 v17, v19
    v_max_f32 v16, v16, v18
    v_max_f32 v17, v17, v19
    v_sub_f32 v216, 0, v16
    v_sub_f32 v217, 0, v16
    v_sub_f32 v218, 0, v16
    v_sub_f32 v219, 0, v16
    v_sub_f32 v220, 0, v17
    v_sub_f32 v221, 0, v17
    v_sub_f32 v222, 0, v17
    v_sub_f32 v223, 0, v17
    s_mov_b32 s17, 0x0
    buffer_load_dwordx4 v[200:203], v8, s[8:11], s17 offen offset:0
    buffer_load_dwordx4 v[204:207], v8, s[8:11], s17 offen offset:1024
    buffer_load_dwordx4 v[208:211], v8, s[8:11], s17 offen offset:2048
    buffer_load_dwordx4 v[212:215], v8, s[8:11], s17 offen offset:3072
    s_waitcnt vmcnt(3)
    v_mfma_f32_16x16x32_bf16 v[184:187], v[200:203], v[152:155], v[216:219]
    v_mfma_f32_16x16x32_bf16 v[188:191], v[200:203], v[168:171], v[220:223]
    s_waitcnt vmcnt(2)
    v_mfma_f32_16x16x32_bf16 v[192:195], v[204:207], v[152:155], v[216:219]
    v_mfma_f32_16x16x32_bf16 v[196:199], v[204:207], v[168:171], v[220:223]
    s_waitcnt vmcnt(1)
    v_mfma_f32_16x16x32_bf16 v[184:187], v[208:211], v[156:159], v[184:187]
    v_mfma_f32_16x16x32_bf16 v[188:191], v[208:211], v[172:175], v[188:191]
    s_waitcnt vmcnt(0)
    v_mfma_f32_16x16x32_bf16 v[192:195], v[212:215], v[156:159], v[192:195]
    v_mfma_f32_16x16x32_bf16 v[196:199], v[212:215], v[172:175], v[196:199]
    s_mov_b32 s17, 0x1000
    buffer_load_dwordx4 v[200:203], v8, s[8:11], s17 offen offset:0
    buffer_load_dwordx4 v[204:207], v8, s[8:11], s17 offen offset:1024
    buffer_load_dwordx4 v[208:211], v8, s[8:11], s17 offen offset:2048
    buffer_load_dwordx4 v[212:215], v8, s[8:11], s17 offen offset:3072
    s_waitcnt vmcnt(3)
    v_mfma_f32_16x16x32_bf16 v[184:187], v[200:203], v[160:163], v[184:187]
    v_mfma_f32_16x16x32_bf16 v[188:191], v[200:203], v[176:179], v[188:191]
    s_waitcnt vmcnt(2)
    v_mfma_f32_16x16x32_bf16 v[192:195], v[204:207], v[160:163], v[192:195]
    v_mfma_f32_16x16x32_bf16 v[196:199], v[204:207], v[176:179], v[196:199]
    s_waitcnt vmcnt(1)
    v_mfma_f32_16x16x32_bf16 v[184:187], v[208:211], v[164:167], v[184:187]
    v_mfma_f32_16x16x32_bf16 v[188:191], v[208:211], v[180:183], v[188:191]
    s_waitcnt vmcnt(0)
    v_mfma_f32_16x16x32_bf16 v[192:195], v[212:215], v[164:167], v[192:195]
    v_mfma_f32_16x16x32_bf16 v[196:199], v[212:215], v[180:183], v[196:199]
    s_nop 3
    v_exp_f32 v184, v184
    v_exp_f32 v185, v185
    s_nop 0
    v_add_f32 v9, v184, v185
    v_cvt_pk_bf16_f32 v24, v184, v185
    v_exp_f32 v186, v186
    v_exp_f32 v187, v187
    v_add_f32 v9, v9, v186
    v_add_f32 v9, v9, v187
    v_cvt_pk_bf16_f32 v25, v186, v187
    v_exp_f32 v188, v188
    v_exp_f32 v189, v189
    s_nop 0
    v_add_f32 v10, v188, v189
    v_cvt_pk_bf16_f32 v28, v188, v189
    v_exp_f32 v190, v190
    v_exp_f32 v191, v191
    v_add_f32 v10, v10, v190
    v_add_f32 v10, v10, v191
    v_cvt_pk_bf16_f32 v29, v190, v191
    v_exp_f32 v192, v192
    v_exp_f32 v193, v193
    v_add_f32 v9, v9, v192
    v_add_f32 v9, v9, v193
    v_cvt_pk_bf16_f32 v26, v192, v193
    v_exp_f32 v194, v194
    v_exp_f32 v195, v195
    v_add_f32 v9, v9, v194
    v_add_f32 v9, v9, v195
    v_cvt_pk_bf16_f32 v27, v194, v195
    v_exp_f32 v196, v196
    v_exp_f32 v197, v197
    v_add_f32 v10, v10, v196
    v_add_f32 v10, v10, v197
    v_cvt_pk_bf16_f32 v30, v196, v197
    v_exp_f32 v198, v198
    v_exp_f32 v199, v199
    v_add_f32 v10, v10, v198
    v_add_f32 v10, v10, v199
    v_cvt_pk_bf16_f32 v31, v198, v199
    s_mov_b32 s17, 0x2000
    buffer_load_dwordx4 v[200:203], v8, s[8:11], s17 offen offset:0
    buffer_load_dwordx4 v[204:207], v8, s[8:11], s17 offen offset:1024
    buffer_load_dwordx4 v[208:211], v8, s[8:11], s17 offen offset:2048
    buffer_load_dwordx4 v[212:215], v8, s[8:11], s17 offen offset:3072
    s_waitcnt vmcnt(3)
    v_mfma_f32_16x16x32_bf16 v[184:187], v[200:203], v[152:155], v[216:219]
    v_mfma_f32_16x16x32_bf16 v[188:191], v[200:203], v[168:171], v[220:223]
    s_waitcnt vmcnt(2)
    v_mfma_f32_16x16x32_bf16 v[192:195], v[204:207], v[152:155], v[216:219]
    v_mfma_f32_16x16x32_bf16 v[196:199], v[204:207], v[168:171], v[220:223]
    s_waitcnt vmcnt(1)
    v_mfma_f32_16x16x32_bf16 v[184:187], v[208:211], v[156:159], v[184:187]
    v_mfma_f32_16x16x32_bf16 v[188:191], v[208:211], v[172:175], v[188:191]
    s_waitcnt vmcnt(0)
    v_mfma_f32_16x16x32_bf16 v[192:195], v[212:215], v[156:159], v[192:195]
    v_mfma_f32_16x16x32_bf16 v[196:199], v[212:215], v[172:175], v[196:199]
    s_mov_b32 s17, 0x3000
    buffer_load_dwordx4 v[200:203], v8, s[8:11], s17 offen offset:0
    buffer_load_dwordx4 v[204:207], v8, s[8:11], s17 offen offset:1024
    buffer_load_dwordx4 v[208:211], v8, s[8:11], s17 offen offset:2048
    buffer_load_dwordx4 v[212:215], v8, s[8:11], s17 offen offset:3072
    s_waitcnt vmcnt(3)
    v_mfma_f32_16x16x32_bf16 v[184:187], v[200:203], v[160:163], v[184:187]
    v_mfma_f32_16x16x32_bf16 v[188:191], v[200:203], v[176:179], v[188:191]
    s_waitcnt vmcnt(2)
    v_mfma_f32_16x16x32_bf16 v[192:195], v[204:207], v[160:163], v[192:195]
    v_mfma_f32_16x16x32_bf16 v[196:199], v[204:207], v[176:179], v[196:199]
    s_waitcnt vmcnt(1)
    v_mfma_f32_16x16x32_bf16 v[184:187], v[208:211], v[164:167], v[184:187]
    v_mfma_f32_16x16x32_bf16 v[188:191], v[208:211], v[180:183], v[188:191]
    s_waitcnt vmcnt(0)
    v_mfma_f32_16x16x32_bf16 v[192:195], v[212:215], v[164:167], v[192:195]
    v_mfma_f32_16x16x32_bf16 v[196:199], v[212:215], v[180:183], v[196:199]
    s_nop 3
    v_exp_f32 v184, v184
    v_exp_f32 v185, v185
    v_add_f32 v9, v9, v184
    v_add_f32 v9, v9, v185
    v_cvt_pk_bf16_f32 v32, v184, v185
    v_exp_f32 v186, v186
    v_exp_f32 v187, v187
    v_add_f32 v9, v9, v186
    v_add_f32 v9, v9, v187
    v_cvt_pk_bf16_f32 v33, v186, v187
    v_exp_f32 v188, v188
    v_exp_f32 v189, v189
    v_add_f32 v10, v10, v188
    v_add_f32 v10, v10, v189
    v_cvt_pk_bf16_f32 v36, v188, v189
    v_exp_f32 v190, v190
    v_exp_f32 v191, v191
    v_add_f32 v10, v10, v190
    v_add_f32 v10, v10, v191
    v_cvt_pk_bf16_f32 v37, v190, v191
    v_exp_f32 v192, v192
    v_exp_f32 v193, v193
    v_add_f32 v9, v9, v192
    v_add_f32 v9, v9, v193
    v_cvt_pk_bf16_f32 v34, v192, v193
    v_exp_f32 v194, v194
    v_exp_f32 v195, v195
    v_add_f32 v9, v9, v194
    v_add_f32 v9, v9, v195
    v_cvt_pk_bf16_f32 v35, v194, v195
    v_exp_f32 v196, v196
    v_exp_f32 v197, v197
    v_add_f32 v10, v10, v196
    v_add_f32 v10, v10, v197
    v_cvt_pk_bf16_f32 v38, v196, v197
    v_exp_f32 v198, v198
    v_exp_f32 v199, v199
    v_add_f32 v10, v10, v198
    v_add_f32 v10, v10, v199
    v_cvt_pk_bf16_f32 v39, v198, v199
    s_mov_b32 s17, 0x4000
    buffer_load_dwordx4 v[200:203], v8, s[8:11], s17 offen offset:0
    buffer_load_dwordx4 v[204:207], v8, s[8:11], s17 offen offset:1024
    buffer_load_dwordx4 v[208:211], v8, s[8:11], s17 offen offset:2048
    buffer_load_dwordx4 v[212:215], v8, s[8:11], s17 offen offset:3072
    s_waitcnt vmcnt(3)
    v_mfma_f32_16x16x32_bf16 v[184:187], v[200:203], v[152:155], v[216:219]
    v_mfma_f32_16x16x32_bf16 v[188:191], v[200:203], v[168:171], v[220:223]
    s_waitcnt vmcnt(2)
    v_mfma_f32_16x16x32_bf16 v[192:195], v[204:207], v[152:155], v[216:219]
    v_mfma_f32_16x16x32_bf16 v[196:199], v[204:207], v[168:171], v[220:223]
    s_waitcnt vmcnt(1)
    v_mfma_f32_16x16x32_bf16 v[184:187], v[208:211], v[156:159], v[184:187]
    v_mfma_f32_16x16x32_bf16 v[188:191], v[208:211], v[172:175], v[188:191]
    s_waitcnt vmcnt(0)
    v_mfma_f32_16x16x32_bf16 v[192:195], v[212:215], v[156:159], v[192:195]
    v_mfma_f32_16x16x32_bf16 v[196:199], v[212:215], v[172:175], v[196:199]
    s_mov_b32 s17, 0x5000
    buffer_load_dwordx4 v[200:203], v8, s[8:11], s17 offen offset:0
    buffer_load_dwordx4 v[204:207], v8, s[8:11], s17 offen offset:1024
    buffer_load_dwordx4 v[208:211], v8, s[8:11], s17 offen offset:2048
    buffer_load_dwordx4 v[212:215], v8, s[8:11], s17 offen offset:3072
    s_waitcnt vmcnt(3)
    v_mfma_f32_16x16x32_bf16 v[184:187], v[200:203], v[160:163], v[184:187]
    v_mfma_f32_16x16x32_bf16 v[188:191], v[200:203], v[176:179], v[188:191]
    s_waitcnt vmcnt(2)
    v_mfma_f32_16x16x32_bf16 v[192:195], v[204:207], v[160:163], v[192:195]
    v_mfma_f32_16x16x32_bf16 v[196:199], v[204:207], v[176:179], v[196:199]
    s_waitcnt vmcnt(1)
    v_mfma_f32_16x16x32_bf16 v[184:187], v[208:211], v[164:167], v[184:187]
    v_mfma_f32_16x16x32_bf16 v[188:191], v[208:211], v[180:183], v[188:191]
    s_waitcnt vmcnt(0)
    v_mfma_f32_16x16x32_bf16 v[192:195], v[212:215], v[164:167], v[192:195]
    v_mfma_f32_16x16x32_bf16 v[196:199], v[212:215], v[180:183], v[196:199]
    s_nop 3
    v_exp_f32 v184, v184
    v_exp_f32 v185, v185
    v_add_f32 v9, v9, v184
    v_add_f32 v9, v9, v185
    v_cvt_pk_bf16_f32 v40, v184, v185
    v_exp_f32 v186, v186
    v_exp_f32 v187, v187
    v_add_f32 v9, v9, v186
    v_add_f32 v9, v9, v187
    v_cvt_pk_bf16_f32 v41, v186, v187
    v_exp_f32 v188, v188
    v_exp_f32 v189, v189
    v_add_f32 v10, v10, v188
    v_add_f32 v10, v10, v189
    v_cvt_pk_bf16_f32 v44, v188, v189
    v_exp_f32 v190, v190
    v_exp_f32 v191, v191
    v_add_f32 v10, v10, v190
    v_add_f32 v10, v10, v191
    v_cvt_pk_bf16_f32 v45, v190, v191
    v_exp_f32 v192, v192
    v_exp_f32 v193, v193
    v_add_f32 v9, v9, v192
    v_add_f32 v9, v9, v193
    v_cvt_pk_bf16_f32 v42, v192, v193
    v_exp_f32 v194, v194
    v_exp_f32 v195, v195
    v_add_f32 v9, v9, v194
    v_add_f32 v9, v9, v195
    v_cvt_pk_bf16_f32 v43, v194, v195
    v_exp_f32 v196, v196
    v_exp_f32 v197, v197
    v_add_f32 v10, v10, v196
    v_add_f32 v10, v10, v197
    v_cvt_pk_bf16_f32 v46, v196, v197
    v_exp_f32 v198, v198
    v_exp_f32 v199, v199
    v_add_f32 v10, v10, v198
    v_add_f32 v10, v10, v199
    v_cvt_pk_bf16_f32 v47, v198, v199
    s_mov_b32 s17, 0x6000
    buffer_load_dwordx4 v[200:203], v8, s[8:11], s17 offen offset:0
    buffer_load_dwordx4 v[204:207], v8, s[8:11], s17 offen offset:1024
    buffer_load_dwordx4 v[208:211], v8, s[8:11], s17 offen offset:2048
    buffer_load_dwordx4 v[212:215], v8, s[8:11], s17 offen offset:3072
    s_waitcnt vmcnt(3)
    v_mfma_f32_16x16x32_bf16 v[184:187], v[200:203], v[152:155], v[216:219]
    v_mfma_f32_16x16x32_bf16 v[188:191], v[200:203], v[168:171], v[220:223]
    s_waitcnt vmcnt(2)
    v_mfma_f32_16x16x32_bf16 v[192:195], v[204:207], v[152:155], v[216:219]
    v_mfma_f32_16x16x32_bf16 v[196:199], v[204:207], v[168:171], v[220:223]
    s_waitcnt vmcnt(1)
    v_mfma_f32_16x16x32_bf16 v[184:187], v[208:211], v[156:159], v[184:187]
    v_mfma_f32_16x16x32_bf16 v[188:191], v[208:211], v[172:175], v[188:191]
    s_waitcnt vmcnt(0)
    v_mfma_f32_16x16x32_bf16 v[192:195], v[212:215], v[156:159], v[192:195]
    v_mfma_f32_16x16x32_bf16 v[196:199], v[212:215], v[172:175], v[196:199]
    s_mov_b32 s17, 0x7000
    buffer_load_dwordx4 v[200:203], v8, s[8:11], s17 offen offset:0
    buffer_load_dwordx4 v[204:207], v8, s[8:11], s17 offen offset:1024
    buffer_load_dwordx4 v[208:211], v8, s[8:11], s17 offen offset:2048
    buffer_load_dwordx4 v[212:215], v8, s[8:11], s17 offen offset:3072
    s_waitcnt vmcnt(3)
    v_mfma_f32_16x16x32_bf16 v[184:187], v[200:203], v[160:163], v[184:187]
    v_mfma_f32_16x16x32_bf16 v[188:191], v[200:203], v[176:179], v[188:191]
    s_waitcnt vmcnt(2)
    v_mfma_f32_16x16x32_bf16 v[192:195], v[204:207], v[160:163], v[192:195]
    v_mfma_f32_16x16x32_bf16 v[196:199], v[204:207], v[176:179], v[196:199]
    s_waitcnt vmcnt(1)
    v_mfma_f32_16x16x32_bf16 v[184:187], v[208:211], v[164:167], v[184:187]
    v_mfma_f32_16x16x32_bf16 v[188:191], v[208:211], v[180:183], v[188:191]
    s_waitcnt vmcnt(0)
    v_mfma_f32_16x16x32_bf16 v[192:195], v[212:215], v[164:167], v[192:195]
    v_mfma_f32_16x16x32_bf16 v[196:199], v[212:215], v[180:183], v[196:199]
    s_nop 3
    v_exp_f32 v184, v184
    v_exp_f32 v185, v185
    v_add_f32 v9, v9, v184
    v_add_f32 v9, v9, v185
    v_cvt_pk_bf16_f32 v48, v184, v185
    v_exp_f32 v186, v186
    v_exp_f32 v187, v187
    v_add_f32 v9, v9, v186
    v_add_f32 v9, v9, v187
    v_cvt_pk_bf16_f32 v49, v186, v187
    v_exp_f32 v188, v188
    v_exp_f32 v189, v189
    v_add_f32 v10, v10, v188
    v_add_f32 v10, v10, v189
    v_cvt_pk_bf16_f32 v52, v188, v189
    v_exp_f32 v190, v190
    v_exp_f32 v191, v191
    v_add_f32 v10, v10, v190
    v_add_f32 v10, v10, v191
    v_cvt_pk_bf16_f32 v53, v190, v191
    v_exp_f32 v192, v192
    v_exp_f32 v193, v193
    v_add_f32 v9, v9, v192
    v_add_f32 v9, v9, v193
    v_cvt_pk_bf16_f32 v50, v192, v193
    v_exp_f32 v194, v194
    v_exp_f32 v195, v195
    v_add_f32 v9, v9, v194
    v_add_f32 v9, v9, v195
    v_cvt_pk_bf16_f32 v51, v194, v195
    v_exp_f32 v196, v196
    v_exp_f32 v197, v197
    v_add_f32 v10, v10, v196
    v_add_f32 v10, v10, v197
    v_cvt_pk_bf16_f32 v54, v196, v197
    v_exp_f32 v198, v198
    v_exp_f32 v199, v199
    v_add_f32 v10, v10, v198
    v_add_f32 v10, v10, v199
    v_cvt_pk_bf16_f32 v55, v198, v199
    s_mov_b32 s17, 0x8000
    buffer_load_dwordx4 v[200:203], v8, s[8:11], s17 offen offset:0
    buffer_load_dwordx4 v[204:207], v8, s[8:11], s17 offen offset:1024
    buffer_load_dwordx4 v[208:211], v8, s[8:11], s17 offen offset:2048
    buffer_load_dwordx4 v[212:215], v8, s[8:11], s17 offen offset:3072
    s_waitcnt vmcnt(3)
    v_mfma_f32_16x16x32_bf16 v[184:187], v[200:203], v[152:155], v[216:219]
    v_mfma_f32_16x16x32_bf16 v[188:191], v[200:203], v[168:171], v[220:223]
    s_waitcnt vmcnt(2)
    v_mfma_f32_16x16x32_bf16 v[192:195], v[204:207], v[152:155], v[216:219]
    v_mfma_f32_16x16x32_bf16 v[196:199], v[204:207], v[168:171], v[220:223]
    s_waitcnt vmcnt(1)
    v_mfma_f32_16x16x32_bf16 v[184:187], v[208:211], v[156:159], v[184:187]
    v_mfma_f32_16x16x32_bf16 v[188:191], v[208:211], v[172:175], v[188:191]
    s_waitcnt vmcnt(0)
    v_mfma_f32_16x16x32_bf16 v[192:195], v[212:215], v[156:159], v[192:195]
    v_mfma_f32_16x16x32_bf16 v[196:199], v[212:215], v[172:175], v[196:199]
    s_mov_b32 s17, 0x9000
    buffer_load_dwordx4 v[200:203], v8, s[8:11], s17 offen offset:0
    buffer_load_dwordx4 v[204:207], v8, s[8:11], s17 offen offset:1024
    buffer_load_dwordx4 v[208:211], v8, s[8:11], s17 offen offset:2048
    buffer_load_dwordx4 v[212:215], v8, s[8:11], s17 offen offset:3072
    s_waitcnt vmcnt(3)
    v_mfma_f32_16x16x32_bf16 v[184:187], v[200:203], v[160:163], v[184:187]
    v_mfma_f32_16x16x32_bf16 v[188:191], v[200:203], v[176:179], v[188:191]
    s_waitcnt vmcnt(2)
    v_mfma_f32_16x16x32_bf16 v[192:195], v[204:207], v[160:163], v[192:195]
    v_mfma_f32_16x16x32_bf16 v[196:199], v[204:207], v[176:179], v[196:199]
    s_waitcnt vmcnt(1)
    v_mfma_f32_16x16x32_bf16 v[184:187], v[208:211], v[164:167], v[184:187]
    v_mfma_f32_16x16x32_bf16 v[188:191], v[208:211], v[180:183], v[188:191]
    s_waitcnt vmcnt(0)
    v_mfma_f32_16x16x32_bf16 v[192:195], v[212:215], v[164:167], v[192:195]
    v_mfma_f32_16x16x32_bf16 v[196:199], v[212:215], v[180:183], v[196:199]
    s_nop 3
    v_exp_f32 v184, v184
    v_exp_f32 v185, v185
    v_add_f32 v9, v9, v184
    v_add_f32 v9, v9, v185
    v_cvt_pk_bf16_f32 v56, v184, v185
    v_exp_f32 v186, v186
    v_exp_f32 v187, v187
    v_add_f32 v9, v9, v186
    v_add_f32 v9, v9, v187
    v_cvt_pk_bf16_f32 v57, v186, v187
    v_exp_f32 v188, v188
    v_exp_f32 v189, v189
    v_add_f32 v10, v10, v188
    v_add_f32 v10, v10, v189
    v_cvt_pk_bf16_f32 v60, v188, v189
    v_exp_f32 v190, v190
    v_exp_f32 v191, v191
    v_add_f32 v10, v10, v190
    v_add_f32 v10, v10, v191
    v_cvt_pk_bf16_f32 v61, v190, v191
    v_exp_f32 v192, v192
    v_exp_f32 v193, v193
    v_add_f32 v9, v9, v192
    v_add_f32 v9, v9, v193
    v_cvt_pk_bf16_f32 v58, v192, v193
    v_exp_f32 v194, v194
    v_exp_f32 v195, v195
    v_add_f32 v9, v9, v194
    v_add_f32 v9, v9, v195
    v_cvt_pk_bf16_f32 v59, v194, v195
    v_exp_f32 v196, v196
    v_exp_f32 v197, v197
    v_add_f32 v10, v10, v196
    v_add_f32 v10, v10, v197
    v_cvt_pk_bf16_f32 v62, v196, v197
    v_exp_f32 v198, v198
    v_exp_f32 v199, v199
    v_add_f32 v10, v10, v198
    v_add_f32 v10, v10, v199
    v_cvt_pk_bf16_f32 v63, v198, v199
    s_mov_b32 s17, 0xa000
    buffer_load_dwordx4 v[200:203], v8, s[8:11], s17 offen offset:0
    buffer_load_dwordx4 v[204:207], v8, s[8:11], s17 offen offset:1024
    buffer_load_dwordx4 v[208:211], v8, s[8:11], s17 offen offset:2048
    buffer_load_dwordx4 v[212:215], v8, s[8:11], s17 offen offset:3072
    s_waitcnt vmcnt(3)
    v_mfma_f32_16x16x32_bf16 v[184:187], v[200:203], v[152:155], v[216:219]
    v_mfma_f32_16x16x32_bf16 v[188:191], v[200:203], v[168:171], v[220:223]
    s_waitcnt vmcnt(2)
    v_mfma_f32_16x16x32_bf16 v[192:195], v[204:207], v[152:155], v[216:219]
    v_mfma_f32_16x16x32_bf16 v[196:199], v[204:207], v[168:171], v[220:223]
    s_waitcnt vmcnt(1)
    v_mfma_f32_16x16x32_bf16 v[184:187], v[208:211], v[156:159], v[184:187]
    v_mfma_f32_16x16x32_bf16 v[188:191], v[208:211], v[172:175], v[188:191]
    s_waitcnt vmcnt(0)
    v_mfma_f32_16x16x32_bf16 v[192:195], v[212:215], v[156:159], v[192:195]
    v_mfma_f32_16x16x32_bf16 v[196:199], v[212:215], v[172:175], v[196:199]
    s_mov_b32 s17, 0xb000
    buffer_load_dwordx4 v[200:203], v8, s[8:11], s17 offen offset:0
    buffer_load_dwordx4 v[204:207], v8, s[8:11], s17 offen offset:1024
    buffer_load_dwordx4 v[208:211], v8, s[8:11], s17 offen offset:2048
    buffer_load_dwordx4 v[212:215], v8, s[8:11], s17 offen offset:3072
    s_waitcnt vmcnt(3)
    v_mfma_f32_16x16x32_bf16 v[184:187], v[200:203], v[160:163], v[184:187]
    v_mfma_f32_16x16x32_bf16 v[188:191], v[200:203], v[176:179], v[188:191]
    s_waitcnt vmcnt(2)
    v_mfma_f32_16x16x32_bf16 v[192:195], v[204:207], v[160:163], v[192:195]
    v_mfma_f32_16x16x32_bf16 v[196:199], v[204:207], v[176:179], v[196:199]
    s_waitcnt vmcnt(1)
    v_mfma_f32_16x16x32_bf16 v[184:187], v[208:211], v[164:167], v[184:187]
    v_mfma_f32_16x16x32_bf16 v[188:191], v[208:211], v[180:183], v[188:191]
    s_waitcnt vmcnt(0)
    v_mfma_f32_16x16x32_bf16 v[192:195], v[212:215], v[164:167], v[192:195]
    v_mfma_f32_16x16x32_bf16 v[196:199], v[212:215], v[180:183], v[196:199]
    s_nop 3
    v_exp_f32 v184, v184
    v_exp_f32 v185, v185
    v_add_f32 v9, v9, v184
    v_add_f32 v9, v9, v185
    v_cvt_pk_bf16_f32 v64, v184, v185
    v_exp_f32 v186, v186
    v_exp_f32 v187, v187
    v_add_f32 v9, v9, v186
    v_add_f32 v9, v9, v187
    v_cvt_pk_bf16_f32 v65, v186, v187
    v_exp_f32 v188, v188
    v_exp_f32 v189, v189
    v_add_f32 v10, v10, v188
    v_add_f32 v10, v10, v189
    v_cvt_pk_bf16_f32 v68, v188, v189
    v_exp_f32 v190, v190
    v_exp_f32 v191, v191
    v_add_f32 v10, v10, v190
    v_add_f32 v10, v10, v191
    v_cvt_pk_bf16_f32 v69, v190, v191
    v_exp_f32 v192, v192
    v_exp_f32 v193, v193
    v_add_f32 v9, v9, v192
    v_add_f32 v9, v9, v193
    v_cvt_pk_bf16_f32 v66, v192, v193
    v_exp_f32 v194, v194
    v_exp_f32 v195, v195
    v_add_f32 v9, v9, v194
    v_add_f32 v9, v9, v195
    v_cvt_pk_bf16_f32 v67, v194, v195
    v_exp_f32 v196, v196
    v_exp_f32 v197, v197
    v_add_f32 v10, v10, v196
    v_add_f32 v10, v10, v197
    v_cvt_pk_bf16_f32 v70, v196, v197
    v_exp_f32 v198, v198
    v_exp_f32 v199, v199
    v_add_f32 v10, v10, v198
    v_add_f32 v10, v10, v199
    v_cvt_pk_bf16_f32 v71, v198, v199
    s_mov_b32 s17, 0xc000
    buffer_load_dwordx4 v[200:203], v8, s[8:11], s17 offen offset:0
    buffer_load_dwordx4 v[204:207], v8, s[8:11], s17 offen offset:1024
    buffer_load_dwordx4 v[208:211], v8, s[8:11], s17 offen offset:2048
    buffer_load_dwordx4 v[212:215], v8, s[8:11], s17 offen offset:3072
    s_waitcnt vmcnt(3)
    v_mfma_f32_16x16x32_bf16 v[184:187], v[200:203], v[152:155], v[216:219]
    v_mfma_f32_16x16x32_bf16 v[188:191], v[200:203], v[168:171], v[220:223]
    s_waitcnt vmcnt(2)
    v_mfma_f32_16x16x32_bf16 v[192:195], v[204:207], v[152:155], v[216:219]
    v_mfma_f32_16x16x32_bf16 v[196:199], v[204:207], v[168:171], v[220:223]
    s_waitcnt vmcnt(1)
    v_mfma_f32_16x16x32_bf16 v[184:187], v[208:211], v[156:159], v[184:187]
    v_mfma_f32_16x16x32_bf16 v[188:191], v[208:211], v[172:175], v[188:191]
    s_waitcnt vmcnt(0)
    v_mfma_f32_16x16x32_bf16 v[192:195], v[212:215], v[156:159], v[192:195]
    v_mfma_f32_16x16x32_bf16 v[196:199], v[212:215], v[172:175], v[196:199]
    s_mov_b32 s17, 0xd000
    buffer_load_dwordx4 v[200:203], v8, s[8:11], s17 offen offset:0
    buffer_load_dwordx4 v[204:207], v8, s[8:11], s17 offen offset:1024
    buffer_load_dwordx4 v[208:211], v8, s[8:11], s17 offen offset:2048
    buffer_load_dwordx4 v[212:215], v8, s[8:11], s17 offen offset:3072
    s_waitcnt vmcnt(3)
    v_mfma_f32_16x16x32_bf16 v[184:187], v[200:203], v[160:163], v[184:187]
    v_mfma_f32_16x16x32_bf16 v[188:191], v[200:203], v[176:179], v[188:191]
    s_waitcnt vmcnt(2)
    v_mfma_f32_16x16x32_bf16 v[192:195], v[204:207], v[160:163], v[192:195]
    v_mfma_f32_16x16x32_bf16 v[196:199], v[204:207], v[176:179], v[196:199]
    s_waitcnt vmcnt(1)
    v_mfma_f32_16x16x32_bf16 v[184:187], v[208:211], v[164:167], v[184:187]
    v_mfma_f32_16x16x32_bf16 v[188:191], v[208:211], v[180:183], v[188:191]
    s_waitcnt vmcnt(0)
    v_mfma_f32_16x16x32_bf16 v[192:195], v[212:215], v[164:167], v[192:195]
    v_mfma_f32_16x16x32_bf16 v[196:199], v[212:215], v[180:183], v[196:199]
    s_nop 3
    v_exp_f32 v184, v184
    v_exp_f32 v185, v185
    v_add_f32 v9, v9, v184
    v_add_f32 v9, v9, v185
    v_cvt_pk_bf16_f32 v72, v184, v185
    v_exp_f32 v186, v186
    v_exp_f32 v187, v187
    v_add_f32 v9, v9, v186
    v_add_f32 v9, v9, v187
    v_cvt_pk_bf16_f32 v73, v186, v187
    v_exp_f32 v188, v188
    v_exp_f32 v189, v189
    v_add_f32 v10, v10, v188
    v_add_f32 v10, v10, v189
    v_cvt_pk_bf16_f32 v76, v188, v189
    v_exp_f32 v190, v190
    v_exp_f32 v191, v191
    v_add_f32 v10, v10, v190
    v_add_f32 v10, v10, v191
    v_cvt_pk_bf16_f32 v77, v190, v191
    v_exp_f32 v192, v192
    v_exp_f32 v193, v193
    v_add_f32 v9, v9, v192
    v_add_f32 v9, v9, v193
    v_cvt_pk_bf16_f32 v74, v192, v193
    v_exp_f32 v194, v194
    v_exp_f32 v195, v195
    v_add_f32 v9, v9, v194
    v_add_f32 v9, v9, v195
    v_cvt_pk_bf16_f32 v75, v194, v195
    v_exp_f32 v196, v196
    v_exp_f32 v197, v197
    v_add_f32 v10, v10, v196
    v_add_f32 v10, v10, v197
    v_cvt_pk_bf16_f32 v78, v196, v197
    v_exp_f32 v198, v198
    v_exp_f32 v199, v199
    v_add_f32 v10, v10, v198
    v_add_f32 v10, v10, v199
    v_cvt_pk_bf16_f32 v79, v198, v199
    s_mov_b32 s17, 0xe000
    buffer_load_dwordx4 v[200:203], v8, s[8:11], s17 offen offset:0
    buffer_load_dwordx4 v[204:207], v8, s[8:11], s17 offen offset:1024
    buffer_load_dwordx4 v[208:211], v8, s[8:11], s17 offen offset:2048
    buffer_load_dwordx4 v[212:215], v8, s[8:11], s17 offen offset:3072
    s_waitcnt vmcnt(3)
    v_mfma_f32_16x16x32_bf16 v[184:187], v[200:203], v[152:155], v[216:219]
    v_mfma_f32_16x16x32_bf16 v[188:191], v[200:203], v[168:171], v[220:223]
    s_waitcnt vmcnt(2)
    v_mfma_f32_16x16x32_bf16 v[192:195], v[204:207], v[152:155], v[216:219]
    v_mfma_f32_16x16x32_bf16 v[196:199], v[204:207], v[168:171], v[220:223]
    s_waitcnt vmcnt(1)
    v_mfma_f32_16x16x32_bf16 v[184:187], v[208:211], v[156:159], v[184:187]
    v_mfma_f32_16x16x32_bf16 v[188:191], v[208:211], v[172:175], v[188:191]
    s_waitcnt vmcnt(0)
    v_mfma_f32_16x16x32_bf16 v[192:195], v[212:215], v[156:159], v[192:195]
    v_mfma_f32_16x16x32_bf16 v[196:199], v[212:215], v[172:175], v[196:199]
    s_mov_b32 s17, 0xf000
    buffer_load_dwordx4 v[200:203], v8, s[8:11], s17 offen offset:0
    buffer_load_dwordx4 v[204:207], v8, s[8:11], s17 offen offset:1024
    buffer_load_dwordx4 v[208:211], v8, s[8:11], s17 offen offset:2048
    buffer_load_dwordx4 v[212:215], v8, s[8:11], s17 offen offset:3072
    s_waitcnt vmcnt(3)
    v_mfma_f32_16x16x32_bf16 v[184:187], v[200:203], v[160:163], v[184:187]
    v_mfma_f32_16x16x32_bf16 v[188:191], v[200:203], v[176:179], v[188:191]
    s_waitcnt vmcnt(2)
    v_mfma_f32_16x16x32_bf16 v[192:195], v[204:207], v[160:163], v[192:195]
    v_mfma_f32_16x16x32_bf16 v[196:199], v[204:207], v[176:179], v[196:199]
    s_waitcnt vmcnt(1)
    v_mfma_f32_16x16x32_bf16 v[184:187], v[208:211], v[164:167], v[184:187]
    v_mfma_f32_16x16x32_bf16 v[188:191], v[208:211], v[180:183], v[188:191]
    s_waitcnt vmcnt(0)
    v_mfma_f32_16x16x32_bf16 v[192:195], v[212:215], v[164:167], v[192:195]
    v_mfma_f32_16x16x32_bf16 v[196:199], v[212:215], v[180:183], v[196:199]
    s_nop 3
    v_exp_f32 v184, v184
    v_exp_f32 v185, v185
    v_add_f32 v9, v9, v184
    v_add_f32 v9, v9, v185
    v_cvt_pk_bf16_f32 v80, v184, v185
    v_exp_f32 v186, v186
    v_exp_f32 v187, v187
    v_add_f32 v9, v9, v186
    v_add_f32 v9, v9, v187
    v_cvt_pk_bf16_f32 v81, v186, v187
    v_exp_f32 v188, v188
    v_exp_f32 v189, v189
    v_add_f32 v10, v10, v188
    v_add_f32 v10, v10, v189
    v_cvt_pk_bf16_f32 v84, v188, v189
    v_exp_f32 v190, v190
    v_exp_f32 v191, v191
    v_add_f32 v10, v10, v190
    v_add_f32 v10, v10, v191
    v_cvt_pk_bf16_f32 v85, v190, v191
    v_exp_f32 v192, v192
    v_exp_f32 v193, v193
    v_add_f32 v9, v9, v192
    v_add_f32 v9, v9, v193
    v_cvt_pk_bf16_f32 v82, v192, v193
    v_exp_f32 v194, v194
    v_exp_f32 v195, v195
    v_add_f32 v9, v9, v194
    v_add_f32 v9, v9, v195
    v_cvt_pk_bf16_f32 v83, v194, v195
    v_exp_f32 v196, v196
    v_exp_f32 v197, v197
    v_add_f32 v10, v10, v196
    v_add_f32 v10, v10, v197
    v_cvt_pk_bf16_f32 v86, v196, v197
    v_exp_f32 v198, v198
    v_exp_f32 v199, v199
    v_add_f32 v10, v10, v198
    v_add_f32 v10, v10, v199
    v_cvt_pk_bf16_f32 v87, v198, v199
    s_mov_b32 s17, 0x10000
    buffer_load_dwordx4 v[200:203], v8, s[8:11], s17 offen offset:0
    buffer_load_dwordx4 v[204:207], v8, s[8:11], s17 offen offset:1024
    buffer_load_dwordx4 v[208:211], v8, s[8:11], s17 offen offset:2048
    buffer_load_dwordx4 v[212:215], v8, s[8:11], s17 offen offset:3072
    s_waitcnt vmcnt(3)
    v_mfma_f32_16x16x32_bf16 v[184:187], v[200:203], v[152:155], v[216:219]
    v_mfma_f32_16x16x32_bf16 v[188:191], v[200:203], v[168:171], v[220:223]
    s_waitcnt vmcnt(2)
    v_mfma_f32_16x16x32_bf16 v[192:195], v[204:207], v[152:155], v[216:219]
    v_mfma_f32_16x16x32_bf16 v[196:199], v[204:207], v[168:171], v[220:223]
    s_waitcnt vmcnt(1)
    v_mfma_f32_16x16x32_bf16 v[184:187], v[208:211], v[156:159], v[184:187]
    v_mfma_f32_16x16x32_bf16 v[188:191], v[208:211], v[172:175], v[188:191]
    s_waitcnt vmcnt(0)
    v_mfma_f32_16x16x32_bf16 v[192:195], v[212:215], v[156:159], v[192:195]
    v_mfma_f32_16x16x32_bf16 v[196:199], v[212:215], v[172:175], v[196:199]
    s_mov_b32 s17, 0x11000
    buffer_load_dwordx4 v[200:203], v8, s[8:11], s17 offen offset:0
    buffer_load_dwordx4 v[204:207], v8, s[8:11], s17 offen offset:1024
    buffer_load_dwordx4 v[208:211], v8, s[8:11], s17 offen offset:2048
    buffer_load_dwordx4 v[212:215], v8, s[8:11], s17 offen offset:3072
    s_waitcnt vmcnt(3)
    v_mfma_f32_16x16x32_bf16 v[184:187], v[200:203], v[160:163], v[184:187]
    v_mfma_f32_16x16x32_bf16 v[188:191], v[200:203], v[176:179], v[188:191]
    s_waitcnt vmcnt(2)
    v_mfma_f32_16x16x32_bf16 v[192:195], v[204:207], v[160:163], v[192:195]
    v_mfma_f32_16x16x32_bf16 v[196:199], v[204:207], v[176:179], v[196:199]
    s_waitcnt vmcnt(1)
    v_mfma_f32_16x16x32_bf16 v[184:187], v[208:211], v[164:167], v[184:187]
    v_mfma_f32_16x16x32_bf16 v[188:191], v[208:211], v[180:183], v[188:191]
    s_waitcnt vmcnt(0)
    v_mfma_f32_16x16x32_bf16 v[192:195], v[212:215], v[164:167], v[192:195]
    v_mfma_f32_16x16x32_bf16 v[196:199], v[212:215], v[180:183], v[196:199]
    s_nop 3
    v_exp_f32 v184, v184
    v_exp_f32 v185, v185
    v_add_f32 v9, v9, v184
    v_add_f32 v9, v9, v185
    v_cvt_pk_bf16_f32 v88, v184, v185
    v_exp_f32 v186, v186
    v_exp_f32 v187, v187
    v_add_f32 v9, v9, v186
    v_add_f32 v9, v9, v187
    v_cvt_pk_bf16_f32 v89, v186, v187
    v_exp_f32 v188, v188
    v_exp_f32 v189, v189
    v_add_f32 v10, v10, v188
    v_add_f32 v10, v10, v189
    v_cvt_pk_bf16_f32 v92, v188, v189
    v_exp_f32 v190, v190
    v_exp_f32 v191, v191
    v_add_f32 v10, v10, v190
    v_add_f32 v10, v10, v191
    v_cvt_pk_bf16_f32 v93, v190, v191
    v_exp_f32 v192, v192
    v_exp_f32 v193, v193
    v_add_f32 v9, v9, v192
    v_add_f32 v9, v9, v193
    v_cvt_pk_bf16_f32 v90, v192, v193
    v_exp_f32 v194, v194
    v_exp_f32 v195, v195
    v_add_f32 v9, v9, v194
    v_add_f32 v9, v9, v195
    v_cvt_pk_bf16_f32 v91, v194, v195
    v_exp_f32 v196, v196
    v_exp_f32 v197, v197
    v_add_f32 v10, v10, v196
    v_add_f32 v10, v10, v197
    v_cvt_pk_bf16_f32 v94, v196, v197
    v_exp_f32 v198, v198
    v_exp_f32 v199, v199
    v_add_f32 v10, v10, v198
    v_add_f32 v10, v10, v199
    v_cvt_pk_bf16_f32 v95, v198, v199
    s_mov_b32 s17, 0x12000
    buffer_load_dwordx4 v[200:203], v8, s[8:11], s17 offen offset:0
    buffer_load_dwordx4 v[204:207], v8, s[8:11], s17 offen offset:1024
    buffer_load_dwordx4 v[208:211], v8, s[8:11], s17 offen offset:2048
    buffer_load_dwordx4 v[212:215], v8, s[8:11], s17 offen offset:3072
    s_waitcnt vmcnt(3)
    v_mfma_f32_16x16x32_bf16 v[184:187], v[200:203], v[152:155], v[216:219]
    v_mfma_f32_16x16x32_bf16 v[188:191], v[200:203], v[168:171], v[220:223]
    s_waitcnt vmcnt(2)
    v_mfma_f32_16x16x32_bf16 v[192:195], v[204:207], v[152:155], v[216:219]
    v_mfma_f32_16x16x32_bf16 v[196:199], v[204:207], v[168:171], v[220:223]
    s_waitcnt vmcnt(1)
    v_mfma_f32_16x16x32_bf16 v[184:187], v[208:211], v[156:159], v[184:187]
    v_mfma_f32_16x16x32_bf16 v[188:191], v[208:211], v[172:175], v[188:191]
    s_waitcnt vmcnt(0)
    v_mfma_f32_16x16x32_bf16 v[192:195], v[212:215], v[156:159], v[192:195]
    v_mfma_f32_16x16x32_bf16 v[196:199], v[212:215], v[172:175], v[196:199]
    s_mov_b32 s17, 0x13000
    buffer_load_dwordx4 v[200:203], v8, s[8:11], s17 offen offset:0
    buffer_load_dwordx4 v[204:207], v8, s[8:11], s17 offen offset:1024
    buffer_load_dwordx4 v[208:211], v8, s[8:11], s17 offen offset:2048
    buffer_load_dwordx4 v[212:215], v8, s[8:11], s17 offen offset:3072
    s_waitcnt vmcnt(3)
    v_mfma_f32_16x16x32_bf16 v[184:187], v[200:203], v[160:163], v[184:187]
    v_mfma_f32_16x16x32_bf16 v[188:191], v[200:203], v[176:179], v[188:191]
    s_waitcnt vmcnt(2)
    v_mfma_f32_16x16x32_bf16 v[192:195], v[204:207], v[160:163], v[192:195]
    v_mfma_f32_16x16x32_bf16 v[196:199], v[204:207], v[176:179], v[196:199]
    s_waitcnt vmcnt(1)
    v_mfma_f32_16x16x32_bf16 v[184:187], v[208:211], v[164:167], v[184:187]
    v_mfma_f32_16x16x32_bf16 v[188:191], v[208:211], v[180:183], v[188:191]
    s_waitcnt vmcnt(0)
    v_mfma_f32_16x16x32_bf16 v[192:195], v[212:215], v[164:167], v[192:195]
    v_mfma_f32_16x16x32_bf16 v[196:199], v[212:215], v[180:183], v[196:199]
    s_nop 3
    v_exp_f32 v184, v184
    v_exp_f32 v185, v185
    v_add_f32 v9, v9, v184
    v_add_f32 v9, v9, v185
    v_cvt_pk_bf16_f32 v96, v184, v185
    v_exp_f32 v186, v186
    v_exp_f32 v187, v187
    v_add_f32 v9, v9, v186
    v_add_f32 v9, v9, v187
    v_cvt_pk_bf16_f32 v97, v186, v187
    v_exp_f32 v188, v188
    v_exp_f32 v189, v189
    v_add_f32 v10, v10, v188
    v_add_f32 v10, v10, v189
    v_cvt_pk_bf16_f32 v100, v188, v189
    v_exp_f32 v190, v190
    v_exp_f32 v191, v191
    v_add_f32 v10, v10, v190
    v_add_f32 v10, v10, v191
    v_cvt_pk_bf16_f32 v101, v190, v191
    v_exp_f32 v192, v192
    v_exp_f32 v193, v193
    v_add_f32 v9, v9, v192
    v_add_f32 v9, v9, v193
    v_cvt_pk_bf16_f32 v98, v192, v193
    v_exp_f32 v194, v194
    v_exp_f32 v195, v195
    v_add_f32 v9, v9, v194
    v_add_f32 v9, v9, v195
    v_cvt_pk_bf16_f32 v99, v194, v195
    v_exp_f32 v196, v196
    v_exp_f32 v197, v197
    v_add_f32 v10, v10, v196
    v_add_f32 v10, v10, v197
    v_cvt_pk_bf16_f32 v102, v196, v197
    v_exp_f32 v198, v198
    v_exp_f32 v199, v199
    v_add_f32 v10, v10, v198
    v_add_f32 v10, v10, v199
    v_cvt_pk_bf16_f32 v103, v198, v199
    s_mov_b32 s17, 0x14000
    buffer_load_dwordx4 v[200:203], v8, s[8:11], s17 offen offset:0
    buffer_load_dwordx4 v[204:207], v8, s[8:11], s17 offen offset:1024
    buffer_load_dwordx4 v[208:211], v8, s[8:11], s17 offen offset:2048
    buffer_load_dwordx4 v[212:215], v8, s[8:11], s17 offen offset:3072
    s_waitcnt vmcnt(3)
    v_mfma_f32_16x16x32_bf16 v[184:187], v[200:203], v[152:155], v[216:219]
    v_mfma_f32_16x16x32_bf16 v[188:191], v[200:203], v[168:171], v[220:223]
    s_waitcnt vmcnt(2)
    v_mfma_f32_16x16x32_bf16 v[192:195], v[204:207], v[152:155], v[216:219]
    v_mfma_f32_16x16x32_bf16 v[196:199], v[204:207], v[168:171], v[220:223]
    s_waitcnt vmcnt(1)
    v_mfma_f32_16x16x32_bf16 v[184:187], v[208:211], v[156:159], v[184:187]
    v_mfma_f32_16x16x32_bf16 v[188:191], v[208:211], v[172:175], v[188:191]
    s_waitcnt vmcnt(0)
    v_mfma_f32_16x16x32_bf16 v[192:195], v[212:215], v[156:159], v[192:195]
    v_mfma_f32_16x16x32_bf16 v[196:199], v[212:215], v[172:175], v[196:199]
    s_mov_b32 s17, 0x15000
    buffer_load_dwordx4 v[200:203], v8, s[8:11], s17 offen offset:0
    buffer_load_dwordx4 v[204:207], v8, s[8:11], s17 offen offset:1024
    buffer_load_dwordx4 v[208:211], v8, s[8:11], s17 offen offset:2048
    buffer_load_dwordx4 v[212:215], v8, s[8:11], s17 offen offset:3072
    s_waitcnt vmcnt(3)
    v_mfma_f32_16x16x32_bf16 v[184:187], v[200:203], v[160:163], v[184:187]
    v_mfma_f32_16x16x32_bf16 v[188:191], v[200:203], v[176:179], v[188:191]
    s_waitcnt vmcnt(2)
    v_mfma_f32_16x16x32_bf16 v[192:195], v[204:207], v[160:163], v[192:195]
    v_mfma_f32_16x16x32_bf16 v[196:199], v[204:207], v[176:179], v[196:199]
    s_waitcnt vmcnt(1)
    v_mfma_f32_16x16x32_bf16 v[184:187], v[208:211], v[164:167], v[184:187]
    v_mfma_f32_16x16x32_bf16 v[188:191], v[208:211], v[180:183], v[188:191]
    s_waitcnt vmcnt(0)
    v_mfma_f32_16x16x32_bf16 v[192:195], v[212:215], v[164:167], v[192:195]
    v_mfma_f32_16x16x32_bf16 v[196:199], v[212:215], v[180:183], v[196:199]
    s_nop 3
    v_exp_f32 v184, v184
    v_exp_f32 v185, v185
    v_add_f32 v9, v9, v184
    v_add_f32 v9, v9, v185
    v_cvt_pk_bf16_f32 v104, v184, v185
    v_exp_f32 v186, v186
    v_exp_f32 v187, v187
    v_add_f32 v9, v9, v186
    v_add_f32 v9, v9, v187
    v_cvt_pk_bf16_f32 v105, v186, v187
    v_exp_f32 v188, v188
    v_exp_f32 v189, v189
    v_add_f32 v10, v10, v188
    v_add_f32 v10, v10, v189
    v_cvt_pk_bf16_f32 v108, v188, v189
    v_exp_f32 v190, v190
    v_exp_f32 v191, v191
    v_add_f32 v10, v10, v190
    v_add_f32 v10, v10, v191
    v_cvt_pk_bf16_f32 v109, v190, v191
    v_exp_f32 v192, v192
    v_exp_f32 v193, v193
    v_add_f32 v9, v9, v192
    v_add_f32 v9, v9, v193
    v_cvt_pk_bf16_f32 v106, v192, v193
    v_exp_f32 v194, v194
    v_exp_f32 v195, v195
    v_add_f32 v9, v9, v194
    v_add_f32 v9, v9, v195
    v_cvt_pk_bf16_f32 v107, v194, v195
    v_exp_f32 v196, v196
    v_exp_f32 v197, v197
    v_add_f32 v10, v10, v196
    v_add_f32 v10, v10, v197
    v_cvt_pk_bf16_f32 v110, v196, v197
    v_exp_f32 v198, v198
    v_exp_f32 v199, v199
    v_add_f32 v10, v10, v198
    v_add_f32 v10, v10, v199
    v_cvt_pk_bf16_f32 v111, v198, v199
    s_mov_b32 s17, 0x16000
    buffer_load_dwordx4 v[200:203], v8, s[8:11], s17 offen offset:0
    buffer_load_dwordx4 v[204:207], v8, s[8:11], s17 offen offset:1024
    buffer_load_dwordx4 v[208:211], v8, s[8:11], s17 offen offset:2048
    buffer_load_dwordx4 v[212:215], v8, s[8:11], s17 offen offset:3072
    s_waitcnt vmcnt(3)
    v_mfma_f32_16x16x32_bf16 v[184:187], v[200:203], v[152:155], v[216:219]
    v_mfma_f32_16x16x32_bf16 v[188:191], v[200:203], v[168:171], v[220:223]
    s_waitcnt vmcnt(2)
    v_mfma_f32_16x16x32_bf16 v[192:195], v[204:207], v[152:155], v[216:219]
    v_mfma_f32_16x16x32_bf16 v[196:199], v[204:207], v[168:171], v[220:223]
    s_waitcnt vmcnt(1)
    v_mfma_f32_16x16x32_bf16 v[184:187], v[208:211], v[156:159], v[184:187]
    v_mfma_f32_16x16x32_bf16 v[188:191], v[208:211], v[172:175], v[188:191]
    s_waitcnt vmcnt(0)
    v_mfma_f32_16x16x32_bf16 v[192:195], v[212:215], v[156:159], v[192:195]
    v_mfma_f32_16x16x32_bf16 v[196:199], v[212:215], v[172:175], v[196:199]
    s_mov_b32 s17, 0x17000
    buffer_load_dwordx4 v[200:203], v8, s[8:11], s17 offen offset:0
    buffer_load_dwordx4 v[204:207], v8, s[8:11], s17 offen offset:1024
    buffer_load_dwordx4 v[208:211], v8, s[8:11], s17 offen offset:2048
    buffer_load_dwordx4 v[212:215], v8, s[8:11], s17 offen offset:3072
    s_waitcnt vmcnt(3)
    v_mfma_f32_16x16x32_bf16 v[184:187], v[200:203], v[160:163], v[184:187]
    v_mfma_f32_16x16x32_bf16 v[188:191], v[200:203], v[176:179], v[188:191]
    s_waitcnt vmcnt(2)
    v_mfma_f32_16x16x32_bf16 v[192:195], v[204:207], v[160:163], v[192:195]
    v_mfma_f32_16x16x32_bf16 v[196:199], v[204:207], v[176:179], v[196:199]
    s_waitcnt vmcnt(1)
    v_mfma_f32_16x16x32_bf16 v[184:187], v[208:211], v[164:167], v[184:187]
    v_mfma_f32_16x16x32_bf16 v[188:191], v[208:211], v[180:183], v[188:191]
    s_waitcnt vmcnt(0)
    v_mfma_f32_16x16x32_bf16 v[192:195], v[212:215], v[164:167], v[192:195]
    v_mfma_f32_16x16x32_bf16 v[196:199], v[212:215], v[180:183], v[196:199]
    s_nop 3
    v_exp_f32 v184, v184
    v_exp_f32 v185, v185
    v_add_f32 v9, v9, v184
    v_add_f32 v9, v9, v185
    v_cvt_pk_bf16_f32 v112, v184, v185
    v_exp_f32 v186, v186
    v_exp_f32 v187, v187
    v_add_f32 v9, v9, v186
    v_add_f32 v9, v9, v187
    v_cvt_pk_bf16_f32 v113, v186, v187
    v_exp_f32 v188, v188
    v_exp_f32 v189, v189
    v_add_f32 v10, v10, v188
    v_add_f32 v10, v10, v189
    v_cvt_pk_bf16_f32 v116, v188, v189
    v_exp_f32 v190, v190
    v_exp_f32 v191, v191
    v_add_f32 v10, v10, v190
    v_add_f32 v10, v10, v191
    v_cvt_pk_bf16_f32 v117, v190, v191
    v_exp_f32 v192, v192
    v_exp_f32 v193, v193
    v_add_f32 v9, v9, v192
    v_add_f32 v9, v9, v193
    v_cvt_pk_bf16_f32 v114, v192, v193
    v_exp_f32 v194, v194
    v_exp_f32 v195, v195
    v_add_f32 v9, v9, v194
    v_add_f32 v9, v9, v195
    v_cvt_pk_bf16_f32 v115, v194, v195
    v_exp_f32 v196, v196
    v_exp_f32 v197, v197
    v_add_f32 v10, v10, v196
    v_add_f32 v10, v10, v197
    v_cvt_pk_bf16_f32 v118, v196, v197
    v_exp_f32 v198, v198
    v_exp_f32 v199, v199
    v_add_f32 v10, v10, v198
    v_add_f32 v10, v10, v199
    v_cvt_pk_bf16_f32 v119, v198, v199
    s_mov_b32 s17, 0x18000
    buffer_load_dwordx4 v[200:203], v8, s[8:11], s17 offen offset:0
    buffer_load_dwordx4 v[204:207], v8, s[8:11], s17 offen offset:1024
    buffer_load_dwordx4 v[208:211], v8, s[8:11], s17 offen offset:2048
    buffer_load_dwordx4 v[212:215], v8, s[8:11], s17 offen offset:3072
    s_waitcnt vmcnt(3)
    v_mfma_f32_16x16x32_bf16 v[184:187], v[200:203], v[152:155], v[216:219]
    v_mfma_f32_16x16x32_bf16 v[188:191], v[200:203], v[168:171], v[220:223]
    s_waitcnt vmcnt(2)
    v_mfma_f32_16x16x32_bf16 v[192:195], v[204:207], v[152:155], v[216:219]
    v_mfma_f32_16x16x32_bf16 v[196:199], v[204:207], v[168:171], v[220:223]
    s_waitcnt vmcnt(1)
    v_mfma_f32_16x16x32_bf16 v[184:187], v[208:211], v[156:159], v[184:187]
    v_mfma_f32_16x16x32_bf16 v[188:191], v[208:211], v[172:175], v[188:191]
    s_waitcnt vmcnt(0)
    v_mfma_f32_16x16x32_bf16 v[192:195], v[212:215], v[156:159], v[192:195]
    v_mfma_f32_16x16x32_bf16 v[196:199], v[212:215], v[172:175], v[196:199]
    s_mov_b32 s17, 0x19000
    buffer_load_dwordx4 v[200:203], v8, s[8:11], s17 offen offset:0
    buffer_load_dwordx4 v[204:207], v8, s[8:11], s17 offen offset:1024
    buffer_load_dwordx4 v[208:211], v8, s[8:11], s17 offen offset:2048
    buffer_load_dwordx4 v[212:215], v8, s[8:11], s17 offen offset:3072
    s_waitcnt vmcnt(3)
    v_mfma_f32_16x16x32_bf16 v[184:187], v[200:203], v[160:163], v[184:187]
    v_mfma_f32_16x16x32_bf16 v[188:191], v[200:203], v[176:179], v[188:191]
    s_waitcnt vmcnt(2)
    v_mfma_f32_16x16x32_bf16 v[192:195], v[204:207], v[160:163], v[192:195]
    v_mfma_f32_16x16x32_bf16 v[196:199], v[204:207], v[176:179], v[196:199]
    s_waitcnt vmcnt(1)
    v_mfma_f32_16x16x32_bf16 v[184:187], v[208:211], v[164:167], v[184:187]
    v_mfma_f32_16x16x32_bf16 v[188:191], v[208:211], v[180:183], v[188:191]
    s_waitcnt vmcnt(0)
    v_mfma_f32_16x16x32_bf16 v[192:195], v[212:215], v[164:167], v[192:195]
    v_mfma_f32_16x16x32_bf16 v[196:199], v[212:215], v[180:183], v[196:199]
    s_nop 3
    v_exp_f32 v184, v184
    v_exp_f32 v185, v185
    v_add_f32 v9, v9, v184
    v_add_f32 v9, v9, v185
    v_cvt_pk_bf16_f32 v120, v184, v185
    v_exp_f32 v186, v186
    v_exp_f32 v187, v187
    v_add_f32 v9, v9, v186
    v_add_f32 v9, v9, v187
    v_cvt_pk_bf16_f32 v121, v186, v187
    v_exp_f32 v188, v188
    v_exp_f32 v189, v189
    v_add_f32 v10, v10, v188
    v_add_f32 v10, v10, v189
    v_cvt_pk_bf16_f32 v124, v188, v189
    v_exp_f32 v190, v190
    v_exp_f32 v191, v191
    v_add_f32 v10, v10, v190
    v_add_f32 v10, v10, v191
    v_cvt_pk_bf16_f32 v125, v190, v191
    v_exp_f32 v192, v192
    v_exp_f32 v193, v193
    v_add_f32 v9, v9, v192
    v_add_f32 v9, v9, v193
    v_cvt_pk_bf16_f32 v122, v192, v193
    v_exp_f32 v194, v194
    v_exp_f32 v195, v195
    v_add_f32 v9, v9, v194
    v_add_f32 v9, v9, v195
    v_cvt_pk_bf16_f32 v123, v194, v195
    v_exp_f32 v196, v196
    v_exp_f32 v197, v197
    v_add_f32 v10, v10, v196
    v_add_f32 v10, v10, v197
    v_cvt_pk_bf16_f32 v126, v196, v197
    v_exp_f32 v198, v198
    v_exp_f32 v199, v199
    v_add_f32 v10, v10, v198
    v_add_f32 v10, v10, v199
    v_cvt_pk_bf16_f32 v127, v198, v199
    s_mov_b32 s17, 0x1a000
    buffer_load_dwordx4 v[200:203], v8, s[8:11], s17 offen offset:0
    buffer_load_dwordx4 v[204:207], v8, s[8:11], s17 offen offset:1024
    buffer_load_dwordx4 v[208:211], v8, s[8:11], s17 offen offset:2048
    buffer_load_dwordx4 v[212:215], v8, s[8:11], s17 offen offset:3072
    s_waitcnt vmcnt(3)
    v_mfma_f32_16x16x32_bf16 v[184:187], v[200:203], v[152:155], v[216:219]
    v_mfma_f32_16x16x32_bf16 v[188:191], v[200:203], v[168:171], v[220:223]
    s_waitcnt vmcnt(2)
    v_mfma_f32_16x16x32_bf16 v[192:195], v[204:207], v[152:155], v[216:219]
    v_mfma_f32_16x16x32_bf16 v[196:199], v[204:207], v[168:171], v[220:223]
    s_waitcnt vmcnt(1)
    v_mfma_f32_16x16x32_bf16 v[184:187], v[208:211], v[156:159], v[184:187]
    v_mfma_f32_16x16x32_bf16 v[188:191], v[208:211], v[172:175], v[188:191]
    s_waitcnt vmcnt(0)
    v_mfma_f32_16x16x32_bf16 v[192:195], v[212:215], v[156:159], v[192:195]
    v_mfma_f32_16x16x32_bf16 v[196:199], v[212:215], v[172:175], v[196:199]
    s_mov_b32 s17, 0x1b000
    buffer_load_dwordx4 v[200:203], v8, s[8:11], s17 offen offset:0
    buffer_load_dwordx4 v[204:207], v8, s[8:11], s17 offen offset:1024
    buffer_load_dwordx4 v[208:211], v8, s[8:11], s17 offen offset:2048
    buffer_load_dwordx4 v[212:215], v8, s[8:11], s17 offen offset:3072
    s_waitcnt vmcnt(3)
    v_mfma_f32_16x16x32_bf16 v[184:187], v[200:203], v[160:163], v[184:187]
    v_mfma_f32_16x16x32_bf16 v[188:191], v[200:203], v[176:179], v[188:191]
    s_waitcnt vmcnt(2)
    v_mfma_f32_16x16x32_bf16 v[192:195], v[204:207], v[160:163], v[192:195]
    v_mfma_f32_16x16x32_bf16 v[196:199], v[204:207], v[176:179], v[196:199]
    s_waitcnt vmcnt(1)
    v_mfma_f32_16x16x32_bf16 v[184:187], v[208:211], v[164:167], v[184:187]
    v_mfma_f32_16x16x32_bf16 v[188:191], v[208:211], v[180:183], v[188:191]
    s_waitcnt vmcnt(0)
    v_mfma_f32_16x16x32_bf16 v[192:195], v[212:215], v[164:167], v[192:195]
    v_mfma_f32_16x16x32_bf16 v[196:199], v[212:215], v[180:183], v[196:199]
    s_nop 3
    v_exp_f32 v184, v184
    v_exp_f32 v185, v185
    v_add_f32 v9, v9, v184
    v_add_f32 v9, v9, v185
    v_cvt_pk_bf16_f32 v128, v184, v185
    v_exp_f32 v186, v186
    v_exp_f32 v187, v187
    v_add_f32 v9, v9, v186
    v_add_f32 v9, v9, v187
    v_cvt_pk_bf16_f32 v129, v186, v187
    v_exp_f32 v188, v188
    v_exp_f32 v189, v189
    v_add_f32 v10, v10, v188
    v_add_f32 v10, v10, v189
    v_cvt_pk_bf16_f32 v132, v188, v189
    v_exp_f32 v190, v190
    v_exp_f32 v191, v191
    v_add_f32 v10, v10, v190
    v_add_f32 v10, v10, v191
    v_cvt_pk_bf16_f32 v133, v190, v191
    v_exp_f32 v192, v192
    v_exp_f32 v193, v193
    v_add_f32 v9, v9, v192
    v_add_f32 v9, v9, v193
    v_cvt_pk_bf16_f32 v130, v192, v193
    v_exp_f32 v194, v194
    v_exp_f32 v195, v195
    v_add_f32 v9, v9, v194
    v_add_f32 v9, v9, v195
    v_cvt_pk_bf16_f32 v131, v194, v195
    v_exp_f32 v196, v196
    v_exp_f32 v197, v197
    v_add_f32 v10, v10, v196
    v_add_f32 v10, v10, v197
    v_cvt_pk_bf16_f32 v134, v196, v197
    v_exp_f32 v198, v198
    v_exp_f32 v199, v199
    v_add_f32 v10, v10, v198
    v_add_f32 v10, v10, v199
    v_cvt_pk_bf16_f32 v135, v198, v199
    s_mov_b32 s17, 0x1c000
    buffer_load_dwordx4 v[200:203], v8, s[8:11], s17 offen offset:0
    buffer_load_dwordx4 v[204:207], v8, s[8:11], s17 offen offset:1024
    buffer_load_dwordx4 v[208:211], v8, s[8:11], s17 offen offset:2048
    buffer_load_dwordx4 v[212:215], v8, s[8:11], s17 offen offset:3072
    s_waitcnt vmcnt(3)
    v_mfma_f32_16x16x32_bf16 v[184:187], v[200:203], v[152:155], v[216:219]
    v_mfma_f32_16x16x32_bf16 v[188:191], v[200:203], v[168:171], v[220:223]
    s_waitcnt vmcnt(2)
    v_mfma_f32_16x16x32_bf16 v[192:195], v[204:207], v[152:155], v[216:219]
    v_mfma_f32_16x16x32_bf16 v[196:199], v[204:207], v[168:171], v[220:223]
    s_waitcnt vmcnt(1)
    v_mfma_f32_16x16x32_bf16 v[184:187], v[208:211], v[156:159], v[184:187]
    v_mfma_f32_16x16x32_bf16 v[188:191], v[208:211], v[172:175], v[188:191]
    s_waitcnt vmcnt(0)
    v_mfma_f32_16x16x32_bf16 v[192:195], v[212:215], v[156:159], v[192:195]
    v_mfma_f32_16x16x32_bf16 v[196:199], v[212:215], v[172:175], v[196:199]
    s_mov_b32 s17, 0x1d000
    buffer_load_dwordx4 v[200:203], v8, s[8:11], s17 offen offset:0
    buffer_load_dwordx4 v[204:207], v8, s[8:11], s17 offen offset:1024
    buffer_load_dwordx4 v[208:211], v8, s[8:11], s17 offen offset:2048
    buffer_load_dwordx4 v[212:215], v8, s[8:11], s17 offen offset:3072
    s_waitcnt vmcnt(3)
    v_mfma_f32_16x16x32_bf16 v[184:187], v[200:203], v[160:163], v[184:187]
    v_mfma_f32_16x16x32_bf16 v[188:191], v[200:203], v[176:179], v[188:191]
    s_waitcnt vmcnt(2)
    v_mfma_f32_16x16x32_bf16 v[192:195], v[204:207], v[160:163], v[192:195]
    v_mfma_f32_16x16x32_bf16 v[196:199], v[204:207], v[176:179], v[196:199]
    s_waitcnt vmcnt(1)
    v_mfma_f32_16x16x32_bf16 v[184:187], v[208:211], v[164:167], v[184:187]
    v_mfma_f32_16x16x32_bf16 v[188:191], v[208:211], v[180:183], v[188:191]
    s_waitcnt vmcnt(0)
    v_mfma_f32_16x16x32_bf16 v[192:195], v[212:215], v[164:167], v[192:195]
    v_mfma_f32_16x16x32_bf16 v[196:199], v[212:215], v[180:183], v[196:199]
    s_nop 3
    v_exp_f32 v184, v184
    v_exp_f32 v185, v185
    v_add_f32 v9, v9, v184
    v_add_f32 v9, v9, v185
    v_cvt_pk_bf16_f32 v136, v184, v185
    v_exp_f32 v186, v186
    v_exp_f32 v187, v187
    v_add_f32 v9, v9, v186
    v_add_f32 v9, v9, v187
    v_cvt_pk_bf16_f32 v137, v186, v187
    v_exp_f32 v188, v188
    v_exp_f32 v189, v189
    v_add_f32 v10, v10, v188
    v_add_f32 v10, v10, v189
    v_cvt_pk_bf16_f32 v140, v188, v189
    v_exp_f32 v190, v190
    v_exp_f32 v191, v191
    v_add_f32 v10, v10, v190
    v_add_f32 v10, v10, v191
    v_cvt_pk_bf16_f32 v141, v190, v191
    v_exp_f32 v192, v192
    v_exp_f32 v193, v193
    v_add_f32 v9, v9, v192
    v_add_f32 v9, v9, v193
    v_cvt_pk_bf16_f32 v138, v192, v193
    v_exp_f32 v194, v194
    v_exp_f32 v195, v195
    v_add_f32 v9, v9, v194
    v_add_f32 v9, v9, v195
    v_cvt_pk_bf16_f32 v139, v194, v195
    v_exp_f32 v196, v196
    v_exp_f32 v197, v197
    v_add_f32 v10, v10, v196
    v_add_f32 v10, v10, v197
    v_cvt_pk_bf16_f32 v142, v196, v197
    v_exp_f32 v198, v198
    v_exp_f32 v199, v199
    v_add_f32 v10, v10, v198
    v_add_f32 v10, v10, v199
    v_cvt_pk_bf16_f32 v143, v198, v199
    s_mov_b32 s17, 0x1e000
    buffer_load_dwordx4 v[200:203], v8, s[8:11], s17 offen offset:0
    buffer_load_dwordx4 v[204:207], v8, s[8:11], s17 offen offset:1024
    buffer_load_dwordx4 v[208:211], v8, s[8:11], s17 offen offset:2048
    buffer_load_dwordx4 v[212:215], v8, s[8:11], s17 offen offset:3072
    s_waitcnt vmcnt(3)
    v_mfma_f32_16x16x32_bf16 v[184:187], v[200:203], v[152:155], v[216:219]
    v_mfma_f32_16x16x32_bf16 v[188:191], v[200:203], v[168:171], v[220:223]
    s_waitcnt vmcnt(2)
    v_mfma_f32_16x16x32_bf16 v[192:195], v[204:207], v[152:155], v[216:219]
    v_mfma_f32_16x16x32_bf16 v[196:199], v[204:207], v[168:171], v[220:223]
    s_waitcnt vmcnt(1)
    v_mfma_f32_16x16x32_bf16 v[184:187], v[208:211], v[156:159], v[184:187]
    v_mfma_f32_16x16x32_bf16 v[188:191], v[208:211], v[172:175], v[188:191]
    s_waitcnt vmcnt(0)
    v_mfma_f32_16x16x32_bf16 v[192:195], v[212:215], v[156:159], v[192:195]
    v_mfma_f32_16x16x32_bf16 v[196:199], v[212:215], v[172:175], v[196:199]
    s_mov_b32 s17, 0x1f000
    buffer_load_dwordx4 v[200:203], v8, s[8:11], s17 offen offset:0
    buffer_load_dwordx4 v[204:207], v8, s[8:11], s17 offen offset:1024
    buffer_load_dwordx4 v[208:211], v8, s[8:11], s17 offen offset:2048
    buffer_load_dwordx4 v[212:215], v8, s[8:11], s17 offen offset:3072
    s_waitcnt vmcnt(3)
    v_mfma_f32_16x16x32_bf16 v[184:187], v[200:203], v[160:163], v[184:187]
    v_mfma_f32_16x16x32_bf16 v[188:191], v[200:203], v[176:179], v[188:191]
    s_waitcnt vmcnt(2)
    v_mfma_f32_16x16x32_bf16 v[192:195], v[204:207], v[160:163], v[192:195]
    v_mfma_f32_16x16x32_bf16 v[196:199], v[204:207], v[176:179], v[196:199]
    s_waitcnt vmcnt(1)
    v_mfma_f32_16x16x32_bf16 v[184:187], v[208:211], v[164:167], v[184:187]
    v_mfma_f32_16x16x32_bf16 v[188:191], v[208:211], v[180:183], v[188:191]
    s_waitcnt vmcnt(0)
    v_mfma_f32_16x16x32_bf16 v[192:195], v[212:215], v[164:167], v[192:195]
    v_mfma_f32_16x16x32_bf16 v[196:199], v[212:215], v[180:183], v[196:199]
    s_nop 3
    v_exp_f32 v184, v184
    v_exp_f32 v185, v185
    v_add_f32 v9, v9, v184
    v_add_f32 v9, v9, v185
    v_cvt_pk_bf16_f32 v144, v184, v185
    v_exp_f32 v186, v186
    v_exp_f32 v187, v187
    v_add_f32 v9, v9, v186
    v_add_f32 v9, v9, v187
    v_cvt_pk_bf16_f32 v145, v186, v187
    v_exp_f32 v188, v188
    v_exp_f32 v189, v189
    v_add_f32 v10, v10, v188
    v_add_f32 v10, v10, v189
    v_cvt_pk_bf16_f32 v148, v188, v189
    v_exp_f32 v190, v190
    v_exp_f32 v191, v191
    v_add_f32 v10, v10, v190
    v_add_f32 v10, v10, v191
    v_cvt_pk_bf16_f32 v149, v190, v191
    v_exp_f32 v192, v192
    v_exp_f32 v193, v193
    v_add_f32 v9, v9, v192
    v_add_f32 v9, v9, v193
    v_cvt_pk_bf16_f32 v146, v192, v193
    v_exp_f32 v194, v194
    v_exp_f32 v195, v195
    v_add_f32 v9, v9, v194
    v_add_f32 v9, v9, v195
    v_cvt_pk_bf16_f32 v147, v194, v195
    v_exp_f32 v196, v196
    v_exp_f32 v197, v197
    v_add_f32 v10, v10, v196
    v_add_f32 v10, v10, v197
    v_cvt_pk_bf16_f32 v150, v196, v197
    v_exp_f32 v198, v198
    v_exp_f32 v199, v199
    v_add_f32 v10, v10, v198
    v_add_f32 v10, v10, v199
    v_cvt_pk_bf16_f32 v151, v198, v199
    v_mov_b32 v16, v9
    v_mov_b32 v18, v10
    s_nop 0
    v_permlane16_swap_b32 v9, v16
    v_permlane16_swap_b32 v10, v18
    v_add_f32 v9, v9, v16
    v_add_f32 v10, v10, v18
    v_mov_b32 v16, v9
    v_mov_b32 v18, v10
    s_nop 0
    v_permlane32_swap_b32 v9, v16
    v_permlane32_swap_b32 v10, v18
    v_add_f32 v9, v9, v16
    v_add_f32 v10, v10, v18
    s_waitcnt vmcnt(0) lgkmcnt(0)
    s_nop 15
    s_nop 3
    s_branch adaLN_cond__sliding_block_cached__moe_arch_mod__prompt_kernel_fixBb
adaLN_cond__sliding_block_cached__moe_arch_mod__prompt_kernel_o17r:
    s_waitcnt vmcnt(0) lgkmcnt(0)
    s_nop 15
    s_nop 3
    s_mov_b32 s27, 0
adaLN_cond__sliding_block_cached__moe_arch_mod__prompt_kernel_o17p:
    buffer_load_dword v12, v13, s[8:11], s19 offen sc1
    s_waitcnt vmcnt(0)
    v_cmp_ne_u32 vcc, s28, v12
    s_add_u32 s27, s27, 1
    s_cmp_ge_u32 s27, 65536
    s_cbranch_scc1 adaLN_cond__sliding_block_cached__moe_arch_mod__prompt_kernel_o17g
    s_cbranch_vccnz adaLN_cond__sliding_block_cached__moe_arch_mod__prompt_kernel_o17p
adaLN_cond__sliding_block_cached__moe_arch_mod__prompt_kernel_o17g:
    s_waitcnt vmcnt(0) lgkmcnt(0)
    s_nop 15
    s_nop 3
    s_branch adaLN_cond__sliding_block_cached__moe_arch_mod__prompt_kernel_o17b
adaLN_cond__sliding_block_cached__moe_arch_mod__prompt_kernel_o218r:
    s_waitcnt vmcnt(0) lgkmcnt(0)
    s_nop 15
    s_nop 3
    s_mov_b32 s27, 0
adaLN_cond__sliding_block_cached__moe_arch_mod__prompt_kernel_o218p:
    buffer_load_dword v12, v13, s[8:11], s19 offen sc1
    s_waitcnt vmcnt(0)
    v_cmp_ne_u32 vcc, s28, v12
    s_add_u32 s27, s27, 1
    s_cmp_ge_u32 s27, 65536
    s_cbranch_scc1 adaLN_cond__sliding_block_cached__moe_arch_mod__prompt_kernel_o218g
    s_cbranch_vccnz adaLN_cond__sliding_block_cached__moe_arch_mod__prompt_kernel_o218p
adaLN_cond__sliding_block_cached__moe_arch_mod__prompt_kernel_o218g:
    s_waitcnt vmcnt(0) lgkmcnt(0)
    s_nop 15
    s_nop 3
    s_branch adaLN_cond__sliding_block_cached__moe_arch_mod__prompt_kernel_o218b
adaLN_cond__sliding_block_cached__moe_arch_mod__prompt_kernel_o219r:
    s_waitcnt vmcnt(0) lgkmcnt(0)
    s_nop 15
    s_nop 3
    s_mov_b32 s27, 0
adaLN_cond__sliding_block_cached__moe_arch_mod__prompt_kernel_o219p:
    buffer_load_dword v12, v13, s[8:11], s19 offen sc1
    s_waitcnt vmcnt(0)
    v_cmp_ne_u32 vcc, s28, v12
    s_add_u32 s27, s27, 1
    s_cmp_ge_u32 s27, 65536
    s_cbranch_scc1 adaLN_cond__sliding_block_cached__moe_arch_mod__prompt_kernel_o219g
    s_cbranch_vccnz adaLN_cond__sliding_block_cached__moe_arch_mod__prompt_kernel_o219p
adaLN_cond__sliding_block_cached__moe_arch_mod__prompt_kernel_o219g:
    s_waitcnt vmcnt(0) lgkmcnt(0)
    s_nop 15
    s_nop 3
    s_branch adaLN_cond__sliding_block_cached__moe_arch_mod__prompt_kernel_o219b
adaLN_cond__sliding_block_cached__moe_arch_mod__prompt_kernel_o220r:
    s_waitcnt vmcnt(0) lgkmcnt(0)
    s_nop 15
    s_nop 3
    s_mov_b32 s27, 0
adaLN_cond__sliding_block_cached__moe_arch_mod__prompt_kernel_o220p:
    buffer_load_dword v12, v13, s[8:11], s19 offen sc1
    s_waitcnt vmcnt(0)
    v_cmp_ne_u32 vcc, s28, v12
    s_add_u32 s27, s27, 1
    s_cmp_ge_u32 s27, 65536
    s_cbranch_scc1 adaLN_cond__sliding_block_cached__moe_arch_mod__prompt_kernel_o220g
    s_cbranch_vccnz adaLN_cond__sliding_block_cached__moe_arch_mod__prompt_kernel_o220p
adaLN_cond__sliding_block_cached__moe_arch_mod__prompt_kernel_o220g:
    s_waitcnt vmcnt(0) lgkmcnt(0)
    s_nop 15
    s_nop 3
    s_branch adaLN_cond__sliding_block_cached__moe_arch_mod__prompt_kernel_o220b
adaLN_cond__sliding_block_cached__moe_arch_mod__prompt_kernel_mf21r:
    s_waitcnt vmcnt(0) lgkmcnt(0)
    s_nop 15
    s_nop 3
    s_mov_b32 s27, 0
adaLN_cond__sliding_block_cached__moe_arch_mod__prompt_kernel_mf21p:
    s_mov_b32 s16, 0x544000
    buffer_load_dwordx4 v[184:187], v2, s[8:11], s16 offen sc1
    s_waitcnt vmcnt(0)
    v_xor_b32 v16, s28, v184
    v_xor_b32 v17, s28, v185
    v_xor_b32 v18, s28, v186
    v_xor_b32 v19, s28, v187
    v_or3_b32 v16, v16, v17, v18
    v_or_b32 v16, v16, v19
    v_cmp_ne_u32 vcc, 0, v16
    s_add_u32 s27, s27, 1
    s_cmp_ge_u32 s27, 65536
    s_cbranch_scc1 adaLN_cond__sliding_block_cached__moe_arch_mod__prompt_kernel_mf21g
    s_cbranch_vccnz adaLN_cond__sliding_block_cached__moe_arch_mod__prompt_kernel_mf21p
adaLN_cond__sliding_block_cached__moe_arch_mod__prompt_kernel_mf21g:
    s_waitcnt vmcnt(0) lgkmcnt(0)
    s_nop 15
    s_nop 3
    s_branch adaLN_cond__sliding_block_cached__moe_arch_mod__prompt_kernel_mf21b
adaLN_cond__sliding_block_cached__moe_arch_mod__prompt_kernel_codeend:
    s_endpgm
.section .rodata,"a"
.p2align 6
.amdhsa_kernel adaLN_cond__sliding_block_cached__moe_arch_mod__prompt_kernel
  .amdhsa_next_free_vgpr 256
  .amdhsa_next_free_sgpr 80
  .amdhsa_accum_offset 256
  .amdhsa_group_segment_fixed_size 0
  .amdhsa_kernarg_size 120
  .amdhsa_user_sgpr_count 2
  .amdhsa_user_sgpr_kernarg_segment_ptr 1
  .amdhsa_system_sgpr_workgroup_id_x 1
  .amdhsa_float_denorm_mode_32 3
.end_amdhsa_kernel
```

```asm
; @launch grid=(256,1,1) block=(512,1,1) lds=163840
.amdgcn_target "amdgcn-amd-amdhsa--gfx950"
.text
.globl adaLN_cond__sliding_block_cached__moe_arch_mod__prompt_kernel
.p2align 8
.type adaLN_cond__sliding_block_cached__moe_arch_mod__prompt_kernel,@function
adaLN_cond__sliding_block_cached__moe_arch_mod__prompt_kernel:
    s_cmp_ge_u32 s2, 256
    s_cbranch_scc1 adaLN_cond__sliding_block_cached__moe_arch_mod__prompt_kernel_end
    s_getpc_b64 s[76:77]
adaLN_cond__sliding_block_cached__moe_arch_mod__prompt_kernel_pc0:
    s_sub_u32 s76, s76, adaLN_cond__sliding_block_cached__moe_arch_mod__prompt_kernel_pc0-adaLN_cond__sliding_block_cached__moe_arch_mod__prompt_kernel
    s_subb_u32 s77, s77, 0
    v_and_b32 v16, 63, v0
    v_lshlrev_b32 v16, 7, v16
    v_lshrrev_b32 v17, 6, v0
    s_lshr_b32 s62, s2, 3
    s_lshl_b32 s62, s62, 13
    v_lshlrev_b32 v18, 13, v17
    v_mov_b32 v19, s62
    v_cmp_eq_u32 vcc, 7, v17
    s_nop 1
    v_cndmask_b32 v18, v18, v19, vcc
    v_add_u32 v16, v16, v18
    v_min_u32 v16, adaLN_cond__sliding_block_cached__moe_arch_mod__prompt_kernel_codeend-adaLN_cond__sliding_block_cached__moe_arch_mod__prompt_kernel-4, v16
    v_mov_b32 v25, s77
    v_add_co_u32 v24, vcc, s76, v16
    s_nop 1
    v_addc_co_u32 v25, vcc, 0, v25, vcc
    v_cmp_gt_u32 vcc, 2, v17
    v_cmp_eq_u32 s[62:63], 7, v17
    s_or_b64 vcc, vcc, s[62:63]
    s_and_saveexec_b64 s[62:63], vcc
    s_cbranch_execz adaLN_cond__sliding_block_cached__moe_arch_mod__prompt_kernel_nocp0
    global_load_dword v26, v[24:25], off
adaLN_cond__sliding_block_cached__moe_arch_mod__prompt_kernel_nocp0:
    s_mov_b64 exec, s[62:63]
    s_load_dwordx4 s[56:59], s[0:1], 96
    s_load_dwordx2 s[60:61], s[0:1], 112
    s_load_dwordx8 s[48:55], s[0:1], 64
    s_load_dwordx16 s[32:47], s[0:1], 0
    s_memrealtime s[62:63]
    v_lshrrev_b32 v16, 6, v0
    v_and_b32 v1, 63, v0
    v_readfirstlane_b32 s3, v16
    v_lshlrev_b32 v2, 4, v1
    s_and_b32 s12, s2, 3
    s_lshl_b32 s12, s12, 3
    s_bfe_u32 s13, s2, 0x30003
    s_add_u32 s12, s12, s13
    s_bfe_u32 s13, s2, 0x10002
    s_lshl_b32 s13, s13, 2
    s_lshr_b32 s14, s2, 6
    s_add_u32 s13, s13, s14
    v_bfe_u32 v16, v1, 2, 2
    v_lshrrev_b32 v17, 4, v1
    v_and_b32 v18, 3, v1
    v_lshlrev_b32 v19, 6, v17
    v_lshl_add_u32 v19, v18, 4, v19
    v_lshl_add_u32 v3, v16, 13, v19
    s_and_b32 s14, s3, 1
    s_lshl_b32 s14, s14, 5
    v_xor_b32 v3, s14, v3
    v_lshlrev_b32 v4, 11, v17
    v_lshl_add_u32 v4, v16, 6, v4
    v_lshl_add_u32 v4, v18, 3, v4
    v_and_b32 v20, 1, v17
    v_lshlrev_b32 v20, 5, v20
    v_sub_u32 v5, v4, v20
    v_add_u32 v4, v4, v20
    s_lshl_b32 s14, s13, 3
    s_add_u32 s14, s14, s3
    s_lshl_b32 s14, s14, 16
    v_add_u32 v7, s14, v2
    s_cmp_ge_u32 s3, 4
    s_cbranch_scc1 adaLN_cond__sliding_block_cached__moe_arch_mod__prompt_kernel_roleB
    v_mov_b32 v132, 0
    v_mov_b32 v133, 0
    v_lshrrev_b32 v16, 3, v0
    v_and_b32 v17, 7, v0
    v_mul_u32_u24 v135, 24576, v16
    v_lshl_add_u32 v135, v17, 4, v135
    v_lshlrev_b32 v136, 2, v16
    s_and_b32 s14, s2, 31
    s_lshr_b32 s15, s2, 5
    s_mul_i32 s26, s15, 1572864
    s_lshl_b32 s16, s14, 7
    s_add_u32 s26, s26, s16
    s_lshl_b32 s29, s15, 8
    v_lshlrev_b32 v137, 3, v0
    s_lshl_b32 s18, s2, 3
    s_add_u32 s18, s18, s3
    s_lshl_b32 s18, s18, 11
    v_and_b32 v18, 15, v1
    v_lshrrev_b32 v19, 4, v1
    v_lshlrev_b32 v138, 11, v18
    v_lshl_add_u32 v138, v19, 4, v138
    s_lshr_b32 s30, s2, 4
    s_and_b32 s31, s2, 15
    s_lshl_b32 s19, s30, 3
    s_add_u32 s19, s19, s3
    s_lshl_b32 s22, s19, 15
    s_lshl_b32 s23, s31, 7
    s_add_u32 s22, s22, s23
    s_lshl_b32 s23, s2, 12
    s_add_u32 s23, s23, 0x600000
    s_or_b32 s25, s2, s3
    s_cmp_eq_u32 s25, 0
    s_cselect_b32 s25, 0, 0x7ffffff0
    s_waitcnt lgkmcnt(0)
    s_mov_b64 s[64:65], s[58:59]
    s_mov_b32 s66, 0x100
    s_mov_b32 s67, 0x20000
    s_or_b32 s28, s62, 1
    v_mov_b32 v134, s28
    s_mov_b64 exec, 1
    buffer_store_dword v134, v132, s[64:67], s25 offen sc1
    s_mov_b64 exec, -1
    s_mov_b64 s[68:69], s[52:53]
    s_mov_b32 s70, 0x800
    s_mov_b32 s71, 0x20000
    s_mov_b64 s[72:73], s[54:55]
    s_mov_b32 s74, 0xc00000
    s_mov_b32 s75, 0x20000
    s_mov_b64 s[76:77], s[32:33]
    s_mov_b32 s78, 0x400000
    s_mov_b32 s79, 0x20000
    s_mov_b64 s[8:9], s[60:61]
    s_mov_b32 s10, 0x3400000
    s_mov_b32 s11, 0x20000
    buffer_load_dwordx4 v[32:35], v2, s[76:79], s18 offen offset:0
    buffer_load_dwordx4 v[36:39], v2, s[76:79], s18 offen offset:1024
    buffer_load_dword v72, v136, s[68:71], s29 offen
    buffer_load_dwordx4 v[24:27], v135, s[72:75], s26 offen
    s_add_u32 s26, s26, 12288
    buffer_load_dwordx4 v[28:31], v135, s[72:75], s26 offen
    s_cmp_eq_u32 s3, 0
    s_cselect_b32 s25, 0, 0x7ffffff0
    buffer_load_dword v134, v132, s[64:67], s25 offen sc1
    buffer_store_dwordx2 v[132:133], v137, s[8:11], s23 offen sc1
    s_barrier
    buffer_load_dwordx4 v[40:43], v138, s[76:79], s22 offen offset:0
    buffer_load_dwordx4 v[44:47], v138, s[76:79], s22 offen offset:64
    s_mov_b32 s29, s19
    s_waitcnt vmcnt(8)
    v_lshlrev_b32 v56, 16, v32
    v_and_b32 v57, 0xffff0000, v32
    v_lshlrev_b32 v58, 16, v33
    v_and_b32 v59, 0xffff0000, v33
    v_lshlrev_b32 v60, 16, v34
    v_and_b32 v61, 0xffff0000, v34
    v_lshlrev_b32 v62, 16, v35
    v_and_b32 v63, 0xffff0000, v35
    s_waitcnt vmcnt(7)
    v_lshlrev_b32 v64, 16, v36
    v_and_b32 v65, 0xffff0000, v36
    v_lshlrev_b32 v66, 16, v37
    v_and_b32 v67, 0xffff0000, v37
    v_lshlrev_b32 v68, 16, v38
    v_and_b32 v69, 0xffff0000, v38
    v_lshlrev_b32 v70, 16, v39
    v_and_b32 v71, 0xffff0000, v39
    v_add_f32 v20, v56, v57
    v_add_f32 v21, v58, v59
    v_add_f32 v20, v20, v60
    v_add_f32 v21, v21, v61
    v_add_f32 v20, v20, v62
    v_add_f32 v21, v21, v63
    v_add_f32 v20, v20, v64
    v_add_f32 v21, v21, v65
    v_add_f32 v20, v20, v66
    v_add_f32 v21, v21, v67
    v_add_f32 v20, v20, v68
    v_add_f32 v21, v21, v69
    v_add_f32 v20, v20, v70
    v_add_f32 v21, v21, v71
    v_add_f32 v128, v20, v21
    s_nop 1
    v_add_f32_dpp v128, v128, v128 row_ror:1 row_mask:0xf bank_mask:0xf
    s_nop 1
    v_add_f32_dpp v128, v128, v128 row_ror:2 row_mask:0xf bank_mask:0xf
    s_nop 1
    v_add_f32_dpp v128, v128, v128 row_ror:4 row_mask:0xf bank_mask:0xf
    s_nop 1
    v_add_f32_dpp v128, v128, v128 row_ror:8 row_mask:0xf bank_mask:0xf
    v_mov_b32 v20, v128
    s_nop 1
    v_permlane16_swap_b32 v128, v20
    v_add_f32 v128, v128, v20
    v_mov_b32 v20, v128
    s_nop 1
    v_permlane32_swap_b32 v128, v20
    v_add_f32 v128, v128, v20
    v_mul_f32 v128, 0x3a800000, v128
    v_sub_f32 v18, v56, v128
    v_mul_f32 v20, v18, v18
    v_sub_f32 v19, v57, v128
    v_mul_f32 v21, v19, v19
    v_sub_f32 v18, v58, v128
    v_sub_f32 v19, v59, v128
    v_fmac_f32 v20, v18, v18
    v_fmac_f32 v21, v19, v19
    v_sub_f32 v18, v60, v128
    v_sub_f32 v19, v61, v128
    v_fmac_f32 v20, v18, v18
    v_fmac_f32 v21, v19, v19
    v_sub_f32 v18, v62, v128
    v_sub_f32 v19, v63, v128
    v_fmac_f32 v20, v18, v18
    v_fmac_f32 v21, v19, v19
    v_sub_f32 v18, v64, v128
    v_sub_f32 v19, v65, v128
    v_fmac_f32 v20, v18, v18
    v_fmac_f32 v21, v19, v19
    v_sub_f32 v18, v66, v128
    v_sub_f32 v19, v67, v128
    v_fmac_f32 v20, v18, v18
    v_fmac_f32 v21, v19, v19
    v_sub_f32 v18, v68, v128
    v_sub_f32 v19, v69, v128
    v_fmac_f32 v20, v18, v18
    v_fmac_f32 v21, v19, v19
    v_sub_f32 v18, v70, v128
    v_sub_f32 v19, v71, v128
    v_fmac_f32 v20, v18, v18
    v_fmac_f32 v21, v19, v19
    v_add_f32 v17, v20, v21
    s_nop 1
    v_add_f32_dpp v17, v17, v17 row_ror:1 row_mask:0xf bank_mask:0xf
    s_nop 1
    v_add_f32_dpp v17, v17, v17 row_ror:2 row_mask:0xf bank_mask:0xf
    s_nop 1
    v_add_f32_dpp v17, v17, v17 row_ror:4 row_mask:0xf bank_mask:0xf
    s_nop 1
    v_add_f32_dpp v17, v17, v17 row_ror:8 row_mask:0xf bank_mask:0xf
    v_mov_b32 v20, v17
    s_nop 1
    v_permlane16_swap_b32 v17, v20
    v_add_f32 v17, v17, v20
    v_mov_b32 v20, v17
    s_nop 1
    v_permlane32_swap_b32 v17, v20
    v_add_f32 v17, v17, v20
    v_mul_f32 v17, 0x3a800000, v17
    v_cvt_pk_bf16_f32 v128, v128, v128
    v_lshlrev_b32 v128, 16, v128
    v_cvt_pk_bf16_f32 v17, v17, v17
    v_lshlrev_b32 v17, 16, v17
    v_add_f32 v17, 0x3727c5ac, v17
    v_cvt_pk_bf16_f32 v17, v17, v17
    v_lshlrev_b32 v17, 16, v17
    v_sqrt_f32 v129, v17
    s_nop 0
    v_cvt_pk_bf16_f32 v129, v129, v129
    v_lshlrev_b32 v129, 16, v129
    v_rcp_f32 v130, v129
    s_lshl_b32 s16, s3, 4
    s_add_u32 s16, s16, 149520
    v_mov_b32 v19, s16
    ds_write_b128 v19, v[128:131]
    s_waitcnt vmcnt(6)
    v_and_b32 v73, 0xffff0000, v72
    v_lshlrev_b32 v72, 16, v72
    v_mul_f32 v16, 0xbfb8aa3b, v72
    v_exp_f32 v16, v16
    s_nop 0
    v_add_f32 v16, 1.0, v16
    v_rcp_f32 v16, v16
    s_nop 0
    v_mul_f32 v72, v72, v16
    v_mul_f32 v17, 0xbfb8aa3b, v73
    v_exp_f32 v17, v17
    s_nop 0
    v_add_f32 v17, 1.0, v17
    v_rcp_f32 v17, v17
    s_nop 0
    v_mul_f32 v73, v73, v17
    v_cvt_pk_bf16_f32 v16, v72, v73
    v_lshlrev_b32 v72, 16, v16
    v_and_b32 v73, 0xffff0000, v16
    s_lshl_b32 s16, s2, 8
    s_add_u32 s16, s16, 0x550000
    s_mov_b32 exec_lo, 0x01010101
    s_mov_b32 exec_hi, 0x01010101
    buffer_store_dword v16, v136, s[8:11], s16 offen sc1
    s_mov_b64 exec, -1
    v_lshrrev_b32 v74, 16, v72
    v_lshrrev_b32 v75, 16, v73
    s_waitcnt vmcnt(6)
    v_dot2_f32_bf16 v49, v24, v72, 0
    v_dot2_f32_bf16 v48, v24, v74, 0
    v_dot2_f32_bf16 v51, v25, v72, 0
    v_dot2_f32_bf16 v50, v25, v74, 0
    v_dot2_f32_bf16 v53, v26, v72, 0
    v_dot2_f32_bf16 v52, v26, v74, 0
    v_dot2_f32_bf16 v55, v27, v72, 0
    v_dot2_f32_bf16 v54, v27, v74, 0
    s_waitcnt vmcnt(5)
    v_dot2c_f32_bf16 v49, v28, v73
    v_dot2c_f32_bf16 v48, v28, v75
    v_dot2c_f32_bf16 v51, v29, v73
    v_dot2c_f32_bf16 v50, v29, v75
    v_dot2c_f32_bf16 v53, v30, v73
    v_dot2c_f32_bf16 v52, v30, v75
    v_dot2c_f32_bf16 v55, v31, v73
    v_dot2c_f32_bf16 v54, v31, v75
    s_nop 0
    v_permlane32_swap_b32 v48, v52
    v_permlane32_swap_b32 v49, v53
    v_permlane32_swap_b32 v50, v54
    v_permlane32_swap_b32 v51, v55
    v_add_f32 v48, v48, v52
    v_add_f32 v49, v49, v53
    v_add_f32 v50, v50, v54
    v_add_f32 v51, v51, v55
    s_nop 0
    v_permlane16_swap_b32 v48, v50
    v_permlane16_swap_b32 v49, v51
    v_add_f32 v48, v48, v50
    v_add_f32 v49, v49, v51
    s_nop 0
    v_add_f32_dpp v48, v48, v48 row_ror:8 row_mask:0xf bank_mask:0xf
    v_add_f32_dpp v49, v49, v49 row_ror:8 row_mask:0xf bank_mask:0xf
    v_and_b32 v16, 7, v1
    v_lshlrev_b32 v16, 5, v16
    v_lshrrev_b32 v17, 4, v1
    v_lshl_add_u32 v16, v17, 3, v16
    s_lshl_b32 s16, s3, 8
    s_add_u32 s16, s16, 147456
    v_add_u32 v16, s16, v16
    ds_write_b64 v16, v[48:49]
    s_waitcnt vmcnt(4)
    v_cmp_eq_u32 vcc, 0, v134
    s_cmp_eq_u32 s3, 0
    s_cselect_b64 s[62:63], -1, 0
    s_and_b64 vcc, vcc, s[62:63]
    s_cbranch_vccnz adaLN_cond__sliding_block_cached__moe_arch_mod__prompt_kernel_n1r
adaLN_cond__sliding_block_cached__moe_arch_mod__prompt_kernel_n1b:
    v_mov_b32 v19, 149504
    s_cmp_eq_u32 s3, 0
    s_cselect_b64 exec, 1, 0
    ds_write_b32 v19, v134
    s_mov_b64 exec, -1
    v_mov_b32 v19, 149504
    v_and_b32 v17, 31, v1
    v_lshlrev_b32 v18, 3, v17
    v_add_u32 v18, 147456, v18
    v_lshlrev_b32 v17, 4, v17
    s_waitcnt lgkmcnt(0)
    s_barrier
    ds_read_b32 v134, v19
    ds_read_b64 v[96:97], v18 offset:0
    ds_read_b64 v[100:101], v18 offset:256
    ds_read_b64 v[104:105], v18 offset:512
    ds_read_b64 v[108:109], v18 offset:768
    ds_read_b64 v[112:113], v18 offset:1024
    ds_read_b64 v[116:117], v18 offset:1280
    ds_read_b64 v[120:121], v18 offset:1536
    ds_read_b64 v[124:125], v18 offset:1792
    s_waitcnt lgkmcnt(8)
    v_readfirstlane_b32 s28, v134
    v_and_b32 v20, 7, v1
    v_lshlrev_b32 v20, 4, v20
    v_add_u32 v21, 149520, v20
    ds_read_b128 v[128:131], v21
    s_waitcnt lgkmcnt(0)
    v_mov_b32 v131, s28
    s_lshl_b32 s16, s2, 7
    s_add_u32 s16, s16, 0x520000
    s_cmp_eq_u32 s3, 0
    s_cselect_b32 s16, s16, 0x7ffffff0
    s_mov_b64 exec, 0xff
    buffer_store_dwordx4 v[128:131], v20, s[8:11], s16 offen sc1
    s_mov_b64 exec, -1
    v_pk_add_f32 v[96:97], v[96:97], v[112:113]
    v_pk_add_f32 v[100:101], v[100:101], v[116:117]
    v_pk_add_f32 v[104:105], v[104:105], v[120:121]
    v_pk_add_f32 v[108:109], v[108:109], v[124:125]
    v_pk_add_f32 v[96:97], v[96:97], v[104:105]
    v_pk_add_f32 v[100:101], v[100:101], v[108:109]
    v_pk_add_f32 v[96:97], v[96:97], v[100:101]
    v_mov_b32 v98, s28
    v_mov_b32 v99, s28
    s_lshl_b32 s16, s14, 3
    s_add_u32 s16, s16, s15
    s_lshl_b32 s16, s16, 9
    s_add_u32 s16, s16, 0x500000
    s_cmp_eq_u32 s3, 0
    s_cselect_b32 s16, s16, 0x7ffffff0
    s_mov_b64 exec, 0xffffffff
    buffer_store_dwordx4 v[96:99], v17, s[8:11], s16 offen sc1
    s_mov_b64 exec, -1
    s_lshr_b32 s16, s3, 2
    s_lshl_b32 s16, s16, 4
    s_add_u32 s16, s16, s31
    s_lshl_b32 s16, s16, 12
    s_and_b32 s17, s3, 3
    s_lshl_b32 s17, s17, 7
    s_add_u32 s16, s16, s17
    s_add_u32 s16, s16, 0x500000
    v_lshrrev_b32 v139, 3, v1
    v_lshlrev_b32 v139, 9, v139
    v_and_b32 v16, 7, v1
    v_lshl_add_u32 v139, v16, 4, v139
    v_and_b32 v140, 15, v1
    v_lshlrev_b32 v140, 4, v140
    s_lshl_b32 s17, s29, 8
    s_add_u32 s17, s17, 0x520000
    s_waitcnt vmcnt(4)
    v_lshlrev_b32 v56, 16, v40
    v_and_b32 v57, 0xffff0000, v40
    v_lshlrev_b32 v58, 16, v41
    v_and_b32 v59, 0xffff0000, v41
    v_lshlrev_b32 v60, 16, v42
    v_and_b32 v61, 0xffff0000, v42
    v_lshlrev_b32 v62, 16, v43
    v_and_b32 v63, 0xffff0000, v43
    s_waitcnt vmcnt(3)
    v_lshlrev_b32 v64, 16, v44
    v_and_b32 v65, 0xffff0000, v44
    v_lshlrev_b32 v66, 16, v45
    v_and_b32 v67, 0xffff0000, v45
    v_lshlrev_b32 v68, 16, v46
    v_and_b32 v69, 0xffff0000, v46
    v_lshlrev_b32 v70, 16, v47
    v_and_b32 v71, 0xffff0000, v47
    s_mov_b32 s27, 0
adaLN_cond__sliding_block_cached__moe_arch_mod__prompt_kernel_g2p:
    buffer_load_dwordx4 v[76:79], v139, s[8:11], s16 offen sc1
    buffer_load_dwordx4 v[80:83], v140, s[8:11], s17 offen sc1
    s_waitcnt vmcnt(1)
    v_cmp_ne_u32 vcc, s28, v78
    v_cmp_ne_u32 s[62:63], s28, v79
    s_or_b64 vcc, vcc, s[62:63]
    s_waitcnt vmcnt(0)
    v_cmp_ne_u32 s[62:63], s28, v83
    s_or_b64 vcc, vcc, s[62:63]
    s_add_u32 s27, s27, 1
    s_cmp_ge_u32 s27, 65536
    s_cbranch_scc1 adaLN_cond__sliding_block_cached__moe_arch_mod__prompt_kernel_g2g
    s_cbranch_vccnz adaLN_cond__sliding_block_cached__moe_arch_mod__prompt_kernel_g2p
adaLN_cond__sliding_block_cached__moe_arch_mod__prompt_kernel_g2g:
    v_add_f32_dpp v76, v76, v76 row_ror:8 row_mask:0xf bank_mask:0xf
    v_add_f32_dpp v77, v77, v77 row_ror:8 row_mask:0xf bank_mask:0xf
    v_mov_b32 v17, v76
    s_nop 1
    v_permlane16_swap_b32 v76, v17
    v_add_f32 v76, v76, v17
    v_mov_b32 v18, v77
    s_nop 1
    v_permlane16_swap_b32 v77, v18
    v_add_f32 v77, v77, v18
    v_mov_b32 v17, v76
    s_nop 1
    v_permlane32_swap_b32 v76, v17
    v_add_f32 v76, v76, v17
    v_mov_b32 v18, v77
    s_nop 1
    v_permlane32_swap_b32 v77, v18
    v_add_f32 v77, v77, v18
    v_cvt_pk_bf16_f32 v17, v76, v77
    v_lshlrev_b32 v76, 16, v17
    v_and_b32 v77, 0xffff0000, v17
    v_add_f32 v76, 0, v76
    v_add_f32 v77, 0, v77
    s_lshl_b32 s16, s3, 6
    s_add_u32 s16, s16, 151552
    v_lshl_add_u32 v16, v16, 3, s16
    ds_write_b64 v16, v[76:77]
    v_lshrrev_b32 v17, 4, v1
    v_lshlrev_b32 v17, 5, v17
    v_add_u32 v17, 151552, v17
    v_sub_f32 v56, v56, v80
    v_sub_f32 v57, v57, v80
    v_sub_f32 v58, v58, v80
    v_sub_f32 v59, v59, v80
    v_sub_f32 v60, v60, v80
    v_sub_f32 v61, v61, v80
    v_sub_f32 v62, v62, v80
    v_sub_f32 v63, v63, v80
    v_sub_f32 v64, v64, v80
    v_sub_f32 v65, v65, v80
    v_sub_f32 v66, v66, v80
    v_sub_f32 v67, v67, v80
    v_sub_f32 v68, v68, v80
    v_sub_f32 v69, v69, v80
    v_sub_f32 v70, v70, v80
    v_sub_f32 v71, v71, v80
    v_cvt_pk_bf16_f32 v18, v56, v57
    v_lshlrev_b32 v56, 16, v18
    v_and_b32 v57, 0xffff0000, v18
    v_cvt_pk_bf16_f32 v19, v58, v59
    v_lshlrev_b32 v58, 16, v19
    v_and_b32 v59, 0xffff0000, v19
    v_cvt_pk_bf16_f32 v18, v60, v61
    v_lshlrev_b32 v60, 16, v18
    v_and_b32 v61, 0xffff0000, v18
    v_cvt_pk_bf16_f32 v19, v62, v63
    v_lshlrev_b32 v62, 16, v19
    v_and_b32 v63, 0xffff0000, v19
    v_cvt_pk_bf16_f32 v18, v64, v65
    v_lshlrev_b32 v64, 16, v18
    v_and_b32 v65, 0xffff0000, v18
    v_cvt_pk_bf16_f32 v19, v66, v67
    v_lshlrev_b32 v66, 16, v19
    v_and_b32 v67, 0xffff0000, v19
    v_cvt_pk_bf16_f32 v18, v68, v69
    v_lshlrev_b32 v68, 16, v18
    v_and_b32 v69, 0xffff0000, v18
    v_cvt_pk_bf16_f32 v19, v70, v71
    v_lshlrev_b32 v70, 16, v19
    v_and_b32 v71, 0xffff0000, v19
    v_mul_f32 v56, v56, v82
    v_mul_f32 v57, v57, v82
    v_mul_f32 v58, v58, v82
    v_mul_f32 v59, v59, v82
    v_mul_f32 v60, v60, v82
    v_mul_f32 v61, v61, v82
    v_mul_f32 v62, v62, v82
    v_mul_f32 v63, v63, v82
    v_mul_f32 v64, v64, v82
    v_mul_f32 v65, v65, v82
    v_mul_f32 v66, v66, v82
    v_mul_f32 v67, v67, v82
    v_mul_f32 v68, v68, v82
    v_mul_f32 v69, v69, v82
    v_mul_f32 v70, v70, v82
    v_mul_f32 v71, v71, v82
    v_cvt_pk_bf16_f32 v18, v56, v57
    v_lshlrev_b32 v56, 16, v18
    v_and_b32 v57, 0xffff0000, v18
    v_cvt_pk_bf16_f32 v19, v58, v59
    v_lshlrev_b32 v58, 16, v19
    v_and_b32 v59, 0xffff0000, v19
    v_cvt_pk_bf16_f32 v18, v60, v61
    v_lshlrev_b32 v60, 16, v18
    v_and_b32 v61, 0xffff0000, v18
    v_cvt_pk_bf16_f32 v19, v62, v63
    v_lshlrev_b32 v62, 16, v19
    v_and_b32 v63, 0xffff0000, v19
    v_cvt_pk_bf16_f32 v18, v64, v65
    v_lshlrev_b32 v64, 16, v18
    v_and_b32 v65, 0xffff0000, v18
    v_cvt_pk_bf16_f32 v19, v66, v67
    v_lshlrev_b32 v66, 16, v19
    v_and_b32 v67, 0xffff0000, v19
    v_cvt_pk_bf16_f32 v18, v68, v69
    v_lshlrev_b32 v68, 16, v18
    v_and_b32 v69, 0xffff0000, v18
    v_cvt_pk_bf16_f32 v19, v70, v71
    v_lshlrev_b32 v70, 16, v19
    v_and_b32 v71, 0xffff0000, v19
    s_lshl_b32 s16, s29, 15
    s_lshl_b32 s17, s31, 11
    s_add_u32 s16, s16, s17
    s_waitcnt lgkmcnt(0)
    s_barrier
    ds_read_b128 v[96:99], v17 offset:256
    ds_read_b128 v[104:107], v17 offset:0
    ds_read_b128 v[100:103], v17 offset:272
    ds_read_b128 v[108:111], v17 offset:16
    ds_read_b128 v[112:115], v17 offset:384
    ds_read_b128 v[120:123], v17 offset:128
    ds_read_b128 v[116:119], v17 offset:400
    ds_read_b128 v[124:127], v17 offset:144
    s_waitcnt lgkmcnt(7)
    v_pk_mul_f32 v[56:57], v[56:57], v[96:97]
    v_pk_mul_f32 v[58:59], v[58:59], v[98:99]
    s_waitcnt lgkmcnt(5)
    v_pk_mul_f32 v[60:61], v[60:61], v[100:101]
    v_pk_mul_f32 v[62:63], v[62:63], v[102:103]
    v_cvt_pk_bf16_f32 v18, v56, v57
    v_lshlrev_b32 v56, 16, v18
    v_and_b32 v57, 0xffff0000, v18
    v_cvt_pk_bf16_f32 v19, v58, v59
    v_lshlrev_b32 v58, 16, v19
    v_and_b32 v59, 0xffff0000, v19
    v_cvt_pk_bf16_f32 v18, v60, v61
    v_lshlrev_b32 v60, 16, v18
    v_and_b32 v61, 0xffff0000, v18
    v_cvt_pk_bf16_f32 v19, v62, v63
    v_lshlrev_b32 v62, 16, v19
    v_and_b32 v63, 0xffff0000, v19
    v_pk_add_f32 v[56:57], v[56:57], v[104:105]
    v_pk_add_f32 v[58:59], v[58:59], v[106:107]
    s_waitcnt lgkmcnt(4)
    v_pk_add_f32 v[60:61], v[60:61], v[108:109]
    v_pk_add_f32 v[62:63], v[62:63], v[110:111]
    v_cvt_pk_bf16_f32 v32, v56, v57
    v_cvt_pk_bf16_f32 v33, v58, v59
    v_cvt_pk_bf16_f32 v34, v60, v61
    v_cvt_pk_bf16_f32 v35, v62, v63
    buffer_store_dwordx4 v[32:35], v2, s[8:11], s16 offen offset:0 sc1
    s_waitcnt lgkmcnt(3)
    v_pk_mul_f32 v[64:65], v[64:65], v[112:113]
    v_pk_mul_f32 v[66:67], v[66:67], v[114:115]
    s_waitcnt lgkmcnt(1)
    v_pk_mul_f32 v[68:69], v[68:69], v[116:117]
    v_pk_mul_f32 v[70:71], v[70:71], v[118:119]
    v_cvt_pk_bf16_f32 v18, v64, v65
    v_lshlrev_b32 v64, 16, v18
    v_and_b32 v65, 0xffff0000, v18
    v_cvt_pk_bf16_f32 v19, v66, v67
    v_lshlrev_b32 v66, 16, v19
    v_and_b32 v67, 0xffff0000, v19
    v_cvt_pk_bf16_f32 v18, v68, v69
    v_lshlrev_b32 v68, 16, v18
    v_and_b32 v69, 0xffff0000, v18
    v_cvt_pk_bf16_f32 v19, v70, v71
    v_lshlrev_b32 v70, 16, v19
    v_and_b32 v71, 0xffff0000, v19
    v_pk_add_f32 v[64:65], v[64:65], v[120:121]
    v_pk_add_f32 v[66:67], v[66:67], v[122:123]
    s_waitcnt lgkmcnt(0)
    v_pk_add_f32 v[68:69], v[68:69], v[124:125]
    v_pk_add_f32 v[70:71], v[70:71], v[126:127]
    v_cvt_pk_bf16_f32 v36, v64, v65
    v_cvt_pk_bf16_f32 v37, v66, v67
    v_cvt_pk_bf16_f32 v38, v68, v69
    v_cvt_pk_bf16_f32 v39, v70, v71
    buffer_store_dwordx4 v[36:39], v2, s[8:11], s16 offen offset:1024 sc1
    s_lshl_b32 s19, s3, 16
    s_lshl_b32 s20, s3, 11
    s_lshl_b32 s16, s12, 8
    s_add_u32 s4, s38, s16
    s_addc_u32 s5, s39, 0
    s_sub_u32 s6, 0x800000, s16
    s_mov_b32 s7, 0x20000
    s_barrier
    s_add_u32 s22, s19, 0x0
    s_add_u32 m0, s20, 0x0
    s_nop 0
    buffer_load_dwordx4 v3, s[4:7], s22 offen lds
    s_add_u32 s22, s19, 0x8000
    s_add_u32 m0, s20, 0x400
    s_nop 0
    buffer_load_dwordx4 v3, s[4:7], s22 offen lds
    s_add_u32 s22, s19, 0x80000
    s_add_u32 m0, s20, 0x4000
    s_nop 0
    buffer_load_dwordx4 v3, s[4:7], s22 offen lds
    s_add_u32 s22, s19, 0x88000
    s_add_u32 m0, s20, 0x4400
    s_nop 0
    buffer_load_dwordx4 v3, s[4:7], s22 offen lds
    s_add_u32 s22, s19, 0x100000
    s_add_u32 m0, s20, 0x8000
    s_nop 0
    buffer_load_dwordx4 v3, s[4:7], s22 offen lds
    s_add_u32 s22, s19, 0x108000
    s_add_u32 m0, s20, 0x8400
    s_nop 0
    buffer_load_dwordx4 v3, s[4:7], s22 offen lds
    v_mov_b32 v134, s28
    s_lshl_b32 s16, s29, 4
    s_add_u32 s16, s16, s31
    s_lshl_b32 s16, s16, 2
    s_add_u32 s16, s16, 0x528000
    v_and_b32 v16, 31, v1
    v_lshlrev_b32 v16, 2, v16
    s_lshl_b32 s17, s13, 3
    s_add_u32 s17, s17, s3
    s_lshl_b32 s17, s17, 7
    s_add_u32 s17, s17, 0x528000
    s_waitcnt vmcnt(6)
    s_mov_b64 exec, 1
    buffer_store_dword v134, v132, s[8:11], s16 offen sc1
    s_mov_b64 exec, -1
    s_waitcnt vmcnt(0)
    s_mov_b32 s27, 0
adaLN_cond__sliding_block_cached__moe_arch_mod__prompt_kernel_h3p:
    buffer_load_dword v17, v16, s[8:11], s17 offen sc1
    s_waitcnt vmcnt(0)
    v_cmp_ne_u32 vcc, s28, v17
    s_add_u32 s27, s27, 1
    s_cmp_ge_u32 s27, 65536
    s_cbranch_scc1 adaLN_cond__sliding_block_cached__moe_arch_mod__prompt_kernel_h3g
    s_cbranch_vccnz adaLN_cond__sliding_block_cached__moe_arch_mod__prompt_kernel_h3p
adaLN_cond__sliding_block_cached__moe_arch_mod__prompt_kernel_h3g:
    s_mov_b32 s23, 0x0
    buffer_load_dwordx4 v[88:91], v7, s[8:11], s23 offen offset:0 sc1
    s_mov_b32 s23, 0x8000
    buffer_load_dwordx4 v[92:95], v7, s[8:11], s23 offen offset:0 sc1
    s_mov_b32 s23, 0x0
    buffer_load_dwordx4 v[96:99], v7, s[8:11], s23 offen offset:1024 sc1
    s_mov_b32 s23, 0x8000
    buffer_load_dwordx4 v[100:103], v7, s[8:11], s23 offen offset:1024 sc1
    s_mov_b32 s23, 0x800
    buffer_load_dwordx4 v[104:107], v7, s[8:11], s23 offen offset:0 sc1
    s_mov_b32 s23, 0x8800
    buffer_load_dwordx4 v[108:111], v7, s[8:11], s23 offen offset:0 sc1
    s_mov_b32 s23, 0x800
    buffer_load_dwordx4 v[112:115], v7, s[8:11], s23 offen offset:1024 sc1
    s_mov_b32 s23, 0x8800
    buffer_load_dwordx4 v[116:119], v7, s[8:11], s23 offen offset:1024 sc1
    s_mov_b32 s23, 0x1000
    buffer_load_dwordx4 v[120:123], v7, s[8:11], s23 offen offset:0 sc1
    s_mov_b32 s23, 0x9000
    buffer_load_dwordx4 v[124:127], v7, s[8:11], s23 offen offset:0 sc1
    s_mov_b32 s23, 0x1000
    buffer_load_dwordx4 v[128:131], v7, s[8:11], s23 offen offset:1024 sc1
    s_mov_b32 s23, 0x9000
    buffer_load_dwordx4 v[132:135], v7, s[8:11], s23 offen offset:1024 sc1
    s_lshr_b32 s21, s12, 3
    s_lshl_b32 s21, s21, 17
    s_add_u32 s21, s21, s20
    s_add_u32 s21, s21, 0x400000
    s_barrier
    ds_read_b64_tr_b16 v[224:225], v4 offset:0
    ds_read_b64_tr_b16 v[226:227], v4 offset:1024
    ds_read_b64_tr_b16 v[228:229], v5 offset:32
    ds_read_b64_tr_b16 v[230:231], v5 offset:1056
    ds_read_b64_tr_b16 v[232:233], v4 offset:256
    ds_read_b64_tr_b16 v[234:235], v4 offset:1280
    s_waitcnt vmcnt(11) lgkmcnt(4)
    v_mfma_f32_16x16x32_bf16 v[24:27], v[224:227], v[88:91], 0
    ds_read_b64_tr_b16 v[236:237], v5 offset:288
    s_waitcnt vmcnt(10)
    v_mfma_f32_16x16x32_bf16 v[28:31], v[224:227], v[92:95], 0
    ds_read_b64_tr_b16 v[238:239], v5 offset:1312
    s_waitcnt lgkmcnt(4)
    v_mfma_f32_16x16x32_bf16 v[32:35], v[228:231], v[88:91], 0
    ds_read_b64_tr_b16 v[240:241], v4 offset:512
    v_mfma_f32_16x16x32_bf16 v[36:39], v[228:231], v[92:95], 0
    ds_read_b64_tr_b16 v[242:243], v4 offset:1536
    s_mov_b32 s23, 0x1800
    buffer_load_dwordx4 v[136:139], v7, s[8:11], s23 offen offset:0 sc1
    s_waitcnt lgkmcnt(4)
    v_mfma_f32_16x16x32_bf16 v[40:43], v[232:235], v[88:91], 0
    ds_read_b64_tr_b16 v[244:245], v5 offset:544
    v_mfma_f32_16x16x32_bf16 v[44:47], v[232:235], v[92:95], 0
    ds_read_b64_tr_b16 v[246:247], v5 offset:1568
    s_waitcnt lgkmcnt(4)
    v_mfma_f32_16x16x32_bf16 v[48:51], v[236:239], v[88:91], 0
    ds_read_b64_tr_b16 v[224:225], v4 offset:768
    v_mfma_f32_16x16x32_bf16 v[52:55], v[236:239], v[92:95], 0
    ds_read_b64_tr_b16 v[226:227], v4 offset:1792
    s_waitcnt lgkmcnt(4)
    v_mfma_f32_16x16x32_bf16 v[56:59], v[240:243], v[88:91], 0
    ds_read_b64_tr_b16 v[228:229], v5 offset:800
    v_mfma_f32_16x16x32_bf16 v[60:63], v[240:243], v[92:95], 0
    ds_read_b64_tr_b16 v[230:231], v5 offset:1824
    s_waitcnt lgkmcnt(4)
    v_mfma_f32_16x16x32_bf16 v[64:67], v[244:247], v[88:91], 0
    ds_read_b64_tr_b16 v[232:233], v4 offset:8192
    v_mfma_f32_16x16x32_bf16 v[68:71], v[244:247], v[92:95], 0
    ds_read_b64_tr_b16 v[234:235], v4 offset:9216
    s_mov_b32 s23, 0x9800
    buffer_load_dwordx4 v[140:143], v7, s[8:11], s23 offen offset:0 sc1
    s_waitcnt lgkmcnt(4)
    v_mfma_f32_16x16x32_bf16 v[72:75], v[224:227], v[88:91], 0
    ds_read_b64_tr_b16 v[236:237], v5 offset:8224
    v_mfma_f32_16x16x32_bf16 v[76:79], v[224:227], v[92:95], 0
    ds_read_b64_tr_b16 v[238:239], v5 offset:9248
    s_waitcnt lgkmcnt(4)
    v_mfma_f32_16x16x32_bf16 v[80:83], v[228:231], v[88:91], 0
    ds_read_b64_tr_b16 v[240:241], v4 offset:8448
    v_mfma_f32_16x16x32_bf16 v[84:87], v[228:231], v[92:95], 0
    ds_read_b64_tr_b16 v[242:243], v4 offset:9472
    s_waitcnt vmcnt(11) lgkmcnt(4)
    v_mfma_f32_16x16x32_bf16 v[24:27], v[232:235], v[96:99], v[24:27]
    ds_read_b64_tr_b16 v[244:245], v5 offset:8480
    s_waitcnt vmcnt(10)
    v_mfma_f32_16x16x32_bf16 v[28:31], v[232:235], v[100:103], v[28:31]
    ds_read_b64_tr_b16 v[246:247], v5 offset:9504
    s_waitcnt lgkmcnt(4)
    v_mfma_f32_16x16x32_bf16 v[32:35], v[236:239], v[96:99], v[32:35]
    ds_read_b64_tr_b16 v[224:225], v4 offset:8704
    v_mfma_f32_16x16x32_bf16 v[36:39], v[236:239], v[100:103], v[36:39]
    ds_read_b64_tr_b16 v[226:227], v4 offset:9728
    s_mov_b32 s23, 0x1800
    buffer_load_dwordx4 v[144:147], v7, s[8:11], s23 offen offset:1024 sc1
    s_waitcnt lgkmcnt(4)
    v_mfma_f32_16x16x32_bf16 v[40:43], v[240:243], v[96:99], v[40:43]
    ds_read_b64_tr_b16 v[228:229], v5 offset:8736
    v_mfma_f32_16x16x32_bf16 v[44:47], v[240:243], v[100:103], v[44:47]
    ds_read_b64_tr_b16 v[230:231], v5 offset:9760
    s_waitcnt lgkmcnt(4)
    v_mfma_f32_16x16x32_bf16 v[48:51], v[244:247], v[96:99], v[48:51]
    ds_read_b64_tr_b16 v[232:233], v4 offset:8960
    v_mfma_f32_16x16x32_bf16 v[52:55], v[244:247], v[100:103], v[52:55]
    ds_read_b64_tr_b16 v[234:235], v4 offset:9984
    s_waitcnt lgkmcnt(4)
    v_mfma_f32_16x16x32_bf16 v[56:59], v[224:227], v[96:99], v[56:59]
    ds_read_b64_tr_b16 v[236:237], v5 offset:8992
    v_mfma_f32_16x16x32_bf16 v[60:63], v[224:227], v[100:103], v[60:63]
    ds_read_b64_tr_b16 v[238:239], v5 offset:10016
    s_waitcnt lgkmcnt(4)
    v_mfma_f32_16x16x32_bf16 v[64:67], v[228:231], v[96:99], v[64:67]
    v_mfma_f32_16x16x32_bf16 v[68:71], v[228:231], v[100:103], v[68:71]
    s_barrier
    ds_read_b64_tr_b16 v[240:241], v4 offset:16384
    ds_read_b64_tr_b16 v[242:243], v4 offset:17408
    s_mov_b32 s23, 0x9800
    buffer_load_dwordx4 v[148:151], v7, s[8:11], s23 offen offset:1024 sc1
    s_waitcnt lgkmcnt(4)
    v_mfma_f32_16x16x32_bf16 v[72:75], v[232:235], v[96:99], v[72:75]
    ds_read_b64_tr_b16 v[244:245], v5 offset:16416
    v_mfma_f32_16x16x32_bf16 v[76:79], v[232:235], v[100:103], v[76:79]
    s_add_u32 s22, s19, 0x180000
    s_add_u32 m0, s20, 0xc000
    s_nop 0
    buffer_load_dwordx4 v3, s[4:7], s22 offen lds
    ds_read_b64_tr_b16 v[246:247], v5 offset:17440
    s_waitcnt lgkmcnt(4)
    v_mfma_f32_16x16x32_bf16 v[80:83], v[236:239], v[96:99], v[80:83]
    ds_read_b64_tr_b16 v[224:225], v4 offset:16640
    v_mfma_f32_16x16x32_bf16 v[84:87], v[236:239], v[100:103], v[84:87]
    ds_read_b64_tr_b16 v[226:227], v4 offset:17664
    s_waitcnt vmcnt(12) lgkmcnt(4)
    v_mfma_f32_16x16x32_bf16 v[24:27], v[240:243], v[104:107], v[24:27]
    ds_read_b64_tr_b16 v[228:229], v5 offset:16672
    s_waitcnt vmcnt(11)
    v_mfma_f32_16x16x32_bf16 v[28:31], v[240:243], v[108:111], v[28:31]
    ds_read_b64_tr_b16 v[230:231], v5 offset:17696
    s_waitcnt lgkmcnt(4)
    v_mfma_f32_16x16x32_bf16 v[32:35], v[244:247], v[104:107], v[32:35]
    ds_read_b64_tr_b16 v[232:233], v4 offset:16896
    v_mfma_f32_16x16x32_bf16 v[36:39], v[244:247], v[108:111], v[36:39]
    ds_read_b64_tr_b16 v[234:235], v4 offset:17920
    s_mov_b32 s23, 0x2000
    buffer_load_dwordx4 v[88:91], v7, s[8:11], s23 offen offset:0 sc1
    s_waitcnt lgkmcnt(4)
    v_mfma_f32_16x16x32_bf16 v[40:43], v[224:227], v[104:107], v[40:43]
    ds_read_b64_tr_b16 v[236:237], v5 offset:16928
    v_mfma_f32_16x16x32_bf16 v[44:47], v[224:227], v[108:111], v[44:47]
    s_add_u32 s22, s19, 0x188000
    s_add_u32 m0, s20, 0xc400
    s_nop 0
    buffer_load_dwordx4 v3, s[4:7], s22 offen lds
    ds_read_b64_tr_b16 v[238:239], v5 offset:17952
    s_waitcnt lgkmcnt(4)
    v_mfma_f32_16x16x32_bf16 v[48:51], v[228:231], v[104:107], v[48:51]
    ds_read_b64_tr_b16 v[240:241], v4 offset:17152
    v_mfma_f32_16x16x32_bf16 v[52:55], v[228:231], v[108:111], v[52:55]
    ds_read_b64_tr_b16 v[242:243], v4 offset:18176
    s_waitcnt lgkmcnt(4)
    v_mfma_f32_16x16x32_bf16 v[56:59], v[232:235], v[104:107], v[56:59]
    ds_read_b64_tr_b16 v[244:245], v5 offset:17184
    v_mfma_f32_16x16x32_bf16 v[60:63], v[232:235], v[108:111], v[60:63]
    ds_read_b64_tr_b16 v[246:247], v5 offset:18208
    s_waitcnt lgkmcnt(4)
    v_mfma_f32_16x16x32_bf16 v[64:67], v[236:239], v[104:107], v[64:67]
    ds_read_b64_tr_b16 v[224:225], v4 offset:24576
    v_mfma_f32_16x16x32_bf16 v[68:71], v[236:239], v[108:111], v[68:71]
    ds_read_b64_tr_b16 v[226:227], v4 offset:25600
    s_mov_b32 s23, 0xa000
    buffer_load_dwordx4 v[92:95], v7, s[8:11], s23 offen offset:0 sc1
    s_waitcnt lgkmcnt(4)
    v_mfma_f32_16x16x32_bf16 v[72:75], v[240:243], v[104:107], v[72:75]
    ds_read_b64_tr_b16 v[228:229], v5 offset:24608
    v_mfma_f32_16x16x32_bf16 v[76:79], v[240:243], v[108:111], v[76:79]
    ds_read_b64_tr_b16 v[230:231], v5 offset:25632
    s_waitcnt lgkmcnt(4)
    v_mfma_f32_16x16x32_bf16 v[80:83], v[244:247], v[104:107], v[80:83]
    ds_read_b64_tr_b16 v[232:233], v4 offset:24832
    v_mfma_f32_16x16x32_bf16 v[84:87], v[244:247], v[108:111], v[84:87]
    ds_read_b64_tr_b16 v[234:235], v4 offset:25856
    s_waitcnt vmcnt(13) lgkmcnt(4)
    v_mfma_f32_16x16x32_bf16 v[24:27], v[224:227], v[112:115], v[24:27]
    ds_read_b64_tr_b16 v[236:237], v5 offset:24864
    s_waitcnt vmcnt(12)
    v_mfma_f32_16x16x32_bf16 v[28:31], v[224:227], v[116:119], v[28:31]
    ds_read_b64_tr_b16 v[238:239], v5 offset:25888
    s_waitcnt lgkmcnt(4)
    v_mfma_f32_16x16x32_bf16 v[32:35], v[228:231], v[112:115], v[32:35]
    ds_read_b64_tr_b16 v[240:241], v4 offset:25088
    v_mfma_f32_16x16x32_bf16 v[36:39], v[228:231], v[116:119], v[36:39]
    ds_read_b64_tr_b16 v[242:243], v4 offset:26112
    s_mov_b32 s23, 0x2000
    buffer_load_dwordx4 v[96:99], v7, s[8:11], s23 offen offset:1024 sc1
    s_waitcnt lgkmcnt(4)
    v_mfma_f32_16x16x32_bf16 v[40:43], v[232:235], v[112:115], v[40:43]
    ds_read_b64_tr_b16 v[244:245], v5 offset:25120
    v_mfma_f32_16x16x32_bf16 v[44:47], v[232:235], v[116:119], v[44:47]
    ds_read_b64_tr_b16 v[246:247], v5 offset:26144
    s_waitcnt lgkmcnt(4)
    v_mfma_f32_16x16x32_bf16 v[48:51], v[236:239], v[112:115], v[48:51]
    ds_read_b64_tr_b16 v[224:225], v4 offset:25344
    v_mfma_f32_16x16x32_bf16 v[52:55], v[236:239], v[116:119], v[52:55]
    ds_read_b64_tr_b16 v[226:227], v4 offset:26368
    s_waitcnt lgkmcnt(4)
    v_mfma_f32_16x16x32_bf16 v[56:59], v[240:243], v[112:115], v[56:59]
    ds_read_b64_tr_b16 v[228:229], v5 offset:25376
    v_mfma_f32_16x16x32_bf16 v[60:63], v[240:243], v[116:119], v[60:63]
    ds_read_b64_tr_b16 v[230:231], v5 offset:26400
    s_waitcnt lgkmcnt(4)
    v_mfma_f32_16x16x32_bf16 v[64:67], v[244:247], v[112:115], v[64:67]
    v_mfma_f32_16x16x32_bf16 v[68:71], v[244:247], v[116:119], v[68:71]
    s_barrier
    ds_read_b64_tr_b16 v[232:233], v4 offset:32768
    ds_read_b64_tr_b16 v[234:235], v4 offset:33792
    s_mov_b32 s23, 0xa000
    buffer_load_dwordx4 v[100:103], v7, s[8:11], s23 offen offset:1024 sc1
    s_waitcnt lgkmcnt(4)
    v_mfma_f32_16x16x32_bf16 v[72:75], v[224:227], v[112:115], v[72:75]
    ds_read_b64_tr_b16 v[236:237], v5 offset:32800
    v_mfma_f32_16x16x32_bf16 v[76:79], v[224:227], v[116:119], v[76:79]
    s_add_u32 s22, s19, 0x200000
    s_add_u32 m0, s20, 0x0
    s_nop 0
    buffer_load_dwordx4 v3, s[4:7], s22 offen lds
    ds_read_b64_tr_b16 v[238:239], v5 offset:33824
    s_waitcnt lgkmcnt(4)
    v_mfma_f32_16x16x32_bf16 v[80:83], v[228:231], v[112:115], v[80:83]
    ds_read_b64_tr_b16 v[240:241], v4 offset:33024
    v_mfma_f32_16x16x32_bf16 v[84:87], v[228:231], v[116:119], v[84:87]
    ds_read_b64_tr_b16 v[242:243], v4 offset:34048
    s_waitcnt vmcnt(14) lgkmcnt(4)
    v_mfma_f32_16x16x32_bf16 v[24:27], v[232:235], v[120:123], v[24:27]
    ds_read_b64_tr_b16 v[244:245], v5 offset:33056
    s_waitcnt vmcnt(13)
    v_mfma_f32_16x16x32_bf16 v[28:31], v[232:235], v[124:127], v[28:31]
    ds_read_b64_tr_b16 v[246:247], v5 offset:34080
    s_waitcnt lgkmcnt(4)
    v_mfma_f32_16x16x32_bf16 v[32:35], v[236:239], v[120:123], v[32:35]
    ds_read_b64_tr_b16 v[224:225], v4 offset:33280
    v_mfma_f32_16x16x32_bf16 v[36:39], v[236:239], v[124:127], v[36:39]
    ds_read_b64_tr_b16 v[226:227], v4 offset:34304
    s_mov_b32 s23, 0x2800
    buffer_load_dwordx4 v[104:107], v7, s[8:11], s23 offen offset:0 sc1
    s_waitcnt lgkmcnt(4)
    v_mfma_f32_16x16x32_bf16 v[40:43], v[240:243], v[120:123], v[40:43]
    ds_read_b64_tr_b16 v[228:229], v5 offset:33312
    v_mfma_f32_16x16x32_bf16 v[44:47], v[240:243], v[124:127], v[44:47]
    s_add_u32 s22, s19, 0x208000
    s_add_u32 m0, s20, 0x400
    s_nop 0
    buffer_load_dwordx4 v3, s[4:7], s22 offen lds
    ds_read_b64_tr_b16 v[230:231], v5 offset:34336
    s_waitcnt lgkmcnt(4)
    v_mfma_f32_16x16x32_bf16 v[48:51], v[244:247], v[120:123], v[48:51]
    ds_read_b64_tr_b16 v[232:233], v4 offset:33536
    v_mfma_f32_16x16x32_bf16 v[52:55], v[244:247], v[124:127], v[52:55]
    ds_read_b64_tr_b16 v[234:235], v4 offset:34560
    s_waitcnt lgkmcnt(4)
    v_mfma_f32_16x16x32_bf16 v[56:59], v[224:227], v[120:123], v[56:59]
    ds_read_b64_tr_b16 v[236:237], v5 offset:33568
    v_mfma_f32_16x16x32_bf16 v[60:63], v[224:227], v[124:127], v[60:63]
    ds_read_b64_tr_b16 v[238:239], v5 offset:34592
    s_waitcnt lgkmcnt(4)
    v_mfma_f32_16x16x32_bf16 v[64:67], v[228:231], v[120:123], v[64:67]
    ds_read_b64_tr_b16 v[240:241], v4 offset:40960
    v_mfma_f32_16x16x32_bf16 v[68:71], v[228:231], v[124:127], v[68:71]
    ds_read_b64_tr_b16 v[242:243], v4 offset:41984
    s_mov_b32 s23, 0xa800
    buffer_load_dwordx4 v[108:111], v7, s[8:11], s23 offen offset:0 sc1
    s_waitcnt lgkmcnt(4)
    v_mfma_f32_16x16x32_bf16 v[72:75], v[232:235], v[120:123], v[72:75]
    ds_read_b64_tr_b16 v[244:245], v5 offset:40992
    v_mfma_f32_16x16x32_bf16 v[76:79], v[232:235], v[124:127], v[76:79]
    ds_read_b64_tr_b16 v[246:247], v5 offset:42016
    s_waitcnt lgkmcnt(4)
    v_mfma_f32_16x16x32_bf16 v[80:83], v[236:239], v[120:123], v[80:83]
    ds_read_b64_tr_b16 v[224:225], v4 offset:41216
    v_mfma_f32_16x16x32_bf16 v[84:87], v[236:239], v[124:127], v[84:87]
    ds_read_b64_tr_b16 v[226:227], v4 offset:42240
    s_waitcnt vmcnt(15) lgkmcnt(4)
    v_mfma_f32_16x16x32_bf16 v[24:27], v[240:243], v[128:131], v[24:27]
    ds_read_b64_tr_b16 v[228:229], v5 offset:41248
    s_waitcnt vmcnt(14)
    v_mfma_f32_16x16x32_bf16 v[28:31], v[240:243], v[132:135], v[28:31]
    ds_read_b64_tr_b16 v[230:231], v5 offset:42272
    s_waitcnt lgkmcnt(4)
    v_mfma_f32_16x16x32_bf16 v[32:35], v[244:247], v[128:131], v[32:35]
    ds_read_b64_tr_b16 v[232:233], v4 offset:41472
    v_mfma_f32_16x16x32_bf16 v[36:39], v[244:247], v[132:135], v[36:39]
    ds_read_b64_tr_b16 v[234:235], v4 offset:42496
    s_mov_b32 s23, 0x2800
    buffer_load_dwordx4 v[112:115], v7, s[8:11], s23 offen offset:1024 sc1
    s_waitcnt lgkmcnt(4)
    v_mfma_f32_16x16x32_bf16 v[40:43], v[224:227], v[128:131], v[40:43]
    ds_read_b64_tr_b16 v[236:237], v5 offset:41504
    v_mfma_f32_16x16x32_bf16 v[44:47], v[224:227], v[132:135], v[44:47]
    ds_read_b64_tr_b16 v[238:239], v5 offset:42528
    s_waitcnt lgkmcnt(4)
    v_mfma_f32_16x16x32_bf16 v[48:51], v[228:231], v[128:131], v[48:51]
    ds_read_b64_tr_b16 v[240:241], v4 offset:41728
    v_mfma_f32_16x16x32_bf16 v[52:55], v[228:231], v[132:135], v[52:55]
    ds_read_b64_tr_b16 v[242:243], v4 offset:42752
    s_waitcnt lgkmcnt(4)
    v_mfma_f32_16x16x32_bf16 v[56:59], v[232:235], v[128:131], v[56:59]
    ds_read_b64_tr_b16 v[244:245], v5 offset:41760
    v_mfma_f32_16x16x32_bf16 v[60:63], v[232:235], v[132:135], v[60:63]
    ds_read_b64_tr_b16 v[246:247], v5 offset:42784
    s_waitcnt lgkmcnt(4)
    v_mfma_f32_16x16x32_bf16 v[64:67], v[236:239], v[128:131], v[64:67]
    v_mfma_f32_16x16x32_bf16 v[68:71], v[236:239], v[132:135], v[68:71]
    s_waitcnt vmcnt(8)
    s_barrier
    ds_read_b64_tr_b16 v[224:225], v4 offset:49152
    ds_read_b64_tr_b16 v[226:227], v4 offset:50176
    s_mov_b32 s23, 0xa800
    buffer_load_dwordx4 v[116:119], v7, s[8:11], s23 offen offset:1024 sc1
    s_waitcnt lgkmcnt(4)
    v_mfma_f32_16x16x32_bf16 v[72:75], v[240:243], v[128:131], v[72:75]
    ds_read_b64_tr_b16 v[228:229], v5 offset:49184
    v_mfma_f32_16x16x32_bf16 v[76:79], v[240:243], v[132:135], v[76:79]
    s_add_u32 s22, s19, 0x280000
    s_add_u32 m0, s20, 0x4000
    s_nop 0
    buffer_load_dwordx4 v3, s[4:7], s22 offen lds
    ds_read_b64_tr_b16 v[230:231], v5 offset:50208
    s_waitcnt lgkmcnt(4)
    v_mfma_f32_16x16x32_bf16 v[80:83], v[244:247], v[128:131], v[80:83]
    ds_read_b64_tr_b16 v[232:233], v4 offset:49408
    v_mfma_f32_16x16x32_bf16 v[84:87], v[244:247], v[132:135], v[84:87]
    ds_read_b64_tr_b16 v[234:235], v4 offset:50432
    s_waitcnt lgkmcnt(4)
    v_mfma_f32_16x16x32_bf16 v[24:27], v[224:227], v[136:139], v[24:27]
    ds_read_b64_tr_b16 v[236:237], v5 offset:49440
    v_mfma_f32_16x16x32_bf16 v[28:31], v[224:227], v[140:143], v[28:31]
    ds_read_b64_tr_b16 v[238:239], v5 offset:50464
    s_waitcnt lgkmcnt(4)
    v_mfma_f32_16x16x32_bf16 v[32:35], v[228:231], v[136:139], v[32:35]
    ds_read_b64_tr_b16 v[240:241], v4 offset:49664
    v_mfma_f32_16x16x32_bf16 v[36:39], v[228:231], v[140:143], v[36:39]
    ds_read_b64_tr_b16 v[242:243], v4 offset:50688
    s_mov_b32 s23, 0x3000
    buffer_load_dwordx4 v[120:123], v7, s[8:11], s23 offen offset:0 sc1
    s_waitcnt lgkmcnt(4)
    v_mfma_f32_16x16x32_bf16 v[40:43], v[232:235], v[136:139], v[40:43]
    ds_read_b64_tr_b16 v[244:245], v5 offset:49696
    v_mfma_f32_16x16x32_bf16 v[44:47], v[232:235], v[140:143], v[44:47]
    s_add_u32 s22, s19, 0x288000
    s_add_u32 m0, s20, 0x4400
    s_nop 0
    buffer_load_dwordx4 v3, s[4:7], s22 offen lds
    ds_read_b64_tr_b16 v[246:247], v5 offset:50720
    s_waitcnt lgkmcnt(4)
    v_mfma_f32_16x16x32_bf16 v[48:51], v[236:239], v[136:139], v[48:51]
    ds_read_b64_tr_b16 v[224:225], v4 offset:49920
    v_mfma_f32_16x16x32_bf16 v[52:55], v[236:239], v[140:143], v[52:55]
    ds_read_b64_tr_b16 v[226:227], v4 offset:50944
    s_waitcnt lgkmcnt(4)
    v_mfma_f32_16x16x32_bf16 v[56:59], v[240:243], v[136:139], v[56:59]
    ds_read_b64_tr_b16 v[228:229], v5 offset:49952
    v_mfma_f32_16x16x32_bf16 v[60:63], v[240:243], v[140:143], v[60:63]
    ds_read_b64_tr_b16 v[230:231], v5 offset:50976
    s_waitcnt lgkmcnt(4)
    v_mfma_f32_16x16x32_bf16 v[64:67], v[244:247], v[136:139], v[64:67]
    ds_read_b64_tr_b16 v[232:233], v4 offset:57344
    v_mfma_f32_16x16x32_bf16 v[68:71], v[244:247], v[140:143], v[68:71]
    ds_read_b64_tr_b16 v[234:235], v4 offset:58368
    s_mov_b32 s23, 0xb000
    buffer_load_dwordx4 v[124:127], v7, s[8:11], s23 offen offset:0 sc1
    s_waitcnt lgkmcnt(4)
    v_mfma_f32_16x16x32_bf16 v[72:75], v[224:227], v[136:139], v[72:75]
    ds_read_b64_tr_b16 v[236:237], v5 offset:57376
    v_mfma_f32_16x16x32_bf16 v[76:79], v[224:227], v[140:143], v[76:79]
    ds_read_b64_tr_b16 v[238:239], v5 offset:58400
    s_waitcnt lgkmcnt(4)
    v_mfma_f32_16x16x32_bf16 v[80:83], v[228:231], v[136:139], v[80:83]
    ds_read_b64_tr_b16 v[240:241], v4 offset:57600
    v_mfma_f32_16x16x32_bf16 v[84:87], v[228:231], v[140:143], v[84:87]
    ds_read_b64_tr_b16 v[242:243], v4 offset:58624
    s_waitcnt lgkmcnt(4)
    v_mfma_f32_16x16x32_bf16 v[24:27], v[232:235], v[144:147], v[24:27]
    ds_read_b64_tr_b16 v[244:245], v5 offset:57632
    v_mfma_f32_16x16x32_bf16 v[28:31], v[232:235], v[148:151], v[28:31]
    ds_read_b64_tr_b16 v[246:247], v5 offset:58656
    s_waitcnt lgkmcnt(4)
    v_mfma_f32_16x16x32_bf16 v[32:35], v[236:239], v[144:147], v[32:35]
    ds_read_b64_tr_b16 v[224:225], v4 offset:57856
    v_mfma_f32_16x16x32_bf16 v[36:39], v[236:239], v[148:151], v[36:39]
    ds_read_b64_tr_b16 v[226:227], v4 offset:58880
    s_mov_b32 s23, 0x3000
    buffer_load_dwordx4 v[128:131], v7, s[8:11], s23 offen offset:1024 sc1
    s_waitcnt lgkmcnt(4)
    v_mfma_f32_16x16x32_bf16 v[40:43], v[240:243], v[144:147], v[40:43]
    ds_read_b64_tr_b16 v[228:229], v5 offset:57888
    v_mfma_f32_16x16x32_bf16 v[44:47], v[240:243], v[148:151], v[44:47]
    ds_read_b64_tr_b16 v[230:231], v5 offset:58912
    s_waitcnt lgkmcnt(4)
    v_mfma_f32_16x16x32_bf16 v[48:51], v[244:247], v[144:147], v[48:51]
    ds_read_b64_tr_b16 v[232:233], v4 offset:58112
    v_mfma_f32_16x16x32_bf16 v[52:55], v[244:247], v[148:151], v[52:55]
    ds_read_b64_tr_b16 v[234:235], v4 offset:59136
    s_waitcnt lgkmcnt(4)
    v_mfma_f32_16x16x32_bf16 v[56:59], v[224:227], v[144:147], v[56:59]
    ds_read_b64_tr_b16 v[236:237], v5 offset:58144
    v_mfma_f32_16x16x32_bf16 v[60:63], v[224:227], v[148:151], v[60:63]
    ds_read_b64_tr_b16 v[238:239], v5 offset:59168
    s_waitcnt lgkmcnt(4)
    v_mfma_f32_16x16x32_bf16 v[64:67], v[228:231], v[144:147], v[64:67]
    v_mfma_f32_16x16x32_bf16 v[68:71], v[228:231], v[148:151], v[68:71]
    s_waitcnt vmcnt(8)
    s_barrier
    ds_read_b64_tr_b16 v[240:241], v4 offset:0
    ds_read_b64_tr_b16 v[242:243], v4 offset:1024
    s_mov_b32 s23, 0xb000
    buffer_load_dwordx4 v[132:135], v7, s[8:11], s23 offen offset:1024 sc1
    s_waitcnt lgkmcnt(4)
    v_mfma_f32_16x16x32_bf16 v[72:75], v[232:235], v[144:147], v[72:75]
    ds_read_b64_tr_b16 v[244:245], v5 offset:32
    v_mfma_f32_16x16x32_bf16 v[76:79], v[232:235], v[148:151], v[76:79]
    s_add_u32 s22, s19, 0x300000
    s_add_u32 m0, s20, 0x8000
    s_nop 0
    buffer_load_dwordx4 v3, s[4:7], s22 offen lds
    ds_read_b64_tr_b16 v[246:247], v5 offset:1056
    s_waitcnt lgkmcnt(4)
    v_mfma_f32_16x16x32_bf16 v[80:83], v[236:239], v[144:147], v[80:83]
    ds_read_b64_tr_b16 v[224:225], v4 offset:256
    v_mfma_f32_16x16x32_bf16 v[84:87], v[236:239], v[148:151], v[84:87]
    ds_read_b64_tr_b16 v[226:227], v4 offset:1280
    s_waitcnt lgkmcnt(4)
    v_mfma_f32_16x16x32_bf16 v[24:27], v[240:243], v[88:91], v[24:27]
    ds_read_b64_tr_b16 v[228:229], v5 offset:288
    v_mfma_f32_16x16x32_bf16 v[28:31], v[240:243], v[92:95], v[28:31]
    ds_read_b64_tr_b16 v[230:231], v5 offset:1312
    s_waitcnt lgkmcnt(4)
    v_mfma_f32_16x16x32_bf16 v[32:35], v[244:247], v[88:91], v[32:35]
    ds_read_b64_tr_b16 v[232:233], v4 offset:512
    v_mfma_f32_16x16x32_bf16 v[36:39], v[244:247], v[92:95], v[36:39]
    ds_read_b64_tr_b16 v[234:235], v4 offset:1536
    s_mov_b32 s23, 0x3800
    buffer_load_dwordx4 v[136:139], v7, s[8:11], s23 offen offset:0 sc1
    s_waitcnt lgkmcnt(4)
    v_mfma_f32_16x16x32_bf16 v[40:43], v[224:227], v[88:91], v[40:43]
    ds_read_b64_tr_b16 v[236:237], v5 offset:544
    v_mfma_f32_16x16x32_bf16 v[44:47], v[224:227], v[92:95], v[44:47]
    s_add_u32 s22, s19, 0x308000
    s_add_u32 m0, s20, 0x8400
    s_nop 0
    buffer_load_dwordx4 v3, s[4:7], s22 offen lds
    ds_read_b64_tr_b16 v[238:239], v5 offset:1568
    s_waitcnt lgkmcnt(4)
    v_mfma_f32_16x16x32_bf16 v[48:51], v[228:231], v[88:91], v[48:51]
    ds_read_b64_tr_b16 v[240:241], v4 offset:768
    v_mfma_f32_16x16x32_bf16 v[52:55], v[228:231], v[92:95], v[52:55]
    ds_read_b64_tr_b16 v[242:243], v4 offset:1792
    s_waitcnt lgkmcnt(4)
    v_mfma_f32_16x16x32_bf16 v[56:59], v[232:235], v[88:91], v[56:59]
    ds_read_b64_tr_b16 v[244:245], v5 offset:800
    v_mfma_f32_16x16x32_bf16 v[60:63], v[232:235], v[92:95], v[60:63]
    ds_read_b64_tr_b16 v[246:247], v5 offset:1824
    s_waitcnt lgkmcnt(4)
    v_mfma_f32_16x16x32_bf16 v[64:67], v[236:239], v[88:91], v[64:67]
    ds_read_b64_tr_b16 v[224:225], v4 offset:8192
    v_mfma_f32_16x16x32_bf16 v[68:71], v[236:239], v[92:95], v[68:71]
    ds_read_b64_tr_b16 v[226:227], v4 offset:9216
    s_mov_b32 s23, 0xb800
    buffer_load_dwordx4 v[140:143], v7, s[8:11], s23 offen offset:0 sc1
    s_waitcnt lgkmcnt(4)
    v_mfma_f32_16x16x32_bf16 v[72:75], v[240:243], v[88:91], v[72:75]
    ds_read_b64_tr_b16 v[228:229], v5 offset:8224
    v_mfma_f32_16x16x32_bf16 v[76:79], v[240:243], v[92:95], v[76:79]
    ds_read_b64_tr_b16 v[230:231], v5 offset:9248
    s_waitcnt lgkmcnt(4)
    v_mfma_f32_16x16x32_bf16 v[80:83], v[244:247], v[88:91], v[80:83]
    ds_read_b64_tr_b16 v[232:233], v4 offset:8448
    v_mfma_f32_16x16x32_bf16 v[84:87], v[244:247], v[92:95], v[84:87]
    ds_read_b64_tr_b16 v[234:235], v4 offset:9472
    s_waitcnt lgkmcnt(4)
    v_mfma_f32_16x16x32_bf16 v[24:27], v[224:227], v[96:99], v[24:27]
    ds_read_b64_tr_b16 v[236:237], v5 offset:8480
    v_mfma_f32_16x16x32_bf16 v[28:31], v[224:227], v[100:103], v[28:31]
    ds_read_b64_tr_b16 v[238:239], v5 offset:9504
    s_waitcnt lgkmcnt(4)
    v_mfma_f32_16x16x32_bf16 v[32:35], v[228:231], v[96:99], v[32:35]
    ds_read_b64_tr_b16 v[240:241], v4 offset:8704
    v_mfma_f32_16x16x32_bf16 v[36:39], v[228:231], v[100:103], v[36:39]
    ds_read_b64_tr_b16 v[242:243], v4 offset:9728
    s_mov_b32 s23, 0x3800
    buffer_load_dwordx4 v[144:147], v7, s[8:11], s23 offen offset:1024 sc1
    s_waitcnt lgkmcnt(4)
    v_mfma_f32_16x16x32_bf16 v[40:43], v[232:235], v[96:99], v[40:43]
    ds_read_b64_tr_b16 v[244:245], v5 offset:8736
    v_mfma_f32_16x16x32_bf16 v[44:47], v[232:235], v[100:103], v[44:47]
    ds_read_b64_tr_b16 v[246:247], v5 offset:9760
    s_waitcnt lgkmcnt(4)
    v_mfma_f32_16x16x32_bf16 v[48:51], v[236:239], v[96:99], v[48:51]
    ds_read_b64_tr_b16 v[224:225], v4 offset:8960
    v_mfma_f32_16x16x32_bf16 v[52:55], v[236:239], v[100:103], v[52:55]
    ds_read_b64_tr_b16 v[226:227], v4 offset:9984
    s_waitcnt lgkmcnt(4)
    v_mfma_f32_16x16x32_bf16 v[56:59], v[240:243], v[96:99], v[56:59]
    ds_read_b64_tr_b16 v[228:229], v5 offset:8992
    v_mfma_f32_16x16x32_bf16 v[60:63], v[240:243], v[100:103], v[60:63]
    ds_read_b64_tr_b16 v[230:231], v5 offset:10016
    s_waitcnt lgkmcnt(4)
    v_mfma_f32_16x16x32_bf16 v[64:67], v[244:247], v[96:99], v[64:67]
    v_mfma_f32_16x16x32_bf16 v[68:71], v[244:247], v[100:103], v[68:71]
    s_waitcnt vmcnt(8)
    s_barrier
    ds_read_b64_tr_b16 v[232:233], v4 offset:16384
    ds_read_b64_tr_b16 v[234:235], v4 offset:17408
    s_mov_b32 s23, 0xb800
    buffer_load_dwordx4 v[148:151], v7, s[8:11], s23 offen offset:1024 sc1
    s_waitcnt lgkmcnt(4)
    v_mfma_f32_16x16x32_bf16 v[72:75], v[224:227], v[96:99], v[72:75]
    ds_read_b64_tr_b16 v[236:237], v5 offset:16416
    v_mfma_f32_16x16x32_bf16 v[76:79], v[224:227], v[100:103], v[76:79]
    s_add_u32 s22, s19, 0x380000
    s_add_u32 m0, s20, 0xc000
    s_nop 0
    buffer_load_dwordx4 v3, s[4:7], s22 offen lds
    ds_read_b64_tr_b16 v[238:239], v5 offset:17440
    s_waitcnt lgkmcnt(4)
    v_mfma_f32_16x16x32_bf16 v[80:83], v[228:231], v[96:99], v[80:83]
    ds_read_b64_tr_b16 v[240:241], v4 offset:16640
    v_mfma_f32_16x16x32_bf16 v[84:87], v[228:231], v[100:103], v[84:87]
    ds_read_b64_tr_b16 v[242:243], v4 offset:17664
    s_waitcnt lgkmcnt(4)
    v_mfma_f32_16x16x32_bf16 v[24:27], v[232:235], v[104:107], v[24:27]
    ds_read_b64_tr_b16 v[244:245], v5 offset:16672
    v_mfma_f32_16x16x32_bf16 v[28:31], v[232:235], v[108:111], v[28:31]
    ds_read_b64_tr_b16 v[246:247], v5 offset:17696
    s_waitcnt lgkmcnt(4)
    v_mfma_f32_16x16x32_bf16 v[32:35], v[236:239], v[104:107], v[32:35]
    ds_read_b64_tr_b16 v[224:225], v4 offset:16896
    v_mfma_f32_16x16x32_bf16 v[36:39], v[236:239], v[108:111], v[36:39]
    ds_read_b64_tr_b16 v[226:227], v4 offset:17920
    s_mov_b32 s23, 0x4000
    buffer_load_dwordx4 v[88:91], v7, s[8:11], s23 offen offset:0 sc1
    s_waitcnt lgkmcnt(4)
    v_mfma_f32_16x16x32_bf16 v[40:43], v[240:243], v[104:107], v[40:43]
    ds_read_b64_tr_b16 v[228:229], v5 offset:16928
    v_mfma_f32_16x16x32_bf16 v[44:47], v[240:243], v[108:111], v[44:47]
    s_add_u32 s22, s19, 0x388000
    s_add_u32 m0, s20, 0xc400
    s_nop 0
    buffer_load_dwordx4 v3, s[4:7], s22 offen lds
    ds_read_b64_tr_b16 v[230:231], v5 offset:17952
    s_waitcnt lgkmcnt(4)
    v_mfma_f32_16x16x32_bf16 v[48:51], v[244:247], v[104:107], v[48:51]
    ds_read_b64_tr_b16 v[232:233], v4 offset:17152
    v_mfma_f32_16x16x32_bf16 v[52:55], v[244:247], v[108:111], v[52:55]
    ds_read_b64_tr_b16 v[234:235], v4 offset:18176
    s_waitcnt lgkmcnt(4)
    v_mfma_f32_16x16x32_bf16 v[56:59], v[224:227], v[104:107], v[56:59]
    ds_read_b64_tr_b16 v[236:237], v5 offset:17184
    v_mfma_f32_16x16x32_bf16 v[60:63], v[224:227], v[108:111], v[60:63]
    ds_read_b64_tr_b16 v[238:239], v5 offset:18208
    s_waitcnt lgkmcnt(4)
    v_mfma_f32_16x16x32_bf16 v[64:67], v[228:231], v[104:107], v[64:67]
    ds_read_b64_tr_b16 v[240:241], v4 offset:24576
    v_mfma_f32_16x16x32_bf16 v[68:71], v[228:231], v[108:111], v[68:71]
    ds_read_b64_tr_b16 v[242:243], v4 offset:25600
    s_mov_b32 s23, 0xc000
    buffer_load_dwordx4 v[92:95], v7, s[8:11], s23 offen offset:0 sc1
    s_waitcnt lgkmcnt(4)
    v_mfma_f32_16x16x32_bf16 v[72:75], v[232:235], v[104:107], v[72:75]
    ds_read_b64_tr_b16 v[244:245], v5 offset:24608
    v_mfma_f32_16x16x32_bf16 v[76:79], v[232:235], v[108:111], v[76:79]
    ds_read_b64_tr_b16 v[246:247], v5 offset:25632
    s_waitcnt lgkmcnt(4)
    v_mfma_f32_16x16x32_bf16 v[80:83], v[236:239], v[104:107], v[80:83]
    ds_read_b64_tr_b16 v[224:225], v4 offset:24832
    v_mfma_f32_16x16x32_bf16 v[84:87], v[236:239], v[108:111], v[84:87]
    ds_read_b64_tr_b16 v[226:227], v4 offset:25856
    s_waitcnt lgkmcnt(4)
    v_mfma_f32_16x16x32_bf16 v[24:27], v[240:243], v[112:115], v[24:27]
    ds_read_b64_tr_b16 v[228:229], v5 offset:24864
    v_mfma_f32_16x16x32_bf16 v[28:31], v[240:243], v[116:119], v[28:31]
    ds_read_b64_tr_b16 v[230:231], v5 offset:25888
    s_waitcnt lgkmcnt(4)
    v_mfma_f32_16x16x32_bf16 v[32:35], v[244:247], v[112:115], v[32:35]
    ds_read_b64_tr_b16 v[232:233], v4 offset:25088
    v_mfma_f32_16x16x32_bf16 v[36:39], v[244:247], v[116:119], v[36:39]
    ds_read_b64_tr_b16 v[234:235], v4 offset:26112
    s_mov_b32 s23, 0x4000
    buffer_load_dwordx4 v[96:99], v7, s[8:11], s23 offen offset:1024 sc1
    s_waitcnt lgkmcnt(4)
    v_mfma_f32_16x16x32_bf16 v[40:43], v[224:227], v[112:115], v[40:43]
    ds_read_b64_tr_b16 v[236:237], v5 offset:25120
    v_mfma_f32_16x16x32_bf16 v[44:47], v[224:227], v[116:119], v[44:47]
    ds_read_b64_tr_b16 v[238:239], v5 offset:26144
    s_waitcnt lgkmcnt(4)
    v_mfma_f32_16x16x32_bf16 v[48:51], v[228:231], v[112:115], v[48:51]
    ds_read_b64_tr_b16 v[240:241], v4 offset:25344
    v_mfma_f32_16x16x32_bf16 v[52:55], v[228:231], v[116:119], v[52:55]
    ds_read_b64_tr_b16 v[242:243], v4 offset:26368
    s_waitcnt lgkmcnt(4)
    v_mfma_f32_16x16x32_bf16 v[56:59], v[232:235], v[112:115], v[56:59]
    ds_read_b64_tr_b16 v[244:245], v5 offset:25376
    v_mfma_f32_16x16x32_bf16 v[60:63], v[232:235], v[116:119], v[60:63]
    ds_read_b64_tr_b16 v[246:247], v5 offset:26400
    s_waitcnt lgkmcnt(4)
    v_mfma_f32_16x16x32_bf16 v[64:67], v[236:239], v[112:115], v[64:67]
    v_mfma_f32_16x16x32_bf16 v[68:71], v[236:239], v[116:119], v[68:71]
    s_waitcnt vmcnt(8)
    s_barrier
    ds_read_b64_tr_b16 v[224:225], v4 offset:32768
    ds_read_b64_tr_b16 v[226:227], v4 offset:33792
    s_mov_b32 s23, 0xc000
    buffer_load_dwordx4 v[100:103], v7, s[8:11], s23 offen offset:1024 sc1
    s_waitcnt lgkmcnt(4)
    v_mfma_f32_16x16x32_bf16 v[72:75], v[240:243], v[112:115], v[72:75]
    ds_read_b64_tr_b16 v[228:229], v5 offset:32800
    v_mfma_f32_16x16x32_bf16 v[76:79], v[240:243], v[116:119], v[76:79]
    s_add_u32 s22, s19, 0x400000
    s_add_u32 m0, s20, 0x0
    s_nop 0
    buffer_load_dwordx4 v3, s[4:7], s22 offen lds
    ds_read_b64_tr_b16 v[230:231], v5 offset:33824
    s_waitcnt lgkmcnt(4)
    v_mfma_f32_16x16x32_bf16 v[80:83], v[244:247], v[112:115], v[80:83]
    ds_read_b64_tr_b16 v[232:233], v4 offset:33024
    v_mfma_f32_16x16x32_bf16 v[84:87], v[244:247], v[116:119], v[84:87]
    ds_read_b64_tr_b16 v[234:235], v4 offset:34048
    s_waitcnt lgkmcnt(4)
    v_mfma_f32_16x16x32_bf16 v[24:27], v[224:227], v[120:123], v[24:27]
    ds_read_b64_tr_b16 v[236:237], v5 offset:33056
    v_mfma_f32_16x16x32_bf16 v[28:31], v[224:227], v[124:127], v[28:31]
    ds_read_b64_tr_b16 v[238:239], v5 offset:34080
    s_waitcnt lgkmcnt(4)
    v_mfma_f32_16x16x32_bf16 v[32:35], v[228:231], v[120:123], v[32:35]
    ds_read_b64_tr_b16 v[240:241], v4 offset:33280
    v_mfma_f32_16x16x32_bf16 v[36:39], v[228:231], v[124:127], v[36:39]
    ds_read_b64_tr_b16 v[242:243], v4 offset:34304
    s_mov_b32 s23, 0x4800
    buffer_load_dwordx4 v[104:107], v7, s[8:11], s23 offen offset:0 sc1
    s_waitcnt lgkmcnt(4)
    v_mfma_f32_16x16x32_bf16 v[40:43], v[232:235], v[120:123], v[40:43]
    ds_read_b64_tr_b16 v[244:245], v5 offset:33312
    v_mfma_f32_16x16x32_bf16 v[44:47], v[232:235], v[124:127], v[44:47]
    s_add_u32 s22, s19, 0x408000
    s_add_u32 m0, s20, 0x400
    s_nop 0
    buffer_load_dwordx4 v3, s[4:7], s22 offen lds
    ds_read_b64_tr_b16 v[246:247], v5 offset:34336
    s_waitcnt lgkmcnt(4)
    v_mfma_f32_16x16x32_bf16 v[48:51], v[236:239], v[120:123], v[48:51]
    ds_read_b64_tr_b16 v[224:225], v4 offset:33536
    v_mfma_f32_16x16x32_bf16 v[52:55], v[236:239], v[124:127], v[52:55]
    ds_read_b64_tr_b16 v[226:227], v4 offset:34560
    s_waitcnt lgkmcnt(4)
    v_mfma_f32_16x16x32_bf16 v[56:59], v[240:243], v[120:123], v[56:59]
    ds_read_b64_tr_b16 v[228:229], v5 offset:33568
    v_mfma_f32_16x16x32_bf16 v[60:63], v[240:243], v[124:127], v[60:63]
    ds_read_b64_tr_b16 v[230:231], v5 offset:34592
    s_waitcnt lgkmcnt(4)
    v_mfma_f32_16x16x32_bf16 v[64:67], v[244:247], v[120:123], v[64:67]
    ds_read_b64_tr_b16 v[232:233], v4 offset:40960
    v_mfma_f32_16x16x32_bf16 v[68:71], v[244:247], v[124:127], v[68:71]
    ds_read_b64_tr_b16 v[234:235], v4 offset:41984
    s_mov_b32 s23, 0xc800
    buffer_load_dwordx4 v[108:111], v7, s[8:11], s23 offen offset:0 sc1
    s_waitcnt lgkmcnt(4)
    v_mfma_f32_16x16x32_bf16 v[72:75], v[224:227], v[120:123], v[72:75]
    ds_read_b64_tr_b16 v[236:237], v5 offset:40992
    v_lshrrev_b32 v21, 4, v1
    v_lshlrev_b32 v21, 9, v21
    v_and_b32 v20, 15, v1
    v_lshl_add_u32 v21, v20, 4, v21
    s_lshr_b32 s18, s12, 3
    s_lshl_b32 s18, s18, 11
    s_add_u32 s18, s18, 0x528100
    buffer_load_dwordx4 v[12:15], v21, s[8:11], s18 offen sc1
    v_mfma_f32_16x16x32_bf16 v[76:79], v[224:227], v[124:127], v[76:79]
    ds_read_b64_tr_b16 v[238:239], v5 offset:42016
    s_waitcnt lgkmcnt(4)
    v_mfma_f32_16x16x32_bf16 v[80:83], v[228:231], v[120:123], v[80:83]
    ds_read_b64_tr_b16 v[240:241], v4 offset:41216
    v_mfma_f32_16x16x32_bf16 v[84:87], v[228:231], v[124:127], v[84:87]
    ds_read_b64_tr_b16 v[242:243], v4 offset:42240
    s_waitcnt lgkmcnt(4)
    v_mfma_f32_16x16x32_bf16 v[24:27], v[232:235], v[128:131], v[24:27]
    ds_read_b64_tr_b16 v[244:245], v5 offset:41248
    v_mfma_f32_16x16x32_bf16 v[28:31], v[232:235], v[132:135], v[28:31]
    ds_read_b64_tr_b16 v[246:247], v5 offset:42272
    s_waitcnt lgkmcnt(4)
    v_mfma_f32_16x16x32_bf16 v[32:35], v[236:239], v[128:131], v[32:35]
    ds_read_b64_tr_b16 v[224:225], v4 offset:41472
    v_mfma_f32_16x16x32_bf16 v[36:39], v[236:239], v[132:135], v[36:39]
    ds_read_b64_tr_b16 v[226:227], v4 offset:42496
    s_mov_b32 s23, 0x4800
    buffer_load_dwordx4 v[112:115], v7, s[8:11], s23 offen offset:1024 sc1
    s_waitcnt lgkmcnt(4)
    v_mfma_f32_16x16x32_bf16 v[40:43], v[240:243], v[128:131], v[40:43]
    ds_read_b64_tr_b16 v[228:229], v5 offset:41504
    v_mfma_f32_16x16x32_bf16 v[44:47], v[240:243], v[132:135], v[44:47]
    ds_read_b64_tr_b16 v[230:231], v5 offset:42528
    s_waitcnt lgkmcnt(4)
    v_mfma_f32_16x16x32_bf16 v[48:51], v[244:247], v[128:131], v[48:51]
    ds_read_b64_tr_b16 v[232:233], v4 offset:41728
    v_mfma_f32_16x16x32_bf16 v[52:55], v[244:247], v[132:135], v[52:55]
    ds_read_b64_tr_b16 v[234:235], v4 offset:42752
    s_waitcnt lgkmcnt(4)
    v_mfma_f32_16x16x32_bf16 v[56:59], v[224:227], v[128:131], v[56:59]
    ds_read_b64_tr_b16 v[236:237], v5 offset:41760
    v_mfma_f32_16x16x32_bf16 v[60:63], v[224:227], v[132:135], v[60:63]
    ds_read_b64_tr_b16 v[238:239], v5 offset:42784
    s_waitcnt lgkmcnt(4)
    v_mfma_f32_16x16x32_bf16 v[64:67], v[228:231], v[128:131], v[64:67]
    v_mfma_f32_16x16x32_bf16 v[68:71], v[228:231], v[132:135], v[68:71]
    s_waitcnt vmcnt(9)
    s_barrier
    ds_read_b64_tr_b16 v[240:241], v4 offset:49152
    ds_read_b64_tr_b16 v[242:243], v4 offset:50176
    s_mov_b32 s23, 0xc800
    buffer_load_dwordx4 v[116:119], v7, s[8:11], s23 offen offset:1024 sc1
    s_waitcnt lgkmcnt(4)
    v_mfma_f32_16x16x32_bf16 v[72:75], v[232:235], v[128:131], v[72:75]
    ds_read_b64_tr_b16 v[244:245], v5 offset:49184
    v_mfma_f32_16x16x32_bf16 v[76:79], v[232:235], v[132:135], v[76:79]
    s_add_u32 s22, s19, 0x480000
    s_add_u32 m0, s20, 0x4000
    s_nop 0
    buffer_load_dwordx4 v3, s[4:7], s22 offen lds
    ds_read_b64_tr_b16 v[246:247], v5 offset:50208
    s_waitcnt lgkmcnt(4)
    v_mfma_f32_16x16x32_bf16 v[80:83], v[236:239], v[128:131], v[80:83]
    ds_read_b64_tr_b16 v[224:225], v4 offset:49408
    v_mfma_f32_16x16x32_bf16 v[84:87], v[236:239], v[132:135], v[84:87]
    ds_read_b64_tr_b16 v[226:227], v4 offset:50432
    s_waitcnt lgkmcnt(4)
    v_mfma_f32_16x16x32_bf16 v[24:27], v[240:243], v[136:139], v[24:27]
    ds_read_b64_tr_b16 v[228:229], v5 offset:49440
    v_mfma_f32_16x16x32_bf16 v[28:31], v[240:243], v[140:143], v[28:31]
    ds_read_b64_tr_b16 v[230:231], v5 offset:50464
    s_waitcnt lgkmcnt(4)
    v_mfma_f32_16x16x32_bf16 v[32:35], v[244:247], v[136:139], v[32:35]
    ds_read_b64_tr_b16 v[232:233], v4 offset:49664
    v_mfma_f32_16x16x32_bf16 v[36:39], v[244:247], v[140:143], v[36:39]
    ds_read_b64_tr_b16 v[234:235], v4 offset:50688
    s_mov_b32 s23, 0x5000
    buffer_load_dwordx4 v[120:123], v7, s[8:11], s23 offen offset:0 sc1
    s_waitcnt lgkmcnt(4)
    v_mfma_f32_16x16x32_bf16 v[40:43], v[224:227], v[136:139], v[40:43]
    ds_read_b64_tr_b16 v[236:237], v5 offset:49696
    v_mfma_f32_16x16x32_bf16 v[44:47], v[224:227], v[140:143], v[44:47]
    s_add_u32 s22, s19, 0x488000
    s_add_u32 m0, s20, 0x4400
    s_nop 0
    buffer_load_dwordx4 v3, s[4:7], s22 offen lds
    ds_read_b64_tr_b16 v[238:239], v5 offset:50720
    s_waitcnt lgkmcnt(4)
    v_mfma_f32_16x16x32_bf16 v[48:51], v[228:231], v[136:139], v[48:51]
    ds_read_b64_tr_b16 v[240:241], v4 offset:49920
    v_mfma_f32_16x16x32_bf16 v[52:55], v[228:231], v[140:143], v[52:55]
    ds_read_b64_tr_b16 v[242:243], v4 offset:50944
    s_waitcnt lgkmcnt(4)
    v_mfma_f32_16x16x32_bf16 v[56:59], v[232:235], v[136:139], v[56:59]
    ds_read_b64_tr_b16 v[244:245], v5 offset:49952
    v_mfma_f32_16x16x32_bf16 v[60:63], v[232:235], v[140:143], v[60:63]
    ds_read_b64_tr_b16 v[246:247], v5 offset:50976
    s_waitcnt lgkmcnt(4)
    v_mfma_f32_16x16x32_bf16 v[64:67], v[236:239], v[136:139], v[64:67]
    ds_read_b64_tr_b16 v[224:225], v4 offset:57344
    v_mfma_f32_16x16x32_bf16 v[68:71], v[236:239], v[140:143], v[68:71]
    ds_read_b64_tr_b16 v[226:227], v4 offset:58368
    s_mov_b32 s23, 0xd000
    buffer_load_dwordx4 v[124:127], v7, s[8:11], s23 offen offset:0 sc1
    s_waitcnt lgkmcnt(4)
    v_mfma_f32_16x16x32_bf16 v[72:75], v[240:243], v[136:139], v[72:75]
    ds_read_b64_tr_b16 v[228:229], v5 offset:57376
    v_mfma_f32_16x16x32_bf16 v[76:79], v[240:243], v[140:143], v[76:79]
    ds_read_b64_tr_b16 v[230:231], v5 offset:58400
    s_waitcnt lgkmcnt(4)
    v_mfma_f32_16x16x32_bf16 v[80:83], v[244:247], v[136:139], v[80:83]
    ds_read_b64_tr_b16 v[232:233], v4 offset:57600
    v_mfma_f32_16x16x32_bf16 v[84:87], v[244:247], v[140:143], v[84:87]
    ds_read_b64_tr_b16 v[234:235], v4 offset:58624
    s_waitcnt lgkmcnt(4)
    v_mfma_f32_16x16x32_bf16 v[24:27], v[224:227], v[144:147], v[24:27]
    ds_read_b64_tr_b16 v[236:237], v5 offset:57632
    v_mfma_f32_16x16x32_bf16 v[28:31], v[224:227], v[148:151], v[28:31]
    ds_read_b64_tr_b16 v[238:239], v5 offset:58656
    s_waitcnt lgkmcnt(4)
    v_mfma_f32_16x16x32_bf16 v[32:35], v[228:231], v[144:147], v[32:35]
    ds_read_b64_tr_b16 v[240:241], v4 offset:57856
    v_mfma_f32_16x16x32_bf16 v[36:39], v[228:231], v[148:151], v[36:39]
    ds_read_b64_tr_b16 v[242:243], v4 offset:58880
    s_mov_b32 s23, 0x5000
    buffer_load_dwordx4 v[128:131], v7, s[8:11], s23 offen offset:1024 sc1
    s_waitcnt lgkmcnt(4)
    v_mfma_f32_16x16x32_bf16 v[40:43], v[232:235], v[144:147], v[40:43]
    ds_read_b64_tr_b16 v[244:245], v5 offset:57888
    v_mfma_f32_16x16x32_bf16 v[44:47], v[232:235], v[148:151], v[44:47]
    ds_read_b64_tr_b16 v[246:247], v5 offset:58912
    s_waitcnt lgkmcnt(4)
    v_mfma_f32_16x16x32_bf16 v[48:51], v[236:239], v[144:147], v[48:51]
    ds_read_b64_tr_b16 v[224:225], v4 offset:58112
    v_mfma_f32_16x16x32_bf16 v[52:55], v[236:239], v[148:151], v[52:55]
    ds_read_b64_tr_b16 v[226:227], v4 offset:59136
    s_waitcnt lgkmcnt(4)
    v_mfma_f32_16x16x32_bf16 v[56:59], v[240:243], v[144:147], v[56:59]
    ds_read_b64_tr_b16 v[228:229], v5 offset:58144
    v_mfma_f32_16x16x32_bf16 v[60:63], v[240:243], v[148:151], v[60:63]
    ds_read_b64_tr_b16 v[230:231], v5 offset:59168
    s_waitcnt lgkmcnt(4)
    v_mfma_f32_16x16x32_bf16 v[64:67], v[244:247], v[144:147], v[64:67]
    v_mfma_f32_16x16x32_bf16 v[68:71], v[244:247], v[148:151], v[68:71]
    s_waitcnt vmcnt(9)
    s_barrier
    ds_read_b64_tr_b16 v[232:233], v4 offset:0
    ds_read_b64_tr_b16 v[234:235], v4 offset:1024
    s_mov_b32 s23, 0xd000
    buffer_load_dwordx4 v[132:135], v7, s[8:11], s23 offen offset:1024 sc1
    s_waitcnt lgkmcnt(4)
    v_mfma_f32_16x16x32_bf16 v[72:75], v[224:227], v[144:147], v[72:75]
    ds_read_b64_tr_b16 v[236:237], v5 offset:32
    v_mfma_f32_16x16x32_bf16 v[76:79], v[224:227], v[148:151], v[76:79]
    s_add_u32 s22, s19, 0x500000
    s_add_u32 m0, s20, 0x8000
    s_nop 0
    buffer_load_dwordx4 v3, s[4:7], s22 offen lds
    ds_read_b64_tr_b16 v[238:239], v5 offset:1056
    s_waitcnt lgkmcnt(4)
    v_mfma_f32_16x16x32_bf16 v[80:83], v[228:231], v[144:147], v[80:83]
    ds_read_b64_tr_b16 v[240:241], v4 offset:256
    v_mfma_f32_16x16x32_bf16 v[84:87], v[228:231], v[148:151], v[84:87]
    ds_read_b64_tr_b16 v[242:243], v4 offset:1280
    s_waitcnt lgkmcnt(4)
    v_mfma_f32_16x16x32_bf16 v[24:27], v[232:235], v[88:91], v[24:27]
    ds_read_b64_tr_b16 v[244:245], v5 offset:288
    v_mfma_f32_16x16x32_bf16 v[28:31], v[232:235], v[92:95], v[28:31]
    ds_read_b64_tr_b16 v[246:247], v5 offset:1312
    s_waitcnt lgkmcnt(4)
    v_mfma_f32_16x16x32_bf16 v[32:35], v[236:239], v[88:91], v[32:35]
    ds_read_b64_tr_b16 v[224:225], v4 offset:512
    v_mfma_f32_16x16x32_bf16 v[36:39], v[236:239], v[92:95], v[36:39]
    ds_read_b64_tr_b16 v[226:227], v4 offset:1536
    s_mov_b32 s23, 0x5800
    buffer_load_dwordx4 v[136:139], v7, s[8:11], s23 offen offset:0 sc1
    s_waitcnt lgkmcnt(4)
    v_mfma_f32_16x16x32_bf16 v[40:43], v[240:243], v[88:91], v[40:43]
    ds_read_b64_tr_b16 v[228:229], v5 offset:544
    v_mfma_f32_16x16x32_bf16 v[44:47], v[240:243], v[92:95], v[44:47]
    s_add_u32 s22, s19, 0x508000
    s_add_u32 m0, s20, 0x8400
    s_nop 0
    buffer_load_dwordx4 v3, s[4:7], s22 offen lds
    ds_read_b64_tr_b16 v[230:231], v5 offset:1568
    s_waitcnt lgkmcnt(4)
    v_mfma_f32_16x16x32_bf16 v[48:51], v[244:247], v[88:91], v[48:51]
    ds_read_b64_tr_b16 v[232:233], v4 offset:768
    v_mfma_f32_16x16x32_bf16 v[52:55], v[244:247], v[92:95], v[52:55]
    ds_read_b64_tr_b16 v[234:235], v4 offset:1792
    s_waitcnt lgkmcnt(4)
    v_mfma_f32_16x16x32_bf16 v[56:59], v[224:227], v[88:91], v[56:59]
    ds_read_b64_tr_b16 v[236:237], v5 offset:800
    v_mfma_f32_16x16x32_bf16 v[60:63], v[224:227], v[92:95], v[60:63]
    ds_read_b64_tr_b16 v[238:239], v5 offset:1824
    s_waitcnt lgkmcnt(4)
    v_mfma_f32_16x16x32_bf16 v[64:67], v[228:231], v[88:91], v[64:67]
    ds_read_b64_tr_b16 v[240:241], v4 offset:8192
    v_mfma_f32_16x16x32_bf16 v[68:71], v[228:231], v[92:95], v[68:71]
    ds_read_b64_tr_b16 v[242:243], v4 offset:9216
    s_mov_b32 s23, 0xd800
    buffer_load_dwordx4 v[140:143], v7, s[8:11], s23 offen offset:0 sc1
    s_waitcnt lgkmcnt(4)
    v_mfma_f32_16x16x32_bf16 v[72:75], v[232:235], v[88:91], v[72:75]
    ds_read_b64_tr_b16 v[244:245], v5 offset:8224
    v_mfma_f32_16x16x32_bf16 v[76:79], v[232:235], v[92:95], v[76:79]
    ds_read_b64_tr_b16 v[246:247], v5 offset:9248
    s_waitcnt lgkmcnt(4)
    v_mfma_f32_16x16x32_bf16 v[80:83], v[236:239], v[88:91], v[80:83]
    ds_read_b64_tr_b16 v[224:225], v4 offset:8448
    v_mfma_f32_16x16x32_bf16 v[84:87], v[236:239], v[92:95], v[84:87]
    ds_read_b64_tr_b16 v[226:227], v4 offset:9472
    s_waitcnt lgkmcnt(4)
    v_mfma_f32_16x16x32_bf16 v[24:27], v[240:243], v[96:99], v[24:27]
    ds_read_b64_tr_b16 v[228:229], v5 offset:8480
    v_mfma_f32_16x16x32_bf16 v[28:31], v[240:243], v[100:103], v[28:31]
    ds_read_b64_tr_b16 v[230:231], v5 offset:9504
    s_waitcnt lgkmcnt(4)
    v_mfma_f32_16x16x32_bf16 v[32:35], v[244:247], v[96:99], v[32:35]
    ds_read_b64_tr_b16 v[232:233], v4 offset:8704
    v_mfma_f32_16x16x32_bf16 v[36:39], v[244:247], v[100:103], v[36:39]
    ds_read_b64_tr_b16 v[234:235], v4 offset:9728
    s_mov_b32 s23, 0x5800
    buffer_load_dwordx4 v[144:147], v7, s[8:11], s23 offen offset:1024 sc1
    s_waitcnt lgkmcnt(4)
    v_mfma_f32_16x16x32_bf16 v[40:43], v[224:227], v[96:99], v[40:43]
    ds_read_b64_tr_b16 v[236:237], v5 offset:8736
    v_mfma_f32_16x16x32_bf16 v[44:47], v[224:227], v[100:103], v[44:47]
    ds_read_b64_tr_b16 v[238:239], v5 offset:9760
    s_waitcnt lgkmcnt(4)
    v_mfma_f32_16x16x32_bf16 v[48:51], v[228:231], v[96:99], v[48:51]
    ds_read_b64_tr_b16 v[240:241], v4 offset:8960
    v_mfma_f32_16x16x32_bf16 v[52:55], v[228:231], v[100:103], v[52:55]
    ds_read_b64_tr_b16 v[242:243], v4 offset:9984
    s_waitcnt lgkmcnt(4)
    v_mfma_f32_16x16x32_bf16 v[56:59], v[232:235], v[96:99], v[56:59]
    ds_read_b64_tr_b16 v[244:245], v5 offset:8992
    v_mfma_f32_16x16x32_bf16 v[60:63], v[232:235], v[100:103], v[60:63]
    ds_read_b64_tr_b16 v[246:247], v5 offset:10016
    s_waitcnt lgkmcnt(4)
    v_mfma_f32_16x16x32_bf16 v[64:67], v[236:239], v[96:99], v[64:67]
    v_mfma_f32_16x16x32_bf16 v[68:71], v[236:239], v[100:103], v[68:71]
    s_waitcnt vmcnt(8)
    s_barrier
    ds_read_b64_tr_b16 v[224:225], v4 offset:16384
    ds_read_b64_tr_b16 v[226:227], v4 offset:17408
    s_mov_b32 s23, 0xd800
    buffer_load_dwordx4 v[148:151], v7, s[8:11], s23 offen offset:1024 sc1
    s_waitcnt lgkmcnt(4)
    v_mfma_f32_16x16x32_bf16 v[72:75], v[240:243], v[96:99], v[72:75]
    ds_read_b64_tr_b16 v[228:229], v5 offset:16416
    v_mfma_f32_16x16x32_bf16 v[76:79], v[240:243], v[100:103], v[76:79]
    s_add_u32 s22, s19, 0x580000
    s_add_u32 m0, s20, 0xc000
    s_nop 0
    buffer_load_dwordx4 v3, s[4:7], s22 offen lds
    ds_read_b64_tr_b16 v[230:231], v5 offset:17440
    s_waitcnt lgkmcnt(4)
    v_mfma_f32_16x16x32_bf16 v[80:83], v[244:247], v[96:99], v[80:83]
    ds_read_b64_tr_b16 v[232:233], v4 offset:16640
    v_mfma_f32_16x16x32_bf16 v[84:87], v[244:247], v[100:103], v[84:87]
    ds_read_b64_tr_b16 v[234:235], v4 offset:17664
    s_waitcnt lgkmcnt(4)
    v_mfma_f32_16x16x32_bf16 v[24:27], v[224:227], v[104:107], v[24:27]
    ds_read_b64_tr_b16 v[236:237], v5 offset:16672
    v_mfma_f32_16x16x32_bf16 v[28:31], v[224:227], v[108:111], v[28:31]
    ds_read_b64_tr_b16 v[238:239], v5 offset:17696
    s_waitcnt lgkmcnt(4)
    v_mfma_f32_16x16x32_bf16 v[32:35], v[228:231], v[104:107], v[32:35]
    ds_read_b64_tr_b16 v[240:241], v4 offset:16896
    v_mfma_f32_16x16x32_bf16 v[36:39], v[228:231], v[108:111], v[36:39]
    ds_read_b64_tr_b16 v[242:243], v4 offset:17920
    s_mov_b32 s23, 0x6000
    buffer_load_dwordx4 v[88:91], v7, s[8:11], s23 offen offset:0 sc1
    s_waitcnt lgkmcnt(4)
    v_mfma_f32_16x16x32_bf16 v[40:43], v[232:235], v[104:107], v[40:43]
    ds_read_b64_tr_b16 v[244:245], v5 offset:16928
    v_mfma_f32_16x16x32_bf16 v[44:47], v[232:235], v[108:111], v[44:47]
    s_add_u32 s22, s19, 0x588000
    s_add_u32 m0, s20, 0xc400
    s_nop 0
    buffer_load_dwordx4 v3, s[4:7], s22 offen lds
    ds_read_b64_tr_b16 v[246:247], v5 offset:17952
    s_waitcnt lgkmcnt(4)
    v_mfma_f32_16x16x32_bf16 v[48:51], v[236:239], v[104:107], v[48:51]
    ds_read_b64_tr_b16 v[224:225], v4 offset:17152
    v_mfma_f32_16x16x32_bf16 v[52:55], v[236:239], v[108:111], v[52:55]
    ds_read_b64_tr_b16 v[226:227], v4 offset:18176
    s_waitcnt lgkmcnt(4)
    v_mfma_f32_16x16x32_bf16 v[56:59], v[240:243], v[104:107], v[56:59]
    ds_read_b64_tr_b16 v[228:229], v5 offset:17184
    v_mfma_f32_16x16x32_bf16 v[60:63], v[240:243], v[108:111], v[60:63]
    ds_read_b64_tr_b16 v[230:231], v5 offset:18208
    s_waitcnt lgkmcnt(4)
    v_mfma_f32_16x16x32_bf16 v[64:67], v[244:247], v[104:107], v[64:67]
    ds_read_b64_tr_b16 v[232:233], v4 offset:24576
    v_mfma_f32_16x16x32_bf16 v[68:71], v[244:247], v[108:111], v[68:71]
    ds_read_b64_tr_b16 v[234:235], v4 offset:25600
    s_mov_b32 s23, 0xe000
    buffer_load_dwordx4 v[92:95], v7, s[8:11], s23 offen offset:0 sc1
    s_waitcnt lgkmcnt(4)
    v_mfma_f32_16x16x32_bf16 v[72:75], v[224:227], v[104:107], v[72:75]
    ds_read_b64_tr_b16 v[236:237], v5 offset:24608
    v_xor_b32 v8, s28, v12
    v_xor_b32 v20, s28, v13
    v_or_b32 v8, v8, v20
    v_xor_b32 v20, s28, v14
    v_or_b32 v8, v8, v20
    v_xor_b32 v20, s28, v15
    v_or_b32 v8, v8, v20
    v_cmp_ne_u32 vcc, 0, v8
    s_cbranch_vccnz adaLN_cond__sliding_block_cached__moe_arch_mod__prompt_kernel_kv4r
adaLN_cond__sliding_block_cached__moe_arch_mod__prompt_kernel_kv4b:
    v_mfma_f32_16x16x32_bf16 v[76:79], v[224:227], v[108:111], v[76:79]
    ds_read_b64_tr_b16 v[238:239], v5 offset:25632
    v_mov_b32 v20, 0
    s_mov_b32 s16, 0x564000
    buffer_load_dword v8, v20, s[8:11], s16 offen sc1
    s_waitcnt lgkmcnt(4)
    v_mfma_f32_16x16x32_bf16 v[80:83], v[228:231], v[104:107], v[80:83]
    ds_read_b64_tr_b16 v[240:241], v4 offset:24832
    v_mfma_f32_16x16x32_bf16 v[84:87], v[228:231], v[108:111], v[84:87]
    ds_read_b64_tr_b16 v[242:243], v4 offset:25856
    s_waitcnt lgkmcnt(4)
    v_mfma_f32_16x16x32_bf16 v[24:27], v[232:235], v[112:115], v[24:27]
    ds_read_b64_tr_b16 v[244:245], v5 offset:24864
    v_mfma_f32_16x16x32_bf16 v[28:31], v[232:235], v[116:119], v[28:31]
    ds_read_b64_tr_b16 v[246:247], v5 offset:25888
    s_waitcnt lgkmcnt(4)
    v_mfma_f32_16x16x32_bf16 v[32:35], v[236:239], v[112:115], v[32:35]
    ds_read_b64_tr_b16 v[224:225], v4 offset:25088
    v_mfma_f32_16x16x32_bf16 v[36:39], v[236:239], v[116:119], v[36:39]
    ds_read_b64_tr_b16 v[226:227], v4 offset:26112
    s_mov_b32 s23, 0x6000
    buffer_load_dwordx4 v[96:99], v7, s[8:11], s23 offen offset:1024 sc1
    s_waitcnt lgkmcnt(4)
    v_mfma_f32_16x16x32_bf16 v[40:43], v[240:243], v[112:115], v[40:43]
    ds_read_b64_tr_b16 v[228:229], v5 offset:25120
    v_mfma_f32_16x16x32_bf16 v[44:47], v[240:243], v[116:119], v[44:47]
    ds_read_b64_tr_b16 v[230:231], v5 offset:26144
    s_waitcnt lgkmcnt(4)
    v_mfma_f32_16x16x32_bf16 v[48:51], v[244:247], v[112:115], v[48:51]
    ds_read_b64_tr_b16 v[232:233], v4 offset:25344
    v_mfma_f32_16x16x32_bf16 v[52:55], v[244:247], v[116:119], v[52:55]
    ds_read_b64_tr_b16 v[234:235], v4 offset:26368
    s_waitcnt lgkmcnt(4)
    v_mfma_f32_16x16x32_bf16 v[56:59], v[224:227], v[112:115], v[56:59]
    ds_read_b64_tr_b16 v[236:237], v5 offset:25376
    v_mfma_f32_16x16x32_bf16 v[60:63], v[224:227], v[116:119], v[60:63]
    ds_read_b64_tr_b16 v[238:239], v5 offset:26400
    s_waitcnt lgkmcnt(4)
    v_mfma_f32_16x16x32_bf16 v[64:67], v[228:231], v[112:115], v[64:67]
    v_mfma_f32_16x16x32_bf16 v[68:71], v[228:231], v[116:119], v[68:71]
    s_waitcnt vmcnt(9)
    s_barrier
    ds_read_b64_tr_b16 v[240:241], v4 offset:32768
    ds_read_b64_tr_b16 v[242:243], v4 offset:33792
    s_mov_b32 s23, 0xe000
    buffer_load_dwordx4 v[100:103], v7, s[8:11], s23 offen offset:1024 sc1
    s_waitcnt lgkmcnt(4)
    v_mfma_f32_16x16x32_bf16 v[72:75], v[232:235], v[112:115], v[72:75]
    ds_read_b64_tr_b16 v[244:245], v5 offset:32800
    v_mfma_f32_16x16x32_bf16 v[76:79], v[232:235], v[116:119], v[76:79]
    s_add_u32 s22, s19, 0x600000
    s_add_u32 m0, s20, 0x0
    s_nop 0
    buffer_load_dwordx4 v3, s[4:7], s22 offen lds
    ds_read_b64_tr_b16 v[246:247], v5 offset:33824
    s_waitcnt lgkmcnt(4)
    v_mfma_f32_16x16x32_bf16 v[80:83], v[236:239], v[112:115], v[80:83]
    ds_read_b64_tr_b16 v[224:225], v4 offset:33024
    v_mfma_f32_16x16x32_bf16 v[84:87], v[236:239], v[116:119], v[84:87]
    ds_read_b64_tr_b16 v[226:227], v4 offset:34048
    s_waitcnt lgkmcnt(4)
    v_mfma_f32_16x16x32_bf16 v[24:27], v[240:243], v[120:123], v[24:27]
    ds_read_b64_tr_b16 v[228:229], v5 offset:33056
    v_mfma_f32_16x16x32_bf16 v[28:31], v[240:243], v[124:127], v[28:31]
    ds_read_b64_tr_b16 v[230:231], v5 offset:34080
    s_waitcnt lgkmcnt(4)
    v_mfma_f32_16x16x32_bf16 v[32:35], v[244:247], v[120:123], v[32:35]
    ds_read_b64_tr_b16 v[232:233], v4 offset:33280
    v_mfma_f32_16x16x32_bf16 v[36:39], v[244:247], v[124:127], v[36:39]
    ds_read_b64_tr_b16 v[234:235], v4 offset:34304
    s_mov_b32 s23, 0x6800
    buffer_load_dwordx4 v[104:107], v7, s[8:11], s23 offen offset:0 sc1
    s_waitcnt lgkmcnt(4)
    v_mfma_f32_16x16x32_bf16 v[40:43], v[224:227], v[120:123], v[40:43]
    ds_read_b64_tr_b16 v[236:237], v5 offset:33312
    v_mfma_f32_16x16x32_bf16 v[44:47], v[224:227], v[124:127], v[44:47]
    s_add_u32 s22, s19, 0x608000
    s_add_u32 m0, s20, 0x400
    s_nop 0
    buffer_load_dwordx4 v3, s[4:7], s22 offen lds
    ds_read_b64_tr_b16 v[238:239], v5 offset:34336
    s_waitcnt lgkmcnt(4)
    v_mfma_f32_16x16x32_bf16 v[48:51], v[228:231], v[120:123], v[48:51]
    ds_read_b64_tr_b16 v[240:241], v4 offset:33536
    v_mfma_f32_16x16x32_bf16 v[52:55], v[228:231], v[124:127], v[52:55]
    ds_read_b64_tr_b16 v[242:243], v4 offset:34560
    s_waitcnt lgkmcnt(4)
    v_mfma_f32_16x16x32_bf16 v[56:59], v[232:235], v[120:123], v[56:59]
    ds_read_b64_tr_b16 v[244:245], v5 offset:33568
    v_mfma_f32_16x16x32_bf16 v[60:63], v[232:235], v[124:127], v[60:63]
    ds_read_b64_tr_b16 v[246:247], v5 offset:34592
    s_waitcnt lgkmcnt(4)
    v_mfma_f32_16x16x32_bf16 v[64:67], v[236:239], v[120:123], v[64:67]
    ds_read_b64_tr_b16 v[224:225], v4 offset:40960
    v_mfma_f32_16x16x32_bf16 v[68:71], v[236:239], v[124:127], v[68:71]
    ds_read_b64_tr_b16 v[226:227], v4 offset:41984
    s_mov_b32 s23, 0xe800
    buffer_load_dwordx4 v[108:111], v7, s[8:11], s23 offen offset:0 sc1
    s_waitcnt lgkmcnt(4)
    v_mfma_f32_16x16x32_bf16 v[72:75], v[240:243], v[120:123], v[72:75]
    ds_read_b64_tr_b16 v[228:229], v5 offset:40992
    v_mfma_f32_16x16x32_bf16 v[76:79], v[240:243], v[124:127], v[76:79]
    ds_read_b64_tr_b16 v[230:231], v5 offset:42016
    s_waitcnt lgkmcnt(4)
    v_mfma_f32_16x16x32_bf16 v[80:83], v[244:247], v[120:123], v[80:83]
    ds_read_b64_tr_b16 v[232:233], v4 offset:41216
    v_mfma_f32_16x16x32_bf16 v[84:87], v[244:247], v[124:127], v[84:87]
    ds_read_b64_tr_b16 v[234:235], v4 offset:42240
    s_waitcnt lgkmcnt(4)
    v_mfma_f32_16x16x32_bf16 v[24:27], v[224:227], v[128:131], v[24:27]
    ds_read_b64_tr_b16 v[236:237], v5 offset:41248
    s_add_u32 s22, s21, 0x0
    s_add_u32 m0, s20, 0x10000
    s_nop 0
    buffer_load_dwordx4 v2, s[8:11], s22 offen sc1 lds
    v_mfma_f32_16x16x32_bf16 v[28:31], v[224:227], v[132:135], v[28:31]
    ds_read_b64_tr_b16 v[238:239], v5 offset:42272
    s_waitcnt lgkmcnt(4)
    v_mfma_f32_16x16x32_bf16 v[32:35], v[228:231], v[128:131], v[32:35]
    ds_read_b64_tr_b16 v[240:241], v4 offset:41472
    v_mfma_f32_16x16x32_bf16 v[36:39], v[228:231], v[132:135], v[36:39]
    ds_read_b64_tr_b16 v[242:243], v4 offset:42496
    s_mov_b32 s23, 0x6800
    buffer_load_dwordx4 v[112:115], v7, s[8:11], s23 offen offset:1024 sc1
    s_waitcnt lgkmcnt(4)
    v_mfma_f32_16x16x32_bf16 v[40:43], v[232:235], v[128:131], v[40:43]
    ds_read_b64_tr_b16 v[244:245], v5 offset:41504
    s_add_u32 s22, s21, 0x400
    s_add_u32 m0, s20, 0x10400
    s_nop 0
    buffer_load_dwordx4 v2, s[8:11], s22 offen sc1 lds
    v_mfma_f32_16x16x32_bf16 v[44:47], v[232:235], v[132:135], v[44:47]
    ds_read_b64_tr_b16 v[246:247], v5 offset:42528
    s_waitcnt lgkmcnt(4)
    v_mfma_f32_16x16x32_bf16 v[48:51], v[236:239], v[128:131], v[48:51]
    ds_read_b64_tr_b16 v[224:225], v4 offset:41728
    v_mfma_f32_16x16x32_bf16 v[52:55], v[236:239], v[132:135], v[52:55]
    ds_read_b64_tr_b16 v[226:227], v4 offset:42752
    s_waitcnt lgkmcnt(4)
    v_mfma_f32_16x16x32_bf16 v[56:59], v[240:243], v[128:131], v[56:59]
    ds_read_b64_tr_b16 v[228:229], v5 offset:41760
    v_mfma_f32_16x16x32_bf16 v[60:63], v[240:243], v[132:135], v[60:63]
    ds_read_b64_tr_b16 v[230:231], v5 offset:42784
    s_waitcnt lgkmcnt(4)
    v_mfma_f32_16x16x32_bf16 v[64:67], v[244:247], v[128:131], v[64:67]
    v_mfma_f32_16x16x32_bf16 v[68:71], v[244:247], v[132:135], v[68:71]
    s_waitcnt vmcnt(11)
    s_barrier
    ds_read_b64_tr_b16 v[232:233], v4 offset:49152
    ds_read_b64_tr_b16 v[234:235], v4 offset:50176
    s_mov_b32 s23, 0xe800
    buffer_load_dwordx4 v[116:119], v7, s[8:11], s23 offen offset:1024 sc1
    s_waitcnt lgkmcnt(4)
    v_mfma_f32_16x16x32_bf16 v[72:75], v[224:227], v[128:131], v[72:75]
    ds_read_b64_tr_b16 v[236:237], v5 offset:49184
    v_mfma_f32_16x16x32_bf16 v[76:79], v[224:227], v[132:135], v[76:79]
    s_add_u32 s22, s19, 0x680000
    s_add_u32 m0, s20, 0x4000
    s_nop 0
    buffer_load_dwordx4 v3, s[4:7], s22 offen lds
    ds_read_b64_tr_b16 v[238:239], v5 offset:50208
    s_waitcnt lgkmcnt(4)
    v_mfma_f32_16x16x32_bf16 v[80:83], v[228:231], v[128:131], v[80:83]
    ds_read_b64_tr_b16 v[240:241], v4 offset:49408
    v_mfma_f32_16x16x32_bf16 v[84:87], v[228:231], v[132:135], v[84:87]
    ds_read_b64_tr_b16 v[242:243], v4 offset:50432
    s_waitcnt lgkmcnt(4)
    v_mfma_f32_16x16x32_bf16 v[24:27], v[232:235], v[136:139], v[24:27]
    ds_read_b64_tr_b16 v[244:245], v5 offset:49440
    v_mfma_f32_16x16x32_bf16 v[28:31], v[232:235], v[140:143], v[28:31]
    ds_read_b64_tr_b16 v[246:247], v5 offset:50464
    s_waitcnt lgkmcnt(4)
    v_mfma_f32_16x16x32_bf16 v[32:35], v[236:239], v[136:139], v[32:35]
    ds_read_b64_tr_b16 v[224:225], v4 offset:49664
    v_mfma_f32_16x16x32_bf16 v[36:39], v[236:239], v[140:143], v[36:39]
    ds_read_b64_tr_b16 v[226:227], v4 offset:50688
    s_mov_b32 s23, 0x7000
    buffer_load_dwordx4 v[120:123], v7, s[8:11], s23 offen offset:0 sc1
    s_waitcnt lgkmcnt(4)
    v_mfma_f32_16x16x32_bf16 v[40:43], v[240:243], v[136:139], v[40:43]
    ds_read_b64_tr_b16 v[228:229], v5 offset:49696
    v_mfma_f32_16x16x32_bf16 v[44:47], v[240:243], v[140:143], v[44:47]
    s_add_u32 s22, s19, 0x688000
    s_add_u32 m0, s20, 0x4400
    s_nop 0
    buffer_load_dwordx4 v3, s[4:7], s22 offen lds
    ds_read_b64_tr_b16 v[230:231], v5 offset:50720
    s_waitcnt lgkmcnt(4)
    v_mfma_f32_16x16x32_bf16 v[48:51], v[244:247], v[136:139], v[48:51]
    ds_read_b64_tr_b16 v[232:233], v4 offset:49920
    v_mfma_f32_16x16x32_bf16 v[52:55], v[244:247], v[140:143], v[52:55]
    ds_read_b64_tr_b16 v[234:235], v4 offset:50944
    s_waitcnt lgkmcnt(4)
    v_mfma_f32_16x16x32_bf16 v[56:59], v[224:227], v[136:139], v[56:59]
    ds_read_b64_tr_b16 v[236:237], v5 offset:49952
    v_mfma_f32_16x16x32_bf16 v[60:63], v[224:227], v[140:143], v[60:63]
    ds_read_b64_tr_b16 v[238:239], v5 offset:50976
    s_waitcnt lgkmcnt(4)
    v_mfma_f32_16x16x32_bf16 v[64:67], v[228:231], v[136:139], v[64:67]
    ds_read_b64_tr_b16 v[240:241], v4 offset:57344
    v_mfma_f32_16x16x32_bf16 v[68:71], v[228:231], v[140:143], v[68:71]
    ds_read_b64_tr_b16 v[242:243], v4 offset:58368
    s_mov_b32 s23, 0xf000
    buffer_load_dwordx4 v[124:127], v7, s[8:11], s23 offen offset:0 sc1
    s_waitcnt lgkmcnt(4)
    v_mfma_f32_16x16x32_bf16 v[72:75], v[232:235], v[136:139], v[72:75]
    ds_read_b64_tr_b16 v[244:245], v5 offset:57376
    v_mfma_f32_16x16x32_bf16 v[76:79], v[232:235], v[140:143], v[76:79]
    ds_read_b64_tr_b16 v[246:247], v5 offset:58400
    s_waitcnt lgkmcnt(4)
    v_mfma_f32_16x16x32_bf16 v[80:83], v[236:239], v[136:139], v[80:83]
    ds_read_b64_tr_b16 v[224:225], v4 offset:57600
    v_mfma_f32_16x16x32_bf16 v[84:87], v[236:239], v[140:143], v[84:87]
    ds_read_b64_tr_b16 v[226:227], v4 offset:58624
    s_waitcnt lgkmcnt(4)
    v_mfma_f32_16x16x32_bf16 v[24:27], v[240:243], v[144:147], v[24:27]
    ds_read_b64_tr_b16 v[228:229], v5 offset:57632
    s_add_u32 s22, s21, 0x4000
    s_add_u32 m0, s20, 0x14000
    s_nop 0
    buffer_load_dwordx4 v2, s[8:11], s22 offen sc1 lds
    v_mfma_f32_16x16x32_bf16 v[28:31], v[240:243], v[148:151], v[28:31]
    ds_read_b64_tr_b16 v[230:231], v5 offset:58656
    s_waitcnt lgkmcnt(4)
    v_mfma_f32_16x16x32_bf16 v[32:35], v[244:247], v[144:147], v[32:35]
    ds_read_b64_tr_b16 v[232:233], v4 offset:57856
    v_mfma_f32_16x16x32_bf16 v[36:39], v[244:247], v[148:151], v[36:39]
    ds_read_b64_tr_b16 v[234:235], v4 offset:58880
    s_mov_b32 s23, 0x7000
    buffer_load_dwordx4 v[128:131], v7, s[8:11], s23 offen offset:1024 sc1
    s_waitcnt lgkmcnt(4)
    v_mfma_f32_16x16x32_bf16 v[40:43], v[224:227], v[144:147], v[40:43]
    ds_read_b64_tr_b16 v[236:237], v5 offset:57888
    s_add_u32 s22, s21, 0x4400
    s_add_u32 m0, s20, 0x14400
    s_nop 0
    buffer_load_dwordx4 v2, s[8:11], s22 offen sc1 lds
    v_mfma_f32_16x16x32_bf16 v[44:47], v[224:227], v[148:151], v[44:47]
    ds_read_b64_tr_b16 v[238:239], v5 offset:58912
    s_waitcnt lgkmcnt(4)
    v_mfma_f32_16x16x32_bf16 v[48:51], v[228:231], v[144:147], v[48:51]
    ds_read_b64_tr_b16 v[240:241], v4 offset:58112
    v_mfma_f32_16x16x32_bf16 v[52:55], v[228:231], v[148:151], v[52:55]
    ds_read_b64_tr_b16 v[242:243], v4 offset:59136
    s_waitcnt lgkmcnt(4)
    v_mfma_f32_16x16x32_bf16 v[56:59], v[232:235], v[144:147], v[56:59]
    ds_read_b64_tr_b16 v[244:245], v5 offset:58144
    v_mfma_f32_16x16x32_bf16 v[60:63], v[232:235], v[148:151], v[60:63]
    ds_read_b64_tr_b16 v[246:247], v5 offset:59168
    s_waitcnt lgkmcnt(4)
    v_mfma_f32_16x16x32_bf16 v[64:67], v[236:239], v[144:147], v[64:67]
    v_mfma_f32_16x16x32_bf16 v[68:71], v[236:239], v[148:151], v[68:71]
    s_waitcnt vmcnt(12)
    s_barrier
    ds_read_b64_tr_b16 v[224:225], v4 offset:0
    ds_read_b64_tr_b16 v[226:227], v4 offset:1024
    s_mov_b32 s23, 0xf000
    buffer_load_dwordx4 v[132:135], v7, s[8:11], s23 offen offset:1024 sc1
    s_waitcnt lgkmcnt(4)
    v_mfma_f32_16x16x32_bf16 v[72:75], v[240:243], v[144:147], v[72:75]
    ds_read_b64_tr_b16 v[228:229], v5 offset:32
    v_mfma_f32_16x16x32_bf16 v[76:79], v[240:243], v[148:151], v[76:79]
    s_add_u32 s22, s19, 0x700000
    s_add_u32 m0, s20, 0x8000
    s_nop 0
    buffer_load_dwordx4 v3, s[4:7], s22 offen lds
    ds_read_b64_tr_b16 v[230:231], v5 offset:1056
    s_waitcnt lgkmcnt(4)
    v_mfma_f32_16x16x32_bf16 v[80:83], v[244:247], v[144:147], v[80:83]
    ds_read_b64_tr_b16 v[232:233], v4 offset:256
    v_mfma_f32_16x16x32_bf16 v[84:87], v[244:247], v[148:151], v[84:87]
    ds_read_b64_tr_b16 v[234:235], v4 offset:1280
    s_waitcnt lgkmcnt(4)
    v_mfma_f32_16x16x32_bf16 v[24:27], v[224:227], v[88:91], v[24:27]
    ds_read_b64_tr_b16 v[236:237], v5 offset:288
    v_mfma_f32_16x16x32_bf16 v[28:31], v[224:227], v[92:95], v[28:31]
    ds_read_b64_tr_b16 v[238:239], v5 offset:1312
    s_waitcnt lgkmcnt(4)
    v_mfma_f32_16x16x32_bf16 v[32:35], v[228:231], v[88:91], v[32:35]
    ds_read_b64_tr_b16 v[240:241], v4 offset:512
    v_mfma_f32_16x16x32_bf16 v[36:39], v[228:231], v[92:95], v[36:39]
    ds_read_b64_tr_b16 v[242:243], v4 offset:1536
    s_mov_b32 s23, 0x7800
    buffer_load_dwordx4 v[136:139], v7, s[8:11], s23 offen offset:0 sc1
    s_waitcnt lgkmcnt(4)
    v_mfma_f32_16x16x32_bf16 v[40:43], v[232:235], v[88:91], v[40:43]
    ds_read_b64_tr_b16 v[244:245], v5 offset:544
    v_mfma_f32_16x16x32_bf16 v[44:47], v[232:235], v[92:95], v[44:47]
    s_add_u32 s22, s19, 0x708000
    s_add_u32 m0, s20, 0x8400
    s_nop 0
    buffer_load_dwordx4 v3, s[4:7], s22 offen lds
    ds_read_b64_tr_b16 v[246:247], v5 offset:1568
    s_waitcnt lgkmcnt(4)
    v_mfma_f32_16x16x32_bf16 v[48:51], v[236:239], v[88:91], v[48:51]
    ds_read_b64_tr_b16 v[224:225], v4 offset:768
    v_mfma_f32_16x16x32_bf16 v[52:55], v[236:239], v[92:95], v[52:55]
    ds_read_b64_tr_b16 v[226:227], v4 offset:1792
    s_waitcnt lgkmcnt(4)
    v_mfma_f32_16x16x32_bf16 v[56:59], v[240:243], v[88:91], v[56:59]
    ds_read_b64_tr_b16 v[228:229], v5 offset:800
    v_mfma_f32_16x16x32_bf16 v[60:63], v[240:243], v[92:95], v[60:63]
    ds_read_b64_tr_b16 v[230:231], v5 offset:1824
    s_waitcnt lgkmcnt(4)
    v_mfma_f32_16x16x32_bf16 v[64:67], v[244:247], v[88:91], v[64:67]
    ds_read_b64_tr_b16 v[232:233], v4 offset:8192
    v_mfma_f32_16x16x32_bf16 v[68:71], v[244:247], v[92:95], v[68:71]
    ds_read_b64_tr_b16 v[234:235], v4 offset:9216
    s_mov_b32 s23, 0xf800
    buffer_load_dwordx4 v[140:143], v7, s[8:11], s23 offen offset:0 sc1
    s_waitcnt lgkmcnt(4)
    v_mfma_f32_16x16x32_bf16 v[72:75], v[224:227], v[88:91], v[72:75]
    ds_read_b64_tr_b16 v[236:237], v5 offset:8224
    v_mfma_f32_16x16x32_bf16 v[76:79], v[224:227], v[92:95], v[76:79]
    ds_read_b64_tr_b16 v[238:239], v5 offset:9248
    s_waitcnt lgkmcnt(4)
    v_mfma_f32_16x16x32_bf16 v[80:83], v[228:231], v[88:91], v[80:83]
    ds_read_b64_tr_b16 v[240:241], v4 offset:8448
    v_mfma_f32_16x16x32_bf16 v[84:87], v[228:231], v[92:95], v[84:87]
    ds_read_b64_tr_b16 v[242:243], v4 offset:9472
    s_waitcnt lgkmcnt(4)
    v_mfma_f32_16x16x32_bf16 v[24:27], v[232:235], v[96:99], v[24:27]
    ds_read_b64_tr_b16 v[244:245], v5 offset:8480
    s_add_u32 s22, s21, 0x8000
    s_add_u32 m0, s20, 0x18000
    s_nop 0
    buffer_load_dwordx4 v2, s[8:11], s22 offen sc1 lds
    v_mfma_f32_16x16x32_bf16 v[28:31], v[232:235], v[100:103], v[28:31]
    ds_read_b64_tr_b16 v[246:247], v5 offset:9504
    s_waitcnt lgkmcnt(4)
    v_mfma_f32_16x16x32_bf16 v[32:35], v[236:239], v[96:99], v[32:35]
    ds_read_b64_tr_b16 v[224:225], v4 offset:8704
    v_mfma_f32_16x16x32_bf16 v[36:39], v[236:239], v[100:103], v[36:39]
    ds_read_b64_tr_b16 v[226:227], v4 offset:9728
    s_mov_b32 s23, 0x7800
    buffer_load_dwordx4 v[144:147], v7, s[8:11], s23 offen offset:1024 sc1
    s_waitcnt lgkmcnt(4)
    v_mfma_f32_16x16x32_bf16 v[40:43], v[240:243], v[96:99], v[40:43]
    ds_read_b64_tr_b16 v[228:229], v5 offset:8736
    s_add_u32 s22, s21, 0x8400
    s_add_u32 m0, s20, 0x18400
    s_nop 0
    buffer_load_dwordx4 v2, s[8:11], s22 offen sc1 lds
    v_mfma_f32_16x16x32_bf16 v[44:47], v[240:243], v[100:103], v[44:47]
    ds_read_b64_tr_b16 v[230:231], v5 offset:9760
    s_waitcnt lgkmcnt(4)
    v_mfma_f32_16x16x32_bf16 v[48:51], v[244:247], v[96:99], v[48:51]
    ds_read_b64_tr_b16 v[232:233], v4 offset:8960
    v_mfma_f32_16x16x32_bf16 v[52:55], v[244:247], v[100:103], v[52:55]
    ds_read_b64_tr_b16 v[234:235], v4 offset:9984
    s_waitcnt lgkmcnt(4)
    v_mfma_f32_16x16x32_bf16 v[56:59], v[224:227], v[96:99], v[56:59]
    ds_read_b64_tr_b16 v[236:237], v5 offset:8992
    v_mfma_f32_16x16x32_bf16 v[60:63], v[224:227], v[100:103], v[60:63]
    ds_read_b64_tr_b16 v[238:239], v5 offset:10016
    s_waitcnt lgkmcnt(4)
    v_mfma_f32_16x16x32_bf16 v[64:67], v[228:231], v[96:99], v[64:67]
    v_mfma_f32_16x16x32_bf16 v[68:71], v[228:231], v[100:103], v[68:71]
    s_waitcnt vmcnt(12)
    s_barrier
    ds_read_b64_tr_b16 v[240:241], v4 offset:16384
    ds_read_b64_tr_b16 v[242:243], v4 offset:17408
    s_mov_b32 s23, 0xf800
    buffer_load_dwordx4 v[148:151], v7, s[8:11], s23 offen offset:1024 sc1
    s_waitcnt lgkmcnt(4)
    v_mfma_f32_16x16x32_bf16 v[72:75], v[232:235], v[96:99], v[72:75]
    ds_read_b64_tr_b16 v[244:245], v5 offset:16416
    v_mfma_f32_16x16x32_bf16 v[76:79], v[232:235], v[100:103], v[76:79]
    s_add_u32 s22, s19, 0x780000
    s_add_u32 m0, s20, 0xc000
    s_nop 0
    buffer_load_dwordx4 v3, s[4:7], s22 offen lds
    ds_read_b64_tr_b16 v[246:247], v5 offset:17440
    s_waitcnt lgkmcnt(4)
    v_mfma_f32_16x16x32_bf16 v[80:83], v[236:239], v[96:99], v[80:83]
    ds_read_b64_tr_b16 v[224:225], v4 offset:16640
    v_mfma_f32_16x16x32_bf16 v[84:87], v[236:239], v[100:103], v[84:87]
    ds_read_b64_tr_b16 v[226:227], v4 offset:17664
    s_waitcnt lgkmcnt(4)
    v_mfma_f32_16x16x32_bf16 v[24:27], v[240:243], v[104:107], v[24:27]
    ds_read_b64_tr_b16 v[228:229], v5 offset:16672
    v_mfma_f32_16x16x32_bf16 v[28:31], v[240:243], v[108:111], v[28:31]
    ds_read_b64_tr_b16 v[230:231], v5 offset:17696
    s_waitcnt lgkmcnt(4)
    v_mfma_f32_16x16x32_bf16 v[32:35], v[244:247], v[104:107], v[32:35]
    ds_read_b64_tr_b16 v[232:233], v4 offset:16896
    v_mfma_f32_16x16x32_bf16 v[36:39], v[244:247], v[108:111], v[36:39]
    ds_read_b64_tr_b16 v[234:235], v4 offset:17920
    s_waitcnt lgkmcnt(4)
    v_mfma_f32_16x16x32_bf16 v[40:43], v[224:227], v[104:107], v[40:43]
    ds_read_b64_tr_b16 v[236:237], v5 offset:16928
    v_mfma_f32_16x16x32_bf16 v[44:47], v[224:227], v[108:111], v[44:47]
    s_add_u32 s22, s19, 0x788000
    s_add_u32 m0, s20, 0xc400
    s_nop 0
    buffer_load_dwordx4 v3, s[4:7], s22 offen lds
    ds_read_b64_tr_b16 v[238:239], v5 offset:17952
    s_waitcnt lgkmcnt(4)
    v_mfma_f32_16x16x32_bf16 v[48:51], v[228:231], v[104:107], v[48:51]
    ds_read_b64_tr_b16 v[240:241], v4 offset:17152
    v_mfma_f32_16x16x32_bf16 v[52:55], v[228:231], v[108:111], v[52:55]
    ds_read_b64_tr_b16 v[242:243], v4 offset:18176
    s_waitcnt lgkmcnt(4)
    v_mfma_f32_16x16x32_bf16 v[56:59], v[232:235], v[104:107], v[56:59]
    ds_read_b64_tr_b16 v[244:245], v5 offset:17184
    v_mfma_f32_16x16x32_bf16 v[60:63], v[232:235], v[108:111], v[60:63]
    ds_read_b64_tr_b16 v[246:247], v5 offset:18208
    s_waitcnt lgkmcnt(4)
    v_mfma_f32_16x16x32_bf16 v[64:67], v[236:239], v[104:107], v[64:67]
    ds_read_b64_tr_b16 v[224:225], v4 offset:24576
    v_mfma_f32_16x16x32_bf16 v[68:71], v[236:239], v[108:111], v[68:71]
    ds_read_b64_tr_b16 v[226:227], v4 offset:25600
    s_waitcnt lgkmcnt(4)
    v_mfma_f32_16x16x32_bf16 v[72:75], v[240:243], v[104:107], v[72:75]
    ds_read_b64_tr_b16 v[228:229], v5 offset:24608
    v_mfma_f32_16x16x32_bf16 v[76:79], v[240:243], v[108:111], v[76:79]
    ds_read_b64_tr_b16 v[230:231], v5 offset:25632
    s_waitcnt lgkmcnt(4)
    v_mfma_f32_16x16x32_bf16 v[80:83], v[244:247], v[104:107], v[80:83]
    ds_read_b64_tr_b16 v[232:233], v4 offset:24832
    v_mfma_f32_16x16x32_bf16 v[84:87], v[244:247], v[108:111], v[84:87]
    ds_read_b64_tr_b16 v[234:235], v4 offset:25856
    s_waitcnt lgkmcnt(4)
    v_mfma_f32_16x16x32_bf16 v[24:27], v[224:227], v[112:115], v[24:27]
    ds_read_b64_tr_b16 v[236:237], v5 offset:24864
    s_add_u32 s22, s21, 0xc000
    s_add_u32 m0, s20, 0x1c000
    s_nop 0
    buffer_load_dwordx4 v2, s[8:11], s22 offen sc1 lds
    v_mfma_f32_16x16x32_bf16 v[28:31], v[224:227], v[116:119], v[28:31]
    ds_read_b64_tr_b16 v[238:239], v5 offset:25888
    s_waitcnt lgkmcnt(4)
    v_mfma_f32_16x16x32_bf16 v[32:35], v[228:231], v[112:115], v[32:35]
    ds_read_b64_tr_b16 v[240:241], v4 offset:25088
    v_mfma_f32_16x16x32_bf16 v[36:39], v[228:231], v[116:119], v[36:39]
    ds_read_b64_tr_b16 v[242:243], v4 offset:26112
    s_waitcnt lgkmcnt(4)
    v_mfma_f32_16x16x32_bf16 v[40:43], v[232:235], v[112:115], v[40:43]
    ds_read_b64_tr_b16 v[244:245], v5 offset:25120
    s_add_u32 s22, s21, 0xc400
    s_add_u32 m0, s20, 0x1c400
    s_nop 0
    buffer_load_dwordx4 v2, s[8:11], s22 offen sc1 lds
    v_mfma_f32_16x16x32_bf16 v[44:47], v[232:235], v[116:119], v[44:47]
    ds_read_b64_tr_b16 v[246:247], v5 offset:26144
    s_waitcnt lgkmcnt(4)
    v_mfma_f32_16x16x32_bf16 v[48:51], v[236:239], v[112:115], v[48:51]
    ds_read_b64_tr_b16 v[224:225], v4 offset:25344
    v_mfma_f32_16x16x32_bf16 v[52:55], v[236:239], v[116:119], v[52:55]
    ds_read_b64_tr_b16 v[226:227], v4 offset:26368
    s_waitcnt lgkmcnt(4)
    v_mfma_f32_16x16x32_bf16 v[56:59], v[240:243], v[112:115], v[56:59]
    ds_read_b64_tr_b16 v[228:229], v5 offset:25376
    v_mfma_f32_16x16x32_bf16 v[60:63], v[240:243], v[116:119], v[60:63]
    ds_read_b64_tr_b16 v[230:231], v5 offset:26400
    s_waitcnt lgkmcnt(4)
    v_mfma_f32_16x16x32_bf16 v[64:67], v[244:247], v[112:115], v[64:67]
    v_mfma_f32_16x16x32_bf16 v[68:71], v[244:247], v[116:119], v[68:71]
    s_waitcnt vmcnt(9)
    s_barrier
    ds_read_b64_tr_b16 v[232:233], v4 offset:32768
    ds_read_b64_tr_b16 v[234:235], v4 offset:33792
    s_waitcnt lgkmcnt(4)
    v_mfma_f32_16x16x32_bf16 v[72:75], v[224:227], v[112:115], v[72:75]
    ds_read_b64_tr_b16 v[236:237], v5 offset:32800
    v_mfma_f32_16x16x32_bf16 v[76:79], v[224:227], v[116:119], v[76:79]
    ds_read_b64_tr_b16 v[238:239], v5 offset:33824
    s_waitcnt lgkmcnt(4)
    v_mfma_f32_16x16x32_bf16 v[80:83], v[228:231], v[112:115], v[80:83]
    ds_read_b64_tr_b16 v[240:241], v4 offset:33024
    v_mfma_f32_16x16x32_bf16 v[84:87], v[228:231], v[116:119], v[84:87]
    ds_read_b64_tr_b16 v[242:243], v4 offset:34048
    s_waitcnt lgkmcnt(4)
    v_mfma_f32_16x16x32_bf16 v[24:27], v[232:235], v[120:123], v[24:27]
    ds_read_b64_tr_b16 v[244:245], v5 offset:33056
    v_mfma_f32_16x16x32_bf16 v[28:31], v[232:235], v[124:127], v[28:31]
    ds_read_b64_tr_b16 v[246:247], v5 offset:34080
    s_waitcnt lgkmcnt(4)
    v_mfma_f32_16x16x32_bf16 v[32:35], v[236:239], v[120:123], v[32:35]
    ds_read_b64_tr_b16 v[224:225], v4 offset:33280
    v_mfma_f32_16x16x32_bf16 v[36:39], v[236:239], v[124:127], v[36:39]
    ds_read_b64_tr_b16 v[226:227], v4 offset:34304
    s_waitcnt lgkmcnt(4)
    v_mfma_f32_16x16x32_bf16 v[40:43], v[240:243], v[120:123], v[40:43]
    ds_read_b64_tr_b16 v[228:229], v5 offset:33312
    v_mfma_f32_16x16x32_bf16 v[44:47], v[240:243], v[124:127], v[44:47]
    ds_read_b64_tr_b16 v[230:231], v5 offset:34336
    s_waitcnt lgkmcnt(4)
    v_mfma_f32_16x16x32_bf16 v[48:51], v[244:247], v[120:123], v[48:51]
    ds_read_b64_tr_b16 v[232:233], v4 offset:33536
    v_mfma_f32_16x16x32_bf16 v[52:55], v[244:247], v[124:127], v[52:55]
    ds_read_b64_tr_b16 v[234:235], v4 offset:34560
    s_waitcnt lgkmcnt(4)
    v_mfma_f32_16x16x32_bf16 v[56:59], v[224:227], v[120:123], v[56:59]
    ds_read_b64_tr_b16 v[236:237], v5 offset:33568
    v_mfma_f32_16x16x32_bf16 v[60:63], v[224:227], v[124:127], v[60:63]
    ds_read_b64_tr_b16 v[238:239], v5 offset:34592
    s_waitcnt lgkmcnt(4)
    v_mfma_f32_16x16x32_bf16 v[64:67], v[228:231], v[120:123], v[64:67]
    ds_read_b64_tr_b16 v[240:241], v4 offset:40960
    v_mfma_f32_16x16x32_bf16 v[68:71], v[228:231], v[124:127], v[68:71]
    ds_read_b64_tr_b16 v[242:243], v4 offset:41984
    s_waitcnt lgkmcnt(4)
    v_mfma_f32_16x16x32_bf16 v[72:75], v[232:235], v[120:123], v[72:75]
    ds_read_b64_tr_b16 v[244:245], v5 offset:40992
    v_mfma_f32_16x16x32_bf16 v[76:79], v[232:235], v[124:127], v[76:79]
    ds_read_b64_tr_b16 v[246:247], v5 offset:42016
    s_waitcnt lgkmcnt(4)
    v_mfma_f32_16x16x32_bf16 v[80:83], v[236:239], v[120:123], v[80:83]
    ds_read_b64_tr_b16 v[224:225], v4 offset:41216
    v_mfma_f32_16x16x32_bf16 v[84:87], v[236:239], v[124:127], v[84:87]
    ds_read_b64_tr_b16 v[226:227], v4 offset:42240
    s_waitcnt lgkmcnt(4)
    v_mfma_f32_16x16x32_bf16 v[24:27], v[240:243], v[128:131], v[24:27]
    ds_read_b64_tr_b16 v[228:229], v5 offset:41248
    v_mfma_f32_16x16x32_bf16 v[28:31], v[240:243], v[132:135], v[28:31]
    ds_read_b64_tr_b16 v[230:231], v5 offset:42272
    s_waitcnt lgkmcnt(4)
    v_mfma_f32_16x16x32_bf16 v[32:35], v[244:247], v[128:131], v[32:35]
    ds_read_b64_tr_b16 v[232:233], v4 offset:41472
    v_mfma_f32_16x16x32_bf16 v[36:39], v[244:247], v[132:135], v[36:39]
    ds_read_b64_tr_b16 v[234:235], v4 offset:42496
    s_waitcnt lgkmcnt(4)
    v_mfma_f32_16x16x32_bf16 v[40:43], v[224:227], v[128:131], v[40:43]
    ds_read_b64_tr_b16 v[236:237], v5 offset:41504
    v_mfma_f32_16x16x32_bf16 v[44:47], v[224:227], v[132:135], v[44:47]
    ds_read_b64_tr_b16 v[238:239], v5 offset:42528
    s_waitcnt lgkmcnt(4)
    v_mfma_f32_16x16x32_bf16 v[48:51], v[228:231], v[128:131], v[48:51]
    ds_read_b64_tr_b16 v[240:241], v4 offset:41728
    v_mfma_f32_16x16x32_bf16 v[52:55], v[228:231], v[132:135], v[52:55]
    ds_read_b64_tr_b16 v[242:243], v4 offset:42752
    s_waitcnt lgkmcnt(4)
    v_mfma_f32_16x16x32_bf16 v[56:59], v[232:235], v[128:131], v[56:59]
    ds_read_b64_tr_b16 v[244:245], v5 offset:41760
    v_mfma_f32_16x16x32_bf16 v[60:63], v[232:235], v[132:135], v[60:63]
    ds_read_b64_tr_b16 v[246:247], v5 offset:42784
    s_waitcnt lgkmcnt(4)
    v_mfma_f32_16x16x32_bf16 v[64:67], v[236:239], v[128:131], v[64:67]
    v_mfma_f32_16x16x32_bf16 v[68:71], v[236:239], v[132:135], v[68:71]
    s_waitcnt vmcnt(2)
    s_barrier
    ds_read_b64_tr_b16 v[224:225], v4 offset:49152
    ds_read_b64_tr_b16 v[226:227], v4 offset:50176
    s_waitcnt lgkmcnt(4)
    v_mfma_f32_16x16x32_bf16 v[72:75], v[240:243], v[128:131], v[72:75]
    ds_read_b64_tr_b16 v[228:229], v5 offset:49184
    v_mfma_f32_16x16x32_bf16 v[76:79], v[240:243], v[132:135], v[76:79]
    ds_read_b64_tr_b16 v[230:231], v5 offset:50208
    s_waitcnt lgkmcnt(4)
    v_mfma_f32_16x16x32_bf16 v[80:83], v[244:247], v[128:131], v[80:83]
    ds_read_b64_tr_b16 v[232:233], v4 offset:49408
    v_mfma_f32_16x16x32_bf16 v[84:87], v[244:247], v[132:135], v[84:87]
    ds_read_b64_tr_b16 v[234:235], v4 offset:50432
    s_waitcnt lgkmcnt(4)
    v_mfma_f32_16x16x32_bf16 v[24:27], v[224:227], v[136:139], v[24:27]
    ds_read_b64_tr_b16 v[236:237], v5 offset:49440
    v_mfma_f32_16x16x32_bf16 v[28:31], v[224:227], v[140:143], v[28:31]
    ds_read_b64_tr_b16 v[238:239], v5 offset:50464
    s_waitcnt lgkmcnt(4)
    v_mfma_f32_16x16x32_bf16 v[32:35], v[228:231], v[136:139], v[32:35]
    ds_read_b64_tr_b16 v[240:241], v4 offset:49664
    v_mfma_f32_16x16x32_bf16 v[36:39], v[228:231], v[140:143], v[36:39]
    ds_read_b64_tr_b16 v[242:243], v4 offset:50688
    s_waitcnt lgkmcnt(4)
    v_mfma_f32_16x16x32_bf16 v[40:43], v[232:235], v[136:139], v[40:43]
    ds_read_b64_tr_b16 v[244:245], v5 offset:49696
    v_mfma_f32_16x16x32_bf16 v[44:47], v[232:235], v[140:143], v[44:47]
    ds_read_b64_tr_b16 v[246:247], v5 offset:50720
    s_waitcnt lgkmcnt(4)
    v_mfma_f32_16x16x32_bf16 v[48:51], v[236:239], v[136:139], v[48:51]
    ds_read_b64_tr_b16 v[224:225], v4 offset:49920
    v_mfma_f32_16x16x32_bf16 v[52:55], v[236:239], v[140:143], v[52:55]
    ds_read_b64_tr_b16 v[226:227], v4 offset:50944
    s_waitcnt lgkmcnt(4)
    v_mfma_f32_16x16x32_bf16 v[56:59], v[240:243], v[136:139], v[56:59]
    ds_read_b64_tr_b16 v[228:229], v5 offset:49952
    v_mfma_f32_16x16x32_bf16 v[60:63], v[240:243], v[140:143], v[60:63]
    ds_read_b64_tr_b16 v[230:231], v5 offset:50976
    s_waitcnt lgkmcnt(4)
    v_mfma_f32_16x16x32_bf16 v[64:67], v[244:247], v[136:139], v[64:67]
    ds_read_b64_tr_b16 v[232:233], v4 offset:57344
    v_mfma_f32_16x16x32_bf16 v[68:71], v[244:247], v[140:143], v[68:71]
    ds_read_b64_tr_b16 v[234:235], v4 offset:58368
    s_waitcnt lgkmcnt(4)
    v_mfma_f32_16x16x32_bf16 v[72:75], v[224:227], v[136:139], v[72:75]
    ds_read_b64_tr_b16 v[236:237], v5 offset:57376
    v_mfma_f32_16x16x32_bf16 v[76:79], v[224:227], v[140:143], v[76:79]
    ds_read_b64_tr_b16 v[238:239], v5 offset:58400
    s_waitcnt lgkmcnt(4)
    v_mfma_f32_16x16x32_bf16 v[80:83], v[228:231], v[136:139], v[80:83]
    ds_read_b64_tr_b16 v[240:241], v4 offset:57600
    v_mfma_f32_16x16x32_bf16 v[84:87], v[228:231], v[140:143], v[84:87]
    ds_read_b64_tr_b16 v[242:243], v4 offset:58624
    s_waitcnt lgkmcnt(4)
    v_mfma_f32_16x16x32_bf16 v[24:27], v[232:235], v[144:147], v[24:27]
    ds_read_b64_tr_b16 v[244:245], v5 offset:57632
    v_mfma_f32_16x16x32_bf16 v[28:31], v[232:235], v[148:151], v[28:31]
    ds_read_b64_tr_b16 v[246:247], v5 offset:58656
    s_waitcnt lgkmcnt(4)
    v_mfma_f32_16x16x32_bf16 v[32:35], v[236:239], v[144:147], v[32:35]
    ds_read_b64_tr_b16 v[224:225], v4 offset:57856
    v_mfma_f32_16x16x32_bf16 v[36:39], v[236:239], v[148:151], v[36:39]
    ds_read_b64_tr_b16 v[226:227], v4 offset:58880
    s_waitcnt lgkmcnt(4)
    v_mfma_f32_16x16x32_bf16 v[40:43], v[240:243], v[144:147], v[40:43]
    ds_read_b64_tr_b16 v[228:229], v5 offset:57888
    v_mfma_f32_16x16x32_bf16 v[44:47], v[240:243], v[148:151], v[44:47]
    ds_read_b64_tr_b16 v[230:231], v5 offset:58912
    s_waitcnt lgkmcnt(4)
    v_mfma_f32_16x16x32_bf16 v[48:51], v[244:247], v[144:147], v[48:51]
    ds_read_b64_tr_b16 v[232:233], v4 offset:58112
    v_mfma_f32_16x16x32_bf16 v[52:55], v[244:247], v[148:151], v[52:55]
    ds_read_b64_tr_b16 v[234:235], v4 offset:59136
    s_waitcnt lgkmcnt(4)
    v_mfma_f32_16x16x32_bf16 v[56:59], v[224:227], v[144:147], v[56:59]
    ds_read_b64_tr_b16 v[236:237], v5 offset:58144
    v_mfma_f32_16x16x32_bf16 v[60:63], v[224:227], v[148:151], v[60:63]
    ds_read_b64_tr_b16 v[238:239], v5 offset:59168
    s_waitcnt lgkmcnt(4)
    v_mfma_f32_16x16x32_bf16 v[64:67], v[228:231], v[144:147], v[64:67]
    v_mfma_f32_16x16x32_bf16 v[68:71], v[228:231], v[148:151], v[68:71]
    s_waitcnt lgkmcnt(2)
    v_mfma_f32_16x16x32_bf16 v[72:75], v[232:235], v[144:147], v[72:75]
    v_mfma_f32_16x16x32_bf16 v[76:79], v[232:235], v[148:151], v[76:79]
    s_waitcnt lgkmcnt(0)
    v_mfma_f32_16x16x32_bf16 v[80:83], v[236:239], v[144:147], v[80:83]
    v_mfma_f32_16x16x32_bf16 v[84:87], v[236:239], v[148:151], v[84:87]
    s_mov_b32 s23, 0x3e0293ee
    v_mul_f32 v24, s23, v24
    v_mul_f32 v25, s23, v25
    v_mul_f32 v26, s23, v26
    v_mul_f32 v27, s23, v27
    v_mul_f32 v28, s23, v28
    v_mul_f32 v29, s23, v29
    v_mul_f32 v30, s23, v30
    v_mul_f32 v31, s23, v31
    v_mul_f32 v32, s23, v32
    v_mul_f32 v33, s23, v33
    v_mul_f32 v34, s23, v34
    v_mul_f32 v35, s23, v35
    v_mul_f32 v36, s23, v36
    v_mul_f32 v37, s23, v37
    v_mul_f32 v38, s23, v38
    v_mul_f32 v39, s23, v39
    v_cvt_pk_bf16_f32 v152, v24, v25
    v_cvt_pk_bf16_f32 v153, v26, v27
    v_cvt_pk_bf16_f32 v168, v28, v29
    v_cvt_pk_bf16_f32 v169, v30, v31
    v_cvt_pk_bf16_f32 v154, v32, v33
    v_cvt_pk_bf16_f32 v155, v34, v35
    v_cvt_pk_bf16_f32 v170, v36, v37
    v_cvt_pk_bf16_f32 v171, v38, v39
    v_add_u32 v4, 0x10000, v2
    v_add_u32 v5, 0x20000, v2
    s_barrier
    ds_read_b128 v[224:227], v4 offset:0
    ds_read_b128 v[228:231], v4 offset:1024
    ds_read_b128 v[232:235], v4 offset:2048
    ds_read_b128 v[236:239], v4 offset:3072
    v_mov_b32 v12, 0x3f803f80
    v_mov_b32 v13, 0x3f803f80
    v_mov_b32 v14, 0x3f803f80
    v_mov_b32 v15, 0x3f803f80
    s_waitcnt lgkmcnt(3)
    v_mfma_f32_16x16x32_bf16 v[184:187], v[224:227], v[152:155], 0
    v_mul_f32 v40, s23, v40
    v_mul_f32 v41, s23, v41
    v_mul_f32 v42, s23, v42
    v_mul_f32 v43, s23, v43
    v_mul_f32 v44, s23, v44
    v_mul_f32 v45, s23, v45
    v_mfma_f32_16x16x32_bf16 v[188:191], v[224:227], v[168:171], 0
    ds_read_b128 v[240:243], v4 offset:4096
    v_mul_f32 v46, s23, v46
    v_mul_f32 v47, s23, v47
    v_mul_f32 v48, s23, v48
    v_mul_f32 v49, s23, v49
    v_mul_f32 v50, s23, v50
    v_mul_f32 v51, s23, v51
    s_and_b32 s29, s2, 7
    s_mul_i32 s29, s29, 28
    s_lshr_b32 s16, s2, 3
    s_add_u32 s29, s29, s16
    s_waitcnt lgkmcnt(3)
    v_mfma_f32_16x16x32_bf16 v[192:195], v[228:231], v[152:155], 0
    s_add_u32 s22, s21, 0x10000
    s_add_u32 m0, s20, 0x20000
    s_nop 0
    buffer_load_dwordx4 v2, s[8:11], s22 offen sc1 lds
    v_mul_f32 v52, s23, v52
    v_mul_f32 v53, s23, v53
    v_mul_f32 v54, s23, v54
    v_mul_f32 v55, s23, v55
    v_cvt_pk_bf16_f32 v156, v40, v41
    v_cvt_pk_bf16_f32 v157, v42, v43
    s_mov_b64 s[76:77], s[54:55]
    s_mov_b32 s78, 0xc00000
    s_mov_b32 s79, 0x20000
    v_bfe_u32 v20, v1, 2, 2
    v_lshlrev_b32 v20, 12, v20
    v_add_u32 v6, v3, v20
    s_lshr_b32 s16, s2, 5
    s_lshl_b32 s16, s16, 7
    s_lshl_b32 s17, s3, 3
    s_add_u32 s16, s16, s17
    s_mul_i32 s14, s16, 12288
    s_and_b32 s16, s2, 31
    s_lshl_b32 s16, s16, 8
    s_add_u32 s14, s14, s16
    s_add_u32 s14, s14, 4096
    v_mfma_f32_16x16x32_bf16 v[196:199], v[228:231], v[168:171], 0
    ds_read_b128 v[244:247], v4 offset:5120
    v_cvt_pk_bf16_f32 v172, v44, v45
    v_cvt_pk_bf16_f32 v173, v46, v47
    v_cvt_pk_bf16_f32 v158, v48, v49
    v_cvt_pk_bf16_f32 v159, v50, v51
    v_cvt_pk_bf16_f32 v174, v52, v53
    v_cvt_pk_bf16_f32 v175, v54, v55
    s_waitcnt lgkmcnt(3)
    v_mfma_f32_16x16x32_bf16 v[184:187], v[232:235], v[156:159], v[184:187]
    v_mul_f32 v56, s23, v56
    v_mul_f32 v57, s23, v57
    v_mul_f32 v58, s23, v58
    v_mul_f32 v59, s23, v59
    v_mul_f32 v60, s23, v60
    v_mul_f32 v61, s23, v61
    v_mfma_f32_16x16x32_bf16 v[188:191], v[232:235], v[172:175], v[188:191]
    ds_read_b128 v[224:227], v4 offset:6144
    v_mul_f32 v62, s23, v62
    v_mul_f32 v63, s23, v63
    v_mul_f32 v64, s23, v64
    v_mul_f32 v65, s23, v65
    v_mul_f32 v66, s23, v66
    v_mul_f32 v67, s23, v67
    s_waitcnt lgkmcnt(3)
    v_mfma_f32_16x16x32_bf16 v[192:195], v[236:239], v[156:159], v[192:195]
    v_mul_f32 v68, s23, v68
    v_mul_f32 v69, s23, v69
    v_mul_f32 v70, s23, v70
    v_mul_f32 v71, s23, v71
    v_cvt_pk_bf16_f32 v160, v56, v57
    v_cvt_pk_bf16_f32 v161, v58, v59
    v_mfma_f32_16x16x32_bf16 v[196:199], v[236:239], v[172:175], v[196:199]
    ds_read_b128 v[228:231], v4 offset:7168
    v_cvt_pk_bf16_f32 v176, v60, v61
    v_cvt_pk_bf16_f32 v177, v62, v63
    v_cvt_pk_bf16_f32 v162, v64, v65
    v_cvt_pk_bf16_f32 v163, v66, v67
    v_cvt_pk_bf16_f32 v178, v68, v69
    v_cvt_pk_bf16_f32 v179, v70, v71
    s_waitcnt lgkmcnt(3)
    v_mfma_f32_16x16x32_bf16 v[184:187], v[240:243], v[160:163], v[184:187]
    v_mul_f32 v72, s23, v72
    v_mul_f32 v73, s23, v73
    v_mul_f32 v74, s23, v74
    v_mul_f32 v75, s23, v75
    v_mul_f32 v76, s23, v76
    v_mul_f32 v77, s23, v77
    v_mfma_f32_16x16x32_bf16 v[188:191], v[240:243], v[176:179], v[188:191]
    ds_read_b128 v[232:235], v4 offset:8192
    v_mul_f32 v78, s23, v78
    v_mul_f32 v79, s23, v79
    v_mul_f32 v80, s23, v80
    v_mul_f32 v81, s23, v81
    v_mul_f32 v82, s23, v82
    v_mul_f32 v83, s23, v83
    s_waitcnt lgkmcnt(3)
    v_mfma_f32_16x16x32_bf16 v[192:195], v[244:247], v[160:163], v[192:195]
    s_add_u32 s22, s21, 0x10400
    s_add_u32 m0, s20, 0x20400
    s_nop 0
    buffer_load_dwordx4 v2, s[8:11], s22 offen sc1 lds
    v_mul_f32 v84, s23, v84
    v_mul_f32 v85, s23, v85
    v_mul_f32 v86, s23, v86
    v_mul_f32 v87, s23, v87
    v_cvt_pk_bf16_f32 v164, v72, v73
    v_cvt_pk_bf16_f32 v165, v74, v75
    v_mfma_f32_16x16x32_bf16 v[196:199], v[244:247], v[176:179], v[196:199]
    ds_read_b128 v[236:239], v4 offset:9216
    v_cvt_pk_bf16_f32 v180, v76, v77
    v_cvt_pk_bf16_f32 v181, v78, v79
    v_cvt_pk_bf16_f32 v166, v80, v81
    v_cvt_pk_bf16_f32 v167, v82, v83
    v_cvt_pk_bf16_f32 v182, v84, v85
    v_cvt_pk_bf16_f32 v183, v86, v87
    s_waitcnt lgkmcnt(3)
    v_mfma_f32_16x16x32_bf16 v[184:187], v[224:227], v[164:167], v[184:187]
    v_mfma_f32_16x16x32_bf16 v[188:191], v[224:227], v[180:183], v[188:191]
    ds_read_b128 v[240:243], v4 offset:10240
    s_waitcnt lgkmcnt(3)
    v_mfma_f32_16x16x32_bf16 v[192:195], v[228:231], v[164:167], v[192:195]
    v_mfma_f32_16x16x32_bf16 v[196:199], v[228:231], v[180:183], v[196:199]
    ds_read_b128 v[244:247], v4 offset:11264
    s_waitcnt lgkmcnt(3)
    v_mfma_f32_16x16x32_bf16 v[200:203], v[232:235], v[152:155], 0
    v_mfma_f32_16x16x32_bf16 v[204:207], v[232:235], v[168:171], 0
    ds_read_b128 v[224:227], v4 offset:12288
    s_waitcnt lgkmcnt(3)
    v_mfma_f32_16x16x32_bf16 v[208:211], v[236:239], v[152:155], 0
    v_mfma_f32_16x16x32_bf16 v[212:215], v[236:239], v[168:171], 0
    ds_read_b128 v[228:231], v4 offset:13312
    s_waitcnt lgkmcnt(3)
    v_mfma_f32_16x16x32_bf16 v[200:203], v[240:243], v[156:159], v[200:203]
    v_mfma_f32_16x16x32_bf16 v[204:207], v[240:243], v[172:175], v[204:207]
    ds_read_b128 v[232:235], v4 offset:14336
    s_waitcnt lgkmcnt(3)
    v_mfma_f32_16x16x32_bf16 v[208:211], v[244:247], v[156:159], v[208:211]
    v_max3_f32 v16, v184, v185, v186
    v_mfma_f32_16x16x32_bf16 v[212:215], v[244:247], v[172:175], v[212:215]
    ds_read_b128 v[236:239], v4 offset:15360
    v_max3_f32 v16, v16, v187, v192
    s_waitcnt lgkmcnt(3)
    v_mfma_f32_16x16x32_bf16 v[200:203], v[224:227], v[160:163], v[200:203]
    v_max3_f32 v16, v16, v193, v194
    v_mfma_f32_16x16x32_bf16 v[204:207], v[224:227], v[176:179], v[204:207]
    s_barrier
    ds_read_b128 v[240:243], v4 offset:16384
    v_max_f32 v16, v16, v195
    s_waitcnt lgkmcnt(3)
    v_mfma_f32_16x16x32_bf16 v[208:211], v[228:231], v[160:163], v[208:211]
    v_max3_f32 v17, v188, v189, v190
    v_mfma_f32_16x16x32_bf16 v[212:215], v[228:231], v[176:179], v[212:215]
    s_add_u32 s22, s21, 0x14000
    s_add_u32 m0, s20, 0x24000
    s_nop 0
    buffer_load_dwordx4 v2, s[8:11], s22 offen sc1 lds
    ds_read_b128 v[244:247], v4 offset:17408
    v_max3_f32 v17, v17, v191, v196
    s_waitcnt lgkmcnt(3)
    v_mfma_f32_16x16x32_bf16 v[200:203], v[232:235], v[164:167], v[200:203]
    v_max3_f32 v17, v17, v197, v198
    v_mfma_f32_16x16x32_bf16 v[204:207], v[232:235], v[180:183], v[204:207]
    ds_read_b128 v[224:227], v4 offset:18432
    v_max_f32 v17, v17, v199
    s_waitcnt lgkmcnt(3)
    v_mfma_f32_16x16x32_bf16 v[208:211], v[236:239], v[164:167], v[208:211]
    v_mfma_f32_16x16x32_bf16 v[212:215], v[236:239], v[180:183], v[212:215]
    ds_read_b128 v[228:231], v4 offset:19456
    v_max3_f32 v16, v16, v200, v201
    v_max3_f32 v16, v16, v202, v203
    s_nop 3
    v_max3_f32 v16, v16, v208, v209
    v_max3_f32 v16, v16, v210, v211
    v_max3_f32 v17, v17, v204, v205
    v_max3_f32 v17, v17, v206, v207
    v_max3_f32 v17, v17, v212, v213
    v_max3_f32 v17, v17, v214, v215
    v_mov_b32 v18, v16
    v_mov_b32 v19, v17
    s_nop 0
    v_permlane16_swap_b32 v16, v18
    v_permlane16_swap_b32 v17, v19
    v_max_f32 v16, v16, v18
    v_max_f32 v17, v17, v19
    v_mov_b32 v18, v16
    v_mov_b32 v19, v17
    s_nop 0
    v_permlane32_swap_b32 v16, v18
    v_permlane32_swap_b32 v17, v19
    v_max_f32 v16, v16, v18
    v_max_f32 v17, v17, v19
    v_sub_f32 v216, 0, v16
    v_sub_f32 v217, 0, v16
    v_sub_f32 v218, 0, v16
    v_sub_f32 v219, 0, v16
    v_sub_f32 v220, 0, v17
    v_sub_f32 v221, 0, v17
    v_sub_f32 v222, 0, v17
    v_sub_f32 v223, 0, v17
    v_add_f32 v184, v184, v216
    v_add_f32 v185, v185, v216
    v_exp_f32 v184, v184
    v_exp_f32 v185, v185
    v_add_f32 v186, v186, v216
    v_add_f32 v187, v187, v216
    v_exp_f32 v186, v186
    v_exp_f32 v187, v187
    v_cvt_pk_bf16_f32 v24, v184, v185
    v_add_f32 v188, v188, v220
    v_add_f32 v189, v189, v220
    v_exp_f32 v188, v188
    v_exp_f32 v189, v189
    v_cvt_pk_bf16_f32 v25, v186, v187
    v_add_f32 v190, v190, v220
    v_add_f32 v191, v191, v220
    v_exp_f32 v190, v190
    v_exp_f32 v191, v191
    v_cvt_pk_bf16_f32 v28, v188, v189
    v_add_f32 v192, v192, v216
    v_add_f32 v193, v193, v216
    v_exp_f32 v192, v192
    v_exp_f32 v193, v193
    v_cvt_pk_bf16_f32 v29, v190, v191
    v_add_f32 v194, v194, v216
    v_add_f32 v195, v195, v216
    v_exp_f32 v194, v194
    v_exp_f32 v195, v195
    v_cvt_pk_bf16_f32 v26, v192, v193
    v_add_f32 v196, v196, v220
    v_add_f32 v197, v197, v220
    v_exp_f32 v196, v196
    v_exp_f32 v197, v197
    v_cvt_pk_bf16_f32 v27, v194, v195
    v_add_f32 v198, v198, v220
    v_add_f32 v199, v199, v220
    v_exp_f32 v198, v198
    v_exp_f32 v199, v199
    v_cvt_pk_bf16_f32 v30, v196, v197
    v_cvt_pk_bf16_f32 v31, v198, v199
    s_waitcnt lgkmcnt(3)
    v_mfma_f32_16x16x32_bf16 v[184:187], v[240:243], v[152:155], v[216:219]
    v_mfma_f32_16x16x32_bf16 v[188:191], v[240:243], v[168:171], v[220:223]
    ds_read_b128 v[232:235], v4 offset:20480
    v_add_f32 v200, v200, v216
    v_add_f32 v201, v201, v216
    v_exp_f32 v200, v200
    v_mfma_f32_16x16x32_bf16 v[248:251], v[12:15], v[24:27], 0
    s_waitcnt lgkmcnt(3)
    v_mfma_f32_16x16x32_bf16 v[192:195], v[244:247], v[152:155], v[216:219]
    v_exp_f32 v201, v201
    v_add_f32 v202, v202, v216
    v_add_f32 v203, v203, v216
    v_mfma_f32_16x16x32_bf16 v[196:199], v[244:247], v[168:171], v[220:223]
    s_add_u32 s22, s21, 0x14400
    s_add_u32 m0, s20, 0x24400
    s_nop 0
    buffer_load_dwordx4 v2, s[8:11], s22 offen sc1 lds
    ds_read_b128 v[236:239], v4 offset:21504
    v_exp_f32 v202, v202
    v_exp_f32 v203, v203
    v_mfma_f32_16x16x32_bf16 v[252:255], v[12:15], v[28:31], 0
    s_waitcnt lgkmcnt(3)
    v_mfma_f32_16x16x32_bf16 v[184:187], v[224:227], v[156:159], v[184:187]
    v_cvt_pk_bf16_f32 v32, v200, v201
    v_add_f32 v204, v204, v220
    v_add_f32 v205, v205, v220
    v_mfma_f32_16x16x32_bf16 v[188:191], v[224:227], v[172:175], v[188:191]
    ds_read_b128 v[240:243], v4 offset:22528
    v_exp_f32 v204, v204
    v_exp_f32 v205, v205
    v_cvt_pk_bf16_f32 v33, v202, v203
    s_mov_b64 s[4:5], s[40:41]
    s_mov_b32 s6, 0x800000
    s_mov_b32 s7, 0x20000
    v_bfe_u32 v20, v1, 2, 2
    v_lshlrev_b32 v21, 13, v20
    v_sub_u32 v3, v3, v21
    v_lshl_add_u32 v3, v20, 11, v3
    s_and_b32 s16, s2, 1
    s_lshl_b32 s24, s16, 22
    s_lshr_b32 s16, s2, 5
    s_lshl_b32 s16, s16, 8
    s_add_u32 s24, s24, s16
    s_lshl_b32 s16, s3, 14
    s_add_u32 s24, s24, s16
    s_waitcnt lgkmcnt(3)
    v_mfma_f32_16x16x32_bf16 v[192:195], v[228:231], v[156:159], v[192:195]
    v_add_f32 v206, v206, v220
    v_add_f32 v207, v207, v220
    v_mfma_f32_16x16x32_bf16 v[196:199], v[228:231], v[172:175], v[196:199]
    ds_read_b128 v[244:247], v4 offset:23552
    v_exp_f32 v206, v206
    v_exp_f32 v207, v207
    v_cvt_pk_bf16_f32 v36, v204, v205
    s_waitcnt lgkmcnt(3)
    v_mfma_f32_16x16x32_bf16 v[184:187], v[232:235], v[160:163], v[184:187]
    v_add_f32 v208, v208, v216
    v_add_f32 v209, v209, v216
    v_exp_f32 v208, v208
    v_mfma_f32_16x16x32_bf16 v[188:191], v[232:235], v[176:179], v[188:191]
    ds_read_b128 v[224:227], v4 offset:24576
    v_exp_f32 v209, v209
    v_cvt_pk_bf16_f32 v37, v206, v207
    s_waitcnt lgkmcnt(3)
    v_mfma_f32_16x16x32_bf16 v[192:195], v[236:239], v[160:163], v[192:195]
    v_add_f32 v210, v210, v216
    v_add_f32 v211, v211, v216
    v_exp_f32 v210, v210
    v_mfma_f32_16x16x32_bf16 v[196:199], v[236:239], v[176:179], v[196:199]
    ds_read_b128 v[228:231], v4 offset:25600
    v_exp_f32 v211, v211
    v_cvt_pk_bf16_f32 v34, v208, v209
    v_add_f32 v212, v212, v220
    s_waitcnt lgkmcnt(3)
    v_mfma_f32_16x16x32_bf16 v[184:187], v[240:243], v[164:167], v[184:187]
    v_add_f32 v213, v213, v220
    v_exp_f32 v212, v212
    v_mfma_f32_16x16x32_bf16 v[188:191], v[240:243], v[180:183], v[188:191]
    ds_read_b128 v[232:235], v4 offset:26624
    v_exp_f32 v213, v213
    v_cvt_pk_bf16_f32 v35, v210, v211
    v_add_f32 v214, v214, v220
    s_waitcnt lgkmcnt(3)
    v_mfma_f32_16x16x32_bf16 v[192:195], v[244:247], v[164:167], v[192:195]
    v_add_f32 v215, v215, v220
    v_exp_f32 v214, v214
    v_exp_f32 v215, v215
    v_mfma_f32_16x16x32_bf16 v[196:199], v[244:247], v[180:183], v[196:199]
    ds_read_b128 v[236:239], v4 offset:27648
    v_cvt_pk_bf16_f32 v38, v212, v213
    v_cvt_pk_bf16_f32 v39, v214, v215
    s_waitcnt lgkmcnt(3)
    v_mfma_f32_16x16x32_bf16 v[200:203], v[224:227], v[152:155], v[216:219]
    v_mfma_f32_16x16x32_bf16 v[204:207], v[224:227], v[168:171], v[220:223]
    ds_read_b128 v[240:243], v4 offset:28672
    v_exp_f32 v184, v184
    v_exp_f32 v185, v185
    v_mfma_f32_16x16x32_bf16 v[248:251], v[12:15], v[32:35], v[248:251]
    s_waitcnt lgkmcnt(3)
    v_mfma_f32_16x16x32_bf16 v[208:211], v[228:231], v[152:155], v[216:219]
    v_exp_f32 v186, v186
    v_exp_f32 v187, v187
    v_mfma_f32_16x16x32_bf16 v[212:215], v[228:231], v[168:171], v[220:223]
    ds_read_b128 v[244:247], v4 offset:29696
    v_cvt_pk_bf16_f32 v40, v184, v185
    v_mfma_f32_16x16x32_bf16 v[252:255], v[12:15], v[36:39], v[252:255]
    s_waitcnt lgkmcnt(3)
    v_mfma_f32_16x16x32_bf16 v[200:203], v[232:235], v[156:159], v[200:203]
    v_exp_f32 v188, v188
    v_exp_f32 v189, v189
    v_mfma_f32_16x16x32_bf16 v[204:207], v[232:235], v[172:175], v[204:207]
    ds_read_b128 v[224:227], v4 offset:30720
    v_cvt_pk_bf16_f32 v41, v186, v187
    s_waitcnt lgkmcnt(3)
    v_mfma_f32_16x16x32_bf16 v[208:211], v[236:239], v[156:159], v[208:211]
    v_exp_f32 v190, v190
    v_exp_f32 v191, v191
    v_mfma_f32_16x16x32_bf16 v[212:215], v[236:239], v[172:175], v[212:215]
    ds_read_b128 v[228:231], v4 offset:31744
    v_cvt_pk_bf16_f32 v44, v188, v189
    v_exp_f32 v192, v192
    s_waitcnt lgkmcnt(3)
    v_mfma_f32_16x16x32_bf16 v[200:203], v[240:243], v[160:163], v[200:203]
    v_exp_f32 v193, v193
    v_mfma_f32_16x16x32_bf16 v[204:207], v[240:243], v[176:179], v[204:207]
    s_barrier
    ds_read_b128 v[232:235], v4 offset:32768
    v_cvt_pk_bf16_f32 v45, v190, v191
    v_exp_f32 v194, v194
    s_waitcnt lgkmcnt(3)
    v_mfma_f32_16x16x32_bf16 v[208:211], v[244:247], v[160:163], v[208:211]
    v_exp_f32 v195, v195
    v_mfma_f32_16x16x32_bf16 v[212:215], v[244:247], v[176:179], v[212:215]
    s_add_u32 s22, s21, 0x18000
    s_add_u32 m0, s20, 0x10000
    s_nop 0
    buffer_load_dwordx4 v2, s[8:11], s22 offen sc1 lds
    ds_read_b128 v[236:239], v4 offset:33792
    v_cvt_pk_bf16_f32 v42, v192, v193
    v_exp_f32 v196, v196
    s_waitcnt lgkmcnt(3)
    v_mfma_f32_16x16x32_bf16 v[200:203], v[224:227], v[164:167], v[200:203]
    v_exp_f32 v197, v197
    v_cvt_pk_bf16_f32 v43, v194, v195
    v_mfma_f32_16x16x32_bf16 v[204:207], v[224:227], v[180:183], v[204:207]
    ds_read_b128 v[240:243], v4 offset:34816
    v_exp_f32 v198, v198
    s_waitcnt lgkmcnt(3)
    v_mfma_f32_16x16x32_bf16 v[208:211], v[228:231], v[164:167], v[208:211]
    v_exp_f32 v199, v199
    v_cvt_pk_bf16_f32 v46, v196, v197
    v_mfma_f32_16x16x32_bf16 v[212:215], v[228:231], v[180:183], v[212:215]
    ds_read_b128 v[244:247], v4 offset:35840
    v_cvt_pk_bf16_f32 v47, v198, v199
    s_waitcnt lgkmcnt(3)
    v_mfma_f32_16x16x32_bf16 v[184:187], v[232:235], v[152:155], v[216:219]
    v_mfma_f32_16x16x32_bf16 v[188:191], v[232:235], v[168:171], v[220:223]
    ds_read_b128 v[224:227], v4 offset:36864
    v_exp_f32 v200, v200
    v_exp_f32 v201, v201
    v_mfma_f32_16x16x32_bf16 v[248:251], v[12:15], v[40:43], v[248:251]
    s_waitcnt lgkmcnt(3)
    v_mfma_f32_16x16x32_bf16 v[192:195], v[236:239], v[152:155], v[216:219]
    v_exp_f32 v202, v202
    v_exp_f32 v203, v203
    v_mfma_f32_16x16x32_bf16 v[196:199], v[236:239], v[168:171], v[220:223]
    s_add_u32 s22, s21, 0x18400
    s_add_u32 m0, s20, 0x10400
    s_nop 0
    buffer_load_dwordx4 v2, s[8:11], s22 offen sc1 lds
    ds_read_b128 v[228:231], v4 offset:37888
    v_cvt_pk_bf16_f32 v48, v200, v201
    v_mfma_f32_16x16x32_bf16 v[252:255], v[12:15], v[44:47], v[252:255]
    s_waitcnt lgkmcnt(3)
    v_mfma_f32_16x16x32_bf16 v[184:187], v[240:243], v[156:159], v[184:187]
    v_exp_f32 v204, v204
    v_exp_f32 v205, v205
    v_mfma_f32_16x16x32_bf16 v[188:191], v[240:243], v[172:175], v[188:191]
    ds_read_b128 v[232:235], v4 offset:38912
    v_cvt_pk_bf16_f32 v49, v202, v203
    s_waitcnt lgkmcnt(3)
    v_mfma_f32_16x16x32_bf16 v[192:195], v[244:247], v[156:159], v[192:195]
    v_exp_f32 v206, v206
    v_exp_f32 v207, v207
    v_mfma_f32_16x16x32_bf16 v[196:199], v[244:247], v[172:175], v[196:199]
    ds_read_b128 v[236:239], v4 offset:39936
    v_cvt_pk_bf16_f32 v52, v204, v205
    v_exp_f32 v208, v208
    s_waitcnt lgkmcnt(3)
    v_mfma_f32_16x16x32_bf16 v[184:187], v[224:227], v[160:163], v[184:187]
    v_exp_f32 v209, v209
    v_mfma_f32_16x16x32_bf16 v[188:191], v[224:227], v[176:179], v[188:191]
    ds_read_b128 v[240:243], v4 offset:40960
    v_cvt_pk_bf16_f32 v53, v206, v207
    v_exp_f32 v210, v210
    s_waitcnt lgkmcnt(3)
    v_mfma_f32_16x16x32_bf16 v[192:195], v[228:231], v[160:163], v[192:195]
    v_exp_f32 v211, v211
    v_mfma_f32_16x16x32_bf16 v[196:199], v[228:231], v[176:179], v[196:199]
    ds_read_b128 v[244:247], v4 offset:41984
    v_cvt_pk_bf16_f32 v50, v208, v209
    v_exp_f32 v212, v212
    s_waitcnt lgkmcnt(3)
    v_mfma_f32_16x16x32_bf16 v[184:187], v[232:235], v[164:167], v[184:187]
    v_exp_f32 v213, v213
    v_cvt_pk_bf16_f32 v51, v210, v211
    v_mfma_f32_16x16x32_bf16 v[188:191], v[232:235], v[180:183], v[188:191]
    ds_read_b128 v[224:227], v4 offset:43008
    v_exp_f32 v214, v214
    s_waitcnt lgkmcnt(3)
    v_mfma_f32_16x16x32_bf16 v[192:195], v[236:239], v[164:167], v[192:195]
    v_exp_f32 v215, v215
    v_cvt_pk_bf16_f32 v54, v212, v213
    v_mfma_f32_16x16x32_bf16 v[196:199], v[236:239], v[180:183], v[196:199]
    ds_read_b128 v[228:231], v4 offset:44032
    v_cvt_pk_bf16_f32 v55, v214, v215
    s_waitcnt lgkmcnt(3)
    v_mfma_f32_16x16x32_bf16 v[200:203], v[240:243], v[152:155], v[216:219]
    v_mfma_f32_16x16x32_bf16 v[204:207], v[240:243], v[168:171], v[220:223]
    ds_read_b128 v[232:235], v4 offset:45056
    v_exp_f32 v184, v184
    v_exp_f32 v185, v185
    v_mfma_f32_16x16x32_bf16 v[248:251], v[12:15], v[48:51], v[248:251]
    s_waitcnt lgkmcnt(3)
    v_mfma_f32_16x16x32_bf16 v[208:211], v[244:247], v[152:155], v[216:219]
    v_exp_f32 v186, v186
    v_exp_f32 v187, v187
    v_mfma_f32_16x16x32_bf16 v[212:215], v[244:247], v[168:171], v[220:223]
    ds_read_b128 v[236:239], v4 offset:46080
    v_cvt_pk_bf16_f32 v56, v184, v185
    v_mfma_f32_16x16x32_bf16 v[252:255], v[12:15], v[52:55], v[252:255]
    s_waitcnt lgkmcnt(3)
    v_mfma_f32_16x16x32_bf16 v[200:203], v[224:227], v[156:159], v[200:203]
    v_exp_f32 v188, v188
    v_exp_f32 v189, v189
    v_mfma_f32_16x16x32_bf16 v[204:207], v[224:227], v[172:175], v[204:207]
    ds_read_b128 v[240:243], v4 offset:47104
    v_cvt_pk_bf16_f32 v57, v186, v187
    s_waitcnt lgkmcnt(3)
    v_mfma_f32_16x16x32_bf16 v[208:211], v[228:231], v[156:159], v[208:211]
    v_exp_f32 v190, v190
    v_exp_f32 v191, v191
    v_mfma_f32_16x16x32_bf16 v[212:215], v[228:231], v[172:175], v[212:215]
    ds_read_b128 v[244:247], v4 offset:48128
    v_cvt_pk_bf16_f32 v60, v188, v189
    v_exp_f32 v192, v192
    s_waitcnt lgkmcnt(3)
    v_mfma_f32_16x16x32_bf16 v[200:203], v[232:235], v[160:163], v[200:203]
    v_exp_f32 v193, v193
    v_mfma_f32_16x16x32_bf16 v[204:207], v[232:235], v[176:179], v[204:207]
    s_waitcnt vmcnt(6)
    s_barrier
    ds_read_b128 v[224:227], v4 offset:49152
    v_cvt_pk_bf16_f32 v61, v190, v191
    v_exp_f32 v194, v194
    s_waitcnt lgkmcnt(3)
    v_mfma_f32_16x16x32_bf16 v[208:211], v[236:239], v[160:163], v[208:211]
    v_exp_f32 v195, v195
    v_mfma_f32_16x16x32_bf16 v[212:215], v[236:239], v[176:179], v[212:215]
    s_add_u32 s22, s21, 0x1c000
    s_add_u32 m0, s20, 0x14000
    s_nop 0
    buffer_load_dwordx4 v2, s[8:11], s22 offen sc1 lds
    ds_read_b128 v[228:231], v4 offset:50176
    v_cvt_pk_bf16_f32 v58, v192, v193
    v_exp_f32 v196, v196
    s_waitcnt lgkmcnt(3)
    v_mfma_f32_16x16x32_bf16 v[200:203], v[240:243], v[164:167], v[200:203]
    v_exp_f32 v197, v197
    v_cvt_pk_bf16_f32 v59, v194, v195
    v_mfma_f32_16x16x32_bf16 v[204:207], v[240:243], v[180:183], v[204:207]
    ds_read_b128 v[232:235], v4 offset:51200
    v_exp_f32 v198, v198
    s_waitcnt lgkmcnt(3)
    v_mfma_f32_16x16x32_bf16 v[208:211], v[244:247], v[164:167], v[208:211]
    v_exp_f32 v199, v199
    v_cvt_pk_bf16_f32 v62, v196, v197
    v_mfma_f32_16x16x32_bf16 v[212:215], v[244:247], v[180:183], v[212:215]
    ds_read_b128 v[236:239], v4 offset:52224
    v_cvt_pk_bf16_f32 v63, v198, v199
    s_waitcnt lgkmcnt(3)
    v_mfma_f32_16x16x32_bf16 v[184:187], v[224:227], v[152:155], v[216:219]
    v_mfma_f32_16x16x32_bf16 v[188:191], v[224:227], v[168:171], v[220:223]
    ds_read_b128 v[240:243], v4 offset:53248
    v_exp_f32 v200, v200
    v_exp_f32 v201, v201
    v_mfma_f32_16x16x32_bf16 v[248:251], v[12:15], v[56:59], v[248:251]
    s_waitcnt lgkmcnt(3)
    v_mfma_f32_16x16x32_bf16 v[192:195], v[228:231], v[152:155], v[216:219]
    v_exp_f32 v202, v202
    v_exp_f32 v203, v203
    v_mfma_f32_16x16x32_bf16 v[196:199], v[228:231], v[168:171], v[220:223]
    s_add_u32 s22, s21, 0x1c400
    s_add_u32 m0, s20, 0x14400
    s_nop 0
    buffer_load_dwordx4 v2, s[8:11], s22 offen sc1 lds
    ds_read_b128 v[244:247], v4 offset:54272
    v_cvt_pk_bf16_f32 v64, v200, v201
    v_mfma_f32_16x16x32_bf16 v[252:255], v[12:15], v[60:63], v[252:255]
    s_waitcnt lgkmcnt(3)
    v_mfma_f32_16x16x32_bf16 v[184:187], v[232:235], v[156:159], v[184:187]
    v_exp_f32 v204, v204
    v_exp_f32 v205, v205
    v_mfma_f32_16x16x32_bf16 v[188:191], v[232:235], v[172:175], v[188:191]
    ds_read_b128 v[224:227], v4 offset:55296
    v_cvt_pk_bf16_f32 v65, v202, v203
    s_waitcnt lgkmcnt(3)
    v_mfma_f32_16x16x32_bf16 v[192:195], v[236:239], v[156:159], v[192:195]
    v_exp_f32 v206, v206
    v_exp_f32 v207, v207
    v_mfma_f32_16x16x32_bf16 v[196:199], v[236:239], v[172:175], v[196:199]
    ds_read_b128 v[228:231], v4 offset:56320
    v_cvt_pk_bf16_f32 v68, v204, v205
    v_exp_f32 v208, v208
    s_waitcnt lgkmcnt(3)
    v_mfma_f32_16x16x32_bf16 v[184:187], v[240:243], v[160:163], v[184:187]
    v_exp_f32 v209, v209
    v_mfma_f32_16x16x32_bf16 v[188:191], v[240:243], v[176:179], v[188:191]
    ds_read_b128 v[232:235], v4 offset:57344
    v_cvt_pk_bf16_f32 v69, v206, v207
    v_exp_f32 v210, v210
    s_waitcnt lgkmcnt(3)
    v_mfma_f32_16x16x32_bf16 v[192:195], v[244:247], v[160:163], v[192:195]
    v_exp_f32 v211, v211
    v_mfma_f32_16x16x32_bf16 v[196:199], v[244:247], v[176:179], v[196:199]
    ds_read_b128 v[236:239], v4 offset:58368
    v_cvt_pk_bf16_f32 v66, v208, v209
    v_exp_f32 v212, v212
    s_waitcnt lgkmcnt(3)
    v_mfma_f32_16x16x32_bf16 v[184:187], v[224:227], v[164:167], v[184:187]
    v_exp_f32 v213, v213
    v_cvt_pk_bf16_f32 v67, v210, v211
    v_mfma_f32_16x16x32_bf16 v[188:191], v[224:227], v[180:183], v[188:191]
    ds_read_b128 v[240:243], v4 offset:59392
    v_exp_f32 v214, v214
    s_waitcnt lgkmcnt(3)
    v_mfma_f32_16x16x32_bf16 v[192:195], v[228:231], v[164:167], v[192:195]
    v_exp_f32 v215, v215
    v_cvt_pk_bf16_f32 v70, v212, v213
    v_mfma_f32_16x16x32_bf16 v[196:199], v[228:231], v[180:183], v[196:199]
    ds_read_b128 v[244:247], v4 offset:60416
    v_cvt_pk_bf16_f32 v71, v214, v215
    s_waitcnt lgkmcnt(3)
    v_mfma_f32_16x16x32_bf16 v[200:203], v[232:235], v[152:155], v[216:219]
    v_mfma_f32_16x16x32_bf16 v[204:207], v[232:235], v[168:171], v[220:223]
    ds_read_b128 v[224:227], v4 offset:61440
    v_exp_f32 v184, v184
    v_exp_f32 v185, v185
    v_mfma_f32_16x16x32_bf16 v[248:251], v[12:15], v[64:67], v[248:251]
    s_waitcnt lgkmcnt(3)
    v_mfma_f32_16x16x32_bf16 v[208:211], v[236:239], v[152:155], v[216:219]
    v_exp_f32 v186, v186
    v_exp_f32 v187, v187
    v_mfma_f32_16x16x32_bf16 v[212:215], v[236:239], v[168:171], v[220:223]
    ds_read_b128 v[228:231], v4 offset:62464
    v_cvt_pk_bf16_f32 v72, v184, v185
    v_mfma_f32_16x16x32_bf16 v[252:255], v[12:15], v[68:71], v[252:255]
    s_waitcnt lgkmcnt(3)
    v_mfma_f32_16x16x32_bf16 v[200:203], v[240:243], v[156:159], v[200:203]
    v_exp_f32 v188, v188
    v_exp_f32 v189, v189
    v_mfma_f32_16x16x32_bf16 v[204:207], v[240:243], v[172:175], v[204:207]
    ds_read_b128 v[232:235], v4 offset:63488
    v_cvt_pk_bf16_f32 v73, v186, v187
    s_waitcnt lgkmcnt(3)
    v_mfma_f32_16x16x32_bf16 v[208:211], v[244:247], v[156:159], v[208:211]
    v_exp_f32 v190, v190
    v_exp_f32 v191, v191
    v_mfma_f32_16x16x32_bf16 v[212:215], v[244:247], v[172:175], v[212:215]
    ds_read_b128 v[236:239], v4 offset:64512
    v_cvt_pk_bf16_f32 v76, v188, v189
    v_exp_f32 v192, v192
    s_waitcnt lgkmcnt(3)
    v_mfma_f32_16x16x32_bf16 v[200:203], v[224:227], v[160:163], v[200:203]
    v_exp_f32 v193, v193
    v_mfma_f32_16x16x32_bf16 v[204:207], v[224:227], v[176:179], v[204:207]
    s_waitcnt vmcnt(6)
    s_barrier
    ds_read_b128 v[240:243], v5 offset:0
    v_cvt_pk_bf16_f32 v77, v190, v191
    v_exp_f32 v194, v194
    s_waitcnt lgkmcnt(3)
    v_mfma_f32_16x16x32_bf16 v[208:211], v[228:231], v[160:163], v[208:211]
    v_exp_f32 v195, v195
    v_mfma_f32_16x16x32_bf16 v[212:215], v[228:231], v[176:179], v[212:215]
    s_add_u32 s22, s21, 0x80000
    s_add_u32 m0, s20, 0x18000
    s_nop 0
    buffer_load_dwordx4 v2, s[8:11], s22 offen sc1 lds
    ds_read_b128 v[244:247], v5 offset:1024
    v_cvt_pk_bf16_f32 v74, v192, v193
    v_exp_f32 v196, v196
    s_waitcnt lgkmcnt(3)
    v_mfma_f32_16x16x32_bf16 v[200:203], v[232:235], v[164:167], v[200:203]
    v_exp_f32 v197, v197
    v_cvt_pk_bf16_f32 v75, v194, v195
    v_mfma_f32_16x16x32_bf16 v[204:207], v[232:235], v[180:183], v[204:207]
    ds_read_b128 v[224:227], v5 offset:2048
    v_exp_f32 v198, v198
    s_waitcnt lgkmcnt(3)
    v_mfma_f32_16x16x32_bf16 v[208:211], v[236:239], v[164:167], v[208:211]
    v_exp_f32 v199, v199
    v_cvt_pk_bf16_f32 v78, v196, v197
    v_mfma_f32_16x16x32_bf16 v[212:215], v[236:239], v[180:183], v[212:215]
    ds_read_b128 v[228:231], v5 offset:3072
    v_cvt_pk_bf16_f32 v79, v198, v199
    s_waitcnt lgkmcnt(3)
    v_mfma_f32_16x16x32_bf16 v[184:187], v[240:243], v[152:155], v[216:219]
    v_mfma_f32_16x16x32_bf16 v[188:191], v[240:243], v[168:171], v[220:223]
    ds_read_b128 v[232:235], v5 offset:4096
    v_exp_f32 v200, v200
    v_exp_f32 v201, v201
    v_mfma_f32_16x16x32_bf16 v[248:251], v[12:15], v[72:75], v[248:251]
    s_waitcnt lgkmcnt(3)
    v_mfma_f32_16x16x32_bf16 v[192:195], v[244:247], v[152:155], v[216:219]
    v_exp_f32 v202, v202
    v_exp_f32 v203, v203
    v_mfma_f32_16x16x32_bf16 v[196:199], v[244:247], v[168:171], v[220:223]
    s_add_u32 s22, s21, 0x80400
    s_add_u32 m0, s20, 0x18400
    s_nop 0
    buffer_load_dwordx4 v2, s[8:11], s22 offen sc1 lds
    ds_read_b128 v[236:239], v5 offset:5120
    v_cvt_pk_bf16_f32 v80, v200, v201
    v_mfma_f32_16x16x32_bf16 v[252:255], v[12:15], v[76:79], v[252:255]
    s_waitcnt lgkmcnt(3)
    v_mfma_f32_16x16x32_bf16 v[184:187], v[224:227], v[156:159], v[184:187]
    v_exp_f32 v204, v204
    v_exp_f32 v205, v205
    v_mfma_f32_16x16x32_bf16 v[188:191], v[224:227], v[172:175], v[188:191]
    ds_read_b128 v[240:243], v5 offset:6144
    v_cvt_pk_bf16_f32 v81, v202, v203
    s_waitcnt lgkmcnt(3)
    v_mfma_f32_16x16x32_bf16 v[192:195], v[228:231], v[156:159], v[192:195]
    v_exp_f32 v206, v206
    v_exp_f32 v207, v207
    v_mfma_f32_16x16x32_bf16 v[196:199], v[228:231], v[172:175], v[196:199]
    ds_read_b128 v[244:247], v5 offset:7168
    v_cvt_pk_bf16_f32 v84, v204, v205
    v_exp_f32 v208, v208
    s_waitcnt lgkmcnt(3)
    v_mfma_f32_16x16x32_bf16 v[184:187], v[232:235], v[160:163], v[184:187]
    v_exp_f32 v209, v209
    v_mfma_f32_16x16x32_bf16 v[188:191], v[232:235], v[176:179], v[188:191]
    ds_read_b128 v[224:227], v5 offset:8192
    v_cvt_pk_bf16_f32 v85, v206, v207
    v_exp_f32 v210, v210
    s_waitcnt lgkmcnt(3)
    v_mfma_f32_16x16x32_bf16 v[192:195], v[236:239], v[160:163], v[192:195]
    v_exp_f32 v211, v211
    v_mfma_f32_16x16x32_bf16 v[196:199], v[236:239], v[176:179], v[196:199]
    ds_read_b128 v[228:231], v5 offset:9216
    v_cvt_pk_bf16_f32 v82, v208, v209
    v_exp_f32 v212, v212
    s_waitcnt lgkmcnt(3)
    v_mfma_f32_16x16x32_bf16 v[184:187], v[240:243], v[164:167], v[184:187]
    v_exp_f32 v213, v213
    v_cvt_pk_bf16_f32 v83, v210, v211
    v_mfma_f32_16x16x32_bf16 v[188:191], v[240:243], v[180:183], v[188:191]
    ds_read_b128 v[232:235], v5 offset:10240
    v_exp_f32 v214, v214
    s_waitcnt lgkmcnt(3)
    v_mfma_f32_16x16x32_bf16 v[192:195], v[244:247], v[164:167], v[192:195]
    v_exp_f32 v215, v215
    v_cvt_pk_bf16_f32 v86, v212, v213
    v_mfma_f32_16x16x32_bf16 v[196:199], v[244:247], v[180:183], v[196:199]
    ds_read_b128 v[236:239], v5 offset:11264
    v_cvt_pk_bf16_f32 v87, v214, v215
    s_waitcnt lgkmcnt(3)
    v_mfma_f32_16x16x32_bf16 v[200:203], v[224:227], v[152:155], v[216:219]
    v_mfma_f32_16x16x32_bf16 v[204:207], v[224:227], v[168:171], v[220:223]
    ds_read_b128 v[240:243], v5 offset:12288
    v_exp_f32 v184, v184
    v_exp_f32 v185, v185
    v_mfma_f32_16x16x32_bf16 v[248:251], v[12:15], v[80:83], v[248:251]
    s_waitcnt lgkmcnt(3)
    v_mfma_f32_16x16x32_bf16 v[208:211], v[228:231], v[152:155], v[216:219]
    v_exp_f32 v186, v186
    v_exp_f32 v187, v187
    v_mfma_f32_16x16x32_bf16 v[212:215], v[228:231], v[168:171], v[220:223]
    ds_read_b128 v[244:247], v5 offset:13312
    v_cvt_pk_bf16_f32 v88, v184, v185
    v_mfma_f32_16x16x32_bf16 v[252:255], v[12:15], v[84:87], v[252:255]
    s_waitcnt lgkmcnt(3)
    v_mfma_f32_16x16x32_bf16 v[200:203], v[232:235], v[156:159], v[200:203]
    v_exp_f32 v188, v188
    v_exp_f32 v189, v189
    v_mfma_f32_16x16x32_bf16 v[204:207], v[232:235], v[172:175], v[204:207]
    ds_read_b128 v[224:227], v5 offset:14336
    v_cvt_pk_bf16_f32 v89, v186, v187
    s_waitcnt lgkmcnt(3)
    v_mfma_f32_16x16x32_bf16 v[208:211], v[236:239], v[156:159], v[208:211]
    v_exp_f32 v190, v190
    v_exp_f32 v191, v191
    v_mfma_f32_16x16x32_bf16 v[212:215], v[236:239], v[172:175], v[212:215]
    ds_read_b128 v[228:231], v5 offset:15360
    v_cvt_pk_bf16_f32 v92, v188, v189
    v_exp_f32 v192, v192
    s_waitcnt lgkmcnt(3)
    v_mfma_f32_16x16x32_bf16 v[200:203], v[240:243], v[160:163], v[200:203]
    v_exp_f32 v193, v193
    v_mfma_f32_16x16x32_bf16 v[204:207], v[240:243], v[176:179], v[204:207]
    s_waitcnt vmcnt(6)
    s_barrier
    ds_read_b128 v[232:235], v5 offset:16384
    v_cvt_pk_bf16_f32 v93, v190, v191
    v_exp_f32 v194, v194
    s_waitcnt lgkmcnt(3)
    v_mfma_f32_16x16x32_bf16 v[208:211], v[244:247], v[160:163], v[208:211]
    v_exp_f32 v195, v195
    v_mfma_f32_16x16x32_bf16 v[212:215], v[244:247], v[176:179], v[212:215]
    s_add_u32 s22, s21, 0x84000
    s_add_u32 m0, s20, 0x1c000
    s_nop 0
    buffer_load_dwordx4 v2, s[8:11], s22 offen sc1 lds
    ds_read_b128 v[236:239], v5 offset:17408
    v_cvt_pk_bf16_f32 v90, v192, v193
    v_exp_f32 v196, v196
    s_waitcnt lgkmcnt(3)
    v_mfma_f32_16x16x32_bf16 v[200:203], v[224:227], v[164:167], v[200:203]
    v_exp_f32 v197, v197
    v_cvt_pk_bf16_f32 v91, v194, v195
    v_mfma_f32_16x16x32_bf16 v[204:207], v[224:227], v[180:183], v[204:207]
    ds_read_b128 v[240:243], v5 offset:18432
    v_exp_f32 v198, v198
    s_waitcnt lgkmcnt(3)
    v_mfma_f32_16x16x32_bf16 v[208:211], v[228:231], v[164:167], v[208:211]
    v_exp_f32 v199, v199
    v_cvt_pk_bf16_f32 v94, v196, v197
    v_mfma_f32_16x16x32_bf16 v[212:215], v[228:231], v[180:183], v[212:215]
    ds_read_b128 v[244:247], v5 offset:19456
    v_cvt_pk_bf16_f32 v95, v198, v199
    s_waitcnt lgkmcnt(3)
    v_mfma_f32_16x16x32_bf16 v[184:187], v[232:235], v[152:155], v[216:219]
    v_mfma_f32_16x16x32_bf16 v[188:191], v[232:235], v[168:171], v[220:223]
    ds_read_b128 v[224:227], v5 offset:20480
    v_exp_f32 v200, v200
    v_exp_f32 v201, v201
    v_mfma_f32_16x16x32_bf16 v[248:251], v[12:15], v[88:91], v[248:251]
    s_waitcnt lgkmcnt(3)
    v_mfma_f32_16x16x32_bf16 v[192:195], v[236:239], v[152:155], v[216:219]
    v_exp_f32 v202, v202
    v_exp_f32 v203, v203
    v_mfma_f32_16x16x32_bf16 v[196:199], v[236:239], v[168:171], v[220:223]
    s_add_u32 s22, s21, 0x84400
    s_add_u32 m0, s20, 0x1c400
    s_nop 0
    buffer_load_dwordx4 v2, s[8:11], s22 offen sc1 lds
    ds_read_b128 v[228:231], v5 offset:21504
    v_cvt_pk_bf16_f32 v96, v200, v201
    v_mfma_f32_16x16x32_bf16 v[252:255], v[12:15], v[92:95], v[252:255]
    s_waitcnt lgkmcnt(3)
    v_mfma_f32_16x16x32_bf16 v[184:187], v[240:243], v[156:159], v[184:187]
    v_exp_f32 v204, v204
    v_exp_f32 v205, v205
    v_mfma_f32_16x16x32_bf16 v[188:191], v[240:243], v[172:175], v[188:191]
    ds_read_b128 v[232:235], v5 offset:22528
    v_cvt_pk_bf16_f32 v97, v202, v203
    s_waitcnt lgkmcnt(3)
    v_mfma_f32_16x16x32_bf16 v[192:195], v[244:247], v[156:159], v[192:195]
    v_exp_f32 v206, v206
    v_exp_f32 v207, v207
    v_mfma_f32_16x16x32_bf16 v[196:199], v[244:247], v[172:175], v[196:199]
    ds_read_b128 v[236:239], v5 offset:23552
    v_cvt_pk_bf16_f32 v100, v204, v205
    v_exp_f32 v208, v208
    s_waitcnt lgkmcnt(3)
    v_mfma_f32_16x16x32_bf16 v[184:187], v[224:227], v[160:163], v[184:187]
    v_exp_f32 v209, v209
    v_mfma_f32_16x16x32_bf16 v[188:191], v[224:227], v[176:179], v[188:191]
    ds_read_b128 v[240:243], v5 offset:24576
    v_cvt_pk_bf16_f32 v101, v206, v207
    v_exp_f32 v210, v210
    s_waitcnt lgkmcnt(3)
    v_mfma_f32_16x16x32_bf16 v[192:195], v[228:231], v[160:163], v[192:195]
    v_exp_f32 v211, v211
    v_mfma_f32_16x16x32_bf16 v[196:199], v[228:231], v[176:179], v[196:199]
    ds_read_b128 v[244:247], v5 offset:25600
    v_cvt_pk_bf16_f32 v98, v208, v209
    v_exp_f32 v212, v212
    s_waitcnt lgkmcnt(3)
    v_mfma_f32_16x16x32_bf16 v[184:187], v[232:235], v[164:167], v[184:187]
    v_exp_f32 v213, v213
    v_cvt_pk_bf16_f32 v99, v210, v211
    v_mfma_f32_16x16x32_bf16 v[188:191], v[232:235], v[180:183], v[188:191]
    ds_read_b128 v[224:227], v5 offset:26624
    v_exp_f32 v214, v214
    s_waitcnt lgkmcnt(3)
    v_mfma_f32_16x16x32_bf16 v[192:195], v[236:239], v[164:167], v[192:195]
    v_exp_f32 v215, v215
    v_cvt_pk_bf16_f32 v102, v212, v213
    v_mfma_f32_16x16x32_bf16 v[196:199], v[236:239], v[180:183], v[196:199]
    ds_read_b128 v[228:231], v5 offset:27648
    v_cvt_pk_bf16_f32 v103, v214, v215
    s_waitcnt lgkmcnt(3)
    v_mfma_f32_16x16x32_bf16 v[200:203], v[240:243], v[152:155], v[216:219]
    v_mfma_f32_16x16x32_bf16 v[204:207], v[240:243], v[168:171], v[220:223]
    ds_read_b128 v[232:235], v5 offset:28672
    v_exp_f32 v184, v184
    v_exp_f32 v185, v185
    v_mfma_f32_16x16x32_bf16 v[248:251], v[12:15], v[96:99], v[248:251]
    s_waitcnt lgkmcnt(3)
    v_mfma_f32_16x16x32_bf16 v[208:211], v[244:247], v[152:155], v[216:219]
    v_exp_f32 v186, v186
    v_exp_f32 v187, v187
    v_mfma_f32_16x16x32_bf16 v[212:215], v[244:247], v[168:171], v[220:223]
    ds_read_b128 v[236:239], v5 offset:29696
    v_cvt_pk_bf16_f32 v104, v184, v185
    v_mfma_f32_16x16x32_bf16 v[252:255], v[12:15], v[100:103], v[252:255]
    s_waitcnt lgkmcnt(3)
    v_mfma_f32_16x16x32_bf16 v[200:203], v[224:227], v[156:159], v[200:203]
    v_exp_f32 v188, v188
    v_exp_f32 v189, v189
    v_mfma_f32_16x16x32_bf16 v[204:207], v[224:227], v[172:175], v[204:207]
    ds_read_b128 v[240:243], v5 offset:30720
    v_cvt_pk_bf16_f32 v105, v186, v187
    s_waitcnt lgkmcnt(3)
    v_mfma_f32_16x16x32_bf16 v[208:211], v[228:231], v[156:159], v[208:211]
    v_exp_f32 v190, v190
    v_exp_f32 v191, v191
    v_mfma_f32_16x16x32_bf16 v[212:215], v[228:231], v[172:175], v[212:215]
    ds_read_b128 v[244:247], v5 offset:31744
    v_cvt_pk_bf16_f32 v108, v188, v189
    v_exp_f32 v192, v192
    s_waitcnt lgkmcnt(3)
    v_mfma_f32_16x16x32_bf16 v[200:203], v[232:235], v[160:163], v[200:203]
    v_exp_f32 v193, v193
    v_mfma_f32_16x16x32_bf16 v[204:207], v[232:235], v[176:179], v[204:207]
    s_waitcnt vmcnt(6)
    s_barrier
    ds_read_b128 v[224:227], v4 offset:0
    v_cvt_pk_bf16_f32 v109, v190, v191
    v_exp_f32 v194, v194
    s_waitcnt lgkmcnt(3)
    v_mfma_f32_16x16x32_bf16 v[208:211], v[236:239], v[160:163], v[208:211]
    v_exp_f32 v195, v195
    v_mfma_f32_16x16x32_bf16 v[212:215], v[236:239], v[176:179], v[212:215]
    s_add_u32 s22, s21, 0x88000
    s_add_u32 m0, s20, 0x20000
    s_nop 0
    buffer_load_dwordx4 v2, s[8:11], s22 offen sc1 lds
    ds_read_b128 v[228:231], v4 offset:1024
    v_cvt_pk_bf16_f32 v106, v192, v193
    v_exp_f32 v196, v196
    s_waitcnt lgkmcnt(3)
    v_mfma_f32_16x16x32_bf16 v[200:203], v[240:243], v[164:167], v[200:203]
    v_exp_f32 v197, v197
    v_cvt_pk_bf16_f32 v107, v194, v195
    v_mfma_f32_16x16x32_bf16 v[204:207], v[240:243], v[180:183], v[204:207]
    ds_read_b128 v[232:235], v4 offset:2048
    v_exp_f32 v198, v198
    s_waitcnt lgkmcnt(3)
    v_mfma_f32_16x16x32_bf16 v[208:211], v[244:247], v[164:167], v[208:211]
    v_exp_f32 v199, v199
    v_cvt_pk_bf16_f32 v110, v196, v197
    v_mfma_f32_16x16x32_bf16 v[212:215], v[244:247], v[180:183], v[212:215]
    ds_read_b128 v[236:239], v4 offset:3072
    v_cvt_pk_bf16_f32 v111, v198, v199
    s_waitcnt lgkmcnt(3)
    v_mfma_f32_16x16x32_bf16 v[184:187], v[224:227], v[152:155], v[216:219]
    v_mfma_f32_16x16x32_bf16 v[188:191], v[224:227], v[168:171], v[220:223]
    ds_read_b128 v[240:243], v4 offset:4096
    v_exp_f32 v200, v200
    v_exp_f32 v201, v201
    v_mfma_f32_16x16x32_bf16 v[248:251], v[12:15], v[104:107], v[248:251]
    s_waitcnt lgkmcnt(3)
    v_mfma_f32_16x16x32_bf16 v[192:195], v[228:231], v[152:155], v[216:219]
    v_exp_f32 v202, v202
    v_exp_f32 v203, v203
    v_mfma_f32_16x16x32_bf16 v[196:199], v[228:231], v[168:171], v[220:223]
    s_add_u32 s22, s21, 0x88400
    s_add_u32 m0, s20, 0x20400
    s_nop 0
    buffer_load_dwordx4 v2, s[8:11], s22 offen sc1 lds
    ds_read_b128 v[244:247], v4 offset:5120
    v_cvt_pk_bf16_f32 v112, v200, v201
    v_mfma_f32_16x16x32_bf16 v[252:255], v[12:15], v[108:111], v[252:255]
    s_waitcnt lgkmcnt(3)
    v_mfma_f32_16x16x32_bf16 v[184:187], v[232:235], v[156:159], v[184:187]
    v_exp_f32 v204, v204
    v_exp_f32 v205, v205
    v_mfma_f32_16x16x32_bf16 v[188:191], v[232:235], v[172:175], v[188:191]
    ds_read_b128 v[224:227], v4 offset:6144
    v_cvt_pk_bf16_f32 v113, v202, v203
    s_waitcnt lgkmcnt(3)
    v_mfma_f32_16x16x32_bf16 v[192:195], v[236:239], v[156:159], v[192:195]
    v_exp_f32 v206, v206
    v_exp_f32 v207, v207
    v_mfma_f32_16x16x32_bf16 v[196:199], v[236:239], v[172:175], v[196:199]
    ds_read_b128 v[228:231], v4 offset:7168
    v_cvt_pk_bf16_f32 v116, v204, v205
    v_exp_f32 v208, v208
    s_waitcnt lgkmcnt(3)
    v_mfma_f32_16x16x32_bf16 v[184:187], v[240:243], v[160:163], v[184:187]
    v_exp_f32 v209, v209
    v_mfma_f32_16x16x32_bf16 v[188:191], v[240:243], v[176:179], v[188:191]
    ds_read_b128 v[232:235], v4 offset:8192
    v_cvt_pk_bf16_f32 v117, v206, v207
    v_exp_f32 v210, v210
    s_waitcnt lgkmcnt(3)
    v_mfma_f32_16x16x32_bf16 v[192:195], v[244:247], v[160:163], v[192:195]
    v_exp_f32 v211, v211
    v_mfma_f32_16x16x32_bf16 v[196:199], v[244:247], v[176:179], v[196:199]
    ds_read_b128 v[236:239], v4 offset:9216
    v_cvt_pk_bf16_f32 v114, v208, v209
    v_exp_f32 v212, v212
    s_waitcnt lgkmcnt(3)
    v_mfma_f32_16x16x32_bf16 v[184:187], v[224:227], v[164:167], v[184:187]
    v_exp_f32 v213, v213
    v_cvt_pk_bf16_f32 v115, v210, v211
    v_mfma_f32_16x16x32_bf16 v[188:191], v[224:227], v[180:183], v[188:191]
    ds_read_b128 v[240:243], v4 offset:10240
    v_exp_f32 v214, v214
    s_waitcnt lgkmcnt(3)
    v_mfma_f32_16x16x32_bf16 v[192:195], v[228:231], v[164:167], v[192:195]
    v_exp_f32 v215, v215
    v_cvt_pk_bf16_f32 v118, v212, v213
    v_mfma_f32_16x16x32_bf16 v[196:199], v[228:231], v[180:183], v[196:199]
    ds_read_b128 v[244:247], v4 offset:11264
    v_cvt_pk_bf16_f32 v119, v214, v215
    s_waitcnt lgkmcnt(3)
    v_mfma_f32_16x16x32_bf16 v[200:203], v[232:235], v[152:155], v[216:219]
    v_mfma_f32_16x16x32_bf16 v[204:207], v[232:235], v[168:171], v[220:223]
    ds_read_b128 v[224:227], v4 offset:12288
    v_exp_f32 v184, v184
    v_exp_f32 v185, v185
    v_mfma_f32_16x16x32_bf16 v[248:251], v[12:15], v[112:115], v[248:251]
    s_waitcnt lgkmcnt(3)
    v_mfma_f32_16x16x32_bf16 v[208:211], v[236:239], v[152:155], v[216:219]
    v_exp_f32 v186, v186
    v_exp_f32 v187, v187
    v_mfma_f32_16x16x32_bf16 v[212:215], v[236:239], v[168:171], v[220:223]
    ds_read_b128 v[228:231], v4 offset:13312
    v_cvt_pk_bf16_f32 v120, v184, v185
    v_mfma_f32_16x16x32_bf16 v[252:255], v[12:15], v[116:119], v[252:255]
    s_waitcnt lgkmcnt(3)
    v_mfma_f32_16x16x32_bf16 v[200:203], v[240:243], v[156:159], v[200:203]
    v_exp_f32 v188, v188
    v_exp_f32 v189, v189
    v_mfma_f32_16x16x32_bf16 v[204:207], v[240:243], v[172:175], v[204:207]
    ds_read_b128 v[232:235], v4 offset:14336
    v_cvt_pk_bf16_f32 v121, v186, v187
    s_waitcnt lgkmcnt(3)
    v_mfma_f32_16x16x32_bf16 v[208:211], v[244:247], v[156:159], v[208:211]
    v_exp_f32 v190, v190
    v_exp_f32 v191, v191
    v_mfma_f32_16x16x32_bf16 v[212:215], v[244:247], v[172:175], v[212:215]
    ds_read_b128 v[236:239], v4 offset:15360
    v_cvt_pk_bf16_f32 v124, v188, v189
    v_exp_f32 v192, v192
    s_waitcnt lgkmcnt(3)
    v_mfma_f32_16x16x32_bf16 v[200:203], v[224:227], v[160:163], v[200:203]
    v_exp_f32 v193, v193
    v_mfma_f32_16x16x32_bf16 v[204:207], v[224:227], v[176:179], v[204:207]
    s_waitcnt vmcnt(6)
    s_barrier
    ds_read_b128 v[240:243], v4 offset:16384
    v_cvt_pk_bf16_f32 v125, v190, v191
    v_exp_f32 v194, v194
    s_waitcnt lgkmcnt(3)
    v_mfma_f32_16x16x32_bf16 v[208:211], v[228:231], v[160:163], v[208:211]
    v_exp_f32 v195, v195
    v_mfma_f32_16x16x32_bf16 v[212:215], v[228:231], v[176:179], v[212:215]
    s_add_u32 s22, s21, 0x8c000
    s_add_u32 m0, s20, 0x24000
    s_nop 0
    buffer_load_dwordx4 v2, s[8:11], s22 offen sc1 lds
    ds_read_b128 v[244:247], v4 offset:17408
    v_cvt_pk_bf16_f32 v122, v192, v193
    v_exp_f32 v196, v196
    s_waitcnt lgkmcnt(3)
    v_mfma_f32_16x16x32_bf16 v[200:203], v[232:235], v[164:167], v[200:203]
    v_exp_f32 v197, v197
    v_cvt_pk_bf16_f32 v123, v194, v195
    v_mfma_f32_16x16x32_bf16 v[204:207], v[232:235], v[180:183], v[204:207]
    ds_read_b128 v[224:227], v4 offset:18432
    v_exp_f32 v198, v198
    s_waitcnt lgkmcnt(3)
    v_mfma_f32_16x16x32_bf16 v[208:211], v[236:239], v[164:167], v[208:211]
    v_exp_f32 v199, v199
    v_cvt_pk_bf16_f32 v126, v196, v197
    v_mfma_f32_16x16x32_bf16 v[212:215], v[236:239], v[180:183], v[212:215]
    ds_read_b128 v[228:231], v4 offset:19456
    v_cvt_pk_bf16_f32 v127, v198, v199
    s_waitcnt lgkmcnt(3)
    v_mfma_f32_16x16x32_bf16 v[184:187], v[240:243], v[152:155], v[216:219]
    v_mfma_f32_16x16x32_bf16 v[188:191], v[240:243], v[168:171], v[220:223]
    ds_read_b128 v[232:235], v4 offset:20480
    v_exp_f32 v200, v200
    v_exp_f32 v201, v201
    v_mfma_f32_16x16x32_bf16 v[248:251], v[12:15], v[120:123], v[248:251]
    s_waitcnt lgkmcnt(3)
    v_mfma_f32_16x16x32_bf16 v[192:195], v[244:247], v[152:155], v[216:219]
    v_exp_f32 v202, v202
    v_exp_f32 v203, v203
    v_mfma_f32_16x16x32_bf16 v[196:199], v[244:247], v[168:171], v[220:223]
    s_add_u32 s22, s21, 0x8c400
    s_add_u32 m0, s20, 0x24400
    s_nop 0
    buffer_load_dwordx4 v2, s[8:11], s22 offen sc1 lds
    ds_read_b128 v[236:239], v4 offset:21504
    v_cvt_pk_bf16_f32 v128, v200, v201
    v_mfma_f32_16x16x32_bf16 v[252:255], v[12:15], v[124:127], v[252:255]
    s_waitcnt lgkmcnt(3)
    v_mfma_f32_16x16x32_bf16 v[184:187], v[224:227], v[156:159], v[184:187]
    v_exp_f32 v204, v204
    v_exp_f32 v205, v205
    v_mfma_f32_16x16x32_bf16 v[188:191], v[224:227], v[172:175], v[188:191]
    ds_read_b128 v[240:243], v4 offset:22528
    v_cvt_pk_bf16_f32 v129, v202, v203
    s_waitcnt lgkmcnt(3)
    v_mfma_f32_16x16x32_bf16 v[192:195], v[228:231], v[156:159], v[192:195]
    v_exp_f32 v206, v206
    v_exp_f32 v207, v207
    v_mfma_f32_16x16x32_bf16 v[196:199], v[228:231], v[172:175], v[196:199]
    ds_read_b128 v[244:247], v4 offset:23552
    v_cvt_pk_bf16_f32 v132, v204, v205
    v_exp_f32 v208, v208
    s_waitcnt lgkmcnt(3)
    v_mfma_f32_16x16x32_bf16 v[184:187], v[232:235], v[160:163], v[184:187]
    v_exp_f32 v209, v209
    v_mfma_f32_16x16x32_bf16 v[188:191], v[232:235], v[176:179], v[188:191]
    ds_read_b128 v[224:227], v4 offset:24576
    v_cvt_pk_bf16_f32 v133, v206, v207
    v_exp_f32 v210, v210
    s_waitcnt lgkmcnt(3)
    v_mfma_f32_16x16x32_bf16 v[192:195], v[236:239], v[160:163], v[192:195]
    v_exp_f32 v211, v211
    v_mfma_f32_16x16x32_bf16 v[196:199], v[236:239], v[176:179], v[196:199]
    ds_read_b128 v[228:231], v4 offset:25600
    v_cvt_pk_bf16_f32 v130, v208, v209
    v_exp_f32 v212, v212
    s_waitcnt lgkmcnt(3)
    v_mfma_f32_16x16x32_bf16 v[184:187], v[240:243], v[164:167], v[184:187]
    v_exp_f32 v213, v213
    v_cvt_pk_bf16_f32 v131, v210, v211
    v_mfma_f32_16x16x32_bf16 v[188:191], v[240:243], v[180:183], v[188:191]
    ds_read_b128 v[232:235], v4 offset:26624
    v_exp_f32 v214, v214
    s_waitcnt lgkmcnt(3)
    v_mfma_f32_16x16x32_bf16 v[192:195], v[244:247], v[164:167], v[192:195]
    v_exp_f32 v215, v215
    v_cvt_pk_bf16_f32 v134, v212, v213
    v_mfma_f32_16x16x32_bf16 v[196:199], v[244:247], v[180:183], v[196:199]
    ds_read_b128 v[236:239], v4 offset:27648
    v_cvt_pk_bf16_f32 v135, v214, v215
    s_waitcnt lgkmcnt(3)
    v_mfma_f32_16x16x32_bf16 v[200:203], v[224:227], v[152:155], v[216:219]
    v_mfma_f32_16x16x32_bf16 v[204:207], v[224:227], v[168:171], v[220:223]
    ds_read_b128 v[240:243], v4 offset:28672
    v_exp_f32 v184, v184
    v_exp_f32 v185, v185
    v_mfma_f32_16x16x32_bf16 v[248:251], v[12:15], v[128:131], v[248:251]
    s_waitcnt lgkmcnt(3)
    v_mfma_f32_16x16x32_bf16 v[208:211], v[228:231], v[152:155], v[216:219]
    v_exp_f32 v186, v186
    v_exp_f32 v187, v187
    v_mfma_f32_16x16x32_bf16 v[212:215], v[228:231], v[168:171], v[220:223]
    ds_read_b128 v[244:247], v4 offset:29696
    v_cvt_pk_bf16_f32 v136, v184, v185
    v_mfma_f32_16x16x32_bf16 v[252:255], v[12:15], v[132:135], v[252:255]
    s_waitcnt lgkmcnt(3)
    v_mfma_f32_16x16x32_bf16 v[200:203], v[232:235], v[156:159], v[200:203]
    v_exp_f32 v188, v188
    v_exp_f32 v189, v189
    v_mfma_f32_16x16x32_bf16 v[204:207], v[232:235], v[172:175], v[204:207]
    ds_read_b128 v[224:227], v4 offset:30720
    v_cvt_pk_bf16_f32 v137, v186, v187
    s_waitcnt lgkmcnt(3)
    v_mfma_f32_16x16x32_bf16 v[208:211], v[236:239], v[156:159], v[208:211]
    v_exp_f32 v190, v190
    v_exp_f32 v191, v191
    v_mfma_f32_16x16x32_bf16 v[212:215], v[236:239], v[172:175], v[212:215]
    ds_read_b128 v[228:231], v4 offset:31744
    v_cvt_pk_bf16_f32 v140, v188, v189
    v_exp_f32 v192, v192
    s_waitcnt lgkmcnt(3)
    v_mfma_f32_16x16x32_bf16 v[200:203], v[240:243], v[160:163], v[200:203]
    v_exp_f32 v193, v193
    v_mfma_f32_16x16x32_bf16 v[204:207], v[240:243], v[176:179], v[204:207]
    v_cvt_pk_bf16_f32 v141, v190, v191
    v_exp_f32 v194, v194
    s_waitcnt lgkmcnt(2)
    v_mfma_f32_16x16x32_bf16 v[208:211], v[244:247], v[160:163], v[208:211]
    v_exp_f32 v195, v195
    v_mfma_f32_16x16x32_bf16 v[212:215], v[244:247], v[176:179], v[212:215]
    v_cvt_pk_bf16_f32 v138, v192, v193
    v_exp_f32 v196, v196
    s_waitcnt lgkmcnt(1)
    v_mfma_f32_16x16x32_bf16 v[200:203], v[224:227], v[164:167], v[200:203]
    v_exp_f32 v197, v197
    v_cvt_pk_bf16_f32 v139, v194, v195
    v_mfma_f32_16x16x32_bf16 v[204:207], v[224:227], v[180:183], v[204:207]
    v_exp_f32 v198, v198
    s_waitcnt lgkmcnt(0)
    v_mfma_f32_16x16x32_bf16 v[208:211], v[228:231], v[164:167], v[208:211]
    v_exp_f32 v199, v199
    v_cvt_pk_bf16_f32 v142, v196, v197
    v_mfma_f32_16x16x32_bf16 v[212:215], v[228:231], v[180:183], v[212:215]
    v_cvt_pk_bf16_f32 v143, v198, v199
    s_waitcnt vmcnt(6)
    s_barrier
    ds_read_b128 v[232:235], v4 offset:32768
    ds_read_b128 v[236:239], v4 offset:33792
    ds_read_b128 v[240:243], v4 offset:34816
    ds_read_b128 v[244:247], v4 offset:35840
    v_mfma_f32_16x16x32_bf16 v[248:251], v[12:15], v[136:139], v[248:251]
    v_mfma_f32_16x16x32_bf16 v[252:255], v[12:15], v[140:143], v[252:255]
    v_exp_f32 v200, v200
    v_exp_f32 v201, v201
    v_exp_f32 v202, v202
    v_exp_f32 v203, v203
    v_cvt_pk_bf16_f32 v144, v200, v201
    v_exp_f32 v204, v204
    v_exp_f32 v205, v205
    v_cvt_pk_bf16_f32 v145, v202, v203
    v_exp_f32 v206, v206
    v_exp_f32 v207, v207
    v_cvt_pk_bf16_f32 v148, v204, v205
    v_exp_f32 v208, v208
    v_exp_f32 v209, v209
    v_cvt_pk_bf16_f32 v149, v206, v207
    v_exp_f32 v210, v210
    v_exp_f32 v211, v211
    v_cvt_pk_bf16_f32 v146, v208, v209
    v_exp_f32 v212, v212
    v_exp_f32 v213, v213
    v_cvt_pk_bf16_f32 v147, v210, v211
    v_exp_f32 v214, v214
    v_exp_f32 v215, v215
    v_cvt_pk_bf16_f32 v150, v212, v213
    v_cvt_pk_bf16_f32 v151, v214, v215
    v_mfma_f32_16x16x32_bf16 v[248:251], v[12:15], v[144:147], v[248:251]
    s_nop 0
    v_mfma_f32_16x16x32_bf16 v[252:255], v[12:15], v[148:151], v[252:255]
    s_nop 5
    v_mov_b32 v9, v248
    s_nop 0
    v_mov_b32 v10, v252
    v_max_f32 v17, v9, v10
    v_readfirstlane_b32 s17, v8
    s_cmp_eq_u32 s17, s28
    s_cselect_b32 s16, 0, 0x71800000
    v_cmp_ngt_f32 vcc, s16, v17
    v_cmp_u_f32 s[76:77], v9, v10
    s_or_b64 vcc, vcc, s[76:77]
    s_cbranch_vccnz adaLN_cond__sliding_block_cached__moe_arch_mod__prompt_kernel_fixA
adaLN_cond__sliding_block_cached__moe_arch_mod__prompt_kernel_fixAb:
    v_rcp_f32 v9, v9
    v_rcp_f32 v10, v10
    s_lshl_b32 s25, s13, 3
    s_add_u32 s25, s25, s3
    s_lshl_b32 s25, s25, 18
    s_lshl_b32 s26, s12, 12
    s_add_u32 s25, s25, s26
    s_add_u32 s25, s25, 0x1000000
    s_add_u32 s26, s25, 131072
    s_lshl_b32 s63, s13, 3
    s_add_u32 s63, s63, s3
    s_lshl_b32 s63, s63, 5
    s_add_u32 s63, s63, s12
    s_lshl_b32 s63, s63, 2
    s_waitcnt lgkmcnt(3)
    v_mfma_f32_16x16x32_bf16 v[184:187], v[232:235], v[24:27], 0
    s_mov_b64 s[76:77], s[54:55]
    s_mov_b32 s78, 0xc00000
    s_mov_b32 s79, 0x20000
    v_mfma_f32_16x16x32_bf16 v[188:191], v[232:235], v[28:31], 0
    ds_read_b128 v[224:227], v4 offset:36864
    s_waitcnt lgkmcnt(3)
    v_mfma_f32_16x16x32_bf16 v[192:195], v[236:239], v[24:27], 0
    s_add_u32 s22, s14, 0x0
    s_add_u32 m0, s20, 0x10000
    s_nop 0
    buffer_load_dwordx4 v6, s[76:79], s22 offen lds
    v_mfma_f32_16x16x32_bf16 v[196:199], v[236:239], v[28:31], 0
    ds_read_b128 v[228:231], v4 offset:37888
    s_waitcnt lgkmcnt(3)
    v_mfma_f32_16x16x32_bf16 v[184:187], v[240:243], v[32:35], v[184:187]
    v_mfma_f32_16x16x32_bf16 v[188:191], v[240:243], v[36:39], v[188:191]
    ds_read_b128 v[232:235], v4 offset:38912
    s_waitcnt lgkmcnt(3)
    v_mfma_f32_16x16x32_bf16 v[192:195], v[244:247], v[32:35], v[192:195]
    v_mfma_f32_16x16x32_bf16 v[196:199], v[244:247], v[36:39], v[196:199]
    ds_read_b128 v[236:239], v4 offset:39936
    s_waitcnt lgkmcnt(3)
    v_mfma_f32_16x16x32_bf16 v[184:187], v[224:227], v[40:43], v[184:187]
    v_mfma_f32_16x16x32_bf16 v[188:191], v[224:227], v[44:47], v[188:191]
    ds_read_b128 v[240:243], v4 offset:40960
    s_waitcnt lgkmcnt(3)
    v_mfma_f32_16x16x32_bf16 v[192:195], v[228:231], v[40:43], v[192:195]
    s_add_u32 s22, s14, 0xc000
    s_add_u32 m0, s20, 0x10400
    s_nop 0
    buffer_load_dwordx4 v6, s[76:79], s22 offen lds
    v_mfma_f32_16x16x32_bf16 v[196:199], v[228:231], v[44:47], v[196:199]
    ds_read_b128 v[244:247], v4 offset:41984
    s_waitcnt lgkmcnt(3)
    v_mfma_f32_16x16x32_bf16 v[184:187], v[232:235], v[48:51], v[184:187]
    v_mfma_f32_16x16x32_bf16 v[188:191], v[232:235], v[52:55], v[188:191]
    ds_read_b128 v[224:227], v4 offset:43008
    s_waitcnt lgkmcnt(3)
    v_mfma_f32_16x16x32_bf16 v[192:195], v[236:239], v[48:51], v[192:195]
    v_mfma_f32_16x16x32_bf16 v[196:199], v[236:239], v[52:55], v[196:199]
    ds_read_b128 v[228:231], v4 offset:44032
    s_waitcnt lgkmcnt(3)
    v_mfma_f32_16x16x32_bf16 v[184:187], v[240:243], v[56:59], v[184:187]
    v_mfma_f32_16x16x32_bf16 v[188:191], v[240:243], v[60:63], v[188:191]
    ds_read_b128 v[232:235], v4 offset:45056
    s_waitcnt lgkmcnt(3)
    v_mfma_f32_16x16x32_bf16 v[192:195], v[244:247], v[56:59], v[192:195]
    v_mfma_f32_16x16x32_bf16 v[196:199], v[244:247], v[60:63], v[196:199]
    ds_read_b128 v[236:239], v4 offset:46080
    s_waitcnt lgkmcnt(3)
    v_mfma_f32_16x16x32_bf16 v[184:187], v[224:227], v[64:67], v[184:187]
    v_mfma_f32_16x16x32_bf16 v[188:191], v[224:227], v[68:71], v[188:191]
    ds_read_b128 v[240:243], v4 offset:47104
    s_waitcnt lgkmcnt(3)
    v_mfma_f32_16x16x32_bf16 v[192:195], v[228:231], v[64:67], v[192:195]
    v_mfma_f32_16x16x32_bf16 v[196:199], v[228:231], v[68:71], v[196:199]
    ds_read_b128 v[244:247], v4 offset:48128
    s_waitcnt lgkmcnt(3)
    v_mfma_f32_16x16x32_bf16 v[184:187], v[232:235], v[72:75], v[184:187]
    v_mfma_f32_16x16x32_bf16 v[188:191], v[232:235], v[76:79], v[188:191]
    s_waitcnt vmcnt(6)
    s_barrier
    ds_read_b128 v[224:227], v4 offset:49152
    s_waitcnt lgkmcnt(3)
    v_mfma_f32_16x16x32_bf16 v[192:195], v[236:239], v[72:75], v[192:195]
    v_mfma_f32_16x16x32_bf16 v[196:199], v[236:239], v[76:79], v[196:199]
    s_add_u32 s22, s14, 0xc0000
    s_add_u32 m0, s20, 0x14000
    s_nop 0
    buffer_load_dwordx4 v6, s[76:79], s22 offen lds
    ds_read_b128 v[228:231], v4 offset:50176
    s_waitcnt lgkmcnt(3)
    v_mfma_f32_16x16x32_bf16 v[184:187], v[240:243], v[80:83], v[184:187]
    v_mfma_f32_16x16x32_bf16 v[188:191], v[240:243], v[84:87], v[188:191]
    ds_read_b128 v[232:235], v4 offset:51200
    s_waitcnt lgkmcnt(3)
    v_mfma_f32_16x16x32_bf16 v[192:195], v[244:247], v[80:83], v[192:195]
    v_mfma_f32_16x16x32_bf16 v[196:199], v[244:247], v[84:87], v[196:199]
    ds_read_b128 v[236:239], v4 offset:52224
    s_waitcnt lgkmcnt(3)
    v_mfma_f32_16x16x32_bf16 v[184:187], v[224:227], v[88:91], v[184:187]
    v_mfma_f32_16x16x32_bf16 v[188:191], v[224:227], v[92:95], v[188:191]
    ds_read_b128 v[240:243], v4 offset:53248
    s_waitcnt lgkmcnt(3)
    v_mfma_f32_16x16x32_bf16 v[192:195], v[228:231], v[88:91], v[192:195]
    v_mfma_f32_16x16x32_bf16 v[196:199], v[228:231], v[92:95], v[196:199]
    s_add_u32 s22, s14, 0xcc000
    s_add_u32 m0, s20, 0x14400
    s_nop 0
    buffer_load_dwordx4 v6, s[76:79], s22 offen lds
    ds_read_b128 v[244:247], v4 offset:54272
    s_waitcnt lgkmcnt(3)
    v_mfma_f32_16x16x32_bf16 v[184:187], v[232:235], v[96:99], v[184:187]
    v_mfma_f32_16x16x32_bf16 v[188:191], v[232:235], v[100:103], v[188:191]
    ds_read_b128 v[224:227], v4 offset:55296
    s_waitcnt lgkmcnt(3)
    v_mfma_f32_16x16x32_bf16 v[192:195], v[236:239], v[96:99], v[192:195]
    v_mfma_f32_16x16x32_bf16 v[196:199], v[236:239], v[100:103], v[196:199]
    ds_read_b128 v[228:231], v4 offset:56320
    s_waitcnt lgkmcnt(3)
    v_mfma_f32_16x16x32_bf16 v[184:187], v[240:243], v[104:107], v[184:187]
    v_mfma_f32_16x16x32_bf16 v[188:191], v[240:243], v[108:111], v[188:191]
    ds_read_b128 v[232:235], v4 offset:57344
    s_waitcnt lgkmcnt(3)
    v_mfma_f32_16x16x32_bf16 v[192:195], v[244:247], v[104:107], v[192:195]
    v_mfma_f32_16x16x32_bf16 v[196:199], v[244:247], v[108:111], v[196:199]
    ds_read_b128 v[236:239], v4 offset:58368
    s_waitcnt lgkmcnt(3)
    v_mfma_f32_16x16x32_bf16 v[184:187], v[224:227], v[112:115], v[184:187]
    v_mfma_f32_16x16x32_bf16 v[188:191], v[224:227], v[116:119], v[188:191]
    ds_read_b128 v[240:243], v4 offset:59392
    s_waitcnt lgkmcnt(3)
    v_mfma_f32_16x16x32_bf16 v[192:195], v[228:231], v[112:115], v[192:195]
    v_mfma_f32_16x16x32_bf16 v[196:199], v[228:231], v[116:119], v[196:199]
    ds_read_b128 v[244:247], v4 offset:60416
    s_waitcnt lgkmcnt(3)
    v_mfma_f32_16x16x32_bf16 v[184:187], v[232:235], v[120:123], v[184:187]
    v_mfma_f32_16x16x32_bf16 v[188:191], v[232:235], v[124:127], v[188:191]
    ds_read_b128 v[224:227], v4 offset:61440
    s_waitcnt lgkmcnt(3)
    v_mfma_f32_16x16x32_bf16 v[192:195], v[236:239], v[120:123], v[192:195]
    v_mfma_f32_16x16x32_bf16 v[196:199], v[236:239], v[124:127], v[196:199]
    ds_read_b128 v[228:231], v4 offset:62464
    s_waitcnt lgkmcnt(3)
    v_mfma_f32_16x16x32_bf16 v[184:187], v[240:243], v[128:131], v[184:187]
    v_mfma_f32_16x16x32_bf16 v[188:191], v[240:243], v[132:135], v[188:191]
    ds_read_b128 v[232:235], v4 offset:63488
    s_waitcnt lgkmcnt(3)
    v_mfma_f32_16x16x32_bf16 v[192:195], v[244:247], v[128:131], v[192:195]
    v_mfma_f32_16x16x32_bf16 v[196:199], v[244:247], v[132:135], v[196:199]
    ds_read_b128 v[236:239], v4 offset:64512
    s_waitcnt lgkmcnt(3)
    v_mfma_f32_16x16x32_bf16 v[184:187], v[224:227], v[136:139], v[184:187]
    v_mfma_f32_16x16x32_bf16 v[188:191], v[224:227], v[140:143], v[188:191]
    s_waitcnt vmcnt(6)
    s_barrier
    ds_read_b128 v[240:243], v5 offset:0
    s_waitcnt lgkmcnt(3)
    v_mfma_f32_16x16x32_bf16 v[192:195], v[228:231], v[136:139], v[192:195]
    v_mfma_f32_16x16x32_bf16 v[196:199], v[228:231], v[140:143], v[196:199]
    s_add_u32 s22, s21, 0x90000
    s_add_u32 m0, s20, 0x18000
    s_nop 0
    buffer_load_dwordx4 v2, s[8:11], s22 offen sc1 lds
    ds_read_b128 v[244:247], v5 offset:1024
    s_waitcnt lgkmcnt(3)
    v_mfma_f32_16x16x32_bf16 v[184:187], v[232:235], v[144:147], v[184:187]
    v_mfma_f32_16x16x32_bf16 v[188:191], v[232:235], v[148:151], v[188:191]
    ds_read_b128 v[224:227], v5 offset:2048
    s_waitcnt lgkmcnt(3)
    v_mfma_f32_16x16x32_bf16 v[192:195], v[236:239], v[144:147], v[192:195]
    v_mfma_f32_16x16x32_bf16 v[196:199], v[236:239], v[148:151], v[196:199]
    ds_read_b128 v[228:231], v5 offset:3072
    s_waitcnt lgkmcnt(3)
    v_mfma_f32_16x16x32_bf16 v[200:203], v[240:243], v[24:27], 0
    v_mfma_f32_16x16x32_bf16 v[204:207], v[240:243], v[28:31], 0
    ds_read_b128 v[232:235], v5 offset:4096
    s_waitcnt lgkmcnt(3)
    v_mfma_f32_16x16x32_bf16 v[208:211], v[244:247], v[24:27], 0
    v_mfma_f32_16x16x32_bf16 v[212:215], v[244:247], v[28:31], 0
    s_add_u32 s22, s21, 0x90400
    s_add_u32 m0, s20, 0x18400
    s_nop 0
    buffer_load_dwordx4 v2, s[8:11], s22 offen sc1 lds
    ds_read_b128 v[236:239], v5 offset:5120
    v_mul_f32 v184, v184, v9
    s_waitcnt lgkmcnt(3)
    v_mfma_f32_16x16x32_bf16 v[200:203], v[224:227], v[32:35], v[200:203]
    v_mul_f32 v185, v185, v9
    v_mfma_f32_16x16x32_bf16 v[204:207], v[224:227], v[36:39], v[204:207]
    ds_read_b128 v[240:243], v5 offset:6144
    v_mul_f32 v186, v186, v9
    s_waitcnt lgkmcnt(3)
    v_mfma_f32_16x16x32_bf16 v[208:211], v[228:231], v[32:35], v[208:211]
    v_mul_f32 v187, v187, v9
    v_mfma_f32_16x16x32_bf16 v[212:215], v[228:231], v[36:39], v[212:215]
    ds_read_b128 v[244:247], v5 offset:7168
    v_mul_f32 v192, v192, v9
    s_waitcnt lgkmcnt(3)
    v_mfma_f32_16x16x32_bf16 v[200:203], v[232:235], v[40:43], v[200:203]
    v_mul_f32 v193, v193, v9
    v_mfma_f32_16x16x32_bf16 v[204:207], v[232:235], v[44:47], v[204:207]
    ds_read_b128 v[224:227], v5 offset:8192
    v_mul_f32 v194, v194, v9
    s_waitcnt lgkmcnt(3)
    v_mfma_f32_16x16x32_bf16 v[208:211], v[236:239], v[40:43], v[208:211]
    v_mul_f32 v195, v195, v9
    v_mfma_f32_16x16x32_bf16 v[212:215], v[236:239], v[44:47], v[212:215]
    ds_read_b128 v[228:231], v5 offset:9216
    v_cvt_pk_bf16_f32 v216, v184, v185
    s_waitcnt lgkmcnt(3)
    v_mfma_f32_16x16x32_bf16 v[200:203], v[240:243], v[48:51], v[200:203]
    v_cvt_pk_bf16_f32 v217, v186, v187
    v_mfma_f32_16x16x32_bf16 v[204:207], v[240:243], v[52:55], v[204:207]
    ds_read_b128 v[232:235], v5 offset:10240
    v_cvt_pk_bf16_f32 v218, v192, v193
    s_waitcnt lgkmcnt(3)
    v_mfma_f32_16x16x32_bf16 v[208:211], v[244:247], v[48:51], v[208:211]
    v_cvt_pk_bf16_f32 v219, v194, v195
    v_mfma_f32_16x16x32_bf16 v[212:215], v[244:247], v[52:55], v[212:215]
    ds_read_b128 v[236:239], v5 offset:11264
    buffer_store_dwordx4 v[216:219], v2, s[8:11], s25 offen offset:0 sc1
    s_waitcnt lgkmcnt(3)
    v_mfma_f32_16x16x32_bf16 v[200:203], v[224:227], v[56:59], v[200:203]
    v_mul_f32 v188, v188, v10
    v_mfma_f32_16x16x32_bf16 v[204:207], v[224:227], v[60:63], v[204:207]
    ds_read_b128 v[240:243], v5 offset:12288
    v_mul_f32 v189, v189, v10
    s_waitcnt lgkmcnt(3)
    v_mfma_f32_16x16x32_bf16 v[208:211], v[228:231], v[56:59], v[208:211]
    v_mul_f32 v190, v190, v10
    v_mfma_f32_16x16x32_bf16 v[212:215], v[228:231], v[60:63], v[212:215]
    ds_read_b128 v[244:247], v5 offset:13312
    v_mul_f32 v191, v191, v10
    s_waitcnt lgkmcnt(3)
    v_mfma_f32_16x16x32_bf16 v[200:203], v[232:235], v[64:67], v[200:203]
    v_mul_f32 v196, v196, v10
    v_mfma_f32_16x16x32_bf16 v[204:207], v[232:235], v[68:71], v[204:207]
    ds_read_b128 v[224:227], v5 offset:14336
    v_mul_f32 v197, v197, v10
    s_waitcnt lgkmcnt(3)
    v_mfma_f32_16x16x32_bf16 v[208:211], v[236:239], v[64:67], v[208:211]
    v_mul_f32 v198, v198, v10
    v_mfma_f32_16x16x32_bf16 v[212:215], v[236:239], v[68:71], v[212:215]
    ds_read_b128 v[228:231], v5 offset:15360
    v_mul_f32 v199, v199, v10
    s_waitcnt lgkmcnt(3)
    v_mfma_f32_16x16x32_bf16 v[200:203], v[240:243], v[72:75], v[200:203]
    v_cvt_pk_bf16_f32 v220, v188, v189
    v_mfma_f32_16x16x32_bf16 v[204:207], v[240:243], v[76:79], v[204:207]
    s_waitcnt vmcnt(7)
    s_barrier
    ds_read_b128 v[232:235], v5 offset:16384
    v_cvt_pk_bf16_f32 v221, v190, v191
    s_waitcnt lgkmcnt(3)
    v_mfma_f32_16x16x32_bf16 v[208:211], v[244:247], v[72:75], v[208:211]
    v_cvt_pk_bf16_f32 v222, v196, v197
    v_mfma_f32_16x16x32_bf16 v[212:215], v[244:247], v[76:79], v[212:215]
    s_add_u32 s22, s21, 0x94000
    s_add_u32 m0, s20, 0x1c000
    s_nop 0
    buffer_load_dwordx4 v2, s[8:11], s22 offen sc1 lds
    ds_read_b128 v[236:239], v5 offset:17408
    v_cvt_pk_bf16_f32 v223, v198, v199
    s_waitcnt lgkmcnt(3)
    v_mfma_f32_16x16x32_bf16 v[200:203], v[224:227], v[80:83], v[200:203]
    buffer_store_dwordx4 v[220:223], v2, s[8:11], s26 offen offset:0 sc1
    v_mfma_f32_16x16x32_bf16 v[204:207], v[224:227], v[84:87], v[204:207]
    ds_read_b128 v[240:243], v5 offset:18432
    s_waitcnt lgkmcnt(3)
    v_mfma_f32_16x16x32_bf16 v[208:211], v[228:231], v[80:83], v[208:211]
    v_mfma_f32_16x16x32_bf16 v[212:215], v[228:231], v[84:87], v[212:215]
    ds_read_b128 v[244:247], v5 offset:19456
    s_waitcnt lgkmcnt(3)
    v_mfma_f32_16x16x32_bf16 v[200:203], v[232:235], v[88:91], v[200:203]
    v_lshrrev_b32 v20, 4, v1
    v_lshlrev_b32 v21, 4, v20
    s_lshl_b32 s16, s2, 8
    s_add_u32 s16, s16, 0x550000
    buffer_load_dwordx4 v[152:155], v21, s[8:11], s16 offen offset:0 sc1
    buffer_load_dwordx4 v[156:159], v21, s[8:11], s16 offen offset:64 sc1
    buffer_load_dwordx4 v[160:163], v21, s[8:11], s16 offen offset:128 sc1
    buffer_load_dwordx4 v[164:167], v21, s[8:11], s16 offen offset:192 sc1
    v_lshlrev_b32 v11, 11, v20
    v_xor_b32 v20, s3, v20
    v_and_b32 v20, 1, v20
    v_lshl_add_u32 v11, v20, 5, v11
    v_bfe_u32 v20, v1, 2, 2
    v_lshl_add_u32 v11, v20, 6, v11
    v_and_b32 v20, 3, v1
    v_lshl_add_u32 v11, v20, 3, v11
    s_lshr_b32 s16, s3, 1
    s_lshl_b32 s16, s16, 8
    s_add_u32 s16, s16, 65536
    v_add_u32 v11, s16, v11
    v_mfma_f32_16x16x32_bf16 v[204:207], v[232:235], v[92:95], v[204:207]
    ds_read_b128 v[224:227], v5 offset:20480
    s_waitcnt lgkmcnt(3)
    v_mfma_f32_16x16x32_bf16 v[208:211], v[236:239], v[88:91], v[208:211]
    v_mfma_f32_16x16x32_bf16 v[212:215], v[236:239], v[92:95], v[212:215]
    s_add_u32 s22, s21, 0x94400
    s_add_u32 m0, s20, 0x1c400
    s_nop 0
    buffer_load_dwordx4 v2, s[8:11], s22 offen sc1 lds
    ds_read_b128 v[228:231], v5 offset:21504
    s_waitcnt lgkmcnt(3)
    v_mfma_f32_16x16x32_bf16 v[200:203], v[240:243], v[96:99], v[200:203]
    v_mfma_f32_16x16x32_bf16 v[204:207], v[240:243], v[100:103], v[204:207]
    ds_read_b128 v[232:235], v5 offset:22528
    s_waitcnt lgkmcnt(3)
    v_mfma_f32_16x16x32_bf16 v[208:211], v[244:247], v[96:99], v[208:211]
    v_mfma_f32_16x16x32_bf16 v[212:215], v[244:247], v[100:103], v[212:215]
    ds_read_b128 v[236:239], v5 offset:23552
    s_waitcnt lgkmcnt(3)
    v_mfma_f32_16x16x32_bf16 v[200:203], v[224:227], v[104:107], v[200:203]
    v_mfma_f32_16x16x32_bf16 v[204:207], v[224:227], v[108:111], v[204:207]
    ds_read_b128 v[240:243], v5 offset:24576
    s_waitcnt lgkmcnt(3)
    v_mfma_f32_16x16x32_bf16 v[208:211], v[228:231], v[104:107], v[208:211]
    v_mfma_f32_16x16x32_bf16 v[212:215], v[228:231], v[108:111], v[212:215]
    ds_read_b128 v[244:247], v5 offset:25600
    s_waitcnt lgkmcnt(3)
    v_mfma_f32_16x16x32_bf16 v[200:203], v[232:235], v[112:115], v[200:203]
    v_mfma_f32_16x16x32_bf16 v[204:207], v[232:235], v[116:119], v[204:207]
    ds_read_b128 v[224:227], v5 offset:26624
    s_waitcnt lgkmcnt(3)
    v_mfma_f32_16x16x32_bf16 v[208:211], v[236:239], v[112:115], v[208:211]
    v_mfma_f32_16x16x32_bf16 v[212:215], v[236:239], v[116:119], v[212:215]
    ds_read_b128 v[228:231], v5 offset:27648
    s_waitcnt lgkmcnt(3)
    v_mfma_f32_16x16x32_bf16 v[200:203], v[240:243], v[120:123], v[200:203]
    v_mfma_f32_16x16x32_bf16 v[204:207], v[240:243], v[124:127], v[204:207]
    ds_read_b128 v[232:235], v5 offset:28672
    s_waitcnt lgkmcnt(3)
    v_mfma_f32_16x16x32_bf16 v[208:211], v[244:247], v[120:123], v[208:211]
    v_mfma_f32_16x16x32_bf16 v[212:215], v[244:247], v[124:127], v[212:215]
    ds_read_b128 v[236:239], v5 offset:29696
    s_waitcnt lgkmcnt(3)
    v_mfma_f32_16x16x32_bf16 v[200:203], v[224:227], v[128:131], v[200:203]
    v_mfma_f32_16x16x32_bf16 v[204:207], v[224:227], v[132:135], v[204:207]
    ds_read_b128 v[240:243], v5 offset:30720
    s_waitcnt lgkmcnt(3)
    v_mfma_f32_16x16x32_bf16 v[208:211], v[228:231], v[128:131], v[208:211]
    v_mfma_f32_16x16x32_bf16 v[212:215], v[228:231], v[132:135], v[212:215]
    ds_read_b128 v[244:247], v5 offset:31744
    s_waitcnt lgkmcnt(3)
    v_mfma_f32_16x16x32_bf16 v[200:203], v[232:235], v[136:139], v[200:203]
    s_waitcnt vmcnt(5)
    s_add_u32 s16, s63, 0x570000
    v_mov_b32 v7, s28
    v_mov_b32 v8, 0
    s_mov_b64 exec, 1
    buffer_store_dword v7, v8, s[8:11], s16 offen sc1
    s_mov_b64 exec, -1
    v_mfma_f32_16x16x32_bf16 v[204:207], v[232:235], v[140:143], v[204:207]
    s_barrier
    ds_read_b128 v[224:227], v4 offset:32768
    s_waitcnt lgkmcnt(3)
    v_mfma_f32_16x16x32_bf16 v[208:211], v[236:239], v[136:139], v[208:211]
    v_mfma_f32_16x16x32_bf16 v[212:215], v[236:239], v[140:143], v[212:215]
    s_add_u32 s22, s21, 0x98000
    s_add_u32 m0, s20, 0x20000
    s_nop 0
    buffer_load_dwordx4 v2, s[8:11], s22 offen sc1 lds
    ds_read_b128 v[228:231], v4 offset:33792
    s_waitcnt lgkmcnt(3)
    v_mfma_f32_16x16x32_bf16 v[200:203], v[240:243], v[144:147], v[200:203]
    ds_read_b64_tr_b16 v[168:169], v11 offset:0
    ds_read_b64_tr_b16 v[170:171], v11 offset:1024
    ds_read_b64_tr_b16 v[172:173], v11 offset:8192
    ds_read_b64_tr_b16 v[174:175], v11 offset:9216
    ds_read_b64_tr_b16 v[176:177], v11 offset:16384
    ds_read_b64_tr_b16 v[178:179], v11 offset:17408
    ds_read_b64_tr_b16 v[180:181], v11 offset:24576
    ds_read_b64_tr_b16 v[182:183], v11 offset:25600
    v_mfma_f32_16x16x32_bf16 v[204:207], v[240:243], v[148:151], v[204:207]
    ds_read_b128 v[232:235], v4 offset:34816
    s_waitcnt lgkmcnt(11)
    v_mfma_f32_16x16x32_bf16 v[208:211], v[244:247], v[144:147], v[208:211]
    v_mfma_f32_16x16x32_bf16 v[212:215], v[244:247], v[148:151], v[212:215]
    ds_read_b128 v[236:239], v4 offset:35840
    s_waitcnt lgkmcnt(11)
    v_mfma_f32_16x16x32_bf16 v[184:187], v[224:227], v[24:27], 0
    v_mfma_f32_16x16x32_bf16 v[188:191], v[224:227], v[28:31], 0
    ds_read_b128 v[240:243], v4 offset:36864
    s_waitcnt lgkmcnt(11)
    v_mfma_f32_16x16x32_bf16 v[192:195], v[228:231], v[24:27], 0
    v_mfma_f32_16x16x32_bf16 v[196:199], v[228:231], v[28:31], 0
    s_add_u32 s22, s21, 0x98400
    s_add_u32 m0, s20, 0x20400
    s_nop 0
    buffer_load_dwordx4 v2, s[8:11], s22 offen sc1 lds
    ds_read_b128 v[244:247], v4 offset:37888
    v_mul_f32 v200, v200, v9
    s_waitcnt lgkmcnt(3)
    v_mfma_f32_16x16x32_bf16 v[184:187], v[232:235], v[32:35], v[184:187]
    v_mul_f32 v201, v201, v9
    v_mfma_f32_16x16x32_bf16 v[188:191], v[232:235], v[36:39], v[188:191]
    ds_read_b128 v[224:227], v4 offset:38912
    v_mul_f32 v202, v202, v9
    s_waitcnt lgkmcnt(3)
    v_mfma_f32_16x16x32_bf16 v[192:195], v[236:239], v[32:35], v[192:195]
    v_mul_f32 v203, v203, v9
    s_waitcnt vmcnt(7)
    v_mfma_f32_16x16x32_bf16 v[248:251], v[168:171], v[152:155], 0
    s_waitcnt vmcnt(6)
    v_mfma_f32_16x16x32_bf16 v[248:251], v[172:175], v[156:159], v[248:251]
    s_waitcnt vmcnt(5)
    v_mfma_f32_16x16x32_bf16 v[248:251], v[176:179], v[160:163], v[248:251]
    s_waitcnt vmcnt(4)
    v_mfma_f32_16x16x32_bf16 v[248:251], v[180:183], v[164:167], v[248:251]
    v_mfma_f32_16x16x32_bf16 v[196:199], v[236:239], v[36:39], v[196:199]
    ds_read_b128 v[228:231], v4 offset:39936
    v_mul_f32 v208, v208, v9
    s_waitcnt lgkmcnt(3)
    v_mfma_f32_16x16x32_bf16 v[184:187], v[240:243], v[40:43], v[184:187]
    v_mul_f32 v209, v209, v9
    v_mfma_f32_16x16x32_bf16 v[188:191], v[240:243], v[44:47], v[188:191]
    ds_read_b128 v[232:235], v4 offset:40960
    v_mul_f32 v210, v210, v9
    s_waitcnt lgkmcnt(3)
    v_mfma_f32_16x16x32_bf16 v[192:195], v[244:247], v[40:43], v[192:195]
    v_mul_f32 v211, v211, v9
    v_mfma_f32_16x16x32_bf16 v[196:199], v[244:247], v[44:47], v[196:199]
    ds_read_b128 v[236:239], v4 offset:41984
    v_cvt_pk_bf16_f32 v216, v200, v201
    s_waitcnt lgkmcnt(3)
    v_mfma_f32_16x16x32_bf16 v[184:187], v[224:227], v[48:51], v[184:187]
    v_cvt_pk_bf16_f32 v217, v202, v203
    v_mfma_f32_16x16x32_bf16 v[188:191], v[224:227], v[52:55], v[188:191]
    ds_read_b128 v[240:243], v4 offset:43008
    v_cvt_pk_bf16_f32 v218, v208, v209
    s_waitcnt lgkmcnt(3)
    v_mfma_f32_16x16x32_bf16 v[192:195], v[228:231], v[48:51], v[192:195]
    v_cvt_pk_bf16_f32 v219, v210, v211
    v_mfma_f32_16x16x32_bf16 v[196:199], v[228:231], v[52:55], v[196:199]
    ds_read_b128 v[244:247], v4 offset:44032
    buffer_store_dwordx4 v[216:219], v2, s[8:11], s25 offen offset:1024 sc1
    s_waitcnt lgkmcnt(3)
    v_mfma_f32_16x16x32_bf16 v[184:187], v[232:235], v[56:59], v[184:187]
    v_mul_f32 v204, v204, v10
    v_mfma_f32_16x16x32_bf16 v[188:191], v[232:235], v[60:63], v[188:191]
    ds_read_b128 v[224:227], v4 offset:45056
    v_mul_f32 v205, v205, v10
    s_waitcnt lgkmcnt(3)
    v_mfma_f32_16x16x32_bf16 v[192:195], v[236:239], v[56:59], v[192:195]
    v_mul_f32 v206, v206, v10
    v_lshrrev_b32 v20, 4, v1
    v_lshlrev_b32 v20, 4, v20
    s_lshr_b32 s16, s2, 5
    s_lshl_b32 s16, s16, 14
    s_and_b32 s17, s2, 31
    s_lshl_b32 s17, s17, 9
    s_add_u32 s16, s16, s17
    s_lshl_b32 s17, s3, 6
    s_add_u32 s16, s16, s17
    s_add_u32 s16, s16, 0x580000
    s_mov_b32 exec_lo, 0x10001
    s_mov_b32 exec_hi, 0x10001
    buffer_store_dwordx4 v[248:251], v20, s[8:11], s16 offen sc1
    s_mov_b64 exec, -1
    v_mfma_f32_16x16x32_bf16 v[196:199], v[236:239], v[60:63], v[196:199]
    ds_read_b128 v[228:231], v4 offset:46080
    v_mul_f32 v207, v207, v10
    s_waitcnt lgkmcnt(3)
    v_mfma_f32_16x16x32_bf16 v[184:187], v[240:243], v[64:67], v[184:187]
    v_mul_f32 v212, v212, v10
    v_mfma_f32_16x16x32_bf16 v[188:191], v[240:243], v[68:71], v[188:191]
    ds_read_b128 v[232:235], v4 offset:47104
    v_mul_f32 v213, v213, v10
    s_waitcnt lgkmcnt(3)
    v_mfma_f32_16x16x32_bf16 v[192:195], v[244:247], v[64:67], v[192:195]
    v_mul_f32 v214, v214, v10
    v_mfma_f32_16x16x32_bf16 v[196:199], v[244:247], v[68:71], v[196:199]
    ds_read_b128 v[236:239], v4 offset:48128
    v_mul_f32 v215, v215, v10
    s_waitcnt lgkmcnt(3)
    v_mfma_f32_16x16x32_bf16 v[184:187], v[224:227], v[72:75], v[184:187]
    v_cvt_pk_bf16_f32 v220, v204, v205
    v_mfma_f32_16x16x32_bf16 v[188:191], v[224:227], v[76:79], v[188:191]
    s_waitcnt vmcnt(5)
    s_barrier
    ds_read_b128 v[240:243], v4 offset:49152
    v_cvt_pk_bf16_f32 v221, v206, v207
    s_waitcnt lgkmcnt(3)
    v_mfma_f32_16x16x32_bf16 v[192:195], v[228:231], v[72:75], v[192:195]
    v_cvt_pk_bf16_f32 v222, v212, v213
    v_mfma_f32_16x16x32_bf16 v[196:199], v[228:231], v[76:79], v[196:199]
    s_add_u32 s22, s21, 0x9c000
    s_add_u32 m0, s20, 0x24000
    s_nop 0
    buffer_load_dwordx4 v2, s[8:11], s22 offen sc1 lds
    ds_read_b128 v[244:247], v4 offset:50176
    v_cvt_pk_bf16_f32 v223, v214, v215
    s_waitcnt lgkmcnt(3)
    v_mfma_f32_16x16x32_bf16 v[184:187], v[232:235], v[80:83], v[184:187]
    buffer_store_dwordx4 v[220:223], v2, s[8:11], s26 offen offset:1024 sc1
    v_mfma_f32_16x16x32_bf16 v[188:191], v[232:235], v[84:87], v[188:191]
    ds_read_b128 v[224:227], v4 offset:51200
    s_waitcnt lgkmcnt(3)
    v_mfma_f32_16x16x32_bf16 v[192:195], v[236:239], v[80:83], v[192:195]
    v_mfma_f32_16x16x32_bf16 v[196:199], v[236:239], v[84:87], v[196:199]
    s_add_u32 s22, s21, 0x9c400
    s_add_u32 m0, s20, 0x24400
    s_nop 0
    buffer_load_dwordx4 v2, s[8:11], s22 offen sc1 lds
    ds_read_b128 v[228:231], v4 offset:52224
    s_waitcnt lgkmcnt(3)
    v_mfma_f32_16x16x32_bf16 v[184:187], v[240:243], v[88:91], v[184:187]
    v_mfma_f32_16x16x32_bf16 v[188:191], v[240:243], v[92:95], v[188:191]
    ds_read_b128 v[232:235], v4 offset:53248
    s_waitcnt lgkmcnt(3)
    v_mfma_f32_16x16x32_bf16 v[192:195], v[244:247], v[88:91], v[192:195]
    v_mfma_f32_16x16x32_bf16 v[196:199], v[244:247], v[92:95], v[196:199]
    s_add_u32 s22, s24, 0x0
    s_add_u32 m0, s20, 0x10000
    s_nop 0
    buffer_load_dwordx4 v3, s[4:7], s22 offen lds
    ds_read_b128 v[236:239], v4 offset:54272
    s_waitcnt lgkmcnt(3)
    v_mfma_f32_16x16x32_bf16 v[184:187], v[224:227], v[96:99], v[184:187]
    v_mfma_f32_16x16x32_bf16 v[188:191], v[224:227], v[100:103], v[188:191]
    ds_read_b128 v[240:243], v4 offset:55296
    s_waitcnt lgkmcnt(3)
    v_mfma_f32_16x16x32_bf16 v[192:195], v[228:231], v[96:99], v[192:195]
    v_mfma_f32_16x16x32_bf16 v[196:199], v[228:231], v[100:103], v[196:199]
    s_add_u32 s22, s24, 0x2000
    s_add_u32 m0, s20, 0x10400
    s_nop 0
    buffer_load_dwordx4 v3, s[4:7], s22 offen lds
    ds_read_b128 v[244:247], v4 offset:56320
    s_waitcnt lgkmcnt(3)
    v_mfma_f32_16x16x32_bf16 v[184:187], v[232:235], v[104:107], v[184:187]
    v_mfma_f32_16x16x32_bf16 v[188:191], v[232:235], v[108:111], v[188:191]
    ds_read_b128 v[224:227], v4 offset:57344
    s_waitcnt lgkmcnt(3)
    v_mfma_f32_16x16x32_bf16 v[192:195], v[236:239], v[104:107], v[192:195]
    v_mfma_f32_16x16x32_bf16 v[196:199], v[236:239], v[108:111], v[196:199]
    ds_read_b128 v[228:231], v4 offset:58368
    s_waitcnt lgkmcnt(3)
    v_mfma_f32_16x16x32_bf16 v[184:187], v[240:243], v[112:115], v[184:187]
    v_mfma_f32_16x16x32_bf16 v[188:191], v[240:243], v[116:119], v[188:191]
    ds_read_b128 v[232:235], v4 offset:59392
    s_waitcnt lgkmcnt(3)
    v_mfma_f32_16x16x32_bf16 v[192:195], v[244:247], v[112:115], v[192:195]
    v_mfma_f32_16x16x32_bf16 v[196:199], v[244:247], v[116:119], v[196:199]
    ds_read_b128 v[236:239], v4 offset:60416
    s_waitcnt lgkmcnt(3)
    v_mfma_f32_16x16x32_bf16 v[184:187], v[224:227], v[120:123], v[184:187]
    v_mfma_f32_16x16x32_bf16 v[188:191], v[224:227], v[124:127], v[188:191]
    ds_read_b128 v[240:243], v4 offset:61440
    s_waitcnt lgkmcnt(3)
    v_mfma_f32_16x16x32_bf16 v[192:195], v[228:231], v[120:123], v[192:195]
    v_mfma_f32_16x16x32_bf16 v[196:199], v[228:231], v[124:127], v[196:199]
    ds_read_b128 v[244:247], v4 offset:62464
    s_waitcnt lgkmcnt(3)
    v_mfma_f32_16x16x32_bf16 v[184:187], v[232:235], v[128:131], v[184:187]
    v_mfma_f32_16x16x32_bf16 v[188:191], v[232:235], v[132:135], v[188:191]
    ds_read_b128 v[224:227], v4 offset:63488
    s_waitcnt lgkmcnt(3)
    v_mfma_f32_16x16x32_bf16 v[192:195], v[236:239], v[128:131], v[192:195]
    v_mfma_f32_16x16x32_bf16 v[196:199], v[236:239], v[132:135], v[196:199]
    ds_read_b128 v[228:231], v4 offset:64512
    s_waitcnt lgkmcnt(3)
    v_mfma_f32_16x16x32_bf16 v[184:187], v[240:243], v[136:139], v[184:187]
    v_mfma_f32_16x16x32_bf16 v[188:191], v[240:243], v[140:143], v[188:191]
    s_waitcnt vmcnt(7)
    s_barrier
    ds_read_b128 v[232:235], v5 offset:0
    s_waitcnt lgkmcnt(3)
    v_mfma_f32_16x16x32_bf16 v[192:195], v[244:247], v[136:139], v[192:195]
    v_mfma_f32_16x16x32_bf16 v[196:199], v[244:247], v[140:143], v[196:199]
    s_add_u32 s22, s24, 0x80000
    s_add_u32 m0, s20, 0x14000
    s_nop 0
    buffer_load_dwordx4 v3, s[4:7], s22 offen lds
    ds_read_b128 v[236:239], v5 offset:1024
    s_waitcnt lgkmcnt(3)
    v_mfma_f32_16x16x32_bf16 v[184:187], v[224:227], v[144:147], v[184:187]
    v_mfma_f32_16x16x32_bf16 v[188:191], v[224:227], v[148:151], v[188:191]
    ds_read_b128 v[240:243], v5 offset:2048
    s_waitcnt lgkmcnt(3)
    v_mfma_f32_16x16x32_bf16 v[192:195], v[228:231], v[144:147], v[192:195]
    v_mfma_f32_16x16x32_bf16 v[196:199], v[228:231], v[148:151], v[196:199]
    s_add_u32 s22, s24, 0x82000
    s_add_u32 m0, s20, 0x14400
    s_nop 0
    buffer_load_dwordx4 v3, s[4:7], s22 offen lds
    ds_read_b128 v[244:247], v5 offset:3072
    s_waitcnt lgkmcnt(3)
    v_mfma_f32_16x16x32_bf16 v[200:203], v[232:235], v[24:27], 0
    v_mfma_f32_16x16x32_bf16 v[204:207], v[232:235], v[28:31], 0
    ds_read_b128 v[224:227], v5 offset:4096
    s_waitcnt lgkmcnt(3)
    v_mfma_f32_16x16x32_bf16 v[208:211], v[236:239], v[24:27], 0
    v_mfma_f32_16x16x32_bf16 v[212:215], v[236:239], v[28:31], 0
    s_add_u32 s22, s24, 0x100000
    s_add_u32 m0, s20, 0x18000
    s_nop 0
    buffer_load_dwordx4 v3, s[4:7], s22 offen lds
    ds_read_b128 v[228:231], v5 offset:5120
    v_mul_f32 v184, v184, v9
    s_waitcnt lgkmcnt(3)
    v_mfma_f32_16x16x32_bf16 v[200:203], v[240:243], v[32:35], v[200:203]
    v_mul_f32 v185, v185, v9
    s_bfe_u32 s30, s2, 0x20001
    s_lshl_b32 s30, s30, 2
    s_bfe_u32 s17, s2, 0x20003
    s_add_u32 s30, s30, s17
    s_lshr_b32 s31, s2, 5
    s_and_b32 s17, s3, 3
    s_lshl_b32 s19, s30, 2
    s_add_u32 s19, s19, s17
    s_and_b32 s16, s2, 1
    s_lshl_b32 s17, s19, 18
    s_lshl_b32 s23, s16, 16
    s_add_u32 s17, s17, s23
    s_add_u32 s17, s17, 0x1000000
    v_add_u32 v6, s17, v2
    s_lshl_b32 s19, s19, 7
    s_lshl_b32 s23, s16, 6
    s_add_u32 s19, s19, s23
    s_add_u32 s19, s19, 0x570000
    v_and_b32 v13, 15, v1
    v_lshlrev_b32 v13, 2, v13
    buffer_load_dword v12, v13, s[8:11], s19 offen sc1
    v_mfma_f32_16x16x32_bf16 v[204:207], v[240:243], v[36:39], v[204:207]
    ds_read_b128 v[232:235], v5 offset:6144
    v_mul_f32 v186, v186, v9
    s_waitcnt lgkmcnt(3)
    v_mfma_f32_16x16x32_bf16 v[208:211], v[244:247], v[32:35], v[208:211]
    v_mul_f32 v187, v187, v9
    v_mfma_f32_16x16x32_bf16 v[212:215], v[244:247], v[36:39], v[212:215]
    s_add_u32 s22, s24, 0x102000
    s_add_u32 m0, s20, 0x18400
    s_nop 0
    buffer_load_dwordx4 v3, s[4:7], s22 offen lds
    ds_read_b128 v[236:239], v5 offset:7168
    v_mul_f32 v192, v192, v9
    s_waitcnt lgkmcnt(3)
    v_mfma_f32_16x16x32_bf16 v[200:203], v[224:227], v[40:43], v[200:203]
    v_mul_f32 v193, v193, v9
    v_mfma_f32_16x16x32_bf16 v[204:207], v[224:227], v[44:47], v[204:207]
    ds_read_b128 v[240:243], v5 offset:8192
    v_mul_f32 v194, v194, v9
    s_waitcnt lgkmcnt(3)
    v_mfma_f32_16x16x32_bf16 v[208:211], v[228:231], v[40:43], v[208:211]
    v_mul_f32 v195, v195, v9
    v_mfma_f32_16x16x32_bf16 v[212:215], v[228:231], v[44:47], v[212:215]
    ds_read_b128 v[244:247], v5 offset:9216
    v_cvt_pk_bf16_f32 v216, v184, v185
    s_waitcnt lgkmcnt(3)
    v_mfma_f32_16x16x32_bf16 v[200:203], v[232:235], v[48:51], v[200:203]
    v_cvt_pk_bf16_f32 v217, v186, v187
    v_mfma_f32_16x16x32_bf16 v[204:207], v[232:235], v[52:55], v[204:207]
    ds_read_b128 v[224:227], v5 offset:10240
    v_cvt_pk_bf16_f32 v218, v192, v193
    s_waitcnt lgkmcnt(3)
    v_mfma_f32_16x16x32_bf16 v[208:211], v[236:239], v[48:51], v[208:211]
    v_cvt_pk_bf16_f32 v219, v194, v195
    v_mfma_f32_16x16x32_bf16 v[212:215], v[236:239], v[52:55], v[212:215]
    ds_read_b128 v[228:231], v5 offset:11264
    buffer_store_dwordx4 v[216:219], v2, s[8:11], s25 offen offset:2048 sc1
    s_waitcnt lgkmcnt(3)
    v_mfma_f32_16x16x32_bf16 v[200:203], v[240:243], v[56:59], v[200:203]
    v_mul_f32 v188, v188, v10
    v_mfma_f32_16x16x32_bf16 v[204:207], v[240:243], v[60:63], v[204:207]
    ds_read_b128 v[232:235], v5 offset:12288
    v_mul_f32 v189, v189, v10
    s_waitcnt lgkmcnt(3)
    v_mfma_f32_16x16x32_bf16 v[208:211], v[244:247], v[56:59], v[208:211]
    v_mul_f32 v190, v190, v10
    v_mfma_f32_16x16x32_bf16 v[212:215], v[244:247], v[60:63], v[212:215]
    ds_read_b128 v[236:239], v5 offset:13312
    v_mul_f32 v191, v191, v10
    s_waitcnt lgkmcnt(3)
    v_mfma_f32_16x16x32_bf16 v[200:203], v[224:227], v[64:67], v[200:203]
    v_mul_f32 v196, v196, v10
    s_waitcnt vmcnt(11)
    v_mfma_f32_16x16x32_bf16 v[204:207], v[224:227], v[68:71], v[204:207]
    ds_read_b128 v[240:243], v5 offset:14336
    v_mul_f32 v197, v197, v10
    s_waitcnt lgkmcnt(3)
    v_mfma_f32_16x16x32_bf16 v[208:211], v[228:231], v[64:67], v[208:211]
    v_mul_f32 v198, v198, v10
    v_mfma_f32_16x16x32_bf16 v[212:215], v[228:231], v[68:71], v[212:215]
    ds_read_b128 v[244:247], v5 offset:15360
    v_mul_f32 v199, v199, v10
    s_waitcnt lgkmcnt(3)
    v_mfma_f32_16x16x32_bf16 v[200:203], v[232:235], v[72:75], v[200:203]
    v_cvt_pk_bf16_f32 v220, v188, v189
    v_mfma_f32_16x16x32_bf16 v[204:207], v[232:235], v[76:79], v[204:207]
    s_waitcnt vmcnt(8)
    s_barrier
    ds_read_b128 v[224:227], v5 offset:16384
    v_cvt_pk_bf16_f32 v221, v190, v191
    s_waitcnt lgkmcnt(3)
    v_mfma_f32_16x16x32_bf16 v[208:211], v[236:239], v[72:75], v[208:211]
    v_cvt_pk_bf16_f32 v222, v196, v197
    v_mfma_f32_16x16x32_bf16 v[212:215], v[236:239], v[76:79], v[212:215]
    s_add_u32 s22, s24, 0x180000
    s_add_u32 m0, s20, 0x1c000
    s_nop 0
    buffer_load_dwordx4 v3, s[4:7], s22 offen lds
    ds_read_b128 v[228:231], v5 offset:17408
    v_cvt_pk_bf16_f32 v223, v198, v199
    v_mov_b32 v20, s28
    v_mov_b32 v21, 0
    s_lshl_b32 s16, s2, 2
    s_add_u32 s16, s16, 0x560000
    s_cmp_eq_u32 s3, 0
    s_cselect_b32 s16, s16, 0x7ffffff0
    s_mov_b64 exec, 1
    buffer_store_dword v20, v21, s[8:11], s16 offen sc1
    s_mov_b64 exec, -1
    s_waitcnt lgkmcnt(3)
    v_mfma_f32_16x16x32_bf16 v[200:203], v[240:243], v[80:83], v[200:203]
    buffer_store_dwordx4 v[220:223], v2, s[8:11], s26 offen offset:2048 sc1
    s_add_u32 s16, s63, 0x572000
    v_mov_b32 v14, s28
    v_mov_b32 v15, 0
    s_mov_b64 exec, 1
    buffer_store_dword v14, v15, s[8:11], s16 offen sc1
    s_mov_b64 exec, -1
    v_mfma_f32_16x16x32_bf16 v[204:207], v[240:243], v[84:87], v[204:207]
    ds_read_b128 v[232:235], v5 offset:18432
    s_waitcnt lgkmcnt(3)
    v_mfma_f32_16x16x32_bf16 v[208:211], v[244:247], v[80:83], v[208:211]
    v_mfma_f32_16x16x32_bf16 v[212:215], v[244:247], v[84:87], v[212:215]
    ds_read_b128 v[236:239], v5 offset:19456
    s_waitcnt lgkmcnt(3)
    v_mfma_f32_16x16x32_bf16 v[200:203], v[224:227], v[88:91], v[200:203]
    v_mfma_f32_16x16x32_bf16 v[204:207], v[224:227], v[92:95], v[204:207]
    ds_read_b128 v[240:243], v5 offset:20480
    s_waitcnt vmcnt(6)
    v_cmp_ne_u32 vcc, s28, v12
    s_cbranch_vccnz adaLN_cond__sliding_block_cached__moe_arch_mod__prompt_kernel_o5r
adaLN_cond__sliding_block_cached__moe_arch_mod__prompt_kernel_o5b:
    s_waitcnt lgkmcnt(3)
    v_mfma_f32_16x16x32_bf16 v[208:211], v[228:231], v[88:91], v[208:211]
    s_mov_b32 s23, 0x0
    buffer_load_dwordx4 v[24:27], v6, s[8:11], s23 offen offset:0 sc1
    v_mfma_f32_16x16x32_bf16 v[212:215], v[228:231], v[92:95], v[212:215]
    s_add_u32 s22, s24, 0x182000
    s_add_u32 m0, s20, 0x1c400
    s_nop 0
    buffer_load_dwordx4 v3, s[4:7], s22 offen lds
    ds_read_b128 v[244:247], v5 offset:21504
    s_waitcnt lgkmcnt(3)
    v_mfma_f32_16x16x32_bf16 v[200:203], v[232:235], v[96:99], v[200:203]
    s_mov_b32 s23, 0x20000
    buffer_load_dwordx4 v[28:31], v6, s[8:11], s23 offen offset:0 sc1
    v_mfma_f32_16x16x32_bf16 v[204:207], v[232:235], v[100:103], v[204:207]
    ds_read_b128 v[224:227], v5 offset:22528
    s_waitcnt lgkmcnt(3)
    v_mfma_f32_16x16x32_bf16 v[208:211], v[236:239], v[96:99], v[208:211]
    v_mfma_f32_16x16x32_bf16 v[212:215], v[236:239], v[100:103], v[212:215]
    ds_read_b128 v[228:231], v5 offset:23552
    s_mov_b32 s23, 0x2000
    buffer_load_dwordx4 v[32:35], v6, s[8:11], s23 offen offset:0 sc1
    s_waitcnt lgkmcnt(3)
    v_mfma_f32_16x16x32_bf16 v[200:203], v[240:243], v[104:107], v[200:203]
    v_mfma_f32_16x16x32_bf16 v[204:207], v[240:243], v[108:111], v[204:207]
    ds_read_b128 v[232:235], v5 offset:24576
    s_waitcnt lgkmcnt(3)
    v_mfma_f32_16x16x32_bf16 v[208:211], v[244:247], v[104:107], v[208:211]
    s_mov_b32 s23, 0x22000
    buffer_load_dwordx4 v[36:39], v6, s[8:11], s23 offen offset:0 sc1
    v_mfma_f32_16x16x32_bf16 v[212:215], v[244:247], v[108:111], v[212:215]
    ds_read_b128 v[236:239], v5 offset:25600
    s_waitcnt lgkmcnt(3)
    v_mfma_f32_16x16x32_bf16 v[200:203], v[224:227], v[112:115], v[200:203]
    v_mfma_f32_16x16x32_bf16 v[204:207], v[224:227], v[116:119], v[204:207]
    ds_read_b128 v[240:243], v5 offset:26624
    s_mov_b32 s23, 0x4000
    buffer_load_dwordx4 v[40:43], v6, s[8:11], s23 offen offset:0 sc1
    s_waitcnt lgkmcnt(3)
    v_mfma_f32_16x16x32_bf16 v[208:211], v[228:231], v[112:115], v[208:211]
    v_mfma_f32_16x16x32_bf16 v[212:215], v[228:231], v[116:119], v[212:215]
    ds_read_b128 v[244:247], v5 offset:27648
    s_waitcnt lgkmcnt(3)
    v_mfma_f32_16x16x32_bf16 v[200:203], v[232:235], v[120:123], v[200:203]
    s_mov_b32 s23, 0x24000
    buffer_load_dwordx4 v[44:47], v6, s[8:11], s23 offen offset:0 sc1
    v_mfma_f32_16x16x32_bf16 v[204:207], v[232:235], v[124:127], v[204:207]
    ds_read_b128 v[224:227], v5 offset:28672
    s_waitcnt lgkmcnt(3)
    v_mfma_f32_16x16x32_bf16 v[208:211], v[236:239], v[120:123], v[208:211]
    v_mfma_f32_16x16x32_bf16 v[212:215], v[236:239], v[124:127], v[212:215]
    ds_read_b128 v[228:231], v5 offset:29696
    s_mov_b32 s23, 0x6000
    buffer_load_dwordx4 v[48:51], v6, s[8:11], s23 offen offset:0 sc1
    s_waitcnt lgkmcnt(3)
    v_mfma_f32_16x16x32_bf16 v[200:203], v[240:243], v[128:131], v[200:203]
    v_mfma_f32_16x16x32_bf16 v[204:207], v[240:243], v[132:135], v[204:207]
    ds_read_b128 v[232:235], v5 offset:30720
    s_waitcnt lgkmcnt(3)
    v_mfma_f32_16x16x32_bf16 v[208:211], v[244:247], v[128:131], v[208:211]
    s_mov_b32 s23, 0x26000
    buffer_load_dwordx4 v[52:55], v6, s[8:11], s23 offen offset:0 sc1
    v_mfma_f32_16x16x32_bf16 v[212:215], v[244:247], v[132:135], v[212:215]
    ds_read_b128 v[236:239], v5 offset:31744
    s_waitcnt lgkmcnt(3)
    v_mfma_f32_16x16x32_bf16 v[200:203], v[224:227], v[136:139], v[200:203]
    v_bfe_u32 v18, v1, 2, 2
    v_lshrrev_b32 v19, 4, v1
    v_mfma_f32_16x16x32_bf16 v[204:207], v[224:227], v[140:143], v[204:207]
    s_mov_b32 s23, 0x8000
    buffer_load_dwordx4 v[56:59], v6, s[8:11], s23 offen offset:0 sc1
    v_and_b32 v17, 3, v1
    v_lshlrev_b32 v16, 11, v19
    s_waitcnt lgkmcnt(2)
    v_mfma_f32_16x16x32_bf16 v[208:211], v[228:231], v[136:139], v[208:211]
    v_lshl_add_u32 v16, v18, 6, v16
    v_lshl_add_u32 v16, v17, 3, v16
    v_mfma_f32_16x16x32_bf16 v[212:215], v[228:231], v[140:143], v[212:215]
    v_add_u32 v16, 0x10000, v16
    v_and_b32 v19, 1, v19
    s_waitcnt lgkmcnt(1)
    v_mfma_f32_16x16x32_bf16 v[200:203], v[232:235], v[144:147], v[200:203]
    s_mov_b32 s23, 0x28000
    buffer_load_dwordx4 v[60:63], v6, s[8:11], s23 offen offset:0 sc1
    v_lshlrev_b32 v19, 5, v19
    v_sub_u32 v5, v16, v19
    v_mfma_f32_16x16x32_bf16 v[204:207], v[232:235], v[148:151], v[204:207]
    v_add_u32 v4, v16, v19
    v_add_u32 v7, 0x10000, v4
    s_waitcnt lgkmcnt(0)
    v_mfma_f32_16x16x32_bf16 v[208:211], v[236:239], v[144:147], v[208:211]
    v_add_u32 v8, 0x10000, v5
    v_mfma_f32_16x16x32_bf16 v[212:215], v[236:239], v[148:151], v[212:215]
    v_mul_f32 v200, v200, v9
    v_mul_f32 v201, v201, v9
    v_mul_f32 v202, v202, v9
    v_mul_f32 v203, v203, v9
    s_nop 1
    v_mul_f32 v208, v208, v9
    v_mul_f32 v209, v209, v9
    v_mul_f32 v210, v210, v9
    v_mul_f32 v211, v211, v9
    v_cvt_pk_bf16_f32 v216, v200, v201
    v_cvt_pk_bf16_f32 v217, v202, v203
    v_cvt_pk_bf16_f32 v218, v208, v209
    v_cvt_pk_bf16_f32 v219, v210, v211
    buffer_store_dwordx4 v[216:219], v2, s[8:11], s25 offen offset:3072 sc1
    v_mul_f32 v204, v204, v10
    v_mul_f32 v205, v205, v10
    v_mul_f32 v206, v206, v10
    v_mul_f32 v207, v207, v10
    v_mul_f32 v212, v212, v10
    v_mul_f32 v213, v213, v10
    v_mul_f32 v214, v214, v10
    v_mul_f32 v215, v215, v10
    v_cvt_pk_bf16_f32 v220, v204, v205
    v_cvt_pk_bf16_f32 v221, v206, v207
    v_cvt_pk_bf16_f32 v222, v212, v213
    v_cvt_pk_bf16_f32 v223, v214, v215
    buffer_store_dwordx4 v[220:223], v2, s[8:11], s26 offen offset:3072 sc1
    s_and_b32 s15, s2, 1
    s_barrier
    ds_read_b64_tr_b16 v[224:225], v4 offset:0
    ds_read_b64_tr_b16 v[226:227], v4 offset:1024
    ds_read_b64_tr_b16 v[228:229], v5 offset:32
    ds_read_b64_tr_b16 v[230:231], v5 offset:1056
    ds_read_b64_tr_b16 v[232:233], v4 offset:256
    ds_read_b64_tr_b16 v[234:235], v4 offset:1280
    ds_read_b64_tr_b16 v[236:237], v5 offset:288
    ds_read_b64_tr_b16 v[238:239], v5 offset:1312
    s_waitcnt vmcnt(12) lgkmcnt(6)
    v_mfma_f32_16x16x32_bf16 v[88:91], v[224:227], v[24:27], 0
    ds_read_b64_tr_b16 v[240:241], v4 offset:512
    s_waitcnt vmcnt(10)
    v_mfma_f32_16x16x32_bf16 v[92:95], v[224:227], v[28:31], 0
    s_add_u32 s22, s24, 0x200000
    s_add_u32 m0, s20, 0x20000
    s_nop 0
    buffer_load_dwordx4 v3, s[4:7], s22 offen lds
    ds_read_b64_tr_b16 v[242:243], v4 offset:1536
    s_waitcnt lgkmcnt(6)
    v_mfma_f32_16x16x32_bf16 v[96:99], v[228:231], v[24:27], 0
    ds_read_b64_tr_b16 v[244:245], v5 offset:544
    s_mov_b32 s23, 0xa000
    buffer_load_dwordx4 v[64:67], v6, s[8:11], s23 offen offset:0 sc1
    v_mfma_f32_16x16x32_bf16 v[100:103], v[228:231], v[28:31], 0
    ds_read_b64_tr_b16 v[246:247], v5 offset:1568
    s_waitcnt lgkmcnt(6)
    v_mfma_f32_16x16x32_bf16 v[104:107], v[232:235], v[24:27], 0
    s_add_u32 s22, s24, 0x202000
    s_add_u32 m0, s20, 0x20400
    s_nop 0
    buffer_load_dwordx4 v3, s[4:7], s22 offen lds
    ds_read_b64_tr_b16 v[224:225], v4 offset:768
    v_mfma_f32_16x16x32_bf16 v[108:111], v[232:235], v[28:31], 0
    ds_read_b64_tr_b16 v[226:227], v4 offset:1792
    s_mov_b32 s23, 0x2a000
    buffer_load_dwordx4 v[68:71], v6, s[8:11], s23 offen offset:0 sc1
    s_waitcnt lgkmcnt(6)
    v_mfma_f32_16x16x32_bf16 v[112:115], v[236:239], v[24:27], 0
    ds_read_b64_tr_b16 v[228:229], v5 offset:800
    v_mfma_f32_16x16x32_bf16 v[116:119], v[236:239], v[28:31], 0
    ds_read_b64_tr_b16 v[230:231], v5 offset:1824
    s_waitcnt lgkmcnt(6)
    v_mfma_f32_16x16x32_bf16 v[120:123], v[240:243], v[24:27], 0
    v_mfma_f32_16x16x32_bf16 v[124:127], v[240:243], v[28:31], 0
    s_barrier
    ds_read_b64_tr_b16 v[232:233], v4 offset:16384
    ds_read_b64_tr_b16 v[234:235], v4 offset:17408
    s_waitcnt lgkmcnt(6)
    v_mfma_f32_16x16x32_bf16 v[128:131], v[244:247], v[24:27], 0
    s_add_u32 s22, s24, 0x280000
    s_add_u32 m0, s20, 0x24000
    s_nop 0
    buffer_load_dwordx4 v3, s[4:7], s22 offen lds
    ds_read_b64_tr_b16 v[236:237], v5 offset:16416
    v_mfma_f32_16x16x32_bf16 v[132:135], v[244:247], v[28:31], 0
    ds_read_b64_tr_b16 v[238:239], v5 offset:17440
    s_waitcnt lgkmcnt(6)
    v_mfma_f32_16x16x32_bf16 v[136:139], v[224:227], v[24:27], 0
    ds_read_b64_tr_b16 v[240:241], v4 offset:16640
    v_mfma_f32_16x16x32_bf16 v[140:143], v[224:227], v[28:31], 0
    s_add_u32 s22, s24, 0x282000
    s_add_u32 m0, s20, 0x24400
    s_nop 0
    buffer_load_dwordx4 v3, s[4:7], s22 offen lds
    ds_read_b64_tr_b16 v[242:243], v4 offset:17664
    s_waitcnt lgkmcnt(6)
    v_mfma_f32_16x16x32_bf16 v[144:147], v[228:231], v[24:27], 0
    ds_read_b64_tr_b16 v[244:245], v5 offset:16672
    v_mfma_f32_16x16x32_bf16 v[148:151], v[228:231], v[28:31], 0
    ds_read_b64_tr_b16 v[246:247], v5 offset:17696
    s_waitcnt vmcnt(15) lgkmcnt(6)
    v_mfma_f32_16x16x32_bf16 v[88:91], v[232:235], v[32:35], v[88:91]
    ds_read_b64_tr_b16 v[224:225], v4 offset:16896
    s_waitcnt vmcnt(14)
    v_mfma_f32_16x16x32_bf16 v[92:95], v[232:235], v[36:39], v[92:95]
    ds_read_b64_tr_b16 v[226:227], v4 offset:17920
    s_waitcnt lgkmcnt(6)
    v_mfma_f32_16x16x32_bf16 v[96:99], v[236:239], v[32:35], v[96:99]
    ds_read_b64_tr_b16 v[228:229], v5 offset:16928
    s_mov_b32 s23, 0xc000
    buffer_load_dwordx4 v[24:27], v6, s[8:11], s23 offen offset:0 sc1
    v_mfma_f32_16x16x32_bf16 v[100:103], v[236:239], v[36:39], v[100:103]
    ds_read_b64_tr_b16 v[230:231], v5 offset:17952
    s_waitcnt lgkmcnt(6)
    v_mfma_f32_16x16x32_bf16 v[104:107], v[240:243], v[32:35], v[104:107]
    v_and_b32 v250, 7, v1
    v_lshlrev_b32 v250, 7, v250
    s_lshr_b32 s14, s2, 3
    s_lshl_b32 s14, s14, 2
    s_add_u32 s14, s14, 0x560000
    buffer_load_dword v248, v250, s[8:11], s14 offen sc1
    ds_read_b64_tr_b16 v[232:233], v4 offset:17152
    v_mfma_f32_16x16x32_bf16 v[108:111], v[240:243], v[36:39], v[108:111]
    ds_read_b64_tr_b16 v[234:235], v4 offset:18176
    s_mov_b32 s23, 0x2c000
    buffer_load_dwordx4 v[28:31], v6, s[8:11], s23 offen offset:0 sc1
    s_waitcnt lgkmcnt(6)
    v_mfma_f32_16x16x32_bf16 v[112:115], v[244:247], v[32:35], v[112:115]
    ds_read_b64_tr_b16 v[236:237], v5 offset:17184
    v_mfma_f32_16x16x32_bf16 v[116:119], v[244:247], v[36:39], v[116:119]
    ds_read_b64_tr_b16 v[238:239], v5 offset:18208
    s_waitcnt lgkmcnt(6)
    v_mfma_f32_16x16x32_bf16 v[120:123], v[224:227], v[32:35], v[120:123]
    v_mfma_f32_16x16x32_bf16 v[124:127], v[224:227], v[36:39], v[124:127]
    s_barrier
    ds_read_b64_tr_b16 v[240:241], v4 offset:32768
    ds_read_b64_tr_b16 v[242:243], v4 offset:33792
    s_add_u32 s19, s19, 8192
    buffer_load_dword v12, v13, s[8:11], s19 offen sc1
    s_waitcnt lgkmcnt(6)
    v_mfma_f32_16x16x32_bf16 v[128:131], v[228:231], v[32:35], v[128:131]
    s_add_u32 s22, s24, 0x300000
    s_add_u32 m0, s20, 0x10000
    s_nop 0
    buffer_load_dwordx4 v3, s[4:7], s22 offen lds
    ds_read_b64_tr_b16 v[244:245], v5 offset:32800
    v_mfma_f32_16x16x32_bf16 v[132:135], v[228:231], v[36:39], v[132:135]
    ds_read_b64_tr_b16 v[246:247], v5 offset:33824
    s_waitcnt lgkmcnt(6)
    v_mfma_f32_16x16x32_bf16 v[136:139], v[232:235], v[32:35], v[136:139]
    ds_read_b64_tr_b16 v[224:225], v4 offset:33024
    v_mfma_f32_16x16x32_bf16 v[140:143], v[232:235], v[36:39], v[140:143]
    s_add_u32 s22, s24, 0x302000
    s_add_u32 m0, s20, 0x10400
    s_nop 0
    buffer_load_dwordx4 v3, s[4:7], s22 offen lds
    ds_read_b64_tr_b16 v[226:227], v4 offset:34048
    s_waitcnt lgkmcnt(6)
    v_mfma_f32_16x16x32_bf16 v[144:147], v[236:239], v[32:35], v[144:147]
    s_add_u32 s16, s63, 0x574000
    v_mov_b32 v14, s28
    v_mov_b32 v15, 0
    s_mov_b64 exec, 1
    buffer_store_dword v14, v15, s[8:11], s16 offen sc1
    s_mov_b64 exec, -1
    ds_read_b64_tr_b16 v[228:229], v5 offset:33056
    v_mfma_f32_16x16x32_bf16 v[148:151], v[236:239], v[36:39], v[148:151]
    ds_read_b64_tr_b16 v[230:231], v5 offset:34080
    s_waitcnt vmcnt(20) lgkmcnt(6)
    v_mfma_f32_16x16x32_bf16 v[88:91], v[240:243], v[40:43], v[88:91]
    ds_read_b64_tr_b16 v[232:233], v4 offset:33280
    s_waitcnt vmcnt(19)
    v_mfma_f32_16x16x32_bf16 v[92:95], v[240:243], v[44:47], v[92:95]
    ds_read_b64_tr_b16 v[234:235], v4 offset:34304
    s_waitcnt lgkmcnt(6)
    v_mfma_f32_16x16x32_bf16 v[96:99], v[244:247], v[40:43], v[96:99]
    ds_read_b64_tr_b16 v[236:237], v5 offset:33312
    s_mov_b32 s23, 0xe000
    buffer_load_dwordx4 v[32:35], v6, s[8:11], s23 offen offset:0 sc1
    v_mfma_f32_16x16x32_bf16 v[100:103], v[244:247], v[44:47], v[100:103]
    ds_read_b64_tr_b16 v[238:239], v5 offset:34336
    s_waitcnt lgkmcnt(6)
    v_mfma_f32_16x16x32_bf16 v[104:107], v[224:227], v[40:43], v[104:107]
    ds_read_b64_tr_b16 v[240:241], v4 offset:33536
    v_mfma_f32_16x16x32_bf16 v[108:111], v[224:227], v[44:47], v[108:111]
    ds_read_b64_tr_b16 v[242:243], v4 offset:34560
    s_mov_b32 s23, 0x2e000
    buffer_load_dwordx4 v[36:39], v6, s[8:11], s23 offen offset:0 sc1
    s_waitcnt lgkmcnt(6)
    v_mfma_f32_16x16x32_bf16 v[112:115], v[228:231], v[40:43], v[112:115]
    ds_read_b64_tr_b16 v[244:245], v5 offset:33568
    v_mfma_f32_16x16x32_bf16 v[116:119], v[228:231], v[44:47], v[116:119]
    ds_read_b64_tr_b16 v[246:247], v5 offset:34592
    s_waitcnt lgkmcnt(6)
    v_mfma_f32_16x16x32_bf16 v[120:123], v[232:235], v[40:43], v[120:123]
    v_mfma_f32_16x16x32_bf16 v[124:127], v[232:235], v[44:47], v[124:127]
    s_barrier
    ds_read_b64_tr_b16 v[224:225], v4 offset:49152
    ds_read_b64_tr_b16 v[226:227], v4 offset:50176
    s_waitcnt lgkmcnt(6)
    v_mfma_f32_16x16x32_bf16 v[128:131], v[236:239], v[40:43], v[128:131]
    s_add_u32 s22, s24, 0x380000
    s_add_u32 m0, s20, 0x14000
    s_nop 0
    buffer_load_dwordx4 v3, s[4:7], s22 offen lds
    ds_read_b64_tr_b16 v[228:229], v5 offset:49184
    v_mfma_f32_16x16x32_bf16 v[132:135], v[236:239], v[44:47], v[132:135]
    ds_read_b64_tr_b16 v[230:231], v5 offset:50208
    s_waitcnt lgkmcnt(6)
    v_mfma_f32_16x16x32_bf16 v[136:139], v[240:243], v[40:43], v[136:139]
    ds_read_b64_tr_b16 v[232:233], v4 offset:49408
    v_mfma_f32_16x16x32_bf16 v[140:143], v[240:243], v[44:47], v[140:143]
    s_add_u32 s22, s24, 0x382000
    s_add_u32 m0, s20, 0x14400
    s_nop 0
    buffer_load_dwordx4 v3, s[4:7], s22 offen lds
    ds_read_b64_tr_b16 v[234:235], v4 offset:50432
    s_waitcnt lgkmcnt(6)
    v_mfma_f32_16x16x32_bf16 v[144:147], v[244:247], v[40:43], v[144:147]
    ds_read_b64_tr_b16 v[236:237], v5 offset:49440
    v_mfma_f32_16x16x32_bf16 v[148:151], v[244:247], v[44:47], v[148:151]
    ds_read_b64_tr_b16 v[238:239], v5 offset:50464
    s_waitcnt vmcnt(7)
    v_cmp_ne_u32 vcc, s28, v12
    s_cbranch_vccnz adaLN_cond__sliding_block_cached__moe_arch_mod__prompt_kernel_o26r
adaLN_cond__sliding_block_cached__moe_arch_mod__prompt_kernel_o26b:
    s_waitcnt lgkmcnt(6)
    v_mfma_f32_16x16x32_bf16 v[88:91], v[224:227], v[48:51], v[88:91]
    ds_read_b64_tr_b16 v[240:241], v4 offset:49664
    v_mfma_f32_16x16x32_bf16 v[92:95], v[224:227], v[52:55], v[92:95]
    ds_read_b64_tr_b16 v[242:243], v4 offset:50688
    s_waitcnt lgkmcnt(6)
    v_mfma_f32_16x16x32_bf16 v[96:99], v[228:231], v[48:51], v[96:99]
    ds_read_b64_tr_b16 v[244:245], v5 offset:49696
    s_mov_b32 s23, 0x0
    buffer_load_dwordx4 v[40:43], v6, s[8:11], s23 offen offset:1024 sc1
    v_mfma_f32_16x16x32_bf16 v[100:103], v[228:231], v[52:55], v[100:103]
    ds_read_b64_tr_b16 v[246:247], v5 offset:50720
    s_waitcnt lgkmcnt(6)
    v_mfma_f32_16x16x32_bf16 v[104:107], v[232:235], v[48:51], v[104:107]
    ds_read_b64_tr_b16 v[224:225], v4 offset:49920
    v_mfma_f32_16x16x32_bf16 v[108:111], v[232:235], v[52:55], v[108:111]
    ds_read_b64_tr_b16 v[226:227], v4 offset:50944
    s_mov_b32 s23, 0x20000
    buffer_load_dwordx4 v[44:47], v6, s[8:11], s23 offen offset:1024 sc1
    s_waitcnt lgkmcnt(6)
    v_mfma_f32_16x16x32_bf16 v[112:115], v[236:239], v[48:51], v[112:115]
    ds_read_b64_tr_b16 v[228:229], v5 offset:49952
    v_mfma_f32_16x16x32_bf16 v[116:119], v[236:239], v[52:55], v[116:119]
    ds_read_b64_tr_b16 v[230:231], v5 offset:50976
    s_waitcnt lgkmcnt(6)
    v_mfma_f32_16x16x32_bf16 v[120:123], v[240:243], v[48:51], v[120:123]
    v_mfma_f32_16x16x32_bf16 v[124:127], v[240:243], v[52:55], v[124:127]
    s_barrier
    ds_read_b64_tr_b16 v[232:233], v7 offset:0
    ds_read_b64_tr_b16 v[234:235], v7 offset:1024
    s_waitcnt lgkmcnt(6)
    v_mfma_f32_16x16x32_bf16 v[128:131], v[244:247], v[48:51], v[128:131]
    s_add_u32 s22, s24, 0x10000
    s_add_u32 m0, s20, 0x18000
    s_nop 0
    buffer_load_dwordx4 v3, s[4:7], s22 offen lds
    ds_read_b64_tr_b16 v[236:237], v8 offset:32
    v_mfma_f32_16x16x32_bf16 v[132:135], v[244:247], v[52:55], v[132:135]
    ds_read_b64_tr_b16 v[238:239], v8 offset:1056
    s_waitcnt lgkmcnt(6)
    v_mfma_f32_16x16x32_bf16 v[136:139], v[224:227], v[48:51], v[136:139]
    v_cmp_ne_u32 vcc, s28, v248
    s_cbranch_vccnz adaLN_cond__sliding_block_cached__moe_arch_mod__prompt_kernel_mp7r
adaLN_cond__sliding_block_cached__moe_arch_mod__prompt_kernel_mp7b:
    ds_read_b64_tr_b16 v[240:241], v7 offset:256
    v_mfma_f32_16x16x32_bf16 v[140:143], v[224:227], v[52:55], v[140:143]
    v_lshrrev_b32 v250, 4, v1
    v_lshlrev_b32 v250, 14, v250
    v_and_b32 v253, 15, v1
    v_lshl_add_u32 v250, v253, 2, v250
    s_lshl_b32 s14, s2, 6
    s_add_u32 s14, s14, 0x580000
    buffer_load_dword v249, v250, s[8:11], s14 offen sc1
    s_add_u32 s14, s14, 0x10000
    buffer_load_dword v254, v250, s[8:11], s14 offen sc1
    s_add_u32 s22, s24, 0x12000
    s_add_u32 m0, s20, 0x18400
    s_nop 0
    buffer_load_dwordx4 v3, s[4:7], s22 offen lds
    ds_read_b64_tr_b16 v[242:243], v7 offset:1280
    s_waitcnt lgkmcnt(6)
    v_mfma_f32_16x16x32_bf16 v[144:147], v[228:231], v[48:51], v[144:147]
    ds_read_b64_tr_b16 v[244:245], v8 offset:288
    v_mfma_f32_16x16x32_bf16 v[148:151], v[228:231], v[52:55], v[148:151]
    ds_read_b64_tr_b16 v[246:247], v8 offset:1312
    s_waitcnt lgkmcnt(6)
    v_mfma_f32_16x16x32_bf16 v[88:91], v[232:235], v[56:59], v[88:91]
    ds_read_b64_tr_b16 v[224:225], v7 offset:512
    v_mfma_f32_16x16x32_bf16 v[92:95], v[232:235], v[60:63], v[92:95]
    ds_read_b64_tr_b16 v[226:227], v7 offset:1536
    s_waitcnt lgkmcnt(6)
    v_mfma_f32_16x16x32_bf16 v[96:99], v[236:239], v[56:59], v[96:99]
    ds_read_b64_tr_b16 v[228:229], v8 offset:544
    s_mov_b32 s23, 0x2000
    buffer_load_dwordx4 v[48:51], v6, s[8:11], s23 offen offset:1024 sc1
    v_mfma_f32_16x16x32_bf16 v[100:103], v[236:239], v[60:63], v[100:103]
    ds_read_b64_tr_b16 v[230:231], v8 offset:1568
    s_waitcnt lgkmcnt(6)
    v_mfma_f32_16x16x32_bf16 v[104:107], v[240:243], v[56:59], v[104:107]
    ds_read_b64_tr_b16 v[232:233], v7 offset:768
    v_mfma_f32_16x16x32_bf16 v[108:111], v[240:243], v[60:63], v[108:111]
    ds_read_b64_tr_b16 v[234:235], v7 offset:1792
    s_mov_b32 s23, 0x22000
    buffer_load_dwordx4 v[52:55], v6, s[8:11], s23 offen offset:1024 sc1
    s_waitcnt lgkmcnt(6)
    v_mfma_f32_16x16x32_bf16 v[112:115], v[244:247], v[56:59], v[112:115]
    ds_read_b64_tr_b16 v[236:237], v8 offset:800
    v_mfma_f32_16x16x32_bf16 v[116:119], v[244:247], v[60:63], v[116:119]
    ds_read_b64_tr_b16 v[238:239], v8 offset:1824
    s_waitcnt lgkmcnt(6)
    v_mfma_f32_16x16x32_bf16 v[120:123], v[224:227], v[56:59], v[120:123]
    v_mfma_f32_16x16x32_bf16 v[124:127], v[224:227], v[60:63], v[124:127]
    s_barrier
    ds_read_b64_tr_b16 v[240:241], v7 offset:16384
    ds_read_b64_tr_b16 v[242:243], v7 offset:17408
    s_waitcnt lgkmcnt(6)
    v_mfma_f32_16x16x32_bf16 v[128:131], v[228:231], v[56:59], v[128:131]
    s_add_u32 s22, s24, 0x90000
    s_add_u32 m0, s20, 0x1c000
    s_nop 0
    buffer_load_dwordx4 v3, s[4:7], s22 offen lds
    ds_read_b64_tr_b16 v[244:245], v8 offset:16416
    v_mfma_f32_16x16x32_bf16 v[132:135], v[228:231], v[60:63], v[132:135]
    ds_read_b64_tr_b16 v[246:247], v8 offset:17440
    s_waitcnt lgkmcnt(6)
    v_mfma_f32_16x16x32_bf16 v[136:139], v[232:235], v[56:59], v[136:139]
    ds_read_b64_tr_b16 v[224:225], v7 offset:16640
    v_mfma_f32_16x16x32_bf16 v[140:143], v[232:235], v[60:63], v[140:143]
    s_add_u32 s22, s24, 0x92000
    s_add_u32 m0, s20, 0x1c400
    s_nop 0
    buffer_load_dwordx4 v3, s[4:7], s22 offen lds
    ds_read_b64_tr_b16 v[226:227], v7 offset:17664
    s_waitcnt lgkmcnt(6)
    v_mfma_f32_16x16x32_bf16 v[144:147], v[236:239], v[56:59], v[144:147]
    ds_read_b64_tr_b16 v[228:229], v8 offset:16672
    v_mfma_f32_16x16x32_bf16 v[148:151], v[236:239], v[60:63], v[148:151]
    ds_read_b64_tr_b16 v[230:231], v8 offset:17696
    s_waitcnt lgkmcnt(6)
    v_mfma_f32_16x16x32_bf16 v[88:91], v[240:243], v[64:67], v[88:91]
    ds_read_b64_tr_b16 v[232:233], v7 offset:16896
    v_mfma_f32_16x16x32_bf16 v[92:95], v[240:243], v[68:71], v[92:95]
    ds_read_b64_tr_b16 v[234:235], v7 offset:17920
    s_waitcnt lgkmcnt(6)
    v_mfma_f32_16x16x32_bf16 v[96:99], v[244:247], v[64:67], v[96:99]
    ds_read_b64_tr_b16 v[236:237], v8 offset:16928
    s_mov_b32 s23, 0x4000
    buffer_load_dwordx4 v[56:59], v6, s[8:11], s23 offen offset:1024 sc1
    v_mfma_f32_16x16x32_bf16 v[100:103], v[244:247], v[68:71], v[100:103]
    ds_read_b64_tr_b16 v[238:239], v8 offset:17952
    s_waitcnt lgkmcnt(6)
    v_mfma_f32_16x16x32_bf16 v[104:107], v[224:227], v[64:67], v[104:107]
    s_waitcnt vmcnt(6)
    v_add_f32 v249, v249, v254
    v_mov_b32 v250, v249
    s_nop 1
    v_permlane16_swap_b32 v249, v250
    v_add_f32 v249, v249, v250
    v_mov_b32 v250, v249
    s_nop 1
    v_permlane32_swap_b32 v249, v250
    v_add_f32 v249, v249, v250
    v_cvt_pk_bf16_f32 v249, v249, v249
    v_lshlrev_b32 v249, 16, v249
    s_lshr_b32 s14, s2, 6
    s_cmp_eq_u32 s14, 2
    s_cselect_b32 s14, 1.0, 0
    v_add_f32 v249, s14, v249
    v_cvt_pk_bf16_f32 v249, v249, v249
    v_lshlrev_b32 v253, 1, v253
    s_lshl_b32 s14, s2, 5
    s_add_u32 s14, s14, 0x540000
    s_cmp_eq_u32 s3, 0
    s_cselect_b32 s14, s14, 0x7ffffff0
    s_mov_b64 exec, 0xffff
    buffer_store_short v249, v253, s[8:11], s14 offen sc1
    s_mov_b64 exec, -1
    ds_read_b64_tr_b16 v[240:241], v7 offset:17152
    v_mfma_f32_16x16x32_bf16 v[108:111], v[224:227], v[68:71], v[108:111]
    ds_read_b64_tr_b16 v[242:243], v7 offset:18176
    s_mov_b32 s23, 0x24000
    buffer_load_dwordx4 v[60:63], v6, s[8:11], s23 offen offset:1024 sc1
    s_waitcnt lgkmcnt(6)
    v_mfma_f32_16x16x32_bf16 v[112:115], v[228:231], v[64:67], v[112:115]
    ds_read_b64_tr_b16 v[244:245], v8 offset:17184
    v_mfma_f32_16x16x32_bf16 v[116:119], v[228:231], v[68:71], v[116:119]
    ds_read_b64_tr_b16 v[246:247], v8 offset:18208
    s_waitcnt lgkmcnt(6)
    v_mfma_f32_16x16x32_bf16 v[120:123], v[232:235], v[64:67], v[120:123]
    v_mfma_f32_16x16x32_bf16 v[124:127], v[232:235], v[68:71], v[124:127]
    s_barrier
    ds_read_b64_tr_b16 v[224:225], v4 offset:0
    ds_read_b64_tr_b16 v[226:227], v4 offset:1024
    s_waitcnt lgkmcnt(6)
    v_mfma_f32_16x16x32_bf16 v[128:131], v[236:239], v[64:67], v[128:131]
    s_add_u32 s16, s63, 0x576000
    v_mov_b32 v14, s28
    v_mov_b32 v15, 0
    s_mov_b64 exec, 1
    buffer_store_dword v14, v15, s[8:11], s16 offen sc1
    s_mov_b64 exec, -1
    s_add_u32 s22, s24, 0x110000
    s_add_u32 m0, s20, 0x20000
    s_nop 0
    buffer_load_dwordx4 v3, s[4:7], s22 offen lds
    ds_read_b64_tr_b16 v[228:229], v5 offset:32
    v_mfma_f32_16x16x32_bf16 v[132:135], v[236:239], v[68:71], v[132:135]
    ds_read_b64_tr_b16 v[230:231], v5 offset:1056
    s_waitcnt lgkmcnt(6)
    v_mfma_f32_16x16x32_bf16 v[136:139], v[240:243], v[64:67], v[136:139]
    ds_read_b64_tr_b16 v[232:233], v4 offset:256
    v_mfma_f32_16x16x32_bf16 v[140:143], v[240:243], v[68:71], v[140:143]
    s_add_u32 s22, s24, 0x112000
    s_add_u32 m0, s20, 0x20400
    s_nop 0
    buffer_load_dwordx4 v3, s[4:7], s22 offen lds
    ds_read_b64_tr_b16 v[234:235], v4 offset:1280
    s_waitcnt lgkmcnt(6)
    v_mfma_f32_16x16x32_bf16 v[144:147], v[244:247], v[64:67], v[144:147]
    ds_read_b64_tr_b16 v[236:237], v5 offset:288
    v_mfma_f32_16x16x32_bf16 v[148:151], v[244:247], v[68:71], v[148:151]
    ds_read_b64_tr_b16 v[238:239], v5 offset:1312
    s_waitcnt lgkmcnt(6)
    v_mfma_f32_16x16x32_bf16 v[88:91], v[224:227], v[24:27], v[88:91]
    ds_read_b64_tr_b16 v[240:241], v4 offset:512
    v_mfma_f32_16x16x32_bf16 v[92:95], v[224:227], v[28:31], v[92:95]
    ds_read_b64_tr_b16 v[242:243], v4 offset:1536
    s_waitcnt lgkmcnt(6)
    v_mfma_f32_16x16x32_bf16 v[96:99], v[228:231], v[24:27], v[96:99]
    ds_read_b64_tr_b16 v[244:245], v5 offset:544
    s_mov_b32 s23, 0x6000
    buffer_load_dwordx4 v[64:67], v6, s[8:11], s23 offen offset:1024 sc1
    v_mfma_f32_16x16x32_bf16 v[100:103], v[228:231], v[28:31], v[100:103]
    ds_read_b64_tr_b16 v[246:247], v5 offset:1568
    s_waitcnt lgkmcnt(6)
    v_mfma_f32_16x16x32_bf16 v[104:107], v[232:235], v[24:27], v[104:107]
    ds_read_b64_tr_b16 v[224:225], v4 offset:768
    v_mfma_f32_16x16x32_bf16 v[108:111], v[232:235], v[28:31], v[108:111]
    ds_read_b64_tr_b16 v[226:227], v4 offset:1792
    s_mov_b32 s23, 0x26000
    buffer_load_dwordx4 v[68:71], v6, s[8:11], s23 offen offset:1024 sc1
    s_waitcnt lgkmcnt(6)
    v_mfma_f32_16x16x32_bf16 v[112:115], v[236:239], v[24:27], v[112:115]
    ds_read_b64_tr_b16 v[228:229], v5 offset:800
    v_mfma_f32_16x16x32_bf16 v[116:119], v[236:239], v[28:31], v[116:119]
    ds_read_b64_tr_b16 v[230:231], v5 offset:1824
    s_waitcnt lgkmcnt(6)
    v_mfma_f32_16x16x32_bf16 v[120:123], v[240:243], v[24:27], v[120:123]
    v_mfma_f32_16x16x32_bf16 v[124:127], v[240:243], v[28:31], v[124:127]
    s_barrier
    ds_read_b64_tr_b16 v[232:233], v4 offset:16384
    ds_read_b64_tr_b16 v[234:235], v4 offset:17408
    s_waitcnt lgkmcnt(6)
    v_mfma_f32_16x16x32_bf16 v[128:131], v[244:247], v[24:27], v[128:131]
    s_add_u32 s22, s24, 0x190000
    s_add_u32 m0, s20, 0x24000
    s_nop 0
    buffer_load_dwordx4 v3, s[4:7], s22 offen lds
    ds_read_b64_tr_b16 v[236:237], v5 offset:16416
    v_mfma_f32_16x16x32_bf16 v[132:135], v[244:247], v[28:31], v[132:135]
    ds_read_b64_tr_b16 v[238:239], v5 offset:17440
    s_waitcnt lgkmcnt(6)
    v_mfma_f32_16x16x32_bf16 v[136:139], v[224:227], v[24:27], v[136:139]
    ds_read_b64_tr_b16 v[240:241], v4 offset:16640
    v_mfma_f32_16x16x32_bf16 v[140:143], v[224:227], v[28:31], v[140:143]
    s_add_u32 s22, s24, 0x192000
    s_add_u32 m0, s20, 0x24400
    s_nop 0
    buffer_load_dwordx4 v3, s[4:7], s22 offen lds
    ds_read_b64_tr_b16 v[242:243], v4 offset:17664
    s_waitcnt lgkmcnt(6)
    v_mfma_f32_16x16x32_bf16 v[144:147], v[228:231], v[24:27], v[144:147]
    ds_read_b64_tr_b16 v[244:245], v5 offset:16672
    v_mfma_f32_16x16x32_bf16 v[148:151], v[228:231], v[28:31], v[148:151]
    ds_read_b64_tr_b16 v[246:247], v5 offset:17696
    s_waitcnt lgkmcnt(6)
    v_mfma_f32_16x16x32_bf16 v[88:91], v[232:235], v[32:35], v[88:91]
    ds_read_b64_tr_b16 v[224:225], v4 offset:16896
    v_mfma_f32_16x16x32_bf16 v[92:95], v[232:235], v[36:39], v[92:95]
    ds_read_b64_tr_b16 v[226:227], v4 offset:17920
    s_waitcnt lgkmcnt(6)
    v_mfma_f32_16x16x32_bf16 v[96:99], v[236:239], v[32:35], v[96:99]
    ds_read_b64_tr_b16 v[228:229], v5 offset:16928
    s_mov_b32 s23, 0x8000
    buffer_load_dwordx4 v[24:27], v6, s[8:11], s23 offen offset:1024 sc1
    v_mfma_f32_16x16x32_bf16 v[100:103], v[236:239], v[36:39], v[100:103]
    ds_read_b64_tr_b16 v[230:231], v5 offset:17952
    s_waitcnt lgkmcnt(6)
    v_mfma_f32_16x16x32_bf16 v[104:107], v[240:243], v[32:35], v[104:107]
    ds_read_b64_tr_b16 v[232:233], v4 offset:17152
    v_mfma_f32_16x16x32_bf16 v[108:111], v[240:243], v[36:39], v[108:111]
    ds_read_b64_tr_b16 v[234:235], v4 offset:18176
    s_mov_b32 s23, 0x28000
    buffer_load_dwordx4 v[28:31], v6, s[8:11], s23 offen offset:1024 sc1
    s_waitcnt lgkmcnt(6)
    v_mfma_f32_16x16x32_bf16 v[112:115], v[244:247], v[32:35], v[112:115]
    ds_read_b64_tr_b16 v[236:237], v5 offset:17184
    v_mfma_f32_16x16x32_bf16 v[116:119], v[244:247], v[36:39], v[116:119]
    ds_read_b64_tr_b16 v[238:239], v5 offset:18208
    s_waitcnt lgkmcnt(6)
    v_mfma_f32_16x16x32_bf16 v[120:123], v[224:227], v[32:35], v[120:123]
    v_mfma_f32_16x16x32_bf16 v[124:127], v[224:227], v[36:39], v[124:127]
    s_waitcnt vmcnt(16)
    s_barrier
    ds_read_b64_tr_b16 v[240:241], v4 offset:32768
    ds_read_b64_tr_b16 v[242:243], v4 offset:33792
    s_waitcnt lgkmcnt(6)
    v_mfma_f32_16x16x32_bf16 v[128:131], v[228:231], v[32:35], v[128:131]
    s_add_u32 s22, s24, 0x210000
    s_add_u32 m0, s20, 0x10000
    s_nop 0
    buffer_load_dwordx4 v3, s[4:7], s22 offen lds
    ds_read_b64_tr_b16 v[244:245], v5 offset:32800
    v_mfma_f32_16x16x32_bf16 v[132:135], v[228:231], v[36:39], v[132:135]
    ds_read_b64_tr_b16 v[246:247], v5 offset:33824
    s_waitcnt lgkmcnt(6)
    v_mfma_f32_16x16x32_bf16 v[136:139], v[232:235], v[32:35], v[136:139]
    ds_read_b64_tr_b16 v[224:225], v4 offset:33024
    v_mfma_f32_16x16x32_bf16 v[140:143], v[232:235], v[36:39], v[140:143]
    s_add_u32 s22, s24, 0x212000
    s_add_u32 m0, s20, 0x10400
    s_nop 0
    buffer_load_dwordx4 v3, s[4:7], s22 offen lds
    ds_read_b64_tr_b16 v[226:227], v4 offset:34048
    s_waitcnt lgkmcnt(6)
    v_mfma_f32_16x16x32_bf16 v[144:147], v[236:239], v[32:35], v[144:147]
    ds_read_b64_tr_b16 v[228:229], v5 offset:33056
    v_mfma_f32_16x16x32_bf16 v[148:151], v[236:239], v[36:39], v[148:151]
    ds_read_b64_tr_b16 v[230:231], v5 offset:34080
    s_waitcnt lgkmcnt(6)
    v_mfma_f32_16x16x32_bf16 v[88:91], v[240:243], v[40:43], v[88:91]
    ds_read_b64_tr_b16 v[232:233], v4 offset:33280
    v_mfma_f32_16x16x32_bf16 v[92:95], v[240:243], v[44:47], v[92:95]
    ds_read_b64_tr_b16 v[234:235], v4 offset:34304
    s_waitcnt lgkmcnt(6)
    v_mfma_f32_16x16x32_bf16 v[96:99], v[244:247], v[40:43], v[96:99]
    ds_read_b64_tr_b16 v[236:237], v5 offset:33312
    s_mov_b32 s23, 0xa000
    buffer_load_dwordx4 v[32:35], v6, s[8:11], s23 offen offset:1024 sc1
    v_mfma_f32_16x16x32_bf16 v[100:103], v[244:247], v[44:47], v[100:103]
    ds_read_b64_tr_b16 v[238:239], v5 offset:34336
    s_waitcnt lgkmcnt(6)
    v_mfma_f32_16x16x32_bf16 v[104:107], v[224:227], v[40:43], v[104:107]
    ds_read_b64_tr_b16 v[240:241], v4 offset:33536
    v_mfma_f32_16x16x32_bf16 v[108:111], v[224:227], v[44:47], v[108:111]
    ds_read_b64_tr_b16 v[242:243], v4 offset:34560
    s_mov_b32 s23, 0x2a000
    buffer_load_dwordx4 v[36:39], v6, s[8:11], s23 offen offset:1024 sc1
    s_waitcnt lgkmcnt(6)
    v_mfma_f32_16x16x32_bf16 v[112:115], v[228:231], v[40:43], v[112:115]
    ds_read_b64_tr_b16 v[244:245], v5 offset:33568
    v_mfma_f32_16x16x32_bf16 v[116:119], v[228:231], v[44:47], v[116:119]
    ds_read_b64_tr_b16 v[246:247], v5 offset:34592
    s_waitcnt lgkmcnt(6)
    v_mfma_f32_16x16x32_bf16 v[120:123], v[232:235], v[40:43], v[120:123]
    v_mfma_f32_16x16x32_bf16 v[124:127], v[232:235], v[44:47], v[124:127]
    s_waitcnt vmcnt(16)
    s_barrier
    ds_read_b64_tr_b16 v[224:225], v4 offset:49152
    ds_read_b64_tr_b16 v[226:227], v4 offset:50176
    s_waitcnt lgkmcnt(6)
    v_mfma_f32_16x16x32_bf16 v[128:131], v[236:239], v[40:43], v[128:131]
    s_add_u32 s22, s24, 0x290000
    s_add_u32 m0, s20, 0x14000
    s_nop 0
    buffer_load_dwordx4 v3, s[4:7], s22 offen lds
    ds_read_b64_tr_b16 v[228:229], v5 offset:49184
    v_mfma_f32_16x16x32_bf16 v[132:135], v[236:239], v[44:47], v[132:135]
    ds_read_b64_tr_b16 v[230:231], v5 offset:50208
    s_waitcnt lgkmcnt(6)
    v_mfma_f32_16x16x32_bf16 v[136:139], v[240:243], v[40:43], v[136:139]
    ds_read_b64_tr_b16 v[232:233], v4 offset:49408
    v_mfma_f32_16x16x32_bf16 v[140:143], v[240:243], v[44:47], v[140:143]
    s_add_u32 s22, s24, 0x292000
    s_add_u32 m0, s20, 0x14400
    s_nop 0
    buffer_load_dwordx4 v3, s[4:7], s22 offen lds
    ds_read_b64_tr_b16 v[234:235], v4 offset:50432
    s_waitcnt lgkmcnt(6)
    v_mfma_f32_16x16x32_bf16 v[144:147], v[244:247], v[40:43], v[144:147]
    ds_read_b64_tr_b16 v[236:237], v5 offset:49440
    v_mfma_f32_16x16x32_bf16 v[148:151], v[244:247], v[44:47], v[148:151]
    ds_read_b64_tr_b16 v[238:239], v5 offset:50464
    s_waitcnt lgkmcnt(6)
    v_mfma_f32_16x16x32_bf16 v[88:91], v[224:227], v[48:51], v[88:91]
    ds_read_b64_tr_b16 v[240:241], v4 offset:49664
    v_mfma_f32_16x16x32_bf16 v[92:95], v[224:227], v[52:55], v[92:95]
    ds_read_b64_tr_b16 v[242:243], v4 offset:50688
    s_waitcnt lgkmcnt(6)
    v_mfma_f32_16x16x32_bf16 v[96:99], v[228:231], v[48:51], v[96:99]
    ds_read_b64_tr_b16 v[244:245], v5 offset:49696
    s_mov_b32 s23, 0xc000
    buffer_load_dwordx4 v[40:43], v6, s[8:11], s23 offen offset:1024 sc1
    v_mfma_f32_16x16x32_bf16 v[100:103], v[228:231], v[52:55], v[100:103]
    ds_read_b64_tr_b16 v[246:247], v5 offset:50720
    s_waitcnt lgkmcnt(6)
    v_mfma_f32_16x16x32_bf16 v[104:107], v[232:235], v[48:51], v[104:107]
    ds_read_b64_tr_b16 v[224:225], v4 offset:49920
    v_mfma_f32_16x16x32_bf16 v[108:111], v[232:235], v[52:55], v[108:111]
    ds_read_b64_tr_b16 v[226:227], v4 offset:50944
    s_mov_b32 s23, 0x2c000
    buffer_load_dwordx4 v[44:47], v6, s[8:11], s23 offen offset:1024 sc1
    s_waitcnt lgkmcnt(6)
    v_mfma_f32_16x16x32_bf16 v[112:115], v[236:239], v[48:51], v[112:115]
    ds_read_b64_tr_b16 v[228:229], v5 offset:49952
    v_mfma_f32_16x16x32_bf16 v[116:119], v[236:239], v[52:55], v[116:119]
    ds_read_b64_tr_b16 v[230:231], v5 offset:50976
    s_waitcnt lgkmcnt(6)
    v_mfma_f32_16x16x32_bf16 v[120:123], v[240:243], v[48:51], v[120:123]
    v_mfma_f32_16x16x32_bf16 v[124:127], v[240:243], v[52:55], v[124:127]
    s_waitcnt vmcnt(14)
    s_barrier
    ds_read_b64_tr_b16 v[232:233], v7 offset:0
    ds_read_b64_tr_b16 v[234:235], v7 offset:1024
    s_add_u32 s19, s19, 8192
    buffer_load_dword v12, v13, s[8:11], s19 offen sc1
    s_waitcnt lgkmcnt(6)
    v_mfma_f32_16x16x32_bf16 v[128:131], v[244:247], v[48:51], v[128:131]
    s_add_u32 s22, s24, 0x310000
    s_add_u32 m0, s20, 0x18000
    s_nop 0
    buffer_load_dwordx4 v3, s[4:7], s22 offen lds
    ds_read_b64_tr_b16 v[236:237], v8 offset:32
    v_mfma_f32_16x16x32_bf16 v[132:135], v[244:247], v[52:55], v[132:135]
    ds_read_b64_tr_b16 v[238:239], v8 offset:1056
    s_waitcnt lgkmcnt(6)
    v_mfma_f32_16x16x32_bf16 v[136:139], v[224:227], v[48:51], v[136:139]
    ds_read_b64_tr_b16 v[240:241], v7 offset:256
    v_mfma_f32_16x16x32_bf16 v[140:143], v[224:227], v[52:55], v[140:143]
    s_add_u32 s22, s24, 0x312000
    s_add_u32 m0, s20, 0x18400
    s_nop 0
    buffer_load_dwordx4 v3, s[4:7], s22 offen lds
    ds_read_b64_tr_b16 v[242:243], v7 offset:1280
    s_waitcnt lgkmcnt(6)
    v_mfma_f32_16x16x32_bf16 v[144:147], v[228:231], v[48:51], v[144:147]
    ds_read_b64_tr_b16 v[244:245], v8 offset:288
    v_mfma_f32_16x16x32_bf16 v[148:151], v[228:231], v[52:55], v[148:151]
    ds_read_b64_tr_b16 v[246:247], v8 offset:1312
    s_waitcnt lgkmcnt(6)
    v_mfma_f32_16x16x32_bf16 v[88:91], v[232:235], v[56:59], v[88:91]
    ds_read_b64_tr_b16 v[224:225], v7 offset:512
    v_mfma_f32_16x16x32_bf16 v[92:95], v[232:235], v[60:63], v[92:95]
    ds_read_b64_tr_b16 v[226:227], v7 offset:1536
    s_waitcnt lgkmcnt(6)
    v_mfma_f32_16x16x32_bf16 v[96:99], v[236:239], v[56:59], v[96:99]
    ds_read_b64_tr_b16 v[228:229], v8 offset:544
    s_mov_b32 s23, 0xe000
    buffer_load_dwordx4 v[48:51], v6, s[8:11], s23 offen offset:1024 sc1
    v_mfma_f32_16x16x32_bf16 v[100:103], v[236:239], v[60:63], v[100:103]
    ds_read_b64_tr_b16 v[230:231], v8 offset:1568
    s_waitcnt lgkmcnt(6)
    v_mfma_f32_16x16x32_bf16 v[104:107], v[240:243], v[56:59], v[104:107]
    ds_read_b64_tr_b16 v[232:233], v7 offset:768
    v_mfma_f32_16x16x32_bf16 v[108:111], v[240:243], v[60:63], v[108:111]
    ds_read_b64_tr_b16 v[234:235], v7 offset:1792
    s_mov_b32 s23, 0x2e000
    buffer_load_dwordx4 v[52:55], v6, s[8:11], s23 offen offset:1024 sc1
    s_waitcnt lgkmcnt(6)
    v_mfma_f32_16x16x32_bf16 v[112:115], v[244:247], v[56:59], v[112:115]
    ds_read_b64_tr_b16 v[236:237], v8 offset:800
    v_mfma_f32_16x16x32_bf16 v[116:119], v[244:247], v[60:63], v[116:119]
    ds_read_b64_tr_b16 v[238:239], v8 offset:1824
    s_waitcnt lgkmcnt(6)
    v_mfma_f32_16x16x32_bf16 v[120:123], v[224:227], v[56:59], v[120:123]
    v_mfma_f32_16x16x32_bf16 v[124:127], v[224:227], v[60:63], v[124:127]
    s_waitcnt vmcnt(15)
    s_barrier
    ds_read_b64_tr_b16 v[240:241], v7 offset:16384
    ds_read_b64_tr_b16 v[242:243], v7 offset:17408
    s_waitcnt lgkmcnt(6)
    v_mfma_f32_16x16x32_bf16 v[128:131], v[228:231], v[56:59], v[128:131]
    s_add_u32 s22, s24, 0x390000
    s_add_u32 m0, s20, 0x1c000
    s_nop 0
    buffer_load_dwordx4 v3, s[4:7], s22 offen lds
    ds_read_b64_tr_b16 v[244:245], v8 offset:16416
    v_mfma_f32_16x16x32_bf16 v[132:135], v[228:231], v[60:63], v[132:135]
    ds_read_b64_tr_b16 v[246:247], v8 offset:17440
    s_waitcnt lgkmcnt(6)
    v_mfma_f32_16x16x32_bf16 v[136:139], v[232:235], v[56:59], v[136:139]
    ds_read_b64_tr_b16 v[224:225], v7 offset:16640
    v_mfma_f32_16x16x32_bf16 v[140:143], v[232:235], v[60:63], v[140:143]
    s_add_u32 s22, s24, 0x392000
    s_add_u32 m0, s20, 0x1c400
    s_nop 0
    buffer_load_dwordx4 v3, s[4:7], s22 offen lds
    ds_read_b64_tr_b16 v[226:227], v7 offset:17664
    s_waitcnt lgkmcnt(6)
    v_mfma_f32_16x16x32_bf16 v[144:147], v[236:239], v[56:59], v[144:147]
    ds_read_b64_tr_b16 v[228:229], v8 offset:16672
    v_mfma_f32_16x16x32_bf16 v[148:151], v[236:239], v[60:63], v[148:151]
    ds_read_b64_tr_b16 v[230:231], v8 offset:17696
    s_waitcnt vmcnt(6)
    v_cmp_ne_u32 vcc, s28, v12
    s_cbranch_vccnz adaLN_cond__sliding_block_cached__moe_arch_mod__prompt_kernel_o28r
adaLN_cond__sliding_block_cached__moe_arch_mod__prompt_kernel_o28b:
    s_waitcnt lgkmcnt(6)
    v_mfma_f32_16x16x32_bf16 v[88:91], v[240:243], v[64:67], v[88:91]
    ds_read_b64_tr_b16 v[232:233], v7 offset:16896
    v_mfma_f32_16x16x32_bf16 v[92:95], v[240:243], v[68:71], v[92:95]
    ds_read_b64_tr_b16 v[234:235], v7 offset:17920
    s_waitcnt lgkmcnt(6)
    v_mfma_f32_16x16x32_bf16 v[96:99], v[244:247], v[64:67], v[96:99]
    ds_read_b64_tr_b16 v[236:237], v8 offset:16928
    s_mov_b32 s23, 0x0
    buffer_load_dwordx4 v[56:59], v6, s[8:11], s23 offen offset:2048 sc1
    v_mfma_f32_16x16x32_bf16 v[100:103], v[244:247], v[68:71], v[100:103]
    ds_read_b64_tr_b16 v[238:239], v8 offset:17952
    s_waitcnt lgkmcnt(6)
    v_mfma_f32_16x16x32_bf16 v[104:107], v[224:227], v[64:67], v[104:107]
    ds_read_b64_tr_b16 v[240:241], v7 offset:17152
    v_mfma_f32_16x16x32_bf16 v[108:111], v[224:227], v[68:71], v[108:111]
    ds_read_b64_tr_b16 v[242:243], v7 offset:18176
    s_mov_b32 s23, 0x20000
    buffer_load_dwordx4 v[60:63], v6, s[8:11], s23 offen offset:2048 sc1
    s_waitcnt lgkmcnt(6)
    v_mfma_f32_16x16x32_bf16 v[112:115], v[228:231], v[64:67], v[112:115]
    ds_read_b64_tr_b16 v[244:245], v8 offset:17184
    v_mfma_f32_16x16x32_bf16 v[116:119], v[228:231], v[68:71], v[116:119]
    ds_read_b64_tr_b16 v[246:247], v8 offset:18208
    s_waitcnt lgkmcnt(6)
    v_mfma_f32_16x16x32_bf16 v[120:123], v[232:235], v[64:67], v[120:123]
    v_mfma_f32_16x16x32_bf16 v[124:127], v[232:235], v[68:71], v[124:127]
    s_barrier
    ds_read_b64_tr_b16 v[224:225], v4 offset:0
    ds_read_b64_tr_b16 v[226:227], v4 offset:1024
    s_waitcnt lgkmcnt(6)
    v_mfma_f32_16x16x32_bf16 v[128:131], v[236:239], v[64:67], v[128:131]
    s_add_u32 s22, s24, 0x20000
    s_add_u32 m0, s20, 0x20000
    s_nop 0
    buffer_load_dwordx4 v3, s[4:7], s22 offen lds
    ds_read_b64_tr_b16 v[228:229], v5 offset:32
    v_mfma_f32_16x16x32_bf16 v[132:135], v[236:239], v[68:71], v[132:135]
    ds_read_b64_tr_b16 v[230:231], v5 offset:1056
    s_waitcnt lgkmcnt(6)
    v_mfma_f32_16x16x32_bf16 v[136:139], v[240:243], v[64:67], v[136:139]
    ds_read_b64_tr_b16 v[232:233], v4 offset:256
    v_mfma_f32_16x16x32_bf16 v[140:143], v[240:243], v[68:71], v[140:143]
    s_add_u32 s22, s24, 0x22000
    s_add_u32 m0, s20, 0x20400
    s_nop 0
    buffer_load_dwordx4 v3, s[4:7], s22 offen lds
    ds_read_b64_tr_b16 v[234:235], v4 offset:1280
    s_waitcnt lgkmcnt(6)
    v_mfma_f32_16x16x32_bf16 v[144:147], v[244:247], v[64:67], v[144:147]
    ds_read_b64_tr_b16 v[236:237], v5 offset:288
    v_mfma_f32_16x16x32_bf16 v[148:151], v[244:247], v[68:71], v[148:151]
    ds_read_b64_tr_b16 v[238:239], v5 offset:1312
    s_waitcnt lgkmcnt(6)
    v_mfma_f32_16x16x32_bf16 v[88:91], v[224:227], v[24:27], v[88:91]
    ds_read_b64_tr_b16 v[240:241], v4 offset:512
    v_mfma_f32_16x16x32_bf16 v[92:95], v[224:227], v[28:31], v[92:95]
    ds_read_b64_tr_b16 v[242:243], v4 offset:1536
    s_waitcnt lgkmcnt(6)
    v_mfma_f32_16x16x32_bf16 v[96:99], v[228:231], v[24:27], v[96:99]
    ds_read_b64_tr_b16 v[244:245], v5 offset:544
    s_mov_b32 s23, 0x2000
    buffer_load_dwordx4 v[64:67], v6, s[8:11], s23 offen offset:2048 sc1
    v_mfma_f32_16x16x32_bf16 v[100:103], v[228:231], v[28:31], v[100:103]
    ds_read_b64_tr_b16 v[246:247], v5 offset:1568
    s_waitcnt lgkmcnt(6)
    v_mfma_f32_16x16x32_bf16 v[104:107], v[232:235], v[24:27], v[104:107]
    ds_read_b64_tr_b16 v[224:225], v4 offset:768
    v_mfma_f32_16x16x32_bf16 v[108:111], v[232:235], v[28:31], v[108:111]
    ds_read_b64_tr_b16 v[226:227], v4 offset:1792
    s_mov_b32 s23, 0x22000
    buffer_load_dwordx4 v[68:71], v6, s[8:11], s23 offen offset:2048 sc1
    s_waitcnt lgkmcnt(6)
    v_mfma_f32_16x16x32_bf16 v[112:115], v[236:239], v[24:27], v[112:115]
    ds_read_b64_tr_b16 v[228:229], v5 offset:800
    v_mfma_f32_16x16x32_bf16 v[116:119], v[236:239], v[28:31], v[116:119]
    ds_read_b64_tr_b16 v[230:231], v5 offset:1824
    s_waitcnt lgkmcnt(6)
    v_mfma_f32_16x16x32_bf16 v[120:123], v[240:243], v[24:27], v[120:123]
    v_mfma_f32_16x16x32_bf16 v[124:127], v[240:243], v[28:31], v[124:127]
    s_barrier
    ds_read_b64_tr_b16 v[232:233], v4 offset:16384
    ds_read_b64_tr_b16 v[234:235], v4 offset:17408
    s_waitcnt lgkmcnt(6)
    v_mfma_f32_16x16x32_bf16 v[128:131], v[244:247], v[24:27], v[128:131]
    s_add_u32 s22, s24, 0xa0000
    s_add_u32 m0, s20, 0x24000
    s_nop 0
    buffer_load_dwordx4 v3, s[4:7], s22 offen lds
    ds_read_b64_tr_b16 v[236:237], v5 offset:16416
    v_mfma_f32_16x16x32_bf16 v[132:135], v[244:247], v[28:31], v[132:135]
    ds_read_b64_tr_b16 v[238:239], v5 offset:17440
    s_waitcnt lgkmcnt(6)
    v_mfma_f32_16x16x32_bf16 v[136:139], v[224:227], v[24:27], v[136:139]
    ds_read_b64_tr_b16 v[240:241], v4 offset:16640
    v_mfma_f32_16x16x32_bf16 v[140:143], v[224:227], v[28:31], v[140:143]
    s_add_u32 s22, s24, 0xa2000
    s_add_u32 m0, s20, 0x24400
    s_nop 0
    buffer_load_dwordx4 v3, s[4:7], s22 offen lds
    ds_read_b64_tr_b16 v[242:243], v4 offset:17664
    s_waitcnt lgkmcnt(6)
    v_mfma_f32_16x16x32_bf16 v[144:147], v[228:231], v[24:27], v[144:147]
    ds_read_b64_tr_b16 v[244:245], v5 offset:16672
    v_mfma_f32_16x16x32_bf16 v[148:151], v[228:231], v[28:31], v[148:151]
    ds_read_b64_tr_b16 v[246:247], v5 offset:17696
    s_waitcnt lgkmcnt(6)
    v_mfma_f32_16x16x32_bf16 v[88:91], v[232:235], v[32:35], v[88:91]
    ds_read_b64_tr_b16 v[224:225], v4 offset:16896
    v_mfma_f32_16x16x32_bf16 v[92:95], v[232:235], v[36:39], v[92:95]
    ds_read_b64_tr_b16 v[226:227], v4 offset:17920
    s_waitcnt lgkmcnt(6)
    v_mfma_f32_16x16x32_bf16 v[96:99], v[236:239], v[32:35], v[96:99]
    ds_read_b64_tr_b16 v[228:229], v5 offset:16928
    s_mov_b32 s23, 0x4000
    buffer_load_dwordx4 v[24:27], v6, s[8:11], s23 offen offset:2048 sc1
    v_mfma_f32_16x16x32_bf16 v[100:103], v[236:239], v[36:39], v[100:103]
    ds_read_b64_tr_b16 v[230:231], v5 offset:17952
    s_waitcnt lgkmcnt(6)
    v_mfma_f32_16x16x32_bf16 v[104:107], v[240:243], v[32:35], v[104:107]
    ds_read_b64_tr_b16 v[232:233], v4 offset:17152
    v_mfma_f32_16x16x32_bf16 v[108:111], v[240:243], v[36:39], v[108:111]
    ds_read_b64_tr_b16 v[234:235], v4 offset:18176
    s_mov_b32 s23, 0x24000
    buffer_load_dwordx4 v[28:31], v6, s[8:11], s23 offen offset:2048 sc1
    s_waitcnt lgkmcnt(6)
    v_mfma_f32_16x16x32_bf16 v[112:115], v[244:247], v[32:35], v[112:115]
    ds_read_b64_tr_b16 v[236:237], v5 offset:17184
    v_mfma_f32_16x16x32_bf16 v[116:119], v[244:247], v[36:39], v[116:119]
    ds_read_b64_tr_b16 v[238:239], v5 offset:18208
    s_waitcnt lgkmcnt(6)
    v_mfma_f32_16x16x32_bf16 v[120:123], v[224:227], v[32:35], v[120:123]
    v_mfma_f32_16x16x32_bf16 v[124:127], v[224:227], v[36:39], v[124:127]
    s_waitcnt vmcnt(14)
    s_barrier
    ds_read_b64_tr_b16 v[240:241], v4 offset:32768
    ds_read_b64_tr_b16 v[242:243], v4 offset:33792
    s_waitcnt lgkmcnt(6)
    v_mfma_f32_16x16x32_bf16 v[128:131], v[228:231], v[32:35], v[128:131]
    s_add_u32 s22, s24, 0x120000
    s_add_u32 m0, s20, 0x10000
    s_nop 0
    buffer_load_dwordx4 v3, s[4:7], s22 offen lds
    ds_read_b64_tr_b16 v[244:245], v5 offset:32800
    v_mfma_f32_16x16x32_bf16 v[132:135], v[228:231], v[36:39], v[132:135]
    ds_read_b64_tr_b16 v[246:247], v5 offset:33824
    s_waitcnt lgkmcnt(6)
    v_mfma_f32_16x16x32_bf16 v[136:139], v[232:235], v[32:35], v[136:139]
    ds_read_b64_tr_b16 v[224:225], v4 offset:33024
    v_mfma_f32_16x16x32_bf16 v[140:143], v[232:235], v[36:39], v[140:143]
    s_add_u32 s22, s24, 0x122000
    s_add_u32 m0, s20, 0x10400
    s_nop 0
    buffer_load_dwordx4 v3, s[4:7], s22 offen lds
    ds_read_b64_tr_b16 v[226:227], v4 offset:34048
    s_waitcnt lgkmcnt(6)
    v_mfma_f32_16x16x32_bf16 v[144:147], v[236:239], v[32:35], v[144:147]
    ds_read_b64_tr_b16 v[228:229], v5 offset:33056
    v_mfma_f32_16x16x32_bf16 v[148:151], v[236:239], v[36:39], v[148:151]
    ds_read_b64_tr_b16 v[230:231], v5 offset:34080
    s_waitcnt lgkmcnt(6)
    v_mfma_f32_16x16x32_bf16 v[88:91], v[240:243], v[40:43], v[88:91]
    ds_read_b64_tr_b16 v[232:233], v4 offset:33280
    v_mfma_f32_16x16x32_bf16 v[92:95], v[240:243], v[44:47], v[92:95]
    ds_read_b64_tr_b16 v[234:235], v4 offset:34304
    s_waitcnt lgkmcnt(6)
    v_mfma_f32_16x16x32_bf16 v[96:99], v[244:247], v[40:43], v[96:99]
    ds_read_b64_tr_b16 v[236:237], v5 offset:33312
    s_mov_b32 s23, 0x6000
    buffer_load_dwordx4 v[32:35], v6, s[8:11], s23 offen offset:2048 sc1
    v_mfma_f32_16x16x32_bf16 v[100:103], v[244:247], v[44:47], v[100:103]
    ds_read_b64_tr_b16 v[238:239], v5 offset:34336
    s_waitcnt lgkmcnt(6)
    v_mfma_f32_16x16x32_bf16 v[104:107], v[224:227], v[40:43], v[104:107]
    ds_read_b64_tr_b16 v[240:241], v4 offset:33536
    v_mfma_f32_16x16x32_bf16 v[108:111], v[224:227], v[44:47], v[108:111]
    ds_read_b64_tr_b16 v[242:243], v4 offset:34560
    s_mov_b32 s23, 0x26000
    buffer_load_dwordx4 v[36:39], v6, s[8:11], s23 offen offset:2048 sc1
    s_waitcnt lgkmcnt(6)
    v_mfma_f32_16x16x32_bf16 v[112:115], v[228:231], v[40:43], v[112:115]
    ds_read_b64_tr_b16 v[244:245], v5 offset:33568
    v_mfma_f32_16x16x32_bf16 v[116:119], v[228:231], v[44:47], v[116:119]
    ds_read_b64_tr_b16 v[246:247], v5 offset:34592
    s_waitcnt lgkmcnt(6)
    v_mfma_f32_16x16x32_bf16 v[120:123], v[232:235], v[40:43], v[120:123]
    v_mfma_f32_16x16x32_bf16 v[124:127], v[232:235], v[44:47], v[124:127]
    s_waitcnt vmcnt(14)
    s_barrier
    ds_read_b64_tr_b16 v[224:225], v4 offset:49152
    ds_read_b64_tr_b16 v[226:227], v4 offset:50176
    s_waitcnt lgkmcnt(6)
    v_mfma_f32_16x16x32_bf16 v[128:131], v[236:239], v[40:43], v[128:131]
    s_add_u32 s22, s24, 0x1a0000
    s_add_u32 m0, s20, 0x14000
    s_nop 0
    buffer_load_dwordx4 v3, s[4:7], s22 offen lds
    ds_read_b64_tr_b16 v[228:229], v5 offset:49184
    v_mfma_f32_16x16x32_bf16 v[132:135], v[236:239], v[44:47], v[132:135]
    ds_read_b64_tr_b16 v[230:231], v5 offset:50208
    s_waitcnt lgkmcnt(6)
    v_mfma_f32_16x16x32_bf16 v[136:139], v[240:243], v[40:43], v[136:139]
    ds_read_b64_tr_b16 v[232:233], v4 offset:49408
    v_mfma_f32_16x16x32_bf16 v[140:143], v[240:243], v[44:47], v[140:143]
    s_add_u32 s22, s24, 0x1a2000
    s_add_u32 m0, s20, 0x14400
    s_nop 0
    buffer_load_dwordx4 v3, s[4:7], s22 offen lds
    ds_read_b64_tr_b16 v[234:235], v4 offset:50432
    s_waitcnt lgkmcnt(6)
    v_mfma_f32_16x16x32_bf16 v[144:147], v[244:247], v[40:43], v[144:147]
    ds_read_b64_tr_b16 v[236:237], v5 offset:49440
    v_mfma_f32_16x16x32_bf16 v[148:151], v[244:247], v[44:47], v[148:151]
    ds_read_b64_tr_b16 v[238:239], v5 offset:50464
    s_waitcnt lgkmcnt(6)
    v_mfma_f32_16x16x32_bf16 v[88:91], v[224:227], v[48:51], v[88:91]
    ds_read_b64_tr_b16 v[240:241], v4 offset:49664
    v_mfma_f32_16x16x32_bf16 v[92:95], v[224:227], v[52:55], v[92:95]
    ds_read_b64_tr_b16 v[242:243], v4 offset:50688
    s_waitcnt lgkmcnt(6)
    v_mfma_f32_16x16x32_bf16 v[96:99], v[228:231], v[48:51], v[96:99]
    ds_read_b64_tr_b16 v[244:245], v5 offset:49696
    s_mov_b32 s23, 0x8000
    buffer_load_dwordx4 v[40:43], v6, s[8:11], s23 offen offset:2048 sc1
    v_mfma_f32_16x16x32_bf16 v[100:103], v[228:231], v[52:55], v[100:103]
    ds_read_b64_tr_b16 v[246:247], v5 offset:50720
    s_waitcnt lgkmcnt(6)
    v_mfma_f32_16x16x32_bf16 v[104:107], v[232:235], v[48:51], v[104:107]
    ds_read_b64_tr_b16 v[224:225], v4 offset:49920
    v_mfma_f32_16x16x32_bf16 v[108:111], v[232:235], v[52:55], v[108:111]
    ds_read_b64_tr_b16 v[226:227], v4 offset:50944
    s_mov_b32 s23, 0x28000
    buffer_load_dwordx4 v[44:47], v6, s[8:11], s23 offen offset:2048 sc1
    s_waitcnt lgkmcnt(6)
    v_mfma_f32_16x16x32_bf16 v[112:115], v[236:239], v[48:51], v[112:115]
    ds_read_b64_tr_b16 v[228:229], v5 offset:49952
    v_mfma_f32_16x16x32_bf16 v[116:119], v[236:239], v[52:55], v[116:119]
    ds_read_b64_tr_b16 v[230:231], v5 offset:50976
    s_waitcnt lgkmcnt(6)
    v_mfma_f32_16x16x32_bf16 v[120:123], v[240:243], v[48:51], v[120:123]
    v_mfma_f32_16x16x32_bf16 v[124:127], v[240:243], v[52:55], v[124:127]
    s_waitcnt vmcnt(14)
    s_barrier
    ds_read_b64_tr_b16 v[232:233], v7 offset:0
    ds_read_b64_tr_b16 v[234:235], v7 offset:1024
    s_waitcnt lgkmcnt(6)
    v_mfma_f32_16x16x32_bf16 v[128:131], v[244:247], v[48:51], v[128:131]
    s_add_u32 s22, s24, 0x220000
    s_add_u32 m0, s20, 0x18000
    s_nop 0
    buffer_load_dwordx4 v3, s[4:7], s22 offen lds
    ds_read_b64_tr_b16 v[236:237], v8 offset:32
    v_mfma_f32_16x16x32_bf16 v[132:135], v[244:247], v[52:55], v[132:135]
    ds_read_b64_tr_b16 v[238:239], v8 offset:1056
    s_waitcnt lgkmcnt(6)
    v_mfma_f32_16x16x32_bf16 v[136:139], v[224:227], v[48:51], v[136:139]
    ds_read_b64_tr_b16 v[240:241], v7 offset:256
    v_mfma_f32_16x16x32_bf16 v[140:143], v[224:227], v[52:55], v[140:143]
    s_add_u32 s22, s24, 0x222000
    s_add_u32 m0, s20, 0x18400
    s_nop 0
    buffer_load_dwordx4 v3, s[4:7], s22 offen lds
    ds_read_b64_tr_b16 v[242:243], v7 offset:1280
    s_waitcnt lgkmcnt(6)
    v_mfma_f32_16x16x32_bf16 v[144:147], v[228:231], v[48:51], v[144:147]
    ds_read_b64_tr_b16 v[244:245], v8 offset:288
    v_mfma_f32_16x16x32_bf16 v[148:151], v[228:231], v[52:55], v[148:151]
    ds_read_b64_tr_b16 v[246:247], v8 offset:1312
    s_waitcnt lgkmcnt(6)
    v_mfma_f32_16x16x32_bf16 v[88:91], v[232:235], v[56:59], v[88:91]
    ds_read_b64_tr_b16 v[224:225], v7 offset:512
    v_mfma_f32_16x16x32_bf16 v[92:95], v[232:235], v[60:63], v[92:95]
    ds_read_b64_tr_b16 v[226:227], v7 offset:1536
    s_waitcnt lgkmcnt(6)
    v_mfma_f32_16x16x32_bf16 v[96:99], v[236:239], v[56:59], v[96:99]
    ds_read_b64_tr_b16 v[228:229], v8 offset:544
    s_mov_b32 s23, 0xa000
    buffer_load_dwordx4 v[48:51], v6, s[8:11], s23 offen offset:2048 sc1
    v_mfma_f32_16x16x32_bf16 v[100:103], v[236:239], v[60:63], v[100:103]
    ds_read_b64_tr_b16 v[230:231], v8 offset:1568
    s_waitcnt lgkmcnt(6)
    v_mfma_f32_16x16x32_bf16 v[104:107], v[240:243], v[56:59], v[104:107]
    ds_read_b64_tr_b16 v[232:233], v7 offset:768
    v_mfma_f32_16x16x32_bf16 v[108:111], v[240:243], v[60:63], v[108:111]
    ds_read_b64_tr_b16 v[234:235], v7 offset:1792
    s_mov_b32 s23, 0x2a000
    buffer_load_dwordx4 v[52:55], v6, s[8:11], s23 offen offset:2048 sc1
    s_waitcnt lgkmcnt(6)
    v_mfma_f32_16x16x32_bf16 v[112:115], v[244:247], v[56:59], v[112:115]
    ds_read_b64_tr_b16 v[236:237], v8 offset:800
    v_mfma_f32_16x16x32_bf16 v[116:119], v[244:247], v[60:63], v[116:119]
    ds_read_b64_tr_b16 v[238:239], v8 offset:1824
    s_waitcnt lgkmcnt(6)
    v_mfma_f32_16x16x32_bf16 v[120:123], v[224:227], v[56:59], v[120:123]
    v_mfma_f32_16x16x32_bf16 v[124:127], v[224:227], v[60:63], v[124:127]
    s_waitcnt vmcnt(14)
    s_barrier
    ds_read_b64_tr_b16 v[240:241], v7 offset:16384
    ds_read_b64_tr_b16 v[242:243], v7 offset:17408
    s_waitcnt lgkmcnt(6)
    v_mfma_f32_16x16x32_bf16 v[128:131], v[228:231], v[56:59], v[128:131]
    s_add_u32 s22, s24, 0x2a0000
    s_add_u32 m0, s20, 0x1c000
    s_nop 0
    buffer_load_dwordx4 v3, s[4:7], s22 offen lds
    ds_read_b64_tr_b16 v[244:245], v8 offset:16416
    v_mfma_f32_16x16x32_bf16 v[132:135], v[228:231], v[60:63], v[132:135]
    ds_read_b64_tr_b16 v[246:247], v8 offset:17440
    s_waitcnt lgkmcnt(6)
    v_mfma_f32_16x16x32_bf16 v[136:139], v[232:235], v[56:59], v[136:139]
    ds_read_b64_tr_b16 v[224:225], v7 offset:16640
    v_mfma_f32_16x16x32_bf16 v[140:143], v[232:235], v[60:63], v[140:143]
    s_add_u32 s22, s24, 0x2a2000
    s_add_u32 m0, s20, 0x1c400
    s_nop 0
    buffer_load_dwordx4 v3, s[4:7], s22 offen lds
    ds_read_b64_tr_b16 v[226:227], v7 offset:17664
    s_waitcnt lgkmcnt(6)
    v_mfma_f32_16x16x32_bf16 v[144:147], v[236:239], v[56:59], v[144:147]
    ds_read_b64_tr_b16 v[228:229], v8 offset:16672
    v_mfma_f32_16x16x32_bf16 v[148:151], v[236:239], v[60:63], v[148:151]
    ds_read_b64_tr_b16 v[230:231], v8 offset:17696
    s_waitcnt lgkmcnt(6)
    v_mfma_f32_16x16x32_bf16 v[88:91], v[240:243], v[64:67], v[88:91]
    ds_read_b64_tr_b16 v[232:233], v7 offset:16896
    v_mfma_f32_16x16x32_bf16 v[92:95], v[240:243], v[68:71], v[92:95]
    ds_read_b64_tr_b16 v[234:235], v7 offset:17920
    s_waitcnt lgkmcnt(6)
    v_mfma_f32_16x16x32_bf16 v[96:99], v[244:247], v[64:67], v[96:99]
    ds_read_b64_tr_b16 v[236:237], v8 offset:16928
    s_mov_b32 s23, 0xc000
    buffer_load_dwordx4 v[56:59], v6, s[8:11], s23 offen offset:2048 sc1
    v_mfma_f32_16x16x32_bf16 v[100:103], v[244:247], v[68:71], v[100:103]
    ds_read_b64_tr_b16 v[238:239], v8 offset:17952
    s_waitcnt lgkmcnt(6)
    v_mfma_f32_16x16x32_bf16 v[104:107], v[224:227], v[64:67], v[104:107]
    ds_read_b64_tr_b16 v[240:241], v7 offset:17152
    v_mfma_f32_16x16x32_bf16 v[108:111], v[224:227], v[68:71], v[108:111]
    ds_read_b64_tr_b16 v[242:243], v7 offset:18176
    s_mov_b32 s23, 0x2c000
    buffer_load_dwordx4 v[60:63], v6, s[8:11], s23 offen offset:2048 sc1
    s_waitcnt lgkmcnt(6)
    v_mfma_f32_16x16x32_bf16 v[112:115], v[228:231], v[64:67], v[112:115]
    ds_read_b64_tr_b16 v[244:245], v8 offset:17184
    v_mfma_f32_16x16x32_bf16 v[116:119], v[228:231], v[68:71], v[116:119]
    ds_read_b64_tr_b16 v[246:247], v8 offset:18208
    s_waitcnt lgkmcnt(6)
    v_mfma_f32_16x16x32_bf16 v[120:123], v[232:235], v[64:67], v[120:123]
    v_mfma_f32_16x16x32_bf16 v[124:127], v[232:235], v[68:71], v[124:127]
    s_waitcnt vmcnt(14)
    s_barrier
    ds_read_b64_tr_b16 v[224:225], v4 offset:0
    ds_read_b64_tr_b16 v[226:227], v4 offset:1024
    s_add_u32 s19, s19, 8192
    buffer_load_dword v12, v13, s[8:11], s19 offen sc1
    s_waitcnt lgkmcnt(6)
    v_mfma_f32_16x16x32_bf16 v[128:131], v[236:239], v[64:67], v[128:131]
    s_add_u32 s22, s24, 0x320000
    s_add_u32 m0, s20, 0x20000
    s_nop 0
    buffer_load_dwordx4 v3, s[4:7], s22 offen lds
    ds_read_b64_tr_b16 v[228:229], v5 offset:32
    v_mfma_f32_16x16x32_bf16 v[132:135], v[236:239], v[68:71], v[132:135]
    ds_read_b64_tr_b16 v[230:231], v5 offset:1056
    s_waitcnt lgkmcnt(6)
    v_mfma_f32_16x16x32_bf16 v[136:139], v[240:243], v[64:67], v[136:139]
    ds_read_b64_tr_b16 v[232:233], v4 offset:256
    v_mfma_f32_16x16x32_bf16 v[140:143], v[240:243], v[68:71], v[140:143]
    s_add_u32 s22, s24, 0x322000
    s_add_u32 m0, s20, 0x20400
    s_nop 0
    buffer_load_dwordx4 v3, s[4:7], s22 offen lds
    ds_read_b64_tr_b16 v[234:235], v4 offset:1280
    s_waitcnt lgkmcnt(6)
    v_mfma_f32_16x16x32_bf16 v[144:147], v[244:247], v[64:67], v[144:147]
    ds_read_b64_tr_b16 v[236:237], v5 offset:288
    v_mfma_f32_16x16x32_bf16 v[148:151], v[244:247], v[68:71], v[148:151]
    ds_read_b64_tr_b16 v[238:239], v5 offset:1312
    s_waitcnt lgkmcnt(6)
    v_mfma_f32_16x16x32_bf16 v[88:91], v[224:227], v[24:27], v[88:91]
    v_mov_b32 v248, s28
    v_mov_b32 v249, 0
    s_lshl_b32 s14, s2, 2
    s_add_u32 s14, s14, 0x544000
    s_cmp_eq_u32 s3, 0
    s_cselect_b32 s14, s14, 0x7ffffff0
    s_mov_b64 exec, 1
    buffer_store_dword v248, v249, s[8:11], s14 offen sc1
    s_mov_b64 exec, -1
    ds_read_b64_tr_b16 v[240:241], v4 offset:512
    v_mfma_f32_16x16x32_bf16 v[92:95], v[224:227], v[28:31], v[92:95]
    ds_read_b64_tr_b16 v[242:243], v4 offset:1536
    s_waitcnt lgkmcnt(6)
    v_mfma_f32_16x16x32_bf16 v[96:99], v[228:231], v[24:27], v[96:99]
    ds_read_b64_tr_b16 v[244:245], v5 offset:544
    s_mov_b32 s23, 0xe000
    buffer_load_dwordx4 v[64:67], v6, s[8:11], s23 offen offset:2048 sc1
    v_mfma_f32_16x16x32_bf16 v[100:103], v[228:231], v[28:31], v[100:103]
    ds_read_b64_tr_b16 v[246:247], v5 offset:1568
    s_waitcnt lgkmcnt(6)
    v_mfma_f32_16x16x32_bf16 v[104:107], v[232:235], v[24:27], v[104:107]
    ds_read_b64_tr_b16 v[224:225], v4 offset:768
    v_mfma_f32_16x16x32_bf16 v[108:111], v[232:235], v[28:31], v[108:111]
    ds_read_b64_tr_b16 v[226:227], v4 offset:1792
    s_mov_b32 s23, 0x2e000
    buffer_load_dwordx4 v[68:71], v6, s[8:11], s23 offen offset:2048 sc1
    s_waitcnt lgkmcnt(6)
    v_mfma_f32_16x16x32_bf16 v[112:115], v[236:239], v[24:27], v[112:115]
    ds_read_b64_tr_b16 v[228:229], v5 offset:800
    v_mfma_f32_16x16x32_bf16 v[116:119], v[236:239], v[28:31], v[116:119]
    ds_read_b64_tr_b16 v[230:231], v5 offset:1824
    s_waitcnt lgkmcnt(6)
    v_mfma_f32_16x16x32_bf16 v[120:123], v[240:243], v[24:27], v[120:123]
    v_mfma_f32_16x16x32_bf16 v[124:127], v[240:243], v[28:31], v[124:127]
    s_waitcnt vmcnt(16)
    s_barrier
    ds_read_b64_tr_b16 v[232:233], v4 offset:16384
    ds_read_b64_tr_b16 v[234:235], v4 offset:17408
    s_waitcnt lgkmcnt(6)
    v_mfma_f32_16x16x32_bf16 v[128:131], v[244:247], v[24:27], v[128:131]
    s_add_u32 s22, s24, 0x3a0000
    s_add_u32 m0, s20, 0x24000
    s_nop 0
    buffer_load_dwordx4 v3, s[4:7], s22 offen lds
    ds_read_b64_tr_b16 v[236:237], v5 offset:16416
    v_mfma_f32_16x16x32_bf16 v[132:135], v[244:247], v[28:31], v[132:135]
    ds_read_b64_tr_b16 v[238:239], v5 offset:17440
    s_waitcnt lgkmcnt(6)
    v_mfma_f32_16x16x32_bf16 v[136:139], v[224:227], v[24:27], v[136:139]
    ds_read_b64_tr_b16 v[240:241], v4 offset:16640
    v_mfma_f32_16x16x32_bf16 v[140:143], v[224:227], v[28:31], v[140:143]
    s_add_u32 s22, s24, 0x3a2000
    s_add_u32 m0, s20, 0x24400
    s_nop 0
    buffer_load_dwordx4 v3, s[4:7], s22 offen lds
    ds_read_b64_tr_b16 v[242:243], v4 offset:17664
    s_waitcnt lgkmcnt(6)
    v_mfma_f32_16x16x32_bf16 v[144:147], v[228:231], v[24:27], v[144:147]
    ds_read_b64_tr_b16 v[244:245], v5 offset:16672
    v_mfma_f32_16x16x32_bf16 v[148:151], v[228:231], v[28:31], v[148:151]
    ds_read_b64_tr_b16 v[246:247], v5 offset:17696
    s_waitcnt vmcnt(7)
    v_cmp_ne_u32 vcc, s28, v12
    s_cbranch_vccnz adaLN_cond__sliding_block_cached__moe_arch_mod__prompt_kernel_o29r
adaLN_cond__sliding_block_cached__moe_arch_mod__prompt_kernel_o29b:
    s_waitcnt lgkmcnt(6)
    v_mfma_f32_16x16x32_bf16 v[88:91], v[232:235], v[32:35], v[88:91]
    ds_read_b64_tr_b16 v[224:225], v4 offset:16896
    v_mfma_f32_16x16x32_bf16 v[92:95], v[232:235], v[36:39], v[92:95]
    ds_read_b64_tr_b16 v[226:227], v4 offset:17920
    s_waitcnt lgkmcnt(6)
    v_mfma_f32_16x16x32_bf16 v[96:99], v[236:239], v[32:35], v[96:99]
    ds_read_b64_tr_b16 v[228:229], v5 offset:16928
    s_mov_b32 s23, 0x0
    buffer_load_dwordx4 v[24:27], v6, s[8:11], s23 offen offset:3072 sc1
    v_mfma_f32_16x16x32_bf16 v[100:103], v[236:239], v[36:39], v[100:103]
    ds_read_b64_tr_b16 v[230:231], v5 offset:17952
    s_waitcnt lgkmcnt(6)
    v_mfma_f32_16x16x32_bf16 v[104:107], v[240:243], v[32:35], v[104:107]
    ds_read_b64_tr_b16 v[232:233], v4 offset:17152
    v_mfma_f32_16x16x32_bf16 v[108:111], v[240:243], v[36:39], v[108:111]
    ds_read_b64_tr_b16 v[234:235], v4 offset:18176
    s_mov_b32 s23, 0x20000
    buffer_load_dwordx4 v[28:31], v6, s[8:11], s23 offen offset:3072 sc1
    s_waitcnt lgkmcnt(6)
    v_mfma_f32_16x16x32_bf16 v[112:115], v[244:247], v[32:35], v[112:115]
    ds_read_b64_tr_b16 v[236:237], v5 offset:17184
    v_mfma_f32_16x16x32_bf16 v[116:119], v[244:247], v[36:39], v[116:119]
    ds_read_b64_tr_b16 v[238:239], v5 offset:18208
    s_waitcnt lgkmcnt(6)
    v_mfma_f32_16x16x32_bf16 v[120:123], v[224:227], v[32:35], v[120:123]
    v_mfma_f32_16x16x32_bf16 v[124:127], v[224:227], v[36:39], v[124:127]
    s_barrier
    ds_read_b64_tr_b16 v[240:241], v4 offset:32768
    ds_read_b64_tr_b16 v[242:243], v4 offset:33792
    s_waitcnt lgkmcnt(6)
    v_mfma_f32_16x16x32_bf16 v[128:131], v[228:231], v[32:35], v[128:131]
    s_add_u32 s22, s24, 0x30000
    s_add_u32 m0, s20, 0x10000
    s_nop 0
    buffer_load_dwordx4 v3, s[4:7], s22 offen lds
    ds_read_b64_tr_b16 v[244:245], v5 offset:32800
    v_mfma_f32_16x16x32_bf16 v[132:135], v[228:231], v[36:39], v[132:135]
    ds_read_b64_tr_b16 v[246:247], v5 offset:33824
    s_waitcnt lgkmcnt(6)
    v_mfma_f32_16x16x32_bf16 v[136:139], v[232:235], v[32:35], v[136:139]
    ds_read_b64_tr_b16 v[224:225], v4 offset:33024
    v_mfma_f32_16x16x32_bf16 v[140:143], v[232:235], v[36:39], v[140:143]
    s_add_u32 s22, s24, 0x32000
    s_add_u32 m0, s20, 0x10400
    s_nop 0
    buffer_load_dwordx4 v3, s[4:7], s22 offen lds
    ds_read_b64_tr_b16 v[226:227], v4 offset:34048
    s_waitcnt lgkmcnt(6)
    v_mfma_f32_16x16x32_bf16 v[144:147], v[236:239], v[32:35], v[144:147]
    ds_read_b64_tr_b16 v[228:229], v5 offset:33056
    v_mfma_f32_16x16x32_bf16 v[148:151], v[236:239], v[36:39], v[148:151]
    ds_read_b64_tr_b16 v[230:231], v5 offset:34080
    s_waitcnt lgkmcnt(6)
    v_mfma_f32_16x16x32_bf16 v[88:91], v[240:243], v[40:43], v[88:91]
    ds_read_b64_tr_b16 v[232:233], v4 offset:33280
    v_mfma_f32_16x16x32_bf16 v[92:95], v[240:243], v[44:47], v[92:95]
    ds_read_b64_tr_b16 v[234:235], v4 offset:34304
    s_waitcnt lgkmcnt(6)
    v_mfma_f32_16x16x32_bf16 v[96:99], v[244:247], v[40:43], v[96:99]
    ds_read_b64_tr_b16 v[236:237], v5 offset:33312
    s_mov_b32 s23, 0x2000
    buffer_load_dwordx4 v[32:35], v6, s[8:11], s23 offen offset:3072 sc1
    v_mfma_f32_16x16x32_bf16 v[100:103], v[244:247], v[44:47], v[100:103]
    ds_read_b64_tr_b16 v[238:239], v5 offset:34336
    s_waitcnt lgkmcnt(6)
    v_mfma_f32_16x16x32_bf16 v[104:107], v[224:227], v[40:43], v[104:107]
    ds_read_b64_tr_b16 v[240:241], v4 offset:33536
    v_mfma_f32_16x16x32_bf16 v[108:111], v[224:227], v[44:47], v[108:111]
    ds_read_b64_tr_b16 v[242:243], v4 offset:34560
    s_mov_b32 s23, 0x22000
    buffer_load_dwordx4 v[36:39], v6, s[8:11], s23 offen offset:3072 sc1
    s_waitcnt lgkmcnt(6)
    v_mfma_f32_16x16x32_bf16 v[112:115], v[228:231], v[40:43], v[112:115]
    ds_read_b64_tr_b16 v[244:245], v5 offset:33568
    v_mfma_f32_16x16x32_bf16 v[116:119], v[228:231], v[44:47], v[116:119]
    ds_read_b64_tr_b16 v[246:247], v5 offset:34592
    s_waitcnt lgkmcnt(6)
    v_mfma_f32_16x16x32_bf16 v[120:123], v[232:235], v[40:43], v[120:123]
    v_mfma_f32_16x16x32_bf16 v[124:127], v[232:235], v[44:47], v[124:127]
    s_barrier
    ds_read_b64_tr_b16 v[224:225], v4 offset:49152
    ds_read_b64_tr_b16 v[226:227], v4 offset:50176
    s_waitcnt lgkmcnt(6)
    v_mfma_f32_16x16x32_bf16 v[128:131], v[236:239], v[40:43], v[128:131]
    s_add_u32 s22, s24, 0xb0000
    s_add_u32 m0, s20, 0x14000
    s_nop 0
    buffer_load_dwordx4 v3, s[4:7], s22 offen lds
    ds_read_b64_tr_b16 v[228:229], v5 offset:49184
    v_mfma_f32_16x16x32_bf16 v[132:135], v[236:239], v[44:47], v[132:135]
    ds_read_b64_tr_b16 v[230:231], v5 offset:50208
    s_waitcnt lgkmcnt(6)
    v_mfma_f32_16x16x32_bf16 v[136:139], v[240:243], v[40:43], v[136:139]
    ds_read_b64_tr_b16 v[232:233], v4 offset:49408
    v_mfma_f32_16x16x32_bf16 v[140:143], v[240:243], v[44:47], v[140:143]
    s_add_u32 s22, s24, 0xb2000
    s_add_u32 m0, s20, 0x14400
    s_nop 0
    buffer_load_dwordx4 v3, s[4:7], s22 offen lds
    ds_read_b64_tr_b16 v[234:235], v4 offset:50432
    s_waitcnt lgkmcnt(6)
    v_mfma_f32_16x16x32_bf16 v[144:147], v[244:247], v[40:43], v[144:147]
    ds_read_b64_tr_b16 v[236:237], v5 offset:49440
    v_mfma_f32_16x16x32_bf16 v[148:151], v[244:247], v[44:47], v[148:151]
    ds_read_b64_tr_b16 v[238:239], v5 offset:50464
    s_waitcnt lgkmcnt(6)
    v_mfma_f32_16x16x32_bf16 v[88:91], v[224:227], v[48:51], v[88:91]
    ds_read_b64_tr_b16 v[240:241], v4 offset:49664
    v_mfma_f32_16x16x32_bf16 v[92:95], v[224:227], v[52:55], v[92:95]
    ds_read_b64_tr_b16 v[242:243], v4 offset:50688
    s_waitcnt lgkmcnt(6)
    v_mfma_f32_16x16x32_bf16 v[96:99], v[228:231], v[48:51], v[96:99]
    ds_read_b64_tr_b16 v[244:245], v5 offset:49696
    s_mov_b32 s23, 0x4000
    buffer_load_dwordx4 v[40:43], v6, s[8:11], s23 offen offset:3072 sc1
    v_mfma_f32_16x16x32_bf16 v[100:103], v[228:231], v[52:55], v[100:103]
    ds_read_b64_tr_b16 v[246:247], v5 offset:50720
    s_waitcnt lgkmcnt(6)
    v_mfma_f32_16x16x32_bf16 v[104:107], v[232:235], v[48:51], v[104:107]
    ds_read_b64_tr_b16 v[224:225], v4 offset:49920
    v_mfma_f32_16x16x32_bf16 v[108:111], v[232:235], v[52:55], v[108:111]
    ds_read_b64_tr_b16 v[226:227], v4 offset:50944
    s_mov_b32 s23, 0x24000
    buffer_load_dwordx4 v[44:47], v6, s[8:11], s23 offen offset:3072 sc1
    s_waitcnt lgkmcnt(6)
    v_mfma_f32_16x16x32_bf16 v[112:115], v[236:239], v[48:51], v[112:115]
    ds_read_b64_tr_b16 v[228:229], v5 offset:49952
    v_mfma_f32_16x16x32_bf16 v[116:119], v[236:239], v[52:55], v[116:119]
    ds_read_b64_tr_b16 v[230:231], v5 offset:50976
    s_waitcnt lgkmcnt(6)
    v_mfma_f32_16x16x32_bf16 v[120:123], v[240:243], v[48:51], v[120:123]
    v_mfma_f32_16x16x32_bf16 v[124:127], v[240:243], v[52:55], v[124:127]
    s_waitcnt vmcnt(15)
    s_barrier
    ds_read_b64_tr_b16 v[232:233], v7 offset:0
    ds_read_b64_tr_b16 v[234:235], v7 offset:1024
    s_waitcnt lgkmcnt(6)
    v_mfma_f32_16x16x32_bf16 v[128:131], v[244:247], v[48:51], v[128:131]
    s_add_u32 s22, s24, 0x130000
    s_add_u32 m0, s20, 0x18000
    s_nop 0
    buffer_load_dwordx4 v3, s[4:7], s22 offen lds
    ds_read_b64_tr_b16 v[236:237], v8 offset:32
    v_mfma_f32_16x16x32_bf16 v[132:135], v[244:247], v[52:55], v[132:135]
    ds_read_b64_tr_b16 v[238:239], v8 offset:1056
    s_waitcnt lgkmcnt(6)
    v_mfma_f32_16x16x32_bf16 v[136:139], v[224:227], v[48:51], v[136:139]
    ds_read_b64_tr_b16 v[240:241], v7 offset:256
    v_mfma_f32_16x16x32_bf16 v[140:143], v[224:227], v[52:55], v[140:143]
    s_add_u32 s22, s24, 0x132000
    s_add_u32 m0, s20, 0x18400
    s_nop 0
    buffer_load_dwordx4 v3, s[4:7], s22 offen lds
    ds_read_b64_tr_b16 v[242:243], v7 offset:1280
    s_waitcnt lgkmcnt(6)
    v_mfma_f32_16x16x32_bf16 v[144:147], v[228:231], v[48:51], v[144:147]
    ds_read_b64_tr_b16 v[244:245], v8 offset:288
    v_mfma_f32_16x16x32_bf16 v[148:151], v[228:231], v[52:55], v[148:151]
    ds_read_b64_tr_b16 v[246:247], v8 offset:1312
    s_waitcnt lgkmcnt(6)
    v_mfma_f32_16x16x32_bf16 v[88:91], v[232:235], v[56:59], v[88:91]
    ds_read_b64_tr_b16 v[224:225], v7 offset:512
    v_mfma_f32_16x16x32_bf16 v[92:95], v[232:235], v[60:63], v[92:95]
    ds_read_b64_tr_b16 v[226:227], v7 offset:1536
    s_waitcnt lgkmcnt(6)
    v_mfma_f32_16x16x32_bf16 v[96:99], v[236:239], v[56:59], v[96:99]
    ds_read_b64_tr_b16 v[228:229], v8 offset:544
    s_mov_b32 s23, 0x6000
    buffer_load_dwordx4 v[48:51], v6, s[8:11], s23 offen offset:3072 sc1
    v_mfma_f32_16x16x32_bf16 v[100:103], v[236:239], v[60:63], v[100:103]
    ds_read_b64_tr_b16 v[230:231], v8 offset:1568
    s_waitcnt lgkmcnt(6)
    v_mfma_f32_16x16x32_bf16 v[104:107], v[240:243], v[56:59], v[104:107]
    ds_read_b64_tr_b16 v[232:233], v7 offset:768
    v_mfma_f32_16x16x32_bf16 v[108:111], v[240:243], v[60:63], v[108:111]
    ds_read_b64_tr_b16 v[234:235], v7 offset:1792
    s_mov_b32 s23, 0x26000
    buffer_load_dwordx4 v[52:55], v6, s[8:11], s23 offen offset:3072 sc1
    s_waitcnt lgkmcnt(6)
    v_mfma_f32_16x16x32_bf16 v[112:115], v[244:247], v[56:59], v[112:115]
    ds_read_b64_tr_b16 v[236:237], v8 offset:800
    v_mfma_f32_16x16x32_bf16 v[116:119], v[244:247], v[60:63], v[116:119]
    ds_read_b64_tr_b16 v[238:239], v8 offset:1824
    s_waitcnt lgkmcnt(6)
    v_mfma_f32_16x16x32_bf16 v[120:123], v[224:227], v[56:59], v[120:123]
    v_mfma_f32_16x16x32_bf16 v[124:127], v[224:227], v[60:63], v[124:127]
    s_waitcnt vmcnt(14)
    s_barrier
    ds_read_b64_tr_b16 v[240:241], v7 offset:16384
    ds_read_b64_tr_b16 v[242:243], v7 offset:17408
    s_waitcnt lgkmcnt(6)
    v_mfma_f32_16x16x32_bf16 v[128:131], v[228:231], v[56:59], v[128:131]
    s_add_u32 s22, s24, 0x1b0000
    s_add_u32 m0, s20, 0x1c000
    s_nop 0
    buffer_load_dwordx4 v3, s[4:7], s22 offen lds
    ds_read_b64_tr_b16 v[244:245], v8 offset:16416
    v_mfma_f32_16x16x32_bf16 v[132:135], v[228:231], v[60:63], v[132:135]
    ds_read_b64_tr_b16 v[246:247], v8 offset:17440
    s_waitcnt lgkmcnt(6)
    v_mfma_f32_16x16x32_bf16 v[136:139], v[232:235], v[56:59], v[136:139]
    ds_read_b64_tr_b16 v[224:225], v7 offset:16640
    v_mfma_f32_16x16x32_bf16 v[140:143], v[232:235], v[60:63], v[140:143]
    s_add_u32 s22, s24, 0x1b2000
    s_add_u32 m0, s20, 0x1c400
    s_nop 0
    buffer_load_dwordx4 v3, s[4:7], s22 offen lds
    ds_read_b64_tr_b16 v[226:227], v7 offset:17664
    s_waitcnt lgkmcnt(6)
    v_mfma_f32_16x16x32_bf16 v[144:147], v[236:239], v[56:59], v[144:147]
    ds_read_b64_tr_b16 v[228:229], v8 offset:16672
    v_mfma_f32_16x16x32_bf16 v[148:151], v[236:239], v[60:63], v[148:151]
    ds_read_b64_tr_b16 v[230:231], v8 offset:17696
    s_waitcnt lgkmcnt(6)
    v_mfma_f32_16x16x32_bf16 v[88:91], v[240:243], v[64:67], v[88:91]
    ds_read_b64_tr_b16 v[232:233], v7 offset:16896
    v_mfma_f32_16x16x32_bf16 v[92:95], v[240:243], v[68:71], v[92:95]
    ds_read_b64_tr_b16 v[234:235], v7 offset:17920
    s_waitcnt lgkmcnt(6)
    v_mfma_f32_16x16x32_bf16 v[96:99], v[244:247], v[64:67], v[96:99]
    ds_read_b64_tr_b16 v[236:237], v8 offset:16928
    s_mov_b32 s23, 0x8000
    buffer_load_dwordx4 v[56:59], v6, s[8:11], s23 offen offset:3072 sc1
    v_mfma_f32_16x16x32_bf16 v[100:103], v[244:247], v[68:71], v[100:103]
    ds_read_b64_tr_b16 v[238:239], v8 offset:17952
    s_waitcnt lgkmcnt(6)
    v_mfma_f32_16x16x32_bf16 v[104:107], v[224:227], v[64:67], v[104:107]
    ds_read_b64_tr_b16 v[240:241], v7 offset:17152
    v_mfma_f32_16x16x32_bf16 v[108:111], v[224:227], v[68:71], v[108:111]
    ds_read_b64_tr_b16 v[242:243], v7 offset:18176
    s_mov_b32 s23, 0x28000
    buffer_load_dwordx4 v[60:63], v6, s[8:11], s23 offen offset:3072 sc1
    s_waitcnt lgkmcnt(6)
    v_mfma_f32_16x16x32_bf16 v[112:115], v[228:231], v[64:67], v[112:115]
    ds_read_b64_tr_b16 v[244:245], v8 offset:17184
    v_mfma_f32_16x16x32_bf16 v[116:119], v[228:231], v[68:71], v[116:119]
    ds_read_b64_tr_b16 v[246:247], v8 offset:18208
    s_waitcnt lgkmcnt(6)
    v_mfma_f32_16x16x32_bf16 v[120:123], v[232:235], v[64:67], v[120:123]
    v_mfma_f32_16x16x32_bf16 v[124:127], v[232:235], v[68:71], v[124:127]
    s_waitcnt vmcnt(14)
    s_barrier
    ds_read_b64_tr_b16 v[224:225], v4 offset:0
    ds_read_b64_tr_b16 v[226:227], v4 offset:1024
    s_waitcnt lgkmcnt(6)
    v_mfma_f32_16x16x32_bf16 v[128:131], v[236:239], v[64:67], v[128:131]
    s_add_u32 s22, s24, 0x230000
    s_add_u32 m0, s20, 0x20000
    s_nop 0
    buffer_load_dwordx4 v3, s[4:7], s22 offen lds
    ds_read_b64_tr_b16 v[228:229], v5 offset:32
    v_mfma_f32_16x16x32_bf16 v[132:135], v[236:239], v[68:71], v[132:135]
    ds_read_b64_tr_b16 v[230:231], v5 offset:1056
    s_waitcnt lgkmcnt(6)
    v_mfma_f32_16x16x32_bf16 v[136:139], v[240:243], v[64:67], v[136:139]
    ds_read_b64_tr_b16 v[232:233], v4 offset:256
    v_mfma_f32_16x16x32_bf16 v[140:143], v[240:243], v[68:71], v[140:143]
    s_add_u32 s22, s24, 0x232000
    s_add_u32 m0, s20, 0x20400
    s_nop 0
    buffer_load_dwordx4 v3, s[4:7], s22 offen lds
    ds_read_b64_tr_b16 v[234:235], v4 offset:1280
    s_waitcnt lgkmcnt(6)
    v_mfma_f32_16x16x32_bf16 v[144:147], v[244:247], v[64:67], v[144:147]
    ds_read_b64_tr_b16 v[236:237], v5 offset:288
    v_mfma_f32_16x16x32_bf16 v[148:151], v[244:247], v[68:71], v[148:151]
    ds_read_b64_tr_b16 v[238:239], v5 offset:1312
    s_waitcnt lgkmcnt(6)
    v_mfma_f32_16x16x32_bf16 v[88:91], v[224:227], v[24:27], v[88:91]
    ds_read_b64_tr_b16 v[240:241], v4 offset:512
    v_mfma_f32_16x16x32_bf16 v[92:95], v[224:227], v[28:31], v[92:95]
    ds_read_b64_tr_b16 v[242:243], v4 offset:1536
    s_waitcnt lgkmcnt(6)
    v_mfma_f32_16x16x32_bf16 v[96:99], v[228:231], v[24:27], v[96:99]
    ds_read_b64_tr_b16 v[244:245], v5 offset:544
    s_mov_b32 s23, 0xa000
    buffer_load_dwordx4 v[64:67], v6, s[8:11], s23 offen offset:3072 sc1
    v_mfma_f32_16x16x32_bf16 v[100:103], v[228:231], v[28:31], v[100:103]
    ds_read_b64_tr_b16 v[246:247], v5 offset:1568
    s_waitcnt lgkmcnt(6)
    v_mfma_f32_16x16x32_bf16 v[104:107], v[232:235], v[24:27], v[104:107]
    ds_read_b64_tr_b16 v[224:225], v4 offset:768
    v_mfma_f32_16x16x32_bf16 v[108:111], v[232:235], v[28:31], v[108:111]
    ds_read_b64_tr_b16 v[226:227], v4 offset:1792
    s_mov_b32 s23, 0x2a000
    buffer_load_dwordx4 v[68:71], v6, s[8:11], s23 offen offset:3072 sc1
    s_waitcnt lgkmcnt(6)
    v_mfma_f32_16x16x32_bf16 v[112:115], v[236:239], v[24:27], v[112:115]
    ds_read_b64_tr_b16 v[228:229], v5 offset:800
    v_mfma_f32_16x16x32_bf16 v[116:119], v[236:239], v[28:31], v[116:119]
    ds_read_b64_tr_b16 v[230:231], v5 offset:1824
    s_waitcnt lgkmcnt(6)
    v_mfma_f32_16x16x32_bf16 v[120:123], v[240:243], v[24:27], v[120:123]
    v_mfma_f32_16x16x32_bf16 v[124:127], v[240:243], v[28:31], v[124:127]
    s_waitcnt vmcnt(14)
    s_barrier
    ds_read_b64_tr_b16 v[232:233], v4 offset:16384
    ds_read_b64_tr_b16 v[234:235], v4 offset:17408
    s_waitcnt lgkmcnt(6)
    v_mfma_f32_16x16x32_bf16 v[128:131], v[244:247], v[24:27], v[128:131]
    s_add_u32 s22, s24, 0x2b0000
    s_add_u32 m0, s20, 0x24000
    s_nop 0
    buffer_load_dwordx4 v3, s[4:7], s22 offen lds
    ds_read_b64_tr_b16 v[236:237], v5 offset:16416
    v_mfma_f32_16x16x32_bf16 v[132:135], v[244:247], v[28:31], v[132:135]
    ds_read_b64_tr_b16 v[238:239], v5 offset:17440
    s_waitcnt lgkmcnt(6)
    v_mfma_f32_16x16x32_bf16 v[136:139], v[224:227], v[24:27], v[136:139]
    ds_read_b64_tr_b16 v[240:241], v4 offset:16640
    v_mfma_f32_16x16x32_bf16 v[140:143], v[224:227], v[28:31], v[140:143]
    s_add_u32 s22, s24, 0x2b2000
    s_add_u32 m0, s20, 0x24400
    s_nop 0
    buffer_load_dwordx4 v3, s[4:7], s22 offen lds
    ds_read_b64_tr_b16 v[242:243], v4 offset:17664
    s_waitcnt lgkmcnt(6)
    v_mfma_f32_16x16x32_bf16 v[144:147], v[228:231], v[24:27], v[144:147]
    ds_read_b64_tr_b16 v[244:245], v5 offset:16672
    v_mfma_f32_16x16x32_bf16 v[148:151], v[228:231], v[28:31], v[148:151]
    ds_read_b64_tr_b16 v[246:247], v5 offset:17696
    s_waitcnt lgkmcnt(6)
    v_mfma_f32_16x16x32_bf16 v[88:91], v[232:235], v[32:35], v[88:91]
    ds_read_b64_tr_b16 v[224:225], v4 offset:16896
    v_mfma_f32_16x16x32_bf16 v[92:95], v[232:235], v[36:39], v[92:95]
    ds_read_b64_tr_b16 v[226:227], v4 offset:17920
    s_waitcnt lgkmcnt(6)
    v_mfma_f32_16x16x32_bf16 v[96:99], v[236:239], v[32:35], v[96:99]
    ds_read_b64_tr_b16 v[228:229], v5 offset:16928
    s_mov_b32 s23, 0xc000
    buffer_load_dwordx4 v[24:27], v6, s[8:11], s23 offen offset:3072 sc1
    v_mfma_f32_16x16x32_bf16 v[100:103], v[236:239], v[36:39], v[100:103]
    ds_read_b64_tr_b16 v[230:231], v5 offset:17952
    s_waitcnt lgkmcnt(6)
    v_mfma_f32_16x16x32_bf16 v[104:107], v[240:243], v[32:35], v[104:107]
    ds_read_b64_tr_b16 v[232:233], v4 offset:17152
    v_mfma_f32_16x16x32_bf16 v[108:111], v[240:243], v[36:39], v[108:111]
    ds_read_b64_tr_b16 v[234:235], v4 offset:18176
    s_mov_b32 s23, 0x2c000
    buffer_load_dwordx4 v[28:31], v6, s[8:11], s23 offen offset:3072 sc1
    s_mov_b32 s16, 0x544000
    buffer_load_dwordx4 v[184:187], v2, s[8:11], s16 offen sc1
    s_waitcnt lgkmcnt(6)
    v_mfma_f32_16x16x32_bf16 v[112:115], v[244:247], v[32:35], v[112:115]
    ds_read_b64_tr_b16 v[236:237], v5 offset:17184
    v_mfma_f32_16x16x32_bf16 v[116:119], v[244:247], v[36:39], v[116:119]
    ds_read_b64_tr_b16 v[238:239], v5 offset:18208
    s_waitcnt lgkmcnt(6)
    v_mfma_f32_16x16x32_bf16 v[120:123], v[224:227], v[32:35], v[120:123]
    v_mfma_f32_16x16x32_bf16 v[124:127], v[224:227], v[36:39], v[124:127]
    s_waitcnt vmcnt(15)
    s_barrier
    ds_read_b64_tr_b16 v[240:241], v4 offset:32768
    ds_read_b64_tr_b16 v[242:243], v4 offset:33792
    s_waitcnt lgkmcnt(6)
    v_mfma_f32_16x16x32_bf16 v[128:131], v[228:231], v[32:35], v[128:131]
    s_add_u32 s22, s24, 0x330000
    s_add_u32 m0, s20, 0x10000
    s_nop 0
    buffer_load_dwordx4 v3, s[4:7], s22 offen lds
    ds_read_b64_tr_b16 v[244:245], v5 offset:32800
    v_mfma_f32_16x16x32_bf16 v[132:135], v[228:231], v[36:39], v[132:135]
    ds_read_b64_tr_b16 v[246:247], v5 offset:33824
    s_waitcnt lgkmcnt(6)
    v_mfma_f32_16x16x32_bf16 v[136:139], v[232:235], v[32:35], v[136:139]
    ds_read_b64_tr_b16 v[224:225], v4 offset:33024
    v_mfma_f32_16x16x32_bf16 v[140:143], v[232:235], v[36:39], v[140:143]
    s_add_u32 s22, s24, 0x332000
    s_add_u32 m0, s20, 0x10400
    s_nop 0
    buffer_load_dwordx4 v3, s[4:7], s22 offen lds
    ds_read_b64_tr_b16 v[226:227], v4 offset:34048
    s_waitcnt lgkmcnt(6)
    v_mfma_f32_16x16x32_bf16 v[144:147], v[236:239], v[32:35], v[144:147]
    ds_read_b64_tr_b16 v[228:229], v5 offset:33056
    v_mfma_f32_16x16x32_bf16 v[148:151], v[236:239], v[36:39], v[148:151]
    ds_read_b64_tr_b16 v[230:231], v5 offset:34080
    s_waitcnt lgkmcnt(6)
    v_mfma_f32_16x16x32_bf16 v[88:91], v[240:243], v[40:43], v[88:91]
    ds_read_b64_tr_b16 v[232:233], v4 offset:33280
    v_mfma_f32_16x16x32_bf16 v[92:95], v[240:243], v[44:47], v[92:95]
    ds_read_b64_tr_b16 v[234:235], v4 offset:34304
    s_waitcnt lgkmcnt(6)
    v_mfma_f32_16x16x32_bf16 v[96:99], v[244:247], v[40:43], v[96:99]
    ds_read_b64_tr_b16 v[236:237], v5 offset:33312
    s_mov_b32 s23, 0xe000
    buffer_load_dwordx4 v[32:35], v6, s[8:11], s23 offen offset:3072 sc1
    v_mfma_f32_16x16x32_bf16 v[100:103], v[244:247], v[44:47], v[100:103]
    ds_read_b64_tr_b16 v[238:239], v5 offset:34336
    s_waitcnt lgkmcnt(6)
    v_mfma_f32_16x16x32_bf16 v[104:107], v[224:227], v[40:43], v[104:107]
    ds_read_b64_tr_b16 v[240:241], v4 offset:33536
    v_mfma_f32_16x16x32_bf16 v[108:111], v[224:227], v[44:47], v[108:111]
    ds_read_b64_tr_b16 v[242:243], v4 offset:34560
    s_mov_b32 s23, 0x2e000
    buffer_load_dwordx4 v[36:39], v6, s[8:11], s23 offen offset:3072 sc1
    s_waitcnt vmcnt(4)
    v_xor_b32 v16, s28, v184
    v_xor_b32 v17, s28, v185
    v_xor_b32 v18, s28, v186
    v_xor_b32 v19, s28, v187
    v_or3_b32 v16, v16, v17, v18
    v_or_b32 v16, v16, v19
    v_cmp_ne_u32 vcc, 0, v16
    s_cbranch_vccnz adaLN_cond__sliding_block_cached__moe_arch_mod__prompt_kernel_mf10r
adaLN_cond__sliding_block_cached__moe_arch_mod__prompt_kernel_mf10b:
    s_waitcnt lgkmcnt(6)
    v_mfma_f32_16x16x32_bf16 v[112:115], v[228:231], v[40:43], v[112:115]
    ds_read_b64_tr_b16 v[244:245], v5 offset:33568
    v_mfma_f32_16x16x32_bf16 v[116:119], v[228:231], v[44:47], v[116:119]
    ds_read_b64_tr_b16 v[246:247], v5 offset:34592
    s_waitcnt lgkmcnt(6)
    v_mfma_f32_16x16x32_bf16 v[120:123], v[232:235], v[40:43], v[120:123]
    v_mfma_f32_16x16x32_bf16 v[124:127], v[232:235], v[44:47], v[124:127]
    s_barrier
    ds_read_b64_tr_b16 v[224:225], v4 offset:49152
    ds_read_b64_tr_b16 v[226:227], v4 offset:50176
    s_waitcnt lgkmcnt(6)
    v_mfma_f32_16x16x32_bf16 v[128:131], v[236:239], v[40:43], v[128:131]
    s_add_u32 s22, s24, 0x3b0000
    s_add_u32 m0, s20, 0x14000
    s_nop 0
    buffer_load_dwordx4 v3, s[4:7], s22 offen lds
    ds_read_b64_tr_b16 v[228:229], v5 offset:49184
    v_mfma_f32_16x16x32_bf16 v[132:135], v[236:239], v[44:47], v[132:135]
    ds_read_b64_tr_b16 v[230:231], v5 offset:50208
    s_waitcnt lgkmcnt(6)
    v_mfma_f32_16x16x32_bf16 v[136:139], v[240:243], v[40:43], v[136:139]
    ds_read_b64_tr_b16 v[232:233], v4 offset:49408
    v_mfma_f32_16x16x32_bf16 v[140:143], v[240:243], v[44:47], v[140:143]
    s_add_u32 s22, s24, 0x3b2000
    s_add_u32 m0, s20, 0x14400
    s_nop 0
    buffer_load_dwordx4 v3, s[4:7], s22 offen lds
    ds_read_b64_tr_b16 v[234:235], v4 offset:50432
    s_waitcnt lgkmcnt(6)
    v_mfma_f32_16x16x32_bf16 v[144:147], v[244:247], v[40:43], v[144:147]
    ds_read_b64_tr_b16 v[236:237], v5 offset:49440
    v_mfma_f32_16x16x32_bf16 v[148:151], v[244:247], v[44:47], v[148:151]
    ds_read_b64_tr_b16 v[238:239], v5 offset:50464
    s_waitcnt lgkmcnt(6)
    v_mfma_f32_16x16x32_bf16 v[88:91], v[224:227], v[48:51], v[88:91]
    ds_read_b64_tr_b16 v[240:241], v4 offset:49664
    v_mfma_f32_16x16x32_bf16 v[92:95], v[224:227], v[52:55], v[92:95]
    ds_read_b64_tr_b16 v[242:243], v4 offset:50688
    s_waitcnt lgkmcnt(6)
    v_mfma_f32_16x16x32_bf16 v[96:99], v[228:231], v[48:51], v[96:99]
    ds_read_b64_tr_b16 v[244:245], v5 offset:49696
    v_mfma_f32_16x16x32_bf16 v[100:103], v[228:231], v[52:55], v[100:103]
    ds_read_b64_tr_b16 v[246:247], v5 offset:50720
    s_waitcnt lgkmcnt(6)
    v_mfma_f32_16x16x32_bf16 v[104:107], v[232:235], v[48:51], v[104:107]
    ds_read_b64_tr_b16 v[224:225], v4 offset:49920
    v_mfma_f32_16x16x32_bf16 v[108:111], v[232:235], v[52:55], v[108:111]
    ds_read_b64_tr_b16 v[226:227], v4 offset:50944
    v_lshrrev_b32 v16, 4, v1
    v_lshlrev_b32 v16, 3, v16
    s_lshl_b32 s16, s31, 8
    s_add_u32 s16, s16, 0x540000
    buffer_load_dwordx2 v[248:249], v16, s[8:11], s16 offen offset:0 sc1
    buffer_load_dwordx2 v[250:251], v16, s[8:11], s16 offen offset:32 sc1
    buffer_load_dwordx2 v[252:253], v16, s[8:11], s16 offen offset:64 sc1
    buffer_load_dwordx2 v[254:255], v16, s[8:11], s16 offen offset:96 sc1
    s_waitcnt lgkmcnt(6)
    v_mfma_f32_16x16x32_bf16 v[112:115], v[236:239], v[48:51], v[112:115]
    ds_read_b64_tr_b16 v[228:229], v5 offset:49952
    v_mfma_f32_16x16x32_bf16 v[116:119], v[236:239], v[52:55], v[116:119]
    ds_read_b64_tr_b16 v[230:231], v5 offset:50976
    s_waitcnt lgkmcnt(6)
    v_mfma_f32_16x16x32_bf16 v[120:123], v[240:243], v[48:51], v[120:123]
    v_mfma_f32_16x16x32_bf16 v[124:127], v[240:243], v[52:55], v[124:127]
    s_barrier
    ds_read_b64_tr_b16 v[232:233], v7 offset:0
    ds_read_b64_tr_b16 v[234:235], v7 offset:1024
    s_waitcnt lgkmcnt(6)
    v_mfma_f32_16x16x32_bf16 v[128:131], v[244:247], v[48:51], v[128:131]
    ds_read_b64_tr_b16 v[236:237], v8 offset:32
    v_mfma_f32_16x16x32_bf16 v[132:135], v[244:247], v[52:55], v[132:135]
    ds_read_b64_tr_b16 v[238:239], v8 offset:1056
    s_waitcnt lgkmcnt(6)
    v_mfma_f32_16x16x32_bf16 v[136:139], v[224:227], v[48:51], v[136:139]
    ds_read_b64_tr_b16 v[240:241], v7 offset:256
    v_mfma_f32_16x16x32_bf16 v[140:143], v[224:227], v[52:55], v[140:143]
    ds_read_b64_tr_b16 v[242:243], v7 offset:1280
    s_waitcnt lgkmcnt(6)
    v_mfma_f32_16x16x32_bf16 v[144:147], v[228:231], v[48:51], v[144:147]
    ds_read_b64_tr_b16 v[244:245], v8 offset:288
    v_mfma_f32_16x16x32_bf16 v[148:151], v[228:231], v[52:55], v[148:151]
    ds_read_b64_tr_b16 v[246:247], v8 offset:1312
    s_waitcnt lgkmcnt(6)
    v_mfma_f32_16x16x32_bf16 v[88:91], v[232:235], v[56:59], v[88:91]
    ds_read_b64_tr_b16 v[224:225], v7 offset:512
    v_mfma_f32_16x16x32_bf16 v[92:95], v[232:235], v[60:63], v[92:95]
    ds_read_b64_tr_b16 v[226:227], v7 offset:1536
    s_waitcnt lgkmcnt(6)
    v_mfma_f32_16x16x32_bf16 v[96:99], v[236:239], v[56:59], v[96:99]
    ds_read_b64_tr_b16 v[228:229], v8 offset:544
    v_mfma_f32_16x16x32_bf16 v[100:103], v[236:239], v[60:63], v[100:103]
    ds_read_b64_tr_b16 v[230:231], v8 offset:1568
    s_waitcnt lgkmcnt(6)
    v_mfma_f32_16x16x32_bf16 v[104:107], v[240:243], v[56:59], v[104:107]
    ds_read_b64_tr_b16 v[232:233], v7 offset:768
    v_mfma_f32_16x16x32_bf16 v[108:111], v[240:243], v[60:63], v[108:111]
    ds_read_b64_tr_b16 v[234:235], v7 offset:1792
    s_waitcnt lgkmcnt(6)
    v_mfma_f32_16x16x32_bf16 v[112:115], v[244:247], v[56:59], v[112:115]
    ds_read_b64_tr_b16 v[236:237], v8 offset:800
    v_mfma_f32_16x16x32_bf16 v[116:119], v[244:247], v[60:63], v[116:119]
    ds_read_b64_tr_b16 v[238:239], v8 offset:1824
    s_waitcnt lgkmcnt(6)
    v_mfma_f32_16x16x32_bf16 v[120:123], v[224:227], v[56:59], v[120:123]
    v_mfma_f32_16x16x32_bf16 v[124:127], v[224:227], v[60:63], v[124:127]
    s_barrier
    ds_read_b64_tr_b16 v[240:241], v7 offset:16384
    ds_read_b64_tr_b16 v[242:243], v7 offset:17408
    s_waitcnt lgkmcnt(6)
    v_mfma_f32_16x16x32_bf16 v[128:131], v[228:231], v[56:59], v[128:131]
    ds_read_b64_tr_b16 v[244:245], v8 offset:16416
    v_mfma_f32_16x16x32_bf16 v[132:135], v[228:231], v[60:63], v[132:135]
    ds_read_b64_tr_b16 v[246:247], v8 offset:17440
    s_waitcnt lgkmcnt(6)
    v_mfma_f32_16x16x32_bf16 v[136:139], v[232:235], v[56:59], v[136:139]
    ds_read_b64_tr_b16 v[224:225], v7 offset:16640
    v_mfma_f32_16x16x32_bf16 v[140:143], v[232:235], v[60:63], v[140:143]
    ds_read_b64_tr_b16 v[226:227], v7 offset:17664
    s_waitcnt lgkmcnt(6)
    v_mfma_f32_16x16x32_bf16 v[144:147], v[236:239], v[56:59], v[144:147]
    ds_read_b64_tr_b16 v[228:229], v8 offset:16672
    v_mfma_f32_16x16x32_bf16 v[148:151], v[236:239], v[60:63], v[148:151]
    ds_read_b64_tr_b16 v[230:231], v8 offset:17696
    s_waitcnt lgkmcnt(6)
    v_mfma_f32_16x16x32_bf16 v[88:91], v[240:243], v[64:67], v[88:91]
    ds_read_b64_tr_b16 v[232:233], v7 offset:16896
    v_mfma_f32_16x16x32_bf16 v[92:95], v[240:243], v[68:71], v[92:95]
    ds_read_b64_tr_b16 v[234:235], v7 offset:17920
    s_waitcnt lgkmcnt(6)
    v_mfma_f32_16x16x32_bf16 v[96:99], v[244:247], v[64:67], v[96:99]
    ds_read_b64_tr_b16 v[236:237], v8 offset:16928
    v_mfma_f32_16x16x32_bf16 v[100:103], v[244:247], v[68:71], v[100:103]
    ds_read_b64_tr_b16 v[238:239], v8 offset:17952
    s_waitcnt lgkmcnt(6)
    v_mfma_f32_16x16x32_bf16 v[104:107], v[224:227], v[64:67], v[104:107]
    ds_read_b64_tr_b16 v[240:241], v7 offset:17152
    v_mfma_f32_16x16x32_bf16 v[108:111], v[224:227], v[68:71], v[108:111]
    ds_read_b64_tr_b16 v[242:243], v7 offset:18176
    s_waitcnt lgkmcnt(6)
    v_mfma_f32_16x16x32_bf16 v[112:115], v[228:231], v[64:67], v[112:115]
    ds_read_b64_tr_b16 v[244:245], v8 offset:17184
    v_mfma_f32_16x16x32_bf16 v[116:119], v[228:231], v[68:71], v[116:119]
    ds_read_b64_tr_b16 v[246:247], v8 offset:18208
    s_waitcnt lgkmcnt(6)
    v_mfma_f32_16x16x32_bf16 v[120:123], v[232:235], v[64:67], v[120:123]
    v_mfma_f32_16x16x32_bf16 v[124:127], v[232:235], v[68:71], v[124:127]
    s_waitcnt vmcnt(8)
    s_barrier
    ds_read_b64_tr_b16 v[224:225], v4 offset:0
    ds_read_b64_tr_b16 v[226:227], v4 offset:1024
    s_waitcnt lgkmcnt(6)
    v_mfma_f32_16x16x32_bf16 v[128:131], v[236:239], v[64:67], v[128:131]
    ds_read_b64_tr_b16 v[228:229], v5 offset:32
    v_mfma_f32_16x16x32_bf16 v[132:135], v[236:239], v[68:71], v[132:135]
    ds_read_b64_tr_b16 v[230:231], v5 offset:1056
    s_waitcnt lgkmcnt(6)
    v_mfma_f32_16x16x32_bf16 v[136:139], v[240:243], v[64:67], v[136:139]
    ds_read_b64_tr_b16 v[232:233], v4 offset:256
    v_mfma_f32_16x16x32_bf16 v[140:143], v[240:243], v[68:71], v[140:143]
    ds_read_b64_tr_b16 v[234:235], v4 offset:1280
    s_waitcnt lgkmcnt(6)
    v_mfma_f32_16x16x32_bf16 v[144:147], v[244:247], v[64:67], v[144:147]
    ds_read_b64_tr_b16 v[236:237], v5 offset:288
    v_mfma_f32_16x16x32_bf16 v[148:151], v[244:247], v[68:71], v[148:151]
    ds_read_b64_tr_b16 v[238:239], v5 offset:1312
    s_waitcnt lgkmcnt(6)
    v_mfma_f32_16x16x32_bf16 v[88:91], v[224:227], v[24:27], v[88:91]
    ds_read_b64_tr_b16 v[240:241], v4 offset:512
    v_mfma_f32_16x16x32_bf16 v[92:95], v[224:227], v[28:31], v[92:95]
    ds_read_b64_tr_b16 v[242:243], v4 offset:1536
    s_waitcnt lgkmcnt(6)
    v_mfma_f32_16x16x32_bf16 v[96:99], v[228:231], v[24:27], v[96:99]
    ds_read_b64_tr_b16 v[244:245], v5 offset:544
    v_mfma_f32_16x16x32_bf16 v[100:103], v[228:231], v[28:31], v[100:103]
    ds_read_b64_tr_b16 v[246:247], v5 offset:1568
    s_waitcnt lgkmcnt(6)
    v_mfma_f32_16x16x32_bf16 v[104:107], v[232:235], v[24:27], v[104:107]
    ds_read_b64_tr_b16 v[224:225], v4 offset:768
    v_mfma_f32_16x16x32_bf16 v[108:111], v[232:235], v[28:31], v[108:111]
    ds_read_b64_tr_b16 v[226:227], v4 offset:1792
    s_waitcnt lgkmcnt(6)
    v_mfma_f32_16x16x32_bf16 v[112:115], v[236:239], v[24:27], v[112:115]
    ds_read_b64_tr_b16 v[228:229], v5 offset:800
    v_mfma_f32_16x16x32_bf16 v[116:119], v[236:239], v[28:31], v[116:119]
    ds_read_b64_tr_b16 v[230:231], v5 offset:1824
    s_waitcnt lgkmcnt(6)
    v_mfma_f32_16x16x32_bf16 v[120:123], v[240:243], v[24:27], v[120:123]
    v_mfma_f32_16x16x32_bf16 v[124:127], v[240:243], v[28:31], v[124:127]
    s_waitcnt vmcnt(4)
    s_barrier
    ds_read_b64_tr_b16 v[232:233], v4 offset:16384
    ds_read_b64_tr_b16 v[234:235], v4 offset:17408
    s_waitcnt lgkmcnt(6)
    v_mfma_f32_16x16x32_bf16 v[128:131], v[244:247], v[24:27], v[128:131]
    ds_read_b64_tr_b16 v[236:237], v5 offset:16416
    v_mfma_f32_16x16x32_bf16 v[132:135], v[244:247], v[28:31], v[132:135]
    ds_read_b64_tr_b16 v[238:239], v5 offset:17440
    s_waitcnt lgkmcnt(6)
    v_mfma_f32_16x16x32_bf16 v[136:139], v[224:227], v[24:27], v[136:139]
    ds_read_b64_tr_b16 v[240:241], v4 offset:16640
    v_mfma_f32_16x16x32_bf16 v[140:143], v[224:227], v[28:31], v[140:143]
    ds_read_b64_tr_b16 v[242:243], v4 offset:17664
    s_waitcnt lgkmcnt(6)
    v_mfma_f32_16x16x32_bf16 v[144:147], v[228:231], v[24:27], v[144:147]
    ds_read_b64_tr_b16 v[244:245], v5 offset:16672
    v_mfma_f32_16x16x32_bf16 v[148:151], v[228:231], v[28:31], v[148:151]
    ds_read_b64_tr_b16 v[246:247], v5 offset:17696
    s_waitcnt lgkmcnt(6)
    v_mfma_f32_16x16x32_bf16 v[88:91], v[232:235], v[32:35], v[88:91]
    ds_read_b64_tr_b16 v[224:225], v4 offset:16896
    v_mfma_f32_16x16x32_bf16 v[92:95], v[232:235], v[36:39], v[92:95]
    ds_read_b64_tr_b16 v[226:227], v4 offset:17920
    s_waitcnt lgkmcnt(6)
    v_mfma_f32_16x16x32_bf16 v[96:99], v[236:239], v[32:35], v[96:99]
    ds_read_b64_tr_b16 v[228:229], v5 offset:16928
    v_mfma_f32_16x16x32_bf16 v[100:103], v[236:239], v[36:39], v[100:103]
    ds_read_b64_tr_b16 v[230:231], v5 offset:17952
    s_waitcnt lgkmcnt(6)
    v_mfma_f32_16x16x32_bf16 v[104:107], v[240:243], v[32:35], v[104:107]
    ds_read_b64_tr_b16 v[232:233], v4 offset:17152
    v_mfma_f32_16x16x32_bf16 v[108:111], v[240:243], v[36:39], v[108:111]
    ds_read_b64_tr_b16 v[234:235], v4 offset:18176
    s_waitcnt lgkmcnt(6)
    v_mfma_f32_16x16x32_bf16 v[112:115], v[244:247], v[32:35], v[112:115]
    ds_read_b64_tr_b16 v[236:237], v5 offset:17184
    v_mfma_f32_16x16x32_bf16 v[116:119], v[244:247], v[36:39], v[116:119]
    ds_read_b64_tr_b16 v[238:239], v5 offset:18208
    s_waitcnt lgkmcnt(6)
    v_mfma_f32_16x16x32_bf16 v[120:123], v[224:227], v[32:35], v[120:123]
    v_mfma_f32_16x16x32_bf16 v[124:127], v[224:227], v[36:39], v[124:127]
    s_waitcnt lgkmcnt(4)
    v_mfma_f32_16x16x32_bf16 v[128:131], v[228:231], v[32:35], v[128:131]
    v_mfma_f32_16x16x32_bf16 v[132:135], v[228:231], v[36:39], v[132:135]
    s_waitcnt lgkmcnt(2)
    v_mfma_f32_16x16x32_bf16 v[136:139], v[232:235], v[32:35], v[136:139]
    v_mfma_f32_16x16x32_bf16 v[140:143], v[232:235], v[36:39], v[140:143]
    s_waitcnt lgkmcnt(0)
    v_mfma_f32_16x16x32_bf16 v[144:147], v[236:239], v[32:35], v[144:147]
    v_mfma_f32_16x16x32_bf16 v[148:151], v[236:239], v[36:39], v[148:151]
    s_lshl_b32 s16, s3, 13
    s_xor_b32 s17, s16, 0x8000
    s_add_u32 s16, s16, 0x18000
    s_add_u32 s17, s17, 0x18000
    v_add_u32 v16, s16, v2
    s_mov_b32 s16, s17
    v_add_u32 v17, s16, v2
    ds_write_b128 v16, v[120:123] offset:0
    ds_write_b128 v16, v[124:127] offset:1024
    ds_write_b128 v16, v[128:131] offset:2048
    ds_write_b128 v16, v[132:135] offset:3072
    ds_write_b128 v16, v[136:139] offset:4096
    ds_write_b128 v16, v[140:143] offset:5120
    ds_write_b128 v16, v[144:147] offset:6144
    ds_write_b128 v16, v[148:151] offset:7168
    s_waitcnt vmcnt(3)
    v_lshlrev_b32 v24, 16, v248
    v_and_b32 v25, 0xffff0000, v248
    v_lshlrev_b32 v26, 16, v249
    v_and_b32 v27, 0xffff0000, v249
    s_waitcnt vmcnt(2)
    v_lshlrev_b32 v28, 16, v250
    v_and_b32 v29, 0xffff0000, v250
    v_lshlrev_b32 v30, 16, v251
    v_and_b32 v31, 0xffff0000, v251
    s_waitcnt vmcnt(1)
    v_lshlrev_b32 v32, 16, v252
    v_and_b32 v33, 0xffff0000, v252
    v_lshlrev_b32 v34, 16, v253
    v_and_b32 v35, 0xffff0000, v253
    s_waitcnt vmcnt(0)
    v_lshlrev_b32 v36, 16, v254
    v_and_b32 v37, 0xffff0000, v254
    v_lshlrev_b32 v38, 16, v255
    v_and_b32 v39, 0xffff0000, v255
    v_and_b32 v18, 15, v1
    v_lshlrev_b32 v18, 6, v18
    v_lshrrev_b32 v19, 4, v1
    v_and_b32 v20, 1, v19
    v_lshl_add_u32 v18, v20, 5, v18
    v_lshrrev_b32 v19, 1, v19
    v_lshl_add_u32 v18, v19, 4, v18
    s_and_b32 s17, s3, 3
    s_lshl_b32 s18, s30, 2
    s_add_u32 s18, s18, s17
    s_lshl_b32 s18, s18, 16
    s_lshl_b32 s19, s15, 22
    s_add_u32 s18, s18, s19
    s_lshl_b32 s19, s31, 12
    s_add_u32 s18, s18, s19
    s_add_u32 s18, s18, 0x2000000
    s_add_u32 s19, s18, 32768
    s_waitcnt lgkmcnt(0)
    s_barrier
    ds_read_b128 v[40:43], v17 offset:0
    ds_read_b128 v[44:47], v17 offset:1024
    ds_read_b128 v[48:51], v17 offset:2048
    ds_read_b128 v[52:55], v17 offset:3072
    ds_read_b128 v[56:59], v17 offset:4096
    ds_read_b128 v[60:63], v17 offset:5120
    ds_read_b128 v[64:67], v17 offset:6144
    ds_read_b128 v[68:71], v17 offset:7168
    s_waitcnt lgkmcnt(7)
    v_pk_add_f32 v[88:89], v[88:89], v[40:41]
    v_pk_add_f32 v[90:91], v[90:91], v[42:43]
    v_pk_mul_f32 v[88:89], v[88:89], v[24:25]
    v_pk_mul_f32 v[90:91], v[90:91], v[26:27]
    v_cvt_pk_bf16_f32 v224, v88, v89
    v_cvt_pk_bf16_f32 v225, v90, v91
    s_waitcnt lgkmcnt(5)
    v_pk_add_f32 v[96:97], v[96:97], v[48:49]
    v_pk_add_f32 v[98:99], v[98:99], v[50:51]
    v_pk_mul_f32 v[96:97], v[96:97], v[28:29]
    v_pk_mul_f32 v[98:99], v[98:99], v[30:31]
    v_cvt_pk_bf16_f32 v226, v96, v97
    v_cvt_pk_bf16_f32 v227, v98, v99
    s_nop 0
    v_permlane16_swap_b32 v224, v226
    v_permlane16_swap_b32 v225, v227
    buffer_store_dwordx4 v[224:227], v18, s[8:11], s18 offen offset:0 sc1
    v_pk_add_f32 v[92:93], v[92:93], v[44:45]
    v_pk_add_f32 v[94:95], v[94:95], v[46:47]
    v_pk_mul_f32 v[92:93], v[92:93], v[24:25]
    v_pk_mul_f32 v[94:95], v[94:95], v[26:27]
    v_cvt_pk_bf16_f32 v228, v92, v93
    v_cvt_pk_bf16_f32 v229, v94, v95
    s_waitcnt lgkmcnt(4)
    v_pk_add_f32 v[100:101], v[100:101], v[52:53]
    v_pk_add_f32 v[102:103], v[102:103], v[54:55]
    v_pk_mul_f32 v[100:101], v[100:101], v[28:29]
    v_pk_mul_f32 v[102:103], v[102:103], v[30:31]
    v_cvt_pk_bf16_f32 v230, v100, v101
    v_cvt_pk_bf16_f32 v231, v102, v103
    s_nop 0
    v_permlane16_swap_b32 v228, v230
    v_permlane16_swap_b32 v229, v231
    buffer_store_dwordx4 v[228:231], v18, s[8:11], s19 offen offset:0 sc1
    s_waitcnt lgkmcnt(3)
    v_pk_add_f32 v[104:105], v[104:105], v[56:57]
    v_pk_add_f32 v[106:107], v[106:107], v[58:59]
    v_pk_mul_f32 v[104:105], v[104:105], v[32:33]
    v_pk_mul_f32 v[106:107], v[106:107], v[34:35]
    v_cvt_pk_bf16_f32 v232, v104, v105
    v_cvt_pk_bf16_f32 v233, v106, v107
    s_waitcnt lgkmcnt(1)
    v_pk_add_f32 v[112:113], v[112:113], v[64:65]
    v_pk_add_f32 v[114:115], v[114:115], v[66:67]
    v_pk_mul_f32 v[112:113], v[112:113], v[36:37]
    v_pk_mul_f32 v[114:115], v[114:115], v[38:39]
    v_cvt_pk_bf16_f32 v234, v112, v113
    v_cvt_pk_bf16_f32 v235, v114, v115
    s_nop 0
    v_permlane16_swap_b32 v232, v234
    v_permlane16_swap_b32 v233, v235
    buffer_store_dwordx4 v[232:235], v18, s[8:11], s18 offen offset:1024 sc1
    v_pk_add_f32 v[108:109], v[108:109], v[60:61]
    v_pk_add_f32 v[110:111], v[110:111], v[62:63]
    v_pk_mul_f32 v[108:109], v[108:109], v[32:33]
    v_pk_mul_f32 v[110:111], v[110:111], v[34:35]
    v_cvt_pk_bf16_f32 v236, v108, v109
    v_cvt_pk_bf16_f32 v237, v110, v111
    s_waitcnt lgkmcnt(0)
    v_pk_add_f32 v[116:117], v[116:117], v[68:69]
    v_pk_add_f32 v[118:119], v[118:119], v[70:71]
    v_pk_mul_f32 v[116:117], v[116:117], v[36:37]
    v_pk_mul_f32 v[118:119], v[118:119], v[38:39]
    v_cvt_pk_bf16_f32 v238, v116, v117
    v_cvt_pk_bf16_f32 v239, v118, v119
    s_nop 0
    v_permlane16_swap_b32 v236, v238
    v_permlane16_swap_b32 v237, v239
    buffer_store_dwordx4 v[236:239], v18, s[8:11], s19 offen offset:1024 sc1
    s_mov_b64 s[64:65], s[44:45]
    s_mov_b32 s66, 0x800
    s_mov_b32 s67, 0x20000
    s_mov_b64 s[76:77], s[32:33]
    s_mov_b32 s78, 0x400000
    s_mov_b32 s79, 0x20000
    s_mov_b64 s[68:69], s[56:57]
    s_mov_b32 s70, 0x400000
    s_mov_b32 s71, 0x20000
    s_lshl_b32 s14, s31, 1
    s_add_u32 s14, s14, s15
    s_lshl_b32 s14, s14, 3
    s_add_u32 s14, s14, s3
    s_lshl_b32 s16, s30, 7
    s_add_u32 s14, s14, s16
    s_lshl_b32 s16, s14, 11
    buffer_load_dwordx4 v[216:219], v2, s[76:79], s16 offen offset:0
    buffer_load_dwordx4 v[220:223], v2, s[76:79], s16 offen offset:1024
    s_lshl_b32 s16, s3, 10
    s_add_u32 m0, s16, 81920
    s_add_u32 s16, s16, 0x540800
    buffer_load_dwordx4 v2, s[8:11], s16 offen sc1 lds
    s_lshl_b32 s16, s30, 5
    s_lshl_b32 s17, s31, 1
    s_add_u32 s16, s16, s17
    s_add_u32 s16, s16, s15
    s_lshl_b32 s16, s16, 2
    s_add_u32 s16, s16, 0x530000
    s_cmp_eq_u32 s3, 0
    s_cselect_b32 s16, s16, 0x7ffffff0
    v_mov_b32 v16, s28
    v_mov_b32 v17, 0
    s_lshr_b32 s18, s14, 4
    s_lshl_b32 s18, s18, 15
    s_and_b32 s19, s14, 15
    s_lshl_b32 s19, s19, 6
    s_add_u32 s18, s18, s19
    s_add_u32 s18, s18, 0x2000000
    s_add_u32 s19, s18, 16384
    v_lshrrev_b32 v18, 2, v1
    v_lshlrev_b32 v18, 10, v18
    v_and_b32 v19, 3, v1
    v_lshl_add_u32 v18, v19, 4, v18
    v_add_u32 v19, 0x400000, v18
    s_lshl_b32 s25, s30, 7
    s_add_u32 s25, s25, 0x530000
    v_and_b32 v20, 15, v1
    v_lshlrev_b32 v20, 2, v20
    s_waitcnt vmcnt(3)
    s_waitcnt vmcnt(0)
    s_barrier
    s_mov_b64 exec, 1
    buffer_store_dword v16, v17, s[8:11], s16 offen sc1
    s_mov_b64 exec, -1
    v_add_u32 v16, 81920, v2
    ds_read_b128 v[184:187], v16 offset:0
    ds_read_b128 v[188:191], v16 offset:1024
    ds_read_b128 v[192:195], v16 offset:2048
    ds_read_b128 v[196:199], v16 offset:3072
    ds_read_b128 v[200:203], v16 offset:4096
    ds_read_b128 v[204:207], v16 offset:5120
    ds_read_b128 v[208:211], v16 offset:6144
    ds_read_b128 v[212:215], v16 offset:7168
    v_mov_b32 v94, 0
    v_mov_b32 v95, 0
    s_waitcnt lgkmcnt(5)
    v_lshlrev_b32 v76, 16, v192
    v_and_b32 v77, 0xffff0000, v192
    s_waitcnt lgkmcnt(1)
    v_lshlrev_b32 v78, 16, v208
    v_and_b32 v79, 0xffff0000, v208
    v_pk_mul_f32 v[60:61], v[76:77], v[78:79]
    v_lshlrev_b32 v76, 16, v184
    v_and_b32 v77, 0xffff0000, v184
    v_fmac_f32 v94, v76, v78
    v_fmac_f32 v94, v77, v79
    v_add_f32 v95, v95, v60
    v_add_f32 v95, v95, v61
    v_lshlrev_b32 v76, 16, v193
    v_and_b32 v77, 0xffff0000, v193
    v_lshlrev_b32 v78, 16, v209
    v_and_b32 v79, 0xffff0000, v209
    v_pk_mul_f32 v[62:63], v[76:77], v[78:79]
    v_lshlrev_b32 v76, 16, v185
    v_and_b32 v77, 0xffff0000, v185
    v_fmac_f32 v94, v76, v78
    v_fmac_f32 v94, v77, v79
    v_add_f32 v95, v95, v62
    v_add_f32 v95, v95, v63
    v_lshlrev_b32 v76, 16, v194
    v_and_b32 v77, 0xffff0000, v194
    v_lshlrev_b32 v78, 16, v210
    v_and_b32 v79, 0xffff0000, v210
    v_pk_mul_f32 v[64:65], v[76:77], v[78:79]
    v_lshlrev_b32 v76, 16, v186
    v_and_b32 v77, 0xffff0000, v186
    v_fmac_f32 v94, v76, v78
    v_fmac_f32 v94, v77, v79
    v_add_f32 v95, v95, v64
    v_add_f32 v95, v95, v65
    v_lshlrev_b32 v76, 16, v195
    v_and_b32 v77, 0xffff0000, v195
    v_lshlrev_b32 v78, 16, v211
    v_and_b32 v79, 0xffff0000, v211
    v_pk_mul_f32 v[66:67], v[76:77], v[78:79]
    v_lshlrev_b32 v76, 16, v187
    v_and_b32 v77, 0xffff0000, v187
    v_fmac_f32 v94, v76, v78
    v_fmac_f32 v94, v77, v79
    v_add_f32 v95, v95, v66
    v_add_f32 v95, v95, v67
    v_lshlrev_b32 v76, 16, v196
    v_and_b32 v77, 0xffff0000, v196
    s_waitcnt lgkmcnt(0)
    v_lshlrev_b32 v78, 16, v212
    v_and_b32 v79, 0xffff0000, v212
    v_pk_mul_f32 v[68:69], v[76:77], v[78:79]
    v_lshlrev_b32 v76, 16, v188
    v_and_b32 v77, 0xffff0000, v188
    v_fmac_f32 v94, v76, v78
    v_fmac_f32 v94, v77, v79
    v_add_f32 v95, v95, v68
    v_add_f32 v95, v95, v69
    v_lshlrev_b32 v76, 16, v197
    v_and_b32 v77, 0xffff0000, v197
    v_lshlrev_b32 v78, 16, v213
    v_and_b32 v79, 0xffff0000, v213
    v_pk_mul_f32 v[70:71], v[76:77], v[78:79]
    v_lshlrev_b32 v76, 16, v189
    v_and_b32 v77, 0xffff0000, v189
    v_fmac_f32 v94, v76, v78
    v_fmac_f32 v94, v77, v79
    v_add_f32 v95, v95, v70
    v_add_f32 v95, v95, v71
    v_lshlrev_b32 v76, 16, v198
    v_and_b32 v77, 0xffff0000, v198
    v_lshlrev_b32 v78, 16, v214
    v_and_b32 v79, 0xffff0000, v214
    v_pk_mul_f32 v[72:73], v[76:77], v[78:79]
    v_lshlrev_b32 v76, 16, v190
    v_and_b32 v77, 0xffff0000, v190
    v_fmac_f32 v94, v76, v78
    v_fmac_f32 v94, v77, v79
    v_add_f32 v95, v95, v72
    v_add_f32 v95, v95, v73
    v_lshlrev_b32 v76, 16, v199
    v_and_b32 v77, 0xffff0000, v199
    v_lshlrev_b32 v78, 16, v215
    v_and_b32 v79, 0xffff0000, v215
    v_pk_mul_f32 v[74:75], v[76:77], v[78:79]
    v_lshlrev_b32 v76, 16, v191
    v_and_b32 v77, 0xffff0000, v191
    v_fmac_f32 v94, v76, v78
    v_fmac_f32 v94, v77, v79
    v_add_f32 v95, v95, v74
    v_add_f32 v95, v95, v75
    v_add_f32_dpp v94, v94, v94 row_ror:1 row_mask:0xf bank_mask:0xf
    s_nop 0
    v_add_f32_dpp v95, v95, v95 row_ror:1 row_mask:0xf bank_mask:0xf
    v_add_f32_dpp v94, v94, v94 row_ror:2 row_mask:0xf bank_mask:0xf
    s_nop 0
    v_add_f32_dpp v95, v95, v95 row_ror:2 row_mask:0xf bank_mask:0xf
    v_add_f32_dpp v94, v94, v94 row_ror:4 row_mask:0xf bank_mask:0xf
    s_nop 0
    v_add_f32_dpp v95, v95, v95 row_ror:4 row_mask:0xf bank_mask:0xf
    v_add_f32_dpp v94, v94, v94 row_ror:8 row_mask:0xf bank_mask:0xf
    s_nop 0
    v_add_f32_dpp v95, v95, v95 row_ror:8 row_mask:0xf bank_mask:0xf
    v_mov_b32 v76, v94
    s_nop 1
    v_permlane16_swap_b32 v94, v76
    v_add_f32 v94, v94, v76
    v_mov_b32 v77, v95
    s_nop 1
    v_permlane16_swap_b32 v95, v77
    v_add_f32 v95, v95, v77
    v_mov_b32 v76, v94
    s_nop 1
    v_permlane32_swap_b32 v94, v76
    v_add_f32 v94, v94, v76
    v_mov_b32 v77, v95
    s_nop 1
    v_permlane32_swap_b32 v95, v77
    v_add_f32 v95, v95, v77
    v_lshlrev_b32 v28, 16, v216
    v_and_b32 v29, 0xffff0000, v216
    v_lshlrev_b32 v30, 16, v217
    v_and_b32 v31, 0xffff0000, v217
    v_lshlrev_b32 v32, 16, v218
    v_and_b32 v33, 0xffff0000, v218
    v_lshlrev_b32 v34, 16, v219
    v_and_b32 v35, 0xffff0000, v219
    v_lshlrev_b32 v36, 16, v220
    v_and_b32 v37, 0xffff0000, v220
    v_lshlrev_b32 v38, 16, v221
    v_and_b32 v39, 0xffff0000, v221
    v_lshlrev_b32 v40, 16, v222
    v_and_b32 v41, 0xffff0000, v222
    v_lshlrev_b32 v42, 16, v223
    v_and_b32 v43, 0xffff0000, v223
    s_mov_b32 s27, 0
adaLN_cond__sliding_block_cached__moe_arch_mod__prompt_kernel_a11p:
    buffer_load_dword v76, v20, s[8:11], s25 offen sc1
    s_waitcnt vmcnt(0)
    v_cmp_ne_u32 vcc, s28, v76
    s_add_u32 s27, s27, 1
    s_cmp_ge_u32 s27, 65536
    s_cbranch_scc1 adaLN_cond__sliding_block_cached__moe_arch_mod__prompt_kernel_a11g
    s_cbranch_vccnz adaLN_cond__sliding_block_cached__moe_arch_mod__prompt_kernel_a11p
adaLN_cond__sliding_block_cached__moe_arch_mod__prompt_kernel_a11g:
    buffer_load_dwordx4 v[44:47], v18, s[8:11], s18 offen sc1
    buffer_load_dwordx4 v[52:55], v19, s[8:11], s18 offen sc1
    buffer_load_dwordx4 v[48:51], v18, s[8:11], s19 offen sc1
    buffer_load_dwordx4 v[56:59], v19, s[8:11], s19 offen sc1
    v_lshlrev_b32 v21, 2, v0
    s_mov_b32 s16, 0x540800
    buffer_load_dword v106, v21, s[8:11], s16 offen sc1
    buffer_load_dword v104, v21, s[8:11], s16 offen offset:2048 sc1
    s_waitcnt vmcnt(5)
    v_lshlrev_b32 v76, 16, v44
    v_and_b32 v77, 0xffff0000, v44
    s_waitcnt vmcnt(4)
    v_lshlrev_b32 v78, 16, v52
    v_and_b32 v79, 0xffff0000, v52
    v_pk_add_f32 v[76:77], v[76:77], v[78:79]
    v_pk_add_f32 v[28:29], v[28:29], v[76:77]
    v_cvt_pk_bf16_f32 v16, v28, v29
    v_lshlrev_b32 v28, 16, v16
    v_and_b32 v29, 0xffff0000, v16
    v_lshlrev_b32 v80, 16, v45
    v_and_b32 v81, 0xffff0000, v45
    v_lshlrev_b32 v82, 16, v53
    v_and_b32 v83, 0xffff0000, v53
    v_pk_add_f32 v[80:81], v[80:81], v[82:83]
    v_pk_add_f32 v[30:31], v[30:31], v[80:81]
    v_cvt_pk_bf16_f32 v17, v30, v31
    v_lshlrev_b32 v30, 16, v17
    v_and_b32 v31, 0xffff0000, v17
    v_lshlrev_b32 v76, 16, v46
    v_and_b32 v77, 0xffff0000, v46
    v_lshlrev_b32 v78, 16, v54
    v_and_b32 v79, 0xffff0000, v54
    v_pk_add_f32 v[76:77], v[76:77], v[78:79]
    v_pk_add_f32 v[32:33], v[32:33], v[76:77]
    v_cvt_pk_bf16_f32 v16, v32, v33
    v_lshlrev_b32 v32, 16, v16
    v_and_b32 v33, 0xffff0000, v16
    v_lshlrev_b32 v80, 16, v47
    v_and_b32 v81, 0xffff0000, v47
    v_lshlrev_b32 v82, 16, v55
    v_and_b32 v83, 0xffff0000, v55
    v_pk_add_f32 v[80:81], v[80:81], v[82:83]
    v_pk_add_f32 v[34:35], v[34:35], v[80:81]
    v_cvt_pk_bf16_f32 v17, v34, v35
    v_lshlrev_b32 v34, 16, v17
    v_and_b32 v35, 0xffff0000, v17
    s_waitcnt vmcnt(3)
    v_lshlrev_b32 v76, 16, v48
    v_and_b32 v77, 0xffff0000, v48
    s_waitcnt vmcnt(2)
    v_lshlrev_b32 v78, 16, v56
    v_and_b32 v79, 0xffff0000, v56
    v_pk_add_f32 v[76:77], v[76:77], v[78:79]
    v_pk_add_f32 v[36:37], v[36:37], v[76:77]
    v_cvt_pk_bf16_f32 v16, v36, v37
    v_lshlrev_b32 v36, 16, v16
    v_and_b32 v37, 0xffff0000, v16
    v_lshlrev_b32 v80, 16, v49
    v_and_b32 v81, 0xffff0000, v49
    v_lshlrev_b32 v82, 16, v57
    v_and_b32 v83, 0xffff0000, v57
    v_pk_add_f32 v[80:81], v[80:81], v[82:83]
    v_pk_add_f32 v[38:39], v[38:39], v[80:81]
    v_cvt_pk_bf16_f32 v17, v38, v39
    v_lshlrev_b32 v38, 16, v17
    v_and_b32 v39, 0xffff0000, v17
    v_lshlrev_b32 v76, 16, v50
    v_and_b32 v77, 0xffff0000, v50
    v_lshlrev_b32 v78, 16, v58
    v_and_b32 v79, 0xffff0000, v58
    v_pk_add_f32 v[76:77], v[76:77], v[78:79]
    v_pk_add_f32 v[40:41], v[40:41], v[76:77]
    v_cvt_pk_bf16_f32 v16, v40, v41
    v_lshlrev_b32 v40, 16, v16
    v_and_b32 v41, 0xffff0000, v16
    v_lshlrev_b32 v80, 16, v51
    v_and_b32 v81, 0xffff0000, v51
    v_lshlrev_b32 v82, 16, v59
    v_and_b32 v83, 0xffff0000, v59
    v_pk_add_f32 v[80:81], v[80:81], v[82:83]
    v_pk_add_f32 v[42:43], v[42:43], v[80:81]
    v_cvt_pk_bf16_f32 v17, v42, v43
    v_lshlrev_b32 v42, 16, v17
    v_and_b32 v43, 0xffff0000, v17
    v_pk_add_f32 v[76:77], v[28:29], v[30:31]
    v_pk_mul_f32 v[78:79], v[28:29], v[28:29]
    v_pk_mul_f32 v[80:81], v[28:29], v[60:61]
    v_pk_fma_f32 v[78:79], v[30:31], v[30:31], v[78:79]
    v_pk_fma_f32 v[80:81], v[30:31], v[62:63], v[80:81]
    v_pk_add_f32 v[76:77], v[76:77], v[32:33]
    v_pk_fma_f32 v[78:79], v[32:33], v[32:33], v[78:79]
    v_pk_fma_f32 v[80:81], v[32:33], v[64:65], v[80:81]
    v_pk_add_f32 v[76:77], v[76:77], v[34:35]
    v_pk_fma_f32 v[78:79], v[34:35], v[34:35], v[78:79]
    v_pk_fma_f32 v[80:81], v[34:35], v[66:67], v[80:81]
    v_pk_add_f32 v[76:77], v[76:77], v[36:37]
    v_pk_fma_f32 v[78:79], v[36:37], v[36:37], v[78:79]
    v_pk_fma_f32 v[80:81], v[36:37], v[68:69], v[80:81]
    v_pk_add_f32 v[76:77], v[76:77], v[38:39]
    v_pk_fma_f32 v[78:79], v[38:39], v[38:39], v[78:79]
    v_pk_fma_f32 v[80:81], v[38:39], v[70:71], v[80:81]
    v_pk_add_f32 v[76:77], v[76:77], v[40:41]
    v_pk_fma_f32 v[78:79], v[40:41], v[40:41], v[78:79]
    v_pk_fma_f32 v[80:81], v[40:41], v[72:73], v[80:81]
    v_pk_add_f32 v[76:77], v[76:77], v[42:43]
    v_pk_fma_f32 v[78:79], v[42:43], v[42:43], v[78:79]
    v_pk_fma_f32 v[80:81], v[42:43], v[74:75], v[80:81]
    v_add_f32 v96, v76, v77
    v_add_f32 v97, v78, v79
    v_add_f32 v98, v80, v81
    v_add_f32_dpp v96, v96, v96 row_ror:1 row_mask:0xf bank_mask:0xf
    v_add_f32_dpp v97, v97, v97 row_ror:1 row_mask:0xf bank_mask:0xf
    v_add_f32_dpp v98, v98, v98 row_ror:1 row_mask:0xf bank_mask:0xf
    v_add_f32_dpp v96, v96, v96 row_ror:2 row_mask:0xf bank_mask:0xf
    v_add_f32_dpp v97, v97, v97 row_ror:2 row_mask:0xf bank_mask:0xf
    v_add_f32_dpp v98, v98, v98 row_ror:2 row_mask:0xf bank_mask:0xf
    v_add_f32_dpp v96, v96, v96 row_ror:4 row_mask:0xf bank_mask:0xf
    v_add_f32_dpp v97, v97, v97 row_ror:4 row_mask:0xf bank_mask:0xf
    v_add_f32_dpp v98, v98, v98 row_ror:4 row_mask:0xf bank_mask:0xf
    v_add_f32_dpp v96, v96, v96 row_ror:8 row_mask:0xf bank_mask:0xf
    v_add_f32_dpp v97, v97, v97 row_ror:8 row_mask:0xf bank_mask:0xf
    v_add_f32_dpp v98, v98, v98 row_ror:8 row_mask:0xf bank_mask:0xf
    v_mov_b32 v76, v96
    s_nop 1
    v_permlane16_swap_b32 v96, v76
    v_add_f32 v96, v96, v76
    v_mov_b32 v77, v97
    s_nop 1
    v_permlane16_swap_b32 v97, v77
    v_add_f32 v97, v97, v77
    v_mov_b32 v78, v98
    s_nop 1
    v_permlane16_swap_b32 v98, v78
    v_add_f32 v98, v98, v78
    v_mov_b32 v76, v96
    s_nop 1
    v_permlane32_swap_b32 v96, v76
    v_add_f32 v96, v96, v76
    v_mov_b32 v77, v97
    s_nop 1
    v_permlane32_swap_b32 v97, v77
    v_add_f32 v97, v97, v77
    v_mov_b32 v78, v98
    s_nop 1
    v_permlane32_swap_b32 v98, v78
    v_add_f32 v98, v98, v78
    v_mul_f32 v96, 0x3a800000, v96
    v_mul_f32 v97, 0x3a800000, v97
    v_fma_f32 v97, -v96, v96, v97
    v_max_f32 v97, 0, v97
    v_fma_f32 v98, -v96, v95, v98
    v_add_f32 v76, 0x3727c5ac, v97
    v_rsq_f32 v76, v76
    s_nop 0
    v_fma_f32 v27, v98, v76, v94
    v_cvt_pk_bf16_f32 v96, v96, v96
    v_lshlrev_b32 v96, 16, v96
    v_cvt_pk_bf16_f32 v97, v97, v97
    v_lshlrev_b32 v97, 16, v97
    v_add_f32 v97, 0x3727c5ac, v97
    v_cvt_pk_bf16_f32 v97, v97, v97
    v_lshlrev_b32 v97, 16, v97
    v_sqrt_f32 v98, v97
    s_nop 0
    v_cvt_pk_bf16_f32 v98, v98, v98
    v_lshlrev_b32 v98, 16, v98
    v_rcp_f32 v99, v98
    v_mov_b32 v25, v96
    v_mov_b32 v26, v98
    v_ashrrev_i32 v16, 31, v27
    v_or_b32 v16, 0x80000000, v16
    v_xor_b32 v24, v27, v16
    v_and_b32 v24, 0xfffff800, v24
    v_max_u32 v24, 0x800, v24
    s_sub_u32 s16, 2047, s14
    v_or_b32 v24, s16, v24
    s_lshl_b32 s16, s3, 4
    s_add_u32 s16, s16, 65536
    v_mov_b32 v16, s16
    ds_write_b128 v16, v[24:27]
    s_waitcnt lgkmcnt(0)
    s_barrier
    v_and_b32 v16, 7, v1
    v_lshlrev_b32 v16, 4, v16
    v_add_u32 v16, 65536, v16
    ds_read_b32 v76, v16
    s_waitcnt lgkmcnt(0)
    v_mov_b32 v77, v76
    s_nop 1
    v_max_u32_dpp v77, v77, v77 row_ror:1 row_mask:0xf bank_mask:0xf
    s_nop 1
    v_max_u32_dpp v77, v77, v77 row_ror:2 row_mask:0xf bank_mask:0xf
    s_nop 1
    v_max_u32_dpp v77, v77, v77 row_ror:4 row_mask:0xf bank_mask:0xf
    v_cmp_eq_u32 vcc, v76, v77
    s_ff1_i32_b64 s16, vcc
    s_lshl_b32 s16, s16, 4
    s_add_u32 s16, s16, 65536
    v_mov_b32 v16, s16
    ds_read_b128 v[24:27], v16
    s_lshl_b32 s16, s2, 4
    s_add_u32 s16, s16, 0x6e0000
    s_cmp_eq_u32 s3, 0
    s_cselect_b32 s16, s16, 0x7ffffff0
    v_mov_b32 v17, 0
    s_mov_b64 exec, 1
    s_waitcnt lgkmcnt(0)
    buffer_store_dwordx4 v[24:27], v17, s[8:11], s16 offen sc1
    s_mov_b64 exec, -1
    v_sub_f32 v44, v28, v96
    v_sub_f32 v45, v29, v96
    v_sub_f32 v46, v30, v96
    v_sub_f32 v47, v31, v96
    v_sub_f32 v48, v32, v96
    v_sub_f32 v49, v33, v96
    v_sub_f32 v50, v34, v96
    v_sub_f32 v51, v35, v96
    v_cvt_pk_bf16_f32 v16, v44, v45
    v_lshlrev_b32 v44, 16, v16
    v_and_b32 v45, 0xffff0000, v16
    v_cvt_pk_bf16_f32 v16, v46, v47
    v_lshlrev_b32 v46, 16, v16
    v_and_b32 v47, 0xffff0000, v16
    v_cvt_pk_bf16_f32 v16, v48, v49
    v_lshlrev_b32 v48, 16, v16
    v_and_b32 v49, 0xffff0000, v16
    v_cvt_pk_bf16_f32 v16, v50, v51
    v_lshlrev_b32 v50, 16, v16
    v_and_b32 v51, 0xffff0000, v16
    v_mul_f32 v52, v44, v99
    v_mul_f32 v53, v45, v99
    v_mul_f32 v54, v46, v99
    v_mul_f32 v55, v47, v99
    v_mul_f32 v56, v48, v99
    v_mul_f32 v57, v49, v99
    v_mul_f32 v58, v50, v99
    v_mul_f32 v59, v51, v99
    v_fma_f32 v44, -v52, v98, v44
    v_fma_f32 v45, -v53, v98, v45
    v_fma_f32 v46, -v54, v98, v46
    v_fma_f32 v47, -v55, v98, v47
    v_fma_f32 v48, -v56, v98, v48
    v_fma_f32 v49, -v57, v98, v49
    v_fma_f32 v50, -v58, v98, v50
    v_fma_f32 v51, -v59, v98, v51
    v_fma_f32 v44, v44, v99, v52
    v_fma_f32 v45, v45, v99, v53
    v_fma_f32 v46, v46, v99, v54
    v_fma_f32 v47, v47, v99, v55
    v_fma_f32 v48, v48, v99, v56
    v_fma_f32 v49, v49, v99, v57
    v_fma_f32 v50, v50, v99, v58
    v_fma_f32 v51, v51, v99, v59
    v_cvt_pk_bf16_f32 v16, v44, v45
    v_lshlrev_b32 v44, 16, v16
    v_and_b32 v45, 0xffff0000, v16
    v_cvt_pk_bf16_f32 v16, v46, v47
    v_lshlrev_b32 v46, 16, v16
    v_and_b32 v47, 0xffff0000, v16
    v_cvt_pk_bf16_f32 v16, v48, v49
    v_lshlrev_b32 v48, 16, v16
    v_and_b32 v49, 0xffff0000, v16
    v_cvt_pk_bf16_f32 v16, v50, v51
    v_lshlrev_b32 v50, 16, v16
    v_and_b32 v51, 0xffff0000, v16
    v_lshlrev_b32 v52, 16, v192
    v_and_b32 v53, 0xffff0000, v192
    v_lshlrev_b32 v54, 16, v193
    v_and_b32 v55, 0xffff0000, v193
    v_lshlrev_b32 v56, 16, v194
    v_and_b32 v57, 0xffff0000, v194
    v_lshlrev_b32 v58, 16, v195
    v_and_b32 v59, 0xffff0000, v195
    v_pk_mul_f32 v[44:45], v[44:45], v[52:53]
    v_pk_mul_f32 v[46:47], v[46:47], v[54:55]
    v_pk_mul_f32 v[48:49], v[48:49], v[56:57]
    v_pk_mul_f32 v[50:51], v[50:51], v[58:59]
    v_cvt_pk_bf16_f32 v16, v44, v45
    v_lshlrev_b32 v44, 16, v16
    v_and_b32 v45, 0xffff0000, v16
    v_cvt_pk_bf16_f32 v16, v46, v47
    v_lshlrev_b32 v46, 16, v16
    v_and_b32 v47, 0xffff0000, v16
    v_cvt_pk_bf16_f32 v16, v48, v49
    v_lshlrev_b32 v48, 16, v16
    v_and_b32 v49, 0xffff0000, v16
    v_cvt_pk_bf16_f32 v16, v50, v51
    v_lshlrev_b32 v50, 16, v16
    v_and_b32 v51, 0xffff0000, v16
    v_lshlrev_b32 v52, 16, v184
    v_and_b32 v53, 0xffff0000, v184
    v_lshlrev_b32 v54, 16, v185
    v_and_b32 v55, 0xffff0000, v185
    v_lshlrev_b32 v56, 16, v186
    v_and_b32 v57, 0xffff0000, v186
    v_lshlrev_b32 v58, 16, v187
    v_and_b32 v59, 0xffff0000, v187
    v_pk_add_f32 v[44:45], v[44:45], v[52:53]
    v_pk_add_f32 v[46:47], v[46:47], v[54:55]
    v_pk_add_f32 v[48:49], v[48:49], v[56:57]
    v_pk_add_f32 v[50:51], v[50:51], v[58:59]
    v_cvt_pk_bf16_f32 v16, v44, v45
    v_lshlrev_b32 v44, 16, v16
    v_and_b32 v45, 0xffff0000, v16
    v_cvt_pk_bf16_f32 v16, v46, v47
    v_lshlrev_b32 v46, 16, v16
    v_and_b32 v47, 0xffff0000, v16
    v_cvt_pk_bf16_f32 v16, v48, v49
    v_lshlrev_b32 v48, 16, v16
    v_and_b32 v49, 0xffff0000, v16
    v_cvt_pk_bf16_f32 v16, v50, v51
    v_lshlrev_b32 v50, 16, v16
    v_and_b32 v51, 0xffff0000, v16
    v_lshlrev_b32 v52, 16, v200
    v_and_b32 v53, 0xffff0000, v200
    v_lshlrev_b32 v54, 16, v201
    v_and_b32 v55, 0xffff0000, v201
    v_lshlrev_b32 v56, 16, v202
    v_and_b32 v57, 0xffff0000, v202
    v_lshlrev_b32 v58, 16, v203
    v_and_b32 v59, 0xffff0000, v203
    v_pk_mul_f32 v[44:45], v[44:45], v[52:53]
    v_pk_mul_f32 v[46:47], v[46:47], v[54:55]
    v_pk_mul_f32 v[48:49], v[48:49], v[56:57]
    v_pk_mul_f32 v[50:51], v[50:51], v[58:59]
    v_cvt_pk_bf16_f32 v16, v44, v45
    v_lshlrev_b32 v44, 16, v16
    v_and_b32 v45, 0xffff0000, v16
    v_cvt_pk_bf16_f32 v16, v46, v47
    v_lshlrev_b32 v46, 16, v16
    v_and_b32 v47, 0xffff0000, v16
    v_cvt_pk_bf16_f32 v16, v48, v49
    v_lshlrev_b32 v48, 16, v16
    v_and_b32 v49, 0xffff0000, v16
    v_cvt_pk_bf16_f32 v16, v50, v51
    v_lshlrev_b32 v50, 16, v16
    v_and_b32 v51, 0xffff0000, v16
    v_pk_add_f32 v[44:45], v[44:45], v[28:29]
    v_pk_add_f32 v[46:47], v[46:47], v[30:31]
    v_pk_add_f32 v[48:49], v[48:49], v[32:33]
    v_pk_add_f32 v[50:51], v[50:51], v[34:35]
    v_cvt_pk_bf16_f32 v28, v44, v45
    v_cvt_pk_bf16_f32 v29, v46, v47
    v_cvt_pk_bf16_f32 v30, v48, v49
    v_cvt_pk_bf16_f32 v31, v50, v51
    v_sub_f32 v44, v36, v96
    v_sub_f32 v45, v37, v96
    v_sub_f32 v46, v38, v96
    v_sub_f32 v47, v39, v96
    v_sub_f32 v48, v40, v96
    v_sub_f32 v49, v41, v96
    v_sub_f32 v50, v42, v96
    v_sub_f32 v51, v43, v96
    v_cvt_pk_bf16_f32 v16, v44, v45
    v_lshlrev_b32 v44, 16, v16
    v_and_b32 v45, 0xffff0000, v16
    v_cvt_pk_bf16_f32 v16, v46, v47
    v_lshlrev_b32 v46, 16, v16
    v_and_b32 v47, 0xffff0000, v16
    v_cvt_pk_bf16_f32 v16, v48, v49
    v_lshlrev_b32 v48, 16, v16
    v_and_b32 v49, 0xffff0000, v16
    v_cvt_pk_bf16_f32 v16, v50, v51
    v_lshlrev_b32 v50, 16, v16
    v_and_b32 v51, 0xffff0000, v16
    v_mul_f32 v52, v44, v99
    v_mul_f32 v53, v45, v99
    v_mul_f32 v54, v46, v99
    v_mul_f32 v55, v47, v99
    v_mul_f32 v56, v48, v99
    v_mul_f32 v57, v49, v99
    v_mul_f32 v58, v50, v99
    v_mul_f32 v59, v51, v99
    v_fma_f32 v44, -v52, v98, v44
    v_fma_f32 v45, -v53, v98, v45
    v_fma_f32 v46, -v54, v98, v46
    v_fma_f32 v47, -v55, v98, v47
    v_fma_f32 v48, -v56, v98, v48
    v_fma_f32 v49, -v57, v98, v49
    v_fma_f32 v50, -v58, v98, v50
    v_fma_f32 v51, -v59, v98, v51
    v_fma_f32 v44, v44, v99, v52
    v_fma_f32 v45, v45, v99, v53
    v_fma_f32 v46, v46, v99, v54
    v_fma_f32 v47, v47, v99, v55
    v_fma_f32 v48, v48, v99, v56
    v_fma_f32 v49, v49, v99, v57
    v_fma_f32 v50, v50, v99, v58
    v_fma_f32 v51, v51, v99, v59
    v_cvt_pk_bf16_f32 v16, v44, v45
    v_lshlrev_b32 v44, 16, v16
    v_and_b32 v45, 0xffff0000, v16
    v_cvt_pk_bf16_f32 v16, v46, v47
    v_lshlrev_b32 v46, 16, v16
    v_and_b32 v47, 0xffff0000, v16
    v_cvt_pk_bf16_f32 v16, v48, v49
    v_lshlrev_b32 v48, 16, v16
    v_and_b32 v49, 0xffff0000, v16
    v_cvt_pk_bf16_f32 v16, v50, v51
    v_lshlrev_b32 v50, 16, v16
    v_and_b32 v51, 0xffff0000, v16
    v_lshlrev_b32 v52, 16, v196
    v_and_b32 v53, 0xffff0000, v196
    v_lshlrev_b32 v54, 16, v197
    v_and_b32 v55, 0xffff0000, v197
    v_lshlrev_b32 v56, 16, v198
    v_and_b32 v57, 0xffff0000, v198
    v_lshlrev_b32 v58, 16, v199
    v_and_b32 v59, 0xffff0000, v199
    v_pk_mul_f32 v[44:45], v[44:45], v[52:53]
    v_pk_mul_f32 v[46:47], v[46:47], v[54:55]
    v_pk_mul_f32 v[48:49], v[48:49], v[56:57]
    v_pk_mul_f32 v[50:51], v[50:51], v[58:59]
    v_cvt_pk_bf16_f32 v16, v44, v45
    v_lshlrev_b32 v44, 16, v16
    v_and_b32 v45, 0xffff0000, v16
    v_cvt_pk_bf16_f32 v16, v46, v47
    v_lshlrev_b32 v46, 16, v16
    v_and_b32 v47, 0xffff0000, v16
    v_cvt_pk_bf16_f32 v16, v48, v49
    v_lshlrev_b32 v48, 16, v16
    v_and_b32 v49, 0xffff0000, v16
    v_cvt_pk_bf16_f32 v16, v50, v51
    v_lshlrev_b32 v50, 16, v16
    v_and_b32 v51, 0xffff0000, v16
    v_lshlrev_b32 v52, 16, v188
    v_and_b32 v53, 0xffff0000, v188
    v_lshlrev_b32 v54, 16, v189
    v_and_b32 v55, 0xffff0000, v189
    v_lshlrev_b32 v56, 16, v190
    v_and_b32 v57, 0xffff0000, v190
    v_lshlrev_b32 v58, 16, v191
    v_and_b32 v59, 0xffff0000, v191
    v_pk_add_f32 v[44:45], v[44:45], v[52:53]
    v_pk_add_f32 v[46:47], v[46:47], v[54:55]
    v_pk_add_f32 v[48:49], v[48:49], v[56:57]
    v_pk_add_f32 v[50:51], v[50:51], v[58:59]
    v_cvt_pk_bf16_f32 v16, v44, v45
    v_lshlrev_b32 v44, 16, v16
    v_and_b32 v45, 0xffff0000, v16
    v_cvt_pk_bf16_f32 v16, v46, v47
    v_lshlrev_b32 v46, 16, v16
    v_and_b32 v47, 0xffff0000, v16
    v_cvt_pk_bf16_f32 v16, v48, v49
    v_lshlrev_b32 v48, 16, v16
    v_and_b32 v49, 0xffff0000, v16
    v_cvt_pk_bf16_f32 v16, v50, v51
    v_lshlrev_b32 v50, 16, v16
    v_and_b32 v51, 0xffff0000, v16
    v_lshlrev_b32 v52, 16, v204
    v_and_b32 v53, 0xffff0000, v204
    v_lshlrev_b32 v54, 16, v205
    v_and_b32 v55, 0xffff0000, v205
    v_lshlrev_b32 v56, 16, v206
    v_and_b32 v57, 0xffff0000, v206
    v_lshlrev_b32 v58, 16, v207
    v_and_b32 v59, 0xffff0000, v207
    v_pk_mul_f32 v[44:45], v[44:45], v[52:53]
    v_pk_mul_f32 v[46:47], v[46:47], v[54:55]
    v_pk_mul_f32 v[48:49], v[48:49], v[56:57]
    v_pk_mul_f32 v[50:51], v[50:51], v[58:59]
    v_cvt_pk_bf16_f32 v16, v44, v45
    v_lshlrev_b32 v44, 16, v16
    v_and_b32 v45, 0xffff0000, v16
    v_cvt_pk_bf16_f32 v16, v46, v47
    v_lshlrev_b32 v46, 16, v16
    v_and_b32 v47, 0xffff0000, v16
    v_cvt_pk_bf16_f32 v16, v48, v49
    v_lshlrev_b32 v48, 16, v16
    v_and_b32 v49, 0xffff0000, v16
    v_cvt_pk_bf16_f32 v16, v50, v51
    v_lshlrev_b32 v50, 16, v16
    v_and_b32 v51, 0xffff0000, v16
    v_pk_add_f32 v[44:45], v[44:45], v[36:37]
    v_pk_add_f32 v[46:47], v[46:47], v[38:39]
    v_pk_add_f32 v[48:49], v[48:49], v[40:41]
    v_pk_add_f32 v[50:51], v[50:51], v[42:43]
    v_cvt_pk_bf16_f32 v36, v44, v45
    v_cvt_pk_bf16_f32 v37, v46, v47
    v_cvt_pk_bf16_f32 v38, v48, v49
    v_cvt_pk_bf16_f32 v39, v50, v51
    v_lshlrev_b32 v18, 4, v0
    s_mov_b32 s16, 0x6e0000
    s_mov_b32 s27, 0
adaLN_cond__sliding_block_cached__moe_arch_mod__prompt_kernel_w12p:
    buffer_load_dwordx4 v[24:27], v18, s[8:11], s16 offen sc1
    s_waitcnt vmcnt(0)
    v_cmp_eq_u32 vcc, 0, v24
    s_add_u32 s27, s27, 1
    s_cmp_ge_u32 s27, 65536
    s_cbranch_scc1 adaLN_cond__sliding_block_cached__moe_arch_mod__prompt_kernel_w12g
    s_cbranch_vccnz adaLN_cond__sliding_block_cached__moe_arch_mod__prompt_kernel_w12p
adaLN_cond__sliding_block_cached__moe_arch_mod__prompt_kernel_w12g:
    v_mov_b32 v76, v24
    s_nop 1
    v_max_u32_dpp v76, v76, v76 row_ror:1 row_mask:0xf bank_mask:0xf
    s_nop 1
    v_max_u32_dpp v76, v76, v76 row_ror:2 row_mask:0xf bank_mask:0xf
    s_nop 1
    v_max_u32_dpp v76, v76, v76 row_ror:4 row_mask:0xf bank_mask:0xf
    s_nop 1
    v_max_u32_dpp v76, v76, v76 row_ror:8 row_mask:0xf bank_mask:0xf
    v_mov_b32 v77, v76
    s_nop 1
    v_permlane16_swap_b32 v76, v77
    v_max_u32 v76, v76, v77
    v_mov_b32 v77, v76
    s_nop 1
    v_permlane32_swap_b32 v76, v77
    v_max_u32 v76, v76, v77
    v_cmp_eq_u32 vcc, v76, v24
    s_lshl_b32 s16, s3, 4
    s_add_u32 s16, s16, 65792
    v_mov_b32 v16, s16
    s_and_saveexec_b64 s[62:63], vcc
    ds_write_b128 v16, v[24:27]
    s_mov_b64 exec, s[62:63]
    s_waitcnt lgkmcnt(0)
    s_barrier
    v_and_b32 v16, 3, v1
    v_lshlrev_b32 v16, 4, v16
    v_add_u32 v16, 65792, v16
    ds_read_b32 v76, v16
    s_waitcnt lgkmcnt(0)
    v_mov_b32 v77, v76
    s_nop 1
    v_max_u32_dpp v77, v77, v77 row_ror:1 row_mask:0xf bank_mask:0xf
    s_nop 1
    v_max_u32_dpp v77, v77, v77 row_ror:2 row_mask:0xf bank_mask:0xf
    v_cmp_eq_u32 vcc, v76, v77
    s_ff1_i32_b64 s16, vcc
    s_lshl_b32 s16, s16, 4
    s_add_u32 s16, s16, 65792
    v_mov_b32 v16, s16
    ds_read_b128 v[24:27], v16
    s_waitcnt lgkmcnt(0)
    v_and_b32 v76, 0x7ff, v24
    v_sub_u32 v76, 2047, v76
    s_nop 0
    v_readfirstlane_b32 s12, v76
    v_rcp_f32 v103, v26
    s_lshr_b32 s18, s12, 4
    s_lshl_b32 s18, s18, 15
    s_and_b32 s19, s12, 15
    s_lshl_b32 s19, s19, 6
    s_add_u32 s18, s18, s19
    s_add_u32 s18, s18, 0x2000000
    s_add_u32 s19, s18, 0x400000
    v_lshrrev_b32 v18, 4, v0
    v_lshlrev_b32 v18, 10, v18
    v_and_b32 v19, 15, v0
    v_lshl_add_u32 v18, v19, 2, v18
    s_lshl_b32 s13, s12, 11
    buffer_load_dword v100, v18, s[8:11], s18 offen sc1
    buffer_load_dword v101, v18, s[8:11], s19 offen sc1
    buffer_load_dword v102, v21, s[76:79], s13 offen
    s_lshl_b32 s16, s14, 11
    s_cmp_lg_u32 s12, s14
    s_cselect_b32 s16, s16, 0x7ffffff0
    buffer_store_dwordx4 v[28:31], v2, s[68:71], s16 offen offset:0 sc1
    buffer_store_dwordx4 v[36:39], v2, s[68:71], s16 offen offset:1024 sc1
    s_lshl_b32 s16, s3, 13
    v_add_u32 v20, s16, v2
    s_waitcnt vmcnt(4)
    v_lshlrev_b32 v76, 16, v100
    v_and_b32 v77, 0xffff0000, v100
    s_waitcnt vmcnt(3)
    v_lshlrev_b32 v78, 16, v101
    v_and_b32 v79, 0xffff0000, v101
    v_pk_add_f32 v[76:77], v[76:77], v[78:79]
    s_waitcnt vmcnt(2)
    v_lshlrev_b32 v78, 16, v102
    v_and_b32 v79, 0xffff0000, v102
    v_pk_add_f32 v[92:93], v[78:79], v[76:77]
    v_cvt_pk_bf16_f32 v76, v92, v93
    v_lshlrev_b32 v92, 16, v76
    v_and_b32 v93, 0xffff0000, v76
    v_cvt_pk_bf16_f32 v100, v92, v93
    v_and_b32 v105, 0xffff0000, v104
    v_lshlrev_b32 v104, 16, v104
    v_and_b32 v107, 0xffff0000, v106
    v_lshlrev_b32 v106, 16, v106
    v_sub_f32 v92, v92, v25
    v_sub_f32 v93, v93, v25
    v_cvt_pk_bf16_f32 v76, v92, v93
    v_lshlrev_b32 v92, 16, v76
    v_and_b32 v93, 0xffff0000, v76
    v_mul_f32 v77, v92, v103
    v_fma_f32 v92, -v77, v26, v92
    v_fma_f32 v92, v92, v103, v77
    v_mul_f32 v77, v93, v103
    v_fma_f32 v93, -v77, v26, v93
    v_fma_f32 v93, v93, v103, v77
    v_cvt_pk_bf16_f32 v76, v92, v93
    v_lshlrev_b32 v92, 16, v76
    v_and_b32 v93, 0xffff0000, v76
    v_mul_f32 v92, v92, v104
    v_mul_f32 v93, v93, v105
    v_cvt_pk_bf16_f32 v76, v92, v93
    v_lshlrev_b32 v92, 16, v76
    v_and_b32 v93, 0xffff0000, v76
    v_add_f32 v92, v92, v106
    v_add_f32 v93, v93, v107
    v_cvt_pk_bf16_f32 v101, v92, v93
    v_add_u32 v16, 66560, v21
    ds_write_b32 v16, v101
    ds_write_b32 v16, v100 offset:2048
    s_waitcnt lgkmcnt(0)
    s_barrier
    ds_read_b128 v[60:63], v20 offset:0
    ds_read_b128 v[64:67], v20 offset:1024
    ds_read_b128 v[68:71], v20 offset:2048
    ds_read_b128 v[72:75], v20 offset:3072
    ds_read_b128 v[108:111], v20 offset:4096
    ds_read_b128 v[112:115], v20 offset:5120
    ds_read_b128 v[116:119], v20 offset:6144
    ds_read_b128 v[120:123], v20 offset:7168
    s_and_b32 s16, s3, 3
    s_lshl_b32 s16, s16, 7
    s_and_b32 s17, s29, 3
    s_lshl_b32 s17, s17, 9
    s_add_u32 s16, s16, s17
    s_add_u32 s16, s16, 66560
    v_lshrrev_b32 v16, 3, v1
    v_lshlrev_b32 v16, 4, v16
    v_add_u32 v16, s16, v16
    ds_read_b128 v[104:107], v16
    s_waitcnt lgkmcnt(0)
    v_lshlrev_b32 v76, 16, v104
    v_and_b32 v77, 0xffff, v104
    v_dot2_f32_bf16 v85, v60, v76, 0
    v_dot2_f32_bf16 v84, v60, v77, 0
    v_dot2_f32_bf16 v87, v61, v76, 0
    v_dot2_f32_bf16 v86, v61, v77, 0
    v_dot2_f32_bf16 v89, v62, v76, 0
    v_dot2_f32_bf16 v88, v62, v77, 0
    v_dot2_f32_bf16 v91, v63, v76, 0
    v_dot2_f32_bf16 v90, v63, v77, 0
    v_and_b32 v78, 0xffff0000, v104
    v_lshrrev_b32 v79, 16, v104
    v_dot2c_f32_bf16 v85, v64, v78
    v_dot2c_f32_bf16 v84, v64, v79
    v_dot2c_f32_bf16 v87, v65, v78
    v_dot2c_f32_bf16 v86, v65, v79
    v_dot2c_f32_bf16 v89, v66, v78
    v_dot2c_f32_bf16 v88, v66, v79
    v_dot2c_f32_bf16 v91, v67, v78
    v_dot2c_f32_bf16 v90, v67, v79
    v_lshlrev_b32 v80, 16, v105
    v_and_b32 v81, 0xffff, v105
    v_dot2c_f32_bf16 v85, v68, v80
    v_dot2c_f32_bf16 v84, v68, v81
    v_dot2c_f32_bf16 v87, v69, v80
    v_dot2c_f32_bf16 v86, v69, v81
    v_dot2c_f32_bf16 v89, v70, v80
    v_dot2c_f32_bf16 v88, v70, v81
    v_dot2c_f32_bf16 v91, v71, v80
    v_dot2c_f32_bf16 v90, v71, v81
    v_and_b32 v82, 0xffff0000, v105
    v_lshrrev_b32 v83, 16, v105
    v_dot2c_f32_bf16 v85, v72, v82
    v_dot2c_f32_bf16 v84, v72, v83
    v_dot2c_f32_bf16 v87, v73, v82
    v_dot2c_f32_bf16 v86, v73, v83
    v_dot2c_f32_bf16 v89, v74, v82
    v_dot2c_f32_bf16 v88, v74, v83
    v_dot2c_f32_bf16 v91, v75, v82
    v_dot2c_f32_bf16 v90, v75, v83
    v_lshlrev_b32 v76, 16, v106
    v_and_b32 v77, 0xffff, v106
    v_dot2c_f32_bf16 v85, v108, v76
    v_dot2c_f32_bf16 v84, v108, v77
    v_dot2c_f32_bf16 v87, v109, v76
    v_dot2c_f32_bf16 v86, v109, v77
    v_dot2c_f32_bf16 v89, v110, v76
    v_dot2c_f32_bf16 v88, v110, v77
    v_dot2c_f32_bf16 v91, v111, v76
    v_dot2c_f32_bf16 v90, v111, v77
    v_and_b32 v78, 0xffff0000, v106
    v_lshrrev_b32 v79, 16, v106
    v_dot2c_f32_bf16 v85, v112, v78
    v_dot2c_f32_bf16 v84, v112, v79
    v_dot2c_f32_bf16 v87, v113, v78
    v_dot2c_f32_bf16 v86, v113, v79
    v_dot2c_f32_bf16 v89, v114, v78
    v_dot2c_f32_bf16 v88, v114, v79
    v_dot2c_f32_bf16 v91, v115, v78
    v_dot2c_f32_bf16 v90, v115, v79
    v_lshlrev_b32 v80, 16, v107
    v_and_b32 v81, 0xffff, v107
    v_dot2c_f32_bf16 v85, v116, v80
    v_dot2c_f32_bf16 v84, v116, v81
    v_dot2c_f32_bf16 v87, v117, v80
    v_dot2c_f32_bf16 v86, v117, v81
    v_dot2c_f32_bf16 v89, v118, v80
    v_dot2c_f32_bf16 v88, v118, v81
    v_dot2c_f32_bf16 v91, v119, v80
    v_dot2c_f32_bf16 v90, v119, v81
    v_and_b32 v82, 0xffff0000, v107
    v_lshrrev_b32 v83, 16, v107
    v_dot2c_f32_bf16 v85, v120, v82
    v_dot2c_f32_bf16 v84, v120, v83
    v_dot2c_f32_bf16 v87, v121, v82
    v_dot2c_f32_bf16 v86, v121, v83
    v_dot2c_f32_bf16 v89, v122, v82
    v_dot2c_f32_bf16 v88, v122, v83
    v_dot2c_f32_bf16 v91, v123, v82
    v_dot2c_f32_bf16 v90, v123, v83
    s_nop 0
    v_permlane32_swap_b32 v84, v88
    v_permlane32_swap_b32 v85, v89
    v_permlane32_swap_b32 v86, v90
    v_permlane32_swap_b32 v87, v91
    v_add_f32 v84, v84, v88
    v_add_f32 v85, v85, v89
    v_add_f32 v86, v86, v90
    v_add_f32 v87, v87, v91
    s_nop 0
    v_permlane16_swap_b32 v84, v86
    v_permlane16_swap_b32 v85, v87
    v_add_f32 v84, v84, v86
    v_add_f32 v85, v85, v87
    s_nop 0
    v_add_f32_dpp v84, v84, v84 row_ror:8 row_mask:0xf bank_mask:0xf
    v_add_f32_dpp v85, v85, v85 row_ror:8 row_mask:0xf bank_mask:0xf
    v_and_b32 v16, 7, v1
    v_lshlrev_b32 v16, 5, v16
    v_lshrrev_b32 v17, 4, v1
    v_lshl_add_u32 v16, v17, 3, v16
    s_lshl_b32 s16, s3, 8
    s_add_u32 s16, s16, 70656
    v_add_u32 v16, s16, v16
    ds_write_b64 v16, v[84:85]
    s_lshr_b32 s16, s3, 2
    s_lshl_b32 s17, s16, 10
    s_add_u32 s17, s17, 70656
    v_lshlrev_b32 v17, 2, v1
    v_add_u32 v16, s17, v17
    s_and_b32 s17, s29, 3
    s_lshl_b32 s17, s17, 1
    s_add_u32 s17, s17, s16
    s_mul_i32 s17, s17, 14336
    s_lshr_b32 s16, s29, 2
    s_lshl_b32 s16, s16, 8
    s_add_u32 s17, s17, s16
    s_add_u32 s17, s17, 0x6e1000
    s_and_b32 s16, s3, 3
    s_cmp_eq_u32 s16, 0
    s_cselect_b32 s17, s17, 0x7ffffff0
    s_cmp_lt_u32 s2, 224
    s_cselect_b32 s17, s17, 0x7ffffff0
    s_waitcnt lgkmcnt(0)
    s_barrier
    ds_read_b32 v84, v16 offset:0
    ds_read_b32 v85, v16 offset:256
    ds_read_b32 v86, v16 offset:512
    ds_read_b32 v87, v16 offset:768
    s_waitcnt lgkmcnt(2)
    v_add_f32 v84, v84, v85
    s_waitcnt lgkmcnt(0)
    v_add_f32 v86, v86, v87
    v_add_f32 v84, v84, v86
    v_or_b32 v84, 1, v84
    buffer_store_dword v84, v17, s[8:11], s17 offen sc1
    s_barrier
    v_lshlrev_b32 v16, 3, v0
    v_add_u32 v17, 73728, v16
    ds_read_b64 v[84:85], v17 offset:0
    ds_read_b64 v[86:87], v17 offset:4096
    ds_read_b64 v[88:89], v17 offset:8192
    ds_read_b64 v[90:91], v17 offset:12288
    s_waitcnt lgkmcnt(2)
    v_pk_add_f32 v[84:85], v[84:85], v[86:87]
    s_waitcnt lgkmcnt(0)
    v_pk_add_f32 v[88:89], v[88:89], v[90:91]
    v_pk_add_f32 v[84:85], v[84:85], v[88:89]
    v_or_b32 v84, 1, v84
    v_or_b32 v85, 1, v85
    s_lshl_b32 s16, s29, 12
    s_add_u32 s16, s16, 0x600000
    s_cmp_lt_u32 s2, 224
    s_cselect_b32 s16, s16, 0x7ffffff0
    buffer_store_dwordx2 v[84:85], v16, s[8:11], s16 offen sc1
    s_cmp_lt_u32 s2, 224
    s_cbranch_scc1 adaLN_cond__sliding_block_cached__moe_arch_mod__prompt_kernel_end
    s_sub_u32 s16, s2, 224
    s_lshl_b32 s17, s16, 7
    s_add_u32 s17, s17, 0x600000
    v_lshrrev_b32 v16, 3, v0
    v_lshlrev_b32 v16, 12, v16
    v_and_b32 v17, 7, v0
    v_lshl_add_u32 v16, v17, 4, v16
    v_cmp_gt_u32 vcc, 256, v0
    v_bfrev_b32 v17, -2
    s_nop 0
    v_cndmask_b32 v17, v17, v16, vcc
    v_mov_b32 v19, 0
    v_cndmask_b32 v18, 1, v19, vcc
    s_lshl_b32 s18, s16, 6
    v_and_b32 v19, 31, v1
    v_lshlrev_b32 v19, 1, v19
    v_add_u32 v19, s18, v19
    s_mov_b32 s19, 0x541800
    buffer_load_ushort v95, v19, s[8:11], s19 offen sc1
    v_add_u32 v20, 66560, v19
    ds_read_u16 v96, v20
    ds_read_u16 v97, v20 offset:2048
    v_mov_b32 v94, v27
    v_cvt_pk_bf16_f32 v94, v94, v94
    v_lshlrev_b32 v94, 16, v94
    v_mul_f32 v94, 0xbfb8aa3b, v94
    v_exp_f32 v94, v94
    s_nop 0
    v_add_f32 v94, 1.0, v94
    v_rcp_f32 v94, v94
    s_nop 0
    v_cvt_pk_bf16_f32 v94, v94, v94
    v_lshlrev_b32 v94, 16, v94
    s_waitcnt vmcnt(0)
    v_lshlrev_b32 v95, 16, v95
    s_waitcnt lgkmcnt(1)
    v_lshlrev_b32 v96, 16, v96
    s_waitcnt lgkmcnt(0)
    v_lshlrev_b32 v97, 16, v97
    s_mov_b32 s27, 0
adaLN_cond__sliding_block_cached__moe_arch_mod__prompt_kernel_y13p:
    s_add_u32 s19, s17, 0x0
    buffer_load_dwordx4 v[44:47], v16, s[8:11], s19 offen sc1
    s_add_u32 s19, s17, 0x40000
    buffer_load_dwordx4 v[48:51], v16, s[8:11], s19 offen sc1
    s_add_u32 s19, s17, 0x80000
    buffer_load_dwordx4 v[52:55], v16, s[8:11], s19 offen sc1
    s_add_u32 s19, s17, 0xc0000
    buffer_load_dwordx4 v[56:59], v17, s[8:11], s19 offen sc1
    s_waitcnt vmcnt(0)
    v_min3_u32 v98, v56, v57, v58
    v_min_u32 v98, v98, v59
    v_or_b32 v98, v98, v18
    v_min3_u32 v98, v98, v44, v45
    v_min3_u32 v98, v98, v46, v47
    v_min3_u32 v98, v98, v48, v49
    v_min3_u32 v98, v98, v50, v51
    v_min3_u32 v98, v98, v52, v53
    v_min3_u32 v98, v98, v54, v55
    v_cmp_eq_u32 vcc, 0, v98
    s_add_u32 s27, s27, 1
    s_cmp_ge_u32 s27, 65536
    s_cbranch_scc1 adaLN_cond__sliding_block_cached__moe_arch_mod__prompt_kernel_y13g
    s_cbranch_vccnz adaLN_cond__sliding_block_cached__moe_arch_mod__prompt_kernel_y13p
adaLN_cond__sliding_block_cached__moe_arch_mod__prompt_kernel_y13g:
    v_pk_add_f32 v[44:45], v[44:45], v[52:53]
    v_pk_add_f32 v[46:47], v[46:47], v[54:55]
    v_pk_add_f32 v[48:49], v[48:49], v[56:57]
    v_pk_add_f32 v[50:51], v[50:51], v[58:59]
    v_pk_add_f32 v[44:45], v[44:45], v[48:49]
    v_pk_add_f32 v[46:47], v[46:47], v[50:51]
    s_nop 0
    v_add_f32_dpp v44, v44, v44 row_ror:8 row_mask:0xf bank_mask:0xf
    v_add_f32_dpp v45, v45, v45 row_ror:8 row_mask:0xf bank_mask:0xf
    v_add_f32_dpp v46, v46, v46 row_ror:8 row_mask:0xf bank_mask:0xf
    v_add_f32_dpp v47, v47, v47 row_ror:8 row_mask:0xf bank_mask:0xf
    s_nop 0
    v_permlane32_swap_b32 v44, v46
    v_permlane32_swap_b32 v45, v47
    v_add_f32 v44, v44, v46
    v_add_f32 v45, v45, v47
    s_nop 1
    v_permlane16_swap_b32 v44, v45
    v_add_f32 v44, v44, v45
    v_and_b32 v16, 7, v1
    v_lshlrev_b32 v16, 4, v16
    v_lshrrev_b32 v17, 4, v1
    v_lshl_add_u32 v16, v17, 2, v16
    s_lshl_b32 s19, s3, 7
    s_add_u32 s19, s19, 91136
    v_add_u32 v16, s19, v16
    ds_write_b32 v16, v44
    v_and_b32 v16, 31, v1
    v_lshlrev_b32 v16, 2, v16
    v_add_u32 v16, 91136, v16
    s_waitcnt lgkmcnt(0)
    s_barrier
    s_cmp_lg_u32 s3, 0
    s_cbranch_scc1 adaLN_cond__sliding_block_cached__moe_arch_mod__prompt_kernel_end
    ds_read_b32 v44, v16 offset:0
    ds_read_b32 v45, v16 offset:128
    ds_read_b32 v46, v16 offset:256
    ds_read_b32 v47, v16 offset:384
    ds_read_b32 v48, v16 offset:512
    ds_read_b32 v49, v16 offset:640
    ds_read_b32 v50, v16 offset:768
    ds_read_b32 v51, v16 offset:896
    s_waitcnt lgkmcnt(3)
    v_add_f32 v44, v44, v48
    s_waitcnt lgkmcnt(2)
    v_add_f32 v45, v45, v49
    s_waitcnt lgkmcnt(1)
    v_add_f32 v46, v46, v50
    s_waitcnt lgkmcnt(0)
    v_add_f32 v47, v47, v51
    v_add_f32 v44, v44, v46
    v_add_f32 v45, v45, v47
    v_add_f32 v44, v44, v45
    v_cvt_pk_bf16_f32 v44, v44, v44
    v_lshlrev_b32 v44, 16, v44
    v_mul_f32 v44, v44, v94
    v_cvt_pk_bf16_f32 v44, v44, v44
    v_lshlrev_b32 v44, 16, v44
    v_add_f32 v44, v44, v96
    v_cvt_pk_bf16_f32 v44, v44, v44
    v_lshlrev_b32 v44, 16, v44
    v_mul_f32 v44, v44, v95
    v_cvt_pk_bf16_f32 v44, v44, v44
    v_lshlrev_b32 v44, 16, v44
    v_add_f32 v44, v44, v97
    v_cvt_pk_bf16_f32 v44, v44, v44
    s_mov_b64 exec, 0xffffffff
    buffer_store_short v44, v19, s[68:71], s13 offen sc1
    s_branch adaLN_cond__sliding_block_cached__moe_arch_mod__prompt_kernel_end
adaLN_cond__sliding_block_cached__moe_arch_mod__prompt_kernel_roleB:
    v_mov_b32 v132, 0
    v_mov_b32 v133, 0
    v_lshrrev_b32 v16, 3, v0
    v_and_b32 v17, 7, v0
    v_mul_u32_u24 v135, 24576, v16
    v_lshl_add_u32 v135, v17, 4, v135
    v_lshlrev_b32 v136, 2, v16
    s_and_b32 s14, s2, 31
    s_lshr_b32 s15, s2, 5
    s_mul_i32 s26, s15, 1572864
    s_lshl_b32 s16, s14, 7
    s_add_u32 s26, s26, s16
    s_lshl_b32 s29, s15, 8
    v_lshlrev_b32 v137, 3, v0
    s_lshl_b32 s18, s2, 3
    s_add_u32 s18, s18, s3
    s_lshl_b32 s18, s18, 11
    v_and_b32 v18, 15, v1
    v_lshrrev_b32 v19, 4, v1
    v_lshlrev_b32 v138, 11, v18
    v_lshl_add_u32 v138, v19, 4, v138
    s_lshr_b32 s30, s2, 4
    s_and_b32 s31, s2, 15
    s_lshl_b32 s19, s30, 3
    s_add_u32 s19, s19, s3
    s_lshl_b32 s22, s19, 15
    s_lshl_b32 s23, s31, 7
    s_add_u32 s22, s22, s23
    s_lshl_b32 s23, s2, 12
    s_add_u32 s23, s23, 0x600000
    s_or_b32 s25, s2, s3
    s_cmp_eq_u32 s25, 0
    s_cselect_b32 s25, 0, 0x7ffffff0
    s_waitcnt lgkmcnt(0)
    s_mov_b64 s[64:65], s[58:59]
    s_mov_b32 s66, 0x100
    s_mov_b32 s67, 0x20000
    s_or_b32 s28, s62, 1
    v_mov_b32 v134, s28
    s_mov_b64 exec, 1
    buffer_store_dword v134, v132, s[64:67], s25 offen sc1
    s_mov_b64 exec, -1
    s_mov_b64 s[68:69], s[52:53]
    s_mov_b32 s70, 0x800
    s_mov_b32 s71, 0x20000
    s_mov_b64 s[72:73], s[54:55]
    s_mov_b32 s74, 0xc00000
    s_mov_b32 s75, 0x20000
    s_mov_b64 s[76:77], s[32:33]
    s_mov_b32 s78, 0x400000
    s_mov_b32 s79, 0x20000
    s_mov_b64 s[8:9], s[60:61]
    s_mov_b32 s10, 0x3400000
    s_mov_b32 s11, 0x20000
    buffer_load_dwordx4 v[32:35], v2, s[76:79], s18 offen offset:0
    buffer_load_dwordx4 v[36:39], v2, s[76:79], s18 offen offset:1024
    buffer_load_dword v72, v136, s[68:71], s29 offen
    buffer_load_dwordx4 v[24:27], v135, s[72:75], s26 offen
    s_add_u32 s26, s26, 12288
    buffer_load_dwordx4 v[28:31], v135, s[72:75], s26 offen
    buffer_store_dwordx2 v[132:133], v137, s[8:11], s23 offen sc1
    s_barrier
    buffer_load_dwordx4 v[40:43], v138, s[76:79], s22 offen offset:0
    buffer_load_dwordx4 v[44:47], v138, s[76:79], s22 offen offset:64
    s_mov_b32 s29, s19
    s_mov_b64 s[64:65], s[34:35]
    s_mov_b32 s66, 0x200000
    s_mov_b32 s67, 0x20000
    s_mov_b64 s[68:69], s[36:37]
    s_mov_b32 s70, 0x200000
    s_mov_b32 s71, 0x20000
    s_lshl_b32 s20, s2, 2
    s_add_u32 s20, s20, s3
    s_sub_u32 s20, s20, 4
    s_lshr_b32 s22, s20, 8
    s_bfe_u32 s23, s20, 0x40004
    s_and_b32 s24, s20, 15
    s_lshl_b32 s25, s22, 19
    s_lshl_b32 s26, s23, 13
    s_add_u32 s25, s25, s26
    s_add_u32 s25, s25, 393216
    v_and_b32 v16, 15, v1
    v_lshrrev_b32 v17, 4, v1
    s_lshl_b32 s21, s22, 17
    s_cmp_ge_u32 s24, 8
    s_cbranch_scc1 adaLN_cond__sliding_block_cached__moe_arch_mod__prompt_kernel_kvV
    v_lshlrev_b32 v18, 8, v16
    v_lshl_add_u32 v18, v17, 3, v18
    s_and_b32 s26, s24, 1
    s_lshl_b32 s26, s26, 12
    s_add_u32 s25, s25, s26
    s_lshr_b32 s26, s24, 1
    s_lshl_b32 s26, s26, 6
    s_add_u32 s25, s25, s26
    buffer_load_dwordx2 v[84:85], v18, s[64:67], s25 offen
    buffer_load_dwordx2 v[86:87], v18, s[64:67], s25 offen offset:32
    s_mov_b32 s26, 0x7ffffff0
    buffer_load_ushort v88, v18, s[64:67], s26 offen
    buffer_load_ushort v89, v18, s[64:67], s26 offen
    buffer_load_ushort v90, v18, s[64:67], s26 offen
    buffer_load_ushort v91, v18, s[64:67], s26 offen
    buffer_load_ushort v92, v18, s[64:67], s26 offen
    buffer_load_ushort v93, v18, s[64:67], s26 offen
    s_lshl_b32 s26, s23, 13
    s_add_u32 s21, s21, s26
    s_lshl_b32 s26, s24, 10
    s_add_u32 s21, s21, s26
    s_add_u32 s21, s21, 0x400000
    s_branch adaLN_cond__sliding_block_cached__moe_arch_mod__prompt_kernel_kvJ
adaLN_cond__sliding_block_cached__moe_arch_mod__prompt_kernel_kvV:
    s_bfe_u32 s26, s24, 0x20001
    s_lshl_b32 s26, s26, 6
    s_add_u32 s25, s25, s26
    s_and_b32 s26, s24, 1
    s_lshl_b32 s26, s26, 3
    s_add_u32 s25, s25, s26
    s_add_u32 s26, s25, 4096
    v_lshrrev_b32 v18, 2, v16
    v_lshlrev_b32 v18, 4, v18
    v_and_b32 v19, 3, v16
    v_lshl_add_u32 v18, v19, 1, v18
    v_lshl_add_u32 v18, v17, 10, v18
    buffer_load_ushort v88, v18, s[68:71], s25 offen offset:0
    buffer_load_ushort v89, v18, s[68:71], s25 offen offset:256
    buffer_load_ushort v90, v18, s[68:71], s25 offen offset:512
    buffer_load_ushort v91, v18, s[68:71], s25 offen offset:768
    buffer_load_ushort v92, v18, s[68:71], s26 offen offset:0
    buffer_load_ushort v93, v18, s[68:71], s26 offen offset:256
    buffer_load_ushort v94, v18, s[68:71], s26 offen offset:512
    buffer_load_ushort v95, v18, s[68:71], s26 offen offset:768
    s_bfe_u32 s26, s24, 0x20001
    s_lshl_b32 s26, s26, 15
    s_add_u32 s21, s21, s26
    s_lshl_b32 s26, s23, 11
    s_add_u32 s21, s21, s26
    s_and_b32 s26, s24, 1
    s_lshl_b32 s26, s26, 10
    s_add_u32 s21, s21, s26
    s_add_u32 s21, s21, 0x480000
adaLN_cond__sliding_block_cached__moe_arch_mod__prompt_kernel_kvJ:
    s_waitcnt vmcnt(15)
    v_lshlrev_b32 v56, 16, v32
    v_and_b32 v57, 0xffff0000, v32
    v_lshlrev_b32 v58, 16, v33
    v_and_b32 v59, 0xffff0000, v33
    v_lshlrev_b32 v60, 16, v34
    v_and_b32 v61, 0xffff0000, v34
    v_lshlrev_b32 v62, 16, v35
    v_and_b32 v63, 0xffff0000, v35
    s_waitcnt vmcnt(14)
    v_lshlrev_b32 v64, 16, v36
    v_and_b32 v65, 0xffff0000, v36
    v_lshlrev_b32 v66, 16, v37
    v_and_b32 v67, 0xffff0000, v37
    v_lshlrev_b32 v68, 16, v38
    v_and_b32 v69, 0xffff0000, v38
    v_lshlrev_b32 v70, 16, v39
    v_and_b32 v71, 0xffff0000, v39
    v_add_f32 v20, v56, v57
    v_add_f32 v21, v58, v59
    v_add_f32 v20, v20, v60
    v_add_f32 v21, v21, v61
    v_add_f32 v20, v20, v62
    v_add_f32 v21, v21, v63
    v_add_f32 v20, v20, v64
    v_add_f32 v21, v21, v65
    v_add_f32 v20, v20, v66
    v_add_f32 v21, v21, v67
    v_add_f32 v20, v20, v68
    v_add_f32 v21, v21, v69
    v_add_f32 v20, v20, v70
    v_add_f32 v21, v21, v71
    v_add_f32 v128, v20, v21
    s_nop 1
    v_add_f32_dpp v128, v128, v128 row_ror:1 row_mask:0xf bank_mask:0xf
    s_nop 1
    v_add_f32_dpp v128, v128, v128 row_ror:2 row_mask:0xf bank_mask:0xf
    s_nop 1
    v_add_f32_dpp v128, v128, v128 row_ror:4 row_mask:0xf bank_mask:0xf
    s_nop 1
    v_add_f32_dpp v128, v128, v128 row_ror:8 row_mask:0xf bank_mask:0xf
    v_mov_b32 v20, v128
    s_nop 1
    v_permlane16_swap_b32 v128, v20
    v_add_f32 v128, v128, v20
    v_mov_b32 v20, v128
    s_nop 1
    v_permlane32_swap_b32 v128, v20
    v_add_f32 v128, v128, v20
    v_mul_f32 v128, 0x3a800000, v128
    v_sub_f32 v18, v56, v128
    v_mul_f32 v20, v18, v18
    v_sub_f32 v19, v57, v128
    v_mul_f32 v21, v19, v19
    v_sub_f32 v18, v58, v128
    v_sub_f32 v19, v59, v128
    v_fmac_f32 v20, v18, v18
    v_fmac_f32 v21, v19, v19
    v_sub_f32 v18, v60, v128
    v_sub_f32 v19, v61, v128
    v_fmac_f32 v20, v18, v18
    v_fmac_f32 v21, v19, v19
    v_sub_f32 v18, v62, v128
    v_sub_f32 v19, v63, v128
    v_fmac_f32 v20, v18, v18
    v_fmac_f32 v21, v19, v19
    v_sub_f32 v18, v64, v128
    v_sub_f32 v19, v65, v128
    v_fmac_f32 v20, v18, v18
    v_fmac_f32 v21, v19, v19
    v_sub_f32 v18, v66, v128
    v_sub_f32 v19, v67, v128
    v_fmac_f32 v20, v18, v18
    v_fmac_f32 v21, v19, v19
    v_sub_f32 v18, v68, v128
    v_sub_f32 v19, v69, v128
    v_fmac_f32 v20, v18, v18
    v_fmac_f32 v21, v19, v19
    v_sub_f32 v18, v70, v128
    v_sub_f32 v19, v71, v128
    v_fmac_f32 v20, v18, v18
    v_fmac_f32 v21, v19, v19
    v_add_f32 v17, v20, v21
    s_nop 1
    v_add_f32_dpp v17, v17, v17 row_ror:1 row_mask:0xf bank_mask:0xf
    s_nop 1
    v_add_f32_dpp v17, v17, v17 row_ror:2 row_mask:0xf bank_mask:0xf
    s_nop 1
    v_add_f32_dpp v17, v17, v17 row_ror:4 row_mask:0xf bank_mask:0xf
    s_nop 1
    v_add_f32_dpp v17, v17, v17 row_ror:8 row_mask:0xf bank_mask:0xf
    v_mov_b32 v20, v17
    s_nop 1
    v_permlane16_swap_b32 v17, v20
    v_add_f32 v17, v17, v20
    v_mov_b32 v20, v17
    s_nop 1
    v_permlane32_swap_b32 v17, v20
    v_add_f32 v17, v17, v20
    v_mul_f32 v17, 0x3a800000, v17
    v_cvt_pk_bf16_f32 v128, v128, v128
    v_lshlrev_b32 v128, 16, v128
    v_cvt_pk_bf16_f32 v17, v17, v17
    v_lshlrev_b32 v17, 16, v17
    v_add_f32 v17, 0x3727c5ac, v17
    v_cvt_pk_bf16_f32 v17, v17, v17
    v_lshlrev_b32 v17, 16, v17
    v_sqrt_f32 v129, v17
    s_nop 0
    v_cvt_pk_bf16_f32 v129, v129, v129
    v_lshlrev_b32 v129, 16, v129
    v_rcp_f32 v130, v129
    s_lshl_b32 s16, s3, 4
    s_add_u32 s16, s16, 149520
    v_mov_b32 v19, s16
    ds_write_b128 v19, v[128:131]
    s_waitcnt vmcnt(13)
    v_and_b32 v73, 0xffff0000, v72
    v_lshlrev_b32 v72, 16, v72
    v_mul_f32 v16, 0xbfb8aa3b, v72
    v_exp_f32 v16, v16
    s_nop 0
    v_add_f32 v16, 1.0, v16
    v_rcp_f32 v16, v16
    s_nop 0
    v_mul_f32 v72, v72, v16
    v_mul_f32 v17, 0xbfb8aa3b, v73
    v_exp_f32 v17, v17
    s_nop 0
    v_add_f32 v17, 1.0, v17
    v_rcp_f32 v17, v17
    s_nop 0
    v_mul_f32 v73, v73, v17
    v_cvt_pk_bf16_f32 v16, v72, v73
    v_lshlrev_b32 v72, 16, v16
    v_and_b32 v73, 0xffff0000, v16
    s_lshl_b32 s16, s2, 8
    s_add_u32 s16, s16, 0x550000
    s_mov_b32 exec_lo, 0x01010101
    s_mov_b32 exec_hi, 0x01010101
    buffer_store_dword v16, v136, s[8:11], s16 offen sc1
    s_mov_b64 exec, -1
    v_lshrrev_b32 v74, 16, v72
    v_lshrrev_b32 v75, 16, v73
    s_waitcnt vmcnt(13)
    v_dot2_f32_bf16 v49, v24, v72, 0
    v_dot2_f32_bf16 v48, v24, v74, 0
    v_dot2_f32_bf16 v51, v25, v72, 0
    v_dot2_f32_bf16 v50, v25, v74, 0
    v_dot2_f32_bf16 v53, v26, v72, 0
    v_dot2_f32_bf16 v52, v26, v74, 0
    v_dot2_f32_bf16 v55, v27, v72, 0
    v_dot2_f32_bf16 v54, v27, v74, 0
    s_waitcnt vmcnt(12)
    v_dot2c_f32_bf16 v49, v28, v73
    v_dot2c_f32_bf16 v48, v28, v75
    v_dot2c_f32_bf16 v51, v29, v73
    v_dot2c_f32_bf16 v50, v29, v75
    v_dot2c_f32_bf16 v53, v30, v73
    v_dot2c_f32_bf16 v52, v30, v75
    v_dot2c_f32_bf16 v55, v31, v73
    v_dot2c_f32_bf16 v54, v31, v75
    s_nop 0
    v_permlane32_swap_b32 v48, v52
    v_permlane32_swap_b32 v49, v53
    v_permlane32_swap_b32 v50, v54
    v_permlane32_swap_b32 v51, v55
    v_add_f32 v48, v48, v52
    v_add_f32 v49, v49, v53
    v_add_f32 v50, v50, v54
    v_add_f32 v51, v51, v55
    s_nop 0
    v_permlane16_swap_b32 v48, v50
    v_permlane16_swap_b32 v49, v51
    v_add_f32 v48, v48, v50
    v_add_f32 v49, v49, v51
    s_nop 0
    v_add_f32_dpp v48, v48, v48 row_ror:8 row_mask:0xf bank_mask:0xf
    v_add_f32_dpp v49, v49, v49 row_ror:8 row_mask:0xf bank_mask:0xf
    v_and_b32 v16, 7, v1
    v_lshlrev_b32 v16, 5, v16
    v_lshrrev_b32 v17, 4, v1
    v_lshl_add_u32 v16, v17, 3, v16
    s_lshl_b32 s16, s3, 8
    s_add_u32 s16, s16, 147456
    v_add_u32 v16, s16, v16
    ds_write_b64 v16, v[48:49]
    v_mov_b32 v19, 149504
    v_and_b32 v17, 31, v1
    v_lshlrev_b32 v18, 3, v17
    v_add_u32 v18, 147456, v18
    v_lshlrev_b32 v17, 4, v17
    s_waitcnt lgkmcnt(0)
    s_barrier
    ds_read_b32 v134, v19
    ds_read_b64 v[96:97], v18 offset:0
    ds_read_b64 v[100:101], v18 offset:256
    ds_read_b64 v[104:105], v18 offset:512
    ds_read_b64 v[108:109], v18 offset:768
    ds_read_b64 v[112:113], v18 offset:1024
    ds_read_b64 v[116:117], v18 offset:1280
    ds_read_b64 v[120:121], v18 offset:1536
    ds_read_b64 v[124:125], v18 offset:1792
    s_waitcnt lgkmcnt(8)
    v_readfirstlane_b32 s28, v134
    v_and_b32 v20, 7, v1
    v_lshlrev_b32 v20, 4, v20
    v_add_u32 v21, 149520, v20
    ds_read_b128 v[128:131], v21
    s_waitcnt lgkmcnt(0)
    v_mov_b32 v131, s28
    s_lshl_b32 s16, s2, 7
    s_add_u32 s16, s16, 0x520000
    s_cmp_eq_u32 s3, 0
    s_cselect_b32 s16, s16, 0x7ffffff0
    s_mov_b64 exec, 0xff
    buffer_store_dwordx4 v[128:131], v20, s[8:11], s16 offen sc1
    s_mov_b64 exec, -1
    v_pk_add_f32 v[96:97], v[96:97], v[112:113]
    v_pk_add_f32 v[100:101], v[100:101], v[116:117]
    v_pk_add_f32 v[104:105], v[104:105], v[120:121]
    v_pk_add_f32 v[108:109], v[108:109], v[124:125]
    v_pk_add_f32 v[96:97], v[96:97], v[104:105]
    v_pk_add_f32 v[100:101], v[100:101], v[108:109]
    v_pk_add_f32 v[96:97], v[96:97], v[100:101]
    v_mov_b32 v98, s28
    v_mov_b32 v99, s28
    s_lshl_b32 s16, s14, 3
    s_add_u32 s16, s16, s15
    s_lshl_b32 s16, s16, 9
    s_add_u32 s16, s16, 0x500000
    s_cmp_eq_u32 s3, 0
    s_cselect_b32 s16, s16, 0x7ffffff0
    s_mov_b64 exec, 0xffffffff
    buffer_store_dwordx4 v[96:99], v17, s[8:11], s16 offen sc1
    s_mov_b64 exec, -1
    s_lshr_b32 s16, s3, 2
    s_lshl_b32 s16, s16, 4
    s_add_u32 s16, s16, s31
    s_lshl_b32 s16, s16, 12
    s_and_b32 s17, s3, 3
    s_lshl_b32 s17, s17, 7
    s_add_u32 s16, s16, s17
    s_add_u32 s16, s16, 0x500000
    v_lshrrev_b32 v139, 3, v1
    v_lshlrev_b32 v139, 9, v139
    v_and_b32 v16, 7, v1
    v_lshl_add_u32 v139, v16, 4, v139
    v_and_b32 v140, 15, v1
    v_lshlrev_b32 v140, 4, v140
    s_lshl_b32 s17, s29, 8
    s_add_u32 s17, s17, 0x520000
    s_waitcnt vmcnt(12)
    v_lshlrev_b32 v56, 16, v40
    v_and_b32 v57, 0xffff0000, v40
    v_lshlrev_b32 v58, 16, v41
    v_and_b32 v59, 0xffff0000, v41
    v_lshlrev_b32 v60, 16, v42
    v_and_b32 v61, 0xffff0000, v42
    v_lshlrev_b32 v62, 16, v43
    v_and_b32 v63, 0xffff0000, v43
    s_waitcnt vmcnt(11)
    v_lshlrev_b32 v64, 16, v44
    v_and_b32 v65, 0xffff0000, v44
    v_lshlrev_b32 v66, 16, v45
    v_and_b32 v67, 0xffff0000, v45
    v_lshlrev_b32 v68, 16, v46
    v_and_b32 v69, 0xffff0000, v46
    v_lshlrev_b32 v70, 16, v47
    v_and_b32 v71, 0xffff0000, v47
    v_mov_b32 v135, 2097152
    v_mul_lo_u32 v135, v135, v1
    s_mov_b64 s[76:77], s[40:41]
    s_mov_b32 s78, 0x800000
    s_mov_b32 s79, 0x20000
    s_mov_b32 s62, 0x0
    s_cmp_eq_u32 s3, 4
    s_cselect_b32 s62, s62, 0x7ffffff0
    buffer_load_dword v136, v135, s[76:79], s62 offen
    s_mov_b64 s[76:77], s[46:47]
    s_mov_b32 s78, 0x700000
    s_mov_b32 s79, 0x20000
    s_mov_b32 s62, 0x0
    s_cmp_eq_u32 s3, 4
    s_cselect_b32 s62, s62, 0x7ffffff0
    buffer_load_dword v136, v135, s[76:79], s62 offen
    s_mov_b64 s[76:77], s[48:49]
    s_mov_b32 s78, 0x700000
    s_mov_b32 s79, 0x20000
    s_mov_b32 s62, 0x0
    s_cmp_eq_u32 s3, 5
    s_cselect_b32 s62, s62, 0x7ffffff0
    buffer_load_dword v136, v135, s[76:79], s62 offen
    s_mov_b64 s[76:77], s[50:51]
    s_mov_b32 s78, 0x700000
    s_mov_b32 s79, 0x20000
    s_mov_b32 s62, 0x0
    s_cmp_eq_u32 s3, 5
    s_cselect_b32 s62, s62, 0x7ffffff0
    buffer_load_dword v136, v135, s[76:79], s62 offen
    s_mov_b64 s[76:77], s[38:39]
    s_mov_b32 s78, 0x800000
    s_mov_b32 s79, 0x20000
    s_mov_b32 s62, 0x0
    s_cmp_eq_u32 s3, 6
    s_cselect_b32 s62, s62, 0x7ffffff0
    buffer_load_dword v136, v135, s[76:79], s62 offen
    s_mov_b64 s[76:77], s[56:57]
    s_mov_b32 s78, 0x400000
    s_mov_b32 s79, 0x20000
    s_mov_b32 s62, 0x0
    s_cmp_eq_u32 s3, 6
    s_cselect_b32 s62, s62, 0x7ffffff0
    buffer_load_dword v136, v135, s[76:79], s62 offen
    s_mov_b64 s[76:77], s[54:55]
    s_mov_b32 s78, 0xc00000
    s_mov_b32 s79, 0x20000
    s_mov_b32 s62, 0x0
    s_cmp_eq_u32 s3, 7
    s_cselect_b32 s62, s62, 0x7ffffff0
    buffer_load_dword v136, v135, s[76:79], s62 offen
    s_mov_b64 s[76:77], s[44:45]
    s_mov_b32 s78, 0x800
    s_mov_b32 s79, 0x20000
    s_mov_b32 s62, 0x0
    s_cmp_eq_u32 s3, 7
    s_cselect_b32 s62, s62, 0x7ffffff0
    buffer_load_dword v136, v135, s[76:79], s62 offen
    s_mov_b32 s27, 0
adaLN_cond__sliding_block_cached__moe_arch_mod__prompt_kernel_g14p:
    buffer_load_dwordx4 v[76:79], v139, s[8:11], s16 offen sc1
    buffer_load_dwordx4 v[80:83], v140, s[8:11], s17 offen sc1
    s_waitcnt vmcnt(1)
    v_cmp_ne_u32 vcc, s28, v78
    v_cmp_ne_u32 s[62:63], s28, v79
    s_or_b64 vcc, vcc, s[62:63]
    s_waitcnt vmcnt(0)
    v_cmp_ne_u32 s[62:63], s28, v83
    s_or_b64 vcc, vcc, s[62:63]
    s_add_u32 s27, s27, 1
    s_cmp_ge_u32 s27, 65536
    s_cbranch_scc1 adaLN_cond__sliding_block_cached__moe_arch_mod__prompt_kernel_g14g
    s_cbranch_vccnz adaLN_cond__sliding_block_cached__moe_arch_mod__prompt_kernel_g14p
adaLN_cond__sliding_block_cached__moe_arch_mod__prompt_kernel_g14g:
    v_add_f32_dpp v76, v76, v76 row_ror:8 row_mask:0xf bank_mask:0xf
    v_add_f32_dpp v77, v77, v77 row_ror:8 row_mask:0xf bank_mask:0xf
    v_mov_b32 v17, v76
    s_nop 1
    v_permlane16_swap_b32 v76, v17
    v_add_f32 v76, v76, v17
    v_mov_b32 v18, v77
    s_nop 1
    v_permlane16_swap_b32 v77, v18
    v_add_f32 v77, v77, v18
    v_mov_b32 v17, v76
    s_nop 1
    v_permlane32_swap_b32 v76, v17
    v_add_f32 v76, v76, v17
    v_mov_b32 v18, v77
    s_nop 1
    v_permlane32_swap_b32 v77, v18
    v_add_f32 v77, v77, v18
    v_cvt_pk_bf16_f32 v17, v76, v77
    v_lshlrev_b32 v76, 16, v17
    v_and_b32 v77, 0xffff0000, v17
    v_add_f32 v76, 1.0, v76
    v_add_f32 v77, 1.0, v77
    v_cvt_pk_bf16_f32 v17, v76, v77
    v_lshlrev_b32 v76, 16, v17
    v_and_b32 v77, 0xffff0000, v17
    s_lshl_b32 s16, s3, 6
    s_add_u32 s16, s16, 151552
    v_lshl_add_u32 v16, v16, 3, s16
    ds_write_b64 v16, v[76:77]
    v_lshrrev_b32 v17, 4, v1
    v_lshlrev_b32 v17, 5, v17
    v_add_u32 v17, 151552, v17
    v_sub_f32 v56, v56, v80
    v_sub_f32 v57, v57, v80
    v_sub_f32 v58, v58, v80
    v_sub_f32 v59, v59, v80
    v_sub_f32 v60, v60, v80
    v_sub_f32 v61, v61, v80
    v_sub_f32 v62, v62, v80
    v_sub_f32 v63, v63, v80
    v_sub_f32 v64, v64, v80
    v_sub_f32 v65, v65, v80
    v_sub_f32 v66, v66, v80
    v_sub_f32 v67, v67, v80
    v_sub_f32 v68, v68, v80
    v_sub_f32 v69, v69, v80
    v_sub_f32 v70, v70, v80
    v_sub_f32 v71, v71, v80
    v_cvt_pk_bf16_f32 v18, v56, v57
    v_lshlrev_b32 v56, 16, v18
    v_and_b32 v57, 0xffff0000, v18
    v_cvt_pk_bf16_f32 v19, v58, v59
    v_lshlrev_b32 v58, 16, v19
    v_and_b32 v59, 0xffff0000, v19
    v_cvt_pk_bf16_f32 v18, v60, v61
    v_lshlrev_b32 v60, 16, v18
    v_and_b32 v61, 0xffff0000, v18
    v_cvt_pk_bf16_f32 v19, v62, v63
    v_lshlrev_b32 v62, 16, v19
    v_and_b32 v63, 0xffff0000, v19
    v_cvt_pk_bf16_f32 v18, v64, v65
    v_lshlrev_b32 v64, 16, v18
    v_and_b32 v65, 0xffff0000, v18
    v_cvt_pk_bf16_f32 v19, v66, v67
    v_lshlrev_b32 v66, 16, v19
    v_and_b32 v67, 0xffff0000, v19
    v_cvt_pk_bf16_f32 v18, v68, v69
    v_lshlrev_b32 v68, 16, v18
    v_and_b32 v69, 0xffff0000, v18
    v_cvt_pk_bf16_f32 v19, v70, v71
    v_lshlrev_b32 v70, 16, v19
    v_and_b32 v71, 0xffff0000, v19
    v_mul_f32 v56, v56, v82
    v_mul_f32 v57, v57, v82
    v_mul_f32 v58, v58, v82
    v_mul_f32 v59, v59, v82
    v_mul_f32 v60, v60, v82
    v_mul_f32 v61, v61, v82
    v_mul_f32 v62, v62, v82
    v_mul_f32 v63, v63, v82
    v_mul_f32 v64, v64, v82
    v_mul_f32 v65, v65, v82
    v_mul_f32 v66, v66, v82
    v_mul_f32 v67, v67, v82
    v_mul_f32 v68, v68, v82
    v_mul_f32 v69, v69, v82
    v_mul_f32 v70, v70, v82
    v_mul_f32 v71, v71, v82
    v_cvt_pk_bf16_f32 v18, v56, v57
    v_lshlrev_b32 v56, 16, v18
    v_and_b32 v57, 0xffff0000, v18
    v_cvt_pk_bf16_f32 v19, v58, v59
    v_lshlrev_b32 v58, 16, v19
    v_and_b32 v59, 0xffff0000, v19
    v_cvt_pk_bf16_f32 v18, v60, v61
    v_lshlrev_b32 v60, 16, v18
    v_and_b32 v61, 0xffff0000, v18
    v_cvt_pk_bf16_f32 v19, v62, v63
    v_lshlrev_b32 v62, 16, v19
    v_and_b32 v63, 0xffff0000, v19
    v_cvt_pk_bf16_f32 v18, v64, v65
    v_lshlrev_b32 v64, 16, v18
    v_and_b32 v65, 0xffff0000, v18
    v_cvt_pk_bf16_f32 v19, v66, v67
    v_lshlrev_b32 v66, 16, v19
    v_and_b32 v67, 0xffff0000, v19
    v_cvt_pk_bf16_f32 v18, v68, v69
    v_lshlrev_b32 v68, 16, v18
    v_and_b32 v69, 0xffff0000, v18
    v_cvt_pk_bf16_f32 v19, v70, v71
    v_lshlrev_b32 v70, 16, v19
    v_and_b32 v71, 0xffff0000, v19
    s_lshl_b32 s16, s29, 15
    s_lshl_b32 s17, s31, 11
    s_add_u32 s16, s16, s17
    s_waitcnt lgkmcnt(0)
    s_barrier
    s_cmp_lt_u32 s24, 8
    s_cbranch_scc1 adaLN_cond__sliding_block_cached__moe_arch_mod__prompt_kernel_kvS
    v_lshl_or_b32 v84, v89, 16, v88
    v_lshl_or_b32 v85, v91, 16, v90
    v_lshl_or_b32 v86, v93, 16, v92
    v_lshl_or_b32 v87, v95, 16, v94
    v_and_b32 v88, 0x7fff, v88
    v_and_b32 v89, 0x7fff, v89
    v_and_b32 v90, 0x7fff, v90
    v_and_b32 v91, 0x7fff, v91
    v_and_b32 v92, 0x7fff, v92
    v_and_b32 v93, 0x7fff, v93
    v_and_b32 v94, 0x7fff, v94
    v_and_b32 v95, 0x7fff, v95
    v_max3_u32 v88, v88, v89, v90
    v_max3_u32 v91, v91, v92, v93
    v_max3_u32 v88, v88, v94, v95
    v_max_u32 v88, v88, v91
    v_cmp_le_u32 vcc, 0x4980, v88
    v_mov_b32 v89, s28
    s_mov_b32 s26, 0x564000
    s_and_saveexec_b64 s[62:63], vcc
    buffer_store_dword v89, v132, s[8:11], s26 offen sc1
    s_mov_b64 exec, s[62:63]
adaLN_cond__sliding_block_cached__moe_arch_mod__prompt_kernel_kvS:
    buffer_store_dwordx4 v[84:87], v2, s[8:11], s21 offen sc1
    ds_read_b128 v[96:99], v17 offset:256
    ds_read_b128 v[104:107], v17 offset:0
    ds_read_b128 v[100:103], v17 offset:272
    ds_read_b128 v[108:111], v17 offset:16
    ds_read_b128 v[112:115], v17 offset:384
    ds_read_b128 v[120:123], v17 offset:128
    ds_read_b128 v[116:119], v17 offset:400
    ds_read_b128 v[124:127], v17 offset:144
    s_waitcnt lgkmcnt(7)
    v_pk_mul_f32 v[56:57], v[56:57], v[96:97]
    v_pk_mul_f32 v[58:59], v[58:59], v[98:99]
    s_waitcnt lgkmcnt(5)
    v_pk_mul_f32 v[60:61], v[60:61], v[100:101]
    v_pk_mul_f32 v[62:63], v[62:63], v[102:103]
    v_cvt_pk_bf16_f32 v18, v56, v57
    v_lshlrev_b32 v56, 16, v18
    v_and_b32 v57, 0xffff0000, v18
    v_cvt_pk_bf16_f32 v19, v58, v59
    v_lshlrev_b32 v58, 16, v19
    v_and_b32 v59, 0xffff0000, v19
    v_cvt_pk_bf16_f32 v18, v60, v61
    v_lshlrev_b32 v60, 16, v18
    v_and_b32 v61, 0xffff0000, v18
    v_cvt_pk_bf16_f32 v19, v62, v63
    v_lshlrev_b32 v62, 16, v19
    v_and_b32 v63, 0xffff0000, v19
    v_pk_add_f32 v[56:57], v[56:57], v[104:105]
    v_pk_add_f32 v[58:59], v[58:59], v[106:107]
    s_waitcnt lgkmcnt(4)
    v_pk_add_f32 v[60:61], v[60:61], v[108:109]
    v_pk_add_f32 v[62:63], v[62:63], v[110:111]
    v_cvt_pk_bf16_f32 v32, v56, v57
    v_cvt_pk_bf16_f32 v33, v58, v59
    v_cvt_pk_bf16_f32 v34, v60, v61
    v_cvt_pk_bf16_f32 v35, v62, v63
    buffer_store_dwordx4 v[32:35], v2, s[8:11], s16 offen offset:0 sc1
    s_waitcnt lgkmcnt(3)
    v_pk_mul_f32 v[64:65], v[64:65], v[112:113]
    v_pk_mul_f32 v[66:67], v[66:67], v[114:115]
    s_waitcnt lgkmcnt(1)
    v_pk_mul_f32 v[68:69], v[68:69], v[116:117]
    v_pk_mul_f32 v[70:71], v[70:71], v[118:119]
    v_cvt_pk_bf16_f32 v18, v64, v65
    v_lshlrev_b32 v64, 16, v18
    v_and_b32 v65, 0xffff0000, v18
    v_cvt_pk_bf16_f32 v19, v66, v67
    v_lshlrev_b32 v66, 16, v19
    v_and_b32 v67, 0xffff0000, v19
    v_cvt_pk_bf16_f32 v18, v68, v69
    v_lshlrev_b32 v68, 16, v18
    v_and_b32 v69, 0xffff0000, v18
    v_cvt_pk_bf16_f32 v19, v70, v71
    v_lshlrev_b32 v70, 16, v19
    v_and_b32 v71, 0xffff0000, v19
    v_pk_add_f32 v[64:65], v[64:65], v[120:121]
    v_pk_add_f32 v[66:67], v[66:67], v[122:123]
    s_waitcnt lgkmcnt(0)
    v_pk_add_f32 v[68:69], v[68:69], v[124:125]
    v_pk_add_f32 v[70:71], v[70:71], v[126:127]
    v_cvt_pk_bf16_f32 v36, v64, v65
    v_cvt_pk_bf16_f32 v37, v66, v67
    v_cvt_pk_bf16_f32 v38, v68, v69
    v_cvt_pk_bf16_f32 v39, v70, v71
    buffer_store_dwordx4 v[36:39], v2, s[8:11], s16 offen offset:1024 sc1
    s_lshl_b32 s19, s3, 16
    s_lshl_b32 s20, s3, 11
    s_lshl_b32 s16, s12, 8
    s_add_u32 s4, s38, s16
    s_addc_u32 s5, s39, 0
    s_sub_u32 s6, 0x800000, s16
    s_mov_b32 s7, 0x20000
    s_barrier
    s_add_u32 s22, s19, 0x0
    s_add_u32 m0, s20, 0x0
    s_nop 0
    buffer_load_dwordx4 v3, s[4:7], s22 offen lds
    s_add_u32 s22, s19, 0x8000
    s_add_u32 m0, s20, 0x400
    s_nop 0
    buffer_load_dwordx4 v3, s[4:7], s22 offen lds
    s_add_u32 s22, s19, 0x80000
    s_add_u32 m0, s20, 0x4000
    s_nop 0
    buffer_load_dwordx4 v3, s[4:7], s22 offen lds
    s_add_u32 s22, s19, 0x88000
    s_add_u32 m0, s20, 0x4400
    s_nop 0
    buffer_load_dwordx4 v3, s[4:7], s22 offen lds
    s_add_u32 s22, s19, 0x100000
    s_add_u32 m0, s20, 0x8000
    s_nop 0
    buffer_load_dwordx4 v3, s[4:7], s22 offen lds
    s_add_u32 s22, s19, 0x108000
    s_add_u32 m0, s20, 0x8400
    s_nop 0
    buffer_load_dwordx4 v3, s[4:7], s22 offen lds
    v_mov_b32 v134, s28
    s_lshl_b32 s16, s29, 4
    s_add_u32 s16, s16, s31
    s_lshl_b32 s16, s16, 2
    s_add_u32 s16, s16, 0x528000
    v_and_b32 v16, 31, v1
    v_lshlrev_b32 v16, 2, v16
    s_lshl_b32 s17, s13, 3
    s_add_u32 s17, s17, s3
    s_lshl_b32 s17, s17, 7
    s_add_u32 s17, s17, 0x528000
    s_waitcnt vmcnt(6)
    s_mov_b64 exec, 1
    buffer_store_dword v134, v132, s[8:11], s16 offen sc1
    s_mov_b64 exec, -1
    s_waitcnt vmcnt(0)
    s_mov_b32 s27, 0
adaLN_cond__sliding_block_cached__moe_arch_mod__prompt_kernel_h15p:
    buffer_load_dword v17, v16, s[8:11], s17 offen sc1
    s_waitcnt vmcnt(0)
    v_cmp_ne_u32 vcc, s28, v17
    s_add_u32 s27, s27, 1
    s_cmp_ge_u32 s27, 65536
    s_cbranch_scc1 adaLN_cond__sliding_block_cached__moe_arch_mod__prompt_kernel_h15g
    s_cbranch_vccnz adaLN_cond__sliding_block_cached__moe_arch_mod__prompt_kernel_h15p
adaLN_cond__sliding_block_cached__moe_arch_mod__prompt_kernel_h15g:
    s_mov_b32 s23, 0x0
    buffer_load_dwordx4 v[88:91], v7, s[8:11], s23 offen offset:0 sc1
    s_mov_b32 s23, 0x8000
    buffer_load_dwordx4 v[92:95], v7, s[8:11], s23 offen offset:0 sc1
    s_mov_b32 s23, 0x0
    buffer_load_dwordx4 v[96:99], v7, s[8:11], s23 offen offset:1024 sc1
    s_mov_b32 s23, 0x8000
    buffer_load_dwordx4 v[100:103], v7, s[8:11], s23 offen offset:1024 sc1
    s_mov_b32 s23, 0x800
    buffer_load_dwordx4 v[104:107], v7, s[8:11], s23 offen offset:0 sc1
    s_mov_b32 s23, 0x8800
    buffer_load_dwordx4 v[108:111], v7, s[8:11], s23 offen offset:0 sc1
    s_mov_b32 s23, 0x800
    buffer_load_dwordx4 v[112:115], v7, s[8:11], s23 offen offset:1024 sc1
    s_mov_b32 s23, 0x8800
    buffer_load_dwordx4 v[116:119], v7, s[8:11], s23 offen offset:1024 sc1
    s_mov_b32 s23, 0x1000
    buffer_load_dwordx4 v[120:123], v7, s[8:11], s23 offen offset:0 sc1
    s_mov_b32 s23, 0x9000
    buffer_load_dwordx4 v[124:127], v7, s[8:11], s23 offen offset:0 sc1
    s_mov_b32 s23, 0x1000
    buffer_load_dwordx4 v[128:131], v7, s[8:11], s23 offen offset:1024 sc1
    s_mov_b32 s23, 0x9000
    buffer_load_dwordx4 v[132:135], v7, s[8:11], s23 offen offset:1024 sc1
    s_lshr_b32 s21, s12, 3
    s_lshl_b32 s21, s21, 17
    s_add_u32 s21, s21, s20
    s_add_u32 s21, s21, 0x400000
    s_barrier
    ds_read_b64_tr_b16 v[224:225], v4 offset:0
    ds_read_b64_tr_b16 v[226:227], v4 offset:1024
    ds_read_b64_tr_b16 v[228:229], v5 offset:32
    ds_read_b64_tr_b16 v[230:231], v5 offset:1056
    ds_read_b64_tr_b16 v[232:233], v4 offset:256
    ds_read_b64_tr_b16 v[234:235], v4 offset:1280
    s_waitcnt vmcnt(11) lgkmcnt(4)
    v_mfma_f32_16x16x32_bf16 v[24:27], v[224:227], v[88:91], 0
    ds_read_b64_tr_b16 v[236:237], v5 offset:288
    s_waitcnt vmcnt(10)
    v_mfma_f32_16x16x32_bf16 v[28:31], v[224:227], v[92:95], 0
    ds_read_b64_tr_b16 v[238:239], v5 offset:1312
    s_waitcnt lgkmcnt(4)
    v_mfma_f32_16x16x32_bf16 v[32:35], v[228:231], v[88:91], 0
    ds_read_b64_tr_b16 v[240:241], v4 offset:512
    v_mfma_f32_16x16x32_bf16 v[36:39], v[228:231], v[92:95], 0
    ds_read_b64_tr_b16 v[242:243], v4 offset:1536
    s_mov_b32 s23, 0x1800
    buffer_load_dwordx4 v[136:139], v7, s[8:11], s23 offen offset:0 sc1
    s_waitcnt lgkmcnt(4)
    v_mfma_f32_16x16x32_bf16 v[40:43], v[232:235], v[88:91], 0
    ds_read_b64_tr_b16 v[244:245], v5 offset:544
    v_mfma_f32_16x16x32_bf16 v[44:47], v[232:235], v[92:95], 0
    ds_read_b64_tr_b16 v[246:247], v5 offset:1568
    s_waitcnt lgkmcnt(4)
    v_mfma_f32_16x16x32_bf16 v[48:51], v[236:239], v[88:91], 0
    ds_read_b64_tr_b16 v[224:225], v4 offset:768
    v_mfma_f32_16x16x32_bf16 v[52:55], v[236:239], v[92:95], 0
    ds_read_b64_tr_b16 v[226:227], v4 offset:1792
    s_waitcnt lgkmcnt(4)
    v_mfma_f32_16x16x32_bf16 v[56:59], v[240:243], v[88:91], 0
    ds_read_b64_tr_b16 v[228:229], v5 offset:800
    v_mfma_f32_16x16x32_bf16 v[60:63], v[240:243], v[92:95], 0
    ds_read_b64_tr_b16 v[230:231], v5 offset:1824
    s_waitcnt lgkmcnt(4)
    v_mfma_f32_16x16x32_bf16 v[64:67], v[244:247], v[88:91], 0
    ds_read_b64_tr_b16 v[232:233], v4 offset:8192
    v_mfma_f32_16x16x32_bf16 v[68:71], v[244:247], v[92:95], 0
    ds_read_b64_tr_b16 v[234:235], v4 offset:9216
    s_mov_b32 s23, 0x9800
    buffer_load_dwordx4 v[140:143], v7, s[8:11], s23 offen offset:0 sc1
    s_waitcnt lgkmcnt(4)
    v_mfma_f32_16x16x32_bf16 v[72:75], v[224:227], v[88:91], 0
    ds_read_b64_tr_b16 v[236:237], v5 offset:8224
    v_mfma_f32_16x16x32_bf16 v[76:79], v[224:227], v[92:95], 0
    ds_read_b64_tr_b16 v[238:239], v5 offset:9248
    s_waitcnt lgkmcnt(4)
    v_mfma_f32_16x16x32_bf16 v[80:83], v[228:231], v[88:91], 0
    ds_read_b64_tr_b16 v[240:241], v4 offset:8448
    v_mfma_f32_16x16x32_bf16 v[84:87], v[228:231], v[92:95], 0
    ds_read_b64_tr_b16 v[242:243], v4 offset:9472
    s_waitcnt vmcnt(11) lgkmcnt(4)
    v_mfma_f32_16x16x32_bf16 v[24:27], v[232:235], v[96:99], v[24:27]
    ds_read_b64_tr_b16 v[244:245], v5 offset:8480
    s_waitcnt vmcnt(10)
    v_mfma_f32_16x16x32_bf16 v[28:31], v[232:235], v[100:103], v[28:31]
    ds_read_b64_tr_b16 v[246:247], v5 offset:9504
    s_waitcnt lgkmcnt(4)
    v_mfma_f32_16x16x32_bf16 v[32:35], v[236:239], v[96:99], v[32:35]
    ds_read_b64_tr_b16 v[224:225], v4 offset:8704
    v_mfma_f32_16x16x32_bf16 v[36:39], v[236:239], v[100:103], v[36:39]
    ds_read_b64_tr_b16 v[226:227], v4 offset:9728
    s_mov_b32 s23, 0x1800
    buffer_load_dwordx4 v[144:147], v7, s[8:11], s23 offen offset:1024 sc1
    s_waitcnt lgkmcnt(4)
    v_mfma_f32_16x16x32_bf16 v[40:43], v[240:243], v[96:99], v[40:43]
    ds_read_b64_tr_b16 v[228:229], v5 offset:8736
    v_mfma_f32_16x16x32_bf16 v[44:47], v[240:243], v[100:103], v[44:47]
    ds_read_b64_tr_b16 v[230:231], v5 offset:9760
    s_waitcnt lgkmcnt(4)
    v_mfma_f32_16x16x32_bf16 v[48:51], v[244:247], v[96:99], v[48:51]
    ds_read_b64_tr_b16 v[232:233], v4 offset:8960
    v_mfma_f32_16x16x32_bf16 v[52:55], v[244:247], v[100:103], v[52:55]
    ds_read_b64_tr_b16 v[234:235], v4 offset:9984
    s_waitcnt lgkmcnt(4)
    v_mfma_f32_16x16x32_bf16 v[56:59], v[224:227], v[96:99], v[56:59]
    ds_read_b64_tr_b16 v[236:237], v5 offset:8992
    v_mfma_f32_16x16x32_bf16 v[60:63], v[224:227], v[100:103], v[60:63]
    ds_read_b64_tr_b16 v[238:239], v5 offset:10016
    s_waitcnt lgkmcnt(4)
    v_mfma_f32_16x16x32_bf16 v[64:67], v[228:231], v[96:99], v[64:67]
    v_mfma_f32_16x16x32_bf16 v[68:71], v[228:231], v[100:103], v[68:71]
    s_barrier
    ds_read_b64_tr_b16 v[240:241], v4 offset:16384
    ds_read_b64_tr_b16 v[242:243], v4 offset:17408
    s_mov_b32 s23, 0x9800
    buffer_load_dwordx4 v[148:151], v7, s[8:11], s23 offen offset:1024 sc1
    s_waitcnt lgkmcnt(4)
    v_mfma_f32_16x16x32_bf16 v[72:75], v[232:235], v[96:99], v[72:75]
    ds_read_b64_tr_b16 v[244:245], v5 offset:16416
    v_mfma_f32_16x16x32_bf16 v[76:79], v[232:235], v[100:103], v[76:79]
    s_add_u32 s22, s19, 0x180000
    s_add_u32 m0, s20, 0xc000
    s_nop 0
    buffer_load_dwordx4 v3, s[4:7], s22 offen lds
    ds_read_b64_tr_b16 v[246:247], v5 offset:17440
    s_waitcnt lgkmcnt(4)
    v_mfma_f32_16x16x32_bf16 v[80:83], v[236:239], v[96:99], v[80:83]
    ds_read_b64_tr_b16 v[224:225], v4 offset:16640
    v_mfma_f32_16x16x32_bf16 v[84:87], v[236:239], v[100:103], v[84:87]
    ds_read_b64_tr_b16 v[226:227], v4 offset:17664
    s_waitcnt vmcnt(12) lgkmcnt(4)
    v_mfma_f32_16x16x32_bf16 v[24:27], v[240:243], v[104:107], v[24:27]
    ds_read_b64_tr_b16 v[228:229], v5 offset:16672
    s_waitcnt vmcnt(11)
    v_mfma_f32_16x16x32_bf16 v[28:31], v[240:243], v[108:111], v[28:31]
    ds_read_b64_tr_b16 v[230:231], v5 offset:17696
    s_waitcnt lgkmcnt(4)
    v_mfma_f32_16x16x32_bf16 v[32:35], v[244:247], v[104:107], v[32:35]
    ds_read_b64_tr_b16 v[232:233], v4 offset:16896
    v_mfma_f32_16x16x32_bf16 v[36:39], v[244:247], v[108:111], v[36:39]
    ds_read_b64_tr_b16 v[234:235], v4 offset:17920
    s_mov_b32 s23, 0x2000
    buffer_load_dwordx4 v[88:91], v7, s[8:11], s23 offen offset:0 sc1
    s_waitcnt lgkmcnt(4)
    v_mfma_f32_16x16x32_bf16 v[40:43], v[224:227], v[104:107], v[40:43]
    ds_read_b64_tr_b16 v[236:237], v5 offset:16928
    v_mfma_f32_16x16x32_bf16 v[44:47], v[224:227], v[108:111], v[44:47]
    s_add_u32 s22, s19, 0x188000
    s_add_u32 m0, s20, 0xc400
    s_nop 0
    buffer_load_dwordx4 v3, s[4:7], s22 offen lds
    ds_read_b64_tr_b16 v[238:239], v5 offset:17952
    s_waitcnt lgkmcnt(4)
    v_mfma_f32_16x16x32_bf16 v[48:51], v[228:231], v[104:107], v[48:51]
    ds_read_b64_tr_b16 v[240:241], v4 offset:17152
    v_mfma_f32_16x16x32_bf16 v[52:55], v[228:231], v[108:111], v[52:55]
    ds_read_b64_tr_b16 v[242:243], v4 offset:18176
    s_waitcnt lgkmcnt(4)
    v_mfma_f32_16x16x32_bf16 v[56:59], v[232:235], v[104:107], v[56:59]
    ds_read_b64_tr_b16 v[244:245], v5 offset:17184
    v_mfma_f32_16x16x32_bf16 v[60:63], v[232:235], v[108:111], v[60:63]
    ds_read_b64_tr_b16 v[246:247], v5 offset:18208
    s_waitcnt lgkmcnt(4)
    v_mfma_f32_16x16x32_bf16 v[64:67], v[236:239], v[104:107], v[64:67]
    ds_read_b64_tr_b16 v[224:225], v4 offset:24576
    v_mfma_f32_16x16x32_bf16 v[68:71], v[236:239], v[108:111], v[68:71]
    ds_read_b64_tr_b16 v[226:227], v4 offset:25600
    s_mov_b32 s23, 0xa000
    buffer_load_dwordx4 v[92:95], v7, s[8:11], s23 offen offset:0 sc1
    s_waitcnt lgkmcnt(4)
    v_mfma_f32_16x16x32_bf16 v[72:75], v[240:243], v[104:107], v[72:75]
    ds_read_b64_tr_b16 v[228:229], v5 offset:24608
    v_mfma_f32_16x16x32_bf16 v[76:79], v[240:243], v[108:111], v[76:79]
    ds_read_b64_tr_b16 v[230:231], v5 offset:25632
    s_waitcnt lgkmcnt(4)
    v_mfma_f32_16x16x32_bf16 v[80:83], v[244:247], v[104:107], v[80:83]
    ds_read_b64_tr_b16 v[232:233], v4 offset:24832
    v_mfma_f32_16x16x32_bf16 v[84:87], v[244:247], v[108:111], v[84:87]
    ds_read_b64_tr_b16 v[234:235], v4 offset:25856
    s_waitcnt vmcnt(13) lgkmcnt(4)
    v_mfma_f32_16x16x32_bf16 v[24:27], v[224:227], v[112:115], v[24:27]
    ds_read_b64_tr_b16 v[236:237], v5 offset:24864
    s_waitcnt vmcnt(12)
    v_mfma_f32_16x16x32_bf16 v[28:31], v[224:227], v[116:119], v[28:31]
    ds_read_b64_tr_b16 v[238:239], v5 offset:25888
    s_waitcnt lgkmcnt(4)
    v_mfma_f32_16x16x32_bf16 v[32:35], v[228:231], v[112:115], v[32:35]
    ds_read_b64_tr_b16 v[240:241], v4 offset:25088
    v_mfma_f32_16x16x32_bf16 v[36:39], v[228:231], v[116:119], v[36:39]
    ds_read_b64_tr_b16 v[242:243], v4 offset:26112
    s_mov_b32 s23, 0x2000
    buffer_load_dwordx4 v[96:99], v7, s[8:11], s23 offen offset:1024 sc1
    s_waitcnt lgkmcnt(4)
    v_mfma_f32_16x16x32_bf16 v[40:43], v[232:235], v[112:115], v[40:43]
    ds_read_b64_tr_b16 v[244:245], v5 offset:25120
    v_mfma_f32_16x16x32_bf16 v[44:47], v[232:235], v[116:119], v[44:47]
    ds_read_b64_tr_b16 v[246:247], v5 offset:26144
    s_waitcnt lgkmcnt(4)
    v_mfma_f32_16x16x32_bf16 v[48:51], v[236:239], v[112:115], v[48:51]
    ds_read_b64_tr_b16 v[224:225], v4 offset:25344
    v_mfma_f32_16x16x32_bf16 v[52:55], v[236:239], v[116:119], v[52:55]
    ds_read_b64_tr_b16 v[226:227], v4 offset:26368
    s_waitcnt lgkmcnt(4)
    v_mfma_f32_16x16x32_bf16 v[56:59], v[240:243], v[112:115], v[56:59]
    ds_read_b64_tr_b16 v[228:229], v5 offset:25376
    v_mfma_f32_16x16x32_bf16 v[60:63], v[240:243], v[116:119], v[60:63]
    ds_read_b64_tr_b16 v[230:231], v5 offset:26400
    s_waitcnt lgkmcnt(4)
    v_mfma_f32_16x16x32_bf16 v[64:67], v[244:247], v[112:115], v[64:67]
    v_mfma_f32_16x16x32_bf16 v[68:71], v[244:247], v[116:119], v[68:71]
    s_barrier
    ds_read_b64_tr_b16 v[232:233], v4 offset:32768
    ds_read_b64_tr_b16 v[234:235], v4 offset:33792
    s_mov_b32 s23, 0xa000
    buffer_load_dwordx4 v[100:103], v7, s[8:11], s23 offen offset:1024 sc1
    s_waitcnt lgkmcnt(4)
    v_mfma_f32_16x16x32_bf16 v[72:75], v[224:227], v[112:115], v[72:75]
    ds_read_b64_tr_b16 v[236:237], v5 offset:32800
    v_mfma_f32_16x16x32_bf16 v[76:79], v[224:227], v[116:119], v[76:79]
    s_add_u32 s22, s19, 0x200000
    s_add_u32 m0, s20, 0x0
    s_nop 0
    buffer_load_dwordx4 v3, s[4:7], s22 offen lds
    ds_read_b64_tr_b16 v[238:239], v5 offset:33824
    s_waitcnt lgkmcnt(4)
    v_mfma_f32_16x16x32_bf16 v[80:83], v[228:231], v[112:115], v[80:83]
    ds_read_b64_tr_b16 v[240:241], v4 offset:33024
    v_mfma_f32_16x16x32_bf16 v[84:87], v[228:231], v[116:119], v[84:87]
    ds_read_b64_tr_b16 v[242:243], v4 offset:34048
    s_waitcnt vmcnt(14) lgkmcnt(4)
    v_mfma_f32_16x16x32_bf16 v[24:27], v[232:235], v[120:123], v[24:27]
    ds_read_b64_tr_b16 v[244:245], v5 offset:33056
    s_waitcnt vmcnt(13)
    v_mfma_f32_16x16x32_bf16 v[28:31], v[232:235], v[124:127], v[28:31]
    ds_read_b64_tr_b16 v[246:247], v5 offset:34080
    s_waitcnt lgkmcnt(4)
    v_mfma_f32_16x16x32_bf16 v[32:35], v[236:239], v[120:123], v[32:35]
    ds_read_b64_tr_b16 v[224:225], v4 offset:33280
    v_mfma_f32_16x16x32_bf16 v[36:39], v[236:239], v[124:127], v[36:39]
    ds_read_b64_tr_b16 v[226:227], v4 offset:34304
    s_mov_b32 s23, 0x2800
    buffer_load_dwordx4 v[104:107], v7, s[8:11], s23 offen offset:0 sc1
    s_waitcnt lgkmcnt(4)
    v_mfma_f32_16x16x32_bf16 v[40:43], v[240:243], v[120:123], v[40:43]
    ds_read_b64_tr_b16 v[228:229], v5 offset:33312
    v_mfma_f32_16x16x32_bf16 v[44:47], v[240:243], v[124:127], v[44:47]
    s_add_u32 s22, s19, 0x208000
    s_add_u32 m0, s20, 0x400
    s_nop 0
    buffer_load_dwordx4 v3, s[4:7], s22 offen lds
    ds_read_b64_tr_b16 v[230:231], v5 offset:34336
    s_waitcnt lgkmcnt(4)
    v_mfma_f32_16x16x32_bf16 v[48:51], v[244:247], v[120:123], v[48:51]
    ds_read_b64_tr_b16 v[232:233], v4 offset:33536
    v_mfma_f32_16x16x32_bf16 v[52:55], v[244:247], v[124:127], v[52:55]
    ds_read_b64_tr_b16 v[234:235], v4 offset:34560
    s_waitcnt lgkmcnt(4)
    v_mfma_f32_16x16x32_bf16 v[56:59], v[224:227], v[120:123], v[56:59]
    ds_read_b64_tr_b16 v[236:237], v5 offset:33568
    v_mfma_f32_16x16x32_bf16 v[60:63], v[224:227], v[124:127], v[60:63]
    ds_read_b64_tr_b16 v[238:239], v5 offset:34592
    s_waitcnt lgkmcnt(4)
    v_mfma_f32_16x16x32_bf16 v[64:67], v[228:231], v[120:123], v[64:67]
    ds_read_b64_tr_b16 v[240:241], v4 offset:40960
    v_mfma_f32_16x16x32_bf16 v[68:71], v[228:231], v[124:127], v[68:71]
    ds_read_b64_tr_b16 v[242:243], v4 offset:41984
    s_mov_b32 s23, 0xa800
    buffer_load_dwordx4 v[108:111], v7, s[8:11], s23 offen offset:0 sc1
    s_waitcnt lgkmcnt(4)
    v_mfma_f32_16x16x32_bf16 v[72:75], v[232:235], v[120:123], v[72:75]
    ds_read_b64_tr_b16 v[244:245], v5 offset:40992
    v_mfma_f32_16x16x32_bf16 v[76:79], v[232:235], v[124:127], v[76:79]
    ds_read_b64_tr_b16 v[246:247], v5 offset:42016
    s_waitcnt lgkmcnt(4)
    v_mfma_f32_16x16x32_bf16 v[80:83], v[236:239], v[120:123], v[80:83]
    ds_read_b64_tr_b16 v[224:225], v4 offset:41216
    v_mfma_f32_16x16x32_bf16 v[84:87], v[236:239], v[124:127], v[84:87]
    ds_read_b64_tr_b16 v[226:227], v4 offset:42240
    s_waitcnt vmcnt(15) lgkmcnt(4)
    v_mfma_f32_16x16x32_bf16 v[24:27], v[240:243], v[128:131], v[24:27]
    ds_read_b64_tr_b16 v[228:229], v5 offset:41248
    s_waitcnt vmcnt(14)
    v_mfma_f32_16x16x32_bf16 v[28:31], v[240:243], v[132:135], v[28:31]
    ds_read_b64_tr_b16 v[230:231], v5 offset:42272
    s_waitcnt lgkmcnt(4)
    v_mfma_f32_16x16x32_bf16 v[32:35], v[244:247], v[128:131], v[32:35]
    ds_read_b64_tr_b16 v[232:233], v4 offset:41472
    v_mfma_f32_16x16x32_bf16 v[36:39], v[244:247], v[132:135], v[36:39]
    ds_read_b64_tr_b16 v[234:235], v4 offset:42496
    s_mov_b32 s23, 0x2800
    buffer_load_dwordx4 v[112:115], v7, s[8:11], s23 offen offset:1024 sc1
    s_waitcnt lgkmcnt(4)
    v_mfma_f32_16x16x32_bf16 v[40:43], v[224:227], v[128:131], v[40:43]
    ds_read_b64_tr_b16 v[236:237], v5 offset:41504
    v_mfma_f32_16x16x32_bf16 v[44:47], v[224:227], v[132:135], v[44:47]
    ds_read_b64_tr_b16 v[238:239], v5 offset:42528
    s_waitcnt lgkmcnt(4)
    v_mfma_f32_16x16x32_bf16 v[48:51], v[228:231], v[128:131], v[48:51]
    ds_read_b64_tr_b16 v[240:241], v4 offset:41728
    v_mfma_f32_16x16x32_bf16 v[52:55], v[228:231], v[132:135], v[52:55]
    ds_read_b64_tr_b16 v[242:243], v4 offset:42752
    s_waitcnt lgkmcnt(4)
    v_mfma_f32_16x16x32_bf16 v[56:59], v[232:235], v[128:131], v[56:59]
    ds_read_b64_tr_b16 v[244:245], v5 offset:41760
    v_mfma_f32_16x16x32_bf16 v[60:63], v[232:235], v[132:135], v[60:63]
    ds_read_b64_tr_b16 v[246:247], v5 offset:42784
    s_waitcnt lgkmcnt(4)
    v_mfma_f32_16x16x32_bf16 v[64:67], v[236:239], v[128:131], v[64:67]
    v_mfma_f32_16x16x32_bf16 v[68:71], v[236:239], v[132:135], v[68:71]
    s_waitcnt vmcnt(8)
    s_barrier
    ds_read_b64_tr_b16 v[224:225], v4 offset:49152
    ds_read_b64_tr_b16 v[226:227], v4 offset:50176
    s_mov_b32 s23, 0xa800
    buffer_load_dwordx4 v[116:119], v7, s[8:11], s23 offen offset:1024 sc1
    s_waitcnt lgkmcnt(4)
    v_mfma_f32_16x16x32_bf16 v[72:75], v[240:243], v[128:131], v[72:75]
    ds_read_b64_tr_b16 v[228:229], v5 offset:49184
    v_mfma_f32_16x16x32_bf16 v[76:79], v[240:243], v[132:135], v[76:79]
    s_add_u32 s22, s19, 0x280000
    s_add_u32 m0, s20, 0x4000
    s_nop 0
    buffer_load_dwordx4 v3, s[4:7], s22 offen lds
    ds_read_b64_tr_b16 v[230:231], v5 offset:50208
    s_waitcnt lgkmcnt(4)
    v_mfma_f32_16x16x32_bf16 v[80:83], v[244:247], v[128:131], v[80:83]
    ds_read_b64_tr_b16 v[232:233], v4 offset:49408
    v_mfma_f32_16x16x32_bf16 v[84:87], v[244:247], v[132:135], v[84:87]
    ds_read_b64_tr_b16 v[234:235], v4 offset:50432
    s_waitcnt lgkmcnt(4)
    v_mfma_f32_16x16x32_bf16 v[24:27], v[224:227], v[136:139], v[24:27]
    ds_read_b64_tr_b16 v[236:237], v5 offset:49440
    v_mfma_f32_16x16x32_bf16 v[28:31], v[224:227], v[140:143], v[28:31]
    ds_read_b64_tr_b16 v[238:239], v5 offset:50464
    s_waitcnt lgkmcnt(4)
    v_mfma_f32_16x16x32_bf16 v[32:35], v[228:231], v[136:139], v[32:35]
    ds_read_b64_tr_b16 v[240:241], v4 offset:49664
    v_mfma_f32_16x16x32_bf16 v[36:39], v[228:231], v[140:143], v[36:39]
    ds_read_b64_tr_b16 v[242:243], v4 offset:50688
    s_mov_b32 s23, 0x3000
    buffer_load_dwordx4 v[120:123], v7, s[8:11], s23 offen offset:0 sc1
    s_waitcnt lgkmcnt(4)
    v_mfma_f32_16x16x32_bf16 v[40:43], v[232:235], v[136:139], v[40:43]
    ds_read_b64_tr_b16 v[244:245], v5 offset:49696
    v_mfma_f32_16x16x32_bf16 v[44:47], v[232:235], v[140:143], v[44:47]
    s_add_u32 s22, s19, 0x288000
    s_add_u32 m0, s20, 0x4400
    s_nop 0
    buffer_load_dwordx4 v3, s[4:7], s22 offen lds
    ds_read_b64_tr_b16 v[246:247], v5 offset:50720
    s_waitcnt lgkmcnt(4)
    v_mfma_f32_16x16x32_bf16 v[48:51], v[236:239], v[136:139], v[48:51]
    ds_read_b64_tr_b16 v[224:225], v4 offset:49920
    v_mfma_f32_16x16x32_bf16 v[52:55], v[236:239], v[140:143], v[52:55]
    ds_read_b64_tr_b16 v[226:227], v4 offset:50944
    s_waitcnt lgkmcnt(4)
    v_mfma_f32_16x16x32_bf16 v[56:59], v[240:243], v[136:139], v[56:59]
    ds_read_b64_tr_b16 v[228:229], v5 offset:49952
    v_mfma_f32_16x16x32_bf16 v[60:63], v[240:243], v[140:143], v[60:63]
    ds_read_b64_tr_b16 v[230:231], v5 offset:50976
    s_waitcnt lgkmcnt(4)
    v_mfma_f32_16x16x32_bf16 v[64:67], v[244:247], v[136:139], v[64:67]
    ds_read_b64_tr_b16 v[232:233], v4 offset:57344
    v_mfma_f32_16x16x32_bf16 v[68:71], v[244:247], v[140:143], v[68:71]
    ds_read_b64_tr_b16 v[234:235], v4 offset:58368
    s_mov_b32 s23, 0xb000
    buffer_load_dwordx4 v[124:127], v7, s[8:11], s23 offen offset:0 sc1
    s_waitcnt lgkmcnt(4)
    v_mfma_f32_16x16x32_bf16 v[72:75], v[224:227], v[136:139], v[72:75]
    ds_read_b64_tr_b16 v[236:237], v5 offset:57376
    v_mfma_f32_16x16x32_bf16 v[76:79], v[224:227], v[140:143], v[76:79]
    ds_read_b64_tr_b16 v[238:239], v5 offset:58400
    s_waitcnt lgkmcnt(4)
    v_mfma_f32_16x16x32_bf16 v[80:83], v[228:231], v[136:139], v[80:83]
    ds_read_b64_tr_b16 v[240:241], v4 offset:57600
    v_mfma_f32_16x16x32_bf16 v[84:87], v[228:231], v[140:143], v[84:87]
    ds_read_b64_tr_b16 v[242:243], v4 offset:58624
    s_waitcnt lgkmcnt(4)
    v_mfma_f32_16x16x32_bf16 v[24:27], v[232:235], v[144:147], v[24:27]
    ds_read_b64_tr_b16 v[244:245], v5 offset:57632
    v_mfma_f32_16x16x32_bf16 v[28:31], v[232:235], v[148:151], v[28:31]
    ds_read_b64_tr_b16 v[246:247], v5 offset:58656
    s_waitcnt lgkmcnt(4)
    v_mfma_f32_16x16x32_bf16 v[32:35], v[236:239], v[144:147], v[32:35]
    ds_read_b64_tr_b16 v[224:225], v4 offset:57856
    v_mfma_f32_16x16x32_bf16 v[36:39], v[236:239], v[148:151], v[36:39]
    ds_read_b64_tr_b16 v[226:227], v4 offset:58880
    s_mov_b32 s23, 0x3000
    buffer_load_dwordx4 v[128:131], v7, s[8:11], s23 offen offset:1024 sc1
    s_waitcnt lgkmcnt(4)
    v_mfma_f32_16x16x32_bf16 v[40:43], v[240:243], v[144:147], v[40:43]
    ds_read_b64_tr_b16 v[228:229], v5 offset:57888
    v_mfma_f32_16x16x32_bf16 v[44:47], v[240:243], v[148:151], v[44:47]
    ds_read_b64_tr_b16 v[230:231], v5 offset:58912
    s_waitcnt lgkmcnt(4)
    v_mfma_f32_16x16x32_bf16 v[48:51], v[244:247], v[144:147], v[48:51]
    ds_read_b64_tr_b16 v[232:233], v4 offset:58112
    v_mfma_f32_16x16x32_bf16 v[52:55], v[244:247], v[148:151], v[52:55]
    ds_read_b64_tr_b16 v[234:235], v4 offset:59136
    s_waitcnt lgkmcnt(4)
    v_mfma_f32_16x16x32_bf16 v[56:59], v[224:227], v[144:147], v[56:59]
    ds_read_b64_tr_b16 v[236:237], v5 offset:58144
    v_mfma_f32_16x16x32_bf16 v[60:63], v[224:227], v[148:151], v[60:63]
    ds_read_b64_tr_b16 v[238:239], v5 offset:59168
    s_waitcnt lgkmcnt(4)
    v_mfma_f32_16x16x32_bf16 v[64:67], v[228:231], v[144:147], v[64:67]
    v_mfma_f32_16x16x32_bf16 v[68:71], v[228:231], v[148:151], v[68:71]
    s_waitcnt vmcnt(8)
    s_barrier
    ds_read_b64_tr_b16 v[240:241], v4 offset:0
    ds_read_b64_tr_b16 v[242:243], v4 offset:1024
    s_mov_b32 s23, 0xb000
    buffer_load_dwordx4 v[132:135], v7, s[8:11], s23 offen offset:1024 sc1
    s_waitcnt lgkmcnt(4)
    v_mfma_f32_16x16x32_bf16 v[72:75], v[232:235], v[144:147], v[72:75]
    ds_read_b64_tr_b16 v[244:245], v5 offset:32
    v_mfma_f32_16x16x32_bf16 v[76:79], v[232:235], v[148:151], v[76:79]
    s_add_u32 s22, s19, 0x300000
    s_add_u32 m0, s20, 0x8000
    s_nop 0
    buffer_load_dwordx4 v3, s[4:7], s22 offen lds
    ds_read_b64_tr_b16 v[246:247], v5 offset:1056
    s_waitcnt lgkmcnt(4)
    v_mfma_f32_16x16x32_bf16 v[80:83], v[236:239], v[144:147], v[80:83]
    ds_read_b64_tr_b16 v[224:225], v4 offset:256
    v_mfma_f32_16x16x32_bf16 v[84:87], v[236:239], v[148:151], v[84:87]
    ds_read_b64_tr_b16 v[226:227], v4 offset:1280
    s_waitcnt lgkmcnt(4)
    v_mfma_f32_16x16x32_bf16 v[24:27], v[240:243], v[88:91], v[24:27]
    ds_read_b64_tr_b16 v[228:229], v5 offset:288
    v_mfma_f32_16x16x32_bf16 v[28:31], v[240:243], v[92:95], v[28:31]
    ds_read_b64_tr_b16 v[230:231], v5 offset:1312
    s_waitcnt lgkmcnt(4)
    v_mfma_f32_16x16x32_bf16 v[32:35], v[244:247], v[88:91], v[32:35]
    ds_read_b64_tr_b16 v[232:233], v4 offset:512
    v_mfma_f32_16x16x32_bf16 v[36:39], v[244:247], v[92:95], v[36:39]
    ds_read_b64_tr_b16 v[234:235], v4 offset:1536
    s_mov_b32 s23, 0x3800
    buffer_load_dwordx4 v[136:139], v7, s[8:11], s23 offen offset:0 sc1
    s_waitcnt lgkmcnt(4)
    v_mfma_f32_16x16x32_bf16 v[40:43], v[224:227], v[88:91], v[40:43]
    ds_read_b64_tr_b16 v[236:237], v5 offset:544
    v_mfma_f32_16x16x32_bf16 v[44:47], v[224:227], v[92:95], v[44:47]
    s_add_u32 s22, s19, 0x308000
    s_add_u32 m0, s20, 0x8400
    s_nop 0
    buffer_load_dwordx4 v3, s[4:7], s22 offen lds
    ds_read_b64_tr_b16 v[238:239], v5 offset:1568
    s_waitcnt lgkmcnt(4)
    v_mfma_f32_16x16x32_bf16 v[48:51], v[228:231], v[88:91], v[48:51]
    ds_read_b64_tr_b16 v[240:241], v4 offset:768
    v_mfma_f32_16x16x32_bf16 v[52:55], v[228:231], v[92:95], v[52:55]
    ds_read_b64_tr_b16 v[242:243], v4 offset:1792
    s_waitcnt lgkmcnt(4)
    v_mfma_f32_16x16x32_bf16 v[56:59], v[232:235], v[88:91], v[56:59]
    ds_read_b64_tr_b16 v[244:245], v5 offset:800
    v_mfma_f32_16x16x32_bf16 v[60:63], v[232:235], v[92:95], v[60:63]
    ds_read_b64_tr_b16 v[246:247], v5 offset:1824
    s_waitcnt lgkmcnt(4)
    v_mfma_f32_16x16x32_bf16 v[64:67], v[236:239], v[88:91], v[64:67]
    ds_read_b64_tr_b16 v[224:225], v4 offset:8192
    v_mfma_f32_16x16x32_bf16 v[68:71], v[236:239], v[92:95], v[68:71]
    ds_read_b64_tr_b16 v[226:227], v4 offset:9216
    s_mov_b32 s23, 0xb800
    buffer_load_dwordx4 v[140:143], v7, s[8:11], s23 offen offset:0 sc1
    s_waitcnt lgkmcnt(4)
    v_mfma_f32_16x16x32_bf16 v[72:75], v[240:243], v[88:91], v[72:75]
    ds_read_b64_tr_b16 v[228:229], v5 offset:8224
    v_mfma_f32_16x16x32_bf16 v[76:79], v[240:243], v[92:95], v[76:79]
    ds_read_b64_tr_b16 v[230:231], v5 offset:9248
    s_waitcnt lgkmcnt(4)
    v_mfma_f32_16x16x32_bf16 v[80:83], v[244:247], v[88:91], v[80:83]
    ds_read_b64_tr_b16 v[232:233], v4 offset:8448
    v_mfma_f32_16x16x32_bf16 v[84:87], v[244:247], v[92:95], v[84:87]
    ds_read_b64_tr_b16 v[234:235], v4 offset:9472
    s_waitcnt lgkmcnt(4)
    v_mfma_f32_16x16x32_bf16 v[24:27], v[224:227], v[96:99], v[24:27]
    ds_read_b64_tr_b16 v[236:237], v5 offset:8480
    v_mfma_f32_16x16x32_bf16 v[28:31], v[224:227], v[100:103], v[28:31]
    ds_read_b64_tr_b16 v[238:239], v5 offset:9504
    s_waitcnt lgkmcnt(4)
    v_mfma_f32_16x16x32_bf16 v[32:35], v[228:231], v[96:99], v[32:35]
    ds_read_b64_tr_b16 v[240:241], v4 offset:8704
    v_mfma_f32_16x16x32_bf16 v[36:39], v[228:231], v[100:103], v[36:39]
    ds_read_b64_tr_b16 v[242:243], v4 offset:9728
    s_mov_b32 s23, 0x3800
    buffer_load_dwordx4 v[144:147], v7, s[8:11], s23 offen offset:1024 sc1
    s_waitcnt lgkmcnt(4)
    v_mfma_f32_16x16x32_bf16 v[40:43], v[232:235], v[96:99], v[40:43]
    ds_read_b64_tr_b16 v[244:245], v5 offset:8736
    v_mfma_f32_16x16x32_bf16 v[44:47], v[232:235], v[100:103], v[44:47]
    ds_read_b64_tr_b16 v[246:247], v5 offset:9760
    s_waitcnt lgkmcnt(4)
    v_mfma_f32_16x16x32_bf16 v[48:51], v[236:239], v[96:99], v[48:51]
    ds_read_b64_tr_b16 v[224:225], v4 offset:8960
    v_mfma_f32_16x16x32_bf16 v[52:55], v[236:239], v[100:103], v[52:55]
    ds_read_b64_tr_b16 v[226:227], v4 offset:9984
    s_waitcnt lgkmcnt(4)
    v_mfma_f32_16x16x32_bf16 v[56:59], v[240:243], v[96:99], v[56:59]
    ds_read_b64_tr_b16 v[228:229], v5 offset:8992
    v_mfma_f32_16x16x32_bf16 v[60:63], v[240:243], v[100:103], v[60:63]
    ds_read_b64_tr_b16 v[230:231], v5 offset:10016
    s_waitcnt lgkmcnt(4)
    v_mfma_f32_16x16x32_bf16 v[64:67], v[244:247], v[96:99], v[64:67]
    v_mfma_f32_16x16x32_bf16 v[68:71], v[244:247], v[100:103], v[68:71]
    s_waitcnt vmcnt(8)
    s_barrier
    ds_read_b64_tr_b16 v[232:233], v4 offset:16384
    ds_read_b64_tr_b16 v[234:235], v4 offset:17408
    s_mov_b32 s23, 0xb800
    buffer_load_dwordx4 v[148:151], v7, s[8:11], s23 offen offset:1024 sc1
    s_waitcnt lgkmcnt(4)
    v_mfma_f32_16x16x32_bf16 v[72:75], v[224:227], v[96:99], v[72:75]
    ds_read_b64_tr_b16 v[236:237], v5 offset:16416
    v_mfma_f32_16x16x32_bf16 v[76:79], v[224:227], v[100:103], v[76:79]
    s_add_u32 s22, s19, 0x380000
    s_add_u32 m0, s20, 0xc000
    s_nop 0
    buffer_load_dwordx4 v3, s[4:7], s22 offen lds
    ds_read_b64_tr_b16 v[238:239], v5 offset:17440
    s_waitcnt lgkmcnt(4)
    v_mfma_f32_16x16x32_bf16 v[80:83], v[228:231], v[96:99], v[80:83]
    ds_read_b64_tr_b16 v[240:241], v4 offset:16640
    v_mfma_f32_16x16x32_bf16 v[84:87], v[228:231], v[100:103], v[84:87]
    ds_read_b64_tr_b16 v[242:243], v4 offset:17664
    s_waitcnt lgkmcnt(4)
    v_mfma_f32_16x16x32_bf16 v[24:27], v[232:235], v[104:107], v[24:27]
    ds_read_b64_tr_b16 v[244:245], v5 offset:16672
    v_mfma_f32_16x16x32_bf16 v[28:31], v[232:235], v[108:111], v[28:31]
    ds_read_b64_tr_b16 v[246:247], v5 offset:17696
    s_waitcnt lgkmcnt(4)
    v_mfma_f32_16x16x32_bf16 v[32:35], v[236:239], v[104:107], v[32:35]
    ds_read_b64_tr_b16 v[224:225], v4 offset:16896
    v_mfma_f32_16x16x32_bf16 v[36:39], v[236:239], v[108:111], v[36:39]
    ds_read_b64_tr_b16 v[226:227], v4 offset:17920
    s_mov_b32 s23, 0x4000
    buffer_load_dwordx4 v[88:91], v7, s[8:11], s23 offen offset:0 sc1
    s_waitcnt lgkmcnt(4)
    v_mfma_f32_16x16x32_bf16 v[40:43], v[240:243], v[104:107], v[40:43]
    ds_read_b64_tr_b16 v[228:229], v5 offset:16928
    v_mfma_f32_16x16x32_bf16 v[44:47], v[240:243], v[108:111], v[44:47]
    s_add_u32 s22, s19, 0x388000
    s_add_u32 m0, s20, 0xc400
    s_nop 0
    buffer_load_dwordx4 v3, s[4:7], s22 offen lds
    ds_read_b64_tr_b16 v[230:231], v5 offset:17952
    s_waitcnt lgkmcnt(4)
    v_mfma_f32_16x16x32_bf16 v[48:51], v[244:247], v[104:107], v[48:51]
    ds_read_b64_tr_b16 v[232:233], v4 offset:17152
    v_mfma_f32_16x16x32_bf16 v[52:55], v[244:247], v[108:111], v[52:55]
    ds_read_b64_tr_b16 v[234:235], v4 offset:18176
    s_waitcnt lgkmcnt(4)
    v_mfma_f32_16x16x32_bf16 v[56:59], v[224:227], v[104:107], v[56:59]
    ds_read_b64_tr_b16 v[236:237], v5 offset:17184
    v_mfma_f32_16x16x32_bf16 v[60:63], v[224:227], v[108:111], v[60:63]
    ds_read_b64_tr_b16 v[238:239], v5 offset:18208
    s_waitcnt lgkmcnt(4)
    v_mfma_f32_16x16x32_bf16 v[64:67], v[228:231], v[104:107], v[64:67]
    ds_read_b64_tr_b16 v[240:241], v4 offset:24576
    v_mfma_f32_16x16x32_bf16 v[68:71], v[228:231], v[108:111], v[68:71]
    ds_read_b64_tr_b16 v[242:243], v4 offset:25600
    s_mov_b32 s23, 0xc000
    buffer_load_dwordx4 v[92:95], v7, s[8:11], s23 offen offset:0 sc1
    s_waitcnt lgkmcnt(4)
    v_mfma_f32_16x16x32_bf16 v[72:75], v[232:235], v[104:107], v[72:75]
    ds_read_b64_tr_b16 v[244:245], v5 offset:24608
    v_mfma_f32_16x16x32_bf16 v[76:79], v[232:235], v[108:111], v[76:79]
    ds_read_b64_tr_b16 v[246:247], v5 offset:25632
    s_waitcnt lgkmcnt(4)
    v_mfma_f32_16x16x32_bf16 v[80:83], v[236:239], v[104:107], v[80:83]
    ds_read_b64_tr_b16 v[224:225], v4 offset:24832
    v_mfma_f32_16x16x32_bf16 v[84:87], v[236:239], v[108:111], v[84:87]
    ds_read_b64_tr_b16 v[226:227], v4 offset:25856
    s_waitcnt lgkmcnt(4)
    v_mfma_f32_16x16x32_bf16 v[24:27], v[240:243], v[112:115], v[24:27]
    ds_read_b64_tr_b16 v[228:229], v5 offset:24864
    v_mfma_f32_16x16x32_bf16 v[28:31], v[240:243], v[116:119], v[28:31]
    ds_read_b64_tr_b16 v[230:231], v5 offset:25888
    s_waitcnt lgkmcnt(4)
    v_mfma_f32_16x16x32_bf16 v[32:35], v[244:247], v[112:115], v[32:35]
    ds_read_b64_tr_b16 v[232:233], v4 offset:25088
    v_mfma_f32_16x16x32_bf16 v[36:39], v[244:247], v[116:119], v[36:39]
    ds_read_b64_tr_b16 v[234:235], v4 offset:26112
    s_mov_b32 s23, 0x4000
    buffer_load_dwordx4 v[96:99], v7, s[8:11], s23 offen offset:1024 sc1
    s_waitcnt lgkmcnt(4)
    v_mfma_f32_16x16x32_bf16 v[40:43], v[224:227], v[112:115], v[40:43]
    ds_read_b64_tr_b16 v[236:237], v5 offset:25120
    v_mfma_f32_16x16x32_bf16 v[44:47], v[224:227], v[116:119], v[44:47]
    ds_read_b64_tr_b16 v[238:239], v5 offset:26144
    s_waitcnt lgkmcnt(4)
    v_mfma_f32_16x16x32_bf16 v[48:51], v[228:231], v[112:115], v[48:51]
    ds_read_b64_tr_b16 v[240:241], v4 offset:25344
    v_mfma_f32_16x16x32_bf16 v[52:55], v[228:231], v[116:119], v[52:55]
    ds_read_b64_tr_b16 v[242:243], v4 offset:26368
    s_waitcnt lgkmcnt(4)
    v_mfma_f32_16x16x32_bf16 v[56:59], v[232:235], v[112:115], v[56:59]
    ds_read_b64_tr_b16 v[244:245], v5 offset:25376
    v_mfma_f32_16x16x32_bf16 v[60:63], v[232:235], v[116:119], v[60:63]
    ds_read_b64_tr_b16 v[246:247], v5 offset:26400
    s_waitcnt lgkmcnt(4)
    v_mfma_f32_16x16x32_bf16 v[64:67], v[236:239], v[112:115], v[64:67]
    v_mfma_f32_16x16x32_bf16 v[68:71], v[236:239], v[116:119], v[68:71]
    s_waitcnt vmcnt(8)
    s_barrier
    ds_read_b64_tr_b16 v[224:225], v4 offset:32768
    ds_read_b64_tr_b16 v[226:227], v4 offset:33792
    s_mov_b32 s23, 0xc000
    buffer_load_dwordx4 v[100:103], v7, s[8:11], s23 offen offset:1024 sc1
    s_waitcnt lgkmcnt(4)
    v_mfma_f32_16x16x32_bf16 v[72:75], v[240:243], v[112:115], v[72:75]
    ds_read_b64_tr_b16 v[228:229], v5 offset:32800
    v_mfma_f32_16x16x32_bf16 v[76:79], v[240:243], v[116:119], v[76:79]
    s_add_u32 s22, s19, 0x400000
    s_add_u32 m0, s20, 0x0
    s_nop 0
    buffer_load_dwordx4 v3, s[4:7], s22 offen lds
    ds_read_b64_tr_b16 v[230:231], v5 offset:33824
    s_waitcnt lgkmcnt(4)
    v_mfma_f32_16x16x32_bf16 v[80:83], v[244:247], v[112:115], v[80:83]
    ds_read_b64_tr_b16 v[232:233], v4 offset:33024
    v_mfma_f32_16x16x32_bf16 v[84:87], v[244:247], v[116:119], v[84:87]
    ds_read_b64_tr_b16 v[234:235], v4 offset:34048
    s_waitcnt lgkmcnt(4)
    v_mfma_f32_16x16x32_bf16 v[24:27], v[224:227], v[120:123], v[24:27]
    ds_read_b64_tr_b16 v[236:237], v5 offset:33056
    v_mfma_f32_16x16x32_bf16 v[28:31], v[224:227], v[124:127], v[28:31]
    ds_read_b64_tr_b16 v[238:239], v5 offset:34080
    s_waitcnt lgkmcnt(4)
    v_mfma_f32_16x16x32_bf16 v[32:35], v[228:231], v[120:123], v[32:35]
    ds_read_b64_tr_b16 v[240:241], v4 offset:33280
    v_mfma_f32_16x16x32_bf16 v[36:39], v[228:231], v[124:127], v[36:39]
    ds_read_b64_tr_b16 v[242:243], v4 offset:34304
    s_mov_b32 s23, 0x4800
    buffer_load_dwordx4 v[104:107], v7, s[8:11], s23 offen offset:0 sc1
    s_waitcnt lgkmcnt(4)
    v_mfma_f32_16x16x32_bf16 v[40:43], v[232:235], v[120:123], v[40:43]
    ds_read_b64_tr_b16 v[244:245], v5 offset:33312
    v_mfma_f32_16x16x32_bf16 v[44:47], v[232:235], v[124:127], v[44:47]
    s_add_u32 s22, s19, 0x408000
    s_add_u32 m0, s20, 0x400
    s_nop 0
    buffer_load_dwordx4 v3, s[4:7], s22 offen lds
    ds_read_b64_tr_b16 v[246:247], v5 offset:34336
    s_waitcnt lgkmcnt(4)
    v_mfma_f32_16x16x32_bf16 v[48:51], v[236:239], v[120:123], v[48:51]
    ds_read_b64_tr_b16 v[224:225], v4 offset:33536
    v_mfma_f32_16x16x32_bf16 v[52:55], v[236:239], v[124:127], v[52:55]
    ds_read_b64_tr_b16 v[226:227], v4 offset:34560
    s_waitcnt lgkmcnt(4)
    v_mfma_f32_16x16x32_bf16 v[56:59], v[240:243], v[120:123], v[56:59]
    ds_read_b64_tr_b16 v[228:229], v5 offset:33568
    v_mfma_f32_16x16x32_bf16 v[60:63], v[240:243], v[124:127], v[60:63]
    ds_read_b64_tr_b16 v[230:231], v5 offset:34592
    s_waitcnt lgkmcnt(4)
    v_mfma_f32_16x16x32_bf16 v[64:67], v[244:247], v[120:123], v[64:67]
    ds_read_b64_tr_b16 v[232:233], v4 offset:40960
    v_mfma_f32_16x16x32_bf16 v[68:71], v[244:247], v[124:127], v[68:71]
    ds_read_b64_tr_b16 v[234:235], v4 offset:41984
    s_mov_b32 s23, 0xc800
    buffer_load_dwordx4 v[108:111], v7, s[8:11], s23 offen offset:0 sc1
    s_waitcnt lgkmcnt(4)
    v_mfma_f32_16x16x32_bf16 v[72:75], v[224:227], v[120:123], v[72:75]
    ds_read_b64_tr_b16 v[236:237], v5 offset:40992
    v_lshrrev_b32 v21, 4, v1
    v_lshlrev_b32 v21, 9, v21
    v_and_b32 v20, 15, v1
    v_lshl_add_u32 v21, v20, 4, v21
    s_lshr_b32 s18, s12, 3
    s_lshl_b32 s18, s18, 11
    s_add_u32 s18, s18, 0x528100
    buffer_load_dwordx4 v[12:15], v21, s[8:11], s18 offen sc1
    v_mfma_f32_16x16x32_bf16 v[76:79], v[224:227], v[124:127], v[76:79]
    ds_read_b64_tr_b16 v[238:239], v5 offset:42016
    s_waitcnt lgkmcnt(4)
    v_mfma_f32_16x16x32_bf16 v[80:83], v[228:231], v[120:123], v[80:83]
    ds_read_b64_tr_b16 v[240:241], v4 offset:41216
    v_mfma_f32_16x16x32_bf16 v[84:87], v[228:231], v[124:127], v[84:87]
    ds_read_b64_tr_b16 v[242:243], v4 offset:42240
    s_waitcnt lgkmcnt(4)
    v_mfma_f32_16x16x32_bf16 v[24:27], v[232:235], v[128:131], v[24:27]
    ds_read_b64_tr_b16 v[244:245], v5 offset:41248
    v_mfma_f32_16x16x32_bf16 v[28:31], v[232:235], v[132:135], v[28:31]
    ds_read_b64_tr_b16 v[246:247], v5 offset:42272
    s_waitcnt lgkmcnt(4)
    v_mfma_f32_16x16x32_bf16 v[32:35], v[236:239], v[128:131], v[32:35]
    ds_read_b64_tr_b16 v[224:225], v4 offset:41472
    v_mfma_f32_16x16x32_bf16 v[36:39], v[236:239], v[132:135], v[36:39]
    ds_read_b64_tr_b16 v[226:227], v4 offset:42496
    s_mov_b32 s23, 0x4800
    buffer_load_dwordx4 v[112:115], v7, s[8:11], s23 offen offset:1024 sc1
    s_waitcnt lgkmcnt(4)
    v_mfma_f32_16x16x32_bf16 v[40:43], v[240:243], v[128:131], v[40:43]
    ds_read_b64_tr_b16 v[228:229], v5 offset:41504
    v_mfma_f32_16x16x32_bf16 v[44:47], v[240:243], v[132:135], v[44:47]
    ds_read_b64_tr_b16 v[230:231], v5 offset:42528
    s_waitcnt lgkmcnt(4)
    v_mfma_f32_16x16x32_bf16 v[48:51], v[244:247], v[128:131], v[48:51]
    ds_read_b64_tr_b16 v[232:233], v4 offset:41728
    v_mfma_f32_16x16x32_bf16 v[52:55], v[244:247], v[132:135], v[52:55]
    ds_read_b64_tr_b16 v[234:235], v4 offset:42752
    s_waitcnt lgkmcnt(4)
    v_mfma_f32_16x16x32_bf16 v[56:59], v[224:227], v[128:131], v[56:59]
    ds_read_b64_tr_b16 v[236:237], v5 offset:41760
    v_mfma_f32_16x16x32_bf16 v[60:63], v[224:227], v[132:135], v[60:63]
    ds_read_b64_tr_b16 v[238:239], v5 offset:42784
    s_waitcnt lgkmcnt(4)
    v_mfma_f32_16x16x32_bf16 v[64:67], v[228:231], v[128:131], v[64:67]
    v_mfma_f32_16x16x32_bf16 v[68:71], v[228:231], v[132:135], v[68:71]
    s_waitcnt vmcnt(9)
    s_barrier
    ds_read_b64_tr_b16 v[240:241], v4 offset:49152
    ds_read_b64_tr_b16 v[242:243], v4 offset:50176
    s_mov_b32 s23, 0xc800
    buffer_load_dwordx4 v[116:119], v7, s[8:11], s23 offen offset:1024 sc1
    s_waitcnt lgkmcnt(4)
    v_mfma_f32_16x16x32_bf16 v[72:75], v[232:235], v[128:131], v[72:75]
    ds_read_b64_tr_b16 v[244:245], v5 offset:49184
    v_mfma_f32_16x16x32_bf16 v[76:79], v[232:235], v[132:135], v[76:79]
    s_add_u32 s22, s19, 0x480000
    s_add_u32 m0, s20, 0x4000
    s_nop 0
    buffer_load_dwordx4 v3, s[4:7], s22 offen lds
    ds_read_b64_tr_b16 v[246:247], v5 offset:50208
    s_waitcnt lgkmcnt(4)
    v_mfma_f32_16x16x32_bf16 v[80:83], v[236:239], v[128:131], v[80:83]
    ds_read_b64_tr_b16 v[224:225], v4 offset:49408
    v_mfma_f32_16x16x32_bf16 v[84:87], v[236:239], v[132:135], v[84:87]
    ds_read_b64_tr_b16 v[226:227], v4 offset:50432
    s_waitcnt lgkmcnt(4)
    v_mfma_f32_16x16x32_bf16 v[24:27], v[240:243], v[136:139], v[24:27]
    ds_read_b64_tr_b16 v[228:229], v5 offset:49440
    v_mfma_f32_16x16x32_bf16 v[28:31], v[240:243], v[140:143], v[28:31]
    ds_read_b64_tr_b16 v[230:231], v5 offset:50464
    s_waitcnt lgkmcnt(4)
    v_mfma_f32_16x16x32_bf16 v[32:35], v[244:247], v[136:139], v[32:35]
    ds_read_b64_tr_b16 v[232:233], v4 offset:49664
    v_mfma_f32_16x16x32_bf16 v[36:39], v[244:247], v[140:143], v[36:39]
    ds_read_b64_tr_b16 v[234:235], v4 offset:50688
    s_mov_b32 s23, 0x5000
    buffer_load_dwordx4 v[120:123], v7, s[8:11], s23 offen offset:0 sc1
    s_waitcnt lgkmcnt(4)
    v_mfma_f32_16x16x32_bf16 v[40:43], v[224:227], v[136:139], v[40:43]
    ds_read_b64_tr_b16 v[236:237], v5 offset:49696
    v_mfma_f32_16x16x32_bf16 v[44:47], v[224:227], v[140:143], v[44:47]
    s_add_u32 s22, s19, 0x488000
    s_add_u32 m0, s20, 0x4400
    s_nop 0
    buffer_load_dwordx4 v3, s[4:7], s22 offen lds
    ds_read_b64_tr_b16 v[238:239], v5 offset:50720
    s_waitcnt lgkmcnt(4)
    v_mfma_f32_16x16x32_bf16 v[48:51], v[228:231], v[136:139], v[48:51]
    ds_read_b64_tr_b16 v[240:241], v4 offset:49920
    v_mfma_f32_16x16x32_bf16 v[52:55], v[228:231], v[140:143], v[52:55]
    ds_read_b64_tr_b16 v[242:243], v4 offset:50944
    s_waitcnt lgkmcnt(4)
    v_mfma_f32_16x16x32_bf16 v[56:59], v[232:235], v[136:139], v[56:59]
    ds_read_b64_tr_b16 v[244:245], v5 offset:49952
    v_mfma_f32_16x16x32_bf16 v[60:63], v[232:235], v[140:143], v[60:63]
    ds_read_b64_tr_b16 v[246:247], v5 offset:50976
    s_waitcnt lgkmcnt(4)
    v_mfma_f32_16x16x32_bf16 v[64:67], v[236:239], v[136:139], v[64:67]
    ds_read_b64_tr_b16 v[224:225], v4 offset:57344
    v_mfma_f32_16x16x32_bf16 v[68:71], v[236:239], v[140:143], v[68:71]
    ds_read_b64_tr_b16 v[226:227], v4 offset:58368
    s_mov_b32 s23, 0xd000
    buffer_load_dwordx4 v[124:127], v7, s[8:11], s23 offen offset:0 sc1
    s_waitcnt lgkmcnt(4)
    v_mfma_f32_16x16x32_bf16 v[72:75], v[240:243], v[136:139], v[72:75]
    ds_read_b64_tr_b16 v[228:229], v5 offset:57376
    v_mfma_f32_16x16x32_bf16 v[76:79], v[240:243], v[140:143], v[76:79]
    ds_read_b64_tr_b16 v[230:231], v5 offset:58400
    s_waitcnt lgkmcnt(4)
    v_mfma_f32_16x16x32_bf16 v[80:83], v[244:247], v[136:139], v[80:83]
    ds_read_b64_tr_b16 v[232:233], v4 offset:57600
    v_mfma_f32_16x16x32_bf16 v[84:87], v[244:247], v[140:143], v[84:87]
    ds_read_b64_tr_b16 v[234:235], v4 offset:58624
    s_waitcnt lgkmcnt(4)
    v_mfma_f32_16x16x32_bf16 v[24:27], v[224:227], v[144:147], v[24:27]
    ds_read_b64_tr_b16 v[236:237], v5 offset:57632
    v_mfma_f32_16x16x32_bf16 v[28:31], v[224:227], v[148:151], v[28:31]
    ds_read_b64_tr_b16 v[238:239], v5 offset:58656
    s_waitcnt lgkmcnt(4)
    v_mfma_f32_16x16x32_bf16 v[32:35], v[228:231], v[144:147], v[32:35]
    ds_read_b64_tr_b16 v[240:241], v4 offset:57856
    v_mfma_f32_16x16x32_bf16 v[36:39], v[228:231], v[148:151], v[36:39]
    ds_read_b64_tr_b16 v[242:243], v4 offset:58880
    s_mov_b32 s23, 0x5000
    buffer_load_dwordx4 v[128:131], v7, s[8:11], s23 offen offset:1024 sc1
    s_waitcnt lgkmcnt(4)
    v_mfma_f32_16x16x32_bf16 v[40:43], v[232:235], v[144:147], v[40:43]
    ds_read_b64_tr_b16 v[244:245], v5 offset:57888
    v_mfma_f32_16x16x32_bf16 v[44:47], v[232:235], v[148:151], v[44:47]
    ds_read_b64_tr_b16 v[246:247], v5 offset:58912
    s_waitcnt lgkmcnt(4)
    v_mfma_f32_16x16x32_bf16 v[48:51], v[236:239], v[144:147], v[48:51]
    ds_read_b64_tr_b16 v[224:225], v4 offset:58112
    v_mfma_f32_16x16x32_bf16 v[52:55], v[236:239], v[148:151], v[52:55]
    ds_read_b64_tr_b16 v[226:227], v4 offset:59136
    s_waitcnt lgkmcnt(4)
    v_mfma_f32_16x16x32_bf16 v[56:59], v[240:243], v[144:147], v[56:59]
    ds_read_b64_tr_b16 v[228:229], v5 offset:58144
    v_mfma_f32_16x16x32_bf16 v[60:63], v[240:243], v[148:151], v[60:63]
    ds_read_b64_tr_b16 v[230:231], v5 offset:59168
    s_waitcnt lgkmcnt(4)
    v_mfma_f32_16x16x32_bf16 v[64:67], v[244:247], v[144:147], v[64:67]
    v_mfma_f32_16x16x32_bf16 v[68:71], v[244:247], v[148:151], v[68:71]
    s_waitcnt vmcnt(9)
    s_barrier
    ds_read_b64_tr_b16 v[232:233], v4 offset:0
    ds_read_b64_tr_b16 v[234:235], v4 offset:1024
    s_mov_b32 s23, 0xd000
    buffer_load_dwordx4 v[132:135], v7, s[8:11], s23 offen offset:1024 sc1
    s_waitcnt lgkmcnt(4)
    v_mfma_f32_16x16x32_bf16 v[72:75], v[224:227], v[144:147], v[72:75]
    ds_read_b64_tr_b16 v[236:237], v5 offset:32
    v_mfma_f32_16x16x32_bf16 v[76:79], v[224:227], v[148:151], v[76:79]
    s_add_u32 s22, s19, 0x500000
    s_add_u32 m0, s20, 0x8000
    s_nop 0
    buffer_load_dwordx4 v3, s[4:7], s22 offen lds
    ds_read_b64_tr_b16 v[238:239], v5 offset:1056
    s_waitcnt lgkmcnt(4)
    v_mfma_f32_16x16x32_bf16 v[80:83], v[228:231], v[144:147], v[80:83]
    ds_read_b64_tr_b16 v[240:241], v4 offset:256
    v_mfma_f32_16x16x32_bf16 v[84:87], v[228:231], v[148:151], v[84:87]
    ds_read_b64_tr_b16 v[242:243], v4 offset:1280
    s_waitcnt lgkmcnt(4)
    v_mfma_f32_16x16x32_bf16 v[24:27], v[232:235], v[88:91], v[24:27]
    ds_read_b64_tr_b16 v[244:245], v5 offset:288
    v_mfma_f32_16x16x32_bf16 v[28:31], v[232:235], v[92:95], v[28:31]
    ds_read_b64_tr_b16 v[246:247], v5 offset:1312
    s_waitcnt lgkmcnt(4)
    v_mfma_f32_16x16x32_bf16 v[32:35], v[236:239], v[88:91], v[32:35]
    ds_read_b64_tr_b16 v[224:225], v4 offset:512
    v_mfma_f32_16x16x32_bf16 v[36:39], v[236:239], v[92:95], v[36:39]
    ds_read_b64_tr_b16 v[226:227], v4 offset:1536
    s_mov_b32 s23, 0x5800
    buffer_load_dwordx4 v[136:139], v7, s[8:11], s23 offen offset:0 sc1
    s_waitcnt lgkmcnt(4)
    v_mfma_f32_16x16x32_bf16 v[40:43], v[240:243], v[88:91], v[40:43]
    ds_read_b64_tr_b16 v[228:229], v5 offset:544
    v_mfma_f32_16x16x32_bf16 v[44:47], v[240:243], v[92:95], v[44:47]
    s_add_u32 s22, s19, 0x508000
    s_add_u32 m0, s20, 0x8400
    s_nop 0
    buffer_load_dwordx4 v3, s[4:7], s22 offen lds
    ds_read_b64_tr_b16 v[230:231], v5 offset:1568
    s_waitcnt lgkmcnt(4)
    v_mfma_f32_16x16x32_bf16 v[48:51], v[244:247], v[88:91], v[48:51]
    ds_read_b64_tr_b16 v[232:233], v4 offset:768
    v_mfma_f32_16x16x32_bf16 v[52:55], v[244:247], v[92:95], v[52:55]
    ds_read_b64_tr_b16 v[234:235], v4 offset:1792
    s_waitcnt lgkmcnt(4)
    v_mfma_f32_16x16x32_bf16 v[56:59], v[224:227], v[88:91], v[56:59]
    ds_read_b64_tr_b16 v[236:237], v5 offset:800
    v_mfma_f32_16x16x32_bf16 v[60:63], v[224:227], v[92:95], v[60:63]
    ds_read_b64_tr_b16 v[238:239], v5 offset:1824
    s_waitcnt lgkmcnt(4)
    v_mfma_f32_16x16x32_bf16 v[64:67], v[228:231], v[88:91], v[64:67]
    ds_read_b64_tr_b16 v[240:241], v4 offset:8192
    v_mfma_f32_16x16x32_bf16 v[68:71], v[228:231], v[92:95], v[68:71]
    ds_read_b64_tr_b16 v[242:243], v4 offset:9216
    s_mov_b32 s23, 0xd800
    buffer_load_dwordx4 v[140:143], v7, s[8:11], s23 offen offset:0 sc1
    s_waitcnt lgkmcnt(4)
    v_mfma_f32_16x16x32_bf16 v[72:75], v[232:235], v[88:91], v[72:75]
    ds_read_b64_tr_b16 v[244:245], v5 offset:8224
    v_mfma_f32_16x16x32_bf16 v[76:79], v[232:235], v[92:95], v[76:79]
    ds_read_b64_tr_b16 v[246:247], v5 offset:9248
    s_waitcnt lgkmcnt(4)
    v_mfma_f32_16x16x32_bf16 v[80:83], v[236:239], v[88:91], v[80:83]
    ds_read_b64_tr_b16 v[224:225], v4 offset:8448
    v_mfma_f32_16x16x32_bf16 v[84:87], v[236:239], v[92:95], v[84:87]
    ds_read_b64_tr_b16 v[226:227], v4 offset:9472
    s_waitcnt lgkmcnt(4)
    v_mfma_f32_16x16x32_bf16 v[24:27], v[240:243], v[96:99], v[24:27]
    ds_read_b64_tr_b16 v[228:229], v5 offset:8480
    v_mfma_f32_16x16x32_bf16 v[28:31], v[240:243], v[100:103], v[28:31]
    ds_read_b64_tr_b16 v[230:231], v5 offset:9504
    s_waitcnt lgkmcnt(4)
    v_mfma_f32_16x16x32_bf16 v[32:35], v[244:247], v[96:99], v[32:35]
    ds_read_b64_tr_b16 v[232:233], v4 offset:8704
    v_mfma_f32_16x16x32_bf16 v[36:39], v[244:247], v[100:103], v[36:39]
    ds_read_b64_tr_b16 v[234:235], v4 offset:9728
    s_mov_b32 s23, 0x5800
    buffer_load_dwordx4 v[144:147], v7, s[8:11], s23 offen offset:1024 sc1
    s_waitcnt lgkmcnt(4)
    v_mfma_f32_16x16x32_bf16 v[40:43], v[224:227], v[96:99], v[40:43]
    ds_read_b64_tr_b16 v[236:237], v5 offset:8736
    v_mfma_f32_16x16x32_bf16 v[44:47], v[224:227], v[100:103], v[44:47]
    ds_read_b64_tr_b16 v[238:239], v5 offset:9760
    s_waitcnt lgkmcnt(4)
    v_mfma_f32_16x16x32_bf16 v[48:51], v[228:231], v[96:99], v[48:51]
    ds_read_b64_tr_b16 v[240:241], v4 offset:8960
    v_mfma_f32_16x16x32_bf16 v[52:55], v[228:231], v[100:103], v[52:55]
    ds_read_b64_tr_b16 v[242:243], v4 offset:9984
    s_waitcnt lgkmcnt(4)
    v_mfma_f32_16x16x32_bf16 v[56:59], v[232:235], v[96:99], v[56:59]
    ds_read_b64_tr_b16 v[244:245], v5 offset:8992
    v_mfma_f32_16x16x32_bf16 v[60:63], v[232:235], v[100:103], v[60:63]
    ds_read_b64_tr_b16 v[246:247], v5 offset:10016
    s_waitcnt lgkmcnt(4)
    v_mfma_f32_16x16x32_bf16 v[64:67], v[236:239], v[96:99], v[64:67]
    v_mfma_f32_16x16x32_bf16 v[68:71], v[236:239], v[100:103], v[68:71]
    s_waitcnt vmcnt(8)
    s_barrier
    ds_read_b64_tr_b16 v[224:225], v4 offset:16384
    ds_read_b64_tr_b16 v[226:227], v4 offset:17408
    s_mov_b32 s23, 0xd800
    buffer_load_dwordx4 v[148:151], v7, s[8:11], s23 offen offset:1024 sc1
    s_waitcnt lgkmcnt(4)
    v_mfma_f32_16x16x32_bf16 v[72:75], v[240:243], v[96:99], v[72:75]
    ds_read_b64_tr_b16 v[228:229], v5 offset:16416
    v_mfma_f32_16x16x32_bf16 v[76:79], v[240:243], v[100:103], v[76:79]
    s_add_u32 s22, s19, 0x580000
    s_add_u32 m0, s20, 0xc000
    s_nop 0
    buffer_load_dwordx4 v3, s[4:7], s22 offen lds
    ds_read_b64_tr_b16 v[230:231], v5 offset:17440
    s_waitcnt lgkmcnt(4)
    v_mfma_f32_16x16x32_bf16 v[80:83], v[244:247], v[96:99], v[80:83]
    ds_read_b64_tr_b16 v[232:233], v4 offset:16640
    v_mfma_f32_16x16x32_bf16 v[84:87], v[244:247], v[100:103], v[84:87]
    ds_read_b64_tr_b16 v[234:235], v4 offset:17664
    s_waitcnt lgkmcnt(4)
    v_mfma_f32_16x16x32_bf16 v[24:27], v[224:227], v[104:107], v[24:27]
    ds_read_b64_tr_b16 v[236:237], v5 offset:16672
    v_mfma_f32_16x16x32_bf16 v[28:31], v[224:227], v[108:111], v[28:31]
    ds_read_b64_tr_b16 v[238:239], v5 offset:17696
    s_waitcnt lgkmcnt(4)
    v_mfma_f32_16x16x32_bf16 v[32:35], v[228:231], v[104:107], v[32:35]
    ds_read_b64_tr_b16 v[240:241], v4 offset:16896
    v_mfma_f32_16x16x32_bf16 v[36:39], v[228:231], v[108:111], v[36:39]
    ds_read_b64_tr_b16 v[242:243], v4 offset:17920
    s_mov_b32 s23, 0x6000
    buffer_load_dwordx4 v[88:91], v7, s[8:11], s23 offen offset:0 sc1
    s_waitcnt lgkmcnt(4)
    v_mfma_f32_16x16x32_bf16 v[40:43], v[232:235], v[104:107], v[40:43]
    ds_read_b64_tr_b16 v[244:245], v5 offset:16928
    v_mfma_f32_16x16x32_bf16 v[44:47], v[232:235], v[108:111], v[44:47]
    s_add_u32 s22, s19, 0x588000
    s_add_u32 m0, s20, 0xc400
    s_nop 0
    buffer_load_dwordx4 v3, s[4:7], s22 offen lds
    ds_read_b64_tr_b16 v[246:247], v5 offset:17952
    s_waitcnt lgkmcnt(4)
    v_mfma_f32_16x16x32_bf16 v[48:51], v[236:239], v[104:107], v[48:51]
    ds_read_b64_tr_b16 v[224:225], v4 offset:17152
    v_mfma_f32_16x16x32_bf16 v[52:55], v[236:239], v[108:111], v[52:55]
    ds_read_b64_tr_b16 v[226:227], v4 offset:18176
    s_waitcnt lgkmcnt(4)
    v_mfma_f32_16x16x32_bf16 v[56:59], v[240:243], v[104:107], v[56:59]
    ds_read_b64_tr_b16 v[228:229], v5 offset:17184
    v_mfma_f32_16x16x32_bf16 v[60:63], v[240:243], v[108:111], v[60:63]
    ds_read_b64_tr_b16 v[230:231], v5 offset:18208
    s_waitcnt lgkmcnt(4)
    v_mfma_f32_16x16x32_bf16 v[64:67], v[244:247], v[104:107], v[64:67]
    ds_read_b64_tr_b16 v[232:233], v4 offset:24576
    v_mfma_f32_16x16x32_bf16 v[68:71], v[244:247], v[108:111], v[68:71]
    ds_read_b64_tr_b16 v[234:235], v4 offset:25600
    s_mov_b32 s23, 0xe000
    buffer_load_dwordx4 v[92:95], v7, s[8:11], s23 offen offset:0 sc1
    s_waitcnt lgkmcnt(4)
    v_mfma_f32_16x16x32_bf16 v[72:75], v[224:227], v[104:107], v[72:75]
    ds_read_b64_tr_b16 v[236:237], v5 offset:24608
    v_xor_b32 v8, s28, v12
    v_xor_b32 v20, s28, v13
    v_or_b32 v8, v8, v20
    v_xor_b32 v20, s28, v14
    v_or_b32 v8, v8, v20
    v_xor_b32 v20, s28, v15
    v_or_b32 v8, v8, v20
    v_cmp_ne_u32 vcc, 0, v8
    s_cbranch_vccnz adaLN_cond__sliding_block_cached__moe_arch_mod__prompt_kernel_kv16r
adaLN_cond__sliding_block_cached__moe_arch_mod__prompt_kernel_kv16b:
    v_mfma_f32_16x16x32_bf16 v[76:79], v[224:227], v[108:111], v[76:79]
    ds_read_b64_tr_b16 v[238:239], v5 offset:25632
    v_mov_b32 v20, 0
    s_mov_b32 s16, 0x564000
    buffer_load_dword v8, v20, s[8:11], s16 offen sc1
    s_waitcnt lgkmcnt(4)
    v_mfma_f32_16x16x32_bf16 v[80:83], v[228:231], v[104:107], v[80:83]
    ds_read_b64_tr_b16 v[240:241], v4 offset:24832
    v_mfma_f32_16x16x32_bf16 v[84:87], v[228:231], v[108:111], v[84:87]
    ds_read_b64_tr_b16 v[242:243], v4 offset:25856
    s_waitcnt lgkmcnt(4)
    v_mfma_f32_16x16x32_bf16 v[24:27], v[232:235], v[112:115], v[24:27]
    ds_read_b64_tr_b16 v[244:245], v5 offset:24864
    v_mfma_f32_16x16x32_bf16 v[28:31], v[232:235], v[116:119], v[28:31]
    ds_read_b64_tr_b16 v[246:247], v5 offset:25888
    s_waitcnt lgkmcnt(4)
    v_mfma_f32_16x16x32_bf16 v[32:35], v[236:239], v[112:115], v[32:35]
    ds_read_b64_tr_b16 v[224:225], v4 offset:25088
    v_mfma_f32_16x16x32_bf16 v[36:39], v[236:239], v[116:119], v[36:39]
    ds_read_b64_tr_b16 v[226:227], v4 offset:26112
    s_mov_b32 s23, 0x6000
    buffer_load_dwordx4 v[96:99], v7, s[8:11], s23 offen offset:1024 sc1
    s_waitcnt lgkmcnt(4)
    v_mfma_f32_16x16x32_bf16 v[40:43], v[240:243], v[112:115], v[40:43]
    ds_read_b64_tr_b16 v[228:229], v5 offset:25120
    v_mfma_f32_16x16x32_bf16 v[44:47], v[240:243], v[116:119], v[44:47]
    ds_read_b64_tr_b16 v[230:231], v5 offset:26144
    s_waitcnt lgkmcnt(4)
    v_mfma_f32_16x16x32_bf16 v[48:51], v[244:247], v[112:115], v[48:51]
    ds_read_b64_tr_b16 v[232:233], v4 offset:25344
    v_mfma_f32_16x16x32_bf16 v[52:55], v[244:247], v[116:119], v[52:55]
    ds_read_b64_tr_b16 v[234:235], v4 offset:26368
    s_waitcnt lgkmcnt(4)
    v_mfma_f32_16x16x32_bf16 v[56:59], v[224:227], v[112:115], v[56:59]
    ds_read_b64_tr_b16 v[236:237], v5 offset:25376
    v_mfma_f32_16x16x32_bf16 v[60:63], v[224:227], v[116:119], v[60:63]
    ds_read_b64_tr_b16 v[238:239], v5 offset:26400
    s_waitcnt lgkmcnt(4)
    v_mfma_f32_16x16x32_bf16 v[64:67], v[228:231], v[112:115], v[64:67]
    v_mfma_f32_16x16x32_bf16 v[68:71], v[228:231], v[116:119], v[68:71]
    s_waitcnt vmcnt(9)
    s_barrier
    ds_read_b64_tr_b16 v[240:241], v4 offset:32768
    ds_read_b64_tr_b16 v[242:243], v4 offset:33792
    s_mov_b32 s23, 0xe000
    buffer_load_dwordx4 v[100:103], v7, s[8:11], s23 offen offset:1024 sc1
    s_waitcnt lgkmcnt(4)
    v_mfma_f32_16x16x32_bf16 v[72:75], v[232:235], v[112:115], v[72:75]
    ds_read_b64_tr_b16 v[244:245], v5 offset:32800
    v_mfma_f32_16x16x32_bf16 v[76:79], v[232:235], v[116:119], v[76:79]
    s_add_u32 s22, s19, 0x600000
    s_add_u32 m0, s20, 0x0
    s_nop 0
    buffer_load_dwordx4 v3, s[4:7], s22 offen lds
    ds_read_b64_tr_b16 v[246:247], v5 offset:33824
    s_waitcnt lgkmcnt(4)
    v_mfma_f32_16x16x32_bf16 v[80:83], v[236:239], v[112:115], v[80:83]
    ds_read_b64_tr_b16 v[224:225], v4 offset:33024
    v_mfma_f32_16x16x32_bf16 v[84:87], v[236:239], v[116:119], v[84:87]
    ds_read_b64_tr_b16 v[226:227], v4 offset:34048
    s_waitcnt lgkmcnt(4)
    v_mfma_f32_16x16x32_bf16 v[24:27], v[240:243], v[120:123], v[24:27]
    ds_read_b64_tr_b16 v[228:229], v5 offset:33056
    v_mfma_f32_16x16x32_bf16 v[28:31], v[240:243], v[124:127], v[28:31]
    ds_read_b64_tr_b16 v[230:231], v5 offset:34080
    s_waitcnt lgkmcnt(4)
    v_mfma_f32_16x16x32_bf16 v[32:35], v[244:247], v[120:123], v[32:35]
    ds_read_b64_tr_b16 v[232:233], v4 offset:33280
    v_mfma_f32_16x16x32_bf16 v[36:39], v[244:247], v[124:127], v[36:39]
    ds_read_b64_tr_b16 v[234:235], v4 offset:34304
    s_mov_b32 s23, 0x6800
    buffer_load_dwordx4 v[104:107], v7, s[8:11], s23 offen offset:0 sc1
    s_waitcnt lgkmcnt(4)
    v_mfma_f32_16x16x32_bf16 v[40:43], v[224:227], v[120:123], v[40:43]
    ds_read_b64_tr_b16 v[236:237], v5 offset:33312
    v_mfma_f32_16x16x32_bf16 v[44:47], v[224:227], v[124:127], v[44:47]
    s_add_u32 s22, s19, 0x608000
    s_add_u32 m0, s20, 0x400
    s_nop 0
    buffer_load_dwordx4 v3, s[4:7], s22 offen lds
    ds_read_b64_tr_b16 v[238:239], v5 offset:34336
    s_waitcnt lgkmcnt(4)
    v_mfma_f32_16x16x32_bf16 v[48:51], v[228:231], v[120:123], v[48:51]
    ds_read_b64_tr_b16 v[240:241], v4 offset:33536
    v_mfma_f32_16x16x32_bf16 v[52:55], v[228:231], v[124:127], v[52:55]
    ds_read_b64_tr_b16 v[242:243], v4 offset:34560
    s_waitcnt lgkmcnt(4)
    v_mfma_f32_16x16x32_bf16 v[56:59], v[232:235], v[120:123], v[56:59]
    ds_read_b64_tr_b16 v[244:245], v5 offset:33568
    v_mfma_f32_16x16x32_bf16 v[60:63], v[232:235], v[124:127], v[60:63]
    ds_read_b64_tr_b16 v[246:247], v5 offset:34592
    s_waitcnt lgkmcnt(4)
    v_mfma_f32_16x16x32_bf16 v[64:67], v[236:239], v[120:123], v[64:67]
    ds_read_b64_tr_b16 v[224:225], v4 offset:40960
    v_mfma_f32_16x16x32_bf16 v[68:71], v[236:239], v[124:127], v[68:71]
    ds_read_b64_tr_b16 v[226:227], v4 offset:41984
    s_mov_b32 s23, 0xe800
    buffer_load_dwordx4 v[108:111], v7, s[8:11], s23 offen offset:0 sc1
    s_waitcnt lgkmcnt(4)
    v_mfma_f32_16x16x32_bf16 v[72:75], v[240:243], v[120:123], v[72:75]
    ds_read_b64_tr_b16 v[228:229], v5 offset:40992
    v_mfma_f32_16x16x32_bf16 v[76:79], v[240:243], v[124:127], v[76:79]
    ds_read_b64_tr_b16 v[230:231], v5 offset:42016
    s_waitcnt lgkmcnt(4)
    v_mfma_f32_16x16x32_bf16 v[80:83], v[244:247], v[120:123], v[80:83]
    ds_read_b64_tr_b16 v[232:233], v4 offset:41216
    v_mfma_f32_16x16x32_bf16 v[84:87], v[244:247], v[124:127], v[84:87]
    ds_read_b64_tr_b16 v[234:235], v4 offset:42240
    s_waitcnt lgkmcnt(4)
    v_mfma_f32_16x16x32_bf16 v[24:27], v[224:227], v[128:131], v[24:27]
    ds_read_b64_tr_b16 v[236:237], v5 offset:41248
    s_add_u32 s22, s21, 0x0
    s_add_u32 m0, s20, 0x10000
    s_nop 0
    buffer_load_dwordx4 v2, s[8:11], s22 offen sc1 lds
    v_mfma_f32_16x16x32_bf16 v[28:31], v[224:227], v[132:135], v[28:31]
    ds_read_b64_tr_b16 v[238:239], v5 offset:42272
    s_waitcnt lgkmcnt(4)
    v_mfma_f32_16x16x32_bf16 v[32:35], v[228:231], v[128:131], v[32:35]
    ds_read_b64_tr_b16 v[240:241], v4 offset:41472
    v_mfma_f32_16x16x32_bf16 v[36:39], v[228:231], v[132:135], v[36:39]
    ds_read_b64_tr_b16 v[242:243], v4 offset:42496
    s_mov_b32 s23, 0x6800
    buffer_load_dwordx4 v[112:115], v7, s[8:11], s23 offen offset:1024 sc1
    s_waitcnt lgkmcnt(4)
    v_mfma_f32_16x16x32_bf16 v[40:43], v[232:235], v[128:131], v[40:43]
    ds_read_b64_tr_b16 v[244:245], v5 offset:41504
    s_add_u32 s22, s21, 0x400
    s_add_u32 m0, s20, 0x10400
    s_nop 0
    buffer_load_dwordx4 v2, s[8:11], s22 offen sc1 lds
    v_mfma_f32_16x16x32_bf16 v[44:47], v[232:235], v[132:135], v[44:47]
    ds_read_b64_tr_b16 v[246:247], v5 offset:42528
    s_waitcnt lgkmcnt(4)
    v_mfma_f32_16x16x32_bf16 v[48:51], v[236:239], v[128:131], v[48:51]
    ds_read_b64_tr_b16 v[224:225], v4 offset:41728
    v_mfma_f32_16x16x32_bf16 v[52:55], v[236:239], v[132:135], v[52:55]
    ds_read_b64_tr_b16 v[226:227], v4 offset:42752
    s_waitcnt lgkmcnt(4)
    v_mfma_f32_16x16x32_bf16 v[56:59], v[240:243], v[128:131], v[56:59]
    ds_read_b64_tr_b16 v[228:229], v5 offset:41760
    v_mfma_f32_16x16x32_bf16 v[60:63], v[240:243], v[132:135], v[60:63]
    ds_read_b64_tr_b16 v[230:231], v5 offset:42784
    s_waitcnt lgkmcnt(4)
    v_mfma_f32_16x16x32_bf16 v[64:67], v[244:247], v[128:131], v[64:67]
    v_mfma_f32_16x16x32_bf16 v[68:71], v[244:247], v[132:135], v[68:71]
    s_waitcnt vmcnt(11)
    s_barrier
    ds_read_b64_tr_b16 v[232:233], v4 offset:49152
    ds_read_b64_tr_b16 v[234:235], v4 offset:50176
    s_mov_b32 s23, 0xe800
    buffer_load_dwordx4 v[116:119], v7, s[8:11], s23 offen offset:1024 sc1
    s_waitcnt lgkmcnt(4)
    v_mfma_f32_16x16x32_bf16 v[72:75], v[224:227], v[128:131], v[72:75]
    ds_read_b64_tr_b16 v[236:237], v5 offset:49184
    v_mfma_f32_16x16x32_bf16 v[76:79], v[224:227], v[132:135], v[76:79]
    s_add_u32 s22, s19, 0x680000
    s_add_u32 m0, s20, 0x4000
    s_nop 0
    buffer_load_dwordx4 v3, s[4:7], s22 offen lds
    ds_read_b64_tr_b16 v[238:239], v5 offset:50208
    s_waitcnt lgkmcnt(4)
    v_mfma_f32_16x16x32_bf16 v[80:83], v[228:231], v[128:131], v[80:83]
    ds_read_b64_tr_b16 v[240:241], v4 offset:49408
    v_mfma_f32_16x16x32_bf16 v[84:87], v[228:231], v[132:135], v[84:87]
    ds_read_b64_tr_b16 v[242:243], v4 offset:50432
    s_waitcnt lgkmcnt(4)
    v_mfma_f32_16x16x32_bf16 v[24:27], v[232:235], v[136:139], v[24:27]
    ds_read_b64_tr_b16 v[244:245], v5 offset:49440
    v_mfma_f32_16x16x32_bf16 v[28:31], v[232:235], v[140:143], v[28:31]
    ds_read_b64_tr_b16 v[246:247], v5 offset:50464
    s_waitcnt lgkmcnt(4)
    v_mfma_f32_16x16x32_bf16 v[32:35], v[236:239], v[136:139], v[32:35]
    ds_read_b64_tr_b16 v[224:225], v4 offset:49664
    v_mfma_f32_16x16x32_bf16 v[36:39], v[236:239], v[140:143], v[36:39]
    ds_read_b64_tr_b16 v[226:227], v4 offset:50688
    s_mov_b32 s23, 0x7000
    buffer_load_dwordx4 v[120:123], v7, s[8:11], s23 offen offset:0 sc1
    s_waitcnt lgkmcnt(4)
    v_mfma_f32_16x16x32_bf16 v[40:43], v[240:243], v[136:139], v[40:43]
    ds_read_b64_tr_b16 v[228:229], v5 offset:49696
    v_mfma_f32_16x16x32_bf16 v[44:47], v[240:243], v[140:143], v[44:47]
    s_add_u32 s22, s19, 0x688000
    s_add_u32 m0, s20, 0x4400
    s_nop 0
    buffer_load_dwordx4 v3, s[4:7], s22 offen lds
    ds_read_b64_tr_b16 v[230:231], v5 offset:50720
    s_waitcnt lgkmcnt(4)
    v_mfma_f32_16x16x32_bf16 v[48:51], v[244:247], v[136:139], v[48:51]
    ds_read_b64_tr_b16 v[232:233], v4 offset:49920
    v_mfma_f32_16x16x32_bf16 v[52:55], v[244:247], v[140:143], v[52:55]
    ds_read_b64_tr_b16 v[234:235], v4 offset:50944
    s_waitcnt lgkmcnt(4)
    v_mfma_f32_16x16x32_bf16 v[56:59], v[224:227], v[136:139], v[56:59]
    ds_read_b64_tr_b16 v[236:237], v5 offset:49952
    v_mfma_f32_16x16x32_bf16 v[60:63], v[224:227], v[140:143], v[60:63]
    ds_read_b64_tr_b16 v[238:239], v5 offset:50976
    s_waitcnt lgkmcnt(4)
    v_mfma_f32_16x16x32_bf16 v[64:67], v[228:231], v[136:139], v[64:67]
    ds_read_b64_tr_b16 v[240:241], v4 offset:57344
    v_mfma_f32_16x16x32_bf16 v[68:71], v[228:231], v[140:143], v[68:71]
    ds_read_b64_tr_b16 v[242:243], v4 offset:58368
    s_mov_b32 s23, 0xf000
    buffer_load_dwordx4 v[124:127], v7, s[8:11], s23 offen offset:0 sc1
    s_waitcnt lgkmcnt(4)
    v_mfma_f32_16x16x32_bf16 v[72:75], v[232:235], v[136:139], v[72:75]
    ds_read_b64_tr_b16 v[244:245], v5 offset:57376
    v_mfma_f32_16x16x32_bf16 v[76:79], v[232:235], v[140:143], v[76:79]
    ds_read_b64_tr_b16 v[246:247], v5 offset:58400
    s_waitcnt lgkmcnt(4)
    v_mfma_f32_16x16x32_bf16 v[80:83], v[236:239], v[136:139], v[80:83]
    ds_read_b64_tr_b16 v[224:225], v4 offset:57600
    v_mfma_f32_16x16x32_bf16 v[84:87], v[236:239], v[140:143], v[84:87]
    ds_read_b64_tr_b16 v[226:227], v4 offset:58624
    s_waitcnt lgkmcnt(4)
    v_mfma_f32_16x16x32_bf16 v[24:27], v[240:243], v[144:147], v[24:27]
    ds_read_b64_tr_b16 v[228:229], v5 offset:57632
    s_add_u32 s22, s21, 0x4000
    s_add_u32 m0, s20, 0x14000
    s_nop 0
    buffer_load_dwordx4 v2, s[8:11], s22 offen sc1 lds
    v_mfma_f32_16x16x32_bf16 v[28:31], v[240:243], v[148:151], v[28:31]
    ds_read_b64_tr_b16 v[230:231], v5 offset:58656
    s_waitcnt lgkmcnt(4)
    v_mfma_f32_16x16x32_bf16 v[32:35], v[244:247], v[144:147], v[32:35]
    ds_read_b64_tr_b16 v[232:233], v4 offset:57856
    v_mfma_f32_16x16x32_bf16 v[36:39], v[244:247], v[148:151], v[36:39]
    ds_read_b64_tr_b16 v[234:235], v4 offset:58880
    s_mov_b32 s23, 0x7000
    buffer_load_dwordx4 v[128:131], v7, s[8:11], s23 offen offset:1024 sc1
    s_waitcnt lgkmcnt(4)
    v_mfma_f32_16x16x32_bf16 v[40:43], v[224:227], v[144:147], v[40:43]
    ds_read_b64_tr_b16 v[236:237], v5 offset:57888
    s_add_u32 s22, s21, 0x4400
    s_add_u32 m0, s20, 0x14400
    s_nop 0
    buffer_load_dwordx4 v2, s[8:11], s22 offen sc1 lds
    v_mfma_f32_16x16x32_bf16 v[44:47], v[224:227], v[148:151], v[44:47]
    ds_read_b64_tr_b16 v[238:239], v5 offset:58912
    s_waitcnt lgkmcnt(4)
    v_mfma_f32_16x16x32_bf16 v[48:51], v[228:231], v[144:147], v[48:51]
    ds_read_b64_tr_b16 v[240:241], v4 offset:58112
    v_mfma_f32_16x16x32_bf16 v[52:55], v[228:231], v[148:151], v[52:55]
    ds_read_b64_tr_b16 v[242:243], v4 offset:59136
    s_waitcnt lgkmcnt(4)
    v_mfma_f32_16x16x32_bf16 v[56:59], v[232:235], v[144:147], v[56:59]
    ds_read_b64_tr_b16 v[244:245], v5 offset:58144
    v_mfma_f32_16x16x32_bf16 v[60:63], v[232:235], v[148:151], v[60:63]
    ds_read_b64_tr_b16 v[246:247], v5 offset:59168
    s_waitcnt lgkmcnt(4)
    v_mfma_f32_16x16x32_bf16 v[64:67], v[236:239], v[144:147], v[64:67]
    v_mfma_f32_16x16x32_bf16 v[68:71], v[236:239], v[148:151], v[68:71]
    s_waitcnt vmcnt(12)
    s_barrier
    ds_read_b64_tr_b16 v[224:225], v4 offset:0
    ds_read_b64_tr_b16 v[226:227], v4 offset:1024
    s_mov_b32 s23, 0xf000
    buffer_load_dwordx4 v[132:135], v7, s[8:11], s23 offen offset:1024 sc1
    s_waitcnt lgkmcnt(4)
    v_mfma_f32_16x16x32_bf16 v[72:75], v[240:243], v[144:147], v[72:75]
    ds_read_b64_tr_b16 v[228:229], v5 offset:32
    v_mfma_f32_16x16x32_bf16 v[76:79], v[240:243], v[148:151], v[76:79]
    s_add_u32 s22, s19, 0x700000
    s_add_u32 m0, s20, 0x8000
    s_nop 0
    buffer_load_dwordx4 v3, s[4:7], s22 offen lds
    ds_read_b64_tr_b16 v[230:231], v5 offset:1056
    s_waitcnt lgkmcnt(4)
    v_mfma_f32_16x16x32_bf16 v[80:83], v[244:247], v[144:147], v[80:83]
    ds_read_b64_tr_b16 v[232:233], v4 offset:256
    v_mfma_f32_16x16x32_bf16 v[84:87], v[244:247], v[148:151], v[84:87]
    ds_read_b64_tr_b16 v[234:235], v4 offset:1280
    s_waitcnt lgkmcnt(4)
    v_mfma_f32_16x16x32_bf16 v[24:27], v[224:227], v[88:91], v[24:27]
    ds_read_b64_tr_b16 v[236:237], v5 offset:288
    v_mfma_f32_16x16x32_bf16 v[28:31], v[224:227], v[92:95], v[28:31]
    ds_read_b64_tr_b16 v[238:239], v5 offset:1312
    s_waitcnt lgkmcnt(4)
    v_mfma_f32_16x16x32_bf16 v[32:35], v[228:231], v[88:91], v[32:35]
    ds_read_b64_tr_b16 v[240:241], v4 offset:512
    v_mfma_f32_16x16x32_bf16 v[36:39], v[228:231], v[92:95], v[36:39]
    ds_read_b64_tr_b16 v[242:243], v4 offset:1536
    s_mov_b32 s23, 0x7800
    buffer_load_dwordx4 v[136:139], v7, s[8:11], s23 offen offset:0 sc1
    s_waitcnt lgkmcnt(4)
    v_mfma_f32_16x16x32_bf16 v[40:43], v[232:235], v[88:91], v[40:43]
    ds_read_b64_tr_b16 v[244:245], v5 offset:544
    v_mfma_f32_16x16x32_bf16 v[44:47], v[232:235], v[92:95], v[44:47]
    s_add_u32 s22, s19, 0x708000
    s_add_u32 m0, s20, 0x8400
    s_nop 0
    buffer_load_dwordx4 v3, s[4:7], s22 offen lds
    ds_read_b64_tr_b16 v[246:247], v5 offset:1568
    s_waitcnt lgkmcnt(4)
    v_mfma_f32_16x16x32_bf16 v[48:51], v[236:239], v[88:91], v[48:51]
    ds_read_b64_tr_b16 v[224:225], v4 offset:768
    v_mfma_f32_16x16x32_bf16 v[52:55], v[236:239], v[92:95], v[52:55]
    ds_read_b64_tr_b16 v[226:227], v4 offset:1792
    s_waitcnt lgkmcnt(4)
    v_mfma_f32_16x16x32_bf16 v[56:59], v[240:243], v[88:91], v[56:59]
    ds_read_b64_tr_b16 v[228:229], v5 offset:800
    v_mfma_f32_16x16x32_bf16 v[60:63], v[240:243], v[92:95], v[60:63]
    ds_read_b64_tr_b16 v[230:231], v5 offset:1824
    s_waitcnt lgkmcnt(4)
    v_mfma_f32_16x16x32_bf16 v[64:67], v[244:247], v[88:91], v[64:67]
    ds_read_b64_tr_b16 v[232:233], v4 offset:8192
    v_mfma_f32_16x16x32_bf16 v[68:71], v[244:247], v[92:95], v[68:71]
    ds_read_b64_tr_b16 v[234:235], v4 offset:9216
    s_mov_b32 s23, 0xf800
    buffer_load_dwordx4 v[140:143], v7, s[8:11], s23 offen offset:0 sc1
    s_waitcnt lgkmcnt(4)
    v_mfma_f32_16x16x32_bf16 v[72:75], v[224:227], v[88:91], v[72:75]
    ds_read_b64_tr_b16 v[236:237], v5 offset:8224
    v_mfma_f32_16x16x32_bf16 v[76:79], v[224:227], v[92:95], v[76:79]
    ds_read_b64_tr_b16 v[238:239], v5 offset:9248
    s_waitcnt lgkmcnt(4)
    v_mfma_f32_16x16x32_bf16 v[80:83], v[228:231], v[88:91], v[80:83]
    ds_read_b64_tr_b16 v[240:241], v4 offset:8448
    v_mfma_f32_16x16x32_bf16 v[84:87], v[228:231], v[92:95], v[84:87]
    ds_read_b64_tr_b16 v[242:243], v4 offset:9472
    s_waitcnt lgkmcnt(4)
    v_mfma_f32_16x16x32_bf16 v[24:27], v[232:235], v[96:99], v[24:27]
    ds_read_b64_tr_b16 v[244:245], v5 offset:8480
    s_add_u32 s22, s21, 0x8000
    s_add_u32 m0, s20, 0x18000
    s_nop 0
    buffer_load_dwordx4 v2, s[8:11], s22 offen sc1 lds
    v_mfma_f32_16x16x32_bf16 v[28:31], v[232:235], v[100:103], v[28:31]
    ds_read_b64_tr_b16 v[246:247], v5 offset:9504
    s_waitcnt lgkmcnt(4)
    v_mfma_f32_16x16x32_bf16 v[32:35], v[236:239], v[96:99], v[32:35]
    ds_read_b64_tr_b16 v[224:225], v4 offset:8704
    v_mfma_f32_16x16x32_bf16 v[36:39], v[236:239], v[100:103], v[36:39]
    ds_read_b64_tr_b16 v[226:227], v4 offset:9728
    s_mov_b32 s23, 0x7800
    buffer_load_dwordx4 v[144:147], v7, s[8:11], s23 offen offset:1024 sc1
    s_waitcnt lgkmcnt(4)
    v_mfma_f32_16x16x32_bf16 v[40:43], v[240:243], v[96:99], v[40:43]
    ds_read_b64_tr_b16 v[228:229], v5 offset:8736
    s_add_u32 s22, s21, 0x8400
    s_add_u32 m0, s20, 0x18400
    s_nop 0
    buffer_load_dwordx4 v2, s[8:11], s22 offen sc1 lds
    v_mfma_f32_16x16x32_bf16 v[44:47], v[240:243], v[100:103], v[44:47]
    ds_read_b64_tr_b16 v[230:231], v5 offset:9760
    s_waitcnt lgkmcnt(4)
    v_mfma_f32_16x16x32_bf16 v[48:51], v[244:247], v[96:99], v[48:51]
    ds_read_b64_tr_b16 v[232:233], v4 offset:8960
    v_mfma_f32_16x16x32_bf16 v[52:55], v[244:247], v[100:103], v[52:55]
    ds_read_b64_tr_b16 v[234:235], v4 offset:9984
    s_waitcnt lgkmcnt(4)
    v_mfma_f32_16x16x32_bf16 v[56:59], v[224:227], v[96:99], v[56:59]
    ds_read_b64_tr_b16 v[236:237], v5 offset:8992
    v_mfma_f32_16x16x32_bf16 v[60:63], v[224:227], v[100:103], v[60:63]
    ds_read_b64_tr_b16 v[238:239], v5 offset:10016
    s_waitcnt lgkmcnt(4)
    v_mfma_f32_16x16x32_bf16 v[64:67], v[228:231], v[96:99], v[64:67]
    v_mfma_f32_16x16x32_bf16 v[68:71], v[228:231], v[100:103], v[68:71]
    s_waitcnt vmcnt(12)
    s_barrier
    ds_read_b64_tr_b16 v[240:241], v4 offset:16384
    ds_read_b64_tr_b16 v[242:243], v4 offset:17408
    s_mov_b32 s23, 0xf800
    buffer_load_dwordx4 v[148:151], v7, s[8:11], s23 offen offset:1024 sc1
    s_waitcnt lgkmcnt(4)
    v_mfma_f32_16x16x32_bf16 v[72:75], v[232:235], v[96:99], v[72:75]
    ds_read_b64_tr_b16 v[244:245], v5 offset:16416
    v_mfma_f32_16x16x32_bf16 v[76:79], v[232:235], v[100:103], v[76:79]
    s_add_u32 s22, s19, 0x780000
    s_add_u32 m0, s20, 0xc000
    s_nop 0
    buffer_load_dwordx4 v3, s[4:7], s22 offen lds
    ds_read_b64_tr_b16 v[246:247], v5 offset:17440
    s_waitcnt lgkmcnt(4)
    v_mfma_f32_16x16x32_bf16 v[80:83], v[236:239], v[96:99], v[80:83]
    ds_read_b64_tr_b16 v[224:225], v4 offset:16640
    v_mfma_f32_16x16x32_bf16 v[84:87], v[236:239], v[100:103], v[84:87]
    ds_read_b64_tr_b16 v[226:227], v4 offset:17664
    s_waitcnt lgkmcnt(4)
    v_mfma_f32_16x16x32_bf16 v[24:27], v[240:243], v[104:107], v[24:27]
    ds_read_b64_tr_b16 v[228:229], v5 offset:16672
    v_mfma_f32_16x16x32_bf16 v[28:31], v[240:243], v[108:111], v[28:31]
    ds_read_b64_tr_b16 v[230:231], v5 offset:17696
    s_waitcnt lgkmcnt(4)
    v_mfma_f32_16x16x32_bf16 v[32:35], v[244:247], v[104:107], v[32:35]
    ds_read_b64_tr_b16 v[232:233], v4 offset:16896
    v_mfma_f32_16x16x32_bf16 v[36:39], v[244:247], v[108:111], v[36:39]
    ds_read_b64_tr_b16 v[234:235], v4 offset:17920
    s_waitcnt lgkmcnt(4)
    v_mfma_f32_16x16x32_bf16 v[40:43], v[224:227], v[104:107], v[40:43]
    ds_read_b64_tr_b16 v[236:237], v5 offset:16928
    v_mfma_f32_16x16x32_bf16 v[44:47], v[224:227], v[108:111], v[44:47]
    s_add_u32 s22, s19, 0x788000
    s_add_u32 m0, s20, 0xc400
    s_nop 0
    buffer_load_dwordx4 v3, s[4:7], s22 offen lds
    ds_read_b64_tr_b16 v[238:239], v5 offset:17952
    s_waitcnt lgkmcnt(4)
    v_mfma_f32_16x16x32_bf16 v[48:51], v[228:231], v[104:107], v[48:51]
    ds_read_b64_tr_b16 v[240:241], v4 offset:17152
    v_mfma_f32_16x16x32_bf16 v[52:55], v[228:231], v[108:111], v[52:55]
    ds_read_b64_tr_b16 v[242:243], v4 offset:18176
    s_waitcnt lgkmcnt(4)
    v_mfma_f32_16x16x32_bf16 v[56:59], v[232:235], v[104:107], v[56:59]
    ds_read_b64_tr_b16 v[244:245], v5 offset:17184
    v_mfma_f32_16x16x32_bf16 v[60:63], v[232:235], v[108:111], v[60:63]
    ds_read_b64_tr_b16 v[246:247], v5 offset:18208
    s_waitcnt lgkmcnt(4)
    v_mfma_f32_16x16x32_bf16 v[64:67], v[236:239], v[104:107], v[64:67]
    ds_read_b64_tr_b16 v[224:225], v4 offset:24576
    v_mfma_f32_16x16x32_bf16 v[68:71], v[236:239], v[108:111], v[68:71]
    ds_read_b64_tr_b16 v[226:227], v4 offset:25600
    s_waitcnt lgkmcnt(4)
    v_mfma_f32_16x16x32_bf16 v[72:75], v[240:243], v[104:107], v[72:75]
    ds_read_b64_tr_b16 v[228:229], v5 offset:24608
    v_mfma_f32_16x16x32_bf16 v[76:79], v[240:243], v[108:111], v[76:79]
    ds_read_b64_tr_b16 v[230:231], v5 offset:25632
    s_waitcnt lgkmcnt(4)
    v_mfma_f32_16x16x32_bf16 v[80:83], v[244:247], v[104:107], v[80:83]
    ds_read_b64_tr_b16 v[232:233], v4 offset:24832
    v_mfma_f32_16x16x32_bf16 v[84:87], v[244:247], v[108:111], v[84:87]
    ds_read_b64_tr_b16 v[234:235], v4 offset:25856
    s_waitcnt lgkmcnt(4)
    v_mfma_f32_16x16x32_bf16 v[24:27], v[224:227], v[112:115], v[24:27]
    ds_read_b64_tr_b16 v[236:237], v5 offset:24864
    s_add_u32 s22, s21, 0xc000
    s_add_u32 m0, s20, 0x1c000
    s_nop 0
    buffer_load_dwordx4 v2, s[8:11], s22 offen sc1 lds
    v_mfma_f32_16x16x32_bf16 v[28:31], v[224:227], v[116:119], v[28:31]
    ds_read_b64_tr_b16 v[238:239], v5 offset:25888
    s_waitcnt lgkmcnt(4)
    v_mfma_f32_16x16x32_bf16 v[32:35], v[228:231], v[112:115], v[32:35]
    ds_read_b64_tr_b16 v[240:241], v4 offset:25088
    v_mfma_f32_16x16x32_bf16 v[36:39], v[228:231], v[116:119], v[36:39]
    ds_read_b64_tr_b16 v[242:243], v4 offset:26112
    s_waitcnt lgkmcnt(4)
    v_mfma_f32_16x16x32_bf16 v[40:43], v[232:235], v[112:115], v[40:43]
    ds_read_b64_tr_b16 v[244:245], v5 offset:25120
    s_add_u32 s22, s21, 0xc400
    s_add_u32 m0, s20, 0x1c400
    s_nop 0
    buffer_load_dwordx4 v2, s[8:11], s22 offen sc1 lds
    v_mfma_f32_16x16x32_bf16 v[44:47], v[232:235], v[116:119], v[44:47]
    ds_read_b64_tr_b16 v[246:247], v5 offset:26144
    s_waitcnt lgkmcnt(4)
    v_mfma_f32_16x16x32_bf16 v[48:51], v[236:239], v[112:115], v[48:51]
    ds_read_b64_tr_b16 v[224:225], v4 offset:25344
    v_mfma_f32_16x16x32_bf16 v[52:55], v[236:239], v[116:119], v[52:55]
    ds_read_b64_tr_b16 v[226:227], v4 offset:26368
    s_waitcnt lgkmcnt(4)
    v_mfma_f32_16x16x32_bf16 v[56:59], v[240:243], v[112:115], v[56:59]
    ds_read_b64_tr_b16 v[228:229], v5 offset:25376
    v_mfma_f32_16x16x32_bf16 v[60:63], v[240:243], v[116:119], v[60:63]
    ds_read_b64_tr_b16 v[230:231], v5 offset:26400
    s_waitcnt lgkmcnt(4)
    v_mfma_f32_16x16x32_bf16 v[64:67], v[244:247], v[112:115], v[64:67]
    v_mfma_f32_16x16x32_bf16 v[68:71], v[244:247], v[116:119], v[68:71]
    s_waitcnt vmcnt(9)
    s_barrier
    ds_read_b64_tr_b16 v[232:233], v4 offset:32768
    ds_read_b64_tr_b16 v[234:235], v4 offset:33792
    s_waitcnt lgkmcnt(4)
    v_mfma_f32_16x16x32_bf16 v[72:75], v[224:227], v[112:115], v[72:75]
    ds_read_b64_tr_b16 v[236:237], v5 offset:32800
    v_mfma_f32_16x16x32_bf16 v[76:79], v[224:227], v[116:119], v[76:79]
    ds_read_b64_tr_b16 v[238:239], v5 offset:33824
    s_waitcnt lgkmcnt(4)
    v_mfma_f32_16x16x32_bf16 v[80:83], v[228:231], v[112:115], v[80:83]
    ds_read_b64_tr_b16 v[240:241], v4 offset:33024
    v_mfma_f32_16x16x32_bf16 v[84:87], v[228:231], v[116:119], v[84:87]
    ds_read_b64_tr_b16 v[242:243], v4 offset:34048
    s_waitcnt lgkmcnt(4)
    v_mfma_f32_16x16x32_bf16 v[24:27], v[232:235], v[120:123], v[24:27]
    ds_read_b64_tr_b16 v[244:245], v5 offset:33056
    v_mfma_f32_16x16x32_bf16 v[28:31], v[232:235], v[124:127], v[28:31]
    ds_read_b64_tr_b16 v[246:247], v5 offset:34080
    s_waitcnt lgkmcnt(4)
    v_mfma_f32_16x16x32_bf16 v[32:35], v[236:239], v[120:123], v[32:35]
    ds_read_b64_tr_b16 v[224:225], v4 offset:33280
    v_mfma_f32_16x16x32_bf16 v[36:39], v[236:239], v[124:127], v[36:39]
    ds_read_b64_tr_b16 v[226:227], v4 offset:34304
    s_waitcnt lgkmcnt(4)
    v_mfma_f32_16x16x32_bf16 v[40:43], v[240:243], v[120:123], v[40:43]
    ds_read_b64_tr_b16 v[228:229], v5 offset:33312
    v_mfma_f32_16x16x32_bf16 v[44:47], v[240:243], v[124:127], v[44:47]
    ds_read_b64_tr_b16 v[230:231], v5 offset:34336
    s_waitcnt lgkmcnt(4)
    v_mfma_f32_16x16x32_bf16 v[48:51], v[244:247], v[120:123], v[48:51]
    ds_read_b64_tr_b16 v[232:233], v4 offset:33536
    v_mfma_f32_16x16x32_bf16 v[52:55], v[244:247], v[124:127], v[52:55]
    ds_read_b64_tr_b16 v[234:235], v4 offset:34560
    s_waitcnt lgkmcnt(4)
    v_mfma_f32_16x16x32_bf16 v[56:59], v[224:227], v[120:123], v[56:59]
    ds_read_b64_tr_b16 v[236:237], v5 offset:33568
    v_mfma_f32_16x16x32_bf16 v[60:63], v[224:227], v[124:127], v[60:63]
    ds_read_b64_tr_b16 v[238:239], v5 offset:34592
    s_waitcnt lgkmcnt(4)
    v_mfma_f32_16x16x32_bf16 v[64:67], v[228:231], v[120:123], v[64:67]
    ds_read_b64_tr_b16 v[240:241], v4 offset:40960
    v_mfma_f32_16x16x32_bf16 v[68:71], v[228:231], v[124:127], v[68:71]
    ds_read_b64_tr_b16 v[242:243], v4 offset:41984
    s_waitcnt lgkmcnt(4)
    v_mfma_f32_16x16x32_bf16 v[72:75], v[232:235], v[120:123], v[72:75]
    ds_read_b64_tr_b16 v[244:245], v5 offset:40992
    v_mfma_f32_16x16x32_bf16 v[76:79], v[232:235], v[124:127], v[76:79]
    ds_read_b64_tr_b16 v[246:247], v5 offset:42016
    s_waitcnt lgkmcnt(4)
    v_mfma_f32_16x16x32_bf16 v[80:83], v[236:239], v[120:123], v[80:83]
    ds_read_b64_tr_b16 v[224:225], v4 offset:41216
    v_mfma_f32_16x16x32_bf16 v[84:87], v[236:239], v[124:127], v[84:87]
    ds_read_b64_tr_b16 v[226:227], v4 offset:42240
    s_waitcnt lgkmcnt(4)
    v_mfma_f32_16x16x32_bf16 v[24:27], v[240:243], v[128:131], v[24:27]
    ds_read_b64_tr_b16 v[228:229], v5 offset:41248
    v_mfma_f32_16x16x32_bf16 v[28:31], v[240:243], v[132:135], v[28:31]
    ds_read_b64_tr_b16 v[230:231], v5 offset:42272
    s_waitcnt lgkmcnt(4)
    v_mfma_f32_16x16x32_bf16 v[32:35], v[244:247], v[128:131], v[32:35]
    ds_read_b64_tr_b16 v[232:233], v4 offset:41472
    v_mfma_f32_16x16x32_bf16 v[36:39], v[244:247], v[132:135], v[36:39]
    ds_read_b64_tr_b16 v[234:235], v4 offset:42496
    s_waitcnt lgkmcnt(4)
    v_mfma_f32_16x16x32_bf16 v[40:43], v[224:227], v[128:131], v[40:43]
    ds_read_b64_tr_b16 v[236:237], v5 offset:41504
    v_mfma_f32_16x16x32_bf16 v[44:47], v[224:227], v[132:135], v[44:47]
    ds_read_b64_tr_b16 v[238:239], v5 offset:42528
    s_waitcnt lgkmcnt(4)
    v_mfma_f32_16x16x32_bf16 v[48:51], v[228:231], v[128:131], v[48:51]
    ds_read_b64_tr_b16 v[240:241], v4 offset:41728
    v_mfma_f32_16x16x32_bf16 v[52:55], v[228:231], v[132:135], v[52:55]
    ds_read_b64_tr_b16 v[242:243], v4 offset:42752
    s_waitcnt lgkmcnt(4)
    v_mfma_f32_16x16x32_bf16 v[56:59], v[232:235], v[128:131], v[56:59]
    ds_read_b64_tr_b16 v[244:245], v5 offset:41760
    v_mfma_f32_16x16x32_bf16 v[60:63], v[232:235], v[132:135], v[60:63]
    ds_read_b64_tr_b16 v[246:247], v5 offset:42784
    s_waitcnt lgkmcnt(4)
    v_mfma_f32_16x16x32_bf16 v[64:67], v[236:239], v[128:131], v[64:67]
    v_mfma_f32_16x16x32_bf16 v[68:71], v[236:239], v[132:135], v[68:71]
    s_waitcnt vmcnt(2)
    s_barrier
    ds_read_b64_tr_b16 v[224:225], v4 offset:49152
    ds_read_b64_tr_b16 v[226:227], v4 offset:50176
    s_waitcnt lgkmcnt(4)
    v_mfma_f32_16x16x32_bf16 v[72:75], v[240:243], v[128:131], v[72:75]
    ds_read_b64_tr_b16 v[228:229], v5 offset:49184
    v_mfma_f32_16x16x32_bf16 v[76:79], v[240:243], v[132:135], v[76:79]
    ds_read_b64_tr_b16 v[230:231], v5 offset:50208
    s_waitcnt lgkmcnt(4)
    v_mfma_f32_16x16x32_bf16 v[80:83], v[244:247], v[128:131], v[80:83]
    ds_read_b64_tr_b16 v[232:233], v4 offset:49408
    v_mfma_f32_16x16x32_bf16 v[84:87], v[244:247], v[132:135], v[84:87]
    ds_read_b64_tr_b16 v[234:235], v4 offset:50432
    s_waitcnt lgkmcnt(4)
    v_mfma_f32_16x16x32_bf16 v[24:27], v[224:227], v[136:139], v[24:27]
    ds_read_b64_tr_b16 v[236:237], v5 offset:49440
    v_mfma_f32_16x16x32_bf16 v[28:31], v[224:227], v[140:143], v[28:31]
    ds_read_b64_tr_b16 v[238:239], v5 offset:50464
    s_waitcnt lgkmcnt(4)
    v_mfma_f32_16x16x32_bf16 v[32:35], v[228:231], v[136:139], v[32:35]
    ds_read_b64_tr_b16 v[240:241], v4 offset:49664
    v_mfma_f32_16x16x32_bf16 v[36:39], v[228:231], v[140:143], v[36:39]
    ds_read_b64_tr_b16 v[242:243], v4 offset:50688
    s_waitcnt lgkmcnt(4)
    v_mfma_f32_16x16x32_bf16 v[40:43], v[232:235], v[136:139], v[40:43]
    ds_read_b64_tr_b16 v[244:245], v5 offset:49696
    v_mfma_f32_16x16x32_bf16 v[44:47], v[232:235], v[140:143], v[44:47]
    ds_read_b64_tr_b16 v[246:247], v5 offset:50720
    s_waitcnt lgkmcnt(4)
    v_mfma_f32_16x16x32_bf16 v[48:51], v[236:239], v[136:139], v[48:51]
    ds_read_b64_tr_b16 v[224:225], v4 offset:49920
    v_mfma_f32_16x16x32_bf16 v[52:55], v[236:239], v[140:143], v[52:55]
    ds_read_b64_tr_b16 v[226:227], v4 offset:50944
    s_waitcnt lgkmcnt(4)
    v_mfma_f32_16x16x32_bf16 v[56:59], v[240:243], v[136:139], v[56:59]
    ds_read_b64_tr_b16 v[228:229], v5 offset:49952
    v_mfma_f32_16x16x32_bf16 v[60:63], v[240:243], v[140:143], v[60:63]
    ds_read_b64_tr_b16 v[230:231], v5 offset:50976
    s_waitcnt lgkmcnt(4)
    v_mfma_f32_16x16x32_bf16 v[64:67], v[244:247], v[136:139], v[64:67]
    ds_read_b64_tr_b16 v[232:233], v4 offset:57344
    v_mfma_f32_16x16x32_bf16 v[68:71], v[244:247], v[140:143], v[68:71]
    ds_read_b64_tr_b16 v[234:235], v4 offset:58368
    s_waitcnt lgkmcnt(4)
    v_mfma_f32_16x16x32_bf16 v[72:75], v[224:227], v[136:139], v[72:75]
    ds_read_b64_tr_b16 v[236:237], v5 offset:57376
    v_mfma_f32_16x16x32_bf16 v[76:79], v[224:227], v[140:143], v[76:79]
    ds_read_b64_tr_b16 v[238:239], v5 offset:58400
    s_waitcnt lgkmcnt(4)
    v_mfma_f32_16x16x32_bf16 v[80:83], v[228:231], v[136:139], v[80:83]
    ds_read_b64_tr_b16 v[240:241], v4 offset:57600
    v_mfma_f32_16x16x32_bf16 v[84:87], v[228:231], v[140:143], v[84:87]
    ds_read_b64_tr_b16 v[242:243], v4 offset:58624
    s_waitcnt lgkmcnt(4)
    v_mfma_f32_16x16x32_bf16 v[24:27], v[232:235], v[144:147], v[24:27]
    ds_read_b64_tr_b16 v[244:245], v5 offset:57632
    v_mfma_f32_16x16x32_bf16 v[28:31], v[232:235], v[148:151], v[28:31]
    ds_read_b64_tr_b16 v[246:247], v5 offset:58656
    s_waitcnt lgkmcnt(4)
    v_mfma_f32_16x16x32_bf16 v[32:35], v[236:239], v[144:147], v[32:35]
    ds_read_b64_tr_b16 v[224:225], v4 offset:57856
    v_mfma_f32_16x16x32_bf16 v[36:39], v[236:239], v[148:151], v[36:39]
    ds_read_b64_tr_b16 v[226:227], v4 offset:58880
    s_waitcnt lgkmcnt(4)
    v_mfma_f32_16x16x32_bf16 v[40:43], v[240:243], v[144:147], v[40:43]
    ds_read_b64_tr_b16 v[228:229], v5 offset:57888
    v_mfma_f32_16x16x32_bf16 v[44:47], v[240:243], v[148:151], v[44:47]
    ds_read_b64_tr_b16 v[230:231], v5 offset:58912
    s_waitcnt lgkmcnt(4)
    v_mfma_f32_16x16x32_bf16 v[48:51], v[244:247], v[144:147], v[48:51]
    ds_read_b64_tr_b16 v[232:233], v4 offset:58112
    v_mfma_f32_16x16x32_bf16 v[52:55], v[244:247], v[148:151], v[52:55]
    ds_read_b64_tr_b16 v[234:235], v4 offset:59136
    s_waitcnt lgkmcnt(4)
    v_mfma_f32_16x16x32_bf16 v[56:59], v[224:227], v[144:147], v[56:59]
    ds_read_b64_tr_b16 v[236:237], v5 offset:58144
    v_mfma_f32_16x16x32_bf16 v[60:63], v[224:227], v[148:151], v[60:63]
    ds_read_b64_tr_b16 v[238:239], v5 offset:59168
    s_waitcnt lgkmcnt(4)
    v_mfma_f32_16x16x32_bf16 v[64:67], v[228:231], v[144:147], v[64:67]
    v_mfma_f32_16x16x32_bf16 v[68:71], v[228:231], v[148:151], v[68:71]
    s_waitcnt lgkmcnt(2)
    v_mfma_f32_16x16x32_bf16 v[72:75], v[232:235], v[144:147], v[72:75]
    v_mfma_f32_16x16x32_bf16 v[76:79], v[232:235], v[148:151], v[76:79]
    s_waitcnt lgkmcnt(0)
    v_mfma_f32_16x16x32_bf16 v[80:83], v[236:239], v[144:147], v[80:83]
    v_mfma_f32_16x16x32_bf16 v[84:87], v[236:239], v[148:151], v[84:87]
    s_mov_b32 s23, 0x3e0293ee
    v_mul_f32 v24, s23, v24
    v_mul_f32 v25, s23, v25
    v_mul_f32 v26, s23, v26
    v_mul_f32 v27, s23, v27
    v_mul_f32 v28, s23, v28
    v_mul_f32 v29, s23, v29
    v_mul_f32 v30, s23, v30
    v_mul_f32 v31, s23, v31
    v_mul_f32 v32, s23, v32
    v_mul_f32 v33, s23, v33
    v_mul_f32 v34, s23, v34
    v_mul_f32 v35, s23, v35
    v_mul_f32 v36, s23, v36
    v_mul_f32 v37, s23, v37
    v_mul_f32 v38, s23, v38
    v_mul_f32 v39, s23, v39
    v_cvt_pk_bf16_f32 v152, v24, v25
    v_cvt_pk_bf16_f32 v153, v26, v27
    v_cvt_pk_bf16_f32 v168, v28, v29
    v_cvt_pk_bf16_f32 v169, v30, v31
    v_cvt_pk_bf16_f32 v154, v32, v33
    v_cvt_pk_bf16_f32 v155, v34, v35
    v_cvt_pk_bf16_f32 v170, v36, v37
    v_cvt_pk_bf16_f32 v171, v38, v39
    v_add_u32 v4, 0x10000, v2
    v_add_u32 v5, 0x20000, v2
    s_barrier
    ds_read_b128 v[224:227], v4 offset:0
    ds_read_b128 v[228:231], v4 offset:1024
    ds_read_b128 v[232:235], v4 offset:2048
    ds_read_b128 v[236:239], v4 offset:3072
    v_mov_b32 v12, 0x3f803f80
    v_mov_b32 v13, 0x3f803f80
    v_mov_b32 v14, 0x3f803f80
    v_mov_b32 v15, 0x3f803f80
    s_waitcnt lgkmcnt(3)
    v_mfma_f32_16x16x32_bf16 v[184:187], v[224:227], v[152:155], 0
    v_mul_f32 v40, s23, v40
    v_mul_f32 v41, s23, v41
    v_mul_f32 v42, s23, v42
    v_mul_f32 v43, s23, v43
    v_mul_f32 v44, s23, v44
    v_mul_f32 v45, s23, v45
    v_mfma_f32_16x16x32_bf16 v[188:191], v[224:227], v[168:171], 0
    ds_read_b128 v[240:243], v4 offset:4096
    v_mul_f32 v46, s23, v46
    v_mul_f32 v47, s23, v47
    v_mul_f32 v48, s23, v48
    v_mul_f32 v49, s23, v49
    v_mul_f32 v50, s23, v50
    v_mul_f32 v51, s23, v51
    s_mov_b64 s[64:65], s[46:47]
    s_mov_b32 s66, 0x700000
    s_mov_b32 s67, 0x20000
    s_mov_b64 s[68:69], s[48:49]
    s_mov_b32 s70, 0x700000
    s_mov_b32 s71, 0x20000
    s_cmp_lt_u32 s2, 224
    s_cselect_b32 s66, 7340032, 0
    s_cselect_b32 s70, 7340032, 0
    s_and_b32 s29, s2, 7
    s_mul_i32 s29, s29, 28
    s_lshr_b32 s16, s2, 3
    s_add_u32 s29, s29, s16
    s_sub_u32 s16, s3, 4
    v_lshrrev_b32 v20, 3, v1
    v_lshlrev_b32 v20, 3, v20
    s_lshl_b32 s17, s16, 6
    v_add_u32 v20, s17, v20
    s_mov_b32 s17, 7168
    v_mul_lo_u32 v11, s17, v20
    v_and_b32 v20, 7, v1
    v_lshl_add_u32 v11, v20, 4, v11
    s_and_b32 s17, s29, 3
    s_mul_i32 s18, s17, 1835008
    s_lshr_b32 s17, s29, 2
    s_lshl_b32 s17, s17, 7
    s_add_u32 s18, s18, s17
    s_lshl_b32 s15, s16, 13
    s_waitcnt lgkmcnt(3)
    v_mfma_f32_16x16x32_bf16 v[192:195], v[228:231], v[152:155], 0
    s_add_u32 s22, s21, 0x10000
    s_add_u32 m0, s20, 0x20000
    s_nop 0
    buffer_load_dwordx4 v2, s[8:11], s22 offen sc1 lds
    v_mul_f32 v52, s23, v52
    v_mul_f32 v53, s23, v53
    v_mul_f32 v54, s23, v54
    v_mul_f32 v55, s23, v55
    v_cvt_pk_bf16_f32 v156, v40, v41
    v_cvt_pk_bf16_f32 v157, v42, v43
    s_mov_b64 s[76:77], s[54:55]
    s_mov_b32 s78, 0xc00000
    s_mov_b32 s79, 0x20000
    v_bfe_u32 v20, v1, 2, 2
    v_lshlrev_b32 v20, 12, v20
    v_add_u32 v6, v3, v20
    s_lshr_b32 s16, s2, 5
    s_lshl_b32 s16, s16, 7
    s_lshl_b32 s17, s3, 3
    s_add_u32 s16, s16, s17
    s_mul_i32 s14, s16, 12288
    s_and_b32 s16, s2, 31
    s_lshl_b32 s16, s16, 8
    s_add_u32 s14, s14, s16
    s_add_u32 s14, s14, 4096
    v_mfma_f32_16x16x32_bf16 v[196:199], v[228:231], v[168:171], 0
    ds_read_b128 v[244:247], v4 offset:5120
    v_cvt_pk_bf16_f32 v172, v44, v45
    v_cvt_pk_bf16_f32 v173, v46, v47
    v_cvt_pk_bf16_f32 v158, v48, v49
    v_cvt_pk_bf16_f32 v159, v50, v51
    v_cvt_pk_bf16_f32 v174, v52, v53
    v_cvt_pk_bf16_f32 v175, v54, v55
    s_waitcnt lgkmcnt(3)
    v_mfma_f32_16x16x32_bf16 v[184:187], v[232:235], v[156:159], v[184:187]
    v_mul_f32 v56, s23, v56
    v_mul_f32 v57, s23, v57
    v_mul_f32 v58, s23, v58
    v_mul_f32 v59, s23, v59
    v_mul_f32 v60, s23, v60
    v_mul_f32 v61, s23, v61
    v_mfma_f32_16x16x32_bf16 v[188:191], v[232:235], v[172:175], v[188:191]
    ds_read_b128 v[224:227], v4 offset:6144
    v_mul_f32 v62, s23, v62
    v_mul_f32 v63, s23, v63
    v_mul_f32 v64, s23, v64
    v_mul_f32 v65, s23, v65
    v_mul_f32 v66, s23, v66
    v_mul_f32 v67, s23, v67
    s_waitcnt lgkmcnt(3)
    v_mfma_f32_16x16x32_bf16 v[192:195], v[236:239], v[156:159], v[192:195]
    v_mul_f32 v68, s23, v68
    v_mul_f32 v69, s23, v69
    v_mul_f32 v70, s23, v70
    v_mul_f32 v71, s23, v71
    v_cvt_pk_bf16_f32 v160, v56, v57
    v_cvt_pk_bf16_f32 v161, v58, v59
    v_mfma_f32_16x16x32_bf16 v[196:199], v[236:239], v[172:175], v[196:199]
    ds_read_b128 v[228:231], v4 offset:7168
    v_cvt_pk_bf16_f32 v176, v60, v61
    v_cvt_pk_bf16_f32 v177, v62, v63
    v_cvt_pk_bf16_f32 v162, v64, v65
    v_cvt_pk_bf16_f32 v163, v66, v67
    v_cvt_pk_bf16_f32 v178, v68, v69
    v_cvt_pk_bf16_f32 v179, v70, v71
    s_waitcnt lgkmcnt(3)
    v_mfma_f32_16x16x32_bf16 v[184:187], v[240:243], v[160:163], v[184:187]
    v_mul_f32 v72, s23, v72
    v_mul_f32 v73, s23, v73
    v_mul_f32 v74, s23, v74
    v_mul_f32 v75, s23, v75
    v_mul_f32 v76, s23, v76
    v_mul_f32 v77, s23, v77
    v_mfma_f32_16x16x32_bf16 v[188:191], v[240:243], v[176:179], v[188:191]
    ds_read_b128 v[232:235], v4 offset:8192
    v_mul_f32 v78, s23, v78
    v_mul_f32 v79, s23, v79
    v_mul_f32 v80, s23, v80
    v_mul_f32 v81, s23, v81
    v_mul_f32 v82, s23, v82
    v_mul_f32 v83, s23, v83
    s_waitcnt lgkmcnt(3)
    v_mfma_f32_16x16x32_bf16 v[192:195], v[244:247], v[160:163], v[192:195]
    s_add_u32 s22, s21, 0x10400
    s_add_u32 m0, s20, 0x20400
    s_nop 0
    buffer_load_dwordx4 v2, s[8:11], s22 offen sc1 lds
    v_mul_f32 v84, s23, v84
    v_mul_f32 v85, s23, v85
    v_mul_f32 v86, s23, v86
    v_mul_f32 v87, s23, v87
    v_cvt_pk_bf16_f32 v164, v72, v73
    v_cvt_pk_bf16_f32 v165, v74, v75
    v_mfma_f32_16x16x32_bf16 v[196:199], v[244:247], v[176:179], v[196:199]
    ds_read_b128 v[236:239], v4 offset:9216
    v_cvt_pk_bf16_f32 v180, v76, v77
    v_cvt_pk_bf16_f32 v181, v78, v79
    v_cvt_pk_bf16_f32 v166, v80, v81
    v_cvt_pk_bf16_f32 v167, v82, v83
    v_cvt_pk_bf16_f32 v182, v84, v85
    v_cvt_pk_bf16_f32 v183, v86, v87
    s_waitcnt lgkmcnt(3)
    v_mfma_f32_16x16x32_bf16 v[184:187], v[224:227], v[164:167], v[184:187]
    v_mfma_f32_16x16x32_bf16 v[188:191], v[224:227], v[180:183], v[188:191]
    ds_read_b128 v[240:243], v4 offset:10240
    s_waitcnt lgkmcnt(3)
    v_mfma_f32_16x16x32_bf16 v[192:195], v[228:231], v[164:167], v[192:195]
    v_mfma_f32_16x16x32_bf16 v[196:199], v[228:231], v[180:183], v[196:199]
    ds_read_b128 v[244:247], v4 offset:11264
    s_waitcnt lgkmcnt(3)
    v_mfma_f32_16x16x32_bf16 v[200:203], v[232:235], v[152:155], 0
    v_mfma_f32_16x16x32_bf16 v[204:207], v[232:235], v[168:171], 0
    ds_read_b128 v[224:227], v4 offset:12288
    s_waitcnt lgkmcnt(3)
    v_mfma_f32_16x16x32_bf16 v[208:211], v[236:239], v[152:155], 0
    v_mfma_f32_16x16x32_bf16 v[212:215], v[236:239], v[168:171], 0
    ds_read_b128 v[228:231], v4 offset:13312
    s_waitcnt lgkmcnt(3)
    v_mfma_f32_16x16x32_bf16 v[200:203], v[240:243], v[156:159], v[200:203]
    v_mfma_f32_16x16x32_bf16 v[204:207], v[240:243], v[172:175], v[204:207]
    ds_read_b128 v[232:235], v4 offset:14336
    s_waitcnt lgkmcnt(3)
    v_mfma_f32_16x16x32_bf16 v[208:211], v[244:247], v[156:159], v[208:211]
    v_max3_f32 v16, v184, v185, v186
    v_mfma_f32_16x16x32_bf16 v[212:215], v[244:247], v[172:175], v[212:215]
    ds_read_b128 v[236:239], v4 offset:15360
    v_max3_f32 v16, v16, v187, v192
    s_waitcnt lgkmcnt(3)
    v_mfma_f32_16x16x32_bf16 v[200:203], v[224:227], v[160:163], v[200:203]
    v_max3_f32 v16, v16, v193, v194
    v_mfma_f32_16x16x32_bf16 v[204:207], v[224:227], v[176:179], v[204:207]
    s_barrier
    ds_read_b128 v[240:243], v4 offset:16384
    v_max_f32 v16, v16, v195
    s_waitcnt lgkmcnt(3)
    v_mfma_f32_16x16x32_bf16 v[208:211], v[228:231], v[160:163], v[208:211]
    v_max3_f32 v17, v188, v189, v190
    v_mfma_f32_16x16x32_bf16 v[212:215], v[228:231], v[176:179], v[212:215]
    s_add_u32 s22, s21, 0x14000
    s_add_u32 m0, s20, 0x24000
    s_nop 0
    buffer_load_dwordx4 v2, s[8:11], s22 offen sc1 lds
    ds_read_b128 v[244:247], v4 offset:17408
    v_max3_f32 v17, v17, v191, v196
    s_waitcnt lgkmcnt(3)
    v_mfma_f32_16x16x32_bf16 v[200:203], v[232:235], v[164:167], v[200:203]
    v_max3_f32 v17, v17, v197, v198
    v_mfma_f32_16x16x32_bf16 v[204:207], v[232:235], v[180:183], v[204:207]
    ds_read_b128 v[224:227], v4 offset:18432
    v_max_f32 v17, v17, v199
    s_waitcnt lgkmcnt(3)
    v_mfma_f32_16x16x32_bf16 v[208:211], v[236:239], v[164:167], v[208:211]
    s_mov_b64 s[72:73], s[40:41]
    s_mov_b32 s74, 0x800000
    s_mov_b32 s75, 0x20000
    v_lshlrev_b32 v21, 7, v1
    s_lshl_b32 s16, s2, 2
    s_add_u32 s16, s16, s3
    s_sub_u32 s16, s16, 4
    s_lshl_b32 s16, s16, 13
    buffer_load_dword v7, v21, s[72:75], s16 offen
    v_mfma_f32_16x16x32_bf16 v[212:215], v[236:239], v[180:183], v[212:215]
    ds_read_b128 v[228:231], v4 offset:19456
    v_max3_f32 v16, v16, v200, v201
    v_max3_f32 v16, v16, v202, v203
    v_max3_f32 v16, v16, v208, v209
    v_max3_f32 v16, v16, v210, v211
    v_max3_f32 v17, v17, v204, v205
    v_max3_f32 v17, v17, v206, v207
    s_nop 0
    v_max3_f32 v17, v17, v212, v213
    v_max3_f32 v17, v17, v214, v215
    v_mov_b32 v18, v16
    v_mov_b32 v19, v17
    s_nop 0
    v_permlane16_swap_b32 v16, v18
    v_permlane16_swap_b32 v17, v19
    v_max_f32 v16, v16, v18
    v_max_f32 v17, v17, v19
    v_mov_b32 v18, v16
    v_mov_b32 v19, v17
    s_nop 0
    v_permlane32_swap_b32 v16, v18
    v_permlane32_swap_b32 v17, v19
    v_max_f32 v16, v16, v18
    v_max_f32 v17, v17, v19
    v_sub_f32 v216, 0, v16
    v_sub_f32 v217, 0, v16
    v_sub_f32 v218, 0, v16
    v_sub_f32 v219, 0, v16
    v_sub_f32 v220, 0, v17
    v_sub_f32 v221, 0, v17
    v_sub_f32 v222, 0, v17
    v_sub_f32 v223, 0, v17
    v_add_f32 v184, v184, v216
    v_add_f32 v185, v185, v216
    v_exp_f32 v184, v184
    v_exp_f32 v185, v185
    v_add_f32 v186, v186, v216
    v_add_f32 v187, v187, v216
    v_exp_f32 v186, v186
    v_exp_f32 v187, v187
    v_cvt_pk_bf16_f32 v24, v184, v185
    v_add_f32 v188, v188, v220
    v_add_f32 v189, v189, v220
    v_exp_f32 v188, v188
    v_exp_f32 v189, v189
    v_cvt_pk_bf16_f32 v25, v186, v187
    v_add_f32 v190, v190, v220
    v_add_f32 v191, v191, v220
    v_exp_f32 v190, v190
    v_exp_f32 v191, v191
    v_cvt_pk_bf16_f32 v28, v188, v189
    v_add_f32 v192, v192, v216
    v_add_f32 v193, v193, v216
    v_exp_f32 v192, v192
    v_exp_f32 v193, v193
    v_cvt_pk_bf16_f32 v29, v190, v191
    v_add_f32 v194, v194, v216
    v_add_f32 v195, v195, v216
    v_exp_f32 v194, v194
    v_exp_f32 v195, v195
    v_cvt_pk_bf16_f32 v26, v192, v193
    v_add_f32 v196, v196, v220
    v_add_f32 v197, v197, v220
    v_exp_f32 v196, v196
    v_exp_f32 v197, v197
    v_cvt_pk_bf16_f32 v27, v194, v195
    v_add_f32 v198, v198, v220
    v_add_f32 v199, v199, v220
    v_exp_f32 v198, v198
    v_exp_f32 v199, v199
    v_cvt_pk_bf16_f32 v30, v196, v197
    v_cvt_pk_bf16_f32 v31, v198, v199
    s_waitcnt lgkmcnt(3)
    v_mfma_f32_16x16x32_bf16 v[184:187], v[240:243], v[152:155], v[216:219]
    v_mfma_f32_16x16x32_bf16 v[188:191], v[240:243], v[168:171], v[220:223]
    ds_read_b128 v[232:235], v4 offset:20480
    v_add_f32 v200, v200, v216
    v_add_f32 v201, v201, v216
    v_exp_f32 v200, v200
    v_mfma_f32_16x16x32_bf16 v[248:251], v[12:15], v[24:27], 0
    s_waitcnt lgkmcnt(3)
    v_mfma_f32_16x16x32_bf16 v[192:195], v[244:247], v[152:155], v[216:219]
    v_exp_f32 v201, v201
    v_add_f32 v202, v202, v216
    v_add_f32 v203, v203, v216
    v_mfma_f32_16x16x32_bf16 v[196:199], v[244:247], v[168:171], v[220:223]
    s_add_u32 s22, s21, 0x14400
    s_add_u32 m0, s20, 0x24400
    s_nop 0
    buffer_load_dwordx4 v2, s[8:11], s22 offen sc1 lds
    ds_read_b128 v[236:239], v4 offset:21504
    v_exp_f32 v202, v202
    v_exp_f32 v203, v203
    v_mfma_f32_16x16x32_bf16 v[252:255], v[12:15], v[28:31], 0
    s_waitcnt lgkmcnt(3)
    v_mfma_f32_16x16x32_bf16 v[184:187], v[224:227], v[156:159], v[184:187]
    v_cvt_pk_bf16_f32 v32, v200, v201
    v_add_f32 v204, v204, v220
    v_add_f32 v205, v205, v220
    v_mfma_f32_16x16x32_bf16 v[188:191], v[224:227], v[172:175], v[188:191]
    ds_read_b128 v[240:243], v4 offset:22528
    v_exp_f32 v204, v204
    v_exp_f32 v205, v205
    v_cvt_pk_bf16_f32 v33, v202, v203
    s_mov_b64 s[4:5], s[40:41]
    s_mov_b32 s6, 0x800000
    s_mov_b32 s7, 0x20000
    v_bfe_u32 v20, v1, 2, 2
    v_lshlrev_b32 v21, 13, v20
    v_sub_u32 v3, v3, v21
    v_lshl_add_u32 v3, v20, 11, v3
    s_and_b32 s16, s2, 1
    s_lshl_b32 s24, s16, 22
    s_lshr_b32 s16, s2, 5
    s_lshl_b32 s16, s16, 8
    s_add_u32 s24, s24, s16
    s_lshl_b32 s16, s3, 14
    s_add_u32 s24, s24, s16
    s_add_u32 s24, s24, 196608
    s_waitcnt lgkmcnt(3)
    v_mfma_f32_16x16x32_bf16 v[192:195], v[228:231], v[156:159], v[192:195]
    v_add_f32 v206, v206, v220
    v_add_f32 v207, v207, v220
    v_mfma_f32_16x16x32_bf16 v[196:199], v[228:231], v[172:175], v[196:199]
    ds_read_b128 v[244:247], v4 offset:23552
    v_exp_f32 v206, v206
    v_exp_f32 v207, v207
    v_cvt_pk_bf16_f32 v36, v204, v205
    s_waitcnt lgkmcnt(3)
    v_mfma_f32_16x16x32_bf16 v[184:187], v[232:235], v[160:163], v[184:187]
    v_add_f32 v208, v208, v216
    v_add_f32 v209, v209, v216
    v_exp_f32 v208, v208
    v_mfma_f32_16x16x32_bf16 v[188:191], v[232:235], v[176:179], v[188:191]
    ds_read_b128 v[224:227], v4 offset:24576
    v_exp_f32 v209, v209
    v_cvt_pk_bf16_f32 v37, v206, v207
    s_waitcnt lgkmcnt(3)
    v_mfma_f32_16x16x32_bf16 v[192:195], v[236:239], v[160:163], v[192:195]
    v_add_f32 v210, v210, v216
    v_add_f32 v211, v211, v216
    v_exp_f32 v210, v210
    v_mfma_f32_16x16x32_bf16 v[196:199], v[236:239], v[176:179], v[196:199]
    ds_read_b128 v[228:231], v4 offset:25600
    v_exp_f32 v211, v211
    v_cvt_pk_bf16_f32 v34, v208, v209
    v_add_f32 v212, v212, v220
    s_waitcnt lgkmcnt(3)
    v_mfma_f32_16x16x32_bf16 v[184:187], v[240:243], v[164:167], v[184:187]
    v_add_f32 v213, v213, v220
    v_exp_f32 v212, v212
    v_mfma_f32_16x16x32_bf16 v[188:191], v[240:243], v[180:183], v[188:191]
    ds_read_b128 v[232:235], v4 offset:26624
    v_exp_f32 v213, v213
    v_cvt_pk_bf16_f32 v35, v210, v211
    v_add_f32 v214, v214, v220
    s_waitcnt lgkmcnt(3)
    v_mfma_f32_16x16x32_bf16 v[192:195], v[244:247], v[164:167], v[192:195]
    v_add_f32 v215, v215, v220
    v_exp_f32 v214, v214
    v_exp_f32 v215, v215
    v_mfma_f32_16x16x32_bf16 v[196:199], v[244:247], v[180:183], v[196:199]
    ds_read_b128 v[236:239], v4 offset:27648
    v_cvt_pk_bf16_f32 v38, v212, v213
    v_cvt_pk_bf16_f32 v39, v214, v215
    s_waitcnt lgkmcnt(3)
    v_mfma_f32_16x16x32_bf16 v[200:203], v[224:227], v[152:155], v[216:219]
    v_mfma_f32_16x16x32_bf16 v[204:207], v[224:227], v[168:171], v[220:223]
    ds_read_b128 v[240:243], v4 offset:28672
    v_exp_f32 v184, v184
    v_exp_f32 v185, v185
    v_mfma_f32_16x16x32_bf16 v[248:251], v[12:15], v[32:35], v[248:251]
    s_waitcnt lgkmcnt(3)
    v_mfma_f32_16x16x32_bf16 v[208:211], v[228:231], v[152:155], v[216:219]
    v_exp_f32 v186, v186
    v_exp_f32 v187, v187
    v_mfma_f32_16x16x32_bf16 v[212:215], v[228:231], v[168:171], v[220:223]
    ds_read_b128 v[244:247], v4 offset:29696
    v_cvt_pk_bf16_f32 v40, v184, v185
    v_mfma_f32_16x16x32_bf16 v[252:255], v[12:15], v[36:39], v[252:255]
    s_waitcnt lgkmcnt(3)
    v_mfma_f32_16x16x32_bf16 v[200:203], v[232:235], v[156:159], v[200:203]
    v_exp_f32 v188, v188
    v_exp_f32 v189, v189
    v_mfma_f32_16x16x32_bf16 v[204:207], v[232:235], v[172:175], v[204:207]
    ds_read_b128 v[224:227], v4 offset:30720
    v_cvt_pk_bf16_f32 v41, v186, v187
    s_waitcnt lgkmcnt(3)
    v_mfma_f32_16x16x32_bf16 v[208:211], v[236:239], v[156:159], v[208:211]
    v_exp_f32 v190, v190
    v_exp_f32 v191, v191
    v_mfma_f32_16x16x32_bf16 v[212:215], v[236:239], v[172:175], v[212:215]
    ds_read_b128 v[228:231], v4 offset:31744
    v_cvt_pk_bf16_f32 v44, v188, v189
    v_exp_f32 v192, v192
    s_waitcnt lgkmcnt(3)
    v_mfma_f32_16x16x32_bf16 v[200:203], v[240:243], v[160:163], v[200:203]
    v_exp_f32 v193, v193
    v_mfma_f32_16x16x32_bf16 v[204:207], v[240:243], v[176:179], v[204:207]
    s_barrier
    ds_read_b128 v[232:235], v4 offset:32768
    v_cvt_pk_bf16_f32 v45, v190, v191
    v_exp_f32 v194, v194
    s_waitcnt lgkmcnt(3)
    v_mfma_f32_16x16x32_bf16 v[208:211], v[244:247], v[160:163], v[208:211]
    v_exp_f32 v195, v195
    v_mfma_f32_16x16x32_bf16 v[212:215], v[244:247], v[176:179], v[212:215]
    s_add_u32 s22, s21, 0x18000
    s_add_u32 m0, s20, 0x10000
    s_nop 0
    buffer_load_dwordx4 v2, s[8:11], s22 offen sc1 lds
    ds_read_b128 v[236:239], v4 offset:33792
    v_cvt_pk_bf16_f32 v42, v192, v193
    v_exp_f32 v196, v196
    s_waitcnt lgkmcnt(3)
    v_mfma_f32_16x16x32_bf16 v[200:203], v[224:227], v[164:167], v[200:203]
    v_exp_f32 v197, v197
    v_cvt_pk_bf16_f32 v43, v194, v195
    v_mfma_f32_16x16x32_bf16 v[204:207], v[224:227], v[180:183], v[204:207]
    ds_read_b128 v[240:243], v4 offset:34816
    v_exp_f32 v198, v198
    s_waitcnt lgkmcnt(3)
    v_mfma_f32_16x16x32_bf16 v[208:211], v[228:231], v[164:167], v[208:211]
    v_exp_f32 v199, v199
    v_cvt_pk_bf16_f32 v46, v196, v197
    v_mfma_f32_16x16x32_bf16 v[212:215], v[228:231], v[180:183], v[212:215]
    ds_read_b128 v[244:247], v4 offset:35840
    v_cvt_pk_bf16_f32 v47, v198, v199
    s_waitcnt lgkmcnt(3)
    v_mfma_f32_16x16x32_bf16 v[184:187], v[232:235], v[152:155], v[216:219]
    v_mfma_f32_16x16x32_bf16 v[188:191], v[232:235], v[168:171], v[220:223]
    ds_read_b128 v[224:227], v4 offset:36864
    v_exp_f32 v200, v200
    v_exp_f32 v201, v201
    v_mfma_f32_16x16x32_bf16 v[248:251], v[12:15], v[40:43], v[248:251]
    s_waitcnt lgkmcnt(3)
    v_mfma_f32_16x16x32_bf16 v[192:195], v[236:239], v[152:155], v[216:219]
    v_exp_f32 v202, v202
    v_exp_f32 v203, v203
    v_mfma_f32_16x16x32_bf16 v[196:199], v[236:239], v[168:171], v[220:223]
    s_add_u32 s22, s21, 0x18400
    s_add_u32 m0, s20, 0x10400
    s_nop 0
    buffer_load_dwordx4 v2, s[8:11], s22 offen sc1 lds
    ds_read_b128 v[228:231], v4 offset:37888
    v_cvt_pk_bf16_f32 v48, v200, v201
    v_mfma_f32_16x16x32_bf16 v[252:255], v[12:15], v[44:47], v[252:255]
    s_waitcnt lgkmcnt(3)
    v_mfma_f32_16x16x32_bf16 v[184:187], v[240:243], v[156:159], v[184:187]
    v_exp_f32 v204, v204
    v_exp_f32 v205, v205
    v_mfma_f32_16x16x32_bf16 v[188:191], v[240:243], v[172:175], v[188:191]
    ds_read_b128 v[232:235], v4 offset:38912
    v_cvt_pk_bf16_f32 v49, v202, v203
    s_waitcnt lgkmcnt(3)
    v_mfma_f32_16x16x32_bf16 v[192:195], v[244:247], v[156:159], v[192:195]
    v_exp_f32 v206, v206
    v_exp_f32 v207, v207
    v_mfma_f32_16x16x32_bf16 v[196:199], v[244:247], v[172:175], v[196:199]
    ds_read_b128 v[236:239], v4 offset:39936
    v_cvt_pk_bf16_f32 v52, v204, v205
    v_exp_f32 v208, v208
    s_waitcnt lgkmcnt(3)
    v_mfma_f32_16x16x32_bf16 v[184:187], v[224:227], v[160:163], v[184:187]
    v_exp_f32 v209, v209
    v_mfma_f32_16x16x32_bf16 v[188:191], v[224:227], v[176:179], v[188:191]
    ds_read_b128 v[240:243], v4 offset:40960
    v_cvt_pk_bf16_f32 v53, v206, v207
    v_exp_f32 v210, v210
    s_waitcnt lgkmcnt(3)
    v_mfma_f32_16x16x32_bf16 v[192:195], v[228:231], v[160:163], v[192:195]
    v_exp_f32 v211, v211
    v_mfma_f32_16x16x32_bf16 v[196:199], v[228:231], v[176:179], v[196:199]
    ds_read_b128 v[244:247], v4 offset:41984
    v_cvt_pk_bf16_f32 v50, v208, v209
    v_exp_f32 v212, v212
    s_waitcnt lgkmcnt(3)
    v_mfma_f32_16x16x32_bf16 v[184:187], v[232:235], v[164:167], v[184:187]
    v_exp_f32 v213, v213
    v_cvt_pk_bf16_f32 v51, v210, v211
    v_mfma_f32_16x16x32_bf16 v[188:191], v[232:235], v[180:183], v[188:191]
    ds_read_b128 v[224:227], v4 offset:43008
    v_exp_f32 v214, v214
    s_waitcnt lgkmcnt(3)
    v_mfma_f32_16x16x32_bf16 v[192:195], v[236:239], v[164:167], v[192:195]
    v_exp_f32 v215, v215
    v_cvt_pk_bf16_f32 v54, v212, v213
    v_mfma_f32_16x16x32_bf16 v[196:199], v[236:239], v[180:183], v[196:199]
    ds_read_b128 v[228:231], v4 offset:44032
    v_cvt_pk_bf16_f32 v55, v214, v215
    s_waitcnt lgkmcnt(3)
    v_mfma_f32_16x16x32_bf16 v[200:203], v[240:243], v[152:155], v[216:219]
    v_mfma_f32_16x16x32_bf16 v[204:207], v[240:243], v[168:171], v[220:223]
    ds_read_b128 v[232:235], v4 offset:45056
    v_exp_f32 v184, v184
    v_exp_f32 v185, v185
    v_mfma_f32_16x16x32_bf16 v[248:251], v[12:15], v[48:51], v[248:251]
    s_waitcnt lgkmcnt(3)
    v_mfma_f32_16x16x32_bf16 v[208:211], v[244:247], v[152:155], v[216:219]
    v_exp_f32 v186, v186
    v_exp_f32 v187, v187
    v_mfma_f32_16x16x32_bf16 v[212:215], v[244:247], v[168:171], v[220:223]
    ds_read_b128 v[236:239], v4 offset:46080
    v_cvt_pk_bf16_f32 v56, v184, v185
    v_mfma_f32_16x16x32_bf16 v[252:255], v[12:15], v[52:55], v[252:255]
    s_waitcnt lgkmcnt(3)
    v_mfma_f32_16x16x32_bf16 v[200:203], v[224:227], v[156:159], v[200:203]
    v_exp_f32 v188, v188
    v_exp_f32 v189, v189
    v_mfma_f32_16x16x32_bf16 v[204:207], v[224:227], v[172:175], v[204:207]
    ds_read_b128 v[240:243], v4 offset:47104
    v_cvt_pk_bf16_f32 v57, v186, v187
    s_waitcnt lgkmcnt(3)
    v_mfma_f32_16x16x32_bf16 v[208:211], v[228:231], v[156:159], v[208:211]
    v_exp_f32 v190, v190
    v_exp_f32 v191, v191
    v_mfma_f32_16x16x32_bf16 v[212:215], v[228:231], v[172:175], v[212:215]
    ds_read_b128 v[244:247], v4 offset:48128
    v_cvt_pk_bf16_f32 v60, v188, v189
    v_exp_f32 v192, v192
    s_waitcnt lgkmcnt(3)
    v_mfma_f32_16x16x32_bf16 v[200:203], v[232:235], v[160:163], v[200:203]
    v_exp_f32 v193, v193
    v_mfma_f32_16x16x32_bf16 v[204:207], v[232:235], v[176:179], v[204:207]
    s_waitcnt vmcnt(7)
    s_barrier
    ds_read_b128 v[224:227], v4 offset:49152
    v_cvt_pk_bf16_f32 v61, v190, v191
    v_exp_f32 v194, v194
    s_waitcnt lgkmcnt(3)
    v_mfma_f32_16x16x32_bf16 v[208:211], v[236:239], v[160:163], v[208:211]
    v_exp_f32 v195, v195
    v_mfma_f32_16x16x32_bf16 v[212:215], v[236:239], v[176:179], v[212:215]
    s_add_u32 s22, s21, 0x1c000
    s_add_u32 m0, s20, 0x14000
    s_nop 0
    buffer_load_dwordx4 v2, s[8:11], s22 offen sc1 lds
    ds_read_b128 v[228:231], v4 offset:50176
    v_cvt_pk_bf16_f32 v58, v192, v193
    v_exp_f32 v196, v196
    s_waitcnt lgkmcnt(3)
    v_mfma_f32_16x16x32_bf16 v[200:203], v[240:243], v[164:167], v[200:203]
    v_exp_f32 v197, v197
    v_cvt_pk_bf16_f32 v59, v194, v195
    v_mfma_f32_16x16x32_bf16 v[204:207], v[240:243], v[180:183], v[204:207]
    ds_read_b128 v[232:235], v4 offset:51200
    v_exp_f32 v198, v198
    s_waitcnt lgkmcnt(3)
    v_mfma_f32_16x16x32_bf16 v[208:211], v[244:247], v[164:167], v[208:211]
    v_exp_f32 v199, v199
    v_cvt_pk_bf16_f32 v62, v196, v197
    v_mfma_f32_16x16x32_bf16 v[212:215], v[244:247], v[180:183], v[212:215]
    ds_read_b128 v[236:239], v4 offset:52224
    v_cvt_pk_bf16_f32 v63, v198, v199
    s_waitcnt lgkmcnt(3)
    v_mfma_f32_16x16x32_bf16 v[184:187], v[224:227], v[152:155], v[216:219]
    v_mfma_f32_16x16x32_bf16 v[188:191], v[224:227], v[168:171], v[220:223]
    ds_read_b128 v[240:243], v4 offset:53248
    v_exp_f32 v200, v200
    v_exp_f32 v201, v201
    v_mfma_f32_16x16x32_bf16 v[248:251], v[12:15], v[56:59], v[248:251]
    s_waitcnt lgkmcnt(3)
    v_mfma_f32_16x16x32_bf16 v[192:195], v[228:231], v[152:155], v[216:219]
    v_exp_f32 v202, v202
    v_exp_f32 v203, v203
    v_mfma_f32_16x16x32_bf16 v[196:199], v[228:231], v[168:171], v[220:223]
    s_add_u32 s22, s21, 0x1c400
    s_add_u32 m0, s20, 0x14400
    s_nop 0
    buffer_load_dwordx4 v2, s[8:11], s22 offen sc1 lds
    ds_read_b128 v[244:247], v4 offset:54272
    v_cvt_pk_bf16_f32 v64, v200, v201
    v_mfma_f32_16x16x32_bf16 v[252:255], v[12:15], v[60:63], v[252:255]
    s_waitcnt lgkmcnt(3)
    v_mfma_f32_16x16x32_bf16 v[184:187], v[232:235], v[156:159], v[184:187]
    v_exp_f32 v204, v204
    v_exp_f32 v205, v205
    v_mfma_f32_16x16x32_bf16 v[188:191], v[232:235], v[172:175], v[188:191]
    ds_read_b128 v[224:227], v4 offset:55296
    v_cvt_pk_bf16_f32 v65, v202, v203
    s_waitcnt lgkmcnt(3)
    v_mfma_f32_16x16x32_bf16 v[192:195], v[236:239], v[156:159], v[192:195]
    v_exp_f32 v206, v206
    v_exp_f32 v207, v207
    v_mfma_f32_16x16x32_bf16 v[196:199], v[236:239], v[172:175], v[196:199]
    ds_read_b128 v[228:231], v4 offset:56320
    v_cvt_pk_bf16_f32 v68, v204, v205
    v_exp_f32 v208, v208
    s_waitcnt lgkmcnt(3)
    v_mfma_f32_16x16x32_bf16 v[184:187], v[240:243], v[160:163], v[184:187]
    v_exp_f32 v209, v209
    v_mfma_f32_16x16x32_bf16 v[188:191], v[240:243], v[176:179], v[188:191]
    ds_read_b128 v[232:235], v4 offset:57344
    v_cvt_pk_bf16_f32 v69, v206, v207
    v_exp_f32 v210, v210
    s_waitcnt lgkmcnt(3)
    v_mfma_f32_16x16x32_bf16 v[192:195], v[244:247], v[160:163], v[192:195]
    v_exp_f32 v211, v211
    v_mfma_f32_16x16x32_bf16 v[196:199], v[244:247], v[176:179], v[196:199]
    ds_read_b128 v[236:239], v4 offset:58368
    v_cvt_pk_bf16_f32 v66, v208, v209
    v_exp_f32 v212, v212
    s_waitcnt lgkmcnt(3)
    v_mfma_f32_16x16x32_bf16 v[184:187], v[224:227], v[164:167], v[184:187]
    v_exp_f32 v213, v213
    v_cvt_pk_bf16_f32 v67, v210, v211
    v_mfma_f32_16x16x32_bf16 v[188:191], v[224:227], v[180:183], v[188:191]
    ds_read_b128 v[240:243], v4 offset:59392
    v_exp_f32 v214, v214
    s_waitcnt lgkmcnt(3)
    v_mfma_f32_16x16x32_bf16 v[192:195], v[228:231], v[164:167], v[192:195]
    v_exp_f32 v215, v215
    v_cvt_pk_bf16_f32 v70, v212, v213
    v_mfma_f32_16x16x32_bf16 v[196:199], v[228:231], v[180:183], v[196:199]
    ds_read_b128 v[244:247], v4 offset:60416
    v_cvt_pk_bf16_f32 v71, v214, v215
    s_waitcnt lgkmcnt(3)
    v_mfma_f32_16x16x32_bf16 v[200:203], v[232:235], v[152:155], v[216:219]
    v_mfma_f32_16x16x32_bf16 v[204:207], v[232:235], v[168:171], v[220:223]
    ds_read_b128 v[224:227], v4 offset:61440
    v_exp_f32 v184, v184
    v_exp_f32 v185, v185
    v_mfma_f32_16x16x32_bf16 v[248:251], v[12:15], v[64:67], v[248:251]
    s_waitcnt lgkmcnt(3)
    v_mfma_f32_16x16x32_bf16 v[208:211], v[236:239], v[152:155], v[216:219]
    v_exp_f32 v186, v186
    v_exp_f32 v187, v187
    v_mfma_f32_16x16x32_bf16 v[212:215], v[236:239], v[168:171], v[220:223]
    ds_read_b128 v[228:231], v4 offset:62464
    v_cvt_pk_bf16_f32 v72, v184, v185
    v_mfma_f32_16x16x32_bf16 v[252:255], v[12:15], v[68:71], v[252:255]
    s_waitcnt lgkmcnt(3)
    v_mfma_f32_16x16x32_bf16 v[200:203], v[240:243], v[156:159], v[200:203]
    v_exp_f32 v188, v188
    v_exp_f32 v189, v189
    v_mfma_f32_16x16x32_bf16 v[204:207], v[240:243], v[172:175], v[204:207]
    ds_read_b128 v[232:235], v4 offset:63488
    v_cvt_pk_bf16_f32 v73, v186, v187
    s_waitcnt lgkmcnt(3)
    v_mfma_f32_16x16x32_bf16 v[208:211], v[244:247], v[156:159], v[208:211]
    v_exp_f32 v190, v190
    v_exp_f32 v191, v191
    v_mfma_f32_16x16x32_bf16 v[212:215], v[244:247], v[172:175], v[212:215]
    ds_read_b128 v[236:239], v4 offset:64512
    v_cvt_pk_bf16_f32 v76, v188, v189
    v_exp_f32 v192, v192
    s_waitcnt lgkmcnt(3)
    v_mfma_f32_16x16x32_bf16 v[200:203], v[224:227], v[160:163], v[200:203]
    v_exp_f32 v193, v193
    v_mfma_f32_16x16x32_bf16 v[204:207], v[224:227], v[176:179], v[204:207]
    s_waitcnt vmcnt(7)
    s_barrier
    ds_read_b128 v[240:243], v5 offset:0
    v_cvt_pk_bf16_f32 v77, v190, v191
    v_exp_f32 v194, v194
    s_waitcnt lgkmcnt(3)
    v_mfma_f32_16x16x32_bf16 v[208:211], v[228:231], v[160:163], v[208:211]
    v_exp_f32 v195, v195
    v_mfma_f32_16x16x32_bf16 v[212:215], v[228:231], v[176:179], v[212:215]
    s_add_u32 s22, s21, 0x80000
    s_add_u32 m0, s20, 0x18000
    s_nop 0
    buffer_load_dwordx4 v2, s[8:11], s22 offen sc1 lds
    ds_read_b128 v[244:247], v5 offset:1024
    v_cvt_pk_bf16_f32 v74, v192, v193
    v_exp_f32 v196, v196
    s_waitcnt lgkmcnt(3)
    v_mfma_f32_16x16x32_bf16 v[200:203], v[232:235], v[164:167], v[200:203]
    v_exp_f32 v197, v197
    v_cvt_pk_bf16_f32 v75, v194, v195
    v_mfma_f32_16x16x32_bf16 v[204:207], v[232:235], v[180:183], v[204:207]
    ds_read_b128 v[224:227], v5 offset:2048
    v_exp_f32 v198, v198
    s_waitcnt lgkmcnt(3)
    v_mfma_f32_16x16x32_bf16 v[208:211], v[236:239], v[164:167], v[208:211]
    v_exp_f32 v199, v199
    v_cvt_pk_bf16_f32 v78, v196, v197
    v_mfma_f32_16x16x32_bf16 v[212:215], v[236:239], v[180:183], v[212:215]
    ds_read_b128 v[228:231], v5 offset:3072
    v_cvt_pk_bf16_f32 v79, v198, v199
    s_waitcnt lgkmcnt(3)
    v_mfma_f32_16x16x32_bf16 v[184:187], v[240:243], v[152:155], v[216:219]
    v_mfma_f32_16x16x32_bf16 v[188:191], v[240:243], v[168:171], v[220:223]
    ds_read_b128 v[232:235], v5 offset:4096
    v_exp_f32 v200, v200
    v_exp_f32 v201, v201
    v_mfma_f32_16x16x32_bf16 v[248:251], v[12:15], v[72:75], v[248:251]
    s_waitcnt lgkmcnt(3)
    v_mfma_f32_16x16x32_bf16 v[192:195], v[244:247], v[152:155], v[216:219]
    v_exp_f32 v202, v202
    v_exp_f32 v203, v203
    v_mfma_f32_16x16x32_bf16 v[196:199], v[244:247], v[168:171], v[220:223]
    s_add_u32 s22, s21, 0x80400
    s_add_u32 m0, s20, 0x18400
    s_nop 0
    buffer_load_dwordx4 v2, s[8:11], s22 offen sc1 lds
    ds_read_b128 v[236:239], v5 offset:5120
    v_cvt_pk_bf16_f32 v80, v200, v201
    v_mfma_f32_16x16x32_bf16 v[252:255], v[12:15], v[76:79], v[252:255]
    s_waitcnt lgkmcnt(3)
    v_mfma_f32_16x16x32_bf16 v[184:187], v[224:227], v[156:159], v[184:187]
    v_exp_f32 v204, v204
    v_exp_f32 v205, v205
    s_add_u32 s22, s18, 0
    s_add_u32 m0, s15, 0
    s_nop 0
    buffer_load_dwordx4 v11, s[64:67], s22 offen lds
    v_mfma_f32_16x16x32_bf16 v[188:191], v[224:227], v[172:175], v[188:191]
    ds_read_b128 v[240:243], v5 offset:6144
    v_cvt_pk_bf16_f32 v81, v202, v203
    s_waitcnt lgkmcnt(3)
    v_mfma_f32_16x16x32_bf16 v[192:195], v[228:231], v[156:159], v[192:195]
    v_exp_f32 v206, v206
    v_exp_f32 v207, v207
    v_mfma_f32_16x16x32_bf16 v[196:199], v[228:231], v[172:175], v[196:199]
    ds_read_b128 v[244:247], v5 offset:7168
    v_cvt_pk_bf16_f32 v84, v204, v205
    v_exp_f32 v208, v208
    s_waitcnt lgkmcnt(3)
    v_mfma_f32_16x16x32_bf16 v[184:187], v[232:235], v[160:163], v[184:187]
    v_exp_f32 v209, v209
    v_mfma_f32_16x16x32_bf16 v[188:191], v[232:235], v[176:179], v[188:191]
    ds_read_b128 v[224:227], v5 offset:8192
    v_cvt_pk_bf16_f32 v85, v206, v207
    v_exp_f32 v210, v210
    s_waitcnt lgkmcnt(3)
    v_mfma_f32_16x16x32_bf16 v[192:195], v[236:239], v[160:163], v[192:195]
    v_exp_f32 v211, v211
    v_mfma_f32_16x16x32_bf16 v[196:199], v[236:239], v[176:179], v[196:199]
    ds_read_b128 v[228:231], v5 offset:9216
    v_cvt_pk_bf16_f32 v82, v208, v209
    v_exp_f32 v212, v212
    s_waitcnt lgkmcnt(3)
    v_mfma_f32_16x16x32_bf16 v[184:187], v[240:243], v[164:167], v[184:187]
    v_exp_f32 v213, v213
    v_cvt_pk_bf16_f32 v83, v210, v211
    v_mfma_f32_16x16x32_bf16 v[188:191], v[240:243], v[180:183], v[188:191]
    ds_read_b128 v[232:235], v5 offset:10240
    v_exp_f32 v214, v214
    s_waitcnt lgkmcnt(3)
    v_mfma_f32_16x16x32_bf16 v[192:195], v[244:247], v[164:167], v[192:195]
    v_exp_f32 v215, v215
    v_cvt_pk_bf16_f32 v86, v212, v213
    v_mfma_f32_16x16x32_bf16 v[196:199], v[244:247], v[180:183], v[196:199]
    ds_read_b128 v[236:239], v5 offset:11264
    v_cvt_pk_bf16_f32 v87, v214, v215
    s_waitcnt lgkmcnt(3)
    v_mfma_f32_16x16x32_bf16 v[200:203], v[224:227], v[152:155], v[216:219]
    v_mfma_f32_16x16x32_bf16 v[204:207], v[224:227], v[168:171], v[220:223]
    ds_read_b128 v[240:243], v5 offset:12288
    v_exp_f32 v184, v184
    v_exp_f32 v185, v185
    v_mfma_f32_16x16x32_bf16 v[248:251], v[12:15], v[80:83], v[248:251]
    s_waitcnt lgkmcnt(3)
    v_mfma_f32_16x16x32_bf16 v[208:211], v[228:231], v[152:155], v[216:219]
    v_exp_f32 v186, v186
    v_exp_f32 v187, v187
    v_mfma_f32_16x16x32_bf16 v[212:215], v[228:231], v[168:171], v[220:223]
    ds_read_b128 v[244:247], v5 offset:13312
    v_cvt_pk_bf16_f32 v88, v184, v185
    s_add_u32 s22, s18, 7168
    s_add_u32 m0, s15, 1024
    s_nop 0
    buffer_load_dwordx4 v11, s[64:67], s22 offen lds
    v_mfma_f32_16x16x32_bf16 v[252:255], v[12:15], v[84:87], v[252:255]
    s_waitcnt lgkmcnt(3)
    v_mfma_f32_16x16x32_bf16 v[200:203], v[232:235], v[156:159], v[200:203]
    v_exp_f32 v188, v188
    v_exp_f32 v189, v189
    v_mfma_f32_16x16x32_bf16 v[204:207], v[232:235], v[172:175], v[204:207]
    ds_read_b128 v[224:227], v5 offset:14336
    v_cvt_pk_bf16_f32 v89, v186, v187
    s_waitcnt lgkmcnt(3)
    v_mfma_f32_16x16x32_bf16 v[208:211], v[236:239], v[156:159], v[208:211]
    v_exp_f32 v190, v190
    v_exp_f32 v191, v191
    v_mfma_f32_16x16x32_bf16 v[212:215], v[236:239], v[172:175], v[212:215]
    ds_read_b128 v[228:231], v5 offset:15360
    v_cvt_pk_bf16_f32 v92, v188, v189
    v_exp_f32 v192, v192
    s_waitcnt lgkmcnt(3)
    v_mfma_f32_16x16x32_bf16 v[200:203], v[240:243], v[160:163], v[200:203]
    v_exp_f32 v193, v193
    v_mfma_f32_16x16x32_bf16 v[204:207], v[240:243], v[176:179], v[204:207]
    s_waitcnt vmcnt(8)
    s_barrier
    ds_read_b128 v[232:235], v5 offset:16384
    v_cvt_pk_bf16_f32 v93, v190, v191
    v_exp_f32 v194, v194
    s_waitcnt lgkmcnt(3)
    v_mfma_f32_16x16x32_bf16 v[208:211], v[244:247], v[160:163], v[208:211]
    v_exp_f32 v195, v195
    v_mfma_f32_16x16x32_bf16 v[212:215], v[244:247], v[176:179], v[212:215]
    s_add_u32 s22, s21, 0x84000
    s_add_u32 m0, s20, 0x1c000
    s_nop 0
    buffer_load_dwordx4 v2, s[8:11], s22 offen sc1 lds
    ds_read_b128 v[236:239], v5 offset:17408
    v_cvt_pk_bf16_f32 v90, v192, v193
    v_exp_f32 v196, v196
    s_waitcnt lgkmcnt(3)
    v_mfma_f32_16x16x32_bf16 v[200:203], v[224:227], v[164:167], v[200:203]
    v_exp_f32 v197, v197
    v_cvt_pk_bf16_f32 v91, v194, v195
    v_mfma_f32_16x16x32_bf16 v[204:207], v[224:227], v[180:183], v[204:207]
    ds_read_b128 v[240:243], v5 offset:18432
    v_exp_f32 v198, v198
    s_waitcnt lgkmcnt(3)
    v_mfma_f32_16x16x32_bf16 v[208:211], v[228:231], v[164:167], v[208:211]
    v_exp_f32 v199, v199
    v_cvt_pk_bf16_f32 v94, v196, v197
    v_mfma_f32_16x16x32_bf16 v[212:215], v[228:231], v[180:183], v[212:215]
    ds_read_b128 v[244:247], v5 offset:19456
    v_cvt_pk_bf16_f32 v95, v198, v199
    s_waitcnt lgkmcnt(3)
    v_mfma_f32_16x16x32_bf16 v[184:187], v[232:235], v[152:155], v[216:219]
    v_mfma_f32_16x16x32_bf16 v[188:191], v[232:235], v[168:171], v[220:223]
    ds_read_b128 v[224:227], v5 offset:20480
    v_exp_f32 v200, v200
    v_exp_f32 v201, v201
    v_mfma_f32_16x16x32_bf16 v[248:251], v[12:15], v[88:91], v[248:251]
    s_waitcnt lgkmcnt(3)
    v_mfma_f32_16x16x32_bf16 v[192:195], v[236:239], v[152:155], v[216:219]
    v_exp_f32 v202, v202
    v_exp_f32 v203, v203
    v_mfma_f32_16x16x32_bf16 v[196:199], v[236:239], v[168:171], v[220:223]
    s_add_u32 s22, s21, 0x84400
    s_add_u32 m0, s20, 0x1c400
    s_nop 0
    buffer_load_dwordx4 v2, s[8:11], s22 offen sc1 lds
    ds_read_b128 v[228:231], v5 offset:21504
    v_cvt_pk_bf16_f32 v96, v200, v201
    s_add_u32 s22, s18, 14336
    s_add_u32 m0, s15, 2048
    s_nop 0
    buffer_load_dwordx4 v11, s[64:67], s22 offen lds
    v_mfma_f32_16x16x32_bf16 v[252:255], v[12:15], v[92:95], v[252:255]
    s_waitcnt lgkmcnt(3)
    v_mfma_f32_16x16x32_bf16 v[184:187], v[240:243], v[156:159], v[184:187]
    v_exp_f32 v204, v204
    v_exp_f32 v205, v205
    v_mfma_f32_16x16x32_bf16 v[188:191], v[240:243], v[172:175], v[188:191]
    ds_read_b128 v[232:235], v5 offset:22528
    v_cvt_pk_bf16_f32 v97, v202, v203
    s_waitcnt lgkmcnt(3)
    v_mfma_f32_16x16x32_bf16 v[192:195], v[244:247], v[156:159], v[192:195]
    v_exp_f32 v206, v206
    v_exp_f32 v207, v207
    v_mfma_f32_16x16x32_bf16 v[196:199], v[244:247], v[172:175], v[196:199]
    ds_read_b128 v[236:239], v5 offset:23552
    v_cvt_pk_bf16_f32 v100, v204, v205
    v_exp_f32 v208, v208
    s_waitcnt lgkmcnt(3)
    v_mfma_f32_16x16x32_bf16 v[184:187], v[224:227], v[160:163], v[184:187]
    v_exp_f32 v209, v209
    v_mfma_f32_16x16x32_bf16 v[188:191], v[224:227], v[176:179], v[188:191]
    ds_read_b128 v[240:243], v5 offset:24576
    v_cvt_pk_bf16_f32 v101, v206, v207
    v_exp_f32 v210, v210
    s_waitcnt lgkmcnt(3)
    v_mfma_f32_16x16x32_bf16 v[192:195], v[228:231], v[160:163], v[192:195]
    v_exp_f32 v211, v211
    v_mfma_f32_16x16x32_bf16 v[196:199], v[228:231], v[176:179], v[196:199]
    ds_read_b128 v[244:247], v5 offset:25600
    v_cvt_pk_bf16_f32 v98, v208, v209
    v_exp_f32 v212, v212
    s_waitcnt lgkmcnt(3)
    v_mfma_f32_16x16x32_bf16 v[184:187], v[232:235], v[164:167], v[184:187]
    v_exp_f32 v213, v213
    v_cvt_pk_bf16_f32 v99, v210, v211
    v_mfma_f32_16x16x32_bf16 v[188:191], v[232:235], v[180:183], v[188:191]
    ds_read_b128 v[224:227], v5 offset:26624
    v_exp_f32 v214, v214
    s_waitcnt lgkmcnt(3)
    v_mfma_f32_16x16x32_bf16 v[192:195], v[236:239], v[164:167], v[192:195]
    v_exp_f32 v215, v215
    v_cvt_pk_bf16_f32 v102, v212, v213
    v_mfma_f32_16x16x32_bf16 v[196:199], v[236:239], v[180:183], v[196:199]
    ds_read_b128 v[228:231], v5 offset:27648
    v_cvt_pk_bf16_f32 v103, v214, v215
    s_waitcnt lgkmcnt(3)
    v_mfma_f32_16x16x32_bf16 v[200:203], v[240:243], v[152:155], v[216:219]
    v_mfma_f32_16x16x32_bf16 v[204:207], v[240:243], v[168:171], v[220:223]
    ds_read_b128 v[232:235], v5 offset:28672
    v_exp_f32 v184, v184
    v_exp_f32 v185, v185
    v_mfma_f32_16x16x32_bf16 v[248:251], v[12:15], v[96:99], v[248:251]
    s_waitcnt lgkmcnt(3)
    v_mfma_f32_16x16x32_bf16 v[208:211], v[244:247], v[152:155], v[216:219]
    v_exp_f32 v186, v186
    v_exp_f32 v187, v187
    s_add_u32 s22, s18, 21504
    s_add_u32 m0, s15, 3072
    s_nop 0
    buffer_load_dwordx4 v11, s[64:67], s22 offen lds
    v_mfma_f32_16x16x32_bf16 v[212:215], v[244:247], v[168:171], v[220:223]
    ds_read_b128 v[236:239], v5 offset:29696
    v_cvt_pk_bf16_f32 v104, v184, v185
    v_mfma_f32_16x16x32_bf16 v[252:255], v[12:15], v[100:103], v[252:255]
    s_waitcnt lgkmcnt(3)
    v_mfma_f32_16x16x32_bf16 v[200:203], v[224:227], v[156:159], v[200:203]
    v_exp_f32 v188, v188
    v_exp_f32 v189, v189
    v_mfma_f32_16x16x32_bf16 v[204:207], v[224:227], v[172:175], v[204:207]
    ds_read_b128 v[240:243], v5 offset:30720
    v_cvt_pk_bf16_f32 v105, v186, v187
    s_waitcnt lgkmcnt(3)
    v_mfma_f32_16x16x32_bf16 v[208:211], v[228:231], v[156:159], v[208:211]
    v_exp_f32 v190, v190
    v_exp_f32 v191, v191
    v_mfma_f32_16x16x32_bf16 v[212:215], v[228:231], v[172:175], v[212:215]
    ds_read_b128 v[244:247], v5 offset:31744
    v_cvt_pk_bf16_f32 v108, v188, v189
    v_exp_f32 v192, v192
    s_waitcnt lgkmcnt(3)
    v_mfma_f32_16x16x32_bf16 v[200:203], v[232:235], v[160:163], v[200:203]
    v_exp_f32 v193, v193
    v_mfma_f32_16x16x32_bf16 v[204:207], v[232:235], v[176:179], v[204:207]
    s_waitcnt vmcnt(10)
    s_barrier
    ds_read_b128 v[224:227], v4 offset:0
    v_cvt_pk_bf16_f32 v109, v190, v191
    v_exp_f32 v194, v194
    s_waitcnt lgkmcnt(3)
    v_mfma_f32_16x16x32_bf16 v[208:211], v[236:239], v[160:163], v[208:211]
    v_exp_f32 v195, v195
    v_mfma_f32_16x16x32_bf16 v[212:215], v[236:239], v[176:179], v[212:215]
    s_add_u32 s22, s21, 0x88000
    s_add_u32 m0, s20, 0x20000
    s_nop 0
    buffer_load_dwordx4 v2, s[8:11], s22 offen sc1 lds
    ds_read_b128 v[228:231], v4 offset:1024
    v_cvt_pk_bf16_f32 v106, v192, v193
    v_exp_f32 v196, v196
    s_waitcnt lgkmcnt(3)
    v_mfma_f32_16x16x32_bf16 v[200:203], v[240:243], v[164:167], v[200:203]
    v_exp_f32 v197, v197
    v_cvt_pk_bf16_f32 v107, v194, v195
    v_mfma_f32_16x16x32_bf16 v[204:207], v[240:243], v[180:183], v[204:207]
    ds_read_b128 v[232:235], v4 offset:2048
    v_exp_f32 v198, v198
    s_waitcnt lgkmcnt(3)
    v_mfma_f32_16x16x32_bf16 v[208:211], v[244:247], v[164:167], v[208:211]
    v_exp_f32 v199, v199
    v_cvt_pk_bf16_f32 v110, v196, v197
    v_mfma_f32_16x16x32_bf16 v[212:215], v[244:247], v[180:183], v[212:215]
    ds_read_b128 v[236:239], v4 offset:3072
    v_cvt_pk_bf16_f32 v111, v198, v199
    s_waitcnt lgkmcnt(3)
    v_mfma_f32_16x16x32_bf16 v[184:187], v[224:227], v[152:155], v[216:219]
    v_mfma_f32_16x16x32_bf16 v[188:191], v[224:227], v[168:171], v[220:223]
    ds_read_b128 v[240:243], v4 offset:4096
    v_exp_f32 v200, v200
    v_exp_f32 v201, v201
    v_mfma_f32_16x16x32_bf16 v[248:251], v[12:15], v[104:107], v[248:251]
    s_waitcnt lgkmcnt(3)
    v_mfma_f32_16x16x32_bf16 v[192:195], v[228:231], v[152:155], v[216:219]
    v_exp_f32 v202, v202
    v_exp_f32 v203, v203
    s_add_u32 s22, s18, 28672
    s_add_u32 m0, s15, 4096
    s_nop 0
    buffer_load_dwordx4 v11, s[64:67], s22 offen lds
    v_mfma_f32_16x16x32_bf16 v[196:199], v[228:231], v[168:171], v[220:223]
    s_add_u32 s22, s21, 0x88400
    s_add_u32 m0, s20, 0x20400
    s_nop 0
    buffer_load_dwordx4 v2, s[8:11], s22 offen sc1 lds
    ds_read_b128 v[244:247], v4 offset:5120
    v_cvt_pk_bf16_f32 v112, v200, v201
    v_mfma_f32_16x16x32_bf16 v[252:255], v[12:15], v[108:111], v[252:255]
    s_waitcnt lgkmcnt(3)
    v_mfma_f32_16x16x32_bf16 v[184:187], v[232:235], v[156:159], v[184:187]
    v_exp_f32 v204, v204
    v_exp_f32 v205, v205
    v_mfma_f32_16x16x32_bf16 v[188:191], v[232:235], v[172:175], v[188:191]
    ds_read_b128 v[224:227], v4 offset:6144
    v_cvt_pk_bf16_f32 v113, v202, v203
    s_waitcnt lgkmcnt(3)
    v_mfma_f32_16x16x32_bf16 v[192:195], v[236:239], v[156:159], v[192:195]
    v_exp_f32 v206, v206
    v_exp_f32 v207, v207
    v_mfma_f32_16x16x32_bf16 v[196:199], v[236:239], v[172:175], v[196:199]
    ds_read_b128 v[228:231], v4 offset:7168
    v_cvt_pk_bf16_f32 v116, v204, v205
    v_exp_f32 v208, v208
    s_waitcnt lgkmcnt(3)
    v_mfma_f32_16x16x32_bf16 v[184:187], v[240:243], v[160:163], v[184:187]
    v_exp_f32 v209, v209
    v_mfma_f32_16x16x32_bf16 v[188:191], v[240:243], v[176:179], v[188:191]
    ds_read_b128 v[232:235], v4 offset:8192
    v_cvt_pk_bf16_f32 v117, v206, v207
    v_exp_f32 v210, v210
    s_waitcnt lgkmcnt(3)
    v_mfma_f32_16x16x32_bf16 v[192:195], v[244:247], v[160:163], v[192:195]
    v_exp_f32 v211, v211
    v_mfma_f32_16x16x32_bf16 v[196:199], v[244:247], v[176:179], v[196:199]
    ds_read_b128 v[236:239], v4 offset:9216
    v_cvt_pk_bf16_f32 v114, v208, v209
    v_exp_f32 v212, v212
    s_waitcnt lgkmcnt(3)
    v_mfma_f32_16x16x32_bf16 v[184:187], v[224:227], v[164:167], v[184:187]
    v_exp_f32 v213, v213
    v_cvt_pk_bf16_f32 v115, v210, v211
    v_mfma_f32_16x16x32_bf16 v[188:191], v[224:227], v[180:183], v[188:191]
    ds_read_b128 v[240:243], v4 offset:10240
    v_exp_f32 v214, v214
    s_waitcnt lgkmcnt(3)
    v_mfma_f32_16x16x32_bf16 v[192:195], v[228:231], v[164:167], v[192:195]
    v_exp_f32 v215, v215
    v_cvt_pk_bf16_f32 v118, v212, v213
    v_mfma_f32_16x16x32_bf16 v[196:199], v[228:231], v[180:183], v[196:199]
    ds_read_b128 v[244:247], v4 offset:11264
    v_cvt_pk_bf16_f32 v119, v214, v215
    s_waitcnt lgkmcnt(3)
    v_mfma_f32_16x16x32_bf16 v[200:203], v[232:235], v[152:155], v[216:219]
    v_mfma_f32_16x16x32_bf16 v[204:207], v[232:235], v[168:171], v[220:223]
    ds_read_b128 v[224:227], v4 offset:12288
    v_exp_f32 v184, v184
    v_exp_f32 v185, v185
    s_add_u32 s22, s18, 35840
    s_add_u32 m0, s15, 5120
    s_nop 0
    buffer_load_dwordx4 v11, s[64:67], s22 offen lds
    v_mfma_f32_16x16x32_bf16 v[248:251], v[12:15], v[112:115], v[248:251]
    s_waitcnt lgkmcnt(3)
    v_mfma_f32_16x16x32_bf16 v[208:211], v[236:239], v[152:155], v[216:219]
    v_exp_f32 v186, v186
    v_exp_f32 v187, v187
    v_mfma_f32_16x16x32_bf16 v[212:215], v[236:239], v[168:171], v[220:223]
    ds_read_b128 v[228:231], v4 offset:13312
    v_cvt_pk_bf16_f32 v120, v184, v185
    v_mfma_f32_16x16x32_bf16 v[252:255], v[12:15], v[116:119], v[252:255]
    s_waitcnt lgkmcnt(3)
    v_mfma_f32_16x16x32_bf16 v[200:203], v[240:243], v[156:159], v[200:203]
    v_exp_f32 v188, v188
    v_exp_f32 v189, v189
    v_mfma_f32_16x16x32_bf16 v[204:207], v[240:243], v[172:175], v[204:207]
    ds_read_b128 v[232:235], v4 offset:14336
    v_cvt_pk_bf16_f32 v121, v186, v187
    s_waitcnt lgkmcnt(3)
    v_mfma_f32_16x16x32_bf16 v[208:211], v[244:247], v[156:159], v[208:211]
    v_exp_f32 v190, v190
    v_exp_f32 v191, v191
    v_mfma_f32_16x16x32_bf16 v[212:215], v[244:247], v[172:175], v[212:215]
    ds_read_b128 v[236:239], v4 offset:15360
    v_cvt_pk_bf16_f32 v124, v188, v189
    v_exp_f32 v192, v192
    s_waitcnt lgkmcnt(3)
    v_mfma_f32_16x16x32_bf16 v[200:203], v[224:227], v[160:163], v[200:203]
    v_exp_f32 v193, v193
    v_mfma_f32_16x16x32_bf16 v[204:207], v[224:227], v[176:179], v[204:207]
    s_waitcnt vmcnt(12)
    s_barrier
    ds_read_b128 v[240:243], v4 offset:16384
    v_cvt_pk_bf16_f32 v125, v190, v191
    v_exp_f32 v194, v194
    s_waitcnt lgkmcnt(3)
    v_mfma_f32_16x16x32_bf16 v[208:211], v[228:231], v[160:163], v[208:211]
    v_exp_f32 v195, v195
    v_mfma_f32_16x16x32_bf16 v[212:215], v[228:231], v[176:179], v[212:215]
    s_add_u32 s22, s21, 0x8c000
    s_add_u32 m0, s20, 0x24000
    s_nop 0
    buffer_load_dwordx4 v2, s[8:11], s22 offen sc1 lds
    ds_read_b128 v[244:247], v4 offset:17408
    v_cvt_pk_bf16_f32 v122, v192, v193
    v_exp_f32 v196, v196
    s_waitcnt lgkmcnt(3)
    v_mfma_f32_16x16x32_bf16 v[200:203], v[232:235], v[164:167], v[200:203]
    v_exp_f32 v197, v197
    v_cvt_pk_bf16_f32 v123, v194, v195
    v_mfma_f32_16x16x32_bf16 v[204:207], v[232:235], v[180:183], v[204:207]
    ds_read_b128 v[224:227], v4 offset:18432
    v_exp_f32 v198, v198
    s_waitcnt lgkmcnt(3)
    v_mfma_f32_16x16x32_bf16 v[208:211], v[236:239], v[164:167], v[208:211]
    v_exp_f32 v199, v199
    v_cvt_pk_bf16_f32 v126, v196, v197
    v_mfma_f32_16x16x32_bf16 v[212:215], v[236:239], v[180:183], v[212:215]
    ds_read_b128 v[228:231], v4 offset:19456
    v_cvt_pk_bf16_f32 v127, v198, v199
    s_waitcnt lgkmcnt(3)
    v_mfma_f32_16x16x32_bf16 v[184:187], v[240:243], v[152:155], v[216:219]
    v_mfma_f32_16x16x32_bf16 v[188:191], v[240:243], v[168:171], v[220:223]
    ds_read_b128 v[232:235], v4 offset:20480
    v_exp_f32 v200, v200
    v_exp_f32 v201, v201
    s_add_u32 s22, s18, 43008
    s_add_u32 m0, s15, 6144
    s_nop 0
    buffer_load_dwordx4 v11, s[64:67], s22 offen lds
    v_mfma_f32_16x16x32_bf16 v[248:251], v[12:15], v[120:123], v[248:251]
    s_waitcnt lgkmcnt(3)
    v_mfma_f32_16x16x32_bf16 v[192:195], v[244:247], v[152:155], v[216:219]
    v_exp_f32 v202, v202
    v_exp_f32 v203, v203
    v_mfma_f32_16x16x32_bf16 v[196:199], v[244:247], v[168:171], v[220:223]
    s_add_u32 s22, s21, 0x8c400
    s_add_u32 m0, s20, 0x24400
    s_nop 0
    buffer_load_dwordx4 v2, s[8:11], s22 offen sc1 lds
    ds_read_b128 v[236:239], v4 offset:21504
    v_cvt_pk_bf16_f32 v128, v200, v201
    v_mfma_f32_16x16x32_bf16 v[252:255], v[12:15], v[124:127], v[252:255]
    s_waitcnt lgkmcnt(3)
    v_mfma_f32_16x16x32_bf16 v[184:187], v[224:227], v[156:159], v[184:187]
    v_exp_f32 v204, v204
    v_exp_f32 v205, v205
    v_mfma_f32_16x16x32_bf16 v[188:191], v[224:227], v[172:175], v[188:191]
    ds_read_b128 v[240:243], v4 offset:22528
    v_cvt_pk_bf16_f32 v129, v202, v203
    s_waitcnt lgkmcnt(3)
    v_mfma_f32_16x16x32_bf16 v[192:195], v[228:231], v[156:159], v[192:195]
    v_exp_f32 v206, v206
    v_exp_f32 v207, v207
    v_mfma_f32_16x16x32_bf16 v[196:199], v[228:231], v[172:175], v[196:199]
    ds_read_b128 v[244:247], v4 offset:23552
    v_cvt_pk_bf16_f32 v132, v204, v205
    v_exp_f32 v208, v208
    s_waitcnt lgkmcnt(3)
    v_mfma_f32_16x16x32_bf16 v[184:187], v[232:235], v[160:163], v[184:187]
    v_exp_f32 v209, v209
    v_mfma_f32_16x16x32_bf16 v[188:191], v[232:235], v[176:179], v[188:191]
    ds_read_b128 v[224:227], v4 offset:24576
    v_cvt_pk_bf16_f32 v133, v206, v207
    v_exp_f32 v210, v210
    s_waitcnt lgkmcnt(3)
    v_mfma_f32_16x16x32_bf16 v[192:195], v[236:239], v[160:163], v[192:195]
    v_exp_f32 v211, v211
    v_mfma_f32_16x16x32_bf16 v[196:199], v[236:239], v[176:179], v[196:199]
    ds_read_b128 v[228:231], v4 offset:25600
    v_cvt_pk_bf16_f32 v130, v208, v209
    v_exp_f32 v212, v212
    s_waitcnt lgkmcnt(3)
    v_mfma_f32_16x16x32_bf16 v[184:187], v[240:243], v[164:167], v[184:187]
    v_exp_f32 v213, v213
    v_cvt_pk_bf16_f32 v131, v210, v211
    v_mfma_f32_16x16x32_bf16 v[188:191], v[240:243], v[180:183], v[188:191]
    ds_read_b128 v[232:235], v4 offset:26624
    v_exp_f32 v214, v214
    s_waitcnt lgkmcnt(3)
    v_mfma_f32_16x16x32_bf16 v[192:195], v[244:247], v[164:167], v[192:195]
    v_exp_f32 v215, v215
    v_cvt_pk_bf16_f32 v134, v212, v213
    v_mfma_f32_16x16x32_bf16 v[196:199], v[244:247], v[180:183], v[196:199]
    ds_read_b128 v[236:239], v4 offset:27648
    v_cvt_pk_bf16_f32 v135, v214, v215
    s_waitcnt lgkmcnt(3)
    v_mfma_f32_16x16x32_bf16 v[200:203], v[224:227], v[152:155], v[216:219]
    s_add_u32 s22, s18, 50176
    s_add_u32 m0, s15, 7168
    s_nop 0
    buffer_load_dwordx4 v11, s[64:67], s22 offen lds
    v_mfma_f32_16x16x32_bf16 v[204:207], v[224:227], v[168:171], v[220:223]
    ds_read_b128 v[240:243], v4 offset:28672
    v_exp_f32 v184, v184
    v_exp_f32 v185, v185
    v_mfma_f32_16x16x32_bf16 v[248:251], v[12:15], v[128:131], v[248:251]
    s_waitcnt lgkmcnt(3)
    v_mfma_f32_16x16x32_bf16 v[208:211], v[228:231], v[152:155], v[216:219]
    v_exp_f32 v186, v186
    v_exp_f32 v187, v187
    v_mfma_f32_16x16x32_bf16 v[212:215], v[228:231], v[168:171], v[220:223]
    ds_read_b128 v[244:247], v4 offset:29696
    v_cvt_pk_bf16_f32 v136, v184, v185
    v_mfma_f32_16x16x32_bf16 v[252:255], v[12:15], v[132:135], v[252:255]
    s_waitcnt lgkmcnt(3)
    v_mfma_f32_16x16x32_bf16 v[200:203], v[232:235], v[156:159], v[200:203]
    v_exp_f32 v188, v188
    v_exp_f32 v189, v189
    v_mfma_f32_16x16x32_bf16 v[204:207], v[232:235], v[172:175], v[204:207]
    ds_read_b128 v[224:227], v4 offset:30720
    v_cvt_pk_bf16_f32 v137, v186, v187
    s_waitcnt lgkmcnt(3)
    v_mfma_f32_16x16x32_bf16 v[208:211], v[236:239], v[156:159], v[208:211]
    v_exp_f32 v190, v190
    v_exp_f32 v191, v191
    v_mfma_f32_16x16x32_bf16 v[212:215], v[236:239], v[172:175], v[212:215]
    ds_read_b128 v[228:231], v4 offset:31744
    v_cvt_pk_bf16_f32 v140, v188, v189
    v_exp_f32 v192, v192
    s_waitcnt lgkmcnt(3)
    v_mfma_f32_16x16x32_bf16 v[200:203], v[240:243], v[160:163], v[200:203]
    v_exp_f32 v193, v193
    v_mfma_f32_16x16x32_bf16 v[204:207], v[240:243], v[176:179], v[204:207]
    v_cvt_pk_bf16_f32 v141, v190, v191
    v_exp_f32 v194, v194
    s_waitcnt lgkmcnt(2)
    v_mfma_f32_16x16x32_bf16 v[208:211], v[244:247], v[160:163], v[208:211]
    v_exp_f32 v195, v195
    v_mfma_f32_16x16x32_bf16 v[212:215], v[244:247], v[176:179], v[212:215]
    v_cvt_pk_bf16_f32 v138, v192, v193
    v_exp_f32 v196, v196
    s_waitcnt lgkmcnt(1)
    v_mfma_f32_16x16x32_bf16 v[200:203], v[224:227], v[164:167], v[200:203]
    v_exp_f32 v197, v197
    v_cvt_pk_bf16_f32 v139, v194, v195
    v_mfma_f32_16x16x32_bf16 v[204:207], v[224:227], v[180:183], v[204:207]
    v_exp_f32 v198, v198
    s_waitcnt lgkmcnt(0)
    v_mfma_f32_16x16x32_bf16 v[208:211], v[228:231], v[164:167], v[208:211]
    v_exp_f32 v199, v199
    v_cvt_pk_bf16_f32 v142, v196, v197
    v_mfma_f32_16x16x32_bf16 v[212:215], v[228:231], v[180:183], v[212:215]
    v_cvt_pk_bf16_f32 v143, v198, v199
    s_waitcnt vmcnt(14)
    s_barrier
    ds_read_b128 v[232:235], v4 offset:32768
    ds_read_b128 v[236:239], v4 offset:33792
    ds_read_b128 v[240:243], v4 offset:34816
    ds_read_b128 v[244:247], v4 offset:35840
    v_mfma_f32_16x16x32_bf16 v[248:251], v[12:15], v[136:139], v[248:251]
    v_mfma_f32_16x16x32_bf16 v[252:255], v[12:15], v[140:143], v[252:255]
    v_exp_f32 v200, v200
    v_exp_f32 v201, v201
    v_exp_f32 v202, v202
    v_exp_f32 v203, v203
    v_cvt_pk_bf16_f32 v144, v200, v201
    v_exp_f32 v204, v204
    v_exp_f32 v205, v205
    v_cvt_pk_bf16_f32 v145, v202, v203
    v_exp_f32 v206, v206
    v_exp_f32 v207, v207
    v_cvt_pk_bf16_f32 v148, v204, v205
    v_exp_f32 v208, v208
    v_exp_f32 v209, v209
    v_cvt_pk_bf16_f32 v149, v206, v207
    v_exp_f32 v210, v210
    v_exp_f32 v211, v211
    v_cvt_pk_bf16_f32 v146, v208, v209
    v_exp_f32 v212, v212
    v_exp_f32 v213, v213
    v_cvt_pk_bf16_f32 v147, v210, v211
    v_exp_f32 v214, v214
    v_exp_f32 v215, v215
    v_cvt_pk_bf16_f32 v150, v212, v213
    v_cvt_pk_bf16_f32 v151, v214, v215
    v_mfma_f32_16x16x32_bf16 v[248:251], v[12:15], v[144:147], v[248:251]
    s_nop 0
    v_mfma_f32_16x16x32_bf16 v[252:255], v[12:15], v[148:151], v[252:255]
    s_nop 5
    v_mov_b32 v9, v248
    s_nop 0
    v_mov_b32 v10, v252
    v_max_f32 v17, v9, v10
    v_readfirstlane_b32 s17, v8
    s_cmp_eq_u32 s17, s28
    s_cselect_b32 s16, 0, 0x71800000
    v_cmp_ngt_f32 vcc, s16, v17
    v_cmp_u_f32 s[76:77], v9, v10
    s_or_b64 vcc, vcc, s[76:77]
    s_cbranch_vccnz adaLN_cond__sliding_block_cached__moe_arch_mod__prompt_kernel_fixB
adaLN_cond__sliding_block_cached__moe_arch_mod__prompt_kernel_fixBb:
    v_rcp_f32 v9, v9
    v_rcp_f32 v10, v10
    s_lshl_b32 s25, s13, 3
    s_add_u32 s25, s25, s3
    s_lshl_b32 s25, s25, 18
    s_lshl_b32 s26, s12, 12
    s_add_u32 s25, s25, s26
    s_add_u32 s25, s25, 0x1000000
    s_add_u32 s26, s25, 131072
    s_lshl_b32 s63, s13, 3
    s_add_u32 s63, s63, s3
    s_lshl_b32 s63, s63, 5
    s_add_u32 s63, s63, s12
    s_lshl_b32 s63, s63, 2
    s_waitcnt lgkmcnt(3)
    v_mfma_f32_16x16x32_bf16 v[184:187], v[232:235], v[24:27], 0
    s_mov_b64 s[76:77], s[54:55]
    s_mov_b32 s78, 0xc00000
    s_mov_b32 s79, 0x20000
    v_mfma_f32_16x16x32_bf16 v[188:191], v[232:235], v[28:31], 0
    ds_read_b128 v[224:227], v4 offset:36864
    s_waitcnt lgkmcnt(3)
    v_mfma_f32_16x16x32_bf16 v[192:195], v[236:239], v[24:27], 0
    s_add_u32 s22, s14, 0x0
    s_add_u32 m0, s20, 0x10000
    s_nop 0
    buffer_load_dwordx4 v6, s[76:79], s22 offen lds
    v_mfma_f32_16x16x32_bf16 v[196:199], v[236:239], v[28:31], 0
    ds_read_b128 v[228:231], v4 offset:37888
    s_waitcnt lgkmcnt(3)
    v_mfma_f32_16x16x32_bf16 v[184:187], v[240:243], v[32:35], v[184:187]
    v_mfma_f32_16x16x32_bf16 v[188:191], v[240:243], v[36:39], v[188:191]
    ds_read_b128 v[232:235], v4 offset:38912
    s_waitcnt lgkmcnt(3)
    v_mfma_f32_16x16x32_bf16 v[192:195], v[244:247], v[32:35], v[192:195]
    v_mfma_f32_16x16x32_bf16 v[196:199], v[244:247], v[36:39], v[196:199]
    ds_read_b128 v[236:239], v4 offset:39936
    s_waitcnt lgkmcnt(3)
    v_mfma_f32_16x16x32_bf16 v[184:187], v[224:227], v[40:43], v[184:187]
    v_mfma_f32_16x16x32_bf16 v[188:191], v[224:227], v[44:47], v[188:191]
    ds_read_b128 v[240:243], v4 offset:40960
    s_waitcnt lgkmcnt(3)
    v_mfma_f32_16x16x32_bf16 v[192:195], v[228:231], v[40:43], v[192:195]
    s_add_u32 s22, s14, 0xc000
    s_add_u32 m0, s20, 0x10400
    s_nop 0
    buffer_load_dwordx4 v6, s[76:79], s22 offen lds
    v_mfma_f32_16x16x32_bf16 v[196:199], v[228:231], v[44:47], v[196:199]
    ds_read_b128 v[244:247], v4 offset:41984
    s_waitcnt lgkmcnt(3)
    v_mfma_f32_16x16x32_bf16 v[184:187], v[232:235], v[48:51], v[184:187]
    v_mfma_f32_16x16x32_bf16 v[188:191], v[232:235], v[52:55], v[188:191]
    ds_read_b128 v[224:227], v4 offset:43008
    s_waitcnt lgkmcnt(3)
    v_mfma_f32_16x16x32_bf16 v[192:195], v[236:239], v[48:51], v[192:195]
    v_mfma_f32_16x16x32_bf16 v[196:199], v[236:239], v[52:55], v[196:199]
    ds_read_b128 v[228:231], v4 offset:44032
    s_waitcnt lgkmcnt(3)
    v_mfma_f32_16x16x32_bf16 v[184:187], v[240:243], v[56:59], v[184:187]
    v_mfma_f32_16x16x32_bf16 v[188:191], v[240:243], v[60:63], v[188:191]
    ds_read_b128 v[232:235], v4 offset:45056
    s_waitcnt lgkmcnt(3)
    v_mfma_f32_16x16x32_bf16 v[192:195], v[244:247], v[56:59], v[192:195]
    v_mfma_f32_16x16x32_bf16 v[196:199], v[244:247], v[60:63], v[196:199]
    ds_read_b128 v[236:239], v4 offset:46080
    s_waitcnt lgkmcnt(3)
    v_mfma_f32_16x16x32_bf16 v[184:187], v[224:227], v[64:67], v[184:187]
    v_mfma_f32_16x16x32_bf16 v[188:191], v[224:227], v[68:71], v[188:191]
    ds_read_b128 v[240:243], v4 offset:47104
    s_waitcnt lgkmcnt(3)
    v_mfma_f32_16x16x32_bf16 v[192:195], v[228:231], v[64:67], v[192:195]
    v_mfma_f32_16x16x32_bf16 v[196:199], v[228:231], v[68:71], v[196:199]
    ds_read_b128 v[244:247], v4 offset:48128
    s_waitcnt lgkmcnt(3)
    v_mfma_f32_16x16x32_bf16 v[184:187], v[232:235], v[72:75], v[184:187]
    v_mfma_f32_16x16x32_bf16 v[188:191], v[232:235], v[76:79], v[188:191]
    s_waitcnt vmcnt(12)
    s_barrier
    ds_read_b128 v[224:227], v4 offset:49152
    s_waitcnt lgkmcnt(3)
    v_mfma_f32_16x16x32_bf16 v[192:195], v[236:239], v[72:75], v[192:195]
    v_mfma_f32_16x16x32_bf16 v[196:199], v[236:239], v[76:79], v[196:199]
    s_add_u32 s22, s14, 0xc0000
    s_add_u32 m0, s20, 0x14000
    s_nop 0
    buffer_load_dwordx4 v6, s[76:79], s22 offen lds
    ds_read_b128 v[228:231], v4 offset:50176
    s_waitcnt lgkmcnt(3)
    v_mfma_f32_16x16x32_bf16 v[184:187], v[240:243], v[80:83], v[184:187]
    v_mfma_f32_16x16x32_bf16 v[188:191], v[240:243], v[84:87], v[188:191]
    ds_read_b128 v[232:235], v4 offset:51200
    s_waitcnt lgkmcnt(3)
    v_mfma_f32_16x16x32_bf16 v[192:195], v[244:247], v[80:83], v[192:195]
    v_mfma_f32_16x16x32_bf16 v[196:199], v[244:247], v[84:87], v[196:199]
    ds_read_b128 v[236:239], v4 offset:52224
    s_waitcnt lgkmcnt(3)
    v_mfma_f32_16x16x32_bf16 v[184:187], v[224:227], v[88:91], v[184:187]
    v_mfma_f32_16x16x32_bf16 v[188:191], v[224:227], v[92:95], v[188:191]
    ds_read_b128 v[240:243], v4 offset:53248
    s_waitcnt lgkmcnt(3)
    v_mfma_f32_16x16x32_bf16 v[192:195], v[228:231], v[88:91], v[192:195]
    v_mfma_f32_16x16x32_bf16 v[196:199], v[228:231], v[92:95], v[196:199]
    s_add_u32 s22, s14, 0xcc000
    s_add_u32 m0, s20, 0x14400
    s_nop 0
    buffer_load_dwordx4 v6, s[76:79], s22 offen lds
    ds_read_b128 v[244:247], v4 offset:54272
    s_waitcnt lgkmcnt(3)
    v_mfma_f32_16x16x32_bf16 v[184:187], v[232:235], v[96:99], v[184:187]
    v_mfma_f32_16x16x32_bf16 v[188:191], v[232:235], v[100:103], v[188:191]
    ds_read_b128 v[224:227], v4 offset:55296
    s_waitcnt lgkmcnt(3)
    v_mfma_f32_16x16x32_bf16 v[192:195], v[236:239], v[96:99], v[192:195]
    v_mfma_f32_16x16x32_bf16 v[196:199], v[236:239], v[100:103], v[196:199]
    ds_read_b128 v[228:231], v4 offset:56320
    s_waitcnt lgkmcnt(3)
    v_mfma_f32_16x16x32_bf16 v[184:187], v[240:243], v[104:107], v[184:187]
    v_mfma_f32_16x16x32_bf16 v[188:191], v[240:243], v[108:111], v[188:191]
    ds_read_b128 v[232:235], v4 offset:57344
    s_waitcnt lgkmcnt(3)
    v_mfma_f32_16x16x32_bf16 v[192:195], v[244:247], v[104:107], v[192:195]
    v_mfma_f32_16x16x32_bf16 v[196:199], v[244:247], v[108:111], v[196:199]
    ds_read_b128 v[236:239], v4 offset:58368
    s_waitcnt lgkmcnt(3)
    v_mfma_f32_16x16x32_bf16 v[184:187], v[224:227], v[112:115], v[184:187]
    v_mfma_f32_16x16x32_bf16 v[188:191], v[224:227], v[116:119], v[188:191]
    ds_read_b128 v[240:243], v4 offset:59392
    s_waitcnt lgkmcnt(3)
    v_mfma_f32_16x16x32_bf16 v[192:195], v[228:231], v[112:115], v[192:195]
    v_mfma_f32_16x16x32_bf16 v[196:199], v[228:231], v[116:119], v[196:199]
    ds_read_b128 v[244:247], v4 offset:60416
    s_waitcnt lgkmcnt(3)
    v_mfma_f32_16x16x32_bf16 v[184:187], v[232:235], v[120:123], v[184:187]
    v_mfma_f32_16x16x32_bf16 v[188:191], v[232:235], v[124:127], v[188:191]
    ds_read_b128 v[224:227], v4 offset:61440
    s_waitcnt lgkmcnt(3)
    v_mfma_f32_16x16x32_bf16 v[192:195], v[236:239], v[120:123], v[192:195]
    v_mfma_f32_16x16x32_bf16 v[196:199], v[236:239], v[124:127], v[196:199]
    ds_read_b128 v[228:231], v4 offset:62464
    s_waitcnt lgkmcnt(3)
    v_mfma_f32_16x16x32_bf16 v[184:187], v[240:243], v[128:131], v[184:187]
    v_mfma_f32_16x16x32_bf16 v[188:191], v[240:243], v[132:135], v[188:191]
    ds_read_b128 v[232:235], v4 offset:63488
    s_waitcnt lgkmcnt(3)
    v_mfma_f32_16x16x32_bf16 v[192:195], v[244:247], v[128:131], v[192:195]
    v_mfma_f32_16x16x32_bf16 v[196:199], v[244:247], v[132:135], v[196:199]
    ds_read_b128 v[236:239], v4 offset:64512
    s_waitcnt lgkmcnt(3)
    v_mfma_f32_16x16x32_bf16 v[184:187], v[224:227], v[136:139], v[184:187]
    v_mfma_f32_16x16x32_bf16 v[188:191], v[224:227], v[140:143], v[188:191]
    s_waitcnt vmcnt(9)
    s_barrier
    ds_read_b128 v[240:243], v5 offset:0
    s_waitcnt lgkmcnt(3)
    v_mfma_f32_16x16x32_bf16 v[192:195], v[228:231], v[136:139], v[192:195]
    v_mfma_f32_16x16x32_bf16 v[196:199], v[228:231], v[140:143], v[196:199]
    s_add_u32 s22, s21, 0x90000
    s_add_u32 m0, s20, 0x18000
    s_nop 0
    buffer_load_dwordx4 v2, s[8:11], s22 offen sc1 lds
    ds_read_b128 v[244:247], v5 offset:1024
    s_waitcnt lgkmcnt(3)
    v_mfma_f32_16x16x32_bf16 v[184:187], v[232:235], v[144:147], v[184:187]
    v_mfma_f32_16x16x32_bf16 v[188:191], v[232:235], v[148:151], v[188:191]
    ds_read_b128 v[224:227], v5 offset:2048
    s_waitcnt lgkmcnt(3)
    v_mfma_f32_16x16x32_bf16 v[192:195], v[236:239], v[144:147], v[192:195]
    v_mfma_f32_16x16x32_bf16 v[196:199], v[236:239], v[148:151], v[196:199]
    ds_read_b128 v[228:231], v5 offset:3072
    s_waitcnt lgkmcnt(3)
    v_mfma_f32_16x16x32_bf16 v[200:203], v[240:243], v[24:27], 0
    v_mfma_f32_16x16x32_bf16 v[204:207], v[240:243], v[28:31], 0
    ds_read_b128 v[232:235], v5 offset:4096
    s_waitcnt lgkmcnt(3)
    v_mfma_f32_16x16x32_bf16 v[208:211], v[244:247], v[24:27], 0
    v_mfma_f32_16x16x32_bf16 v[212:215], v[244:247], v[28:31], 0
    s_add_u32 s22, s21, 0x90400
    s_add_u32 m0, s20, 0x18400
    s_nop 0
    buffer_load_dwordx4 v2, s[8:11], s22 offen sc1 lds
    ds_read_b128 v[236:239], v5 offset:5120
    v_mul_f32 v184, v184, v9
    s_waitcnt lgkmcnt(3)
    v_mfma_f32_16x16x32_bf16 v[200:203], v[224:227], v[32:35], v[200:203]
    v_mul_f32 v185, v185, v9
    v_mfma_f32_16x16x32_bf16 v[204:207], v[224:227], v[36:39], v[204:207]
    ds_read_b128 v[240:243], v5 offset:6144
    v_mul_f32 v186, v186, v9
    s_waitcnt lgkmcnt(3)
    v_mfma_f32_16x16x32_bf16 v[208:211], v[228:231], v[32:35], v[208:211]
    v_mul_f32 v187, v187, v9
    v_mfma_f32_16x16x32_bf16 v[212:215], v[228:231], v[36:39], v[212:215]
    ds_read_b128 v[244:247], v5 offset:7168
    v_mul_f32 v192, v192, v9
    s_waitcnt lgkmcnt(3)
    v_mfma_f32_16x16x32_bf16 v[200:203], v[232:235], v[40:43], v[200:203]
    v_mul_f32 v193, v193, v9
    v_mfma_f32_16x16x32_bf16 v[204:207], v[232:235], v[44:47], v[204:207]
    ds_read_b128 v[224:227], v5 offset:8192
    v_mul_f32 v194, v194, v9
    s_waitcnt lgkmcnt(3)
    v_mfma_f32_16x16x32_bf16 v[208:211], v[236:239], v[40:43], v[208:211]
    v_mul_f32 v195, v195, v9
    v_mfma_f32_16x16x32_bf16 v[212:215], v[236:239], v[44:47], v[212:215]
    ds_read_b128 v[228:231], v5 offset:9216
    v_cvt_pk_bf16_f32 v216, v184, v185
    s_waitcnt lgkmcnt(3)
    v_mfma_f32_16x16x32_bf16 v[200:203], v[240:243], v[48:51], v[200:203]
    v_cvt_pk_bf16_f32 v217, v186, v187
    v_mfma_f32_16x16x32_bf16 v[204:207], v[240:243], v[52:55], v[204:207]
    ds_read_b128 v[232:235], v5 offset:10240
    v_cvt_pk_bf16_f32 v218, v192, v193
    s_waitcnt lgkmcnt(3)
    v_mfma_f32_16x16x32_bf16 v[208:211], v[244:247], v[48:51], v[208:211]
    v_cvt_pk_bf16_f32 v219, v194, v195
    v_mfma_f32_16x16x32_bf16 v[212:215], v[244:247], v[52:55], v[212:215]
    ds_read_b128 v[236:239], v5 offset:11264
    buffer_store_dwordx4 v[216:219], v2, s[8:11], s25 offen offset:0 sc1
    s_waitcnt lgkmcnt(3)
    v_mfma_f32_16x16x32_bf16 v[200:203], v[224:227], v[56:59], v[200:203]
    v_mul_f32 v188, v188, v10
    v_mfma_f32_16x16x32_bf16 v[204:207], v[224:227], v[60:63], v[204:207]
    ds_read_b128 v[240:243], v5 offset:12288
    v_mul_f32 v189, v189, v10
    s_waitcnt lgkmcnt(3)
    v_mfma_f32_16x16x32_bf16 v[208:211], v[228:231], v[56:59], v[208:211]
    v_mul_f32 v190, v190, v10
    v_mfma_f32_16x16x32_bf16 v[212:215], v[228:231], v[60:63], v[212:215]
    ds_read_b128 v[244:247], v5 offset:13312
    v_mul_f32 v191, v191, v10
    s_waitcnt lgkmcnt(3)
    v_mfma_f32_16x16x32_bf16 v[200:203], v[232:235], v[64:67], v[200:203]
    v_mul_f32 v196, v196, v10
    v_mfma_f32_16x16x32_bf16 v[204:207], v[232:235], v[68:71], v[204:207]
    ds_read_b128 v[224:227], v5 offset:14336
    v_mul_f32 v197, v197, v10
    s_waitcnt lgkmcnt(3)
    v_mfma_f32_16x16x32_bf16 v[208:211], v[236:239], v[64:67], v[208:211]
    v_mul_f32 v198, v198, v10
    v_mfma_f32_16x16x32_bf16 v[212:215], v[236:239], v[68:71], v[212:215]
    ds_read_b128 v[228:231], v5 offset:15360
    v_mul_f32 v199, v199, v10
    s_waitcnt lgkmcnt(3)
    v_mfma_f32_16x16x32_bf16 v[200:203], v[240:243], v[72:75], v[200:203]
    v_cvt_pk_bf16_f32 v220, v188, v189
    v_mfma_f32_16x16x32_bf16 v[204:207], v[240:243], v[76:79], v[204:207]
    s_waitcnt vmcnt(8)
    s_barrier
    ds_read_b128 v[232:235], v5 offset:16384
    v_cvt_pk_bf16_f32 v221, v190, v191
    s_waitcnt lgkmcnt(3)
    v_mfma_f32_16x16x32_bf16 v[208:211], v[244:247], v[72:75], v[208:211]
    v_cvt_pk_bf16_f32 v222, v196, v197
    v_mfma_f32_16x16x32_bf16 v[212:215], v[244:247], v[76:79], v[212:215]
    s_add_u32 s22, s21, 0x94000
    s_add_u32 m0, s20, 0x1c000
    s_nop 0
    buffer_load_dwordx4 v2, s[8:11], s22 offen sc1 lds
    ds_read_b128 v[236:239], v5 offset:17408
    v_cvt_pk_bf16_f32 v223, v198, v199
    s_waitcnt lgkmcnt(3)
    v_mfma_f32_16x16x32_bf16 v[200:203], v[224:227], v[80:83], v[200:203]
    buffer_store_dwordx4 v[220:223], v2, s[8:11], s26 offen offset:0 sc1
    v_mfma_f32_16x16x32_bf16 v[204:207], v[224:227], v[84:87], v[204:207]
    ds_read_b128 v[240:243], v5 offset:18432
    s_waitcnt lgkmcnt(3)
    v_mfma_f32_16x16x32_bf16 v[208:211], v[228:231], v[80:83], v[208:211]
    v_mfma_f32_16x16x32_bf16 v[212:215], v[228:231], v[84:87], v[212:215]
    ds_read_b128 v[244:247], v5 offset:19456
    s_waitcnt lgkmcnt(3)
    v_mfma_f32_16x16x32_bf16 v[200:203], v[232:235], v[88:91], v[200:203]
    v_lshrrev_b32 v20, 4, v1
    v_lshlrev_b32 v21, 4, v20
    s_lshl_b32 s16, s2, 8
    s_add_u32 s16, s16, 0x550000
    buffer_load_dwordx4 v[152:155], v21, s[8:11], s16 offen offset:0 sc1
    buffer_load_dwordx4 v[156:159], v21, s[8:11], s16 offen offset:64 sc1
    buffer_load_dwordx4 v[160:163], v21, s[8:11], s16 offen offset:128 sc1
    buffer_load_dwordx4 v[164:167], v21, s[8:11], s16 offen offset:192 sc1
    v_lshlrev_b32 v11, 11, v20
    v_xor_b32 v20, s3, v20
    v_and_b32 v20, 1, v20
    v_lshl_add_u32 v11, v20, 5, v11
    v_bfe_u32 v20, v1, 2, 2
    v_lshl_add_u32 v11, v20, 6, v11
    v_and_b32 v20, 3, v1
    v_lshl_add_u32 v11, v20, 3, v11
    s_lshr_b32 s16, s3, 1
    s_lshl_b32 s16, s16, 8
    s_add_u32 s16, s16, 65536
    v_add_u32 v11, s16, v11
    v_mfma_f32_16x16x32_bf16 v[204:207], v[232:235], v[92:95], v[204:207]
    ds_read_b128 v[224:227], v5 offset:20480
    s_waitcnt lgkmcnt(3)
    v_mfma_f32_16x16x32_bf16 v[208:211], v[236:239], v[88:91], v[208:211]
    v_mfma_f32_16x16x32_bf16 v[212:215], v[236:239], v[92:95], v[212:215]
    s_add_u32 s22, s21, 0x94400
    s_add_u32 m0, s20, 0x1c400
    s_nop 0
    buffer_load_dwordx4 v2, s[8:11], s22 offen sc1 lds
    ds_read_b128 v[228:231], v5 offset:21504
    s_waitcnt lgkmcnt(3)
    v_mfma_f32_16x16x32_bf16 v[200:203], v[240:243], v[96:99], v[200:203]
    v_mfma_f32_16x16x32_bf16 v[204:207], v[240:243], v[100:103], v[204:207]
    ds_read_b128 v[232:235], v5 offset:22528
    s_waitcnt lgkmcnt(3)
    v_mfma_f32_16x16x32_bf16 v[208:211], v[244:247], v[96:99], v[208:211]
    v_mfma_f32_16x16x32_bf16 v[212:215], v[244:247], v[100:103], v[212:215]
    ds_read_b128 v[236:239], v5 offset:23552
    s_waitcnt lgkmcnt(3)
    v_mfma_f32_16x16x32_bf16 v[200:203], v[224:227], v[104:107], v[200:203]
    v_mfma_f32_16x16x32_bf16 v[204:207], v[224:227], v[108:111], v[204:207]
    ds_read_b128 v[240:243], v5 offset:24576
    s_waitcnt lgkmcnt(3)
    v_mfma_f32_16x16x32_bf16 v[208:211], v[228:231], v[104:107], v[208:211]
    v_mfma_f32_16x16x32_bf16 v[212:215], v[228:231], v[108:111], v[212:215]
    ds_read_b128 v[244:247], v5 offset:25600
    s_waitcnt lgkmcnt(3)
    v_mfma_f32_16x16x32_bf16 v[200:203], v[232:235], v[112:115], v[200:203]
    v_mfma_f32_16x16x32_bf16 v[204:207], v[232:235], v[116:119], v[204:207]
    ds_read_b128 v[224:227], v5 offset:26624
    s_waitcnt lgkmcnt(3)
    v_mfma_f32_16x16x32_bf16 v[208:211], v[236:239], v[112:115], v[208:211]
    v_mfma_f32_16x16x32_bf16 v[212:215], v[236:239], v[116:119], v[212:215]
    ds_read_b128 v[228:231], v5 offset:27648
    s_waitcnt lgkmcnt(3)
    v_mfma_f32_16x16x32_bf16 v[200:203], v[240:243], v[120:123], v[200:203]
    v_mfma_f32_16x16x32_bf16 v[204:207], v[240:243], v[124:127], v[204:207]
    ds_read_b128 v[232:235], v5 offset:28672
    s_waitcnt lgkmcnt(3)
    v_mfma_f32_16x16x32_bf16 v[208:211], v[244:247], v[120:123], v[208:211]
    v_mfma_f32_16x16x32_bf16 v[212:215], v[244:247], v[124:127], v[212:215]
    ds_read_b128 v[236:239], v5 offset:29696
    s_waitcnt lgkmcnt(3)
    v_mfma_f32_16x16x32_bf16 v[200:203], v[224:227], v[128:131], v[200:203]
    v_mfma_f32_16x16x32_bf16 v[204:207], v[224:227], v[132:135], v[204:207]
    ds_read_b128 v[240:243], v5 offset:30720
    s_waitcnt lgkmcnt(3)
    v_mfma_f32_16x16x32_bf16 v[208:211], v[228:231], v[128:131], v[208:211]
    v_mfma_f32_16x16x32_bf16 v[212:215], v[228:231], v[132:135], v[212:215]
    ds_read_b128 v[244:247], v5 offset:31744
    s_waitcnt lgkmcnt(3)
    v_mfma_f32_16x16x32_bf16 v[200:203], v[232:235], v[136:139], v[200:203]
    s_waitcnt vmcnt(5)
    s_add_u32 s16, s63, 0x570000
    v_mov_b32 v7, s28
    v_mov_b32 v8, 0
    s_mov_b64 exec, 1
    buffer_store_dword v7, v8, s[8:11], s16 offen sc1
    s_mov_b64 exec, -1
    v_mfma_f32_16x16x32_bf16 v[204:207], v[232:235], v[140:143], v[204:207]
    s_barrier
    ds_read_b128 v[224:227], v4 offset:32768
    s_waitcnt lgkmcnt(3)
    v_mfma_f32_16x16x32_bf16 v[208:211], v[236:239], v[136:139], v[208:211]
    v_mfma_f32_16x16x32_bf16 v[212:215], v[236:239], v[140:143], v[212:215]
    s_add_u32 s22, s21, 0x98000
    s_add_u32 m0, s20, 0x20000
    s_nop 0
    buffer_load_dwordx4 v2, s[8:11], s22 offen sc1 lds
    ds_read_b128 v[228:231], v4 offset:33792
    s_waitcnt lgkmcnt(3)
    v_mfma_f32_16x16x32_bf16 v[200:203], v[240:243], v[144:147], v[200:203]
    ds_read_b64_tr_b16 v[168:169], v11 offset:0
    ds_read_b64_tr_b16 v[170:171], v11 offset:1024
    ds_read_b64_tr_b16 v[172:173], v11 offset:8192
    ds_read_b64_tr_b16 v[174:175], v11 offset:9216
    ds_read_b64_tr_b16 v[176:177], v11 offset:16384
    ds_read_b64_tr_b16 v[178:179], v11 offset:17408
    ds_read_b64_tr_b16 v[180:181], v11 offset:24576
    ds_read_b64_tr_b16 v[182:183], v11 offset:25600
    v_mfma_f32_16x16x32_bf16 v[204:207], v[240:243], v[148:151], v[204:207]
    ds_read_b128 v[232:235], v4 offset:34816
    s_waitcnt lgkmcnt(11)
    v_mfma_f32_16x16x32_bf16 v[208:211], v[244:247], v[144:147], v[208:211]
    v_mfma_f32_16x16x32_bf16 v[212:215], v[244:247], v[148:151], v[212:215]
    ds_read_b128 v[236:239], v4 offset:35840
    s_waitcnt lgkmcnt(11)
    v_mfma_f32_16x16x32_bf16 v[184:187], v[224:227], v[24:27], 0
    v_mfma_f32_16x16x32_bf16 v[188:191], v[224:227], v[28:31], 0
    ds_read_b128 v[240:243], v4 offset:36864
    s_waitcnt lgkmcnt(11)
    v_mfma_f32_16x16x32_bf16 v[192:195], v[228:231], v[24:27], 0
    v_mfma_f32_16x16x32_bf16 v[196:199], v[228:231], v[28:31], 0
    s_add_u32 s22, s21, 0x98400
    s_add_u32 m0, s20, 0x20400
    s_nop 0
    buffer_load_dwordx4 v2, s[8:11], s22 offen sc1 lds
    ds_read_b128 v[244:247], v4 offset:37888
    v_mul_f32 v200, v200, v9
    s_waitcnt lgkmcnt(3)
    v_mfma_f32_16x16x32_bf16 v[184:187], v[232:235], v[32:35], v[184:187]
    v_mul_f32 v201, v201, v9
    v_mfma_f32_16x16x32_bf16 v[188:191], v[232:235], v[36:39], v[188:191]
    ds_read_b128 v[224:227], v4 offset:38912
    v_mul_f32 v202, v202, v9
    s_waitcnt lgkmcnt(3)
    v_mfma_f32_16x16x32_bf16 v[192:195], v[236:239], v[32:35], v[192:195]
    v_mul_f32 v203, v203, v9
    s_waitcnt vmcnt(7)
    v_mfma_f32_16x16x32_bf16 v[248:251], v[168:171], v[152:155], 0
    s_waitcnt vmcnt(6)
    v_mfma_f32_16x16x32_bf16 v[248:251], v[172:175], v[156:159], v[248:251]
    s_waitcnt vmcnt(5)
    v_mfma_f32_16x16x32_bf16 v[248:251], v[176:179], v[160:163], v[248:251]
    s_waitcnt vmcnt(4)
    v_mfma_f32_16x16x32_bf16 v[248:251], v[180:183], v[164:167], v[248:251]
    v_mfma_f32_16x16x32_bf16 v[196:199], v[236:239], v[36:39], v[196:199]
    ds_read_b128 v[228:231], v4 offset:39936
    v_mul_f32 v208, v208, v9
    s_waitcnt lgkmcnt(3)
    v_mfma_f32_16x16x32_bf16 v[184:187], v[240:243], v[40:43], v[184:187]
    v_mul_f32 v209, v209, v9
    v_mfma_f32_16x16x32_bf16 v[188:191], v[240:243], v[44:47], v[188:191]
    ds_read_b128 v[232:235], v4 offset:40960
    v_mul_f32 v210, v210, v9
    s_waitcnt lgkmcnt(3)
    v_mfma_f32_16x16x32_bf16 v[192:195], v[244:247], v[40:43], v[192:195]
    v_mul_f32 v211, v211, v9
    v_mfma_f32_16x16x32_bf16 v[196:199], v[244:247], v[44:47], v[196:199]
    ds_read_b128 v[236:239], v4 offset:41984
    v_cvt_pk_bf16_f32 v216, v200, v201
    s_waitcnt lgkmcnt(3)
    v_mfma_f32_16x16x32_bf16 v[184:187], v[224:227], v[48:51], v[184:187]
    v_cvt_pk_bf16_f32 v217, v202, v203
    v_mfma_f32_16x16x32_bf16 v[188:191], v[224:227], v[52:55], v[188:191]
    ds_read_b128 v[240:243], v4 offset:43008
    v_cvt_pk_bf16_f32 v218, v208, v209
    s_waitcnt lgkmcnt(3)
    v_mfma_f32_16x16x32_bf16 v[192:195], v[228:231], v[48:51], v[192:195]
    v_cvt_pk_bf16_f32 v219, v210, v211
    v_mfma_f32_16x16x32_bf16 v[196:199], v[228:231], v[52:55], v[196:199]
    ds_read_b128 v[244:247], v4 offset:44032
    buffer_store_dwordx4 v[216:219], v2, s[8:11], s25 offen offset:1024 sc1
    s_waitcnt lgkmcnt(3)
    v_mfma_f32_16x16x32_bf16 v[184:187], v[232:235], v[56:59], v[184:187]
    v_mul_f32 v204, v204, v10
    v_mfma_f32_16x16x32_bf16 v[188:191], v[232:235], v[60:63], v[188:191]
    ds_read_b128 v[224:227], v4 offset:45056
    v_mul_f32 v205, v205, v10
    s_waitcnt lgkmcnt(3)
    v_mfma_f32_16x16x32_bf16 v[192:195], v[236:239], v[56:59], v[192:195]
    v_mul_f32 v206, v206, v10
    v_lshrrev_b32 v20, 4, v1
    v_lshlrev_b32 v20, 4, v20
    s_lshr_b32 s16, s2, 5
    s_lshl_b32 s16, s16, 14
    s_and_b32 s17, s2, 31
    s_lshl_b32 s17, s17, 9
    s_add_u32 s16, s16, s17
    s_lshl_b32 s17, s3, 6
    s_add_u32 s16, s16, s17
    s_add_u32 s16, s16, 0x580000
    s_mov_b32 exec_lo, 0x10001
    s_mov_b32 exec_hi, 0x10001
    buffer_store_dwordx4 v[248:251], v20, s[8:11], s16 offen sc1
    s_mov_b64 exec, -1
    v_mfma_f32_16x16x32_bf16 v[196:199], v[236:239], v[60:63], v[196:199]
    ds_read_b128 v[228:231], v4 offset:46080
    v_mul_f32 v207, v207, v10
    s_waitcnt lgkmcnt(3)
    v_mfma_f32_16x16x32_bf16 v[184:187], v[240:243], v[64:67], v[184:187]
    v_mul_f32 v212, v212, v10
    v_mfma_f32_16x16x32_bf16 v[188:191], v[240:243], v[68:71], v[188:191]
    ds_read_b128 v[232:235], v4 offset:47104
    v_mul_f32 v213, v213, v10
    s_waitcnt lgkmcnt(3)
    v_mfma_f32_16x16x32_bf16 v[192:195], v[244:247], v[64:67], v[192:195]
    v_mul_f32 v214, v214, v10
    v_mfma_f32_16x16x32_bf16 v[196:199], v[244:247], v[68:71], v[196:199]
    ds_read_b128 v[236:239], v4 offset:48128
    v_mul_f32 v215, v215, v10
    s_waitcnt lgkmcnt(3)
    v_mfma_f32_16x16x32_bf16 v[184:187], v[224:227], v[72:75], v[184:187]
    v_cvt_pk_bf16_f32 v220, v204, v205
    v_mfma_f32_16x16x32_bf16 v[188:191], v[224:227], v[76:79], v[188:191]
    s_waitcnt vmcnt(5)
    s_barrier
    ds_read_b128 v[240:243], v4 offset:49152
    v_cvt_pk_bf16_f32 v221, v206, v207
    s_waitcnt lgkmcnt(3)
    v_mfma_f32_16x16x32_bf16 v[192:195], v[228:231], v[72:75], v[192:195]
    v_cvt_pk_bf16_f32 v222, v212, v213
    v_mfma_f32_16x16x32_bf16 v[196:199], v[228:231], v[76:79], v[196:199]
    s_add_u32 s22, s21, 0x9c000
    s_add_u32 m0, s20, 0x24000
    s_nop 0
    buffer_load_dwordx4 v2, s[8:11], s22 offen sc1 lds
    ds_read_b128 v[244:247], v4 offset:50176
    v_cvt_pk_bf16_f32 v223, v214, v215
    s_waitcnt lgkmcnt(3)
    v_mfma_f32_16x16x32_bf16 v[184:187], v[232:235], v[80:83], v[184:187]
    buffer_store_dwordx4 v[220:223], v2, s[8:11], s26 offen offset:1024 sc1
    v_mfma_f32_16x16x32_bf16 v[188:191], v[232:235], v[84:87], v[188:191]
    ds_read_b128 v[224:227], v4 offset:51200
    s_waitcnt lgkmcnt(3)
    v_mfma_f32_16x16x32_bf16 v[192:195], v[236:239], v[80:83], v[192:195]
    v_mfma_f32_16x16x32_bf16 v[196:199], v[236:239], v[84:87], v[196:199]
    s_add_u32 s22, s21, 0x9c400
    s_add_u32 m0, s20, 0x24400
    s_nop 0
    buffer_load_dwordx4 v2, s[8:11], s22 offen sc1 lds
    ds_read_b128 v[228:231], v4 offset:52224
    s_waitcnt lgkmcnt(3)
    v_mfma_f32_16x16x32_bf16 v[184:187], v[240:243], v[88:91], v[184:187]
    v_mfma_f32_16x16x32_bf16 v[188:191], v[240:243], v[92:95], v[188:191]
    ds_read_b128 v[232:235], v4 offset:53248
    s_waitcnt lgkmcnt(3)
    v_mfma_f32_16x16x32_bf16 v[192:195], v[244:247], v[88:91], v[192:195]
    v_mfma_f32_16x16x32_bf16 v[196:199], v[244:247], v[92:95], v[196:199]
    s_add_u32 s22, s24, 0x0
    s_add_u32 m0, s20, 0x10000
    s_nop 0
    buffer_load_dwordx4 v3, s[4:7], s22 offen lds
    ds_read_b128 v[236:239], v4 offset:54272
    s_waitcnt lgkmcnt(3)
    v_mfma_f32_16x16x32_bf16 v[184:187], v[224:227], v[96:99], v[184:187]
    v_mfma_f32_16x16x32_bf16 v[188:191], v[224:227], v[100:103], v[188:191]
    ds_read_b128 v[240:243], v4 offset:55296
    s_waitcnt lgkmcnt(3)
    v_mfma_f32_16x16x32_bf16 v[192:195], v[228:231], v[96:99], v[192:195]
    v_mfma_f32_16x16x32_bf16 v[196:199], v[228:231], v[100:103], v[196:199]
    s_add_u32 s22, s24, 0x2000
    s_add_u32 m0, s20, 0x10400
    s_nop 0
    buffer_load_dwordx4 v3, s[4:7], s22 offen lds
    ds_read_b128 v[244:247], v4 offset:56320
    s_waitcnt lgkmcnt(3)
    v_mfma_f32_16x16x32_bf16 v[184:187], v[232:235], v[104:107], v[184:187]
    v_mfma_f32_16x16x32_bf16 v[188:191], v[232:235], v[108:111], v[188:191]
    ds_read_b128 v[224:227], v4 offset:57344
    s_waitcnt lgkmcnt(3)
    v_mfma_f32_16x16x32_bf16 v[192:195], v[236:239], v[104:107], v[192:195]
    v_mfma_f32_16x16x32_bf16 v[196:199], v[236:239], v[108:111], v[196:199]
    ds_read_b128 v[228:231], v4 offset:58368
    s_waitcnt lgkmcnt(3)
    v_mfma_f32_16x16x32_bf16 v[184:187], v[240:243], v[112:115], v[184:187]
    v_mfma_f32_16x16x32_bf16 v[188:191], v[240:243], v[116:119], v[188:191]
    ds_read_b128 v[232:235], v4 offset:59392
    s_waitcnt lgkmcnt(3)
    v_mfma_f32_16x16x32_bf16 v[192:195], v[244:247], v[112:115], v[192:195]
    v_mfma_f32_16x16x32_bf16 v[196:199], v[244:247], v[116:119], v[196:199]
    ds_read_b128 v[236:239], v4 offset:60416
    s_waitcnt lgkmcnt(3)
    v_mfma_f32_16x16x32_bf16 v[184:187], v[224:227], v[120:123], v[184:187]
    v_mfma_f32_16x16x32_bf16 v[188:191], v[224:227], v[124:127], v[188:191]
    ds_read_b128 v[240:243], v4 offset:61440
    s_waitcnt lgkmcnt(3)
    v_mfma_f32_16x16x32_bf16 v[192:195], v[228:231], v[120:123], v[192:195]
    v_mfma_f32_16x16x32_bf16 v[196:199], v[228:231], v[124:127], v[196:199]
    ds_read_b128 v[244:247], v4 offset:62464
    s_waitcnt lgkmcnt(3)
    v_mfma_f32_16x16x32_bf16 v[184:187], v[232:235], v[128:131], v[184:187]
    v_mfma_f32_16x16x32_bf16 v[188:191], v[232:235], v[132:135], v[188:191]
    ds_read_b128 v[224:227], v4 offset:63488
    s_waitcnt lgkmcnt(3)
    v_mfma_f32_16x16x32_bf16 v[192:195], v[236:239], v[128:131], v[192:195]
    v_mfma_f32_16x16x32_bf16 v[196:199], v[236:239], v[132:135], v[196:199]
    ds_read_b128 v[228:231], v4 offset:64512
    s_waitcnt lgkmcnt(3)
    v_mfma_f32_16x16x32_bf16 v[184:187], v[240:243], v[136:139], v[184:187]
    v_mfma_f32_16x16x32_bf16 v[188:191], v[240:243], v[140:143], v[188:191]
    s_waitcnt vmcnt(7)
    s_barrier
    ds_read_b128 v[232:235], v5 offset:0
    s_waitcnt lgkmcnt(3)
    v_mfma_f32_16x16x32_bf16 v[192:195], v[244:247], v[136:139], v[192:195]
    v_mfma_f32_16x16x32_bf16 v[196:199], v[244:247], v[140:143], v[196:199]
    s_add_u32 s22, s24, 0x80000
    s_add_u32 m0, s20, 0x14000
    s_nop 0
    buffer_load_dwordx4 v3, s[4:7], s22 offen lds
    ds_read_b128 v[236:239], v5 offset:1024
    s_waitcnt lgkmcnt(3)
    v_mfma_f32_16x16x32_bf16 v[184:187], v[224:227], v[144:147], v[184:187]
    v_mfma_f32_16x16x32_bf16 v[188:191], v[224:227], v[148:151], v[188:191]
    ds_read_b128 v[240:243], v5 offset:2048
    s_waitcnt lgkmcnt(3)
    v_mfma_f32_16x16x32_bf16 v[192:195], v[228:231], v[144:147], v[192:195]
    v_mfma_f32_16x16x32_bf16 v[196:199], v[228:231], v[148:151], v[196:199]
    s_add_u32 s22, s24, 0x82000
    s_add_u32 m0, s20, 0x14400
    s_nop 0
    buffer_load_dwordx4 v3, s[4:7], s22 offen lds
    ds_read_b128 v[244:247], v5 offset:3072
    s_waitcnt lgkmcnt(3)
    v_mfma_f32_16x16x32_bf16 v[200:203], v[232:235], v[24:27], 0
    v_mfma_f32_16x16x32_bf16 v[204:207], v[232:235], v[28:31], 0
    ds_read_b128 v[224:227], v5 offset:4096
    s_waitcnt lgkmcnt(3)
    v_mfma_f32_16x16x32_bf16 v[208:211], v[236:239], v[24:27], 0
    v_mfma_f32_16x16x32_bf16 v[212:215], v[236:239], v[28:31], 0
    s_add_u32 s22, s24, 0x100000
    s_add_u32 m0, s20, 0x18000
    s_nop 0
    buffer_load_dwordx4 v3, s[4:7], s22 offen lds
    ds_read_b128 v[228:231], v5 offset:5120
    v_mul_f32 v184, v184, v9
    s_waitcnt lgkmcnt(3)
    v_mfma_f32_16x16x32_bf16 v[200:203], v[240:243], v[32:35], v[200:203]
    v_mul_f32 v185, v185, v9
    s_bfe_u32 s30, s2, 0x20001
    s_lshl_b32 s30, s30, 2
    s_bfe_u32 s17, s2, 0x20003
    s_add_u32 s30, s30, s17
    s_lshr_b32 s31, s2, 5
    s_and_b32 s17, s3, 3
    s_lshl_b32 s19, s30, 2
    s_add_u32 s19, s19, s17
    s_and_b32 s16, s2, 1
    s_lshl_b32 s17, s19, 18
    s_lshl_b32 s23, s16, 16
    s_add_u32 s17, s17, s23
    s_add_u32 s17, s17, 0x1001000
    v_add_u32 v6, s17, v2
    s_lshl_b32 s19, s19, 7
    s_lshl_b32 s23, s16, 6
    s_add_u32 s19, s19, s23
    s_add_u32 s19, s19, 0x570000
    v_and_b32 v13, 15, v1
    v_lshlrev_b32 v13, 2, v13
    buffer_load_dword v12, v13, s[8:11], s19 offen sc1
    v_mfma_f32_16x16x32_bf16 v[204:207], v[240:243], v[36:39], v[204:207]
    ds_read_b128 v[232:235], v5 offset:6144
    v_mul_f32 v186, v186, v9
    s_waitcnt lgkmcnt(3)
    v_mfma_f32_16x16x32_bf16 v[208:211], v[244:247], v[32:35], v[208:211]
    v_mul_f32 v187, v187, v9
    v_mfma_f32_16x16x32_bf16 v[212:215], v[244:247], v[36:39], v[212:215]
    s_add_u32 s22, s24, 0x102000
    s_add_u32 m0, s20, 0x18400
    s_nop 0
    buffer_load_dwordx4 v3, s[4:7], s22 offen lds
    ds_read_b128 v[236:239], v5 offset:7168
    v_mul_f32 v192, v192, v9
    s_waitcnt lgkmcnt(3)
    v_mfma_f32_16x16x32_bf16 v[200:203], v[224:227], v[40:43], v[200:203]
    v_mul_f32 v193, v193, v9
    v_mfma_f32_16x16x32_bf16 v[204:207], v[224:227], v[44:47], v[204:207]
    ds_read_b128 v[240:243], v5 offset:8192
    v_mul_f32 v194, v194, v9
    s_waitcnt lgkmcnt(3)
    v_mfma_f32_16x16x32_bf16 v[208:211], v[228:231], v[40:43], v[208:211]
    v_mul_f32 v195, v195, v9
    v_mfma_f32_16x16x32_bf16 v[212:215], v[228:231], v[44:47], v[212:215]
    ds_read_b128 v[244:247], v5 offset:9216
    v_cvt_pk_bf16_f32 v216, v184, v185
    s_waitcnt lgkmcnt(3)
    v_mfma_f32_16x16x32_bf16 v[200:203], v[232:235], v[48:51], v[200:203]
    v_cvt_pk_bf16_f32 v217, v186, v187
    v_mfma_f32_16x16x32_bf16 v[204:207], v[232:235], v[52:55], v[204:207]
    ds_read_b128 v[224:227], v5 offset:10240
    v_cvt_pk_bf16_f32 v218, v192, v193
    s_waitcnt lgkmcnt(3)
    v_mfma_f32_16x16x32_bf16 v[208:211], v[236:239], v[48:51], v[208:211]
    v_cvt_pk_bf16_f32 v219, v194, v195
    v_mfma_f32_16x16x32_bf16 v[212:215], v[236:239], v[52:55], v[212:215]
    ds_read_b128 v[228:231], v5 offset:11264
    buffer_store_dwordx4 v[216:219], v2, s[8:11], s25 offen offset:2048 sc1
    s_waitcnt lgkmcnt(3)
    v_mfma_f32_16x16x32_bf16 v[200:203], v[240:243], v[56:59], v[200:203]
    v_mul_f32 v188, v188, v10
    v_mfma_f32_16x16x32_bf16 v[204:207], v[240:243], v[60:63], v[204:207]
    ds_read_b128 v[232:235], v5 offset:12288
    v_mul_f32 v189, v189, v10
    s_waitcnt lgkmcnt(3)
    v_mfma_f32_16x16x32_bf16 v[208:211], v[244:247], v[56:59], v[208:211]
    v_mul_f32 v190, v190, v10
    v_mfma_f32_16x16x32_bf16 v[212:215], v[244:247], v[60:63], v[212:215]
    ds_read_b128 v[236:239], v5 offset:13312
    v_mul_f32 v191, v191, v10
    s_waitcnt lgkmcnt(3)
    v_mfma_f32_16x16x32_bf16 v[200:203], v[224:227], v[64:67], v[200:203]
    v_mul_f32 v196, v196, v10
    s_waitcnt vmcnt(11)
    v_mfma_f32_16x16x32_bf16 v[204:207], v[224:227], v[68:71], v[204:207]
    ds_read_b128 v[240:243], v5 offset:14336
    v_mul_f32 v197, v197, v10
    s_waitcnt lgkmcnt(3)
    v_mfma_f32_16x16x32_bf16 v[208:211], v[228:231], v[64:67], v[208:211]
    v_mul_f32 v198, v198, v10
    v_mfma_f32_16x16x32_bf16 v[212:215], v[228:231], v[68:71], v[212:215]
    ds_read_b128 v[244:247], v5 offset:15360
    v_mul_f32 v199, v199, v10
    s_waitcnt lgkmcnt(3)
    v_mfma_f32_16x16x32_bf16 v[200:203], v[232:235], v[72:75], v[200:203]
    v_cvt_pk_bf16_f32 v220, v188, v189
    v_mfma_f32_16x16x32_bf16 v[204:207], v[232:235], v[76:79], v[204:207]
    s_waitcnt vmcnt(8)
    s_barrier
    ds_read_b128 v[224:227], v5 offset:16384
    v_cvt_pk_bf16_f32 v221, v190, v191
    s_waitcnt lgkmcnt(3)
    v_mfma_f32_16x16x32_bf16 v[208:211], v[236:239], v[72:75], v[208:211]
    v_cvt_pk_bf16_f32 v222, v196, v197
    v_mfma_f32_16x16x32_bf16 v[212:215], v[236:239], v[76:79], v[212:215]
    s_add_u32 s22, s24, 0x180000
    s_add_u32 m0, s20, 0x1c000
    s_nop 0
    buffer_load_dwordx4 v3, s[4:7], s22 offen lds
    ds_read_b128 v[228:231], v5 offset:17408
    v_cvt_pk_bf16_f32 v223, v198, v199
    s_waitcnt lgkmcnt(3)
    v_mfma_f32_16x16x32_bf16 v[200:203], v[240:243], v[80:83], v[200:203]
    buffer_store_dwordx4 v[220:223], v2, s[8:11], s26 offen offset:2048 sc1
    s_add_u32 s16, s63, 0x572000
    v_mov_b32 v14, s28
    v_mov_b32 v15, 0
    s_mov_b64 exec, 1
    buffer_store_dword v14, v15, s[8:11], s16 offen sc1
    s_mov_b64 exec, -1
    v_mfma_f32_16x16x32_bf16 v[204:207], v[240:243], v[84:87], v[204:207]
    ds_read_b128 v[232:235], v5 offset:18432
    s_waitcnt lgkmcnt(3)
    v_mfma_f32_16x16x32_bf16 v[208:211], v[244:247], v[80:83], v[208:211]
    v_mfma_f32_16x16x32_bf16 v[212:215], v[244:247], v[84:87], v[212:215]
    ds_read_b128 v[236:239], v5 offset:19456
    s_waitcnt lgkmcnt(3)
    v_mfma_f32_16x16x32_bf16 v[200:203], v[224:227], v[88:91], v[200:203]
    v_mfma_f32_16x16x32_bf16 v[204:207], v[224:227], v[92:95], v[204:207]
    ds_read_b128 v[240:243], v5 offset:20480
    s_waitcnt vmcnt(5)
    v_cmp_ne_u32 vcc, s28, v12
    s_cbranch_vccnz adaLN_cond__sliding_block_cached__moe_arch_mod__prompt_kernel_o17r
adaLN_cond__sliding_block_cached__moe_arch_mod__prompt_kernel_o17b:
    s_waitcnt lgkmcnt(3)
    v_mfma_f32_16x16x32_bf16 v[208:211], v[228:231], v[88:91], v[208:211]
    s_mov_b32 s23, 0x0
    buffer_load_dwordx4 v[24:27], v6, s[8:11], s23 offen offset:0 sc1
    v_mfma_f32_16x16x32_bf16 v[212:215], v[228:231], v[92:95], v[212:215]
    s_add_u32 s22, s24, 0x182000
    s_add_u32 m0, s20, 0x1c400
    s_nop 0
    buffer_load_dwordx4 v3, s[4:7], s22 offen lds
    ds_read_b128 v[244:247], v5 offset:21504
    s_waitcnt lgkmcnt(3)
    v_mfma_f32_16x16x32_bf16 v[200:203], v[232:235], v[96:99], v[200:203]
    s_mov_b32 s23, 0x20000
    buffer_load_dwordx4 v[28:31], v6, s[8:11], s23 offen offset:0 sc1
    v_mfma_f32_16x16x32_bf16 v[204:207], v[232:235], v[100:103], v[204:207]
    ds_read_b128 v[224:227], v5 offset:22528
    s_waitcnt lgkmcnt(3)
    v_mfma_f32_16x16x32_bf16 v[208:211], v[236:239], v[96:99], v[208:211]
    v_mfma_f32_16x16x32_bf16 v[212:215], v[236:239], v[100:103], v[212:215]
    ds_read_b128 v[228:231], v5 offset:23552
    s_mov_b32 s23, 0x2000
    buffer_load_dwordx4 v[32:35], v6, s[8:11], s23 offen offset:0 sc1
    s_waitcnt lgkmcnt(3)
    v_mfma_f32_16x16x32_bf16 v[200:203], v[240:243], v[104:107], v[200:203]
    v_mfma_f32_16x16x32_bf16 v[204:207], v[240:243], v[108:111], v[204:207]
    ds_read_b128 v[232:235], v5 offset:24576
    s_waitcnt lgkmcnt(3)
    v_mfma_f32_16x16x32_bf16 v[208:211], v[244:247], v[104:107], v[208:211]
    s_mov_b32 s23, 0x22000
    buffer_load_dwordx4 v[36:39], v6, s[8:11], s23 offen offset:0 sc1
    v_mfma_f32_16x16x32_bf16 v[212:215], v[244:247], v[108:111], v[212:215]
    ds_read_b128 v[236:239], v5 offset:25600
    s_waitcnt lgkmcnt(3)
    v_mfma_f32_16x16x32_bf16 v[200:203], v[224:227], v[112:115], v[200:203]
    v_mfma_f32_16x16x32_bf16 v[204:207], v[224:227], v[116:119], v[204:207]
    ds_read_b128 v[240:243], v5 offset:26624
    s_mov_b32 s23, 0x4000
    buffer_load_dwordx4 v[40:43], v6, s[8:11], s23 offen offset:0 sc1
    s_waitcnt lgkmcnt(3)
    v_mfma_f32_16x16x32_bf16 v[208:211], v[228:231], v[112:115], v[208:211]
    v_mfma_f32_16x16x32_bf16 v[212:215], v[228:231], v[116:119], v[212:215]
    ds_read_b128 v[244:247], v5 offset:27648
    s_waitcnt lgkmcnt(3)
    v_mfma_f32_16x16x32_bf16 v[200:203], v[232:235], v[120:123], v[200:203]
    s_mov_b32 s23, 0x24000
    buffer_load_dwordx4 v[44:47], v6, s[8:11], s23 offen offset:0 sc1
    v_mfma_f32_16x16x32_bf16 v[204:207], v[232:235], v[124:127], v[204:207]
    ds_read_b128 v[224:227], v5 offset:28672
    s_waitcnt lgkmcnt(3)
    v_mfma_f32_16x16x32_bf16 v[208:211], v[236:239], v[120:123], v[208:211]
    v_mfma_f32_16x16x32_bf16 v[212:215], v[236:239], v[124:127], v[212:215]
    ds_read_b128 v[228:231], v5 offset:29696
    s_mov_b32 s23, 0x6000
    buffer_load_dwordx4 v[48:51], v6, s[8:11], s23 offen offset:0 sc1
    s_waitcnt lgkmcnt(3)
    v_mfma_f32_16x16x32_bf16 v[200:203], v[240:243], v[128:131], v[200:203]
    v_mfma_f32_16x16x32_bf16 v[204:207], v[240:243], v[132:135], v[204:207]
    ds_read_b128 v[232:235], v5 offset:30720
    s_waitcnt lgkmcnt(3)
    v_mfma_f32_16x16x32_bf16 v[208:211], v[244:247], v[128:131], v[208:211]
    s_mov_b32 s23, 0x26000
    buffer_load_dwordx4 v[52:55], v6, s[8:11], s23 offen offset:0 sc1
    v_mfma_f32_16x16x32_bf16 v[212:215], v[244:247], v[132:135], v[212:215]
    ds_read_b128 v[236:239], v5 offset:31744
    s_waitcnt lgkmcnt(3)
    v_mfma_f32_16x16x32_bf16 v[200:203], v[224:227], v[136:139], v[200:203]
    v_bfe_u32 v18, v1, 2, 2
    v_lshrrev_b32 v19, 4, v1
    v_mfma_f32_16x16x32_bf16 v[204:207], v[224:227], v[140:143], v[204:207]
    s_mov_b32 s23, 0x8000
    buffer_load_dwordx4 v[56:59], v6, s[8:11], s23 offen offset:0 sc1
    v_and_b32 v17, 3, v1
    v_lshlrev_b32 v16, 11, v19
    s_waitcnt lgkmcnt(2)
    v_mfma_f32_16x16x32_bf16 v[208:211], v[228:231], v[136:139], v[208:211]
    v_lshl_add_u32 v16, v18, 6, v16
    v_lshl_add_u32 v16, v17, 3, v16
    v_mfma_f32_16x16x32_bf16 v[212:215], v[228:231], v[140:143], v[212:215]
    v_add_u32 v16, 0x12000, v16
    v_and_b32 v19, 1, v19
    s_waitcnt lgkmcnt(1)
    v_mfma_f32_16x16x32_bf16 v[200:203], v[232:235], v[144:147], v[200:203]
    s_mov_b32 s23, 0x28000
    buffer_load_dwordx4 v[60:63], v6, s[8:11], s23 offen offset:0 sc1
    v_lshlrev_b32 v19, 5, v19
    v_sub_u32 v5, v16, v19
    v_mfma_f32_16x16x32_bf16 v[204:207], v[232:235], v[148:151], v[204:207]
    v_add_u32 v4, v16, v19
    v_add_u32 v7, 0x10000, v4
    s_waitcnt lgkmcnt(0)
    v_mfma_f32_16x16x32_bf16 v[208:211], v[236:239], v[144:147], v[208:211]
    v_add_u32 v8, 0x10000, v5
    v_mfma_f32_16x16x32_bf16 v[212:215], v[236:239], v[148:151], v[212:215]
    v_mul_f32 v200, v200, v9
    v_mul_f32 v201, v201, v9
    v_mul_f32 v202, v202, v9
    v_mul_f32 v203, v203, v9
    s_nop 1
    v_mul_f32 v208, v208, v9
    v_mul_f32 v209, v209, v9
    v_mul_f32 v210, v210, v9
    v_mul_f32 v211, v211, v9
    v_cvt_pk_bf16_f32 v216, v200, v201
    v_cvt_pk_bf16_f32 v217, v202, v203
    v_cvt_pk_bf16_f32 v218, v208, v209
    v_cvt_pk_bf16_f32 v219, v210, v211
    buffer_store_dwordx4 v[216:219], v2, s[8:11], s25 offen offset:3072 sc1
    v_mul_f32 v204, v204, v10
    v_mul_f32 v205, v205, v10
    v_mul_f32 v206, v206, v10
    v_mul_f32 v207, v207, v10
    v_mul_f32 v212, v212, v10
    v_mul_f32 v213, v213, v10
    v_mul_f32 v214, v214, v10
    v_mul_f32 v215, v215, v10
    v_cvt_pk_bf16_f32 v220, v204, v205
    v_cvt_pk_bf16_f32 v221, v206, v207
    v_cvt_pk_bf16_f32 v222, v212, v213
    v_cvt_pk_bf16_f32 v223, v214, v215
    buffer_store_dwordx4 v[220:223], v2, s[8:11], s26 offen offset:3072 sc1
    s_and_b32 s15, s2, 1
    s_barrier
    ds_read_b64_tr_b16 v[224:225], v4 offset:0
    ds_read_b64_tr_b16 v[226:227], v4 offset:1024
    ds_read_b64_tr_b16 v[228:229], v5 offset:32
    ds_read_b64_tr_b16 v[230:231], v5 offset:1056
    ds_read_b64_tr_b16 v[232:233], v4 offset:256
    ds_read_b64_tr_b16 v[234:235], v4 offset:1280
    ds_read_b64_tr_b16 v[236:237], v5 offset:288
    ds_read_b64_tr_b16 v[238:239], v5 offset:1312
    s_waitcnt vmcnt(12) lgkmcnt(6)
    v_mfma_f32_16x16x32_bf16 v[88:91], v[224:227], v[24:27], 0
    ds_read_b64_tr_b16 v[240:241], v4 offset:512
    s_waitcnt vmcnt(10)
    v_mfma_f32_16x16x32_bf16 v[92:95], v[224:227], v[28:31], 0
    ds_read_b64_tr_b16 v[242:243], v4 offset:1536
    s_waitcnt lgkmcnt(6)
    v_mfma_f32_16x16x32_bf16 v[96:99], v[228:231], v[24:27], 0
    ds_read_b64_tr_b16 v[244:245], v5 offset:544
    v_mfma_f32_16x16x32_bf16 v[100:103], v[228:231], v[28:31], 0
    ds_read_b64_tr_b16 v[246:247], v5 offset:1568
    s_waitcnt lgkmcnt(6)
    v_mfma_f32_16x16x32_bf16 v[104:107], v[232:235], v[24:27], 0
    ds_read_b64_tr_b16 v[224:225], v4 offset:768
    v_mfma_f32_16x16x32_bf16 v[108:111], v[232:235], v[28:31], 0
    ds_read_b64_tr_b16 v[226:227], v4 offset:1792
    s_waitcnt lgkmcnt(6)
    v_mfma_f32_16x16x32_bf16 v[112:115], v[236:239], v[24:27], 0
    ds_read_b64_tr_b16 v[228:229], v5 offset:800
    v_mfma_f32_16x16x32_bf16 v[116:119], v[236:239], v[28:31], 0
    ds_read_b64_tr_b16 v[230:231], v5 offset:1824
    s_waitcnt lgkmcnt(6)
    v_mfma_f32_16x16x32_bf16 v[120:123], v[240:243], v[24:27], 0
    s_add_u32 s22, s24, 0x200000
    s_add_u32 m0, s20, 0x20000
    s_nop 0
    buffer_load_dwordx4 v3, s[4:7], s22 offen lds
    v_mfma_f32_16x16x32_bf16 v[124:127], v[240:243], v[28:31], 0
    s_barrier
    ds_read_b64_tr_b16 v[232:233], v4 offset:16384
    ds_read_b64_tr_b16 v[234:235], v4 offset:17408
    s_waitcnt lgkmcnt(6)
    v_mfma_f32_16x16x32_bf16 v[128:131], v[244:247], v[24:27], 0
    ds_read_b64_tr_b16 v[236:237], v5 offset:16416
    s_mov_b32 s23, 0xa000
    buffer_load_dwordx4 v[64:67], v6, s[8:11], s23 offen offset:0 sc1
    v_mfma_f32_16x16x32_bf16 v[132:135], v[244:247], v[28:31], 0
    s_add_u32 s22, s24, 0x202000
    s_add_u32 m0, s20, 0x20400
    s_nop 0
    buffer_load_dwordx4 v3, s[4:7], s22 offen lds
    ds_read_b64_tr_b16 v[238:239], v5 offset:17440
    s_waitcnt lgkmcnt(6)
    v_mfma_f32_16x16x32_bf16 v[136:139], v[224:227], v[24:27], 0
    ds_read_b64_tr_b16 v[240:241], v4 offset:16640
    v_mfma_f32_16x16x32_bf16 v[140:143], v[224:227], v[28:31], 0
    ds_read_b64_tr_b16 v[242:243], v4 offset:17664
    s_mov_b32 s23, 0x2a000
    buffer_load_dwordx4 v[68:71], v6, s[8:11], s23 offen offset:0 sc1
    s_waitcnt lgkmcnt(6)
    v_mfma_f32_16x16x32_bf16 v[144:147], v[228:231], v[24:27], 0
    ds_read_b64_tr_b16 v[244:245], v5 offset:16672
    v_mfma_f32_16x16x32_bf16 v[148:151], v[228:231], v[28:31], 0
    ds_read_b64_tr_b16 v[246:247], v5 offset:17696
    s_waitcnt vmcnt(13) lgkmcnt(6)
    v_mfma_f32_16x16x32_bf16 v[88:91], v[232:235], v[32:35], v[88:91]
    ds_read_b64_tr_b16 v[224:225], v4 offset:16896
    s_waitcnt vmcnt(12)
    v_mfma_f32_16x16x32_bf16 v[92:95], v[232:235], v[36:39], v[92:95]
    s_add_u32 s22, s24, 0x280000
    s_add_u32 m0, s20, 0x24000
    s_nop 0
    buffer_load_dwordx4 v3, s[4:7], s22 offen lds
    ds_read_b64_tr_b16 v[226:227], v4 offset:17920
    s_waitcnt lgkmcnt(6)
    v_mfma_f32_16x16x32_bf16 v[96:99], v[236:239], v[32:35], v[96:99]
    ds_read_b64_tr_b16 v[228:229], v5 offset:16928
    v_mfma_f32_16x16x32_bf16 v[100:103], v[236:239], v[36:39], v[100:103]
    ds_read_b64_tr_b16 v[230:231], v5 offset:17952
    s_waitcnt lgkmcnt(6)
    v_mfma_f32_16x16x32_bf16 v[104:107], v[240:243], v[32:35], v[104:107]
    s_add_u32 s22, s24, 0x282000
    s_add_u32 m0, s20, 0x24400
    s_nop 0
    buffer_load_dwordx4 v3, s[4:7], s22 offen lds
    ds_read_b64_tr_b16 v[232:233], v4 offset:17152
    v_mfma_f32_16x16x32_bf16 v[108:111], v[240:243], v[36:39], v[108:111]
    ds_read_b64_tr_b16 v[234:235], v4 offset:18176
    s_waitcnt lgkmcnt(6)
    v_mfma_f32_16x16x32_bf16 v[112:115], v[244:247], v[32:35], v[112:115]
    ds_read_b64_tr_b16 v[236:237], v5 offset:17184
    v_mfma_f32_16x16x32_bf16 v[116:119], v[244:247], v[36:39], v[116:119]
    ds_read_b64_tr_b16 v[238:239], v5 offset:18208
    s_waitcnt lgkmcnt(6)
    v_mfma_f32_16x16x32_bf16 v[120:123], v[224:227], v[32:35], v[120:123]
    v_mfma_f32_16x16x32_bf16 v[124:127], v[224:227], v[36:39], v[124:127]
    s_barrier
    ds_read_b64_tr_b16 v[240:241], v4 offset:32768
    ds_read_b64_tr_b16 v[242:243], v4 offset:33792
    s_add_u32 s19, s19, 8192
    buffer_load_dword v12, v13, s[8:11], s19 offen sc1
    s_waitcnt lgkmcnt(6)
    v_mfma_f32_16x16x32_bf16 v[128:131], v[228:231], v[32:35], v[128:131]
    ds_read_b64_tr_b16 v[244:245], v5 offset:32800
    s_mov_b32 s23, 0xc000
    buffer_load_dwordx4 v[24:27], v6, s[8:11], s23 offen offset:0 sc1
    v_mfma_f32_16x16x32_bf16 v[132:135], v[228:231], v[36:39], v[132:135]
    ds_read_b64_tr_b16 v[246:247], v5 offset:33824
    s_waitcnt lgkmcnt(6)
    v_mfma_f32_16x16x32_bf16 v[136:139], v[232:235], v[32:35], v[136:139]
    ds_read_b64_tr_b16 v[224:225], v4 offset:33024
    v_mfma_f32_16x16x32_bf16 v[140:143], v[232:235], v[36:39], v[140:143]
    ds_read_b64_tr_b16 v[226:227], v4 offset:34048
    s_mov_b32 s23, 0x2c000
    buffer_load_dwordx4 v[28:31], v6, s[8:11], s23 offen offset:0 sc1
    s_waitcnt lgkmcnt(6)
    v_mfma_f32_16x16x32_bf16 v[144:147], v[236:239], v[32:35], v[144:147]
    s_add_u32 s16, s63, 0x574000
    v_mov_b32 v14, s28
    v_mov_b32 v15, 0
    s_mov_b64 exec, 1
    buffer_store_dword v14, v15, s[8:11], s16 offen sc1
    s_mov_b64 exec, -1
    ds_read_b64_tr_b16 v[228:229], v5 offset:33056
    v_mfma_f32_16x16x32_bf16 v[148:151], v[236:239], v[36:39], v[148:151]
    ds_read_b64_tr_b16 v[230:231], v5 offset:34080
    s_waitcnt vmcnt(17) lgkmcnt(6)
    v_mfma_f32_16x16x32_bf16 v[88:91], v[240:243], v[40:43], v[88:91]
    ds_read_b64_tr_b16 v[232:233], v4 offset:33280
    s_waitcnt vmcnt(16)
    v_mfma_f32_16x16x32_bf16 v[92:95], v[240:243], v[44:47], v[92:95]
    s_add_u32 s22, s24, 0x300000
    s_add_u32 m0, s20, 0x10000
    s_nop 0
    buffer_load_dwordx4 v3, s[4:7], s22 offen lds
    ds_read_b64_tr_b16 v[234:235], v4 offset:34304
    s_waitcnt lgkmcnt(6)
    v_mfma_f32_16x16x32_bf16 v[96:99], v[244:247], v[40:43], v[96:99]
    ds_read_b64_tr_b16 v[236:237], v5 offset:33312
    v_mfma_f32_16x16x32_bf16 v[100:103], v[244:247], v[44:47], v[100:103]
    ds_read_b64_tr_b16 v[238:239], v5 offset:34336
    s_waitcnt lgkmcnt(6)
    v_mfma_f32_16x16x32_bf16 v[104:107], v[224:227], v[40:43], v[104:107]
    s_add_u32 s22, s24, 0x302000
    s_add_u32 m0, s20, 0x10400
    s_nop 0
    buffer_load_dwordx4 v3, s[4:7], s22 offen lds
    ds_read_b64_tr_b16 v[240:241], v4 offset:33536
    v_mfma_f32_16x16x32_bf16 v[108:111], v[224:227], v[44:47], v[108:111]
    ds_read_b64_tr_b16 v[242:243], v4 offset:34560
    s_waitcnt lgkmcnt(6)
    v_mfma_f32_16x16x32_bf16 v[112:115], v[228:231], v[40:43], v[112:115]
    ds_read_b64_tr_b16 v[244:245], v5 offset:33568
    v_mfma_f32_16x16x32_bf16 v[116:119], v[228:231], v[44:47], v[116:119]
    ds_read_b64_tr_b16 v[246:247], v5 offset:34592
    s_waitcnt lgkmcnt(6)
    v_mfma_f32_16x16x32_bf16 v[120:123], v[232:235], v[40:43], v[120:123]
    v_mfma_f32_16x16x32_bf16 v[124:127], v[232:235], v[44:47], v[124:127]
    s_barrier
    ds_read_b64_tr_b16 v[224:225], v4 offset:49152
    ds_read_b64_tr_b16 v[226:227], v4 offset:50176
    s_waitcnt lgkmcnt(6)
    v_mfma_f32_16x16x32_bf16 v[128:131], v[236:239], v[40:43], v[128:131]
    ds_read_b64_tr_b16 v[228:229], v5 offset:49184
    s_mov_b32 s23, 0xe000
    buffer_load_dwordx4 v[32:35], v6, s[8:11], s23 offen offset:0 sc1
    v_mfma_f32_16x16x32_bf16 v[132:135], v[236:239], v[44:47], v[132:135]
    ds_read_b64_tr_b16 v[230:231], v5 offset:50208
    s_waitcnt lgkmcnt(6)
    v_mfma_f32_16x16x32_bf16 v[136:139], v[240:243], v[40:43], v[136:139]
    ds_read_b64_tr_b16 v[232:233], v4 offset:49408
    v_mfma_f32_16x16x32_bf16 v[140:143], v[240:243], v[44:47], v[140:143]
    ds_read_b64_tr_b16 v[234:235], v4 offset:50432
    s_mov_b32 s23, 0x2e000
    buffer_load_dwordx4 v[36:39], v6, s[8:11], s23 offen offset:0 sc1
    s_waitcnt lgkmcnt(6)
    v_mfma_f32_16x16x32_bf16 v[144:147], v[244:247], v[40:43], v[144:147]
    ds_read_b64_tr_b16 v[236:237], v5 offset:49440
    v_mfma_f32_16x16x32_bf16 v[148:151], v[244:247], v[44:47], v[148:151]
    ds_read_b64_tr_b16 v[238:239], v5 offset:50464
    s_waitcnt vmcnt(7)
    v_cmp_ne_u32 vcc, s28, v12
    s_cbranch_vccnz adaLN_cond__sliding_block_cached__moe_arch_mod__prompt_kernel_o218r
adaLN_cond__sliding_block_cached__moe_arch_mod__prompt_kernel_o218b:
    s_waitcnt lgkmcnt(6)
    v_mfma_f32_16x16x32_bf16 v[88:91], v[224:227], v[48:51], v[88:91]
    ds_read_b64_tr_b16 v[240:241], v4 offset:49664
    v_mfma_f32_16x16x32_bf16 v[92:95], v[224:227], v[52:55], v[92:95]
    s_add_u32 s22, s24, 0x380000
    s_add_u32 m0, s20, 0x14000
    s_nop 0
    buffer_load_dwordx4 v3, s[4:7], s22 offen lds
    ds_read_b64_tr_b16 v[242:243], v4 offset:50688
    s_waitcnt lgkmcnt(6)
    v_mfma_f32_16x16x32_bf16 v[96:99], v[228:231], v[48:51], v[96:99]
    ds_read_b64_tr_b16 v[244:245], v5 offset:49696
    v_mfma_f32_16x16x32_bf16 v[100:103], v[228:231], v[52:55], v[100:103]
    ds_read_b64_tr_b16 v[246:247], v5 offset:50720
    s_waitcnt lgkmcnt(6)
    v_mfma_f32_16x16x32_bf16 v[104:107], v[232:235], v[48:51], v[104:107]
    s_add_u32 s22, s24, 0x382000
    s_add_u32 m0, s20, 0x14400
    s_nop 0
    buffer_load_dwordx4 v3, s[4:7], s22 offen lds
    ds_read_b64_tr_b16 v[224:225], v4 offset:49920
    v_mfma_f32_16x16x32_bf16 v[108:111], v[232:235], v[52:55], v[108:111]
    ds_read_b64_tr_b16 v[226:227], v4 offset:50944
    s_waitcnt lgkmcnt(6)
    v_mfma_f32_16x16x32_bf16 v[112:115], v[236:239], v[48:51], v[112:115]
    ds_read_b64_tr_b16 v[228:229], v5 offset:49952
    v_mfma_f32_16x16x32_bf16 v[116:119], v[236:239], v[52:55], v[116:119]
    ds_read_b64_tr_b16 v[230:231], v5 offset:50976
    s_waitcnt lgkmcnt(6)
    v_mfma_f32_16x16x32_bf16 v[120:123], v[240:243], v[48:51], v[120:123]
    v_mfma_f32_16x16x32_bf16 v[124:127], v[240:243], v[52:55], v[124:127]
    s_barrier
    ds_read_b64_tr_b16 v[232:233], v7 offset:0
    ds_read_b64_tr_b16 v[234:235], v7 offset:1024
    s_waitcnt lgkmcnt(6)
    v_mfma_f32_16x16x32_bf16 v[128:131], v[244:247], v[48:51], v[128:131]
    ds_read_b64_tr_b16 v[236:237], v8 offset:32
    s_mov_b32 s23, 0x0
    buffer_load_dwordx4 v[40:43], v6, s[8:11], s23 offen offset:1024 sc1
    v_mfma_f32_16x16x32_bf16 v[132:135], v[244:247], v[52:55], v[132:135]
    ds_read_b64_tr_b16 v[238:239], v8 offset:1056
    s_waitcnt lgkmcnt(6)
    v_mfma_f32_16x16x32_bf16 v[136:139], v[224:227], v[48:51], v[136:139]
    ds_read_b64_tr_b16 v[240:241], v7 offset:256
    v_mfma_f32_16x16x32_bf16 v[140:143], v[224:227], v[52:55], v[140:143]
    ds_read_b64_tr_b16 v[242:243], v7 offset:1280
    s_mov_b32 s23, 0x20000
    buffer_load_dwordx4 v[44:47], v6, s[8:11], s23 offen offset:1024 sc1
    s_waitcnt lgkmcnt(6)
    v_mfma_f32_16x16x32_bf16 v[144:147], v[228:231], v[48:51], v[144:147]
    ds_read_b64_tr_b16 v[244:245], v8 offset:288
    v_mfma_f32_16x16x32_bf16 v[148:151], v[228:231], v[52:55], v[148:151]
    ds_read_b64_tr_b16 v[246:247], v8 offset:1312
    s_waitcnt lgkmcnt(6)
    v_mfma_f32_16x16x32_bf16 v[88:91], v[232:235], v[56:59], v[88:91]
    ds_read_b64_tr_b16 v[224:225], v7 offset:512
    v_mfma_f32_16x16x32_bf16 v[92:95], v[232:235], v[60:63], v[92:95]
    s_add_u32 s22, s24, 0x10000
    s_add_u32 m0, s20, 0x18000
    s_nop 0
    buffer_load_dwordx4 v3, s[4:7], s22 offen lds
    ds_read_b64_tr_b16 v[226:227], v7 offset:1536
    s_waitcnt lgkmcnt(6)
    v_mfma_f32_16x16x32_bf16 v[96:99], v[236:239], v[56:59], v[96:99]
    ds_read_b64_tr_b16 v[228:229], v8 offset:544
    v_mfma_f32_16x16x32_bf16 v[100:103], v[236:239], v[60:63], v[100:103]
    ds_read_b64_tr_b16 v[230:231], v8 offset:1568
    s_waitcnt lgkmcnt(6)
    v_mfma_f32_16x16x32_bf16 v[104:107], v[240:243], v[56:59], v[104:107]
    s_add_u32 s22, s24, 0x12000
    s_add_u32 m0, s20, 0x18400
    s_nop 0
    buffer_load_dwordx4 v3, s[4:7], s22 offen lds
    ds_read_b64_tr_b16 v[232:233], v7 offset:768
    v_mfma_f32_16x16x32_bf16 v[108:111], v[240:243], v[60:63], v[108:111]
    ds_read_b64_tr_b16 v[234:235], v7 offset:1792
    s_waitcnt lgkmcnt(6)
    v_mfma_f32_16x16x32_bf16 v[112:115], v[244:247], v[56:59], v[112:115]
    ds_read_b64_tr_b16 v[236:237], v8 offset:800
    v_mfma_f32_16x16x32_bf16 v[116:119], v[244:247], v[60:63], v[116:119]
    ds_read_b64_tr_b16 v[238:239], v8 offset:1824
    s_waitcnt lgkmcnt(6)
    v_mfma_f32_16x16x32_bf16 v[120:123], v[224:227], v[56:59], v[120:123]
    v_mfma_f32_16x16x32_bf16 v[124:127], v[224:227], v[60:63], v[124:127]
    s_barrier
    ds_read_b64_tr_b16 v[240:241], v7 offset:16384
    ds_read_b64_tr_b16 v[242:243], v7 offset:17408
    s_waitcnt lgkmcnt(6)
    v_mfma_f32_16x16x32_bf16 v[128:131], v[228:231], v[56:59], v[128:131]
    ds_read_b64_tr_b16 v[244:245], v8 offset:16416
    s_mov_b32 s23, 0x2000
    buffer_load_dwordx4 v[48:51], v6, s[8:11], s23 offen offset:1024 sc1
    v_mfma_f32_16x16x32_bf16 v[132:135], v[228:231], v[60:63], v[132:135]
    ds_read_b64_tr_b16 v[246:247], v8 offset:17440
    s_waitcnt lgkmcnt(6)
    v_mfma_f32_16x16x32_bf16 v[136:139], v[232:235], v[56:59], v[136:139]
    ds_read_b64_tr_b16 v[224:225], v7 offset:16640
    v_mfma_f32_16x16x32_bf16 v[140:143], v[232:235], v[60:63], v[140:143]
    ds_read_b64_tr_b16 v[226:227], v7 offset:17664
    s_mov_b32 s23, 0x22000
    buffer_load_dwordx4 v[52:55], v6, s[8:11], s23 offen offset:1024 sc1
    s_waitcnt lgkmcnt(6)
    v_mfma_f32_16x16x32_bf16 v[144:147], v[236:239], v[56:59], v[144:147]
    ds_read_b64_tr_b16 v[228:229], v8 offset:16672
    v_mfma_f32_16x16x32_bf16 v[148:151], v[236:239], v[60:63], v[148:151]
    ds_read_b64_tr_b16 v[230:231], v8 offset:17696
    s_waitcnt lgkmcnt(6)
    v_mfma_f32_16x16x32_bf16 v[88:91], v[240:243], v[64:67], v[88:91]
    ds_read_b64_tr_b16 v[232:233], v7 offset:16896
    v_mfma_f32_16x16x32_bf16 v[92:95], v[240:243], v[68:71], v[92:95]
    s_add_u32 s22, s24, 0x90000
    s_add_u32 m0, s20, 0x1c000
    s_nop 0
    buffer_load_dwordx4 v3, s[4:7], s22 offen lds
    ds_read_b64_tr_b16 v[234:235], v7 offset:17920
    s_waitcnt lgkmcnt(6)
    v_mfma_f32_16x16x32_bf16 v[96:99], v[244:247], v[64:67], v[96:99]
    ds_read_b64_tr_b16 v[236:237], v8 offset:16928
    v_mfma_f32_16x16x32_bf16 v[100:103], v[244:247], v[68:71], v[100:103]
    ds_read_b64_tr_b16 v[238:239], v8 offset:17952
    s_waitcnt lgkmcnt(6)
    v_mfma_f32_16x16x32_bf16 v[104:107], v[224:227], v[64:67], v[104:107]
    s_add_u32 s22, s24, 0x92000
    s_add_u32 m0, s20, 0x1c400
    s_nop 0
    buffer_load_dwordx4 v3, s[4:7], s22 offen lds
    ds_read_b64_tr_b16 v[240:241], v7 offset:17152
    v_mfma_f32_16x16x32_bf16 v[108:111], v[224:227], v[68:71], v[108:111]
    ds_read_b64_tr_b16 v[242:243], v7 offset:18176
    s_waitcnt lgkmcnt(6)
    v_mfma_f32_16x16x32_bf16 v[112:115], v[228:231], v[64:67], v[112:115]
    ds_read_b64_tr_b16 v[244:245], v8 offset:17184
    v_mfma_f32_16x16x32_bf16 v[116:119], v[228:231], v[68:71], v[116:119]
    ds_read_b64_tr_b16 v[246:247], v8 offset:18208
    s_waitcnt lgkmcnt(6)
    v_mfma_f32_16x16x32_bf16 v[120:123], v[232:235], v[64:67], v[120:123]
    v_mfma_f32_16x16x32_bf16 v[124:127], v[232:235], v[68:71], v[124:127]
    s_waitcnt vmcnt(12)
    s_barrier
    ds_read_b64_tr_b16 v[224:225], v4 offset:0
    ds_read_b64_tr_b16 v[226:227], v4 offset:1024
    s_waitcnt lgkmcnt(6)
    v_mfma_f32_16x16x32_bf16 v[128:131], v[236:239], v[64:67], v[128:131]
    s_add_u32 s16, s63, 0x576000
    v_mov_b32 v14, s28
    v_mov_b32 v15, 0
    s_mov_b64 exec, 1
    buffer_store_dword v14, v15, s[8:11], s16 offen sc1
    s_mov_b64 exec, -1
    ds_read_b64_tr_b16 v[228:229], v5 offset:32
    s_mov_b32 s23, 0x4000
    buffer_load_dwordx4 v[56:59], v6, s[8:11], s23 offen offset:1024 sc1
    v_mfma_f32_16x16x32_bf16 v[132:135], v[236:239], v[68:71], v[132:135]
    ds_read_b64_tr_b16 v[230:231], v5 offset:1056
    s_waitcnt lgkmcnt(6)
    v_mfma_f32_16x16x32_bf16 v[136:139], v[240:243], v[64:67], v[136:139]
    ds_read_b64_tr_b16 v[232:233], v4 offset:256
    v_mfma_f32_16x16x32_bf16 v[140:143], v[240:243], v[68:71], v[140:143]
    ds_read_b64_tr_b16 v[234:235], v4 offset:1280
    s_mov_b32 s23, 0x24000
    buffer_load_dwordx4 v[60:63], v6, s[8:11], s23 offen offset:1024 sc1
    s_waitcnt lgkmcnt(6)
    v_mfma_f32_16x16x32_bf16 v[144:147], v[244:247], v[64:67], v[144:147]
    ds_read_b64_tr_b16 v[236:237], v5 offset:288
    v_mfma_f32_16x16x32_bf16 v[148:151], v[244:247], v[68:71], v[148:151]
    ds_read_b64_tr_b16 v[238:239], v5 offset:1312
    s_waitcnt lgkmcnt(6)
    v_mfma_f32_16x16x32_bf16 v[88:91], v[224:227], v[24:27], v[88:91]
    ds_read_b64_tr_b16 v[240:241], v4 offset:512
    v_mfma_f32_16x16x32_bf16 v[92:95], v[224:227], v[28:31], v[92:95]
    s_add_u32 s22, s24, 0x110000
    s_add_u32 m0, s20, 0x20000
    s_nop 0
    buffer_load_dwordx4 v3, s[4:7], s22 offen lds
    ds_read_b64_tr_b16 v[242:243], v4 offset:1536
    s_waitcnt lgkmcnt(6)
    v_mfma_f32_16x16x32_bf16 v[96:99], v[228:231], v[24:27], v[96:99]
    ds_read_b64_tr_b16 v[244:245], v5 offset:544
    v_mfma_f32_16x16x32_bf16 v[100:103], v[228:231], v[28:31], v[100:103]
    ds_read_b64_tr_b16 v[246:247], v5 offset:1568
    s_waitcnt lgkmcnt(6)
    v_mfma_f32_16x16x32_bf16 v[104:107], v[232:235], v[24:27], v[104:107]
    s_add_u32 s22, s24, 0x112000
    s_add_u32 m0, s20, 0x20400
    s_nop 0
    buffer_load_dwordx4 v3, s[4:7], s22 offen lds
    ds_read_b64_tr_b16 v[224:225], v4 offset:768
    v_mfma_f32_16x16x32_bf16 v[108:111], v[232:235], v[28:31], v[108:111]
    ds_read_b64_tr_b16 v[226:227], v4 offset:1792
    s_waitcnt lgkmcnt(6)
    v_mfma_f32_16x16x32_bf16 v[112:115], v[236:239], v[24:27], v[112:115]
    ds_read_b64_tr_b16 v[228:229], v5 offset:800
    v_mfma_f32_16x16x32_bf16 v[116:119], v[236:239], v[28:31], v[116:119]
    ds_read_b64_tr_b16 v[230:231], v5 offset:1824
    s_waitcnt lgkmcnt(6)
    v_mfma_f32_16x16x32_bf16 v[120:123], v[240:243], v[24:27], v[120:123]
    v_mfma_f32_16x16x32_bf16 v[124:127], v[240:243], v[28:31], v[124:127]
    s_waitcnt vmcnt(13)
    s_barrier
    ds_read_b64_tr_b16 v[232:233], v4 offset:16384
    ds_read_b64_tr_b16 v[234:235], v4 offset:17408
    s_waitcnt lgkmcnt(6)
    v_mfma_f32_16x16x32_bf16 v[128:131], v[244:247], v[24:27], v[128:131]
    ds_read_b64_tr_b16 v[236:237], v5 offset:16416
    s_mov_b32 s23, 0x6000
    buffer_load_dwordx4 v[64:67], v6, s[8:11], s23 offen offset:1024 sc1
    v_mfma_f32_16x16x32_bf16 v[132:135], v[244:247], v[28:31], v[132:135]
    ds_read_b64_tr_b16 v[238:239], v5 offset:17440
    s_waitcnt lgkmcnt(6)
    v_mfma_f32_16x16x32_bf16 v[136:139], v[224:227], v[24:27], v[136:139]
    ds_read_b64_tr_b16 v[240:241], v4 offset:16640
    v_mfma_f32_16x16x32_bf16 v[140:143], v[224:227], v[28:31], v[140:143]
    ds_read_b64_tr_b16 v[242:243], v4 offset:17664
    s_mov_b32 s23, 0x26000
    buffer_load_dwordx4 v[68:71], v6, s[8:11], s23 offen offset:1024 sc1
    s_waitcnt lgkmcnt(6)
    v_mfma_f32_16x16x32_bf16 v[144:147], v[228:231], v[24:27], v[144:147]
    ds_read_b64_tr_b16 v[244:245], v5 offset:16672
    v_mfma_f32_16x16x32_bf16 v[148:151], v[228:231], v[28:31], v[148:151]
    ds_read_b64_tr_b16 v[246:247], v5 offset:17696
    s_waitcnt lgkmcnt(6)
    v_mfma_f32_16x16x32_bf16 v[88:91], v[232:235], v[32:35], v[88:91]
    ds_read_b64_tr_b16 v[224:225], v4 offset:16896
    v_mfma_f32_16x16x32_bf16 v[92:95], v[232:235], v[36:39], v[92:95]
    s_add_u32 s22, s24, 0x190000
    s_add_u32 m0, s20, 0x24000
    s_nop 0
    buffer_load_dwordx4 v3, s[4:7], s22 offen lds
    ds_read_b64_tr_b16 v[226:227], v4 offset:17920
    s_waitcnt lgkmcnt(6)
    v_mfma_f32_16x16x32_bf16 v[96:99], v[236:239], v[32:35], v[96:99]
    ds_read_b64_tr_b16 v[228:229], v5 offset:16928
    v_mfma_f32_16x16x32_bf16 v[100:103], v[236:239], v[36:39], v[100:103]
    ds_read_b64_tr_b16 v[230:231], v5 offset:17952
    s_waitcnt lgkmcnt(6)
    v_mfma_f32_16x16x32_bf16 v[104:107], v[240:243], v[32:35], v[104:107]
    s_add_u32 s22, s24, 0x192000
    s_add_u32 m0, s20, 0x24400
    s_nop 0
    buffer_load_dwordx4 v3, s[4:7], s22 offen lds
    ds_read_b64_tr_b16 v[232:233], v4 offset:17152
    v_mfma_f32_16x16x32_bf16 v[108:111], v[240:243], v[36:39], v[108:111]
    ds_read_b64_tr_b16 v[234:235], v4 offset:18176
    s_waitcnt lgkmcnt(6)
    v_mfma_f32_16x16x32_bf16 v[112:115], v[244:247], v[32:35], v[112:115]
    ds_read_b64_tr_b16 v[236:237], v5 offset:17184
    v_mfma_f32_16x16x32_bf16 v[116:119], v[244:247], v[36:39], v[116:119]
    ds_read_b64_tr_b16 v[238:239], v5 offset:18208
    s_waitcnt lgkmcnt(6)
    v_mfma_f32_16x16x32_bf16 v[120:123], v[224:227], v[32:35], v[120:123]
    v_mfma_f32_16x16x32_bf16 v[124:127], v[224:227], v[36:39], v[124:127]
    s_waitcnt vmcnt(13)
    s_barrier
    ds_read_b64_tr_b16 v[240:241], v4 offset:32768
    ds_read_b64_tr_b16 v[242:243], v4 offset:33792
    s_waitcnt lgkmcnt(6)
    v_mfma_f32_16x16x32_bf16 v[128:131], v[228:231], v[32:35], v[128:131]
    ds_read_b64_tr_b16 v[244:245], v5 offset:32800
    s_mov_b32 s23, 0x8000
    buffer_load_dwordx4 v[24:27], v6, s[8:11], s23 offen offset:1024 sc1
    v_mfma_f32_16x16x32_bf16 v[132:135], v[228:231], v[36:39], v[132:135]
    ds_read_b64_tr_b16 v[246:247], v5 offset:33824
    s_waitcnt lgkmcnt(6)
    v_mfma_f32_16x16x32_bf16 v[136:139], v[232:235], v[32:35], v[136:139]
    ds_read_b64_tr_b16 v[224:225], v4 offset:33024
    v_mfma_f32_16x16x32_bf16 v[140:143], v[232:235], v[36:39], v[140:143]
    ds_read_b64_tr_b16 v[226:227], v4 offset:34048
    s_mov_b32 s23, 0x28000
    buffer_load_dwordx4 v[28:31], v6, s[8:11], s23 offen offset:1024 sc1
    s_waitcnt lgkmcnt(6)
    v_mfma_f32_16x16x32_bf16 v[144:147], v[236:239], v[32:35], v[144:147]
    ds_read_b64_tr_b16 v[228:229], v5 offset:33056
    v_mfma_f32_16x16x32_bf16 v[148:151], v[236:239], v[36:39], v[148:151]
    ds_read_b64_tr_b16 v[230:231], v5 offset:34080
    s_waitcnt lgkmcnt(6)
    v_mfma_f32_16x16x32_bf16 v[88:91], v[240:243], v[40:43], v[88:91]
    ds_read_b64_tr_b16 v[232:233], v4 offset:33280
    v_mfma_f32_16x16x32_bf16 v[92:95], v[240:243], v[44:47], v[92:95]
    s_add_u32 s22, s24, 0x210000
    s_add_u32 m0, s20, 0x10000
    s_nop 0
    buffer_load_dwordx4 v3, s[4:7], s22 offen lds
    ds_read_b64_tr_b16 v[234:235], v4 offset:34304
    s_waitcnt lgkmcnt(6)
    v_mfma_f32_16x16x32_bf16 v[96:99], v[244:247], v[40:43], v[96:99]
    ds_read_b64_tr_b16 v[236:237], v5 offset:33312
    v_mfma_f32_16x16x32_bf16 v[100:103], v[244:247], v[44:47], v[100:103]
    ds_read_b64_tr_b16 v[238:239], v5 offset:34336
    s_waitcnt lgkmcnt(6)
    v_mfma_f32_16x16x32_bf16 v[104:107], v[224:227], v[40:43], v[104:107]
    s_add_u32 s22, s24, 0x212000
    s_add_u32 m0, s20, 0x10400
    s_nop 0
    buffer_load_dwordx4 v3, s[4:7], s22 offen lds
    ds_read_b64_tr_b16 v[240:241], v4 offset:33536
    v_mfma_f32_16x16x32_bf16 v[108:111], v[224:227], v[44:47], v[108:111]
    ds_read_b64_tr_b16 v[242:243], v4 offset:34560
    s_waitcnt lgkmcnt(6)
    v_mfma_f32_16x16x32_bf16 v[112:115], v[228:231], v[40:43], v[112:115]
    ds_read_b64_tr_b16 v[244:245], v5 offset:33568
    v_mfma_f32_16x16x32_bf16 v[116:119], v[228:231], v[44:47], v[116:119]
    ds_read_b64_tr_b16 v[246:247], v5 offset:34592
    s_waitcnt lgkmcnt(6)
    v_mfma_f32_16x16x32_bf16 v[120:123], v[232:235], v[40:43], v[120:123]
    v_mfma_f32_16x16x32_bf16 v[124:127], v[232:235], v[44:47], v[124:127]
    s_waitcnt vmcnt(13)
    s_barrier
    ds_read_b64_tr_b16 v[224:225], v4 offset:49152
    ds_read_b64_tr_b16 v[226:227], v4 offset:50176
    s_waitcnt lgkmcnt(6)
    v_mfma_f32_16x16x32_bf16 v[128:131], v[236:239], v[40:43], v[128:131]
    ds_read_b64_tr_b16 v[228:229], v5 offset:49184
    s_mov_b32 s23, 0xa000
    buffer_load_dwordx4 v[32:35], v6, s[8:11], s23 offen offset:1024 sc1
    v_mfma_f32_16x16x32_bf16 v[132:135], v[236:239], v[44:47], v[132:135]
    ds_read_b64_tr_b16 v[230:231], v5 offset:50208
    s_waitcnt lgkmcnt(6)
    v_mfma_f32_16x16x32_bf16 v[136:139], v[240:243], v[40:43], v[136:139]
    ds_read_b64_tr_b16 v[232:233], v4 offset:49408
    v_mfma_f32_16x16x32_bf16 v[140:143], v[240:243], v[44:47], v[140:143]
    ds_read_b64_tr_b16 v[234:235], v4 offset:50432
    s_mov_b32 s23, 0x2a000
    buffer_load_dwordx4 v[36:39], v6, s[8:11], s23 offen offset:1024 sc1
    s_waitcnt lgkmcnt(6)
    v_mfma_f32_16x16x32_bf16 v[144:147], v[244:247], v[40:43], v[144:147]
    ds_read_b64_tr_b16 v[236:237], v5 offset:49440
    v_mfma_f32_16x16x32_bf16 v[148:151], v[244:247], v[44:47], v[148:151]
    ds_read_b64_tr_b16 v[238:239], v5 offset:50464
    s_waitcnt lgkmcnt(6)
    v_mfma_f32_16x16x32_bf16 v[88:91], v[224:227], v[48:51], v[88:91]
    ds_read_b64_tr_b16 v[240:241], v4 offset:49664
    v_mfma_f32_16x16x32_bf16 v[92:95], v[224:227], v[52:55], v[92:95]
    s_add_u32 s22, s24, 0x290000
    s_add_u32 m0, s20, 0x14000
    s_nop 0
    buffer_load_dwordx4 v3, s[4:7], s22 offen lds
    ds_read_b64_tr_b16 v[242:243], v4 offset:50688
    s_waitcnt lgkmcnt(6)
    v_mfma_f32_16x16x32_bf16 v[96:99], v[228:231], v[48:51], v[96:99]
    ds_read_b64_tr_b16 v[244:245], v5 offset:49696
    v_mfma_f32_16x16x32_bf16 v[100:103], v[228:231], v[52:55], v[100:103]
    ds_read_b64_tr_b16 v[246:247], v5 offset:50720
    s_waitcnt lgkmcnt(6)
    v_mfma_f32_16x16x32_bf16 v[104:107], v[232:235], v[48:51], v[104:107]
    s_add_u32 s22, s24, 0x292000
    s_add_u32 m0, s20, 0x14400
    s_nop 0
    buffer_load_dwordx4 v3, s[4:7], s22 offen lds
    ds_read_b64_tr_b16 v[224:225], v4 offset:49920
    v_mfma_f32_16x16x32_bf16 v[108:111], v[232:235], v[52:55], v[108:111]
    ds_read_b64_tr_b16 v[226:227], v4 offset:50944
    s_waitcnt lgkmcnt(6)
    v_mfma_f32_16x16x32_bf16 v[112:115], v[236:239], v[48:51], v[112:115]
    ds_read_b64_tr_b16 v[228:229], v5 offset:49952
    v_mfma_f32_16x16x32_bf16 v[116:119], v[236:239], v[52:55], v[116:119]
    ds_read_b64_tr_b16 v[230:231], v5 offset:50976
    s_waitcnt lgkmcnt(6)
    v_mfma_f32_16x16x32_bf16 v[120:123], v[240:243], v[48:51], v[120:123]
    v_mfma_f32_16x16x32_bf16 v[124:127], v[240:243], v[52:55], v[124:127]
    s_waitcnt vmcnt(12)
    s_barrier
    ds_read_b64_tr_b16 v[232:233], v7 offset:0
    ds_read_b64_tr_b16 v[234:235], v7 offset:1024
    s_add_u32 s19, s19, 8192
    buffer_load_dword v12, v13, s[8:11], s19 offen sc1
    s_waitcnt lgkmcnt(6)
    v_mfma_f32_16x16x32_bf16 v[128:131], v[244:247], v[48:51], v[128:131]
    ds_read_b64_tr_b16 v[236:237], v8 offset:32
    s_mov_b32 s23, 0xc000
    buffer_load_dwordx4 v[40:43], v6, s[8:11], s23 offen offset:1024 sc1
    v_mfma_f32_16x16x32_bf16 v[132:135], v[244:247], v[52:55], v[132:135]
    ds_read_b64_tr_b16 v[238:239], v8 offset:1056
    s_waitcnt lgkmcnt(6)
    v_mfma_f32_16x16x32_bf16 v[136:139], v[224:227], v[48:51], v[136:139]
    ds_read_b64_tr_b16 v[240:241], v7 offset:256
    v_mfma_f32_16x16x32_bf16 v[140:143], v[224:227], v[52:55], v[140:143]
    ds_read_b64_tr_b16 v[242:243], v7 offset:1280
    s_mov_b32 s23, 0x2c000
    buffer_load_dwordx4 v[44:47], v6, s[8:11], s23 offen offset:1024 sc1
    s_waitcnt lgkmcnt(6)
    v_mfma_f32_16x16x32_bf16 v[144:147], v[228:231], v[48:51], v[144:147]
    ds_read_b64_tr_b16 v[244:245], v8 offset:288
    v_mfma_f32_16x16x32_bf16 v[148:151], v[228:231], v[52:55], v[148:151]
    ds_read_b64_tr_b16 v[246:247], v8 offset:1312
    s_waitcnt lgkmcnt(6)
    v_mfma_f32_16x16x32_bf16 v[88:91], v[232:235], v[56:59], v[88:91]
    ds_read_b64_tr_b16 v[224:225], v7 offset:512
    v_mfma_f32_16x16x32_bf16 v[92:95], v[232:235], v[60:63], v[92:95]
    s_add_u32 s22, s24, 0x310000
    s_add_u32 m0, s20, 0x18000
    s_nop 0
    buffer_load_dwordx4 v3, s[4:7], s22 offen lds
    ds_read_b64_tr_b16 v[226:227], v7 offset:1536
    s_waitcnt lgkmcnt(6)
    v_mfma_f32_16x16x32_bf16 v[96:99], v[236:239], v[56:59], v[96:99]
    ds_read_b64_tr_b16 v[228:229], v8 offset:544
    v_mfma_f32_16x16x32_bf16 v[100:103], v[236:239], v[60:63], v[100:103]
    ds_read_b64_tr_b16 v[230:231], v8 offset:1568
    s_waitcnt lgkmcnt(6)
    v_mfma_f32_16x16x32_bf16 v[104:107], v[240:243], v[56:59], v[104:107]
    s_add_u32 s22, s24, 0x312000
    s_add_u32 m0, s20, 0x18400
    s_nop 0
    buffer_load_dwordx4 v3, s[4:7], s22 offen lds
    ds_read_b64_tr_b16 v[232:233], v7 offset:768
    v_mfma_f32_16x16x32_bf16 v[108:111], v[240:243], v[60:63], v[108:111]
    ds_read_b64_tr_b16 v[234:235], v7 offset:1792
    s_waitcnt lgkmcnt(6)
    v_mfma_f32_16x16x32_bf16 v[112:115], v[244:247], v[56:59], v[112:115]
    ds_read_b64_tr_b16 v[236:237], v8 offset:800
    v_mfma_f32_16x16x32_bf16 v[116:119], v[244:247], v[60:63], v[116:119]
    ds_read_b64_tr_b16 v[238:239], v8 offset:1824
    s_waitcnt lgkmcnt(6)
    v_mfma_f32_16x16x32_bf16 v[120:123], v[224:227], v[56:59], v[120:123]
    v_mfma_f32_16x16x32_bf16 v[124:127], v[224:227], v[60:63], v[124:127]
    s_waitcnt vmcnt(13)
    s_barrier
    ds_read_b64_tr_b16 v[240:241], v7 offset:16384
    ds_read_b64_tr_b16 v[242:243], v7 offset:17408
    s_waitcnt lgkmcnt(6)
    v_mfma_f32_16x16x32_bf16 v[128:131], v[228:231], v[56:59], v[128:131]
    ds_read_b64_tr_b16 v[244:245], v8 offset:16416
    s_mov_b32 s23, 0xe000
    buffer_load_dwordx4 v[48:51], v6, s[8:11], s23 offen offset:1024 sc1
    v_mfma_f32_16x16x32_bf16 v[132:135], v[228:231], v[60:63], v[132:135]
    ds_read_b64_tr_b16 v[246:247], v8 offset:17440
    s_waitcnt lgkmcnt(6)
    v_mfma_f32_16x16x32_bf16 v[136:139], v[232:235], v[56:59], v[136:139]
    ds_read_b64_tr_b16 v[224:225], v7 offset:16640
    v_mfma_f32_16x16x32_bf16 v[140:143], v[232:235], v[60:63], v[140:143]
    ds_read_b64_tr_b16 v[226:227], v7 offset:17664
    s_mov_b32 s23, 0x2e000
    buffer_load_dwordx4 v[52:55], v6, s[8:11], s23 offen offset:1024 sc1
    s_waitcnt lgkmcnt(6)
    v_mfma_f32_16x16x32_bf16 v[144:147], v[236:239], v[56:59], v[144:147]
    ds_read_b64_tr_b16 v[228:229], v8 offset:16672
    v_mfma_f32_16x16x32_bf16 v[148:151], v[236:239], v[60:63], v[148:151]
    ds_read_b64_tr_b16 v[230:231], v8 offset:17696
    s_waitcnt vmcnt(6)
    v_cmp_ne_u32 vcc, s28, v12
    s_cbranch_vccnz adaLN_cond__sliding_block_cached__moe_arch_mod__prompt_kernel_o219r
adaLN_cond__sliding_block_cached__moe_arch_mod__prompt_kernel_o219b:
    s_waitcnt lgkmcnt(6)
    v_mfma_f32_16x16x32_bf16 v[88:91], v[240:243], v[64:67], v[88:91]
    ds_read_b64_tr_b16 v[232:233], v7 offset:16896
    v_mfma_f32_16x16x32_bf16 v[92:95], v[240:243], v[68:71], v[92:95]
    s_add_u32 s22, s24, 0x390000
    s_add_u32 m0, s20, 0x1c000
    s_nop 0
    buffer_load_dwordx4 v3, s[4:7], s22 offen lds
    ds_read_b64_tr_b16 v[234:235], v7 offset:17920
    s_waitcnt lgkmcnt(6)
    v_mfma_f32_16x16x32_bf16 v[96:99], v[244:247], v[64:67], v[96:99]
    ds_read_b64_tr_b16 v[236:237], v8 offset:16928
    v_mfma_f32_16x16x32_bf16 v[100:103], v[244:247], v[68:71], v[100:103]
    ds_read_b64_tr_b16 v[238:239], v8 offset:17952
    s_waitcnt lgkmcnt(6)
    v_mfma_f32_16x16x32_bf16 v[104:107], v[224:227], v[64:67], v[104:107]
    s_add_u32 s22, s24, 0x392000
    s_add_u32 m0, s20, 0x1c400
    s_nop 0
    buffer_load_dwordx4 v3, s[4:7], s22 offen lds
    ds_read_b64_tr_b16 v[240:241], v7 offset:17152
    v_mfma_f32_16x16x32_bf16 v[108:111], v[224:227], v[68:71], v[108:111]
    ds_read_b64_tr_b16 v[242:243], v7 offset:18176
    s_waitcnt lgkmcnt(6)
    v_mfma_f32_16x16x32_bf16 v[112:115], v[228:231], v[64:67], v[112:115]
    ds_read_b64_tr_b16 v[244:245], v8 offset:17184
    v_mfma_f32_16x16x32_bf16 v[116:119], v[228:231], v[68:71], v[116:119]
    ds_read_b64_tr_b16 v[246:247], v8 offset:18208
    s_waitcnt lgkmcnt(6)
    v_mfma_f32_16x16x32_bf16 v[120:123], v[232:235], v[64:67], v[120:123]
    v_mfma_f32_16x16x32_bf16 v[124:127], v[232:235], v[68:71], v[124:127]
    s_barrier
    ds_read_b64_tr_b16 v[224:225], v4 offset:0
    ds_read_b64_tr_b16 v[226:227], v4 offset:1024
    s_waitcnt lgkmcnt(6)
    v_mfma_f32_16x16x32_bf16 v[128:131], v[236:239], v[64:67], v[128:131]
    ds_read_b64_tr_b16 v[228:229], v5 offset:32
    s_mov_b32 s23, 0x0
    buffer_load_dwordx4 v[56:59], v6, s[8:11], s23 offen offset:2048 sc1
    v_mfma_f32_16x16x32_bf16 v[132:135], v[236:239], v[68:71], v[132:135]
    ds_read_b64_tr_b16 v[230:231], v5 offset:1056
    s_waitcnt lgkmcnt(6)
    v_mfma_f32_16x16x32_bf16 v[136:139], v[240:243], v[64:67], v[136:139]
    ds_read_b64_tr_b16 v[232:233], v4 offset:256
    v_mfma_f32_16x16x32_bf16 v[140:143], v[240:243], v[68:71], v[140:143]
    ds_read_b64_tr_b16 v[234:235], v4 offset:1280
    s_mov_b32 s23, 0x20000
    buffer_load_dwordx4 v[60:63], v6, s[8:11], s23 offen offset:2048 sc1
    s_waitcnt lgkmcnt(6)
    v_mfma_f32_16x16x32_bf16 v[144:147], v[244:247], v[64:67], v[144:147]
    ds_read_b64_tr_b16 v[236:237], v5 offset:288
    v_mfma_f32_16x16x32_bf16 v[148:151], v[244:247], v[68:71], v[148:151]
    ds_read_b64_tr_b16 v[238:239], v5 offset:1312
    s_waitcnt lgkmcnt(6)
    v_mfma_f32_16x16x32_bf16 v[88:91], v[224:227], v[24:27], v[88:91]
    ds_read_b64_tr_b16 v[240:241], v4 offset:512
    v_mfma_f32_16x16x32_bf16 v[92:95], v[224:227], v[28:31], v[92:95]
    s_add_u32 s22, s24, 0x20000
    s_add_u32 m0, s20, 0x20000
    s_nop 0
    buffer_load_dwordx4 v3, s[4:7], s22 offen lds
    ds_read_b64_tr_b16 v[242:243], v4 offset:1536
    s_waitcnt lgkmcnt(6)
    v_mfma_f32_16x16x32_bf16 v[96:99], v[228:231], v[24:27], v[96:99]
    ds_read_b64_tr_b16 v[244:245], v5 offset:544
    v_mfma_f32_16x16x32_bf16 v[100:103], v[228:231], v[28:31], v[100:103]
    ds_read_b64_tr_b16 v[246:247], v5 offset:1568
    s_waitcnt lgkmcnt(6)
    v_mfma_f32_16x16x32_bf16 v[104:107], v[232:235], v[24:27], v[104:107]
    s_add_u32 s22, s24, 0x22000
    s_add_u32 m0, s20, 0x20400
    s_nop 0
    buffer_load_dwordx4 v3, s[4:7], s22 offen lds
    ds_read_b64_tr_b16 v[224:225], v4 offset:768
    v_mfma_f32_16x16x32_bf16 v[108:111], v[232:235], v[28:31], v[108:111]
    ds_read_b64_tr_b16 v[226:227], v4 offset:1792
    s_waitcnt lgkmcnt(6)
    v_mfma_f32_16x16x32_bf16 v[112:115], v[236:239], v[24:27], v[112:115]
    ds_read_b64_tr_b16 v[228:229], v5 offset:800
    v_mfma_f32_16x16x32_bf16 v[116:119], v[236:239], v[28:31], v[116:119]
    ds_read_b64_tr_b16 v[230:231], v5 offset:1824
    s_waitcnt lgkmcnt(6)
    v_mfma_f32_16x16x32_bf16 v[120:123], v[240:243], v[24:27], v[120:123]
    v_mfma_f32_16x16x32_bf16 v[124:127], v[240:243], v[28:31], v[124:127]
    s_barrier
    ds_read_b64_tr_b16 v[232:233], v4 offset:16384
    ds_read_b64_tr_b16 v[234:235], v4 offset:17408
    s_waitcnt lgkmcnt(6)
    v_mfma_f32_16x16x32_bf16 v[128:131], v[244:247], v[24:27], v[128:131]
    ds_read_b64_tr_b16 v[236:237], v5 offset:16416
    s_mov_b32 s23, 0x2000
    buffer_load_dwordx4 v[64:67], v6, s[8:11], s23 offen offset:2048 sc1
    v_mfma_f32_16x16x32_bf16 v[132:135], v[244:247], v[28:31], v[132:135]
    ds_read_b64_tr_b16 v[238:239], v5 offset:17440
    s_waitcnt lgkmcnt(6)
    v_mfma_f32_16x16x32_bf16 v[136:139], v[224:227], v[24:27], v[136:139]
    ds_read_b64_tr_b16 v[240:241], v4 offset:16640
    v_mfma_f32_16x16x32_bf16 v[140:143], v[224:227], v[28:31], v[140:143]
    ds_read_b64_tr_b16 v[242:243], v4 offset:17664
    s_mov_b32 s23, 0x22000
    buffer_load_dwordx4 v[68:71], v6, s[8:11], s23 offen offset:2048 sc1
    s_waitcnt lgkmcnt(6)
    v_mfma_f32_16x16x32_bf16 v[144:147], v[228:231], v[24:27], v[144:147]
    ds_read_b64_tr_b16 v[244:245], v5 offset:16672
    v_mfma_f32_16x16x32_bf16 v[148:151], v[228:231], v[28:31], v[148:151]
    ds_read_b64_tr_b16 v[246:247], v5 offset:17696
    s_waitcnt lgkmcnt(6)
    v_mfma_f32_16x16x32_bf16 v[88:91], v[232:235], v[32:35], v[88:91]
    ds_read_b64_tr_b16 v[224:225], v4 offset:16896
    v_mfma_f32_16x16x32_bf16 v[92:95], v[232:235], v[36:39], v[92:95]
    s_add_u32 s22, s24, 0xa0000
    s_add_u32 m0, s20, 0x24000
    s_nop 0
    buffer_load_dwordx4 v3, s[4:7], s22 offen lds
    ds_read_b64_tr_b16 v[226:227], v4 offset:17920
    s_waitcnt lgkmcnt(6)
    v_mfma_f32_16x16x32_bf16 v[96:99], v[236:239], v[32:35], v[96:99]
    ds_read_b64_tr_b16 v[228:229], v5 offset:16928
    v_mfma_f32_16x16x32_bf16 v[100:103], v[236:239], v[36:39], v[100:103]
    ds_read_b64_tr_b16 v[230:231], v5 offset:17952
    s_waitcnt lgkmcnt(6)
    v_mfma_f32_16x16x32_bf16 v[104:107], v[240:243], v[32:35], v[104:107]
    s_add_u32 s22, s24, 0xa2000
    s_add_u32 m0, s20, 0x24400
    s_nop 0
    buffer_load_dwordx4 v3, s[4:7], s22 offen lds
    ds_read_b64_tr_b16 v[232:233], v4 offset:17152
    v_mfma_f32_16x16x32_bf16 v[108:111], v[240:243], v[36:39], v[108:111]
    ds_read_b64_tr_b16 v[234:235], v4 offset:18176
    s_waitcnt lgkmcnt(6)
    v_mfma_f32_16x16x32_bf16 v[112:115], v[244:247], v[32:35], v[112:115]
    ds_read_b64_tr_b16 v[236:237], v5 offset:17184
    v_mfma_f32_16x16x32_bf16 v[116:119], v[244:247], v[36:39], v[116:119]
    ds_read_b64_tr_b16 v[238:239], v5 offset:18208
    s_waitcnt lgkmcnt(6)
    v_mfma_f32_16x16x32_bf16 v[120:123], v[224:227], v[32:35], v[120:123]
    v_mfma_f32_16x16x32_bf16 v[124:127], v[224:227], v[36:39], v[124:127]
    s_waitcnt vmcnt(12)
    s_barrier
    ds_read_b64_tr_b16 v[240:241], v4 offset:32768
    ds_read_b64_tr_b16 v[242:243], v4 offset:33792
    s_waitcnt lgkmcnt(6)
    v_mfma_f32_16x16x32_bf16 v[128:131], v[228:231], v[32:35], v[128:131]
    ds_read_b64_tr_b16 v[244:245], v5 offset:32800
    s_mov_b32 s23, 0x4000
    buffer_load_dwordx4 v[24:27], v6, s[8:11], s23 offen offset:2048 sc1
    v_mfma_f32_16x16x32_bf16 v[132:135], v[228:231], v[36:39], v[132:135]
    ds_read_b64_tr_b16 v[246:247], v5 offset:33824
    s_waitcnt lgkmcnt(6)
    v_mfma_f32_16x16x32_bf16 v[136:139], v[232:235], v[32:35], v[136:139]
    ds_read_b64_tr_b16 v[224:225], v4 offset:33024
    v_mfma_f32_16x16x32_bf16 v[140:143], v[232:235], v[36:39], v[140:143]
    ds_read_b64_tr_b16 v[226:227], v4 offset:34048
    s_mov_b32 s23, 0x24000
    buffer_load_dwordx4 v[28:31], v6, s[8:11], s23 offen offset:2048 sc1
    s_waitcnt lgkmcnt(6)
    v_mfma_f32_16x16x32_bf16 v[144:147], v[236:239], v[32:35], v[144:147]
    ds_read_b64_tr_b16 v[228:229], v5 offset:33056
    v_mfma_f32_16x16x32_bf16 v[148:151], v[236:239], v[36:39], v[148:151]
    ds_read_b64_tr_b16 v[230:231], v5 offset:34080
    s_waitcnt lgkmcnt(6)
    v_mfma_f32_16x16x32_bf16 v[88:91], v[240:243], v[40:43], v[88:91]
    ds_read_b64_tr_b16 v[232:233], v4 offset:33280
    v_mfma_f32_16x16x32_bf16 v[92:95], v[240:243], v[44:47], v[92:95]
    s_add_u32 s22, s24, 0x120000
    s_add_u32 m0, s20, 0x10000
    s_nop 0
    buffer_load_dwordx4 v3, s[4:7], s22 offen lds
    ds_read_b64_tr_b16 v[234:235], v4 offset:34304
    s_waitcnt lgkmcnt(6)
    v_mfma_f32_16x16x32_bf16 v[96:99], v[244:247], v[40:43], v[96:99]
    ds_read_b64_tr_b16 v[236:237], v5 offset:33312
    v_mfma_f32_16x16x32_bf16 v[100:103], v[244:247], v[44:47], v[100:103]
    ds_read_b64_tr_b16 v[238:239], v5 offset:34336
    s_waitcnt lgkmcnt(6)
    v_mfma_f32_16x16x32_bf16 v[104:107], v[224:227], v[40:43], v[104:107]
    s_add_u32 s22, s24, 0x122000
    s_add_u32 m0, s20, 0x10400
    s_nop 0
    buffer_load_dwordx4 v3, s[4:7], s22 offen lds
    ds_read_b64_tr_b16 v[240:241], v4 offset:33536
    v_mfma_f32_16x16x32_bf16 v[108:111], v[224:227], v[44:47], v[108:111]
    ds_read_b64_tr_b16 v[242:243], v4 offset:34560
    s_waitcnt lgkmcnt(6)
    v_mfma_f32_16x16x32_bf16 v[112:115], v[228:231], v[40:43], v[112:115]
    ds_read_b64_tr_b16 v[244:245], v5 offset:33568
    v_mfma_f32_16x16x32_bf16 v[116:119], v[228:231], v[44:47], v[116:119]
    ds_read_b64_tr_b16 v[246:247], v5 offset:34592
    s_waitcnt lgkmcnt(6)
    v_mfma_f32_16x16x32_bf16 v[120:123], v[232:235], v[40:43], v[120:123]
    v_mfma_f32_16x16x32_bf16 v[124:127], v[232:235], v[44:47], v[124:127]
    s_waitcnt vmcnt(12)
    s_barrier
    ds_read_b64_tr_b16 v[224:225], v4 offset:49152
    ds_read_b64_tr_b16 v[226:227], v4 offset:50176
    s_waitcnt lgkmcnt(6)
    v_mfma_f32_16x16x32_bf16 v[128:131], v[236:239], v[40:43], v[128:131]
    ds_read_b64_tr_b16 v[228:229], v5 offset:49184
    s_mov_b32 s23, 0x6000
    buffer_load_dwordx4 v[32:35], v6, s[8:11], s23 offen offset:2048 sc1
    v_mfma_f32_16x16x32_bf16 v[132:135], v[236:239], v[44:47], v[132:135]
    ds_read_b64_tr_b16 v[230:231], v5 offset:50208
    s_waitcnt lgkmcnt(6)
    v_mfma_f32_16x16x32_bf16 v[136:139], v[240:243], v[40:43], v[136:139]
    ds_read_b64_tr_b16 v[232:233], v4 offset:49408
    v_mfma_f32_16x16x32_bf16 v[140:143], v[240:243], v[44:47], v[140:143]
    ds_read_b64_tr_b16 v[234:235], v4 offset:50432
    s_mov_b32 s23, 0x26000
    buffer_load_dwordx4 v[36:39], v6, s[8:11], s23 offen offset:2048 sc1
    s_waitcnt lgkmcnt(6)
    v_mfma_f32_16x16x32_bf16 v[144:147], v[244:247], v[40:43], v[144:147]
    ds_read_b64_tr_b16 v[236:237], v5 offset:49440
    v_mfma_f32_16x16x32_bf16 v[148:151], v[244:247], v[44:47], v[148:151]
    ds_read_b64_tr_b16 v[238:239], v5 offset:50464
    s_waitcnt lgkmcnt(6)
    v_mfma_f32_16x16x32_bf16 v[88:91], v[224:227], v[48:51], v[88:91]
    ds_read_b64_tr_b16 v[240:241], v4 offset:49664
    v_mfma_f32_16x16x32_bf16 v[92:95], v[224:227], v[52:55], v[92:95]
    s_add_u32 s22, s24, 0x1a0000
    s_add_u32 m0, s20, 0x14000
    s_nop 0
    buffer_load_dwordx4 v3, s[4:7], s22 offen lds
    ds_read_b64_tr_b16 v[242:243], v4 offset:50688
    s_waitcnt lgkmcnt(6)
    v_mfma_f32_16x16x32_bf16 v[96:99], v[228:231], v[48:51], v[96:99]
    ds_read_b64_tr_b16 v[244:245], v5 offset:49696
    v_mfma_f32_16x16x32_bf16 v[100:103], v[228:231], v[52:55], v[100:103]
    ds_read_b64_tr_b16 v[246:247], v5 offset:50720
    s_waitcnt lgkmcnt(6)
    v_mfma_f32_16x16x32_bf16 v[104:107], v[232:235], v[48:51], v[104:107]
    s_add_u32 s22, s24, 0x1a2000
    s_add_u32 m0, s20, 0x14400
    s_nop 0
    buffer_load_dwordx4 v3, s[4:7], s22 offen lds
    ds_read_b64_tr_b16 v[224:225], v4 offset:49920
    v_mfma_f32_16x16x32_bf16 v[108:111], v[232:235], v[52:55], v[108:111]
    ds_read_b64_tr_b16 v[226:227], v4 offset:50944
    s_waitcnt lgkmcnt(6)
    v_mfma_f32_16x16x32_bf16 v[112:115], v[236:239], v[48:51], v[112:115]
    ds_read_b64_tr_b16 v[228:229], v5 offset:49952
    v_mfma_f32_16x16x32_bf16 v[116:119], v[236:239], v[52:55], v[116:119]
    ds_read_b64_tr_b16 v[230:231], v5 offset:50976
    s_waitcnt lgkmcnt(6)
    v_mfma_f32_16x16x32_bf16 v[120:123], v[240:243], v[48:51], v[120:123]
    v_mfma_f32_16x16x32_bf16 v[124:127], v[240:243], v[52:55], v[124:127]
    s_waitcnt vmcnt(12)
    s_barrier
    ds_read_b64_tr_b16 v[232:233], v7 offset:0
    ds_read_b64_tr_b16 v[234:235], v7 offset:1024
    s_waitcnt lgkmcnt(6)
    v_mfma_f32_16x16x32_bf16 v[128:131], v[244:247], v[48:51], v[128:131]
    ds_read_b64_tr_b16 v[236:237], v8 offset:32
    s_mov_b32 s23, 0x8000
    buffer_load_dwordx4 v[40:43], v6, s[8:11], s23 offen offset:2048 sc1
    v_mfma_f32_16x16x32_bf16 v[132:135], v[244:247], v[52:55], v[132:135]
    ds_read_b64_tr_b16 v[238:239], v8 offset:1056
    s_waitcnt lgkmcnt(6)
    v_mfma_f32_16x16x32_bf16 v[136:139], v[224:227], v[48:51], v[136:139]
    ds_read_b64_tr_b16 v[240:241], v7 offset:256
    v_mfma_f32_16x16x32_bf16 v[140:143], v[224:227], v[52:55], v[140:143]
    ds_read_b64_tr_b16 v[242:243], v7 offset:1280
    s_mov_b32 s23, 0x28000
    buffer_load_dwordx4 v[44:47], v6, s[8:11], s23 offen offset:2048 sc1
    s_waitcnt lgkmcnt(6)
    v_mfma_f32_16x16x32_bf16 v[144:147], v[228:231], v[48:51], v[144:147]
    ds_read_b64_tr_b16 v[244:245], v8 offset:288
    v_mfma_f32_16x16x32_bf16 v[148:151], v[228:231], v[52:55], v[148:151]
    ds_read_b64_tr_b16 v[246:247], v8 offset:1312
    s_waitcnt lgkmcnt(6)
    v_mfma_f32_16x16x32_bf16 v[88:91], v[232:235], v[56:59], v[88:91]
    ds_read_b64_tr_b16 v[224:225], v7 offset:512
    v_mfma_f32_16x16x32_bf16 v[92:95], v[232:235], v[60:63], v[92:95]
    s_add_u32 s22, s24, 0x220000
    s_add_u32 m0, s20, 0x18000
    s_nop 0
    buffer_load_dwordx4 v3, s[4:7], s22 offen lds
    ds_read_b64_tr_b16 v[226:227], v7 offset:1536
    s_waitcnt lgkmcnt(6)
    v_mfma_f32_16x16x32_bf16 v[96:99], v[236:239], v[56:59], v[96:99]
    ds_read_b64_tr_b16 v[228:229], v8 offset:544
    v_mfma_f32_16x16x32_bf16 v[100:103], v[236:239], v[60:63], v[100:103]
    ds_read_b64_tr_b16 v[230:231], v8 offset:1568
    s_waitcnt lgkmcnt(6)
    v_mfma_f32_16x16x32_bf16 v[104:107], v[240:243], v[56:59], v[104:107]
    s_add_u32 s22, s24, 0x222000
    s_add_u32 m0, s20, 0x18400
    s_nop 0
    buffer_load_dwordx4 v3, s[4:7], s22 offen lds
    ds_read_b64_tr_b16 v[232:233], v7 offset:768
    v_mfma_f32_16x16x32_bf16 v[108:111], v[240:243], v[60:63], v[108:111]
    ds_read_b64_tr_b16 v[234:235], v7 offset:1792
    s_waitcnt lgkmcnt(6)
    v_mfma_f32_16x16x32_bf16 v[112:115], v[244:247], v[56:59], v[112:115]
    ds_read_b64_tr_b16 v[236:237], v8 offset:800
    v_mfma_f32_16x16x32_bf16 v[116:119], v[244:247], v[60:63], v[116:119]
    ds_read_b64_tr_b16 v[238:239], v8 offset:1824
    s_waitcnt lgkmcnt(6)
    v_mfma_f32_16x16x32_bf16 v[120:123], v[224:227], v[56:59], v[120:123]
    v_mfma_f32_16x16x32_bf16 v[124:127], v[224:227], v[60:63], v[124:127]
    s_waitcnt vmcnt(12)
    s_barrier
    ds_read_b64_tr_b16 v[240:241], v7 offset:16384
    ds_read_b64_tr_b16 v[242:243], v7 offset:17408
    s_waitcnt lgkmcnt(6)
    v_mfma_f32_16x16x32_bf16 v[128:131], v[228:231], v[56:59], v[128:131]
    ds_read_b64_tr_b16 v[244:245], v8 offset:16416
    s_mov_b32 s23, 0xa000
    buffer_load_dwordx4 v[48:51], v6, s[8:11], s23 offen offset:2048 sc1
    v_mfma_f32_16x16x32_bf16 v[132:135], v[228:231], v[60:63], v[132:135]
    ds_read_b64_tr_b16 v[246:247], v8 offset:17440
    s_waitcnt lgkmcnt(6)
    v_mfma_f32_16x16x32_bf16 v[136:139], v[232:235], v[56:59], v[136:139]
    ds_read_b64_tr_b16 v[224:225], v7 offset:16640
    v_mfma_f32_16x16x32_bf16 v[140:143], v[232:235], v[60:63], v[140:143]
    ds_read_b64_tr_b16 v[226:227], v7 offset:17664
    s_mov_b32 s23, 0x2a000
    buffer_load_dwordx4 v[52:55], v6, s[8:11], s23 offen offset:2048 sc1
    s_waitcnt lgkmcnt(6)
    v_mfma_f32_16x16x32_bf16 v[144:147], v[236:239], v[56:59], v[144:147]
    ds_read_b64_tr_b16 v[228:229], v8 offset:16672
    v_mfma_f32_16x16x32_bf16 v[148:151], v[236:239], v[60:63], v[148:151]
    ds_read_b64_tr_b16 v[230:231], v8 offset:17696
    s_waitcnt lgkmcnt(6)
    v_mfma_f32_16x16x32_bf16 v[88:91], v[240:243], v[64:67], v[88:91]
    ds_read_b64_tr_b16 v[232:233], v7 offset:16896
    v_mfma_f32_16x16x32_bf16 v[92:95], v[240:243], v[68:71], v[92:95]
    s_add_u32 s22, s24, 0x2a0000
    s_add_u32 m0, s20, 0x1c000
    s_nop 0
    buffer_load_dwordx4 v3, s[4:7], s22 offen lds
    ds_read_b64_tr_b16 v[234:235], v7 offset:17920
    s_waitcnt lgkmcnt(6)
    v_mfma_f32_16x16x32_bf16 v[96:99], v[244:247], v[64:67], v[96:99]
    ds_read_b64_tr_b16 v[236:237], v8 offset:16928
    v_mfma_f32_16x16x32_bf16 v[100:103], v[244:247], v[68:71], v[100:103]
    ds_read_b64_tr_b16 v[238:239], v8 offset:17952
    s_waitcnt lgkmcnt(6)
    v_mfma_f32_16x16x32_bf16 v[104:107], v[224:227], v[64:67], v[104:107]
    s_add_u32 s22, s24, 0x2a2000
    s_add_u32 m0, s20, 0x1c400
    s_nop 0
    buffer_load_dwordx4 v3, s[4:7], s22 offen lds
    ds_read_b64_tr_b16 v[240:241], v7 offset:17152
    v_mfma_f32_16x16x32_bf16 v[108:111], v[224:227], v[68:71], v[108:111]
    ds_read_b64_tr_b16 v[242:243], v7 offset:18176
    s_waitcnt lgkmcnt(6)
    v_mfma_f32_16x16x32_bf16 v[112:115], v[228:231], v[64:67], v[112:115]
    ds_read_b64_tr_b16 v[244:245], v8 offset:17184
    v_mfma_f32_16x16x32_bf16 v[116:119], v[228:231], v[68:71], v[116:119]
    ds_read_b64_tr_b16 v[246:247], v8 offset:18208
    s_waitcnt lgkmcnt(6)
    v_mfma_f32_16x16x32_bf16 v[120:123], v[232:235], v[64:67], v[120:123]
    v_mfma_f32_16x16x32_bf16 v[124:127], v[232:235], v[68:71], v[124:127]
    s_waitcnt vmcnt(12)
    s_barrier
    ds_read_b64_tr_b16 v[224:225], v4 offset:0
    ds_read_b64_tr_b16 v[226:227], v4 offset:1024
    s_add_u32 s19, s19, 8192
    buffer_load_dword v12, v13, s[8:11], s19 offen sc1
    s_waitcnt lgkmcnt(6)
    v_mfma_f32_16x16x32_bf16 v[128:131], v[236:239], v[64:67], v[128:131]
    ds_read_b64_tr_b16 v[228:229], v5 offset:32
    s_mov_b32 s23, 0xc000
    buffer_load_dwordx4 v[56:59], v6, s[8:11], s23 offen offset:2048 sc1
    v_mfma_f32_16x16x32_bf16 v[132:135], v[236:239], v[68:71], v[132:135]
    ds_read_b64_tr_b16 v[230:231], v5 offset:1056
    s_waitcnt lgkmcnt(6)
    v_mfma_f32_16x16x32_bf16 v[136:139], v[240:243], v[64:67], v[136:139]
    ds_read_b64_tr_b16 v[232:233], v4 offset:256
    v_mfma_f32_16x16x32_bf16 v[140:143], v[240:243], v[68:71], v[140:143]
    ds_read_b64_tr_b16 v[234:235], v4 offset:1280
    s_mov_b32 s23, 0x2c000
    buffer_load_dwordx4 v[60:63], v6, s[8:11], s23 offen offset:2048 sc1
    s_waitcnt lgkmcnt(6)
    v_mfma_f32_16x16x32_bf16 v[144:147], v[244:247], v[64:67], v[144:147]
    ds_read_b64_tr_b16 v[236:237], v5 offset:288
    v_mfma_f32_16x16x32_bf16 v[148:151], v[244:247], v[68:71], v[148:151]
    ds_read_b64_tr_b16 v[238:239], v5 offset:1312
    s_waitcnt lgkmcnt(6)
    v_mfma_f32_16x16x32_bf16 v[88:91], v[224:227], v[24:27], v[88:91]
    ds_read_b64_tr_b16 v[240:241], v4 offset:512
    v_mfma_f32_16x16x32_bf16 v[92:95], v[224:227], v[28:31], v[92:95]
    s_add_u32 s22, s24, 0x320000
    s_add_u32 m0, s20, 0x20000
    s_nop 0
    buffer_load_dwordx4 v3, s[4:7], s22 offen lds
    ds_read_b64_tr_b16 v[242:243], v4 offset:1536
    s_waitcnt lgkmcnt(6)
    v_mfma_f32_16x16x32_bf16 v[96:99], v[228:231], v[24:27], v[96:99]
    ds_read_b64_tr_b16 v[244:245], v5 offset:544
    v_mfma_f32_16x16x32_bf16 v[100:103], v[228:231], v[28:31], v[100:103]
    ds_read_b64_tr_b16 v[246:247], v5 offset:1568
    s_waitcnt lgkmcnt(6)
    v_mfma_f32_16x16x32_bf16 v[104:107], v[232:235], v[24:27], v[104:107]
    s_add_u32 s22, s24, 0x322000
    s_add_u32 m0, s20, 0x20400
    s_nop 0
    buffer_load_dwordx4 v3, s[4:7], s22 offen lds
    ds_read_b64_tr_b16 v[224:225], v4 offset:768
    v_mfma_f32_16x16x32_bf16 v[108:111], v[232:235], v[28:31], v[108:111]
    ds_read_b64_tr_b16 v[226:227], v4 offset:1792
    s_waitcnt lgkmcnt(6)
    v_mfma_f32_16x16x32_bf16 v[112:115], v[236:239], v[24:27], v[112:115]
    ds_read_b64_tr_b16 v[228:229], v5 offset:800
    v_mfma_f32_16x16x32_bf16 v[116:119], v[236:239], v[28:31], v[116:119]
    ds_read_b64_tr_b16 v[230:231], v5 offset:1824
    s_waitcnt lgkmcnt(6)
    v_mfma_f32_16x16x32_bf16 v[120:123], v[240:243], v[24:27], v[120:123]
    v_mfma_f32_16x16x32_bf16 v[124:127], v[240:243], v[28:31], v[124:127]
    s_waitcnt vmcnt(13)
    s_barrier
    ds_read_b64_tr_b16 v[232:233], v4 offset:16384
    ds_read_b64_tr_b16 v[234:235], v4 offset:17408
    s_waitcnt lgkmcnt(6)
    v_mfma_f32_16x16x32_bf16 v[128:131], v[244:247], v[24:27], v[128:131]
    ds_read_b64_tr_b16 v[236:237], v5 offset:16416
    s_mov_b32 s23, 0xe000
    buffer_load_dwordx4 v[64:67], v6, s[8:11], s23 offen offset:2048 sc1
    v_mfma_f32_16x16x32_bf16 v[132:135], v[244:247], v[28:31], v[132:135]
    ds_read_b64_tr_b16 v[238:239], v5 offset:17440
    s_waitcnt lgkmcnt(6)
    v_mfma_f32_16x16x32_bf16 v[136:139], v[224:227], v[24:27], v[136:139]
    ds_read_b64_tr_b16 v[240:241], v4 offset:16640
    v_mfma_f32_16x16x32_bf16 v[140:143], v[224:227], v[28:31], v[140:143]
    ds_read_b64_tr_b16 v[242:243], v4 offset:17664
    s_mov_b32 s23, 0x2e000
    buffer_load_dwordx4 v[68:71], v6, s[8:11], s23 offen offset:2048 sc1
    s_waitcnt lgkmcnt(6)
    v_mfma_f32_16x16x32_bf16 v[144:147], v[228:231], v[24:27], v[144:147]
    ds_read_b64_tr_b16 v[244:245], v5 offset:16672
    v_mfma_f32_16x16x32_bf16 v[148:151], v[228:231], v[28:31], v[148:151]
    ds_read_b64_tr_b16 v[246:247], v5 offset:17696
    s_waitcnt vmcnt(6)
    v_cmp_ne_u32 vcc, s28, v12
    s_cbranch_vccnz adaLN_cond__sliding_block_cached__moe_arch_mod__prompt_kernel_o220r
adaLN_cond__sliding_block_cached__moe_arch_mod__prompt_kernel_o220b:
    s_waitcnt lgkmcnt(6)
    v_mfma_f32_16x16x32_bf16 v[88:91], v[232:235], v[32:35], v[88:91]
    ds_read_b64_tr_b16 v[224:225], v4 offset:16896
    v_mfma_f32_16x16x32_bf16 v[92:95], v[232:235], v[36:39], v[92:95]
    s_add_u32 s22, s24, 0x3a0000
    s_add_u32 m0, s20, 0x24000
    s_nop 0
    buffer_load_dwordx4 v3, s[4:7], s22 offen lds
    ds_read_b64_tr_b16 v[226:227], v4 offset:17920
    s_waitcnt lgkmcnt(6)
    v_mfma_f32_16x16x32_bf16 v[96:99], v[236:239], v[32:35], v[96:99]
    ds_read_b64_tr_b16 v[228:229], v5 offset:16928
    v_mfma_f32_16x16x32_bf16 v[100:103], v[236:239], v[36:39], v[100:103]
    ds_read_b64_tr_b16 v[230:231], v5 offset:17952
    s_waitcnt lgkmcnt(6)
    v_mfma_f32_16x16x32_bf16 v[104:107], v[240:243], v[32:35], v[104:107]
    s_add_u32 s22, s24, 0x3a2000
    s_add_u32 m0, s20, 0x24400
    s_nop 0
    buffer_load_dwordx4 v3, s[4:7], s22 offen lds
    ds_read_b64_tr_b16 v[232:233], v4 offset:17152
    v_mfma_f32_16x16x32_bf16 v[108:111], v[240:243], v[36:39], v[108:111]
    ds_read_b64_tr_b16 v[234:235], v4 offset:18176
    s_waitcnt lgkmcnt(6)
    v_mfma_f32_16x16x32_bf16 v[112:115], v[244:247], v[32:35], v[112:115]
    ds_read_b64_tr_b16 v[236:237], v5 offset:17184
    v_mfma_f32_16x16x32_bf16 v[116:119], v[244:247], v[36:39], v[116:119]
    ds_read_b64_tr_b16 v[238:239], v5 offset:18208
    s_waitcnt lgkmcnt(6)
    v_mfma_f32_16x16x32_bf16 v[120:123], v[224:227], v[32:35], v[120:123]
    v_mfma_f32_16x16x32_bf16 v[124:127], v[224:227], v[36:39], v[124:127]
    s_barrier
    ds_read_b64_tr_b16 v[240:241], v4 offset:32768
    ds_read_b64_tr_b16 v[242:243], v4 offset:33792
    s_waitcnt lgkmcnt(6)
    v_mfma_f32_16x16x32_bf16 v[128:131], v[228:231], v[32:35], v[128:131]
    ds_read_b64_tr_b16 v[244:245], v5 offset:32800
    s_mov_b32 s23, 0x0
    buffer_load_dwordx4 v[24:27], v6, s[8:11], s23 offen offset:3072 sc1
    v_mfma_f32_16x16x32_bf16 v[132:135], v[228:231], v[36:39], v[132:135]
    ds_read_b64_tr_b16 v[246:247], v5 offset:33824
    s_waitcnt lgkmcnt(6)
    v_mfma_f32_16x16x32_bf16 v[136:139], v[232:235], v[32:35], v[136:139]
    ds_read_b64_tr_b16 v[224:225], v4 offset:33024
    v_mfma_f32_16x16x32_bf16 v[140:143], v[232:235], v[36:39], v[140:143]
    ds_read_b64_tr_b16 v[226:227], v4 offset:34048
    s_mov_b32 s23, 0x20000
    buffer_load_dwordx4 v[28:31], v6, s[8:11], s23 offen offset:3072 sc1
    s_waitcnt lgkmcnt(6)
    v_mfma_f32_16x16x32_bf16 v[144:147], v[236:239], v[32:35], v[144:147]
    ds_read_b64_tr_b16 v[228:229], v5 offset:33056
    v_mfma_f32_16x16x32_bf16 v[148:151], v[236:239], v[36:39], v[148:151]
    ds_read_b64_tr_b16 v[230:231], v5 offset:34080
    s_waitcnt lgkmcnt(6)
    v_mfma_f32_16x16x32_bf16 v[88:91], v[240:243], v[40:43], v[88:91]
    ds_read_b64_tr_b16 v[232:233], v4 offset:33280
    v_mfma_f32_16x16x32_bf16 v[92:95], v[240:243], v[44:47], v[92:95]
    s_add_u32 s22, s24, 0x30000
    s_add_u32 m0, s20, 0x10000
    s_nop 0
    buffer_load_dwordx4 v3, s[4:7], s22 offen lds
    ds_read_b64_tr_b16 v[234:235], v4 offset:34304
    s_waitcnt lgkmcnt(6)
    v_mfma_f32_16x16x32_bf16 v[96:99], v[244:247], v[40:43], v[96:99]
    ds_read_b64_tr_b16 v[236:237], v5 offset:33312
    v_mfma_f32_16x16x32_bf16 v[100:103], v[244:247], v[44:47], v[100:103]
    ds_read_b64_tr_b16 v[238:239], v5 offset:34336
    s_waitcnt lgkmcnt(6)
    v_mfma_f32_16x16x32_bf16 v[104:107], v[224:227], v[40:43], v[104:107]
    s_add_u32 s22, s24, 0x32000
    s_add_u32 m0, s20, 0x10400
    s_nop 0
    buffer_load_dwordx4 v3, s[4:7], s22 offen lds
    ds_read_b64_tr_b16 v[240:241], v4 offset:33536
    v_mfma_f32_16x16x32_bf16 v[108:111], v[224:227], v[44:47], v[108:111]
    ds_read_b64_tr_b16 v[242:243], v4 offset:34560
    s_waitcnt lgkmcnt(6)
    v_mfma_f32_16x16x32_bf16 v[112:115], v[228:231], v[40:43], v[112:115]
    ds_read_b64_tr_b16 v[244:245], v5 offset:33568
    v_mfma_f32_16x16x32_bf16 v[116:119], v[228:231], v[44:47], v[116:119]
    ds_read_b64_tr_b16 v[246:247], v5 offset:34592
    s_waitcnt lgkmcnt(6)
    v_mfma_f32_16x16x32_bf16 v[120:123], v[232:235], v[40:43], v[120:123]
    v_mfma_f32_16x16x32_bf16 v[124:127], v[232:235], v[44:47], v[124:127]
    s_barrier
    ds_read_b64_tr_b16 v[224:225], v4 offset:49152
    ds_read_b64_tr_b16 v[226:227], v4 offset:50176
    s_waitcnt lgkmcnt(6)
    v_mfma_f32_16x16x32_bf16 v[128:131], v[236:239], v[40:43], v[128:131]
    ds_read_b64_tr_b16 v[228:229], v5 offset:49184
    s_mov_b32 s23, 0x2000
    buffer_load_dwordx4 v[32:35], v6, s[8:11], s23 offen offset:3072 sc1
    v_mfma_f32_16x16x32_bf16 v[132:135], v[236:239], v[44:47], v[132:135]
    ds_read_b64_tr_b16 v[230:231], v5 offset:50208
    s_waitcnt lgkmcnt(6)
    v_mfma_f32_16x16x32_bf16 v[136:139], v[240:243], v[40:43], v[136:139]
    ds_read_b64_tr_b16 v[232:233], v4 offset:49408
    v_mfma_f32_16x16x32_bf16 v[140:143], v[240:243], v[44:47], v[140:143]
    ds_read_b64_tr_b16 v[234:235], v4 offset:50432
    s_mov_b32 s23, 0x22000
    buffer_load_dwordx4 v[36:39], v6, s[8:11], s23 offen offset:3072 sc1
    s_waitcnt lgkmcnt(6)
    v_mfma_f32_16x16x32_bf16 v[144:147], v[244:247], v[40:43], v[144:147]
    ds_read_b64_tr_b16 v[236:237], v5 offset:49440
    v_mfma_f32_16x16x32_bf16 v[148:151], v[244:247], v[44:47], v[148:151]
    ds_read_b64_tr_b16 v[238:239], v5 offset:50464
    s_waitcnt lgkmcnt(6)
    v_mfma_f32_16x16x32_bf16 v[88:91], v[224:227], v[48:51], v[88:91]
    ds_read_b64_tr_b16 v[240:241], v4 offset:49664
    v_mfma_f32_16x16x32_bf16 v[92:95], v[224:227], v[52:55], v[92:95]
    s_add_u32 s22, s24, 0xb0000
    s_add_u32 m0, s20, 0x14000
    s_nop 0
    buffer_load_dwordx4 v3, s[4:7], s22 offen lds
    ds_read_b64_tr_b16 v[242:243], v4 offset:50688
    s_waitcnt lgkmcnt(6)
    v_mfma_f32_16x16x32_bf16 v[96:99], v[228:231], v[48:51], v[96:99]
    ds_read_b64_tr_b16 v[244:245], v5 offset:49696
    v_mfma_f32_16x16x32_bf16 v[100:103], v[228:231], v[52:55], v[100:103]
    ds_read_b64_tr_b16 v[246:247], v5 offset:50720
    s_waitcnt lgkmcnt(6)
    v_mfma_f32_16x16x32_bf16 v[104:107], v[232:235], v[48:51], v[104:107]
    s_add_u32 s22, s24, 0xb2000
    s_add_u32 m0, s20, 0x14400
    s_nop 0
    buffer_load_dwordx4 v3, s[4:7], s22 offen lds
    ds_read_b64_tr_b16 v[224:225], v4 offset:49920
    v_mfma_f32_16x16x32_bf16 v[108:111], v[232:235], v[52:55], v[108:111]
    ds_read_b64_tr_b16 v[226:227], v4 offset:50944
    s_waitcnt lgkmcnt(6)
    v_mfma_f32_16x16x32_bf16 v[112:115], v[236:239], v[48:51], v[112:115]
    ds_read_b64_tr_b16 v[228:229], v5 offset:49952
    v_mfma_f32_16x16x32_bf16 v[116:119], v[236:239], v[52:55], v[116:119]
    ds_read_b64_tr_b16 v[230:231], v5 offset:50976
    s_waitcnt lgkmcnt(6)
    v_mfma_f32_16x16x32_bf16 v[120:123], v[240:243], v[48:51], v[120:123]
    v_mfma_f32_16x16x32_bf16 v[124:127], v[240:243], v[52:55], v[124:127]
    s_waitcnt vmcnt(12)
    s_barrier
    ds_read_b64_tr_b16 v[232:233], v7 offset:0
    ds_read_b64_tr_b16 v[234:235], v7 offset:1024
    s_waitcnt lgkmcnt(6)
    v_mfma_f32_16x16x32_bf16 v[128:131], v[244:247], v[48:51], v[128:131]
    ds_read_b64_tr_b16 v[236:237], v8 offset:32
    s_mov_b32 s23, 0x4000
    buffer_load_dwordx4 v[40:43], v6, s[8:11], s23 offen offset:3072 sc1
    v_mfma_f32_16x16x32_bf16 v[132:135], v[244:247], v[52:55], v[132:135]
    ds_read_b64_tr_b16 v[238:239], v8 offset:1056
    s_waitcnt lgkmcnt(6)
    v_mfma_f32_16x16x32_bf16 v[136:139], v[224:227], v[48:51], v[136:139]
    ds_read_b64_tr_b16 v[240:241], v7 offset:256
    v_mfma_f32_16x16x32_bf16 v[140:143], v[224:227], v[52:55], v[140:143]
    ds_read_b64_tr_b16 v[242:243], v7 offset:1280
    s_mov_b32 s23, 0x24000
    buffer_load_dwordx4 v[44:47], v6, s[8:11], s23 offen offset:3072 sc1
    s_waitcnt lgkmcnt(6)
    v_mfma_f32_16x16x32_bf16 v[144:147], v[228:231], v[48:51], v[144:147]
    ds_read_b64_tr_b16 v[244:245], v8 offset:288
    v_mfma_f32_16x16x32_bf16 v[148:151], v[228:231], v[52:55], v[148:151]
    ds_read_b64_tr_b16 v[246:247], v8 offset:1312
    s_waitcnt lgkmcnt(6)
    v_mfma_f32_16x16x32_bf16 v[88:91], v[232:235], v[56:59], v[88:91]
    ds_read_b64_tr_b16 v[224:225], v7 offset:512
    v_mfma_f32_16x16x32_bf16 v[92:95], v[232:235], v[60:63], v[92:95]
    s_add_u32 s22, s24, 0x130000
    s_add_u32 m0, s20, 0x18000
    s_nop 0
    buffer_load_dwordx4 v3, s[4:7], s22 offen lds
    ds_read_b64_tr_b16 v[226:227], v7 offset:1536
    s_waitcnt lgkmcnt(6)
    v_mfma_f32_16x16x32_bf16 v[96:99], v[236:239], v[56:59], v[96:99]
    ds_read_b64_tr_b16 v[228:229], v8 offset:544
    v_mfma_f32_16x16x32_bf16 v[100:103], v[236:239], v[60:63], v[100:103]
    ds_read_b64_tr_b16 v[230:231], v8 offset:1568
    s_waitcnt lgkmcnt(6)
    v_mfma_f32_16x16x32_bf16 v[104:107], v[240:243], v[56:59], v[104:107]
    s_add_u32 s22, s24, 0x132000
    s_add_u32 m0, s20, 0x18400
    s_nop 0
    buffer_load_dwordx4 v3, s[4:7], s22 offen lds
    ds_read_b64_tr_b16 v[232:233], v7 offset:768
    v_mfma_f32_16x16x32_bf16 v[108:111], v[240:243], v[60:63], v[108:111]
    ds_read_b64_tr_b16 v[234:235], v7 offset:1792
    s_waitcnt lgkmcnt(6)
    v_mfma_f32_16x16x32_bf16 v[112:115], v[244:247], v[56:59], v[112:115]
    ds_read_b64_tr_b16 v[236:237], v8 offset:800
    v_mfma_f32_16x16x32_bf16 v[116:119], v[244:247], v[60:63], v[116:119]
    ds_read_b64_tr_b16 v[238:239], v8 offset:1824
    s_waitcnt lgkmcnt(6)
    v_mfma_f32_16x16x32_bf16 v[120:123], v[224:227], v[56:59], v[120:123]
    v_mfma_f32_16x16x32_bf16 v[124:127], v[224:227], v[60:63], v[124:127]
    s_waitcnt vmcnt(12)
    s_barrier
    ds_read_b64_tr_b16 v[240:241], v7 offset:16384
    ds_read_b64_tr_b16 v[242:243], v7 offset:17408
    s_waitcnt lgkmcnt(6)
    v_mfma_f32_16x16x32_bf16 v[128:131], v[228:231], v[56:59], v[128:131]
    ds_read_b64_tr_b16 v[244:245], v8 offset:16416
    s_mov_b32 s23, 0x6000
    buffer_load_dwordx4 v[48:51], v6, s[8:11], s23 offen offset:3072 sc1
    v_mfma_f32_16x16x32_bf16 v[132:135], v[228:231], v[60:63], v[132:135]
    ds_read_b64_tr_b16 v[246:247], v8 offset:17440
    s_waitcnt lgkmcnt(6)
    v_mfma_f32_16x16x32_bf16 v[136:139], v[232:235], v[56:59], v[136:139]
    ds_read_b64_tr_b16 v[224:225], v7 offset:16640
    v_mfma_f32_16x16x32_bf16 v[140:143], v[232:235], v[60:63], v[140:143]
    ds_read_b64_tr_b16 v[226:227], v7 offset:17664
    s_mov_b32 s23, 0x26000
    buffer_load_dwordx4 v[52:55], v6, s[8:11], s23 offen offset:3072 sc1
    s_waitcnt lgkmcnt(6)
    v_mfma_f32_16x16x32_bf16 v[144:147], v[236:239], v[56:59], v[144:147]
    ds_read_b64_tr_b16 v[228:229], v8 offset:16672
    v_mfma_f32_16x16x32_bf16 v[148:151], v[236:239], v[60:63], v[148:151]
    ds_read_b64_tr_b16 v[230:231], v8 offset:17696
    s_waitcnt lgkmcnt(6)
    v_mfma_f32_16x16x32_bf16 v[88:91], v[240:243], v[64:67], v[88:91]
    ds_read_b64_tr_b16 v[232:233], v7 offset:16896
    v_mfma_f32_16x16x32_bf16 v[92:95], v[240:243], v[68:71], v[92:95]
    s_add_u32 s22, s24, 0x1b0000
    s_add_u32 m0, s20, 0x1c000
    s_nop 0
    buffer_load_dwordx4 v3, s[4:7], s22 offen lds
    ds_read_b64_tr_b16 v[234:235], v7 offset:17920
    s_waitcnt lgkmcnt(6)
    v_mfma_f32_16x16x32_bf16 v[96:99], v[244:247], v[64:67], v[96:99]
    ds_read_b64_tr_b16 v[236:237], v8 offset:16928
    v_mfma_f32_16x16x32_bf16 v[100:103], v[244:247], v[68:71], v[100:103]
    ds_read_b64_tr_b16 v[238:239], v8 offset:17952
    s_waitcnt lgkmcnt(6)
    v_mfma_f32_16x16x32_bf16 v[104:107], v[224:227], v[64:67], v[104:107]
    s_add_u32 s22, s24, 0x1b2000
    s_add_u32 m0, s20, 0x1c400
    s_nop 0
    buffer_load_dwordx4 v3, s[4:7], s22 offen lds
    ds_read_b64_tr_b16 v[240:241], v7 offset:17152
    v_mfma_f32_16x16x32_bf16 v[108:111], v[224:227], v[68:71], v[108:111]
    ds_read_b64_tr_b16 v[242:243], v7 offset:18176
    s_waitcnt lgkmcnt(6)
    v_mfma_f32_16x16x32_bf16 v[112:115], v[228:231], v[64:67], v[112:115]
    ds_read_b64_tr_b16 v[244:245], v8 offset:17184
    v_mfma_f32_16x16x32_bf16 v[116:119], v[228:231], v[68:71], v[116:119]
    ds_read_b64_tr_b16 v[246:247], v8 offset:18208
    s_waitcnt lgkmcnt(6)
    v_mfma_f32_16x16x32_bf16 v[120:123], v[232:235], v[64:67], v[120:123]
    v_mfma_f32_16x16x32_bf16 v[124:127], v[232:235], v[68:71], v[124:127]
    s_waitcnt vmcnt(12)
    s_barrier
    ds_read_b64_tr_b16 v[224:225], v4 offset:0
    ds_read_b64_tr_b16 v[226:227], v4 offset:1024
    s_waitcnt lgkmcnt(6)
    v_mfma_f32_16x16x32_bf16 v[128:131], v[236:239], v[64:67], v[128:131]
    ds_read_b64_tr_b16 v[228:229], v5 offset:32
    s_mov_b32 s23, 0x8000
    buffer_load_dwordx4 v[56:59], v6, s[8:11], s23 offen offset:3072 sc1
    v_mfma_f32_16x16x32_bf16 v[132:135], v[236:239], v[68:71], v[132:135]
    ds_read_b64_tr_b16 v[230:231], v5 offset:1056
    s_waitcnt lgkmcnt(6)
    v_mfma_f32_16x16x32_bf16 v[136:139], v[240:243], v[64:67], v[136:139]
    ds_read_b64_tr_b16 v[232:233], v4 offset:256
    v_mfma_f32_16x16x32_bf16 v[140:143], v[240:243], v[68:71], v[140:143]
    ds_read_b64_tr_b16 v[234:235], v4 offset:1280
    s_mov_b32 s23, 0x28000
    buffer_load_dwordx4 v[60:63], v6, s[8:11], s23 offen offset:3072 sc1
    s_waitcnt lgkmcnt(6)
    v_mfma_f32_16x16x32_bf16 v[144:147], v[244:247], v[64:67], v[144:147]
    ds_read_b64_tr_b16 v[236:237], v5 offset:288
    v_mfma_f32_16x16x32_bf16 v[148:151], v[244:247], v[68:71], v[148:151]
    ds_read_b64_tr_b16 v[238:239], v5 offset:1312
    s_waitcnt lgkmcnt(6)
    v_mfma_f32_16x16x32_bf16 v[88:91], v[224:227], v[24:27], v[88:91]
    ds_read_b64_tr_b16 v[240:241], v4 offset:512
    v_mfma_f32_16x16x32_bf16 v[92:95], v[224:227], v[28:31], v[92:95]
    s_add_u32 s22, s24, 0x230000
    s_add_u32 m0, s20, 0x20000
    s_nop 0
    buffer_load_dwordx4 v3, s[4:7], s22 offen lds
    ds_read_b64_tr_b16 v[242:243], v4 offset:1536
    s_waitcnt lgkmcnt(6)
    v_mfma_f32_16x16x32_bf16 v[96:99], v[228:231], v[24:27], v[96:99]
    ds_read_b64_tr_b16 v[244:245], v5 offset:544
    v_mfma_f32_16x16x32_bf16 v[100:103], v[228:231], v[28:31], v[100:103]
    ds_read_b64_tr_b16 v[246:247], v5 offset:1568
    s_waitcnt lgkmcnt(6)
    v_mfma_f32_16x16x32_bf16 v[104:107], v[232:235], v[24:27], v[104:107]
    s_add_u32 s22, s24, 0x232000
    s_add_u32 m0, s20, 0x20400
    s_nop 0
    buffer_load_dwordx4 v3, s[4:7], s22 offen lds
    ds_read_b64_tr_b16 v[224:225], v4 offset:768
    v_mfma_f32_16x16x32_bf16 v[108:111], v[232:235], v[28:31], v[108:111]
    ds_read_b64_tr_b16 v[226:227], v4 offset:1792
    s_waitcnt lgkmcnt(6)
    v_mfma_f32_16x16x32_bf16 v[112:115], v[236:239], v[24:27], v[112:115]
    ds_read_b64_tr_b16 v[228:229], v5 offset:800
    v_mfma_f32_16x16x32_bf16 v[116:119], v[236:239], v[28:31], v[116:119]
    ds_read_b64_tr_b16 v[230:231], v5 offset:1824
    s_waitcnt lgkmcnt(6)
    v_mfma_f32_16x16x32_bf16 v[120:123], v[240:243], v[24:27], v[120:123]
    v_mfma_f32_16x16x32_bf16 v[124:127], v[240:243], v[28:31], v[124:127]
    s_waitcnt vmcnt(12)
    s_barrier
    ds_read_b64_tr_b16 v[232:233], v4 offset:16384
    ds_read_b64_tr_b16 v[234:235], v4 offset:17408
    s_waitcnt lgkmcnt(6)
    v_mfma_f32_16x16x32_bf16 v[128:131], v[244:247], v[24:27], v[128:131]
    ds_read_b64_tr_b16 v[236:237], v5 offset:16416
    s_mov_b32 s23, 0xa000
    buffer_load_dwordx4 v[64:67], v6, s[8:11], s23 offen offset:3072 sc1
    v_mfma_f32_16x16x32_bf16 v[132:135], v[244:247], v[28:31], v[132:135]
    ds_read_b64_tr_b16 v[238:239], v5 offset:17440
    s_waitcnt lgkmcnt(6)
    v_mfma_f32_16x16x32_bf16 v[136:139], v[224:227], v[24:27], v[136:139]
    ds_read_b64_tr_b16 v[240:241], v4 offset:16640
    v_mfma_f32_16x16x32_bf16 v[140:143], v[224:227], v[28:31], v[140:143]
    ds_read_b64_tr_b16 v[242:243], v4 offset:17664
    s_mov_b32 s23, 0x2a000
    buffer_load_dwordx4 v[68:71], v6, s[8:11], s23 offen offset:3072 sc1
    s_waitcnt lgkmcnt(6)
    v_mfma_f32_16x16x32_bf16 v[144:147], v[228:231], v[24:27], v[144:147]
    ds_read_b64_tr_b16 v[244:245], v5 offset:16672
    v_mfma_f32_16x16x32_bf16 v[148:151], v[228:231], v[28:31], v[148:151]
    ds_read_b64_tr_b16 v[246:247], v5 offset:17696
    s_waitcnt lgkmcnt(6)
    v_mfma_f32_16x16x32_bf16 v[88:91], v[232:235], v[32:35], v[88:91]
    ds_read_b64_tr_b16 v[224:225], v4 offset:16896
    v_mfma_f32_16x16x32_bf16 v[92:95], v[232:235], v[36:39], v[92:95]
    s_add_u32 s22, s24, 0x2b0000
    s_add_u32 m0, s20, 0x24000
    s_nop 0
    buffer_load_dwordx4 v3, s[4:7], s22 offen lds
    ds_read_b64_tr_b16 v[226:227], v4 offset:17920
    s_waitcnt lgkmcnt(6)
    v_mfma_f32_16x16x32_bf16 v[96:99], v[236:239], v[32:35], v[96:99]
    ds_read_b64_tr_b16 v[228:229], v5 offset:16928
    v_mfma_f32_16x16x32_bf16 v[100:103], v[236:239], v[36:39], v[100:103]
    ds_read_b64_tr_b16 v[230:231], v5 offset:17952
    s_waitcnt lgkmcnt(6)
    v_mfma_f32_16x16x32_bf16 v[104:107], v[240:243], v[32:35], v[104:107]
    s_add_u32 s22, s24, 0x2b2000
    s_add_u32 m0, s20, 0x24400
    s_nop 0
    buffer_load_dwordx4 v3, s[4:7], s22 offen lds
    ds_read_b64_tr_b16 v[232:233], v4 offset:17152
    v_mfma_f32_16x16x32_bf16 v[108:111], v[240:243], v[36:39], v[108:111]
    ds_read_b64_tr_b16 v[234:235], v4 offset:18176
    s_mov_b32 s16, 0x544000
    buffer_load_dwordx4 v[184:187], v2, s[8:11], s16 offen sc1
    s_waitcnt lgkmcnt(6)
    v_mfma_f32_16x16x32_bf16 v[112:115], v[244:247], v[32:35], v[112:115]
    ds_read_b64_tr_b16 v[236:237], v5 offset:17184
    v_mfma_f32_16x16x32_bf16 v[116:119], v[244:247], v[36:39], v[116:119]
    ds_read_b64_tr_b16 v[238:239], v5 offset:18208
    s_waitcnt lgkmcnt(6)
    v_mfma_f32_16x16x32_bf16 v[120:123], v[224:227], v[32:35], v[120:123]
    v_mfma_f32_16x16x32_bf16 v[124:127], v[224:227], v[36:39], v[124:127]
    s_waitcnt vmcnt(13)
    s_barrier
    ds_read_b64_tr_b16 v[240:241], v4 offset:32768
    ds_read_b64_tr_b16 v[242:243], v4 offset:33792
    s_waitcnt lgkmcnt(6)
    v_mfma_f32_16x16x32_bf16 v[128:131], v[228:231], v[32:35], v[128:131]
    ds_read_b64_tr_b16 v[244:245], v5 offset:32800
    s_mov_b32 s23, 0xc000
    buffer_load_dwordx4 v[24:27], v6, s[8:11], s23 offen offset:3072 sc1
    v_mfma_f32_16x16x32_bf16 v[132:135], v[228:231], v[36:39], v[132:135]
    ds_read_b64_tr_b16 v[246:247], v5 offset:33824
    s_waitcnt lgkmcnt(6)
    v_mfma_f32_16x16x32_bf16 v[136:139], v[232:235], v[32:35], v[136:139]
    ds_read_b64_tr_b16 v[224:225], v4 offset:33024
    v_mfma_f32_16x16x32_bf16 v[140:143], v[232:235], v[36:39], v[140:143]
    ds_read_b64_tr_b16 v[226:227], v4 offset:34048
    s_mov_b32 s23, 0x2c000
    buffer_load_dwordx4 v[28:31], v6, s[8:11], s23 offen offset:3072 sc1
    s_waitcnt lgkmcnt(6)
    v_mfma_f32_16x16x32_bf16 v[144:147], v[236:239], v[32:35], v[144:147]
    ds_read_b64_tr_b16 v[228:229], v5 offset:33056
    v_mfma_f32_16x16x32_bf16 v[148:151], v[236:239], v[36:39], v[148:151]
    ds_read_b64_tr_b16 v[230:231], v5 offset:34080
    s_waitcnt lgkmcnt(6)
    v_mfma_f32_16x16x32_bf16 v[88:91], v[240:243], v[40:43], v[88:91]
    ds_read_b64_tr_b16 v[232:233], v4 offset:33280
    v_mfma_f32_16x16x32_bf16 v[92:95], v[240:243], v[44:47], v[92:95]
    s_add_u32 s22, s24, 0x330000
    s_add_u32 m0, s20, 0x10000
    s_nop 0
    buffer_load_dwordx4 v3, s[4:7], s22 offen lds
    ds_read_b64_tr_b16 v[234:235], v4 offset:34304
    s_waitcnt lgkmcnt(6)
    v_mfma_f32_16x16x32_bf16 v[96:99], v[244:247], v[40:43], v[96:99]
    ds_read_b64_tr_b16 v[236:237], v5 offset:33312
    v_mfma_f32_16x16x32_bf16 v[100:103], v[244:247], v[44:47], v[100:103]
    ds_read_b64_tr_b16 v[238:239], v5 offset:34336
    s_waitcnt lgkmcnt(6)
    v_mfma_f32_16x16x32_bf16 v[104:107], v[224:227], v[40:43], v[104:107]
    s_add_u32 s22, s24, 0x332000
    s_add_u32 m0, s20, 0x10400
    s_nop 0
    buffer_load_dwordx4 v3, s[4:7], s22 offen lds
    ds_read_b64_tr_b16 v[240:241], v4 offset:33536
    v_mfma_f32_16x16x32_bf16 v[108:111], v[224:227], v[44:47], v[108:111]
    ds_read_b64_tr_b16 v[242:243], v4 offset:34560
    s_waitcnt vmcnt(4)
    v_xor_b32 v16, s28, v184
    v_xor_b32 v17, s28, v185
    v_xor_b32 v18, s28, v186
    v_xor_b32 v19, s28, v187
    v_or3_b32 v16, v16, v17, v18
    v_or_b32 v16, v16, v19
    v_cmp_ne_u32 vcc, 0, v16
    s_cbranch_vccnz adaLN_cond__sliding_block_cached__moe_arch_mod__prompt_kernel_mf21r
adaLN_cond__sliding_block_cached__moe_arch_mod__prompt_kernel_mf21b:
    s_waitcnt lgkmcnt(6)
    v_mfma_f32_16x16x32_bf16 v[112:115], v[228:231], v[40:43], v[112:115]
    ds_read_b64_tr_b16 v[244:245], v5 offset:33568
    v_mfma_f32_16x16x32_bf16 v[116:119], v[228:231], v[44:47], v[116:119]
    ds_read_b64_tr_b16 v[246:247], v5 offset:34592
    s_waitcnt lgkmcnt(6)
    v_mfma_f32_16x16x32_bf16 v[120:123], v[232:235], v[40:43], v[120:123]
    v_mfma_f32_16x16x32_bf16 v[124:127], v[232:235], v[44:47], v[124:127]
    s_barrier
    ds_read_b64_tr_b16 v[224:225], v4 offset:49152
    ds_read_b64_tr_b16 v[226:227], v4 offset:50176
    s_waitcnt lgkmcnt(6)
    v_mfma_f32_16x16x32_bf16 v[128:131], v[236:239], v[40:43], v[128:131]
    ds_read_b64_tr_b16 v[228:229], v5 offset:49184
    s_mov_b32 s23, 0xe000
    buffer_load_dwordx4 v[32:35], v6, s[8:11], s23 offen offset:3072 sc1
    v_mfma_f32_16x16x32_bf16 v[132:135], v[236:239], v[44:47], v[132:135]
    ds_read_b64_tr_b16 v[230:231], v5 offset:50208
    s_waitcnt lgkmcnt(6)
    v_mfma_f32_16x16x32_bf16 v[136:139], v[240:243], v[40:43], v[136:139]
    ds_read_b64_tr_b16 v[232:233], v4 offset:49408
    v_mfma_f32_16x16x32_bf16 v[140:143], v[240:243], v[44:47], v[140:143]
    ds_read_b64_tr_b16 v[234:235], v4 offset:50432
    s_mov_b32 s23, 0x2e000
    buffer_load_dwordx4 v[36:39], v6, s[8:11], s23 offen offset:3072 sc1
    s_waitcnt lgkmcnt(6)
    v_mfma_f32_16x16x32_bf16 v[144:147], v[244:247], v[40:43], v[144:147]
    ds_read_b64_tr_b16 v[236:237], v5 offset:49440
    v_mfma_f32_16x16x32_bf16 v[148:151], v[244:247], v[44:47], v[148:151]
    ds_read_b64_tr_b16 v[238:239], v5 offset:50464
    s_waitcnt lgkmcnt(6)
    v_mfma_f32_16x16x32_bf16 v[88:91], v[224:227], v[48:51], v[88:91]
    ds_read_b64_tr_b16 v[240:241], v4 offset:49664
    v_mfma_f32_16x16x32_bf16 v[92:95], v[224:227], v[52:55], v[92:95]
    s_add_u32 s22, s24, 0x3b0000
    s_add_u32 m0, s20, 0x14000
    s_nop 0
    buffer_load_dwordx4 v3, s[4:7], s22 offen lds
    ds_read_b64_tr_b16 v[242:243], v4 offset:50688
    s_waitcnt lgkmcnt(6)
    v_mfma_f32_16x16x32_bf16 v[96:99], v[228:231], v[48:51], v[96:99]
    ds_read_b64_tr_b16 v[244:245], v5 offset:49696
    v_mfma_f32_16x16x32_bf16 v[100:103], v[228:231], v[52:55], v[100:103]
    ds_read_b64_tr_b16 v[246:247], v5 offset:50720
    s_waitcnt lgkmcnt(6)
    v_mfma_f32_16x16x32_bf16 v[104:107], v[232:235], v[48:51], v[104:107]
    s_add_u32 s22, s24, 0x3b2000
    s_add_u32 m0, s20, 0x14400
    s_nop 0
    buffer_load_dwordx4 v3, s[4:7], s22 offen lds
    ds_read_b64_tr_b16 v[224:225], v4 offset:49920
    v_mfma_f32_16x16x32_bf16 v[108:111], v[232:235], v[52:55], v[108:111]
    ds_read_b64_tr_b16 v[226:227], v4 offset:50944
    v_lshrrev_b32 v16, 4, v1
    v_lshlrev_b32 v16, 3, v16
    s_lshl_b32 s16, s31, 8
    s_add_u32 s16, s16, 0x540080
    buffer_load_dwordx2 v[248:249], v16, s[8:11], s16 offen offset:0 sc1
    buffer_load_dwordx2 v[250:251], v16, s[8:11], s16 offen offset:32 sc1
    buffer_load_dwordx2 v[252:253], v16, s[8:11], s16 offen offset:64 sc1
    buffer_load_dwordx2 v[254:255], v16, s[8:11], s16 offen offset:96 sc1
    s_waitcnt lgkmcnt(6)
    v_mfma_f32_16x16x32_bf16 v[112:115], v[236:239], v[48:51], v[112:115]
    ds_read_b64_tr_b16 v[228:229], v5 offset:49952
    v_mfma_f32_16x16x32_bf16 v[116:119], v[236:239], v[52:55], v[116:119]
    ds_read_b64_tr_b16 v[230:231], v5 offset:50976
    s_waitcnt lgkmcnt(6)
    v_mfma_f32_16x16x32_bf16 v[120:123], v[240:243], v[48:51], v[120:123]
    v_mfma_f32_16x16x32_bf16 v[124:127], v[240:243], v[52:55], v[124:127]
    s_barrier
    ds_read_b64_tr_b16 v[232:233], v7 offset:0
    ds_read_b64_tr_b16 v[234:235], v7 offset:1024
    s_waitcnt lgkmcnt(6)
    v_mfma_f32_16x16x32_bf16 v[128:131], v[244:247], v[48:51], v[128:131]
    ds_read_b64_tr_b16 v[236:237], v8 offset:32
    v_mfma_f32_16x16x32_bf16 v[132:135], v[244:247], v[52:55], v[132:135]
    ds_read_b64_tr_b16 v[238:239], v8 offset:1056
    s_waitcnt lgkmcnt(6)
    v_mfma_f32_16x16x32_bf16 v[136:139], v[224:227], v[48:51], v[136:139]
    ds_read_b64_tr_b16 v[240:241], v7 offset:256
    v_mfma_f32_16x16x32_bf16 v[140:143], v[224:227], v[52:55], v[140:143]
    ds_read_b64_tr_b16 v[242:243], v7 offset:1280
    s_waitcnt lgkmcnt(6)
    v_mfma_f32_16x16x32_bf16 v[144:147], v[228:231], v[48:51], v[144:147]
    ds_read_b64_tr_b16 v[244:245], v8 offset:288
    v_mfma_f32_16x16x32_bf16 v[148:151], v[228:231], v[52:55], v[148:151]
    ds_read_b64_tr_b16 v[246:247], v8 offset:1312
    s_waitcnt lgkmcnt(6)
    v_mfma_f32_16x16x32_bf16 v[88:91], v[232:235], v[56:59], v[88:91]
    ds_read_b64_tr_b16 v[224:225], v7 offset:512
    v_mfma_f32_16x16x32_bf16 v[92:95], v[232:235], v[60:63], v[92:95]
    ds_read_b64_tr_b16 v[226:227], v7 offset:1536
    s_waitcnt lgkmcnt(6)
    v_mfma_f32_16x16x32_bf16 v[96:99], v[236:239], v[56:59], v[96:99]
    ds_read_b64_tr_b16 v[228:229], v8 offset:544
    v_mfma_f32_16x16x32_bf16 v[100:103], v[236:239], v[60:63], v[100:103]
    ds_read_b64_tr_b16 v[230:231], v8 offset:1568
    s_waitcnt lgkmcnt(6)
    v_mfma_f32_16x16x32_bf16 v[104:107], v[240:243], v[56:59], v[104:107]
    ds_read_b64_tr_b16 v[232:233], v7 offset:768
    v_mfma_f32_16x16x32_bf16 v[108:111], v[240:243], v[60:63], v[108:111]
    ds_read_b64_tr_b16 v[234:235], v7 offset:1792
    s_waitcnt lgkmcnt(6)
    v_mfma_f32_16x16x32_bf16 v[112:115], v[244:247], v[56:59], v[112:115]
    ds_read_b64_tr_b16 v[236:237], v8 offset:800
    v_mfma_f32_16x16x32_bf16 v[116:119], v[244:247], v[60:63], v[116:119]
    ds_read_b64_tr_b16 v[238:239], v8 offset:1824
    s_waitcnt lgkmcnt(6)
    v_mfma_f32_16x16x32_bf16 v[120:123], v[224:227], v[56:59], v[120:123]
    s_mov_b64 s[72:73], s[48:49]
    s_mov_b32 s74, 0x700000
    s_mov_b32 s75, 0x20000
    s_cmp_lt_u32 s2, 224
    s_cselect_b32 s74, 7340032, 0
    s_and_b32 s16, s3, 3
    v_lshrrev_b32 v20, 3, v1
    v_lshlrev_b32 v20, 3, v20
    s_lshl_b32 s17, s16, 6
    v_add_u32 v20, s17, v20
    s_mov_b32 s17, 7168
    v_mul_lo_u32 v21, s17, v20
    v_and_b32 v20, 7, v1
    v_lshl_add_u32 v21, v20, 4, v21
    s_and_b32 s17, s29, 3
    s_mul_i32 s18, s17, 1835008
    s_lshr_b32 s17, s29, 2
    s_lshl_b32 s17, s17, 7
    s_add_u32 s18, s18, s17
    s_lshl_b32 s16, s16, 13
    s_add_u32 s22, s18, 0
    s_add_u32 m0, s16, 32768
    s_nop 0
    buffer_load_dwordx4 v21, s[72:75], s22 offen lds
    s_add_u32 s22, s18, 7168
    s_add_u32 m0, s16, 33792
    s_nop 0
    buffer_load_dwordx4 v21, s[72:75], s22 offen lds
    s_add_u32 s22, s18, 14336
    s_add_u32 m0, s16, 34816
    s_nop 0
    buffer_load_dwordx4 v21, s[72:75], s22 offen lds
    s_add_u32 s22, s18, 21504
    s_add_u32 m0, s16, 35840
    s_nop 0
    buffer_load_dwordx4 v21, s[72:75], s22 offen lds
    s_add_u32 s22, s18, 28672
    s_add_u32 m0, s16, 36864
    s_nop 0
    buffer_load_dwordx4 v21, s[72:75], s22 offen lds
    s_add_u32 s22, s18, 35840
    s_add_u32 m0, s16, 37888
    s_nop 0
    buffer_load_dwordx4 v21, s[72:75], s22 offen lds
    s_add_u32 s22, s18, 43008
    s_add_u32 m0, s16, 38912
    s_nop 0
    buffer_load_dwordx4 v21, s[72:75], s22 offen lds
    s_add_u32 s22, s18, 50176
    s_add_u32 m0, s16, 39936
    s_nop 0
    buffer_load_dwordx4 v21, s[72:75], s22 offen lds
    v_mfma_f32_16x16x32_bf16 v[124:127], v[224:227], v[60:63], v[124:127]
    s_barrier
    ds_read_b64_tr_b16 v[240:241], v7 offset:16384
    ds_read_b64_tr_b16 v[242:243], v7 offset:17408
    s_waitcnt lgkmcnt(6)
    v_mfma_f32_16x16x32_bf16 v[128:131], v[228:231], v[56:59], v[128:131]
    ds_read_b64_tr_b16 v[244:245], v8 offset:16416
    v_mfma_f32_16x16x32_bf16 v[132:135], v[228:231], v[60:63], v[132:135]
    ds_read_b64_tr_b16 v[246:247], v8 offset:17440
    s_waitcnt lgkmcnt(6)
    v_mfma_f32_16x16x32_bf16 v[136:139], v[232:235], v[56:59], v[136:139]
    ds_read_b64_tr_b16 v[224:225], v7 offset:16640
    v_mfma_f32_16x16x32_bf16 v[140:143], v[232:235], v[60:63], v[140:143]
    ds_read_b64_tr_b16 v[226:227], v7 offset:17664
    s_waitcnt lgkmcnt(6)
    v_mfma_f32_16x16x32_bf16 v[144:147], v[236:239], v[56:59], v[144:147]
    ds_read_b64_tr_b16 v[228:229], v8 offset:16672
    v_mfma_f32_16x16x32_bf16 v[148:151], v[236:239], v[60:63], v[148:151]
    ds_read_b64_tr_b16 v[230:231], v8 offset:17696
    s_waitcnt lgkmcnt(6)
    v_mfma_f32_16x16x32_bf16 v[88:91], v[240:243], v[64:67], v[88:91]
    ds_read_b64_tr_b16 v[232:233], v7 offset:16896
    v_mfma_f32_16x16x32_bf16 v[92:95], v[240:243], v[68:71], v[92:95]
    ds_read_b64_tr_b16 v[234:235], v7 offset:17920
    s_waitcnt lgkmcnt(6)
    v_mfma_f32_16x16x32_bf16 v[96:99], v[244:247], v[64:67], v[96:99]
    ds_read_b64_tr_b16 v[236:237], v8 offset:16928
    v_mfma_f32_16x16x32_bf16 v[100:103], v[244:247], v[68:71], v[100:103]
    ds_read_b64_tr_b16 v[238:239], v8 offset:17952
    s_waitcnt lgkmcnt(6)
    v_mfma_f32_16x16x32_bf16 v[104:107], v[224:227], v[64:67], v[104:107]
    ds_read_b64_tr_b16 v[240:241], v7 offset:17152
    v_mfma_f32_16x16x32_bf16 v[108:111], v[224:227], v[68:71], v[108:111]
    ds_read_b64_tr_b16 v[242:243], v7 offset:18176
    s_waitcnt lgkmcnt(6)
    v_mfma_f32_16x16x32_bf16 v[112:115], v[228:231], v[64:67], v[112:115]
    ds_read_b64_tr_b16 v[244:245], v8 offset:17184
    v_mfma_f32_16x16x32_bf16 v[116:119], v[228:231], v[68:71], v[116:119]
    ds_read_b64_tr_b16 v[246:247], v8 offset:18208
    s_waitcnt lgkmcnt(6)
    v_mfma_f32_16x16x32_bf16 v[120:123], v[232:235], v[64:67], v[120:123]
    v_mfma_f32_16x16x32_bf16 v[124:127], v[232:235], v[68:71], v[124:127]
    s_waitcnt vmcnt(16)
    s_barrier
    ds_read_b64_tr_b16 v[224:225], v4 offset:0
    ds_read_b64_tr_b16 v[226:227], v4 offset:1024
    s_waitcnt lgkmcnt(6)
    v_mfma_f32_16x16x32_bf16 v[128:131], v[236:239], v[64:67], v[128:131]
    ds_read_b64_tr_b16 v[228:229], v5 offset:32
    v_mfma_f32_16x16x32_bf16 v[132:135], v[236:239], v[68:71], v[132:135]
    ds_read_b64_tr_b16 v[230:231], v5 offset:1056
    s_waitcnt lgkmcnt(6)
    v_mfma_f32_16x16x32_bf16 v[136:139], v[240:243], v[64:67], v[136:139]
    ds_read_b64_tr_b16 v[232:233], v4 offset:256
    v_mfma_f32_16x16x32_bf16 v[140:143], v[240:243], v[68:71], v[140:143]
    ds_read_b64_tr_b16 v[234:235], v4 offset:1280
    s_waitcnt lgkmcnt(6)
    v_mfma_f32_16x16x32_bf16 v[144:147], v[244:247], v[64:67], v[144:147]
    ds_read_b64_tr_b16 v[236:237], v5 offset:288
    v_mfma_f32_16x16x32_bf16 v[148:151], v[244:247], v[68:71], v[148:151]
    ds_read_b64_tr_b16 v[238:239], v5 offset:1312
    s_waitcnt lgkmcnt(6)
    v_mfma_f32_16x16x32_bf16 v[88:91], v[224:227], v[24:27], v[88:91]
    ds_read_b64_tr_b16 v[240:241], v4 offset:512
    v_mfma_f32_16x16x32_bf16 v[92:95], v[224:227], v[28:31], v[92:95]
    ds_read_b64_tr_b16 v[242:243], v4 offset:1536
    s_waitcnt lgkmcnt(6)
    v_mfma_f32_16x16x32_bf16 v[96:99], v[228:231], v[24:27], v[96:99]
    ds_read_b64_tr_b16 v[244:245], v5 offset:544
    v_mfma_f32_16x16x32_bf16 v[100:103], v[228:231], v[28:31], v[100:103]
    ds_read_b64_tr_b16 v[246:247], v5 offset:1568
    s_waitcnt lgkmcnt(6)
    v_mfma_f32_16x16x32_bf16 v[104:107], v[232:235], v[24:27], v[104:107]
    ds_read_b64_tr_b16 v[224:225], v4 offset:768
    v_mfma_f32_16x16x32_bf16 v[108:111], v[232:235], v[28:31], v[108:111]
    ds_read_b64_tr_b16 v[226:227], v4 offset:1792
    s_waitcnt lgkmcnt(6)
    v_mfma_f32_16x16x32_bf16 v[112:115], v[236:239], v[24:27], v[112:115]
    ds_read_b64_tr_b16 v[228:229], v5 offset:800
    v_mfma_f32_16x16x32_bf16 v[116:119], v[236:239], v[28:31], v[116:119]
    ds_read_b64_tr_b16 v[230:231], v5 offset:1824
    s_waitcnt lgkmcnt(6)
    v_mfma_f32_16x16x32_bf16 v[120:123], v[240:243], v[24:27], v[120:123]
    v_mfma_f32_16x16x32_bf16 v[124:127], v[240:243], v[28:31], v[124:127]
    s_waitcnt vmcnt(12)
    s_barrier
    ds_read_b64_tr_b16 v[232:233], v4 offset:16384
    ds_read_b64_tr_b16 v[234:235], v4 offset:17408
    s_waitcnt lgkmcnt(6)
    v_mfma_f32_16x16x32_bf16 v[128:131], v[244:247], v[24:27], v[128:131]
    ds_read_b64_tr_b16 v[236:237], v5 offset:16416
    v_mfma_f32_16x16x32_bf16 v[132:135], v[244:247], v[28:31], v[132:135]
    ds_read_b64_tr_b16 v[238:239], v5 offset:17440
    s_waitcnt lgkmcnt(6)
    v_mfma_f32_16x16x32_bf16 v[136:139], v[224:227], v[24:27], v[136:139]
    ds_read_b64_tr_b16 v[240:241], v4 offset:16640
    v_mfma_f32_16x16x32_bf16 v[140:143], v[224:227], v[28:31], v[140:143]
    ds_read_b64_tr_b16 v[242:243], v4 offset:17664
    s_waitcnt lgkmcnt(6)
    v_mfma_f32_16x16x32_bf16 v[144:147], v[228:231], v[24:27], v[144:147]
    ds_read_b64_tr_b16 v[244:245], v5 offset:16672
    v_mfma_f32_16x16x32_bf16 v[148:151], v[228:231], v[28:31], v[148:151]
    ds_read_b64_tr_b16 v[246:247], v5 offset:17696
    s_waitcnt lgkmcnt(6)
    v_mfma_f32_16x16x32_bf16 v[88:91], v[232:235], v[32:35], v[88:91]
    ds_read_b64_tr_b16 v[224:225], v4 offset:16896
    v_mfma_f32_16x16x32_bf16 v[92:95], v[232:235], v[36:39], v[92:95]
    ds_read_b64_tr_b16 v[226:227], v4 offset:17920
    s_waitcnt lgkmcnt(6)
    v_mfma_f32_16x16x32_bf16 v[96:99], v[236:239], v[32:35], v[96:99]
    ds_read_b64_tr_b16 v[228:229], v5 offset:16928
    v_mfma_f32_16x16x32_bf16 v[100:103], v[236:239], v[36:39], v[100:103]
    ds_read_b64_tr_b16 v[230:231], v5 offset:17952
    s_waitcnt lgkmcnt(6)
    v_mfma_f32_16x16x32_bf16 v[104:107], v[240:243], v[32:35], v[104:107]
    ds_read_b64_tr_b16 v[232:233], v4 offset:17152
    v_mfma_f32_16x16x32_bf16 v[108:111], v[240:243], v[36:39], v[108:111]
    ds_read_b64_tr_b16 v[234:235], v4 offset:18176
    s_waitcnt lgkmcnt(6)
    v_mfma_f32_16x16x32_bf16 v[112:115], v[244:247], v[32:35], v[112:115]
    ds_read_b64_tr_b16 v[236:237], v5 offset:17184
    v_mfma_f32_16x16x32_bf16 v[116:119], v[244:247], v[36:39], v[116:119]
    ds_read_b64_tr_b16 v[238:239], v5 offset:18208
    s_waitcnt lgkmcnt(6)
    v_mfma_f32_16x16x32_bf16 v[120:123], v[224:227], v[32:35], v[120:123]
    v_mfma_f32_16x16x32_bf16 v[124:127], v[224:227], v[36:39], v[124:127]
    s_waitcnt lgkmcnt(4)
    v_mfma_f32_16x16x32_bf16 v[128:131], v[228:231], v[32:35], v[128:131]
    v_mfma_f32_16x16x32_bf16 v[132:135], v[228:231], v[36:39], v[132:135]
    s_waitcnt lgkmcnt(2)
    v_mfma_f32_16x16x32_bf16 v[136:139], v[232:235], v[32:35], v[136:139]
    v_mfma_f32_16x16x32_bf16 v[140:143], v[232:235], v[36:39], v[140:143]
    s_waitcnt lgkmcnt(0)
    v_mfma_f32_16x16x32_bf16 v[144:147], v[236:239], v[32:35], v[144:147]
    v_mfma_f32_16x16x32_bf16 v[148:151], v[236:239], v[36:39], v[148:151]
    s_lshl_b32 s16, s3, 13
    s_xor_b32 s17, s16, 0x8000
    s_add_u32 s16, s16, 0x18000
    s_add_u32 s17, s17, 0x18000
    v_add_u32 v16, s16, v2
    s_mov_b32 s16, s17
    v_add_u32 v17, s16, v2
    ds_write_b128 v16, v[88:91] offset:0
    ds_write_b128 v16, v[92:95] offset:1024
    ds_write_b128 v16, v[96:99] offset:2048
    ds_write_b128 v16, v[100:103] offset:3072
    ds_write_b128 v16, v[104:107] offset:4096
    ds_write_b128 v16, v[108:111] offset:5120
    ds_write_b128 v16, v[112:115] offset:6144
    ds_write_b128 v16, v[116:119] offset:7168
    s_waitcnt vmcnt(11)
    v_lshlrev_b32 v24, 16, v248
    v_and_b32 v25, 0xffff0000, v248
    v_lshlrev_b32 v26, 16, v249
    v_and_b32 v27, 0xffff0000, v249
    s_waitcnt vmcnt(10)
    v_lshlrev_b32 v28, 16, v250
    v_and_b32 v29, 0xffff0000, v250
    v_lshlrev_b32 v30, 16, v251
    v_and_b32 v31, 0xffff0000, v251
    s_waitcnt vmcnt(9)
    v_lshlrev_b32 v32, 16, v252
    v_and_b32 v33, 0xffff0000, v252
    v_lshlrev_b32 v34, 16, v253
    v_and_b32 v35, 0xffff0000, v253
    s_waitcnt vmcnt(8)
    v_lshlrev_b32 v36, 16, v254
    v_and_b32 v37, 0xffff0000, v254
    v_lshlrev_b32 v38, 16, v255
    v_and_b32 v39, 0xffff0000, v255
    v_and_b32 v18, 15, v1
    v_lshlrev_b32 v18, 6, v18
    v_lshrrev_b32 v19, 4, v1
    v_and_b32 v20, 1, v19
    v_lshl_add_u32 v18, v20, 5, v18
    v_lshrrev_b32 v19, 1, v19
    v_lshl_add_u32 v18, v19, 4, v18
    s_and_b32 s17, s3, 3
    s_lshl_b32 s18, s30, 2
    s_add_u32 s18, s18, s17
    s_lshl_b32 s18, s18, 16
    s_lshl_b32 s19, s15, 22
    s_add_u32 s18, s18, s19
    s_lshl_b32 s19, s31, 12
    s_add_u32 s18, s18, s19
    s_add_u32 s18, s18, 0x2000800
    s_add_u32 s19, s18, 32768
    s_waitcnt lgkmcnt(0)
    s_barrier
    ds_read_b128 v[40:43], v17 offset:0
    ds_read_b128 v[44:47], v17 offset:1024
    ds_read_b128 v[48:51], v17 offset:2048
    ds_read_b128 v[52:55], v17 offset:3072
    ds_read_b128 v[56:59], v17 offset:4096
    ds_read_b128 v[60:63], v17 offset:5120
    ds_read_b128 v[64:67], v17 offset:6144
    ds_read_b128 v[68:71], v17 offset:7168
    s_waitcnt lgkmcnt(7)
    v_pk_add_f32 v[120:121], v[120:121], v[40:41]
    v_pk_add_f32 v[122:123], v[122:123], v[42:43]
    v_pk_mul_f32 v[120:121], v[120:121], v[24:25]
    v_pk_mul_f32 v[122:123], v[122:123], v[26:27]
    v_cvt_pk_bf16_f32 v224, v120, v121
    v_cvt_pk_bf16_f32 v225, v122, v123
    s_waitcnt lgkmcnt(5)
    v_pk_add_f32 v[128:129], v[128:129], v[48:49]
    v_pk_add_f32 v[130:131], v[130:131], v[50:51]
    v_pk_mul_f32 v[128:129], v[128:129], v[28:29]
    v_pk_mul_f32 v[130:131], v[130:131], v[30:31]
    v_cvt_pk_bf16_f32 v226, v128, v129
    v_cvt_pk_bf16_f32 v227, v130, v131
    s_nop 0
    v_permlane16_swap_b32 v224, v226
    v_permlane16_swap_b32 v225, v227
    buffer_store_dwordx4 v[224:227], v18, s[8:11], s18 offen offset:0 sc1
    v_pk_add_f32 v[124:125], v[124:125], v[44:45]
    v_pk_add_f32 v[126:127], v[126:127], v[46:47]
    v_pk_mul_f32 v[124:125], v[124:125], v[24:25]
    v_pk_mul_f32 v[126:127], v[126:127], v[26:27]
    v_cvt_pk_bf16_f32 v228, v124, v125
    v_cvt_pk_bf16_f32 v229, v126, v127
    s_waitcnt lgkmcnt(4)
    v_pk_add_f32 v[132:133], v[132:133], v[52:53]
    v_pk_add_f32 v[134:135], v[134:135], v[54:55]
    v_pk_mul_f32 v[132:133], v[132:133], v[28:29]
    v_pk_mul_f32 v[134:135], v[134:135], v[30:31]
    v_cvt_pk_bf16_f32 v230, v132, v133
    v_cvt_pk_bf16_f32 v231, v134, v135
    s_nop 0
    v_permlane16_swap_b32 v228, v230
    v_permlane16_swap_b32 v229, v231
    buffer_store_dwordx4 v[228:231], v18, s[8:11], s19 offen offset:0 sc1
    s_waitcnt lgkmcnt(3)
    v_pk_add_f32 v[136:137], v[136:137], v[56:57]
    v_pk_add_f32 v[138:139], v[138:139], v[58:59]
    v_pk_mul_f32 v[136:137], v[136:137], v[32:33]
    v_pk_mul_f32 v[138:139], v[138:139], v[34:35]
    v_cvt_pk_bf16_f32 v232, v136, v137
    v_cvt_pk_bf16_f32 v233, v138, v139
    s_waitcnt lgkmcnt(1)
    v_pk_add_f32 v[144:145], v[144:145], v[64:65]
    v_pk_add_f32 v[146:147], v[146:147], v[66:67]
    v_pk_mul_f32 v[144:145], v[144:145], v[36:37]
    v_pk_mul_f32 v[146:147], v[146:147], v[38:39]
    v_cvt_pk_bf16_f32 v234, v144, v145
    v_cvt_pk_bf16_f32 v235, v146, v147
    s_nop 0
    v_permlane16_swap_b32 v232, v234
    v_permlane16_swap_b32 v233, v235
    buffer_store_dwordx4 v[232:235], v18, s[8:11], s18 offen offset:1024 sc1
    v_pk_add_f32 v[140:141], v[140:141], v[60:61]
    v_pk_add_f32 v[142:143], v[142:143], v[62:63]
    v_pk_mul_f32 v[140:141], v[140:141], v[32:33]
    v_pk_mul_f32 v[142:143], v[142:143], v[34:35]
    v_cvt_pk_bf16_f32 v236, v140, v141
    v_cvt_pk_bf16_f32 v237, v142, v143
    s_waitcnt lgkmcnt(0)
    v_pk_add_f32 v[148:149], v[148:149], v[68:69]
    v_pk_add_f32 v[150:151], v[150:151], v[70:71]
    v_pk_mul_f32 v[148:149], v[148:149], v[36:37]
    v_pk_mul_f32 v[150:151], v[150:151], v[38:39]
    v_cvt_pk_bf16_f32 v238, v148, v149
    v_cvt_pk_bf16_f32 v239, v150, v151
    s_nop 0
    v_permlane16_swap_b32 v236, v238
    v_permlane16_swap_b32 v237, v239
    buffer_store_dwordx4 v[236:239], v18, s[8:11], s19 offen offset:1024 sc1
    s_mov_b64 s[64:65], s[44:45]
    s_mov_b32 s66, 0x800
    s_mov_b32 s67, 0x20000
    s_mov_b64 s[76:77], s[32:33]
    s_mov_b32 s78, 0x400000
    s_mov_b32 s79, 0x20000
    s_mov_b64 s[68:69], s[56:57]
    s_mov_b32 s70, 0x400000
    s_mov_b32 s71, 0x20000
    s_lshl_b32 s14, s31, 1
    s_add_u32 s14, s14, s15
    s_lshl_b32 s14, s14, 3
    s_add_u32 s14, s14, s3
    s_lshl_b32 s16, s30, 7
    s_add_u32 s14, s14, s16
    s_lshl_b32 s16, s14, 11
    buffer_load_dwordx4 v[216:219], v2, s[76:79], s16 offen offset:0
    buffer_load_dwordx4 v[220:223], v2, s[76:79], s16 offen offset:1024
    s_lshl_b32 s16, s3, 10
    s_add_u32 m0, s16, 81920
    s_add_u32 s17, s16, 0x540800
    s_cmp_lt_u32 s3, 6
    s_cselect_b32 s17, s17, 0x7ffffff0
    s_sub_u32 s23, s16, 6144
    s_cmp_ge_u32 s3, 6
    s_cselect_b32 s23, s23, 0x7ffffff0
    s_cbranch_scc1 adaLN_cond__sliding_block_cached__moe_arch_mod__prompt_kernel_mlw
    buffer_load_dwordx4 v2, s[8:11], s17 offen sc1 lds
    s_branch adaLN_cond__sliding_block_cached__moe_arch_mod__prompt_kernel_mlj
adaLN_cond__sliding_block_cached__moe_arch_mod__prompt_kernel_mlw:
    buffer_load_dwordx4 v2, s[64:67], s23 offen lds
adaLN_cond__sliding_block_cached__moe_arch_mod__prompt_kernel_mlj:
    s_lshl_b32 s16, s30, 5
    s_lshl_b32 s17, s31, 1
    s_add_u32 s16, s16, s17
    s_add_u32 s16, s16, s15
    s_lshl_b32 s16, s16, 2
    s_add_u32 s16, s16, 0x530000
    s_cmp_eq_u32 s3, 0
    s_cselect_b32 s16, s16, 0x7ffffff0
    v_mov_b32 v16, s28
    v_mov_b32 v17, 0
    s_lshr_b32 s18, s14, 4
    s_lshl_b32 s18, s18, 15
    s_and_b32 s19, s14, 15
    s_lshl_b32 s19, s19, 6
    s_add_u32 s18, s18, s19
    s_add_u32 s18, s18, 0x2000000
    s_add_u32 s19, s18, 16384
    v_lshrrev_b32 v18, 2, v1
    v_lshlrev_b32 v18, 10, v18
    v_and_b32 v19, 3, v1
    v_lshl_add_u32 v18, v19, 4, v18
    v_add_u32 v19, 0x400000, v18
    s_lshl_b32 s25, s30, 7
    s_add_u32 s25, s25, 0x530000
    v_and_b32 v20, 15, v1
    v_lshlrev_b32 v20, 2, v20
    s_waitcnt vmcnt(3)
    s_waitcnt vmcnt(0)
    s_barrier
    s_mov_b64 exec, 1
    buffer_store_dword v16, v17, s[8:11], s16 offen sc1
    s_mov_b64 exec, -1
    v_add_u32 v16, 81920, v2
    ds_read_b128 v[184:187], v16 offset:0
    ds_read_b128 v[188:191], v16 offset:1024
    ds_read_b128 v[192:195], v16 offset:2048
    ds_read_b128 v[196:199], v16 offset:3072
    ds_read_b128 v[200:203], v16 offset:4096
    ds_read_b128 v[204:207], v16 offset:5120
    ds_read_b128 v[208:211], v16 offset:6144
    ds_read_b128 v[212:215], v16 offset:7168
    v_mov_b32 v94, 0
    v_mov_b32 v95, 0
    s_waitcnt lgkmcnt(5)
    v_lshlrev_b32 v76, 16, v192
    v_and_b32 v77, 0xffff0000, v192
    s_waitcnt lgkmcnt(1)
    v_lshlrev_b32 v78, 16, v208
    v_and_b32 v79, 0xffff0000, v208
    v_pk_mul_f32 v[60:61], v[76:77], v[78:79]
    v_lshlrev_b32 v76, 16, v184
    v_and_b32 v77, 0xffff0000, v184
    v_fmac_f32 v94, v76, v78
    v_fmac_f32 v94, v77, v79
    v_add_f32 v95, v95, v60
    v_add_f32 v95, v95, v61
    v_lshlrev_b32 v76, 16, v193
    v_and_b32 v77, 0xffff0000, v193
    v_lshlrev_b32 v78, 16, v209
    v_and_b32 v79, 0xffff0000, v209
    v_pk_mul_f32 v[62:63], v[76:77], v[78:79]
    v_lshlrev_b32 v76, 16, v185
    v_and_b32 v77, 0xffff0000, v185
    v_fmac_f32 v94, v76, v78
    v_fmac_f32 v94, v77, v79
    v_add_f32 v95, v95, v62
    v_add_f32 v95, v95, v63
    v_lshlrev_b32 v76, 16, v194
    v_and_b32 v77, 0xffff0000, v194
    v_lshlrev_b32 v78, 16, v210
    v_and_b32 v79, 0xffff0000, v210
    v_pk_mul_f32 v[64:65], v[76:77], v[78:79]
    v_lshlrev_b32 v76, 16, v186
    v_and_b32 v77, 0xffff0000, v186
    v_fmac_f32 v94, v76, v78
    v_fmac_f32 v94, v77, v79
    v_add_f32 v95, v95, v64
    v_add_f32 v95, v95, v65
    v_lshlrev_b32 v76, 16, v195
    v_and_b32 v77, 0xffff0000, v195
    v_lshlrev_b32 v78, 16, v211
    v_and_b32 v79, 0xffff0000, v211
    v_pk_mul_f32 v[66:67], v[76:77], v[78:79]
    v_lshlrev_b32 v76, 16, v187
    v_and_b32 v77, 0xffff0000, v187
    v_fmac_f32 v94, v76, v78
    v_fmac_f32 v94, v77, v79
    v_add_f32 v95, v95, v66
    v_add_f32 v95, v95, v67
    v_lshlrev_b32 v76, 16, v196
    v_and_b32 v77, 0xffff0000, v196
    s_waitcnt lgkmcnt(0)
    v_lshlrev_b32 v78, 16, v212
    v_and_b32 v79, 0xffff0000, v212
    v_pk_mul_f32 v[68:69], v[76:77], v[78:79]
    v_lshlrev_b32 v76, 16, v188
    v_and_b32 v77, 0xffff0000, v188
    v_fmac_f32 v94, v76, v78
    v_fmac_f32 v94, v77, v79
    v_add_f32 v95, v95, v68
    v_add_f32 v95, v95, v69
    v_lshlrev_b32 v76, 16, v197
    v_and_b32 v77, 0xffff0000, v197
    v_lshlrev_b32 v78, 16, v213
    v_and_b32 v79, 0xffff0000, v213
    v_pk_mul_f32 v[70:71], v[76:77], v[78:79]
    v_lshlrev_b32 v76, 16, v189
    v_and_b32 v77, 0xffff0000, v189
    v_fmac_f32 v94, v76, v78
    v_fmac_f32 v94, v77, v79
    v_add_f32 v95, v95, v70
    v_add_f32 v95, v95, v71
    v_lshlrev_b32 v76, 16, v198
    v_and_b32 v77, 0xffff0000, v198
    v_lshlrev_b32 v78, 16, v214
    v_and_b32 v79, 0xffff0000, v214
    v_pk_mul_f32 v[72:73], v[76:77], v[78:79]
    v_lshlrev_b32 v76, 16, v190
    v_and_b32 v77, 0xffff0000, v190
    v_fmac_f32 v94, v76, v78
    v_fmac_f32 v94, v77, v79
    v_add_f32 v95, v95, v72
    v_add_f32 v95, v95, v73
    v_lshlrev_b32 v76, 16, v199
    v_and_b32 v77, 0xffff0000, v199
    v_lshlrev_b32 v78, 16, v215
    v_and_b32 v79, 0xffff0000, v215
    v_pk_mul_f32 v[74:75], v[76:77], v[78:79]
    v_lshlrev_b32 v76, 16, v191
    v_and_b32 v77, 0xffff0000, v191
    v_fmac_f32 v94, v76, v78
    v_fmac_f32 v94, v77, v79
    v_add_f32 v95, v95, v74
    v_add_f32 v95, v95, v75
    v_add_f32_dpp v94, v94, v94 row_ror:1 row_mask:0xf bank_mask:0xf
    s_nop 0
    v_add_f32_dpp v95, v95, v95 row_ror:1 row_mask:0xf bank_mask:0xf
    v_add_f32_dpp v94, v94, v94 row_ror:2 row_mask:0xf bank_mask:0xf
    s_nop 0
    v_add_f32_dpp v95, v95, v95 row_ror:2 row_mask:0xf bank_mask:0xf
    v_add_f32_dpp v94, v94, v94 row_ror:4 row_mask:0xf bank_mask:0xf
    s_nop 0
    v_add_f32_dpp v95, v95, v95 row_ror:4 row_mask:0xf bank_mask:0xf
    v_add_f32_dpp v94, v94, v94 row_ror:8 row_mask:0xf bank_mask:0xf
    s_nop 0
    v_add_f32_dpp v95, v95, v95 row_ror:8 row_mask:0xf bank_mask:0xf
    v_mov_b32 v76, v94
    s_nop 1
    v_permlane16_swap_b32 v94, v76
    v_add_f32 v94, v94, v76
    v_mov_b32 v77, v95
    s_nop 1
    v_permlane16_swap_b32 v95, v77
    v_add_f32 v95, v95, v77
    v_mov_b32 v76, v94
    s_nop 1
    v_permlane32_swap_b32 v94, v76
    v_add_f32 v94, v94, v76
    v_mov_b32 v77, v95
    s_nop 1
    v_permlane32_swap_b32 v95, v77
    v_add_f32 v95, v95, v77
    v_lshlrev_b32 v28, 16, v216
    v_and_b32 v29, 0xffff0000, v216
    v_lshlrev_b32 v30, 16, v217
    v_and_b32 v31, 0xffff0000, v217
    v_lshlrev_b32 v32, 16, v218
    v_and_b32 v33, 0xffff0000, v218
    v_lshlrev_b32 v34, 16, v219
    v_and_b32 v35, 0xffff0000, v219
    v_lshlrev_b32 v36, 16, v220
    v_and_b32 v37, 0xffff0000, v220
    v_lshlrev_b32 v38, 16, v221
    v_and_b32 v39, 0xffff0000, v221
    v_lshlrev_b32 v40, 16, v222
    v_and_b32 v41, 0xffff0000, v222
    v_lshlrev_b32 v42, 16, v223
    v_and_b32 v43, 0xffff0000, v223
    s_mov_b32 s27, 0
adaLN_cond__sliding_block_cached__moe_arch_mod__prompt_kernel_a22p:
    buffer_load_dword v76, v20, s[8:11], s25 offen sc1
    s_waitcnt vmcnt(0)
    v_cmp_ne_u32 vcc, s28, v76
    s_add_u32 s27, s27, 1
    s_cmp_ge_u32 s27, 65536
    s_cbranch_scc1 adaLN_cond__sliding_block_cached__moe_arch_mod__prompt_kernel_a22g
    s_cbranch_vccnz adaLN_cond__sliding_block_cached__moe_arch_mod__prompt_kernel_a22p
adaLN_cond__sliding_block_cached__moe_arch_mod__prompt_kernel_a22g:
    buffer_load_dwordx4 v[44:47], v18, s[8:11], s18 offen sc1
    buffer_load_dwordx4 v[52:55], v19, s[8:11], s18 offen sc1
    buffer_load_dwordx4 v[48:51], v18, s[8:11], s19 offen sc1
    buffer_load_dwordx4 v[56:59], v19, s[8:11], s19 offen sc1
    v_lshlrev_b32 v21, 2, v0
    s_mov_b32 s16, 0x540800
    buffer_load_dword v106, v21, s[8:11], s16 offen sc1
    buffer_load_dword v104, v21, s[8:11], s16 offen offset:2048 sc1
    s_waitcnt vmcnt(5)
    v_lshlrev_b32 v76, 16, v44
    v_and_b32 v77, 0xffff0000, v44
    s_waitcnt vmcnt(4)
    v_lshlrev_b32 v78, 16, v52
    v_and_b32 v79, 0xffff0000, v52
    v_pk_add_f32 v[76:77], v[76:77], v[78:79]
    v_pk_add_f32 v[28:29], v[28:29], v[76:77]
    v_cvt_pk_bf16_f32 v16, v28, v29
    v_lshlrev_b32 v28, 16, v16
    v_and_b32 v29, 0xffff0000, v16
    v_lshlrev_b32 v80, 16, v45
    v_and_b32 v81, 0xffff0000, v45
    v_lshlrev_b32 v82, 16, v53
    v_and_b32 v83, 0xffff0000, v53
    v_pk_add_f32 v[80:81], v[80:81], v[82:83]
    v_pk_add_f32 v[30:31], v[30:31], v[80:81]
    v_cvt_pk_bf16_f32 v17, v30, v31
    v_lshlrev_b32 v30, 16, v17
    v_and_b32 v31, 0xffff0000, v17
    v_lshlrev_b32 v76, 16, v46
    v_and_b32 v77, 0xffff0000, v46
    v_lshlrev_b32 v78, 16, v54
    v_and_b32 v79, 0xffff0000, v54
    v_pk_add_f32 v[76:77], v[76:77], v[78:79]
    v_pk_add_f32 v[32:33], v[32:33], v[76:77]
    v_cvt_pk_bf16_f32 v16, v32, v33
    v_lshlrev_b32 v32, 16, v16
    v_and_b32 v33, 0xffff0000, v16
    v_lshlrev_b32 v80, 16, v47
    v_and_b32 v81, 0xffff0000, v47
    v_lshlrev_b32 v82, 16, v55
    v_and_b32 v83, 0xffff0000, v55
    v_pk_add_f32 v[80:81], v[80:81], v[82:83]
    v_pk_add_f32 v[34:35], v[34:35], v[80:81]
    v_cvt_pk_bf16_f32 v17, v34, v35
    v_lshlrev_b32 v34, 16, v17
    v_and_b32 v35, 0xffff0000, v17
    s_waitcnt vmcnt(3)
    v_lshlrev_b32 v76, 16, v48
    v_and_b32 v77, 0xffff0000, v48
    s_waitcnt vmcnt(2)
    v_lshlrev_b32 v78, 16, v56
    v_and_b32 v79, 0xffff0000, v56
    v_pk_add_f32 v[76:77], v[76:77], v[78:79]
    v_pk_add_f32 v[36:37], v[36:37], v[76:77]
    v_cvt_pk_bf16_f32 v16, v36, v37
    v_lshlrev_b32 v36, 16, v16
    v_and_b32 v37, 0xffff0000, v16
    v_lshlrev_b32 v80, 16, v49
    v_and_b32 v81, 0xffff0000, v49
    v_lshlrev_b32 v82, 16, v57
    v_and_b32 v83, 0xffff0000, v57
    v_pk_add_f32 v[80:81], v[80:81], v[82:83]
    v_pk_add_f32 v[38:39], v[38:39], v[80:81]
    v_cvt_pk_bf16_f32 v17, v38, v39
    v_lshlrev_b32 v38, 16, v17
    v_and_b32 v39, 0xffff0000, v17
    v_lshlrev_b32 v76, 16, v50
    v_and_b32 v77, 0xffff0000, v50
    v_lshlrev_b32 v78, 16, v58
    v_and_b32 v79, 0xffff0000, v58
    v_pk_add_f32 v[76:77], v[76:77], v[78:79]
    v_pk_add_f32 v[40:41], v[40:41], v[76:77]
    v_cvt_pk_bf16_f32 v16, v40, v41
    v_lshlrev_b32 v40, 16, v16
    v_and_b32 v41, 0xffff0000, v16
    v_lshlrev_b32 v80, 16, v51
    v_and_b32 v81, 0xffff0000, v51
    v_lshlrev_b32 v82, 16, v59
    v_and_b32 v83, 0xffff0000, v59
    v_pk_add_f32 v[80:81], v[80:81], v[82:83]
    v_pk_add_f32 v[42:43], v[42:43], v[80:81]
    v_cvt_pk_bf16_f32 v17, v42, v43
    v_lshlrev_b32 v42, 16, v17
    v_and_b32 v43, 0xffff0000, v17
    v_pk_add_f32 v[76:77], v[28:29], v[30:31]
    v_pk_mul_f32 v[78:79], v[28:29], v[28:29]
    v_pk_mul_f32 v[80:81], v[28:29], v[60:61]
    v_pk_fma_f32 v[78:79], v[30:31], v[30:31], v[78:79]
    v_pk_fma_f32 v[80:81], v[30:31], v[62:63], v[80:81]
    v_pk_add_f32 v[76:77], v[76:77], v[32:33]
    v_pk_fma_f32 v[78:79], v[32:33], v[32:33], v[78:79]
    v_pk_fma_f32 v[80:81], v[32:33], v[64:65], v[80:81]
    v_pk_add_f32 v[76:77], v[76:77], v[34:35]
    v_pk_fma_f32 v[78:79], v[34:35], v[34:35], v[78:79]
    v_pk_fma_f32 v[80:81], v[34:35], v[66:67], v[80:81]
    v_pk_add_f32 v[76:77], v[76:77], v[36:37]
    v_pk_fma_f32 v[78:79], v[36:37], v[36:37], v[78:79]
    v_pk_fma_f32 v[80:81], v[36:37], v[68:69], v[80:81]
    v_pk_add_f32 v[76:77], v[76:77], v[38:39]
    v_pk_fma_f32 v[78:79], v[38:39], v[38:39], v[78:79]
    v_pk_fma_f32 v[80:81], v[38:39], v[70:71], v[80:81]
    v_pk_add_f32 v[76:77], v[76:77], v[40:41]
    v_pk_fma_f32 v[78:79], v[40:41], v[40:41], v[78:79]
    v_pk_fma_f32 v[80:81], v[40:41], v[72:73], v[80:81]
    v_pk_add_f32 v[76:77], v[76:77], v[42:43]
    v_pk_fma_f32 v[78:79], v[42:43], v[42:43], v[78:79]
    v_pk_fma_f32 v[80:81], v[42:43], v[74:75], v[80:81]
    v_add_f32 v96, v76, v77
    v_add_f32 v97, v78, v79
    v_add_f32 v98, v80, v81
    v_add_f32_dpp v96, v96, v96 row_ror:1 row_mask:0xf bank_mask:0xf
    v_add_f32_dpp v97, v97, v97 row_ror:1 row_mask:0xf bank_mask:0xf
    v_add_f32_dpp v98, v98, v98 row_ror:1 row_mask:0xf bank_mask:0xf
    v_add_f32_dpp v96, v96, v96 row_ror:2 row_mask:0xf bank_mask:0xf
    v_add_f32_dpp v97, v97, v97 row_ror:2 row_mask:0xf bank_mask:0xf
    v_add_f32_dpp v98, v98, v98 row_ror:2 row_mask:0xf bank_mask:0xf
    v_add_f32_dpp v96, v96, v96 row_ror:4 row_mask:0xf bank_mask:0xf
    v_add_f32_dpp v97, v97, v97 row_ror:4 row_mask:0xf bank_mask:0xf
    v_add_f32_dpp v98, v98, v98 row_ror:4 row_mask:0xf bank_mask:0xf
    v_add_f32_dpp v96, v96, v96 row_ror:8 row_mask:0xf bank_mask:0xf
    v_add_f32_dpp v97, v97, v97 row_ror:8 row_mask:0xf bank_mask:0xf
    v_add_f32_dpp v98, v98, v98 row_ror:8 row_mask:0xf bank_mask:0xf
    v_mov_b32 v76, v96
    s_nop 1
    v_permlane16_swap_b32 v96, v76
    v_add_f32 v96, v96, v76
    v_mov_b32 v77, v97
    s_nop 1
    v_permlane16_swap_b32 v97, v77
    v_add_f32 v97, v97, v77
    v_mov_b32 v78, v98
    s_nop 1
    v_permlane16_swap_b32 v98, v78
    v_add_f32 v98, v98, v78
    v_mov_b32 v76, v96
    s_nop 1
    v_permlane32_swap_b32 v96, v76
    v_add_f32 v96, v96, v76
    v_mov_b32 v77, v97
    s_nop 1
    v_permlane32_swap_b32 v97, v77
    v_add_f32 v97, v97, v77
    v_mov_b32 v78, v98
    s_nop 1
    v_permlane32_swap_b32 v98, v78
    v_add_f32 v98, v98, v78
    v_mul_f32 v96, 0x3a800000, v96
    v_mul_f32 v97, 0x3a800000, v97
    v_fma_f32 v97, -v96, v96, v97
    v_max_f32 v97, 0, v97
    v_fma_f32 v98, -v96, v95, v98
    v_add_f32 v76, 0x3727c5ac, v97
    v_rsq_f32 v76, v76
    s_nop 0
    v_fma_f32 v27, v98, v76, v94
    v_cvt_pk_bf16_f32 v96, v96, v96
    v_lshlrev_b32 v96, 16, v96
    v_cvt_pk_bf16_f32 v97, v97, v97
    v_lshlrev_b32 v97, 16, v97
    v_add_f32 v97, 0x3727c5ac, v97
    v_cvt_pk_bf16_f32 v97, v97, v97
    v_lshlrev_b32 v97, 16, v97
    v_sqrt_f32 v98, v97
    s_nop 0
    v_cvt_pk_bf16_f32 v98, v98, v98
    v_lshlrev_b32 v98, 16, v98
    v_rcp_f32 v99, v98
    v_mov_b32 v25, v96
    v_mov_b32 v26, v98
    v_ashrrev_i32 v16, 31, v27
    v_or_b32 v16, 0x80000000, v16
    v_xor_b32 v24, v27, v16
    v_and_b32 v24, 0xfffff800, v24
    v_max_u32 v24, 0x800, v24
    s_sub_u32 s16, 2047, s14
    v_or_b32 v24, s16, v24
    s_lshl_b32 s16, s3, 4
    s_add_u32 s16, s16, 65536
    v_mov_b32 v16, s16
    ds_write_b128 v16, v[24:27]
    s_waitcnt lgkmcnt(0)
    s_barrier
    v_and_b32 v16, 7, v1
    v_lshlrev_b32 v16, 4, v16
    v_add_u32 v16, 65536, v16
    ds_read_b32 v76, v16
    s_waitcnt lgkmcnt(0)
    v_mov_b32 v77, v76
    s_nop 1
    v_max_u32_dpp v77, v77, v77 row_ror:1 row_mask:0xf bank_mask:0xf
    s_nop 1
    v_max_u32_dpp v77, v77, v77 row_ror:2 row_mask:0xf bank_mask:0xf
    s_nop 1
    v_max_u32_dpp v77, v77, v77 row_ror:4 row_mask:0xf bank_mask:0xf
    v_cmp_eq_u32 vcc, v76, v77
    s_ff1_i32_b64 s16, vcc
    s_lshl_b32 s16, s16, 4
    s_add_u32 s16, s16, 65536
    v_mov_b32 v16, s16
    ds_read_b128 v[24:27], v16
    s_lshl_b32 s16, s2, 4
    s_add_u32 s16, s16, 0x6e0000
    s_cmp_eq_u32 s3, 0
    s_cselect_b32 s16, s16, 0x7ffffff0
    v_mov_b32 v17, 0
    s_mov_b64 exec, 1
    s_waitcnt lgkmcnt(0)
    buffer_store_dwordx4 v[24:27], v17, s[8:11], s16 offen sc1
    s_mov_b64 exec, -1
    s_mov_b64 s[72:73], s[50:51]
    s_mov_b32 s74, 0x700000
    s_mov_b32 s75, 0x20000
    s_cmp_lt_u32 s2, 224
    s_cselect_b32 s74, 7340032, 0
    s_lshl_b32 s17, s29, 4
    s_sub_u32 s16, s3, 4
    s_lshl_b32 s16, s16, 2
    s_add_u32 s16, s16, s17
    s_lshl_b32 s16, s16, 11
    s_add_u32 s17, s16, 0
    buffer_load_dwordx4 v[152:155], v2, s[72:75], s17 offen offset:0
    buffer_load_dwordx4 v[156:159], v2, s[72:75], s17 offen offset:1024
    s_add_u32 s17, s16, 2048
    buffer_load_dwordx4 v[160:163], v2, s[72:75], s17 offen offset:0
    buffer_load_dwordx4 v[164:167], v2, s[72:75], s17 offen offset:1024
    s_add_u32 s17, s16, 4096
    buffer_load_dwordx4 v[168:171], v2, s[72:75], s17 offen offset:0
    buffer_load_dwordx4 v[172:175], v2, s[72:75], s17 offen offset:1024
    s_add_u32 s17, s16, 6144
    buffer_load_dwordx4 v[176:179], v2, s[72:75], s17 offen offset:0
    buffer_load_dwordx4 v[180:183], v2, s[72:75], s17 offen offset:1024
    v_sub_f32 v44, v28, v96
    v_sub_f32 v45, v29, v96
    v_sub_f32 v46, v30, v96
    v_sub_f32 v47, v31, v96
    v_sub_f32 v48, v32, v96
    v_sub_f32 v49, v33, v96
    v_sub_f32 v50, v34, v96
    v_sub_f32 v51, v35, v96
    v_cvt_pk_bf16_f32 v16, v44, v45
    v_lshlrev_b32 v44, 16, v16
    v_and_b32 v45, 0xffff0000, v16
    v_cvt_pk_bf16_f32 v16, v46, v47
    v_lshlrev_b32 v46, 16, v16
    v_and_b32 v47, 0xffff0000, v16
    v_cvt_pk_bf16_f32 v16, v48, v49
    v_lshlrev_b32 v48, 16, v16
    v_and_b32 v49, 0xffff0000, v16
    v_cvt_pk_bf16_f32 v16, v50, v51
    v_lshlrev_b32 v50, 16, v16
    v_and_b32 v51, 0xffff0000, v16
    v_mul_f32 v52, v44, v99
    v_mul_f32 v53, v45, v99
    v_mul_f32 v54, v46, v99
    v_mul_f32 v55, v47, v99
    v_mul_f32 v56, v48, v99
    v_mul_f32 v57, v49, v99
    v_mul_f32 v58, v50, v99
    v_mul_f32 v59, v51, v99
    v_fma_f32 v44, -v52, v98, v44
    v_fma_f32 v45, -v53, v98, v45
    v_fma_f32 v46, -v54, v98, v46
    v_fma_f32 v47, -v55, v98, v47
    v_fma_f32 v48, -v56, v98, v48
    v_fma_f32 v49, -v57, v98, v49
    v_fma_f32 v50, -v58, v98, v50
    v_fma_f32 v51, -v59, v98, v51
    v_fma_f32 v44, v44, v99, v52
    v_fma_f32 v45, v45, v99, v53
    v_fma_f32 v46, v46, v99, v54
    v_fma_f32 v47, v47, v99, v55
    v_fma_f32 v48, v48, v99, v56
    v_fma_f32 v49, v49, v99, v57
    v_fma_f32 v50, v50, v99, v58
    v_fma_f32 v51, v51, v99, v59
    v_cvt_pk_bf16_f32 v16, v44, v45
    v_lshlrev_b32 v44, 16, v16
    v_and_b32 v45, 0xffff0000, v16
    v_cvt_pk_bf16_f32 v16, v46, v47
    v_lshlrev_b32 v46, 16, v16
    v_and_b32 v47, 0xffff0000, v16
    v_cvt_pk_bf16_f32 v16, v48, v49
    v_lshlrev_b32 v48, 16, v16
    v_and_b32 v49, 0xffff0000, v16
    v_cvt_pk_bf16_f32 v16, v50, v51
    v_lshlrev_b32 v50, 16, v16
    v_and_b32 v51, 0xffff0000, v16
    v_lshlrev_b32 v52, 16, v192
    v_and_b32 v53, 0xffff0000, v192
    v_lshlrev_b32 v54, 16, v193
    v_and_b32 v55, 0xffff0000, v193
    v_lshlrev_b32 v56, 16, v194
    v_and_b32 v57, 0xffff0000, v194
    v_lshlrev_b32 v58, 16, v195
    v_and_b32 v59, 0xffff0000, v195
    v_pk_mul_f32 v[44:45], v[44:45], v[52:53]
    v_pk_mul_f32 v[46:47], v[46:47], v[54:55]
    v_pk_mul_f32 v[48:49], v[48:49], v[56:57]
    v_pk_mul_f32 v[50:51], v[50:51], v[58:59]
    v_cvt_pk_bf16_f32 v16, v44, v45
    v_lshlrev_b32 v44, 16, v16
    v_and_b32 v45, 0xffff0000, v16
    v_cvt_pk_bf16_f32 v16, v46, v47
    v_lshlrev_b32 v46, 16, v16
    v_and_b32 v47, 0xffff0000, v16
    v_cvt_pk_bf16_f32 v16, v48, v49
    v_lshlrev_b32 v48, 16, v16
    v_and_b32 v49, 0xffff0000, v16
    v_cvt_pk_bf16_f32 v16, v50, v51
    v_lshlrev_b32 v50, 16, v16
    v_and_b32 v51, 0xffff0000, v16
    v_lshlrev_b32 v52, 16, v184
    v_and_b32 v53, 0xffff0000, v184
    v_lshlrev_b32 v54, 16, v185
    v_and_b32 v55, 0xffff0000, v185
    v_lshlrev_b32 v56, 16, v186
    v_and_b32 v57, 0xffff0000, v186
    v_lshlrev_b32 v58, 16, v187
    v_and_b32 v59, 0xffff0000, v187
    v_pk_add_f32 v[44:45], v[44:45], v[52:53]
    v_pk_add_f32 v[46:47], v[46:47], v[54:55]
    v_pk_add_f32 v[48:49], v[48:49], v[56:57]
    v_pk_add_f32 v[50:51], v[50:51], v[58:59]
    v_cvt_pk_bf16_f32 v16, v44, v45
    v_lshlrev_b32 v44, 16, v16
    v_and_b32 v45, 0xffff0000, v16
    v_cvt_pk_bf16_f32 v16, v46, v47
    v_lshlrev_b32 v46, 16, v16
    v_and_b32 v47, 0xffff0000, v16
    v_cvt_pk_bf16_f32 v16, v48, v49
    v_lshlrev_b32 v48, 16, v16
    v_and_b32 v49, 0xffff0000, v16
    v_cvt_pk_bf16_f32 v16, v50, v51
    v_lshlrev_b32 v50, 16, v16
    v_and_b32 v51, 0xffff0000, v16
    v_lshlrev_b32 v52, 16, v200
    v_and_b32 v53, 0xffff0000, v200
    v_lshlrev_b32 v54, 16, v201
    v_and_b32 v55, 0xffff0000, v201
    v_lshlrev_b32 v56, 16, v202
    v_and_b32 v57, 0xffff0000, v202
    v_lshlrev_b32 v58, 16, v203
    v_and_b32 v59, 0xffff0000, v203
    v_pk_mul_f32 v[44:45], v[44:45], v[52:53]
    v_pk_mul_f32 v[46:47], v[46:47], v[54:55]
    v_pk_mul_f32 v[48:49], v[48:49], v[56:57]
    v_pk_mul_f32 v[50:51], v[50:51], v[58:59]
    v_cvt_pk_bf16_f32 v16, v44, v45
    v_lshlrev_b32 v44, 16, v16
    v_and_b32 v45, 0xffff0000, v16
    v_cvt_pk_bf16_f32 v16, v46, v47
    v_lshlrev_b32 v46, 16, v16
    v_and_b32 v47, 0xffff0000, v16
    v_cvt_pk_bf16_f32 v16, v48, v49
    v_lshlrev_b32 v48, 16, v16
    v_and_b32 v49, 0xffff0000, v16
    v_cvt_pk_bf16_f32 v16, v50, v51
    v_lshlrev_b32 v50, 16, v16
    v_and_b32 v51, 0xffff0000, v16
    v_pk_add_f32 v[44:45], v[44:45], v[28:29]
    v_pk_add_f32 v[46:47], v[46:47], v[30:31]
    v_pk_add_f32 v[48:49], v[48:49], v[32:33]
    v_pk_add_f32 v[50:51], v[50:51], v[34:35]
    v_cvt_pk_bf16_f32 v28, v44, v45
    v_cvt_pk_bf16_f32 v29, v46, v47
    v_cvt_pk_bf16_f32 v30, v48, v49
    v_cvt_pk_bf16_f32 v31, v50, v51
    v_sub_f32 v44, v36, v96
    v_sub_f32 v45, v37, v96
    v_sub_f32 v46, v38, v96
    v_sub_f32 v47, v39, v96
    v_sub_f32 v48, v40, v96
    v_sub_f32 v49, v41, v96
    v_sub_f32 v50, v42, v96
    v_sub_f32 v51, v43, v96
    v_cvt_pk_bf16_f32 v16, v44, v45
    v_lshlrev_b32 v44, 16, v16
    v_and_b32 v45, 0xffff0000, v16
    v_cvt_pk_bf16_f32 v16, v46, v47
    v_lshlrev_b32 v46, 16, v16
    v_and_b32 v47, 0xffff0000, v16
    v_cvt_pk_bf16_f32 v16, v48, v49
    v_lshlrev_b32 v48, 16, v16
    v_and_b32 v49, 0xffff0000, v16
    v_cvt_pk_bf16_f32 v16, v50, v51
    v_lshlrev_b32 v50, 16, v16
    v_and_b32 v51, 0xffff0000, v16
    v_mul_f32 v52, v44, v99
    v_mul_f32 v53, v45, v99
    v_mul_f32 v54, v46, v99
    v_mul_f32 v55, v47, v99
    v_mul_f32 v56, v48, v99
    v_mul_f32 v57, v49, v99
    v_mul_f32 v58, v50, v99
    v_mul_f32 v59, v51, v99
    v_fma_f32 v44, -v52, v98, v44
    v_fma_f32 v45, -v53, v98, v45
    v_fma_f32 v46, -v54, v98, v46
    v_fma_f32 v47, -v55, v98, v47
    v_fma_f32 v48, -v56, v98, v48
    v_fma_f32 v49, -v57, v98, v49
    v_fma_f32 v50, -v58, v98, v50
    v_fma_f32 v51, -v59, v98, v51
    v_fma_f32 v44, v44, v99, v52
    v_fma_f32 v45, v45, v99, v53
    v_fma_f32 v46, v46, v99, v54
    v_fma_f32 v47, v47, v99, v55
    v_fma_f32 v48, v48, v99, v56
    v_fma_f32 v49, v49, v99, v57
    v_fma_f32 v50, v50, v99, v58
    v_fma_f32 v51, v51, v99, v59
    v_cvt_pk_bf16_f32 v16, v44, v45
    v_lshlrev_b32 v44, 16, v16
    v_and_b32 v45, 0xffff0000, v16
    v_cvt_pk_bf16_f32 v16, v46, v47
    v_lshlrev_b32 v46, 16, v16
    v_and_b32 v47, 0xffff0000, v16
    v_cvt_pk_bf16_f32 v16, v48, v49
    v_lshlrev_b32 v48, 16, v16
    v_and_b32 v49, 0xffff0000, v16
    v_cvt_pk_bf16_f32 v16, v50, v51
    v_lshlrev_b32 v50, 16, v16
    v_and_b32 v51, 0xffff0000, v16
    v_lshlrev_b32 v52, 16, v196
    v_and_b32 v53, 0xffff0000, v196
    v_lshlrev_b32 v54, 16, v197
    v_and_b32 v55, 0xffff0000, v197
    v_lshlrev_b32 v56, 16, v198
    v_and_b32 v57, 0xffff0000, v198
    v_lshlrev_b32 v58, 16, v199
    v_and_b32 v59, 0xffff0000, v199
    v_pk_mul_f32 v[44:45], v[44:45], v[52:53]
    v_pk_mul_f32 v[46:47], v[46:47], v[54:55]
    v_pk_mul_f32 v[48:49], v[48:49], v[56:57]
    v_pk_mul_f32 v[50:51], v[50:51], v[58:59]
    v_cvt_pk_bf16_f32 v16, v44, v45
    v_lshlrev_b32 v44, 16, v16
    v_and_b32 v45, 0xffff0000, v16
    v_cvt_pk_bf16_f32 v16, v46, v47
    v_lshlrev_b32 v46, 16, v16
    v_and_b32 v47, 0xffff0000, v16
    v_cvt_pk_bf16_f32 v16, v48, v49
    v_lshlrev_b32 v48, 16, v16
    v_and_b32 v49, 0xffff0000, v16
    v_cvt_pk_bf16_f32 v16, v50, v51
    v_lshlrev_b32 v50, 16, v16
    v_and_b32 v51, 0xffff0000, v16
    v_lshlrev_b32 v52, 16, v188
    v_and_b32 v53, 0xffff0000, v188
    v_lshlrev_b32 v54, 16, v189
    v_and_b32 v55, 0xffff0000, v189
    v_lshlrev_b32 v56, 16, v190
    v_and_b32 v57, 0xffff0000, v190
    v_lshlrev_b32 v58, 16, v191
    v_and_b32 v59, 0xffff0000, v191
    v_pk_add_f32 v[44:45], v[44:45], v[52:53]
    v_pk_add_f32 v[46:47], v[46:47], v[54:55]
    v_pk_add_f32 v[48:49], v[48:49], v[56:57]
    v_pk_add_f32 v[50:51], v[50:51], v[58:59]
    v_cvt_pk_bf16_f32 v16, v44, v45
    v_lshlrev_b32 v44, 16, v16
    v_and_b32 v45, 0xffff0000, v16
    v_cvt_pk_bf16_f32 v16, v46, v47
    v_lshlrev_b32 v46, 16, v16
    v_and_b32 v47, 0xffff0000, v16
    v_cvt_pk_bf16_f32 v16, v48, v49
    v_lshlrev_b32 v48, 16, v16
    v_and_b32 v49, 0xffff0000, v16
    v_cvt_pk_bf16_f32 v16, v50, v51
    v_lshlrev_b32 v50, 16, v16
    v_and_b32 v51, 0xffff0000, v16
    v_lshlrev_b32 v52, 16, v204
    v_and_b32 v53, 0xffff0000, v204
    v_lshlrev_b32 v54, 16, v205
    v_and_b32 v55, 0xffff0000, v205
    v_lshlrev_b32 v56, 16, v206
    v_and_b32 v57, 0xffff0000, v206
    v_lshlrev_b32 v58, 16, v207
    v_and_b32 v59, 0xffff0000, v207
    v_pk_mul_f32 v[44:45], v[44:45], v[52:53]
    v_pk_mul_f32 v[46:47], v[46:47], v[54:55]
    v_pk_mul_f32 v[48:49], v[48:49], v[56:57]
    v_pk_mul_f32 v[50:51], v[50:51], v[58:59]
    v_cvt_pk_bf16_f32 v16, v44, v45
    v_lshlrev_b32 v44, 16, v16
    v_and_b32 v45, 0xffff0000, v16
    v_cvt_pk_bf16_f32 v16, v46, v47
    v_lshlrev_b32 v46, 16, v16
    v_and_b32 v47, 0xffff0000, v16
    v_cvt_pk_bf16_f32 v16, v48, v49
    v_lshlrev_b32 v48, 16, v16
    v_and_b32 v49, 0xffff0000, v16
    v_cvt_pk_bf16_f32 v16, v50, v51
    v_lshlrev_b32 v50, 16, v16
    v_and_b32 v51, 0xffff0000, v16
    v_pk_add_f32 v[44:45], v[44:45], v[36:37]
    v_pk_add_f32 v[46:47], v[46:47], v[38:39]
    v_pk_add_f32 v[48:49], v[48:49], v[40:41]
    v_pk_add_f32 v[50:51], v[50:51], v[42:43]
    v_cvt_pk_bf16_f32 v36, v44, v45
    v_cvt_pk_bf16_f32 v37, v46, v47
    v_cvt_pk_bf16_f32 v38, v48, v49
    v_cvt_pk_bf16_f32 v39, v50, v51
    s_barrier
    v_and_b32 v16, 3, v1
    v_lshlrev_b32 v16, 4, v16
    v_add_u32 v16, 65792, v16
    ds_read_b32 v76, v16
    s_waitcnt lgkmcnt(0)
    v_mov_b32 v77, v76
    s_nop 1
    v_max_u32_dpp v77, v77, v77 row_ror:1 row_mask:0xf bank_mask:0xf
    s_nop 1
    v_max_u32_dpp v77, v77, v77 row_ror:2 row_mask:0xf bank_mask:0xf
    v_cmp_eq_u32 vcc, v76, v77
    s_ff1_i32_b64 s16, vcc
    s_lshl_b32 s16, s16, 4
    s_add_u32 s16, s16, 65792
    v_mov_b32 v16, s16
    ds_read_b128 v[24:27], v16
    s_waitcnt lgkmcnt(0)
    v_and_b32 v76, 0x7ff, v24
    v_sub_u32 v76, 2047, v76
    s_nop 0
    v_readfirstlane_b32 s12, v76
    v_rcp_f32 v103, v26
    s_lshr_b32 s18, s12, 4
    s_lshl_b32 s18, s18, 15
    s_and_b32 s19, s12, 15
    s_lshl_b32 s19, s19, 6
    s_add_u32 s18, s18, s19
    s_add_u32 s18, s18, 0x2000000
    s_add_u32 s19, s18, 0x400000
    v_lshrrev_b32 v18, 4, v0
    v_lshlrev_b32 v18, 10, v18
    v_and_b32 v19, 15, v0
    v_lshl_add_u32 v18, v19, 2, v18
    s_lshl_b32 s13, s12, 11
    buffer_load_dword v100, v18, s[8:11], s18 offen sc1
    buffer_load_dword v101, v18, s[8:11], s19 offen sc1
    buffer_load_dword v102, v21, s[76:79], s13 offen
    s_lshl_b32 s16, s14, 11
    s_cmp_lg_u32 s12, s14
    s_cselect_b32 s16, s16, 0x7ffffff0
    buffer_store_dwordx4 v[28:31], v2, s[68:71], s16 offen offset:0 sc1
    buffer_store_dwordx4 v[36:39], v2, s[68:71], s16 offen offset:1024 sc1
    s_lshl_b32 s16, s3, 13
    v_add_u32 v20, s16, v2
    s_waitcnt vmcnt(4)
    v_lshlrev_b32 v76, 16, v100
    v_and_b32 v77, 0xffff0000, v100
    s_waitcnt vmcnt(3)
    v_lshlrev_b32 v78, 16, v101
    v_and_b32 v79, 0xffff0000, v101
    v_pk_add_f32 v[76:77], v[76:77], v[78:79]
    s_waitcnt vmcnt(2)
    v_lshlrev_b32 v78, 16, v102
    v_and_b32 v79, 0xffff0000, v102
    v_pk_add_f32 v[92:93], v[78:79], v[76:77]
    v_cvt_pk_bf16_f32 v76, v92, v93
    v_lshlrev_b32 v92, 16, v76
    v_and_b32 v93, 0xffff0000, v76
    v_cvt_pk_bf16_f32 v100, v92, v93
    v_and_b32 v105, 0xffff0000, v104
    v_lshlrev_b32 v104, 16, v104
    v_and_b32 v107, 0xffff0000, v106
    v_lshlrev_b32 v106, 16, v106
    v_sub_f32 v92, v92, v25
    v_sub_f32 v93, v93, v25
    v_cvt_pk_bf16_f32 v76, v92, v93
    v_lshlrev_b32 v92, 16, v76
    v_and_b32 v93, 0xffff0000, v76
    v_mul_f32 v77, v92, v103
    v_fma_f32 v92, -v77, v26, v92
    v_fma_f32 v92, v92, v103, v77
    v_mul_f32 v77, v93, v103
    v_fma_f32 v93, -v77, v26, v93
    v_fma_f32 v93, v93, v103, v77
    v_cvt_pk_bf16_f32 v76, v92, v93
    v_lshlrev_b32 v92, 16, v76
    v_and_b32 v93, 0xffff0000, v76
    v_mul_f32 v92, v92, v104
    v_mul_f32 v93, v93, v105
    v_cvt_pk_bf16_f32 v76, v92, v93
    v_lshlrev_b32 v92, 16, v76
    v_and_b32 v93, 0xffff0000, v76
    v_add_f32 v92, v92, v106
    v_add_f32 v93, v93, v107
    v_cvt_pk_bf16_f32 v101, v92, v93
    v_add_u32 v16, 66560, v21
    ds_write_b32 v16, v101
    ds_write_b32 v16, v100 offset:2048
    s_waitcnt lgkmcnt(0)
    s_barrier
    ds_read_b128 v[60:63], v20 offset:0
    ds_read_b128 v[64:67], v20 offset:1024
    ds_read_b128 v[68:71], v20 offset:2048
    ds_read_b128 v[72:75], v20 offset:3072
    ds_read_b128 v[108:111], v20 offset:4096
    ds_read_b128 v[112:115], v20 offset:5120
    ds_read_b128 v[116:119], v20 offset:6144
    ds_read_b128 v[120:123], v20 offset:7168
    s_and_b32 s16, s3, 3
    s_lshl_b32 s16, s16, 7
    s_and_b32 s17, s29, 3
    s_lshl_b32 s17, s17, 9
    s_add_u32 s16, s16, s17
    s_add_u32 s16, s16, 66560
    v_lshrrev_b32 v16, 3, v1
    v_lshlrev_b32 v16, 4, v16
    v_add_u32 v16, s16, v16
    ds_read_b128 v[104:107], v16
    s_waitcnt lgkmcnt(0)
    v_lshlrev_b32 v76, 16, v104
    v_and_b32 v77, 0xffff, v104
    v_dot2_f32_bf16 v85, v60, v76, 0
    v_dot2_f32_bf16 v84, v60, v77, 0
    v_dot2_f32_bf16 v87, v61, v76, 0
    v_dot2_f32_bf16 v86, v61, v77, 0
    v_dot2_f32_bf16 v89, v62, v76, 0
    v_dot2_f32_bf16 v88, v62, v77, 0
    v_dot2_f32_bf16 v91, v63, v76, 0
    v_dot2_f32_bf16 v90, v63, v77, 0
    v_and_b32 v78, 0xffff0000, v104
    v_lshrrev_b32 v79, 16, v104
    v_dot2c_f32_bf16 v85, v64, v78
    v_dot2c_f32_bf16 v84, v64, v79
    v_dot2c_f32_bf16 v87, v65, v78
    v_dot2c_f32_bf16 v86, v65, v79
    v_dot2c_f32_bf16 v89, v66, v78
    v_dot2c_f32_bf16 v88, v66, v79
    v_dot2c_f32_bf16 v91, v67, v78
    v_dot2c_f32_bf16 v90, v67, v79
    v_lshlrev_b32 v80, 16, v105
    v_and_b32 v81, 0xffff, v105
    v_dot2c_f32_bf16 v85, v68, v80
    v_dot2c_f32_bf16 v84, v68, v81
    v_dot2c_f32_bf16 v87, v69, v80
    v_dot2c_f32_bf16 v86, v69, v81
    v_dot2c_f32_bf16 v89, v70, v80
    v_dot2c_f32_bf16 v88, v70, v81
    v_dot2c_f32_bf16 v91, v71, v80
    v_dot2c_f32_bf16 v90, v71, v81
    v_and_b32 v82, 0xffff0000, v105
    v_lshrrev_b32 v83, 16, v105
    v_dot2c_f32_bf16 v85, v72, v82
    v_dot2c_f32_bf16 v84, v72, v83
    v_dot2c_f32_bf16 v87, v73, v82
    v_dot2c_f32_bf16 v86, v73, v83
    v_dot2c_f32_bf16 v89, v74, v82
    v_dot2c_f32_bf16 v88, v74, v83
    v_dot2c_f32_bf16 v91, v75, v82
    v_dot2c_f32_bf16 v90, v75, v83
    v_lshlrev_b32 v76, 16, v106
    v_and_b32 v77, 0xffff, v106
    v_dot2c_f32_bf16 v85, v108, v76
    v_dot2c_f32_bf16 v84, v108, v77
    v_dot2c_f32_bf16 v87, v109, v76
    v_dot2c_f32_bf16 v86, v109, v77
    v_dot2c_f32_bf16 v89, v110, v76
    v_dot2c_f32_bf16 v88, v110, v77
    v_dot2c_f32_bf16 v91, v111, v76
    v_dot2c_f32_bf16 v90, v111, v77
    v_and_b32 v78, 0xffff0000, v106
    v_lshrrev_b32 v79, 16, v106
    v_dot2c_f32_bf16 v85, v112, v78
    v_dot2c_f32_bf16 v84, v112, v79
    v_dot2c_f32_bf16 v87, v113, v78
    v_dot2c_f32_bf16 v86, v113, v79
    v_dot2c_f32_bf16 v89, v114, v78
    v_dot2c_f32_bf16 v88, v114, v79
    v_dot2c_f32_bf16 v91, v115, v78
    v_dot2c_f32_bf16 v90, v115, v79
    v_lshlrev_b32 v80, 16, v107
    v_and_b32 v81, 0xffff, v107
    v_dot2c_f32_bf16 v85, v116, v80
    v_dot2c_f32_bf16 v84, v116, v81
    v_dot2c_f32_bf16 v87, v117, v80
    v_dot2c_f32_bf16 v86, v117, v81
    v_dot2c_f32_bf16 v89, v118, v80
    v_dot2c_f32_bf16 v88, v118, v81
    v_dot2c_f32_bf16 v91, v119, v80
    v_dot2c_f32_bf16 v90, v119, v81
    v_and_b32 v82, 0xffff0000, v107
    v_lshrrev_b32 v83, 16, v107
    v_dot2c_f32_bf16 v85, v120, v82
    v_dot2c_f32_bf16 v84, v120, v83
    v_dot2c_f32_bf16 v87, v121, v82
    v_dot2c_f32_bf16 v86, v121, v83
    v_dot2c_f32_bf16 v89, v122, v82
    v_dot2c_f32_bf16 v88, v122, v83
    v_dot2c_f32_bf16 v91, v123, v82
    v_dot2c_f32_bf16 v90, v123, v83
    s_nop 0
    v_permlane32_swap_b32 v84, v88
    v_permlane32_swap_b32 v85, v89
    v_permlane32_swap_b32 v86, v90
    v_permlane32_swap_b32 v87, v91
    v_add_f32 v84, v84, v88
    v_add_f32 v85, v85, v89
    v_add_f32 v86, v86, v90
    v_add_f32 v87, v87, v91
    s_nop 0
    v_permlane16_swap_b32 v84, v86
    v_permlane16_swap_b32 v85, v87
    v_add_f32 v84, v84, v86
    v_add_f32 v85, v85, v87
    s_nop 0
    v_add_f32_dpp v84, v84, v84 row_ror:8 row_mask:0xf bank_mask:0xf
    v_add_f32_dpp v85, v85, v85 row_ror:8 row_mask:0xf bank_mask:0xf
    v_and_b32 v16, 7, v1
    v_lshlrev_b32 v16, 5, v16
    v_lshrrev_b32 v17, 4, v1
    v_lshl_add_u32 v16, v17, 3, v16
    s_lshl_b32 s16, s3, 8
    s_add_u32 s16, s16, 70656
    v_add_u32 v16, s16, v16
    ds_write_b64 v16, v[84:85]
    s_lshr_b32 s16, s3, 2
    s_lshl_b32 s17, s16, 10
    s_add_u32 s17, s17, 70656
    v_lshlrev_b32 v17, 2, v1
    v_add_u32 v16, s17, v17
    s_and_b32 s17, s29, 3
    s_lshl_b32 s17, s17, 1
    s_add_u32 s17, s17, s16
    s_mul_i32 s17, s17, 14336
    s_lshr_b32 s16, s29, 2
    s_lshl_b32 s16, s16, 8
    s_add_u32 s17, s17, s16
    s_add_u32 s17, s17, 0x6e1000
    s_and_b32 s16, s3, 3
    s_cmp_eq_u32 s16, 0
    s_cselect_b32 s17, s17, 0x7ffffff0
    s_cmp_lt_u32 s2, 224
    s_cselect_b32 s17, s17, 0x7ffffff0
    s_waitcnt lgkmcnt(0)
    s_barrier
    ds_read_b32 v84, v16 offset:0
    ds_read_b32 v85, v16 offset:256
    ds_read_b32 v86, v16 offset:512
    ds_read_b32 v87, v16 offset:768
    s_waitcnt lgkmcnt(2)
    v_add_f32 v84, v84, v85
    s_waitcnt lgkmcnt(0)
    v_add_f32 v86, v86, v87
    v_add_f32 v84, v84, v86
    v_or_b32 v84, 1, v84
    buffer_store_dword v84, v17, s[8:11], s17 offen sc1
    v_lshrrev_b32 v16, 4, v1
    v_mul_u32_u24 v16, 28672, v16
    v_and_b32 v17, 15, v1
    v_lshl_add_u32 v16, v17, 2, v16
    s_lshl_b32 s16, s29, 6
    s_add_u32 s16, s16, 0x6e1000
    s_add_u32 s17, s16, 14336
    s_mov_b32 s27, 0
adaLN_cond__sliding_block_cached__moe_arch_mod__prompt_kernel_gu23p:
    buffer_load_dword v84, v16, s[8:11], s16 offen sc1
    buffer_load_dword v85, v16, s[8:11], s17 offen sc1
    s_waitcnt vmcnt(0)
    v_min_u32 v86, v84, v85
    v_cmp_eq_u32 vcc, 0, v86
    s_cmp_lt_u32 s2, 224
    s_cselect_b64 s[62:63], -1, 0
    s_and_b64 vcc, vcc, s[62:63]
    s_add_u32 s27, s27, 1
    s_cmp_ge_u32 s27, 65536
    s_cbranch_scc1 adaLN_cond__sliding_block_cached__moe_arch_mod__prompt_kernel_gu23g
    s_cbranch_vccnz adaLN_cond__sliding_block_cached__moe_arch_mod__prompt_kernel_gu23p
adaLN_cond__sliding_block_cached__moe_arch_mod__prompt_kernel_gu23g:
    v_mov_b32 v86, v84
    s_nop 1
    v_permlane16_swap_b32 v84, v86
    v_add_f32 v84, v84, v86
    v_mov_b32 v87, v85
    s_nop 1
    v_permlane16_swap_b32 v85, v87
    v_add_f32 v85, v85, v87
    v_mov_b32 v86, v84
    s_nop 1
    v_permlane32_swap_b32 v84, v86
    v_add_f32 v84, v84, v86
    v_mov_b32 v87, v85
    s_nop 1
    v_permlane32_swap_b32 v85, v87
    v_add_f32 v85, v85, v87
    v_cvt_pk_bf16_f32 v86, v84, v85
    v_lshlrev_b32 v84, 16, v86
    v_and_b32 v85, 0xffff0000, v86
    v_mul_f32 v86, 0xbfb8aa3b, v84
    v_exp_f32 v86, v86
    s_nop 0
    v_add_f32 v86, 1.0, v86
    v_rcp_f32 v86, v86
    s_nop 0
    v_mul_f32 v84, v84, v86
    v_cvt_pk_bf16_f32 v84, v84, v84
    v_lshlrev_b32 v84, 16, v84
    v_mul_f32 v84, v84, v85
    v_cvt_pk_bf16_f32 v84, v84, v84
    v_lshlrev_b32 v84, 16, v84
    s_sub_u32 s16, s3, 4
    s_lshl_b32 s16, s16, 2
    s_add_u32 s17, s16, 0
    v_readlane_b32 s20, v84, s17
    s_lshr_b32 s4, s20, 16
    s_add_u32 s17, s16, 1
    v_readlane_b32 s21, v84, s17
    s_lshr_b32 s5, s21, 16
    s_add_u32 s17, s16, 2
    v_readlane_b32 s22, v84, s17
    s_lshr_b32 s6, s22, 16
    s_add_u32 s17, s16, 3
    v_readlane_b32 s23, v84, s17
    s_lshr_b32 s7, s23, 16
    v_dot2_f32_bf16 v45, v152, s20, 0
    v_dot2_f32_bf16 v44, v152, s4, 0
    v_dot2_f32_bf16 v47, v153, s20, 0
    v_dot2_f32_bf16 v46, v153, s4, 0
    v_dot2_f32_bf16 v49, v154, s20, 0
    v_dot2_f32_bf16 v48, v154, s4, 0
    v_dot2_f32_bf16 v51, v155, s20, 0
    v_dot2_f32_bf16 v50, v155, s4, 0
    v_dot2_f32_bf16 v53, v156, s20, 0
    v_dot2_f32_bf16 v52, v156, s4, 0
    v_dot2_f32_bf16 v55, v157, s20, 0
    v_dot2_f32_bf16 v54, v157, s4, 0
    v_dot2_f32_bf16 v57, v158, s20, 0
    v_dot2_f32_bf16 v56, v158, s4, 0
    v_dot2_f32_bf16 v59, v159, s20, 0
    v_dot2_f32_bf16 v58, v159, s4, 0
    v_dot2c_f32_bf16 v45, s21, v160
    v_dot2c_f32_bf16 v44, s5, v160
    v_dot2c_f32_bf16 v47, s21, v161
    v_dot2c_f32_bf16 v46, s5, v161
    v_dot2c_f32_bf16 v49, s21, v162
    v_dot2c_f32_bf16 v48, s5, v162
    v_dot2c_f32_bf16 v51, s21, v163
    v_dot2c_f32_bf16 v50, s5, v163
    v_dot2c_f32_bf16 v53, s21, v164
    v_dot2c_f32_bf16 v52, s5, v164
    v_dot2c_f32_bf16 v55, s21, v165
    v_dot2c_f32_bf16 v54, s5, v165
    v_dot2c_f32_bf16 v57, s21, v166
    v_dot2c_f32_bf16 v56, s5, v166
    v_dot2c_f32_bf16 v59, s21, v167
    v_dot2c_f32_bf16 v58, s5, v167
    v_dot2c_f32_bf16 v45, s22, v168
    v_dot2c_f32_bf16 v44, s6, v168
    v_dot2c_f32_bf16 v47, s22, v169
    v_dot2c_f32_bf16 v46, s6, v169
    v_dot2c_f32_bf16 v49, s22, v170
    v_dot2c_f32_bf16 v48, s6, v170
    v_dot2c_f32_bf16 v51, s22, v171
    v_dot2c_f32_bf16 v50, s6, v171
    v_dot2c_f32_bf16 v53, s22, v172
    v_dot2c_f32_bf16 v52, s6, v172
    v_dot2c_f32_bf16 v55, s22, v173
    v_dot2c_f32_bf16 v54, s6, v173
    v_dot2c_f32_bf16 v57, s22, v174
    v_dot2c_f32_bf16 v56, s6, v174
    v_dot2c_f32_bf16 v59, s22, v175
    v_dot2c_f32_bf16 v58, s6, v175
    v_dot2c_f32_bf16 v45, s23, v176
    v_dot2c_f32_bf16 v44, s7, v176
    v_dot2c_f32_bf16 v47, s23, v177
    v_dot2c_f32_bf16 v46, s7, v177
    v_dot2c_f32_bf16 v49, s23, v178
    v_dot2c_f32_bf16 v48, s7, v178
    v_dot2c_f32_bf16 v51, s23, v179
    v_dot2c_f32_bf16 v50, s7, v179
    v_dot2c_f32_bf16 v53, s23, v180
    v_dot2c_f32_bf16 v52, s7, v180
    v_dot2c_f32_bf16 v55, s23, v181
    v_dot2c_f32_bf16 v54, s7, v181
    v_dot2c_f32_bf16 v57, s23, v182
    v_dot2c_f32_bf16 v56, s7, v182
    v_dot2c_f32_bf16 v59, s23, v183
    v_dot2c_f32_bf16 v58, s7, v183
    s_sub_u32 s16, s3, 4
    s_lshl_b32 s16, s16, 12
    s_add_u32 s16, s16, 73728
    v_lshlrev_b32 v16, 5, v1
    v_add_u32 v16, s16, v16
    ds_write_b128 v16, v[44:47] offset:0
    ds_write_b128 v16, v[48:51] offset:16
    ds_write_b128 v16, v[52:55] offset:2048
    ds_write_b128 v16, v[56:59] offset:2064
    s_waitcnt lgkmcnt(0)
    s_barrier
    v_lshlrev_b32 v16, 3, v0
    v_add_u32 v17, 73728, v16
    ds_read_b64 v[84:85], v17 offset:0
    ds_read_b64 v[86:87], v17 offset:4096
    ds_read_b64 v[88:89], v17 offset:8192
    ds_read_b64 v[90:91], v17 offset:12288
    s_waitcnt lgkmcnt(2)
    v_pk_add_f32 v[84:85], v[84:85], v[86:87]
    s_waitcnt lgkmcnt(0)
    v_pk_add_f32 v[88:89], v[88:89], v[90:91]
    v_pk_add_f32 v[84:85], v[84:85], v[88:89]
    v_or_b32 v84, 1, v84
    v_or_b32 v85, 1, v85
    s_lshl_b32 s16, s29, 12
    s_add_u32 s16, s16, 0x600000
    s_cmp_lt_u32 s2, 224
    s_cselect_b32 s16, s16, 0x7ffffff0
    buffer_store_dwordx2 v[84:85], v16, s[8:11], s16 offen sc1
    s_cmp_lt_u32 s2, 224
    s_cbranch_scc1 adaLN_cond__sliding_block_cached__moe_arch_mod__prompt_kernel_end
    s_sub_u32 s16, s2, 224
    s_lshl_b32 s17, s16, 7
    s_add_u32 s17, s17, 0x600000
    v_lshrrev_b32 v16, 3, v0
    v_lshlrev_b32 v16, 12, v16
    v_and_b32 v17, 7, v0
    v_lshl_add_u32 v16, v17, 4, v16
    v_cmp_gt_u32 vcc, 256, v0
    v_bfrev_b32 v17, -2
    s_nop 0
    v_cndmask_b32 v17, v17, v16, vcc
    v_mov_b32 v19, 0
    v_cndmask_b32 v18, 1, v19, vcc
    s_lshl_b32 s18, s16, 6
    v_and_b32 v19, 31, v1
    v_lshlrev_b32 v19, 1, v19
    v_add_u32 v19, s18, v19
    s_mov_b32 s19, 0x541800
    buffer_load_ushort v95, v19, s[8:11], s19 offen sc1
    v_add_u32 v20, 66560, v19
    ds_read_u16 v96, v20
    ds_read_u16 v97, v20 offset:2048
    v_mov_b32 v94, v27
    v_cvt_pk_bf16_f32 v94, v94, v94
    v_lshlrev_b32 v94, 16, v94
    v_mul_f32 v94, 0xbfb8aa3b, v94
    v_exp_f32 v94, v94
    s_nop 0
    v_add_f32 v94, 1.0, v94
    v_rcp_f32 v94, v94
    s_nop 0
    v_cvt_pk_bf16_f32 v94, v94, v94
    v_lshlrev_b32 v94, 16, v94
    s_waitcnt vmcnt(0)
    v_lshlrev_b32 v95, 16, v95
    s_waitcnt lgkmcnt(1)
    v_lshlrev_b32 v96, 16, v96
    s_waitcnt lgkmcnt(0)
    v_lshlrev_b32 v97, 16, v97
    s_mov_b32 s27, 0
adaLN_cond__sliding_block_cached__moe_arch_mod__prompt_kernel_y24p:
    s_add_u32 s19, s17, 0x0
    buffer_load_dwordx4 v[44:47], v16, s[8:11], s19 offen sc1
    s_add_u32 s19, s17, 0x40000
    buffer_load_dwordx4 v[48:51], v16, s[8:11], s19 offen sc1
    s_add_u32 s19, s17, 0x80000
    buffer_load_dwordx4 v[52:55], v16, s[8:11], s19 offen sc1
    s_add_u32 s19, s17, 0xc0000
    buffer_load_dwordx4 v[56:59], v17, s[8:11], s19 offen sc1
    s_waitcnt vmcnt(0)
    v_min3_u32 v98, v56, v57, v58
    v_min_u32 v98, v98, v59
    v_or_b32 v98, v98, v18
    v_min3_u32 v98, v98, v44, v45
    v_min3_u32 v98, v98, v46, v47
    v_min3_u32 v98, v98, v48, v49
    v_min3_u32 v98, v98, v50, v51
    v_min3_u32 v98, v98, v52, v53
    v_min3_u32 v98, v98, v54, v55
    v_cmp_eq_u32 vcc, 0, v98
    s_add_u32 s27, s27, 1
    s_cmp_ge_u32 s27, 65536
    s_cbranch_scc1 adaLN_cond__sliding_block_cached__moe_arch_mod__prompt_kernel_y24g
    s_cbranch_vccnz adaLN_cond__sliding_block_cached__moe_arch_mod__prompt_kernel_y24p
adaLN_cond__sliding_block_cached__moe_arch_mod__prompt_kernel_y24g:
    v_pk_add_f32 v[44:45], v[44:45], v[52:53]
    v_pk_add_f32 v[46:47], v[46:47], v[54:55]
    v_pk_add_f32 v[48:49], v[48:49], v[56:57]
    v_pk_add_f32 v[50:51], v[50:51], v[58:59]
    v_pk_add_f32 v[44:45], v[44:45], v[48:49]
    v_pk_add_f32 v[46:47], v[46:47], v[50:51]
    s_nop 0
    v_add_f32_dpp v44, v44, v44 row_ror:8 row_mask:0xf bank_mask:0xf
    v_add_f32_dpp v45, v45, v45 row_ror:8 row_mask:0xf bank_mask:0xf
    v_add_f32_dpp v46, v46, v46 row_ror:8 row_mask:0xf bank_mask:0xf
    v_add_f32_dpp v47, v47, v47 row_ror:8 row_mask:0xf bank_mask:0xf
    s_nop 0
    v_permlane32_swap_b32 v44, v46
    v_permlane32_swap_b32 v45, v47
    v_add_f32 v44, v44, v46
    v_add_f32 v45, v45, v47
    s_nop 1
    v_permlane16_swap_b32 v44, v45
    v_add_f32 v44, v44, v45
    v_and_b32 v16, 7, v1
    v_lshlrev_b32 v16, 4, v16
    v_lshrrev_b32 v17, 4, v1
    v_lshl_add_u32 v16, v17, 2, v16
    s_lshl_b32 s19, s3, 7
    s_add_u32 s19, s19, 91136
    v_add_u32 v16, s19, v16
    ds_write_b32 v16, v44
    v_and_b32 v16, 31, v1
    v_lshlrev_b32 v16, 2, v16
    v_add_u32 v16, 91136, v16
    s_waitcnt lgkmcnt(0)
    s_barrier
    s_cmp_lg_u32 s3, 0
    s_cbranch_scc1 adaLN_cond__sliding_block_cached__moe_arch_mod__prompt_kernel_end
    ds_read_b32 v44, v16 offset:0
    ds_read_b32 v45, v16 offset:128
    ds_read_b32 v46, v16 offset:256
    ds_read_b32 v47, v16 offset:384
    ds_read_b32 v48, v16 offset:512
    ds_read_b32 v49, v16 offset:640
    ds_read_b32 v50, v16 offset:768
    ds_read_b32 v51, v16 offset:896
    s_waitcnt lgkmcnt(3)
    v_add_f32 v44, v44, v48
    s_waitcnt lgkmcnt(2)
    v_add_f32 v45, v45, v49
    s_waitcnt lgkmcnt(1)
    v_add_f32 v46, v46, v50
    s_waitcnt lgkmcnt(0)
    v_add_f32 v47, v47, v51
    v_add_f32 v44, v44, v46
    v_add_f32 v45, v45, v47
    v_add_f32 v44, v44, v45
    v_cvt_pk_bf16_f32 v44, v44, v44
    v_lshlrev_b32 v44, 16, v44
    v_mul_f32 v44, v44, v94
    v_cvt_pk_bf16_f32 v44, v44, v44
    v_lshlrev_b32 v44, 16, v44
    v_add_f32 v44, v44, v96
    v_cvt_pk_bf16_f32 v44, v44, v44
    v_lshlrev_b32 v44, 16, v44
    v_mul_f32 v44, v44, v95
    v_cvt_pk_bf16_f32 v44, v44, v44
    v_lshlrev_b32 v44, 16, v44
    v_add_f32 v44, v44, v97
    v_cvt_pk_bf16_f32 v44, v44, v44
    s_mov_b64 exec, 0xffffffff
    buffer_store_short v44, v19, s[68:71], s13 offen sc1
adaLN_cond__sliding_block_cached__moe_arch_mod__prompt_kernel_end:
    s_endpgm
adaLN_cond__sliding_block_cached__moe_arch_mod__prompt_kernel_n1r:
    s_mov_b32 s27, 0
adaLN_cond__sliding_block_cached__moe_arch_mod__prompt_kernel_n1p:
    buffer_load_dword v134, v132, s[64:67], 0 offen sc1
    s_waitcnt vmcnt(0)
    v_cmp_eq_u32 vcc, 0, v134
    s_cmp_eq_u32 s3, 0
    s_cselect_b64 s[62:63], -1, 0
    s_and_b64 vcc, vcc, s[62:63]
    s_add_u32 s27, s27, 1
    s_cmp_ge_u32 s27, 65536
    s_cbranch_scc1 adaLN_cond__sliding_block_cached__moe_arch_mod__prompt_kernel_n1g
    s_cbranch_vccnz adaLN_cond__sliding_block_cached__moe_arch_mod__prompt_kernel_n1p
adaLN_cond__sliding_block_cached__moe_arch_mod__prompt_kernel_n1g:
    s_waitcnt vmcnt(0) lgkmcnt(0)
    s_nop 15
    s_nop 3
    s_branch adaLN_cond__sliding_block_cached__moe_arch_mod__prompt_kernel_n1b
adaLN_cond__sliding_block_cached__moe_arch_mod__prompt_kernel_kv4r:
    s_waitcnt vmcnt(0) lgkmcnt(0)
    s_nop 15
    s_nop 3
    s_mov_b32 s27, 0
adaLN_cond__sliding_block_cached__moe_arch_mod__prompt_kernel_kv4p:
    buffer_load_dwordx4 v[12:15], v21, s[8:11], s18 offen sc1
    s_waitcnt vmcnt(0)
    v_xor_b32 v8, s28, v12
    v_xor_b32 v20, s28, v13
    v_or_b32 v8, v8, v20
    v_xor_b32 v20, s28, v14
    v_or_b32 v8, v8, v20
    v_xor_b32 v20, s28, v15
    v_or_b32 v8, v8, v20
    v_cmp_ne_u32 vcc, 0, v8
    s_add_u32 s27, s27, 1
    s_cmp_ge_u32 s27, 65536
    s_cbranch_scc1 adaLN_cond__sliding_block_cached__moe_arch_mod__prompt_kernel_kv4g
    s_cbranch_vccnz adaLN_cond__sliding_block_cached__moe_arch_mod__prompt_kernel_kv4p
adaLN_cond__sliding_block_cached__moe_arch_mod__prompt_kernel_kv4g:
    s_waitcnt vmcnt(0) lgkmcnt(0)
    s_nop 15
    s_nop 3
    s_branch adaLN_cond__sliding_block_cached__moe_arch_mod__prompt_kernel_kv4b
adaLN_cond__sliding_block_cached__moe_arch_mod__prompt_kernel_fixA:
    s_waitcnt vmcnt(0) lgkmcnt(0)
    s_nop 15
    s_nop 3
    s_lshr_b32 s16, s12, 3
    s_lshl_b32 s16, s16, 17
    s_add_u32 s16, s16, 0x400000
    v_add_u32 v8, s16, v2
    v_mov_b32 v16, 0xff7fffff
    v_mov_b32 v17, 0xff7fffff
    s_mov_b32 s16, 0
adaLN_cond__sliding_block_cached__moe_arch_mod__prompt_kernel_fixAm:
    s_add_u32 s17, s16, 0
    buffer_load_dwordx4 v[200:203], v8, s[8:11], s17 offen offset:0
    buffer_load_dwordx4 v[204:207], v8, s[8:11], s17 offen offset:1024
    buffer_load_dwordx4 v[208:211], v8, s[8:11], s17 offen offset:2048
    buffer_load_dwordx4 v[212:215], v8, s[8:11], s17 offen offset:3072
    s_waitcnt vmcnt(3)
    v_mfma_f32_16x16x32_bf16 v[184:187], v[200:203], v[152:155], 0
    v_mfma_f32_16x16x32_bf16 v[188:191], v[200:203], v[168:171], 0
    s_waitcnt vmcnt(2)
    v_mfma_f32_16x16x32_bf16 v[192:195], v[204:207], v[152:155], 0
    v_mfma_f32_16x16x32_bf16 v[196:199], v[204:207], v[168:171], 0
    s_waitcnt vmcnt(1)
    v_mfma_f32_16x16x32_bf16 v[184:187], v[208:211], v[156:159], v[184:187]
    v_mfma_f32_16x16x32_bf16 v[188:191], v[208:211], v[172:175], v[188:191]
    s_waitcnt vmcnt(0)
    v_mfma_f32_16x16x32_bf16 v[192:195], v[212:215], v[156:159], v[192:195]
    v_mfma_f32_16x16x32_bf16 v[196:199], v[212:215], v[172:175], v[196:199]
    s_add_u32 s17, s16, 4096
    buffer_load_dwordx4 v[200:203], v8, s[8:11], s17 offen offset:0
    buffer_load_dwordx4 v[204:207], v8, s[8:11], s17 offen offset:1024
    buffer_load_dwordx4 v[208:211], v8, s[8:11], s17 offen offset:2048
    buffer_load_dwordx4 v[212:215], v8, s[8:11], s17 offen offset:3072
    s_waitcnt vmcnt(3)
    v_mfma_f32_16x16x32_bf16 v[184:187], v[200:203], v[160:163], v[184:187]
    v_mfma_f32_16x16x32_bf16 v[188:191], v[200:203], v[176:179], v[188:191]
    s_waitcnt vmcnt(2)
    v_mfma_f32_16x16x32_bf16 v[192:195], v[204:207], v[160:163], v[192:195]
    v_mfma_f32_16x16x32_bf16 v[196:199], v[204:207], v[176:179], v[196:199]
    s_waitcnt vmcnt(1)
    v_mfma_f32_16x16x32_bf16 v[184:187], v[208:211], v[164:167], v[184:187]
    v_mfma_f32_16x16x32_bf16 v[188:191], v[208:211], v[180:183], v[188:191]
    s_waitcnt vmcnt(0)
    v_mfma_f32_16x16x32_bf16 v[192:195], v[212:215], v[164:167], v[192:195]
    v_mfma_f32_16x16x32_bf16 v[196:199], v[212:215], v[180:183], v[196:199]
    s_nop 3
    v_max3_f32 v16, v16, v184, v185
    v_max3_f32 v16, v16, v186, v187
    v_max3_f32 v17, v17, v188, v189
    v_max3_f32 v17, v17, v190, v191
    v_max3_f32 v16, v16, v192, v193
    v_max3_f32 v16, v16, v194, v195
    v_max3_f32 v17, v17, v196, v197
    v_max3_f32 v17, v17, v198, v199
    s_add_u32 s16, s16, 8192
    s_cmp_lt_u32 s16, 0x20000
    s_cbranch_scc1 adaLN_cond__sliding_block_cached__moe_arch_mod__prompt_kernel_fixAm
    v_mov_b32 v18, v16
    v_mov_b32 v19, v17
    s_nop 0
    v_permlane16_swap_b32 v16, v18
    v_permlane16_swap_b32 v17, v19
    v_max_f32 v16, v16, v18
    v_max_f32 v17, v17, v19
    v_mov_b32 v18, v16
    v_mov_b32 v19, v17
    s_nop 0
    v_permlane32_swap_b32 v16, v18
    v_permlane32_swap_b32 v17, v19
    v_max_f32 v16, v16, v18
    v_max_f32 v17, v17, v19
    v_sub_f32 v216, 0, v16
    v_sub_f32 v217, 0, v16
    v_sub_f32 v218, 0, v16
    v_sub_f32 v219, 0, v16
    v_sub_f32 v220, 0, v17
    v_sub_f32 v221, 0, v17
    v_sub_f32 v222, 0, v17
    v_sub_f32 v223, 0, v17
    s_mov_b32 s17, 0x0
    buffer_load_dwordx4 v[200:203], v8, s[8:11], s17 offen offset:0
    buffer_load_dwordx4 v[204:207], v8, s[8:11], s17 offen offset:1024
    buffer_load_dwordx4 v[208:211], v8, s[8:11], s17 offen offset:2048
    buffer_load_dwordx4 v[212:215], v8, s[8:11], s17 offen offset:3072
    s_waitcnt vmcnt(3)
    v_mfma_f32_16x16x32_bf16 v[184:187], v[200:203], v[152:155], v[216:219]
    v_mfma_f32_16x16x32_bf16 v[188:191], v[200:203], v[168:171], v[220:223]
    s_waitcnt vmcnt(2)
    v_mfma_f32_16x16x32_bf16 v[192:195], v[204:207], v[152:155], v[216:219]
    v_mfma_f32_16x16x32_bf16 v[196:199], v[204:207], v[168:171], v[220:223]
    s_waitcnt vmcnt(1)
    v_mfma_f32_16x16x32_bf16 v[184:187], v[208:211], v[156:159], v[184:187]
    v_mfma_f32_16x16x32_bf16 v[188:191], v[208:211], v[172:175], v[188:191]
    s_waitcnt vmcnt(0)
    v_mfma_f32_16x16x32_bf16 v[192:195], v[212:215], v[156:159], v[192:195]
    v_mfma_f32_16x16x32_bf16 v[196:199], v[212:215], v[172:175], v[196:199]
    s_mov_b32 s17, 0x1000
    buffer_load_dwordx4 v[200:203], v8, s[8:11], s17 offen offset:0
    buffer_load_dwordx4 v[204:207], v8, s[8:11], s17 offen offset:1024
    buffer_load_dwordx4 v[208:211], v8, s[8:11], s17 offen offset:2048
    buffer_load_dwordx4 v[212:215], v8, s[8:11], s17 offen offset:3072
    s_waitcnt vmcnt(3)
    v_mfma_f32_16x16x32_bf16 v[184:187], v[200:203], v[160:163], v[184:187]
    v_mfma_f32_16x16x32_bf16 v[188:191], v[200:203], v[176:179], v[188:191]
    s_waitcnt vmcnt(2)
    v_mfma_f32_16x16x32_bf16 v[192:195], v[204:207], v[160:163], v[192:195]
    v_mfma_f32_16x16x32_bf16 v[196:199], v[204:207], v[176:179], v[196:199]
    s_waitcnt vmcnt(1)
    v_mfma_f32_16x16x32_bf16 v[184:187], v[208:211], v[164:167], v[184:187]
    v_mfma_f32_16x16x32_bf16 v[188:191], v[208:211], v[180:183], v[188:191]
    s_waitcnt vmcnt(0)
    v_mfma_f32_16x16x32_bf16 v[192:195], v[212:215], v[164:167], v[192:195]
    v_mfma_f32_16x16x32_bf16 v[196:199], v[212:215], v[180:183], v[196:199]
    s_nop 3
    v_exp_f32 v184, v184
    v_exp_f32 v185, v185
    s_nop 0
    v_add_f32 v9, v184, v185
    v_cvt_pk_bf16_f32 v24, v184, v185
    v_exp_f32 v186, v186
    v_exp_f32 v187, v187
    v_add_f32 v9, v9, v186
    v_add_f32 v9, v9, v187
    v_cvt_pk_bf16_f32 v25, v186, v187
    v_exp_f32 v188, v188
    v_exp_f32 v189, v189
    s_nop 0
    v_add_f32 v10, v188, v189
    v_cvt_pk_bf16_f32 v28, v188, v189
    v_exp_f32 v190, v190
    v_exp_f32 v191, v191
    v_add_f32 v10, v10, v190
    v_add_f32 v10, v10, v191
    v_cvt_pk_bf16_f32 v29, v190, v191
    v_exp_f32 v192, v192
    v_exp_f32 v193, v193
    v_add_f32 v9, v9, v192
    v_add_f32 v9, v9, v193
    v_cvt_pk_bf16_f32 v26, v192, v193
    v_exp_f32 v194, v194
    v_exp_f32 v195, v195
    v_add_f32 v9, v9, v194
    v_add_f32 v9, v9, v195
    v_cvt_pk_bf16_f32 v27, v194, v195
    v_exp_f32 v196, v196
    v_exp_f32 v197, v197
    v_add_f32 v10, v10, v196
    v_add_f32 v10, v10, v197
    v_cvt_pk_bf16_f32 v30, v196, v197
    v_exp_f32 v198, v198
    v_exp_f32 v199, v199
    v_add_f32 v10, v10, v198
    v_add_f32 v10, v10, v199
    v_cvt_pk_bf16_f32 v31, v198, v199
    s_mov_b32 s17, 0x2000
    buffer_load_dwordx4 v[200:203], v8, s[8:11], s17 offen offset:0
    buffer_load_dwordx4 v[204:207], v8, s[8:11], s17 offen offset:1024
    buffer_load_dwordx4 v[208:211], v8, s[8:11], s17 offen offset:2048
    buffer_load_dwordx4 v[212:215], v8, s[8:11], s17 offen offset:3072
    s_waitcnt vmcnt(3)
    v_mfma_f32_16x16x32_bf16 v[184:187], v[200:203], v[152:155], v[216:219]
    v_mfma_f32_16x16x32_bf16 v[188:191], v[200:203], v[168:171], v[220:223]
    s_waitcnt vmcnt(2)
    v_mfma_f32_16x16x32_bf16 v[192:195], v[204:207], v[152:155], v[216:219]
    v_mfma_f32_16x16x32_bf16 v[196:199], v[204:207], v[168:171], v[220:223]
    s_waitcnt vmcnt(1)
    v_mfma_f32_16x16x32_bf16 v[184:187], v[208:211], v[156:159], v[184:187]
    v_mfma_f32_16x16x32_bf16 v[188:191], v[208:211], v[172:175], v[188:191]
    s_waitcnt vmcnt(0)
    v_mfma_f32_16x16x32_bf16 v[192:195], v[212:215], v[156:159], v[192:195]
    v_mfma_f32_16x16x32_bf16 v[196:199], v[212:215], v[172:175], v[196:199]
    s_mov_b32 s17, 0x3000
    buffer_load_dwordx4 v[200:203], v8, s[8:11], s17 offen offset:0
    buffer_load_dwordx4 v[204:207], v8, s[8:11], s17 offen offset:1024
    buffer_load_dwordx4 v[208:211], v8, s[8:11], s17 offen offset:2048
    buffer_load_dwordx4 v[212:215], v8, s[8:11], s17 offen offset:3072
    s_waitcnt vmcnt(3)
    v_mfma_f32_16x16x32_bf16 v[184:187], v[200:203], v[160:163], v[184:187]
    v_mfma_f32_16x16x32_bf16 v[188:191], v[200:203], v[176:179], v[188:191]
    s_waitcnt vmcnt(2)
    v_mfma_f32_16x16x32_bf16 v[192:195], v[204:207], v[160:163], v[192:195]
    v_mfma_f32_16x16x32_bf16 v[196:199], v[204:207], v[176:179], v[196:199]
    s_waitcnt vmcnt(1)
    v_mfma_f32_16x16x32_bf16 v[184:187], v[208:211], v[164:167], v[184:187]
    v_mfma_f32_16x16x32_bf16 v[188:191], v[208:211], v[180:183], v[188:191]
    s_waitcnt vmcnt(0)
    v_mfma_f32_16x16x32_bf16 v[192:195], v[212:215], v[164:167], v[192:195]
    v_mfma_f32_16x16x32_bf16 v[196:199], v[212:215], v[180:183], v[196:199]
    s_nop 3
    v_exp_f32 v184, v184
    v_exp_f32 v185, v185
    v_add_f32 v9, v9, v184
    v_add_f32 v9, v9, v185
    v_cvt_pk_bf16_f32 v32, v184, v185
    v_exp_f32 v186, v186
    v_exp_f32 v187, v187
    v_add_f32 v9, v9, v186
    v_add_f32 v9, v9, v187
    v_cvt_pk_bf16_f32 v33, v186, v187
    v_exp_f32 v188, v188
    v_exp_f32 v189, v189
    v_add_f32 v10, v10, v188
    v_add_f32 v10, v10, v189
    v_cvt_pk_bf16_f32 v36, v188, v189
    v_exp_f32 v190, v190
    v_exp_f32 v191, v191
    v_add_f32 v10, v10, v190
    v_add_f32 v10, v10, v191
    v_cvt_pk_bf16_f32 v37, v190, v191
    v_exp_f32 v192, v192
    v_exp_f32 v193, v193
    v_add_f32 v9, v9, v192
    v_add_f32 v9, v9, v193
    v_cvt_pk_bf16_f32 v34, v192, v193
    v_exp_f32 v194, v194
    v_exp_f32 v195, v195
    v_add_f32 v9, v9, v194
    v_add_f32 v9, v9, v195
    v_cvt_pk_bf16_f32 v35, v194, v195
    v_exp_f32 v196, v196
    v_exp_f32 v197, v197
    v_add_f32 v10, v10, v196
    v_add_f32 v10, v10, v197
    v_cvt_pk_bf16_f32 v38, v196, v197
    v_exp_f32 v198, v198
    v_exp_f32 v199, v199
    v_add_f32 v10, v10, v198
    v_add_f32 v10, v10, v199
    v_cvt_pk_bf16_f32 v39, v198, v199
    s_mov_b32 s17, 0x4000
    buffer_load_dwordx4 v[200:203], v8, s[8:11], s17 offen offset:0
    buffer_load_dwordx4 v[204:207], v8, s[8:11], s17 offen offset:1024
    buffer_load_dwordx4 v[208:211], v8, s[8:11], s17 offen offset:2048
    buffer_load_dwordx4 v[212:215], v8, s[8:11], s17 offen offset:3072
    s_waitcnt vmcnt(3)
    v_mfma_f32_16x16x32_bf16 v[184:187], v[200:203], v[152:155], v[216:219]
    v_mfma_f32_16x16x32_bf16 v[188:191], v[200:203], v[168:171], v[220:223]
    s_waitcnt vmcnt(2)
    v_mfma_f32_16x16x32_bf16 v[192:195], v[204:207], v[152:155], v[216:219]
    v_mfma_f32_16x16x32_bf16 v[196:199], v[204:207], v[168:171], v[220:223]
    s_waitcnt vmcnt(1)
    v_mfma_f32_16x16x32_bf16 v[184:187], v[208:211], v[156:159], v[184:187]
    v_mfma_f32_16x16x32_bf16 v[188:191], v[208:211], v[172:175], v[188:191]
    s_waitcnt vmcnt(0)
    v_mfma_f32_16x16x32_bf16 v[192:195], v[212:215], v[156:159], v[192:195]
    v_mfma_f32_16x16x32_bf16 v[196:199], v[212:215], v[172:175], v[196:199]
    s_mov_b32 s17, 0x5000
    buffer_load_dwordx4 v[200:203], v8, s[8:11], s17 offen offset:0
    buffer_load_dwordx4 v[204:207], v8, s[8:11], s17 offen offset:1024
    buffer_load_dwordx4 v[208:211], v8, s[8:11], s17 offen offset:2048
    buffer_load_dwordx4 v[212:215], v8, s[8:11], s17 offen offset:3072
    s_waitcnt vmcnt(3)
    v_mfma_f32_16x16x32_bf16 v[184:187], v[200:203], v[160:163], v[184:187]
    v_mfma_f32_16x16x32_bf16 v[188:191], v[200:203], v[176:179], v[188:191]
    s_waitcnt vmcnt(2)
    v_mfma_f32_16x16x32_bf16 v[192:195], v[204:207], v[160:163], v[192:195]
    v_mfma_f32_16x16x32_bf16 v[196:199], v[204:207], v[176:179], v[196:199]
    s_waitcnt vmcnt(1)
    v_mfma_f32_16x16x32_bf16 v[184:187], v[208:211], v[164:167], v[184:187]
    v_mfma_f32_16x16x32_bf16 v[188:191], v[208:211], v[180:183], v[188:191]
    s_waitcnt vmcnt(0)
    v_mfma_f32_16x16x32_bf16 v[192:195], v[212:215], v[164:167], v[192:195]
    v_mfma_f32_16x16x32_bf16 v[196:199], v[212:215], v[180:183], v[196:199]
    s_nop 3
    v_exp_f32 v184, v184
    v_exp_f32 v185, v185
    v_add_f32 v9, v9, v184
    v_add_f32 v9, v9, v185
    v_cvt_pk_bf16_f32 v40, v184, v185
    v_exp_f32 v186, v186
    v_exp_f32 v187, v187
    v_add_f32 v9, v9, v186
    v_add_f32 v9, v9, v187
    v_cvt_pk_bf16_f32 v41, v186, v187
    v_exp_f32 v188, v188
    v_exp_f32 v189, v189
    v_add_f32 v10, v10, v188
    v_add_f32 v10, v10, v189
    v_cvt_pk_bf16_f32 v44, v188, v189
    v_exp_f32 v190, v190
    v_exp_f32 v191, v191
    v_add_f32 v10, v10, v190
    v_add_f32 v10, v10, v191
    v_cvt_pk_bf16_f32 v45, v190, v191
    v_exp_f32 v192, v192
    v_exp_f32 v193, v193
    v_add_f32 v9, v9, v192
    v_add_f32 v9, v9, v193
    v_cvt_pk_bf16_f32 v42, v192, v193
    v_exp_f32 v194, v194
    v_exp_f32 v195, v195
    v_add_f32 v9, v9, v194
    v_add_f32 v9, v9, v195
    v_cvt_pk_bf16_f32 v43, v194, v195
    v_exp_f32 v196, v196
    v_exp_f32 v197, v197
    v_add_f32 v10, v10, v196
    v_add_f32 v10, v10, v197
    v_cvt_pk_bf16_f32 v46, v196, v197
    v_exp_f32 v198, v198
    v_exp_f32 v199, v199
    v_add_f32 v10, v10, v198
    v_add_f32 v10, v10, v199
    v_cvt_pk_bf16_f32 v47, v198, v199
    s_mov_b32 s17, 0x6000
    buffer_load_dwordx4 v[200:203], v8, s[8:11], s17 offen offset:0
    buffer_load_dwordx4 v[204:207], v8, s[8:11], s17 offen offset:1024
    buffer_load_dwordx4 v[208:211], v8, s[8:11], s17 offen offset:2048
    buffer_load_dwordx4 v[212:215], v8, s[8:11], s17 offen offset:3072
    s_waitcnt vmcnt(3)
    v_mfma_f32_16x16x32_bf16 v[184:187], v[200:203], v[152:155], v[216:219]
    v_mfma_f32_16x16x32_bf16 v[188:191], v[200:203], v[168:171], v[220:223]
    s_waitcnt vmcnt(2)
    v_mfma_f32_16x16x32_bf16 v[192:195], v[204:207], v[152:155], v[216:219]
    v_mfma_f32_16x16x32_bf16 v[196:199], v[204:207], v[168:171], v[220:223]
    s_waitcnt vmcnt(1)
    v_mfma_f32_16x16x32_bf16 v[184:187], v[208:211], v[156:159], v[184:187]
    v_mfma_f32_16x16x32_bf16 v[188:191], v[208:211], v[172:175], v[188:191]
    s_waitcnt vmcnt(0)
    v_mfma_f32_16x16x32_bf16 v[192:195], v[212:215], v[156:159], v[192:195]
    v_mfma_f32_16x16x32_bf16 v[196:199], v[212:215], v[172:175], v[196:199]
    s_mov_b32 s17, 0x7000
    buffer_load_dwordx4 v[200:203], v8, s[8:11], s17 offen offset:0
    buffer_load_dwordx4 v[204:207], v8, s[8:11], s17 offen offset:1024
    buffer_load_dwordx4 v[208:211], v8, s[8:11], s17 offen offset:2048
    buffer_load_dwordx4 v[212:215], v8, s[8:11], s17 offen offset:3072
    s_waitcnt vmcnt(3)
    v_mfma_f32_16x16x32_bf16 v[184:187], v[200:203], v[160:163], v[184:187]
    v_mfma_f32_16x16x32_bf16 v[188:191], v[200:203], v[176:179], v[188:191]
    s_waitcnt vmcnt(2)
    v_mfma_f32_16x16x32_bf16 v[192:195], v[204:207], v[160:163], v[192:195]
    v_mfma_f32_16x16x32_bf16 v[196:199], v[204:207], v[176:179], v[196:199]
    s_waitcnt vmcnt(1)
    v_mfma_f32_16x16x32_bf16 v[184:187], v[208:211], v[164:167], v[184:187]
    v_mfma_f32_16x16x32_bf16 v[188:191], v[208:211], v[180:183], v[188:191]
    s_waitcnt vmcnt(0)
    v_mfma_f32_16x16x32_bf16 v[192:195], v[212:215], v[164:167], v[192:195]
    v_mfma_f32_16x16x32_bf16 v[196:199], v[212:215], v[180:183], v[196:199]
    s_nop 3
    v_exp_f32 v184, v184
    v_exp_f32 v185, v185
    v_add_f32 v9, v9, v184
    v_add_f32 v9, v9, v185
    v_cvt_pk_bf16_f32 v48, v184, v185
    v_exp_f32 v186, v186
    v_exp_f32 v187, v187
    v_add_f32 v9, v9, v186
    v_add_f32 v9, v9, v187
    v_cvt_pk_bf16_f32 v49, v186, v187
    v_exp_f32 v188, v188
    v_exp_f32 v189, v189
    v_add_f32 v10, v10, v188
    v_add_f32 v10, v10, v189
    v_cvt_pk_bf16_f32 v52, v188, v189
    v_exp_f32 v190, v190
    v_exp_f32 v191, v191
    v_add_f32 v10, v10, v190
    v_add_f32 v10, v10, v191
    v_cvt_pk_bf16_f32 v53, v190, v191
    v_exp_f32 v192, v192
    v_exp_f32 v193, v193
    v_add_f32 v9, v9, v192
    v_add_f32 v9, v9, v193
    v_cvt_pk_bf16_f32 v50, v192, v193
    v_exp_f32 v194, v194
    v_exp_f32 v195, v195
    v_add_f32 v9, v9, v194
    v_add_f32 v9, v9, v195
    v_cvt_pk_bf16_f32 v51, v194, v195
    v_exp_f32 v196, v196
    v_exp_f32 v197, v197
    v_add_f32 v10, v10, v196
    v_add_f32 v10, v10, v197
    v_cvt_pk_bf16_f32 v54, v196, v197
    v_exp_f32 v198, v198
    v_exp_f32 v199, v199
    v_add_f32 v10, v10, v198
    v_add_f32 v10, v10, v199
    v_cvt_pk_bf16_f32 v55, v198, v199
    s_mov_b32 s17, 0x8000
    buffer_load_dwordx4 v[200:203], v8, s[8:11], s17 offen offset:0
    buffer_load_dwordx4 v[204:207], v8, s[8:11], s17 offen offset:1024
    buffer_load_dwordx4 v[208:211], v8, s[8:11], s17 offen offset:2048
    buffer_load_dwordx4 v[212:215], v8, s[8:11], s17 offen offset:3072
    s_waitcnt vmcnt(3)
    v_mfma_f32_16x16x32_bf16 v[184:187], v[200:203], v[152:155], v[216:219]
    v_mfma_f32_16x16x32_bf16 v[188:191], v[200:203], v[168:171], v[220:223]
    s_waitcnt vmcnt(2)
    v_mfma_f32_16x16x32_bf16 v[192:195], v[204:207], v[152:155], v[216:219]
    v_mfma_f32_16x16x32_bf16 v[196:199], v[204:207], v[168:171], v[220:223]
    s_waitcnt vmcnt(1)
    v_mfma_f32_16x16x32_bf16 v[184:187], v[208:211], v[156:159], v[184:187]
    v_mfma_f32_16x16x32_bf16 v[188:191], v[208:211], v[172:175], v[188:191]
    s_waitcnt vmcnt(0)
    v_mfma_f32_16x16x32_bf16 v[192:195], v[212:215], v[156:159], v[192:195]
    v_mfma_f32_16x16x32_bf16 v[196:199], v[212:215], v[172:175], v[196:199]
    s_mov_b32 s17, 0x9000
    buffer_load_dwordx4 v[200:203], v8, s[8:11], s17 offen offset:0
    buffer_load_dwordx4 v[204:207], v8, s[8:11], s17 offen offset:1024
    buffer_load_dwordx4 v[208:211], v8, s[8:11], s17 offen offset:2048
    buffer_load_dwordx4 v[212:215], v8, s[8:11], s17 offen offset:3072
    s_waitcnt vmcnt(3)
    v_mfma_f32_16x16x32_bf16 v[184:187], v[200:203], v[160:163], v[184:187]
    v_mfma_f32_16x16x32_bf16 v[188:191], v[200:203], v[176:179], v[188:191]
    s_waitcnt vmcnt(2)
    v_mfma_f32_16x16x32_bf16 v[192:195], v[204:207], v[160:163], v[192:195]
    v_mfma_f32_16x16x32_bf16 v[196:199], v[204:207], v[176:179], v[196:199]
    s_waitcnt vmcnt(1)
    v_mfma_f32_16x16x32_bf16 v[184:187], v[208:211], v[164:167], v[184:187]
    v_mfma_f32_16x16x32_bf16 v[188:191], v[208:211], v[180:183], v[188:191]
    s_waitcnt vmcnt(0)
    v_mfma_f32_16x16x32_bf16 v[192:195], v[212:215], v[164:167], v[192:195]
    v_mfma_f32_16x16x32_bf16 v[196:199], v[212:215], v[180:183], v[196:199]
    s_nop 3
    v_exp_f32 v184, v184
    v_exp_f32 v185, v185
    v_add_f32 v9, v9, v184
    v_add_f32 v9, v9, v185
    v_cvt_pk_bf16_f32 v56, v184, v185
    v_exp_f32 v186, v186
    v_exp_f32 v187, v187
    v_add_f32 v9, v9, v186
    v_add_f32 v9, v9, v187
    v_cvt_pk_bf16_f32 v57, v186, v187
    v_exp_f32 v188, v188
    v_exp_f32 v189, v189
    v_add_f32 v10, v10, v188
    v_add_f32 v10, v10, v189
    v_cvt_pk_bf16_f32 v60, v188, v189
    v_exp_f32 v190, v190
    v_exp_f32 v191, v191
    v_add_f32 v10, v10, v190
    v_add_f32 v10, v10, v191
    v_cvt_pk_bf16_f32 v61, v190, v191
    v_exp_f32 v192, v192
    v_exp_f32 v193, v193
    v_add_f32 v9, v9, v192
    v_add_f32 v9, v9, v193
    v_cvt_pk_bf16_f32 v58, v192, v193
    v_exp_f32 v194, v194
    v_exp_f32 v195, v195
    v_add_f32 v9, v9, v194
    v_add_f32 v9, v9, v195
    v_cvt_pk_bf16_f32 v59, v194, v195
    v_exp_f32 v196, v196
    v_exp_f32 v197, v197
    v_add_f32 v10, v10, v196
    v_add_f32 v10, v10, v197
    v_cvt_pk_bf16_f32 v62, v196, v197
    v_exp_f32 v198, v198
    v_exp_f32 v199, v199
    v_add_f32 v10, v10, v198
    v_add_f32 v10, v10, v199
    v_cvt_pk_bf16_f32 v63, v198, v199
    s_mov_b32 s17, 0xa000
    buffer_load_dwordx4 v[200:203], v8, s[8:11], s17 offen offset:0
    buffer_load_dwordx4 v[204:207], v8, s[8:11], s17 offen offset:1024
    buffer_load_dwordx4 v[208:211], v8, s[8:11], s17 offen offset:2048
    buffer_load_dwordx4 v[212:215], v8, s[8:11], s17 offen offset:3072
    s_waitcnt vmcnt(3)
    v_mfma_f32_16x16x32_bf16 v[184:187], v[200:203], v[152:155], v[216:219]
    v_mfma_f32_16x16x32_bf16 v[188:191], v[200:203], v[168:171], v[220:223]
    s_waitcnt vmcnt(2)
    v_mfma_f32_16x16x32_bf16 v[192:195], v[204:207], v[152:155], v[216:219]
    v_mfma_f32_16x16x32_bf16 v[196:199], v[204:207], v[168:171], v[220:223]
    s_waitcnt vmcnt(1)
    v_mfma_f32_16x16x32_bf16 v[184:187], v[208:211], v[156:159], v[184:187]
    v_mfma_f32_16x16x32_bf16 v[188:191], v[208:211], v[172:175], v[188:191]
    s_waitcnt vmcnt(0)
    v_mfma_f32_16x16x32_bf16 v[192:195], v[212:215], v[156:159], v[192:195]
    v_mfma_f32_16x16x32_bf16 v[196:199], v[212:215], v[172:175], v[196:199]
    s_mov_b32 s17, 0xb000
    buffer_load_dwordx4 v[200:203], v8, s[8:11], s17 offen offset:0
    buffer_load_dwordx4 v[204:207], v8, s[8:11], s17 offen offset:1024
    buffer_load_dwordx4 v[208:211], v8, s[8:11], s17 offen offset:2048
    buffer_load_dwordx4 v[212:215], v8, s[8:11], s17 offen offset:3072
    s_waitcnt vmcnt(3)
    v_mfma_f32_16x16x32_bf16 v[184:187], v[200:203], v[160:163], v[184:187]
    v_mfma_f32_16x16x32_bf16 v[188:191], v[200:203], v[176:179], v[188:191]
    s_waitcnt vmcnt(2)
    v_mfma_f32_16x16x32_bf16 v[192:195], v[204:207], v[160:163], v[192:195]
    v_mfma_f32_16x16x32_bf16 v[196:199], v[204:207], v[176:179], v[196:199]
    s_waitcnt vmcnt(1)
    v_mfma_f32_16x16x32_bf16 v[184:187], v[208:211], v[164:167], v[184:187]
    v_mfma_f32_16x16x32_bf16 v[188:191], v[208:211], v[180:183], v[188:191]
    s_waitcnt vmcnt(0)
    v_mfma_f32_16x16x32_bf16 v[192:195], v[212:215], v[164:167], v[192:195]
    v_mfma_f32_16x16x32_bf16 v[196:199], v[212:215], v[180:183], v[196:199]
    s_nop 3
    v_exp_f32 v184, v184
    v_exp_f32 v185, v185
    v_add_f32 v9, v9, v184
    v_add_f32 v9, v9, v185
    v_cvt_pk_bf16_f32 v64, v184, v185
    v_exp_f32 v186, v186
    v_exp_f32 v187, v187
    v_add_f32 v9, v9, v186
    v_add_f32 v9, v9, v187
    v_cvt_pk_bf16_f32 v65, v186, v187
    v_exp_f32 v188, v188
    v_exp_f32 v189, v189
    v_add_f32 v10, v10, v188
    v_add_f32 v10, v10, v189
    v_cvt_pk_bf16_f32 v68, v188, v189
    v_exp_f32 v190, v190
    v_exp_f32 v191, v191
    v_add_f32 v10, v10, v190
    v_add_f32 v10, v10, v191
    v_cvt_pk_bf16_f32 v69, v190, v191
    v_exp_f32 v192, v192
    v_exp_f32 v193, v193
    v_add_f32 v9, v9, v192
    v_add_f32 v9, v9, v193
    v_cvt_pk_bf16_f32 v66, v192, v193
    v_exp_f32 v194, v194
    v_exp_f32 v195, v195
    v_add_f32 v9, v9, v194
    v_add_f32 v9, v9, v195
    v_cvt_pk_bf16_f32 v67, v194, v195
    v_exp_f32 v196, v196
    v_exp_f32 v197, v197
    v_add_f32 v10, v10, v196
    v_add_f32 v10, v10, v197
    v_cvt_pk_bf16_f32 v70, v196, v197
    v_exp_f32 v198, v198
    v_exp_f32 v199, v199
    v_add_f32 v10, v10, v198
    v_add_f32 v10, v10, v199
    v_cvt_pk_bf16_f32 v71, v198, v199
    s_mov_b32 s17, 0xc000
    buffer_load_dwordx4 v[200:203], v8, s[8:11], s17 offen offset:0
    buffer_load_dwordx4 v[204:207], v8, s[8:11], s17 offen offset:1024
    buffer_load_dwordx4 v[208:211], v8, s[8:11], s17 offen offset:2048
    buffer_load_dwordx4 v[212:215], v8, s[8:11], s17 offen offset:3072
    s_waitcnt vmcnt(3)
    v_mfma_f32_16x16x32_bf16 v[184:187], v[200:203], v[152:155], v[216:219]
    v_mfma_f32_16x16x32_bf16 v[188:191], v[200:203], v[168:171], v[220:223]
    s_waitcnt vmcnt(2)
    v_mfma_f32_16x16x32_bf16 v[192:195], v[204:207], v[152:155], v[216:219]
    v_mfma_f32_16x16x32_bf16 v[196:199], v[204:207], v[168:171], v[220:223]
    s_waitcnt vmcnt(1)
    v_mfma_f32_16x16x32_bf16 v[184:187], v[208:211], v[156:159], v[184:187]
    v_mfma_f32_16x16x32_bf16 v[188:191], v[208:211], v[172:175], v[188:191]
    s_waitcnt vmcnt(0)
    v_mfma_f32_16x16x32_bf16 v[192:195], v[212:215], v[156:159], v[192:195]
    v_mfma_f32_16x16x32_bf16 v[196:199], v[212:215], v[172:175], v[196:199]
    s_mov_b32 s17, 0xd000
    buffer_load_dwordx4 v[200:203], v8, s[8:11], s17 offen offset:0
    buffer_load_dwordx4 v[204:207], v8, s[8:11], s17 offen offset:1024
    buffer_load_dwordx4 v[208:211], v8, s[8:11], s17 offen offset:2048
    buffer_load_dwordx4 v[212:215], v8, s[8:11], s17 offen offset:3072
    s_waitcnt vmcnt(3)
    v_mfma_f32_16x16x32_bf16 v[184:187], v[200:203], v[160:163], v[184:187]
    v_mfma_f32_16x16x32_bf16 v[188:191], v[200:203], v[176:179], v[188:191]
    s_waitcnt vmcnt(2)
    v_mfma_f32_16x16x32_bf16 v[192:195], v[204:207], v[160:163], v[192:195]
    v_mfma_f32_16x16x32_bf16 v[196:199], v[204:207], v[176:179], v[196:199]
    s_waitcnt vmcnt(1)
    v_mfma_f32_16x16x32_bf16 v[184:187], v[208:211], v[164:167], v[184:187]
    v_mfma_f32_16x16x32_bf16 v[188:191], v[208:211], v[180:183], v[188:191]
    s_waitcnt vmcnt(0)
    v_mfma_f32_16x16x32_bf16 v[192:195], v[212:215], v[164:167], v[192:195]
    v_mfma_f32_16x16x32_bf16 v[196:199], v[212:215], v[180:183], v[196:199]
    s_nop 3
    v_exp_f32 v184, v184
    v_exp_f32 v185, v185
    v_add_f32 v9, v9, v184
    v_add_f32 v9, v9, v185
    v_cvt_pk_bf16_f32 v72, v184, v185
    v_exp_f32 v186, v186
    v_exp_f32 v187, v187
    v_add_f32 v9, v9, v186
    v_add_f32 v9, v9, v187
    v_cvt_pk_bf16_f32 v73, v186, v187
    v_exp_f32 v188, v188
    v_exp_f32 v189, v189
    v_add_f32 v10, v10, v188
    v_add_f32 v10, v10, v189
    v_cvt_pk_bf16_f32 v76, v188, v189
    v_exp_f32 v190, v190
    v_exp_f32 v191, v191
    v_add_f32 v10, v10, v190
    v_add_f32 v10, v10, v191
    v_cvt_pk_bf16_f32 v77, v190, v191
    v_exp_f32 v192, v192
    v_exp_f32 v193, v193
    v_add_f32 v9, v9, v192
    v_add_f32 v9, v9, v193
    v_cvt_pk_bf16_f32 v74, v192, v193
    v_exp_f32 v194, v194
    v_exp_f32 v195, v195
    v_add_f32 v9, v9, v194
    v_add_f32 v9, v9, v195
    v_cvt_pk_bf16_f32 v75, v194, v195
    v_exp_f32 v196, v196
    v_exp_f32 v197, v197
    v_add_f32 v10, v10, v196
    v_add_f32 v10, v10, v197
    v_cvt_pk_bf16_f32 v78, v196, v197
    v_exp_f32 v198, v198
    v_exp_f32 v199, v199
    v_add_f32 v10, v10, v198
    v_add_f32 v10, v10, v199
    v_cvt_pk_bf16_f32 v79, v198, v199
    s_mov_b32 s17, 0xe000
    buffer_load_dwordx4 v[200:203], v8, s[8:11], s17 offen offset:0
    buffer_load_dwordx4 v[204:207], v8, s[8:11], s17 offen offset:1024
    buffer_load_dwordx4 v[208:211], v8, s[8:11], s17 offen offset:2048
    buffer_load_dwordx4 v[212:215], v8, s[8:11], s17 offen offset:3072
    s_waitcnt vmcnt(3)
    v_mfma_f32_16x16x32_bf16 v[184:187], v[200:203], v[152:155], v[216:219]
    v_mfma_f32_16x16x32_bf16 v[188:191], v[200:203], v[168:171], v[220:223]
    s_waitcnt vmcnt(2)
    v_mfma_f32_16x16x32_bf16 v[192:195], v[204:207], v[152:155], v[216:219]
    v_mfma_f32_16x16x32_bf16 v[196:199], v[204:207], v[168:171], v[220:223]
    s_waitcnt vmcnt(1)
    v_mfma_f32_16x16x32_bf16 v[184:187], v[208:211], v[156:159], v[184:187]
    v_mfma_f32_16x16x32_bf16 v[188:191], v[208:211], v[172:175], v[188:191]
    s_waitcnt vmcnt(0)
    v_mfma_f32_16x16x32_bf16 v[192:195], v[212:215], v[156:159], v[192:195]
    v_mfma_f32_16x16x32_bf16 v[196:199], v[212:215], v[172:175], v[196:199]
    s_mov_b32 s17, 0xf000
    buffer_load_dwordx4 v[200:203], v8, s[8:11], s17 offen offset:0
    buffer_load_dwordx4 v[204:207], v8, s[8:11], s17 offen offset:1024
    buffer_load_dwordx4 v[208:211], v8, s[8:11], s17 offen offset:2048
    buffer_load_dwordx4 v[212:215], v8, s[8:11], s17 offen offset:3072
    s_waitcnt vmcnt(3)
    v_mfma_f32_16x16x32_bf16 v[184:187], v[200:203], v[160:163], v[184:187]
    v_mfma_f32_16x16x32_bf16 v[188:191], v[200:203], v[176:179], v[188:191]
    s_waitcnt vmcnt(2)
    v_mfma_f32_16x16x32_bf16 v[192:195], v[204:207], v[160:163], v[192:195]
    v_mfma_f32_16x16x32_bf16 v[196:199], v[204:207], v[176:179], v[196:199]
    s_waitcnt vmcnt(1)
    v_mfma_f32_16x16x32_bf16 v[184:187], v[208:211], v[164:167], v[184:187]
    v_mfma_f32_16x16x32_bf16 v[188:191], v[208:211], v[180:183], v[188:191]
    s_waitcnt vmcnt(0)
    v_mfma_f32_16x16x32_bf16 v[192:195], v[212:215], v[164:167], v[192:195]
    v_mfma_f32_16x16x32_bf16 v[196:199], v[212:215], v[180:183], v[196:199]
    s_nop 3
    v_exp_f32 v184, v184
    v_exp_f32 v185, v185
    v_add_f32 v9, v9, v184
    v_add_f32 v9, v9, v185
    v_cvt_pk_bf16_f32 v80, v184, v185
    v_exp_f32 v186, v186
    v_exp_f32 v187, v187
    v_add_f32 v9, v9, v186
    v_add_f32 v9, v9, v187
    v_cvt_pk_bf16_f32 v81, v186, v187
    v_exp_f32 v188, v188
    v_exp_f32 v189, v189
    v_add_f32 v10, v10, v188
    v_add_f32 v10, v10, v189
    v_cvt_pk_bf16_f32 v84, v188, v189
    v_exp_f32 v190, v190
    v_exp_f32 v191, v191
    v_add_f32 v10, v10, v190
    v_add_f32 v10, v10, v191
    v_cvt_pk_bf16_f32 v85, v190, v191
    v_exp_f32 v192, v192
    v_exp_f32 v193, v193
    v_add_f32 v9, v9, v192
    v_add_f32 v9, v9, v193
    v_cvt_pk_bf16_f32 v82, v192, v193
    v_exp_f32 v194, v194
    v_exp_f32 v195, v195
    v_add_f32 v9, v9, v194
    v_add_f32 v9, v9, v195
    v_cvt_pk_bf16_f32 v83, v194, v195
    v_exp_f32 v196, v196
    v_exp_f32 v197, v197
    v_add_f32 v10, v10, v196
    v_add_f32 v10, v10, v197
    v_cvt_pk_bf16_f32 v86, v196, v197
    v_exp_f32 v198, v198
    v_exp_f32 v199, v199
    v_add_f32 v10, v10, v198
    v_add_f32 v10, v10, v199
    v_cvt_pk_bf16_f32 v87, v198, v199
    s_mov_b32 s17, 0x10000
    buffer_load_dwordx4 v[200:203], v8, s[8:11], s17 offen offset:0
    buffer_load_dwordx4 v[204:207], v8, s[8:11], s17 offen offset:1024
    buffer_load_dwordx4 v[208:211], v8, s[8:11], s17 offen offset:2048
    buffer_load_dwordx4 v[212:215], v8, s[8:11], s17 offen offset:3072
    s_waitcnt vmcnt(3)
    v_mfma_f32_16x16x32_bf16 v[184:187], v[200:203], v[152:155], v[216:219]
    v_mfma_f32_16x16x32_bf16 v[188:191], v[200:203], v[168:171], v[220:223]
    s_waitcnt vmcnt(2)
    v_mfma_f32_16x16x32_bf16 v[192:195], v[204:207], v[152:155], v[216:219]
    v_mfma_f32_16x16x32_bf16 v[196:199], v[204:207], v[168:171], v[220:223]
    s_waitcnt vmcnt(1)
    v_mfma_f32_16x16x32_bf16 v[184:187], v[208:211], v[156:159], v[184:187]
    v_mfma_f32_16x16x32_bf16 v[188:191], v[208:211], v[172:175], v[188:191]
    s_waitcnt vmcnt(0)
    v_mfma_f32_16x16x32_bf16 v[192:195], v[212:215], v[156:159], v[192:195]
    v_mfma_f32_16x16x32_bf16 v[196:199], v[212:215], v[172:175], v[196:199]
    s_mov_b32 s17, 0x11000
    buffer_load_dwordx4 v[200:203], v8, s[8:11], s17 offen offset:0
    buffer_load_dwordx4 v[204:207], v8, s[8:11], s17 offen offset:1024
    buffer_load_dwordx4 v[208:211], v8, s[8:11], s17 offen offset:2048
    buffer_load_dwordx4 v[212:215], v8, s[8:11], s17 offen offset:3072
    s_waitcnt vmcnt(3)
    v_mfma_f32_16x16x32_bf16 v[184:187], v[200:203], v[160:163], v[184:187]
    v_mfma_f32_16x16x32_bf16 v[188:191], v[200:203], v[176:179], v[188:191]
    s_waitcnt vmcnt(2)
    v_mfma_f32_16x16x32_bf16 v[192:195], v[204:207], v[160:163], v[192:195]
    v_mfma_f32_16x16x32_bf16 v[196:199], v[204:207], v[176:179], v[196:199]
    s_waitcnt vmcnt(1)
    v_mfma_f32_16x16x32_bf16 v[184:187], v[208:211], v[164:167], v[184:187]
    v_mfma_f32_16x16x32_bf16 v[188:191], v[208:211], v[180:183], v[188:191]
    s_waitcnt vmcnt(0)
    v_mfma_f32_16x16x32_bf16 v[192:195], v[212:215], v[164:167], v[192:195]
    v_mfma_f32_16x16x32_bf16 v[196:199], v[212:215], v[180:183], v[196:199]
    s_nop 3
    v_exp_f32 v184, v184
    v_exp_f32 v185, v185
    v_add_f32 v9, v9, v184
    v_add_f32 v9, v9, v185
    v_cvt_pk_bf16_f32 v88, v184, v185
    v_exp_f32 v186, v186
    v_exp_f32 v187, v187
    v_add_f32 v9, v9, v186
    v_add_f32 v9, v9, v187
    v_cvt_pk_bf16_f32 v89, v186, v187
    v_exp_f32 v188, v188
    v_exp_f32 v189, v189
    v_add_f32 v10, v10, v188
    v_add_f32 v10, v10, v189
    v_cvt_pk_bf16_f32 v92, v188, v189
    v_exp_f32 v190, v190
    v_exp_f32 v191, v191
    v_add_f32 v10, v10, v190
    v_add_f32 v10, v10, v191
    v_cvt_pk_bf16_f32 v93, v190, v191
    v_exp_f32 v192, v192
    v_exp_f32 v193, v193
    v_add_f32 v9, v9, v192
    v_add_f32 v9, v9, v193
    v_cvt_pk_bf16_f32 v90, v192, v193
    v_exp_f32 v194, v194
    v_exp_f32 v195, v195
    v_add_f32 v9, v9, v194
    v_add_f32 v9, v9, v195
    v_cvt_pk_bf16_f32 v91, v194, v195
    v_exp_f32 v196, v196
    v_exp_f32 v197, v197
    v_add_f32 v10, v10, v196
    v_add_f32 v10, v10, v197
    v_cvt_pk_bf16_f32 v94, v196, v197
    v_exp_f32 v198, v198
    v_exp_f32 v199, v199
    v_add_f32 v10, v10, v198
    v_add_f32 v10, v10, v199
    v_cvt_pk_bf16_f32 v95, v198, v199
    s_mov_b32 s17, 0x12000
    buffer_load_dwordx4 v[200:203], v8, s[8:11], s17 offen offset:0
    buffer_load_dwordx4 v[204:207], v8, s[8:11], s17 offen offset:1024
    buffer_load_dwordx4 v[208:211], v8, s[8:11], s17 offen offset:2048
    buffer_load_dwordx4 v[212:215], v8, s[8:11], s17 offen offset:3072
    s_waitcnt vmcnt(3)
    v_mfma_f32_16x16x32_bf16 v[184:187], v[200:203], v[152:155], v[216:219]
    v_mfma_f32_16x16x32_bf16 v[188:191], v[200:203], v[168:171], v[220:223]
    s_waitcnt vmcnt(2)
    v_mfma_f32_16x16x32_bf16 v[192:195], v[204:207], v[152:155], v[216:219]
    v_mfma_f32_16x16x32_bf16 v[196:199], v[204:207], v[168:171], v[220:223]
    s_waitcnt vmcnt(1)
    v_mfma_f32_16x16x32_bf16 v[184:187], v[208:211], v[156:159], v[184:187]
    v_mfma_f32_16x16x32_bf16 v[188:191], v[208:211], v[172:175], v[188:191]
    s_waitcnt vmcnt(0)
    v_mfma_f32_16x16x32_bf16 v[192:195], v[212:215], v[156:159], v[192:195]
    v_mfma_f32_16x16x32_bf16 v[196:199], v[212:215], v[172:175], v[196:199]
    s_mov_b32 s17, 0x13000
    buffer_load_dwordx4 v[200:203], v8, s[8:11], s17 offen offset:0
    buffer_load_dwordx4 v[204:207], v8, s[8:11], s17 offen offset:1024
    buffer_load_dwordx4 v[208:211], v8, s[8:11], s17 offen offset:2048
    buffer_load_dwordx4 v[212:215], v8, s[8:11], s17 offen offset:3072
    s_waitcnt vmcnt(3)
    v_mfma_f32_16x16x32_bf16 v[184:187], v[200:203], v[160:163], v[184:187]
    v_mfma_f32_16x16x32_bf16 v[188:191], v[200:203], v[176:179], v[188:191]
    s_waitcnt vmcnt(2)
    v_mfma_f32_16x16x32_bf16 v[192:195], v[204:207], v[160:163], v[192:195]
    v_mfma_f32_16x16x32_bf16 v[196:199], v[204:207], v[176:179], v[196:199]
    s_waitcnt vmcnt(1)
    v_mfma_f32_16x16x32_bf16 v[184:187], v[208:211], v[164:167], v[184:187]
    v_mfma_f32_16x16x32_bf16 v[188:191], v[208:211], v[180:183], v[188:191]
    s_waitcnt vmcnt(0)
    v_mfma_f32_16x16x32_bf16 v[192:195], v[212:215], v[164:167], v[192:195]
    v_mfma_f32_16x16x32_bf16 v[196:199], v[212:215], v[180:183], v[196:199]
    s_nop 3
    v_exp_f32 v184, v184
    v_exp_f32 v185, v185
    v_add_f32 v9, v9, v184
    v_add_f32 v9, v9, v185
    v_cvt_pk_bf16_f32 v96, v184, v185
    v_exp_f32 v186, v186
    v_exp_f32 v187, v187
    v_add_f32 v9, v9, v186
    v_add_f32 v9, v9, v187
    v_cvt_pk_bf16_f32 v97, v186, v187
    v_exp_f32 v188, v188
    v_exp_f32 v189, v189
    v_add_f32 v10, v10, v188
    v_add_f32 v10, v10, v189
    v_cvt_pk_bf16_f32 v100, v188, v189
    v_exp_f32 v190, v190
    v_exp_f32 v191, v191
    v_add_f32 v10, v10, v190
    v_add_f32 v10, v10, v191
    v_cvt_pk_bf16_f32 v101, v190, v191
    v_exp_f32 v192, v192
    v_exp_f32 v193, v193
    v_add_f32 v9, v9, v192
    v_add_f32 v9, v9, v193
    v_cvt_pk_bf16_f32 v98, v192, v193
    v_exp_f32 v194, v194
    v_exp_f32 v195, v195
    v_add_f32 v9, v9, v194
    v_add_f32 v9, v9, v195
    v_cvt_pk_bf16_f32 v99, v194, v195
    v_exp_f32 v196, v196
    v_exp_f32 v197, v197
    v_add_f32 v10, v10, v196
    v_add_f32 v10, v10, v197
    v_cvt_pk_bf16_f32 v102, v196, v197
    v_exp_f32 v198, v198
    v_exp_f32 v199, v199
    v_add_f32 v10, v10, v198
    v_add_f32 v10, v10, v199
    v_cvt_pk_bf16_f32 v103, v198, v199
    s_mov_b32 s17, 0x14000
    buffer_load_dwordx4 v[200:203], v8, s[8:11], s17 offen offset:0
    buffer_load_dwordx4 v[204:207], v8, s[8:11], s17 offen offset:1024
    buffer_load_dwordx4 v[208:211], v8, s[8:11], s17 offen offset:2048
    buffer_load_dwordx4 v[212:215], v8, s[8:11], s17 offen offset:3072
    s_waitcnt vmcnt(3)
    v_mfma_f32_16x16x32_bf16 v[184:187], v[200:203], v[152:155], v[216:219]
    v_mfma_f32_16x16x32_bf16 v[188:191], v[200:203], v[168:171], v[220:223]
    s_waitcnt vmcnt(2)
    v_mfma_f32_16x16x32_bf16 v[192:195], v[204:207], v[152:155], v[216:219]
    v_mfma_f32_16x16x32_bf16 v[196:199], v[204:207], v[168:171], v[220:223]
    s_waitcnt vmcnt(1)
    v_mfma_f32_16x16x32_bf16 v[184:187], v[208:211], v[156:159], v[184:187]
    v_mfma_f32_16x16x32_bf16 v[188:191], v[208:211], v[172:175], v[188:191]
    s_waitcnt vmcnt(0)
    v_mfma_f32_16x16x32_bf16 v[192:195], v[212:215], v[156:159], v[192:195]
    v_mfma_f32_16x16x32_bf16 v[196:199], v[212:215], v[172:175], v[196:199]
    s_mov_b32 s17, 0x15000
    buffer_load_dwordx4 v[200:203], v8, s[8:11], s17 offen offset:0
    buffer_load_dwordx4 v[204:207], v8, s[8:11], s17 offen offset:1024
    buffer_load_dwordx4 v[208:211], v8, s[8:11], s17 offen offset:2048
    buffer_load_dwordx4 v[212:215], v8, s[8:11], s17 offen offset:3072
    s_waitcnt vmcnt(3)
    v_mfma_f32_16x16x32_bf16 v[184:187], v[200:203], v[160:163], v[184:187]
    v_mfma_f32_16x16x32_bf16 v[188:191], v[200:203], v[176:179], v[188:191]
    s_waitcnt vmcnt(2)
    v_mfma_f32_16x16x32_bf16 v[192:195], v[204:207], v[160:163], v[192:195]
    v_mfma_f32_16x16x32_bf16 v[196:199], v[204:207], v[176:179], v[196:199]
    s_waitcnt vmcnt(1)
    v_mfma_f32_16x16x32_bf16 v[184:187], v[208:211], v[164:167], v[184:187]
    v_mfma_f32_16x16x32_bf16 v[188:191], v[208:211], v[180:183], v[188:191]
    s_waitcnt vmcnt(0)
    v_mfma_f32_16x16x32_bf16 v[192:195], v[212:215], v[164:167], v[192:195]
    v_mfma_f32_16x16x32_bf16 v[196:199], v[212:215], v[180:183], v[196:199]
    s_nop 3
    v_exp_f32 v184, v184
    v_exp_f32 v185, v185
    v_add_f32 v9, v9, v184
    v_add_f32 v9, v9, v185
    v_cvt_pk_bf16_f32 v104, v184, v185
    v_exp_f32 v186, v186
    v_exp_f32 v187, v187
    v_add_f32 v9, v9, v186
    v_add_f32 v9, v9, v187
    v_cvt_pk_bf16_f32 v105, v186, v187
    v_exp_f32 v188, v188
    v_exp_f32 v189, v189
    v_add_f32 v10, v10, v188
    v_add_f32 v10, v10, v189
    v_cvt_pk_bf16_f32 v108, v188, v189
    v_exp_f32 v190, v190
    v_exp_f32 v191, v191
    v_add_f32 v10, v10, v190
    v_add_f32 v10, v10, v191
    v_cvt_pk_bf16_f32 v109, v190, v191
    v_exp_f32 v192, v192
    v_exp_f32 v193, v193
    v_add_f32 v9, v9, v192
    v_add_f32 v9, v9, v193
    v_cvt_pk_bf16_f32 v106, v192, v193
    v_exp_f32 v194, v194
    v_exp_f32 v195, v195
    v_add_f32 v9, v9, v194
    v_add_f32 v9, v9, v195
    v_cvt_pk_bf16_f32 v107, v194, v195
    v_exp_f32 v196, v196
    v_exp_f32 v197, v197
    v_add_f32 v10, v10, v196
    v_add_f32 v10, v10, v197
    v_cvt_pk_bf16_f32 v110, v196, v197
    v_exp_f32 v198, v198
    v_exp_f32 v199, v199
    v_add_f32 v10, v10, v198
    v_add_f32 v10, v10, v199
    v_cvt_pk_bf16_f32 v111, v198, v199
    s_mov_b32 s17, 0x16000
    buffer_load_dwordx4 v[200:203], v8, s[8:11], s17 offen offset:0
    buffer_load_dwordx4 v[204:207], v8, s[8:11], s17 offen offset:1024
    buffer_load_dwordx4 v[208:211], v8, s[8:11], s17 offen offset:2048
    buffer_load_dwordx4 v[212:215], v8, s[8:11], s17 offen offset:3072
    s_waitcnt vmcnt(3)
    v_mfma_f32_16x16x32_bf16 v[184:187], v[200:203], v[152:155], v[216:219]
    v_mfma_f32_16x16x32_bf16 v[188:191], v[200:203], v[168:171], v[220:223]
    s_waitcnt vmcnt(2)
    v_mfma_f32_16x16x32_bf16 v[192:195], v[204:207], v[152:155], v[216:219]
    v_mfma_f32_16x16x32_bf16 v[196:199], v[204:207], v[168:171], v[220:223]
    s_waitcnt vmcnt(1)
    v_mfma_f32_16x16x32_bf16 v[184:187], v[208:211], v[156:159], v[184:187]
    v_mfma_f32_16x16x32_bf16 v[188:191], v[208:211], v[172:175], v[188:191]
    s_waitcnt vmcnt(0)
    v_mfma_f32_16x16x32_bf16 v[192:195], v[212:215], v[156:159], v[192:195]
    v_mfma_f32_16x16x32_bf16 v[196:199], v[212:215], v[172:175], v[196:199]
    s_mov_b32 s17, 0x17000
    buffer_load_dwordx4 v[200:203], v8, s[8:11], s17 offen offset:0
    buffer_load_dwordx4 v[204:207], v8, s[8:11], s17 offen offset:1024
    buffer_load_dwordx4 v[208:211], v8, s[8:11], s17 offen offset:2048
    buffer_load_dwordx4 v[212:215], v8, s[8:11], s17 offen offset:3072
    s_waitcnt vmcnt(3)
    v_mfma_f32_16x16x32_bf16 v[184:187], v[200:203], v[160:163], v[184:187]
    v_mfma_f32_16x16x32_bf16 v[188:191], v[200:203], v[176:179], v[188:191]
    s_waitcnt vmcnt(2)
    v_mfma_f32_16x16x32_bf16 v[192:195], v[204:207], v[160:163], v[192:195]
    v_mfma_f32_16x16x32_bf16 v[196:199], v[204:207], v[176:179], v[196:199]
    s_waitcnt vmcnt(1)
    v_mfma_f32_16x16x32_bf16 v[184:187], v[208:211], v[164:167], v[184:187]
    v_mfma_f32_16x16x32_bf16 v[188:191], v[208:211], v[180:183], v[188:191]
    s_waitcnt vmcnt(0)
    v_mfma_f32_16x16x32_bf16 v[192:195], v[212:215], v[164:167], v[192:195]
    v_mfma_f32_16x16x32_bf16 v[196:199], v[212:215], v[180:183], v[196:199]
    s_nop 3
    v_exp_f32 v184, v184
    v_exp_f32 v185, v185
    v_add_f32 v9, v9, v184
    v_add_f32 v9, v9, v185
    v_cvt_pk_bf16_f32 v112, v184, v185
    v_exp_f32 v186, v186
    v_exp_f32 v187, v187
    v_add_f32 v9, v9, v186
    v_add_f32 v9, v9, v187
    v_cvt_pk_bf16_f32 v113, v186, v187
    v_exp_f32 v188, v188
    v_exp_f32 v189, v189
    v_add_f32 v10, v10, v188
    v_add_f32 v10, v10, v189
    v_cvt_pk_bf16_f32 v116, v188, v189
    v_exp_f32 v190, v190
    v_exp_f32 v191, v191
    v_add_f32 v10, v10, v190
    v_add_f32 v10, v10, v191
    v_cvt_pk_bf16_f32 v117, v190, v191
    v_exp_f32 v192, v192
    v_exp_f32 v193, v193
    v_add_f32 v9, v9, v192
    v_add_f32 v9, v9, v193
    v_cvt_pk_bf16_f32 v114, v192, v193
    v_exp_f32 v194, v194
    v_exp_f32 v195, v195
    v_add_f32 v9, v9, v194
    v_add_f32 v9, v9, v195
    v_cvt_pk_bf16_f32 v115, v194, v195
    v_exp_f32 v196, v196
    v_exp_f32 v197, v197
    v_add_f32 v10, v10, v196
    v_add_f32 v10, v10, v197
    v_cvt_pk_bf16_f32 v118, v196, v197
    v_exp_f32 v198, v198
    v_exp_f32 v199, v199
    v_add_f32 v10, v10, v198
    v_add_f32 v10, v10, v199
    v_cvt_pk_bf16_f32 v119, v198, v199
    s_mov_b32 s17, 0x18000
    buffer_load_dwordx4 v[200:203], v8, s[8:11], s17 offen offset:0
    buffer_load_dwordx4 v[204:207], v8, s[8:11], s17 offen offset:1024
    buffer_load_dwordx4 v[208:211], v8, s[8:11], s17 offen offset:2048
    buffer_load_dwordx4 v[212:215], v8, s[8:11], s17 offen offset:3072
    s_waitcnt vmcnt(3)
    v_mfma_f32_16x16x32_bf16 v[184:187], v[200:203], v[152:155], v[216:219]
    v_mfma_f32_16x16x32_bf16 v[188:191], v[200:203], v[168:171], v[220:223]
    s_waitcnt vmcnt(2)
    v_mfma_f32_16x16x32_bf16 v[192:195], v[204:207], v[152:155], v[216:219]
    v_mfma_f32_16x16x32_bf16 v[196:199], v[204:207], v[168:171], v[220:223]
    s_waitcnt vmcnt(1)
    v_mfma_f32_16x16x32_bf16 v[184:187], v[208:211], v[156:159], v[184:187]
    v_mfma_f32_16x16x32_bf16 v[188:191], v[208:211], v[172:175], v[188:191]
    s_waitcnt vmcnt(0)
    v_mfma_f32_16x16x32_bf16 v[192:195], v[212:215], v[156:159], v[192:195]
    v_mfma_f32_16x16x32_bf16 v[196:199], v[212:215], v[172:175], v[196:199]
    s_mov_b32 s17, 0x19000
    buffer_load_dwordx4 v[200:203], v8, s[8:11], s17 offen offset:0
    buffer_load_dwordx4 v[204:207], v8, s[8:11], s17 offen offset:1024
    buffer_load_dwordx4 v[208:211], v8, s[8:11], s17 offen offset:2048
    buffer_load_dwordx4 v[212:215], v8, s[8:11], s17 offen offset:3072
    s_waitcnt vmcnt(3)
    v_mfma_f32_16x16x32_bf16 v[184:187], v[200:203], v[160:163], v[184:187]
    v_mfma_f32_16x16x32_bf16 v[188:191], v[200:203], v[176:179], v[188:191]
    s_waitcnt vmcnt(2)
    v_mfma_f32_16x16x32_bf16 v[192:195], v[204:207], v[160:163], v[192:195]
    v_mfma_f32_16x16x32_bf16 v[196:199], v[204:207], v[176:179], v[196:199]
    s_waitcnt vmcnt(1)
    v_mfma_f32_16x16x32_bf16 v[184:187], v[208:211], v[164:167], v[184:187]
    v_mfma_f32_16x16x32_bf16 v[188:191], v[208:211], v[180:183], v[188:191]
    s_waitcnt vmcnt(0)
    v_mfma_f32_16x16x32_bf16 v[192:195], v[212:215], v[164:167], v[192:195]
    v_mfma_f32_16x16x32_bf16 v[196:199], v[212:215], v[180:183], v[196:199]
    s_nop 3
    v_exp_f32 v184, v184
    v_exp_f32 v185, v185
    v_add_f32 v9, v9, v184
    v_add_f32 v9, v9, v185
    v_cvt_pk_bf16_f32 v120, v184, v185
    v_exp_f32 v186, v186
    v_exp_f32 v187, v187
    v_add_f32 v9, v9, v186
    v_add_f32 v9, v9, v187
    v_cvt_pk_bf16_f32 v121, v186, v187
    v_exp_f32 v188, v188
    v_exp_f32 v189, v189
    v_add_f32 v10, v10, v188
    v_add_f32 v10, v10, v189
    v_cvt_pk_bf16_f32 v124, v188, v189
    v_exp_f32 v190, v190
    v_exp_f32 v191, v191
    v_add_f32 v10, v10, v190
    v_add_f32 v10, v10, v191
    v_cvt_pk_bf16_f32 v125, v190, v191
    v_exp_f32 v192, v192
    v_exp_f32 v193, v193
    v_add_f32 v9, v9, v192
    v_add_f32 v9, v9, v193
    v_cvt_pk_bf16_f32 v122, v192, v193
    v_exp_f32 v194, v194
    v_exp_f32 v195, v195
    v_add_f32 v9, v9, v194
    v_add_f32 v9, v9, v195
    v_cvt_pk_bf16_f32 v123, v194, v195
    v_exp_f32 v196, v196
    v_exp_f32 v197, v197
    v_add_f32 v10, v10, v196
    v_add_f32 v10, v10, v197
    v_cvt_pk_bf16_f32 v126, v196, v197
    v_exp_f32 v198, v198
    v_exp_f32 v199, v199
    v_add_f32 v10, v10, v198
    v_add_f32 v10, v10, v199
    v_cvt_pk_bf16_f32 v127, v198, v199
    s_mov_b32 s17, 0x1a000
    buffer_load_dwordx4 v[200:203], v8, s[8:11], s17 offen offset:0
    buffer_load_dwordx4 v[204:207], v8, s[8:11], s17 offen offset:1024
    buffer_load_dwordx4 v[208:211], v8, s[8:11], s17 offen offset:2048
    buffer_load_dwordx4 v[212:215], v8, s[8:11], s17 offen offset:3072
    s_waitcnt vmcnt(3)
    v_mfma_f32_16x16x32_bf16 v[184:187], v[200:203], v[152:155], v[216:219]
    v_mfma_f32_16x16x32_bf16 v[188:191], v[200:203], v[168:171], v[220:223]
    s_waitcnt vmcnt(2)
    v_mfma_f32_16x16x32_bf16 v[192:195], v[204:207], v[152:155], v[216:219]
    v_mfma_f32_16x16x32_bf16 v[196:199], v[204:207], v[168:171], v[220:223]
    s_waitcnt vmcnt(1)
    v_mfma_f32_16x16x32_bf16 v[184:187], v[208:211], v[156:159], v[184:187]
    v_mfma_f32_16x16x32_bf16 v[188:191], v[208:211], v[172:175], v[188:191]
    s_waitcnt vmcnt(0)
    v_mfma_f32_16x16x32_bf16 v[192:195], v[212:215], v[156:159], v[192:195]
    v_mfma_f32_16x16x32_bf16 v[196:199], v[212:215], v[172:175], v[196:199]
    s_mov_b32 s17, 0x1b000
    buffer_load_dwordx4 v[200:203], v8, s[8:11], s17 offen offset:0
    buffer_load_dwordx4 v[204:207], v8, s[8:11], s17 offen offset:1024
    buffer_load_dwordx4 v[208:211], v8, s[8:11], s17 offen offset:2048
    buffer_load_dwordx4 v[212:215], v8, s[8:11], s17 offen offset:3072
    s_waitcnt vmcnt(3)
    v_mfma_f32_16x16x32_bf16 v[184:187], v[200:203], v[160:163], v[184:187]
    v_mfma_f32_16x16x32_bf16 v[188:191], v[200:203], v[176:179], v[188:191]
    s_waitcnt vmcnt(2)
    v_mfma_f32_16x16x32_bf16 v[192:195], v[204:207], v[160:163], v[192:195]
    v_mfma_f32_16x16x32_bf16 v[196:199], v[204:207], v[176:179], v[196:199]
    s_waitcnt vmcnt(1)
    v_mfma_f32_16x16x32_bf16 v[184:187], v[208:211], v[164:167], v[184:187]
    v_mfma_f32_16x16x32_bf16 v[188:191], v[208:211], v[180:183], v[188:191]
    s_waitcnt vmcnt(0)
    v_mfma_f32_16x16x32_bf16 v[192:195], v[212:215], v[164:167], v[192:195]
    v_mfma_f32_16x16x32_bf16 v[196:199], v[212:215], v[180:183], v[196:199]
    s_nop 3
    v_exp_f32 v184, v184
    v_exp_f32 v185, v185
    v_add_f32 v9, v9, v184
    v_add_f32 v9, v9, v185
    v_cvt_pk_bf16_f32 v128, v184, v185
    v_exp_f32 v186, v186
    v_exp_f32 v187, v187
    v_add_f32 v9, v9, v186
    v_add_f32 v9, v9, v187
    v_cvt_pk_bf16_f32 v129, v186, v187
    v_exp_f32 v188, v188
    v_exp_f32 v189, v189
    v_add_f32 v10, v10, v188
    v_add_f32 v10, v10, v189
    v_cvt_pk_bf16_f32 v132, v188, v189
    v_exp_f32 v190, v190
    v_exp_f32 v191, v191
    v_add_f32 v10, v10, v190
    v_add_f32 v10, v10, v191
    v_cvt_pk_bf16_f32 v133, v190, v191
    v_exp_f32 v192, v192
    v_exp_f32 v193, v193
    v_add_f32 v9, v9, v192
    v_add_f32 v9, v9, v193
    v_cvt_pk_bf16_f32 v130, v192, v193
    v_exp_f32 v194, v194
    v_exp_f32 v195, v195
    v_add_f32 v9, v9, v194
    v_add_f32 v9, v9, v195
    v_cvt_pk_bf16_f32 v131, v194, v195
    v_exp_f32 v196, v196
    v_exp_f32 v197, v197
    v_add_f32 v10, v10, v196
    v_add_f32 v10, v10, v197
    v_cvt_pk_bf16_f32 v134, v196, v197
    v_exp_f32 v198, v198
    v_exp_f32 v199, v199
    v_add_f32 v10, v10, v198
    v_add_f32 v10, v10, v199
    v_cvt_pk_bf16_f32 v135, v198, v199
    s_mov_b32 s17, 0x1c000
    buffer_load_dwordx4 v[200:203], v8, s[8:11], s17 offen offset:0
    buffer_load_dwordx4 v[204:207], v8, s[8:11], s17 offen offset:1024
    buffer_load_dwordx4 v[208:211], v8, s[8:11], s17 offen offset:2048
    buffer_load_dwordx4 v[212:215], v8, s[8:11], s17 offen offset:3072
    s_waitcnt vmcnt(3)
    v_mfma_f32_16x16x32_bf16 v[184:187], v[200:203], v[152:155], v[216:219]
    v_mfma_f32_16x16x32_bf16 v[188:191], v[200:203], v[168:171], v[220:223]
    s_waitcnt vmcnt(2)
    v_mfma_f32_16x16x32_bf16 v[192:195], v[204:207], v[152:155], v[216:219]
    v_mfma_f32_16x16x32_bf16 v[196:199], v[204:207], v[168:171], v[220:223]
    s_waitcnt vmcnt(1)
    v_mfma_f32_16x16x32_bf16 v[184:187], v[208:211], v[156:159], v[184:187]
    v_mfma_f32_16x16x32_bf16 v[188:191], v[208:211], v[172:175], v[188:191]
    s_waitcnt vmcnt(0)
    v_mfma_f32_16x16x32_bf16 v[192:195], v[212:215], v[156:159], v[192:195]
    v_mfma_f32_16x16x32_bf16 v[196:199], v[212:215], v[172:175], v[196:199]
    s_mov_b32 s17, 0x1d000
    buffer_load_dwordx4 v[200:203], v8, s[8:11], s17 offen offset:0
    buffer_load_dwordx4 v[204:207], v8, s[8:11], s17 offen offset:1024
    buffer_load_dwordx4 v[208:211], v8, s[8:11], s17 offen offset:2048
    buffer_load_dwordx4 v[212:215], v8, s[8:11], s17 offen offset:3072
    s_waitcnt vmcnt(3)
    v_mfma_f32_16x16x32_bf16 v[184:187], v[200:203], v[160:163], v[184:187]
    v_mfma_f32_16x16x32_bf16 v[188:191], v[200:203], v[176:179], v[188:191]
    s_waitcnt vmcnt(2)
    v_mfma_f32_16x16x32_bf16 v[192:195], v[204:207], v[160:163], v[192:195]
    v_mfma_f32_16x16x32_bf16 v[196:199], v[204:207], v[176:179], v[196:199]
    s_waitcnt vmcnt(1)
    v_mfma_f32_16x16x32_bf16 v[184:187], v[208:211], v[164:167], v[184:187]
    v_mfma_f32_16x16x32_bf16 v[188:191], v[208:211], v[180:183], v[188:191]
    s_waitcnt vmcnt(0)
    v_mfma_f32_16x16x32_bf16 v[192:195], v[212:215], v[164:167], v[192:195]
    v_mfma_f32_16x16x32_bf16 v[196:199], v[212:215], v[180:183], v[196:199]
    s_nop 3
    v_exp_f32 v184, v184
    v_exp_f32 v185, v185
    v_add_f32 v9, v9, v184
    v_add_f32 v9, v9, v185
    v_cvt_pk_bf16_f32 v136, v184, v185
    v_exp_f32 v186, v186
    v_exp_f32 v187, v187
    v_add_f32 v9, v9, v186
    v_add_f32 v9, v9, v187
    v_cvt_pk_bf16_f32 v137, v186, v187
    v_exp_f32 v188, v188
    v_exp_f32 v189, v189
    v_add_f32 v10, v10, v188
    v_add_f32 v10, v10, v189
    v_cvt_pk_bf16_f32 v140, v188, v189
    v_exp_f32 v190, v190
    v_exp_f32 v191, v191
    v_add_f32 v10, v10, v190
    v_add_f32 v10, v10, v191
    v_cvt_pk_bf16_f32 v141, v190, v191
    v_exp_f32 v192, v192
    v_exp_f32 v193, v193
    v_add_f32 v9, v9, v192
    v_add_f32 v9, v9, v193
    v_cvt_pk_bf16_f32 v138, v192, v193
    v_exp_f32 v194, v194
    v_exp_f32 v195, v195
    v_add_f32 v9, v9, v194
    v_add_f32 v9, v9, v195
    v_cvt_pk_bf16_f32 v139, v194, v195
    v_exp_f32 v196, v196
    v_exp_f32 v197, v197
    v_add_f32 v10, v10, v196
    v_add_f32 v10, v10, v197
    v_cvt_pk_bf16_f32 v142, v196, v197
    v_exp_f32 v198, v198
    v_exp_f32 v199, v199
    v_add_f32 v10, v10, v198
    v_add_f32 v10, v10, v199
    v_cvt_pk_bf16_f32 v143, v198, v199
    s_mov_b32 s17, 0x1e000
    buffer_load_dwordx4 v[200:203], v8, s[8:11], s17 offen offset:0
    buffer_load_dwordx4 v[204:207], v8, s[8:11], s17 offen offset:1024
    buffer_load_dwordx4 v[208:211], v8, s[8:11], s17 offen offset:2048
    buffer_load_dwordx4 v[212:215], v8, s[8:11], s17 offen offset:3072
    s_waitcnt vmcnt(3)
    v_mfma_f32_16x16x32_bf16 v[184:187], v[200:203], v[152:155], v[216:219]
    v_mfma_f32_16x16x32_bf16 v[188:191], v[200:203], v[168:171], v[220:223]
    s_waitcnt vmcnt(2)
    v_mfma_f32_16x16x32_bf16 v[192:195], v[204:207], v[152:155], v[216:219]
    v_mfma_f32_16x16x32_bf16 v[196:199], v[204:207], v[168:171], v[220:223]
    s_waitcnt vmcnt(1)
    v_mfma_f32_16x16x32_bf16 v[184:187], v[208:211], v[156:159], v[184:187]
    v_mfma_f32_16x16x32_bf16 v[188:191], v[208:211], v[172:175], v[188:191]
    s_waitcnt vmcnt(0)
    v_mfma_f32_16x16x32_bf16 v[192:195], v[212:215], v[156:159], v[192:195]
    v_mfma_f32_16x16x32_bf16 v[196:199], v[212:215], v[172:175], v[196:199]
    s_mov_b32 s17, 0x1f000
    buffer_load_dwordx4 v[200:203], v8, s[8:11], s17 offen offset:0
    buffer_load_dwordx4 v[204:207], v8, s[8:11], s17 offen offset:1024
    buffer_load_dwordx4 v[208:211], v8, s[8:11], s17 offen offset:2048
    buffer_load_dwordx4 v[212:215], v8, s[8:11], s17 offen offset:3072
    s_waitcnt vmcnt(3)
    v_mfma_f32_16x16x32_bf16 v[184:187], v[200:203], v[160:163], v[184:187]
    v_mfma_f32_16x16x32_bf16 v[188:191], v[200:203], v[176:179], v[188:191]
    s_waitcnt vmcnt(2)
    v_mfma_f32_16x16x32_bf16 v[192:195], v[204:207], v[160:163], v[192:195]
    v_mfma_f32_16x16x32_bf16 v[196:199], v[204:207], v[176:179], v[196:199]
    s_waitcnt vmcnt(1)
    v_mfma_f32_16x16x32_bf16 v[184:187], v[208:211], v[164:167], v[184:187]
    v_mfma_f32_16x16x32_bf16 v[188:191], v[208:211], v[180:183], v[188:191]
    s_waitcnt vmcnt(0)
    v_mfma_f32_16x16x32_bf16 v[192:195], v[212:215], v[164:167], v[192:195]
    v_mfma_f32_16x16x32_bf16 v[196:199], v[212:215], v[180:183], v[196:199]
    s_nop 3
    v_exp_f32 v184, v184
    v_exp_f32 v185, v185
    v_add_f32 v9, v9, v184
    v_add_f32 v9, v9, v185
    v_cvt_pk_bf16_f32 v144, v184, v185
    v_exp_f32 v186, v186
    v_exp_f32 v187, v187
    v_add_f32 v9, v9, v186
    v_add_f32 v9, v9, v187
    v_cvt_pk_bf16_f32 v145, v186, v187
    v_exp_f32 v188, v188
    v_exp_f32 v189, v189
    v_add_f32 v10, v10, v188
    v_add_f32 v10, v10, v189
    v_cvt_pk_bf16_f32 v148, v188, v189
    v_exp_f32 v190, v190
    v_exp_f32 v191, v191
    v_add_f32 v10, v10, v190
    v_add_f32 v10, v10, v191
    v_cvt_pk_bf16_f32 v149, v190, v191
    v_exp_f32 v192, v192
    v_exp_f32 v193, v193
    v_add_f32 v9, v9, v192
    v_add_f32 v9, v9, v193
    v_cvt_pk_bf16_f32 v146, v192, v193
    v_exp_f32 v194, v194
    v_exp_f32 v195, v195
    v_add_f32 v9, v9, v194
    v_add_f32 v9, v9, v195
    v_cvt_pk_bf16_f32 v147, v194, v195
    v_exp_f32 v196, v196
    v_exp_f32 v197, v197
    v_add_f32 v10, v10, v196
    v_add_f32 v10, v10, v197
    v_cvt_pk_bf16_f32 v150, v196, v197
    v_exp_f32 v198, v198
    v_exp_f32 v199, v199
    v_add_f32 v10, v10, v198
    v_add_f32 v10, v10, v199
    v_cvt_pk_bf16_f32 v151, v198, v199
    v_mov_b32 v16, v9
    v_mov_b32 v18, v10
    s_nop 0
    v_permlane16_swap_b32 v9, v16
    v_permlane16_swap_b32 v10, v18
    v_add_f32 v9, v9, v16
    v_add_f32 v10, v10, v18
    v_mov_b32 v16, v9
    v_mov_b32 v18, v10
    s_nop 0
    v_permlane32_swap_b32 v9, v16
    v_permlane32_swap_b32 v10, v18
    v_add_f32 v9, v9, v16
    v_add_f32 v10, v10, v18
    s_waitcnt vmcnt(0) lgkmcnt(0)
    s_nop 15
    s_nop 3
    s_branch adaLN_cond__sliding_block_cached__moe_arch_mod__prompt_kernel_fixAb
adaLN_cond__sliding_block_cached__moe_arch_mod__prompt_kernel_o5r:
    s_waitcnt vmcnt(0) lgkmcnt(0)
    s_nop 15
    s_nop 3
    s_mov_b32 s27, 0
adaLN_cond__sliding_block_cached__moe_arch_mod__prompt_kernel_o5p:
    buffer_load_dword v12, v13, s[8:11], s19 offen sc1
    s_waitcnt vmcnt(0)
    v_cmp_ne_u32 vcc, s28, v12
    s_add_u32 s27, s27, 1
    s_cmp_ge_u32 s27, 65536
    s_cbranch_scc1 adaLN_cond__sliding_block_cached__moe_arch_mod__prompt_kernel_o5g
    s_cbranch_vccnz adaLN_cond__sliding_block_cached__moe_arch_mod__prompt_kernel_o5p
adaLN_cond__sliding_block_cached__moe_arch_mod__prompt_kernel_o5g:
    s_waitcnt vmcnt(0) lgkmcnt(0)
    s_nop 15
    s_nop 3
    s_branch adaLN_cond__sliding_block_cached__moe_arch_mod__prompt_kernel_o5b
adaLN_cond__sliding_block_cached__moe_arch_mod__prompt_kernel_o26r:
    s_waitcnt vmcnt(0) lgkmcnt(0)
    s_nop 15
    s_nop 3
    s_mov_b32 s27, 0
adaLN_cond__sliding_block_cached__moe_arch_mod__prompt_kernel_o26p:
    buffer_load_dword v12, v13, s[8:11], s19 offen sc1
    s_waitcnt vmcnt(0)
    v_cmp_ne_u32 vcc, s28, v12
    s_add_u32 s27, s27, 1
    s_cmp_ge_u32 s27, 65536
    s_cbranch_scc1 adaLN_cond__sliding_block_cached__moe_arch_mod__prompt_kernel_o26g
    s_cbranch_vccnz adaLN_cond__sliding_block_cached__moe_arch_mod__prompt_kernel_o26p
adaLN_cond__sliding_block_cached__moe_arch_mod__prompt_kernel_o26g:
    s_waitcnt vmcnt(0) lgkmcnt(0)
    s_nop 15
    s_nop 3
    s_branch adaLN_cond__sliding_block_cached__moe_arch_mod__prompt_kernel_o26b
adaLN_cond__sliding_block_cached__moe_arch_mod__prompt_kernel_mp7r:
    s_waitcnt vmcnt(0) lgkmcnt(0)
    s_nop 15
    s_nop 3
    s_mov_b32 s27, 0
adaLN_cond__sliding_block_cached__moe_arch_mod__prompt_kernel_mp7p:
    buffer_load_dword v248, v250, s[8:11], s14 offen sc1
    s_waitcnt vmcnt(0)
    v_cmp_ne_u32 vcc, s28, v248
    s_add_u32 s27, s27, 1
    s_cmp_ge_u32 s27, 65536
    s_cbranch_scc1 adaLN_cond__sliding_block_cached__moe_arch_mod__prompt_kernel_mp7g
    s_cbranch_vccnz adaLN_cond__sliding_block_cached__moe_arch_mod__prompt_kernel_mp7p
adaLN_cond__sliding_block_cached__moe_arch_mod__prompt_kernel_mp7g:
    s_waitcnt vmcnt(0) lgkmcnt(0)
    s_nop 15
    s_nop 3
    s_branch adaLN_cond__sliding_block_cached__moe_arch_mod__prompt_kernel_mp7b
adaLN_cond__sliding_block_cached__moe_arch_mod__prompt_kernel_o28r:
    s_waitcnt vmcnt(0) lgkmcnt(0)
    s_nop 15
    s_nop 3
    s_mov_b32 s27, 0
adaLN_cond__sliding_block_cached__moe_arch_mod__prompt_kernel_o28p:
    buffer_load_dword v12, v13, s[8:11], s19 offen sc1
    s_waitcnt vmcnt(0)
    v_cmp_ne_u32 vcc, s28, v12
    s_add_u32 s27, s27, 1
    s_cmp_ge_u32 s27, 65536
    s_cbranch_scc1 adaLN_cond__sliding_block_cached__moe_arch_mod__prompt_kernel_o28g
    s_cbranch_vccnz adaLN_cond__sliding_block_cached__moe_arch_mod__prompt_kernel_o28p
adaLN_cond__sliding_block_cached__moe_arch_mod__prompt_kernel_o28g:
    s_waitcnt vmcnt(0) lgkmcnt(0)
    s_nop 15
    s_nop 3
    s_branch adaLN_cond__sliding_block_cached__moe_arch_mod__prompt_kernel_o28b
adaLN_cond__sliding_block_cached__moe_arch_mod__prompt_kernel_o29r:
    s_waitcnt vmcnt(0) lgkmcnt(0)
    s_nop 15
    s_nop 3
    s_mov_b32 s27, 0
adaLN_cond__sliding_block_cached__moe_arch_mod__prompt_kernel_o29p:
    buffer_load_dword v12, v13, s[8:11], s19 offen sc1
    s_waitcnt vmcnt(0)
    v_cmp_ne_u32 vcc, s28, v12
    s_add_u32 s27, s27, 1
    s_cmp_ge_u32 s27, 65536
    s_cbranch_scc1 adaLN_cond__sliding_block_cached__moe_arch_mod__prompt_kernel_o29g
    s_cbranch_vccnz adaLN_cond__sliding_block_cached__moe_arch_mod__prompt_kernel_o29p
adaLN_cond__sliding_block_cached__moe_arch_mod__prompt_kernel_o29g:
    s_waitcnt vmcnt(0) lgkmcnt(0)
    s_nop 15
    s_nop 3
    s_branch adaLN_cond__sliding_block_cached__moe_arch_mod__prompt_kernel_o29b
adaLN_cond__sliding_block_cached__moe_arch_mod__prompt_kernel_mf10r:
    s_waitcnt vmcnt(0) lgkmcnt(0)
    s_nop 15
    s_nop 3
    s_mov_b32 s27, 0
adaLN_cond__sliding_block_cached__moe_arch_mod__prompt_kernel_mf10p:
    s_mov_b32 s16, 0x544000
    buffer_load_dwordx4 v[184:187], v2, s[8:11], s16 offen sc1
    s_waitcnt vmcnt(0)
    v_xor_b32 v16, s28, v184
    v_xor_b32 v17, s28, v185
    v_xor_b32 v18, s28, v186
    v_xor_b32 v19, s28, v187
    v_or3_b32 v16, v16, v17, v18
    v_or_b32 v16, v16, v19
    v_cmp_ne_u32 vcc, 0, v16
    s_add_u32 s27, s27, 1
    s_cmp_ge_u32 s27, 65536
    s_cbranch_scc1 adaLN_cond__sliding_block_cached__moe_arch_mod__prompt_kernel_mf10g
    s_cbranch_vccnz adaLN_cond__sliding_block_cached__moe_arch_mod__prompt_kernel_mf10p
adaLN_cond__sliding_block_cached__moe_arch_mod__prompt_kernel_mf10g:
    s_waitcnt vmcnt(0) lgkmcnt(0)
    s_nop 15
    s_nop 3
    s_branch adaLN_cond__sliding_block_cached__moe_arch_mod__prompt_kernel_mf10b
adaLN_cond__sliding_block_cached__moe_arch_mod__prompt_kernel_kv16r:
    s_waitcnt vmcnt(0) lgkmcnt(0)
    s_nop 15
    s_nop 3
    s_mov_b32 s27, 0
adaLN_cond__sliding_block_cached__moe_arch_mod__prompt_kernel_kv16p:
    buffer_load_dwordx4 v[12:15], v21, s[8:11], s18 offen sc1
    s_waitcnt vmcnt(0)
    v_xor_b32 v8, s28, v12
    v_xor_b32 v20, s28, v13
    v_or_b32 v8, v8, v20
    v_xor_b32 v20, s28, v14
    v_or_b32 v8, v8, v20
    v_xor_b32 v20, s28, v15
    v_or_b32 v8, v8, v20
    v_cmp_ne_u32 vcc, 0, v8
    s_add_u32 s27, s27, 1
    s_cmp_ge_u32 s27, 65536
    s_cbranch_scc1 adaLN_cond__sliding_block_cached__moe_arch_mod__prompt_kernel_kv16g
    s_cbranch_vccnz adaLN_cond__sliding_block_cached__moe_arch_mod__prompt_kernel_kv16p
adaLN_cond__sliding_block_cached__moe_arch_mod__prompt_kernel_kv16g:
    s_waitcnt vmcnt(0) lgkmcnt(0)
    s_nop 15
    s_nop 3
    s_branch adaLN_cond__sliding_block_cached__moe_arch_mod__prompt_kernel_kv16b
adaLN_cond__sliding_block_cached__moe_arch_mod__prompt_kernel_fixB:
    s_waitcnt vmcnt(0) lgkmcnt(0)
    s_nop 15
    s_nop 3
    s_lshr_b32 s16, s12, 3
    s_lshl_b32 s16, s16, 17
    s_add_u32 s16, s16, 0x400000
    v_add_u32 v8, s16, v2
    v_mov_b32 v16, 0xff7fffff
    v_mov_b32 v17, 0xff7fffff
    s_mov_b32 s16, 0
adaLN_cond__sliding_block_cached__moe_arch_mod__prompt_kernel_fixBm:
    s_add_u32 s17, s16, 0
    buffer_load_dwordx4 v[200:203], v8, s[8:11], s17 offen offset:0
    buffer_load_dwordx4 v[204:207], v8, s[8:11], s17 offen offset:1024
    buffer_load_dwordx4 v[208:211], v8, s[8:11], s17 offen offset:2048
    buffer_load_dwordx4 v[212:215], v8, s[8:11], s17 offen offset:3072
    s_waitcnt vmcnt(3)
    v_mfma_f32_16x16x32_bf16 v[184:187], v[200:203], v[152:155], 0
    v_mfma_f32_16x16x32_bf16 v[188:191], v[200:203], v[168:171], 0
    s_waitcnt vmcnt(2)
    v_mfma_f32_16x16x32_bf16 v[192:195], v[204:207], v[152:155], 0
    v_mfma_f32_16x16x32_bf16 v[196:199], v[204:207], v[168:171], 0
    s_waitcnt vmcnt(1)
    v_mfma_f32_16x16x32_bf16 v[184:187], v[208:211], v[156:159], v[184:187]
    v_mfma_f32_16x16x32_bf16 v[188:191], v[208:211], v[172:175], v[188:191]
    s_waitcnt vmcnt(0)
    v_mfma_f32_16x16x32_bf16 v[192:195], v[212:215], v[156:159], v[192:195]
    v_mfma_f32_16x16x32_bf16 v[196:199], v[212:215], v[172:175], v[196:199]
    s_add_u32 s17, s16, 4096
    buffer_load_dwordx4 v[200:203], v8, s[8:11], s17 offen offset:0
    buffer_load_dwordx4 v[204:207], v8, s[8:11], s17 offen offset:1024
    buffer_load_dwordx4 v[208:211], v8, s[8:11], s17 offen offset:2048
    buffer_load_dwordx4 v[212:215], v8, s[8:11], s17 offen offset:3072
    s_waitcnt vmcnt(3)
    v_mfma_f32_16x16x32_bf16 v[184:187], v[200:203], v[160:163], v[184:187]
    v_mfma_f32_16x16x32_bf16 v[188:191], v[200:203], v[176:179], v[188:191]
    s_waitcnt vmcnt(2)
    v_mfma_f32_16x16x32_bf16 v[192:195], v[204:207], v[160:163], v[192:195]
    v_mfma_f32_16x16x32_bf16 v[196:199], v[204:207], v[176:179], v[196:199]
    s_waitcnt vmcnt(1)
    v_mfma_f32_16x16x32_bf16 v[184:187], v[208:211], v[164:167], v[184:187]
    v_mfma_f32_16x16x32_bf16 v[188:191], v[208:211], v[180:183], v[188:191]
    s_waitcnt vmcnt(0)
    v_mfma_f32_16x16x32_bf16 v[192:195], v[212:215], v[164:167], v[192:195]
    v_mfma_f32_16x16x32_bf16 v[196:199], v[212:215], v[180:183], v[196:199]
    s_nop 3
    v_max3_f32 v16, v16, v184, v185
    v_max3_f32 v16, v16, v186, v187
    v_max3_f32 v17, v17, v188, v189
    v_max3_f32 v17, v17, v190, v191
    v_max3_f32 v16, v16, v192, v193
    v_max3_f32 v16, v16, v194, v195
    v_max3_f32 v17, v17, v196, v197
    v_max3_f32 v17, v17, v198, v199
    s_add_u32 s16, s16, 8192
    s_cmp_lt_u32 s16, 0x20000
    s_cbranch_scc1 adaLN_cond__sliding_block_cached__moe_arch_mod__prompt_kernel_fixBm
    v_mov_b32 v18, v16
    v_mov_b32 v19, v17
    s_nop 0
    v_permlane16_swap_b32 v16, v18
    v_permlane16_swap_b32 v17, v19
    v_max_f32 v16, v16, v18
    v_max_f32 v17, v17, v19
    v_mov_b32 v18, v16
    v_mov_b32 v19, v17
    s_nop 0
    v_permlane32_swap_b32 v16, v18
    v_permlane32_swap_b32 v17, v19
    v_max_f32 v16, v16, v18
    v_max_f32 v17, v17, v19
    v_sub_f32 v216, 0, v16
    v_sub_f32 v217, 0, v16
    v_sub_f32 v218, 0, v16
    v_sub_f32 v219, 0, v16
    v_sub_f32 v220, 0, v17
    v_sub_f32 v221, 0, v17
    v_sub_f32 v222, 0, v17
    v_sub_f32 v223, 0, v17
    s_mov_b32 s17, 0x0
    buffer_load_dwordx4 v[200:203], v8, s[8:11], s17 offen offset:0
    buffer_load_dwordx4 v[204:207], v8, s[8:11], s17 offen offset:1024
    buffer_load_dwordx4 v[208:211], v8, s[8:11], s17 offen offset:2048
    buffer_load_dwordx4 v[212:215], v8, s[8:11], s17 offen offset:3072
    s_waitcnt vmcnt(3)
    v_mfma_f32_16x16x32_bf16 v[184:187], v[200:203], v[152:155], v[216:219]
    v_mfma_f32_16x16x32_bf16 v[188:191], v[200:203], v[168:171], v[220:223]
    s_waitcnt vmcnt(2)
    v_mfma_f32_16x16x32_bf16 v[192:195], v[204:207], v[152:155], v[216:219]
    v_mfma_f32_16x16x32_bf16 v[196:199], v[204:207], v[168:171], v[220:223]
    s_waitcnt vmcnt(1)
    v_mfma_f32_16x16x32_bf16 v[184:187], v[208:211], v[156:159], v[184:187]
    v_mfma_f32_16x16x32_bf16 v[188:191], v[208:211], v[172:175], v[188:191]
    s_waitcnt vmcnt(0)
    v_mfma_f32_16x16x32_bf16 v[192:195], v[212:215], v[156:159], v[192:195]
    v_mfma_f32_16x16x32_bf16 v[196:199], v[212:215], v[172:175], v[196:199]
    s_mov_b32 s17, 0x1000
    buffer_load_dwordx4 v[200:203], v8, s[8:11], s17 offen offset:0
    buffer_load_dwordx4 v[204:207], v8, s[8:11], s17 offen offset:1024
    buffer_load_dwordx4 v[208:211], v8, s[8:11], s17 offen offset:2048
    buffer_load_dwordx4 v[212:215], v8, s[8:11], s17 offen offset:3072
    s_waitcnt vmcnt(3)
    v_mfma_f32_16x16x32_bf16 v[184:187], v[200:203], v[160:163], v[184:187]
    v_mfma_f32_16x16x32_bf16 v[188:191], v[200:203], v[176:179], v[188:191]
    s_waitcnt vmcnt(2)
    v_mfma_f32_16x16x32_bf16 v[192:195], v[204:207], v[160:163], v[192:195]
    v_mfma_f32_16x16x32_bf16 v[196:199], v[204:207], v[176:179], v[196:199]
    s_waitcnt vmcnt(1)
    v_mfma_f32_16x16x32_bf16 v[184:187], v[208:211], v[164:167], v[184:187]
    v_mfma_f32_16x16x32_bf16 v[188:191], v[208:211], v[180:183], v[188:191]
    s_waitcnt vmcnt(0)
    v_mfma_f32_16x16x32_bf16 v[192:195], v[212:215], v[164:167], v[192:195]
    v_mfma_f32_16x16x32_bf16 v[196:199], v[212:215], v[180:183], v[196:199]
    s_nop 3
    v_exp_f32 v184, v184
    v_exp_f32 v185, v185
    s_nop 0
    v_add_f32 v9, v184, v185
    v_cvt_pk_bf16_f32 v24, v184, v185
    v_exp_f32 v186, v186
    v_exp_f32 v187, v187
    v_add_f32 v9, v9, v186
    v_add_f32 v9, v9, v187
    v_cvt_pk_bf16_f32 v25, v186, v187
    v_exp_f32 v188, v188
    v_exp_f32 v189, v189
    s_nop 0
    v_add_f32 v10, v188, v189
    v_cvt_pk_bf16_f32 v28, v188, v189
    v_exp_f32 v190, v190
    v_exp_f32 v191, v191
    v_add_f32 v10, v10, v190
    v_add_f32 v10, v10, v191
    v_cvt_pk_bf16_f32 v29, v190, v191
    v_exp_f32 v192, v192
    v_exp_f32 v193, v193
    v_add_f32 v9, v9, v192
    v_add_f32 v9, v9, v193
    v_cvt_pk_bf16_f32 v26, v192, v193
    v_exp_f32 v194, v194
    v_exp_f32 v195, v195
    v_add_f32 v9, v9, v194
    v_add_f32 v9, v9, v195
    v_cvt_pk_bf16_f32 v27, v194, v195
    v_exp_f32 v196, v196
    v_exp_f32 v197, v197
    v_add_f32 v10, v10, v196
    v_add_f32 v10, v10, v197
    v_cvt_pk_bf16_f32 v30, v196, v197
    v_exp_f32 v198, v198
    v_exp_f32 v199, v199
    v_add_f32 v10, v10, v198
    v_add_f32 v10, v10, v199
    v_cvt_pk_bf16_f32 v31, v198, v199
    s_mov_b32 s17, 0x2000
    buffer_load_dwordx4 v[200:203], v8, s[8:11], s17 offen offset:0
    buffer_load_dwordx4 v[204:207], v8, s[8:11], s17 offen offset:1024
    buffer_load_dwordx4 v[208:211], v8, s[8:11], s17 offen offset:2048
    buffer_load_dwordx4 v[212:215], v8, s[8:11], s17 offen offset:3072
    s_waitcnt vmcnt(3)
    v_mfma_f32_16x16x32_bf16 v[184:187], v[200:203], v[152:155], v[216:219]
    v_mfma_f32_16x16x32_bf16 v[188:191], v[200:203], v[168:171], v[220:223]
    s_waitcnt vmcnt(2)
    v_mfma_f32_16x16x32_bf16 v[192:195], v[204:207], v[152:155], v[216:219]
    v_mfma_f32_16x16x32_bf16 v[196:199], v[204:207], v[168:171], v[220:223]
    s_waitcnt vmcnt(1)
    v_mfma_f32_16x16x32_bf16 v[184:187], v[208:211], v[156:159], v[184:187]
    v_mfma_f32_16x16x32_bf16 v[188:191], v[208:211], v[172:175], v[188:191]
    s_waitcnt vmcnt(0)
    v_mfma_f32_16x16x32_bf16 v[192:195], v[212:215], v[156:159], v[192:195]
    v_mfma_f32_16x16x32_bf16 v[196:199], v[212:215], v[172:175], v[196:199]
    s_mov_b32 s17, 0x3000
    buffer_load_dwordx4 v[200:203], v8, s[8:11], s17 offen offset:0
    buffer_load_dwordx4 v[204:207], v8, s[8:11], s17 offen offset:1024
    buffer_load_dwordx4 v[208:211], v8, s[8:11], s17 offen offset:2048
    buffer_load_dwordx4 v[212:215], v8, s[8:11], s17 offen offset:3072
    s_waitcnt vmcnt(3)
    v_mfma_f32_16x16x32_bf16 v[184:187], v[200:203], v[160:163], v[184:187]
    v_mfma_f32_16x16x32_bf16 v[188:191], v[200:203], v[176:179], v[188:191]
    s_waitcnt vmcnt(2)
    v_mfma_f32_16x16x32_bf16 v[192:195], v[204:207], v[160:163], v[192:195]
    v_mfma_f32_16x16x32_bf16 v[196:199], v[204:207], v[176:179], v[196:199]
    s_waitcnt vmcnt(1)
    v_mfma_f32_16x16x32_bf16 v[184:187], v[208:211], v[164:167], v[184:187]
    v_mfma_f32_16x16x32_bf16 v[188:191], v[208:211], v[180:183], v[188:191]
    s_waitcnt vmcnt(0)
    v_mfma_f32_16x16x32_bf16 v[192:195], v[212:215], v[164:167], v[192:195]
    v_mfma_f32_16x16x32_bf16 v[196:199], v[212:215], v[180:183], v[196:199]
    s_nop 3
    v_exp_f32 v184, v184
    v_exp_f32 v185, v185
    v_add_f32 v9, v9, v184
    v_add_f32 v9, v9, v185
    v_cvt_pk_bf16_f32 v32, v184, v185
    v_exp_f32 v186, v186
    v_exp_f32 v187, v187
    v_add_f32 v9, v9, v186
    v_add_f32 v9, v9, v187
    v_cvt_pk_bf16_f32 v33, v186, v187
    v_exp_f32 v188, v188
    v_exp_f32 v189, v189
    v_add_f32 v10, v10, v188
    v_add_f32 v10, v10, v189
    v_cvt_pk_bf16_f32 v36, v188, v189
    v_exp_f32 v190, v190
    v_exp_f32 v191, v191
    v_add_f32 v10, v10, v190
    v_add_f32 v10, v10, v191
    v_cvt_pk_bf16_f32 v37, v190, v191
    v_exp_f32 v192, v192
    v_exp_f32 v193, v193
    v_add_f32 v9, v9, v192
    v_add_f32 v9, v9, v193
    v_cvt_pk_bf16_f32 v34, v192, v193
    v_exp_f32 v194, v194
    v_exp_f32 v195, v195
    v_add_f32 v9, v9, v194
    v_add_f32 v9, v9, v195
    v_cvt_pk_bf16_f32 v35, v194, v195
    v_exp_f32 v196, v196
    v_exp_f32 v197, v197
    v_add_f32 v10, v10, v196
    v_add_f32 v10, v10, v197
    v_cvt_pk_bf16_f32 v38, v196, v197
    v_exp_f32 v198, v198
    v_exp_f32 v199, v199
    v_add_f32 v10, v10, v198
    v_add_f32 v10, v10, v199
    v_cvt_pk_bf16_f32 v39, v198, v199
    s_mov_b32 s17, 0x4000
    buffer_load_dwordx4 v[200:203], v8, s[8:11], s17 offen offset:0
    buffer_load_dwordx4 v[204:207], v8, s[8:11], s17 offen offset:1024
    buffer_load_dwordx4 v[208:211], v8, s[8:11], s17 offen offset:2048
    buffer_load_dwordx4 v[212:215], v8, s[8:11], s17 offen offset:3072
    s_waitcnt vmcnt(3)
    v_mfma_f32_16x16x32_bf16 v[184:187], v[200:203], v[152:155], v[216:219]
    v_mfma_f32_16x16x32_bf16 v[188:191], v[200:203], v[168:171], v[220:223]
    s_waitcnt vmcnt(2)
    v_mfma_f32_16x16x32_bf16 v[192:195], v[204:207], v[152:155], v[216:219]
    v_mfma_f32_16x16x32_bf16 v[196:199], v[204:207], v[168:171], v[220:223]
    s_waitcnt vmcnt(1)
    v_mfma_f32_16x16x32_bf16 v[184:187], v[208:211], v[156:159], v[184:187]
    v_mfma_f32_16x16x32_bf16 v[188:191], v[208:211], v[172:175], v[188:191]
    s_waitcnt vmcnt(0)
    v_mfma_f32_16x16x32_bf16 v[192:195], v[212:215], v[156:159], v[192:195]
    v_mfma_f32_16x16x32_bf16 v[196:199], v[212:215], v[172:175], v[196:199]
    s_mov_b32 s17, 0x5000
    buffer_load_dwordx4 v[200:203], v8, s[8:11], s17 offen offset:0
    buffer_load_dwordx4 v[204:207], v8, s[8:11], s17 offen offset:1024
    buffer_load_dwordx4 v[208:211], v8, s[8:11], s17 offen offset:2048
    buffer_load_dwordx4 v[212:215], v8, s[8:11], s17 offen offset:3072
    s_waitcnt vmcnt(3)
    v_mfma_f32_16x16x32_bf16 v[184:187], v[200:203], v[160:163], v[184:187]
    v_mfma_f32_16x16x32_bf16 v[188:191], v[200:203], v[176:179], v[188:191]
    s_waitcnt vmcnt(2)
    v_mfma_f32_16x16x32_bf16 v[192:195], v[204:207], v[160:163], v[192:195]
    v_mfma_f32_16x16x32_bf16 v[196:199], v[204:207], v[176:179], v[196:199]
    s_waitcnt vmcnt(1)
    v_mfma_f32_16x16x32_bf16 v[184:187], v[208:211], v[164:167], v[184:187]
    v_mfma_f32_16x16x32_bf16 v[188:191], v[208:211], v[180:183], v[188:191]
    s_waitcnt vmcnt(0)
    v_mfma_f32_16x16x32_bf16 v[192:195], v[212:215], v[164:167], v[192:195]
    v_mfma_f32_16x16x32_bf16 v[196:199], v[212:215], v[180:183], v[196:199]
    s_nop 3
    v_exp_f32 v184, v184
    v_exp_f32 v185, v185
    v_add_f32 v9, v9, v184
    v_add_f32 v9, v9, v185
    v_cvt_pk_bf16_f32 v40, v184, v185
    v_exp_f32 v186, v186
    v_exp_f32 v187, v187
    v_add_f32 v9, v9, v186
    v_add_f32 v9, v9, v187
    v_cvt_pk_bf16_f32 v41, v186, v187
    v_exp_f32 v188, v188
    v_exp_f32 v189, v189
    v_add_f32 v10, v10, v188
    v_add_f32 v10, v10, v189
    v_cvt_pk_bf16_f32 v44, v188, v189
    v_exp_f32 v190, v190
    v_exp_f32 v191, v191
    v_add_f32 v10, v10, v190
    v_add_f32 v10, v10, v191
    v_cvt_pk_bf16_f32 v45, v190, v191
    v_exp_f32 v192, v192
    v_exp_f32 v193, v193
    v_add_f32 v9, v9, v192
    v_add_f32 v9, v9, v193
    v_cvt_pk_bf16_f32 v42, v192, v193
    v_exp_f32 v194, v194
    v_exp_f32 v195, v195
    v_add_f32 v9, v9, v194
    v_add_f32 v9, v9, v195
    v_cvt_pk_bf16_f32 v43, v194, v195
    v_exp_f32 v196, v196
    v_exp_f32 v197, v197
    v_add_f32 v10, v10, v196
    v_add_f32 v10, v10, v197
    v_cvt_pk_bf16_f32 v46, v196, v197
    v_exp_f32 v198, v198
    v_exp_f32 v199, v199
    v_add_f32 v10, v10, v198
    v_add_f32 v10, v10, v199
    v_cvt_pk_bf16_f32 v47, v198, v199
    s_mov_b32 s17, 0x6000
    buffer_load_dwordx4 v[200:203], v8, s[8:11], s17 offen offset:0
    buffer_load_dwordx4 v[204:207], v8, s[8:11], s17 offen offset:1024
    buffer_load_dwordx4 v[208:211], v8, s[8:11], s17 offen offset:2048
    buffer_load_dwordx4 v[212:215], v8, s[8:11], s17 offen offset:3072
    s_waitcnt vmcnt(3)
    v_mfma_f32_16x16x32_bf16 v[184:187], v[200:203], v[152:155], v[216:219]
    v_mfma_f32_16x16x32_bf16 v[188:191], v[200:203], v[168:171], v[220:223]
    s_waitcnt vmcnt(2)
    v_mfma_f32_16x16x32_bf16 v[192:195], v[204:207], v[152:155], v[216:219]
    v_mfma_f32_16x16x32_bf16 v[196:199], v[204:207], v[168:171], v[220:223]
    s_waitcnt vmcnt(1)
    v_mfma_f32_16x16x32_bf16 v[184:187], v[208:211], v[156:159], v[184:187]
    v_mfma_f32_16x16x32_bf16 v[188:191], v[208:211], v[172:175], v[188:191]
    s_waitcnt vmcnt(0)
    v_mfma_f32_16x16x32_bf16 v[192:195], v[212:215], v[156:159], v[192:195]
    v_mfma_f32_16x16x32_bf16 v[196:199], v[212:215], v[172:175], v[196:199]
    s_mov_b32 s17, 0x7000
    buffer_load_dwordx4 v[200:203], v8, s[8:11], s17 offen offset:0
    buffer_load_dwordx4 v[204:207], v8, s[8:11], s17 offen offset:1024
    buffer_load_dwordx4 v[208:211], v8, s[8:11], s17 offen offset:2048
    buffer_load_dwordx4 v[212:215], v8, s[8:11], s17 offen offset:3072
    s_waitcnt vmcnt(3)
    v_mfma_f32_16x16x32_bf16 v[184:187], v[200:203], v[160:163], v[184:187]
    v_mfma_f32_16x16x32_bf16 v[188:191], v[200:203], v[176:179], v[188:191]
    s_waitcnt vmcnt(2)
    v_mfma_f32_16x16x32_bf16 v[192:195], v[204:207], v[160:163], v[192:195]
    v_mfma_f32_16x16x32_bf16 v[196:199], v[204:207], v[176:179], v[196:199]
    s_waitcnt vmcnt(1)
    v_mfma_f32_16x16x32_bf16 v[184:187], v[208:211], v[164:167], v[184:187]
    v_mfma_f32_16x16x32_bf16 v[188:191], v[208:211], v[180:183], v[188:191]
    s_waitcnt vmcnt(0)
    v_mfma_f32_16x16x32_bf16 v[192:195], v[212:215], v[164:167], v[192:195]
    v_mfma_f32_16x16x32_bf16 v[196:199], v[212:215], v[180:183], v[196:199]
    s_nop 3
    v_exp_f32 v184, v184
    v_exp_f32 v185, v185
    v_add_f32 v9, v9, v184
    v_add_f32 v9, v9, v185
    v_cvt_pk_bf16_f32 v48, v184, v185
    v_exp_f32 v186, v186
    v_exp_f32 v187, v187
    v_add_f32 v9, v9, v186
    v_add_f32 v9, v9, v187
    v_cvt_pk_bf16_f32 v49, v186, v187
    v_exp_f32 v188, v188
    v_exp_f32 v189, v189
    v_add_f32 v10, v10, v188
    v_add_f32 v10, v10, v189
    v_cvt_pk_bf16_f32 v52, v188, v189
    v_exp_f32 v190, v190
    v_exp_f32 v191, v191
    v_add_f32 v10, v10, v190
    v_add_f32 v10, v10, v191
    v_cvt_pk_bf16_f32 v53, v190, v191
    v_exp_f32 v192, v192
    v_exp_f32 v193, v193
    v_add_f32 v9, v9, v192
    v_add_f32 v9, v9, v193
    v_cvt_pk_bf16_f32 v50, v192, v193
    v_exp_f32 v194, v194
    v_exp_f32 v195, v195
    v_add_f32 v9, v9, v194
    v_add_f32 v9, v9, v195
    v_cvt_pk_bf16_f32 v51, v194, v195
    v_exp_f32 v196, v196
    v_exp_f32 v197, v197
    v_add_f32 v10, v10, v196
    v_add_f32 v10, v10, v197
    v_cvt_pk_bf16_f32 v54, v196, v197
    v_exp_f32 v198, v198
    v_exp_f32 v199, v199
    v_add_f32 v10, v10, v198
    v_add_f32 v10, v10, v199
    v_cvt_pk_bf16_f32 v55, v198, v199
    s_mov_b32 s17, 0x8000
    buffer_load_dwordx4 v[200:203], v8, s[8:11], s17 offen offset:0
    buffer_load_dwordx4 v[204:207], v8, s[8:11], s17 offen offset:1024
    buffer_load_dwordx4 v[208:211], v8, s[8:11], s17 offen offset:2048
    buffer_load_dwordx4 v[212:215], v8, s[8:11], s17 offen offset:3072
    s_waitcnt vmcnt(3)
    v_mfma_f32_16x16x32_bf16 v[184:187], v[200:203], v[152:155], v[216:219]
    v_mfma_f32_16x16x32_bf16 v[188:191], v[200:203], v[168:171], v[220:223]
    s_waitcnt vmcnt(2)
    v_mfma_f32_16x16x32_bf16 v[192:195], v[204:207], v[152:155], v[216:219]
    v_mfma_f32_16x16x32_bf16 v[196:199], v[204:207], v[168:171], v[220:223]
    s_waitcnt vmcnt(1)
    v_mfma_f32_16x16x32_bf16 v[184:187], v[208:211], v[156:159], v[184:187]
    v_mfma_f32_16x16x32_bf16 v[188:191], v[208:211], v[172:175], v[188:191]
    s_waitcnt vmcnt(0)
    v_mfma_f32_16x16x32_bf16 v[192:195], v[212:215], v[156:159], v[192:195]
    v_mfma_f32_16x16x32_bf16 v[196:199], v[212:215], v[172:175], v[196:199]
    s_mov_b32 s17, 0x9000
    buffer_load_dwordx4 v[200:203], v8, s[8:11], s17 offen offset:0
    buffer_load_dwordx4 v[204:207], v8, s[8:11], s17 offen offset:1024
    buffer_load_dwordx4 v[208:211], v8, s[8:11], s17 offen offset:2048
    buffer_load_dwordx4 v[212:215], v8, s[8:11], s17 offen offset:3072
    s_waitcnt vmcnt(3)
    v_mfma_f32_16x16x32_bf16 v[184:187], v[200:203], v[160:163], v[184:187]
    v_mfma_f32_16x16x32_bf16 v[188:191], v[200:203], v[176:179], v[188:191]
    s_waitcnt vmcnt(2)
    v_mfma_f32_16x16x32_bf16 v[192:195], v[204:207], v[160:163], v[192:195]
    v_mfma_f32_16x16x32_bf16 v[196:199], v[204:207], v[176:179], v[196:199]
    s_waitcnt vmcnt(1)
    v_mfma_f32_16x16x32_bf16 v[184:187], v[208:211], v[164:167], v[184:187]
    v_mfma_f32_16x16x32_bf16 v[188:191], v[208:211], v[180:183], v[188:191]
    s_waitcnt vmcnt(0)
    v_mfma_f32_16x16x32_bf16 v[192:195], v[212:215], v[164:167], v[192:195]
    v_mfma_f32_16x16x32_bf16 v[196:199], v[212:215], v[180:183], v[196:199]
    s_nop 3
    v_exp_f32 v184, v184
    v_exp_f32 v185, v185
    v_add_f32 v9, v9, v184
    v_add_f32 v9, v9, v185
    v_cvt_pk_bf16_f32 v56, v184, v185
    v_exp_f32 v186, v186
    v_exp_f32 v187, v187
    v_add_f32 v9, v9, v186
    v_add_f32 v9, v9, v187
    v_cvt_pk_bf16_f32 v57, v186, v187
    v_exp_f32 v188, v188
    v_exp_f32 v189, v189
    v_add_f32 v10, v10, v188
    v_add_f32 v10, v10, v189
    v_cvt_pk_bf16_f32 v60, v188, v189
    v_exp_f32 v190, v190
    v_exp_f32 v191, v191
    v_add_f32 v10, v10, v190
    v_add_f32 v10, v10, v191
    v_cvt_pk_bf16_f32 v61, v190, v191
    v_exp_f32 v192, v192
    v_exp_f32 v193, v193
    v_add_f32 v9, v9, v192
    v_add_f32 v9, v9, v193
    v_cvt_pk_bf16_f32 v58, v192, v193
    v_exp_f32 v194, v194
    v_exp_f32 v195, v195
    v_add_f32 v9, v9, v194
    v_add_f32 v9, v9, v195
    v_cvt_pk_bf16_f32 v59, v194, v195
    v_exp_f32 v196, v196
    v_exp_f32 v197, v197
    v_add_f32 v10, v10, v196
    v_add_f32 v10, v10, v197
    v_cvt_pk_bf16_f32 v62, v196, v197
    v_exp_f32 v198, v198
    v_exp_f32 v199, v199
    v_add_f32 v10, v10, v198
    v_add_f32 v10, v10, v199
    v_cvt_pk_bf16_f32 v63, v198, v199
    s_mov_b32 s17, 0xa000
    buffer_load_dwordx4 v[200:203], v8, s[8:11], s17 offen offset:0
    buffer_load_dwordx4 v[204:207], v8, s[8:11], s17 offen offset:1024
    buffer_load_dwordx4 v[208:211], v8, s[8:11], s17 offen offset:2048
    buffer_load_dwordx4 v[212:215], v8, s[8:11], s17 offen offset:3072
    s_waitcnt vmcnt(3)
    v_mfma_f32_16x16x32_bf16 v[184:187], v[200:203], v[152:155], v[216:219]
    v_mfma_f32_16x16x32_bf16 v[188:191], v[200:203], v[168:171], v[220:223]
    s_waitcnt vmcnt(2)
    v_mfma_f32_16x16x32_bf16 v[192:195], v[204:207], v[152:155], v[216:219]
    v_mfma_f32_16x16x32_bf16 v[196:199], v[204:207], v[168:171], v[220:223]
    s_waitcnt vmcnt(1)
    v_mfma_f32_16x16x32_bf16 v[184:187], v[208:211], v[156:159], v[184:187]
    v_mfma_f32_16x16x32_bf16 v[188:191], v[208:211], v[172:175], v[188:191]
    s_waitcnt vmcnt(0)
    v_mfma_f32_16x16x32_bf16 v[192:195], v[212:215], v[156:159], v[192:195]
    v_mfma_f32_16x16x32_bf16 v[196:199], v[212:215], v[172:175], v[196:199]
    s_mov_b32 s17, 0xb000
    buffer_load_dwordx4 v[200:203], v8, s[8:11], s17 offen offset:0
    buffer_load_dwordx4 v[204:207], v8, s[8:11], s17 offen offset:1024
    buffer_load_dwordx4 v[208:211], v8, s[8:11], s17 offen offset:2048
    buffer_load_dwordx4 v[212:215], v8, s[8:11], s17 offen offset:3072
    s_waitcnt vmcnt(3)
    v_mfma_f32_16x16x32_bf16 v[184:187], v[200:203], v[160:163], v[184:187]
    v_mfma_f32_16x16x32_bf16 v[188:191], v[200:203], v[176:179], v[188:191]
    s_waitcnt vmcnt(2)
    v_mfma_f32_16x16x32_bf16 v[192:195], v[204:207], v[160:163], v[192:195]
    v_mfma_f32_16x16x32_bf16 v[196:199], v[204:207], v[176:179], v[196:199]
    s_waitcnt vmcnt(1)
    v_mfma_f32_16x16x32_bf16 v[184:187], v[208:211], v[164:167], v[184:187]
    v_mfma_f32_16x16x32_bf16 v[188:191], v[208:211], v[180:183], v[188:191]
    s_waitcnt vmcnt(0)
    v_mfma_f32_16x16x32_bf16 v[192:195], v[212:215], v[164:167], v[192:195]
    v_mfma_f32_16x16x32_bf16 v[196:199], v[212:215], v[180:183], v[196:199]
    s_nop 3
    v_exp_f32 v184, v184
    v_exp_f32 v185, v185
    v_add_f32 v9, v9, v184
    v_add_f32 v9, v9, v185
    v_cvt_pk_bf16_f32 v64, v184, v185
    v_exp_f32 v186, v186
    v_exp_f32 v187, v187
    v_add_f32 v9, v9, v186
    v_add_f32 v9, v9, v187
    v_cvt_pk_bf16_f32 v65, v186, v187
    v_exp_f32 v188, v188
    v_exp_f32 v189, v189
    v_add_f32 v10, v10, v188
    v_add_f32 v10, v10, v189
    v_cvt_pk_bf16_f32 v68, v188, v189
    v_exp_f32 v190, v190
    v_exp_f32 v191, v191
    v_add_f32 v10, v10, v190
    v_add_f32 v10, v10, v191
    v_cvt_pk_bf16_f32 v69, v190, v191
    v_exp_f32 v192, v192
    v_exp_f32 v193, v193
    v_add_f32 v9, v9, v192
    v_add_f32 v9, v9, v193
    v_cvt_pk_bf16_f32 v66, v192, v193
    v_exp_f32 v194, v194
    v_exp_f32 v195, v195
    v_add_f32 v9, v9, v194
    v_add_f32 v9, v9, v195
    v_cvt_pk_bf16_f32 v67, v194, v195
    v_exp_f32 v196, v196
    v_exp_f32 v197, v197
    v_add_f32 v10, v10, v196
    v_add_f32 v10, v10, v197
    v_cvt_pk_bf16_f32 v70, v196, v197
    v_exp_f32 v198, v198
    v_exp_f32 v199, v199
    v_add_f32 v10, v10, v198
    v_add_f32 v10, v10, v199
    v_cvt_pk_bf16_f32 v71, v198, v199
    s_mov_b32 s17, 0xc000
    buffer_load_dwordx4 v[200:203], v8, s[8:11], s17 offen offset:0
    buffer_load_dwordx4 v[204:207], v8, s[8:11], s17 offen offset:1024
    buffer_load_dwordx4 v[208:211], v8, s[8:11], s17 offen offset:2048
    buffer_load_dwordx4 v[212:215], v8, s[8:11], s17 offen offset:3072
    s_waitcnt vmcnt(3)
    v_mfma_f32_16x16x32_bf16 v[184:187], v[200:203], v[152:155], v[216:219]
    v_mfma_f32_16x16x32_bf16 v[188:191], v[200:203], v[168:171], v[220:223]
    s_waitcnt vmcnt(2)
    v_mfma_f32_16x16x32_bf16 v[192:195], v[204:207], v[152:155], v[216:219]
    v_mfma_f32_16x16x32_bf16 v[196:199], v[204:207], v[168:171], v[220:223]
    s_waitcnt vmcnt(1)
    v_mfma_f32_16x16x32_bf16 v[184:187], v[208:211], v[156:159], v[184:187]
    v_mfma_f32_16x16x32_bf16 v[188:191], v[208:211], v[172:175], v[188:191]
    s_waitcnt vmcnt(0)
    v_mfma_f32_16x16x32_bf16 v[192:195], v[212:215], v[156:159], v[192:195]
    v_mfma_f32_16x16x32_bf16 v[196:199], v[212:215], v[172:175], v[196:199]
    s_mov_b32 s17, 0xd000
    buffer_load_dwordx4 v[200:203], v8, s[8:11], s17 offen offset:0
    buffer_load_dwordx4 v[204:207], v8, s[8:11], s17 offen offset:1024
    buffer_load_dwordx4 v[208:211], v8, s[8:11], s17 offen offset:2048
    buffer_load_dwordx4 v[212:215], v8, s[8:11], s17 offen offset:3072
    s_waitcnt vmcnt(3)
    v_mfma_f32_16x16x32_bf16 v[184:187], v[200:203], v[160:163], v[184:187]
    v_mfma_f32_16x16x32_bf16 v[188:191], v[200:203], v[176:179], v[188:191]
    s_waitcnt vmcnt(2)
    v_mfma_f32_16x16x32_bf16 v[192:195], v[204:207], v[160:163], v[192:195]
    v_mfma_f32_16x16x32_bf16 v[196:199], v[204:207], v[176:179], v[196:199]
    s_waitcnt vmcnt(1)
    v_mfma_f32_16x16x32_bf16 v[184:187], v[208:211], v[164:167], v[184:187]
    v_mfma_f32_16x16x32_bf16 v[188:191], v[208:211], v[180:183], v[188:191]
    s_waitcnt vmcnt(0)
    v_mfma_f32_16x16x32_bf16 v[192:195], v[212:215], v[164:167], v[192:195]
    v_mfma_f32_16x16x32_bf16 v[196:199], v[212:215], v[180:183], v[196:199]
    s_nop 3
    v_exp_f32 v184, v184
    v_exp_f32 v185, v185
    v_add_f32 v9, v9, v184
    v_add_f32 v9, v9, v185
    v_cvt_pk_bf16_f32 v72, v184, v185
    v_exp_f32 v186, v186
    v_exp_f32 v187, v187
    v_add_f32 v9, v9, v186
    v_add_f32 v9, v9, v187
    v_cvt_pk_bf16_f32 v73, v186, v187
    v_exp_f32 v188, v188
    v_exp_f32 v189, v189
    v_add_f32 v10, v10, v188
    v_add_f32 v10, v10, v189
    v_cvt_pk_bf16_f32 v76, v188, v189
    v_exp_f32 v190, v190
    v_exp_f32 v191, v191
    v_add_f32 v10, v10, v190
    v_add_f32 v10, v10, v191
    v_cvt_pk_bf16_f32 v77, v190, v191
    v_exp_f32 v192, v192
    v_exp_f32 v193, v193
    v_add_f32 v9, v9, v192
    v_add_f32 v9, v9, v193
    v_cvt_pk_bf16_f32 v74, v192, v193
    v_exp_f32 v194, v194
    v_exp_f32 v195, v195
    v_add_f32 v9, v9, v194
    v_add_f32 v9, v9, v195
    v_cvt_pk_bf16_f32 v75, v194, v195
    v_exp_f32 v196, v196
    v_exp_f32 v197, v197
    v_add_f32 v10, v10, v196
    v_add_f32 v10, v10, v197
    v_cvt_pk_bf16_f32 v78, v196, v197
    v_exp_f32 v198, v198
    v_exp_f32 v199, v199
    v_add_f32 v10, v10, v198
    v_add_f32 v10, v10, v199
    v_cvt_pk_bf16_f32 v79, v198, v199
    s_mov_b32 s17, 0xe000
    buffer_load_dwordx4 v[200:203], v8, s[8:11], s17 offen offset:0
    buffer_load_dwordx4 v[204:207], v8, s[8:11], s17 offen offset:1024
    buffer_load_dwordx4 v[208:211], v8, s[8:11], s17 offen offset:2048
    buffer_load_dwordx4 v[212:215], v8, s[8:11], s17 offen offset:3072
    s_waitcnt vmcnt(3)
    v_mfma_f32_16x16x32_bf16 v[184:187], v[200:203], v[152:155], v[216:219]
    v_mfma_f32_16x16x32_bf16 v[188:191], v[200:203], v[168:171], v[220:223]
    s_waitcnt vmcnt(2)
    v_mfma_f32_16x16x32_bf16 v[192:195], v[204:207], v[152:155], v[216:219]
    v_mfma_f32_16x16x32_bf16 v[196:199], v[204:207], v[168:171], v[220:223]
    s_waitcnt vmcnt(1)
    v_mfma_f32_16x16x32_bf16 v[184:187], v[208:211], v[156:159], v[184:187]
    v_mfma_f32_16x16x32_bf16 v[188:191], v[208:211], v[172:175], v[188:191]
    s_waitcnt vmcnt(0)
    v_mfma_f32_16x16x32_bf16 v[192:195], v[212:215], v[156:159], v[192:195]
    v_mfma_f32_16x16x32_bf16 v[196:199], v[212:215], v[172:175], v[196:199]
    s_mov_b32 s17, 0xf000
    buffer_load_dwordx4 v[200:203], v8, s[8:11], s17 offen offset:0
    buffer_load_dwordx4 v[204:207], v8, s[8:11], s17 offen offset:1024
    buffer_load_dwordx4 v[208:211], v8, s[8:11], s17 offen offset:2048
    buffer_load_dwordx4 v[212:215], v8, s[8:11], s17 offen offset:3072
    s_waitcnt vmcnt(3)
    v_mfma_f32_16x16x32_bf16 v[184:187], v[200:203], v[160:163], v[184:187]
    v_mfma_f32_16x16x32_bf16 v[188:191], v[200:203], v[176:179], v[188:191]
    s_waitcnt vmcnt(2)
    v_mfma_f32_16x16x32_bf16 v[192:195], v[204:207], v[160:163], v[192:195]
    v_mfma_f32_16x16x32_bf16 v[196:199], v[204:207], v[176:179], v[196:199]
    s_waitcnt vmcnt(1)
    v_mfma_f32_16x16x32_bf16 v[184:187], v[208:211], v[164:167], v[184:187]
    v_mfma_f32_16x16x32_bf16 v[188:191], v[208:211], v[180:183], v[188:191]
    s_waitcnt vmcnt(0)
    v_mfma_f32_16x16x32_bf16 v[192:195], v[212:215], v[164:167], v[192:195]
    v_mfma_f32_16x16x32_bf16 v[196:199], v[212:215], v[180:183], v[196:199]
    s_nop 3
    v_exp_f32 v184, v184
    v_exp_f32 v185, v185
    v_add_f32 v9, v9, v184
    v_add_f32 v9, v9, v185
    v_cvt_pk_bf16_f32 v80, v184, v185
    v_exp_f32 v186, v186
    v_exp_f32 v187, v187
    v_add_f32 v9, v9, v186
    v_add_f32 v9, v9, v187
    v_cvt_pk_bf16_f32 v81, v186, v187
    v_exp_f32 v188, v188
    v_exp_f32 v189, v189
    v_add_f32 v10, v10, v188
    v_add_f32 v10, v10, v189
    v_cvt_pk_bf16_f32 v84, v188, v189
    v_exp_f32 v190, v190
    v_exp_f32 v191, v191
    v_add_f32 v10, v10, v190
    v_add_f32 v10, v10, v191
    v_cvt_pk_bf16_f32 v85, v190, v191
    v_exp_f32 v192, v192
    v_exp_f32 v193, v193
    v_add_f32 v9, v9, v192
    v_add_f32 v9, v9, v193
    v_cvt_pk_bf16_f32 v82, v192, v193
    v_exp_f32 v194, v194
    v_exp_f32 v195, v195
    v_add_f32 v9, v9, v194
    v_add_f32 v9, v9, v195
    v_cvt_pk_bf16_f32 v83, v194, v195
    v_exp_f32 v196, v196
    v_exp_f32 v197, v197
    v_add_f32 v10, v10, v196
    v_add_f32 v10, v10, v197
    v_cvt_pk_bf16_f32 v86, v196, v197
    v_exp_f32 v198, v198
    v_exp_f32 v199, v199
    v_add_f32 v10, v10, v198
    v_add_f32 v10, v10, v199
    v_cvt_pk_bf16_f32 v87, v198, v199
    s_mov_b32 s17, 0x10000
    buffer_load_dwordx4 v[200:203], v8, s[8:11], s17 offen offset:0
    buffer_load_dwordx4 v[204:207], v8, s[8:11], s17 offen offset:1024
    buffer_load_dwordx4 v[208:211], v8, s[8:11], s17 offen offset:2048
    buffer_load_dwordx4 v[212:215], v8, s[8:11], s17 offen offset:3072
    s_waitcnt vmcnt(3)
    v_mfma_f32_16x16x32_bf16 v[184:187], v[200:203], v[152:155], v[216:219]
    v_mfma_f32_16x16x32_bf16 v[188:191], v[200:203], v[168:171], v[220:223]
    s_waitcnt vmcnt(2)
    v_mfma_f32_16x16x32_bf16 v[192:195], v[204:207], v[152:155], v[216:219]
    v_mfma_f32_16x16x32_bf16 v[196:199], v[204:207], v[168:171], v[220:223]
    s_waitcnt vmcnt(1)
    v_mfma_f32_16x16x32_bf16 v[184:187], v[208:211], v[156:159], v[184:187]
    v_mfma_f32_16x16x32_bf16 v[188:191], v[208:211], v[172:175], v[188:191]
    s_waitcnt vmcnt(0)
    v_mfma_f32_16x16x32_bf16 v[192:195], v[212:215], v[156:159], v[192:195]
    v_mfma_f32_16x16x32_bf16 v[196:199], v[212:215], v[172:175], v[196:199]
    s_mov_b32 s17, 0x11000
    buffer_load_dwordx4 v[200:203], v8, s[8:11], s17 offen offset:0
    buffer_load_dwordx4 v[204:207], v8, s[8:11], s17 offen offset:1024
    buffer_load_dwordx4 v[208:211], v8, s[8:11], s17 offen offset:2048
    buffer_load_dwordx4 v[212:215], v8, s[8:11], s17 offen offset:3072
    s_waitcnt vmcnt(3)
    v_mfma_f32_16x16x32_bf16 v[184:187], v[200:203], v[160:163], v[184:187]
    v_mfma_f32_16x16x32_bf16 v[188:191], v[200:203], v[176:179], v[188:191]
    s_waitcnt vmcnt(2)
    v_mfma_f32_16x16x32_bf16 v[192:195], v[204:207], v[160:163], v[192:195]
    v_mfma_f32_16x16x32_bf16 v[196:199], v[204:207], v[176:179], v[196:199]
    s_waitcnt vmcnt(1)
    v_mfma_f32_16x16x32_bf16 v[184:187], v[208:211], v[164:167], v[184:187]
    v_mfma_f32_16x16x32_bf16 v[188:191], v[208:211], v[180:183], v[188:191]
    s_waitcnt vmcnt(0)
    v_mfma_f32_16x16x32_bf16 v[192:195], v[212:215], v[164:167], v[192:195]
    v_mfma_f32_16x16x32_bf16 v[196:199], v[212:215], v[180:183], v[196:199]
    s_nop 3
    v_exp_f32 v184, v184
    v_exp_f32 v185, v185
    v_add_f32 v9, v9, v184
    v_add_f32 v9, v9, v185
    v_cvt_pk_bf16_f32 v88, v184, v185
    v_exp_f32 v186, v186
    v_exp_f32 v187, v187
    v_add_f32 v9, v9, v186
    v_add_f32 v9, v9, v187
    v_cvt_pk_bf16_f32 v89, v186, v187
    v_exp_f32 v188, v188
    v_exp_f32 v189, v189
    v_add_f32 v10, v10, v188
    v_add_f32 v10, v10, v189
    v_cvt_pk_bf16_f32 v92, v188, v189
    v_exp_f32 v190, v190
    v_exp_f32 v191, v191
    v_add_f32 v10, v10, v190
    v_add_f32 v10, v10, v191
    v_cvt_pk_bf16_f32 v93, v190, v191
    v_exp_f32 v192, v192
    v_exp_f32 v193, v193
    v_add_f32 v9, v9, v192
    v_add_f32 v9, v9, v193
    v_cvt_pk_bf16_f32 v90, v192, v193
    v_exp_f32 v194, v194
    v_exp_f32 v195, v195
    v_add_f32 v9, v9, v194
    v_add_f32 v9, v9, v195
    v_cvt_pk_bf16_f32 v91, v194, v195
    v_exp_f32 v196, v196
    v_exp_f32 v197, v197
    v_add_f32 v10, v10, v196
    v_add_f32 v10, v10, v197
    v_cvt_pk_bf16_f32 v94, v196, v197
    v_exp_f32 v198, v198
    v_exp_f32 v199, v199
    v_add_f32 v10, v10, v198
    v_add_f32 v10, v10, v199
    v_cvt_pk_bf16_f32 v95, v198, v199
    s_mov_b32 s17, 0x12000
    buffer_load_dwordx4 v[200:203], v8, s[8:11], s17 offen offset:0
    buffer_load_dwordx4 v[204:207], v8, s[8:11], s17 offen offset:1024
    buffer_load_dwordx4 v[208:211], v8, s[8:11], s17 offen offset:2048
    buffer_load_dwordx4 v[212:215], v8, s[8:11], s17 offen offset:3072
    s_waitcnt vmcnt(3)
    v_mfma_f32_16x16x32_bf16 v[184:187], v[200:203], v[152:155], v[216:219]
    v_mfma_f32_16x16x32_bf16 v[188:191], v[200:203], v[168:171], v[220:223]
    s_waitcnt vmcnt(2)
    v_mfma_f32_16x16x32_bf16 v[192:195], v[204:207], v[152:155], v[216:219]
    v_mfma_f32_16x16x32_bf16 v[196:199], v[204:207], v[168:171], v[220:223]
    s_waitcnt vmcnt(1)
    v_mfma_f32_16x16x32_bf16 v[184:187], v[208:211], v[156:159], v[184:187]
    v_mfma_f32_16x16x32_bf16 v[188:191], v[208:211], v[172:175], v[188:191]
    s_waitcnt vmcnt(0)
    v_mfma_f32_16x16x32_bf16 v[192:195], v[212:215], v[156:159], v[192:195]
    v_mfma_f32_16x16x32_bf16 v[196:199], v[212:215], v[172:175], v[196:199]
    s_mov_b32 s17, 0x13000
    buffer_load_dwordx4 v[200:203], v8, s[8:11], s17 offen offset:0
    buffer_load_dwordx4 v[204:207], v8, s[8:11], s17 offen offset:1024
    buffer_load_dwordx4 v[208:211], v8, s[8:11], s17 offen offset:2048
    buffer_load_dwordx4 v[212:215], v8, s[8:11], s17 offen offset:3072
    s_waitcnt vmcnt(3)
    v_mfma_f32_16x16x32_bf16 v[184:187], v[200:203], v[160:163], v[184:187]
    v_mfma_f32_16x16x32_bf16 v[188:191], v[200:203], v[176:179], v[188:191]
    s_waitcnt vmcnt(2)
    v_mfma_f32_16x16x32_bf16 v[192:195], v[204:207], v[160:163], v[192:195]
    v_mfma_f32_16x16x32_bf16 v[196:199], v[204:207], v[176:179], v[196:199]
    s_waitcnt vmcnt(1)
    v_mfma_f32_16x16x32_bf16 v[184:187], v[208:211], v[164:167], v[184:187]
    v_mfma_f32_16x16x32_bf16 v[188:191], v[208:211], v[180:183], v[188:191]
    s_waitcnt vmcnt(0)
    v_mfma_f32_16x16x32_bf16 v[192:195], v[212:215], v[164:167], v[192:195]
    v_mfma_f32_16x16x32_bf16 v[196:199], v[212:215], v[180:183], v[196:199]
    s_nop 3
    v_exp_f32 v184, v184
    v_exp_f32 v185, v185
    v_add_f32 v9, v9, v184
    v_add_f32 v9, v9, v185
    v_cvt_pk_bf16_f32 v96, v184, v185
    v_exp_f32 v186, v186
    v_exp_f32 v187, v187
    v_add_f32 v9, v9, v186
    v_add_f32 v9, v9, v187
    v_cvt_pk_bf16_f32 v97, v186, v187
    v_exp_f32 v188, v188
    v_exp_f32 v189, v189
    v_add_f32 v10, v10, v188
    v_add_f32 v10, v10, v189
    v_cvt_pk_bf16_f32 v100, v188, v189
    v_exp_f32 v190, v190
    v_exp_f32 v191, v191
    v_add_f32 v10, v10, v190
    v_add_f32 v10, v10, v191
    v_cvt_pk_bf16_f32 v101, v190, v191
    v_exp_f32 v192, v192
    v_exp_f32 v193, v193
    v_add_f32 v9, v9, v192
    v_add_f32 v9, v9, v193
    v_cvt_pk_bf16_f32 v98, v192, v193
    v_exp_f32 v194, v194
    v_exp_f32 v195, v195
    v_add_f32 v9, v9, v194
    v_add_f32 v9, v9, v195
    v_cvt_pk_bf16_f32 v99, v194, v195
    v_exp_f32 v196, v196
    v_exp_f32 v197, v197
    v_add_f32 v10, v10, v196
    v_add_f32 v10, v10, v197
    v_cvt_pk_bf16_f32 v102, v196, v197
    v_exp_f32 v198, v198
    v_exp_f32 v199, v199
    v_add_f32 v10, v10, v198
    v_add_f32 v10, v10, v199
    v_cvt_pk_bf16_f32 v103, v198, v199
    s_mov_b32 s17, 0x14000
    buffer_load_dwordx4 v[200:203], v8, s[8:11], s17 offen offset:0
    buffer_load_dwordx4 v[204:207], v8, s[8:11], s17 offen offset:1024
    buffer_load_dwordx4 v[208:211], v8, s[8:11], s17 offen offset:2048
    buffer_load_dwordx4 v[212:215], v8, s[8:11], s17 offen offset:3072
    s_waitcnt vmcnt(3)
    v_mfma_f32_16x16x32_bf16 v[184:187], v[200:203], v[152:155], v[216:219]
    v_mfma_f32_16x16x32_bf16 v[188:191], v[200:203], v[168:171], v[220:223]
    s_waitcnt vmcnt(2)
    v_mfma_f32_16x16x32_bf16 v[192:195], v[204:207], v[152:155], v[216:219]
    v_mfma_f32_16x16x32_bf16 v[196:199], v[204:207], v[168:171], v[220:223]
    s_waitcnt vmcnt(1)
    v_mfma_f32_16x16x32_bf16 v[184:187], v[208:211], v[156:159], v[184:187]
    v_mfma_f32_16x16x32_bf16 v[188:191], v[208:211], v[172:175], v[188:191]
    s_waitcnt vmcnt(0)
    v_mfma_f32_16x16x32_bf16 v[192:195], v[212:215], v[156:159], v[192:195]
    v_mfma_f32_16x16x32_bf16 v[196:199], v[212:215], v[172:175], v[196:199]
    s_mov_b32 s17, 0x15000
    buffer_load_dwordx4 v[200:203], v8, s[8:11], s17 offen offset:0
    buffer_load_dwordx4 v[204:207], v8, s[8:11], s17 offen offset:1024
    buffer_load_dwordx4 v[208:211], v8, s[8:11], s17 offen offset:2048
    buffer_load_dwordx4 v[212:215], v8, s[8:11], s17 offen offset:3072
    s_waitcnt vmcnt(3)
    v_mfma_f32_16x16x32_bf16 v[184:187], v[200:203], v[160:163], v[184:187]
    v_mfma_f32_16x16x32_bf16 v[188:191], v[200:203], v[176:179], v[188:191]
    s_waitcnt vmcnt(2)
    v_mfma_f32_16x16x32_bf16 v[192:195], v[204:207], v[160:163], v[192:195]
    v_mfma_f32_16x16x32_bf16 v[196:199], v[204:207], v[176:179], v[196:199]
    s_waitcnt vmcnt(1)
    v_mfma_f32_16x16x32_bf16 v[184:187], v[208:211], v[164:167], v[184:187]
    v_mfma_f32_16x16x32_bf16 v[188:191], v[208:211], v[180:183], v[188:191]
    s_waitcnt vmcnt(0)
    v_mfma_f32_16x16x32_bf16 v[192:195], v[212:215], v[164:167], v[192:195]
    v_mfma_f32_16x16x32_bf16 v[196:199], v[212:215], v[180:183], v[196:199]
    s_nop 3
    v_exp_f32 v184, v184
    v_exp_f32 v185, v185
    v_add_f32 v9, v9, v184
    v_add_f32 v9, v9, v185
    v_cvt_pk_bf16_f32 v104, v184, v185
    v_exp_f32 v186, v186
    v_exp_f32 v187, v187
    v_add_f32 v9, v9, v186
    v_add_f32 v9, v9, v187
    v_cvt_pk_bf16_f32 v105, v186, v187
    v_exp_f32 v188, v188
    v_exp_f32 v189, v189
    v_add_f32 v10, v10, v188
    v_add_f32 v10, v10, v189
    v_cvt_pk_bf16_f32 v108, v188, v189
    v_exp_f32 v190, v190
    v_exp_f32 v191, v191
    v_add_f32 v10, v10, v190
    v_add_f32 v10, v10, v191
    v_cvt_pk_bf16_f32 v109, v190, v191
    v_exp_f32 v192, v192
    v_exp_f32 v193, v193
    v_add_f32 v9, v9, v192
    v_add_f32 v9, v9, v193
    v_cvt_pk_bf16_f32 v106, v192, v193
    v_exp_f32 v194, v194
    v_exp_f32 v195, v195
    v_add_f32 v9, v9, v194
    v_add_f32 v9, v9, v195
    v_cvt_pk_bf16_f32 v107, v194, v195
    v_exp_f32 v196, v196
    v_exp_f32 v197, v197
    v_add_f32 v10, v10, v196
    v_add_f32 v10, v10, v197
    v_cvt_pk_bf16_f32 v110, v196, v197
    v_exp_f32 v198, v198
    v_exp_f32 v199, v199
    v_add_f32 v10, v10, v198
    v_add_f32 v10, v10, v199
    v_cvt_pk_bf16_f32 v111, v198, v199
    s_mov_b32 s17, 0x16000
    buffer_load_dwordx4 v[200:203], v8, s[8:11], s17 offen offset:0
    buffer_load_dwordx4 v[204:207], v8, s[8:11], s17 offen offset:1024
    buffer_load_dwordx4 v[208:211], v8, s[8:11], s17 offen offset:2048
    buffer_load_dwordx4 v[212:215], v8, s[8:11], s17 offen offset:3072
    s_waitcnt vmcnt(3)
    v_mfma_f32_16x16x32_bf16 v[184:187], v[200:203], v[152:155], v[216:219]
    v_mfma_f32_16x16x32_bf16 v[188:191], v[200:203], v[168:171], v[220:223]
    s_waitcnt vmcnt(2)
    v_mfma_f32_16x16x32_bf16 v[192:195], v[204:207], v[152:155], v[216:219]
    v_mfma_f32_16x16x32_bf16 v[196:199], v[204:207], v[168:171], v[220:223]
    s_waitcnt vmcnt(1)
    v_mfma_f32_16x16x32_bf16 v[184:187], v[208:211], v[156:159], v[184:187]
    v_mfma_f32_16x16x32_bf16 v[188:191], v[208:211], v[172:175], v[188:191]
    s_waitcnt vmcnt(0)
    v_mfma_f32_16x16x32_bf16 v[192:195], v[212:215], v[156:159], v[192:195]
    v_mfma_f32_16x16x32_bf16 v[196:199], v[212:215], v[172:175], v[196:199]
    s_mov_b32 s17, 0x17000
    buffer_load_dwordx4 v[200:203], v8, s[8:11], s17 offen offset:0
    buffer_load_dwordx4 v[204:207], v8, s[8:11], s17 offen offset:1024
    buffer_load_dwordx4 v[208:211], v8, s[8:11], s17 offen offset:2048
    buffer_load_dwordx4 v[212:215], v8, s[8:11], s17 offen offset:3072
    s_waitcnt vmcnt(3)
    v_mfma_f32_16x16x32_bf16 v[184:187], v[200:203], v[160:163], v[184:187]
    v_mfma_f32_16x16x32_bf16 v[188:191], v[200:203], v[176:179], v[188:191]
    s_waitcnt vmcnt(2)
    v_mfma_f32_16x16x32_bf16 v[192:195], v[204:207], v[160:163], v[192:195]
    v_mfma_f32_16x16x32_bf16 v[196:199], v[204:207], v[176:179], v[196:199]
    s_waitcnt vmcnt(1)
    v_mfma_f32_16x16x32_bf16 v[184:187], v[208:211], v[164:167], v[184:187]
    v_mfma_f32_16x16x32_bf16 v[188:191], v[208:211], v[180:183], v[188:191]
    s_waitcnt vmcnt(0)
    v_mfma_f32_16x16x32_bf16 v[192:195], v[212:215], v[164:167], v[192:195]
    v_mfma_f32_16x16x32_bf16 v[196:199], v[212:215], v[180:183], v[196:199]
    s_nop 3
    v_exp_f32 v184, v184
    v_exp_f32 v185, v185
    v_add_f32 v9, v9, v184
    v_add_f32 v9, v9, v185
    v_cvt_pk_bf16_f32 v112, v184, v185
    v_exp_f32 v186, v186
    v_exp_f32 v187, v187
    v_add_f32 v9, v9, v186
    v_add_f32 v9, v9, v187
    v_cvt_pk_bf16_f32 v113, v186, v187
    v_exp_f32 v188, v188
    v_exp_f32 v189, v189
    v_add_f32 v10, v10, v188
    v_add_f32 v10, v10, v189
    v_cvt_pk_bf16_f32 v116, v188, v189
    v_exp_f32 v190, v190
    v_exp_f32 v191, v191
    v_add_f32 v10, v10, v190
    v_add_f32 v10, v10, v191
    v_cvt_pk_bf16_f32 v117, v190, v191
    v_exp_f32 v192, v192
    v_exp_f32 v193, v193
    v_add_f32 v9, v9, v192
    v_add_f32 v9, v9, v193
    v_cvt_pk_bf16_f32 v114, v192, v193
    v_exp_f32 v194, v194
    v_exp_f32 v195, v195
    v_add_f32 v9, v9, v194
    v_add_f32 v9, v9, v195
    v_cvt_pk_bf16_f32 v115, v194, v195
    v_exp_f32 v196, v196
    v_exp_f32 v197, v197
    v_add_f32 v10, v10, v196
    v_add_f32 v10, v10, v197
    v_cvt_pk_bf16_f32 v118, v196, v197
    v_exp_f32 v198, v198
    v_exp_f32 v199, v199
    v_add_f32 v10, v10, v198
    v_add_f32 v10, v10, v199
    v_cvt_pk_bf16_f32 v119, v198, v199
    s_mov_b32 s17, 0x18000
    buffer_load_dwordx4 v[200:203], v8, s[8:11], s17 offen offset:0
    buffer_load_dwordx4 v[204:207], v8, s[8:11], s17 offen offset:1024
    buffer_load_dwordx4 v[208:211], v8, s[8:11], s17 offen offset:2048
    buffer_load_dwordx4 v[212:215], v8, s[8:11], s17 offen offset:3072
    s_waitcnt vmcnt(3)
    v_mfma_f32_16x16x32_bf16 v[184:187], v[200:203], v[152:155], v[216:219]
    v_mfma_f32_16x16x32_bf16 v[188:191], v[200:203], v[168:171], v[220:223]
    s_waitcnt vmcnt(2)
    v_mfma_f32_16x16x32_bf16 v[192:195], v[204:207], v[152:155], v[216:219]
    v_mfma_f32_16x16x32_bf16 v[196:199], v[204:207], v[168:171], v[220:223]
    s_waitcnt vmcnt(1)
    v_mfma_f32_16x16x32_bf16 v[184:187], v[208:211], v[156:159], v[184:187]
    v_mfma_f32_16x16x32_bf16 v[188:191], v[208:211], v[172:175], v[188:191]
    s_waitcnt vmcnt(0)
    v_mfma_f32_16x16x32_bf16 v[192:195], v[212:215], v[156:159], v[192:195]
    v_mfma_f32_16x16x32_bf16 v[196:199], v[212:215], v[172:175], v[196:199]
    s_mov_b32 s17, 0x19000
    buffer_load_dwordx4 v[200:203], v8, s[8:11], s17 offen offset:0
    buffer_load_dwordx4 v[204:207], v8, s[8:11], s17 offen offset:1024
    buffer_load_dwordx4 v[208:211], v8, s[8:11], s17 offen offset:2048
    buffer_load_dwordx4 v[212:215], v8, s[8:11], s17 offen offset:3072
    s_waitcnt vmcnt(3)
    v_mfma_f32_16x16x32_bf16 v[184:187], v[200:203], v[160:163], v[184:187]
    v_mfma_f32_16x16x32_bf16 v[188:191], v[200:203], v[176:179], v[188:191]
    s_waitcnt vmcnt(2)
    v_mfma_f32_16x16x32_bf16 v[192:195], v[204:207], v[160:163], v[192:195]
    v_mfma_f32_16x16x32_bf16 v[196:199], v[204:207], v[176:179], v[196:199]
    s_waitcnt vmcnt(1)
    v_mfma_f32_16x16x32_bf16 v[184:187], v[208:211], v[164:167], v[184:187]
    v_mfma_f32_16x16x32_bf16 v[188:191], v[208:211], v[180:183], v[188:191]
    s_waitcnt vmcnt(0)
    v_mfma_f32_16x16x32_bf16 v[192:195], v[212:215], v[164:167], v[192:195]
    v_mfma_f32_16x16x32_bf16 v[196:199], v[212:215], v[180:183], v[196:199]
    s_nop 3
    v_exp_f32 v184, v184
    v_exp_f32 v185, v185
    v_add_f32 v9, v9, v184
    v_add_f32 v9, v9, v185
    v_cvt_pk_bf16_f32 v120, v184, v185
    v_exp_f32 v186, v186
    v_exp_f32 v187, v187
    v_add_f32 v9, v9, v186
    v_add_f32 v9, v9, v187
    v_cvt_pk_bf16_f32 v121, v186, v187
    v_exp_f32 v188, v188
    v_exp_f32 v189, v189
    v_add_f32 v10, v10, v188
    v_add_f32 v10, v10, v189
    v_cvt_pk_bf16_f32 v124, v188, v189
    v_exp_f32 v190, v190
    v_exp_f32 v191, v191
    v_add_f32 v10, v10, v190
    v_add_f32 v10, v10, v191
    v_cvt_pk_bf16_f32 v125, v190, v191
    v_exp_f32 v192, v192
    v_exp_f32 v193, v193
    v_add_f32 v9, v9, v192
    v_add_f32 v9, v9, v193
    v_cvt_pk_bf16_f32 v122, v192, v193
    v_exp_f32 v194, v194
    v_exp_f32 v195, v195
    v_add_f32 v9, v9, v194
    v_add_f32 v9, v9, v195
    v_cvt_pk_bf16_f32 v123, v194, v195
    v_exp_f32 v196, v196
    v_exp_f32 v197, v197
    v_add_f32 v10, v10, v196
    v_add_f32 v10, v10, v197
    v_cvt_pk_bf16_f32 v126, v196, v197
    v_exp_f32 v198, v198
    v_exp_f32 v199, v199
    v_add_f32 v10, v10, v198
    v_add_f32 v10, v10, v199
    v_cvt_pk_bf16_f32 v127, v198, v199
    s_mov_b32 s17, 0x1a000
    buffer_load_dwordx4 v[200:203], v8, s[8:11], s17 offen offset:0
    buffer_load_dwordx4 v[204:207], v8, s[8:11], s17 offen offset:1024
    buffer_load_dwordx4 v[208:211], v8, s[8:11], s17 offen offset:2048
    buffer_load_dwordx4 v[212:215], v8, s[8:11], s17 offen offset:3072
    s_waitcnt vmcnt(3)
    v_mfma_f32_16x16x32_bf16 v[184:187], v[200:203], v[152:155], v[216:219]
    v_mfma_f32_16x16x32_bf16 v[188:191], v[200:203], v[168:171], v[220:223]
    s_waitcnt vmcnt(2)
    v_mfma_f32_16x16x32_bf16 v[192:195], v[204:207], v[152:155], v[216:219]
    v_mfma_f32_16x16x32_bf16 v[196:199], v[204:207], v[168:171], v[220:223]
    s_waitcnt vmcnt(1)
    v_mfma_f32_16x16x32_bf16 v[184:187], v[208:211], v[156:159], v[184:187]
    v_mfma_f32_16x16x32_bf16 v[188:191], v[208:211], v[172:175], v[188:191]
    s_waitcnt vmcnt(0)
    v_mfma_f32_16x16x32_bf16 v[192:195], v[212:215], v[156:159], v[192:195]
    v_mfma_f32_16x16x32_bf16 v[196:199], v[212:215], v[172:175], v[196:199]
    s_mov_b32 s17, 0x1b000
    buffer_load_dwordx4 v[200:203], v8, s[8:11], s17 offen offset:0
    buffer_load_dwordx4 v[204:207], v8, s[8:11], s17 offen offset:1024
    buffer_load_dwordx4 v[208:211], v8, s[8:11], s17 offen offset:2048
    buffer_load_dwordx4 v[212:215], v8, s[8:11], s17 offen offset:3072
    s_waitcnt vmcnt(3)
    v_mfma_f32_16x16x32_bf16 v[184:187], v[200:203], v[160:163], v[184:187]
    v_mfma_f32_16x16x32_bf16 v[188:191], v[200:203], v[176:179], v[188:191]
    s_waitcnt vmcnt(2)
    v_mfma_f32_16x16x32_bf16 v[192:195], v[204:207], v[160:163], v[192:195]
    v_mfma_f32_16x16x32_bf16 v[196:199], v[204:207], v[176:179], v[196:199]
    s_waitcnt vmcnt(1)
    v_mfma_f32_16x16x32_bf16 v[184:187], v[208:211], v[164:167], v[184:187]
    v_mfma_f32_16x16x32_bf16 v[188:191], v[208:211], v[180:183], v[188:191]
    s_waitcnt vmcnt(0)
    v_mfma_f32_16x16x32_bf16 v[192:195], v[212:215], v[164:167], v[192:195]
    v_mfma_f32_16x16x32_bf16 v[196:199], v[212:215], v[180:183], v[196:199]
    s_nop 3
    v_exp_f32 v184, v184
    v_exp_f32 v185, v185
    v_add_f32 v9, v9, v184
    v_add_f32 v9, v9, v185
    v_cvt_pk_bf16_f32 v128, v184, v185
    v_exp_f32 v186, v186
    v_exp_f32 v187, v187
    v_add_f32 v9, v9, v186
    v_add_f32 v9, v9, v187
    v_cvt_pk_bf16_f32 v129, v186, v187
    v_exp_f32 v188, v188
    v_exp_f32 v189, v189
    v_add_f32 v10, v10, v188
    v_add_f32 v10, v10, v189
    v_cvt_pk_bf16_f32 v132, v188, v189
    v_exp_f32 v190, v190
    v_exp_f32 v191, v191
    v_add_f32 v10, v10, v190
    v_add_f32 v10, v10, v191
    v_cvt_pk_bf16_f32 v133, v190, v191
    v_exp_f32 v192, v192
    v_exp_f32 v193, v193
    v_add_f32 v9, v9, v192
    v_add_f32 v9, v9, v193
    v_cvt_pk_bf16_f32 v130, v192, v193
    v_exp_f32 v194, v194
    v_exp_f32 v195, v195
    v_add_f32 v9, v9, v194
    v_add_f32 v9, v9, v195
    v_cvt_pk_bf16_f32 v131, v194, v195
    v_exp_f32 v196, v196
    v_exp_f32 v197, v197
    v_add_f32 v10, v10, v196
    v_add_f32 v10, v10, v197
    v_cvt_pk_bf16_f32 v134, v196, v197
    v_exp_f32 v198, v198
    v_exp_f32 v199, v199
    v_add_f32 v10, v10, v198
    v_add_f32 v10, v10, v199
    v_cvt_pk_bf16_f32 v135, v198, v199
    s_mov_b32 s17, 0x1c000
    buffer_load_dwordx4 v[200:203], v8, s[8:11], s17 offen offset:0
    buffer_load_dwordx4 v[204:207], v8, s[8:11], s17 offen offset:1024
    buffer_load_dwordx4 v[208:211], v8, s[8:11], s17 offen offset:2048
    buffer_load_dwordx4 v[212:215], v8, s[8:11], s17 offen offset:3072
    s_waitcnt vmcnt(3)
    v_mfma_f32_16x16x32_bf16 v[184:187], v[200:203], v[152:155], v[216:219]
    v_mfma_f32_16x16x32_bf16 v[188:191], v[200:203], v[168:171], v[220:223]
    s_waitcnt vmcnt(2)
    v_mfma_f32_16x16x32_bf16 v[192:195], v[204:207], v[152:155], v[216:219]
    v_mfma_f32_16x16x32_bf16 v[196:199], v[204:207], v[168:171], v[220:223]
    s_waitcnt vmcnt(1)
    v_mfma_f32_16x16x32_bf16 v[184:187], v[208:211], v[156:159], v[184:187]
    v_mfma_f32_16x16x32_bf16 v[188:191], v[208:211], v[172:175], v[188:191]
    s_waitcnt vmcnt(0)
    v_mfma_f32_16x16x32_bf16 v[192:195], v[212:215], v[156:159], v[192:195]
    v_mfma_f32_16x16x32_bf16 v[196:199], v[212:215], v[172:175], v[196:199]
    s_mov_b32 s17, 0x1d000
    buffer_load_dwordx4 v[200:203], v8, s[8:11], s17 offen offset:0
    buffer_load_dwordx4 v[204:207], v8, s[8:11], s17 offen offset:1024
    buffer_load_dwordx4 v[208:211], v8, s[8:11], s17 offen offset:2048
    buffer_load_dwordx4 v[212:215], v8, s[8:11], s17 offen offset:3072
    s_waitcnt vmcnt(3)
    v_mfma_f32_16x16x32_bf16 v[184:187], v[200:203], v[160:163], v[184:187]
    v_mfma_f32_16x16x32_bf16 v[188:191], v[200:203], v[176:179], v[188:191]
    s_waitcnt vmcnt(2)
    v_mfma_f32_16x16x32_bf16 v[192:195], v[204:207], v[160:163], v[192:195]
    v_mfma_f32_16x16x32_bf16 v[196:199], v[204:207], v[176:179], v[196:199]
    s_waitcnt vmcnt(1)
    v_mfma_f32_16x16x32_bf16 v[184:187], v[208:211], v[164:167], v[184:187]
    v_mfma_f32_16x16x32_bf16 v[188:191], v[208:211], v[180:183], v[188:191]
    s_waitcnt vmcnt(0)
    v_mfma_f32_16x16x32_bf16 v[192:195], v[212:215], v[164:167], v[192:195]
    v_mfma_f32_16x16x32_bf16 v[196:199], v[212:215], v[180:183], v[196:199]
    s_nop 3
    v_exp_f32 v184, v184
    v_exp_f32 v185, v185
    v_add_f32 v9, v9, v184
    v_add_f32 v9, v9, v185
    v_cvt_pk_bf16_f32 v136, v184, v185
    v_exp_f32 v186, v186
    v_exp_f32 v187, v187
    v_add_f32 v9, v9, v186
    v_add_f32 v9, v9, v187
    v_cvt_pk_bf16_f32 v137, v186, v187
    v_exp_f32 v188, v188
    v_exp_f32 v189, v189
    v_add_f32 v10, v10, v188
    v_add_f32 v10, v10, v189
    v_cvt_pk_bf16_f32 v140, v188, v189
    v_exp_f32 v190, v190
    v_exp_f32 v191, v191
    v_add_f32 v10, v10, v190
    v_add_f32 v10, v10, v191
    v_cvt_pk_bf16_f32 v141, v190, v191
    v_exp_f32 v192, v192
    v_exp_f32 v193, v193
    v_add_f32 v9, v9, v192
    v_add_f32 v9, v9, v193
    v_cvt_pk_bf16_f32 v138, v192, v193
    v_exp_f32 v194, v194
    v_exp_f32 v195, v195
    v_add_f32 v9, v9, v194
    v_add_f32 v9, v9, v195
    v_cvt_pk_bf16_f32 v139, v194, v195
    v_exp_f32 v196, v196
    v_exp_f32 v197, v197
    v_add_f32 v10, v10, v196
    v_add_f32 v10, v10, v197
    v_cvt_pk_bf16_f32 v142, v196, v197
    v_exp_f32 v198, v198
    v_exp_f32 v199, v199
    v_add_f32 v10, v10, v198
    v_add_f32 v10, v10, v199
    v_cvt_pk_bf16_f32 v143, v198, v199
    s_mov_b32 s17, 0x1e000
    buffer_load_dwordx4 v[200:203], v8, s[8:11], s17 offen offset:0
    buffer_load_dwordx4 v[204:207], v8, s[8:11], s17 offen offset:1024
    buffer_load_dwordx4 v[208:211], v8, s[8:11], s17 offen offset:2048
    buffer_load_dwordx4 v[212:215], v8, s[8:11], s17 offen offset:3072
    s_waitcnt vmcnt(3)
    v_mfma_f32_16x16x32_bf16 v[184:187], v[200:203], v[152:155], v[216:219]
    v_mfma_f32_16x16x32_bf16 v[188:191], v[200:203], v[168:171], v[220:223]
    s_waitcnt vmcnt(2)
    v_mfma_f32_16x16x32_bf16 v[192:195], v[204:207], v[152:155], v[216:219]
    v_mfma_f32_16x16x32_bf16 v[196:199], v[204:207], v[168:171], v[220:223]
    s_waitcnt vmcnt(1)
    v_mfma_f32_16x16x32_bf16 v[184:187], v[208:211], v[156:159], v[184:187]
    v_mfma_f32_16x16x32_bf16 v[188:191], v[208:211], v[172:175], v[188:191]
    s_waitcnt vmcnt(0)
    v_mfma_f32_16x16x32_bf16 v[192:195], v[212:215], v[156:159], v[192:195]
    v_mfma_f32_16x16x32_bf16 v[196:199], v[212:215], v[172:175], v[196:199]
    s_mov_b32 s17, 0x1f000
    buffer_load_dwordx4 v[200:203], v8, s[8:11], s17 offen offset:0
    buffer_load_dwordx4 v[204:207], v8, s[8:11], s17 offen offset:1024
    buffer_load_dwordx4 v[208:211], v8, s[8:11], s17 offen offset:2048
    buffer_load_dwordx4 v[212:215], v8, s[8:11], s17 offen offset:3072
    s_waitcnt vmcnt(3)
    v_mfma_f32_16x16x32_bf16 v[184:187], v[200:203], v[160:163], v[184:187]
    v_mfma_f32_16x16x32_bf16 v[188:191], v[200:203], v[176:179], v[188:191]
    s_waitcnt vmcnt(2)
    v_mfma_f32_16x16x32_bf16 v[192:195], v[204:207], v[160:163], v[192:195]
    v_mfma_f32_16x16x32_bf16 v[196:199], v[204:207], v[176:179], v[196:199]
    s_waitcnt vmcnt(1)
    v_mfma_f32_16x16x32_bf16 v[184:187], v[208:211], v[164:167], v[184:187]
    v_mfma_f32_16x16x32_bf16 v[188:191], v[208:211], v[180:183], v[188:191]
    s_waitcnt vmcnt(0)
    v_mfma_f32_16x16x32_bf16 v[192:195], v[212:215], v[164:167], v[192:195]
    v_mfma_f32_16x16x32_bf16 v[196:199], v[212:215], v[180:183], v[196:199]
    s_nop 3
    v_exp_f32 v184, v184
    v_exp_f32 v185, v185
    v_add_f32 v9, v9, v184
    v_add_f32 v9, v9, v185
    v_cvt_pk_bf16_f32 v144, v184, v185
    v_exp_f32 v186, v186
    v_exp_f32 v187, v187
    v_add_f32 v9, v9, v186
    v_add_f32 v9, v9, v187
    v_cvt_pk_bf16_f32 v145, v186, v187
    v_exp_f32 v188, v188
    v_exp_f32 v189, v189
    v_add_f32 v10, v10, v188
    v_add_f32 v10, v10, v189
    v_cvt_pk_bf16_f32 v148, v188, v189
    v_exp_f32 v190, v190
    v_exp_f32 v191, v191
    v_add_f32 v10, v10, v190
    v_add_f32 v10, v10, v191
    v_cvt_pk_bf16_f32 v149, v190, v191
    v_exp_f32 v192, v192
    v_exp_f32 v193, v193
    v_add_f32 v9, v9, v192
    v_add_f32 v9, v9, v193
    v_cvt_pk_bf16_f32 v146, v192, v193
    v_exp_f32 v194, v194
    v_exp_f32 v195, v195
    v_add_f32 v9, v9, v194
    v_add_f32 v9, v9, v195
    v_cvt_pk_bf16_f32 v147, v194, v195
    v_exp_f32 v196, v196
    v_exp_f32 v197, v197
    v_add_f32 v10, v10, v196
    v_add_f32 v10, v10, v197
    v_cvt_pk_bf16_f32 v150, v196, v197
    v_exp_f32 v198, v198
    v_exp_f32 v199, v199
    v_add_f32 v10, v10, v198
    v_add_f32 v10, v10, v199
    v_cvt_pk_bf16_f32 v151, v198, v199
    v_mov_b32 v16, v9
    v_mov_b32 v18, v10
    s_nop 0
    v_permlane16_swap_b32 v9, v16
    v_permlane16_swap_b32 v10, v18
    v_add_f32 v9, v9, v16
    v_add_f32 v10, v10, v18
    v_mov_b32 v16, v9
    v_mov_b32 v18, v10
    s_nop 0
    v_permlane32_swap_b32 v9, v16
    v_permlane32_swap_b32 v10, v18
    v_add_f32 v9, v9, v16
    v_add_f32 v10, v10, v18
    s_waitcnt vmcnt(0) lgkmcnt(0)
    s_nop 15
    s_nop 3
    s_branch adaLN_cond__sliding_block_cached__moe_arch_mod__prompt_kernel_fixBb
adaLN_cond__sliding_block_cached__moe_arch_mod__prompt_kernel_o17r:
    s_waitcnt vmcnt(0) lgkmcnt(0)
    s_nop 15
    s_nop 3
    s_mov_b32 s27, 0
adaLN_cond__sliding_block_cached__moe_arch_mod__prompt_kernel_o17p:
    buffer_load_dword v12, v13, s[8:11], s19 offen sc1
    s_waitcnt vmcnt(0)
    v_cmp_ne_u32 vcc, s28, v12
    s_add_u32 s27, s27, 1
    s_cmp_ge_u32 s27, 65536
    s_cbranch_scc1 adaLN_cond__sliding_block_cached__moe_arch_mod__prompt_kernel_o17g
    s_cbranch_vccnz adaLN_cond__sliding_block_cached__moe_arch_mod__prompt_kernel_o17p
adaLN_cond__sliding_block_cached__moe_arch_mod__prompt_kernel_o17g:
    s_waitcnt vmcnt(0) lgkmcnt(0)
    s_nop 15
    s_nop 3
    s_branch adaLN_cond__sliding_block_cached__moe_arch_mod__prompt_kernel_o17b
adaLN_cond__sliding_block_cached__moe_arch_mod__prompt_kernel_o218r:
    s_waitcnt vmcnt(0) lgkmcnt(0)
    s_nop 15
    s_nop 3
    s_mov_b32 s27, 0
adaLN_cond__sliding_block_cached__moe_arch_mod__prompt_kernel_o218p:
    buffer_load_dword v12, v13, s[8:11], s19 offen sc1
    s_waitcnt vmcnt(0)
    v_cmp_ne_u32 vcc, s28, v12
    s_add_u32 s27, s27, 1
    s_cmp_ge_u32 s27, 65536
    s_cbranch_scc1 adaLN_cond__sliding_block_cached__moe_arch_mod__prompt_kernel_o218g
    s_cbranch_vccnz adaLN_cond__sliding_block_cached__moe_arch_mod__prompt_kernel_o218p
adaLN_cond__sliding_block_cached__moe_arch_mod__prompt_kernel_o218g:
    s_waitcnt vmcnt(0) lgkmcnt(0)
    s_nop 15
    s_nop 3
    s_branch adaLN_cond__sliding_block_cached__moe_arch_mod__prompt_kernel_o218b
adaLN_cond__sliding_block_cached__moe_arch_mod__prompt_kernel_o219r:
    s_waitcnt vmcnt(0) lgkmcnt(0)
    s_nop 15
    s_nop 3
    s_mov_b32 s27, 0
adaLN_cond__sliding_block_cached__moe_arch_mod__prompt_kernel_o219p:
    buffer_load_dword v12, v13, s[8:11], s19 offen sc1
    s_waitcnt vmcnt(0)
    v_cmp_ne_u32 vcc, s28, v12
    s_add_u32 s27, s27, 1
    s_cmp_ge_u32 s27, 65536
    s_cbranch_scc1 adaLN_cond__sliding_block_cached__moe_arch_mod__prompt_kernel_o219g
    s_cbranch_vccnz adaLN_cond__sliding_block_cached__moe_arch_mod__prompt_kernel_o219p
adaLN_cond__sliding_block_cached__moe_arch_mod__prompt_kernel_o219g:
    s_waitcnt vmcnt(0) lgkmcnt(0)
    s_nop 15
    s_nop 3
    s_branch adaLN_cond__sliding_block_cached__moe_arch_mod__prompt_kernel_o219b
adaLN_cond__sliding_block_cached__moe_arch_mod__prompt_kernel_o220r:
    s_waitcnt vmcnt(0) lgkmcnt(0)
    s_nop 15
    s_nop 3
    s_mov_b32 s27, 0
adaLN_cond__sliding_block_cached__moe_arch_mod__prompt_kernel_o220p:
    buffer_load_dword v12, v13, s[8:11], s19 offen sc1
    s_waitcnt vmcnt(0)
    v_cmp_ne_u32 vcc, s28, v12
    s_add_u32 s27, s27, 1
    s_cmp_ge_u32 s27, 65536
    s_cbranch_scc1 adaLN_cond__sliding_block_cached__moe_arch_mod__prompt_kernel_o220g
    s_cbranch_vccnz adaLN_cond__sliding_block_cached__moe_arch_mod__prompt_kernel_o220p
adaLN_cond__sliding_block_cached__moe_arch_mod__prompt_kernel_o220g:
    s_waitcnt vmcnt(0) lgkmcnt(0)
    s_nop 15
    s_nop 3
    s_branch adaLN_cond__sliding_block_cached__moe_arch_mod__prompt_kernel_o220b
adaLN_cond__sliding_block_cached__moe_arch_mod__prompt_kernel_mf21r:
    s_waitcnt vmcnt(0) lgkmcnt(0)
    s_nop 15
    s_nop 3
    s_mov_b32 s27, 0
adaLN_cond__sliding_block_cached__moe_arch_mod__prompt_kernel_mf21p:
    s_mov_b32 s16, 0x544000
    buffer_load_dwordx4 v[184:187], v2, s[8:11], s16 offen sc1
    s_waitcnt vmcnt(0)
    v_xor_b32 v16, s28, v184
    v_xor_b32 v17, s28, v185
    v_xor_b32 v18, s28, v186
    v_xor_b32 v19, s28, v187
    v_or3_b32 v16, v16, v17, v18
    v_or_b32 v16, v16, v19
    v_cmp_ne_u32 vcc, 0, v16
    s_add_u32 s27, s27, 1
    s_cmp_ge_u32 s27, 65536
    s_cbranch_scc1 adaLN_cond__sliding_block_cached__moe_arch_mod__prompt_kernel_mf21g
    s_cbranch_vccnz adaLN_cond__sliding_block_cached__moe_arch_mod__prompt_kernel_mf21p
adaLN_cond__sliding_block_cached__moe_arch_mod__prompt_kernel_mf21g:
    s_waitcnt vmcnt(0) lgkmcnt(0)
    s_nop 15
    s_nop 3
    s_branch adaLN_cond__sliding_block_cached__moe_arch_mod__prompt_kernel_mf21b
adaLN_cond__sliding_block_cached__moe_arch_mod__prompt_kernel_codeend:
    s_endpgm
.section .rodata,"a"
.p2align 6
.amdhsa_kernel adaLN_cond__sliding_block_cached__moe_arch_mod__prompt_kernel
  .amdhsa_next_free_vgpr 256
  .amdhsa_next_free_sgpr 80
  .amdhsa_accum_offset 256
  .amdhsa_group_segment_fixed_size 0
  .amdhsa_kernarg_size 120
  .amdhsa_user_sgpr_count 2
  .amdhsa_user_sgpr_kernarg_segment_ptr 1
  .amdhsa_system_sgpr_workgroup_id_x 1
  .amdhsa_float_denorm_mode_32 3
.end_amdhsa_kernel
```

```asm
; @launch grid=(256,1,1) block=(512,1,1) lds=163840
.amdgcn_target "amdgcn-amd-amdhsa--gfx950"
.text
.globl adaLN_cond__sliding_block_cached__moe_arch_mod__prompt_kernel
.p2align 8
.type adaLN_cond__sliding_block_cached__moe_arch_mod__prompt_kernel,@function
adaLN_cond__sliding_block_cached__moe_arch_mod__prompt_kernel:
    s_cmp_ge_u32 s2, 256
    s_cbranch_scc1 adaLN_cond__sliding_block_cached__moe_arch_mod__prompt_kernel_end
    s_getpc_b64 s[76:77]
adaLN_cond__sliding_block_cached__moe_arch_mod__prompt_kernel_pc0:
    s_sub_u32 s76, s76, adaLN_cond__sliding_block_cached__moe_arch_mod__prompt_kernel_pc0-adaLN_cond__sliding_block_cached__moe_arch_mod__prompt_kernel
    s_subb_u32 s77, s77, 0
    v_and_b32 v16, 63, v0
    v_lshlrev_b32 v16, 7, v16
    v_lshrrev_b32 v17, 6, v0
    s_lshr_b32 s62, s2, 3
    s_lshl_b32 s62, s62, 13
    v_lshlrev_b32 v18, 13, v17
    v_mov_b32 v19, s62
    v_cmp_eq_u32 vcc, 7, v17
    s_nop 1
    v_cndmask_b32 v18, v18, v19, vcc
    v_add_u32 v16, v16, v18
    v_min_u32 v16, adaLN_cond__sliding_block_cached__moe_arch_mod__prompt_kernel_codeend-adaLN_cond__sliding_block_cached__moe_arch_mod__prompt_kernel-4, v16
    v_mov_b32 v25, s77
    v_add_co_u32 v24, vcc, s76, v16
    s_nop 1
    v_addc_co_u32 v25, vcc, 0, v25, vcc
    v_cmp_gt_u32 vcc, 2, v17
    v_cmp_eq_u32 s[62:63], 7, v17
    s_or_b64 vcc, vcc, s[62:63]
    s_and_saveexec_b64 s[62:63], vcc
    s_cbranch_execz adaLN_cond__sliding_block_cached__moe_arch_mod__prompt_kernel_nocp0
    global_load_dword v26, v[24:25], off
adaLN_cond__sliding_block_cached__moe_arch_mod__prompt_kernel_nocp0:
    s_mov_b64 exec, s[62:63]
    s_load_dwordx4 s[56:59], s[0:1], 96
    s_load_dwordx2 s[60:61], s[0:1], 112
    s_load_dwordx8 s[48:55], s[0:1], 64
    s_load_dwordx16 s[32:47], s[0:1], 0
    s_memrealtime s[62:63]
    v_lshrrev_b32 v16, 6, v0
    v_and_b32 v1, 63, v0
    v_readfirstlane_b32 s3, v16
    v_lshlrev_b32 v2, 4, v1
    s_and_b32 s12, s2, 3
    s_lshl_b32 s12, s12, 3
    s_bfe_u32 s13, s2, 0x30003
    s_add_u32 s12, s12, s13
    s_bfe_u32 s13, s2, 0x10002
    s_lshl_b32 s13, s13, 2
    s_lshr_b32 s14, s2, 6
    s_add_u32 s13, s13, s14
    v_bfe_u32 v16, v1, 2, 2
    v_lshrrev_b32 v17, 4, v1
    v_and_b32 v18, 3, v1
    v_lshlrev_b32 v19, 6, v17
    v_lshl_add_u32 v19, v18, 4, v19
    v_lshl_add_u32 v3, v16, 13, v19
    s_and_b32 s14, s3, 1
    s_lshl_b32 s14, s14, 5
    v_xor_b32 v3, s14, v3
    v_lshlrev_b32 v4, 11, v17
    v_lshl_add_u32 v4, v16, 6, v4
    v_lshl_add_u32 v4, v18, 3, v4
    v_and_b32 v20, 1, v17
    v_lshlrev_b32 v20, 5, v20
    v_sub_u32 v5, v4, v20
    v_add_u32 v4, v4, v20
    s_lshl_b32 s14, s13, 3
    s_add_u32 s14, s14, s3
    s_lshl_b32 s14, s14, 16
    v_add_u32 v7, s14, v2
    s_cmp_ge_u32 s3, 4
    s_cbranch_scc1 adaLN_cond__sliding_block_cached__moe_arch_mod__prompt_kernel_roleB
    v_mov_b32 v132, 0
    v_mov_b32 v133, 0
    v_lshrrev_b32 v16, 3, v0
    v_and_b32 v17, 7, v0
    v_mul_u32_u24 v135, 24576, v16
    v_lshl_add_u32 v135, v17, 4, v135
    v_lshlrev_b32 v136, 2, v16
    s_and_b32 s14, s2, 31
    s_lshr_b32 s15, s2, 5
    s_mul_i32 s26, s15, 1572864
    s_lshl_b32 s16, s14, 7
    s_add_u32 s26, s26, s16
    s_lshl_b32 s29, s15, 8
    v_lshlrev_b32 v137, 3, v0
    s_lshl_b32 s18, s2, 3
    s_add_u32 s18, s18, s3
    s_lshl_b32 s18, s18, 11
    v_and_b32 v18, 15, v1
    v_lshrrev_b32 v19, 4, v1
    v_lshlrev_b32 v138, 11, v18
    v_lshl_add_u32 v138, v19, 4, v138
    s_lshr_b32 s30, s2, 4
    s_and_b32 s31, s2, 15
    s_lshl_b32 s19, s30, 3
    s_add_u32 s19, s19, s3
    s_lshl_b32 s22, s19, 15
    s_lshl_b32 s23, s31, 7
    s_add_u32 s22, s22, s23
    s_lshl_b32 s23, s2, 12
    s_add_u32 s23, s23, 0x600000
    s_or_b32 s25, s2, s3
    s_cmp_eq_u32 s25, 0
    s_cselect_b32 s25, 0, 0x7ffffff0
    s_waitcnt lgkmcnt(0)
    s_mov_b64 s[64:65], s[58:59]
    s_mov_b32 s66, 0x100
    s_mov_b32 s67, 0x20000
    s_or_b32 s28, s62, 1
    v_mov_b32 v134, s28
    s_mov_b64 exec, 1
    buffer_store_dword v134, v132, s[64:67], s25 offen sc1
    s_mov_b64 exec, -1
    s_mov_b64 s[68:69], s[52:53]
    s_mov_b32 s70, 0x800
    s_mov_b32 s71, 0x20000
    s_mov_b64 s[72:73], s[54:55]
    s_mov_b32 s74, 0xc00000
    s_mov_b32 s75, 0x20000
    s_mov_b64 s[76:77], s[32:33]
    s_mov_b32 s78, 0x400000
    s_mov_b32 s79, 0x20000
    s_mov_b64 s[8:9], s[60:61]
    s_mov_b32 s10, 0x3400000
    s_mov_b32 s11, 0x20000
    buffer_load_dwordx4 v[32:35], v2, s[76:79], s18 offen offset:0
    buffer_load_dwordx4 v[36:39], v2, s[76:79], s18 offen offset:1024
    buffer_load_dword v72, v136, s[68:71], s29 offen
    buffer_load_dwordx4 v[24:27], v135, s[72:75], s26 offen
    s_add_u32 s26, s26, 12288
    buffer_load_dwordx4 v[28:31], v135, s[72:75], s26 offen
    s_cmp_eq_u32 s3, 0
    s_cselect_b32 s25, 0, 0x7ffffff0
    buffer_load_dword v134, v132, s[64:67], s25 offen sc1
    buffer_store_dwordx2 v[132:133], v137, s[8:11], s23 offen sc1
    s_barrier
    buffer_load_dwordx4 v[40:43], v138, s[76:79], s22 offen offset:0
    buffer_load_dwordx4 v[44:47], v138, s[76:79], s22 offen offset:64
    s_mov_b32 s29, s19
    s_waitcnt vmcnt(8)
    v_lshlrev_b32 v56, 16, v32
    v_and_b32 v57, 0xffff0000, v32
    v_lshlrev_b32 v58, 16, v33
    v_and_b32 v59, 0xffff0000, v33
    v_lshlrev_b32 v60, 16, v34
    v_and_b32 v61, 0xffff0000, v34
    v_lshlrev_b32 v62, 16, v35
    v_and_b32 v63, 0xffff0000, v35
    s_waitcnt vmcnt(7)
    v_lshlrev_b32 v64, 16, v36
    v_and_b32 v65, 0xffff0000, v36
    v_lshlrev_b32 v66, 16, v37
    v_and_b32 v67, 0xffff0000, v37
    v_lshlrev_b32 v68, 16, v38
    v_and_b32 v69, 0xffff0000, v38
    v_lshlrev_b32 v70, 16, v39
    v_and_b32 v71, 0xffff0000, v39
    v_add_f32 v20, v56, v57
    v_add_f32 v21, v58, v59
    v_add_f32 v20, v20, v60
    v_add_f32 v21, v21, v61
    v_add_f32 v20, v20, v62
    v_add_f32 v21, v21, v63
    v_add_f32 v20, v20, v64
    v_add_f32 v21, v21, v65
    v_add_f32 v20, v20, v66
    v_add_f32 v21, v21, v67
    v_add_f32 v20, v20, v68
    v_add_f32 v21, v21, v69
    v_add_f32 v20, v20, v70
    v_add_f32 v21, v21, v71
    v_add_f32 v128, v20, v21
    s_nop 1
    v_add_f32_dpp v128, v128, v128 row_ror:1 row_mask:0xf bank_mask:0xf
    s_nop 1
    v_add_f32_dpp v128, v128, v128 row_ror:2 row_mask:0xf bank_mask:0xf
    s_nop 1
    v_add_f32_dpp v128, v128, v128 row_ror:4 row_mask:0xf bank_mask:0xf
    s_nop 1
    v_add_f32_dpp v128, v128, v128 row_ror:8 row_mask:0xf bank_mask:0xf
    v_mov_b32 v20, v128
    s_nop 1
    v_permlane16_swap_b32 v128, v20
    v_add_f32 v128, v128, v20
    v_mov_b32 v20, v128
    s_nop 1
    v_permlane32_swap_b32 v128, v20
    v_add_f32 v128, v128, v20
    v_mul_f32 v128, 0x3a800000, v128
    v_sub_f32 v18, v56, v128
    v_mul_f32 v20, v18, v18
    v_sub_f32 v19, v57, v128
    v_mul_f32 v21, v19, v19
    v_sub_f32 v18, v58, v128
    v_sub_f32 v19, v59, v128
    v_fmac_f32 v20, v18, v18
    v_fmac_f32 v21, v19, v19
    v_sub_f32 v18, v60, v128
    v_sub_f32 v19, v61, v128
    v_fmac_f32 v20, v18, v18
    v_fmac_f32 v21, v19, v19
    v_sub_f32 v18, v62, v128
    v_sub_f32 v19, v63, v128
    v_fmac_f32 v20, v18, v18
    v_fmac_f32 v21, v19, v19
    v_sub_f32 v18, v64, v128
    v_sub_f32 v19, v65, v128
    v_fmac_f32 v20, v18, v18
    v_fmac_f32 v21, v19, v19
    v_sub_f32 v18, v66, v128
    v_sub_f32 v19, v67, v128
    v_fmac_f32 v20, v18, v18
    v_fmac_f32 v21, v19, v19
    v_sub_f32 v18, v68, v128
    v_sub_f32 v19, v69, v128
    v_fmac_f32 v20, v18, v18
    v_fmac_f32 v21, v19, v19
    v_sub_f32 v18, v70, v128
    v_sub_f32 v19, v71, v128
    v_fmac_f32 v20, v18, v18
    v_fmac_f32 v21, v19, v19
    v_add_f32 v17, v20, v21
    s_nop 1
    v_add_f32_dpp v17, v17, v17 row_ror:1 row_mask:0xf bank_mask:0xf
    s_nop 1
    v_add_f32_dpp v17, v17, v17 row_ror:2 row_mask:0xf bank_mask:0xf
    s_nop 1
    v_add_f32_dpp v17, v17, v17 row_ror:4 row_mask:0xf bank_mask:0xf
    s_nop 1
    v_add_f32_dpp v17, v17, v17 row_ror:8 row_mask:0xf bank_mask:0xf
    v_mov_b32 v20, v17
    s_nop 1
    v_permlane16_swap_b32 v17, v20
    v_add_f32 v17, v17, v20
    v_mov_b32 v20, v17
    s_nop 1
    v_permlane32_swap_b32 v17, v20
    v_add_f32 v17, v17, v20
    v_mul_f32 v17, 0x3a800000, v17
    v_cvt_pk_bf16_f32 v128, v128, v128
    v_lshlrev_b32 v128, 16, v128
    v_cvt_pk_bf16_f32 v17, v17, v17
    v_lshlrev_b32 v17, 16, v17
    v_add_f32 v17, 0x3727c5ac, v17
    v_cvt_pk_bf16_f32 v17, v17, v17
    v_lshlrev_b32 v17, 16, v17
    v_sqrt_f32 v129, v17
    s_nop 0
    v_cvt_pk_bf16_f32 v129, v129, v129
    v_lshlrev_b32 v129, 16, v129
    v_rcp_f32 v130, v129
    s_lshl_b32 s16, s3, 4
    s_add_u32 s16, s16, 149520
    v_mov_b32 v19, s16
    ds_write_b128 v19, v[128:131]
    s_waitcnt vmcnt(6)
    v_and_b32 v73, 0xffff0000, v72
    v_lshlrev_b32 v72, 16, v72
    v_mul_f32 v16, 0xbfb8aa3b, v72
    v_exp_f32 v16, v16
    s_nop 0
    v_add_f32 v16, 1.0, v16
    v_rcp_f32 v16, v16
    s_nop 0
    v_mul_f32 v72, v72, v16
    v_mul_f32 v17, 0xbfb8aa3b, v73
    v_exp_f32 v17, v17
    s_nop 0
    v_add_f32 v17, 1.0, v17
    v_rcp_f32 v17, v17
    s_nop 0
    v_mul_f32 v73, v73, v17
    v_cvt_pk_bf16_f32 v16, v72, v73
    v_lshlrev_b32 v72, 16, v16
    v_and_b32 v73, 0xffff0000, v16
    s_lshl_b32 s16, s2, 8
    s_add_u32 s16, s16, 0x550000
    s_mov_b32 exec_lo, 0x01010101
    s_mov_b32 exec_hi, 0x01010101
    buffer_store_dword v16, v136, s[8:11], s16 offen sc1
    s_mov_b64 exec, -1
    v_lshrrev_b32 v74, 16, v72
    v_lshrrev_b32 v75, 16, v73
    s_waitcnt vmcnt(6)
    v_dot2_f32_bf16 v49, v24, v72, 0
    v_dot2_f32_bf16 v48, v24, v74, 0
    v_dot2_f32_bf16 v51, v25, v72, 0
    v_dot2_f32_bf16 v50, v25, v74, 0
    v_dot2_f32_bf16 v53, v26, v72, 0
    v_dot2_f32_bf16 v52, v26, v74, 0
    v_dot2_f32_bf16 v55, v27, v72, 0
    v_dot2_f32_bf16 v54, v27, v74, 0
    s_waitcnt vmcnt(5)
    v_dot2c_f32_bf16 v49, v28, v73
    v_dot2c_f32_bf16 v48, v28, v75
    v_dot2c_f32_bf16 v51, v29, v73
    v_dot2c_f32_bf16 v50, v29, v75
    v_dot2c_f32_bf16 v53, v30, v73
    v_dot2c_f32_bf16 v52, v30, v75
    v_dot2c_f32_bf16 v55, v31, v73
    v_dot2c_f32_bf16 v54, v31, v75
    s_nop 0
    v_permlane32_swap_b32 v48, v52
    v_permlane32_swap_b32 v49, v53
    v_permlane32_swap_b32 v50, v54
    v_permlane32_swap_b32 v51, v55
    v_add_f32 v48, v48, v52
    v_add_f32 v49, v49, v53
    v_add_f32 v50, v50, v54
    v_add_f32 v51, v51, v55
    s_nop 0
    v_permlane16_swap_b32 v48, v50
    v_permlane16_swap_b32 v49, v51
    v_add_f32 v48, v48, v50
    v_add_f32 v49, v49, v51
    s_nop 0
    v_add_f32_dpp v48, v48, v48 row_ror:8 row_mask:0xf bank_mask:0xf
    v_add_f32_dpp v49, v49, v49 row_ror:8 row_mask:0xf bank_mask:0xf
    v_and_b32 v16, 7, v1
    v_lshlrev_b32 v16, 5, v16
    v_lshrrev_b32 v17, 4, v1
    v_lshl_add_u32 v16, v17, 3, v16
    s_lshl_b32 s16, s3, 8
    s_add_u32 s16, s16, 147456
    v_add_u32 v16, s16, v16
    ds_write_b64 v16, v[48:49]
    s_waitcnt vmcnt(4)
    v_cmp_eq_u32 vcc, 0, v134
    s_cmp_eq_u32 s3, 0
    s_cselect_b64 s[62:63], -1, 0
    s_and_b64 vcc, vcc, s[62:63]
    s_cbranch_vccnz adaLN_cond__sliding_block_cached__moe_arch_mod__prompt_kernel_n1r
adaLN_cond__sliding_block_cached__moe_arch_mod__prompt_kernel_n1b:
    v_mov_b32 v19, 149504
    s_cmp_eq_u32 s3, 0
    s_cselect_b64 exec, 1, 0
    ds_write_b32 v19, v134
    s_mov_b64 exec, -1
    v_mov_b32 v19, 149504
    v_and_b32 v17, 31, v1
    v_lshlrev_b32 v18, 3, v17
    v_add_u32 v18, 147456, v18
    v_lshlrev_b32 v17, 4, v17
    s_waitcnt lgkmcnt(0)
    s_barrier
    ds_read_b32 v134, v19
    ds_read_b64 v[96:97], v18 offset:0
    ds_read_b64 v[100:101], v18 offset:256
    ds_read_b64 v[104:105], v18 offset:512
    ds_read_b64 v[108:109], v18 offset:768
    ds_read_b64 v[112:113], v18 offset:1024
    ds_read_b64 v[116:117], v18 offset:1280
    ds_read_b64 v[120:121], v18 offset:1536
    ds_read_b64 v[124:125], v18 offset:1792
    s_waitcnt lgkmcnt(8)
    v_readfirstlane_b32 s28, v134
    v_and_b32 v20, 7, v1
    v_lshlrev_b32 v20, 4, v20
    v_add_u32 v21, 149520, v20
    ds_read_b128 v[128:131], v21
    s_waitcnt lgkmcnt(0)
    v_mov_b32 v131, s28
    s_lshl_b32 s16, s2, 7
    s_add_u32 s16, s16, 0x520000
    s_cmp_eq_u32 s3, 0
    s_cselect_b32 s16, s16, 0x7ffffff0
    s_mov_b64 exec, 0xff
    buffer_store_dwordx4 v[128:131], v20, s[8:11], s16 offen sc1
    s_mov_b64 exec, -1
    v_pk_add_f32 v[96:97], v[96:97], v[112:113]
    v_pk_add_f32 v[100:101], v[100:101], v[116:117]
    v_pk_add_f32 v[104:105], v[104:105], v[120:121]
    v_pk_add_f32 v[108:109], v[108:109], v[124:125]
    v_pk_add_f32 v[96:97], v[96:97], v[104:105]
    v_pk_add_f32 v[100:101], v[100:101], v[108:109]
    v_pk_add_f32 v[96:97], v[96:97], v[100:101]
    v_mov_b32 v98, s28
    v_mov_b32 v99, s28
    s_lshl_b32 s16, s14, 3
    s_add_u32 s16, s16, s15
    s_lshl_b32 s16, s16, 9
    s_add_u32 s16, s16, 0x500000
    s_cmp_eq_u32 s3, 0
    s_cselect_b32 s16, s16, 0x7ffffff0
    s_mov_b64 exec, 0xffffffff
    buffer_store_dwordx4 v[96:99], v17, s[8:11], s16 offen sc1
    s_mov_b64 exec, -1
    s_lshr_b32 s16, s3, 2
    s_lshl_b32 s16, s16, 4
    s_add_u32 s16, s16, s31
    s_lshl_b32 s16, s16, 12
    s_and_b32 s17, s3, 3
    s_lshl_b32 s17, s17, 7
    s_add_u32 s16, s16, s17
    s_add_u32 s16, s16, 0x500000
    v_lshrrev_b32 v139, 3, v1
    v_lshlrev_b32 v139, 9, v139
    v_and_b32 v16, 7, v1
    v_lshl_add_u32 v139, v16, 4, v139
    v_and_b32 v140, 15, v1
    v_lshlrev_b32 v140, 4, v140
    s_lshl_b32 s17, s29, 8
    s_add_u32 s17, s17, 0x520000
    s_waitcnt vmcnt(4)
    v_lshlrev_b32 v56, 16, v40
    v_and_b32 v57, 0xffff0000, v40
    v_lshlrev_b32 v58, 16, v41
    v_and_b32 v59, 0xffff0000, v41
    v_lshlrev_b32 v60, 16, v42
    v_and_b32 v61, 0xffff0000, v42
    v_lshlrev_b32 v62, 16, v43
    v_and_b32 v63, 0xffff0000, v43
    s_waitcnt vmcnt(3)
    v_lshlrev_b32 v64, 16, v44
    v_and_b32 v65, 0xffff0000, v44
    v_lshlrev_b32 v66, 16, v45
    v_and_b32 v67, 0xffff0000, v45
    v_lshlrev_b32 v68, 16, v46
    v_and_b32 v69, 0xffff0000, v46
    v_lshlrev_b32 v70, 16, v47
    v_and_b32 v71, 0xffff0000, v47
    s_mov_b32 s27, 0
adaLN_cond__sliding_block_cached__moe_arch_mod__prompt_kernel_g2p:
    buffer_load_dwordx4 v[76:79], v139, s[8:11], s16 offen sc1
    buffer_load_dwordx4 v[80:83], v140, s[8:11], s17 offen sc1
    s_waitcnt vmcnt(1)
    v_cmp_ne_u32 vcc, s28, v78
    v_cmp_ne_u32 s[62:63], s28, v79
    s_or_b64 vcc, vcc, s[62:63]
    s_waitcnt vmcnt(0)
    v_cmp_ne_u32 s[62:63], s28, v83
    s_or_b64 vcc, vcc, s[62:63]
    s_add_u32 s27, s27, 1
    s_cmp_ge_u32 s27, 65536
    s_cbranch_scc1 adaLN_cond__sliding_block_cached__moe_arch_mod__prompt_kernel_g2g
    s_cbranch_vccnz adaLN_cond__sliding_block_cached__moe_arch_mod__prompt_kernel_g2p
adaLN_cond__sliding_block_cached__moe_arch_mod__prompt_kernel_g2g:
    v_add_f32_dpp v76, v76, v76 row_ror:8 row_mask:0xf bank_mask:0xf
    v_add_f32_dpp v77, v77, v77 row_ror:8 row_mask:0xf bank_mask:0xf
    v_mov_b32 v17, v76
    s_nop 1
    v_permlane16_swap_b32 v76, v17
    v_add_f32 v76, v76, v17
    v_mov_b32 v18, v77
    s_nop 1
    v_permlane16_swap_b32 v77, v18
    v_add_f32 v77, v77, v18
    v_mov_b32 v17, v76
    s_nop 1
    v_permlane32_swap_b32 v76, v17
    v_add_f32 v76, v76, v17
    v_mov_b32 v18, v77
    s_nop 1
    v_permlane32_swap_b32 v77, v18
    v_add_f32 v77, v77, v18
    v_cvt_pk_bf16_f32 v17, v76, v77
    v_lshlrev_b32 v76, 16, v17
    v_and_b32 v77, 0xffff0000, v17
    v_add_f32 v76, 0, v76
    v_add_f32 v77, 0, v77
    s_lshl_b32 s16, s3, 6
    s_add_u32 s16, s16, 151552
    v_lshl_add_u32 v16, v16, 3, s16
    ds_write_b64 v16, v[76:77]
    v_lshrrev_b32 v17, 4, v1
    v_lshlrev_b32 v17, 5, v17
    v_add_u32 v17, 151552, v17
    v_sub_f32 v56, v56, v80
    v_sub_f32 v57, v57, v80
    v_sub_f32 v58, v58, v80
    v_sub_f32 v59, v59, v80
    v_sub_f32 v60, v60, v80
    v_sub_f32 v61, v61, v80
    v_sub_f32 v62, v62, v80
    v_sub_f32 v63, v63, v80
    v_sub_f32 v64, v64, v80
    v_sub_f32 v65, v65, v80
    v_sub_f32 v66, v66, v80
    v_sub_f32 v67, v67, v80
    v_sub_f32 v68, v68, v80
    v_sub_f32 v69, v69, v80
    v_sub_f32 v70, v70, v80
    v_sub_f32 v71, v71, v80
    v_cvt_pk_bf16_f32 v18, v56, v57
    v_lshlrev_b32 v56, 16, v18
    v_and_b32 v57, 0xffff0000, v18
    v_cvt_pk_bf16_f32 v19, v58, v59
    v_lshlrev_b32 v58, 16, v19
    v_and_b32 v59, 0xffff0000, v19
    v_cvt_pk_bf16_f32 v18, v60, v61
    v_lshlrev_b32 v60, 16, v18
    v_and_b32 v61, 0xffff0000, v18
    v_cvt_pk_bf16_f32 v19, v62, v63
    v_lshlrev_b32 v62, 16, v19
    v_and_b32 v63, 0xffff0000, v19
    v_cvt_pk_bf16_f32 v18, v64, v65
    v_lshlrev_b32 v64, 16, v18
    v_and_b32 v65, 0xffff0000, v18
    v_cvt_pk_bf16_f32 v19, v66, v67
    v_lshlrev_b32 v66, 16, v19
    v_and_b32 v67, 0xffff0000, v19
    v_cvt_pk_bf16_f32 v18, v68, v69
    v_lshlrev_b32 v68, 16, v18
    v_and_b32 v69, 0xffff0000, v18
    v_cvt_pk_bf16_f32 v19, v70, v71
    v_lshlrev_b32 v70, 16, v19
    v_and_b32 v71, 0xffff0000, v19
    v_mul_f32 v56, v56, v82
    v_mul_f32 v57, v57, v82
    v_mul_f32 v58, v58, v82
    v_mul_f32 v59, v59, v82
    v_mul_f32 v60, v60, v82
    v_mul_f32 v61, v61, v82
    v_mul_f32 v62, v62, v82
    v_mul_f32 v63, v63, v82
    v_mul_f32 v64, v64, v82
    v_mul_f32 v65, v65, v82
    v_mul_f32 v66, v66, v82
    v_mul_f32 v67, v67, v82
    v_mul_f32 v68, v68, v82
    v_mul_f32 v69, v69, v82
    v_mul_f32 v70, v70, v82
    v_mul_f32 v71, v71, v82
    v_cvt_pk_bf16_f32 v18, v56, v57
    v_lshlrev_b32 v56, 16, v18
    v_and_b32 v57, 0xffff0000, v18
    v_cvt_pk_bf16_f32 v19, v58, v59
    v_lshlrev_b32 v58, 16, v19
    v_and_b32 v59, 0xffff0000, v19
    v_cvt_pk_bf16_f32 v18, v60, v61
    v_lshlrev_b32 v60, 16, v18
    v_and_b32 v61, 0xffff0000, v18
    v_cvt_pk_bf16_f32 v19, v62, v63
    v_lshlrev_b32 v62, 16, v19
    v_and_b32 v63, 0xffff0000, v19
    v_cvt_pk_bf16_f32 v18, v64, v65
    v_lshlrev_b32 v64, 16, v18
    v_and_b32 v65, 0xffff0000, v18
    v_cvt_pk_bf16_f32 v19, v66, v67
    v_lshlrev_b32 v66, 16, v19
    v_and_b32 v67, 0xffff0000, v19
    v_cvt_pk_bf16_f32 v18, v68, v69
    v_lshlrev_b32 v68, 16, v18
    v_and_b32 v69, 0xffff0000, v18
    v_cvt_pk_bf16_f32 v19, v70, v71
    v_lshlrev_b32 v70, 16, v19
    v_and_b32 v71, 0xffff0000, v19
    s_lshl_b32 s16, s29, 15
    s_lshl_b32 s17, s31, 11
    s_add_u32 s16, s16, s17
    s_waitcnt lgkmcnt(0)
    s_barrier
    ds_read_b128 v[96:99], v17 offset:256
    ds_read_b128 v[104:107], v17 offset:0
    ds_read_b128 v[100:103], v17 offset:272
    ds_read_b128 v[108:111], v17 offset:16
    ds_read_b128 v[112:115], v17 offset:384
    ds_read_b128 v[120:123], v17 offset:128
    ds_read_b128 v[116:119], v17 offset:400
    ds_read_b128 v[124:127], v17 offset:144
    s_waitcnt lgkmcnt(7)
    v_pk_mul_f32 v[56:57], v[56:57], v[96:97]
    v_pk_mul_f32 v[58:59], v[58:59], v[98:99]
    s_waitcnt lgkmcnt(5)
    v_pk_mul_f32 v[60:61], v[60:61], v[100:101]
    v_pk_mul_f32 v[62:63], v[62:63], v[102:103]
    v_cvt_pk_bf16_f32 v18, v56, v57
    v_lshlrev_b32 v56, 16, v18
    v_and_b32 v57, 0xffff0000, v18
    v_cvt_pk_bf16_f32 v19, v58, v59
    v_lshlrev_b32 v58, 16, v19
    v_and_b32 v59, 0xffff0000, v19
    v_cvt_pk_bf16_f32 v18, v60, v61
    v_lshlrev_b32 v60, 16, v18
    v_and_b32 v61, 0xffff0000, v18
    v_cvt_pk_bf16_f32 v19, v62, v63
    v_lshlrev_b32 v62, 16, v19
    v_and_b32 v63, 0xffff0000, v19
    v_pk_add_f32 v[56:57], v[56:57], v[104:105]
    v_pk_add_f32 v[58:59], v[58:59], v[106:107]
    s_waitcnt lgkmcnt(4)
    v_pk_add_f32 v[60:61], v[60:61], v[108:109]
    v_pk_add_f32 v[62:63], v[62:63], v[110:111]
    v_cvt_pk_bf16_f32 v32, v56, v57
    v_cvt_pk_bf16_f32 v33, v58, v59
    v_cvt_pk_bf16_f32 v34, v60, v61
    v_cvt_pk_bf16_f32 v35, v62, v63
    buffer_store_dwordx4 v[32:35], v2, s[8:11], s16 offen offset:0 sc1
    s_waitcnt lgkmcnt(3)
    v_pk_mul_f32 v[64:65], v[64:65], v[112:113]
    v_pk_mul_f32 v[66:67], v[66:67], v[114:115]
    s_waitcnt lgkmcnt(1)
    v_pk_mul_f32 v[68:69], v[68:69], v[116:117]
    v_pk_mul_f32 v[70:71], v[70:71], v[118:119]
    v_cvt_pk_bf16_f32 v18, v64, v65
    v_lshlrev_b32 v64, 16, v18
    v_and_b32 v65, 0xffff0000, v18
    v_cvt_pk_bf16_f32 v19, v66, v67
    v_lshlrev_b32 v66, 16, v19
    v_and_b32 v67, 0xffff0000, v19
    v_cvt_pk_bf16_f32 v18, v68, v69
    v_lshlrev_b32 v68, 16, v18
    v_and_b32 v69, 0xffff0000, v18
    v_cvt_pk_bf16_f32 v19, v70, v71
    v_lshlrev_b32 v70, 16, v19
    v_and_b32 v71, 0xffff0000, v19
    v_pk_add_f32 v[64:65], v[64:65], v[120:121]
    v_pk_add_f32 v[66:67], v[66:67], v[122:123]
    s_waitcnt lgkmcnt(0)
    v_pk_add_f32 v[68:69], v[68:69], v[124:125]
    v_pk_add_f32 v[70:71], v[70:71], v[126:127]
    v_cvt_pk_bf16_f32 v36, v64, v65
    v_cvt_pk_bf16_f32 v37, v66, v67
    v_cvt_pk_bf16_f32 v38, v68, v69
    v_cvt_pk_bf16_f32 v39, v70, v71
    buffer_store_dwordx4 v[36:39], v2, s[8:11], s16 offen offset:1024 sc1
    s_lshl_b32 s19, s3, 16
    s_lshl_b32 s20, s3, 11
    s_lshl_b32 s16, s12, 8
    s_add_u32 s4, s38, s16
    s_addc_u32 s5, s39, 0
    s_sub_u32 s6, 0x800000, s16
    s_mov_b32 s7, 0x20000
    s_barrier
    s_add_u32 s22, s19, 0x0
    s_add_u32 m0, s20, 0x0
    s_nop 0
    buffer_load_dwordx4 v3, s[4:7], s22 offen lds
    s_add_u32 s22, s19, 0x8000
    s_add_u32 m0, s20, 0x400
    s_nop 0
    buffer_load_dwordx4 v3, s[4:7], s22 offen lds
    s_add_u32 s22, s19, 0x80000
    s_add_u32 m0, s20, 0x4000
    s_nop 0
    buffer_load_dwordx4 v3, s[4:7], s22 offen lds
    s_add_u32 s22, s19, 0x88000
    s_add_u32 m0, s20, 0x4400
    s_nop 0
    buffer_load_dwordx4 v3, s[4:7], s22 offen lds
    s_add_u32 s22, s19, 0x100000
    s_add_u32 m0, s20, 0x8000
    s_nop 0
    buffer_load_dwordx4 v3, s[4:7], s22 offen lds
    s_add_u32 s22, s19, 0x108000
    s_add_u32 m0, s20, 0x8400
    s_nop 0
    buffer_load_dwordx4 v3, s[4:7], s22 offen lds
    v_mov_b32 v134, s28
    s_lshl_b32 s16, s29, 4
    s_add_u32 s16, s16, s31
    s_lshl_b32 s16, s16, 2
    s_add_u32 s16, s16, 0x528000
    v_and_b32 v16, 31, v1
    v_lshlrev_b32 v16, 2, v16
    s_lshl_b32 s17, s13, 3
    s_add_u32 s17, s17, s3
    s_lshl_b32 s17, s17, 7
    s_add_u32 s17, s17, 0x528000
    s_waitcnt vmcnt(6)
    s_mov_b64 exec, 1
    buffer_store_dword v134, v132, s[8:11], s16 offen sc1
    s_mov_b64 exec, -1
    s_waitcnt vmcnt(0)
    s_mov_b32 s27, 0
adaLN_cond__sliding_block_cached__moe_arch_mod__prompt_kernel_h3p:
    buffer_load_dword v17, v16, s[8:11], s17 offen sc1
    s_waitcnt vmcnt(0)
    v_cmp_ne_u32 vcc, s28, v17
    s_add_u32 s27, s27, 1
    s_cmp_ge_u32 s27, 65536
    s_cbranch_scc1 adaLN_cond__sliding_block_cached__moe_arch_mod__prompt_kernel_h3g
    s_cbranch_vccnz adaLN_cond__sliding_block_cached__moe_arch_mod__prompt_kernel_h3p
adaLN_cond__sliding_block_cached__moe_arch_mod__prompt_kernel_h3g:
    s_mov_b32 s23, 0x0
    buffer_load_dwordx4 v[88:91], v7, s[8:11], s23 offen offset:0 sc1
    s_mov_b32 s23, 0x8000
    buffer_load_dwordx4 v[92:95], v7, s[8:11], s23 offen offset:0 sc1
    s_mov_b32 s23, 0x0
    buffer_load_dwordx4 v[96:99], v7, s[8:11], s23 offen offset:1024 sc1
    s_mov_b32 s23, 0x8000
    buffer_load_dwordx4 v[100:103], v7, s[8:11], s23 offen offset:1024 sc1
    s_mov_b32 s23, 0x800
    buffer_load_dwordx4 v[104:107], v7, s[8:11], s23 offen offset:0 sc1
    s_mov_b32 s23, 0x8800
    buffer_load_dwordx4 v[108:111], v7, s[8:11], s23 offen offset:0 sc1
    s_mov_b32 s23, 0x800
    buffer_load_dwordx4 v[112:115], v7, s[8:11], s23 offen offset:1024 sc1
    s_mov_b32 s23, 0x8800
    buffer_load_dwordx4 v[116:119], v7, s[8:11], s23 offen offset:1024 sc1
    s_mov_b32 s23, 0x1000
    buffer_load_dwordx4 v[120:123], v7, s[8:11], s23 offen offset:0 sc1
    s_mov_b32 s23, 0x9000
    buffer_load_dwordx4 v[124:127], v7, s[8:11], s23 offen offset:0 sc1
    s_mov_b32 s23, 0x1000
    buffer_load_dwordx4 v[128:131], v7, s[8:11], s23 offen offset:1024 sc1
    s_mov_b32 s23, 0x9000
    buffer_load_dwordx4 v[132:135], v7, s[8:11], s23 offen offset:1024 sc1
    s_lshr_b32 s21, s12, 3
    s_lshl_b32 s21, s21, 17
    s_add_u32 s21, s21, s20
    s_add_u32 s21, s21, 0x400000
    s_barrier
    ds_read_b64_tr_b16 v[224:225], v4 offset:0
    ds_read_b64_tr_b16 v[226:227], v4 offset:1024
    ds_read_b64_tr_b16 v[228:229], v5 offset:32
    ds_read_b64_tr_b16 v[230:231], v5 offset:1056
    ds_read_b64_tr_b16 v[232:233], v4 offset:256
    ds_read_b64_tr_b16 v[234:235], v4 offset:1280
    s_waitcnt vmcnt(11) lgkmcnt(4)
    v_mfma_f32_16x16x32_bf16 v[24:27], v[224:227], v[88:91], 0
    ds_read_b64_tr_b16 v[236:237], v5 offset:288
    s_waitcnt vmcnt(10)
    v_mfma_f32_16x16x32_bf16 v[28:31], v[224:227], v[92:95], 0
    ds_read_b64_tr_b16 v[238:239], v5 offset:1312
    s_waitcnt lgkmcnt(4)
    v_mfma_f32_16x16x32_bf16 v[32:35], v[228:231], v[88:91], 0
    ds_read_b64_tr_b16 v[240:241], v4 offset:512
    v_mfma_f32_16x16x32_bf16 v[36:39], v[228:231], v[92:95], 0
    ds_read_b64_tr_b16 v[242:243], v4 offset:1536
    s_mov_b32 s23, 0x1800
    buffer_load_dwordx4 v[136:139], v7, s[8:11], s23 offen offset:0 sc1
    s_waitcnt lgkmcnt(4)
    v_mfma_f32_16x16x32_bf16 v[40:43], v[232:235], v[88:91], 0
    ds_read_b64_tr_b16 v[244:245], v5 offset:544
    v_mfma_f32_16x16x32_bf16 v[44:47], v[232:235], v[92:95], 0
    ds_read_b64_tr_b16 v[246:247], v5 offset:1568
    s_waitcnt lgkmcnt(4)
    v_mfma_f32_16x16x32_bf16 v[48:51], v[236:239], v[88:91], 0
    ds_read_b64_tr_b16 v[224:225], v4 offset:768
    v_mfma_f32_16x16x32_bf16 v[52:55], v[236:239], v[92:95], 0
    ds_read_b64_tr_b16 v[226:227], v4 offset:1792
    s_waitcnt lgkmcnt(4)
    v_mfma_f32_16x16x32_bf16 v[56:59], v[240:243], v[88:91], 0
    ds_read_b64_tr_b16 v[228:229], v5 offset:800
    v_mfma_f32_16x16x32_bf16 v[60:63], v[240:243], v[92:95], 0
    ds_read_b64_tr_b16 v[230:231], v5 offset:1824
    s_waitcnt lgkmcnt(4)
    v_mfma_f32_16x16x32_bf16 v[64:67], v[244:247], v[88:91], 0
    ds_read_b64_tr_b16 v[232:233], v4 offset:8192
    v_mfma_f32_16x16x32_bf16 v[68:71], v[244:247], v[92:95], 0
    ds_read_b64_tr_b16 v[234:235], v4 offset:9216
    s_mov_b32 s23, 0x9800
    buffer_load_dwordx4 v[140:143], v7, s[8:11], s23 offen offset:0 sc1
    s_waitcnt lgkmcnt(4)
    v_mfma_f32_16x16x32_bf16 v[72:75], v[224:227], v[88:91], 0
    ds_read_b64_tr_b16 v[236:237], v5 offset:8224
    v_mfma_f32_16x16x32_bf16 v[76:79], v[224:227], v[92:95], 0
    ds_read_b64_tr_b16 v[238:239], v5 offset:9248
    s_waitcnt lgkmcnt(4)
    v_mfma_f32_16x16x32_bf16 v[80:83], v[228:231], v[88:91], 0
    ds_read_b64_tr_b16 v[240:241], v4 offset:8448
    v_mfma_f32_16x16x32_bf16 v[84:87], v[228:231], v[92:95], 0
    ds_read_b64_tr_b16 v[242:243], v4 offset:9472
    s_waitcnt vmcnt(11) lgkmcnt(4)
    v_mfma_f32_16x16x32_bf16 v[24:27], v[232:235], v[96:99], v[24:27]
    ds_read_b64_tr_b16 v[244:245], v5 offset:8480
    s_waitcnt vmcnt(10)
    v_mfma_f32_16x16x32_bf16 v[28:31], v[232:235], v[100:103], v[28:31]
    ds_read_b64_tr_b16 v[246:247], v5 offset:9504
    s_waitcnt lgkmcnt(4)
    v_mfma_f32_16x16x32_bf16 v[32:35], v[236:239], v[96:99], v[32:35]
    ds_read_b64_tr_b16 v[224:225], v4 offset:8704
    v_mfma_f32_16x16x32_bf16 v[36:39], v[236:239], v[100:103], v[36:39]
    ds_read_b64_tr_b16 v[226:227], v4 offset:9728
    s_mov_b32 s23, 0x1800
    buffer_load_dwordx4 v[144:147], v7, s[8:11], s23 offen offset:1024 sc1
    s_waitcnt lgkmcnt(4)
    v_mfma_f32_16x16x32_bf16 v[40:43], v[240:243], v[96:99], v[40:43]
    ds_read_b64_tr_b16 v[228:229], v5 offset:8736
    v_mfma_f32_16x16x32_bf16 v[44:47], v[240:243], v[100:103], v[44:47]
    ds_read_b64_tr_b16 v[230:231], v5 offset:9760
    s_waitcnt lgkmcnt(4)
    v_mfma_f32_16x16x32_bf16 v[48:51], v[244:247], v[96:99], v[48:51]
    ds_read_b64_tr_b16 v[232:233], v4 offset:8960
    v_mfma_f32_16x16x32_bf16 v[52:55], v[244:247], v[100:103], v[52:55]
    ds_read_b64_tr_b16 v[234:235], v4 offset:9984
    s_waitcnt lgkmcnt(4)
    v_mfma_f32_16x16x32_bf16 v[56:59], v[224:227], v[96:99], v[56:59]
    ds_read_b64_tr_b16 v[236:237], v5 offset:8992
    v_mfma_f32_16x16x32_bf16 v[60:63], v[224:227], v[100:103], v[60:63]
    ds_read_b64_tr_b16 v[238:239], v5 offset:10016
    s_waitcnt lgkmcnt(4)
    v_mfma_f32_16x16x32_bf16 v[64:67], v[228:231], v[96:99], v[64:67]
    v_mfma_f32_16x16x32_bf16 v[68:71], v[228:231], v[100:103], v[68:71]
    s_barrier
    ds_read_b64_tr_b16 v[240:241], v4 offset:16384
    ds_read_b64_tr_b16 v[242:243], v4 offset:17408
    s_mov_b32 s23, 0x9800
    buffer_load_dwordx4 v[148:151], v7, s[8:11], s23 offen offset:1024 sc1
    s_waitcnt lgkmcnt(4)
    v_mfma_f32_16x16x32_bf16 v[72:75], v[232:235], v[96:99], v[72:75]
    ds_read_b64_tr_b16 v[244:245], v5 offset:16416
    v_mfma_f32_16x16x32_bf16 v[76:79], v[232:235], v[100:103], v[76:79]
    s_add_u32 s22, s19, 0x180000
    s_add_u32 m0, s20, 0xc000
    s_nop 0
    buffer_load_dwordx4 v3, s[4:7], s22 offen lds
    ds_read_b64_tr_b16 v[246:247], v5 offset:17440
    s_waitcnt lgkmcnt(4)
    v_mfma_f32_16x16x32_bf16 v[80:83], v[236:239], v[96:99], v[80:83]
    ds_read_b64_tr_b16 v[224:225], v4 offset:16640
    v_mfma_f32_16x16x32_bf16 v[84:87], v[236:239], v[100:103], v[84:87]
    ds_read_b64_tr_b16 v[226:227], v4 offset:17664
    s_waitcnt vmcnt(12) lgkmcnt(4)
    v_mfma_f32_16x16x32_bf16 v[24:27], v[240:243], v[104:107], v[24:27]
    ds_read_b64_tr_b16 v[228:229], v5 offset:16672
    s_waitcnt vmcnt(11)
    v_mfma_f32_16x16x32_bf16 v[28:31], v[240:243], v[108:111], v[28:31]
    ds_read_b64_tr_b16 v[230:231], v5 offset:17696
    s_waitcnt lgkmcnt(4)
    v_mfma_f32_16x16x32_bf16 v[32:35], v[244:247], v[104:107], v[32:35]
    ds_read_b64_tr_b16 v[232:233], v4 offset:16896
    v_mfma_f32_16x16x32_bf16 v[36:39], v[244:247], v[108:111], v[36:39]
    ds_read_b64_tr_b16 v[234:235], v4 offset:17920
    s_mov_b32 s23, 0x2000
    buffer_load_dwordx4 v[88:91], v7, s[8:11], s23 offen offset:0 sc1
    s_waitcnt lgkmcnt(4)
    v_mfma_f32_16x16x32_bf16 v[40:43], v[224:227], v[104:107], v[40:43]
    ds_read_b64_tr_b16 v[236:237], v5 offset:16928
    v_mfma_f32_16x16x32_bf16 v[44:47], v[224:227], v[108:111], v[44:47]
    s_add_u32 s22, s19, 0x188000
    s_add_u32 m0, s20, 0xc400
    s_nop 0
    buffer_load_dwordx4 v3, s[4:7], s22 offen lds
    ds_read_b64_tr_b16 v[238:239], v5 offset:17952
    s_waitcnt lgkmcnt(4)
    v_mfma_f32_16x16x32_bf16 v[48:51], v[228:231], v[104:107], v[48:51]
    ds_read_b64_tr_b16 v[240:241], v4 offset:17152
    v_mfma_f32_16x16x32_bf16 v[52:55], v[228:231], v[108:111], v[52:55]
    ds_read_b64_tr_b16 v[242:243], v4 offset:18176
    s_waitcnt lgkmcnt(4)
    v_mfma_f32_16x16x32_bf16 v[56:59], v[232:235], v[104:107], v[56:59]
    ds_read_b64_tr_b16 v[244:245], v5 offset:17184
    v_mfma_f32_16x16x32_bf16 v[60:63], v[232:235], v[108:111], v[60:63]
    ds_read_b64_tr_b16 v[246:247], v5 offset:18208
    s_waitcnt lgkmcnt(4)
    v_mfma_f32_16x16x32_bf16 v[64:67], v[236:239], v[104:107], v[64:67]
    ds_read_b64_tr_b16 v[224:225], v4 offset:24576
    v_mfma_f32_16x16x32_bf16 v[68:71], v[236:239], v[108:111], v[68:71]
    ds_read_b64_tr_b16 v[226:227], v4 offset:25600
    s_mov_b32 s23, 0xa000
    buffer_load_dwordx4 v[92:95], v7, s[8:11], s23 offen offset:0 sc1
    s_waitcnt lgkmcnt(4)
    v_mfma_f32_16x16x32_bf16 v[72:75], v[240:243], v[104:107], v[72:75]
    ds_read_b64_tr_b16 v[228:229], v5 offset:24608
    v_mfma_f32_16x16x32_bf16 v[76:79], v[240:243], v[108:111], v[76:79]
    ds_read_b64_tr_b16 v[230:231], v5 offset:25632
    s_waitcnt lgkmcnt(4)
    v_mfma_f32_16x16x32_bf16 v[80:83], v[244:247], v[104:107], v[80:83]
    ds_read_b64_tr_b16 v[232:233], v4 offset:24832
    v_mfma_f32_16x16x32_bf16 v[84:87], v[244:247], v[108:111], v[84:87]
    ds_read_b64_tr_b16 v[234:235], v4 offset:25856
    s_waitcnt vmcnt(13) lgkmcnt(4)
    v_mfma_f32_16x16x32_bf16 v[24:27], v[224:227], v[112:115], v[24:27]
    ds_read_b64_tr_b16 v[236:237], v5 offset:24864
    s_waitcnt vmcnt(12)
    v_mfma_f32_16x16x32_bf16 v[28:31], v[224:227], v[116:119], v[28:31]
    ds_read_b64_tr_b16 v[238:239], v5 offset:25888
    s_waitcnt lgkmcnt(4)
    v_mfma_f32_16x16x32_bf16 v[32:35], v[228:231], v[112:115], v[32:35]
    ds_read_b64_tr_b16 v[240:241], v4 offset:25088
    v_mfma_f32_16x16x32_bf16 v[36:39], v[228:231], v[116:119], v[36:39]
    ds_read_b64_tr_b16 v[242:243], v4 offset:26112
    s_mov_b32 s23, 0x2000
    buffer_load_dwordx4 v[96:99], v7, s[8:11], s23 offen offset:1024 sc1
    s_waitcnt lgkmcnt(4)
    v_mfma_f32_16x16x32_bf16 v[40:43], v[232:235], v[112:115], v[40:43]
    ds_read_b64_tr_b16 v[244:245], v5 offset:25120
    v_mfma_f32_16x16x32_bf16 v[44:47], v[232:235], v[116:119], v[44:47]
    ds_read_b64_tr_b16 v[246:247], v5 offset:26144
    s_waitcnt lgkmcnt(4)
    v_mfma_f32_16x16x32_bf16 v[48:51], v[236:239], v[112:115], v[48:51]
    ds_read_b64_tr_b16 v[224:225], v4 offset:25344
    v_mfma_f32_16x16x32_bf16 v[52:55], v[236:239], v[116:119], v[52:55]
    ds_read_b64_tr_b16 v[226:227], v4 offset:26368
    s_waitcnt lgkmcnt(4)
    v_mfma_f32_16x16x32_bf16 v[56:59], v[240:243], v[112:115], v[56:59]
    ds_read_b64_tr_b16 v[228:229], v5 offset:25376
    v_mfma_f32_16x16x32_bf16 v[60:63], v[240:243], v[116:119], v[60:63]
    ds_read_b64_tr_b16 v[230:231], v5 offset:26400
    s_waitcnt lgkmcnt(4)
    v_mfma_f32_16x16x32_bf16 v[64:67], v[244:247], v[112:115], v[64:67]
    v_mfma_f32_16x16x32_bf16 v[68:71], v[244:247], v[116:119], v[68:71]
    s_barrier
    ds_read_b64_tr_b16 v[232:233], v4 offset:32768
    ds_read_b64_tr_b16 v[234:235], v4 offset:33792
    s_mov_b32 s23, 0xa000
    buffer_load_dwordx4 v[100:103], v7, s[8:11], s23 offen offset:1024 sc1
    s_waitcnt lgkmcnt(4)
    v_mfma_f32_16x16x32_bf16 v[72:75], v[224:227], v[112:115], v[72:75]
    ds_read_b64_tr_b16 v[236:237], v5 offset:32800
    v_mfma_f32_16x16x32_bf16 v[76:79], v[224:227], v[116:119], v[76:79]
    s_add_u32 s22, s19, 0x200000
    s_add_u32 m0, s20, 0x0
    s_nop 0
    buffer_load_dwordx4 v3, s[4:7], s22 offen lds
    ds_read_b64_tr_b16 v[238:239], v5 offset:33824
    s_waitcnt lgkmcnt(4)
    v_mfma_f32_16x16x32_bf16 v[80:83], v[228:231], v[112:115], v[80:83]
    ds_read_b64_tr_b16 v[240:241], v4 offset:33024
    v_mfma_f32_16x16x32_bf16 v[84:87], v[228:231], v[116:119], v[84:87]
    ds_read_b64_tr_b16 v[242:243], v4 offset:34048
    s_waitcnt vmcnt(14) lgkmcnt(4)
    v_mfma_f32_16x16x32_bf16 v[24:27], v[232:235], v[120:123], v[24:27]
    ds_read_b64_tr_b16 v[244:245], v5 offset:33056
    s_waitcnt vmcnt(13)
    v_mfma_f32_16x16x32_bf16 v[28:31], v[232:235], v[124:127], v[28:31]
    ds_read_b64_tr_b16 v[246:247], v5 offset:34080
    s_waitcnt lgkmcnt(4)
    v_mfma_f32_16x16x32_bf16 v[32:35], v[236:239], v[120:123], v[32:35]
    ds_read_b64_tr_b16 v[224:225], v4 offset:33280
    v_mfma_f32_16x16x32_bf16 v[36:39], v[236:239], v[124:127], v[36:39]
    ds_read_b64_tr_b16 v[226:227], v4 offset:34304
    s_mov_b32 s23, 0x2800
    buffer_load_dwordx4 v[104:107], v7, s[8:11], s23 offen offset:0 sc1
    s_waitcnt lgkmcnt(4)
    v_mfma_f32_16x16x32_bf16 v[40:43], v[240:243], v[120:123], v[40:43]
    ds_read_b64_tr_b16 v[228:229], v5 offset:33312
    v_mfma_f32_16x16x32_bf16 v[44:47], v[240:243], v[124:127], v[44:47]
    s_add_u32 s22, s19, 0x208000
    s_add_u32 m0, s20, 0x400
    s_nop 0
    buffer_load_dwordx4 v3, s[4:7], s22 offen lds
    ds_read_b64_tr_b16 v[230:231], v5 offset:34336
    s_waitcnt lgkmcnt(4)
    v_mfma_f32_16x16x32_bf16 v[48:51], v[244:247], v[120:123], v[48:51]
    ds_read_b64_tr_b16 v[232:233], v4 offset:33536
    v_mfma_f32_16x16x32_bf16 v[52:55], v[244:247], v[124:127], v[52:55]
    ds_read_b64_tr_b16 v[234:235], v4 offset:34560
    s_waitcnt lgkmcnt(4)
    v_mfma_f32_16x16x32_bf16 v[56:59], v[224:227], v[120:123], v[56:59]
    ds_read_b64_tr_b16 v[236:237], v5 offset:33568
    v_mfma_f32_16x16x32_bf16 v[60:63], v[224:227], v[124:127], v[60:63]
    ds_read_b64_tr_b16 v[238:239], v5 offset:34592
    s_waitcnt lgkmcnt(4)
    v_mfma_f32_16x16x32_bf16 v[64:67], v[228:231], v[120:123], v[64:67]
    ds_read_b64_tr_b16 v[240:241], v4 offset:40960
    v_mfma_f32_16x16x32_bf16 v[68:71], v[228:231], v[124:127], v[68:71]
    ds_read_b64_tr_b16 v[242:243], v4 offset:41984
    s_mov_b32 s23, 0xa800
    buffer_load_dwordx4 v[108:111], v7, s[8:11], s23 offen offset:0 sc1
    s_waitcnt lgkmcnt(4)
    v_mfma_f32_16x16x32_bf16 v[72:75], v[232:235], v[120:123], v[72:75]
    ds_read_b64_tr_b16 v[244:245], v5 offset:40992
    v_mfma_f32_16x16x32_bf16 v[76:79], v[232:235], v[124:127], v[76:79]
    ds_read_b64_tr_b16 v[246:247], v5 offset:42016
    s_waitcnt lgkmcnt(4)
    v_mfma_f32_16x16x32_bf16 v[80:83], v[236:239], v[120:123], v[80:83]
    ds_read_b64_tr_b16 v[224:225], v4 offset:41216
    v_mfma_f32_16x16x32_bf16 v[84:87], v[236:239], v[124:127], v[84:87]
    ds_read_b64_tr_b16 v[226:227], v4 offset:42240
    s_waitcnt vmcnt(15) lgkmcnt(4)
    v_mfma_f32_16x16x32_bf16 v[24:27], v[240:243], v[128:131], v[24:27]
    ds_read_b64_tr_b16 v[228:229], v5 offset:41248
    s_waitcnt vmcnt(14)
    v_mfma_f32_16x16x32_bf16 v[28:31], v[240:243], v[132:135], v[28:31]
    ds_read_b64_tr_b16 v[230:231], v5 offset:42272
    s_waitcnt lgkmcnt(4)
    v_mfma_f32_16x16x32_bf16 v[32:35], v[244:247], v[128:131], v[32:35]
    ds_read_b64_tr_b16 v[232:233], v4 offset:41472
    v_mfma_f32_16x16x32_bf16 v[36:39], v[244:247], v[132:135], v[36:39]
    ds_read_b64_tr_b16 v[234:235], v4 offset:42496
    s_mov_b32 s23, 0x2800
    buffer_load_dwordx4 v[112:115], v7, s[8:11], s23 offen offset:1024 sc1
    s_waitcnt lgkmcnt(4)
    v_mfma_f32_16x16x32_bf16 v[40:43], v[224:227], v[128:131], v[40:43]
    ds_read_b64_tr_b16 v[236:237], v5 offset:41504
    v_mfma_f32_16x16x32_bf16 v[44:47], v[224:227], v[132:135], v[44:47]
    ds_read_b64_tr_b16 v[238:239], v5 offset:42528
    s_waitcnt lgkmcnt(4)
    v_mfma_f32_16x16x32_bf16 v[48:51], v[228:231], v[128:131], v[48:51]
    ds_read_b64_tr_b16 v[240:241], v4 offset:41728
    v_mfma_f32_16x16x32_bf16 v[52:55], v[228:231], v[132:135], v[52:55]
    ds_read_b64_tr_b16 v[242:243], v4 offset:42752
    s_waitcnt lgkmcnt(4)
    v_mfma_f32_16x16x32_bf16 v[56:59], v[232:235], v[128:131], v[56:59]
    ds_read_b64_tr_b16 v[244:245], v5 offset:41760
    v_mfma_f32_16x16x32_bf16 v[60:63], v[232:235], v[132:135], v[60:63]
    ds_read_b64_tr_b16 v[246:247], v5 offset:42784
    s_waitcnt lgkmcnt(4)
    v_mfma_f32_16x16x32_bf16 v[64:67], v[236:239], v[128:131], v[64:67]
    v_mfma_f32_16x16x32_bf16 v[68:71], v[236:239], v[132:135], v[68:71]
    s_waitcnt vmcnt(8)
    s_barrier
    ds_read_b64_tr_b16 v[224:225], v4 offset:49152
    ds_read_b64_tr_b16 v[226:227], v4 offset:50176
    s_mov_b32 s23, 0xa800
    buffer_load_dwordx4 v[116:119], v7, s[8:11], s23 offen offset:1024 sc1
    s_waitcnt lgkmcnt(4)
    v_mfma_f32_16x16x32_bf16 v[72:75], v[240:243], v[128:131], v[72:75]
    ds_read_b64_tr_b16 v[228:229], v5 offset:49184
    v_mfma_f32_16x16x32_bf16 v[76:79], v[240:243], v[132:135], v[76:79]
    s_add_u32 s22, s19, 0x280000
    s_add_u32 m0, s20, 0x4000
    s_nop 0
    buffer_load_dwordx4 v3, s[4:7], s22 offen lds
    ds_read_b64_tr_b16 v[230:231], v5 offset:50208
    s_waitcnt lgkmcnt(4)
    v_mfma_f32_16x16x32_bf16 v[80:83], v[244:247], v[128:131], v[80:83]
    ds_read_b64_tr_b16 v[232:233], v4 offset:49408
    v_mfma_f32_16x16x32_bf16 v[84:87], v[244:247], v[132:135], v[84:87]
    ds_read_b64_tr_b16 v[234:235], v4 offset:50432
    s_waitcnt lgkmcnt(4)
    v_mfma_f32_16x16x32_bf16 v[24:27], v[224:227], v[136:139], v[24:27]
    ds_read_b64_tr_b16 v[236:237], v5 offset:49440
    v_mfma_f32_16x16x32_bf16 v[28:31], v[224:227], v[140:143], v[28:31]
    ds_read_b64_tr_b16 v[238:239], v5 offset:50464
    s_waitcnt lgkmcnt(4)
    v_mfma_f32_16x16x32_bf16 v[32:35], v[228:231], v[136:139], v[32:35]
    ds_read_b64_tr_b16 v[240:241], v4 offset:49664
    v_mfma_f32_16x16x32_bf16 v[36:39], v[228:231], v[140:143], v[36:39]
    ds_read_b64_tr_b16 v[242:243], v4 offset:50688
    s_mov_b32 s23, 0x3000
    buffer_load_dwordx4 v[120:123], v7, s[8:11], s23 offen offset:0 sc1
    s_waitcnt lgkmcnt(4)
    v_mfma_f32_16x16x32_bf16 v[40:43], v[232:235], v[136:139], v[40:43]
    ds_read_b64_tr_b16 v[244:245], v5 offset:49696
    v_mfma_f32_16x16x32_bf16 v[44:47], v[232:235], v[140:143], v[44:47]
    s_add_u32 s22, s19, 0x288000
    s_add_u32 m0, s20, 0x4400
    s_nop 0
    buffer_load_dwordx4 v3, s[4:7], s22 offen lds
    ds_read_b64_tr_b16 v[246:247], v5 offset:50720
    s_waitcnt lgkmcnt(4)
    v_mfma_f32_16x16x32_bf16 v[48:51], v[236:239], v[136:139], v[48:51]
    ds_read_b64_tr_b16 v[224:225], v4 offset:49920
    v_mfma_f32_16x16x32_bf16 v[52:55], v[236:239], v[140:143], v[52:55]
    ds_read_b64_tr_b16 v[226:227], v4 offset:50944
    s_waitcnt lgkmcnt(4)
    v_mfma_f32_16x16x32_bf16 v[56:59], v[240:243], v[136:139], v[56:59]
    ds_read_b64_tr_b16 v[228:229], v5 offset:49952
    v_mfma_f32_16x16x32_bf16 v[60:63], v[240:243], v[140:143], v[60:63]
    ds_read_b64_tr_b16 v[230:231], v5 offset:50976
    s_waitcnt lgkmcnt(4)
    v_mfma_f32_16x16x32_bf16 v[64:67], v[244:247], v[136:139], v[64:67]
    ds_read_b64_tr_b16 v[232:233], v4 offset:57344
    v_mfma_f32_16x16x32_bf16 v[68:71], v[244:247], v[140:143], v[68:71]
    ds_read_b64_tr_b16 v[234:235], v4 offset:58368
    s_mov_b32 s23, 0xb000
    buffer_load_dwordx4 v[124:127], v7, s[8:11], s23 offen offset:0 sc1
    s_waitcnt lgkmcnt(4)
    v_mfma_f32_16x16x32_bf16 v[72:75], v[224:227], v[136:139], v[72:75]
    ds_read_b64_tr_b16 v[236:237], v5 offset:57376
    v_mfma_f32_16x16x32_bf16 v[76:79], v[224:227], v[140:143], v[76:79]
    ds_read_b64_tr_b16 v[238:239], v5 offset:58400
    s_waitcnt lgkmcnt(4)
    v_mfma_f32_16x16x32_bf16 v[80:83], v[228:231], v[136:139], v[80:83]
    ds_read_b64_tr_b16 v[240:241], v4 offset:57600
    v_mfma_f32_16x16x32_bf16 v[84:87], v[228:231], v[140:143], v[84:87]
    ds_read_b64_tr_b16 v[242:243], v4 offset:58624
    s_waitcnt lgkmcnt(4)
    v_mfma_f32_16x16x32_bf16 v[24:27], v[232:235], v[144:147], v[24:27]
    ds_read_b64_tr_b16 v[244:245], v5 offset:57632
    v_mfma_f32_16x16x32_bf16 v[28:31], v[232:235], v[148:151], v[28:31]
    ds_read_b64_tr_b16 v[246:247], v5 offset:58656
    s_waitcnt lgkmcnt(4)
    v_mfma_f32_16x16x32_bf16 v[32:35], v[236:239], v[144:147], v[32:35]
    ds_read_b64_tr_b16 v[224:225], v4 offset:57856
    v_mfma_f32_16x16x32_bf16 v[36:39], v[236:239], v[148:151], v[36:39]
    ds_read_b64_tr_b16 v[226:227], v4 offset:58880
    s_mov_b32 s23, 0x3000
    buffer_load_dwordx4 v[128:131], v7, s[8:11], s23 offen offset:1024 sc1
    s_waitcnt lgkmcnt(4)
    v_mfma_f32_16x16x32_bf16 v[40:43], v[240:243], v[144:147], v[40:43]
    ds_read_b64_tr_b16 v[228:229], v5 offset:57888
    v_mfma_f32_16x16x32_bf16 v[44:47], v[240:243], v[148:151], v[44:47]
    ds_read_b64_tr_b16 v[230:231], v5 offset:58912
    s_waitcnt lgkmcnt(4)
    v_mfma_f32_16x16x32_bf16 v[48:51], v[244:247], v[144:147], v[48:51]
    ds_read_b64_tr_b16 v[232:233], v4 offset:58112
    v_mfma_f32_16x16x32_bf16 v[52:55], v[244:247], v[148:151], v[52:55]
    ds_read_b64_tr_b16 v[234:235], v4 offset:59136
    s_waitcnt lgkmcnt(4)
    v_mfma_f32_16x16x32_bf16 v[56:59], v[224:227], v[144:147], v[56:59]
    ds_read_b64_tr_b16 v[236:237], v5 offset:58144
    v_mfma_f32_16x16x32_bf16 v[60:63], v[224:227], v[148:151], v[60:63]
    ds_read_b64_tr_b16 v[238:239], v5 offset:59168
    s_waitcnt lgkmcnt(4)
    v_mfma_f32_16x16x32_bf16 v[64:67], v[228:231], v[144:147], v[64:67]
    v_mfma_f32_16x16x32_bf16 v[68:71], v[228:231], v[148:151], v[68:71]
    s_waitcnt vmcnt(8)
    s_barrier
    ds_read_b64_tr_b16 v[240:241], v4 offset:0
    ds_read_b64_tr_b16 v[242:243], v4 offset:1024
    s_mov_b32 s23, 0xb000
    buffer_load_dwordx4 v[132:135], v7, s[8:11], s23 offen offset:1024 sc1
    s_waitcnt lgkmcnt(4)
    v_mfma_f32_16x16x32_bf16 v[72:75], v[232:235], v[144:147], v[72:75]
    ds_read_b64_tr_b16 v[244:245], v5 offset:32
    v_mfma_f32_16x16x32_bf16 v[76:79], v[232:235], v[148:151], v[76:79]
    s_add_u32 s22, s19, 0x300000
    s_add_u32 m0, s20, 0x8000
    s_nop 0
    buffer_load_dwordx4 v3, s[4:7], s22 offen lds
    ds_read_b64_tr_b16 v[246:247], v5 offset:1056
    s_waitcnt lgkmcnt(4)
    v_mfma_f32_16x16x32_bf16 v[80:83], v[236:239], v[144:147], v[80:83]
    ds_read_b64_tr_b16 v[224:225], v4 offset:256
    v_mfma_f32_16x16x32_bf16 v[84:87], v[236:239], v[148:151], v[84:87]
    ds_read_b64_tr_b16 v[226:227], v4 offset:1280
    s_waitcnt lgkmcnt(4)
    v_mfma_f32_16x16x32_bf16 v[24:27], v[240:243], v[88:91], v[24:27]
    ds_read_b64_tr_b16 v[228:229], v5 offset:288
    v_mfma_f32_16x16x32_bf16 v[28:31], v[240:243], v[92:95], v[28:31]
    ds_read_b64_tr_b16 v[230:231], v5 offset:1312
    s_waitcnt lgkmcnt(4)
    v_mfma_f32_16x16x32_bf16 v[32:35], v[244:247], v[88:91], v[32:35]
    ds_read_b64_tr_b16 v[232:233], v4 offset:512
    v_mfma_f32_16x16x32_bf16 v[36:39], v[244:247], v[92:95], v[36:39]
    ds_read_b64_tr_b16 v[234:235], v4 offset:1536
    s_mov_b32 s23, 0x3800
    buffer_load_dwordx4 v[136:139], v7, s[8:11], s23 offen offset:0 sc1
    s_waitcnt lgkmcnt(4)
    v_mfma_f32_16x16x32_bf16 v[40:43], v[224:227], v[88:91], v[40:43]
    ds_read_b64_tr_b16 v[236:237], v5 offset:544
    v_mfma_f32_16x16x32_bf16 v[44:47], v[224:227], v[92:95], v[44:47]
    s_add_u32 s22, s19, 0x308000
    s_add_u32 m0, s20, 0x8400
    s_nop 0
    buffer_load_dwordx4 v3, s[4:7], s22 offen lds
    ds_read_b64_tr_b16 v[238:239], v5 offset:1568
    s_waitcnt lgkmcnt(4)
    v_mfma_f32_16x16x32_bf16 v[48:51], v[228:231], v[88:91], v[48:51]
    ds_read_b64_tr_b16 v[240:241], v4 offset:768
    v_mfma_f32_16x16x32_bf16 v[52:55], v[228:231], v[92:95], v[52:55]
    ds_read_b64_tr_b16 v[242:243], v4 offset:1792
    s_waitcnt lgkmcnt(4)
    v_mfma_f32_16x16x32_bf16 v[56:59], v[232:235], v[88:91], v[56:59]
    ds_read_b64_tr_b16 v[244:245], v5 offset:800
    v_mfma_f32_16x16x32_bf16 v[60:63], v[232:235], v[92:95], v[60:63]
    ds_read_b64_tr_b16 v[246:247], v5 offset:1824
    s_waitcnt lgkmcnt(4)
    v_mfma_f32_16x16x32_bf16 v[64:67], v[236:239], v[88:91], v[64:67]
    ds_read_b64_tr_b16 v[224:225], v4 offset:8192
    v_mfma_f32_16x16x32_bf16 v[68:71], v[236:239], v[92:95], v[68:71]
    ds_read_b64_tr_b16 v[226:227], v4 offset:9216
    s_mov_b32 s23, 0xb800
    buffer_load_dwordx4 v[140:143], v7, s[8:11], s23 offen offset:0 sc1
    s_waitcnt lgkmcnt(4)
    v_mfma_f32_16x16x32_bf16 v[72:75], v[240:243], v[88:91], v[72:75]
    ds_read_b64_tr_b16 v[228:229], v5 offset:8224
    v_mfma_f32_16x16x32_bf16 v[76:79], v[240:243], v[92:95], v[76:79]
    ds_read_b64_tr_b16 v[230:231], v5 offset:9248
    s_waitcnt lgkmcnt(4)
    v_mfma_f32_16x16x32_bf16 v[80:83], v[244:247], v[88:91], v[80:83]
    ds_read_b64_tr_b16 v[232:233], v4 offset:8448
    v_mfma_f32_16x16x32_bf16 v[84:87], v[244:247], v[92:95], v[84:87]
    ds_read_b64_tr_b16 v[234:235], v4 offset:9472
    s_waitcnt lgkmcnt(4)
    v_mfma_f32_16x16x32_bf16 v[24:27], v[224:227], v[96:99], v[24:27]
    ds_read_b64_tr_b16 v[236:237], v5 offset:8480
    v_mfma_f32_16x16x32_bf16 v[28:31], v[224:227], v[100:103], v[28:31]
    ds_read_b64_tr_b16 v[238:239], v5 offset:9504
    s_waitcnt lgkmcnt(4)
    v_mfma_f32_16x16x32_bf16 v[32:35], v[228:231], v[96:99], v[32:35]
    ds_read_b64_tr_b16 v[240:241], v4 offset:8704
    v_mfma_f32_16x16x32_bf16 v[36:39], v[228:231], v[100:103], v[36:39]
    ds_read_b64_tr_b16 v[242:243], v4 offset:9728
    s_mov_b32 s23, 0x3800
    buffer_load_dwordx4 v[144:147], v7, s[8:11], s23 offen offset:1024 sc1
    s_waitcnt lgkmcnt(4)
    v_mfma_f32_16x16x32_bf16 v[40:43], v[232:235], v[96:99], v[40:43]
    ds_read_b64_tr_b16 v[244:245], v5 offset:8736
    v_mfma_f32_16x16x32_bf16 v[44:47], v[232:235], v[100:103], v[44:47]
    ds_read_b64_tr_b16 v[246:247], v5 offset:9760
    s_waitcnt lgkmcnt(4)
    v_mfma_f32_16x16x32_bf16 v[48:51], v[236:239], v[96:99], v[48:51]
    ds_read_b64_tr_b16 v[224:225], v4 offset:8960
    v_mfma_f32_16x16x32_bf16 v[52:55], v[236:239], v[100:103], v[52:55]
    ds_read_b64_tr_b16 v[226:227], v4 offset:9984
    s_waitcnt lgkmcnt(4)
    v_mfma_f32_16x16x32_bf16 v[56:59], v[240:243], v[96:99], v[56:59]
    ds_read_b64_tr_b16 v[228:229], v5 offset:8992
    v_mfma_f32_16x16x32_bf16 v[60:63], v[240:243], v[100:103], v[60:63]
    ds_read_b64_tr_b16 v[230:231], v5 offset:10016
    s_waitcnt lgkmcnt(4)
    v_mfma_f32_16x16x32_bf16 v[64:67], v[244:247], v[96:99], v[64:67]
    v_mfma_f32_16x16x32_bf16 v[68:71], v[244:247], v[100:103], v[68:71]
    s_waitcnt vmcnt(8)
    s_barrier
    ds_read_b64_tr_b16 v[232:233], v4 offset:16384
    ds_read_b64_tr_b16 v[234:235], v4 offset:17408
    s_mov_b32 s23, 0xb800
    buffer_load_dwordx4 v[148:151], v7, s[8:11], s23 offen offset:1024 sc1
    s_waitcnt lgkmcnt(4)
    v_mfma_f32_16x16x32_bf16 v[72:75], v[224:227], v[96:99], v[72:75]
    ds_read_b64_tr_b16 v[236:237], v5 offset:16416
    v_mfma_f32_16x16x32_bf16 v[76:79], v[224:227], v[100:103], v[76:79]
    s_add_u32 s22, s19, 0x380000
    s_add_u32 m0, s20, 0xc000
    s_nop 0
    buffer_load_dwordx4 v3, s[4:7], s22 offen lds
    ds_read_b64_tr_b16 v[238:239], v5 offset:17440
    s_waitcnt lgkmcnt(4)
    v_mfma_f32_16x16x32_bf16 v[80:83], v[228:231], v[96:99], v[80:83]
    ds_read_b64_tr_b16 v[240:241], v4 offset:16640
    v_mfma_f32_16x16x32_bf16 v[84:87], v[228:231], v[100:103], v[84:87]
    ds_read_b64_tr_b16 v[242:243], v4 offset:17664
    s_waitcnt lgkmcnt(4)
    v_mfma_f32_16x16x32_bf16 v[24:27], v[232:235], v[104:107], v[24:27]
    ds_read_b64_tr_b16 v[244:245], v5 offset:16672
    v_mfma_f32_16x16x32_bf16 v[28:31], v[232:235], v[108:111], v[28:31]
    ds_read_b64_tr_b16 v[246:247], v5 offset:17696
    s_waitcnt lgkmcnt(4)
    v_mfma_f32_16x16x32_bf16 v[32:35], v[236:239], v[104:107], v[32:35]
    ds_read_b64_tr_b16 v[224:225], v4 offset:16896
    v_mfma_f32_16x16x32_bf16 v[36:39], v[236:239], v[108:111], v[36:39]
    ds_read_b64_tr_b16 v[226:227], v4 offset:17920
    s_mov_b32 s23, 0x4000
    buffer_load_dwordx4 v[88:91], v7, s[8:11], s23 offen offset:0 sc1
    s_waitcnt lgkmcnt(4)
    v_mfma_f32_16x16x32_bf16 v[40:43], v[240:243], v[104:107], v[40:43]
    ds_read_b64_tr_b16 v[228:229], v5 offset:16928
    v_mfma_f32_16x16x32_bf16 v[44:47], v[240:243], v[108:111], v[44:47]
    s_add_u32 s22, s19, 0x388000
    s_add_u32 m0, s20, 0xc400
    s_nop 0
    buffer_load_dwordx4 v3, s[4:7], s22 offen lds
    ds_read_b64_tr_b16 v[230:231], v5 offset:17952
    s_waitcnt lgkmcnt(4)
    v_mfma_f32_16x16x32_bf16 v[48:51], v[244:247], v[104:107], v[48:51]
    ds_read_b64_tr_b16 v[232:233], v4 offset:17152
    v_mfma_f32_16x16x32_bf16 v[52:55], v[244:247], v[108:111], v[52:55]
    ds_read_b64_tr_b16 v[234:235], v4 offset:18176
    s_waitcnt lgkmcnt(4)
    v_mfma_f32_16x16x32_bf16 v[56:59], v[224:227], v[104:107], v[56:59]
    ds_read_b64_tr_b16 v[236:237], v5 offset:17184
    v_mfma_f32_16x16x32_bf16 v[60:63], v[224:227], v[108:111], v[60:63]
    ds_read_b64_tr_b16 v[238:239], v5 offset:18208
    s_waitcnt lgkmcnt(4)
    v_mfma_f32_16x16x32_bf16 v[64:67], v[228:231], v[104:107], v[64:67]
    ds_read_b64_tr_b16 v[240:241], v4 offset:24576
    v_mfma_f32_16x16x32_bf16 v[68:71], v[228:231], v[108:111], v[68:71]
    ds_read_b64_tr_b16 v[242:243], v4 offset:25600
    s_mov_b32 s23, 0xc000
    buffer_load_dwordx4 v[92:95], v7, s[8:11], s23 offen offset:0 sc1
    s_waitcnt lgkmcnt(4)
    v_mfma_f32_16x16x32_bf16 v[72:75], v[232:235], v[104:107], v[72:75]
    ds_read_b64_tr_b16 v[244:245], v5 offset:24608
    v_mfma_f32_16x16x32_bf16 v[76:79], v[232:235], v[108:111], v[76:79]
    ds_read_b64_tr_b16 v[246:247], v5 offset:25632
    s_waitcnt lgkmcnt(4)
    v_mfma_f32_16x16x32_bf16 v[80:83], v[236:239], v[104:107], v[80:83]
    ds_read_b64_tr_b16 v[224:225], v4 offset:24832
    v_mfma_f32_16x16x32_bf16 v[84:87], v[236:239], v[108:111], v[84:87]
    ds_read_b64_tr_b16 v[226:227], v4 offset:25856
    s_waitcnt lgkmcnt(4)
    v_mfma_f32_16x16x32_bf16 v[24:27], v[240:243], v[112:115], v[24:27]
    ds_read_b64_tr_b16 v[228:229], v5 offset:24864
    v_mfma_f32_16x16x32_bf16 v[28:31], v[240:243], v[116:119], v[28:31]
    ds_read_b64_tr_b16 v[230:231], v5 offset:25888
    s_waitcnt lgkmcnt(4)
    v_mfma_f32_16x16x32_bf16 v[32:35], v[244:247], v[112:115], v[32:35]
    ds_read_b64_tr_b16 v[232:233], v4 offset:25088
    v_mfma_f32_16x16x32_bf16 v[36:39], v[244:247], v[116:119], v[36:39]
    ds_read_b64_tr_b16 v[234:235], v4 offset:26112
    s_mov_b32 s23, 0x4000
    buffer_load_dwordx4 v[96:99], v7, s[8:11], s23 offen offset:1024 sc1
    s_waitcnt lgkmcnt(4)
    v_mfma_f32_16x16x32_bf16 v[40:43], v[224:227], v[112:115], v[40:43]
    ds_read_b64_tr_b16 v[236:237], v5 offset:25120
    v_mfma_f32_16x16x32_bf16 v[44:47], v[224:227], v[116:119], v[44:47]
    ds_read_b64_tr_b16 v[238:239], v5 offset:26144
    s_waitcnt lgkmcnt(4)
    v_mfma_f32_16x16x32_bf16 v[48:51], v[228:231], v[112:115], v[48:51]
    ds_read_b64_tr_b16 v[240:241], v4 offset:25344
    v_mfma_f32_16x16x32_bf16 v[52:55], v[228:231], v[116:119], v[52:55]
    ds_read_b64_tr_b16 v[242:243], v4 offset:26368
    s_waitcnt lgkmcnt(4)
    v_mfma_f32_16x16x32_bf16 v[56:59], v[232:235], v[112:115], v[56:59]
    ds_read_b64_tr_b16 v[244:245], v5 offset:25376
    v_mfma_f32_16x16x32_bf16 v[60:63], v[232:235], v[116:119], v[60:63]
    ds_read_b64_tr_b16 v[246:247], v5 offset:26400
    s_waitcnt lgkmcnt(4)
    v_mfma_f32_16x16x32_bf16 v[64:67], v[236:239], v[112:115], v[64:67]
    v_mfma_f32_16x16x32_bf16 v[68:71], v[236:239], v[116:119], v[68:71]
    s_waitcnt vmcnt(8)
    s_barrier
    ds_read_b64_tr_b16 v[224:225], v4 offset:32768
    ds_read_b64_tr_b16 v[226:227], v4 offset:33792
    s_mov_b32 s23, 0xc000
    buffer_load_dwordx4 v[100:103], v7, s[8:11], s23 offen offset:1024 sc1
    s_waitcnt lgkmcnt(4)
    v_mfma_f32_16x16x32_bf16 v[72:75], v[240:243], v[112:115], v[72:75]
    ds_read_b64_tr_b16 v[228:229], v5 offset:32800
    v_mfma_f32_16x16x32_bf16 v[76:79], v[240:243], v[116:119], v[76:79]
    s_add_u32 s22, s19, 0x400000
    s_add_u32 m0, s20, 0x0
    s_nop 0
    buffer_load_dwordx4 v3, s[4:7], s22 offen lds
    ds_read_b64_tr_b16 v[230:231], v5 offset:33824
    s_waitcnt lgkmcnt(4)
    v_mfma_f32_16x16x32_bf16 v[80:83], v[244:247], v[112:115], v[80:83]
    ds_read_b64_tr_b16 v[232:233], v4 offset:33024
    v_mfma_f32_16x16x32_bf16 v[84:87], v[244:247], v[116:119], v[84:87]
    ds_read_b64_tr_b16 v[234:235], v4 offset:34048
    s_waitcnt lgkmcnt(4)
    v_mfma_f32_16x16x32_bf16 v[24:27], v[224:227], v[120:123], v[24:27]
    ds_read_b64_tr_b16 v[236:237], v5 offset:33056
    v_mfma_f32_16x16x32_bf16 v[28:31], v[224:227], v[124:127], v[28:31]
    ds_read_b64_tr_b16 v[238:239], v5 offset:34080
    s_waitcnt lgkmcnt(4)
    v_mfma_f32_16x16x32_bf16 v[32:35], v[228:231], v[120:123], v[32:35]
    ds_read_b64_tr_b16 v[240:241], v4 offset:33280
    v_mfma_f32_16x16x32_bf16 v[36:39], v[228:231], v[124:127], v[36:39]
    ds_read_b64_tr_b16 v[242:243], v4 offset:34304
    s_mov_b32 s23, 0x4800
    buffer_load_dwordx4 v[104:107], v7, s[8:11], s23 offen offset:0 sc1
    s_waitcnt lgkmcnt(4)
    v_mfma_f32_16x16x32_bf16 v[40:43], v[232:235], v[120:123], v[40:43]
    ds_read_b64_tr_b16 v[244:245], v5 offset:33312
    v_mfma_f32_16x16x32_bf16 v[44:47], v[232:235], v[124:127], v[44:47]
    s_add_u32 s22, s19, 0x408000
    s_add_u32 m0, s20, 0x400
    s_nop 0
    buffer_load_dwordx4 v3, s[4:7], s22 offen lds
    ds_read_b64_tr_b16 v[246:247], v5 offset:34336
    s_waitcnt lgkmcnt(4)
    v_mfma_f32_16x16x32_bf16 v[48:51], v[236:239], v[120:123], v[48:51]
    ds_read_b64_tr_b16 v[224:225], v4 offset:33536
    v_mfma_f32_16x16x32_bf16 v[52:55], v[236:239], v[124:127], v[52:55]
    ds_read_b64_tr_b16 v[226:227], v4 offset:34560
    s_waitcnt lgkmcnt(4)
    v_mfma_f32_16x16x32_bf16 v[56:59], v[240:243], v[120:123], v[56:59]
    ds_read_b64_tr_b16 v[228:229], v5 offset:33568
    v_mfma_f32_16x16x32_bf16 v[60:63], v[240:243], v[124:127], v[60:63]
    ds_read_b64_tr_b16 v[230:231], v5 offset:34592
    s_waitcnt lgkmcnt(4)
    v_mfma_f32_16x16x32_bf16 v[64:67], v[244:247], v[120:123], v[64:67]
    ds_read_b64_tr_b16 v[232:233], v4 offset:40960
    v_mfma_f32_16x16x32_bf16 v[68:71], v[244:247], v[124:127], v[68:71]
    ds_read_b64_tr_b16 v[234:235], v4 offset:41984
    s_mov_b32 s23, 0xc800
    buffer_load_dwordx4 v[108:111], v7, s[8:11], s23 offen offset:0 sc1
    s_waitcnt lgkmcnt(4)
    v_mfma_f32_16x16x32_bf16 v[72:75], v[224:227], v[120:123], v[72:75]
    ds_read_b64_tr_b16 v[236:237], v5 offset:40992
    v_lshrrev_b32 v21, 4, v1
    v_lshlrev_b32 v21, 9, v21
    v_and_b32 v20, 15, v1
    v_lshl_add_u32 v21, v20, 4, v21
    s_lshr_b32 s18, s12, 3
    s_lshl_b32 s18, s18, 11
    s_add_u32 s18, s18, 0x528100
    buffer_load_dwordx4 v[12:15], v21, s[8:11], s18 offen sc1
    v_mfma_f32_16x16x32_bf16 v[76:79], v[224:227], v[124:127], v[76:79]
    ds_read_b64_tr_b16 v[238:239], v5 offset:42016
    s_waitcnt lgkmcnt(4)
    v_mfma_f32_16x16x32_bf16 v[80:83], v[228:231], v[120:123], v[80:83]
    ds_read_b64_tr_b16 v[240:241], v4 offset:41216
    v_mfma_f32_16x16x32_bf16 v[84:87], v[228:231], v[124:127], v[84:87]
    ds_read_b64_tr_b16 v[242:243], v4 offset:42240
    s_waitcnt lgkmcnt(4)
    v_mfma_f32_16x16x32_bf16 v[24:27], v[232:235], v[128:131], v[24:27]
    ds_read_b64_tr_b16 v[244:245], v5 offset:41248
    v_mfma_f32_16x16x32_bf16 v[28:31], v[232:235], v[132:135], v[28:31]
    ds_read_b64_tr_b16 v[246:247], v5 offset:42272
    s_waitcnt lgkmcnt(4)
    v_mfma_f32_16x16x32_bf16 v[32:35], v[236:239], v[128:131], v[32:35]
    ds_read_b64_tr_b16 v[224:225], v4 offset:41472
    v_mfma_f32_16x16x32_bf16 v[36:39], v[236:239], v[132:135], v[36:39]
    ds_read_b64_tr_b16 v[226:227], v4 offset:42496
    s_mov_b32 s23, 0x4800
    buffer_load_dwordx4 v[112:115], v7, s[8:11], s23 offen offset:1024 sc1
    s_waitcnt lgkmcnt(4)
    v_mfma_f32_16x16x32_bf16 v[40:43], v[240:243], v[128:131], v[40:43]
    ds_read_b64_tr_b16 v[228:229], v5 offset:41504
    v_mfma_f32_16x16x32_bf16 v[44:47], v[240:243], v[132:135], v[44:47]
    ds_read_b64_tr_b16 v[230:231], v5 offset:42528
    s_waitcnt lgkmcnt(4)
    v_mfma_f32_16x16x32_bf16 v[48:51], v[244:247], v[128:131], v[48:51]
    ds_read_b64_tr_b16 v[232:233], v4 offset:41728
    v_mfma_f32_16x16x32_bf16 v[52:55], v[244:247], v[132:135], v[52:55]
    ds_read_b64_tr_b16 v[234:235], v4 offset:42752
    s_waitcnt lgkmcnt(4)
    v_mfma_f32_16x16x32_bf16 v[56:59], v[224:227], v[128:131], v[56:59]
    ds_read_b64_tr_b16 v[236:237], v5 offset:41760
    v_mfma_f32_16x16x32_bf16 v[60:63], v[224:227], v[132:135], v[60:63]
    ds_read_b64_tr_b16 v[238:239], v5 offset:42784
    s_waitcnt lgkmcnt(4)
    v_mfma_f32_16x16x32_bf16 v[64:67], v[228:231], v[128:131], v[64:67]
    v_mfma_f32_16x16x32_bf16 v[68:71], v[228:231], v[132:135], v[68:71]
    s_waitcnt vmcnt(9)
    s_barrier
    ds_read_b64_tr_b16 v[240:241], v4 offset:49152
    ds_read_b64_tr_b16 v[242:243], v4 offset:50176
    s_mov_b32 s23, 0xc800
    buffer_load_dwordx4 v[116:119], v7, s[8:11], s23 offen offset:1024 sc1
    s_waitcnt lgkmcnt(4)
    v_mfma_f32_16x16x32_bf16 v[72:75], v[232:235], v[128:131], v[72:75]
    ds_read_b64_tr_b16 v[244:245], v5 offset:49184
    v_mfma_f32_16x16x32_bf16 v[76:79], v[232:235], v[132:135], v[76:79]
    s_add_u32 s22, s19, 0x480000
    s_add_u32 m0, s20, 0x4000
    s_nop 0
    buffer_load_dwordx4 v3, s[4:7], s22 offen lds
    ds_read_b64_tr_b16 v[246:247], v5 offset:50208
    s_waitcnt lgkmcnt(4)
    v_mfma_f32_16x16x32_bf16 v[80:83], v[236:239], v[128:131], v[80:83]
    ds_read_b64_tr_b16 v[224:225], v4 offset:49408
    v_mfma_f32_16x16x32_bf16 v[84:87], v[236:239], v[132:135], v[84:87]
    ds_read_b64_tr_b16 v[226:227], v4 offset:50432
    s_waitcnt lgkmcnt(4)
    v_mfma_f32_16x16x32_bf16 v[24:27], v[240:243], v[136:139], v[24:27]
    ds_read_b64_tr_b16 v[228:229], v5 offset:49440
    v_mfma_f32_16x16x32_bf16 v[28:31], v[240:243], v[140:143], v[28:31]
    ds_read_b64_tr_b16 v[230:231], v5 offset:50464
    s_waitcnt lgkmcnt(4)
    v_mfma_f32_16x16x32_bf16 v[32:35], v[244:247], v[136:139], v[32:35]
    ds_read_b64_tr_b16 v[232:233], v4 offset:49664
    v_mfma_f32_16x16x32_bf16 v[36:39], v[244:247], v[140:143], v[36:39]
    ds_read_b64_tr_b16 v[234:235], v4 offset:50688
    s_mov_b32 s23, 0x5000
    buffer_load_dwordx4 v[120:123], v7, s[8:11], s23 offen offset:0 sc1
    s_waitcnt lgkmcnt(4)
    v_mfma_f32_16x16x32_bf16 v[40:43], v[224:227], v[136:139], v[40:43]
    ds_read_b64_tr_b16 v[236:237], v5 offset:49696
    v_mfma_f32_16x16x32_bf16 v[44:47], v[224:227], v[140:143], v[44:47]
    s_add_u32 s22, s19, 0x488000
    s_add_u32 m0, s20, 0x4400
    s_nop 0
    buffer_load_dwordx4 v3, s[4:7], s22 offen lds
    ds_read_b64_tr_b16 v[238:239], v5 offset:50720
    s_waitcnt lgkmcnt(4)
    v_mfma_f32_16x16x32_bf16 v[48:51], v[228:231], v[136:139], v[48:51]
    ds_read_b64_tr_b16 v[240:241], v4 offset:49920
    v_mfma_f32_16x16x32_bf16 v[52:55], v[228:231], v[140:143], v[52:55]
    ds_read_b64_tr_b16 v[242:243], v4 offset:50944
    s_waitcnt lgkmcnt(4)
    v_mfma_f32_16x16x32_bf16 v[56:59], v[232:235], v[136:139], v[56:59]
    ds_read_b64_tr_b16 v[244:245], v5 offset:49952
    v_mfma_f32_16x16x32_bf16 v[60:63], v[232:235], v[140:143], v[60:63]
    ds_read_b64_tr_b16 v[246:247], v5 offset:50976
    s_waitcnt lgkmcnt(4)
    v_mfma_f32_16x16x32_bf16 v[64:67], v[236:239], v[136:139], v[64:67]
    ds_read_b64_tr_b16 v[224:225], v4 offset:57344
    v_mfma_f32_16x16x32_bf16 v[68:71], v[236:239], v[140:143], v[68:71]
    ds_read_b64_tr_b16 v[226:227], v4 offset:58368
    s_mov_b32 s23, 0xd000
    buffer_load_dwordx4 v[124:127], v7, s[8:11], s23 offen offset:0 sc1
    s_waitcnt lgkmcnt(4)
    v_mfma_f32_16x16x32_bf16 v[72:75], v[240:243], v[136:139], v[72:75]
    ds_read_b64_tr_b16 v[228:229], v5 offset:57376
    v_mfma_f32_16x16x32_bf16 v[76:79], v[240:243], v[140:143], v[76:79]
    ds_read_b64_tr_b16 v[230:231], v5 offset:58400
    s_waitcnt lgkmcnt(4)
    v_mfma_f32_16x16x32_bf16 v[80:83], v[244:247], v[136:139], v[80:83]
    ds_read_b64_tr_b16 v[232:233], v4 offset:57600
    v_mfma_f32_16x16x32_bf16 v[84:87], v[244:247], v[140:143], v[84:87]
    ds_read_b64_tr_b16 v[234:235], v4 offset:58624
    s_waitcnt lgkmcnt(4)
    v_mfma_f32_16x16x32_bf16 v[24:27], v[224:227], v[144:147], v[24:27]
    ds_read_b64_tr_b16 v[236:237], v5 offset:57632
    v_mfma_f32_16x16x32_bf16 v[28:31], v[224:227], v[148:151], v[28:31]
    ds_read_b64_tr_b16 v[238:239], v5 offset:58656
    s_waitcnt lgkmcnt(4)
    v_mfma_f32_16x16x32_bf16 v[32:35], v[228:231], v[144:147], v[32:35]
    ds_read_b64_tr_b16 v[240:241], v4 offset:57856
    v_mfma_f32_16x16x32_bf16 v[36:39], v[228:231], v[148:151], v[36:39]
    ds_read_b64_tr_b16 v[242:243], v4 offset:58880
    s_mov_b32 s23, 0x5000
    buffer_load_dwordx4 v[128:131], v7, s[8:11], s23 offen offset:1024 sc1
    s_waitcnt lgkmcnt(4)
    v_mfma_f32_16x16x32_bf16 v[40:43], v[232:235], v[144:147], v[40:43]
    ds_read_b64_tr_b16 v[244:245], v5 offset:57888
    v_mfma_f32_16x16x32_bf16 v[44:47], v[232:235], v[148:151], v[44:47]
    ds_read_b64_tr_b16 v[246:247], v5 offset:58912
    s_waitcnt lgkmcnt(4)
    v_mfma_f32_16x16x32_bf16 v[48:51], v[236:239], v[144:147], v[48:51]
    ds_read_b64_tr_b16 v[224:225], v4 offset:58112
    v_mfma_f32_16x16x32_bf16 v[52:55], v[236:239], v[148:151], v[52:55]
    ds_read_b64_tr_b16 v[226:227], v4 offset:59136
    s_waitcnt lgkmcnt(4)
    v_mfma_f32_16x16x32_bf16 v[56:59], v[240:243], v[144:147], v[56:59]
    ds_read_b64_tr_b16 v[228:229], v5 offset:58144
    v_mfma_f32_16x16x32_bf16 v[60:63], v[240:243], v[148:151], v[60:63]
    ds_read_b64_tr_b16 v[230:231], v5 offset:59168
    s_waitcnt lgkmcnt(4)
    v_mfma_f32_16x16x32_bf16 v[64:67], v[244:247], v[144:147], v[64:67]
    v_mfma_f32_16x16x32_bf16 v[68:71], v[244:247], v[148:151], v[68:71]
    s_waitcnt vmcnt(9)
    s_barrier
    ds_read_b64_tr_b16 v[232:233], v4 offset:0
    ds_read_b64_tr_b16 v[234:235], v4 offset:1024
    s_mov_b32 s23, 0xd000
    buffer_load_dwordx4 v[132:135], v7, s[8:11], s23 offen offset:1024 sc1
    s_waitcnt lgkmcnt(4)
    v_mfma_f32_16x16x32_bf16 v[72:75], v[224:227], v[144:147], v[72:75]
    ds_read_b64_tr_b16 v[236:237], v5 offset:32
    v_mfma_f32_16x16x32_bf16 v[76:79], v[224:227], v[148:151], v[76:79]
    s_add_u32 s22, s19, 0x500000
    s_add_u32 m0, s20, 0x8000
    s_nop 0
    buffer_load_dwordx4 v3, s[4:7], s22 offen lds
    ds_read_b64_tr_b16 v[238:239], v5 offset:1056
    s_waitcnt lgkmcnt(4)
    v_mfma_f32_16x16x32_bf16 v[80:83], v[228:231], v[144:147], v[80:83]
    ds_read_b64_tr_b16 v[240:241], v4 offset:256
    v_mfma_f32_16x16x32_bf16 v[84:87], v[228:231], v[148:151], v[84:87]
    ds_read_b64_tr_b16 v[242:243], v4 offset:1280
    s_waitcnt lgkmcnt(4)
    v_mfma_f32_16x16x32_bf16 v[24:27], v[232:235], v[88:91], v[24:27]
    ds_read_b64_tr_b16 v[244:245], v5 offset:288
    v_mfma_f32_16x16x32_bf16 v[28:31], v[232:235], v[92:95], v[28:31]
    ds_read_b64_tr_b16 v[246:247], v5 offset:1312
    s_waitcnt lgkmcnt(4)
    v_mfma_f32_16x16x32_bf16 v[32:35], v[236:239], v[88:91], v[32:35]
    ds_read_b64_tr_b16 v[224:225], v4 offset:512
    v_mfma_f32_16x16x32_bf16 v[36:39], v[236:239], v[92:95], v[36:39]
    ds_read_b64_tr_b16 v[226:227], v4 offset:1536
    s_mov_b32 s23, 0x5800
    buffer_load_dwordx4 v[136:139], v7, s[8:11], s23 offen offset:0 sc1
    s_waitcnt lgkmcnt(4)
    v_mfma_f32_16x16x32_bf16 v[40:43], v[240:243], v[88:91], v[40:43]
    ds_read_b64_tr_b16 v[228:229], v5 offset:544
    v_mfma_f32_16x16x32_bf16 v[44:47], v[240:243], v[92:95], v[44:47]
    s_add_u32 s22, s19, 0x508000
    s_add_u32 m0, s20, 0x8400
    s_nop 0
    buffer_load_dwordx4 v3, s[4:7], s22 offen lds
    ds_read_b64_tr_b16 v[230:231], v5 offset:1568
    s_waitcnt lgkmcnt(4)
    v_mfma_f32_16x16x32_bf16 v[48:51], v[244:247], v[88:91], v[48:51]
    ds_read_b64_tr_b16 v[232:233], v4 offset:768
    v_mfma_f32_16x16x32_bf16 v[52:55], v[244:247], v[92:95], v[52:55]
    ds_read_b64_tr_b16 v[234:235], v4 offset:1792
    s_waitcnt lgkmcnt(4)
    v_mfma_f32_16x16x32_bf16 v[56:59], v[224:227], v[88:91], v[56:59]
    ds_read_b64_tr_b16 v[236:237], v5 offset:800
    v_mfma_f32_16x16x32_bf16 v[60:63], v[224:227], v[92:95], v[60:63]
    ds_read_b64_tr_b16 v[238:239], v5 offset:1824
    s_waitcnt lgkmcnt(4)
    v_mfma_f32_16x16x32_bf16 v[64:67], v[228:231], v[88:91], v[64:67]
    ds_read_b64_tr_b16 v[240:241], v4 offset:8192
    v_mfma_f32_16x16x32_bf16 v[68:71], v[228:231], v[92:95], v[68:71]
    ds_read_b64_tr_b16 v[242:243], v4 offset:9216
    s_mov_b32 s23, 0xd800
    buffer_load_dwordx4 v[140:143], v7, s[8:11], s23 offen offset:0 sc1
    s_waitcnt lgkmcnt(4)
    v_mfma_f32_16x16x32_bf16 v[72:75], v[232:235], v[88:91], v[72:75]
    ds_read_b64_tr_b16 v[244:245], v5 offset:8224
    v_mfma_f32_16x16x32_bf16 v[76:79], v[232:235], v[92:95], v[76:79]
    ds_read_b64_tr_b16 v[246:247], v5 offset:9248
    s_waitcnt lgkmcnt(4)
    v_mfma_f32_16x16x32_bf16 v[80:83], v[236:239], v[88:91], v[80:83]
    ds_read_b64_tr_b16 v[224:225], v4 offset:8448
    v_mfma_f32_16x16x32_bf16 v[84:87], v[236:239], v[92:95], v[84:87]
    ds_read_b64_tr_b16 v[226:227], v4 offset:9472
    s_waitcnt lgkmcnt(4)
    v_mfma_f32_16x16x32_bf16 v[24:27], v[240:243], v[96:99], v[24:27]
    ds_read_b64_tr_b16 v[228:229], v5 offset:8480
    v_mfma_f32_16x16x32_bf16 v[28:31], v[240:243], v[100:103], v[28:31]
    ds_read_b64_tr_b16 v[230:231], v5 offset:9504
    s_waitcnt lgkmcnt(4)
    v_mfma_f32_16x16x32_bf16 v[32:35], v[244:247], v[96:99], v[32:35]
    ds_read_b64_tr_b16 v[232:233], v4 offset:8704
    v_mfma_f32_16x16x32_bf16 v[36:39], v[244:247], v[100:103], v[36:39]
    ds_read_b64_tr_b16 v[234:235], v4 offset:9728
    s_mov_b32 s23, 0x5800
    buffer_load_dwordx4 v[144:147], v7, s[8:11], s23 offen offset:1024 sc1
    s_waitcnt lgkmcnt(4)
    v_mfma_f32_16x16x32_bf16 v[40:43], v[224:227], v[96:99], v[40:43]
    ds_read_b64_tr_b16 v[236:237], v5 offset:8736
    v_mfma_f32_16x16x32_bf16 v[44:47], v[224:227], v[100:103], v[44:47]
    ds_read_b64_tr_b16 v[238:239], v5 offset:9760
    s_waitcnt lgkmcnt(4)
    v_mfma_f32_16x16x32_bf16 v[48:51], v[228:231], v[96:99], v[48:51]
    ds_read_b64_tr_b16 v[240:241], v4 offset:8960
    v_mfma_f32_16x16x32_bf16 v[52:55], v[228:231], v[100:103], v[52:55]
    ds_read_b64_tr_b16 v[242:243], v4 offset:9984
    s_waitcnt lgkmcnt(4)
    v_mfma_f32_16x16x32_bf16 v[56:59], v[232:235], v[96:99], v[56:59]
    ds_read_b64_tr_b16 v[244:245], v5 offset:8992
    v_mfma_f32_16x16x32_bf16 v[60:63], v[232:235], v[100:103], v[60:63]
    ds_read_b64_tr_b16 v[246:247], v5 offset:10016
    s_waitcnt lgkmcnt(4)
    v_mfma_f32_16x16x32_bf16 v[64:67], v[236:239], v[96:99], v[64:67]
    v_mfma_f32_16x16x32_bf16 v[68:71], v[236:239], v[100:103], v[68:71]
    s_waitcnt vmcnt(8)
    s_barrier
    ds_read_b64_tr_b16 v[224:225], v4 offset:16384
    ds_read_b64_tr_b16 v[226:227], v4 offset:17408
    s_mov_b32 s23, 0xd800
    buffer_load_dwordx4 v[148:151], v7, s[8:11], s23 offen offset:1024 sc1
    s_waitcnt lgkmcnt(4)
    v_mfma_f32_16x16x32_bf16 v[72:75], v[240:243], v[96:99], v[72:75]
    ds_read_b64_tr_b16 v[228:229], v5 offset:16416
    v_mfma_f32_16x16x32_bf16 v[76:79], v[240:243], v[100:103], v[76:79]
    s_add_u32 s22, s19, 0x580000
    s_add_u32 m0, s20, 0xc000
    s_nop 0
    buffer_load_dwordx4 v3, s[4:7], s22 offen lds
    ds_read_b64_tr_b16 v[230:231], v5 offset:17440
    s_waitcnt lgkmcnt(4)
    v_mfma_f32_16x16x32_bf16 v[80:83], v[244:247], v[96:99], v[80:83]
    ds_read_b64_tr_b16 v[232:233], v4 offset:16640
    v_mfma_f32_16x16x32_bf16 v[84:87], v[244:247], v[100:103], v[84:87]
    ds_read_b64_tr_b16 v[234:235], v4 offset:17664
    s_waitcnt lgkmcnt(4)
    v_mfma_f32_16x16x32_bf16 v[24:27], v[224:227], v[104:107], v[24:27]
    ds_read_b64_tr_b16 v[236:237], v5 offset:16672
    v_mfma_f32_16x16x32_bf16 v[28:31], v[224:227], v[108:111], v[28:31]
    ds_read_b64_tr_b16 v[238:239], v5 offset:17696
    s_waitcnt lgkmcnt(4)
    v_mfma_f32_16x16x32_bf16 v[32:35], v[228:231], v[104:107], v[32:35]
    ds_read_b64_tr_b16 v[240:241], v4 offset:16896
    v_mfma_f32_16x16x32_bf16 v[36:39], v[228:231], v[108:111], v[36:39]
    ds_read_b64_tr_b16 v[242:243], v4 offset:17920
    s_mov_b32 s23, 0x6000
    buffer_load_dwordx4 v[88:91], v7, s[8:11], s23 offen offset:0 sc1
    s_waitcnt lgkmcnt(4)
    v_mfma_f32_16x16x32_bf16 v[40:43], v[232:235], v[104:107], v[40:43]
    ds_read_b64_tr_b16 v[244:245], v5 offset:16928
    v_mfma_f32_16x16x32_bf16 v[44:47], v[232:235], v[108:111], v[44:47]
    s_add_u32 s22, s19, 0x588000
    s_add_u32 m0, s20, 0xc400
    s_nop 0
    buffer_load_dwordx4 v3, s[4:7], s22 offen lds
    ds_read_b64_tr_b16 v[246:247], v5 offset:17952
    s_waitcnt lgkmcnt(4)
    v_mfma_f32_16x16x32_bf16 v[48:51], v[236:239], v[104:107], v[48:51]
    ds_read_b64_tr_b16 v[224:225], v4 offset:17152
    v_mfma_f32_16x16x32_bf16 v[52:55], v[236:239], v[108:111], v[52:55]
    ds_read_b64_tr_b16 v[226:227], v4 offset:18176
    s_waitcnt lgkmcnt(4)
    v_mfma_f32_16x16x32_bf16 v[56:59], v[240:243], v[104:107], v[56:59]
    ds_read_b64_tr_b16 v[228:229], v5 offset:17184
    v_mfma_f32_16x16x32_bf16 v[60:63], v[240:243], v[108:111], v[60:63]
    ds_read_b64_tr_b16 v[230:231], v5 offset:18208
    s_waitcnt lgkmcnt(4)
    v_mfma_f32_16x16x32_bf16 v[64:67], v[244:247], v[104:107], v[64:67]
    ds_read_b64_tr_b16 v[232:233], v4 offset:24576
    v_mfma_f32_16x16x32_bf16 v[68:71], v[244:247], v[108:111], v[68:71]
    ds_read_b64_tr_b16 v[234:235], v4 offset:25600
    s_mov_b32 s23, 0xe000
    buffer_load_dwordx4 v[92:95], v7, s[8:11], s23 offen offset:0 sc1
    s_waitcnt lgkmcnt(4)
    v_mfma_f32_16x16x32_bf16 v[72:75], v[224:227], v[104:107], v[72:75]
    ds_read_b64_tr_b16 v[236:237], v5 offset:24608
    v_xor_b32 v8, s28, v12
    v_xor_b32 v20, s28, v13
    v_or_b32 v8, v8, v20
    v_xor_b32 v20, s28, v14
    v_or_b32 v8, v8, v20
    v_xor_b32 v20, s28, v15
    v_or_b32 v8, v8, v20
    v_cmp_ne_u32 vcc, 0, v8
    s_cbranch_vccnz adaLN_cond__sliding_block_cached__moe_arch_mod__prompt_kernel_kv4r
adaLN_cond__sliding_block_cached__moe_arch_mod__prompt_kernel_kv4b:
    v_mfma_f32_16x16x32_bf16 v[76:79], v[224:227], v[108:111], v[76:79]
    ds_read_b64_tr_b16 v[238:239], v5 offset:25632
    v_mov_b32 v20, 0
    s_mov_b32 s16, 0x564000
    buffer_load_dword v8, v20, s[8:11], s16 offen sc1
    s_waitcnt lgkmcnt(4)
    v_mfma_f32_16x16x32_bf16 v[80:83], v[228:231], v[104:107], v[80:83]
    ds_read_b64_tr_b16 v[240:241], v4 offset:24832
    v_mfma_f32_16x16x32_bf16 v[84:87], v[228:231], v[108:111], v[84:87]
    ds_read_b64_tr_b16 v[242:243], v4 offset:25856
    s_waitcnt lgkmcnt(4)
    v_mfma_f32_16x16x32_bf16 v[24:27], v[232:235], v[112:115], v[24:27]
    ds_read_b64_tr_b16 v[244:245], v5 offset:24864
    v_mfma_f32_16x16x32_bf16 v[28:31], v[232:235], v[116:119], v[28:31]
    ds_read_b64_tr_b16 v[246:247], v5 offset:25888
    s_waitcnt lgkmcnt(4)
    v_mfma_f32_16x16x32_bf16 v[32:35], v[236:239], v[112:115], v[32:35]
    ds_read_b64_tr_b16 v[224:225], v4 offset:25088
    v_mfma_f32_16x16x32_bf16 v[36:39], v[236:239], v[116:119], v[36:39]
    ds_read_b64_tr_b16 v[226:227], v4 offset:26112
    s_mov_b32 s23, 0x6000
    buffer_load_dwordx4 v[96:99], v7, s[8:11], s23 offen offset:1024 sc1
    s_waitcnt lgkmcnt(4)
    v_mfma_f32_16x16x32_bf16 v[40:43], v[240:243], v[112:115], v[40:43]
    ds_read_b64_tr_b16 v[228:229], v5 offset:25120
    v_mfma_f32_16x16x32_bf16 v[44:47], v[240:243], v[116:119], v[44:47]
    ds_read_b64_tr_b16 v[230:231], v5 offset:26144
    s_waitcnt lgkmcnt(4)
    v_mfma_f32_16x16x32_bf16 v[48:51], v[244:247], v[112:115], v[48:51]
    ds_read_b64_tr_b16 v[232:233], v4 offset:25344
    v_mfma_f32_16x16x32_bf16 v[52:55], v[244:247], v[116:119], v[52:55]
    ds_read_b64_tr_b16 v[234:235], v4 offset:26368
    s_waitcnt lgkmcnt(4)
    v_mfma_f32_16x16x32_bf16 v[56:59], v[224:227], v[112:115], v[56:59]
    ds_read_b64_tr_b16 v[236:237], v5 offset:25376
    v_mfma_f32_16x16x32_bf16 v[60:63], v[224:227], v[116:119], v[60:63]
    ds_read_b64_tr_b16 v[238:239], v5 offset:26400
    s_waitcnt lgkmcnt(4)
    v_mfma_f32_16x16x32_bf16 v[64:67], v[228:231], v[112:115], v[64:67]
    v_mfma_f32_16x16x32_bf16 v[68:71], v[228:231], v[116:119], v[68:71]
    s_waitcnt vmcnt(9)
    s_barrier
    ds_read_b64_tr_b16 v[240:241], v4 offset:32768
    ds_read_b64_tr_b16 v[242:243], v4 offset:33792
    s_mov_b32 s23, 0xe000
    buffer_load_dwordx4 v[100:103], v7, s[8:11], s23 offen offset:1024 sc1
    s_waitcnt lgkmcnt(4)
    v_mfma_f32_16x16x32_bf16 v[72:75], v[232:235], v[112:115], v[72:75]
    ds_read_b64_tr_b16 v[244:245], v5 offset:32800
    v_mfma_f32_16x16x32_bf16 v[76:79], v[232:235], v[116:119], v[76:79]
    s_add_u32 s22, s19, 0x600000
    s_add_u32 m0, s20, 0x0
    s_nop 0
    buffer_load_dwordx4 v3, s[4:7], s22 offen lds
    ds_read_b64_tr_b16 v[246:247], v5 offset:33824
    s_waitcnt lgkmcnt(4)
    v_mfma_f32_16x16x32_bf16 v[80:83], v[236:239], v[112:115], v[80:83]
    ds_read_b64_tr_b16 v[224:225], v4 offset:33024
    v_mfma_f32_16x16x32_bf16 v[84:87], v[236:239], v[116:119], v[84:87]
    ds_read_b64_tr_b16 v[226:227], v4 offset:34048
    s_waitcnt lgkmcnt(4)
    v_mfma_f32_16x16x32_bf16 v[24:27], v[240:243], v[120:123], v[24:27]
    ds_read_b64_tr_b16 v[228:229], v5 offset:33056
    v_mfma_f32_16x16x32_bf16 v[28:31], v[240:243], v[124:127], v[28:31]
    ds_read_b64_tr_b16 v[230:231], v5 offset:34080
    s_waitcnt lgkmcnt(4)
    v_mfma_f32_16x16x32_bf16 v[32:35], v[244:247], v[120:123], v[32:35]
    ds_read_b64_tr_b16 v[232:233], v4 offset:33280
    v_mfma_f32_16x16x32_bf16 v[36:39], v[244:247], v[124:127], v[36:39]
    ds_read_b64_tr_b16 v[234:235], v4 offset:34304
    s_mov_b32 s23, 0x6800
    buffer_load_dwordx4 v[104:107], v7, s[8:11], s23 offen offset:0 sc1
    s_waitcnt lgkmcnt(4)
    v_mfma_f32_16x16x32_bf16 v[40:43], v[224:227], v[120:123], v[40:43]
    ds_read_b64_tr_b16 v[236:237], v5 offset:33312
    v_mfma_f32_16x16x32_bf16 v[44:47], v[224:227], v[124:127], v[44:47]
    s_add_u32 s22, s19, 0x608000
    s_add_u32 m0, s20, 0x400
    s_nop 0
    buffer_load_dwordx4 v3, s[4:7], s22 offen lds
    ds_read_b64_tr_b16 v[238:239], v5 offset:34336
    s_waitcnt lgkmcnt(4)
    v_mfma_f32_16x16x32_bf16 v[48:51], v[228:231], v[120:123], v[48:51]
    ds_read_b64_tr_b16 v[240:241], v4 offset:33536
    v_mfma_f32_16x16x32_bf16 v[52:55], v[228:231], v[124:127], v[52:55]
    ds_read_b64_tr_b16 v[242:243], v4 offset:34560
    s_waitcnt lgkmcnt(4)
    v_mfma_f32_16x16x32_bf16 v[56:59], v[232:235], v[120:123], v[56:59]
    ds_read_b64_tr_b16 v[244:245], v5 offset:33568
    v_mfma_f32_16x16x32_bf16 v[60:63], v[232:235], v[124:127], v[60:63]
    ds_read_b64_tr_b16 v[246:247], v5 offset:34592
    s_waitcnt lgkmcnt(4)
    v_mfma_f32_16x16x32_bf16 v[64:67], v[236:239], v[120:123], v[64:67]
    ds_read_b64_tr_b16 v[224:225], v4 offset:40960
    v_mfma_f32_16x16x32_bf16 v[68:71], v[236:239], v[124:127], v[68:71]
    ds_read_b64_tr_b16 v[226:227], v4 offset:41984
    s_mov_b32 s23, 0xe800
    buffer_load_dwordx4 v[108:111], v7, s[8:11], s23 offen offset:0 sc1
    s_waitcnt lgkmcnt(4)
    v_mfma_f32_16x16x32_bf16 v[72:75], v[240:243], v[120:123], v[72:75]
    ds_read_b64_tr_b16 v[228:229], v5 offset:40992
    v_mfma_f32_16x16x32_bf16 v[76:79], v[240:243], v[124:127], v[76:79]
    ds_read_b64_tr_b16 v[230:231], v5 offset:42016
    s_waitcnt lgkmcnt(4)
    v_mfma_f32_16x16x32_bf16 v[80:83], v[244:247], v[120:123], v[80:83]
    ds_read_b64_tr_b16 v[232:233], v4 offset:41216
    v_mfma_f32_16x16x32_bf16 v[84:87], v[244:247], v[124:127], v[84:87]
    ds_read_b64_tr_b16 v[234:235], v4 offset:42240
    s_waitcnt lgkmcnt(4)
    v_mfma_f32_16x16x32_bf16 v[24:27], v[224:227], v[128:131], v[24:27]
    ds_read_b64_tr_b16 v[236:237], v5 offset:41248
    s_add_u32 s22, s21, 0x0
    s_add_u32 m0, s20, 0x10000
    s_nop 0
    buffer_load_dwordx4 v2, s[8:11], s22 offen sc1 lds
    v_mfma_f32_16x16x32_bf16 v[28:31], v[224:227], v[132:135], v[28:31]
    ds_read_b64_tr_b16 v[238:239], v5 offset:42272
    s_waitcnt lgkmcnt(4)
    v_mfma_f32_16x16x32_bf16 v[32:35], v[228:231], v[128:131], v[32:35]
    ds_read_b64_tr_b16 v[240:241], v4 offset:41472
    v_mfma_f32_16x16x32_bf16 v[36:39], v[228:231], v[132:135], v[36:39]
    ds_read_b64_tr_b16 v[242:243], v4 offset:42496
    s_mov_b32 s23, 0x6800
    buffer_load_dwordx4 v[112:115], v7, s[8:11], s23 offen offset:1024 sc1
    s_waitcnt lgkmcnt(4)
    v_mfma_f32_16x16x32_bf16 v[40:43], v[232:235], v[128:131], v[40:43]
    ds_read_b64_tr_b16 v[244:245], v5 offset:41504
    s_add_u32 s22, s21, 0x400
    s_add_u32 m0, s20, 0x10400
    s_nop 0
    buffer_load_dwordx4 v2, s[8:11], s22 offen sc1 lds
    v_mfma_f32_16x16x32_bf16 v[44:47], v[232:235], v[132:135], v[44:47]
    ds_read_b64_tr_b16 v[246:247], v5 offset:42528
    s_waitcnt lgkmcnt(4)
    v_mfma_f32_16x16x32_bf16 v[48:51], v[236:239], v[128:131], v[48:51]
    ds_read_b64_tr_b16 v[224:225], v4 offset:41728
    v_mfma_f32_16x16x32_bf16 v[52:55], v[236:239], v[132:135], v[52:55]
    ds_read_b64_tr_b16 v[226:227], v4 offset:42752
    s_waitcnt lgkmcnt(4)
    v_mfma_f32_16x16x32_bf16 v[56:59], v[240:243], v[128:131], v[56:59]
    ds_read_b64_tr_b16 v[228:229], v5 offset:41760
    v_mfma_f32_16x16x32_bf16 v[60:63], v[240:243], v[132:135], v[60:63]
    ds_read_b64_tr_b16 v[230:231], v5 offset:42784
    s_waitcnt lgkmcnt(4)
    v_mfma_f32_16x16x32_bf16 v[64:67], v[244:247], v[128:131], v[64:67]
    v_mfma_f32_16x16x32_bf16 v[68:71], v[244:247], v[132:135], v[68:71]
    s_waitcnt vmcnt(11)
    s_barrier
    ds_read_b64_tr_b16 v[232:233], v4 offset:49152
    ds_read_b64_tr_b16 v[234:235], v4 offset:50176
    s_mov_b32 s23, 0xe800
    buffer_load_dwordx4 v[116:119], v7, s[8:11], s23 offen offset:1024 sc1
    s_waitcnt lgkmcnt(4)
    v_mfma_f32_16x16x32_bf16 v[72:75], v[224:227], v[128:131], v[72:75]
    ds_read_b64_tr_b16 v[236:237], v5 offset:49184
    v_mfma_f32_16x16x32_bf16 v[76:79], v[224:227], v[132:135], v[76:79]
    s_add_u32 s22, s19, 0x680000
    s_add_u32 m0, s20, 0x4000
    s_nop 0
    buffer_load_dwordx4 v3, s[4:7], s22 offen lds
    ds_read_b64_tr_b16 v[238:239], v5 offset:50208
    s_waitcnt lgkmcnt(4)
    v_mfma_f32_16x16x32_bf16 v[80:83], v[228:231], v[128:131], v[80:83]
    ds_read_b64_tr_b16 v[240:241], v4 offset:49408
    v_mfma_f32_16x16x32_bf16 v[84:87], v[228:231], v[132:135], v[84:87]
    ds_read_b64_tr_b16 v[242:243], v4 offset:50432
    s_waitcnt lgkmcnt(4)
    v_mfma_f32_16x16x32_bf16 v[24:27], v[232:235], v[136:139], v[24:27]
    ds_read_b64_tr_b16 v[244:245], v5 offset:49440
    v_mfma_f32_16x16x32_bf16 v[28:31], v[232:235], v[140:143], v[28:31]
    ds_read_b64_tr_b16 v[246:247], v5 offset:50464
    s_waitcnt lgkmcnt(4)
    v_mfma_f32_16x16x32_bf16 v[32:35], v[236:239], v[136:139], v[32:35]
    ds_read_b64_tr_b16 v[224:225], v4 offset:49664
    v_mfma_f32_16x16x32_bf16 v[36:39], v[236:239], v[140:143], v[36:39]
    ds_read_b64_tr_b16 v[226:227], v4 offset:50688
    s_mov_b32 s23, 0x7000
    buffer_load_dwordx4 v[120:123], v7, s[8:11], s23 offen offset:0 sc1
    s_waitcnt lgkmcnt(4)
    v_mfma_f32_16x16x32_bf16 v[40:43], v[240:243], v[136:139], v[40:43]
    ds_read_b64_tr_b16 v[228:229], v5 offset:49696
    v_mfma_f32_16x16x32_bf16 v[44:47], v[240:243], v[140:143], v[44:47]
    s_add_u32 s22, s19, 0x688000
    s_add_u32 m0, s20, 0x4400
    s_nop 0
    buffer_load_dwordx4 v3, s[4:7], s22 offen lds
    ds_read_b64_tr_b16 v[230:231], v5 offset:50720
    s_waitcnt lgkmcnt(4)
    v_mfma_f32_16x16x32_bf16 v[48:51], v[244:247], v[136:139], v[48:51]
    ds_read_b64_tr_b16 v[232:233], v4 offset:49920
    v_mfma_f32_16x16x32_bf16 v[52:55], v[244:247], v[140:143], v[52:55]
    ds_read_b64_tr_b16 v[234:235], v4 offset:50944
    s_waitcnt lgkmcnt(4)
    v_mfma_f32_16x16x32_bf16 v[56:59], v[224:227], v[136:139], v[56:59]
    ds_read_b64_tr_b16 v[236:237], v5 offset:49952
    v_mfma_f32_16x16x32_bf16 v[60:63], v[224:227], v[140:143], v[60:63]
    ds_read_b64_tr_b16 v[238:239], v5 offset:50976
    s_waitcnt lgkmcnt(4)
    v_mfma_f32_16x16x32_bf16 v[64:67], v[228:231], v[136:139], v[64:67]
    ds_read_b64_tr_b16 v[240:241], v4 offset:57344
    v_mfma_f32_16x16x32_bf16 v[68:71], v[228:231], v[140:143], v[68:71]
    ds_read_b64_tr_b16 v[242:243], v4 offset:58368
    s_mov_b32 s23, 0xf000
    buffer_load_dwordx4 v[124:127], v7, s[8:11], s23 offen offset:0 sc1
    s_waitcnt lgkmcnt(4)
    v_mfma_f32_16x16x32_bf16 v[72:75], v[232:235], v[136:139], v[72:75]
    ds_read_b64_tr_b16 v[244:245], v5 offset:57376
    v_mfma_f32_16x16x32_bf16 v[76:79], v[232:235], v[140:143], v[76:79]
    ds_read_b64_tr_b16 v[246:247], v5 offset:58400
    s_waitcnt lgkmcnt(4)
    v_mfma_f32_16x16x32_bf16 v[80:83], v[236:239], v[136:139], v[80:83]
    ds_read_b64_tr_b16 v[224:225], v4 offset:57600
    v_mfma_f32_16x16x32_bf16 v[84:87], v[236:239], v[140:143], v[84:87]
    ds_read_b64_tr_b16 v[226:227], v4 offset:58624
    s_waitcnt lgkmcnt(4)
    v_mfma_f32_16x16x32_bf16 v[24:27], v[240:243], v[144:147], v[24:27]
    ds_read_b64_tr_b16 v[228:229], v5 offset:57632
    s_add_u32 s22, s21, 0x4000
    s_add_u32 m0, s20, 0x14000
    s_nop 0
    buffer_load_dwordx4 v2, s[8:11], s22 offen sc1 lds
    v_mfma_f32_16x16x32_bf16 v[28:31], v[240:243], v[148:151], v[28:31]
    ds_read_b64_tr_b16 v[230:231], v5 offset:58656
    s_waitcnt lgkmcnt(4)
    v_mfma_f32_16x16x32_bf16 v[32:35], v[244:247], v[144:147], v[32:35]
    ds_read_b64_tr_b16 v[232:233], v4 offset:57856
    v_mfma_f32_16x16x32_bf16 v[36:39], v[244:247], v[148:151], v[36:39]
    ds_read_b64_tr_b16 v[234:235], v4 offset:58880
    s_mov_b32 s23, 0x7000
    buffer_load_dwordx4 v[128:131], v7, s[8:11], s23 offen offset:1024 sc1
    s_waitcnt lgkmcnt(4)
    v_mfma_f32_16x16x32_bf16 v[40:43], v[224:227], v[144:147], v[40:43]
    ds_read_b64_tr_b16 v[236:237], v5 offset:57888
    s_add_u32 s22, s21, 0x4400
    s_add_u32 m0, s20, 0x14400
    s_nop 0
    buffer_load_dwordx4 v2, s[8:11], s22 offen sc1 lds
    v_mfma_f32_16x16x32_bf16 v[44:47], v[224:227], v[148:151], v[44:47]
    ds_read_b64_tr_b16 v[238:239], v5 offset:58912
    s_waitcnt lgkmcnt(4)
    v_mfma_f32_16x16x32_bf16 v[48:51], v[228:231], v[144:147], v[48:51]
    ds_read_b64_tr_b16 v[240:241], v4 offset:58112
    v_mfma_f32_16x16x32_bf16 v[52:55], v[228:231], v[148:151], v[52:55]
    ds_read_b64_tr_b16 v[242:243], v4 offset:59136
    s_waitcnt lgkmcnt(4)
    v_mfma_f32_16x16x32_bf16 v[56:59], v[232:235], v[144:147], v[56:59]
    ds_read_b64_tr_b16 v[244:245], v5 offset:58144
    v_mfma_f32_16x16x32_bf16 v[60:63], v[232:235], v[148:151], v[60:63]
    ds_read_b64_tr_b16 v[246:247], v5 offset:59168
    s_waitcnt lgkmcnt(4)
    v_mfma_f32_16x16x32_bf16 v[64:67], v[236:239], v[144:147], v[64:67]
    v_mfma_f32_16x16x32_bf16 v[68:71], v[236:239], v[148:151], v[68:71]
    s_waitcnt vmcnt(12)
    s_barrier
    ds_read_b64_tr_b16 v[224:225], v4 offset:0
    ds_read_b64_tr_b16 v[226:227], v4 offset:1024
    s_mov_b32 s23, 0xf000
    buffer_load_dwordx4 v[132:135], v7, s[8:11], s23 offen offset:1024 sc1
    s_waitcnt lgkmcnt(4)
    v_mfma_f32_16x16x32_bf16 v[72:75], v[240:243], v[144:147], v[72:75]
    ds_read_b64_tr_b16 v[228:229], v5 offset:32
    v_mfma_f32_16x16x32_bf16 v[76:79], v[240:243], v[148:151], v[76:79]
    s_add_u32 s22, s19, 0x700000
    s_add_u32 m0, s20, 0x8000
    s_nop 0
    buffer_load_dwordx4 v3, s[4:7], s22 offen lds
    ds_read_b64_tr_b16 v[230:231], v5 offset:1056
    s_waitcnt lgkmcnt(4)
    v_mfma_f32_16x16x32_bf16 v[80:83], v[244:247], v[144:147], v[80:83]
    ds_read_b64_tr_b16 v[232:233], v4 offset:256
    v_mfma_f32_16x16x32_bf16 v[84:87], v[244:247], v[148:151], v[84:87]
    ds_read_b64_tr_b16 v[234:235], v4 offset:1280
    s_waitcnt lgkmcnt(4)
    v_mfma_f32_16x16x32_bf16 v[24:27], v[224:227], v[88:91], v[24:27]
    ds_read_b64_tr_b16 v[236:237], v5 offset:288
    v_mfma_f32_16x16x32_bf16 v[28:31], v[224:227], v[92:95], v[28:31]
    ds_read_b64_tr_b16 v[238:239], v5 offset:1312
    s_waitcnt lgkmcnt(4)
    v_mfma_f32_16x16x32_bf16 v[32:35], v[228:231], v[88:91], v[32:35]
    ds_read_b64_tr_b16 v[240:241], v4 offset:512
    v_mfma_f32_16x16x32_bf16 v[36:39], v[228:231], v[92:95], v[36:39]
    ds_read_b64_tr_b16 v[242:243], v4 offset:1536
    s_mov_b32 s23, 0x7800
    buffer_load_dwordx4 v[136:139], v7, s[8:11], s23 offen offset:0 sc1
    s_waitcnt lgkmcnt(4)
    v_mfma_f32_16x16x32_bf16 v[40:43], v[232:235], v[88:91], v[40:43]
    ds_read_b64_tr_b16 v[244:245], v5 offset:544
    v_mfma_f32_16x16x32_bf16 v[44:47], v[232:235], v[92:95], v[44:47]
    s_add_u32 s22, s19, 0x708000
    s_add_u32 m0, s20, 0x8400
    s_nop 0
    buffer_load_dwordx4 v3, s[4:7], s22 offen lds
    ds_read_b64_tr_b16 v[246:247], v5 offset:1568
    s_waitcnt lgkmcnt(4)
    v_mfma_f32_16x16x32_bf16 v[48:51], v[236:239], v[88:91], v[48:51]
    ds_read_b64_tr_b16 v[224:225], v4 offset:768
    v_mfma_f32_16x16x32_bf16 v[52:55], v[236:239], v[92:95], v[52:55]
    ds_read_b64_tr_b16 v[226:227], v4 offset:1792
    s_waitcnt lgkmcnt(4)
    v_mfma_f32_16x16x32_bf16 v[56:59], v[240:243], v[88:91], v[56:59]
    ds_read_b64_tr_b16 v[228:229], v5 offset:800
    v_mfma_f32_16x16x32_bf16 v[60:63], v[240:243], v[92:95], v[60:63]
    ds_read_b64_tr_b16 v[230:231], v5 offset:1824
    s_waitcnt lgkmcnt(4)
    v_mfma_f32_16x16x32_bf16 v[64:67], v[244:247], v[88:91], v[64:67]
    ds_read_b64_tr_b16 v[232:233], v4 offset:8192
    v_mfma_f32_16x16x32_bf16 v[68:71], v[244:247], v[92:95], v[68:71]
    ds_read_b64_tr_b16 v[234:235], v4 offset:9216
    s_mov_b32 s23, 0xf800
    buffer_load_dwordx4 v[140:143], v7, s[8:11], s23 offen offset:0 sc1
    s_waitcnt lgkmcnt(4)
    v_mfma_f32_16x16x32_bf16 v[72:75], v[224:227], v[88:91], v[72:75]
    ds_read_b64_tr_b16 v[236:237], v5 offset:8224
    v_mfma_f32_16x16x32_bf16 v[76:79], v[224:227], v[92:95], v[76:79]
    ds_read_b64_tr_b16 v[238:239], v5 offset:9248
    s_waitcnt lgkmcnt(4)
    v_mfma_f32_16x16x32_bf16 v[80:83], v[228:231], v[88:91], v[80:83]
    ds_read_b64_tr_b16 v[240:241], v4 offset:8448
    v_mfma_f32_16x16x32_bf16 v[84:87], v[228:231], v[92:95], v[84:87]
    ds_read_b64_tr_b16 v[242:243], v4 offset:9472
    s_waitcnt lgkmcnt(4)
    v_mfma_f32_16x16x32_bf16 v[24:27], v[232:235], v[96:99], v[24:27]
    ds_read_b64_tr_b16 v[244:245], v5 offset:8480
    s_add_u32 s22, s21, 0x8000
    s_add_u32 m0, s20, 0x18000
    s_nop 0
    buffer_load_dwordx4 v2, s[8:11], s22 offen sc1 lds
    v_mfma_f32_16x16x32_bf16 v[28:31], v[232:235], v[100:103], v[28:31]
    ds_read_b64_tr_b16 v[246:247], v5 offset:9504
    s_waitcnt lgkmcnt(4)
    v_mfma_f32_16x16x32_bf16 v[32:35], v[236:239], v[96:99], v[32:35]
    ds_read_b64_tr_b16 v[224:225], v4 offset:8704
    v_mfma_f32_16x16x32_bf16 v[36:39], v[236:239], v[100:103], v[36:39]
    ds_read_b64_tr_b16 v[226:227], v4 offset:9728
    s_mov_b32 s23, 0x7800
    buffer_load_dwordx4 v[144:147], v7, s[8:11], s23 offen offset:1024 sc1
    s_waitcnt lgkmcnt(4)
    v_mfma_f32_16x16x32_bf16 v[40:43], v[240:243], v[96:99], v[40:43]
    ds_read_b64_tr_b16 v[228:229], v5 offset:8736
    s_add_u32 s22, s21, 0x8400
    s_add_u32 m0, s20, 0x18400
    s_nop 0
    buffer_load_dwordx4 v2, s[8:11], s22 offen sc1 lds
    v_mfma_f32_16x16x32_bf16 v[44:47], v[240:243], v[100:103], v[44:47]
    ds_read_b64_tr_b16 v[230:231], v5 offset:9760
    s_waitcnt lgkmcnt(4)
    v_mfma_f32_16x16x32_bf16 v[48:51], v[244:247], v[96:99], v[48:51]
    ds_read_b64_tr_b16 v[232:233], v4 offset:8960
    v_mfma_f32_16x16x32_bf16 v[52:55], v[244:247], v[100:103], v[52:55]
    ds_read_b64_tr_b16 v[234:235], v4 offset:9984
    s_waitcnt lgkmcnt(4)
    v_mfma_f32_16x16x32_bf16 v[56:59], v[224:227], v[96:99], v[56:59]
    ds_read_b64_tr_b16 v[236:237], v5 offset:8992
    v_mfma_f32_16x16x32_bf16 v[60:63], v[224:227], v[100:103], v[60:63]
    ds_read_b64_tr_b16 v[238:239], v5 offset:10016
    s_waitcnt lgkmcnt(4)
    v_mfma_f32_16x16x32_bf16 v[64:67], v[228:231], v[96:99], v[64:67]
    v_mfma_f32_16x16x32_bf16 v[68:71], v[228:231], v[100:103], v[68:71]
    s_waitcnt vmcnt(12)
    s_barrier
    ds_read_b64_tr_b16 v[240:241], v4 offset:16384
    ds_read_b64_tr_b16 v[242:243], v4 offset:17408
    s_mov_b32 s23, 0xf800
    buffer_load_dwordx4 v[148:151], v7, s[8:11], s23 offen offset:1024 sc1
    s_waitcnt lgkmcnt(4)
    v_mfma_f32_16x16x32_bf16 v[72:75], v[232:235], v[96:99], v[72:75]
    ds_read_b64_tr_b16 v[244:245], v5 offset:16416
    v_mfma_f32_16x16x32_bf16 v[76:79], v[232:235], v[100:103], v[76:79]
    s_add_u32 s22, s19, 0x780000
    s_add_u32 m0, s20, 0xc000
    s_nop 0
    buffer_load_dwordx4 v3, s[4:7], s22 offen lds
    ds_read_b64_tr_b16 v[246:247], v5 offset:17440
    s_waitcnt lgkmcnt(4)
    v_mfma_f32_16x16x32_bf16 v[80:83], v[236:239], v[96:99], v[80:83]
    ds_read_b64_tr_b16 v[224:225], v4 offset:16640
    v_mfma_f32_16x16x32_bf16 v[84:87], v[236:239], v[100:103], v[84:87]
    ds_read_b64_tr_b16 v[226:227], v4 offset:17664
    s_waitcnt lgkmcnt(4)
    v_mfma_f32_16x16x32_bf16 v[24:27], v[240:243], v[104:107], v[24:27]
    ds_read_b64_tr_b16 v[228:229], v5 offset:16672
    v_mfma_f32_16x16x32_bf16 v[28:31], v[240:243], v[108:111], v[28:31]
    ds_read_b64_tr_b16 v[230:231], v5 offset:17696
    s_waitcnt lgkmcnt(4)
    v_mfma_f32_16x16x32_bf16 v[32:35], v[244:247], v[104:107], v[32:35]
    ds_read_b64_tr_b16 v[232:233], v4 offset:16896
    v_mfma_f32_16x16x32_bf16 v[36:39], v[244:247], v[108:111], v[36:39]
    ds_read_b64_tr_b16 v[234:235], v4 offset:17920
    s_waitcnt lgkmcnt(4)
    v_mfma_f32_16x16x32_bf16 v[40:43], v[224:227], v[104:107], v[40:43]
    ds_read_b64_tr_b16 v[236:237], v5 offset:16928
    v_mfma_f32_16x16x32_bf16 v[44:47], v[224:227], v[108:111], v[44:47]
    s_add_u32 s22, s19, 0x788000
    s_add_u32 m0, s20, 0xc400
    s_nop 0
    buffer_load_dwordx4 v3, s[4:7], s22 offen lds
    ds_read_b64_tr_b16 v[238:239], v5 offset:17952
    s_waitcnt lgkmcnt(4)
    v_mfma_f32_16x16x32_bf16 v[48:51], v[228:231], v[104:107], v[48:51]
    ds_read_b64_tr_b16 v[240:241], v4 offset:17152
    v_mfma_f32_16x16x32_bf16 v[52:55], v[228:231], v[108:111], v[52:55]
    ds_read_b64_tr_b16 v[242:243], v4 offset:18176
    s_waitcnt lgkmcnt(4)
    v_mfma_f32_16x16x32_bf16 v[56:59], v[232:235], v[104:107], v[56:59]
    ds_read_b64_tr_b16 v[244:245], v5 offset:17184
    v_mfma_f32_16x16x32_bf16 v[60:63], v[232:235], v[108:111], v[60:63]
    ds_read_b64_tr_b16 v[246:247], v5 offset:18208
    s_waitcnt lgkmcnt(4)
    v_mfma_f32_16x16x32_bf16 v[64:67], v[236:239], v[104:107], v[64:67]
    ds_read_b64_tr_b16 v[224:225], v4 offset:24576
    v_mfma_f32_16x16x32_bf16 v[68:71], v[236:239], v[108:111], v[68:71]
    ds_read_b64_tr_b16 v[226:227], v4 offset:25600
    s_waitcnt lgkmcnt(4)
    v_mfma_f32_16x16x32_bf16 v[72:75], v[240:243], v[104:107], v[72:75]
    ds_read_b64_tr_b16 v[228:229], v5 offset:24608
    v_mfma_f32_16x16x32_bf16 v[76:79], v[240:243], v[108:111], v[76:79]
    ds_read_b64_tr_b16 v[230:231], v5 offset:25632
    s_waitcnt lgkmcnt(4)
    v_mfma_f32_16x16x32_bf16 v[80:83], v[244:247], v[104:107], v[80:83]
    ds_read_b64_tr_b16 v[232:233], v4 offset:24832
    v_mfma_f32_16x16x32_bf16 v[84:87], v[244:247], v[108:111], v[84:87]
    ds_read_b64_tr_b16 v[234:235], v4 offset:25856
    s_waitcnt lgkmcnt(4)
    v_mfma_f32_16x16x32_bf16 v[24:27], v[224:227], v[112:115], v[24:27]
    ds_read_b64_tr_b16 v[236:237], v5 offset:24864
    s_add_u32 s22, s21, 0xc000
    s_add_u32 m0, s20, 0x1c000
    s_nop 0
    buffer_load_dwordx4 v2, s[8:11], s22 offen sc1 lds
    v_mfma_f32_16x16x32_bf16 v[28:31], v[224:227], v[116:119], v[28:31]
    ds_read_b64_tr_b16 v[238:239], v5 offset:25888
    s_waitcnt lgkmcnt(4)
    v_mfma_f32_16x16x32_bf16 v[32:35], v[228:231], v[112:115], v[32:35]
    ds_read_b64_tr_b16 v[240:241], v4 offset:25088
    v_mfma_f32_16x16x32_bf16 v[36:39], v[228:231], v[116:119], v[36:39]
    ds_read_b64_tr_b16 v[242:243], v4 offset:26112
    s_waitcnt lgkmcnt(4)
    v_mfma_f32_16x16x32_bf16 v[40:43], v[232:235], v[112:115], v[40:43]
    ds_read_b64_tr_b16 v[244:245], v5 offset:25120
    s_add_u32 s22, s21, 0xc400
    s_add_u32 m0, s20, 0x1c400
    s_nop 0
    buffer_load_dwordx4 v2, s[8:11], s22 offen sc1 lds
    v_mfma_f32_16x16x32_bf16 v[44:47], v[232:235], v[116:119], v[44:47]
    ds_read_b64_tr_b16 v[246:247], v5 offset:26144
    s_waitcnt lgkmcnt(4)
    v_mfma_f32_16x16x32_bf16 v[48:51], v[236:239], v[112:115], v[48:51]
    ds_read_b64_tr_b16 v[224:225], v4 offset:25344
    v_mfma_f32_16x16x32_bf16 v[52:55], v[236:239], v[116:119], v[52:55]
    ds_read_b64_tr_b16 v[226:227], v4 offset:26368
    s_waitcnt lgkmcnt(4)
    v_mfma_f32_16x16x32_bf16 v[56:59], v[240:243], v[112:115], v[56:59]
    ds_read_b64_tr_b16 v[228:229], v5 offset:25376
    v_mfma_f32_16x16x32_bf16 v[60:63], v[240:243], v[116:119], v[60:63]
    ds_read_b64_tr_b16 v[230:231], v5 offset:26400
    s_waitcnt lgkmcnt(4)
    v_mfma_f32_16x16x32_bf16 v[64:67], v[244:247], v[112:115], v[64:67]
    v_mfma_f32_16x16x32_bf16 v[68:71], v[244:247], v[116:119], v[68:71]
    s_waitcnt vmcnt(9)
    s_barrier
    ds_read_b64_tr_b16 v[232:233], v4 offset:32768
    ds_read_b64_tr_b16 v[234:235], v4 offset:33792
    s_waitcnt lgkmcnt(4)
    v_mfma_f32_16x16x32_bf16 v[72:75], v[224:227], v[112:115], v[72:75]
    ds_read_b64_tr_b16 v[236:237], v5 offset:32800
    v_mfma_f32_16x16x32_bf16 v[76:79], v[224:227], v[116:119], v[76:79]
    ds_read_b64_tr_b16 v[238:239], v5 offset:33824
    s_waitcnt lgkmcnt(4)
    v_mfma_f32_16x16x32_bf16 v[80:83], v[228:231], v[112:115], v[80:83]
    ds_read_b64_tr_b16 v[240:241], v4 offset:33024
    v_mfma_f32_16x16x32_bf16 v[84:87], v[228:231], v[116:119], v[84:87]
    ds_read_b64_tr_b16 v[242:243], v4 offset:34048
    s_waitcnt lgkmcnt(4)
    v_mfma_f32_16x16x32_bf16 v[24:27], v[232:235], v[120:123], v[24:27]
    ds_read_b64_tr_b16 v[244:245], v5 offset:33056
    v_mfma_f32_16x16x32_bf16 v[28:31], v[232:235], v[124:127], v[28:31]
    ds_read_b64_tr_b16 v[246:247], v5 offset:34080
    s_waitcnt lgkmcnt(4)
    v_mfma_f32_16x16x32_bf16 v[32:35], v[236:239], v[120:123], v[32:35]
    ds_read_b64_tr_b16 v[224:225], v4 offset:33280
    v_mfma_f32_16x16x32_bf16 v[36:39], v[236:239], v[124:127], v[36:39]
    ds_read_b64_tr_b16 v[226:227], v4 offset:34304
    s_waitcnt lgkmcnt(4)
    v_mfma_f32_16x16x32_bf16 v[40:43], v[240:243], v[120:123], v[40:43]
    ds_read_b64_tr_b16 v[228:229], v5 offset:33312
    v_mfma_f32_16x16x32_bf16 v[44:47], v[240:243], v[124:127], v[44:47]
    ds_read_b64_tr_b16 v[230:231], v5 offset:34336
    s_waitcnt lgkmcnt(4)
    v_mfma_f32_16x16x32_bf16 v[48:51], v[244:247], v[120:123], v[48:51]
    ds_read_b64_tr_b16 v[232:233], v4 offset:33536
    v_mfma_f32_16x16x32_bf16 v[52:55], v[244:247], v[124:127], v[52:55]
    ds_read_b64_tr_b16 v[234:235], v4 offset:34560
    s_waitcnt lgkmcnt(4)
    v_mfma_f32_16x16x32_bf16 v[56:59], v[224:227], v[120:123], v[56:59]
    ds_read_b64_tr_b16 v[236:237], v5 offset:33568
    v_mfma_f32_16x16x32_bf16 v[60:63], v[224:227], v[124:127], v[60:63]
    ds_read_b64_tr_b16 v[238:239], v5 offset:34592
    s_waitcnt lgkmcnt(4)
    v_mfma_f32_16x16x32_bf16 v[64:67], v[228:231], v[120:123], v[64:67]
    ds_read_b64_tr_b16 v[240:241], v4 offset:40960
    v_mfma_f32_16x16x32_bf16 v[68:71], v[228:231], v[124:127], v[68:71]
    ds_read_b64_tr_b16 v[242:243], v4 offset:41984
    s_waitcnt lgkmcnt(4)
    v_mfma_f32_16x16x32_bf16 v[72:75], v[232:235], v[120:123], v[72:75]
    ds_read_b64_tr_b16 v[244:245], v5 offset:40992
    v_mfma_f32_16x16x32_bf16 v[76:79], v[232:235], v[124:127], v[76:79]
    ds_read_b64_tr_b16 v[246:247], v5 offset:42016
    s_waitcnt lgkmcnt(4)
    v_mfma_f32_16x16x32_bf16 v[80:83], v[236:239], v[120:123], v[80:83]
    ds_read_b64_tr_b16 v[224:225], v4 offset:41216
    v_mfma_f32_16x16x32_bf16 v[84:87], v[236:239], v[124:127], v[84:87]
    ds_read_b64_tr_b16 v[226:227], v4 offset:42240
    s_waitcnt lgkmcnt(4)
    v_mfma_f32_16x16x32_bf16 v[24:27], v[240:243], v[128:131], v[24:27]
    ds_read_b64_tr_b16 v[228:229], v5 offset:41248
    v_mfma_f32_16x16x32_bf16 v[28:31], v[240:243], v[132:135], v[28:31]
    ds_read_b64_tr_b16 v[230:231], v5 offset:42272
    s_waitcnt lgkmcnt(4)
    v_mfma_f32_16x16x32_bf16 v[32:35], v[244:247], v[128:131], v[32:35]
    ds_read_b64_tr_b16 v[232:233], v4 offset:41472
    v_mfma_f32_16x16x32_bf16 v[36:39], v[244:247], v[132:135], v[36:39]
    ds_read_b64_tr_b16 v[234:235], v4 offset:42496
    s_waitcnt lgkmcnt(4)
    v_mfma_f32_16x16x32_bf16 v[40:43], v[224:227], v[128:131], v[40:43]
    ds_read_b64_tr_b16 v[236:237], v5 offset:41504
    v_mfma_f32_16x16x32_bf16 v[44:47], v[224:227], v[132:135], v[44:47]
    ds_read_b64_tr_b16 v[238:239], v5 offset:42528
    s_waitcnt lgkmcnt(4)
    v_mfma_f32_16x16x32_bf16 v[48:51], v[228:231], v[128:131], v[48:51]
    ds_read_b64_tr_b16 v[240:241], v4 offset:41728
    v_mfma_f32_16x16x32_bf16 v[52:55], v[228:231], v[132:135], v[52:55]
    ds_read_b64_tr_b16 v[242:243], v4 offset:42752
    s_waitcnt lgkmcnt(4)
    v_mfma_f32_16x16x32_bf16 v[56:59], v[232:235], v[128:131], v[56:59]
    ds_read_b64_tr_b16 v[244:245], v5 offset:41760
    v_mfma_f32_16x16x32_bf16 v[60:63], v[232:235], v[132:135], v[60:63]
    ds_read_b64_tr_b16 v[246:247], v5 offset:42784
    s_waitcnt lgkmcnt(4)
    v_mfma_f32_16x16x32_bf16 v[64:67], v[236:239], v[128:131], v[64:67]
    v_mfma_f32_16x16x32_bf16 v[68:71], v[236:239], v[132:135], v[68:71]
    s_waitcnt vmcnt(2)
    s_barrier
    ds_read_b64_tr_b16 v[224:225], v4 offset:49152
    ds_read_b64_tr_b16 v[226:227], v4 offset:50176
    s_waitcnt lgkmcnt(4)
    v_mfma_f32_16x16x32_bf16 v[72:75], v[240:243], v[128:131], v[72:75]
    ds_read_b64_tr_b16 v[228:229], v5 offset:49184
    v_mfma_f32_16x16x32_bf16 v[76:79], v[240:243], v[132:135], v[76:79]
    ds_read_b64_tr_b16 v[230:231], v5 offset:50208
    s_waitcnt lgkmcnt(4)
    v_mfma_f32_16x16x32_bf16 v[80:83], v[244:247], v[128:131], v[80:83]
    ds_read_b64_tr_b16 v[232:233], v4 offset:49408
    v_mfma_f32_16x16x32_bf16 v[84:87], v[244:247], v[132:135], v[84:87]
    ds_read_b64_tr_b16 v[234:235], v4 offset:50432
    s_waitcnt lgkmcnt(4)
    v_mfma_f32_16x16x32_bf16 v[24:27], v[224:227], v[136:139], v[24:27]
    ds_read_b64_tr_b16 v[236:237], v5 offset:49440
    v_mfma_f32_16x16x32_bf16 v[28:31], v[224:227], v[140:143], v[28:31]
    ds_read_b64_tr_b16 v[238:239], v5 offset:50464
    s_waitcnt lgkmcnt(4)
    v_mfma_f32_16x16x32_bf16 v[32:35], v[228:231], v[136:139], v[32:35]
    ds_read_b64_tr_b16 v[240:241], v4 offset:49664
    v_mfma_f32_16x16x32_bf16 v[36:39], v[228:231], v[140:143], v[36:39]
    ds_read_b64_tr_b16 v[242:243], v4 offset:50688
    s_waitcnt lgkmcnt(4)
    v_mfma_f32_16x16x32_bf16 v[40:43], v[232:235], v[136:139], v[40:43]
    ds_read_b64_tr_b16 v[244:245], v5 offset:49696
    v_mfma_f32_16x16x32_bf16 v[44:47], v[232:235], v[140:143], v[44:47]
    ds_read_b64_tr_b16 v[246:247], v5 offset:50720
    s_waitcnt lgkmcnt(4)
    v_mfma_f32_16x16x32_bf16 v[48:51], v[236:239], v[136:139], v[48:51]
    ds_read_b64_tr_b16 v[224:225], v4 offset:49920
    v_mfma_f32_16x16x32_bf16 v[52:55], v[236:239], v[140:143], v[52:55]
    ds_read_b64_tr_b16 v[226:227], v4 offset:50944
    s_waitcnt lgkmcnt(4)
    v_mfma_f32_16x16x32_bf16 v[56:59], v[240:243], v[136:139], v[56:59]
    ds_read_b64_tr_b16 v[228:229], v5 offset:49952
    v_mfma_f32_16x16x32_bf16 v[60:63], v[240:243], v[140:143], v[60:63]
    ds_read_b64_tr_b16 v[230:231], v5 offset:50976
    s_waitcnt lgkmcnt(4)
    v_mfma_f32_16x16x32_bf16 v[64:67], v[244:247], v[136:139], v[64:67]
    ds_read_b64_tr_b16 v[232:233], v4 offset:57344
    v_mfma_f32_16x16x32_bf16 v[68:71], v[244:247], v[140:143], v[68:71]
    ds_read_b64_tr_b16 v[234:235], v4 offset:58368
    s_waitcnt lgkmcnt(4)
    v_mfma_f32_16x16x32_bf16 v[72:75], v[224:227], v[136:139], v[72:75]
    ds_read_b64_tr_b16 v[236:237], v5 offset:57376
    v_mfma_f32_16x16x32_bf16 v[76:79], v[224:227], v[140:143], v[76:79]
    ds_read_b64_tr_b16 v[238:239], v5 offset:58400
    s_waitcnt lgkmcnt(4)
    v_mfma_f32_16x16x32_bf16 v[80:83], v[228:231], v[136:139], v[80:83]
    ds_read_b64_tr_b16 v[240:241], v4 offset:57600
    v_mfma_f32_16x16x32_bf16 v[84:87], v[228:231], v[140:143], v[84:87]
    ds_read_b64_tr_b16 v[242:243], v4 offset:58624
    s_waitcnt lgkmcnt(4)
    v_mfma_f32_16x16x32_bf16 v[24:27], v[232:235], v[144:147], v[24:27]
    ds_read_b64_tr_b16 v[244:245], v5 offset:57632
    v_mfma_f32_16x16x32_bf16 v[28:31], v[232:235], v[148:151], v[28:31]
    ds_read_b64_tr_b16 v[246:247], v5 offset:58656
    s_waitcnt lgkmcnt(4)
    v_mfma_f32_16x16x32_bf16 v[32:35], v[236:239], v[144:147], v[32:35]
    ds_read_b64_tr_b16 v[224:225], v4 offset:57856
    v_mfma_f32_16x16x32_bf16 v[36:39], v[236:239], v[148:151], v[36:39]
    ds_read_b64_tr_b16 v[226:227], v4 offset:58880
    s_waitcnt lgkmcnt(4)
    v_mfma_f32_16x16x32_bf16 v[40:43], v[240:243], v[144:147], v[40:43]
    ds_read_b64_tr_b16 v[228:229], v5 offset:57888
    v_mfma_f32_16x16x32_bf16 v[44:47], v[240:243], v[148:151], v[44:47]
    ds_read_b64_tr_b16 v[230:231], v5 offset:58912
    s_waitcnt lgkmcnt(4)
    v_mfma_f32_16x16x32_bf16 v[48:51], v[244:247], v[144:147], v[48:51]
    ds_read_b64_tr_b16 v[232:233], v4 offset:58112
    v_mfma_f32_16x16x32_bf16 v[52:55], v[244:247], v[148:151], v[52:55]
    ds_read_b64_tr_b16 v[234:235], v4 offset:59136
    s_waitcnt lgkmcnt(4)
    v_mfma_f32_16x16x32_bf16 v[56:59], v[224:227], v[144:147], v[56:59]
    ds_read_b64_tr_b16 v[236:237], v5 offset:58144
    v_mfma_f32_16x16x32_bf16 v[60:63], v[224:227], v[148:151], v[60:63]
    ds_read_b64_tr_b16 v[238:239], v5 offset:59168
    s_waitcnt lgkmcnt(4)
    v_mfma_f32_16x16x32_bf16 v[64:67], v[228:231], v[144:147], v[64:67]
    v_mfma_f32_16x16x32_bf16 v[68:71], v[228:231], v[148:151], v[68:71]
    s_waitcnt lgkmcnt(2)
    v_mfma_f32_16x16x32_bf16 v[72:75], v[232:235], v[144:147], v[72:75]
    v_mfma_f32_16x16x32_bf16 v[76:79], v[232:235], v[148:151], v[76:79]
    s_waitcnt lgkmcnt(0)
    v_mfma_f32_16x16x32_bf16 v[80:83], v[236:239], v[144:147], v[80:83]
    v_mfma_f32_16x16x32_bf16 v[84:87], v[236:239], v[148:151], v[84:87]
    s_mov_b32 s23, 0x3e0293ee
    v_mul_f32 v24, s23, v24
    v_mul_f32 v25, s23, v25
    v_mul_f32 v26, s23, v26
    v_mul_f32 v27, s23, v27
    v_mul_f32 v28, s23, v28
    v_mul_f32 v29, s23, v29
    v_mul_f32 v30, s23, v30
    v_mul_f32 v31, s23, v31
    v_mul_f32 v32, s23, v32
    v_mul_f32 v33, s23, v33
    v_mul_f32 v34, s23, v34
    v_mul_f32 v35, s23, v35
    v_mul_f32 v36, s23, v36
    v_mul_f32 v37, s23, v37
    v_mul_f32 v38, s23, v38
    v_mul_f32 v39, s23, v39
    v_cvt_pk_bf16_f32 v152, v24, v25
    v_cvt_pk_bf16_f32 v153, v26, v27
    v_cvt_pk_bf16_f32 v168, v28, v29
    v_cvt_pk_bf16_f32 v169, v30, v31
    v_cvt_pk_bf16_f32 v154, v32, v33
    v_cvt_pk_bf16_f32 v155, v34, v35
    v_cvt_pk_bf16_f32 v170, v36, v37
    v_cvt_pk_bf16_f32 v171, v38, v39
    v_add_u32 v4, 0x10000, v2
    v_add_u32 v5, 0x20000, v2
    s_barrier
    ds_read_b128 v[224:227], v4 offset:0
    ds_read_b128 v[228:231], v4 offset:1024
    ds_read_b128 v[232:235], v4 offset:2048
    ds_read_b128 v[236:239], v4 offset:3072
    v_mov_b32 v12, 0x3f803f80
    v_mov_b32 v13, 0x3f803f80
    v_mov_b32 v14, 0x3f803f80
    v_mov_b32 v15, 0x3f803f80
    s_waitcnt lgkmcnt(3)
    v_mfma_f32_16x16x32_bf16 v[184:187], v[224:227], v[152:155], 0
    v_mul_f32 v40, s23, v40
    v_mul_f32 v41, s23, v41
    v_mul_f32 v42, s23, v42
    v_mul_f32 v43, s23, v43
    v_mul_f32 v44, s23, v44
    v_mul_f32 v45, s23, v45
    v_mfma_f32_16x16x32_bf16 v[188:191], v[224:227], v[168:171], 0
    ds_read_b128 v[240:243], v4 offset:4096
    v_mul_f32 v46, s23, v46
    v_mul_f32 v47, s23, v47
    v_mul_f32 v48, s23, v48
    v_mul_f32 v49, s23, v49
    v_mul_f32 v50, s23, v50
    v_mul_f32 v51, s23, v51
    s_and_b32 s29, s2, 7
    s_mul_i32 s29, s29, 28
    s_lshr_b32 s16, s2, 3
    s_add_u32 s29, s29, s16
    s_waitcnt lgkmcnt(3)
    v_mfma_f32_16x16x32_bf16 v[192:195], v[228:231], v[152:155], 0
    s_add_u32 s22, s21, 0x10000
    s_add_u32 m0, s20, 0x20000
    s_nop 0
    buffer_load_dwordx4 v2, s[8:11], s22 offen sc1 lds
    v_mul_f32 v52, s23, v52
    v_mul_f32 v53, s23, v53
    v_mul_f32 v54, s23, v54
    v_mul_f32 v55, s23, v55
    v_cvt_pk_bf16_f32 v156, v40, v41
    v_cvt_pk_bf16_f32 v157, v42, v43
    s_mov_b64 s[76:77], s[54:55]
    s_mov_b32 s78, 0xc00000
    s_mov_b32 s79, 0x20000
    v_bfe_u32 v20, v1, 2, 2
    v_lshlrev_b32 v20, 12, v20
    v_add_u32 v6, v3, v20
    s_lshr_b32 s16, s2, 5
    s_lshl_b32 s16, s16, 7
    s_lshl_b32 s17, s3, 3
    s_add_u32 s16, s16, s17
    s_mul_i32 s14, s16, 12288
    s_and_b32 s16, s2, 31
    s_lshl_b32 s16, s16, 8
    s_add_u32 s14, s14, s16
    s_add_u32 s14, s14, 4096
    v_mfma_f32_16x16x32_bf16 v[196:199], v[228:231], v[168:171], 0
    ds_read_b128 v[244:247], v4 offset:5120
    v_cvt_pk_bf16_f32 v172, v44, v45
    v_cvt_pk_bf16_f32 v173, v46, v47
    v_cvt_pk_bf16_f32 v158, v48, v49
    v_cvt_pk_bf16_f32 v159, v50, v51
    v_cvt_pk_bf16_f32 v174, v52, v53
    v_cvt_pk_bf16_f32 v175, v54, v55
    s_waitcnt lgkmcnt(3)
    v_mfma_f32_16x16x32_bf16 v[184:187], v[232:235], v[156:159], v[184:187]
    v_mul_f32 v56, s23, v56
    v_mul_f32 v57, s23, v57
    v_mul_f32 v58, s23, v58
    v_mul_f32 v59, s23, v59
    v_mul_f32 v60, s23, v60
    v_mul_f32 v61, s23, v61
    v_mfma_f32_16x16x32_bf16 v[188:191], v[232:235], v[172:175], v[188:191]
    ds_read_b128 v[224:227], v4 offset:6144
    v_mul_f32 v62, s23, v62
    v_mul_f32 v63, s23, v63
    v_mul_f32 v64, s23, v64
    v_mul_f32 v65, s23, v65
    v_mul_f32 v66, s23, v66
    v_mul_f32 v67, s23, v67
    s_waitcnt lgkmcnt(3)
    v_mfma_f32_16x16x32_bf16 v[192:195], v[236:239], v[156:159], v[192:195]
    v_mul_f32 v68, s23, v68
    v_mul_f32 v69, s23, v69
    v_mul_f32 v70, s23, v70
    v_mul_f32 v71, s23, v71
    v_cvt_pk_bf16_f32 v160, v56, v57
    v_cvt_pk_bf16_f32 v161, v58, v59
    v_mfma_f32_16x16x32_bf16 v[196:199], v[236:239], v[172:175], v[196:199]
    ds_read_b128 v[228:231], v4 offset:7168
    v_cvt_pk_bf16_f32 v176, v60, v61
    v_cvt_pk_bf16_f32 v177, v62, v63
    v_cvt_pk_bf16_f32 v162, v64, v65
    v_cvt_pk_bf16_f32 v163, v66, v67
    v_cvt_pk_bf16_f32 v178, v68, v69
    v_cvt_pk_bf16_f32 v179, v70, v71
    s_waitcnt lgkmcnt(3)
    v_mfma_f32_16x16x32_bf16 v[184:187], v[240:243], v[160:163], v[184:187]
    v_mul_f32 v72, s23, v72
    v_mul_f32 v73, s23, v73
    v_mul_f32 v74, s23, v74
    v_mul_f32 v75, s23, v75
    v_mul_f32 v76, s23, v76
    v_mul_f32 v77, s23, v77
    v_mfma_f32_16x16x32_bf16 v[188:191], v[240:243], v[176:179], v[188:191]
    ds_read_b128 v[232:235], v4 offset:8192
    v_mul_f32 v78, s23, v78
    v_mul_f32 v79, s23, v79
    v_mul_f32 v80, s23, v80
    v_mul_f32 v81, s23, v81
    v_mul_f32 v82, s23, v82
    v_mul_f32 v83, s23, v83
    s_waitcnt lgkmcnt(3)
    v_mfma_f32_16x16x32_bf16 v[192:195], v[244:247], v[160:163], v[192:195]
    s_add_u32 s22, s21, 0x10400
    s_add_u32 m0, s20, 0x20400
    s_nop 0
    buffer_load_dwordx4 v2, s[8:11], s22 offen sc1 lds
    v_mul_f32 v84, s23, v84
    v_mul_f32 v85, s23, v85
    v_mul_f32 v86, s23, v86
    v_mul_f32 v87, s23, v87
    v_cvt_pk_bf16_f32 v164, v72, v73
    v_cvt_pk_bf16_f32 v165, v74, v75
    v_mfma_f32_16x16x32_bf16 v[196:199], v[244:247], v[176:179], v[196:199]
    ds_read_b128 v[236:239], v4 offset:9216
    v_cvt_pk_bf16_f32 v180, v76, v77
    v_cvt_pk_bf16_f32 v181, v78, v79
    v_cvt_pk_bf16_f32 v166, v80, v81
    v_cvt_pk_bf16_f32 v167, v82, v83
    v_cvt_pk_bf16_f32 v182, v84, v85
    v_cvt_pk_bf16_f32 v183, v86, v87
    s_waitcnt lgkmcnt(3)
    v_mfma_f32_16x16x32_bf16 v[184:187], v[224:227], v[164:167], v[184:187]
    v_mfma_f32_16x16x32_bf16 v[188:191], v[224:227], v[180:183], v[188:191]
    ds_read_b128 v[240:243], v4 offset:10240
    s_waitcnt lgkmcnt(3)
    v_mfma_f32_16x16x32_bf16 v[192:195], v[228:231], v[164:167], v[192:195]
    v_mfma_f32_16x16x32_bf16 v[196:199], v[228:231], v[180:183], v[196:199]
    ds_read_b128 v[244:247], v4 offset:11264
    s_waitcnt lgkmcnt(3)
    v_mfma_f32_16x16x32_bf16 v[200:203], v[232:235], v[152:155], 0
    v_mfma_f32_16x16x32_bf16 v[204:207], v[232:235], v[168:171], 0
    ds_read_b128 v[224:227], v4 offset:12288
    s_waitcnt lgkmcnt(3)
    v_mfma_f32_16x16x32_bf16 v[208:211], v[236:239], v[152:155], 0
    v_mfma_f32_16x16x32_bf16 v[212:215], v[236:239], v[168:171], 0
    ds_read_b128 v[228:231], v4 offset:13312
    s_waitcnt lgkmcnt(3)
    v_mfma_f32_16x16x32_bf16 v[200:203], v[240:243], v[156:159], v[200:203]
    v_mfma_f32_16x16x32_bf16 v[204:207], v[240:243], v[172:175], v[204:207]
    ds_read_b128 v[232:235], v4 offset:14336
    s_waitcnt lgkmcnt(3)
    v_mfma_f32_16x16x32_bf16 v[208:211], v[244:247], v[156:159], v[208:211]
    v_max3_f32 v16, v184, v185, v186
    v_mfma_f32_16x16x32_bf16 v[212:215], v[244:247], v[172:175], v[212:215]
    ds_read_b128 v[236:239], v4 offset:15360
    v_max3_f32 v16, v16, v187, v192
    s_waitcnt lgkmcnt(3)
    v_mfma_f32_16x16x32_bf16 v[200:203], v[224:227], v[160:163], v[200:203]
    v_max3_f32 v16, v16, v193, v194
    v_mfma_f32_16x16x32_bf16 v[204:207], v[224:227], v[176:179], v[204:207]
    s_barrier
    ds_read_b128 v[240:243], v4 offset:16384
    v_max_f32 v16, v16, v195
    s_waitcnt lgkmcnt(3)
    v_mfma_f32_16x16x32_bf16 v[208:211], v[228:231], v[160:163], v[208:211]
    v_max3_f32 v17, v188, v189, v190
    v_mfma_f32_16x16x32_bf16 v[212:215], v[228:231], v[176:179], v[212:215]
    s_add_u32 s22, s21, 0x14000
    s_add_u32 m0, s20, 0x24000
    s_nop 0
    buffer_load_dwordx4 v2, s[8:11], s22 offen sc1 lds
    ds_read_b128 v[244:247], v4 offset:17408
    v_max3_f32 v17, v17, v191, v196
    s_waitcnt lgkmcnt(3)
    v_mfma_f32_16x16x32_bf16 v[200:203], v[232:235], v[164:167], v[200:203]
    v_max3_f32 v17, v17, v197, v198
    v_mfma_f32_16x16x32_bf16 v[204:207], v[232:235], v[180:183], v[204:207]
    ds_read_b128 v[224:227], v4 offset:18432
    v_max_f32 v17, v17, v199
    s_waitcnt lgkmcnt(3)
    v_mfma_f32_16x16x32_bf16 v[208:211], v[236:239], v[164:167], v[208:211]
    v_mfma_f32_16x16x32_bf16 v[212:215], v[236:239], v[180:183], v[212:215]
    ds_read_b128 v[228:231], v4 offset:19456
    v_max3_f32 v16, v16, v200, v201
    v_max3_f32 v16, v16, v202, v203
    s_nop 3
    v_max3_f32 v16, v16, v208, v209
    v_max3_f32 v16, v16, v210, v211
    v_max3_f32 v17, v17, v204, v205
    v_max3_f32 v17, v17, v206, v207
    v_max3_f32 v17, v17, v212, v213
    v_max3_f32 v17, v17, v214, v215
    v_mov_b32 v18, v16
    v_mov_b32 v19, v17
    s_nop 0
    v_permlane16_swap_b32 v16, v18
    v_permlane16_swap_b32 v17, v19
    v_max_f32 v16, v16, v18
    v_max_f32 v17, v17, v19
    v_mov_b32 v18, v16
    v_mov_b32 v19, v17
    s_nop 0
    v_permlane32_swap_b32 v16, v18
    v_permlane32_swap_b32 v17, v19
    v_max_f32 v16, v16, v18
    v_max_f32 v17, v17, v19
    v_sub_f32 v216, 0, v16
    v_sub_f32 v217, 0, v16
    v_sub_f32 v218, 0, v16
    v_sub_f32 v219, 0, v16
    v_sub_f32 v220, 0, v17
    v_sub_f32 v221, 0, v17
    v_sub_f32 v222, 0, v17
    v_sub_f32 v223, 0, v17
    v_add_f32 v184, v184, v216
    v_add_f32 v185, v185, v216
    v_exp_f32 v184, v184
    v_exp_f32 v185, v185
    v_add_f32 v186, v186, v216
    v_add_f32 v187, v187, v216
    v_exp_f32 v186, v186
    v_exp_f32 v187, v187
    v_cvt_pk_bf16_f32 v24, v184, v185
    v_add_f32 v188, v188, v220
    v_add_f32 v189, v189, v220
    v_exp_f32 v188, v188
    v_exp_f32 v189, v189
    v_cvt_pk_bf16_f32 v25, v186, v187
    v_add_f32 v190, v190, v220
    v_add_f32 v191, v191, v220
    v_exp_f32 v190, v190
    v_exp_f32 v191, v191
    v_cvt_pk_bf16_f32 v28, v188, v189
    v_add_f32 v192, v192, v216
    v_add_f32 v193, v193, v216
    v_exp_f32 v192, v192
    v_exp_f32 v193, v193
    v_cvt_pk_bf16_f32 v29, v190, v191
    v_add_f32 v194, v194, v216
    v_add_f32 v195, v195, v216
    v_exp_f32 v194, v194
    v_exp_f32 v195, v195
    v_cvt_pk_bf16_f32 v26, v192, v193
    v_add_f32 v196, v196, v220
    v_add_f32 v197, v197, v220
    v_exp_f32 v196, v196
    v_exp_f32 v197, v197
    v_cvt_pk_bf16_f32 v27, v194, v195
    v_add_f32 v198, v198, v220
    v_add_f32 v199, v199, v220
    v_exp_f32 v198, v198
    v_exp_f32 v199, v199
    v_cvt_pk_bf16_f32 v30, v196, v197
    v_cvt_pk_bf16_f32 v31, v198, v199
    s_waitcnt lgkmcnt(3)
    v_mfma_f32_16x16x32_bf16 v[184:187], v[240:243], v[152:155], v[216:219]
    v_mfma_f32_16x16x32_bf16 v[188:191], v[240:243], v[168:171], v[220:223]
    ds_read_b128 v[232:235], v4 offset:20480
    v_add_f32 v200, v200, v216
    v_add_f32 v201, v201, v216
    v_exp_f32 v200, v200
    v_mfma_f32_16x16x32_bf16 v[248:251], v[12:15], v[24:27], 0
    s_waitcnt lgkmcnt(3)
    v_mfma_f32_16x16x32_bf16 v[192:195], v[244:247], v[152:155], v[216:219]
    v_exp_f32 v201, v201
    v_add_f32 v202, v202, v216
    v_add_f32 v203, v203, v216
    v_mfma_f32_16x16x32_bf16 v[196:199], v[244:247], v[168:171], v[220:223]
    s_add_u32 s22, s21, 0x14400
    s_add_u32 m0, s20, 0x24400
    s_nop 0
    buffer_load_dwordx4 v2, s[8:11], s22 offen sc1 lds
    ds_read_b128 v[236:239], v4 offset:21504
    v_exp_f32 v202, v202
    v_exp_f32 v203, v203
    v_mfma_f32_16x16x32_bf16 v[252:255], v[12:15], v[28:31], 0
    s_waitcnt lgkmcnt(3)
    v_mfma_f32_16x16x32_bf16 v[184:187], v[224:227], v[156:159], v[184:187]
    v_cvt_pk_bf16_f32 v32, v200, v201
    v_add_f32 v204, v204, v220
    v_add_f32 v205, v205, v220
    v_mfma_f32_16x16x32_bf16 v[188:191], v[224:227], v[172:175], v[188:191]
    ds_read_b128 v[240:243], v4 offset:22528
    v_exp_f32 v204, v204
    v_exp_f32 v205, v205
    v_cvt_pk_bf16_f32 v33, v202, v203
    s_mov_b64 s[4:5], s[40:41]
    s_mov_b32 s6, 0x800000
    s_mov_b32 s7, 0x20000
    v_bfe_u32 v20, v1, 2, 2
    v_lshlrev_b32 v21, 13, v20
    v_sub_u32 v3, v3, v21
    v_lshl_add_u32 v3, v20, 11, v3
    s_and_b32 s16, s2, 1
    s_lshl_b32 s24, s16, 22
    s_lshr_b32 s16, s2, 5
    s_lshl_b32 s16, s16, 8
    s_add_u32 s24, s24, s16
    s_lshl_b32 s16, s3, 14
    s_add_u32 s24, s24, s16
    s_waitcnt lgkmcnt(3)
    v_mfma_f32_16x16x32_bf16 v[192:195], v[228:231], v[156:159], v[192:195]
    v_add_f32 v206, v206, v220
    v_add_f32 v207, v207, v220
    v_mfma_f32_16x16x32_bf16 v[196:199], v[228:231], v[172:175], v[196:199]
    ds_read_b128 v[244:247], v4 offset:23552
    v_exp_f32 v206, v206
    v_exp_f32 v207, v207
    v_cvt_pk_bf16_f32 v36, v204, v205
    s_waitcnt lgkmcnt(3)
    v_mfma_f32_16x16x32_bf16 v[184:187], v[232:235], v[160:163], v[184:187]
    v_add_f32 v208, v208, v216
    v_add_f32 v209, v209, v216
    v_exp_f32 v208, v208
    v_mfma_f32_16x16x32_bf16 v[188:191], v[232:235], v[176:179], v[188:191]
    ds_read_b128 v[224:227], v4 offset:24576
    v_exp_f32 v209, v209
    v_cvt_pk_bf16_f32 v37, v206, v207
    s_waitcnt lgkmcnt(3)
    v_mfma_f32_16x16x32_bf16 v[192:195], v[236:239], v[160:163], v[192:195]
    v_add_f32 v210, v210, v216
    v_add_f32 v211, v211, v216
    v_exp_f32 v210, v210
    v_mfma_f32_16x16x32_bf16 v[196:199], v[236:239], v[176:179], v[196:199]
    ds_read_b128 v[228:231], v4 offset:25600
    v_exp_f32 v211, v211
    v_cvt_pk_bf16_f32 v34, v208, v209
    v_add_f32 v212, v212, v220
    s_waitcnt lgkmcnt(3)
    v_mfma_f32_16x16x32_bf16 v[184:187], v[240:243], v[164:167], v[184:187]
    v_add_f32 v213, v213, v220
    v_exp_f32 v212, v212
    v_mfma_f32_16x16x32_bf16 v[188:191], v[240:243], v[180:183], v[188:191]
    ds_read_b128 v[232:235], v4 offset:26624
    v_exp_f32 v213, v213
    v_cvt_pk_bf16_f32 v35, v210, v211
    v_add_f32 v214, v214, v220
    s_waitcnt lgkmcnt(3)
    v_mfma_f32_16x16x32_bf16 v[192:195], v[244:247], v[164:167], v[192:195]
    v_add_f32 v215, v215, v220
    v_exp_f32 v214, v214
    v_exp_f32 v215, v215
    v_mfma_f32_16x16x32_bf16 v[196:199], v[244:247], v[180:183], v[196:199]
    ds_read_b128 v[236:239], v4 offset:27648
    v_cvt_pk_bf16_f32 v38, v212, v213
    v_cvt_pk_bf16_f32 v39, v214, v215
    s_waitcnt lgkmcnt(3)
    v_mfma_f32_16x16x32_bf16 v[200:203], v[224:227], v[152:155], v[216:219]
    v_mfma_f32_16x16x32_bf16 v[204:207], v[224:227], v[168:171], v[220:223]
    ds_read_b128 v[240:243], v4 offset:28672
    v_exp_f32 v184, v184
    v_exp_f32 v185, v185
    v_mfma_f32_16x16x32_bf16 v[248:251], v[12:15], v[32:35], v[248:251]
    s_waitcnt lgkmcnt(3)
    v_mfma_f32_16x16x32_bf16 v[208:211], v[228:231], v[152:155], v[216:219]
    v_exp_f32 v186, v186
    v_exp_f32 v187, v187
    v_mfma_f32_16x16x32_bf16 v[212:215], v[228:231], v[168:171], v[220:223]
    ds_read_b128 v[244:247], v4 offset:29696
    v_cvt_pk_bf16_f32 v40, v184, v185
    v_mfma_f32_16x16x32_bf16 v[252:255], v[12:15], v[36:39], v[252:255]
    s_waitcnt lgkmcnt(3)
    v_mfma_f32_16x16x32_bf16 v[200:203], v[232:235], v[156:159], v[200:203]
    v_exp_f32 v188, v188
    v_exp_f32 v189, v189
    v_mfma_f32_16x16x32_bf16 v[204:207], v[232:235], v[172:175], v[204:207]
    ds_read_b128 v[224:227], v4 offset:30720
    v_cvt_pk_bf16_f32 v41, v186, v187
    s_waitcnt lgkmcnt(3)
    v_mfma_f32_16x16x32_bf16 v[208:211], v[236:239], v[156:159], v[208:211]
    v_exp_f32 v190, v190
    v_exp_f32 v191, v191
    v_mfma_f32_16x16x32_bf16 v[212:215], v[236:239], v[172:175], v[212:215]
    ds_read_b128 v[228:231], v4 offset:31744
    v_cvt_pk_bf16_f32 v44, v188, v189
    v_exp_f32 v192, v192
    s_waitcnt lgkmcnt(3)
    v_mfma_f32_16x16x32_bf16 v[200:203], v[240:243], v[160:163], v[200:203]
    v_exp_f32 v193, v193
    v_mfma_f32_16x16x32_bf16 v[204:207], v[240:243], v[176:179], v[204:207]
    s_barrier
    ds_read_b128 v[232:235], v4 offset:32768
    v_cvt_pk_bf16_f32 v45, v190, v191
    v_exp_f32 v194, v194
    s_waitcnt lgkmcnt(3)
    v_mfma_f32_16x16x32_bf16 v[208:211], v[244:247], v[160:163], v[208:211]
    v_exp_f32 v195, v195
    v_mfma_f32_16x16x32_bf16 v[212:215], v[244:247], v[176:179], v[212:215]
    s_add_u32 s22, s21, 0x18000
    s_add_u32 m0, s20, 0x10000
    s_nop 0
    buffer_load_dwordx4 v2, s[8:11], s22 offen sc1 lds
    ds_read_b128 v[236:239], v4 offset:33792
    v_cvt_pk_bf16_f32 v42, v192, v193
    v_exp_f32 v196, v196
    s_waitcnt lgkmcnt(3)
    v_mfma_f32_16x16x32_bf16 v[200:203], v[224:227], v[164:167], v[200:203]
    v_exp_f32 v197, v197
    v_cvt_pk_bf16_f32 v43, v194, v195
    v_mfma_f32_16x16x32_bf16 v[204:207], v[224:227], v[180:183], v[204:207]
    ds_read_b128 v[240:243], v4 offset:34816
    v_exp_f32 v198, v198
    s_waitcnt lgkmcnt(3)
    v_mfma_f32_16x16x32_bf16 v[208:211], v[228:231], v[164:167], v[208:211]
    v_exp_f32 v199, v199
    v_cvt_pk_bf16_f32 v46, v196, v197
    v_mfma_f32_16x16x32_bf16 v[212:215], v[228:231], v[180:183], v[212:215]
    ds_read_b128 v[244:247], v4 offset:35840
    v_cvt_pk_bf16_f32 v47, v198, v199
    s_waitcnt lgkmcnt(3)
    v_mfma_f32_16x16x32_bf16 v[184:187], v[232:235], v[152:155], v[216:219]
    v_mfma_f32_16x16x32_bf16 v[188:191], v[232:235], v[168:171], v[220:223]
    ds_read_b128 v[224:227], v4 offset:36864
    v_exp_f32 v200, v200
    v_exp_f32 v201, v201
    v_mfma_f32_16x16x32_bf16 v[248:251], v[12:15], v[40:43], v[248:251]
    s_waitcnt lgkmcnt(3)
    v_mfma_f32_16x16x32_bf16 v[192:195], v[236:239], v[152:155], v[216:219]
    v_exp_f32 v202, v202
    v_exp_f32 v203, v203
    v_mfma_f32_16x16x32_bf16 v[196:199], v[236:239], v[168:171], v[220:223]
    s_add_u32 s22, s21, 0x18400
    s_add_u32 m0, s20, 0x10400
    s_nop 0
    buffer_load_dwordx4 v2, s[8:11], s22 offen sc1 lds
    ds_read_b128 v[228:231], v4 offset:37888
    v_cvt_pk_bf16_f32 v48, v200, v201
    v_mfma_f32_16x16x32_bf16 v[252:255], v[12:15], v[44:47], v[252:255]
    s_waitcnt lgkmcnt(3)
    v_mfma_f32_16x16x32_bf16 v[184:187], v[240:243], v[156:159], v[184:187]
    v_exp_f32 v204, v204
    v_exp_f32 v205, v205
    v_mfma_f32_16x16x32_bf16 v[188:191], v[240:243], v[172:175], v[188:191]
    ds_read_b128 v[232:235], v4 offset:38912
    v_cvt_pk_bf16_f32 v49, v202, v203
    s_waitcnt lgkmcnt(3)
    v_mfma_f32_16x16x32_bf16 v[192:195], v[244:247], v[156:159], v[192:195]
    v_exp_f32 v206, v206
    v_exp_f32 v207, v207
    v_mfma_f32_16x16x32_bf16 v[196:199], v[244:247], v[172:175], v[196:199]
    ds_read_b128 v[236:239], v4 offset:39936
    v_cvt_pk_bf16_f32 v52, v204, v205
    v_exp_f32 v208, v208
    s_waitcnt lgkmcnt(3)
    v_mfma_f32_16x16x32_bf16 v[184:187], v[224:227], v[160:163], v[184:187]
    v_exp_f32 v209, v209
    v_mfma_f32_16x16x32_bf16 v[188:191], v[224:227], v[176:179], v[188:191]
    ds_read_b128 v[240:243], v4 offset:40960
    v_cvt_pk_bf16_f32 v53, v206, v207
    v_exp_f32 v210, v210
    s_waitcnt lgkmcnt(3)
    v_mfma_f32_16x16x32_bf16 v[192:195], v[228:231], v[160:163], v[192:195]
    v_exp_f32 v211, v211
    v_mfma_f32_16x16x32_bf16 v[196:199], v[228:231], v[176:179], v[196:199]
    ds_read_b128 v[244:247], v4 offset:41984
    v_cvt_pk_bf16_f32 v50, v208, v209
    v_exp_f32 v212, v212
    s_waitcnt lgkmcnt(3)
    v_mfma_f32_16x16x32_bf16 v[184:187], v[232:235], v[164:167], v[184:187]
    v_exp_f32 v213, v213
    v_cvt_pk_bf16_f32 v51, v210, v211
    v_mfma_f32_16x16x32_bf16 v[188:191], v[232:235], v[180:183], v[188:191]
    ds_read_b128 v[224:227], v4 offset:43008
    v_exp_f32 v214, v214
    s_waitcnt lgkmcnt(3)
    v_mfma_f32_16x16x32_bf16 v[192:195], v[236:239], v[164:167], v[192:195]
    v_exp_f32 v215, v215
    v_cvt_pk_bf16_f32 v54, v212, v213
    v_mfma_f32_16x16x32_bf16 v[196:199], v[236:239], v[180:183], v[196:199]
    ds_read_b128 v[228:231], v4 offset:44032
    v_cvt_pk_bf16_f32 v55, v214, v215
    s_waitcnt lgkmcnt(3)
    v_mfma_f32_16x16x32_bf16 v[200:203], v[240:243], v[152:155], v[216:219]
    v_mfma_f32_16x16x32_bf16 v[204:207], v[240:243], v[168:171], v[220:223]
    ds_read_b128 v[232:235], v4 offset:45056
    v_exp_f32 v184, v184
    v_exp_f32 v185, v185
    v_mfma_f32_16x16x32_bf16 v[248:251], v[12:15], v[48:51], v[248:251]
    s_waitcnt lgkmcnt(3)
    v_mfma_f32_16x16x32_bf16 v[208:211], v[244:247], v[152:155], v[216:219]
    v_exp_f32 v186, v186
    v_exp_f32 v187, v187
    v_mfma_f32_16x16x32_bf16 v[212:215], v[244:247], v[168:171], v[220:223]
    ds_read_b128 v[236:239], v4 offset:46080
    v_cvt_pk_bf16_f32 v56, v184, v185
    v_mfma_f32_16x16x32_bf16 v[252:255], v[12:15], v[52:55], v[252:255]
    s_waitcnt lgkmcnt(3)
    v_mfma_f32_16x16x32_bf16 v[200:203], v[224:227], v[156:159], v[200:203]
    v_exp_f32 v188, v188
    v_exp_f32 v189, v189
    v_mfma_f32_16x16x32_bf16 v[204:207], v[224:227], v[172:175], v[204:207]
    ds_read_b128 v[240:243], v4 offset:47104
    v_cvt_pk_bf16_f32 v57, v186, v187
    s_waitcnt lgkmcnt(3)
    v_mfma_f32_16x16x32_bf16 v[208:211], v[228:231], v[156:159], v[208:211]
    v_exp_f32 v190, v190
    v_exp_f32 v191, v191
    v_mfma_f32_16x16x32_bf16 v[212:215], v[228:231], v[172:175], v[212:215]
    ds_read_b128 v[244:247], v4 offset:48128
    v_cvt_pk_bf16_f32 v60, v188, v189
    v_exp_f32 v192, v192
    s_waitcnt lgkmcnt(3)
    v_mfma_f32_16x16x32_bf16 v[200:203], v[232:235], v[160:163], v[200:203]
    v_exp_f32 v193, v193
    v_mfma_f32_16x16x32_bf16 v[204:207], v[232:235], v[176:179], v[204:207]
    s_waitcnt vmcnt(6)
    s_barrier
    ds_read_b128 v[224:227], v4 offset:49152
    v_cvt_pk_bf16_f32 v61, v190, v191
    v_exp_f32 v194, v194
    s_waitcnt lgkmcnt(3)
    v_mfma_f32_16x16x32_bf16 v[208:211], v[236:239], v[160:163], v[208:211]
    v_exp_f32 v195, v195
    v_mfma_f32_16x16x32_bf16 v[212:215], v[236:239], v[176:179], v[212:215]
    s_add_u32 s22, s21, 0x1c000
    s_add_u32 m0, s20, 0x14000
    s_nop 0
    buffer_load_dwordx4 v2, s[8:11], s22 offen sc1 lds
    ds_read_b128 v[228:231], v4 offset:50176
    v_cvt_pk_bf16_f32 v58, v192, v193
    v_exp_f32 v196, v196
    s_waitcnt lgkmcnt(3)
    v_mfma_f32_16x16x32_bf16 v[200:203], v[240:243], v[164:167], v[200:203]
    v_exp_f32 v197, v197
    v_cvt_pk_bf16_f32 v59, v194, v195
    v_mfma_f32_16x16x32_bf16 v[204:207], v[240:243], v[180:183], v[204:207]
    ds_read_b128 v[232:235], v4 offset:51200
    v_exp_f32 v198, v198
    s_waitcnt lgkmcnt(3)
    v_mfma_f32_16x16x32_bf16 v[208:211], v[244:247], v[164:167], v[208:211]
    v_exp_f32 v199, v199
    v_cvt_pk_bf16_f32 v62, v196, v197
    v_mfma_f32_16x16x32_bf16 v[212:215], v[244:247], v[180:183], v[212:215]
    ds_read_b128 v[236:239], v4 offset:52224
    v_cvt_pk_bf16_f32 v63, v198, v199
    s_waitcnt lgkmcnt(3)
    v_mfma_f32_16x16x32_bf16 v[184:187], v[224:227], v[152:155], v[216:219]
    v_mfma_f32_16x16x32_bf16 v[188:191], v[224:227], v[168:171], v[220:223]
    ds_read_b128 v[240:243], v4 offset:53248
    v_exp_f32 v200, v200
    v_exp_f32 v201, v201
    v_mfma_f32_16x16x32_bf16 v[248:251], v[12:15], v[56:59], v[248:251]
    s_waitcnt lgkmcnt(3)
    v_mfma_f32_16x16x32_bf16 v[192:195], v[228:231], v[152:155], v[216:219]
    v_exp_f32 v202, v202
    v_exp_f32 v203, v203
    v_mfma_f32_16x16x32_bf16 v[196:199], v[228:231], v[168:171], v[220:223]
    s_add_u32 s22, s21, 0x1c400
    s_add_u32 m0, s20, 0x14400
    s_nop 0
    buffer_load_dwordx4 v2, s[8:11], s22 offen sc1 lds
    ds_read_b128 v[244:247], v4 offset:54272
    v_cvt_pk_bf16_f32 v64, v200, v201
    v_mfma_f32_16x16x32_bf16 v[252:255], v[12:15], v[60:63], v[252:255]
    s_waitcnt lgkmcnt(3)
    v_mfma_f32_16x16x32_bf16 v[184:187], v[232:235], v[156:159], v[184:187]
    v_exp_f32 v204, v204
    v_exp_f32 v205, v205
    v_mfma_f32_16x16x32_bf16 v[188:191], v[232:235], v[172:175], v[188:191]
    ds_read_b128 v[224:227], v4 offset:55296
    v_cvt_pk_bf16_f32 v65, v202, v203
    s_waitcnt lgkmcnt(3)
    v_mfma_f32_16x16x32_bf16 v[192:195], v[236:239], v[156:159], v[192:195]
    v_exp_f32 v206, v206
    v_exp_f32 v207, v207
    v_mfma_f32_16x16x32_bf16 v[196:199], v[236:239], v[172:175], v[196:199]
    ds_read_b128 v[228:231], v4 offset:56320
    v_cvt_pk_bf16_f32 v68, v204, v205
    v_exp_f32 v208, v208
    s_waitcnt lgkmcnt(3)
    v_mfma_f32_16x16x32_bf16 v[184:187], v[240:243], v[160:163], v[184:187]
    v_exp_f32 v209, v209
    v_mfma_f32_16x16x32_bf16 v[188:191], v[240:243], v[176:179], v[188:191]
    ds_read_b128 v[232:235], v4 offset:57344
    v_cvt_pk_bf16_f32 v69, v206, v207
    v_exp_f32 v210, v210
    s_waitcnt lgkmcnt(3)
    v_mfma_f32_16x16x32_bf16 v[192:195], v[244:247], v[160:163], v[192:195]
    v_exp_f32 v211, v211
    v_mfma_f32_16x16x32_bf16 v[196:199], v[244:247], v[176:179], v[196:199]
    ds_read_b128 v[236:239], v4 offset:58368
    v_cvt_pk_bf16_f32 v66, v208, v209
    v_exp_f32 v212, v212
    s_waitcnt lgkmcnt(3)
    v_mfma_f32_16x16x32_bf16 v[184:187], v[224:227], v[164:167], v[184:187]
    v_exp_f32 v213, v213
    v_cvt_pk_bf16_f32 v67, v210, v211
    v_mfma_f32_16x16x32_bf16 v[188:191], v[224:227], v[180:183], v[188:191]
    ds_read_b128 v[240:243], v4 offset:59392
    v_exp_f32 v214, v214
    s_waitcnt lgkmcnt(3)
    v_mfma_f32_16x16x32_bf16 v[192:195], v[228:231], v[164:167], v[192:195]
    v_exp_f32 v215, v215
    v_cvt_pk_bf16_f32 v70, v212, v213
    v_mfma_f32_16x16x32_bf16 v[196:199], v[228:231], v[180:183], v[196:199]
    ds_read_b128 v[244:247], v4 offset:60416
    v_cvt_pk_bf16_f32 v71, v214, v215
    s_waitcnt lgkmcnt(3)
    v_mfma_f32_16x16x32_bf16 v[200:203], v[232:235], v[152:155], v[216:219]
    v_mfma_f32_16x16x32_bf16 v[204:207], v[232:235], v[168:171], v[220:223]
    ds_read_b128 v[224:227], v4 offset:61440
    v_exp_f32 v184, v184
    v_exp_f32 v185, v185
    v_mfma_f32_16x16x32_bf16 v[248:251], v[12:15], v[64:67], v[248:251]
    s_waitcnt lgkmcnt(3)
    v_mfma_f32_16x16x32_bf16 v[208:211], v[236:239], v[152:155], v[216:219]
    v_exp_f32 v186, v186
    v_exp_f32 v187, v187
    v_mfma_f32_16x16x32_bf16 v[212:215], v[236:239], v[168:171], v[220:223]
    ds_read_b128 v[228:231], v4 offset:62464
    v_cvt_pk_bf16_f32 v72, v184, v185
    v_mfma_f32_16x16x32_bf16 v[252:255], v[12:15], v[68:71], v[252:255]
    s_waitcnt lgkmcnt(3)
    v_mfma_f32_16x16x32_bf16 v[200:203], v[240:243], v[156:159], v[200:203]
    v_exp_f32 v188, v188
    v_exp_f32 v189, v189
    v_mfma_f32_16x16x32_bf16 v[204:207], v[240:243], v[172:175], v[204:207]
    ds_read_b128 v[232:235], v4 offset:63488
    v_cvt_pk_bf16_f32 v73, v186, v187
    s_waitcnt lgkmcnt(3)
    v_mfma_f32_16x16x32_bf16 v[208:211], v[244:247], v[156:159], v[208:211]
    v_exp_f32 v190, v190
    v_exp_f32 v191, v191
    v_mfma_f32_16x16x32_bf16 v[212:215], v[244:247], v[172:175], v[212:215]
    ds_read_b128 v[236:239], v4 offset:64512
    v_cvt_pk_bf16_f32 v76, v188, v189
    v_exp_f32 v192, v192
    s_waitcnt lgkmcnt(3)
    v_mfma_f32_16x16x32_bf16 v[200:203], v[224:227], v[160:163], v[200:203]
    v_exp_f32 v193, v193
    v_mfma_f32_16x16x32_bf16 v[204:207], v[224:227], v[176:179], v[204:207]
    s_waitcnt vmcnt(6)
    s_barrier
    ds_read_b128 v[240:243], v5 offset:0
    v_cvt_pk_bf16_f32 v77, v190, v191
    v_exp_f32 v194, v194
    s_waitcnt lgkmcnt(3)
    v_mfma_f32_16x16x32_bf16 v[208:211], v[228:231], v[160:163], v[208:211]
    v_exp_f32 v195, v195
    v_mfma_f32_16x16x32_bf16 v[212:215], v[228:231], v[176:179], v[212:215]
    s_add_u32 s22, s21, 0x80000
    s_add_u32 m0, s20, 0x18000
    s_nop 0
    buffer_load_dwordx4 v2, s[8:11], s22 offen sc1 lds
    ds_read_b128 v[244:247], v5 offset:1024
    v_cvt_pk_bf16_f32 v74, v192, v193
    v_exp_f32 v196, v196
    s_waitcnt lgkmcnt(3)
    v_mfma_f32_16x16x32_bf16 v[200:203], v[232:235], v[164:167], v[200:203]
    v_exp_f32 v197, v197
    v_cvt_pk_bf16_f32 v75, v194, v195
    v_mfma_f32_16x16x32_bf16 v[204:207], v[232:235], v[180:183], v[204:207]
    ds_read_b128 v[224:227], v5 offset:2048
    v_exp_f32 v198, v198
    s_waitcnt lgkmcnt(3)
    v_mfma_f32_16x16x32_bf16 v[208:211], v[236:239], v[164:167], v[208:211]
    v_exp_f32 v199, v199
    v_cvt_pk_bf16_f32 v78, v196, v197
    v_mfma_f32_16x16x32_bf16 v[212:215], v[236:239], v[180:183], v[212:215]
    ds_read_b128 v[228:231], v5 offset:3072
    v_cvt_pk_bf16_f32 v79, v198, v199
    s_waitcnt lgkmcnt(3)
    v_mfma_f32_16x16x32_bf16 v[184:187], v[240:243], v[152:155], v[216:219]
    v_mfma_f32_16x16x32_bf16 v[188:191], v[240:243], v[168:171], v[220:223]
    ds_read_b128 v[232:235], v5 offset:4096
    v_exp_f32 v200, v200
    v_exp_f32 v201, v201
    v_mfma_f32_16x16x32_bf16 v[248:251], v[12:15], v[72:75], v[248:251]
    s_waitcnt lgkmcnt(3)
    v_mfma_f32_16x16x32_bf16 v[192:195], v[244:247], v[152:155], v[216:219]
    v_exp_f32 v202, v202
    v_exp_f32 v203, v203
    v_mfma_f32_16x16x32_bf16 v[196:199], v[244:247], v[168:171], v[220:223]
    s_add_u32 s22, s21, 0x80400
    s_add_u32 m0, s20, 0x18400
    s_nop 0
    buffer_load_dwordx4 v2, s[8:11], s22 offen sc1 lds
    ds_read_b128 v[236:239], v5 offset:5120
    v_cvt_pk_bf16_f32 v80, v200, v201
    v_mfma_f32_16x16x32_bf16 v[252:255], v[12:15], v[76:79], v[252:255]
    s_waitcnt lgkmcnt(3)
    v_mfma_f32_16x16x32_bf16 v[184:187], v[224:227], v[156:159], v[184:187]
    v_exp_f32 v204, v204
    v_exp_f32 v205, v205
    v_mfma_f32_16x16x32_bf16 v[188:191], v[224:227], v[172:175], v[188:191]
    ds_read_b128 v[240:243], v5 offset:6144
    v_cvt_pk_bf16_f32 v81, v202, v203
    s_waitcnt lgkmcnt(3)
    v_mfma_f32_16x16x32_bf16 v[192:195], v[228:231], v[156:159], v[192:195]
    v_exp_f32 v206, v206
    v_exp_f32 v207, v207
    v_mfma_f32_16x16x32_bf16 v[196:199], v[228:231], v[172:175], v[196:199]
    ds_read_b128 v[244:247], v5 offset:7168
    v_cvt_pk_bf16_f32 v84, v204, v205
    v_exp_f32 v208, v208
    s_waitcnt lgkmcnt(3)
    v_mfma_f32_16x16x32_bf16 v[184:187], v[232:235], v[160:163], v[184:187]
    v_exp_f32 v209, v209
    v_mfma_f32_16x16x32_bf16 v[188:191], v[232:235], v[176:179], v[188:191]
    ds_read_b128 v[224:227], v5 offset:8192
    v_cvt_pk_bf16_f32 v85, v206, v207
    v_exp_f32 v210, v210
    s_waitcnt lgkmcnt(3)
    v_mfma_f32_16x16x32_bf16 v[192:195], v[236:239], v[160:163], v[192:195]
    v_exp_f32 v211, v211
    v_mfma_f32_16x16x32_bf16 v[196:199], v[236:239], v[176:179], v[196:199]
    ds_read_b128 v[228:231], v5 offset:9216
    v_cvt_pk_bf16_f32 v82, v208, v209
    v_exp_f32 v212, v212
    s_waitcnt lgkmcnt(3)
    v_mfma_f32_16x16x32_bf16 v[184:187], v[240:243], v[164:167], v[184:187]
    v_exp_f32 v213, v213
    v_cvt_pk_bf16_f32 v83, v210, v211
    v_mfma_f32_16x16x32_bf16 v[188:191], v[240:243], v[180:183], v[188:191]
    ds_read_b128 v[232:235], v5 offset:10240
    v_exp_f32 v214, v214
    s_waitcnt lgkmcnt(3)
    v_mfma_f32_16x16x32_bf16 v[192:195], v[244:247], v[164:167], v[192:195]
    v_exp_f32 v215, v215
    v_cvt_pk_bf16_f32 v86, v212, v213
    v_mfma_f32_16x16x32_bf16 v[196:199], v[244:247], v[180:183], v[196:199]
    ds_read_b128 v[236:239], v5 offset:11264
    v_cvt_pk_bf16_f32 v87, v214, v215
    s_waitcnt lgkmcnt(3)
    v_mfma_f32_16x16x32_bf16 v[200:203], v[224:227], v[152:155], v[216:219]
    v_mfma_f32_16x16x32_bf16 v[204:207], v[224:227], v[168:171], v[220:223]
    ds_read_b128 v[240:243], v5 offset:12288
    v_exp_f32 v184, v184
    v_exp_f32 v185, v185
    v_mfma_f32_16x16x32_bf16 v[248:251], v[12:15], v[80:83], v[248:251]
    s_waitcnt lgkmcnt(3)
    v_mfma_f32_16x16x32_bf16 v[208:211], v[228:231], v[152:155], v[216:219]
    v_exp_f32 v186, v186
    v_exp_f32 v187, v187
    v_mfma_f32_16x16x32_bf16 v[212:215], v[228:231], v[168:171], v[220:223]
    ds_read_b128 v[244:247], v5 offset:13312
    v_cvt_pk_bf16_f32 v88, v184, v185
    v_mfma_f32_16x16x32_bf16 v[252:255], v[12:15], v[84:87], v[252:255]
    s_waitcnt lgkmcnt(3)
    v_mfma_f32_16x16x32_bf16 v[200:203], v[232:235], v[156:159], v[200:203]
    v_exp_f32 v188, v188
    v_exp_f32 v189, v189
    v_mfma_f32_16x16x32_bf16 v[204:207], v[232:235], v[172:175], v[204:207]
    ds_read_b128 v[224:227], v5 offset:14336
    v_cvt_pk_bf16_f32 v89, v186, v187
    s_waitcnt lgkmcnt(3)
    v_mfma_f32_16x16x32_bf16 v[208:211], v[236:239], v[156:159], v[208:211]
    v_exp_f32 v190, v190
    v_exp_f32 v191, v191
    v_mfma_f32_16x16x32_bf16 v[212:215], v[236:239], v[172:175], v[212:215]
    ds_read_b128 v[228:231], v5 offset:15360
    v_cvt_pk_bf16_f32 v92, v188, v189
    v_exp_f32 v192, v192
    s_waitcnt lgkmcnt(3)
    v_mfma_f32_16x16x32_bf16 v[200:203], v[240:243], v[160:163], v[200:203]
    v_exp_f32 v193, v193
    v_mfma_f32_16x16x32_bf16 v[204:207], v[240:243], v[176:179], v[204:207]
    s_waitcnt vmcnt(6)
    s_barrier
    ds_read_b128 v[232:235], v5 offset:16384
    v_cvt_pk_bf16_f32 v93, v190, v191
    v_exp_f32 v194, v194
    s_waitcnt lgkmcnt(3)
    v_mfma_f32_16x16x32_bf16 v[208:211], v[244:247], v[160:163], v[208:211]
    v_exp_f32 v195, v195
    v_mfma_f32_16x16x32_bf16 v[212:215], v[244:247], v[176:179], v[212:215]
    s_add_u32 s22, s21, 0x84000
    s_add_u32 m0, s20, 0x1c000
    s_nop 0
    buffer_load_dwordx4 v2, s[8:11], s22 offen sc1 lds
    ds_read_b128 v[236:239], v5 offset:17408
    v_cvt_pk_bf16_f32 v90, v192, v193
    v_exp_f32 v196, v196
    s_waitcnt lgkmcnt(3)
    v_mfma_f32_16x16x32_bf16 v[200:203], v[224:227], v[164:167], v[200:203]
    v_exp_f32 v197, v197
    v_cvt_pk_bf16_f32 v91, v194, v195
    v_mfma_f32_16x16x32_bf16 v[204:207], v[224:227], v[180:183], v[204:207]
    ds_read_b128 v[240:243], v5 offset:18432
    v_exp_f32 v198, v198
    s_waitcnt lgkmcnt(3)
    v_mfma_f32_16x16x32_bf16 v[208:211], v[228:231], v[164:167], v[208:211]
    v_exp_f32 v199, v199
    v_cvt_pk_bf16_f32 v94, v196, v197
    v_mfma_f32_16x16x32_bf16 v[212:215], v[228:231], v[180:183], v[212:215]
    ds_read_b128 v[244:247], v5 offset:19456
    v_cvt_pk_bf16_f32 v95, v198, v199
    s_waitcnt lgkmcnt(3)
    v_mfma_f32_16x16x32_bf16 v[184:187], v[232:235], v[152:155], v[216:219]
    v_mfma_f32_16x16x32_bf16 v[188:191], v[232:235], v[168:171], v[220:223]
    ds_read_b128 v[224:227], v5 offset:20480
    v_exp_f32 v200, v200
    v_exp_f32 v201, v201
    v_mfma_f32_16x16x32_bf16 v[248:251], v[12:15], v[88:91], v[248:251]
    s_waitcnt lgkmcnt(3)
    v_mfma_f32_16x16x32_bf16 v[192:195], v[236:239], v[152:155], v[216:219]
    v_exp_f32 v202, v202
    v_exp_f32 v203, v203
    v_mfma_f32_16x16x32_bf16 v[196:199], v[236:239], v[168:171], v[220:223]
    s_add_u32 s22, s21, 0x84400
    s_add_u32 m0, s20, 0x1c400
    s_nop 0
    buffer_load_dwordx4 v2, s[8:11], s22 offen sc1 lds
    ds_read_b128 v[228:231], v5 offset:21504
    v_cvt_pk_bf16_f32 v96, v200, v201
    v_mfma_f32_16x16x32_bf16 v[252:255], v[12:15], v[92:95], v[252:255]
    s_waitcnt lgkmcnt(3)
    v_mfma_f32_16x16x32_bf16 v[184:187], v[240:243], v[156:159], v[184:187]
    v_exp_f32 v204, v204
    v_exp_f32 v205, v205
    v_mfma_f32_16x16x32_bf16 v[188:191], v[240:243], v[172:175], v[188:191]
    ds_read_b128 v[232:235], v5 offset:22528
    v_cvt_pk_bf16_f32 v97, v202, v203
    s_waitcnt lgkmcnt(3)
    v_mfma_f32_16x16x32_bf16 v[192:195], v[244:247], v[156:159], v[192:195]
    v_exp_f32 v206, v206
    v_exp_f32 v207, v207
    v_mfma_f32_16x16x32_bf16 v[196:199], v[244:247], v[172:175], v[196:199]
    ds_read_b128 v[236:239], v5 offset:23552
    v_cvt_pk_bf16_f32 v100, v204, v205
    v_exp_f32 v208, v208
    s_waitcnt lgkmcnt(3)
    v_mfma_f32_16x16x32_bf16 v[184:187], v[224:227], v[160:163], v[184:187]
    v_exp_f32 v209, v209
    v_mfma_f32_16x16x32_bf16 v[188:191], v[224:227], v[176:179], v[188:191]
    ds_read_b128 v[240:243], v5 offset:24576
    v_cvt_pk_bf16_f32 v101, v206, v207
    v_exp_f32 v210, v210
    s_waitcnt lgkmcnt(3)
    v_mfma_f32_16x16x32_bf16 v[192:195], v[228:231], v[160:163], v[192:195]
    v_exp_f32 v211, v211
    v_mfma_f32_16x16x32_bf16 v[196:199], v[228:231], v[176:179], v[196:199]
    ds_read_b128 v[244:247], v5 offset:25600
    v_cvt_pk_bf16_f32 v98, v208, v209
    v_exp_f32 v212, v212
    s_waitcnt lgkmcnt(3)
    v_mfma_f32_16x16x32_bf16 v[184:187], v[232:235], v[164:167], v[184:187]
    v_exp_f32 v213, v213
    v_cvt_pk_bf16_f32 v99, v210, v211
    v_mfma_f32_16x16x32_bf16 v[188:191], v[232:235], v[180:183], v[188:191]
    ds_read_b128 v[224:227], v5 offset:26624
    v_exp_f32 v214, v214
    s_waitcnt lgkmcnt(3)
    v_mfma_f32_16x16x32_bf16 v[192:195], v[236:239], v[164:167], v[192:195]
    v_exp_f32 v215, v215
    v_cvt_pk_bf16_f32 v102, v212, v213
    v_mfma_f32_16x16x32_bf16 v[196:199], v[236:239], v[180:183], v[196:199]
    ds_read_b128 v[228:231], v5 offset:27648
    v_cvt_pk_bf16_f32 v103, v214, v215
    s_waitcnt lgkmcnt(3)
    v_mfma_f32_16x16x32_bf16 v[200:203], v[240:243], v[152:155], v[216:219]
    v_mfma_f32_16x16x32_bf16 v[204:207], v[240:243], v[168:171], v[220:223]
    ds_read_b128 v[232:235], v5 offset:28672
    v_exp_f32 v184, v184
    v_exp_f32 v185, v185
    v_mfma_f32_16x16x32_bf16 v[248:251], v[12:15], v[96:99], v[248:251]
    s_waitcnt lgkmcnt(3)
    v_mfma_f32_16x16x32_bf16 v[208:211], v[244:247], v[152:155], v[216:219]
    v_exp_f32 v186, v186
    v_exp_f32 v187, v187
    v_mfma_f32_16x16x32_bf16 v[212:215], v[244:247], v[168:171], v[220:223]
    ds_read_b128 v[236:239], v5 offset:29696
    v_cvt_pk_bf16_f32 v104, v184, v185
    v_mfma_f32_16x16x32_bf16 v[252:255], v[12:15], v[100:103], v[252:255]
    s_waitcnt lgkmcnt(3)
    v_mfma_f32_16x16x32_bf16 v[200:203], v[224:227], v[156:159], v[200:203]
    v_exp_f32 v188, v188
    v_exp_f32 v189, v189
    v_mfma_f32_16x16x32_bf16 v[204:207], v[224:227], v[172:175], v[204:207]
    ds_read_b128 v[240:243], v5 offset:30720
    v_cvt_pk_bf16_f32 v105, v186, v187
    s_waitcnt lgkmcnt(3)
    v_mfma_f32_16x16x32_bf16 v[208:211], v[228:231], v[156:159], v[208:211]
    v_exp_f32 v190, v190
    v_exp_f32 v191, v191
    v_mfma_f32_16x16x32_bf16 v[212:215], v[228:231], v[172:175], v[212:215]
    ds_read_b128 v[244:247], v5 offset:31744
    v_cvt_pk_bf16_f32 v108, v188, v189
    v_exp_f32 v192, v192
    s_waitcnt lgkmcnt(3)
    v_mfma_f32_16x16x32_bf16 v[200:203], v[232:235], v[160:163], v[200:203]
    v_exp_f32 v193, v193
    v_mfma_f32_16x16x32_bf16 v[204:207], v[232:235], v[176:179], v[204:207]
    s_waitcnt vmcnt(6)
    s_barrier
    ds_read_b128 v[224:227], v4 offset:0
    v_cvt_pk_bf16_f32 v109, v190, v191
    v_exp_f32 v194, v194
    s_waitcnt lgkmcnt(3)
    v_mfma_f32_16x16x32_bf16 v[208:211], v[236:239], v[160:163], v[208:211]
    v_exp_f32 v195, v195
    v_mfma_f32_16x16x32_bf16 v[212:215], v[236:239], v[176:179], v[212:215]
    s_add_u32 s22, s21, 0x88000
    s_add_u32 m0, s20, 0x20000
    s_nop 0
    buffer_load_dwordx4 v2, s[8:11], s22 offen sc1 lds
    ds_read_b128 v[228:231], v4 offset:1024
    v_cvt_pk_bf16_f32 v106, v192, v193
    v_exp_f32 v196, v196
    s_waitcnt lgkmcnt(3)
    v_mfma_f32_16x16x32_bf16 v[200:203], v[240:243], v[164:167], v[200:203]
    v_exp_f32 v197, v197
    v_cvt_pk_bf16_f32 v107, v194, v195
    v_mfma_f32_16x16x32_bf16 v[204:207], v[240:243], v[180:183], v[204:207]
    ds_read_b128 v[232:235], v4 offset:2048
    v_exp_f32 v198, v198
    s_waitcnt lgkmcnt(3)
    v_mfma_f32_16x16x32_bf16 v[208:211], v[244:247], v[164:167], v[208:211]
    v_exp_f32 v199, v199
    v_cvt_pk_bf16_f32 v110, v196, v197
    v_mfma_f32_16x16x32_bf16 v[212:215], v[244:247], v[180:183], v[212:215]
    ds_read_b128 v[236:239], v4 offset:3072
    v_cvt_pk_bf16_f32 v111, v198, v199
    s_waitcnt lgkmcnt(3)
    v_mfma_f32_16x16x32_bf16 v[184:187], v[224:227], v[152:155], v[216:219]
    v_mfma_f32_16x16x32_bf16 v[188:191], v[224:227], v[168:171], v[220:223]
    ds_read_b128 v[240:243], v4 offset:4096
    v_exp_f32 v200, v200
    v_exp_f32 v201, v201
    v_mfma_f32_16x16x32_bf16 v[248:251], v[12:15], v[104:107], v[248:251]
    s_waitcnt lgkmcnt(3)
    v_mfma_f32_16x16x32_bf16 v[192:195], v[228:231], v[152:155], v[216:219]
    v_exp_f32 v202, v202
    v_exp_f32 v203, v203
    v_mfma_f32_16x16x32_bf16 v[196:199], v[228:231], v[168:171], v[220:223]
    s_add_u32 s22, s21, 0x88400
    s_add_u32 m0, s20, 0x20400
    s_nop 0
    buffer_load_dwordx4 v2, s[8:11], s22 offen sc1 lds
    ds_read_b128 v[244:247], v4 offset:5120
    v_cvt_pk_bf16_f32 v112, v200, v201
    v_mfma_f32_16x16x32_bf16 v[252:255], v[12:15], v[108:111], v[252:255]
    s_waitcnt lgkmcnt(3)
    v_mfma_f32_16x16x32_bf16 v[184:187], v[232:235], v[156:159], v[184:187]
    v_exp_f32 v204, v204
    v_exp_f32 v205, v205
    v_mfma_f32_16x16x32_bf16 v[188:191], v[232:235], v[172:175], v[188:191]
    ds_read_b128 v[224:227], v4 offset:6144
    v_cvt_pk_bf16_f32 v113, v202, v203
    s_waitcnt lgkmcnt(3)
    v_mfma_f32_16x16x32_bf16 v[192:195], v[236:239], v[156:159], v[192:195]
    v_exp_f32 v206, v206
    v_exp_f32 v207, v207
    v_mfma_f32_16x16x32_bf16 v[196:199], v[236:239], v[172:175], v[196:199]
    ds_read_b128 v[228:231], v4 offset:7168
    v_cvt_pk_bf16_f32 v116, v204, v205
    v_exp_f32 v208, v208
    s_waitcnt lgkmcnt(3)
    v_mfma_f32_16x16x32_bf16 v[184:187], v[240:243], v[160:163], v[184:187]
    v_exp_f32 v209, v209
    v_mfma_f32_16x16x32_bf16 v[188:191], v[240:243], v[176:179], v[188:191]
    ds_read_b128 v[232:235], v4 offset:8192
    v_cvt_pk_bf16_f32 v117, v206, v207
    v_exp_f32 v210, v210
    s_waitcnt lgkmcnt(3)
    v_mfma_f32_16x16x32_bf16 v[192:195], v[244:247], v[160:163], v[192:195]
    v_exp_f32 v211, v211
    v_mfma_f32_16x16x32_bf16 v[196:199], v[244:247], v[176:179], v[196:199]
    ds_read_b128 v[236:239], v4 offset:9216
    v_cvt_pk_bf16_f32 v114, v208, v209
    v_exp_f32 v212, v212
    s_waitcnt lgkmcnt(3)
    v_mfma_f32_16x16x32_bf16 v[184:187], v[224:227], v[164:167], v[184:187]
    v_exp_f32 v213, v213
    v_cvt_pk_bf16_f32 v115, v210, v211
    v_mfma_f32_16x16x32_bf16 v[188:191], v[224:227], v[180:183], v[188:191]
    ds_read_b128 v[240:243], v4 offset:10240
    v_exp_f32 v214, v214
    s_waitcnt lgkmcnt(3)
    v_mfma_f32_16x16x32_bf16 v[192:195], v[228:231], v[164:167], v[192:195]
    v_exp_f32 v215, v215
    v_cvt_pk_bf16_f32 v118, v212, v213
    v_mfma_f32_16x16x32_bf16 v[196:199], v[228:231], v[180:183], v[196:199]
    ds_read_b128 v[244:247], v4 offset:11264
    v_cvt_pk_bf16_f32 v119, v214, v215
    s_waitcnt lgkmcnt(3)
    v_mfma_f32_16x16x32_bf16 v[200:203], v[232:235], v[152:155], v[216:219]
    v_mfma_f32_16x16x32_bf16 v[204:207], v[232:235], v[168:171], v[220:223]
    ds_read_b128 v[224:227], v4 offset:12288
    v_exp_f32 v184, v184
    v_exp_f32 v185, v185
    v_mfma_f32_16x16x32_bf16 v[248:251], v[12:15], v[112:115], v[248:251]
    s_waitcnt lgkmcnt(3)
    v_mfma_f32_16x16x32_bf16 v[208:211], v[236:239], v[152:155], v[216:219]
    v_exp_f32 v186, v186
    v_exp_f32 v187, v187
    v_mfma_f32_16x16x32_bf16 v[212:215], v[236:239], v[168:171], v[220:223]
    ds_read_b128 v[228:231], v4 offset:13312
    v_cvt_pk_bf16_f32 v120, v184, v185
    v_mfma_f32_16x16x32_bf16 v[252:255], v[12:15], v[116:119], v[252:255]
    s_waitcnt lgkmcnt(3)
    v_mfma_f32_16x16x32_bf16 v[200:203], v[240:243], v[156:159], v[200:203]
    v_exp_f32 v188, v188
    v_exp_f32 v189, v189
    v_mfma_f32_16x16x32_bf16 v[204:207], v[240:243], v[172:175], v[204:207]
    ds_read_b128 v[232:235], v4 offset:14336
    v_cvt_pk_bf16_f32 v121, v186, v187
    s_waitcnt lgkmcnt(3)
    v_mfma_f32_16x16x32_bf16 v[208:211], v[244:247], v[156:159], v[208:211]
    v_exp_f32 v190, v190
    v_exp_f32 v191, v191
    v_mfma_f32_16x16x32_bf16 v[212:215], v[244:247], v[172:175], v[212:215]
    ds_read_b128 v[236:239], v4 offset:15360
    v_cvt_pk_bf16_f32 v124, v188, v189
    v_exp_f32 v192, v192
    s_waitcnt lgkmcnt(3)
    v_mfma_f32_16x16x32_bf16 v[200:203], v[224:227], v[160:163], v[200:203]
    v_exp_f32 v193, v193
    v_mfma_f32_16x16x32_bf16 v[204:207], v[224:227], v[176:179], v[204:207]
    s_waitcnt vmcnt(6)
    s_barrier
    ds_read_b128 v[240:243], v4 offset:16384
    v_cvt_pk_bf16_f32 v125, v190, v191
    v_exp_f32 v194, v194
    s_waitcnt lgkmcnt(3)
    v_mfma_f32_16x16x32_bf16 v[208:211], v[228:231], v[160:163], v[208:211]
    v_exp_f32 v195, v195
    v_mfma_f32_16x16x32_bf16 v[212:215], v[228:231], v[176:179], v[212:215]
    s_add_u32 s22, s21, 0x8c000
    s_add_u32 m0, s20, 0x24000
    s_nop 0
    buffer_load_dwordx4 v2, s[8:11], s22 offen sc1 lds
    ds_read_b128 v[244:247], v4 offset:17408
    v_cvt_pk_bf16_f32 v122, v192, v193
    v_exp_f32 v196, v196
    s_waitcnt lgkmcnt(3)
    v_mfma_f32_16x16x32_bf16 v[200:203], v[232:235], v[164:167], v[200:203]
    v_exp_f32 v197, v197
    v_cvt_pk_bf16_f32 v123, v194, v195
    v_mfma_f32_16x16x32_bf16 v[204:207], v[232:235], v[180:183], v[204:207]
    ds_read_b128 v[224:227], v4 offset:18432
    v_exp_f32 v198, v198
    s_waitcnt lgkmcnt(3)
    v_mfma_f32_16x16x32_bf16 v[208:211], v[236:239], v[164:167], v[208:211]
    v_exp_f32 v199, v199
    v_cvt_pk_bf16_f32 v126, v196, v197
    v_mfma_f32_16x16x32_bf16 v[212:215], v[236:239], v[180:183], v[212:215]
    ds_read_b128 v[228:231], v4 offset:19456
    v_cvt_pk_bf16_f32 v127, v198, v199
    s_waitcnt lgkmcnt(3)
    v_mfma_f32_16x16x32_bf16 v[184:187], v[240:243], v[152:155], v[216:219]
    v_mfma_f32_16x16x32_bf16 v[188:191], v[240:243], v[168:171], v[220:223]
    ds_read_b128 v[232:235], v4 offset:20480
    v_exp_f32 v200, v200
    v_exp_f32 v201, v201
    v_mfma_f32_16x16x32_bf16 v[248:251], v[12:15], v[120:123], v[248:251]
    s_waitcnt lgkmcnt(3)
    v_mfma_f32_16x16x32_bf16 v[192:195], v[244:247], v[152:155], v[216:219]
    v_exp_f32 v202, v202
    v_exp_f32 v203, v203
    v_mfma_f32_16x16x32_bf16 v[196:199], v[244:247], v[168:171], v[220:223]
    s_add_u32 s22, s21, 0x8c400
    s_add_u32 m0, s20, 0x24400
    s_nop 0
    buffer_load_dwordx4 v2, s[8:11], s22 offen sc1 lds
    ds_read_b128 v[236:239], v4 offset:21504
    v_cvt_pk_bf16_f32 v128, v200, v201
    v_mfma_f32_16x16x32_bf16 v[252:255], v[12:15], v[124:127], v[252:255]
    s_waitcnt lgkmcnt(3)
    v_mfma_f32_16x16x32_bf16 v[184:187], v[224:227], v[156:159], v[184:187]
    v_exp_f32 v204, v204
    v_exp_f32 v205, v205
    v_mfma_f32_16x16x32_bf16 v[188:191], v[224:227], v[172:175], v[188:191]
    ds_read_b128 v[240:243], v4 offset:22528
    v_cvt_pk_bf16_f32 v129, v202, v203
    s_waitcnt lgkmcnt(3)
    v_mfma_f32_16x16x32_bf16 v[192:195], v[228:231], v[156:159], v[192:195]
    v_exp_f32 v206, v206
    v_exp_f32 v207, v207
    v_mfma_f32_16x16x32_bf16 v[196:199], v[228:231], v[172:175], v[196:199]
    ds_read_b128 v[244:247], v4 offset:23552
    v_cvt_pk_bf16_f32 v132, v204, v205
    v_exp_f32 v208, v208
    s_waitcnt lgkmcnt(3)
    v_mfma_f32_16x16x32_bf16 v[184:187], v[232:235], v[160:163], v[184:187]
    v_exp_f32 v209, v209
    v_mfma_f32_16x16x32_bf16 v[188:191], v[232:235], v[176:179], v[188:191]
    ds_read_b128 v[224:227], v4 offset:24576
    v_cvt_pk_bf16_f32 v133, v206, v207
    v_exp_f32 v210, v210
    s_waitcnt lgkmcnt(3)
    v_mfma_f32_16x16x32_bf16 v[192:195], v[236:239], v[160:163], v[192:195]
    v_exp_f32 v211, v211
    v_mfma_f32_16x16x32_bf16 v[196:199], v[236:239], v[176:179], v[196:199]
    ds_read_b128 v[228:231], v4 offset:25600
    v_cvt_pk_bf16_f32 v130, v208, v209
    v_exp_f32 v212, v212
    s_waitcnt lgkmcnt(3)
    v_mfma_f32_16x16x32_bf16 v[184:187], v[240:243], v[164:167], v[184:187]
    v_exp_f32 v213, v213
    v_cvt_pk_bf16_f32 v131, v210, v211
    v_mfma_f32_16x16x32_bf16 v[188:191], v[240:243], v[180:183], v[188:191]
    ds_read_b128 v[232:235], v4 offset:26624
    v_exp_f32 v214, v214
    s_waitcnt lgkmcnt(3)
    v_mfma_f32_16x16x32_bf16 v[192:195], v[244:247], v[164:167], v[192:195]
    v_exp_f32 v215, v215
    v_cvt_pk_bf16_f32 v134, v212, v213
    v_mfma_f32_16x16x32_bf16 v[196:199], v[244:247], v[180:183], v[196:199]
    ds_read_b128 v[236:239], v4 offset:27648
    v_cvt_pk_bf16_f32 v135, v214, v215
    s_waitcnt lgkmcnt(3)
    v_mfma_f32_16x16x32_bf16 v[200:203], v[224:227], v[152:155], v[216:219]
    v_mfma_f32_16x16x32_bf16 v[204:207], v[224:227], v[168:171], v[220:223]
    ds_read_b128 v[240:243], v4 offset:28672
    v_exp_f32 v184, v184
    v_exp_f32 v185, v185
    v_mfma_f32_16x16x32_bf16 v[248:251], v[12:15], v[128:131], v[248:251]
    s_waitcnt lgkmcnt(3)
    v_mfma_f32_16x16x32_bf16 v[208:211], v[228:231], v[152:155], v[216:219]
    v_exp_f32 v186, v186
    v_exp_f32 v187, v187
    v_mfma_f32_16x16x32_bf16 v[212:215], v[228:231], v[168:171], v[220:223]
    ds_read_b128 v[244:247], v4 offset:29696
    v_cvt_pk_bf16_f32 v136, v184, v185
    v_mfma_f32_16x16x32_bf16 v[252:255], v[12:15], v[132:135], v[252:255]
    s_waitcnt lgkmcnt(3)
    v_mfma_f32_16x16x32_bf16 v[200:203], v[232:235], v[156:159], v[200:203]
    v_exp_f32 v188, v188
    v_exp_f32 v189, v189
    v_mfma_f32_16x16x32_bf16 v[204:207], v[232:235], v[172:175], v[204:207]
    ds_read_b128 v[224:227], v4 offset:30720
    v_cvt_pk_bf16_f32 v137, v186, v187
    s_waitcnt lgkmcnt(3)
    v_mfma_f32_16x16x32_bf16 v[208:211], v[236:239], v[156:159], v[208:211]
    v_exp_f32 v190, v190
    v_exp_f32 v191, v191
    v_mfma_f32_16x16x32_bf16 v[212:215], v[236:239], v[172:175], v[212:215]
    ds_read_b128 v[228:231], v4 offset:31744
    v_cvt_pk_bf16_f32 v140, v188, v189
    v_exp_f32 v192, v192
    s_waitcnt lgkmcnt(3)
    v_mfma_f32_16x16x32_bf16 v[200:203], v[240:243], v[160:163], v[200:203]
    v_exp_f32 v193, v193
    v_mfma_f32_16x16x32_bf16 v[204:207], v[240:243], v[176:179], v[204:207]
    v_cvt_pk_bf16_f32 v141, v190, v191
    v_exp_f32 v194, v194
    s_waitcnt lgkmcnt(2)
    v_mfma_f32_16x16x32_bf16 v[208:211], v[244:247], v[160:163], v[208:211]
    v_exp_f32 v195, v195
    v_mfma_f32_16x16x32_bf16 v[212:215], v[244:247], v[176:179], v[212:215]
    v_cvt_pk_bf16_f32 v138, v192, v193
    v_exp_f32 v196, v196
    s_waitcnt lgkmcnt(1)
    v_mfma_f32_16x16x32_bf16 v[200:203], v[224:227], v[164:167], v[200:203]
    v_exp_f32 v197, v197
    v_cvt_pk_bf16_f32 v139, v194, v195
    v_mfma_f32_16x16x32_bf16 v[204:207], v[224:227], v[180:183], v[204:207]
    v_exp_f32 v198, v198
    s_waitcnt lgkmcnt(0)
    v_mfma_f32_16x16x32_bf16 v[208:211], v[228:231], v[164:167], v[208:211]
    v_exp_f32 v199, v199
    v_cvt_pk_bf16_f32 v142, v196, v197
    v_mfma_f32_16x16x32_bf16 v[212:215], v[228:231], v[180:183], v[212:215]
    v_cvt_pk_bf16_f32 v143, v198, v199
    s_waitcnt vmcnt(6)
    s_barrier
    ds_read_b128 v[232:235], v4 offset:32768
    ds_read_b128 v[236:239], v4 offset:33792
    ds_read_b128 v[240:243], v4 offset:34816
    ds_read_b128 v[244:247], v4 offset:35840
    v_mfma_f32_16x16x32_bf16 v[248:251], v[12:15], v[136:139], v[248:251]
    v_mfma_f32_16x16x32_bf16 v[252:255], v[12:15], v[140:143], v[252:255]
    v_exp_f32 v200, v200
    v_exp_f32 v201, v201
    v_exp_f32 v202, v202
    v_exp_f32 v203, v203
    v_cvt_pk_bf16_f32 v144, v200, v201
    v_exp_f32 v204, v204
    v_exp_f32 v205, v205
    v_cvt_pk_bf16_f32 v145, v202, v203
    v_exp_f32 v206, v206
    v_exp_f32 v207, v207
    v_cvt_pk_bf16_f32 v148, v204, v205
    v_exp_f32 v208, v208
    v_exp_f32 v209, v209
    v_cvt_pk_bf16_f32 v149, v206, v207
    v_exp_f32 v210, v210
    v_exp_f32 v211, v211
    v_cvt_pk_bf16_f32 v146, v208, v209
    v_exp_f32 v212, v212
    v_exp_f32 v213, v213
    v_cvt_pk_bf16_f32 v147, v210, v211
    v_exp_f32 v214, v214
    v_exp_f32 v215, v215
    v_cvt_pk_bf16_f32 v150, v212, v213
    v_cvt_pk_bf16_f32 v151, v214, v215
    v_mfma_f32_16x16x32_bf16 v[248:251], v[12:15], v[144:147], v[248:251]
    s_nop 0
    v_mfma_f32_16x16x32_bf16 v[252:255], v[12:15], v[148:151], v[252:255]
    s_nop 5
    v_mov_b32 v9, v248
    s_nop 0
    v_mov_b32 v10, v252
    v_max_f32 v17, v9, v10
    v_readfirstlane_b32 s17, v8
    s_cmp_eq_u32 s17, s28
    s_cselect_b32 s16, 0, 0x71800000
    v_cmp_ngt_f32 vcc, s16, v17
    v_cmp_u_f32 s[76:77], v9, v10
    s_or_b64 vcc, vcc, s[76:77]
    s_cbranch_vccnz adaLN_cond__sliding_block_cached__moe_arch_mod__prompt_kernel_fixA
adaLN_cond__sliding_block_cached__moe_arch_mod__prompt_kernel_fixAb:
    v_rcp_f32 v9, v9
    v_rcp_f32 v10, v10
    s_lshl_b32 s25, s13, 3
    s_add_u32 s25, s25, s3
    s_lshl_b32 s25, s25, 18
    s_lshl_b32 s26, s12, 12
    s_add_u32 s25, s25, s26
    s_add_u32 s25, s25, 0x1000000
    s_add_u32 s26, s25, 131072
    s_lshl_b32 s63, s13, 3
    s_add_u32 s63, s63, s3
    s_lshl_b32 s63, s63, 5
    s_add_u32 s63, s63, s12
    s_lshl_b32 s63, s63, 2
    s_waitcnt lgkmcnt(3)
    v_mfma_f32_16x16x32_bf16 v[184:187], v[232:235], v[24:27], 0
    s_mov_b64 s[76:77], s[54:55]
    s_mov_b32 s78, 0xc00000
    s_mov_b32 s79, 0x20000
    v_mfma_f32_16x16x32_bf16 v[188:191], v[232:235], v[28:31], 0
    ds_read_b128 v[224:227], v4 offset:36864
    s_waitcnt lgkmcnt(3)
    v_mfma_f32_16x16x32_bf16 v[192:195], v[236:239], v[24:27], 0
    s_add_u32 s22, s14, 0x0
    s_add_u32 m0, s20, 0x10000
    s_nop 0
    buffer_load_dwordx4 v6, s[76:79], s22 offen lds
    v_mfma_f32_16x16x32_bf16 v[196:199], v[236:239], v[28:31], 0
    ds_read_b128 v[228:231], v4 offset:37888
    s_waitcnt lgkmcnt(3)
    v_mfma_f32_16x16x32_bf16 v[184:187], v[240:243], v[32:35], v[184:187]
    v_mfma_f32_16x16x32_bf16 v[188:191], v[240:243], v[36:39], v[188:191]
    ds_read_b128 v[232:235], v4 offset:38912
    s_waitcnt lgkmcnt(3)
    v_mfma_f32_16x16x32_bf16 v[192:195], v[244:247], v[32:35], v[192:195]
    v_mfma_f32_16x16x32_bf16 v[196:199], v[244:247], v[36:39], v[196:199]
    ds_read_b128 v[236:239], v4 offset:39936
    s_waitcnt lgkmcnt(3)
    v_mfma_f32_16x16x32_bf16 v[184:187], v[224:227], v[40:43], v[184:187]
    v_mfma_f32_16x16x32_bf16 v[188:191], v[224:227], v[44:47], v[188:191]
    ds_read_b128 v[240:243], v4 offset:40960
    s_waitcnt lgkmcnt(3)
    v_mfma_f32_16x16x32_bf16 v[192:195], v[228:231], v[40:43], v[192:195]
    s_add_u32 s22, s14, 0xc000
    s_add_u32 m0, s20, 0x10400
    s_nop 0
    buffer_load_dwordx4 v6, s[76:79], s22 offen lds
    v_mfma_f32_16x16x32_bf16 v[196:199], v[228:231], v[44:47], v[196:199]
    ds_read_b128 v[244:247], v4 offset:41984
    s_waitcnt lgkmcnt(3)
    v_mfma_f32_16x16x32_bf16 v[184:187], v[232:235], v[48:51], v[184:187]
    v_mfma_f32_16x16x32_bf16 v[188:191], v[232:235], v[52:55], v[188:191]
    ds_read_b128 v[224:227], v4 offset:43008
    s_waitcnt lgkmcnt(3)
    v_mfma_f32_16x16x32_bf16 v[192:195], v[236:239], v[48:51], v[192:195]
    v_mfma_f32_16x16x32_bf16 v[196:199], v[236:239], v[52:55], v[196:199]
    ds_read_b128 v[228:231], v4 offset:44032
    s_waitcnt lgkmcnt(3)
    v_mfma_f32_16x16x32_bf16 v[184:187], v[240:243], v[56:59], v[184:187]
    v_mfma_f32_16x16x32_bf16 v[188:191], v[240:243], v[60:63], v[188:191]
    ds_read_b128 v[232:235], v4 offset:45056
    s_waitcnt lgkmcnt(3)
    v_mfma_f32_16x16x32_bf16 v[192:195], v[244:247], v[56:59], v[192:195]
    v_mfma_f32_16x16x32_bf16 v[196:199], v[244:247], v[60:63], v[196:199]
    ds_read_b128 v[236:239], v4 offset:46080
    s_waitcnt lgkmcnt(3)
    v_mfma_f32_16x16x32_bf16 v[184:187], v[224:227], v[64:67], v[184:187]
    v_mfma_f32_16x16x32_bf16 v[188:191], v[224:227], v[68:71], v[188:191]
    ds_read_b128 v[240:243], v4 offset:47104
    s_waitcnt lgkmcnt(3)
    v_mfma_f32_16x16x32_bf16 v[192:195], v[228:231], v[64:67], v[192:195]
    v_mfma_f32_16x16x32_bf16 v[196:199], v[228:231], v[68:71], v[196:199]
    ds_read_b128 v[244:247], v4 offset:48128
    s_waitcnt lgkmcnt(3)
    v_mfma_f32_16x16x32_bf16 v[184:187], v[232:235], v[72:75], v[184:187]
    v_mfma_f32_16x16x32_bf16 v[188:191], v[232:235], v[76:79], v[188:191]
    s_waitcnt vmcnt(6)
    s_barrier
    ds_read_b128 v[224:227], v4 offset:49152
    s_waitcnt lgkmcnt(3)
    v_mfma_f32_16x16x32_bf16 v[192:195], v[236:239], v[72:75], v[192:195]
    v_mfma_f32_16x16x32_bf16 v[196:199], v[236:239], v[76:79], v[196:199]
    s_add_u32 s22, s14, 0xc0000
    s_add_u32 m0, s20, 0x14000
    s_nop 0
    buffer_load_dwordx4 v6, s[76:79], s22 offen lds
    ds_read_b128 v[228:231], v4 offset:50176
    s_waitcnt lgkmcnt(3)
    v_mfma_f32_16x16x32_bf16 v[184:187], v[240:243], v[80:83], v[184:187]
    v_mfma_f32_16x16x32_bf16 v[188:191], v[240:243], v[84:87], v[188:191]
    ds_read_b128 v[232:235], v4 offset:51200
    s_waitcnt lgkmcnt(3)
    v_mfma_f32_16x16x32_bf16 v[192:195], v[244:247], v[80:83], v[192:195]
    v_mfma_f32_16x16x32_bf16 v[196:199], v[244:247], v[84:87], v[196:199]
    ds_read_b128 v[236:239], v4 offset:52224
    s_waitcnt lgkmcnt(3)
    v_mfma_f32_16x16x32_bf16 v[184:187], v[224:227], v[88:91], v[184:187]
    v_mfma_f32_16x16x32_bf16 v[188:191], v[224:227], v[92:95], v[188:191]
    ds_read_b128 v[240:243], v4 offset:53248
    s_waitcnt lgkmcnt(3)
    v_mfma_f32_16x16x32_bf16 v[192:195], v[228:231], v[88:91], v[192:195]
    v_mfma_f32_16x16x32_bf16 v[196:199], v[228:231], v[92:95], v[196:199]
    s_add_u32 s22, s14, 0xcc000
    s_add_u32 m0, s20, 0x14400
    s_nop 0
    buffer_load_dwordx4 v6, s[76:79], s22 offen lds
    ds_read_b128 v[244:247], v4 offset:54272
    s_waitcnt lgkmcnt(3)
    v_mfma_f32_16x16x32_bf16 v[184:187], v[232:235], v[96:99], v[184:187]
    v_mfma_f32_16x16x32_bf16 v[188:191], v[232:235], v[100:103], v[188:191]
    ds_read_b128 v[224:227], v4 offset:55296
    s_waitcnt lgkmcnt(3)
    v_mfma_f32_16x16x32_bf16 v[192:195], v[236:239], v[96:99], v[192:195]
    v_mfma_f32_16x16x32_bf16 v[196:199], v[236:239], v[100:103], v[196:199]
    ds_read_b128 v[228:231], v4 offset:56320
    s_waitcnt lgkmcnt(3)
    v_mfma_f32_16x16x32_bf16 v[184:187], v[240:243], v[104:107], v[184:187]
    v_mfma_f32_16x16x32_bf16 v[188:191], v[240:243], v[108:111], v[188:191]
    ds_read_b128 v[232:235], v4 offset:57344
    s_waitcnt lgkmcnt(3)
    v_mfma_f32_16x16x32_bf16 v[192:195], v[244:247], v[104:107], v[192:195]
    v_mfma_f32_16x16x32_bf16 v[196:199], v[244:247], v[108:111], v[196:199]
    ds_read_b128 v[236:239], v4 offset:58368
    s_waitcnt lgkmcnt(3)
    v_mfma_f32_16x16x32_bf16 v[184:187], v[224:227], v[112:115], v[184:187]
    v_mfma_f32_16x16x32_bf16 v[188:191], v[224:227], v[116:119], v[188:191]
    ds_read_b128 v[240:243], v4 offset:59392
    s_waitcnt lgkmcnt(3)
    v_mfma_f32_16x16x32_bf16 v[192:195], v[228:231], v[112:115], v[192:195]
    v_mfma_f32_16x16x32_bf16 v[196:199], v[228:231], v[116:119], v[196:199]
    ds_read_b128 v[244:247], v4 offset:60416
    s_waitcnt lgkmcnt(3)
    v_mfma_f32_16x16x32_bf16 v[184:187], v[232:235], v[120:123], v[184:187]
    v_mfma_f32_16x16x32_bf16 v[188:191], v[232:235], v[124:127], v[188:191]
    ds_read_b128 v[224:227], v4 offset:61440
    s_waitcnt lgkmcnt(3)
    v_mfma_f32_16x16x32_bf16 v[192:195], v[236:239], v[120:123], v[192:195]
    v_mfma_f32_16x16x32_bf16 v[196:199], v[236:239], v[124:127], v[196:199]
    ds_read_b128 v[228:231], v4 offset:62464
    s_waitcnt lgkmcnt(3)
    v_mfma_f32_16x16x32_bf16 v[184:187], v[240:243], v[128:131], v[184:187]
    v_mfma_f32_16x16x32_bf16 v[188:191], v[240:243], v[132:135], v[188:191]
    ds_read_b128 v[232:235], v4 offset:63488
    s_waitcnt lgkmcnt(3)
    v_mfma_f32_16x16x32_bf16 v[192:195], v[244:247], v[128:131], v[192:195]
    v_mfma_f32_16x16x32_bf16 v[196:199], v[244:247], v[132:135], v[196:199]
    ds_read_b128 v[236:239], v4 offset:64512
    s_waitcnt lgkmcnt(3)
    v_mfma_f32_16x16x32_bf16 v[184:187], v[224:227], v[136:139], v[184:187]
    v_mfma_f32_16x16x32_bf16 v[188:191], v[224:227], v[140:143], v[188:191]
    s_waitcnt vmcnt(6)
    s_barrier
    ds_read_b128 v[240:243], v5 offset:0
    s_waitcnt lgkmcnt(3)
    v_mfma_f32_16x16x32_bf16 v[192:195], v[228:231], v[136:139], v[192:195]
    v_mfma_f32_16x16x32_bf16 v[196:199], v[228:231], v[140:143], v[196:199]
    s_add_u32 s22, s21, 0x90000
    s_add_u32 m0, s20, 0x18000
    s_nop 0
    buffer_load_dwordx4 v2, s[8:11], s22 offen sc1 lds
    ds_read_b128 v[244:247], v5 offset:1024
    s_waitcnt lgkmcnt(3)
    v_mfma_f32_16x16x32_bf16 v[184:187], v[232:235], v[144:147], v[184:187]
    v_mfma_f32_16x16x32_bf16 v[188:191], v[232:235], v[148:151], v[188:191]
    ds_read_b128 v[224:227], v5 offset:2048
    s_waitcnt lgkmcnt(3)
    v_mfma_f32_16x16x32_bf16 v[192:195], v[236:239], v[144:147], v[192:195]
    v_mfma_f32_16x16x32_bf16 v[196:199], v[236:239], v[148:151], v[196:199]
    ds_read_b128 v[228:231], v5 offset:3072
    s_waitcnt lgkmcnt(3)
    v_mfma_f32_16x16x32_bf16 v[200:203], v[240:243], v[24:27], 0
    v_mfma_f32_16x16x32_bf16 v[204:207], v[240:243], v[28:31], 0
    ds_read_b128 v[232:235], v5 offset:4096
    s_waitcnt lgkmcnt(3)
    v_mfma_f32_16x16x32_bf16 v[208:211], v[244:247], v[24:27], 0
    v_mfma_f32_16x16x32_bf16 v[212:215], v[244:247], v[28:31], 0
    s_add_u32 s22, s21, 0x90400
    s_add_u32 m0, s20, 0x18400
    s_nop 0
    buffer_load_dwordx4 v2, s[8:11], s22 offen sc1 lds
    ds_read_b128 v[236:239], v5 offset:5120
    v_mul_f32 v184, v184, v9
    s_waitcnt lgkmcnt(3)
    v_mfma_f32_16x16x32_bf16 v[200:203], v[224:227], v[32:35], v[200:203]
    v_mul_f32 v185, v185, v9
    v_mfma_f32_16x16x32_bf16 v[204:207], v[224:227], v[36:39], v[204:207]
    ds_read_b128 v[240:243], v5 offset:6144
    v_mul_f32 v186, v186, v9
    s_waitcnt lgkmcnt(3)
    v_mfma_f32_16x16x32_bf16 v[208:211], v[228:231], v[32:35], v[208:211]
    v_mul_f32 v187, v187, v9
    v_mfma_f32_16x16x32_bf16 v[212:215], v[228:231], v[36:39], v[212:215]
    ds_read_b128 v[244:247], v5 offset:7168
    v_mul_f32 v192, v192, v9
    s_waitcnt lgkmcnt(3)
    v_mfma_f32_16x16x32_bf16 v[200:203], v[232:235], v[40:43], v[200:203]
    v_mul_f32 v193, v193, v9
    v_mfma_f32_16x16x32_bf16 v[204:207], v[232:235], v[44:47], v[204:207]
    ds_read_b128 v[224:227], v5 offset:8192
    v_mul_f32 v194, v194, v9
    s_waitcnt lgkmcnt(3)
    v_mfma_f32_16x16x32_bf16 v[208:211], v[236:239], v[40:43], v[208:211]
    v_mul_f32 v195, v195, v9
    v_mfma_f32_16x16x32_bf16 v[212:215], v[236:239], v[44:47], v[212:215]
    ds_read_b128 v[228:231], v5 offset:9216
    v_cvt_pk_bf16_f32 v216, v184, v185
    s_waitcnt lgkmcnt(3)
    v_mfma_f32_16x16x32_bf16 v[200:203], v[240:243], v[48:51], v[200:203]
    v_cvt_pk_bf16_f32 v217, v186, v187
    v_mfma_f32_16x16x32_bf16 v[204:207], v[240:243], v[52:55], v[204:207]
    ds_read_b128 v[232:235], v5 offset:10240
    v_cvt_pk_bf16_f32 v218, v192, v193
    s_waitcnt lgkmcnt(3)
    v_mfma_f32_16x16x32_bf16 v[208:211], v[244:247], v[48:51], v[208:211]
    v_cvt_pk_bf16_f32 v219, v194, v195
    v_mfma_f32_16x16x32_bf16 v[212:215], v[244:247], v[52:55], v[212:215]
    ds_read_b128 v[236:239], v5 offset:11264
    buffer_store_dwordx4 v[216:219], v2, s[8:11], s25 offen offset:0 sc1
    s_waitcnt lgkmcnt(3)
    v_mfma_f32_16x16x32_bf16 v[200:203], v[224:227], v[56:59], v[200:203]
    v_mul_f32 v188, v188, v10
    v_mfma_f32_16x16x32_bf16 v[204:207], v[224:227], v[60:63], v[204:207]
    ds_read_b128 v[240:243], v5 offset:12288
    v_mul_f32 v189, v189, v10
    s_waitcnt lgkmcnt(3)
    v_mfma_f32_16x16x32_bf16 v[208:211], v[228:231], v[56:59], v[208:211]
    v_mul_f32 v190, v190, v10
    v_mfma_f32_16x16x32_bf16 v[212:215], v[228:231], v[60:63], v[212:215]
    ds_read_b128 v[244:247], v5 offset:13312
    v_mul_f32 v191, v191, v10
    s_waitcnt lgkmcnt(3)
    v_mfma_f32_16x16x32_bf16 v[200:203], v[232:235], v[64:67], v[200:203]
    v_mul_f32 v196, v196, v10
    v_mfma_f32_16x16x32_bf16 v[204:207], v[232:235], v[68:71], v[204:207]
    ds_read_b128 v[224:227], v5 offset:14336
    v_mul_f32 v197, v197, v10
    s_waitcnt lgkmcnt(3)
    v_mfma_f32_16x16x32_bf16 v[208:211], v[236:239], v[64:67], v[208:211]
    v_mul_f32 v198, v198, v10
    v_mfma_f32_16x16x32_bf16 v[212:215], v[236:239], v[68:71], v[212:215]
    ds_read_b128 v[228:231], v5 offset:15360
    v_mul_f32 v199, v199, v10
    s_waitcnt lgkmcnt(3)
    v_mfma_f32_16x16x32_bf16 v[200:203], v[240:243], v[72:75], v[200:203]
    v_cvt_pk_bf16_f32 v220, v188, v189
    v_mfma_f32_16x16x32_bf16 v[204:207], v[240:243], v[76:79], v[204:207]
    s_waitcnt vmcnt(7)
    s_barrier
    ds_read_b128 v[232:235], v5 offset:16384
    v_cvt_pk_bf16_f32 v221, v190, v191
    s_waitcnt lgkmcnt(3)
    v_mfma_f32_16x16x32_bf16 v[208:211], v[244:247], v[72:75], v[208:211]
    v_cvt_pk_bf16_f32 v222, v196, v197
    v_mfma_f32_16x16x32_bf16 v[212:215], v[244:247], v[76:79], v[212:215]
    s_add_u32 s22, s21, 0x94000
    s_add_u32 m0, s20, 0x1c000
    s_nop 0
    buffer_load_dwordx4 v2, s[8:11], s22 offen sc1 lds
    ds_read_b128 v[236:239], v5 offset:17408
    v_cvt_pk_bf16_f32 v223, v198, v199
    s_waitcnt lgkmcnt(3)
    v_mfma_f32_16x16x32_bf16 v[200:203], v[224:227], v[80:83], v[200:203]
    buffer_store_dwordx4 v[220:223], v2, s[8:11], s26 offen offset:0 sc1
    v_mfma_f32_16x16x32_bf16 v[204:207], v[224:227], v[84:87], v[204:207]
    ds_read_b128 v[240:243], v5 offset:18432
    s_waitcnt lgkmcnt(3)
    v_mfma_f32_16x16x32_bf16 v[208:211], v[228:231], v[80:83], v[208:211]
    v_mfma_f32_16x16x32_bf16 v[212:215], v[228:231], v[84:87], v[212:215]
    ds_read_b128 v[244:247], v5 offset:19456
    s_waitcnt lgkmcnt(3)
    v_mfma_f32_16x16x32_bf16 v[200:203], v[232:235], v[88:91], v[200:203]
    v_lshrrev_b32 v20, 4, v1
    v_lshlrev_b32 v21, 4, v20
    s_lshl_b32 s16, s2, 8
    s_add_u32 s16, s16, 0x550000
    buffer_load_dwordx4 v[152:155], v21, s[8:11], s16 offen offset:0 sc1
    buffer_load_dwordx4 v[156:159], v21, s[8:11], s16 offen offset:64 sc1
    buffer_load_dwordx4 v[160:163], v21, s[8:11], s16 offen offset:128 sc1
    buffer_load_dwordx4 v[164:167], v21, s[8:11], s16 offen offset:192 sc1
    v_lshlrev_b32 v11, 11, v20
    v_xor_b32 v20, s3, v20
    v_and_b32 v20, 1, v20
    v_lshl_add_u32 v11, v20, 5, v11
    v_bfe_u32 v20, v1, 2, 2
    v_lshl_add_u32 v11, v20, 6, v11
    v_and_b32 v20, 3, v1
    v_lshl_add_u32 v11, v20, 3, v11
    s_lshr_b32 s16, s3, 1
    s_lshl_b32 s16, s16, 8
    s_add_u32 s16, s16, 65536
    v_add_u32 v11, s16, v11
    v_mfma_f32_16x16x32_bf16 v[204:207], v[232:235], v[92:95], v[204:207]
    ds_read_b128 v[224:227], v5 offset:20480
    s_waitcnt lgkmcnt(3)
    v_mfma_f32_16x16x32_bf16 v[208:211], v[236:239], v[88:91], v[208:211]
    v_mfma_f32_16x16x32_bf16 v[212:215], v[236:239], v[92:95], v[212:215]
    s_add_u32 s22, s21, 0x94400
    s_add_u32 m0, s20, 0x1c400
    s_nop 0
    buffer_load_dwordx4 v2, s[8:11], s22 offen sc1 lds
    ds_read_b128 v[228:231], v5 offset:21504
    s_waitcnt lgkmcnt(3)
    v_mfma_f32_16x16x32_bf16 v[200:203], v[240:243], v[96:99], v[200:203]
    v_mfma_f32_16x16x32_bf16 v[204:207], v[240:243], v[100:103], v[204:207]
    ds_read_b128 v[232:235], v5 offset:22528
    s_waitcnt lgkmcnt(3)
    v_mfma_f32_16x16x32_bf16 v[208:211], v[244:247], v[96:99], v[208:211]
    v_mfma_f32_16x16x32_bf16 v[212:215], v[244:247], v[100:103], v[212:215]
    ds_read_b128 v[236:239], v5 offset:23552
    s_waitcnt lgkmcnt(3)
    v_mfma_f32_16x16x32_bf16 v[200:203], v[224:227], v[104:107], v[200:203]
    v_mfma_f32_16x16x32_bf16 v[204:207], v[224:227], v[108:111], v[204:207]
    ds_read_b128 v[240:243], v5 offset:24576
    s_waitcnt lgkmcnt(3)
    v_mfma_f32_16x16x32_bf16 v[208:211], v[228:231], v[104:107], v[208:211]
    v_mfma_f32_16x16x32_bf16 v[212:215], v[228:231], v[108:111], v[212:215]
    ds_read_b128 v[244:247], v5 offset:25600
    s_waitcnt lgkmcnt(3)
    v_mfma_f32_16x16x32_bf16 v[200:203], v[232:235], v[112:115], v[200:203]
    v_mfma_f32_16x16x32_bf16 v[204:207], v[232:235], v[116:119], v[204:207]
    ds_read_b128 v[224:227], v5 offset:26624
    s_waitcnt lgkmcnt(3)
    v_mfma_f32_16x16x32_bf16 v[208:211], v[236:239], v[112:115], v[208:211]
    v_mfma_f32_16x16x32_bf16 v[212:215], v[236:239], v[116:119], v[212:215]
    ds_read_b128 v[228:231], v5 offset:27648
    s_waitcnt lgkmcnt(3)
    v_mfma_f32_16x16x32_bf16 v[200:203], v[240:243], v[120:123], v[200:203]
    v_mfma_f32_16x16x32_bf16 v[204:207], v[240:243], v[124:127], v[204:207]
    ds_read_b128 v[232:235], v5 offset:28672
    s_waitcnt lgkmcnt(3)
    v_mfma_f32_16x16x32_bf16 v[208:211], v[244:247], v[120:123], v[208:211]
    v_mfma_f32_16x16x32_bf16 v[212:215], v[244:247], v[124:127], v[212:215]
    ds_read_b128 v[236:239], v5 offset:29696
    s_waitcnt lgkmcnt(3)
    v_mfma_f32_16x16x32_bf16 v[200:203], v[224:227], v[128:131], v[200:203]
    v_mfma_f32_16x16x32_bf16 v[204:207], v[224:227], v[132:135], v[204:207]
    ds_read_b128 v[240:243], v5 offset:30720
    s_waitcnt lgkmcnt(3)
    v_mfma_f32_16x16x32_bf16 v[208:211], v[228:231], v[128:131], v[208:211]
    v_mfma_f32_16x16x32_bf16 v[212:215], v[228:231], v[132:135], v[212:215]
    ds_read_b128 v[244:247], v5 offset:31744
    s_waitcnt lgkmcnt(3)
    v_mfma_f32_16x16x32_bf16 v[200:203], v[232:235], v[136:139], v[200:203]
    s_waitcnt vmcnt(5)
    s_add_u32 s16, s63, 0x570000
    v_mov_b32 v7, s28
    v_mov_b32 v8, 0
    s_mov_b64 exec, 1
    buffer_store_dword v7, v8, s[8:11], s16 offen sc1
    s_mov_b64 exec, -1
    v_mfma_f32_16x16x32_bf16 v[204:207], v[232:235], v[140:143], v[204:207]
    s_barrier
    ds_read_b128 v[224:227], v4 offset:32768
    s_waitcnt lgkmcnt(3)
    v_mfma_f32_16x16x32_bf16 v[208:211], v[236:239], v[136:139], v[208:211]
    v_mfma_f32_16x16x32_bf16 v[212:215], v[236:239], v[140:143], v[212:215]
    s_add_u32 s22, s21, 0x98000
    s_add_u32 m0, s20, 0x20000
    s_nop 0
    buffer_load_dwordx4 v2, s[8:11], s22 offen sc1 lds
    ds_read_b128 v[228:231], v4 offset:33792
    s_waitcnt lgkmcnt(3)
    v_mfma_f32_16x16x32_bf16 v[200:203], v[240:243], v[144:147], v[200:203]
    ds_read_b64_tr_b16 v[168:169], v11 offset:0
    ds_read_b64_tr_b16 v[170:171], v11 offset:1024
    ds_read_b64_tr_b16 v[172:173], v11 offset:8192
    ds_read_b64_tr_b16 v[174:175], v11 offset:9216
    ds_read_b64_tr_b16 v[176:177], v11 offset:16384
    ds_read_b64_tr_b16 v[178:179], v11 offset:17408
    ds_read_b64_tr_b16 v[180:181], v11 offset:24576
    ds_read_b64_tr_b16 v[182:183], v11 offset:25600
    v_mfma_f32_16x16x32_bf16 v[204:207], v[240:243], v[148:151], v[204:207]
    ds_read_b128 v[232:235], v4 offset:34816
    s_waitcnt lgkmcnt(11)
    v_mfma_f32_16x16x32_bf16 v[208:211], v[244:247], v[144:147], v[208:211]
    v_mfma_f32_16x16x32_bf16 v[212:215], v[244:247], v[148:151], v[212:215]
    ds_read_b128 v[236:239], v4 offset:35840
    s_waitcnt lgkmcnt(11)
    v_mfma_f32_16x16x32_bf16 v[184:187], v[224:227], v[24:27], 0
    v_mfma_f32_16x16x32_bf16 v[188:191], v[224:227], v[28:31], 0
    ds_read_b128 v[240:243], v4 offset:36864
    s_waitcnt lgkmcnt(11)
    v_mfma_f32_16x16x32_bf16 v[192:195], v[228:231], v[24:27], 0
    v_mfma_f32_16x16x32_bf16 v[196:199], v[228:231], v[28:31], 0
    s_add_u32 s22, s21, 0x98400
    s_add_u32 m0, s20, 0x20400
    s_nop 0
    buffer_load_dwordx4 v2, s[8:11], s22 offen sc1 lds
    ds_read_b128 v[244:247], v4 offset:37888
    v_mul_f32 v200, v200, v9
    s_waitcnt lgkmcnt(3)
    v_mfma_f32_16x16x32_bf16 v[184:187], v[232:235], v[32:35], v[184:187]
    v_mul_f32 v201, v201, v9
    v_mfma_f32_16x16x32_bf16 v[188:191], v[232:235], v[36:39], v[188:191]
    ds_read_b128 v[224:227], v4 offset:38912
    v_mul_f32 v202, v202, v9
    s_waitcnt lgkmcnt(3)
    v_mfma_f32_16x16x32_bf16 v[192:195], v[236:239], v[32:35], v[192:195]
    v_mul_f32 v203, v203, v9
    s_waitcnt vmcnt(7)
    v_mfma_f32_16x16x32_bf16 v[248:251], v[168:171], v[152:155], 0
    s_waitcnt vmcnt(6)
    v_mfma_f32_16x16x32_bf16 v[248:251], v[172:175], v[156:159], v[248:251]
    s_waitcnt vmcnt(5)
    v_mfma_f32_16x16x32_bf16 v[248:251], v[176:179], v[160:163], v[248:251]
    s_waitcnt vmcnt(4)
    v_mfma_f32_16x16x32_bf16 v[248:251], v[180:183], v[164:167], v[248:251]
    v_mfma_f32_16x16x32_bf16 v[196:199], v[236:239], v[36:39], v[196:199]
    ds_read_b128 v[228:231], v4 offset:39936
    v_mul_f32 v208, v208, v9
    s_waitcnt lgkmcnt(3)
    v_mfma_f32_16x16x32_bf16 v[184:187], v[240:243], v[40:43], v[184:187]
    v_mul_f32 v209, v209, v9
    v_mfma_f32_16x16x32_bf16 v[188:191], v[240:243], v[44:47], v[188:191]
    ds_read_b128 v[232:235], v4 offset:40960
    v_mul_f32 v210, v210, v9
    s_waitcnt lgkmcnt(3)
    v_mfma_f32_16x16x32_bf16 v[192:195], v[244:247], v[40:43], v[192:195]
    v_mul_f32 v211, v211, v9
    v_mfma_f32_16x16x32_bf16 v[196:199], v[244:247], v[44:47], v[196:199]
    ds_read_b128 v[236:239], v4 offset:41984
    v_cvt_pk_bf16_f32 v216, v200, v201
    s_waitcnt lgkmcnt(3)
    v_mfma_f32_16x16x32_bf16 v[184:187], v[224:227], v[48:51], v[184:187]
    v_cvt_pk_bf16_f32 v217, v202, v203
    v_mfma_f32_16x16x32_bf16 v[188:191], v[224:227], v[52:55], v[188:191]
    ds_read_b128 v[240:243], v4 offset:43008
    v_cvt_pk_bf16_f32 v218, v208, v209
    s_waitcnt lgkmcnt(3)
    v_mfma_f32_16x16x32_bf16 v[192:195], v[228:231], v[48:51], v[192:195]
    v_cvt_pk_bf16_f32 v219, v210, v211
    v_mfma_f32_16x16x32_bf16 v[196:199], v[228:231], v[52:55], v[196:199]
    ds_read_b128 v[244:247], v4 offset:44032
    buffer_store_dwordx4 v[216:219], v2, s[8:11], s25 offen offset:1024 sc1
    s_waitcnt lgkmcnt(3)
    v_mfma_f32_16x16x32_bf16 v[184:187], v[232:235], v[56:59], v[184:187]
    v_mul_f32 v204, v204, v10
    v_mfma_f32_16x16x32_bf16 v[188:191], v[232:235], v[60:63], v[188:191]
    ds_read_b128 v[224:227], v4 offset:45056
    v_mul_f32 v205, v205, v10
    s_waitcnt lgkmcnt(3)
    v_mfma_f32_16x16x32_bf16 v[192:195], v[236:239], v[56:59], v[192:195]
    v_mul_f32 v206, v206, v10
    v_lshrrev_b32 v20, 4, v1
    v_lshlrev_b32 v20, 4, v20
    s_lshr_b32 s16, s2, 5
    s_lshl_b32 s16, s16, 14
    s_and_b32 s17, s2, 31
    s_lshl_b32 s17, s17, 9
    s_add_u32 s16, s16, s17
    s_lshl_b32 s17, s3, 6
    s_add_u32 s16, s16, s17
    s_add_u32 s16, s16, 0x580000
    s_mov_b32 exec_lo, 0x10001
    s_mov_b32 exec_hi, 0x10001
    buffer_store_dwordx4 v[248:251], v20, s[8:11], s16 offen sc1
    s_mov_b64 exec, -1
    v_mfma_f32_16x16x32_bf16 v[196:199], v[236:239], v[60:63], v[196:199]
    ds_read_b128 v[228:231], v4 offset:46080
    v_mul_f32 v207, v207, v10
    s_waitcnt lgkmcnt(3)
    v_mfma_f32_16x16x32_bf16 v[184:187], v[240:243], v[64:67], v[184:187]
    v_mul_f32 v212, v212, v10
    v_mfma_f32_16x16x32_bf16 v[188:191], v[240:243], v[68:71], v[188:191]
    ds_read_b128 v[232:235], v4 offset:47104
    v_mul_f32 v213, v213, v10
    s_waitcnt lgkmcnt(3)
    v_mfma_f32_16x16x32_bf16 v[192:195], v[244:247], v[64:67], v[192:195]
    v_mul_f32 v214, v214, v10
    v_mfma_f32_16x16x32_bf16 v[196:199], v[244:247], v[68:71], v[196:199]
    ds_read_b128 v[236:239], v4 offset:48128
    v_mul_f32 v215, v215, v10
    s_waitcnt lgkmcnt(3)
    v_mfma_f32_16x16x32_bf16 v[184:187], v[224:227], v[72:75], v[184:187]
    v_cvt_pk_bf16_f32 v220, v204, v205
    v_mfma_f32_16x16x32_bf16 v[188:191], v[224:227], v[76:79], v[188:191]
    s_waitcnt vmcnt(5)
    s_barrier
    ds_read_b128 v[240:243], v4 offset:49152
    v_cvt_pk_bf16_f32 v221, v206, v207
    s_waitcnt lgkmcnt(3)
    v_mfma_f32_16x16x32_bf16 v[192:195], v[228:231], v[72:75], v[192:195]
    v_cvt_pk_bf16_f32 v222, v212, v213
    v_mfma_f32_16x16x32_bf16 v[196:199], v[228:231], v[76:79], v[196:199]
    s_add_u32 s22, s21, 0x9c000
    s_add_u32 m0, s20, 0x24000
    s_nop 0
    buffer_load_dwordx4 v2, s[8:11], s22 offen sc1 lds
    ds_read_b128 v[244:247], v4 offset:50176
    v_cvt_pk_bf16_f32 v223, v214, v215
    s_waitcnt lgkmcnt(3)
    v_mfma_f32_16x16x32_bf16 v[184:187], v[232:235], v[80:83], v[184:187]
    buffer_store_dwordx4 v[220:223], v2, s[8:11], s26 offen offset:1024 sc1
    v_mfma_f32_16x16x32_bf16 v[188:191], v[232:235], v[84:87], v[188:191]
    ds_read_b128 v[224:227], v4 offset:51200
    s_waitcnt lgkmcnt(3)
    v_mfma_f32_16x16x32_bf16 v[192:195], v[236:239], v[80:83], v[192:195]
    v_mfma_f32_16x16x32_bf16 v[196:199], v[236:239], v[84:87], v[196:199]
    s_add_u32 s22, s21, 0x9c400
    s_add_u32 m0, s20, 0x24400
    s_nop 0
    buffer_load_dwordx4 v2, s[8:11], s22 offen sc1 lds
    ds_read_b128 v[228:231], v4 offset:52224
    s_waitcnt lgkmcnt(3)
    v_mfma_f32_16x16x32_bf16 v[184:187], v[240:243], v[88:91], v[184:187]
    v_mfma_f32_16x16x32_bf16 v[188:191], v[240:243], v[92:95], v[188:191]
    ds_read_b128 v[232:235], v4 offset:53248
    s_waitcnt lgkmcnt(3)
    v_mfma_f32_16x16x32_bf16 v[192:195], v[244:247], v[88:91], v[192:195]
    v_mfma_f32_16x16x32_bf16 v[196:199], v[244:247], v[92:95], v[196:199]
    s_add_u32 s22, s24, 0x0
    s_add_u32 m0, s20, 0x10000
    s_nop 0
    buffer_load_dwordx4 v3, s[4:7], s22 offen lds
    ds_read_b128 v[236:239], v4 offset:54272
    s_waitcnt lgkmcnt(3)
    v_mfma_f32_16x16x32_bf16 v[184:187], v[224:227], v[96:99], v[184:187]
    v_mfma_f32_16x16x32_bf16 v[188:191], v[224:227], v[100:103], v[188:191]
    ds_read_b128 v[240:243], v4 offset:55296
    s_waitcnt lgkmcnt(3)
    v_mfma_f32_16x16x32_bf16 v[192:195], v[228:231], v[96:99], v[192:195]
    v_mfma_f32_16x16x32_bf16 v[196:199], v[228:231], v[100:103], v[196:199]
    s_add_u32 s22, s24, 0x2000
    s_add_u32 m0, s20, 0x10400
    s_nop 0
    buffer_load_dwordx4 v3, s[4:7], s22 offen lds
    ds_read_b128 v[244:247], v4 offset:56320
    s_waitcnt lgkmcnt(3)
    v_mfma_f32_16x16x32_bf16 v[184:187], v[232:235], v[104:107], v[184:187]
    v_mfma_f32_16x16x32_bf16 v[188:191], v[232:235], v[108:111], v[188:191]
    ds_read_b128 v[224:227], v4 offset:57344
    s_waitcnt lgkmcnt(3)
    v_mfma_f32_16x16x32_bf16 v[192:195], v[236:239], v[104:107], v[192:195]
    v_mfma_f32_16x16x32_bf16 v[196:199], v[236:239], v[108:111], v[196:199]
    ds_read_b128 v[228:231], v4 offset:58368
    s_waitcnt lgkmcnt(3)
    v_mfma_f32_16x16x32_bf16 v[184:187], v[240:243], v[112:115], v[184:187]
    v_mfma_f32_16x16x32_bf16 v[188:191], v[240:243], v[116:119], v[188:191]
    ds_read_b128 v[232:235], v4 offset:59392
    s_waitcnt lgkmcnt(3)
    v_mfma_f32_16x16x32_bf16 v[192:195], v[244:247], v[112:115], v[192:195]
    v_mfma_f32_16x16x32_bf16 v[196:199], v[244:247], v[116:119], v[196:199]
    ds_read_b128 v[236:239], v4 offset:60416
    s_waitcnt lgkmcnt(3)
    v_mfma_f32_16x16x32_bf16 v[184:187], v[224:227], v[120:123], v[184:187]
    v_mfma_f32_16x16x32_bf16 v[188:191], v[224:227], v[124:127], v[188:191]
    ds_read_b128 v[240:243], v4 offset:61440
    s_waitcnt lgkmcnt(3)
    v_mfma_f32_16x16x32_bf16 v[192:195], v[228:231], v[120:123], v[192:195]
    v_mfma_f32_16x16x32_bf16 v[196:199], v[228:231], v[124:127], v[196:199]
    ds_read_b128 v[244:247], v4 offset:62464
    s_waitcnt lgkmcnt(3)
    v_mfma_f32_16x16x32_bf16 v[184:187], v[232:235], v[128:131], v[184:187]
    v_mfma_f32_16x16x32_bf16 v[188:191], v[232:235], v[132:135], v[188:191]
    ds_read_b128 v[224:227], v4 offset:63488
    s_waitcnt lgkmcnt(3)
    v_mfma_f32_16x16x32_bf16 v[192:195], v[236:239], v[128:131], v[192:195]
    v_mfma_f32_16x16x32_bf16 v[196:199], v[236:239], v[132:135], v[196:199]
    ds_read_b128 v[228:231], v4 offset:64512
    s_waitcnt lgkmcnt(3)
    v_mfma_f32_16x16x32_bf16 v[184:187], v[240:243], v[136:139], v[184:187]
    v_mfma_f32_16x16x32_bf16 v[188:191], v[240:243], v[140:143], v[188:191]
    s_waitcnt vmcnt(7)
    s_barrier
    ds_read_b128 v[232:235], v5 offset:0
    s_waitcnt lgkmcnt(3)
    v_mfma_f32_16x16x32_bf16 v[192:195], v[244:247], v[136:139], v[192:195]
    v_mfma_f32_16x16x32_bf16 v[196:199], v[244:247], v[140:143], v[196:199]
    s_add_u32 s22, s24, 0x80000
    s_add_u32 m0, s20, 0x14000
    s_nop 0
    buffer_load_dwordx4 v3, s[4:7], s22 offen lds
    ds_read_b128 v[236:239], v5 offset:1024
    s_waitcnt lgkmcnt(3)
    v_mfma_f32_16x16x32_bf16 v[184:187], v[224:227], v[144:147], v[184:187]
    v_mfma_f32_16x16x32_bf16 v[188:191], v[224:227], v[148:151], v[188:191]
    ds_read_b128 v[240:243], v5 offset:2048
    s_waitcnt lgkmcnt(3)
    v_mfma_f32_16x16x32_bf16 v[192:195], v[228:231], v[144:147], v[192:195]
    v_mfma_f32_16x16x32_bf16 v[196:199], v[228:231], v[148:151], v[196:199]
    s_add_u32 s22, s24, 0x82000
    s_add_u32 m0, s20, 0x14400
    s_nop 0
    buffer_load_dwordx4 v3, s[4:7], s22 offen lds
    ds_read_b128 v[244:247], v5 offset:3072
    s_waitcnt lgkmcnt(3)
    v_mfma_f32_16x16x32_bf16 v[200:203], v[232:235], v[24:27], 0
    v_mfma_f32_16x16x32_bf16 v[204:207], v[232:235], v[28:31], 0
    ds_read_b128 v[224:227], v5 offset:4096
    s_waitcnt lgkmcnt(3)
    v_mfma_f32_16x16x32_bf16 v[208:211], v[236:239], v[24:27], 0
    v_mfma_f32_16x16x32_bf16 v[212:215], v[236:239], v[28:31], 0
    s_add_u32 s22, s24, 0x100000
    s_add_u32 m0, s20, 0x18000
    s_nop 0
    buffer_load_dwordx4 v3, s[4:7], s22 offen lds
    ds_read_b128 v[228:231], v5 offset:5120
    v_mul_f32 v184, v184, v9
    s_waitcnt lgkmcnt(3)
    v_mfma_f32_16x16x32_bf16 v[200:203], v[240:243], v[32:35], v[200:203]
    v_mul_f32 v185, v185, v9
    v_mfma_f32_16x16x32_bf16 v[204:207], v[240:243], v[36:39], v[204:207]
    ds_read_b128 v[232:235], v5 offset:6144
    v_mul_f32 v186, v186, v9
    s_waitcnt lgkmcnt(3)
    v_mfma_f32_16x16x32_bf16 v[208:211], v[244:247], v[32:35], v[208:211]
    v_mul_f32 v187, v187, v9
    v_mfma_f32_16x16x32_bf16 v[212:215], v[244:247], v[36:39], v[212:215]
    s_add_u32 s22, s24, 0x102000
    s_add_u32 m0, s20, 0x18400
    s_nop 0
    buffer_load_dwordx4 v3, s[4:7], s22 offen lds
    ds_read_b128 v[236:239], v5 offset:7168
    v_mul_f32 v192, v192, v9
    s_waitcnt lgkmcnt(3)
    v_mfma_f32_16x16x32_bf16 v[200:203], v[224:227], v[40:43], v[200:203]
    v_mul_f32 v193, v193, v9
    v_mfma_f32_16x16x32_bf16 v[204:207], v[224:227], v[44:47], v[204:207]
    ds_read_b128 v[240:243], v5 offset:8192
    v_mul_f32 v194, v194, v9
    s_waitcnt lgkmcnt(3)
    v_mfma_f32_16x16x32_bf16 v[208:211], v[228:231], v[40:43], v[208:211]
    v_mul_f32 v195, v195, v9
    v_mfma_f32_16x16x32_bf16 v[212:215], v[228:231], v[44:47], v[212:215]
    ds_read_b128 v[244:247], v5 offset:9216
    v_cvt_pk_bf16_f32 v216, v184, v185
    s_waitcnt lgkmcnt(3)
    v_mfma_f32_16x16x32_bf16 v[200:203], v[232:235], v[48:51], v[200:203]
    v_cvt_pk_bf16_f32 v217, v186, v187
    v_mfma_f32_16x16x32_bf16 v[204:207], v[232:235], v[52:55], v[204:207]
    ds_read_b128 v[224:227], v5 offset:10240
    v_cvt_pk_bf16_f32 v218, v192, v193
    s_waitcnt lgkmcnt(3)
    v_mfma_f32_16x16x32_bf16 v[208:211], v[236:239], v[48:51], v[208:211]
    v_cvt_pk_bf16_f32 v219, v194, v195
    v_mfma_f32_16x16x32_bf16 v[212:215], v[236:239], v[52:55], v[212:215]
    ds_read_b128 v[228:231], v5 offset:11264
    buffer_store_dwordx4 v[216:219], v2, s[8:11], s25 offen offset:2048 sc1
    s_waitcnt lgkmcnt(3)
    v_mfma_f32_16x16x32_bf16 v[200:203], v[240:243], v[56:59], v[200:203]
    v_mul_f32 v188, v188, v10
    v_mfma_f32_16x16x32_bf16 v[204:207], v[240:243], v[60:63], v[204:207]
    ds_read_b128 v[232:235], v5 offset:12288
    v_mul_f32 v189, v189, v10
    s_waitcnt lgkmcnt(3)
    v_mfma_f32_16x16x32_bf16 v[208:211], v[244:247], v[56:59], v[208:211]
    v_mul_f32 v190, v190, v10
    v_mfma_f32_16x16x32_bf16 v[212:215], v[244:247], v[60:63], v[212:215]
    ds_read_b128 v[236:239], v5 offset:13312
    v_mul_f32 v191, v191, v10
    s_waitcnt lgkmcnt(3)
    v_mfma_f32_16x16x32_bf16 v[200:203], v[224:227], v[64:67], v[200:203]
    v_mul_f32 v196, v196, v10
    s_waitcnt vmcnt(10)
    s_bfe_u32 s30, s2, 0x20001
    s_lshl_b32 s30, s30, 2
    s_bfe_u32 s17, s2, 0x20003
    s_add_u32 s30, s30, s17
    s_lshr_b32 s31, s2, 5
    s_and_b32 s17, s3, 3
    s_lshl_b32 s19, s30, 2
    s_add_u32 s19, s19, s17
    s_and_b32 s16, s2, 1
    s_lshl_b32 s17, s19, 18
    s_lshl_b32 s23, s16, 16
    s_add_u32 s17, s17, s23
    s_add_u32 s17, s17, 0x1000000
    v_add_u32 v6, s17, v2
    s_lshl_b32 s19, s19, 7
    s_lshl_b32 s23, s16, 6
    s_add_u32 s19, s19, s23
    s_add_u32 s19, s19, 0x570000
    v_and_b32 v13, 15, v1
    v_lshlrev_b32 v13, 2, v13
    buffer_load_dword v12, v13, s[8:11], s19 offen sc1
    v_mfma_f32_16x16x32_bf16 v[204:207], v[224:227], v[68:71], v[204:207]
    ds_read_b128 v[240:243], v5 offset:14336
    v_mul_f32 v197, v197, v10
    s_waitcnt lgkmcnt(3)
    v_mfma_f32_16x16x32_bf16 v[208:211], v[228:231], v[64:67], v[208:211]
    v_mul_f32 v198, v198, v10
    v_mfma_f32_16x16x32_bf16 v[212:215], v[228:231], v[68:71], v[212:215]
    ds_read_b128 v[244:247], v5 offset:15360
    v_mul_f32 v199, v199, v10
    s_waitcnt lgkmcnt(3)
    v_mfma_f32_16x16x32_bf16 v[200:203], v[232:235], v[72:75], v[200:203]
    v_cvt_pk_bf16_f32 v220, v188, v189
    v_mfma_f32_16x16x32_bf16 v[204:207], v[232:235], v[76:79], v[204:207]
    s_waitcnt vmcnt(8)
    s_barrier
    ds_read_b128 v[224:227], v5 offset:16384
    v_cvt_pk_bf16_f32 v221, v190, v191
    s_waitcnt lgkmcnt(3)
    v_mfma_f32_16x16x32_bf16 v[208:211], v[236:239], v[72:75], v[208:211]
    v_cvt_pk_bf16_f32 v222, v196, v197
    v_mfma_f32_16x16x32_bf16 v[212:215], v[236:239], v[76:79], v[212:215]
    s_add_u32 s22, s24, 0x180000
    s_add_u32 m0, s20, 0x1c000
    s_nop 0
    buffer_load_dwordx4 v3, s[4:7], s22 offen lds
    ds_read_b128 v[228:231], v5 offset:17408
    v_cvt_pk_bf16_f32 v223, v198, v199
    v_mov_b32 v20, s28
    v_mov_b32 v21, 0
    s_lshl_b32 s16, s2, 2
    s_add_u32 s16, s16, 0x560000
    s_cmp_eq_u32 s3, 0
    s_cselect_b32 s16, s16, 0x7ffffff0
    s_mov_b64 exec, 1
    buffer_store_dword v20, v21, s[8:11], s16 offen sc1
    s_mov_b64 exec, -1
    s_waitcnt lgkmcnt(3)
    v_mfma_f32_16x16x32_bf16 v[200:203], v[240:243], v[80:83], v[200:203]
    buffer_store_dwordx4 v[220:223], v2, s[8:11], s26 offen offset:2048 sc1
    s_add_u32 s16, s63, 0x572000
    v_mov_b32 v14, s28
    v_mov_b32 v15, 0
    s_mov_b64 exec, 1
    buffer_store_dword v14, v15, s[8:11], s16 offen sc1
    s_mov_b64 exec, -1
    v_mfma_f32_16x16x32_bf16 v[204:207], v[240:243], v[84:87], v[204:207]
    ds_read_b128 v[232:235], v5 offset:18432
    s_waitcnt lgkmcnt(3)
    v_mfma_f32_16x16x32_bf16 v[208:211], v[244:247], v[80:83], v[208:211]
    v_mfma_f32_16x16x32_bf16 v[212:215], v[244:247], v[84:87], v[212:215]
    ds_read_b128 v[236:239], v5 offset:19456
    s_waitcnt lgkmcnt(3)
    v_mfma_f32_16x16x32_bf16 v[200:203], v[224:227], v[88:91], v[200:203]
    v_mfma_f32_16x16x32_bf16 v[204:207], v[224:227], v[92:95], v[204:207]
    ds_read_b128 v[240:243], v5 offset:20480
    s_waitcnt lgkmcnt(3)
    v_mfma_f32_16x16x32_bf16 v[208:211], v[228:231], v[88:91], v[208:211]
    v_mfma_f32_16x16x32_bf16 v[212:215], v[228:231], v[92:95], v[212:215]
    s_add_u32 s22, s24, 0x182000
    s_add_u32 m0, s20, 0x1c400
    s_nop 0
    buffer_load_dwordx4 v3, s[4:7], s22 offen lds
    ds_read_b128 v[244:247], v5 offset:21504
    s_waitcnt lgkmcnt(3)
    v_mfma_f32_16x16x32_bf16 v[200:203], v[232:235], v[96:99], v[200:203]
    v_mfma_f32_16x16x32_bf16 v[204:207], v[232:235], v[100:103], v[204:207]
    ds_read_b128 v[224:227], v5 offset:22528
    s_waitcnt lgkmcnt(3)
    v_mfma_f32_16x16x32_bf16 v[208:211], v[236:239], v[96:99], v[208:211]
    v_mfma_f32_16x16x32_bf16 v[212:215], v[236:239], v[100:103], v[212:215]
    ds_read_b128 v[228:231], v5 offset:23552
    s_waitcnt lgkmcnt(3)
    v_mfma_f32_16x16x32_bf16 v[200:203], v[240:243], v[104:107], v[200:203]
    s_waitcnt vmcnt(5)
    v_cmp_ne_u32 vcc, s28, v12
    s_cbranch_vccnz adaLN_cond__sliding_block_cached__moe_arch_mod__prompt_kernel_o5r
adaLN_cond__sliding_block_cached__moe_arch_mod__prompt_kernel_o5b:
    v_mfma_f32_16x16x32_bf16 v[204:207], v[240:243], v[108:111], v[204:207]
    ds_read_b128 v[232:235], v5 offset:24576
    s_mov_b32 s23, 0x0
    buffer_load_dwordx4 v[24:27], v6, s[8:11], s23 offen offset:0 sc1
    s_waitcnt lgkmcnt(3)
    v_mfma_f32_16x16x32_bf16 v[208:211], v[244:247], v[104:107], v[208:211]
    v_mfma_f32_16x16x32_bf16 v[212:215], v[244:247], v[108:111], v[212:215]
    ds_read_b128 v[236:239], v5 offset:25600
    s_mov_b32 s23, 0x20000
    buffer_load_dwordx4 v[28:31], v6, s[8:11], s23 offen offset:0 sc1
    s_waitcnt lgkmcnt(3)
    v_mfma_f32_16x16x32_bf16 v[200:203], v[224:227], v[112:115], v[200:203]
    v_mfma_f32_16x16x32_bf16 v[204:207], v[224:227], v[116:119], v[204:207]
    ds_read_b128 v[240:243], v5 offset:26624
    s_waitcnt lgkmcnt(3)
    v_mfma_f32_16x16x32_bf16 v[208:211], v[228:231], v[112:115], v[208:211]
    s_mov_b32 s23, 0x2000
    buffer_load_dwordx4 v[32:35], v6, s[8:11], s23 offen offset:0 sc1
    v_mfma_f32_16x16x32_bf16 v[212:215], v[228:231], v[116:119], v[212:215]
    ds_read_b128 v[244:247], v5 offset:27648
    s_waitcnt lgkmcnt(3)
    v_mfma_f32_16x16x32_bf16 v[200:203], v[232:235], v[120:123], v[200:203]
    v_mfma_f32_16x16x32_bf16 v[204:207], v[232:235], v[124:127], v[204:207]
    ds_read_b128 v[224:227], v5 offset:28672
    s_mov_b32 s23, 0x22000
    buffer_load_dwordx4 v[36:39], v6, s[8:11], s23 offen offset:0 sc1
    s_waitcnt lgkmcnt(3)
    v_mfma_f32_16x16x32_bf16 v[208:211], v[236:239], v[120:123], v[208:211]
    v_mfma_f32_16x16x32_bf16 v[212:215], v[236:239], v[124:127], v[212:215]
    ds_read_b128 v[228:231], v5 offset:29696
    s_waitcnt lgkmcnt(3)
    v_mfma_f32_16x16x32_bf16 v[200:203], v[240:243], v[128:131], v[200:203]
    s_mov_b32 s23, 0x4000
    buffer_load_dwordx4 v[40:43], v6, s[8:11], s23 offen offset:0 sc1
    v_mfma_f32_16x16x32_bf16 v[204:207], v[240:243], v[132:135], v[204:207]
    ds_read_b128 v[232:235], v5 offset:30720
    s_waitcnt lgkmcnt(3)
    v_mfma_f32_16x16x32_bf16 v[208:211], v[244:247], v[128:131], v[208:211]
    v_mfma_f32_16x16x32_bf16 v[212:215], v[244:247], v[132:135], v[212:215]
    ds_read_b128 v[236:239], v5 offset:31744
    s_mov_b32 s23, 0x24000
    buffer_load_dwordx4 v[44:47], v6, s[8:11], s23 offen offset:0 sc1
    s_waitcnt lgkmcnt(3)
    v_mfma_f32_16x16x32_bf16 v[200:203], v[224:227], v[136:139], v[200:203]
    v_bfe_u32 v18, v1, 2, 2
    v_lshrrev_b32 v19, 4, v1
    v_mfma_f32_16x16x32_bf16 v[204:207], v[224:227], v[140:143], v[204:207]
    v_and_b32 v17, 3, v1
    v_lshlrev_b32 v16, 11, v19
    s_waitcnt lgkmcnt(2)
    v_mfma_f32_16x16x32_bf16 v[208:211], v[228:231], v[136:139], v[208:211]
    s_mov_b32 s23, 0x6000
    buffer_load_dwordx4 v[48:51], v6, s[8:11], s23 offen offset:0 sc1
    v_lshl_add_u32 v16, v18, 6, v16
    v_lshl_add_u32 v16, v17, 3, v16
    v_mfma_f32_16x16x32_bf16 v[212:215], v[228:231], v[140:143], v[212:215]
    v_add_u32 v16, 0x10000, v16
    v_and_b32 v19, 1, v19
    s_waitcnt lgkmcnt(1)
    v_mfma_f32_16x16x32_bf16 v[200:203], v[232:235], v[144:147], v[200:203]
    v_lshlrev_b32 v19, 5, v19
    v_sub_u32 v5, v16, v19
    v_mfma_f32_16x16x32_bf16 v[204:207], v[232:235], v[148:151], v[204:207]
    s_mov_b32 s23, 0x26000
    buffer_load_dwordx4 v[52:55], v6, s[8:11], s23 offen offset:0 sc1
    v_add_u32 v4, v16, v19
    v_add_u32 v7, 0x10000, v4
    s_waitcnt lgkmcnt(0)
    v_mfma_f32_16x16x32_bf16 v[208:211], v[236:239], v[144:147], v[208:211]
    v_add_u32 v8, 0x10000, v5
    v_mfma_f32_16x16x32_bf16 v[212:215], v[236:239], v[148:151], v[212:215]
    s_mov_b32 s23, 0x8000
    buffer_load_dwordx4 v[56:59], v6, s[8:11], s23 offen offset:0 sc1
    s_mov_b32 s23, 0x28000
    buffer_load_dwordx4 v[60:63], v6, s[8:11], s23 offen offset:0 sc1
    v_mul_f32 v200, v200, v9
    v_mul_f32 v201, v201, v9
    v_mul_f32 v202, v202, v9
    v_mul_f32 v203, v203, v9
    v_mul_f32 v208, v208, v9
    v_mul_f32 v209, v209, v9
    v_mul_f32 v210, v210, v9
    v_mul_f32 v211, v211, v9
    v_cvt_pk_bf16_f32 v216, v200, v201
    v_cvt_pk_bf16_f32 v217, v202, v203
    v_cvt_pk_bf16_f32 v218, v208, v209
    v_cvt_pk_bf16_f32 v219, v210, v211
    buffer_store_dwordx4 v[216:219], v2, s[8:11], s25 offen offset:3072 sc1
    v_mul_f32 v204, v204, v10
    v_mul_f32 v205, v205, v10
    v_mul_f32 v206, v206, v10
    v_mul_f32 v207, v207, v10
    v_mul_f32 v212, v212, v10
    v_mul_f32 v213, v213, v10
    v_mul_f32 v214, v214, v10
    v_mul_f32 v215, v215, v10
    v_cvt_pk_bf16_f32 v220, v204, v205
    v_cvt_pk_bf16_f32 v221, v206, v207
    v_cvt_pk_bf16_f32 v222, v212, v213
    v_cvt_pk_bf16_f32 v223, v214, v215
    buffer_store_dwordx4 v[220:223], v2, s[8:11], s26 offen offset:3072 sc1
    s_and_b32 s15, s2, 1
    s_barrier
    ds_read_b64_tr_b16 v[224:225], v4 offset:0
    ds_read_b64_tr_b16 v[226:227], v4 offset:1024
    ds_read_b64_tr_b16 v[228:229], v5 offset:32
    ds_read_b64_tr_b16 v[230:231], v5 offset:1056
    ds_read_b64_tr_b16 v[232:233], v4 offset:256
    ds_read_b64_tr_b16 v[234:235], v4 offset:1280
    ds_read_b64_tr_b16 v[236:237], v5 offset:288
    ds_read_b64_tr_b16 v[238:239], v5 offset:1312
    s_waitcnt vmcnt(11) lgkmcnt(6)
    v_mfma_f32_16x16x32_bf16 v[88:91], v[224:227], v[24:27], 0
    ds_read_b64_tr_b16 v[240:241], v4 offset:512
    s_waitcnt vmcnt(10)
    v_mfma_f32_16x16x32_bf16 v[92:95], v[224:227], v[28:31], 0
    s_add_u32 s22, s24, 0x200000
    s_add_u32 m0, s20, 0x20000
    s_nop 0
    buffer_load_dwordx4 v3, s[4:7], s22 offen lds
    ds_read_b64_tr_b16 v[242:243], v4 offset:1536
    s_waitcnt lgkmcnt(6)
    v_mfma_f32_16x16x32_bf16 v[96:99], v[228:231], v[24:27], 0
    ds_read_b64_tr_b16 v[244:245], v5 offset:544
    s_mov_b32 s23, 0xa000
    buffer_load_dwordx4 v[64:67], v6, s[8:11], s23 offen offset:0 sc1
    v_mfma_f32_16x16x32_bf16 v[100:103], v[228:231], v[28:31], 0
    ds_read_b64_tr_b16 v[246:247], v5 offset:1568
    s_waitcnt lgkmcnt(6)
    v_mfma_f32_16x16x32_bf16 v[104:107], v[232:235], v[24:27], 0
    s_add_u32 s22, s24, 0x202000
    s_add_u32 m0, s20, 0x20400
    s_nop 0
    buffer_load_dwordx4 v3, s[4:7], s22 offen lds
    ds_read_b64_tr_b16 v[224:225], v4 offset:768
    v_mfma_f32_16x16x32_bf16 v[108:111], v[232:235], v[28:31], 0
    ds_read_b64_tr_b16 v[226:227], v4 offset:1792
    s_mov_b32 s23, 0x2a000
    buffer_load_dwordx4 v[68:71], v6, s[8:11], s23 offen offset:0 sc1
    s_waitcnt lgkmcnt(6)
    v_mfma_f32_16x16x32_bf16 v[112:115], v[236:239], v[24:27], 0
    ds_read_b64_tr_b16 v[228:229], v5 offset:800
    v_mfma_f32_16x16x32_bf16 v[116:119], v[236:239], v[28:31], 0
    ds_read_b64_tr_b16 v[230:231], v5 offset:1824
    s_waitcnt lgkmcnt(6)
    v_mfma_f32_16x16x32_bf16 v[120:123], v[240:243], v[24:27], 0
    v_mfma_f32_16x16x32_bf16 v[124:127], v[240:243], v[28:31], 0
    s_barrier
    ds_read_b64_tr_b16 v[232:233], v4 offset:16384
    ds_read_b64_tr_b16 v[234:235], v4 offset:17408
    s_waitcnt lgkmcnt(6)
    v_mfma_f32_16x16x32_bf16 v[128:131], v[244:247], v[24:27], 0
    s_add_u32 s22, s24, 0x280000
    s_add_u32 m0, s20, 0x24000
    s_nop 0
    buffer_load_dwordx4 v3, s[4:7], s22 offen lds
    ds_read_b64_tr_b16 v[236:237], v5 offset:16416
    v_mfma_f32_16x16x32_bf16 v[132:135], v[244:247], v[28:31], 0
    ds_read_b64_tr_b16 v[238:239], v5 offset:17440
    s_waitcnt lgkmcnt(6)
    v_mfma_f32_16x16x32_bf16 v[136:139], v[224:227], v[24:27], 0
    ds_read_b64_tr_b16 v[240:241], v4 offset:16640
    v_mfma_f32_16x16x32_bf16 v[140:143], v[224:227], v[28:31], 0
    s_add_u32 s22, s24, 0x282000
    s_add_u32 m0, s20, 0x24400
    s_nop 0
    buffer_load_dwordx4 v3, s[4:7], s22 offen lds
    ds_read_b64_tr_b16 v[242:243], v4 offset:17664
    s_waitcnt lgkmcnt(6)
    v_mfma_f32_16x16x32_bf16 v[144:147], v[228:231], v[24:27], 0
    ds_read_b64_tr_b16 v[244:245], v5 offset:16672
    v_mfma_f32_16x16x32_bf16 v[148:151], v[228:231], v[28:31], 0
    ds_read_b64_tr_b16 v[246:247], v5 offset:17696
    s_waitcnt vmcnt(15) lgkmcnt(6)
    v_mfma_f32_16x16x32_bf16 v[88:91], v[232:235], v[32:35], v[88:91]
    ds_read_b64_tr_b16 v[224:225], v4 offset:16896
    s_waitcnt vmcnt(14)
    v_mfma_f32_16x16x32_bf16 v[92:95], v[232:235], v[36:39], v[92:95]
    ds_read_b64_tr_b16 v[226:227], v4 offset:17920
    s_waitcnt lgkmcnt(6)
    v_mfma_f32_16x16x32_bf16 v[96:99], v[236:239], v[32:35], v[96:99]
    ds_read_b64_tr_b16 v[228:229], v5 offset:16928
    s_mov_b32 s23, 0xc000
    buffer_load_dwordx4 v[24:27], v6, s[8:11], s23 offen offset:0 sc1
    v_mfma_f32_16x16x32_bf16 v[100:103], v[236:239], v[36:39], v[100:103]
    ds_read_b64_tr_b16 v[230:231], v5 offset:17952
    s_waitcnt lgkmcnt(6)
    v_mfma_f32_16x16x32_bf16 v[104:107], v[240:243], v[32:35], v[104:107]
    v_and_b32 v250, 7, v1
    v_lshlrev_b32 v250, 7, v250
    s_lshr_b32 s14, s2, 3
    s_lshl_b32 s14, s14, 2
    s_add_u32 s14, s14, 0x560000
    buffer_load_dword v248, v250, s[8:11], s14 offen sc1
    ds_read_b64_tr_b16 v[232:233], v4 offset:17152
    v_mfma_f32_16x16x32_bf16 v[108:111], v[240:243], v[36:39], v[108:111]
    ds_read_b64_tr_b16 v[234:235], v4 offset:18176
    s_mov_b32 s23, 0x2c000
    buffer_load_dwordx4 v[28:31], v6, s[8:11], s23 offen offset:0 sc1
    s_waitcnt lgkmcnt(6)
    v_mfma_f32_16x16x32_bf16 v[112:115], v[244:247], v[32:35], v[112:115]
    ds_read_b64_tr_b16 v[236:237], v5 offset:17184
    v_mfma_f32_16x16x32_bf16 v[116:119], v[244:247], v[36:39], v[116:119]
    ds_read_b64_tr_b16 v[238:239], v5 offset:18208
    s_waitcnt lgkmcnt(6)
    v_mfma_f32_16x16x32_bf16 v[120:123], v[224:227], v[32:35], v[120:123]
    v_mfma_f32_16x16x32_bf16 v[124:127], v[224:227], v[36:39], v[124:127]
    s_barrier
    ds_read_b64_tr_b16 v[240:241], v4 offset:32768
    ds_read_b64_tr_b16 v[242:243], v4 offset:33792
    s_add_u32 s19, s19, 8192
    buffer_load_dword v12, v13, s[8:11], s19 offen sc1
    s_waitcnt lgkmcnt(6)
    v_mfma_f32_16x16x32_bf16 v[128:131], v[228:231], v[32:35], v[128:131]
    s_add_u32 s22, s24, 0x300000
    s_add_u32 m0, s20, 0x10000
    s_nop 0
    buffer_load_dwordx4 v3, s[4:7], s22 offen lds
    ds_read_b64_tr_b16 v[244:245], v5 offset:32800
    v_mfma_f32_16x16x32_bf16 v[132:135], v[228:231], v[36:39], v[132:135]
    ds_read_b64_tr_b16 v[246:247], v5 offset:33824
    s_waitcnt lgkmcnt(6)
    v_mfma_f32_16x16x32_bf16 v[136:139], v[232:235], v[32:35], v[136:139]
    ds_read_b64_tr_b16 v[224:225], v4 offset:33024
    v_mfma_f32_16x16x32_bf16 v[140:143], v[232:235], v[36:39], v[140:143]
    s_add_u32 s22, s24, 0x302000
    s_add_u32 m0, s20, 0x10400
    s_nop 0
    buffer_load_dwordx4 v3, s[4:7], s22 offen lds
    ds_read_b64_tr_b16 v[226:227], v4 offset:34048
    s_waitcnt lgkmcnt(6)
    v_mfma_f32_16x16x32_bf16 v[144:147], v[236:239], v[32:35], v[144:147]
    s_add_u32 s16, s63, 0x574000
    v_mov_b32 v14, s28
    v_mov_b32 v15, 0
    s_mov_b64 exec, 1
    buffer_store_dword v14, v15, s[8:11], s16 offen sc1
    s_mov_b64 exec, -1
    ds_read_b64_tr_b16 v[228:229], v5 offset:33056
    v_mfma_f32_16x16x32_bf16 v[148:151], v[236:239], v[36:39], v[148:151]
    ds_read_b64_tr_b16 v[230:231], v5 offset:34080
    s_waitcnt vmcnt(20) lgkmcnt(6)
    v_mfma_f32_16x16x32_bf16 v[88:91], v[240:243], v[40:43], v[88:91]
    ds_read_b64_tr_b16 v[232:233], v4 offset:33280
    s_waitcnt vmcnt(19)
    v_mfma_f32_16x16x32_bf16 v[92:95], v[240:243], v[44:47], v[92:95]
    ds_read_b64_tr_b16 v[234:235], v4 offset:34304
    s_waitcnt lgkmcnt(6)
    v_mfma_f32_16x16x32_bf16 v[96:99], v[244:247], v[40:43], v[96:99]
    ds_read_b64_tr_b16 v[236:237], v5 offset:33312
    s_mov_b32 s23, 0xe000
    buffer_load_dwordx4 v[32:35], v6, s[8:11], s23 offen offset:0 sc1
    v_mfma_f32_16x16x32_bf16 v[100:103], v[244:247], v[44:47], v[100:103]
    ds_read_b64_tr_b16 v[238:239], v5 offset:34336
    s_waitcnt lgkmcnt(6)
    v_mfma_f32_16x16x32_bf16 v[104:107], v[224:227], v[40:43], v[104:107]
    ds_read_b64_tr_b16 v[240:241], v4 offset:33536
    v_mfma_f32_16x16x32_bf16 v[108:111], v[224:227], v[44:47], v[108:111]
    ds_read_b64_tr_b16 v[242:243], v4 offset:34560
    s_mov_b32 s23, 0x2e000
    buffer_load_dwordx4 v[36:39], v6, s[8:11], s23 offen offset:0 sc1
    s_waitcnt lgkmcnt(6)
    v_mfma_f32_16x16x32_bf16 v[112:115], v[228:231], v[40:43], v[112:115]
    ds_read_b64_tr_b16 v[244:245], v5 offset:33568
    v_mfma_f32_16x16x32_bf16 v[116:119], v[228:231], v[44:47], v[116:119]
    ds_read_b64_tr_b16 v[246:247], v5 offset:34592
    s_waitcnt lgkmcnt(6)
    v_mfma_f32_16x16x32_bf16 v[120:123], v[232:235], v[40:43], v[120:123]
    v_mfma_f32_16x16x32_bf16 v[124:127], v[232:235], v[44:47], v[124:127]
    s_barrier
    ds_read_b64_tr_b16 v[224:225], v4 offset:49152
    ds_read_b64_tr_b16 v[226:227], v4 offset:50176
    s_waitcnt lgkmcnt(6)
    v_mfma_f32_16x16x32_bf16 v[128:131], v[236:239], v[40:43], v[128:131]
    s_add_u32 s22, s24, 0x380000
    s_add_u32 m0, s20, 0x14000
    s_nop 0
    buffer_load_dwordx4 v3, s[4:7], s22 offen lds
    ds_read_b64_tr_b16 v[228:229], v5 offset:49184
    v_mfma_f32_16x16x32_bf16 v[132:135], v[236:239], v[44:47], v[132:135]
    ds_read_b64_tr_b16 v[230:231], v5 offset:50208
    s_waitcnt lgkmcnt(6)
    v_mfma_f32_16x16x32_bf16 v[136:139], v[240:243], v[40:43], v[136:139]
    ds_read_b64_tr_b16 v[232:233], v4 offset:49408
    v_mfma_f32_16x16x32_bf16 v[140:143], v[240:243], v[44:47], v[140:143]
    s_add_u32 s22, s24, 0x382000
    s_add_u32 m0, s20, 0x14400
    s_nop 0
    buffer_load_dwordx4 v3, s[4:7], s22 offen lds
    ds_read_b64_tr_b16 v[234:235], v4 offset:50432
    s_waitcnt lgkmcnt(6)
    v_mfma_f32_16x16x32_bf16 v[144:147], v[244:247], v[40:43], v[144:147]
    ds_read_b64_tr_b16 v[236:237], v5 offset:49440
    v_mfma_f32_16x16x32_bf16 v[148:151], v[244:247], v[44:47], v[148:151]
    ds_read_b64_tr_b16 v[238:239], v5 offset:50464
    s_waitcnt vmcnt(7)
    v_cmp_ne_u32 vcc, s28, v12
    s_cbranch_vccnz adaLN_cond__sliding_block_cached__moe_arch_mod__prompt_kernel_o26r
adaLN_cond__sliding_block_cached__moe_arch_mod__prompt_kernel_o26b:
    s_waitcnt lgkmcnt(6)
    v_mfma_f32_16x16x32_bf16 v[88:91], v[224:227], v[48:51], v[88:91]
    ds_read_b64_tr_b16 v[240:241], v4 offset:49664
    v_mfma_f32_16x16x32_bf16 v[92:95], v[224:227], v[52:55], v[92:95]
    ds_read_b64_tr_b16 v[242:243], v4 offset:50688
    s_waitcnt lgkmcnt(6)
    v_mfma_f32_16x16x32_bf16 v[96:99], v[228:231], v[48:51], v[96:99]
    ds_read_b64_tr_b16 v[244:245], v5 offset:49696
    s_mov_b32 s23, 0x0
    buffer_load_dwordx4 v[40:43], v6, s[8:11], s23 offen offset:1024 sc1
    v_mfma_f32_16x16x32_bf16 v[100:103], v[228:231], v[52:55], v[100:103]
    ds_read_b64_tr_b16 v[246:247], v5 offset:50720
    s_waitcnt lgkmcnt(6)
    v_mfma_f32_16x16x32_bf16 v[104:107], v[232:235], v[48:51], v[104:107]
    ds_read_b64_tr_b16 v[224:225], v4 offset:49920
    v_mfma_f32_16x16x32_bf16 v[108:111], v[232:235], v[52:55], v[108:111]
    ds_read_b64_tr_b16 v[226:227], v4 offset:50944
    s_mov_b32 s23, 0x20000
    buffer_load_dwordx4 v[44:47], v6, s[8:11], s23 offen offset:1024 sc1
    s_waitcnt lgkmcnt(6)
    v_mfma_f32_16x16x32_bf16 v[112:115], v[236:239], v[48:51], v[112:115]
    ds_read_b64_tr_b16 v[228:229], v5 offset:49952
    v_mfma_f32_16x16x32_bf16 v[116:119], v[236:239], v[52:55], v[116:119]
    ds_read_b64_tr_b16 v[230:231], v5 offset:50976
    s_waitcnt lgkmcnt(6)
    v_mfma_f32_16x16x32_bf16 v[120:123], v[240:243], v[48:51], v[120:123]
    v_mfma_f32_16x16x32_bf16 v[124:127], v[240:243], v[52:55], v[124:127]
    s_barrier
    ds_read_b64_tr_b16 v[232:233], v7 offset:0
    ds_read_b64_tr_b16 v[234:235], v7 offset:1024
    s_waitcnt lgkmcnt(6)
    v_mfma_f32_16x16x32_bf16 v[128:131], v[244:247], v[48:51], v[128:131]
    s_add_u32 s22, s24, 0x10000
    s_add_u32 m0, s20, 0x18000
    s_nop 0
    buffer_load_dwordx4 v3, s[4:7], s22 offen lds
    ds_read_b64_tr_b16 v[236:237], v8 offset:32
    v_mfma_f32_16x16x32_bf16 v[132:135], v[244:247], v[52:55], v[132:135]
    ds_read_b64_tr_b16 v[238:239], v8 offset:1056
    s_waitcnt lgkmcnt(6)
    v_mfma_f32_16x16x32_bf16 v[136:139], v[224:227], v[48:51], v[136:139]
    v_cmp_ne_u32 vcc, s28, v248
    s_cbranch_vccnz adaLN_cond__sliding_block_cached__moe_arch_mod__prompt_kernel_mp7r
adaLN_cond__sliding_block_cached__moe_arch_mod__prompt_kernel_mp7b:
    ds_read_b64_tr_b16 v[240:241], v7 offset:256
    v_mfma_f32_16x16x32_bf16 v[140:143], v[224:227], v[52:55], v[140:143]
    v_lshrrev_b32 v250, 4, v1
    v_lshlrev_b32 v250, 14, v250
    v_and_b32 v253, 15, v1
    v_lshl_add_u32 v250, v253, 2, v250
    s_lshl_b32 s14, s2, 6
    s_add_u32 s14, s14, 0x580000
    buffer_load_dword v249, v250, s[8:11], s14 offen sc1
    s_add_u32 s14, s14, 0x10000
    buffer_load_dword v254, v250, s[8:11], s14 offen sc1
    s_add_u32 s22, s24, 0x12000
    s_add_u32 m0, s20, 0x18400
    s_nop 0
    buffer_load_dwordx4 v3, s[4:7], s22 offen lds
    ds_read_b64_tr_b16 v[242:243], v7 offset:1280
    s_waitcnt lgkmcnt(6)
    v_mfma_f32_16x16x32_bf16 v[144:147], v[228:231], v[48:51], v[144:147]
    ds_read_b64_tr_b16 v[244:245], v8 offset:288
    v_mfma_f32_16x16x32_bf16 v[148:151], v[228:231], v[52:55], v[148:151]
    ds_read_b64_tr_b16 v[246:247], v8 offset:1312
    s_waitcnt lgkmcnt(6)
    v_mfma_f32_16x16x32_bf16 v[88:91], v[232:235], v[56:59], v[88:91]
    ds_read_b64_tr_b16 v[224:225], v7 offset:512
    v_mfma_f32_16x16x32_bf16 v[92:95], v[232:235], v[60:63], v[92:95]
    ds_read_b64_tr_b16 v[226:227], v7 offset:1536
    s_waitcnt lgkmcnt(6)
    v_mfma_f32_16x16x32_bf16 v[96:99], v[236:239], v[56:59], v[96:99]
    ds_read_b64_tr_b16 v[228:229], v8 offset:544
    s_mov_b32 s23, 0x2000
    buffer_load_dwordx4 v[48:51], v6, s[8:11], s23 offen offset:1024 sc1
    v_mfma_f32_16x16x32_bf16 v[100:103], v[236:239], v[60:63], v[100:103]
    ds_read_b64_tr_b16 v[230:231], v8 offset:1568
    s_waitcnt lgkmcnt(6)
    v_mfma_f32_16x16x32_bf16 v[104:107], v[240:243], v[56:59], v[104:107]
    ds_read_b64_tr_b16 v[232:233], v7 offset:768
    v_mfma_f32_16x16x32_bf16 v[108:111], v[240:243], v[60:63], v[108:111]
    ds_read_b64_tr_b16 v[234:235], v7 offset:1792
    s_mov_b32 s23, 0x22000
    buffer_load_dwordx4 v[52:55], v6, s[8:11], s23 offen offset:1024 sc1
    s_waitcnt lgkmcnt(6)
    v_mfma_f32_16x16x32_bf16 v[112:115], v[244:247], v[56:59], v[112:115]
    ds_read_b64_tr_b16 v[236:237], v8 offset:800
    v_mfma_f32_16x16x32_bf16 v[116:119], v[244:247], v[60:63], v[116:119]
    ds_read_b64_tr_b16 v[238:239], v8 offset:1824
    s_waitcnt lgkmcnt(6)
    v_mfma_f32_16x16x32_bf16 v[120:123], v[224:227], v[56:59], v[120:123]
    v_mfma_f32_16x16x32_bf16 v[124:127], v[224:227], v[60:63], v[124:127]
    s_barrier
    ds_read_b64_tr_b16 v[240:241], v7 offset:16384
    ds_read_b64_tr_b16 v[242:243], v7 offset:17408
    s_waitcnt lgkmcnt(6)
    v_mfma_f32_16x16x32_bf16 v[128:131], v[228:231], v[56:59], v[128:131]
    s_add_u32 s22, s24, 0x90000
    s_add_u32 m0, s20, 0x1c000
    s_nop 0
    buffer_load_dwordx4 v3, s[4:7], s22 offen lds
    ds_read_b64_tr_b16 v[244:245], v8 offset:16416
    v_mfma_f32_16x16x32_bf16 v[132:135], v[228:231], v[60:63], v[132:135]
    ds_read_b64_tr_b16 v[246:247], v8 offset:17440
    s_waitcnt lgkmcnt(6)
    v_mfma_f32_16x16x32_bf16 v[136:139], v[232:235], v[56:59], v[136:139]
    ds_read_b64_tr_b16 v[224:225], v7 offset:16640
    v_mfma_f32_16x16x32_bf16 v[140:143], v[232:235], v[60:63], v[140:143]
    s_add_u32 s22, s24, 0x92000
    s_add_u32 m0, s20, 0x1c400
    s_nop 0
    buffer_load_dwordx4 v3, s[4:7], s22 offen lds
    ds_read_b64_tr_b16 v[226:227], v7 offset:17664
    s_waitcnt lgkmcnt(6)
    v_mfma_f32_16x16x32_bf16 v[144:147], v[236:239], v[56:59], v[144:147]
    ds_read_b64_tr_b16 v[228:229], v8 offset:16672
    v_mfma_f32_16x16x32_bf16 v[148:151], v[236:239], v[60:63], v[148:151]
    ds_read_b64_tr_b16 v[230:231], v8 offset:17696
    s_waitcnt lgkmcnt(6)
    v_mfma_f32_16x16x32_bf16 v[88:91], v[240:243], v[64:67], v[88:91]
    ds_read_b64_tr_b16 v[232:233], v7 offset:16896
    v_mfma_f32_16x16x32_bf16 v[92:95], v[240:243], v[68:71], v[92:95]
    ds_read_b64_tr_b16 v[234:235], v7 offset:17920
    s_waitcnt lgkmcnt(6)
    v_mfma_f32_16x16x32_bf16 v[96:99], v[244:247], v[64:67], v[96:99]
    ds_read_b64_tr_b16 v[236:237], v8 offset:16928
    s_mov_b32 s23, 0x4000
    buffer_load_dwordx4 v[56:59], v6, s[8:11], s23 offen offset:1024 sc1
    v_mfma_f32_16x16x32_bf16 v[100:103], v[244:247], v[68:71], v[100:103]
    ds_read_b64_tr_b16 v[238:239], v8 offset:17952
    s_waitcnt lgkmcnt(6)
    v_mfma_f32_16x16x32_bf16 v[104:107], v[224:227], v[64:67], v[104:107]
    s_waitcnt vmcnt(6)
    v_add_f32 v249, v249, v254
    v_mov_b32 v250, v249
    s_nop 1
    v_permlane16_swap_b32 v249, v250
    v_add_f32 v249, v249, v250
    v_mov_b32 v250, v249
    s_nop 1
    v_permlane32_swap_b32 v249, v250
    v_add_f32 v249, v249, v250
    v_cvt_pk_bf16_f32 v249, v249, v249
    v_lshlrev_b32 v249, 16, v249
    s_lshr_b32 s14, s2, 6
    s_cmp_eq_u32 s14, 2
    s_cselect_b32 s14, 1.0, 0
    v_add_f32 v249, s14, v249
    v_cvt_pk_bf16_f32 v249, v249, v249
    v_lshlrev_b32 v253, 1, v253
    s_lshl_b32 s14, s2, 5
    s_add_u32 s14, s14, 0x540000
    s_cmp_eq_u32 s3, 0
    s_cselect_b32 s14, s14, 0x7ffffff0
    s_mov_b64 exec, 0xffff
    buffer_store_short v249, v253, s[8:11], s14 offen sc1
    s_mov_b64 exec, -1
    ds_read_b64_tr_b16 v[240:241], v7 offset:17152
    v_mfma_f32_16x16x32_bf16 v[108:111], v[224:227], v[68:71], v[108:111]
    ds_read_b64_tr_b16 v[242:243], v7 offset:18176
    s_mov_b32 s23, 0x24000
    buffer_load_dwordx4 v[60:63], v6, s[8:11], s23 offen offset:1024 sc1
    s_waitcnt lgkmcnt(6)
    v_mfma_f32_16x16x32_bf16 v[112:115], v[228:231], v[64:67], v[112:115]
    ds_read_b64_tr_b16 v[244:245], v8 offset:17184
    v_mfma_f32_16x16x32_bf16 v[116:119], v[228:231], v[68:71], v[116:119]
    ds_read_b64_tr_b16 v[246:247], v8 offset:18208
    s_waitcnt lgkmcnt(6)
    v_mfma_f32_16x16x32_bf16 v[120:123], v[232:235], v[64:67], v[120:123]
    v_mfma_f32_16x16x32_bf16 v[124:127], v[232:235], v[68:71], v[124:127]
    s_barrier
    ds_read_b64_tr_b16 v[224:225], v4 offset:0
    ds_read_b64_tr_b16 v[226:227], v4 offset:1024
    s_waitcnt lgkmcnt(6)
    v_mfma_f32_16x16x32_bf16 v[128:131], v[236:239], v[64:67], v[128:131]
    s_add_u32 s16, s63, 0x576000
    v_mov_b32 v14, s28
    v_mov_b32 v15, 0
    s_mov_b64 exec, 1
    buffer_store_dword v14, v15, s[8:11], s16 offen sc1
    s_mov_b64 exec, -1
    s_add_u32 s22, s24, 0x110000
    s_add_u32 m0, s20, 0x20000
    s_nop 0
    buffer_load_dwordx4 v3, s[4:7], s22 offen lds
    ds_read_b64_tr_b16 v[228:229], v5 offset:32
    v_mfma_f32_16x16x32_bf16 v[132:135], v[236:239], v[68:71], v[132:135]
    ds_read_b64_tr_b16 v[230:231], v5 offset:1056
    s_waitcnt lgkmcnt(6)
    v_mfma_f32_16x16x32_bf16 v[136:139], v[240:243], v[64:67], v[136:139]
    ds_read_b64_tr_b16 v[232:233], v4 offset:256
    v_mfma_f32_16x16x32_bf16 v[140:143], v[240:243], v[68:71], v[140:143]
    s_add_u32 s22, s24, 0x112000
    s_add_u32 m0, s20, 0x20400
    s_nop 0
    buffer_load_dwordx4 v3, s[4:7], s22 offen lds
    ds_read_b64_tr_b16 v[234:235], v4 offset:1280
    s_waitcnt lgkmcnt(6)
    v_mfma_f32_16x16x32_bf16 v[144:147], v[244:247], v[64:67], v[144:147]
    ds_read_b64_tr_b16 v[236:237], v5 offset:288
    v_mfma_f32_16x16x32_bf16 v[148:151], v[244:247], v[68:71], v[148:151]
    ds_read_b64_tr_b16 v[238:239], v5 offset:1312
    s_waitcnt lgkmcnt(6)
    v_mfma_f32_16x16x32_bf16 v[88:91], v[224:227], v[24:27], v[88:91]
    ds_read_b64_tr_b16 v[240:241], v4 offset:512
    v_mfma_f32_16x16x32_bf16 v[92:95], v[224:227], v[28:31], v[92:95]
    ds_read_b64_tr_b16 v[242:243], v4 offset:1536
    s_waitcnt lgkmcnt(6)
    v_mfma_f32_16x16x32_bf16 v[96:99], v[228:231], v[24:27], v[96:99]
    ds_read_b64_tr_b16 v[244:245], v5 offset:544
    s_mov_b32 s23, 0x6000
    buffer_load_dwordx4 v[64:67], v6, s[8:11], s23 offen offset:1024 sc1
    v_mfma_f32_16x16x32_bf16 v[100:103], v[228:231], v[28:31], v[100:103]
    ds_read_b64_tr_b16 v[246:247], v5 offset:1568
    s_waitcnt lgkmcnt(6)
    v_mfma_f32_16x16x32_bf16 v[104:107], v[232:235], v[24:27], v[104:107]
    ds_read_b64_tr_b16 v[224:225], v4 offset:768
    v_mfma_f32_16x16x32_bf16 v[108:111], v[232:235], v[28:31], v[108:111]
    ds_read_b64_tr_b16 v[226:227], v4 offset:1792
    s_mov_b32 s23, 0x26000
    buffer_load_dwordx4 v[68:71], v6, s[8:11], s23 offen offset:1024 sc1
    s_waitcnt lgkmcnt(6)
    v_mfma_f32_16x16x32_bf16 v[112:115], v[236:239], v[24:27], v[112:115]
    ds_read_b64_tr_b16 v[228:229], v5 offset:800
    v_mfma_f32_16x16x32_bf16 v[116:119], v[236:239], v[28:31], v[116:119]
    ds_read_b64_tr_b16 v[230:231], v5 offset:1824
    s_waitcnt lgkmcnt(6)
    v_mfma_f32_16x16x32_bf16 v[120:123], v[240:243], v[24:27], v[120:123]
    v_mfma_f32_16x16x32_bf16 v[124:127], v[240:243], v[28:31], v[124:127]
    s_barrier
    ds_read_b64_tr_b16 v[232:233], v4 offset:16384
    ds_read_b64_tr_b16 v[234:235], v4 offset:17408
    s_waitcnt lgkmcnt(6)
    v_mfma_f32_16x16x32_bf16 v[128:131], v[244:247], v[24:27], v[128:131]
    s_add_u32 s22, s24, 0x190000
    s_add_u32 m0, s20, 0x24000
    s_nop 0
    buffer_load_dwordx4 v3, s[4:7], s22 offen lds
    ds_read_b64_tr_b16 v[236:237], v5 offset:16416
    v_mfma_f32_16x16x32_bf16 v[132:135], v[244:247], v[28:31], v[132:135]
    ds_read_b64_tr_b16 v[238:239], v5 offset:17440
    s_waitcnt lgkmcnt(6)
    v_mfma_f32_16x16x32_bf16 v[136:139], v[224:227], v[24:27], v[136:139]
    ds_read_b64_tr_b16 v[240:241], v4 offset:16640
    v_mfma_f32_16x16x32_bf16 v[140:143], v[224:227], v[28:31], v[140:143]
    s_add_u32 s22, s24, 0x192000
    s_add_u32 m0, s20, 0x24400
    s_nop 0
    buffer_load_dwordx4 v3, s[4:7], s22 offen lds
    ds_read_b64_tr_b16 v[242:243], v4 offset:17664
    s_waitcnt lgkmcnt(6)
    v_mfma_f32_16x16x32_bf16 v[144:147], v[228:231], v[24:27], v[144:147]
    ds_read_b64_tr_b16 v[244:245], v5 offset:16672
    v_mfma_f32_16x16x32_bf16 v[148:151], v[228:231], v[28:31], v[148:151]
    ds_read_b64_tr_b16 v[246:247], v5 offset:17696
    s_waitcnt lgkmcnt(6)
    v_mfma_f32_16x16x32_bf16 v[88:91], v[232:235], v[32:35], v[88:91]
    ds_read_b64_tr_b16 v[224:225], v4 offset:16896
    v_mfma_f32_16x16x32_bf16 v[92:95], v[232:235], v[36:39], v[92:95]
    ds_read_b64_tr_b16 v[226:227], v4 offset:17920
    s_waitcnt lgkmcnt(6)
    v_mfma_f32_16x16x32_bf16 v[96:99], v[236:239], v[32:35], v[96:99]
    ds_read_b64_tr_b16 v[228:229], v5 offset:16928
    s_mov_b32 s23, 0x8000
    buffer_load_dwordx4 v[24:27], v6, s[8:11], s23 offen offset:1024 sc1
    v_mfma_f32_16x16x32_bf16 v[100:103], v[236:239], v[36:39], v[100:103]
    ds_read_b64_tr_b16 v[230:231], v5 offset:17952
    s_waitcnt lgkmcnt(6)
    v_mfma_f32_16x16x32_bf16 v[104:107], v[240:243], v[32:35], v[104:107]
    ds_read_b64_tr_b16 v[232:233], v4 offset:17152
    v_mfma_f32_16x16x32_bf16 v[108:111], v[240:243], v[36:39], v[108:111]
    ds_read_b64_tr_b16 v[234:235], v4 offset:18176
    s_mov_b32 s23, 0x28000
    buffer_load_dwordx4 v[28:31], v6, s[8:11], s23 offen offset:1024 sc1
    s_waitcnt lgkmcnt(6)
    v_mfma_f32_16x16x32_bf16 v[112:115], v[244:247], v[32:35], v[112:115]
    ds_read_b64_tr_b16 v[236:237], v5 offset:17184
    v_mfma_f32_16x16x32_bf16 v[116:119], v[244:247], v[36:39], v[116:119]
    ds_read_b64_tr_b16 v[238:239], v5 offset:18208
    s_waitcnt lgkmcnt(6)
    v_mfma_f32_16x16x32_bf16 v[120:123], v[224:227], v[32:35], v[120:123]
    v_mfma_f32_16x16x32_bf16 v[124:127], v[224:227], v[36:39], v[124:127]
    s_waitcnt vmcnt(16)
    s_barrier
    ds_read_b64_tr_b16 v[240:241], v4 offset:32768
    ds_read_b64_tr_b16 v[242:243], v4 offset:33792
    s_waitcnt lgkmcnt(6)
    v_mfma_f32_16x16x32_bf16 v[128:131], v[228:231], v[32:35], v[128:131]
    s_add_u32 s22, s24, 0x210000
    s_add_u32 m0, s20, 0x10000
    s_nop 0
    buffer_load_dwordx4 v3, s[4:7], s22 offen lds
    ds_read_b64_tr_b16 v[244:245], v5 offset:32800
    v_mfma_f32_16x16x32_bf16 v[132:135], v[228:231], v[36:39], v[132:135]
    ds_read_b64_tr_b16 v[246:247], v5 offset:33824
    s_waitcnt lgkmcnt(6)
    v_mfma_f32_16x16x32_bf16 v[136:139], v[232:235], v[32:35], v[136:139]
    ds_read_b64_tr_b16 v[224:225], v4 offset:33024
    v_mfma_f32_16x16x32_bf16 v[140:143], v[232:235], v[36:39], v[140:143]
    s_add_u32 s22, s24, 0x212000
    s_add_u32 m0, s20, 0x10400
    s_nop 0
    buffer_load_dwordx4 v3, s[4:7], s22 offen lds
    ds_read_b64_tr_b16 v[226:227], v4 offset:34048
    s_waitcnt lgkmcnt(6)
    v_mfma_f32_16x16x32_bf16 v[144:147], v[236:239], v[32:35], v[144:147]
    ds_read_b64_tr_b16 v[228:229], v5 offset:33056
    v_mfma_f32_16x16x32_bf16 v[148:151], v[236:239], v[36:39], v[148:151]
    ds_read_b64_tr_b16 v[230:231], v5 offset:34080
    s_waitcnt lgkmcnt(6)
    v_mfma_f32_16x16x32_bf16 v[88:91], v[240:243], v[40:43], v[88:91]
    ds_read_b64_tr_b16 v[232:233], v4 offset:33280
    v_mfma_f32_16x16x32_bf16 v[92:95], v[240:243], v[44:47], v[92:95]
    ds_read_b64_tr_b16 v[234:235], v4 offset:34304
    s_waitcnt lgkmcnt(6)
    v_mfma_f32_16x16x32_bf16 v[96:99], v[244:247], v[40:43], v[96:99]
    ds_read_b64_tr_b16 v[236:237], v5 offset:33312
    s_mov_b32 s23, 0xa000
    buffer_load_dwordx4 v[32:35], v6, s[8:11], s23 offen offset:1024 sc1
    v_mfma_f32_16x16x32_bf16 v[100:103], v[244:247], v[44:47], v[100:103]
    ds_read_b64_tr_b16 v[238:239], v5 offset:34336
    s_waitcnt lgkmcnt(6)
    v_mfma_f32_16x16x32_bf16 v[104:107], v[224:227], v[40:43], v[104:107]
    ds_read_b64_tr_b16 v[240:241], v4 offset:33536
    v_mfma_f32_16x16x32_bf16 v[108:111], v[224:227], v[44:47], v[108:111]
    ds_read_b64_tr_b16 v[242:243], v4 offset:34560
    s_mov_b32 s23, 0x2a000
    buffer_load_dwordx4 v[36:39], v6, s[8:11], s23 offen offset:1024 sc1
    s_waitcnt lgkmcnt(6)
    v_mfma_f32_16x16x32_bf16 v[112:115], v[228:231], v[40:43], v[112:115]
    ds_read_b64_tr_b16 v[244:245], v5 offset:33568
    v_mfma_f32_16x16x32_bf16 v[116:119], v[228:231], v[44:47], v[116:119]
    ds_read_b64_tr_b16 v[246:247], v5 offset:34592
    s_waitcnt lgkmcnt(6)
    v_mfma_f32_16x16x32_bf16 v[120:123], v[232:235], v[40:43], v[120:123]
    v_mfma_f32_16x16x32_bf16 v[124:127], v[232:235], v[44:47], v[124:127]
    s_waitcnt vmcnt(16)
    s_barrier
    ds_read_b64_tr_b16 v[224:225], v4 offset:49152
    ds_read_b64_tr_b16 v[226:227], v4 offset:50176
    s_waitcnt lgkmcnt(6)
    v_mfma_f32_16x16x32_bf16 v[128:131], v[236:239], v[40:43], v[128:131]
    s_add_u32 s22, s24, 0x290000
    s_add_u32 m0, s20, 0x14000
    s_nop 0
    buffer_load_dwordx4 v3, s[4:7], s22 offen lds
    ds_read_b64_tr_b16 v[228:229], v5 offset:49184
    v_mfma_f32_16x16x32_bf16 v[132:135], v[236:239], v[44:47], v[132:135]
    ds_read_b64_tr_b16 v[230:231], v5 offset:50208
    s_waitcnt lgkmcnt(6)
    v_mfma_f32_16x16x32_bf16 v[136:139], v[240:243], v[40:43], v[136:139]
    ds_read_b64_tr_b16 v[232:233], v4 offset:49408
    v_mfma_f32_16x16x32_bf16 v[140:143], v[240:243], v[44:47], v[140:143]
    s_add_u32 s22, s24, 0x292000
    s_add_u32 m0, s20, 0x14400
    s_nop 0
    buffer_load_dwordx4 v3, s[4:7], s22 offen lds
    ds_read_b64_tr_b16 v[234:235], v4 offset:50432
    s_waitcnt lgkmcnt(6)
    v_mfma_f32_16x16x32_bf16 v[144:147], v[244:247], v[40:43], v[144:147]
    ds_read_b64_tr_b16 v[236:237], v5 offset:49440
    v_mfma_f32_16x16x32_bf16 v[148:151], v[244:247], v[44:47], v[148:151]
    ds_read_b64_tr_b16 v[238:239], v5 offset:50464
    s_waitcnt lgkmcnt(6)
    v_mfma_f32_16x16x32_bf16 v[88:91], v[224:227], v[48:51], v[88:91]
    ds_read_b64_tr_b16 v[240:241], v4 offset:49664
    v_mfma_f32_16x16x32_bf16 v[92:95], v[224:227], v[52:55], v[92:95]
    ds_read_b64_tr_b16 v[242:243], v4 offset:50688
    s_waitcnt lgkmcnt(6)
    v_mfma_f32_16x16x32_bf16 v[96:99], v[228:231], v[48:51], v[96:99]
    ds_read_b64_tr_b16 v[244:245], v5 offset:49696
    s_mov_b32 s23, 0xc000
    buffer_load_dwordx4 v[40:43], v6, s[8:11], s23 offen offset:1024 sc1
    v_mfma_f32_16x16x32_bf16 v[100:103], v[228:231], v[52:55], v[100:103]
    ds_read_b64_tr_b16 v[246:247], v5 offset:50720
    s_waitcnt lgkmcnt(6)
    v_mfma_f32_16x16x32_bf16 v[104:107], v[232:235], v[48:51], v[104:107]
    ds_read_b64_tr_b16 v[224:225], v4 offset:49920
    v_mfma_f32_16x16x32_bf16 v[108:111], v[232:235], v[52:55], v[108:111]
    ds_read_b64_tr_b16 v[226:227], v4 offset:50944
    s_mov_b32 s23, 0x2c000
    buffer_load_dwordx4 v[44:47], v6, s[8:11], s23 offen offset:1024 sc1
    s_waitcnt lgkmcnt(6)
    v_mfma_f32_16x16x32_bf16 v[112:115], v[236:239], v[48:51], v[112:115]
    ds_read_b64_tr_b16 v[228:229], v5 offset:49952
    v_mfma_f32_16x16x32_bf16 v[116:119], v[236:239], v[52:55], v[116:119]
    ds_read_b64_tr_b16 v[230:231], v5 offset:50976
    s_waitcnt lgkmcnt(6)
    v_mfma_f32_16x16x32_bf16 v[120:123], v[240:243], v[48:51], v[120:123]
    v_mfma_f32_16x16x32_bf16 v[124:127], v[240:243], v[52:55], v[124:127]
    s_waitcnt vmcnt(14)
    s_barrier
    ds_read_b64_tr_b16 v[232:233], v7 offset:0
    ds_read_b64_tr_b16 v[234:235], v7 offset:1024
    s_add_u32 s19, s19, 8192
    buffer_load_dword v12, v13, s[8:11], s19 offen sc1
    s_waitcnt lgkmcnt(6)
    v_mfma_f32_16x16x32_bf16 v[128:131], v[244:247], v[48:51], v[128:131]
    s_add_u32 s22, s24, 0x310000
    s_add_u32 m0, s20, 0x18000
    s_nop 0
    buffer_load_dwordx4 v3, s[4:7], s22 offen lds
    ds_read_b64_tr_b16 v[236:237], v8 offset:32
    v_mfma_f32_16x16x32_bf16 v[132:135], v[244:247], v[52:55], v[132:135]
    ds_read_b64_tr_b16 v[238:239], v8 offset:1056
    s_waitcnt lgkmcnt(6)
    v_mfma_f32_16x16x32_bf16 v[136:139], v[224:227], v[48:51], v[136:139]
    ds_read_b64_tr_b16 v[240:241], v7 offset:256
    v_mfma_f32_16x16x32_bf16 v[140:143], v[224:227], v[52:55], v[140:143]
    s_add_u32 s22, s24, 0x312000
    s_add_u32 m0, s20, 0x18400
    s_nop 0
    buffer_load_dwordx4 v3, s[4:7], s22 offen lds
    ds_read_b64_tr_b16 v[242:243], v7 offset:1280
    s_waitcnt lgkmcnt(6)
    v_mfma_f32_16x16x32_bf16 v[144:147], v[228:231], v[48:51], v[144:147]
    ds_read_b64_tr_b16 v[244:245], v8 offset:288
    v_mfma_f32_16x16x32_bf16 v[148:151], v[228:231], v[52:55], v[148:151]
    ds_read_b64_tr_b16 v[246:247], v8 offset:1312
    s_waitcnt lgkmcnt(6)
    v_mfma_f32_16x16x32_bf16 v[88:91], v[232:235], v[56:59], v[88:91]
    ds_read_b64_tr_b16 v[224:225], v7 offset:512
    v_mfma_f32_16x16x32_bf16 v[92:95], v[232:235], v[60:63], v[92:95]
    ds_read_b64_tr_b16 v[226:227], v7 offset:1536
    s_waitcnt lgkmcnt(6)
    v_mfma_f32_16x16x32_bf16 v[96:99], v[236:239], v[56:59], v[96:99]
    ds_read_b64_tr_b16 v[228:229], v8 offset:544
    s_mov_b32 s23, 0xe000
    buffer_load_dwordx4 v[48:51], v6, s[8:11], s23 offen offset:1024 sc1
    v_mfma_f32_16x16x32_bf16 v[100:103], v[236:239], v[60:63], v[100:103]
    ds_read_b64_tr_b16 v[230:231], v8 offset:1568
    s_waitcnt lgkmcnt(6)
    v_mfma_f32_16x16x32_bf16 v[104:107], v[240:243], v[56:59], v[104:107]
    ds_read_b64_tr_b16 v[232:233], v7 offset:768
    v_mfma_f32_16x16x32_bf16 v[108:111], v[240:243], v[60:63], v[108:111]
    ds_read_b64_tr_b16 v[234:235], v7 offset:1792
    s_mov_b32 s23, 0x2e000
    buffer_load_dwordx4 v[52:55], v6, s[8:11], s23 offen offset:1024 sc1
    s_waitcnt lgkmcnt(6)
    v_mfma_f32_16x16x32_bf16 v[112:115], v[244:247], v[56:59], v[112:115]
    ds_read_b64_tr_b16 v[236:237], v8 offset:800
    v_mfma_f32_16x16x32_bf16 v[116:119], v[244:247], v[60:63], v[116:119]
    ds_read_b64_tr_b16 v[238:239], v8 offset:1824
    s_waitcnt lgkmcnt(6)
    v_mfma_f32_16x16x32_bf16 v[120:123], v[224:227], v[56:59], v[120:123]
    v_mfma_f32_16x16x32_bf16 v[124:127], v[224:227], v[60:63], v[124:127]
    s_waitcnt vmcnt(15)
    s_barrier
    ds_read_b64_tr_b16 v[240:241], v7 offset:16384
    ds_read_b64_tr_b16 v[242:243], v7 offset:17408
    s_waitcnt lgkmcnt(6)
    v_mfma_f32_16x16x32_bf16 v[128:131], v[228:231], v[56:59], v[128:131]
    s_add_u32 s22, s24, 0x390000
    s_add_u32 m0, s20, 0x1c000
    s_nop 0
    buffer_load_dwordx4 v3, s[4:7], s22 offen lds
    ds_read_b64_tr_b16 v[244:245], v8 offset:16416
    v_mfma_f32_16x16x32_bf16 v[132:135], v[228:231], v[60:63], v[132:135]
    ds_read_b64_tr_b16 v[246:247], v8 offset:17440
    s_waitcnt lgkmcnt(6)
    v_mfma_f32_16x16x32_bf16 v[136:139], v[232:235], v[56:59], v[136:139]
    ds_read_b64_tr_b16 v[224:225], v7 offset:16640
    v_mfma_f32_16x16x32_bf16 v[140:143], v[232:235], v[60:63], v[140:143]
    s_add_u32 s22, s24, 0x392000
    s_add_u32 m0, s20, 0x1c400
    s_nop 0
    buffer_load_dwordx4 v3, s[4:7], s22 offen lds
    ds_read_b64_tr_b16 v[226:227], v7 offset:17664
    s_waitcnt lgkmcnt(6)
    v_mfma_f32_16x16x32_bf16 v[144:147], v[236:239], v[56:59], v[144:147]
    ds_read_b64_tr_b16 v[228:229], v8 offset:16672
    v_mfma_f32_16x16x32_bf16 v[148:151], v[236:239], v[60:63], v[148:151]
    ds_read_b64_tr_b16 v[230:231], v8 offset:17696
    s_waitcnt vmcnt(6)
    v_cmp_ne_u32 vcc, s28, v12
    s_cbranch_vccnz adaLN_cond__sliding_block_cached__moe_arch_mod__prompt_kernel_o28r
adaLN_cond__sliding_block_cached__moe_arch_mod__prompt_kernel_o28b:
    s_waitcnt lgkmcnt(6)
    v_mfma_f32_16x16x32_bf16 v[88:91], v[240:243], v[64:67], v[88:91]
    ds_read_b64_tr_b16 v[232:233], v7 offset:16896
    v_mfma_f32_16x16x32_bf16 v[92:95], v[240:243], v[68:71], v[92:95]
    ds_read_b64_tr_b16 v[234:235], v7 offset:17920
    s_waitcnt lgkmcnt(6)
    v_mfma_f32_16x16x32_bf16 v[96:99], v[244:247], v[64:67], v[96:99]
    ds_read_b64_tr_b16 v[236:237], v8 offset:16928
    s_mov_b32 s23, 0x0
    buffer_load_dwordx4 v[56:59], v6, s[8:11], s23 offen offset:2048 sc1
    v_mfma_f32_16x16x32_bf16 v[100:103], v[244:247], v[68:71], v[100:103]
    ds_read_b64_tr_b16 v[238:239], v8 offset:17952
    s_waitcnt lgkmcnt(6)
    v_mfma_f32_16x16x32_bf16 v[104:107], v[224:227], v[64:67], v[104:107]
    ds_read_b64_tr_b16 v[240:241], v7 offset:17152
    v_mfma_f32_16x16x32_bf16 v[108:111], v[224:227], v[68:71], v[108:111]
    ds_read_b64_tr_b16 v[242:243], v7 offset:18176
    s_mov_b32 s23, 0x20000
    buffer_load_dwordx4 v[60:63], v6, s[8:11], s23 offen offset:2048 sc1
    s_waitcnt lgkmcnt(6)
    v_mfma_f32_16x16x32_bf16 v[112:115], v[228:231], v[64:67], v[112:115]
    ds_read_b64_tr_b16 v[244:245], v8 offset:17184
    v_mfma_f32_16x16x32_bf16 v[116:119], v[228:231], v[68:71], v[116:119]
    ds_read_b64_tr_b16 v[246:247], v8 offset:18208
    s_waitcnt lgkmcnt(6)
    v_mfma_f32_16x16x32_bf16 v[120:123], v[232:235], v[64:67], v[120:123]
    v_mfma_f32_16x16x32_bf16 v[124:127], v[232:235], v[68:71], v[124:127]
    s_barrier
    ds_read_b64_tr_b16 v[224:225], v4 offset:0
    ds_read_b64_tr_b16 v[226:227], v4 offset:1024
    s_waitcnt lgkmcnt(6)
    v_mfma_f32_16x16x32_bf16 v[128:131], v[236:239], v[64:67], v[128:131]
    s_add_u32 s22, s24, 0x20000
    s_add_u32 m0, s20, 0x20000
    s_nop 0
    buffer_load_dwordx4 v3, s[4:7], s22 offen lds
    ds_read_b64_tr_b16 v[228:229], v5 offset:32
    v_mfma_f32_16x16x32_bf16 v[132:135], v[236:239], v[68:71], v[132:135]
    ds_read_b64_tr_b16 v[230:231], v5 offset:1056
    s_waitcnt lgkmcnt(6)
    v_mfma_f32_16x16x32_bf16 v[136:139], v[240:243], v[64:67], v[136:139]
    ds_read_b64_tr_b16 v[232:233], v4 offset:256
    v_mfma_f32_16x16x32_bf16 v[140:143], v[240:243], v[68:71], v[140:143]
    s_add_u32 s22, s24, 0x22000
    s_add_u32 m0, s20, 0x20400
    s_nop 0
    buffer_load_dwordx4 v3, s[4:7], s22 offen lds
    ds_read_b64_tr_b16 v[234:235], v4 offset:1280
    s_waitcnt lgkmcnt(6)
    v_mfma_f32_16x16x32_bf16 v[144:147], v[244:247], v[64:67], v[144:147]
    ds_read_b64_tr_b16 v[236:237], v5 offset:288
    v_mfma_f32_16x16x32_bf16 v[148:151], v[244:247], v[68:71], v[148:151]
    ds_read_b64_tr_b16 v[238:239], v5 offset:1312
    s_waitcnt lgkmcnt(6)
    v_mfma_f32_16x16x32_bf16 v[88:91], v[224:227], v[24:27], v[88:91]
    ds_read_b64_tr_b16 v[240:241], v4 offset:512
    v_mfma_f32_16x16x32_bf16 v[92:95], v[224:227], v[28:31], v[92:95]
    ds_read_b64_tr_b16 v[242:243], v4 offset:1536
    s_waitcnt lgkmcnt(6)
    v_mfma_f32_16x16x32_bf16 v[96:99], v[228:231], v[24:27], v[96:99]
    ds_read_b64_tr_b16 v[244:245], v5 offset:544
    s_mov_b32 s23, 0x2000
    buffer_load_dwordx4 v[64:67], v6, s[8:11], s23 offen offset:2048 sc1
    v_mfma_f32_16x16x32_bf16 v[100:103], v[228:231], v[28:31], v[100:103]
    ds_read_b64_tr_b16 v[246:247], v5 offset:1568
    s_waitcnt lgkmcnt(6)
    v_mfma_f32_16x16x32_bf16 v[104:107], v[232:235], v[24:27], v[104:107]
    ds_read_b64_tr_b16 v[224:225], v4 offset:768
    v_mfma_f32_16x16x32_bf16 v[108:111], v[232:235], v[28:31], v[108:111]
    ds_read_b64_tr_b16 v[226:227], v4 offset:1792
    s_mov_b32 s23, 0x22000
    buffer_load_dwordx4 v[68:71], v6, s[8:11], s23 offen offset:2048 sc1
    s_waitcnt lgkmcnt(6)
    v_mfma_f32_16x16x32_bf16 v[112:115], v[236:239], v[24:27], v[112:115]
    ds_read_b64_tr_b16 v[228:229], v5 offset:800
    v_mfma_f32_16x16x32_bf16 v[116:119], v[236:239], v[28:31], v[116:119]
    ds_read_b64_tr_b16 v[230:231], v5 offset:1824
    s_waitcnt lgkmcnt(6)
    v_mfma_f32_16x16x32_bf16 v[120:123], v[240:243], v[24:27], v[120:123]
    v_mfma_f32_16x16x32_bf16 v[124:127], v[240:243], v[28:31], v[124:127]
    s_barrier
    ds_read_b64_tr_b16 v[232:233], v4 offset:16384
    ds_read_b64_tr_b16 v[234:235], v4 offset:17408
    s_waitcnt lgkmcnt(6)
    v_mfma_f32_16x16x32_bf16 v[128:131], v[244:247], v[24:27], v[128:131]
    s_add_u32 s22, s24, 0xa0000
    s_add_u32 m0, s20, 0x24000
    s_nop 0
    buffer_load_dwordx4 v3, s[4:7], s22 offen lds
    ds_read_b64_tr_b16 v[236:237], v5 offset:16416
    v_mfma_f32_16x16x32_bf16 v[132:135], v[244:247], v[28:31], v[132:135]
    ds_read_b64_tr_b16 v[238:239], v5 offset:17440
    s_waitcnt lgkmcnt(6)
    v_mfma_f32_16x16x32_bf16 v[136:139], v[224:227], v[24:27], v[136:139]
    ds_read_b64_tr_b16 v[240:241], v4 offset:16640
    v_mfma_f32_16x16x32_bf16 v[140:143], v[224:227], v[28:31], v[140:143]
    s_add_u32 s22, s24, 0xa2000
    s_add_u32 m0, s20, 0x24400
    s_nop 0
    buffer_load_dwordx4 v3, s[4:7], s22 offen lds
    ds_read_b64_tr_b16 v[242:243], v4 offset:17664
    s_waitcnt lgkmcnt(6)
    v_mfma_f32_16x16x32_bf16 v[144:147], v[228:231], v[24:27], v[144:147]
    ds_read_b64_tr_b16 v[244:245], v5 offset:16672
    v_mfma_f32_16x16x32_bf16 v[148:151], v[228:231], v[28:31], v[148:151]
    ds_read_b64_tr_b16 v[246:247], v5 offset:17696
    s_waitcnt lgkmcnt(6)
    v_mfma_f32_16x16x32_bf16 v[88:91], v[232:235], v[32:35], v[88:91]
    ds_read_b64_tr_b16 v[224:225], v4 offset:16896
    v_mfma_f32_16x16x32_bf16 v[92:95], v[232:235], v[36:39], v[92:95]
    ds_read_b64_tr_b16 v[226:227], v4 offset:17920
    s_waitcnt lgkmcnt(6)
    v_mfma_f32_16x16x32_bf16 v[96:99], v[236:239], v[32:35], v[96:99]
    ds_read_b64_tr_b16 v[228:229], v5 offset:16928
    s_mov_b32 s23, 0x4000
    buffer_load_dwordx4 v[24:27], v6, s[8:11], s23 offen offset:2048 sc1
    v_mfma_f32_16x16x32_bf16 v[100:103], v[236:239], v[36:39], v[100:103]
    ds_read_b64_tr_b16 v[230:231], v5 offset:17952
    s_waitcnt lgkmcnt(6)
    v_mfma_f32_16x16x32_bf16 v[104:107], v[240:243], v[32:35], v[104:107]
    ds_read_b64_tr_b16 v[232:233], v4 offset:17152
    v_mfma_f32_16x16x32_bf16 v[108:111], v[240:243], v[36:39], v[108:111]
    ds_read_b64_tr_b16 v[234:235], v4 offset:18176
    s_mov_b32 s23, 0x24000
    buffer_load_dwordx4 v[28:31], v6, s[8:11], s23 offen offset:2048 sc1
    s_waitcnt lgkmcnt(6)
    v_mfma_f32_16x16x32_bf16 v[112:115], v[244:247], v[32:35], v[112:115]
    ds_read_b64_tr_b16 v[236:237], v5 offset:17184
    v_mfma_f32_16x16x32_bf16 v[116:119], v[244:247], v[36:39], v[116:119]
    ds_read_b64_tr_b16 v[238:239], v5 offset:18208
    s_waitcnt lgkmcnt(6)
    v_mfma_f32_16x16x32_bf16 v[120:123], v[224:227], v[32:35], v[120:123]
    v_mfma_f32_16x16x32_bf16 v[124:127], v[224:227], v[36:39], v[124:127]
    s_waitcnt vmcnt(14)
    s_barrier
    ds_read_b64_tr_b16 v[240:241], v4 offset:32768
    ds_read_b64_tr_b16 v[242:243], v4 offset:33792
    s_waitcnt lgkmcnt(6)
    v_mfma_f32_16x16x32_bf16 v[128:131], v[228:231], v[32:35], v[128:131]
    s_add_u32 s22, s24, 0x120000
    s_add_u32 m0, s20, 0x10000
    s_nop 0
    buffer_load_dwordx4 v3, s[4:7], s22 offen lds
    ds_read_b64_tr_b16 v[244:245], v5 offset:32800
    v_mfma_f32_16x16x32_bf16 v[132:135], v[228:231], v[36:39], v[132:135]
    ds_read_b64_tr_b16 v[246:247], v5 offset:33824
    s_waitcnt lgkmcnt(6)
    v_mfma_f32_16x16x32_bf16 v[136:139], v[232:235], v[32:35], v[136:139]
    ds_read_b64_tr_b16 v[224:225], v4 offset:33024
    v_mfma_f32_16x16x32_bf16 v[140:143], v[232:235], v[36:39], v[140:143]
    s_add_u32 s22, s24, 0x122000
    s_add_u32 m0, s20, 0x10400
    s_nop 0
    buffer_load_dwordx4 v3, s[4:7], s22 offen lds
    ds_read_b64_tr_b16 v[226:227], v4 offset:34048
    s_waitcnt lgkmcnt(6)
    v_mfma_f32_16x16x32_bf16 v[144:147], v[236:239], v[32:35], v[144:147]
    ds_read_b64_tr_b16 v[228:229], v5 offset:33056
    v_mfma_f32_16x16x32_bf16 v[148:151], v[236:239], v[36:39], v[148:151]
    ds_read_b64_tr_b16 v[230:231], v5 offset:34080
    s_waitcnt lgkmcnt(6)
    v_mfma_f32_16x16x32_bf16 v[88:91], v[240:243], v[40:43], v[88:91]
    ds_read_b64_tr_b16 v[232:233], v4 offset:33280
    v_mfma_f32_16x16x32_bf16 v[92:95], v[240:243], v[44:47], v[92:95]
    ds_read_b64_tr_b16 v[234:235], v4 offset:34304
    s_waitcnt lgkmcnt(6)
    v_mfma_f32_16x16x32_bf16 v[96:99], v[244:247], v[40:43], v[96:99]
    ds_read_b64_tr_b16 v[236:237], v5 offset:33312
    s_mov_b32 s23, 0x6000
    buffer_load_dwordx4 v[32:35], v6, s[8:11], s23 offen offset:2048 sc1
    v_mfma_f32_16x16x32_bf16 v[100:103], v[244:247], v[44:47], v[100:103]
    ds_read_b64_tr_b16 v[238:239], v5 offset:34336
    s_waitcnt lgkmcnt(6)
    v_mfma_f32_16x16x32_bf16 v[104:107], v[224:227], v[40:43], v[104:107]
    ds_read_b64_tr_b16 v[240:241], v4 offset:33536
    v_mfma_f32_16x16x32_bf16 v[108:111], v[224:227], v[44:47], v[108:111]
    ds_read_b64_tr_b16 v[242:243], v4 offset:34560
    s_mov_b32 s23, 0x26000
    buffer_load_dwordx4 v[36:39], v6, s[8:11], s23 offen offset:2048 sc1
    s_waitcnt lgkmcnt(6)
    v_mfma_f32_16x16x32_bf16 v[112:115], v[228:231], v[40:43], v[112:115]
    ds_read_b64_tr_b16 v[244:245], v5 offset:33568
    v_mfma_f32_16x16x32_bf16 v[116:119], v[228:231], v[44:47], v[116:119]
    ds_read_b64_tr_b16 v[246:247], v5 offset:34592
    s_waitcnt lgkmcnt(6)
    v_mfma_f32_16x16x32_bf16 v[120:123], v[232:235], v[40:43], v[120:123]
    v_mfma_f32_16x16x32_bf16 v[124:127], v[232:235], v[44:47], v[124:127]
    s_waitcnt vmcnt(14)
    s_barrier
    ds_read_b64_tr_b16 v[224:225], v4 offset:49152
    ds_read_b64_tr_b16 v[226:227], v4 offset:50176
    s_waitcnt lgkmcnt(6)
    v_mfma_f32_16x16x32_bf16 v[128:131], v[236:239], v[40:43], v[128:131]
    s_add_u32 s22, s24, 0x1a0000
    s_add_u32 m0, s20, 0x14000
    s_nop 0
    buffer_load_dwordx4 v3, s[4:7], s22 offen lds
    ds_read_b64_tr_b16 v[228:229], v5 offset:49184
    v_mfma_f32_16x16x32_bf16 v[132:135], v[236:239], v[44:47], v[132:135]
    ds_read_b64_tr_b16 v[230:231], v5 offset:50208
    s_waitcnt lgkmcnt(6)
    v_mfma_f32_16x16x32_bf16 v[136:139], v[240:243], v[40:43], v[136:139]
    ds_read_b64_tr_b16 v[232:233], v4 offset:49408
    v_mfma_f32_16x16x32_bf16 v[140:143], v[240:243], v[44:47], v[140:143]
    s_add_u32 s22, s24, 0x1a2000
    s_add_u32 m0, s20, 0x14400
    s_nop 0
    buffer_load_dwordx4 v3, s[4:7], s22 offen lds
    ds_read_b64_tr_b16 v[234:235], v4 offset:50432
    s_waitcnt lgkmcnt(6)
    v_mfma_f32_16x16x32_bf16 v[144:147], v[244:247], v[40:43], v[144:147]
    ds_read_b64_tr_b16 v[236:237], v5 offset:49440
    v_mfma_f32_16x16x32_bf16 v[148:151], v[244:247], v[44:47], v[148:151]
    ds_read_b64_tr_b16 v[238:239], v5 offset:50464
    s_waitcnt lgkmcnt(6)
    v_mfma_f32_16x16x32_bf16 v[88:91], v[224:227], v[48:51], v[88:91]
    ds_read_b64_tr_b16 v[240:241], v4 offset:49664
    v_mfma_f32_16x16x32_bf16 v[92:95], v[224:227], v[52:55], v[92:95]
    ds_read_b64_tr_b16 v[242:243], v4 offset:50688
    s_waitcnt lgkmcnt(6)
    v_mfma_f32_16x16x32_bf16 v[96:99], v[228:231], v[48:51], v[96:99]
    ds_read_b64_tr_b16 v[244:245], v5 offset:49696
    s_mov_b32 s23, 0x8000
    buffer_load_dwordx4 v[40:43], v6, s[8:11], s23 offen offset:2048 sc1
    v_mfma_f32_16x16x32_bf16 v[100:103], v[228:231], v[52:55], v[100:103]
    ds_read_b64_tr_b16 v[246:247], v5 offset:50720
    s_waitcnt lgkmcnt(6)
    v_mfma_f32_16x16x32_bf16 v[104:107], v[232:235], v[48:51], v[104:107]
    ds_read_b64_tr_b16 v[224:225], v4 offset:49920
    v_mfma_f32_16x16x32_bf16 v[108:111], v[232:235], v[52:55], v[108:111]
    ds_read_b64_tr_b16 v[226:227], v4 offset:50944
    s_mov_b32 s23, 0x28000
    buffer_load_dwordx4 v[44:47], v6, s[8:11], s23 offen offset:2048 sc1
    s_waitcnt lgkmcnt(6)
    v_mfma_f32_16x16x32_bf16 v[112:115], v[236:239], v[48:51], v[112:115]
    ds_read_b64_tr_b16 v[228:229], v5 offset:49952
    v_mfma_f32_16x16x32_bf16 v[116:119], v[236:239], v[52:55], v[116:119]
    ds_read_b64_tr_b16 v[230:231], v5 offset:50976
    s_waitcnt lgkmcnt(6)
    v_mfma_f32_16x16x32_bf16 v[120:123], v[240:243], v[48:51], v[120:123]
    v_mfma_f32_16x16x32_bf16 v[124:127], v[240:243], v[52:55], v[124:127]
    s_waitcnt vmcnt(14)
    s_barrier
    ds_read_b64_tr_b16 v[232:233], v7 offset:0
    ds_read_b64_tr_b16 v[234:235], v7 offset:1024
    s_waitcnt lgkmcnt(6)
    v_mfma_f32_16x16x32_bf16 v[128:131], v[244:247], v[48:51], v[128:131]
    s_add_u32 s22, s24, 0x220000
    s_add_u32 m0, s20, 0x18000
    s_nop 0
    buffer_load_dwordx4 v3, s[4:7], s22 offen lds
    ds_read_b64_tr_b16 v[236:237], v8 offset:32
    v_mfma_f32_16x16x32_bf16 v[132:135], v[244:247], v[52:55], v[132:135]
    ds_read_b64_tr_b16 v[238:239], v8 offset:1056
    s_waitcnt lgkmcnt(6)
    v_mfma_f32_16x16x32_bf16 v[136:139], v[224:227], v[48:51], v[136:139]
    ds_read_b64_tr_b16 v[240:241], v7 offset:256
    v_mfma_f32_16x16x32_bf16 v[140:143], v[224:227], v[52:55], v[140:143]
    s_add_u32 s22, s24, 0x222000
    s_add_u32 m0, s20, 0x18400
    s_nop 0
    buffer_load_dwordx4 v3, s[4:7], s22 offen lds
    ds_read_b64_tr_b16 v[242:243], v7 offset:1280
    s_waitcnt lgkmcnt(6)
    v_mfma_f32_16x16x32_bf16 v[144:147], v[228:231], v[48:51], v[144:147]
    ds_read_b64_tr_b16 v[244:245], v8 offset:288
    v_mfma_f32_16x16x32_bf16 v[148:151], v[228:231], v[52:55], v[148:151]
    ds_read_b64_tr_b16 v[246:247], v8 offset:1312
    s_waitcnt lgkmcnt(6)
    v_mfma_f32_16x16x32_bf16 v[88:91], v[232:235], v[56:59], v[88:91]
    ds_read_b64_tr_b16 v[224:225], v7 offset:512
    v_mfma_f32_16x16x32_bf16 v[92:95], v[232:235], v[60:63], v[92:95]
    ds_read_b64_tr_b16 v[226:227], v7 offset:1536
    s_waitcnt lgkmcnt(6)
    v_mfma_f32_16x16x32_bf16 v[96:99], v[236:239], v[56:59], v[96:99]
    ds_read_b64_tr_b16 v[228:229], v8 offset:544
    s_mov_b32 s23, 0xa000
    buffer_load_dwordx4 v[48:51], v6, s[8:11], s23 offen offset:2048 sc1
    v_mfma_f32_16x16x32_bf16 v[100:103], v[236:239], v[60:63], v[100:103]
    ds_read_b64_tr_b16 v[230:231], v8 offset:1568
    s_waitcnt lgkmcnt(6)
    v_mfma_f32_16x16x32_bf16 v[104:107], v[240:243], v[56:59], v[104:107]
    ds_read_b64_tr_b16 v[232:233], v7 offset:768
    v_mfma_f32_16x16x32_bf16 v[108:111], v[240:243], v[60:63], v[108:111]
    ds_read_b64_tr_b16 v[234:235], v7 offset:1792
    s_mov_b32 s23, 0x2a000
    buffer_load_dwordx4 v[52:55], v6, s[8:11], s23 offen offset:2048 sc1
    s_waitcnt lgkmcnt(6)
    v_mfma_f32_16x16x32_bf16 v[112:115], v[244:247], v[56:59], v[112:115]
    ds_read_b64_tr_b16 v[236:237], v8 offset:800
    v_mfma_f32_16x16x32_bf16 v[116:119], v[244:247], v[60:63], v[116:119]
    ds_read_b64_tr_b16 v[238:239], v8 offset:1824
    s_waitcnt lgkmcnt(6)
    v_mfma_f32_16x16x32_bf16 v[120:123], v[224:227], v[56:59], v[120:123]
    v_mfma_f32_16x16x32_bf16 v[124:127], v[224:227], v[60:63], v[124:127]
    s_waitcnt vmcnt(14)
    s_barrier
    ds_read_b64_tr_b16 v[240:241], v7 offset:16384
    ds_read_b64_tr_b16 v[242:243], v7 offset:17408
    s_waitcnt lgkmcnt(6)
    v_mfma_f32_16x16x32_bf16 v[128:131], v[228:231], v[56:59], v[128:131]
    s_add_u32 s22, s24, 0x2a0000
    s_add_u32 m0, s20, 0x1c000
    s_nop 0
    buffer_load_dwordx4 v3, s[4:7], s22 offen lds
    ds_read_b64_tr_b16 v[244:245], v8 offset:16416
    v_mfma_f32_16x16x32_bf16 v[132:135], v[228:231], v[60:63], v[132:135]
    ds_read_b64_tr_b16 v[246:247], v8 offset:17440
    s_waitcnt lgkmcnt(6)
    v_mfma_f32_16x16x32_bf16 v[136:139], v[232:235], v[56:59], v[136:139]
    ds_read_b64_tr_b16 v[224:225], v7 offset:16640
    v_mfma_f32_16x16x32_bf16 v[140:143], v[232:235], v[60:63], v[140:143]
    s_add_u32 s22, s24, 0x2a2000
    s_add_u32 m0, s20, 0x1c400
    s_nop 0
    buffer_load_dwordx4 v3, s[4:7], s22 offen lds
    ds_read_b64_tr_b16 v[226:227], v7 offset:17664
    s_waitcnt lgkmcnt(6)
    v_mfma_f32_16x16x32_bf16 v[144:147], v[236:239], v[56:59], v[144:147]
    ds_read_b64_tr_b16 v[228:229], v8 offset:16672
    v_mfma_f32_16x16x32_bf16 v[148:151], v[236:239], v[60:63], v[148:151]
    ds_read_b64_tr_b16 v[230:231], v8 offset:17696
    s_waitcnt lgkmcnt(6)
    v_mfma_f32_16x16x32_bf16 v[88:91], v[240:243], v[64:67], v[88:91]
    ds_read_b64_tr_b16 v[232:233], v7 offset:16896
    v_mfma_f32_16x16x32_bf16 v[92:95], v[240:243], v[68:71], v[92:95]
    ds_read_b64_tr_b16 v[234:235], v7 offset:17920
    s_waitcnt lgkmcnt(6)
    v_mfma_f32_16x16x32_bf16 v[96:99], v[244:247], v[64:67], v[96:99]
    ds_read_b64_tr_b16 v[236:237], v8 offset:16928
    s_mov_b32 s23, 0xc000
    buffer_load_dwordx4 v[56:59], v6, s[8:11], s23 offen offset:2048 sc1
    v_mfma_f32_16x16x32_bf16 v[100:103], v[244:247], v[68:71], v[100:103]
    ds_read_b64_tr_b16 v[238:239], v8 offset:17952
    s_waitcnt lgkmcnt(6)
    v_mfma_f32_16x16x32_bf16 v[104:107], v[224:227], v[64:67], v[104:107]
    ds_read_b64_tr_b16 v[240:241], v7 offset:17152
    v_mfma_f32_16x16x32_bf16 v[108:111], v[224:227], v[68:71], v[108:111]
    ds_read_b64_tr_b16 v[242:243], v7 offset:18176
    s_mov_b32 s23, 0x2c000
    buffer_load_dwordx4 v[60:63], v6, s[8:11], s23 offen offset:2048 sc1
    s_waitcnt lgkmcnt(6)
    v_mfma_f32_16x16x32_bf16 v[112:115], v[228:231], v[64:67], v[112:115]
    ds_read_b64_tr_b16 v[244:245], v8 offset:17184
    v_mfma_f32_16x16x32_bf16 v[116:119], v[228:231], v[68:71], v[116:119]
    ds_read_b64_tr_b16 v[246:247], v8 offset:18208
    s_waitcnt lgkmcnt(6)
    v_mfma_f32_16x16x32_bf16 v[120:123], v[232:235], v[64:67], v[120:123]
    v_mfma_f32_16x16x32_bf16 v[124:127], v[232:235], v[68:71], v[124:127]
    s_waitcnt vmcnt(14)
    s_barrier
    ds_read_b64_tr_b16 v[224:225], v4 offset:0
    ds_read_b64_tr_b16 v[226:227], v4 offset:1024
    s_add_u32 s19, s19, 8192
    buffer_load_dword v12, v13, s[8:11], s19 offen sc1
    s_waitcnt lgkmcnt(6)
    v_mfma_f32_16x16x32_bf16 v[128:131], v[236:239], v[64:67], v[128:131]
    s_add_u32 s22, s24, 0x320000
    s_add_u32 m0, s20, 0x20000
    s_nop 0
    buffer_load_dwordx4 v3, s[4:7], s22 offen lds
    ds_read_b64_tr_b16 v[228:229], v5 offset:32
    v_mfma_f32_16x16x32_bf16 v[132:135], v[236:239], v[68:71], v[132:135]
    ds_read_b64_tr_b16 v[230:231], v5 offset:1056
    s_waitcnt lgkmcnt(6)
    v_mfma_f32_16x16x32_bf16 v[136:139], v[240:243], v[64:67], v[136:139]
    ds_read_b64_tr_b16 v[232:233], v4 offset:256
    v_mfma_f32_16x16x32_bf16 v[140:143], v[240:243], v[68:71], v[140:143]
    s_add_u32 s22, s24, 0x322000
    s_add_u32 m0, s20, 0x20400
    s_nop 0
    buffer_load_dwordx4 v3, s[4:7], s22 offen lds
    ds_read_b64_tr_b16 v[234:235], v4 offset:1280
    s_waitcnt lgkmcnt(6)
    v_mfma_f32_16x16x32_bf16 v[144:147], v[244:247], v[64:67], v[144:147]
    ds_read_b64_tr_b16 v[236:237], v5 offset:288
    v_mfma_f32_16x16x32_bf16 v[148:151], v[244:247], v[68:71], v[148:151]
    ds_read_b64_tr_b16 v[238:239], v5 offset:1312
    s_waitcnt lgkmcnt(6)
    v_mfma_f32_16x16x32_bf16 v[88:91], v[224:227], v[24:27], v[88:91]
    v_mov_b32 v248, s28
    v_mov_b32 v249, 0
    s_lshl_b32 s14, s2, 2
    s_add_u32 s14, s14, 0x544000
    s_cmp_eq_u32 s3, 0
    s_cselect_b32 s14, s14, 0x7ffffff0
    s_mov_b64 exec, 1
    buffer_store_dword v248, v249, s[8:11], s14 offen sc1
    s_mov_b64 exec, -1
    ds_read_b64_tr_b16 v[240:241], v4 offset:512
    v_mfma_f32_16x16x32_bf16 v[92:95], v[224:227], v[28:31], v[92:95]
    ds_read_b64_tr_b16 v[242:243], v4 offset:1536
    s_waitcnt lgkmcnt(6)
    v_mfma_f32_16x16x32_bf16 v[96:99], v[228:231], v[24:27], v[96:99]
    ds_read_b64_tr_b16 v[244:245], v5 offset:544
    s_mov_b32 s23, 0xe000
    buffer_load_dwordx4 v[64:67], v6, s[8:11], s23 offen offset:2048 sc1
    v_mfma_f32_16x16x32_bf16 v[100:103], v[228:231], v[28:31], v[100:103]
    ds_read_b64_tr_b16 v[246:247], v5 offset:1568
    s_waitcnt lgkmcnt(6)
    v_mfma_f32_16x16x32_bf16 v[104:107], v[232:235], v[24:27], v[104:107]
    ds_read_b64_tr_b16 v[224:225], v4 offset:768
    v_mfma_f32_16x16x32_bf16 v[108:111], v[232:235], v[28:31], v[108:111]
    ds_read_b64_tr_b16 v[226:227], v4 offset:1792
    s_mov_b32 s23, 0x2e000
    buffer_load_dwordx4 v[68:71], v6, s[8:11], s23 offen offset:2048 sc1
    s_waitcnt lgkmcnt(6)
    v_mfma_f32_16x16x32_bf16 v[112:115], v[236:239], v[24:27], v[112:115]
    ds_read_b64_tr_b16 v[228:229], v5 offset:800
    v_mfma_f32_16x16x32_bf16 v[116:119], v[236:239], v[28:31], v[116:119]
    ds_read_b64_tr_b16 v[230:231], v5 offset:1824
    s_waitcnt lgkmcnt(6)
    v_mfma_f32_16x16x32_bf16 v[120:123], v[240:243], v[24:27], v[120:123]
    v_mfma_f32_16x16x32_bf16 v[124:127], v[240:243], v[28:31], v[124:127]
    s_waitcnt vmcnt(16)
    s_barrier
    ds_read_b64_tr_b16 v[232:233], v4 offset:16384
    ds_read_b64_tr_b16 v[234:235], v4 offset:17408
    s_waitcnt lgkmcnt(6)
    v_mfma_f32_16x16x32_bf16 v[128:131], v[244:247], v[24:27], v[128:131]
    s_add_u32 s22, s24, 0x3a0000
    s_add_u32 m0, s20, 0x24000
    s_nop 0
    buffer_load_dwordx4 v3, s[4:7], s22 offen lds
    ds_read_b64_tr_b16 v[236:237], v5 offset:16416
    v_mfma_f32_16x16x32_bf16 v[132:135], v[244:247], v[28:31], v[132:135]
    ds_read_b64_tr_b16 v[238:239], v5 offset:17440
    s_waitcnt lgkmcnt(6)
    v_mfma_f32_16x16x32_bf16 v[136:139], v[224:227], v[24:27], v[136:139]
    ds_read_b64_tr_b16 v[240:241], v4 offset:16640
    v_mfma_f32_16x16x32_bf16 v[140:143], v[224:227], v[28:31], v[140:143]
    s_add_u32 s22, s24, 0x3a2000
    s_add_u32 m0, s20, 0x24400
    s_nop 0
    buffer_load_dwordx4 v3, s[4:7], s22 offen lds
    ds_read_b64_tr_b16 v[242:243], v4 offset:17664
    s_waitcnt lgkmcnt(6)
    v_mfma_f32_16x16x32_bf16 v[144:147], v[228:231], v[24:27], v[144:147]
    ds_read_b64_tr_b16 v[244:245], v5 offset:16672
    v_mfma_f32_16x16x32_bf16 v[148:151], v[228:231], v[28:31], v[148:151]
    ds_read_b64_tr_b16 v[246:247], v5 offset:17696
    s_waitcnt vmcnt(7)
    v_cmp_ne_u32 vcc, s28, v12
    s_cbranch_vccnz adaLN_cond__sliding_block_cached__moe_arch_mod__prompt_kernel_o29r
adaLN_cond__sliding_block_cached__moe_arch_mod__prompt_kernel_o29b:
    s_waitcnt lgkmcnt(6)
    v_mfma_f32_16x16x32_bf16 v[88:91], v[232:235], v[32:35], v[88:91]
    ds_read_b64_tr_b16 v[224:225], v4 offset:16896
    v_mfma_f32_16x16x32_bf16 v[92:95], v[232:235], v[36:39], v[92:95]
    ds_read_b64_tr_b16 v[226:227], v4 offset:17920
    s_waitcnt lgkmcnt(6)
    v_mfma_f32_16x16x32_bf16 v[96:99], v[236:239], v[32:35], v[96:99]
    ds_read_b64_tr_b16 v[228:229], v5 offset:16928
    s_mov_b32 s23, 0x0
    buffer_load_dwordx4 v[24:27], v6, s[8:11], s23 offen offset:3072 sc1
    v_mfma_f32_16x16x32_bf16 v[100:103], v[236:239], v[36:39], v[100:103]
    ds_read_b64_tr_b16 v[230:231], v5 offset:17952
    s_waitcnt lgkmcnt(6)
    v_mfma_f32_16x16x32_bf16 v[104:107], v[240:243], v[32:35], v[104:107]
    ds_read_b64_tr_b16 v[232:233], v4 offset:17152
    v_mfma_f32_16x16x32_bf16 v[108:111], v[240:243], v[36:39], v[108:111]
    ds_read_b64_tr_b16 v[234:235], v4 offset:18176
    s_mov_b32 s23, 0x20000
    buffer_load_dwordx4 v[28:31], v6, s[8:11], s23 offen offset:3072 sc1
    s_waitcnt lgkmcnt(6)
    v_mfma_f32_16x16x32_bf16 v[112:115], v[244:247], v[32:35], v[112:115]
    ds_read_b64_tr_b16 v[236:237], v5 offset:17184
    v_mfma_f32_16x16x32_bf16 v[116:119], v[244:247], v[36:39], v[116:119]
    ds_read_b64_tr_b16 v[238:239], v5 offset:18208
    s_waitcnt lgkmcnt(6)
    v_mfma_f32_16x16x32_bf16 v[120:123], v[224:227], v[32:35], v[120:123]
    v_mfma_f32_16x16x32_bf16 v[124:127], v[224:227], v[36:39], v[124:127]
    s_barrier
    ds_read_b64_tr_b16 v[240:241], v4 offset:32768
    ds_read_b64_tr_b16 v[242:243], v4 offset:33792
    s_waitcnt lgkmcnt(6)
    v_mfma_f32_16x16x32_bf16 v[128:131], v[228:231], v[32:35], v[128:131]
    s_add_u32 s22, s24, 0x30000
    s_add_u32 m0, s20, 0x10000
    s_nop 0
    buffer_load_dwordx4 v3, s[4:7], s22 offen lds
    ds_read_b64_tr_b16 v[244:245], v5 offset:32800
    v_mfma_f32_16x16x32_bf16 v[132:135], v[228:231], v[36:39], v[132:135]
    ds_read_b64_tr_b16 v[246:247], v5 offset:33824
    s_waitcnt lgkmcnt(6)
    v_mfma_f32_16x16x32_bf16 v[136:139], v[232:235], v[32:35], v[136:139]
    ds_read_b64_tr_b16 v[224:225], v4 offset:33024
    v_mfma_f32_16x16x32_bf16 v[140:143], v[232:235], v[36:39], v[140:143]
    s_add_u32 s22, s24, 0x32000
    s_add_u32 m0, s20, 0x10400
    s_nop 0
    buffer_load_dwordx4 v3, s[4:7], s22 offen lds
    ds_read_b64_tr_b16 v[226:227], v4 offset:34048
    s_waitcnt lgkmcnt(6)
    v_mfma_f32_16x16x32_bf16 v[144:147], v[236:239], v[32:35], v[144:147]
    ds_read_b64_tr_b16 v[228:229], v5 offset:33056
    v_mfma_f32_16x16x32_bf16 v[148:151], v[236:239], v[36:39], v[148:151]
    ds_read_b64_tr_b16 v[230:231], v5 offset:34080
    s_waitcnt lgkmcnt(6)
    v_mfma_f32_16x16x32_bf16 v[88:91], v[240:243], v[40:43], v[88:91]
    ds_read_b64_tr_b16 v[232:233], v4 offset:33280
    v_mfma_f32_16x16x32_bf16 v[92:95], v[240:243], v[44:47], v[92:95]
    ds_read_b64_tr_b16 v[234:235], v4 offset:34304
    s_waitcnt lgkmcnt(6)
    v_mfma_f32_16x16x32_bf16 v[96:99], v[244:247], v[40:43], v[96:99]
    ds_read_b64_tr_b16 v[236:237], v5 offset:33312
    s_mov_b32 s23, 0x2000
    buffer_load_dwordx4 v[32:35], v6, s[8:11], s23 offen offset:3072 sc1
    v_mfma_f32_16x16x32_bf16 v[100:103], v[244:247], v[44:47], v[100:103]
    ds_read_b64_tr_b16 v[238:239], v5 offset:34336
    s_waitcnt lgkmcnt(6)
    v_mfma_f32_16x16x32_bf16 v[104:107], v[224:227], v[40:43], v[104:107]
    ds_read_b64_tr_b16 v[240:241], v4 offset:33536
    v_mfma_f32_16x16x32_bf16 v[108:111], v[224:227], v[44:47], v[108:111]
    ds_read_b64_tr_b16 v[242:243], v4 offset:34560
    s_mov_b32 s23, 0x22000
    buffer_load_dwordx4 v[36:39], v6, s[8:11], s23 offen offset:3072 sc1
    s_waitcnt lgkmcnt(6)
    v_mfma_f32_16x16x32_bf16 v[112:115], v[228:231], v[40:43], v[112:115]
    ds_read_b64_tr_b16 v[244:245], v5 offset:33568
    v_mfma_f32_16x16x32_bf16 v[116:119], v[228:231], v[44:47], v[116:119]
    ds_read_b64_tr_b16 v[246:247], v5 offset:34592
    s_waitcnt lgkmcnt(6)
    v_mfma_f32_16x16x32_bf16 v[120:123], v[232:235], v[40:43], v[120:123]
    v_mfma_f32_16x16x32_bf16 v[124:127], v[232:235], v[44:47], v[124:127]
    s_barrier
    ds_read_b64_tr_b16 v[224:225], v4 offset:49152
    ds_read_b64_tr_b16 v[226:227], v4 offset:50176
    s_waitcnt lgkmcnt(6)
    v_mfma_f32_16x16x32_bf16 v[128:131], v[236:239], v[40:43], v[128:131]
    s_add_u32 s22, s24, 0xb0000
    s_add_u32 m0, s20, 0x14000
    s_nop 0
    buffer_load_dwordx4 v3, s[4:7], s22 offen lds
    ds_read_b64_tr_b16 v[228:229], v5 offset:49184
    v_mfma_f32_16x16x32_bf16 v[132:135], v[236:239], v[44:47], v[132:135]
    ds_read_b64_tr_b16 v[230:231], v5 offset:50208
    s_waitcnt lgkmcnt(6)
    v_mfma_f32_16x16x32_bf16 v[136:139], v[240:243], v[40:43], v[136:139]
    ds_read_b64_tr_b16 v[232:233], v4 offset:49408
    v_mfma_f32_16x16x32_bf16 v[140:143], v[240:243], v[44:47], v[140:143]
    s_add_u32 s22, s24, 0xb2000
    s_add_u32 m0, s20, 0x14400
    s_nop 0
    buffer_load_dwordx4 v3, s[4:7], s22 offen lds
    ds_read_b64_tr_b16 v[234:235], v4 offset:50432
    s_waitcnt lgkmcnt(6)
    v_mfma_f32_16x16x32_bf16 v[144:147], v[244:247], v[40:43], v[144:147]
    ds_read_b64_tr_b16 v[236:237], v5 offset:49440
    v_mfma_f32_16x16x32_bf16 v[148:151], v[244:247], v[44:47], v[148:151]
    ds_read_b64_tr_b16 v[238:239], v5 offset:50464
    s_waitcnt lgkmcnt(6)
    v_mfma_f32_16x16x32_bf16 v[88:91], v[224:227], v[48:51], v[88:91]
    ds_read_b64_tr_b16 v[240:241], v4 offset:49664
    v_mfma_f32_16x16x32_bf16 v[92:95], v[224:227], v[52:55], v[92:95]
    ds_read_b64_tr_b16 v[242:243], v4 offset:50688
    s_waitcnt lgkmcnt(6)
    v_mfma_f32_16x16x32_bf16 v[96:99], v[228:231], v[48:51], v[96:99]
    ds_read_b64_tr_b16 v[244:245], v5 offset:49696
    s_mov_b32 s23, 0x4000
    buffer_load_dwordx4 v[40:43], v6, s[8:11], s23 offen offset:3072 sc1
    v_mfma_f32_16x16x32_bf16 v[100:103], v[228:231], v[52:55], v[100:103]
    ds_read_b64_tr_b16 v[246:247], v5 offset:50720
    s_waitcnt lgkmcnt(6)
    v_mfma_f32_16x16x32_bf16 v[104:107], v[232:235], v[48:51], v[104:107]
    ds_read_b64_tr_b16 v[224:225], v4 offset:49920
    v_mfma_f32_16x16x32_bf16 v[108:111], v[232:235], v[52:55], v[108:111]
    ds_read_b64_tr_b16 v[226:227], v4 offset:50944
    s_mov_b32 s23, 0x24000
    buffer_load_dwordx4 v[44:47], v6, s[8:11], s23 offen offset:3072 sc1
    s_waitcnt lgkmcnt(6)
    v_mfma_f32_16x16x32_bf16 v[112:115], v[236:239], v[48:51], v[112:115]
    ds_read_b64_tr_b16 v[228:229], v5 offset:49952
    v_mfma_f32_16x16x32_bf16 v[116:119], v[236:239], v[52:55], v[116:119]
    ds_read_b64_tr_b16 v[230:231], v5 offset:50976
    s_waitcnt lgkmcnt(6)
    v_mfma_f32_16x16x32_bf16 v[120:123], v[240:243], v[48:51], v[120:123]
    v_mfma_f32_16x16x32_bf16 v[124:127], v[240:243], v[52:55], v[124:127]
    s_waitcnt vmcnt(15)
    s_barrier
    ds_read_b64_tr_b16 v[232:233], v7 offset:0
    ds_read_b64_tr_b16 v[234:235], v7 offset:1024
    s_waitcnt lgkmcnt(6)
    v_mfma_f32_16x16x32_bf16 v[128:131], v[244:247], v[48:51], v[128:131]
    s_add_u32 s22, s24, 0x130000
    s_add_u32 m0, s20, 0x18000
    s_nop 0
    buffer_load_dwordx4 v3, s[4:7], s22 offen lds
    ds_read_b64_tr_b16 v[236:237], v8 offset:32
    v_mfma_f32_16x16x32_bf16 v[132:135], v[244:247], v[52:55], v[132:135]
    ds_read_b64_tr_b16 v[238:239], v8 offset:1056
    s_waitcnt lgkmcnt(6)
    v_mfma_f32_16x16x32_bf16 v[136:139], v[224:227], v[48:51], v[136:139]
    ds_read_b64_tr_b16 v[240:241], v7 offset:256
    v_mfma_f32_16x16x32_bf16 v[140:143], v[224:227], v[52:55], v[140:143]
    s_add_u32 s22, s24, 0x132000
    s_add_u32 m0, s20, 0x18400
    s_nop 0
    buffer_load_dwordx4 v3, s[4:7], s22 offen lds
    ds_read_b64_tr_b16 v[242:243], v7 offset:1280
    s_waitcnt lgkmcnt(6)
    v_mfma_f32_16x16x32_bf16 v[144:147], v[228:231], v[48:51], v[144:147]
    ds_read_b64_tr_b16 v[244:245], v8 offset:288
    v_mfma_f32_16x16x32_bf16 v[148:151], v[228:231], v[52:55], v[148:151]
    ds_read_b64_tr_b16 v[246:247], v8 offset:1312
    s_waitcnt lgkmcnt(6)
    v_mfma_f32_16x16x32_bf16 v[88:91], v[232:235], v[56:59], v[88:91]
    ds_read_b64_tr_b16 v[224:225], v7 offset:512
    v_mfma_f32_16x16x32_bf16 v[92:95], v[232:235], v[60:63], v[92:95]
    ds_read_b64_tr_b16 v[226:227], v7 offset:1536
    s_waitcnt lgkmcnt(6)
    v_mfma_f32_16x16x32_bf16 v[96:99], v[236:239], v[56:59], v[96:99]
    ds_read_b64_tr_b16 v[228:229], v8 offset:544
    s_mov_b32 s23, 0x6000
    buffer_load_dwordx4 v[48:51], v6, s[8:11], s23 offen offset:3072 sc1
    v_mfma_f32_16x16x32_bf16 v[100:103], v[236:239], v[60:63], v[100:103]
    ds_read_b64_tr_b16 v[230:231], v8 offset:1568
    s_waitcnt lgkmcnt(6)
    v_mfma_f32_16x16x32_bf16 v[104:107], v[240:243], v[56:59], v[104:107]
    ds_read_b64_tr_b16 v[232:233], v7 offset:768
    v_mfma_f32_16x16x32_bf16 v[108:111], v[240:243], v[60:63], v[108:111]
    ds_read_b64_tr_b16 v[234:235], v7 offset:1792
    s_mov_b32 s23, 0x26000
    buffer_load_dwordx4 v[52:55], v6, s[8:11], s23 offen offset:3072 sc1
    s_waitcnt lgkmcnt(6)
    v_mfma_f32_16x16x32_bf16 v[112:115], v[244:247], v[56:59], v[112:115]
    ds_read_b64_tr_b16 v[236:237], v8 offset:800
    v_mfma_f32_16x16x32_bf16 v[116:119], v[244:247], v[60:63], v[116:119]
    ds_read_b64_tr_b16 v[238:239], v8 offset:1824
    s_waitcnt lgkmcnt(6)
    v_mfma_f32_16x16x32_bf16 v[120:123], v[224:227], v[56:59], v[120:123]
    v_mfma_f32_16x16x32_bf16 v[124:127], v[224:227], v[60:63], v[124:127]
    s_waitcnt vmcnt(14)
    s_barrier
    ds_read_b64_tr_b16 v[240:241], v7 offset:16384
    ds_read_b64_tr_b16 v[242:243], v7 offset:17408
    s_waitcnt lgkmcnt(6)
    v_mfma_f32_16x16x32_bf16 v[128:131], v[228:231], v[56:59], v[128:131]
    s_add_u32 s22, s24, 0x1b0000
    s_add_u32 m0, s20, 0x1c000
    s_nop 0
    buffer_load_dwordx4 v3, s[4:7], s22 offen lds
    ds_read_b64_tr_b16 v[244:245], v8 offset:16416
    v_mfma_f32_16x16x32_bf16 v[132:135], v[228:231], v[60:63], v[132:135]
    ds_read_b64_tr_b16 v[246:247], v8 offset:17440
    s_waitcnt lgkmcnt(6)
    v_mfma_f32_16x16x32_bf16 v[136:139], v[232:235], v[56:59], v[136:139]
    ds_read_b64_tr_b16 v[224:225], v7 offset:16640
    v_mfma_f32_16x16x32_bf16 v[140:143], v[232:235], v[60:63], v[140:143]
    s_add_u32 s22, s24, 0x1b2000
    s_add_u32 m0, s20, 0x1c400
    s_nop 0
    buffer_load_dwordx4 v3, s[4:7], s22 offen lds
    ds_read_b64_tr_b16 v[226:227], v7 offset:17664
    s_waitcnt lgkmcnt(6)
    v_mfma_f32_16x16x32_bf16 v[144:147], v[236:239], v[56:59], v[144:147]
    ds_read_b64_tr_b16 v[228:229], v8 offset:16672
    v_mfma_f32_16x16x32_bf16 v[148:151], v[236:239], v[60:63], v[148:151]
    ds_read_b64_tr_b16 v[230:231], v8 offset:17696
    s_waitcnt lgkmcnt(6)
    v_mfma_f32_16x16x32_bf16 v[88:91], v[240:243], v[64:67], v[88:91]
    ds_read_b64_tr_b16 v[232:233], v7 offset:16896
    v_mfma_f32_16x16x32_bf16 v[92:95], v[240:243], v[68:71], v[92:95]
    ds_read_b64_tr_b16 v[234:235], v7 offset:17920
    s_waitcnt lgkmcnt(6)
    v_mfma_f32_16x16x32_bf16 v[96:99], v[244:247], v[64:67], v[96:99]
    ds_read_b64_tr_b16 v[236:237], v8 offset:16928
    s_mov_b32 s23, 0x8000
    buffer_load_dwordx4 v[56:59], v6, s[8:11], s23 offen offset:3072 sc1
    v_mfma_f32_16x16x32_bf16 v[100:103], v[244:247], v[68:71], v[100:103]
    ds_read_b64_tr_b16 v[238:239], v8 offset:17952
    s_waitcnt lgkmcnt(6)
    v_mfma_f32_16x16x32_bf16 v[104:107], v[224:227], v[64:67], v[104:107]
    ds_read_b64_tr_b16 v[240:241], v7 offset:17152
    v_mfma_f32_16x16x32_bf16 v[108:111], v[224:227], v[68:71], v[108:111]
    ds_read_b64_tr_b16 v[242:243], v7 offset:18176
    s_mov_b32 s23, 0x28000
    buffer_load_dwordx4 v[60:63], v6, s[8:11], s23 offen offset:3072 sc1
    s_waitcnt lgkmcnt(6)
    v_mfma_f32_16x16x32_bf16 v[112:115], v[228:231], v[64:67], v[112:115]
    ds_read_b64_tr_b16 v[244:245], v8 offset:17184
    v_mfma_f32_16x16x32_bf16 v[116:119], v[228:231], v[68:71], v[116:119]
    ds_read_b64_tr_b16 v[246:247], v8 offset:18208
    s_waitcnt lgkmcnt(6)
    v_mfma_f32_16x16x32_bf16 v[120:123], v[232:235], v[64:67], v[120:123]
    v_mfma_f32_16x16x32_bf16 v[124:127], v[232:235], v[68:71], v[124:127]
    s_waitcnt vmcnt(14)
    s_barrier
    ds_read_b64_tr_b16 v[224:225], v4 offset:0
    ds_read_b64_tr_b16 v[226:227], v4 offset:1024
    s_waitcnt lgkmcnt(6)
    v_mfma_f32_16x16x32_bf16 v[128:131], v[236:239], v[64:67], v[128:131]
    s_add_u32 s22, s24, 0x230000
    s_add_u32 m0, s20, 0x20000
    s_nop 0
    buffer_load_dwordx4 v3, s[4:7], s22 offen lds
    ds_read_b64_tr_b16 v[228:229], v5 offset:32
    v_mfma_f32_16x16x32_bf16 v[132:135], v[236:239], v[68:71], v[132:135]
    ds_read_b64_tr_b16 v[230:231], v5 offset:1056
    s_waitcnt lgkmcnt(6)
    v_mfma_f32_16x16x32_bf16 v[136:139], v[240:243], v[64:67], v[136:139]
    ds_read_b64_tr_b16 v[232:233], v4 offset:256
    v_mfma_f32_16x16x32_bf16 v[140:143], v[240:243], v[68:71], v[140:143]
    s_add_u32 s22, s24, 0x232000
    s_add_u32 m0, s20, 0x20400
    s_nop 0
    buffer_load_dwordx4 v3, s[4:7], s22 offen lds
    ds_read_b64_tr_b16 v[234:235], v4 offset:1280
    s_waitcnt lgkmcnt(6)
    v_mfma_f32_16x16x32_bf16 v[144:147], v[244:247], v[64:67], v[144:147]
    ds_read_b64_tr_b16 v[236:237], v5 offset:288
    v_mfma_f32_16x16x32_bf16 v[148:151], v[244:247], v[68:71], v[148:151]
    ds_read_b64_tr_b16 v[238:239], v5 offset:1312
    s_waitcnt lgkmcnt(6)
    v_mfma_f32_16x16x32_bf16 v[88:91], v[224:227], v[24:27], v[88:91]
    ds_read_b64_tr_b16 v[240:241], v4 offset:512
    v_mfma_f32_16x16x32_bf16 v[92:95], v[224:227], v[28:31], v[92:95]
    ds_read_b64_tr_b16 v[242:243], v4 offset:1536
    s_waitcnt lgkmcnt(6)
    v_mfma_f32_16x16x32_bf16 v[96:99], v[228:231], v[24:27], v[96:99]
    ds_read_b64_tr_b16 v[244:245], v5 offset:544
    s_mov_b32 s23, 0xa000
    buffer_load_dwordx4 v[64:67], v6, s[8:11], s23 offen offset:3072 sc1
    v_mfma_f32_16x16x32_bf16 v[100:103], v[228:231], v[28:31], v[100:103]
    ds_read_b64_tr_b16 v[246:247], v5 offset:1568
    s_waitcnt lgkmcnt(6)
    v_mfma_f32_16x16x32_bf16 v[104:107], v[232:235], v[24:27], v[104:107]
    ds_read_b64_tr_b16 v[224:225], v4 offset:768
    v_mfma_f32_16x16x32_bf16 v[108:111], v[232:235], v[28:31], v[108:111]
    ds_read_b64_tr_b16 v[226:227], v4 offset:1792
    s_mov_b32 s23, 0x2a000
    buffer_load_dwordx4 v[68:71], v6, s[8:11], s23 offen offset:3072 sc1
    s_waitcnt lgkmcnt(6)
    v_mfma_f32_16x16x32_bf16 v[112:115], v[236:239], v[24:27], v[112:115]
    ds_read_b64_tr_b16 v[228:229], v5 offset:800
    v_mfma_f32_16x16x32_bf16 v[116:119], v[236:239], v[28:31], v[116:119]
    ds_read_b64_tr_b16 v[230:231], v5 offset:1824
    s_waitcnt lgkmcnt(6)
    v_mfma_f32_16x16x32_bf16 v[120:123], v[240:243], v[24:27], v[120:123]
    v_mfma_f32_16x16x32_bf16 v[124:127], v[240:243], v[28:31], v[124:127]
    s_waitcnt vmcnt(14)
    s_barrier
    ds_read_b64_tr_b16 v[232:233], v4 offset:16384
    ds_read_b64_tr_b16 v[234:235], v4 offset:17408
    s_waitcnt lgkmcnt(6)
    v_mfma_f32_16x16x32_bf16 v[128:131], v[244:247], v[24:27], v[128:131]
    s_add_u32 s22, s24, 0x2b0000
    s_add_u32 m0, s20, 0x24000
    s_nop 0
    buffer_load_dwordx4 v3, s[4:7], s22 offen lds
    ds_read_b64_tr_b16 v[236:237], v5 offset:16416
    v_mfma_f32_16x16x32_bf16 v[132:135], v[244:247], v[28:31], v[132:135]
    ds_read_b64_tr_b16 v[238:239], v5 offset:17440
    s_waitcnt lgkmcnt(6)
    v_mfma_f32_16x16x32_bf16 v[136:139], v[224:227], v[24:27], v[136:139]
    ds_read_b64_tr_b16 v[240:241], v4 offset:16640
    v_mfma_f32_16x16x32_bf16 v[140:143], v[224:227], v[28:31], v[140:143]
    s_add_u32 s22, s24, 0x2b2000
    s_add_u32 m0, s20, 0x24400
    s_nop 0
    buffer_load_dwordx4 v3, s[4:7], s22 offen lds
    ds_read_b64_tr_b16 v[242:243], v4 offset:17664
    s_waitcnt lgkmcnt(6)
    v_mfma_f32_16x16x32_bf16 v[144:147], v[228:231], v[24:27], v[144:147]
    ds_read_b64_tr_b16 v[244:245], v5 offset:16672
    v_mfma_f32_16x16x32_bf16 v[148:151], v[228:231], v[28:31], v[148:151]
    ds_read_b64_tr_b16 v[246:247], v5 offset:17696
    s_waitcnt lgkmcnt(6)
    v_mfma_f32_16x16x32_bf16 v[88:91], v[232:235], v[32:35], v[88:91]
    ds_read_b64_tr_b16 v[224:225], v4 offset:16896
    v_mfma_f32_16x16x32_bf16 v[92:95], v[232:235], v[36:39], v[92:95]
    ds_read_b64_tr_b16 v[226:227], v4 offset:17920
    s_waitcnt lgkmcnt(6)
    v_mfma_f32_16x16x32_bf16 v[96:99], v[236:239], v[32:35], v[96:99]
    ds_read_b64_tr_b16 v[228:229], v5 offset:16928
    s_mov_b32 s23, 0xc000
    buffer_load_dwordx4 v[24:27], v6, s[8:11], s23 offen offset:3072 sc1
    v_mfma_f32_16x16x32_bf16 v[100:103], v[236:239], v[36:39], v[100:103]
    ds_read_b64_tr_b16 v[230:231], v5 offset:17952
    s_waitcnt lgkmcnt(6)
    v_mfma_f32_16x16x32_bf16 v[104:107], v[240:243], v[32:35], v[104:107]
    ds_read_b64_tr_b16 v[232:233], v4 offset:17152
    v_mfma_f32_16x16x32_bf16 v[108:111], v[240:243], v[36:39], v[108:111]
    ds_read_b64_tr_b16 v[234:235], v4 offset:18176
    s_mov_b32 s23, 0x2c000
    buffer_load_dwordx4 v[28:31], v6, s[8:11], s23 offen offset:3072 sc1
    s_mov_b32 s16, 0x544000
    buffer_load_dwordx4 v[184:187], v2, s[8:11], s16 offen sc1
    s_waitcnt lgkmcnt(6)
    v_mfma_f32_16x16x32_bf16 v[112:115], v[244:247], v[32:35], v[112:115]
    ds_read_b64_tr_b16 v[236:237], v5 offset:17184
    v_mfma_f32_16x16x32_bf16 v[116:119], v[244:247], v[36:39], v[116:119]
    ds_read_b64_tr_b16 v[238:239], v5 offset:18208
    s_waitcnt lgkmcnt(6)
    v_mfma_f32_16x16x32_bf16 v[120:123], v[224:227], v[32:35], v[120:123]
    v_mfma_f32_16x16x32_bf16 v[124:127], v[224:227], v[36:39], v[124:127]
    s_waitcnt vmcnt(15)
    s_barrier
    ds_read_b64_tr_b16 v[240:241], v4 offset:32768
    ds_read_b64_tr_b16 v[242:243], v4 offset:33792
    s_waitcnt lgkmcnt(6)
    v_mfma_f32_16x16x32_bf16 v[128:131], v[228:231], v[32:35], v[128:131]
    s_add_u32 s22, s24, 0x330000
    s_add_u32 m0, s20, 0x10000
    s_nop 0
    buffer_load_dwordx4 v3, s[4:7], s22 offen lds
    ds_read_b64_tr_b16 v[244:245], v5 offset:32800
    v_mfma_f32_16x16x32_bf16 v[132:135], v[228:231], v[36:39], v[132:135]
    ds_read_b64_tr_b16 v[246:247], v5 offset:33824
    s_waitcnt lgkmcnt(6)
    v_mfma_f32_16x16x32_bf16 v[136:139], v[232:235], v[32:35], v[136:139]
    ds_read_b64_tr_b16 v[224:225], v4 offset:33024
    v_mfma_f32_16x16x32_bf16 v[140:143], v[232:235], v[36:39], v[140:143]
    s_add_u32 s22, s24, 0x332000
    s_add_u32 m0, s20, 0x10400
    s_nop 0
    buffer_load_dwordx4 v3, s[4:7], s22 offen lds
    ds_read_b64_tr_b16 v[226:227], v4 offset:34048
    s_waitcnt lgkmcnt(6)
    v_mfma_f32_16x16x32_bf16 v[144:147], v[236:239], v[32:35], v[144:147]
    ds_read_b64_tr_b16 v[228:229], v5 offset:33056
    v_mfma_f32_16x16x32_bf16 v[148:151], v[236:239], v[36:39], v[148:151]
    ds_read_b64_tr_b16 v[230:231], v5 offset:34080
    s_waitcnt lgkmcnt(6)
    v_mfma_f32_16x16x32_bf16 v[88:91], v[240:243], v[40:43], v[88:91]
    ds_read_b64_tr_b16 v[232:233], v4 offset:33280
    v_mfma_f32_16x16x32_bf16 v[92:95], v[240:243], v[44:47], v[92:95]
    ds_read_b64_tr_b16 v[234:235], v4 offset:34304
    s_waitcnt lgkmcnt(6)
    v_mfma_f32_16x16x32_bf16 v[96:99], v[244:247], v[40:43], v[96:99]
    ds_read_b64_tr_b16 v[236:237], v5 offset:33312
    s_mov_b32 s23, 0xe000
    buffer_load_dwordx4 v[32:35], v6, s[8:11], s23 offen offset:3072 sc1
    v_mfma_f32_16x16x32_bf16 v[100:103], v[244:247], v[44:47], v[100:103]
    ds_read_b64_tr_b16 v[238:239], v5 offset:34336
    s_waitcnt lgkmcnt(6)
    v_mfma_f32_16x16x32_bf16 v[104:107], v[224:227], v[40:43], v[104:107]
    ds_read_b64_tr_b16 v[240:241], v4 offset:33536
    v_mfma_f32_16x16x32_bf16 v[108:111], v[224:227], v[44:47], v[108:111]
    ds_read_b64_tr_b16 v[242:243], v4 offset:34560
    s_mov_b32 s23, 0x2e000
    buffer_load_dwordx4 v[36:39], v6, s[8:11], s23 offen offset:3072 sc1
    s_waitcnt vmcnt(4)
    v_xor_b32 v16, s28, v184
    v_xor_b32 v17, s28, v185
    v_xor_b32 v18, s28, v186
    v_xor_b32 v19, s28, v187
    v_or3_b32 v16, v16, v17, v18
    v_or_b32 v16, v16, v19
    v_cmp_ne_u32 vcc, 0, v16
    s_cbranch_vccnz adaLN_cond__sliding_block_cached__moe_arch_mod__prompt_kernel_mf10r
adaLN_cond__sliding_block_cached__moe_arch_mod__prompt_kernel_mf10b:
    s_waitcnt lgkmcnt(6)
    v_mfma_f32_16x16x32_bf16 v[112:115], v[228:231], v[40:43], v[112:115]
    ds_read_b64_tr_b16 v[244:245], v5 offset:33568
    v_mfma_f32_16x16x32_bf16 v[116:119], v[228:231], v[44:47], v[116:119]
    ds_read_b64_tr_b16 v[246:247], v5 offset:34592
    s_waitcnt lgkmcnt(6)
    v_mfma_f32_16x16x32_bf16 v[120:123], v[232:235], v[40:43], v[120:123]
    v_mfma_f32_16x16x32_bf16 v[124:127], v[232:235], v[44:47], v[124:127]
    s_barrier
    ds_read_b64_tr_b16 v[224:225], v4 offset:49152
    ds_read_b64_tr_b16 v[226:227], v4 offset:50176
    s_waitcnt lgkmcnt(6)
    v_mfma_f32_16x16x32_bf16 v[128:131], v[236:239], v[40:43], v[128:131]
    s_add_u32 s22, s24, 0x3b0000
    s_add_u32 m0, s20, 0x14000
    s_nop 0
    buffer_load_dwordx4 v3, s[4:7], s22 offen lds
    ds_read_b64_tr_b16 v[228:229], v5 offset:49184
    v_mfma_f32_16x16x32_bf16 v[132:135], v[236:239], v[44:47], v[132:135]
    ds_read_b64_tr_b16 v[230:231], v5 offset:50208
    s_waitcnt lgkmcnt(6)
    v_mfma_f32_16x16x32_bf16 v[136:139], v[240:243], v[40:43], v[136:139]
    ds_read_b64_tr_b16 v[232:233], v4 offset:49408
    v_mfma_f32_16x16x32_bf16 v[140:143], v[240:243], v[44:47], v[140:143]
    s_add_u32 s22, s24, 0x3b2000
    s_add_u32 m0, s20, 0x14400
    s_nop 0
    buffer_load_dwordx4 v3, s[4:7], s22 offen lds
    ds_read_b64_tr_b16 v[234:235], v4 offset:50432
    s_waitcnt lgkmcnt(6)
    v_mfma_f32_16x16x32_bf16 v[144:147], v[244:247], v[40:43], v[144:147]
    ds_read_b64_tr_b16 v[236:237], v5 offset:49440
    v_mfma_f32_16x16x32_bf16 v[148:151], v[244:247], v[44:47], v[148:151]
    ds_read_b64_tr_b16 v[238:239], v5 offset:50464
    s_waitcnt lgkmcnt(6)
    v_mfma_f32_16x16x32_bf16 v[88:91], v[224:227], v[48:51], v[88:91]
    ds_read_b64_tr_b16 v[240:241], v4 offset:49664
    v_mfma_f32_16x16x32_bf16 v[92:95], v[224:227], v[52:55], v[92:95]
    ds_read_b64_tr_b16 v[242:243], v4 offset:50688
    s_waitcnt lgkmcnt(6)
    v_mfma_f32_16x16x32_bf16 v[96:99], v[228:231], v[48:51], v[96:99]
    ds_read_b64_tr_b16 v[244:245], v5 offset:49696
    v_mfma_f32_16x16x32_bf16 v[100:103], v[228:231], v[52:55], v[100:103]
    ds_read_b64_tr_b16 v[246:247], v5 offset:50720
    s_waitcnt lgkmcnt(6)
    v_mfma_f32_16x16x32_bf16 v[104:107], v[232:235], v[48:51], v[104:107]
    ds_read_b64_tr_b16 v[224:225], v4 offset:49920
    v_mfma_f32_16x16x32_bf16 v[108:111], v[232:235], v[52:55], v[108:111]
    ds_read_b64_tr_b16 v[226:227], v4 offset:50944
    v_lshrrev_b32 v16, 4, v1
    v_lshlrev_b32 v16, 3, v16
    s_lshl_b32 s16, s31, 8
    s_add_u32 s16, s16, 0x540000
    buffer_load_dwordx2 v[248:249], v16, s[8:11], s16 offen offset:0 sc1
    buffer_load_dwordx2 v[250:251], v16, s[8:11], s16 offen offset:32 sc1
    buffer_load_dwordx2 v[252:253], v16, s[8:11], s16 offen offset:64 sc1
    buffer_load_dwordx2 v[254:255], v16, s[8:11], s16 offen offset:96 sc1
    s_waitcnt lgkmcnt(6)
    v_mfma_f32_16x16x32_bf16 v[112:115], v[236:239], v[48:51], v[112:115]
    ds_read_b64_tr_b16 v[228:229], v5 offset:49952
    v_mfma_f32_16x16x32_bf16 v[116:119], v[236:239], v[52:55], v[116:119]
    ds_read_b64_tr_b16 v[230:231], v5 offset:50976
    s_waitcnt lgkmcnt(6)
    v_mfma_f32_16x16x32_bf16 v[120:123], v[240:243], v[48:51], v[120:123]
    v_mfma_f32_16x16x32_bf16 v[124:127], v[240:243], v[52:55], v[124:127]
    s_barrier
    ds_read_b64_tr_b16 v[232:233], v7 offset:0
    ds_read_b64_tr_b16 v[234:235], v7 offset:1024
    s_waitcnt lgkmcnt(6)
    v_mfma_f32_16x16x32_bf16 v[128:131], v[244:247], v[48:51], v[128:131]
    ds_read_b64_tr_b16 v[236:237], v8 offset:32
    v_mfma_f32_16x16x32_bf16 v[132:135], v[244:247], v[52:55], v[132:135]
    ds_read_b64_tr_b16 v[238:239], v8 offset:1056
    s_waitcnt lgkmcnt(6)
    v_mfma_f32_16x16x32_bf16 v[136:139], v[224:227], v[48:51], v[136:139]
    ds_read_b64_tr_b16 v[240:241], v7 offset:256
    v_mfma_f32_16x16x32_bf16 v[140:143], v[224:227], v[52:55], v[140:143]
    ds_read_b64_tr_b16 v[242:243], v7 offset:1280
    s_waitcnt lgkmcnt(6)
    v_mfma_f32_16x16x32_bf16 v[144:147], v[228:231], v[48:51], v[144:147]
    ds_read_b64_tr_b16 v[244:245], v8 offset:288
    v_mfma_f32_16x16x32_bf16 v[148:151], v[228:231], v[52:55], v[148:151]
    ds_read_b64_tr_b16 v[246:247], v8 offset:1312
    s_waitcnt lgkmcnt(6)
    v_mfma_f32_16x16x32_bf16 v[88:91], v[232:235], v[56:59], v[88:91]
    ds_read_b64_tr_b16 v[224:225], v7 offset:512
    v_mfma_f32_16x16x32_bf16 v[92:95], v[232:235], v[60:63], v[92:95]
    ds_read_b64_tr_b16 v[226:227], v7 offset:1536
    s_waitcnt lgkmcnt(6)
    v_mfma_f32_16x16x32_bf16 v[96:99], v[236:239], v[56:59], v[96:99]
    ds_read_b64_tr_b16 v[228:229], v8 offset:544
    v_mfma_f32_16x16x32_bf16 v[100:103], v[236:239], v[60:63], v[100:103]
    ds_read_b64_tr_b16 v[230:231], v8 offset:1568
    s_waitcnt lgkmcnt(6)
    v_mfma_f32_16x16x32_bf16 v[104:107], v[240:243], v[56:59], v[104:107]
    ds_read_b64_tr_b16 v[232:233], v7 offset:768
    v_mfma_f32_16x16x32_bf16 v[108:111], v[240:243], v[60:63], v[108:111]
    ds_read_b64_tr_b16 v[234:235], v7 offset:1792
    s_waitcnt lgkmcnt(6)
    v_mfma_f32_16x16x32_bf16 v[112:115], v[244:247], v[56:59], v[112:115]
    ds_read_b64_tr_b16 v[236:237], v8 offset:800
    v_mfma_f32_16x16x32_bf16 v[116:119], v[244:247], v[60:63], v[116:119]
    ds_read_b64_tr_b16 v[238:239], v8 offset:1824
    s_waitcnt lgkmcnt(6)
    v_mfma_f32_16x16x32_bf16 v[120:123], v[224:227], v[56:59], v[120:123]
    v_mfma_f32_16x16x32_bf16 v[124:127], v[224:227], v[60:63], v[124:127]
    s_barrier
    ds_read_b64_tr_b16 v[240:241], v7 offset:16384
    ds_read_b64_tr_b16 v[242:243], v7 offset:17408
    s_waitcnt lgkmcnt(6)
    v_mfma_f32_16x16x32_bf16 v[128:131], v[228:231], v[56:59], v[128:131]
    ds_read_b64_tr_b16 v[244:245], v8 offset:16416
    v_mfma_f32_16x16x32_bf16 v[132:135], v[228:231], v[60:63], v[132:135]
    ds_read_b64_tr_b16 v[246:247], v8 offset:17440
    s_waitcnt lgkmcnt(6)
    v_mfma_f32_16x16x32_bf16 v[136:139], v[232:235], v[56:59], v[136:139]
    ds_read_b64_tr_b16 v[224:225], v7 offset:16640
    v_mfma_f32_16x16x32_bf16 v[140:143], v[232:235], v[60:63], v[140:143]
    ds_read_b64_tr_b16 v[226:227], v7 offset:17664
    s_waitcnt lgkmcnt(6)
    v_mfma_f32_16x16x32_bf16 v[144:147], v[236:239], v[56:59], v[144:147]
    ds_read_b64_tr_b16 v[228:229], v8 offset:16672
    v_mfma_f32_16x16x32_bf16 v[148:151], v[236:239], v[60:63], v[148:151]
    ds_read_b64_tr_b16 v[230:231], v8 offset:17696
    s_waitcnt lgkmcnt(6)
    v_mfma_f32_16x16x32_bf16 v[88:91], v[240:243], v[64:67], v[88:91]
    ds_read_b64_tr_b16 v[232:233], v7 offset:16896
    v_mfma_f32_16x16x32_bf16 v[92:95], v[240:243], v[68:71], v[92:95]
    ds_read_b64_tr_b16 v[234:235], v7 offset:17920
    s_waitcnt lgkmcnt(6)
    v_mfma_f32_16x16x32_bf16 v[96:99], v[244:247], v[64:67], v[96:99]
    ds_read_b64_tr_b16 v[236:237], v8 offset:16928
    v_mfma_f32_16x16x32_bf16 v[100:103], v[244:247], v[68:71], v[100:103]
    ds_read_b64_tr_b16 v[238:239], v8 offset:17952
    s_waitcnt lgkmcnt(6)
    v_mfma_f32_16x16x32_bf16 v[104:107], v[224:227], v[64:67], v[104:107]
    ds_read_b64_tr_b16 v[240:241], v7 offset:17152
    v_mfma_f32_16x16x32_bf16 v[108:111], v[224:227], v[68:71], v[108:111]
    ds_read_b64_tr_b16 v[242:243], v7 offset:18176
    s_waitcnt lgkmcnt(6)
    v_mfma_f32_16x16x32_bf16 v[112:115], v[228:231], v[64:67], v[112:115]
    ds_read_b64_tr_b16 v[244:245], v8 offset:17184
    v_mfma_f32_16x16x32_bf16 v[116:119], v[228:231], v[68:71], v[116:119]
    ds_read_b64_tr_b16 v[246:247], v8 offset:18208
    s_waitcnt lgkmcnt(6)
    v_mfma_f32_16x16x32_bf16 v[120:123], v[232:235], v[64:67], v[120:123]
    v_mfma_f32_16x16x32_bf16 v[124:127], v[232:235], v[68:71], v[124:127]
    s_waitcnt vmcnt(8)
    s_barrier
    ds_read_b64_tr_b16 v[224:225], v4 offset:0
    ds_read_b64_tr_b16 v[226:227], v4 offset:1024
    s_waitcnt lgkmcnt(6)
    v_mfma_f32_16x16x32_bf16 v[128:131], v[236:239], v[64:67], v[128:131]
    ds_read_b64_tr_b16 v[228:229], v5 offset:32
    v_mfma_f32_16x16x32_bf16 v[132:135], v[236:239], v[68:71], v[132:135]
    ds_read_b64_tr_b16 v[230:231], v5 offset:1056
    s_waitcnt lgkmcnt(6)
    v_mfma_f32_16x16x32_bf16 v[136:139], v[240:243], v[64:67], v[136:139]
    ds_read_b64_tr_b16 v[232:233], v4 offset:256
    v_mfma_f32_16x16x32_bf16 v[140:143], v[240:243], v[68:71], v[140:143]
    ds_read_b64_tr_b16 v[234:235], v4 offset:1280
    s_waitcnt lgkmcnt(6)
    v_mfma_f32_16x16x32_bf16 v[144:147], v[244:247], v[64:67], v[144:147]
    ds_read_b64_tr_b16 v[236:237], v5 offset:288
    v_mfma_f32_16x16x32_bf16 v[148:151], v[244:247], v[68:71], v[148:151]
    ds_read_b64_tr_b16 v[238:239], v5 offset:1312
    s_waitcnt lgkmcnt(6)
    v_mfma_f32_16x16x32_bf16 v[88:91], v[224:227], v[24:27], v[88:91]
    ds_read_b64_tr_b16 v[240:241], v4 offset:512
    v_mfma_f32_16x16x32_bf16 v[92:95], v[224:227], v[28:31], v[92:95]
    ds_read_b64_tr_b16 v[242:243], v4 offset:1536
    s_waitcnt lgkmcnt(6)
    v_mfma_f32_16x16x32_bf16 v[96:99], v[228:231], v[24:27], v[96:99]
    ds_read_b64_tr_b16 v[244:245], v5 offset:544
    v_mfma_f32_16x16x32_bf16 v[100:103], v[228:231], v[28:31], v[100:103]
    ds_read_b64_tr_b16 v[246:247], v5 offset:1568
    s_waitcnt lgkmcnt(6)
    v_mfma_f32_16x16x32_bf16 v[104:107], v[232:235], v[24:27], v[104:107]
    ds_read_b64_tr_b16 v[224:225], v4 offset:768
    v_mfma_f32_16x16x32_bf16 v[108:111], v[232:235], v[28:31], v[108:111]
    ds_read_b64_tr_b16 v[226:227], v4 offset:1792
    s_waitcnt lgkmcnt(6)
    v_mfma_f32_16x16x32_bf16 v[112:115], v[236:239], v[24:27], v[112:115]
    ds_read_b64_tr_b16 v[228:229], v5 offset:800
    v_mfma_f32_16x16x32_bf16 v[116:119], v[236:239], v[28:31], v[116:119]
    ds_read_b64_tr_b16 v[230:231], v5 offset:1824
    s_waitcnt lgkmcnt(6)
    v_mfma_f32_16x16x32_bf16 v[120:123], v[240:243], v[24:27], v[120:123]
    v_mfma_f32_16x16x32_bf16 v[124:127], v[240:243], v[28:31], v[124:127]
    s_waitcnt vmcnt(4)
    s_barrier
    ds_read_b64_tr_b16 v[232:233], v4 offset:16384
    ds_read_b64_tr_b16 v[234:235], v4 offset:17408
    s_waitcnt lgkmcnt(6)
    v_mfma_f32_16x16x32_bf16 v[128:131], v[244:247], v[24:27], v[128:131]
    ds_read_b64_tr_b16 v[236:237], v5 offset:16416
    v_mfma_f32_16x16x32_bf16 v[132:135], v[244:247], v[28:31], v[132:135]
    ds_read_b64_tr_b16 v[238:239], v5 offset:17440
    s_waitcnt lgkmcnt(6)
    v_mfma_f32_16x16x32_bf16 v[136:139], v[224:227], v[24:27], v[136:139]
    ds_read_b64_tr_b16 v[240:241], v4 offset:16640
    v_mfma_f32_16x16x32_bf16 v[140:143], v[224:227], v[28:31], v[140:143]
    ds_read_b64_tr_b16 v[242:243], v4 offset:17664
    s_waitcnt lgkmcnt(6)
    v_mfma_f32_16x16x32_bf16 v[144:147], v[228:231], v[24:27], v[144:147]
    ds_read_b64_tr_b16 v[244:245], v5 offset:16672
    v_mfma_f32_16x16x32_bf16 v[148:151], v[228:231], v[28:31], v[148:151]
    ds_read_b64_tr_b16 v[246:247], v5 offset:17696
    s_waitcnt lgkmcnt(6)
    v_mfma_f32_16x16x32_bf16 v[88:91], v[232:235], v[32:35], v[88:91]
    ds_read_b64_tr_b16 v[224:225], v4 offset:16896
    v_mfma_f32_16x16x32_bf16 v[92:95], v[232:235], v[36:39], v[92:95]
    ds_read_b64_tr_b16 v[226:227], v4 offset:17920
    s_waitcnt lgkmcnt(6)
    v_mfma_f32_16x16x32_bf16 v[96:99], v[236:239], v[32:35], v[96:99]
    ds_read_b64_tr_b16 v[228:229], v5 offset:16928
    v_mfma_f32_16x16x32_bf16 v[100:103], v[236:239], v[36:39], v[100:103]
    ds_read_b64_tr_b16 v[230:231], v5 offset:17952
    s_waitcnt lgkmcnt(6)
    v_mfma_f32_16x16x32_bf16 v[104:107], v[240:243], v[32:35], v[104:107]
    ds_read_b64_tr_b16 v[232:233], v4 offset:17152
    v_mfma_f32_16x16x32_bf16 v[108:111], v[240:243], v[36:39], v[108:111]
    ds_read_b64_tr_b16 v[234:235], v4 offset:18176
    s_waitcnt lgkmcnt(6)
    v_mfma_f32_16x16x32_bf16 v[112:115], v[244:247], v[32:35], v[112:115]
    ds_read_b64_tr_b16 v[236:237], v5 offset:17184
    v_mfma_f32_16x16x32_bf16 v[116:119], v[244:247], v[36:39], v[116:119]
    ds_read_b64_tr_b16 v[238:239], v5 offset:18208
    s_waitcnt lgkmcnt(6)
    v_mfma_f32_16x16x32_bf16 v[120:123], v[224:227], v[32:35], v[120:123]
    v_mfma_f32_16x16x32_bf16 v[124:127], v[224:227], v[36:39], v[124:127]
    s_waitcnt lgkmcnt(4)
    v_mfma_f32_16x16x32_bf16 v[128:131], v[228:231], v[32:35], v[128:131]
    v_mfma_f32_16x16x32_bf16 v[132:135], v[228:231], v[36:39], v[132:135]
    s_waitcnt lgkmcnt(2)
    v_mfma_f32_16x16x32_bf16 v[136:139], v[232:235], v[32:35], v[136:139]
    v_mfma_f32_16x16x32_bf16 v[140:143], v[232:235], v[36:39], v[140:143]
    s_waitcnt lgkmcnt(0)
    v_mfma_f32_16x16x32_bf16 v[144:147], v[236:239], v[32:35], v[144:147]
    v_mfma_f32_16x16x32_bf16 v[148:151], v[236:239], v[36:39], v[148:151]
    s_lshl_b32 s16, s3, 13
    s_xor_b32 s17, s16, 0x8000
    s_add_u32 s16, s16, 0x18000
    s_add_u32 s17, s17, 0x18000
    v_add_u32 v16, s16, v2
    s_mov_b32 s16, s17
    v_add_u32 v17, s16, v2
    ds_write_b128 v16, v[120:123] offset:0
    ds_write_b128 v16, v[124:127] offset:1024
    ds_write_b128 v16, v[128:131] offset:2048
    ds_write_b128 v16, v[132:135] offset:3072
    ds_write_b128 v16, v[136:139] offset:4096
    ds_write_b128 v16, v[140:143] offset:5120
    ds_write_b128 v16, v[144:147] offset:6144
    ds_write_b128 v16, v[148:151] offset:7168
    s_waitcnt vmcnt(3)
    v_lshlrev_b32 v24, 16, v248
    v_and_b32 v25, 0xffff0000, v248
    v_lshlrev_b32 v26, 16, v249
    v_and_b32 v27, 0xffff0000, v249
    s_waitcnt vmcnt(2)
    v_lshlrev_b32 v28, 16, v250
    v_and_b32 v29, 0xffff0000, v250
    v_lshlrev_b32 v30, 16, v251
    v_and_b32 v31, 0xffff0000, v251
    s_waitcnt vmcnt(1)
    v_lshlrev_b32 v32, 16, v252
    v_and_b32 v33, 0xffff0000, v252
    v_lshlrev_b32 v34, 16, v253
    v_and_b32 v35, 0xffff0000, v253
    s_waitcnt vmcnt(0)
    v_lshlrev_b32 v36, 16, v254
    v_and_b32 v37, 0xffff0000, v254
    v_lshlrev_b32 v38, 16, v255
    v_and_b32 v39, 0xffff0000, v255
    v_and_b32 v18, 15, v1
    v_lshlrev_b32 v18, 6, v18
    v_lshrrev_b32 v19, 4, v1
    v_and_b32 v20, 1, v19
    v_lshl_add_u32 v18, v20, 5, v18
    v_lshrrev_b32 v19, 1, v19
    v_lshl_add_u32 v18, v19, 4, v18
    s_and_b32 s17, s3, 3
    s_lshl_b32 s18, s30, 2
    s_add_u32 s18, s18, s17
    s_lshl_b32 s18, s18, 16
    s_lshl_b32 s19, s15, 22
    s_add_u32 s18, s18, s19
    s_lshl_b32 s19, s31, 12
    s_add_u32 s18, s18, s19
    s_add_u32 s18, s18, 0x2000000
    s_add_u32 s19, s18, 32768
    s_waitcnt lgkmcnt(0)
    s_barrier
    ds_read_b128 v[40:43], v17 offset:0
    ds_read_b128 v[44:47], v17 offset:1024
    ds_read_b128 v[48:51], v17 offset:2048
    ds_read_b128 v[52:55], v17 offset:3072
    ds_read_b128 v[56:59], v17 offset:4096
    ds_read_b128 v[60:63], v17 offset:5120
    ds_read_b128 v[64:67], v17 offset:6144
    ds_read_b128 v[68:71], v17 offset:7168
    s_waitcnt lgkmcnt(7)
    v_pk_add_f32 v[88:89], v[88:89], v[40:41]
    v_pk_add_f32 v[90:91], v[90:91], v[42:43]
    v_pk_mul_f32 v[88:89], v[88:89], v[24:25]
    v_pk_mul_f32 v[90:91], v[90:91], v[26:27]
    v_cvt_pk_bf16_f32 v224, v88, v89
    v_cvt_pk_bf16_f32 v225, v90, v91
    s_waitcnt lgkmcnt(5)
    v_pk_add_f32 v[96:97], v[96:97], v[48:49]
    v_pk_add_f32 v[98:99], v[98:99], v[50:51]
    v_pk_mul_f32 v[96:97], v[96:97], v[28:29]
    v_pk_mul_f32 v[98:99], v[98:99], v[30:31]
    v_cvt_pk_bf16_f32 v226, v96, v97
    v_cvt_pk_bf16_f32 v227, v98, v99
    s_nop 0
    v_permlane16_swap_b32 v224, v226
    v_permlane16_swap_b32 v225, v227
    buffer_store_dwordx4 v[224:227], v18, s[8:11], s18 offen offset:0 sc1
    v_pk_add_f32 v[92:93], v[92:93], v[44:45]
    v_pk_add_f32 v[94:95], v[94:95], v[46:47]
    v_pk_mul_f32 v[92:93], v[92:93], v[24:25]
    v_pk_mul_f32 v[94:95], v[94:95], v[26:27]
    v_cvt_pk_bf16_f32 v228, v92, v93
    v_cvt_pk_bf16_f32 v229, v94, v95
    s_waitcnt lgkmcnt(4)
    v_pk_add_f32 v[100:101], v[100:101], v[52:53]
    v_pk_add_f32 v[102:103], v[102:103], v[54:55]
    v_pk_mul_f32 v[100:101], v[100:101], v[28:29]
    v_pk_mul_f32 v[102:103], v[102:103], v[30:31]
    v_cvt_pk_bf16_f32 v230, v100, v101
    v_cvt_pk_bf16_f32 v231, v102, v103
    s_nop 0
    v_permlane16_swap_b32 v228, v230
    v_permlane16_swap_b32 v229, v231
    buffer_store_dwordx4 v[228:231], v18, s[8:11], s19 offen offset:0 sc1
    s_waitcnt lgkmcnt(3)
    v_pk_add_f32 v[104:105], v[104:105], v[56:57]
    v_pk_add_f32 v[106:107], v[106:107], v[58:59]
    v_pk_mul_f32 v[104:105], v[104:105], v[32:33]
    v_pk_mul_f32 v[106:107], v[106:107], v[34:35]
    v_cvt_pk_bf16_f32 v232, v104, v105
    v_cvt_pk_bf16_f32 v233, v106, v107
    s_waitcnt lgkmcnt(1)
    v_pk_add_f32 v[112:113], v[112:113], v[64:65]
    v_pk_add_f32 v[114:115], v[114:115], v[66:67]
    v_pk_mul_f32 v[112:113], v[112:113], v[36:37]
    v_pk_mul_f32 v[114:115], v[114:115], v[38:39]
    v_cvt_pk_bf16_f32 v234, v112, v113
    v_cvt_pk_bf16_f32 v235, v114, v115
    s_nop 0
    v_permlane16_swap_b32 v232, v234
    v_permlane16_swap_b32 v233, v235
    buffer_store_dwordx4 v[232:235], v18, s[8:11], s18 offen offset:1024 sc1
    v_pk_add_f32 v[108:109], v[108:109], v[60:61]
    v_pk_add_f32 v[110:111], v[110:111], v[62:63]
    v_pk_mul_f32 v[108:109], v[108:109], v[32:33]
    v_pk_mul_f32 v[110:111], v[110:111], v[34:35]
    v_cvt_pk_bf16_f32 v236, v108, v109
    v_cvt_pk_bf16_f32 v237, v110, v111
    s_waitcnt lgkmcnt(0)
    v_pk_add_f32 v[116:117], v[116:117], v[68:69]
    v_pk_add_f32 v[118:119], v[118:119], v[70:71]
    v_pk_mul_f32 v[116:117], v[116:117], v[36:37]
    v_pk_mul_f32 v[118:119], v[118:119], v[38:39]
    v_cvt_pk_bf16_f32 v238, v116, v117
    v_cvt_pk_bf16_f32 v239, v118, v119
    s_nop 0
    v_permlane16_swap_b32 v236, v238
    v_permlane16_swap_b32 v237, v239
    buffer_store_dwordx4 v[236:239], v18, s[8:11], s19 offen offset:1024 sc1
    s_mov_b64 s[64:65], s[44:45]
    s_mov_b32 s66, 0x800
    s_mov_b32 s67, 0x20000
    s_mov_b64 s[76:77], s[32:33]
    s_mov_b32 s78, 0x400000
    s_mov_b32 s79, 0x20000
    s_mov_b64 s[68:69], s[56:57]
    s_mov_b32 s70, 0x400000
    s_mov_b32 s71, 0x20000
    s_lshl_b32 s14, s31, 1
    s_add_u32 s14, s14, s15
    s_lshl_b32 s14, s14, 3
    s_add_u32 s14, s14, s3
    s_lshl_b32 s16, s30, 7
    s_add_u32 s14, s14, s16
    s_lshl_b32 s16, s14, 11
    buffer_load_dwordx4 v[216:219], v2, s[76:79], s16 offen offset:0
    buffer_load_dwordx4 v[220:223], v2, s[76:79], s16 offen offset:1024
    s_lshl_b32 s16, s3, 10
    s_add_u32 m0, s16, 81920
    s_add_u32 s16, s16, 0x540800
    buffer_load_dwordx4 v2, s[8:11], s16 offen sc1 lds
    s_lshl_b32 s16, s30, 5
    s_lshl_b32 s17, s31, 1
    s_add_u32 s16, s16, s17
    s_add_u32 s16, s16, s15
    s_lshl_b32 s16, s16, 2
    s_add_u32 s16, s16, 0x530000
    s_cmp_eq_u32 s3, 0
    s_cselect_b32 s16, s16, 0x7ffffff0
    v_mov_b32 v16, s28
    v_mov_b32 v17, 0
    s_lshr_b32 s18, s14, 4
    s_lshl_b32 s18, s18, 15
    s_and_b32 s19, s14, 15
    s_lshl_b32 s19, s19, 6
    s_add_u32 s18, s18, s19
    s_add_u32 s18, s18, 0x2000000
    s_add_u32 s19, s18, 16384
    v_lshrrev_b32 v18, 2, v1
    v_lshlrev_b32 v18, 10, v18
    v_and_b32 v19, 3, v1
    v_lshl_add_u32 v18, v19, 4, v18
    v_add_u32 v19, 0x400000, v18
    s_lshl_b32 s25, s30, 7
    s_add_u32 s25, s25, 0x530000
    v_and_b32 v20, 15, v1
    v_lshlrev_b32 v20, 2, v20
    s_waitcnt vmcnt(3)
    s_waitcnt vmcnt(0)
    s_barrier
    s_mov_b64 exec, 1
    buffer_store_dword v16, v17, s[8:11], s16 offen sc1
    s_mov_b64 exec, -1
    v_add_u32 v16, 81920, v2
    ds_read_b128 v[184:187], v16 offset:0
    ds_read_b128 v[188:191], v16 offset:1024
    ds_read_b128 v[192:195], v16 offset:2048
    ds_read_b128 v[196:199], v16 offset:3072
    ds_read_b128 v[200:203], v16 offset:4096
    ds_read_b128 v[204:207], v16 offset:5120
    ds_read_b128 v[208:211], v16 offset:6144
    ds_read_b128 v[212:215], v16 offset:7168
    v_mov_b32 v94, 0
    v_mov_b32 v95, 0
    s_waitcnt lgkmcnt(5)
    v_lshlrev_b32 v76, 16, v192
    v_and_b32 v77, 0xffff0000, v192
    s_waitcnt lgkmcnt(1)
    v_lshlrev_b32 v78, 16, v208
    v_and_b32 v79, 0xffff0000, v208
    v_pk_mul_f32 v[60:61], v[76:77], v[78:79]
    v_lshlrev_b32 v76, 16, v184
    v_and_b32 v77, 0xffff0000, v184
    v_fmac_f32 v94, v76, v78
    v_fmac_f32 v94, v77, v79
    v_add_f32 v95, v95, v60
    v_add_f32 v95, v95, v61
    v_lshlrev_b32 v76, 16, v193
    v_and_b32 v77, 0xffff0000, v193
    v_lshlrev_b32 v78, 16, v209
    v_and_b32 v79, 0xffff0000, v209
    v_pk_mul_f32 v[62:63], v[76:77], v[78:79]
    v_lshlrev_b32 v76, 16, v185
    v_and_b32 v77, 0xffff0000, v185
    v_fmac_f32 v94, v76, v78
    v_fmac_f32 v94, v77, v79
    v_add_f32 v95, v95, v62
    v_add_f32 v95, v95, v63
    v_lshlrev_b32 v76, 16, v194
    v_and_b32 v77, 0xffff0000, v194
    v_lshlrev_b32 v78, 16, v210
    v_and_b32 v79, 0xffff0000, v210
    v_pk_mul_f32 v[64:65], v[76:77], v[78:79]
    v_lshlrev_b32 v76, 16, v186
    v_and_b32 v77, 0xffff0000, v186
    v_fmac_f32 v94, v76, v78
    v_fmac_f32 v94, v77, v79
    v_add_f32 v95, v95, v64
    v_add_f32 v95, v95, v65
    v_lshlrev_b32 v76, 16, v195
    v_and_b32 v77, 0xffff0000, v195
    v_lshlrev_b32 v78, 16, v211
    v_and_b32 v79, 0xffff0000, v211
    v_pk_mul_f32 v[66:67], v[76:77], v[78:79]
    v_lshlrev_b32 v76, 16, v187
    v_and_b32 v77, 0xffff0000, v187
    v_fmac_f32 v94, v76, v78
    v_fmac_f32 v94, v77, v79
    v_add_f32 v95, v95, v66
    v_add_f32 v95, v95, v67
    v_lshlrev_b32 v76, 16, v196
    v_and_b32 v77, 0xffff0000, v196
    s_waitcnt lgkmcnt(0)
    v_lshlrev_b32 v78, 16, v212
    v_and_b32 v79, 0xffff0000, v212
    v_pk_mul_f32 v[68:69], v[76:77], v[78:79]
    v_lshlrev_b32 v76, 16, v188
    v_and_b32 v77, 0xffff0000, v188
    v_fmac_f32 v94, v76, v78
    v_fmac_f32 v94, v77, v79
    v_add_f32 v95, v95, v68
    v_add_f32 v95, v95, v69
    v_lshlrev_b32 v76, 16, v197
    v_and_b32 v77, 0xffff0000, v197
    v_lshlrev_b32 v78, 16, v213
    v_and_b32 v79, 0xffff0000, v213
    v_pk_mul_f32 v[70:71], v[76:77], v[78:79]
    v_lshlrev_b32 v76, 16, v189
    v_and_b32 v77, 0xffff0000, v189
    v_fmac_f32 v94, v76, v78
    v_fmac_f32 v94, v77, v79
    v_add_f32 v95, v95, v70
    v_add_f32 v95, v95, v71
    v_lshlrev_b32 v76, 16, v198
    v_and_b32 v77, 0xffff0000, v198
    v_lshlrev_b32 v78, 16, v214
    v_and_b32 v79, 0xffff0000, v214
    v_pk_mul_f32 v[72:73], v[76:77], v[78:79]
    v_lshlrev_b32 v76, 16, v190
    v_and_b32 v77, 0xffff0000, v190
    v_fmac_f32 v94, v76, v78
    v_fmac_f32 v94, v77, v79
    v_add_f32 v95, v95, v72
    v_add_f32 v95, v95, v73
    v_lshlrev_b32 v76, 16, v199
    v_and_b32 v77, 0xffff0000, v199
    v_lshlrev_b32 v78, 16, v215
    v_and_b32 v79, 0xffff0000, v215
    v_pk_mul_f32 v[74:75], v[76:77], v[78:79]
    v_lshlrev_b32 v76, 16, v191
    v_and_b32 v77, 0xffff0000, v191
    v_fmac_f32 v94, v76, v78
    v_fmac_f32 v94, v77, v79
    v_add_f32 v95, v95, v74
    v_add_f32 v95, v95, v75
    v_add_f32_dpp v94, v94, v94 row_ror:1 row_mask:0xf bank_mask:0xf
    s_nop 0
    v_add_f32_dpp v95, v95, v95 row_ror:1 row_mask:0xf bank_mask:0xf
    v_add_f32_dpp v94, v94, v94 row_ror:2 row_mask:0xf bank_mask:0xf
    s_nop 0
    v_add_f32_dpp v95, v95, v95 row_ror:2 row_mask:0xf bank_mask:0xf
    v_add_f32_dpp v94, v94, v94 row_ror:4 row_mask:0xf bank_mask:0xf
    s_nop 0
    v_add_f32_dpp v95, v95, v95 row_ror:4 row_mask:0xf bank_mask:0xf
    v_add_f32_dpp v94, v94, v94 row_ror:8 row_mask:0xf bank_mask:0xf
    s_nop 0
    v_add_f32_dpp v95, v95, v95 row_ror:8 row_mask:0xf bank_mask:0xf
    v_mov_b32 v76, v94
    s_nop 1
    v_permlane16_swap_b32 v94, v76
    v_add_f32 v94, v94, v76
    v_mov_b32 v77, v95
    s_nop 1
    v_permlane16_swap_b32 v95, v77
    v_add_f32 v95, v95, v77
    v_mov_b32 v76, v94
    s_nop 1
    v_permlane32_swap_b32 v94, v76
    v_add_f32 v94, v94, v76
    v_mov_b32 v77, v95
    s_nop 1
    v_permlane32_swap_b32 v95, v77
    v_add_f32 v95, v95, v77
    v_lshlrev_b32 v28, 16, v216
    v_and_b32 v29, 0xffff0000, v216
    v_lshlrev_b32 v30, 16, v217
    v_and_b32 v31, 0xffff0000, v217
    v_lshlrev_b32 v32, 16, v218
    v_and_b32 v33, 0xffff0000, v218
    v_lshlrev_b32 v34, 16, v219
    v_and_b32 v35, 0xffff0000, v219
    v_lshlrev_b32 v36, 16, v220
    v_and_b32 v37, 0xffff0000, v220
    v_lshlrev_b32 v38, 16, v221
    v_and_b32 v39, 0xffff0000, v221
    v_lshlrev_b32 v40, 16, v222
    v_and_b32 v41, 0xffff0000, v222
    v_lshlrev_b32 v42, 16, v223
    v_and_b32 v43, 0xffff0000, v223
    s_mov_b32 s27, 0
adaLN_cond__sliding_block_cached__moe_arch_mod__prompt_kernel_a11p:
    buffer_load_dword v76, v20, s[8:11], s25 offen sc1
    s_waitcnt vmcnt(0)
    v_cmp_ne_u32 vcc, s28, v76
    s_add_u32 s27, s27, 1
    s_cmp_ge_u32 s27, 65536
    s_cbranch_scc1 adaLN_cond__sliding_block_cached__moe_arch_mod__prompt_kernel_a11g
    s_cbranch_vccnz adaLN_cond__sliding_block_cached__moe_arch_mod__prompt_kernel_a11p
adaLN_cond__sliding_block_cached__moe_arch_mod__prompt_kernel_a11g:
    buffer_load_dwordx4 v[44:47], v18, s[8:11], s18 offen sc1
    buffer_load_dwordx4 v[52:55], v19, s[8:11], s18 offen sc1
    buffer_load_dwordx4 v[48:51], v18, s[8:11], s19 offen sc1
    buffer_load_dwordx4 v[56:59], v19, s[8:11], s19 offen sc1
    v_lshlrev_b32 v21, 2, v0
    s_mov_b32 s16, 0x540800
    buffer_load_dword v106, v21, s[8:11], s16 offen sc1
    buffer_load_dword v104, v21, s[8:11], s16 offen offset:2048 sc1
    s_waitcnt vmcnt(5)
    v_lshlrev_b32 v76, 16, v44
    v_and_b32 v77, 0xffff0000, v44
    s_waitcnt vmcnt(4)
    v_lshlrev_b32 v78, 16, v52
    v_and_b32 v79, 0xffff0000, v52
    v_pk_add_f32 v[76:77], v[76:77], v[78:79]
    v_pk_add_f32 v[28:29], v[28:29], v[76:77]
    v_cvt_pk_bf16_f32 v16, v28, v29
    v_lshlrev_b32 v28, 16, v16
    v_and_b32 v29, 0xffff0000, v16
    v_lshlrev_b32 v80, 16, v45
    v_and_b32 v81, 0xffff0000, v45
    v_lshlrev_b32 v82, 16, v53
    v_and_b32 v83, 0xffff0000, v53
    v_pk_add_f32 v[80:81], v[80:81], v[82:83]
    v_pk_add_f32 v[30:31], v[30:31], v[80:81]
    v_cvt_pk_bf16_f32 v17, v30, v31
    v_lshlrev_b32 v30, 16, v17
    v_and_b32 v31, 0xffff0000, v17
    v_lshlrev_b32 v76, 16, v46
    v_and_b32 v77, 0xffff0000, v46
    v_lshlrev_b32 v78, 16, v54
    v_and_b32 v79, 0xffff0000, v54
    v_pk_add_f32 v[76:77], v[76:77], v[78:79]
    v_pk_add_f32 v[32:33], v[32:33], v[76:77]
    v_cvt_pk_bf16_f32 v16, v32, v33
    v_lshlrev_b32 v32, 16, v16
    v_and_b32 v33, 0xffff0000, v16
    v_lshlrev_b32 v80, 16, v47
    v_and_b32 v81, 0xffff0000, v47
    v_lshlrev_b32 v82, 16, v55
    v_and_b32 v83, 0xffff0000, v55
    v_pk_add_f32 v[80:81], v[80:81], v[82:83]
    v_pk_add_f32 v[34:35], v[34:35], v[80:81]
    v_cvt_pk_bf16_f32 v17, v34, v35
    v_lshlrev_b32 v34, 16, v17
    v_and_b32 v35, 0xffff0000, v17
    s_waitcnt vmcnt(3)
    v_lshlrev_b32 v76, 16, v48
    v_and_b32 v77, 0xffff0000, v48
    s_waitcnt vmcnt(2)
    v_lshlrev_b32 v78, 16, v56
    v_and_b32 v79, 0xffff0000, v56
    v_pk_add_f32 v[76:77], v[76:77], v[78:79]
    v_pk_add_f32 v[36:37], v[36:37], v[76:77]
    v_cvt_pk_bf16_f32 v16, v36, v37
    v_lshlrev_b32 v36, 16, v16
    v_and_b32 v37, 0xffff0000, v16
    v_lshlrev_b32 v80, 16, v49
    v_and_b32 v81, 0xffff0000, v49
    v_lshlrev_b32 v82, 16, v57
    v_and_b32 v83, 0xffff0000, v57
    v_pk_add_f32 v[80:81], v[80:81], v[82:83]
    v_pk_add_f32 v[38:39], v[38:39], v[80:81]
    v_cvt_pk_bf16_f32 v17, v38, v39
    v_lshlrev_b32 v38, 16, v17
    v_and_b32 v39, 0xffff0000, v17
    v_lshlrev_b32 v76, 16, v50
    v_and_b32 v77, 0xffff0000, v50
    v_lshlrev_b32 v78, 16, v58
    v_and_b32 v79, 0xffff0000, v58
    v_pk_add_f32 v[76:77], v[76:77], v[78:79]
    v_pk_add_f32 v[40:41], v[40:41], v[76:77]
    v_cvt_pk_bf16_f32 v16, v40, v41
    v_lshlrev_b32 v40, 16, v16
    v_and_b32 v41, 0xffff0000, v16
    v_lshlrev_b32 v80, 16, v51
    v_and_b32 v81, 0xffff0000, v51
    v_lshlrev_b32 v82, 16, v59
    v_and_b32 v83, 0xffff0000, v59
    v_pk_add_f32 v[80:81], v[80:81], v[82:83]
    v_pk_add_f32 v[42:43], v[42:43], v[80:81]
    v_cvt_pk_bf16_f32 v17, v42, v43
    v_lshlrev_b32 v42, 16, v17
    v_and_b32 v43, 0xffff0000, v17
    v_pk_add_f32 v[76:77], v[28:29], v[30:31]
    v_pk_mul_f32 v[78:79], v[28:29], v[28:29]
    v_pk_mul_f32 v[80:81], v[28:29], v[60:61]
    v_pk_fma_f32 v[78:79], v[30:31], v[30:31], v[78:79]
    v_pk_fma_f32 v[80:81], v[30:31], v[62:63], v[80:81]
    v_pk_add_f32 v[76:77], v[76:77], v[32:33]
    v_pk_fma_f32 v[78:79], v[32:33], v[32:33], v[78:79]
    v_pk_fma_f32 v[80:81], v[32:33], v[64:65], v[80:81]
    v_pk_add_f32 v[76:77], v[76:77], v[34:35]
    v_pk_fma_f32 v[78:79], v[34:35], v[34:35], v[78:79]
    v_pk_fma_f32 v[80:81], v[34:35], v[66:67], v[80:81]
    v_pk_add_f32 v[76:77], v[76:77], v[36:37]
    v_pk_fma_f32 v[78:79], v[36:37], v[36:37], v[78:79]
    v_pk_fma_f32 v[80:81], v[36:37], v[68:69], v[80:81]
    v_pk_add_f32 v[76:77], v[76:77], v[38:39]
    v_pk_fma_f32 v[78:79], v[38:39], v[38:39], v[78:79]
    v_pk_fma_f32 v[80:81], v[38:39], v[70:71], v[80:81]
    v_pk_add_f32 v[76:77], v[76:77], v[40:41]
    v_pk_fma_f32 v[78:79], v[40:41], v[40:41], v[78:79]
    v_pk_fma_f32 v[80:81], v[40:41], v[72:73], v[80:81]
    v_pk_add_f32 v[76:77], v[76:77], v[42:43]
    v_pk_fma_f32 v[78:79], v[42:43], v[42:43], v[78:79]
    v_pk_fma_f32 v[80:81], v[42:43], v[74:75], v[80:81]
    v_add_f32 v96, v76, v77
    v_add_f32 v97, v78, v79
    v_add_f32 v98, v80, v81
    v_add_f32_dpp v96, v96, v96 row_ror:1 row_mask:0xf bank_mask:0xf
    v_add_f32_dpp v97, v97, v97 row_ror:1 row_mask:0xf bank_mask:0xf
    v_add_f32_dpp v98, v98, v98 row_ror:1 row_mask:0xf bank_mask:0xf
    v_add_f32_dpp v96, v96, v96 row_ror:2 row_mask:0xf bank_mask:0xf
    v_add_f32_dpp v97, v97, v97 row_ror:2 row_mask:0xf bank_mask:0xf
    v_add_f32_dpp v98, v98, v98 row_ror:2 row_mask:0xf bank_mask:0xf
    v_add_f32_dpp v96, v96, v96 row_ror:4 row_mask:0xf bank_mask:0xf
    v_add_f32_dpp v97, v97, v97 row_ror:4 row_mask:0xf bank_mask:0xf
    v_add_f32_dpp v98, v98, v98 row_ror:4 row_mask:0xf bank_mask:0xf
    v_add_f32_dpp v96, v96, v96 row_ror:8 row_mask:0xf bank_mask:0xf
    v_add_f32_dpp v97, v97, v97 row_ror:8 row_mask:0xf bank_mask:0xf
    v_add_f32_dpp v98, v98, v98 row_ror:8 row_mask:0xf bank_mask:0xf
    v_mov_b32 v76, v96
    s_nop 1
    v_permlane16_swap_b32 v96, v76
    v_add_f32 v96, v96, v76
    v_mov_b32 v77, v97
    s_nop 1
    v_permlane16_swap_b32 v97, v77
    v_add_f32 v97, v97, v77
    v_mov_b32 v78, v98
    s_nop 1
    v_permlane16_swap_b32 v98, v78
    v_add_f32 v98, v98, v78
    v_mov_b32 v76, v96
    s_nop 1
    v_permlane32_swap_b32 v96, v76
    v_add_f32 v96, v96, v76
    v_mov_b32 v77, v97
    s_nop 1
    v_permlane32_swap_b32 v97, v77
    v_add_f32 v97, v97, v77
    v_mov_b32 v78, v98
    s_nop 1
    v_permlane32_swap_b32 v98, v78
    v_add_f32 v98, v98, v78
    v_mul_f32 v96, 0x3a800000, v96
    v_mul_f32 v97, 0x3a800000, v97
    v_fma_f32 v97, -v96, v96, v97
    v_max_f32 v97, 0, v97
    v_fma_f32 v98, -v96, v95, v98
    v_add_f32 v76, 0x3727c5ac, v97
    v_rsq_f32 v76, v76
    s_nop 0
    v_fma_f32 v27, v98, v76, v94
    v_cvt_pk_bf16_f32 v96, v96, v96
    v_lshlrev_b32 v96, 16, v96
    v_cvt_pk_bf16_f32 v97, v97, v97
    v_lshlrev_b32 v97, 16, v97
    v_add_f32 v97, 0x3727c5ac, v97
    v_cvt_pk_bf16_f32 v97, v97, v97
    v_lshlrev_b32 v97, 16, v97
    v_sqrt_f32 v98, v97
    s_nop 0
    v_cvt_pk_bf16_f32 v98, v98, v98
    v_lshlrev_b32 v98, 16, v98
    v_rcp_f32 v99, v98
    v_mov_b32 v25, v96
    v_mov_b32 v26, v98
    v_ashrrev_i32 v16, 31, v27
    v_or_b32 v16, 0x80000000, v16
    v_xor_b32 v24, v27, v16
    v_and_b32 v24, 0xfffff800, v24
    v_max_u32 v24, 0x800, v24
    s_sub_u32 s16, 2047, s14
    v_or_b32 v24, s16, v24
    s_lshl_b32 s16, s3, 4
    s_add_u32 s16, s16, 65536
    v_mov_b32 v16, s16
    ds_write_b128 v16, v[24:27]
    s_waitcnt lgkmcnt(0)
    s_barrier
    v_and_b32 v16, 7, v1
    v_lshlrev_b32 v16, 4, v16
    v_add_u32 v16, 65536, v16
    ds_read_b32 v76, v16
    s_waitcnt lgkmcnt(0)
    v_mov_b32 v77, v76
    s_nop 1
    v_max_u32_dpp v77, v77, v77 row_ror:1 row_mask:0xf bank_mask:0xf
    s_nop 1
    v_max_u32_dpp v77, v77, v77 row_ror:2 row_mask:0xf bank_mask:0xf
    s_nop 1
    v_max_u32_dpp v77, v77, v77 row_ror:4 row_mask:0xf bank_mask:0xf
    v_cmp_eq_u32 vcc, v76, v77
    s_ff1_i32_b64 s16, vcc
    s_lshl_b32 s16, s16, 4
    s_add_u32 s16, s16, 65536
    v_mov_b32 v16, s16
    ds_read_b128 v[24:27], v16
    s_lshl_b32 s16, s2, 4
    s_add_u32 s16, s16, 0x6e0000
    s_cmp_eq_u32 s3, 0
    s_cselect_b32 s16, s16, 0x7ffffff0
    v_mov_b32 v17, 0
    s_mov_b64 exec, 1
    s_waitcnt lgkmcnt(0)
    buffer_store_dwordx4 v[24:27], v17, s[8:11], s16 offen sc1
    s_mov_b64 exec, -1
    v_sub_f32 v44, v28, v96
    v_sub_f32 v45, v29, v96
    v_sub_f32 v46, v30, v96
    v_sub_f32 v47, v31, v96
    v_sub_f32 v48, v32, v96
    v_sub_f32 v49, v33, v96
    v_sub_f32 v50, v34, v96
    v_sub_f32 v51, v35, v96
    v_cvt_pk_bf16_f32 v16, v44, v45
    v_lshlrev_b32 v44, 16, v16
    v_and_b32 v45, 0xffff0000, v16
    v_cvt_pk_bf16_f32 v16, v46, v47
    v_lshlrev_b32 v46, 16, v16
    v_and_b32 v47, 0xffff0000, v16
    v_cvt_pk_bf16_f32 v16, v48, v49
    v_lshlrev_b32 v48, 16, v16
    v_and_b32 v49, 0xffff0000, v16
    v_cvt_pk_bf16_f32 v16, v50, v51
    v_lshlrev_b32 v50, 16, v16
    v_and_b32 v51, 0xffff0000, v16
    v_mul_f32 v52, v44, v99
    v_mul_f32 v53, v45, v99
    v_mul_f32 v54, v46, v99
    v_mul_f32 v55, v47, v99
    v_mul_f32 v56, v48, v99
    v_mul_f32 v57, v49, v99
    v_mul_f32 v58, v50, v99
    v_mul_f32 v59, v51, v99
    v_fma_f32 v44, -v52, v98, v44
    v_fma_f32 v45, -v53, v98, v45
    v_fma_f32 v46, -v54, v98, v46
    v_fma_f32 v47, -v55, v98, v47
    v_fma_f32 v48, -v56, v98, v48
    v_fma_f32 v49, -v57, v98, v49
    v_fma_f32 v50, -v58, v98, v50
    v_fma_f32 v51, -v59, v98, v51
    v_fma_f32 v44, v44, v99, v52
    v_fma_f32 v45, v45, v99, v53
    v_fma_f32 v46, v46, v99, v54
    v_fma_f32 v47, v47, v99, v55
    v_fma_f32 v48, v48, v99, v56
    v_fma_f32 v49, v49, v99, v57
    v_fma_f32 v50, v50, v99, v58
    v_fma_f32 v51, v51, v99, v59
    v_cvt_pk_bf16_f32 v16, v44, v45
    v_lshlrev_b32 v44, 16, v16
    v_and_b32 v45, 0xffff0000, v16
    v_cvt_pk_bf16_f32 v16, v46, v47
    v_lshlrev_b32 v46, 16, v16
    v_and_b32 v47, 0xffff0000, v16
    v_cvt_pk_bf16_f32 v16, v48, v49
    v_lshlrev_b32 v48, 16, v16
    v_and_b32 v49, 0xffff0000, v16
    v_cvt_pk_bf16_f32 v16, v50, v51
    v_lshlrev_b32 v50, 16, v16
    v_and_b32 v51, 0xffff0000, v16
    v_lshlrev_b32 v52, 16, v192
    v_and_b32 v53, 0xffff0000, v192
    v_lshlrev_b32 v54, 16, v193
    v_and_b32 v55, 0xffff0000, v193
    v_lshlrev_b32 v56, 16, v194
    v_and_b32 v57, 0xffff0000, v194
    v_lshlrev_b32 v58, 16, v195
    v_and_b32 v59, 0xffff0000, v195
    v_pk_mul_f32 v[44:45], v[44:45], v[52:53]
    v_pk_mul_f32 v[46:47], v[46:47], v[54:55]
    v_pk_mul_f32 v[48:49], v[48:49], v[56:57]
    v_pk_mul_f32 v[50:51], v[50:51], v[58:59]
    v_cvt_pk_bf16_f32 v16, v44, v45
    v_lshlrev_b32 v44, 16, v16
    v_and_b32 v45, 0xffff0000, v16
    v_cvt_pk_bf16_f32 v16, v46, v47
    v_lshlrev_b32 v46, 16, v16
    v_and_b32 v47, 0xffff0000, v16
    v_cvt_pk_bf16_f32 v16, v48, v49
    v_lshlrev_b32 v48, 16, v16
    v_and_b32 v49, 0xffff0000, v16
    v_cvt_pk_bf16_f32 v16, v50, v51
    v_lshlrev_b32 v50, 16, v16
    v_and_b32 v51, 0xffff0000, v16
    v_lshlrev_b32 v52, 16, v184
    v_and_b32 v53, 0xffff0000, v184
    v_lshlrev_b32 v54, 16, v185
    v_and_b32 v55, 0xffff0000, v185
    v_lshlrev_b32 v56, 16, v186
    v_and_b32 v57, 0xffff0000, v186
    v_lshlrev_b32 v58, 16, v187
    v_and_b32 v59, 0xffff0000, v187
    v_pk_add_f32 v[44:45], v[44:45], v[52:53]
    v_pk_add_f32 v[46:47], v[46:47], v[54:55]
    v_pk_add_f32 v[48:49], v[48:49], v[56:57]
    v_pk_add_f32 v[50:51], v[50:51], v[58:59]
    v_cvt_pk_bf16_f32 v16, v44, v45
    v_lshlrev_b32 v44, 16, v16
    v_and_b32 v45, 0xffff0000, v16
    v_cvt_pk_bf16_f32 v16, v46, v47
    v_lshlrev_b32 v46, 16, v16
    v_and_b32 v47, 0xffff0000, v16
    v_cvt_pk_bf16_f32 v16, v48, v49
    v_lshlrev_b32 v48, 16, v16
    v_and_b32 v49, 0xffff0000, v16
    v_cvt_pk_bf16_f32 v16, v50, v51
    v_lshlrev_b32 v50, 16, v16
    v_and_b32 v51, 0xffff0000, v16
    v_lshlrev_b32 v52, 16, v200
    v_and_b32 v53, 0xffff0000, v200
    v_lshlrev_b32 v54, 16, v201
    v_and_b32 v55, 0xffff0000, v201
    v_lshlrev_b32 v56, 16, v202
    v_and_b32 v57, 0xffff0000, v202
    v_lshlrev_b32 v58, 16, v203
    v_and_b32 v59, 0xffff0000, v203
    v_pk_mul_f32 v[44:45], v[44:45], v[52:53]
    v_pk_mul_f32 v[46:47], v[46:47], v[54:55]
    v_pk_mul_f32 v[48:49], v[48:49], v[56:57]
    v_pk_mul_f32 v[50:51], v[50:51], v[58:59]
    v_cvt_pk_bf16_f32 v16, v44, v45
    v_lshlrev_b32 v44, 16, v16
    v_and_b32 v45, 0xffff0000, v16
    v_cvt_pk_bf16_f32 v16, v46, v47
    v_lshlrev_b32 v46, 16, v16
    v_and_b32 v47, 0xffff0000, v16
    v_cvt_pk_bf16_f32 v16, v48, v49
    v_lshlrev_b32 v48, 16, v16
    v_and_b32 v49, 0xffff0000, v16
    v_cvt_pk_bf16_f32 v16, v50, v51
    v_lshlrev_b32 v50, 16, v16
    v_and_b32 v51, 0xffff0000, v16
    v_pk_add_f32 v[44:45], v[44:45], v[28:29]
    v_pk_add_f32 v[46:47], v[46:47], v[30:31]
    v_pk_add_f32 v[48:49], v[48:49], v[32:33]
    v_pk_add_f32 v[50:51], v[50:51], v[34:35]
    v_cvt_pk_bf16_f32 v28, v44, v45
    v_cvt_pk_bf16_f32 v29, v46, v47
    v_cvt_pk_bf16_f32 v30, v48, v49
    v_cvt_pk_bf16_f32 v31, v50, v51
    v_sub_f32 v44, v36, v96
    v_sub_f32 v45, v37, v96
    v_sub_f32 v46, v38, v96
    v_sub_f32 v47, v39, v96
    v_sub_f32 v48, v40, v96
    v_sub_f32 v49, v41, v96
    v_sub_f32 v50, v42, v96
    v_sub_f32 v51, v43, v96
    v_cvt_pk_bf16_f32 v16, v44, v45
    v_lshlrev_b32 v44, 16, v16
    v_and_b32 v45, 0xffff0000, v16
    v_cvt_pk_bf16_f32 v16, v46, v47
    v_lshlrev_b32 v46, 16, v16
    v_and_b32 v47, 0xffff0000, v16
    v_cvt_pk_bf16_f32 v16, v48, v49
    v_lshlrev_b32 v48, 16, v16
    v_and_b32 v49, 0xffff0000, v16
    v_cvt_pk_bf16_f32 v16, v50, v51
    v_lshlrev_b32 v50, 16, v16
    v_and_b32 v51, 0xffff0000, v16
    v_mul_f32 v52, v44, v99
    v_mul_f32 v53, v45, v99
    v_mul_f32 v54, v46, v99
    v_mul_f32 v55, v47, v99
    v_mul_f32 v56, v48, v99
    v_mul_f32 v57, v49, v99
    v_mul_f32 v58, v50, v99
    v_mul_f32 v59, v51, v99
    v_fma_f32 v44, -v52, v98, v44
    v_fma_f32 v45, -v53, v98, v45
    v_fma_f32 v46, -v54, v98, v46
    v_fma_f32 v47, -v55, v98, v47
    v_fma_f32 v48, -v56, v98, v48
    v_fma_f32 v49, -v57, v98, v49
    v_fma_f32 v50, -v58, v98, v50
    v_fma_f32 v51, -v59, v98, v51
    v_fma_f32 v44, v44, v99, v52
    v_fma_f32 v45, v45, v99, v53
    v_fma_f32 v46, v46, v99, v54
    v_fma_f32 v47, v47, v99, v55
    v_fma_f32 v48, v48, v99, v56
    v_fma_f32 v49, v49, v99, v57
    v_fma_f32 v50, v50, v99, v58
    v_fma_f32 v51, v51, v99, v59
    v_cvt_pk_bf16_f32 v16, v44, v45
    v_lshlrev_b32 v44, 16, v16
    v_and_b32 v45, 0xffff0000, v16
    v_cvt_pk_bf16_f32 v16, v46, v47
    v_lshlrev_b32 v46, 16, v16
    v_and_b32 v47, 0xffff0000, v16
    v_cvt_pk_bf16_f32 v16, v48, v49
    v_lshlrev_b32 v48, 16, v16
    v_and_b32 v49, 0xffff0000, v16
    v_cvt_pk_bf16_f32 v16, v50, v51
    v_lshlrev_b32 v50, 16, v16
    v_and_b32 v51, 0xffff0000, v16
    v_lshlrev_b32 v52, 16, v196
    v_and_b32 v53, 0xffff0000, v196
    v_lshlrev_b32 v54, 16, v197
    v_and_b32 v55, 0xffff0000, v197
    v_lshlrev_b32 v56, 16, v198
    v_and_b32 v57, 0xffff0000, v198
    v_lshlrev_b32 v58, 16, v199
    v_and_b32 v59, 0xffff0000, v199
    v_pk_mul_f32 v[44:45], v[44:45], v[52:53]
    v_pk_mul_f32 v[46:47], v[46:47], v[54:55]
    v_pk_mul_f32 v[48:49], v[48:49], v[56:57]
    v_pk_mul_f32 v[50:51], v[50:51], v[58:59]
    v_cvt_pk_bf16_f32 v16, v44, v45
    v_lshlrev_b32 v44, 16, v16
    v_and_b32 v45, 0xffff0000, v16
    v_cvt_pk_bf16_f32 v16, v46, v47
    v_lshlrev_b32 v46, 16, v16
    v_and_b32 v47, 0xffff0000, v16
    v_cvt_pk_bf16_f32 v16, v48, v49
    v_lshlrev_b32 v48, 16, v16
    v_and_b32 v49, 0xffff0000, v16
    v_cvt_pk_bf16_f32 v16, v50, v51
    v_lshlrev_b32 v50, 16, v16
    v_and_b32 v51, 0xffff0000, v16
    v_lshlrev_b32 v52, 16, v188
    v_and_b32 v53, 0xffff0000, v188
    v_lshlrev_b32 v54, 16, v189
    v_and_b32 v55, 0xffff0000, v189
    v_lshlrev_b32 v56, 16, v190
    v_and_b32 v57, 0xffff0000, v190
    v_lshlrev_b32 v58, 16, v191
    v_and_b32 v59, 0xffff0000, v191
    v_pk_add_f32 v[44:45], v[44:45], v[52:53]
    v_pk_add_f32 v[46:47], v[46:47], v[54:55]
    v_pk_add_f32 v[48:49], v[48:49], v[56:57]
    v_pk_add_f32 v[50:51], v[50:51], v[58:59]
    v_cvt_pk_bf16_f32 v16, v44, v45
    v_lshlrev_b32 v44, 16, v16
    v_and_b32 v45, 0xffff0000, v16
    v_cvt_pk_bf16_f32 v16, v46, v47
    v_lshlrev_b32 v46, 16, v16
    v_and_b32 v47, 0xffff0000, v16
    v_cvt_pk_bf16_f32 v16, v48, v49
    v_lshlrev_b32 v48, 16, v16
    v_and_b32 v49, 0xffff0000, v16
    v_cvt_pk_bf16_f32 v16, v50, v51
    v_lshlrev_b32 v50, 16, v16
    v_and_b32 v51, 0xffff0000, v16
    v_lshlrev_b32 v52, 16, v204
    v_and_b32 v53, 0xffff0000, v204
    v_lshlrev_b32 v54, 16, v205
    v_and_b32 v55, 0xffff0000, v205
    v_lshlrev_b32 v56, 16, v206
    v_and_b32 v57, 0xffff0000, v206
    v_lshlrev_b32 v58, 16, v207
    v_and_b32 v59, 0xffff0000, v207
    v_pk_mul_f32 v[44:45], v[44:45], v[52:53]
    v_pk_mul_f32 v[46:47], v[46:47], v[54:55]
    v_pk_mul_f32 v[48:49], v[48:49], v[56:57]
    v_pk_mul_f32 v[50:51], v[50:51], v[58:59]
    v_cvt_pk_bf16_f32 v16, v44, v45
    v_lshlrev_b32 v44, 16, v16
    v_and_b32 v45, 0xffff0000, v16
    v_cvt_pk_bf16_f32 v16, v46, v47
    v_lshlrev_b32 v46, 16, v16
    v_and_b32 v47, 0xffff0000, v16
    v_cvt_pk_bf16_f32 v16, v48, v49
    v_lshlrev_b32 v48, 16, v16
    v_and_b32 v49, 0xffff0000, v16
    v_cvt_pk_bf16_f32 v16, v50, v51
    v_lshlrev_b32 v50, 16, v16
    v_and_b32 v51, 0xffff0000, v16
    v_pk_add_f32 v[44:45], v[44:45], v[36:37]
    v_pk_add_f32 v[46:47], v[46:47], v[38:39]
    v_pk_add_f32 v[48:49], v[48:49], v[40:41]
    v_pk_add_f32 v[50:51], v[50:51], v[42:43]
    v_cvt_pk_bf16_f32 v36, v44, v45
    v_cvt_pk_bf16_f32 v37, v46, v47
    v_cvt_pk_bf16_f32 v38, v48, v49
    v_cvt_pk_bf16_f32 v39, v50, v51
    v_lshlrev_b32 v18, 4, v0
    s_mov_b32 s16, 0x6e0000
    s_mov_b32 s27, 0
adaLN_cond__sliding_block_cached__moe_arch_mod__prompt_kernel_w12p:
    buffer_load_dwordx4 v[24:27], v18, s[8:11], s16 offen sc1
    s_waitcnt vmcnt(0)
    v_cmp_eq_u32 vcc, 0, v24
    s_add_u32 s27, s27, 1
    s_cmp_ge_u32 s27, 65536
    s_cbranch_scc1 adaLN_cond__sliding_block_cached__moe_arch_mod__prompt_kernel_w12g
    s_cbranch_vccnz adaLN_cond__sliding_block_cached__moe_arch_mod__prompt_kernel_w12p
adaLN_cond__sliding_block_cached__moe_arch_mod__prompt_kernel_w12g:
    v_mov_b32 v76, v24
    s_nop 1
    v_max_u32_dpp v76, v76, v76 row_ror:1 row_mask:0xf bank_mask:0xf
    s_nop 1
    v_max_u32_dpp v76, v76, v76 row_ror:2 row_mask:0xf bank_mask:0xf
    s_nop 1
    v_max_u32_dpp v76, v76, v76 row_ror:4 row_mask:0xf bank_mask:0xf
    s_nop 1
    v_max_u32_dpp v76, v76, v76 row_ror:8 row_mask:0xf bank_mask:0xf
    v_mov_b32 v77, v76
    s_nop 1
    v_permlane16_swap_b32 v76, v77
    v_max_u32 v76, v76, v77
    v_mov_b32 v77, v76
    s_nop 1
    v_permlane32_swap_b32 v76, v77
    v_max_u32 v76, v76, v77
    v_cmp_eq_u32 vcc, v76, v24
    s_lshl_b32 s16, s3, 4
    s_add_u32 s16, s16, 65792
    v_mov_b32 v16, s16
    s_and_saveexec_b64 s[62:63], vcc
    ds_write_b128 v16, v[24:27]
    s_mov_b64 exec, s[62:63]
    s_waitcnt lgkmcnt(0)
    s_barrier
    v_and_b32 v16, 3, v1
    v_lshlrev_b32 v16, 4, v16
    v_add_u32 v16, 65792, v16
    ds_read_b32 v76, v16
    s_waitcnt lgkmcnt(0)
    v_mov_b32 v77, v76
    s_nop 1
    v_max_u32_dpp v77, v77, v77 row_ror:1 row_mask:0xf bank_mask:0xf
    s_nop 1
    v_max_u32_dpp v77, v77, v77 row_ror:2 row_mask:0xf bank_mask:0xf
    v_cmp_eq_u32 vcc, v76, v77
    s_ff1_i32_b64 s16, vcc
    s_lshl_b32 s16, s16, 4
    s_add_u32 s16, s16, 65792
    v_mov_b32 v16, s16
    ds_read_b128 v[24:27], v16
    s_waitcnt lgkmcnt(0)
    v_and_b32 v76, 0x7ff, v24
    v_sub_u32 v76, 2047, v76
    s_nop 0
    v_readfirstlane_b32 s12, v76
    v_rcp_f32 v103, v26
    s_lshr_b32 s18, s12, 4
    s_lshl_b32 s18, s18, 15
    s_and_b32 s19, s12, 15
    s_lshl_b32 s19, s19, 6
    s_add_u32 s18, s18, s19
    s_add_u32 s18, s18, 0x2000000
    s_add_u32 s19, s18, 0x400000
    v_lshrrev_b32 v18, 4, v0
    v_lshlrev_b32 v18, 10, v18
    v_and_b32 v19, 15, v0
    v_lshl_add_u32 v18, v19, 2, v18
    s_lshl_b32 s13, s12, 11
    buffer_load_dword v100, v18, s[8:11], s18 offen sc1
    buffer_load_dword v101, v18, s[8:11], s19 offen sc1
    buffer_load_dword v102, v21, s[76:79], s13 offen
    s_lshl_b32 s16, s14, 11
    s_cmp_lg_u32 s12, s14
    s_cselect_b32 s16, s16, 0x7ffffff0
    buffer_store_dwordx4 v[28:31], v2, s[68:71], s16 offen offset:0 sc1
    buffer_store_dwordx4 v[36:39], v2, s[68:71], s16 offen offset:1024 sc1
    s_lshl_b32 s16, s3, 13
    v_add_u32 v20, s16, v2
    s_waitcnt vmcnt(4)
    v_lshlrev_b32 v76, 16, v100
    v_and_b32 v77, 0xffff0000, v100
    s_waitcnt vmcnt(3)
    v_lshlrev_b32 v78, 16, v101
    v_and_b32 v79, 0xffff0000, v101
    v_pk_add_f32 v[76:77], v[76:77], v[78:79]
    s_waitcnt vmcnt(2)
    v_lshlrev_b32 v78, 16, v102
    v_and_b32 v79, 0xffff0000, v102
    v_pk_add_f32 v[92:93], v[78:79], v[76:77]
    v_cvt_pk_bf16_f32 v76, v92, v93
    v_lshlrev_b32 v92, 16, v76
    v_and_b32 v93, 0xffff0000, v76
    v_cvt_pk_bf16_f32 v100, v92, v93
    v_and_b32 v105, 0xffff0000, v104
    v_lshlrev_b32 v104, 16, v104
    v_and_b32 v107, 0xffff0000, v106
    v_lshlrev_b32 v106, 16, v106
    v_sub_f32 v92, v92, v25
    v_sub_f32 v93, v93, v25
    v_cvt_pk_bf16_f32 v76, v92, v93
    v_lshlrev_b32 v92, 16, v76
    v_and_b32 v93, 0xffff0000, v76
    v_mul_f32 v77, v92, v103
    v_fma_f32 v92, -v77, v26, v92
    v_fma_f32 v92, v92, v103, v77
    v_mul_f32 v77, v93, v103
    v_fma_f32 v93, -v77, v26, v93
    v_fma_f32 v93, v93, v103, v77
    v_cvt_pk_bf16_f32 v76, v92, v93
    v_lshlrev_b32 v92, 16, v76
    v_and_b32 v93, 0xffff0000, v76
    v_mul_f32 v92, v92, v104
    v_mul_f32 v93, v93, v105
    v_cvt_pk_bf16_f32 v76, v92, v93
    v_lshlrev_b32 v92, 16, v76
    v_and_b32 v93, 0xffff0000, v76
    v_add_f32 v92, v92, v106
    v_add_f32 v93, v93, v107
    v_cvt_pk_bf16_f32 v101, v92, v93
    v_add_u32 v16, 66560, v21
    ds_write_b32 v16, v101
    ds_write_b32 v16, v100 offset:2048
    s_waitcnt lgkmcnt(0)
    s_barrier
    ds_read_b128 v[60:63], v20 offset:0
    ds_read_b128 v[64:67], v20 offset:1024
    ds_read_b128 v[68:71], v20 offset:2048
    ds_read_b128 v[72:75], v20 offset:3072
    ds_read_b128 v[108:111], v20 offset:4096
    ds_read_b128 v[112:115], v20 offset:5120
    ds_read_b128 v[116:119], v20 offset:6144
    ds_read_b128 v[120:123], v20 offset:7168
    s_and_b32 s16, s3, 3
    s_lshl_b32 s16, s16, 7
    s_and_b32 s17, s29, 3
    s_lshl_b32 s17, s17, 9
    s_add_u32 s16, s16, s17
    s_add_u32 s16, s16, 66560
    v_lshrrev_b32 v16, 3, v1
    v_lshlrev_b32 v16, 4, v16
    v_add_u32 v16, s16, v16
    ds_read_b128 v[104:107], v16
    s_waitcnt lgkmcnt(0)
    v_lshlrev_b32 v76, 16, v104
    v_and_b32 v77, 0xffff, v104
    v_dot2_f32_bf16 v85, v60, v76, 0
    v_dot2_f32_bf16 v84, v60, v77, 0
    v_dot2_f32_bf16 v87, v61, v76, 0
    v_dot2_f32_bf16 v86, v61, v77, 0
    v_dot2_f32_bf16 v89, v62, v76, 0
    v_dot2_f32_bf16 v88, v62, v77, 0
    v_dot2_f32_bf16 v91, v63, v76, 0
    v_dot2_f32_bf16 v90, v63, v77, 0
    v_and_b32 v78, 0xffff0000, v104
    v_lshrrev_b32 v79, 16, v104
    v_dot2c_f32_bf16 v85, v64, v78
    v_dot2c_f32_bf16 v84, v64, v79
    v_dot2c_f32_bf16 v87, v65, v78
    v_dot2c_f32_bf16 v86, v65, v79
    v_dot2c_f32_bf16 v89, v66, v78
    v_dot2c_f32_bf16 v88, v66, v79
    v_dot2c_f32_bf16 v91, v67, v78
    v_dot2c_f32_bf16 v90, v67, v79
    v_lshlrev_b32 v80, 16, v105
    v_and_b32 v81, 0xffff, v105
    v_dot2c_f32_bf16 v85, v68, v80
    v_dot2c_f32_bf16 v84, v68, v81
    v_dot2c_f32_bf16 v87, v69, v80
    v_dot2c_f32_bf16 v86, v69, v81
    v_dot2c_f32_bf16 v89, v70, v80
    v_dot2c_f32_bf16 v88, v70, v81
    v_dot2c_f32_bf16 v91, v71, v80
    v_dot2c_f32_bf16 v90, v71, v81
    v_and_b32 v82, 0xffff0000, v105
    v_lshrrev_b32 v83, 16, v105
    v_dot2c_f32_bf16 v85, v72, v82
    v_dot2c_f32_bf16 v84, v72, v83
    v_dot2c_f32_bf16 v87, v73, v82
    v_dot2c_f32_bf16 v86, v73, v83
    v_dot2c_f32_bf16 v89, v74, v82
    v_dot2c_f32_bf16 v88, v74, v83
    v_dot2c_f32_bf16 v91, v75, v82
    v_dot2c_f32_bf16 v90, v75, v83
    v_lshlrev_b32 v76, 16, v106
    v_and_b32 v77, 0xffff, v106
    v_dot2c_f32_bf16 v85, v108, v76
    v_dot2c_f32_bf16 v84, v108, v77
    v_dot2c_f32_bf16 v87, v109, v76
    v_dot2c_f32_bf16 v86, v109, v77
    v_dot2c_f32_bf16 v89, v110, v76
    v_dot2c_f32_bf16 v88, v110, v77
    v_dot2c_f32_bf16 v91, v111, v76
    v_dot2c_f32_bf16 v90, v111, v77
    v_and_b32 v78, 0xffff0000, v106
    v_lshrrev_b32 v79, 16, v106
    v_dot2c_f32_bf16 v85, v112, v78
    v_dot2c_f32_bf16 v84, v112, v79
    v_dot2c_f32_bf16 v87, v113, v78
    v_dot2c_f32_bf16 v86, v113, v79
    v_dot2c_f32_bf16 v89, v114, v78
    v_dot2c_f32_bf16 v88, v114, v79
    v_dot2c_f32_bf16 v91, v115, v78
    v_dot2c_f32_bf16 v90, v115, v79
    v_lshlrev_b32 v80, 16, v107
    v_and_b32 v81, 0xffff, v107
    v_dot2c_f32_bf16 v85, v116, v80
    v_dot2c_f32_bf16 v84, v116, v81
    v_dot2c_f32_bf16 v87, v117, v80
    v_dot2c_f32_bf16 v86, v117, v81
    v_dot2c_f32_bf16 v89, v118, v80
    v_dot2c_f32_bf16 v88, v118, v81
    v_dot2c_f32_bf16 v91, v119, v80
    v_dot2c_f32_bf16 v90, v119, v81
    v_and_b32 v82, 0xffff0000, v107
    v_lshrrev_b32 v83, 16, v107
    v_dot2c_f32_bf16 v85, v120, v82
    v_dot2c_f32_bf16 v84, v120, v83
    v_dot2c_f32_bf16 v87, v121, v82
    v_dot2c_f32_bf16 v86, v121, v83
    v_dot2c_f32_bf16 v89, v122, v82
    v_dot2c_f32_bf16 v88, v122, v83
    v_dot2c_f32_bf16 v91, v123, v82
    v_dot2c_f32_bf16 v90, v123, v83
    s_nop 0
    v_permlane32_swap_b32 v84, v88
    v_permlane32_swap_b32 v85, v89
    v_permlane32_swap_b32 v86, v90
    v_permlane32_swap_b32 v87, v91
    v_add_f32 v84, v84, v88
    v_add_f32 v85, v85, v89
    v_add_f32 v86, v86, v90
    v_add_f32 v87, v87, v91
    s_nop 0
    v_permlane16_swap_b32 v84, v86
    v_permlane16_swap_b32 v85, v87
    v_add_f32 v84, v84, v86
    v_add_f32 v85, v85, v87
    s_nop 0
    v_add_f32_dpp v84, v84, v84 row_ror:8 row_mask:0xf bank_mask:0xf
    v_add_f32_dpp v85, v85, v85 row_ror:8 row_mask:0xf bank_mask:0xf
    v_and_b32 v16, 7, v1
    v_lshlrev_b32 v16, 5, v16
    v_lshrrev_b32 v17, 4, v1
    v_lshl_add_u32 v16, v17, 3, v16
    s_lshl_b32 s16, s3, 8
    s_add_u32 s16, s16, 70656
    v_add_u32 v16, s16, v16
    ds_write_b64 v16, v[84:85]
    s_lshr_b32 s16, s3, 2
    s_lshl_b32 s17, s16, 10
    s_add_u32 s17, s17, 70656
    v_lshlrev_b32 v17, 2, v1
    v_add_u32 v16, s17, v17
    s_and_b32 s17, s29, 3
    s_lshl_b32 s17, s17, 1
    s_add_u32 s17, s17, s16
    s_mul_i32 s17, s17, 14336
    s_lshr_b32 s16, s29, 2
    s_lshl_b32 s16, s16, 8
    s_add_u32 s17, s17, s16
    s_add_u32 s17, s17, 0x6e1000
    s_and_b32 s16, s3, 3
    s_cmp_eq_u32 s16, 0
    s_cselect_b32 s17, s17, 0x7ffffff0
    s_cmp_lt_u32 s2, 224
    s_cselect_b32 s17, s17, 0x7ffffff0
    s_waitcnt lgkmcnt(0)
    s_barrier
    ds_read_b32 v84, v16 offset:0
    ds_read_b32 v85, v16 offset:256
    ds_read_b32 v86, v16 offset:512
    ds_read_b32 v87, v16 offset:768
    s_waitcnt lgkmcnt(2)
    v_add_f32 v84, v84, v85
    s_waitcnt lgkmcnt(0)
    v_add_f32 v86, v86, v87
    v_add_f32 v84, v84, v86
    v_or_b32 v84, 1, v84
    buffer_store_dword v84, v17, s[8:11], s17 offen sc1
    s_barrier
    v_lshlrev_b32 v16, 3, v0
    v_add_u32 v17, 73728, v16
    ds_read_b64 v[84:85], v17 offset:0
    ds_read_b64 v[86:87], v17 offset:4096
    ds_read_b64 v[88:89], v17 offset:8192
    ds_read_b64 v[90:91], v17 offset:12288
    s_waitcnt lgkmcnt(2)
    v_pk_add_f32 v[84:85], v[84:85], v[86:87]
    s_waitcnt lgkmcnt(0)
    v_pk_add_f32 v[88:89], v[88:89], v[90:91]
    v_pk_add_f32 v[84:85], v[84:85], v[88:89]
    v_or_b32 v84, 1, v84
    v_or_b32 v85, 1, v85
    s_lshl_b32 s16, s29, 12
    s_add_u32 s16, s16, 0x600000
    s_cmp_lt_u32 s2, 224
    s_cselect_b32 s16, s16, 0x7ffffff0
    buffer_store_dwordx2 v[84:85], v16, s[8:11], s16 offen sc1
    s_cmp_lt_u32 s2, 224
    s_cbranch_scc1 adaLN_cond__sliding_block_cached__moe_arch_mod__prompt_kernel_end
    s_sub_u32 s16, s2, 224
    s_lshl_b32 s17, s16, 7
    s_add_u32 s17, s17, 0x600000
    v_lshrrev_b32 v16, 3, v0
    v_lshlrev_b32 v16, 12, v16
    v_and_b32 v17, 7, v0
    v_lshl_add_u32 v16, v17, 4, v16
    v_cmp_gt_u32 vcc, 256, v0
    v_bfrev_b32 v17, -2
    s_nop 0
    v_cndmask_b32 v17, v17, v16, vcc
    v_mov_b32 v19, 0
    v_cndmask_b32 v18, 1, v19, vcc
    s_lshl_b32 s18, s16, 6
    v_and_b32 v19, 31, v1
    v_lshlrev_b32 v19, 1, v19
    v_add_u32 v19, s18, v19
    s_mov_b32 s19, 0x541800
    buffer_load_ushort v95, v19, s[8:11], s19 offen sc1
    v_add_u32 v20, 66560, v19
    ds_read_u16 v96, v20
    ds_read_u16 v97, v20 offset:2048
    v_mov_b32 v94, v27
    v_cvt_pk_bf16_f32 v94, v94, v94
    v_lshlrev_b32 v94, 16, v94
    v_mul_f32 v94, 0xbfb8aa3b, v94
    v_exp_f32 v94, v94
    s_nop 0
    v_add_f32 v94, 1.0, v94
    v_rcp_f32 v94, v94
    s_nop 0
    v_cvt_pk_bf16_f32 v94, v94, v94
    v_lshlrev_b32 v94, 16, v94
    s_waitcnt vmcnt(0)
    v_lshlrev_b32 v95, 16, v95
    s_waitcnt lgkmcnt(1)
    v_lshlrev_b32 v96, 16, v96
    s_waitcnt lgkmcnt(0)
    v_lshlrev_b32 v97, 16, v97
    s_mov_b32 s27, 0
adaLN_cond__sliding_block_cached__moe_arch_mod__prompt_kernel_y13p:
    s_add_u32 s19, s17, 0x0
    buffer_load_dwordx4 v[44:47], v16, s[8:11], s19 offen sc1
    s_add_u32 s19, s17, 0x40000
    buffer_load_dwordx4 v[48:51], v16, s[8:11], s19 offen sc1
    s_add_u32 s19, s17, 0x80000
    buffer_load_dwordx4 v[52:55], v16, s[8:11], s19 offen sc1
    s_add_u32 s19, s17, 0xc0000
    buffer_load_dwordx4 v[56:59], v17, s[8:11], s19 offen sc1
    s_waitcnt vmcnt(0)
    v_min3_u32 v98, v56, v57, v58
    v_min_u32 v98, v98, v59
    v_or_b32 v98, v98, v18
    v_min3_u32 v98, v98, v44, v45
    v_min3_u32 v98, v98, v46, v47
    v_min3_u32 v98, v98, v48, v49
    v_min3_u32 v98, v98, v50, v51
    v_min3_u32 v98, v98, v52, v53
    v_min3_u32 v98, v98, v54, v55
    v_cmp_eq_u32 vcc, 0, v98
    s_add_u32 s27, s27, 1
    s_cmp_ge_u32 s27, 65536
    s_cbranch_scc1 adaLN_cond__sliding_block_cached__moe_arch_mod__prompt_kernel_y13g
    s_cbranch_vccnz adaLN_cond__sliding_block_cached__moe_arch_mod__prompt_kernel_y13p
adaLN_cond__sliding_block_cached__moe_arch_mod__prompt_kernel_y13g:
    v_pk_add_f32 v[44:45], v[44:45], v[52:53]
    v_pk_add_f32 v[46:47], v[46:47], v[54:55]
    v_pk_add_f32 v[48:49], v[48:49], v[56:57]
    v_pk_add_f32 v[50:51], v[50:51], v[58:59]
    v_pk_add_f32 v[44:45], v[44:45], v[48:49]
    v_pk_add_f32 v[46:47], v[46:47], v[50:51]
    s_nop 0
    v_add_f32_dpp v44, v44, v44 row_ror:8 row_mask:0xf bank_mask:0xf
    v_add_f32_dpp v45, v45, v45 row_ror:8 row_mask:0xf bank_mask:0xf
    v_add_f32_dpp v46, v46, v46 row_ror:8 row_mask:0xf bank_mask:0xf
    v_add_f32_dpp v47, v47, v47 row_ror:8 row_mask:0xf bank_mask:0xf
    s_nop 0
    v_permlane32_swap_b32 v44, v46
    v_permlane32_swap_b32 v45, v47
    v_add_f32 v44, v44, v46
    v_add_f32 v45, v45, v47
    s_nop 1
    v_permlane16_swap_b32 v44, v45
    v_add_f32 v44, v44, v45
    v_and_b32 v16, 7, v1
    v_lshlrev_b32 v16, 4, v16
    v_lshrrev_b32 v17, 4, v1
    v_lshl_add_u32 v16, v17, 2, v16
    s_lshl_b32 s19, s3, 7
    s_add_u32 s19, s19, 91136
    v_add_u32 v16, s19, v16
    ds_write_b32 v16, v44
    v_and_b32 v16, 31, v1
    v_lshlrev_b32 v16, 2, v16
    v_add_u32 v16, 91136, v16
    s_waitcnt lgkmcnt(0)
    s_barrier
    s_cmp_lg_u32 s3, 0
    s_cbranch_scc1 adaLN_cond__sliding_block_cached__moe_arch_mod__prompt_kernel_end
    ds_read_b32 v44, v16 offset:0
    ds_read_b32 v45, v16 offset:128
    ds_read_b32 v46, v16 offset:256
    ds_read_b32 v47, v16 offset:384
    ds_read_b32 v48, v16 offset:512
    ds_read_b32 v49, v16 offset:640
    ds_read_b32 v50, v16 offset:768
    ds_read_b32 v51, v16 offset:896
    s_waitcnt lgkmcnt(3)
    v_add_f32 v44, v44, v48
    s_waitcnt lgkmcnt(2)
    v_add_f32 v45, v45, v49
    s_waitcnt lgkmcnt(1)
    v_add_f32 v46, v46, v50
    s_waitcnt lgkmcnt(0)
    v_add_f32 v47, v47, v51
    v_add_f32 v44, v44, v46
    v_add_f32 v45, v45, v47
    v_add_f32 v44, v44, v45
    v_cvt_pk_bf16_f32 v44, v44, v44
    v_lshlrev_b32 v44, 16, v44
    v_mul_f32 v44, v44, v94
    v_cvt_pk_bf16_f32 v44, v44, v44
    v_lshlrev_b32 v44, 16, v44
    v_add_f32 v44, v44, v96
    v_cvt_pk_bf16_f32 v44, v44, v44
    v_lshlrev_b32 v44, 16, v44
    v_mul_f32 v44, v44, v95
    v_cvt_pk_bf16_f32 v44, v44, v44
    v_lshlrev_b32 v44, 16, v44
    v_add_f32 v44, v44, v97
    v_cvt_pk_bf16_f32 v44, v44, v44
    s_mov_b64 exec, 0xffffffff
    buffer_store_short v44, v19, s[68:71], s13 offen sc1
    s_branch adaLN_cond__sliding_block_cached__moe_arch_mod__prompt_kernel_end
adaLN_cond__sliding_block_cached__moe_arch_mod__prompt_kernel_roleB:
    v_mov_b32 v132, 0
    v_mov_b32 v133, 0
    v_lshrrev_b32 v16, 3, v0
    v_and_b32 v17, 7, v0
    v_mul_u32_u24 v135, 24576, v16
    v_lshl_add_u32 v135, v17, 4, v135
    v_lshlrev_b32 v136, 2, v16
    s_and_b32 s14, s2, 31
    s_lshr_b32 s15, s2, 5
    s_mul_i32 s26, s15, 1572864
    s_lshl_b32 s16, s14, 7
    s_add_u32 s26, s26, s16
    s_lshl_b32 s29, s15, 8
    v_lshlrev_b32 v137, 3, v0
    s_lshl_b32 s18, s2, 3
    s_add_u32 s18, s18, s3
    s_lshl_b32 s18, s18, 11
    v_and_b32 v18, 15, v1
    v_lshrrev_b32 v19, 4, v1
    v_lshlrev_b32 v138, 11, v18
    v_lshl_add_u32 v138, v19, 4, v138
    s_lshr_b32 s30, s2, 4
    s_and_b32 s31, s2, 15
    s_lshl_b32 s19, s30, 3
    s_add_u32 s19, s19, s3
    s_lshl_b32 s22, s19, 15
    s_lshl_b32 s23, s31, 7
    s_add_u32 s22, s22, s23
    s_lshl_b32 s23, s2, 12
    s_add_u32 s23, s23, 0x600000
    s_or_b32 s25, s2, s3
    s_cmp_eq_u32 s25, 0
    s_cselect_b32 s25, 0, 0x7ffffff0
    s_waitcnt lgkmcnt(0)
    s_mov_b64 s[64:65], s[58:59]
    s_mov_b32 s66, 0x100
    s_mov_b32 s67, 0x20000
    s_or_b32 s28, s62, 1
    v_mov_b32 v134, s28
    s_mov_b64 exec, 1
    buffer_store_dword v134, v132, s[64:67], s25 offen sc1
    s_mov_b64 exec, -1
    s_mov_b64 s[68:69], s[52:53]
    s_mov_b32 s70, 0x800
    s_mov_b32 s71, 0x20000
    s_mov_b64 s[72:73], s[54:55]
    s_mov_b32 s74, 0xc00000
    s_mov_b32 s75, 0x20000
    s_mov_b64 s[76:77], s[32:33]
    s_mov_b32 s78, 0x400000
    s_mov_b32 s79, 0x20000
    s_mov_b64 s[8:9], s[60:61]
    s_mov_b32 s10, 0x3400000
    s_mov_b32 s11, 0x20000
    buffer_load_dwordx4 v[32:35], v2, s[76:79], s18 offen offset:0
    buffer_load_dwordx4 v[36:39], v2, s[76:79], s18 offen offset:1024
    buffer_load_dword v72, v136, s[68:71], s29 offen
    buffer_load_dwordx4 v[24:27], v135, s[72:75], s26 offen
    s_add_u32 s26, s26, 12288
    buffer_load_dwordx4 v[28:31], v135, s[72:75], s26 offen
    buffer_store_dwordx2 v[132:133], v137, s[8:11], s23 offen sc1
    s_barrier
    buffer_load_dwordx4 v[40:43], v138, s[76:79], s22 offen offset:0
    buffer_load_dwordx4 v[44:47], v138, s[76:79], s22 offen offset:64
    s_mov_b32 s29, s19
    s_mov_b64 s[64:65], s[34:35]
    s_mov_b32 s66, 0x200000
    s_mov_b32 s67, 0x20000
    s_mov_b64 s[68:69], s[36:37]
    s_mov_b32 s70, 0x200000
    s_mov_b32 s71, 0x20000
    s_lshl_b32 s20, s2, 2
    s_add_u32 s20, s20, s3
    s_sub_u32 s20, s20, 4
    s_lshr_b32 s22, s20, 8
    s_bfe_u32 s23, s20, 0x40004
    s_and_b32 s24, s20, 15
    s_lshl_b32 s25, s22, 19
    s_lshl_b32 s26, s23, 13
    s_add_u32 s25, s25, s26
    s_add_u32 s25, s25, 393216
    v_and_b32 v16, 15, v1
    v_lshrrev_b32 v17, 4, v1
    s_lshl_b32 s21, s22, 17
    s_cmp_ge_u32 s24, 8
    s_cbranch_scc1 adaLN_cond__sliding_block_cached__moe_arch_mod__prompt_kernel_kvV
    v_lshlrev_b32 v18, 8, v16
    v_lshl_add_u32 v18, v17, 3, v18
    s_and_b32 s26, s24, 1
    s_lshl_b32 s26, s26, 12
    s_add_u32 s25, s25, s26
    s_lshr_b32 s26, s24, 1
    s_lshl_b32 s26, s26, 6
    s_add_u32 s25, s25, s26
    buffer_load_dwordx2 v[84:85], v18, s[64:67], s25 offen
    buffer_load_dwordx2 v[86:87], v18, s[64:67], s25 offen offset:32
    s_mov_b32 s26, 0x7ffffff0
    buffer_load_ushort v88, v18, s[64:67], s26 offen
    buffer_load_ushort v89, v18, s[64:67], s26 offen
    buffer_load_ushort v90, v18, s[64:67], s26 offen
    buffer_load_ushort v91, v18, s[64:67], s26 offen
    buffer_load_ushort v92, v18, s[64:67], s26 offen
    buffer_load_ushort v93, v18, s[64:67], s26 offen
    s_lshl_b32 s26, s23, 13
    s_add_u32 s21, s21, s26
    s_lshl_b32 s26, s24, 10
    s_add_u32 s21, s21, s26
    s_add_u32 s21, s21, 0x400000
    s_branch adaLN_cond__sliding_block_cached__moe_arch_mod__prompt_kernel_kvJ
adaLN_cond__sliding_block_cached__moe_arch_mod__prompt_kernel_kvV:
    s_bfe_u32 s26, s24, 0x20001
    s_lshl_b32 s26, s26, 6
    s_add_u32 s25, s25, s26
    s_and_b32 s26, s24, 1
    s_lshl_b32 s26, s26, 3
    s_add_u32 s25, s25, s26
    s_add_u32 s26, s25, 4096
    v_lshrrev_b32 v18, 2, v16
    v_lshlrev_b32 v18, 4, v18
    v_and_b32 v19, 3, v16
    v_lshl_add_u32 v18, v19, 1, v18
    v_lshl_add_u32 v18, v17, 10, v18
    buffer_load_ushort v88, v18, s[68:71], s25 offen offset:0
    buffer_load_ushort v89, v18, s[68:71], s25 offen offset:256
    buffer_load_ushort v90, v18, s[68:71], s25 offen offset:512
    buffer_load_ushort v91, v18, s[68:71], s25 offen offset:768
    buffer_load_ushort v92, v18, s[68:71], s26 offen offset:0
    buffer_load_ushort v93, v18, s[68:71], s26 offen offset:256
    buffer_load_ushort v94, v18, s[68:71], s26 offen offset:512
    buffer_load_ushort v95, v18, s[68:71], s26 offen offset:768
    s_bfe_u32 s26, s24, 0x20001
    s_lshl_b32 s26, s26, 15
    s_add_u32 s21, s21, s26
    s_lshl_b32 s26, s23, 11
    s_add_u32 s21, s21, s26
    s_and_b32 s26, s24, 1
    s_lshl_b32 s26, s26, 10
    s_add_u32 s21, s21, s26
    s_add_u32 s21, s21, 0x480000
adaLN_cond__sliding_block_cached__moe_arch_mod__prompt_kernel_kvJ:
    s_waitcnt vmcnt(15)
    v_lshlrev_b32 v56, 16, v32
    v_and_b32 v57, 0xffff0000, v32
    v_lshlrev_b32 v58, 16, v33
    v_and_b32 v59, 0xffff0000, v33
    v_lshlrev_b32 v60, 16, v34
    v_and_b32 v61, 0xffff0000, v34
    v_lshlrev_b32 v62, 16, v35
    v_and_b32 v63, 0xffff0000, v35
    s_waitcnt vmcnt(14)
    v_lshlrev_b32 v64, 16, v36
    v_and_b32 v65, 0xffff0000, v36
    v_lshlrev_b32 v66, 16, v37
    v_and_b32 v67, 0xffff0000, v37
    v_lshlrev_b32 v68, 16, v38
    v_and_b32 v69, 0xffff0000, v38
    v_lshlrev_b32 v70, 16, v39
    v_and_b32 v71, 0xffff0000, v39
    v_add_f32 v20, v56, v57
    v_add_f32 v21, v58, v59
    v_add_f32 v20, v20, v60
    v_add_f32 v21, v21, v61
    v_add_f32 v20, v20, v62
    v_add_f32 v21, v21, v63
    v_add_f32 v20, v20, v64
    v_add_f32 v21, v21, v65
    v_add_f32 v20, v20, v66
    v_add_f32 v21, v21, v67
    v_add_f32 v20, v20, v68
    v_add_f32 v21, v21, v69
    v_add_f32 v20, v20, v70
    v_add_f32 v21, v21, v71
    v_add_f32 v128, v20, v21
    s_nop 1
    v_add_f32_dpp v128, v128, v128 row_ror:1 row_mask:0xf bank_mask:0xf
    s_nop 1
    v_add_f32_dpp v128, v128, v128 row_ror:2 row_mask:0xf bank_mask:0xf
    s_nop 1
    v_add_f32_dpp v128, v128, v128 row_ror:4 row_mask:0xf bank_mask:0xf
    s_nop 1
    v_add_f32_dpp v128, v128, v128 row_ror:8 row_mask:0xf bank_mask:0xf
    v_mov_b32 v20, v128
    s_nop 1
    v_permlane16_swap_b32 v128, v20
    v_add_f32 v128, v128, v20
    v_mov_b32 v20, v128
    s_nop 1
    v_permlane32_swap_b32 v128, v20
    v_add_f32 v128, v128, v20
    v_mul_f32 v128, 0x3a800000, v128
    v_sub_f32 v18, v56, v128
    v_mul_f32 v20, v18, v18
    v_sub_f32 v19, v57, v128
    v_mul_f32 v21, v19, v19
    v_sub_f32 v18, v58, v128
    v_sub_f32 v19, v59, v128
    v_fmac_f32 v20, v18, v18
    v_fmac_f32 v21, v19, v19
    v_sub_f32 v18, v60, v128
    v_sub_f32 v19, v61, v128
    v_fmac_f32 v20, v18, v18
    v_fmac_f32 v21, v19, v19
    v_sub_f32 v18, v62, v128
    v_sub_f32 v19, v63, v128
    v_fmac_f32 v20, v18, v18
    v_fmac_f32 v21, v19, v19
    v_sub_f32 v18, v64, v128
    v_sub_f32 v19, v65, v128
    v_fmac_f32 v20, v18, v18
    v_fmac_f32 v21, v19, v19
    v_sub_f32 v18, v66, v128
    v_sub_f32 v19, v67, v128
    v_fmac_f32 v20, v18, v18
    v_fmac_f32 v21, v19, v19
    v_sub_f32 v18, v68, v128
    v_sub_f32 v19, v69, v128
    v_fmac_f32 v20, v18, v18
    v_fmac_f32 v21, v19, v19
    v_sub_f32 v18, v70, v128
    v_sub_f32 v19, v71, v128
    v_fmac_f32 v20, v18, v18
    v_fmac_f32 v21, v19, v19
    v_add_f32 v17, v20, v21
    s_nop 1
    v_add_f32_dpp v17, v17, v17 row_ror:1 row_mask:0xf bank_mask:0xf
    s_nop 1
    v_add_f32_dpp v17, v17, v17 row_ror:2 row_mask:0xf bank_mask:0xf
    s_nop 1
    v_add_f32_dpp v17, v17, v17 row_ror:4 row_mask:0xf bank_mask:0xf
    s_nop 1
    v_add_f32_dpp v17, v17, v17 row_ror:8 row_mask:0xf bank_mask:0xf
    v_mov_b32 v20, v17
    s_nop 1
    v_permlane16_swap_b32 v17, v20
    v_add_f32 v17, v17, v20
    v_mov_b32 v20, v17
    s_nop 1
    v_permlane32_swap_b32 v17, v20
    v_add_f32 v17, v17, v20
    v_mul_f32 v17, 0x3a800000, v17
    v_cvt_pk_bf16_f32 v128, v128, v128
    v_lshlrev_b32 v128, 16, v128
    v_cvt_pk_bf16_f32 v17, v17, v17
    v_lshlrev_b32 v17, 16, v17
    v_add_f32 v17, 0x3727c5ac, v17
    v_cvt_pk_bf16_f32 v17, v17, v17
    v_lshlrev_b32 v17, 16, v17
    v_sqrt_f32 v129, v17
    s_nop 0
    v_cvt_pk_bf16_f32 v129, v129, v129
    v_lshlrev_b32 v129, 16, v129
    v_rcp_f32 v130, v129
    s_lshl_b32 s16, s3, 4
    s_add_u32 s16, s16, 149520
    v_mov_b32 v19, s16
    ds_write_b128 v19, v[128:131]
    s_waitcnt vmcnt(13)
    v_and_b32 v73, 0xffff0000, v72
    v_lshlrev_b32 v72, 16, v72
    v_mul_f32 v16, 0xbfb8aa3b, v72
    v_exp_f32 v16, v16
    s_nop 0
    v_add_f32 v16, 1.0, v16
    v_rcp_f32 v16, v16
    s_nop 0
    v_mul_f32 v72, v72, v16
    v_mul_f32 v17, 0xbfb8aa3b, v73
    v_exp_f32 v17, v17
    s_nop 0
    v_add_f32 v17, 1.0, v17
    v_rcp_f32 v17, v17
    s_nop 0
    v_mul_f32 v73, v73, v17
    v_cvt_pk_bf16_f32 v16, v72, v73
    v_lshlrev_b32 v72, 16, v16
    v_and_b32 v73, 0xffff0000, v16
    s_lshl_b32 s16, s2, 8
    s_add_u32 s16, s16, 0x550000
    s_mov_b32 exec_lo, 0x01010101
    s_mov_b32 exec_hi, 0x01010101
    buffer_store_dword v16, v136, s[8:11], s16 offen sc1
    s_mov_b64 exec, -1
    v_lshrrev_b32 v74, 16, v72
    v_lshrrev_b32 v75, 16, v73
    s_waitcnt vmcnt(13)
    v_dot2_f32_bf16 v49, v24, v72, 0
    v_dot2_f32_bf16 v48, v24, v74, 0
    v_dot2_f32_bf16 v51, v25, v72, 0
    v_dot2_f32_bf16 v50, v25, v74, 0
    v_dot2_f32_bf16 v53, v26, v72, 0
    v_dot2_f32_bf16 v52, v26, v74, 0
    v_dot2_f32_bf16 v55, v27, v72, 0
    v_dot2_f32_bf16 v54, v27, v74, 0
    s_waitcnt vmcnt(12)
    v_dot2c_f32_bf16 v49, v28, v73
    v_dot2c_f32_bf16 v48, v28, v75
    v_dot2c_f32_bf16 v51, v29, v73
    v_dot2c_f32_bf16 v50, v29, v75
    v_dot2c_f32_bf16 v53, v30, v73
    v_dot2c_f32_bf16 v52, v30, v75
    v_dot2c_f32_bf16 v55, v31, v73
    v_dot2c_f32_bf16 v54, v31, v75
    s_nop 0
    v_permlane32_swap_b32 v48, v52
    v_permlane32_swap_b32 v49, v53
    v_permlane32_swap_b32 v50, v54
    v_permlane32_swap_b32 v51, v55
    v_add_f32 v48, v48, v52
    v_add_f32 v49, v49, v53
    v_add_f32 v50, v50, v54
    v_add_f32 v51, v51, v55
    s_nop 0
    v_permlane16_swap_b32 v48, v50
    v_permlane16_swap_b32 v49, v51
    v_add_f32 v48, v48, v50
    v_add_f32 v49, v49, v51
    s_nop 0
    v_add_f32_dpp v48, v48, v48 row_ror:8 row_mask:0xf bank_mask:0xf
    v_add_f32_dpp v49, v49, v49 row_ror:8 row_mask:0xf bank_mask:0xf
    v_and_b32 v16, 7, v1
    v_lshlrev_b32 v16, 5, v16
    v_lshrrev_b32 v17, 4, v1
    v_lshl_add_u32 v16, v17, 3, v16
    s_lshl_b32 s16, s3, 8
    s_add_u32 s16, s16, 147456
    v_add_u32 v16, s16, v16
    ds_write_b64 v16, v[48:49]
    v_mov_b32 v19, 149504
    v_and_b32 v17, 31, v1
    v_lshlrev_b32 v18, 3, v17
    v_add_u32 v18, 147456, v18
    v_lshlrev_b32 v17, 4, v17
    s_waitcnt lgkmcnt(0)
    s_barrier
    ds_read_b32 v134, v19
    ds_read_b64 v[96:97], v18 offset:0
    ds_read_b64 v[100:101], v18 offset:256
    ds_read_b64 v[104:105], v18 offset:512
    ds_read_b64 v[108:109], v18 offset:768
    ds_read_b64 v[112:113], v18 offset:1024
    ds_read_b64 v[116:117], v18 offset:1280
    ds_read_b64 v[120:121], v18 offset:1536
    ds_read_b64 v[124:125], v18 offset:1792
    s_waitcnt lgkmcnt(8)
    v_readfirstlane_b32 s28, v134
    v_and_b32 v20, 7, v1
    v_lshlrev_b32 v20, 4, v20
    v_add_u32 v21, 149520, v20
    ds_read_b128 v[128:131], v21
    s_waitcnt lgkmcnt(0)
    v_mov_b32 v131, s28
    s_lshl_b32 s16, s2, 7
    s_add_u32 s16, s16, 0x520000
    s_cmp_eq_u32 s3, 0
    s_cselect_b32 s16, s16, 0x7ffffff0
    s_mov_b64 exec, 0xff
    buffer_store_dwordx4 v[128:131], v20, s[8:11], s16 offen sc1
    s_mov_b64 exec, -1
    v_pk_add_f32 v[96:97], v[96:97], v[112:113]
    v_pk_add_f32 v[100:101], v[100:101], v[116:117]
    v_pk_add_f32 v[104:105], v[104:105], v[120:121]
    v_pk_add_f32 v[108:109], v[108:109], v[124:125]
    v_pk_add_f32 v[96:97], v[96:97], v[104:105]
    v_pk_add_f32 v[100:101], v[100:101], v[108:109]
    v_pk_add_f32 v[96:97], v[96:97], v[100:101]
    v_mov_b32 v98, s28
    v_mov_b32 v99, s28
    s_lshl_b32 s16, s14, 3
    s_add_u32 s16, s16, s15
    s_lshl_b32 s16, s16, 9
    s_add_u32 s16, s16, 0x500000
    s_cmp_eq_u32 s3, 0
    s_cselect_b32 s16, s16, 0x7ffffff0
    s_mov_b64 exec, 0xffffffff
    buffer_store_dwordx4 v[96:99], v17, s[8:11], s16 offen sc1
    s_mov_b64 exec, -1
    s_lshr_b32 s16, s3, 2
    s_lshl_b32 s16, s16, 4
    s_add_u32 s16, s16, s31
    s_lshl_b32 s16, s16, 12
    s_and_b32 s17, s3, 3
    s_lshl_b32 s17, s17, 7
    s_add_u32 s16, s16, s17
    s_add_u32 s16, s16, 0x500000
    v_lshrrev_b32 v139, 3, v1
    v_lshlrev_b32 v139, 9, v139
    v_and_b32 v16, 7, v1
    v_lshl_add_u32 v139, v16, 4, v139
    v_and_b32 v140, 15, v1
    v_lshlrev_b32 v140, 4, v140
    s_lshl_b32 s17, s29, 8
    s_add_u32 s17, s17, 0x520000
    s_waitcnt vmcnt(12)
    v_lshlrev_b32 v56, 16, v40
    v_and_b32 v57, 0xffff0000, v40
    v_lshlrev_b32 v58, 16, v41
    v_and_b32 v59, 0xffff0000, v41
    v_lshlrev_b32 v60, 16, v42
    v_and_b32 v61, 0xffff0000, v42
    v_lshlrev_b32 v62, 16, v43
    v_and_b32 v63, 0xffff0000, v43
    s_waitcnt vmcnt(11)
    v_lshlrev_b32 v64, 16, v44
    v_and_b32 v65, 0xffff0000, v44
    v_lshlrev_b32 v66, 16, v45
    v_and_b32 v67, 0xffff0000, v45
    v_lshlrev_b32 v68, 16, v46
    v_and_b32 v69, 0xffff0000, v46
    v_lshlrev_b32 v70, 16, v47
    v_and_b32 v71, 0xffff0000, v47
    v_mov_b32 v135, 2097152
    v_mul_lo_u32 v135, v135, v1
    s_mov_b64 s[76:77], s[40:41]
    s_mov_b32 s78, 0x800000
    s_mov_b32 s79, 0x20000
    s_mov_b32 s62, 0x0
    s_cmp_eq_u32 s3, 4
    s_cselect_b32 s62, s62, 0x7ffffff0
    buffer_load_dword v136, v135, s[76:79], s62 offen
    s_mov_b64 s[76:77], s[46:47]
    s_mov_b32 s78, 0x700000
    s_mov_b32 s79, 0x20000
    s_mov_b32 s62, 0x0
    s_cmp_eq_u32 s3, 4
    s_cselect_b32 s62, s62, 0x7ffffff0
    buffer_load_dword v136, v135, s[76:79], s62 offen
    s_mov_b64 s[76:77], s[48:49]
    s_mov_b32 s78, 0x700000
    s_mov_b32 s79, 0x20000
    s_mov_b32 s62, 0x0
    s_cmp_eq_u32 s3, 5
    s_cselect_b32 s62, s62, 0x7ffffff0
    buffer_load_dword v136, v135, s[76:79], s62 offen
    s_mov_b64 s[76:77], s[50:51]
    s_mov_b32 s78, 0x700000
    s_mov_b32 s79, 0x20000
    s_mov_b32 s62, 0x0
    s_cmp_eq_u32 s3, 5
    s_cselect_b32 s62, s62, 0x7ffffff0
    buffer_load_dword v136, v135, s[76:79], s62 offen
    s_mov_b64 s[76:77], s[38:39]
    s_mov_b32 s78, 0x800000
    s_mov_b32 s79, 0x20000
    s_mov_b32 s62, 0x0
    s_cmp_eq_u32 s3, 6
    s_cselect_b32 s62, s62, 0x7ffffff0
    buffer_load_dword v136, v135, s[76:79], s62 offen
    s_mov_b64 s[76:77], s[56:57]
    s_mov_b32 s78, 0x400000
    s_mov_b32 s79, 0x20000
    s_mov_b32 s62, 0x0
    s_cmp_eq_u32 s3, 6
    s_cselect_b32 s62, s62, 0x7ffffff0
    buffer_load_dword v136, v135, s[76:79], s62 offen
    s_mov_b64 s[76:77], s[54:55]
    s_mov_b32 s78, 0xc00000
    s_mov_b32 s79, 0x20000
    s_mov_b32 s62, 0x0
    s_cmp_eq_u32 s3, 7
    s_cselect_b32 s62, s62, 0x7ffffff0
    buffer_load_dword v136, v135, s[76:79], s62 offen
    s_mov_b64 s[76:77], s[44:45]
    s_mov_b32 s78, 0x800
    s_mov_b32 s79, 0x20000
    s_mov_b32 s62, 0x0
    s_cmp_eq_u32 s3, 7
    s_cselect_b32 s62, s62, 0x7ffffff0
    buffer_load_dword v136, v135, s[76:79], s62 offen
    s_mov_b32 s27, 0
adaLN_cond__sliding_block_cached__moe_arch_mod__prompt_kernel_g14p:
    buffer_load_dwordx4 v[76:79], v139, s[8:11], s16 offen sc1
    buffer_load_dwordx4 v[80:83], v140, s[8:11], s17 offen sc1
    s_waitcnt vmcnt(1)
    v_cmp_ne_u32 vcc, s28, v78
    v_cmp_ne_u32 s[62:63], s28, v79
    s_or_b64 vcc, vcc, s[62:63]
    s_waitcnt vmcnt(0)
    v_cmp_ne_u32 s[62:63], s28, v83
    s_or_b64 vcc, vcc, s[62:63]
    s_add_u32 s27, s27, 1
    s_cmp_ge_u32 s27, 65536
    s_cbranch_scc1 adaLN_cond__sliding_block_cached__moe_arch_mod__prompt_kernel_g14g
    s_cbranch_vccnz adaLN_cond__sliding_block_cached__moe_arch_mod__prompt_kernel_g14p
adaLN_cond__sliding_block_cached__moe_arch_mod__prompt_kernel_g14g:
    v_add_f32_dpp v76, v76, v76 row_ror:8 row_mask:0xf bank_mask:0xf
    v_add_f32_dpp v77, v77, v77 row_ror:8 row_mask:0xf bank_mask:0xf
    v_mov_b32 v17, v76
    s_nop 1
    v_permlane16_swap_b32 v76, v17
    v_add_f32 v76, v76, v17
    v_mov_b32 v18, v77
    s_nop 1
    v_permlane16_swap_b32 v77, v18
    v_add_f32 v77, v77, v18
    v_mov_b32 v17, v76
    s_nop 1
    v_permlane32_swap_b32 v76, v17
    v_add_f32 v76, v76, v17
    v_mov_b32 v18, v77
    s_nop 1
    v_permlane32_swap_b32 v77, v18
    v_add_f32 v77, v77, v18
    v_cvt_pk_bf16_f32 v17, v76, v77
    v_lshlrev_b32 v76, 16, v17
    v_and_b32 v77, 0xffff0000, v17
    v_add_f32 v76, 1.0, v76
    v_add_f32 v77, 1.0, v77
    v_cvt_pk_bf16_f32 v17, v76, v77
    v_lshlrev_b32 v76, 16, v17
    v_and_b32 v77, 0xffff0000, v17
    s_lshl_b32 s16, s3, 6
    s_add_u32 s16, s16, 151552
    v_lshl_add_u32 v16, v16, 3, s16
    ds_write_b64 v16, v[76:77]
    v_lshrrev_b32 v17, 4, v1
    v_lshlrev_b32 v17, 5, v17
    v_add_u32 v17, 151552, v17
    v_sub_f32 v56, v56, v80
    v_sub_f32 v57, v57, v80
    v_sub_f32 v58, v58, v80
    v_sub_f32 v59, v59, v80
    v_sub_f32 v60, v60, v80
    v_sub_f32 v61, v61, v80
    v_sub_f32 v62, v62, v80
    v_sub_f32 v63, v63, v80
    v_sub_f32 v64, v64, v80
    v_sub_f32 v65, v65, v80
    v_sub_f32 v66, v66, v80
    v_sub_f32 v67, v67, v80
    v_sub_f32 v68, v68, v80
    v_sub_f32 v69, v69, v80
    v_sub_f32 v70, v70, v80
    v_sub_f32 v71, v71, v80
    v_cvt_pk_bf16_f32 v18, v56, v57
    v_lshlrev_b32 v56, 16, v18
    v_and_b32 v57, 0xffff0000, v18
    v_cvt_pk_bf16_f32 v19, v58, v59
    v_lshlrev_b32 v58, 16, v19
    v_and_b32 v59, 0xffff0000, v19
    v_cvt_pk_bf16_f32 v18, v60, v61
    v_lshlrev_b32 v60, 16, v18
    v_and_b32 v61, 0xffff0000, v18
    v_cvt_pk_bf16_f32 v19, v62, v63
    v_lshlrev_b32 v62, 16, v19
    v_and_b32 v63, 0xffff0000, v19
    v_cvt_pk_bf16_f32 v18, v64, v65
    v_lshlrev_b32 v64, 16, v18
    v_and_b32 v65, 0xffff0000, v18
    v_cvt_pk_bf16_f32 v19, v66, v67
    v_lshlrev_b32 v66, 16, v19
    v_and_b32 v67, 0xffff0000, v19
    v_cvt_pk_bf16_f32 v18, v68, v69
    v_lshlrev_b32 v68, 16, v18
    v_and_b32 v69, 0xffff0000, v18
    v_cvt_pk_bf16_f32 v19, v70, v71
    v_lshlrev_b32 v70, 16, v19
    v_and_b32 v71, 0xffff0000, v19
    v_mul_f32 v56, v56, v82
    v_mul_f32 v57, v57, v82
    v_mul_f32 v58, v58, v82
    v_mul_f32 v59, v59, v82
    v_mul_f32 v60, v60, v82
    v_mul_f32 v61, v61, v82
    v_mul_f32 v62, v62, v82
    v_mul_f32 v63, v63, v82
    v_mul_f32 v64, v64, v82
    v_mul_f32 v65, v65, v82
    v_mul_f32 v66, v66, v82
    v_mul_f32 v67, v67, v82
    v_mul_f32 v68, v68, v82
    v_mul_f32 v69, v69, v82
    v_mul_f32 v70, v70, v82
    v_mul_f32 v71, v71, v82
    v_cvt_pk_bf16_f32 v18, v56, v57
    v_lshlrev_b32 v56, 16, v18
    v_and_b32 v57, 0xffff0000, v18
    v_cvt_pk_bf16_f32 v19, v58, v59
    v_lshlrev_b32 v58, 16, v19
    v_and_b32 v59, 0xffff0000, v19
    v_cvt_pk_bf16_f32 v18, v60, v61
    v_lshlrev_b32 v60, 16, v18
    v_and_b32 v61, 0xffff0000, v18
    v_cvt_pk_bf16_f32 v19, v62, v63
    v_lshlrev_b32 v62, 16, v19
    v_and_b32 v63, 0xffff0000, v19
    v_cvt_pk_bf16_f32 v18, v64, v65
    v_lshlrev_b32 v64, 16, v18
    v_and_b32 v65, 0xffff0000, v18
    v_cvt_pk_bf16_f32 v19, v66, v67
    v_lshlrev_b32 v66, 16, v19
    v_and_b32 v67, 0xffff0000, v19
    v_cvt_pk_bf16_f32 v18, v68, v69
    v_lshlrev_b32 v68, 16, v18
    v_and_b32 v69, 0xffff0000, v18
    v_cvt_pk_bf16_f32 v19, v70, v71
    v_lshlrev_b32 v70, 16, v19
    v_and_b32 v71, 0xffff0000, v19
    s_lshl_b32 s16, s29, 15
    s_lshl_b32 s17, s31, 11
    s_add_u32 s16, s16, s17
    s_waitcnt lgkmcnt(0)
    s_barrier
    s_cmp_lt_u32 s24, 8
    s_cbranch_scc1 adaLN_cond__sliding_block_cached__moe_arch_mod__prompt_kernel_kvS
    v_lshl_or_b32 v84, v89, 16, v88
    v_lshl_or_b32 v85, v91, 16, v90
    v_lshl_or_b32 v86, v93, 16, v92
    v_lshl_or_b32 v87, v95, 16, v94
    v_and_b32 v88, 0x7fff, v88
    v_and_b32 v89, 0x7fff, v89
    v_and_b32 v90, 0x7fff, v90
    v_and_b32 v91, 0x7fff, v91
    v_and_b32 v92, 0x7fff, v92
    v_and_b32 v93, 0x7fff, v93
    v_and_b32 v94, 0x7fff, v94
    v_and_b32 v95, 0x7fff, v95
    v_max3_u32 v88, v88, v89, v90
    v_max3_u32 v91, v91, v92, v93
    v_max3_u32 v88, v88, v94, v95
    v_max_u32 v88, v88, v91
    v_cmp_le_u32 vcc, 0x4980, v88
    v_mov_b32 v89, s28
    s_mov_b32 s26, 0x564000
    s_and_saveexec_b64 s[62:63], vcc
    buffer_store_dword v89, v132, s[8:11], s26 offen sc1
    s_mov_b64 exec, s[62:63]
adaLN_cond__sliding_block_cached__moe_arch_mod__prompt_kernel_kvS:
    buffer_store_dwordx4 v[84:87], v2, s[8:11], s21 offen sc1
    ds_read_b128 v[96:99], v17 offset:256
    ds_read_b128 v[104:107], v17 offset:0
    ds_read_b128 v[100:103], v17 offset:272
    ds_read_b128 v[108:111], v17 offset:16
    ds_read_b128 v[112:115], v17 offset:384
    ds_read_b128 v[120:123], v17 offset:128
    ds_read_b128 v[116:119], v17 offset:400
    ds_read_b128 v[124:127], v17 offset:144
    s_waitcnt lgkmcnt(7)
    v_pk_mul_f32 v[56:57], v[56:57], v[96:97]
    v_pk_mul_f32 v[58:59], v[58:59], v[98:99]
    s_waitcnt lgkmcnt(5)
    v_pk_mul_f32 v[60:61], v[60:61], v[100:101]
    v_pk_mul_f32 v[62:63], v[62:63], v[102:103]
    v_cvt_pk_bf16_f32 v18, v56, v57
    v_lshlrev_b32 v56, 16, v18
    v_and_b32 v57, 0xffff0000, v18
    v_cvt_pk_bf16_f32 v19, v58, v59
    v_lshlrev_b32 v58, 16, v19
    v_and_b32 v59, 0xffff0000, v19
    v_cvt_pk_bf16_f32 v18, v60, v61
    v_lshlrev_b32 v60, 16, v18
    v_and_b32 v61, 0xffff0000, v18
    v_cvt_pk_bf16_f32 v19, v62, v63
    v_lshlrev_b32 v62, 16, v19
    v_and_b32 v63, 0xffff0000, v19
    v_pk_add_f32 v[56:57], v[56:57], v[104:105]
    v_pk_add_f32 v[58:59], v[58:59], v[106:107]
    s_waitcnt lgkmcnt(4)
    v_pk_add_f32 v[60:61], v[60:61], v[108:109]
    v_pk_add_f32 v[62:63], v[62:63], v[110:111]
    v_cvt_pk_bf16_f32 v32, v56, v57
    v_cvt_pk_bf16_f32 v33, v58, v59
    v_cvt_pk_bf16_f32 v34, v60, v61
    v_cvt_pk_bf16_f32 v35, v62, v63
    buffer_store_dwordx4 v[32:35], v2, s[8:11], s16 offen offset:0 sc1
    s_waitcnt lgkmcnt(3)
    v_pk_mul_f32 v[64:65], v[64:65], v[112:113]
    v_pk_mul_f32 v[66:67], v[66:67], v[114:115]
    s_waitcnt lgkmcnt(1)
    v_pk_mul_f32 v[68:69], v[68:69], v[116:117]
    v_pk_mul_f32 v[70:71], v[70:71], v[118:119]
    v_cvt_pk_bf16_f32 v18, v64, v65
    v_lshlrev_b32 v64, 16, v18
    v_and_b32 v65, 0xffff0000, v18
    v_cvt_pk_bf16_f32 v19, v66, v67
    v_lshlrev_b32 v66, 16, v19
    v_and_b32 v67, 0xffff0000, v19
    v_cvt_pk_bf16_f32 v18, v68, v69
    v_lshlrev_b32 v68, 16, v18
    v_and_b32 v69, 0xffff0000, v18
    v_cvt_pk_bf16_f32 v19, v70, v71
    v_lshlrev_b32 v70, 16, v19
    v_and_b32 v71, 0xffff0000, v19
    v_pk_add_f32 v[64:65], v[64:65], v[120:121]
    v_pk_add_f32 v[66:67], v[66:67], v[122:123]
    s_waitcnt lgkmcnt(0)
    v_pk_add_f32 v[68:69], v[68:69], v[124:125]
    v_pk_add_f32 v[70:71], v[70:71], v[126:127]
    v_cvt_pk_bf16_f32 v36, v64, v65
    v_cvt_pk_bf16_f32 v37, v66, v67
    v_cvt_pk_bf16_f32 v38, v68, v69
    v_cvt_pk_bf16_f32 v39, v70, v71
    buffer_store_dwordx4 v[36:39], v2, s[8:11], s16 offen offset:1024 sc1
    s_lshl_b32 s19, s3, 16
    s_lshl_b32 s20, s3, 11
    s_lshl_b32 s16, s12, 8
    s_add_u32 s4, s38, s16
    s_addc_u32 s5, s39, 0
    s_sub_u32 s6, 0x800000, s16
    s_mov_b32 s7, 0x20000
    s_barrier
    s_add_u32 s22, s19, 0x0
    s_add_u32 m0, s20, 0x0
    s_nop 0
    buffer_load_dwordx4 v3, s[4:7], s22 offen lds
    s_add_u32 s22, s19, 0x8000
    s_add_u32 m0, s20, 0x400
    s_nop 0
    buffer_load_dwordx4 v3, s[4:7], s22 offen lds
    s_add_u32 s22, s19, 0x80000
    s_add_u32 m0, s20, 0x4000
    s_nop 0
    buffer_load_dwordx4 v3, s[4:7], s22 offen lds
    s_add_u32 s22, s19, 0x88000
    s_add_u32 m0, s20, 0x4400
    s_nop 0
    buffer_load_dwordx4 v3, s[4:7], s22 offen lds
    s_add_u32 s22, s19, 0x100000
    s_add_u32 m0, s20, 0x8000
    s_nop 0
    buffer_load_dwordx4 v3, s[4:7], s22 offen lds
    s_add_u32 s22, s19, 0x108000
    s_add_u32 m0, s20, 0x8400
    s_nop 0
    buffer_load_dwordx4 v3, s[4:7], s22 offen lds
    v_mov_b32 v134, s28
    s_lshl_b32 s16, s29, 4
    s_add_u32 s16, s16, s31
    s_lshl_b32 s16, s16, 2
    s_add_u32 s16, s16, 0x528000
    v_and_b32 v16, 31, v1
    v_lshlrev_b32 v16, 2, v16
    s_lshl_b32 s17, s13, 3
    s_add_u32 s17, s17, s3
    s_lshl_b32 s17, s17, 7
    s_add_u32 s17, s17, 0x528000
    s_waitcnt vmcnt(6)
    s_mov_b64 exec, 1
    buffer_store_dword v134, v132, s[8:11], s16 offen sc1
    s_mov_b64 exec, -1
    s_waitcnt vmcnt(0)
    s_mov_b32 s27, 0
adaLN_cond__sliding_block_cached__moe_arch_mod__prompt_kernel_h15p:
    buffer_load_dword v17, v16, s[8:11], s17 offen sc1
    s_waitcnt vmcnt(0)
    v_cmp_ne_u32 vcc, s28, v17
    s_add_u32 s27, s27, 1
    s_cmp_ge_u32 s27, 65536
    s_cbranch_scc1 adaLN_cond__sliding_block_cached__moe_arch_mod__prompt_kernel_h15g
    s_cbranch_vccnz adaLN_cond__sliding_block_cached__moe_arch_mod__prompt_kernel_h15p
adaLN_cond__sliding_block_cached__moe_arch_mod__prompt_kernel_h15g:
    s_mov_b32 s23, 0x0
    buffer_load_dwordx4 v[88:91], v7, s[8:11], s23 offen offset:0 sc1
    s_mov_b32 s23, 0x8000
    buffer_load_dwordx4 v[92:95], v7, s[8:11], s23 offen offset:0 sc1
    s_mov_b32 s23, 0x0
    buffer_load_dwordx4 v[96:99], v7, s[8:11], s23 offen offset:1024 sc1
    s_mov_b32 s23, 0x8000
    buffer_load_dwordx4 v[100:103], v7, s[8:11], s23 offen offset:1024 sc1
    s_mov_b32 s23, 0x800
    buffer_load_dwordx4 v[104:107], v7, s[8:11], s23 offen offset:0 sc1
    s_mov_b32 s23, 0x8800
    buffer_load_dwordx4 v[108:111], v7, s[8:11], s23 offen offset:0 sc1
    s_mov_b32 s23, 0x800
    buffer_load_dwordx4 v[112:115], v7, s[8:11], s23 offen offset:1024 sc1
    s_mov_b32 s23, 0x8800
    buffer_load_dwordx4 v[116:119], v7, s[8:11], s23 offen offset:1024 sc1
    s_mov_b32 s23, 0x1000
    buffer_load_dwordx4 v[120:123], v7, s[8:11], s23 offen offset:0 sc1
    s_mov_b32 s23, 0x9000
    buffer_load_dwordx4 v[124:127], v7, s[8:11], s23 offen offset:0 sc1
    s_mov_b32 s23, 0x1000
    buffer_load_dwordx4 v[128:131], v7, s[8:11], s23 offen offset:1024 sc1
    s_mov_b32 s23, 0x9000
    buffer_load_dwordx4 v[132:135], v7, s[8:11], s23 offen offset:1024 sc1
    s_lshr_b32 s21, s12, 3
    s_lshl_b32 s21, s21, 17
    s_add_u32 s21, s21, s20
    s_add_u32 s21, s21, 0x400000
    s_barrier
    ds_read_b64_tr_b16 v[224:225], v4 offset:0
    ds_read_b64_tr_b16 v[226:227], v4 offset:1024
    ds_read_b64_tr_b16 v[228:229], v5 offset:32
    ds_read_b64_tr_b16 v[230:231], v5 offset:1056
    ds_read_b64_tr_b16 v[232:233], v4 offset:256
    ds_read_b64_tr_b16 v[234:235], v4 offset:1280
    s_waitcnt vmcnt(11) lgkmcnt(4)
    v_mfma_f32_16x16x32_bf16 v[24:27], v[224:227], v[88:91], 0
    ds_read_b64_tr_b16 v[236:237], v5 offset:288
    s_waitcnt vmcnt(10)
    v_mfma_f32_16x16x32_bf16 v[28:31], v[224:227], v[92:95], 0
    ds_read_b64_tr_b16 v[238:239], v5 offset:1312
    s_waitcnt lgkmcnt(4)
    v_mfma_f32_16x16x32_bf16 v[32:35], v[228:231], v[88:91], 0
    ds_read_b64_tr_b16 v[240:241], v4 offset:512
    v_mfma_f32_16x16x32_bf16 v[36:39], v[228:231], v[92:95], 0
    ds_read_b64_tr_b16 v[242:243], v4 offset:1536
    s_mov_b32 s23, 0x1800
    buffer_load_dwordx4 v[136:139], v7, s[8:11], s23 offen offset:0 sc1
    s_waitcnt lgkmcnt(4)
    v_mfma_f32_16x16x32_bf16 v[40:43], v[232:235], v[88:91], 0
    ds_read_b64_tr_b16 v[244:245], v5 offset:544
    v_mfma_f32_16x16x32_bf16 v[44:47], v[232:235], v[92:95], 0
    ds_read_b64_tr_b16 v[246:247], v5 offset:1568
    s_waitcnt lgkmcnt(4)
    v_mfma_f32_16x16x32_bf16 v[48:51], v[236:239], v[88:91], 0
    ds_read_b64_tr_b16 v[224:225], v4 offset:768
    v_mfma_f32_16x16x32_bf16 v[52:55], v[236:239], v[92:95], 0
    ds_read_b64_tr_b16 v[226:227], v4 offset:1792
    s_waitcnt lgkmcnt(4)
    v_mfma_f32_16x16x32_bf16 v[56:59], v[240:243], v[88:91], 0
    ds_read_b64_tr_b16 v[228:229], v5 offset:800
    v_mfma_f32_16x16x32_bf16 v[60:63], v[240:243], v[92:95], 0
    ds_read_b64_tr_b16 v[230:231], v5 offset:1824
    s_waitcnt lgkmcnt(4)
    v_mfma_f32_16x16x32_bf16 v[64:67], v[244:247], v[88:91], 0
    ds_read_b64_tr_b16 v[232:233], v4 offset:8192
    v_mfma_f32_16x16x32_bf16 v[68:71], v[244:247], v[92:95], 0
    ds_read_b64_tr_b16 v[234:235], v4 offset:9216
    s_mov_b32 s23, 0x9800
    buffer_load_dwordx4 v[140:143], v7, s[8:11], s23 offen offset:0 sc1
    s_waitcnt lgkmcnt(4)
    v_mfma_f32_16x16x32_bf16 v[72:75], v[224:227], v[88:91], 0
    ds_read_b64_tr_b16 v[236:237], v5 offset:8224
    v_mfma_f32_16x16x32_bf16 v[76:79], v[224:227], v[92:95], 0
    ds_read_b64_tr_b16 v[238:239], v5 offset:9248
    s_waitcnt lgkmcnt(4)
    v_mfma_f32_16x16x32_bf16 v[80:83], v[228:231], v[88:91], 0
    ds_read_b64_tr_b16 v[240:241], v4 offset:8448
    v_mfma_f32_16x16x32_bf16 v[84:87], v[228:231], v[92:95], 0
    ds_read_b64_tr_b16 v[242:243], v4 offset:9472
    s_waitcnt vmcnt(11) lgkmcnt(4)
    v_mfma_f32_16x16x32_bf16 v[24:27], v[232:235], v[96:99], v[24:27]
    ds_read_b64_tr_b16 v[244:245], v5 offset:8480
    s_waitcnt vmcnt(10)
    v_mfma_f32_16x16x32_bf16 v[28:31], v[232:235], v[100:103], v[28:31]
    ds_read_b64_tr_b16 v[246:247], v5 offset:9504
    s_waitcnt lgkmcnt(4)
    v_mfma_f32_16x16x32_bf16 v[32:35], v[236:239], v[96:99], v[32:35]
    ds_read_b64_tr_b16 v[224:225], v4 offset:8704
    v_mfma_f32_16x16x32_bf16 v[36:39], v[236:239], v[100:103], v[36:39]
    ds_read_b64_tr_b16 v[226:227], v4 offset:9728
    s_mov_b32 s23, 0x1800
    buffer_load_dwordx4 v[144:147], v7, s[8:11], s23 offen offset:1024 sc1
    s_waitcnt lgkmcnt(4)
    v_mfma_f32_16x16x32_bf16 v[40:43], v[240:243], v[96:99], v[40:43]
    ds_read_b64_tr_b16 v[228:229], v5 offset:8736
    v_mfma_f32_16x16x32_bf16 v[44:47], v[240:243], v[100:103], v[44:47]
    ds_read_b64_tr_b16 v[230:231], v5 offset:9760
    s_waitcnt lgkmcnt(4)
    v_mfma_f32_16x16x32_bf16 v[48:51], v[244:247], v[96:99], v[48:51]
    ds_read_b64_tr_b16 v[232:233], v4 offset:8960
    v_mfma_f32_16x16x32_bf16 v[52:55], v[244:247], v[100:103], v[52:55]
    ds_read_b64_tr_b16 v[234:235], v4 offset:9984
    s_waitcnt lgkmcnt(4)
    v_mfma_f32_16x16x32_bf16 v[56:59], v[224:227], v[96:99], v[56:59]
    ds_read_b64_tr_b16 v[236:237], v5 offset:8992
    v_mfma_f32_16x16x32_bf16 v[60:63], v[224:227], v[100:103], v[60:63]
    ds_read_b64_tr_b16 v[238:239], v5 offset:10016
    s_waitcnt lgkmcnt(4)
    v_mfma_f32_16x16x32_bf16 v[64:67], v[228:231], v[96:99], v[64:67]
    v_mfma_f32_16x16x32_bf16 v[68:71], v[228:231], v[100:103], v[68:71]
    s_barrier
    ds_read_b64_tr_b16 v[240:241], v4 offset:16384
    ds_read_b64_tr_b16 v[242:243], v4 offset:17408
    s_mov_b32 s23, 0x9800
    buffer_load_dwordx4 v[148:151], v7, s[8:11], s23 offen offset:1024 sc1
    s_waitcnt lgkmcnt(4)
    v_mfma_f32_16x16x32_bf16 v[72:75], v[232:235], v[96:99], v[72:75]
    ds_read_b64_tr_b16 v[244:245], v5 offset:16416
    v_mfma_f32_16x16x32_bf16 v[76:79], v[232:235], v[100:103], v[76:79]
    s_add_u32 s22, s19, 0x180000
    s_add_u32 m0, s20, 0xc000
    s_nop 0
    buffer_load_dwordx4 v3, s[4:7], s22 offen lds
    ds_read_b64_tr_b16 v[246:247], v5 offset:17440
    s_waitcnt lgkmcnt(4)
    v_mfma_f32_16x16x32_bf16 v[80:83], v[236:239], v[96:99], v[80:83]
    ds_read_b64_tr_b16 v[224:225], v4 offset:16640
    v_mfma_f32_16x16x32_bf16 v[84:87], v[236:239], v[100:103], v[84:87]
    ds_read_b64_tr_b16 v[226:227], v4 offset:17664
    s_waitcnt vmcnt(12) lgkmcnt(4)
    v_mfma_f32_16x16x32_bf16 v[24:27], v[240:243], v[104:107], v[24:27]
    ds_read_b64_tr_b16 v[228:229], v5 offset:16672
    s_waitcnt vmcnt(11)
    v_mfma_f32_16x16x32_bf16 v[28:31], v[240:243], v[108:111], v[28:31]
    ds_read_b64_tr_b16 v[230:231], v5 offset:17696
    s_waitcnt lgkmcnt(4)
    v_mfma_f32_16x16x32_bf16 v[32:35], v[244:247], v[104:107], v[32:35]
    ds_read_b64_tr_b16 v[232:233], v4 offset:16896
    v_mfma_f32_16x16x32_bf16 v[36:39], v[244:247], v[108:111], v[36:39]
    ds_read_b64_tr_b16 v[234:235], v4 offset:17920
    s_mov_b32 s23, 0x2000
    buffer_load_dwordx4 v[88:91], v7, s[8:11], s23 offen offset:0 sc1
    s_waitcnt lgkmcnt(4)
    v_mfma_f32_16x16x32_bf16 v[40:43], v[224:227], v[104:107], v[40:43]
    ds_read_b64_tr_b16 v[236:237], v5 offset:16928
    v_mfma_f32_16x16x32_bf16 v[44:47], v[224:227], v[108:111], v[44:47]
    s_add_u32 s22, s19, 0x188000
    s_add_u32 m0, s20, 0xc400
    s_nop 0
    buffer_load_dwordx4 v3, s[4:7], s22 offen lds
    ds_read_b64_tr_b16 v[238:239], v5 offset:17952
    s_waitcnt lgkmcnt(4)
    v_mfma_f32_16x16x32_bf16 v[48:51], v[228:231], v[104:107], v[48:51]
    ds_read_b64_tr_b16 v[240:241], v4 offset:17152
    v_mfma_f32_16x16x32_bf16 v[52:55], v[228:231], v[108:111], v[52:55]
    ds_read_b64_tr_b16 v[242:243], v4 offset:18176
    s_waitcnt lgkmcnt(4)
    v_mfma_f32_16x16x32_bf16 v[56:59], v[232:235], v[104:107], v[56:59]
    ds_read_b64_tr_b16 v[244:245], v5 offset:17184
    v_mfma_f32_16x16x32_bf16 v[60:63], v[232:235], v[108:111], v[60:63]
    ds_read_b64_tr_b16 v[246:247], v5 offset:18208
    s_waitcnt lgkmcnt(4)
    v_mfma_f32_16x16x32_bf16 v[64:67], v[236:239], v[104:107], v[64:67]
    ds_read_b64_tr_b16 v[224:225], v4 offset:24576
    v_mfma_f32_16x16x32_bf16 v[68:71], v[236:239], v[108:111], v[68:71]
    ds_read_b64_tr_b16 v[226:227], v4 offset:25600
    s_mov_b32 s23, 0xa000
    buffer_load_dwordx4 v[92:95], v7, s[8:11], s23 offen offset:0 sc1
    s_waitcnt lgkmcnt(4)
    v_mfma_f32_16x16x32_bf16 v[72:75], v[240:243], v[104:107], v[72:75]
    ds_read_b64_tr_b16 v[228:229], v5 offset:24608
    v_mfma_f32_16x16x32_bf16 v[76:79], v[240:243], v[108:111], v[76:79]
    ds_read_b64_tr_b16 v[230:231], v5 offset:25632
    s_waitcnt lgkmcnt(4)
    v_mfma_f32_16x16x32_bf16 v[80:83], v[244:247], v[104:107], v[80:83]
    ds_read_b64_tr_b16 v[232:233], v4 offset:24832
    v_mfma_f32_16x16x32_bf16 v[84:87], v[244:247], v[108:111], v[84:87]
    ds_read_b64_tr_b16 v[234:235], v4 offset:25856
    s_waitcnt vmcnt(13) lgkmcnt(4)
    v_mfma_f32_16x16x32_bf16 v[24:27], v[224:227], v[112:115], v[24:27]
    ds_read_b64_tr_b16 v[236:237], v5 offset:24864
    s_waitcnt vmcnt(12)
    v_mfma_f32_16x16x32_bf16 v[28:31], v[224:227], v[116:119], v[28:31]
    ds_read_b64_tr_b16 v[238:239], v5 offset:25888
    s_waitcnt lgkmcnt(4)
    v_mfma_f32_16x16x32_bf16 v[32:35], v[228:231], v[112:115], v[32:35]
    ds_read_b64_tr_b16 v[240:241], v4 offset:25088
    v_mfma_f32_16x16x32_bf16 v[36:39], v[228:231], v[116:119], v[36:39]
    ds_read_b64_tr_b16 v[242:243], v4 offset:26112
    s_mov_b32 s23, 0x2000
    buffer_load_dwordx4 v[96:99], v7, s[8:11], s23 offen offset:1024 sc1
    s_waitcnt lgkmcnt(4)
    v_mfma_f32_16x16x32_bf16 v[40:43], v[232:235], v[112:115], v[40:43]
    ds_read_b64_tr_b16 v[244:245], v5 offset:25120
    v_mfma_f32_16x16x32_bf16 v[44:47], v[232:235], v[116:119], v[44:47]
    ds_read_b64_tr_b16 v[246:247], v5 offset:26144
    s_waitcnt lgkmcnt(4)
    v_mfma_f32_16x16x32_bf16 v[48:51], v[236:239], v[112:115], v[48:51]
    ds_read_b64_tr_b16 v[224:225], v4 offset:25344
    v_mfma_f32_16x16x32_bf16 v[52:55], v[236:239], v[116:119], v[52:55]
    ds_read_b64_tr_b16 v[226:227], v4 offset:26368
    s_waitcnt lgkmcnt(4)
    v_mfma_f32_16x16x32_bf16 v[56:59], v[240:243], v[112:115], v[56:59]
    ds_read_b64_tr_b16 v[228:229], v5 offset:25376
    v_mfma_f32_16x16x32_bf16 v[60:63], v[240:243], v[116:119], v[60:63]
    ds_read_b64_tr_b16 v[230:231], v5 offset:26400
    s_waitcnt lgkmcnt(4)
    v_mfma_f32_16x16x32_bf16 v[64:67], v[244:247], v[112:115], v[64:67]
    v_mfma_f32_16x16x32_bf16 v[68:71], v[244:247], v[116:119], v[68:71]
    s_barrier
    ds_read_b64_tr_b16 v[232:233], v4 offset:32768
    ds_read_b64_tr_b16 v[234:235], v4 offset:33792
    s_mov_b32 s23, 0xa000
    buffer_load_dwordx4 v[100:103], v7, s[8:11], s23 offen offset:1024 sc1
    s_waitcnt lgkmcnt(4)
    v_mfma_f32_16x16x32_bf16 v[72:75], v[224:227], v[112:115], v[72:75]
    ds_read_b64_tr_b16 v[236:237], v5 offset:32800
    v_mfma_f32_16x16x32_bf16 v[76:79], v[224:227], v[116:119], v[76:79]
    s_add_u32 s22, s19, 0x200000
    s_add_u32 m0, s20, 0x0
    s_nop 0
    buffer_load_dwordx4 v3, s[4:7], s22 offen lds
    ds_read_b64_tr_b16 v[238:239], v5 offset:33824
    s_waitcnt lgkmcnt(4)
    v_mfma_f32_16x16x32_bf16 v[80:83], v[228:231], v[112:115], v[80:83]
    ds_read_b64_tr_b16 v[240:241], v4 offset:33024
    v_mfma_f32_16x16x32_bf16 v[84:87], v[228:231], v[116:119], v[84:87]
    ds_read_b64_tr_b16 v[242:243], v4 offset:34048
    s_waitcnt vmcnt(14) lgkmcnt(4)
    v_mfma_f32_16x16x32_bf16 v[24:27], v[232:235], v[120:123], v[24:27]
    ds_read_b64_tr_b16 v[244:245], v5 offset:33056
    s_waitcnt vmcnt(13)
    v_mfma_f32_16x16x32_bf16 v[28:31], v[232:235], v[124:127], v[28:31]
    ds_read_b64_tr_b16 v[246:247], v5 offset:34080
    s_waitcnt lgkmcnt(4)
    v_mfma_f32_16x16x32_bf16 v[32:35], v[236:239], v[120:123], v[32:35]
    ds_read_b64_tr_b16 v[224:225], v4 offset:33280
    v_mfma_f32_16x16x32_bf16 v[36:39], v[236:239], v[124:127], v[36:39]
    ds_read_b64_tr_b16 v[226:227], v4 offset:34304
    s_mov_b32 s23, 0x2800
    buffer_load_dwordx4 v[104:107], v7, s[8:11], s23 offen offset:0 sc1
    s_waitcnt lgkmcnt(4)
    v_mfma_f32_16x16x32_bf16 v[40:43], v[240:243], v[120:123], v[40:43]
    ds_read_b64_tr_b16 v[228:229], v5 offset:33312
    v_mfma_f32_16x16x32_bf16 v[44:47], v[240:243], v[124:127], v[44:47]
    s_add_u32 s22, s19, 0x208000
    s_add_u32 m0, s20, 0x400
    s_nop 0
    buffer_load_dwordx4 v3, s[4:7], s22 offen lds
    ds_read_b64_tr_b16 v[230:231], v5 offset:34336
    s_waitcnt lgkmcnt(4)
    v_mfma_f32_16x16x32_bf16 v[48:51], v[244:247], v[120:123], v[48:51]
    ds_read_b64_tr_b16 v[232:233], v4 offset:33536
    v_mfma_f32_16x16x32_bf16 v[52:55], v[244:247], v[124:127], v[52:55]
    ds_read_b64_tr_b16 v[234:235], v4 offset:34560
    s_waitcnt lgkmcnt(4)
    v_mfma_f32_16x16x32_bf16 v[56:59], v[224:227], v[120:123], v[56:59]
    ds_read_b64_tr_b16 v[236:237], v5 offset:33568
    v_mfma_f32_16x16x32_bf16 v[60:63], v[224:227], v[124:127], v[60:63]
    ds_read_b64_tr_b16 v[238:239], v5 offset:34592
    s_waitcnt lgkmcnt(4)
    v_mfma_f32_16x16x32_bf16 v[64:67], v[228:231], v[120:123], v[64:67]
    ds_read_b64_tr_b16 v[240:241], v4 offset:40960
    v_mfma_f32_16x16x32_bf16 v[68:71], v[228:231], v[124:127], v[68:71]
    ds_read_b64_tr_b16 v[242:243], v4 offset:41984
    s_mov_b32 s23, 0xa800
    buffer_load_dwordx4 v[108:111], v7, s[8:11], s23 offen offset:0 sc1
    s_waitcnt lgkmcnt(4)
    v_mfma_f32_16x16x32_bf16 v[72:75], v[232:235], v[120:123], v[72:75]
    ds_read_b64_tr_b16 v[244:245], v5 offset:40992
    v_mfma_f32_16x16x32_bf16 v[76:79], v[232:235], v[124:127], v[76:79]
    ds_read_b64_tr_b16 v[246:247], v5 offset:42016
    s_waitcnt lgkmcnt(4)
    v_mfma_f32_16x16x32_bf16 v[80:83], v[236:239], v[120:123], v[80:83]
    ds_read_b64_tr_b16 v[224:225], v4 offset:41216
    v_mfma_f32_16x16x32_bf16 v[84:87], v[236:239], v[124:127], v[84:87]
    ds_read_b64_tr_b16 v[226:227], v4 offset:42240
    s_waitcnt vmcnt(15) lgkmcnt(4)
    v_mfma_f32_16x16x32_bf16 v[24:27], v[240:243], v[128:131], v[24:27]
    ds_read_b64_tr_b16 v[228:229], v5 offset:41248
    s_waitcnt vmcnt(14)
    v_mfma_f32_16x16x32_bf16 v[28:31], v[240:243], v[132:135], v[28:31]
    ds_read_b64_tr_b16 v[230:231], v5 offset:42272
    s_waitcnt lgkmcnt(4)
    v_mfma_f32_16x16x32_bf16 v[32:35], v[244:247], v[128:131], v[32:35]
    ds_read_b64_tr_b16 v[232:233], v4 offset:41472
    v_mfma_f32_16x16x32_bf16 v[36:39], v[244:247], v[132:135], v[36:39]
    ds_read_b64_tr_b16 v[234:235], v4 offset:42496
    s_mov_b32 s23, 0x2800
    buffer_load_dwordx4 v[112:115], v7, s[8:11], s23 offen offset:1024 sc1
    s_waitcnt lgkmcnt(4)
    v_mfma_f32_16x16x32_bf16 v[40:43], v[224:227], v[128:131], v[40:43]
    ds_read_b64_tr_b16 v[236:237], v5 offset:41504
    v_mfma_f32_16x16x32_bf16 v[44:47], v[224:227], v[132:135], v[44:47]
    ds_read_b64_tr_b16 v[238:239], v5 offset:42528
    s_waitcnt lgkmcnt(4)
    v_mfma_f32_16x16x32_bf16 v[48:51], v[228:231], v[128:131], v[48:51]
    ds_read_b64_tr_b16 v[240:241], v4 offset:41728
    v_mfma_f32_16x16x32_bf16 v[52:55], v[228:231], v[132:135], v[52:55]
    ds_read_b64_tr_b16 v[242:243], v4 offset:42752
    s_waitcnt lgkmcnt(4)
    v_mfma_f32_16x16x32_bf16 v[56:59], v[232:235], v[128:131], v[56:59]
    ds_read_b64_tr_b16 v[244:245], v5 offset:41760
    v_mfma_f32_16x16x32_bf16 v[60:63], v[232:235], v[132:135], v[60:63]
    ds_read_b64_tr_b16 v[246:247], v5 offset:42784
    s_waitcnt lgkmcnt(4)
    v_mfma_f32_16x16x32_bf16 v[64:67], v[236:239], v[128:131], v[64:67]
    v_mfma_f32_16x16x32_bf16 v[68:71], v[236:239], v[132:135], v[68:71]
    s_waitcnt vmcnt(8)
    s_barrier
    ds_read_b64_tr_b16 v[224:225], v4 offset:49152
    ds_read_b64_tr_b16 v[226:227], v4 offset:50176
    s_mov_b32 s23, 0xa800
    buffer_load_dwordx4 v[116:119], v7, s[8:11], s23 offen offset:1024 sc1
    s_waitcnt lgkmcnt(4)
    v_mfma_f32_16x16x32_bf16 v[72:75], v[240:243], v[128:131], v[72:75]
    ds_read_b64_tr_b16 v[228:229], v5 offset:49184
    v_mfma_f32_16x16x32_bf16 v[76:79], v[240:243], v[132:135], v[76:79]
    s_add_u32 s22, s19, 0x280000
    s_add_u32 m0, s20, 0x4000
    s_nop 0
    buffer_load_dwordx4 v3, s[4:7], s22 offen lds
    ds_read_b64_tr_b16 v[230:231], v5 offset:50208
    s_waitcnt lgkmcnt(4)
    v_mfma_f32_16x16x32_bf16 v[80:83], v[244:247], v[128:131], v[80:83]
    ds_read_b64_tr_b16 v[232:233], v4 offset:49408
    v_mfma_f32_16x16x32_bf16 v[84:87], v[244:247], v[132:135], v[84:87]
    ds_read_b64_tr_b16 v[234:235], v4 offset:50432
    s_waitcnt lgkmcnt(4)
    v_mfma_f32_16x16x32_bf16 v[24:27], v[224:227], v[136:139], v[24:27]
    ds_read_b64_tr_b16 v[236:237], v5 offset:49440
    v_mfma_f32_16x16x32_bf16 v[28:31], v[224:227], v[140:143], v[28:31]
    ds_read_b64_tr_b16 v[238:239], v5 offset:50464
    s_waitcnt lgkmcnt(4)
    v_mfma_f32_16x16x32_bf16 v[32:35], v[228:231], v[136:139], v[32:35]
    ds_read_b64_tr_b16 v[240:241], v4 offset:49664
    v_mfma_f32_16x16x32_bf16 v[36:39], v[228:231], v[140:143], v[36:39]
    ds_read_b64_tr_b16 v[242:243], v4 offset:50688
    s_mov_b32 s23, 0x3000
    buffer_load_dwordx4 v[120:123], v7, s[8:11], s23 offen offset:0 sc1
    s_waitcnt lgkmcnt(4)
    v_mfma_f32_16x16x32_bf16 v[40:43], v[232:235], v[136:139], v[40:43]
    ds_read_b64_tr_b16 v[244:245], v5 offset:49696
    v_mfma_f32_16x16x32_bf16 v[44:47], v[232:235], v[140:143], v[44:47]
    s_add_u32 s22, s19, 0x288000
    s_add_u32 m0, s20, 0x4400
    s_nop 0
    buffer_load_dwordx4 v3, s[4:7], s22 offen lds
    ds_read_b64_tr_b16 v[246:247], v5 offset:50720
    s_waitcnt lgkmcnt(4)
    v_mfma_f32_16x16x32_bf16 v[48:51], v[236:239], v[136:139], v[48:51]
    ds_read_b64_tr_b16 v[224:225], v4 offset:49920
    v_mfma_f32_16x16x32_bf16 v[52:55], v[236:239], v[140:143], v[52:55]
    ds_read_b64_tr_b16 v[226:227], v4 offset:50944
    s_waitcnt lgkmcnt(4)
    v_mfma_f32_16x16x32_bf16 v[56:59], v[240:243], v[136:139], v[56:59]
    ds_read_b64_tr_b16 v[228:229], v5 offset:49952
    v_mfma_f32_16x16x32_bf16 v[60:63], v[240:243], v[140:143], v[60:63]
    ds_read_b64_tr_b16 v[230:231], v5 offset:50976
    s_waitcnt lgkmcnt(4)
    v_mfma_f32_16x16x32_bf16 v[64:67], v[244:247], v[136:139], v[64:67]
    ds_read_b64_tr_b16 v[232:233], v4 offset:57344
    v_mfma_f32_16x16x32_bf16 v[68:71], v[244:247], v[140:143], v[68:71]
    ds_read_b64_tr_b16 v[234:235], v4 offset:58368
    s_mov_b32 s23, 0xb000
    buffer_load_dwordx4 v[124:127], v7, s[8:11], s23 offen offset:0 sc1
    s_waitcnt lgkmcnt(4)
    v_mfma_f32_16x16x32_bf16 v[72:75], v[224:227], v[136:139], v[72:75]
    ds_read_b64_tr_b16 v[236:237], v5 offset:57376
    v_mfma_f32_16x16x32_bf16 v[76:79], v[224:227], v[140:143], v[76:79]
    ds_read_b64_tr_b16 v[238:239], v5 offset:58400
    s_waitcnt lgkmcnt(4)
    v_mfma_f32_16x16x32_bf16 v[80:83], v[228:231], v[136:139], v[80:83]
    ds_read_b64_tr_b16 v[240:241], v4 offset:57600
    v_mfma_f32_16x16x32_bf16 v[84:87], v[228:231], v[140:143], v[84:87]
    ds_read_b64_tr_b16 v[242:243], v4 offset:58624
    s_waitcnt lgkmcnt(4)
    v_mfma_f32_16x16x32_bf16 v[24:27], v[232:235], v[144:147], v[24:27]
    ds_read_b64_tr_b16 v[244:245], v5 offset:57632
    v_mfma_f32_16x16x32_bf16 v[28:31], v[232:235], v[148:151], v[28:31]
    ds_read_b64_tr_b16 v[246:247], v5 offset:58656
    s_waitcnt lgkmcnt(4)
    v_mfma_f32_16x16x32_bf16 v[32:35], v[236:239], v[144:147], v[32:35]
    ds_read_b64_tr_b16 v[224:225], v4 offset:57856
    v_mfma_f32_16x16x32_bf16 v[36:39], v[236:239], v[148:151], v[36:39]
    ds_read_b64_tr_b16 v[226:227], v4 offset:58880
    s_mov_b32 s23, 0x3000
    buffer_load_dwordx4 v[128:131], v7, s[8:11], s23 offen offset:1024 sc1
    s_waitcnt lgkmcnt(4)
    v_mfma_f32_16x16x32_bf16 v[40:43], v[240:243], v[144:147], v[40:43]
    ds_read_b64_tr_b16 v[228:229], v5 offset:57888
    v_mfma_f32_16x16x32_bf16 v[44:47], v[240:243], v[148:151], v[44:47]
    ds_read_b64_tr_b16 v[230:231], v5 offset:58912
    s_waitcnt lgkmcnt(4)
    v_mfma_f32_16x16x32_bf16 v[48:51], v[244:247], v[144:147], v[48:51]
    ds_read_b64_tr_b16 v[232:233], v4 offset:58112
    v_mfma_f32_16x16x32_bf16 v[52:55], v[244:247], v[148:151], v[52:55]
    ds_read_b64_tr_b16 v[234:235], v4 offset:59136
    s_waitcnt lgkmcnt(4)
    v_mfma_f32_16x16x32_bf16 v[56:59], v[224:227], v[144:147], v[56:59]
    ds_read_b64_tr_b16 v[236:237], v5 offset:58144
    v_mfma_f32_16x16x32_bf16 v[60:63], v[224:227], v[148:151], v[60:63]
    ds_read_b64_tr_b16 v[238:239], v5 offset:59168
    s_waitcnt lgkmcnt(4)
    v_mfma_f32_16x16x32_bf16 v[64:67], v[228:231], v[144:147], v[64:67]
    v_mfma_f32_16x16x32_bf16 v[68:71], v[228:231], v[148:151], v[68:71]
    s_waitcnt vmcnt(8)
    s_barrier
    ds_read_b64_tr_b16 v[240:241], v4 offset:0
    ds_read_b64_tr_b16 v[242:243], v4 offset:1024
    s_mov_b32 s23, 0xb000
    buffer_load_dwordx4 v[132:135], v7, s[8:11], s23 offen offset:1024 sc1
    s_waitcnt lgkmcnt(4)
    v_mfma_f32_16x16x32_bf16 v[72:75], v[232:235], v[144:147], v[72:75]
    ds_read_b64_tr_b16 v[244:245], v5 offset:32
    v_mfma_f32_16x16x32_bf16 v[76:79], v[232:235], v[148:151], v[76:79]
    s_add_u32 s22, s19, 0x300000
    s_add_u32 m0, s20, 0x8000
    s_nop 0
    buffer_load_dwordx4 v3, s[4:7], s22 offen lds
    ds_read_b64_tr_b16 v[246:247], v5 offset:1056
    s_waitcnt lgkmcnt(4)
    v_mfma_f32_16x16x32_bf16 v[80:83], v[236:239], v[144:147], v[80:83]
    ds_read_b64_tr_b16 v[224:225], v4 offset:256
    v_mfma_f32_16x16x32_bf16 v[84:87], v[236:239], v[148:151], v[84:87]
    ds_read_b64_tr_b16 v[226:227], v4 offset:1280
    s_waitcnt lgkmcnt(4)
    v_mfma_f32_16x16x32_bf16 v[24:27], v[240:243], v[88:91], v[24:27]
    ds_read_b64_tr_b16 v[228:229], v5 offset:288
    v_mfma_f32_16x16x32_bf16 v[28:31], v[240:243], v[92:95], v[28:31]
    ds_read_b64_tr_b16 v[230:231], v5 offset:1312
    s_waitcnt lgkmcnt(4)
    v_mfma_f32_16x16x32_bf16 v[32:35], v[244:247], v[88:91], v[32:35]
    ds_read_b64_tr_b16 v[232:233], v4 offset:512
    v_mfma_f32_16x16x32_bf16 v[36:39], v[244:247], v[92:95], v[36:39]
    ds_read_b64_tr_b16 v[234:235], v4 offset:1536
    s_mov_b32 s23, 0x3800
    buffer_load_dwordx4 v[136:139], v7, s[8:11], s23 offen offset:0 sc1
    s_waitcnt lgkmcnt(4)
    v_mfma_f32_16x16x32_bf16 v[40:43], v[224:227], v[88:91], v[40:43]
    ds_read_b64_tr_b16 v[236:237], v5 offset:544
    v_mfma_f32_16x16x32_bf16 v[44:47], v[224:227], v[92:95], v[44:47]
    s_add_u32 s22, s19, 0x308000
    s_add_u32 m0, s20, 0x8400
    s_nop 0
    buffer_load_dwordx4 v3, s[4:7], s22 offen lds
    ds_read_b64_tr_b16 v[238:239], v5 offset:1568
    s_waitcnt lgkmcnt(4)
    v_mfma_f32_16x16x32_bf16 v[48:51], v[228:231], v[88:91], v[48:51]
    ds_read_b64_tr_b16 v[240:241], v4 offset:768
    v_mfma_f32_16x16x32_bf16 v[52:55], v[228:231], v[92:95], v[52:55]
    ds_read_b64_tr_b16 v[242:243], v4 offset:1792
    s_waitcnt lgkmcnt(4)
    v_mfma_f32_16x16x32_bf16 v[56:59], v[232:235], v[88:91], v[56:59]
    ds_read_b64_tr_b16 v[244:245], v5 offset:800
    v_mfma_f32_16x16x32_bf16 v[60:63], v[232:235], v[92:95], v[60:63]
    ds_read_b64_tr_b16 v[246:247], v5 offset:1824
    s_waitcnt lgkmcnt(4)
    v_mfma_f32_16x16x32_bf16 v[64:67], v[236:239], v[88:91], v[64:67]
    ds_read_b64_tr_b16 v[224:225], v4 offset:8192
    v_mfma_f32_16x16x32_bf16 v[68:71], v[236:239], v[92:95], v[68:71]
    ds_read_b64_tr_b16 v[226:227], v4 offset:9216
    s_mov_b32 s23, 0xb800
    buffer_load_dwordx4 v[140:143], v7, s[8:11], s23 offen offset:0 sc1
    s_waitcnt lgkmcnt(4)
    v_mfma_f32_16x16x32_bf16 v[72:75], v[240:243], v[88:91], v[72:75]
    ds_read_b64_tr_b16 v[228:229], v5 offset:8224
    v_mfma_f32_16x16x32_bf16 v[76:79], v[240:243], v[92:95], v[76:79]
    ds_read_b64_tr_b16 v[230:231], v5 offset:9248
    s_waitcnt lgkmcnt(4)
    v_mfma_f32_16x16x32_bf16 v[80:83], v[244:247], v[88:91], v[80:83]
    ds_read_b64_tr_b16 v[232:233], v4 offset:8448
    v_mfma_f32_16x16x32_bf16 v[84:87], v[244:247], v[92:95], v[84:87]
    ds_read_b64_tr_b16 v[234:235], v4 offset:9472
    s_waitcnt lgkmcnt(4)
    v_mfma_f32_16x16x32_bf16 v[24:27], v[224:227], v[96:99], v[24:27]
    ds_read_b64_tr_b16 v[236:237], v5 offset:8480
    v_mfma_f32_16x16x32_bf16 v[28:31], v[224:227], v[100:103], v[28:31]
    ds_read_b64_tr_b16 v[238:239], v5 offset:9504
    s_waitcnt lgkmcnt(4)
    v_mfma_f32_16x16x32_bf16 v[32:35], v[228:231], v[96:99], v[32:35]
    ds_read_b64_tr_b16 v[240:241], v4 offset:8704
    v_mfma_f32_16x16x32_bf16 v[36:39], v[228:231], v[100:103], v[36:39]
    ds_read_b64_tr_b16 v[242:243], v4 offset:9728
    s_mov_b32 s23, 0x3800
    buffer_load_dwordx4 v[144:147], v7, s[8:11], s23 offen offset:1024 sc1
    s_waitcnt lgkmcnt(4)
    v_mfma_f32_16x16x32_bf16 v[40:43], v[232:235], v[96:99], v[40:43]
    ds_read_b64_tr_b16 v[244:245], v5 offset:8736
    v_mfma_f32_16x16x32_bf16 v[44:47], v[232:235], v[100:103], v[44:47]
    ds_read_b64_tr_b16 v[246:247], v5 offset:9760
    s_waitcnt lgkmcnt(4)
    v_mfma_f32_16x16x32_bf16 v[48:51], v[236:239], v[96:99], v[48:51]
    ds_read_b64_tr_b16 v[224:225], v4 offset:8960
    v_mfma_f32_16x16x32_bf16 v[52:55], v[236:239], v[100:103], v[52:55]
    ds_read_b64_tr_b16 v[226:227], v4 offset:9984
    s_waitcnt lgkmcnt(4)
    v_mfma_f32_16x16x32_bf16 v[56:59], v[240:243], v[96:99], v[56:59]
    ds_read_b64_tr_b16 v[228:229], v5 offset:8992
    v_mfma_f32_16x16x32_bf16 v[60:63], v[240:243], v[100:103], v[60:63]
    ds_read_b64_tr_b16 v[230:231], v5 offset:10016
    s_waitcnt lgkmcnt(4)
    v_mfma_f32_16x16x32_bf16 v[64:67], v[244:247], v[96:99], v[64:67]
    v_mfma_f32_16x16x32_bf16 v[68:71], v[244:247], v[100:103], v[68:71]
    s_waitcnt vmcnt(8)
    s_barrier
    ds_read_b64_tr_b16 v[232:233], v4 offset:16384
    ds_read_b64_tr_b16 v[234:235], v4 offset:17408
    s_mov_b32 s23, 0xb800
    buffer_load_dwordx4 v[148:151], v7, s[8:11], s23 offen offset:1024 sc1
    s_waitcnt lgkmcnt(4)
    v_mfma_f32_16x16x32_bf16 v[72:75], v[224:227], v[96:99], v[72:75]
    ds_read_b64_tr_b16 v[236:237], v5 offset:16416
    v_mfma_f32_16x16x32_bf16 v[76:79], v[224:227], v[100:103], v[76:79]
    s_add_u32 s22, s19, 0x380000
    s_add_u32 m0, s20, 0xc000
    s_nop 0
    buffer_load_dwordx4 v3, s[4:7], s22 offen lds
    ds_read_b64_tr_b16 v[238:239], v5 offset:17440
    s_waitcnt lgkmcnt(4)
    v_mfma_f32_16x16x32_bf16 v[80:83], v[228:231], v[96:99], v[80:83]
    ds_read_b64_tr_b16 v[240:241], v4 offset:16640
    v_mfma_f32_16x16x32_bf16 v[84:87], v[228:231], v[100:103], v[84:87]
    ds_read_b64_tr_b16 v[242:243], v4 offset:17664
    s_waitcnt lgkmcnt(4)
    v_mfma_f32_16x16x32_bf16 v[24:27], v[232:235], v[104:107], v[24:27]
    ds_read_b64_tr_b16 v[244:245], v5 offset:16672
    v_mfma_f32_16x16x32_bf16 v[28:31], v[232:235], v[108:111], v[28:31]
    ds_read_b64_tr_b16 v[246:247], v5 offset:17696
    s_waitcnt lgkmcnt(4)
    v_mfma_f32_16x16x32_bf16 v[32:35], v[236:239], v[104:107], v[32:35]
    ds_read_b64_tr_b16 v[224:225], v4 offset:16896
    v_mfma_f32_16x16x32_bf16 v[36:39], v[236:239], v[108:111], v[36:39]
    ds_read_b64_tr_b16 v[226:227], v4 offset:17920
    s_mov_b32 s23, 0x4000
    buffer_load_dwordx4 v[88:91], v7, s[8:11], s23 offen offset:0 sc1
    s_waitcnt lgkmcnt(4)
    v_mfma_f32_16x16x32_bf16 v[40:43], v[240:243], v[104:107], v[40:43]
    ds_read_b64_tr_b16 v[228:229], v5 offset:16928
    v_mfma_f32_16x16x32_bf16 v[44:47], v[240:243], v[108:111], v[44:47]
    s_add_u32 s22, s19, 0x388000
    s_add_u32 m0, s20, 0xc400
    s_nop 0
    buffer_load_dwordx4 v3, s[4:7], s22 offen lds
    ds_read_b64_tr_b16 v[230:231], v5 offset:17952
    s_waitcnt lgkmcnt(4)
    v_mfma_f32_16x16x32_bf16 v[48:51], v[244:247], v[104:107], v[48:51]
    ds_read_b64_tr_b16 v[232:233], v4 offset:17152
    v_mfma_f32_16x16x32_bf16 v[52:55], v[244:247], v[108:111], v[52:55]
    ds_read_b64_tr_b16 v[234:235], v4 offset:18176
    s_waitcnt lgkmcnt(4)
    v_mfma_f32_16x16x32_bf16 v[56:59], v[224:227], v[104:107], v[56:59]
    ds_read_b64_tr_b16 v[236:237], v5 offset:17184
    v_mfma_f32_16x16x32_bf16 v[60:63], v[224:227], v[108:111], v[60:63]
    ds_read_b64_tr_b16 v[238:239], v5 offset:18208
    s_waitcnt lgkmcnt(4)
    v_mfma_f32_16x16x32_bf16 v[64:67], v[228:231], v[104:107], v[64:67]
    ds_read_b64_tr_b16 v[240:241], v4 offset:24576
    v_mfma_f32_16x16x32_bf16 v[68:71], v[228:231], v[108:111], v[68:71]
    ds_read_b64_tr_b16 v[242:243], v4 offset:25600
    s_mov_b32 s23, 0xc000
    buffer_load_dwordx4 v[92:95], v7, s[8:11], s23 offen offset:0 sc1
    s_waitcnt lgkmcnt(4)
    v_mfma_f32_16x16x32_bf16 v[72:75], v[232:235], v[104:107], v[72:75]
    ds_read_b64_tr_b16 v[244:245], v5 offset:24608
    v_mfma_f32_16x16x32_bf16 v[76:79], v[232:235], v[108:111], v[76:79]
    ds_read_b64_tr_b16 v[246:247], v5 offset:25632
    s_waitcnt lgkmcnt(4)
    v_mfma_f32_16x16x32_bf16 v[80:83], v[236:239], v[104:107], v[80:83]
    ds_read_b64_tr_b16 v[224:225], v4 offset:24832
    v_mfma_f32_16x16x32_bf16 v[84:87], v[236:239], v[108:111], v[84:87]
    ds_read_b64_tr_b16 v[226:227], v4 offset:25856
    s_waitcnt lgkmcnt(4)
    v_mfma_f32_16x16x32_bf16 v[24:27], v[240:243], v[112:115], v[24:27]
    ds_read_b64_tr_b16 v[228:229], v5 offset:24864
    v_mfma_f32_16x16x32_bf16 v[28:31], v[240:243], v[116:119], v[28:31]
    ds_read_b64_tr_b16 v[230:231], v5 offset:25888
    s_waitcnt lgkmcnt(4)
    v_mfma_f32_16x16x32_bf16 v[32:35], v[244:247], v[112:115], v[32:35]
    ds_read_b64_tr_b16 v[232:233], v4 offset:25088
    v_mfma_f32_16x16x32_bf16 v[36:39], v[244:247], v[116:119], v[36:39]
    ds_read_b64_tr_b16 v[234:235], v4 offset:26112
    s_mov_b32 s23, 0x4000
    buffer_load_dwordx4 v[96:99], v7, s[8:11], s23 offen offset:1024 sc1
    s_waitcnt lgkmcnt(4)
    v_mfma_f32_16x16x32_bf16 v[40:43], v[224:227], v[112:115], v[40:43]
    ds_read_b64_tr_b16 v[236:237], v5 offset:25120
    v_mfma_f32_16x16x32_bf16 v[44:47], v[224:227], v[116:119], v[44:47]
    ds_read_b64_tr_b16 v[238:239], v5 offset:26144
    s_waitcnt lgkmcnt(4)
    v_mfma_f32_16x16x32_bf16 v[48:51], v[228:231], v[112:115], v[48:51]
    ds_read_b64_tr_b16 v[240:241], v4 offset:25344
    v_mfma_f32_16x16x32_bf16 v[52:55], v[228:231], v[116:119], v[52:55]
    ds_read_b64_tr_b16 v[242:243], v4 offset:26368
    s_waitcnt lgkmcnt(4)
    v_mfma_f32_16x16x32_bf16 v[56:59], v[232:235], v[112:115], v[56:59]
    ds_read_b64_tr_b16 v[244:245], v5 offset:25376
    v_mfma_f32_16x16x32_bf16 v[60:63], v[232:235], v[116:119], v[60:63]
    ds_read_b64_tr_b16 v[246:247], v5 offset:26400
    s_waitcnt lgkmcnt(4)
    v_mfma_f32_16x16x32_bf16 v[64:67], v[236:239], v[112:115], v[64:67]
    v_mfma_f32_16x16x32_bf16 v[68:71], v[236:239], v[116:119], v[68:71]
    s_waitcnt vmcnt(8)
    s_barrier
    ds_read_b64_tr_b16 v[224:225], v4 offset:32768
    ds_read_b64_tr_b16 v[226:227], v4 offset:33792
    s_mov_b32 s23, 0xc000
    buffer_load_dwordx4 v[100:103], v7, s[8:11], s23 offen offset:1024 sc1
    s_waitcnt lgkmcnt(4)
    v_mfma_f32_16x16x32_bf16 v[72:75], v[240:243], v[112:115], v[72:75]
    ds_read_b64_tr_b16 v[228:229], v5 offset:32800
    v_mfma_f32_16x16x32_bf16 v[76:79], v[240:243], v[116:119], v[76:79]
    s_add_u32 s22, s19, 0x400000
    s_add_u32 m0, s20, 0x0
    s_nop 0
    buffer_load_dwordx4 v3, s[4:7], s22 offen lds
    ds_read_b64_tr_b16 v[230:231], v5 offset:33824
    s_waitcnt lgkmcnt(4)
    v_mfma_f32_16x16x32_bf16 v[80:83], v[244:247], v[112:115], v[80:83]
    ds_read_b64_tr_b16 v[232:233], v4 offset:33024
    v_mfma_f32_16x16x32_bf16 v[84:87], v[244:247], v[116:119], v[84:87]
    ds_read_b64_tr_b16 v[234:235], v4 offset:34048
    s_waitcnt lgkmcnt(4)
    v_mfma_f32_16x16x32_bf16 v[24:27], v[224:227], v[120:123], v[24:27]
    ds_read_b64_tr_b16 v[236:237], v5 offset:33056
    v_mfma_f32_16x16x32_bf16 v[28:31], v[224:227], v[124:127], v[28:31]
    ds_read_b64_tr_b16 v[238:239], v5 offset:34080
    s_waitcnt lgkmcnt(4)
    v_mfma_f32_16x16x32_bf16 v[32:35], v[228:231], v[120:123], v[32:35]
    ds_read_b64_tr_b16 v[240:241], v4 offset:33280
    v_mfma_f32_16x16x32_bf16 v[36:39], v[228:231], v[124:127], v[36:39]
    ds_read_b64_tr_b16 v[242:243], v4 offset:34304
    s_mov_b32 s23, 0x4800
    buffer_load_dwordx4 v[104:107], v7, s[8:11], s23 offen offset:0 sc1
    s_waitcnt lgkmcnt(4)
    v_mfma_f32_16x16x32_bf16 v[40:43], v[232:235], v[120:123], v[40:43]
    ds_read_b64_tr_b16 v[244:245], v5 offset:33312
    v_mfma_f32_16x16x32_bf16 v[44:47], v[232:235], v[124:127], v[44:47]
    s_add_u32 s22, s19, 0x408000
    s_add_u32 m0, s20, 0x400
    s_nop 0
    buffer_load_dwordx4 v3, s[4:7], s22 offen lds
    ds_read_b64_tr_b16 v[246:247], v5 offset:34336
    s_waitcnt lgkmcnt(4)
    v_mfma_f32_16x16x32_bf16 v[48:51], v[236:239], v[120:123], v[48:51]
    ds_read_b64_tr_b16 v[224:225], v4 offset:33536
    v_mfma_f32_16x16x32_bf16 v[52:55], v[236:239], v[124:127], v[52:55]
    ds_read_b64_tr_b16 v[226:227], v4 offset:34560
    s_waitcnt lgkmcnt(4)
    v_mfma_f32_16x16x32_bf16 v[56:59], v[240:243], v[120:123], v[56:59]
    ds_read_b64_tr_b16 v[228:229], v5 offset:33568
    v_mfma_f32_16x16x32_bf16 v[60:63], v[240:243], v[124:127], v[60:63]
    ds_read_b64_tr_b16 v[230:231], v5 offset:34592
    s_waitcnt lgkmcnt(4)
    v_mfma_f32_16x16x32_bf16 v[64:67], v[244:247], v[120:123], v[64:67]
    ds_read_b64_tr_b16 v[232:233], v4 offset:40960
    v_mfma_f32_16x16x32_bf16 v[68:71], v[244:247], v[124:127], v[68:71]
    ds_read_b64_tr_b16 v[234:235], v4 offset:41984
    s_mov_b32 s23, 0xc800
    buffer_load_dwordx4 v[108:111], v7, s[8:11], s23 offen offset:0 sc1
    s_waitcnt lgkmcnt(4)
    v_mfma_f32_16x16x32_bf16 v[72:75], v[224:227], v[120:123], v[72:75]
    ds_read_b64_tr_b16 v[236:237], v5 offset:40992
    v_lshrrev_b32 v21, 4, v1
    v_lshlrev_b32 v21, 9, v21
    v_and_b32 v20, 15, v1
    v_lshl_add_u32 v21, v20, 4, v21
    s_lshr_b32 s18, s12, 3
    s_lshl_b32 s18, s18, 11
    s_add_u32 s18, s18, 0x528100
    buffer_load_dwordx4 v[12:15], v21, s[8:11], s18 offen sc1
    v_mfma_f32_16x16x32_bf16 v[76:79], v[224:227], v[124:127], v[76:79]
    ds_read_b64_tr_b16 v[238:239], v5 offset:42016
    s_waitcnt lgkmcnt(4)
    v_mfma_f32_16x16x32_bf16 v[80:83], v[228:231], v[120:123], v[80:83]
    ds_read_b64_tr_b16 v[240:241], v4 offset:41216
    v_mfma_f32_16x16x32_bf16 v[84:87], v[228:231], v[124:127], v[84:87]
    ds_read_b64_tr_b16 v[242:243], v4 offset:42240
    s_waitcnt lgkmcnt(4)
    v_mfma_f32_16x16x32_bf16 v[24:27], v[232:235], v[128:131], v[24:27]
    ds_read_b64_tr_b16 v[244:245], v5 offset:41248
    v_mfma_f32_16x16x32_bf16 v[28:31], v[232:235], v[132:135], v[28:31]
    ds_read_b64_tr_b16 v[246:247], v5 offset:42272
    s_waitcnt lgkmcnt(4)
    v_mfma_f32_16x16x32_bf16 v[32:35], v[236:239], v[128:131], v[32:35]
    ds_read_b64_tr_b16 v[224:225], v4 offset:41472
    v_mfma_f32_16x16x32_bf16 v[36:39], v[236:239], v[132:135], v[36:39]
    ds_read_b64_tr_b16 v[226:227], v4 offset:42496
    s_mov_b32 s23, 0x4800
    buffer_load_dwordx4 v[112:115], v7, s[8:11], s23 offen offset:1024 sc1
    s_waitcnt lgkmcnt(4)
    v_mfma_f32_16x16x32_bf16 v[40:43], v[240:243], v[128:131], v[40:43]
    ds_read_b64_tr_b16 v[228:229], v5 offset:41504
    v_mfma_f32_16x16x32_bf16 v[44:47], v[240:243], v[132:135], v[44:47]
    ds_read_b64_tr_b16 v[230:231], v5 offset:42528
    s_waitcnt lgkmcnt(4)
    v_mfma_f32_16x16x32_bf16 v[48:51], v[244:247], v[128:131], v[48:51]
    ds_read_b64_tr_b16 v[232:233], v4 offset:41728
    v_mfma_f32_16x16x32_bf16 v[52:55], v[244:247], v[132:135], v[52:55]
    ds_read_b64_tr_b16 v[234:235], v4 offset:42752
    s_waitcnt lgkmcnt(4)
    v_mfma_f32_16x16x32_bf16 v[56:59], v[224:227], v[128:131], v[56:59]
    ds_read_b64_tr_b16 v[236:237], v5 offset:41760
    v_mfma_f32_16x16x32_bf16 v[60:63], v[224:227], v[132:135], v[60:63]
    ds_read_b64_tr_b16 v[238:239], v5 offset:42784
    s_waitcnt lgkmcnt(4)
    v_mfma_f32_16x16x32_bf16 v[64:67], v[228:231], v[128:131], v[64:67]
    v_mfma_f32_16x16x32_bf16 v[68:71], v[228:231], v[132:135], v[68:71]
    s_waitcnt vmcnt(9)
    s_barrier
    ds_read_b64_tr_b16 v[240:241], v4 offset:49152
    ds_read_b64_tr_b16 v[242:243], v4 offset:50176
    s_mov_b32 s23, 0xc800
    buffer_load_dwordx4 v[116:119], v7, s[8:11], s23 offen offset:1024 sc1
    s_waitcnt lgkmcnt(4)
    v_mfma_f32_16x16x32_bf16 v[72:75], v[232:235], v[128:131], v[72:75]
    ds_read_b64_tr_b16 v[244:245], v5 offset:49184
    v_mfma_f32_16x16x32_bf16 v[76:79], v[232:235], v[132:135], v[76:79]
    s_add_u32 s22, s19, 0x480000
    s_add_u32 m0, s20, 0x4000
    s_nop 0
    buffer_load_dwordx4 v3, s[4:7], s22 offen lds
    ds_read_b64_tr_b16 v[246:247], v5 offset:50208
    s_waitcnt lgkmcnt(4)
    v_mfma_f32_16x16x32_bf16 v[80:83], v[236:239], v[128:131], v[80:83]
    ds_read_b64_tr_b16 v[224:225], v4 offset:49408
    v_mfma_f32_16x16x32_bf16 v[84:87], v[236:239], v[132:135], v[84:87]
    ds_read_b64_tr_b16 v[226:227], v4 offset:50432
    s_waitcnt lgkmcnt(4)
    v_mfma_f32_16x16x32_bf16 v[24:27], v[240:243], v[136:139], v[24:27]
    ds_read_b64_tr_b16 v[228:229], v5 offset:49440
    v_mfma_f32_16x16x32_bf16 v[28:31], v[240:243], v[140:143], v[28:31]
    ds_read_b64_tr_b16 v[230:231], v5 offset:50464
    s_waitcnt lgkmcnt(4)
    v_mfma_f32_16x16x32_bf16 v[32:35], v[244:247], v[136:139], v[32:35]
    ds_read_b64_tr_b16 v[232:233], v4 offset:49664
    v_mfma_f32_16x16x32_bf16 v[36:39], v[244:247], v[140:143], v[36:39]
    ds_read_b64_tr_b16 v[234:235], v4 offset:50688
    s_mov_b32 s23, 0x5000
    buffer_load_dwordx4 v[120:123], v7, s[8:11], s23 offen offset:0 sc1
    s_waitcnt lgkmcnt(4)
    v_mfma_f32_16x16x32_bf16 v[40:43], v[224:227], v[136:139], v[40:43]
    ds_read_b64_tr_b16 v[236:237], v5 offset:49696
    v_mfma_f32_16x16x32_bf16 v[44:47], v[224:227], v[140:143], v[44:47]
    s_add_u32 s22, s19, 0x488000
    s_add_u32 m0, s20, 0x4400
    s_nop 0
    buffer_load_dwordx4 v3, s[4:7], s22 offen lds
    ds_read_b64_tr_b16 v[238:239], v5 offset:50720
    s_waitcnt lgkmcnt(4)
    v_mfma_f32_16x16x32_bf16 v[48:51], v[228:231], v[136:139], v[48:51]
    ds_read_b64_tr_b16 v[240:241], v4 offset:49920
    v_mfma_f32_16x16x32_bf16 v[52:55], v[228:231], v[140:143], v[52:55]
    ds_read_b64_tr_b16 v[242:243], v4 offset:50944
    s_waitcnt lgkmcnt(4)
    v_mfma_f32_16x16x32_bf16 v[56:59], v[232:235], v[136:139], v[56:59]
    ds_read_b64_tr_b16 v[244:245], v5 offset:49952
    v_mfma_f32_16x16x32_bf16 v[60:63], v[232:235], v[140:143], v[60:63]
    ds_read_b64_tr_b16 v[246:247], v5 offset:50976
    s_waitcnt lgkmcnt(4)
    v_mfma_f32_16x16x32_bf16 v[64:67], v[236:239], v[136:139], v[64:67]
    ds_read_b64_tr_b16 v[224:225], v4 offset:57344
    v_mfma_f32_16x16x32_bf16 v[68:71], v[236:239], v[140:143], v[68:71]
    ds_read_b64_tr_b16 v[226:227], v4 offset:58368
    s_mov_b32 s23, 0xd000
    buffer_load_dwordx4 v[124:127], v7, s[8:11], s23 offen offset:0 sc1
    s_waitcnt lgkmcnt(4)
    v_mfma_f32_16x16x32_bf16 v[72:75], v[240:243], v[136:139], v[72:75]
    ds_read_b64_tr_b16 v[228:229], v5 offset:57376
    v_mfma_f32_16x16x32_bf16 v[76:79], v[240:243], v[140:143], v[76:79]
    ds_read_b64_tr_b16 v[230:231], v5 offset:58400
    s_waitcnt lgkmcnt(4)
    v_mfma_f32_16x16x32_bf16 v[80:83], v[244:247], v[136:139], v[80:83]
    ds_read_b64_tr_b16 v[232:233], v4 offset:57600
    v_mfma_f32_16x16x32_bf16 v[84:87], v[244:247], v[140:143], v[84:87]
    ds_read_b64_tr_b16 v[234:235], v4 offset:58624
    s_waitcnt lgkmcnt(4)
    v_mfma_f32_16x16x32_bf16 v[24:27], v[224:227], v[144:147], v[24:27]
    ds_read_b64_tr_b16 v[236:237], v5 offset:57632
    v_mfma_f32_16x16x32_bf16 v[28:31], v[224:227], v[148:151], v[28:31]
    ds_read_b64_tr_b16 v[238:239], v5 offset:58656
    s_waitcnt lgkmcnt(4)
    v_mfma_f32_16x16x32_bf16 v[32:35], v[228:231], v[144:147], v[32:35]
    ds_read_b64_tr_b16 v[240:241], v4 offset:57856
    v_mfma_f32_16x16x32_bf16 v[36:39], v[228:231], v[148:151], v[36:39]
    ds_read_b64_tr_b16 v[242:243], v4 offset:58880
    s_mov_b32 s23, 0x5000
    buffer_load_dwordx4 v[128:131], v7, s[8:11], s23 offen offset:1024 sc1
    s_waitcnt lgkmcnt(4)
    v_mfma_f32_16x16x32_bf16 v[40:43], v[232:235], v[144:147], v[40:43]
    ds_read_b64_tr_b16 v[244:245], v5 offset:57888
    v_mfma_f32_16x16x32_bf16 v[44:47], v[232:235], v[148:151], v[44:47]
    ds_read_b64_tr_b16 v[246:247], v5 offset:58912
    s_waitcnt lgkmcnt(4)
    v_mfma_f32_16x16x32_bf16 v[48:51], v[236:239], v[144:147], v[48:51]
    ds_read_b64_tr_b16 v[224:225], v4 offset:58112
    v_mfma_f32_16x16x32_bf16 v[52:55], v[236:239], v[148:151], v[52:55]
    ds_read_b64_tr_b16 v[226:227], v4 offset:59136
    s_waitcnt lgkmcnt(4)
    v_mfma_f32_16x16x32_bf16 v[56:59], v[240:243], v[144:147], v[56:59]
    ds_read_b64_tr_b16 v[228:229], v5 offset:58144
    v_mfma_f32_16x16x32_bf16 v[60:63], v[240:243], v[148:151], v[60:63]
    ds_read_b64_tr_b16 v[230:231], v5 offset:59168
    s_waitcnt lgkmcnt(4)
    v_mfma_f32_16x16x32_bf16 v[64:67], v[244:247], v[144:147], v[64:67]
    v_mfma_f32_16x16x32_bf16 v[68:71], v[244:247], v[148:151], v[68:71]
    s_waitcnt vmcnt(9)
    s_barrier
    ds_read_b64_tr_b16 v[232:233], v4 offset:0
    ds_read_b64_tr_b16 v[234:235], v4 offset:1024
    s_mov_b32 s23, 0xd000
    buffer_load_dwordx4 v[132:135], v7, s[8:11], s23 offen offset:1024 sc1
    s_waitcnt lgkmcnt(4)
    v_mfma_f32_16x16x32_bf16 v[72:75], v[224:227], v[144:147], v[72:75]
    ds_read_b64_tr_b16 v[236:237], v5 offset:32
    v_mfma_f32_16x16x32_bf16 v[76:79], v[224:227], v[148:151], v[76:79]
    s_add_u32 s22, s19, 0x500000
    s_add_u32 m0, s20, 0x8000
    s_nop 0
    buffer_load_dwordx4 v3, s[4:7], s22 offen lds
    ds_read_b64_tr_b16 v[238:239], v5 offset:1056
    s_waitcnt lgkmcnt(4)
    v_mfma_f32_16x16x32_bf16 v[80:83], v[228:231], v[144:147], v[80:83]
    ds_read_b64_tr_b16 v[240:241], v4 offset:256
    v_mfma_f32_16x16x32_bf16 v[84:87], v[228:231], v[148:151], v[84:87]
    ds_read_b64_tr_b16 v[242:243], v4 offset:1280
    s_waitcnt lgkmcnt(4)
    v_mfma_f32_16x16x32_bf16 v[24:27], v[232:235], v[88:91], v[24:27]
    ds_read_b64_tr_b16 v[244:245], v5 offset:288
    v_mfma_f32_16x16x32_bf16 v[28:31], v[232:235], v[92:95], v[28:31]
    ds_read_b64_tr_b16 v[246:247], v5 offset:1312
    s_waitcnt lgkmcnt(4)
    v_mfma_f32_16x16x32_bf16 v[32:35], v[236:239], v[88:91], v[32:35]
    ds_read_b64_tr_b16 v[224:225], v4 offset:512
    v_mfma_f32_16x16x32_bf16 v[36:39], v[236:239], v[92:95], v[36:39]
    ds_read_b64_tr_b16 v[226:227], v4 offset:1536
    s_mov_b32 s23, 0x5800
    buffer_load_dwordx4 v[136:139], v7, s[8:11], s23 offen offset:0 sc1
    s_waitcnt lgkmcnt(4)
    v_mfma_f32_16x16x32_bf16 v[40:43], v[240:243], v[88:91], v[40:43]
    ds_read_b64_tr_b16 v[228:229], v5 offset:544
    v_mfma_f32_16x16x32_bf16 v[44:47], v[240:243], v[92:95], v[44:47]
    s_add_u32 s22, s19, 0x508000
    s_add_u32 m0, s20, 0x8400
    s_nop 0
    buffer_load_dwordx4 v3, s[4:7], s22 offen lds
    ds_read_b64_tr_b16 v[230:231], v5 offset:1568
    s_waitcnt lgkmcnt(4)
    v_mfma_f32_16x16x32_bf16 v[48:51], v[244:247], v[88:91], v[48:51]
    ds_read_b64_tr_b16 v[232:233], v4 offset:768
    v_mfma_f32_16x16x32_bf16 v[52:55], v[244:247], v[92:95], v[52:55]
    ds_read_b64_tr_b16 v[234:235], v4 offset:1792
    s_waitcnt lgkmcnt(4)
    v_mfma_f32_16x16x32_bf16 v[56:59], v[224:227], v[88:91], v[56:59]
    ds_read_b64_tr_b16 v[236:237], v5 offset:800
    v_mfma_f32_16x16x32_bf16 v[60:63], v[224:227], v[92:95], v[60:63]
    ds_read_b64_tr_b16 v[238:239], v5 offset:1824
    s_waitcnt lgkmcnt(4)
    v_mfma_f32_16x16x32_bf16 v[64:67], v[228:231], v[88:91], v[64:67]
    ds_read_b64_tr_b16 v[240:241], v4 offset:8192
    v_mfma_f32_16x16x32_bf16 v[68:71], v[228:231], v[92:95], v[68:71]
    ds_read_b64_tr_b16 v[242:243], v4 offset:9216
    s_mov_b32 s23, 0xd800
    buffer_load_dwordx4 v[140:143], v7, s[8:11], s23 offen offset:0 sc1
    s_waitcnt lgkmcnt(4)
    v_mfma_f32_16x16x32_bf16 v[72:75], v[232:235], v[88:91], v[72:75]
    ds_read_b64_tr_b16 v[244:245], v5 offset:8224
    v_mfma_f32_16x16x32_bf16 v[76:79], v[232:235], v[92:95], v[76:79]
    ds_read_b64_tr_b16 v[246:247], v5 offset:9248
    s_waitcnt lgkmcnt(4)
    v_mfma_f32_16x16x32_bf16 v[80:83], v[236:239], v[88:91], v[80:83]
    ds_read_b64_tr_b16 v[224:225], v4 offset:8448
    v_mfma_f32_16x16x32_bf16 v[84:87], v[236:239], v[92:95], v[84:87]
    ds_read_b64_tr_b16 v[226:227], v4 offset:9472
    s_waitcnt lgkmcnt(4)
    v_mfma_f32_16x16x32_bf16 v[24:27], v[240:243], v[96:99], v[24:27]
    ds_read_b64_tr_b16 v[228:229], v5 offset:8480
    v_mfma_f32_16x16x32_bf16 v[28:31], v[240:243], v[100:103], v[28:31]
    ds_read_b64_tr_b16 v[230:231], v5 offset:9504
    s_waitcnt lgkmcnt(4)
    v_mfma_f32_16x16x32_bf16 v[32:35], v[244:247], v[96:99], v[32:35]
    ds_read_b64_tr_b16 v[232:233], v4 offset:8704
    v_mfma_f32_16x16x32_bf16 v[36:39], v[244:247], v[100:103], v[36:39]
    ds_read_b64_tr_b16 v[234:235], v4 offset:9728
    s_mov_b32 s23, 0x5800
    buffer_load_dwordx4 v[144:147], v7, s[8:11], s23 offen offset:1024 sc1
    s_waitcnt lgkmcnt(4)
    v_mfma_f32_16x16x32_bf16 v[40:43], v[224:227], v[96:99], v[40:43]
    ds_read_b64_tr_b16 v[236:237], v5 offset:8736
    v_mfma_f32_16x16x32_bf16 v[44:47], v[224:227], v[100:103], v[44:47]
    ds_read_b64_tr_b16 v[238:239], v5 offset:9760
    s_waitcnt lgkmcnt(4)
    v_mfma_f32_16x16x32_bf16 v[48:51], v[228:231], v[96:99], v[48:51]
    ds_read_b64_tr_b16 v[240:241], v4 offset:8960
    v_mfma_f32_16x16x32_bf16 v[52:55], v[228:231], v[100:103], v[52:55]
    ds_read_b64_tr_b16 v[242:243], v4 offset:9984
    s_waitcnt lgkmcnt(4)
    v_mfma_f32_16x16x32_bf16 v[56:59], v[232:235], v[96:99], v[56:59]
    ds_read_b64_tr_b16 v[244:245], v5 offset:8992
    v_mfma_f32_16x16x32_bf16 v[60:63], v[232:235], v[100:103], v[60:63]
    ds_read_b64_tr_b16 v[246:247], v5 offset:10016
    s_waitcnt lgkmcnt(4)
    v_mfma_f32_16x16x32_bf16 v[64:67], v[236:239], v[96:99], v[64:67]
    v_mfma_f32_16x16x32_bf16 v[68:71], v[236:239], v[100:103], v[68:71]
    s_waitcnt vmcnt(8)
    s_barrier
    ds_read_b64_tr_b16 v[224:225], v4 offset:16384
    ds_read_b64_tr_b16 v[226:227], v4 offset:17408
    s_mov_b32 s23, 0xd800
    buffer_load_dwordx4 v[148:151], v7, s[8:11], s23 offen offset:1024 sc1
    s_waitcnt lgkmcnt(4)
    v_mfma_f32_16x16x32_bf16 v[72:75], v[240:243], v[96:99], v[72:75]
    ds_read_b64_tr_b16 v[228:229], v5 offset:16416
    v_mfma_f32_16x16x32_bf16 v[76:79], v[240:243], v[100:103], v[76:79]
    s_add_u32 s22, s19, 0x580000
    s_add_u32 m0, s20, 0xc000
    s_nop 0
    buffer_load_dwordx4 v3, s[4:7], s22 offen lds
    ds_read_b64_tr_b16 v[230:231], v5 offset:17440
    s_waitcnt lgkmcnt(4)
    v_mfma_f32_16x16x32_bf16 v[80:83], v[244:247], v[96:99], v[80:83]
    ds_read_b64_tr_b16 v[232:233], v4 offset:16640
    v_mfma_f32_16x16x32_bf16 v[84:87], v[244:247], v[100:103], v[84:87]
    ds_read_b64_tr_b16 v[234:235], v4 offset:17664
    s_waitcnt lgkmcnt(4)
    v_mfma_f32_16x16x32_bf16 v[24:27], v[224:227], v[104:107], v[24:27]
    ds_read_b64_tr_b16 v[236:237], v5 offset:16672
    v_mfma_f32_16x16x32_bf16 v[28:31], v[224:227], v[108:111], v[28:31]
    ds_read_b64_tr_b16 v[238:239], v5 offset:17696
    s_waitcnt lgkmcnt(4)
    v_mfma_f32_16x16x32_bf16 v[32:35], v[228:231], v[104:107], v[32:35]
    ds_read_b64_tr_b16 v[240:241], v4 offset:16896
    v_mfma_f32_16x16x32_bf16 v[36:39], v[228:231], v[108:111], v[36:39]
    ds_read_b64_tr_b16 v[242:243], v4 offset:17920
    s_mov_b32 s23, 0x6000
    buffer_load_dwordx4 v[88:91], v7, s[8:11], s23 offen offset:0 sc1
    s_waitcnt lgkmcnt(4)
    v_mfma_f32_16x16x32_bf16 v[40:43], v[232:235], v[104:107], v[40:43]
    ds_read_b64_tr_b16 v[244:245], v5 offset:16928
    v_mfma_f32_16x16x32_bf16 v[44:47], v[232:235], v[108:111], v[44:47]
    s_add_u32 s22, s19, 0x588000
    s_add_u32 m0, s20, 0xc400
    s_nop 0
    buffer_load_dwordx4 v3, s[4:7], s22 offen lds
    ds_read_b64_tr_b16 v[246:247], v5 offset:17952
    s_waitcnt lgkmcnt(4)
    v_mfma_f32_16x16x32_bf16 v[48:51], v[236:239], v[104:107], v[48:51]
    ds_read_b64_tr_b16 v[224:225], v4 offset:17152
    v_mfma_f32_16x16x32_bf16 v[52:55], v[236:239], v[108:111], v[52:55]
    ds_read_b64_tr_b16 v[226:227], v4 offset:18176
    s_waitcnt lgkmcnt(4)
    v_mfma_f32_16x16x32_bf16 v[56:59], v[240:243], v[104:107], v[56:59]
    ds_read_b64_tr_b16 v[228:229], v5 offset:17184
    v_mfma_f32_16x16x32_bf16 v[60:63], v[240:243], v[108:111], v[60:63]
    ds_read_b64_tr_b16 v[230:231], v5 offset:18208
    s_waitcnt lgkmcnt(4)
    v_mfma_f32_16x16x32_bf16 v[64:67], v[244:247], v[104:107], v[64:67]
    ds_read_b64_tr_b16 v[232:233], v4 offset:24576
    v_mfma_f32_16x16x32_bf16 v[68:71], v[244:247], v[108:111], v[68:71]
    ds_read_b64_tr_b16 v[234:235], v4 offset:25600
    s_mov_b32 s23, 0xe000
    buffer_load_dwordx4 v[92:95], v7, s[8:11], s23 offen offset:0 sc1
    s_waitcnt lgkmcnt(4)
    v_mfma_f32_16x16x32_bf16 v[72:75], v[224:227], v[104:107], v[72:75]
    ds_read_b64_tr_b16 v[236:237], v5 offset:24608
    v_xor_b32 v8, s28, v12
    v_xor_b32 v20, s28, v13
    v_or_b32 v8, v8, v20
    v_xor_b32 v20, s28, v14
    v_or_b32 v8, v8, v20
    v_xor_b32 v20, s28, v15
    v_or_b32 v8, v8, v20
    v_cmp_ne_u32 vcc, 0, v8
    s_cbranch_vccnz adaLN_cond__sliding_block_cached__moe_arch_mod__prompt_kernel_kv16r
adaLN_cond__sliding_block_cached__moe_arch_mod__prompt_kernel_kv16b:
    v_mfma_f32_16x16x32_bf16 v[76:79], v[224:227], v[108:111], v[76:79]
    ds_read_b64_tr_b16 v[238:239], v5 offset:25632
    v_mov_b32 v20, 0
    s_mov_b32 s16, 0x564000
    buffer_load_dword v8, v20, s[8:11], s16 offen sc1
    s_waitcnt lgkmcnt(4)
    v_mfma_f32_16x16x32_bf16 v[80:83], v[228:231], v[104:107], v[80:83]
    ds_read_b64_tr_b16 v[240:241], v4 offset:24832
    v_mfma_f32_16x16x32_bf16 v[84:87], v[228:231], v[108:111], v[84:87]
    ds_read_b64_tr_b16 v[242:243], v4 offset:25856
    s_waitcnt lgkmcnt(4)
    v_mfma_f32_16x16x32_bf16 v[24:27], v[232:235], v[112:115], v[24:27]
    ds_read_b64_tr_b16 v[244:245], v5 offset:24864
    v_mfma_f32_16x16x32_bf16 v[28:31], v[232:235], v[116:119], v[28:31]
    ds_read_b64_tr_b16 v[246:247], v5 offset:25888
    s_waitcnt lgkmcnt(4)
    v_mfma_f32_16x16x32_bf16 v[32:35], v[236:239], v[112:115], v[32:35]
    ds_read_b64_tr_b16 v[224:225], v4 offset:25088
    v_mfma_f32_16x16x32_bf16 v[36:39], v[236:239], v[116:119], v[36:39]
    ds_read_b64_tr_b16 v[226:227], v4 offset:26112
    s_mov_b32 s23, 0x6000
    buffer_load_dwordx4 v[96:99], v7, s[8:11], s23 offen offset:1024 sc1
    s_waitcnt lgkmcnt(4)
    v_mfma_f32_16x16x32_bf16 v[40:43], v[240:243], v[112:115], v[40:43]
    ds_read_b64_tr_b16 v[228:229], v5 offset:25120
    v_mfma_f32_16x16x32_bf16 v[44:47], v[240:243], v[116:119], v[44:47]
    ds_read_b64_tr_b16 v[230:231], v5 offset:26144
    s_waitcnt lgkmcnt(4)
    v_mfma_f32_16x16x32_bf16 v[48:51], v[244:247], v[112:115], v[48:51]
    ds_read_b64_tr_b16 v[232:233], v4 offset:25344
    v_mfma_f32_16x16x32_bf16 v[52:55], v[244:247], v[116:119], v[52:55]
    ds_read_b64_tr_b16 v[234:235], v4 offset:26368
    s_waitcnt lgkmcnt(4)
    v_mfma_f32_16x16x32_bf16 v[56:59], v[224:227], v[112:115], v[56:59]
    ds_read_b64_tr_b16 v[236:237], v5 offset:25376
    v_mfma_f32_16x16x32_bf16 v[60:63], v[224:227], v[116:119], v[60:63]
    ds_read_b64_tr_b16 v[238:239], v5 offset:26400
    s_waitcnt lgkmcnt(4)
    v_mfma_f32_16x16x32_bf16 v[64:67], v[228:231], v[112:115], v[64:67]
    v_mfma_f32_16x16x32_bf16 v[68:71], v[228:231], v[116:119], v[68:71]
    s_waitcnt vmcnt(9)
    s_barrier
    ds_read_b64_tr_b16 v[240:241], v4 offset:32768
    ds_read_b64_tr_b16 v[242:243], v4 offset:33792
    s_mov_b32 s23, 0xe000
    buffer_load_dwordx4 v[100:103], v7, s[8:11], s23 offen offset:1024 sc1
    s_waitcnt lgkmcnt(4)
    v_mfma_f32_16x16x32_bf16 v[72:75], v[232:235], v[112:115], v[72:75]
    ds_read_b64_tr_b16 v[244:245], v5 offset:32800
    v_mfma_f32_16x16x32_bf16 v[76:79], v[232:235], v[116:119], v[76:79]
    s_add_u32 s22, s19, 0x600000
    s_add_u32 m0, s20, 0x0
    s_nop 0
    buffer_load_dwordx4 v3, s[4:7], s22 offen lds
    ds_read_b64_tr_b16 v[246:247], v5 offset:33824
    s_waitcnt lgkmcnt(4)
    v_mfma_f32_16x16x32_bf16 v[80:83], v[236:239], v[112:115], v[80:83]
    ds_read_b64_tr_b16 v[224:225], v4 offset:33024
    v_mfma_f32_16x16x32_bf16 v[84:87], v[236:239], v[116:119], v[84:87]
    ds_read_b64_tr_b16 v[226:227], v4 offset:34048
    s_waitcnt lgkmcnt(4)
    v_mfma_f32_16x16x32_bf16 v[24:27], v[240:243], v[120:123], v[24:27]
    ds_read_b64_tr_b16 v[228:229], v5 offset:33056
    v_mfma_f32_16x16x32_bf16 v[28:31], v[240:243], v[124:127], v[28:31]
    ds_read_b64_tr_b16 v[230:231], v5 offset:34080
    s_waitcnt lgkmcnt(4)
    v_mfma_f32_16x16x32_bf16 v[32:35], v[244:247], v[120:123], v[32:35]
    ds_read_b64_tr_b16 v[232:233], v4 offset:33280
    v_mfma_f32_16x16x32_bf16 v[36:39], v[244:247], v[124:127], v[36:39]
    ds_read_b64_tr_b16 v[234:235], v4 offset:34304
    s_mov_b32 s23, 0x6800
    buffer_load_dwordx4 v[104:107], v7, s[8:11], s23 offen offset:0 sc1
    s_waitcnt lgkmcnt(4)
    v_mfma_f32_16x16x32_bf16 v[40:43], v[224:227], v[120:123], v[40:43]
    ds_read_b64_tr_b16 v[236:237], v5 offset:33312
    v_mfma_f32_16x16x32_bf16 v[44:47], v[224:227], v[124:127], v[44:47]
    s_add_u32 s22, s19, 0x608000
    s_add_u32 m0, s20, 0x400
    s_nop 0
    buffer_load_dwordx4 v3, s[4:7], s22 offen lds
    ds_read_b64_tr_b16 v[238:239], v5 offset:34336
    s_waitcnt lgkmcnt(4)
    v_mfma_f32_16x16x32_bf16 v[48:51], v[228:231], v[120:123], v[48:51]
    ds_read_b64_tr_b16 v[240:241], v4 offset:33536
    v_mfma_f32_16x16x32_bf16 v[52:55], v[228:231], v[124:127], v[52:55]
    ds_read_b64_tr_b16 v[242:243], v4 offset:34560
    s_waitcnt lgkmcnt(4)
    v_mfma_f32_16x16x32_bf16 v[56:59], v[232:235], v[120:123], v[56:59]
    ds_read_b64_tr_b16 v[244:245], v5 offset:33568
    v_mfma_f32_16x16x32_bf16 v[60:63], v[232:235], v[124:127], v[60:63]
    ds_read_b64_tr_b16 v[246:247], v5 offset:34592
    s_waitcnt lgkmcnt(4)
    v_mfma_f32_16x16x32_bf16 v[64:67], v[236:239], v[120:123], v[64:67]
    ds_read_b64_tr_b16 v[224:225], v4 offset:40960
    v_mfma_f32_16x16x32_bf16 v[68:71], v[236:239], v[124:127], v[68:71]
    ds_read_b64_tr_b16 v[226:227], v4 offset:41984
    s_mov_b32 s23, 0xe800
    buffer_load_dwordx4 v[108:111], v7, s[8:11], s23 offen offset:0 sc1
    s_waitcnt lgkmcnt(4)
    v_mfma_f32_16x16x32_bf16 v[72:75], v[240:243], v[120:123], v[72:75]
    ds_read_b64_tr_b16 v[228:229], v5 offset:40992
    v_mfma_f32_16x16x32_bf16 v[76:79], v[240:243], v[124:127], v[76:79]
    ds_read_b64_tr_b16 v[230:231], v5 offset:42016
    s_waitcnt lgkmcnt(4)
    v_mfma_f32_16x16x32_bf16 v[80:83], v[244:247], v[120:123], v[80:83]
    ds_read_b64_tr_b16 v[232:233], v4 offset:41216
    v_mfma_f32_16x16x32_bf16 v[84:87], v[244:247], v[124:127], v[84:87]
    ds_read_b64_tr_b16 v[234:235], v4 offset:42240
    s_waitcnt lgkmcnt(4)
    v_mfma_f32_16x16x32_bf16 v[24:27], v[224:227], v[128:131], v[24:27]
    ds_read_b64_tr_b16 v[236:237], v5 offset:41248
    s_add_u32 s22, s21, 0x0
    s_add_u32 m0, s20, 0x10000
    s_nop 0
    buffer_load_dwordx4 v2, s[8:11], s22 offen sc1 lds
    v_mfma_f32_16x16x32_bf16 v[28:31], v[224:227], v[132:135], v[28:31]
    ds_read_b64_tr_b16 v[238:239], v5 offset:42272
    s_waitcnt lgkmcnt(4)
    v_mfma_f32_16x16x32_bf16 v[32:35], v[228:231], v[128:131], v[32:35]
    ds_read_b64_tr_b16 v[240:241], v4 offset:41472
    v_mfma_f32_16x16x32_bf16 v[36:39], v[228:231], v[132:135], v[36:39]
    ds_read_b64_tr_b16 v[242:243], v4 offset:42496
    s_mov_b32 s23, 0x6800
    buffer_load_dwordx4 v[112:115], v7, s[8:11], s23 offen offset:1024 sc1
    s_waitcnt lgkmcnt(4)
    v_mfma_f32_16x16x32_bf16 v[40:43], v[232:235], v[128:131], v[40:43]
    ds_read_b64_tr_b16 v[244:245], v5 offset:41504
    s_add_u32 s22, s21, 0x400
    s_add_u32 m0, s20, 0x10400
    s_nop 0
    buffer_load_dwordx4 v2, s[8:11], s22 offen sc1 lds
    v_mfma_f32_16x16x32_bf16 v[44:47], v[232:235], v[132:135], v[44:47]
    ds_read_b64_tr_b16 v[246:247], v5 offset:42528
    s_waitcnt lgkmcnt(4)
    v_mfma_f32_16x16x32_bf16 v[48:51], v[236:239], v[128:131], v[48:51]
    ds_read_b64_tr_b16 v[224:225], v4 offset:41728
    v_mfma_f32_16x16x32_bf16 v[52:55], v[236:239], v[132:135], v[52:55]
    ds_read_b64_tr_b16 v[226:227], v4 offset:42752
    s_waitcnt lgkmcnt(4)
    v_mfma_f32_16x16x32_bf16 v[56:59], v[240:243], v[128:131], v[56:59]
    ds_read_b64_tr_b16 v[228:229], v5 offset:41760
    v_mfma_f32_16x16x32_bf16 v[60:63], v[240:243], v[132:135], v[60:63]
    ds_read_b64_tr_b16 v[230:231], v5 offset:42784
    s_waitcnt lgkmcnt(4)
    v_mfma_f32_16x16x32_bf16 v[64:67], v[244:247], v[128:131], v[64:67]
    v_mfma_f32_16x16x32_bf16 v[68:71], v[244:247], v[132:135], v[68:71]
    s_waitcnt vmcnt(11)
    s_barrier
    ds_read_b64_tr_b16 v[232:233], v4 offset:49152
    ds_read_b64_tr_b16 v[234:235], v4 offset:50176
    s_mov_b32 s23, 0xe800
    buffer_load_dwordx4 v[116:119], v7, s[8:11], s23 offen offset:1024 sc1
    s_waitcnt lgkmcnt(4)
    v_mfma_f32_16x16x32_bf16 v[72:75], v[224:227], v[128:131], v[72:75]
    ds_read_b64_tr_b16 v[236:237], v5 offset:49184
    v_mfma_f32_16x16x32_bf16 v[76:79], v[224:227], v[132:135], v[76:79]
    s_add_u32 s22, s19, 0x680000
    s_add_u32 m0, s20, 0x4000
    s_nop 0
    buffer_load_dwordx4 v3, s[4:7], s22 offen lds
    ds_read_b64_tr_b16 v[238:239], v5 offset:50208
    s_waitcnt lgkmcnt(4)
    v_mfma_f32_16x16x32_bf16 v[80:83], v[228:231], v[128:131], v[80:83]
    ds_read_b64_tr_b16 v[240:241], v4 offset:49408
    v_mfma_f32_16x16x32_bf16 v[84:87], v[228:231], v[132:135], v[84:87]
    ds_read_b64_tr_b16 v[242:243], v4 offset:50432
    s_waitcnt lgkmcnt(4)
    v_mfma_f32_16x16x32_bf16 v[24:27], v[232:235], v[136:139], v[24:27]
    ds_read_b64_tr_b16 v[244:245], v5 offset:49440
    v_mfma_f32_16x16x32_bf16 v[28:31], v[232:235], v[140:143], v[28:31]
    ds_read_b64_tr_b16 v[246:247], v5 offset:50464
    s_waitcnt lgkmcnt(4)
    v_mfma_f32_16x16x32_bf16 v[32:35], v[236:239], v[136:139], v[32:35]
    ds_read_b64_tr_b16 v[224:225], v4 offset:49664
    v_mfma_f32_16x16x32_bf16 v[36:39], v[236:239], v[140:143], v[36:39]
    ds_read_b64_tr_b16 v[226:227], v4 offset:50688
    s_mov_b32 s23, 0x7000
    buffer_load_dwordx4 v[120:123], v7, s[8:11], s23 offen offset:0 sc1
    s_waitcnt lgkmcnt(4)
    v_mfma_f32_16x16x32_bf16 v[40:43], v[240:243], v[136:139], v[40:43]
    ds_read_b64_tr_b16 v[228:229], v5 offset:49696
    v_mfma_f32_16x16x32_bf16 v[44:47], v[240:243], v[140:143], v[44:47]
    s_add_u32 s22, s19, 0x688000
    s_add_u32 m0, s20, 0x4400
    s_nop 0
    buffer_load_dwordx4 v3, s[4:7], s22 offen lds
    ds_read_b64_tr_b16 v[230:231], v5 offset:50720
    s_waitcnt lgkmcnt(4)
    v_mfma_f32_16x16x32_bf16 v[48:51], v[244:247], v[136:139], v[48:51]
    ds_read_b64_tr_b16 v[232:233], v4 offset:49920
    v_mfma_f32_16x16x32_bf16 v[52:55], v[244:247], v[140:143], v[52:55]
    ds_read_b64_tr_b16 v[234:235], v4 offset:50944
    s_waitcnt lgkmcnt(4)
    v_mfma_f32_16x16x32_bf16 v[56:59], v[224:227], v[136:139], v[56:59]
    ds_read_b64_tr_b16 v[236:237], v5 offset:49952
    v_mfma_f32_16x16x32_bf16 v[60:63], v[224:227], v[140:143], v[60:63]
    ds_read_b64_tr_b16 v[238:239], v5 offset:50976
    s_waitcnt lgkmcnt(4)
    v_mfma_f32_16x16x32_bf16 v[64:67], v[228:231], v[136:139], v[64:67]
    ds_read_b64_tr_b16 v[240:241], v4 offset:57344
    v_mfma_f32_16x16x32_bf16 v[68:71], v[228:231], v[140:143], v[68:71]
    ds_read_b64_tr_b16 v[242:243], v4 offset:58368
    s_mov_b32 s23, 0xf000
    buffer_load_dwordx4 v[124:127], v7, s[8:11], s23 offen offset:0 sc1
    s_waitcnt lgkmcnt(4)
    v_mfma_f32_16x16x32_bf16 v[72:75], v[232:235], v[136:139], v[72:75]
    ds_read_b64_tr_b16 v[244:245], v5 offset:57376
    v_mfma_f32_16x16x32_bf16 v[76:79], v[232:235], v[140:143], v[76:79]
    ds_read_b64_tr_b16 v[246:247], v5 offset:58400
    s_waitcnt lgkmcnt(4)
    v_mfma_f32_16x16x32_bf16 v[80:83], v[236:239], v[136:139], v[80:83]
    ds_read_b64_tr_b16 v[224:225], v4 offset:57600
    v_mfma_f32_16x16x32_bf16 v[84:87], v[236:239], v[140:143], v[84:87]
    ds_read_b64_tr_b16 v[226:227], v4 offset:58624
    s_waitcnt lgkmcnt(4)
    v_mfma_f32_16x16x32_bf16 v[24:27], v[240:243], v[144:147], v[24:27]
    ds_read_b64_tr_b16 v[228:229], v5 offset:57632
    s_add_u32 s22, s21, 0x4000
    s_add_u32 m0, s20, 0x14000
    s_nop 0
    buffer_load_dwordx4 v2, s[8:11], s22 offen sc1 lds
    v_mfma_f32_16x16x32_bf16 v[28:31], v[240:243], v[148:151], v[28:31]
    ds_read_b64_tr_b16 v[230:231], v5 offset:58656
    s_waitcnt lgkmcnt(4)
    v_mfma_f32_16x16x32_bf16 v[32:35], v[244:247], v[144:147], v[32:35]
    ds_read_b64_tr_b16 v[232:233], v4 offset:57856
    v_mfma_f32_16x16x32_bf16 v[36:39], v[244:247], v[148:151], v[36:39]
    ds_read_b64_tr_b16 v[234:235], v4 offset:58880
    s_mov_b32 s23, 0x7000
    buffer_load_dwordx4 v[128:131], v7, s[8:11], s23 offen offset:1024 sc1
    s_waitcnt lgkmcnt(4)
    v_mfma_f32_16x16x32_bf16 v[40:43], v[224:227], v[144:147], v[40:43]
    ds_read_b64_tr_b16 v[236:237], v5 offset:57888
    s_add_u32 s22, s21, 0x4400
    s_add_u32 m0, s20, 0x14400
    s_nop 0
    buffer_load_dwordx4 v2, s[8:11], s22 offen sc1 lds
    v_mfma_f32_16x16x32_bf16 v[44:47], v[224:227], v[148:151], v[44:47]
    ds_read_b64_tr_b16 v[238:239], v5 offset:58912
    s_waitcnt lgkmcnt(4)
    v_mfma_f32_16x16x32_bf16 v[48:51], v[228:231], v[144:147], v[48:51]
    ds_read_b64_tr_b16 v[240:241], v4 offset:58112
    v_mfma_f32_16x16x32_bf16 v[52:55], v[228:231], v[148:151], v[52:55]
    ds_read_b64_tr_b16 v[242:243], v4 offset:59136
    s_waitcnt lgkmcnt(4)
    v_mfma_f32_16x16x32_bf16 v[56:59], v[232:235], v[144:147], v[56:59]
    ds_read_b64_tr_b16 v[244:245], v5 offset:58144
    v_mfma_f32_16x16x32_bf16 v[60:63], v[232:235], v[148:151], v[60:63]
    ds_read_b64_tr_b16 v[246:247], v5 offset:59168
    s_waitcnt lgkmcnt(4)
    v_mfma_f32_16x16x32_bf16 v[64:67], v[236:239], v[144:147], v[64:67]
    v_mfma_f32_16x16x32_bf16 v[68:71], v[236:239], v[148:151], v[68:71]
    s_waitcnt vmcnt(12)
    s_barrier
    ds_read_b64_tr_b16 v[224:225], v4 offset:0
    ds_read_b64_tr_b16 v[226:227], v4 offset:1024
    s_mov_b32 s23, 0xf000
    buffer_load_dwordx4 v[132:135], v7, s[8:11], s23 offen offset:1024 sc1
    s_waitcnt lgkmcnt(4)
    v_mfma_f32_16x16x32_bf16 v[72:75], v[240:243], v[144:147], v[72:75]
    ds_read_b64_tr_b16 v[228:229], v5 offset:32
    v_mfma_f32_16x16x32_bf16 v[76:79], v[240:243], v[148:151], v[76:79]
    s_add_u32 s22, s19, 0x700000
    s_add_u32 m0, s20, 0x8000
    s_nop 0
    buffer_load_dwordx4 v3, s[4:7], s22 offen lds
    ds_read_b64_tr_b16 v[230:231], v5 offset:1056
    s_waitcnt lgkmcnt(4)
    v_mfma_f32_16x16x32_bf16 v[80:83], v[244:247], v[144:147], v[80:83]
    ds_read_b64_tr_b16 v[232:233], v4 offset:256
    v_mfma_f32_16x16x32_bf16 v[84:87], v[244:247], v[148:151], v[84:87]
    ds_read_b64_tr_b16 v[234:235], v4 offset:1280
    s_waitcnt lgkmcnt(4)
    v_mfma_f32_16x16x32_bf16 v[24:27], v[224:227], v[88:91], v[24:27]
    ds_read_b64_tr_b16 v[236:237], v5 offset:288
    v_mfma_f32_16x16x32_bf16 v[28:31], v[224:227], v[92:95], v[28:31]
    ds_read_b64_tr_b16 v[238:239], v5 offset:1312
    s_waitcnt lgkmcnt(4)
    v_mfma_f32_16x16x32_bf16 v[32:35], v[228:231], v[88:91], v[32:35]
    ds_read_b64_tr_b16 v[240:241], v4 offset:512
    v_mfma_f32_16x16x32_bf16 v[36:39], v[228:231], v[92:95], v[36:39]
    ds_read_b64_tr_b16 v[242:243], v4 offset:1536
    s_mov_b32 s23, 0x7800
    buffer_load_dwordx4 v[136:139], v7, s[8:11], s23 offen offset:0 sc1
    s_waitcnt lgkmcnt(4)
    v_mfma_f32_16x16x32_bf16 v[40:43], v[232:235], v[88:91], v[40:43]
    ds_read_b64_tr_b16 v[244:245], v5 offset:544
    v_mfma_f32_16x16x32_bf16 v[44:47], v[232:235], v[92:95], v[44:47]
    s_add_u32 s22, s19, 0x708000
    s_add_u32 m0, s20, 0x8400
    s_nop 0
    buffer_load_dwordx4 v3, s[4:7], s22 offen lds
    ds_read_b64_tr_b16 v[246:247], v5 offset:1568
    s_waitcnt lgkmcnt(4)
    v_mfma_f32_16x16x32_bf16 v[48:51], v[236:239], v[88:91], v[48:51]
    ds_read_b64_tr_b16 v[224:225], v4 offset:768
    v_mfma_f32_16x16x32_bf16 v[52:55], v[236:239], v[92:95], v[52:55]
    ds_read_b64_tr_b16 v[226:227], v4 offset:1792
    s_waitcnt lgkmcnt(4)
    v_mfma_f32_16x16x32_bf16 v[56:59], v[240:243], v[88:91], v[56:59]
    ds_read_b64_tr_b16 v[228:229], v5 offset:800
    v_mfma_f32_16x16x32_bf16 v[60:63], v[240:243], v[92:95], v[60:63]
    ds_read_b64_tr_b16 v[230:231], v5 offset:1824
    s_waitcnt lgkmcnt(4)
    v_mfma_f32_16x16x32_bf16 v[64:67], v[244:247], v[88:91], v[64:67]
    ds_read_b64_tr_b16 v[232:233], v4 offset:8192
    v_mfma_f32_16x16x32_bf16 v[68:71], v[244:247], v[92:95], v[68:71]
    ds_read_b64_tr_b16 v[234:235], v4 offset:9216
    s_mov_b32 s23, 0xf800
    buffer_load_dwordx4 v[140:143], v7, s[8:11], s23 offen offset:0 sc1
    s_waitcnt lgkmcnt(4)
    v_mfma_f32_16x16x32_bf16 v[72:75], v[224:227], v[88:91], v[72:75]
    ds_read_b64_tr_b16 v[236:237], v5 offset:8224
    v_mfma_f32_16x16x32_bf16 v[76:79], v[224:227], v[92:95], v[76:79]
    ds_read_b64_tr_b16 v[238:239], v5 offset:9248
    s_waitcnt lgkmcnt(4)
    v_mfma_f32_16x16x32_bf16 v[80:83], v[228:231], v[88:91], v[80:83]
    ds_read_b64_tr_b16 v[240:241], v4 offset:8448
    v_mfma_f32_16x16x32_bf16 v[84:87], v[228:231], v[92:95], v[84:87]
    ds_read_b64_tr_b16 v[242:243], v4 offset:9472
    s_waitcnt lgkmcnt(4)
    v_mfma_f32_16x16x32_bf16 v[24:27], v[232:235], v[96:99], v[24:27]
    ds_read_b64_tr_b16 v[244:245], v5 offset:8480
    s_add_u32 s22, s21, 0x8000
    s_add_u32 m0, s20, 0x18000
    s_nop 0
    buffer_load_dwordx4 v2, s[8:11], s22 offen sc1 lds
    v_mfma_f32_16x16x32_bf16 v[28:31], v[232:235], v[100:103], v[28:31]
    ds_read_b64_tr_b16 v[246:247], v5 offset:9504
    s_waitcnt lgkmcnt(4)
    v_mfma_f32_16x16x32_bf16 v[32:35], v[236:239], v[96:99], v[32:35]
    ds_read_b64_tr_b16 v[224:225], v4 offset:8704
    v_mfma_f32_16x16x32_bf16 v[36:39], v[236:239], v[100:103], v[36:39]
    ds_read_b64_tr_b16 v[226:227], v4 offset:9728
    s_mov_b32 s23, 0x7800
    buffer_load_dwordx4 v[144:147], v7, s[8:11], s23 offen offset:1024 sc1
    s_waitcnt lgkmcnt(4)
    v_mfma_f32_16x16x32_bf16 v[40:43], v[240:243], v[96:99], v[40:43]
    ds_read_b64_tr_b16 v[228:229], v5 offset:8736
    s_add_u32 s22, s21, 0x8400
    s_add_u32 m0, s20, 0x18400
    s_nop 0
    buffer_load_dwordx4 v2, s[8:11], s22 offen sc1 lds
    v_mfma_f32_16x16x32_bf16 v[44:47], v[240:243], v[100:103], v[44:47]
    ds_read_b64_tr_b16 v[230:231], v5 offset:9760
    s_waitcnt lgkmcnt(4)
    v_mfma_f32_16x16x32_bf16 v[48:51], v[244:247], v[96:99], v[48:51]
    ds_read_b64_tr_b16 v[232:233], v4 offset:8960
    v_mfma_f32_16x16x32_bf16 v[52:55], v[244:247], v[100:103], v[52:55]
    ds_read_b64_tr_b16 v[234:235], v4 offset:9984
    s_waitcnt lgkmcnt(4)
    v_mfma_f32_16x16x32_bf16 v[56:59], v[224:227], v[96:99], v[56:59]
    ds_read_b64_tr_b16 v[236:237], v5 offset:8992
    v_mfma_f32_16x16x32_bf16 v[60:63], v[224:227], v[100:103], v[60:63]
    ds_read_b64_tr_b16 v[238:239], v5 offset:10016
    s_waitcnt lgkmcnt(4)
    v_mfma_f32_16x16x32_bf16 v[64:67], v[228:231], v[96:99], v[64:67]
    v_mfma_f32_16x16x32_bf16 v[68:71], v[228:231], v[100:103], v[68:71]
    s_waitcnt vmcnt(12)
    s_barrier
    ds_read_b64_tr_b16 v[240:241], v4 offset:16384
    ds_read_b64_tr_b16 v[242:243], v4 offset:17408
    s_mov_b32 s23, 0xf800
    buffer_load_dwordx4 v[148:151], v7, s[8:11], s23 offen offset:1024 sc1
    s_waitcnt lgkmcnt(4)
    v_mfma_f32_16x16x32_bf16 v[72:75], v[232:235], v[96:99], v[72:75]
    ds_read_b64_tr_b16 v[244:245], v5 offset:16416
    v_mfma_f32_16x16x32_bf16 v[76:79], v[232:235], v[100:103], v[76:79]
    s_add_u32 s22, s19, 0x780000
    s_add_u32 m0, s20, 0xc000
    s_nop 0
    buffer_load_dwordx4 v3, s[4:7], s22 offen lds
    ds_read_b64_tr_b16 v[246:247], v5 offset:17440
    s_waitcnt lgkmcnt(4)
    v_mfma_f32_16x16x32_bf16 v[80:83], v[236:239], v[96:99], v[80:83]
    ds_read_b64_tr_b16 v[224:225], v4 offset:16640
    v_mfma_f32_16x16x32_bf16 v[84:87], v[236:239], v[100:103], v[84:87]
    ds_read_b64_tr_b16 v[226:227], v4 offset:17664
    s_waitcnt lgkmcnt(4)
    v_mfma_f32_16x16x32_bf16 v[24:27], v[240:243], v[104:107], v[24:27]
    ds_read_b64_tr_b16 v[228:229], v5 offset:16672
    v_mfma_f32_16x16x32_bf16 v[28:31], v[240:243], v[108:111], v[28:31]
    ds_read_b64_tr_b16 v[230:231], v5 offset:17696
    s_waitcnt lgkmcnt(4)
    v_mfma_f32_16x16x32_bf16 v[32:35], v[244:247], v[104:107], v[32:35]
    ds_read_b64_tr_b16 v[232:233], v4 offset:16896
    v_mfma_f32_16x16x32_bf16 v[36:39], v[244:247], v[108:111], v[36:39]
    ds_read_b64_tr_b16 v[234:235], v4 offset:17920
    s_waitcnt lgkmcnt(4)
    v_mfma_f32_16x16x32_bf16 v[40:43], v[224:227], v[104:107], v[40:43]
    ds_read_b64_tr_b16 v[236:237], v5 offset:16928
    v_mfma_f32_16x16x32_bf16 v[44:47], v[224:227], v[108:111], v[44:47]
    s_add_u32 s22, s19, 0x788000
    s_add_u32 m0, s20, 0xc400
    s_nop 0
    buffer_load_dwordx4 v3, s[4:7], s22 offen lds
    ds_read_b64_tr_b16 v[238:239], v5 offset:17952
    s_waitcnt lgkmcnt(4)
    v_mfma_f32_16x16x32_bf16 v[48:51], v[228:231], v[104:107], v[48:51]
    ds_read_b64_tr_b16 v[240:241], v4 offset:17152
    v_mfma_f32_16x16x32_bf16 v[52:55], v[228:231], v[108:111], v[52:55]
    ds_read_b64_tr_b16 v[242:243], v4 offset:18176
    s_waitcnt lgkmcnt(4)
    v_mfma_f32_16x16x32_bf16 v[56:59], v[232:235], v[104:107], v[56:59]
    ds_read_b64_tr_b16 v[244:245], v5 offset:17184
    v_mfma_f32_16x16x32_bf16 v[60:63], v[232:235], v[108:111], v[60:63]
    ds_read_b64_tr_b16 v[246:247], v5 offset:18208
    s_waitcnt lgkmcnt(4)
    v_mfma_f32_16x16x32_bf16 v[64:67], v[236:239], v[104:107], v[64:67]
    ds_read_b64_tr_b16 v[224:225], v4 offset:24576
    v_mfma_f32_16x16x32_bf16 v[68:71], v[236:239], v[108:111], v[68:71]
    ds_read_b64_tr_b16 v[226:227], v4 offset:25600
    s_waitcnt lgkmcnt(4)
    v_mfma_f32_16x16x32_bf16 v[72:75], v[240:243], v[104:107], v[72:75]
    ds_read_b64_tr_b16 v[228:229], v5 offset:24608
    v_mfma_f32_16x16x32_bf16 v[76:79], v[240:243], v[108:111], v[76:79]
    ds_read_b64_tr_b16 v[230:231], v5 offset:25632
    s_waitcnt lgkmcnt(4)
    v_mfma_f32_16x16x32_bf16 v[80:83], v[244:247], v[104:107], v[80:83]
    ds_read_b64_tr_b16 v[232:233], v4 offset:24832
    v_mfma_f32_16x16x32_bf16 v[84:87], v[244:247], v[108:111], v[84:87]
    ds_read_b64_tr_b16 v[234:235], v4 offset:25856
    s_waitcnt lgkmcnt(4)
    v_mfma_f32_16x16x32_bf16 v[24:27], v[224:227], v[112:115], v[24:27]
    ds_read_b64_tr_b16 v[236:237], v5 offset:24864
    s_add_u32 s22, s21, 0xc000
    s_add_u32 m0, s20, 0x1c000
    s_nop 0
    buffer_load_dwordx4 v2, s[8:11], s22 offen sc1 lds
    v_mfma_f32_16x16x32_bf16 v[28:31], v[224:227], v[116:119], v[28:31]
    ds_read_b64_tr_b16 v[238:239], v5 offset:25888
    s_waitcnt lgkmcnt(4)
    v_mfma_f32_16x16x32_bf16 v[32:35], v[228:231], v[112:115], v[32:35]
    ds_read_b64_tr_b16 v[240:241], v4 offset:25088
    v_mfma_f32_16x16x32_bf16 v[36:39], v[228:231], v[116:119], v[36:39]
    ds_read_b64_tr_b16 v[242:243], v4 offset:26112
    s_waitcnt lgkmcnt(4)
    v_mfma_f32_16x16x32_bf16 v[40:43], v[232:235], v[112:115], v[40:43]
    ds_read_b64_tr_b16 v[244:245], v5 offset:25120
    s_add_u32 s22, s21, 0xc400
    s_add_u32 m0, s20, 0x1c400
    s_nop 0
    buffer_load_dwordx4 v2, s[8:11], s22 offen sc1 lds
    v_mfma_f32_16x16x32_bf16 v[44:47], v[232:235], v[116:119], v[44:47]
    ds_read_b64_tr_b16 v[246:247], v5 offset:26144
    s_waitcnt lgkmcnt(4)
    v_mfma_f32_16x16x32_bf16 v[48:51], v[236:239], v[112:115], v[48:51]
    ds_read_b64_tr_b16 v[224:225], v4 offset:25344
    v_mfma_f32_16x16x32_bf16 v[52:55], v[236:239], v[116:119], v[52:55]
    ds_read_b64_tr_b16 v[226:227], v4 offset:26368
    s_waitcnt lgkmcnt(4)
    v_mfma_f32_16x16x32_bf16 v[56:59], v[240:243], v[112:115], v[56:59]
    ds_read_b64_tr_b16 v[228:229], v5 offset:25376
    v_mfma_f32_16x16x32_bf16 v[60:63], v[240:243], v[116:119], v[60:63]
    ds_read_b64_tr_b16 v[230:231], v5 offset:26400
    s_waitcnt lgkmcnt(4)
    v_mfma_f32_16x16x32_bf16 v[64:67], v[244:247], v[112:115], v[64:67]
    v_mfma_f32_16x16x32_bf16 v[68:71], v[244:247], v[116:119], v[68:71]
    s_waitcnt vmcnt(9)
    s_barrier
    ds_read_b64_tr_b16 v[232:233], v4 offset:32768
    ds_read_b64_tr_b16 v[234:235], v4 offset:33792
    s_waitcnt lgkmcnt(4)
    v_mfma_f32_16x16x32_bf16 v[72:75], v[224:227], v[112:115], v[72:75]
    ds_read_b64_tr_b16 v[236:237], v5 offset:32800
    v_mfma_f32_16x16x32_bf16 v[76:79], v[224:227], v[116:119], v[76:79]
    ds_read_b64_tr_b16 v[238:239], v5 offset:33824
    s_waitcnt lgkmcnt(4)
    v_mfma_f32_16x16x32_bf16 v[80:83], v[228:231], v[112:115], v[80:83]
    ds_read_b64_tr_b16 v[240:241], v4 offset:33024
    v_mfma_f32_16x16x32_bf16 v[84:87], v[228:231], v[116:119], v[84:87]
    ds_read_b64_tr_b16 v[242:243], v4 offset:34048
    s_waitcnt lgkmcnt(4)
    v_mfma_f32_16x16x32_bf16 v[24:27], v[232:235], v[120:123], v[24:27]
    ds_read_b64_tr_b16 v[244:245], v5 offset:33056
    v_mfma_f32_16x16x32_bf16 v[28:31], v[232:235], v[124:127], v[28:31]
    ds_read_b64_tr_b16 v[246:247], v5 offset:34080
    s_waitcnt lgkmcnt(4)
    v_mfma_f32_16x16x32_bf16 v[32:35], v[236:239], v[120:123], v[32:35]
    ds_read_b64_tr_b16 v[224:225], v4 offset:33280
    v_mfma_f32_16x16x32_bf16 v[36:39], v[236:239], v[124:127], v[36:39]
    ds_read_b64_tr_b16 v[226:227], v4 offset:34304
    s_waitcnt lgkmcnt(4)
    v_mfma_f32_16x16x32_bf16 v[40:43], v[240:243], v[120:123], v[40:43]
    ds_read_b64_tr_b16 v[228:229], v5 offset:33312
    v_mfma_f32_16x16x32_bf16 v[44:47], v[240:243], v[124:127], v[44:47]
    ds_read_b64_tr_b16 v[230:231], v5 offset:34336
    s_waitcnt lgkmcnt(4)
    v_mfma_f32_16x16x32_bf16 v[48:51], v[244:247], v[120:123], v[48:51]
    ds_read_b64_tr_b16 v[232:233], v4 offset:33536
    v_mfma_f32_16x16x32_bf16 v[52:55], v[244:247], v[124:127], v[52:55]
    ds_read_b64_tr_b16 v[234:235], v4 offset:34560
    s_waitcnt lgkmcnt(4)
    v_mfma_f32_16x16x32_bf16 v[56:59], v[224:227], v[120:123], v[56:59]
    ds_read_b64_tr_b16 v[236:237], v5 offset:33568
    v_mfma_f32_16x16x32_bf16 v[60:63], v[224:227], v[124:127], v[60:63]
    ds_read_b64_tr_b16 v[238:239], v5 offset:34592
    s_waitcnt lgkmcnt(4)
    v_mfma_f32_16x16x32_bf16 v[64:67], v[228:231], v[120:123], v[64:67]
    ds_read_b64_tr_b16 v[240:241], v4 offset:40960
    v_mfma_f32_16x16x32_bf16 v[68:71], v[228:231], v[124:127], v[68:71]
    ds_read_b64_tr_b16 v[242:243], v4 offset:41984
    s_waitcnt lgkmcnt(4)
    v_mfma_f32_16x16x32_bf16 v[72:75], v[232:235], v[120:123], v[72:75]
    ds_read_b64_tr_b16 v[244:245], v5 offset:40992
    v_mfma_f32_16x16x32_bf16 v[76:79], v[232:235], v[124:127], v[76:79]
    ds_read_b64_tr_b16 v[246:247], v5 offset:42016
    s_waitcnt lgkmcnt(4)
    v_mfma_f32_16x16x32_bf16 v[80:83], v[236:239], v[120:123], v[80:83]
    ds_read_b64_tr_b16 v[224:225], v4 offset:41216
    v_mfma_f32_16x16x32_bf16 v[84:87], v[236:239], v[124:127], v[84:87]
    ds_read_b64_tr_b16 v[226:227], v4 offset:42240
    s_waitcnt lgkmcnt(4)
    v_mfma_f32_16x16x32_bf16 v[24:27], v[240:243], v[128:131], v[24:27]
    ds_read_b64_tr_b16 v[228:229], v5 offset:41248
    v_mfma_f32_16x16x32_bf16 v[28:31], v[240:243], v[132:135], v[28:31]
    ds_read_b64_tr_b16 v[230:231], v5 offset:42272
    s_waitcnt lgkmcnt(4)
    v_mfma_f32_16x16x32_bf16 v[32:35], v[244:247], v[128:131], v[32:35]
    ds_read_b64_tr_b16 v[232:233], v4 offset:41472
    v_mfma_f32_16x16x32_bf16 v[36:39], v[244:247], v[132:135], v[36:39]
    ds_read_b64_tr_b16 v[234:235], v4 offset:42496
    s_waitcnt lgkmcnt(4)
    v_mfma_f32_16x16x32_bf16 v[40:43], v[224:227], v[128:131], v[40:43]
    ds_read_b64_tr_b16 v[236:237], v5 offset:41504
    v_mfma_f32_16x16x32_bf16 v[44:47], v[224:227], v[132:135], v[44:47]
    ds_read_b64_tr_b16 v[238:239], v5 offset:42528
    s_waitcnt lgkmcnt(4)
    v_mfma_f32_16x16x32_bf16 v[48:51], v[228:231], v[128:131], v[48:51]
    ds_read_b64_tr_b16 v[240:241], v4 offset:41728
    v_mfma_f32_16x16x32_bf16 v[52:55], v[228:231], v[132:135], v[52:55]
    ds_read_b64_tr_b16 v[242:243], v4 offset:42752
    s_waitcnt lgkmcnt(4)
    v_mfma_f32_16x16x32_bf16 v[56:59], v[232:235], v[128:131], v[56:59]
    ds_read_b64_tr_b16 v[244:245], v5 offset:41760
    v_mfma_f32_16x16x32_bf16 v[60:63], v[232:235], v[132:135], v[60:63]
    ds_read_b64_tr_b16 v[246:247], v5 offset:42784
    s_waitcnt lgkmcnt(4)
    v_mfma_f32_16x16x32_bf16 v[64:67], v[236:239], v[128:131], v[64:67]
    v_mfma_f32_16x16x32_bf16 v[68:71], v[236:239], v[132:135], v[68:71]
    s_waitcnt vmcnt(2)
    s_barrier
    ds_read_b64_tr_b16 v[224:225], v4 offset:49152
    ds_read_b64_tr_b16 v[226:227], v4 offset:50176
    s_waitcnt lgkmcnt(4)
    v_mfma_f32_16x16x32_bf16 v[72:75], v[240:243], v[128:131], v[72:75]
    ds_read_b64_tr_b16 v[228:229], v5 offset:49184
    v_mfma_f32_16x16x32_bf16 v[76:79], v[240:243], v[132:135], v[76:79]
    ds_read_b64_tr_b16 v[230:231], v5 offset:50208
    s_waitcnt lgkmcnt(4)
    v_mfma_f32_16x16x32_bf16 v[80:83], v[244:247], v[128:131], v[80:83]
    ds_read_b64_tr_b16 v[232:233], v4 offset:49408
    v_mfma_f32_16x16x32_bf16 v[84:87], v[244:247], v[132:135], v[84:87]
    ds_read_b64_tr_b16 v[234:235], v4 offset:50432
    s_waitcnt lgkmcnt(4)
    v_mfma_f32_16x16x32_bf16 v[24:27], v[224:227], v[136:139], v[24:27]
    ds_read_b64_tr_b16 v[236:237], v5 offset:49440
    v_mfma_f32_16x16x32_bf16 v[28:31], v[224:227], v[140:143], v[28:31]
    ds_read_b64_tr_b16 v[238:239], v5 offset:50464
    s_waitcnt lgkmcnt(4)
    v_mfma_f32_16x16x32_bf16 v[32:35], v[228:231], v[136:139], v[32:35]
    ds_read_b64_tr_b16 v[240:241], v4 offset:49664
    v_mfma_f32_16x16x32_bf16 v[36:39], v[228:231], v[140:143], v[36:39]
    ds_read_b64_tr_b16 v[242:243], v4 offset:50688
    s_waitcnt lgkmcnt(4)
    v_mfma_f32_16x16x32_bf16 v[40:43], v[232:235], v[136:139], v[40:43]
    ds_read_b64_tr_b16 v[244:245], v5 offset:49696
    v_mfma_f32_16x16x32_bf16 v[44:47], v[232:235], v[140:143], v[44:47]
    ds_read_b64_tr_b16 v[246:247], v5 offset:50720
    s_waitcnt lgkmcnt(4)
    v_mfma_f32_16x16x32_bf16 v[48:51], v[236:239], v[136:139], v[48:51]
    ds_read_b64_tr_b16 v[224:225], v4 offset:49920
    v_mfma_f32_16x16x32_bf16 v[52:55], v[236:239], v[140:143], v[52:55]
    ds_read_b64_tr_b16 v[226:227], v4 offset:50944
    s_waitcnt lgkmcnt(4)
    v_mfma_f32_16x16x32_bf16 v[56:59], v[240:243], v[136:139], v[56:59]
    ds_read_b64_tr_b16 v[228:229], v5 offset:49952
    v_mfma_f32_16x16x32_bf16 v[60:63], v[240:243], v[140:143], v[60:63]
    ds_read_b64_tr_b16 v[230:231], v5 offset:50976
    s_waitcnt lgkmcnt(4)
    v_mfma_f32_16x16x32_bf16 v[64:67], v[244:247], v[136:139], v[64:67]
    ds_read_b64_tr_b16 v[232:233], v4 offset:57344
    v_mfma_f32_16x16x32_bf16 v[68:71], v[244:247], v[140:143], v[68:71]
    ds_read_b64_tr_b16 v[234:235], v4 offset:58368
    s_waitcnt lgkmcnt(4)
    v_mfma_f32_16x16x32_bf16 v[72:75], v[224:227], v[136:139], v[72:75]
    ds_read_b64_tr_b16 v[236:237], v5 offset:57376
    v_mfma_f32_16x16x32_bf16 v[76:79], v[224:227], v[140:143], v[76:79]
    ds_read_b64_tr_b16 v[238:239], v5 offset:58400
    s_waitcnt lgkmcnt(4)
    v_mfma_f32_16x16x32_bf16 v[80:83], v[228:231], v[136:139], v[80:83]
    ds_read_b64_tr_b16 v[240:241], v4 offset:57600
    v_mfma_f32_16x16x32_bf16 v[84:87], v[228:231], v[140:143], v[84:87]
    ds_read_b64_tr_b16 v[242:243], v4 offset:58624
    s_waitcnt lgkmcnt(4)
    v_mfma_f32_16x16x32_bf16 v[24:27], v[232:235], v[144:147], v[24:27]
    ds_read_b64_tr_b16 v[244:245], v5 offset:57632
    v_mfma_f32_16x16x32_bf16 v[28:31], v[232:235], v[148:151], v[28:31]
    ds_read_b64_tr_b16 v[246:247], v5 offset:58656
    s_waitcnt lgkmcnt(4)
    v_mfma_f32_16x16x32_bf16 v[32:35], v[236:239], v[144:147], v[32:35]
    ds_read_b64_tr_b16 v[224:225], v4 offset:57856
    v_mfma_f32_16x16x32_bf16 v[36:39], v[236:239], v[148:151], v[36:39]
    ds_read_b64_tr_b16 v[226:227], v4 offset:58880
    s_waitcnt lgkmcnt(4)
    v_mfma_f32_16x16x32_bf16 v[40:43], v[240:243], v[144:147], v[40:43]
    ds_read_b64_tr_b16 v[228:229], v5 offset:57888
    v_mfma_f32_16x16x32_bf16 v[44:47], v[240:243], v[148:151], v[44:47]
    ds_read_b64_tr_b16 v[230:231], v5 offset:58912
    s_waitcnt lgkmcnt(4)
    v_mfma_f32_16x16x32_bf16 v[48:51], v[244:247], v[144:147], v[48:51]
    ds_read_b64_tr_b16 v[232:233], v4 offset:58112
    v_mfma_f32_16x16x32_bf16 v[52:55], v[244:247], v[148:151], v[52:55]
    ds_read_b64_tr_b16 v[234:235], v4 offset:59136
    s_waitcnt lgkmcnt(4)
    v_mfma_f32_16x16x32_bf16 v[56:59], v[224:227], v[144:147], v[56:59]
    ds_read_b64_tr_b16 v[236:237], v5 offset:58144
    v_mfma_f32_16x16x32_bf16 v[60:63], v[224:227], v[148:151], v[60:63]
    ds_read_b64_tr_b16 v[238:239], v5 offset:59168
    s_waitcnt lgkmcnt(4)
    v_mfma_f32_16x16x32_bf16 v[64:67], v[228:231], v[144:147], v[64:67]
    v_mfma_f32_16x16x32_bf16 v[68:71], v[228:231], v[148:151], v[68:71]
    s_waitcnt lgkmcnt(2)
    v_mfma_f32_16x16x32_bf16 v[72:75], v[232:235], v[144:147], v[72:75]
    v_mfma_f32_16x16x32_bf16 v[76:79], v[232:235], v[148:151], v[76:79]
    s_waitcnt lgkmcnt(0)
    v_mfma_f32_16x16x32_bf16 v[80:83], v[236:239], v[144:147], v[80:83]
    v_mfma_f32_16x16x32_bf16 v[84:87], v[236:239], v[148:151], v[84:87]
    s_mov_b32 s23, 0x3e0293ee
    v_mul_f32 v24, s23, v24
    v_mul_f32 v25, s23, v25
    v_mul_f32 v26, s23, v26
    v_mul_f32 v27, s23, v27
    v_mul_f32 v28, s23, v28
    v_mul_f32 v29, s23, v29
    v_mul_f32 v30, s23, v30
    v_mul_f32 v31, s23, v31
    v_mul_f32 v32, s23, v32
    v_mul_f32 v33, s23, v33
    v_mul_f32 v34, s23, v34
    v_mul_f32 v35, s23, v35
    v_mul_f32 v36, s23, v36
    v_mul_f32 v37, s23, v37
    v_mul_f32 v38, s23, v38
    v_mul_f32 v39, s23, v39
    v_cvt_pk_bf16_f32 v152, v24, v25
    v_cvt_pk_bf16_f32 v153, v26, v27
    v_cvt_pk_bf16_f32 v168, v28, v29
    v_cvt_pk_bf16_f32 v169, v30, v31
    v_cvt_pk_bf16_f32 v154, v32, v33
    v_cvt_pk_bf16_f32 v155, v34, v35
    v_cvt_pk_bf16_f32 v170, v36, v37
    v_cvt_pk_bf16_f32 v171, v38, v39
    v_add_u32 v4, 0x10000, v2
    v_add_u32 v5, 0x20000, v2
    s_barrier
    ds_read_b128 v[224:227], v4 offset:0
    ds_read_b128 v[228:231], v4 offset:1024
    ds_read_b128 v[232:235], v4 offset:2048
    ds_read_b128 v[236:239], v4 offset:3072
    v_mov_b32 v12, 0x3f803f80
    v_mov_b32 v13, 0x3f803f80
    v_mov_b32 v14, 0x3f803f80
    v_mov_b32 v15, 0x3f803f80
    s_waitcnt lgkmcnt(3)
    v_mfma_f32_16x16x32_bf16 v[184:187], v[224:227], v[152:155], 0
    v_mul_f32 v40, s23, v40
    v_mul_f32 v41, s23, v41
    v_mul_f32 v42, s23, v42
    v_mul_f32 v43, s23, v43
    v_mul_f32 v44, s23, v44
    v_mul_f32 v45, s23, v45
    v_mfma_f32_16x16x32_bf16 v[188:191], v[224:227], v[168:171], 0
    ds_read_b128 v[240:243], v4 offset:4096
    v_mul_f32 v46, s23, v46
    v_mul_f32 v47, s23, v47
    v_mul_f32 v48, s23, v48
    v_mul_f32 v49, s23, v49
    v_mul_f32 v50, s23, v50
    v_mul_f32 v51, s23, v51
    s_mov_b64 s[64:65], s[46:47]
    s_mov_b32 s66, 0x700000
    s_mov_b32 s67, 0x20000
    s_mov_b64 s[68:69], s[48:49]
    s_mov_b32 s70, 0x700000
    s_mov_b32 s71, 0x20000
    s_cmp_lt_u32 s2, 224
    s_cselect_b32 s66, 7340032, 0
    s_cselect_b32 s70, 7340032, 0
    s_and_b32 s29, s2, 7
    s_mul_i32 s29, s29, 28
    s_lshr_b32 s16, s2, 3
    s_add_u32 s29, s29, s16
    s_sub_u32 s16, s3, 4
    v_lshrrev_b32 v20, 3, v1
    v_lshlrev_b32 v20, 3, v20
    s_lshl_b32 s17, s16, 6
    v_add_u32 v20, s17, v20
    s_mov_b32 s17, 7168
    v_mul_lo_u32 v11, s17, v20
    v_and_b32 v20, 7, v1
    v_lshl_add_u32 v11, v20, 4, v11
    s_and_b32 s17, s29, 3
    s_mul_i32 s18, s17, 1835008
    s_lshr_b32 s17, s29, 2
    s_lshl_b32 s17, s17, 7
    s_add_u32 s18, s18, s17
    s_lshl_b32 s15, s16, 13
    s_waitcnt lgkmcnt(3)
    v_mfma_f32_16x16x32_bf16 v[192:195], v[228:231], v[152:155], 0
    s_add_u32 s22, s21, 0x10000
    s_add_u32 m0, s20, 0x20000
    s_nop 0
    buffer_load_dwordx4 v2, s[8:11], s22 offen sc1 lds
    v_mul_f32 v52, s23, v52
    v_mul_f32 v53, s23, v53
    v_mul_f32 v54, s23, v54
    v_mul_f32 v55, s23, v55
    v_cvt_pk_bf16_f32 v156, v40, v41
    v_cvt_pk_bf16_f32 v157, v42, v43
    s_mov_b64 s[76:77], s[54:55]
    s_mov_b32 s78, 0xc00000
    s_mov_b32 s79, 0x20000
    v_bfe_u32 v20, v1, 2, 2
    v_lshlrev_b32 v20, 12, v20
    v_add_u32 v6, v3, v20
    s_lshr_b32 s16, s2, 5
    s_lshl_b32 s16, s16, 7
    s_lshl_b32 s17, s3, 3
    s_add_u32 s16, s16, s17
    s_mul_i32 s14, s16, 12288
    s_and_b32 s16, s2, 31
    s_lshl_b32 s16, s16, 8
    s_add_u32 s14, s14, s16
    s_add_u32 s14, s14, 4096
    v_mfma_f32_16x16x32_bf16 v[196:199], v[228:231], v[168:171], 0
    ds_read_b128 v[244:247], v4 offset:5120
    v_cvt_pk_bf16_f32 v172, v44, v45
    v_cvt_pk_bf16_f32 v173, v46, v47
    v_cvt_pk_bf16_f32 v158, v48, v49
    v_cvt_pk_bf16_f32 v159, v50, v51
    v_cvt_pk_bf16_f32 v174, v52, v53
    v_cvt_pk_bf16_f32 v175, v54, v55
    s_waitcnt lgkmcnt(3)
    v_mfma_f32_16x16x32_bf16 v[184:187], v[232:235], v[156:159], v[184:187]
    v_mul_f32 v56, s23, v56
    v_mul_f32 v57, s23, v57
    v_mul_f32 v58, s23, v58
    v_mul_f32 v59, s23, v59
    v_mul_f32 v60, s23, v60
    v_mul_f32 v61, s23, v61
    v_mfma_f32_16x16x32_bf16 v[188:191], v[232:235], v[172:175], v[188:191]
    ds_read_b128 v[224:227], v4 offset:6144
    v_mul_f32 v62, s23, v62
    v_mul_f32 v63, s23, v63
    v_mul_f32 v64, s23, v64
    v_mul_f32 v65, s23, v65
    v_mul_f32 v66, s23, v66
    v_mul_f32 v67, s23, v67
    s_waitcnt lgkmcnt(3)
    v_mfma_f32_16x16x32_bf16 v[192:195], v[236:239], v[156:159], v[192:195]
    v_mul_f32 v68, s23, v68
    v_mul_f32 v69, s23, v69
    v_mul_f32 v70, s23, v70
    v_mul_f32 v71, s23, v71
    v_cvt_pk_bf16_f32 v160, v56, v57
    v_cvt_pk_bf16_f32 v161, v58, v59
    v_mfma_f32_16x16x32_bf16 v[196:199], v[236:239], v[172:175], v[196:199]
    ds_read_b128 v[228:231], v4 offset:7168
    v_cvt_pk_bf16_f32 v176, v60, v61
    v_cvt_pk_bf16_f32 v177, v62, v63
    v_cvt_pk_bf16_f32 v162, v64, v65
    v_cvt_pk_bf16_f32 v163, v66, v67
    v_cvt_pk_bf16_f32 v178, v68, v69
    v_cvt_pk_bf16_f32 v179, v70, v71
    s_waitcnt lgkmcnt(3)
    v_mfma_f32_16x16x32_bf16 v[184:187], v[240:243], v[160:163], v[184:187]
    v_mul_f32 v72, s23, v72
    v_mul_f32 v73, s23, v73
    v_mul_f32 v74, s23, v74
    v_mul_f32 v75, s23, v75
    v_mul_f32 v76, s23, v76
    v_mul_f32 v77, s23, v77
    v_mfma_f32_16x16x32_bf16 v[188:191], v[240:243], v[176:179], v[188:191]
    ds_read_b128 v[232:235], v4 offset:8192
    v_mul_f32 v78, s23, v78
    v_mul_f32 v79, s23, v79
    v_mul_f32 v80, s23, v80
    v_mul_f32 v81, s23, v81
    v_mul_f32 v82, s23, v82
    v_mul_f32 v83, s23, v83
    s_waitcnt lgkmcnt(3)
    v_mfma_f32_16x16x32_bf16 v[192:195], v[244:247], v[160:163], v[192:195]
    s_add_u32 s22, s21, 0x10400
    s_add_u32 m0, s20, 0x20400
    s_nop 0
    buffer_load_dwordx4 v2, s[8:11], s22 offen sc1 lds
    v_mul_f32 v84, s23, v84
    v_mul_f32 v85, s23, v85
    v_mul_f32 v86, s23, v86
    v_mul_f32 v87, s23, v87
    v_cvt_pk_bf16_f32 v164, v72, v73
    v_cvt_pk_bf16_f32 v165, v74, v75
    v_mfma_f32_16x16x32_bf16 v[196:199], v[244:247], v[176:179], v[196:199]
    ds_read_b128 v[236:239], v4 offset:9216
    v_cvt_pk_bf16_f32 v180, v76, v77
    v_cvt_pk_bf16_f32 v181, v78, v79
    v_cvt_pk_bf16_f32 v166, v80, v81
    v_cvt_pk_bf16_f32 v167, v82, v83
    v_cvt_pk_bf16_f32 v182, v84, v85
    v_cvt_pk_bf16_f32 v183, v86, v87
    s_waitcnt lgkmcnt(3)
    v_mfma_f32_16x16x32_bf16 v[184:187], v[224:227], v[164:167], v[184:187]
    v_mfma_f32_16x16x32_bf16 v[188:191], v[224:227], v[180:183], v[188:191]
    ds_read_b128 v[240:243], v4 offset:10240
    s_waitcnt lgkmcnt(3)
    v_mfma_f32_16x16x32_bf16 v[192:195], v[228:231], v[164:167], v[192:195]
    v_mfma_f32_16x16x32_bf16 v[196:199], v[228:231], v[180:183], v[196:199]
    ds_read_b128 v[244:247], v4 offset:11264
    s_waitcnt lgkmcnt(3)
    v_mfma_f32_16x16x32_bf16 v[200:203], v[232:235], v[152:155], 0
    v_mfma_f32_16x16x32_bf16 v[204:207], v[232:235], v[168:171], 0
    ds_read_b128 v[224:227], v4 offset:12288
    s_waitcnt lgkmcnt(3)
    v_mfma_f32_16x16x32_bf16 v[208:211], v[236:239], v[152:155], 0
    v_mfma_f32_16x16x32_bf16 v[212:215], v[236:239], v[168:171], 0
    ds_read_b128 v[228:231], v4 offset:13312
    s_waitcnt lgkmcnt(3)
    v_mfma_f32_16x16x32_bf16 v[200:203], v[240:243], v[156:159], v[200:203]
    v_mfma_f32_16x16x32_bf16 v[204:207], v[240:243], v[172:175], v[204:207]
    ds_read_b128 v[232:235], v4 offset:14336
    s_waitcnt lgkmcnt(3)
    v_mfma_f32_16x16x32_bf16 v[208:211], v[244:247], v[156:159], v[208:211]
    v_max3_f32 v16, v184, v185, v186
    v_mfma_f32_16x16x32_bf16 v[212:215], v[244:247], v[172:175], v[212:215]
    ds_read_b128 v[236:239], v4 offset:15360
    v_max3_f32 v16, v16, v187, v192
    s_waitcnt lgkmcnt(3)
    v_mfma_f32_16x16x32_bf16 v[200:203], v[224:227], v[160:163], v[200:203]
    v_max3_f32 v16, v16, v193, v194
    v_mfma_f32_16x16x32_bf16 v[204:207], v[224:227], v[176:179], v[204:207]
    s_barrier
    ds_read_b128 v[240:243], v4 offset:16384
    v_max_f32 v16, v16, v195
    s_waitcnt lgkmcnt(3)
    v_mfma_f32_16x16x32_bf16 v[208:211], v[228:231], v[160:163], v[208:211]
    v_max3_f32 v17, v188, v189, v190
    v_mfma_f32_16x16x32_bf16 v[212:215], v[228:231], v[176:179], v[212:215]
    s_add_u32 s22, s21, 0x14000
    s_add_u32 m0, s20, 0x24000
    s_nop 0
    buffer_load_dwordx4 v2, s[8:11], s22 offen sc1 lds
    ds_read_b128 v[244:247], v4 offset:17408
    v_max3_f32 v17, v17, v191, v196
    s_waitcnt lgkmcnt(3)
    v_mfma_f32_16x16x32_bf16 v[200:203], v[232:235], v[164:167], v[200:203]
    v_max3_f32 v17, v17, v197, v198
    v_mfma_f32_16x16x32_bf16 v[204:207], v[232:235], v[180:183], v[204:207]
    ds_read_b128 v[224:227], v4 offset:18432
    v_max_f32 v17, v17, v199
    s_waitcnt lgkmcnt(3)
    v_mfma_f32_16x16x32_bf16 v[208:211], v[236:239], v[164:167], v[208:211]
    s_mov_b64 s[72:73], s[40:41]
    s_mov_b32 s74, 0x800000
    s_mov_b32 s75, 0x20000
    v_lshlrev_b32 v21, 7, v1
    s_lshl_b32 s16, s2, 2
    s_add_u32 s16, s16, s3
    s_sub_u32 s16, s16, 4
    s_lshl_b32 s16, s16, 13
    buffer_load_dword v7, v21, s[72:75], s16 offen
    v_mfma_f32_16x16x32_bf16 v[212:215], v[236:239], v[180:183], v[212:215]
    ds_read_b128 v[228:231], v4 offset:19456
    v_max3_f32 v16, v16, v200, v201
    v_max3_f32 v16, v16, v202, v203
    v_max3_f32 v16, v16, v208, v209
    v_max3_f32 v16, v16, v210, v211
    v_max3_f32 v17, v17, v204, v205
    v_max3_f32 v17, v17, v206, v207
    s_nop 0
    v_max3_f32 v17, v17, v212, v213
    v_max3_f32 v17, v17, v214, v215
    v_mov_b32 v18, v16
    v_mov_b32 v19, v17
    s_nop 0
    v_permlane16_swap_b32 v16, v18
    v_permlane16_swap_b32 v17, v19
    v_max_f32 v16, v16, v18
    v_max_f32 v17, v17, v19
    v_mov_b32 v18, v16
    v_mov_b32 v19, v17
    s_nop 0
    v_permlane32_swap_b32 v16, v18
    v_permlane32_swap_b32 v17, v19
    v_max_f32 v16, v16, v18
    v_max_f32 v17, v17, v19
    v_sub_f32 v216, 0, v16
    v_sub_f32 v217, 0, v16
    v_sub_f32 v218, 0, v16
    v_sub_f32 v219, 0, v16
    v_sub_f32 v220, 0, v17
    v_sub_f32 v221, 0, v17
    v_sub_f32 v222, 0, v17
    v_sub_f32 v223, 0, v17
    v_add_f32 v184, v184, v216
    v_add_f32 v185, v185, v216
    v_exp_f32 v184, v184
    v_exp_f32 v185, v185
    v_add_f32 v186, v186, v216
    v_add_f32 v187, v187, v216
    v_exp_f32 v186, v186
    v_exp_f32 v187, v187
    v_cvt_pk_bf16_f32 v24, v184, v185
    v_add_f32 v188, v188, v220
    v_add_f32 v189, v189, v220
    v_exp_f32 v188, v188
    v_exp_f32 v189, v189
    v_cvt_pk_bf16_f32 v25, v186, v187
    v_add_f32 v190, v190, v220
    v_add_f32 v191, v191, v220
    v_exp_f32 v190, v190
    v_exp_f32 v191, v191
    v_cvt_pk_bf16_f32 v28, v188, v189
    v_add_f32 v192, v192, v216
    v_add_f32 v193, v193, v216
    v_exp_f32 v192, v192
    v_exp_f32 v193, v193
    v_cvt_pk_bf16_f32 v29, v190, v191
    v_add_f32 v194, v194, v216
    v_add_f32 v195, v195, v216
    v_exp_f32 v194, v194
    v_exp_f32 v195, v195
    v_cvt_pk_bf16_f32 v26, v192, v193
    v_add_f32 v196, v196, v220
    v_add_f32 v197, v197, v220
    v_exp_f32 v196, v196
    v_exp_f32 v197, v197
    v_cvt_pk_bf16_f32 v27, v194, v195
    v_add_f32 v198, v198, v220
    v_add_f32 v199, v199, v220
    v_exp_f32 v198, v198
    v_exp_f32 v199, v199
    v_cvt_pk_bf16_f32 v30, v196, v197
    v_cvt_pk_bf16_f32 v31, v198, v199
    s_waitcnt lgkmcnt(3)
    v_mfma_f32_16x16x32_bf16 v[184:187], v[240:243], v[152:155], v[216:219]
    v_mfma_f32_16x16x32_bf16 v[188:191], v[240:243], v[168:171], v[220:223]
    ds_read_b128 v[232:235], v4 offset:20480
    v_add_f32 v200, v200, v216
    v_add_f32 v201, v201, v216
    v_exp_f32 v200, v200
    v_mfma_f32_16x16x32_bf16 v[248:251], v[12:15], v[24:27], 0
    s_waitcnt lgkmcnt(3)
    v_mfma_f32_16x16x32_bf16 v[192:195], v[244:247], v[152:155], v[216:219]
    v_exp_f32 v201, v201
    v_add_f32 v202, v202, v216
    v_add_f32 v203, v203, v216
    v_mfma_f32_16x16x32_bf16 v[196:199], v[244:247], v[168:171], v[220:223]
    s_add_u32 s22, s21, 0x14400
    s_add_u32 m0, s20, 0x24400
    s_nop 0
    buffer_load_dwordx4 v2, s[8:11], s22 offen sc1 lds
    ds_read_b128 v[236:239], v4 offset:21504
    v_exp_f32 v202, v202
    v_exp_f32 v203, v203
    v_mfma_f32_16x16x32_bf16 v[252:255], v[12:15], v[28:31], 0
    s_waitcnt lgkmcnt(3)
    v_mfma_f32_16x16x32_bf16 v[184:187], v[224:227], v[156:159], v[184:187]
    v_cvt_pk_bf16_f32 v32, v200, v201
    v_add_f32 v204, v204, v220
    v_add_f32 v205, v205, v220
    v_mfma_f32_16x16x32_bf16 v[188:191], v[224:227], v[172:175], v[188:191]
    ds_read_b128 v[240:243], v4 offset:22528
    v_exp_f32 v204, v204
    v_exp_f32 v205, v205
    v_cvt_pk_bf16_f32 v33, v202, v203
    s_mov_b64 s[4:5], s[40:41]
    s_mov_b32 s6, 0x800000
    s_mov_b32 s7, 0x20000
    v_bfe_u32 v20, v1, 2, 2
    v_lshlrev_b32 v21, 13, v20
    v_sub_u32 v3, v3, v21
    v_lshl_add_u32 v3, v20, 11, v3
    s_and_b32 s16, s2, 1
    s_lshl_b32 s24, s16, 22
    s_lshr_b32 s16, s2, 5
    s_lshl_b32 s16, s16, 8
    s_add_u32 s24, s24, s16
    s_lshl_b32 s16, s3, 14
    s_add_u32 s24, s24, s16
    s_add_u32 s24, s24, 196608
    s_waitcnt lgkmcnt(3)
    v_mfma_f32_16x16x32_bf16 v[192:195], v[228:231], v[156:159], v[192:195]
    v_add_f32 v206, v206, v220
    v_add_f32 v207, v207, v220
    v_mfma_f32_16x16x32_bf16 v[196:199], v[228:231], v[172:175], v[196:199]
    ds_read_b128 v[244:247], v4 offset:23552
    v_exp_f32 v206, v206
    v_exp_f32 v207, v207
    v_cvt_pk_bf16_f32 v36, v204, v205
    s_waitcnt lgkmcnt(3)
    v_mfma_f32_16x16x32_bf16 v[184:187], v[232:235], v[160:163], v[184:187]
    v_add_f32 v208, v208, v216
    v_add_f32 v209, v209, v216
    v_exp_f32 v208, v208
    v_mfma_f32_16x16x32_bf16 v[188:191], v[232:235], v[176:179], v[188:191]
    ds_read_b128 v[224:227], v4 offset:24576
    v_exp_f32 v209, v209
    v_cvt_pk_bf16_f32 v37, v206, v207
    s_waitcnt lgkmcnt(3)
    v_mfma_f32_16x16x32_bf16 v[192:195], v[236:239], v[160:163], v[192:195]
    v_add_f32 v210, v210, v216
    v_add_f32 v211, v211, v216
    v_exp_f32 v210, v210
    v_mfma_f32_16x16x32_bf16 v[196:199], v[236:239], v[176:179], v[196:199]
    ds_read_b128 v[228:231], v4 offset:25600
    v_exp_f32 v211, v211
    v_cvt_pk_bf16_f32 v34, v208, v209
    v_add_f32 v212, v212, v220
    s_waitcnt lgkmcnt(3)
    v_mfma_f32_16x16x32_bf16 v[184:187], v[240:243], v[164:167], v[184:187]
    v_add_f32 v213, v213, v220
    v_exp_f32 v212, v212
    v_mfma_f32_16x16x32_bf16 v[188:191], v[240:243], v[180:183], v[188:191]
    ds_read_b128 v[232:235], v4 offset:26624
    v_exp_f32 v213, v213
    v_cvt_pk_bf16_f32 v35, v210, v211
    v_add_f32 v214, v214, v220
    s_waitcnt lgkmcnt(3)
    v_mfma_f32_16x16x32_bf16 v[192:195], v[244:247], v[164:167], v[192:195]
    v_add_f32 v215, v215, v220
    v_exp_f32 v214, v214
    v_exp_f32 v215, v215
    v_mfma_f32_16x16x32_bf16 v[196:199], v[244:247], v[180:183], v[196:199]
    ds_read_b128 v[236:239], v4 offset:27648
    v_cvt_pk_bf16_f32 v38, v212, v213
    v_cvt_pk_bf16_f32 v39, v214, v215
    s_waitcnt lgkmcnt(3)
    v_mfma_f32_16x16x32_bf16 v[200:203], v[224:227], v[152:155], v[216:219]
    v_mfma_f32_16x16x32_bf16 v[204:207], v[224:227], v[168:171], v[220:223]
    ds_read_b128 v[240:243], v4 offset:28672
    v_exp_f32 v184, v184
    v_exp_f32 v185, v185
    v_mfma_f32_16x16x32_bf16 v[248:251], v[12:15], v[32:35], v[248:251]
    s_waitcnt lgkmcnt(3)
    v_mfma_f32_16x16x32_bf16 v[208:211], v[228:231], v[152:155], v[216:219]
    v_exp_f32 v186, v186
    v_exp_f32 v187, v187
    v_mfma_f32_16x16x32_bf16 v[212:215], v[228:231], v[168:171], v[220:223]
    ds_read_b128 v[244:247], v4 offset:29696
    v_cvt_pk_bf16_f32 v40, v184, v185
    v_mfma_f32_16x16x32_bf16 v[252:255], v[12:15], v[36:39], v[252:255]
    s_waitcnt lgkmcnt(3)
    v_mfma_f32_16x16x32_bf16 v[200:203], v[232:235], v[156:159], v[200:203]
    v_exp_f32 v188, v188
    v_exp_f32 v189, v189
    v_mfma_f32_16x16x32_bf16 v[204:207], v[232:235], v[172:175], v[204:207]
    ds_read_b128 v[224:227], v4 offset:30720
    v_cvt_pk_bf16_f32 v41, v186, v187
    s_waitcnt lgkmcnt(3)
    v_mfma_f32_16x16x32_bf16 v[208:211], v[236:239], v[156:159], v[208:211]
    v_exp_f32 v190, v190
    v_exp_f32 v191, v191
    v_mfma_f32_16x16x32_bf16 v[212:215], v[236:239], v[172:175], v[212:215]
    ds_read_b128 v[228:231], v4 offset:31744
    v_cvt_pk_bf16_f32 v44, v188, v189
    v_exp_f32 v192, v192
    s_waitcnt lgkmcnt(3)
    v_mfma_f32_16x16x32_bf16 v[200:203], v[240:243], v[160:163], v[200:203]
    v_exp_f32 v193, v193
    v_mfma_f32_16x16x32_bf16 v[204:207], v[240:243], v[176:179], v[204:207]
    s_barrier
    ds_read_b128 v[232:235], v4 offset:32768
    v_cvt_pk_bf16_f32 v45, v190, v191
    v_exp_f32 v194, v194
    s_waitcnt lgkmcnt(3)
    v_mfma_f32_16x16x32_bf16 v[208:211], v[244:247], v[160:163], v[208:211]
    v_exp_f32 v195, v195
    v_mfma_f32_16x16x32_bf16 v[212:215], v[244:247], v[176:179], v[212:215]
    s_add_u32 s22, s21, 0x18000
    s_add_u32 m0, s20, 0x10000
    s_nop 0
    buffer_load_dwordx4 v2, s[8:11], s22 offen sc1 lds
    ds_read_b128 v[236:239], v4 offset:33792
    v_cvt_pk_bf16_f32 v42, v192, v193
    v_exp_f32 v196, v196
    s_waitcnt lgkmcnt(3)
    v_mfma_f32_16x16x32_bf16 v[200:203], v[224:227], v[164:167], v[200:203]
    v_exp_f32 v197, v197
    v_cvt_pk_bf16_f32 v43, v194, v195
    v_mfma_f32_16x16x32_bf16 v[204:207], v[224:227], v[180:183], v[204:207]
    ds_read_b128 v[240:243], v4 offset:34816
    v_exp_f32 v198, v198
    s_waitcnt lgkmcnt(3)
    v_mfma_f32_16x16x32_bf16 v[208:211], v[228:231], v[164:167], v[208:211]
    v_exp_f32 v199, v199
    v_cvt_pk_bf16_f32 v46, v196, v197
    v_mfma_f32_16x16x32_bf16 v[212:215], v[228:231], v[180:183], v[212:215]
    ds_read_b128 v[244:247], v4 offset:35840
    v_cvt_pk_bf16_f32 v47, v198, v199
    s_waitcnt lgkmcnt(3)
    v_mfma_f32_16x16x32_bf16 v[184:187], v[232:235], v[152:155], v[216:219]
    v_mfma_f32_16x16x32_bf16 v[188:191], v[232:235], v[168:171], v[220:223]
    ds_read_b128 v[224:227], v4 offset:36864
    v_exp_f32 v200, v200
    v_exp_f32 v201, v201
    v_mfma_f32_16x16x32_bf16 v[248:251], v[12:15], v[40:43], v[248:251]
    s_waitcnt lgkmcnt(3)
    v_mfma_f32_16x16x32_bf16 v[192:195], v[236:239], v[152:155], v[216:219]
    v_exp_f32 v202, v202
    v_exp_f32 v203, v203
    v_mfma_f32_16x16x32_bf16 v[196:199], v[236:239], v[168:171], v[220:223]
    s_add_u32 s22, s21, 0x18400
    s_add_u32 m0, s20, 0x10400
    s_nop 0
    buffer_load_dwordx4 v2, s[8:11], s22 offen sc1 lds
    ds_read_b128 v[228:231], v4 offset:37888
    v_cvt_pk_bf16_f32 v48, v200, v201
    v_mfma_f32_16x16x32_bf16 v[252:255], v[12:15], v[44:47], v[252:255]
    s_waitcnt lgkmcnt(3)
    v_mfma_f32_16x16x32_bf16 v[184:187], v[240:243], v[156:159], v[184:187]
    v_exp_f32 v204, v204
    v_exp_f32 v205, v205
    v_mfma_f32_16x16x32_bf16 v[188:191], v[240:243], v[172:175], v[188:191]
    ds_read_b128 v[232:235], v4 offset:38912
    v_cvt_pk_bf16_f32 v49, v202, v203
    s_waitcnt lgkmcnt(3)
    v_mfma_f32_16x16x32_bf16 v[192:195], v[244:247], v[156:159], v[192:195]
    v_exp_f32 v206, v206
    v_exp_f32 v207, v207
    v_mfma_f32_16x16x32_bf16 v[196:199], v[244:247], v[172:175], v[196:199]
    ds_read_b128 v[236:239], v4 offset:39936
    v_cvt_pk_bf16_f32 v52, v204, v205
    v_exp_f32 v208, v208
    s_waitcnt lgkmcnt(3)
    v_mfma_f32_16x16x32_bf16 v[184:187], v[224:227], v[160:163], v[184:187]
    v_exp_f32 v209, v209
    v_mfma_f32_16x16x32_bf16 v[188:191], v[224:227], v[176:179], v[188:191]
    ds_read_b128 v[240:243], v4 offset:40960
    v_cvt_pk_bf16_f32 v53, v206, v207
    v_exp_f32 v210, v210
    s_waitcnt lgkmcnt(3)
    v_mfma_f32_16x16x32_bf16 v[192:195], v[228:231], v[160:163], v[192:195]
    v_exp_f32 v211, v211
    v_mfma_f32_16x16x32_bf16 v[196:199], v[228:231], v[176:179], v[196:199]
    ds_read_b128 v[244:247], v4 offset:41984
    v_cvt_pk_bf16_f32 v50, v208, v209
    v_exp_f32 v212, v212
    s_waitcnt lgkmcnt(3)
    v_mfma_f32_16x16x32_bf16 v[184:187], v[232:235], v[164:167], v[184:187]
    v_exp_f32 v213, v213
    v_cvt_pk_bf16_f32 v51, v210, v211
    v_mfma_f32_16x16x32_bf16 v[188:191], v[232:235], v[180:183], v[188:191]
    ds_read_b128 v[224:227], v4 offset:43008
    v_exp_f32 v214, v214
    s_waitcnt lgkmcnt(3)
    v_mfma_f32_16x16x32_bf16 v[192:195], v[236:239], v[164:167], v[192:195]
    v_exp_f32 v215, v215
    v_cvt_pk_bf16_f32 v54, v212, v213
    v_mfma_f32_16x16x32_bf16 v[196:199], v[236:239], v[180:183], v[196:199]
    ds_read_b128 v[228:231], v4 offset:44032
    v_cvt_pk_bf16_f32 v55, v214, v215
    s_waitcnt lgkmcnt(3)
    v_mfma_f32_16x16x32_bf16 v[200:203], v[240:243], v[152:155], v[216:219]
    v_mfma_f32_16x16x32_bf16 v[204:207], v[240:243], v[168:171], v[220:223]
    ds_read_b128 v[232:235], v4 offset:45056
    v_exp_f32 v184, v184
    v_exp_f32 v185, v185
    v_mfma_f32_16x16x32_bf16 v[248:251], v[12:15], v[48:51], v[248:251]
    s_waitcnt lgkmcnt(3)
    v_mfma_f32_16x16x32_bf16 v[208:211], v[244:247], v[152:155], v[216:219]
    v_exp_f32 v186, v186
    v_exp_f32 v187, v187
    v_mfma_f32_16x16x32_bf16 v[212:215], v[244:247], v[168:171], v[220:223]
    ds_read_b128 v[236:239], v4 offset:46080
    v_cvt_pk_bf16_f32 v56, v184, v185
    v_mfma_f32_16x16x32_bf16 v[252:255], v[12:15], v[52:55], v[252:255]
    s_waitcnt lgkmcnt(3)
    v_mfma_f32_16x16x32_bf16 v[200:203], v[224:227], v[156:159], v[200:203]
    v_exp_f32 v188, v188
    v_exp_f32 v189, v189
    v_mfma_f32_16x16x32_bf16 v[204:207], v[224:227], v[172:175], v[204:207]
    ds_read_b128 v[240:243], v4 offset:47104
    v_cvt_pk_bf16_f32 v57, v186, v187
    s_waitcnt lgkmcnt(3)
    v_mfma_f32_16x16x32_bf16 v[208:211], v[228:231], v[156:159], v[208:211]
    v_exp_f32 v190, v190
    v_exp_f32 v191, v191
    v_mfma_f32_16x16x32_bf16 v[212:215], v[228:231], v[172:175], v[212:215]
    ds_read_b128 v[244:247], v4 offset:48128
    v_cvt_pk_bf16_f32 v60, v188, v189
    v_exp_f32 v192, v192
    s_waitcnt lgkmcnt(3)
    v_mfma_f32_16x16x32_bf16 v[200:203], v[232:235], v[160:163], v[200:203]
    v_exp_f32 v193, v193
    v_mfma_f32_16x16x32_bf16 v[204:207], v[232:235], v[176:179], v[204:207]
    s_waitcnt vmcnt(7)
    s_barrier
    ds_read_b128 v[224:227], v4 offset:49152
    v_cvt_pk_bf16_f32 v61, v190, v191
    v_exp_f32 v194, v194
    s_waitcnt lgkmcnt(3)
    v_mfma_f32_16x16x32_bf16 v[208:211], v[236:239], v[160:163], v[208:211]
    v_exp_f32 v195, v195
    v_mfma_f32_16x16x32_bf16 v[212:215], v[236:239], v[176:179], v[212:215]
    s_add_u32 s22, s21, 0x1c000
    s_add_u32 m0, s20, 0x14000
    s_nop 0
    buffer_load_dwordx4 v2, s[8:11], s22 offen sc1 lds
    ds_read_b128 v[228:231], v4 offset:50176
    v_cvt_pk_bf16_f32 v58, v192, v193
    v_exp_f32 v196, v196
    s_waitcnt lgkmcnt(3)
    v_mfma_f32_16x16x32_bf16 v[200:203], v[240:243], v[164:167], v[200:203]
    v_exp_f32 v197, v197
    v_cvt_pk_bf16_f32 v59, v194, v195
    v_mfma_f32_16x16x32_bf16 v[204:207], v[240:243], v[180:183], v[204:207]
    ds_read_b128 v[232:235], v4 offset:51200
    v_exp_f32 v198, v198
    s_waitcnt lgkmcnt(3)
    v_mfma_f32_16x16x32_bf16 v[208:211], v[244:247], v[164:167], v[208:211]
    v_exp_f32 v199, v199
    v_cvt_pk_bf16_f32 v62, v196, v197
    v_mfma_f32_16x16x32_bf16 v[212:215], v[244:247], v[180:183], v[212:215]
    ds_read_b128 v[236:239], v4 offset:52224
    v_cvt_pk_bf16_f32 v63, v198, v199
    s_waitcnt lgkmcnt(3)
    v_mfma_f32_16x16x32_bf16 v[184:187], v[224:227], v[152:155], v[216:219]
    v_mfma_f32_16x16x32_bf16 v[188:191], v[224:227], v[168:171], v[220:223]
    ds_read_b128 v[240:243], v4 offset:53248
    v_exp_f32 v200, v200
    v_exp_f32 v201, v201
    v_mfma_f32_16x16x32_bf16 v[248:251], v[12:15], v[56:59], v[248:251]
    s_waitcnt lgkmcnt(3)
    v_mfma_f32_16x16x32_bf16 v[192:195], v[228:231], v[152:155], v[216:219]
    v_exp_f32 v202, v202
    v_exp_f32 v203, v203
    v_mfma_f32_16x16x32_bf16 v[196:199], v[228:231], v[168:171], v[220:223]
    s_add_u32 s22, s21, 0x1c400
    s_add_u32 m0, s20, 0x14400
    s_nop 0
    buffer_load_dwordx4 v2, s[8:11], s22 offen sc1 lds
    ds_read_b128 v[244:247], v4 offset:54272
    v_cvt_pk_bf16_f32 v64, v200, v201
    v_mfma_f32_16x16x32_bf16 v[252:255], v[12:15], v[60:63], v[252:255]
    s_waitcnt lgkmcnt(3)
    v_mfma_f32_16x16x32_bf16 v[184:187], v[232:235], v[156:159], v[184:187]
    v_exp_f32 v204, v204
    v_exp_f32 v205, v205
    v_mfma_f32_16x16x32_bf16 v[188:191], v[232:235], v[172:175], v[188:191]
    ds_read_b128 v[224:227], v4 offset:55296
    v_cvt_pk_bf16_f32 v65, v202, v203
    s_waitcnt lgkmcnt(3)
    v_mfma_f32_16x16x32_bf16 v[192:195], v[236:239], v[156:159], v[192:195]
    v_exp_f32 v206, v206
    v_exp_f32 v207, v207
    v_mfma_f32_16x16x32_bf16 v[196:199], v[236:239], v[172:175], v[196:199]
    ds_read_b128 v[228:231], v4 offset:56320
    v_cvt_pk_bf16_f32 v68, v204, v205
    v_exp_f32 v208, v208
    s_waitcnt lgkmcnt(3)
    v_mfma_f32_16x16x32_bf16 v[184:187], v[240:243], v[160:163], v[184:187]
    v_exp_f32 v209, v209
    v_mfma_f32_16x16x32_bf16 v[188:191], v[240:243], v[176:179], v[188:191]
    ds_read_b128 v[232:235], v4 offset:57344
    v_cvt_pk_bf16_f32 v69, v206, v207
    v_exp_f32 v210, v210
    s_waitcnt lgkmcnt(3)
    v_mfma_f32_16x16x32_bf16 v[192:195], v[244:247], v[160:163], v[192:195]
    v_exp_f32 v211, v211
    v_mfma_f32_16x16x32_bf16 v[196:199], v[244:247], v[176:179], v[196:199]
    ds_read_b128 v[236:239], v4 offset:58368
    v_cvt_pk_bf16_f32 v66, v208, v209
    v_exp_f32 v212, v212
    s_waitcnt lgkmcnt(3)
    v_mfma_f32_16x16x32_bf16 v[184:187], v[224:227], v[164:167], v[184:187]
    v_exp_f32 v213, v213
    v_cvt_pk_bf16_f32 v67, v210, v211
    v_mfma_f32_16x16x32_bf16 v[188:191], v[224:227], v[180:183], v[188:191]
    ds_read_b128 v[240:243], v4 offset:59392
    v_exp_f32 v214, v214
    s_waitcnt lgkmcnt(3)
    v_mfma_f32_16x16x32_bf16 v[192:195], v[228:231], v[164:167], v[192:195]
    v_exp_f32 v215, v215
    v_cvt_pk_bf16_f32 v70, v212, v213
    v_mfma_f32_16x16x32_bf16 v[196:199], v[228:231], v[180:183], v[196:199]
    ds_read_b128 v[244:247], v4 offset:60416
    v_cvt_pk_bf16_f32 v71, v214, v215
    s_waitcnt lgkmcnt(3)
    v_mfma_f32_16x16x32_bf16 v[200:203], v[232:235], v[152:155], v[216:219]
    v_mfma_f32_16x16x32_bf16 v[204:207], v[232:235], v[168:171], v[220:223]
    ds_read_b128 v[224:227], v4 offset:61440
    v_exp_f32 v184, v184
    v_exp_f32 v185, v185
    v_mfma_f32_16x16x32_bf16 v[248:251], v[12:15], v[64:67], v[248:251]
    s_waitcnt lgkmcnt(3)
    v_mfma_f32_16x16x32_bf16 v[208:211], v[236:239], v[152:155], v[216:219]
    v_exp_f32 v186, v186
    v_exp_f32 v187, v187
    v_mfma_f32_16x16x32_bf16 v[212:215], v[236:239], v[168:171], v[220:223]
    ds_read_b128 v[228:231], v4 offset:62464
    v_cvt_pk_bf16_f32 v72, v184, v185
    v_mfma_f32_16x16x32_bf16 v[252:255], v[12:15], v[68:71], v[252:255]
    s_waitcnt lgkmcnt(3)
    v_mfma_f32_16x16x32_bf16 v[200:203], v[240:243], v[156:159], v[200:203]
    v_exp_f32 v188, v188
    v_exp_f32 v189, v189
    v_mfma_f32_16x16x32_bf16 v[204:207], v[240:243], v[172:175], v[204:207]
    ds_read_b128 v[232:235], v4 offset:63488
    v_cvt_pk_bf16_f32 v73, v186, v187
    s_waitcnt lgkmcnt(3)
    v_mfma_f32_16x16x32_bf16 v[208:211], v[244:247], v[156:159], v[208:211]
    v_exp_f32 v190, v190
    v_exp_f32 v191, v191
    v_mfma_f32_16x16x32_bf16 v[212:215], v[244:247], v[172:175], v[212:215]
    ds_read_b128 v[236:239], v4 offset:64512
    v_cvt_pk_bf16_f32 v76, v188, v189
    v_exp_f32 v192, v192
    s_waitcnt lgkmcnt(3)
    v_mfma_f32_16x16x32_bf16 v[200:203], v[224:227], v[160:163], v[200:203]
    v_exp_f32 v193, v193
    v_mfma_f32_16x16x32_bf16 v[204:207], v[224:227], v[176:179], v[204:207]
    s_waitcnt vmcnt(7)
    s_barrier
    ds_read_b128 v[240:243], v5 offset:0
    v_cvt_pk_bf16_f32 v77, v190, v191
    v_exp_f32 v194, v194
    s_waitcnt lgkmcnt(3)
    v_mfma_f32_16x16x32_bf16 v[208:211], v[228:231], v[160:163], v[208:211]
    v_exp_f32 v195, v195
    v_mfma_f32_16x16x32_bf16 v[212:215], v[228:231], v[176:179], v[212:215]
    s_add_u32 s22, s21, 0x80000
    s_add_u32 m0, s20, 0x18000
    s_nop 0
    buffer_load_dwordx4 v2, s[8:11], s22 offen sc1 lds
    ds_read_b128 v[244:247], v5 offset:1024
    v_cvt_pk_bf16_f32 v74, v192, v193
    v_exp_f32 v196, v196
    s_waitcnt lgkmcnt(3)
    v_mfma_f32_16x16x32_bf16 v[200:203], v[232:235], v[164:167], v[200:203]
    v_exp_f32 v197, v197
    v_cvt_pk_bf16_f32 v75, v194, v195
    v_mfma_f32_16x16x32_bf16 v[204:207], v[232:235], v[180:183], v[204:207]
    ds_read_b128 v[224:227], v5 offset:2048
    v_exp_f32 v198, v198
    s_waitcnt lgkmcnt(3)
    v_mfma_f32_16x16x32_bf16 v[208:211], v[236:239], v[164:167], v[208:211]
    v_exp_f32 v199, v199
    v_cvt_pk_bf16_f32 v78, v196, v197
    v_mfma_f32_16x16x32_bf16 v[212:215], v[236:239], v[180:183], v[212:215]
    ds_read_b128 v[228:231], v5 offset:3072
    v_cvt_pk_bf16_f32 v79, v198, v199
    s_waitcnt lgkmcnt(3)
    v_mfma_f32_16x16x32_bf16 v[184:187], v[240:243], v[152:155], v[216:219]
    v_mfma_f32_16x16x32_bf16 v[188:191], v[240:243], v[168:171], v[220:223]
    ds_read_b128 v[232:235], v5 offset:4096
    v_exp_f32 v200, v200
    v_exp_f32 v201, v201
    v_mfma_f32_16x16x32_bf16 v[248:251], v[12:15], v[72:75], v[248:251]
    s_waitcnt lgkmcnt(3)
    v_mfma_f32_16x16x32_bf16 v[192:195], v[244:247], v[152:155], v[216:219]
    v_exp_f32 v202, v202
    v_exp_f32 v203, v203
    v_mfma_f32_16x16x32_bf16 v[196:199], v[244:247], v[168:171], v[220:223]
    s_add_u32 s22, s21, 0x80400
    s_add_u32 m0, s20, 0x18400
    s_nop 0
    buffer_load_dwordx4 v2, s[8:11], s22 offen sc1 lds
    ds_read_b128 v[236:239], v5 offset:5120
    v_cvt_pk_bf16_f32 v80, v200, v201
    v_mfma_f32_16x16x32_bf16 v[252:255], v[12:15], v[76:79], v[252:255]
    s_waitcnt lgkmcnt(3)
    v_mfma_f32_16x16x32_bf16 v[184:187], v[224:227], v[156:159], v[184:187]
    v_exp_f32 v204, v204
    v_exp_f32 v205, v205
    s_add_u32 s22, s18, 0
    s_add_u32 m0, s15, 0
    s_nop 0
    buffer_load_dwordx4 v11, s[64:67], s22 offen lds
    v_mfma_f32_16x16x32_bf16 v[188:191], v[224:227], v[172:175], v[188:191]
    ds_read_b128 v[240:243], v5 offset:6144
    v_cvt_pk_bf16_f32 v81, v202, v203
    s_waitcnt lgkmcnt(3)
    v_mfma_f32_16x16x32_bf16 v[192:195], v[228:231], v[156:159], v[192:195]
    v_exp_f32 v206, v206
    v_exp_f32 v207, v207
    v_mfma_f32_16x16x32_bf16 v[196:199], v[228:231], v[172:175], v[196:199]
    ds_read_b128 v[244:247], v5 offset:7168
    v_cvt_pk_bf16_f32 v84, v204, v205
    v_exp_f32 v208, v208
    s_waitcnt lgkmcnt(3)
    v_mfma_f32_16x16x32_bf16 v[184:187], v[232:235], v[160:163], v[184:187]
    v_exp_f32 v209, v209
    v_mfma_f32_16x16x32_bf16 v[188:191], v[232:235], v[176:179], v[188:191]
    ds_read_b128 v[224:227], v5 offset:8192
    v_cvt_pk_bf16_f32 v85, v206, v207
    v_exp_f32 v210, v210
    s_waitcnt lgkmcnt(3)
    v_mfma_f32_16x16x32_bf16 v[192:195], v[236:239], v[160:163], v[192:195]
    v_exp_f32 v211, v211
    v_mfma_f32_16x16x32_bf16 v[196:199], v[236:239], v[176:179], v[196:199]
    ds_read_b128 v[228:231], v5 offset:9216
    v_cvt_pk_bf16_f32 v82, v208, v209
    v_exp_f32 v212, v212
    s_waitcnt lgkmcnt(3)
    v_mfma_f32_16x16x32_bf16 v[184:187], v[240:243], v[164:167], v[184:187]
    v_exp_f32 v213, v213
    v_cvt_pk_bf16_f32 v83, v210, v211
    v_mfma_f32_16x16x32_bf16 v[188:191], v[240:243], v[180:183], v[188:191]
    ds_read_b128 v[232:235], v5 offset:10240
    v_exp_f32 v214, v214
    s_waitcnt lgkmcnt(3)
    v_mfma_f32_16x16x32_bf16 v[192:195], v[244:247], v[164:167], v[192:195]
    v_exp_f32 v215, v215
    v_cvt_pk_bf16_f32 v86, v212, v213
    v_mfma_f32_16x16x32_bf16 v[196:199], v[244:247], v[180:183], v[196:199]
    ds_read_b128 v[236:239], v5 offset:11264
    v_cvt_pk_bf16_f32 v87, v214, v215
    s_waitcnt lgkmcnt(3)
    v_mfma_f32_16x16x32_bf16 v[200:203], v[224:227], v[152:155], v[216:219]
    v_mfma_f32_16x16x32_bf16 v[204:207], v[224:227], v[168:171], v[220:223]
    ds_read_b128 v[240:243], v5 offset:12288
    v_exp_f32 v184, v184
    v_exp_f32 v185, v185
    v_mfma_f32_16x16x32_bf16 v[248:251], v[12:15], v[80:83], v[248:251]
    s_waitcnt lgkmcnt(3)
    v_mfma_f32_16x16x32_bf16 v[208:211], v[228:231], v[152:155], v[216:219]
    v_exp_f32 v186, v186
    v_exp_f32 v187, v187
    v_mfma_f32_16x16x32_bf16 v[212:215], v[228:231], v[168:171], v[220:223]
    ds_read_b128 v[244:247], v5 offset:13312
    v_cvt_pk_bf16_f32 v88, v184, v185
    s_add_u32 s22, s18, 7168
    s_add_u32 m0, s15, 1024
    s_nop 0
    buffer_load_dwordx4 v11, s[64:67], s22 offen lds
    v_mfma_f32_16x16x32_bf16 v[252:255], v[12:15], v[84:87], v[252:255]
    s_waitcnt lgkmcnt(3)
    v_mfma_f32_16x16x32_bf16 v[200:203], v[232:235], v[156:159], v[200:203]
    v_exp_f32 v188, v188
    v_exp_f32 v189, v189
    v_mfma_f32_16x16x32_bf16 v[204:207], v[232:235], v[172:175], v[204:207]
    ds_read_b128 v[224:227], v5 offset:14336
    v_cvt_pk_bf16_f32 v89, v186, v187
    s_waitcnt lgkmcnt(3)
    v_mfma_f32_16x16x32_bf16 v[208:211], v[236:239], v[156:159], v[208:211]
    v_exp_f32 v190, v190
    v_exp_f32 v191, v191
    v_mfma_f32_16x16x32_bf16 v[212:215], v[236:239], v[172:175], v[212:215]
    ds_read_b128 v[228:231], v5 offset:15360
    v_cvt_pk_bf16_f32 v92, v188, v189
    v_exp_f32 v192, v192
    s_waitcnt lgkmcnt(3)
    v_mfma_f32_16x16x32_bf16 v[200:203], v[240:243], v[160:163], v[200:203]
    v_exp_f32 v193, v193
    v_mfma_f32_16x16x32_bf16 v[204:207], v[240:243], v[176:179], v[204:207]
    s_waitcnt vmcnt(8)
    s_barrier
    ds_read_b128 v[232:235], v5 offset:16384
    v_cvt_pk_bf16_f32 v93, v190, v191
    v_exp_f32 v194, v194
    s_waitcnt lgkmcnt(3)
    v_mfma_f32_16x16x32_bf16 v[208:211], v[244:247], v[160:163], v[208:211]
    v_exp_f32 v195, v195
    v_mfma_f32_16x16x32_bf16 v[212:215], v[244:247], v[176:179], v[212:215]
    s_add_u32 s22, s21, 0x84000
    s_add_u32 m0, s20, 0x1c000
    s_nop 0
    buffer_load_dwordx4 v2, s[8:11], s22 offen sc1 lds
    ds_read_b128 v[236:239], v5 offset:17408
    v_cvt_pk_bf16_f32 v90, v192, v193
    v_exp_f32 v196, v196
    s_waitcnt lgkmcnt(3)
    v_mfma_f32_16x16x32_bf16 v[200:203], v[224:227], v[164:167], v[200:203]
    v_exp_f32 v197, v197
    v_cvt_pk_bf16_f32 v91, v194, v195
    v_mfma_f32_16x16x32_bf16 v[204:207], v[224:227], v[180:183], v[204:207]
    ds_read_b128 v[240:243], v5 offset:18432
    v_exp_f32 v198, v198
    s_waitcnt lgkmcnt(3)
    v_mfma_f32_16x16x32_bf16 v[208:211], v[228:231], v[164:167], v[208:211]
    v_exp_f32 v199, v199
    v_cvt_pk_bf16_f32 v94, v196, v197
    v_mfma_f32_16x16x32_bf16 v[212:215], v[228:231], v[180:183], v[212:215]
    ds_read_b128 v[244:247], v5 offset:19456
    v_cvt_pk_bf16_f32 v95, v198, v199
    s_waitcnt lgkmcnt(3)
    v_mfma_f32_16x16x32_bf16 v[184:187], v[232:235], v[152:155], v[216:219]
    v_mfma_f32_16x16x32_bf16 v[188:191], v[232:235], v[168:171], v[220:223]
    ds_read_b128 v[224:227], v5 offset:20480
    v_exp_f32 v200, v200
    v_exp_f32 v201, v201
    v_mfma_f32_16x16x32_bf16 v[248:251], v[12:15], v[88:91], v[248:251]
    s_waitcnt lgkmcnt(3)
    v_mfma_f32_16x16x32_bf16 v[192:195], v[236:239], v[152:155], v[216:219]
    v_exp_f32 v202, v202
    v_exp_f32 v203, v203
    v_mfma_f32_16x16x32_bf16 v[196:199], v[236:239], v[168:171], v[220:223]
    s_add_u32 s22, s21, 0x84400
    s_add_u32 m0, s20, 0x1c400
    s_nop 0
    buffer_load_dwordx4 v2, s[8:11], s22 offen sc1 lds
    ds_read_b128 v[228:231], v5 offset:21504
    v_cvt_pk_bf16_f32 v96, v200, v201
    s_add_u32 s22, s18, 14336
    s_add_u32 m0, s15, 2048
    s_nop 0
    buffer_load_dwordx4 v11, s[64:67], s22 offen lds
    v_mfma_f32_16x16x32_bf16 v[252:255], v[12:15], v[92:95], v[252:255]
    s_waitcnt lgkmcnt(3)
    v_mfma_f32_16x16x32_bf16 v[184:187], v[240:243], v[156:159], v[184:187]
    v_exp_f32 v204, v204
    v_exp_f32 v205, v205
    v_mfma_f32_16x16x32_bf16 v[188:191], v[240:243], v[172:175], v[188:191]
    ds_read_b128 v[232:235], v5 offset:22528
    v_cvt_pk_bf16_f32 v97, v202, v203
    s_waitcnt lgkmcnt(3)
    v_mfma_f32_16x16x32_bf16 v[192:195], v[244:247], v[156:159], v[192:195]
    v_exp_f32 v206, v206
    v_exp_f32 v207, v207
    v_mfma_f32_16x16x32_bf16 v[196:199], v[244:247], v[172:175], v[196:199]
    ds_read_b128 v[236:239], v5 offset:23552
    v_cvt_pk_bf16_f32 v100, v204, v205
    v_exp_f32 v208, v208
    s_waitcnt lgkmcnt(3)
    v_mfma_f32_16x16x32_bf16 v[184:187], v[224:227], v[160:163], v[184:187]
    v_exp_f32 v209, v209
    v_mfma_f32_16x16x32_bf16 v[188:191], v[224:227], v[176:179], v[188:191]
    ds_read_b128 v[240:243], v5 offset:24576
    v_cvt_pk_bf16_f32 v101, v206, v207
    v_exp_f32 v210, v210
    s_waitcnt lgkmcnt(3)
    v_mfma_f32_16x16x32_bf16 v[192:195], v[228:231], v[160:163], v[192:195]
    v_exp_f32 v211, v211
    v_mfma_f32_16x16x32_bf16 v[196:199], v[228:231], v[176:179], v[196:199]
    ds_read_b128 v[244:247], v5 offset:25600
    v_cvt_pk_bf16_f32 v98, v208, v209
    v_exp_f32 v212, v212
    s_waitcnt lgkmcnt(3)
    v_mfma_f32_16x16x32_bf16 v[184:187], v[232:235], v[164:167], v[184:187]
    v_exp_f32 v213, v213
    v_cvt_pk_bf16_f32 v99, v210, v211
    v_mfma_f32_16x16x32_bf16 v[188:191], v[232:235], v[180:183], v[188:191]
    ds_read_b128 v[224:227], v5 offset:26624
    v_exp_f32 v214, v214
    s_waitcnt lgkmcnt(3)
    v_mfma_f32_16x16x32_bf16 v[192:195], v[236:239], v[164:167], v[192:195]
    v_exp_f32 v215, v215
    v_cvt_pk_bf16_f32 v102, v212, v213
    v_mfma_f32_16x16x32_bf16 v[196:199], v[236:239], v[180:183], v[196:199]
    ds_read_b128 v[228:231], v5 offset:27648
    v_cvt_pk_bf16_f32 v103, v214, v215
    s_waitcnt lgkmcnt(3)
    v_mfma_f32_16x16x32_bf16 v[200:203], v[240:243], v[152:155], v[216:219]
    v_mfma_f32_16x16x32_bf16 v[204:207], v[240:243], v[168:171], v[220:223]
    ds_read_b128 v[232:235], v5 offset:28672
    v_exp_f32 v184, v184
    v_exp_f32 v185, v185
    v_mfma_f32_16x16x32_bf16 v[248:251], v[12:15], v[96:99], v[248:251]
    s_waitcnt lgkmcnt(3)
    v_mfma_f32_16x16x32_bf16 v[208:211], v[244:247], v[152:155], v[216:219]
    v_exp_f32 v186, v186
    v_exp_f32 v187, v187
    s_add_u32 s22, s18, 21504
    s_add_u32 m0, s15, 3072
    s_nop 0
    buffer_load_dwordx4 v11, s[64:67], s22 offen lds
    v_mfma_f32_16x16x32_bf16 v[212:215], v[244:247], v[168:171], v[220:223]
    ds_read_b128 v[236:239], v5 offset:29696
    v_cvt_pk_bf16_f32 v104, v184, v185
    v_mfma_f32_16x16x32_bf16 v[252:255], v[12:15], v[100:103], v[252:255]
    s_waitcnt lgkmcnt(3)
    v_mfma_f32_16x16x32_bf16 v[200:203], v[224:227], v[156:159], v[200:203]
    v_exp_f32 v188, v188
    v_exp_f32 v189, v189
    v_mfma_f32_16x16x32_bf16 v[204:207], v[224:227], v[172:175], v[204:207]
    ds_read_b128 v[240:243], v5 offset:30720
    v_cvt_pk_bf16_f32 v105, v186, v187
    s_waitcnt lgkmcnt(3)
    v_mfma_f32_16x16x32_bf16 v[208:211], v[228:231], v[156:159], v[208:211]
    v_exp_f32 v190, v190
    v_exp_f32 v191, v191
    v_mfma_f32_16x16x32_bf16 v[212:215], v[228:231], v[172:175], v[212:215]
    ds_read_b128 v[244:247], v5 offset:31744
    v_cvt_pk_bf16_f32 v108, v188, v189
    v_exp_f32 v192, v192
    s_waitcnt lgkmcnt(3)
    v_mfma_f32_16x16x32_bf16 v[200:203], v[232:235], v[160:163], v[200:203]
    v_exp_f32 v193, v193
    v_mfma_f32_16x16x32_bf16 v[204:207], v[232:235], v[176:179], v[204:207]
    s_waitcnt vmcnt(10)
    s_barrier
    ds_read_b128 v[224:227], v4 offset:0
    v_cvt_pk_bf16_f32 v109, v190, v191
    v_exp_f32 v194, v194
    s_waitcnt lgkmcnt(3)
    v_mfma_f32_16x16x32_bf16 v[208:211], v[236:239], v[160:163], v[208:211]
    v_exp_f32 v195, v195
    v_mfma_f32_16x16x32_bf16 v[212:215], v[236:239], v[176:179], v[212:215]
    s_add_u32 s22, s21, 0x88000
    s_add_u32 m0, s20, 0x20000
    s_nop 0
    buffer_load_dwordx4 v2, s[8:11], s22 offen sc1 lds
    ds_read_b128 v[228:231], v4 offset:1024
    v_cvt_pk_bf16_f32 v106, v192, v193
    v_exp_f32 v196, v196
    s_waitcnt lgkmcnt(3)
    v_mfma_f32_16x16x32_bf16 v[200:203], v[240:243], v[164:167], v[200:203]
    v_exp_f32 v197, v197
    v_cvt_pk_bf16_f32 v107, v194, v195
    v_mfma_f32_16x16x32_bf16 v[204:207], v[240:243], v[180:183], v[204:207]
    ds_read_b128 v[232:235], v4 offset:2048
    v_exp_f32 v198, v198
    s_waitcnt lgkmcnt(3)
    v_mfma_f32_16x16x32_bf16 v[208:211], v[244:247], v[164:167], v[208:211]
    v_exp_f32 v199, v199
    v_cvt_pk_bf16_f32 v110, v196, v197
    v_mfma_f32_16x16x32_bf16 v[212:215], v[244:247], v[180:183], v[212:215]
    ds_read_b128 v[236:239], v4 offset:3072
    v_cvt_pk_bf16_f32 v111, v198, v199
    s_waitcnt lgkmcnt(3)
    v_mfma_f32_16x16x32_bf16 v[184:187], v[224:227], v[152:155], v[216:219]
    v_mfma_f32_16x16x32_bf16 v[188:191], v[224:227], v[168:171], v[220:223]
    ds_read_b128 v[240:243], v4 offset:4096
    v_exp_f32 v200, v200
    v_exp_f32 v201, v201
    v_mfma_f32_16x16x32_bf16 v[248:251], v[12:15], v[104:107], v[248:251]
    s_waitcnt lgkmcnt(3)
    v_mfma_f32_16x16x32_bf16 v[192:195], v[228:231], v[152:155], v[216:219]
    v_exp_f32 v202, v202
    v_exp_f32 v203, v203
    s_add_u32 s22, s18, 28672
    s_add_u32 m0, s15, 4096
    s_nop 0
    buffer_load_dwordx4 v11, s[64:67], s22 offen lds
    v_mfma_f32_16x16x32_bf16 v[196:199], v[228:231], v[168:171], v[220:223]
    s_add_u32 s22, s21, 0x88400
    s_add_u32 m0, s20, 0x20400
    s_nop 0
    buffer_load_dwordx4 v2, s[8:11], s22 offen sc1 lds
    ds_read_b128 v[244:247], v4 offset:5120
    v_cvt_pk_bf16_f32 v112, v200, v201
    v_mfma_f32_16x16x32_bf16 v[252:255], v[12:15], v[108:111], v[252:255]
    s_waitcnt lgkmcnt(3)
    v_mfma_f32_16x16x32_bf16 v[184:187], v[232:235], v[156:159], v[184:187]
    v_exp_f32 v204, v204
    v_exp_f32 v205, v205
    v_mfma_f32_16x16x32_bf16 v[188:191], v[232:235], v[172:175], v[188:191]
    ds_read_b128 v[224:227], v4 offset:6144
    v_cvt_pk_bf16_f32 v113, v202, v203
    s_waitcnt lgkmcnt(3)
    v_mfma_f32_16x16x32_bf16 v[192:195], v[236:239], v[156:159], v[192:195]
    v_exp_f32 v206, v206
    v_exp_f32 v207, v207
    v_mfma_f32_16x16x32_bf16 v[196:199], v[236:239], v[172:175], v[196:199]
    ds_read_b128 v[228:231], v4 offset:7168
    v_cvt_pk_bf16_f32 v116, v204, v205
    v_exp_f32 v208, v208
    s_waitcnt lgkmcnt(3)
    v_mfma_f32_16x16x32_bf16 v[184:187], v[240:243], v[160:163], v[184:187]
    v_exp_f32 v209, v209
    v_mfma_f32_16x16x32_bf16 v[188:191], v[240:243], v[176:179], v[188:191]
    ds_read_b128 v[232:235], v4 offset:8192
    v_cvt_pk_bf16_f32 v117, v206, v207
    v_exp_f32 v210, v210
    s_waitcnt lgkmcnt(3)
    v_mfma_f32_16x16x32_bf16 v[192:195], v[244:247], v[160:163], v[192:195]
    v_exp_f32 v211, v211
    v_mfma_f32_16x16x32_bf16 v[196:199], v[244:247], v[176:179], v[196:199]
    ds_read_b128 v[236:239], v4 offset:9216
    v_cvt_pk_bf16_f32 v114, v208, v209
    v_exp_f32 v212, v212
    s_waitcnt lgkmcnt(3)
    v_mfma_f32_16x16x32_bf16 v[184:187], v[224:227], v[164:167], v[184:187]
    v_exp_f32 v213, v213
    v_cvt_pk_bf16_f32 v115, v210, v211
    v_mfma_f32_16x16x32_bf16 v[188:191], v[224:227], v[180:183], v[188:191]
    ds_read_b128 v[240:243], v4 offset:10240
    v_exp_f32 v214, v214
    s_waitcnt lgkmcnt(3)
    v_mfma_f32_16x16x32_bf16 v[192:195], v[228:231], v[164:167], v[192:195]
    v_exp_f32 v215, v215
    v_cvt_pk_bf16_f32 v118, v212, v213
    v_mfma_f32_16x16x32_bf16 v[196:199], v[228:231], v[180:183], v[196:199]
    ds_read_b128 v[244:247], v4 offset:11264
    v_cvt_pk_bf16_f32 v119, v214, v215
    s_waitcnt lgkmcnt(3)
    v_mfma_f32_16x16x32_bf16 v[200:203], v[232:235], v[152:155], v[216:219]
    v_mfma_f32_16x16x32_bf16 v[204:207], v[232:235], v[168:171], v[220:223]
    ds_read_b128 v[224:227], v4 offset:12288
    v_exp_f32 v184, v184
    v_exp_f32 v185, v185
    s_add_u32 s22, s18, 35840
    s_add_u32 m0, s15, 5120
    s_nop 0
    buffer_load_dwordx4 v11, s[64:67], s22 offen lds
    v_mfma_f32_16x16x32_bf16 v[248:251], v[12:15], v[112:115], v[248:251]
    s_waitcnt lgkmcnt(3)
    v_mfma_f32_16x16x32_bf16 v[208:211], v[236:239], v[152:155], v[216:219]
    v_exp_f32 v186, v186
    v_exp_f32 v187, v187
    v_mfma_f32_16x16x32_bf16 v[212:215], v[236:239], v[168:171], v[220:223]
    ds_read_b128 v[228:231], v4 offset:13312
    v_cvt_pk_bf16_f32 v120, v184, v185
    v_mfma_f32_16x16x32_bf16 v[252:255], v[12:15], v[116:119], v[252:255]
    s_waitcnt lgkmcnt(3)
    v_mfma_f32_16x16x32_bf16 v[200:203], v[240:243], v[156:159], v[200:203]
    v_exp_f32 v188, v188
    v_exp_f32 v189, v189
    v_mfma_f32_16x16x32_bf16 v[204:207], v[240:243], v[172:175], v[204:207]
    ds_read_b128 v[232:235], v4 offset:14336
    v_cvt_pk_bf16_f32 v121, v186, v187
    s_waitcnt lgkmcnt(3)
    v_mfma_f32_16x16x32_bf16 v[208:211], v[244:247], v[156:159], v[208:211]
    v_exp_f32 v190, v190
    v_exp_f32 v191, v191
    v_mfma_f32_16x16x32_bf16 v[212:215], v[244:247], v[172:175], v[212:215]
    ds_read_b128 v[236:239], v4 offset:15360
    v_cvt_pk_bf16_f32 v124, v188, v189
    v_exp_f32 v192, v192
    s_waitcnt lgkmcnt(3)
    v_mfma_f32_16x16x32_bf16 v[200:203], v[224:227], v[160:163], v[200:203]
    v_exp_f32 v193, v193
    v_mfma_f32_16x16x32_bf16 v[204:207], v[224:227], v[176:179], v[204:207]
    s_waitcnt vmcnt(12)
    s_barrier
    ds_read_b128 v[240:243], v4 offset:16384
    v_cvt_pk_bf16_f32 v125, v190, v191
    v_exp_f32 v194, v194
    s_waitcnt lgkmcnt(3)
    v_mfma_f32_16x16x32_bf16 v[208:211], v[228:231], v[160:163], v[208:211]
    v_exp_f32 v195, v195
    v_mfma_f32_16x16x32_bf16 v[212:215], v[228:231], v[176:179], v[212:215]
    s_add_u32 s22, s21, 0x8c000
    s_add_u32 m0, s20, 0x24000
    s_nop 0
    buffer_load_dwordx4 v2, s[8:11], s22 offen sc1 lds
    ds_read_b128 v[244:247], v4 offset:17408
    v_cvt_pk_bf16_f32 v122, v192, v193
    v_exp_f32 v196, v196
    s_waitcnt lgkmcnt(3)
    v_mfma_f32_16x16x32_bf16 v[200:203], v[232:235], v[164:167], v[200:203]
    v_exp_f32 v197, v197
    v_cvt_pk_bf16_f32 v123, v194, v195
    v_mfma_f32_16x16x32_bf16 v[204:207], v[232:235], v[180:183], v[204:207]
    ds_read_b128 v[224:227], v4 offset:18432
    v_exp_f32 v198, v198
    s_waitcnt lgkmcnt(3)
    v_mfma_f32_16x16x32_bf16 v[208:211], v[236:239], v[164:167], v[208:211]
    v_exp_f32 v199, v199
    v_cvt_pk_bf16_f32 v126, v196, v197
    v_mfma_f32_16x16x32_bf16 v[212:215], v[236:239], v[180:183], v[212:215]
    ds_read_b128 v[228:231], v4 offset:19456
    v_cvt_pk_bf16_f32 v127, v198, v199
    s_waitcnt lgkmcnt(3)
    v_mfma_f32_16x16x32_bf16 v[184:187], v[240:243], v[152:155], v[216:219]
    v_mfma_f32_16x16x32_bf16 v[188:191], v[240:243], v[168:171], v[220:223]
    ds_read_b128 v[232:235], v4 offset:20480
    v_exp_f32 v200, v200
    v_exp_f32 v201, v201
    s_add_u32 s22, s18, 43008
    s_add_u32 m0, s15, 6144
    s_nop 0
    buffer_load_dwordx4 v11, s[64:67], s22 offen lds
    v_mfma_f32_16x16x32_bf16 v[248:251], v[12:15], v[120:123], v[248:251]
    s_waitcnt lgkmcnt(3)
    v_mfma_f32_16x16x32_bf16 v[192:195], v[244:247], v[152:155], v[216:219]
    v_exp_f32 v202, v202
    v_exp_f32 v203, v203
    v_mfma_f32_16x16x32_bf16 v[196:199], v[244:247], v[168:171], v[220:223]
    s_add_u32 s22, s21, 0x8c400
    s_add_u32 m0, s20, 0x24400
    s_nop 0
    buffer_load_dwordx4 v2, s[8:11], s22 offen sc1 lds
    ds_read_b128 v[236:239], v4 offset:21504
    v_cvt_pk_bf16_f32 v128, v200, v201
    v_mfma_f32_16x16x32_bf16 v[252:255], v[12:15], v[124:127], v[252:255]
    s_waitcnt lgkmcnt(3)
    v_mfma_f32_16x16x32_bf16 v[184:187], v[224:227], v[156:159], v[184:187]
    v_exp_f32 v204, v204
    v_exp_f32 v205, v205
    v_mfma_f32_16x16x32_bf16 v[188:191], v[224:227], v[172:175], v[188:191]
    ds_read_b128 v[240:243], v4 offset:22528
    v_cvt_pk_bf16_f32 v129, v202, v203
    s_waitcnt lgkmcnt(3)
    v_mfma_f32_16x16x32_bf16 v[192:195], v[228:231], v[156:159], v[192:195]
    v_exp_f32 v206, v206
    v_exp_f32 v207, v207
    v_mfma_f32_16x16x32_bf16 v[196:199], v[228:231], v[172:175], v[196:199]
    ds_read_b128 v[244:247], v4 offset:23552
    v_cvt_pk_bf16_f32 v132, v204, v205
    v_exp_f32 v208, v208
    s_waitcnt lgkmcnt(3)
    v_mfma_f32_16x16x32_bf16 v[184:187], v[232:235], v[160:163], v[184:187]
    v_exp_f32 v209, v209
    v_mfma_f32_16x16x32_bf16 v[188:191], v[232:235], v[176:179], v[188:191]
    ds_read_b128 v[224:227], v4 offset:24576
    v_cvt_pk_bf16_f32 v133, v206, v207
    v_exp_f32 v210, v210
    s_waitcnt lgkmcnt(3)
    v_mfma_f32_16x16x32_bf16 v[192:195], v[236:239], v[160:163], v[192:195]
    v_exp_f32 v211, v211
    v_mfma_f32_16x16x32_bf16 v[196:199], v[236:239], v[176:179], v[196:199]
    ds_read_b128 v[228:231], v4 offset:25600
    v_cvt_pk_bf16_f32 v130, v208, v209
    v_exp_f32 v212, v212
    s_waitcnt lgkmcnt(3)
    v_mfma_f32_16x16x32_bf16 v[184:187], v[240:243], v[164:167], v[184:187]
    v_exp_f32 v213, v213
    v_cvt_pk_bf16_f32 v131, v210, v211
    v_mfma_f32_16x16x32_bf16 v[188:191], v[240:243], v[180:183], v[188:191]
    ds_read_b128 v[232:235], v4 offset:26624
    v_exp_f32 v214, v214
    s_waitcnt lgkmcnt(3)
    v_mfma_f32_16x16x32_bf16 v[192:195], v[244:247], v[164:167], v[192:195]
    v_exp_f32 v215, v215
    v_cvt_pk_bf16_f32 v134, v212, v213
    v_mfma_f32_16x16x32_bf16 v[196:199], v[244:247], v[180:183], v[196:199]
    ds_read_b128 v[236:239], v4 offset:27648
    v_cvt_pk_bf16_f32 v135, v214, v215
    s_waitcnt lgkmcnt(3)
    v_mfma_f32_16x16x32_bf16 v[200:203], v[224:227], v[152:155], v[216:219]
    s_add_u32 s22, s18, 50176
    s_add_u32 m0, s15, 7168
    s_nop 0
    buffer_load_dwordx4 v11, s[64:67], s22 offen lds
    v_mfma_f32_16x16x32_bf16 v[204:207], v[224:227], v[168:171], v[220:223]
    ds_read_b128 v[240:243], v4 offset:28672
    v_exp_f32 v184, v184
    v_exp_f32 v185, v185
    v_mfma_f32_16x16x32_bf16 v[248:251], v[12:15], v[128:131], v[248:251]
    s_waitcnt lgkmcnt(3)
    v_mfma_f32_16x16x32_bf16 v[208:211], v[228:231], v[152:155], v[216:219]
    v_exp_f32 v186, v186
    v_exp_f32 v187, v187
    v_mfma_f32_16x16x32_bf16 v[212:215], v[228:231], v[168:171], v[220:223]
    ds_read_b128 v[244:247], v4 offset:29696
    v_cvt_pk_bf16_f32 v136, v184, v185
    v_mfma_f32_16x16x32_bf16 v[252:255], v[12:15], v[132:135], v[252:255]
    s_waitcnt lgkmcnt(3)
    v_mfma_f32_16x16x32_bf16 v[200:203], v[232:235], v[156:159], v[200:203]
    v_exp_f32 v188, v188
    v_exp_f32 v189, v189
    v_mfma_f32_16x16x32_bf16 v[204:207], v[232:235], v[172:175], v[204:207]
    ds_read_b128 v[224:227], v4 offset:30720
    v_cvt_pk_bf16_f32 v137, v186, v187
    s_waitcnt lgkmcnt(3)
    v_mfma_f32_16x16x32_bf16 v[208:211], v[236:239], v[156:159], v[208:211]
    v_exp_f32 v190, v190
    v_exp_f32 v191, v191
    v_mfma_f32_16x16x32_bf16 v[212:215], v[236:239], v[172:175], v[212:215]
    ds_read_b128 v[228:231], v4 offset:31744
    v_cvt_pk_bf16_f32 v140, v188, v189
    v_exp_f32 v192, v192
    s_waitcnt lgkmcnt(3)
    v_mfma_f32_16x16x32_bf16 v[200:203], v[240:243], v[160:163], v[200:203]
    v_exp_f32 v193, v193
    v_mfma_f32_16x16x32_bf16 v[204:207], v[240:243], v[176:179], v[204:207]
    v_cvt_pk_bf16_f32 v141, v190, v191
    v_exp_f32 v194, v194
    s_waitcnt lgkmcnt(2)
    v_mfma_f32_16x16x32_bf16 v[208:211], v[244:247], v[160:163], v[208:211]
    v_exp_f32 v195, v195
    v_mfma_f32_16x16x32_bf16 v[212:215], v[244:247], v[176:179], v[212:215]
    v_cvt_pk_bf16_f32 v138, v192, v193
    v_exp_f32 v196, v196
    s_waitcnt lgkmcnt(1)
    v_mfma_f32_16x16x32_bf16 v[200:203], v[224:227], v[164:167], v[200:203]
    v_exp_f32 v197, v197
    v_cvt_pk_bf16_f32 v139, v194, v195
    v_mfma_f32_16x16x32_bf16 v[204:207], v[224:227], v[180:183], v[204:207]
    v_exp_f32 v198, v198
    s_waitcnt lgkmcnt(0)
    v_mfma_f32_16x16x32_bf16 v[208:211], v[228:231], v[164:167], v[208:211]
    v_exp_f32 v199, v199
    v_cvt_pk_bf16_f32 v142, v196, v197
    v_mfma_f32_16x16x32_bf16 v[212:215], v[228:231], v[180:183], v[212:215]
    v_cvt_pk_bf16_f32 v143, v198, v199
    s_waitcnt vmcnt(14)
    s_barrier
    ds_read_b128 v[232:235], v4 offset:32768
    ds_read_b128 v[236:239], v4 offset:33792
    ds_read_b128 v[240:243], v4 offset:34816
    ds_read_b128 v[244:247], v4 offset:35840
    v_mfma_f32_16x16x32_bf16 v[248:251], v[12:15], v[136:139], v[248:251]
    v_mfma_f32_16x16x32_bf16 v[252:255], v[12:15], v[140:143], v[252:255]
    v_exp_f32 v200, v200
    v_exp_f32 v201, v201
    v_exp_f32 v202, v202
    v_exp_f32 v203, v203
    v_cvt_pk_bf16_f32 v144, v200, v201
    v_exp_f32 v204, v204
    v_exp_f32 v205, v205
    v_cvt_pk_bf16_f32 v145, v202, v203
    v_exp_f32 v206, v206
    v_exp_f32 v207, v207
    v_cvt_pk_bf16_f32 v148, v204, v205
    v_exp_f32 v208, v208
    v_exp_f32 v209, v209
    v_cvt_pk_bf16_f32 v149, v206, v207
    v_exp_f32 v210, v210
    v_exp_f32 v211, v211
    v_cvt_pk_bf16_f32 v146, v208, v209
    v_exp_f32 v212, v212
    v_exp_f32 v213, v213
    v_cvt_pk_bf16_f32 v147, v210, v211
    v_exp_f32 v214, v214
    v_exp_f32 v215, v215
    v_cvt_pk_bf16_f32 v150, v212, v213
    v_cvt_pk_bf16_f32 v151, v214, v215
    v_mfma_f32_16x16x32_bf16 v[248:251], v[12:15], v[144:147], v[248:251]
    s_nop 0
    v_mfma_f32_16x16x32_bf16 v[252:255], v[12:15], v[148:151], v[252:255]
    s_nop 5
    v_mov_b32 v9, v248
    s_nop 0
    v_mov_b32 v10, v252
    v_max_f32 v17, v9, v10
    v_readfirstlane_b32 s17, v8
    s_cmp_eq_u32 s17, s28
    s_cselect_b32 s16, 0, 0x71800000
    v_cmp_ngt_f32 vcc, s16, v17
    v_cmp_u_f32 s[76:77], v9, v10
    s_or_b64 vcc, vcc, s[76:77]
    s_cbranch_vccnz adaLN_cond__sliding_block_cached__moe_arch_mod__prompt_kernel_fixB
adaLN_cond__sliding_block_cached__moe_arch_mod__prompt_kernel_fixBb:
    v_rcp_f32 v9, v9
    v_rcp_f32 v10, v10
    s_lshl_b32 s25, s13, 3
    s_add_u32 s25, s25, s3
    s_lshl_b32 s25, s25, 18
    s_lshl_b32 s26, s12, 12
    s_add_u32 s25, s25, s26
    s_add_u32 s25, s25, 0x1000000
    s_add_u32 s26, s25, 131072
    s_lshl_b32 s63, s13, 3
    s_add_u32 s63, s63, s3
    s_lshl_b32 s63, s63, 5
    s_add_u32 s63, s63, s12
    s_lshl_b32 s63, s63, 2
    s_waitcnt lgkmcnt(3)
    v_mfma_f32_16x16x32_bf16 v[184:187], v[232:235], v[24:27], 0
    s_mov_b64 s[76:77], s[54:55]
    s_mov_b32 s78, 0xc00000
    s_mov_b32 s79, 0x20000
    v_mfma_f32_16x16x32_bf16 v[188:191], v[232:235], v[28:31], 0
    ds_read_b128 v[224:227], v4 offset:36864
    s_waitcnt lgkmcnt(3)
    v_mfma_f32_16x16x32_bf16 v[192:195], v[236:239], v[24:27], 0
    s_add_u32 s22, s14, 0x0
    s_add_u32 m0, s20, 0x10000
    s_nop 0
    buffer_load_dwordx4 v6, s[76:79], s22 offen lds
    v_mfma_f32_16x16x32_bf16 v[196:199], v[236:239], v[28:31], 0
    ds_read_b128 v[228:231], v4 offset:37888
    s_waitcnt lgkmcnt(3)
    v_mfma_f32_16x16x32_bf16 v[184:187], v[240:243], v[32:35], v[184:187]
    v_mfma_f32_16x16x32_bf16 v[188:191], v[240:243], v[36:39], v[188:191]
    ds_read_b128 v[232:235], v4 offset:38912
    s_waitcnt lgkmcnt(3)
    v_mfma_f32_16x16x32_bf16 v[192:195], v[244:247], v[32:35], v[192:195]
    v_mfma_f32_16x16x32_bf16 v[196:199], v[244:247], v[36:39], v[196:199]
    ds_read_b128 v[236:239], v4 offset:39936
    s_waitcnt lgkmcnt(3)
    v_mfma_f32_16x16x32_bf16 v[184:187], v[224:227], v[40:43], v[184:187]
    v_mfma_f32_16x16x32_bf16 v[188:191], v[224:227], v[44:47], v[188:191]
    ds_read_b128 v[240:243], v4 offset:40960
    s_waitcnt lgkmcnt(3)
    v_mfma_f32_16x16x32_bf16 v[192:195], v[228:231], v[40:43], v[192:195]
    s_add_u32 s22, s14, 0xc000
    s_add_u32 m0, s20, 0x10400
    s_nop 0
    buffer_load_dwordx4 v6, s[76:79], s22 offen lds
    v_mfma_f32_16x16x32_bf16 v[196:199], v[228:231], v[44:47], v[196:199]
    ds_read_b128 v[244:247], v4 offset:41984
    s_waitcnt lgkmcnt(3)
    v_mfma_f32_16x16x32_bf16 v[184:187], v[232:235], v[48:51], v[184:187]
    v_mfma_f32_16x16x32_bf16 v[188:191], v[232:235], v[52:55], v[188:191]
    ds_read_b128 v[224:227], v4 offset:43008
    s_waitcnt lgkmcnt(3)
    v_mfma_f32_16x16x32_bf16 v[192:195], v[236:239], v[48:51], v[192:195]
    v_mfma_f32_16x16x32_bf16 v[196:199], v[236:239], v[52:55], v[196:199]
    ds_read_b128 v[228:231], v4 offset:44032
    s_waitcnt lgkmcnt(3)
    v_mfma_f32_16x16x32_bf16 v[184:187], v[240:243], v[56:59], v[184:187]
    v_mfma_f32_16x16x32_bf16 v[188:191], v[240:243], v[60:63], v[188:191]
    ds_read_b128 v[232:235], v4 offset:45056
    s_waitcnt lgkmcnt(3)
    v_mfma_f32_16x16x32_bf16 v[192:195], v[244:247], v[56:59], v[192:195]
    v_mfma_f32_16x16x32_bf16 v[196:199], v[244:247], v[60:63], v[196:199]
    ds_read_b128 v[236:239], v4 offset:46080
    s_waitcnt lgkmcnt(3)
    v_mfma_f32_16x16x32_bf16 v[184:187], v[224:227], v[64:67], v[184:187]
    v_mfma_f32_16x16x32_bf16 v[188:191], v[224:227], v[68:71], v[188:191]
    ds_read_b128 v[240:243], v4 offset:47104
    s_waitcnt lgkmcnt(3)
    v_mfma_f32_16x16x32_bf16 v[192:195], v[228:231], v[64:67], v[192:195]
    v_mfma_f32_16x16x32_bf16 v[196:199], v[228:231], v[68:71], v[196:199]
    ds_read_b128 v[244:247], v4 offset:48128
    s_waitcnt lgkmcnt(3)
    v_mfma_f32_16x16x32_bf16 v[184:187], v[232:235], v[72:75], v[184:187]
    v_mfma_f32_16x16x32_bf16 v[188:191], v[232:235], v[76:79], v[188:191]
    s_waitcnt vmcnt(12)
    s_barrier
    ds_read_b128 v[224:227], v4 offset:49152
    s_waitcnt lgkmcnt(3)
    v_mfma_f32_16x16x32_bf16 v[192:195], v[236:239], v[72:75], v[192:195]
    v_mfma_f32_16x16x32_bf16 v[196:199], v[236:239], v[76:79], v[196:199]
    s_add_u32 s22, s14, 0xc0000
    s_add_u32 m0, s20, 0x14000
    s_nop 0
    buffer_load_dwordx4 v6, s[76:79], s22 offen lds
    ds_read_b128 v[228:231], v4 offset:50176
    s_waitcnt lgkmcnt(3)
    v_mfma_f32_16x16x32_bf16 v[184:187], v[240:243], v[80:83], v[184:187]
    v_mfma_f32_16x16x32_bf16 v[188:191], v[240:243], v[84:87], v[188:191]
    ds_read_b128 v[232:235], v4 offset:51200
    s_waitcnt lgkmcnt(3)
    v_mfma_f32_16x16x32_bf16 v[192:195], v[244:247], v[80:83], v[192:195]
    v_mfma_f32_16x16x32_bf16 v[196:199], v[244:247], v[84:87], v[196:199]
    ds_read_b128 v[236:239], v4 offset:52224
    s_waitcnt lgkmcnt(3)
    v_mfma_f32_16x16x32_bf16 v[184:187], v[224:227], v[88:91], v[184:187]
    v_mfma_f32_16x16x32_bf16 v[188:191], v[224:227], v[92:95], v[188:191]
    ds_read_b128 v[240:243], v4 offset:53248
    s_waitcnt lgkmcnt(3)
    v_mfma_f32_16x16x32_bf16 v[192:195], v[228:231], v[88:91], v[192:195]
    v_mfma_f32_16x16x32_bf16 v[196:199], v[228:231], v[92:95], v[196:199]
    s_add_u32 s22, s14, 0xcc000
    s_add_u32 m0, s20, 0x14400
    s_nop 0
    buffer_load_dwordx4 v6, s[76:79], s22 offen lds
    ds_read_b128 v[244:247], v4 offset:54272
    s_waitcnt lgkmcnt(3)
    v_mfma_f32_16x16x32_bf16 v[184:187], v[232:235], v[96:99], v[184:187]
    v_mfma_f32_16x16x32_bf16 v[188:191], v[232:235], v[100:103], v[188:191]
    ds_read_b128 v[224:227], v4 offset:55296
    s_waitcnt lgkmcnt(3)
    v_mfma_f32_16x16x32_bf16 v[192:195], v[236:239], v[96:99], v[192:195]
    v_mfma_f32_16x16x32_bf16 v[196:199], v[236:239], v[100:103], v[196:199]
    ds_read_b128 v[228:231], v4 offset:56320
    s_waitcnt lgkmcnt(3)
    v_mfma_f32_16x16x32_bf16 v[184:187], v[240:243], v[104:107], v[184:187]
    v_mfma_f32_16x16x32_bf16 v[188:191], v[240:243], v[108:111], v[188:191]
    ds_read_b128 v[232:235], v4 offset:57344
    s_waitcnt lgkmcnt(3)
    v_mfma_f32_16x16x32_bf16 v[192:195], v[244:247], v[104:107], v[192:195]
    v_mfma_f32_16x16x32_bf16 v[196:199], v[244:247], v[108:111], v[196:199]
    ds_read_b128 v[236:239], v4 offset:58368
    s_waitcnt lgkmcnt(3)
    v_mfma_f32_16x16x32_bf16 v[184:187], v[224:227], v[112:115], v[184:187]
    v_mfma_f32_16x16x32_bf16 v[188:191], v[224:227], v[116:119], v[188:191]
    ds_read_b128 v[240:243], v4 offset:59392
    s_waitcnt lgkmcnt(3)
    v_mfma_f32_16x16x32_bf16 v[192:195], v[228:231], v[112:115], v[192:195]
    v_mfma_f32_16x16x32_bf16 v[196:199], v[228:231], v[116:119], v[196:199]
    ds_read_b128 v[244:247], v4 offset:60416
    s_waitcnt lgkmcnt(3)
    v_mfma_f32_16x16x32_bf16 v[184:187], v[232:235], v[120:123], v[184:187]
    v_mfma_f32_16x16x32_bf16 v[188:191], v[232:235], v[124:127], v[188:191]
    ds_read_b128 v[224:227], v4 offset:61440
    s_waitcnt lgkmcnt(3)
    v_mfma_f32_16x16x32_bf16 v[192:195], v[236:239], v[120:123], v[192:195]
    v_mfma_f32_16x16x32_bf16 v[196:199], v[236:239], v[124:127], v[196:199]
    ds_read_b128 v[228:231], v4 offset:62464
    s_waitcnt lgkmcnt(3)
    v_mfma_f32_16x16x32_bf16 v[184:187], v[240:243], v[128:131], v[184:187]
    v_mfma_f32_16x16x32_bf16 v[188:191], v[240:243], v[132:135], v[188:191]
    ds_read_b128 v[232:235], v4 offset:63488
    s_waitcnt lgkmcnt(3)
    v_mfma_f32_16x16x32_bf16 v[192:195], v[244:247], v[128:131], v[192:195]
    v_mfma_f32_16x16x32_bf16 v[196:199], v[244:247], v[132:135], v[196:199]
    ds_read_b128 v[236:239], v4 offset:64512
    s_waitcnt lgkmcnt(3)
    v_mfma_f32_16x16x32_bf16 v[184:187], v[224:227], v[136:139], v[184:187]
    v_mfma_f32_16x16x32_bf16 v[188:191], v[224:227], v[140:143], v[188:191]
    s_waitcnt vmcnt(9)
    s_barrier
    ds_read_b128 v[240:243], v5 offset:0
    s_waitcnt lgkmcnt(3)
    v_mfma_f32_16x16x32_bf16 v[192:195], v[228:231], v[136:139], v[192:195]
    v_mfma_f32_16x16x32_bf16 v[196:199], v[228:231], v[140:143], v[196:199]
    s_add_u32 s22, s21, 0x90000
    s_add_u32 m0, s20, 0x18000
    s_nop 0
    buffer_load_dwordx4 v2, s[8:11], s22 offen sc1 lds
    ds_read_b128 v[244:247], v5 offset:1024
    s_waitcnt lgkmcnt(3)
    v_mfma_f32_16x16x32_bf16 v[184:187], v[232:235], v[144:147], v[184:187]
    v_mfma_f32_16x16x32_bf16 v[188:191], v[232:235], v[148:151], v[188:191]
    ds_read_b128 v[224:227], v5 offset:2048
    s_waitcnt lgkmcnt(3)
    v_mfma_f32_16x16x32_bf16 v[192:195], v[236:239], v[144:147], v[192:195]
    v_mfma_f32_16x16x32_bf16 v[196:199], v[236:239], v[148:151], v[196:199]
    ds_read_b128 v[228:231], v5 offset:3072
    s_waitcnt lgkmcnt(3)
    v_mfma_f32_16x16x32_bf16 v[200:203], v[240:243], v[24:27], 0
    v_mfma_f32_16x16x32_bf16 v[204:207], v[240:243], v[28:31], 0
    ds_read_b128 v[232:235], v5 offset:4096
    s_waitcnt lgkmcnt(3)
    v_mfma_f32_16x16x32_bf16 v[208:211], v[244:247], v[24:27], 0
    v_mfma_f32_16x16x32_bf16 v[212:215], v[244:247], v[28:31], 0
    s_add_u32 s22, s21, 0x90400
    s_add_u32 m0, s20, 0x18400
    s_nop 0
    buffer_load_dwordx4 v2, s[8:11], s22 offen sc1 lds
    ds_read_b128 v[236:239], v5 offset:5120
    v_mul_f32 v184, v184, v9
    s_waitcnt lgkmcnt(3)
    v_mfma_f32_16x16x32_bf16 v[200:203], v[224:227], v[32:35], v[200:203]
    v_mul_f32 v185, v185, v9
    v_mfma_f32_16x16x32_bf16 v[204:207], v[224:227], v[36:39], v[204:207]
    ds_read_b128 v[240:243], v5 offset:6144
    v_mul_f32 v186, v186, v9
    s_waitcnt lgkmcnt(3)
    v_mfma_f32_16x16x32_bf16 v[208:211], v[228:231], v[32:35], v[208:211]
    v_mul_f32 v187, v187, v9
    v_mfma_f32_16x16x32_bf16 v[212:215], v[228:231], v[36:39], v[212:215]
    ds_read_b128 v[244:247], v5 offset:7168
    v_mul_f32 v192, v192, v9
    s_waitcnt lgkmcnt(3)
    v_mfma_f32_16x16x32_bf16 v[200:203], v[232:235], v[40:43], v[200:203]
    v_mul_f32 v193, v193, v9
    v_mfma_f32_16x16x32_bf16 v[204:207], v[232:235], v[44:47], v[204:207]
    ds_read_b128 v[224:227], v5 offset:8192
    v_mul_f32 v194, v194, v9
    s_waitcnt lgkmcnt(3)
    v_mfma_f32_16x16x32_bf16 v[208:211], v[236:239], v[40:43], v[208:211]
    v_mul_f32 v195, v195, v9
    v_mfma_f32_16x16x32_bf16 v[212:215], v[236:239], v[44:47], v[212:215]
    ds_read_b128 v[228:231], v5 offset:9216
    v_cvt_pk_bf16_f32 v216, v184, v185
    s_waitcnt lgkmcnt(3)
    v_mfma_f32_16x16x32_bf16 v[200:203], v[240:243], v[48:51], v[200:203]
    v_cvt_pk_bf16_f32 v217, v186, v187
    v_mfma_f32_16x16x32_bf16 v[204:207], v[240:243], v[52:55], v[204:207]
    ds_read_b128 v[232:235], v5 offset:10240
    v_cvt_pk_bf16_f32 v218, v192, v193
    s_waitcnt lgkmcnt(3)
    v_mfma_f32_16x16x32_bf16 v[208:211], v[244:247], v[48:51], v[208:211]
    v_cvt_pk_bf16_f32 v219, v194, v195
    v_mfma_f32_16x16x32_bf16 v[212:215], v[244:247], v[52:55], v[212:215]
    ds_read_b128 v[236:239], v5 offset:11264
    buffer_store_dwordx4 v[216:219], v2, s[8:11], s25 offen offset:0 sc1
    s_waitcnt lgkmcnt(3)
    v_mfma_f32_16x16x32_bf16 v[200:203], v[224:227], v[56:59], v[200:203]
    v_mul_f32 v188, v188, v10
    v_mfma_f32_16x16x32_bf16 v[204:207], v[224:227], v[60:63], v[204:207]
    ds_read_b128 v[240:243], v5 offset:12288
    v_mul_f32 v189, v189, v10
    s_waitcnt lgkmcnt(3)
    v_mfma_f32_16x16x32_bf16 v[208:211], v[228:231], v[56:59], v[208:211]
    v_mul_f32 v190, v190, v10
    v_mfma_f32_16x16x32_bf16 v[212:215], v[228:231], v[60:63], v[212:215]
    ds_read_b128 v[244:247], v5 offset:13312
    v_mul_f32 v191, v191, v10
    s_waitcnt lgkmcnt(3)
    v_mfma_f32_16x16x32_bf16 v[200:203], v[232:235], v[64:67], v[200:203]
    v_mul_f32 v196, v196, v10
    v_mfma_f32_16x16x32_bf16 v[204:207], v[232:235], v[68:71], v[204:207]
    ds_read_b128 v[224:227], v5 offset:14336
    v_mul_f32 v197, v197, v10
    s_waitcnt lgkmcnt(3)
    v_mfma_f32_16x16x32_bf16 v[208:211], v[236:239], v[64:67], v[208:211]
    v_mul_f32 v198, v198, v10
    v_mfma_f32_16x16x32_bf16 v[212:215], v[236:239], v[68:71], v[212:215]
    ds_read_b128 v[228:231], v5 offset:15360
    v_mul_f32 v199, v199, v10
    s_waitcnt lgkmcnt(3)
    v_mfma_f32_16x16x32_bf16 v[200:203], v[240:243], v[72:75], v[200:203]
    v_cvt_pk_bf16_f32 v220, v188, v189
    v_mfma_f32_16x16x32_bf16 v[204:207], v[240:243], v[76:79], v[204:207]
    s_waitcnt vmcnt(8)
    s_barrier
    ds_read_b128 v[232:235], v5 offset:16384
    v_cvt_pk_bf16_f32 v221, v190, v191
    s_waitcnt lgkmcnt(3)
    v_mfma_f32_16x16x32_bf16 v[208:211], v[244:247], v[72:75], v[208:211]
    v_cvt_pk_bf16_f32 v222, v196, v197
    v_mfma_f32_16x16x32_bf16 v[212:215], v[244:247], v[76:79], v[212:215]
    s_add_u32 s22, s21, 0x94000
    s_add_u32 m0, s20, 0x1c000
    s_nop 0
    buffer_load_dwordx4 v2, s[8:11], s22 offen sc1 lds
    ds_read_b128 v[236:239], v5 offset:17408
    v_cvt_pk_bf16_f32 v223, v198, v199
    s_waitcnt lgkmcnt(3)
    v_mfma_f32_16x16x32_bf16 v[200:203], v[224:227], v[80:83], v[200:203]
    buffer_store_dwordx4 v[220:223], v2, s[8:11], s26 offen offset:0 sc1
    v_mfma_f32_16x16x32_bf16 v[204:207], v[224:227], v[84:87], v[204:207]
    ds_read_b128 v[240:243], v5 offset:18432
    s_waitcnt lgkmcnt(3)
    v_mfma_f32_16x16x32_bf16 v[208:211], v[228:231], v[80:83], v[208:211]
    v_mfma_f32_16x16x32_bf16 v[212:215], v[228:231], v[84:87], v[212:215]
    ds_read_b128 v[244:247], v5 offset:19456
    s_waitcnt lgkmcnt(3)
    v_mfma_f32_16x16x32_bf16 v[200:203], v[232:235], v[88:91], v[200:203]
    v_lshrrev_b32 v20, 4, v1
    v_lshlrev_b32 v21, 4, v20
    s_lshl_b32 s16, s2, 8
    s_add_u32 s16, s16, 0x550000
    buffer_load_dwordx4 v[152:155], v21, s[8:11], s16 offen offset:0 sc1
    buffer_load_dwordx4 v[156:159], v21, s[8:11], s16 offen offset:64 sc1
    buffer_load_dwordx4 v[160:163], v21, s[8:11], s16 offen offset:128 sc1
    buffer_load_dwordx4 v[164:167], v21, s[8:11], s16 offen offset:192 sc1
    v_lshlrev_b32 v11, 11, v20
    v_xor_b32 v20, s3, v20
    v_and_b32 v20, 1, v20
    v_lshl_add_u32 v11, v20, 5, v11
    v_bfe_u32 v20, v1, 2, 2
    v_lshl_add_u32 v11, v20, 6, v11
    v_and_b32 v20, 3, v1
    v_lshl_add_u32 v11, v20, 3, v11
    s_lshr_b32 s16, s3, 1
    s_lshl_b32 s16, s16, 8
    s_add_u32 s16, s16, 65536
    v_add_u32 v11, s16, v11
    v_mfma_f32_16x16x32_bf16 v[204:207], v[232:235], v[92:95], v[204:207]
    ds_read_b128 v[224:227], v5 offset:20480
    s_waitcnt lgkmcnt(3)
    v_mfma_f32_16x16x32_bf16 v[208:211], v[236:239], v[88:91], v[208:211]
    v_mfma_f32_16x16x32_bf16 v[212:215], v[236:239], v[92:95], v[212:215]
    s_add_u32 s22, s21, 0x94400
    s_add_u32 m0, s20, 0x1c400
    s_nop 0
    buffer_load_dwordx4 v2, s[8:11], s22 offen sc1 lds
    ds_read_b128 v[228:231], v5 offset:21504
    s_waitcnt lgkmcnt(3)
    v_mfma_f32_16x16x32_bf16 v[200:203], v[240:243], v[96:99], v[200:203]
    v_mfma_f32_16x16x32_bf16 v[204:207], v[240:243], v[100:103], v[204:207]
    ds_read_b128 v[232:235], v5 offset:22528
    s_waitcnt lgkmcnt(3)
    v_mfma_f32_16x16x32_bf16 v[208:211], v[244:247], v[96:99], v[208:211]
    v_mfma_f32_16x16x32_bf16 v[212:215], v[244:247], v[100:103], v[212:215]
    ds_read_b128 v[236:239], v5 offset:23552
    s_waitcnt lgkmcnt(3)
    v_mfma_f32_16x16x32_bf16 v[200:203], v[224:227], v[104:107], v[200:203]
    v_mfma_f32_16x16x32_bf16 v[204:207], v[224:227], v[108:111], v[204:207]
    ds_read_b128 v[240:243], v5 offset:24576
    s_waitcnt lgkmcnt(3)
    v_mfma_f32_16x16x32_bf16 v[208:211], v[228:231], v[104:107], v[208:211]
    v_mfma_f32_16x16x32_bf16 v[212:215], v[228:231], v[108:111], v[212:215]
    ds_read_b128 v[244:247], v5 offset:25600
    s_waitcnt lgkmcnt(3)
    v_mfma_f32_16x16x32_bf16 v[200:203], v[232:235], v[112:115], v[200:203]
    v_mfma_f32_16x16x32_bf16 v[204:207], v[232:235], v[116:119], v[204:207]
    ds_read_b128 v[224:227], v5 offset:26624
    s_waitcnt lgkmcnt(3)
    v_mfma_f32_16x16x32_bf16 v[208:211], v[236:239], v[112:115], v[208:211]
    v_mfma_f32_16x16x32_bf16 v[212:215], v[236:239], v[116:119], v[212:215]
    ds_read_b128 v[228:231], v5 offset:27648
    s_waitcnt lgkmcnt(3)
    v_mfma_f32_16x16x32_bf16 v[200:203], v[240:243], v[120:123], v[200:203]
    v_mfma_f32_16x16x32_bf16 v[204:207], v[240:243], v[124:127], v[204:207]
    ds_read_b128 v[232:235], v5 offset:28672
    s_waitcnt lgkmcnt(3)
    v_mfma_f32_16x16x32_bf16 v[208:211], v[244:247], v[120:123], v[208:211]
    v_mfma_f32_16x16x32_bf16 v[212:215], v[244:247], v[124:127], v[212:215]
    ds_read_b128 v[236:239], v5 offset:29696
    s_waitcnt lgkmcnt(3)
    v_mfma_f32_16x16x32_bf16 v[200:203], v[224:227], v[128:131], v[200:203]
    v_mfma_f32_16x16x32_bf16 v[204:207], v[224:227], v[132:135], v[204:207]
    ds_read_b128 v[240:243], v5 offset:30720
    s_waitcnt lgkmcnt(3)
    v_mfma_f32_16x16x32_bf16 v[208:211], v[228:231], v[128:131], v[208:211]
    v_mfma_f32_16x16x32_bf16 v[212:215], v[228:231], v[132:135], v[212:215]
    ds_read_b128 v[244:247], v5 offset:31744
    s_waitcnt lgkmcnt(3)
    v_mfma_f32_16x16x32_bf16 v[200:203], v[232:235], v[136:139], v[200:203]
    s_waitcnt vmcnt(5)
    s_add_u32 s16, s63, 0x570000
    v_mov_b32 v7, s28
    v_mov_b32 v8, 0
    s_mov_b64 exec, 1
    buffer_store_dword v7, v8, s[8:11], s16 offen sc1
    s_mov_b64 exec, -1
    v_mfma_f32_16x16x32_bf16 v[204:207], v[232:235], v[140:143], v[204:207]
    s_barrier
    ds_read_b128 v[224:227], v4 offset:32768
    s_waitcnt lgkmcnt(3)
    v_mfma_f32_16x16x32_bf16 v[208:211], v[236:239], v[136:139], v[208:211]
    v_mfma_f32_16x16x32_bf16 v[212:215], v[236:239], v[140:143], v[212:215]
    s_add_u32 s22, s21, 0x98000
    s_add_u32 m0, s20, 0x20000
    s_nop 0
    buffer_load_dwordx4 v2, s[8:11], s22 offen sc1 lds
    ds_read_b128 v[228:231], v4 offset:33792
    s_waitcnt lgkmcnt(3)
    v_mfma_f32_16x16x32_bf16 v[200:203], v[240:243], v[144:147], v[200:203]
    ds_read_b64_tr_b16 v[168:169], v11 offset:0
    ds_read_b64_tr_b16 v[170:171], v11 offset:1024
    ds_read_b64_tr_b16 v[172:173], v11 offset:8192
    ds_read_b64_tr_b16 v[174:175], v11 offset:9216
    ds_read_b64_tr_b16 v[176:177], v11 offset:16384
    ds_read_b64_tr_b16 v[178:179], v11 offset:17408
    ds_read_b64_tr_b16 v[180:181], v11 offset:24576
    ds_read_b64_tr_b16 v[182:183], v11 offset:25600
    v_mfma_f32_16x16x32_bf16 v[204:207], v[240:243], v[148:151], v[204:207]
    ds_read_b128 v[232:235], v4 offset:34816
    s_waitcnt lgkmcnt(11)
    v_mfma_f32_16x16x32_bf16 v[208:211], v[244:247], v[144:147], v[208:211]
    v_mfma_f32_16x16x32_bf16 v[212:215], v[244:247], v[148:151], v[212:215]
    ds_read_b128 v[236:239], v4 offset:35840
    s_waitcnt lgkmcnt(11)
    v_mfma_f32_16x16x32_bf16 v[184:187], v[224:227], v[24:27], 0
    v_mfma_f32_16x16x32_bf16 v[188:191], v[224:227], v[28:31], 0
    ds_read_b128 v[240:243], v4 offset:36864
    s_waitcnt lgkmcnt(11)
    v_mfma_f32_16x16x32_bf16 v[192:195], v[228:231], v[24:27], 0
    v_mfma_f32_16x16x32_bf16 v[196:199], v[228:231], v[28:31], 0
    s_add_u32 s22, s21, 0x98400
    s_add_u32 m0, s20, 0x20400
    s_nop 0
    buffer_load_dwordx4 v2, s[8:11], s22 offen sc1 lds
    ds_read_b128 v[244:247], v4 offset:37888
    v_mul_f32 v200, v200, v9
    s_waitcnt lgkmcnt(3)
    v_mfma_f32_16x16x32_bf16 v[184:187], v[232:235], v[32:35], v[184:187]
    v_mul_f32 v201, v201, v9
    v_mfma_f32_16x16x32_bf16 v[188:191], v[232:235], v[36:39], v[188:191]
    ds_read_b128 v[224:227], v4 offset:38912
    v_mul_f32 v202, v202, v9
    s_waitcnt lgkmcnt(3)
    v_mfma_f32_16x16x32_bf16 v[192:195], v[236:239], v[32:35], v[192:195]
    v_mul_f32 v203, v203, v9
    s_waitcnt vmcnt(7)
    v_mfma_f32_16x16x32_bf16 v[248:251], v[168:171], v[152:155], 0
    s_waitcnt vmcnt(6)
    v_mfma_f32_16x16x32_bf16 v[248:251], v[172:175], v[156:159], v[248:251]
    s_waitcnt vmcnt(5)
    v_mfma_f32_16x16x32_bf16 v[248:251], v[176:179], v[160:163], v[248:251]
    s_waitcnt vmcnt(4)
    v_mfma_f32_16x16x32_bf16 v[248:251], v[180:183], v[164:167], v[248:251]
    v_mfma_f32_16x16x32_bf16 v[196:199], v[236:239], v[36:39], v[196:199]
    ds_read_b128 v[228:231], v4 offset:39936
    v_mul_f32 v208, v208, v9
    s_waitcnt lgkmcnt(3)
    v_mfma_f32_16x16x32_bf16 v[184:187], v[240:243], v[40:43], v[184:187]
    v_mul_f32 v209, v209, v9
    v_mfma_f32_16x16x32_bf16 v[188:191], v[240:243], v[44:47], v[188:191]
    ds_read_b128 v[232:235], v4 offset:40960
    v_mul_f32 v210, v210, v9
    s_waitcnt lgkmcnt(3)
    v_mfma_f32_16x16x32_bf16 v[192:195], v[244:247], v[40:43], v[192:195]
    v_mul_f32 v211, v211, v9
    v_mfma_f32_16x16x32_bf16 v[196:199], v[244:247], v[44:47], v[196:199]
    ds_read_b128 v[236:239], v4 offset:41984
    v_cvt_pk_bf16_f32 v216, v200, v201
    s_waitcnt lgkmcnt(3)
    v_mfma_f32_16x16x32_bf16 v[184:187], v[224:227], v[48:51], v[184:187]
    v_cvt_pk_bf16_f32 v217, v202, v203
    v_mfma_f32_16x16x32_bf16 v[188:191], v[224:227], v[52:55], v[188:191]
    ds_read_b128 v[240:243], v4 offset:43008
    v_cvt_pk_bf16_f32 v218, v208, v209
    s_waitcnt lgkmcnt(3)
    v_mfma_f32_16x16x32_bf16 v[192:195], v[228:231], v[48:51], v[192:195]
    v_cvt_pk_bf16_f32 v219, v210, v211
    v_mfma_f32_16x16x32_bf16 v[196:199], v[228:231], v[52:55], v[196:199]
    ds_read_b128 v[244:247], v4 offset:44032
    buffer_store_dwordx4 v[216:219], v2, s[8:11], s25 offen offset:1024 sc1
    s_waitcnt lgkmcnt(3)
    v_mfma_f32_16x16x32_bf16 v[184:187], v[232:235], v[56:59], v[184:187]
    v_mul_f32 v204, v204, v10
    v_mfma_f32_16x16x32_bf16 v[188:191], v[232:235], v[60:63], v[188:191]
    ds_read_b128 v[224:227], v4 offset:45056
    v_mul_f32 v205, v205, v10
    s_waitcnt lgkmcnt(3)
    v_mfma_f32_16x16x32_bf16 v[192:195], v[236:239], v[56:59], v[192:195]
    v_mul_f32 v206, v206, v10
    v_lshrrev_b32 v20, 4, v1
    v_lshlrev_b32 v20, 4, v20
    s_lshr_b32 s16, s2, 5
    s_lshl_b32 s16, s16, 14
    s_and_b32 s17, s2, 31
    s_lshl_b32 s17, s17, 9
    s_add_u32 s16, s16, s17
    s_lshl_b32 s17, s3, 6
    s_add_u32 s16, s16, s17
    s_add_u32 s16, s16, 0x580000
    s_mov_b32 exec_lo, 0x10001
    s_mov_b32 exec_hi, 0x10001
    buffer_store_dwordx4 v[248:251], v20, s[8:11], s16 offen sc1
    s_mov_b64 exec, -1
    v_mfma_f32_16x16x32_bf16 v[196:199], v[236:239], v[60:63], v[196:199]
    ds_read_b128 v[228:231], v4 offset:46080
    v_mul_f32 v207, v207, v10
    s_waitcnt lgkmcnt(3)
    v_mfma_f32_16x16x32_bf16 v[184:187], v[240:243], v[64:67], v[184:187]
    v_mul_f32 v212, v212, v10
    v_mfma_f32_16x16x32_bf16 v[188:191], v[240:243], v[68:71], v[188:191]
    ds_read_b128 v[232:235], v4 offset:47104
    v_mul_f32 v213, v213, v10
    s_waitcnt lgkmcnt(3)
    v_mfma_f32_16x16x32_bf16 v[192:195], v[244:247], v[64:67], v[192:195]
    v_mul_f32 v214, v214, v10
    v_mfma_f32_16x16x32_bf16 v[196:199], v[244:247], v[68:71], v[196:199]
    ds_read_b128 v[236:239], v4 offset:48128
    v_mul_f32 v215, v215, v10
    s_waitcnt lgkmcnt(3)
    v_mfma_f32_16x16x32_bf16 v[184:187], v[224:227], v[72:75], v[184:187]
    v_cvt_pk_bf16_f32 v220, v204, v205
    v_mfma_f32_16x16x32_bf16 v[188:191], v[224:227], v[76:79], v[188:191]
    s_waitcnt vmcnt(5)
    s_barrier
    ds_read_b128 v[240:243], v4 offset:49152
    v_cvt_pk_bf16_f32 v221, v206, v207
    s_waitcnt lgkmcnt(3)
    v_mfma_f32_16x16x32_bf16 v[192:195], v[228:231], v[72:75], v[192:195]
    v_cvt_pk_bf16_f32 v222, v212, v213
    v_mfma_f32_16x16x32_bf16 v[196:199], v[228:231], v[76:79], v[196:199]
    s_add_u32 s22, s21, 0x9c000
    s_add_u32 m0, s20, 0x24000
    s_nop 0
    buffer_load_dwordx4 v2, s[8:11], s22 offen sc1 lds
    ds_read_b128 v[244:247], v4 offset:50176
    v_cvt_pk_bf16_f32 v223, v214, v215
    s_waitcnt lgkmcnt(3)
    v_mfma_f32_16x16x32_bf16 v[184:187], v[232:235], v[80:83], v[184:187]
    buffer_store_dwordx4 v[220:223], v2, s[8:11], s26 offen offset:1024 sc1
    v_mfma_f32_16x16x32_bf16 v[188:191], v[232:235], v[84:87], v[188:191]
    ds_read_b128 v[224:227], v4 offset:51200
    s_waitcnt lgkmcnt(3)
    v_mfma_f32_16x16x32_bf16 v[192:195], v[236:239], v[80:83], v[192:195]
    v_mfma_f32_16x16x32_bf16 v[196:199], v[236:239], v[84:87], v[196:199]
    s_add_u32 s22, s21, 0x9c400
    s_add_u32 m0, s20, 0x24400
    s_nop 0
    buffer_load_dwordx4 v2, s[8:11], s22 offen sc1 lds
    ds_read_b128 v[228:231], v4 offset:52224
    s_waitcnt lgkmcnt(3)
    v_mfma_f32_16x16x32_bf16 v[184:187], v[240:243], v[88:91], v[184:187]
    v_mfma_f32_16x16x32_bf16 v[188:191], v[240:243], v[92:95], v[188:191]
    ds_read_b128 v[232:235], v4 offset:53248
    s_waitcnt lgkmcnt(3)
    v_mfma_f32_16x16x32_bf16 v[192:195], v[244:247], v[88:91], v[192:195]
    v_mfma_f32_16x16x32_bf16 v[196:199], v[244:247], v[92:95], v[196:199]
    s_add_u32 s22, s24, 0x0
    s_add_u32 m0, s20, 0x10000
    s_nop 0
    buffer_load_dwordx4 v3, s[4:7], s22 offen lds
    ds_read_b128 v[236:239], v4 offset:54272
    s_waitcnt lgkmcnt(3)
    v_mfma_f32_16x16x32_bf16 v[184:187], v[224:227], v[96:99], v[184:187]
    v_mfma_f32_16x16x32_bf16 v[188:191], v[224:227], v[100:103], v[188:191]
    ds_read_b128 v[240:243], v4 offset:55296
    s_waitcnt lgkmcnt(3)
    v_mfma_f32_16x16x32_bf16 v[192:195], v[228:231], v[96:99], v[192:195]
    v_mfma_f32_16x16x32_bf16 v[196:199], v[228:231], v[100:103], v[196:199]
    s_add_u32 s22, s24, 0x2000
    s_add_u32 m0, s20, 0x10400
    s_nop 0
    buffer_load_dwordx4 v3, s[4:7], s22 offen lds
    ds_read_b128 v[244:247], v4 offset:56320
    s_waitcnt lgkmcnt(3)
    v_mfma_f32_16x16x32_bf16 v[184:187], v[232:235], v[104:107], v[184:187]
    v_mfma_f32_16x16x32_bf16 v[188:191], v[232:235], v[108:111], v[188:191]
    ds_read_b128 v[224:227], v4 offset:57344
    s_waitcnt lgkmcnt(3)
    v_mfma_f32_16x16x32_bf16 v[192:195], v[236:239], v[104:107], v[192:195]
    v_mfma_f32_16x16x32_bf16 v[196:199], v[236:239], v[108:111], v[196:199]
    ds_read_b128 v[228:231], v4 offset:58368
    s_waitcnt lgkmcnt(3)
    v_mfma_f32_16x16x32_bf16 v[184:187], v[240:243], v[112:115], v[184:187]
    v_mfma_f32_16x16x32_bf16 v[188:191], v[240:243], v[116:119], v[188:191]
    ds_read_b128 v[232:235], v4 offset:59392
    s_waitcnt lgkmcnt(3)
    v_mfma_f32_16x16x32_bf16 v[192:195], v[244:247], v[112:115], v[192:195]
    v_mfma_f32_16x16x32_bf16 v[196:199], v[244:247], v[116:119], v[196:199]
    ds_read_b128 v[236:239], v4 offset:60416
    s_waitcnt lgkmcnt(3)
    v_mfma_f32_16x16x32_bf16 v[184:187], v[224:227], v[120:123], v[184:187]
    v_mfma_f32_16x16x32_bf16 v[188:191], v[224:227], v[124:127], v[188:191]
    ds_read_b128 v[240:243], v4 offset:61440
    s_waitcnt lgkmcnt(3)
    v_mfma_f32_16x16x32_bf16 v[192:195], v[228:231], v[120:123], v[192:195]
    v_mfma_f32_16x16x32_bf16 v[196:199], v[228:231], v[124:127], v[196:199]
    ds_read_b128 v[244:247], v4 offset:62464
    s_waitcnt lgkmcnt(3)
    v_mfma_f32_16x16x32_bf16 v[184:187], v[232:235], v[128:131], v[184:187]
    v_mfma_f32_16x16x32_bf16 v[188:191], v[232:235], v[132:135], v[188:191]
    ds_read_b128 v[224:227], v4 offset:63488
    s_waitcnt lgkmcnt(3)
    v_mfma_f32_16x16x32_bf16 v[192:195], v[236:239], v[128:131], v[192:195]
    v_mfma_f32_16x16x32_bf16 v[196:199], v[236:239], v[132:135], v[196:199]
    ds_read_b128 v[228:231], v4 offset:64512
    s_waitcnt lgkmcnt(3)
    v_mfma_f32_16x16x32_bf16 v[184:187], v[240:243], v[136:139], v[184:187]
    v_mfma_f32_16x16x32_bf16 v[188:191], v[240:243], v[140:143], v[188:191]
    s_waitcnt vmcnt(7)
    s_barrier
    ds_read_b128 v[232:235], v5 offset:0
    s_waitcnt lgkmcnt(3)
    v_mfma_f32_16x16x32_bf16 v[192:195], v[244:247], v[136:139], v[192:195]
    v_mfma_f32_16x16x32_bf16 v[196:199], v[244:247], v[140:143], v[196:199]
    s_add_u32 s22, s24, 0x80000
    s_add_u32 m0, s20, 0x14000
    s_nop 0
    buffer_load_dwordx4 v3, s[4:7], s22 offen lds
    ds_read_b128 v[236:239], v5 offset:1024
    s_waitcnt lgkmcnt(3)
    v_mfma_f32_16x16x32_bf16 v[184:187], v[224:227], v[144:147], v[184:187]
    v_mfma_f32_16x16x32_bf16 v[188:191], v[224:227], v[148:151], v[188:191]
    ds_read_b128 v[240:243], v5 offset:2048
    s_waitcnt lgkmcnt(3)
    v_mfma_f32_16x16x32_bf16 v[192:195], v[228:231], v[144:147], v[192:195]
    v_mfma_f32_16x16x32_bf16 v[196:199], v[228:231], v[148:151], v[196:199]
    s_add_u32 s22, s24, 0x82000
    s_add_u32 m0, s20, 0x14400
    s_nop 0
    buffer_load_dwordx4 v3, s[4:7], s22 offen lds
    ds_read_b128 v[244:247], v5 offset:3072
    s_waitcnt lgkmcnt(3)
    v_mfma_f32_16x16x32_bf16 v[200:203], v[232:235], v[24:27], 0
    v_mfma_f32_16x16x32_bf16 v[204:207], v[232:235], v[28:31], 0
    ds_read_b128 v[224:227], v5 offset:4096
    s_waitcnt lgkmcnt(3)
    v_mfma_f32_16x16x32_bf16 v[208:211], v[236:239], v[24:27], 0
    v_mfma_f32_16x16x32_bf16 v[212:215], v[236:239], v[28:31], 0
    s_add_u32 s22, s24, 0x100000
    s_add_u32 m0, s20, 0x18000
    s_nop 0
    buffer_load_dwordx4 v3, s[4:7], s22 offen lds
    ds_read_b128 v[228:231], v5 offset:5120
    v_mul_f32 v184, v184, v9
    s_waitcnt lgkmcnt(3)
    v_mfma_f32_16x16x32_bf16 v[200:203], v[240:243], v[32:35], v[200:203]
    v_mul_f32 v185, v185, v9
    v_mfma_f32_16x16x32_bf16 v[204:207], v[240:243], v[36:39], v[204:207]
    ds_read_b128 v[232:235], v5 offset:6144
    v_mul_f32 v186, v186, v9
    s_waitcnt lgkmcnt(3)
    v_mfma_f32_16x16x32_bf16 v[208:211], v[244:247], v[32:35], v[208:211]
    v_mul_f32 v187, v187, v9
    v_mfma_f32_16x16x32_bf16 v[212:215], v[244:247], v[36:39], v[212:215]
    s_add_u32 s22, s24, 0x102000
    s_add_u32 m0, s20, 0x18400
    s_nop 0
    buffer_load_dwordx4 v3, s[4:7], s22 offen lds
    ds_read_b128 v[236:239], v5 offset:7168
    v_mul_f32 v192, v192, v9
    s_waitcnt lgkmcnt(3)
    v_mfma_f32_16x16x32_bf16 v[200:203], v[224:227], v[40:43], v[200:203]
    v_mul_f32 v193, v193, v9
    v_mfma_f32_16x16x32_bf16 v[204:207], v[224:227], v[44:47], v[204:207]
    ds_read_b128 v[240:243], v5 offset:8192
    v_mul_f32 v194, v194, v9
    s_waitcnt lgkmcnt(3)
    v_mfma_f32_16x16x32_bf16 v[208:211], v[228:231], v[40:43], v[208:211]
    v_mul_f32 v195, v195, v9
    v_mfma_f32_16x16x32_bf16 v[212:215], v[228:231], v[44:47], v[212:215]
    ds_read_b128 v[244:247], v5 offset:9216
    v_cvt_pk_bf16_f32 v216, v184, v185
    s_waitcnt lgkmcnt(3)
    v_mfma_f32_16x16x32_bf16 v[200:203], v[232:235], v[48:51], v[200:203]
    v_cvt_pk_bf16_f32 v217, v186, v187
    v_mfma_f32_16x16x32_bf16 v[204:207], v[232:235], v[52:55], v[204:207]
    ds_read_b128 v[224:227], v5 offset:10240
    v_cvt_pk_bf16_f32 v218, v192, v193
    s_waitcnt lgkmcnt(3)
    v_mfma_f32_16x16x32_bf16 v[208:211], v[236:239], v[48:51], v[208:211]
    v_cvt_pk_bf16_f32 v219, v194, v195
    v_mfma_f32_16x16x32_bf16 v[212:215], v[236:239], v[52:55], v[212:215]
    ds_read_b128 v[228:231], v5 offset:11264
    buffer_store_dwordx4 v[216:219], v2, s[8:11], s25 offen offset:2048 sc1
    s_waitcnt lgkmcnt(3)
    v_mfma_f32_16x16x32_bf16 v[200:203], v[240:243], v[56:59], v[200:203]
    v_mul_f32 v188, v188, v10
    v_mfma_f32_16x16x32_bf16 v[204:207], v[240:243], v[60:63], v[204:207]
    ds_read_b128 v[232:235], v5 offset:12288
    v_mul_f32 v189, v189, v10
    s_waitcnt lgkmcnt(3)
    v_mfma_f32_16x16x32_bf16 v[208:211], v[244:247], v[56:59], v[208:211]
    v_mul_f32 v190, v190, v10
    v_mfma_f32_16x16x32_bf16 v[212:215], v[244:247], v[60:63], v[212:215]
    ds_read_b128 v[236:239], v5 offset:13312
    v_mul_f32 v191, v191, v10
    s_waitcnt lgkmcnt(3)
    v_mfma_f32_16x16x32_bf16 v[200:203], v[224:227], v[64:67], v[200:203]
    v_mul_f32 v196, v196, v10
    s_waitcnt vmcnt(10)
    s_bfe_u32 s30, s2, 0x20001
    s_lshl_b32 s30, s30, 2
    s_bfe_u32 s17, s2, 0x20003
    s_add_u32 s30, s30, s17
    s_lshr_b32 s31, s2, 5
    s_and_b32 s17, s3, 3
    s_lshl_b32 s19, s30, 2
    s_add_u32 s19, s19, s17
    s_and_b32 s16, s2, 1
    s_lshl_b32 s17, s19, 18
    s_lshl_b32 s23, s16, 16
    s_add_u32 s17, s17, s23
    s_add_u32 s17, s17, 0x1001000
    v_add_u32 v6, s17, v2
    s_lshl_b32 s19, s19, 7
    s_lshl_b32 s23, s16, 6
    s_add_u32 s19, s19, s23
    s_add_u32 s19, s19, 0x570000
    v_and_b32 v13, 15, v1
    v_lshlrev_b32 v13, 2, v13
    buffer_load_dword v12, v13, s[8:11], s19 offen sc1
    v_mfma_f32_16x16x32_bf16 v[204:207], v[224:227], v[68:71], v[204:207]
    ds_read_b128 v[240:243], v5 offset:14336
    v_mul_f32 v197, v197, v10
    s_waitcnt lgkmcnt(3)
    v_mfma_f32_16x16x32_bf16 v[208:211], v[228:231], v[64:67], v[208:211]
    v_mul_f32 v198, v198, v10
    v_mfma_f32_16x16x32_bf16 v[212:215], v[228:231], v[68:71], v[212:215]
    ds_read_b128 v[244:247], v5 offset:15360
    v_mul_f32 v199, v199, v10
    s_waitcnt lgkmcnt(3)
    v_mfma_f32_16x16x32_bf16 v[200:203], v[232:235], v[72:75], v[200:203]
    v_cvt_pk_bf16_f32 v220, v188, v189
    v_mfma_f32_16x16x32_bf16 v[204:207], v[232:235], v[76:79], v[204:207]
    s_waitcnt vmcnt(8)
    s_barrier
    ds_read_b128 v[224:227], v5 offset:16384
    v_cvt_pk_bf16_f32 v221, v190, v191
    s_waitcnt lgkmcnt(3)
    v_mfma_f32_16x16x32_bf16 v[208:211], v[236:239], v[72:75], v[208:211]
    v_cvt_pk_bf16_f32 v222, v196, v197
    v_mfma_f32_16x16x32_bf16 v[212:215], v[236:239], v[76:79], v[212:215]
    s_add_u32 s22, s24, 0x180000
    s_add_u32 m0, s20, 0x1c000
    s_nop 0
    buffer_load_dwordx4 v3, s[4:7], s22 offen lds
    ds_read_b128 v[228:231], v5 offset:17408
    v_cvt_pk_bf16_f32 v223, v198, v199
    s_waitcnt lgkmcnt(3)
    v_mfma_f32_16x16x32_bf16 v[200:203], v[240:243], v[80:83], v[200:203]
    buffer_store_dwordx4 v[220:223], v2, s[8:11], s26 offen offset:2048 sc1
    s_add_u32 s16, s63, 0x572000
    v_mov_b32 v14, s28
    v_mov_b32 v15, 0
    s_mov_b64 exec, 1
    buffer_store_dword v14, v15, s[8:11], s16 offen sc1
    s_mov_b64 exec, -1
    v_mfma_f32_16x16x32_bf16 v[204:207], v[240:243], v[84:87], v[204:207]
    ds_read_b128 v[232:235], v5 offset:18432
    s_waitcnt lgkmcnt(3)
    v_mfma_f32_16x16x32_bf16 v[208:211], v[244:247], v[80:83], v[208:211]
    v_mfma_f32_16x16x32_bf16 v[212:215], v[244:247], v[84:87], v[212:215]
    ds_read_b128 v[236:239], v5 offset:19456
    s_waitcnt lgkmcnt(3)
    v_mfma_f32_16x16x32_bf16 v[200:203], v[224:227], v[88:91], v[200:203]
    v_mfma_f32_16x16x32_bf16 v[204:207], v[224:227], v[92:95], v[204:207]
    ds_read_b128 v[240:243], v5 offset:20480
    s_waitcnt lgkmcnt(3)
    v_mfma_f32_16x16x32_bf16 v[208:211], v[228:231], v[88:91], v[208:211]
    v_mfma_f32_16x16x32_bf16 v[212:215], v[228:231], v[92:95], v[212:215]
    s_add_u32 s22, s24, 0x182000
    s_add_u32 m0, s20, 0x1c400
    s_nop 0
    buffer_load_dwordx4 v3, s[4:7], s22 offen lds
    ds_read_b128 v[244:247], v5 offset:21504
    s_waitcnt lgkmcnt(3)
    v_mfma_f32_16x16x32_bf16 v[200:203], v[232:235], v[96:99], v[200:203]
    v_mfma_f32_16x16x32_bf16 v[204:207], v[232:235], v[100:103], v[204:207]
    ds_read_b128 v[224:227], v5 offset:22528
    s_waitcnt lgkmcnt(3)
    v_mfma_f32_16x16x32_bf16 v[208:211], v[236:239], v[96:99], v[208:211]
    v_mfma_f32_16x16x32_bf16 v[212:215], v[236:239], v[100:103], v[212:215]
    ds_read_b128 v[228:231], v5 offset:23552
    s_waitcnt lgkmcnt(3)
    v_mfma_f32_16x16x32_bf16 v[200:203], v[240:243], v[104:107], v[200:203]
    s_waitcnt vmcnt(4)
    v_cmp_ne_u32 vcc, s28, v12
    s_cbranch_vccnz adaLN_cond__sliding_block_cached__moe_arch_mod__prompt_kernel_o17r
adaLN_cond__sliding_block_cached__moe_arch_mod__prompt_kernel_o17b:
    v_mfma_f32_16x16x32_bf16 v[204:207], v[240:243], v[108:111], v[204:207]
    ds_read_b128 v[232:235], v5 offset:24576
    s_mov_b32 s23, 0x0
    buffer_load_dwordx4 v[24:27], v6, s[8:11], s23 offen offset:0 sc1
    s_waitcnt lgkmcnt(3)
    v_mfma_f32_16x16x32_bf16 v[208:211], v[244:247], v[104:107], v[208:211]
    v_mfma_f32_16x16x32_bf16 v[212:215], v[244:247], v[108:111], v[212:215]
    ds_read_b128 v[236:239], v5 offset:25600
    s_mov_b32 s23, 0x20000
    buffer_load_dwordx4 v[28:31], v6, s[8:11], s23 offen offset:0 sc1
    s_waitcnt lgkmcnt(3)
    v_mfma_f32_16x16x32_bf16 v[200:203], v[224:227], v[112:115], v[200:203]
    v_mfma_f32_16x16x32_bf16 v[204:207], v[224:227], v[116:119], v[204:207]
    ds_read_b128 v[240:243], v5 offset:26624
    s_waitcnt lgkmcnt(3)
    v_mfma_f32_16x16x32_bf16 v[208:211], v[228:231], v[112:115], v[208:211]
    s_mov_b32 s23, 0x2000
    buffer_load_dwordx4 v[32:35], v6, s[8:11], s23 offen offset:0 sc1
    v_mfma_f32_16x16x32_bf16 v[212:215], v[228:231], v[116:119], v[212:215]
    ds_read_b128 v[244:247], v5 offset:27648
    s_waitcnt lgkmcnt(3)
    v_mfma_f32_16x16x32_bf16 v[200:203], v[232:235], v[120:123], v[200:203]
    v_mfma_f32_16x16x32_bf16 v[204:207], v[232:235], v[124:127], v[204:207]
    ds_read_b128 v[224:227], v5 offset:28672
    s_mov_b32 s23, 0x22000
    buffer_load_dwordx4 v[36:39], v6, s[8:11], s23 offen offset:0 sc1
    s_waitcnt lgkmcnt(3)
    v_mfma_f32_16x16x32_bf16 v[208:211], v[236:239], v[120:123], v[208:211]
    v_mfma_f32_16x16x32_bf16 v[212:215], v[236:239], v[124:127], v[212:215]
    ds_read_b128 v[228:231], v5 offset:29696
    s_waitcnt lgkmcnt(3)
    v_mfma_f32_16x16x32_bf16 v[200:203], v[240:243], v[128:131], v[200:203]
    s_mov_b32 s23, 0x4000
    buffer_load_dwordx4 v[40:43], v6, s[8:11], s23 offen offset:0 sc1
    v_mfma_f32_16x16x32_bf16 v[204:207], v[240:243], v[132:135], v[204:207]
    ds_read_b128 v[232:235], v5 offset:30720
    s_waitcnt lgkmcnt(3)
    v_mfma_f32_16x16x32_bf16 v[208:211], v[244:247], v[128:131], v[208:211]
    v_mfma_f32_16x16x32_bf16 v[212:215], v[244:247], v[132:135], v[212:215]
    ds_read_b128 v[236:239], v5 offset:31744
    s_mov_b32 s23, 0x24000
    buffer_load_dwordx4 v[44:47], v6, s[8:11], s23 offen offset:0 sc1
    s_waitcnt lgkmcnt(3)
    v_mfma_f32_16x16x32_bf16 v[200:203], v[224:227], v[136:139], v[200:203]
    v_bfe_u32 v18, v1, 2, 2
    v_lshrrev_b32 v19, 4, v1
    v_mfma_f32_16x16x32_bf16 v[204:207], v[224:227], v[140:143], v[204:207]
    v_and_b32 v17, 3, v1
    v_lshlrev_b32 v16, 11, v19
    s_waitcnt lgkmcnt(2)
    v_mfma_f32_16x16x32_bf16 v[208:211], v[228:231], v[136:139], v[208:211]
    s_mov_b32 s23, 0x6000
    buffer_load_dwordx4 v[48:51], v6, s[8:11], s23 offen offset:0 sc1
    v_lshl_add_u32 v16, v18, 6, v16
    v_lshl_add_u32 v16, v17, 3, v16
    v_mfma_f32_16x16x32_bf16 v[212:215], v[228:231], v[140:143], v[212:215]
    v_add_u32 v16, 0x12000, v16
    v_and_b32 v19, 1, v19
    s_waitcnt lgkmcnt(1)
    v_mfma_f32_16x16x32_bf16 v[200:203], v[232:235], v[144:147], v[200:203]
    v_lshlrev_b32 v19, 5, v19
    v_sub_u32 v5, v16, v19
    v_mfma_f32_16x16x32_bf16 v[204:207], v[232:235], v[148:151], v[204:207]
    s_mov_b32 s23, 0x26000
    buffer_load_dwordx4 v[52:55], v6, s[8:11], s23 offen offset:0 sc1
    v_add_u32 v4, v16, v19
    v_add_u32 v7, 0x10000, v4
    s_waitcnt lgkmcnt(0)
    v_mfma_f32_16x16x32_bf16 v[208:211], v[236:239], v[144:147], v[208:211]
    v_add_u32 v8, 0x10000, v5
    v_mfma_f32_16x16x32_bf16 v[212:215], v[236:239], v[148:151], v[212:215]
    s_mov_b32 s23, 0x8000
    buffer_load_dwordx4 v[56:59], v6, s[8:11], s23 offen offset:0 sc1
    s_mov_b32 s23, 0x28000
    buffer_load_dwordx4 v[60:63], v6, s[8:11], s23 offen offset:0 sc1
    v_mul_f32 v200, v200, v9
    v_mul_f32 v201, v201, v9
    v_mul_f32 v202, v202, v9
    v_mul_f32 v203, v203, v9
    v_mul_f32 v208, v208, v9
    v_mul_f32 v209, v209, v9
    v_mul_f32 v210, v210, v9
    v_mul_f32 v211, v211, v9
    v_cvt_pk_bf16_f32 v216, v200, v201
    v_cvt_pk_bf16_f32 v217, v202, v203
    v_cvt_pk_bf16_f32 v218, v208, v209
    v_cvt_pk_bf16_f32 v219, v210, v211
    buffer_store_dwordx4 v[216:219], v2, s[8:11], s25 offen offset:3072 sc1
    v_mul_f32 v204, v204, v10
    v_mul_f32 v205, v205, v10
    v_mul_f32 v206, v206, v10
    v_mul_f32 v207, v207, v10
    v_mul_f32 v212, v212, v10
    v_mul_f32 v213, v213, v10
    v_mul_f32 v214, v214, v10
    v_mul_f32 v215, v215, v10
    v_cvt_pk_bf16_f32 v220, v204, v205
    v_cvt_pk_bf16_f32 v221, v206, v207
    v_cvt_pk_bf16_f32 v222, v212, v213
    v_cvt_pk_bf16_f32 v223, v214, v215
    buffer_store_dwordx4 v[220:223], v2, s[8:11], s26 offen offset:3072 sc1
    s_and_b32 s15, s2, 1
    s_barrier
    ds_read_b64_tr_b16 v[224:225], v4 offset:0
    ds_read_b64_tr_b16 v[226:227], v4 offset:1024
    ds_read_b64_tr_b16 v[228:229], v5 offset:32
    ds_read_b64_tr_b16 v[230:231], v5 offset:1056
    ds_read_b64_tr_b16 v[232:233], v4 offset:256
    ds_read_b64_tr_b16 v[234:235], v4 offset:1280
    ds_read_b64_tr_b16 v[236:237], v5 offset:288
    ds_read_b64_tr_b16 v[238:239], v5 offset:1312
    s_waitcnt vmcnt(11) lgkmcnt(6)
    v_mfma_f32_16x16x32_bf16 v[88:91], v[224:227], v[24:27], 0
    ds_read_b64_tr_b16 v[240:241], v4 offset:512
    s_waitcnt vmcnt(10)
    v_mfma_f32_16x16x32_bf16 v[92:95], v[224:227], v[28:31], 0
    ds_read_b64_tr_b16 v[242:243], v4 offset:1536
    s_waitcnt lgkmcnt(6)
    v_mfma_f32_16x16x32_bf16 v[96:99], v[228:231], v[24:27], 0
    ds_read_b64_tr_b16 v[244:245], v5 offset:544
    v_mfma_f32_16x16x32_bf16 v[100:103], v[228:231], v[28:31], 0
    ds_read_b64_tr_b16 v[246:247], v5 offset:1568
    s_waitcnt lgkmcnt(6)
    v_mfma_f32_16x16x32_bf16 v[104:107], v[232:235], v[24:27], 0
    ds_read_b64_tr_b16 v[224:225], v4 offset:768
    v_mfma_f32_16x16x32_bf16 v[108:111], v[232:235], v[28:31], 0
    ds_read_b64_tr_b16 v[226:227], v4 offset:1792
    s_waitcnt lgkmcnt(6)
    v_mfma_f32_16x16x32_bf16 v[112:115], v[236:239], v[24:27], 0
    ds_read_b64_tr_b16 v[228:229], v5 offset:800
    v_mfma_f32_16x16x32_bf16 v[116:119], v[236:239], v[28:31], 0
    ds_read_b64_tr_b16 v[230:231], v5 offset:1824
    s_waitcnt lgkmcnt(6)
    v_mfma_f32_16x16x32_bf16 v[120:123], v[240:243], v[24:27], 0
    s_add_u32 s22, s24, 0x200000
    s_add_u32 m0, s20, 0x20000
    s_nop 0
    buffer_load_dwordx4 v3, s[4:7], s22 offen lds
    v_mfma_f32_16x16x32_bf16 v[124:127], v[240:243], v[28:31], 0
    s_barrier
    ds_read_b64_tr_b16 v[232:233], v4 offset:16384
    ds_read_b64_tr_b16 v[234:235], v4 offset:17408
    s_waitcnt lgkmcnt(6)
    v_mfma_f32_16x16x32_bf16 v[128:131], v[244:247], v[24:27], 0
    ds_read_b64_tr_b16 v[236:237], v5 offset:16416
    s_mov_b32 s23, 0xa000
    buffer_load_dwordx4 v[64:67], v6, s[8:11], s23 offen offset:0 sc1
    v_mfma_f32_16x16x32_bf16 v[132:135], v[244:247], v[28:31], 0
    s_add_u32 s22, s24, 0x202000
    s_add_u32 m0, s20, 0x20400
    s_nop 0
    buffer_load_dwordx4 v3, s[4:7], s22 offen lds
    ds_read_b64_tr_b16 v[238:239], v5 offset:17440
    s_waitcnt lgkmcnt(6)
    v_mfma_f32_16x16x32_bf16 v[136:139], v[224:227], v[24:27], 0
    ds_read_b64_tr_b16 v[240:241], v4 offset:16640
    v_mfma_f32_16x16x32_bf16 v[140:143], v[224:227], v[28:31], 0
    ds_read_b64_tr_b16 v[242:243], v4 offset:17664
    s_mov_b32 s23, 0x2a000
    buffer_load_dwordx4 v[68:71], v6, s[8:11], s23 offen offset:0 sc1
    s_waitcnt lgkmcnt(6)
    v_mfma_f32_16x16x32_bf16 v[144:147], v[228:231], v[24:27], 0
    ds_read_b64_tr_b16 v[244:245], v5 offset:16672
    v_mfma_f32_16x16x32_bf16 v[148:151], v[228:231], v[28:31], 0
    ds_read_b64_tr_b16 v[246:247], v5 offset:17696
    s_waitcnt vmcnt(13) lgkmcnt(6)
    v_mfma_f32_16x16x32_bf16 v[88:91], v[232:235], v[32:35], v[88:91]
    ds_read_b64_tr_b16 v[224:225], v4 offset:16896
    s_waitcnt vmcnt(12)
    v_mfma_f32_16x16x32_bf16 v[92:95], v[232:235], v[36:39], v[92:95]
    s_add_u32 s22, s24, 0x280000
    s_add_u32 m0, s20, 0x24000
    s_nop 0
    buffer_load_dwordx4 v3, s[4:7], s22 offen lds
    ds_read_b64_tr_b16 v[226:227], v4 offset:17920
    s_waitcnt lgkmcnt(6)
    v_mfma_f32_16x16x32_bf16 v[96:99], v[236:239], v[32:35], v[96:99]
    ds_read_b64_tr_b16 v[228:229], v5 offset:16928
    v_mfma_f32_16x16x32_bf16 v[100:103], v[236:239], v[36:39], v[100:103]
    ds_read_b64_tr_b16 v[230:231], v5 offset:17952
    s_waitcnt lgkmcnt(6)
    v_mfma_f32_16x16x32_bf16 v[104:107], v[240:243], v[32:35], v[104:107]
    s_add_u32 s22, s24, 0x282000
    s_add_u32 m0, s20, 0x24400
    s_nop 0
    buffer_load_dwordx4 v3, s[4:7], s22 offen lds
    ds_read_b64_tr_b16 v[232:233], v4 offset:17152
    v_mfma_f32_16x16x32_bf16 v[108:111], v[240:243], v[36:39], v[108:111]
    ds_read_b64_tr_b16 v[234:235], v4 offset:18176
    s_waitcnt lgkmcnt(6)
    v_mfma_f32_16x16x32_bf16 v[112:115], v[244:247], v[32:35], v[112:115]
    ds_read_b64_tr_b16 v[236:237], v5 offset:17184
    v_mfma_f32_16x16x32_bf16 v[116:119], v[244:247], v[36:39], v[116:119]
    ds_read_b64_tr_b16 v[238:239], v5 offset:18208
    s_waitcnt lgkmcnt(6)
    v_mfma_f32_16x16x32_bf16 v[120:123], v[224:227], v[32:35], v[120:123]
    v_mfma_f32_16x16x32_bf16 v[124:127], v[224:227], v[36:39], v[124:127]
    s_barrier
    ds_read_b64_tr_b16 v[240:241], v4 offset:32768
    ds_read_b64_tr_b16 v[242:243], v4 offset:33792
    s_add_u32 s19, s19, 8192
    buffer_load_dword v12, v13, s[8:11], s19 offen sc1
    s_waitcnt lgkmcnt(6)
    v_mfma_f32_16x16x32_bf16 v[128:131], v[228:231], v[32:35], v[128:131]
    ds_read_b64_tr_b16 v[244:245], v5 offset:32800
    s_mov_b32 s23, 0xc000
    buffer_load_dwordx4 v[24:27], v6, s[8:11], s23 offen offset:0 sc1
    v_mfma_f32_16x16x32_bf16 v[132:135], v[228:231], v[36:39], v[132:135]
    ds_read_b64_tr_b16 v[246:247], v5 offset:33824
    s_waitcnt lgkmcnt(6)
    v_mfma_f32_16x16x32_bf16 v[136:139], v[232:235], v[32:35], v[136:139]
    ds_read_b64_tr_b16 v[224:225], v4 offset:33024
    v_mfma_f32_16x16x32_bf16 v[140:143], v[232:235], v[36:39], v[140:143]
    ds_read_b64_tr_b16 v[226:227], v4 offset:34048
    s_mov_b32 s23, 0x2c000
    buffer_load_dwordx4 v[28:31], v6, s[8:11], s23 offen offset:0 sc1
    s_waitcnt lgkmcnt(6)
    v_mfma_f32_16x16x32_bf16 v[144:147], v[236:239], v[32:35], v[144:147]
    s_add_u32 s16, s63, 0x574000
    v_mov_b32 v14, s28
    v_mov_b32 v15, 0
    s_mov_b64 exec, 1
    buffer_store_dword v14, v15, s[8:11], s16 offen sc1
    s_mov_b64 exec, -1
    ds_read_b64_tr_b16 v[228:229], v5 offset:33056
    v_mfma_f32_16x16x32_bf16 v[148:151], v[236:239], v[36:39], v[148:151]
    ds_read_b64_tr_b16 v[230:231], v5 offset:34080
    s_waitcnt vmcnt(17) lgkmcnt(6)
    v_mfma_f32_16x16x32_bf16 v[88:91], v[240:243], v[40:43], v[88:91]
    ds_read_b64_tr_b16 v[232:233], v4 offset:33280
    s_waitcnt vmcnt(16)
    v_mfma_f32_16x16x32_bf16 v[92:95], v[240:243], v[44:47], v[92:95]
    s_add_u32 s22, s24, 0x300000
    s_add_u32 m0, s20, 0x10000
    s_nop 0
    buffer_load_dwordx4 v3, s[4:7], s22 offen lds
    ds_read_b64_tr_b16 v[234:235], v4 offset:34304
    s_waitcnt lgkmcnt(6)
    v_mfma_f32_16x16x32_bf16 v[96:99], v[244:247], v[40:43], v[96:99]
    ds_read_b64_tr_b16 v[236:237], v5 offset:33312
    v_mfma_f32_16x16x32_bf16 v[100:103], v[244:247], v[44:47], v[100:103]
    ds_read_b64_tr_b16 v[238:239], v5 offset:34336
    s_waitcnt lgkmcnt(6)
    v_mfma_f32_16x16x32_bf16 v[104:107], v[224:227], v[40:43], v[104:107]
    s_add_u32 s22, s24, 0x302000
    s_add_u32 m0, s20, 0x10400
    s_nop 0
    buffer_load_dwordx4 v3, s[4:7], s22 offen lds
    ds_read_b64_tr_b16 v[240:241], v4 offset:33536
    v_mfma_f32_16x16x32_bf16 v[108:111], v[224:227], v[44:47], v[108:111]
    ds_read_b64_tr_b16 v[242:243], v4 offset:34560
    s_waitcnt lgkmcnt(6)
    v_mfma_f32_16x16x32_bf16 v[112:115], v[228:231], v[40:43], v[112:115]
    ds_read_b64_tr_b16 v[244:245], v5 offset:33568
    v_mfma_f32_16x16x32_bf16 v[116:119], v[228:231], v[44:47], v[116:119]
    ds_read_b64_tr_b16 v[246:247], v5 offset:34592
    s_waitcnt lgkmcnt(6)
    v_mfma_f32_16x16x32_bf16 v[120:123], v[232:235], v[40:43], v[120:123]
    v_mfma_f32_16x16x32_bf16 v[124:127], v[232:235], v[44:47], v[124:127]
    s_barrier
    ds_read_b64_tr_b16 v[224:225], v4 offset:49152
    ds_read_b64_tr_b16 v[226:227], v4 offset:50176
    s_waitcnt lgkmcnt(6)
    v_mfma_f32_16x16x32_bf16 v[128:131], v[236:239], v[40:43], v[128:131]
    ds_read_b64_tr_b16 v[228:229], v5 offset:49184
    s_mov_b32 s23, 0xe000
    buffer_load_dwordx4 v[32:35], v6, s[8:11], s23 offen offset:0 sc1
    v_mfma_f32_16x16x32_bf16 v[132:135], v[236:239], v[44:47], v[132:135]
    ds_read_b64_tr_b16 v[230:231], v5 offset:50208
    s_waitcnt lgkmcnt(6)
    v_mfma_f32_16x16x32_bf16 v[136:139], v[240:243], v[40:43], v[136:139]
    ds_read_b64_tr_b16 v[232:233], v4 offset:49408
    v_mfma_f32_16x16x32_bf16 v[140:143], v[240:243], v[44:47], v[140:143]
    ds_read_b64_tr_b16 v[234:235], v4 offset:50432
    s_mov_b32 s23, 0x2e000
    buffer_load_dwordx4 v[36:39], v6, s[8:11], s23 offen offset:0 sc1
    s_waitcnt lgkmcnt(6)
    v_mfma_f32_16x16x32_bf16 v[144:147], v[244:247], v[40:43], v[144:147]
    ds_read_b64_tr_b16 v[236:237], v5 offset:49440
    v_mfma_f32_16x16x32_bf16 v[148:151], v[244:247], v[44:47], v[148:151]
    ds_read_b64_tr_b16 v[238:239], v5 offset:50464
    s_waitcnt vmcnt(7)
    v_cmp_ne_u32 vcc, s28, v12
    s_cbranch_vccnz adaLN_cond__sliding_block_cached__moe_arch_mod__prompt_kernel_o218r
adaLN_cond__sliding_block_cached__moe_arch_mod__prompt_kernel_o218b:
    s_waitcnt lgkmcnt(6)
    v_mfma_f32_16x16x32_bf16 v[88:91], v[224:227], v[48:51], v[88:91]
    ds_read_b64_tr_b16 v[240:241], v4 offset:49664
    v_mfma_f32_16x16x32_bf16 v[92:95], v[224:227], v[52:55], v[92:95]
    s_add_u32 s22, s24, 0x380000
    s_add_u32 m0, s20, 0x14000
    s_nop 0
    buffer_load_dwordx4 v3, s[4:7], s22 offen lds
    ds_read_b64_tr_b16 v[242:243], v4 offset:50688
    s_waitcnt lgkmcnt(6)
    v_mfma_f32_16x16x32_bf16 v[96:99], v[228:231], v[48:51], v[96:99]
    ds_read_b64_tr_b16 v[244:245], v5 offset:49696
    v_mfma_f32_16x16x32_bf16 v[100:103], v[228:231], v[52:55], v[100:103]
    ds_read_b64_tr_b16 v[246:247], v5 offset:50720
    s_waitcnt lgkmcnt(6)
    v_mfma_f32_16x16x32_bf16 v[104:107], v[232:235], v[48:51], v[104:107]
    s_add_u32 s22, s24, 0x382000
    s_add_u32 m0, s20, 0x14400
    s_nop 0
    buffer_load_dwordx4 v3, s[4:7], s22 offen lds
    ds_read_b64_tr_b16 v[224:225], v4 offset:49920
    v_mfma_f32_16x16x32_bf16 v[108:111], v[232:235], v[52:55], v[108:111]
    ds_read_b64_tr_b16 v[226:227], v4 offset:50944
    s_waitcnt lgkmcnt(6)
    v_mfma_f32_16x16x32_bf16 v[112:115], v[236:239], v[48:51], v[112:115]
    ds_read_b64_tr_b16 v[228:229], v5 offset:49952
    v_mfma_f32_16x16x32_bf16 v[116:119], v[236:239], v[52:55], v[116:119]
    ds_read_b64_tr_b16 v[230:231], v5 offset:50976
    s_waitcnt lgkmcnt(6)
    v_mfma_f32_16x16x32_bf16 v[120:123], v[240:243], v[48:51], v[120:123]
    v_mfma_f32_16x16x32_bf16 v[124:127], v[240:243], v[52:55], v[124:127]
    s_barrier
    ds_read_b64_tr_b16 v[232:233], v7 offset:0
    ds_read_b64_tr_b16 v[234:235], v7 offset:1024
    s_waitcnt lgkmcnt(6)
    v_mfma_f32_16x16x32_bf16 v[128:131], v[244:247], v[48:51], v[128:131]
    ds_read_b64_tr_b16 v[236:237], v8 offset:32
    s_mov_b32 s23, 0x0
    buffer_load_dwordx4 v[40:43], v6, s[8:11], s23 offen offset:1024 sc1
    v_mfma_f32_16x16x32_bf16 v[132:135], v[244:247], v[52:55], v[132:135]
    ds_read_b64_tr_b16 v[238:239], v8 offset:1056
    s_waitcnt lgkmcnt(6)
    v_mfma_f32_16x16x32_bf16 v[136:139], v[224:227], v[48:51], v[136:139]
    ds_read_b64_tr_b16 v[240:241], v7 offset:256
    v_mfma_f32_16x16x32_bf16 v[140:143], v[224:227], v[52:55], v[140:143]
    ds_read_b64_tr_b16 v[242:243], v7 offset:1280
    s_mov_b32 s23, 0x20000
    buffer_load_dwordx4 v[44:47], v6, s[8:11], s23 offen offset:1024 sc1
    s_waitcnt lgkmcnt(6)
    v_mfma_f32_16x16x32_bf16 v[144:147], v[228:231], v[48:51], v[144:147]
    ds_read_b64_tr_b16 v[244:245], v8 offset:288
    v_mfma_f32_16x16x32_bf16 v[148:151], v[228:231], v[52:55], v[148:151]
    ds_read_b64_tr_b16 v[246:247], v8 offset:1312
    s_waitcnt lgkmcnt(6)
    v_mfma_f32_16x16x32_bf16 v[88:91], v[232:235], v[56:59], v[88:91]
    ds_read_b64_tr_b16 v[224:225], v7 offset:512
    v_mfma_f32_16x16x32_bf16 v[92:95], v[232:235], v[60:63], v[92:95]
    s_add_u32 s22, s24, 0x10000
    s_add_u32 m0, s20, 0x18000
    s_nop 0
    buffer_load_dwordx4 v3, s[4:7], s22 offen lds
    ds_read_b64_tr_b16 v[226:227], v7 offset:1536
    s_waitcnt lgkmcnt(6)
    v_mfma_f32_16x16x32_bf16 v[96:99], v[236:239], v[56:59], v[96:99]
    ds_read_b64_tr_b16 v[228:229], v8 offset:544
    v_mfma_f32_16x16x32_bf16 v[100:103], v[236:239], v[60:63], v[100:103]
    ds_read_b64_tr_b16 v[230:231], v8 offset:1568
    s_waitcnt lgkmcnt(6)
    v_mfma_f32_16x16x32_bf16 v[104:107], v[240:243], v[56:59], v[104:107]
    s_add_u32 s22, s24, 0x12000
    s_add_u32 m0, s20, 0x18400
    s_nop 0
    buffer_load_dwordx4 v3, s[4:7], s22 offen lds
    ds_read_b64_tr_b16 v[232:233], v7 offset:768
    v_mfma_f32_16x16x32_bf16 v[108:111], v[240:243], v[60:63], v[108:111]
    ds_read_b64_tr_b16 v[234:235], v7 offset:1792
    s_waitcnt lgkmcnt(6)
    v_mfma_f32_16x16x32_bf16 v[112:115], v[244:247], v[56:59], v[112:115]
    ds_read_b64_tr_b16 v[236:237], v8 offset:800
    v_mfma_f32_16x16x32_bf16 v[116:119], v[244:247], v[60:63], v[116:119]
    ds_read_b64_tr_b16 v[238:239], v8 offset:1824
    s_waitcnt lgkmcnt(6)
    v_mfma_f32_16x16x32_bf16 v[120:123], v[224:227], v[56:59], v[120:123]
    v_mfma_f32_16x16x32_bf16 v[124:127], v[224:227], v[60:63], v[124:127]
    s_barrier
    ds_read_b64_tr_b16 v[240:241], v7 offset:16384
    ds_read_b64_tr_b16 v[242:243], v7 offset:17408
    s_waitcnt lgkmcnt(6)
    v_mfma_f32_16x16x32_bf16 v[128:131], v[228:231], v[56:59], v[128:131]
    ds_read_b64_tr_b16 v[244:245], v8 offset:16416
    s_mov_b32 s23, 0x2000
    buffer_load_dwordx4 v[48:51], v6, s[8:11], s23 offen offset:1024 sc1
    v_mfma_f32_16x16x32_bf16 v[132:135], v[228:231], v[60:63], v[132:135]
    ds_read_b64_tr_b16 v[246:247], v8 offset:17440
    s_waitcnt lgkmcnt(6)
    v_mfma_f32_16x16x32_bf16 v[136:139], v[232:235], v[56:59], v[136:139]
    ds_read_b64_tr_b16 v[224:225], v7 offset:16640
    v_mfma_f32_16x16x32_bf16 v[140:143], v[232:235], v[60:63], v[140:143]
    ds_read_b64_tr_b16 v[226:227], v7 offset:17664
    s_mov_b32 s23, 0x22000
    buffer_load_dwordx4 v[52:55], v6, s[8:11], s23 offen offset:1024 sc1
    s_waitcnt lgkmcnt(6)
    v_mfma_f32_16x16x32_bf16 v[144:147], v[236:239], v[56:59], v[144:147]
    ds_read_b64_tr_b16 v[228:229], v8 offset:16672
    v_mfma_f32_16x16x32_bf16 v[148:151], v[236:239], v[60:63], v[148:151]
    ds_read_b64_tr_b16 v[230:231], v8 offset:17696
    s_waitcnt lgkmcnt(6)
    v_mfma_f32_16x16x32_bf16 v[88:91], v[240:243], v[64:67], v[88:91]
    ds_read_b64_tr_b16 v[232:233], v7 offset:16896
    v_mfma_f32_16x16x32_bf16 v[92:95], v[240:243], v[68:71], v[92:95]
    s_add_u32 s22, s24, 0x90000
    s_add_u32 m0, s20, 0x1c000
    s_nop 0
    buffer_load_dwordx4 v3, s[4:7], s22 offen lds
    ds_read_b64_tr_b16 v[234:235], v7 offset:17920
    s_waitcnt lgkmcnt(6)
    v_mfma_f32_16x16x32_bf16 v[96:99], v[244:247], v[64:67], v[96:99]
    ds_read_b64_tr_b16 v[236:237], v8 offset:16928
    v_mfma_f32_16x16x32_bf16 v[100:103], v[244:247], v[68:71], v[100:103]
    ds_read_b64_tr_b16 v[238:239], v8 offset:17952
    s_waitcnt lgkmcnt(6)
    v_mfma_f32_16x16x32_bf16 v[104:107], v[224:227], v[64:67], v[104:107]
    s_add_u32 s22, s24, 0x92000
    s_add_u32 m0, s20, 0x1c400
    s_nop 0
    buffer_load_dwordx4 v3, s[4:7], s22 offen lds
    ds_read_b64_tr_b16 v[240:241], v7 offset:17152
    v_mfma_f32_16x16x32_bf16 v[108:111], v[224:227], v[68:71], v[108:111]
    ds_read_b64_tr_b16 v[242:243], v7 offset:18176
    s_waitcnt lgkmcnt(6)
    v_mfma_f32_16x16x32_bf16 v[112:115], v[228:231], v[64:67], v[112:115]
    ds_read_b64_tr_b16 v[244:245], v8 offset:17184
    v_mfma_f32_16x16x32_bf16 v[116:119], v[228:231], v[68:71], v[116:119]
    ds_read_b64_tr_b16 v[246:247], v8 offset:18208
    s_waitcnt lgkmcnt(6)
    v_mfma_f32_16x16x32_bf16 v[120:123], v[232:235], v[64:67], v[120:123]
    v_mfma_f32_16x16x32_bf16 v[124:127], v[232:235], v[68:71], v[124:127]
    s_waitcnt vmcnt(12)
    s_barrier
    ds_read_b64_tr_b16 v[224:225], v4 offset:0
    ds_read_b64_tr_b16 v[226:227], v4 offset:1024
    s_waitcnt lgkmcnt(6)
    v_mfma_f32_16x16x32_bf16 v[128:131], v[236:239], v[64:67], v[128:131]
    s_add_u32 s16, s63, 0x576000
    v_mov_b32 v14, s28
    v_mov_b32 v15, 0
    s_mov_b64 exec, 1
    buffer_store_dword v14, v15, s[8:11], s16 offen sc1
    s_mov_b64 exec, -1
    ds_read_b64_tr_b16 v[228:229], v5 offset:32
    s_mov_b32 s23, 0x4000
    buffer_load_dwordx4 v[56:59], v6, s[8:11], s23 offen offset:1024 sc1
    v_mfma_f32_16x16x32_bf16 v[132:135], v[236:239], v[68:71], v[132:135]
    ds_read_b64_tr_b16 v[230:231], v5 offset:1056
    s_waitcnt lgkmcnt(6)
    v_mfma_f32_16x16x32_bf16 v[136:139], v[240:243], v[64:67], v[136:139]
    ds_read_b64_tr_b16 v[232:233], v4 offset:256
    v_mfma_f32_16x16x32_bf16 v[140:143], v[240:243], v[68:71], v[140:143]
    ds_read_b64_tr_b16 v[234:235], v4 offset:1280
    s_mov_b32 s23, 0x24000
    buffer_load_dwordx4 v[60:63], v6, s[8:11], s23 offen offset:1024 sc1
    s_waitcnt lgkmcnt(6)
    v_mfma_f32_16x16x32_bf16 v[144:147], v[244:247], v[64:67], v[144:147]
    ds_read_b64_tr_b16 v[236:237], v5 offset:288
    v_mfma_f32_16x16x32_bf16 v[148:151], v[244:247], v[68:71], v[148:151]
    ds_read_b64_tr_b16 v[238:239], v5 offset:1312
    s_waitcnt lgkmcnt(6)
    v_mfma_f32_16x16x32_bf16 v[88:91], v[224:227], v[24:27], v[88:91]
    ds_read_b64_tr_b16 v[240:241], v4 offset:512
    v_mfma_f32_16x16x32_bf16 v[92:95], v[224:227], v[28:31], v[92:95]
    s_add_u32 s22, s24, 0x110000
    s_add_u32 m0, s20, 0x20000
    s_nop 0
    buffer_load_dwordx4 v3, s[4:7], s22 offen lds
    ds_read_b64_tr_b16 v[242:243], v4 offset:1536
    s_waitcnt lgkmcnt(6)
    v_mfma_f32_16x16x32_bf16 v[96:99], v[228:231], v[24:27], v[96:99]
    ds_read_b64_tr_b16 v[244:245], v5 offset:544
    v_mfma_f32_16x16x32_bf16 v[100:103], v[228:231], v[28:31], v[100:103]
    ds_read_b64_tr_b16 v[246:247], v5 offset:1568
    s_waitcnt lgkmcnt(6)
    v_mfma_f32_16x16x32_bf16 v[104:107], v[232:235], v[24:27], v[104:107]
    s_add_u32 s22, s24, 0x112000
    s_add_u32 m0, s20, 0x20400
    s_nop 0
    buffer_load_dwordx4 v3, s[4:7], s22 offen lds
    ds_read_b64_tr_b16 v[224:225], v4 offset:768
    v_mfma_f32_16x16x32_bf16 v[108:111], v[232:235], v[28:31], v[108:111]
    ds_read_b64_tr_b16 v[226:227], v4 offset:1792
    s_waitcnt lgkmcnt(6)
    v_mfma_f32_16x16x32_bf16 v[112:115], v[236:239], v[24:27], v[112:115]
    ds_read_b64_tr_b16 v[228:229], v5 offset:800
    v_mfma_f32_16x16x32_bf16 v[116:119], v[236:239], v[28:31], v[116:119]
    ds_read_b64_tr_b16 v[230:231], v5 offset:1824
    s_waitcnt lgkmcnt(6)
    v_mfma_f32_16x16x32_bf16 v[120:123], v[240:243], v[24:27], v[120:123]
    v_mfma_f32_16x16x32_bf16 v[124:127], v[240:243], v[28:31], v[124:127]
    s_waitcnt vmcnt(13)
    s_barrier
    ds_read_b64_tr_b16 v[232:233], v4 offset:16384
    ds_read_b64_tr_b16 v[234:235], v4 offset:17408
    s_waitcnt lgkmcnt(6)
    v_mfma_f32_16x16x32_bf16 v[128:131], v[244:247], v[24:27], v[128:131]
    ds_read_b64_tr_b16 v[236:237], v5 offset:16416
    s_mov_b32 s23, 0x6000
    buffer_load_dwordx4 v[64:67], v6, s[8:11], s23 offen offset:1024 sc1
    v_mfma_f32_16x16x32_bf16 v[132:135], v[244:247], v[28:31], v[132:135]
    ds_read_b64_tr_b16 v[238:239], v5 offset:17440
    s_waitcnt lgkmcnt(6)
    v_mfma_f32_16x16x32_bf16 v[136:139], v[224:227], v[24:27], v[136:139]
    ds_read_b64_tr_b16 v[240:241], v4 offset:16640
    v_mfma_f32_16x16x32_bf16 v[140:143], v[224:227], v[28:31], v[140:143]
    ds_read_b64_tr_b16 v[242:243], v4 offset:17664
    s_mov_b32 s23, 0x26000
    buffer_load_dwordx4 v[68:71], v6, s[8:11], s23 offen offset:1024 sc1
    s_waitcnt lgkmcnt(6)
    v_mfma_f32_16x16x32_bf16 v[144:147], v[228:231], v[24:27], v[144:147]
    ds_read_b64_tr_b16 v[244:245], v5 offset:16672
    v_mfma_f32_16x16x32_bf16 v[148:151], v[228:231], v[28:31], v[148:151]
    ds_read_b64_tr_b16 v[246:247], v5 offset:17696
    s_waitcnt lgkmcnt(6)
    v_mfma_f32_16x16x32_bf16 v[88:91], v[232:235], v[32:35], v[88:91]
    ds_read_b64_tr_b16 v[224:225], v4 offset:16896
    v_mfma_f32_16x16x32_bf16 v[92:95], v[232:235], v[36:39], v[92:95]
    s_add_u32 s22, s24, 0x190000
    s_add_u32 m0, s20, 0x24000
    s_nop 0
    buffer_load_dwordx4 v3, s[4:7], s22 offen lds
    ds_read_b64_tr_b16 v[226:227], v4 offset:17920
    s_waitcnt lgkmcnt(6)
    v_mfma_f32_16x16x32_bf16 v[96:99], v[236:239], v[32:35], v[96:99]
    ds_read_b64_tr_b16 v[228:229], v5 offset:16928
    v_mfma_f32_16x16x32_bf16 v[100:103], v[236:239], v[36:39], v[100:103]
    ds_read_b64_tr_b16 v[230:231], v5 offset:17952
    s_waitcnt lgkmcnt(6)
    v_mfma_f32_16x16x32_bf16 v[104:107], v[240:243], v[32:35], v[104:107]
    s_add_u32 s22, s24, 0x192000
    s_add_u32 m0, s20, 0x24400
    s_nop 0
    buffer_load_dwordx4 v3, s[4:7], s22 offen lds
    ds_read_b64_tr_b16 v[232:233], v4 offset:17152
    v_mfma_f32_16x16x32_bf16 v[108:111], v[240:243], v[36:39], v[108:111]
    ds_read_b64_tr_b16 v[234:235], v4 offset:18176
    s_waitcnt lgkmcnt(6)
    v_mfma_f32_16x16x32_bf16 v[112:115], v[244:247], v[32:35], v[112:115]
    ds_read_b64_tr_b16 v[236:237], v5 offset:17184
    v_mfma_f32_16x16x32_bf16 v[116:119], v[244:247], v[36:39], v[116:119]
    ds_read_b64_tr_b16 v[238:239], v5 offset:18208
    s_waitcnt lgkmcnt(6)
    v_mfma_f32_16x16x32_bf16 v[120:123], v[224:227], v[32:35], v[120:123]
    v_mfma_f32_16x16x32_bf16 v[124:127], v[224:227], v[36:39], v[124:127]
    s_waitcnt vmcnt(13)
    s_barrier
    ds_read_b64_tr_b16 v[240:241], v4 offset:32768
    ds_read_b64_tr_b16 v[242:243], v4 offset:33792
    s_waitcnt lgkmcnt(6)
    v_mfma_f32_16x16x32_bf16 v[128:131], v[228:231], v[32:35], v[128:131]
    ds_read_b64_tr_b16 v[244:245], v5 offset:32800
    s_mov_b32 s23, 0x8000
    buffer_load_dwordx4 v[24:27], v6, s[8:11], s23 offen offset:1024 sc1
    v_mfma_f32_16x16x32_bf16 v[132:135], v[228:231], v[36:39], v[132:135]
    ds_read_b64_tr_b16 v[246:247], v5 offset:33824
    s_waitcnt lgkmcnt(6)
    v_mfma_f32_16x16x32_bf16 v[136:139], v[232:235], v[32:35], v[136:139]
    ds_read_b64_tr_b16 v[224:225], v4 offset:33024
    v_mfma_f32_16x16x32_bf16 v[140:143], v[232:235], v[36:39], v[140:143]
    ds_read_b64_tr_b16 v[226:227], v4 offset:34048
    s_mov_b32 s23, 0x28000
    buffer_load_dwordx4 v[28:31], v6, s[8:11], s23 offen offset:1024 sc1
    s_waitcnt lgkmcnt(6)
    v_mfma_f32_16x16x32_bf16 v[144:147], v[236:239], v[32:35], v[144:147]
    ds_read_b64_tr_b16 v[228:229], v5 offset:33056
    v_mfma_f32_16x16x32_bf16 v[148:151], v[236:239], v[36:39], v[148:151]
    ds_read_b64_tr_b16 v[230:231], v5 offset:34080
    s_waitcnt lgkmcnt(6)
    v_mfma_f32_16x16x32_bf16 v[88:91], v[240:243], v[40:43], v[88:91]
    ds_read_b64_tr_b16 v[232:233], v4 offset:33280
    v_mfma_f32_16x16x32_bf16 v[92:95], v[240:243], v[44:47], v[92:95]
    s_add_u32 s22, s24, 0x210000
    s_add_u32 m0, s20, 0x10000
    s_nop 0
    buffer_load_dwordx4 v3, s[4:7], s22 offen lds
    ds_read_b64_tr_b16 v[234:235], v4 offset:34304
    s_waitcnt lgkmcnt(6)
    v_mfma_f32_16x16x32_bf16 v[96:99], v[244:247], v[40:43], v[96:99]
    ds_read_b64_tr_b16 v[236:237], v5 offset:33312
    v_mfma_f32_16x16x32_bf16 v[100:103], v[244:247], v[44:47], v[100:103]
    ds_read_b64_tr_b16 v[238:239], v5 offset:34336
    s_waitcnt lgkmcnt(6)
    v_mfma_f32_16x16x32_bf16 v[104:107], v[224:227], v[40:43], v[104:107]
    s_add_u32 s22, s24, 0x212000
    s_add_u32 m0, s20, 0x10400
    s_nop 0
    buffer_load_dwordx4 v3, s[4:7], s22 offen lds
    ds_read_b64_tr_b16 v[240:241], v4 offset:33536
    v_mfma_f32_16x16x32_bf16 v[108:111], v[224:227], v[44:47], v[108:111]
    ds_read_b64_tr_b16 v[242:243], v4 offset:34560
    s_waitcnt lgkmcnt(6)
    v_mfma_f32_16x16x32_bf16 v[112:115], v[228:231], v[40:43], v[112:115]
    ds_read_b64_tr_b16 v[244:245], v5 offset:33568
    v_mfma_f32_16x16x32_bf16 v[116:119], v[228:231], v[44:47], v[116:119]
    ds_read_b64_tr_b16 v[246:247], v5 offset:34592
    s_waitcnt lgkmcnt(6)
    v_mfma_f32_16x16x32_bf16 v[120:123], v[232:235], v[40:43], v[120:123]
    v_mfma_f32_16x16x32_bf16 v[124:127], v[232:235], v[44:47], v[124:127]
    s_waitcnt vmcnt(13)
    s_barrier
    ds_read_b64_tr_b16 v[224:225], v4 offset:49152
    ds_read_b64_tr_b16 v[226:227], v4 offset:50176
    s_waitcnt lgkmcnt(6)
    v_mfma_f32_16x16x32_bf16 v[128:131], v[236:239], v[40:43], v[128:131]
    ds_read_b64_tr_b16 v[228:229], v5 offset:49184
    s_mov_b32 s23, 0xa000
    buffer_load_dwordx4 v[32:35], v6, s[8:11], s23 offen offset:1024 sc1
    v_mfma_f32_16x16x32_bf16 v[132:135], v[236:239], v[44:47], v[132:135]
    ds_read_b64_tr_b16 v[230:231], v5 offset:50208
    s_waitcnt lgkmcnt(6)
    v_mfma_f32_16x16x32_bf16 v[136:139], v[240:243], v[40:43], v[136:139]
    ds_read_b64_tr_b16 v[232:233], v4 offset:49408
    v_mfma_f32_16x16x32_bf16 v[140:143], v[240:243], v[44:47], v[140:143]
    ds_read_b64_tr_b16 v[234:235], v4 offset:50432
    s_mov_b32 s23, 0x2a000
    buffer_load_dwordx4 v[36:39], v6, s[8:11], s23 offen offset:1024 sc1
    s_waitcnt lgkmcnt(6)
    v_mfma_f32_16x16x32_bf16 v[144:147], v[244:247], v[40:43], v[144:147]
    ds_read_b64_tr_b16 v[236:237], v5 offset:49440
    v_mfma_f32_16x16x32_bf16 v[148:151], v[244:247], v[44:47], v[148:151]
    ds_read_b64_tr_b16 v[238:239], v5 offset:50464
    s_waitcnt lgkmcnt(6)
    v_mfma_f32_16x16x32_bf16 v[88:91], v[224:227], v[48:51], v[88:91]
    ds_read_b64_tr_b16 v[240:241], v4 offset:49664
    v_mfma_f32_16x16x32_bf16 v[92:95], v[224:227], v[52:55], v[92:95]
    s_add_u32 s22, s24, 0x290000
    s_add_u32 m0, s20, 0x14000
    s_nop 0
    buffer_load_dwordx4 v3, s[4:7], s22 offen lds
    ds_read_b64_tr_b16 v[242:243], v4 offset:50688
    s_waitcnt lgkmcnt(6)
    v_mfma_f32_16x16x32_bf16 v[96:99], v[228:231], v[48:51], v[96:99]
    ds_read_b64_tr_b16 v[244:245], v5 offset:49696
    v_mfma_f32_16x16x32_bf16 v[100:103], v[228:231], v[52:55], v[100:103]
    ds_read_b64_tr_b16 v[246:247], v5 offset:50720
    s_waitcnt lgkmcnt(6)
    v_mfma_f32_16x16x32_bf16 v[104:107], v[232:235], v[48:51], v[104:107]
    s_add_u32 s22, s24, 0x292000
    s_add_u32 m0, s20, 0x14400
    s_nop 0
    buffer_load_dwordx4 v3, s[4:7], s22 offen lds
    ds_read_b64_tr_b16 v[224:225], v4 offset:49920
    v_mfma_f32_16x16x32_bf16 v[108:111], v[232:235], v[52:55], v[108:111]
    ds_read_b64_tr_b16 v[226:227], v4 offset:50944
    s_waitcnt lgkmcnt(6)
    v_mfma_f32_16x16x32_bf16 v[112:115], v[236:239], v[48:51], v[112:115]
    ds_read_b64_tr_b16 v[228:229], v5 offset:49952
    v_mfma_f32_16x16x32_bf16 v[116:119], v[236:239], v[52:55], v[116:119]
    ds_read_b64_tr_b16 v[230:231], v5 offset:50976
    s_waitcnt lgkmcnt(6)
    v_mfma_f32_16x16x32_bf16 v[120:123], v[240:243], v[48:51], v[120:123]
    v_mfma_f32_16x16x32_bf16 v[124:127], v[240:243], v[52:55], v[124:127]
    s_waitcnt vmcnt(12)
    s_barrier
    ds_read_b64_tr_b16 v[232:233], v7 offset:0
    ds_read_b64_tr_b16 v[234:235], v7 offset:1024
    s_add_u32 s19, s19, 8192
    buffer_load_dword v12, v13, s[8:11], s19 offen sc1
    s_waitcnt lgkmcnt(6)
    v_mfma_f32_16x16x32_bf16 v[128:131], v[244:247], v[48:51], v[128:131]
    ds_read_b64_tr_b16 v[236:237], v8 offset:32
    s_mov_b32 s23, 0xc000
    buffer_load_dwordx4 v[40:43], v6, s[8:11], s23 offen offset:1024 sc1
    v_mfma_f32_16x16x32_bf16 v[132:135], v[244:247], v[52:55], v[132:135]
    ds_read_b64_tr_b16 v[238:239], v8 offset:1056
    s_waitcnt lgkmcnt(6)
    v_mfma_f32_16x16x32_bf16 v[136:139], v[224:227], v[48:51], v[136:139]
    ds_read_b64_tr_b16 v[240:241], v7 offset:256
    v_mfma_f32_16x16x32_bf16 v[140:143], v[224:227], v[52:55], v[140:143]
    ds_read_b64_tr_b16 v[242:243], v7 offset:1280
    s_mov_b32 s23, 0x2c000
    buffer_load_dwordx4 v[44:47], v6, s[8:11], s23 offen offset:1024 sc1
    s_waitcnt lgkmcnt(6)
    v_mfma_f32_16x16x32_bf16 v[144:147], v[228:231], v[48:51], v[144:147]
    ds_read_b64_tr_b16 v[244:245], v8 offset:288
    v_mfma_f32_16x16x32_bf16 v[148:151], v[228:231], v[52:55], v[148:151]
    ds_read_b64_tr_b16 v[246:247], v8 offset:1312
    s_waitcnt lgkmcnt(6)
    v_mfma_f32_16x16x32_bf16 v[88:91], v[232:235], v[56:59], v[88:91]
    ds_read_b64_tr_b16 v[224:225], v7 offset:512
    v_mfma_f32_16x16x32_bf16 v[92:95], v[232:235], v[60:63], v[92:95]
    s_add_u32 s22, s24, 0x310000
    s_add_u32 m0, s20, 0x18000
    s_nop 0
    buffer_load_dwordx4 v3, s[4:7], s22 offen lds
    ds_read_b64_tr_b16 v[226:227], v7 offset:1536
    s_waitcnt lgkmcnt(6)
    v_mfma_f32_16x16x32_bf16 v[96:99], v[236:239], v[56:59], v[96:99]
    ds_read_b64_tr_b16 v[228:229], v8 offset:544
    v_mfma_f32_16x16x32_bf16 v[100:103], v[236:239], v[60:63], v[100:103]
    ds_read_b64_tr_b16 v[230:231], v8 offset:1568
    s_waitcnt lgkmcnt(6)
    v_mfma_f32_16x16x32_bf16 v[104:107], v[240:243], v[56:59], v[104:107]
    s_add_u32 s22, s24, 0x312000
    s_add_u32 m0, s20, 0x18400
    s_nop 0
    buffer_load_dwordx4 v3, s[4:7], s22 offen lds
    ds_read_b64_tr_b16 v[232:233], v7 offset:768
    v_mfma_f32_16x16x32_bf16 v[108:111], v[240:243], v[60:63], v[108:111]
    ds_read_b64_tr_b16 v[234:235], v7 offset:1792
    s_waitcnt lgkmcnt(6)
    v_mfma_f32_16x16x32_bf16 v[112:115], v[244:247], v[56:59], v[112:115]
    ds_read_b64_tr_b16 v[236:237], v8 offset:800
    v_mfma_f32_16x16x32_bf16 v[116:119], v[244:247], v[60:63], v[116:119]
    ds_read_b64_tr_b16 v[238:239], v8 offset:1824
    s_waitcnt lgkmcnt(6)
    v_mfma_f32_16x16x32_bf16 v[120:123], v[224:227], v[56:59], v[120:123]
    v_mfma_f32_16x16x32_bf16 v[124:127], v[224:227], v[60:63], v[124:127]
    s_waitcnt vmcnt(13)
    s_barrier
    ds_read_b64_tr_b16 v[240:241], v7 offset:16384
    ds_read_b64_tr_b16 v[242:243], v7 offset:17408
    s_waitcnt lgkmcnt(6)
    v_mfma_f32_16x16x32_bf16 v[128:131], v[228:231], v[56:59], v[128:131]
    ds_read_b64_tr_b16 v[244:245], v8 offset:16416
    s_mov_b32 s23, 0xe000
    buffer_load_dwordx4 v[48:51], v6, s[8:11], s23 offen offset:1024 sc1
    v_mfma_f32_16x16x32_bf16 v[132:135], v[228:231], v[60:63], v[132:135]
    ds_read_b64_tr_b16 v[246:247], v8 offset:17440
    s_waitcnt lgkmcnt(6)
    v_mfma_f32_16x16x32_bf16 v[136:139], v[232:235], v[56:59], v[136:139]
    ds_read_b64_tr_b16 v[224:225], v7 offset:16640
    v_mfma_f32_16x16x32_bf16 v[140:143], v[232:235], v[60:63], v[140:143]
    ds_read_b64_tr_b16 v[226:227], v7 offset:17664
    s_mov_b32 s23, 0x2e000
    buffer_load_dwordx4 v[52:55], v6, s[8:11], s23 offen offset:1024 sc1
    s_waitcnt lgkmcnt(6)
    v_mfma_f32_16x16x32_bf16 v[144:147], v[236:239], v[56:59], v[144:147]
    ds_read_b64_tr_b16 v[228:229], v8 offset:16672
    v_mfma_f32_16x16x32_bf16 v[148:151], v[236:239], v[60:63], v[148:151]
    ds_read_b64_tr_b16 v[230:231], v8 offset:17696
    s_waitcnt vmcnt(6)
    v_cmp_ne_u32 vcc, s28, v12
    s_cbranch_vccnz adaLN_cond__sliding_block_cached__moe_arch_mod__prompt_kernel_o219r
adaLN_cond__sliding_block_cached__moe_arch_mod__prompt_kernel_o219b:
    s_waitcnt lgkmcnt(6)
    v_mfma_f32_16x16x32_bf16 v[88:91], v[240:243], v[64:67], v[88:91]
    ds_read_b64_tr_b16 v[232:233], v7 offset:16896
    v_mfma_f32_16x16x32_bf16 v[92:95], v[240:243], v[68:71], v[92:95]
    s_add_u32 s22, s24, 0x390000
    s_add_u32 m0, s20, 0x1c000
    s_nop 0
    buffer_load_dwordx4 v3, s[4:7], s22 offen lds
    ds_read_b64_tr_b16 v[234:235], v7 offset:17920
    s_waitcnt lgkmcnt(6)
    v_mfma_f32_16x16x32_bf16 v[96:99], v[244:247], v[64:67], v[96:99]
    ds_read_b64_tr_b16 v[236:237], v8 offset:16928
    v_mfma_f32_16x16x32_bf16 v[100:103], v[244:247], v[68:71], v[100:103]
    ds_read_b64_tr_b16 v[238:239], v8 offset:17952
    s_waitcnt lgkmcnt(6)
    v_mfma_f32_16x16x32_bf16 v[104:107], v[224:227], v[64:67], v[104:107]
    s_add_u32 s22, s24, 0x392000
    s_add_u32 m0, s20, 0x1c400
    s_nop 0
    buffer_load_dwordx4 v3, s[4:7], s22 offen lds
    ds_read_b64_tr_b16 v[240:241], v7 offset:17152
    v_mfma_f32_16x16x32_bf16 v[108:111], v[224:227], v[68:71], v[108:111]
    ds_read_b64_tr_b16 v[242:243], v7 offset:18176
    s_waitcnt lgkmcnt(6)
    v_mfma_f32_16x16x32_bf16 v[112:115], v[228:231], v[64:67], v[112:115]
    ds_read_b64_tr_b16 v[244:245], v8 offset:17184
    v_mfma_f32_16x16x32_bf16 v[116:119], v[228:231], v[68:71], v[116:119]
    ds_read_b64_tr_b16 v[246:247], v8 offset:18208
    s_waitcnt lgkmcnt(6)
    v_mfma_f32_16x16x32_bf16 v[120:123], v[232:235], v[64:67], v[120:123]
    v_mfma_f32_16x16x32_bf16 v[124:127], v[232:235], v[68:71], v[124:127]
    s_barrier
    ds_read_b64_tr_b16 v[224:225], v4 offset:0
    ds_read_b64_tr_b16 v[226:227], v4 offset:1024
    s_waitcnt lgkmcnt(6)
    v_mfma_f32_16x16x32_bf16 v[128:131], v[236:239], v[64:67], v[128:131]
    ds_read_b64_tr_b16 v[228:229], v5 offset:32
    s_mov_b32 s23, 0x0
    buffer_load_dwordx4 v[56:59], v6, s[8:11], s23 offen offset:2048 sc1
    v_mfma_f32_16x16x32_bf16 v[132:135], v[236:239], v[68:71], v[132:135]
    ds_read_b64_tr_b16 v[230:231], v5 offset:1056
    s_waitcnt lgkmcnt(6)
    v_mfma_f32_16x16x32_bf16 v[136:139], v[240:243], v[64:67], v[136:139]
    ds_read_b64_tr_b16 v[232:233], v4 offset:256
    v_mfma_f32_16x16x32_bf16 v[140:143], v[240:243], v[68:71], v[140:143]
    ds_read_b64_tr_b16 v[234:235], v4 offset:1280
    s_mov_b32 s23, 0x20000
    buffer_load_dwordx4 v[60:63], v6, s[8:11], s23 offen offset:2048 sc1
    s_waitcnt lgkmcnt(6)
    v_mfma_f32_16x16x32_bf16 v[144:147], v[244:247], v[64:67], v[144:147]
    ds_read_b64_tr_b16 v[236:237], v5 offset:288
    v_mfma_f32_16x16x32_bf16 v[148:151], v[244:247], v[68:71], v[148:151]
    ds_read_b64_tr_b16 v[238:239], v5 offset:1312
    s_waitcnt lgkmcnt(6)
    v_mfma_f32_16x16x32_bf16 v[88:91], v[224:227], v[24:27], v[88:91]
    ds_read_b64_tr_b16 v[240:241], v4 offset:512
    v_mfma_f32_16x16x32_bf16 v[92:95], v[224:227], v[28:31], v[92:95]
    s_add_u32 s22, s24, 0x20000
    s_add_u32 m0, s20, 0x20000
    s_nop 0
    buffer_load_dwordx4 v3, s[4:7], s22 offen lds
    ds_read_b64_tr_b16 v[242:243], v4 offset:1536
    s_waitcnt lgkmcnt(6)
    v_mfma_f32_16x16x32_bf16 v[96:99], v[228:231], v[24:27], v[96:99]
    ds_read_b64_tr_b16 v[244:245], v5 offset:544
    v_mfma_f32_16x16x32_bf16 v[100:103], v[228:231], v[28:31], v[100:103]
    ds_read_b64_tr_b16 v[246:247], v5 offset:1568
    s_waitcnt lgkmcnt(6)
    v_mfma_f32_16x16x32_bf16 v[104:107], v[232:235], v[24:27], v[104:107]
    s_add_u32 s22, s24, 0x22000
    s_add_u32 m0, s20, 0x20400
    s_nop 0
    buffer_load_dwordx4 v3, s[4:7], s22 offen lds
    ds_read_b64_tr_b16 v[224:225], v4 offset:768
    v_mfma_f32_16x16x32_bf16 v[108:111], v[232:235], v[28:31], v[108:111]
    ds_read_b64_tr_b16 v[226:227], v4 offset:1792
    s_waitcnt lgkmcnt(6)
    v_mfma_f32_16x16x32_bf16 v[112:115], v[236:239], v[24:27], v[112:115]
    ds_read_b64_tr_b16 v[228:229], v5 offset:800
    v_mfma_f32_16x16x32_bf16 v[116:119], v[236:239], v[28:31], v[116:119]
    ds_read_b64_tr_b16 v[230:231], v5 offset:1824
    s_waitcnt lgkmcnt(6)
    v_mfma_f32_16x16x32_bf16 v[120:123], v[240:243], v[24:27], v[120:123]
    v_mfma_f32_16x16x32_bf16 v[124:127], v[240:243], v[28:31], v[124:127]
    s_barrier
    ds_read_b64_tr_b16 v[232:233], v4 offset:16384
    ds_read_b64_tr_b16 v[234:235], v4 offset:17408
    s_waitcnt lgkmcnt(6)
    v_mfma_f32_16x16x32_bf16 v[128:131], v[244:247], v[24:27], v[128:131]
    ds_read_b64_tr_b16 v[236:237], v5 offset:16416
    s_mov_b32 s23, 0x2000
    buffer_load_dwordx4 v[64:67], v6, s[8:11], s23 offen offset:2048 sc1
    v_mfma_f32_16x16x32_bf16 v[132:135], v[244:247], v[28:31], v[132:135]
    ds_read_b64_tr_b16 v[238:239], v5 offset:17440
    s_waitcnt lgkmcnt(6)
    v_mfma_f32_16x16x32_bf16 v[136:139], v[224:227], v[24:27], v[136:139]
    ds_read_b64_tr_b16 v[240:241], v4 offset:16640
    v_mfma_f32_16x16x32_bf16 v[140:143], v[224:227], v[28:31], v[140:143]
    ds_read_b64_tr_b16 v[242:243], v4 offset:17664
    s_mov_b32 s23, 0x22000
    buffer_load_dwordx4 v[68:71], v6, s[8:11], s23 offen offset:2048 sc1
    s_waitcnt lgkmcnt(6)
    v_mfma_f32_16x16x32_bf16 v[144:147], v[228:231], v[24:27], v[144:147]
    ds_read_b64_tr_b16 v[244:245], v5 offset:16672
    v_mfma_f32_16x16x32_bf16 v[148:151], v[228:231], v[28:31], v[148:151]
    ds_read_b64_tr_b16 v[246:247], v5 offset:17696
    s_waitcnt lgkmcnt(6)
    v_mfma_f32_16x16x32_bf16 v[88:91], v[232:235], v[32:35], v[88:91]
    ds_read_b64_tr_b16 v[224:225], v4 offset:16896
    v_mfma_f32_16x16x32_bf16 v[92:95], v[232:235], v[36:39], v[92:95]
    s_add_u32 s22, s24, 0xa0000
    s_add_u32 m0, s20, 0x24000
    s_nop 0
    buffer_load_dwordx4 v3, s[4:7], s22 offen lds
    ds_read_b64_tr_b16 v[226:227], v4 offset:17920
    s_waitcnt lgkmcnt(6)
    v_mfma_f32_16x16x32_bf16 v[96:99], v[236:239], v[32:35], v[96:99]
    ds_read_b64_tr_b16 v[228:229], v5 offset:16928
    v_mfma_f32_16x16x32_bf16 v[100:103], v[236:239], v[36:39], v[100:103]
    ds_read_b64_tr_b16 v[230:231], v5 offset:17952
    s_waitcnt lgkmcnt(6)
    v_mfma_f32_16x16x32_bf16 v[104:107], v[240:243], v[32:35], v[104:107]
    s_add_u32 s22, s24, 0xa2000
    s_add_u32 m0, s20, 0x24400
    s_nop 0
    buffer_load_dwordx4 v3, s[4:7], s22 offen lds
    ds_read_b64_tr_b16 v[232:233], v4 offset:17152
    v_mfma_f32_16x16x32_bf16 v[108:111], v[240:243], v[36:39], v[108:111]
    ds_read_b64_tr_b16 v[234:235], v4 offset:18176
    s_waitcnt lgkmcnt(6)
    v_mfma_f32_16x16x32_bf16 v[112:115], v[244:247], v[32:35], v[112:115]
    ds_read_b64_tr_b16 v[236:237], v5 offset:17184
    v_mfma_f32_16x16x32_bf16 v[116:119], v[244:247], v[36:39], v[116:119]
    ds_read_b64_tr_b16 v[238:239], v5 offset:18208
    s_waitcnt lgkmcnt(6)
    v_mfma_f32_16x16x32_bf16 v[120:123], v[224:227], v[32:35], v[120:123]
    v_mfma_f32_16x16x32_bf16 v[124:127], v[224:227], v[36:39], v[124:127]
    s_waitcnt vmcnt(12)
    s_barrier
    ds_read_b64_tr_b16 v[240:241], v4 offset:32768
    ds_read_b64_tr_b16 v[242:243], v4 offset:33792
    s_waitcnt lgkmcnt(6)
    v_mfma_f32_16x16x32_bf16 v[128:131], v[228:231], v[32:35], v[128:131]
    ds_read_b64_tr_b16 v[244:245], v5 offset:32800
    s_mov_b32 s23, 0x4000
    buffer_load_dwordx4 v[24:27], v6, s[8:11], s23 offen offset:2048 sc1
    v_mfma_f32_16x16x32_bf16 v[132:135], v[228:231], v[36:39], v[132:135]
    ds_read_b64_tr_b16 v[246:247], v5 offset:33824
    s_waitcnt lgkmcnt(6)
    v_mfma_f32_16x16x32_bf16 v[136:139], v[232:235], v[32:35], v[136:139]
    ds_read_b64_tr_b16 v[224:225], v4 offset:33024
    v_mfma_f32_16x16x32_bf16 v[140:143], v[232:235], v[36:39], v[140:143]
    ds_read_b64_tr_b16 v[226:227], v4 offset:34048
    s_mov_b32 s23, 0x24000
    buffer_load_dwordx4 v[28:31], v6, s[8:11], s23 offen offset:2048 sc1
    s_waitcnt lgkmcnt(6)
    v_mfma_f32_16x16x32_bf16 v[144:147], v[236:239], v[32:35], v[144:147]
    ds_read_b64_tr_b16 v[228:229], v5 offset:33056
    v_mfma_f32_16x16x32_bf16 v[148:151], v[236:239], v[36:39], v[148:151]
    ds_read_b64_tr_b16 v[230:231], v5 offset:34080
    s_waitcnt lgkmcnt(6)
    v_mfma_f32_16x16x32_bf16 v[88:91], v[240:243], v[40:43], v[88:91]
    ds_read_b64_tr_b16 v[232:233], v4 offset:33280
    v_mfma_f32_16x16x32_bf16 v[92:95], v[240:243], v[44:47], v[92:95]
    s_add_u32 s22, s24, 0x120000
    s_add_u32 m0, s20, 0x10000
    s_nop 0
    buffer_load_dwordx4 v3, s[4:7], s22 offen lds
    ds_read_b64_tr_b16 v[234:235], v4 offset:34304
    s_waitcnt lgkmcnt(6)
    v_mfma_f32_16x16x32_bf16 v[96:99], v[244:247], v[40:43], v[96:99]
    ds_read_b64_tr_b16 v[236:237], v5 offset:33312
    v_mfma_f32_16x16x32_bf16 v[100:103], v[244:247], v[44:47], v[100:103]
    ds_read_b64_tr_b16 v[238:239], v5 offset:34336
    s_waitcnt lgkmcnt(6)
    v_mfma_f32_16x16x32_bf16 v[104:107], v[224:227], v[40:43], v[104:107]
    s_add_u32 s22, s24, 0x122000
    s_add_u32 m0, s20, 0x10400
    s_nop 0
    buffer_load_dwordx4 v3, s[4:7], s22 offen lds
    ds_read_b64_tr_b16 v[240:241], v4 offset:33536
    v_mfma_f32_16x16x32_bf16 v[108:111], v[224:227], v[44:47], v[108:111]
    ds_read_b64_tr_b16 v[242:243], v4 offset:34560
    s_waitcnt lgkmcnt(6)
    v_mfma_f32_16x16x32_bf16 v[112:115], v[228:231], v[40:43], v[112:115]
    ds_read_b64_tr_b16 v[244:245], v5 offset:33568
    v_mfma_f32_16x16x32_bf16 v[116:119], v[228:231], v[44:47], v[116:119]
    ds_read_b64_tr_b16 v[246:247], v5 offset:34592
    s_waitcnt lgkmcnt(6)
    v_mfma_f32_16x16x32_bf16 v[120:123], v[232:235], v[40:43], v[120:123]
    v_mfma_f32_16x16x32_bf16 v[124:127], v[232:235], v[44:47], v[124:127]
    s_waitcnt vmcnt(12)
    s_barrier
    ds_read_b64_tr_b16 v[224:225], v4 offset:49152
    ds_read_b64_tr_b16 v[226:227], v4 offset:50176
    s_waitcnt lgkmcnt(6)
    v_mfma_f32_16x16x32_bf16 v[128:131], v[236:239], v[40:43], v[128:131]
    ds_read_b64_tr_b16 v[228:229], v5 offset:49184
    s_mov_b32 s23, 0x6000
    buffer_load_dwordx4 v[32:35], v6, s[8:11], s23 offen offset:2048 sc1
    v_mfma_f32_16x16x32_bf16 v[132:135], v[236:239], v[44:47], v[132:135]
    ds_read_b64_tr_b16 v[230:231], v5 offset:50208
    s_waitcnt lgkmcnt(6)
    v_mfma_f32_16x16x32_bf16 v[136:139], v[240:243], v[40:43], v[136:139]
    ds_read_b64_tr_b16 v[232:233], v4 offset:49408
    v_mfma_f32_16x16x32_bf16 v[140:143], v[240:243], v[44:47], v[140:143]
    ds_read_b64_tr_b16 v[234:235], v4 offset:50432
    s_mov_b32 s23, 0x26000
    buffer_load_dwordx4 v[36:39], v6, s[8:11], s23 offen offset:2048 sc1
    s_waitcnt lgkmcnt(6)
    v_mfma_f32_16x16x32_bf16 v[144:147], v[244:247], v[40:43], v[144:147]
    ds_read_b64_tr_b16 v[236:237], v5 offset:49440
    v_mfma_f32_16x16x32_bf16 v[148:151], v[244:247], v[44:47], v[148:151]
    ds_read_b64_tr_b16 v[238:239], v5 offset:50464
    s_waitcnt lgkmcnt(6)
    v_mfma_f32_16x16x32_bf16 v[88:91], v[224:227], v[48:51], v[88:91]
    ds_read_b64_tr_b16 v[240:241], v4 offset:49664
    v_mfma_f32_16x16x32_bf16 v[92:95], v[224:227], v[52:55], v[92:95]
    s_add_u32 s22, s24, 0x1a0000
    s_add_u32 m0, s20, 0x14000
    s_nop 0
    buffer_load_dwordx4 v3, s[4:7], s22 offen lds
    ds_read_b64_tr_b16 v[242:243], v4 offset:50688
    s_waitcnt lgkmcnt(6)
    v_mfma_f32_16x16x32_bf16 v[96:99], v[228:231], v[48:51], v[96:99]
    ds_read_b64_tr_b16 v[244:245], v5 offset:49696
    v_mfma_f32_16x16x32_bf16 v[100:103], v[228:231], v[52:55], v[100:103]
    ds_read_b64_tr_b16 v[246:247], v5 offset:50720
    s_waitcnt lgkmcnt(6)
    v_mfma_f32_16x16x32_bf16 v[104:107], v[232:235], v[48:51], v[104:107]
    s_add_u32 s22, s24, 0x1a2000
    s_add_u32 m0, s20, 0x14400
    s_nop 0
    buffer_load_dwordx4 v3, s[4:7], s22 offen lds
    ds_read_b64_tr_b16 v[224:225], v4 offset:49920
    v_mfma_f32_16x16x32_bf16 v[108:111], v[232:235], v[52:55], v[108:111]
    ds_read_b64_tr_b16 v[226:227], v4 offset:50944
    s_waitcnt lgkmcnt(6)
    v_mfma_f32_16x16x32_bf16 v[112:115], v[236:239], v[48:51], v[112:115]
    ds_read_b64_tr_b16 v[228:229], v5 offset:49952
    v_mfma_f32_16x16x32_bf16 v[116:119], v[236:239], v[52:55], v[116:119]
    ds_read_b64_tr_b16 v[230:231], v5 offset:50976
    s_waitcnt lgkmcnt(6)
    v_mfma_f32_16x16x32_bf16 v[120:123], v[240:243], v[48:51], v[120:123]
    v_mfma_f32_16x16x32_bf16 v[124:127], v[240:243], v[52:55], v[124:127]
    s_waitcnt vmcnt(12)
    s_barrier
    ds_read_b64_tr_b16 v[232:233], v7 offset:0
    ds_read_b64_tr_b16 v[234:235], v7 offset:1024
    s_waitcnt lgkmcnt(6)
    v_mfma_f32_16x16x32_bf16 v[128:131], v[244:247], v[48:51], v[128:131]
    ds_read_b64_tr_b16 v[236:237], v8 offset:32
    s_mov_b32 s23, 0x8000
    buffer_load_dwordx4 v[40:43], v6, s[8:11], s23 offen offset:2048 sc1
    v_mfma_f32_16x16x32_bf16 v[132:135], v[244:247], v[52:55], v[132:135]
    ds_read_b64_tr_b16 v[238:239], v8 offset:1056
    s_waitcnt lgkmcnt(6)
    v_mfma_f32_16x16x32_bf16 v[136:139], v[224:227], v[48:51], v[136:139]
    ds_read_b64_tr_b16 v[240:241], v7 offset:256
    v_mfma_f32_16x16x32_bf16 v[140:143], v[224:227], v[52:55], v[140:143]
    ds_read_b64_tr_b16 v[242:243], v7 offset:1280
    s_mov_b32 s23, 0x28000
    buffer_load_dwordx4 v[44:47], v6, s[8:11], s23 offen offset:2048 sc1
    s_waitcnt lgkmcnt(6)
    v_mfma_f32_16x16x32_bf16 v[144:147], v[228:231], v[48:51], v[144:147]
    ds_read_b64_tr_b16 v[244:245], v8 offset:288
    v_mfma_f32_16x16x32_bf16 v[148:151], v[228:231], v[52:55], v[148:151]
    ds_read_b64_tr_b16 v[246:247], v8 offset:1312
    s_waitcnt lgkmcnt(6)
    v_mfma_f32_16x16x32_bf16 v[88:91], v[232:235], v[56:59], v[88:91]
    ds_read_b64_tr_b16 v[224:225], v7 offset:512
    v_mfma_f32_16x16x32_bf16 v[92:95], v[232:235], v[60:63], v[92:95]
    s_add_u32 s22, s24, 0x220000
    s_add_u32 m0, s20, 0x18000
    s_nop 0
    buffer_load_dwordx4 v3, s[4:7], s22 offen lds
    ds_read_b64_tr_b16 v[226:227], v7 offset:1536
    s_waitcnt lgkmcnt(6)
    v_mfma_f32_16x16x32_bf16 v[96:99], v[236:239], v[56:59], v[96:99]
    ds_read_b64_tr_b16 v[228:229], v8 offset:544
    v_mfma_f32_16x16x32_bf16 v[100:103], v[236:239], v[60:63], v[100:103]
    ds_read_b64_tr_b16 v[230:231], v8 offset:1568
    s_waitcnt lgkmcnt(6)
    v_mfma_f32_16x16x32_bf16 v[104:107], v[240:243], v[56:59], v[104:107]
    s_add_u32 s22, s24, 0x222000
    s_add_u32 m0, s20, 0x18400
    s_nop 0
    buffer_load_dwordx4 v3, s[4:7], s22 offen lds
    ds_read_b64_tr_b16 v[232:233], v7 offset:768
    v_mfma_f32_16x16x32_bf16 v[108:111], v[240:243], v[60:63], v[108:111]
    ds_read_b64_tr_b16 v[234:235], v7 offset:1792
    s_waitcnt lgkmcnt(6)
    v_mfma_f32_16x16x32_bf16 v[112:115], v[244:247], v[56:59], v[112:115]
    ds_read_b64_tr_b16 v[236:237], v8 offset:800
    v_mfma_f32_16x16x32_bf16 v[116:119], v[244:247], v[60:63], v[116:119]
    ds_read_b64_tr_b16 v[238:239], v8 offset:1824
    s_waitcnt lgkmcnt(6)
    v_mfma_f32_16x16x32_bf16 v[120:123], v[224:227], v[56:59], v[120:123]
    v_mfma_f32_16x16x32_bf16 v[124:127], v[224:227], v[60:63], v[124:127]
    s_waitcnt vmcnt(12)
    s_barrier
    ds_read_b64_tr_b16 v[240:241], v7 offset:16384
    ds_read_b64_tr_b16 v[242:243], v7 offset:17408
    s_waitcnt lgkmcnt(6)
    v_mfma_f32_16x16x32_bf16 v[128:131], v[228:231], v[56:59], v[128:131]
    ds_read_b64_tr_b16 v[244:245], v8 offset:16416
    s_mov_b32 s23, 0xa000
    buffer_load_dwordx4 v[48:51], v6, s[8:11], s23 offen offset:2048 sc1
    v_mfma_f32_16x16x32_bf16 v[132:135], v[228:231], v[60:63], v[132:135]
    ds_read_b64_tr_b16 v[246:247], v8 offset:17440
    s_waitcnt lgkmcnt(6)
    v_mfma_f32_16x16x32_bf16 v[136:139], v[232:235], v[56:59], v[136:139]
    ds_read_b64_tr_b16 v[224:225], v7 offset:16640
    v_mfma_f32_16x16x32_bf16 v[140:143], v[232:235], v[60:63], v[140:143]
    ds_read_b64_tr_b16 v[226:227], v7 offset:17664
    s_mov_b32 s23, 0x2a000
    buffer_load_dwordx4 v[52:55], v6, s[8:11], s23 offen offset:2048 sc1
    s_waitcnt lgkmcnt(6)
    v_mfma_f32_16x16x32_bf16 v[144:147], v[236:239], v[56:59], v[144:147]
    ds_read_b64_tr_b16 v[228:229], v8 offset:16672
    v_mfma_f32_16x16x32_bf16 v[148:151], v[236:239], v[60:63], v[148:151]
    ds_read_b64_tr_b16 v[230:231], v8 offset:17696
    s_waitcnt lgkmcnt(6)
    v_mfma_f32_16x16x32_bf16 v[88:91], v[240:243], v[64:67], v[88:91]
    ds_read_b64_tr_b16 v[232:233], v7 offset:16896
    v_mfma_f32_16x16x32_bf16 v[92:95], v[240:243], v[68:71], v[92:95]
    s_add_u32 s22, s24, 0x2a0000
    s_add_u32 m0, s20, 0x1c000
    s_nop 0
    buffer_load_dwordx4 v3, s[4:7], s22 offen lds
    ds_read_b64_tr_b16 v[234:235], v7 offset:17920
    s_waitcnt lgkmcnt(6)
    v_mfma_f32_16x16x32_bf16 v[96:99], v[244:247], v[64:67], v[96:99]
    ds_read_b64_tr_b16 v[236:237], v8 offset:16928
    v_mfma_f32_16x16x32_bf16 v[100:103], v[244:247], v[68:71], v[100:103]
    ds_read_b64_tr_b16 v[238:239], v8 offset:17952
    s_waitcnt lgkmcnt(6)
    v_mfma_f32_16x16x32_bf16 v[104:107], v[224:227], v[64:67], v[104:107]
    s_add_u32 s22, s24, 0x2a2000
    s_add_u32 m0, s20, 0x1c400
    s_nop 0
    buffer_load_dwordx4 v3, s[4:7], s22 offen lds
    ds_read_b64_tr_b16 v[240:241], v7 offset:17152
    v_mfma_f32_16x16x32_bf16 v[108:111], v[224:227], v[68:71], v[108:111]
    ds_read_b64_tr_b16 v[242:243], v7 offset:18176
    s_waitcnt lgkmcnt(6)
    v_mfma_f32_16x16x32_bf16 v[112:115], v[228:231], v[64:67], v[112:115]
    ds_read_b64_tr_b16 v[244:245], v8 offset:17184
    v_mfma_f32_16x16x32_bf16 v[116:119], v[228:231], v[68:71], v[116:119]
    ds_read_b64_tr_b16 v[246:247], v8 offset:18208
    s_waitcnt lgkmcnt(6)
    v_mfma_f32_16x16x32_bf16 v[120:123], v[232:235], v[64:67], v[120:123]
    v_mfma_f32_16x16x32_bf16 v[124:127], v[232:235], v[68:71], v[124:127]
    s_waitcnt vmcnt(12)
    s_barrier
    ds_read_b64_tr_b16 v[224:225], v4 offset:0
    ds_read_b64_tr_b16 v[226:227], v4 offset:1024
    s_add_u32 s19, s19, 8192
    buffer_load_dword v12, v13, s[8:11], s19 offen sc1
    s_waitcnt lgkmcnt(6)
    v_mfma_f32_16x16x32_bf16 v[128:131], v[236:239], v[64:67], v[128:131]
    ds_read_b64_tr_b16 v[228:229], v5 offset:32
    s_mov_b32 s23, 0xc000
    buffer_load_dwordx4 v[56:59], v6, s[8:11], s23 offen offset:2048 sc1
    v_mfma_f32_16x16x32_bf16 v[132:135], v[236:239], v[68:71], v[132:135]
    ds_read_b64_tr_b16 v[230:231], v5 offset:1056
    s_waitcnt lgkmcnt(6)
    v_mfma_f32_16x16x32_bf16 v[136:139], v[240:243], v[64:67], v[136:139]
    ds_read_b64_tr_b16 v[232:233], v4 offset:256
    v_mfma_f32_16x16x32_bf16 v[140:143], v[240:243], v[68:71], v[140:143]
    ds_read_b64_tr_b16 v[234:235], v4 offset:1280
    s_mov_b32 s23, 0x2c000
    buffer_load_dwordx4 v[60:63], v6, s[8:11], s23 offen offset:2048 sc1
    s_waitcnt lgkmcnt(6)
    v_mfma_f32_16x16x32_bf16 v[144:147], v[244:247], v[64:67], v[144:147]
    ds_read_b64_tr_b16 v[236:237], v5 offset:288
    v_mfma_f32_16x16x32_bf16 v[148:151], v[244:247], v[68:71], v[148:151]
    ds_read_b64_tr_b16 v[238:239], v5 offset:1312
    s_waitcnt lgkmcnt(6)
    v_mfma_f32_16x16x32_bf16 v[88:91], v[224:227], v[24:27], v[88:91]
    ds_read_b64_tr_b16 v[240:241], v4 offset:512
    v_mfma_f32_16x16x32_bf16 v[92:95], v[224:227], v[28:31], v[92:95]
    s_add_u32 s22, s24, 0x320000
    s_add_u32 m0, s20, 0x20000
    s_nop 0
    buffer_load_dwordx4 v3, s[4:7], s22 offen lds
    ds_read_b64_tr_b16 v[242:243], v4 offset:1536
    s_waitcnt lgkmcnt(6)
    v_mfma_f32_16x16x32_bf16 v[96:99], v[228:231], v[24:27], v[96:99]
    ds_read_b64_tr_b16 v[244:245], v5 offset:544
    v_mfma_f32_16x16x32_bf16 v[100:103], v[228:231], v[28:31], v[100:103]
    ds_read_b64_tr_b16 v[246:247], v5 offset:1568
    s_waitcnt lgkmcnt(6)
    v_mfma_f32_16x16x32_bf16 v[104:107], v[232:235], v[24:27], v[104:107]
    s_add_u32 s22, s24, 0x322000
    s_add_u32 m0, s20, 0x20400
    s_nop 0
    buffer_load_dwordx4 v3, s[4:7], s22 offen lds
    ds_read_b64_tr_b16 v[224:225], v4 offset:768
    v_mfma_f32_16x16x32_bf16 v[108:111], v[232:235], v[28:31], v[108:111]
    ds_read_b64_tr_b16 v[226:227], v4 offset:1792
    s_waitcnt lgkmcnt(6)
    v_mfma_f32_16x16x32_bf16 v[112:115], v[236:239], v[24:27], v[112:115]
    ds_read_b64_tr_b16 v[228:229], v5 offset:800
    v_mfma_f32_16x16x32_bf16 v[116:119], v[236:239], v[28:31], v[116:119]
    ds_read_b64_tr_b16 v[230:231], v5 offset:1824
    s_waitcnt lgkmcnt(6)
    v_mfma_f32_16x16x32_bf16 v[120:123], v[240:243], v[24:27], v[120:123]
    v_mfma_f32_16x16x32_bf16 v[124:127], v[240:243], v[28:31], v[124:127]
    s_waitcnt vmcnt(13)
    s_barrier
    ds_read_b64_tr_b16 v[232:233], v4 offset:16384
    ds_read_b64_tr_b16 v[234:235], v4 offset:17408
    s_waitcnt lgkmcnt(6)
    v_mfma_f32_16x16x32_bf16 v[128:131], v[244:247], v[24:27], v[128:131]
    ds_read_b64_tr_b16 v[236:237], v5 offset:16416
    s_mov_b32 s23, 0xe000
    buffer_load_dwordx4 v[64:67], v6, s[8:11], s23 offen offset:2048 sc1
    v_mfma_f32_16x16x32_bf16 v[132:135], v[244:247], v[28:31], v[132:135]
    ds_read_b64_tr_b16 v[238:239], v5 offset:17440
    s_waitcnt lgkmcnt(6)
    v_mfma_f32_16x16x32_bf16 v[136:139], v[224:227], v[24:27], v[136:139]
    ds_read_b64_tr_b16 v[240:241], v4 offset:16640
    v_mfma_f32_16x16x32_bf16 v[140:143], v[224:227], v[28:31], v[140:143]
    ds_read_b64_tr_b16 v[242:243], v4 offset:17664
    s_mov_b32 s23, 0x2e000
    buffer_load_dwordx4 v[68:71], v6, s[8:11], s23 offen offset:2048 sc1
    s_waitcnt lgkmcnt(6)
    v_mfma_f32_16x16x32_bf16 v[144:147], v[228:231], v[24:27], v[144:147]
    ds_read_b64_tr_b16 v[244:245], v5 offset:16672
    v_mfma_f32_16x16x32_bf16 v[148:151], v[228:231], v[28:31], v[148:151]
    ds_read_b64_tr_b16 v[246:247], v5 offset:17696
    s_waitcnt vmcnt(6)
    v_cmp_ne_u32 vcc, s28, v12
    s_cbranch_vccnz adaLN_cond__sliding_block_cached__moe_arch_mod__prompt_kernel_o220r
adaLN_cond__sliding_block_cached__moe_arch_mod__prompt_kernel_o220b:
    s_waitcnt lgkmcnt(6)
    v_mfma_f32_16x16x32_bf16 v[88:91], v[232:235], v[32:35], v[88:91]
    ds_read_b64_tr_b16 v[224:225], v4 offset:16896
    v_mfma_f32_16x16x32_bf16 v[92:95], v[232:235], v[36:39], v[92:95]
    s_add_u32 s22, s24, 0x3a0000
    s_add_u32 m0, s20, 0x24000
    s_nop 0
    buffer_load_dwordx4 v3, s[4:7], s22 offen lds
    ds_read_b64_tr_b16 v[226:227], v4 offset:17920
    s_waitcnt lgkmcnt(6)
    v_mfma_f32_16x16x32_bf16 v[96:99], v[236:239], v[32:35], v[96:99]
    ds_read_b64_tr_b16 v[228:229], v5 offset:16928
    v_mfma_f32_16x16x32_bf16 v[100:103], v[236:239], v[36:39], v[100:103]
    ds_read_b64_tr_b16 v[230:231], v5 offset:17952
    s_waitcnt lgkmcnt(6)
    v_mfma_f32_16x16x32_bf16 v[104:107], v[240:243], v[32:35], v[104:107]
    s_add_u32 s22, s24, 0x3a2000
    s_add_u32 m0, s20, 0x24400
    s_nop 0
    buffer_load_dwordx4 v3, s[4:7], s22 offen lds
    ds_read_b64_tr_b16 v[232:233], v4 offset:17152
    v_mfma_f32_16x16x32_bf16 v[108:111], v[240:243], v[36:39], v[108:111]
    ds_read_b64_tr_b16 v[234:235], v4 offset:18176
    s_waitcnt lgkmcnt(6)
    v_mfma_f32_16x16x32_bf16 v[112:115], v[244:247], v[32:35], v[112:115]
    ds_read_b64_tr_b16 v[236:237], v5 offset:17184
    v_mfma_f32_16x16x32_bf16 v[116:119], v[244:247], v[36:39], v[116:119]
    ds_read_b64_tr_b16 v[238:239], v5 offset:18208
    s_waitcnt lgkmcnt(6)
    v_mfma_f32_16x16x32_bf16 v[120:123], v[224:227], v[32:35], v[120:123]
    v_mfma_f32_16x16x32_bf16 v[124:127], v[224:227], v[36:39], v[124:127]
    s_barrier
    ds_read_b64_tr_b16 v[240:241], v4 offset:32768
    ds_read_b64_tr_b16 v[242:243], v4 offset:33792
    s_waitcnt lgkmcnt(6)
    v_mfma_f32_16x16x32_bf16 v[128:131], v[228:231], v[32:35], v[128:131]
    ds_read_b64_tr_b16 v[244:245], v5 offset:32800
    s_mov_b32 s23, 0x0
    buffer_load_dwordx4 v[24:27], v6, s[8:11], s23 offen offset:3072 sc1
    v_mfma_f32_16x16x32_bf16 v[132:135], v[228:231], v[36:39], v[132:135]
    ds_read_b64_tr_b16 v[246:247], v5 offset:33824
    s_waitcnt lgkmcnt(6)
    v_mfma_f32_16x16x32_bf16 v[136:139], v[232:235], v[32:35], v[136:139]
    ds_read_b64_tr_b16 v[224:225], v4 offset:33024
    v_mfma_f32_16x16x32_bf16 v[140:143], v[232:235], v[36:39], v[140:143]
    ds_read_b64_tr_b16 v[226:227], v4 offset:34048
    s_mov_b32 s23, 0x20000
    buffer_load_dwordx4 v[28:31], v6, s[8:11], s23 offen offset:3072 sc1
    s_waitcnt lgkmcnt(6)
    v_mfma_f32_16x16x32_bf16 v[144:147], v[236:239], v[32:35], v[144:147]
    ds_read_b64_tr_b16 v[228:229], v5 offset:33056
    v_mfma_f32_16x16x32_bf16 v[148:151], v[236:239], v[36:39], v[148:151]
    ds_read_b64_tr_b16 v[230:231], v5 offset:34080
    s_waitcnt lgkmcnt(6)
    v_mfma_f32_16x16x32_bf16 v[88:91], v[240:243], v[40:43], v[88:91]
    ds_read_b64_tr_b16 v[232:233], v4 offset:33280
    v_mfma_f32_16x16x32_bf16 v[92:95], v[240:243], v[44:47], v[92:95]
    s_add_u32 s22, s24, 0x30000
    s_add_u32 m0, s20, 0x10000
    s_nop 0
    buffer_load_dwordx4 v3, s[4:7], s22 offen lds
    ds_read_b64_tr_b16 v[234:235], v4 offset:34304
    s_waitcnt lgkmcnt(6)
    v_mfma_f32_16x16x32_bf16 v[96:99], v[244:247], v[40:43], v[96:99]
    ds_read_b64_tr_b16 v[236:237], v5 offset:33312
    v_mfma_f32_16x16x32_bf16 v[100:103], v[244:247], v[44:47], v[100:103]
    ds_read_b64_tr_b16 v[238:239], v5 offset:34336
    s_waitcnt lgkmcnt(6)
    v_mfma_f32_16x16x32_bf16 v[104:107], v[224:227], v[40:43], v[104:107]
    s_add_u32 s22, s24, 0x32000
    s_add_u32 m0, s20, 0x10400
    s_nop 0
    buffer_load_dwordx4 v3, s[4:7], s22 offen lds
    ds_read_b64_tr_b16 v[240:241], v4 offset:33536
    v_mfma_f32_16x16x32_bf16 v[108:111], v[224:227], v[44:47], v[108:111]
    ds_read_b64_tr_b16 v[242:243], v4 offset:34560
    s_waitcnt lgkmcnt(6)
    v_mfma_f32_16x16x32_bf16 v[112:115], v[228:231], v[40:43], v[112:115]
    ds_read_b64_tr_b16 v[244:245], v5 offset:33568
    v_mfma_f32_16x16x32_bf16 v[116:119], v[228:231], v[44:47], v[116:119]
    ds_read_b64_tr_b16 v[246:247], v5 offset:34592
    s_waitcnt lgkmcnt(6)
    v_mfma_f32_16x16x32_bf16 v[120:123], v[232:235], v[40:43], v[120:123]
    v_mfma_f32_16x16x32_bf16 v[124:127], v[232:235], v[44:47], v[124:127]
    s_barrier
    ds_read_b64_tr_b16 v[224:225], v4 offset:49152
    ds_read_b64_tr_b16 v[226:227], v4 offset:50176
    s_waitcnt lgkmcnt(6)
    v_mfma_f32_16x16x32_bf16 v[128:131], v[236:239], v[40:43], v[128:131]
    ds_read_b64_tr_b16 v[228:229], v5 offset:49184
    s_mov_b32 s23, 0x2000
    buffer_load_dwordx4 v[32:35], v6, s[8:11], s23 offen offset:3072 sc1
    v_mfma_f32_16x16x32_bf16 v[132:135], v[236:239], v[44:47], v[132:135]
    ds_read_b64_tr_b16 v[230:231], v5 offset:50208
    s_waitcnt lgkmcnt(6)
    v_mfma_f32_16x16x32_bf16 v[136:139], v[240:243], v[40:43], v[136:139]
    ds_read_b64_tr_b16 v[232:233], v4 offset:49408
    v_mfma_f32_16x16x32_bf16 v[140:143], v[240:243], v[44:47], v[140:143]
    ds_read_b64_tr_b16 v[234:235], v4 offset:50432
    s_mov_b32 s23, 0x22000
    buffer_load_dwordx4 v[36:39], v6, s[8:11], s23 offen offset:3072 sc1
    s_waitcnt lgkmcnt(6)
    v_mfma_f32_16x16x32_bf16 v[144:147], v[244:247], v[40:43], v[144:147]
    ds_read_b64_tr_b16 v[236:237], v5 offset:49440
    v_mfma_f32_16x16x32_bf16 v[148:151], v[244:247], v[44:47], v[148:151]
    ds_read_b64_tr_b16 v[238:239], v5 offset:50464
    s_waitcnt lgkmcnt(6)
    v_mfma_f32_16x16x32_bf16 v[88:91], v[224:227], v[48:51], v[88:91]
    ds_read_b64_tr_b16 v[240:241], v4 offset:49664
    v_mfma_f32_16x16x32_bf16 v[92:95], v[224:227], v[52:55], v[92:95]
    s_add_u32 s22, s24, 0xb0000
    s_add_u32 m0, s20, 0x14000
    s_nop 0
    buffer_load_dwordx4 v3, s[4:7], s22 offen lds
    ds_read_b64_tr_b16 v[242:243], v4 offset:50688
    s_waitcnt lgkmcnt(6)
    v_mfma_f32_16x16x32_bf16 v[96:99], v[228:231], v[48:51], v[96:99]
    ds_read_b64_tr_b16 v[244:245], v5 offset:49696
    v_mfma_f32_16x16x32_bf16 v[100:103], v[228:231], v[52:55], v[100:103]
    ds_read_b64_tr_b16 v[246:247], v5 offset:50720
    s_waitcnt lgkmcnt(6)
    v_mfma_f32_16x16x32_bf16 v[104:107], v[232:235], v[48:51], v[104:107]
    s_add_u32 s22, s24, 0xb2000
    s_add_u32 m0, s20, 0x14400
    s_nop 0
    buffer_load_dwordx4 v3, s[4:7], s22 offen lds
    ds_read_b64_tr_b16 v[224:225], v4 offset:49920
    v_mfma_f32_16x16x32_bf16 v[108:111], v[232:235], v[52:55], v[108:111]
    ds_read_b64_tr_b16 v[226:227], v4 offset:50944
    s_waitcnt lgkmcnt(6)
    v_mfma_f32_16x16x32_bf16 v[112:115], v[236:239], v[48:51], v[112:115]
    ds_read_b64_tr_b16 v[228:229], v5 offset:49952
    v_mfma_f32_16x16x32_bf16 v[116:119], v[236:239], v[52:55], v[116:119]
    ds_read_b64_tr_b16 v[230:231], v5 offset:50976
    s_waitcnt lgkmcnt(6)
    v_mfma_f32_16x16x32_bf16 v[120:123], v[240:243], v[48:51], v[120:123]
    v_mfma_f32_16x16x32_bf16 v[124:127], v[240:243], v[52:55], v[124:127]
    s_waitcnt vmcnt(12)
    s_barrier
    ds_read_b64_tr_b16 v[232:233], v7 offset:0
    ds_read_b64_tr_b16 v[234:235], v7 offset:1024
    s_waitcnt lgkmcnt(6)
    v_mfma_f32_16x16x32_bf16 v[128:131], v[244:247], v[48:51], v[128:131]
    ds_read_b64_tr_b16 v[236:237], v8 offset:32
    s_mov_b32 s23, 0x4000
    buffer_load_dwordx4 v[40:43], v6, s[8:11], s23 offen offset:3072 sc1
    v_mfma_f32_16x16x32_bf16 v[132:135], v[244:247], v[52:55], v[132:135]
    ds_read_b64_tr_b16 v[238:239], v8 offset:1056
    s_waitcnt lgkmcnt(6)
    v_mfma_f32_16x16x32_bf16 v[136:139], v[224:227], v[48:51], v[136:139]
    ds_read_b64_tr_b16 v[240:241], v7 offset:256
    v_mfma_f32_16x16x32_bf16 v[140:143], v[224:227], v[52:55], v[140:143]
    ds_read_b64_tr_b16 v[242:243], v7 offset:1280
    s_mov_b32 s23, 0x24000
    buffer_load_dwordx4 v[44:47], v6, s[8:11], s23 offen offset:3072 sc1
    s_waitcnt lgkmcnt(6)
    v_mfma_f32_16x16x32_bf16 v[144:147], v[228:231], v[48:51], v[144:147]
    ds_read_b64_tr_b16 v[244:245], v8 offset:288
    v_mfma_f32_16x16x32_bf16 v[148:151], v[228:231], v[52:55], v[148:151]
    ds_read_b64_tr_b16 v[246:247], v8 offset:1312
    s_waitcnt lgkmcnt(6)
    v_mfma_f32_16x16x32_bf16 v[88:91], v[232:235], v[56:59], v[88:91]
    ds_read_b64_tr_b16 v[224:225], v7 offset:512
    v_mfma_f32_16x16x32_bf16 v[92:95], v[232:235], v[60:63], v[92:95]
    s_add_u32 s22, s24, 0x130000
    s_add_u32 m0, s20, 0x18000
    s_nop 0
    buffer_load_dwordx4 v3, s[4:7], s22 offen lds
    ds_read_b64_tr_b16 v[226:227], v7 offset:1536
    s_waitcnt lgkmcnt(6)
    v_mfma_f32_16x16x32_bf16 v[96:99], v[236:239], v[56:59], v[96:99]
    ds_read_b64_tr_b16 v[228:229], v8 offset:544
    v_mfma_f32_16x16x32_bf16 v[100:103], v[236:239], v[60:63], v[100:103]
    ds_read_b64_tr_b16 v[230:231], v8 offset:1568
    s_waitcnt lgkmcnt(6)
    v_mfma_f32_16x16x32_bf16 v[104:107], v[240:243], v[56:59], v[104:107]
    s_add_u32 s22, s24, 0x132000
    s_add_u32 m0, s20, 0x18400
    s_nop 0
    buffer_load_dwordx4 v3, s[4:7], s22 offen lds
    ds_read_b64_tr_b16 v[232:233], v7 offset:768
    v_mfma_f32_16x16x32_bf16 v[108:111], v[240:243], v[60:63], v[108:111]
    ds_read_b64_tr_b16 v[234:235], v7 offset:1792
    s_waitcnt lgkmcnt(6)
    v_mfma_f32_16x16x32_bf16 v[112:115], v[244:247], v[56:59], v[112:115]
    ds_read_b64_tr_b16 v[236:237], v8 offset:800
    v_mfma_f32_16x16x32_bf16 v[116:119], v[244:247], v[60:63], v[116:119]
    ds_read_b64_tr_b16 v[238:239], v8 offset:1824
    s_waitcnt lgkmcnt(6)
    v_mfma_f32_16x16x32_bf16 v[120:123], v[224:227], v[56:59], v[120:123]
    v_mfma_f32_16x16x32_bf16 v[124:127], v[224:227], v[60:63], v[124:127]
    s_waitcnt vmcnt(12)
    s_barrier
    ds_read_b64_tr_b16 v[240:241], v7 offset:16384
    ds_read_b64_tr_b16 v[242:243], v7 offset:17408
    s_waitcnt lgkmcnt(6)
    v_mfma_f32_16x16x32_bf16 v[128:131], v[228:231], v[56:59], v[128:131]
    ds_read_b64_tr_b16 v[244:245], v8 offset:16416
    s_mov_b32 s23, 0x6000
    buffer_load_dwordx4 v[48:51], v6, s[8:11], s23 offen offset:3072 sc1
    v_mfma_f32_16x16x32_bf16 v[132:135], v[228:231], v[60:63], v[132:135]
    ds_read_b64_tr_b16 v[246:247], v8 offset:17440
    s_waitcnt lgkmcnt(6)
    v_mfma_f32_16x16x32_bf16 v[136:139], v[232:235], v[56:59], v[136:139]
    ds_read_b64_tr_b16 v[224:225], v7 offset:16640
    v_mfma_f32_16x16x32_bf16 v[140:143], v[232:235], v[60:63], v[140:143]
    ds_read_b64_tr_b16 v[226:227], v7 offset:17664
    s_mov_b32 s23, 0x26000
    buffer_load_dwordx4 v[52:55], v6, s[8:11], s23 offen offset:3072 sc1
    s_waitcnt lgkmcnt(6)
    v_mfma_f32_16x16x32_bf16 v[144:147], v[236:239], v[56:59], v[144:147]
    ds_read_b64_tr_b16 v[228:229], v8 offset:16672
    v_mfma_f32_16x16x32_bf16 v[148:151], v[236:239], v[60:63], v[148:151]
    ds_read_b64_tr_b16 v[230:231], v8 offset:17696
    s_waitcnt lgkmcnt(6)
    v_mfma_f32_16x16x32_bf16 v[88:91], v[240:243], v[64:67], v[88:91]
    ds_read_b64_tr_b16 v[232:233], v7 offset:16896
    v_mfma_f32_16x16x32_bf16 v[92:95], v[240:243], v[68:71], v[92:95]
    s_add_u32 s22, s24, 0x1b0000
    s_add_u32 m0, s20, 0x1c000
    s_nop 0
    buffer_load_dwordx4 v3, s[4:7], s22 offen lds
    ds_read_b64_tr_b16 v[234:235], v7 offset:17920
    s_waitcnt lgkmcnt(6)
    v_mfma_f32_16x16x32_bf16 v[96:99], v[244:247], v[64:67], v[96:99]
    ds_read_b64_tr_b16 v[236:237], v8 offset:16928
    v_mfma_f32_16x16x32_bf16 v[100:103], v[244:247], v[68:71], v[100:103]
    ds_read_b64_tr_b16 v[238:239], v8 offset:17952
    s_waitcnt lgkmcnt(6)
    v_mfma_f32_16x16x32_bf16 v[104:107], v[224:227], v[64:67], v[104:107]
    s_add_u32 s22, s24, 0x1b2000
    s_add_u32 m0, s20, 0x1c400
    s_nop 0
    buffer_load_dwordx4 v3, s[4:7], s22 offen lds
    ds_read_b64_tr_b16 v[240:241], v7 offset:17152
    v_mfma_f32_16x16x32_bf16 v[108:111], v[224:227], v[68:71], v[108:111]
    ds_read_b64_tr_b16 v[242:243], v7 offset:18176
    s_waitcnt lgkmcnt(6)
    v_mfma_f32_16x16x32_bf16 v[112:115], v[228:231], v[64:67], v[112:115]
    ds_read_b64_tr_b16 v[244:245], v8 offset:17184
    v_mfma_f32_16x16x32_bf16 v[116:119], v[228:231], v[68:71], v[116:119]
    ds_read_b64_tr_b16 v[246:247], v8 offset:18208
    s_waitcnt lgkmcnt(6)
    v_mfma_f32_16x16x32_bf16 v[120:123], v[232:235], v[64:67], v[120:123]
    v_mfma_f32_16x16x32_bf16 v[124:127], v[232:235], v[68:71], v[124:127]
    s_waitcnt vmcnt(12)
    s_barrier
    ds_read_b64_tr_b16 v[224:225], v4 offset:0
    ds_read_b64_tr_b16 v[226:227], v4 offset:1024
    s_waitcnt lgkmcnt(6)
    v_mfma_f32_16x16x32_bf16 v[128:131], v[236:239], v[64:67], v[128:131]
    ds_read_b64_tr_b16 v[228:229], v5 offset:32
    s_mov_b32 s23, 0x8000
    buffer_load_dwordx4 v[56:59], v6, s[8:11], s23 offen offset:3072 sc1
    v_mfma_f32_16x16x32_bf16 v[132:135], v[236:239], v[68:71], v[132:135]
    ds_read_b64_tr_b16 v[230:231], v5 offset:1056
    s_waitcnt lgkmcnt(6)
    v_mfma_f32_16x16x32_bf16 v[136:139], v[240:243], v[64:67], v[136:139]
    ds_read_b64_tr_b16 v[232:233], v4 offset:256
    v_mfma_f32_16x16x32_bf16 v[140:143], v[240:243], v[68:71], v[140:143]
    ds_read_b64_tr_b16 v[234:235], v4 offset:1280
    s_mov_b32 s23, 0x28000
    buffer_load_dwordx4 v[60:63], v6, s[8:11], s23 offen offset:3072 sc1
    s_waitcnt lgkmcnt(6)
    v_mfma_f32_16x16x32_bf16 v[144:147], v[244:247], v[64:67], v[144:147]
    ds_read_b64_tr_b16 v[236:237], v5 offset:288
    v_mfma_f32_16x16x32_bf16 v[148:151], v[244:247], v[68:71], v[148:151]
    ds_read_b64_tr_b16 v[238:239], v5 offset:1312
    s_waitcnt lgkmcnt(6)
    v_mfma_f32_16x16x32_bf16 v[88:91], v[224:227], v[24:27], v[88:91]
    ds_read_b64_tr_b16 v[240:241], v4 offset:512
    v_mfma_f32_16x16x32_bf16 v[92:95], v[224:227], v[28:31], v[92:95]
    s_add_u32 s22, s24, 0x230000
    s_add_u32 m0, s20, 0x20000
    s_nop 0
    buffer_load_dwordx4 v3, s[4:7], s22 offen lds
    ds_read_b64_tr_b16 v[242:243], v4 offset:1536
    s_waitcnt lgkmcnt(6)
    v_mfma_f32_16x16x32_bf16 v[96:99], v[228:231], v[24:27], v[96:99]
    ds_read_b64_tr_b16 v[244:245], v5 offset:544
    v_mfma_f32_16x16x32_bf16 v[100:103], v[228:231], v[28:31], v[100:103]
    ds_read_b64_tr_b16 v[246:247], v5 offset:1568
    s_waitcnt lgkmcnt(6)
    v_mfma_f32_16x16x32_bf16 v[104:107], v[232:235], v[24:27], v[104:107]
    s_add_u32 s22, s24, 0x232000
    s_add_u32 m0, s20, 0x20400
    s_nop 0
    buffer_load_dwordx4 v3, s[4:7], s22 offen lds
    ds_read_b64_tr_b16 v[224:225], v4 offset:768
    v_mfma_f32_16x16x32_bf16 v[108:111], v[232:235], v[28:31], v[108:111]
    ds_read_b64_tr_b16 v[226:227], v4 offset:1792
    s_waitcnt lgkmcnt(6)
    v_mfma_f32_16x16x32_bf16 v[112:115], v[236:239], v[24:27], v[112:115]
    ds_read_b64_tr_b16 v[228:229], v5 offset:800
    v_mfma_f32_16x16x32_bf16 v[116:119], v[236:239], v[28:31], v[116:119]
    ds_read_b64_tr_b16 v[230:231], v5 offset:1824
    s_waitcnt lgkmcnt(6)
    v_mfma_f32_16x16x32_bf16 v[120:123], v[240:243], v[24:27], v[120:123]
    v_mfma_f32_16x16x32_bf16 v[124:127], v[240:243], v[28:31], v[124:127]
    s_waitcnt vmcnt(12)
    s_barrier
    ds_read_b64_tr_b16 v[232:233], v4 offset:16384
    ds_read_b64_tr_b16 v[234:235], v4 offset:17408
    s_waitcnt lgkmcnt(6)
    v_mfma_f32_16x16x32_bf16 v[128:131], v[244:247], v[24:27], v[128:131]
    ds_read_b64_tr_b16 v[236:237], v5 offset:16416
    s_mov_b32 s23, 0xa000
    buffer_load_dwordx4 v[64:67], v6, s[8:11], s23 offen offset:3072 sc1
    v_mfma_f32_16x16x32_bf16 v[132:135], v[244:247], v[28:31], v[132:135]
    ds_read_b64_tr_b16 v[238:239], v5 offset:17440
    s_waitcnt lgkmcnt(6)
    v_mfma_f32_16x16x32_bf16 v[136:139], v[224:227], v[24:27], v[136:139]
    ds_read_b64_tr_b16 v[240:241], v4 offset:16640
    v_mfma_f32_16x16x32_bf16 v[140:143], v[224:227], v[28:31], v[140:143]
    ds_read_b64_tr_b16 v[242:243], v4 offset:17664
    s_mov_b32 s23, 0x2a000
    buffer_load_dwordx4 v[68:71], v6, s[8:11], s23 offen offset:3072 sc1
    s_waitcnt lgkmcnt(6)
    v_mfma_f32_16x16x32_bf16 v[144:147], v[228:231], v[24:27], v[144:147]
    ds_read_b64_tr_b16 v[244:245], v5 offset:16672
    v_mfma_f32_16x16x32_bf16 v[148:151], v[228:231], v[28:31], v[148:151]
    ds_read_b64_tr_b16 v[246:247], v5 offset:17696
    s_waitcnt lgkmcnt(6)
    v_mfma_f32_16x16x32_bf16 v[88:91], v[232:235], v[32:35], v[88:91]
    ds_read_b64_tr_b16 v[224:225], v4 offset:16896
    v_mfma_f32_16x16x32_bf16 v[92:95], v[232:235], v[36:39], v[92:95]
    s_add_u32 s22, s24, 0x2b0000
    s_add_u32 m0, s20, 0x24000
    s_nop 0
    buffer_load_dwordx4 v3, s[4:7], s22 offen lds
    ds_read_b64_tr_b16 v[226:227], v4 offset:17920
    s_waitcnt lgkmcnt(6)
    v_mfma_f32_16x16x32_bf16 v[96:99], v[236:239], v[32:35], v[96:99]
    ds_read_b64_tr_b16 v[228:229], v5 offset:16928
    v_mfma_f32_16x16x32_bf16 v[100:103], v[236:239], v[36:39], v[100:103]
    ds_read_b64_tr_b16 v[230:231], v5 offset:17952
    s_waitcnt lgkmcnt(6)
    v_mfma_f32_16x16x32_bf16 v[104:107], v[240:243], v[32:35], v[104:107]
    s_add_u32 s22, s24, 0x2b2000
    s_add_u32 m0, s20, 0x24400
    s_nop 0
    buffer_load_dwordx4 v3, s[4:7], s22 offen lds
    ds_read_b64_tr_b16 v[232:233], v4 offset:17152
    v_mfma_f32_16x16x32_bf16 v[108:111], v[240:243], v[36:39], v[108:111]
    ds_read_b64_tr_b16 v[234:235], v4 offset:18176
    s_mov_b32 s16, 0x544000
    buffer_load_dwordx4 v[184:187], v2, s[8:11], s16 offen sc1
    s_waitcnt lgkmcnt(6)
    v_mfma_f32_16x16x32_bf16 v[112:115], v[244:247], v[32:35], v[112:115]
    ds_read_b64_tr_b16 v[236:237], v5 offset:17184
    v_mfma_f32_16x16x32_bf16 v[116:119], v[244:247], v[36:39], v[116:119]
    ds_read_b64_tr_b16 v[238:239], v5 offset:18208
    s_waitcnt lgkmcnt(6)
    v_mfma_f32_16x16x32_bf16 v[120:123], v[224:227], v[32:35], v[120:123]
    v_mfma_f32_16x16x32_bf16 v[124:127], v[224:227], v[36:39], v[124:127]
    s_waitcnt vmcnt(13)
    s_barrier
    ds_read_b64_tr_b16 v[240:241], v4 offset:32768
    ds_read_b64_tr_b16 v[242:243], v4 offset:33792
    s_waitcnt lgkmcnt(6)
    v_mfma_f32_16x16x32_bf16 v[128:131], v[228:231], v[32:35], v[128:131]
    ds_read_b64_tr_b16 v[244:245], v5 offset:32800
    s_mov_b32 s23, 0xc000
    buffer_load_dwordx4 v[24:27], v6, s[8:11], s23 offen offset:3072 sc1
    v_mfma_f32_16x16x32_bf16 v[132:135], v[228:231], v[36:39], v[132:135]
    ds_read_b64_tr_b16 v[246:247], v5 offset:33824
    s_waitcnt lgkmcnt(6)
    v_mfma_f32_16x16x32_bf16 v[136:139], v[232:235], v[32:35], v[136:139]
    ds_read_b64_tr_b16 v[224:225], v4 offset:33024
    v_mfma_f32_16x16x32_bf16 v[140:143], v[232:235], v[36:39], v[140:143]
    ds_read_b64_tr_b16 v[226:227], v4 offset:34048
    s_mov_b32 s23, 0x2c000
    buffer_load_dwordx4 v[28:31], v6, s[8:11], s23 offen offset:3072 sc1
    s_waitcnt lgkmcnt(6)
    v_mfma_f32_16x16x32_bf16 v[144:147], v[236:239], v[32:35], v[144:147]
    ds_read_b64_tr_b16 v[228:229], v5 offset:33056
    v_mfma_f32_16x16x32_bf16 v[148:151], v[236:239], v[36:39], v[148:151]
    ds_read_b64_tr_b16 v[230:231], v5 offset:34080
    s_waitcnt lgkmcnt(6)
    v_mfma_f32_16x16x32_bf16 v[88:91], v[240:243], v[40:43], v[88:91]
    ds_read_b64_tr_b16 v[232:233], v4 offset:33280
    v_mfma_f32_16x16x32_bf16 v[92:95], v[240:243], v[44:47], v[92:95]
    s_add_u32 s22, s24, 0x330000
    s_add_u32 m0, s20, 0x10000
    s_nop 0
    buffer_load_dwordx4 v3, s[4:7], s22 offen lds
    ds_read_b64_tr_b16 v[234:235], v4 offset:34304
    s_waitcnt lgkmcnt(6)
    v_mfma_f32_16x16x32_bf16 v[96:99], v[244:247], v[40:43], v[96:99]
    ds_read_b64_tr_b16 v[236:237], v5 offset:33312
    v_mfma_f32_16x16x32_bf16 v[100:103], v[244:247], v[44:47], v[100:103]
    ds_read_b64_tr_b16 v[238:239], v5 offset:34336
    s_waitcnt lgkmcnt(6)
    v_mfma_f32_16x16x32_bf16 v[104:107], v[224:227], v[40:43], v[104:107]
    s_add_u32 s22, s24, 0x332000
    s_add_u32 m0, s20, 0x10400
    s_nop 0
    buffer_load_dwordx4 v3, s[4:7], s22 offen lds
    ds_read_b64_tr_b16 v[240:241], v4 offset:33536
    v_mfma_f32_16x16x32_bf16 v[108:111], v[224:227], v[44:47], v[108:111]
    ds_read_b64_tr_b16 v[242:243], v4 offset:34560
    s_waitcnt vmcnt(4)
    v_xor_b32 v16, s28, v184
    v_xor_b32 v17, s28, v185
    v_xor_b32 v18, s28, v186
    v_xor_b32 v19, s28, v187
    v_or3_b32 v16, v16, v17, v18
    v_or_b32 v16, v16, v19
    v_cmp_ne_u32 vcc, 0, v16
    s_cbranch_vccnz adaLN_cond__sliding_block_cached__moe_arch_mod__prompt_kernel_mf21r
adaLN_cond__sliding_block_cached__moe_arch_mod__prompt_kernel_mf21b:
    s_waitcnt lgkmcnt(6)
    v_mfma_f32_16x16x32_bf16 v[112:115], v[228:231], v[40:43], v[112:115]
    ds_read_b64_tr_b16 v[244:245], v5 offset:33568
    v_mfma_f32_16x16x32_bf16 v[116:119], v[228:231], v[44:47], v[116:119]
    ds_read_b64_tr_b16 v[246:247], v5 offset:34592
    s_waitcnt lgkmcnt(6)
    v_mfma_f32_16x16x32_bf16 v[120:123], v[232:235], v[40:43], v[120:123]
    v_mfma_f32_16x16x32_bf16 v[124:127], v[232:235], v[44:47], v[124:127]
    s_barrier
    ds_read_b64_tr_b16 v[224:225], v4 offset:49152
    ds_read_b64_tr_b16 v[226:227], v4 offset:50176
    s_waitcnt lgkmcnt(6)
    v_mfma_f32_16x16x32_bf16 v[128:131], v[236:239], v[40:43], v[128:131]
    ds_read_b64_tr_b16 v[228:229], v5 offset:49184
    s_mov_b32 s23, 0xe000
    buffer_load_dwordx4 v[32:35], v6, s[8:11], s23 offen offset:3072 sc1
    v_mfma_f32_16x16x32_bf16 v[132:135], v[236:239], v[44:47], v[132:135]
    ds_read_b64_tr_b16 v[230:231], v5 offset:50208
    s_waitcnt lgkmcnt(6)
    v_mfma_f32_16x16x32_bf16 v[136:139], v[240:243], v[40:43], v[136:139]
    ds_read_b64_tr_b16 v[232:233], v4 offset:49408
    v_mfma_f32_16x16x32_bf16 v[140:143], v[240:243], v[44:47], v[140:143]
    ds_read_b64_tr_b16 v[234:235], v4 offset:50432
    s_mov_b32 s23, 0x2e000
    buffer_load_dwordx4 v[36:39], v6, s[8:11], s23 offen offset:3072 sc1
    s_waitcnt lgkmcnt(6)
    v_mfma_f32_16x16x32_bf16 v[144:147], v[244:247], v[40:43], v[144:147]
    ds_read_b64_tr_b16 v[236:237], v5 offset:49440
    v_mfma_f32_16x16x32_bf16 v[148:151], v[244:247], v[44:47], v[148:151]
    ds_read_b64_tr_b16 v[238:239], v5 offset:50464
    s_waitcnt lgkmcnt(6)
    v_mfma_f32_16x16x32_bf16 v[88:91], v[224:227], v[48:51], v[88:91]
    ds_read_b64_tr_b16 v[240:241], v4 offset:49664
    v_mfma_f32_16x16x32_bf16 v[92:95], v[224:227], v[52:55], v[92:95]
    s_add_u32 s22, s24, 0x3b0000
    s_add_u32 m0, s20, 0x14000
    s_nop 0
    buffer_load_dwordx4 v3, s[4:7], s22 offen lds
    ds_read_b64_tr_b16 v[242:243], v4 offset:50688
    s_waitcnt lgkmcnt(6)
    v_mfma_f32_16x16x32_bf16 v[96:99], v[228:231], v[48:51], v[96:99]
    ds_read_b64_tr_b16 v[244:245], v5 offset:49696
    v_mfma_f32_16x16x32_bf16 v[100:103], v[228:231], v[52:55], v[100:103]
    ds_read_b64_tr_b16 v[246:247], v5 offset:50720
    s_waitcnt lgkmcnt(6)
    v_mfma_f32_16x16x32_bf16 v[104:107], v[232:235], v[48:51], v[104:107]
    s_add_u32 s22, s24, 0x3b2000
    s_add_u32 m0, s20, 0x14400
    s_nop 0
    buffer_load_dwordx4 v3, s[4:7], s22 offen lds
    ds_read_b64_tr_b16 v[224:225], v4 offset:49920
    v_mfma_f32_16x16x32_bf16 v[108:111], v[232:235], v[52:55], v[108:111]
    ds_read_b64_tr_b16 v[226:227], v4 offset:50944
    v_lshrrev_b32 v16, 4, v1
    v_lshlrev_b32 v16, 3, v16
    s_lshl_b32 s16, s31, 8
    s_add_u32 s16, s16, 0x540080
    buffer_load_dwordx2 v[248:249], v16, s[8:11], s16 offen offset:0 sc1
    buffer_load_dwordx2 v[250:251], v16, s[8:11], s16 offen offset:32 sc1
    buffer_load_dwordx2 v[252:253], v16, s[8:11], s16 offen offset:64 sc1
    buffer_load_dwordx2 v[254:255], v16, s[8:11], s16 offen offset:96 sc1
    s_waitcnt lgkmcnt(6)
    v_mfma_f32_16x16x32_bf16 v[112:115], v[236:239], v[48:51], v[112:115]
    ds_read_b64_tr_b16 v[228:229], v5 offset:49952
    v_mfma_f32_16x16x32_bf16 v[116:119], v[236:239], v[52:55], v[116:119]
    ds_read_b64_tr_b16 v[230:231], v5 offset:50976
    s_waitcnt lgkmcnt(6)
    v_mfma_f32_16x16x32_bf16 v[120:123], v[240:243], v[48:51], v[120:123]
    v_mfma_f32_16x16x32_bf16 v[124:127], v[240:243], v[52:55], v[124:127]
    s_barrier
    ds_read_b64_tr_b16 v[232:233], v7 offset:0
    ds_read_b64_tr_b16 v[234:235], v7 offset:1024
    s_waitcnt lgkmcnt(6)
    v_mfma_f32_16x16x32_bf16 v[128:131], v[244:247], v[48:51], v[128:131]
    ds_read_b64_tr_b16 v[236:237], v8 offset:32
    v_mfma_f32_16x16x32_bf16 v[132:135], v[244:247], v[52:55], v[132:135]
    ds_read_b64_tr_b16 v[238:239], v8 offset:1056
    s_waitcnt lgkmcnt(6)
    v_mfma_f32_16x16x32_bf16 v[136:139], v[224:227], v[48:51], v[136:139]
    ds_read_b64_tr_b16 v[240:241], v7 offset:256
    v_mfma_f32_16x16x32_bf16 v[140:143], v[224:227], v[52:55], v[140:143]
    ds_read_b64_tr_b16 v[242:243], v7 offset:1280
    s_waitcnt lgkmcnt(6)
    v_mfma_f32_16x16x32_bf16 v[144:147], v[228:231], v[48:51], v[144:147]
    ds_read_b64_tr_b16 v[244:245], v8 offset:288
    v_mfma_f32_16x16x32_bf16 v[148:151], v[228:231], v[52:55], v[148:151]
    ds_read_b64_tr_b16 v[246:247], v8 offset:1312
    s_waitcnt lgkmcnt(6)
    v_mfma_f32_16x16x32_bf16 v[88:91], v[232:235], v[56:59], v[88:91]
    ds_read_b64_tr_b16 v[224:225], v7 offset:512
    v_mfma_f32_16x16x32_bf16 v[92:95], v[232:235], v[60:63], v[92:95]
    ds_read_b64_tr_b16 v[226:227], v7 offset:1536
    s_waitcnt lgkmcnt(6)
    v_mfma_f32_16x16x32_bf16 v[96:99], v[236:239], v[56:59], v[96:99]
    ds_read_b64_tr_b16 v[228:229], v8 offset:544
    v_mfma_f32_16x16x32_bf16 v[100:103], v[236:239], v[60:63], v[100:103]
    ds_read_b64_tr_b16 v[230:231], v8 offset:1568
    s_waitcnt lgkmcnt(6)
    v_mfma_f32_16x16x32_bf16 v[104:107], v[240:243], v[56:59], v[104:107]
    ds_read_b64_tr_b16 v[232:233], v7 offset:768
    v_mfma_f32_16x16x32_bf16 v[108:111], v[240:243], v[60:63], v[108:111]
    ds_read_b64_tr_b16 v[234:235], v7 offset:1792
    s_waitcnt lgkmcnt(6)
    v_mfma_f32_16x16x32_bf16 v[112:115], v[244:247], v[56:59], v[112:115]
    ds_read_b64_tr_b16 v[236:237], v8 offset:800
    v_mfma_f32_16x16x32_bf16 v[116:119], v[244:247], v[60:63], v[116:119]
    ds_read_b64_tr_b16 v[238:239], v8 offset:1824
    s_waitcnt lgkmcnt(6)
    v_mfma_f32_16x16x32_bf16 v[120:123], v[224:227], v[56:59], v[120:123]
    s_mov_b64 s[72:73], s[48:49]
    s_mov_b32 s74, 0x700000
    s_mov_b32 s75, 0x20000
    s_cmp_lt_u32 s2, 224
    s_cselect_b32 s74, 7340032, 0
    s_and_b32 s16, s3, 3
    v_lshrrev_b32 v20, 3, v1
    v_lshlrev_b32 v20, 3, v20
    s_lshl_b32 s17, s16, 6
    v_add_u32 v20, s17, v20
    s_mov_b32 s17, 7168
    v_mul_lo_u32 v21, s17, v20
    v_and_b32 v20, 7, v1
    v_lshl_add_u32 v21, v20, 4, v21
    s_and_b32 s17, s29, 3
    s_mul_i32 s18, s17, 1835008
    s_lshr_b32 s17, s29, 2
    s_lshl_b32 s17, s17, 7
    s_add_u32 s18, s18, s17
    s_lshl_b32 s16, s16, 13
    s_add_u32 s22, s18, 0
    s_add_u32 m0, s16, 32768
    s_nop 0
    buffer_load_dwordx4 v21, s[72:75], s22 offen lds
    s_add_u32 s22, s18, 7168
    s_add_u32 m0, s16, 33792
    s_nop 0
    buffer_load_dwordx4 v21, s[72:75], s22 offen lds
    s_add_u32 s22, s18, 14336
    s_add_u32 m0, s16, 34816
    s_nop 0
    buffer_load_dwordx4 v21, s[72:75], s22 offen lds
    s_add_u32 s22, s18, 21504
    s_add_u32 m0, s16, 35840
    s_nop 0
    buffer_load_dwordx4 v21, s[72:75], s22 offen lds
    s_add_u32 s22, s18, 28672
    s_add_u32 m0, s16, 36864
    s_nop 0
    buffer_load_dwordx4 v21, s[72:75], s22 offen lds
    s_add_u32 s22, s18, 35840
    s_add_u32 m0, s16, 37888
    s_nop 0
    buffer_load_dwordx4 v21, s[72:75], s22 offen lds
    s_add_u32 s22, s18, 43008
    s_add_u32 m0, s16, 38912
    s_nop 0
    buffer_load_dwordx4 v21, s[72:75], s22 offen lds
    s_add_u32 s22, s18, 50176
    s_add_u32 m0, s16, 39936
    s_nop 0
    buffer_load_dwordx4 v21, s[72:75], s22 offen lds
    v_mfma_f32_16x16x32_bf16 v[124:127], v[224:227], v[60:63], v[124:127]
    s_barrier
    ds_read_b64_tr_b16 v[240:241], v7 offset:16384
    ds_read_b64_tr_b16 v[242:243], v7 offset:17408
    s_waitcnt lgkmcnt(6)
    v_mfma_f32_16x16x32_bf16 v[128:131], v[228:231], v[56:59], v[128:131]
    ds_read_b64_tr_b16 v[244:245], v8 offset:16416
    v_mfma_f32_16x16x32_bf16 v[132:135], v[228:231], v[60:63], v[132:135]
    ds_read_b64_tr_b16 v[246:247], v8 offset:17440
    s_waitcnt lgkmcnt(6)
    v_mfma_f32_16x16x32_bf16 v[136:139], v[232:235], v[56:59], v[136:139]
    ds_read_b64_tr_b16 v[224:225], v7 offset:16640
    v_mfma_f32_16x16x32_bf16 v[140:143], v[232:235], v[60:63], v[140:143]
    ds_read_b64_tr_b16 v[226:227], v7 offset:17664
    s_waitcnt lgkmcnt(6)
    v_mfma_f32_16x16x32_bf16 v[144:147], v[236:239], v[56:59], v[144:147]
    ds_read_b64_tr_b16 v[228:229], v8 offset:16672
    v_mfma_f32_16x16x32_bf16 v[148:151], v[236:239], v[60:63], v[148:151]
    ds_read_b64_tr_b16 v[230:231], v8 offset:17696
    s_waitcnt lgkmcnt(6)
    v_mfma_f32_16x16x32_bf16 v[88:91], v[240:243], v[64:67], v[88:91]
    ds_read_b64_tr_b16 v[232:233], v7 offset:16896
    v_mfma_f32_16x16x32_bf16 v[92:95], v[240:243], v[68:71], v[92:95]
    ds_read_b64_tr_b16 v[234:235], v7 offset:17920
    s_waitcnt lgkmcnt(6)
    v_mfma_f32_16x16x32_bf16 v[96:99], v[244:247], v[64:67], v[96:99]
    ds_read_b64_tr_b16 v[236:237], v8 offset:16928
    v_mfma_f32_16x16x32_bf16 v[100:103], v[244:247], v[68:71], v[100:103]
    ds_read_b64_tr_b16 v[238:239], v8 offset:17952
    s_waitcnt lgkmcnt(6)
    v_mfma_f32_16x16x32_bf16 v[104:107], v[224:227], v[64:67], v[104:107]
    ds_read_b64_tr_b16 v[240:241], v7 offset:17152
    v_mfma_f32_16x16x32_bf16 v[108:111], v[224:227], v[68:71], v[108:111]
    ds_read_b64_tr_b16 v[242:243], v7 offset:18176
    s_waitcnt lgkmcnt(6)
    v_mfma_f32_16x16x32_bf16 v[112:115], v[228:231], v[64:67], v[112:115]
    ds_read_b64_tr_b16 v[244:245], v8 offset:17184
    v_mfma_f32_16x16x32_bf16 v[116:119], v[228:231], v[68:71], v[116:119]
    ds_read_b64_tr_b16 v[246:247], v8 offset:18208
    s_waitcnt lgkmcnt(6)
    v_mfma_f32_16x16x32_bf16 v[120:123], v[232:235], v[64:67], v[120:123]
    v_mfma_f32_16x16x32_bf16 v[124:127], v[232:235], v[68:71], v[124:127]
    s_waitcnt vmcnt(16)
    s_barrier
    ds_read_b64_tr_b16 v[224:225], v4 offset:0
    ds_read_b64_tr_b16 v[226:227], v4 offset:1024
    s_waitcnt lgkmcnt(6)
    v_mfma_f32_16x16x32_bf16 v[128:131], v[236:239], v[64:67], v[128:131]
    ds_read_b64_tr_b16 v[228:229], v5 offset:32
    v_mfma_f32_16x16x32_bf16 v[132:135], v[236:239], v[68:71], v[132:135]
    ds_read_b64_tr_b16 v[230:231], v5 offset:1056
    s_waitcnt lgkmcnt(6)
    v_mfma_f32_16x16x32_bf16 v[136:139], v[240:243], v[64:67], v[136:139]
    ds_read_b64_tr_b16 v[232:233], v4 offset:256
    v_mfma_f32_16x16x32_bf16 v[140:143], v[240:243], v[68:71], v[140:143]
    ds_read_b64_tr_b16 v[234:235], v4 offset:1280
    s_waitcnt lgkmcnt(6)
    v_mfma_f32_16x16x32_bf16 v[144:147], v[244:247], v[64:67], v[144:147]
    ds_read_b64_tr_b16 v[236:237], v5 offset:288
    v_mfma_f32_16x16x32_bf16 v[148:151], v[244:247], v[68:71], v[148:151]
    ds_read_b64_tr_b16 v[238:239], v5 offset:1312
    s_waitcnt lgkmcnt(6)
    v_mfma_f32_16x16x32_bf16 v[88:91], v[224:227], v[24:27], v[88:91]
    ds_read_b64_tr_b16 v[240:241], v4 offset:512
    v_mfma_f32_16x16x32_bf16 v[92:95], v[224:227], v[28:31], v[92:95]
    ds_read_b64_tr_b16 v[242:243], v4 offset:1536
    s_waitcnt lgkmcnt(6)
    v_mfma_f32_16x16x32_bf16 v[96:99], v[228:231], v[24:27], v[96:99]
    ds_read_b64_tr_b16 v[244:245], v5 offset:544
    v_mfma_f32_16x16x32_bf16 v[100:103], v[228:231], v[28:31], v[100:103]
    ds_read_b64_tr_b16 v[246:247], v5 offset:1568
    s_waitcnt lgkmcnt(6)
    v_mfma_f32_16x16x32_bf16 v[104:107], v[232:235], v[24:27], v[104:107]
    ds_read_b64_tr_b16 v[224:225], v4 offset:768
    v_mfma_f32_16x16x32_bf16 v[108:111], v[232:235], v[28:31], v[108:111]
    ds_read_b64_tr_b16 v[226:227], v4 offset:1792
    s_waitcnt lgkmcnt(6)
    v_mfma_f32_16x16x32_bf16 v[112:115], v[236:239], v[24:27], v[112:115]
    ds_read_b64_tr_b16 v[228:229], v5 offset:800
    v_mfma_f32_16x16x32_bf16 v[116:119], v[236:239], v[28:31], v[116:119]
    ds_read_b64_tr_b16 v[230:231], v5 offset:1824
    s_waitcnt lgkmcnt(6)
    v_mfma_f32_16x16x32_bf16 v[120:123], v[240:243], v[24:27], v[120:123]
    v_mfma_f32_16x16x32_bf16 v[124:127], v[240:243], v[28:31], v[124:127]
    s_waitcnt vmcnt(12)
    s_barrier
    ds_read_b64_tr_b16 v[232:233], v4 offset:16384
    ds_read_b64_tr_b16 v[234:235], v4 offset:17408
    s_waitcnt lgkmcnt(6)
    v_mfma_f32_16x16x32_bf16 v[128:131], v[244:247], v[24:27], v[128:131]
    ds_read_b64_tr_b16 v[236:237], v5 offset:16416
    v_mfma_f32_16x16x32_bf16 v[132:135], v[244:247], v[28:31], v[132:135]
    ds_read_b64_tr_b16 v[238:239], v5 offset:17440
    s_waitcnt lgkmcnt(6)
    v_mfma_f32_16x16x32_bf16 v[136:139], v[224:227], v[24:27], v[136:139]
    ds_read_b64_tr_b16 v[240:241], v4 offset:16640
    v_mfma_f32_16x16x32_bf16 v[140:143], v[224:227], v[28:31], v[140:143]
    ds_read_b64_tr_b16 v[242:243], v4 offset:17664
    s_waitcnt lgkmcnt(6)
    v_mfma_f32_16x16x32_bf16 v[144:147], v[228:231], v[24:27], v[144:147]
    ds_read_b64_tr_b16 v[244:245], v5 offset:16672
    v_mfma_f32_16x16x32_bf16 v[148:151], v[228:231], v[28:31], v[148:151]
    ds_read_b64_tr_b16 v[246:247], v5 offset:17696
    s_waitcnt lgkmcnt(6)
    v_mfma_f32_16x16x32_bf16 v[88:91], v[232:235], v[32:35], v[88:91]
    ds_read_b64_tr_b16 v[224:225], v4 offset:16896
    v_mfma_f32_16x16x32_bf16 v[92:95], v[232:235], v[36:39], v[92:95]
    ds_read_b64_tr_b16 v[226:227], v4 offset:17920
    s_waitcnt lgkmcnt(6)
    v_mfma_f32_16x16x32_bf16 v[96:99], v[236:239], v[32:35], v[96:99]
    ds_read_b64_tr_b16 v[228:229], v5 offset:16928
    v_mfma_f32_16x16x32_bf16 v[100:103], v[236:239], v[36:39], v[100:103]
    ds_read_b64_tr_b16 v[230:231], v5 offset:17952
    s_waitcnt lgkmcnt(6)
    v_mfma_f32_16x16x32_bf16 v[104:107], v[240:243], v[32:35], v[104:107]
    ds_read_b64_tr_b16 v[232:233], v4 offset:17152
    v_mfma_f32_16x16x32_bf16 v[108:111], v[240:243], v[36:39], v[108:111]
    ds_read_b64_tr_b16 v[234:235], v4 offset:18176
    s_waitcnt lgkmcnt(6)
    v_mfma_f32_16x16x32_bf16 v[112:115], v[244:247], v[32:35], v[112:115]
    ds_read_b64_tr_b16 v[236:237], v5 offset:17184
    v_mfma_f32_16x16x32_bf16 v[116:119], v[244:247], v[36:39], v[116:119]
    ds_read_b64_tr_b16 v[238:239], v5 offset:18208
    s_waitcnt lgkmcnt(6)
    v_mfma_f32_16x16x32_bf16 v[120:123], v[224:227], v[32:35], v[120:123]
    v_mfma_f32_16x16x32_bf16 v[124:127], v[224:227], v[36:39], v[124:127]
    s_waitcnt lgkmcnt(4)
    v_mfma_f32_16x16x32_bf16 v[128:131], v[228:231], v[32:35], v[128:131]
    v_mfma_f32_16x16x32_bf16 v[132:135], v[228:231], v[36:39], v[132:135]
    s_waitcnt lgkmcnt(2)
    v_mfma_f32_16x16x32_bf16 v[136:139], v[232:235], v[32:35], v[136:139]
    v_mfma_f32_16x16x32_bf16 v[140:143], v[232:235], v[36:39], v[140:143]
    s_waitcnt lgkmcnt(0)
    v_mfma_f32_16x16x32_bf16 v[144:147], v[236:239], v[32:35], v[144:147]
    v_mfma_f32_16x16x32_bf16 v[148:151], v[236:239], v[36:39], v[148:151]
    s_lshl_b32 s16, s3, 13
    s_xor_b32 s17, s16, 0x8000
    s_add_u32 s16, s16, 0x18000
    s_add_u32 s17, s17, 0x18000
    v_add_u32 v16, s16, v2
    s_mov_b32 s16, s17
    v_add_u32 v17, s16, v2
    ds_write_b128 v16, v[88:91] offset:0
    ds_write_b128 v16, v[92:95] offset:1024
    ds_write_b128 v16, v[96:99] offset:2048
    ds_write_b128 v16, v[100:103] offset:3072
    ds_write_b128 v16, v[104:107] offset:4096
    ds_write_b128 v16, v[108:111] offset:5120
    ds_write_b128 v16, v[112:115] offset:6144
    ds_write_b128 v16, v[116:119] offset:7168
    s_waitcnt vmcnt(11)
    v_lshlrev_b32 v24, 16, v248
    v_and_b32 v25, 0xffff0000, v248
    v_lshlrev_b32 v26, 16, v249
    v_and_b32 v27, 0xffff0000, v249
    s_waitcnt vmcnt(10)
    v_lshlrev_b32 v28, 16, v250
    v_and_b32 v29, 0xffff0000, v250
    v_lshlrev_b32 v30, 16, v251
    v_and_b32 v31, 0xffff0000, v251
    s_waitcnt vmcnt(9)
    v_lshlrev_b32 v32, 16, v252
    v_and_b32 v33, 0xffff0000, v252
    v_lshlrev_b32 v34, 16, v253
    v_and_b32 v35, 0xffff0000, v253
    s_waitcnt vmcnt(8)
    v_lshlrev_b32 v36, 16, v254
    v_and_b32 v37, 0xffff0000, v254
    v_lshlrev_b32 v38, 16, v255
    v_and_b32 v39, 0xffff0000, v255
    v_and_b32 v18, 15, v1
    v_lshlrev_b32 v18, 6, v18
    v_lshrrev_b32 v19, 4, v1
    v_and_b32 v20, 1, v19
    v_lshl_add_u32 v18, v20, 5, v18
    v_lshrrev_b32 v19, 1, v19
    v_lshl_add_u32 v18, v19, 4, v18
    s_and_b32 s17, s3, 3
    s_lshl_b32 s18, s30, 2
    s_add_u32 s18, s18, s17
    s_lshl_b32 s18, s18, 16
    s_lshl_b32 s19, s15, 22
    s_add_u32 s18, s18, s19
    s_lshl_b32 s19, s31, 12
    s_add_u32 s18, s18, s19
    s_add_u32 s18, s18, 0x2000800
    s_add_u32 s19, s18, 32768
    s_waitcnt lgkmcnt(0)
    s_barrier
    ds_read_b128 v[40:43], v17 offset:0
    ds_read_b128 v[44:47], v17 offset:1024
    ds_read_b128 v[48:51], v17 offset:2048
    ds_read_b128 v[52:55], v17 offset:3072
    ds_read_b128 v[56:59], v17 offset:4096
    ds_read_b128 v[60:63], v17 offset:5120
    ds_read_b128 v[64:67], v17 offset:6144
    ds_read_b128 v[68:71], v17 offset:7168
    s_waitcnt lgkmcnt(7)
    v_pk_add_f32 v[120:121], v[120:121], v[40:41]
    v_pk_add_f32 v[122:123], v[122:123], v[42:43]
    v_pk_mul_f32 v[120:121], v[120:121], v[24:25]
    v_pk_mul_f32 v[122:123], v[122:123], v[26:27]
    v_cvt_pk_bf16_f32 v224, v120, v121
    v_cvt_pk_bf16_f32 v225, v122, v123
    s_waitcnt lgkmcnt(5)
    v_pk_add_f32 v[128:129], v[128:129], v[48:49]
    v_pk_add_f32 v[130:131], v[130:131], v[50:51]
    v_pk_mul_f32 v[128:129], v[128:129], v[28:29]
    v_pk_mul_f32 v[130:131], v[130:131], v[30:31]
    v_cvt_pk_bf16_f32 v226, v128, v129
    v_cvt_pk_bf16_f32 v227, v130, v131
    s_nop 0
    v_permlane16_swap_b32 v224, v226
    v_permlane16_swap_b32 v225, v227
    buffer_store_dwordx4 v[224:227], v18, s[8:11], s18 offen offset:0 sc1
    v_pk_add_f32 v[124:125], v[124:125], v[44:45]
    v_pk_add_f32 v[126:127], v[126:127], v[46:47]
    v_pk_mul_f32 v[124:125], v[124:125], v[24:25]
    v_pk_mul_f32 v[126:127], v[126:127], v[26:27]
    v_cvt_pk_bf16_f32 v228, v124, v125
    v_cvt_pk_bf16_f32 v229, v126, v127
    s_waitcnt lgkmcnt(4)
    v_pk_add_f32 v[132:133], v[132:133], v[52:53]
    v_pk_add_f32 v[134:135], v[134:135], v[54:55]
    v_pk_mul_f32 v[132:133], v[132:133], v[28:29]
    v_pk_mul_f32 v[134:135], v[134:135], v[30:31]
    v_cvt_pk_bf16_f32 v230, v132, v133
    v_cvt_pk_bf16_f32 v231, v134, v135
    s_nop 0
    v_permlane16_swap_b32 v228, v230
    v_permlane16_swap_b32 v229, v231
    buffer_store_dwordx4 v[228:231], v18, s[8:11], s19 offen offset:0 sc1
    s_waitcnt lgkmcnt(3)
    v_pk_add_f32 v[136:137], v[136:137], v[56:57]
    v_pk_add_f32 v[138:139], v[138:139], v[58:59]
    v_pk_mul_f32 v[136:137], v[136:137], v[32:33]
    v_pk_mul_f32 v[138:139], v[138:139], v[34:35]
    v_cvt_pk_bf16_f32 v232, v136, v137
    v_cvt_pk_bf16_f32 v233, v138, v139
    s_waitcnt lgkmcnt(1)
    v_pk_add_f32 v[144:145], v[144:145], v[64:65]
    v_pk_add_f32 v[146:147], v[146:147], v[66:67]
    v_pk_mul_f32 v[144:145], v[144:145], v[36:37]
    v_pk_mul_f32 v[146:147], v[146:147], v[38:39]
    v_cvt_pk_bf16_f32 v234, v144, v145
    v_cvt_pk_bf16_f32 v235, v146, v147
    s_nop 0
    v_permlane16_swap_b32 v232, v234
    v_permlane16_swap_b32 v233, v235
    buffer_store_dwordx4 v[232:235], v18, s[8:11], s18 offen offset:1024 sc1
    v_pk_add_f32 v[140:141], v[140:141], v[60:61]
    v_pk_add_f32 v[142:143], v[142:143], v[62:63]
    v_pk_mul_f32 v[140:141], v[140:141], v[32:33]
    v_pk_mul_f32 v[142:143], v[142:143], v[34:35]
    v_cvt_pk_bf16_f32 v236, v140, v141
    v_cvt_pk_bf16_f32 v237, v142, v143
    s_waitcnt lgkmcnt(0)
    v_pk_add_f32 v[148:149], v[148:149], v[68:69]
    v_pk_add_f32 v[150:151], v[150:151], v[70:71]
    v_pk_mul_f32 v[148:149], v[148:149], v[36:37]
    v_pk_mul_f32 v[150:151], v[150:151], v[38:39]
    v_cvt_pk_bf16_f32 v238, v148, v149
    v_cvt_pk_bf16_f32 v239, v150, v151
    s_nop 0
    v_permlane16_swap_b32 v236, v238
    v_permlane16_swap_b32 v237, v239
    buffer_store_dwordx4 v[236:239], v18, s[8:11], s19 offen offset:1024 sc1
    s_mov_b64 s[64:65], s[44:45]
    s_mov_b32 s66, 0x800
    s_mov_b32 s67, 0x20000
    s_mov_b64 s[76:77], s[32:33]
    s_mov_b32 s78, 0x400000
    s_mov_b32 s79, 0x20000
    s_mov_b64 s[68:69], s[56:57]
    s_mov_b32 s70, 0x400000
    s_mov_b32 s71, 0x20000
    s_lshl_b32 s14, s31, 1
    s_add_u32 s14, s14, s15
    s_lshl_b32 s14, s14, 3
    s_add_u32 s14, s14, s3
    s_lshl_b32 s16, s30, 7
    s_add_u32 s14, s14, s16
    s_lshl_b32 s16, s14, 11
    buffer_load_dwordx4 v[216:219], v2, s[76:79], s16 offen offset:0
    buffer_load_dwordx4 v[220:223], v2, s[76:79], s16 offen offset:1024
    s_lshl_b32 s16, s3, 10
    s_add_u32 m0, s16, 81920
    s_add_u32 s17, s16, 0x540800
    s_cmp_lt_u32 s3, 6
    s_cselect_b32 s17, s17, 0x7ffffff0
    s_sub_u32 s23, s16, 6144
    s_cmp_ge_u32 s3, 6
    s_cselect_b32 s23, s23, 0x7ffffff0
    s_cbranch_scc1 adaLN_cond__sliding_block_cached__moe_arch_mod__prompt_kernel_mlw
    buffer_load_dwordx4 v2, s[8:11], s17 offen sc1 lds
    s_branch adaLN_cond__sliding_block_cached__moe_arch_mod__prompt_kernel_mlj
adaLN_cond__sliding_block_cached__moe_arch_mod__prompt_kernel_mlw:
    buffer_load_dwordx4 v2, s[64:67], s23 offen lds
adaLN_cond__sliding_block_cached__moe_arch_mod__prompt_kernel_mlj:
    s_lshl_b32 s16, s30, 5
    s_lshl_b32 s17, s31, 1
    s_add_u32 s16, s16, s17
    s_add_u32 s16, s16, s15
    s_lshl_b32 s16, s16, 2
    s_add_u32 s16, s16, 0x530000
    s_cmp_eq_u32 s3, 0
    s_cselect_b32 s16, s16, 0x7ffffff0
    v_mov_b32 v16, s28
    v_mov_b32 v17, 0
    s_lshr_b32 s18, s14, 4
    s_lshl_b32 s18, s18, 15
    s_and_b32 s19, s14, 15
    s_lshl_b32 s19, s19, 6
    s_add_u32 s18, s18, s19
    s_add_u32 s18, s18, 0x2000000
    s_add_u32 s19, s18, 16384
    v_lshrrev_b32 v18, 2, v1
    v_lshlrev_b32 v18, 10, v18
    v_and_b32 v19, 3, v1
    v_lshl_add_u32 v18, v19, 4, v18
    v_add_u32 v19, 0x400000, v18
    s_lshl_b32 s25, s30, 7
    s_add_u32 s25, s25, 0x530000
    v_and_b32 v20, 15, v1
    v_lshlrev_b32 v20, 2, v20
    s_waitcnt vmcnt(3)
    s_waitcnt vmcnt(0)
    s_barrier
    s_mov_b64 exec, 1
    buffer_store_dword v16, v17, s[8:11], s16 offen sc1
    s_mov_b64 exec, -1
    v_add_u32 v16, 81920, v2
    ds_read_b128 v[184:187], v16 offset:0
    ds_read_b128 v[188:191], v16 offset:1024
    ds_read_b128 v[192:195], v16 offset:2048
    ds_read_b128 v[196:199], v16 offset:3072
    ds_read_b128 v[200:203], v16 offset:4096
    ds_read_b128 v[204:207], v16 offset:5120
    ds_read_b128 v[208:211], v16 offset:6144
    ds_read_b128 v[212:215], v16 offset:7168
    v_mov_b32 v94, 0
    v_mov_b32 v95, 0
    s_waitcnt lgkmcnt(5)
    v_lshlrev_b32 v76, 16, v192
    v_and_b32 v77, 0xffff0000, v192
    s_waitcnt lgkmcnt(1)
    v_lshlrev_b32 v78, 16, v208
    v_and_b32 v79, 0xffff0000, v208
    v_pk_mul_f32 v[60:61], v[76:77], v[78:79]
    v_lshlrev_b32 v76, 16, v184
    v_and_b32 v77, 0xffff0000, v184
    v_fmac_f32 v94, v76, v78
    v_fmac_f32 v94, v77, v79
    v_add_f32 v95, v95, v60
    v_add_f32 v95, v95, v61
    v_lshlrev_b32 v76, 16, v193
    v_and_b32 v77, 0xffff0000, v193
    v_lshlrev_b32 v78, 16, v209
    v_and_b32 v79, 0xffff0000, v209
    v_pk_mul_f32 v[62:63], v[76:77], v[78:79]
    v_lshlrev_b32 v76, 16, v185
    v_and_b32 v77, 0xffff0000, v185
    v_fmac_f32 v94, v76, v78
    v_fmac_f32 v94, v77, v79
    v_add_f32 v95, v95, v62
    v_add_f32 v95, v95, v63
    v_lshlrev_b32 v76, 16, v194
    v_and_b32 v77, 0xffff0000, v194
    v_lshlrev_b32 v78, 16, v210
    v_and_b32 v79, 0xffff0000, v210
    v_pk_mul_f32 v[64:65], v[76:77], v[78:79]
    v_lshlrev_b32 v76, 16, v186
    v_and_b32 v77, 0xffff0000, v186
    v_fmac_f32 v94, v76, v78
    v_fmac_f32 v94, v77, v79
    v_add_f32 v95, v95, v64
    v_add_f32 v95, v95, v65
    v_lshlrev_b32 v76, 16, v195
    v_and_b32 v77, 0xffff0000, v195
    v_lshlrev_b32 v78, 16, v211
    v_and_b32 v79, 0xffff0000, v211
    v_pk_mul_f32 v[66:67], v[76:77], v[78:79]
    v_lshlrev_b32 v76, 16, v187
    v_and_b32 v77, 0xffff0000, v187
    v_fmac_f32 v94, v76, v78
    v_fmac_f32 v94, v77, v79
    v_add_f32 v95, v95, v66
    v_add_f32 v95, v95, v67
    v_lshlrev_b32 v76, 16, v196
    v_and_b32 v77, 0xffff0000, v196
    s_waitcnt lgkmcnt(0)
    v_lshlrev_b32 v78, 16, v212
    v_and_b32 v79, 0xffff0000, v212
    v_pk_mul_f32 v[68:69], v[76:77], v[78:79]
    v_lshlrev_b32 v76, 16, v188
    v_and_b32 v77, 0xffff0000, v188
    v_fmac_f32 v94, v76, v78
    v_fmac_f32 v94, v77, v79
    v_add_f32 v95, v95, v68
    v_add_f32 v95, v95, v69
    v_lshlrev_b32 v76, 16, v197
    v_and_b32 v77, 0xffff0000, v197
    v_lshlrev_b32 v78, 16, v213
    v_and_b32 v79, 0xffff0000, v213
    v_pk_mul_f32 v[70:71], v[76:77], v[78:79]
    v_lshlrev_b32 v76, 16, v189
    v_and_b32 v77, 0xffff0000, v189
    v_fmac_f32 v94, v76, v78
    v_fmac_f32 v94, v77, v79
    v_add_f32 v95, v95, v70
    v_add_f32 v95, v95, v71
    v_lshlrev_b32 v76, 16, v198
    v_and_b32 v77, 0xffff0000, v198
    v_lshlrev_b32 v78, 16, v214
    v_and_b32 v79, 0xffff0000, v214
    v_pk_mul_f32 v[72:73], v[76:77], v[78:79]
    v_lshlrev_b32 v76, 16, v190
    v_and_b32 v77, 0xffff0000, v190
    v_fmac_f32 v94, v76, v78
    v_fmac_f32 v94, v77, v79
    v_add_f32 v95, v95, v72
    v_add_f32 v95, v95, v73
    v_lshlrev_b32 v76, 16, v199
    v_and_b32 v77, 0xffff0000, v199
    v_lshlrev_b32 v78, 16, v215
    v_and_b32 v79, 0xffff0000, v215
    v_pk_mul_f32 v[74:75], v[76:77], v[78:79]
    v_lshlrev_b32 v76, 16, v191
    v_and_b32 v77, 0xffff0000, v191
    v_fmac_f32 v94, v76, v78
    v_fmac_f32 v94, v77, v79
    v_add_f32 v95, v95, v74
    v_add_f32 v95, v95, v75
    v_add_f32_dpp v94, v94, v94 row_ror:1 row_mask:0xf bank_mask:0xf
    s_nop 0
    v_add_f32_dpp v95, v95, v95 row_ror:1 row_mask:0xf bank_mask:0xf
    v_add_f32_dpp v94, v94, v94 row_ror:2 row_mask:0xf bank_mask:0xf
    s_nop 0
    v_add_f32_dpp v95, v95, v95 row_ror:2 row_mask:0xf bank_mask:0xf
    v_add_f32_dpp v94, v94, v94 row_ror:4 row_mask:0xf bank_mask:0xf
    s_nop 0
    v_add_f32_dpp v95, v95, v95 row_ror:4 row_mask:0xf bank_mask:0xf
    v_add_f32_dpp v94, v94, v94 row_ror:8 row_mask:0xf bank_mask:0xf
    s_nop 0
    v_add_f32_dpp v95, v95, v95 row_ror:8 row_mask:0xf bank_mask:0xf
    v_mov_b32 v76, v94
    s_nop 1
    v_permlane16_swap_b32 v94, v76
    v_add_f32 v94, v94, v76
    v_mov_b32 v77, v95
    s_nop 1
    v_permlane16_swap_b32 v95, v77
    v_add_f32 v95, v95, v77
    v_mov_b32 v76, v94
    s_nop 1
    v_permlane32_swap_b32 v94, v76
    v_add_f32 v94, v94, v76
    v_mov_b32 v77, v95
    s_nop 1
    v_permlane32_swap_b32 v95, v77
    v_add_f32 v95, v95, v77
    v_lshlrev_b32 v28, 16, v216
    v_and_b32 v29, 0xffff0000, v216
    v_lshlrev_b32 v30, 16, v217
    v_and_b32 v31, 0xffff0000, v217
    v_lshlrev_b32 v32, 16, v218
    v_and_b32 v33, 0xffff0000, v218
    v_lshlrev_b32 v34, 16, v219
    v_and_b32 v35, 0xffff0000, v219
    v_lshlrev_b32 v36, 16, v220
    v_and_b32 v37, 0xffff0000, v220
    v_lshlrev_b32 v38, 16, v221
    v_and_b32 v39, 0xffff0000, v221
    v_lshlrev_b32 v40, 16, v222
    v_and_b32 v41, 0xffff0000, v222
    v_lshlrev_b32 v42, 16, v223
    v_and_b32 v43, 0xffff0000, v223
    s_mov_b32 s27, 0
adaLN_cond__sliding_block_cached__moe_arch_mod__prompt_kernel_a22p:
    buffer_load_dword v76, v20, s[8:11], s25 offen sc1
    s_waitcnt vmcnt(0)
    v_cmp_ne_u32 vcc, s28, v76
    s_add_u32 s27, s27, 1
    s_cmp_ge_u32 s27, 65536
    s_cbranch_scc1 adaLN_cond__sliding_block_cached__moe_arch_mod__prompt_kernel_a22g
    s_cbranch_vccnz adaLN_cond__sliding_block_cached__moe_arch_mod__prompt_kernel_a22p
adaLN_cond__sliding_block_cached__moe_arch_mod__prompt_kernel_a22g:
    buffer_load_dwordx4 v[44:47], v18, s[8:11], s18 offen sc1
    buffer_load_dwordx4 v[52:55], v19, s[8:11], s18 offen sc1
    buffer_load_dwordx4 v[48:51], v18, s[8:11], s19 offen sc1
    buffer_load_dwordx4 v[56:59], v19, s[8:11], s19 offen sc1
    v_lshlrev_b32 v21, 2, v0
    s_mov_b32 s16, 0x540800
    buffer_load_dword v106, v21, s[8:11], s16 offen sc1
    buffer_load_dword v104, v21, s[8:11], s16 offen offset:2048 sc1
    s_waitcnt vmcnt(5)
    v_lshlrev_b32 v76, 16, v44
    v_and_b32 v77, 0xffff0000, v44
    s_waitcnt vmcnt(4)
    v_lshlrev_b32 v78, 16, v52
    v_and_b32 v79, 0xffff0000, v52
    v_pk_add_f32 v[76:77], v[76:77], v[78:79]
    v_pk_add_f32 v[28:29], v[28:29], v[76:77]
    v_cvt_pk_bf16_f32 v16, v28, v29
    v_lshlrev_b32 v28, 16, v16
    v_and_b32 v29, 0xffff0000, v16
    v_lshlrev_b32 v80, 16, v45
    v_and_b32 v81, 0xffff0000, v45
    v_lshlrev_b32 v82, 16, v53
    v_and_b32 v83, 0xffff0000, v53
    v_pk_add_f32 v[80:81], v[80:81], v[82:83]
    v_pk_add_f32 v[30:31], v[30:31], v[80:81]
    v_cvt_pk_bf16_f32 v17, v30, v31
    v_lshlrev_b32 v30, 16, v17
    v_and_b32 v31, 0xffff0000, v17
    v_lshlrev_b32 v76, 16, v46
    v_and_b32 v77, 0xffff0000, v46
    v_lshlrev_b32 v78, 16, v54
    v_and_b32 v79, 0xffff0000, v54
    v_pk_add_f32 v[76:77], v[76:77], v[78:79]
    v_pk_add_f32 v[32:33], v[32:33], v[76:77]
    v_cvt_pk_bf16_f32 v16, v32, v33
    v_lshlrev_b32 v32, 16, v16
    v_and_b32 v33, 0xffff0000, v16
    v_lshlrev_b32 v80, 16, v47
    v_and_b32 v81, 0xffff0000, v47
    v_lshlrev_b32 v82, 16, v55
    v_and_b32 v83, 0xffff0000, v55
    v_pk_add_f32 v[80:81], v[80:81], v[82:83]
    v_pk_add_f32 v[34:35], v[34:35], v[80:81]
    v_cvt_pk_bf16_f32 v17, v34, v35
    v_lshlrev_b32 v34, 16, v17
    v_and_b32 v35, 0xffff0000, v17
    s_waitcnt vmcnt(3)
    v_lshlrev_b32 v76, 16, v48
    v_and_b32 v77, 0xffff0000, v48
    s_waitcnt vmcnt(2)
    v_lshlrev_b32 v78, 16, v56
    v_and_b32 v79, 0xffff0000, v56
    v_pk_add_f32 v[76:77], v[76:77], v[78:79]
    v_pk_add_f32 v[36:37], v[36:37], v[76:77]
    v_cvt_pk_bf16_f32 v16, v36, v37
    v_lshlrev_b32 v36, 16, v16
    v_and_b32 v37, 0xffff0000, v16
    v_lshlrev_b32 v80, 16, v49
    v_and_b32 v81, 0xffff0000, v49
    v_lshlrev_b32 v82, 16, v57
    v_and_b32 v83, 0xffff0000, v57
    v_pk_add_f32 v[80:81], v[80:81], v[82:83]
    v_pk_add_f32 v[38:39], v[38:39], v[80:81]
    v_cvt_pk_bf16_f32 v17, v38, v39
    v_lshlrev_b32 v38, 16, v17
    v_and_b32 v39, 0xffff0000, v17
    v_lshlrev_b32 v76, 16, v50
    v_and_b32 v77, 0xffff0000, v50
    v_lshlrev_b32 v78, 16, v58
    v_and_b32 v79, 0xffff0000, v58
    v_pk_add_f32 v[76:77], v[76:77], v[78:79]
    v_pk_add_f32 v[40:41], v[40:41], v[76:77]
    v_cvt_pk_bf16_f32 v16, v40, v41
    v_lshlrev_b32 v40, 16, v16
    v_and_b32 v41, 0xffff0000, v16
    v_lshlrev_b32 v80, 16, v51
    v_and_b32 v81, 0xffff0000, v51
    v_lshlrev_b32 v82, 16, v59
    v_and_b32 v83, 0xffff0000, v59
    v_pk_add_f32 v[80:81], v[80:81], v[82:83]
    v_pk_add_f32 v[42:43], v[42:43], v[80:81]
    v_cvt_pk_bf16_f32 v17, v42, v43
    v_lshlrev_b32 v42, 16, v17
    v_and_b32 v43, 0xffff0000, v17
    v_pk_add_f32 v[76:77], v[28:29], v[30:31]
    v_pk_mul_f32 v[78:79], v[28:29], v[28:29]
    v_pk_mul_f32 v[80:81], v[28:29], v[60:61]
    v_pk_fma_f32 v[78:79], v[30:31], v[30:31], v[78:79]
    v_pk_fma_f32 v[80:81], v[30:31], v[62:63], v[80:81]
    v_pk_add_f32 v[76:77], v[76:77], v[32:33]
    v_pk_fma_f32 v[78:79], v[32:33], v[32:33], v[78:79]
    v_pk_fma_f32 v[80:81], v[32:33], v[64:65], v[80:81]
    v_pk_add_f32 v[76:77], v[76:77], v[34:35]
    v_pk_fma_f32 v[78:79], v[34:35], v[34:35], v[78:79]
    v_pk_fma_f32 v[80:81], v[34:35], v[66:67], v[80:81]
    v_pk_add_f32 v[76:77], v[76:77], v[36:37]
    v_pk_fma_f32 v[78:79], v[36:37], v[36:37], v[78:79]
    v_pk_fma_f32 v[80:81], v[36:37], v[68:69], v[80:81]
    v_pk_add_f32 v[76:77], v[76:77], v[38:39]
    v_pk_fma_f32 v[78:79], v[38:39], v[38:39], v[78:79]
    v_pk_fma_f32 v[80:81], v[38:39], v[70:71], v[80:81]
    v_pk_add_f32 v[76:77], v[76:77], v[40:41]
    v_pk_fma_f32 v[78:79], v[40:41], v[40:41], v[78:79]
    v_pk_fma_f32 v[80:81], v[40:41], v[72:73], v[80:81]
    v_pk_add_f32 v[76:77], v[76:77], v[42:43]
    v_pk_fma_f32 v[78:79], v[42:43], v[42:43], v[78:79]
    v_pk_fma_f32 v[80:81], v[42:43], v[74:75], v[80:81]
    v_add_f32 v96, v76, v77
    v_add_f32 v97, v78, v79
    v_add_f32 v98, v80, v81
    v_add_f32_dpp v96, v96, v96 row_ror:1 row_mask:0xf bank_mask:0xf
    v_add_f32_dpp v97, v97, v97 row_ror:1 row_mask:0xf bank_mask:0xf
    v_add_f32_dpp v98, v98, v98 row_ror:1 row_mask:0xf bank_mask:0xf
    v_add_f32_dpp v96, v96, v96 row_ror:2 row_mask:0xf bank_mask:0xf
    v_add_f32_dpp v97, v97, v97 row_ror:2 row_mask:0xf bank_mask:0xf
    v_add_f32_dpp v98, v98, v98 row_ror:2 row_mask:0xf bank_mask:0xf
    v_add_f32_dpp v96, v96, v96 row_ror:4 row_mask:0xf bank_mask:0xf
    v_add_f32_dpp v97, v97, v97 row_ror:4 row_mask:0xf bank_mask:0xf
    v_add_f32_dpp v98, v98, v98 row_ror:4 row_mask:0xf bank_mask:0xf
    v_add_f32_dpp v96, v96, v96 row_ror:8 row_mask:0xf bank_mask:0xf
    v_add_f32_dpp v97, v97, v97 row_ror:8 row_mask:0xf bank_mask:0xf
    v_add_f32_dpp v98, v98, v98 row_ror:8 row_mask:0xf bank_mask:0xf
    v_mov_b32 v76, v96
    s_nop 1
    v_permlane16_swap_b32 v96, v76
    v_add_f32 v96, v96, v76
    v_mov_b32 v77, v97
    s_nop 1
    v_permlane16_swap_b32 v97, v77
    v_add_f32 v97, v97, v77
    v_mov_b32 v78, v98
    s_nop 1
    v_permlane16_swap_b32 v98, v78
    v_add_f32 v98, v98, v78
    v_mov_b32 v76, v96
    s_nop 1
    v_permlane32_swap_b32 v96, v76
    v_add_f32 v96, v96, v76
    v_mov_b32 v77, v97
    s_nop 1
    v_permlane32_swap_b32 v97, v77
    v_add_f32 v97, v97, v77
    v_mov_b32 v78, v98
    s_nop 1
    v_permlane32_swap_b32 v98, v78
    v_add_f32 v98, v98, v78
    v_mul_f32 v96, 0x3a800000, v96
    v_mul_f32 v97, 0x3a800000, v97
    v_fma_f32 v97, -v96, v96, v97
    v_max_f32 v97, 0, v97
    v_fma_f32 v98, -v96, v95, v98
    v_add_f32 v76, 0x3727c5ac, v97
    v_rsq_f32 v76, v76
    s_nop 0
    v_fma_f32 v27, v98, v76, v94
    v_cvt_pk_bf16_f32 v96, v96, v96
    v_lshlrev_b32 v96, 16, v96
    v_cvt_pk_bf16_f32 v97, v97, v97
    v_lshlrev_b32 v97, 16, v97
    v_add_f32 v97, 0x3727c5ac, v97
    v_cvt_pk_bf16_f32 v97, v97, v97
    v_lshlrev_b32 v97, 16, v97
    v_sqrt_f32 v98, v97
    s_nop 0
    v_cvt_pk_bf16_f32 v98, v98, v98
    v_lshlrev_b32 v98, 16, v98
    v_rcp_f32 v99, v98
    v_mov_b32 v25, v96
    v_mov_b32 v26, v98
    v_ashrrev_i32 v16, 31, v27
    v_or_b32 v16, 0x80000000, v16
    v_xor_b32 v24, v27, v16
    v_and_b32 v24, 0xfffff800, v24
    v_max_u32 v24, 0x800, v24
    s_sub_u32 s16, 2047, s14
    v_or_b32 v24, s16, v24
    s_lshl_b32 s16, s3, 4
    s_add_u32 s16, s16, 65536
    v_mov_b32 v16, s16
    ds_write_b128 v16, v[24:27]
    s_waitcnt lgkmcnt(0)
    s_barrier
    v_and_b32 v16, 7, v1
    v_lshlrev_b32 v16, 4, v16
    v_add_u32 v16, 65536, v16
    ds_read_b32 v76, v16
    s_waitcnt lgkmcnt(0)
    v_mov_b32 v77, v76
    s_nop 1
    v_max_u32_dpp v77, v77, v77 row_ror:1 row_mask:0xf bank_mask:0xf
    s_nop 1
    v_max_u32_dpp v77, v77, v77 row_ror:2 row_mask:0xf bank_mask:0xf
    s_nop 1
    v_max_u32_dpp v77, v77, v77 row_ror:4 row_mask:0xf bank_mask:0xf
    v_cmp_eq_u32 vcc, v76, v77
    s_ff1_i32_b64 s16, vcc
    s_lshl_b32 s16, s16, 4
    s_add_u32 s16, s16, 65536
    v_mov_b32 v16, s16
    ds_read_b128 v[24:27], v16
    s_lshl_b32 s16, s2, 4
    s_add_u32 s16, s16, 0x6e0000
    s_cmp_eq_u32 s3, 0
    s_cselect_b32 s16, s16, 0x7ffffff0
    v_mov_b32 v17, 0
    s_mov_b64 exec, 1
    s_waitcnt lgkmcnt(0)
    buffer_store_dwordx4 v[24:27], v17, s[8:11], s16 offen sc1
    s_mov_b64 exec, -1
    s_mov_b64 s[72:73], s[50:51]
    s_mov_b32 s74, 0x700000
    s_mov_b32 s75, 0x20000
    s_cmp_lt_u32 s2, 224
    s_cselect_b32 s74, 7340032, 0
    s_lshl_b32 s17, s29, 4
    s_sub_u32 s16, s3, 4
    s_lshl_b32 s16, s16, 2
    s_add_u32 s16, s16, s17
    s_lshl_b32 s16, s16, 11
    s_add_u32 s17, s16, 0
    buffer_load_dwordx4 v[152:155], v2, s[72:75], s17 offen offset:0
    buffer_load_dwordx4 v[156:159], v2, s[72:75], s17 offen offset:1024
    s_add_u32 s17, s16, 2048
    buffer_load_dwordx4 v[160:163], v2, s[72:75], s17 offen offset:0
    buffer_load_dwordx4 v[164:167], v2, s[72:75], s17 offen offset:1024
    s_add_u32 s17, s16, 4096
    buffer_load_dwordx4 v[168:171], v2, s[72:75], s17 offen offset:0
    buffer_load_dwordx4 v[172:175], v2, s[72:75], s17 offen offset:1024
    s_add_u32 s17, s16, 6144
    buffer_load_dwordx4 v[176:179], v2, s[72:75], s17 offen offset:0
    buffer_load_dwordx4 v[180:183], v2, s[72:75], s17 offen offset:1024
    v_sub_f32 v44, v28, v96
    v_sub_f32 v45, v29, v96
    v_sub_f32 v46, v30, v96
    v_sub_f32 v47, v31, v96
    v_sub_f32 v48, v32, v96
    v_sub_f32 v49, v33, v96
    v_sub_f32 v50, v34, v96
    v_sub_f32 v51, v35, v96
    v_cvt_pk_bf16_f32 v16, v44, v45
    v_lshlrev_b32 v44, 16, v16
    v_and_b32 v45, 0xffff0000, v16
    v_cvt_pk_bf16_f32 v16, v46, v47
    v_lshlrev_b32 v46, 16, v16
    v_and_b32 v47, 0xffff0000, v16
    v_cvt_pk_bf16_f32 v16, v48, v49
    v_lshlrev_b32 v48, 16, v16
    v_and_b32 v49, 0xffff0000, v16
    v_cvt_pk_bf16_f32 v16, v50, v51
    v_lshlrev_b32 v50, 16, v16
    v_and_b32 v51, 0xffff0000, v16
    v_mul_f32 v52, v44, v99
    v_mul_f32 v53, v45, v99
    v_mul_f32 v54, v46, v99
    v_mul_f32 v55, v47, v99
    v_mul_f32 v56, v48, v99
    v_mul_f32 v57, v49, v99
    v_mul_f32 v58, v50, v99
    v_mul_f32 v59, v51, v99
    v_fma_f32 v44, -v52, v98, v44
    v_fma_f32 v45, -v53, v98, v45
    v_fma_f32 v46, -v54, v98, v46
    v_fma_f32 v47, -v55, v98, v47
    v_fma_f32 v48, -v56, v98, v48
    v_fma_f32 v49, -v57, v98, v49
    v_fma_f32 v50, -v58, v98, v50
    v_fma_f32 v51, -v59, v98, v51
    v_fma_f32 v44, v44, v99, v52
    v_fma_f32 v45, v45, v99, v53
    v_fma_f32 v46, v46, v99, v54
    v_fma_f32 v47, v47, v99, v55
    v_fma_f32 v48, v48, v99, v56
    v_fma_f32 v49, v49, v99, v57
    v_fma_f32 v50, v50, v99, v58
    v_fma_f32 v51, v51, v99, v59
    v_cvt_pk_bf16_f32 v16, v44, v45
    v_lshlrev_b32 v44, 16, v16
    v_and_b32 v45, 0xffff0000, v16
    v_cvt_pk_bf16_f32 v16, v46, v47
    v_lshlrev_b32 v46, 16, v16
    v_and_b32 v47, 0xffff0000, v16
    v_cvt_pk_bf16_f32 v16, v48, v49
    v_lshlrev_b32 v48, 16, v16
    v_and_b32 v49, 0xffff0000, v16
    v_cvt_pk_bf16_f32 v16, v50, v51
    v_lshlrev_b32 v50, 16, v16
    v_and_b32 v51, 0xffff0000, v16
    v_lshlrev_b32 v52, 16, v192
    v_and_b32 v53, 0xffff0000, v192
    v_lshlrev_b32 v54, 16, v193
    v_and_b32 v55, 0xffff0000, v193
    v_lshlrev_b32 v56, 16, v194
    v_and_b32 v57, 0xffff0000, v194
    v_lshlrev_b32 v58, 16, v195
    v_and_b32 v59, 0xffff0000, v195
    v_pk_mul_f32 v[44:45], v[44:45], v[52:53]
    v_pk_mul_f32 v[46:47], v[46:47], v[54:55]
    v_pk_mul_f32 v[48:49], v[48:49], v[56:57]
    v_pk_mul_f32 v[50:51], v[50:51], v[58:59]
    v_cvt_pk_bf16_f32 v16, v44, v45
    v_lshlrev_b32 v44, 16, v16
    v_and_b32 v45, 0xffff0000, v16
    v_cvt_pk_bf16_f32 v16, v46, v47
    v_lshlrev_b32 v46, 16, v16
    v_and_b32 v47, 0xffff0000, v16
    v_cvt_pk_bf16_f32 v16, v48, v49
    v_lshlrev_b32 v48, 16, v16
    v_and_b32 v49, 0xffff0000, v16
    v_cvt_pk_bf16_f32 v16, v50, v51
    v_lshlrev_b32 v50, 16, v16
    v_and_b32 v51, 0xffff0000, v16
    v_lshlrev_b32 v52, 16, v184
    v_and_b32 v53, 0xffff0000, v184
    v_lshlrev_b32 v54, 16, v185
    v_and_b32 v55, 0xffff0000, v185
    v_lshlrev_b32 v56, 16, v186
    v_and_b32 v57, 0xffff0000, v186
    v_lshlrev_b32 v58, 16, v187
    v_and_b32 v59, 0xffff0000, v187
    v_pk_add_f32 v[44:45], v[44:45], v[52:53]
    v_pk_add_f32 v[46:47], v[46:47], v[54:55]
    v_pk_add_f32 v[48:49], v[48:49], v[56:57]
    v_pk_add_f32 v[50:51], v[50:51], v[58:59]
    v_cvt_pk_bf16_f32 v16, v44, v45
    v_lshlrev_b32 v44, 16, v16
    v_and_b32 v45, 0xffff0000, v16
    v_cvt_pk_bf16_f32 v16, v46, v47
    v_lshlrev_b32 v46, 16, v16
    v_and_b32 v47, 0xffff0000, v16
    v_cvt_pk_bf16_f32 v16, v48, v49
    v_lshlrev_b32 v48, 16, v16
    v_and_b32 v49, 0xffff0000, v16
    v_cvt_pk_bf16_f32 v16, v50, v51
    v_lshlrev_b32 v50, 16, v16
    v_and_b32 v51, 0xffff0000, v16
    v_lshlrev_b32 v52, 16, v200
    v_and_b32 v53, 0xffff0000, v200
    v_lshlrev_b32 v54, 16, v201
    v_and_b32 v55, 0xffff0000, v201
    v_lshlrev_b32 v56, 16, v202
    v_and_b32 v57, 0xffff0000, v202
    v_lshlrev_b32 v58, 16, v203
    v_and_b32 v59, 0xffff0000, v203
    v_pk_mul_f32 v[44:45], v[44:45], v[52:53]
    v_pk_mul_f32 v[46:47], v[46:47], v[54:55]
    v_pk_mul_f32 v[48:49], v[48:49], v[56:57]
    v_pk_mul_f32 v[50:51], v[50:51], v[58:59]
    v_cvt_pk_bf16_f32 v16, v44, v45
    v_lshlrev_b32 v44, 16, v16
    v_and_b32 v45, 0xffff0000, v16
    v_cvt_pk_bf16_f32 v16, v46, v47
    v_lshlrev_b32 v46, 16, v16
    v_and_b32 v47, 0xffff0000, v16
    v_cvt_pk_bf16_f32 v16, v48, v49
    v_lshlrev_b32 v48, 16, v16
    v_and_b32 v49, 0xffff0000, v16
    v_cvt_pk_bf16_f32 v16, v50, v51
    v_lshlrev_b32 v50, 16, v16
    v_and_b32 v51, 0xffff0000, v16
    v_pk_add_f32 v[44:45], v[44:45], v[28:29]
    v_pk_add_f32 v[46:47], v[46:47], v[30:31]
    v_pk_add_f32 v[48:49], v[48:49], v[32:33]
    v_pk_add_f32 v[50:51], v[50:51], v[34:35]
    v_cvt_pk_bf16_f32 v28, v44, v45
    v_cvt_pk_bf16_f32 v29, v46, v47
    v_cvt_pk_bf16_f32 v30, v48, v49
    v_cvt_pk_bf16_f32 v31, v50, v51
    v_sub_f32 v44, v36, v96
    v_sub_f32 v45, v37, v96
    v_sub_f32 v46, v38, v96
    v_sub_f32 v47, v39, v96
    v_sub_f32 v48, v40, v96
    v_sub_f32 v49, v41, v96
    v_sub_f32 v50, v42, v96
    v_sub_f32 v51, v43, v96
    v_cvt_pk_bf16_f32 v16, v44, v45
    v_lshlrev_b32 v44, 16, v16
    v_and_b32 v45, 0xffff0000, v16
    v_cvt_pk_bf16_f32 v16, v46, v47
    v_lshlrev_b32 v46, 16, v16
    v_and_b32 v47, 0xffff0000, v16
    v_cvt_pk_bf16_f32 v16, v48, v49
    v_lshlrev_b32 v48, 16, v16
    v_and_b32 v49, 0xffff0000, v16
    v_cvt_pk_bf16_f32 v16, v50, v51
    v_lshlrev_b32 v50, 16, v16
    v_and_b32 v51, 0xffff0000, v16
    v_mul_f32 v52, v44, v99
    v_mul_f32 v53, v45, v99
    v_mul_f32 v54, v46, v99
    v_mul_f32 v55, v47, v99
    v_mul_f32 v56, v48, v99
    v_mul_f32 v57, v49, v99
    v_mul_f32 v58, v50, v99
    v_mul_f32 v59, v51, v99
    v_fma_f32 v44, -v52, v98, v44
    v_fma_f32 v45, -v53, v98, v45
    v_fma_f32 v46, -v54, v98, v46
    v_fma_f32 v47, -v55, v98, v47
    v_fma_f32 v48, -v56, v98, v48
    v_fma_f32 v49, -v57, v98, v49
    v_fma_f32 v50, -v58, v98, v50
    v_fma_f32 v51, -v59, v98, v51
    v_fma_f32 v44, v44, v99, v52
    v_fma_f32 v45, v45, v99, v53
    v_fma_f32 v46, v46, v99, v54
    v_fma_f32 v47, v47, v99, v55
    v_fma_f32 v48, v48, v99, v56
    v_fma_f32 v49, v49, v99, v57
    v_fma_f32 v50, v50, v99, v58
    v_fma_f32 v51, v51, v99, v59
    v_cvt_pk_bf16_f32 v16, v44, v45
    v_lshlrev_b32 v44, 16, v16
    v_and_b32 v45, 0xffff0000, v16
    v_cvt_pk_bf16_f32 v16, v46, v47
    v_lshlrev_b32 v46, 16, v16
    v_and_b32 v47, 0xffff0000, v16
    v_cvt_pk_bf16_f32 v16, v48, v49
    v_lshlrev_b32 v48, 16, v16
    v_and_b32 v49, 0xffff0000, v16
    v_cvt_pk_bf16_f32 v16, v50, v51
    v_lshlrev_b32 v50, 16, v16
    v_and_b32 v51, 0xffff0000, v16
    v_lshlrev_b32 v52, 16, v196
    v_and_b32 v53, 0xffff0000, v196
    v_lshlrev_b32 v54, 16, v197
    v_and_b32 v55, 0xffff0000, v197
    v_lshlrev_b32 v56, 16, v198
    v_and_b32 v57, 0xffff0000, v198
    v_lshlrev_b32 v58, 16, v199
    v_and_b32 v59, 0xffff0000, v199
    v_pk_mul_f32 v[44:45], v[44:45], v[52:53]
    v_pk_mul_f32 v[46:47], v[46:47], v[54:55]
    v_pk_mul_f32 v[48:49], v[48:49], v[56:57]
    v_pk_mul_f32 v[50:51], v[50:51], v[58:59]
    v_cvt_pk_bf16_f32 v16, v44, v45
    v_lshlrev_b32 v44, 16, v16
    v_and_b32 v45, 0xffff0000, v16
    v_cvt_pk_bf16_f32 v16, v46, v47
    v_lshlrev_b32 v46, 16, v16
    v_and_b32 v47, 0xffff0000, v16
    v_cvt_pk_bf16_f32 v16, v48, v49
    v_lshlrev_b32 v48, 16, v16
    v_and_b32 v49, 0xffff0000, v16
    v_cvt_pk_bf16_f32 v16, v50, v51
    v_lshlrev_b32 v50, 16, v16
    v_and_b32 v51, 0xffff0000, v16
    v_lshlrev_b32 v52, 16, v188
    v_and_b32 v53, 0xffff0000, v188
    v_lshlrev_b32 v54, 16, v189
    v_and_b32 v55, 0xffff0000, v189
    v_lshlrev_b32 v56, 16, v190
    v_and_b32 v57, 0xffff0000, v190
    v_lshlrev_b32 v58, 16, v191
    v_and_b32 v59, 0xffff0000, v191
    v_pk_add_f32 v[44:45], v[44:45], v[52:53]
    v_pk_add_f32 v[46:47], v[46:47], v[54:55]
    v_pk_add_f32 v[48:49], v[48:49], v[56:57]
    v_pk_add_f32 v[50:51], v[50:51], v[58:59]
    v_cvt_pk_bf16_f32 v16, v44, v45
    v_lshlrev_b32 v44, 16, v16
    v_and_b32 v45, 0xffff0000, v16
    v_cvt_pk_bf16_f32 v16, v46, v47
    v_lshlrev_b32 v46, 16, v16
    v_and_b32 v47, 0xffff0000, v16
    v_cvt_pk_bf16_f32 v16, v48, v49
    v_lshlrev_b32 v48, 16, v16
    v_and_b32 v49, 0xffff0000, v16
    v_cvt_pk_bf16_f32 v16, v50, v51
    v_lshlrev_b32 v50, 16, v16
    v_and_b32 v51, 0xffff0000, v16
    v_lshlrev_b32 v52, 16, v204
    v_and_b32 v53, 0xffff0000, v204
    v_lshlrev_b32 v54, 16, v205
    v_and_b32 v55, 0xffff0000, v205
    v_lshlrev_b32 v56, 16, v206
    v_and_b32 v57, 0xffff0000, v206
    v_lshlrev_b32 v58, 16, v207
    v_and_b32 v59, 0xffff0000, v207
    v_pk_mul_f32 v[44:45], v[44:45], v[52:53]
    v_pk_mul_f32 v[46:47], v[46:47], v[54:55]
    v_pk_mul_f32 v[48:49], v[48:49], v[56:57]
    v_pk_mul_f32 v[50:51], v[50:51], v[58:59]
    v_cvt_pk_bf16_f32 v16, v44, v45
    v_lshlrev_b32 v44, 16, v16
    v_and_b32 v45, 0xffff0000, v16
    v_cvt_pk_bf16_f32 v16, v46, v47
    v_lshlrev_b32 v46, 16, v16
    v_and_b32 v47, 0xffff0000, v16
    v_cvt_pk_bf16_f32 v16, v48, v49
    v_lshlrev_b32 v48, 16, v16
    v_and_b32 v49, 0xffff0000, v16
    v_cvt_pk_bf16_f32 v16, v50, v51
    v_lshlrev_b32 v50, 16, v16
    v_and_b32 v51, 0xffff0000, v16
    v_pk_add_f32 v[44:45], v[44:45], v[36:37]
    v_pk_add_f32 v[46:47], v[46:47], v[38:39]
    v_pk_add_f32 v[48:49], v[48:49], v[40:41]
    v_pk_add_f32 v[50:51], v[50:51], v[42:43]
    v_cvt_pk_bf16_f32 v36, v44, v45
    v_cvt_pk_bf16_f32 v37, v46, v47
    v_cvt_pk_bf16_f32 v38, v48, v49
    v_cvt_pk_bf16_f32 v39, v50, v51
    s_barrier
    v_and_b32 v16, 3, v1
    v_lshlrev_b32 v16, 4, v16
    v_add_u32 v16, 65792, v16
    ds_read_b32 v76, v16
    s_waitcnt lgkmcnt(0)
    v_mov_b32 v77, v76
    s_nop 1
    v_max_u32_dpp v77, v77, v77 row_ror:1 row_mask:0xf bank_mask:0xf
    s_nop 1
    v_max_u32_dpp v77, v77, v77 row_ror:2 row_mask:0xf bank_mask:0xf
    v_cmp_eq_u32 vcc, v76, v77
    s_ff1_i32_b64 s16, vcc
    s_lshl_b32 s16, s16, 4
    s_add_u32 s16, s16, 65792
    v_mov_b32 v16, s16
    ds_read_b128 v[24:27], v16
    s_waitcnt lgkmcnt(0)
    v_and_b32 v76, 0x7ff, v24
    v_sub_u32 v76, 2047, v76
    s_nop 0
    v_readfirstlane_b32 s12, v76
    v_rcp_f32 v103, v26
    s_lshr_b32 s18, s12, 4
    s_lshl_b32 s18, s18, 15
    s_and_b32 s19, s12, 15
    s_lshl_b32 s19, s19, 6
    s_add_u32 s18, s18, s19
    s_add_u32 s18, s18, 0x2000000
    s_add_u32 s19, s18, 0x400000
    v_lshrrev_b32 v18, 4, v0
    v_lshlrev_b32 v18, 10, v18
    v_and_b32 v19, 15, v0
    v_lshl_add_u32 v18, v19, 2, v18
    s_lshl_b32 s13, s12, 11
    buffer_load_dword v100, v18, s[8:11], s18 offen sc1
    buffer_load_dword v101, v18, s[8:11], s19 offen sc1
    buffer_load_dword v102, v21, s[76:79], s13 offen
    s_lshl_b32 s16, s14, 11
    s_cmp_lg_u32 s12, s14
    s_cselect_b32 s16, s16, 0x7ffffff0
    buffer_store_dwordx4 v[28:31], v2, s[68:71], s16 offen offset:0 sc1
    buffer_store_dwordx4 v[36:39], v2, s[68:71], s16 offen offset:1024 sc1
    s_lshl_b32 s16, s3, 13
    v_add_u32 v20, s16, v2
    s_waitcnt vmcnt(4)
    v_lshlrev_b32 v76, 16, v100
    v_and_b32 v77, 0xffff0000, v100
    s_waitcnt vmcnt(3)
    v_lshlrev_b32 v78, 16, v101
    v_and_b32 v79, 0xffff0000, v101
    v_pk_add_f32 v[76:77], v[76:77], v[78:79]
    s_waitcnt vmcnt(2)
    v_lshlrev_b32 v78, 16, v102
    v_and_b32 v79, 0xffff0000, v102
    v_pk_add_f32 v[92:93], v[78:79], v[76:77]
    v_cvt_pk_bf16_f32 v76, v92, v93
    v_lshlrev_b32 v92, 16, v76
    v_and_b32 v93, 0xffff0000, v76
    v_cvt_pk_bf16_f32 v100, v92, v93
    v_and_b32 v105, 0xffff0000, v104
    v_lshlrev_b32 v104, 16, v104
    v_and_b32 v107, 0xffff0000, v106
    v_lshlrev_b32 v106, 16, v106
    v_sub_f32 v92, v92, v25
    v_sub_f32 v93, v93, v25
    v_cvt_pk_bf16_f32 v76, v92, v93
    v_lshlrev_b32 v92, 16, v76
    v_and_b32 v93, 0xffff0000, v76
    v_mul_f32 v77, v92, v103
    v_fma_f32 v92, -v77, v26, v92
    v_fma_f32 v92, v92, v103, v77
    v_mul_f32 v77, v93, v103
    v_fma_f32 v93, -v77, v26, v93
    v_fma_f32 v93, v93, v103, v77
    v_cvt_pk_bf16_f32 v76, v92, v93
    v_lshlrev_b32 v92, 16, v76
    v_and_b32 v93, 0xffff0000, v76
    v_mul_f32 v92, v92, v104
    v_mul_f32 v93, v93, v105
    v_cvt_pk_bf16_f32 v76, v92, v93
    v_lshlrev_b32 v92, 16, v76
    v_and_b32 v93, 0xffff0000, v76
    v_add_f32 v92, v92, v106
    v_add_f32 v93, v93, v107
    v_cvt_pk_bf16_f32 v101, v92, v93
    v_add_u32 v16, 66560, v21
    ds_write_b32 v16, v101
    ds_write_b32 v16, v100 offset:2048
    s_waitcnt lgkmcnt(0)
    s_barrier
    ds_read_b128 v[60:63], v20 offset:0
    ds_read_b128 v[64:67], v20 offset:1024
    ds_read_b128 v[68:71], v20 offset:2048
    ds_read_b128 v[72:75], v20 offset:3072
    ds_read_b128 v[108:111], v20 offset:4096
    ds_read_b128 v[112:115], v20 offset:5120
    ds_read_b128 v[116:119], v20 offset:6144
    ds_read_b128 v[120:123], v20 offset:7168
    s_and_b32 s16, s3, 3
    s_lshl_b32 s16, s16, 7
    s_and_b32 s17, s29, 3
    s_lshl_b32 s17, s17, 9
    s_add_u32 s16, s16, s17
    s_add_u32 s16, s16, 66560
    v_lshrrev_b32 v16, 3, v1
    v_lshlrev_b32 v16, 4, v16
    v_add_u32 v16, s16, v16
    ds_read_b128 v[104:107], v16
    s_waitcnt lgkmcnt(0)
    v_lshlrev_b32 v76, 16, v104
    v_and_b32 v77, 0xffff, v104
    v_dot2_f32_bf16 v85, v60, v76, 0
    v_dot2_f32_bf16 v84, v60, v77, 0
    v_dot2_f32_bf16 v87, v61, v76, 0
    v_dot2_f32_bf16 v86, v61, v77, 0
    v_dot2_f32_bf16 v89, v62, v76, 0
    v_dot2_f32_bf16 v88, v62, v77, 0
    v_dot2_f32_bf16 v91, v63, v76, 0
    v_dot2_f32_bf16 v90, v63, v77, 0
    v_and_b32 v78, 0xffff0000, v104
    v_lshrrev_b32 v79, 16, v104
    v_dot2c_f32_bf16 v85, v64, v78
    v_dot2c_f32_bf16 v84, v64, v79
    v_dot2c_f32_bf16 v87, v65, v78
    v_dot2c_f32_bf16 v86, v65, v79
    v_dot2c_f32_bf16 v89, v66, v78
    v_dot2c_f32_bf16 v88, v66, v79
    v_dot2c_f32_bf16 v91, v67, v78
    v_dot2c_f32_bf16 v90, v67, v79
    v_lshlrev_b32 v80, 16, v105
    v_and_b32 v81, 0xffff, v105
    v_dot2c_f32_bf16 v85, v68, v80
    v_dot2c_f32_bf16 v84, v68, v81
    v_dot2c_f32_bf16 v87, v69, v80
    v_dot2c_f32_bf16 v86, v69, v81
    v_dot2c_f32_bf16 v89, v70, v80
    v_dot2c_f32_bf16 v88, v70, v81
    v_dot2c_f32_bf16 v91, v71, v80
    v_dot2c_f32_bf16 v90, v71, v81
    v_and_b32 v82, 0xffff0000, v105
    v_lshrrev_b32 v83, 16, v105
    v_dot2c_f32_bf16 v85, v72, v82
    v_dot2c_f32_bf16 v84, v72, v83
    v_dot2c_f32_bf16 v87, v73, v82
    v_dot2c_f32_bf16 v86, v73, v83
    v_dot2c_f32_bf16 v89, v74, v82
    v_dot2c_f32_bf16 v88, v74, v83
    v_dot2c_f32_bf16 v91, v75, v82
    v_dot2c_f32_bf16 v90, v75, v83
    v_lshlrev_b32 v76, 16, v106
    v_and_b32 v77, 0xffff, v106
    v_dot2c_f32_bf16 v85, v108, v76
    v_dot2c_f32_bf16 v84, v108, v77
    v_dot2c_f32_bf16 v87, v109, v76
    v_dot2c_f32_bf16 v86, v109, v77
    v_dot2c_f32_bf16 v89, v110, v76
    v_dot2c_f32_bf16 v88, v110, v77
    v_dot2c_f32_bf16 v91, v111, v76
    v_dot2c_f32_bf16 v90, v111, v77
    v_and_b32 v78, 0xffff0000, v106
    v_lshrrev_b32 v79, 16, v106
    v_dot2c_f32_bf16 v85, v112, v78
    v_dot2c_f32_bf16 v84, v112, v79
    v_dot2c_f32_bf16 v87, v113, v78
    v_dot2c_f32_bf16 v86, v113, v79
    v_dot2c_f32_bf16 v89, v114, v78
    v_dot2c_f32_bf16 v88, v114, v79
    v_dot2c_f32_bf16 v91, v115, v78
    v_dot2c_f32_bf16 v90, v115, v79
    v_lshlrev_b32 v80, 16, v107
    v_and_b32 v81, 0xffff, v107
    v_dot2c_f32_bf16 v85, v116, v80
    v_dot2c_f32_bf16 v84, v116, v81
    v_dot2c_f32_bf16 v87, v117, v80
    v_dot2c_f32_bf16 v86, v117, v81
    v_dot2c_f32_bf16 v89, v118, v80
    v_dot2c_f32_bf16 v88, v118, v81
    v_dot2c_f32_bf16 v91, v119, v80
    v_dot2c_f32_bf16 v90, v119, v81
    v_and_b32 v82, 0xffff0000, v107
    v_lshrrev_b32 v83, 16, v107
    v_dot2c_f32_bf16 v85, v120, v82
    v_dot2c_f32_bf16 v84, v120, v83
    v_dot2c_f32_bf16 v87, v121, v82
    v_dot2c_f32_bf16 v86, v121, v83
    v_dot2c_f32_bf16 v89, v122, v82
    v_dot2c_f32_bf16 v88, v122, v83
    v_dot2c_f32_bf16 v91, v123, v82
    v_dot2c_f32_bf16 v90, v123, v83
    s_nop 0
    v_permlane32_swap_b32 v84, v88
    v_permlane32_swap_b32 v85, v89
    v_permlane32_swap_b32 v86, v90
    v_permlane32_swap_b32 v87, v91
    v_add_f32 v84, v84, v88
    v_add_f32 v85, v85, v89
    v_add_f32 v86, v86, v90
    v_add_f32 v87, v87, v91
    s_nop 0
    v_permlane16_swap_b32 v84, v86
    v_permlane16_swap_b32 v85, v87
    v_add_f32 v84, v84, v86
    v_add_f32 v85, v85, v87
    s_nop 0
    v_add_f32_dpp v84, v84, v84 row_ror:8 row_mask:0xf bank_mask:0xf
    v_add_f32_dpp v85, v85, v85 row_ror:8 row_mask:0xf bank_mask:0xf
    v_and_b32 v16, 7, v1
    v_lshlrev_b32 v16, 5, v16
    v_lshrrev_b32 v17, 4, v1
    v_lshl_add_u32 v16, v17, 3, v16
    s_lshl_b32 s16, s3, 8
    s_add_u32 s16, s16, 70656
    v_add_u32 v16, s16, v16
    ds_write_b64 v16, v[84:85]
    s_lshr_b32 s16, s3, 2
    s_lshl_b32 s17, s16, 10
    s_add_u32 s17, s17, 70656
    v_lshlrev_b32 v17, 2, v1
    v_add_u32 v16, s17, v17
    s_and_b32 s17, s29, 3
    s_lshl_b32 s17, s17, 1
    s_add_u32 s17, s17, s16
    s_mul_i32 s17, s17, 14336
    s_lshr_b32 s16, s29, 2
    s_lshl_b32 s16, s16, 8
    s_add_u32 s17, s17, s16
    s_add_u32 s17, s17, 0x6e1000
    s_and_b32 s16, s3, 3
    s_cmp_eq_u32 s16, 0
    s_cselect_b32 s17, s17, 0x7ffffff0
    s_cmp_lt_u32 s2, 224
    s_cselect_b32 s17, s17, 0x7ffffff0
    s_waitcnt lgkmcnt(0)
    s_barrier
    ds_read_b32 v84, v16 offset:0
    ds_read_b32 v85, v16 offset:256
    ds_read_b32 v86, v16 offset:512
    ds_read_b32 v87, v16 offset:768
    s_waitcnt lgkmcnt(2)
    v_add_f32 v84, v84, v85
    s_waitcnt lgkmcnt(0)
    v_add_f32 v86, v86, v87
    v_add_f32 v84, v84, v86
    v_or_b32 v84, 1, v84
    buffer_store_dword v84, v17, s[8:11], s17 offen sc1
    v_lshrrev_b32 v16, 4, v1
    v_mul_u32_u24 v16, 28672, v16
    v_and_b32 v17, 15, v1
    v_lshl_add_u32 v16, v17, 2, v16
    s_lshl_b32 s16, s29, 6
    s_add_u32 s16, s16, 0x6e1000
    s_add_u32 s17, s16, 14336
    s_mov_b32 s27, 0
adaLN_cond__sliding_block_cached__moe_arch_mod__prompt_kernel_gu23p:
    buffer_load_dword v84, v16, s[8:11], s16 offen sc1
    buffer_load_dword v85, v16, s[8:11], s17 offen sc1
    s_waitcnt vmcnt(0)
    v_min_u32 v86, v84, v85
    v_cmp_eq_u32 vcc, 0, v86
    s_cmp_lt_u32 s2, 224
    s_cselect_b64 s[62:63], -1, 0
    s_and_b64 vcc, vcc, s[62:63]
    s_add_u32 s27, s27, 1
    s_cmp_ge_u32 s27, 65536
    s_cbranch_scc1 adaLN_cond__sliding_block_cached__moe_arch_mod__prompt_kernel_gu23g
    s_cbranch_vccnz adaLN_cond__sliding_block_cached__moe_arch_mod__prompt_kernel_gu23p
adaLN_cond__sliding_block_cached__moe_arch_mod__prompt_kernel_gu23g:
    v_mov_b32 v86, v84
    s_nop 1
    v_permlane16_swap_b32 v84, v86
    v_add_f32 v84, v84, v86
    v_mov_b32 v87, v85
    s_nop 1
    v_permlane16_swap_b32 v85, v87
    v_add_f32 v85, v85, v87
    v_mov_b32 v86, v84
    s_nop 1
    v_permlane32_swap_b32 v84, v86
    v_add_f32 v84, v84, v86
    v_mov_b32 v87, v85
    s_nop 1
    v_permlane32_swap_b32 v85, v87
    v_add_f32 v85, v85, v87
    v_cvt_pk_bf16_f32 v86, v84, v85
    v_lshlrev_b32 v84, 16, v86
    v_and_b32 v85, 0xffff0000, v86
    v_mul_f32 v86, 0xbfb8aa3b, v84
    v_exp_f32 v86, v86
    s_nop 0
    v_add_f32 v86, 1.0, v86
    v_rcp_f32 v86, v86
    s_nop 0
    v_mul_f32 v84, v84, v86
    v_cvt_pk_bf16_f32 v84, v84, v84
    v_lshlrev_b32 v84, 16, v84
    v_mul_f32 v84, v84, v85
    v_cvt_pk_bf16_f32 v84, v84, v84
    v_lshlrev_b32 v84, 16, v84
    s_sub_u32 s16, s3, 4
    s_lshl_b32 s16, s16, 2
    s_add_u32 s17, s16, 0
    v_readlane_b32 s20, v84, s17
    s_lshr_b32 s4, s20, 16
    s_add_u32 s17, s16, 1
    v_readlane_b32 s21, v84, s17
    s_lshr_b32 s5, s21, 16
    s_add_u32 s17, s16, 2
    v_readlane_b32 s22, v84, s17
    s_lshr_b32 s6, s22, 16
    s_add_u32 s17, s16, 3
    v_readlane_b32 s23, v84, s17
    s_lshr_b32 s7, s23, 16
    v_dot2_f32_bf16 v45, v152, s20, 0
    v_dot2_f32_bf16 v44, v152, s4, 0
    v_dot2_f32_bf16 v47, v153, s20, 0
    v_dot2_f32_bf16 v46, v153, s4, 0
    v_dot2_f32_bf16 v49, v154, s20, 0
    v_dot2_f32_bf16 v48, v154, s4, 0
    v_dot2_f32_bf16 v51, v155, s20, 0
    v_dot2_f32_bf16 v50, v155, s4, 0
    v_dot2_f32_bf16 v53, v156, s20, 0
    v_dot2_f32_bf16 v52, v156, s4, 0
    v_dot2_f32_bf16 v55, v157, s20, 0
    v_dot2_f32_bf16 v54, v157, s4, 0
    v_dot2_f32_bf16 v57, v158, s20, 0
    v_dot2_f32_bf16 v56, v158, s4, 0
    v_dot2_f32_bf16 v59, v159, s20, 0
    v_dot2_f32_bf16 v58, v159, s4, 0
    v_dot2c_f32_bf16 v45, s21, v160
    v_dot2c_f32_bf16 v44, s5, v160
    v_dot2c_f32_bf16 v47, s21, v161
    v_dot2c_f32_bf16 v46, s5, v161
    v_dot2c_f32_bf16 v49, s21, v162
    v_dot2c_f32_bf16 v48, s5, v162
    v_dot2c_f32_bf16 v51, s21, v163
    v_dot2c_f32_bf16 v50, s5, v163
    v_dot2c_f32_bf16 v53, s21, v164
    v_dot2c_f32_bf16 v52, s5, v164
    v_dot2c_f32_bf16 v55, s21, v165
    v_dot2c_f32_bf16 v54, s5, v165
    v_dot2c_f32_bf16 v57, s21, v166
    v_dot2c_f32_bf16 v56, s5, v166
    v_dot2c_f32_bf16 v59, s21, v167
    v_dot2c_f32_bf16 v58, s5, v167
    v_dot2c_f32_bf16 v45, s22, v168
    v_dot2c_f32_bf16 v44, s6, v168
    v_dot2c_f32_bf16 v47, s22, v169
    v_dot2c_f32_bf16 v46, s6, v169
    v_dot2c_f32_bf16 v49, s22, v170
    v_dot2c_f32_bf16 v48, s6, v170
    v_dot2c_f32_bf16 v51, s22, v171
    v_dot2c_f32_bf16 v50, s6, v171
    v_dot2c_f32_bf16 v53, s22, v172
    v_dot2c_f32_bf16 v52, s6, v172
    v_dot2c_f32_bf16 v55, s22, v173
    v_dot2c_f32_bf16 v54, s6, v173
    v_dot2c_f32_bf16 v57, s22, v174
    v_dot2c_f32_bf16 v56, s6, v174
    v_dot2c_f32_bf16 v59, s22, v175
    v_dot2c_f32_bf16 v58, s6, v175
    v_dot2c_f32_bf16 v45, s23, v176
    v_dot2c_f32_bf16 v44, s7, v176
    v_dot2c_f32_bf16 v47, s23, v177
    v_dot2c_f32_bf16 v46, s7, v177
    v_dot2c_f32_bf16 v49, s23, v178
    v_dot2c_f32_bf16 v48, s7, v178
    v_dot2c_f32_bf16 v51, s23, v179
    v_dot2c_f32_bf16 v50, s7, v179
    v_dot2c_f32_bf16 v53, s23, v180
    v_dot2c_f32_bf16 v52, s7, v180
    v_dot2c_f32_bf16 v55, s23, v181
    v_dot2c_f32_bf16 v54, s7, v181
    v_dot2c_f32_bf16 v57, s23, v182
    v_dot2c_f32_bf16 v56, s7, v182
    v_dot2c_f32_bf16 v59, s23, v183
    v_dot2c_f32_bf16 v58, s7, v183
    s_sub_u32 s16, s3, 4
    s_lshl_b32 s16, s16, 12
    s_add_u32 s16, s16, 73728
    v_lshlrev_b32 v16, 5, v1
    v_add_u32 v16, s16, v16
    ds_write_b128 v16, v[44:47] offset:0
    ds_write_b128 v16, v[48:51] offset:16
    ds_write_b128 v16, v[52:55] offset:2048
    ds_write_b128 v16, v[56:59] offset:2064
    s_waitcnt lgkmcnt(0)
    s_barrier
    v_lshlrev_b32 v16, 3, v0
    v_add_u32 v17, 73728, v16
    ds_read_b64 v[84:85], v17 offset:0
    ds_read_b64 v[86:87], v17 offset:4096
    ds_read_b64 v[88:89], v17 offset:8192
    ds_read_b64 v[90:91], v17 offset:12288
    s_waitcnt lgkmcnt(2)
    v_pk_add_f32 v[84:85], v[84:85], v[86:87]
    s_waitcnt lgkmcnt(0)
    v_pk_add_f32 v[88:89], v[88:89], v[90:91]
    v_pk_add_f32 v[84:85], v[84:85], v[88:89]
    v_or_b32 v84, 1, v84
    v_or_b32 v85, 1, v85
    s_lshl_b32 s16, s29, 12
    s_add_u32 s16, s16, 0x600000
    s_cmp_lt_u32 s2, 224
    s_cselect_b32 s16, s16, 0x7ffffff0
    buffer_store_dwordx2 v[84:85], v16, s[8:11], s16 offen sc1
    s_cmp_lt_u32 s2, 224
    s_cbranch_scc1 adaLN_cond__sliding_block_cached__moe_arch_mod__prompt_kernel_end
    s_sub_u32 s16, s2, 224
    s_lshl_b32 s17, s16, 7
    s_add_u32 s17, s17, 0x600000
    v_lshrrev_b32 v16, 3, v0
    v_lshlrev_b32 v16, 12, v16
    v_and_b32 v17, 7, v0
    v_lshl_add_u32 v16, v17, 4, v16
    v_cmp_gt_u32 vcc, 256, v0
    v_bfrev_b32 v17, -2
    s_nop 0
    v_cndmask_b32 v17, v17, v16, vcc
    v_mov_b32 v19, 0
    v_cndmask_b32 v18, 1, v19, vcc
    s_lshl_b32 s18, s16, 6
    v_and_b32 v19, 31, v1
    v_lshlrev_b32 v19, 1, v19
    v_add_u32 v19, s18, v19
    s_mov_b32 s19, 0x541800
    buffer_load_ushort v95, v19, s[8:11], s19 offen sc1
    v_add_u32 v20, 66560, v19
    ds_read_u16 v96, v20
    ds_read_u16 v97, v20 offset:2048
    v_mov_b32 v94, v27
    v_cvt_pk_bf16_f32 v94, v94, v94
    v_lshlrev_b32 v94, 16, v94
    v_mul_f32 v94, 0xbfb8aa3b, v94
    v_exp_f32 v94, v94
    s_nop 0
    v_add_f32 v94, 1.0, v94
    v_rcp_f32 v94, v94
    s_nop 0
    v_cvt_pk_bf16_f32 v94, v94, v94
    v_lshlrev_b32 v94, 16, v94
    s_waitcnt vmcnt(0)
    v_lshlrev_b32 v95, 16, v95
    s_waitcnt lgkmcnt(1)
    v_lshlrev_b32 v96, 16, v96
    s_waitcnt lgkmcnt(0)
    v_lshlrev_b32 v97, 16, v97
    s_mov_b32 s27, 0
adaLN_cond__sliding_block_cached__moe_arch_mod__prompt_kernel_y24p:
    s_add_u32 s19, s17, 0x0
    buffer_load_dwordx4 v[44:47], v16, s[8:11], s19 offen sc1
    s_add_u32 s19, s17, 0x40000
    buffer_load_dwordx4 v[48:51], v16, s[8:11], s19 offen sc1
    s_add_u32 s19, s17, 0x80000
    buffer_load_dwordx4 v[52:55], v16, s[8:11], s19 offen sc1
    s_add_u32 s19, s17, 0xc0000
    buffer_load_dwordx4 v[56:59], v17, s[8:11], s19 offen sc1
    s_waitcnt vmcnt(0)
    v_min3_u32 v98, v56, v57, v58
    v_min_u32 v98, v98, v59
    v_or_b32 v98, v98, v18
    v_min3_u32 v98, v98, v44, v45
    v_min3_u32 v98, v98, v46, v47
    v_min3_u32 v98, v98, v48, v49
    v_min3_u32 v98, v98, v50, v51
    v_min3_u32 v98, v98, v52, v53
    v_min3_u32 v98, v98, v54, v55
    v_cmp_eq_u32 vcc, 0, v98
    s_add_u32 s27, s27, 1
    s_cmp_ge_u32 s27, 65536
    s_cbranch_scc1 adaLN_cond__sliding_block_cached__moe_arch_mod__prompt_kernel_y24g
    s_cbranch_vccnz adaLN_cond__sliding_block_cached__moe_arch_mod__prompt_kernel_y24p
adaLN_cond__sliding_block_cached__moe_arch_mod__prompt_kernel_y24g:
    v_pk_add_f32 v[44:45], v[44:45], v[52:53]
    v_pk_add_f32 v[46:47], v[46:47], v[54:55]
    v_pk_add_f32 v[48:49], v[48:49], v[56:57]
    v_pk_add_f32 v[50:51], v[50:51], v[58:59]
    v_pk_add_f32 v[44:45], v[44:45], v[48:49]
    v_pk_add_f32 v[46:47], v[46:47], v[50:51]
    s_nop 0
    v_add_f32_dpp v44, v44, v44 row_ror:8 row_mask:0xf bank_mask:0xf
    v_add_f32_dpp v45, v45, v45 row_ror:8 row_mask:0xf bank_mask:0xf
    v_add_f32_dpp v46, v46, v46 row_ror:8 row_mask:0xf bank_mask:0xf
    v_add_f32_dpp v47, v47, v47 row_ror:8 row_mask:0xf bank_mask:0xf
    s_nop 0
    v_permlane32_swap_b32 v44, v46
    v_permlane32_swap_b32 v45, v47
    v_add_f32 v44, v44, v46
    v_add_f32 v45, v45, v47
    s_nop 1
    v_permlane16_swap_b32 v44, v45
    v_add_f32 v44, v44, v45
    v_and_b32 v16, 7, v1
    v_lshlrev_b32 v16, 4, v16
    v_lshrrev_b32 v17, 4, v1
    v_lshl_add_u32 v16, v17, 2, v16
    s_lshl_b32 s19, s3, 7
    s_add_u32 s19, s19, 91136
    v_add_u32 v16, s19, v16
    ds_write_b32 v16, v44
    v_and_b32 v16, 31, v1
    v_lshlrev_b32 v16, 2, v16
    v_add_u32 v16, 91136, v16
    s_waitcnt lgkmcnt(0)
    s_barrier
    s_cmp_lg_u32 s3, 0
    s_cbranch_scc1 adaLN_cond__sliding_block_cached__moe_arch_mod__prompt_kernel_end
    ds_read_b32 v44, v16 offset:0
    ds_read_b32 v45, v16 offset:128
    ds_read_b32 v46, v16 offset:256
    ds_read_b32 v47, v16 offset:384
    ds_read_b32 v48, v16 offset:512
    ds_read_b32 v49, v16 offset:640
    ds_read_b32 v50, v16 offset:768
    ds_read_b32 v51, v16 offset:896
    s_waitcnt lgkmcnt(3)
    v_add_f32 v44, v44, v48
    s_waitcnt lgkmcnt(2)
    v_add_f32 v45, v45, v49
    s_waitcnt lgkmcnt(1)
    v_add_f32 v46, v46, v50
    s_waitcnt lgkmcnt(0)
    v_add_f32 v47, v47, v51
    v_add_f32 v44, v44, v46
    v_add_f32 v45, v45, v47
    v_add_f32 v44, v44, v45
    v_cvt_pk_bf16_f32 v44, v44, v44
    v_lshlrev_b32 v44, 16, v44
    v_mul_f32 v44, v44, v94
    v_cvt_pk_bf16_f32 v44, v44, v44
    v_lshlrev_b32 v44, 16, v44
    v_add_f32 v44, v44, v96
    v_cvt_pk_bf16_f32 v44, v44, v44
    v_lshlrev_b32 v44, 16, v44
    v_mul_f32 v44, v44, v95
    v_cvt_pk_bf16_f32 v44, v44, v44
    v_lshlrev_b32 v44, 16, v44
    v_add_f32 v44, v44, v97
    v_cvt_pk_bf16_f32 v44, v44, v44
    s_mov_b64 exec, 0xffffffff
    buffer_store_short v44, v19, s[68:71], s13 offen sc1
adaLN_cond__sliding_block_cached__moe_arch_mod__prompt_kernel_end:
    s_endpgm
adaLN_cond__sliding_block_cached__moe_arch_mod__prompt_kernel_n1r:
    s_mov_b32 s27, 0
adaLN_cond__sliding_block_cached__moe_arch_mod__prompt_kernel_n1p:
    buffer_load_dword v134, v132, s[64:67], 0 offen sc1
    s_waitcnt vmcnt(0)
    v_cmp_eq_u32 vcc, 0, v134
    s_cmp_eq_u32 s3, 0
    s_cselect_b64 s[62:63], -1, 0
    s_and_b64 vcc, vcc, s[62:63]
    s_add_u32 s27, s27, 1
    s_cmp_ge_u32 s27, 65536
    s_cbranch_scc1 adaLN_cond__sliding_block_cached__moe_arch_mod__prompt_kernel_n1g
    s_cbranch_vccnz adaLN_cond__sliding_block_cached__moe_arch_mod__prompt_kernel_n1p
adaLN_cond__sliding_block_cached__moe_arch_mod__prompt_kernel_n1g:
    s_waitcnt vmcnt(0) lgkmcnt(0)
    s_nop 15
    s_nop 3
    s_branch adaLN_cond__sliding_block_cached__moe_arch_mod__prompt_kernel_n1b
adaLN_cond__sliding_block_cached__moe_arch_mod__prompt_kernel_kv4r:
    s_waitcnt vmcnt(0) lgkmcnt(0)
    s_nop 15
    s_nop 3
    s_mov_b32 s27, 0
adaLN_cond__sliding_block_cached__moe_arch_mod__prompt_kernel_kv4p:
    buffer_load_dwordx4 v[12:15], v21, s[8:11], s18 offen sc1
    s_waitcnt vmcnt(0)
    v_xor_b32 v8, s28, v12
    v_xor_b32 v20, s28, v13
    v_or_b32 v8, v8, v20
    v_xor_b32 v20, s28, v14
    v_or_b32 v8, v8, v20
    v_xor_b32 v20, s28, v15
    v_or_b32 v8, v8, v20
    v_cmp_ne_u32 vcc, 0, v8
    s_add_u32 s27, s27, 1
    s_cmp_ge_u32 s27, 65536
    s_cbranch_scc1 adaLN_cond__sliding_block_cached__moe_arch_mod__prompt_kernel_kv4g
    s_cbranch_vccnz adaLN_cond__sliding_block_cached__moe_arch_mod__prompt_kernel_kv4p
adaLN_cond__sliding_block_cached__moe_arch_mod__prompt_kernel_kv4g:
    s_waitcnt vmcnt(0) lgkmcnt(0)
    s_nop 15
    s_nop 3
    s_branch adaLN_cond__sliding_block_cached__moe_arch_mod__prompt_kernel_kv4b
adaLN_cond__sliding_block_cached__moe_arch_mod__prompt_kernel_fixA:
    s_waitcnt vmcnt(0) lgkmcnt(0)
    s_nop 15
    s_nop 3
    s_lshr_b32 s16, s12, 3
    s_lshl_b32 s16, s16, 17
    s_add_u32 s16, s16, 0x400000
    v_add_u32 v8, s16, v2
    v_mov_b32 v16, 0xff7fffff
    v_mov_b32 v17, 0xff7fffff
    s_mov_b32 s16, 0
adaLN_cond__sliding_block_cached__moe_arch_mod__prompt_kernel_fixAm:
    s_add_u32 s17, s16, 0
    buffer_load_dwordx4 v[200:203], v8, s[8:11], s17 offen offset:0
    buffer_load_dwordx4 v[204:207], v8, s[8:11], s17 offen offset:1024
    buffer_load_dwordx4 v[208:211], v8, s[8:11], s17 offen offset:2048
    buffer_load_dwordx4 v[212:215], v8, s[8:11], s17 offen offset:3072
    s_waitcnt vmcnt(3)
    v_mfma_f32_16x16x32_bf16 v[184:187], v[200:203], v[152:155], 0
    v_mfma_f32_16x16x32_bf16 v[188:191], v[200:203], v[168:171], 0
    s_waitcnt vmcnt(2)
    v_mfma_f32_16x16x32_bf16 v[192:195], v[204:207], v[152:155], 0
    v_mfma_f32_16x16x32_bf16 v[196:199], v[204:207], v[168:171], 0
    s_waitcnt vmcnt(1)
    v_mfma_f32_16x16x32_bf16 v[184:187], v[208:211], v[156:159], v[184:187]
    v_mfma_f32_16x16x32_bf16 v[188:191], v[208:211], v[172:175], v[188:191]
    s_waitcnt vmcnt(0)
    v_mfma_f32_16x16x32_bf16 v[192:195], v[212:215], v[156:159], v[192:195]
    v_mfma_f32_16x16x32_bf16 v[196:199], v[212:215], v[172:175], v[196:199]
    s_add_u32 s17, s16, 4096
    buffer_load_dwordx4 v[200:203], v8, s[8:11], s17 offen offset:0
    buffer_load_dwordx4 v[204:207], v8, s[8:11], s17 offen offset:1024
    buffer_load_dwordx4 v[208:211], v8, s[8:11], s17 offen offset:2048
    buffer_load_dwordx4 v[212:215], v8, s[8:11], s17 offen offset:3072
    s_waitcnt vmcnt(3)
    v_mfma_f32_16x16x32_bf16 v[184:187], v[200:203], v[160:163], v[184:187]
    v_mfma_f32_16x16x32_bf16 v[188:191], v[200:203], v[176:179], v[188:191]
    s_waitcnt vmcnt(2)
    v_mfma_f32_16x16x32_bf16 v[192:195], v[204:207], v[160:163], v[192:195]
    v_mfma_f32_16x16x32_bf16 v[196:199], v[204:207], v[176:179], v[196:199]
    s_waitcnt vmcnt(1)
    v_mfma_f32_16x16x32_bf16 v[184:187], v[208:211], v[164:167], v[184:187]
    v_mfma_f32_16x16x32_bf16 v[188:191], v[208:211], v[180:183], v[188:191]
    s_waitcnt vmcnt(0)
    v_mfma_f32_16x16x32_bf16 v[192:195], v[212:215], v[164:167], v[192:195]
    v_mfma_f32_16x16x32_bf16 v[196:199], v[212:215], v[180:183], v[196:199]
    s_nop 3
    v_max3_f32 v16, v16, v184, v185
    v_max3_f32 v16, v16, v186, v187
    v_max3_f32 v17, v17, v188, v189
    v_max3_f32 v17, v17, v190, v191
    v_max3_f32 v16, v16, v192, v193
    v_max3_f32 v16, v16, v194, v195
    v_max3_f32 v17, v17, v196, v197
    v_max3_f32 v17, v17, v198, v199
    s_add_u32 s16, s16, 8192
    s_cmp_lt_u32 s16, 0x20000
    s_cbranch_scc1 adaLN_cond__sliding_block_cached__moe_arch_mod__prompt_kernel_fixAm
    v_mov_b32 v18, v16
    v_mov_b32 v19, v17
    s_nop 0
    v_permlane16_swap_b32 v16, v18
    v_permlane16_swap_b32 v17, v19
    v_max_f32 v16, v16, v18
    v_max_f32 v17, v17, v19
    v_mov_b32 v18, v16
    v_mov_b32 v19, v17
    s_nop 0
    v_permlane32_swap_b32 v16, v18
    v_permlane32_swap_b32 v17, v19
    v_max_f32 v16, v16, v18
    v_max_f32 v17, v17, v19
    v_sub_f32 v216, 0, v16
    v_sub_f32 v217, 0, v16
    v_sub_f32 v218, 0, v16
    v_sub_f32 v219, 0, v16
    v_sub_f32 v220, 0, v17
    v_sub_f32 v221, 0, v17
    v_sub_f32 v222, 0, v17
    v_sub_f32 v223, 0, v17
    s_mov_b32 s17, 0x0
    buffer_load_dwordx4 v[200:203], v8, s[8:11], s17 offen offset:0
    buffer_load_dwordx4 v[204:207], v8, s[8:11], s17 offen offset:1024
    buffer_load_dwordx4 v[208:211], v8, s[8:11], s17 offen offset:2048
    buffer_load_dwordx4 v[212:215], v8, s[8:11], s17 offen offset:3072
    s_waitcnt vmcnt(3)
    v_mfma_f32_16x16x32_bf16 v[184:187], v[200:203], v[152:155], v[216:219]
    v_mfma_f32_16x16x32_bf16 v[188:191], v[200:203], v[168:171], v[220:223]
    s_waitcnt vmcnt(2)
    v_mfma_f32_16x16x32_bf16 v[192:195], v[204:207], v[152:155], v[216:219]
    v_mfma_f32_16x16x32_bf16 v[196:199], v[204:207], v[168:171], v[220:223]
    s_waitcnt vmcnt(1)
    v_mfma_f32_16x16x32_bf16 v[184:187], v[208:211], v[156:159], v[184:187]
    v_mfma_f32_16x16x32_bf16 v[188:191], v[208:211], v[172:175], v[188:191]
    s_waitcnt vmcnt(0)
    v_mfma_f32_16x16x32_bf16 v[192:195], v[212:215], v[156:159], v[192:195]
    v_mfma_f32_16x16x32_bf16 v[196:199], v[212:215], v[172:175], v[196:199]
    s_mov_b32 s17, 0x1000
    buffer_load_dwordx4 v[200:203], v8, s[8:11], s17 offen offset:0
    buffer_load_dwordx4 v[204:207], v8, s[8:11], s17 offen offset:1024
    buffer_load_dwordx4 v[208:211], v8, s[8:11], s17 offen offset:2048
    buffer_load_dwordx4 v[212:215], v8, s[8:11], s17 offen offset:3072
    s_waitcnt vmcnt(3)
    v_mfma_f32_16x16x32_bf16 v[184:187], v[200:203], v[160:163], v[184:187]
    v_mfma_f32_16x16x32_bf16 v[188:191], v[200:203], v[176:179], v[188:191]
    s_waitcnt vmcnt(2)
    v_mfma_f32_16x16x32_bf16 v[192:195], v[204:207], v[160:163], v[192:195]
    v_mfma_f32_16x16x32_bf16 v[196:199], v[204:207], v[176:179], v[196:199]
    s_waitcnt vmcnt(1)
    v_mfma_f32_16x16x32_bf16 v[184:187], v[208:211], v[164:167], v[184:187]
    v_mfma_f32_16x16x32_bf16 v[188:191], v[208:211], v[180:183], v[188:191]
    s_waitcnt vmcnt(0)
    v_mfma_f32_16x16x32_bf16 v[192:195], v[212:215], v[164:167], v[192:195]
    v_mfma_f32_16x16x32_bf16 v[196:199], v[212:215], v[180:183], v[196:199]
    s_nop 3
    v_exp_f32 v184, v184
    v_exp_f32 v185, v185
    s_nop 0
    v_add_f32 v9, v184, v185
    v_cvt_pk_bf16_f32 v24, v184, v185
    v_exp_f32 v186, v186
    v_exp_f32 v187, v187
    v_add_f32 v9, v9, v186
    v_add_f32 v9, v9, v187
    v_cvt_pk_bf16_f32 v25, v186, v187
    v_exp_f32 v188, v188
    v_exp_f32 v189, v189
    s_nop 0
    v_add_f32 v10, v188, v189
    v_cvt_pk_bf16_f32 v28, v188, v189
    v_exp_f32 v190, v190
    v_exp_f32 v191, v191
    v_add_f32 v10, v10, v190
    v_add_f32 v10, v10, v191
    v_cvt_pk_bf16_f32 v29, v190, v191
    v_exp_f32 v192, v192
    v_exp_f32 v193, v193
    v_add_f32 v9, v9, v192
    v_add_f32 v9, v9, v193
    v_cvt_pk_bf16_f32 v26, v192, v193
    v_exp_f32 v194, v194
    v_exp_f32 v195, v195
    v_add_f32 v9, v9, v194
    v_add_f32 v9, v9, v195
    v_cvt_pk_bf16_f32 v27, v194, v195
    v_exp_f32 v196, v196
    v_exp_f32 v197, v197
    v_add_f32 v10, v10, v196
    v_add_f32 v10, v10, v197
    v_cvt_pk_bf16_f32 v30, v196, v197
    v_exp_f32 v198, v198
    v_exp_f32 v199, v199
    v_add_f32 v10, v10, v198
    v_add_f32 v10, v10, v199
    v_cvt_pk_bf16_f32 v31, v198, v199
    s_mov_b32 s17, 0x2000
    buffer_load_dwordx4 v[200:203], v8, s[8:11], s17 offen offset:0
    buffer_load_dwordx4 v[204:207], v8, s[8:11], s17 offen offset:1024
    buffer_load_dwordx4 v[208:211], v8, s[8:11], s17 offen offset:2048
    buffer_load_dwordx4 v[212:215], v8, s[8:11], s17 offen offset:3072
    s_waitcnt vmcnt(3)
    v_mfma_f32_16x16x32_bf16 v[184:187], v[200:203], v[152:155], v[216:219]
    v_mfma_f32_16x16x32_bf16 v[188:191], v[200:203], v[168:171], v[220:223]
    s_waitcnt vmcnt(2)
    v_mfma_f32_16x16x32_bf16 v[192:195], v[204:207], v[152:155], v[216:219]
    v_mfma_f32_16x16x32_bf16 v[196:199], v[204:207], v[168:171], v[220:223]
    s_waitcnt vmcnt(1)
    v_mfma_f32_16x16x32_bf16 v[184:187], v[208:211], v[156:159], v[184:187]
    v_mfma_f32_16x16x32_bf16 v[188:191], v[208:211], v[172:175], v[188:191]
    s_waitcnt vmcnt(0)
    v_mfma_f32_16x16x32_bf16 v[192:195], v[212:215], v[156:159], v[192:195]
    v_mfma_f32_16x16x32_bf16 v[196:199], v[212:215], v[172:175], v[196:199]
    s_mov_b32 s17, 0x3000
    buffer_load_dwordx4 v[200:203], v8, s[8:11], s17 offen offset:0
    buffer_load_dwordx4 v[204:207], v8, s[8:11], s17 offen offset:1024
    buffer_load_dwordx4 v[208:211], v8, s[8:11], s17 offen offset:2048
    buffer_load_dwordx4 v[212:215], v8, s[8:11], s17 offen offset:3072
    s_waitcnt vmcnt(3)
    v_mfma_f32_16x16x32_bf16 v[184:187], v[200:203], v[160:163], v[184:187]
    v_mfma_f32_16x16x32_bf16 v[188:191], v[200:203], v[176:179], v[188:191]
    s_waitcnt vmcnt(2)
    v_mfma_f32_16x16x32_bf16 v[192:195], v[204:207], v[160:163], v[192:195]
    v_mfma_f32_16x16x32_bf16 v[196:199], v[204:207], v[176:179], v[196:199]
    s_waitcnt vmcnt(1)
    v_mfma_f32_16x16x32_bf16 v[184:187], v[208:211], v[164:167], v[184:187]
    v_mfma_f32_16x16x32_bf16 v[188:191], v[208:211], v[180:183], v[188:191]
    s_waitcnt vmcnt(0)
    v_mfma_f32_16x16x32_bf16 v[192:195], v[212:215], v[164:167], v[192:195]
    v_mfma_f32_16x16x32_bf16 v[196:199], v[212:215], v[180:183], v[196:199]
    s_nop 3
    v_exp_f32 v184, v184
    v_exp_f32 v185, v185
    v_add_f32 v9, v9, v184
    v_add_f32 v9, v9, v185
    v_cvt_pk_bf16_f32 v32, v184, v185
    v_exp_f32 v186, v186
    v_exp_f32 v187, v187
    v_add_f32 v9, v9, v186
    v_add_f32 v9, v9, v187
    v_cvt_pk_bf16_f32 v33, v186, v187
    v_exp_f32 v188, v188
    v_exp_f32 v189, v189
    v_add_f32 v10, v10, v188
    v_add_f32 v10, v10, v189
    v_cvt_pk_bf16_f32 v36, v188, v189
    v_exp_f32 v190, v190
    v_exp_f32 v191, v191
    v_add_f32 v10, v10, v190
    v_add_f32 v10, v10, v191
    v_cvt_pk_bf16_f32 v37, v190, v191
    v_exp_f32 v192, v192
    v_exp_f32 v193, v193
    v_add_f32 v9, v9, v192
    v_add_f32 v9, v9, v193
    v_cvt_pk_bf16_f32 v34, v192, v193
    v_exp_f32 v194, v194
    v_exp_f32 v195, v195
    v_add_f32 v9, v9, v194
    v_add_f32 v9, v9, v195
    v_cvt_pk_bf16_f32 v35, v194, v195
    v_exp_f32 v196, v196
    v_exp_f32 v197, v197
    v_add_f32 v10, v10, v196
    v_add_f32 v10, v10, v197
    v_cvt_pk_bf16_f32 v38, v196, v197
    v_exp_f32 v198, v198
    v_exp_f32 v199, v199
    v_add_f32 v10, v10, v198
    v_add_f32 v10, v10, v199
    v_cvt_pk_bf16_f32 v39, v198, v199
    s_mov_b32 s17, 0x4000
    buffer_load_dwordx4 v[200:203], v8, s[8:11], s17 offen offset:0
    buffer_load_dwordx4 v[204:207], v8, s[8:11], s17 offen offset:1024
    buffer_load_dwordx4 v[208:211], v8, s[8:11], s17 offen offset:2048
    buffer_load_dwordx4 v[212:215], v8, s[8:11], s17 offen offset:3072
    s_waitcnt vmcnt(3)
    v_mfma_f32_16x16x32_bf16 v[184:187], v[200:203], v[152:155], v[216:219]
    v_mfma_f32_16x16x32_bf16 v[188:191], v[200:203], v[168:171], v[220:223]
    s_waitcnt vmcnt(2)
    v_mfma_f32_16x16x32_bf16 v[192:195], v[204:207], v[152:155], v[216:219]
    v_mfma_f32_16x16x32_bf16 v[196:199], v[204:207], v[168:171], v[220:223]
    s_waitcnt vmcnt(1)
    v_mfma_f32_16x16x32_bf16 v[184:187], v[208:211], v[156:159], v[184:187]
    v_mfma_f32_16x16x32_bf16 v[188:191], v[208:211], v[172:175], v[188:191]
    s_waitcnt vmcnt(0)
    v_mfma_f32_16x16x32_bf16 v[192:195], v[212:215], v[156:159], v[192:195]
    v_mfma_f32_16x16x32_bf16 v[196:199], v[212:215], v[172:175], v[196:199]
    s_mov_b32 s17, 0x5000
    buffer_load_dwordx4 v[200:203], v8, s[8:11], s17 offen offset:0
    buffer_load_dwordx4 v[204:207], v8, s[8:11], s17 offen offset:1024
    buffer_load_dwordx4 v[208:211], v8, s[8:11], s17 offen offset:2048
    buffer_load_dwordx4 v[212:215], v8, s[8:11], s17 offen offset:3072
    s_waitcnt vmcnt(3)
    v_mfma_f32_16x16x32_bf16 v[184:187], v[200:203], v[160:163], v[184:187]
    v_mfma_f32_16x16x32_bf16 v[188:191], v[200:203], v[176:179], v[188:191]
    s_waitcnt vmcnt(2)
    v_mfma_f32_16x16x32_bf16 v[192:195], v[204:207], v[160:163], v[192:195]
    v_mfma_f32_16x16x32_bf16 v[196:199], v[204:207], v[176:179], v[196:199]
    s_waitcnt vmcnt(1)
    v_mfma_f32_16x16x32_bf16 v[184:187], v[208:211], v[164:167], v[184:187]
    v_mfma_f32_16x16x32_bf16 v[188:191], v[208:211], v[180:183], v[188:191]
    s_waitcnt vmcnt(0)
    v_mfma_f32_16x16x32_bf16 v[192:195], v[212:215], v[164:167], v[192:195]
    v_mfma_f32_16x16x32_bf16 v[196:199], v[212:215], v[180:183], v[196:199]
    s_nop 3
    v_exp_f32 v184, v184
    v_exp_f32 v185, v185
    v_add_f32 v9, v9, v184
    v_add_f32 v9, v9, v185
    v_cvt_pk_bf16_f32 v40, v184, v185
    v_exp_f32 v186, v186
    v_exp_f32 v187, v187
    v_add_f32 v9, v9, v186
    v_add_f32 v9, v9, v187
    v_cvt_pk_bf16_f32 v41, v186, v187
    v_exp_f32 v188, v188
    v_exp_f32 v189, v189
    v_add_f32 v10, v10, v188
    v_add_f32 v10, v10, v189
    v_cvt_pk_bf16_f32 v44, v188, v189
    v_exp_f32 v190, v190
    v_exp_f32 v191, v191
    v_add_f32 v10, v10, v190
    v_add_f32 v10, v10, v191
    v_cvt_pk_bf16_f32 v45, v190, v191
    v_exp_f32 v192, v192
    v_exp_f32 v193, v193
    v_add_f32 v9, v9, v192
    v_add_f32 v9, v9, v193
    v_cvt_pk_bf16_f32 v42, v192, v193
    v_exp_f32 v194, v194
    v_exp_f32 v195, v195
    v_add_f32 v9, v9, v194
    v_add_f32 v9, v9, v195
    v_cvt_pk_bf16_f32 v43, v194, v195
    v_exp_f32 v196, v196
    v_exp_f32 v197, v197
    v_add_f32 v10, v10, v196
    v_add_f32 v10, v10, v197
    v_cvt_pk_bf16_f32 v46, v196, v197
    v_exp_f32 v198, v198
    v_exp_f32 v199, v199
    v_add_f32 v10, v10, v198
    v_add_f32 v10, v10, v199
    v_cvt_pk_bf16_f32 v47, v198, v199
    s_mov_b32 s17, 0x6000
    buffer_load_dwordx4 v[200:203], v8, s[8:11], s17 offen offset:0
    buffer_load_dwordx4 v[204:207], v8, s[8:11], s17 offen offset:1024
    buffer_load_dwordx4 v[208:211], v8, s[8:11], s17 offen offset:2048
    buffer_load_dwordx4 v[212:215], v8, s[8:11], s17 offen offset:3072
    s_waitcnt vmcnt(3)
    v_mfma_f32_16x16x32_bf16 v[184:187], v[200:203], v[152:155], v[216:219]
    v_mfma_f32_16x16x32_bf16 v[188:191], v[200:203], v[168:171], v[220:223]
    s_waitcnt vmcnt(2)
    v_mfma_f32_16x16x32_bf16 v[192:195], v[204:207], v[152:155], v[216:219]
    v_mfma_f32_16x16x32_bf16 v[196:199], v[204:207], v[168:171], v[220:223]
    s_waitcnt vmcnt(1)
    v_mfma_f32_16x16x32_bf16 v[184:187], v[208:211], v[156:159], v[184:187]
    v_mfma_f32_16x16x32_bf16 v[188:191], v[208:211], v[172:175], v[188:191]
    s_waitcnt vmcnt(0)
    v_mfma_f32_16x16x32_bf16 v[192:195], v[212:215], v[156:159], v[192:195]
    v_mfma_f32_16x16x32_bf16 v[196:199], v[212:215], v[172:175], v[196:199]
    s_mov_b32 s17, 0x7000
    buffer_load_dwordx4 v[200:203], v8, s[8:11], s17 offen offset:0
    buffer_load_dwordx4 v[204:207], v8, s[8:11], s17 offen offset:1024
    buffer_load_dwordx4 v[208:211], v8, s[8:11], s17 offen offset:2048
    buffer_load_dwordx4 v[212:215], v8, s[8:11], s17 offen offset:3072
    s_waitcnt vmcnt(3)
    v_mfma_f32_16x16x32_bf16 v[184:187], v[200:203], v[160:163], v[184:187]
    v_mfma_f32_16x16x32_bf16 v[188:191], v[200:203], v[176:179], v[188:191]
    s_waitcnt vmcnt(2)
    v_mfma_f32_16x16x32_bf16 v[192:195], v[204:207], v[160:163], v[192:195]
    v_mfma_f32_16x16x32_bf16 v[196:199], v[204:207], v[176:179], v[196:199]
    s_waitcnt vmcnt(1)
    v_mfma_f32_16x16x32_bf16 v[184:187], v[208:211], v[164:167], v[184:187]
    v_mfma_f32_16x16x32_bf16 v[188:191], v[208:211], v[180:183], v[188:191]
    s_waitcnt vmcnt(0)
    v_mfma_f32_16x16x32_bf16 v[192:195], v[212:215], v[164:167], v[192:195]
    v_mfma_f32_16x16x32_bf16 v[196:199], v[212:215], v[180:183], v[196:199]
    s_nop 3
    v_exp_f32 v184, v184
    v_exp_f32 v185, v185
    v_add_f32 v9, v9, v184
    v_add_f32 v9, v9, v185
    v_cvt_pk_bf16_f32 v48, v184, v185
    v_exp_f32 v186, v186
    v_exp_f32 v187, v187
    v_add_f32 v9, v9, v186
    v_add_f32 v9, v9, v187
    v_cvt_pk_bf16_f32 v49, v186, v187
    v_exp_f32 v188, v188
    v_exp_f32 v189, v189
    v_add_f32 v10, v10, v188
    v_add_f32 v10, v10, v189
    v_cvt_pk_bf16_f32 v52, v188, v189
    v_exp_f32 v190, v190
    v_exp_f32 v191, v191
    v_add_f32 v10, v10, v190
    v_add_f32 v10, v10, v191
    v_cvt_pk_bf16_f32 v53, v190, v191
    v_exp_f32 v192, v192
    v_exp_f32 v193, v193
    v_add_f32 v9, v9, v192
    v_add_f32 v9, v9, v193
    v_cvt_pk_bf16_f32 v50, v192, v193
    v_exp_f32 v194, v194
    v_exp_f32 v195, v195
    v_add_f32 v9, v9, v194
    v_add_f32 v9, v9, v195
    v_cvt_pk_bf16_f32 v51, v194, v195
    v_exp_f32 v196, v196
    v_exp_f32 v197, v197
    v_add_f32 v10, v10, v196
    v_add_f32 v10, v10, v197
    v_cvt_pk_bf16_f32 v54, v196, v197
    v_exp_f32 v198, v198
    v_exp_f32 v199, v199
    v_add_f32 v10, v10, v198
    v_add_f32 v10, v10, v199
    v_cvt_pk_bf16_f32 v55, v198, v199
    s_mov_b32 s17, 0x8000
    buffer_load_dwordx4 v[200:203], v8, s[8:11], s17 offen offset:0
    buffer_load_dwordx4 v[204:207], v8, s[8:11], s17 offen offset:1024
    buffer_load_dwordx4 v[208:211], v8, s[8:11], s17 offen offset:2048
    buffer_load_dwordx4 v[212:215], v8, s[8:11], s17 offen offset:3072
    s_waitcnt vmcnt(3)
    v_mfma_f32_16x16x32_bf16 v[184:187], v[200:203], v[152:155], v[216:219]
    v_mfma_f32_16x16x32_bf16 v[188:191], v[200:203], v[168:171], v[220:223]
    s_waitcnt vmcnt(2)
    v_mfma_f32_16x16x32_bf16 v[192:195], v[204:207], v[152:155], v[216:219]
    v_mfma_f32_16x16x32_bf16 v[196:199], v[204:207], v[168:171], v[220:223]
    s_waitcnt vmcnt(1)
    v_mfma_f32_16x16x32_bf16 v[184:187], v[208:211], v[156:159], v[184:187]
    v_mfma_f32_16x16x32_bf16 v[188:191], v[208:211], v[172:175], v[188:191]
    s_waitcnt vmcnt(0)
    v_mfma_f32_16x16x32_bf16 v[192:195], v[212:215], v[156:159], v[192:195]
    v_mfma_f32_16x16x32_bf16 v[196:199], v[212:215], v[172:175], v[196:199]
    s_mov_b32 s17, 0x9000
    buffer_load_dwordx4 v[200:203], v8, s[8:11], s17 offen offset:0
    buffer_load_dwordx4 v[204:207], v8, s[8:11], s17 offen offset:1024
    buffer_load_dwordx4 v[208:211], v8, s[8:11], s17 offen offset:2048
    buffer_load_dwordx4 v[212:215], v8, s[8:11], s17 offen offset:3072
    s_waitcnt vmcnt(3)
    v_mfma_f32_16x16x32_bf16 v[184:187], v[200:203], v[160:163], v[184:187]
    v_mfma_f32_16x16x32_bf16 v[188:191], v[200:203], v[176:179], v[188:191]
    s_waitcnt vmcnt(2)
    v_mfma_f32_16x16x32_bf16 v[192:195], v[204:207], v[160:163], v[192:195]
    v_mfma_f32_16x16x32_bf16 v[196:199], v[204:207], v[176:179], v[196:199]
    s_waitcnt vmcnt(1)
    v_mfma_f32_16x16x32_bf16 v[184:187], v[208:211], v[164:167], v[184:187]
    v_mfma_f32_16x16x32_bf16 v[188:191], v[208:211], v[180:183], v[188:191]
    s_waitcnt vmcnt(0)
    v_mfma_f32_16x16x32_bf16 v[192:195], v[212:215], v[164:167], v[192:195]
    v_mfma_f32_16x16x32_bf16 v[196:199], v[212:215], v[180:183], v[196:199]
    s_nop 3
    v_exp_f32 v184, v184
    v_exp_f32 v185, v185
    v_add_f32 v9, v9, v184
    v_add_f32 v9, v9, v185
    v_cvt_pk_bf16_f32 v56, v184, v185
    v_exp_f32 v186, v186
    v_exp_f32 v187, v187
    v_add_f32 v9, v9, v186
    v_add_f32 v9, v9, v187
    v_cvt_pk_bf16_f32 v57, v186, v187
    v_exp_f32 v188, v188
    v_exp_f32 v189, v189
    v_add_f32 v10, v10, v188
    v_add_f32 v10, v10, v189
    v_cvt_pk_bf16_f32 v60, v188, v189
    v_exp_f32 v190, v190
    v_exp_f32 v191, v191
    v_add_f32 v10, v10, v190
    v_add_f32 v10, v10, v191
    v_cvt_pk_bf16_f32 v61, v190, v191
    v_exp_f32 v192, v192
    v_exp_f32 v193, v193
    v_add_f32 v9, v9, v192
    v_add_f32 v9, v9, v193
    v_cvt_pk_bf16_f32 v58, v192, v193
    v_exp_f32 v194, v194
    v_exp_f32 v195, v195
    v_add_f32 v9, v9, v194
    v_add_f32 v9, v9, v195
    v_cvt_pk_bf16_f32 v59, v194, v195
    v_exp_f32 v196, v196
    v_exp_f32 v197, v197
    v_add_f32 v10, v10, v196
    v_add_f32 v10, v10, v197
    v_cvt_pk_bf16_f32 v62, v196, v197
    v_exp_f32 v198, v198
    v_exp_f32 v199, v199
    v_add_f32 v10, v10, v198
    v_add_f32 v10, v10, v199
    v_cvt_pk_bf16_f32 v63, v198, v199
    s_mov_b32 s17, 0xa000
    buffer_load_dwordx4 v[200:203], v8, s[8:11], s17 offen offset:0
    buffer_load_dwordx4 v[204:207], v8, s[8:11], s17 offen offset:1024
    buffer_load_dwordx4 v[208:211], v8, s[8:11], s17 offen offset:2048
    buffer_load_dwordx4 v[212:215], v8, s[8:11], s17 offen offset:3072
    s_waitcnt vmcnt(3)
    v_mfma_f32_16x16x32_bf16 v[184:187], v[200:203], v[152:155], v[216:219]
    v_mfma_f32_16x16x32_bf16 v[188:191], v[200:203], v[168:171], v[220:223]
    s_waitcnt vmcnt(2)
    v_mfma_f32_16x16x32_bf16 v[192:195], v[204:207], v[152:155], v[216:219]
    v_mfma_f32_16x16x32_bf16 v[196:199], v[204:207], v[168:171], v[220:223]
    s_waitcnt vmcnt(1)
    v_mfma_f32_16x16x32_bf16 v[184:187], v[208:211], v[156:159], v[184:187]
    v_mfma_f32_16x16x32_bf16 v[188:191], v[208:211], v[172:175], v[188:191]
    s_waitcnt vmcnt(0)
    v_mfma_f32_16x16x32_bf16 v[192:195], v[212:215], v[156:159], v[192:195]
    v_mfma_f32_16x16x32_bf16 v[196:199], v[212:215], v[172:175], v[196:199]
    s_mov_b32 s17, 0xb000
    buffer_load_dwordx4 v[200:203], v8, s[8:11], s17 offen offset:0
    buffer_load_dwordx4 v[204:207], v8, s[8:11], s17 offen offset:1024
    buffer_load_dwordx4 v[208:211], v8, s[8:11], s17 offen offset:2048
    buffer_load_dwordx4 v[212:215], v8, s[8:11], s17 offen offset:3072
    s_waitcnt vmcnt(3)
    v_mfma_f32_16x16x32_bf16 v[184:187], v[200:203], v[160:163], v[184:187]
    v_mfma_f32_16x16x32_bf16 v[188:191], v[200:203], v[176:179], v[188:191]
    s_waitcnt vmcnt(2)
    v_mfma_f32_16x16x32_bf16 v[192:195], v[204:207], v[160:163], v[192:195]
    v_mfma_f32_16x16x32_bf16 v[196:199], v[204:207], v[176:179], v[196:199]
    s_waitcnt vmcnt(1)
    v_mfma_f32_16x16x32_bf16 v[184:187], v[208:211], v[164:167], v[184:187]
    v_mfma_f32_16x16x32_bf16 v[188:191], v[208:211], v[180:183], v[188:191]
    s_waitcnt vmcnt(0)
    v_mfma_f32_16x16x32_bf16 v[192:195], v[212:215], v[164:167], v[192:195]
    v_mfma_f32_16x16x32_bf16 v[196:199], v[212:215], v[180:183], v[196:199]
    s_nop 3
    v_exp_f32 v184, v184
    v_exp_f32 v185, v185
    v_add_f32 v9, v9, v184
    v_add_f32 v9, v9, v185
    v_cvt_pk_bf16_f32 v64, v184, v185
    v_exp_f32 v186, v186
    v_exp_f32 v187, v187
    v_add_f32 v9, v9, v186
    v_add_f32 v9, v9, v187
    v_cvt_pk_bf16_f32 v65, v186, v187
    v_exp_f32 v188, v188
    v_exp_f32 v189, v189
    v_add_f32 v10, v10, v188
    v_add_f32 v10, v10, v189
    v_cvt_pk_bf16_f32 v68, v188, v189
    v_exp_f32 v190, v190
    v_exp_f32 v191, v191
    v_add_f32 v10, v10, v190
    v_add_f32 v10, v10, v191
    v_cvt_pk_bf16_f32 v69, v190, v191
    v_exp_f32 v192, v192
    v_exp_f32 v193, v193
    v_add_f32 v9, v9, v192
    v_add_f32 v9, v9, v193
    v_cvt_pk_bf16_f32 v66, v192, v193
    v_exp_f32 v194, v194
    v_exp_f32 v195, v195
    v_add_f32 v9, v9, v194
    v_add_f32 v9, v9, v195
    v_cvt_pk_bf16_f32 v67, v194, v195
    v_exp_f32 v196, v196
    v_exp_f32 v197, v197
    v_add_f32 v10, v10, v196
    v_add_f32 v10, v10, v197
    v_cvt_pk_bf16_f32 v70, v196, v197
    v_exp_f32 v198, v198
    v_exp_f32 v199, v199
    v_add_f32 v10, v10, v198
    v_add_f32 v10, v10, v199
    v_cvt_pk_bf16_f32 v71, v198, v199
    s_mov_b32 s17, 0xc000
    buffer_load_dwordx4 v[200:203], v8, s[8:11], s17 offen offset:0
    buffer_load_dwordx4 v[204:207], v8, s[8:11], s17 offen offset:1024
    buffer_load_dwordx4 v[208:211], v8, s[8:11], s17 offen offset:2048
    buffer_load_dwordx4 v[212:215], v8, s[8:11], s17 offen offset:3072
    s_waitcnt vmcnt(3)
    v_mfma_f32_16x16x32_bf16 v[184:187], v[200:203], v[152:155], v[216:219]
    v_mfma_f32_16x16x32_bf16 v[188:191], v[200:203], v[168:171], v[220:223]
    s_waitcnt vmcnt(2)
    v_mfma_f32_16x16x32_bf16 v[192:195], v[204:207], v[152:155], v[216:219]
    v_mfma_f32_16x16x32_bf16 v[196:199], v[204:207], v[168:171], v[220:223]
    s_waitcnt vmcnt(1)
    v_mfma_f32_16x16x32_bf16 v[184:187], v[208:211], v[156:159], v[184:187]
    v_mfma_f32_16x16x32_bf16 v[188:191], v[208:211], v[172:175], v[188:191]
    s_waitcnt vmcnt(0)
    v_mfma_f32_16x16x32_bf16 v[192:195], v[212:215], v[156:159], v[192:195]
    v_mfma_f32_16x16x32_bf16 v[196:199], v[212:215], v[172:175], v[196:199]
    s_mov_b32 s17, 0xd000
    buffer_load_dwordx4 v[200:203], v8, s[8:11], s17 offen offset:0
    buffer_load_dwordx4 v[204:207], v8, s[8:11], s17 offen offset:1024
    buffer_load_dwordx4 v[208:211], v8, s[8:11], s17 offen offset:2048
    buffer_load_dwordx4 v[212:215], v8, s[8:11], s17 offen offset:3072
    s_waitcnt vmcnt(3)
    v_mfma_f32_16x16x32_bf16 v[184:187], v[200:203], v[160:163], v[184:187]
    v_mfma_f32_16x16x32_bf16 v[188:191], v[200:203], v[176:179], v[188:191]
    s_waitcnt vmcnt(2)
    v_mfma_f32_16x16x32_bf16 v[192:195], v[204:207], v[160:163], v[192:195]
    v_mfma_f32_16x16x32_bf16 v[196:199], v[204:207], v[176:179], v[196:199]
    s_waitcnt vmcnt(1)
    v_mfma_f32_16x16x32_bf16 v[184:187], v[208:211], v[164:167], v[184:187]
    v_mfma_f32_16x16x32_bf16 v[188:191], v[208:211], v[180:183], v[188:191]
    s_waitcnt vmcnt(0)
    v_mfma_f32_16x16x32_bf16 v[192:195], v[212:215], v[164:167], v[192:195]
    v_mfma_f32_16x16x32_bf16 v[196:199], v[212:215], v[180:183], v[196:199]
    s_nop 3
    v_exp_f32 v184, v184
    v_exp_f32 v185, v185
    v_add_f32 v9, v9, v184
    v_add_f32 v9, v9, v185
    v_cvt_pk_bf16_f32 v72, v184, v185
    v_exp_f32 v186, v186
    v_exp_f32 v187, v187
    v_add_f32 v9, v9, v186
    v_add_f32 v9, v9, v187
    v_cvt_pk_bf16_f32 v73, v186, v187
    v_exp_f32 v188, v188
    v_exp_f32 v189, v189
    v_add_f32 v10, v10, v188
    v_add_f32 v10, v10, v189
    v_cvt_pk_bf16_f32 v76, v188, v189
    v_exp_f32 v190, v190
    v_exp_f32 v191, v191
    v_add_f32 v10, v10, v190
    v_add_f32 v10, v10, v191
    v_cvt_pk_bf16_f32 v77, v190, v191
    v_exp_f32 v192, v192
    v_exp_f32 v193, v193
    v_add_f32 v9, v9, v192
    v_add_f32 v9, v9, v193
    v_cvt_pk_bf16_f32 v74, v192, v193
    v_exp_f32 v194, v194
    v_exp_f32 v195, v195
    v_add_f32 v9, v9, v194
    v_add_f32 v9, v9, v195
    v_cvt_pk_bf16_f32 v75, v194, v195
    v_exp_f32 v196, v196
    v_exp_f32 v197, v197
    v_add_f32 v10, v10, v196
    v_add_f32 v10, v10, v197
    v_cvt_pk_bf16_f32 v78, v196, v197
    v_exp_f32 v198, v198
    v_exp_f32 v199, v199
    v_add_f32 v10, v10, v198
    v_add_f32 v10, v10, v199
    v_cvt_pk_bf16_f32 v79, v198, v199
    s_mov_b32 s17, 0xe000
    buffer_load_dwordx4 v[200:203], v8, s[8:11], s17 offen offset:0
    buffer_load_dwordx4 v[204:207], v8, s[8:11], s17 offen offset:1024
    buffer_load_dwordx4 v[208:211], v8, s[8:11], s17 offen offset:2048
    buffer_load_dwordx4 v[212:215], v8, s[8:11], s17 offen offset:3072
    s_waitcnt vmcnt(3)
    v_mfma_f32_16x16x32_bf16 v[184:187], v[200:203], v[152:155], v[216:219]
    v_mfma_f32_16x16x32_bf16 v[188:191], v[200:203], v[168:171], v[220:223]
    s_waitcnt vmcnt(2)
    v_mfma_f32_16x16x32_bf16 v[192:195], v[204:207], v[152:155], v[216:219]
    v_mfma_f32_16x16x32_bf16 v[196:199], v[204:207], v[168:171], v[220:223]
    s_waitcnt vmcnt(1)
    v_mfma_f32_16x16x32_bf16 v[184:187], v[208:211], v[156:159], v[184:187]
    v_mfma_f32_16x16x32_bf16 v[188:191], v[208:211], v[172:175], v[188:191]
    s_waitcnt vmcnt(0)
    v_mfma_f32_16x16x32_bf16 v[192:195], v[212:215], v[156:159], v[192:195]
    v_mfma_f32_16x16x32_bf16 v[196:199], v[212:215], v[172:175], v[196:199]
    s_mov_b32 s17, 0xf000
    buffer_load_dwordx4 v[200:203], v8, s[8:11], s17 offen offset:0
    buffer_load_dwordx4 v[204:207], v8, s[8:11], s17 offen offset:1024
    buffer_load_dwordx4 v[208:211], v8, s[8:11], s17 offen offset:2048
    buffer_load_dwordx4 v[212:215], v8, s[8:11], s17 offen offset:3072
    s_waitcnt vmcnt(3)
    v_mfma_f32_16x16x32_bf16 v[184:187], v[200:203], v[160:163], v[184:187]
    v_mfma_f32_16x16x32_bf16 v[188:191], v[200:203], v[176:179], v[188:191]
    s_waitcnt vmcnt(2)
    v_mfma_f32_16x16x32_bf16 v[192:195], v[204:207], v[160:163], v[192:195]
    v_mfma_f32_16x16x32_bf16 v[196:199], v[204:207], v[176:179], v[196:199]
    s_waitcnt vmcnt(1)
    v_mfma_f32_16x16x32_bf16 v[184:187], v[208:211], v[164:167], v[184:187]
    v_mfma_f32_16x16x32_bf16 v[188:191], v[208:211], v[180:183], v[188:191]
    s_waitcnt vmcnt(0)
    v_mfma_f32_16x16x32_bf16 v[192:195], v[212:215], v[164:167], v[192:195]
    v_mfma_f32_16x16x32_bf16 v[196:199], v[212:215], v[180:183], v[196:199]
    s_nop 3
    v_exp_f32 v184, v184
    v_exp_f32 v185, v185
    v_add_f32 v9, v9, v184
    v_add_f32 v9, v9, v185
    v_cvt_pk_bf16_f32 v80, v184, v185
    v_exp_f32 v186, v186
    v_exp_f32 v187, v187
    v_add_f32 v9, v9, v186
    v_add_f32 v9, v9, v187
    v_cvt_pk_bf16_f32 v81, v186, v187
    v_exp_f32 v188, v188
    v_exp_f32 v189, v189
    v_add_f32 v10, v10, v188
    v_add_f32 v10, v10, v189
    v_cvt_pk_bf16_f32 v84, v188, v189
    v_exp_f32 v190, v190
    v_exp_f32 v191, v191
    v_add_f32 v10, v10, v190
    v_add_f32 v10, v10, v191
    v_cvt_pk_bf16_f32 v85, v190, v191
    v_exp_f32 v192, v192
    v_exp_f32 v193, v193
    v_add_f32 v9, v9, v192
    v_add_f32 v9, v9, v193
    v_cvt_pk_bf16_f32 v82, v192, v193
    v_exp_f32 v194, v194
    v_exp_f32 v195, v195
    v_add_f32 v9, v9, v194
    v_add_f32 v9, v9, v195
    v_cvt_pk_bf16_f32 v83, v194, v195
    v_exp_f32 v196, v196
    v_exp_f32 v197, v197
    v_add_f32 v10, v10, v196
    v_add_f32 v10, v10, v197
    v_cvt_pk_bf16_f32 v86, v196, v197
    v_exp_f32 v198, v198
    v_exp_f32 v199, v199
    v_add_f32 v10, v10, v198
    v_add_f32 v10, v10, v199
    v_cvt_pk_bf16_f32 v87, v198, v199
    s_mov_b32 s17, 0x10000
    buffer_load_dwordx4 v[200:203], v8, s[8:11], s17 offen offset:0
    buffer_load_dwordx4 v[204:207], v8, s[8:11], s17 offen offset:1024
    buffer_load_dwordx4 v[208:211], v8, s[8:11], s17 offen offset:2048
    buffer_load_dwordx4 v[212:215], v8, s[8:11], s17 offen offset:3072
    s_waitcnt vmcnt(3)
    v_mfma_f32_16x16x32_bf16 v[184:187], v[200:203], v[152:155], v[216:219]
    v_mfma_f32_16x16x32_bf16 v[188:191], v[200:203], v[168:171], v[220:223]
    s_waitcnt vmcnt(2)
    v_mfma_f32_16x16x32_bf16 v[192:195], v[204:207], v[152:155], v[216:219]
    v_mfma_f32_16x16x32_bf16 v[196:199], v[204:207], v[168:171], v[220:223]
    s_waitcnt vmcnt(1)
    v_mfma_f32_16x16x32_bf16 v[184:187], v[208:211], v[156:159], v[184:187]
    v_mfma_f32_16x16x32_bf16 v[188:191], v[208:211], v[172:175], v[188:191]
    s_waitcnt vmcnt(0)
    v_mfma_f32_16x16x32_bf16 v[192:195], v[212:215], v[156:159], v[192:195]
    v_mfma_f32_16x16x32_bf16 v[196:199], v[212:215], v[172:175], v[196:199]
    s_mov_b32 s17, 0x11000
    buffer_load_dwordx4 v[200:203], v8, s[8:11], s17 offen offset:0
    buffer_load_dwordx4 v[204:207], v8, s[8:11], s17 offen offset:1024
    buffer_load_dwordx4 v[208:211], v8, s[8:11], s17 offen offset:2048
    buffer_load_dwordx4 v[212:215], v8, s[8:11], s17 offen offset:3072
    s_waitcnt vmcnt(3)
    v_mfma_f32_16x16x32_bf16 v[184:187], v[200:203], v[160:163], v[184:187]
    v_mfma_f32_16x16x32_bf16 v[188:191], v[200:203], v[176:179], v[188:191]
    s_waitcnt vmcnt(2)
    v_mfma_f32_16x16x32_bf16 v[192:195], v[204:207], v[160:163], v[192:195]
    v_mfma_f32_16x16x32_bf16 v[196:199], v[204:207], v[176:179], v[196:199]
    s_waitcnt vmcnt(1)
    v_mfma_f32_16x16x32_bf16 v[184:187], v[208:211], v[164:167], v[184:187]
    v_mfma_f32_16x16x32_bf16 v[188:191], v[208:211], v[180:183], v[188:191]
    s_waitcnt vmcnt(0)
    v_mfma_f32_16x16x32_bf16 v[192:195], v[212:215], v[164:167], v[192:195]
    v_mfma_f32_16x16x32_bf16 v[196:199], v[212:215], v[180:183], v[196:199]
    s_nop 3
    v_exp_f32 v184, v184
    v_exp_f32 v185, v185
    v_add_f32 v9, v9, v184
    v_add_f32 v9, v9, v185
    v_cvt_pk_bf16_f32 v88, v184, v185
    v_exp_f32 v186, v186
    v_exp_f32 v187, v187
    v_add_f32 v9, v9, v186
    v_add_f32 v9, v9, v187
    v_cvt_pk_bf16_f32 v89, v186, v187
    v_exp_f32 v188, v188
    v_exp_f32 v189, v189
    v_add_f32 v10, v10, v188
    v_add_f32 v10, v10, v189
    v_cvt_pk_bf16_f32 v92, v188, v189
    v_exp_f32 v190, v190
    v_exp_f32 v191, v191
    v_add_f32 v10, v10, v190
    v_add_f32 v10, v10, v191
    v_cvt_pk_bf16_f32 v93, v190, v191
    v_exp_f32 v192, v192
    v_exp_f32 v193, v193
    v_add_f32 v9, v9, v192
    v_add_f32 v9, v9, v193
    v_cvt_pk_bf16_f32 v90, v192, v193
    v_exp_f32 v194, v194
    v_exp_f32 v195, v195
    v_add_f32 v9, v9, v194
    v_add_f32 v9, v9, v195
    v_cvt_pk_bf16_f32 v91, v194, v195
    v_exp_f32 v196, v196
    v_exp_f32 v197, v197
    v_add_f32 v10, v10, v196
    v_add_f32 v10, v10, v197
    v_cvt_pk_bf16_f32 v94, v196, v197
    v_exp_f32 v198, v198
    v_exp_f32 v199, v199
    v_add_f32 v10, v10, v198
    v_add_f32 v10, v10, v199
    v_cvt_pk_bf16_f32 v95, v198, v199
    s_mov_b32 s17, 0x12000
    buffer_load_dwordx4 v[200:203], v8, s[8:11], s17 offen offset:0
    buffer_load_dwordx4 v[204:207], v8, s[8:11], s17 offen offset:1024
    buffer_load_dwordx4 v[208:211], v8, s[8:11], s17 offen offset:2048
    buffer_load_dwordx4 v[212:215], v8, s[8:11], s17 offen offset:3072
    s_waitcnt vmcnt(3)
    v_mfma_f32_16x16x32_bf16 v[184:187], v[200:203], v[152:155], v[216:219]
    v_mfma_f32_16x16x32_bf16 v[188:191], v[200:203], v[168:171], v[220:223]
    s_waitcnt vmcnt(2)
    v_mfma_f32_16x16x32_bf16 v[192:195], v[204:207], v[152:155], v[216:219]
    v_mfma_f32_16x16x32_bf16 v[196:199], v[204:207], v[168:171], v[220:223]
    s_waitcnt vmcnt(1)
    v_mfma_f32_16x16x32_bf16 v[184:187], v[208:211], v[156:159], v[184:187]
    v_mfma_f32_16x16x32_bf16 v[188:191], v[208:211], v[172:175], v[188:191]
    s_waitcnt vmcnt(0)
    v_mfma_f32_16x16x32_bf16 v[192:195], v[212:215], v[156:159], v[192:195]
    v_mfma_f32_16x16x32_bf16 v[196:199], v[212:215], v[172:175], v[196:199]
    s_mov_b32 s17, 0x13000
    buffer_load_dwordx4 v[200:203], v8, s[8:11], s17 offen offset:0
    buffer_load_dwordx4 v[204:207], v8, s[8:11], s17 offen offset:1024
    buffer_load_dwordx4 v[208:211], v8, s[8:11], s17 offen offset:2048
    buffer_load_dwordx4 v[212:215], v8, s[8:11], s17 offen offset:3072
    s_waitcnt vmcnt(3)
    v_mfma_f32_16x16x32_bf16 v[184:187], v[200:203], v[160:163], v[184:187]
    v_mfma_f32_16x16x32_bf16 v[188:191], v[200:203], v[176:179], v[188:191]
    s_waitcnt vmcnt(2)
    v_mfma_f32_16x16x32_bf16 v[192:195], v[204:207], v[160:163], v[192:195]
    v_mfma_f32_16x16x32_bf16 v[196:199], v[204:207], v[176:179], v[196:199]
    s_waitcnt vmcnt(1)
    v_mfma_f32_16x16x32_bf16 v[184:187], v[208:211], v[164:167], v[184:187]
    v_mfma_f32_16x16x32_bf16 v[188:191], v[208:211], v[180:183], v[188:191]
    s_waitcnt vmcnt(0)
    v_mfma_f32_16x16x32_bf16 v[192:195], v[212:215], v[164:167], v[192:195]
    v_mfma_f32_16x16x32_bf16 v[196:199], v[212:215], v[180:183], v[196:199]
    s_nop 3
    v_exp_f32 v184, v184
    v_exp_f32 v185, v185
    v_add_f32 v9, v9, v184
    v_add_f32 v9, v9, v185
    v_cvt_pk_bf16_f32 v96, v184, v185
    v_exp_f32 v186, v186
    v_exp_f32 v187, v187
    v_add_f32 v9, v9, v186
    v_add_f32 v9, v9, v187
    v_cvt_pk_bf16_f32 v97, v186, v187
    v_exp_f32 v188, v188
    v_exp_f32 v189, v189
    v_add_f32 v10, v10, v188
    v_add_f32 v10, v10, v189
    v_cvt_pk_bf16_f32 v100, v188, v189
    v_exp_f32 v190, v190
    v_exp_f32 v191, v191
    v_add_f32 v10, v10, v190
    v_add_f32 v10, v10, v191
    v_cvt_pk_bf16_f32 v101, v190, v191
    v_exp_f32 v192, v192
    v_exp_f32 v193, v193
    v_add_f32 v9, v9, v192
    v_add_f32 v9, v9, v193
    v_cvt_pk_bf16_f32 v98, v192, v193
    v_exp_f32 v194, v194
    v_exp_f32 v195, v195
    v_add_f32 v9, v9, v194
    v_add_f32 v9, v9, v195
    v_cvt_pk_bf16_f32 v99, v194, v195
    v_exp_f32 v196, v196
    v_exp_f32 v197, v197
    v_add_f32 v10, v10, v196
    v_add_f32 v10, v10, v197
    v_cvt_pk_bf16_f32 v102, v196, v197
    v_exp_f32 v198, v198
    v_exp_f32 v199, v199
    v_add_f32 v10, v10, v198
    v_add_f32 v10, v10, v199
    v_cvt_pk_bf16_f32 v103, v198, v199
    s_mov_b32 s17, 0x14000
    buffer_load_dwordx4 v[200:203], v8, s[8:11], s17 offen offset:0
    buffer_load_dwordx4 v[204:207], v8, s[8:11], s17 offen offset:1024
    buffer_load_dwordx4 v[208:211], v8, s[8:11], s17 offen offset:2048
    buffer_load_dwordx4 v[212:215], v8, s[8:11], s17 offen offset:3072
    s_waitcnt vmcnt(3)
    v_mfma_f32_16x16x32_bf16 v[184:187], v[200:203], v[152:155], v[216:219]
    v_mfma_f32_16x16x32_bf16 v[188:191], v[200:203], v[168:171], v[220:223]
    s_waitcnt vmcnt(2)
    v_mfma_f32_16x16x32_bf16 v[192:195], v[204:207], v[152:155], v[216:219]
    v_mfma_f32_16x16x32_bf16 v[196:199], v[204:207], v[168:171], v[220:223]
    s_waitcnt vmcnt(1)
    v_mfma_f32_16x16x32_bf16 v[184:187], v[208:211], v[156:159], v[184:187]
    v_mfma_f32_16x16x32_bf16 v[188:191], v[208:211], v[172:175], v[188:191]
    s_waitcnt vmcnt(0)
    v_mfma_f32_16x16x32_bf16 v[192:195], v[212:215], v[156:159], v[192:195]
    v_mfma_f32_16x16x32_bf16 v[196:199], v[212:215], v[172:175], v[196:199]
    s_mov_b32 s17, 0x15000
    buffer_load_dwordx4 v[200:203], v8, s[8:11], s17 offen offset:0
    buffer_load_dwordx4 v[204:207], v8, s[8:11], s17 offen offset:1024
    buffer_load_dwordx4 v[208:211], v8, s[8:11], s17 offen offset:2048
    buffer_load_dwordx4 v[212:215], v8, s[8:11], s17 offen offset:3072
    s_waitcnt vmcnt(3)
    v_mfma_f32_16x16x32_bf16 v[184:187], v[200:203], v[160:163], v[184:187]
    v_mfma_f32_16x16x32_bf16 v[188:191], v[200:203], v[176:179], v[188:191]
    s_waitcnt vmcnt(2)
    v_mfma_f32_16x16x32_bf16 v[192:195], v[204:207], v[160:163], v[192:195]
    v_mfma_f32_16x16x32_bf16 v[196:199], v[204:207], v[176:179], v[196:199]
    s_waitcnt vmcnt(1)
    v_mfma_f32_16x16x32_bf16 v[184:187], v[208:211], v[164:167], v[184:187]
    v_mfma_f32_16x16x32_bf16 v[188:191], v[208:211], v[180:183], v[188:191]
    s_waitcnt vmcnt(0)
    v_mfma_f32_16x16x32_bf16 v[192:195], v[212:215], v[164:167], v[192:195]
    v_mfma_f32_16x16x32_bf16 v[196:199], v[212:215], v[180:183], v[196:199]
    s_nop 3
    v_exp_f32 v184, v184
    v_exp_f32 v185, v185
    v_add_f32 v9, v9, v184
    v_add_f32 v9, v9, v185
    v_cvt_pk_bf16_f32 v104, v184, v185
    v_exp_f32 v186, v186
    v_exp_f32 v187, v187
    v_add_f32 v9, v9, v186
    v_add_f32 v9, v9, v187
    v_cvt_pk_bf16_f32 v105, v186, v187
    v_exp_f32 v188, v188
    v_exp_f32 v189, v189
    v_add_f32 v10, v10, v188
    v_add_f32 v10, v10, v189
    v_cvt_pk_bf16_f32 v108, v188, v189
    v_exp_f32 v190, v190
    v_exp_f32 v191, v191
    v_add_f32 v10, v10, v190
    v_add_f32 v10, v10, v191
    v_cvt_pk_bf16_f32 v109, v190, v191
    v_exp_f32 v192, v192
    v_exp_f32 v193, v193
    v_add_f32 v9, v9, v192
    v_add_f32 v9, v9, v193
    v_cvt_pk_bf16_f32 v106, v192, v193
    v_exp_f32 v194, v194
    v_exp_f32 v195, v195
    v_add_f32 v9, v9, v194
    v_add_f32 v9, v9, v195
    v_cvt_pk_bf16_f32 v107, v194, v195
    v_exp_f32 v196, v196
    v_exp_f32 v197, v197
    v_add_f32 v10, v10, v196
    v_add_f32 v10, v10, v197
    v_cvt_pk_bf16_f32 v110, v196, v197
    v_exp_f32 v198, v198
    v_exp_f32 v199, v199
    v_add_f32 v10, v10, v198
    v_add_f32 v10, v10, v199
    v_cvt_pk_bf16_f32 v111, v198, v199
    s_mov_b32 s17, 0x16000
    buffer_load_dwordx4 v[200:203], v8, s[8:11], s17 offen offset:0
    buffer_load_dwordx4 v[204:207], v8, s[8:11], s17 offen offset:1024
    buffer_load_dwordx4 v[208:211], v8, s[8:11], s17 offen offset:2048
    buffer_load_dwordx4 v[212:215], v8, s[8:11], s17 offen offset:3072
    s_waitcnt vmcnt(3)
    v_mfma_f32_16x16x32_bf16 v[184:187], v[200:203], v[152:155], v[216:219]
    v_mfma_f32_16x16x32_bf16 v[188:191], v[200:203], v[168:171], v[220:223]
    s_waitcnt vmcnt(2)
    v_mfma_f32_16x16x32_bf16 v[192:195], v[204:207], v[152:155], v[216:219]
    v_mfma_f32_16x16x32_bf16 v[196:199], v[204:207], v[168:171], v[220:223]
    s_waitcnt vmcnt(1)
    v_mfma_f32_16x16x32_bf16 v[184:187], v[208:211], v[156:159], v[184:187]
    v_mfma_f32_16x16x32_bf16 v[188:191], v[208:211], v[172:175], v[188:191]
    s_waitcnt vmcnt(0)
    v_mfma_f32_16x16x32_bf16 v[192:195], v[212:215], v[156:159], v[192:195]
    v_mfma_f32_16x16x32_bf16 v[196:199], v[212:215], v[172:175], v[196:199]
    s_mov_b32 s17, 0x17000
    buffer_load_dwordx4 v[200:203], v8, s[8:11], s17 offen offset:0
    buffer_load_dwordx4 v[204:207], v8, s[8:11], s17 offen offset:1024
    buffer_load_dwordx4 v[208:211], v8, s[8:11], s17 offen offset:2048
    buffer_load_dwordx4 v[212:215], v8, s[8:11], s17 offen offset:3072
    s_waitcnt vmcnt(3)
    v_mfma_f32_16x16x32_bf16 v[184:187], v[200:203], v[160:163], v[184:187]
    v_mfma_f32_16x16x32_bf16 v[188:191], v[200:203], v[176:179], v[188:191]
    s_waitcnt vmcnt(2)
    v_mfma_f32_16x16x32_bf16 v[192:195], v[204:207], v[160:163], v[192:195]
    v_mfma_f32_16x16x32_bf16 v[196:199], v[204:207], v[176:179], v[196:199]
    s_waitcnt vmcnt(1)
    v_mfma_f32_16x16x32_bf16 v[184:187], v[208:211], v[164:167], v[184:187]
    v_mfma_f32_16x16x32_bf16 v[188:191], v[208:211], v[180:183], v[188:191]
    s_waitcnt vmcnt(0)
    v_mfma_f32_16x16x32_bf16 v[192:195], v[212:215], v[164:167], v[192:195]
    v_mfma_f32_16x16x32_bf16 v[196:199], v[212:215], v[180:183], v[196:199]
    s_nop 3
    v_exp_f32 v184, v184
    v_exp_f32 v185, v185
    v_add_f32 v9, v9, v184
    v_add_f32 v9, v9, v185
    v_cvt_pk_bf16_f32 v112, v184, v185
    v_exp_f32 v186, v186
    v_exp_f32 v187, v187
    v_add_f32 v9, v9, v186
    v_add_f32 v9, v9, v187
    v_cvt_pk_bf16_f32 v113, v186, v187
    v_exp_f32 v188, v188
    v_exp_f32 v189, v189
    v_add_f32 v10, v10, v188
    v_add_f32 v10, v10, v189
    v_cvt_pk_bf16_f32 v116, v188, v189
    v_exp_f32 v190, v190
    v_exp_f32 v191, v191
    v_add_f32 v10, v10, v190
    v_add_f32 v10, v10, v191
    v_cvt_pk_bf16_f32 v117, v190, v191
    v_exp_f32 v192, v192
    v_exp_f32 v193, v193
    v_add_f32 v9, v9, v192
    v_add_f32 v9, v9, v193
    v_cvt_pk_bf16_f32 v114, v192, v193
    v_exp_f32 v194, v194
    v_exp_f32 v195, v195
    v_add_f32 v9, v9, v194
    v_add_f32 v9, v9, v195
    v_cvt_pk_bf16_f32 v115, v194, v195
    v_exp_f32 v196, v196
    v_exp_f32 v197, v197
    v_add_f32 v10, v10, v196
    v_add_f32 v10, v10, v197
    v_cvt_pk_bf16_f32 v118, v196, v197
    v_exp_f32 v198, v198
    v_exp_f32 v199, v199
    v_add_f32 v10, v10, v198
    v_add_f32 v10, v10, v199
    v_cvt_pk_bf16_f32 v119, v198, v199
    s_mov_b32 s17, 0x18000
    buffer_load_dwordx4 v[200:203], v8, s[8:11], s17 offen offset:0
    buffer_load_dwordx4 v[204:207], v8, s[8:11], s17 offen offset:1024
    buffer_load_dwordx4 v[208:211], v8, s[8:11], s17 offen offset:2048
    buffer_load_dwordx4 v[212:215], v8, s[8:11], s17 offen offset:3072
    s_waitcnt vmcnt(3)
    v_mfma_f32_16x16x32_bf16 v[184:187], v[200:203], v[152:155], v[216:219]
    v_mfma_f32_16x16x32_bf16 v[188:191], v[200:203], v[168:171], v[220:223]
    s_waitcnt vmcnt(2)
    v_mfma_f32_16x16x32_bf16 v[192:195], v[204:207], v[152:155], v[216:219]
    v_mfma_f32_16x16x32_bf16 v[196:199], v[204:207], v[168:171], v[220:223]
    s_waitcnt vmcnt(1)
    v_mfma_f32_16x16x32_bf16 v[184:187], v[208:211], v[156:159], v[184:187]
    v_mfma_f32_16x16x32_bf16 v[188:191], v[208:211], v[172:175], v[188:191]
    s_waitcnt vmcnt(0)
    v_mfma_f32_16x16x32_bf16 v[192:195], v[212:215], v[156:159], v[192:195]
    v_mfma_f32_16x16x32_bf16 v[196:199], v[212:215], v[172:175], v[196:199]
    s_mov_b32 s17, 0x19000
    buffer_load_dwordx4 v[200:203], v8, s[8:11], s17 offen offset:0
    buffer_load_dwordx4 v[204:207], v8, s[8:11], s17 offen offset:1024
    buffer_load_dwordx4 v[208:211], v8, s[8:11], s17 offen offset:2048
    buffer_load_dwordx4 v[212:215], v8, s[8:11], s17 offen offset:3072
    s_waitcnt vmcnt(3)
    v_mfma_f32_16x16x32_bf16 v[184:187], v[200:203], v[160:163], v[184:187]
    v_mfma_f32_16x16x32_bf16 v[188:191], v[200:203], v[176:179], v[188:191]
    s_waitcnt vmcnt(2)
    v_mfma_f32_16x16x32_bf16 v[192:195], v[204:207], v[160:163], v[192:195]
    v_mfma_f32_16x16x32_bf16 v[196:199], v[204:207], v[176:179], v[196:199]
    s_waitcnt vmcnt(1)
    v_mfma_f32_16x16x32_bf16 v[184:187], v[208:211], v[164:167], v[184:187]
    v_mfma_f32_16x16x32_bf16 v[188:191], v[208:211], v[180:183], v[188:191]
    s_waitcnt vmcnt(0)
    v_mfma_f32_16x16x32_bf16 v[192:195], v[212:215], v[164:167], v[192:195]
    v_mfma_f32_16x16x32_bf16 v[196:199], v[212:215], v[180:183], v[196:199]
    s_nop 3
    v_exp_f32 v184, v184
    v_exp_f32 v185, v185
    v_add_f32 v9, v9, v184
    v_add_f32 v9, v9, v185
    v_cvt_pk_bf16_f32 v120, v184, v185
    v_exp_f32 v186, v186
    v_exp_f32 v187, v187
    v_add_f32 v9, v9, v186
    v_add_f32 v9, v9, v187
    v_cvt_pk_bf16_f32 v121, v186, v187
    v_exp_f32 v188, v188
    v_exp_f32 v189, v189
    v_add_f32 v10, v10, v188
    v_add_f32 v10, v10, v189
    v_cvt_pk_bf16_f32 v124, v188, v189
    v_exp_f32 v190, v190
    v_exp_f32 v191, v191
    v_add_f32 v10, v10, v190
    v_add_f32 v10, v10, v191
    v_cvt_pk_bf16_f32 v125, v190, v191
    v_exp_f32 v192, v192
    v_exp_f32 v193, v193
    v_add_f32 v9, v9, v192
    v_add_f32 v9, v9, v193
    v_cvt_pk_bf16_f32 v122, v192, v193
    v_exp_f32 v194, v194
    v_exp_f32 v195, v195
    v_add_f32 v9, v9, v194
    v_add_f32 v9, v9, v195
    v_cvt_pk_bf16_f32 v123, v194, v195
    v_exp_f32 v196, v196
    v_exp_f32 v197, v197
    v_add_f32 v10, v10, v196
    v_add_f32 v10, v10, v197
    v_cvt_pk_bf16_f32 v126, v196, v197
    v_exp_f32 v198, v198
    v_exp_f32 v199, v199
    v_add_f32 v10, v10, v198
    v_add_f32 v10, v10, v199
    v_cvt_pk_bf16_f32 v127, v198, v199
    s_mov_b32 s17, 0x1a000
    buffer_load_dwordx4 v[200:203], v8, s[8:11], s17 offen offset:0
    buffer_load_dwordx4 v[204:207], v8, s[8:11], s17 offen offset:1024
    buffer_load_dwordx4 v[208:211], v8, s[8:11], s17 offen offset:2048
    buffer_load_dwordx4 v[212:215], v8, s[8:11], s17 offen offset:3072
    s_waitcnt vmcnt(3)
    v_mfma_f32_16x16x32_bf16 v[184:187], v[200:203], v[152:155], v[216:219]
    v_mfma_f32_16x16x32_bf16 v[188:191], v[200:203], v[168:171], v[220:223]
    s_waitcnt vmcnt(2)
    v_mfma_f32_16x16x32_bf16 v[192:195], v[204:207], v[152:155], v[216:219]
    v_mfma_f32_16x16x32_bf16 v[196:199], v[204:207], v[168:171], v[220:223]
    s_waitcnt vmcnt(1)
    v_mfma_f32_16x16x32_bf16 v[184:187], v[208:211], v[156:159], v[184:187]
    v_mfma_f32_16x16x32_bf16 v[188:191], v[208:211], v[172:175], v[188:191]
    s_waitcnt vmcnt(0)
    v_mfma_f32_16x16x32_bf16 v[192:195], v[212:215], v[156:159], v[192:195]
    v_mfma_f32_16x16x32_bf16 v[196:199], v[212:215], v[172:175], v[196:199]
    s_mov_b32 s17, 0x1b000
    buffer_load_dwordx4 v[200:203], v8, s[8:11], s17 offen offset:0
    buffer_load_dwordx4 v[204:207], v8, s[8:11], s17 offen offset:1024
    buffer_load_dwordx4 v[208:211], v8, s[8:11], s17 offen offset:2048
    buffer_load_dwordx4 v[212:215], v8, s[8:11], s17 offen offset:3072
    s_waitcnt vmcnt(3)
    v_mfma_f32_16x16x32_bf16 v[184:187], v[200:203], v[160:163], v[184:187]
    v_mfma_f32_16x16x32_bf16 v[188:191], v[200:203], v[176:179], v[188:191]
    s_waitcnt vmcnt(2)
    v_mfma_f32_16x16x32_bf16 v[192:195], v[204:207], v[160:163], v[192:195]
    v_mfma_f32_16x16x32_bf16 v[196:199], v[204:207], v[176:179], v[196:199]
    s_waitcnt vmcnt(1)
    v_mfma_f32_16x16x32_bf16 v[184:187], v[208:211], v[164:167], v[184:187]
    v_mfma_f32_16x16x32_bf16 v[188:191], v[208:211], v[180:183], v[188:191]
    s_waitcnt vmcnt(0)
    v_mfma_f32_16x16x32_bf16 v[192:195], v[212:215], v[164:167], v[192:195]
    v_mfma_f32_16x16x32_bf16 v[196:199], v[212:215], v[180:183], v[196:199]
    s_nop 3
    v_exp_f32 v184, v184
    v_exp_f32 v185, v185
    v_add_f32 v9, v9, v184
    v_add_f32 v9, v9, v185
    v_cvt_pk_bf16_f32 v128, v184, v185
    v_exp_f32 v186, v186
    v_exp_f32 v187, v187
    v_add_f32 v9, v9, v186
    v_add_f32 v9, v9, v187
    v_cvt_pk_bf16_f32 v129, v186, v187
    v_exp_f32 v188, v188
    v_exp_f32 v189, v189
    v_add_f32 v10, v10, v188
    v_add_f32 v10, v10, v189
    v_cvt_pk_bf16_f32 v132, v188, v189
    v_exp_f32 v190, v190
    v_exp_f32 v191, v191
    v_add_f32 v10, v10, v190
    v_add_f32 v10, v10, v191
    v_cvt_pk_bf16_f32 v133, v190, v191
    v_exp_f32 v192, v192
    v_exp_f32 v193, v193
    v_add_f32 v9, v9, v192
    v_add_f32 v9, v9, v193
    v_cvt_pk_bf16_f32 v130, v192, v193
    v_exp_f32 v194, v194
    v_exp_f32 v195, v195
    v_add_f32 v9, v9, v194
    v_add_f32 v9, v9, v195
    v_cvt_pk_bf16_f32 v131, v194, v195
    v_exp_f32 v196, v196
    v_exp_f32 v197, v197
    v_add_f32 v10, v10, v196
    v_add_f32 v10, v10, v197
    v_cvt_pk_bf16_f32 v134, v196, v197
    v_exp_f32 v198, v198
    v_exp_f32 v199, v199
    v_add_f32 v10, v10, v198
    v_add_f32 v10, v10, v199
    v_cvt_pk_bf16_f32 v135, v198, v199
    s_mov_b32 s17, 0x1c000
    buffer_load_dwordx4 v[200:203], v8, s[8:11], s17 offen offset:0
    buffer_load_dwordx4 v[204:207], v8, s[8:11], s17 offen offset:1024
    buffer_load_dwordx4 v[208:211], v8, s[8:11], s17 offen offset:2048
    buffer_load_dwordx4 v[212:215], v8, s[8:11], s17 offen offset:3072
    s_waitcnt vmcnt(3)
    v_mfma_f32_16x16x32_bf16 v[184:187], v[200:203], v[152:155], v[216:219]
    v_mfma_f32_16x16x32_bf16 v[188:191], v[200:203], v[168:171], v[220:223]
    s_waitcnt vmcnt(2)
    v_mfma_f32_16x16x32_bf16 v[192:195], v[204:207], v[152:155], v[216:219]
    v_mfma_f32_16x16x32_bf16 v[196:199], v[204:207], v[168:171], v[220:223]
    s_waitcnt vmcnt(1)
    v_mfma_f32_16x16x32_bf16 v[184:187], v[208:211], v[156:159], v[184:187]
    v_mfma_f32_16x16x32_bf16 v[188:191], v[208:211], v[172:175], v[188:191]
    s_waitcnt vmcnt(0)
    v_mfma_f32_16x16x32_bf16 v[192:195], v[212:215], v[156:159], v[192:195]
    v_mfma_f32_16x16x32_bf16 v[196:199], v[212:215], v[172:175], v[196:199]
    s_mov_b32 s17, 0x1d000
    buffer_load_dwordx4 v[200:203], v8, s[8:11], s17 offen offset:0
    buffer_load_dwordx4 v[204:207], v8, s[8:11], s17 offen offset:1024
    buffer_load_dwordx4 v[208:211], v8, s[8:11], s17 offen offset:2048
    buffer_load_dwordx4 v[212:215], v8, s[8:11], s17 offen offset:3072
    s_waitcnt vmcnt(3)
    v_mfma_f32_16x16x32_bf16 v[184:187], v[200:203], v[160:163], v[184:187]
    v_mfma_f32_16x16x32_bf16 v[188:191], v[200:203], v[176:179], v[188:191]
    s_waitcnt vmcnt(2)
    v_mfma_f32_16x16x32_bf16 v[192:195], v[204:207], v[160:163], v[192:195]
    v_mfma_f32_16x16x32_bf16 v[196:199], v[204:207], v[176:179], v[196:199]
    s_waitcnt vmcnt(1)
    v_mfma_f32_16x16x32_bf16 v[184:187], v[208:211], v[164:167], v[184:187]
    v_mfma_f32_16x16x32_bf16 v[188:191], v[208:211], v[180:183], v[188:191]
    s_waitcnt vmcnt(0)
    v_mfma_f32_16x16x32_bf16 v[192:195], v[212:215], v[164:167], v[192:195]
    v_mfma_f32_16x16x32_bf16 v[196:199], v[212:215], v[180:183], v[196:199]
    s_nop 3
    v_exp_f32 v184, v184
    v_exp_f32 v185, v185
    v_add_f32 v9, v9, v184
    v_add_f32 v9, v9, v185
    v_cvt_pk_bf16_f32 v136, v184, v185
    v_exp_f32 v186, v186
    v_exp_f32 v187, v187
    v_add_f32 v9, v9, v186
    v_add_f32 v9, v9, v187
    v_cvt_pk_bf16_f32 v137, v186, v187
    v_exp_f32 v188, v188
    v_exp_f32 v189, v189
    v_add_f32 v10, v10, v188
    v_add_f32 v10, v10, v189
    v_cvt_pk_bf16_f32 v140, v188, v189
    v_exp_f32 v190, v190
    v_exp_f32 v191, v191
    v_add_f32 v10, v10, v190
    v_add_f32 v10, v10, v191
    v_cvt_pk_bf16_f32 v141, v190, v191
    v_exp_f32 v192, v192
    v_exp_f32 v193, v193
    v_add_f32 v9, v9, v192
    v_add_f32 v9, v9, v193
    v_cvt_pk_bf16_f32 v138, v192, v193
    v_exp_f32 v194, v194
    v_exp_f32 v195, v195
    v_add_f32 v9, v9, v194
    v_add_f32 v9, v9, v195
    v_cvt_pk_bf16_f32 v139, v194, v195
    v_exp_f32 v196, v196
    v_exp_f32 v197, v197
    v_add_f32 v10, v10, v196
    v_add_f32 v10, v10, v197
    v_cvt_pk_bf16_f32 v142, v196, v197
    v_exp_f32 v198, v198
    v_exp_f32 v199, v199
    v_add_f32 v10, v10, v198
    v_add_f32 v10, v10, v199
    v_cvt_pk_bf16_f32 v143, v198, v199
    s_mov_b32 s17, 0x1e000
    buffer_load_dwordx4 v[200:203], v8, s[8:11], s17 offen offset:0
    buffer_load_dwordx4 v[204:207], v8, s[8:11], s17 offen offset:1024
    buffer_load_dwordx4 v[208:211], v8, s[8:11], s17 offen offset:2048
    buffer_load_dwordx4 v[212:215], v8, s[8:11], s17 offen offset:3072
    s_waitcnt vmcnt(3)
    v_mfma_f32_16x16x32_bf16 v[184:187], v[200:203], v[152:155], v[216:219]
    v_mfma_f32_16x16x32_bf16 v[188:191], v[200:203], v[168:171], v[220:223]
    s_waitcnt vmcnt(2)
    v_mfma_f32_16x16x32_bf16 v[192:195], v[204:207], v[152:155], v[216:219]
    v_mfma_f32_16x16x32_bf16 v[196:199], v[204:207], v[168:171], v[220:223]
    s_waitcnt vmcnt(1)
    v_mfma_f32_16x16x32_bf16 v[184:187], v[208:211], v[156:159], v[184:187]
    v_mfma_f32_16x16x32_bf16 v[188:191], v[208:211], v[172:175], v[188:191]
    s_waitcnt vmcnt(0)
    v_mfma_f32_16x16x32_bf16 v[192:195], v[212:215], v[156:159], v[192:195]
    v_mfma_f32_16x16x32_bf16 v[196:199], v[212:215], v[172:175], v[196:199]
    s_mov_b32 s17, 0x1f000
    buffer_load_dwordx4 v[200:203], v8, s[8:11], s17 offen offset:0
    buffer_load_dwordx4 v[204:207], v8, s[8:11], s17 offen offset:1024
    buffer_load_dwordx4 v[208:211], v8, s[8:11], s17 offen offset:2048
    buffer_load_dwordx4 v[212:215], v8, s[8:11], s17 offen offset:3072
    s_waitcnt vmcnt(3)
    v_mfma_f32_16x16x32_bf16 v[184:187], v[200:203], v[160:163], v[184:187]
    v_mfma_f32_16x16x32_bf16 v[188:191], v[200:203], v[176:179], v[188:191]
    s_waitcnt vmcnt(2)
    v_mfma_f32_16x16x32_bf16 v[192:195], v[204:207], v[160:163], v[192:195]
    v_mfma_f32_16x16x32_bf16 v[196:199], v[204:207], v[176:179], v[196:199]
    s_waitcnt vmcnt(1)
    v_mfma_f32_16x16x32_bf16 v[184:187], v[208:211], v[164:167], v[184:187]
    v_mfma_f32_16x16x32_bf16 v[188:191], v[208:211], v[180:183], v[188:191]
    s_waitcnt vmcnt(0)
    v_mfma_f32_16x16x32_bf16 v[192:195], v[212:215], v[164:167], v[192:195]
    v_mfma_f32_16x16x32_bf16 v[196:199], v[212:215], v[180:183], v[196:199]
    s_nop 3
    v_exp_f32 v184, v184
    v_exp_f32 v185, v185
    v_add_f32 v9, v9, v184
    v_add_f32 v9, v9, v185
    v_cvt_pk_bf16_f32 v144, v184, v185
    v_exp_f32 v186, v186
    v_exp_f32 v187, v187
    v_add_f32 v9, v9, v186
    v_add_f32 v9, v9, v187
    v_cvt_pk_bf16_f32 v145, v186, v187
    v_exp_f32 v188, v188
    v_exp_f32 v189, v189
    v_add_f32 v10, v10, v188
    v_add_f32 v10, v10, v189
    v_cvt_pk_bf16_f32 v148, v188, v189
    v_exp_f32 v190, v190
    v_exp_f32 v191, v191
    v_add_f32 v10, v10, v190
    v_add_f32 v10, v10, v191
    v_cvt_pk_bf16_f32 v149, v190, v191
    v_exp_f32 v192, v192
    v_exp_f32 v193, v193
    v_add_f32 v9, v9, v192
    v_add_f32 v9, v9, v193
    v_cvt_pk_bf16_f32 v146, v192, v193
    v_exp_f32 v194, v194
    v_exp_f32 v195, v195
    v_add_f32 v9, v9, v194
    v_add_f32 v9, v9, v195
    v_cvt_pk_bf16_f32 v147, v194, v195
    v_exp_f32 v196, v196
    v_exp_f32 v197, v197
    v_add_f32 v10, v10, v196
    v_add_f32 v10, v10, v197
    v_cvt_pk_bf16_f32 v150, v196, v197
    v_exp_f32 v198, v198
    v_exp_f32 v199, v199
    v_add_f32 v10, v10, v198
    v_add_f32 v10, v10, v199
    v_cvt_pk_bf16_f32 v151, v198, v199
    v_mov_b32 v16, v9
    v_mov_b32 v18, v10
    s_nop 0
    v_permlane16_swap_b32 v9, v16
    v_permlane16_swap_b32 v10, v18
    v_add_f32 v9, v9, v16
    v_add_f32 v10, v10, v18
    v_mov_b32 v16, v9
    v_mov_b32 v18, v10
    s_nop 0
    v_permlane32_swap_b32 v9, v16
    v_permlane32_swap_b32 v10, v18
    v_add_f32 v9, v9, v16
    v_add_f32 v10, v10, v18
    s_waitcnt vmcnt(0) lgkmcnt(0)
    s_nop 15
    s_nop 3
    s_branch adaLN_cond__sliding_block_cached__moe_arch_mod__prompt_kernel_fixAb
adaLN_cond__sliding_block_cached__moe_arch_mod__prompt_kernel_o5r:
    s_waitcnt vmcnt(0) lgkmcnt(0)
    s_nop 15
    s_nop 3
    s_mov_b32 s27, 0
adaLN_cond__sliding_block_cached__moe_arch_mod__prompt_kernel_o5p:
    buffer_load_dword v12, v13, s[8:11], s19 offen sc1
    s_waitcnt vmcnt(0)
    v_cmp_ne_u32 vcc, s28, v12
    s_add_u32 s27, s27, 1
    s_cmp_ge_u32 s27, 65536
    s_cbranch_scc1 adaLN_cond__sliding_block_cached__moe_arch_mod__prompt_kernel_o5g
    s_cbranch_vccnz adaLN_cond__sliding_block_cached__moe_arch_mod__prompt_kernel_o5p
adaLN_cond__sliding_block_cached__moe_arch_mod__prompt_kernel_o5g:
    s_waitcnt vmcnt(0) lgkmcnt(0)
    s_nop 15
    s_nop 3
    s_branch adaLN_cond__sliding_block_cached__moe_arch_mod__prompt_kernel_o5b
adaLN_cond__sliding_block_cached__moe_arch_mod__prompt_kernel_o26r:
    s_waitcnt vmcnt(0) lgkmcnt(0)
    s_nop 15
    s_nop 3
    s_mov_b32 s27, 0
adaLN_cond__sliding_block_cached__moe_arch_mod__prompt_kernel_o26p:
    buffer_load_dword v12, v13, s[8:11], s19 offen sc1
    s_waitcnt vmcnt(0)
    v_cmp_ne_u32 vcc, s28, v12
    s_add_u32 s27, s27, 1
    s_cmp_ge_u32 s27, 65536
    s_cbranch_scc1 adaLN_cond__sliding_block_cached__moe_arch_mod__prompt_kernel_o26g
    s_cbranch_vccnz adaLN_cond__sliding_block_cached__moe_arch_mod__prompt_kernel_o26p
adaLN_cond__sliding_block_cached__moe_arch_mod__prompt_kernel_o26g:
    s_waitcnt vmcnt(0) lgkmcnt(0)
    s_nop 15
    s_nop 3
    s_branch adaLN_cond__sliding_block_cached__moe_arch_mod__prompt_kernel_o26b
adaLN_cond__sliding_block_cached__moe_arch_mod__prompt_kernel_mp7r:
    s_waitcnt vmcnt(0) lgkmcnt(0)
    s_nop 15
    s_nop 3
    s_mov_b32 s27, 0
adaLN_cond__sliding_block_cached__moe_arch_mod__prompt_kernel_mp7p:
    buffer_load_dword v248, v250, s[8:11], s14 offen sc1
    s_waitcnt vmcnt(0)
    v_cmp_ne_u32 vcc, s28, v248
    s_add_u32 s27, s27, 1
    s_cmp_ge_u32 s27, 65536
    s_cbranch_scc1 adaLN_cond__sliding_block_cached__moe_arch_mod__prompt_kernel_mp7g
    s_cbranch_vccnz adaLN_cond__sliding_block_cached__moe_arch_mod__prompt_kernel_mp7p
adaLN_cond__sliding_block_cached__moe_arch_mod__prompt_kernel_mp7g:
    s_waitcnt vmcnt(0) lgkmcnt(0)
    s_nop 15
    s_nop 3
    s_branch adaLN_cond__sliding_block_cached__moe_arch_mod__prompt_kernel_mp7b
adaLN_cond__sliding_block_cached__moe_arch_mod__prompt_kernel_o28r:
    s_waitcnt vmcnt(0) lgkmcnt(0)
    s_nop 15
    s_nop 3
    s_mov_b32 s27, 0
adaLN_cond__sliding_block_cached__moe_arch_mod__prompt_kernel_o28p:
    buffer_load_dword v12, v13, s[8:11], s19 offen sc1
    s_waitcnt vmcnt(0)
    v_cmp_ne_u32 vcc, s28, v12
    s_add_u32 s27, s27, 1
    s_cmp_ge_u32 s27, 65536
    s_cbranch_scc1 adaLN_cond__sliding_block_cached__moe_arch_mod__prompt_kernel_o28g
    s_cbranch_vccnz adaLN_cond__sliding_block_cached__moe_arch_mod__prompt_kernel_o28p
adaLN_cond__sliding_block_cached__moe_arch_mod__prompt_kernel_o28g:
    s_waitcnt vmcnt(0) lgkmcnt(0)
    s_nop 15
    s_nop 3
    s_branch adaLN_cond__sliding_block_cached__moe_arch_mod__prompt_kernel_o28b
adaLN_cond__sliding_block_cached__moe_arch_mod__prompt_kernel_o29r:
    s_waitcnt vmcnt(0) lgkmcnt(0)
    s_nop 15
    s_nop 3
    s_mov_b32 s27, 0
adaLN_cond__sliding_block_cached__moe_arch_mod__prompt_kernel_o29p:
    buffer_load_dword v12, v13, s[8:11], s19 offen sc1
    s_waitcnt vmcnt(0)
    v_cmp_ne_u32 vcc, s28, v12
    s_add_u32 s27, s27, 1
    s_cmp_ge_u32 s27, 65536
    s_cbranch_scc1 adaLN_cond__sliding_block_cached__moe_arch_mod__prompt_kernel_o29g
    s_cbranch_vccnz adaLN_cond__sliding_block_cached__moe_arch_mod__prompt_kernel_o29p
adaLN_cond__sliding_block_cached__moe_arch_mod__prompt_kernel_o29g:
    s_waitcnt vmcnt(0) lgkmcnt(0)
    s_nop 15
    s_nop 3
    s_branch adaLN_cond__sliding_block_cached__moe_arch_mod__prompt_kernel_o29b
adaLN_cond__sliding_block_cached__moe_arch_mod__prompt_kernel_mf10r:
    s_waitcnt vmcnt(0) lgkmcnt(0)
    s_nop 15
    s_nop 3
    s_mov_b32 s27, 0
adaLN_cond__sliding_block_cached__moe_arch_mod__prompt_kernel_mf10p:
    s_mov_b32 s16, 0x544000
    buffer_load_dwordx4 v[184:187], v2, s[8:11], s16 offen sc1
    s_waitcnt vmcnt(0)
    v_xor_b32 v16, s28, v184
    v_xor_b32 v17, s28, v185
    v_xor_b32 v18, s28, v186
    v_xor_b32 v19, s28, v187
    v_or3_b32 v16, v16, v17, v18
    v_or_b32 v16, v16, v19
    v_cmp_ne_u32 vcc, 0, v16
    s_add_u32 s27, s27, 1
    s_cmp_ge_u32 s27, 65536
    s_cbranch_scc1 adaLN_cond__sliding_block_cached__moe_arch_mod__prompt_kernel_mf10g
    s_cbranch_vccnz adaLN_cond__sliding_block_cached__moe_arch_mod__prompt_kernel_mf10p
adaLN_cond__sliding_block_cached__moe_arch_mod__prompt_kernel_mf10g:
    s_waitcnt vmcnt(0) lgkmcnt(0)
    s_nop 15
    s_nop 3
    s_branch adaLN_cond__sliding_block_cached__moe_arch_mod__prompt_kernel_mf10b
adaLN_cond__sliding_block_cached__moe_arch_mod__prompt_kernel_kv16r:
    s_waitcnt vmcnt(0) lgkmcnt(0)
    s_nop 15
    s_nop 3
    s_mov_b32 s27, 0
adaLN_cond__sliding_block_cached__moe_arch_mod__prompt_kernel_kv16p:
    buffer_load_dwordx4 v[12:15], v21, s[8:11], s18 offen sc1
    s_waitcnt vmcnt(0)
    v_xor_b32 v8, s28, v12
    v_xor_b32 v20, s28, v13
    v_or_b32 v8, v8, v20
    v_xor_b32 v20, s28, v14
    v_or_b32 v8, v8, v20
    v_xor_b32 v20, s28, v15
    v_or_b32 v8, v8, v20
    v_cmp_ne_u32 vcc, 0, v8
    s_add_u32 s27, s27, 1
    s_cmp_ge_u32 s27, 65536
    s_cbranch_scc1 adaLN_cond__sliding_block_cached__moe_arch_mod__prompt_kernel_kv16g
    s_cbranch_vccnz adaLN_cond__sliding_block_cached__moe_arch_mod__prompt_kernel_kv16p
adaLN_cond__sliding_block_cached__moe_arch_mod__prompt_kernel_kv16g:
    s_waitcnt vmcnt(0) lgkmcnt(0)
    s_nop 15
    s_nop 3
    s_branch adaLN_cond__sliding_block_cached__moe_arch_mod__prompt_kernel_kv16b
adaLN_cond__sliding_block_cached__moe_arch_mod__prompt_kernel_fixB:
    s_waitcnt vmcnt(0) lgkmcnt(0)
    s_nop 15
    s_nop 3
    s_lshr_b32 s16, s12, 3
    s_lshl_b32 s16, s16, 17
    s_add_u32 s16, s16, 0x400000
    v_add_u32 v8, s16, v2
    v_mov_b32 v16, 0xff7fffff
    v_mov_b32 v17, 0xff7fffff
    s_mov_b32 s16, 0
adaLN_cond__sliding_block_cached__moe_arch_mod__prompt_kernel_fixBm:
    s_add_u32 s17, s16, 0
    buffer_load_dwordx4 v[200:203], v8, s[8:11], s17 offen offset:0
    buffer_load_dwordx4 v[204:207], v8, s[8:11], s17 offen offset:1024
    buffer_load_dwordx4 v[208:211], v8, s[8:11], s17 offen offset:2048
    buffer_load_dwordx4 v[212:215], v8, s[8:11], s17 offen offset:3072
    s_waitcnt vmcnt(3)
    v_mfma_f32_16x16x32_bf16 v[184:187], v[200:203], v[152:155], 0
    v_mfma_f32_16x16x32_bf16 v[188:191], v[200:203], v[168:171], 0
    s_waitcnt vmcnt(2)
    v_mfma_f32_16x16x32_bf16 v[192:195], v[204:207], v[152:155], 0
    v_mfma_f32_16x16x32_bf16 v[196:199], v[204:207], v[168:171], 0
    s_waitcnt vmcnt(1)
    v_mfma_f32_16x16x32_bf16 v[184:187], v[208:211], v[156:159], v[184:187]
    v_mfma_f32_16x16x32_bf16 v[188:191], v[208:211], v[172:175], v[188:191]
    s_waitcnt vmcnt(0)
    v_mfma_f32_16x16x32_bf16 v[192:195], v[212:215], v[156:159], v[192:195]
    v_mfma_f32_16x16x32_bf16 v[196:199], v[212:215], v[172:175], v[196:199]
    s_add_u32 s17, s16, 4096
    buffer_load_dwordx4 v[200:203], v8, s[8:11], s17 offen offset:0
    buffer_load_dwordx4 v[204:207], v8, s[8:11], s17 offen offset:1024
    buffer_load_dwordx4 v[208:211], v8, s[8:11], s17 offen offset:2048
    buffer_load_dwordx4 v[212:215], v8, s[8:11], s17 offen offset:3072
    s_waitcnt vmcnt(3)
    v_mfma_f32_16x16x32_bf16 v[184:187], v[200:203], v[160:163], v[184:187]
    v_mfma_f32_16x16x32_bf16 v[188:191], v[200:203], v[176:179], v[188:191]
    s_waitcnt vmcnt(2)
    v_mfma_f32_16x16x32_bf16 v[192:195], v[204:207], v[160:163], v[192:195]
    v_mfma_f32_16x16x32_bf16 v[196:199], v[204:207], v[176:179], v[196:199]
    s_waitcnt vmcnt(1)
    v_mfma_f32_16x16x32_bf16 v[184:187], v[208:211], v[164:167], v[184:187]
    v_mfma_f32_16x16x32_bf16 v[188:191], v[208:211], v[180:183], v[188:191]
    s_waitcnt vmcnt(0)
    v_mfma_f32_16x16x32_bf16 v[192:195], v[212:215], v[164:167], v[192:195]
    v_mfma_f32_16x16x32_bf16 v[196:199], v[212:215], v[180:183], v[196:199]
    s_nop 3
    v_max3_f32 v16, v16, v184, v185
    v_max3_f32 v16, v16, v186, v187
    v_max3_f32 v17, v17, v188, v189
    v_max3_f32 v17, v17, v190, v191
    v_max3_f32 v16, v16, v192, v193
    v_max3_f32 v16, v16, v194, v195
    v_max3_f32 v17, v17, v196, v197
    v_max3_f32 v17, v17, v198, v199
    s_add_u32 s16, s16, 8192
    s_cmp_lt_u32 s16, 0x20000
    s_cbranch_scc1 adaLN_cond__sliding_block_cached__moe_arch_mod__prompt_kernel_fixBm
    v_mov_b32 v18, v16
    v_mov_b32 v19, v17
    s_nop 0
    v_permlane16_swap_b32 v16, v18
    v_permlane16_swap_b32 v17, v19
    v_max_f32 v16, v16, v18
    v_max_f32 v17, v17, v19
    v_mov_b32 v18, v16
    v_mov_b32 v19, v17
    s_nop 0
    v_permlane32_swap_b32 v16, v18
    v_permlane32_swap_b32 v17, v19
    v_max_f32 v16, v16, v18
    v_max_f32 v17, v17, v19
    v_sub_f32 v216, 0, v16
    v_sub_f32 v217, 0, v16
    v_sub_f32 v218, 0, v16
    v_sub_f32 v219, 0, v16
    v_sub_f32 v220, 0, v17
    v_sub_f32 v221, 0, v17
    v_sub_f32 v222, 0, v17
    v_sub_f32 v223, 0, v17
    s_mov_b32 s17, 0x0
    buffer_load_dwordx4 v[200:203], v8, s[8:11], s17 offen offset:0
    buffer_load_dwordx4 v[204:207], v8, s[8:11], s17 offen offset:1024
    buffer_load_dwordx4 v[208:211], v8, s[8:11], s17 offen offset:2048
    buffer_load_dwordx4 v[212:215], v8, s[8:11], s17 offen offset:3072
    s_waitcnt vmcnt(3)
    v_mfma_f32_16x16x32_bf16 v[184:187], v[200:203], v[152:155], v[216:219]
    v_mfma_f32_16x16x32_bf16 v[188:191], v[200:203], v[168:171], v[220:223]
    s_waitcnt vmcnt(2)
    v_mfma_f32_16x16x32_bf16 v[192:195], v[204:207], v[152:155], v[216:219]
    v_mfma_f32_16x16x32_bf16 v[196:199], v[204:207], v[168:171], v[220:223]
    s_waitcnt vmcnt(1)
    v_mfma_f32_16x16x32_bf16 v[184:187], v[208:211], v[156:159], v[184:187]
    v_mfma_f32_16x16x32_bf16 v[188:191], v[208:211], v[172:175], v[188:191]
    s_waitcnt vmcnt(0)
    v_mfma_f32_16x16x32_bf16 v[192:195], v[212:215], v[156:159], v[192:195]
    v_mfma_f32_16x16x32_bf16 v[196:199], v[212:215], v[172:175], v[196:199]
    s_mov_b32 s17, 0x1000
    buffer_load_dwordx4 v[200:203], v8, s[8:11], s17 offen offset:0
    buffer_load_dwordx4 v[204:207], v8, s[8:11], s17 offen offset:1024
    buffer_load_dwordx4 v[208:211], v8, s[8:11], s17 offen offset:2048
    buffer_load_dwordx4 v[212:215], v8, s[8:11], s17 offen offset:3072
    s_waitcnt vmcnt(3)
    v_mfma_f32_16x16x32_bf16 v[184:187], v[200:203], v[160:163], v[184:187]
    v_mfma_f32_16x16x32_bf16 v[188:191], v[200:203], v[176:179], v[188:191]
    s_waitcnt vmcnt(2)
    v_mfma_f32_16x16x32_bf16 v[192:195], v[204:207], v[160:163], v[192:195]
    v_mfma_f32_16x16x32_bf16 v[196:199], v[204:207], v[176:179], v[196:199]
    s_waitcnt vmcnt(1)
    v_mfma_f32_16x16x32_bf16 v[184:187], v[208:211], v[164:167], v[184:187]
    v_mfma_f32_16x16x32_bf16 v[188:191], v[208:211], v[180:183], v[188:191]
    s_waitcnt vmcnt(0)
    v_mfma_f32_16x16x32_bf16 v[192:195], v[212:215], v[164:167], v[192:195]
    v_mfma_f32_16x16x32_bf16 v[196:199], v[212:215], v[180:183], v[196:199]
    s_nop 3
    v_exp_f32 v184, v184
    v_exp_f32 v185, v185
    s_nop 0
    v_add_f32 v9, v184, v185
    v_cvt_pk_bf16_f32 v24, v184, v185
    v_exp_f32 v186, v186
    v_exp_f32 v187, v187
    v_add_f32 v9, v9, v186
    v_add_f32 v9, v9, v187
    v_cvt_pk_bf16_f32 v25, v186, v187
    v_exp_f32 v188, v188
    v_exp_f32 v189, v189
    s_nop 0
    v_add_f32 v10, v188, v189
    v_cvt_pk_bf16_f32 v28, v188, v189
    v_exp_f32 v190, v190
    v_exp_f32 v191, v191
    v_add_f32 v10, v10, v190
    v_add_f32 v10, v10, v191
    v_cvt_pk_bf16_f32 v29, v190, v191
    v_exp_f32 v192, v192
    v_exp_f32 v193, v193
    v_add_f32 v9, v9, v192
    v_add_f32 v9, v9, v193
    v_cvt_pk_bf16_f32 v26, v192, v193
    v_exp_f32 v194, v194
    v_exp_f32 v195, v195
    v_add_f32 v9, v9, v194
    v_add_f32 v9, v9, v195
    v_cvt_pk_bf16_f32 v27, v194, v195
    v_exp_f32 v196, v196
    v_exp_f32 v197, v197
    v_add_f32 v10, v10, v196
    v_add_f32 v10, v10, v197
    v_cvt_pk_bf16_f32 v30, v196, v197
    v_exp_f32 v198, v198
    v_exp_f32 v199, v199
    v_add_f32 v10, v10, v198
    v_add_f32 v10, v10, v199
    v_cvt_pk_bf16_f32 v31, v198, v199
    s_mov_b32 s17, 0x2000
    buffer_load_dwordx4 v[200:203], v8, s[8:11], s17 offen offset:0
    buffer_load_dwordx4 v[204:207], v8, s[8:11], s17 offen offset:1024
    buffer_load_dwordx4 v[208:211], v8, s[8:11], s17 offen offset:2048
    buffer_load_dwordx4 v[212:215], v8, s[8:11], s17 offen offset:3072
    s_waitcnt vmcnt(3)
    v_mfma_f32_16x16x32_bf16 v[184:187], v[200:203], v[152:155], v[216:219]
    v_mfma_f32_16x16x32_bf16 v[188:191], v[200:203], v[168:171], v[220:223]
    s_waitcnt vmcnt(2)
    v_mfma_f32_16x16x32_bf16 v[192:195], v[204:207], v[152:155], v[216:219]
    v_mfma_f32_16x16x32_bf16 v[196:199], v[204:207], v[168:171], v[220:223]
    s_waitcnt vmcnt(1)
    v_mfma_f32_16x16x32_bf16 v[184:187], v[208:211], v[156:159], v[184:187]
    v_mfma_f32_16x16x32_bf16 v[188:191], v[208:211], v[172:175], v[188:191]
    s_waitcnt vmcnt(0)
    v_mfma_f32_16x16x32_bf16 v[192:195], v[212:215], v[156:159], v[192:195]
    v_mfma_f32_16x16x32_bf16 v[196:199], v[212:215], v[172:175], v[196:199]
    s_mov_b32 s17, 0x3000
    buffer_load_dwordx4 v[200:203], v8, s[8:11], s17 offen offset:0
    buffer_load_dwordx4 v[204:207], v8, s[8:11], s17 offen offset:1024
    buffer_load_dwordx4 v[208:211], v8, s[8:11], s17 offen offset:2048
    buffer_load_dwordx4 v[212:215], v8, s[8:11], s17 offen offset:3072
    s_waitcnt vmcnt(3)
    v_mfma_f32_16x16x32_bf16 v[184:187], v[200:203], v[160:163], v[184:187]
    v_mfma_f32_16x16x32_bf16 v[188:191], v[200:203], v[176:179], v[188:191]
    s_waitcnt vmcnt(2)
    v_mfma_f32_16x16x32_bf16 v[192:195], v[204:207], v[160:163], v[192:195]
    v_mfma_f32_16x16x32_bf16 v[196:199], v[204:207], v[176:179], v[196:199]
    s_waitcnt vmcnt(1)
    v_mfma_f32_16x16x32_bf16 v[184:187], v[208:211], v[164:167], v[184:187]
    v_mfma_f32_16x16x32_bf16 v[188:191], v[208:211], v[180:183], v[188:191]
    s_waitcnt vmcnt(0)
    v_mfma_f32_16x16x32_bf16 v[192:195], v[212:215], v[164:167], v[192:195]
    v_mfma_f32_16x16x32_bf16 v[196:199], v[212:215], v[180:183], v[196:199]
    s_nop 3
    v_exp_f32 v184, v184
    v_exp_f32 v185, v185
    v_add_f32 v9, v9, v184
    v_add_f32 v9, v9, v185
    v_cvt_pk_bf16_f32 v32, v184, v185
    v_exp_f32 v186, v186
    v_exp_f32 v187, v187
    v_add_f32 v9, v9, v186
    v_add_f32 v9, v9, v187
    v_cvt_pk_bf16_f32 v33, v186, v187
    v_exp_f32 v188, v188
    v_exp_f32 v189, v189
    v_add_f32 v10, v10, v188
    v_add_f32 v10, v10, v189
    v_cvt_pk_bf16_f32 v36, v188, v189
    v_exp_f32 v190, v190
    v_exp_f32 v191, v191
    v_add_f32 v10, v10, v190
    v_add_f32 v10, v10, v191
    v_cvt_pk_bf16_f32 v37, v190, v191
    v_exp_f32 v192, v192
    v_exp_f32 v193, v193
    v_add_f32 v9, v9, v192
    v_add_f32 v9, v9, v193
    v_cvt_pk_bf16_f32 v34, v192, v193
    v_exp_f32 v194, v194
    v_exp_f32 v195, v195
    v_add_f32 v9, v9, v194
    v_add_f32 v9, v9, v195
    v_cvt_pk_bf16_f32 v35, v194, v195
    v_exp_f32 v196, v196
    v_exp_f32 v197, v197
    v_add_f32 v10, v10, v196
    v_add_f32 v10, v10, v197
    v_cvt_pk_bf16_f32 v38, v196, v197
    v_exp_f32 v198, v198
    v_exp_f32 v199, v199
    v_add_f32 v10, v10, v198
    v_add_f32 v10, v10, v199
    v_cvt_pk_bf16_f32 v39, v198, v199
    s_mov_b32 s17, 0x4000
    buffer_load_dwordx4 v[200:203], v8, s[8:11], s17 offen offset:0
    buffer_load_dwordx4 v[204:207], v8, s[8:11], s17 offen offset:1024
    buffer_load_dwordx4 v[208:211], v8, s[8:11], s17 offen offset:2048
    buffer_load_dwordx4 v[212:215], v8, s[8:11], s17 offen offset:3072
    s_waitcnt vmcnt(3)
    v_mfma_f32_16x16x32_bf16 v[184:187], v[200:203], v[152:155], v[216:219]
    v_mfma_f32_16x16x32_bf16 v[188:191], v[200:203], v[168:171], v[220:223]
    s_waitcnt vmcnt(2)
    v_mfma_f32_16x16x32_bf16 v[192:195], v[204:207], v[152:155], v[216:219]
    v_mfma_f32_16x16x32_bf16 v[196:199], v[204:207], v[168:171], v[220:223]
    s_waitcnt vmcnt(1)
    v_mfma_f32_16x16x32_bf16 v[184:187], v[208:211], v[156:159], v[184:187]
    v_mfma_f32_16x16x32_bf16 v[188:191], v[208:211], v[172:175], v[188:191]
    s_waitcnt vmcnt(0)
    v_mfma_f32_16x16x32_bf16 v[192:195], v[212:215], v[156:159], v[192:195]
    v_mfma_f32_16x16x32_bf16 v[196:199], v[212:215], v[172:175], v[196:199]
    s_mov_b32 s17, 0x5000
    buffer_load_dwordx4 v[200:203], v8, s[8:11], s17 offen offset:0
    buffer_load_dwordx4 v[204:207], v8, s[8:11], s17 offen offset:1024
    buffer_load_dwordx4 v[208:211], v8, s[8:11], s17 offen offset:2048
    buffer_load_dwordx4 v[212:215], v8, s[8:11], s17 offen offset:3072
    s_waitcnt vmcnt(3)
    v_mfma_f32_16x16x32_bf16 v[184:187], v[200:203], v[160:163], v[184:187]
    v_mfma_f32_16x16x32_bf16 v[188:191], v[200:203], v[176:179], v[188:191]
    s_waitcnt vmcnt(2)
    v_mfma_f32_16x16x32_bf16 v[192:195], v[204:207], v[160:163], v[192:195]
    v_mfma_f32_16x16x32_bf16 v[196:199], v[204:207], v[176:179], v[196:199]
    s_waitcnt vmcnt(1)
    v_mfma_f32_16x16x32_bf16 v[184:187], v[208:211], v[164:167], v[184:187]
    v_mfma_f32_16x16x32_bf16 v[188:191], v[208:211], v[180:183], v[188:191]
    s_waitcnt vmcnt(0)
    v_mfma_f32_16x16x32_bf16 v[192:195], v[212:215], v[164:167], v[192:195]
    v_mfma_f32_16x16x32_bf16 v[196:199], v[212:215], v[180:183], v[196:199]
    s_nop 3
    v_exp_f32 v184, v184
    v_exp_f32 v185, v185
    v_add_f32 v9, v9, v184
    v_add_f32 v9, v9, v185
    v_cvt_pk_bf16_f32 v40, v184, v185
    v_exp_f32 v186, v186
    v_exp_f32 v187, v187
    v_add_f32 v9, v9, v186
    v_add_f32 v9, v9, v187
    v_cvt_pk_bf16_f32 v41, v186, v187
    v_exp_f32 v188, v188
    v_exp_f32 v189, v189
    v_add_f32 v10, v10, v188
    v_add_f32 v10, v10, v189
    v_cvt_pk_bf16_f32 v44, v188, v189
    v_exp_f32 v190, v190
    v_exp_f32 v191, v191
    v_add_f32 v10, v10, v190
    v_add_f32 v10, v10, v191
    v_cvt_pk_bf16_f32 v45, v190, v191
    v_exp_f32 v192, v192
    v_exp_f32 v193, v193
    v_add_f32 v9, v9, v192
    v_add_f32 v9, v9, v193
    v_cvt_pk_bf16_f32 v42, v192, v193
    v_exp_f32 v194, v194
    v_exp_f32 v195, v195
    v_add_f32 v9, v9, v194
    v_add_f32 v9, v9, v195
    v_cvt_pk_bf16_f32 v43, v194, v195
    v_exp_f32 v196, v196
    v_exp_f32 v197, v197
    v_add_f32 v10, v10, v196
    v_add_f32 v10, v10, v197
    v_cvt_pk_bf16_f32 v46, v196, v197
    v_exp_f32 v198, v198
    v_exp_f32 v199, v199
    v_add_f32 v10, v10, v198
    v_add_f32 v10, v10, v199
    v_cvt_pk_bf16_f32 v47, v198, v199
    s_mov_b32 s17, 0x6000
    buffer_load_dwordx4 v[200:203], v8, s[8:11], s17 offen offset:0
    buffer_load_dwordx4 v[204:207], v8, s[8:11], s17 offen offset:1024
    buffer_load_dwordx4 v[208:211], v8, s[8:11], s17 offen offset:2048
    buffer_load_dwordx4 v[212:215], v8, s[8:11], s17 offen offset:3072
    s_waitcnt vmcnt(3)
    v_mfma_f32_16x16x32_bf16 v[184:187], v[200:203], v[152:155], v[216:219]
    v_mfma_f32_16x16x32_bf16 v[188:191], v[200:203], v[168:171], v[220:223]
    s_waitcnt vmcnt(2)
    v_mfma_f32_16x16x32_bf16 v[192:195], v[204:207], v[152:155], v[216:219]
    v_mfma_f32_16x16x32_bf16 v[196:199], v[204:207], v[168:171], v[220:223]
    s_waitcnt vmcnt(1)
    v_mfma_f32_16x16x32_bf16 v[184:187], v[208:211], v[156:159], v[184:187]
    v_mfma_f32_16x16x32_bf16 v[188:191], v[208:211], v[172:175], v[188:191]
    s_waitcnt vmcnt(0)
    v_mfma_f32_16x16x32_bf16 v[192:195], v[212:215], v[156:159], v[192:195]
    v_mfma_f32_16x16x32_bf16 v[196:199], v[212:215], v[172:175], v[196:199]
    s_mov_b32 s17, 0x7000
    buffer_load_dwordx4 v[200:203], v8, s[8:11], s17 offen offset:0
    buffer_load_dwordx4 v[204:207], v8, s[8:11], s17 offen offset:1024
    buffer_load_dwordx4 v[208:211], v8, s[8:11], s17 offen offset:2048
    buffer_load_dwordx4 v[212:215], v8, s[8:11], s17 offen offset:3072
    s_waitcnt vmcnt(3)
    v_mfma_f32_16x16x32_bf16 v[184:187], v[200:203], v[160:163], v[184:187]
    v_mfma_f32_16x16x32_bf16 v[188:191], v[200:203], v[176:179], v[188:191]
    s_waitcnt vmcnt(2)
    v_mfma_f32_16x16x32_bf16 v[192:195], v[204:207], v[160:163], v[192:195]
    v_mfma_f32_16x16x32_bf16 v[196:199], v[204:207], v[176:179], v[196:199]
    s_waitcnt vmcnt(1)
    v_mfma_f32_16x16x32_bf16 v[184:187], v[208:211], v[164:167], v[184:187]
    v_mfma_f32_16x16x32_bf16 v[188:191], v[208:211], v[180:183], v[188:191]
    s_waitcnt vmcnt(0)
    v_mfma_f32_16x16x32_bf16 v[192:195], v[212:215], v[164:167], v[192:195]
    v_mfma_f32_16x16x32_bf16 v[196:199], v[212:215], v[180:183], v[196:199]
    s_nop 3
    v_exp_f32 v184, v184
    v_exp_f32 v185, v185
    v_add_f32 v9, v9, v184
    v_add_f32 v9, v9, v185
    v_cvt_pk_bf16_f32 v48, v184, v185
    v_exp_f32 v186, v186
    v_exp_f32 v187, v187
    v_add_f32 v9, v9, v186
    v_add_f32 v9, v9, v187
    v_cvt_pk_bf16_f32 v49, v186, v187
    v_exp_f32 v188, v188
    v_exp_f32 v189, v189
    v_add_f32 v10, v10, v188
    v_add_f32 v10, v10, v189
    v_cvt_pk_bf16_f32 v52, v188, v189
    v_exp_f32 v190, v190
    v_exp_f32 v191, v191
    v_add_f32 v10, v10, v190
    v_add_f32 v10, v10, v191
    v_cvt_pk_bf16_f32 v53, v190, v191
    v_exp_f32 v192, v192
    v_exp_f32 v193, v193
    v_add_f32 v9, v9, v192
    v_add_f32 v9, v9, v193
    v_cvt_pk_bf16_f32 v50, v192, v193
    v_exp_f32 v194, v194
    v_exp_f32 v195, v195
    v_add_f32 v9, v9, v194
    v_add_f32 v9, v9, v195
    v_cvt_pk_bf16_f32 v51, v194, v195
    v_exp_f32 v196, v196
    v_exp_f32 v197, v197
    v_add_f32 v10, v10, v196
    v_add_f32 v10, v10, v197
    v_cvt_pk_bf16_f32 v54, v196, v197
    v_exp_f32 v198, v198
    v_exp_f32 v199, v199
    v_add_f32 v10, v10, v198
    v_add_f32 v10, v10, v199
    v_cvt_pk_bf16_f32 v55, v198, v199
    s_mov_b32 s17, 0x8000
    buffer_load_dwordx4 v[200:203], v8, s[8:11], s17 offen offset:0
    buffer_load_dwordx4 v[204:207], v8, s[8:11], s17 offen offset:1024
    buffer_load_dwordx4 v[208:211], v8, s[8:11], s17 offen offset:2048
    buffer_load_dwordx4 v[212:215], v8, s[8:11], s17 offen offset:3072
    s_waitcnt vmcnt(3)
    v_mfma_f32_16x16x32_bf16 v[184:187], v[200:203], v[152:155], v[216:219]
    v_mfma_f32_16x16x32_bf16 v[188:191], v[200:203], v[168:171], v[220:223]
    s_waitcnt vmcnt(2)
    v_mfma_f32_16x16x32_bf16 v[192:195], v[204:207], v[152:155], v[216:219]
    v_mfma_f32_16x16x32_bf16 v[196:199], v[204:207], v[168:171], v[220:223]
    s_waitcnt vmcnt(1)
    v_mfma_f32_16x16x32_bf16 v[184:187], v[208:211], v[156:159], v[184:187]
    v_mfma_f32_16x16x32_bf16 v[188:191], v[208:211], v[172:175], v[188:191]
    s_waitcnt vmcnt(0)
    v_mfma_f32_16x16x32_bf16 v[192:195], v[212:215], v[156:159], v[192:195]
    v_mfma_f32_16x16x32_bf16 v[196:199], v[212:215], v[172:175], v[196:199]
    s_mov_b32 s17, 0x9000
    buffer_load_dwordx4 v[200:203], v8, s[8:11], s17 offen offset:0
    buffer_load_dwordx4 v[204:207], v8, s[8:11], s17 offen offset:1024
    buffer_load_dwordx4 v[208:211], v8, s[8:11], s17 offen offset:2048
    buffer_load_dwordx4 v[212:215], v8, s[8:11], s17 offen offset:3072
    s_waitcnt vmcnt(3)
    v_mfma_f32_16x16x32_bf16 v[184:187], v[200:203], v[160:163], v[184:187]
    v_mfma_f32_16x16x32_bf16 v[188:191], v[200:203], v[176:179], v[188:191]
    s_waitcnt vmcnt(2)
    v_mfma_f32_16x16x32_bf16 v[192:195], v[204:207], v[160:163], v[192:195]
    v_mfma_f32_16x16x32_bf16 v[196:199], v[204:207], v[176:179], v[196:199]
    s_waitcnt vmcnt(1)
    v_mfma_f32_16x16x32_bf16 v[184:187], v[208:211], v[164:167], v[184:187]
    v_mfma_f32_16x16x32_bf16 v[188:191], v[208:211], v[180:183], v[188:191]
    s_waitcnt vmcnt(0)
    v_mfma_f32_16x16x32_bf16 v[192:195], v[212:215], v[164:167], v[192:195]
    v_mfma_f32_16x16x32_bf16 v[196:199], v[212:215], v[180:183], v[196:199]
    s_nop 3
    v_exp_f32 v184, v184
    v_exp_f32 v185, v185
    v_add_f32 v9, v9, v184
    v_add_f32 v9, v9, v185
    v_cvt_pk_bf16_f32 v56, v184, v185
    v_exp_f32 v186, v186
    v_exp_f32 v187, v187
    v_add_f32 v9, v9, v186
    v_add_f32 v9, v9, v187
    v_cvt_pk_bf16_f32 v57, v186, v187
    v_exp_f32 v188, v188
    v_exp_f32 v189, v189
    v_add_f32 v10, v10, v188
    v_add_f32 v10, v10, v189
    v_cvt_pk_bf16_f32 v60, v188, v189
    v_exp_f32 v190, v190
    v_exp_f32 v191, v191
    v_add_f32 v10, v10, v190
    v_add_f32 v10, v10, v191
    v_cvt_pk_bf16_f32 v61, v190, v191
    v_exp_f32 v192, v192
    v_exp_f32 v193, v193
    v_add_f32 v9, v9, v192
    v_add_f32 v9, v9, v193
    v_cvt_pk_bf16_f32 v58, v192, v193
    v_exp_f32 v194, v194
    v_exp_f32 v195, v195
    v_add_f32 v9, v9, v194
    v_add_f32 v9, v9, v195
    v_cvt_pk_bf16_f32 v59, v194, v195
    v_exp_f32 v196, v196
    v_exp_f32 v197, v197
    v_add_f32 v10, v10, v196
    v_add_f32 v10, v10, v197
    v_cvt_pk_bf16_f32 v62, v196, v197
    v_exp_f32 v198, v198
    v_exp_f32 v199, v199
    v_add_f32 v10, v10, v198
    v_add_f32 v10, v10, v199
    v_cvt_pk_bf16_f32 v63, v198, v199
    s_mov_b32 s17, 0xa000
    buffer_load_dwordx4 v[200:203], v8, s[8:11], s17 offen offset:0
    buffer_load_dwordx4 v[204:207], v8, s[8:11], s17 offen offset:1024
    buffer_load_dwordx4 v[208:211], v8, s[8:11], s17 offen offset:2048
    buffer_load_dwordx4 v[212:215], v8, s[8:11], s17 offen offset:3072
    s_waitcnt vmcnt(3)
    v_mfma_f32_16x16x32_bf16 v[184:187], v[200:203], v[152:155], v[216:219]
    v_mfma_f32_16x16x32_bf16 v[188:191], v[200:203], v[168:171], v[220:223]
    s_waitcnt vmcnt(2)
    v_mfma_f32_16x16x32_bf16 v[192:195], v[204:207], v[152:155], v[216:219]
    v_mfma_f32_16x16x32_bf16 v[196:199], v[204:207], v[168:171], v[220:223]
    s_waitcnt vmcnt(1)
    v_mfma_f32_16x16x32_bf16 v[184:187], v[208:211], v[156:159], v[184:187]
    v_mfma_f32_16x16x32_bf16 v[188:191], v[208:211], v[172:175], v[188:191]
    s_waitcnt vmcnt(0)
    v_mfma_f32_16x16x32_bf16 v[192:195], v[212:215], v[156:159], v[192:195]
    v_mfma_f32_16x16x32_bf16 v[196:199], v[212:215], v[172:175], v[196:199]
    s_mov_b32 s17, 0xb000
    buffer_load_dwordx4 v[200:203], v8, s[8:11], s17 offen offset:0
    buffer_load_dwordx4 v[204:207], v8, s[8:11], s17 offen offset:1024
    buffer_load_dwordx4 v[208:211], v8, s[8:11], s17 offen offset:2048
    buffer_load_dwordx4 v[212:215], v8, s[8:11], s17 offen offset:3072
    s_waitcnt vmcnt(3)
    v_mfma_f32_16x16x32_bf16 v[184:187], v[200:203], v[160:163], v[184:187]
    v_mfma_f32_16x16x32_bf16 v[188:191], v[200:203], v[176:179], v[188:191]
    s_waitcnt vmcnt(2)
    v_mfma_f32_16x16x32_bf16 v[192:195], v[204:207], v[160:163], v[192:195]
    v_mfma_f32_16x16x32_bf16 v[196:199], v[204:207], v[176:179], v[196:199]
    s_waitcnt vmcnt(1)
    v_mfma_f32_16x16x32_bf16 v[184:187], v[208:211], v[164:167], v[184:187]
    v_mfma_f32_16x16x32_bf16 v[188:191], v[208:211], v[180:183], v[188:191]
    s_waitcnt vmcnt(0)
    v_mfma_f32_16x16x32_bf16 v[192:195], v[212:215], v[164:167], v[192:195]
    v_mfma_f32_16x16x32_bf16 v[196:199], v[212:215], v[180:183], v[196:199]
    s_nop 3
    v_exp_f32 v184, v184
    v_exp_f32 v185, v185
    v_add_f32 v9, v9, v184
    v_add_f32 v9, v9, v185
    v_cvt_pk_bf16_f32 v64, v184, v185
    v_exp_f32 v186, v186
    v_exp_f32 v187, v187
    v_add_f32 v9, v9, v186
    v_add_f32 v9, v9, v187
    v_cvt_pk_bf16_f32 v65, v186, v187
    v_exp_f32 v188, v188
    v_exp_f32 v189, v189
    v_add_f32 v10, v10, v188
    v_add_f32 v10, v10, v189
    v_cvt_pk_bf16_f32 v68, v188, v189
    v_exp_f32 v190, v190
    v_exp_f32 v191, v191
    v_add_f32 v10, v10, v190
    v_add_f32 v10, v10, v191
    v_cvt_pk_bf16_f32 v69, v190, v191
    v_exp_f32 v192, v192
    v_exp_f32 v193, v193
    v_add_f32 v9, v9, v192
    v_add_f32 v9, v9, v193
    v_cvt_pk_bf16_f32 v66, v192, v193
    v_exp_f32 v194, v194
    v_exp_f32 v195, v195
    v_add_f32 v9, v9, v194
    v_add_f32 v9, v9, v195
    v_cvt_pk_bf16_f32 v67, v194, v195
    v_exp_f32 v196, v196
    v_exp_f32 v197, v197
    v_add_f32 v10, v10, v196
    v_add_f32 v10, v10, v197
    v_cvt_pk_bf16_f32 v70, v196, v197
    v_exp_f32 v198, v198
    v_exp_f32 v199, v199
    v_add_f32 v10, v10, v198
    v_add_f32 v10, v10, v199
    v_cvt_pk_bf16_f32 v71, v198, v199
    s_mov_b32 s17, 0xc000
    buffer_load_dwordx4 v[200:203], v8, s[8:11], s17 offen offset:0
    buffer_load_dwordx4 v[204:207], v8, s[8:11], s17 offen offset:1024
    buffer_load_dwordx4 v[208:211], v8, s[8:11], s17 offen offset:2048
    buffer_load_dwordx4 v[212:215], v8, s[8:11], s17 offen offset:3072
    s_waitcnt vmcnt(3)
    v_mfma_f32_16x16x32_bf16 v[184:187], v[200:203], v[152:155], v[216:219]
    v_mfma_f32_16x16x32_bf16 v[188:191], v[200:203], v[168:171], v[220:223]
    s_waitcnt vmcnt(2)
    v_mfma_f32_16x16x32_bf16 v[192:195], v[204:207], v[152:155], v[216:219]
    v_mfma_f32_16x16x32_bf16 v[196:199], v[204:207], v[168:171], v[220:223]
    s_waitcnt vmcnt(1)
    v_mfma_f32_16x16x32_bf16 v[184:187], v[208:211], v[156:159], v[184:187]
    v_mfma_f32_16x16x32_bf16 v[188:191], v[208:211], v[172:175], v[188:191]
    s_waitcnt vmcnt(0)
    v_mfma_f32_16x16x32_bf16 v[192:195], v[212:215], v[156:159], v[192:195]
    v_mfma_f32_16x16x32_bf16 v[196:199], v[212:215], v[172:175], v[196:199]
    s_mov_b32 s17, 0xd000
    buffer_load_dwordx4 v[200:203], v8, s[8:11], s17 offen offset:0
    buffer_load_dwordx4 v[204:207], v8, s[8:11], s17 offen offset:1024
    buffer_load_dwordx4 v[208:211], v8, s[8:11], s17 offen offset:2048
    buffer_load_dwordx4 v[212:215], v8, s[8:11], s17 offen offset:3072
    s_waitcnt vmcnt(3)
    v_mfma_f32_16x16x32_bf16 v[184:187], v[200:203], v[160:163], v[184:187]
    v_mfma_f32_16x16x32_bf16 v[188:191], v[200:203], v[176:179], v[188:191]
    s_waitcnt vmcnt(2)
    v_mfma_f32_16x16x32_bf16 v[192:195], v[204:207], v[160:163], v[192:195]
    v_mfma_f32_16x16x32_bf16 v[196:199], v[204:207], v[176:179], v[196:199]
    s_waitcnt vmcnt(1)
    v_mfma_f32_16x16x32_bf16 v[184:187], v[208:211], v[164:167], v[184:187]
    v_mfma_f32_16x16x32_bf16 v[188:191], v[208:211], v[180:183], v[188:191]
    s_waitcnt vmcnt(0)
    v_mfma_f32_16x16x32_bf16 v[192:195], v[212:215], v[164:167], v[192:195]
    v_mfma_f32_16x16x32_bf16 v[196:199], v[212:215], v[180:183], v[196:199]
    s_nop 3
    v_exp_f32 v184, v184
    v_exp_f32 v185, v185
    v_add_f32 v9, v9, v184
    v_add_f32 v9, v9, v185
    v_cvt_pk_bf16_f32 v72, v184, v185
    v_exp_f32 v186, v186
    v_exp_f32 v187, v187
    v_add_f32 v9, v9, v186
    v_add_f32 v9, v9, v187
    v_cvt_pk_bf16_f32 v73, v186, v187
    v_exp_f32 v188, v188
    v_exp_f32 v189, v189
    v_add_f32 v10, v10, v188
    v_add_f32 v10, v10, v189
    v_cvt_pk_bf16_f32 v76, v188, v189
    v_exp_f32 v190, v190
    v_exp_f32 v191, v191
    v_add_f32 v10, v10, v190
    v_add_f32 v10, v10, v191
    v_cvt_pk_bf16_f32 v77, v190, v191
    v_exp_f32 v192, v192
    v_exp_f32 v193, v193
    v_add_f32 v9, v9, v192
    v_add_f32 v9, v9, v193
    v_cvt_pk_bf16_f32 v74, v192, v193
    v_exp_f32 v194, v194
    v_exp_f32 v195, v195
    v_add_f32 v9, v9, v194
    v_add_f32 v9, v9, v195
    v_cvt_pk_bf16_f32 v75, v194, v195
    v_exp_f32 v196, v196
    v_exp_f32 v197, v197
    v_add_f32 v10, v10, v196
    v_add_f32 v10, v10, v197
    v_cvt_pk_bf16_f32 v78, v196, v197
    v_exp_f32 v198, v198
    v_exp_f32 v199, v199
    v_add_f32 v10, v10, v198
    v_add_f32 v10, v10, v199
    v_cvt_pk_bf16_f32 v79, v198, v199
    s_mov_b32 s17, 0xe000
    buffer_load_dwordx4 v[200:203], v8, s[8:11], s17 offen offset:0
    buffer_load_dwordx4 v[204:207], v8, s[8:11], s17 offen offset:1024
    buffer_load_dwordx4 v[208:211], v8, s[8:11], s17 offen offset:2048
    buffer_load_dwordx4 v[212:215], v8, s[8:11], s17 offen offset:3072
    s_waitcnt vmcnt(3)
    v_mfma_f32_16x16x32_bf16 v[184:187], v[200:203], v[152:155], v[216:219]
    v_mfma_f32_16x16x32_bf16 v[188:191], v[200:203], v[168:171], v[220:223]
    s_waitcnt vmcnt(2)
    v_mfma_f32_16x16x32_bf16 v[192:195], v[204:207], v[152:155], v[216:219]
    v_mfma_f32_16x16x32_bf16 v[196:199], v[204:207], v[168:171], v[220:223]
    s_waitcnt vmcnt(1)
    v_mfma_f32_16x16x32_bf16 v[184:187], v[208:211], v[156:159], v[184:187]
    v_mfma_f32_16x16x32_bf16 v[188:191], v[208:211], v[172:175], v[188:191]
    s_waitcnt vmcnt(0)
    v_mfma_f32_16x16x32_bf16 v[192:195], v[212:215], v[156:159], v[192:195]
    v_mfma_f32_16x16x32_bf16 v[196:199], v[212:215], v[172:175], v[196:199]
    s_mov_b32 s17, 0xf000
    buffer_load_dwordx4 v[200:203], v8, s[8:11], s17 offen offset:0
    buffer_load_dwordx4 v[204:207], v8, s[8:11], s17 offen offset:1024
    buffer_load_dwordx4 v[208:211], v8, s[8:11], s17 offen offset:2048
    buffer_load_dwordx4 v[212:215], v8, s[8:11], s17 offen offset:3072
    s_waitcnt vmcnt(3)
    v_mfma_f32_16x16x32_bf16 v[184:187], v[200:203], v[160:163], v[184:187]
    v_mfma_f32_16x16x32_bf16 v[188:191], v[200:203], v[176:179], v[188:191]
    s_waitcnt vmcnt(2)
    v_mfma_f32_16x16x32_bf16 v[192:195], v[204:207], v[160:163], v[192:195]
    v_mfma_f32_16x16x32_bf16 v[196:199], v[204:207], v[176:179], v[196:199]
    s_waitcnt vmcnt(1)
    v_mfma_f32_16x16x32_bf16 v[184:187], v[208:211], v[164:167], v[184:187]
    v_mfma_f32_16x16x32_bf16 v[188:191], v[208:211], v[180:183], v[188:191]
    s_waitcnt vmcnt(0)
    v_mfma_f32_16x16x32_bf16 v[192:195], v[212:215], v[164:167], v[192:195]
    v_mfma_f32_16x16x32_bf16 v[196:199], v[212:215], v[180:183], v[196:199]
    s_nop 3
    v_exp_f32 v184, v184
    v_exp_f32 v185, v185
    v_add_f32 v9, v9, v184
    v_add_f32 v9, v9, v185
    v_cvt_pk_bf16_f32 v80, v184, v185
    v_exp_f32 v186, v186
    v_exp_f32 v187, v187
    v_add_f32 v9, v9, v186
    v_add_f32 v9, v9, v187
    v_cvt_pk_bf16_f32 v81, v186, v187
    v_exp_f32 v188, v188
    v_exp_f32 v189, v189
    v_add_f32 v10, v10, v188
    v_add_f32 v10, v10, v189
    v_cvt_pk_bf16_f32 v84, v188, v189
    v_exp_f32 v190, v190
    v_exp_f32 v191, v191
    v_add_f32 v10, v10, v190
    v_add_f32 v10, v10, v191
    v_cvt_pk_bf16_f32 v85, v190, v191
    v_exp_f32 v192, v192
    v_exp_f32 v193, v193
    v_add_f32 v9, v9, v192
    v_add_f32 v9, v9, v193
    v_cvt_pk_bf16_f32 v82, v192, v193
    v_exp_f32 v194, v194
    v_exp_f32 v195, v195
    v_add_f32 v9, v9, v194
    v_add_f32 v9, v9, v195
    v_cvt_pk_bf16_f32 v83, v194, v195
    v_exp_f32 v196, v196
    v_exp_f32 v197, v197
    v_add_f32 v10, v10, v196
    v_add_f32 v10, v10, v197
    v_cvt_pk_bf16_f32 v86, v196, v197
    v_exp_f32 v198, v198
    v_exp_f32 v199, v199
    v_add_f32 v10, v10, v198
    v_add_f32 v10, v10, v199
    v_cvt_pk_bf16_f32 v87, v198, v199
    s_mov_b32 s17, 0x10000
    buffer_load_dwordx4 v[200:203], v8, s[8:11], s17 offen offset:0
    buffer_load_dwordx4 v[204:207], v8, s[8:11], s17 offen offset:1024
    buffer_load_dwordx4 v[208:211], v8, s[8:11], s17 offen offset:2048
    buffer_load_dwordx4 v[212:215], v8, s[8:11], s17 offen offset:3072
    s_waitcnt vmcnt(3)
    v_mfma_f32_16x16x32_bf16 v[184:187], v[200:203], v[152:155], v[216:219]
    v_mfma_f32_16x16x32_bf16 v[188:191], v[200:203], v[168:171], v[220:223]
    s_waitcnt vmcnt(2)
    v_mfma_f32_16x16x32_bf16 v[192:195], v[204:207], v[152:155], v[216:219]
    v_mfma_f32_16x16x32_bf16 v[196:199], v[204:207], v[168:171], v[220:223]
    s_waitcnt vmcnt(1)
    v_mfma_f32_16x16x32_bf16 v[184:187], v[208:211], v[156:159], v[184:187]
    v_mfma_f32_16x16x32_bf16 v[188:191], v[208:211], v[172:175], v[188:191]
    s_waitcnt vmcnt(0)
    v_mfma_f32_16x16x32_bf16 v[192:195], v[212:215], v[156:159], v[192:195]
    v_mfma_f32_16x16x32_bf16 v[196:199], v[212:215], v[172:175], v[196:199]
    s_mov_b32 s17, 0x11000
    buffer_load_dwordx4 v[200:203], v8, s[8:11], s17 offen offset:0
    buffer_load_dwordx4 v[204:207], v8, s[8:11], s17 offen offset:1024
    buffer_load_dwordx4 v[208:211], v8, s[8:11], s17 offen offset:2048
    buffer_load_dwordx4 v[212:215], v8, s[8:11], s17 offen offset:3072
    s_waitcnt vmcnt(3)
    v_mfma_f32_16x16x32_bf16 v[184:187], v[200:203], v[160:163], v[184:187]
    v_mfma_f32_16x16x32_bf16 v[188:191], v[200:203], v[176:179], v[188:191]
    s_waitcnt vmcnt(2)
    v_mfma_f32_16x16x32_bf16 v[192:195], v[204:207], v[160:163], v[192:195]
    v_mfma_f32_16x16x32_bf16 v[196:199], v[204:207], v[176:179], v[196:199]
    s_waitcnt vmcnt(1)
    v_mfma_f32_16x16x32_bf16 v[184:187], v[208:211], v[164:167], v[184:187]
    v_mfma_f32_16x16x32_bf16 v[188:191], v[208:211], v[180:183], v[188:191]
    s_waitcnt vmcnt(0)
    v_mfma_f32_16x16x32_bf16 v[192:195], v[212:215], v[164:167], v[192:195]
    v_mfma_f32_16x16x32_bf16 v[196:199], v[212:215], v[180:183], v[196:199]
    s_nop 3
    v_exp_f32 v184, v184
    v_exp_f32 v185, v185
    v_add_f32 v9, v9, v184
    v_add_f32 v9, v9, v185
    v_cvt_pk_bf16_f32 v88, v184, v185
    v_exp_f32 v186, v186
    v_exp_f32 v187, v187
    v_add_f32 v9, v9, v186
    v_add_f32 v9, v9, v187
    v_cvt_pk_bf16_f32 v89, v186, v187
    v_exp_f32 v188, v188
    v_exp_f32 v189, v189
    v_add_f32 v10, v10, v188
    v_add_f32 v10, v10, v189
    v_cvt_pk_bf16_f32 v92, v188, v189
    v_exp_f32 v190, v190
    v_exp_f32 v191, v191
    v_add_f32 v10, v10, v190
    v_add_f32 v10, v10, v191
    v_cvt_pk_bf16_f32 v93, v190, v191
    v_exp_f32 v192, v192
    v_exp_f32 v193, v193
    v_add_f32 v9, v9, v192
    v_add_f32 v9, v9, v193
    v_cvt_pk_bf16_f32 v90, v192, v193
    v_exp_f32 v194, v194
    v_exp_f32 v195, v195
    v_add_f32 v9, v9, v194
    v_add_f32 v9, v9, v195
    v_cvt_pk_bf16_f32 v91, v194, v195
    v_exp_f32 v196, v196
    v_exp_f32 v197, v197
    v_add_f32 v10, v10, v196
    v_add_f32 v10, v10, v197
    v_cvt_pk_bf16_f32 v94, v196, v197
    v_exp_f32 v198, v198
    v_exp_f32 v199, v199
    v_add_f32 v10, v10, v198
    v_add_f32 v10, v10, v199
    v_cvt_pk_bf16_f32 v95, v198, v199
    s_mov_b32 s17, 0x12000
    buffer_load_dwordx4 v[200:203], v8, s[8:11], s17 offen offset:0
    buffer_load_dwordx4 v[204:207], v8, s[8:11], s17 offen offset:1024
    buffer_load_dwordx4 v[208:211], v8, s[8:11], s17 offen offset:2048
    buffer_load_dwordx4 v[212:215], v8, s[8:11], s17 offen offset:3072
    s_waitcnt vmcnt(3)
    v_mfma_f32_16x16x32_bf16 v[184:187], v[200:203], v[152:155], v[216:219]
    v_mfma_f32_16x16x32_bf16 v[188:191], v[200:203], v[168:171], v[220:223]
    s_waitcnt vmcnt(2)
    v_mfma_f32_16x16x32_bf16 v[192:195], v[204:207], v[152:155], v[216:219]
    v_mfma_f32_16x16x32_bf16 v[196:199], v[204:207], v[168:171], v[220:223]
    s_waitcnt vmcnt(1)
    v_mfma_f32_16x16x32_bf16 v[184:187], v[208:211], v[156:159], v[184:187]
    v_mfma_f32_16x16x32_bf16 v[188:191], v[208:211], v[172:175], v[188:191]
    s_waitcnt vmcnt(0)
    v_mfma_f32_16x16x32_bf16 v[192:195], v[212:215], v[156:159], v[192:195]
    v_mfma_f32_16x16x32_bf16 v[196:199], v[212:215], v[172:175], v[196:199]
    s_mov_b32 s17, 0x13000
    buffer_load_dwordx4 v[200:203], v8, s[8:11], s17 offen offset:0
    buffer_load_dwordx4 v[204:207], v8, s[8:11], s17 offen offset:1024
    buffer_load_dwordx4 v[208:211], v8, s[8:11], s17 offen offset:2048
    buffer_load_dwordx4 v[212:215], v8, s[8:11], s17 offen offset:3072
    s_waitcnt vmcnt(3)
    v_mfma_f32_16x16x32_bf16 v[184:187], v[200:203], v[160:163], v[184:187]
    v_mfma_f32_16x16x32_bf16 v[188:191], v[200:203], v[176:179], v[188:191]
    s_waitcnt vmcnt(2)
    v_mfma_f32_16x16x32_bf16 v[192:195], v[204:207], v[160:163], v[192:195]
    v_mfma_f32_16x16x32_bf16 v[196:199], v[204:207], v[176:179], v[196:199]
    s_waitcnt vmcnt(1)
    v_mfma_f32_16x16x32_bf16 v[184:187], v[208:211], v[164:167], v[184:187]
    v_mfma_f32_16x16x32_bf16 v[188:191], v[208:211], v[180:183], v[188:191]
    s_waitcnt vmcnt(0)
    v_mfma_f32_16x16x32_bf16 v[192:195], v[212:215], v[164:167], v[192:195]
    v_mfma_f32_16x16x32_bf16 v[196:199], v[212:215], v[180:183], v[196:199]
    s_nop 3
    v_exp_f32 v184, v184
    v_exp_f32 v185, v185
    v_add_f32 v9, v9, v184
    v_add_f32 v9, v9, v185
    v_cvt_pk_bf16_f32 v96, v184, v185
    v_exp_f32 v186, v186
    v_exp_f32 v187, v187
    v_add_f32 v9, v9, v186
    v_add_f32 v9, v9, v187
    v_cvt_pk_bf16_f32 v97, v186, v187
    v_exp_f32 v188, v188
    v_exp_f32 v189, v189
    v_add_f32 v10, v10, v188
    v_add_f32 v10, v10, v189
    v_cvt_pk_bf16_f32 v100, v188, v189
    v_exp_f32 v190, v190
    v_exp_f32 v191, v191
    v_add_f32 v10, v10, v190
    v_add_f32 v10, v10, v191
    v_cvt_pk_bf16_f32 v101, v190, v191
    v_exp_f32 v192, v192
    v_exp_f32 v193, v193
    v_add_f32 v9, v9, v192
    v_add_f32 v9, v9, v193
    v_cvt_pk_bf16_f32 v98, v192, v193
    v_exp_f32 v194, v194
    v_exp_f32 v195, v195
    v_add_f32 v9, v9, v194
    v_add_f32 v9, v9, v195
    v_cvt_pk_bf16_f32 v99, v194, v195
    v_exp_f32 v196, v196
    v_exp_f32 v197, v197
    v_add_f32 v10, v10, v196
    v_add_f32 v10, v10, v197
    v_cvt_pk_bf16_f32 v102, v196, v197
    v_exp_f32 v198, v198
    v_exp_f32 v199, v199
    v_add_f32 v10, v10, v198
    v_add_f32 v10, v10, v199
    v_cvt_pk_bf16_f32 v103, v198, v199
    s_mov_b32 s17, 0x14000
    buffer_load_dwordx4 v[200:203], v8, s[8:11], s17 offen offset:0
    buffer_load_dwordx4 v[204:207], v8, s[8:11], s17 offen offset:1024
    buffer_load_dwordx4 v[208:211], v8, s[8:11], s17 offen offset:2048
    buffer_load_dwordx4 v[212:215], v8, s[8:11], s17 offen offset:3072
    s_waitcnt vmcnt(3)
    v_mfma_f32_16x16x32_bf16 v[184:187], v[200:203], v[152:155], v[216:219]
    v_mfma_f32_16x16x32_bf16 v[188:191], v[200:203], v[168:171], v[220:223]
    s_waitcnt vmcnt(2)
    v_mfma_f32_16x16x32_bf16 v[192:195], v[204:207], v[152:155], v[216:219]
    v_mfma_f32_16x16x32_bf16 v[196:199], v[204:207], v[168:171], v[220:223]
    s_waitcnt vmcnt(1)
    v_mfma_f32_16x16x32_bf16 v[184:187], v[208:211], v[156:159], v[184:187]
    v_mfma_f32_16x16x32_bf16 v[188:191], v[208:211], v[172:175], v[188:191]
    s_waitcnt vmcnt(0)
    v_mfma_f32_16x16x32_bf16 v[192:195], v[212:215], v[156:159], v[192:195]
    v_mfma_f32_16x16x32_bf16 v[196:199], v[212:215], v[172:175], v[196:199]
    s_mov_b32 s17, 0x15000
    buffer_load_dwordx4 v[200:203], v8, s[8:11], s17 offen offset:0
    buffer_load_dwordx4 v[204:207], v8, s[8:11], s17 offen offset:1024
    buffer_load_dwordx4 v[208:211], v8, s[8:11], s17 offen offset:2048
    buffer_load_dwordx4 v[212:215], v8, s[8:11], s17 offen offset:3072
    s_waitcnt vmcnt(3)
    v_mfma_f32_16x16x32_bf16 v[184:187], v[200:203], v[160:163], v[184:187]
    v_mfma_f32_16x16x32_bf16 v[188:191], v[200:203], v[176:179], v[188:191]
    s_waitcnt vmcnt(2)
    v_mfma_f32_16x16x32_bf16 v[192:195], v[204:207], v[160:163], v[192:195]
    v_mfma_f32_16x16x32_bf16 v[196:199], v[204:207], v[176:179], v[196:199]
    s_waitcnt vmcnt(1)
    v_mfma_f32_16x16x32_bf16 v[184:187], v[208:211], v[164:167], v[184:187]
    v_mfma_f32_16x16x32_bf16 v[188:191], v[208:211], v[180:183], v[188:191]
    s_waitcnt vmcnt(0)
    v_mfma_f32_16x16x32_bf16 v[192:195], v[212:215], v[164:167], v[192:195]
    v_mfma_f32_16x16x32_bf16 v[196:199], v[212:215], v[180:183], v[196:199]
    s_nop 3
    v_exp_f32 v184, v184
    v_exp_f32 v185, v185
    v_add_f32 v9, v9, v184
    v_add_f32 v9, v9, v185
    v_cvt_pk_bf16_f32 v104, v184, v185
    v_exp_f32 v186, v186
    v_exp_f32 v187, v187
    v_add_f32 v9, v9, v186
    v_add_f32 v9, v9, v187
    v_cvt_pk_bf16_f32 v105, v186, v187
    v_exp_f32 v188, v188
    v_exp_f32 v189, v189
    v_add_f32 v10, v10, v188
    v_add_f32 v10, v10, v189
    v_cvt_pk_bf16_f32 v108, v188, v189
    v_exp_f32 v190, v190
    v_exp_f32 v191, v191
    v_add_f32 v10, v10, v190
    v_add_f32 v10, v10, v191
    v_cvt_pk_bf16_f32 v109, v190, v191
    v_exp_f32 v192, v192
    v_exp_f32 v193, v193
    v_add_f32 v9, v9, v192
    v_add_f32 v9, v9, v193
    v_cvt_pk_bf16_f32 v106, v192, v193
    v_exp_f32 v194, v194
    v_exp_f32 v195, v195
    v_add_f32 v9, v9, v194
    v_add_f32 v9, v9, v195
    v_cvt_pk_bf16_f32 v107, v194, v195
    v_exp_f32 v196, v196
    v_exp_f32 v197, v197
    v_add_f32 v10, v10, v196
    v_add_f32 v10, v10, v197
    v_cvt_pk_bf16_f32 v110, v196, v197
    v_exp_f32 v198, v198
    v_exp_f32 v199, v199
    v_add_f32 v10, v10, v198
    v_add_f32 v10, v10, v199
    v_cvt_pk_bf16_f32 v111, v198, v199
    s_mov_b32 s17, 0x16000
    buffer_load_dwordx4 v[200:203], v8, s[8:11], s17 offen offset:0
    buffer_load_dwordx4 v[204:207], v8, s[8:11], s17 offen offset:1024
    buffer_load_dwordx4 v[208:211], v8, s[8:11], s17 offen offset:2048
    buffer_load_dwordx4 v[212:215], v8, s[8:11], s17 offen offset:3072
    s_waitcnt vmcnt(3)
    v_mfma_f32_16x16x32_bf16 v[184:187], v[200:203], v[152:155], v[216:219]
    v_mfma_f32_16x16x32_bf16 v[188:191], v[200:203], v[168:171], v[220:223]
    s_waitcnt vmcnt(2)
    v_mfma_f32_16x16x32_bf16 v[192:195], v[204:207], v[152:155], v[216:219]
    v_mfma_f32_16x16x32_bf16 v[196:199], v[204:207], v[168:171], v[220:223]
    s_waitcnt vmcnt(1)
    v_mfma_f32_16x16x32_bf16 v[184:187], v[208:211], v[156:159], v[184:187]
    v_mfma_f32_16x16x32_bf16 v[188:191], v[208:211], v[172:175], v[188:191]
    s_waitcnt vmcnt(0)
    v_mfma_f32_16x16x32_bf16 v[192:195], v[212:215], v[156:159], v[192:195]
    v_mfma_f32_16x16x32_bf16 v[196:199], v[212:215], v[172:175], v[196:199]
    s_mov_b32 s17, 0x17000
    buffer_load_dwordx4 v[200:203], v8, s[8:11], s17 offen offset:0
    buffer_load_dwordx4 v[204:207], v8, s[8:11], s17 offen offset:1024
    buffer_load_dwordx4 v[208:211], v8, s[8:11], s17 offen offset:2048
    buffer_load_dwordx4 v[212:215], v8, s[8:11], s17 offen offset:3072
    s_waitcnt vmcnt(3)
    v_mfma_f32_16x16x32_bf16 v[184:187], v[200:203], v[160:163], v[184:187]
    v_mfma_f32_16x16x32_bf16 v[188:191], v[200:203], v[176:179], v[188:191]
    s_waitcnt vmcnt(2)
    v_mfma_f32_16x16x32_bf16 v[192:195], v[204:207], v[160:163], v[192:195]
    v_mfma_f32_16x16x32_bf16 v[196:199], v[204:207], v[176:179], v[196:199]
    s_waitcnt vmcnt(1)
    v_mfma_f32_16x16x32_bf16 v[184:187], v[208:211], v[164:167], v[184:187]
    v_mfma_f32_16x16x32_bf16 v[188:191], v[208:211], v[180:183], v[188:191]
    s_waitcnt vmcnt(0)
    v_mfma_f32_16x16x32_bf16 v[192:195], v[212:215], v[164:167], v[192:195]
    v_mfma_f32_16x16x32_bf16 v[196:199], v[212:215], v[180:183], v[196:199]
    s_nop 3
    v_exp_f32 v184, v184
    v_exp_f32 v185, v185
    v_add_f32 v9, v9, v184
    v_add_f32 v9, v9, v185
    v_cvt_pk_bf16_f32 v112, v184, v185
    v_exp_f32 v186, v186
    v_exp_f32 v187, v187
    v_add_f32 v9, v9, v186
    v_add_f32 v9, v9, v187
    v_cvt_pk_bf16_f32 v113, v186, v187
    v_exp_f32 v188, v188
    v_exp_f32 v189, v189
    v_add_f32 v10, v10, v188
    v_add_f32 v10, v10, v189
    v_cvt_pk_bf16_f32 v116, v188, v189
    v_exp_f32 v190, v190
    v_exp_f32 v191, v191
    v_add_f32 v10, v10, v190
    v_add_f32 v10, v10, v191
    v_cvt_pk_bf16_f32 v117, v190, v191
    v_exp_f32 v192, v192
    v_exp_f32 v193, v193
    v_add_f32 v9, v9, v192
    v_add_f32 v9, v9, v193
    v_cvt_pk_bf16_f32 v114, v192, v193
    v_exp_f32 v194, v194
    v_exp_f32 v195, v195
    v_add_f32 v9, v9, v194
    v_add_f32 v9, v9, v195
    v_cvt_pk_bf16_f32 v115, v194, v195
    v_exp_f32 v196, v196
    v_exp_f32 v197, v197
    v_add_f32 v10, v10, v196
    v_add_f32 v10, v10, v197
    v_cvt_pk_bf16_f32 v118, v196, v197
    v_exp_f32 v198, v198
    v_exp_f32 v199, v199
    v_add_f32 v10, v10, v198
    v_add_f32 v10, v10, v199
    v_cvt_pk_bf16_f32 v119, v198, v199
    s_mov_b32 s17, 0x18000
    buffer_load_dwordx4 v[200:203], v8, s[8:11], s17 offen offset:0
    buffer_load_dwordx4 v[204:207], v8, s[8:11], s17 offen offset:1024
    buffer_load_dwordx4 v[208:211], v8, s[8:11], s17 offen offset:2048
    buffer_load_dwordx4 v[212:215], v8, s[8:11], s17 offen offset:3072
    s_waitcnt vmcnt(3)
    v_mfma_f32_16x16x32_bf16 v[184:187], v[200:203], v[152:155], v[216:219]
    v_mfma_f32_16x16x32_bf16 v[188:191], v[200:203], v[168:171], v[220:223]
    s_waitcnt vmcnt(2)
    v_mfma_f32_16x16x32_bf16 v[192:195], v[204:207], v[152:155], v[216:219]
    v_mfma_f32_16x16x32_bf16 v[196:199], v[204:207], v[168:171], v[220:223]
    s_waitcnt vmcnt(1)
    v_mfma_f32_16x16x32_bf16 v[184:187], v[208:211], v[156:159], v[184:187]
    v_mfma_f32_16x16x32_bf16 v[188:191], v[208:211], v[172:175], v[188:191]
    s_waitcnt vmcnt(0)
    v_mfma_f32_16x16x32_bf16 v[192:195], v[212:215], v[156:159], v[192:195]
    v_mfma_f32_16x16x32_bf16 v[196:199], v[212:215], v[172:175], v[196:199]
    s_mov_b32 s17, 0x19000
    buffer_load_dwordx4 v[200:203], v8, s[8:11], s17 offen offset:0
    buffer_load_dwordx4 v[204:207], v8, s[8:11], s17 offen offset:1024
    buffer_load_dwordx4 v[208:211], v8, s[8:11], s17 offen offset:2048
    buffer_load_dwordx4 v[212:215], v8, s[8:11], s17 offen offset:3072
    s_waitcnt vmcnt(3)
    v_mfma_f32_16x16x32_bf16 v[184:187], v[200:203], v[160:163], v[184:187]
    v_mfma_f32_16x16x32_bf16 v[188:191], v[200:203], v[176:179], v[188:191]
    s_waitcnt vmcnt(2)
    v_mfma_f32_16x16x32_bf16 v[192:195], v[204:207], v[160:163], v[192:195]
    v_mfma_f32_16x16x32_bf16 v[196:199], v[204:207], v[176:179], v[196:199]
    s_waitcnt vmcnt(1)
    v_mfma_f32_16x16x32_bf16 v[184:187], v[208:211], v[164:167], v[184:187]
    v_mfma_f32_16x16x32_bf16 v[188:191], v[208:211], v[180:183], v[188:191]
    s_waitcnt vmcnt(0)
    v_mfma_f32_16x16x32_bf16 v[192:195], v[212:215], v[164:167], v[192:195]
    v_mfma_f32_16x16x32_bf16 v[196:199], v[212:215], v[180:183], v[196:199]
    s_nop 3
    v_exp_f32 v184, v184
    v_exp_f32 v185, v185
    v_add_f32 v9, v9, v184
    v_add_f32 v9, v9, v185
    v_cvt_pk_bf16_f32 v120, v184, v185
    v_exp_f32 v186, v186
    v_exp_f32 v187, v187
    v_add_f32 v9, v9, v186
    v_add_f32 v9, v9, v187
    v_cvt_pk_bf16_f32 v121, v186, v187
    v_exp_f32 v188, v188
    v_exp_f32 v189, v189
    v_add_f32 v10, v10, v188
    v_add_f32 v10, v10, v189
    v_cvt_pk_bf16_f32 v124, v188, v189
    v_exp_f32 v190, v190
    v_exp_f32 v191, v191
    v_add_f32 v10, v10, v190
    v_add_f32 v10, v10, v191
    v_cvt_pk_bf16_f32 v125, v190, v191
    v_exp_f32 v192, v192
    v_exp_f32 v193, v193
    v_add_f32 v9, v9, v192
    v_add_f32 v9, v9, v193
    v_cvt_pk_bf16_f32 v122, v192, v193
    v_exp_f32 v194, v194
    v_exp_f32 v195, v195
    v_add_f32 v9, v9, v194
    v_add_f32 v9, v9, v195
    v_cvt_pk_bf16_f32 v123, v194, v195
    v_exp_f32 v196, v196
    v_exp_f32 v197, v197
    v_add_f32 v10, v10, v196
    v_add_f32 v10, v10, v197
    v_cvt_pk_bf16_f32 v126, v196, v197
    v_exp_f32 v198, v198
    v_exp_f32 v199, v199
    v_add_f32 v10, v10, v198
    v_add_f32 v10, v10, v199
    v_cvt_pk_bf16_f32 v127, v198, v199
    s_mov_b32 s17, 0x1a000
    buffer_load_dwordx4 v[200:203], v8, s[8:11], s17 offen offset:0
    buffer_load_dwordx4 v[204:207], v8, s[8:11], s17 offen offset:1024
    buffer_load_dwordx4 v[208:211], v8, s[8:11], s17 offen offset:2048
    buffer_load_dwordx4 v[212:215], v8, s[8:11], s17 offen offset:3072
    s_waitcnt vmcnt(3)
    v_mfma_f32_16x16x32_bf16 v[184:187], v[200:203], v[152:155], v[216:219]
    v_mfma_f32_16x16x32_bf16 v[188:191], v[200:203], v[168:171], v[220:223]
    s_waitcnt vmcnt(2)
    v_mfma_f32_16x16x32_bf16 v[192:195], v[204:207], v[152:155], v[216:219]
    v_mfma_f32_16x16x32_bf16 v[196:199], v[204:207], v[168:171], v[220:223]
    s_waitcnt vmcnt(1)
    v_mfma_f32_16x16x32_bf16 v[184:187], v[208:211], v[156:159], v[184:187]
    v_mfma_f32_16x16x32_bf16 v[188:191], v[208:211], v[172:175], v[188:191]
    s_waitcnt vmcnt(0)
    v_mfma_f32_16x16x32_bf16 v[192:195], v[212:215], v[156:159], v[192:195]
    v_mfma_f32_16x16x32_bf16 v[196:199], v[212:215], v[172:175], v[196:199]
    s_mov_b32 s17, 0x1b000
    buffer_load_dwordx4 v[200:203], v8, s[8:11], s17 offen offset:0
    buffer_load_dwordx4 v[204:207], v8, s[8:11], s17 offen offset:1024
    buffer_load_dwordx4 v[208:211], v8, s[8:11], s17 offen offset:2048
    buffer_load_dwordx4 v[212:215], v8, s[8:11], s17 offen offset:3072
    s_waitcnt vmcnt(3)
    v_mfma_f32_16x16x32_bf16 v[184:187], v[200:203], v[160:163], v[184:187]
    v_mfma_f32_16x16x32_bf16 v[188:191], v[200:203], v[176:179], v[188:191]
    s_waitcnt vmcnt(2)
    v_mfma_f32_16x16x32_bf16 v[192:195], v[204:207], v[160:163], v[192:195]
    v_mfma_f32_16x16x32_bf16 v[196:199], v[204:207], v[176:179], v[196:199]
    s_waitcnt vmcnt(1)
    v_mfma_f32_16x16x32_bf16 v[184:187], v[208:211], v[164:167], v[184:187]
    v_mfma_f32_16x16x32_bf16 v[188:191], v[208:211], v[180:183], v[188:191]
    s_waitcnt vmcnt(0)
    v_mfma_f32_16x16x32_bf16 v[192:195], v[212:215], v[164:167], v[192:195]
    v_mfma_f32_16x16x32_bf16 v[196:199], v[212:215], v[180:183], v[196:199]
    s_nop 3
    v_exp_f32 v184, v184
    v_exp_f32 v185, v185
    v_add_f32 v9, v9, v184
    v_add_f32 v9, v9, v185
    v_cvt_pk_bf16_f32 v128, v184, v185
    v_exp_f32 v186, v186
    v_exp_f32 v187, v187
    v_add_f32 v9, v9, v186
    v_add_f32 v9, v9, v187
    v_cvt_pk_bf16_f32 v129, v186, v187
    v_exp_f32 v188, v188
    v_exp_f32 v189, v189
    v_add_f32 v10, v10, v188
    v_add_f32 v10, v10, v189
    v_cvt_pk_bf16_f32 v132, v188, v189
    v_exp_f32 v190, v190
    v_exp_f32 v191, v191
    v_add_f32 v10, v10, v190
    v_add_f32 v10, v10, v191
    v_cvt_pk_bf16_f32 v133, v190, v191
    v_exp_f32 v192, v192
    v_exp_f32 v193, v193
    v_add_f32 v9, v9, v192
    v_add_f32 v9, v9, v193
    v_cvt_pk_bf16_f32 v130, v192, v193
    v_exp_f32 v194, v194
    v_exp_f32 v195, v195
    v_add_f32 v9, v9, v194
    v_add_f32 v9, v9, v195
    v_cvt_pk_bf16_f32 v131, v194, v195
    v_exp_f32 v196, v196
    v_exp_f32 v197, v197
    v_add_f32 v10, v10, v196
    v_add_f32 v10, v10, v197
    v_cvt_pk_bf16_f32 v134, v196, v197
    v_exp_f32 v198, v198
    v_exp_f32 v199, v199
    v_add_f32 v10, v10, v198
    v_add_f32 v10, v10, v199
    v_cvt_pk_bf16_f32 v135, v198, v199
    s_mov_b32 s17, 0x1c000
    buffer_load_dwordx4 v[200:203], v8, s[8:11], s17 offen offset:0
    buffer_load_dwordx4 v[204:207], v8, s[8:11], s17 offen offset:1024
    buffer_load_dwordx4 v[208:211], v8, s[8:11], s17 offen offset:2048
    buffer_load_dwordx4 v[212:215], v8, s[8:11], s17 offen offset:3072
    s_waitcnt vmcnt(3)
    v_mfma_f32_16x16x32_bf16 v[184:187], v[200:203], v[152:155], v[216:219]
    v_mfma_f32_16x16x32_bf16 v[188:191], v[200:203], v[168:171], v[220:223]
    s_waitcnt vmcnt(2)
    v_mfma_f32_16x16x32_bf16 v[192:195], v[204:207], v[152:155], v[216:219]
    v_mfma_f32_16x16x32_bf16 v[196:199], v[204:207], v[168:171], v[220:223]
    s_waitcnt vmcnt(1)
    v_mfma_f32_16x16x32_bf16 v[184:187], v[208:211], v[156:159], v[184:187]
    v_mfma_f32_16x16x32_bf16 v[188:191], v[208:211], v[172:175], v[188:191]
    s_waitcnt vmcnt(0)
    v_mfma_f32_16x16x32_bf16 v[192:195], v[212:215], v[156:159], v[192:195]
    v_mfma_f32_16x16x32_bf16 v[196:199], v[212:215], v[172:175], v[196:199]
    s_mov_b32 s17, 0x1d000
    buffer_load_dwordx4 v[200:203], v8, s[8:11], s17 offen offset:0
    buffer_load_dwordx4 v[204:207], v8, s[8:11], s17 offen offset:1024
    buffer_load_dwordx4 v[208:211], v8, s[8:11], s17 offen offset:2048
    buffer_load_dwordx4 v[212:215], v8, s[8:11], s17 offen offset:3072
    s_waitcnt vmcnt(3)
    v_mfma_f32_16x16x32_bf16 v[184:187], v[200:203], v[160:163], v[184:187]
    v_mfma_f32_16x16x32_bf16 v[188:191], v[200:203], v[176:179], v[188:191]
    s_waitcnt vmcnt(2)
    v_mfma_f32_16x16x32_bf16 v[192:195], v[204:207], v[160:163], v[192:195]
    v_mfma_f32_16x16x32_bf16 v[196:199], v[204:207], v[176:179], v[196:199]
    s_waitcnt vmcnt(1)
    v_mfma_f32_16x16x32_bf16 v[184:187], v[208:211], v[164:167], v[184:187]
    v_mfma_f32_16x16x32_bf16 v[188:191], v[208:211], v[180:183], v[188:191]
    s_waitcnt vmcnt(0)
    v_mfma_f32_16x16x32_bf16 v[192:195], v[212:215], v[164:167], v[192:195]
    v_mfma_f32_16x16x32_bf16 v[196:199], v[212:215], v[180:183], v[196:199]
    s_nop 3
    v_exp_f32 v184, v184
    v_exp_f32 v185, v185
    v_add_f32 v9, v9, v184
    v_add_f32 v9, v9, v185
    v_cvt_pk_bf16_f32 v136, v184, v185
    v_exp_f32 v186, v186
    v_exp_f32 v187, v187
    v_add_f32 v9, v9, v186
    v_add_f32 v9, v9, v187
    v_cvt_pk_bf16_f32 v137, v186, v187
    v_exp_f32 v188, v188
    v_exp_f32 v189, v189
    v_add_f32 v10, v10, v188
    v_add_f32 v10, v10, v189
    v_cvt_pk_bf16_f32 v140, v188, v189
    v_exp_f32 v190, v190
    v_exp_f32 v191, v191
    v_add_f32 v10, v10, v190
    v_add_f32 v10, v10, v191
    v_cvt_pk_bf16_f32 v141, v190, v191
    v_exp_f32 v192, v192
    v_exp_f32 v193, v193
    v_add_f32 v9, v9, v192
    v_add_f32 v9, v9, v193
    v_cvt_pk_bf16_f32 v138, v192, v193
    v_exp_f32 v194, v194
    v_exp_f32 v195, v195
    v_add_f32 v9, v9, v194
    v_add_f32 v9, v9, v195
    v_cvt_pk_bf16_f32 v139, v194, v195
    v_exp_f32 v196, v196
    v_exp_f32 v197, v197
    v_add_f32 v10, v10, v196
    v_add_f32 v10, v10, v197
    v_cvt_pk_bf16_f32 v142, v196, v197
    v_exp_f32 v198, v198
    v_exp_f32 v199, v199
    v_add_f32 v10, v10, v198
    v_add_f32 v10, v10, v199
    v_cvt_pk_bf16_f32 v143, v198, v199
    s_mov_b32 s17, 0x1e000
    buffer_load_dwordx4 v[200:203], v8, s[8:11], s17 offen offset:0
    buffer_load_dwordx4 v[204:207], v8, s[8:11], s17 offen offset:1024
    buffer_load_dwordx4 v[208:211], v8, s[8:11], s17 offen offset:2048
    buffer_load_dwordx4 v[212:215], v8, s[8:11], s17 offen offset:3072
    s_waitcnt vmcnt(3)
    v_mfma_f32_16x16x32_bf16 v[184:187], v[200:203], v[152:155], v[216:219]
    v_mfma_f32_16x16x32_bf16 v[188:191], v[200:203], v[168:171], v[220:223]
    s_waitcnt vmcnt(2)
    v_mfma_f32_16x16x32_bf16 v[192:195], v[204:207], v[152:155], v[216:219]
    v_mfma_f32_16x16x32_bf16 v[196:199], v[204:207], v[168:171], v[220:223]
    s_waitcnt vmcnt(1)
    v_mfma_f32_16x16x32_bf16 v[184:187], v[208:211], v[156:159], v[184:187]
    v_mfma_f32_16x16x32_bf16 v[188:191], v[208:211], v[172:175], v[188:191]
    s_waitcnt vmcnt(0)
    v_mfma_f32_16x16x32_bf16 v[192:195], v[212:215], v[156:159], v[192:195]
    v_mfma_f32_16x16x32_bf16 v[196:199], v[212:215], v[172:175], v[196:199]
    s_mov_b32 s17, 0x1f000
    buffer_load_dwordx4 v[200:203], v8, s[8:11], s17 offen offset:0
    buffer_load_dwordx4 v[204:207], v8, s[8:11], s17 offen offset:1024
    buffer_load_dwordx4 v[208:211], v8, s[8:11], s17 offen offset:2048
    buffer_load_dwordx4 v[212:215], v8, s[8:11], s17 offen offset:3072
    s_waitcnt vmcnt(3)
    v_mfma_f32_16x16x32_bf16 v[184:187], v[200:203], v[160:163], v[184:187]
    v_mfma_f32_16x16x32_bf16 v[188:191], v[200:203], v[176:179], v[188:191]
    s_waitcnt vmcnt(2)
    v_mfma_f32_16x16x32_bf16 v[192:195], v[204:207], v[160:163], v[192:195]
    v_mfma_f32_16x16x32_bf16 v[196:199], v[204:207], v[176:179], v[196:199]
    s_waitcnt vmcnt(1)
    v_mfma_f32_16x16x32_bf16 v[184:187], v[208:211], v[164:167], v[184:187]
    v_mfma_f32_16x16x32_bf16 v[188:191], v[208:211], v[180:183], v[188:191]
    s_waitcnt vmcnt(0)
    v_mfma_f32_16x16x32_bf16 v[192:195], v[212:215], v[164:167], v[192:195]
    v_mfma_f32_16x16x32_bf16 v[196:199], v[212:215], v[180:183], v[196:199]
    s_nop 3
    v_exp_f32 v184, v184
    v_exp_f32 v185, v185
    v_add_f32 v9, v9, v184
    v_add_f32 v9, v9, v185
    v_cvt_pk_bf16_f32 v144, v184, v185
    v_exp_f32 v186, v186
    v_exp_f32 v187, v187
    v_add_f32 v9, v9, v186
    v_add_f32 v9, v9, v187
    v_cvt_pk_bf16_f32 v145, v186, v187
    v_exp_f32 v188, v188
    v_exp_f32 v189, v189
    v_add_f32 v10, v10, v188
    v_add_f32 v10, v10, v189
    v_cvt_pk_bf16_f32 v148, v188, v189
    v_exp_f32 v190, v190
    v_exp_f32 v191, v191
    v_add_f32 v10, v10, v190
    v_add_f32 v10, v10, v191
    v_cvt_pk_bf16_f32 v149, v190, v191
    v_exp_f32 v192, v192
    v_exp_f32 v193, v193
    v_add_f32 v9, v9, v192
    v_add_f32 v9, v9, v193
    v_cvt_pk_bf16_f32 v146, v192, v193
    v_exp_f32 v194, v194
    v_exp_f32 v195, v195
    v_add_f32 v9, v9, v194
    v_add_f32 v9, v9, v195
    v_cvt_pk_bf16_f32 v147, v194, v195
    v_exp_f32 v196, v196
    v_exp_f32 v197, v197
    v_add_f32 v10, v10, v196
    v_add_f32 v10, v10, v197
    v_cvt_pk_bf16_f32 v150, v196, v197
    v_exp_f32 v198, v198
    v_exp_f32 v199, v199
    v_add_f32 v10, v10, v198
    v_add_f32 v10, v10, v199
    v_cvt_pk_bf16_f32 v151, v198, v199
    v_mov_b32 v16, v9
    v_mov_b32 v18, v10
    s_nop 0
    v_permlane16_swap_b32 v9, v16
    v_permlane16_swap_b32 v10, v18
    v_add_f32 v9, v9, v16
    v_add_f32 v10, v10, v18
    v_mov_b32 v16, v9
    v_mov_b32 v18, v10
    s_nop 0
    v_permlane32_swap_b32 v9, v16
    v_permlane32_swap_b32 v10, v18
    v_add_f32 v9, v9, v16
    v_add_f32 v10, v10, v18
    s_waitcnt vmcnt(0) lgkmcnt(0)
    s_nop 15
    s_nop 3
    s_branch adaLN_cond__sliding_block_cached__moe_arch_mod__prompt_kernel_fixBb
adaLN_cond__sliding_block_cached__moe_arch_mod__prompt_kernel_o17r:
    s_waitcnt vmcnt(0) lgkmcnt(0)
    s_nop 15
    s_nop 3
    s_mov_b32 s27, 0
adaLN_cond__sliding_block_cached__moe_arch_mod__prompt_kernel_o17p:
    buffer_load_dword v12, v13, s[8:11], s19 offen sc1
    s_waitcnt vmcnt(0)
    v_cmp_ne_u32 vcc, s28, v12
    s_add_u32 s27, s27, 1
    s_cmp_ge_u32 s27, 65536
    s_cbranch_scc1 adaLN_cond__sliding_block_cached__moe_arch_mod__prompt_kernel_o17g
    s_cbranch_vccnz adaLN_cond__sliding_block_cached__moe_arch_mod__prompt_kernel_o17p
adaLN_cond__sliding_block_cached__moe_arch_mod__prompt_kernel_o17g:
    s_waitcnt vmcnt(0) lgkmcnt(0)
    s_nop 15
    s_nop 3
    s_branch adaLN_cond__sliding_block_cached__moe_arch_mod__prompt_kernel_o17b
adaLN_cond__sliding_block_cached__moe_arch_mod__prompt_kernel_o218r:
    s_waitcnt vmcnt(0) lgkmcnt(0)
    s_nop 15
    s_nop 3
    s_mov_b32 s27, 0
adaLN_cond__sliding_block_cached__moe_arch_mod__prompt_kernel_o218p:
    buffer_load_dword v12, v13, s[8:11], s19 offen sc1
    s_waitcnt vmcnt(0)
    v_cmp_ne_u32 vcc, s28, v12
    s_add_u32 s27, s27, 1
    s_cmp_ge_u32 s27, 65536
    s_cbranch_scc1 adaLN_cond__sliding_block_cached__moe_arch_mod__prompt_kernel_o218g
    s_cbranch_vccnz adaLN_cond__sliding_block_cached__moe_arch_mod__prompt_kernel_o218p
adaLN_cond__sliding_block_cached__moe_arch_mod__prompt_kernel_o218g:
    s_waitcnt vmcnt(0) lgkmcnt(0)
    s_nop 15
    s_nop 3
    s_branch adaLN_cond__sliding_block_cached__moe_arch_mod__prompt_kernel_o218b
adaLN_cond__sliding_block_cached__moe_arch_mod__prompt_kernel_o219r:
    s_waitcnt vmcnt(0) lgkmcnt(0)
    s_nop 15
    s_nop 3
    s_mov_b32 s27, 0
adaLN_cond__sliding_block_cached__moe_arch_mod__prompt_kernel_o219p:
    buffer_load_dword v12, v13, s[8:11], s19 offen sc1
    s_waitcnt vmcnt(0)
    v_cmp_ne_u32 vcc, s28, v12
    s_add_u32 s27, s27, 1
    s_cmp_ge_u32 s27, 65536
    s_cbranch_scc1 adaLN_cond__sliding_block_cached__moe_arch_mod__prompt_kernel_o219g
    s_cbranch_vccnz adaLN_cond__sliding_block_cached__moe_arch_mod__prompt_kernel_o219p
adaLN_cond__sliding_block_cached__moe_arch_mod__prompt_kernel_o219g:
    s_waitcnt vmcnt(0) lgkmcnt(0)
    s_nop 15
    s_nop 3
    s_branch adaLN_cond__sliding_block_cached__moe_arch_mod__prompt_kernel_o219b
adaLN_cond__sliding_block_cached__moe_arch_mod__prompt_kernel_o220r:
    s_waitcnt vmcnt(0) lgkmcnt(0)
    s_nop 15
    s_nop 3
    s_mov_b32 s27, 0
adaLN_cond__sliding_block_cached__moe_arch_mod__prompt_kernel_o220p:
    buffer_load_dword v12, v13, s[8:11], s19 offen sc1
    s_waitcnt vmcnt(0)
    v_cmp_ne_u32 vcc, s28, v12
    s_add_u32 s27, s27, 1
    s_cmp_ge_u32 s27, 65536
    s_cbranch_scc1 adaLN_cond__sliding_block_cached__moe_arch_mod__prompt_kernel_o220g
    s_cbranch_vccnz adaLN_cond__sliding_block_cached__moe_arch_mod__prompt_kernel_o220p
adaLN_cond__sliding_block_cached__moe_arch_mod__prompt_kernel_o220g:
    s_waitcnt vmcnt(0) lgkmcnt(0)
    s_nop 15
    s_nop 3
    s_branch adaLN_cond__sliding_block_cached__moe_arch_mod__prompt_kernel_o220b
adaLN_cond__sliding_block_cached__moe_arch_mod__prompt_kernel_mf21r:
    s_waitcnt vmcnt(0) lgkmcnt(0)
    s_nop 15
    s_nop 3
    s_mov_b32 s27, 0
adaLN_cond__sliding_block_cached__moe_arch_mod__prompt_kernel_mf21p:
    s_mov_b32 s16, 0x544000
    buffer_load_dwordx4 v[184:187], v2, s[8:11], s16 offen sc1
    s_waitcnt vmcnt(0)
    v_xor_b32 v16, s28, v184
    v_xor_b32 v17, s28, v185
    v_xor_b32 v18, s28, v186
    v_xor_b32 v19, s28, v187
    v_or3_b32 v16, v16, v17, v18
    v_or_b32 v16, v16, v19
    v_cmp_ne_u32 vcc, 0, v16
    s_add_u32 s27, s27, 1
    s_cmp_ge_u32 s27, 65536
    s_cbranch_scc1 adaLN_cond__sliding_block_cached__moe_arch_mod__prompt_kernel_mf21g
    s_cbranch_vccnz adaLN_cond__sliding_block_cached__moe_arch_mod__prompt_kernel_mf21p
adaLN_cond__sliding_block_cached__moe_arch_mod__prompt_kernel_mf21g:
    s_waitcnt vmcnt(0) lgkmcnt(0)
    s_nop 15
    s_nop 3
    s_branch adaLN_cond__sliding_block_cached__moe_arch_mod__prompt_kernel_mf21b
adaLN_cond__sliding_block_cached__moe_arch_mod__prompt_kernel_codeend:
    s_endpgm
.section .rodata,"a"
.p2align 6
.amdhsa_kernel adaLN_cond__sliding_block_cached__moe_arch_mod__prompt_kernel
  .amdhsa_next_free_vgpr 256
  .amdhsa_next_free_sgpr 80
  .amdhsa_accum_offset 256
  .amdhsa_group_segment_fixed_size 0
  .amdhsa_kernarg_size 120
  .amdhsa_user_sgpr_count 2
  .amdhsa_user_sgpr_kernarg_segment_ptr 1
  .amdhsa_system_sgpr_workgroup_id_x 1
  .amdhsa_float_denorm_mode_32 3
.end_amdhsa_kernel
```
